```python
import torch

def _softmax(x, axis=-1):
    return torch.softmax(x, dim=axis)
def _gelu(x):
    return torch.nn.functional.gelu(x, approximate="tanh")
def _silu(x):
    return torch.nn.functional.silu(x)
def _sigmoid(x):
    return torch.sigmoid(x)
def _layernorm(x, axis=-1, eps=1e-5):
    m = x.mean(dim=axis, keepdim=True)
    v = x.var(dim=axis, keepdim=True, unbiased=False)
    return (x - m) / torch.sqrt(v + eps)
def _scatter_add(tgt, idx, src, axis=0):
    return tgt.clone().index_add_(axis, idx, src)
def _segment_sum(src, seg, n):
    out = torch.zeros((n,) + src.shape[1:], dtype=src.dtype)
    return out.index_add_(0, seg, src)
def _pad(x, pw):
    flat = tuple(v for pair in reversed(pw) for v in pair)
    return torch.nn.functional.pad(x, flat)

kernel_name = 'gated_mix__compressed_kv_cla__ssm_conv_h3__prompt'

def setup_inputs():

    _w = (lambda a: (lambda t: t.to(torch.bfloat16) if t.is_floating_point() else t)(torch.as_tensor(a)))
    def _A_setup():
        B, H, Sq, Sk, D, M = 1, 32, 2048, 2048, 128, 1024
        Dc = 4 * D
        return {
            "x": _w((lambda *s: torch.randn(*s, dtype=torch.bfloat16) * 0.05)(B, Sq, M)),
            "c_kv": _w((lambda *s: torch.randn(*s, dtype=torch.bfloat16) * 0.8)(B, Sk, Dc)),
            "w_q": _w((lambda *s: torch.randn(*s, dtype=torch.bfloat16) * 6.4)(M, H, D) * (M ** -0.5)),
            "w_uk": _w((lambda *s: torch.randn(*s, dtype=torch.bfloat16) * 6.4)(Dc, H, D) * (Dc ** -0.5)),
            "w_uv": _w((lambda *s: torch.randn(*s, dtype=torch.bfloat16) * 0.8)(Dc, H, D) * (Dc ** -0.5)),
            "w_o": _w((lambda *s: torch.randn(*s, dtype=torch.bfloat16) * 0.8)(H, D, M) * ((H * D) ** -0.5)),
        }
    _A_in = _A_setup()

    def _B_setup():
        B, S, D = 1, 2048, 1024
        ks = 4
        return {
            "q": _w((lambda *s: torch.randn(*s, dtype=torch.bfloat16) * 0.05)(B, S, D)),
            "k": _w((lambda *s: torch.randn(*s, dtype=torch.bfloat16) * 0.8)(B, S, D)),
            "v": _w((lambda *s: torch.randn(*s, dtype=torch.bfloat16) * 0.8)(B, S, D)),
            "shift_k": _w((lambda *s: torch.randn(*s, dtype=torch.bfloat16) * 0.8)(D, ks) * 0.5),
            "ssm_k": _w((lambda *s: torch.randn(*s, dtype=torch.bfloat16) * 1.6)(D, S) * (1.0 / S ** 0.5)),
            "ssm_D": _w((lambda *s: torch.randn(*s, dtype=torch.bfloat16) * 0.8)(D)),
        }
    _B_in = _B_setup()

    return {
        "A_x": _A_in["x"],
        "A_c_kv": _A_in["c_kv"],
        "A_w_q": _A_in["w_q"],
        "A_w_uk": _A_in["w_uk"],
        "A_w_uv": _A_in["w_uv"],
        "A_w_o": _A_in["w_o"],
        "B_q": _B_in["q"],
        "B_k": _B_in["k"],
        "B_v": _B_in["v"],
        "B_shift_k": _B_in["shift_k"],
        "B_ssm_k": _B_in["ssm_k"],
        "B_ssm_D": _B_in["ssm_D"],
        "gate_w": _w((lambda *s: torch.randn(*s, dtype=torch.bfloat16) * 0.05)(1024) * 16.0),
    }

def reference(A_x, A_c_kv, A_w_q, A_w_uk, A_w_uv, A_w_o, B_q, B_k, B_v, B_shift_k, B_ssm_k, B_ssm_D, gate_w):
    def _A_ref(x, c_kv, w_q, w_uk, w_uv, w_o):
        B, Sq, M = x.shape[0], x.shape[1], x.shape[2]
        Sk = c_kv.shape[1]
        H, D = w_q.shape[1], w_q.shape[2]
        q = torch.einsum("bqm,mhd->bhqd", x, w_q)
        k = torch.einsum("bkc,chd->bhkd", c_kv, w_uk)
        v = torch.einsum("bkc,chd->bhkd", c_kv, w_uv)
        scores = torch.einsum("bhqd,bhkd->bhqk", q, k) * (D ** -0.5)
        off = Sk - Sq
        qi = torch.arange(Sq)[:, None]
        kj = torch.arange(Sk)[None, :]
        cmask = kj <= (qi + off)
        scores = torch.where(cmask[None, None], scores, -1e9)
        p = _softmax(scores, axis=-1)
        ctx = torch.einsum("bhqk,bhkd->bhqd", p, v)
        return torch.einsum("bhqd,hdm->bqm", ctx, w_o)

    def _B_ref(q, k, v, shift_k, ssm_k, ssm_D):
        B, S, D = q.shape
        ks = shift_k.shape[-1]
        k_pad = _pad(k, ((0, 0), (ks - 1, 0), (0, 0)))
        k_shift = torch.zeros_like(k)
        for t in range(ks):
            k_shift = k_shift + k_pad[:, t:t + S, :] * shift_k[:, ks - 1 - t][None, None, :]
        kv = k_shift * v
        L = 2 * S
        kv_pad = _pad(kv, ((0, 0), (0, S), (0, 0)))
        kf_pad = _pad(ssm_k, ((0, 0), (0, S)))
        kv_f = (lambda x, axes=(-2,-1): torch.fft.rfft2(x.float(), dim=axes))(kv_pad[:, None, :, :], axes=(1, 2))
        kf_f = (lambda x, axes=(-2,-1): torch.fft.rfft2(x.float(), dim=axes))(kf_pad[:, None, :], axes=(1, 2))
        kf_f = (lambda x, *d: x.permute(*d))(kf_f, 1, 2, 0)
        y_f = kv_f * kf_f[None, :, :, :]
        y = (lambda x, s, axes=(-2,-1): torch.fft.irfft2(x, s=s, dim=axes).to(torch.bfloat16))(y_f, (1, L), axes=(1, 2))[:, 0, :S, :]
        y = y + kv * ssm_D[None, None, :]
        return q * y

    x = A_x
    g = _sigmoid((x * gate_w).sum(-1, keepdims=True))
    a = _A_ref(x, A_c_kv, A_w_q, A_w_uk, A_w_uv, A_w_o)
    b = _B_ref(x, B_k, B_v, B_shift_k, B_ssm_k, B_ssm_D)
    return g * a + (1 - g) * b
```

```asm
; @launch grid=(256,1,1) block=(256,1,1) lds=163840
.amdgcn_target "amdgcn-amd-amdhsa--gfx950"
.text
.globl gated_mix__compressed_kv_cla__ssm_conv_h3__prompt_kernel
.p2align 8
.type gated_mix__compressed_kv_cla__ssm_conv_h3__prompt_kernel,@function
gated_mix__compressed_kv_cla__ssm_conv_h3__prompt_kernel:
s_cmp_ge_u32 s2, 256
s_cbranch_scc1 Lend
s_load_dwordx2 s[4:5], s[0:1], 0
s_load_dwordx2 s[8:9], s[0:1], 8
s_load_dwordx2 s[16:17], s[0:1], 24
s_load_dwordx2 s[20:21], s[0:1], 32
s_load_dwordx2 s[12:13], s[0:1], 16
s_load_dwordx2 s[24:25], s[0:1], 40
s_load_dwordx2 s[28:29], s[0:1], 56
s_load_dwordx2 s[32:33], s[0:1], 64
s_load_dwordx2 s[52:53], s[0:1], 72
s_load_dwordx2 s[36:37], s[0:1], 80
s_load_dwordx2 s[54:55], s[0:1], 88
s_load_dwordx2 s[56:57], s[0:1], 96
s_load_dwordx2 s[40:41], s[0:1], 104
s_load_dwordx2 s[48:49], s[0:1], 112
s_load_dwordx2 s[44:45], s[0:1], 120
s_mov_b32 s6, 0x400000
s_mov_b32 s7, 0x20000
s_mov_b32 s10, 0x200000
s_mov_b32 s11, 0x20000
s_mov_b32 s14, 0x800000
s_mov_b32 s15, 0x20000
s_mov_b32 s18, 0x400000
s_mov_b32 s19, 0x20000
s_mov_b32 s22, 0x400000
s_mov_b32 s23, 0x20000
s_mov_b32 s26, 0x800000
s_mov_b32 s27, 0x20000
s_mov_b32 s30, 0x400000
s_mov_b32 s31, 0x20000
s_mov_b32 s34, 0x400000
s_mov_b32 s35, 0x20000
s_mov_b32 s38, 0x400000
s_mov_b32 s39, 0x20000
s_mov_b32 s42, 0x400000
s_mov_b32 s43, 0x20000
s_mov_b32 s46, 0x8000000
s_mov_b32 s47, 0x20000
s_mov_b32 s50, 0x100
s_mov_b32 s51, 0x20000
v_lshrrev_b32 v26, 6, v0
v_and_b32 v0, 63, v0
s_lshr_b32 s62, s2, 3
v_readfirstlane_b32 s58, v26
s_and_b32 s73, s2, 7
s_lshr_b32 s74, s62, 3
s_and_b32 s60, s62, 7
s_lshl_b32 s59, s73, 2
s_add_u32 s59, s59, s74
s_lshl_b32 s74, s74, 1
s_add_u32 s61, s60, s74
s_and_b32 s61, s61, 7
s_lshl_b32 s63, s58, 13
s_lshl_b32 s64, s58, 12
s_lshl_b32 s65, s60, 18
s_lshl_b32 s73, s58, 16
s_add_u32 s65, s65, s73
s_mov_b32 s67, s65
s_sub_u32 s74, 15, s60
s_lshl_b32 s68, s74, 18
s_add_u32 s68, s68, s73
s_lshl_b32 s66, s58, 17
s_lshl_b32 s73, s59, 8
s_add_u32 s66, s66, s73
v_lshlrev_b32 v1, 4, v0
v_lshrrev_b32 v26, 4, v0
v_and_b32 v27, 7, v0
v_xor_b32 v27, v27, v26
v_lshlrev_b32 v27, 4, v27
v_lshrrev_b32 v28, 3, v0
v_lshl_add_u32 v2, v28, 10, v27
v_xor_b32 v3, 64, v2
v_lshl_add_u32 v4, v28, 11, v27
v_xor_b32 v5, 64, v4
v_and_b32 v27, 15, v0
v_lshlrev_b32 v28, 1, v26
v_xor_b32 v28, v28, v27
v_lshlrev_b32 v28, 4, v28
v_lshl_add_u32 v6, v26, 13, v28
v_xor_b32 v7, 0x80, v6
s_lshl_b32 s91, s59, 3
s_add_u32 s91, s91, s60
s_lshl_b32 s93, s91, 2
s_add_u32 s93, s93, s58
s_lshl_b32 s91, s91, 7
s_add_u32 s91, s91, 0x3810000
s_lshl_b32 s75, s93, 1
s_and_b32 s75, s75, 0xffc
s_lshl_b32 s93, s93, 12
s_mul_i32 s92, s58, 21248
s_waitcnt lgkmcnt(0)
s_load_dwordx2 s[88:89], s[36:37], s93
s_load_dword s90, s[54:55], s75
s_add_u32 s73, s61, 0
s_and_b32 s73, s73, 7
s_lshl_b32 s69, s73, 7
s_add_u32 s69, s69, s65
s_lshl_b32 s71, s73, 19
s_add_u32 s71, s71, s66
s_add_u32 m0, s63, 65536
s_add_u32 s72, s69, 0
buffer_load_dwordx4 v2, s[8:11], s72 offen lds
s_add_u32 s72, s69, 7168
buffer_load_dwordx4 v3, s[8:11], s72 offen offset:1024 lds
s_add_u32 s72, s69, 14336
buffer_load_dwordx4 v2, s[8:11], s72 offen offset:2048 lds
s_add_u32 s72, s69, 21504
buffer_load_dwordx4 v3, s[8:11], s72 offen offset:3072 lds
s_add_u32 m0, s64, 0
s_add_u32 s72, s71, 0
buffer_load_dwordx4 v6, s[16:19], s72 offen lds
s_add_u32 s72, s71, 31744
buffer_load_dwordx4 v6, s[16:19], s72 offen offset:1024 lds
s_add_u32 s72, s71, 63488
buffer_load_dwordx4 v7, s[16:19], s72 offen offset:2048 lds
s_add_u32 s72, s71, 95232
buffer_load_dwordx4 v7, s[16:19], s72 offen offset:3072 lds
s_add_u32 m0, s63, 69632
s_add_u32 s72, s69, 32768
buffer_load_dwordx4 v2, s[8:11], s72 offen lds
s_add_u32 s72, s69, 39936
buffer_load_dwordx4 v3, s[8:11], s72 offen offset:1024 lds
s_add_u32 s72, s69, 47104
buffer_load_dwordx4 v2, s[8:11], s72 offen offset:2048 lds
s_add_u32 s72, s69, 54272
buffer_load_dwordx4 v3, s[8:11], s72 offen offset:3072 lds
s_add_u32 m0, s64, 16384
s_add_u32 s72, s71, 0
buffer_load_dwordx4 v6, s[20:23], s72 offen lds
s_add_u32 s72, s71, 31744
buffer_load_dwordx4 v6, s[20:23], s72 offen offset:1024 lds
s_add_u32 s72, s71, 63488
buffer_load_dwordx4 v7, s[20:23], s72 offen offset:2048 lds
s_add_u32 s72, s71, 95232
buffer_load_dwordx4 v7, s[20:23], s72 offen offset:3072 lds
s_getpc_b64 s[98:99]
Lpc0:
s_lshl_b32 s73, s62, 2
s_add_u32 s73, s73, s58
s_lshl_b32 s73, s73, 10
v_and_b32 v26, 7, v0
v_lshlrev_b32 v26, 7, v26
v_add_u32 v26, s73, v26
v_min_u32 v26, Lcode_end-Lpc0, v26
global_load_dword v31, v26, s[98:99]
s_add_u32 s73, s61, 1
s_and_b32 s73, s73, 7
s_lshl_b32 s69, s73, 7
s_add_u32 s69, s69, s65
s_lshl_b32 s71, s73, 19
s_add_u32 s71, s71, s66
s_add_u32 m0, s63, 98304
s_add_u32 s72, s69, 0
buffer_load_dwordx4 v2, s[8:11], s72 offen lds
s_add_u32 s72, s69, 7168
buffer_load_dwordx4 v3, s[8:11], s72 offen offset:1024 lds
s_add_u32 s72, s69, 14336
buffer_load_dwordx4 v2, s[8:11], s72 offen offset:2048 lds
s_add_u32 s72, s69, 21504
buffer_load_dwordx4 v3, s[8:11], s72 offen offset:3072 lds
s_add_u32 m0, s64, 32768
s_add_u32 s72, s71, 0
buffer_load_dwordx4 v6, s[16:19], s72 offen lds
s_add_u32 s72, s71, 31744
buffer_load_dwordx4 v6, s[16:19], s72 offen offset:1024 lds
s_add_u32 s72, s71, 63488
buffer_load_dwordx4 v7, s[16:19], s72 offen offset:2048 lds
s_add_u32 s72, s71, 95232
buffer_load_dwordx4 v7, s[16:19], s72 offen offset:3072 lds
s_add_u32 m0, s63, 102400
s_add_u32 s72, s69, 32768
buffer_load_dwordx4 v2, s[8:11], s72 offen lds
s_add_u32 s72, s69, 39936
buffer_load_dwordx4 v3, s[8:11], s72 offen offset:1024 lds
s_add_u32 s72, s69, 47104
buffer_load_dwordx4 v2, s[8:11], s72 offen offset:2048 lds
s_add_u32 s72, s69, 54272
buffer_load_dwordx4 v3, s[8:11], s72 offen offset:3072 lds
s_add_u32 m0, s64, 49152
s_add_u32 s72, s71, 0
buffer_load_dwordx4 v6, s[20:23], s72 offen lds
s_add_u32 s72, s71, 31744
buffer_load_dwordx4 v6, s[20:23], s72 offen offset:1024 lds
s_add_u32 s72, s71, 63488
buffer_load_dwordx4 v7, s[20:23], s72 offen offset:2048 lds
s_add_u32 s72, s71, 95232
buffer_load_dwordx4 v7, s[20:23], s72 offen offset:3072 lds
s_and_b32 s73, s2, 15
s_lshr_b32 s74, s2, 4
s_lshl_b32 s74, s74, 7
s_lshl_b32 s75, s58, 5
s_add_u32 s74, s74, s75
v_lshrrev_b32 v29, 5, v0
v_lshlrev_b32 v29, 4, v29
v_add_u32 v29, s74, v29
v_and_b32 v30, 31, v0
s_lshl_b32 s73, s73, 5
v_add_u32 v30, s73, v30
v_lshlrev_b32 v26, 11, v29
v_lshl_add_u32 v26, v30, 2, v26
v_subrev_u32 v27, 0x1800, v26
v_sub_u32 v29, 0x7f0, v29
v_lshlrev_b32 v29, 1, v29
v_lshl_add_u32 v28, v30, 13, v29
v_lshlrev_b32 v30, 4, v30
global_load_dwordx4 v[68:71], v30, s[52:53]
s_mov_b32 s80, 0x1000
buffer_load_dword v32, v27, s[28:31], 0 offen
buffer_load_dword v33, v27, s[28:31], 0 offen offset:2048
v_add_u32 v27, 0x1000, v27
buffer_load_dword v34, v27, s[28:31], 0 offen
s_mov_b32 s80, 0
buffer_load_dword v35, v26, s[28:31], s80 offen
buffer_load_dword v51, v26, s[32:35], s80 offen nt
buffer_load_dword v36, v26, s[28:31], s80 offen offset:2048
buffer_load_dword v52, v26, s[32:35], s80 offen offset:2048 nt
s_mov_b32 s80, 4096
buffer_load_dword v37, v26, s[28:31], s80 offen
buffer_load_dword v53, v26, s[32:35], s80 offen nt
buffer_load_dword v38, v26, s[28:31], s80 offen offset:2048
buffer_load_dword v54, v26, s[32:35], s80 offen offset:2048 nt
s_mov_b32 s80, 8192
buffer_load_dword v39, v26, s[28:31], s80 offen
buffer_load_dword v55, v26, s[32:35], s80 offen nt
buffer_load_dword v40, v26, s[28:31], s80 offen offset:2048
buffer_load_dword v56, v26, s[32:35], s80 offen offset:2048 nt
s_mov_b32 s80, 12288
buffer_load_dword v41, v26, s[28:31], s80 offen
buffer_load_dword v57, v26, s[32:35], s80 offen nt
buffer_load_dword v42, v26, s[28:31], s80 offen offset:2048
buffer_load_dword v58, v26, s[32:35], s80 offen offset:2048 nt
s_mov_b32 s80, 16384
buffer_load_dword v43, v26, s[28:31], s80 offen
buffer_load_dword v59, v26, s[32:35], s80 offen nt
buffer_load_dword v44, v26, s[28:31], s80 offen offset:2048
buffer_load_dword v60, v26, s[32:35], s80 offen offset:2048 nt
s_mov_b32 s80, 20480
buffer_load_dword v45, v26, s[28:31], s80 offen
buffer_load_dword v61, v26, s[32:35], s80 offen nt
buffer_load_dword v46, v26, s[28:31], s80 offen offset:2048
buffer_load_dword v62, v26, s[32:35], s80 offen offset:2048 nt
s_mov_b32 s80, 24576
buffer_load_dword v47, v26, s[28:31], s80 offen
buffer_load_dword v63, v26, s[32:35], s80 offen nt
buffer_load_dword v48, v26, s[28:31], s80 offen offset:2048
buffer_load_dword v64, v26, s[32:35], s80 offen offset:2048 nt
s_mov_b32 s80, 28672
buffer_load_dword v49, v26, s[28:31], s80 offen
buffer_load_dword v65, v26, s[32:35], s80 offen nt
buffer_load_dword v50, v26, s[28:31], s80 offen offset:2048
buffer_load_dword v66, v26, s[32:35], s80 offen offset:2048 nt
s_lshl_b32 s73, s2, 14
s_lshl_b32 s74, s58, 12
s_add_u32 s76, s73, s74
buffer_load_dwordx4 v[108:111], v1, s[4:7], s76 offen
buffer_load_dwordx4 v[112:115], v1, s[4:7], s76 offen offset:1024
buffer_load_dwordx4 v[116:119], v1, s[4:7], s76 offen offset:2048
buffer_load_dwordx4 v[120:123], v1, s[4:7], s76 offen offset:3072
v_or_b32 v29, s58, v0
v_mov_b32 v30, 0
v_min_u32 v29, 1, v29
v_lshlrev_b32 v29, 30, v29
buffer_store_dword v30, v29, s[44:47], s91 offen sc1
v_and_b32 v29, 15, v0
v_lshrrev_b32 v30, 4, v0
v_lshrrev_b32 v24, 1, v29
v_xor_b32 v24, v24, v30
v_lshlrev_b32 v24, 4, v24
v_lshl_add_u32 v24, v29, 7, v24
s_add_u32 s73, s63, 131072
v_add_u32 v16, s73, v24
v_xor_b32 v17, 64, v16
v_subrev_u32 v18, 0x10000, v16
v_subrev_u32 v19, 0x10000, v17
s_lshr_b32 s73, s58, 1
s_lshl_b32 s74, s73, 14
s_add_u32 s74, s74, 0x10000
v_add_u32 v24, s74, v24
v_xor_b32 v25, 64, v24
v_lshrrev_b32 v8, 2, v29
v_and_b32 v9, 1, v30
v_lshl_add_u32 v9, v9, 2, v8
v_lshl_add_u32 v8, v30, 3, v8
v_lshlrev_b32 v8, 8, v8
v_lshl_add_u32 v8, v9, 5, v8
v_and_b32 v29, 3, v0
v_lshl_add_u32 v8, v29, 3, v8
s_and_b32 s74, s58, 1
s_lshl_b32 s75, s74, 7
v_xor_b32 v20, s75, v8
v_xor_b32 v9, 32, v8
v_xor_b32 v10, 64, v8
v_xor_b32 v11, 96, v8
v_xor_b32 v12, 128, v8
v_xor_b32 v13, 160, v8
v_xor_b32 v14, 192, v8
v_xor_b32 v15, 224, v8
v_xor_b32 v21, 32, v20
v_xor_b32 v22, 64, v20
v_xor_b32 v23, 96, v20
s_lshl_b32 s77, s59, 20
s_add_u32 s81, s77, s64
s_sub_u32 s81, s81, 0x4000
s_lshl_b32 s75, s60, 17
s_add_u32 s77, s77, s75
s_lshl_b32 s73, s73, 16
s_add_u32 s77, s77, s73
s_lshl_b32 s75, s74, 12
s_add_u32 s78, s77, s75
s_add_u32 s78, s78, 0x4000
s_lshl_b32 s75, s74, 11
s_add_u32 s77, s77, s75
s_mov_b32 s79, 0x3e0293ee
s_waitcnt vmcnt(58)
s_barrier
ds_read_b64_tr_b16 v[160:161], v20 offset:0
ds_read_b64_tr_b16 v[162:163], v20 offset:1024
ds_read_b128 v[128:131], v24 offset:0
ds_read_b128 v[132:135], v24 offset:2048
ds_read_b128 v[136:139], v24 offset:4096
ds_read_b128 v[140:143], v24 offset:6144
ds_read_b128 v[144:147], v24 offset:8192
ds_read_b128 v[148:151], v24 offset:10240
ds_read_b128 v[152:155], v24 offset:12288
ds_read_b128 v[156:159], v24 offset:14336
ds_read_b64_tr_b16 v[164:165], v21 offset:0
ds_read_b64_tr_b16 v[166:167], v21 offset:1024
ds_read_b64_tr_b16 v[168:169], v22 offset:0
ds_read_b64_tr_b16 v[170:171], v22 offset:1024
ds_read_b64_tr_b16 v[172:173], v23 offset:0
ds_read_b64_tr_b16 v[174:175], v23 offset:1024
ds_read_b64_tr_b16 v[176:177], v20 offset:16384
ds_read_b64_tr_b16 v[178:179], v20 offset:17408
ds_read_b64_tr_b16 v[180:181], v21 offset:16384
ds_read_b64_tr_b16 v[182:183], v21 offset:17408
ds_read_b64_tr_b16 v[184:185], v22 offset:16384
ds_read_b64_tr_b16 v[186:187], v22 offset:17408
ds_read_b64_tr_b16 v[188:189], v23 offset:16384
ds_read_b64_tr_b16 v[190:191], v23 offset:17408
s_waitcnt lgkmcnt(0)
v_mfma_f32_16x16x32_bf16 a[0:3], v[160:163], v[128:131], 0
ds_read_b64_tr_b16 v[224:225], v20 offset:8192
v_mfma_f32_16x16x32_bf16 a[4:7], v[160:163], v[132:135], 0
v_mfma_f32_16x16x32_bf16 a[8:11], v[160:163], v[136:139], 0
ds_read_b64_tr_b16 v[226:227], v20 offset:9216
v_mfma_f32_16x16x32_bf16 a[12:15], v[160:163], v[140:143], 0
v_mfma_f32_16x16x32_bf16 a[16:19], v[160:163], v[144:147], 0
ds_read_b128 v[192:195], v25 offset:0
v_mfma_f32_16x16x32_bf16 a[20:23], v[160:163], v[148:151], 0
v_mfma_f32_16x16x32_bf16 a[24:27], v[160:163], v[152:155], 0
ds_read_b128 v[196:199], v25 offset:2048
v_mfma_f32_16x16x32_bf16 a[28:31], v[160:163], v[156:159], 0
v_mfma_f32_16x16x32_bf16 a[60:63], v[164:167], v[156:159], 0
ds_read_b128 v[200:203], v25 offset:4096
v_mfma_f32_16x16x32_bf16 a[56:59], v[164:167], v[152:155], 0
v_mfma_f32_16x16x32_bf16 a[52:55], v[164:167], v[148:151], 0
ds_read_b128 v[204:207], v25 offset:6144
v_mfma_f32_16x16x32_bf16 a[48:51], v[164:167], v[144:147], 0
v_mfma_f32_16x16x32_bf16 a[44:47], v[164:167], v[140:143], 0
ds_read_b128 v[208:211], v25 offset:8192
v_mfma_f32_16x16x32_bf16 a[40:43], v[164:167], v[136:139], 0
v_mfma_f32_16x16x32_bf16 a[36:39], v[164:167], v[132:135], 0
ds_read_b128 v[212:215], v25 offset:10240
v_mfma_f32_16x16x32_bf16 a[32:35], v[164:167], v[128:131], 0
v_mfma_f32_16x16x32_bf16 a[64:67], v[168:171], v[128:131], 0
ds_read_b128 v[216:219], v25 offset:12288
v_mfma_f32_16x16x32_bf16 a[68:71], v[168:171], v[132:135], 0
v_mfma_f32_16x16x32_bf16 a[72:75], v[168:171], v[136:139], 0
ds_read_b128 v[220:223], v25 offset:14336
v_mfma_f32_16x16x32_bf16 a[76:79], v[168:171], v[140:143], 0
v_mfma_f32_16x16x32_bf16 a[80:83], v[168:171], v[144:147], 0
ds_read_b64_tr_b16 v[228:229], v21 offset:8192
v_mfma_f32_16x16x32_bf16 a[84:87], v[168:171], v[148:151], 0
v_mfma_f32_16x16x32_bf16 a[88:91], v[168:171], v[152:155], 0
ds_read_b64_tr_b16 v[230:231], v21 offset:9216
v_mfma_f32_16x16x32_bf16 a[92:95], v[168:171], v[156:159], 0
v_mfma_f32_16x16x32_bf16 a[124:127], v[172:175], v[156:159], 0
ds_read_b64_tr_b16 v[232:233], v22 offset:8192
v_mfma_f32_16x16x32_bf16 a[120:123], v[172:175], v[152:155], 0
v_mfma_f32_16x16x32_bf16 a[116:119], v[172:175], v[148:151], 0
ds_read_b64_tr_b16 v[234:235], v22 offset:9216
v_mfma_f32_16x16x32_bf16 a[112:115], v[172:175], v[144:147], 0
v_mfma_f32_16x16x32_bf16 a[108:111], v[172:175], v[140:143], 0
ds_read_b64_tr_b16 v[236:237], v23 offset:8192
v_mfma_f32_16x16x32_bf16 a[104:107], v[172:175], v[136:139], 0
v_mfma_f32_16x16x32_bf16 a[100:103], v[172:175], v[132:135], 0
ds_read_b64_tr_b16 v[238:239], v23 offset:9216
v_mfma_f32_16x16x32_bf16 a[96:99], v[172:175], v[128:131], 0
v_mfma_f32_16x16x32_bf16 a[128:131], v[128:131], v[176:179], 0
ds_read_b64_tr_b16 v[240:241], v20 offset:24576
v_mfma_f32_16x16x32_bf16 a[132:135], v[132:135], v[176:179], 0
v_mfma_f32_16x16x32_bf16 a[136:139], v[136:139], v[176:179], 0
ds_read_b64_tr_b16 v[242:243], v20 offset:25600
v_mfma_f32_16x16x32_bf16 a[140:143], v[140:143], v[176:179], 0
v_mfma_f32_16x16x32_bf16 a[144:147], v[144:147], v[176:179], 0
ds_read_b64_tr_b16 v[244:245], v21 offset:24576
v_mfma_f32_16x16x32_bf16 a[148:151], v[148:151], v[176:179], 0
v_mfma_f32_16x16x32_bf16 a[152:155], v[152:155], v[176:179], 0
ds_read_b64_tr_b16 v[246:247], v21 offset:25600
v_mfma_f32_16x16x32_bf16 a[156:159], v[156:159], v[176:179], 0
v_mfma_f32_16x16x32_bf16 a[188:191], v[156:159], v[180:183], 0
ds_read_b64_tr_b16 v[248:249], v22 offset:24576
v_mfma_f32_16x16x32_bf16 a[184:187], v[152:155], v[180:183], 0
v_mfma_f32_16x16x32_bf16 a[180:183], v[148:151], v[180:183], 0
ds_read_b64_tr_b16 v[250:251], v22 offset:25600
v_mfma_f32_16x16x32_bf16 a[176:179], v[144:147], v[180:183], 0
v_mfma_f32_16x16x32_bf16 a[172:175], v[140:143], v[180:183], 0
ds_read_b64_tr_b16 v[252:253], v23 offset:24576
v_mfma_f32_16x16x32_bf16 a[168:171], v[136:139], v[180:183], 0
v_mfma_f32_16x16x32_bf16 a[164:167], v[132:135], v[180:183], 0
ds_read_b64_tr_b16 v[254:255], v23 offset:25600
v_mfma_f32_16x16x32_bf16 a[160:163], v[128:131], v[180:183], 0
v_mfma_f32_16x16x32_bf16 a[192:195], v[128:131], v[184:187], 0
v_mfma_f32_16x16x32_bf16 a[196:199], v[132:135], v[184:187], 0
v_mfma_f32_16x16x32_bf16 a[200:203], v[136:139], v[184:187], 0
v_mfma_f32_16x16x32_bf16 a[204:207], v[140:143], v[184:187], 0
v_mfma_f32_16x16x32_bf16 a[208:211], v[144:147], v[184:187], 0
v_mfma_f32_16x16x32_bf16 a[212:215], v[148:151], v[184:187], 0
v_mfma_f32_16x16x32_bf16 a[216:219], v[152:155], v[184:187], 0
v_mfma_f32_16x16x32_bf16 a[220:223], v[156:159], v[184:187], 0
v_mfma_f32_16x16x32_bf16 a[252:255], v[156:159], v[188:191], 0
v_mfma_f32_16x16x32_bf16 a[248:251], v[152:155], v[188:191], 0
v_mfma_f32_16x16x32_bf16 a[244:247], v[148:151], v[188:191], 0
v_mfma_f32_16x16x32_bf16 a[240:243], v[144:147], v[188:191], 0
v_mfma_f32_16x16x32_bf16 a[236:239], v[140:143], v[188:191], 0
v_mfma_f32_16x16x32_bf16 a[232:235], v[136:139], v[188:191], 0
v_mfma_f32_16x16x32_bf16 a[228:231], v[132:135], v[188:191], 0
s_waitcnt vmcnt(41) lgkmcnt(0)
v_mfma_f32_16x16x32_bf16 a[224:227], v[128:131], v[188:191], 0
s_barrier
v_mfma_f32_16x16x32_bf16 a[0:3], v[224:227], v[192:195], a[0:3]
s_add_u32 s73, s61, 2
ds_read_b64_tr_b16 v[160:161], v20 offset:32768
v_mfma_f32_16x16x32_bf16 a[4:7], v[224:227], v[196:199], a[4:7]
s_and_b32 s73, s73, 7
v_mfma_f32_16x16x32_bf16 a[8:11], v[224:227], v[200:203], a[8:11]
s_lshl_b32 s69, s73, 7
ds_read_b64_tr_b16 v[162:163], v20 offset:33792
v_mfma_f32_16x16x32_bf16 a[12:15], v[224:227], v[204:207], a[12:15]
s_add_u32 s69, s69, s65
v_mfma_f32_16x16x32_bf16 a[16:19], v[224:227], v[208:211], a[16:19]
s_lshl_b32 s71, s73, 19
ds_read_b128 v[128:131], v24 offset:32768
v_mfma_f32_16x16x32_bf16 a[20:23], v[224:227], v[212:215], a[20:23]
s_add_u32 s71, s71, s66
v_mfma_f32_16x16x32_bf16 a[24:27], v[224:227], v[216:219], a[24:27]
s_add_u32 m0, s63, 65536
ds_read_b128 v[132:135], v24 offset:34816
v_mfma_f32_16x16x32_bf16 a[28:31], v[224:227], v[220:223], a[28:31]
s_add_u32 s72, s69, 0
buffer_load_dwordx4 v2, s[8:11], s72 offen lds
v_mfma_f32_16x16x32_bf16 a[60:63], v[228:231], v[220:223], a[60:63]
s_add_u32 s72, s69, 7168
ds_read_b128 v[136:139], v24 offset:36864
v_mfma_f32_16x16x32_bf16 a[56:59], v[228:231], v[216:219], a[56:59]
buffer_load_dwordx4 v3, s[8:11], s72 offen offset:1024 lds
v_mfma_f32_16x16x32_bf16 a[52:55], v[228:231], v[212:215], a[52:55]
s_add_u32 s72, s69, 14336
ds_read_b128 v[140:143], v24 offset:38912
v_mfma_f32_16x16x32_bf16 a[48:51], v[228:231], v[208:211], a[48:51]
buffer_load_dwordx4 v2, s[8:11], s72 offen offset:2048 lds
v_mfma_f32_16x16x32_bf16 a[44:47], v[228:231], v[204:207], a[44:47]
ds_read_b128 v[144:147], v24 offset:40960
v_mfma_f32_16x16x32_bf16 a[40:43], v[228:231], v[200:203], a[40:43]
v_mfma_f32_16x16x32_bf16 a[36:39], v[228:231], v[196:199], a[36:39]
s_add_u32 s72, s69, 21504
ds_read_b128 v[148:151], v24 offset:43008
v_mfma_f32_16x16x32_bf16 a[32:35], v[228:231], v[192:195], a[32:35]
buffer_load_dwordx4 v3, s[8:11], s72 offen offset:3072 lds
v_mfma_f32_16x16x32_bf16 a[64:67], v[232:235], v[192:195], a[64:67]
ds_read_b128 v[152:155], v24 offset:45056
v_mfma_f32_16x16x32_bf16 a[68:71], v[232:235], v[196:199], a[68:71]
v_mfma_f32_16x16x32_bf16 a[72:75], v[232:235], v[200:203], a[72:75]
ds_read_b128 v[156:159], v24 offset:47104
v_mfma_f32_16x16x32_bf16 a[76:79], v[232:235], v[204:207], a[76:79]
s_add_u32 m0, s64, 0
v_mfma_f32_16x16x32_bf16 a[80:83], v[232:235], v[208:211], a[80:83]
s_add_u32 s72, s71, 0
ds_read_b64_tr_b16 v[164:165], v21 offset:32768
v_mfma_f32_16x16x32_bf16 a[84:87], v[232:235], v[212:215], a[84:87]
buffer_load_dwordx4 v6, s[16:19], s72 offen lds
v_mfma_f32_16x16x32_bf16 a[88:91], v[232:235], v[216:219], a[88:91]
ds_read_b64_tr_b16 v[166:167], v21 offset:33792
v_mfma_f32_16x16x32_bf16 a[92:95], v[232:235], v[220:223], a[92:95]
v_mfma_f32_16x16x32_bf16 a[124:127], v[236:239], v[220:223], a[124:127]
s_add_u32 s72, s71, 31744
ds_read_b64_tr_b16 v[168:169], v22 offset:32768
v_mfma_f32_16x16x32_bf16 a[120:123], v[236:239], v[216:219], a[120:123]
buffer_load_dwordx4 v6, s[16:19], s72 offen offset:1024 lds
v_mfma_f32_16x16x32_bf16 a[116:119], v[236:239], v[212:215], a[116:119]
ds_read_b64_tr_b16 v[170:171], v22 offset:33792
v_mfma_f32_16x16x32_bf16 a[112:115], v[236:239], v[208:211], a[112:115]
v_mfma_f32_16x16x32_bf16 a[108:111], v[236:239], v[204:207], a[108:111]
s_add_u32 s72, s71, 63488
ds_read_b64_tr_b16 v[172:173], v23 offset:32768
v_mfma_f32_16x16x32_bf16 a[104:107], v[236:239], v[200:203], a[104:107]
buffer_load_dwordx4 v7, s[16:19], s72 offen offset:2048 lds
v_mfma_f32_16x16x32_bf16 a[100:103], v[236:239], v[196:199], a[100:103]
ds_read_b64_tr_b16 v[174:175], v23 offset:33792
v_mfma_f32_16x16x32_bf16 a[96:99], v[236:239], v[192:195], a[96:99]
v_mfma_f32_16x16x32_bf16 a[128:131], v[192:195], v[240:243], a[128:131]
ds_read_b64_tr_b16 v[176:177], v20 offset:49152
v_mfma_f32_16x16x32_bf16 a[132:135], v[196:199], v[240:243], a[132:135]
s_add_u32 s72, s71, 95232
buffer_load_dwordx4 v7, s[16:19], s72 offen offset:3072 lds
v_mfma_f32_16x16x32_bf16 a[136:139], v[200:203], v[240:243], a[136:139]
ds_read_b64_tr_b16 v[178:179], v20 offset:50176
v_mfma_f32_16x16x32_bf16 a[140:143], v[204:207], v[240:243], a[140:143]
v_mfma_f32_16x16x32_bf16 a[144:147], v[208:211], v[240:243], a[144:147]
ds_read_b64_tr_b16 v[180:181], v21 offset:49152
v_mfma_f32_16x16x32_bf16 a[148:151], v[212:215], v[240:243], a[148:151]
v_mfma_f32_16x16x32_bf16 a[152:155], v[216:219], v[240:243], a[152:155]
s_add_u32 m0, s63, 69632
ds_read_b64_tr_b16 v[182:183], v21 offset:50176
v_mfma_f32_16x16x32_bf16 a[156:159], v[220:223], v[240:243], a[156:159]
s_add_u32 s72, s69, 32768
buffer_load_dwordx4 v2, s[8:11], s72 offen lds
v_mfma_f32_16x16x32_bf16 a[188:191], v[220:223], v[244:247], a[188:191]
ds_read_b64_tr_b16 v[184:185], v22 offset:49152
v_mfma_f32_16x16x32_bf16 a[184:187], v[216:219], v[244:247], a[184:187]
v_mfma_f32_16x16x32_bf16 a[180:183], v[212:215], v[244:247], a[180:183]
ds_read_b64_tr_b16 v[186:187], v22 offset:50176
v_mfma_f32_16x16x32_bf16 a[176:179], v[208:211], v[244:247], a[176:179]
s_add_u32 s72, s69, 39936
buffer_load_dwordx4 v3, s[8:11], s72 offen offset:1024 lds
v_mfma_f32_16x16x32_bf16 a[172:175], v[204:207], v[244:247], a[172:175]
ds_read_b64_tr_b16 v[188:189], v23 offset:49152
v_mfma_f32_16x16x32_bf16 a[168:171], v[200:203], v[244:247], a[168:171]
v_mfma_f32_16x16x32_bf16 a[164:167], v[196:199], v[244:247], a[164:167]
ds_read_b64_tr_b16 v[190:191], v23 offset:50176
v_mfma_f32_16x16x32_bf16 a[160:163], v[192:195], v[244:247], a[160:163]
v_mfma_f32_16x16x32_bf16 a[192:195], v[192:195], v[248:251], a[192:195]
s_add_u32 s72, s69, 47104
buffer_load_dwordx4 v2, s[8:11], s72 offen offset:2048 lds
v_mfma_f32_16x16x32_bf16 a[196:199], v[196:199], v[248:251], a[196:199]
v_mfma_f32_16x16x32_bf16 a[200:203], v[200:203], v[248:251], a[200:203]
v_mfma_f32_16x16x32_bf16 a[204:207], v[204:207], v[248:251], a[204:207]
v_mfma_f32_16x16x32_bf16 a[208:211], v[208:211], v[248:251], a[208:211]
s_add_u32 s72, s69, 54272
buffer_load_dwordx4 v3, s[8:11], s72 offen offset:3072 lds
v_mfma_f32_16x16x32_bf16 a[212:215], v[212:215], v[248:251], a[212:215]
v_mfma_f32_16x16x32_bf16 a[216:219], v[216:219], v[248:251], a[216:219]
v_mfma_f32_16x16x32_bf16 a[220:223], v[220:223], v[248:251], a[220:223]
v_mfma_f32_16x16x32_bf16 a[252:255], v[220:223], v[252:255], a[252:255]
v_mfma_f32_16x16x32_bf16 a[248:251], v[216:219], v[252:255], a[248:251]
s_add_u32 m0, s64, 16384
v_mfma_f32_16x16x32_bf16 a[244:247], v[212:215], v[252:255], a[244:247]
s_add_u32 s72, s71, 0
buffer_load_dwordx4 v6, s[20:23], s72 offen lds
v_mfma_f32_16x16x32_bf16 a[240:243], v[208:211], v[252:255], a[240:243]
v_mfma_f32_16x16x32_bf16 a[236:239], v[204:207], v[252:255], a[236:239]
v_mfma_f32_16x16x32_bf16 a[232:235], v[200:203], v[252:255], a[232:235]
v_mfma_f32_16x16x32_bf16 a[228:231], v[196:199], v[252:255], a[228:231]
s_add_u32 s72, s71, 31744
buffer_load_dwordx4 v6, s[20:23], s72 offen offset:1024 lds
v_mfma_f32_16x16x32_bf16 a[224:227], v[192:195], v[252:255], a[224:227]
s_waitcnt lgkmcnt(0)
v_mfma_f32_16x16x32_bf16 a[0:3], v[160:163], v[128:131], a[0:3]
ds_read_b64_tr_b16 v[224:225], v20 offset:40960
v_mfma_f32_16x16x32_bf16 a[4:7], v[160:163], v[132:135], a[4:7]
v_mfma_f32_16x16x32_bf16 a[8:11], v[160:163], v[136:139], a[8:11]
ds_read_b64_tr_b16 v[226:227], v20 offset:41984
v_mfma_f32_16x16x32_bf16 a[12:15], v[160:163], v[140:143], a[12:15]
s_add_u32 s72, s71, 63488
buffer_load_dwordx4 v7, s[20:23], s72 offen offset:2048 lds
v_mfma_f32_16x16x32_bf16 a[16:19], v[160:163], v[144:147], a[16:19]
ds_read_b128 v[192:195], v25 offset:32768
v_mfma_f32_16x16x32_bf16 a[20:23], v[160:163], v[148:151], a[20:23]
v_mfma_f32_16x16x32_bf16 a[24:27], v[160:163], v[152:155], a[24:27]
ds_read_b128 v[196:199], v25 offset:34816
v_mfma_f32_16x16x32_bf16 a[28:31], v[160:163], v[156:159], a[28:31]
v_mfma_f32_16x16x32_bf16 a[60:63], v[164:167], v[156:159], a[60:63]
s_add_u32 s72, s71, 95232
ds_read_b128 v[200:203], v25 offset:36864
v_mfma_f32_16x16x32_bf16 a[56:59], v[164:167], v[152:155], a[56:59]
buffer_load_dwordx4 v7, s[20:23], s72 offen offset:3072 lds
v_mfma_f32_16x16x32_bf16 a[52:55], v[164:167], v[148:151], a[52:55]
ds_read_b128 v[204:207], v25 offset:38912
v_mfma_f32_16x16x32_bf16 a[48:51], v[164:167], v[144:147], a[48:51]
v_mfma_f32_16x16x32_bf16 a[44:47], v[164:167], v[140:143], a[44:47]
ds_read_b128 v[208:211], v25 offset:40960
v_mfma_f32_16x16x32_bf16 a[40:43], v[164:167], v[136:139], a[40:43]
v_mfma_f32_16x16x32_bf16 a[36:39], v[164:167], v[132:135], a[36:39]
ds_read_b128 v[212:215], v25 offset:43008
v_mfma_f32_16x16x32_bf16 a[32:35], v[164:167], v[128:131], a[32:35]
v_mfma_f32_16x16x32_bf16 a[64:67], v[168:171], v[128:131], a[64:67]
ds_read_b128 v[216:219], v25 offset:45056
v_mfma_f32_16x16x32_bf16 a[68:71], v[168:171], v[132:135], a[68:71]
v_mfma_f32_16x16x32_bf16 a[72:75], v[168:171], v[136:139], a[72:75]
ds_read_b128 v[220:223], v25 offset:47104
v_mfma_f32_16x16x32_bf16 a[76:79], v[168:171], v[140:143], a[76:79]
v_mfma_f32_16x16x32_bf16 a[80:83], v[168:171], v[144:147], a[80:83]
ds_read_b64_tr_b16 v[228:229], v21 offset:40960
v_mfma_f32_16x16x32_bf16 a[84:87], v[168:171], v[148:151], a[84:87]
v_mfma_f32_16x16x32_bf16 a[88:91], v[168:171], v[152:155], a[88:91]
ds_read_b64_tr_b16 v[230:231], v21 offset:41984
v_mfma_f32_16x16x32_bf16 a[92:95], v[168:171], v[156:159], a[92:95]
v_mfma_f32_16x16x32_bf16 a[124:127], v[172:175], v[156:159], a[124:127]
ds_read_b64_tr_b16 v[232:233], v22 offset:40960
v_mfma_f32_16x16x32_bf16 a[120:123], v[172:175], v[152:155], a[120:123]
v_mfma_f32_16x16x32_bf16 a[116:119], v[172:175], v[148:151], a[116:119]
ds_read_b64_tr_b16 v[234:235], v22 offset:41984
v_mfma_f32_16x16x32_bf16 a[112:115], v[172:175], v[144:147], a[112:115]
v_mfma_f32_16x16x32_bf16 a[108:111], v[172:175], v[140:143], a[108:111]
ds_read_b64_tr_b16 v[236:237], v23 offset:40960
v_mfma_f32_16x16x32_bf16 a[104:107], v[172:175], v[136:139], a[104:107]
v_mfma_f32_16x16x32_bf16 a[100:103], v[172:175], v[132:135], a[100:103]
ds_read_b64_tr_b16 v[238:239], v23 offset:41984
v_mfma_f32_16x16x32_bf16 a[96:99], v[172:175], v[128:131], a[96:99]
v_mfma_f32_16x16x32_bf16 a[128:131], v[128:131], v[176:179], a[128:131]
ds_read_b64_tr_b16 v[240:241], v20 offset:57344
v_mfma_f32_16x16x32_bf16 a[132:135], v[132:135], v[176:179], a[132:135]
v_mfma_f32_16x16x32_bf16 a[136:139], v[136:139], v[176:179], a[136:139]
ds_read_b64_tr_b16 v[242:243], v20 offset:58368
v_mfma_f32_16x16x32_bf16 a[140:143], v[140:143], v[176:179], a[140:143]
v_mfma_f32_16x16x32_bf16 a[144:147], v[144:147], v[176:179], a[144:147]
ds_read_b64_tr_b16 v[244:245], v21 offset:57344
v_mfma_f32_16x16x32_bf16 a[148:151], v[148:151], v[176:179], a[148:151]
v_mfma_f32_16x16x32_bf16 a[152:155], v[152:155], v[176:179], a[152:155]
ds_read_b64_tr_b16 v[246:247], v21 offset:58368
v_mfma_f32_16x16x32_bf16 a[156:159], v[156:159], v[176:179], a[156:159]
v_mfma_f32_16x16x32_bf16 a[188:191], v[156:159], v[180:183], a[188:191]
ds_read_b64_tr_b16 v[248:249], v22 offset:57344
v_mfma_f32_16x16x32_bf16 a[184:187], v[152:155], v[180:183], a[184:187]
v_mfma_f32_16x16x32_bf16 a[180:183], v[148:151], v[180:183], a[180:183]
ds_read_b64_tr_b16 v[250:251], v22 offset:58368
v_mfma_f32_16x16x32_bf16 a[176:179], v[144:147], v[180:183], a[176:179]
v_mfma_f32_16x16x32_bf16 a[172:175], v[140:143], v[180:183], a[172:175]
ds_read_b64_tr_b16 v[252:253], v23 offset:57344
v_mfma_f32_16x16x32_bf16 a[168:171], v[136:139], v[180:183], a[168:171]
v_mfma_f32_16x16x32_bf16 a[164:167], v[132:135], v[180:183], a[164:167]
ds_read_b64_tr_b16 v[254:255], v23 offset:58368
v_mfma_f32_16x16x32_bf16 a[160:163], v[128:131], v[180:183], a[160:163]
v_mfma_f32_16x16x32_bf16 a[192:195], v[128:131], v[184:187], a[192:195]
v_mfma_f32_16x16x32_bf16 a[196:199], v[132:135], v[184:187], a[196:199]
v_mfma_f32_16x16x32_bf16 a[200:203], v[136:139], v[184:187], a[200:203]
v_mfma_f32_16x16x32_bf16 a[204:207], v[140:143], v[184:187], a[204:207]
v_mfma_f32_16x16x32_bf16 a[208:211], v[144:147], v[184:187], a[208:211]
v_mfma_f32_16x16x32_bf16 a[212:215], v[148:151], v[184:187], a[212:215]
v_mfma_f32_16x16x32_bf16 a[216:219], v[152:155], v[184:187], a[216:219]
v_mfma_f32_16x16x32_bf16 a[220:223], v[156:159], v[184:187], a[220:223]
v_mfma_f32_16x16x32_bf16 a[252:255], v[156:159], v[188:191], a[252:255]
v_mfma_f32_16x16x32_bf16 a[248:251], v[152:155], v[188:191], a[248:251]
v_mfma_f32_16x16x32_bf16 a[244:247], v[148:151], v[188:191], a[244:247]
v_mfma_f32_16x16x32_bf16 a[240:243], v[144:147], v[188:191], a[240:243]
v_mfma_f32_16x16x32_bf16 a[236:239], v[140:143], v[188:191], a[236:239]
v_mfma_f32_16x16x32_bf16 a[232:235], v[136:139], v[188:191], a[232:235]
v_mfma_f32_16x16x32_bf16 a[228:231], v[132:135], v[188:191], a[228:231]
s_waitcnt vmcnt(0) lgkmcnt(0)
v_mfma_f32_16x16x32_bf16 a[224:227], v[128:131], v[188:191], a[224:227]
s_barrier
v_mfma_f32_16x16x32_bf16 a[0:3], v[224:227], v[192:195], a[0:3]
s_add_u32 s73, s61, 3
ds_read_b64_tr_b16 v[160:161], v20 offset:0
v_mfma_f32_16x16x32_bf16 a[4:7], v[224:227], v[196:199], a[4:7]
s_and_b32 s73, s73, 7
v_mfma_f32_16x16x32_bf16 a[8:11], v[224:227], v[200:203], a[8:11]
s_lshl_b32 s69, s73, 7
ds_read_b64_tr_b16 v[162:163], v20 offset:1024
v_mfma_f32_16x16x32_bf16 a[12:15], v[224:227], v[204:207], a[12:15]
s_add_u32 s69, s69, s65
v_mfma_f32_16x16x32_bf16 a[16:19], v[224:227], v[208:211], a[16:19]
s_lshl_b32 s71, s73, 19
ds_read_b128 v[128:131], v24 offset:0
v_mfma_f32_16x16x32_bf16 a[20:23], v[224:227], v[212:215], a[20:23]
s_add_u32 s71, s71, s66
v_mfma_f32_16x16x32_bf16 a[24:27], v[224:227], v[216:219], a[24:27]
s_add_u32 m0, s63, 98304
ds_read_b128 v[132:135], v24 offset:2048
v_mfma_f32_16x16x32_bf16 a[28:31], v[224:227], v[220:223], a[28:31]
s_add_u32 s72, s69, 0
buffer_load_dwordx4 v2, s[8:11], s72 offen lds
v_mfma_f32_16x16x32_bf16 a[60:63], v[228:231], v[220:223], a[60:63]
s_add_u32 s72, s69, 7168
ds_read_b128 v[136:139], v24 offset:4096
v_mfma_f32_16x16x32_bf16 a[56:59], v[228:231], v[216:219], a[56:59]
buffer_load_dwordx4 v3, s[8:11], s72 offen offset:1024 lds
v_mfma_f32_16x16x32_bf16 a[52:55], v[228:231], v[212:215], a[52:55]
s_add_u32 s72, s69, 14336
ds_read_b128 v[140:143], v24 offset:6144
v_mfma_f32_16x16x32_bf16 a[48:51], v[228:231], v[208:211], a[48:51]
buffer_load_dwordx4 v2, s[8:11], s72 offen offset:2048 lds
v_mfma_f32_16x16x32_bf16 a[44:47], v[228:231], v[204:207], a[44:47]
ds_read_b128 v[144:147], v24 offset:8192
v_mfma_f32_16x16x32_bf16 a[40:43], v[228:231], v[200:203], a[40:43]
v_mfma_f32_16x16x32_bf16 a[36:39], v[228:231], v[196:199], a[36:39]
s_add_u32 s72, s69, 21504
ds_read_b128 v[148:151], v24 offset:10240
v_mfma_f32_16x16x32_bf16 a[32:35], v[228:231], v[192:195], a[32:35]
buffer_load_dwordx4 v3, s[8:11], s72 offen offset:3072 lds
v_mfma_f32_16x16x32_bf16 a[64:67], v[232:235], v[192:195], a[64:67]
ds_read_b128 v[152:155], v24 offset:12288
v_mfma_f32_16x16x32_bf16 a[68:71], v[232:235], v[196:199], a[68:71]
v_mfma_f32_16x16x32_bf16 a[72:75], v[232:235], v[200:203], a[72:75]
ds_read_b128 v[156:159], v24 offset:14336
v_mfma_f32_16x16x32_bf16 a[76:79], v[232:235], v[204:207], a[76:79]
s_add_u32 m0, s64, 32768
v_mfma_f32_16x16x32_bf16 a[80:83], v[232:235], v[208:211], a[80:83]
s_add_u32 s72, s71, 0
ds_read_b64_tr_b16 v[164:165], v21 offset:0
v_mfma_f32_16x16x32_bf16 a[84:87], v[232:235], v[212:215], a[84:87]
buffer_load_dwordx4 v6, s[16:19], s72 offen lds
v_mfma_f32_16x16x32_bf16 a[88:91], v[232:235], v[216:219], a[88:91]
ds_read_b64_tr_b16 v[166:167], v21 offset:1024
v_mfma_f32_16x16x32_bf16 a[92:95], v[232:235], v[220:223], a[92:95]
v_mfma_f32_16x16x32_bf16 a[124:127], v[236:239], v[220:223], a[124:127]
s_add_u32 s72, s71, 31744
ds_read_b64_tr_b16 v[168:169], v22 offset:0
v_mfma_f32_16x16x32_bf16 a[120:123], v[236:239], v[216:219], a[120:123]
buffer_load_dwordx4 v6, s[16:19], s72 offen offset:1024 lds
v_mfma_f32_16x16x32_bf16 a[116:119], v[236:239], v[212:215], a[116:119]
ds_read_b64_tr_b16 v[170:171], v22 offset:1024
v_mfma_f32_16x16x32_bf16 a[112:115], v[236:239], v[208:211], a[112:115]
v_mfma_f32_16x16x32_bf16 a[108:111], v[236:239], v[204:207], a[108:111]
s_add_u32 s72, s71, 63488
ds_read_b64_tr_b16 v[172:173], v23 offset:0
v_mfma_f32_16x16x32_bf16 a[104:107], v[236:239], v[200:203], a[104:107]
buffer_load_dwordx4 v7, s[16:19], s72 offen offset:2048 lds
v_mfma_f32_16x16x32_bf16 a[100:103], v[236:239], v[196:199], a[100:103]
ds_read_b64_tr_b16 v[174:175], v23 offset:1024
v_mfma_f32_16x16x32_bf16 a[96:99], v[236:239], v[192:195], a[96:99]
v_mfma_f32_16x16x32_bf16 a[128:131], v[192:195], v[240:243], a[128:131]
ds_read_b64_tr_b16 v[176:177], v20 offset:16384
v_mfma_f32_16x16x32_bf16 a[132:135], v[196:199], v[240:243], a[132:135]
s_add_u32 s72, s71, 95232
buffer_load_dwordx4 v7, s[16:19], s72 offen offset:3072 lds
v_mfma_f32_16x16x32_bf16 a[136:139], v[200:203], v[240:243], a[136:139]
ds_read_b64_tr_b16 v[178:179], v20 offset:17408
v_mfma_f32_16x16x32_bf16 a[140:143], v[204:207], v[240:243], a[140:143]
v_mfma_f32_16x16x32_bf16 a[144:147], v[208:211], v[240:243], a[144:147]
ds_read_b64_tr_b16 v[180:181], v21 offset:16384
v_mfma_f32_16x16x32_bf16 a[148:151], v[212:215], v[240:243], a[148:151]
v_mfma_f32_16x16x32_bf16 a[152:155], v[216:219], v[240:243], a[152:155]
s_add_u32 m0, s63, 102400
ds_read_b64_tr_b16 v[182:183], v21 offset:17408
v_mfma_f32_16x16x32_bf16 a[156:159], v[220:223], v[240:243], a[156:159]
s_add_u32 s72, s69, 32768
buffer_load_dwordx4 v2, s[8:11], s72 offen lds
v_mfma_f32_16x16x32_bf16 a[188:191], v[220:223], v[244:247], a[188:191]
ds_read_b64_tr_b16 v[184:185], v22 offset:16384
v_mfma_f32_16x16x32_bf16 a[184:187], v[216:219], v[244:247], a[184:187]
v_mfma_f32_16x16x32_bf16 a[180:183], v[212:215], v[244:247], a[180:183]
ds_read_b64_tr_b16 v[186:187], v22 offset:17408
v_mfma_f32_16x16x32_bf16 a[176:179], v[208:211], v[244:247], a[176:179]
s_add_u32 s72, s69, 39936
buffer_load_dwordx4 v3, s[8:11], s72 offen offset:1024 lds
v_mfma_f32_16x16x32_bf16 a[172:175], v[204:207], v[244:247], a[172:175]
ds_read_b64_tr_b16 v[188:189], v23 offset:16384
v_mfma_f32_16x16x32_bf16 a[168:171], v[200:203], v[244:247], a[168:171]
v_mfma_f32_16x16x32_bf16 a[164:167], v[196:199], v[244:247], a[164:167]
ds_read_b64_tr_b16 v[190:191], v23 offset:17408
v_mfma_f32_16x16x32_bf16 a[160:163], v[192:195], v[244:247], a[160:163]
v_mfma_f32_16x16x32_bf16 a[192:195], v[192:195], v[248:251], a[192:195]
s_add_u32 s72, s69, 47104
buffer_load_dwordx4 v2, s[8:11], s72 offen offset:2048 lds
v_mfma_f32_16x16x32_bf16 a[196:199], v[196:199], v[248:251], a[196:199]
v_mfma_f32_16x16x32_bf16 a[200:203], v[200:203], v[248:251], a[200:203]
v_mfma_f32_16x16x32_bf16 a[204:207], v[204:207], v[248:251], a[204:207]
v_mfma_f32_16x16x32_bf16 a[208:211], v[208:211], v[248:251], a[208:211]
s_add_u32 s72, s69, 54272
buffer_load_dwordx4 v3, s[8:11], s72 offen offset:3072 lds
v_mfma_f32_16x16x32_bf16 a[212:215], v[212:215], v[248:251], a[212:215]
v_mfma_f32_16x16x32_bf16 a[216:219], v[216:219], v[248:251], a[216:219]
v_mfma_f32_16x16x32_bf16 a[220:223], v[220:223], v[248:251], a[220:223]
v_mfma_f32_16x16x32_bf16 a[252:255], v[220:223], v[252:255], a[252:255]
v_mfma_f32_16x16x32_bf16 a[248:251], v[216:219], v[252:255], a[248:251]
s_add_u32 m0, s64, 49152
v_mfma_f32_16x16x32_bf16 a[244:247], v[212:215], v[252:255], a[244:247]
s_add_u32 s72, s71, 0
buffer_load_dwordx4 v6, s[20:23], s72 offen lds
v_mfma_f32_16x16x32_bf16 a[240:243], v[208:211], v[252:255], a[240:243]
v_mfma_f32_16x16x32_bf16 a[236:239], v[204:207], v[252:255], a[236:239]
v_mfma_f32_16x16x32_bf16 a[232:235], v[200:203], v[252:255], a[232:235]
v_mfma_f32_16x16x32_bf16 a[228:231], v[196:199], v[252:255], a[228:231]
s_add_u32 s72, s71, 31744
buffer_load_dwordx4 v6, s[20:23], s72 offen offset:1024 lds
v_mfma_f32_16x16x32_bf16 a[224:227], v[192:195], v[252:255], a[224:227]
s_waitcnt lgkmcnt(0)
v_mfma_f32_16x16x32_bf16 a[0:3], v[160:163], v[128:131], a[0:3]
s_waitcnt vmcnt(31)
ds_read_b64_tr_b16 v[224:225], v20 offset:8192
v_lshlrev_b32 v72, 16, v68
v_mfma_f32_16x16x32_bf16 a[4:7], v[160:163], v[132:135], a[4:7]
v_and_b32 v73, 0xffff0000, v68
v_lshlrev_b32 v74, 16, v69
v_mfma_f32_16x16x32_bf16 a[8:11], v[160:163], v[136:139], a[8:11]
ds_read_b64_tr_b16 v[226:227], v20 offset:9216
v_and_b32 v75, 0xffff0000, v69
v_mfma_f32_16x16x32_bf16 a[12:15], v[160:163], v[140:143], a[12:15]
s_add_u32 s72, s71, 63488
buffer_load_dwordx4 v7, s[20:23], s72 offen offset:2048 lds
v_mfma_f32_16x16x32_bf16 a[16:19], v[160:163], v[144:147], a[16:19]
ds_read_b128 v[192:195], v25 offset:0
v_lshlrev_b32 v76, 16, v32
v_mfma_f32_16x16x32_bf16 a[20:23], v[160:163], v[148:151], a[20:23]
v_lshlrev_b32 v77, 16, v33
v_lshlrev_b32 v78, 16, v34
v_mfma_f32_16x16x32_bf16 a[24:27], v[160:163], v[152:155], a[24:27]
ds_read_b128 v[196:199], v25 offset:2048
v_lshlrev_b32 v79, 16, v35
v_mfma_f32_16x16x32_bf16 a[28:31], v[160:163], v[156:159], a[28:31]
v_lshlrev_b32 v80, 16, v36
v_lshlrev_b32 v81, 16, v37
v_mfma_f32_16x16x32_bf16 a[60:63], v[164:167], v[156:159], a[60:63]
s_add_u32 s72, s71, 95232
ds_read_b128 v[200:203], v25 offset:4096
v_lshlrev_b32 v82, 16, v38
v_mfma_f32_16x16x32_bf16 a[56:59], v[164:167], v[152:155], a[56:59]
buffer_load_dwordx4 v7, s[20:23], s72 offen offset:3072 lds
v_mfma_f32_16x16x32_bf16 a[52:55], v[164:167], v[148:151], a[52:55]
ds_read_b128 v[204:207], v25 offset:6144
v_lshlrev_b32 v83, 16, v39
v_mfma_f32_16x16x32_bf16 a[48:51], v[164:167], v[144:147], a[48:51]
v_lshlrev_b32 v84, 16, v40
v_lshlrev_b32 v85, 16, v41
v_mfma_f32_16x16x32_bf16 a[44:47], v[164:167], v[140:143], a[44:47]
ds_read_b128 v[208:211], v25 offset:8192
v_lshlrev_b32 v86, 16, v42
v_mfma_f32_16x16x32_bf16 a[40:43], v[164:167], v[136:139], a[40:43]
v_lshlrev_b32 v87, 16, v43
v_lshlrev_b32 v88, 16, v44
v_mfma_f32_16x16x32_bf16 a[36:39], v[164:167], v[132:135], a[36:39]
ds_read_b128 v[212:215], v25 offset:10240
v_lshlrev_b32 v89, 16, v45
v_mfma_f32_16x16x32_bf16 a[32:35], v[164:167], v[128:131], a[32:35]
v_lshlrev_b32 v90, 16, v46
v_lshlrev_b32 v91, 16, v47
v_mfma_f32_16x16x32_bf16 a[64:67], v[168:171], v[128:131], a[64:67]
ds_read_b128 v[216:219], v25 offset:12288
v_lshlrev_b32 v92, 16, v48
v_mfma_f32_16x16x32_bf16 a[68:71], v[168:171], v[132:135], a[68:71]
v_lshlrev_b32 v93, 16, v49
v_lshlrev_b32 v94, 16, v50
v_mfma_f32_16x16x32_bf16 a[72:75], v[168:171], v[136:139], a[72:75]
ds_read_b128 v[220:223], v25 offset:14336
v_mul_f32 v95, v75, v91
v_mfma_f32_16x16x32_bf16 a[76:79], v[168:171], v[140:143], a[76:79]
v_lshlrev_b32 v97, 16, v66
v_fmac_f32 v95, v74, v92
v_mfma_f32_16x16x32_bf16 a[80:83], v[168:171], v[144:147], a[80:83]
ds_read_b64_tr_b16 v[228:229], v21 offset:8192
v_fmac_f32 v95, v73, v93
v_mfma_f32_16x16x32_bf16 a[84:87], v[168:171], v[148:151], a[84:87]
v_fmac_f32 v95, v72, v94
v_mul_f32 v95, v95, v97
v_mfma_f32_16x16x32_bf16 a[88:91], v[168:171], v[152:155], a[88:91]
ds_read_b64_tr_b16 v[230:231], v21 offset:9216
v_mul_f32 v96, v75, v90
v_mfma_f32_16x16x32_bf16 a[92:95], v[168:171], v[156:159], a[92:95]
v_lshlrev_b32 v97, 16, v65
v_fmac_f32 v96, v74, v91
v_mfma_f32_16x16x32_bf16 a[124:127], v[172:175], v[156:159], a[124:127]
ds_read_b64_tr_b16 v[232:233], v22 offset:8192
v_fmac_f32 v96, v73, v92
v_mfma_f32_16x16x32_bf16 a[120:123], v[172:175], v[152:155], a[120:123]
v_fmac_f32 v96, v72, v93
v_mul_f32 v96, v96, v97
v_mfma_f32_16x16x32_bf16 a[116:119], v[172:175], v[148:151], a[116:119]
ds_read_b64_tr_b16 v[234:235], v22 offset:9216
v_cvt_pk_bf16_f32 v100, v95, v96
v_mfma_f32_16x16x32_bf16 a[112:115], v[172:175], v[144:147], a[112:115]
v_mul_f32 v95, v75, v89
v_lshlrev_b32 v97, 16, v64
v_mfma_f32_16x16x32_bf16 a[108:111], v[172:175], v[140:143], a[108:111]
ds_read_b64_tr_b16 v[236:237], v23 offset:8192
v_fmac_f32 v95, v74, v90
v_mfma_f32_16x16x32_bf16 a[104:107], v[172:175], v[136:139], a[104:107]
v_fmac_f32 v95, v73, v91
v_fmac_f32 v95, v72, v92
v_mfma_f32_16x16x32_bf16 a[100:103], v[172:175], v[132:135], a[100:103]
ds_read_b64_tr_b16 v[238:239], v23 offset:9216
v_mul_f32 v95, v95, v97
v_mfma_f32_16x16x32_bf16 a[96:99], v[172:175], v[128:131], a[96:99]
v_mul_f32 v96, v75, v88
v_lshlrev_b32 v97, 16, v63
v_mfma_f32_16x16x32_bf16 a[128:131], v[128:131], v[176:179], a[128:131]
ds_read_b64_tr_b16 v[240:241], v20 offset:24576
v_fmac_f32 v96, v74, v89
v_mfma_f32_16x16x32_bf16 a[132:135], v[132:135], v[176:179], a[132:135]
v_fmac_f32 v96, v73, v90
v_fmac_f32 v96, v72, v91
v_mfma_f32_16x16x32_bf16 a[136:139], v[136:139], v[176:179], a[136:139]
ds_read_b64_tr_b16 v[242:243], v20 offset:25600
v_mul_f32 v96, v96, v97
v_mfma_f32_16x16x32_bf16 a[140:143], v[140:143], v[176:179], a[140:143]
v_cvt_pk_bf16_f32 v101, v95, v96
v_mul_f32 v95, v75, v87
v_mfma_f32_16x16x32_bf16 a[144:147], v[144:147], v[176:179], a[144:147]
ds_read_b64_tr_b16 v[244:245], v21 offset:24576
v_lshlrev_b32 v97, 16, v62
v_mfma_f32_16x16x32_bf16 a[148:151], v[148:151], v[176:179], a[148:151]
v_fmac_f32 v95, v74, v88
v_fmac_f32 v95, v73, v89
v_mfma_f32_16x16x32_bf16 a[152:155], v[152:155], v[176:179], a[152:155]
ds_read_b64_tr_b16 v[246:247], v21 offset:25600
v_fmac_f32 v95, v72, v90
v_mfma_f32_16x16x32_bf16 a[156:159], v[156:159], v[176:179], a[156:159]
v_mul_f32 v95, v95, v97
v_mul_f32 v96, v75, v86
v_mfma_f32_16x16x32_bf16 a[188:191], v[156:159], v[180:183], a[188:191]
ds_read_b64_tr_b16 v[248:249], v22 offset:24576
v_lshlrev_b32 v97, 16, v61
v_mfma_f32_16x16x32_bf16 a[184:187], v[152:155], v[180:183], a[184:187]
v_fmac_f32 v96, v74, v87
v_fmac_f32 v96, v73, v88
v_mfma_f32_16x16x32_bf16 a[180:183], v[148:151], v[180:183], a[180:183]
ds_read_b64_tr_b16 v[250:251], v22 offset:25600
v_fmac_f32 v96, v72, v89
v_mfma_f32_16x16x32_bf16 a[176:179], v[144:147], v[180:183], a[176:179]
v_mul_f32 v96, v96, v97
v_cvt_pk_bf16_f32 v102, v95, v96
v_mfma_f32_16x16x32_bf16 a[172:175], v[140:143], v[180:183], a[172:175]
ds_read_b64_tr_b16 v[252:253], v23 offset:24576
v_mul_f32 v95, v75, v85
v_mfma_f32_16x16x32_bf16 a[168:171], v[136:139], v[180:183], a[168:171]
v_lshlrev_b32 v97, 16, v60
v_fmac_f32 v95, v74, v86
v_mfma_f32_16x16x32_bf16 a[164:167], v[132:135], v[180:183], a[164:167]
ds_read_b64_tr_b16 v[254:255], v23 offset:25600
v_fmac_f32 v95, v73, v87
v_mfma_f32_16x16x32_bf16 a[160:163], v[128:131], v[180:183], a[160:163]
v_fmac_f32 v95, v72, v88
v_mul_f32 v95, v95, v97
v_mfma_f32_16x16x32_bf16 a[192:195], v[128:131], v[184:187], a[192:195]
v_mul_f32 v96, v75, v84
v_lshlrev_b32 v97, 16, v59
v_mfma_f32_16x16x32_bf16 a[196:199], v[132:135], v[184:187], a[196:199]
v_fmac_f32 v96, v74, v85
v_fmac_f32 v96, v73, v86
v_mfma_f32_16x16x32_bf16 a[200:203], v[136:139], v[184:187], a[200:203]
v_fmac_f32 v96, v72, v87
v_mul_f32 v96, v96, v97
v_mfma_f32_16x16x32_bf16 a[204:207], v[140:143], v[184:187], a[204:207]
v_cvt_pk_bf16_f32 v103, v95, v96
v_mfma_f32_16x16x32_bf16 a[208:211], v[144:147], v[184:187], a[208:211]
s_mov_b32 s80, 0x3000000
buffer_store_dwordx4 v[100:103], v28, s[44:47], s80 offen sc1
v_mfma_f32_16x16x32_bf16 a[212:215], v[148:151], v[184:187], a[212:215]
v_mul_f32 v95, v75, v83
v_lshlrev_b32 v97, 16, v58
v_mfma_f32_16x16x32_bf16 a[216:219], v[152:155], v[184:187], a[216:219]
v_fmac_f32 v95, v74, v84
v_fmac_f32 v95, v73, v85
v_mfma_f32_16x16x32_bf16 a[220:223], v[156:159], v[184:187], a[220:223]
v_fmac_f32 v95, v72, v86
v_mul_f32 v95, v95, v97
v_mfma_f32_16x16x32_bf16 a[252:255], v[156:159], v[188:191], a[252:255]
v_mul_f32 v96, v75, v82
v_lshlrev_b32 v97, 16, v57
v_mfma_f32_16x16x32_bf16 a[248:251], v[152:155], v[188:191], a[248:251]
v_fmac_f32 v96, v74, v83
v_fmac_f32 v96, v73, v84
v_mfma_f32_16x16x32_bf16 a[244:247], v[148:151], v[188:191], a[244:247]
v_fmac_f32 v96, v72, v85
v_mul_f32 v96, v96, v97
v_mfma_f32_16x16x32_bf16 a[240:243], v[144:147], v[188:191], a[240:243]
v_cvt_pk_bf16_f32 v104, v95, v96
v_mul_f32 v95, v75, v81
v_mfma_f32_16x16x32_bf16 a[236:239], v[140:143], v[188:191], a[236:239]
v_lshlrev_b32 v97, 16, v56
v_fmac_f32 v95, v74, v82
v_mfma_f32_16x16x32_bf16 a[232:235], v[136:139], v[188:191], a[232:235]
v_fmac_f32 v95, v73, v83
v_fmac_f32 v95, v72, v84
v_mfma_f32_16x16x32_bf16 a[228:231], v[132:135], v[188:191], a[228:231]
s_waitcnt vmcnt(1) lgkmcnt(0)
v_mul_f32 v95, v95, v97
v_mul_f32 v96, v75, v80
v_mfma_f32_16x16x32_bf16 a[224:227], v[128:131], v[188:191], a[224:227]
s_barrier
v_lshlrev_b32 v97, 16, v55
v_fmac_f32 v96, v74, v81
v_mfma_f32_16x16x32_bf16 a[0:3], v[224:227], v[192:195], a[0:3]
s_add_u32 s73, s61, 4
ds_read_b64_tr_b16 v[160:161], v20 offset:32768
v_fmac_f32 v96, v73, v82
v_mfma_f32_16x16x32_bf16 a[4:7], v[224:227], v[196:199], a[4:7]
s_and_b32 s73, s73, 7
v_fmac_f32 v96, v72, v83
v_mul_f32 v96, v96, v97
v_mfma_f32_16x16x32_bf16 a[8:11], v[224:227], v[200:203], a[8:11]
s_lshl_b32 s69, s73, 7
ds_read_b64_tr_b16 v[162:163], v20 offset:33792
v_cvt_pk_bf16_f32 v105, v95, v96
v_mfma_f32_16x16x32_bf16 a[12:15], v[224:227], v[204:207], a[12:15]
s_add_u32 s69, s69, s65
v_mul_f32 v95, v75, v79
v_lshlrev_b32 v97, 16, v54
v_mfma_f32_16x16x32_bf16 a[16:19], v[224:227], v[208:211], a[16:19]
s_lshl_b32 s71, s73, 19
ds_read_b128 v[128:131], v24 offset:32768
v_fmac_f32 v95, v74, v80
v_mfma_f32_16x16x32_bf16 a[20:23], v[224:227], v[212:215], a[20:23]
s_add_u32 s71, s71, s66
v_fmac_f32 v95, v73, v81
v_fmac_f32 v95, v72, v82
v_mfma_f32_16x16x32_bf16 a[24:27], v[224:227], v[216:219], a[24:27]
s_add_u32 m0, s63, 65536
ds_read_b128 v[132:135], v24 offset:34816
v_mul_f32 v95, v95, v97
v_mfma_f32_16x16x32_bf16 a[28:31], v[224:227], v[220:223], a[28:31]
s_add_u32 s72, s69, 0
buffer_load_dwordx4 v2, s[8:11], s72 offen lds
v_mfma_f32_16x16x32_bf16 a[60:63], v[228:231], v[220:223], a[60:63]
s_add_u32 s72, s69, 7168
ds_read_b128 v[136:139], v24 offset:36864
v_mul_f32 v96, v75, v78
v_mfma_f32_16x16x32_bf16 a[56:59], v[228:231], v[216:219], a[56:59]
buffer_load_dwordx4 v3, s[8:11], s72 offen offset:1024 lds
v_mfma_f32_16x16x32_bf16 a[52:55], v[228:231], v[212:215], a[52:55]
s_add_u32 s72, s69, 14336
ds_read_b128 v[140:143], v24 offset:38912
v_lshlrev_b32 v97, 16, v53
v_mfma_f32_16x16x32_bf16 a[48:51], v[228:231], v[208:211], a[48:51]
buffer_load_dwordx4 v2, s[8:11], s72 offen offset:2048 lds
v_mfma_f32_16x16x32_bf16 a[44:47], v[228:231], v[204:207], a[44:47]
ds_read_b128 v[144:147], v24 offset:40960
v_fmac_f32 v96, v74, v79
v_mfma_f32_16x16x32_bf16 a[40:43], v[228:231], v[200:203], a[40:43]
v_fmac_f32 v96, v73, v80
v_fmac_f32 v96, v72, v81
v_mfma_f32_16x16x32_bf16 a[36:39], v[228:231], v[196:199], a[36:39]
s_add_u32 s72, s69, 21504
ds_read_b128 v[148:151], v24 offset:43008
v_mul_f32 v96, v96, v97
v_mfma_f32_16x16x32_bf16 a[32:35], v[228:231], v[192:195], a[32:35]
buffer_load_dwordx4 v3, s[8:11], s72 offen offset:3072 lds
v_mfma_f32_16x16x32_bf16 a[64:67], v[232:235], v[192:195], a[64:67]
ds_read_b128 v[152:155], v24 offset:45056
v_cvt_pk_bf16_f32 v106, v95, v96
v_mfma_f32_16x16x32_bf16 a[68:71], v[232:235], v[196:199], a[68:71]
v_mul_f32 v95, v75, v77
v_lshlrev_b32 v97, 16, v52
v_mfma_f32_16x16x32_bf16 a[72:75], v[232:235], v[200:203], a[72:75]
ds_read_b128 v[156:159], v24 offset:47104
v_fmac_f32 v95, v74, v78
v_mfma_f32_16x16x32_bf16 a[76:79], v[232:235], v[204:207], a[76:79]
s_add_u32 m0, s64, 0
v_fmac_f32 v95, v73, v79
v_fmac_f32 v95, v72, v80
v_mfma_f32_16x16x32_bf16 a[80:83], v[232:235], v[208:211], a[80:83]
s_add_u32 s72, s71, 0
ds_read_b64_tr_b16 v[164:165], v21 offset:32768
v_mul_f32 v95, v95, v97
v_mfma_f32_16x16x32_bf16 a[84:87], v[232:235], v[212:215], a[84:87]
buffer_load_dwordx4 v6, s[16:19], s72 offen lds
v_mfma_f32_16x16x32_bf16 a[88:91], v[232:235], v[216:219], a[88:91]
ds_read_b64_tr_b16 v[166:167], v21 offset:33792
v_mul_f32 v96, v75, v76
v_mfma_f32_16x16x32_bf16 a[92:95], v[232:235], v[220:223], a[92:95]
v_lshlrev_b32 v97, 16, v51
v_fmac_f32 v96, v74, v77
v_mfma_f32_16x16x32_bf16 a[124:127], v[236:239], v[220:223], a[124:127]
s_add_u32 s72, s71, 31744
ds_read_b64_tr_b16 v[168:169], v22 offset:32768
v_fmac_f32 v96, v73, v78
v_mfma_f32_16x16x32_bf16 a[120:123], v[236:239], v[216:219], a[120:123]
buffer_load_dwordx4 v6, s[16:19], s72 offen offset:1024 lds
v_mfma_f32_16x16x32_bf16 a[116:119], v[236:239], v[212:215], a[116:119]
ds_read_b64_tr_b16 v[170:171], v22 offset:33792
v_fmac_f32 v96, v72, v79
v_mfma_f32_16x16x32_bf16 a[112:115], v[236:239], v[208:211], a[112:115]
v_mul_f32 v96, v96, v97
v_cvt_pk_bf16_f32 v107, v95, v96
v_mfma_f32_16x16x32_bf16 a[108:111], v[236:239], v[204:207], a[108:111]
s_add_u32 s72, s71, 63488
ds_read_b64_tr_b16 v[172:173], v23 offset:32768
v_mfma_f32_16x16x32_bf16 a[104:107], v[236:239], v[200:203], a[104:107]
buffer_load_dwordx4 v7, s[16:19], s72 offen offset:2048 lds
v_mfma_f32_16x16x32_bf16 a[100:103], v[236:239], v[196:199], a[100:103]
ds_read_b64_tr_b16 v[174:175], v23 offset:33792
v_mfma_f32_16x16x32_bf16 a[96:99], v[236:239], v[192:195], a[96:99]
buffer_store_dwordx4 v[104:107], v28, s[44:47], s80 offen offset:16 sc1
v_mfma_f32_16x16x32_bf16 a[128:131], v[192:195], v[240:243], a[128:131]
ds_read_b64_tr_b16 v[176:177], v20 offset:49152
v_mfma_f32_16x16x32_bf16 a[132:135], v[196:199], v[240:243], a[132:135]
s_add_u32 s72, s71, 95232
buffer_load_dwordx4 v7, s[16:19], s72 offen offset:3072 lds
v_mfma_f32_16x16x32_bf16 a[136:139], v[200:203], v[240:243], a[136:139]
ds_read_b64_tr_b16 v[178:179], v20 offset:50176
v_mfma_f32_16x16x32_bf16 a[140:143], v[204:207], v[240:243], a[140:143]
global_load_dwordx4 v[84:87], v1, s[56:57]
v_mfma_f32_16x16x32_bf16 a[144:147], v[208:211], v[240:243], a[144:147]
ds_read_b64_tr_b16 v[180:181], v21 offset:49152
v_mfma_f32_16x16x32_bf16 a[148:151], v[212:215], v[240:243], a[148:151]
global_load_dwordx4 v[88:91], v1, s[56:57] offset:1024
v_mfma_f32_16x16x32_bf16 a[152:155], v[216:219], v[240:243], a[152:155]
s_add_u32 m0, s63, 69632
ds_read_b64_tr_b16 v[182:183], v21 offset:50176
v_lshlrev_b32 v72, 16, v70
v_mfma_f32_16x16x32_bf16 a[156:159], v[220:223], v[240:243], a[156:159]
s_add_u32 s72, s69, 32768
buffer_load_dwordx4 v2, s[8:11], s72 offen lds
v_mfma_f32_16x16x32_bf16 a[188:191], v[220:223], v[244:247], a[188:191]
ds_read_b64_tr_b16 v[184:185], v22 offset:49152
v_and_b32 v73, 0xffff0000, v70
v_mfma_f32_16x16x32_bf16 a[184:187], v[216:219], v[244:247], a[184:187]
v_lshlrev_b32 v74, 16, v71
v_and_b32 v75, 0xffff0000, v71
v_mfma_f32_16x16x32_bf16 a[180:183], v[212:215], v[244:247], a[180:183]
ds_read_b64_tr_b16 v[186:187], v22 offset:50176
v_and_b32 v32, 0xffff0000, v32
v_mfma_f32_16x16x32_bf16 a[176:179], v[208:211], v[244:247], a[176:179]
s_add_u32 s72, s69, 39936
buffer_load_dwordx4 v3, s[8:11], s72 offen offset:1024 lds
v_mfma_f32_16x16x32_bf16 a[172:175], v[204:207], v[244:247], a[172:175]
ds_read_b64_tr_b16 v[188:189], v23 offset:49152
v_and_b32 v33, 0xffff0000, v33
v_mfma_f32_16x16x32_bf16 a[168:171], v[200:203], v[244:247], a[168:171]
v_and_b32 v34, 0xffff0000, v34
v_and_b32 v35, 0xffff0000, v35
v_mfma_f32_16x16x32_bf16 a[164:167], v[196:199], v[244:247], a[164:167]
ds_read_b64_tr_b16 v[190:191], v23 offset:50176
v_and_b32 v36, 0xffff0000, v36
v_mfma_f32_16x16x32_bf16 a[160:163], v[192:195], v[244:247], a[160:163]
v_and_b32 v37, 0xffff0000, v37
v_and_b32 v38, 0xffff0000, v38
v_mfma_f32_16x16x32_bf16 a[192:195], v[192:195], v[248:251], a[192:195]
s_add_u32 s72, s69, 47104
buffer_load_dwordx4 v2, s[8:11], s72 offen offset:2048 lds
v_mfma_f32_16x16x32_bf16 a[196:199], v[196:199], v[248:251], a[196:199]
v_and_b32 v39, 0xffff0000, v39
v_and_b32 v40, 0xffff0000, v40
v_mfma_f32_16x16x32_bf16 a[200:203], v[200:203], v[248:251], a[200:203]
v_and_b32 v41, 0xffff0000, v41
v_and_b32 v42, 0xffff0000, v42
v_mfma_f32_16x16x32_bf16 a[204:207], v[204:207], v[248:251], a[204:207]
v_and_b32 v43, 0xffff0000, v43
v_and_b32 v44, 0xffff0000, v44
v_mfma_f32_16x16x32_bf16 a[208:211], v[208:211], v[248:251], a[208:211]
s_add_u32 s72, s69, 54272
buffer_load_dwordx4 v3, s[8:11], s72 offen offset:3072 lds
v_mfma_f32_16x16x32_bf16 a[212:215], v[212:215], v[248:251], a[212:215]
v_and_b32 v45, 0xffff0000, v45
v_and_b32 v46, 0xffff0000, v46
v_mfma_f32_16x16x32_bf16 a[216:219], v[216:219], v[248:251], a[216:219]
v_and_b32 v47, 0xffff0000, v47
v_and_b32 v48, 0xffff0000, v48
v_mfma_f32_16x16x32_bf16 a[220:223], v[220:223], v[248:251], a[220:223]
v_and_b32 v49, 0xffff0000, v49
v_and_b32 v50, 0xffff0000, v50
v_mfma_f32_16x16x32_bf16 a[252:255], v[220:223], v[252:255], a[252:255]
v_mul_f32 v95, v75, v47
v_and_b32 v97, 0xffff0000, v66
v_mfma_f32_16x16x32_bf16 a[248:251], v[216:219], v[252:255], a[248:251]
s_add_u32 m0, s64, 16384
v_fmac_f32 v95, v74, v48
v_fmac_f32 v95, v73, v49
v_mfma_f32_16x16x32_bf16 a[244:247], v[212:215], v[252:255], a[244:247]
s_add_u32 s72, s71, 0
buffer_load_dwordx4 v6, s[20:23], s72 offen lds
v_mfma_f32_16x16x32_bf16 a[240:243], v[208:211], v[252:255], a[240:243]
v_fmac_f32 v95, v72, v50
v_mul_f32 v95, v95, v97
v_mfma_f32_16x16x32_bf16 a[236:239], v[204:207], v[252:255], a[236:239]
v_mul_f32 v96, v75, v46
v_and_b32 v97, 0xffff0000, v65
v_mfma_f32_16x16x32_bf16 a[232:235], v[200:203], v[252:255], a[232:235]
v_fmac_f32 v96, v74, v47
v_fmac_f32 v96, v73, v48
v_mfma_f32_16x16x32_bf16 a[228:231], v[196:199], v[252:255], a[228:231]
s_add_u32 s72, s71, 31744
buffer_load_dwordx4 v6, s[20:23], s72 offen offset:1024 lds
v_mfma_f32_16x16x32_bf16 a[224:227], v[192:195], v[252:255], a[224:227]
s_waitcnt lgkmcnt(0)
v_fmac_f32 v96, v72, v49
v_mul_f32 v96, v96, v97
v_mfma_f32_16x16x32_bf16 a[0:3], v[160:163], v[128:131], a[0:3]
ds_read_b64_tr_b16 v[224:225], v20 offset:40960
v_cvt_pk_bf16_f32 v100, v95, v96
v_mfma_f32_16x16x32_bf16 a[4:7], v[160:163], v[132:135], a[4:7]
v_mul_f32 v95, v75, v45
v_and_b32 v97, 0xffff0000, v64
v_mfma_f32_16x16x32_bf16 a[8:11], v[160:163], v[136:139], a[8:11]
ds_read_b64_tr_b16 v[226:227], v20 offset:41984
v_fmac_f32 v95, v74, v46
v_mfma_f32_16x16x32_bf16 a[12:15], v[160:163], v[140:143], a[12:15]
s_add_u32 s72, s71, 63488
buffer_load_dwordx4 v7, s[20:23], s72 offen offset:2048 lds
v_mfma_f32_16x16x32_bf16 a[16:19], v[160:163], v[144:147], a[16:19]
ds_read_b128 v[192:195], v25 offset:32768
v_fmac_f32 v95, v73, v47
v_mfma_f32_16x16x32_bf16 a[20:23], v[160:163], v[148:151], a[20:23]
v_fmac_f32 v95, v72, v48
v_mul_f32 v95, v95, v97
v_mfma_f32_16x16x32_bf16 a[24:27], v[160:163], v[152:155], a[24:27]
ds_read_b128 v[196:199], v25 offset:34816
v_mul_f32 v96, v75, v44
v_mfma_f32_16x16x32_bf16 a[28:31], v[160:163], v[156:159], a[28:31]
v_and_b32 v97, 0xffff0000, v63
v_fmac_f32 v96, v74, v45
v_mfma_f32_16x16x32_bf16 a[60:63], v[164:167], v[156:159], a[60:63]
s_add_u32 s72, s71, 95232
ds_read_b128 v[200:203], v25 offset:36864
v_fmac_f32 v96, v73, v46
v_mfma_f32_16x16x32_bf16 a[56:59], v[164:167], v[152:155], a[56:59]
buffer_load_dwordx4 v7, s[20:23], s72 offen offset:3072 lds
v_mfma_f32_16x16x32_bf16 a[52:55], v[164:167], v[148:151], a[52:55]
ds_read_b128 v[204:207], v25 offset:38912
v_fmac_f32 v96, v72, v47
v_mfma_f32_16x16x32_bf16 a[48:51], v[164:167], v[144:147], a[48:51]
v_mul_f32 v96, v96, v97
v_cvt_pk_bf16_f32 v101, v95, v96
v_mfma_f32_16x16x32_bf16 a[44:47], v[164:167], v[140:143], a[44:47]
ds_read_b128 v[208:211], v25 offset:40960
v_mul_f32 v95, v75, v43
v_mfma_f32_16x16x32_bf16 a[40:43], v[164:167], v[136:139], a[40:43]
v_and_b32 v97, 0xffff0000, v62
v_fmac_f32 v95, v74, v44
v_mfma_f32_16x16x32_bf16 a[36:39], v[164:167], v[132:135], a[36:39]
ds_read_b128 v[212:215], v25 offset:43008
v_fmac_f32 v95, v73, v45
v_mfma_f32_16x16x32_bf16 a[32:35], v[164:167], v[128:131], a[32:35]
v_fmac_f32 v95, v72, v46
v_mul_f32 v95, v95, v97
v_mfma_f32_16x16x32_bf16 a[64:67], v[168:171], v[128:131], a[64:67]
ds_read_b128 v[216:219], v25 offset:45056
v_mul_f32 v96, v75, v42
v_mfma_f32_16x16x32_bf16 a[68:71], v[168:171], v[132:135], a[68:71]
v_and_b32 v97, 0xffff0000, v61
v_fmac_f32 v96, v74, v43
v_mfma_f32_16x16x32_bf16 a[72:75], v[168:171], v[136:139], a[72:75]
ds_read_b128 v[220:223], v25 offset:47104
v_fmac_f32 v96, v73, v44
v_mfma_f32_16x16x32_bf16 a[76:79], v[168:171], v[140:143], a[76:79]
v_fmac_f32 v96, v72, v45
v_mul_f32 v96, v96, v97
v_mfma_f32_16x16x32_bf16 a[80:83], v[168:171], v[144:147], a[80:83]
ds_read_b64_tr_b16 v[228:229], v21 offset:40960
v_cvt_pk_bf16_f32 v102, v95, v96
v_mfma_f32_16x16x32_bf16 a[84:87], v[168:171], v[148:151], a[84:87]
v_mul_f32 v95, v75, v41
v_and_b32 v97, 0xffff0000, v60
v_mfma_f32_16x16x32_bf16 a[88:91], v[168:171], v[152:155], a[88:91]
ds_read_b64_tr_b16 v[230:231], v21 offset:41984
v_fmac_f32 v95, v74, v42
v_mfma_f32_16x16x32_bf16 a[92:95], v[168:171], v[156:159], a[92:95]
v_fmac_f32 v95, v73, v43
v_fmac_f32 v95, v72, v44
v_mfma_f32_16x16x32_bf16 a[124:127], v[172:175], v[156:159], a[124:127]
ds_read_b64_tr_b16 v[232:233], v22 offset:40960
v_mul_f32 v95, v95, v97
v_mfma_f32_16x16x32_bf16 a[120:123], v[172:175], v[152:155], a[120:123]
v_mul_f32 v96, v75, v40
v_and_b32 v97, 0xffff0000, v59
v_mfma_f32_16x16x32_bf16 a[116:119], v[172:175], v[148:151], a[116:119]
ds_read_b64_tr_b16 v[234:235], v22 offset:41984
v_fmac_f32 v96, v74, v41
v_mfma_f32_16x16x32_bf16 a[112:115], v[172:175], v[144:147], a[112:115]
v_fmac_f32 v96, v73, v42
v_fmac_f32 v96, v72, v43
v_mfma_f32_16x16x32_bf16 a[108:111], v[172:175], v[140:143], a[108:111]
ds_read_b64_tr_b16 v[236:237], v23 offset:40960
v_mul_f32 v96, v96, v97
v_mfma_f32_16x16x32_bf16 a[104:107], v[172:175], v[136:139], a[104:107]
v_cvt_pk_bf16_f32 v103, v95, v96
v_mfma_f32_16x16x32_bf16 a[100:103], v[172:175], v[132:135], a[100:103]
s_mov_b32 s80, 0x3001000
ds_read_b64_tr_b16 v[238:239], v23 offset:41984
v_mfma_f32_16x16x32_bf16 a[96:99], v[172:175], v[128:131], a[96:99]
buffer_store_dwordx4 v[100:103], v28, s[44:47], s80 offen sc1
v_mfma_f32_16x16x32_bf16 a[128:131], v[128:131], v[176:179], a[128:131]
ds_read_b64_tr_b16 v[240:241], v20 offset:57344
v_mul_f32 v95, v75, v39
v_mfma_f32_16x16x32_bf16 a[132:135], v[132:135], v[176:179], a[132:135]
v_and_b32 v97, 0xffff0000, v58
v_fmac_f32 v95, v74, v40
v_mfma_f32_16x16x32_bf16 a[136:139], v[136:139], v[176:179], a[136:139]
ds_read_b64_tr_b16 v[242:243], v20 offset:58368
v_fmac_f32 v95, v73, v41
v_mfma_f32_16x16x32_bf16 a[140:143], v[140:143], v[176:179], a[140:143]
v_fmac_f32 v95, v72, v42
v_mul_f32 v95, v95, v97
v_mfma_f32_16x16x32_bf16 a[144:147], v[144:147], v[176:179], a[144:147]
ds_read_b64_tr_b16 v[244:245], v21 offset:57344
v_mul_f32 v96, v75, v38
v_mfma_f32_16x16x32_bf16 a[148:151], v[148:151], v[176:179], a[148:151]
v_and_b32 v97, 0xffff0000, v57
v_fmac_f32 v96, v74, v39
v_mfma_f32_16x16x32_bf16 a[152:155], v[152:155], v[176:179], a[152:155]
ds_read_b64_tr_b16 v[246:247], v21 offset:58368
v_fmac_f32 v96, v73, v40
v_mfma_f32_16x16x32_bf16 a[156:159], v[156:159], v[176:179], a[156:159]
v_fmac_f32 v96, v72, v41
v_mul_f32 v96, v96, v97
v_mfma_f32_16x16x32_bf16 a[188:191], v[156:159], v[180:183], a[188:191]
ds_read_b64_tr_b16 v[248:249], v22 offset:57344
v_cvt_pk_bf16_f32 v104, v95, v96
v_mfma_f32_16x16x32_bf16 a[184:187], v[152:155], v[180:183], a[184:187]
v_mul_f32 v95, v75, v37
v_and_b32 v97, 0xffff0000, v56
v_mfma_f32_16x16x32_bf16 a[180:183], v[148:151], v[180:183], a[180:183]
ds_read_b64_tr_b16 v[250:251], v22 offset:58368
v_fmac_f32 v95, v74, v38
v_mfma_f32_16x16x32_bf16 a[176:179], v[144:147], v[180:183], a[176:179]
v_fmac_f32 v95, v73, v39
v_fmac_f32 v95, v72, v40
v_mfma_f32_16x16x32_bf16 a[172:175], v[140:143], v[180:183], a[172:175]
ds_read_b64_tr_b16 v[252:253], v23 offset:57344
v_mul_f32 v95, v95, v97
v_mfma_f32_16x16x32_bf16 a[168:171], v[136:139], v[180:183], a[168:171]
v_mul_f32 v96, v75, v36
v_and_b32 v97, 0xffff0000, v55
v_mfma_f32_16x16x32_bf16 a[164:167], v[132:135], v[180:183], a[164:167]
ds_read_b64_tr_b16 v[254:255], v23 offset:58368
v_fmac_f32 v96, v74, v37
v_mfma_f32_16x16x32_bf16 a[160:163], v[128:131], v[180:183], a[160:163]
v_fmac_f32 v96, v73, v38
v_fmac_f32 v96, v72, v39
v_mfma_f32_16x16x32_bf16 a[192:195], v[128:131], v[184:187], a[192:195]
v_mul_f32 v96, v96, v97
v_cvt_pk_bf16_f32 v105, v95, v96
v_mfma_f32_16x16x32_bf16 a[196:199], v[132:135], v[184:187], a[196:199]
v_mul_f32 v95, v75, v35
v_and_b32 v97, 0xffff0000, v54
v_mfma_f32_16x16x32_bf16 a[200:203], v[136:139], v[184:187], a[200:203]
v_fmac_f32 v95, v74, v36
v_fmac_f32 v95, v73, v37
v_mfma_f32_16x16x32_bf16 a[204:207], v[140:143], v[184:187], a[204:207]
v_fmac_f32 v95, v72, v38
v_mul_f32 v95, v95, v97
v_mfma_f32_16x16x32_bf16 a[208:211], v[144:147], v[184:187], a[208:211]
v_mul_f32 v96, v75, v34
v_and_b32 v97, 0xffff0000, v53
v_mfma_f32_16x16x32_bf16 a[212:215], v[148:151], v[184:187], a[212:215]
v_fmac_f32 v96, v74, v35
v_fmac_f32 v96, v73, v36
v_mfma_f32_16x16x32_bf16 a[216:219], v[152:155], v[184:187], a[216:219]
v_fmac_f32 v96, v72, v37
v_mul_f32 v96, v96, v97
v_mfma_f32_16x16x32_bf16 a[220:223], v[156:159], v[184:187], a[220:223]
v_cvt_pk_bf16_f32 v106, v95, v96
v_mul_f32 v95, v75, v33
v_mfma_f32_16x16x32_bf16 a[252:255], v[156:159], v[188:191], a[252:255]
v_and_b32 v97, 0xffff0000, v52
v_fmac_f32 v95, v74, v34
v_mfma_f32_16x16x32_bf16 a[248:251], v[152:155], v[188:191], a[248:251]
v_fmac_f32 v95, v73, v35
v_fmac_f32 v95, v72, v36
v_mfma_f32_16x16x32_bf16 a[244:247], v[148:151], v[188:191], a[244:247]
v_mul_f32 v95, v95, v97
v_mul_f32 v96, v75, v32
v_mfma_f32_16x16x32_bf16 a[240:243], v[144:147], v[188:191], a[240:243]
v_and_b32 v97, 0xffff0000, v51
v_fmac_f32 v96, v74, v33
v_mfma_f32_16x16x32_bf16 a[236:239], v[140:143], v[188:191], a[236:239]
v_fmac_f32 v96, v73, v34
v_fmac_f32 v96, v72, v35
v_mfma_f32_16x16x32_bf16 a[232:235], v[136:139], v[188:191], a[232:235]
v_mul_f32 v96, v96, v97
v_cvt_pk_bf16_f32 v107, v95, v96
v_mfma_f32_16x16x32_bf16 a[228:231], v[132:135], v[188:191], a[228:231]
s_waitcnt vmcnt(1) lgkmcnt(0)
buffer_store_dwordx4 v[104:107], v28, s[44:47], s80 offen offset:16 sc1
v_mfma_f32_16x16x32_bf16 a[224:227], v[128:131], v[188:191], a[224:227]
s_barrier
v_mfma_f32_16x16x32_bf16 a[0:3], v[224:227], v[192:195], a[0:3]
s_add_u32 s73, s61, 5
ds_read_b64_tr_b16 v[160:161], v20 offset:0
v_mfma_f32_16x16x32_bf16 a[4:7], v[224:227], v[196:199], a[4:7]
s_and_b32 s73, s73, 7
v_mfma_f32_16x16x32_bf16 a[8:11], v[224:227], v[200:203], a[8:11]
s_lshl_b32 s69, s73, 7
ds_read_b64_tr_b16 v[162:163], v20 offset:1024
v_mfma_f32_16x16x32_bf16 a[12:15], v[224:227], v[204:207], a[12:15]
s_add_u32 s69, s69, s65
v_mfma_f32_16x16x32_bf16 a[16:19], v[224:227], v[208:211], a[16:19]
s_lshl_b32 s71, s73, 19
ds_read_b128 v[128:131], v24 offset:0
v_mfma_f32_16x16x32_bf16 a[20:23], v[224:227], v[212:215], a[20:23]
s_add_u32 s71, s71, s66
v_mfma_f32_16x16x32_bf16 a[24:27], v[224:227], v[216:219], a[24:27]
s_add_u32 m0, s63, 98304
ds_read_b128 v[132:135], v24 offset:2048
v_mfma_f32_16x16x32_bf16 a[28:31], v[224:227], v[220:223], a[28:31]
s_add_u32 s72, s69, 0
buffer_load_dwordx4 v2, s[8:11], s72 offen lds
v_mfma_f32_16x16x32_bf16 a[60:63], v[228:231], v[220:223], a[60:63]
s_add_u32 s72, s69, 7168
ds_read_b128 v[136:139], v24 offset:4096
v_mfma_f32_16x16x32_bf16 a[56:59], v[228:231], v[216:219], a[56:59]
s_waitcnt vmcnt(11)
buffer_load_dwordx4 v3, s[8:11], s72 offen offset:1024 lds
v_mfma_f32_16x16x32_bf16 a[52:55], v[228:231], v[212:215], a[52:55]
s_add_u32 s72, s69, 14336
ds_read_b128 v[140:143], v24 offset:6144
v_lshlrev_b32 v78, 16, v84
v_mfma_f32_16x16x32_bf16 a[48:51], v[228:231], v[208:211], a[48:51]
buffer_load_dwordx4 v2, s[8:11], s72 offen offset:2048 lds
v_mfma_f32_16x16x32_bf16 a[44:47], v[228:231], v[204:207], a[44:47]
ds_read_b128 v[144:147], v24 offset:8192
v_lshlrev_b32 v79, 16, v108
v_mfma_f32_16x16x32_bf16 a[40:43], v[228:231], v[200:203], a[40:43]
v_mul_f32 v76, v78, v79
v_lshlrev_b32 v80, 16, v116
v_mfma_f32_16x16x32_bf16 a[36:39], v[228:231], v[196:199], a[36:39]
s_add_u32 s72, s69, 21504
ds_read_b128 v[148:151], v24 offset:10240
v_mul_f32 v77, v78, v80
v_mfma_f32_16x16x32_bf16 a[32:35], v[228:231], v[192:195], a[32:35]
buffer_load_dwordx4 v3, s[8:11], s72 offen offset:3072 lds
v_mfma_f32_16x16x32_bf16 a[64:67], v[232:235], v[192:195], a[64:67]
ds_read_b128 v[152:155], v24 offset:12288
v_and_b32 v78, 0xffff0000, v84
v_mfma_f32_16x16x32_bf16 a[68:71], v[232:235], v[196:199], a[68:71]
v_and_b32 v79, 0xffff0000, v108
v_fmac_f32 v76, v78, v79
v_mfma_f32_16x16x32_bf16 a[72:75], v[232:235], v[200:203], a[72:75]
ds_read_b128 v[156:159], v24 offset:14336
v_and_b32 v80, 0xffff0000, v116
v_mfma_f32_16x16x32_bf16 a[76:79], v[232:235], v[204:207], a[76:79]
s_add_u32 m0, s64, 32768
v_fmac_f32 v77, v78, v80
v_lshlrev_b32 v78, 16, v85
v_mfma_f32_16x16x32_bf16 a[80:83], v[232:235], v[208:211], a[80:83]
s_add_u32 s72, s71, 0
ds_read_b64_tr_b16 v[164:165], v21 offset:0
v_lshlrev_b32 v79, 16, v109
v_mfma_f32_16x16x32_bf16 a[84:87], v[232:235], v[212:215], a[84:87]
buffer_load_dwordx4 v6, s[16:19], s72 offen lds
v_mfma_f32_16x16x32_bf16 a[88:91], v[232:235], v[216:219], a[88:91]
ds_read_b64_tr_b16 v[166:167], v21 offset:1024
v_fmac_f32 v76, v78, v79
v_mfma_f32_16x16x32_bf16 a[92:95], v[232:235], v[220:223], a[92:95]
v_lshlrev_b32 v80, 16, v117
v_fmac_f32 v77, v78, v80
v_mfma_f32_16x16x32_bf16 a[124:127], v[236:239], v[220:223], a[124:127]
s_add_u32 s72, s71, 31744
ds_read_b64_tr_b16 v[168:169], v22 offset:0
v_and_b32 v78, 0xffff0000, v85
v_mfma_f32_16x16x32_bf16 a[120:123], v[236:239], v[216:219], a[120:123]
buffer_load_dwordx4 v6, s[16:19], s72 offen offset:1024 lds
v_mfma_f32_16x16x32_bf16 a[116:119], v[236:239], v[212:215], a[116:119]
ds_read_b64_tr_b16 v[170:171], v22 offset:1024
v_and_b32 v79, 0xffff0000, v109
v_mfma_f32_16x16x32_bf16 a[112:115], v[236:239], v[208:211], a[112:115]
v_fmac_f32 v76, v78, v79
v_and_b32 v80, 0xffff0000, v117
v_mfma_f32_16x16x32_bf16 a[108:111], v[236:239], v[204:207], a[108:111]
s_add_u32 s72, s71, 63488
ds_read_b64_tr_b16 v[172:173], v23 offset:0
v_fmac_f32 v77, v78, v80
v_mfma_f32_16x16x32_bf16 a[104:107], v[236:239], v[200:203], a[104:107]
buffer_load_dwordx4 v7, s[16:19], s72 offen offset:2048 lds
v_mfma_f32_16x16x32_bf16 a[100:103], v[236:239], v[196:199], a[100:103]
ds_read_b64_tr_b16 v[174:175], v23 offset:1024
v_lshlrev_b32 v78, 16, v86
v_mfma_f32_16x16x32_bf16 a[96:99], v[236:239], v[192:195], a[96:99]
v_lshlrev_b32 v79, 16, v110
v_fmac_f32 v76, v78, v79
v_mfma_f32_16x16x32_bf16 a[128:131], v[192:195], v[240:243], a[128:131]
ds_read_b64_tr_b16 v[176:177], v20 offset:16384
v_lshlrev_b32 v80, 16, v118
v_mfma_f32_16x16x32_bf16 a[132:135], v[196:199], v[240:243], a[132:135]
s_add_u32 s72, s71, 95232
buffer_load_dwordx4 v7, s[16:19], s72 offen offset:3072 lds
v_mfma_f32_16x16x32_bf16 a[136:139], v[200:203], v[240:243], a[136:139]
ds_read_b64_tr_b16 v[178:179], v20 offset:17408
v_fmac_f32 v77, v78, v80
v_mfma_f32_16x16x32_bf16 a[140:143], v[204:207], v[240:243], a[140:143]
v_and_b32 v78, 0xffff0000, v86
v_and_b32 v79, 0xffff0000, v110
v_mfma_f32_16x16x32_bf16 a[144:147], v[208:211], v[240:243], a[144:147]
ds_read_b64_tr_b16 v[180:181], v21 offset:16384
v_fmac_f32 v76, v78, v79
v_mfma_f32_16x16x32_bf16 a[148:151], v[212:215], v[240:243], a[148:151]
v_and_b32 v80, 0xffff0000, v118
v_fmac_f32 v77, v78, v80
v_mfma_f32_16x16x32_bf16 a[152:155], v[216:219], v[240:243], a[152:155]
s_add_u32 m0, s63, 102400
ds_read_b64_tr_b16 v[182:183], v21 offset:17408
v_lshlrev_b32 v78, 16, v87
v_mfma_f32_16x16x32_bf16 a[156:159], v[220:223], v[240:243], a[156:159]
s_add_u32 s72, s69, 32768
buffer_load_dwordx4 v2, s[8:11], s72 offen lds
v_mfma_f32_16x16x32_bf16 a[188:191], v[220:223], v[244:247], a[188:191]
ds_read_b64_tr_b16 v[184:185], v22 offset:16384
v_lshlrev_b32 v79, 16, v111
v_mfma_f32_16x16x32_bf16 a[184:187], v[216:219], v[244:247], a[184:187]
v_fmac_f32 v76, v78, v79
v_lshlrev_b32 v80, 16, v119
v_mfma_f32_16x16x32_bf16 a[180:183], v[212:215], v[244:247], a[180:183]
ds_read_b64_tr_b16 v[186:187], v22 offset:17408
v_fmac_f32 v77, v78, v80
v_mfma_f32_16x16x32_bf16 a[176:179], v[208:211], v[244:247], a[176:179]
s_add_u32 s72, s69, 39936
buffer_load_dwordx4 v3, s[8:11], s72 offen offset:1024 lds
v_mfma_f32_16x16x32_bf16 a[172:175], v[204:207], v[244:247], a[172:175]
ds_read_b64_tr_b16 v[188:189], v23 offset:16384
v_and_b32 v78, 0xffff0000, v87
v_mfma_f32_16x16x32_bf16 a[168:171], v[200:203], v[244:247], a[168:171]
v_and_b32 v79, 0xffff0000, v111
v_fmac_f32 v76, v78, v79
v_mfma_f32_16x16x32_bf16 a[164:167], v[196:199], v[244:247], a[164:167]
ds_read_b64_tr_b16 v[190:191], v23 offset:17408
v_and_b32 v80, 0xffff0000, v119
v_mfma_f32_16x16x32_bf16 a[160:163], v[192:195], v[244:247], a[160:163]
v_fmac_f32 v77, v78, v80
v_lshlrev_b32 v78, 16, v88
v_mfma_f32_16x16x32_bf16 a[192:195], v[192:195], v[248:251], a[192:195]
s_add_u32 s72, s69, 47104
buffer_load_dwordx4 v2, s[8:11], s72 offen offset:2048 lds
v_mfma_f32_16x16x32_bf16 a[196:199], v[196:199], v[248:251], a[196:199]
v_lshlrev_b32 v79, 16, v112
v_fmac_f32 v76, v78, v79
v_mfma_f32_16x16x32_bf16 a[200:203], v[200:203], v[248:251], a[200:203]
v_lshlrev_b32 v80, 16, v120
v_fmac_f32 v77, v78, v80
v_mfma_f32_16x16x32_bf16 a[204:207], v[204:207], v[248:251], a[204:207]
v_and_b32 v78, 0xffff0000, v88
v_and_b32 v79, 0xffff0000, v112
v_mfma_f32_16x16x32_bf16 a[208:211], v[208:211], v[248:251], a[208:211]
s_add_u32 s72, s69, 54272
buffer_load_dwordx4 v3, s[8:11], s72 offen offset:3072 lds
v_mfma_f32_16x16x32_bf16 a[212:215], v[212:215], v[248:251], a[212:215]
v_fmac_f32 v76, v78, v79
v_and_b32 v80, 0xffff0000, v120
v_mfma_f32_16x16x32_bf16 a[216:219], v[216:219], v[248:251], a[216:219]
v_fmac_f32 v77, v78, v80
v_lshlrev_b32 v78, 16, v89
v_mfma_f32_16x16x32_bf16 a[220:223], v[220:223], v[248:251], a[220:223]
v_lshlrev_b32 v79, 16, v113
v_fmac_f32 v76, v78, v79
v_mfma_f32_16x16x32_bf16 a[252:255], v[220:223], v[252:255], a[252:255]
v_lshlrev_b32 v80, 16, v121
v_fmac_f32 v77, v78, v80
v_mfma_f32_16x16x32_bf16 a[248:251], v[216:219], v[252:255], a[248:251]
s_add_u32 m0, s64, 49152
v_and_b32 v78, 0xffff0000, v89
v_and_b32 v79, 0xffff0000, v113
v_mfma_f32_16x16x32_bf16 a[244:247], v[212:215], v[252:255], a[244:247]
s_add_u32 s72, s71, 0
buffer_load_dwordx4 v6, s[20:23], s72 offen lds
v_mfma_f32_16x16x32_bf16 a[240:243], v[208:211], v[252:255], a[240:243]
v_fmac_f32 v76, v78, v79
v_and_b32 v80, 0xffff0000, v121
v_mfma_f32_16x16x32_bf16 a[236:239], v[204:207], v[252:255], a[236:239]
v_fmac_f32 v77, v78, v80
v_lshlrev_b32 v78, 16, v90
v_mfma_f32_16x16x32_bf16 a[232:235], v[200:203], v[252:255], a[232:235]
v_lshlrev_b32 v79, 16, v114
v_fmac_f32 v76, v78, v79
v_mfma_f32_16x16x32_bf16 a[228:231], v[196:199], v[252:255], a[228:231]
s_add_u32 s72, s71, 31744
buffer_load_dwordx4 v6, s[20:23], s72 offen offset:1024 lds
v_mfma_f32_16x16x32_bf16 a[224:227], v[192:195], v[252:255], a[224:227]
s_waitcnt lgkmcnt(0)
v_lshlrev_b32 v80, 16, v122
v_fmac_f32 v77, v78, v80
v_mfma_f32_16x16x32_bf16 a[0:3], v[160:163], v[128:131], a[0:3]
ds_read_b64_tr_b16 v[224:225], v20 offset:8192
v_and_b32 v78, 0xffff0000, v90
v_mfma_f32_16x16x32_bf16 a[4:7], v[160:163], v[132:135], a[4:7]
v_and_b32 v79, 0xffff0000, v114
v_fmac_f32 v76, v78, v79
v_mfma_f32_16x16x32_bf16 a[8:11], v[160:163], v[136:139], a[8:11]
ds_read_b64_tr_b16 v[226:227], v20 offset:9216
v_and_b32 v80, 0xffff0000, v122
v_mfma_f32_16x16x32_bf16 a[12:15], v[160:163], v[140:143], a[12:15]
s_add_u32 s72, s71, 63488
buffer_load_dwordx4 v7, s[20:23], s72 offen offset:2048 lds
v_mfma_f32_16x16x32_bf16 a[16:19], v[160:163], v[144:147], a[16:19]
ds_read_b128 v[192:195], v25 offset:0
v_fmac_f32 v77, v78, v80
v_mfma_f32_16x16x32_bf16 a[20:23], v[160:163], v[148:151], a[20:23]
v_lshlrev_b32 v78, 16, v91
v_lshlrev_b32 v79, 16, v115
v_mfma_f32_16x16x32_bf16 a[24:27], v[160:163], v[152:155], a[24:27]
ds_read_b128 v[196:199], v25 offset:2048
v_fmac_f32 v76, v78, v79
v_mfma_f32_16x16x32_bf16 a[28:31], v[160:163], v[156:159], a[28:31]
v_lshlrev_b32 v80, 16, v123
v_fmac_f32 v77, v78, v80
v_mfma_f32_16x16x32_bf16 a[60:63], v[164:167], v[156:159], a[60:63]
s_add_u32 s72, s71, 95232
ds_read_b128 v[200:203], v25 offset:4096
v_and_b32 v78, 0xffff0000, v91
v_mfma_f32_16x16x32_bf16 a[56:59], v[164:167], v[152:155], a[56:59]
buffer_load_dwordx4 v7, s[20:23], s72 offen offset:3072 lds
v_mfma_f32_16x16x32_bf16 a[52:55], v[164:167], v[148:151], a[52:55]
ds_read_b128 v[204:207], v25 offset:6144
v_and_b32 v79, 0xffff0000, v115
v_mfma_f32_16x16x32_bf16 a[48:51], v[164:167], v[144:147], a[48:51]
v_fmac_f32 v76, v78, v79
v_and_b32 v80, 0xffff0000, v123
v_mfma_f32_16x16x32_bf16 a[44:47], v[164:167], v[140:143], a[44:47]
ds_read_b128 v[208:211], v25 offset:8192
v_fmac_f32 v77, v78, v80
v_mfma_f32_16x16x32_bf16 a[40:43], v[164:167], v[136:139], a[40:43]
v_add_f32_dpp v76, v76, v76 row_ror:8 row_mask:0xf bank_mask:0xf
v_add_f32_dpp v77, v77, v77 row_ror:8 row_mask:0xf bank_mask:0xf
v_mfma_f32_16x16x32_bf16 a[36:39], v[164:167], v[132:135], a[36:39]
ds_read_b128 v[212:215], v25 offset:10240
v_add_f32_dpp v76, v76, v76 row_ror:4 row_mask:0xf bank_mask:0xf
v_mfma_f32_16x16x32_bf16 a[32:35], v[164:167], v[128:131], a[32:35]
v_add_f32_dpp v77, v77, v77 row_ror:4 row_mask:0xf bank_mask:0xf
v_add_f32_dpp v76, v76, v76 row_ror:2 row_mask:0xf bank_mask:0xf
v_mfma_f32_16x16x32_bf16 a[64:67], v[168:171], v[128:131], a[64:67]
ds_read_b128 v[216:219], v25 offset:12288
v_add_f32_dpp v77, v77, v77 row_ror:2 row_mask:0xf bank_mask:0xf
v_mfma_f32_16x16x32_bf16 a[68:71], v[168:171], v[132:135], a[68:71]
v_add_f32_dpp v76, v76, v76 row_ror:1 row_mask:0xf bank_mask:0xf
v_add_f32_dpp v77, v77, v77 row_ror:1 row_mask:0xf bank_mask:0xf
v_mfma_f32_16x16x32_bf16 a[72:75], v[168:171], v[136:139], a[72:75]
ds_read_b128 v[220:223], v25 offset:14336
v_mov_b32 v78, v76
v_mfma_f32_16x16x32_bf16 a[76:79], v[168:171], v[140:143], a[76:79]
v_mov_b32 v79, v77
v_permlane16_swap_b32 v76, v78
v_mfma_f32_16x16x32_bf16 a[80:83], v[168:171], v[144:147], a[80:83]
ds_read_b64_tr_b16 v[228:229], v21 offset:8192
v_permlane16_swap_b32 v77, v79
v_mfma_f32_16x16x32_bf16 a[84:87], v[168:171], v[148:151], a[84:87]
v_add_f32 v76, v76, v78
v_add_f32 v77, v77, v79
v_mfma_f32_16x16x32_bf16 a[88:91], v[168:171], v[152:155], a[88:91]
ds_read_b64_tr_b16 v[230:231], v21 offset:9216
v_mov_b32 v78, v76
v_mfma_f32_16x16x32_bf16 a[92:95], v[168:171], v[156:159], a[92:95]
v_mov_b32 v79, v77
v_permlane32_swap_b32 v76, v78
v_mfma_f32_16x16x32_bf16 a[124:127], v[172:175], v[156:159], a[124:127]
ds_read_b64_tr_b16 v[232:233], v22 offset:8192
v_permlane32_swap_b32 v77, v79
v_mfma_f32_16x16x32_bf16 a[120:123], v[172:175], v[152:155], a[120:123]
v_add_f32 v76, v76, v78
v_add_f32 v77, v77, v79
v_mfma_f32_16x16x32_bf16 a[116:119], v[172:175], v[148:151], a[116:119]
ds_read_b64_tr_b16 v[234:235], v22 offset:9216
v_mul_f32 v76, 0xbfb8aa3b, v76
v_mfma_f32_16x16x32_bf16 a[112:115], v[172:175], v[144:147], a[112:115]
v_mul_f32 v77, 0xbfb8aa3b, v77
v_mfma_f32_16x16x32_bf16 a[108:111], v[172:175], v[140:143], a[108:111]
ds_read_b64_tr_b16 v[236:237], v23 offset:8192
v_mfma_f32_16x16x32_bf16 a[104:107], v[172:175], v[136:139], a[104:107]
v_exp_f32 v76, v76
v_mfma_f32_16x16x32_bf16 a[100:103], v[172:175], v[132:135], a[100:103]
ds_read_b64_tr_b16 v[238:239], v23 offset:9216
v_mfma_f32_16x16x32_bf16 a[96:99], v[172:175], v[128:131], a[96:99]
v_exp_f32 v77, v77
v_mfma_f32_16x16x32_bf16 a[128:131], v[128:131], v[176:179], a[128:131]
ds_read_b64_tr_b16 v[240:241], v20 offset:24576
v_add_f32 v76, 1.0, v76
v_mfma_f32_16x16x32_bf16 a[132:135], v[132:135], v[176:179], a[132:135]
v_add_f32 v77, 1.0, v77
v_mfma_f32_16x16x32_bf16 a[136:139], v[136:139], v[176:179], a[136:139]
ds_read_b64_tr_b16 v[242:243], v20 offset:25600
v_mfma_f32_16x16x32_bf16 a[140:143], v[140:143], v[176:179], a[140:143]
v_rcp_f32 v76, v76
v_mfma_f32_16x16x32_bf16 a[144:147], v[144:147], v[176:179], a[144:147]
ds_read_b64_tr_b16 v[244:245], v21 offset:24576
v_mfma_f32_16x16x32_bf16 a[148:151], v[148:151], v[176:179], a[148:151]
v_rcp_f32 v77, v77
v_mfma_f32_16x16x32_bf16 a[152:155], v[152:155], v[176:179], a[152:155]
s_lshr_b32 s80, s76, 9
ds_read_b64_tr_b16 v[246:247], v21 offset:25600
v_mfma_f32_16x16x32_bf16 a[156:159], v[156:159], v[176:179], a[156:159]
s_add_u32 s80, s80, 0x3800000
v_min_u32 v78, 1, v0
v_lshlrev_b32 v78, 30, v78
v_mfma_f32_16x16x32_bf16 a[188:191], v[156:159], v[180:183], a[188:191]
ds_read_b64_tr_b16 v[248:249], v22 offset:24576
v_mfma_f32_16x16x32_bf16 a[184:187], v[152:155], v[180:183], a[184:187]
buffer_store_dwordx2 v[76:77], v78, s[44:47], s80 offen sc1
v_mfma_f32_16x16x32_bf16 a[180:183], v[148:151], v[180:183], a[180:183]
ds_read_b64_tr_b16 v[250:251], v22 offset:25600
v_mfma_f32_16x16x32_bf16 a[176:179], v[144:147], v[180:183], a[176:179]
v_mfma_f32_16x16x32_bf16 a[172:175], v[140:143], v[180:183], a[172:175]
ds_read_b64_tr_b16 v[252:253], v23 offset:24576
v_mfma_f32_16x16x32_bf16 a[168:171], v[136:139], v[180:183], a[168:171]
v_mfma_f32_16x16x32_bf16 a[164:167], v[132:135], v[180:183], a[164:167]
ds_read_b64_tr_b16 v[254:255], v23 offset:25600
v_mfma_f32_16x16x32_bf16 a[160:163], v[128:131], v[180:183], a[160:163]
v_mfma_f32_16x16x32_bf16 a[192:195], v[128:131], v[184:187], a[192:195]
v_mfma_f32_16x16x32_bf16 a[196:199], v[132:135], v[184:187], a[196:199]
v_mfma_f32_16x16x32_bf16 a[200:203], v[136:139], v[184:187], a[200:203]
v_mfma_f32_16x16x32_bf16 a[204:207], v[140:143], v[184:187], a[204:207]
v_mfma_f32_16x16x32_bf16 a[208:211], v[144:147], v[184:187], a[208:211]
v_mfma_f32_16x16x32_bf16 a[212:215], v[148:151], v[184:187], a[212:215]
v_mfma_f32_16x16x32_bf16 a[216:219], v[152:155], v[184:187], a[216:219]
v_mfma_f32_16x16x32_bf16 a[220:223], v[156:159], v[184:187], a[220:223]
v_mfma_f32_16x16x32_bf16 a[252:255], v[156:159], v[188:191], a[252:255]
v_mfma_f32_16x16x32_bf16 a[248:251], v[152:155], v[188:191], a[248:251]
v_mfma_f32_16x16x32_bf16 a[244:247], v[148:151], v[188:191], a[244:247]
v_mfma_f32_16x16x32_bf16 a[240:243], v[144:147], v[188:191], a[240:243]
v_mfma_f32_16x16x32_bf16 a[236:239], v[140:143], v[188:191], a[236:239]
v_mfma_f32_16x16x32_bf16 a[232:235], v[136:139], v[188:191], a[232:235]
v_mfma_f32_16x16x32_bf16 a[228:231], v[132:135], v[188:191], a[228:231]
s_waitcnt vmcnt(1) lgkmcnt(0)
v_mfma_f32_16x16x32_bf16 a[224:227], v[128:131], v[188:191], a[224:227]
s_barrier
v_mfma_f32_16x16x32_bf16 a[0:3], v[224:227], v[192:195], a[0:3]
s_add_u32 s73, s61, 6
ds_read_b64_tr_b16 v[160:161], v20 offset:32768
v_mfma_f32_16x16x32_bf16 a[4:7], v[224:227], v[196:199], a[4:7]
s_and_b32 s73, s73, 7
v_mfma_f32_16x16x32_bf16 a[8:11], v[224:227], v[200:203], a[8:11]
s_lshl_b32 s69, s73, 7
ds_read_b64_tr_b16 v[162:163], v20 offset:33792
v_mfma_f32_16x16x32_bf16 a[12:15], v[224:227], v[204:207], a[12:15]
s_add_u32 s69, s69, s65
v_mfma_f32_16x16x32_bf16 a[16:19], v[224:227], v[208:211], a[16:19]
s_lshl_b32 s71, s73, 19
ds_read_b128 v[128:131], v24 offset:32768
v_mfma_f32_16x16x32_bf16 a[20:23], v[224:227], v[212:215], a[20:23]
s_add_u32 s71, s71, s66
v_mfma_f32_16x16x32_bf16 a[24:27], v[224:227], v[216:219], a[24:27]
s_add_u32 m0, s63, 65536
ds_read_b128 v[132:135], v24 offset:34816
v_mfma_f32_16x16x32_bf16 a[28:31], v[224:227], v[220:223], a[28:31]
s_add_u32 s72, s69, 0
buffer_load_dwordx4 v2, s[8:11], s72 offen lds
v_mfma_f32_16x16x32_bf16 a[60:63], v[228:231], v[220:223], a[60:63]
s_add_u32 s72, s69, 7168
ds_read_b128 v[136:139], v24 offset:36864
v_mfma_f32_16x16x32_bf16 a[56:59], v[228:231], v[216:219], a[56:59]
buffer_load_dwordx4 v3, s[8:11], s72 offen offset:1024 lds
v_mfma_f32_16x16x32_bf16 a[52:55], v[228:231], v[212:215], a[52:55]
s_add_u32 s72, s69, 14336
ds_read_b128 v[140:143], v24 offset:38912
v_mfma_f32_16x16x32_bf16 a[48:51], v[228:231], v[208:211], a[48:51]
buffer_load_dwordx4 v2, s[8:11], s72 offen offset:2048 lds
v_mfma_f32_16x16x32_bf16 a[44:47], v[228:231], v[204:207], a[44:47]
ds_read_b128 v[144:147], v24 offset:40960
v_mfma_f32_16x16x32_bf16 a[40:43], v[228:231], v[200:203], a[40:43]
v_mfma_f32_16x16x32_bf16 a[36:39], v[228:231], v[196:199], a[36:39]
s_add_u32 s72, s69, 21504
ds_read_b128 v[148:151], v24 offset:43008
v_mfma_f32_16x16x32_bf16 a[32:35], v[228:231], v[192:195], a[32:35]
buffer_load_dwordx4 v3, s[8:11], s72 offen offset:3072 lds
v_mfma_f32_16x16x32_bf16 a[64:67], v[232:235], v[192:195], a[64:67]
ds_read_b128 v[152:155], v24 offset:45056
v_mfma_f32_16x16x32_bf16 a[68:71], v[232:235], v[196:199], a[68:71]
v_mfma_f32_16x16x32_bf16 a[72:75], v[232:235], v[200:203], a[72:75]
ds_read_b128 v[156:159], v24 offset:47104
v_mfma_f32_16x16x32_bf16 a[76:79], v[232:235], v[204:207], a[76:79]
s_add_u32 m0, s64, 0
v_mfma_f32_16x16x32_bf16 a[80:83], v[232:235], v[208:211], a[80:83]
s_add_u32 s72, s71, 0
ds_read_b64_tr_b16 v[164:165], v21 offset:32768
v_mfma_f32_16x16x32_bf16 a[84:87], v[232:235], v[212:215], a[84:87]
buffer_load_dwordx4 v6, s[16:19], s72 offen lds
v_mfma_f32_16x16x32_bf16 a[88:91], v[232:235], v[216:219], a[88:91]
ds_read_b64_tr_b16 v[166:167], v21 offset:33792
v_mfma_f32_16x16x32_bf16 a[92:95], v[232:235], v[220:223], a[92:95]
v_mfma_f32_16x16x32_bf16 a[124:127], v[236:239], v[220:223], a[124:127]
s_add_u32 s72, s71, 31744
ds_read_b64_tr_b16 v[168:169], v22 offset:32768
v_mfma_f32_16x16x32_bf16 a[120:123], v[236:239], v[216:219], a[120:123]
buffer_load_dwordx4 v6, s[16:19], s72 offen offset:1024 lds
v_mfma_f32_16x16x32_bf16 a[116:119], v[236:239], v[212:215], a[116:119]
ds_read_b64_tr_b16 v[170:171], v22 offset:33792
v_mfma_f32_16x16x32_bf16 a[112:115], v[236:239], v[208:211], a[112:115]
v_mfma_f32_16x16x32_bf16 a[108:111], v[236:239], v[204:207], a[108:111]
s_add_u32 s72, s71, 63488
ds_read_b64_tr_b16 v[172:173], v23 offset:32768
v_mfma_f32_16x16x32_bf16 a[104:107], v[236:239], v[200:203], a[104:107]
buffer_load_dwordx4 v7, s[16:19], s72 offen offset:2048 lds
v_mfma_f32_16x16x32_bf16 a[100:103], v[236:239], v[196:199], a[100:103]
ds_read_b64_tr_b16 v[174:175], v23 offset:33792
v_mfma_f32_16x16x32_bf16 a[96:99], v[236:239], v[192:195], a[96:99]
v_mfma_f32_16x16x32_bf16 a[128:131], v[192:195], v[240:243], a[128:131]
ds_read_b64_tr_b16 v[176:177], v20 offset:49152
v_mfma_f32_16x16x32_bf16 a[132:135], v[196:199], v[240:243], a[132:135]
s_add_u32 s72, s71, 95232
buffer_load_dwordx4 v7, s[16:19], s72 offen offset:3072 lds
v_mfma_f32_16x16x32_bf16 a[136:139], v[200:203], v[240:243], a[136:139]
ds_read_b64_tr_b16 v[178:179], v20 offset:50176
v_mfma_f32_16x16x32_bf16 a[140:143], v[204:207], v[240:243], a[140:143]
v_mfma_f32_16x16x32_bf16 a[144:147], v[208:211], v[240:243], a[144:147]
ds_read_b64_tr_b16 v[180:181], v21 offset:49152
v_mfma_f32_16x16x32_bf16 a[148:151], v[212:215], v[240:243], a[148:151]
v_mfma_f32_16x16x32_bf16 a[152:155], v[216:219], v[240:243], a[152:155]
s_add_u32 m0, s63, 69632
ds_read_b64_tr_b16 v[182:183], v21 offset:50176
v_mfma_f32_16x16x32_bf16 a[156:159], v[220:223], v[240:243], a[156:159]
s_add_u32 s72, s69, 32768
buffer_load_dwordx4 v2, s[8:11], s72 offen lds
v_mfma_f32_16x16x32_bf16 a[188:191], v[220:223], v[244:247], a[188:191]
ds_read_b64_tr_b16 v[184:185], v22 offset:49152
v_mfma_f32_16x16x32_bf16 a[184:187], v[216:219], v[244:247], a[184:187]
v_mfma_f32_16x16x32_bf16 a[180:183], v[212:215], v[244:247], a[180:183]
ds_read_b64_tr_b16 v[186:187], v22 offset:50176
v_mfma_f32_16x16x32_bf16 a[176:179], v[208:211], v[244:247], a[176:179]
s_add_u32 s72, s69, 39936
buffer_load_dwordx4 v3, s[8:11], s72 offen offset:1024 lds
v_mfma_f32_16x16x32_bf16 a[172:175], v[204:207], v[244:247], a[172:175]
ds_read_b64_tr_b16 v[188:189], v23 offset:49152
v_mfma_f32_16x16x32_bf16 a[168:171], v[200:203], v[244:247], a[168:171]
v_mfma_f32_16x16x32_bf16 a[164:167], v[196:199], v[244:247], a[164:167]
ds_read_b64_tr_b16 v[190:191], v23 offset:50176
v_mfma_f32_16x16x32_bf16 a[160:163], v[192:195], v[244:247], a[160:163]
v_mfma_f32_16x16x32_bf16 a[192:195], v[192:195], v[248:251], a[192:195]
s_add_u32 s72, s69, 47104
buffer_load_dwordx4 v2, s[8:11], s72 offen offset:2048 lds
v_mfma_f32_16x16x32_bf16 a[196:199], v[196:199], v[248:251], a[196:199]
v_mfma_f32_16x16x32_bf16 a[200:203], v[200:203], v[248:251], a[200:203]
v_mfma_f32_16x16x32_bf16 a[204:207], v[204:207], v[248:251], a[204:207]
v_mfma_f32_16x16x32_bf16 a[208:211], v[208:211], v[248:251], a[208:211]
s_add_u32 s72, s69, 54272
buffer_load_dwordx4 v3, s[8:11], s72 offen offset:3072 lds
v_mfma_f32_16x16x32_bf16 a[212:215], v[212:215], v[248:251], a[212:215]
v_mfma_f32_16x16x32_bf16 a[216:219], v[216:219], v[248:251], a[216:219]
v_mfma_f32_16x16x32_bf16 a[220:223], v[220:223], v[248:251], a[220:223]
v_mfma_f32_16x16x32_bf16 a[252:255], v[220:223], v[252:255], a[252:255]
v_mfma_f32_16x16x32_bf16 a[248:251], v[216:219], v[252:255], a[248:251]
s_add_u32 m0, s64, 16384
v_mfma_f32_16x16x32_bf16 a[244:247], v[212:215], v[252:255], a[244:247]
s_add_u32 s72, s71, 0
buffer_load_dwordx4 v6, s[20:23], s72 offen lds
v_mfma_f32_16x16x32_bf16 a[240:243], v[208:211], v[252:255], a[240:243]
v_mfma_f32_16x16x32_bf16 a[236:239], v[204:207], v[252:255], a[236:239]
v_mfma_f32_16x16x32_bf16 a[232:235], v[200:203], v[252:255], a[232:235]
v_mfma_f32_16x16x32_bf16 a[228:231], v[196:199], v[252:255], a[228:231]
s_add_u32 s72, s71, 31744
buffer_load_dwordx4 v6, s[20:23], s72 offen offset:1024 lds
v_mfma_f32_16x16x32_bf16 a[224:227], v[192:195], v[252:255], a[224:227]
s_waitcnt lgkmcnt(0)
v_mfma_f32_16x16x32_bf16 a[0:3], v[160:163], v[128:131], a[0:3]
ds_read_b64_tr_b16 v[224:225], v20 offset:40960
v_mfma_f32_16x16x32_bf16 a[4:7], v[160:163], v[132:135], a[4:7]
v_mfma_f32_16x16x32_bf16 a[8:11], v[160:163], v[136:139], a[8:11]
ds_read_b64_tr_b16 v[226:227], v20 offset:41984
v_mfma_f32_16x16x32_bf16 a[12:15], v[160:163], v[140:143], a[12:15]
s_add_u32 s72, s71, 63488
buffer_load_dwordx4 v7, s[20:23], s72 offen offset:2048 lds
v_mfma_f32_16x16x32_bf16 a[16:19], v[160:163], v[144:147], a[16:19]
ds_read_b128 v[192:195], v25 offset:32768
v_mfma_f32_16x16x32_bf16 a[20:23], v[160:163], v[148:151], a[20:23]
v_mfma_f32_16x16x32_bf16 a[24:27], v[160:163], v[152:155], a[24:27]
ds_read_b128 v[196:199], v25 offset:34816
v_mfma_f32_16x16x32_bf16 a[28:31], v[160:163], v[156:159], a[28:31]
v_mfma_f32_16x16x32_bf16 a[60:63], v[164:167], v[156:159], a[60:63]
s_add_u32 s72, s71, 95232
ds_read_b128 v[200:203], v25 offset:36864
v_mfma_f32_16x16x32_bf16 a[56:59], v[164:167], v[152:155], a[56:59]
buffer_load_dwordx4 v7, s[20:23], s72 offen offset:3072 lds
v_mfma_f32_16x16x32_bf16 a[52:55], v[164:167], v[148:151], a[52:55]
ds_read_b128 v[204:207], v25 offset:38912
v_mfma_f32_16x16x32_bf16 a[48:51], v[164:167], v[144:147], a[48:51]
v_mfma_f32_16x16x32_bf16 a[44:47], v[164:167], v[140:143], a[44:47]
ds_read_b128 v[208:211], v25 offset:40960
v_mfma_f32_16x16x32_bf16 a[40:43], v[164:167], v[136:139], a[40:43]
v_mfma_f32_16x16x32_bf16 a[36:39], v[164:167], v[132:135], a[36:39]
ds_read_b128 v[212:215], v25 offset:43008
v_mfma_f32_16x16x32_bf16 a[32:35], v[164:167], v[128:131], a[32:35]
v_mfma_f32_16x16x32_bf16 a[64:67], v[168:171], v[128:131], a[64:67]
ds_read_b128 v[216:219], v25 offset:45056
v_mfma_f32_16x16x32_bf16 a[68:71], v[168:171], v[132:135], a[68:71]
v_mfma_f32_16x16x32_bf16 a[72:75], v[168:171], v[136:139], a[72:75]
ds_read_b128 v[220:223], v25 offset:47104
v_mfma_f32_16x16x32_bf16 a[76:79], v[168:171], v[140:143], a[76:79]
v_mfma_f32_16x16x32_bf16 a[80:83], v[168:171], v[144:147], a[80:83]
ds_read_b64_tr_b16 v[228:229], v21 offset:40960
v_mfma_f32_16x16x32_bf16 a[84:87], v[168:171], v[148:151], a[84:87]
v_mfma_f32_16x16x32_bf16 a[88:91], v[168:171], v[152:155], a[88:91]
ds_read_b64_tr_b16 v[230:231], v21 offset:41984
v_mfma_f32_16x16x32_bf16 a[92:95], v[168:171], v[156:159], a[92:95]
v_mfma_f32_16x16x32_bf16 a[124:127], v[172:175], v[156:159], a[124:127]
ds_read_b64_tr_b16 v[232:233], v22 offset:40960
v_mfma_f32_16x16x32_bf16 a[120:123], v[172:175], v[152:155], a[120:123]
v_mfma_f32_16x16x32_bf16 a[116:119], v[172:175], v[148:151], a[116:119]
ds_read_b64_tr_b16 v[234:235], v22 offset:41984
v_mfma_f32_16x16x32_bf16 a[112:115], v[172:175], v[144:147], a[112:115]
v_mfma_f32_16x16x32_bf16 a[108:111], v[172:175], v[140:143], a[108:111]
ds_read_b64_tr_b16 v[236:237], v23 offset:40960
v_mfma_f32_16x16x32_bf16 a[104:107], v[172:175], v[136:139], a[104:107]
v_mfma_f32_16x16x32_bf16 a[100:103], v[172:175], v[132:135], a[100:103]
ds_read_b64_tr_b16 v[238:239], v23 offset:41984
v_mfma_f32_16x16x32_bf16 a[96:99], v[172:175], v[128:131], a[96:99]
v_mfma_f32_16x16x32_bf16 a[128:131], v[128:131], v[176:179], a[128:131]
ds_read_b64_tr_b16 v[240:241], v20 offset:57344
v_mfma_f32_16x16x32_bf16 a[132:135], v[132:135], v[176:179], a[132:135]
v_mfma_f32_16x16x32_bf16 a[136:139], v[136:139], v[176:179], a[136:139]
ds_read_b64_tr_b16 v[242:243], v20 offset:58368
v_mfma_f32_16x16x32_bf16 a[140:143], v[140:143], v[176:179], a[140:143]
v_mfma_f32_16x16x32_bf16 a[144:147], v[144:147], v[176:179], a[144:147]
ds_read_b64_tr_b16 v[244:245], v21 offset:57344
v_mfma_f32_16x16x32_bf16 a[148:151], v[148:151], v[176:179], a[148:151]
v_mfma_f32_16x16x32_bf16 a[152:155], v[152:155], v[176:179], a[152:155]
ds_read_b64_tr_b16 v[246:247], v21 offset:58368
v_mfma_f32_16x16x32_bf16 a[156:159], v[156:159], v[176:179], a[156:159]
v_mfma_f32_16x16x32_bf16 a[188:191], v[156:159], v[180:183], a[188:191]
ds_read_b64_tr_b16 v[248:249], v22 offset:57344
v_mfma_f32_16x16x32_bf16 a[184:187], v[152:155], v[180:183], a[184:187]
v_mfma_f32_16x16x32_bf16 a[180:183], v[148:151], v[180:183], a[180:183]
ds_read_b64_tr_b16 v[250:251], v22 offset:58368
v_mfma_f32_16x16x32_bf16 a[176:179], v[144:147], v[180:183], a[176:179]
v_mfma_f32_16x16x32_bf16 a[172:175], v[140:143], v[180:183], a[172:175]
ds_read_b64_tr_b16 v[252:253], v23 offset:57344
v_mfma_f32_16x16x32_bf16 a[168:171], v[136:139], v[180:183], a[168:171]
v_mfma_f32_16x16x32_bf16 a[164:167], v[132:135], v[180:183], a[164:167]
ds_read_b64_tr_b16 v[254:255], v23 offset:58368
v_mfma_f32_16x16x32_bf16 a[160:163], v[128:131], v[180:183], a[160:163]
v_mfma_f32_16x16x32_bf16 a[192:195], v[128:131], v[184:187], a[192:195]
v_mfma_f32_16x16x32_bf16 a[196:199], v[132:135], v[184:187], a[196:199]
v_mfma_f32_16x16x32_bf16 a[200:203], v[136:139], v[184:187], a[200:203]
v_mfma_f32_16x16x32_bf16 a[204:207], v[140:143], v[184:187], a[204:207]
v_mfma_f32_16x16x32_bf16 a[208:211], v[144:147], v[184:187], a[208:211]
v_mfma_f32_16x16x32_bf16 a[212:215], v[148:151], v[184:187], a[212:215]
v_mfma_f32_16x16x32_bf16 a[216:219], v[152:155], v[184:187], a[216:219]
v_mfma_f32_16x16x32_bf16 a[220:223], v[156:159], v[184:187], a[220:223]
v_mfma_f32_16x16x32_bf16 a[252:255], v[156:159], v[188:191], a[252:255]
v_mfma_f32_16x16x32_bf16 a[248:251], v[152:155], v[188:191], a[248:251]
v_mfma_f32_16x16x32_bf16 a[244:247], v[148:151], v[188:191], a[244:247]
v_mfma_f32_16x16x32_bf16 a[240:243], v[144:147], v[188:191], a[240:243]
v_mfma_f32_16x16x32_bf16 a[236:239], v[140:143], v[188:191], a[236:239]
v_mfma_f32_16x16x32_bf16 a[232:235], v[136:139], v[188:191], a[232:235]
v_mfma_f32_16x16x32_bf16 a[228:231], v[132:135], v[188:191], a[228:231]
s_waitcnt vmcnt(0) lgkmcnt(0)
v_mfma_f32_16x16x32_bf16 a[224:227], v[128:131], v[188:191], a[224:227]
s_barrier
v_mfma_f32_16x16x32_bf16 a[0:3], v[224:227], v[192:195], a[0:3]
s_add_u32 s73, s61, 7
ds_read_b64_tr_b16 v[160:161], v20 offset:0
v_mfma_f32_16x16x32_bf16 a[4:7], v[224:227], v[196:199], a[4:7]
s_and_b32 s73, s73, 7
v_mfma_f32_16x16x32_bf16 a[8:11], v[224:227], v[200:203], a[8:11]
s_lshl_b32 s69, s73, 7
ds_read_b64_tr_b16 v[162:163], v20 offset:1024
v_mfma_f32_16x16x32_bf16 a[12:15], v[224:227], v[204:207], a[12:15]
s_add_u32 s69, s69, s65
v_mfma_f32_16x16x32_bf16 a[16:19], v[224:227], v[208:211], a[16:19]
s_lshl_b32 s71, s73, 19
ds_read_b128 v[128:131], v24 offset:0
v_mfma_f32_16x16x32_bf16 a[20:23], v[224:227], v[212:215], a[20:23]
s_add_u32 s71, s71, s66
v_mfma_f32_16x16x32_bf16 a[24:27], v[224:227], v[216:219], a[24:27]
s_add_u32 m0, s63, 98304
ds_read_b128 v[132:135], v24 offset:2048
v_mfma_f32_16x16x32_bf16 a[28:31], v[224:227], v[220:223], a[28:31]
s_add_u32 s72, s69, 0
buffer_load_dwordx4 v2, s[8:11], s72 offen lds
v_mfma_f32_16x16x32_bf16 a[60:63], v[228:231], v[220:223], a[60:63]
s_add_u32 s72, s69, 7168
ds_read_b128 v[136:139], v24 offset:4096
v_mfma_f32_16x16x32_bf16 a[56:59], v[228:231], v[216:219], a[56:59]
buffer_load_dwordx4 v3, s[8:11], s72 offen offset:1024 lds
v_mfma_f32_16x16x32_bf16 a[52:55], v[228:231], v[212:215], a[52:55]
s_add_u32 s72, s69, 14336
ds_read_b128 v[140:143], v24 offset:6144
v_mfma_f32_16x16x32_bf16 a[48:51], v[228:231], v[208:211], a[48:51]
buffer_load_dwordx4 v2, s[8:11], s72 offen offset:2048 lds
v_mfma_f32_16x16x32_bf16 a[44:47], v[228:231], v[204:207], a[44:47]
ds_read_b128 v[144:147], v24 offset:8192
v_mfma_f32_16x16x32_bf16 a[40:43], v[228:231], v[200:203], a[40:43]
v_mfma_f32_16x16x32_bf16 a[36:39], v[228:231], v[196:199], a[36:39]
s_add_u32 s72, s69, 21504
ds_read_b128 v[148:151], v24 offset:10240
v_mfma_f32_16x16x32_bf16 a[32:35], v[228:231], v[192:195], a[32:35]
buffer_load_dwordx4 v3, s[8:11], s72 offen offset:3072 lds
v_mfma_f32_16x16x32_bf16 a[64:67], v[232:235], v[192:195], a[64:67]
ds_read_b128 v[152:155], v24 offset:12288
v_mfma_f32_16x16x32_bf16 a[68:71], v[232:235], v[196:199], a[68:71]
v_mfma_f32_16x16x32_bf16 a[72:75], v[232:235], v[200:203], a[72:75]
ds_read_b128 v[156:159], v24 offset:14336
v_mfma_f32_16x16x32_bf16 a[76:79], v[232:235], v[204:207], a[76:79]
s_add_u32 m0, s64, 32768
v_mfma_f32_16x16x32_bf16 a[80:83], v[232:235], v[208:211], a[80:83]
s_add_u32 s72, s71, 0
ds_read_b64_tr_b16 v[164:165], v21 offset:0
v_mfma_f32_16x16x32_bf16 a[84:87], v[232:235], v[212:215], a[84:87]
buffer_load_dwordx4 v6, s[16:19], s72 offen lds
v_mfma_f32_16x16x32_bf16 a[88:91], v[232:235], v[216:219], a[88:91]
ds_read_b64_tr_b16 v[166:167], v21 offset:1024
v_mfma_f32_16x16x32_bf16 a[92:95], v[232:235], v[220:223], a[92:95]
v_mfma_f32_16x16x32_bf16 a[124:127], v[236:239], v[220:223], a[124:127]
s_add_u32 s72, s71, 31744
ds_read_b64_tr_b16 v[168:169], v22 offset:0
v_mfma_f32_16x16x32_bf16 a[120:123], v[236:239], v[216:219], a[120:123]
buffer_load_dwordx4 v6, s[16:19], s72 offen offset:1024 lds
v_mfma_f32_16x16x32_bf16 a[116:119], v[236:239], v[212:215], a[116:119]
ds_read_b64_tr_b16 v[170:171], v22 offset:1024
v_mfma_f32_16x16x32_bf16 a[112:115], v[236:239], v[208:211], a[112:115]
v_mfma_f32_16x16x32_bf16 a[108:111], v[236:239], v[204:207], a[108:111]
s_add_u32 s72, s71, 63488
ds_read_b64_tr_b16 v[172:173], v23 offset:0
v_mfma_f32_16x16x32_bf16 a[104:107], v[236:239], v[200:203], a[104:107]
buffer_load_dwordx4 v7, s[16:19], s72 offen offset:2048 lds
v_mfma_f32_16x16x32_bf16 a[100:103], v[236:239], v[196:199], a[100:103]
ds_read_b64_tr_b16 v[174:175], v23 offset:1024
v_mfma_f32_16x16x32_bf16 a[96:99], v[236:239], v[192:195], a[96:99]
v_mfma_f32_16x16x32_bf16 a[128:131], v[192:195], v[240:243], a[128:131]
ds_read_b64_tr_b16 v[176:177], v20 offset:16384
v_mfma_f32_16x16x32_bf16 a[132:135], v[196:199], v[240:243], a[132:135]
s_add_u32 s72, s71, 95232
buffer_load_dwordx4 v7, s[16:19], s72 offen offset:3072 lds
v_mfma_f32_16x16x32_bf16 a[136:139], v[200:203], v[240:243], a[136:139]
ds_read_b64_tr_b16 v[178:179], v20 offset:17408
v_mfma_f32_16x16x32_bf16 a[140:143], v[204:207], v[240:243], a[140:143]
v_mfma_f32_16x16x32_bf16 a[144:147], v[208:211], v[240:243], a[144:147]
ds_read_b64_tr_b16 v[180:181], v21 offset:16384
v_mfma_f32_16x16x32_bf16 a[148:151], v[212:215], v[240:243], a[148:151]
v_mfma_f32_16x16x32_bf16 a[152:155], v[216:219], v[240:243], a[152:155]
s_add_u32 m0, s63, 102400
ds_read_b64_tr_b16 v[182:183], v21 offset:17408
v_mfma_f32_16x16x32_bf16 a[156:159], v[220:223], v[240:243], a[156:159]
s_add_u32 s72, s69, 32768
buffer_load_dwordx4 v2, s[8:11], s72 offen lds
v_mfma_f32_16x16x32_bf16 a[188:191], v[220:223], v[244:247], a[188:191]
ds_read_b64_tr_b16 v[184:185], v22 offset:16384
v_mfma_f32_16x16x32_bf16 a[184:187], v[216:219], v[244:247], a[184:187]
v_mfma_f32_16x16x32_bf16 a[180:183], v[212:215], v[244:247], a[180:183]
ds_read_b64_tr_b16 v[186:187], v22 offset:17408
v_mfma_f32_16x16x32_bf16 a[176:179], v[208:211], v[244:247], a[176:179]
s_add_u32 s72, s69, 39936
buffer_load_dwordx4 v3, s[8:11], s72 offen offset:1024 lds
v_mfma_f32_16x16x32_bf16 a[172:175], v[204:207], v[244:247], a[172:175]
ds_read_b64_tr_b16 v[188:189], v23 offset:16384
v_mfma_f32_16x16x32_bf16 a[168:171], v[200:203], v[244:247], a[168:171]
v_mfma_f32_16x16x32_bf16 a[164:167], v[196:199], v[244:247], a[164:167]
ds_read_b64_tr_b16 v[190:191], v23 offset:17408
v_mfma_f32_16x16x32_bf16 a[160:163], v[192:195], v[244:247], a[160:163]
v_mfma_f32_16x16x32_bf16 a[192:195], v[192:195], v[248:251], a[192:195]
s_add_u32 s72, s69, 47104
buffer_load_dwordx4 v2, s[8:11], s72 offen offset:2048 lds
v_mfma_f32_16x16x32_bf16 a[196:199], v[196:199], v[248:251], a[196:199]
v_mfma_f32_16x16x32_bf16 a[200:203], v[200:203], v[248:251], a[200:203]
v_mfma_f32_16x16x32_bf16 a[204:207], v[204:207], v[248:251], a[204:207]
v_mfma_f32_16x16x32_bf16 a[208:211], v[208:211], v[248:251], a[208:211]
s_add_u32 s72, s69, 54272
buffer_load_dwordx4 v3, s[8:11], s72 offen offset:3072 lds
v_mfma_f32_16x16x32_bf16 a[212:215], v[212:215], v[248:251], a[212:215]
v_mfma_f32_16x16x32_bf16 a[216:219], v[216:219], v[248:251], a[216:219]
v_mfma_f32_16x16x32_bf16 a[220:223], v[220:223], v[248:251], a[220:223]
v_mfma_f32_16x16x32_bf16 a[252:255], v[220:223], v[252:255], a[252:255]
v_mfma_f32_16x16x32_bf16 a[248:251], v[216:219], v[252:255], a[248:251]
s_add_u32 m0, s64, 49152
v_mfma_f32_16x16x32_bf16 a[244:247], v[212:215], v[252:255], a[244:247]
s_add_u32 s72, s71, 0
buffer_load_dwordx4 v6, s[20:23], s72 offen lds
v_mfma_f32_16x16x32_bf16 a[240:243], v[208:211], v[252:255], a[240:243]
v_mfma_f32_16x16x32_bf16 a[236:239], v[204:207], v[252:255], a[236:239]
v_mfma_f32_16x16x32_bf16 a[232:235], v[200:203], v[252:255], a[232:235]
v_mfma_f32_16x16x32_bf16 a[228:231], v[196:199], v[252:255], a[228:231]
s_add_u32 s72, s71, 31744
buffer_load_dwordx4 v6, s[20:23], s72 offen offset:1024 lds
v_mfma_f32_16x16x32_bf16 a[224:227], v[192:195], v[252:255], a[224:227]
s_waitcnt lgkmcnt(0)
v_mfma_f32_16x16x32_bf16 a[0:3], v[160:163], v[128:131], a[0:3]
ds_read_b64_tr_b16 v[224:225], v20 offset:8192
v_mfma_f32_16x16x32_bf16 a[4:7], v[160:163], v[132:135], a[4:7]
v_mfma_f32_16x16x32_bf16 a[8:11], v[160:163], v[136:139], a[8:11]
ds_read_b64_tr_b16 v[226:227], v20 offset:9216
v_mfma_f32_16x16x32_bf16 a[12:15], v[160:163], v[140:143], a[12:15]
s_add_u32 s72, s71, 63488
buffer_load_dwordx4 v7, s[20:23], s72 offen offset:2048 lds
v_mfma_f32_16x16x32_bf16 a[16:19], v[160:163], v[144:147], a[16:19]
ds_read_b128 v[192:195], v25 offset:0
v_mfma_f32_16x16x32_bf16 a[20:23], v[160:163], v[148:151], a[20:23]
v_mfma_f32_16x16x32_bf16 a[24:27], v[160:163], v[152:155], a[24:27]
ds_read_b128 v[196:199], v25 offset:2048
v_mfma_f32_16x16x32_bf16 a[28:31], v[160:163], v[156:159], a[28:31]
v_mfma_f32_16x16x32_bf16 a[60:63], v[164:167], v[156:159], a[60:63]
s_add_u32 s72, s71, 95232
ds_read_b128 v[200:203], v25 offset:4096
v_mfma_f32_16x16x32_bf16 a[56:59], v[164:167], v[152:155], a[56:59]
buffer_load_dwordx4 v7, s[20:23], s72 offen offset:3072 lds
v_mfma_f32_16x16x32_bf16 a[52:55], v[164:167], v[148:151], a[52:55]
ds_read_b128 v[204:207], v25 offset:6144
v_mfma_f32_16x16x32_bf16 a[48:51], v[164:167], v[144:147], a[48:51]
v_mfma_f32_16x16x32_bf16 a[44:47], v[164:167], v[140:143], a[44:47]
ds_read_b128 v[208:211], v25 offset:8192
v_mfma_f32_16x16x32_bf16 a[40:43], v[164:167], v[136:139], a[40:43]
v_mfma_f32_16x16x32_bf16 a[36:39], v[164:167], v[132:135], a[36:39]
ds_read_b128 v[212:215], v25 offset:10240
v_mfma_f32_16x16x32_bf16 a[32:35], v[164:167], v[128:131], a[32:35]
v_mfma_f32_16x16x32_bf16 a[64:67], v[168:171], v[128:131], a[64:67]
ds_read_b128 v[216:219], v25 offset:12288
v_mfma_f32_16x16x32_bf16 a[68:71], v[168:171], v[132:135], a[68:71]
v_mfma_f32_16x16x32_bf16 a[72:75], v[168:171], v[136:139], a[72:75]
ds_read_b128 v[220:223], v25 offset:14336
v_mfma_f32_16x16x32_bf16 a[76:79], v[168:171], v[140:143], a[76:79]
v_mfma_f32_16x16x32_bf16 a[80:83], v[168:171], v[144:147], a[80:83]
ds_read_b64_tr_b16 v[228:229], v21 offset:8192
v_mfma_f32_16x16x32_bf16 a[84:87], v[168:171], v[148:151], a[84:87]
v_mfma_f32_16x16x32_bf16 a[88:91], v[168:171], v[152:155], a[88:91]
ds_read_b64_tr_b16 v[230:231], v21 offset:9216
v_mfma_f32_16x16x32_bf16 a[92:95], v[168:171], v[156:159], a[92:95]
v_mfma_f32_16x16x32_bf16 a[124:127], v[172:175], v[156:159], a[124:127]
ds_read_b64_tr_b16 v[232:233], v22 offset:8192
v_mfma_f32_16x16x32_bf16 a[120:123], v[172:175], v[152:155], a[120:123]
v_mfma_f32_16x16x32_bf16 a[116:119], v[172:175], v[148:151], a[116:119]
ds_read_b64_tr_b16 v[234:235], v22 offset:9216
v_mfma_f32_16x16x32_bf16 a[112:115], v[172:175], v[144:147], a[112:115]
v_mfma_f32_16x16x32_bf16 a[108:111], v[172:175], v[140:143], a[108:111]
ds_read_b64_tr_b16 v[236:237], v23 offset:8192
v_mfma_f32_16x16x32_bf16 a[104:107], v[172:175], v[136:139], a[104:107]
v_mfma_f32_16x16x32_bf16 a[100:103], v[172:175], v[132:135], a[100:103]
ds_read_b64_tr_b16 v[238:239], v23 offset:9216
v_mfma_f32_16x16x32_bf16 a[96:99], v[172:175], v[128:131], a[96:99]
v_mfma_f32_16x16x32_bf16 a[128:131], v[128:131], v[176:179], a[128:131]
ds_read_b64_tr_b16 v[240:241], v20 offset:24576
v_mfma_f32_16x16x32_bf16 a[132:135], v[132:135], v[176:179], a[132:135]
v_mfma_f32_16x16x32_bf16 a[136:139], v[136:139], v[176:179], a[136:139]
ds_read_b64_tr_b16 v[242:243], v20 offset:25600
v_mfma_f32_16x16x32_bf16 a[140:143], v[140:143], v[176:179], a[140:143]
v_mfma_f32_16x16x32_bf16 a[144:147], v[144:147], v[176:179], a[144:147]
ds_read_b64_tr_b16 v[244:245], v21 offset:24576
v_mfma_f32_16x16x32_bf16 a[148:151], v[148:151], v[176:179], a[148:151]
v_mfma_f32_16x16x32_bf16 a[152:155], v[152:155], v[176:179], a[152:155]
ds_read_b64_tr_b16 v[246:247], v21 offset:25600
v_mfma_f32_16x16x32_bf16 a[156:159], v[156:159], v[176:179], a[156:159]
v_mfma_f32_16x16x32_bf16 a[188:191], v[156:159], v[180:183], a[188:191]
ds_read_b64_tr_b16 v[248:249], v22 offset:24576
v_mfma_f32_16x16x32_bf16 a[184:187], v[152:155], v[180:183], a[184:187]
v_mfma_f32_16x16x32_bf16 a[180:183], v[148:151], v[180:183], a[180:183]
ds_read_b64_tr_b16 v[250:251], v22 offset:25600
v_mfma_f32_16x16x32_bf16 a[176:179], v[144:147], v[180:183], a[176:179]
v_mfma_f32_16x16x32_bf16 a[172:175], v[140:143], v[180:183], a[172:175]
ds_read_b64_tr_b16 v[252:253], v23 offset:24576
v_mfma_f32_16x16x32_bf16 a[168:171], v[136:139], v[180:183], a[168:171]
v_mfma_f32_16x16x32_bf16 a[164:167], v[132:135], v[180:183], a[164:167]
ds_read_b64_tr_b16 v[254:255], v23 offset:25600
v_mfma_f32_16x16x32_bf16 a[160:163], v[128:131], v[180:183], a[160:163]
v_mfma_f32_16x16x32_bf16 a[192:195], v[128:131], v[184:187], a[192:195]
v_mfma_f32_16x16x32_bf16 a[196:199], v[132:135], v[184:187], a[196:199]
v_mfma_f32_16x16x32_bf16 a[200:203], v[136:139], v[184:187], a[200:203]
v_mfma_f32_16x16x32_bf16 a[204:207], v[140:143], v[184:187], a[204:207]
v_mfma_f32_16x16x32_bf16 a[208:211], v[144:147], v[184:187], a[208:211]
v_mfma_f32_16x16x32_bf16 a[212:215], v[148:151], v[184:187], a[212:215]
v_mfma_f32_16x16x32_bf16 a[216:219], v[152:155], v[184:187], a[216:219]
v_mfma_f32_16x16x32_bf16 a[220:223], v[156:159], v[184:187], a[220:223]
v_mfma_f32_16x16x32_bf16 a[252:255], v[156:159], v[188:191], a[252:255]
v_mfma_f32_16x16x32_bf16 a[248:251], v[152:155], v[188:191], a[248:251]
v_mfma_f32_16x16x32_bf16 a[244:247], v[148:151], v[188:191], a[244:247]
v_mfma_f32_16x16x32_bf16 a[240:243], v[144:147], v[188:191], a[240:243]
v_mfma_f32_16x16x32_bf16 a[236:239], v[140:143], v[188:191], a[236:239]
v_mfma_f32_16x16x32_bf16 a[232:235], v[136:139], v[188:191], a[232:235]
v_mfma_f32_16x16x32_bf16 a[228:231], v[132:135], v[188:191], a[228:231]
s_waitcnt vmcnt(0) lgkmcnt(0)
v_mfma_f32_16x16x32_bf16 a[224:227], v[128:131], v[188:191], a[224:227]
s_barrier
v_mfma_f32_16x16x32_bf16 a[0:3], v[224:227], v[192:195], a[0:3]
s_add_u32 s73, s61, 0
ds_read_b64_tr_b16 v[160:161], v20 offset:32768
v_mfma_f32_16x16x32_bf16 a[4:7], v[224:227], v[196:199], a[4:7]
s_and_b32 s73, s73, 7
v_mfma_f32_16x16x32_bf16 a[8:11], v[224:227], v[200:203], a[8:11]
s_lshl_b32 s71, s73, 19
ds_read_b64_tr_b16 v[162:163], v20 offset:33792
v_mfma_f32_16x16x32_bf16 a[12:15], v[224:227], v[204:207], a[12:15]
s_add_u32 s71, s71, s66
v_mfma_f32_16x16x32_bf16 a[16:19], v[224:227], v[208:211], a[16:19]
s_lshl_b32 s73, s73, 7
ds_read_b128 v[128:131], v24 offset:32768
v_mfma_f32_16x16x32_bf16 a[20:23], v[224:227], v[212:215], a[20:23]
s_add_u32 s69, s73, s67
v_mfma_f32_16x16x32_bf16 a[24:27], v[224:227], v[216:219], a[24:27]
s_add_u32 s70, s73, s68
ds_read_b128 v[132:135], v24 offset:34816
v_mfma_f32_16x16x32_bf16 a[28:31], v[224:227], v[220:223], a[28:31]
s_add_u32 m0, s64, 0
v_mfma_f32_16x16x32_bf16 a[60:63], v[228:231], v[220:223], a[60:63]
s_add_u32 s72, s71, 0
ds_read_b128 v[136:139], v24 offset:36864
v_mfma_f32_16x16x32_bf16 a[56:59], v[228:231], v[216:219], a[56:59]
s_lshl_b32 s80, s59, 2
buffer_load_dwordx4 v6, s[12:15], s72 offen lds
v_mfma_f32_16x16x32_bf16 a[52:55], v[228:231], v[212:215], a[52:55]
s_add_u32 s72, s71, 31744
ds_read_b128 v[140:143], v24 offset:38912
v_or_b32 v26, s58, v0
v_mfma_f32_16x16x32_bf16 a[48:51], v[228:231], v[208:211], a[48:51]
buffer_load_dwordx4 v6, s[12:15], s72 offen offset:1024 lds
v_mfma_f32_16x16x32_bf16 a[44:47], v[228:231], v[204:207], a[44:47]
s_add_u32 s72, s71, 63488
ds_read_b128 v[144:147], v24 offset:40960
v_mov_b32 v27, 1
v_mfma_f32_16x16x32_bf16 a[40:43], v[228:231], v[200:203], a[40:43]
buffer_load_dwordx4 v7, s[12:15], s72 offen offset:2048 lds
v_mfma_f32_16x16x32_bf16 a[36:39], v[228:231], v[196:199], a[36:39]
ds_read_b128 v[148:151], v24 offset:43008
v_lshlrev_b32 v26, 8, v26
v_mfma_f32_16x16x32_bf16 a[32:35], v[228:231], v[192:195], a[32:35]
s_add_u32 s72, s71, 95232
buffer_load_dwordx4 v7, s[12:15], s72 offen offset:3072 lds
v_mfma_f32_16x16x32_bf16 a[64:67], v[232:235], v[192:195], a[64:67]
ds_read_b128 v[152:155], v24 offset:45056
v_mfma_f32_16x16x32_bf16 a[68:71], v[232:235], v[196:199], a[68:71]
buffer_atomic_add v27, v26, s[48:51], s80 offen sc1
v_mfma_f32_16x16x32_bf16 a[72:75], v[232:235], v[200:203], a[72:75]
ds_read_b128 v[156:159], v24 offset:47104
v_mfma_f32_16x16x32_bf16 a[76:79], v[232:235], v[204:207], a[76:79]
v_mfma_f32_16x16x32_bf16 a[80:83], v[232:235], v[208:211], a[80:83]
s_add_u32 m0, s63, 131072
ds_read_b64_tr_b16 v[164:165], v21 offset:32768
v_mfma_f32_16x16x32_bf16 a[84:87], v[232:235], v[212:215], a[84:87]
s_add_u32 s72, s69, 0
buffer_load_dwordx4 v4, s[4:7], s72 offen lds
v_mfma_f32_16x16x32_bf16 a[88:91], v[232:235], v[216:219], a[88:91]
ds_read_b64_tr_b16 v[166:167], v21 offset:33792
v_mfma_f32_16x16x32_bf16 a[92:95], v[232:235], v[220:223], a[92:95]
v_mfma_f32_16x16x32_bf16 a[124:127], v[236:239], v[220:223], a[124:127]
ds_read_b64_tr_b16 v[168:169], v22 offset:32768
v_mfma_f32_16x16x32_bf16 a[120:123], v[236:239], v[216:219], a[120:123]
s_add_u32 s72, s69, 15360
buffer_load_dwordx4 v5, s[4:7], s72 offen offset:1024 lds
v_mfma_f32_16x16x32_bf16 a[116:119], v[236:239], v[212:215], a[116:119]
ds_read_b64_tr_b16 v[170:171], v22 offset:33792
v_mfma_f32_16x16x32_bf16 a[112:115], v[236:239], v[208:211], a[112:115]
v_mfma_f32_16x16x32_bf16 a[108:111], v[236:239], v[204:207], a[108:111]
ds_read_b64_tr_b16 v[172:173], v23 offset:32768
v_mfma_f32_16x16x32_bf16 a[104:107], v[236:239], v[200:203], a[104:107]
v_mfma_f32_16x16x32_bf16 a[100:103], v[236:239], v[196:199], a[100:103]
s_add_u32 s72, s69, 30720
ds_read_b64_tr_b16 v[174:175], v23 offset:33792
v_mfma_f32_16x16x32_bf16 a[96:99], v[236:239], v[192:195], a[96:99]
buffer_load_dwordx4 v4, s[4:7], s72 offen offset:2048 lds
v_mfma_f32_16x16x32_bf16 a[128:131], v[192:195], v[240:243], a[128:131]
ds_read_b64_tr_b16 v[176:177], v20 offset:49152
v_mfma_f32_16x16x32_bf16 a[132:135], v[196:199], v[240:243], a[132:135]
v_mfma_f32_16x16x32_bf16 a[136:139], v[200:203], v[240:243], a[136:139]
ds_read_b64_tr_b16 v[178:179], v20 offset:50176
v_mfma_f32_16x16x32_bf16 a[140:143], v[204:207], v[240:243], a[140:143]
s_add_u32 s72, s69, 46080
buffer_load_dwordx4 v5, s[4:7], s72 offen offset:3072 lds
v_mfma_f32_16x16x32_bf16 a[144:147], v[208:211], v[240:243], a[144:147]
ds_read_b64_tr_b16 v[180:181], v21 offset:49152
v_mfma_f32_16x16x32_bf16 a[148:151], v[212:215], v[240:243], a[148:151]
v_mfma_f32_16x16x32_bf16 a[152:155], v[216:219], v[240:243], a[152:155]
ds_read_b64_tr_b16 v[182:183], v21 offset:50176
v_mfma_f32_16x16x32_bf16 a[156:159], v[220:223], v[240:243], a[156:159]
v_mfma_f32_16x16x32_bf16 a[188:191], v[220:223], v[244:247], a[188:191]
s_add_u32 m0, s63, 135168
ds_read_b64_tr_b16 v[184:185], v22 offset:49152
v_mfma_f32_16x16x32_bf16 a[184:187], v[216:219], v[244:247], a[184:187]
s_add_u32 s72, s70, 0
buffer_load_dwordx4 v4, s[4:7], s72 offen lds
v_mfma_f32_16x16x32_bf16 a[180:183], v[212:215], v[244:247], a[180:183]
ds_read_b64_tr_b16 v[186:187], v22 offset:50176
v_mfma_f32_16x16x32_bf16 a[176:179], v[208:211], v[244:247], a[176:179]
v_mfma_f32_16x16x32_bf16 a[172:175], v[204:207], v[244:247], a[172:175]
ds_read_b64_tr_b16 v[188:189], v23 offset:49152
v_mfma_f32_16x16x32_bf16 a[168:171], v[200:203], v[244:247], a[168:171]
s_add_u32 s72, s70, 15360
buffer_load_dwordx4 v5, s[4:7], s72 offen offset:1024 lds
v_mfma_f32_16x16x32_bf16 a[164:167], v[196:199], v[244:247], a[164:167]
ds_read_b64_tr_b16 v[190:191], v23 offset:50176
v_mfma_f32_16x16x32_bf16 a[160:163], v[192:195], v[244:247], a[160:163]
v_mfma_f32_16x16x32_bf16 a[192:195], v[192:195], v[248:251], a[192:195]
v_mfma_f32_16x16x32_bf16 a[196:199], v[196:199], v[248:251], a[196:199]
v_mfma_f32_16x16x32_bf16 a[200:203], v[200:203], v[248:251], a[200:203]
s_add_u32 s72, s70, 30720
buffer_load_dwordx4 v4, s[4:7], s72 offen offset:2048 lds
v_mfma_f32_16x16x32_bf16 a[204:207], v[204:207], v[248:251], a[204:207]
v_mfma_f32_16x16x32_bf16 a[208:211], v[208:211], v[248:251], a[208:211]
v_mfma_f32_16x16x32_bf16 a[212:215], v[212:215], v[248:251], a[212:215]
v_mfma_f32_16x16x32_bf16 a[216:219], v[216:219], v[248:251], a[216:219]
v_mfma_f32_16x16x32_bf16 a[220:223], v[220:223], v[248:251], a[220:223]
s_add_u32 s72, s70, 46080
buffer_load_dwordx4 v5, s[4:7], s72 offen offset:3072 lds
v_mfma_f32_16x16x32_bf16 a[252:255], v[220:223], v[252:255], a[252:255]
v_mfma_f32_16x16x32_bf16 a[248:251], v[216:219], v[252:255], a[248:251]
v_mfma_f32_16x16x32_bf16 a[244:247], v[212:215], v[252:255], a[244:247]
v_mfma_f32_16x16x32_bf16 a[240:243], v[208:211], v[252:255], a[240:243]
v_mfma_f32_16x16x32_bf16 a[236:239], v[204:207], v[252:255], a[236:239]
s_add_u32 s73, s61, 1
v_mfma_f32_16x16x32_bf16 a[232:235], v[200:203], v[252:255], a[232:235]
s_and_b32 s73, s73, 7
v_mfma_f32_16x16x32_bf16 a[228:231], v[196:199], v[252:255], a[228:231]
s_lshl_b32 s71, s73, 19
v_mfma_f32_16x16x32_bf16 a[224:227], v[192:195], v[252:255], a[224:227]
s_waitcnt lgkmcnt(0)
v_mfma_f32_16x16x32_bf16 a[0:3], v[160:163], v[128:131], a[0:3]
s_add_u32 s71, s71, s66
ds_read_b64_tr_b16 v[224:225], v20 offset:40960
v_mfma_f32_16x16x32_bf16 a[4:7], v[160:163], v[132:135], a[4:7]
s_lshl_b32 s73, s73, 7
v_mfma_f32_16x16x32_bf16 a[8:11], v[160:163], v[136:139], a[8:11]
s_add_u32 s69, s73, s67
ds_read_b64_tr_b16 v[226:227], v20 offset:41984
v_mfma_f32_16x16x32_bf16 a[12:15], v[160:163], v[140:143], a[12:15]
s_add_u32 s70, s73, s68
v_mfma_f32_16x16x32_bf16 a[16:19], v[160:163], v[144:147], a[16:19]
s_add_u32 m0, s64, 16384
ds_read_b128 v[192:195], v25 offset:32768
v_mfma_f32_16x16x32_bf16 a[20:23], v[160:163], v[148:151], a[20:23]
s_add_u32 s72, s71, 0
buffer_load_dwordx4 v6, s[12:15], s72 offen lds
v_mfma_f32_16x16x32_bf16 a[24:27], v[160:163], v[152:155], a[24:27]
s_add_u32 s72, s71, 31744
ds_read_b128 v[196:199], v25 offset:34816
v_mfma_f32_16x16x32_bf16 a[28:31], v[160:163], v[156:159], a[28:31]
buffer_load_dwordx4 v6, s[12:15], s72 offen offset:1024 lds
v_mfma_f32_16x16x32_bf16 a[60:63], v[164:167], v[156:159], a[60:63]
s_add_u32 s72, s71, 63488
ds_read_b128 v[200:203], v25 offset:36864
v_mfma_f32_16x16x32_bf16 a[56:59], v[164:167], v[152:155], a[56:59]
buffer_load_dwordx4 v7, s[12:15], s72 offen offset:2048 lds
v_mfma_f32_16x16x32_bf16 a[52:55], v[164:167], v[148:151], a[52:55]
ds_read_b128 v[204:207], v25 offset:38912
v_mfma_f32_16x16x32_bf16 a[48:51], v[164:167], v[144:147], a[48:51]
s_add_u32 s72, s71, 95232
buffer_load_dwordx4 v7, s[12:15], s72 offen offset:3072 lds
v_mfma_f32_16x16x32_bf16 a[44:47], v[164:167], v[140:143], a[44:47]
ds_read_b128 v[208:211], v25 offset:40960
v_mfma_f32_16x16x32_bf16 a[40:43], v[164:167], v[136:139], a[40:43]
v_mfma_f32_16x16x32_bf16 a[36:39], v[164:167], v[132:135], a[36:39]
ds_read_b128 v[212:215], v25 offset:43008
v_mfma_f32_16x16x32_bf16 a[32:35], v[164:167], v[128:131], a[32:35]
v_mfma_f32_16x16x32_bf16 a[64:67], v[168:171], v[128:131], a[64:67]
s_add_u32 m0, s63, 65536
ds_read_b128 v[216:219], v25 offset:45056
v_mfma_f32_16x16x32_bf16 a[68:71], v[168:171], v[132:135], a[68:71]
s_add_u32 s72, s69, 0
buffer_load_dwordx4 v4, s[4:7], s72 offen lds
v_mfma_f32_16x16x32_bf16 a[72:75], v[168:171], v[136:139], a[72:75]
ds_read_b128 v[220:223], v25 offset:47104
v_mfma_f32_16x16x32_bf16 a[76:79], v[168:171], v[140:143], a[76:79]
v_mfma_f32_16x16x32_bf16 a[80:83], v[168:171], v[144:147], a[80:83]
ds_read_b64_tr_b16 v[228:229], v21 offset:40960
v_mfma_f32_16x16x32_bf16 a[84:87], v[168:171], v[148:151], a[84:87]
s_add_u32 s72, s69, 15360
buffer_load_dwordx4 v5, s[4:7], s72 offen offset:1024 lds
v_mfma_f32_16x16x32_bf16 a[88:91], v[168:171], v[152:155], a[88:91]
ds_read_b64_tr_b16 v[230:231], v21 offset:41984
v_mfma_f32_16x16x32_bf16 a[92:95], v[168:171], v[156:159], a[92:95]
v_mfma_f32_16x16x32_bf16 a[124:127], v[172:175], v[156:159], a[124:127]
ds_read_b64_tr_b16 v[232:233], v22 offset:40960
v_mfma_f32_16x16x32_bf16 a[120:123], v[172:175], v[152:155], a[120:123]
v_mfma_f32_16x16x32_bf16 a[116:119], v[172:175], v[148:151], a[116:119]
s_add_u32 s72, s69, 30720
ds_read_b64_tr_b16 v[234:235], v22 offset:41984
v_mfma_f32_16x16x32_bf16 a[112:115], v[172:175], v[144:147], a[112:115]
buffer_load_dwordx4 v4, s[4:7], s72 offen offset:2048 lds
v_mfma_f32_16x16x32_bf16 a[108:111], v[172:175], v[140:143], a[108:111]
ds_read_b64_tr_b16 v[236:237], v23 offset:40960
v_mfma_f32_16x16x32_bf16 a[104:107], v[172:175], v[136:139], a[104:107]
v_mfma_f32_16x16x32_bf16 a[100:103], v[172:175], v[132:135], a[100:103]
ds_read_b64_tr_b16 v[238:239], v23 offset:41984
v_mfma_f32_16x16x32_bf16 a[96:99], v[172:175], v[128:131], a[96:99]
s_add_u32 s72, s69, 46080
buffer_load_dwordx4 v5, s[4:7], s72 offen offset:3072 lds
v_mfma_f32_16x16x32_bf16 a[128:131], v[128:131], v[176:179], a[128:131]
ds_read_b64_tr_b16 v[240:241], v20 offset:57344
v_mfma_f32_16x16x32_bf16 a[132:135], v[132:135], v[176:179], a[132:135]
v_mfma_f32_16x16x32_bf16 a[136:139], v[136:139], v[176:179], a[136:139]
ds_read_b64_tr_b16 v[242:243], v20 offset:58368
v_mfma_f32_16x16x32_bf16 a[140:143], v[140:143], v[176:179], a[140:143]
v_mfma_f32_16x16x32_bf16 a[144:147], v[144:147], v[176:179], a[144:147]
s_add_u32 m0, s63, 69632
ds_read_b64_tr_b16 v[244:245], v21 offset:57344
v_mfma_f32_16x16x32_bf16 a[148:151], v[148:151], v[176:179], a[148:151]
s_add_u32 s72, s70, 0
buffer_load_dwordx4 v4, s[4:7], s72 offen lds
v_mfma_f32_16x16x32_bf16 a[152:155], v[152:155], v[176:179], a[152:155]
ds_read_b64_tr_b16 v[246:247], v21 offset:58368
v_mfma_f32_16x16x32_bf16 a[156:159], v[156:159], v[176:179], a[156:159]
v_mfma_f32_16x16x32_bf16 a[188:191], v[156:159], v[180:183], a[188:191]
ds_read_b64_tr_b16 v[248:249], v22 offset:57344
v_mfma_f32_16x16x32_bf16 a[184:187], v[152:155], v[180:183], a[184:187]
s_add_u32 s72, s70, 15360
buffer_load_dwordx4 v5, s[4:7], s72 offen offset:1024 lds
v_mfma_f32_16x16x32_bf16 a[180:183], v[148:151], v[180:183], a[180:183]
ds_read_b64_tr_b16 v[250:251], v22 offset:58368
v_mfma_f32_16x16x32_bf16 a[176:179], v[144:147], v[180:183], a[176:179]
v_mfma_f32_16x16x32_bf16 a[172:175], v[140:143], v[180:183], a[172:175]
ds_read_b64_tr_b16 v[252:253], v23 offset:57344
v_mfma_f32_16x16x32_bf16 a[168:171], v[136:139], v[180:183], a[168:171]
v_mfma_f32_16x16x32_bf16 a[164:167], v[132:135], v[180:183], a[164:167]
s_add_u32 s72, s70, 30720
ds_read_b64_tr_b16 v[254:255], v23 offset:58368
v_mfma_f32_16x16x32_bf16 a[160:163], v[128:131], v[180:183], a[160:163]
buffer_load_dwordx4 v4, s[4:7], s72 offen offset:2048 lds
v_mfma_f32_16x16x32_bf16 a[192:195], v[128:131], v[184:187], a[192:195]
v_mfma_f32_16x16x32_bf16 a[196:199], v[132:135], v[184:187], a[196:199]
v_mfma_f32_16x16x32_bf16 a[200:203], v[136:139], v[184:187], a[200:203]
v_mfma_f32_16x16x32_bf16 a[204:207], v[140:143], v[184:187], a[204:207]
s_add_u32 s72, s70, 46080
buffer_load_dwordx4 v5, s[4:7], s72 offen offset:3072 lds
v_mfma_f32_16x16x32_bf16 a[208:211], v[144:147], v[184:187], a[208:211]
v_mfma_f32_16x16x32_bf16 a[212:215], v[148:151], v[184:187], a[212:215]
v_mfma_f32_16x16x32_bf16 a[216:219], v[152:155], v[184:187], a[216:219]
v_mfma_f32_16x16x32_bf16 a[220:223], v[156:159], v[184:187], a[220:223]
v_mfma_f32_16x16x32_bf16 a[252:255], v[156:159], v[188:191], a[252:255]
v_mfma_f32_16x16x32_bf16 a[248:251], v[152:155], v[188:191], a[248:251]
v_mfma_f32_16x16x32_bf16 a[244:247], v[148:151], v[188:191], a[244:247]
v_mfma_f32_16x16x32_bf16 a[240:243], v[144:147], v[188:191], a[240:243]
v_mfma_f32_16x16x32_bf16 a[236:239], v[140:143], v[188:191], a[236:239]
v_mfma_f32_16x16x32_bf16 a[232:235], v[136:139], v[188:191], a[232:235]
v_mfma_f32_16x16x32_bf16 a[228:231], v[132:135], v[188:191], a[228:231]
s_waitcnt vmcnt(12) lgkmcnt(0)
v_mfma_f32_16x16x32_bf16 a[224:227], v[128:131], v[188:191], a[224:227]
s_barrier
v_mfma_f32_16x16x32_bf16 a[0:3], v[224:227], v[192:195], a[0:3]
s_add_u32 s73, s61, 2
ds_read_b64_tr_b16 v[32:33], v8 offset:0
v_mfma_f32_16x16x32_bf16 a[4:7], v[224:227], v[196:199], a[4:7]
s_and_b32 s73, s73, 7
v_mfma_f32_16x16x32_bf16 a[8:11], v[224:227], v[200:203], a[8:11]
s_lshl_b32 s71, s73, 19
ds_read_b64_tr_b16 v[34:35], v8 offset:1024
v_mfma_f32_16x16x32_bf16 a[12:15], v[224:227], v[204:207], a[12:15]
s_add_u32 s71, s71, s66
v_mfma_f32_16x16x32_bf16 a[16:19], v[224:227], v[208:211], a[16:19]
s_lshl_b32 s73, s73, 7
ds_read_b128 v[64:67], v16 offset:0
v_mfma_f32_16x16x32_bf16 a[20:23], v[224:227], v[212:215], a[20:23]
s_add_u32 s69, s73, s67
v_mfma_f32_16x16x32_bf16 a[24:27], v[224:227], v[216:219], a[24:27]
s_add_u32 s70, s73, s68
ds_read_b128 v[68:71], v16 offset:2048
v_mfma_f32_16x16x32_bf16 a[28:31], v[224:227], v[220:223], a[28:31]
s_add_u32 m0, s64, 32768
v_mfma_f32_16x16x32_bf16 a[60:63], v[228:231], v[220:223], a[60:63]
s_add_u32 s72, s71, 0
ds_read_b128 v[72:75], v16 offset:4096
v_mfma_f32_16x16x32_bf16 a[56:59], v[228:231], v[216:219], a[56:59]
buffer_load_dwordx4 v6, s[12:15], s72 offen lds
v_mfma_f32_16x16x32_bf16 a[52:55], v[228:231], v[212:215], a[52:55]
s_add_u32 s72, s71, 31744
ds_read_b128 v[76:79], v16 offset:6144
v_mfma_f32_16x16x32_bf16 a[48:51], v[228:231], v[208:211], a[48:51]
buffer_load_dwordx4 v6, s[12:15], s72 offen offset:1024 lds
v_mfma_f32_16x16x32_bf16 a[44:47], v[228:231], v[204:207], a[44:47]
s_add_u32 s72, s71, 63488
ds_read_b64_tr_b16 v[36:37], v9 offset:0
v_mfma_f32_16x16x32_bf16 a[40:43], v[228:231], v[200:203], a[40:43]
buffer_load_dwordx4 v7, s[12:15], s72 offen offset:2048 lds
v_mfma_f32_16x16x32_bf16 a[36:39], v[228:231], v[196:199], a[36:39]
ds_read_b64_tr_b16 v[38:39], v9 offset:1024
v_mfma_f32_16x16x32_bf16 a[32:35], v[228:231], v[192:195], a[32:35]
s_add_u32 s72, s71, 95232
buffer_load_dwordx4 v7, s[12:15], s72 offen offset:3072 lds
v_mfma_f32_16x16x32_bf16 a[64:67], v[232:235], v[192:195], a[64:67]
ds_read_b64_tr_b16 v[40:41], v10 offset:0
v_mfma_f32_16x16x32_bf16 a[68:71], v[232:235], v[196:199], a[68:71]
v_mfma_f32_16x16x32_bf16 a[72:75], v[232:235], v[200:203], a[72:75]
ds_read_b64_tr_b16 v[42:43], v10 offset:1024
v_mfma_f32_16x16x32_bf16 a[76:79], v[232:235], v[204:207], a[76:79]
v_mfma_f32_16x16x32_bf16 a[80:83], v[232:235], v[208:211], a[80:83]
s_add_u32 m0, s63, 98304
ds_read_b64_tr_b16 v[44:45], v11 offset:0
v_mfma_f32_16x16x32_bf16 a[84:87], v[232:235], v[212:215], a[84:87]
s_add_u32 s72, s69, 0
buffer_load_dwordx4 v4, s[4:7], s72 offen lds
v_mfma_f32_16x16x32_bf16 a[88:91], v[232:235], v[216:219], a[88:91]
ds_read_b64_tr_b16 v[46:47], v11 offset:1024
v_mfma_f32_16x16x32_bf16 a[92:95], v[232:235], v[220:223], a[92:95]
v_mfma_f32_16x16x32_bf16 a[124:127], v[236:239], v[220:223], a[124:127]
ds_read_b64_tr_b16 v[48:49], v12 offset:0
v_mfma_f32_16x16x32_bf16 a[120:123], v[236:239], v[216:219], a[120:123]
s_add_u32 s72, s69, 15360
buffer_load_dwordx4 v5, s[4:7], s72 offen offset:1024 lds
v_mfma_f32_16x16x32_bf16 a[116:119], v[236:239], v[212:215], a[116:119]
ds_read_b64_tr_b16 v[50:51], v12 offset:1024
v_accvgpr_read_b32 v20, a0
v_mfma_f32_16x16x32_bf16 a[112:115], v[236:239], v[208:211], a[112:115]
v_accvgpr_read_b32 v28, a1
v_accvgpr_read_b32 v21, a2
v_mfma_f32_16x16x32_bf16 a[108:111], v[236:239], v[204:207], a[108:111]
ds_read_b64_tr_b16 v[52:53], v13 offset:0
v_accvgpr_read_b32 v29, a3
v_mfma_f32_16x16x32_bf16 a[104:107], v[236:239], v[200:203], a[104:107]
s_add_u32 s80, s77, 0
v_accvgpr_read_b32 v22, a32
v_accvgpr_read_b32 v30, a33
v_mfma_f32_16x16x32_bf16 a[100:103], v[236:239], v[196:199], a[100:103]
s_add_u32 s72, s69, 30720
ds_read_b64_tr_b16 v[54:55], v13 offset:1024
v_accvgpr_read_b32 v23, a34
v_mfma_f32_16x16x32_bf16 a[96:99], v[236:239], v[192:195], a[96:99]
buffer_load_dwordx4 v4, s[4:7], s72 offen offset:2048 lds
v_mfma_f32_16x16x32_bf16 a[128:131], v[192:195], v[240:243], a[128:131]
ds_read_b64_tr_b16 v[56:57], v14 offset:0
v_accvgpr_read_b32 v31, a35
v_mfma_f32_16x16x32_bf16 a[132:135], v[196:199], v[240:243], a[132:135]
v_mul_f32 v20, s79, v20
v_mul_f32 v28, s79, v28
v_mfma_f32_16x16x32_bf16 a[136:139], v[200:203], v[240:243], a[136:139]
ds_read_b64_tr_b16 v[58:59], v14 offset:1024
v_mul_f32 v21, s79, v21
v_mfma_f32_16x16x32_bf16 a[140:143], v[204:207], v[240:243], a[140:143]
s_add_u32 s72, s69, 46080
buffer_load_dwordx4 v5, s[4:7], s72 offen offset:3072 lds
v_mfma_f32_16x16x32_bf16 a[144:147], v[208:211], v[240:243], a[144:147]
ds_read_b64_tr_b16 v[60:61], v15 offset:0
v_mul_f32 v29, s79, v29
v_mfma_f32_16x16x32_bf16 a[148:151], v[212:215], v[240:243], a[148:151]
v_mul_f32 v22, s79, v22
v_mul_f32 v30, s79, v30
v_mfma_f32_16x16x32_bf16 a[152:155], v[216:219], v[240:243], a[152:155]
ds_read_b64_tr_b16 v[62:63], v15 offset:1024
v_mul_f32 v23, s79, v23
v_mfma_f32_16x16x32_bf16 a[156:159], v[220:223], v[240:243], a[156:159]
v_mul_f32 v31, s79, v31
v_cvt_pk_bf16_f32 v20, v20, v28
v_mfma_f32_16x16x32_bf16 a[188:191], v[220:223], v[244:247], a[188:191]
s_add_u32 m0, s63, 102400
v_cvt_pk_bf16_f32 v21, v21, v29
v_cvt_pk_bf16_f32 v22, v22, v30
v_mfma_f32_16x16x32_bf16 a[184:187], v[216:219], v[244:247], a[184:187]
s_add_u32 s72, s70, 0
buffer_load_dwordx4 v4, s[4:7], s72 offen lds
v_mfma_f32_16x16x32_bf16 a[180:183], v[212:215], v[244:247], a[180:183]
v_cvt_pk_bf16_f32 v23, v23, v31
v_mfma_f32_16x16x32_bf16 a[176:179], v[208:211], v[244:247], a[176:179]
buffer_store_dwordx4 v[20:23], v1, s[44:47], s80 offen sc1
v_mfma_f32_16x16x32_bf16 a[172:175], v[204:207], v[244:247], a[172:175]
v_accvgpr_read_b32 v24, a4
v_accvgpr_read_b32 v28, a5
v_mfma_f32_16x16x32_bf16 a[168:171], v[200:203], v[244:247], a[168:171]
s_add_u32 s72, s70, 15360
buffer_load_dwordx4 v5, s[4:7], s72 offen offset:1024 lds
v_mfma_f32_16x16x32_bf16 a[164:167], v[196:199], v[244:247], a[164:167]
v_accvgpr_read_b32 v25, a6
v_accvgpr_read_b32 v29, a7
v_mfma_f32_16x16x32_bf16 a[160:163], v[192:195], v[244:247], a[160:163]
s_add_u32 s80, s77, 4096
v_accvgpr_read_b32 v26, a36
v_accvgpr_read_b32 v30, a37
v_mfma_f32_16x16x32_bf16 a[192:195], v[192:195], v[248:251], a[192:195]
v_accvgpr_read_b32 v27, a38
v_accvgpr_read_b32 v31, a39
v_mfma_f32_16x16x32_bf16 a[196:199], v[196:199], v[248:251], a[196:199]
v_mul_f32 v24, s79, v24
v_mul_f32 v28, s79, v28
v_mfma_f32_16x16x32_bf16 a[200:203], v[200:203], v[248:251], a[200:203]
s_add_u32 s72, s70, 30720
buffer_load_dwordx4 v4, s[4:7], s72 offen offset:2048 lds
v_mfma_f32_16x16x32_bf16 a[204:207], v[204:207], v[248:251], a[204:207]
v_mul_f32 v25, s79, v25
v_mul_f32 v29, s79, v29
v_mfma_f32_16x16x32_bf16 a[208:211], v[208:211], v[248:251], a[208:211]
v_mul_f32 v26, s79, v26
v_mul_f32 v30, s79, v30
v_mfma_f32_16x16x32_bf16 a[212:215], v[212:215], v[248:251], a[212:215]
v_mul_f32 v27, s79, v27
v_mul_f32 v31, s79, v31
v_mfma_f32_16x16x32_bf16 a[216:219], v[216:219], v[248:251], a[216:219]
v_cvt_pk_bf16_f32 v24, v24, v28
v_cvt_pk_bf16_f32 v25, v25, v29
v_mfma_f32_16x16x32_bf16 a[220:223], v[220:223], v[248:251], a[220:223]
s_add_u32 s72, s70, 46080
buffer_load_dwordx4 v5, s[4:7], s72 offen offset:3072 lds
v_mfma_f32_16x16x32_bf16 a[252:255], v[220:223], v[252:255], a[252:255]
v_cvt_pk_bf16_f32 v26, v26, v30
v_cvt_pk_bf16_f32 v27, v27, v31
v_mfma_f32_16x16x32_bf16 a[248:251], v[216:219], v[252:255], a[248:251]
buffer_store_dwordx4 v[24:27], v1, s[44:47], s80 offen sc1
v_mfma_f32_16x16x32_bf16 a[244:247], v[212:215], v[252:255], a[244:247]
v_accvgpr_read_b32 v20, a8
v_accvgpr_read_b32 v28, a9
v_mfma_f32_16x16x32_bf16 a[240:243], v[208:211], v[252:255], a[240:243]
v_accvgpr_read_b32 v21, a10
v_accvgpr_read_b32 v29, a11
v_mfma_f32_16x16x32_bf16 a[236:239], v[204:207], v[252:255], a[236:239]
s_add_u32 s80, s77, 8192
v_accvgpr_read_b32 v22, a40
v_accvgpr_read_b32 v30, a41
v_mfma_f32_16x16x32_bf16 a[232:235], v[200:203], v[252:255], a[232:235]
v_accvgpr_read_b32 v23, a42
v_accvgpr_read_b32 v31, a43
v_mfma_f32_16x16x32_bf16 a[228:231], v[196:199], v[252:255], a[228:231]
v_mul_f32 v20, s79, v20
v_mul_f32 v28, s79, v28
v_mfma_f32_16x16x32_bf16 a[224:227], v[192:195], v[252:255], a[224:227]
s_waitcnt lgkmcnt(0)
v_mul_f32 v21, s79, v21
v_mul_f32 v29, s79, v29
v_mfma_f32_16x16x32_bf16 v[128:131], v[32:35], v[64:67], 0
ds_read_b64_tr_b16 v[80:81], v8 offset:8192
ds_read_b64_tr_b16 v[82:83], v8 offset:9216
v_mfma_f32_16x16x32_bf16 v[132:135], v[32:35], v[68:71], 0
ds_read_b128 v[112:115], v17 offset:0
ds_read_b128 v[116:119], v17 offset:2048
v_mfma_f32_16x16x32_bf16 v[136:139], v[32:35], v[72:75], 0
ds_read_b128 v[120:123], v17 offset:4096
ds_read_b128 v[124:127], v17 offset:6144
v_mfma_f32_16x16x32_bf16 v[140:143], v[32:35], v[76:79], 0
ds_read_b64_tr_b16 v[84:85], v9 offset:8192
ds_read_b64_tr_b16 v[86:87], v9 offset:9216
v_mfma_f32_16x16x32_bf16 v[156:159], v[36:39], v[76:79], 0
ds_read_b64_tr_b16 v[88:89], v10 offset:8192
v_mul_f32 v22, s79, v22
v_mfma_f32_16x16x32_bf16 v[152:155], v[36:39], v[72:75], 0
ds_read_b64_tr_b16 v[90:91], v10 offset:9216
v_mul_f32 v30, s79, v30
v_mfma_f32_16x16x32_bf16 v[148:151], v[36:39], v[68:71], 0
ds_read_b64_tr_b16 v[92:93], v11 offset:8192
v_mul_f32 v23, s79, v23
v_mfma_f32_16x16x32_bf16 v[144:147], v[36:39], v[64:67], 0
ds_read_b64_tr_b16 v[94:95], v11 offset:9216
v_mul_f32 v31, s79, v31
v_mfma_f32_16x16x32_bf16 v[160:163], v[40:43], v[64:67], 0
ds_read_b64_tr_b16 v[96:97], v12 offset:8192
v_cvt_pk_bf16_f32 v20, v20, v28
v_mfma_f32_16x16x32_bf16 v[164:167], v[40:43], v[68:71], 0
ds_read_b64_tr_b16 v[98:99], v12 offset:9216
v_cvt_pk_bf16_f32 v21, v21, v29
v_mfma_f32_16x16x32_bf16 v[168:171], v[40:43], v[72:75], 0
ds_read_b64_tr_b16 v[100:101], v13 offset:8192
v_cvt_pk_bf16_f32 v22, v22, v30
v_mfma_f32_16x16x32_bf16 v[172:175], v[40:43], v[76:79], 0
ds_read_b64_tr_b16 v[102:103], v13 offset:9216
v_cvt_pk_bf16_f32 v23, v23, v31
v_mfma_f32_16x16x32_bf16 v[188:191], v[44:47], v[76:79], 0
ds_read_b64_tr_b16 v[104:105], v14 offset:8192
v_mfma_f32_16x16x32_bf16 v[184:187], v[44:47], v[72:75], 0
ds_read_b64_tr_b16 v[106:107], v14 offset:9216
v_mfma_f32_16x16x32_bf16 v[180:183], v[44:47], v[68:71], 0
ds_read_b64_tr_b16 v[108:109], v15 offset:8192
v_mfma_f32_16x16x32_bf16 v[176:179], v[44:47], v[64:67], 0
ds_read_b64_tr_b16 v[110:111], v15 offset:9216
v_mfma_f32_16x16x32_bf16 v[192:195], v[48:51], v[64:67], 0
buffer_store_dwordx4 v[20:23], v1, s[44:47], s80 offen sc1
v_mfma_f32_16x16x32_bf16 v[196:199], v[48:51], v[68:71], 0
v_accvgpr_read_b32 v24, a12
v_accvgpr_read_b32 v28, a13
v_mfma_f32_16x16x32_bf16 v[200:203], v[48:51], v[72:75], 0
v_accvgpr_read_b32 v25, a14
v_accvgpr_read_b32 v29, a15
v_mfma_f32_16x16x32_bf16 v[204:207], v[48:51], v[76:79], 0
s_add_u32 s80, s77, 12288
v_accvgpr_read_b32 v26, a44
v_accvgpr_read_b32 v30, a45
v_mfma_f32_16x16x32_bf16 v[220:223], v[52:55], v[76:79], 0
v_accvgpr_read_b32 v27, a46
v_accvgpr_read_b32 v31, a47
v_mfma_f32_16x16x32_bf16 v[216:219], v[52:55], v[72:75], 0
v_mul_f32 v24, s79, v24
v_mul_f32 v28, s79, v28
v_mfma_f32_16x16x32_bf16 v[212:215], v[52:55], v[68:71], 0
v_mul_f32 v25, s79, v25
v_mul_f32 v29, s79, v29
v_mfma_f32_16x16x32_bf16 v[208:211], v[52:55], v[64:67], 0
v_mul_f32 v26, s79, v26
v_mul_f32 v30, s79, v30
v_mfma_f32_16x16x32_bf16 v[224:227], v[56:59], v[64:67], 0
v_mul_f32 v27, s79, v27
v_mul_f32 v31, s79, v31
v_mfma_f32_16x16x32_bf16 v[228:231], v[56:59], v[68:71], 0
v_cvt_pk_bf16_f32 v24, v24, v28
v_cvt_pk_bf16_f32 v25, v25, v29
v_mfma_f32_16x16x32_bf16 v[232:235], v[56:59], v[72:75], 0
v_cvt_pk_bf16_f32 v26, v26, v30
v_cvt_pk_bf16_f32 v27, v27, v31
v_mfma_f32_16x16x32_bf16 v[236:239], v[56:59], v[76:79], 0
buffer_store_dwordx4 v[24:27], v1, s[44:47], s80 offen sc1
v_mfma_f32_16x16x32_bf16 v[252:255], v[60:63], v[76:79], 0
v_accvgpr_read_b32 v20, a16
v_accvgpr_read_b32 v28, a17
v_mfma_f32_16x16x32_bf16 v[248:251], v[60:63], v[72:75], 0
v_accvgpr_read_b32 v21, a18
v_accvgpr_read_b32 v29, a19
v_mfma_f32_16x16x32_bf16 v[244:247], v[60:63], v[68:71], 0
s_waitcnt vmcnt(16) lgkmcnt(0)
v_mfma_f32_16x16x32_bf16 v[240:243], v[60:63], v[64:67], 0
s_barrier
v_mfma_f32_16x16x32_bf16 v[128:131], v[80:83], v[112:115], v[128:131]
s_add_u32 s73, s61, 3
ds_read_b64_tr_b16 v[32:33], v8 offset:16384
ds_read_b64_tr_b16 v[34:35], v8 offset:17408
v_mfma_f32_16x16x32_bf16 v[132:135], v[80:83], v[116:119], v[132:135]
s_and_b32 s73, s73, 7
ds_read_b128 v[64:67], v18 offset:0
ds_read_b128 v[68:71], v18 offset:2048
v_mfma_f32_16x16x32_bf16 v[136:139], v[80:83], v[120:123], v[136:139]
s_lshl_b32 s71, s73, 19
ds_read_b128 v[72:75], v18 offset:4096
ds_read_b128 v[76:79], v18 offset:6144
v_mfma_f32_16x16x32_bf16 v[140:143], v[80:83], v[124:127], v[140:143]
s_add_u32 s71, s71, s66
ds_read_b64_tr_b16 v[36:37], v9 offset:16384
ds_read_b64_tr_b16 v[38:39], v9 offset:17408
v_mfma_f32_16x16x32_bf16 v[156:159], v[84:87], v[124:127], v[156:159]
s_lshl_b32 s73, s73, 7
ds_read_b64_tr_b16 v[40:41], v10 offset:16384
v_mfma_f32_16x16x32_bf16 v[152:155], v[84:87], v[120:123], v[152:155]
s_add_u32 s69, s73, s67
ds_read_b64_tr_b16 v[42:43], v10 offset:17408
v_mfma_f32_16x16x32_bf16 v[148:151], v[84:87], v[116:119], v[148:151]
s_add_u32 s70, s73, s68
ds_read_b64_tr_b16 v[44:45], v11 offset:16384
v_mfma_f32_16x16x32_bf16 v[144:147], v[84:87], v[112:115], v[144:147]
s_add_u32 m0, s64, 0
ds_read_b64_tr_b16 v[46:47], v11 offset:17408
v_mfma_f32_16x16x32_bf16 v[160:163], v[88:91], v[112:115], v[160:163]
s_add_u32 s72, s71, 0
buffer_load_dwordx4 v6, s[12:15], s72 offen lds
v_mfma_f32_16x16x32_bf16 v[164:167], v[88:91], v[116:119], v[164:167]
s_add_u32 s72, s71, 31744
buffer_load_dwordx4 v6, s[12:15], s72 offen offset:1024 lds
v_mfma_f32_16x16x32_bf16 v[168:171], v[88:91], v[120:123], v[168:171]
s_add_u32 s72, s71, 63488
buffer_load_dwordx4 v7, s[12:15], s72 offen offset:2048 lds
v_mfma_f32_16x16x32_bf16 v[172:175], v[88:91], v[124:127], v[172:175]
s_add_u32 s80, s77, 32768
ds_read_b64_tr_b16 v[48:49], v12 offset:16384
v_accvgpr_read_b32 v22, a48
v_mfma_f32_16x16x32_bf16 v[188:191], v[92:95], v[124:127], v[188:191]
ds_read_b64_tr_b16 v[50:51], v12 offset:17408
v_accvgpr_read_b32 v30, a49
v_mfma_f32_16x16x32_bf16 v[184:187], v[92:95], v[120:123], v[184:187]
ds_read_b64_tr_b16 v[52:53], v13 offset:16384
v_accvgpr_read_b32 v23, a50
v_mfma_f32_16x16x32_bf16 v[180:183], v[92:95], v[116:119], v[180:183]
s_add_u32 s72, s71, 95232
buffer_load_dwordx4 v7, s[12:15], s72 offen offset:3072 lds
v_mfma_f32_16x16x32_bf16 v[176:179], v[92:95], v[112:115], v[176:179]
ds_read_b64_tr_b16 v[54:55], v13 offset:17408
v_accvgpr_read_b32 v31, a51
v_mfma_f32_16x16x32_bf16 v[192:195], v[96:99], v[112:115], v[192:195]
ds_read_b64_tr_b16 v[56:57], v14 offset:16384
v_mul_f32 v20, s79, v20
v_mfma_f32_16x16x32_bf16 v[196:199], v[96:99], v[116:119], v[196:199]
ds_read_b64_tr_b16 v[58:59], v14 offset:17408
v_mul_f32 v28, s79, v28
v_mfma_f32_16x16x32_bf16 v[200:203], v[96:99], v[120:123], v[200:203]
ds_read_b64_tr_b16 v[60:61], v15 offset:16384
v_mul_f32 v21, s79, v21
v_mfma_f32_16x16x32_bf16 v[204:207], v[96:99], v[124:127], v[204:207]
s_add_u32 m0, s63, 131072
ds_read_b64_tr_b16 v[62:63], v15 offset:17408
v_mul_f32 v29, s79, v29
v_mfma_f32_16x16x32_bf16 v[220:223], v[100:103], v[124:127], v[220:223]
s_add_u32 s72, s69, 0
buffer_load_dwordx4 v4, s[4:7], s72 offen lds
v_mfma_f32_16x16x32_bf16 v[216:219], v[100:103], v[120:123], v[216:219]
v_mul_f32 v22, s79, v22
v_mul_f32 v30, s79, v30
v_mfma_f32_16x16x32_bf16 v[212:215], v[100:103], v[116:119], v[212:215]
v_mul_f32 v23, s79, v23
v_mul_f32 v31, s79, v31
v_mfma_f32_16x16x32_bf16 v[208:211], v[100:103], v[112:115], v[208:211]
v_cvt_pk_bf16_f32 v20, v20, v28
v_cvt_pk_bf16_f32 v21, v21, v29
v_mfma_f32_16x16x32_bf16 v[224:227], v[104:107], v[112:115], v[224:227]
s_add_u32 s72, s69, 15360
buffer_load_dwordx4 v5, s[4:7], s72 offen offset:1024 lds
v_mfma_f32_16x16x32_bf16 v[228:231], v[104:107], v[116:119], v[228:231]
v_cvt_pk_bf16_f32 v22, v22, v30
v_cvt_pk_bf16_f32 v23, v23, v31
v_mfma_f32_16x16x32_bf16 v[232:235], v[104:107], v[120:123], v[232:235]
buffer_store_dwordx4 v[20:23], v1, s[44:47], s80 offen sc1
v_mfma_f32_16x16x32_bf16 v[236:239], v[104:107], v[124:127], v[236:239]
v_accvgpr_read_b32 v24, a20
v_accvgpr_read_b32 v28, a21
v_mfma_f32_16x16x32_bf16 v[252:255], v[108:111], v[124:127], v[252:255]
v_accvgpr_read_b32 v25, a22
v_accvgpr_read_b32 v29, a23
v_mfma_f32_16x16x32_bf16 v[248:251], v[108:111], v[120:123], v[248:251]
s_add_u32 s72, s69, 30720
buffer_load_dwordx4 v4, s[4:7], s72 offen offset:2048 lds
v_mfma_f32_16x16x32_bf16 v[244:247], v[108:111], v[116:119], v[244:247]
s_add_u32 s80, s77, 36864
v_accvgpr_read_b32 v26, a52
v_accvgpr_read_b32 v30, a53
v_mfma_f32_16x16x32_bf16 v[240:243], v[108:111], v[112:115], v[240:243]
s_waitcnt lgkmcnt(0)
v_accvgpr_read_b32 v27, a54
v_accvgpr_read_b32 v31, a55
v_mfma_f32_16x16x32_bf16 v[128:131], v[32:35], v[64:67], v[128:131]
ds_read_b64_tr_b16 v[80:81], v8 offset:24576
ds_read_b64_tr_b16 v[82:83], v8 offset:25600
v_mfma_f32_16x16x32_bf16 v[132:135], v[32:35], v[68:71], v[132:135]
ds_read_b128 v[112:115], v19 offset:0
ds_read_b128 v[116:119], v19 offset:2048
v_mfma_f32_16x16x32_bf16 v[136:139], v[32:35], v[72:75], v[136:139]
s_add_u32 s72, s69, 46080
buffer_load_dwordx4 v5, s[4:7], s72 offen offset:3072 lds
v_mfma_f32_16x16x32_bf16 v[140:143], v[32:35], v[76:79], v[140:143]
ds_read_b128 v[120:123], v19 offset:4096
ds_read_b128 v[124:127], v19 offset:6144
v_mfma_f32_16x16x32_bf16 v[156:159], v[36:39], v[76:79], v[156:159]
ds_read_b64_tr_b16 v[84:85], v9 offset:24576
ds_read_b64_tr_b16 v[86:87], v9 offset:25600
v_mfma_f32_16x16x32_bf16 v[152:155], v[36:39], v[72:75], v[152:155]
ds_read_b64_tr_b16 v[88:89], v10 offset:24576
v_mul_f32 v24, s79, v24
v_mfma_f32_16x16x32_bf16 v[148:151], v[36:39], v[68:71], v[148:151]
ds_read_b64_tr_b16 v[90:91], v10 offset:25600
v_mul_f32 v28, s79, v28
v_mfma_f32_16x16x32_bf16 v[144:147], v[36:39], v[64:67], v[144:147]
s_add_u32 m0, s63, 135168
ds_read_b64_tr_b16 v[92:93], v11 offset:24576
v_mul_f32 v25, s79, v25
v_mfma_f32_16x16x32_bf16 v[160:163], v[40:43], v[64:67], v[160:163]
s_add_u32 s72, s70, 0
buffer_load_dwordx4 v4, s[4:7], s72 offen lds
v_mfma_f32_16x16x32_bf16 v[164:167], v[40:43], v[68:71], v[164:167]
ds_read_b64_tr_b16 v[94:95], v11 offset:25600
v_mul_f32 v29, s79, v29
v_mfma_f32_16x16x32_bf16 v[168:171], v[40:43], v[72:75], v[168:171]
ds_read_b64_tr_b16 v[96:97], v12 offset:24576
v_mul_f32 v26, s79, v26
v_mfma_f32_16x16x32_bf16 v[172:175], v[40:43], v[76:79], v[172:175]
ds_read_b64_tr_b16 v[98:99], v12 offset:25600
v_mul_f32 v30, s79, v30
v_mfma_f32_16x16x32_bf16 v[188:191], v[44:47], v[76:79], v[188:191]
s_add_u32 s72, s70, 15360
buffer_load_dwordx4 v5, s[4:7], s72 offen offset:1024 lds
v_mfma_f32_16x16x32_bf16 v[184:187], v[44:47], v[72:75], v[184:187]
ds_read_b64_tr_b16 v[100:101], v13 offset:24576
v_mul_f32 v27, s79, v27
v_mfma_f32_16x16x32_bf16 v[180:183], v[44:47], v[68:71], v[180:183]
ds_read_b64_tr_b16 v[102:103], v13 offset:25600
v_mul_f32 v31, s79, v31
v_mfma_f32_16x16x32_bf16 v[176:179], v[44:47], v[64:67], v[176:179]
ds_read_b64_tr_b16 v[104:105], v14 offset:24576
v_cvt_pk_bf16_f32 v24, v24, v28
v_mfma_f32_16x16x32_bf16 v[192:195], v[48:51], v[64:67], v[192:195]
ds_read_b64_tr_b16 v[106:107], v14 offset:25600
v_cvt_pk_bf16_f32 v25, v25, v29
v_mfma_f32_16x16x32_bf16 v[196:199], v[48:51], v[68:71], v[196:199]
s_add_u32 s72, s70, 30720
buffer_load_dwordx4 v4, s[4:7], s72 offen offset:2048 lds
v_mfma_f32_16x16x32_bf16 v[200:203], v[48:51], v[72:75], v[200:203]
ds_read_b64_tr_b16 v[108:109], v15 offset:24576
v_cvt_pk_bf16_f32 v26, v26, v30
v_mfma_f32_16x16x32_bf16 v[204:207], v[48:51], v[76:79], v[204:207]
ds_read_b64_tr_b16 v[110:111], v15 offset:25600
v_cvt_pk_bf16_f32 v27, v27, v31
v_mfma_f32_16x16x32_bf16 v[220:223], v[52:55], v[76:79], v[220:223]
buffer_store_dwordx4 v[24:27], v1, s[44:47], s80 offen sc1
v_mfma_f32_16x16x32_bf16 v[216:219], v[52:55], v[72:75], v[216:219]
v_accvgpr_read_b32 v20, a24
v_accvgpr_read_b32 v28, a25
v_mfma_f32_16x16x32_bf16 v[212:215], v[52:55], v[68:71], v[212:215]
s_add_u32 s72, s70, 46080
buffer_load_dwordx4 v5, s[4:7], s72 offen offset:3072 lds
v_mfma_f32_16x16x32_bf16 v[208:211], v[52:55], v[64:67], v[208:211]
v_accvgpr_read_b32 v21, a26
v_accvgpr_read_b32 v29, a27
v_mfma_f32_16x16x32_bf16 v[224:227], v[56:59], v[64:67], v[224:227]
s_add_u32 s80, s77, 40960
v_accvgpr_read_b32 v22, a56
v_accvgpr_read_b32 v30, a57
v_mfma_f32_16x16x32_bf16 v[228:231], v[56:59], v[68:71], v[228:231]
v_accvgpr_read_b32 v23, a58
v_accvgpr_read_b32 v31, a59
v_mfma_f32_16x16x32_bf16 v[232:235], v[56:59], v[72:75], v[232:235]
v_mul_f32 v20, s79, v20
v_mul_f32 v28, s79, v28
v_mfma_f32_16x16x32_bf16 v[236:239], v[56:59], v[76:79], v[236:239]
v_mul_f32 v21, s79, v21
v_mul_f32 v29, s79, v29
v_mfma_f32_16x16x32_bf16 v[252:255], v[60:63], v[76:79], v[252:255]
v_mul_f32 v22, s79, v22
v_mul_f32 v30, s79, v30
v_mfma_f32_16x16x32_bf16 v[248:251], v[60:63], v[72:75], v[248:251]
v_mul_f32 v23, s79, v23
v_mul_f32 v31, s79, v31
v_mfma_f32_16x16x32_bf16 v[244:247], v[60:63], v[68:71], v[244:247]
s_waitcnt vmcnt(17) lgkmcnt(0)
v_cvt_pk_bf16_f32 v20, v20, v28
v_cvt_pk_bf16_f32 v21, v21, v29
v_mfma_f32_16x16x32_bf16 v[240:243], v[60:63], v[64:67], v[240:243]
s_barrier
v_cvt_pk_bf16_f32 v22, v22, v30
v_cvt_pk_bf16_f32 v23, v23, v31
v_mfma_f32_16x16x32_bf16 v[128:131], v[80:83], v[112:115], v[128:131]
s_add_u32 s73, s61, 4
ds_read_b64_tr_b16 v[32:33], v8 offset:32768
ds_read_b64_tr_b16 v[34:35], v8 offset:33792
v_mfma_f32_16x16x32_bf16 v[132:135], v[80:83], v[116:119], v[132:135]
s_and_b32 s73, s73, 7
ds_read_b128 v[64:67], v18 offset:32768
ds_read_b128 v[68:71], v18 offset:34816
v_mfma_f32_16x16x32_bf16 v[136:139], v[80:83], v[120:123], v[136:139]
s_lshl_b32 s71, s73, 19
ds_read_b128 v[72:75], v18 offset:36864
ds_read_b128 v[76:79], v18 offset:38912
v_mfma_f32_16x16x32_bf16 v[140:143], v[80:83], v[124:127], v[140:143]
s_add_u32 s71, s71, s66
ds_read_b64_tr_b16 v[36:37], v9 offset:32768
ds_read_b64_tr_b16 v[38:39], v9 offset:33792
v_mfma_f32_16x16x32_bf16 v[156:159], v[84:87], v[124:127], v[156:159]
s_lshl_b32 s73, s73, 7
ds_read_b64_tr_b16 v[40:41], v10 offset:32768
v_mfma_f32_16x16x32_bf16 v[152:155], v[84:87], v[120:123], v[152:155]
s_add_u32 s69, s73, s67
ds_read_b64_tr_b16 v[42:43], v10 offset:33792
v_mfma_f32_16x16x32_bf16 v[148:151], v[84:87], v[116:119], v[148:151]
s_add_u32 s70, s73, s68
ds_read_b64_tr_b16 v[44:45], v11 offset:32768
v_mfma_f32_16x16x32_bf16 v[144:147], v[84:87], v[112:115], v[144:147]
s_add_u32 m0, s64, 16384
ds_read_b64_tr_b16 v[46:47], v11 offset:33792
v_mfma_f32_16x16x32_bf16 v[160:163], v[88:91], v[112:115], v[160:163]
s_add_u32 s72, s71, 0
buffer_load_dwordx4 v6, s[12:15], s72 offen lds
v_mfma_f32_16x16x32_bf16 v[164:167], v[88:91], v[116:119], v[164:167]
s_add_u32 s72, s71, 31744
buffer_load_dwordx4 v6, s[12:15], s72 offen offset:1024 lds
v_mfma_f32_16x16x32_bf16 v[168:171], v[88:91], v[120:123], v[168:171]
s_add_u32 s72, s71, 63488
buffer_load_dwordx4 v7, s[12:15], s72 offen offset:2048 lds
v_mfma_f32_16x16x32_bf16 v[172:175], v[88:91], v[124:127], v[172:175]
ds_read_b64_tr_b16 v[48:49], v12 offset:32768
v_mfma_f32_16x16x32_bf16 v[188:191], v[92:95], v[124:127], v[188:191]
ds_read_b64_tr_b16 v[50:51], v12 offset:33792
v_mfma_f32_16x16x32_bf16 v[184:187], v[92:95], v[120:123], v[184:187]
ds_read_b64_tr_b16 v[52:53], v13 offset:32768
v_mfma_f32_16x16x32_bf16 v[180:183], v[92:95], v[116:119], v[180:183]
s_add_u32 s72, s71, 95232
buffer_load_dwordx4 v7, s[12:15], s72 offen offset:3072 lds
v_mfma_f32_16x16x32_bf16 v[176:179], v[92:95], v[112:115], v[176:179]
ds_read_b64_tr_b16 v[54:55], v13 offset:33792
v_mfma_f32_16x16x32_bf16 v[192:195], v[96:99], v[112:115], v[192:195]
ds_read_b64_tr_b16 v[56:57], v14 offset:32768
v_mfma_f32_16x16x32_bf16 v[196:199], v[96:99], v[116:119], v[196:199]
ds_read_b64_tr_b16 v[58:59], v14 offset:33792
v_mfma_f32_16x16x32_bf16 v[200:203], v[96:99], v[120:123], v[200:203]
ds_read_b64_tr_b16 v[60:61], v15 offset:32768
v_mfma_f32_16x16x32_bf16 v[204:207], v[96:99], v[124:127], v[204:207]
s_add_u32 m0, s63, 65536
ds_read_b64_tr_b16 v[62:63], v15 offset:33792
v_mfma_f32_16x16x32_bf16 v[220:223], v[100:103], v[124:127], v[220:223]
s_add_u32 s72, s69, 0
buffer_load_dwordx4 v4, s[4:7], s72 offen lds
v_mfma_f32_16x16x32_bf16 v[216:219], v[100:103], v[120:123], v[216:219]
buffer_store_dwordx4 v[20:23], v1, s[44:47], s80 offen sc1
v_mfma_f32_16x16x32_bf16 v[212:215], v[100:103], v[116:119], v[212:215]
v_accvgpr_read_b32 v24, a28
v_accvgpr_read_b32 v28, a29
v_mfma_f32_16x16x32_bf16 v[208:211], v[100:103], v[112:115], v[208:211]
v_accvgpr_read_b32 v25, a30
v_accvgpr_read_b32 v29, a31
v_mfma_f32_16x16x32_bf16 v[224:227], v[104:107], v[112:115], v[224:227]
s_add_u32 s72, s69, 15360
buffer_load_dwordx4 v5, s[4:7], s72 offen offset:1024 lds
v_mfma_f32_16x16x32_bf16 v[228:231], v[104:107], v[116:119], v[228:231]
s_add_u32 s80, s77, 45056
v_accvgpr_read_b32 v26, a60
v_accvgpr_read_b32 v30, a61
v_mfma_f32_16x16x32_bf16 v[232:235], v[104:107], v[120:123], v[232:235]
v_accvgpr_read_b32 v27, a62
v_accvgpr_read_b32 v31, a63
v_mfma_f32_16x16x32_bf16 v[236:239], v[104:107], v[124:127], v[236:239]
v_mul_f32 v24, s79, v24
v_mul_f32 v28, s79, v28
v_mfma_f32_16x16x32_bf16 v[252:255], v[108:111], v[124:127], v[252:255]
v_mul_f32 v25, s79, v25
v_mul_f32 v29, s79, v29
v_mfma_f32_16x16x32_bf16 v[248:251], v[108:111], v[120:123], v[248:251]
s_add_u32 s72, s69, 30720
buffer_load_dwordx4 v4, s[4:7], s72 offen offset:2048 lds
v_mfma_f32_16x16x32_bf16 v[244:247], v[108:111], v[116:119], v[244:247]
v_mul_f32 v26, s79, v26
v_mul_f32 v30, s79, v30
v_mfma_f32_16x16x32_bf16 v[240:243], v[108:111], v[112:115], v[240:243]
s_waitcnt lgkmcnt(0)
v_mul_f32 v27, s79, v27
v_mul_f32 v31, s79, v31
v_mfma_f32_16x16x32_bf16 v[128:131], v[32:35], v[64:67], v[128:131]
ds_read_b64_tr_b16 v[80:81], v8 offset:40960
ds_read_b64_tr_b16 v[82:83], v8 offset:41984
v_mfma_f32_16x16x32_bf16 v[132:135], v[32:35], v[68:71], v[132:135]
ds_read_b128 v[112:115], v19 offset:32768
ds_read_b128 v[116:119], v19 offset:34816
v_mfma_f32_16x16x32_bf16 v[136:139], v[32:35], v[72:75], v[136:139]
s_add_u32 s72, s69, 46080
buffer_load_dwordx4 v5, s[4:7], s72 offen offset:3072 lds
v_mfma_f32_16x16x32_bf16 v[140:143], v[32:35], v[76:79], v[140:143]
ds_read_b128 v[120:123], v19 offset:36864
ds_read_b128 v[124:127], v19 offset:38912
v_mfma_f32_16x16x32_bf16 v[156:159], v[36:39], v[76:79], v[156:159]
ds_read_b64_tr_b16 v[84:85], v9 offset:40960
ds_read_b64_tr_b16 v[86:87], v9 offset:41984
v_mfma_f32_16x16x32_bf16 v[152:155], v[36:39], v[72:75], v[152:155]
ds_read_b64_tr_b16 v[88:89], v10 offset:40960
v_cvt_pk_bf16_f32 v24, v24, v28
v_mfma_f32_16x16x32_bf16 v[148:151], v[36:39], v[68:71], v[148:151]
ds_read_b64_tr_b16 v[90:91], v10 offset:41984
v_cvt_pk_bf16_f32 v25, v25, v29
v_mfma_f32_16x16x32_bf16 v[144:147], v[36:39], v[64:67], v[144:147]
s_add_u32 m0, s63, 69632
ds_read_b64_tr_b16 v[92:93], v11 offset:40960
v_cvt_pk_bf16_f32 v26, v26, v30
v_mfma_f32_16x16x32_bf16 v[160:163], v[40:43], v[64:67], v[160:163]
s_add_u32 s72, s70, 0
buffer_load_dwordx4 v4, s[4:7], s72 offen lds
v_mfma_f32_16x16x32_bf16 v[164:167], v[40:43], v[68:71], v[164:167]
ds_read_b64_tr_b16 v[94:95], v11 offset:41984
v_cvt_pk_bf16_f32 v27, v27, v31
v_mfma_f32_16x16x32_bf16 v[168:171], v[40:43], v[72:75], v[168:171]
ds_read_b64_tr_b16 v[96:97], v12 offset:40960
v_mfma_f32_16x16x32_bf16 v[172:175], v[40:43], v[76:79], v[172:175]
ds_read_b64_tr_b16 v[98:99], v12 offset:41984
v_mfma_f32_16x16x32_bf16 v[188:191], v[44:47], v[76:79], v[188:191]
s_add_u32 s72, s70, 15360
buffer_load_dwordx4 v5, s[4:7], s72 offen offset:1024 lds
v_mfma_f32_16x16x32_bf16 v[184:187], v[44:47], v[72:75], v[184:187]
ds_read_b64_tr_b16 v[100:101], v13 offset:40960
v_mfma_f32_16x16x32_bf16 v[180:183], v[44:47], v[68:71], v[180:183]
ds_read_b64_tr_b16 v[102:103], v13 offset:41984
v_mfma_f32_16x16x32_bf16 v[176:179], v[44:47], v[64:67], v[176:179]
ds_read_b64_tr_b16 v[104:105], v14 offset:40960
v_mfma_f32_16x16x32_bf16 v[192:195], v[48:51], v[64:67], v[192:195]
ds_read_b64_tr_b16 v[106:107], v14 offset:41984
v_mfma_f32_16x16x32_bf16 v[196:199], v[48:51], v[68:71], v[196:199]
s_add_u32 s72, s70, 30720
buffer_load_dwordx4 v4, s[4:7], s72 offen offset:2048 lds
v_mfma_f32_16x16x32_bf16 v[200:203], v[48:51], v[72:75], v[200:203]
ds_read_b64_tr_b16 v[108:109], v15 offset:40960
v_mfma_f32_16x16x32_bf16 v[204:207], v[48:51], v[76:79], v[204:207]
ds_read_b64_tr_b16 v[110:111], v15 offset:41984
v_mfma_f32_16x16x32_bf16 v[220:223], v[52:55], v[76:79], v[220:223]
buffer_store_dwordx4 v[24:27], v1, s[44:47], s80 offen sc1
v_mfma_f32_16x16x32_bf16 v[216:219], v[52:55], v[72:75], v[216:219]
v_accvgpr_read_b32 v20, a64
v_accvgpr_read_b32 v28, a65
v_mfma_f32_16x16x32_bf16 v[212:215], v[52:55], v[68:71], v[212:215]
s_add_u32 s72, s70, 46080
buffer_load_dwordx4 v5, s[4:7], s72 offen offset:3072 lds
v_mfma_f32_16x16x32_bf16 v[208:211], v[52:55], v[64:67], v[208:211]
v_accvgpr_read_b32 v21, a66
v_accvgpr_read_b32 v29, a67
v_mfma_f32_16x16x32_bf16 v[224:227], v[56:59], v[64:67], v[224:227]
s_add_u32 s80, s77, 1024
v_accvgpr_read_b32 v22, a96
v_accvgpr_read_b32 v30, a97
v_mfma_f32_16x16x32_bf16 v[228:231], v[56:59], v[68:71], v[228:231]
v_accvgpr_read_b32 v23, a98
v_accvgpr_read_b32 v31, a99
v_mfma_f32_16x16x32_bf16 v[232:235], v[56:59], v[72:75], v[232:235]
v_mul_f32 v20, s79, v20
v_mul_f32 v28, s79, v28
v_mfma_f32_16x16x32_bf16 v[236:239], v[56:59], v[76:79], v[236:239]
v_mul_f32 v21, s79, v21
v_mul_f32 v29, s79, v29
v_mfma_f32_16x16x32_bf16 v[252:255], v[60:63], v[76:79], v[252:255]
v_mul_f32 v22, s79, v22
v_mul_f32 v30, s79, v30
v_mfma_f32_16x16x32_bf16 v[248:251], v[60:63], v[72:75], v[248:251]
v_mul_f32 v23, s79, v23
v_mul_f32 v31, s79, v31
v_mfma_f32_16x16x32_bf16 v[244:247], v[60:63], v[68:71], v[244:247]
s_waitcnt vmcnt(14) lgkmcnt(0)
v_cvt_pk_bf16_f32 v20, v20, v28
v_cvt_pk_bf16_f32 v21, v21, v29
v_mfma_f32_16x16x32_bf16 v[240:243], v[60:63], v[64:67], v[240:243]
s_barrier
v_cvt_pk_bf16_f32 v22, v22, v30
v_cvt_pk_bf16_f32 v23, v23, v31
v_mfma_f32_16x16x32_bf16 v[128:131], v[80:83], v[112:115], v[128:131]
s_add_u32 s73, s61, 5
ds_read_b64_tr_b16 v[32:33], v8 offset:0
ds_read_b64_tr_b16 v[34:35], v8 offset:1024
v_mfma_f32_16x16x32_bf16 v[132:135], v[80:83], v[116:119], v[132:135]
s_and_b32 s73, s73, 7
ds_read_b128 v[64:67], v16 offset:0
ds_read_b128 v[68:71], v16 offset:2048
v_mfma_f32_16x16x32_bf16 v[136:139], v[80:83], v[120:123], v[136:139]
s_lshl_b32 s71, s73, 19
ds_read_b128 v[72:75], v16 offset:4096
ds_read_b128 v[76:79], v16 offset:6144
v_mfma_f32_16x16x32_bf16 v[140:143], v[80:83], v[124:127], v[140:143]
s_add_u32 s71, s71, s66
ds_read_b64_tr_b16 v[36:37], v9 offset:0
ds_read_b64_tr_b16 v[38:39], v9 offset:1024
v_mfma_f32_16x16x32_bf16 v[156:159], v[84:87], v[124:127], v[156:159]
s_lshl_b32 s73, s73, 7
ds_read_b64_tr_b16 v[40:41], v10 offset:0
v_mfma_f32_16x16x32_bf16 v[152:155], v[84:87], v[120:123], v[152:155]
s_add_u32 s69, s73, s67
ds_read_b64_tr_b16 v[42:43], v10 offset:1024
v_mfma_f32_16x16x32_bf16 v[148:151], v[84:87], v[116:119], v[148:151]
s_add_u32 s70, s73, s68
ds_read_b64_tr_b16 v[44:45], v11 offset:0
v_mfma_f32_16x16x32_bf16 v[144:147], v[84:87], v[112:115], v[144:147]
s_add_u32 m0, s64, 32768
ds_read_b64_tr_b16 v[46:47], v11 offset:1024
v_mfma_f32_16x16x32_bf16 v[160:163], v[88:91], v[112:115], v[160:163]
s_add_u32 s72, s71, 0
buffer_load_dwordx4 v6, s[12:15], s72 offen lds
v_mfma_f32_16x16x32_bf16 v[164:167], v[88:91], v[116:119], v[164:167]
s_add_u32 s72, s71, 31744
buffer_load_dwordx4 v6, s[12:15], s72 offen offset:1024 lds
v_mfma_f32_16x16x32_bf16 v[168:171], v[88:91], v[120:123], v[168:171]
s_add_u32 s72, s71, 63488
buffer_load_dwordx4 v7, s[12:15], s72 offen offset:2048 lds
v_mfma_f32_16x16x32_bf16 v[172:175], v[88:91], v[124:127], v[172:175]
ds_read_b64_tr_b16 v[48:49], v12 offset:0
v_mfma_f32_16x16x32_bf16 v[188:191], v[92:95], v[124:127], v[188:191]
ds_read_b64_tr_b16 v[50:51], v12 offset:1024
v_mfma_f32_16x16x32_bf16 v[184:187], v[92:95], v[120:123], v[184:187]
ds_read_b64_tr_b16 v[52:53], v13 offset:0
v_mfma_f32_16x16x32_bf16 v[180:183], v[92:95], v[116:119], v[180:183]
s_add_u32 s72, s71, 95232
buffer_load_dwordx4 v7, s[12:15], s72 offen offset:3072 lds
v_mfma_f32_16x16x32_bf16 v[176:179], v[92:95], v[112:115], v[176:179]
ds_read_b64_tr_b16 v[54:55], v13 offset:1024
v_mfma_f32_16x16x32_bf16 v[192:195], v[96:99], v[112:115], v[192:195]
ds_read_b64_tr_b16 v[56:57], v14 offset:0
v_mfma_f32_16x16x32_bf16 v[196:199], v[96:99], v[116:119], v[196:199]
ds_read_b64_tr_b16 v[58:59], v14 offset:1024
v_mfma_f32_16x16x32_bf16 v[200:203], v[96:99], v[120:123], v[200:203]
ds_read_b64_tr_b16 v[60:61], v15 offset:0
v_mfma_f32_16x16x32_bf16 v[204:207], v[96:99], v[124:127], v[204:207]
s_add_u32 m0, s63, 98304
ds_read_b64_tr_b16 v[62:63], v15 offset:1024
v_mfma_f32_16x16x32_bf16 v[220:223], v[100:103], v[124:127], v[220:223]
s_add_u32 s72, s69, 0
buffer_load_dwordx4 v4, s[4:7], s72 offen lds
v_mfma_f32_16x16x32_bf16 v[216:219], v[100:103], v[120:123], v[216:219]
buffer_store_dwordx4 v[20:23], v1, s[44:47], s80 offen sc1
v_mfma_f32_16x16x32_bf16 v[212:215], v[100:103], v[116:119], v[212:215]
v_accvgpr_read_b32 v24, a68
v_accvgpr_read_b32 v28, a69
v_mfma_f32_16x16x32_bf16 v[208:211], v[100:103], v[112:115], v[208:211]
v_accvgpr_read_b32 v25, a70
v_accvgpr_read_b32 v29, a71
v_mfma_f32_16x16x32_bf16 v[224:227], v[104:107], v[112:115], v[224:227]
s_add_u32 s72, s69, 15360
buffer_load_dwordx4 v5, s[4:7], s72 offen offset:1024 lds
v_mfma_f32_16x16x32_bf16 v[228:231], v[104:107], v[116:119], v[228:231]
s_add_u32 s80, s77, 5120
v_accvgpr_read_b32 v26, a100
v_accvgpr_read_b32 v30, a101
v_mfma_f32_16x16x32_bf16 v[232:235], v[104:107], v[120:123], v[232:235]
v_accvgpr_read_b32 v27, a102
v_accvgpr_read_b32 v31, a103
v_mfma_f32_16x16x32_bf16 v[236:239], v[104:107], v[124:127], v[236:239]
v_mul_f32 v24, s79, v24
v_mul_f32 v28, s79, v28
v_mfma_f32_16x16x32_bf16 v[252:255], v[108:111], v[124:127], v[252:255]
v_mul_f32 v25, s79, v25
v_mul_f32 v29, s79, v29
v_mfma_f32_16x16x32_bf16 v[248:251], v[108:111], v[120:123], v[248:251]
s_add_u32 s72, s69, 30720
buffer_load_dwordx4 v4, s[4:7], s72 offen offset:2048 lds
v_mfma_f32_16x16x32_bf16 v[244:247], v[108:111], v[116:119], v[244:247]
v_mul_f32 v26, s79, v26
v_mul_f32 v30, s79, v30
v_mfma_f32_16x16x32_bf16 v[240:243], v[108:111], v[112:115], v[240:243]
s_waitcnt lgkmcnt(0)
v_mul_f32 v27, s79, v27
v_mul_f32 v31, s79, v31
v_mfma_f32_16x16x32_bf16 v[128:131], v[32:35], v[64:67], v[128:131]
ds_read_b64_tr_b16 v[80:81], v8 offset:8192
ds_read_b64_tr_b16 v[82:83], v8 offset:9216
v_mfma_f32_16x16x32_bf16 v[132:135], v[32:35], v[68:71], v[132:135]
ds_read_b128 v[112:115], v17 offset:0
ds_read_b128 v[116:119], v17 offset:2048
v_mfma_f32_16x16x32_bf16 v[136:139], v[32:35], v[72:75], v[136:139]
s_add_u32 s72, s69, 46080
buffer_load_dwordx4 v5, s[4:7], s72 offen offset:3072 lds
v_mfma_f32_16x16x32_bf16 v[140:143], v[32:35], v[76:79], v[140:143]
ds_read_b128 v[120:123], v17 offset:4096
ds_read_b128 v[124:127], v17 offset:6144
v_mfma_f32_16x16x32_bf16 v[156:159], v[36:39], v[76:79], v[156:159]
ds_read_b64_tr_b16 v[84:85], v9 offset:8192
ds_read_b64_tr_b16 v[86:87], v9 offset:9216
v_mfma_f32_16x16x32_bf16 v[152:155], v[36:39], v[72:75], v[152:155]
ds_read_b64_tr_b16 v[88:89], v10 offset:8192
v_cvt_pk_bf16_f32 v24, v24, v28
v_mfma_f32_16x16x32_bf16 v[148:151], v[36:39], v[68:71], v[148:151]
ds_read_b64_tr_b16 v[90:91], v10 offset:9216
v_cvt_pk_bf16_f32 v25, v25, v29
v_mfma_f32_16x16x32_bf16 v[144:147], v[36:39], v[64:67], v[144:147]
s_add_u32 m0, s63, 102400
ds_read_b64_tr_b16 v[92:93], v11 offset:8192
v_cvt_pk_bf16_f32 v26, v26, v30
v_mfma_f32_16x16x32_bf16 v[160:163], v[40:43], v[64:67], v[160:163]
s_add_u32 s72, s70, 0
buffer_load_dwordx4 v4, s[4:7], s72 offen lds
v_mfma_f32_16x16x32_bf16 v[164:167], v[40:43], v[68:71], v[164:167]
ds_read_b64_tr_b16 v[94:95], v11 offset:9216
v_cvt_pk_bf16_f32 v27, v27, v31
v_mfma_f32_16x16x32_bf16 v[168:171], v[40:43], v[72:75], v[168:171]
ds_read_b64_tr_b16 v[96:97], v12 offset:8192
v_mfma_f32_16x16x32_bf16 v[172:175], v[40:43], v[76:79], v[172:175]
ds_read_b64_tr_b16 v[98:99], v12 offset:9216
v_mfma_f32_16x16x32_bf16 v[188:191], v[44:47], v[76:79], v[188:191]
s_add_u32 s72, s70, 15360
buffer_load_dwordx4 v5, s[4:7], s72 offen offset:1024 lds
v_mfma_f32_16x16x32_bf16 v[184:187], v[44:47], v[72:75], v[184:187]
ds_read_b64_tr_b16 v[100:101], v13 offset:8192
v_mfma_f32_16x16x32_bf16 v[180:183], v[44:47], v[68:71], v[180:183]
ds_read_b64_tr_b16 v[102:103], v13 offset:9216
v_mfma_f32_16x16x32_bf16 v[176:179], v[44:47], v[64:67], v[176:179]
ds_read_b64_tr_b16 v[104:105], v14 offset:8192
v_mfma_f32_16x16x32_bf16 v[192:195], v[48:51], v[64:67], v[192:195]
ds_read_b64_tr_b16 v[106:107], v14 offset:9216
v_mfma_f32_16x16x32_bf16 v[196:199], v[48:51], v[68:71], v[196:199]
s_add_u32 s72, s70, 30720
buffer_load_dwordx4 v4, s[4:7], s72 offen offset:2048 lds
v_mfma_f32_16x16x32_bf16 v[200:203], v[48:51], v[72:75], v[200:203]
ds_read_b64_tr_b16 v[108:109], v15 offset:8192
v_mfma_f32_16x16x32_bf16 v[204:207], v[48:51], v[76:79], v[204:207]
ds_read_b64_tr_b16 v[110:111], v15 offset:9216
v_mfma_f32_16x16x32_bf16 v[220:223], v[52:55], v[76:79], v[220:223]
buffer_store_dwordx4 v[24:27], v1, s[44:47], s80 offen sc1
v_mfma_f32_16x16x32_bf16 v[216:219], v[52:55], v[72:75], v[216:219]
v_accvgpr_read_b32 v20, a72
v_accvgpr_read_b32 v28, a73
v_mfma_f32_16x16x32_bf16 v[212:215], v[52:55], v[68:71], v[212:215]
s_add_u32 s72, s70, 46080
buffer_load_dwordx4 v5, s[4:7], s72 offen offset:3072 lds
v_mfma_f32_16x16x32_bf16 v[208:211], v[52:55], v[64:67], v[208:211]
v_accvgpr_read_b32 v21, a74
v_accvgpr_read_b32 v29, a75
v_mfma_f32_16x16x32_bf16 v[224:227], v[56:59], v[64:67], v[224:227]
s_add_u32 s80, s77, 9216
v_accvgpr_read_b32 v22, a104
v_accvgpr_read_b32 v30, a105
v_mfma_f32_16x16x32_bf16 v[228:231], v[56:59], v[68:71], v[228:231]
v_accvgpr_read_b32 v23, a106
v_accvgpr_read_b32 v31, a107
v_mfma_f32_16x16x32_bf16 v[232:235], v[56:59], v[72:75], v[232:235]
v_mul_f32 v20, s79, v20
v_mul_f32 v28, s79, v28
v_mfma_f32_16x16x32_bf16 v[236:239], v[56:59], v[76:79], v[236:239]
v_mul_f32 v21, s79, v21
v_mul_f32 v29, s79, v29
v_mfma_f32_16x16x32_bf16 v[252:255], v[60:63], v[76:79], v[252:255]
v_mul_f32 v22, s79, v22
v_mul_f32 v30, s79, v30
v_mfma_f32_16x16x32_bf16 v[248:251], v[60:63], v[72:75], v[248:251]
v_mul_f32 v23, s79, v23
v_mul_f32 v31, s79, v31
v_mfma_f32_16x16x32_bf16 v[244:247], v[60:63], v[68:71], v[244:247]
s_waitcnt vmcnt(14) lgkmcnt(0)
v_cvt_pk_bf16_f32 v20, v20, v28
v_cvt_pk_bf16_f32 v21, v21, v29
v_mfma_f32_16x16x32_bf16 v[240:243], v[60:63], v[64:67], v[240:243]
s_barrier
v_cvt_pk_bf16_f32 v22, v22, v30
v_cvt_pk_bf16_f32 v23, v23, v31
v_mfma_f32_16x16x32_bf16 v[128:131], v[80:83], v[112:115], v[128:131]
s_add_u32 s73, s61, 6
ds_read_b64_tr_b16 v[32:33], v8 offset:16384
ds_read_b64_tr_b16 v[34:35], v8 offset:17408
v_mfma_f32_16x16x32_bf16 v[132:135], v[80:83], v[116:119], v[132:135]
s_and_b32 s73, s73, 7
ds_read_b128 v[64:67], v18 offset:0
ds_read_b128 v[68:71], v18 offset:2048
v_mfma_f32_16x16x32_bf16 v[136:139], v[80:83], v[120:123], v[136:139]
s_lshl_b32 s71, s73, 19
ds_read_b128 v[72:75], v18 offset:4096
ds_read_b128 v[76:79], v18 offset:6144
v_mfma_f32_16x16x32_bf16 v[140:143], v[80:83], v[124:127], v[140:143]
s_add_u32 s71, s71, s66
ds_read_b64_tr_b16 v[36:37], v9 offset:16384
ds_read_b64_tr_b16 v[38:39], v9 offset:17408
v_mfma_f32_16x16x32_bf16 v[156:159], v[84:87], v[124:127], v[156:159]
s_lshl_b32 s73, s73, 7
ds_read_b64_tr_b16 v[40:41], v10 offset:16384
v_mfma_f32_16x16x32_bf16 v[152:155], v[84:87], v[120:123], v[152:155]
s_add_u32 s69, s73, s67
ds_read_b64_tr_b16 v[42:43], v10 offset:17408
v_mfma_f32_16x16x32_bf16 v[148:151], v[84:87], v[116:119], v[148:151]
s_add_u32 s70, s73, s68
ds_read_b64_tr_b16 v[44:45], v11 offset:16384
v_mfma_f32_16x16x32_bf16 v[144:147], v[84:87], v[112:115], v[144:147]
s_add_u32 m0, s64, 0
ds_read_b64_tr_b16 v[46:47], v11 offset:17408
v_mfma_f32_16x16x32_bf16 v[160:163], v[88:91], v[112:115], v[160:163]
s_add_u32 s72, s71, 0
buffer_load_dwordx4 v6, s[12:15], s72 offen lds
v_mfma_f32_16x16x32_bf16 v[164:167], v[88:91], v[116:119], v[164:167]
s_add_u32 s72, s71, 31744
buffer_load_dwordx4 v6, s[12:15], s72 offen offset:1024 lds
v_mfma_f32_16x16x32_bf16 v[168:171], v[88:91], v[120:123], v[168:171]
s_add_u32 s72, s71, 63488
buffer_load_dwordx4 v7, s[12:15], s72 offen offset:2048 lds
v_mfma_f32_16x16x32_bf16 v[172:175], v[88:91], v[124:127], v[172:175]
ds_read_b64_tr_b16 v[48:49], v12 offset:16384
v_mfma_f32_16x16x32_bf16 v[188:191], v[92:95], v[124:127], v[188:191]
ds_read_b64_tr_b16 v[50:51], v12 offset:17408
v_mfma_f32_16x16x32_bf16 v[184:187], v[92:95], v[120:123], v[184:187]
ds_read_b64_tr_b16 v[52:53], v13 offset:16384
v_mfma_f32_16x16x32_bf16 v[180:183], v[92:95], v[116:119], v[180:183]
s_add_u32 s72, s71, 95232
buffer_load_dwordx4 v7, s[12:15], s72 offen offset:3072 lds
v_mfma_f32_16x16x32_bf16 v[176:179], v[92:95], v[112:115], v[176:179]
ds_read_b64_tr_b16 v[54:55], v13 offset:17408
v_mfma_f32_16x16x32_bf16 v[192:195], v[96:99], v[112:115], v[192:195]
ds_read_b64_tr_b16 v[56:57], v14 offset:16384
v_mfma_f32_16x16x32_bf16 v[196:199], v[96:99], v[116:119], v[196:199]
ds_read_b64_tr_b16 v[58:59], v14 offset:17408
v_mfma_f32_16x16x32_bf16 v[200:203], v[96:99], v[120:123], v[200:203]
ds_read_b64_tr_b16 v[60:61], v15 offset:16384
v_mfma_f32_16x16x32_bf16 v[204:207], v[96:99], v[124:127], v[204:207]
s_add_u32 m0, s63, 131072
ds_read_b64_tr_b16 v[62:63], v15 offset:17408
v_mfma_f32_16x16x32_bf16 v[220:223], v[100:103], v[124:127], v[220:223]
s_add_u32 s72, s69, 0
buffer_load_dwordx4 v4, s[4:7], s72 offen lds
v_mfma_f32_16x16x32_bf16 v[216:219], v[100:103], v[120:123], v[216:219]
buffer_store_dwordx4 v[20:23], v1, s[44:47], s80 offen sc1
v_mfma_f32_16x16x32_bf16 v[212:215], v[100:103], v[116:119], v[212:215]
v_accvgpr_read_b32 v24, a76
v_accvgpr_read_b32 v28, a77
v_mfma_f32_16x16x32_bf16 v[208:211], v[100:103], v[112:115], v[208:211]
v_accvgpr_read_b32 v25, a78
v_accvgpr_read_b32 v29, a79
v_mfma_f32_16x16x32_bf16 v[224:227], v[104:107], v[112:115], v[224:227]
s_add_u32 s72, s69, 15360
buffer_load_dwordx4 v5, s[4:7], s72 offen offset:1024 lds
v_mfma_f32_16x16x32_bf16 v[228:231], v[104:107], v[116:119], v[228:231]
s_add_u32 s80, s77, 13312
v_accvgpr_read_b32 v26, a108
v_accvgpr_read_b32 v30, a109
v_mfma_f32_16x16x32_bf16 v[232:235], v[104:107], v[120:123], v[232:235]
v_accvgpr_read_b32 v27, a110
v_accvgpr_read_b32 v31, a111
v_mfma_f32_16x16x32_bf16 v[236:239], v[104:107], v[124:127], v[236:239]
v_mul_f32 v24, s79, v24
v_mul_f32 v28, s79, v28
v_mfma_f32_16x16x32_bf16 v[252:255], v[108:111], v[124:127], v[252:255]
v_mul_f32 v25, s79, v25
v_mul_f32 v29, s79, v29
v_mfma_f32_16x16x32_bf16 v[248:251], v[108:111], v[120:123], v[248:251]
s_add_u32 s72, s69, 30720
buffer_load_dwordx4 v4, s[4:7], s72 offen offset:2048 lds
v_mfma_f32_16x16x32_bf16 v[244:247], v[108:111], v[116:119], v[244:247]
v_mul_f32 v26, s79, v26
v_mul_f32 v30, s79, v30
v_mfma_f32_16x16x32_bf16 v[240:243], v[108:111], v[112:115], v[240:243]
s_waitcnt lgkmcnt(0)
v_mul_f32 v27, s79, v27
v_mul_f32 v31, s79, v31
v_mfma_f32_16x16x32_bf16 v[128:131], v[32:35], v[64:67], v[128:131]
ds_read_b64_tr_b16 v[80:81], v8 offset:24576
ds_read_b64_tr_b16 v[82:83], v8 offset:25600
v_mfma_f32_16x16x32_bf16 v[132:135], v[32:35], v[68:71], v[132:135]
ds_read_b128 v[112:115], v19 offset:0
ds_read_b128 v[116:119], v19 offset:2048
v_mfma_f32_16x16x32_bf16 v[136:139], v[32:35], v[72:75], v[136:139]
s_add_u32 s72, s69, 46080
buffer_load_dwordx4 v5, s[4:7], s72 offen offset:3072 lds
v_mfma_f32_16x16x32_bf16 v[140:143], v[32:35], v[76:79], v[140:143]
ds_read_b128 v[120:123], v19 offset:4096
ds_read_b128 v[124:127], v19 offset:6144
v_mfma_f32_16x16x32_bf16 v[156:159], v[36:39], v[76:79], v[156:159]
ds_read_b64_tr_b16 v[84:85], v9 offset:24576
ds_read_b64_tr_b16 v[86:87], v9 offset:25600
v_mfma_f32_16x16x32_bf16 v[152:155], v[36:39], v[72:75], v[152:155]
ds_read_b64_tr_b16 v[88:89], v10 offset:24576
v_cvt_pk_bf16_f32 v24, v24, v28
v_mfma_f32_16x16x32_bf16 v[148:151], v[36:39], v[68:71], v[148:151]
ds_read_b64_tr_b16 v[90:91], v10 offset:25600
v_cvt_pk_bf16_f32 v25, v25, v29
v_mfma_f32_16x16x32_bf16 v[144:147], v[36:39], v[64:67], v[144:147]
s_add_u32 m0, s63, 135168
ds_read_b64_tr_b16 v[92:93], v11 offset:24576
v_cvt_pk_bf16_f32 v26, v26, v30
v_mfma_f32_16x16x32_bf16 v[160:163], v[40:43], v[64:67], v[160:163]
s_add_u32 s72, s70, 0
buffer_load_dwordx4 v4, s[4:7], s72 offen lds
v_mfma_f32_16x16x32_bf16 v[164:167], v[40:43], v[68:71], v[164:167]
ds_read_b64_tr_b16 v[94:95], v11 offset:25600
v_cvt_pk_bf16_f32 v27, v27, v31
v_mfma_f32_16x16x32_bf16 v[168:171], v[40:43], v[72:75], v[168:171]
ds_read_b64_tr_b16 v[96:97], v12 offset:24576
v_mfma_f32_16x16x32_bf16 v[172:175], v[40:43], v[76:79], v[172:175]
ds_read_b64_tr_b16 v[98:99], v12 offset:25600
v_mfma_f32_16x16x32_bf16 v[188:191], v[44:47], v[76:79], v[188:191]
s_add_u32 s72, s70, 15360
buffer_load_dwordx4 v5, s[4:7], s72 offen offset:1024 lds
v_mfma_f32_16x16x32_bf16 v[184:187], v[44:47], v[72:75], v[184:187]
ds_read_b64_tr_b16 v[100:101], v13 offset:24576
v_mfma_f32_16x16x32_bf16 v[180:183], v[44:47], v[68:71], v[180:183]
ds_read_b64_tr_b16 v[102:103], v13 offset:25600
v_mfma_f32_16x16x32_bf16 v[176:179], v[44:47], v[64:67], v[176:179]
ds_read_b64_tr_b16 v[104:105], v14 offset:24576
v_mfma_f32_16x16x32_bf16 v[192:195], v[48:51], v[64:67], v[192:195]
ds_read_b64_tr_b16 v[106:107], v14 offset:25600
v_mfma_f32_16x16x32_bf16 v[196:199], v[48:51], v[68:71], v[196:199]
s_add_u32 s72, s70, 30720
buffer_load_dwordx4 v4, s[4:7], s72 offen offset:2048 lds
v_mfma_f32_16x16x32_bf16 v[200:203], v[48:51], v[72:75], v[200:203]
ds_read_b64_tr_b16 v[108:109], v15 offset:24576
v_mfma_f32_16x16x32_bf16 v[204:207], v[48:51], v[76:79], v[204:207]
ds_read_b64_tr_b16 v[110:111], v15 offset:25600
v_mfma_f32_16x16x32_bf16 v[220:223], v[52:55], v[76:79], v[220:223]
buffer_store_dwordx4 v[24:27], v1, s[44:47], s80 offen sc1
v_mfma_f32_16x16x32_bf16 v[216:219], v[52:55], v[72:75], v[216:219]
v_accvgpr_read_b32 v20, a80
v_accvgpr_read_b32 v28, a81
v_mfma_f32_16x16x32_bf16 v[212:215], v[52:55], v[68:71], v[212:215]
s_add_u32 s72, s70, 46080
buffer_load_dwordx4 v5, s[4:7], s72 offen offset:3072 lds
v_mfma_f32_16x16x32_bf16 v[208:211], v[52:55], v[64:67], v[208:211]
v_accvgpr_read_b32 v21, a82
v_accvgpr_read_b32 v29, a83
v_mfma_f32_16x16x32_bf16 v[224:227], v[56:59], v[64:67], v[224:227]
s_add_u32 s80, s77, 33792
v_accvgpr_read_b32 v22, a112
v_accvgpr_read_b32 v30, a113
v_mfma_f32_16x16x32_bf16 v[228:231], v[56:59], v[68:71], v[228:231]
v_accvgpr_read_b32 v23, a114
v_accvgpr_read_b32 v31, a115
v_mfma_f32_16x16x32_bf16 v[232:235], v[56:59], v[72:75], v[232:235]
v_mul_f32 v20, s79, v20
v_mul_f32 v28, s79, v28
v_mfma_f32_16x16x32_bf16 v[236:239], v[56:59], v[76:79], v[236:239]
v_mul_f32 v21, s79, v21
v_mul_f32 v29, s79, v29
v_mfma_f32_16x16x32_bf16 v[252:255], v[60:63], v[76:79], v[252:255]
v_mul_f32 v22, s79, v22
v_mul_f32 v30, s79, v30
v_mfma_f32_16x16x32_bf16 v[248:251], v[60:63], v[72:75], v[248:251]
v_mul_f32 v23, s79, v23
v_mul_f32 v31, s79, v31
v_mfma_f32_16x16x32_bf16 v[244:247], v[60:63], v[68:71], v[244:247]
s_waitcnt vmcnt(14) lgkmcnt(0)
v_cvt_pk_bf16_f32 v20, v20, v28
v_cvt_pk_bf16_f32 v21, v21, v29
v_mfma_f32_16x16x32_bf16 v[240:243], v[60:63], v[64:67], v[240:243]
s_barrier
v_cvt_pk_bf16_f32 v22, v22, v30
v_cvt_pk_bf16_f32 v23, v23, v31
v_mfma_f32_16x16x32_bf16 v[128:131], v[80:83], v[112:115], v[128:131]
s_add_u32 s73, s61, 7
ds_read_b64_tr_b16 v[32:33], v8 offset:32768
ds_read_b64_tr_b16 v[34:35], v8 offset:33792
v_mfma_f32_16x16x32_bf16 v[132:135], v[80:83], v[116:119], v[132:135]
s_and_b32 s73, s73, 7
ds_read_b128 v[64:67], v18 offset:32768
ds_read_b128 v[68:71], v18 offset:34816
v_mfma_f32_16x16x32_bf16 v[136:139], v[80:83], v[120:123], v[136:139]
s_lshl_b32 s71, s73, 19
ds_read_b128 v[72:75], v18 offset:36864
ds_read_b128 v[76:79], v18 offset:38912
v_mfma_f32_16x16x32_bf16 v[140:143], v[80:83], v[124:127], v[140:143]
s_add_u32 s71, s71, s66
ds_read_b64_tr_b16 v[36:37], v9 offset:32768
ds_read_b64_tr_b16 v[38:39], v9 offset:33792
v_mfma_f32_16x16x32_bf16 v[156:159], v[84:87], v[124:127], v[156:159]
s_lshl_b32 s73, s73, 7
ds_read_b64_tr_b16 v[40:41], v10 offset:32768
v_mfma_f32_16x16x32_bf16 v[152:155], v[84:87], v[120:123], v[152:155]
s_add_u32 s69, s73, s67
ds_read_b64_tr_b16 v[42:43], v10 offset:33792
v_mfma_f32_16x16x32_bf16 v[148:151], v[84:87], v[116:119], v[148:151]
s_add_u32 s70, s73, s68
ds_read_b64_tr_b16 v[44:45], v11 offset:32768
v_mfma_f32_16x16x32_bf16 v[144:147], v[84:87], v[112:115], v[144:147]
s_add_u32 m0, s64, 16384
ds_read_b64_tr_b16 v[46:47], v11 offset:33792
v_mfma_f32_16x16x32_bf16 v[160:163], v[88:91], v[112:115], v[160:163]
s_add_u32 s72, s71, 0
buffer_load_dwordx4 v6, s[12:15], s72 offen lds
v_mfma_f32_16x16x32_bf16 v[164:167], v[88:91], v[116:119], v[164:167]
s_add_u32 s72, s71, 31744
buffer_load_dwordx4 v6, s[12:15], s72 offen offset:1024 lds
v_mfma_f32_16x16x32_bf16 v[168:171], v[88:91], v[120:123], v[168:171]
s_add_u32 s72, s71, 63488
buffer_load_dwordx4 v7, s[12:15], s72 offen offset:2048 lds
v_mfma_f32_16x16x32_bf16 v[172:175], v[88:91], v[124:127], v[172:175]
ds_read_b64_tr_b16 v[48:49], v12 offset:32768
v_mfma_f32_16x16x32_bf16 v[188:191], v[92:95], v[124:127], v[188:191]
ds_read_b64_tr_b16 v[50:51], v12 offset:33792
v_mfma_f32_16x16x32_bf16 v[184:187], v[92:95], v[120:123], v[184:187]
ds_read_b64_tr_b16 v[52:53], v13 offset:32768
v_mfma_f32_16x16x32_bf16 v[180:183], v[92:95], v[116:119], v[180:183]
s_add_u32 s72, s71, 95232
buffer_load_dwordx4 v7, s[12:15], s72 offen offset:3072 lds
v_mfma_f32_16x16x32_bf16 v[176:179], v[92:95], v[112:115], v[176:179]
ds_read_b64_tr_b16 v[54:55], v13 offset:33792
v_mfma_f32_16x16x32_bf16 v[192:195], v[96:99], v[112:115], v[192:195]
ds_read_b64_tr_b16 v[56:57], v14 offset:32768
v_mfma_f32_16x16x32_bf16 v[196:199], v[96:99], v[116:119], v[196:199]
ds_read_b64_tr_b16 v[58:59], v14 offset:33792
v_mfma_f32_16x16x32_bf16 v[200:203], v[96:99], v[120:123], v[200:203]
ds_read_b64_tr_b16 v[60:61], v15 offset:32768
v_mfma_f32_16x16x32_bf16 v[204:207], v[96:99], v[124:127], v[204:207]
s_add_u32 m0, s63, 65536
ds_read_b64_tr_b16 v[62:63], v15 offset:33792
v_mfma_f32_16x16x32_bf16 v[220:223], v[100:103], v[124:127], v[220:223]
s_add_u32 s72, s69, 0
buffer_load_dwordx4 v4, s[4:7], s72 offen lds
v_mfma_f32_16x16x32_bf16 v[216:219], v[100:103], v[120:123], v[216:219]
buffer_store_dwordx4 v[20:23], v1, s[44:47], s80 offen sc1
v_mfma_f32_16x16x32_bf16 v[212:215], v[100:103], v[116:119], v[212:215]
v_accvgpr_read_b32 v24, a84
v_accvgpr_read_b32 v28, a85
v_mfma_f32_16x16x32_bf16 v[208:211], v[100:103], v[112:115], v[208:211]
v_accvgpr_read_b32 v25, a86
v_accvgpr_read_b32 v29, a87
v_mfma_f32_16x16x32_bf16 v[224:227], v[104:107], v[112:115], v[224:227]
s_add_u32 s72, s69, 15360
buffer_load_dwordx4 v5, s[4:7], s72 offen offset:1024 lds
v_mfma_f32_16x16x32_bf16 v[228:231], v[104:107], v[116:119], v[228:231]
s_add_u32 s80, s77, 37888
v_accvgpr_read_b32 v26, a116
v_accvgpr_read_b32 v30, a117
v_mfma_f32_16x16x32_bf16 v[232:235], v[104:107], v[120:123], v[232:235]
v_accvgpr_read_b32 v27, a118
v_accvgpr_read_b32 v31, a119
v_mfma_f32_16x16x32_bf16 v[236:239], v[104:107], v[124:127], v[236:239]
v_mul_f32 v24, s79, v24
v_mul_f32 v28, s79, v28
v_mfma_f32_16x16x32_bf16 v[252:255], v[108:111], v[124:127], v[252:255]
v_mul_f32 v25, s79, v25
v_mul_f32 v29, s79, v29
v_mfma_f32_16x16x32_bf16 v[248:251], v[108:111], v[120:123], v[248:251]
s_add_u32 s72, s69, 30720
buffer_load_dwordx4 v4, s[4:7], s72 offen offset:2048 lds
v_mfma_f32_16x16x32_bf16 v[244:247], v[108:111], v[116:119], v[244:247]
v_mul_f32 v26, s79, v26
v_mul_f32 v30, s79, v30
v_mfma_f32_16x16x32_bf16 v[240:243], v[108:111], v[112:115], v[240:243]
s_waitcnt lgkmcnt(0)
v_mul_f32 v27, s79, v27
v_mul_f32 v31, s79, v31
v_mfma_f32_16x16x32_bf16 v[128:131], v[32:35], v[64:67], v[128:131]
ds_read_b64_tr_b16 v[80:81], v8 offset:40960
ds_read_b64_tr_b16 v[82:83], v8 offset:41984
v_mfma_f32_16x16x32_bf16 v[132:135], v[32:35], v[68:71], v[132:135]
ds_read_b128 v[112:115], v19 offset:32768
ds_read_b128 v[116:119], v19 offset:34816
v_mfma_f32_16x16x32_bf16 v[136:139], v[32:35], v[72:75], v[136:139]
s_add_u32 s72, s69, 46080
buffer_load_dwordx4 v5, s[4:7], s72 offen offset:3072 lds
v_mfma_f32_16x16x32_bf16 v[140:143], v[32:35], v[76:79], v[140:143]
ds_read_b128 v[120:123], v19 offset:36864
ds_read_b128 v[124:127], v19 offset:38912
v_mfma_f32_16x16x32_bf16 v[156:159], v[36:39], v[76:79], v[156:159]
ds_read_b64_tr_b16 v[84:85], v9 offset:40960
ds_read_b64_tr_b16 v[86:87], v9 offset:41984
v_mfma_f32_16x16x32_bf16 v[152:155], v[36:39], v[72:75], v[152:155]
ds_read_b64_tr_b16 v[88:89], v10 offset:40960
v_cvt_pk_bf16_f32 v24, v24, v28
v_mfma_f32_16x16x32_bf16 v[148:151], v[36:39], v[68:71], v[148:151]
ds_read_b64_tr_b16 v[90:91], v10 offset:41984
v_cvt_pk_bf16_f32 v25, v25, v29
v_mfma_f32_16x16x32_bf16 v[144:147], v[36:39], v[64:67], v[144:147]
s_add_u32 m0, s63, 69632
ds_read_b64_tr_b16 v[92:93], v11 offset:40960
v_cvt_pk_bf16_f32 v26, v26, v30
v_mfma_f32_16x16x32_bf16 v[160:163], v[40:43], v[64:67], v[160:163]
s_add_u32 s72, s70, 0
buffer_load_dwordx4 v4, s[4:7], s72 offen lds
v_mfma_f32_16x16x32_bf16 v[164:167], v[40:43], v[68:71], v[164:167]
ds_read_b64_tr_b16 v[94:95], v11 offset:41984
v_cvt_pk_bf16_f32 v27, v27, v31
v_mfma_f32_16x16x32_bf16 v[168:171], v[40:43], v[72:75], v[168:171]
ds_read_b64_tr_b16 v[96:97], v12 offset:40960
v_mfma_f32_16x16x32_bf16 v[172:175], v[40:43], v[76:79], v[172:175]
ds_read_b64_tr_b16 v[98:99], v12 offset:41984
v_mfma_f32_16x16x32_bf16 v[188:191], v[44:47], v[76:79], v[188:191]
s_add_u32 s72, s70, 15360
buffer_load_dwordx4 v5, s[4:7], s72 offen offset:1024 lds
v_mfma_f32_16x16x32_bf16 v[184:187], v[44:47], v[72:75], v[184:187]
ds_read_b64_tr_b16 v[100:101], v13 offset:40960
v_mfma_f32_16x16x32_bf16 v[180:183], v[44:47], v[68:71], v[180:183]
ds_read_b64_tr_b16 v[102:103], v13 offset:41984
v_mfma_f32_16x16x32_bf16 v[176:179], v[44:47], v[64:67], v[176:179]
ds_read_b64_tr_b16 v[104:105], v14 offset:40960
v_mfma_f32_16x16x32_bf16 v[192:195], v[48:51], v[64:67], v[192:195]
ds_read_b64_tr_b16 v[106:107], v14 offset:41984
v_mfma_f32_16x16x32_bf16 v[196:199], v[48:51], v[68:71], v[196:199]
s_add_u32 s72, s70, 30720
buffer_load_dwordx4 v4, s[4:7], s72 offen offset:2048 lds
v_mfma_f32_16x16x32_bf16 v[200:203], v[48:51], v[72:75], v[200:203]
ds_read_b64_tr_b16 v[108:109], v15 offset:40960
v_mfma_f32_16x16x32_bf16 v[204:207], v[48:51], v[76:79], v[204:207]
ds_read_b64_tr_b16 v[110:111], v15 offset:41984
v_mfma_f32_16x16x32_bf16 v[220:223], v[52:55], v[76:79], v[220:223]
buffer_store_dwordx4 v[24:27], v1, s[44:47], s80 offen sc1
v_mfma_f32_16x16x32_bf16 v[216:219], v[52:55], v[72:75], v[216:219]
v_accvgpr_read_b32 v20, a88
v_accvgpr_read_b32 v28, a89
v_mfma_f32_16x16x32_bf16 v[212:215], v[52:55], v[68:71], v[212:215]
s_add_u32 s72, s70, 46080
buffer_load_dwordx4 v5, s[4:7], s72 offen offset:3072 lds
v_mfma_f32_16x16x32_bf16 v[208:211], v[52:55], v[64:67], v[208:211]
v_accvgpr_read_b32 v21, a90
v_accvgpr_read_b32 v29, a91
v_mfma_f32_16x16x32_bf16 v[224:227], v[56:59], v[64:67], v[224:227]
s_add_u32 s80, s77, 41984
v_accvgpr_read_b32 v22, a120
v_accvgpr_read_b32 v30, a121
v_mfma_f32_16x16x32_bf16 v[228:231], v[56:59], v[68:71], v[228:231]
v_accvgpr_read_b32 v23, a122
v_accvgpr_read_b32 v31, a123
v_mfma_f32_16x16x32_bf16 v[232:235], v[56:59], v[72:75], v[232:235]
v_mul_f32 v20, s79, v20
v_mul_f32 v28, s79, v28
v_mfma_f32_16x16x32_bf16 v[236:239], v[56:59], v[76:79], v[236:239]
v_mul_f32 v21, s79, v21
v_mul_f32 v29, s79, v29
v_mfma_f32_16x16x32_bf16 v[252:255], v[60:63], v[76:79], v[252:255]
v_mul_f32 v22, s79, v22
v_mul_f32 v30, s79, v30
v_mfma_f32_16x16x32_bf16 v[248:251], v[60:63], v[72:75], v[248:251]
v_mul_f32 v23, s79, v23
v_mul_f32 v31, s79, v31
v_mfma_f32_16x16x32_bf16 v[244:247], v[60:63], v[68:71], v[244:247]
s_waitcnt vmcnt(14) lgkmcnt(0)
v_cvt_pk_bf16_f32 v20, v20, v28
v_cvt_pk_bf16_f32 v21, v21, v29
v_mfma_f32_16x16x32_bf16 v[240:243], v[60:63], v[64:67], v[240:243]
s_barrier
v_cvt_pk_bf16_f32 v22, v22, v30
v_cvt_pk_bf16_f32 v23, v23, v31
v_mfma_f32_16x16x32_bf16 v[128:131], v[80:83], v[112:115], v[128:131]
s_add_u32 s73, s61, 8
ds_read_b64_tr_b16 v[32:33], v8 offset:0
ds_read_b64_tr_b16 v[34:35], v8 offset:1024
v_mfma_f32_16x16x32_bf16 v[132:135], v[80:83], v[116:119], v[132:135]
s_and_b32 s73, s73, 7
ds_read_b128 v[64:67], v16 offset:0
ds_read_b128 v[68:71], v16 offset:2048
v_mfma_f32_16x16x32_bf16 v[136:139], v[80:83], v[120:123], v[136:139]
s_or_b32 s73, s73, 8
ds_read_b128 v[72:75], v16 offset:4096
ds_read_b128 v[76:79], v16 offset:6144
v_mfma_f32_16x16x32_bf16 v[140:143], v[80:83], v[124:127], v[140:143]
s_lshl_b32 s71, s73, 19
ds_read_b64_tr_b16 v[36:37], v9 offset:0
ds_read_b64_tr_b16 v[38:39], v9 offset:1024
v_mfma_f32_16x16x32_bf16 v[156:159], v[84:87], v[124:127], v[156:159]
s_add_u32 s71, s71, s66
ds_read_b64_tr_b16 v[40:41], v10 offset:0
v_mfma_f32_16x16x32_bf16 v[152:155], v[84:87], v[120:123], v[152:155]
s_lshl_b32 s73, s73, 7
ds_read_b64_tr_b16 v[42:43], v10 offset:1024
v_mfma_f32_16x16x32_bf16 v[148:151], v[84:87], v[116:119], v[148:151]
s_add_u32 s69, s73, s67
ds_read_b64_tr_b16 v[44:45], v11 offset:0
v_mfma_f32_16x16x32_bf16 v[144:147], v[84:87], v[112:115], v[144:147]
s_add_u32 s70, s73, s68
ds_read_b64_tr_b16 v[46:47], v11 offset:1024
v_mfma_f32_16x16x32_bf16 v[160:163], v[88:91], v[112:115], v[160:163]
s_add_u32 m0, s64, 32768
ds_read_b64_tr_b16 v[48:49], v12 offset:0
v_mfma_f32_16x16x32_bf16 v[164:167], v[88:91], v[116:119], v[164:167]
s_add_u32 s72, s71, 0
buffer_load_dwordx4 v6, s[12:15], s72 offen lds
v_mfma_f32_16x16x32_bf16 v[168:171], v[88:91], v[120:123], v[168:171]
s_add_u32 s72, s71, 31744
buffer_load_dwordx4 v6, s[12:15], s72 offen offset:1024 lds
v_mfma_f32_16x16x32_bf16 v[172:175], v[88:91], v[124:127], v[172:175]
s_add_u32 s72, s71, 63488
buffer_load_dwordx4 v7, s[12:15], s72 offen offset:2048 lds
v_mfma_f32_16x16x32_bf16 v[188:191], v[92:95], v[124:127], v[188:191]
ds_read_b64_tr_b16 v[50:51], v12 offset:1024
v_mfma_f32_16x16x32_bf16 v[184:187], v[92:95], v[120:123], v[184:187]
ds_read_b64_tr_b16 v[52:53], v13 offset:0
v_mfma_f32_16x16x32_bf16 v[180:183], v[92:95], v[116:119], v[180:183]
s_add_u32 s72, s71, 95232
buffer_load_dwordx4 v7, s[12:15], s72 offen offset:3072 lds
v_mfma_f32_16x16x32_bf16 v[176:179], v[92:95], v[112:115], v[176:179]
ds_read_b64_tr_b16 v[54:55], v13 offset:1024
v_mfma_f32_16x16x32_bf16 v[192:195], v[96:99], v[112:115], v[192:195]
ds_read_b64_tr_b16 v[56:57], v14 offset:0
v_mfma_f32_16x16x32_bf16 v[196:199], v[96:99], v[116:119], v[196:199]
ds_read_b64_tr_b16 v[58:59], v14 offset:1024
v_mfma_f32_16x16x32_bf16 v[200:203], v[96:99], v[120:123], v[200:203]
ds_read_b64_tr_b16 v[60:61], v15 offset:0
v_mfma_f32_16x16x32_bf16 v[204:207], v[96:99], v[124:127], v[204:207]
s_add_u32 m0, s63, 98304
ds_read_b64_tr_b16 v[62:63], v15 offset:1024
v_mfma_f32_16x16x32_bf16 v[220:223], v[100:103], v[124:127], v[220:223]
s_add_u32 s72, s69, 0
buffer_load_dwordx4 v4, s[4:7], s72 offen lds
v_mfma_f32_16x16x32_bf16 v[216:219], v[100:103], v[120:123], v[216:219]
buffer_store_dwordx4 v[20:23], v1, s[44:47], s80 offen sc1
v_mfma_f32_16x16x32_bf16 v[212:215], v[100:103], v[116:119], v[212:215]
v_accvgpr_read_b32 v24, a92
v_accvgpr_read_b32 v28, a93
v_mfma_f32_16x16x32_bf16 v[208:211], v[100:103], v[112:115], v[208:211]
v_accvgpr_read_b32 v25, a94
v_accvgpr_read_b32 v29, a95
v_mfma_f32_16x16x32_bf16 v[224:227], v[104:107], v[112:115], v[224:227]
s_add_u32 s72, s69, 15360
buffer_load_dwordx4 v5, s[4:7], s72 offen offset:1024 lds
v_mfma_f32_16x16x32_bf16 v[228:231], v[104:107], v[116:119], v[228:231]
s_add_u32 s80, s77, 46080
v_accvgpr_read_b32 v26, a124
v_accvgpr_read_b32 v30, a125
v_mfma_f32_16x16x32_bf16 v[232:235], v[104:107], v[120:123], v[232:235]
v_accvgpr_read_b32 v27, a126
v_accvgpr_read_b32 v31, a127
v_mfma_f32_16x16x32_bf16 v[236:239], v[104:107], v[124:127], v[236:239]
v_mul_f32 v24, s79, v24
v_mul_f32 v28, s79, v28
v_mfma_f32_16x16x32_bf16 v[252:255], v[108:111], v[124:127], v[252:255]
v_mul_f32 v25, s79, v25
v_mul_f32 v29, s79, v29
v_mfma_f32_16x16x32_bf16 v[248:251], v[108:111], v[120:123], v[248:251]
s_add_u32 s72, s69, 30720
buffer_load_dwordx4 v4, s[4:7], s72 offen offset:2048 lds
v_mfma_f32_16x16x32_bf16 v[244:247], v[108:111], v[116:119], v[244:247]
v_mul_f32 v26, s79, v26
v_mul_f32 v30, s79, v30
v_mfma_f32_16x16x32_bf16 v[240:243], v[108:111], v[112:115], v[240:243]
s_waitcnt lgkmcnt(0)
v_mul_f32 v27, s79, v27
v_mul_f32 v31, s79, v31
v_mfma_f32_16x16x32_bf16 v[128:131], v[32:35], v[64:67], v[128:131]
ds_read_b64_tr_b16 v[80:81], v8 offset:8192
ds_read_b64_tr_b16 v[82:83], v8 offset:9216
v_mfma_f32_16x16x32_bf16 v[132:135], v[32:35], v[68:71], v[132:135]
ds_read_b128 v[112:115], v17 offset:0
ds_read_b128 v[116:119], v17 offset:2048
v_mfma_f32_16x16x32_bf16 v[136:139], v[32:35], v[72:75], v[136:139]
s_add_u32 s72, s69, 46080
buffer_load_dwordx4 v5, s[4:7], s72 offen offset:3072 lds
v_mfma_f32_16x16x32_bf16 v[140:143], v[32:35], v[76:79], v[140:143]
ds_read_b128 v[120:123], v17 offset:4096
ds_read_b128 v[124:127], v17 offset:6144
v_mfma_f32_16x16x32_bf16 v[156:159], v[36:39], v[76:79], v[156:159]
ds_read_b64_tr_b16 v[84:85], v9 offset:8192
ds_read_b64_tr_b16 v[86:87], v9 offset:9216
v_mfma_f32_16x16x32_bf16 v[152:155], v[36:39], v[72:75], v[152:155]
ds_read_b64_tr_b16 v[88:89], v10 offset:8192
v_cvt_pk_bf16_f32 v24, v24, v28
v_mfma_f32_16x16x32_bf16 v[148:151], v[36:39], v[68:71], v[148:151]
ds_read_b64_tr_b16 v[90:91], v10 offset:9216
v_cvt_pk_bf16_f32 v25, v25, v29
v_mfma_f32_16x16x32_bf16 v[144:147], v[36:39], v[64:67], v[144:147]
s_add_u32 m0, s63, 102400
ds_read_b64_tr_b16 v[92:93], v11 offset:8192
v_cvt_pk_bf16_f32 v26, v26, v30
v_mfma_f32_16x16x32_bf16 v[160:163], v[40:43], v[64:67], v[160:163]
s_add_u32 s72, s70, 0
buffer_load_dwordx4 v4, s[4:7], s72 offen lds
v_mfma_f32_16x16x32_bf16 v[164:167], v[40:43], v[68:71], v[164:167]
ds_read_b64_tr_b16 v[94:95], v11 offset:9216
v_cvt_pk_bf16_f32 v27, v27, v31
v_mfma_f32_16x16x32_bf16 v[168:171], v[40:43], v[72:75], v[168:171]
ds_read_b64_tr_b16 v[96:97], v12 offset:8192
v_mfma_f32_16x16x32_bf16 v[172:175], v[40:43], v[76:79], v[172:175]
ds_read_b64_tr_b16 v[98:99], v12 offset:9216
v_mfma_f32_16x16x32_bf16 v[188:191], v[44:47], v[76:79], v[188:191]
s_add_u32 s72, s70, 15360
buffer_load_dwordx4 v5, s[4:7], s72 offen offset:1024 lds
v_mfma_f32_16x16x32_bf16 v[184:187], v[44:47], v[72:75], v[184:187]
ds_read_b64_tr_b16 v[100:101], v13 offset:8192
v_mfma_f32_16x16x32_bf16 v[180:183], v[44:47], v[68:71], v[180:183]
ds_read_b64_tr_b16 v[102:103], v13 offset:9216
v_mfma_f32_16x16x32_bf16 v[176:179], v[44:47], v[64:67], v[176:179]
ds_read_b64_tr_b16 v[104:105], v14 offset:8192
v_mfma_f32_16x16x32_bf16 v[192:195], v[48:51], v[64:67], v[192:195]
ds_read_b64_tr_b16 v[106:107], v14 offset:9216
v_mfma_f32_16x16x32_bf16 v[196:199], v[48:51], v[68:71], v[196:199]
s_add_u32 s72, s70, 30720
buffer_load_dwordx4 v4, s[4:7], s72 offen offset:2048 lds
v_mfma_f32_16x16x32_bf16 v[200:203], v[48:51], v[72:75], v[200:203]
ds_read_b64_tr_b16 v[108:109], v15 offset:8192
v_mfma_f32_16x16x32_bf16 v[204:207], v[48:51], v[76:79], v[204:207]
ds_read_b64_tr_b16 v[110:111], v15 offset:9216
v_mfma_f32_16x16x32_bf16 v[220:223], v[52:55], v[76:79], v[220:223]
buffer_store_dwordx4 v[24:27], v1, s[44:47], s80 offen sc1
v_mfma_f32_16x16x32_bf16 v[216:219], v[52:55], v[72:75], v[216:219]
v_accvgpr_read_b32 v20, a128
v_accvgpr_read_b32 v28, a129
v_mfma_f32_16x16x32_bf16 v[212:215], v[52:55], v[68:71], v[212:215]
s_add_u32 s72, s70, 46080
buffer_load_dwordx4 v5, s[4:7], s72 offen offset:3072 lds
v_mfma_f32_16x16x32_bf16 v[208:211], v[52:55], v[64:67], v[208:211]
v_accvgpr_read_b32 v21, a130
v_accvgpr_read_b32 v29, a131
v_mfma_f32_16x16x32_bf16 v[224:227], v[56:59], v[64:67], v[224:227]
s_add_u32 s80, s78, 0
v_accvgpr_read_b32 v22, a132
v_accvgpr_read_b32 v30, a133
v_mfma_f32_16x16x32_bf16 v[228:231], v[56:59], v[68:71], v[228:231]
v_accvgpr_read_b32 v23, a134
v_accvgpr_read_b32 v31, a135
v_mfma_f32_16x16x32_bf16 v[232:235], v[56:59], v[72:75], v[232:235]
v_cvt_pk_bf16_f32 v20, v20, v28
v_cvt_pk_bf16_f32 v21, v21, v29
v_mfma_f32_16x16x32_bf16 v[236:239], v[56:59], v[76:79], v[236:239]
v_cvt_pk_bf16_f32 v22, v22, v30
v_cvt_pk_bf16_f32 v23, v23, v31
v_mfma_f32_16x16x32_bf16 v[252:255], v[60:63], v[76:79], v[252:255]
buffer_store_dwordx4 v[20:23], v1, s[44:47], s80 offen sc1
v_mfma_f32_16x16x32_bf16 v[248:251], v[60:63], v[72:75], v[248:251]
v_accvgpr_read_b32 v24, a136
v_accvgpr_read_b32 v28, a137
v_mfma_f32_16x16x32_bf16 v[244:247], v[60:63], v[68:71], v[244:247]
s_waitcnt vmcnt(15) lgkmcnt(0)
v_accvgpr_read_b32 v25, a138
v_accvgpr_read_b32 v29, a139
v_mfma_f32_16x16x32_bf16 v[240:243], v[60:63], v[64:67], v[240:243]
s_barrier
v_mfma_f32_16x16x32_bf16 v[128:131], v[80:83], v[112:115], v[128:131]
s_add_u32 s73, s61, 9
ds_read_b64_tr_b16 v[32:33], v8 offset:16384
ds_read_b64_tr_b16 v[34:35], v8 offset:17408
v_mfma_f32_16x16x32_bf16 v[132:135], v[80:83], v[116:119], v[132:135]
s_and_b32 s73, s73, 7
ds_read_b128 v[64:67], v18 offset:0
ds_read_b128 v[68:71], v18 offset:2048
v_mfma_f32_16x16x32_bf16 v[136:139], v[80:83], v[120:123], v[136:139]
s_or_b32 s73, s73, 8
ds_read_b128 v[72:75], v18 offset:4096
ds_read_b128 v[76:79], v18 offset:6144
v_mfma_f32_16x16x32_bf16 v[140:143], v[80:83], v[124:127], v[140:143]
s_lshl_b32 s71, s73, 19
ds_read_b64_tr_b16 v[36:37], v9 offset:16384
ds_read_b64_tr_b16 v[38:39], v9 offset:17408
v_mfma_f32_16x16x32_bf16 v[156:159], v[84:87], v[124:127], v[156:159]
s_add_u32 s71, s71, s66
ds_read_b64_tr_b16 v[40:41], v10 offset:16384
v_mfma_f32_16x16x32_bf16 v[152:155], v[84:87], v[120:123], v[152:155]
s_lshl_b32 s73, s73, 7
ds_read_b64_tr_b16 v[42:43], v10 offset:17408
v_mfma_f32_16x16x32_bf16 v[148:151], v[84:87], v[116:119], v[148:151]
s_add_u32 s69, s73, s67
ds_read_b64_tr_b16 v[44:45], v11 offset:16384
v_mfma_f32_16x16x32_bf16 v[144:147], v[84:87], v[112:115], v[144:147]
s_add_u32 s70, s73, s68
ds_read_b64_tr_b16 v[46:47], v11 offset:17408
v_mfma_f32_16x16x32_bf16 v[160:163], v[88:91], v[112:115], v[160:163]
s_add_u32 m0, s64, 0
ds_read_b64_tr_b16 v[48:49], v12 offset:16384
v_mfma_f32_16x16x32_bf16 v[164:167], v[88:91], v[116:119], v[164:167]
s_add_u32 s72, s71, 0
buffer_load_dwordx4 v6, s[12:15], s72 offen lds
v_mfma_f32_16x16x32_bf16 v[168:171], v[88:91], v[120:123], v[168:171]
s_add_u32 s72, s71, 31744
buffer_load_dwordx4 v6, s[12:15], s72 offen offset:1024 lds
v_mfma_f32_16x16x32_bf16 v[172:175], v[88:91], v[124:127], v[172:175]
s_add_u32 s72, s71, 63488
buffer_load_dwordx4 v7, s[12:15], s72 offen offset:2048 lds
v_mfma_f32_16x16x32_bf16 v[188:191], v[92:95], v[124:127], v[188:191]
s_add_u32 s80, s78, 8192
ds_read_b64_tr_b16 v[50:51], v12 offset:17408
v_accvgpr_read_b32 v26, a140
v_mfma_f32_16x16x32_bf16 v[184:187], v[92:95], v[120:123], v[184:187]
ds_read_b64_tr_b16 v[52:53], v13 offset:16384
v_accvgpr_read_b32 v30, a141
v_mfma_f32_16x16x32_bf16 v[180:183], v[92:95], v[116:119], v[180:183]
s_add_u32 s72, s71, 95232
buffer_load_dwordx4 v7, s[12:15], s72 offen offset:3072 lds
v_mfma_f32_16x16x32_bf16 v[176:179], v[92:95], v[112:115], v[176:179]
ds_read_b64_tr_b16 v[54:55], v13 offset:17408
v_accvgpr_read_b32 v27, a142
v_mfma_f32_16x16x32_bf16 v[192:195], v[96:99], v[112:115], v[192:195]
ds_read_b64_tr_b16 v[56:57], v14 offset:16384
v_accvgpr_read_b32 v31, a143
v_mfma_f32_16x16x32_bf16 v[196:199], v[96:99], v[116:119], v[196:199]
ds_read_b64_tr_b16 v[58:59], v14 offset:17408
v_cvt_pk_bf16_f32 v24, v24, v28
v_mfma_f32_16x16x32_bf16 v[200:203], v[96:99], v[120:123], v[200:203]
ds_read_b64_tr_b16 v[60:61], v15 offset:16384
v_cvt_pk_bf16_f32 v25, v25, v29
v_mfma_f32_16x16x32_bf16 v[204:207], v[96:99], v[124:127], v[204:207]
s_add_u32 m0, s63, 131072
ds_read_b64_tr_b16 v[62:63], v15 offset:17408
v_cvt_pk_bf16_f32 v26, v26, v30
v_mfma_f32_16x16x32_bf16 v[220:223], v[100:103], v[124:127], v[220:223]
s_add_u32 s72, s69, 0
buffer_load_dwordx4 v4, s[4:7], s72 offen lds
v_mfma_f32_16x16x32_bf16 v[216:219], v[100:103], v[120:123], v[216:219]
v_cvt_pk_bf16_f32 v27, v27, v31
v_mfma_f32_16x16x32_bf16 v[212:215], v[100:103], v[116:119], v[212:215]
buffer_store_dwordx4 v[24:27], v1, s[44:47], s80 offen sc1
v_mfma_f32_16x16x32_bf16 v[208:211], v[100:103], v[112:115], v[208:211]
v_accvgpr_read_b32 v20, a144
v_accvgpr_read_b32 v28, a145
v_mfma_f32_16x16x32_bf16 v[224:227], v[104:107], v[112:115], v[224:227]
s_add_u32 s72, s69, 15360
buffer_load_dwordx4 v5, s[4:7], s72 offen offset:1024 lds
v_mfma_f32_16x16x32_bf16 v[228:231], v[104:107], v[116:119], v[228:231]
v_accvgpr_read_b32 v21, a146
v_accvgpr_read_b32 v29, a147
v_mfma_f32_16x16x32_bf16 v[232:235], v[104:107], v[120:123], v[232:235]
s_add_u32 s80, s78, 32768
v_accvgpr_read_b32 v22, a148
v_accvgpr_read_b32 v30, a149
v_mfma_f32_16x16x32_bf16 v[236:239], v[104:107], v[124:127], v[236:239]
v_accvgpr_read_b32 v23, a150
v_accvgpr_read_b32 v31, a151
v_mfma_f32_16x16x32_bf16 v[252:255], v[108:111], v[124:127], v[252:255]
v_cvt_pk_bf16_f32 v20, v20, v28
v_cvt_pk_bf16_f32 v21, v21, v29
v_mfma_f32_16x16x32_bf16 v[248:251], v[108:111], v[120:123], v[248:251]
s_add_u32 s72, s69, 30720
buffer_load_dwordx4 v4, s[4:7], s72 offen offset:2048 lds
v_mfma_f32_16x16x32_bf16 v[244:247], v[108:111], v[116:119], v[244:247]
v_cvt_pk_bf16_f32 v22, v22, v30
v_cvt_pk_bf16_f32 v23, v23, v31
v_mfma_f32_16x16x32_bf16 v[240:243], v[108:111], v[112:115], v[240:243]
s_waitcnt lgkmcnt(0)
buffer_store_dwordx4 v[20:23], v1, s[44:47], s80 offen sc1
v_mfma_f32_16x16x32_bf16 v[128:131], v[32:35], v[64:67], v[128:131]
ds_read_b64_tr_b16 v[80:81], v8 offset:24576
ds_read_b64_tr_b16 v[82:83], v8 offset:25600
v_mfma_f32_16x16x32_bf16 v[132:135], v[32:35], v[68:71], v[132:135]
ds_read_b128 v[112:115], v19 offset:0
ds_read_b128 v[116:119], v19 offset:2048
v_mfma_f32_16x16x32_bf16 v[136:139], v[32:35], v[72:75], v[136:139]
s_add_u32 s72, s69, 46080
buffer_load_dwordx4 v5, s[4:7], s72 offen offset:3072 lds
v_mfma_f32_16x16x32_bf16 v[140:143], v[32:35], v[76:79], v[140:143]
ds_read_b128 v[120:123], v19 offset:4096
ds_read_b128 v[124:127], v19 offset:6144
v_mfma_f32_16x16x32_bf16 v[156:159], v[36:39], v[76:79], v[156:159]
ds_read_b64_tr_b16 v[84:85], v9 offset:24576
ds_read_b64_tr_b16 v[86:87], v9 offset:25600
v_mfma_f32_16x16x32_bf16 v[152:155], v[36:39], v[72:75], v[152:155]
ds_read_b64_tr_b16 v[88:89], v10 offset:24576
v_accvgpr_read_b32 v24, a152
v_mfma_f32_16x16x32_bf16 v[148:151], v[36:39], v[68:71], v[148:151]
ds_read_b64_tr_b16 v[90:91], v10 offset:25600
v_accvgpr_read_b32 v28, a153
v_mfma_f32_16x16x32_bf16 v[144:147], v[36:39], v[64:67], v[144:147]
s_add_u32 m0, s63, 135168
ds_read_b64_tr_b16 v[92:93], v11 offset:24576
v_accvgpr_read_b32 v25, a154
v_mfma_f32_16x16x32_bf16 v[160:163], v[40:43], v[64:67], v[160:163]
s_add_u32 s72, s70, 0
buffer_load_dwordx4 v4, s[4:7], s72 offen lds
v_mfma_f32_16x16x32_bf16 v[164:167], v[40:43], v[68:71], v[164:167]
ds_read_b64_tr_b16 v[94:95], v11 offset:25600
v_accvgpr_read_b32 v29, a155
v_mfma_f32_16x16x32_bf16 v[168:171], v[40:43], v[72:75], v[168:171]
s_add_u32 s80, s78, 40960
ds_read_b64_tr_b16 v[96:97], v12 offset:24576
v_accvgpr_read_b32 v26, a156
v_mfma_f32_16x16x32_bf16 v[172:175], v[40:43], v[76:79], v[172:175]
ds_read_b64_tr_b16 v[98:99], v12 offset:25600
v_accvgpr_read_b32 v30, a157
v_mfma_f32_16x16x32_bf16 v[188:191], v[44:47], v[76:79], v[188:191]
s_add_u32 s72, s70, 15360
buffer_load_dwordx4 v5, s[4:7], s72 offen offset:1024 lds
v_mfma_f32_16x16x32_bf16 v[184:187], v[44:47], v[72:75], v[184:187]
ds_read_b64_tr_b16 v[100:101], v13 offset:24576
v_accvgpr_read_b32 v27, a158
v_mfma_f32_16x16x32_bf16 v[180:183], v[44:47], v[68:71], v[180:183]
ds_read_b64_tr_b16 v[102:103], v13 offset:25600
v_accvgpr_read_b32 v31, a159
v_mfma_f32_16x16x32_bf16 v[176:179], v[44:47], v[64:67], v[176:179]
ds_read_b64_tr_b16 v[104:105], v14 offset:24576
v_cvt_pk_bf16_f32 v24, v24, v28
v_mfma_f32_16x16x32_bf16 v[192:195], v[48:51], v[64:67], v[192:195]
ds_read_b64_tr_b16 v[106:107], v14 offset:25600
v_cvt_pk_bf16_f32 v25, v25, v29
v_mfma_f32_16x16x32_bf16 v[196:199], v[48:51], v[68:71], v[196:199]
s_add_u32 s72, s70, 30720
buffer_load_dwordx4 v4, s[4:7], s72 offen offset:2048 lds
v_mfma_f32_16x16x32_bf16 v[200:203], v[48:51], v[72:75], v[200:203]
ds_read_b64_tr_b16 v[108:109], v15 offset:24576
v_cvt_pk_bf16_f32 v26, v26, v30
v_mfma_f32_16x16x32_bf16 v[204:207], v[48:51], v[76:79], v[204:207]
ds_read_b64_tr_b16 v[110:111], v15 offset:25600
v_cvt_pk_bf16_f32 v27, v27, v31
v_mfma_f32_16x16x32_bf16 v[220:223], v[52:55], v[76:79], v[220:223]
buffer_store_dwordx4 v[24:27], v1, s[44:47], s80 offen sc1
v_mfma_f32_16x16x32_bf16 v[216:219], v[52:55], v[72:75], v[216:219]
v_accvgpr_read_b32 v20, a160
v_accvgpr_read_b32 v28, a161
v_mfma_f32_16x16x32_bf16 v[212:215], v[52:55], v[68:71], v[212:215]
s_add_u32 s72, s70, 46080
buffer_load_dwordx4 v5, s[4:7], s72 offen offset:3072 lds
v_mfma_f32_16x16x32_bf16 v[208:211], v[52:55], v[64:67], v[208:211]
v_accvgpr_read_b32 v21, a162
v_accvgpr_read_b32 v29, a163
v_mfma_f32_16x16x32_bf16 v[224:227], v[56:59], v[64:67], v[224:227]
s_add_u32 s80, s78, 1024
v_accvgpr_read_b32 v22, a164
v_accvgpr_read_b32 v30, a165
v_mfma_f32_16x16x32_bf16 v[228:231], v[56:59], v[68:71], v[228:231]
v_accvgpr_read_b32 v23, a166
v_accvgpr_read_b32 v31, a167
v_mfma_f32_16x16x32_bf16 v[232:235], v[56:59], v[72:75], v[232:235]
v_cvt_pk_bf16_f32 v20, v20, v28
v_cvt_pk_bf16_f32 v21, v21, v29
v_mfma_f32_16x16x32_bf16 v[236:239], v[56:59], v[76:79], v[236:239]
v_cvt_pk_bf16_f32 v22, v22, v30
v_cvt_pk_bf16_f32 v23, v23, v31
v_mfma_f32_16x16x32_bf16 v[252:255], v[60:63], v[76:79], v[252:255]
buffer_store_dwordx4 v[20:23], v1, s[44:47], s80 offen sc1
v_mfma_f32_16x16x32_bf16 v[248:251], v[60:63], v[72:75], v[248:251]
v_accvgpr_read_b32 v24, a168
v_accvgpr_read_b32 v28, a169
v_mfma_f32_16x16x32_bf16 v[244:247], v[60:63], v[68:71], v[244:247]
s_waitcnt vmcnt(17) lgkmcnt(0)
v_accvgpr_read_b32 v25, a170
v_accvgpr_read_b32 v29, a171
v_mfma_f32_16x16x32_bf16 v[240:243], v[60:63], v[64:67], v[240:243]
s_barrier
v_mfma_f32_16x16x32_bf16 v[128:131], v[80:83], v[112:115], v[128:131]
s_add_u32 s73, s61, 10
ds_read_b64_tr_b16 v[32:33], v8 offset:32768
ds_read_b64_tr_b16 v[34:35], v8 offset:33792
v_mfma_f32_16x16x32_bf16 v[132:135], v[80:83], v[116:119], v[132:135]
s_and_b32 s73, s73, 7
ds_read_b128 v[64:67], v18 offset:32768
ds_read_b128 v[68:71], v18 offset:34816
v_mfma_f32_16x16x32_bf16 v[136:139], v[80:83], v[120:123], v[136:139]
s_or_b32 s73, s73, 8
ds_read_b128 v[72:75], v18 offset:36864
ds_read_b128 v[76:79], v18 offset:38912
v_mfma_f32_16x16x32_bf16 v[140:143], v[80:83], v[124:127], v[140:143]
s_lshl_b32 s71, s73, 19
ds_read_b64_tr_b16 v[36:37], v9 offset:32768
ds_read_b64_tr_b16 v[38:39], v9 offset:33792
v_mfma_f32_16x16x32_bf16 v[156:159], v[84:87], v[124:127], v[156:159]
s_add_u32 s71, s71, s66
ds_read_b64_tr_b16 v[40:41], v10 offset:32768
v_mfma_f32_16x16x32_bf16 v[152:155], v[84:87], v[120:123], v[152:155]
s_lshl_b32 s73, s73, 7
ds_read_b64_tr_b16 v[42:43], v10 offset:33792
v_mfma_f32_16x16x32_bf16 v[148:151], v[84:87], v[116:119], v[148:151]
s_add_u32 s69, s73, s67
ds_read_b64_tr_b16 v[44:45], v11 offset:32768
v_mfma_f32_16x16x32_bf16 v[144:147], v[84:87], v[112:115], v[144:147]
s_add_u32 s70, s73, s68
ds_read_b64_tr_b16 v[46:47], v11 offset:33792
v_mfma_f32_16x16x32_bf16 v[160:163], v[88:91], v[112:115], v[160:163]
s_add_u32 m0, s64, 16384
ds_read_b64_tr_b16 v[48:49], v12 offset:32768
v_mfma_f32_16x16x32_bf16 v[164:167], v[88:91], v[116:119], v[164:167]
s_add_u32 s72, s71, 0
buffer_load_dwordx4 v6, s[12:15], s72 offen lds
v_mfma_f32_16x16x32_bf16 v[168:171], v[88:91], v[120:123], v[168:171]
s_add_u32 s72, s71, 31744
buffer_load_dwordx4 v6, s[12:15], s72 offen offset:1024 lds
v_mfma_f32_16x16x32_bf16 v[172:175], v[88:91], v[124:127], v[172:175]
s_add_u32 s72, s71, 63488
buffer_load_dwordx4 v7, s[12:15], s72 offen offset:2048 lds
v_mfma_f32_16x16x32_bf16 v[188:191], v[92:95], v[124:127], v[188:191]
s_add_u32 s80, s78, 9216
ds_read_b64_tr_b16 v[50:51], v12 offset:33792
v_accvgpr_read_b32 v26, a172
v_mfma_f32_16x16x32_bf16 v[184:187], v[92:95], v[120:123], v[184:187]
ds_read_b64_tr_b16 v[52:53], v13 offset:32768
v_accvgpr_read_b32 v30, a173
v_mfma_f32_16x16x32_bf16 v[180:183], v[92:95], v[116:119], v[180:183]
s_add_u32 s72, s71, 95232
buffer_load_dwordx4 v7, s[12:15], s72 offen offset:3072 lds
v_mfma_f32_16x16x32_bf16 v[176:179], v[92:95], v[112:115], v[176:179]
ds_read_b64_tr_b16 v[54:55], v13 offset:33792
v_accvgpr_read_b32 v27, a174
v_mfma_f32_16x16x32_bf16 v[192:195], v[96:99], v[112:115], v[192:195]
ds_read_b64_tr_b16 v[56:57], v14 offset:32768
v_accvgpr_read_b32 v31, a175
v_mfma_f32_16x16x32_bf16 v[196:199], v[96:99], v[116:119], v[196:199]
ds_read_b64_tr_b16 v[58:59], v14 offset:33792
v_cvt_pk_bf16_f32 v24, v24, v28
v_mfma_f32_16x16x32_bf16 v[200:203], v[96:99], v[120:123], v[200:203]
ds_read_b64_tr_b16 v[60:61], v15 offset:32768
v_cvt_pk_bf16_f32 v25, v25, v29
v_mfma_f32_16x16x32_bf16 v[204:207], v[96:99], v[124:127], v[204:207]
s_add_u32 m0, s63, 65536
ds_read_b64_tr_b16 v[62:63], v15 offset:33792
v_cvt_pk_bf16_f32 v26, v26, v30
v_mfma_f32_16x16x32_bf16 v[220:223], v[100:103], v[124:127], v[220:223]
s_add_u32 s72, s69, 0
buffer_load_dwordx4 v4, s[4:7], s72 offen lds
v_mfma_f32_16x16x32_bf16 v[216:219], v[100:103], v[120:123], v[216:219]
v_cvt_pk_bf16_f32 v27, v27, v31
v_mfma_f32_16x16x32_bf16 v[212:215], v[100:103], v[116:119], v[212:215]
buffer_store_dwordx4 v[24:27], v1, s[44:47], s80 offen sc1
v_mfma_f32_16x16x32_bf16 v[208:211], v[100:103], v[112:115], v[208:211]
v_accvgpr_read_b32 v20, a176
v_accvgpr_read_b32 v28, a177
v_mfma_f32_16x16x32_bf16 v[224:227], v[104:107], v[112:115], v[224:227]
s_add_u32 s72, s69, 15360
buffer_load_dwordx4 v5, s[4:7], s72 offen offset:1024 lds
v_mfma_f32_16x16x32_bf16 v[228:231], v[104:107], v[116:119], v[228:231]
v_accvgpr_read_b32 v21, a178
v_accvgpr_read_b32 v29, a179
v_mfma_f32_16x16x32_bf16 v[232:235], v[104:107], v[120:123], v[232:235]
s_add_u32 s80, s78, 33792
v_accvgpr_read_b32 v22, a180
v_accvgpr_read_b32 v30, a181
v_mfma_f32_16x16x32_bf16 v[236:239], v[104:107], v[124:127], v[236:239]
v_accvgpr_read_b32 v23, a182
v_accvgpr_read_b32 v31, a183
v_mfma_f32_16x16x32_bf16 v[252:255], v[108:111], v[124:127], v[252:255]
v_cvt_pk_bf16_f32 v20, v20, v28
v_cvt_pk_bf16_f32 v21, v21, v29
v_mfma_f32_16x16x32_bf16 v[248:251], v[108:111], v[120:123], v[248:251]
s_add_u32 s72, s69, 30720
buffer_load_dwordx4 v4, s[4:7], s72 offen offset:2048 lds
v_mfma_f32_16x16x32_bf16 v[244:247], v[108:111], v[116:119], v[244:247]
v_cvt_pk_bf16_f32 v22, v22, v30
v_cvt_pk_bf16_f32 v23, v23, v31
v_mfma_f32_16x16x32_bf16 v[240:243], v[108:111], v[112:115], v[240:243]
s_waitcnt lgkmcnt(0)
buffer_store_dwordx4 v[20:23], v1, s[44:47], s80 offen sc1
v_mfma_f32_16x16x32_bf16 v[128:131], v[32:35], v[64:67], v[128:131]
ds_read_b64_tr_b16 v[80:81], v8 offset:40960
ds_read_b64_tr_b16 v[82:83], v8 offset:41984
v_mfma_f32_16x16x32_bf16 v[132:135], v[32:35], v[68:71], v[132:135]
ds_read_b128 v[112:115], v19 offset:32768
ds_read_b128 v[116:119], v19 offset:34816
v_mfma_f32_16x16x32_bf16 v[136:139], v[32:35], v[72:75], v[136:139]
s_add_u32 s72, s69, 46080
buffer_load_dwordx4 v5, s[4:7], s72 offen offset:3072 lds
v_mfma_f32_16x16x32_bf16 v[140:143], v[32:35], v[76:79], v[140:143]
ds_read_b128 v[120:123], v19 offset:36864
ds_read_b128 v[124:127], v19 offset:38912
v_mfma_f32_16x16x32_bf16 v[156:159], v[36:39], v[76:79], v[156:159]
ds_read_b64_tr_b16 v[84:85], v9 offset:40960
ds_read_b64_tr_b16 v[86:87], v9 offset:41984
v_mfma_f32_16x16x32_bf16 v[152:155], v[36:39], v[72:75], v[152:155]
ds_read_b64_tr_b16 v[88:89], v10 offset:40960
v_accvgpr_read_b32 v24, a184
v_mfma_f32_16x16x32_bf16 v[148:151], v[36:39], v[68:71], v[148:151]
ds_read_b64_tr_b16 v[90:91], v10 offset:41984
v_accvgpr_read_b32 v28, a185
v_mfma_f32_16x16x32_bf16 v[144:147], v[36:39], v[64:67], v[144:147]
s_add_u32 m0, s63, 69632
ds_read_b64_tr_b16 v[92:93], v11 offset:40960
v_accvgpr_read_b32 v25, a186
v_mfma_f32_16x16x32_bf16 v[160:163], v[40:43], v[64:67], v[160:163]
s_add_u32 s72, s70, 0
buffer_load_dwordx4 v4, s[4:7], s72 offen lds
v_mfma_f32_16x16x32_bf16 v[164:167], v[40:43], v[68:71], v[164:167]
ds_read_b64_tr_b16 v[94:95], v11 offset:41984
v_accvgpr_read_b32 v29, a187
v_mfma_f32_16x16x32_bf16 v[168:171], v[40:43], v[72:75], v[168:171]
s_add_u32 s80, s78, 41984
ds_read_b64_tr_b16 v[96:97], v12 offset:40960
v_accvgpr_read_b32 v26, a188
v_mfma_f32_16x16x32_bf16 v[172:175], v[40:43], v[76:79], v[172:175]
ds_read_b64_tr_b16 v[98:99], v12 offset:41984
v_accvgpr_read_b32 v30, a189
v_mfma_f32_16x16x32_bf16 v[188:191], v[44:47], v[76:79], v[188:191]
s_add_u32 s72, s70, 15360
buffer_load_dwordx4 v5, s[4:7], s72 offen offset:1024 lds
v_mfma_f32_16x16x32_bf16 v[184:187], v[44:47], v[72:75], v[184:187]
ds_read_b64_tr_b16 v[100:101], v13 offset:40960
v_accvgpr_read_b32 v27, a190
v_mfma_f32_16x16x32_bf16 v[180:183], v[44:47], v[68:71], v[180:183]
ds_read_b64_tr_b16 v[102:103], v13 offset:41984
v_accvgpr_read_b32 v31, a191
v_mfma_f32_16x16x32_bf16 v[176:179], v[44:47], v[64:67], v[176:179]
ds_read_b64_tr_b16 v[104:105], v14 offset:40960
v_cvt_pk_bf16_f32 v24, v24, v28
v_mfma_f32_16x16x32_bf16 v[192:195], v[48:51], v[64:67], v[192:195]
ds_read_b64_tr_b16 v[106:107], v14 offset:41984
v_cvt_pk_bf16_f32 v25, v25, v29
v_mfma_f32_16x16x32_bf16 v[196:199], v[48:51], v[68:71], v[196:199]
s_add_u32 s72, s70, 30720
buffer_load_dwordx4 v4, s[4:7], s72 offen offset:2048 lds
v_mfma_f32_16x16x32_bf16 v[200:203], v[48:51], v[72:75], v[200:203]
ds_read_b64_tr_b16 v[108:109], v15 offset:40960
v_cvt_pk_bf16_f32 v26, v26, v30
v_mfma_f32_16x16x32_bf16 v[204:207], v[48:51], v[76:79], v[204:207]
ds_read_b64_tr_b16 v[110:111], v15 offset:41984
v_cvt_pk_bf16_f32 v27, v27, v31
v_mfma_f32_16x16x32_bf16 v[220:223], v[52:55], v[76:79], v[220:223]
buffer_store_dwordx4 v[24:27], v1, s[44:47], s80 offen sc1
v_mfma_f32_16x16x32_bf16 v[216:219], v[52:55], v[72:75], v[216:219]
v_accvgpr_read_b32 v20, a192
v_accvgpr_read_b32 v28, a193
v_mfma_f32_16x16x32_bf16 v[212:215], v[52:55], v[68:71], v[212:215]
s_add_u32 s72, s70, 46080
buffer_load_dwordx4 v5, s[4:7], s72 offen offset:3072 lds
v_mfma_f32_16x16x32_bf16 v[208:211], v[52:55], v[64:67], v[208:211]
v_accvgpr_read_b32 v21, a194
v_accvgpr_read_b32 v29, a195
v_mfma_f32_16x16x32_bf16 v[224:227], v[56:59], v[64:67], v[224:227]
s_add_u32 s80, s78, 2048
v_accvgpr_read_b32 v22, a196
v_accvgpr_read_b32 v30, a197
v_mfma_f32_16x16x32_bf16 v[228:231], v[56:59], v[68:71], v[228:231]
v_accvgpr_read_b32 v23, a198
v_accvgpr_read_b32 v31, a199
v_mfma_f32_16x16x32_bf16 v[232:235], v[56:59], v[72:75], v[232:235]
v_cvt_pk_bf16_f32 v20, v20, v28
v_cvt_pk_bf16_f32 v21, v21, v29
v_mfma_f32_16x16x32_bf16 v[236:239], v[56:59], v[76:79], v[236:239]
v_cvt_pk_bf16_f32 v22, v22, v30
v_cvt_pk_bf16_f32 v23, v23, v31
v_mfma_f32_16x16x32_bf16 v[252:255], v[60:63], v[76:79], v[252:255]
buffer_store_dwordx4 v[20:23], v1, s[44:47], s80 offen sc1
v_mfma_f32_16x16x32_bf16 v[248:251], v[60:63], v[72:75], v[248:251]
v_accvgpr_read_b32 v24, a200
v_accvgpr_read_b32 v28, a201
v_mfma_f32_16x16x32_bf16 v[244:247], v[60:63], v[68:71], v[244:247]
s_waitcnt vmcnt(17) lgkmcnt(0)
v_accvgpr_read_b32 v25, a202
v_accvgpr_read_b32 v29, a203
v_mfma_f32_16x16x32_bf16 v[240:243], v[60:63], v[64:67], v[240:243]
s_barrier
v_mfma_f32_16x16x32_bf16 v[128:131], v[80:83], v[112:115], v[128:131]
s_add_u32 s73, s61, 11
ds_read_b64_tr_b16 v[32:33], v8 offset:0
ds_read_b64_tr_b16 v[34:35], v8 offset:1024
v_mfma_f32_16x16x32_bf16 v[132:135], v[80:83], v[116:119], v[132:135]
s_and_b32 s73, s73, 7
ds_read_b128 v[64:67], v16 offset:0
ds_read_b128 v[68:71], v16 offset:2048
v_mfma_f32_16x16x32_bf16 v[136:139], v[80:83], v[120:123], v[136:139]
s_or_b32 s73, s73, 8
ds_read_b128 v[72:75], v16 offset:4096
ds_read_b128 v[76:79], v16 offset:6144
v_mfma_f32_16x16x32_bf16 v[140:143], v[80:83], v[124:127], v[140:143]
s_lshl_b32 s71, s73, 19
ds_read_b64_tr_b16 v[36:37], v9 offset:0
ds_read_b64_tr_b16 v[38:39], v9 offset:1024
v_mfma_f32_16x16x32_bf16 v[156:159], v[84:87], v[124:127], v[156:159]
s_add_u32 s71, s71, s66
ds_read_b64_tr_b16 v[40:41], v10 offset:0
v_mfma_f32_16x16x32_bf16 v[152:155], v[84:87], v[120:123], v[152:155]
s_lshl_b32 s73, s73, 7
ds_read_b64_tr_b16 v[42:43], v10 offset:1024
v_mfma_f32_16x16x32_bf16 v[148:151], v[84:87], v[116:119], v[148:151]
s_add_u32 s69, s73, s67
ds_read_b64_tr_b16 v[44:45], v11 offset:0
v_mfma_f32_16x16x32_bf16 v[144:147], v[84:87], v[112:115], v[144:147]
s_add_u32 s70, s73, s68
ds_read_b64_tr_b16 v[46:47], v11 offset:1024
v_mfma_f32_16x16x32_bf16 v[160:163], v[88:91], v[112:115], v[160:163]
s_add_u32 m0, s64, 32768
ds_read_b64_tr_b16 v[48:49], v12 offset:0
v_mfma_f32_16x16x32_bf16 v[164:167], v[88:91], v[116:119], v[164:167]
s_add_u32 s72, s71, 0
buffer_load_dwordx4 v6, s[12:15], s72 offen lds
v_mfma_f32_16x16x32_bf16 v[168:171], v[88:91], v[120:123], v[168:171]
s_add_u32 s72, s71, 31744
buffer_load_dwordx4 v6, s[12:15], s72 offen offset:1024 lds
v_mfma_f32_16x16x32_bf16 v[172:175], v[88:91], v[124:127], v[172:175]
s_add_u32 s72, s71, 63488
buffer_load_dwordx4 v7, s[12:15], s72 offen offset:2048 lds
v_mfma_f32_16x16x32_bf16 v[188:191], v[92:95], v[124:127], v[188:191]
s_add_u32 s80, s78, 10240
ds_read_b64_tr_b16 v[50:51], v12 offset:1024
v_accvgpr_read_b32 v26, a204
v_mfma_f32_16x16x32_bf16 v[184:187], v[92:95], v[120:123], v[184:187]
ds_read_b64_tr_b16 v[52:53], v13 offset:0
v_accvgpr_read_b32 v30, a205
v_mfma_f32_16x16x32_bf16 v[180:183], v[92:95], v[116:119], v[180:183]
s_add_u32 s72, s71, 95232
buffer_load_dwordx4 v7, s[12:15], s72 offen offset:3072 lds
v_mfma_f32_16x16x32_bf16 v[176:179], v[92:95], v[112:115], v[176:179]
ds_read_b64_tr_b16 v[54:55], v13 offset:1024
v_accvgpr_read_b32 v27, a206
v_mfma_f32_16x16x32_bf16 v[192:195], v[96:99], v[112:115], v[192:195]
ds_read_b64_tr_b16 v[56:57], v14 offset:0
v_accvgpr_read_b32 v31, a207
v_mfma_f32_16x16x32_bf16 v[196:199], v[96:99], v[116:119], v[196:199]
ds_read_b64_tr_b16 v[58:59], v14 offset:1024
v_cvt_pk_bf16_f32 v24, v24, v28
v_mfma_f32_16x16x32_bf16 v[200:203], v[96:99], v[120:123], v[200:203]
ds_read_b64_tr_b16 v[60:61], v15 offset:0
v_cvt_pk_bf16_f32 v25, v25, v29
v_mfma_f32_16x16x32_bf16 v[204:207], v[96:99], v[124:127], v[204:207]
s_add_u32 m0, s63, 98304
ds_read_b64_tr_b16 v[62:63], v15 offset:1024
v_cvt_pk_bf16_f32 v26, v26, v30
v_mfma_f32_16x16x32_bf16 v[220:223], v[100:103], v[124:127], v[220:223]
s_add_u32 s72, s69, 0
buffer_load_dwordx4 v4, s[4:7], s72 offen lds
v_mfma_f32_16x16x32_bf16 v[216:219], v[100:103], v[120:123], v[216:219]
v_cvt_pk_bf16_f32 v27, v27, v31
v_mfma_f32_16x16x32_bf16 v[212:215], v[100:103], v[116:119], v[212:215]
buffer_store_dwordx4 v[24:27], v1, s[44:47], s80 offen sc1
v_mfma_f32_16x16x32_bf16 v[208:211], v[100:103], v[112:115], v[208:211]
v_accvgpr_read_b32 v20, a208
v_accvgpr_read_b32 v28, a209
v_mfma_f32_16x16x32_bf16 v[224:227], v[104:107], v[112:115], v[224:227]
s_add_u32 s72, s69, 15360
buffer_load_dwordx4 v5, s[4:7], s72 offen offset:1024 lds
v_mfma_f32_16x16x32_bf16 v[228:231], v[104:107], v[116:119], v[228:231]
v_accvgpr_read_b32 v21, a210
v_accvgpr_read_b32 v29, a211
v_mfma_f32_16x16x32_bf16 v[232:235], v[104:107], v[120:123], v[232:235]
s_add_u32 s80, s78, 34816
v_accvgpr_read_b32 v22, a212
v_accvgpr_read_b32 v30, a213
v_mfma_f32_16x16x32_bf16 v[236:239], v[104:107], v[124:127], v[236:239]
v_accvgpr_read_b32 v23, a214
v_accvgpr_read_b32 v31, a215
v_mfma_f32_16x16x32_bf16 v[252:255], v[108:111], v[124:127], v[252:255]
v_cvt_pk_bf16_f32 v20, v20, v28
v_cvt_pk_bf16_f32 v21, v21, v29
v_mfma_f32_16x16x32_bf16 v[248:251], v[108:111], v[120:123], v[248:251]
s_add_u32 s72, s69, 30720
buffer_load_dwordx4 v4, s[4:7], s72 offen offset:2048 lds
v_mfma_f32_16x16x32_bf16 v[244:247], v[108:111], v[116:119], v[244:247]
v_cvt_pk_bf16_f32 v22, v22, v30
v_cvt_pk_bf16_f32 v23, v23, v31
v_mfma_f32_16x16x32_bf16 v[240:243], v[108:111], v[112:115], v[240:243]
s_waitcnt lgkmcnt(0)
buffer_store_dwordx4 v[20:23], v1, s[44:47], s80 offen sc1
v_mfma_f32_16x16x32_bf16 v[128:131], v[32:35], v[64:67], v[128:131]
ds_read_b64_tr_b16 v[80:81], v8 offset:8192
ds_read_b64_tr_b16 v[82:83], v8 offset:9216
v_mfma_f32_16x16x32_bf16 v[132:135], v[32:35], v[68:71], v[132:135]
ds_read_b128 v[112:115], v17 offset:0
ds_read_b128 v[116:119], v17 offset:2048
v_mfma_f32_16x16x32_bf16 v[136:139], v[32:35], v[72:75], v[136:139]
s_add_u32 s72, s69, 46080
buffer_load_dwordx4 v5, s[4:7], s72 offen offset:3072 lds
v_mfma_f32_16x16x32_bf16 v[140:143], v[32:35], v[76:79], v[140:143]
ds_read_b128 v[120:123], v17 offset:4096
ds_read_b128 v[124:127], v17 offset:6144
v_mfma_f32_16x16x32_bf16 v[156:159], v[36:39], v[76:79], v[156:159]
ds_read_b64_tr_b16 v[84:85], v9 offset:8192
ds_read_b64_tr_b16 v[86:87], v9 offset:9216
v_mfma_f32_16x16x32_bf16 v[152:155], v[36:39], v[72:75], v[152:155]
ds_read_b64_tr_b16 v[88:89], v10 offset:8192
v_accvgpr_read_b32 v24, a216
v_mfma_f32_16x16x32_bf16 v[148:151], v[36:39], v[68:71], v[148:151]
ds_read_b64_tr_b16 v[90:91], v10 offset:9216
v_accvgpr_read_b32 v28, a217
v_mfma_f32_16x16x32_bf16 v[144:147], v[36:39], v[64:67], v[144:147]
s_add_u32 m0, s63, 102400
ds_read_b64_tr_b16 v[92:93], v11 offset:8192
v_accvgpr_read_b32 v25, a218
v_mfma_f32_16x16x32_bf16 v[160:163], v[40:43], v[64:67], v[160:163]
s_add_u32 s72, s70, 0
buffer_load_dwordx4 v4, s[4:7], s72 offen lds
v_mfma_f32_16x16x32_bf16 v[164:167], v[40:43], v[68:71], v[164:167]
ds_read_b64_tr_b16 v[94:95], v11 offset:9216
v_accvgpr_read_b32 v29, a219
v_mfma_f32_16x16x32_bf16 v[168:171], v[40:43], v[72:75], v[168:171]
s_add_u32 s80, s78, 43008
ds_read_b64_tr_b16 v[96:97], v12 offset:8192
v_accvgpr_read_b32 v26, a220
v_mfma_f32_16x16x32_bf16 v[172:175], v[40:43], v[76:79], v[172:175]
ds_read_b64_tr_b16 v[98:99], v12 offset:9216
v_accvgpr_read_b32 v30, a221
v_mfma_f32_16x16x32_bf16 v[188:191], v[44:47], v[76:79], v[188:191]
s_add_u32 s72, s70, 15360
buffer_load_dwordx4 v5, s[4:7], s72 offen offset:1024 lds
v_mfma_f32_16x16x32_bf16 v[184:187], v[44:47], v[72:75], v[184:187]
ds_read_b64_tr_b16 v[100:101], v13 offset:8192
v_accvgpr_read_b32 v27, a222
v_mfma_f32_16x16x32_bf16 v[180:183], v[44:47], v[68:71], v[180:183]
ds_read_b64_tr_b16 v[102:103], v13 offset:9216
v_accvgpr_read_b32 v31, a223
v_mfma_f32_16x16x32_bf16 v[176:179], v[44:47], v[64:67], v[176:179]
ds_read_b64_tr_b16 v[104:105], v14 offset:8192
v_cvt_pk_bf16_f32 v24, v24, v28
v_mfma_f32_16x16x32_bf16 v[192:195], v[48:51], v[64:67], v[192:195]
ds_read_b64_tr_b16 v[106:107], v14 offset:9216
v_cvt_pk_bf16_f32 v25, v25, v29
v_mfma_f32_16x16x32_bf16 v[196:199], v[48:51], v[68:71], v[196:199]
s_add_u32 s72, s70, 30720
buffer_load_dwordx4 v4, s[4:7], s72 offen offset:2048 lds
v_mfma_f32_16x16x32_bf16 v[200:203], v[48:51], v[72:75], v[200:203]
ds_read_b64_tr_b16 v[108:109], v15 offset:8192
v_cvt_pk_bf16_f32 v26, v26, v30
v_mfma_f32_16x16x32_bf16 v[204:207], v[48:51], v[76:79], v[204:207]
ds_read_b64_tr_b16 v[110:111], v15 offset:9216
v_cvt_pk_bf16_f32 v27, v27, v31
v_mfma_f32_16x16x32_bf16 v[220:223], v[52:55], v[76:79], v[220:223]
buffer_store_dwordx4 v[24:27], v1, s[44:47], s80 offen sc1
v_mfma_f32_16x16x32_bf16 v[216:219], v[52:55], v[72:75], v[216:219]
v_accvgpr_read_b32 v20, a224
v_accvgpr_read_b32 v28, a225
v_mfma_f32_16x16x32_bf16 v[212:215], v[52:55], v[68:71], v[212:215]
s_add_u32 s72, s70, 46080
buffer_load_dwordx4 v5, s[4:7], s72 offen offset:3072 lds
v_mfma_f32_16x16x32_bf16 v[208:211], v[52:55], v[64:67], v[208:211]
v_accvgpr_read_b32 v21, a226
v_accvgpr_read_b32 v29, a227
v_mfma_f32_16x16x32_bf16 v[224:227], v[56:59], v[64:67], v[224:227]
s_add_u32 s80, s78, 3072
v_accvgpr_read_b32 v22, a228
v_accvgpr_read_b32 v30, a229
v_mfma_f32_16x16x32_bf16 v[228:231], v[56:59], v[68:71], v[228:231]
v_accvgpr_read_b32 v23, a230
v_accvgpr_read_b32 v31, a231
v_mfma_f32_16x16x32_bf16 v[232:235], v[56:59], v[72:75], v[232:235]
v_cvt_pk_bf16_f32 v20, v20, v28
v_cvt_pk_bf16_f32 v21, v21, v29
v_mfma_f32_16x16x32_bf16 v[236:239], v[56:59], v[76:79], v[236:239]
v_cvt_pk_bf16_f32 v22, v22, v30
v_cvt_pk_bf16_f32 v23, v23, v31
v_mfma_f32_16x16x32_bf16 v[252:255], v[60:63], v[76:79], v[252:255]
buffer_store_dwordx4 v[20:23], v1, s[44:47], s80 offen sc1
v_mfma_f32_16x16x32_bf16 v[248:251], v[60:63], v[72:75], v[248:251]
v_accvgpr_read_b32 v24, a232
v_accvgpr_read_b32 v28, a233
v_mfma_f32_16x16x32_bf16 v[244:247], v[60:63], v[68:71], v[244:247]
s_waitcnt vmcnt(17) lgkmcnt(0)
v_accvgpr_read_b32 v25, a234
v_accvgpr_read_b32 v29, a235
v_mfma_f32_16x16x32_bf16 v[240:243], v[60:63], v[64:67], v[240:243]
s_barrier
v_mfma_f32_16x16x32_bf16 v[128:131], v[80:83], v[112:115], v[128:131]
s_add_u32 s73, s61, 12
ds_read_b64_tr_b16 v[32:33], v8 offset:16384
ds_read_b64_tr_b16 v[34:35], v8 offset:17408
v_mfma_f32_16x16x32_bf16 v[132:135], v[80:83], v[116:119], v[132:135]
s_and_b32 s73, s73, 7
ds_read_b128 v[64:67], v18 offset:0
ds_read_b128 v[68:71], v18 offset:2048
v_mfma_f32_16x16x32_bf16 v[136:139], v[80:83], v[120:123], v[136:139]
s_or_b32 s73, s73, 8
v_and_b32 v2, 31, v0
v_lshlrev_b32 v2, 2, v2
v_mfma_f32_16x16x32_bf16 v[140:143], v[80:83], v[124:127], v[140:143]
s_lshl_b32 s71, s73, 19
buffer_load_dword v3, v2, s[48:51], 0 offen sc1
v_mfma_f32_16x16x32_bf16 v[156:159], v[84:87], v[124:127], v[156:159]
s_add_u32 s71, s71, s66
ds_read_b128 v[72:75], v18 offset:4096
ds_read_b128 v[76:79], v18 offset:6144
v_mfma_f32_16x16x32_bf16 v[152:155], v[84:87], v[120:123], v[152:155]
s_lshl_b32 s73, s73, 7
ds_read_b64_tr_b16 v[36:37], v9 offset:16384
ds_read_b64_tr_b16 v[38:39], v9 offset:17408
v_mfma_f32_16x16x32_bf16 v[148:151], v[84:87], v[116:119], v[148:151]
s_add_u32 s69, s73, s67
ds_read_b64_tr_b16 v[40:41], v10 offset:16384
v_mfma_f32_16x16x32_bf16 v[144:147], v[84:87], v[112:115], v[144:147]
s_add_u32 s70, s73, s68
ds_read_b64_tr_b16 v[42:43], v10 offset:17408
v_mfma_f32_16x16x32_bf16 v[160:163], v[88:91], v[112:115], v[160:163]
s_add_u32 m0, s64, 0
ds_read_b64_tr_b16 v[44:45], v11 offset:16384
v_mfma_f32_16x16x32_bf16 v[164:167], v[88:91], v[116:119], v[164:167]
s_add_u32 s72, s71, 0
buffer_load_dwordx4 v6, s[12:15], s72 offen lds
v_mfma_f32_16x16x32_bf16 v[168:171], v[88:91], v[120:123], v[168:171]
s_add_u32 s72, s71, 31744
buffer_load_dwordx4 v6, s[12:15], s72 offen offset:1024 lds
v_mfma_f32_16x16x32_bf16 v[172:175], v[88:91], v[124:127], v[172:175]
s_add_u32 s72, s71, 63488
buffer_load_dwordx4 v7, s[12:15], s72 offen offset:2048 lds
v_mfma_f32_16x16x32_bf16 v[188:191], v[92:95], v[124:127], v[188:191]
s_add_u32 s80, s78, 11264
ds_read_b64_tr_b16 v[46:47], v11 offset:17408
v_accvgpr_read_b32 v26, a236
v_mfma_f32_16x16x32_bf16 v[184:187], v[92:95], v[120:123], v[184:187]
ds_read_b64_tr_b16 v[48:49], v12 offset:16384
v_accvgpr_read_b32 v30, a237
v_mfma_f32_16x16x32_bf16 v[180:183], v[92:95], v[116:119], v[180:183]
s_add_u32 s72, s71, 95232
buffer_load_dwordx4 v7, s[12:15], s72 offen offset:3072 lds
v_mfma_f32_16x16x32_bf16 v[176:179], v[92:95], v[112:115], v[176:179]
ds_read_b64_tr_b16 v[50:51], v12 offset:17408
v_accvgpr_read_b32 v27, a238
v_mfma_f32_16x16x32_bf16 v[192:195], v[96:99], v[112:115], v[192:195]
ds_read_b64_tr_b16 v[52:53], v13 offset:16384
v_accvgpr_read_b32 v31, a239
v_mfma_f32_16x16x32_bf16 v[196:199], v[96:99], v[116:119], v[196:199]
ds_read_b64_tr_b16 v[54:55], v13 offset:17408
v_cvt_pk_bf16_f32 v24, v24, v28
v_mfma_f32_16x16x32_bf16 v[200:203], v[96:99], v[120:123], v[200:203]
ds_read_b64_tr_b16 v[56:57], v14 offset:16384
v_cvt_pk_bf16_f32 v25, v25, v29
v_mfma_f32_16x16x32_bf16 v[204:207], v[96:99], v[124:127], v[204:207]
s_add_u32 m0, s63, 131072
ds_read_b64_tr_b16 v[58:59], v14 offset:17408
v_cvt_pk_bf16_f32 v26, v26, v30
v_mfma_f32_16x16x32_bf16 v[220:223], v[100:103], v[124:127], v[220:223]
s_add_u32 s72, s69, 0
buffer_load_dwordx4 v4, s[4:7], s72 offen lds
v_mfma_f32_16x16x32_bf16 v[216:219], v[100:103], v[120:123], v[216:219]
ds_read_b64_tr_b16 v[60:61], v15 offset:16384
v_cvt_pk_bf16_f32 v27, v27, v31
v_mfma_f32_16x16x32_bf16 v[212:215], v[100:103], v[116:119], v[212:215]
ds_read_b64_tr_b16 v[62:63], v15 offset:17408
v_mfma_f32_16x16x32_bf16 v[208:211], v[100:103], v[112:115], v[208:211]
buffer_store_dwordx4 v[24:27], v1, s[44:47], s80 offen sc1
v_mfma_f32_16x16x32_bf16 v[224:227], v[104:107], v[112:115], v[224:227]
s_add_u32 s72, s69, 15360
buffer_load_dwordx4 v5, s[4:7], s72 offen offset:1024 lds
v_mfma_f32_16x16x32_bf16 v[228:231], v[104:107], v[116:119], v[228:231]
v_accvgpr_read_b32 v20, a240
v_accvgpr_read_b32 v28, a241
v_mfma_f32_16x16x32_bf16 v[232:235], v[104:107], v[120:123], v[232:235]
v_accvgpr_read_b32 v21, a242
v_accvgpr_read_b32 v29, a243
v_mfma_f32_16x16x32_bf16 v[236:239], v[104:107], v[124:127], v[236:239]
s_add_u32 s80, s78, 35840
v_accvgpr_read_b32 v22, a244
v_accvgpr_read_b32 v30, a245
v_mfma_f32_16x16x32_bf16 v[252:255], v[108:111], v[124:127], v[252:255]
v_accvgpr_read_b32 v23, a246
v_accvgpr_read_b32 v31, a247
v_mfma_f32_16x16x32_bf16 v[248:251], v[108:111], v[120:123], v[248:251]
s_add_u32 s72, s69, 30720
buffer_load_dwordx4 v4, s[4:7], s72 offen offset:2048 lds
v_mfma_f32_16x16x32_bf16 v[244:247], v[108:111], v[116:119], v[244:247]
v_cvt_pk_bf16_f32 v20, v20, v28
v_cvt_pk_bf16_f32 v21, v21, v29
v_mfma_f32_16x16x32_bf16 v[240:243], v[108:111], v[112:115], v[240:243]
s_waitcnt lgkmcnt(0)
v_cvt_pk_bf16_f32 v22, v22, v30
v_cvt_pk_bf16_f32 v23, v23, v31
v_mfma_f32_16x16x32_bf16 v[128:131], v[32:35], v[64:67], v[128:131]
ds_read_b64_tr_b16 v[80:81], v8 offset:24576
ds_read_b64_tr_b16 v[82:83], v8 offset:25600
v_mfma_f32_16x16x32_bf16 v[132:135], v[32:35], v[68:71], v[132:135]
ds_read_b128 v[112:115], v19 offset:0
ds_read_b128 v[116:119], v19 offset:2048
v_mfma_f32_16x16x32_bf16 v[136:139], v[32:35], v[72:75], v[136:139]
s_add_u32 s72, s69, 46080
buffer_load_dwordx4 v5, s[4:7], s72 offen offset:3072 lds
v_mfma_f32_16x16x32_bf16 v[140:143], v[32:35], v[76:79], v[140:143]
ds_read_b128 v[120:123], v19 offset:4096
ds_read_b128 v[124:127], v19 offset:6144
v_mfma_f32_16x16x32_bf16 v[156:159], v[36:39], v[76:79], v[156:159]
ds_read_b64_tr_b16 v[84:85], v9 offset:24576
ds_read_b64_tr_b16 v[86:87], v9 offset:25600
v_mfma_f32_16x16x32_bf16 v[152:155], v[36:39], v[72:75], v[152:155]
ds_read_b64_tr_b16 v[88:89], v10 offset:24576
v_mfma_f32_16x16x32_bf16 v[148:151], v[36:39], v[68:71], v[148:151]
ds_read_b64_tr_b16 v[90:91], v10 offset:25600
v_mfma_f32_16x16x32_bf16 v[144:147], v[36:39], v[64:67], v[144:147]
s_add_u32 m0, s63, 135168
ds_read_b64_tr_b16 v[92:93], v11 offset:24576
v_mfma_f32_16x16x32_bf16 v[160:163], v[40:43], v[64:67], v[160:163]
s_add_u32 s72, s70, 0
buffer_load_dwordx4 v4, s[4:7], s72 offen lds
v_mfma_f32_16x16x32_bf16 v[164:167], v[40:43], v[68:71], v[164:167]
ds_read_b64_tr_b16 v[94:95], v11 offset:25600
v_mfma_f32_16x16x32_bf16 v[168:171], v[40:43], v[72:75], v[168:171]
ds_read_b64_tr_b16 v[96:97], v12 offset:24576
v_mfma_f32_16x16x32_bf16 v[172:175], v[40:43], v[76:79], v[172:175]
ds_read_b64_tr_b16 v[98:99], v12 offset:25600
v_mfma_f32_16x16x32_bf16 v[188:191], v[44:47], v[76:79], v[188:191]
s_add_u32 s72, s70, 15360
buffer_load_dwordx4 v5, s[4:7], s72 offen offset:1024 lds
v_mfma_f32_16x16x32_bf16 v[184:187], v[44:47], v[72:75], v[184:187]
ds_read_b64_tr_b16 v[100:101], v13 offset:24576
v_mfma_f32_16x16x32_bf16 v[180:183], v[44:47], v[68:71], v[180:183]
ds_read_b64_tr_b16 v[102:103], v13 offset:25600
v_mfma_f32_16x16x32_bf16 v[176:179], v[44:47], v[64:67], v[176:179]
ds_read_b64_tr_b16 v[104:105], v14 offset:24576
v_mfma_f32_16x16x32_bf16 v[192:195], v[48:51], v[64:67], v[192:195]
ds_read_b64_tr_b16 v[106:107], v14 offset:25600
v_mfma_f32_16x16x32_bf16 v[196:199], v[48:51], v[68:71], v[196:199]
s_add_u32 s72, s70, 30720
buffer_load_dwordx4 v4, s[4:7], s72 offen offset:2048 lds
v_mfma_f32_16x16x32_bf16 v[200:203], v[48:51], v[72:75], v[200:203]
ds_read_b64_tr_b16 v[108:109], v15 offset:24576
v_mfma_f32_16x16x32_bf16 v[204:207], v[48:51], v[76:79], v[204:207]
ds_read_b64_tr_b16 v[110:111], v15 offset:25600
v_mfma_f32_16x16x32_bf16 v[220:223], v[52:55], v[76:79], v[220:223]
buffer_store_dwordx4 v[20:23], v1, s[44:47], s80 offen sc1
v_mfma_f32_16x16x32_bf16 v[216:219], v[52:55], v[72:75], v[216:219]
v_accvgpr_read_b32 v24, a248
v_accvgpr_read_b32 v28, a249
v_mfma_f32_16x16x32_bf16 v[212:215], v[52:55], v[68:71], v[212:215]
s_add_u32 s72, s70, 46080
buffer_load_dwordx4 v5, s[4:7], s72 offen offset:3072 lds
v_mfma_f32_16x16x32_bf16 v[208:211], v[52:55], v[64:67], v[208:211]
v_accvgpr_read_b32 v25, a250
v_accvgpr_read_b32 v29, a251
v_mfma_f32_16x16x32_bf16 v[224:227], v[56:59], v[64:67], v[224:227]
s_add_u32 s80, s78, 44032
v_accvgpr_read_b32 v26, a252
v_accvgpr_read_b32 v30, a253
v_mfma_f32_16x16x32_bf16 v[228:231], v[56:59], v[68:71], v[228:231]
v_accvgpr_read_b32 v27, a254
v_accvgpr_read_b32 v31, a255
v_mfma_f32_16x16x32_bf16 v[232:235], v[56:59], v[72:75], v[232:235]
v_cvt_pk_bf16_f32 v24, v24, v28
v_cvt_pk_bf16_f32 v25, v25, v29
v_mfma_f32_16x16x32_bf16 v[236:239], v[56:59], v[76:79], v[236:239]
v_cvt_pk_bf16_f32 v26, v26, v30
v_cvt_pk_bf16_f32 v27, v27, v31
v_mfma_f32_16x16x32_bf16 v[252:255], v[60:63], v[76:79], v[252:255]
buffer_store_dwordx4 v[24:27], v1, s[44:47], s80 offen sc1
v_mfma_f32_16x16x32_bf16 v[248:251], v[60:63], v[72:75], v[248:251]
v_mfma_f32_16x16x32_bf16 v[244:247], v[60:63], v[68:71], v[244:247]
s_waitcnt vmcnt(0) lgkmcnt(0)
v_mfma_f32_16x16x32_bf16 v[240:243], v[60:63], v[64:67], v[240:243]
s_barrier
v_mfma_f32_16x16x32_bf16 v[128:131], v[80:83], v[112:115], v[128:131]
s_add_u32 s73, s61, 13
ds_read_b64_tr_b16 v[32:33], v8 offset:32768
ds_read_b64_tr_b16 v[34:35], v8 offset:33792
v_mfma_f32_16x16x32_bf16 v[132:135], v[80:83], v[116:119], v[132:135]
s_and_b32 s73, s73, 7
ds_read_b128 v[64:67], v18 offset:32768
ds_read_b128 v[68:71], v18 offset:34816
v_mfma_f32_16x16x32_bf16 v[136:139], v[80:83], v[120:123], v[136:139]
s_or_b32 s73, s73, 8
ds_read_b128 v[72:75], v18 offset:36864
ds_read_b128 v[76:79], v18 offset:38912
v_mfma_f32_16x16x32_bf16 v[140:143], v[80:83], v[124:127], v[140:143]
s_lshl_b32 s71, s73, 19
ds_read_b64_tr_b16 v[36:37], v9 offset:32768
ds_read_b64_tr_b16 v[38:39], v9 offset:33792
v_mfma_f32_16x16x32_bf16 v[156:159], v[84:87], v[124:127], v[156:159]
s_add_u32 s71, s71, s66
ds_read_b64_tr_b16 v[40:41], v10 offset:32768
v_or_b32 v20, s58, v0
v_mfma_f32_16x16x32_bf16 v[152:155], v[84:87], v[120:123], v[152:155]
s_lshl_b32 s73, s73, 7
ds_read_b64_tr_b16 v[42:43], v10 offset:33792
v_mov_b32 v21, 1
v_mfma_f32_16x16x32_bf16 v[148:151], v[84:87], v[116:119], v[148:151]
s_add_u32 s69, s73, s67
ds_read_b64_tr_b16 v[44:45], v11 offset:32768
v_min_u32 v20, 1, v20
v_mfma_f32_16x16x32_bf16 v[144:147], v[84:87], v[112:115], v[144:147]
s_add_u32 s70, s73, s68
ds_read_b64_tr_b16 v[46:47], v11 offset:33792
v_lshlrev_b32 v20, 30, v20
v_mfma_f32_16x16x32_bf16 v[160:163], v[88:91], v[112:115], v[160:163]
s_add_u32 m0, s64, 16384
ds_read_b64_tr_b16 v[48:49], v12 offset:32768
v_mfma_f32_16x16x32_bf16 v[164:167], v[88:91], v[116:119], v[164:167]
s_add_u32 s72, s71, 0
buffer_load_dwordx4 v6, s[12:15], s72 offen lds
v_mfma_f32_16x16x32_bf16 v[168:171], v[88:91], v[120:123], v[168:171]
s_add_u32 s72, s71, 31744
buffer_load_dwordx4 v6, s[12:15], s72 offen offset:1024 lds
v_mfma_f32_16x16x32_bf16 v[172:175], v[88:91], v[124:127], v[172:175]
s_add_u32 s72, s71, 63488
buffer_load_dwordx4 v7, s[12:15], s72 offen offset:2048 lds
v_mfma_f32_16x16x32_bf16 v[188:191], v[92:95], v[124:127], v[188:191]
ds_read_b64_tr_b16 v[50:51], v12 offset:33792
v_mfma_f32_16x16x32_bf16 v[184:187], v[92:95], v[120:123], v[184:187]
ds_read_b64_tr_b16 v[52:53], v13 offset:32768
v_mfma_f32_16x16x32_bf16 v[180:183], v[92:95], v[116:119], v[180:183]
s_add_u32 s72, s71, 95232
buffer_load_dwordx4 v7, s[12:15], s72 offen offset:3072 lds
v_mfma_f32_16x16x32_bf16 v[176:179], v[92:95], v[112:115], v[176:179]
ds_read_b64_tr_b16 v[54:55], v13 offset:33792
v_mfma_f32_16x16x32_bf16 v[192:195], v[96:99], v[112:115], v[192:195]
ds_read_b64_tr_b16 v[56:57], v14 offset:32768
v_mfma_f32_16x16x32_bf16 v[196:199], v[96:99], v[116:119], v[196:199]
ds_read_b64_tr_b16 v[58:59], v14 offset:33792
v_mfma_f32_16x16x32_bf16 v[200:203], v[96:99], v[120:123], v[200:203]
ds_read_b64_tr_b16 v[60:61], v15 offset:32768
v_mfma_f32_16x16x32_bf16 v[204:207], v[96:99], v[124:127], v[204:207]
s_add_u32 m0, s63, 65536
ds_read_b64_tr_b16 v[62:63], v15 offset:33792
v_mfma_f32_16x16x32_bf16 v[220:223], v[100:103], v[124:127], v[220:223]
s_add_u32 s72, s69, 0
buffer_load_dwordx4 v4, s[4:7], s72 offen lds
v_mfma_f32_16x16x32_bf16 v[216:219], v[100:103], v[120:123], v[216:219]
buffer_store_dword v21, v20, s[44:47], s91 offen sc1
v_mfma_f32_16x16x32_bf16 v[212:215], v[100:103], v[116:119], v[212:215]
v_mfma_f32_16x16x32_bf16 v[208:211], v[100:103], v[112:115], v[208:211]
v_mfma_f32_16x16x32_bf16 v[224:227], v[104:107], v[112:115], v[224:227]
s_add_u32 s72, s69, 15360
buffer_load_dwordx4 v5, s[4:7], s72 offen offset:1024 lds
v_mfma_f32_16x16x32_bf16 v[228:231], v[104:107], v[116:119], v[228:231]
v_mfma_f32_16x16x32_bf16 v[232:235], v[104:107], v[120:123], v[232:235]
v_mfma_f32_16x16x32_bf16 v[236:239], v[104:107], v[124:127], v[236:239]
v_mfma_f32_16x16x32_bf16 v[252:255], v[108:111], v[124:127], v[252:255]
v_mfma_f32_16x16x32_bf16 v[248:251], v[108:111], v[120:123], v[248:251]
s_add_u32 s72, s69, 30720
buffer_load_dwordx4 v4, s[4:7], s72 offen offset:2048 lds
v_mfma_f32_16x16x32_bf16 v[244:247], v[108:111], v[116:119], v[244:247]
v_mfma_f32_16x16x32_bf16 v[240:243], v[108:111], v[112:115], v[240:243]
s_waitcnt lgkmcnt(0)
v_mfma_f32_16x16x32_bf16 v[128:131], v[32:35], v[64:67], v[128:131]
ds_read_b64_tr_b16 v[80:81], v8 offset:40960
ds_read_b64_tr_b16 v[82:83], v8 offset:41984
v_mfma_f32_16x16x32_bf16 v[132:135], v[32:35], v[68:71], v[132:135]
ds_read_b128 v[112:115], v19 offset:32768
ds_read_b128 v[116:119], v19 offset:34816
v_mfma_f32_16x16x32_bf16 v[136:139], v[32:35], v[72:75], v[136:139]
s_add_u32 s72, s69, 46080
buffer_load_dwordx4 v5, s[4:7], s72 offen offset:3072 lds
v_mfma_f32_16x16x32_bf16 v[140:143], v[32:35], v[76:79], v[140:143]
ds_read_b128 v[120:123], v19 offset:36864
ds_read_b128 v[124:127], v19 offset:38912
v_mfma_f32_16x16x32_bf16 v[156:159], v[36:39], v[76:79], v[156:159]
ds_read_b64_tr_b16 v[84:85], v9 offset:40960
ds_read_b64_tr_b16 v[86:87], v9 offset:41984
v_mfma_f32_16x16x32_bf16 v[152:155], v[36:39], v[72:75], v[152:155]
ds_read_b64_tr_b16 v[88:89], v10 offset:40960
v_mfma_f32_16x16x32_bf16 v[148:151], v[36:39], v[68:71], v[148:151]
ds_read_b64_tr_b16 v[90:91], v10 offset:41984
v_mfma_f32_16x16x32_bf16 v[144:147], v[36:39], v[64:67], v[144:147]
s_add_u32 m0, s63, 69632
ds_read_b64_tr_b16 v[92:93], v11 offset:40960
v_mfma_f32_16x16x32_bf16 v[160:163], v[40:43], v[64:67], v[160:163]
s_add_u32 s72, s70, 0
buffer_load_dwordx4 v4, s[4:7], s72 offen lds
v_mfma_f32_16x16x32_bf16 v[164:167], v[40:43], v[68:71], v[164:167]
ds_read_b64_tr_b16 v[94:95], v11 offset:41984
v_mfma_f32_16x16x32_bf16 v[168:171], v[40:43], v[72:75], v[168:171]
ds_read_b64_tr_b16 v[96:97], v12 offset:40960
v_mfma_f32_16x16x32_bf16 v[172:175], v[40:43], v[76:79], v[172:175]
ds_read_b64_tr_b16 v[98:99], v12 offset:41984
v_mfma_f32_16x16x32_bf16 v[188:191], v[44:47], v[76:79], v[188:191]
s_add_u32 s72, s70, 15360
buffer_load_dwordx4 v5, s[4:7], s72 offen offset:1024 lds
v_mfma_f32_16x16x32_bf16 v[184:187], v[44:47], v[72:75], v[184:187]
ds_read_b64_tr_b16 v[100:101], v13 offset:40960
v_mfma_f32_16x16x32_bf16 v[180:183], v[44:47], v[68:71], v[180:183]
ds_read_b64_tr_b16 v[102:103], v13 offset:41984
v_mfma_f32_16x16x32_bf16 v[176:179], v[44:47], v[64:67], v[176:179]
ds_read_b64_tr_b16 v[104:105], v14 offset:40960
v_mfma_f32_16x16x32_bf16 v[192:195], v[48:51], v[64:67], v[192:195]
ds_read_b64_tr_b16 v[106:107], v14 offset:41984
v_mfma_f32_16x16x32_bf16 v[196:199], v[48:51], v[68:71], v[196:199]
s_add_u32 s72, s70, 30720
buffer_load_dwordx4 v4, s[4:7], s72 offen offset:2048 lds
v_mfma_f32_16x16x32_bf16 v[200:203], v[48:51], v[72:75], v[200:203]
ds_read_b64_tr_b16 v[108:109], v15 offset:40960
v_mfma_f32_16x16x32_bf16 v[204:207], v[48:51], v[76:79], v[204:207]
ds_read_b64_tr_b16 v[110:111], v15 offset:41984
v_mfma_f32_16x16x32_bf16 v[220:223], v[52:55], v[76:79], v[220:223]
v_mfma_f32_16x16x32_bf16 v[216:219], v[52:55], v[72:75], v[216:219]
v_mfma_f32_16x16x32_bf16 v[212:215], v[52:55], v[68:71], v[212:215]
s_add_u32 s72, s70, 46080
buffer_load_dwordx4 v5, s[4:7], s72 offen offset:3072 lds
v_mfma_f32_16x16x32_bf16 v[208:211], v[52:55], v[64:67], v[208:211]
v_mfma_f32_16x16x32_bf16 v[224:227], v[56:59], v[64:67], v[224:227]
v_mfma_f32_16x16x32_bf16 v[228:231], v[56:59], v[68:71], v[228:231]
v_mfma_f32_16x16x32_bf16 v[232:235], v[56:59], v[72:75], v[232:235]
v_mfma_f32_16x16x32_bf16 v[236:239], v[56:59], v[76:79], v[236:239]
v_mfma_f32_16x16x32_bf16 v[252:255], v[60:63], v[76:79], v[252:255]
v_mfma_f32_16x16x32_bf16 v[248:251], v[60:63], v[72:75], v[248:251]
v_mfma_f32_16x16x32_bf16 v[244:247], v[60:63], v[68:71], v[244:247]
s_waitcnt vmcnt(14) lgkmcnt(0)
v_mfma_f32_16x16x32_bf16 v[240:243], v[60:63], v[64:67], v[240:243]
s_barrier
v_mfma_f32_16x16x32_bf16 v[128:131], v[80:83], v[112:115], v[128:131]
s_add_u32 s73, s61, 14
s_waitcnt vmcnt(28)
v_cmp_gt_u32 vcc, 8, v3
s_cbranch_vccnz Lspin1
Lback2:
v_mfma_f32_16x16x32_bf16 v[132:135], v[80:83], v[116:119], v[132:135]
s_and_b32 s73, s73, 7
ds_read_b64_tr_b16 v[32:33], v8 offset:0
ds_read_b64_tr_b16 v[34:35], v8 offset:1024
v_mfma_f32_16x16x32_bf16 v[136:139], v[80:83], v[120:123], v[136:139]
s_or_b32 s73, s73, 8
ds_read_b128 v[64:67], v16 offset:0
ds_read_b128 v[68:71], v16 offset:2048
v_mfma_f32_16x16x32_bf16 v[140:143], v[80:83], v[124:127], v[140:143]
s_lshl_b32 s71, s73, 19
ds_read_b128 v[72:75], v16 offset:4096
ds_read_b128 v[76:79], v16 offset:6144
v_mfma_f32_16x16x32_bf16 v[156:159], v[84:87], v[124:127], v[156:159]
s_add_u32 s71, s71, s66
ds_read_b64_tr_b16 v[36:37], v9 offset:0
ds_read_b64_tr_b16 v[38:39], v9 offset:1024
v_mfma_f32_16x16x32_bf16 v[152:155], v[84:87], v[120:123], v[152:155]
s_lshl_b32 s73, s73, 7
ds_read_b64_tr_b16 v[40:41], v10 offset:0
v_mfma_f32_16x16x32_bf16 v[148:151], v[84:87], v[116:119], v[148:151]
s_add_u32 s69, s73, s67
ds_read_b64_tr_b16 v[42:43], v10 offset:1024
v_mfma_f32_16x16x32_bf16 v[144:147], v[84:87], v[112:115], v[144:147]
s_add_u32 s70, s73, s68
ds_read_b64_tr_b16 v[44:45], v11 offset:0
v_mfma_f32_16x16x32_bf16 v[160:163], v[88:91], v[112:115], v[160:163]
s_add_u32 m0, s64, 32768
ds_read_b64_tr_b16 v[46:47], v11 offset:1024
v_mfma_f32_16x16x32_bf16 v[164:167], v[88:91], v[116:119], v[164:167]
s_add_u32 s72, s71, 0
buffer_load_dwordx4 v6, s[12:15], s72 offen lds
v_mfma_f32_16x16x32_bf16 v[168:171], v[88:91], v[120:123], v[168:171]
s_add_u32 s72, s71, 31744
buffer_load_dwordx4 v6, s[12:15], s72 offen offset:1024 lds
v_mfma_f32_16x16x32_bf16 v[172:175], v[88:91], v[124:127], v[172:175]
s_add_u32 s72, s71, 63488
buffer_load_dwordx4 v7, s[12:15], s72 offen offset:2048 lds
v_mfma_f32_16x16x32_bf16 v[188:191], v[92:95], v[124:127], v[188:191]
ds_read_b64_tr_b16 v[48:49], v12 offset:0
v_mfma_f32_16x16x32_bf16 v[184:187], v[92:95], v[120:123], v[184:187]
ds_read_b64_tr_b16 v[50:51], v12 offset:1024
v_mfma_f32_16x16x32_bf16 v[180:183], v[92:95], v[116:119], v[180:183]
s_add_u32 s72, s71, 95232
buffer_load_dwordx4 v7, s[12:15], s72 offen offset:3072 lds
v_mfma_f32_16x16x32_bf16 v[176:179], v[92:95], v[112:115], v[176:179]
ds_read_b64_tr_b16 v[52:53], v13 offset:0
v_mfma_f32_16x16x32_bf16 v[192:195], v[96:99], v[112:115], v[192:195]
ds_read_b64_tr_b16 v[54:55], v13 offset:1024
v_mfma_f32_16x16x32_bf16 v[196:199], v[96:99], v[116:119], v[196:199]
ds_read_b64_tr_b16 v[56:57], v14 offset:0
v_mfma_f32_16x16x32_bf16 v[200:203], v[96:99], v[120:123], v[200:203]
ds_read_b64_tr_b16 v[58:59], v14 offset:1024
v_mfma_f32_16x16x32_bf16 v[204:207], v[96:99], v[124:127], v[204:207]
s_add_u32 m0, s63, 98304
ds_read_b64_tr_b16 v[60:61], v15 offset:0
v_mfma_f32_16x16x32_bf16 v[220:223], v[100:103], v[124:127], v[220:223]
s_add_u32 s72, s69, 0
buffer_load_dwordx4 v4, s[4:7], s72 offen lds
v_mfma_f32_16x16x32_bf16 v[216:219], v[100:103], v[120:123], v[216:219]
ds_read_b64_tr_b16 v[62:63], v15 offset:1024
v_mfma_f32_16x16x32_bf16 v[212:215], v[100:103], v[116:119], v[212:215]
v_mfma_f32_16x16x32_bf16 v[208:211], v[100:103], v[112:115], v[208:211]
v_mfma_f32_16x16x32_bf16 v[224:227], v[104:107], v[112:115], v[224:227]
s_add_u32 s72, s69, 15360
buffer_load_dwordx4 v5, s[4:7], s72 offen offset:1024 lds
v_mfma_f32_16x16x32_bf16 v[228:231], v[104:107], v[116:119], v[228:231]
v_mfma_f32_16x16x32_bf16 v[232:235], v[104:107], v[120:123], v[232:235]
v_mfma_f32_16x16x32_bf16 v[236:239], v[104:107], v[124:127], v[236:239]
v_mfma_f32_16x16x32_bf16 v[252:255], v[108:111], v[124:127], v[252:255]
v_mfma_f32_16x16x32_bf16 v[248:251], v[108:111], v[120:123], v[248:251]
s_add_u32 s72, s69, 30720
buffer_load_dwordx4 v4, s[4:7], s72 offen offset:2048 lds
v_mfma_f32_16x16x32_bf16 v[244:247], v[108:111], v[116:119], v[244:247]
v_mfma_f32_16x16x32_bf16 v[240:243], v[108:111], v[112:115], v[240:243]
s_waitcnt lgkmcnt(0)
v_mfma_f32_16x16x32_bf16 v[128:131], v[32:35], v[64:67], v[128:131]
ds_read_b64_tr_b16 v[80:81], v8 offset:8192
ds_read_b64_tr_b16 v[82:83], v8 offset:9216
v_mfma_f32_16x16x32_bf16 v[132:135], v[32:35], v[68:71], v[132:135]
ds_read_b128 v[112:115], v17 offset:0
ds_read_b128 v[116:119], v17 offset:2048
v_mfma_f32_16x16x32_bf16 v[136:139], v[32:35], v[72:75], v[136:139]
s_add_u32 s72, s69, 46080
buffer_load_dwordx4 v5, s[4:7], s72 offen offset:3072 lds
v_mfma_f32_16x16x32_bf16 v[140:143], v[32:35], v[76:79], v[140:143]
ds_read_b128 v[120:123], v17 offset:4096
ds_read_b128 v[124:127], v17 offset:6144
v_mfma_f32_16x16x32_bf16 v[156:159], v[36:39], v[76:79], v[156:159]
ds_read_b64_tr_b16 v[84:85], v9 offset:8192
ds_read_b64_tr_b16 v[86:87], v9 offset:9216
v_mfma_f32_16x16x32_bf16 v[152:155], v[36:39], v[72:75], v[152:155]
ds_read_b64_tr_b16 v[88:89], v10 offset:8192
v_mfma_f32_16x16x32_bf16 v[148:151], v[36:39], v[68:71], v[148:151]
ds_read_b64_tr_b16 v[90:91], v10 offset:9216
v_mfma_f32_16x16x32_bf16 v[144:147], v[36:39], v[64:67], v[144:147]
s_add_u32 m0, s63, 102400
ds_read_b64_tr_b16 v[92:93], v11 offset:8192
v_mfma_f32_16x16x32_bf16 v[160:163], v[40:43], v[64:67], v[160:163]
s_add_u32 s72, s70, 0
buffer_load_dwordx4 v4, s[4:7], s72 offen lds
v_mfma_f32_16x16x32_bf16 v[164:167], v[40:43], v[68:71], v[164:167]
ds_read_b64_tr_b16 v[94:95], v11 offset:9216
v_mfma_f32_16x16x32_bf16 v[168:171], v[40:43], v[72:75], v[168:171]
ds_read_b64_tr_b16 v[96:97], v12 offset:8192
v_mfma_f32_16x16x32_bf16 v[172:175], v[40:43], v[76:79], v[172:175]
ds_read_b64_tr_b16 v[98:99], v12 offset:9216
v_mfma_f32_16x16x32_bf16 v[188:191], v[44:47], v[76:79], v[188:191]
s_add_u32 s72, s70, 15360
buffer_load_dwordx4 v5, s[4:7], s72 offen offset:1024 lds
v_mfma_f32_16x16x32_bf16 v[184:187], v[44:47], v[72:75], v[184:187]
ds_read_b64_tr_b16 v[100:101], v13 offset:8192
v_mfma_f32_16x16x32_bf16 v[180:183], v[44:47], v[68:71], v[180:183]
ds_read_b64_tr_b16 v[102:103], v13 offset:9216
v_mfma_f32_16x16x32_bf16 v[176:179], v[44:47], v[64:67], v[176:179]
ds_read_b64_tr_b16 v[104:105], v14 offset:8192
v_mfma_f32_16x16x32_bf16 v[192:195], v[48:51], v[64:67], v[192:195]
ds_read_b64_tr_b16 v[106:107], v14 offset:9216
v_mfma_f32_16x16x32_bf16 v[196:199], v[48:51], v[68:71], v[196:199]
s_add_u32 s72, s70, 30720
buffer_load_dwordx4 v4, s[4:7], s72 offen offset:2048 lds
v_mfma_f32_16x16x32_bf16 v[200:203], v[48:51], v[72:75], v[200:203]
ds_read_b64_tr_b16 v[108:109], v15 offset:8192
v_mfma_f32_16x16x32_bf16 v[204:207], v[48:51], v[76:79], v[204:207]
ds_read_b64_tr_b16 v[110:111], v15 offset:9216
v_mfma_f32_16x16x32_bf16 v[220:223], v[52:55], v[76:79], v[220:223]
v_mfma_f32_16x16x32_bf16 v[216:219], v[52:55], v[72:75], v[216:219]
v_mfma_f32_16x16x32_bf16 v[212:215], v[52:55], v[68:71], v[212:215]
s_add_u32 s72, s70, 46080
buffer_load_dwordx4 v5, s[4:7], s72 offen offset:3072 lds
v_mfma_f32_16x16x32_bf16 v[208:211], v[52:55], v[64:67], v[208:211]
v_mfma_f32_16x16x32_bf16 v[224:227], v[56:59], v[64:67], v[224:227]
v_mfma_f32_16x16x32_bf16 v[228:231], v[56:59], v[68:71], v[228:231]
v_mfma_f32_16x16x32_bf16 v[232:235], v[56:59], v[72:75], v[232:235]
v_mfma_f32_16x16x32_bf16 v[236:239], v[56:59], v[76:79], v[236:239]
v_mfma_f32_16x16x32_bf16 v[252:255], v[60:63], v[76:79], v[252:255]
v_mfma_f32_16x16x32_bf16 v[248:251], v[60:63], v[72:75], v[248:251]
v_mfma_f32_16x16x32_bf16 v[244:247], v[60:63], v[68:71], v[244:247]
s_waitcnt vmcnt(12) lgkmcnt(0)
v_mfma_f32_16x16x32_bf16 v[240:243], v[60:63], v[64:67], v[240:243]
s_barrier
v_mfma_f32_16x16x32_bf16 v[128:131], v[80:83], v[112:115], v[128:131]
s_add_u32 s73, s61, 15
ds_read_b64_tr_b16 v[32:33], v8 offset:16384
ds_read_b64_tr_b16 v[34:35], v8 offset:17408
v_mfma_f32_16x16x32_bf16 v[132:135], v[80:83], v[116:119], v[132:135]
s_and_b32 s73, s73, 7
ds_read_b128 v[64:67], v18 offset:0
ds_read_b128 v[68:71], v18 offset:2048
v_mfma_f32_16x16x32_bf16 v[136:139], v[80:83], v[120:123], v[136:139]
s_or_b32 s73, s73, 8
ds_read_b128 v[72:75], v18 offset:4096
ds_read_b128 v[76:79], v18 offset:6144
v_mfma_f32_16x16x32_bf16 v[140:143], v[80:83], v[124:127], v[140:143]
s_lshl_b32 s71, s73, 19
ds_read_b64_tr_b16 v[36:37], v9 offset:16384
ds_read_b64_tr_b16 v[38:39], v9 offset:17408
v_mfma_f32_16x16x32_bf16 v[156:159], v[84:87], v[124:127], v[156:159]
s_add_u32 s71, s71, s66
ds_read_b64_tr_b16 v[40:41], v10 offset:16384
v_mfma_f32_16x16x32_bf16 v[152:155], v[84:87], v[120:123], v[152:155]
s_lshl_b32 s73, s73, 7
ds_read_b64_tr_b16 v[42:43], v10 offset:17408
v_mfma_f32_16x16x32_bf16 v[148:151], v[84:87], v[116:119], v[148:151]
s_add_u32 s69, s73, s67
ds_read_b64_tr_b16 v[44:45], v11 offset:16384
v_mfma_f32_16x16x32_bf16 v[144:147], v[84:87], v[112:115], v[144:147]
s_add_u32 s70, s73, s68
ds_read_b64_tr_b16 v[46:47], v11 offset:17408
v_mfma_f32_16x16x32_bf16 v[160:163], v[88:91], v[112:115], v[160:163]
s_add_u32 m0, s64, 0
ds_read_b64_tr_b16 v[48:49], v12 offset:16384
v_mfma_f32_16x16x32_bf16 v[164:167], v[88:91], v[116:119], v[164:167]
s_add_u32 s72, s71, 0
buffer_load_dwordx4 v6, s[12:15], s72 offen lds
v_mfma_f32_16x16x32_bf16 v[168:171], v[88:91], v[120:123], v[168:171]
s_add_u32 s72, s71, 31744
buffer_load_dwordx4 v6, s[12:15], s72 offen offset:1024 lds
v_mfma_f32_16x16x32_bf16 v[172:175], v[88:91], v[124:127], v[172:175]
s_add_u32 s72, s71, 63488
buffer_load_dwordx4 v7, s[12:15], s72 offen offset:2048 lds
v_mfma_f32_16x16x32_bf16 v[188:191], v[92:95], v[124:127], v[188:191]
s_and_b32 s75, s91, 0xfffffc7f
v_and_b32 v2, 7, v0
v_lshlrev_b32 v2, 7, v2
v_mfma_f32_16x16x32_bf16 v[184:187], v[92:95], v[120:123], v[184:187]
buffer_load_dword v3, v2, s[44:47], s75 offen sc1
v_mfma_f32_16x16x32_bf16 v[180:183], v[92:95], v[116:119], v[180:183]
s_add_u32 s72, s71, 95232
buffer_load_dwordx4 v7, s[12:15], s72 offen offset:3072 lds
v_mfma_f32_16x16x32_bf16 v[176:179], v[92:95], v[112:115], v[176:179]
ds_read_b64_tr_b16 v[50:51], v12 offset:17408
v_mfma_f32_16x16x32_bf16 v[192:195], v[96:99], v[112:115], v[192:195]
ds_read_b64_tr_b16 v[52:53], v13 offset:16384
v_mfma_f32_16x16x32_bf16 v[196:199], v[96:99], v[116:119], v[196:199]
ds_read_b64_tr_b16 v[54:55], v13 offset:17408
v_mfma_f32_16x16x32_bf16 v[200:203], v[96:99], v[120:123], v[200:203]
ds_read_b64_tr_b16 v[56:57], v14 offset:16384
v_mfma_f32_16x16x32_bf16 v[204:207], v[96:99], v[124:127], v[204:207]
s_add_u32 m0, s63, 131072
ds_read_b64_tr_b16 v[58:59], v14 offset:17408
v_mfma_f32_16x16x32_bf16 v[220:223], v[100:103], v[124:127], v[220:223]
s_add_u32 s72, s69, 0
buffer_load_dwordx4 v4, s[4:7], s72 offen lds
v_mfma_f32_16x16x32_bf16 v[216:219], v[100:103], v[120:123], v[216:219]
ds_read_b64_tr_b16 v[60:61], v15 offset:16384
v_mfma_f32_16x16x32_bf16 v[212:215], v[100:103], v[116:119], v[212:215]
ds_read_b64_tr_b16 v[62:63], v15 offset:17408
v_mfma_f32_16x16x32_bf16 v[208:211], v[100:103], v[112:115], v[208:211]
v_mfma_f32_16x16x32_bf16 v[224:227], v[104:107], v[112:115], v[224:227]
s_add_u32 s72, s69, 15360
buffer_load_dwordx4 v5, s[4:7], s72 offen offset:1024 lds
v_mfma_f32_16x16x32_bf16 v[228:231], v[104:107], v[116:119], v[228:231]
v_mfma_f32_16x16x32_bf16 v[232:235], v[104:107], v[120:123], v[232:235]
v_mfma_f32_16x16x32_bf16 v[236:239], v[104:107], v[124:127], v[236:239]
v_mfma_f32_16x16x32_bf16 v[252:255], v[108:111], v[124:127], v[252:255]
v_mfma_f32_16x16x32_bf16 v[248:251], v[108:111], v[120:123], v[248:251]
s_add_u32 s72, s69, 30720
buffer_load_dwordx4 v4, s[4:7], s72 offen offset:2048 lds
v_mfma_f32_16x16x32_bf16 v[244:247], v[108:111], v[116:119], v[244:247]
v_mfma_f32_16x16x32_bf16 v[240:243], v[108:111], v[112:115], v[240:243]
s_waitcnt lgkmcnt(0)
v_mfma_f32_16x16x32_bf16 v[128:131], v[32:35], v[64:67], v[128:131]
ds_read_b64_tr_b16 v[80:81], v8 offset:24576
ds_read_b64_tr_b16 v[82:83], v8 offset:25600
v_mfma_f32_16x16x32_bf16 v[132:135], v[32:35], v[68:71], v[132:135]
ds_read_b128 v[112:115], v19 offset:0
ds_read_b128 v[116:119], v19 offset:2048
v_mfma_f32_16x16x32_bf16 v[136:139], v[32:35], v[72:75], v[136:139]
s_add_u32 s72, s69, 46080
buffer_load_dwordx4 v5, s[4:7], s72 offen offset:3072 lds
v_mfma_f32_16x16x32_bf16 v[140:143], v[32:35], v[76:79], v[140:143]
ds_read_b128 v[120:123], v19 offset:4096
ds_read_b128 v[124:127], v19 offset:6144
v_mfma_f32_16x16x32_bf16 v[156:159], v[36:39], v[76:79], v[156:159]
ds_read_b64_tr_b16 v[84:85], v9 offset:24576
ds_read_b64_tr_b16 v[86:87], v9 offset:25600
v_mfma_f32_16x16x32_bf16 v[152:155], v[36:39], v[72:75], v[152:155]
ds_read_b64_tr_b16 v[88:89], v10 offset:24576
v_mfma_f32_16x16x32_bf16 v[148:151], v[36:39], v[68:71], v[148:151]
ds_read_b64_tr_b16 v[90:91], v10 offset:25600
v_mfma_f32_16x16x32_bf16 v[144:147], v[36:39], v[64:67], v[144:147]
s_add_u32 m0, s63, 135168
ds_read_b64_tr_b16 v[92:93], v11 offset:24576
v_mfma_f32_16x16x32_bf16 v[160:163], v[40:43], v[64:67], v[160:163]
s_add_u32 s72, s70, 0
buffer_load_dwordx4 v4, s[4:7], s72 offen lds
v_mfma_f32_16x16x32_bf16 v[164:167], v[40:43], v[68:71], v[164:167]
ds_read_b64_tr_b16 v[94:95], v11 offset:25600
v_mfma_f32_16x16x32_bf16 v[168:171], v[40:43], v[72:75], v[168:171]
ds_read_b64_tr_b16 v[96:97], v12 offset:24576
v_mfma_f32_16x16x32_bf16 v[172:175], v[40:43], v[76:79], v[172:175]
ds_read_b64_tr_b16 v[98:99], v12 offset:25600
v_mfma_f32_16x16x32_bf16 v[188:191], v[44:47], v[76:79], v[188:191]
s_add_u32 s72, s70, 15360
buffer_load_dwordx4 v5, s[4:7], s72 offen offset:1024 lds
v_mfma_f32_16x16x32_bf16 v[184:187], v[44:47], v[72:75], v[184:187]
ds_read_b64_tr_b16 v[100:101], v13 offset:24576
v_mfma_f32_16x16x32_bf16 v[180:183], v[44:47], v[68:71], v[180:183]
ds_read_b64_tr_b16 v[102:103], v13 offset:25600
v_mfma_f32_16x16x32_bf16 v[176:179], v[44:47], v[64:67], v[176:179]
ds_read_b64_tr_b16 v[104:105], v14 offset:24576
v_mfma_f32_16x16x32_bf16 v[192:195], v[48:51], v[64:67], v[192:195]
ds_read_b64_tr_b16 v[106:107], v14 offset:25600
v_mfma_f32_16x16x32_bf16 v[196:199], v[48:51], v[68:71], v[196:199]
s_add_u32 s72, s70, 30720
buffer_load_dwordx4 v4, s[4:7], s72 offen offset:2048 lds
v_mfma_f32_16x16x32_bf16 v[200:203], v[48:51], v[72:75], v[200:203]
ds_read_b64_tr_b16 v[108:109], v15 offset:24576
v_mfma_f32_16x16x32_bf16 v[204:207], v[48:51], v[76:79], v[204:207]
ds_read_b64_tr_b16 v[110:111], v15 offset:25600
v_mfma_f32_16x16x32_bf16 v[220:223], v[52:55], v[76:79], v[220:223]
v_mfma_f32_16x16x32_bf16 v[216:219], v[52:55], v[72:75], v[216:219]
v_mfma_f32_16x16x32_bf16 v[212:215], v[52:55], v[68:71], v[212:215]
s_add_u32 s72, s70, 46080
buffer_load_dwordx4 v5, s[4:7], s72 offen offset:3072 lds
v_mfma_f32_16x16x32_bf16 v[208:211], v[52:55], v[64:67], v[208:211]
v_mfma_f32_16x16x32_bf16 v[224:227], v[56:59], v[64:67], v[224:227]
v_mfma_f32_16x16x32_bf16 v[228:231], v[56:59], v[68:71], v[228:231]
v_mfma_f32_16x16x32_bf16 v[232:235], v[56:59], v[72:75], v[232:235]
v_mfma_f32_16x16x32_bf16 v[236:239], v[56:59], v[76:79], v[236:239]
v_mfma_f32_16x16x32_bf16 v[252:255], v[60:63], v[76:79], v[252:255]
v_mfma_f32_16x16x32_bf16 v[248:251], v[60:63], v[72:75], v[248:251]
v_mfma_f32_16x16x32_bf16 v[244:247], v[60:63], v[68:71], v[244:247]
s_waitcnt vmcnt(13) lgkmcnt(0)
v_mfma_f32_16x16x32_bf16 v[240:243], v[60:63], v[64:67], v[240:243]
s_barrier
v_mfma_f32_16x16x32_bf16 v[128:131], v[80:83], v[112:115], v[128:131]
s_waitcnt vmcnt(9)
v_cmp_gt_u32 vcc, 1, v3
s_cbranch_vccnz Lspin4
Lback5:
v_mfma_f32_16x16x32_bf16 v[132:135], v[80:83], v[116:119], v[132:135]
s_add_u32 m0, s64, 49152
ds_read_b64_tr_b16 v[32:33], v8 offset:32768
ds_read_b64_tr_b16 v[34:35], v8 offset:33792
v_mfma_f32_16x16x32_bf16 v[136:139], v[80:83], v[120:123], v[136:139]
s_add_u32 s72, s81, 16384
buffer_load_dwordx4 v1, s[44:47], s72 offen sc1 lds
v_mfma_f32_16x16x32_bf16 v[140:143], v[80:83], v[124:127], v[140:143]
ds_read_b128 v[64:67], v18 offset:32768
ds_read_b128 v[68:71], v18 offset:34816
v_mfma_f32_16x16x32_bf16 v[156:159], v[84:87], v[124:127], v[156:159]
ds_read_b128 v[72:75], v18 offset:36864
ds_read_b128 v[76:79], v18 offset:38912
v_mfma_f32_16x16x32_bf16 v[152:155], v[84:87], v[120:123], v[152:155]
buffer_load_dwordx4 v1, s[44:47], s72 offen offset:1024 sc1 lds
v_mfma_f32_16x16x32_bf16 v[148:151], v[84:87], v[116:119], v[148:151]
ds_read_b64_tr_b16 v[36:37], v9 offset:32768
ds_read_b64_tr_b16 v[38:39], v9 offset:33792
v_mfma_f32_16x16x32_bf16 v[144:147], v[84:87], v[112:115], v[144:147]
ds_read_b64_tr_b16 v[40:41], v10 offset:32768
v_mfma_f32_16x16x32_bf16 v[160:163], v[88:91], v[112:115], v[160:163]
ds_read_b64_tr_b16 v[42:43], v10 offset:33792
v_mfma_f32_16x16x32_bf16 v[164:167], v[88:91], v[116:119], v[164:167]
ds_read_b64_tr_b16 v[44:45], v11 offset:32768
v_mfma_f32_16x16x32_bf16 v[168:171], v[88:91], v[120:123], v[168:171]
buffer_load_dwordx4 v1, s[44:47], s72 offen offset:2048 sc1 lds
v_mfma_f32_16x16x32_bf16 v[172:175], v[88:91], v[124:127], v[172:175]
ds_read_b64_tr_b16 v[46:47], v11 offset:33792
v_mfma_f32_16x16x32_bf16 v[188:191], v[92:95], v[124:127], v[188:191]
ds_read_b64_tr_b16 v[48:49], v12 offset:32768
v_mfma_f32_16x16x32_bf16 v[184:187], v[92:95], v[120:123], v[184:187]
ds_read_b64_tr_b16 v[50:51], v12 offset:33792
v_mfma_f32_16x16x32_bf16 v[180:183], v[92:95], v[116:119], v[180:183]
ds_read_b64_tr_b16 v[52:53], v13 offset:32768
v_mfma_f32_16x16x32_bf16 v[176:179], v[92:95], v[112:115], v[176:179]
buffer_load_dwordx4 v1, s[44:47], s72 offen offset:3072 sc1 lds
v_mfma_f32_16x16x32_bf16 v[192:195], v[96:99], v[112:115], v[192:195]
ds_read_b64_tr_b16 v[54:55], v13 offset:33792
v_mfma_f32_16x16x32_bf16 v[196:199], v[96:99], v[116:119], v[196:199]
ds_read_b64_tr_b16 v[56:57], v14 offset:32768
v_mfma_f32_16x16x32_bf16 v[200:203], v[96:99], v[120:123], v[200:203]
ds_read_b64_tr_b16 v[58:59], v14 offset:33792
v_mfma_f32_16x16x32_bf16 v[204:207], v[96:99], v[124:127], v[204:207]
ds_read_b64_tr_b16 v[60:61], v15 offset:32768
v_mfma_f32_16x16x32_bf16 v[220:223], v[100:103], v[124:127], v[220:223]
s_add_u32 s81, s81, 0x8000
ds_read_b64_tr_b16 v[62:63], v15 offset:33792
v_mfma_f32_16x16x32_bf16 v[216:219], v[100:103], v[120:123], v[216:219]
s_add_u32 m0, s64, 81920
v_mfma_f32_16x16x32_bf16 v[212:215], v[100:103], v[116:119], v[212:215]
s_add_u32 s72, s81, 16384
buffer_load_dwordx4 v1, s[44:47], s72 offen sc1 lds
v_mfma_f32_16x16x32_bf16 v[208:211], v[100:103], v[112:115], v[208:211]
v_mfma_f32_16x16x32_bf16 v[224:227], v[104:107], v[112:115], v[224:227]
v_mfma_f32_16x16x32_bf16 v[228:231], v[104:107], v[116:119], v[228:231]
buffer_load_dwordx4 v1, s[44:47], s72 offen offset:1024 sc1 lds
v_mfma_f32_16x16x32_bf16 v[232:235], v[104:107], v[120:123], v[232:235]
v_mfma_f32_16x16x32_bf16 v[236:239], v[104:107], v[124:127], v[236:239]
v_mfma_f32_16x16x32_bf16 v[252:255], v[108:111], v[124:127], v[252:255]
v_mfma_f32_16x16x32_bf16 v[248:251], v[108:111], v[120:123], v[248:251]
v_mfma_f32_16x16x32_bf16 v[244:247], v[108:111], v[116:119], v[244:247]
buffer_load_dwordx4 v1, s[44:47], s72 offen offset:2048 sc1 lds
v_mfma_f32_16x16x32_bf16 v[240:243], v[108:111], v[112:115], v[240:243]
s_waitcnt lgkmcnt(0)
v_mfma_f32_16x16x32_bf16 v[128:131], v[32:35], v[64:67], v[128:131]
ds_read_b64_tr_b16 v[80:81], v8 offset:40960
ds_read_b64_tr_b16 v[82:83], v8 offset:41984
v_mfma_f32_16x16x32_bf16 v[132:135], v[32:35], v[68:71], v[132:135]
ds_read_b128 v[112:115], v19 offset:32768
ds_read_b128 v[116:119], v19 offset:34816
v_mfma_f32_16x16x32_bf16 v[136:139], v[32:35], v[72:75], v[136:139]
buffer_load_dwordx4 v1, s[44:47], s72 offen offset:3072 sc1 lds
v_mfma_f32_16x16x32_bf16 v[140:143], v[32:35], v[76:79], v[140:143]
ds_read_b128 v[120:123], v19 offset:36864
ds_read_b128 v[124:127], v19 offset:38912
v_mfma_f32_16x16x32_bf16 v[156:159], v[36:39], v[76:79], v[156:159]
ds_read_b64_tr_b16 v[84:85], v9 offset:40960
ds_read_b64_tr_b16 v[86:87], v9 offset:41984
v_mfma_f32_16x16x32_bf16 v[152:155], v[36:39], v[72:75], v[152:155]
ds_read_b64_tr_b16 v[88:89], v10 offset:40960
v_mfma_f32_16x16x32_bf16 v[148:151], v[36:39], v[68:71], v[148:151]
ds_read_b64_tr_b16 v[90:91], v10 offset:41984
v_mfma_f32_16x16x32_bf16 v[144:147], v[36:39], v[64:67], v[144:147]
s_add_u32 m0, s64, 65536
ds_read_b64_tr_b16 v[92:93], v11 offset:40960
v_mfma_f32_16x16x32_bf16 v[160:163], v[40:43], v[64:67], v[160:163]
s_add_u32 s72, s81, 0
buffer_load_dwordx4 v1, s[44:47], s72 offen sc1 lds
v_mfma_f32_16x16x32_bf16 v[164:167], v[40:43], v[68:71], v[164:167]
ds_read_b64_tr_b16 v[94:95], v11 offset:41984
v_mfma_f32_16x16x32_bf16 v[168:171], v[40:43], v[72:75], v[168:171]
ds_read_b64_tr_b16 v[96:97], v12 offset:40960
v_mfma_f32_16x16x32_bf16 v[172:175], v[40:43], v[76:79], v[172:175]
ds_read_b64_tr_b16 v[98:99], v12 offset:41984
v_mfma_f32_16x16x32_bf16 v[188:191], v[44:47], v[76:79], v[188:191]
buffer_load_dwordx4 v1, s[44:47], s72 offen offset:1024 sc1 lds
v_mfma_f32_16x16x32_bf16 v[184:187], v[44:47], v[72:75], v[184:187]
ds_read_b64_tr_b16 v[100:101], v13 offset:40960
v_mfma_f32_16x16x32_bf16 v[180:183], v[44:47], v[68:71], v[180:183]
ds_read_b64_tr_b16 v[102:103], v13 offset:41984
v_mfma_f32_16x16x32_bf16 v[176:179], v[44:47], v[64:67], v[176:179]
ds_read_b64_tr_b16 v[104:105], v14 offset:40960
v_mfma_f32_16x16x32_bf16 v[192:195], v[48:51], v[64:67], v[192:195]
ds_read_b64_tr_b16 v[106:107], v14 offset:41984
v_mfma_f32_16x16x32_bf16 v[196:199], v[48:51], v[68:71], v[196:199]
buffer_load_dwordx4 v1, s[44:47], s72 offen offset:2048 sc1 lds
v_mfma_f32_16x16x32_bf16 v[200:203], v[48:51], v[72:75], v[200:203]
ds_read_b64_tr_b16 v[108:109], v15 offset:40960
v_mfma_f32_16x16x32_bf16 v[204:207], v[48:51], v[76:79], v[204:207]
ds_read_b64_tr_b16 v[110:111], v15 offset:41984
v_mfma_f32_16x16x32_bf16 v[220:223], v[52:55], v[76:79], v[220:223]
v_mfma_f32_16x16x32_bf16 v[216:219], v[52:55], v[72:75], v[216:219]
v_mfma_f32_16x16x32_bf16 v[212:215], v[52:55], v[68:71], v[212:215]
buffer_load_dwordx4 v1, s[44:47], s72 offen offset:3072 sc1 lds
v_mfma_f32_16x16x32_bf16 v[208:211], v[52:55], v[64:67], v[208:211]
v_mfma_f32_16x16x32_bf16 v[224:227], v[56:59], v[64:67], v[224:227]
v_mfma_f32_16x16x32_bf16 v[228:231], v[56:59], v[68:71], v[228:231]
v_mfma_f32_16x16x32_bf16 v[232:235], v[56:59], v[72:75], v[232:235]
v_mfma_f32_16x16x32_bf16 v[236:239], v[56:59], v[76:79], v[236:239]
v_mfma_f32_16x16x32_bf16 v[252:255], v[60:63], v[76:79], v[252:255]
v_mfma_f32_16x16x32_bf16 v[248:251], v[60:63], v[72:75], v[248:251]
v_mfma_f32_16x16x32_bf16 v[244:247], v[60:63], v[68:71], v[244:247]
s_waitcnt vmcnt(12) lgkmcnt(0)
v_mfma_f32_16x16x32_bf16 v[240:243], v[60:63], v[64:67], v[240:243]
s_barrier
v_mfma_f32_16x16x32_bf16 v[128:131], v[80:83], v[112:115], v[128:131]
s_add_u32 s81, s81, 0x8000
ds_read_b64_tr_b16 v[32:33], v8 offset:0
ds_read_b64_tr_b16 v[34:35], v8 offset:1024
v_mfma_f32_16x16x32_bf16 v[132:135], v[80:83], v[116:119], v[132:135]
s_add_u32 m0, s64, 114688
ds_read_b128 v[64:67], v16 offset:0
ds_read_b128 v[68:71], v16 offset:2048
v_mfma_f32_16x16x32_bf16 v[136:139], v[80:83], v[120:123], v[136:139]
s_add_u32 s72, s81, 16384
buffer_load_dwordx4 v1, s[44:47], s72 offen sc1 lds
v_mfma_f32_16x16x32_bf16 v[140:143], v[80:83], v[124:127], v[140:143]
ds_read_b128 v[72:75], v16 offset:4096
ds_read_b128 v[76:79], v16 offset:6144
v_mfma_f32_16x16x32_bf16 v[156:159], v[84:87], v[124:127], v[156:159]
ds_read_b64_tr_b16 v[36:37], v9 offset:0
ds_read_b64_tr_b16 v[38:39], v9 offset:1024
v_mfma_f32_16x16x32_bf16 v[152:155], v[84:87], v[120:123], v[152:155]
ds_read_b64_tr_b16 v[40:41], v10 offset:0
v_mfma_f32_16x16x32_bf16 v[148:151], v[84:87], v[116:119], v[148:151]
ds_read_b64_tr_b16 v[42:43], v10 offset:1024
v_mfma_f32_16x16x32_bf16 v[144:147], v[84:87], v[112:115], v[144:147]
buffer_load_dwordx4 v1, s[44:47], s72 offen offset:1024 sc1 lds
v_mfma_f32_16x16x32_bf16 v[160:163], v[88:91], v[112:115], v[160:163]
ds_read_b64_tr_b16 v[44:45], v11 offset:0
v_mfma_f32_16x16x32_bf16 v[164:167], v[88:91], v[116:119], v[164:167]
ds_read_b64_tr_b16 v[46:47], v11 offset:1024
v_mfma_f32_16x16x32_bf16 v[168:171], v[88:91], v[120:123], v[168:171]
ds_read_b64_tr_b16 v[48:49], v12 offset:0
v_mfma_f32_16x16x32_bf16 v[172:175], v[88:91], v[124:127], v[172:175]
ds_read_b64_tr_b16 v[50:51], v12 offset:1024
v_mfma_f32_16x16x32_bf16 v[188:191], v[92:95], v[124:127], v[188:191]
ds_read_b64_tr_b16 v[52:53], v13 offset:0
v_mfma_f32_16x16x32_bf16 v[184:187], v[92:95], v[120:123], v[184:187]
ds_read_b64_tr_b16 v[54:55], v13 offset:1024
v_mfma_f32_16x16x32_bf16 v[180:183], v[92:95], v[116:119], v[180:183]
buffer_load_dwordx4 v1, s[44:47], s72 offen offset:2048 sc1 lds
v_mfma_f32_16x16x32_bf16 v[176:179], v[92:95], v[112:115], v[176:179]
ds_read_b64_tr_b16 v[56:57], v14 offset:0
v_mfma_f32_16x16x32_bf16 v[192:195], v[96:99], v[112:115], v[192:195]
ds_read_b64_tr_b16 v[58:59], v14 offset:1024
v_mfma_f32_16x16x32_bf16 v[196:199], v[96:99], v[116:119], v[196:199]
ds_read_b64_tr_b16 v[60:61], v15 offset:0
v_mfma_f32_16x16x32_bf16 v[200:203], v[96:99], v[120:123], v[200:203]
ds_read_b64_tr_b16 v[62:63], v15 offset:1024
v_mfma_f32_16x16x32_bf16 v[204:207], v[96:99], v[124:127], v[204:207]
v_mfma_f32_16x16x32_bf16 v[220:223], v[100:103], v[124:127], v[220:223]
v_mfma_f32_16x16x32_bf16 v[216:219], v[100:103], v[120:123], v[216:219]
v_mfma_f32_16x16x32_bf16 v[212:215], v[100:103], v[116:119], v[212:215]
buffer_load_dwordx4 v1, s[44:47], s72 offen offset:3072 sc1 lds
v_mfma_f32_16x16x32_bf16 v[208:211], v[100:103], v[112:115], v[208:211]
v_mfma_f32_16x16x32_bf16 v[224:227], v[104:107], v[112:115], v[224:227]
v_mfma_f32_16x16x32_bf16 v[228:231], v[104:107], v[116:119], v[228:231]
v_mfma_f32_16x16x32_bf16 v[232:235], v[104:107], v[120:123], v[232:235]
v_mfma_f32_16x16x32_bf16 v[236:239], v[104:107], v[124:127], v[236:239]
v_mfma_f32_16x16x32_bf16 v[252:255], v[108:111], v[124:127], v[252:255]
v_mfma_f32_16x16x32_bf16 v[248:251], v[108:111], v[120:123], v[248:251]
s_add_u32 m0, s64, 98304
v_mfma_f32_16x16x32_bf16 v[244:247], v[108:111], v[116:119], v[244:247]
s_add_u32 s72, s81, 0
buffer_load_dwordx4 v1, s[44:47], s72 offen sc1 lds
v_mfma_f32_16x16x32_bf16 v[240:243], v[108:111], v[112:115], v[240:243]
s_waitcnt lgkmcnt(0)
v_mfma_f32_16x16x32_bf16 v[128:131], v[32:35], v[64:67], v[128:131]
ds_read_b64_tr_b16 v[80:81], v8 offset:8192
v_add_u32 v2, 0x8000, v1
v_mfma_f32_16x16x32_bf16 v[132:135], v[32:35], v[68:71], v[132:135]
ds_read_b64_tr_b16 v[82:83], v8 offset:9216
ds_read_b128 v[112:115], v17 offset:0
v_mfma_f32_16x16x32_bf16 v[136:139], v[32:35], v[72:75], v[136:139]
ds_read_b128 v[116:119], v17 offset:2048
ds_read_b128 v[120:123], v17 offset:4096
v_mfma_f32_16x16x32_bf16 v[140:143], v[32:35], v[76:79], v[140:143]
ds_read_b128 v[124:127], v17 offset:6144
ds_read_b64_tr_b16 v[84:85], v9 offset:8192
v_mfma_f32_16x16x32_bf16 v[156:159], v[36:39], v[76:79], v[156:159]
buffer_load_dwordx4 v1, s[44:47], s72 offen offset:1024 sc1 lds
v_mfma_f32_16x16x32_bf16 v[152:155], v[36:39], v[72:75], v[152:155]
ds_read_b64_tr_b16 v[86:87], v9 offset:9216
v_mfma_f32_16x16x32_bf16 v[148:151], v[36:39], v[68:71], v[148:151]
ds_read_b64_tr_b16 v[88:89], v10 offset:8192
v_mfma_f32_16x16x32_bf16 v[144:147], v[36:39], v[64:67], v[144:147]
ds_read_b64_tr_b16 v[90:91], v10 offset:9216
v_mfma_f32_16x16x32_bf16 v[160:163], v[40:43], v[64:67], v[160:163]
ds_read_b64_tr_b16 v[92:93], v11 offset:8192
v_mfma_f32_16x16x32_bf16 v[164:167], v[40:43], v[68:71], v[164:167]
ds_read_b64_tr_b16 v[94:95], v11 offset:9216
v_mfma_f32_16x16x32_bf16 v[168:171], v[40:43], v[72:75], v[168:171]
ds_read_b64_tr_b16 v[96:97], v12 offset:8192
v_mfma_f32_16x16x32_bf16 v[172:175], v[40:43], v[76:79], v[172:175]
ds_read_b64_tr_b16 v[98:99], v12 offset:9216
v_mfma_f32_16x16x32_bf16 v[188:191], v[44:47], v[76:79], v[188:191]
buffer_load_dwordx4 v1, s[44:47], s72 offen offset:2048 sc1 lds
v_mfma_f32_16x16x32_bf16 v[184:187], v[44:47], v[72:75], v[184:187]
ds_read_b64_tr_b16 v[100:101], v13 offset:8192
v_mfma_f32_16x16x32_bf16 v[180:183], v[44:47], v[68:71], v[180:183]
ds_read_b64_tr_b16 v[102:103], v13 offset:9216
v_mfma_f32_16x16x32_bf16 v[176:179], v[44:47], v[64:67], v[176:179]
ds_read_b64_tr_b16 v[104:105], v14 offset:8192
v_mfma_f32_16x16x32_bf16 v[192:195], v[48:51], v[64:67], v[192:195]
ds_read_b64_tr_b16 v[106:107], v14 offset:9216
v_mfma_f32_16x16x32_bf16 v[196:199], v[48:51], v[68:71], v[196:199]
ds_read_b64_tr_b16 v[108:109], v15 offset:8192
v_mfma_f32_16x16x32_bf16 v[200:203], v[48:51], v[72:75], v[200:203]
ds_read_b64_tr_b16 v[110:111], v15 offset:9216
v_mfma_f32_16x16x32_bf16 v[204:207], v[48:51], v[76:79], v[204:207]
buffer_load_dwordx4 v1, s[44:47], s72 offen offset:3072 sc1 lds
v_mfma_f32_16x16x32_bf16 v[220:223], v[52:55], v[76:79], v[220:223]
v_mfma_f32_16x16x32_bf16 v[216:219], v[52:55], v[72:75], v[216:219]
v_mfma_f32_16x16x32_bf16 v[212:215], v[52:55], v[68:71], v[212:215]
v_mfma_f32_16x16x32_bf16 v[208:211], v[52:55], v[64:67], v[208:211]
v_mfma_f32_16x16x32_bf16 v[224:227], v[56:59], v[64:67], v[224:227]
v_mfma_f32_16x16x32_bf16 v[228:231], v[56:59], v[68:71], v[228:231]
v_mfma_f32_16x16x32_bf16 v[232:235], v[56:59], v[72:75], v[232:235]
v_mfma_f32_16x16x32_bf16 v[236:239], v[56:59], v[76:79], v[236:239]
v_mfma_f32_16x16x32_bf16 v[252:255], v[60:63], v[76:79], v[252:255]
v_mfma_f32_16x16x32_bf16 v[248:251], v[60:63], v[72:75], v[248:251]
v_mfma_f32_16x16x32_bf16 v[244:247], v[60:63], v[68:71], v[244:247]
s_waitcnt vmcnt(16) lgkmcnt(0)
v_mfma_f32_16x16x32_bf16 v[240:243], v[60:63], v[64:67], v[240:243]
s_barrier
v_mfma_f32_16x16x32_bf16 v[128:131], v[80:83], v[112:115], v[128:131]
ds_read_b128 a[128:131], v2 offset:16384
v_mfma_f32_16x16x32_bf16 v[132:135], v[80:83], v[116:119], v[132:135]
ds_read_b128 a[144:147], v2 offset:20480
v_mfma_f32_16x16x32_bf16 v[136:139], v[80:83], v[120:123], v[136:139]
ds_read_b128 a[132:135], v2 offset:17408
v_mfma_f32_16x16x32_bf16 v[140:143], v[80:83], v[124:127], v[140:143]
ds_read_b128 a[148:151], v2 offset:21504
v_mfma_f32_16x16x32_bf16 v[156:159], v[84:87], v[124:127], v[156:159]
ds_read_b128 a[136:139], v2 offset:18432
v_mfma_f32_16x16x32_bf16 v[152:155], v[84:87], v[120:123], v[152:155]
ds_read_b128 a[152:155], v2 offset:22528
v_mfma_f32_16x16x32_bf16 v[148:151], v[84:87], v[116:119], v[148:151]
ds_read_b128 a[140:143], v2 offset:19456
v_mfma_f32_16x16x32_bf16 v[144:147], v[84:87], v[112:115], v[144:147]
ds_read_b128 a[156:159], v2 offset:23552
v_mfma_f32_16x16x32_bf16 v[160:163], v[88:91], v[112:115], v[160:163]
v_mfma_f32_16x16x32_bf16 v[164:167], v[88:91], v[116:119], v[164:167]
v_mfma_f32_16x16x32_bf16 v[168:171], v[88:91], v[120:123], v[168:171]
v_mfma_f32_16x16x32_bf16 v[172:175], v[88:91], v[124:127], v[172:175]
v_mfma_f32_16x16x32_bf16 v[188:191], v[92:95], v[124:127], v[188:191]
v_cvt_pk_bf16_f32 v64, v140, v141
v_cvt_pk_bf16_f32 v65, v142, v143
v_mfma_f32_16x16x32_bf16 v[184:187], v[92:95], v[120:123], v[184:187]
v_cvt_pk_bf16_f32 v66, v156, v157
v_cvt_pk_bf16_f32 v67, v158, v159
v_mfma_f32_16x16x32_bf16 v[180:183], v[92:95], v[116:119], v[180:183]
v_cvt_pk_bf16_f32 v48, v136, v137
v_cvt_pk_bf16_f32 v49, v138, v139
v_mfma_f32_16x16x32_bf16 v[176:179], v[92:95], v[112:115], v[176:179]
v_cvt_pk_bf16_f32 v50, v152, v153
v_cvt_pk_bf16_f32 v51, v154, v155
v_mfma_f32_16x16x32_bf16 v[192:195], v[96:99], v[112:115], v[192:195]
v_cvt_pk_bf16_f32 v32, v132, v133
v_cvt_pk_bf16_f32 v33, v134, v135
v_mfma_f32_16x16x32_bf16 v[196:199], v[96:99], v[116:119], v[196:199]
v_cvt_pk_bf16_f32 v34, v148, v149
v_cvt_pk_bf16_f32 v35, v150, v151
v_mfma_f32_16x16x32_bf16 v[200:203], v[96:99], v[120:123], v[200:203]
v_cvt_pk_bf16_f32 v16, v128, v129
v_cvt_pk_bf16_f32 v17, v130, v131
v_mfma_f32_16x16x32_bf16 v[204:207], v[96:99], v[124:127], v[204:207]
v_cvt_pk_bf16_f32 v18, v144, v145
v_cvt_pk_bf16_f32 v19, v146, v147
v_mfma_f32_16x16x32_bf16 v[220:223], v[100:103], v[124:127], v[220:223]
v_cvt_pk_bf16_f32 v68, v172, v173
v_cvt_pk_bf16_f32 v69, v174, v175
v_mfma_f32_16x16x32_bf16 v[216:219], v[100:103], v[120:123], v[216:219]
v_cvt_pk_bf16_f32 v70, v188, v189
v_cvt_pk_bf16_f32 v71, v190, v191
v_mfma_f32_16x16x32_bf16 v[212:215], v[100:103], v[116:119], v[212:215]
v_cvt_pk_bf16_f32 v52, v168, v169
v_cvt_pk_bf16_f32 v53, v170, v171
v_mfma_f32_16x16x32_bf16 v[208:211], v[100:103], v[112:115], v[208:211]
v_cvt_pk_bf16_f32 v54, v184, v185
v_cvt_pk_bf16_f32 v55, v186, v187
v_mfma_f32_16x16x32_bf16 v[224:227], v[104:107], v[112:115], v[224:227]
v_cvt_pk_bf16_f32 v36, v164, v165
v_cvt_pk_bf16_f32 v37, v166, v167
v_mfma_f32_16x16x32_bf16 v[228:231], v[104:107], v[116:119], v[228:231]
v_cvt_pk_bf16_f32 v38, v180, v181
v_cvt_pk_bf16_f32 v39, v182, v183
v_mfma_f32_16x16x32_bf16 v[232:235], v[104:107], v[120:123], v[232:235]
v_cvt_pk_bf16_f32 v20, v160, v161
v_cvt_pk_bf16_f32 v21, v162, v163
v_mfma_f32_16x16x32_bf16 v[236:239], v[104:107], v[124:127], v[236:239]
v_cvt_pk_bf16_f32 v22, v176, v177
v_cvt_pk_bf16_f32 v23, v178, v179
v_mfma_f32_16x16x32_bf16 v[252:255], v[108:111], v[124:127], v[252:255]
v_cvt_pk_bf16_f32 v72, v204, v205
v_cvt_pk_bf16_f32 v73, v206, v207
v_mfma_f32_16x16x32_bf16 v[248:251], v[108:111], v[120:123], v[248:251]
v_cvt_pk_bf16_f32 v74, v220, v221
v_cvt_pk_bf16_f32 v75, v222, v223
v_mfma_f32_16x16x32_bf16 v[244:247], v[108:111], v[116:119], v[244:247]
v_cvt_pk_bf16_f32 v56, v200, v201
v_cvt_pk_bf16_f32 v57, v202, v203
v_mfma_f32_16x16x32_bf16 v[240:243], v[108:111], v[112:115], v[240:243]
v_cvt_pk_bf16_f32 v58, v216, v217
v_cvt_pk_bf16_f32 v59, v218, v219
v_cvt_pk_bf16_f32 v40, v196, v197
v_cvt_pk_bf16_f32 v41, v198, v199
v_cvt_pk_bf16_f32 v42, v212, v213
v_cvt_pk_bf16_f32 v43, v214, v215
v_cvt_pk_bf16_f32 v24, v192, v193
v_cvt_pk_bf16_f32 v25, v194, v195
v_cvt_pk_bf16_f32 v26, v208, v209
v_cvt_pk_bf16_f32 v27, v210, v211
v_cvt_pk_bf16_f32 v76, v236, v237
v_cvt_pk_bf16_f32 v77, v238, v239
v_cvt_pk_bf16_f32 v78, v252, v253
v_cvt_pk_bf16_f32 v79, v254, v255
v_cvt_pk_bf16_f32 v60, v232, v233
v_cvt_pk_bf16_f32 v61, v234, v235
v_cvt_pk_bf16_f32 v62, v248, v249
v_cvt_pk_bf16_f32 v63, v250, v251
v_cvt_pk_bf16_f32 v44, v228, v229
v_cvt_pk_bf16_f32 v45, v230, v231
v_cvt_pk_bf16_f32 v46, v244, v245
v_cvt_pk_bf16_f32 v47, v246, v247
v_cvt_pk_bf16_f32 v28, v224, v225
v_cvt_pk_bf16_f32 v29, v226, v227
v_cvt_pk_bf16_f32 v30, v240, v241
v_cvt_pk_bf16_f32 v31, v242, v243
v_mov_b32 v124, 0xff800000
v_mov_b32 v125, 0xff800000
v_mov_b32 v126, 0xff800000
v_mov_b32 v127, 0xff800000
s_lshl_b32 s84, s60, 2
s_add_u32 s84, s84, s58
s_lshl_b32 s85, s60, 3
s_sub_u32 s85, s58, s85
s_add_u32 s85, s85, 56
s_mov_b32 s86, 0
Lattn:
s_mov_b32 s82, 0x10000
s_waitcnt lgkmcnt(0)
v_mfma_f32_16x16x32_bf16 v[136:139], a[128:131], v[48:51], 0
ds_read_b128 a[160:163], v2 offset:24576
v_lshrrev_b32 v240, 4, v0
v_mfma_f32_16x16x32_bf16 v[140:143], a[128:131], v[64:67], 0
ds_read_b128 a[176:179], v2 offset:28672
v_and_b32 v241, 15, v0
v_mfma_f32_16x16x32_bf16 v[152:155], a[144:147], v[48:51], 0
ds_read_b128 a[164:167], v2 offset:25600
v_lshlrev_b32 v240, 2, v240
v_mfma_f32_16x16x32_bf16 v[156:159], a[144:147], v[64:67], 0
ds_read_b128 a[180:183], v2 offset:29696
v_sub_u32 v240, v241, v240
v_mfma_f32_16x16x32_bf16 v[136:139], a[132:135], v[52:55], v[136:139]
ds_read_b128 a[168:171], v2 offset:26624
v_mov_b32 v112, 0xff800000
v_mfma_f32_16x16x32_bf16 v[140:143], a[132:135], v[68:71], v[140:143]
ds_read_b128 a[184:187], v2 offset:30720
v_mov_b32 v113, 0xff800000
v_mfma_f32_16x16x32_bf16 v[156:159], a[148:151], v[68:71], v[156:159]
ds_read_b128 a[172:175], v2 offset:27648
v_mov_b32 v114, 0xff800000
v_mfma_f32_16x16x32_bf16 v[152:155], a[148:151], v[52:55], v[152:155]
ds_read_b128 a[188:191], v2 offset:31744
v_mov_b32 v115, 0xff800000
v_mfma_f32_16x16x32_bf16 v[140:143], a[136:139], v[72:75], v[140:143]
v_cmp_gt_i32 vcc, 0, v240
v_mov_b32 v120, 0x3f803f80
v_mfma_f32_16x16x32_bf16 v[136:139], a[136:139], v[56:59], v[136:139]
v_cndmask_b32 v116, 0, v112, vcc
v_cmp_gt_i32 vcc, 1, v240
v_mfma_f32_16x16x32_bf16 v[152:155], a[152:155], v[56:59], v[152:155]
v_mov_b32 v121, 0x3f803f80
v_cndmask_b32 v117, 0, v112, vcc
v_mfma_f32_16x16x32_bf16 v[156:159], a[152:155], v[72:75], v[156:159]
v_cmp_gt_i32 vcc, 2, v240
v_mov_b32 v122, 0x3f803f80
v_mfma_f32_16x16x32_bf16 v[136:139], a[140:143], v[60:63], v[136:139]
v_cndmask_b32 v118, 0, v112, vcc
v_cmp_gt_i32 vcc, 3, v240
v_mfma_f32_16x16x32_bf16 v[140:143], a[140:143], v[76:79], v[140:143]
v_mov_b32 v123, 0x3f803f80
v_cndmask_b32 v119, 0, v112, vcc
v_mfma_f32_16x16x32_bf16 v[156:159], a[156:159], v[76:79], v[156:159]
v_mfma_f32_16x16x32_bf16 v[152:155], a[156:159], v[60:63], v[152:155]
s_cmp_eq_u32 s84, 0
s_cbranch_scc1 Lalt7
v_mfma_f32_16x16x32_bf16 v[128:131], a[128:131], v[16:19], 0
v_mfma_f32_16x16x32_bf16 v[132:135], a[128:131], v[32:35], 0
v_mfma_f32_16x16x32_bf16 v[144:147], a[144:147], v[16:19], 0
v_mfma_f32_16x16x32_bf16 v[148:151], a[144:147], v[32:35], 0
Ljoin8:
v_mfma_f32_16x16x32_bf16 v[128:131], a[132:135], v[20:23], v[128:131]
v_mfma_f32_16x16x32_bf16 v[132:135], a[132:135], v[36:39], v[132:135]
v_max3_f32 v240, v136, v137, v126
v_max3_f32 v242, v140, v141, v127
v_mfma_f32_16x16x32_bf16 v[148:151], a[148:151], v[36:39], v[148:151]
v_max3_f32 v240, v240, v138, v139
v_max3_f32 v242, v242, v142, v143
v_mfma_f32_16x16x32_bf16 v[144:147], a[148:151], v[20:23], v[144:147]
v_max3_f32 v240, v240, v152, v153
v_max3_f32 v242, v242, v156, v157
v_mfma_f32_16x16x32_bf16 v[132:135], a[136:139], v[40:43], v[132:135]
v_max3_f32 v240, v240, v154, v155
v_max3_f32 v242, v242, v158, v159
v_mfma_f32_16x16x32_bf16 v[128:131], a[136:139], v[24:27], v[128:131]
v_mov_b32 v241, v240
v_mov_b32 v243, v242
v_mfma_f32_16x16x32_bf16 v[144:147], a[152:155], v[24:27], v[144:147]
v_permlane16_swap_b32 v240, v241
v_permlane16_swap_b32 v242, v243
v_mfma_f32_16x16x32_bf16 v[148:151], a[152:155], v[40:43], v[148:151]
v_max_f32 v240, v240, v241
v_max_f32 v242, v242, v243
v_mfma_f32_16x16x32_bf16 v[128:131], a[140:143], v[28:31], v[128:131]
v_mov_b32 v241, v240
v_mov_b32 v243, v242
v_mfma_f32_16x16x32_bf16 v[132:135], a[140:143], v[44:47], v[132:135]
v_permlane32_swap_b32 v240, v241
v_permlane32_swap_b32 v242, v243
v_mfma_f32_16x16x32_bf16 v[148:151], a[156:159], v[44:47], v[148:151]
v_max_f32 v240, v240, v241
v_max_f32 v242, v242, v243
v_mfma_f32_16x16x32_bf16 v[144:147], a[156:159], v[28:31], v[144:147]
v_sub_f32 v88, 0, v240
v_sub_f32 v89, 0, v240
v_sub_f32 v90, 0, v240
v_sub_f32 v91, 0, v240
v_sub_f32 v104, v116, v240
v_sub_f32 v105, v117, v240
v_sub_f32 v106, v118, v240
v_sub_f32 v107, v119, v240
v_sub_f32 v136, v136, v240
v_sub_f32 v137, v137, v240
v_sub_f32 v138, v138, v240
v_sub_f32 v139, v139, v240
v_sub_f32 v152, v152, v240
v_sub_f32 v153, v153, v240
v_sub_f32 v154, v154, v240
v_sub_f32 v155, v155, v240
v_sub_f32 v92, 0, v242
v_sub_f32 v93, 0, v242
v_sub_f32 v94, 0, v242
v_sub_f32 v95, 0, v242
v_sub_f32 v108, v116, v242
v_sub_f32 v109, v117, v242
v_sub_f32 v110, v118, v242
v_sub_f32 v111, v119, v242
v_sub_f32 v140, v140, v242
v_sub_f32 v141, v141, v242
v_sub_f32 v142, v142, v242
v_sub_f32 v143, v143, v242
v_sub_f32 v156, v156, v242
v_sub_f32 v157, v157, v242
v_sub_f32 v158, v158, v242
v_sub_f32 v159, v159, v242
v_max3_f32 v240, v128, v129, v124
v_max3_f32 v242, v132, v133, v125
v_max3_f32 v240, v240, v130, v131
v_max3_f32 v242, v242, v134, v135
v_max3_f32 v240, v240, v144, v145
v_max3_f32 v242, v242, v148, v149
v_max3_f32 v240, v240, v146, v147
v_max3_f32 v242, v242, v150, v151
v_mov_b32 v241, v240
v_mov_b32 v243, v242
s_nop 0
v_permlane16_swap_b32 v240, v241
v_permlane16_swap_b32 v242, v243
v_max_f32 v240, v240, v241
v_max_f32 v242, v242, v243
v_mov_b32 v241, v240
v_mov_b32 v243, v242
s_nop 0
v_permlane32_swap_b32 v240, v241
v_permlane32_swap_b32 v242, v243
v_max_f32 v240, v240, v241
v_max_f32 v242, v242, v243
v_sub_f32 v80, 0, v240
v_sub_f32 v81, 0, v240
v_sub_f32 v82, 0, v240
v_sub_f32 v83, 0, v240
v_sub_f32 v96, v116, v240
v_sub_f32 v97, v117, v240
v_sub_f32 v98, v118, v240
v_sub_f32 v99, v119, v240
v_sub_f32 v128, v128, v240
v_sub_f32 v129, v129, v240
v_sub_f32 v130, v130, v240
v_sub_f32 v131, v131, v240
v_sub_f32 v144, v144, v240
v_sub_f32 v145, v145, v240
v_sub_f32 v146, v146, v240
v_sub_f32 v147, v147, v240
v_sub_f32 v84, 0, v242
v_sub_f32 v85, 0, v242
v_sub_f32 v86, 0, v242
v_sub_f32 v87, 0, v242
v_sub_f32 v100, v116, v242
v_sub_f32 v101, v117, v242
v_sub_f32 v102, v118, v242
v_sub_f32 v103, v119, v242
v_sub_f32 v132, v132, v242
v_sub_f32 v133, v133, v242
v_sub_f32 v134, v134, v242
v_sub_f32 v135, v135, v242
v_sub_f32 v148, v148, v242
v_sub_f32 v149, v149, v242
v_sub_f32 v150, v150, v242
v_sub_f32 v151, v151, v242
v_add_u32 v2, s82, v1
s_waitcnt vmcnt(8) lgkmcnt(0)
s_barrier
s_cmp_le_u32 s84, 1
s_cbranch_scc1 Lalt9
v_mfma_f32_16x16x32_bf16 v[160:163], a[160:163], v[16:19], v[80:83]
s_xor_b32 s74, s82, 0x10000
v_exp_f32 v128, v128
v_mfma_f32_16x16x32_bf16 v[164:167], a[160:163], v[32:35], v[84:87]
s_add_u32 s74, s74, s64
ds_read_b128 a[128:131], v2 offset:16384
ds_read_b128 a[144:147], v2 offset:20480
v_mfma_f32_16x16x32_bf16 v[176:179], a[176:179], v[16:19], v[80:83]
s_add_u32 s81, s81, 0x8000
v_exp_f32 v129, v129
v_mfma_f32_16x16x32_bf16 v[180:183], a[176:179], v[32:35], v[84:87]
s_add_u32 m0, s74, 16384
v_exp_f32 v130, v130
Ljoin11:
v_mfma_f32_16x16x32_bf16 v[168:171], a[160:163], v[48:51], v[88:91]
s_add_u32 s72, s81, 16384
v_exp_f32 v131, v131
v_mfma_f32_16x16x32_bf16 v[172:175], a[160:163], v[64:67], v[92:95]
v_exp_f32 v144, v144
v_mfma_f32_16x16x32_bf16 v[184:187], a[176:179], v[48:51], v[88:91]
ds_read_b128 a[132:135], v2 offset:17408
ds_read_b128 a[148:151], v2 offset:21504
v_mfma_f32_16x16x32_bf16 v[188:191], a[176:179], v[64:67], v[92:95]
ds_read_b128 a[136:139], v2 offset:18432
ds_read_b128 a[152:155], v2 offset:22528
v_mfma_f32_16x16x32_bf16 v[160:163], a[164:167], v[20:23], v[160:163]
ds_read_b128 a[140:143], v2 offset:19456
ds_read_b128 a[156:159], v2 offset:23552
v_mfma_f32_16x16x32_bf16 v[164:167], a[164:167], v[36:39], v[164:167]
ds_read_b128 a[192:195], v2 offset:0
ds_read_b128 a[196:199], v2 offset:1024
v_mfma_f32_16x16x32_bf16 v[168:171], a[164:167], v[52:55], v[168:171]
ds_read_b128 a[200:203], v2 offset:2048
ds_read_b128 a[204:207], v2 offset:3072
v_mfma_f32_16x16x32_bf16 v[172:175], a[164:167], v[68:71], v[172:175]
ds_read_b128 a[208:211], v2 offset:4096
ds_read_b128 a[212:215], v2 offset:5120
v_mfma_f32_16x16x32_bf16 v[188:191], a[180:183], v[68:71], v[188:191]
ds_read_b128 a[216:219], v2 offset:6144
ds_read_b128 a[220:223], v2 offset:7168
v_mfma_f32_16x16x32_bf16 v[184:187], a[180:183], v[52:55], v[184:187]
v_cvt_pk_bf16_f32 v192, v128, v129
v_cvt_pk_bf16_f32 v193, v130, v131
v_mfma_f32_16x16x32_bf16 v[180:183], a[180:183], v[36:39], v[180:183]
buffer_load_dwordx4 v1, s[44:47], s72 offen sc1 lds
v_mfma_f32_16x16x32_bf16 v[176:179], a[180:183], v[20:23], v[176:179]
v_exp_f32 v145, v145
v_mfma_f32_16x16x32_bf16 v[172:175], a[168:171], v[72:75], v[172:175]
v_exp_f32 v146, v146
v_mfma_f32_16x16x32_bf16 v[168:171], a[168:171], v[56:59], v[168:171]
v_exp_f32 v147, v147
v_mfma_f32_16x16x32_bf16 v[164:167], a[168:171], v[40:43], v[164:167]
v_exp_f32 v132, v132
v_mfma_f32_16x16x32_bf16 v[160:163], a[168:171], v[24:27], v[160:163]
v_cvt_pk_bf16_f32 v194, v144, v145
v_cvt_pk_bf16_f32 v195, v146, v147
v_mfma_f32_16x16x32_bf16 v[176:179], a[184:187], v[24:27], v[176:179]
v_exp_f32 v133, v133
v_mfma_f32_16x16x32_bf16 v[180:183], a[184:187], v[40:43], v[180:183]
v_exp_f32 v134, v134
v_mfma_f32_16x16x32_bf16 v[184:187], a[184:187], v[56:59], v[184:187]
v_exp_f32 v135, v135
v_mfma_f32_16x16x32_bf16 v[188:191], a[184:187], v[72:75], v[188:191]
v_exp_f32 v148, v148
v_mfma_f32_16x16x32_bf16 v[160:163], a[172:175], v[28:31], v[160:163]
v_cvt_pk_bf16_f32 v196, v132, v133
v_cvt_pk_bf16_f32 v197, v134, v135
v_mfma_f32_16x16x32_bf16 v[164:167], a[172:175], v[44:47], v[164:167]
buffer_load_dwordx4 v1, s[44:47], s72 offen offset:1024 sc1 lds
v_mfma_f32_16x16x32_bf16 v[168:171], a[172:175], v[60:63], v[168:171]
v_exp_f32 v149, v149
v_mfma_f32_16x16x32_bf16 v[172:175], a[172:175], v[76:79], v[172:175]
v_exp_f32 v150, v150
v_mfma_f32_16x16x32_bf16 v[188:191], a[188:191], v[76:79], v[188:191]
v_exp_f32 v151, v151
v_mfma_f32_16x16x32_bf16 v[184:187], a[188:191], v[60:63], v[184:187]
buffer_load_dwordx4 v1, s[44:47], s72 offen offset:2048 sc1 lds
v_mfma_f32_16x16x32_bf16 v[180:183], a[188:191], v[44:47], v[180:183]
buffer_load_dwordx4 v1, s[44:47], s72 offen offset:3072 sc1 lds
v_mfma_f32_16x16x32_bf16 v[176:179], a[188:191], v[28:31], v[176:179]
s_waitcnt lgkmcnt(8)
v_exp_f32 v136, v136
v_cvt_pk_bf16_f32 v198, v148, v149
v_cvt_pk_bf16_f32 v199, v150, v151
v_exp_f32 v137, v137
v_exp_f32 v138, v138
v_cvt_pk_bf16_f32 v200, v136, v137
v_exp_f32 v139, v139
v_exp_f32 v152, v152
v_cvt_pk_bf16_f32 v201, v138, v139
v_exp_f32 v153, v153
v_exp_f32 v154, v154
v_cvt_pk_bf16_f32 v202, v152, v153
v_exp_f32 v155, v155
v_exp_f32 v140, v140
v_cvt_pk_bf16_f32 v203, v154, v155
v_exp_f32 v141, v141
v_exp_f32 v142, v142
v_cvt_pk_bf16_f32 v204, v140, v141
v_exp_f32 v143, v143
v_exp_f32 v156, v156
v_cvt_pk_bf16_f32 v205, v142, v143
v_exp_f32 v157, v157
v_exp_f32 v158, v158
v_cvt_pk_bf16_f32 v206, v156, v157
v_exp_f32 v159, v159
s_nop 0
v_cvt_pk_bf16_f32 v207, v158, v159
s_cmp_le_u32 s84, 2
s_cbranch_scc1 Lalt12
v_mfma_f32_16x16x32_bf16 v[128:131], a[128:131], v[16:19], v[80:83]
s_add_u32 s82, s82, 0x8000
ds_read_b128 a[160:163], v2 offset:24576
v_mfma_f32_16x16x32_bf16 v[132:135], a[128:131], v[32:35], v[84:87]
s_and_b32 s82, s82, 0x1ffff
v_exp_f32 v160, v160
v_mfma_f32_16x16x32_bf16 v[144:147], a[144:147], v[16:19], v[80:83]
s_add_u32 m0, s74, 0
v_exp_f32 v161, v161
v_mfma_f32_16x16x32_bf16 v[148:151], a[144:147], v[32:35], v[84:87]
s_add_u32 s72, s81, 0
ds_read_b128 a[176:179], v2 offset:28672
v_cvt_pk_bf16_f32 v208, v160, v161
Ljoin14:
v_mfma_f32_16x16x32_bf16 v[136:139], a[128:131], v[48:51], v[88:91]
v_exp_f32 v162, v162
v_mfma_f32_16x16x32_bf16 v[140:143], a[128:131], v[64:67], v[92:95]
v_exp_f32 v163, v163
v_mfma_f32_16x16x32_bf16 v[152:155], a[144:147], v[48:51], v[88:91]
ds_read_b128 a[164:167], v2 offset:25600
v_cvt_pk_bf16_f32 v209, v162, v163
v_mfma_f32_16x16x32_bf16 v[156:159], a[144:147], v[64:67], v[92:95]
v_exp_f32 v176, v176
v_mfma_f32_16x16x32_bf16 v[128:131], a[132:135], v[20:23], v[128:131]
buffer_load_dwordx4 v1, s[44:47], s72 offen sc1 lds
v_mfma_f32_16x16x32_bf16 v[132:135], a[132:135], v[36:39], v[132:135]
v_exp_f32 v177, v177
v_mfma_f32_16x16x32_bf16 v[136:139], a[132:135], v[52:55], v[136:139]
ds_read_b128 a[180:183], v2 offset:29696
v_cvt_pk_bf16_f32 v210, v176, v177
v_mfma_f32_16x16x32_bf16 v[140:143], a[132:135], v[68:71], v[140:143]
v_exp_f32 v178, v178
v_mfma_f32_16x16x32_bf16 v[156:159], a[148:151], v[68:71], v[156:159]
v_exp_f32 v179, v179
v_mfma_f32_16x16x32_bf16 v[152:155], a[148:151], v[52:55], v[152:155]
ds_read_b128 a[168:171], v2 offset:26624
v_cvt_pk_bf16_f32 v211, v178, v179
v_mfma_f32_16x16x32_bf16 v[148:151], a[148:151], v[36:39], v[148:151]
v_exp_f32 v164, v164
v_mfma_f32_16x16x32_bf16 v[144:147], a[148:151], v[20:23], v[144:147]
v_exp_f32 v165, v165
v_mfma_f32_16x16x32_bf16 v[140:143], a[136:139], v[72:75], v[140:143]
ds_read_b128 a[184:187], v2 offset:30720
v_cvt_pk_bf16_f32 v212, v164, v165
v_mfma_f32_16x16x32_bf16 v[136:139], a[136:139], v[56:59], v[136:139]
v_exp_f32 v166, v166
v_mfma_f32_16x16x32_bf16 v[132:135], a[136:139], v[40:43], v[132:135]
v_exp_f32 v167, v167
v_mfma_f32_16x16x32_bf16 v[128:131], a[136:139], v[24:27], v[128:131]
ds_read_b128 a[172:175], v2 offset:27648
v_cvt_pk_bf16_f32 v213, v166, v167
v_mfma_f32_16x16x32_bf16 v[144:147], a[152:155], v[24:27], v[144:147]
v_exp_f32 v180, v180
v_mfma_f32_16x16x32_bf16 v[148:151], a[152:155], v[40:43], v[148:151]
buffer_load_dwordx4 v1, s[44:47], s72 offen offset:1024 sc1 lds
v_mfma_f32_16x16x32_bf16 v[152:155], a[152:155], v[56:59], v[152:155]
v_exp_f32 v181, v181
v_mfma_f32_16x16x32_bf16 v[156:159], a[152:155], v[72:75], v[156:159]
ds_read_b128 a[188:191], v2 offset:31744
v_cvt_pk_bf16_f32 v214, v180, v181
v_mfma_f32_16x16x32_bf16 v[128:131], a[140:143], v[28:31], v[128:131]
v_exp_f32 v182, v182
v_mfma_f32_16x16x32_bf16 v[132:135], a[140:143], v[44:47], v[132:135]
v_exp_f32 v183, v183
v_mfma_f32_16x16x32_bf16 v[136:139], a[140:143], v[60:63], v[136:139]
ds_read_b128 a[224:227], v2 offset:8192
v_cvt_pk_bf16_f32 v215, v182, v183
v_mfma_f32_16x16x32_bf16 v[140:143], a[140:143], v[76:79], v[140:143]
v_exp_f32 v168, v168
v_mfma_f32_16x16x32_bf16 v[156:159], a[156:159], v[76:79], v[156:159]
v_exp_f32 v169, v169
v_mfma_f32_16x16x32_bf16 v[152:155], a[156:159], v[60:63], v[152:155]
ds_read_b128 a[228:231], v2 offset:9216
v_cvt_pk_bf16_f32 v216, v168, v169
v_mfma_f32_16x16x32_bf16 v[148:151], a[156:159], v[44:47], v[148:151]
v_exp_f32 v170, v170
v_mfma_f32_16x16x32_bf16 v[144:147], a[156:159], v[28:31], v[144:147]
s_waitcnt lgkmcnt(10)
v_exp_f32 v171, v171
v_mfma_f32_16x16x32_bf16 a[0:3], a[192:195], v[192:195], 0
ds_read_b128 a[232:235], v2 offset:10240
v_cvt_pk_bf16_f32 v217, v170, v171
v_mfma_f32_16x16x32_bf16 a[32:35], a[192:195], v[196:199], 0
v_exp_f32 v184, v184
v_mfma_f32_16x16x32_bf16 a[64:67], a[192:195], v[200:203], 0
buffer_load_dwordx4 v1, s[44:47], s72 offen offset:2048 sc1 lds
v_mfma_f32_16x16x32_bf16 a[96:99], a[192:195], v[204:207], 0
v_exp_f32 v185, v185
v_mfma_f32_16x16x32_bf16 a[100:103], a[196:199], v[204:207], 0
ds_read_b128 a[236:239], v2 offset:11264
v_cvt_pk_bf16_f32 v218, v184, v185
v_mfma_f32_16x16x32_bf16 a[68:71], a[196:199], v[200:203], 0
v_exp_f32 v186, v186
v_mfma_f32_16x16x32_bf16 a[36:39], a[196:199], v[196:199], 0
v_exp_f32 v187, v187
v_mfma_f32_16x16x32_bf16 a[4:7], a[196:199], v[192:195], 0
ds_read_b128 a[240:243], v2 offset:12288
v_cvt_pk_bf16_f32 v219, v186, v187
v_mfma_f32_16x16x32_bf16 a[8:11], a[200:203], v[192:195], 0
v_exp_f32 v172, v172
v_mfma_f32_16x16x32_bf16 a[40:43], a[200:203], v[196:199], 0
v_exp_f32 v173, v173
v_mfma_f32_16x16x32_bf16 a[72:75], a[200:203], v[200:203], 0
ds_read_b128 a[244:247], v2 offset:13312
v_cvt_pk_bf16_f32 v220, v172, v173
v_mfma_f32_16x16x32_bf16 a[104:107], a[200:203], v[204:207], 0
v_exp_f32 v174, v174
v_mfma_f32_16x16x32_bf16 a[108:111], a[204:207], v[204:207], 0
v_exp_f32 v175, v175
v_mfma_f32_16x16x32_bf16 a[76:79], a[204:207], v[200:203], 0
ds_read_b128 a[248:251], v2 offset:14336
v_cvt_pk_bf16_f32 v221, v174, v175
v_mfma_f32_16x16x32_bf16 a[44:47], a[204:207], v[196:199], 0
v_exp_f32 v188, v188
v_mfma_f32_16x16x32_bf16 a[12:15], a[204:207], v[192:195], 0
buffer_load_dwordx4 v1, s[44:47], s72 offen offset:3072 sc1 lds
v_mfma_f32_16x16x32_bf16 a[16:19], a[208:211], v[192:195], 0
v_exp_f32 v189, v189
v_mfma_f32_16x16x32_bf16 a[48:51], a[208:211], v[196:199], 0
ds_read_b128 a[252:255], v2 offset:15360
v_cvt_pk_bf16_f32 v222, v188, v189
v_mfma_f32_16x16x32_bf16 a[80:83], a[208:211], v[200:203], 0
v_exp_f32 v190, v190
v_mfma_f32_16x16x32_bf16 a[112:115], a[208:211], v[204:207], 0
v_exp_f32 v191, v191
v_mfma_f32_16x16x32_bf16 a[116:119], a[212:215], v[204:207], 0
v_cvt_pk_bf16_f32 v223, v190, v191
v_add_u32 v2, s82, v1
v_mfma_f32_16x16x32_bf16 a[84:87], a[212:215], v[200:203], 0
v_mfma_f32_16x16x32_bf16 a[52:55], a[212:215], v[196:199], 0
v_mfma_f32_16x16x32_bf16 a[20:23], a[212:215], v[192:195], 0
v_mfma_f32_16x16x32_bf16 a[24:27], a[216:219], v[192:195], 0
v_mfma_f32_16x16x32_bf16 a[56:59], a[216:219], v[196:199], 0
v_mfma_f32_16x16x32_bf16 a[88:91], a[216:219], v[200:203], 0
v_mfma_f32_16x16x32_bf16 a[120:123], a[216:219], v[204:207], 0
v_mfma_f32_16x16x32_bf16 a[124:127], a[220:223], v[204:207], 0
v_mfma_f32_16x16x32_bf16 a[92:95], a[220:223], v[200:203], 0
v_mfma_f32_16x16x32_bf16 a[60:63], a[220:223], v[196:199], 0
v_mfma_f32_16x16x32_bf16 a[28:31], a[220:223], v[192:195], 0
v_mfma_f32_16x16x32_bf16 v[224:227], v[120:123], v[192:195], 0
v_mfma_f32_16x16x32_bf16 v[228:231], v[120:123], v[196:199], 0
v_mfma_f32_16x16x32_bf16 v[232:235], v[120:123], v[200:203], 0
s_waitcnt vmcnt(8) lgkmcnt(8)
v_mfma_f32_16x16x32_bf16 v[236:239], v[120:123], v[204:207], 0
s_barrier
s_cmp_eq_u32 s60, 0
s_cbranch_scc1 LLT3
s_lshl_b32 s83, s60, 1
s_sub_u32 s83, 2, s83
s_cmp_eq_u32 s83, 0
s_cbranch_scc1 LLT1
LloopI:
v_mfma_f32_16x16x32_bf16 v[160:163], a[160:163], v[16:19], v[80:83]
s_xor_b32 s74, s82, 0x10000
v_exp_f32 v128, v128
v_mfma_f32_16x16x32_bf16 v[164:167], a[160:163], v[32:35], v[84:87]
s_add_u32 s74, s74, s64
ds_read_b128 a[128:131], v2 offset:16384
v_mfma_f32_16x16x32_bf16 v[168:171], a[160:163], v[48:51], v[88:91]
s_add_u32 s81, s81, 0x8000
v_exp_f32 v129, v129
v_mfma_f32_16x16x32_bf16 v[172:175], a[160:163], v[64:67], v[92:95]
s_add_u32 m0, s74, 16384
v_exp_f32 v130, v130
v_mfma_f32_16x16x32_bf16 v[176:179], a[176:179], v[16:19], v[80:83]
s_add_u32 s72, s81, 16384
ds_read_b128 a[144:147], v2 offset:20480
v_cvt_pk_bf16_f32 v192, v128, v129
v_mfma_f32_16x16x32_bf16 v[180:183], a[176:179], v[32:35], v[84:87]
v_exp_f32 v131, v131
v_mfma_f32_16x16x32_bf16 v[184:187], a[176:179], v[48:51], v[88:91]
v_exp_f32 v144, v144
v_mfma_f32_16x16x32_bf16 v[188:191], a[176:179], v[64:67], v[92:95]
ds_read_b128 a[132:135], v2 offset:17408
v_cvt_pk_bf16_f32 v193, v130, v131
v_mfma_f32_16x16x32_bf16 v[160:163], a[164:167], v[20:23], v[160:163]
buffer_load_dwordx4 v1, s[44:47], s72 offen sc1 lds
v_mfma_f32_16x16x32_bf16 v[164:167], a[164:167], v[36:39], v[164:167]
v_exp_f32 v145, v145
v_mfma_f32_16x16x32_bf16 v[168:171], a[164:167], v[52:55], v[168:171]
v_exp_f32 v146, v146
v_mfma_f32_16x16x32_bf16 v[172:175], a[164:167], v[68:71], v[172:175]
ds_read_b128 a[148:151], v2 offset:21504
v_cvt_pk_bf16_f32 v194, v144, v145
v_mfma_f32_16x16x32_bf16 v[188:191], a[180:183], v[68:71], v[188:191]
v_exp_f32 v147, v147
v_mfma_f32_16x16x32_bf16 v[184:187], a[180:183], v[52:55], v[184:187]
v_exp_f32 v132, v132
v_mfma_f32_16x16x32_bf16 v[180:183], a[180:183], v[36:39], v[180:183]
ds_read_b128 a[136:139], v2 offset:18432
v_cvt_pk_bf16_f32 v195, v146, v147
v_mfma_f32_16x16x32_bf16 v[176:179], a[180:183], v[20:23], v[176:179]
v_exp_f32 v133, v133
v_mfma_f32_16x16x32_bf16 v[172:175], a[168:171], v[72:75], v[172:175]
v_exp_f32 v134, v134
v_mfma_f32_16x16x32_bf16 v[168:171], a[168:171], v[56:59], v[168:171]
ds_read_b128 a[152:155], v2 offset:22528
v_cvt_pk_bf16_f32 v196, v132, v133
v_mfma_f32_16x16x32_bf16 v[164:167], a[168:171], v[40:43], v[164:167]
v_exp_f32 v135, v135
v_mfma_f32_16x16x32_bf16 v[160:163], a[168:171], v[24:27], v[160:163]
v_exp_f32 v148, v148
v_mfma_f32_16x16x32_bf16 v[176:179], a[184:187], v[24:27], v[176:179]
ds_read_b128 a[140:143], v2 offset:19456
v_cvt_pk_bf16_f32 v197, v134, v135
v_mfma_f32_16x16x32_bf16 v[180:183], a[184:187], v[40:43], v[180:183]
buffer_load_dwordx4 v1, s[44:47], s72 offen offset:1024 sc1 lds
v_mfma_f32_16x16x32_bf16 v[184:187], a[184:187], v[56:59], v[184:187]
v_exp_f32 v149, v149
v_mfma_f32_16x16x32_bf16 v[188:191], a[184:187], v[72:75], v[188:191]
v_exp_f32 v150, v150
v_mfma_f32_16x16x32_bf16 v[160:163], a[172:175], v[28:31], v[160:163]
ds_read_b128 a[156:159], v2 offset:23552
v_cvt_pk_bf16_f32 v198, v148, v149
v_mfma_f32_16x16x32_bf16 v[164:167], a[172:175], v[44:47], v[164:167]
v_exp_f32 v151, v151
v_mfma_f32_16x16x32_bf16 v[168:171], a[172:175], v[60:63], v[168:171]
v_exp_f32 v136, v136
v_mfma_f32_16x16x32_bf16 v[172:175], a[172:175], v[76:79], v[172:175]
ds_read_b128 a[192:195], v2 offset:0
v_cvt_pk_bf16_f32 v199, v150, v151
v_mfma_f32_16x16x32_bf16 v[188:191], a[188:191], v[76:79], v[188:191]
v_exp_f32 v137, v137
v_mfma_f32_16x16x32_bf16 v[184:187], a[188:191], v[60:63], v[184:187]
v_exp_f32 v138, v138
v_mfma_f32_16x16x32_bf16 v[180:183], a[188:191], v[44:47], v[180:183]
ds_read_b128 a[196:199], v2 offset:1024
v_cvt_pk_bf16_f32 v200, v136, v137
v_mfma_f32_16x16x32_bf16 v[176:179], a[188:191], v[28:31], v[176:179]
s_waitcnt lgkmcnt(10)
v_exp_f32 v139, v139
v_mfma_f32_16x16x32_bf16 a[0:3], a[224:227], v[208:211], a[0:3]
v_exp_f32 v152, v152
v_mfma_f32_16x16x32_bf16 a[32:35], a[224:227], v[212:215], a[32:35]
ds_read_b128 a[200:203], v2 offset:2048
v_cvt_pk_bf16_f32 v201, v138, v139
v_mfma_f32_16x16x32_bf16 a[64:67], a[224:227], v[216:219], a[64:67]
buffer_load_dwordx4 v1, s[44:47], s72 offen offset:2048 sc1 lds
v_mfma_f32_16x16x32_bf16 a[96:99], a[224:227], v[220:223], a[96:99]
v_exp_f32 v153, v153
v_mfma_f32_16x16x32_bf16 a[100:103], a[228:231], v[220:223], a[100:103]
v_exp_f32 v154, v154
v_mfma_f32_16x16x32_bf16 a[68:71], a[228:231], v[216:219], a[68:71]
ds_read_b128 a[204:207], v2 offset:3072
v_cvt_pk_bf16_f32 v202, v152, v153
v_mfma_f32_16x16x32_bf16 a[36:39], a[228:231], v[212:215], a[36:39]
v_exp_f32 v155, v155
v_mfma_f32_16x16x32_bf16 a[4:7], a[228:231], v[208:211], a[4:7]
v_exp_f32 v140, v140
v_mfma_f32_16x16x32_bf16 a[8:11], a[232:235], v[208:211], a[8:11]
ds_read_b128 a[208:211], v2 offset:4096
v_cvt_pk_bf16_f32 v203, v154, v155
v_mfma_f32_16x16x32_bf16 a[40:43], a[232:235], v[212:215], a[40:43]
v_exp_f32 v141, v141
v_mfma_f32_16x16x32_bf16 a[72:75], a[232:235], v[216:219], a[72:75]
v_exp_f32 v142, v142
v_mfma_f32_16x16x32_bf16 a[104:107], a[232:235], v[220:223], a[104:107]
ds_read_b128 a[212:215], v2 offset:5120
v_cvt_pk_bf16_f32 v204, v140, v141
v_mfma_f32_16x16x32_bf16 a[108:111], a[236:239], v[220:223], a[108:111]
v_exp_f32 v143, v143
v_mfma_f32_16x16x32_bf16 a[76:79], a[236:239], v[216:219], a[76:79]
v_exp_f32 v156, v156
v_mfma_f32_16x16x32_bf16 a[44:47], a[236:239], v[212:215], a[44:47]
ds_read_b128 a[216:219], v2 offset:6144
v_cvt_pk_bf16_f32 v205, v142, v143
v_mfma_f32_16x16x32_bf16 a[12:15], a[236:239], v[208:211], a[12:15]
buffer_load_dwordx4 v1, s[44:47], s72 offen offset:3072 sc1 lds
v_mfma_f32_16x16x32_bf16 a[16:19], a[240:243], v[208:211], a[16:19]
v_exp_f32 v157, v157
v_mfma_f32_16x16x32_bf16 a[48:51], a[240:243], v[212:215], a[48:51]
v_exp_f32 v158, v158
v_mfma_f32_16x16x32_bf16 a[80:83], a[240:243], v[216:219], a[80:83]
ds_read_b128 a[220:223], v2 offset:7168
v_cvt_pk_bf16_f32 v206, v156, v157
v_mfma_f32_16x16x32_bf16 a[112:115], a[240:243], v[220:223], a[112:115]
v_exp_f32 v159, v159
v_mfma_f32_16x16x32_bf16 a[116:119], a[244:247], v[220:223], a[116:119]
v_cvt_pk_bf16_f32 v207, v158, v159
v_mfma_f32_16x16x32_bf16 a[84:87], a[244:247], v[216:219], a[84:87]
v_mfma_f32_16x16x32_bf16 a[52:55], a[244:247], v[212:215], a[52:55]
v_mfma_f32_16x16x32_bf16 a[20:23], a[244:247], v[208:211], a[20:23]
v_mfma_f32_16x16x32_bf16 a[24:27], a[248:251], v[208:211], a[24:27]
v_mfma_f32_16x16x32_bf16 a[56:59], a[248:251], v[212:215], a[56:59]
v_mfma_f32_16x16x32_bf16 a[88:91], a[248:251], v[216:219], a[88:91]
v_mfma_f32_16x16x32_bf16 a[120:123], a[248:251], v[220:223], a[120:123]
v_mfma_f32_16x16x32_bf16 a[124:127], a[252:255], v[220:223], a[124:127]
v_mfma_f32_16x16x32_bf16 a[92:95], a[252:255], v[216:219], a[92:95]
v_mfma_f32_16x16x32_bf16 a[60:63], a[252:255], v[212:215], a[60:63]
v_mfma_f32_16x16x32_bf16 a[28:31], a[252:255], v[208:211], a[28:31]
v_mfma_f32_16x16x32_bf16 v[224:227], v[120:123], v[208:211], v[224:227]
v_mfma_f32_16x16x32_bf16 v[228:231], v[120:123], v[212:215], v[228:231]
v_mfma_f32_16x16x32_bf16 v[232:235], v[120:123], v[216:219], v[232:235]
v_mfma_f32_16x16x32_bf16 v[236:239], v[120:123], v[220:223], v[236:239]
s_waitcnt lgkmcnt(8)
v_mfma_f32_16x16x32_bf16 v[128:131], a[128:131], v[16:19], v[80:83]
s_add_u32 s82, s82, 0x8000
ds_read_b128 a[160:163], v2 offset:24576
v_mfma_f32_16x16x32_bf16 v[132:135], a[128:131], v[32:35], v[84:87]
s_and_b32 s82, s82, 0x1ffff
v_exp_f32 v160, v160
v_mfma_f32_16x16x32_bf16 v[136:139], a[128:131], v[48:51], v[88:91]
s_add_u32 m0, s74, 0
v_exp_f32 v161, v161
v_mfma_f32_16x16x32_bf16 v[140:143], a[128:131], v[64:67], v[92:95]
s_add_u32 s72, s81, 0
ds_read_b128 a[176:179], v2 offset:28672
v_cvt_pk_bf16_f32 v208, v160, v161
v_mfma_f32_16x16x32_bf16 v[144:147], a[144:147], v[16:19], v[80:83]
v_exp_f32 v162, v162
v_mfma_f32_16x16x32_bf16 v[148:151], a[144:147], v[32:35], v[84:87]
v_exp_f32 v163, v163
v_mfma_f32_16x16x32_bf16 v[152:155], a[144:147], v[48:51], v[88:91]
ds_read_b128 a[164:167], v2 offset:25600
v_cvt_pk_bf16_f32 v209, v162, v163
v_mfma_f32_16x16x32_bf16 v[156:159], a[144:147], v[64:67], v[92:95]
v_exp_f32 v176, v176
v_mfma_f32_16x16x32_bf16 v[128:131], a[132:135], v[20:23], v[128:131]
buffer_load_dwordx4 v1, s[44:47], s72 offen sc1 lds
v_mfma_f32_16x16x32_bf16 v[132:135], a[132:135], v[36:39], v[132:135]
v_exp_f32 v177, v177
v_mfma_f32_16x16x32_bf16 v[136:139], a[132:135], v[52:55], v[136:139]
ds_read_b128 a[180:183], v2 offset:29696
v_cvt_pk_bf16_f32 v210, v176, v177
v_mfma_f32_16x16x32_bf16 v[140:143], a[132:135], v[68:71], v[140:143]
v_exp_f32 v178, v178
v_mfma_f32_16x16x32_bf16 v[156:159], a[148:151], v[68:71], v[156:159]
v_exp_f32 v179, v179
v_mfma_f32_16x16x32_bf16 v[152:155], a[148:151], v[52:55], v[152:155]
ds_read_b128 a[168:171], v2 offset:26624
v_cvt_pk_bf16_f32 v211, v178, v179
v_mfma_f32_16x16x32_bf16 v[148:151], a[148:151], v[36:39], v[148:151]
v_exp_f32 v164, v164
v_mfma_f32_16x16x32_bf16 v[144:147], a[148:151], v[20:23], v[144:147]
v_exp_f32 v165, v165
v_mfma_f32_16x16x32_bf16 v[140:143], a[136:139], v[72:75], v[140:143]
ds_read_b128 a[184:187], v2 offset:30720
v_cvt_pk_bf16_f32 v212, v164, v165
v_mfma_f32_16x16x32_bf16 v[136:139], a[136:139], v[56:59], v[136:139]
v_exp_f32 v166, v166
v_mfma_f32_16x16x32_bf16 v[132:135], a[136:139], v[40:43], v[132:135]
v_exp_f32 v167, v167
v_mfma_f32_16x16x32_bf16 v[128:131], a[136:139], v[24:27], v[128:131]
ds_read_b128 a[172:175], v2 offset:27648
v_cvt_pk_bf16_f32 v213, v166, v167
v_mfma_f32_16x16x32_bf16 v[144:147], a[152:155], v[24:27], v[144:147]
v_exp_f32 v180, v180
v_mfma_f32_16x16x32_bf16 v[148:151], a[152:155], v[40:43], v[148:151]
buffer_load_dwordx4 v1, s[44:47], s72 offen offset:1024 sc1 lds
v_mfma_f32_16x16x32_bf16 v[152:155], a[152:155], v[56:59], v[152:155]
v_exp_f32 v181, v181
v_mfma_f32_16x16x32_bf16 v[156:159], a[152:155], v[72:75], v[156:159]
ds_read_b128 a[188:191], v2 offset:31744
v_cvt_pk_bf16_f32 v214, v180, v181
v_mfma_f32_16x16x32_bf16 v[128:131], a[140:143], v[28:31], v[128:131]
v_exp_f32 v182, v182
v_mfma_f32_16x16x32_bf16 v[132:135], a[140:143], v[44:47], v[132:135]
v_exp_f32 v183, v183
v_mfma_f32_16x16x32_bf16 v[136:139], a[140:143], v[60:63], v[136:139]
ds_read_b128 a[224:227], v2 offset:8192
v_cvt_pk_bf16_f32 v215, v182, v183
v_mfma_f32_16x16x32_bf16 v[140:143], a[140:143], v[76:79], v[140:143]
v_exp_f32 v168, v168
v_mfma_f32_16x16x32_bf16 v[156:159], a[156:159], v[76:79], v[156:159]
v_exp_f32 v169, v169
v_mfma_f32_16x16x32_bf16 v[152:155], a[156:159], v[60:63], v[152:155]
ds_read_b128 a[228:231], v2 offset:9216
v_cvt_pk_bf16_f32 v216, v168, v169
v_mfma_f32_16x16x32_bf16 v[148:151], a[156:159], v[44:47], v[148:151]
v_exp_f32 v170, v170
v_mfma_f32_16x16x32_bf16 v[144:147], a[156:159], v[28:31], v[144:147]
s_waitcnt lgkmcnt(10)
v_exp_f32 v171, v171
v_mfma_f32_16x16x32_bf16 a[0:3], a[192:195], v[192:195], a[0:3]
ds_read_b128 a[232:235], v2 offset:10240
v_cvt_pk_bf16_f32 v217, v170, v171
v_mfma_f32_16x16x32_bf16 a[32:35], a[192:195], v[196:199], a[32:35]
v_exp_f32 v184, v184
v_mfma_f32_16x16x32_bf16 a[64:67], a[192:195], v[200:203], a[64:67]
buffer_load_dwordx4 v1, s[44:47], s72 offen offset:2048 sc1 lds
v_mfma_f32_16x16x32_bf16 a[96:99], a[192:195], v[204:207], a[96:99]
v_exp_f32 v185, v185
v_mfma_f32_16x16x32_bf16 a[100:103], a[196:199], v[204:207], a[100:103]
ds_read_b128 a[236:239], v2 offset:11264
v_cvt_pk_bf16_f32 v218, v184, v185
v_mfma_f32_16x16x32_bf16 a[68:71], a[196:199], v[200:203], a[68:71]
v_exp_f32 v186, v186
v_mfma_f32_16x16x32_bf16 a[36:39], a[196:199], v[196:199], a[36:39]
v_exp_f32 v187, v187
v_mfma_f32_16x16x32_bf16 a[4:7], a[196:199], v[192:195], a[4:7]
ds_read_b128 a[240:243], v2 offset:12288
v_cvt_pk_bf16_f32 v219, v186, v187
v_mfma_f32_16x16x32_bf16 a[8:11], a[200:203], v[192:195], a[8:11]
v_exp_f32 v172, v172
v_mfma_f32_16x16x32_bf16 a[40:43], a[200:203], v[196:199], a[40:43]
v_exp_f32 v173, v173
v_mfma_f32_16x16x32_bf16 a[72:75], a[200:203], v[200:203], a[72:75]
ds_read_b128 a[244:247], v2 offset:13312
v_cvt_pk_bf16_f32 v220, v172, v173
v_mfma_f32_16x16x32_bf16 a[104:107], a[200:203], v[204:207], a[104:107]
v_exp_f32 v174, v174
v_mfma_f32_16x16x32_bf16 a[108:111], a[204:207], v[204:207], a[108:111]
v_exp_f32 v175, v175
v_mfma_f32_16x16x32_bf16 a[76:79], a[204:207], v[200:203], a[76:79]
ds_read_b128 a[248:251], v2 offset:14336
v_cvt_pk_bf16_f32 v221, v174, v175
v_mfma_f32_16x16x32_bf16 a[44:47], a[204:207], v[196:199], a[44:47]
v_exp_f32 v188, v188
v_mfma_f32_16x16x32_bf16 a[12:15], a[204:207], v[192:195], a[12:15]
buffer_load_dwordx4 v1, s[44:47], s72 offen offset:3072 sc1 lds
v_mfma_f32_16x16x32_bf16 a[16:19], a[208:211], v[192:195], a[16:19]
v_exp_f32 v189, v189
v_mfma_f32_16x16x32_bf16 a[48:51], a[208:211], v[196:199], a[48:51]
ds_read_b128 a[252:255], v2 offset:15360
v_cvt_pk_bf16_f32 v222, v188, v189
v_mfma_f32_16x16x32_bf16 a[80:83], a[208:211], v[200:203], a[80:83]
v_exp_f32 v190, v190
v_mfma_f32_16x16x32_bf16 a[112:115], a[208:211], v[204:207], a[112:115]
v_exp_f32 v191, v191
v_mfma_f32_16x16x32_bf16 a[116:119], a[212:215], v[204:207], a[116:119]
v_cvt_pk_bf16_f32 v223, v190, v191
v_add_u32 v2, s82, v1
v_mfma_f32_16x16x32_bf16 a[84:87], a[212:215], v[200:203], a[84:87]
v_mfma_f32_16x16x32_bf16 a[52:55], a[212:215], v[196:199], a[52:55]
v_mfma_f32_16x16x32_bf16 a[20:23], a[212:215], v[192:195], a[20:23]
v_mfma_f32_16x16x32_bf16 a[24:27], a[216:219], v[192:195], a[24:27]
v_mfma_f32_16x16x32_bf16 a[56:59], a[216:219], v[196:199], a[56:59]
v_mfma_f32_16x16x32_bf16 a[88:91], a[216:219], v[200:203], a[88:91]
v_mfma_f32_16x16x32_bf16 a[120:123], a[216:219], v[204:207], a[120:123]
v_mfma_f32_16x16x32_bf16 a[124:127], a[220:223], v[204:207], a[124:127]
v_mfma_f32_16x16x32_bf16 a[92:95], a[220:223], v[200:203], a[92:95]
v_mfma_f32_16x16x32_bf16 a[60:63], a[220:223], v[196:199], a[60:63]
v_mfma_f32_16x16x32_bf16 a[28:31], a[220:223], v[192:195], a[28:31]
v_mfma_f32_16x16x32_bf16 v[224:227], v[120:123], v[192:195], v[224:227]
v_mfma_f32_16x16x32_bf16 v[228:231], v[120:123], v[196:199], v[228:231]
s_waitcnt vmcnt(8) lgkmcnt(8)
v_mfma_f32_16x16x32_bf16 v[232:235], v[120:123], v[200:203], v[232:235]
s_barrier
v_mfma_f32_16x16x32_bf16 v[236:239], v[120:123], v[204:207], v[236:239]
s_add_u32 s83, s83, 1
s_cbranch_scc0 LloopI
LLT1:
v_mfma_f32_16x16x32_bf16 v[160:163], a[160:163], v[16:19], v[80:83]
s_xor_b32 s74, s82, 0x10000
v_exp_f32 v128, v128
v_mfma_f32_16x16x32_bf16 v[164:167], a[160:163], v[32:35], v[84:87]
s_add_u32 s74, s74, s64
ds_read_b128 a[128:131], v2 offset:16384
v_mfma_f32_16x16x32_bf16 v[168:171], a[160:163], v[48:51], v[88:91]
s_add_u32 s81, s81, 0x8000
v_exp_f32 v129, v129
v_mfma_f32_16x16x32_bf16 v[172:175], a[160:163], v[64:67], v[92:95]
s_add_u32 m0, s74, 16384
v_exp_f32 v130, v130
v_mfma_f32_16x16x32_bf16 v[176:179], a[176:179], v[16:19], v[80:83]
s_add_u32 s72, s81, 16384
ds_read_b128 a[144:147], v2 offset:20480
v_cvt_pk_bf16_f32 v192, v128, v129
v_mfma_f32_16x16x32_bf16 v[180:183], a[176:179], v[32:35], v[84:87]
v_exp_f32 v131, v131
v_mfma_f32_16x16x32_bf16 v[184:187], a[176:179], v[48:51], v[88:91]
v_exp_f32 v144, v144
v_mfma_f32_16x16x32_bf16 v[188:191], a[176:179], v[64:67], v[92:95]
ds_read_b128 a[132:135], v2 offset:17408
v_cvt_pk_bf16_f32 v193, v130, v131
v_mfma_f32_16x16x32_bf16 v[160:163], a[164:167], v[20:23], v[160:163]
buffer_load_dwordx4 v1, s[44:47], s72 offen sc1 lds
v_mfma_f32_16x16x32_bf16 v[164:167], a[164:167], v[36:39], v[164:167]
v_exp_f32 v145, v145
v_mfma_f32_16x16x32_bf16 v[168:171], a[164:167], v[52:55], v[168:171]
v_exp_f32 v146, v146
v_mfma_f32_16x16x32_bf16 v[172:175], a[164:167], v[68:71], v[172:175]
ds_read_b128 a[148:151], v2 offset:21504
v_cvt_pk_bf16_f32 v194, v144, v145
v_mfma_f32_16x16x32_bf16 v[188:191], a[180:183], v[68:71], v[188:191]
v_exp_f32 v147, v147
v_mfma_f32_16x16x32_bf16 v[184:187], a[180:183], v[52:55], v[184:187]
v_exp_f32 v132, v132
v_mfma_f32_16x16x32_bf16 v[180:183], a[180:183], v[36:39], v[180:183]
ds_read_b128 a[136:139], v2 offset:18432
v_cvt_pk_bf16_f32 v195, v146, v147
v_mfma_f32_16x16x32_bf16 v[176:179], a[180:183], v[20:23], v[176:179]
v_exp_f32 v133, v133
v_mfma_f32_16x16x32_bf16 v[172:175], a[168:171], v[72:75], v[172:175]
v_exp_f32 v134, v134
v_mfma_f32_16x16x32_bf16 v[168:171], a[168:171], v[56:59], v[168:171]
ds_read_b128 a[152:155], v2 offset:22528
v_cvt_pk_bf16_f32 v196, v132, v133
v_mfma_f32_16x16x32_bf16 v[164:167], a[168:171], v[40:43], v[164:167]
v_exp_f32 v135, v135
v_mfma_f32_16x16x32_bf16 v[160:163], a[168:171], v[24:27], v[160:163]
v_exp_f32 v148, v148
v_mfma_f32_16x16x32_bf16 v[176:179], a[184:187], v[24:27], v[176:179]
ds_read_b128 a[140:143], v2 offset:19456
v_cvt_pk_bf16_f32 v197, v134, v135
v_mfma_f32_16x16x32_bf16 v[180:183], a[184:187], v[40:43], v[180:183]
buffer_load_dwordx4 v1, s[44:47], s72 offen offset:1024 sc1 lds
v_mfma_f32_16x16x32_bf16 v[184:187], a[184:187], v[56:59], v[184:187]
v_exp_f32 v149, v149
v_mfma_f32_16x16x32_bf16 v[188:191], a[184:187], v[72:75], v[188:191]
v_exp_f32 v150, v150
v_mfma_f32_16x16x32_bf16 v[160:163], a[172:175], v[28:31], v[160:163]
ds_read_b128 a[156:159], v2 offset:23552
v_cvt_pk_bf16_f32 v198, v148, v149
v_mfma_f32_16x16x32_bf16 v[164:167], a[172:175], v[44:47], v[164:167]
v_exp_f32 v151, v151
v_mfma_f32_16x16x32_bf16 v[168:171], a[172:175], v[60:63], v[168:171]
v_exp_f32 v136, v136
v_mfma_f32_16x16x32_bf16 v[172:175], a[172:175], v[76:79], v[172:175]
ds_read_b128 a[192:195], v2 offset:0
v_cvt_pk_bf16_f32 v199, v150, v151
v_mfma_f32_16x16x32_bf16 v[188:191], a[188:191], v[76:79], v[188:191]
v_exp_f32 v137, v137
v_mfma_f32_16x16x32_bf16 v[184:187], a[188:191], v[60:63], v[184:187]
v_exp_f32 v138, v138
v_mfma_f32_16x16x32_bf16 v[180:183], a[188:191], v[44:47], v[180:183]
ds_read_b128 a[196:199], v2 offset:1024
v_cvt_pk_bf16_f32 v200, v136, v137
v_mfma_f32_16x16x32_bf16 v[176:179], a[188:191], v[28:31], v[176:179]
s_waitcnt lgkmcnt(10)
v_exp_f32 v139, v139
v_mfma_f32_16x16x32_bf16 a[0:3], a[224:227], v[208:211], a[0:3]
v_exp_f32 v152, v152
v_mfma_f32_16x16x32_bf16 a[32:35], a[224:227], v[212:215], a[32:35]
ds_read_b128 a[200:203], v2 offset:2048
v_cvt_pk_bf16_f32 v201, v138, v139
v_mfma_f32_16x16x32_bf16 a[64:67], a[224:227], v[216:219], a[64:67]
buffer_load_dwordx4 v1, s[44:47], s72 offen offset:2048 sc1 lds
v_mfma_f32_16x16x32_bf16 a[96:99], a[224:227], v[220:223], a[96:99]
v_exp_f32 v153, v153
v_mfma_f32_16x16x32_bf16 a[100:103], a[228:231], v[220:223], a[100:103]
v_exp_f32 v154, v154
v_mfma_f32_16x16x32_bf16 a[68:71], a[228:231], v[216:219], a[68:71]
ds_read_b128 a[204:207], v2 offset:3072
v_cvt_pk_bf16_f32 v202, v152, v153
v_mfma_f32_16x16x32_bf16 a[36:39], a[228:231], v[212:215], a[36:39]
v_exp_f32 v155, v155
v_mfma_f32_16x16x32_bf16 a[4:7], a[228:231], v[208:211], a[4:7]
v_exp_f32 v140, v140
v_mfma_f32_16x16x32_bf16 a[8:11], a[232:235], v[208:211], a[8:11]
ds_read_b128 a[208:211], v2 offset:4096
v_cvt_pk_bf16_f32 v203, v154, v155
v_mfma_f32_16x16x32_bf16 a[40:43], a[232:235], v[212:215], a[40:43]
v_exp_f32 v141, v141
v_mfma_f32_16x16x32_bf16 a[72:75], a[232:235], v[216:219], a[72:75]
v_exp_f32 v142, v142
v_mfma_f32_16x16x32_bf16 a[104:107], a[232:235], v[220:223], a[104:107]
ds_read_b128 a[212:215], v2 offset:5120
v_cvt_pk_bf16_f32 v204, v140, v141
v_mfma_f32_16x16x32_bf16 a[108:111], a[236:239], v[220:223], a[108:111]
v_exp_f32 v143, v143
v_mfma_f32_16x16x32_bf16 a[76:79], a[236:239], v[216:219], a[76:79]
v_exp_f32 v156, v156
v_mfma_f32_16x16x32_bf16 a[44:47], a[236:239], v[212:215], a[44:47]
ds_read_b128 a[216:219], v2 offset:6144
v_cvt_pk_bf16_f32 v205, v142, v143
v_mfma_f32_16x16x32_bf16 a[12:15], a[236:239], v[208:211], a[12:15]
buffer_load_dwordx4 v1, s[44:47], s72 offen offset:3072 sc1 lds
v_mfma_f32_16x16x32_bf16 a[16:19], a[240:243], v[208:211], a[16:19]
v_exp_f32 v157, v157
v_mfma_f32_16x16x32_bf16 a[48:51], a[240:243], v[212:215], a[48:51]
v_exp_f32 v158, v158
v_mfma_f32_16x16x32_bf16 a[80:83], a[240:243], v[216:219], a[80:83]
ds_read_b128 a[220:223], v2 offset:7168
v_cvt_pk_bf16_f32 v206, v156, v157
v_mfma_f32_16x16x32_bf16 a[112:115], a[240:243], v[220:223], a[112:115]
v_exp_f32 v159, v159
v_mfma_f32_16x16x32_bf16 a[116:119], a[244:247], v[220:223], a[116:119]
v_cvt_pk_bf16_f32 v207, v158, v159
v_mfma_f32_16x16x32_bf16 a[84:87], a[244:247], v[216:219], a[84:87]
v_mfma_f32_16x16x32_bf16 a[52:55], a[244:247], v[212:215], a[52:55]
v_mfma_f32_16x16x32_bf16 a[20:23], a[244:247], v[208:211], a[20:23]
v_mfma_f32_16x16x32_bf16 a[24:27], a[248:251], v[208:211], a[24:27]
v_mfma_f32_16x16x32_bf16 a[56:59], a[248:251], v[212:215], a[56:59]
v_mfma_f32_16x16x32_bf16 a[88:91], a[248:251], v[216:219], a[88:91]
v_mfma_f32_16x16x32_bf16 a[120:123], a[248:251], v[220:223], a[120:123]
v_mfma_f32_16x16x32_bf16 a[124:127], a[252:255], v[220:223], a[124:127]
v_mfma_f32_16x16x32_bf16 a[92:95], a[252:255], v[216:219], a[92:95]
v_mfma_f32_16x16x32_bf16 a[60:63], a[252:255], v[212:215], a[60:63]
v_mfma_f32_16x16x32_bf16 a[28:31], a[252:255], v[208:211], a[28:31]
v_mfma_f32_16x16x32_bf16 v[224:227], v[120:123], v[208:211], v[224:227]
v_mfma_f32_16x16x32_bf16 v[228:231], v[120:123], v[212:215], v[228:231]
v_mfma_f32_16x16x32_bf16 v[232:235], v[120:123], v[216:219], v[232:235]
v_mfma_f32_16x16x32_bf16 v[236:239], v[120:123], v[220:223], v[236:239]
s_waitcnt lgkmcnt(8)
s_cmp_le_u32 s58, 0
s_cbranch_scc1 Lalt15
v_mfma_f32_16x16x32_bf16 v[128:131], a[128:131], v[16:19], v[80:83]
s_add_u32 s82, s82, 0x8000
ds_read_b128 a[160:163], v2 offset:24576
v_mfma_f32_16x16x32_bf16 v[132:135], a[128:131], v[32:35], v[84:87]
s_and_b32 s82, s82, 0x1ffff
v_exp_f32 v160, v160
v_mfma_f32_16x16x32_bf16 v[144:147], a[144:147], v[16:19], v[80:83]
s_add_u32 m0, s74, 0
v_exp_f32 v161, v161
v_mfma_f32_16x16x32_bf16 v[148:151], a[144:147], v[32:35], v[84:87]
s_add_u32 s72, s81, 0
ds_read_b128 a[176:179], v2 offset:28672
v_cvt_pk_bf16_f32 v208, v160, v161
Ljoin17:
v_mfma_f32_16x16x32_bf16 v[136:139], a[128:131], v[48:51], v[88:91]
v_exp_f32 v162, v162
v_mfma_f32_16x16x32_bf16 v[140:143], a[128:131], v[64:67], v[92:95]
v_exp_f32 v163, v163
v_mfma_f32_16x16x32_bf16 v[152:155], a[144:147], v[48:51], v[88:91]
ds_read_b128 a[164:167], v2 offset:25600
v_cvt_pk_bf16_f32 v209, v162, v163
v_mfma_f32_16x16x32_bf16 v[156:159], a[144:147], v[64:67], v[92:95]
v_exp_f32 v176, v176
v_mfma_f32_16x16x32_bf16 v[128:131], a[132:135], v[20:23], v[128:131]
buffer_load_dwordx4 v1, s[44:47], s72 offen sc1 lds
v_mfma_f32_16x16x32_bf16 v[132:135], a[132:135], v[36:39], v[132:135]
v_exp_f32 v177, v177
v_mfma_f32_16x16x32_bf16 v[136:139], a[132:135], v[52:55], v[136:139]
ds_read_b128 a[180:183], v2 offset:29696
v_cvt_pk_bf16_f32 v210, v176, v177
v_mfma_f32_16x16x32_bf16 v[140:143], a[132:135], v[68:71], v[140:143]
v_exp_f32 v178, v178
v_mfma_f32_16x16x32_bf16 v[156:159], a[148:151], v[68:71], v[156:159]
v_exp_f32 v179, v179
v_mfma_f32_16x16x32_bf16 v[152:155], a[148:151], v[52:55], v[152:155]
ds_read_b128 a[168:171], v2 offset:26624
v_cvt_pk_bf16_f32 v211, v178, v179
v_mfma_f32_16x16x32_bf16 v[148:151], a[148:151], v[36:39], v[148:151]
v_exp_f32 v164, v164
v_mfma_f32_16x16x32_bf16 v[144:147], a[148:151], v[20:23], v[144:147]
v_exp_f32 v165, v165
v_mfma_f32_16x16x32_bf16 v[140:143], a[136:139], v[72:75], v[140:143]
ds_read_b128 a[184:187], v2 offset:30720
v_cvt_pk_bf16_f32 v212, v164, v165
v_mfma_f32_16x16x32_bf16 v[136:139], a[136:139], v[56:59], v[136:139]
v_exp_f32 v166, v166
v_mfma_f32_16x16x32_bf16 v[132:135], a[136:139], v[40:43], v[132:135]
v_exp_f32 v167, v167
v_mfma_f32_16x16x32_bf16 v[128:131], a[136:139], v[24:27], v[128:131]
ds_read_b128 a[172:175], v2 offset:27648
v_cvt_pk_bf16_f32 v213, v166, v167
v_mfma_f32_16x16x32_bf16 v[144:147], a[152:155], v[24:27], v[144:147]
v_exp_f32 v180, v180
v_mfma_f32_16x16x32_bf16 v[148:151], a[152:155], v[40:43], v[148:151]
buffer_load_dwordx4 v1, s[44:47], s72 offen offset:1024 sc1 lds
v_mfma_f32_16x16x32_bf16 v[152:155], a[152:155], v[56:59], v[152:155]
v_exp_f32 v181, v181
v_mfma_f32_16x16x32_bf16 v[156:159], a[152:155], v[72:75], v[156:159]
ds_read_b128 a[188:191], v2 offset:31744
v_cvt_pk_bf16_f32 v214, v180, v181
v_mfma_f32_16x16x32_bf16 v[128:131], a[140:143], v[28:31], v[128:131]
v_exp_f32 v182, v182
v_mfma_f32_16x16x32_bf16 v[132:135], a[140:143], v[44:47], v[132:135]
v_exp_f32 v183, v183
v_mfma_f32_16x16x32_bf16 v[136:139], a[140:143], v[60:63], v[136:139]
ds_read_b128 a[224:227], v2 offset:8192
v_cvt_pk_bf16_f32 v215, v182, v183
v_mfma_f32_16x16x32_bf16 v[140:143], a[140:143], v[76:79], v[140:143]
v_exp_f32 v168, v168
v_mfma_f32_16x16x32_bf16 v[156:159], a[156:159], v[76:79], v[156:159]
v_exp_f32 v169, v169
v_mfma_f32_16x16x32_bf16 v[152:155], a[156:159], v[60:63], v[152:155]
ds_read_b128 a[228:231], v2 offset:9216
v_cvt_pk_bf16_f32 v216, v168, v169
v_mfma_f32_16x16x32_bf16 v[148:151], a[156:159], v[44:47], v[148:151]
v_exp_f32 v170, v170
v_mfma_f32_16x16x32_bf16 v[144:147], a[156:159], v[28:31], v[144:147]
s_waitcnt lgkmcnt(10)
v_exp_f32 v171, v171
v_mfma_f32_16x16x32_bf16 a[0:3], a[192:195], v[192:195], a[0:3]
ds_read_b128 a[232:235], v2 offset:10240
v_cvt_pk_bf16_f32 v217, v170, v171
v_mfma_f32_16x16x32_bf16 a[32:35], a[192:195], v[196:199], a[32:35]
v_exp_f32 v184, v184
v_mfma_f32_16x16x32_bf16 a[64:67], a[192:195], v[200:203], a[64:67]
buffer_load_dwordx4 v1, s[44:47], s72 offen offset:2048 sc1 lds
v_mfma_f32_16x16x32_bf16 a[96:99], a[192:195], v[204:207], a[96:99]
v_exp_f32 v185, v185
v_mfma_f32_16x16x32_bf16 a[100:103], a[196:199], v[204:207], a[100:103]
ds_read_b128 a[236:239], v2 offset:11264
v_cvt_pk_bf16_f32 v218, v184, v185
v_mfma_f32_16x16x32_bf16 a[68:71], a[196:199], v[200:203], a[68:71]
v_exp_f32 v186, v186
v_mfma_f32_16x16x32_bf16 a[36:39], a[196:199], v[196:199], a[36:39]
v_exp_f32 v187, v187
v_mfma_f32_16x16x32_bf16 a[4:7], a[196:199], v[192:195], a[4:7]
ds_read_b128 a[240:243], v2 offset:12288
v_cvt_pk_bf16_f32 v219, v186, v187
v_mfma_f32_16x16x32_bf16 a[8:11], a[200:203], v[192:195], a[8:11]
v_exp_f32 v172, v172
v_mfma_f32_16x16x32_bf16 a[40:43], a[200:203], v[196:199], a[40:43]
v_exp_f32 v173, v173
v_mfma_f32_16x16x32_bf16 a[72:75], a[200:203], v[200:203], a[72:75]
ds_read_b128 a[244:247], v2 offset:13312
v_cvt_pk_bf16_f32 v220, v172, v173
v_mfma_f32_16x16x32_bf16 a[104:107], a[200:203], v[204:207], a[104:107]
v_exp_f32 v174, v174
v_mfma_f32_16x16x32_bf16 a[108:111], a[204:207], v[204:207], a[108:111]
v_exp_f32 v175, v175
v_mfma_f32_16x16x32_bf16 a[76:79], a[204:207], v[200:203], a[76:79]
ds_read_b128 a[248:251], v2 offset:14336
v_cvt_pk_bf16_f32 v221, v174, v175
v_mfma_f32_16x16x32_bf16 a[44:47], a[204:207], v[196:199], a[44:47]
v_exp_f32 v188, v188
v_mfma_f32_16x16x32_bf16 a[12:15], a[204:207], v[192:195], a[12:15]
buffer_load_dwordx4 v1, s[44:47], s72 offen offset:3072 sc1 lds
v_mfma_f32_16x16x32_bf16 a[16:19], a[208:211], v[192:195], a[16:19]
v_exp_f32 v189, v189
v_mfma_f32_16x16x32_bf16 a[48:51], a[208:211], v[196:199], a[48:51]
ds_read_b128 a[252:255], v2 offset:15360
v_cvt_pk_bf16_f32 v222, v188, v189
v_mfma_f32_16x16x32_bf16 a[80:83], a[208:211], v[200:203], a[80:83]
v_exp_f32 v190, v190
v_mfma_f32_16x16x32_bf16 a[112:115], a[208:211], v[204:207], a[112:115]
v_exp_f32 v191, v191
v_mfma_f32_16x16x32_bf16 a[116:119], a[212:215], v[204:207], a[116:119]
v_cvt_pk_bf16_f32 v223, v190, v191
v_add_u32 v2, s82, v1
v_mfma_f32_16x16x32_bf16 a[84:87], a[212:215], v[200:203], a[84:87]
v_mfma_f32_16x16x32_bf16 a[52:55], a[212:215], v[196:199], a[52:55]
v_mfma_f32_16x16x32_bf16 a[20:23], a[212:215], v[192:195], a[20:23]
v_mfma_f32_16x16x32_bf16 a[24:27], a[216:219], v[192:195], a[24:27]
v_mfma_f32_16x16x32_bf16 a[56:59], a[216:219], v[196:199], a[56:59]
v_mfma_f32_16x16x32_bf16 a[88:91], a[216:219], v[200:203], a[88:91]
v_mfma_f32_16x16x32_bf16 a[120:123], a[216:219], v[204:207], a[120:123]
v_mfma_f32_16x16x32_bf16 a[124:127], a[220:223], v[204:207], a[124:127]
v_mfma_f32_16x16x32_bf16 a[92:95], a[220:223], v[200:203], a[92:95]
v_mfma_f32_16x16x32_bf16 a[60:63], a[220:223], v[196:199], a[60:63]
v_mfma_f32_16x16x32_bf16 a[28:31], a[220:223], v[192:195], a[28:31]
v_mfma_f32_16x16x32_bf16 v[224:227], v[120:123], v[192:195], v[224:227]
v_mfma_f32_16x16x32_bf16 v[228:231], v[120:123], v[196:199], v[228:231]
v_mfma_f32_16x16x32_bf16 v[232:235], v[120:123], v[200:203], v[232:235]
s_waitcnt vmcnt(8) lgkmcnt(8)
v_mfma_f32_16x16x32_bf16 v[236:239], v[120:123], v[204:207], v[236:239]
s_barrier
s_cmp_le_u32 s58, 1
s_cbranch_scc1 Lalt18
v_mfma_f32_16x16x32_bf16 v[160:163], a[160:163], v[16:19], v[80:83]
s_xor_b32 s74, s82, 0x10000
v_exp_f32 v128, v128
v_mfma_f32_16x16x32_bf16 v[164:167], a[160:163], v[32:35], v[84:87]
s_add_u32 s74, s74, s64
ds_read_b128 a[128:131], v2 offset:16384
v_mfma_f32_16x16x32_bf16 v[176:179], a[176:179], v[16:19], v[80:83]
s_add_u32 s81, s81, 0x8000
v_exp_f32 v129, v129
v_mfma_f32_16x16x32_bf16 v[180:183], a[176:179], v[32:35], v[84:87]
s_add_u32 m0, s74, 16384
v_exp_f32 v130, v130
Ljoin20:
v_mfma_f32_16x16x32_bf16 v[168:171], a[160:163], v[48:51], v[88:91]
s_add_u32 s72, s81, 16384
ds_read_b128 a[144:147], v2 offset:20480
v_cvt_pk_bf16_f32 v192, v128, v129
v_mfma_f32_16x16x32_bf16 v[172:175], a[160:163], v[64:67], v[92:95]
v_exp_f32 v131, v131
v_mfma_f32_16x16x32_bf16 v[184:187], a[176:179], v[48:51], v[88:91]
v_exp_f32 v144, v144
v_mfma_f32_16x16x32_bf16 v[188:191], a[176:179], v[64:67], v[92:95]
ds_read_b128 a[132:135], v2 offset:17408
v_cvt_pk_bf16_f32 v193, v130, v131
v_mfma_f32_16x16x32_bf16 v[160:163], a[164:167], v[20:23], v[160:163]
buffer_load_dwordx4 v1, s[44:47], s72 offen sc1 lds
v_mfma_f32_16x16x32_bf16 v[164:167], a[164:167], v[36:39], v[164:167]
v_exp_f32 v145, v145
v_mfma_f32_16x16x32_bf16 v[168:171], a[164:167], v[52:55], v[168:171]
v_exp_f32 v146, v146
v_mfma_f32_16x16x32_bf16 v[172:175], a[164:167], v[68:71], v[172:175]
ds_read_b128 a[148:151], v2 offset:21504
v_cvt_pk_bf16_f32 v194, v144, v145
v_mfma_f32_16x16x32_bf16 v[188:191], a[180:183], v[68:71], v[188:191]
v_exp_f32 v147, v147
v_mfma_f32_16x16x32_bf16 v[184:187], a[180:183], v[52:55], v[184:187]
v_exp_f32 v132, v132
v_mfma_f32_16x16x32_bf16 v[180:183], a[180:183], v[36:39], v[180:183]
ds_read_b128 a[136:139], v2 offset:18432
v_cvt_pk_bf16_f32 v195, v146, v147
v_mfma_f32_16x16x32_bf16 v[176:179], a[180:183], v[20:23], v[176:179]
v_exp_f32 v133, v133
v_mfma_f32_16x16x32_bf16 v[172:175], a[168:171], v[72:75], v[172:175]
v_exp_f32 v134, v134
v_mfma_f32_16x16x32_bf16 v[168:171], a[168:171], v[56:59], v[168:171]
ds_read_b128 a[152:155], v2 offset:22528
v_cvt_pk_bf16_f32 v196, v132, v133
v_mfma_f32_16x16x32_bf16 v[164:167], a[168:171], v[40:43], v[164:167]
v_exp_f32 v135, v135
v_mfma_f32_16x16x32_bf16 v[160:163], a[168:171], v[24:27], v[160:163]
v_exp_f32 v148, v148
v_mfma_f32_16x16x32_bf16 v[176:179], a[184:187], v[24:27], v[176:179]
ds_read_b128 a[140:143], v2 offset:19456
v_cvt_pk_bf16_f32 v197, v134, v135
v_mfma_f32_16x16x32_bf16 v[180:183], a[184:187], v[40:43], v[180:183]
buffer_load_dwordx4 v1, s[44:47], s72 offen offset:1024 sc1 lds
v_mfma_f32_16x16x32_bf16 v[184:187], a[184:187], v[56:59], v[184:187]
v_exp_f32 v149, v149
v_mfma_f32_16x16x32_bf16 v[188:191], a[184:187], v[72:75], v[188:191]
v_exp_f32 v150, v150
v_mfma_f32_16x16x32_bf16 v[160:163], a[172:175], v[28:31], v[160:163]
ds_read_b128 a[156:159], v2 offset:23552
v_cvt_pk_bf16_f32 v198, v148, v149
v_mfma_f32_16x16x32_bf16 v[164:167], a[172:175], v[44:47], v[164:167]
v_exp_f32 v151, v151
v_mfma_f32_16x16x32_bf16 v[168:171], a[172:175], v[60:63], v[168:171]
v_exp_f32 v136, v136
v_mfma_f32_16x16x32_bf16 v[172:175], a[172:175], v[76:79], v[172:175]
ds_read_b128 a[192:195], v2 offset:0
v_cvt_pk_bf16_f32 v199, v150, v151
v_mfma_f32_16x16x32_bf16 v[188:191], a[188:191], v[76:79], v[188:191]
v_exp_f32 v137, v137
v_mfma_f32_16x16x32_bf16 v[184:187], a[188:191], v[60:63], v[184:187]
v_exp_f32 v138, v138
v_mfma_f32_16x16x32_bf16 v[180:183], a[188:191], v[44:47], v[180:183]
ds_read_b128 a[196:199], v2 offset:1024
v_cvt_pk_bf16_f32 v200, v136, v137
v_mfma_f32_16x16x32_bf16 v[176:179], a[188:191], v[28:31], v[176:179]
s_waitcnt lgkmcnt(10)
v_exp_f32 v139, v139
v_mfma_f32_16x16x32_bf16 a[0:3], a[224:227], v[208:211], a[0:3]
v_exp_f32 v152, v152
v_mfma_f32_16x16x32_bf16 a[32:35], a[224:227], v[212:215], a[32:35]
ds_read_b128 a[200:203], v2 offset:2048
v_cvt_pk_bf16_f32 v201, v138, v139
v_mfma_f32_16x16x32_bf16 a[64:67], a[224:227], v[216:219], a[64:67]
buffer_load_dwordx4 v1, s[44:47], s72 offen offset:2048 sc1 lds
v_mfma_f32_16x16x32_bf16 a[96:99], a[224:227], v[220:223], a[96:99]
v_exp_f32 v153, v153
v_mfma_f32_16x16x32_bf16 a[100:103], a[228:231], v[220:223], a[100:103]
v_exp_f32 v154, v154
v_mfma_f32_16x16x32_bf16 a[68:71], a[228:231], v[216:219], a[68:71]
ds_read_b128 a[204:207], v2 offset:3072
v_cvt_pk_bf16_f32 v202, v152, v153
v_mfma_f32_16x16x32_bf16 a[36:39], a[228:231], v[212:215], a[36:39]
v_exp_f32 v155, v155
v_mfma_f32_16x16x32_bf16 a[4:7], a[228:231], v[208:211], a[4:7]
v_exp_f32 v140, v140
v_mfma_f32_16x16x32_bf16 a[8:11], a[232:235], v[208:211], a[8:11]
ds_read_b128 a[208:211], v2 offset:4096
v_cvt_pk_bf16_f32 v203, v154, v155
v_mfma_f32_16x16x32_bf16 a[40:43], a[232:235], v[212:215], a[40:43]
v_exp_f32 v141, v141
v_mfma_f32_16x16x32_bf16 a[72:75], a[232:235], v[216:219], a[72:75]
v_exp_f32 v142, v142
v_mfma_f32_16x16x32_bf16 a[104:107], a[232:235], v[220:223], a[104:107]
ds_read_b128 a[212:215], v2 offset:5120
v_cvt_pk_bf16_f32 v204, v140, v141
v_mfma_f32_16x16x32_bf16 a[108:111], a[236:239], v[220:223], a[108:111]
v_exp_f32 v143, v143
v_mfma_f32_16x16x32_bf16 a[76:79], a[236:239], v[216:219], a[76:79]
v_exp_f32 v156, v156
v_mfma_f32_16x16x32_bf16 a[44:47], a[236:239], v[212:215], a[44:47]
ds_read_b128 a[216:219], v2 offset:6144
v_cvt_pk_bf16_f32 v205, v142, v143
v_mfma_f32_16x16x32_bf16 a[12:15], a[236:239], v[208:211], a[12:15]
buffer_load_dwordx4 v1, s[44:47], s72 offen offset:3072 sc1 lds
v_mfma_f32_16x16x32_bf16 a[16:19], a[240:243], v[208:211], a[16:19]
v_exp_f32 v157, v157
v_mfma_f32_16x16x32_bf16 a[48:51], a[240:243], v[212:215], a[48:51]
v_exp_f32 v158, v158
v_mfma_f32_16x16x32_bf16 a[80:83], a[240:243], v[216:219], a[80:83]
ds_read_b128 a[220:223], v2 offset:7168
v_cvt_pk_bf16_f32 v206, v156, v157
v_mfma_f32_16x16x32_bf16 a[112:115], a[240:243], v[220:223], a[112:115]
v_exp_f32 v159, v159
v_mfma_f32_16x16x32_bf16 a[116:119], a[244:247], v[220:223], a[116:119]
v_cvt_pk_bf16_f32 v207, v158, v159
v_mfma_f32_16x16x32_bf16 a[84:87], a[244:247], v[216:219], a[84:87]
v_mfma_f32_16x16x32_bf16 a[52:55], a[244:247], v[212:215], a[52:55]
v_mfma_f32_16x16x32_bf16 a[20:23], a[244:247], v[208:211], a[20:23]
v_mfma_f32_16x16x32_bf16 a[24:27], a[248:251], v[208:211], a[24:27]
v_mfma_f32_16x16x32_bf16 a[56:59], a[248:251], v[212:215], a[56:59]
v_mfma_f32_16x16x32_bf16 a[88:91], a[248:251], v[216:219], a[88:91]
v_mfma_f32_16x16x32_bf16 a[120:123], a[248:251], v[220:223], a[120:123]
v_mfma_f32_16x16x32_bf16 a[124:127], a[252:255], v[220:223], a[124:127]
v_mfma_f32_16x16x32_bf16 a[92:95], a[252:255], v[216:219], a[92:95]
v_mfma_f32_16x16x32_bf16 a[60:63], a[252:255], v[212:215], a[60:63]
v_mfma_f32_16x16x32_bf16 a[28:31], a[252:255], v[208:211], a[28:31]
v_mfma_f32_16x16x32_bf16 v[224:227], v[120:123], v[208:211], v[224:227]
v_mfma_f32_16x16x32_bf16 v[228:231], v[120:123], v[212:215], v[228:231]
v_mfma_f32_16x16x32_bf16 v[232:235], v[120:123], v[216:219], v[232:235]
v_mfma_f32_16x16x32_bf16 v[236:239], v[120:123], v[220:223], v[236:239]
s_waitcnt lgkmcnt(8)
s_cmp_le_u32 s58, 2
s_cbranch_scc1 Lalt21
v_mfma_f32_16x16x32_bf16 v[128:131], a[128:131], v[16:19], v[80:83]
s_add_u32 s82, s82, 0x8000
ds_read_b128 a[160:163], v2 offset:24576
v_mfma_f32_16x16x32_bf16 v[132:135], a[128:131], v[32:35], v[84:87]
s_and_b32 s82, s82, 0x1ffff
v_exp_f32 v160, v160
v_mfma_f32_16x16x32_bf16 v[144:147], a[144:147], v[16:19], v[80:83]
s_add_u32 m0, s74, 0
v_exp_f32 v161, v161
v_mfma_f32_16x16x32_bf16 v[148:151], a[144:147], v[32:35], v[84:87]
s_add_u32 s72, s81, 0
ds_read_b128 a[176:179], v2 offset:28672
v_cvt_pk_bf16_f32 v208, v160, v161
Ljoin23:
v_mfma_f32_16x16x32_bf16 v[136:139], a[128:131], v[48:51], v[88:91]
v_exp_f32 v162, v162
v_mfma_f32_16x16x32_bf16 v[140:143], a[128:131], v[64:67], v[92:95]
v_exp_f32 v163, v163
v_mfma_f32_16x16x32_bf16 v[152:155], a[144:147], v[48:51], v[88:91]
ds_read_b128 a[164:167], v2 offset:25600
v_cvt_pk_bf16_f32 v209, v162, v163
v_mfma_f32_16x16x32_bf16 v[156:159], a[144:147], v[64:67], v[92:95]
v_exp_f32 v176, v176
v_mfma_f32_16x16x32_bf16 v[128:131], a[132:135], v[20:23], v[128:131]
buffer_load_dwordx4 v1, s[44:47], s72 offen sc1 lds
v_mfma_f32_16x16x32_bf16 v[132:135], a[132:135], v[36:39], v[132:135]
v_exp_f32 v177, v177
v_mfma_f32_16x16x32_bf16 v[136:139], a[132:135], v[52:55], v[136:139]
ds_read_b128 a[180:183], v2 offset:29696
v_cvt_pk_bf16_f32 v210, v176, v177
v_mfma_f32_16x16x32_bf16 v[140:143], a[132:135], v[68:71], v[140:143]
v_exp_f32 v178, v178
v_mfma_f32_16x16x32_bf16 v[156:159], a[148:151], v[68:71], v[156:159]
v_exp_f32 v179, v179
v_mfma_f32_16x16x32_bf16 v[152:155], a[148:151], v[52:55], v[152:155]
ds_read_b128 a[168:171], v2 offset:26624
v_cvt_pk_bf16_f32 v211, v178, v179
v_mfma_f32_16x16x32_bf16 v[148:151], a[148:151], v[36:39], v[148:151]
v_exp_f32 v164, v164
v_mfma_f32_16x16x32_bf16 v[144:147], a[148:151], v[20:23], v[144:147]
v_exp_f32 v165, v165
v_mfma_f32_16x16x32_bf16 v[140:143], a[136:139], v[72:75], v[140:143]
ds_read_b128 a[184:187], v2 offset:30720
v_cvt_pk_bf16_f32 v212, v164, v165
v_mfma_f32_16x16x32_bf16 v[136:139], a[136:139], v[56:59], v[136:139]
v_exp_f32 v166, v166
v_mfma_f32_16x16x32_bf16 v[132:135], a[136:139], v[40:43], v[132:135]
v_exp_f32 v167, v167
v_mfma_f32_16x16x32_bf16 v[128:131], a[136:139], v[24:27], v[128:131]
ds_read_b128 a[172:175], v2 offset:27648
v_cvt_pk_bf16_f32 v213, v166, v167
v_mfma_f32_16x16x32_bf16 v[144:147], a[152:155], v[24:27], v[144:147]
v_exp_f32 v180, v180
v_mfma_f32_16x16x32_bf16 v[148:151], a[152:155], v[40:43], v[148:151]
buffer_load_dwordx4 v1, s[44:47], s72 offen offset:1024 sc1 lds
v_mfma_f32_16x16x32_bf16 v[152:155], a[152:155], v[56:59], v[152:155]
v_exp_f32 v181, v181
v_mfma_f32_16x16x32_bf16 v[156:159], a[152:155], v[72:75], v[156:159]
ds_read_b128 a[188:191], v2 offset:31744
v_cvt_pk_bf16_f32 v214, v180, v181
v_mfma_f32_16x16x32_bf16 v[128:131], a[140:143], v[28:31], v[128:131]
v_exp_f32 v182, v182
v_mfma_f32_16x16x32_bf16 v[132:135], a[140:143], v[44:47], v[132:135]
v_exp_f32 v183, v183
v_mfma_f32_16x16x32_bf16 v[136:139], a[140:143], v[60:63], v[136:139]
ds_read_b128 a[224:227], v2 offset:8192
v_cvt_pk_bf16_f32 v215, v182, v183
v_mfma_f32_16x16x32_bf16 v[140:143], a[140:143], v[76:79], v[140:143]
v_exp_f32 v168, v168
v_mfma_f32_16x16x32_bf16 v[156:159], a[156:159], v[76:79], v[156:159]
v_exp_f32 v169, v169
v_mfma_f32_16x16x32_bf16 v[152:155], a[156:159], v[60:63], v[152:155]
ds_read_b128 a[228:231], v2 offset:9216
v_cvt_pk_bf16_f32 v216, v168, v169
v_mfma_f32_16x16x32_bf16 v[148:151], a[156:159], v[44:47], v[148:151]
v_exp_f32 v170, v170
v_mfma_f32_16x16x32_bf16 v[144:147], a[156:159], v[28:31], v[144:147]
s_waitcnt lgkmcnt(10)
v_exp_f32 v171, v171
v_mfma_f32_16x16x32_bf16 a[0:3], a[192:195], v[192:195], a[0:3]
ds_read_b128 a[232:235], v2 offset:10240
v_cvt_pk_bf16_f32 v217, v170, v171
v_mfma_f32_16x16x32_bf16 a[32:35], a[192:195], v[196:199], a[32:35]
v_exp_f32 v184, v184
v_mfma_f32_16x16x32_bf16 a[64:67], a[192:195], v[200:203], a[64:67]
buffer_load_dwordx4 v1, s[44:47], s72 offen offset:2048 sc1 lds
v_mfma_f32_16x16x32_bf16 a[96:99], a[192:195], v[204:207], a[96:99]
v_exp_f32 v185, v185
v_mfma_f32_16x16x32_bf16 a[100:103], a[196:199], v[204:207], a[100:103]
ds_read_b128 a[236:239], v2 offset:11264
v_cvt_pk_bf16_f32 v218, v184, v185
v_mfma_f32_16x16x32_bf16 a[68:71], a[196:199], v[200:203], a[68:71]
v_exp_f32 v186, v186
v_mfma_f32_16x16x32_bf16 a[36:39], a[196:199], v[196:199], a[36:39]
v_exp_f32 v187, v187
v_mfma_f32_16x16x32_bf16 a[4:7], a[196:199], v[192:195], a[4:7]
ds_read_b128 a[240:243], v2 offset:12288
v_cvt_pk_bf16_f32 v219, v186, v187
v_mfma_f32_16x16x32_bf16 a[8:11], a[200:203], v[192:195], a[8:11]
v_exp_f32 v172, v172
v_mfma_f32_16x16x32_bf16 a[40:43], a[200:203], v[196:199], a[40:43]
v_exp_f32 v173, v173
v_mfma_f32_16x16x32_bf16 a[72:75], a[200:203], v[200:203], a[72:75]
ds_read_b128 a[244:247], v2 offset:13312
v_cvt_pk_bf16_f32 v220, v172, v173
v_mfma_f32_16x16x32_bf16 a[104:107], a[200:203], v[204:207], a[104:107]
v_exp_f32 v174, v174
v_mfma_f32_16x16x32_bf16 a[108:111], a[204:207], v[204:207], a[108:111]
v_exp_f32 v175, v175
v_mfma_f32_16x16x32_bf16 a[76:79], a[204:207], v[200:203], a[76:79]
ds_read_b128 a[248:251], v2 offset:14336
v_cvt_pk_bf16_f32 v221, v174, v175
v_mfma_f32_16x16x32_bf16 a[44:47], a[204:207], v[196:199], a[44:47]
v_exp_f32 v188, v188
v_mfma_f32_16x16x32_bf16 a[12:15], a[204:207], v[192:195], a[12:15]
buffer_load_dwordx4 v1, s[44:47], s72 offen offset:3072 sc1 lds
v_mfma_f32_16x16x32_bf16 a[16:19], a[208:211], v[192:195], a[16:19]
v_exp_f32 v189, v189
v_mfma_f32_16x16x32_bf16 a[48:51], a[208:211], v[196:199], a[48:51]
ds_read_b128 a[252:255], v2 offset:15360
v_cvt_pk_bf16_f32 v222, v188, v189
v_mfma_f32_16x16x32_bf16 a[80:83], a[208:211], v[200:203], a[80:83]
v_exp_f32 v190, v190
v_mfma_f32_16x16x32_bf16 a[112:115], a[208:211], v[204:207], a[112:115]
v_exp_f32 v191, v191
v_mfma_f32_16x16x32_bf16 a[116:119], a[212:215], v[204:207], a[116:119]
v_cvt_pk_bf16_f32 v223, v190, v191
v_add_u32 v2, s82, v1
v_mfma_f32_16x16x32_bf16 a[84:87], a[212:215], v[200:203], a[84:87]
v_mfma_f32_16x16x32_bf16 a[52:55], a[212:215], v[196:199], a[52:55]
v_mfma_f32_16x16x32_bf16 a[20:23], a[212:215], v[192:195], a[20:23]
v_mfma_f32_16x16x32_bf16 a[24:27], a[216:219], v[192:195], a[24:27]
v_mfma_f32_16x16x32_bf16 a[56:59], a[216:219], v[196:199], a[56:59]
v_mfma_f32_16x16x32_bf16 a[88:91], a[216:219], v[200:203], a[88:91]
v_mfma_f32_16x16x32_bf16 a[120:123], a[216:219], v[204:207], a[120:123]
v_mfma_f32_16x16x32_bf16 a[124:127], a[220:223], v[204:207], a[124:127]
v_mfma_f32_16x16x32_bf16 a[92:95], a[220:223], v[200:203], a[92:95]
v_mfma_f32_16x16x32_bf16 a[60:63], a[220:223], v[196:199], a[60:63]
v_mfma_f32_16x16x32_bf16 a[28:31], a[220:223], v[192:195], a[28:31]
v_mfma_f32_16x16x32_bf16 v[224:227], v[120:123], v[192:195], v[224:227]
v_mfma_f32_16x16x32_bf16 v[228:231], v[120:123], v[196:199], v[228:231]
v_mfma_f32_16x16x32_bf16 v[232:235], v[120:123], v[200:203], v[232:235]
s_waitcnt vmcnt(8) lgkmcnt(8)
v_mfma_f32_16x16x32_bf16 v[236:239], v[120:123], v[204:207], v[236:239]
s_barrier
LLT3:
s_cmp_le_u32 s58, 3
s_cbranch_scc1 Lalt24
v_mfma_f32_16x16x32_bf16 v[160:163], a[160:163], v[16:19], v[80:83]
s_xor_b32 s74, s82, 0x10000
v_exp_f32 v128, v128
v_mfma_f32_16x16x32_bf16 v[164:167], a[160:163], v[32:35], v[84:87]
s_add_u32 s74, s74, s64
ds_read_b128 a[128:131], v2 offset:16384
v_mfma_f32_16x16x32_bf16 v[176:179], a[176:179], v[16:19], v[80:83]
s_add_u32 s81, s81, 0x8000
v_exp_f32 v129, v129
v_mfma_f32_16x16x32_bf16 v[180:183], a[176:179], v[32:35], v[84:87]
s_add_u32 m0, s74, 16384
v_exp_f32 v130, v130
Ljoin26:
v_mfma_f32_16x16x32_bf16 v[168:171], a[160:163], v[48:51], v[88:91]
s_add_u32 s72, s81, 16384
ds_read_b128 a[144:147], v2 offset:20480
v_cvt_pk_bf16_f32 v192, v128, v129
v_mfma_f32_16x16x32_bf16 v[172:175], a[160:163], v[64:67], v[92:95]
v_exp_f32 v131, v131
v_mfma_f32_16x16x32_bf16 v[184:187], a[176:179], v[48:51], v[88:91]
v_exp_f32 v144, v144
v_mfma_f32_16x16x32_bf16 v[188:191], a[176:179], v[64:67], v[92:95]
ds_read_b128 a[132:135], v2 offset:17408
v_cvt_pk_bf16_f32 v193, v130, v131
v_mfma_f32_16x16x32_bf16 v[160:163], a[164:167], v[20:23], v[160:163]
buffer_load_dwordx4 v1, s[44:47], s72 offen sc1 lds
v_mfma_f32_16x16x32_bf16 v[164:167], a[164:167], v[36:39], v[164:167]
v_exp_f32 v145, v145
v_mfma_f32_16x16x32_bf16 v[168:171], a[164:167], v[52:55], v[168:171]
v_exp_f32 v146, v146
v_mfma_f32_16x16x32_bf16 v[172:175], a[164:167], v[68:71], v[172:175]
ds_read_b128 a[148:151], v2 offset:21504
v_cvt_pk_bf16_f32 v194, v144, v145
v_mfma_f32_16x16x32_bf16 v[188:191], a[180:183], v[68:71], v[188:191]
v_exp_f32 v147, v147
v_mfma_f32_16x16x32_bf16 v[184:187], a[180:183], v[52:55], v[184:187]
v_exp_f32 v132, v132
v_mfma_f32_16x16x32_bf16 v[180:183], a[180:183], v[36:39], v[180:183]
ds_read_b128 a[136:139], v2 offset:18432
v_cvt_pk_bf16_f32 v195, v146, v147
v_mfma_f32_16x16x32_bf16 v[176:179], a[180:183], v[20:23], v[176:179]
v_exp_f32 v133, v133
v_mfma_f32_16x16x32_bf16 v[172:175], a[168:171], v[72:75], v[172:175]
v_exp_f32 v134, v134
v_mfma_f32_16x16x32_bf16 v[168:171], a[168:171], v[56:59], v[168:171]
ds_read_b128 a[152:155], v2 offset:22528
v_cvt_pk_bf16_f32 v196, v132, v133
v_mfma_f32_16x16x32_bf16 v[164:167], a[168:171], v[40:43], v[164:167]
v_exp_f32 v135, v135
v_mfma_f32_16x16x32_bf16 v[160:163], a[168:171], v[24:27], v[160:163]
v_exp_f32 v148, v148
v_mfma_f32_16x16x32_bf16 v[176:179], a[184:187], v[24:27], v[176:179]
ds_read_b128 a[140:143], v2 offset:19456
v_cvt_pk_bf16_f32 v197, v134, v135
v_mfma_f32_16x16x32_bf16 v[180:183], a[184:187], v[40:43], v[180:183]
buffer_load_dwordx4 v1, s[44:47], s72 offen offset:1024 sc1 lds
v_mfma_f32_16x16x32_bf16 v[184:187], a[184:187], v[56:59], v[184:187]
v_exp_f32 v149, v149
v_mfma_f32_16x16x32_bf16 v[188:191], a[184:187], v[72:75], v[188:191]
v_exp_f32 v150, v150
v_mfma_f32_16x16x32_bf16 v[160:163], a[172:175], v[28:31], v[160:163]
ds_read_b128 a[156:159], v2 offset:23552
v_cvt_pk_bf16_f32 v198, v148, v149
v_mfma_f32_16x16x32_bf16 v[164:167], a[172:175], v[44:47], v[164:167]
v_exp_f32 v151, v151
v_mfma_f32_16x16x32_bf16 v[168:171], a[172:175], v[60:63], v[168:171]
v_exp_f32 v136, v136
v_mfma_f32_16x16x32_bf16 v[172:175], a[172:175], v[76:79], v[172:175]
ds_read_b128 a[192:195], v2 offset:0
v_cvt_pk_bf16_f32 v199, v150, v151
v_mfma_f32_16x16x32_bf16 v[188:191], a[188:191], v[76:79], v[188:191]
v_exp_f32 v137, v137
v_mfma_f32_16x16x32_bf16 v[184:187], a[188:191], v[60:63], v[184:187]
v_exp_f32 v138, v138
v_mfma_f32_16x16x32_bf16 v[180:183], a[188:191], v[44:47], v[180:183]
ds_read_b128 a[196:199], v2 offset:1024
v_cvt_pk_bf16_f32 v200, v136, v137
v_mfma_f32_16x16x32_bf16 v[176:179], a[188:191], v[28:31], v[176:179]
s_waitcnt lgkmcnt(10)
v_exp_f32 v139, v139
v_mfma_f32_16x16x32_bf16 a[0:3], a[224:227], v[208:211], a[0:3]
v_exp_f32 v152, v152
v_mfma_f32_16x16x32_bf16 a[32:35], a[224:227], v[212:215], a[32:35]
ds_read_b128 a[200:203], v2 offset:2048
v_cvt_pk_bf16_f32 v201, v138, v139
v_mfma_f32_16x16x32_bf16 a[64:67], a[224:227], v[216:219], a[64:67]
buffer_load_dwordx4 v1, s[44:47], s72 offen offset:2048 sc1 lds
v_mfma_f32_16x16x32_bf16 a[96:99], a[224:227], v[220:223], a[96:99]
v_exp_f32 v153, v153
v_mfma_f32_16x16x32_bf16 a[100:103], a[228:231], v[220:223], a[100:103]
v_exp_f32 v154, v154
v_mfma_f32_16x16x32_bf16 a[68:71], a[228:231], v[216:219], a[68:71]
ds_read_b128 a[204:207], v2 offset:3072
v_cvt_pk_bf16_f32 v202, v152, v153
v_mfma_f32_16x16x32_bf16 a[36:39], a[228:231], v[212:215], a[36:39]
v_exp_f32 v155, v155
v_mfma_f32_16x16x32_bf16 a[4:7], a[228:231], v[208:211], a[4:7]
v_exp_f32 v140, v140
v_mfma_f32_16x16x32_bf16 a[8:11], a[232:235], v[208:211], a[8:11]
ds_read_b128 a[208:211], v2 offset:4096
v_cvt_pk_bf16_f32 v203, v154, v155
v_mfma_f32_16x16x32_bf16 a[40:43], a[232:235], v[212:215], a[40:43]
v_exp_f32 v141, v141
v_mfma_f32_16x16x32_bf16 a[72:75], a[232:235], v[216:219], a[72:75]
v_exp_f32 v142, v142
v_mfma_f32_16x16x32_bf16 a[104:107], a[232:235], v[220:223], a[104:107]
ds_read_b128 a[212:215], v2 offset:5120
v_cvt_pk_bf16_f32 v204, v140, v141
v_mfma_f32_16x16x32_bf16 a[108:111], a[236:239], v[220:223], a[108:111]
v_exp_f32 v143, v143
v_mfma_f32_16x16x32_bf16 a[76:79], a[236:239], v[216:219], a[76:79]
v_exp_f32 v156, v156
v_mfma_f32_16x16x32_bf16 a[44:47], a[236:239], v[212:215], a[44:47]
ds_read_b128 a[216:219], v2 offset:6144
v_cvt_pk_bf16_f32 v205, v142, v143
v_mfma_f32_16x16x32_bf16 a[12:15], a[236:239], v[208:211], a[12:15]
buffer_load_dwordx4 v1, s[44:47], s72 offen offset:3072 sc1 lds
v_mfma_f32_16x16x32_bf16 a[16:19], a[240:243], v[208:211], a[16:19]
v_exp_f32 v157, v157
v_mfma_f32_16x16x32_bf16 a[48:51], a[240:243], v[212:215], a[48:51]
v_exp_f32 v158, v158
v_mfma_f32_16x16x32_bf16 a[80:83], a[240:243], v[216:219], a[80:83]
ds_read_b128 a[220:223], v2 offset:7168
v_cvt_pk_bf16_f32 v206, v156, v157
v_mfma_f32_16x16x32_bf16 a[112:115], a[240:243], v[220:223], a[112:115]
v_exp_f32 v159, v159
v_mfma_f32_16x16x32_bf16 a[116:119], a[244:247], v[220:223], a[116:119]
v_cvt_pk_bf16_f32 v207, v158, v159
v_mfma_f32_16x16x32_bf16 a[84:87], a[244:247], v[216:219], a[84:87]
v_mfma_f32_16x16x32_bf16 a[52:55], a[244:247], v[212:215], a[52:55]
v_mfma_f32_16x16x32_bf16 a[20:23], a[244:247], v[208:211], a[20:23]
v_mfma_f32_16x16x32_bf16 a[24:27], a[248:251], v[208:211], a[24:27]
v_mfma_f32_16x16x32_bf16 a[56:59], a[248:251], v[212:215], a[56:59]
v_mfma_f32_16x16x32_bf16 a[88:91], a[248:251], v[216:219], a[88:91]
v_mfma_f32_16x16x32_bf16 a[120:123], a[248:251], v[220:223], a[120:123]
v_mfma_f32_16x16x32_bf16 a[124:127], a[252:255], v[220:223], a[124:127]
v_mfma_f32_16x16x32_bf16 a[92:95], a[252:255], v[216:219], a[92:95]
v_mfma_f32_16x16x32_bf16 a[60:63], a[252:255], v[212:215], a[60:63]
v_mfma_f32_16x16x32_bf16 a[28:31], a[252:255], v[208:211], a[28:31]
v_mfma_f32_16x16x32_bf16 v[224:227], v[120:123], v[208:211], v[224:227]
v_mfma_f32_16x16x32_bf16 v[228:231], v[120:123], v[212:215], v[228:231]
v_mfma_f32_16x16x32_bf16 v[232:235], v[120:123], v[216:219], v[232:235]
v_mfma_f32_16x16x32_bf16 v[236:239], v[120:123], v[220:223], v[236:239]
s_waitcnt lgkmcnt(8)
s_cmp_le_u32 s85, 0
s_cbranch_scc1 Lalt27
v_mfma_f32_16x16x32_bf16 v[136:139], a[128:131], v[48:51], v[88:91]
s_add_u32 s82, s82, 0x8000
ds_read_b128 a[160:163], v2 offset:24576
ds_read_b128 a[176:179], v2 offset:28672
v_mfma_f32_16x16x32_bf16 v[140:143], a[128:131], v[64:67], v[92:95]
s_and_b32 s82, s82, 0x1ffff
v_exp_f32 v160, v160
v_mfma_f32_16x16x32_bf16 v[152:155], a[144:147], v[48:51], v[88:91]
s_add_u32 m0, s74, 0
v_exp_f32 v161, v161
v_mfma_f32_16x16x32_bf16 v[156:159], a[144:147], v[64:67], v[92:95]
s_add_u32 s72, s81, 0
v_exp_f32 v162, v162
Ljoin29:
v_mfma_f32_16x16x32_bf16 v[136:139], a[132:135], v[52:55], v[136:139]
v_exp_f32 v163, v163
v_mfma_f32_16x16x32_bf16 v[140:143], a[132:135], v[68:71], v[140:143]
ds_read_b128 a[164:167], v2 offset:25600
v_cvt_pk_bf16_f32 v208, v160, v161
v_mfma_f32_16x16x32_bf16 v[156:159], a[148:151], v[68:71], v[156:159]
v_exp_f32 v176, v176
v_mfma_f32_16x16x32_bf16 v[152:155], a[148:151], v[52:55], v[152:155]
buffer_load_dwordx4 v1, s[44:47], s72 offen sc1 lds
v_mfma_f32_16x16x32_bf16 v[140:143], a[136:139], v[72:75], v[140:143]
v_exp_f32 v177, v177
v_mfma_f32_16x16x32_bf16 v[136:139], a[136:139], v[56:59], v[136:139]
ds_read_b128 a[180:183], v2 offset:29696
v_cvt_pk_bf16_f32 v209, v162, v163
v_mfma_f32_16x16x32_bf16 v[152:155], a[152:155], v[56:59], v[152:155]
v_exp_f32 v178, v178
v_mfma_f32_16x16x32_bf16 v[156:159], a[152:155], v[72:75], v[156:159]
v_exp_f32 v179, v179
v_mfma_f32_16x16x32_bf16 v[136:139], a[140:143], v[60:63], v[136:139]
ds_read_b128 a[168:171], v2 offset:26624
v_cvt_pk_bf16_f32 v210, v176, v177
v_mfma_f32_16x16x32_bf16 v[140:143], a[140:143], v[76:79], v[140:143]
v_exp_f32 v164, v164
v_mfma_f32_16x16x32_bf16 v[156:159], a[156:159], v[76:79], v[156:159]
v_exp_f32 v165, v165
v_mfma_f32_16x16x32_bf16 v[152:155], a[156:159], v[60:63], v[152:155]
s_waitcnt lgkmcnt(5)
ds_read_b128 a[184:187], v2 offset:30720
v_cvt_pk_bf16_f32 v211, v178, v179
v_mfma_f32_16x16x32_bf16 a[0:3], a[192:195], v[192:195], a[0:3]
v_exp_f32 v166, v166
v_mfma_f32_16x16x32_bf16 a[32:35], a[192:195], v[196:199], a[32:35]
v_exp_f32 v167, v167
v_mfma_f32_16x16x32_bf16 a[64:67], a[192:195], v[200:203], a[64:67]
ds_read_b128 a[172:175], v2 offset:27648
v_cvt_pk_bf16_f32 v212, v164, v165
v_mfma_f32_16x16x32_bf16 a[96:99], a[192:195], v[204:207], a[96:99]
v_exp_f32 v180, v180
v_mfma_f32_16x16x32_bf16 a[100:103], a[196:199], v[204:207], a[100:103]
buffer_load_dwordx4 v1, s[44:47], s72 offen offset:1024 sc1 lds
v_mfma_f32_16x16x32_bf16 a[68:71], a[196:199], v[200:203], a[68:71]
v_exp_f32 v181, v181
v_mfma_f32_16x16x32_bf16 a[36:39], a[196:199], v[196:199], a[36:39]
ds_read_b128 a[188:191], v2 offset:31744
v_cvt_pk_bf16_f32 v213, v166, v167
v_mfma_f32_16x16x32_bf16 a[4:7], a[196:199], v[192:195], a[4:7]
v_exp_f32 v182, v182
v_mfma_f32_16x16x32_bf16 a[8:11], a[200:203], v[192:195], a[8:11]
v_exp_f32 v183, v183
v_mfma_f32_16x16x32_bf16 a[40:43], a[200:203], v[196:199], a[40:43]
ds_read_b128 a[224:227], v2 offset:8192
v_cvt_pk_bf16_f32 v214, v180, v181
v_mfma_f32_16x16x32_bf16 a[72:75], a[200:203], v[200:203], a[72:75]
v_exp_f32 v168, v168
v_mfma_f32_16x16x32_bf16 a[104:107], a[200:203], v[204:207], a[104:107]
v_exp_f32 v169, v169
v_mfma_f32_16x16x32_bf16 a[108:111], a[204:207], v[204:207], a[108:111]
ds_read_b128 a[228:231], v2 offset:9216
v_cvt_pk_bf16_f32 v215, v182, v183
v_mfma_f32_16x16x32_bf16 a[76:79], a[204:207], v[200:203], a[76:79]
v_exp_f32 v170, v170
v_mfma_f32_16x16x32_bf16 a[44:47], a[204:207], v[196:199], a[44:47]
v_exp_f32 v171, v171
v_mfma_f32_16x16x32_bf16 a[12:15], a[204:207], v[192:195], a[12:15]
ds_read_b128 a[232:235], v2 offset:10240
v_cvt_pk_bf16_f32 v216, v168, v169
v_mfma_f32_16x16x32_bf16 a[16:19], a[208:211], v[192:195], a[16:19]
v_exp_f32 v184, v184
v_mfma_f32_16x16x32_bf16 a[48:51], a[208:211], v[196:199], a[48:51]
buffer_load_dwordx4 v1, s[44:47], s72 offen offset:2048 sc1 lds
v_mfma_f32_16x16x32_bf16 a[80:83], a[208:211], v[200:203], a[80:83]
v_exp_f32 v185, v185
v_mfma_f32_16x16x32_bf16 a[112:115], a[208:211], v[204:207], a[112:115]
ds_read_b128 a[236:239], v2 offset:11264
v_cvt_pk_bf16_f32 v217, v170, v171
v_mfma_f32_16x16x32_bf16 a[116:119], a[212:215], v[204:207], a[116:119]
v_exp_f32 v186, v186
v_mfma_f32_16x16x32_bf16 a[84:87], a[212:215], v[200:203], a[84:87]
v_exp_f32 v187, v187
v_mfma_f32_16x16x32_bf16 a[52:55], a[212:215], v[196:199], a[52:55]
ds_read_b128 a[240:243], v2 offset:12288
v_cvt_pk_bf16_f32 v218, v184, v185
v_mfma_f32_16x16x32_bf16 a[20:23], a[212:215], v[192:195], a[20:23]
v_exp_f32 v172, v172
v_mfma_f32_16x16x32_bf16 a[24:27], a[216:219], v[192:195], a[24:27]
v_exp_f32 v173, v173
v_mfma_f32_16x16x32_bf16 a[56:59], a[216:219], v[196:199], a[56:59]
ds_read_b128 a[244:247], v2 offset:13312
v_cvt_pk_bf16_f32 v219, v186, v187
v_mfma_f32_16x16x32_bf16 a[88:91], a[216:219], v[200:203], a[88:91]
v_exp_f32 v174, v174
v_mfma_f32_16x16x32_bf16 a[120:123], a[216:219], v[204:207], a[120:123]
v_exp_f32 v175, v175
v_mfma_f32_16x16x32_bf16 a[124:127], a[220:223], v[204:207], a[124:127]
ds_read_b128 a[248:251], v2 offset:14336
v_cvt_pk_bf16_f32 v220, v172, v173
v_mfma_f32_16x16x32_bf16 a[92:95], a[220:223], v[200:203], a[92:95]
v_exp_f32 v188, v188
v_mfma_f32_16x16x32_bf16 a[60:63], a[220:223], v[196:199], a[60:63]
buffer_load_dwordx4 v1, s[44:47], s72 offen offset:3072 sc1 lds
v_mfma_f32_16x16x32_bf16 a[28:31], a[220:223], v[192:195], a[28:31]
v_exp_f32 v189, v189
v_mfma_f32_16x16x32_bf16 v[224:227], v[120:123], v[192:195], v[224:227]
ds_read_b128 a[252:255], v2 offset:15360
v_cvt_pk_bf16_f32 v221, v174, v175
v_mfma_f32_16x16x32_bf16 v[228:231], v[120:123], v[196:199], v[228:231]
v_exp_f32 v190, v190
v_mfma_f32_16x16x32_bf16 v[232:235], v[120:123], v[200:203], v[232:235]
s_waitcnt vmcnt(8) lgkmcnt(8)
v_exp_f32 v191, v191
v_mfma_f32_16x16x32_bf16 v[236:239], v[120:123], v[204:207], v[236:239]
s_barrier
v_cvt_pk_bf16_f32 v222, v188, v189
v_cvt_pk_bf16_f32 v223, v190, v191
v_add_u32 v2, s82, v1
s_cmp_le_u32 s85, 1
s_cbranch_scc1 Lalt30
v_mfma_f32_16x16x32_bf16 v[168:171], a[160:163], v[48:51], v[88:91]
s_xor_b32 s74, s82, 0x10000
v_exp_f32 v136, v136
v_mfma_f32_16x16x32_bf16 v[172:175], a[160:163], v[64:67], v[92:95]
s_add_u32 s74, s74, s64
ds_read_b128 a[128:131], v2 offset:16384
v_mfma_f32_16x16x32_bf16 v[184:187], a[176:179], v[48:51], v[88:91]
s_add_u32 s81, s81, 0x8000
v_exp_f32 v137, v137
v_mfma_f32_16x16x32_bf16 v[188:191], a[176:179], v[64:67], v[92:95]
s_add_u32 m0, s74, 16384
ds_read_b128 a[144:147], v2 offset:20480
v_cvt_pk_bf16_f32 v200, v136, v137
Ljoin32:
v_mfma_f32_16x16x32_bf16 v[168:171], a[164:167], v[52:55], v[168:171]
s_add_u32 s72, s81, 16384
v_exp_f32 v138, v138
v_mfma_f32_16x16x32_bf16 v[172:175], a[164:167], v[68:71], v[172:175]
ds_read_b128 a[132:135], v2 offset:17408
v_mfma_f32_16x16x32_bf16 v[188:191], a[180:183], v[68:71], v[188:191]
buffer_load_dwordx4 v1, s[44:47], s72 offen sc1 lds
v_mfma_f32_16x16x32_bf16 v[184:187], a[180:183], v[52:55], v[184:187]
v_exp_f32 v139, v139
v_mfma_f32_16x16x32_bf16 v[172:175], a[168:171], v[72:75], v[172:175]
ds_read_b128 a[148:151], v2 offset:21504
v_cvt_pk_bf16_f32 v201, v138, v139
v_mfma_f32_16x16x32_bf16 v[168:171], a[168:171], v[56:59], v[168:171]
v_exp_f32 v152, v152
v_mfma_f32_16x16x32_bf16 v[184:187], a[184:187], v[56:59], v[184:187]
ds_read_b128 a[136:139], v2 offset:18432
v_mfma_f32_16x16x32_bf16 v[188:191], a[184:187], v[72:75], v[188:191]
v_exp_f32 v153, v153
v_mfma_f32_16x16x32_bf16 v[168:171], a[172:175], v[60:63], v[168:171]
ds_read_b128 a[152:155], v2 offset:22528
v_cvt_pk_bf16_f32 v202, v152, v153
v_mfma_f32_16x16x32_bf16 v[172:175], a[172:175], v[76:79], v[172:175]
v_exp_f32 v154, v154
v_mfma_f32_16x16x32_bf16 v[188:191], a[188:191], v[76:79], v[188:191]
ds_read_b128 a[140:143], v2 offset:19456
v_mfma_f32_16x16x32_bf16 v[184:187], a[188:191], v[60:63], v[184:187]
s_waitcnt lgkmcnt(7)
buffer_load_dwordx4 v1, s[44:47], s72 offen offset:1024 sc1 lds
v_mfma_f32_16x16x32_bf16 a[0:3], a[224:227], v[208:211], a[0:3]
v_exp_f32 v155, v155
v_mfma_f32_16x16x32_bf16 a[32:35], a[224:227], v[212:215], a[32:35]
ds_read_b128 a[156:159], v2 offset:23552
v_cvt_pk_bf16_f32 v203, v154, v155
v_mfma_f32_16x16x32_bf16 a[64:67], a[224:227], v[216:219], a[64:67]
v_exp_f32 v140, v140
v_mfma_f32_16x16x32_bf16 a[96:99], a[224:227], v[220:223], a[96:99]
ds_read_b128 a[192:195], v2 offset:0
v_mfma_f32_16x16x32_bf16 a[100:103], a[228:231], v[220:223], a[100:103]
v_exp_f32 v141, v141
v_mfma_f32_16x16x32_bf16 a[68:71], a[228:231], v[216:219], a[68:71]
ds_read_b128 a[196:199], v2 offset:1024
v_cvt_pk_bf16_f32 v204, v140, v141
v_mfma_f32_16x16x32_bf16 a[36:39], a[228:231], v[212:215], a[36:39]
v_exp_f32 v142, v142
v_mfma_f32_16x16x32_bf16 a[4:7], a[228:231], v[208:211], a[4:7]
ds_read_b128 a[200:203], v2 offset:2048
v_mfma_f32_16x16x32_bf16 a[8:11], a[232:235], v[208:211], a[8:11]
buffer_load_dwordx4 v1, s[44:47], s72 offen offset:2048 sc1 lds
v_mfma_f32_16x16x32_bf16 a[40:43], a[232:235], v[212:215], a[40:43]
v_exp_f32 v143, v143
v_mfma_f32_16x16x32_bf16 a[72:75], a[232:235], v[216:219], a[72:75]
ds_read_b128 a[204:207], v2 offset:3072
v_cvt_pk_bf16_f32 v205, v142, v143
v_mfma_f32_16x16x32_bf16 a[104:107], a[232:235], v[220:223], a[104:107]
v_exp_f32 v156, v156
v_mfma_f32_16x16x32_bf16 a[108:111], a[236:239], v[220:223], a[108:111]
ds_read_b128 a[208:211], v2 offset:4096
v_mfma_f32_16x16x32_bf16 a[76:79], a[236:239], v[216:219], a[76:79]
v_exp_f32 v157, v157
v_mfma_f32_16x16x32_bf16 a[44:47], a[236:239], v[212:215], a[44:47]
ds_read_b128 a[212:215], v2 offset:5120
v_cvt_pk_bf16_f32 v206, v156, v157
v_mfma_f32_16x16x32_bf16 a[12:15], a[236:239], v[208:211], a[12:15]
v_exp_f32 v158, v158
v_mfma_f32_16x16x32_bf16 a[16:19], a[240:243], v[208:211], a[16:19]
ds_read_b128 a[216:219], v2 offset:6144
v_mfma_f32_16x16x32_bf16 a[48:51], a[240:243], v[212:215], a[48:51]
buffer_load_dwordx4 v1, s[44:47], s72 offen offset:3072 sc1 lds
v_mfma_f32_16x16x32_bf16 a[80:83], a[240:243], v[216:219], a[80:83]
v_exp_f32 v159, v159
v_mfma_f32_16x16x32_bf16 a[112:115], a[240:243], v[220:223], a[112:115]
ds_read_b128 a[220:223], v2 offset:7168
v_cvt_pk_bf16_f32 v207, v158, v159
v_mfma_f32_16x16x32_bf16 a[116:119], a[244:247], v[220:223], a[116:119]
v_mfma_f32_16x16x32_bf16 a[84:87], a[244:247], v[216:219], a[84:87]
v_mfma_f32_16x16x32_bf16 a[52:55], a[244:247], v[212:215], a[52:55]
v_mfma_f32_16x16x32_bf16 a[20:23], a[244:247], v[208:211], a[20:23]
v_mfma_f32_16x16x32_bf16 a[24:27], a[248:251], v[208:211], a[24:27]
v_mfma_f32_16x16x32_bf16 a[56:59], a[248:251], v[212:215], a[56:59]
v_mfma_f32_16x16x32_bf16 a[88:91], a[248:251], v[216:219], a[88:91]
v_mfma_f32_16x16x32_bf16 a[120:123], a[248:251], v[220:223], a[120:123]
v_mfma_f32_16x16x32_bf16 a[124:127], a[252:255], v[220:223], a[124:127]
v_mfma_f32_16x16x32_bf16 a[92:95], a[252:255], v[216:219], a[92:95]
v_mfma_f32_16x16x32_bf16 a[60:63], a[252:255], v[212:215], a[60:63]
v_mfma_f32_16x16x32_bf16 a[28:31], a[252:255], v[208:211], a[28:31]
v_mfma_f32_16x16x32_bf16 v[224:227], v[120:123], v[208:211], v[224:227]
v_mfma_f32_16x16x32_bf16 v[228:231], v[120:123], v[212:215], v[228:231]
v_mfma_f32_16x16x32_bf16 v[232:235], v[120:123], v[216:219], v[232:235]
v_mfma_f32_16x16x32_bf16 v[236:239], v[120:123], v[220:223], v[236:239]
s_waitcnt lgkmcnt(8)
s_cmp_le_u32 s85, 2
s_cbranch_scc1 Lalt33
v_mfma_f32_16x16x32_bf16 v[136:139], a[128:131], v[48:51], v[88:91]
s_add_u32 s82, s82, 0x8000
ds_read_b128 a[160:163], v2 offset:24576
ds_read_b128 a[176:179], v2 offset:28672
v_mfma_f32_16x16x32_bf16 v[140:143], a[128:131], v[64:67], v[92:95]
s_and_b32 s82, s82, 0x1ffff
v_exp_f32 v168, v168
v_mfma_f32_16x16x32_bf16 v[152:155], a[144:147], v[48:51], v[88:91]
s_add_u32 m0, s74, 0
v_exp_f32 v169, v169
v_mfma_f32_16x16x32_bf16 v[156:159], a[144:147], v[64:67], v[92:95]
s_add_u32 s72, s81, 0
ds_read_b128 a[164:167], v2 offset:25600
v_cvt_pk_bf16_f32 v216, v168, v169
Ljoin35:
v_mfma_f32_16x16x32_bf16 v[136:139], a[132:135], v[52:55], v[136:139]
v_exp_f32 v170, v170
v_mfma_f32_16x16x32_bf16 v[140:143], a[132:135], v[68:71], v[140:143]
buffer_load_dwordx4 v1, s[44:47], s72 offen sc1 lds
v_mfma_f32_16x16x32_bf16 v[156:159], a[148:151], v[68:71], v[156:159]
ds_read_b128 a[180:183], v2 offset:29696
ds_read_b128 a[168:171], v2 offset:26624
v_mfma_f32_16x16x32_bf16 v[152:155], a[148:151], v[52:55], v[152:155]
v_exp_f32 v171, v171
v_mfma_f32_16x16x32_bf16 v[140:143], a[136:139], v[72:75], v[140:143]
v_exp_f32 v184, v184
v_mfma_f32_16x16x32_bf16 v[136:139], a[136:139], v[56:59], v[136:139]
ds_read_b128 a[184:187], v2 offset:30720
v_cvt_pk_bf16_f32 v217, v170, v171
v_mfma_f32_16x16x32_bf16 v[152:155], a[152:155], v[56:59], v[152:155]
v_exp_f32 v185, v185
v_mfma_f32_16x16x32_bf16 v[156:159], a[152:155], v[72:75], v[156:159]
ds_read_b128 a[172:175], v2 offset:27648
v_cvt_pk_bf16_f32 v218, v184, v185
v_mfma_f32_16x16x32_bf16 v[136:139], a[140:143], v[60:63], v[136:139]
v_exp_f32 v186, v186
v_mfma_f32_16x16x32_bf16 v[140:143], a[140:143], v[76:79], v[140:143]
buffer_load_dwordx4 v1, s[44:47], s72 offen offset:1024 sc1 lds
v_mfma_f32_16x16x32_bf16 v[156:159], a[156:159], v[76:79], v[156:159]
ds_read_b128 a[188:191], v2 offset:31744
ds_read_b128 a[224:227], v2 offset:8192
v_mfma_f32_16x16x32_bf16 v[152:155], a[156:159], v[60:63], v[152:155]
s_waitcnt lgkmcnt(9)
v_exp_f32 v187, v187
v_mfma_f32_16x16x32_bf16 a[64:67], a[192:195], v[200:203], a[64:67]
v_exp_f32 v172, v172
v_mfma_f32_16x16x32_bf16 a[96:99], a[192:195], v[204:207], a[96:99]
ds_read_b128 a[228:231], v2 offset:9216
v_cvt_pk_bf16_f32 v219, v186, v187
v_mfma_f32_16x16x32_bf16 a[100:103], a[196:199], v[204:207], a[100:103]
v_exp_f32 v173, v173
v_mfma_f32_16x16x32_bf16 a[68:71], a[196:199], v[200:203], a[68:71]
ds_read_b128 a[232:235], v2 offset:10240
v_cvt_pk_bf16_f32 v220, v172, v173
v_mfma_f32_16x16x32_bf16 a[72:75], a[200:203], v[200:203], a[72:75]
v_exp_f32 v174, v174
v_mfma_f32_16x16x32_bf16 a[104:107], a[200:203], v[204:207], a[104:107]
buffer_load_dwordx4 v1, s[44:47], s72 offen offset:2048 sc1 lds
v_mfma_f32_16x16x32_bf16 a[108:111], a[204:207], v[204:207], a[108:111]
ds_read_b128 a[236:239], v2 offset:11264
v_mfma_f32_16x16x32_bf16 a[76:79], a[204:207], v[200:203], a[76:79]
v_exp_f32 v175, v175
v_mfma_f32_16x16x32_bf16 a[80:83], a[208:211], v[200:203], a[80:83]
ds_read_b128 a[240:243], v2 offset:12288
v_cvt_pk_bf16_f32 v221, v174, v175
v_mfma_f32_16x16x32_bf16 a[112:115], a[208:211], v[204:207], a[112:115]
v_exp_f32 v188, v188
v_mfma_f32_16x16x32_bf16 a[116:119], a[212:215], v[204:207], a[116:119]
ds_read_b128 a[244:247], v2 offset:13312
v_mfma_f32_16x16x32_bf16 a[84:87], a[212:215], v[200:203], a[84:87]
v_exp_f32 v189, v189
v_mfma_f32_16x16x32_bf16 a[88:91], a[216:219], v[200:203], a[88:91]
ds_read_b128 a[248:251], v2 offset:14336
v_cvt_pk_bf16_f32 v222, v188, v189
v_mfma_f32_16x16x32_bf16 a[120:123], a[216:219], v[204:207], a[120:123]
buffer_load_dwordx4 v1, s[44:47], s72 offen offset:3072 sc1 lds
v_mfma_f32_16x16x32_bf16 a[124:127], a[220:223], v[204:207], a[124:127]
v_exp_f32 v190, v190
v_mfma_f32_16x16x32_bf16 a[92:95], a[220:223], v[200:203], a[92:95]
ds_read_b128 a[252:255], v2 offset:15360
v_add_u32 v2, s82, v1
v_mfma_f32_16x16x32_bf16 v[232:235], v[120:123], v[200:203], v[232:235]
s_waitcnt vmcnt(8) lgkmcnt(8)
v_exp_f32 v191, v191
v_mfma_f32_16x16x32_bf16 v[236:239], v[120:123], v[204:207], v[236:239]
s_barrier
v_cvt_pk_bf16_f32 v223, v190, v191
s_cmp_eq_u32 s60, 7
s_cbranch_scc1 LHT3
s_lshl_b32 s83, s60, 2
s_sub_u32 s83, s83, 26
LloopII:
v_mfma_f32_16x16x32_bf16 v[168:171], a[160:163], v[48:51], v[88:91]
s_xor_b32 s74, s82, 0x10000
v_exp_f32 v136, v136
v_mfma_f32_16x16x32_bf16 v[172:175], a[160:163], v[64:67], v[92:95]
s_add_u32 s74, s74, s64
ds_read_b128 a[128:131], v2 offset:16384
ds_read_b128 a[144:147], v2 offset:20480
v_mfma_f32_16x16x32_bf16 v[184:187], a[176:179], v[48:51], v[88:91]
s_add_u32 s81, s81, 0x8000
v_exp_f32 v137, v137
v_mfma_f32_16x16x32_bf16 v[188:191], a[176:179], v[64:67], v[92:95]
s_add_u32 m0, s74, 16384
v_exp_f32 v138, v138
v_mfma_f32_16x16x32_bf16 v[168:171], a[164:167], v[52:55], v[168:171]
s_add_u32 s72, s81, 16384
ds_read_b128 a[132:135], v2 offset:17408
v_cvt_pk_bf16_f32 v200, v136, v137
v_mfma_f32_16x16x32_bf16 v[172:175], a[164:167], v[68:71], v[172:175]
buffer_load_dwordx4 v1, s[44:47], s72 offen sc1 lds
v_mfma_f32_16x16x32_bf16 v[188:191], a[180:183], v[68:71], v[188:191]
v_exp_f32 v139, v139
v_mfma_f32_16x16x32_bf16 v[184:187], a[180:183], v[52:55], v[184:187]
ds_read_b128 a[148:151], v2 offset:21504
v_cvt_pk_bf16_f32 v201, v138, v139
v_mfma_f32_16x16x32_bf16 v[172:175], a[168:171], v[72:75], v[172:175]
v_exp_f32 v152, v152
v_mfma_f32_16x16x32_bf16 v[168:171], a[168:171], v[56:59], v[168:171]
ds_read_b128 a[136:139], v2 offset:18432
ds_read_b128 a[152:155], v2 offset:22528
v_mfma_f32_16x16x32_bf16 v[184:187], a[184:187], v[56:59], v[184:187]
v_exp_f32 v153, v153
v_mfma_f32_16x16x32_bf16 v[188:191], a[184:187], v[72:75], v[188:191]
v_exp_f32 v154, v154
v_mfma_f32_16x16x32_bf16 v[168:171], a[172:175], v[60:63], v[168:171]
ds_read_b128 a[140:143], v2 offset:19456
v_cvt_pk_bf16_f32 v202, v152, v153
v_mfma_f32_16x16x32_bf16 v[172:175], a[172:175], v[76:79], v[172:175]
buffer_load_dwordx4 v1, s[44:47], s72 offen offset:1024 sc1 lds
v_mfma_f32_16x16x32_bf16 v[188:191], a[188:191], v[76:79], v[188:191]
v_exp_f32 v155, v155
v_mfma_f32_16x16x32_bf16 v[184:187], a[188:191], v[60:63], v[184:187]
s_waitcnt lgkmcnt(7)
ds_read_b128 a[156:159], v2 offset:23552
v_cvt_pk_bf16_f32 v203, v154, v155
v_mfma_f32_16x16x32_bf16 a[64:67], a[224:227], v[216:219], a[64:67]
v_exp_f32 v140, v140
v_mfma_f32_16x16x32_bf16 a[96:99], a[224:227], v[220:223], a[96:99]
ds_read_b128 a[192:195], v2 offset:0
ds_read_b128 a[196:199], v2 offset:1024
v_mfma_f32_16x16x32_bf16 a[100:103], a[228:231], v[220:223], a[100:103]
v_exp_f32 v141, v141
v_mfma_f32_16x16x32_bf16 a[68:71], a[228:231], v[216:219], a[68:71]
v_exp_f32 v142, v142
v_mfma_f32_16x16x32_bf16 a[72:75], a[232:235], v[216:219], a[72:75]
ds_read_b128 a[200:203], v2 offset:2048
v_cvt_pk_bf16_f32 v204, v140, v141
v_mfma_f32_16x16x32_bf16 a[104:107], a[232:235], v[220:223], a[104:107]
buffer_load_dwordx4 v1, s[44:47], s72 offen offset:2048 sc1 lds
v_mfma_f32_16x16x32_bf16 a[108:111], a[236:239], v[220:223], a[108:111]
v_exp_f32 v143, v143
v_mfma_f32_16x16x32_bf16 a[76:79], a[236:239], v[216:219], a[76:79]
ds_read_b128 a[204:207], v2 offset:3072
v_cvt_pk_bf16_f32 v205, v142, v143
v_mfma_f32_16x16x32_bf16 a[80:83], a[240:243], v[216:219], a[80:83]
v_exp_f32 v156, v156
v_mfma_f32_16x16x32_bf16 a[112:115], a[240:243], v[220:223], a[112:115]
ds_read_b128 a[208:211], v2 offset:4096
v_mfma_f32_16x16x32_bf16 a[116:119], a[244:247], v[220:223], a[116:119]
v_exp_f32 v157, v157
v_mfma_f32_16x16x32_bf16 a[84:87], a[244:247], v[216:219], a[84:87]
ds_read_b128 a[212:215], v2 offset:5120
v_cvt_pk_bf16_f32 v206, v156, v157
v_mfma_f32_16x16x32_bf16 a[88:91], a[248:251], v[216:219], a[88:91]
v_exp_f32 v158, v158
v_mfma_f32_16x16x32_bf16 a[120:123], a[248:251], v[220:223], a[120:123]
ds_read_b128 a[216:219], v2 offset:6144
v_mfma_f32_16x16x32_bf16 a[124:127], a[252:255], v[220:223], a[124:127]
buffer_load_dwordx4 v1, s[44:47], s72 offen offset:3072 sc1 lds
v_mfma_f32_16x16x32_bf16 a[92:95], a[252:255], v[216:219], a[92:95]
v_exp_f32 v159, v159
v_mfma_f32_16x16x32_bf16 v[232:235], v[120:123], v[216:219], v[232:235]
ds_read_b128 a[220:223], v2 offset:7168
v_cvt_pk_bf16_f32 v207, v158, v159
v_mfma_f32_16x16x32_bf16 v[236:239], v[120:123], v[220:223], v[236:239]
s_waitcnt lgkmcnt(8)
v_mfma_f32_16x16x32_bf16 v[136:139], a[128:131], v[48:51], v[88:91]
s_add_u32 s82, s82, 0x8000
ds_read_b128 a[160:163], v2 offset:24576
ds_read_b128 a[176:179], v2 offset:28672
v_mfma_f32_16x16x32_bf16 v[140:143], a[128:131], v[64:67], v[92:95]
s_and_b32 s82, s82, 0x1ffff
v_exp_f32 v168, v168
v_mfma_f32_16x16x32_bf16 v[152:155], a[144:147], v[48:51], v[88:91]
s_add_u32 m0, s74, 0
v_exp_f32 v169, v169
v_mfma_f32_16x16x32_bf16 v[156:159], a[144:147], v[64:67], v[92:95]
s_add_u32 s72, s81, 0
ds_read_b128 a[164:167], v2 offset:25600
v_cvt_pk_bf16_f32 v216, v168, v169
v_mfma_f32_16x16x32_bf16 v[136:139], a[132:135], v[52:55], v[136:139]
v_exp_f32 v170, v170
v_mfma_f32_16x16x32_bf16 v[140:143], a[132:135], v[68:71], v[140:143]
buffer_load_dwordx4 v1, s[44:47], s72 offen sc1 lds
v_mfma_f32_16x16x32_bf16 v[156:159], a[148:151], v[68:71], v[156:159]
ds_read_b128 a[180:183], v2 offset:29696
ds_read_b128 a[168:171], v2 offset:26624
v_mfma_f32_16x16x32_bf16 v[152:155], a[148:151], v[52:55], v[152:155]
v_exp_f32 v171, v171
v_mfma_f32_16x16x32_bf16 v[140:143], a[136:139], v[72:75], v[140:143]
v_exp_f32 v184, v184
v_mfma_f32_16x16x32_bf16 v[136:139], a[136:139], v[56:59], v[136:139]
ds_read_b128 a[184:187], v2 offset:30720
v_cvt_pk_bf16_f32 v217, v170, v171
v_mfma_f32_16x16x32_bf16 v[152:155], a[152:155], v[56:59], v[152:155]
v_exp_f32 v185, v185
v_mfma_f32_16x16x32_bf16 v[156:159], a[152:155], v[72:75], v[156:159]
ds_read_b128 a[172:175], v2 offset:27648
v_cvt_pk_bf16_f32 v218, v184, v185
v_mfma_f32_16x16x32_bf16 v[136:139], a[140:143], v[60:63], v[136:139]
buffer_load_dwordx4 v1, s[44:47], s72 offen offset:1024 sc1 lds
v_mfma_f32_16x16x32_bf16 v[140:143], a[140:143], v[76:79], v[140:143]
v_exp_f32 v186, v186
v_mfma_f32_16x16x32_bf16 v[156:159], a[156:159], v[76:79], v[156:159]
ds_read_b128 a[188:191], v2 offset:31744
ds_read_b128 a[224:227], v2 offset:8192
v_mfma_f32_16x16x32_bf16 v[152:155], a[156:159], v[60:63], v[152:155]
s_waitcnt lgkmcnt(9)
v_exp_f32 v187, v187
v_mfma_f32_16x16x32_bf16 a[64:67], a[192:195], v[200:203], a[64:67]
v_exp_f32 v172, v172
v_mfma_f32_16x16x32_bf16 a[96:99], a[192:195], v[204:207], a[96:99]
ds_read_b128 a[228:231], v2 offset:9216
v_cvt_pk_bf16_f32 v219, v186, v187
v_mfma_f32_16x16x32_bf16 a[100:103], a[196:199], v[204:207], a[100:103]
v_exp_f32 v173, v173
v_mfma_f32_16x16x32_bf16 a[68:71], a[196:199], v[200:203], a[68:71]
ds_read_b128 a[232:235], v2 offset:10240
v_cvt_pk_bf16_f32 v220, v172, v173
v_mfma_f32_16x16x32_bf16 a[72:75], a[200:203], v[200:203], a[72:75]
buffer_load_dwordx4 v1, s[44:47], s72 offen offset:2048 sc1 lds
v_mfma_f32_16x16x32_bf16 a[104:107], a[200:203], v[204:207], a[104:107]
v_exp_f32 v174, v174
v_mfma_f32_16x16x32_bf16 a[108:111], a[204:207], v[204:207], a[108:111]
ds_read_b128 a[236:239], v2 offset:11264
v_mfma_f32_16x16x32_bf16 a[76:79], a[204:207], v[200:203], a[76:79]
v_exp_f32 v175, v175
v_mfma_f32_16x16x32_bf16 a[80:83], a[208:211], v[200:203], a[80:83]
ds_read_b128 a[240:243], v2 offset:12288
v_cvt_pk_bf16_f32 v221, v174, v175
v_mfma_f32_16x16x32_bf16 a[112:115], a[208:211], v[204:207], a[112:115]
v_exp_f32 v188, v188
v_mfma_f32_16x16x32_bf16 a[116:119], a[212:215], v[204:207], a[116:119]
ds_read_b128 a[244:247], v2 offset:13312
v_mfma_f32_16x16x32_bf16 a[84:87], a[212:215], v[200:203], a[84:87]
v_exp_f32 v189, v189
v_mfma_f32_16x16x32_bf16 a[88:91], a[216:219], v[200:203], a[88:91]
ds_read_b128 a[248:251], v2 offset:14336
v_cvt_pk_bf16_f32 v222, v188, v189
v_mfma_f32_16x16x32_bf16 a[120:123], a[216:219], v[204:207], a[120:123]
buffer_load_dwordx4 v1, s[44:47], s72 offen offset:3072 sc1 lds
v_mfma_f32_16x16x32_bf16 a[124:127], a[220:223], v[204:207], a[124:127]
ds_read_b128 a[252:255], v2 offset:15360
v_add_u32 v2, s82, v1
v_mfma_f32_16x16x32_bf16 a[92:95], a[220:223], v[200:203], a[92:95]
s_waitcnt vmcnt(8) lgkmcnt(8)
v_exp_f32 v190, v190
v_mfma_f32_16x16x32_bf16 v[232:235], v[120:123], v[200:203], v[232:235]
s_barrier
v_exp_f32 v191, v191
v_mfma_f32_16x16x32_bf16 v[236:239], v[120:123], v[204:207], v[236:239]
s_add_u32 s83, s83, 1
v_cvt_pk_bf16_f32 v223, v190, v191
s_cbranch_scc0 LloopII
v_mfma_f32_16x16x32_bf16 v[168:171], a[160:163], v[48:51], v[88:91]
s_xor_b32 s74, s82, 0x10000
v_exp_f32 v136, v136
v_mfma_f32_16x16x32_bf16 v[172:175], a[160:163], v[64:67], v[92:95]
s_add_u32 s74, s74, s64
ds_read_b128 a[128:131], v2 offset:16384
ds_read_b128 a[144:147], v2 offset:20480
v_mfma_f32_16x16x32_bf16 v[184:187], a[176:179], v[48:51], v[88:91]
s_add_u32 s81, s81, 0x8000
v_exp_f32 v137, v137
v_mfma_f32_16x16x32_bf16 v[188:191], a[176:179], v[64:67], v[92:95]
s_add_u32 m0, s74, 0
v_exp_f32 v138, v138
v_mfma_f32_16x16x32_bf16 v[168:171], a[164:167], v[52:55], v[168:171]
s_add_u32 s72, s81, 0
ds_read_b128 a[132:135], v2 offset:17408
v_cvt_pk_bf16_f32 v200, v136, v137
v_mfma_f32_16x16x32_bf16 v[172:175], a[164:167], v[68:71], v[172:175]
buffer_load_dwordx4 v1, s[44:47], s72 offen sc1 lds
v_mfma_f32_16x16x32_bf16 v[188:191], a[180:183], v[68:71], v[188:191]
v_exp_f32 v139, v139
v_mfma_f32_16x16x32_bf16 v[184:187], a[180:183], v[52:55], v[184:187]
ds_read_b128 a[148:151], v2 offset:21504
v_cvt_pk_bf16_f32 v201, v138, v139
v_mfma_f32_16x16x32_bf16 v[172:175], a[168:171], v[72:75], v[172:175]
v_exp_f32 v152, v152
v_mfma_f32_16x16x32_bf16 v[168:171], a[168:171], v[56:59], v[168:171]
ds_read_b128 a[136:139], v2 offset:18432
ds_read_b128 a[152:155], v2 offset:22528
v_mfma_f32_16x16x32_bf16 v[184:187], a[184:187], v[56:59], v[184:187]
v_exp_f32 v153, v153
v_mfma_f32_16x16x32_bf16 v[188:191], a[184:187], v[72:75], v[188:191]
v_exp_f32 v154, v154
v_mfma_f32_16x16x32_bf16 v[168:171], a[172:175], v[60:63], v[168:171]
ds_read_b128 a[140:143], v2 offset:19456
v_cvt_pk_bf16_f32 v202, v152, v153
v_mfma_f32_16x16x32_bf16 v[172:175], a[172:175], v[76:79], v[172:175]
buffer_load_dwordx4 v1, s[44:47], s72 offen offset:1024 sc1 lds
v_mfma_f32_16x16x32_bf16 v[188:191], a[188:191], v[76:79], v[188:191]
v_exp_f32 v155, v155
v_mfma_f32_16x16x32_bf16 v[184:187], a[188:191], v[60:63], v[184:187]
s_waitcnt lgkmcnt(7)
ds_read_b128 a[156:159], v2 offset:23552
v_cvt_pk_bf16_f32 v203, v154, v155
v_mfma_f32_16x16x32_bf16 a[64:67], a[224:227], v[216:219], a[64:67]
v_exp_f32 v140, v140
v_mfma_f32_16x16x32_bf16 a[96:99], a[224:227], v[220:223], a[96:99]
ds_read_b128 a[192:195], v2 offset:0
ds_read_b128 a[196:199], v2 offset:1024
v_mfma_f32_16x16x32_bf16 a[100:103], a[228:231], v[220:223], a[100:103]
v_exp_f32 v141, v141
v_mfma_f32_16x16x32_bf16 a[68:71], a[228:231], v[216:219], a[68:71]
v_exp_f32 v142, v142
v_mfma_f32_16x16x32_bf16 a[72:75], a[232:235], v[216:219], a[72:75]
ds_read_b128 a[200:203], v2 offset:2048
v_cvt_pk_bf16_f32 v204, v140, v141
v_mfma_f32_16x16x32_bf16 a[104:107], a[232:235], v[220:223], a[104:107]
buffer_load_dwordx4 v1, s[44:47], s72 offen offset:2048 sc1 lds
v_mfma_f32_16x16x32_bf16 a[108:111], a[236:239], v[220:223], a[108:111]
v_exp_f32 v143, v143
v_mfma_f32_16x16x32_bf16 a[76:79], a[236:239], v[216:219], a[76:79]
ds_read_b128 a[204:207], v2 offset:3072
v_cvt_pk_bf16_f32 v205, v142, v143
v_mfma_f32_16x16x32_bf16 a[80:83], a[240:243], v[216:219], a[80:83]
v_exp_f32 v156, v156
v_mfma_f32_16x16x32_bf16 a[112:115], a[240:243], v[220:223], a[112:115]
ds_read_b128 a[208:211], v2 offset:4096
v_mfma_f32_16x16x32_bf16 a[116:119], a[244:247], v[220:223], a[116:119]
v_exp_f32 v157, v157
v_mfma_f32_16x16x32_bf16 a[84:87], a[244:247], v[216:219], a[84:87]
ds_read_b128 a[212:215], v2 offset:5120
v_cvt_pk_bf16_f32 v206, v156, v157
v_mfma_f32_16x16x32_bf16 a[88:91], a[248:251], v[216:219], a[88:91]
v_exp_f32 v158, v158
v_mfma_f32_16x16x32_bf16 a[120:123], a[248:251], v[220:223], a[120:123]
ds_read_b128 a[216:219], v2 offset:6144
v_mfma_f32_16x16x32_bf16 a[124:127], a[252:255], v[220:223], a[124:127]
buffer_load_dwordx4 v1, s[44:47], s72 offen offset:3072 sc1 lds
v_mfma_f32_16x16x32_bf16 a[92:95], a[252:255], v[216:219], a[92:95]
v_exp_f32 v159, v159
v_mfma_f32_16x16x32_bf16 v[232:235], v[120:123], v[216:219], v[232:235]
ds_read_b128 a[220:223], v2 offset:7168
v_cvt_pk_bf16_f32 v207, v158, v159
v_mfma_f32_16x16x32_bf16 v[236:239], v[120:123], v[220:223], v[236:239]
s_waitcnt lgkmcnt(8)
s_cmp_le_u32 s58, 0
s_cbranch_scc1 Lalt36
v_mfma_f32_16x16x32_bf16 v[136:139], a[128:131], v[48:51], v[88:91]
s_add_u32 s82, s82, 0x8000
ds_read_b128 a[160:163], v2 offset:24576
v_mfma_f32_16x16x32_bf16 v[140:143], a[128:131], v[64:67], v[92:95]
s_and_b32 s82, s82, 0x1ffff
v_exp_f32 v168, v168
v_mfma_f32_16x16x32_bf16 v[152:155], a[144:147], v[48:51], v[88:91]
ds_read_b128 a[176:179], v2 offset:28672
v_mfma_f32_16x16x32_bf16 v[156:159], a[144:147], v[64:67], v[92:95]
v_exp_f32 v169, v169
Ljoin38:
v_mfma_f32_16x16x32_bf16 v[136:139], a[132:135], v[52:55], v[136:139]
ds_read_b128 a[164:167], v2 offset:25600
v_cvt_pk_bf16_f32 v216, v168, v169
v_mfma_f32_16x16x32_bf16 v[140:143], a[132:135], v[68:71], v[140:143]
v_exp_f32 v170, v170
v_mfma_f32_16x16x32_bf16 v[156:159], a[148:151], v[68:71], v[156:159]
ds_read_b128 a[180:183], v2 offset:29696
v_mfma_f32_16x16x32_bf16 v[152:155], a[148:151], v[52:55], v[152:155]
v_exp_f32 v171, v171
v_mfma_f32_16x16x32_bf16 v[140:143], a[136:139], v[72:75], v[140:143]
ds_read_b128 a[168:171], v2 offset:26624
v_cvt_pk_bf16_f32 v217, v170, v171
v_mfma_f32_16x16x32_bf16 v[136:139], a[136:139], v[56:59], v[136:139]
v_exp_f32 v184, v184
v_mfma_f32_16x16x32_bf16 v[152:155], a[152:155], v[56:59], v[152:155]
ds_read_b128 a[184:187], v2 offset:30720
v_mfma_f32_16x16x32_bf16 v[156:159], a[152:155], v[72:75], v[156:159]
v_exp_f32 v185, v185
v_mfma_f32_16x16x32_bf16 v[136:139], a[140:143], v[60:63], v[136:139]
ds_read_b128 a[172:175], v2 offset:27648
v_cvt_pk_bf16_f32 v218, v184, v185
v_mfma_f32_16x16x32_bf16 v[140:143], a[140:143], v[76:79], v[140:143]
v_exp_f32 v186, v186
v_mfma_f32_16x16x32_bf16 v[156:159], a[156:159], v[76:79], v[156:159]
ds_read_b128 a[188:191], v2 offset:31744
v_mfma_f32_16x16x32_bf16 v[152:155], a[156:159], v[60:63], v[152:155]
s_waitcnt lgkmcnt(8)
v_exp_f32 v187, v187
v_mfma_f32_16x16x32_bf16 a[64:67], a[192:195], v[200:203], a[64:67]
ds_read_b128 a[224:227], v2 offset:8192
v_cvt_pk_bf16_f32 v219, v186, v187
v_mfma_f32_16x16x32_bf16 a[96:99], a[192:195], v[204:207], a[96:99]
v_exp_f32 v172, v172
v_mfma_f32_16x16x32_bf16 a[100:103], a[196:199], v[204:207], a[100:103]
ds_read_b128 a[228:231], v2 offset:9216
v_mfma_f32_16x16x32_bf16 a[68:71], a[196:199], v[200:203], a[68:71]
v_exp_f32 v173, v173
v_mfma_f32_16x16x32_bf16 a[72:75], a[200:203], v[200:203], a[72:75]
ds_read_b128 a[232:235], v2 offset:10240
v_cvt_pk_bf16_f32 v220, v172, v173
v_mfma_f32_16x16x32_bf16 a[104:107], a[200:203], v[204:207], a[104:107]
v_exp_f32 v174, v174
v_mfma_f32_16x16x32_bf16 a[108:111], a[204:207], v[204:207], a[108:111]
ds_read_b128 a[236:239], v2 offset:11264
v_mfma_f32_16x16x32_bf16 a[76:79], a[204:207], v[200:203], a[76:79]
v_exp_f32 v175, v175
v_mfma_f32_16x16x32_bf16 a[80:83], a[208:211], v[200:203], a[80:83]
ds_read_b128 a[240:243], v2 offset:12288
v_cvt_pk_bf16_f32 v221, v174, v175
v_mfma_f32_16x16x32_bf16 a[112:115], a[208:211], v[204:207], a[112:115]
v_exp_f32 v188, v188
v_mfma_f32_16x16x32_bf16 a[116:119], a[212:215], v[204:207], a[116:119]
ds_read_b128 a[244:247], v2 offset:13312
v_mfma_f32_16x16x32_bf16 a[84:87], a[212:215], v[200:203], a[84:87]
v_exp_f32 v189, v189
v_mfma_f32_16x16x32_bf16 a[88:91], a[216:219], v[200:203], a[88:91]
ds_read_b128 a[248:251], v2 offset:14336
v_cvt_pk_bf16_f32 v222, v188, v189
v_mfma_f32_16x16x32_bf16 a[120:123], a[216:219], v[204:207], a[120:123]
v_exp_f32 v190, v190
v_mfma_f32_16x16x32_bf16 a[124:127], a[220:223], v[204:207], a[124:127]
ds_read_b128 a[252:255], v2 offset:15360
v_add_u32 v2, s82, v1
v_mfma_f32_16x16x32_bf16 a[92:95], a[220:223], v[200:203], a[92:95]
v_exp_f32 v191, v191
v_mfma_f32_16x16x32_bf16 v[232:235], v[120:123], v[200:203], v[232:235]
s_waitcnt vmcnt(4) lgkmcnt(8)
v_cvt_pk_bf16_f32 v223, v190, v191
v_mfma_f32_16x16x32_bf16 v[236:239], v[120:123], v[204:207], v[236:239]
s_barrier
s_cmp_le_u32 s58, 1
s_cbranch_scc1 Lalt39
v_mfma_f32_16x16x32_bf16 v[168:171], a[160:163], v[48:51], v[88:91]
v_exp_f32 v136, v136
v_mfma_f32_16x16x32_bf16 v[172:175], a[160:163], v[64:67], v[92:95]
ds_read_b128 a[128:131], v2 offset:16384
v_mfma_f32_16x16x32_bf16 v[184:187], a[176:179], v[48:51], v[88:91]
v_exp_f32 v137, v137
v_mfma_f32_16x16x32_bf16 v[188:191], a[176:179], v[64:67], v[92:95]
ds_read_b128 a[144:147], v2 offset:20480
v_cvt_pk_bf16_f32 v200, v136, v137
Ljoin41:
v_mfma_f32_16x16x32_bf16 v[168:171], a[164:167], v[52:55], v[168:171]
v_exp_f32 v138, v138
v_mfma_f32_16x16x32_bf16 v[172:175], a[164:167], v[68:71], v[172:175]
ds_read_b128 a[132:135], v2 offset:17408
v_mfma_f32_16x16x32_bf16 v[188:191], a[180:183], v[68:71], v[188:191]
v_exp_f32 v139, v139
v_mfma_f32_16x16x32_bf16 v[184:187], a[180:183], v[52:55], v[184:187]
ds_read_b128 a[148:151], v2 offset:21504
v_cvt_pk_bf16_f32 v201, v138, v139
v_mfma_f32_16x16x32_bf16 v[172:175], a[168:171], v[72:75], v[172:175]
v_exp_f32 v152, v152
v_mfma_f32_16x16x32_bf16 v[168:171], a[168:171], v[56:59], v[168:171]
ds_read_b128 a[136:139], v2 offset:18432
v_mfma_f32_16x16x32_bf16 v[184:187], a[184:187], v[56:59], v[184:187]
v_exp_f32 v153, v153
v_mfma_f32_16x16x32_bf16 v[188:191], a[184:187], v[72:75], v[188:191]
ds_read_b128 a[152:155], v2 offset:22528
v_cvt_pk_bf16_f32 v202, v152, v153
v_mfma_f32_16x16x32_bf16 v[168:171], a[172:175], v[60:63], v[168:171]
v_exp_f32 v154, v154
v_mfma_f32_16x16x32_bf16 v[172:175], a[172:175], v[76:79], v[172:175]
ds_read_b128 a[140:143], v2 offset:19456
v_mfma_f32_16x16x32_bf16 v[188:191], a[188:191], v[76:79], v[188:191]
v_exp_f32 v155, v155
v_mfma_f32_16x16x32_bf16 v[184:187], a[188:191], v[60:63], v[184:187]
s_waitcnt lgkmcnt(7)
ds_read_b128 a[156:159], v2 offset:23552
v_cvt_pk_bf16_f32 v203, v154, v155
v_mfma_f32_16x16x32_bf16 a[64:67], a[224:227], v[216:219], a[64:67]
v_exp_f32 v140, v140
v_mfma_f32_16x16x32_bf16 a[96:99], a[224:227], v[220:223], a[96:99]
ds_read_b128 a[192:195], v2 offset:0
v_mfma_f32_16x16x32_bf16 a[100:103], a[228:231], v[220:223], a[100:103]
v_exp_f32 v141, v141
v_mfma_f32_16x16x32_bf16 a[68:71], a[228:231], v[216:219], a[68:71]
ds_read_b128 a[196:199], v2 offset:1024
v_cvt_pk_bf16_f32 v204, v140, v141
v_mfma_f32_16x16x32_bf16 a[72:75], a[232:235], v[216:219], a[72:75]
v_exp_f32 v142, v142
v_mfma_f32_16x16x32_bf16 a[104:107], a[232:235], v[220:223], a[104:107]
ds_read_b128 a[200:203], v2 offset:2048
v_mfma_f32_16x16x32_bf16 a[108:111], a[236:239], v[220:223], a[108:111]
v_exp_f32 v143, v143
v_mfma_f32_16x16x32_bf16 a[76:79], a[236:239], v[216:219], a[76:79]
ds_read_b128 a[204:207], v2 offset:3072
v_cvt_pk_bf16_f32 v205, v142, v143
v_mfma_f32_16x16x32_bf16 a[80:83], a[240:243], v[216:219], a[80:83]
v_exp_f32 v156, v156
v_mfma_f32_16x16x32_bf16 a[112:115], a[240:243], v[220:223], a[112:115]
ds_read_b128 a[208:211], v2 offset:4096
v_mfma_f32_16x16x32_bf16 a[116:119], a[244:247], v[220:223], a[116:119]
v_exp_f32 v157, v157
v_mfma_f32_16x16x32_bf16 a[84:87], a[244:247], v[216:219], a[84:87]
ds_read_b128 a[212:215], v2 offset:5120
v_cvt_pk_bf16_f32 v206, v156, v157
v_mfma_f32_16x16x32_bf16 a[88:91], a[248:251], v[216:219], a[88:91]
v_exp_f32 v158, v158
v_mfma_f32_16x16x32_bf16 a[120:123], a[248:251], v[220:223], a[120:123]
ds_read_b128 a[216:219], v2 offset:6144
v_mfma_f32_16x16x32_bf16 a[124:127], a[252:255], v[220:223], a[124:127]
v_exp_f32 v159, v159
v_mfma_f32_16x16x32_bf16 a[92:95], a[252:255], v[216:219], a[92:95]
ds_read_b128 a[220:223], v2 offset:7168
v_cvt_pk_bf16_f32 v207, v158, v159
v_mfma_f32_16x16x32_bf16 v[232:235], v[120:123], v[216:219], v[232:235]
v_mfma_f32_16x16x32_bf16 v[236:239], v[120:123], v[220:223], v[236:239]
s_waitcnt lgkmcnt(8)
s_cmp_le_u32 s58, 2
s_cbranch_scc1 Lalt42
v_mfma_f32_16x16x32_bf16 v[136:139], a[128:131], v[48:51], v[88:91]
s_add_u32 s82, s82, 0x8000
ds_read_b128 a[160:163], v2 offset:24576
v_mfma_f32_16x16x32_bf16 v[140:143], a[128:131], v[64:67], v[92:95]
s_and_b32 s82, s82, 0x1ffff
v_exp_f32 v168, v168
v_mfma_f32_16x16x32_bf16 v[152:155], a[144:147], v[48:51], v[88:91]
ds_read_b128 a[176:179], v2 offset:28672
v_mfma_f32_16x16x32_bf16 v[156:159], a[144:147], v[64:67], v[92:95]
v_exp_f32 v169, v169
Ljoin44:
v_mfma_f32_16x16x32_bf16 v[136:139], a[132:135], v[52:55], v[136:139]
ds_read_b128 a[164:167], v2 offset:25600
v_cvt_pk_bf16_f32 v216, v168, v169
v_mfma_f32_16x16x32_bf16 v[140:143], a[132:135], v[68:71], v[140:143]
v_exp_f32 v170, v170
v_mfma_f32_16x16x32_bf16 v[156:159], a[148:151], v[68:71], v[156:159]
ds_read_b128 a[180:183], v2 offset:29696
v_mfma_f32_16x16x32_bf16 v[152:155], a[148:151], v[52:55], v[152:155]
v_exp_f32 v171, v171
v_mfma_f32_16x16x32_bf16 v[140:143], a[136:139], v[72:75], v[140:143]
ds_read_b128 a[168:171], v2 offset:26624
v_cvt_pk_bf16_f32 v217, v170, v171
v_mfma_f32_16x16x32_bf16 v[136:139], a[136:139], v[56:59], v[136:139]
v_exp_f32 v184, v184
v_mfma_f32_16x16x32_bf16 v[152:155], a[152:155], v[56:59], v[152:155]
ds_read_b128 a[184:187], v2 offset:30720
v_mfma_f32_16x16x32_bf16 v[156:159], a[152:155], v[72:75], v[156:159]
v_exp_f32 v185, v185
v_mfma_f32_16x16x32_bf16 v[136:139], a[140:143], v[60:63], v[136:139]
ds_read_b128 a[172:175], v2 offset:27648
v_cvt_pk_bf16_f32 v218, v184, v185
v_mfma_f32_16x16x32_bf16 v[140:143], a[140:143], v[76:79], v[140:143]
v_exp_f32 v186, v186
v_mfma_f32_16x16x32_bf16 v[156:159], a[156:159], v[76:79], v[156:159]
ds_read_b128 a[188:191], v2 offset:31744
v_mfma_f32_16x16x32_bf16 v[152:155], a[156:159], v[60:63], v[152:155]
s_waitcnt lgkmcnt(8)
v_exp_f32 v187, v187
v_mfma_f32_16x16x32_bf16 a[64:67], a[192:195], v[200:203], a[64:67]
ds_read_b128 a[224:227], v2 offset:8192
v_cvt_pk_bf16_f32 v219, v186, v187
v_mfma_f32_16x16x32_bf16 a[96:99], a[192:195], v[204:207], a[96:99]
v_exp_f32 v172, v172
v_mfma_f32_16x16x32_bf16 a[100:103], a[196:199], v[204:207], a[100:103]
ds_read_b128 a[228:231], v2 offset:9216
v_mfma_f32_16x16x32_bf16 a[68:71], a[196:199], v[200:203], a[68:71]
v_exp_f32 v173, v173
v_mfma_f32_16x16x32_bf16 a[72:75], a[200:203], v[200:203], a[72:75]
ds_read_b128 a[232:235], v2 offset:10240
v_cvt_pk_bf16_f32 v220, v172, v173
v_mfma_f32_16x16x32_bf16 a[104:107], a[200:203], v[204:207], a[104:107]
v_exp_f32 v174, v174
v_mfma_f32_16x16x32_bf16 a[108:111], a[204:207], v[204:207], a[108:111]
ds_read_b128 a[236:239], v2 offset:11264
v_mfma_f32_16x16x32_bf16 a[76:79], a[204:207], v[200:203], a[76:79]
v_exp_f32 v175, v175
v_mfma_f32_16x16x32_bf16 a[80:83], a[208:211], v[200:203], a[80:83]
ds_read_b128 a[240:243], v2 offset:12288
v_cvt_pk_bf16_f32 v221, v174, v175
v_mfma_f32_16x16x32_bf16 a[112:115], a[208:211], v[204:207], a[112:115]
v_exp_f32 v188, v188
v_mfma_f32_16x16x32_bf16 a[116:119], a[212:215], v[204:207], a[116:119]
ds_read_b128 a[244:247], v2 offset:13312
v_mfma_f32_16x16x32_bf16 a[84:87], a[212:215], v[200:203], a[84:87]
v_exp_f32 v189, v189
v_mfma_f32_16x16x32_bf16 a[88:91], a[216:219], v[200:203], a[88:91]
ds_read_b128 a[248:251], v2 offset:14336
v_cvt_pk_bf16_f32 v222, v188, v189
v_mfma_f32_16x16x32_bf16 a[120:123], a[216:219], v[204:207], a[120:123]
v_exp_f32 v190, v190
v_mfma_f32_16x16x32_bf16 a[124:127], a[220:223], v[204:207], a[124:127]
ds_read_b128 a[252:255], v2 offset:15360
v_add_u32 v2, s82, v1
v_mfma_f32_16x16x32_bf16 a[92:95], a[220:223], v[200:203], a[92:95]
v_exp_f32 v191, v191
v_mfma_f32_16x16x32_bf16 v[232:235], v[120:123], v[200:203], v[232:235]
s_waitcnt vmcnt(0) lgkmcnt(8)
v_cvt_pk_bf16_f32 v223, v190, v191
v_mfma_f32_16x16x32_bf16 v[236:239], v[120:123], v[204:207], v[236:239]
s_barrier
LHT3:
s_cmp_le_u32 s58, 3
s_cbranch_scc1 Lalt45
v_mfma_f32_16x16x32_bf16 v[168:171], a[160:163], v[48:51], v[88:91]
v_exp_f32 v136, v136
v_mfma_f32_16x16x32_bf16 v[172:175], a[160:163], v[64:67], v[92:95]
ds_read_b128 a[192:195], v2 offset:0
v_mfma_f32_16x16x32_bf16 v[184:187], a[176:179], v[48:51], v[88:91]
v_exp_f32 v137, v137
v_mfma_f32_16x16x32_bf16 v[188:191], a[176:179], v[64:67], v[92:95]
v_exp_f32 v138, v138
Ljoin47:
v_mfma_f32_16x16x32_bf16 v[168:171], a[164:167], v[52:55], v[168:171]
ds_read_b128 a[196:199], v2 offset:1024
v_cvt_pk_bf16_f32 v200, v136, v137
v_mfma_f32_16x16x32_bf16 v[172:175], a[164:167], v[68:71], v[172:175]
v_exp_f32 v139, v139
v_mfma_f32_16x16x32_bf16 v[188:191], a[180:183], v[68:71], v[188:191]
v_exp_f32 v152, v152
v_mfma_f32_16x16x32_bf16 v[184:187], a[180:183], v[52:55], v[184:187]
ds_read_b128 a[200:203], v2 offset:2048
v_cvt_pk_bf16_f32 v201, v138, v139
v_mfma_f32_16x16x32_bf16 v[172:175], a[168:171], v[72:75], v[172:175]
v_exp_f32 v153, v153
v_mfma_f32_16x16x32_bf16 v[168:171], a[168:171], v[56:59], v[168:171]
v_exp_f32 v154, v154
v_mfma_f32_16x16x32_bf16 v[184:187], a[184:187], v[56:59], v[184:187]
ds_read_b128 a[204:207], v2 offset:3072
v_cvt_pk_bf16_f32 v202, v152, v153
v_mfma_f32_16x16x32_bf16 v[188:191], a[184:187], v[72:75], v[188:191]
v_exp_f32 v155, v155
v_mfma_f32_16x16x32_bf16 v[168:171], a[172:175], v[60:63], v[168:171]
v_exp_f32 v140, v140
v_mfma_f32_16x16x32_bf16 v[172:175], a[172:175], v[76:79], v[172:175]
ds_read_b128 a[208:211], v2 offset:4096
v_cvt_pk_bf16_f32 v203, v154, v155
v_mfma_f32_16x16x32_bf16 v[188:191], a[188:191], v[76:79], v[188:191]
v_exp_f32 v141, v141
v_mfma_f32_16x16x32_bf16 v[184:187], a[188:191], v[60:63], v[184:187]
s_waitcnt lgkmcnt(5)
v_exp_f32 v142, v142
v_mfma_f32_16x16x32_bf16 a[64:67], a[224:227], v[216:219], a[64:67]
ds_read_b128 a[212:215], v2 offset:5120
v_cvt_pk_bf16_f32 v204, v140, v141
v_mfma_f32_16x16x32_bf16 a[96:99], a[224:227], v[220:223], a[96:99]
v_exp_f32 v143, v143
v_mfma_f32_16x16x32_bf16 a[100:103], a[228:231], v[220:223], a[100:103]
v_exp_f32 v156, v156
v_mfma_f32_16x16x32_bf16 a[68:71], a[228:231], v[216:219], a[68:71]
ds_read_b128 a[216:219], v2 offset:6144
v_cvt_pk_bf16_f32 v205, v142, v143
v_mfma_f32_16x16x32_bf16 a[72:75], a[232:235], v[216:219], a[72:75]
v_exp_f32 v157, v157
v_mfma_f32_16x16x32_bf16 a[104:107], a[232:235], v[220:223], a[104:107]
v_exp_f32 v158, v158
v_mfma_f32_16x16x32_bf16 a[108:111], a[236:239], v[220:223], a[108:111]
ds_read_b128 a[220:223], v2 offset:7168
v_cvt_pk_bf16_f32 v206, v156, v157
v_mfma_f32_16x16x32_bf16 a[76:79], a[236:239], v[216:219], a[76:79]
v_exp_f32 v159, v159
v_mfma_f32_16x16x32_bf16 a[80:83], a[240:243], v[216:219], a[80:83]
v_cvt_pk_bf16_f32 v207, v158, v159
v_mfma_f32_16x16x32_bf16 a[112:115], a[240:243], v[220:223], a[112:115]
v_mfma_f32_16x16x32_bf16 a[116:119], a[244:247], v[220:223], a[116:119]
v_mfma_f32_16x16x32_bf16 a[84:87], a[244:247], v[216:219], a[84:87]
v_mfma_f32_16x16x32_bf16 a[88:91], a[248:251], v[216:219], a[88:91]
v_mfma_f32_16x16x32_bf16 a[120:123], a[248:251], v[220:223], a[120:123]
v_mfma_f32_16x16x32_bf16 a[124:127], a[252:255], v[220:223], a[124:127]
v_mfma_f32_16x16x32_bf16 a[92:95], a[252:255], v[216:219], a[92:95]
v_mfma_f32_16x16x32_bf16 v[232:235], v[120:123], v[216:219], v[232:235]
v_mfma_f32_16x16x32_bf16 v[236:239], v[120:123], v[220:223], v[236:239]
s_waitcnt lgkmcnt(0)
v_mfma_f32_16x16x32_bf16 a[64:67], a[192:195], v[200:203], a[64:67]
s_add_u32 s82, s82, 0x8000
ds_read_b128 a[224:227], v2 offset:8192
ds_read_b128 a[228:231], v2 offset:9216
v_mfma_f32_16x16x32_bf16 a[96:99], a[192:195], v[204:207], a[96:99]
s_and_b32 s82, s82, 0x1ffff
v_exp_f32 v168, v168
v_mfma_f32_16x16x32_bf16 a[100:103], a[196:199], v[204:207], a[100:103]
v_exp_f32 v169, v169
v_mfma_f32_16x16x32_bf16 a[68:71], a[196:199], v[200:203], a[68:71]
v_exp_f32 v170, v170
v_mfma_f32_16x16x32_bf16 a[72:75], a[200:203], v[200:203], a[72:75]
v_exp_f32 v171, v171
v_mfma_f32_16x16x32_bf16 a[104:107], a[200:203], v[204:207], a[104:107]
ds_read_b128 a[232:235], v2 offset:10240
ds_read_b128 a[236:239], v2 offset:11264
v_mfma_f32_16x16x32_bf16 a[108:111], a[204:207], v[204:207], a[108:111]
v_exp_f32 v184, v184
v_mfma_f32_16x16x32_bf16 a[76:79], a[204:207], v[200:203], a[76:79]
ds_read_b128 a[240:243], v2 offset:12288
ds_read_b128 a[244:247], v2 offset:13312
v_mfma_f32_16x16x32_bf16 a[80:83], a[208:211], v[200:203], a[80:83]
ds_read_b128 a[248:251], v2 offset:14336
ds_read_b128 a[252:255], v2 offset:15360
v_mfma_f32_16x16x32_bf16 a[112:115], a[208:211], v[204:207], a[112:115]
v_cvt_pk_bf16_f32 v216, v168, v169
v_cvt_pk_bf16_f32 v217, v170, v171
v_mfma_f32_16x16x32_bf16 a[116:119], a[212:215], v[204:207], a[116:119]
v_exp_f32 v185, v185
v_mfma_f32_16x16x32_bf16 a[84:87], a[212:215], v[200:203], a[84:87]
v_exp_f32 v186, v186
v_mfma_f32_16x16x32_bf16 a[88:91], a[216:219], v[200:203], a[88:91]
v_exp_f32 v187, v187
v_mfma_f32_16x16x32_bf16 a[120:123], a[216:219], v[204:207], a[120:123]
v_exp_f32 v172, v172
v_mfma_f32_16x16x32_bf16 a[124:127], a[220:223], v[204:207], a[124:127]
v_cvt_pk_bf16_f32 v218, v184, v185
v_cvt_pk_bf16_f32 v219, v186, v187
v_mfma_f32_16x16x32_bf16 a[92:95], a[220:223], v[200:203], a[92:95]
v_exp_f32 v173, v173
v_mfma_f32_16x16x32_bf16 v[232:235], v[120:123], v[200:203], v[232:235]
s_waitcnt vmcnt(0) lgkmcnt(0)
v_exp_f32 v174, v174
v_mfma_f32_16x16x32_bf16 v[236:239], v[120:123], v[204:207], v[236:239]
s_barrier
v_exp_f32 v175, v175
v_add_u32 v2, s82, v1
v_cvt_pk_bf16_f32 v220, v172, v173
v_exp_f32 v188, v188
v_cvt_pk_bf16_f32 v221, v174, v175
v_exp_f32 v189, v189
v_exp_f32 v190, v190
v_cvt_pk_bf16_f32 v222, v188, v189
v_exp_f32 v191, v191
s_nop 0
v_cvt_pk_bf16_f32 v223, v190, v191
v_mfma_f32_16x16x32_bf16 a[64:67], a[224:227], v[216:219], a[64:67]
s_add_u32 m0, s92, 16640
v_mfma_f32_16x16x32_bf16 a[96:99], a[224:227], v[220:223], a[96:99]
s_add_u32 s72, s93, 0x3000000
buffer_load_dwordx4 v1, s[44:47], s72 offen sc1 lds
v_mfma_f32_16x16x32_bf16 a[100:103], a[228:231], v[220:223], a[100:103]
buffer_load_dwordx4 v1, s[44:47], s72 offen offset:1024 sc1 lds
v_mfma_f32_16x16x32_bf16 a[68:71], a[228:231], v[216:219], a[68:71]
buffer_load_dwordx4 v1, s[44:47], s72 offen offset:2048 sc1 lds
v_mfma_f32_16x16x32_bf16 a[72:75], a[232:235], v[216:219], a[72:75]
buffer_load_dwordx4 v1, s[44:47], s72 offen offset:3072 sc1 lds
v_mfma_f32_16x16x32_bf16 a[104:107], a[232:235], v[220:223], a[104:107]
s_add_u32 m0, s92, 32
v_mfma_f32_16x16x32_bf16 a[108:111], a[236:239], v[220:223], a[108:111]
s_add_u32 s72, s93, 0
buffer_load_dwordx4 v1, s[36:39], s72 offen lds
v_mfma_f32_16x16x32_bf16 a[76:79], a[236:239], v[216:219], a[76:79]
buffer_load_dwordx4 v1, s[36:39], s72 offen offset:1024 lds
v_mfma_f32_16x16x32_bf16 a[80:83], a[240:243], v[216:219], a[80:83]
buffer_load_dwordx4 v1, s[36:39], s72 offen offset:2048 lds
v_mfma_f32_16x16x32_bf16 a[112:115], a[240:243], v[220:223], a[112:115]
buffer_load_dwordx4 v1, s[36:39], s72 offen offset:3072 lds
v_mfma_f32_16x16x32_bf16 a[116:119], a[244:247], v[220:223], a[116:119]
s_add_u32 m0, s92, 4192
v_mfma_f32_16x16x32_bf16 a[84:87], a[244:247], v[216:219], a[84:87]
s_add_u32 s72, s93, 2
buffer_load_dwordx4 v1, s[36:39], s72 offen lds
v_mfma_f32_16x16x32_bf16 a[88:91], a[248:251], v[216:219], a[88:91]
buffer_load_dwordx4 v1, s[36:39], s72 offen offset:1024 lds
v_mfma_f32_16x16x32_bf16 a[120:123], a[248:251], v[220:223], a[120:123]
buffer_load_dwordx4 v1, s[36:39], s72 offen offset:2048 lds
v_mfma_f32_16x16x32_bf16 a[124:127], a[252:255], v[220:223], a[124:127]
buffer_load_dwordx4 v1, s[36:39], s72 offen offset:3072 lds
v_mfma_f32_16x16x32_bf16 a[92:95], a[252:255], v[216:219], a[92:95]
s_add_u32 m0, s92, 8352
v_mfma_f32_16x16x32_bf16 v[232:235], v[120:123], v[216:219], v[232:235]
s_add_u32 s72, s93, 4
buffer_load_dwordx4 v1, s[36:39], s72 offen lds
v_mfma_f32_16x16x32_bf16 v[236:239], v[120:123], v[220:223], v[236:239]
buffer_load_dwordx4 v1, s[36:39], s72 offen offset:1024 lds
buffer_load_dwordx4 v1, s[36:39], s72 offen offset:2048 lds
buffer_load_dwordx4 v1, s[36:39], s72 offen offset:3072 lds
s_add_u32 m0, s92, 12512
s_add_u32 s72, s93, 6
buffer_load_dwordx4 v1, s[36:39], s72 offen lds
buffer_load_dwordx4 v1, s[36:39], s72 offen offset:1024 lds
buffer_load_dwordx4 v1, s[36:39], s72 offen offset:2048 lds
buffer_load_dwordx4 v1, s[36:39], s72 offen offset:3072 lds
v_bfe_u32 v128, v0, 2, 2
v_and_b32 v129, 3, v0
v_mul_u32_u24 v130, 4160, v128
v_lshl_add_u32 v130, v129, 3, v130
v_add_u32 v130, s92, v130
v_lshlrev_b32 v128, 4, v128
v_sub_u32 v128, 48, v128
v_lshlrev_b64 v[132:133], 16, s[88:89]
v_cmp_eq_u32 vcc, 3, v129
v_lshlrev_b64 v[132:133], v128, v[132:133]
v_mov_b32 v134, 0
v_mov_b32 v135, 0
v_cndmask_b32 v132, 0, v132, vcc
v_cndmask_b32 v133, 0, v133, vcc
s_add_u32 s73, s92, 20736
v_lshlrev_b32 v131, 3, v0
v_add_u32 v131, s73, v131
ds_write_b64 v130, v[132:133]
ds_write_b64 v131, v[134:135]
v_and_b32 v128, 15, v0
v_lshrrev_b32 v129, 4, v0
v_add_u32 v136, 1, v128
v_and_b32 v137, 3, v136
v_lshrrev_b32 v136, 2, v136
v_mul_u32_u24 v137, 4160, v137
v_lshl_add_u32 v137, v136, 3, v137
v_lshl_add_u32 v137, v129, 4, v137
v_add_u32 v164, s92, v137
s_add_u32 s73, s92, 17120
v_lshlrev_b32 v136, 5, v128
v_sub_u32 v136, s73, v136
v_lshl_add_u32 v165, v129, 4, v136
v_lshrrev_b32 v136, 3, v128
v_and_b32 v137, 7, v0
v_lshlrev_b32 v137, 3, v137
v_lshl_add_u32 v137, v136, 8, v137
v_lshl_add_u32 v166, v129, 6, v137
s_and_b32 s73, s58, 1
s_lshl_b32 s73, s73, 4
s_lshr_b32 s73, s90, s73
s_and_b32 s73, s73, 0xffff
v_lshl_add_u32 v136, v129, 3, v128
v_sub_u32 v136, 15, v136
v_and_b32 v137, 1, v136
v_lshlrev_b32 v137, 4, v137
v_lshlrev_b32 v137, v137, s73
v_lshrrev_b32 v136, 1, v136
v_cmp_eq_u32 vcc, 0, v136
s_nop 1
v_cndmask_b32 v160, 0, v137, vcc
v_cmp_eq_u32 vcc, 1, v136
s_nop 1
v_cndmask_b32 v161, 0, v137, vcc
v_cmp_eq_u32 vcc, 2, v136
s_nop 1
v_cndmask_b32 v162, 0, v137, vcc
v_cmp_eq_u32 vcc, 3, v136
s_nop 1
v_cndmask_b32 v163, 0, v137, vcc
s_lshr_b32 s75, s59, 3
s_lshl_b32 s75, s75, 2
s_and_b32 s73, s59, 3
s_add_u32 s75, s75, s73
s_lshl_b32 s76, s59, 1
s_and_b32 s76, s76, 8
s_add_u32 s76, s76, s60
s_lshl_b32 s94, s58, 16
s_lshl_b32 s73, s76, 7
s_add_u32 s94, s94, s73
s_lshl_b32 s95, s75, 20
s_lshl_b32 s73, s58, 18
s_add_u32 s95, s95, s73
s_add_u32 s95, s95, 0x2000000
v_lshlrev_b32 v136, 1, v129
v_and_b32 v137, 7, v0
v_xor_b32 v137, v137, v136
v_lshlrev_b32 v137, 4, v137
v_lshrrev_b32 v136, 3, v0
v_lshl_add_u32 v4, v136, 11, v137
s_add_u32 s71, s61, 0
s_and_b32 s71, s71, 7
s_lshl_b32 s71, s71, 18
s_add_u32 s71, s71, s94
s_add_u32 m0, s64, 98304
s_add_u32 s72, s71, 0
buffer_load_dwordx4 v4, s[24:27], s72 offen lds
s_add_u32 s72, s71, 15360
buffer_load_dwordx4 v4, s[24:27], s72 offen offset:1024 lds
s_add_u32 s72, s71, 30720
buffer_load_dwordx4 v4, s[24:27], s72 offen offset:2048 lds
s_add_u32 s72, s71, 46080
buffer_load_dwordx4 v4, s[24:27], s72 offen offset:3072 lds
s_mov_b32 s73, 0x5d800000
v_add_f32 v240, v224, v228
v_add_f32 v241, v232, v236
v_add_f32 v240, v240, v241
v_cmp_nlt_f32 vcc, v240, s73
s_cmp_lg_u64 vcc, 0
s_cselect_b32 s73, 1, 0
s_lshl_b32 s74, s58, 2
s_add_u32 s74, s74, 90112
v_mov_b32 v240, s73
v_mov_b32 v241, s74
ds_write_b32 v241, v240
v_rcp_f32 v224, v224
v_rcp_f32 v228, v228
v_rcp_f32 v232, v232
v_rcp_f32 v236, v236
s_lshl_b32 s73, s59, 12
s_add_u32 s73, s73, 0x2000000
s_lshl_b32 s69, s67, 2
s_add_u32 s69, s69, s73
s_lshl_b32 s70, s68, 2
s_add_u32 s70, s70, s73
v_mov_b32 v225, v224
v_accvgpr_read_b32 v240, a0
v_accvgpr_read_b32 v241, a1
v_accvgpr_read_b32 v242, a2
v_accvgpr_read_b32 v243, a3
v_accvgpr_read_b32 v244, a4
v_accvgpr_read_b32 v245, a5
v_accvgpr_read_b32 v246, a6
v_accvgpr_read_b32 v247, a7
v_pk_mul_f32 v[240:241], v[240:241], v[224:225]
v_pk_mul_f32 v[242:243], v[242:243], v[224:225]
v_pk_mul_f32 v[244:245], v[244:245], v[224:225]
v_pk_mul_f32 v[246:247], v[246:247], v[224:225]
v_cvt_pk_bf16_f32 v240, v240, v241
v_cvt_pk_bf16_f32 v241, v242, v243
v_cvt_pk_bf16_f32 v242, v244, v245
v_cvt_pk_bf16_f32 v243, v246, v247
buffer_store_dwordx4 v[240:243], v1, s[44:47], s69 offen sc1
v_accvgpr_read_b32 v248, a8
v_accvgpr_read_b32 v249, a9
v_accvgpr_read_b32 v250, a10
v_accvgpr_read_b32 v251, a11
v_accvgpr_read_b32 v252, a12
v_accvgpr_read_b32 v253, a13
v_accvgpr_read_b32 v254, a14
v_accvgpr_read_b32 v255, a15
v_pk_mul_f32 v[248:249], v[248:249], v[224:225]
v_pk_mul_f32 v[250:251], v[250:251], v[224:225]
v_pk_mul_f32 v[252:253], v[252:253], v[224:225]
v_pk_mul_f32 v[254:255], v[254:255], v[224:225]
v_cvt_pk_bf16_f32 v248, v248, v249
v_cvt_pk_bf16_f32 v249, v250, v251
v_cvt_pk_bf16_f32 v250, v252, v253
v_cvt_pk_bf16_f32 v251, v254, v255
buffer_store_dwordx4 v[248:251], v1, s[44:47], s69 offen offset:1024 sc1
v_accvgpr_read_b32 v240, a16
v_accvgpr_read_b32 v241, a17
v_accvgpr_read_b32 v242, a18
v_accvgpr_read_b32 v243, a19
v_accvgpr_read_b32 v244, a20
v_accvgpr_read_b32 v245, a21
v_accvgpr_read_b32 v246, a22
v_accvgpr_read_b32 v247, a23
v_pk_mul_f32 v[240:241], v[240:241], v[224:225]
v_pk_mul_f32 v[242:243], v[242:243], v[224:225]
v_pk_mul_f32 v[244:245], v[244:245], v[224:225]
v_pk_mul_f32 v[246:247], v[246:247], v[224:225]
v_cvt_pk_bf16_f32 v240, v240, v241
v_cvt_pk_bf16_f32 v241, v242, v243
v_cvt_pk_bf16_f32 v242, v244, v245
v_cvt_pk_bf16_f32 v243, v246, v247
buffer_store_dwordx4 v[240:243], v1, s[44:47], s69 offen offset:2048 sc1
v_accvgpr_read_b32 v248, a24
v_accvgpr_read_b32 v249, a25
v_accvgpr_read_b32 v250, a26
v_accvgpr_read_b32 v251, a27
v_accvgpr_read_b32 v252, a28
v_accvgpr_read_b32 v253, a29
v_accvgpr_read_b32 v254, a30
v_accvgpr_read_b32 v255, a31
v_pk_mul_f32 v[248:249], v[248:249], v[224:225]
v_pk_mul_f32 v[250:251], v[250:251], v[224:225]
v_pk_mul_f32 v[252:253], v[252:253], v[224:225]
v_pk_mul_f32 v[254:255], v[254:255], v[224:225]
v_cvt_pk_bf16_f32 v248, v248, v249
v_cvt_pk_bf16_f32 v249, v250, v251
v_cvt_pk_bf16_f32 v250, v252, v253
v_cvt_pk_bf16_f32 v251, v254, v255
buffer_store_dwordx4 v[248:251], v1, s[44:47], s69 offen offset:3072 sc1
s_add_u32 s69, s69, 0x20000
v_mov_b32 v229, v228
v_accvgpr_read_b32 v240, a32
v_accvgpr_read_b32 v241, a33
v_accvgpr_read_b32 v242, a34
v_accvgpr_read_b32 v243, a35
v_accvgpr_read_b32 v244, a36
v_accvgpr_read_b32 v245, a37
v_accvgpr_read_b32 v246, a38
v_accvgpr_read_b32 v247, a39
v_pk_mul_f32 v[240:241], v[240:241], v[228:229]
v_pk_mul_f32 v[242:243], v[242:243], v[228:229]
v_pk_mul_f32 v[244:245], v[244:245], v[228:229]
v_pk_mul_f32 v[246:247], v[246:247], v[228:229]
v_cvt_pk_bf16_f32 v240, v240, v241
v_cvt_pk_bf16_f32 v241, v242, v243
v_cvt_pk_bf16_f32 v242, v244, v245
v_cvt_pk_bf16_f32 v243, v246, v247
buffer_store_dwordx4 v[240:243], v1, s[44:47], s69 offen sc1
v_accvgpr_read_b32 v248, a40
v_accvgpr_read_b32 v249, a41
v_accvgpr_read_b32 v250, a42
v_accvgpr_read_b32 v251, a43
v_accvgpr_read_b32 v252, a44
v_accvgpr_read_b32 v253, a45
v_accvgpr_read_b32 v254, a46
v_accvgpr_read_b32 v255, a47
v_pk_mul_f32 v[248:249], v[248:249], v[228:229]
v_pk_mul_f32 v[250:251], v[250:251], v[228:229]
v_pk_mul_f32 v[252:253], v[252:253], v[228:229]
v_pk_mul_f32 v[254:255], v[254:255], v[228:229]
v_cvt_pk_bf16_f32 v248, v248, v249
v_cvt_pk_bf16_f32 v249, v250, v251
v_cvt_pk_bf16_f32 v250, v252, v253
v_cvt_pk_bf16_f32 v251, v254, v255
buffer_store_dwordx4 v[248:251], v1, s[44:47], s69 offen offset:1024 sc1
v_accvgpr_read_b32 v240, a48
v_accvgpr_read_b32 v241, a49
v_accvgpr_read_b32 v242, a50
v_accvgpr_read_b32 v243, a51
v_accvgpr_read_b32 v244, a52
v_accvgpr_read_b32 v245, a53
v_accvgpr_read_b32 v246, a54
v_accvgpr_read_b32 v247, a55
v_pk_mul_f32 v[240:241], v[240:241], v[228:229]
v_pk_mul_f32 v[242:243], v[242:243], v[228:229]
v_pk_mul_f32 v[244:245], v[244:245], v[228:229]
v_pk_mul_f32 v[246:247], v[246:247], v[228:229]
v_cvt_pk_bf16_f32 v240, v240, v241
v_cvt_pk_bf16_f32 v241, v242, v243
v_cvt_pk_bf16_f32 v242, v244, v245
v_cvt_pk_bf16_f32 v243, v246, v247
buffer_store_dwordx4 v[240:243], v1, s[44:47], s69 offen offset:2048 sc1
v_accvgpr_read_b32 v248, a56
v_accvgpr_read_b32 v249, a57
v_accvgpr_read_b32 v250, a58
v_accvgpr_read_b32 v251, a59
v_accvgpr_read_b32 v252, a60
v_accvgpr_read_b32 v253, a61
v_accvgpr_read_b32 v254, a62
v_accvgpr_read_b32 v255, a63
v_pk_mul_f32 v[248:249], v[248:249], v[228:229]
v_pk_mul_f32 v[250:251], v[250:251], v[228:229]
v_pk_mul_f32 v[252:253], v[252:253], v[228:229]
v_pk_mul_f32 v[254:255], v[254:255], v[228:229]
v_cvt_pk_bf16_f32 v248, v248, v249
v_cvt_pk_bf16_f32 v249, v250, v251
v_cvt_pk_bf16_f32 v250, v252, v253
v_cvt_pk_bf16_f32 v251, v254, v255
buffer_store_dwordx4 v[248:251], v1, s[44:47], s69 offen offset:3072 sc1
v_mov_b32 v233, v232
v_accvgpr_read_b32 v240, a64
v_accvgpr_read_b32 v241, a65
v_accvgpr_read_b32 v242, a66
v_accvgpr_read_b32 v243, a67
v_accvgpr_read_b32 v244, a68
v_accvgpr_read_b32 v245, a69
v_accvgpr_read_b32 v246, a70
v_accvgpr_read_b32 v247, a71
v_pk_mul_f32 v[240:241], v[240:241], v[232:233]
v_pk_mul_f32 v[242:243], v[242:243], v[232:233]
v_pk_mul_f32 v[244:245], v[244:245], v[232:233]
v_pk_mul_f32 v[246:247], v[246:247], v[232:233]
v_cvt_pk_bf16_f32 v240, v240, v241
v_cvt_pk_bf16_f32 v241, v242, v243
v_cvt_pk_bf16_f32 v242, v244, v245
v_cvt_pk_bf16_f32 v243, v246, v247
buffer_store_dwordx4 v[240:243], v1, s[44:47], s70 offen sc1
v_accvgpr_read_b32 v248, a72
v_accvgpr_read_b32 v249, a73
v_accvgpr_read_b32 v250, a74
v_accvgpr_read_b32 v251, a75
v_accvgpr_read_b32 v252, a76
v_accvgpr_read_b32 v253, a77
v_accvgpr_read_b32 v254, a78
v_accvgpr_read_b32 v255, a79
v_pk_mul_f32 v[248:249], v[248:249], v[232:233]
v_pk_mul_f32 v[250:251], v[250:251], v[232:233]
v_pk_mul_f32 v[252:253], v[252:253], v[232:233]
v_pk_mul_f32 v[254:255], v[254:255], v[232:233]
v_cvt_pk_bf16_f32 v248, v248, v249
v_cvt_pk_bf16_f32 v249, v250, v251
v_cvt_pk_bf16_f32 v250, v252, v253
v_cvt_pk_bf16_f32 v251, v254, v255
buffer_store_dwordx4 v[248:251], v1, s[44:47], s70 offen offset:1024 sc1
v_accvgpr_read_b32 v240, a80
v_accvgpr_read_b32 v241, a81
v_accvgpr_read_b32 v242, a82
v_accvgpr_read_b32 v243, a83
v_accvgpr_read_b32 v244, a84
v_accvgpr_read_b32 v245, a85
v_accvgpr_read_b32 v246, a86
v_accvgpr_read_b32 v247, a87
v_pk_mul_f32 v[240:241], v[240:241], v[232:233]
v_pk_mul_f32 v[242:243], v[242:243], v[232:233]
v_pk_mul_f32 v[244:245], v[244:245], v[232:233]
v_pk_mul_f32 v[246:247], v[246:247], v[232:233]
v_cvt_pk_bf16_f32 v240, v240, v241
v_cvt_pk_bf16_f32 v241, v242, v243
v_cvt_pk_bf16_f32 v242, v244, v245
v_cvt_pk_bf16_f32 v243, v246, v247
buffer_store_dwordx4 v[240:243], v1, s[44:47], s70 offen offset:2048 sc1
v_accvgpr_read_b32 v248, a88
v_accvgpr_read_b32 v249, a89
v_accvgpr_read_b32 v250, a90
v_accvgpr_read_b32 v251, a91
v_accvgpr_read_b32 v252, a92
v_accvgpr_read_b32 v253, a93
v_accvgpr_read_b32 v254, a94
v_accvgpr_read_b32 v255, a95
v_pk_mul_f32 v[248:249], v[248:249], v[232:233]
v_pk_mul_f32 v[250:251], v[250:251], v[232:233]
v_pk_mul_f32 v[252:253], v[252:253], v[232:233]
v_pk_mul_f32 v[254:255], v[254:255], v[232:233]
v_cvt_pk_bf16_f32 v248, v248, v249
v_cvt_pk_bf16_f32 v249, v250, v251
v_cvt_pk_bf16_f32 v250, v252, v253
v_cvt_pk_bf16_f32 v251, v254, v255
buffer_store_dwordx4 v[248:251], v1, s[44:47], s70 offen offset:3072 sc1
s_add_u32 s70, s70, 0x20000
v_mov_b32 v237, v236
v_accvgpr_read_b32 v240, a96
v_accvgpr_read_b32 v241, a97
v_accvgpr_read_b32 v242, a98
v_accvgpr_read_b32 v243, a99
v_accvgpr_read_b32 v244, a100
v_accvgpr_read_b32 v245, a101
v_accvgpr_read_b32 v246, a102
v_accvgpr_read_b32 v247, a103
v_pk_mul_f32 v[240:241], v[240:241], v[236:237]
v_pk_mul_f32 v[242:243], v[242:243], v[236:237]
v_pk_mul_f32 v[244:245], v[244:245], v[236:237]
v_pk_mul_f32 v[246:247], v[246:247], v[236:237]
v_cvt_pk_bf16_f32 v240, v240, v241
v_cvt_pk_bf16_f32 v241, v242, v243
v_cvt_pk_bf16_f32 v242, v244, v245
v_cvt_pk_bf16_f32 v243, v246, v247
buffer_store_dwordx4 v[240:243], v1, s[44:47], s70 offen sc1
v_accvgpr_read_b32 v248, a104
v_accvgpr_read_b32 v249, a105
v_accvgpr_read_b32 v250, a106
v_accvgpr_read_b32 v251, a107
v_accvgpr_read_b32 v252, a108
v_accvgpr_read_b32 v253, a109
v_accvgpr_read_b32 v254, a110
v_accvgpr_read_b32 v255, a111
v_pk_mul_f32 v[248:249], v[248:249], v[236:237]
v_pk_mul_f32 v[250:251], v[250:251], v[236:237]
v_pk_mul_f32 v[252:253], v[252:253], v[236:237]
v_pk_mul_f32 v[254:255], v[254:255], v[236:237]
v_cvt_pk_bf16_f32 v248, v248, v249
v_cvt_pk_bf16_f32 v249, v250, v251
v_cvt_pk_bf16_f32 v250, v252, v253
v_cvt_pk_bf16_f32 v251, v254, v255
buffer_store_dwordx4 v[248:251], v1, s[44:47], s70 offen offset:1024 sc1
v_accvgpr_read_b32 v240, a112
v_accvgpr_read_b32 v241, a113
v_accvgpr_read_b32 v242, a114
v_accvgpr_read_b32 v243, a115
v_accvgpr_read_b32 v244, a116
v_accvgpr_read_b32 v245, a117
v_accvgpr_read_b32 v246, a118
v_accvgpr_read_b32 v247, a119
v_pk_mul_f32 v[240:241], v[240:241], v[236:237]
v_pk_mul_f32 v[242:243], v[242:243], v[236:237]
v_pk_mul_f32 v[244:245], v[244:245], v[236:237]
v_pk_mul_f32 v[246:247], v[246:247], v[236:237]
v_cvt_pk_bf16_f32 v240, v240, v241
v_cvt_pk_bf16_f32 v241, v242, v243
v_cvt_pk_bf16_f32 v242, v244, v245
v_cvt_pk_bf16_f32 v243, v246, v247
buffer_store_dwordx4 v[240:243], v1, s[44:47], s70 offen offset:2048 sc1
v_accvgpr_read_b32 v248, a120
v_accvgpr_read_b32 v249, a121
v_accvgpr_read_b32 v250, a122
v_accvgpr_read_b32 v251, a123
v_accvgpr_read_b32 v252, a124
v_accvgpr_read_b32 v253, a125
v_accvgpr_read_b32 v254, a126
v_accvgpr_read_b32 v255, a127
v_pk_mul_f32 v[248:249], v[248:249], v[236:237]
v_pk_mul_f32 v[250:251], v[250:251], v[236:237]
v_pk_mul_f32 v[252:253], v[252:253], v[236:237]
v_pk_mul_f32 v[254:255], v[254:255], v[236:237]
v_cvt_pk_bf16_f32 v248, v248, v249
v_cvt_pk_bf16_f32 v249, v250, v251
v_cvt_pk_bf16_f32 v250, v252, v253
v_cvt_pk_bf16_f32 v251, v254, v255
buffer_store_dwordx4 v[248:251], v1, s[44:47], s70 offen offset:3072 sc1
s_waitcnt vmcnt(20) lgkmcnt(0)
ds_read_b128 a[192:195], v165 offset:3584
ds_read_b64 a[128:129], v164 offset:0
ds_read_b64 a[130:131], v164 offset:8
ds_read_b128 a[196:199], v165 offset:3072
ds_read_b64 a[132:133], v164 offset:512
ds_read_b64 a[134:135], v164 offset:520
ds_read_b128 a[200:203], v165 offset:2560
ds_read_b64 a[136:137], v164 offset:1024
ds_read_b64 a[138:139], v164 offset:1032
ds_read_b128 a[204:207], v165 offset:2048
ds_read_b64 a[140:141], v164 offset:1536
ds_read_b64 a[142:143], v164 offset:1544
ds_read_b128 a[208:211], v165 offset:1536
ds_read_b64 a[144:145], v164 offset:2048
ds_read_b64 a[146:147], v164 offset:2056
ds_read_b128 a[212:215], v165 offset:1024
ds_read_b64 a[148:149], v164 offset:2560
ds_read_b64 a[150:151], v164 offset:2568
ds_read_b128 a[216:219], v165 offset:512
ds_read_b64 a[152:153], v164 offset:3072
ds_read_b64 a[154:155], v164 offset:3080
ds_read_b128 a[220:223], v165 offset:0
ds_read_b64 a[156:157], v164 offset:3584
ds_read_b64 a[158:159], v164 offset:3592
s_waitcnt lgkmcnt(0)
v_mfma_f32_16x16x32_bf16 v[128:131], v[160:163], a[192:195], 0
s_add_u32 s71, s61, 1
ds_read_b128 a[224:227], v165 offset:3648
v_mfma_f32_16x16x32_bf16 v[132:135], v[160:163], a[196:199], 0
s_and_b32 s71, s71, 7
ds_read_b64 a[160:161], v164 offset:64
v_mfma_f32_16x16x32_bf16 v[136:139], v[160:163], a[200:203], 0
s_lshl_b32 s71, s71, 18
ds_read_b64 a[162:163], v164 offset:72
v_mfma_f32_16x16x32_bf16 v[140:143], v[160:163], a[204:207], 0
s_add_u32 s71, s71, s94
ds_read_b128 a[228:231], v165 offset:3136
v_mfma_f32_16x16x32_bf16 v[144:147], v[160:163], a[208:211], 0
s_add_u32 m0, s64, 114688
ds_read_b64 a[164:165], v164 offset:576
v_mfma_f32_16x16x32_bf16 v[148:151], v[160:163], a[212:215], 0
s_add_u32 s72, s71, 0
ds_read_b64 a[166:167], v164 offset:584
v_mfma_f32_16x16x32_bf16 v[152:155], v[160:163], a[216:219], 0
ds_read_b128 a[232:235], v165 offset:2624
v_mfma_f32_16x16x32_bf16 v[156:159], v[160:163], a[220:223], 0
ds_read_b64 a[168:169], v164 offset:1088
v_mfma_f32_16x16x32_bf16 v[128:131], a[128:131], a[192:195], v[128:131]
ds_read_b64 a[170:171], v164 offset:1096
v_mfma_f32_16x16x32_bf16 v[132:135], a[128:131], a[196:199], v[132:135]
ds_read_b128 a[236:239], v165 offset:2112
v_mfma_f32_16x16x32_bf16 v[136:139], a[128:131], a[200:203], v[136:139]
ds_read_b64 a[172:173], v164 offset:1600
v_mfma_f32_16x16x32_bf16 v[140:143], a[128:131], a[204:207], v[140:143]
ds_read_b64 a[174:175], v164 offset:1608
v_mfma_f32_16x16x32_bf16 v[144:147], a[128:131], a[208:211], v[144:147]
ds_read_b128 a[240:243], v165 offset:1600
v_mfma_f32_16x16x32_bf16 v[148:151], a[128:131], a[212:215], v[148:151]
ds_read_b64 a[176:177], v164 offset:2112
v_mfma_f32_16x16x32_bf16 v[152:155], a[128:131], a[216:219], v[152:155]
ds_read_b64 a[178:179], v164 offset:2120
v_mfma_f32_16x16x32_bf16 v[156:159], a[128:131], a[220:223], v[156:159]
ds_read_b128 a[244:247], v165 offset:1088
v_mfma_f32_16x16x32_bf16 v[132:135], a[132:135], a[192:195], v[132:135]
ds_read_b64 a[180:181], v164 offset:2624
v_mfma_f32_16x16x32_bf16 v[136:139], a[132:135], a[196:199], v[136:139]
ds_read_b64 a[182:183], v164 offset:2632
v_mfma_f32_16x16x32_bf16 v[140:143], a[132:135], a[200:203], v[140:143]
ds_read_b128 a[248:251], v165 offset:576
v_mfma_f32_16x16x32_bf16 v[144:147], a[132:135], a[204:207], v[144:147]
ds_read_b64 a[184:185], v164 offset:3136
v_mfma_f32_16x16x32_bf16 v[148:151], a[132:135], a[208:211], v[148:151]
ds_read_b64 a[186:187], v164 offset:3144
v_mfma_f32_16x16x32_bf16 v[152:155], a[132:135], a[212:215], v[152:155]
ds_read_b128 a[252:255], v165 offset:64
v_mfma_f32_16x16x32_bf16 v[156:159], a[132:135], a[216:219], v[156:159]
ds_read_b64 a[188:189], v164 offset:3648
v_mfma_f32_16x16x32_bf16 v[136:139], a[136:139], a[192:195], v[136:139]
ds_read_b64 a[190:191], v164 offset:3656
v_mfma_f32_16x16x32_bf16 v[140:143], a[136:139], a[196:199], v[140:143]
buffer_load_dwordx4 v4, s[24:27], s72 offen lds
v_mfma_f32_16x16x32_bf16 v[144:147], a[136:139], a[200:203], v[144:147]
s_add_u32 s72, s71, 15360
buffer_load_dwordx4 v4, s[24:27], s72 offen offset:1024 lds
v_mfma_f32_16x16x32_bf16 v[148:151], a[136:139], a[204:207], v[148:151]
v_mfma_f32_16x16x32_bf16 v[152:155], a[136:139], a[208:211], v[152:155]
v_mfma_f32_16x16x32_bf16 v[156:159], a[136:139], a[212:215], v[156:159]
v_mfma_f32_16x16x32_bf16 v[140:143], a[140:143], a[192:195], v[140:143]
v_mfma_f32_16x16x32_bf16 v[144:147], a[140:143], a[196:199], v[144:147]
v_mfma_f32_16x16x32_bf16 v[148:151], a[140:143], a[200:203], v[148:151]
v_mfma_f32_16x16x32_bf16 v[152:155], a[140:143], a[204:207], v[152:155]
v_mfma_f32_16x16x32_bf16 v[156:159], a[140:143], a[208:211], v[156:159]
v_mfma_f32_16x16x32_bf16 v[144:147], a[144:147], a[192:195], v[144:147]
v_mfma_f32_16x16x32_bf16 v[148:151], a[144:147], a[196:199], v[148:151]
v_mfma_f32_16x16x32_bf16 v[152:155], a[144:147], a[200:203], v[152:155]
s_add_u32 s72, s71, 30720
buffer_load_dwordx4 v4, s[24:27], s72 offen offset:2048 lds
v_mfma_f32_16x16x32_bf16 v[156:159], a[144:147], a[204:207], v[156:159]
v_mfma_f32_16x16x32_bf16 v[148:151], a[148:151], a[192:195], v[148:151]
v_mfma_f32_16x16x32_bf16 v[152:155], a[148:151], a[196:199], v[152:155]
v_mfma_f32_16x16x32_bf16 v[156:159], a[148:151], a[200:203], v[156:159]
v_mfma_f32_16x16x32_bf16 v[152:155], a[152:155], a[192:195], v[152:155]
v_mfma_f32_16x16x32_bf16 v[156:159], a[152:155], a[196:199], v[156:159]
v_mfma_f32_16x16x32_bf16 v[156:159], a[156:159], a[192:195], v[156:159]
s_waitcnt lgkmcnt(0)
v_mfma_f32_16x16x32_bf16 v[128:131], a[160:163], a[224:227], v[128:131]
ds_read_b128 a[192:195], v165 offset:3712
v_mfma_f32_16x16x32_bf16 v[132:135], a[160:163], a[228:231], v[132:135]
ds_read_b64 a[128:129], v164 offset:128
v_mfma_f32_16x16x32_bf16 v[136:139], a[160:163], a[232:235], v[136:139]
ds_read_b64 a[130:131], v164 offset:136
v_mfma_f32_16x16x32_bf16 v[140:143], a[160:163], a[236:239], v[140:143]
ds_read_b128 a[196:199], v165 offset:3200
v_mfma_f32_16x16x32_bf16 v[144:147], a[160:163], a[240:243], v[144:147]
ds_read_b64 a[132:133], v164 offset:640
v_mfma_f32_16x16x32_bf16 v[148:151], a[160:163], a[244:247], v[148:151]
ds_read_b64 a[134:135], v164 offset:648
v_mfma_f32_16x16x32_bf16 v[152:155], a[160:163], a[248:251], v[152:155]
ds_read_b128 a[200:203], v165 offset:2688
v_mfma_f32_16x16x32_bf16 v[156:159], a[160:163], a[252:255], v[156:159]
ds_read_b64 a[136:137], v164 offset:1152
v_mfma_f32_16x16x32_bf16 v[132:135], a[164:167], a[224:227], v[132:135]
ds_read_b64 a[138:139], v164 offset:1160
v_mfma_f32_16x16x32_bf16 v[136:139], a[164:167], a[228:231], v[136:139]
ds_read_b128 a[204:207], v165 offset:2176
v_mfma_f32_16x16x32_bf16 v[140:143], a[164:167], a[232:235], v[140:143]
s_add_u32 s72, s71, 46080
ds_read_b64 a[140:141], v164 offset:1664
v_mfma_f32_16x16x32_bf16 v[144:147], a[164:167], a[236:239], v[144:147]
ds_read_b64 a[142:143], v164 offset:1672
v_mfma_f32_16x16x32_bf16 v[148:151], a[164:167], a[240:243], v[148:151]
ds_read_b128 a[208:211], v165 offset:1664
v_mfma_f32_16x16x32_bf16 v[152:155], a[164:167], a[244:247], v[152:155]
ds_read_b64 a[144:145], v164 offset:2176
v_mfma_f32_16x16x32_bf16 v[156:159], a[164:167], a[248:251], v[156:159]
ds_read_b64 a[146:147], v164 offset:2184
v_mfma_f32_16x16x32_bf16 v[136:139], a[168:171], a[224:227], v[136:139]
ds_read_b128 a[212:215], v165 offset:1152
v_mfma_f32_16x16x32_bf16 v[140:143], a[168:171], a[228:231], v[140:143]
ds_read_b64 a[148:149], v164 offset:2688
v_mfma_f32_16x16x32_bf16 v[144:147], a[168:171], a[232:235], v[144:147]
ds_read_b64 a[150:151], v164 offset:2696
v_mfma_f32_16x16x32_bf16 v[148:151], a[168:171], a[236:239], v[148:151]
ds_read_b128 a[216:219], v165 offset:640
v_mfma_f32_16x16x32_bf16 v[152:155], a[168:171], a[240:243], v[152:155]
ds_read_b64 a[152:153], v164 offset:3200
v_mfma_f32_16x16x32_bf16 v[156:159], a[168:171], a[244:247], v[156:159]
ds_read_b64 a[154:155], v164 offset:3208
v_mfma_f32_16x16x32_bf16 v[140:143], a[172:175], a[224:227], v[140:143]
ds_read_b128 a[220:223], v165 offset:128
v_mfma_f32_16x16x32_bf16 v[144:147], a[172:175], a[228:231], v[144:147]
ds_read_b64 a[156:157], v164 offset:3712
v_mfma_f32_16x16x32_bf16 v[148:151], a[172:175], a[232:235], v[148:151]
ds_read_b64 a[158:159], v164 offset:3720
v_mfma_f32_16x16x32_bf16 v[152:155], a[172:175], a[236:239], v[152:155]
buffer_load_dwordx4 v4, s[24:27], s72 offen offset:3072 lds
v_mfma_f32_16x16x32_bf16 v[156:159], a[172:175], a[240:243], v[156:159]
v_mfma_f32_16x16x32_bf16 v[144:147], a[176:179], a[224:227], v[144:147]
v_mfma_f32_16x16x32_bf16 v[148:151], a[176:179], a[228:231], v[148:151]
v_mfma_f32_16x16x32_bf16 v[152:155], a[176:179], a[232:235], v[152:155]
s_add_u32 s71, s61, 2
v_mfma_f32_16x16x32_bf16 v[156:159], a[176:179], a[236:239], v[156:159]
s_and_b32 s71, s71, 7
v_mfma_f32_16x16x32_bf16 v[148:151], a[180:183], a[224:227], v[148:151]
s_lshl_b32 s71, s71, 18
v_mfma_f32_16x16x32_bf16 v[152:155], a[180:183], a[228:231], v[152:155]
s_add_u32 s71, s71, s94
v_mfma_f32_16x16x32_bf16 v[156:159], a[180:183], a[232:235], v[156:159]
s_add_u32 m0, s64, 131072
v_mfma_f32_16x16x32_bf16 v[152:155], a[184:187], a[224:227], v[152:155]
s_add_u32 s72, s71, 0
buffer_load_dwordx4 v4, s[24:27], s72 offen lds
v_mfma_f32_16x16x32_bf16 v[156:159], a[184:187], a[228:231], v[156:159]
v_mfma_f32_16x16x32_bf16 v[156:159], a[188:191], a[224:227], v[156:159]
s_waitcnt lgkmcnt(0)
v_mfma_f32_16x16x32_bf16 v[128:131], a[128:131], a[192:195], v[128:131]
ds_read_b128 a[224:227], v165 offset:3776
v_mfma_f32_16x16x32_bf16 v[132:135], a[128:131], a[196:199], v[132:135]
ds_read_b64 a[160:161], v164 offset:192
v_mfma_f32_16x16x32_bf16 v[136:139], a[128:131], a[200:203], v[136:139]
ds_read_b64 a[162:163], v164 offset:200
v_mfma_f32_16x16x32_bf16 v[140:143], a[128:131], a[204:207], v[140:143]
ds_read_b128 a[228:231], v165 offset:3264
v_mfma_f32_16x16x32_bf16 v[144:147], a[128:131], a[208:211], v[144:147]
ds_read_b64 a[164:165], v164 offset:704
v_mfma_f32_16x16x32_bf16 v[148:151], a[128:131], a[212:215], v[148:151]
ds_read_b64 a[166:167], v164 offset:712
v_mfma_f32_16x16x32_bf16 v[152:155], a[128:131], a[216:219], v[152:155]
ds_read_b128 a[232:235], v165 offset:2752
v_mfma_f32_16x16x32_bf16 v[156:159], a[128:131], a[220:223], v[156:159]
ds_read_b64 a[168:169], v164 offset:1216
v_mfma_f32_16x16x32_bf16 v[132:135], a[132:135], a[192:195], v[132:135]
ds_read_b64 a[170:171], v164 offset:1224
v_mfma_f32_16x16x32_bf16 v[136:139], a[132:135], a[196:199], v[136:139]
ds_read_b128 a[236:239], v165 offset:2240
v_mfma_f32_16x16x32_bf16 v[140:143], a[132:135], a[200:203], v[140:143]
s_add_u32 s72, s71, 15360
ds_read_b64 a[172:173], v164 offset:1728
v_mfma_f32_16x16x32_bf16 v[144:147], a[132:135], a[204:207], v[144:147]
ds_read_b64 a[174:175], v164 offset:1736
v_mfma_f32_16x16x32_bf16 v[148:151], a[132:135], a[208:211], v[148:151]
ds_read_b128 a[240:243], v165 offset:1728
v_mfma_f32_16x16x32_bf16 v[152:155], a[132:135], a[212:215], v[152:155]
ds_read_b64 a[176:177], v164 offset:2240
v_mfma_f32_16x16x32_bf16 v[156:159], a[132:135], a[216:219], v[156:159]
ds_read_b64 a[178:179], v164 offset:2248
v_mfma_f32_16x16x32_bf16 v[136:139], a[136:139], a[192:195], v[136:139]
ds_read_b128 a[244:247], v165 offset:1216
v_mfma_f32_16x16x32_bf16 v[140:143], a[136:139], a[196:199], v[140:143]
ds_read_b64 a[180:181], v164 offset:2752
v_mfma_f32_16x16x32_bf16 v[144:147], a[136:139], a[200:203], v[144:147]
ds_read_b64 a[182:183], v164 offset:2760
v_mfma_f32_16x16x32_bf16 v[148:151], a[136:139], a[204:207], v[148:151]
ds_read_b128 a[248:251], v165 offset:704
v_mfma_f32_16x16x32_bf16 v[152:155], a[136:139], a[208:211], v[152:155]
ds_read_b64 a[184:185], v164 offset:3264
v_mfma_f32_16x16x32_bf16 v[156:159], a[136:139], a[212:215], v[156:159]
ds_read_b64 a[186:187], v164 offset:3272
v_mfma_f32_16x16x32_bf16 v[140:143], a[140:143], a[192:195], v[140:143]
ds_read_b128 a[252:255], v165 offset:192
v_mfma_f32_16x16x32_bf16 v[144:147], a[140:143], a[196:199], v[144:147]
ds_read_b64 a[188:189], v164 offset:3776
v_mfma_f32_16x16x32_bf16 v[148:151], a[140:143], a[200:203], v[148:151]
ds_read_b64 a[190:191], v164 offset:3784
v_mfma_f32_16x16x32_bf16 v[152:155], a[140:143], a[204:207], v[152:155]
buffer_load_dwordx4 v4, s[24:27], s72 offen offset:1024 lds
v_mfma_f32_16x16x32_bf16 v[156:159], a[140:143], a[208:211], v[156:159]
v_mfma_f32_16x16x32_bf16 v[144:147], a[144:147], a[192:195], v[144:147]
v_mfma_f32_16x16x32_bf16 v[148:151], a[144:147], a[196:199], v[148:151]
v_mfma_f32_16x16x32_bf16 v[152:155], a[144:147], a[200:203], v[152:155]
s_add_u32 s72, s71, 30720
buffer_load_dwordx4 v4, s[24:27], s72 offen offset:2048 lds
v_mfma_f32_16x16x32_bf16 v[156:159], a[144:147], a[204:207], v[156:159]
v_mfma_f32_16x16x32_bf16 v[148:151], a[148:151], a[192:195], v[148:151]
v_mfma_f32_16x16x32_bf16 v[152:155], a[148:151], a[196:199], v[152:155]
v_mfma_f32_16x16x32_bf16 v[156:159], a[148:151], a[200:203], v[156:159]
v_mfma_f32_16x16x32_bf16 v[152:155], a[152:155], a[192:195], v[152:155]
s_waitcnt vmcnt(7)
v_mfma_f32_16x16x32_bf16 v[156:159], a[152:155], a[196:199], v[156:159]
s_barrier
v_mfma_f32_16x16x32_bf16 v[156:159], a[156:159], a[192:195], v[156:159]
s_waitcnt lgkmcnt(0)
v_mfma_f32_16x16x32_bf16 v[128:131], a[160:163], a[224:227], v[128:131]
ds_read_b128 a[192:195], v165 offset:3840
v_mov_b32 v244, 90112
v_mfma_f32_16x16x32_bf16 v[132:135], a[160:163], a[228:231], v[132:135]
ds_read_b64 a[128:129], v164 offset:256
ds_read_b128 v[240:243], v244
v_mfma_f32_16x16x32_bf16 v[136:139], a[160:163], a[232:235], v[136:139]
ds_read_b64 a[130:131], v164 offset:264
v_mfma_f32_16x16x32_bf16 v[140:143], a[160:163], a[236:239], v[140:143]
ds_read_b128 a[196:199], v165 offset:3328
v_mfma_f32_16x16x32_bf16 v[144:147], a[160:163], a[240:243], v[144:147]
ds_read_b64 a[132:133], v164 offset:768
v_mfma_f32_16x16x32_bf16 v[148:151], a[160:163], a[244:247], v[148:151]
ds_read_b64 a[134:135], v164 offset:776
v_mfma_f32_16x16x32_bf16 v[152:155], a[160:163], a[248:251], v[152:155]
ds_read_b128 a[200:203], v165 offset:2816
v_mfma_f32_16x16x32_bf16 v[156:159], a[160:163], a[252:255], v[156:159]
ds_read_b64 a[136:137], v164 offset:1280
v_mfma_f32_16x16x32_bf16 v[132:135], a[164:167], a[224:227], v[132:135]
ds_read_b64 a[138:139], v164 offset:1288
v_mfma_f32_16x16x32_bf16 v[136:139], a[164:167], a[228:231], v[136:139]
s_waitcnt lgkmcnt(7)
ds_read_b128 a[204:207], v165 offset:2304
v_or3_b32 v240, v240, v241, v242
v_mfma_f32_16x16x32_bf16 v[140:143], a[164:167], a[232:235], v[140:143]
s_add_u32 s72, s71, 46080
ds_read_b64 a[140:141], v164 offset:1792
v_or_b32 v240, v240, v243
v_mfma_f32_16x16x32_bf16 v[144:147], a[164:167], a[236:239], v[144:147]
ds_read_b64 a[142:143], v164 offset:1800
v_cmp_lt_u32 vcc, s86, v240
s_cbranch_vccnz Lslow
v_mfma_f32_16x16x32_bf16 v[148:151], a[164:167], a[240:243], v[148:151]
ds_read_b128 a[208:211], v165 offset:1792
v_or_b32 v240, s58, v0
v_mfma_f32_16x16x32_bf16 v[152:155], a[164:167], a[244:247], v[152:155]
ds_read_b64 a[144:145], v164 offset:2304
v_mov_b32 v241, 2
v_mfma_f32_16x16x32_bf16 v[156:159], a[164:167], a[248:251], v[156:159]
ds_read_b64 a[146:147], v164 offset:2312
v_min_u32 v240, 1, v240
v_mfma_f32_16x16x32_bf16 v[136:139], a[168:171], a[224:227], v[136:139]
ds_read_b128 a[212:215], v165 offset:1280
v_lshlrev_b32 v240, 30, v240
v_mfma_f32_16x16x32_bf16 v[140:143], a[168:171], a[228:231], v[140:143]
ds_read_b64 a[148:149], v164 offset:2816
v_mfma_f32_16x16x32_bf16 v[144:147], a[168:171], a[232:235], v[144:147]
ds_read_b64 a[150:151], v164 offset:2824
v_mfma_f32_16x16x32_bf16 v[148:151], a[168:171], a[236:239], v[148:151]
ds_read_b128 a[216:219], v165 offset:768
v_mfma_f32_16x16x32_bf16 v[152:155], a[168:171], a[240:243], v[152:155]
ds_read_b64 a[152:153], v164 offset:3328
v_mfma_f32_16x16x32_bf16 v[156:159], a[168:171], a[244:247], v[156:159]
ds_read_b64 a[154:155], v164 offset:3336
v_mfma_f32_16x16x32_bf16 v[140:143], a[172:175], a[224:227], v[140:143]
ds_read_b128 a[220:223], v165 offset:256
v_mfma_f32_16x16x32_bf16 v[144:147], a[172:175], a[228:231], v[144:147]
ds_read_b64 a[156:157], v164 offset:3840
v_mfma_f32_16x16x32_bf16 v[148:151], a[172:175], a[232:235], v[148:151]
ds_read_b64 a[158:159], v164 offset:3848
v_mfma_f32_16x16x32_bf16 v[152:155], a[172:175], a[236:239], v[152:155]
buffer_store_dword v241, v240, s[44:47], s91 offen sc1
v_mfma_f32_16x16x32_bf16 v[156:159], a[172:175], a[240:243], v[156:159]
v_and_b32 v112, 15, v0
v_lshrrev_b32 v113, 2, v0
v_mfma_f32_16x16x32_bf16 v[144:147], a[176:179], a[224:227], v[144:147]
v_bfe_u32 v114, v0, 3, 2
v_and_b32 v115, 3, v0
v_mfma_f32_16x16x32_bf16 v[148:151], a[176:179], a[228:231], v[148:151]
v_lshlrev_b32 v8, 7, v113
v_lshl_add_u32 v8, v114, 5, v8
v_mfma_f32_16x16x32_bf16 v[152:155], a[176:179], a[232:235], v[152:155]
v_lshl_add_u32 v8, v115, 3, v8
v_add_u32 v8, 98304, v8
v_mfma_f32_16x16x32_bf16 v[156:159], a[176:179], a[236:239], v[156:159]
v_xor_b32 v9, 32, v8
v_xor_b32 v10, 64, v8
v_mfma_f32_16x16x32_bf16 v[148:151], a[180:183], a[224:227], v[148:151]
v_xor_b32 v11, 0x60, v8
v_lshlrev_b32 v5, 8, v113
v_mfma_f32_16x16x32_bf16 v[152:155], a[180:183], a[228:231], v[152:155]
v_lshl_add_u32 v5, v115, 6, v5
v_mfma_f32_16x16x32_bf16 v[156:159], a[180:183], a[232:235], v[156:159]
s_lshl_b32 s73, s58, 4
buffer_load_dwordx4 v4, s[24:27], s72 offen offset:3072 lds
v_mfma_f32_16x16x32_bf16 v[152:155], a[184:187], a[224:227], v[152:155]
s_add_u32 s73, s73, 0x4000
v_add_u32 v5, s73, v5
v_bfe_u32 v114, v0, 1, 2
v_mfma_f32_16x16x32_bf16 v[156:159], a[184:187], a[228:231], v[156:159]
s_add_u32 s71, s61, 3
v_lshrrev_b32 v115, 4, v0
v_lshlrev_b32 v12, 7, v112
v_mfma_f32_16x16x32_bf16 v[156:159], a[188:191], a[224:227], v[156:159]
s_waitcnt lgkmcnt(0)
v_lshl_add_u32 v12, v114, 5, v12
v_lshl_add_u32 v12, v115, 3, v12
v_mfma_f32_16x16x32_bf16 v[128:131], a[128:131], a[192:195], v[128:131]
s_and_b32 s71, s71, 7
ds_read_b128 a[224:227], v165 offset:3904
v_add_u32 v12, s64, v12
v_mfma_f32_16x16x32_bf16 v[132:135], a[128:131], a[196:199], v[132:135]
s_lshl_b32 s71, s71, 18
ds_read_b64 a[160:161], v164 offset:320
v_xor_b32 v13, 32, v12
v_mfma_f32_16x16x32_bf16 v[136:139], a[128:131], a[200:203], v[136:139]
s_add_u32 s71, s71, s94
ds_read_b64 a[162:163], v164 offset:328
v_xor_b32 v14, 64, v12
v_mfma_f32_16x16x32_bf16 v[140:143], a[128:131], a[204:207], v[140:143]
s_add_u32 m0, s64, 147456
ds_read_b128 a[228:231], v165 offset:3392
v_xor_b32 v15, 0x60, v12
v_mfma_f32_16x16x32_bf16 v[144:147], a[128:131], a[208:211], v[144:147]
s_add_u32 s72, s71, 0
ds_read_b64 a[164:165], v164 offset:832
v_mfma_f32_16x16x32_bf16 v[148:151], a[128:131], a[212:215], v[148:151]
ds_read_b64 a[166:167], v164 offset:840
v_mfma_f32_16x16x32_bf16 v[152:155], a[128:131], a[216:219], v[152:155]
ds_read_b128 a[232:235], v165 offset:2880
v_mfma_f32_16x16x32_bf16 v[156:159], a[128:131], a[220:223], v[156:159]
ds_read_b64 a[168:169], v164 offset:1344
v_mfma_f32_16x16x32_bf16 v[132:135], a[132:135], a[192:195], v[132:135]
ds_read_b64 a[170:171], v164 offset:1352
v_mfma_f32_16x16x32_bf16 v[136:139], a[132:135], a[196:199], v[136:139]
ds_read_b128 a[236:239], v165 offset:2368
v_mfma_f32_16x16x32_bf16 v[140:143], a[132:135], a[200:203], v[140:143]
ds_read_b64 a[172:173], v164 offset:1856
v_mfma_f32_16x16x32_bf16 v[144:147], a[132:135], a[204:207], v[144:147]
ds_read_b64 a[174:175], v164 offset:1864
v_mfma_f32_16x16x32_bf16 v[148:151], a[132:135], a[208:211], v[148:151]
ds_read_b128 a[240:243], v165 offset:1856
v_mfma_f32_16x16x32_bf16 v[152:155], a[132:135], a[212:215], v[152:155]
ds_read_b64 a[176:177], v164 offset:2368
v_mfma_f32_16x16x32_bf16 v[156:159], a[132:135], a[216:219], v[156:159]
ds_read_b64 a[178:179], v164 offset:2376
v_mfma_f32_16x16x32_bf16 v[136:139], a[136:139], a[192:195], v[136:139]
ds_read_b128 a[244:247], v165 offset:1344
v_mfma_f32_16x16x32_bf16 v[140:143], a[136:139], a[196:199], v[140:143]
ds_read_b64 a[180:181], v164 offset:2880
v_mfma_f32_16x16x32_bf16 v[144:147], a[136:139], a[200:203], v[144:147]
ds_read_b64 a[182:183], v164 offset:2888
v_mfma_f32_16x16x32_bf16 v[148:151], a[136:139], a[204:207], v[148:151]
ds_read_b128 a[248:251], v165 offset:832
v_mfma_f32_16x16x32_bf16 v[152:155], a[136:139], a[208:211], v[152:155]
ds_read_b64 a[184:185], v164 offset:3392
v_mfma_f32_16x16x32_bf16 v[156:159], a[136:139], a[212:215], v[156:159]
ds_read_b64 a[186:187], v164 offset:3400
v_mfma_f32_16x16x32_bf16 v[140:143], a[140:143], a[192:195], v[140:143]
ds_read_b128 a[252:255], v165 offset:320
v_mfma_f32_16x16x32_bf16 v[144:147], a[140:143], a[196:199], v[144:147]
ds_read_b64 a[188:189], v164 offset:3904
v_mfma_f32_16x16x32_bf16 v[148:151], a[140:143], a[200:203], v[148:151]
ds_read_b64 a[190:191], v164 offset:3912
v_mfma_f32_16x16x32_bf16 v[152:155], a[140:143], a[204:207], v[152:155]
buffer_load_dwordx4 v4, s[24:27], s72 offen lds
v_mfma_f32_16x16x32_bf16 v[156:159], a[140:143], a[208:211], v[156:159]
s_add_u32 s72, s71, 15360
buffer_load_dwordx4 v4, s[24:27], s72 offen offset:1024 lds
v_mfma_f32_16x16x32_bf16 v[144:147], a[144:147], a[192:195], v[144:147]
v_mfma_f32_16x16x32_bf16 v[148:151], a[144:147], a[196:199], v[148:151]
v_mfma_f32_16x16x32_bf16 v[152:155], a[144:147], a[200:203], v[152:155]
s_add_u32 s72, s71, 30720
buffer_load_dwordx4 v4, s[24:27], s72 offen offset:2048 lds
v_mfma_f32_16x16x32_bf16 v[156:159], a[144:147], a[204:207], v[156:159]
v_mfma_f32_16x16x32_bf16 v[148:151], a[148:151], a[192:195], v[148:151]
v_mfma_f32_16x16x32_bf16 v[152:155], a[148:151], a[196:199], v[152:155]
v_mfma_f32_16x16x32_bf16 v[156:159], a[148:151], a[200:203], v[156:159]
v_mfma_f32_16x16x32_bf16 v[152:155], a[152:155], a[192:195], v[152:155]
v_mfma_f32_16x16x32_bf16 v[156:159], a[152:155], a[196:199], v[156:159]
v_mfma_f32_16x16x32_bf16 v[156:159], a[156:159], a[192:195], v[156:159]
s_waitcnt lgkmcnt(0)
v_mfma_f32_16x16x32_bf16 v[128:131], a[160:163], a[224:227], v[128:131]
ds_read_b128 a[192:195], v165 offset:3968
v_mfma_f32_16x16x32_bf16 v[132:135], a[160:163], a[228:231], v[132:135]
ds_read_b64 a[128:129], v164 offset:384
v_mfma_f32_16x16x32_bf16 v[136:139], a[160:163], a[232:235], v[136:139]
ds_read_b64 a[130:131], v164 offset:392
v_mfma_f32_16x16x32_bf16 v[140:143], a[160:163], a[236:239], v[140:143]
ds_read_b128 a[196:199], v165 offset:3456
v_mfma_f32_16x16x32_bf16 v[144:147], a[160:163], a[240:243], v[144:147]
ds_read_b64 a[132:133], v164 offset:896
v_mfma_f32_16x16x32_bf16 v[148:151], a[160:163], a[244:247], v[148:151]
ds_read_b64 a[134:135], v164 offset:904
v_mfma_f32_16x16x32_bf16 v[152:155], a[160:163], a[248:251], v[152:155]
ds_read_b128 a[200:203], v165 offset:2944
v_mfma_f32_16x16x32_bf16 v[156:159], a[160:163], a[252:255], v[156:159]
ds_read_b64 a[136:137], v164 offset:1408
v_mfma_f32_16x16x32_bf16 v[132:135], a[164:167], a[224:227], v[132:135]
ds_read_b64 a[138:139], v164 offset:1416
v_mfma_f32_16x16x32_bf16 v[136:139], a[164:167], a[228:231], v[136:139]
ds_read_b128 a[204:207], v165 offset:2432
v_mfma_f32_16x16x32_bf16 v[140:143], a[164:167], a[232:235], v[140:143]
s_add_u32 s72, s71, 46080
ds_read_b64 a[140:141], v164 offset:1920
v_mfma_f32_16x16x32_bf16 v[144:147], a[164:167], a[236:239], v[144:147]
ds_read_b64 a[142:143], v164 offset:1928
v_mfma_f32_16x16x32_bf16 v[148:151], a[164:167], a[240:243], v[148:151]
ds_read_b128 a[208:211], v165 offset:1920
v_mfma_f32_16x16x32_bf16 v[152:155], a[164:167], a[244:247], v[152:155]
ds_read_b64 a[144:145], v164 offset:2432
v_mfma_f32_16x16x32_bf16 v[156:159], a[164:167], a[248:251], v[156:159]
ds_read_b64 a[146:147], v164 offset:2440
v_mfma_f32_16x16x32_bf16 v[136:139], a[168:171], a[224:227], v[136:139]
ds_read_b128 a[212:215], v165 offset:1408
v_mfma_f32_16x16x32_bf16 v[140:143], a[168:171], a[228:231], v[140:143]
ds_read_b64 a[148:149], v164 offset:2944
v_mfma_f32_16x16x32_bf16 v[144:147], a[168:171], a[232:235], v[144:147]
ds_read_b64 a[150:151], v164 offset:2952
v_mfma_f32_16x16x32_bf16 v[148:151], a[168:171], a[236:239], v[148:151]
ds_read_b128 a[216:219], v165 offset:896
v_mfma_f32_16x16x32_bf16 v[152:155], a[168:171], a[240:243], v[152:155]
ds_read_b64 a[152:153], v164 offset:3456
v_mfma_f32_16x16x32_bf16 v[156:159], a[168:171], a[244:247], v[156:159]
ds_read_b64 a[154:155], v164 offset:3464
v_mfma_f32_16x16x32_bf16 v[140:143], a[172:175], a[224:227], v[140:143]
ds_read_b128 a[220:223], v165 offset:384
v_mfma_f32_16x16x32_bf16 v[144:147], a[172:175], a[228:231], v[144:147]
ds_read_b64 a[156:157], v164 offset:3968
v_mfma_f32_16x16x32_bf16 v[148:151], a[172:175], a[232:235], v[148:151]
ds_read_b64 a[158:159], v164 offset:3976
v_mfma_f32_16x16x32_bf16 v[152:155], a[172:175], a[236:239], v[152:155]
buffer_load_dwordx4 v4, s[24:27], s72 offen offset:3072 lds
v_mfma_f32_16x16x32_bf16 v[156:159], a[172:175], a[240:243], v[156:159]
v_mfma_f32_16x16x32_bf16 v[144:147], a[176:179], a[224:227], v[144:147]
v_mfma_f32_16x16x32_bf16 v[148:151], a[176:179], a[228:231], v[148:151]
v_mfma_f32_16x16x32_bf16 v[152:155], a[176:179], a[232:235], v[152:155]
v_mfma_f32_16x16x32_bf16 v[156:159], a[176:179], a[236:239], v[156:159]
v_mfma_f32_16x16x32_bf16 v[148:151], a[180:183], a[224:227], v[148:151]
v_mfma_f32_16x16x32_bf16 v[152:155], a[180:183], a[228:231], v[152:155]
v_mfma_f32_16x16x32_bf16 v[156:159], a[180:183], a[232:235], v[156:159]
v_mfma_f32_16x16x32_bf16 v[152:155], a[184:187], a[224:227], v[152:155]
v_mfma_f32_16x16x32_bf16 v[156:159], a[184:187], a[228:231], v[156:159]
v_mfma_f32_16x16x32_bf16 v[156:159], a[188:191], a[224:227], v[156:159]
s_waitcnt lgkmcnt(0)
v_mfma_f32_16x16x32_bf16 v[128:131], a[128:131], a[192:195], v[128:131]
s_add_u32 s80, s93, 0x3400000
ds_read_b128 a[224:227], v165 offset:4032
v_mfma_f32_16x16x32_bf16 v[132:135], a[128:131], a[196:199], v[132:135]
s_sub_u32 s74, 15, s75
ds_read_b64 a[160:161], v164 offset:448
v_mfma_f32_16x16x32_bf16 v[136:139], a[128:131], a[200:203], v[136:139]
s_min_u32 s74, s74, s75
ds_read_b64 a[162:163], v164 offset:456
v_mfma_f32_16x16x32_bf16 v[140:143], a[128:131], a[204:207], v[140:143]
s_lshl_b32 s74, s74, 7
ds_read_b128 a[228:231], v165 offset:3520
v_mfma_f32_16x16x32_bf16 v[144:147], a[128:131], a[208:211], v[144:147]
s_add_u32 s74, s74, 0x3810000
ds_read_b64 a[164:165], v164 offset:960
v_and_b32 v2, 31, v0
v_mfma_f32_16x16x32_bf16 v[148:151], a[128:131], a[212:215], v[148:151]
ds_read_b64 a[166:167], v164 offset:968
v_lshlrev_b32 v2, 10, v2
v_mfma_f32_16x16x32_bf16 v[152:155], a[128:131], a[216:219], v[152:155]
ds_read_b128 a[232:235], v165 offset:3008
v_mfma_f32_16x16x32_bf16 v[156:159], a[128:131], a[220:223], v[156:159]
ds_read_b64 a[168:169], v164 offset:1472
v_mfma_f32_16x16x32_bf16 v[132:135], a[132:135], a[192:195], v[132:135]
ds_read_b64 a[170:171], v164 offset:1480
v_mfma_f32_16x16x32_bf16 v[136:139], a[132:135], a[196:199], v[136:139]
ds_read_b128 a[236:239], v165 offset:2496
v_mfma_f32_16x16x32_bf16 v[140:143], a[132:135], a[200:203], v[140:143]
ds_read_b64 a[172:173], v164 offset:1984
v_mfma_f32_16x16x32_bf16 v[144:147], a[132:135], a[204:207], v[144:147]
ds_read_b64 a[174:175], v164 offset:1992
v_mfma_f32_16x16x32_bf16 v[148:151], a[132:135], a[208:211], v[148:151]
ds_read_b128 a[240:243], v165 offset:1984
v_mfma_f32_16x16x32_bf16 v[152:155], a[132:135], a[212:215], v[152:155]
ds_read_b64 a[176:177], v164 offset:2496
v_mfma_f32_16x16x32_bf16 v[156:159], a[132:135], a[216:219], v[156:159]
ds_read_b64 a[178:179], v164 offset:2504
v_mfma_f32_16x16x32_bf16 v[136:139], a[136:139], a[192:195], v[136:139]
ds_read_b128 a[244:247], v165 offset:1472
v_mfma_f32_16x16x32_bf16 v[140:143], a[136:139], a[196:199], v[140:143]
ds_read_b64 a[180:181], v164 offset:3008
v_mfma_f32_16x16x32_bf16 v[144:147], a[136:139], a[200:203], v[144:147]
ds_read_b64 a[182:183], v164 offset:3016
v_mfma_f32_16x16x32_bf16 v[148:151], a[136:139], a[204:207], v[148:151]
ds_read_b128 a[248:251], v165 offset:960
v_mfma_f32_16x16x32_bf16 v[152:155], a[136:139], a[208:211], v[152:155]
ds_read_b64 a[184:185], v164 offset:3520
v_mfma_f32_16x16x32_bf16 v[156:159], a[136:139], a[212:215], v[156:159]
ds_read_b64 a[186:187], v164 offset:3528
v_mfma_f32_16x16x32_bf16 v[140:143], a[140:143], a[192:195], v[140:143]
ds_read_b128 a[252:255], v165 offset:448
v_mfma_f32_16x16x32_bf16 v[144:147], a[140:143], a[196:199], v[144:147]
ds_read_b64 a[188:189], v164 offset:4032
v_mfma_f32_16x16x32_bf16 v[148:151], a[140:143], a[200:203], v[148:151]
ds_read_b64 a[190:191], v164 offset:4040
v_mfma_f32_16x16x32_bf16 v[152:155], a[140:143], a[204:207], v[152:155]
buffer_load_dword v3, v2, s[44:47], s74 offen sc1
v_mfma_f32_16x16x32_bf16 v[156:159], a[140:143], a[208:211], v[156:159]
v_mfma_f32_16x16x32_bf16 v[144:147], a[144:147], a[192:195], v[144:147]
v_mfma_f32_16x16x32_bf16 v[148:151], a[144:147], a[196:199], v[148:151]
v_mfma_f32_16x16x32_bf16 v[152:155], a[144:147], a[200:203], v[152:155]
v_mfma_f32_16x16x32_bf16 v[156:159], a[144:147], a[204:207], v[156:159]
v_mfma_f32_16x16x32_bf16 v[148:151], a[148:151], a[192:195], v[148:151]
v_mfma_f32_16x16x32_bf16 v[152:155], a[148:151], a[196:199], v[152:155]
v_mfma_f32_16x16x32_bf16 v[156:159], a[148:151], a[200:203], v[156:159]
v_mfma_f32_16x16x32_bf16 v[152:155], a[152:155], a[192:195], v[152:155]
v_mfma_f32_16x16x32_bf16 v[156:159], a[152:155], a[196:199], v[156:159]
v_mfma_f32_16x16x32_bf16 v[156:159], a[156:159], a[192:195], v[156:159]
s_waitcnt lgkmcnt(0)
s_waitcnt vmcnt(0)
v_cmp_gt_u32 vcc, 2, v3
s_cbranch_vccnz Lspin60
Lback61:
v_mfma_f32_16x16x32_bf16 v[128:131], a[160:163], a[224:227], v[128:131]
s_add_u32 s69, s61, 0
ds_read_b64_tr_b16 v[192:193], v8 offset:0
v_mfma_f32_16x16x32_bf16 v[132:135], a[160:163], a[228:231], v[132:135]
s_and_b32 s69, s69, 7
ds_read_b64_tr_b16 v[194:195], v8 offset:2048
v_mfma_f32_16x16x32_bf16 v[136:139], a[160:163], a[232:235], v[136:139]
s_lshl_b32 s69, s69, 12
ds_read_b64_tr_b16 v[196:197], v9 offset:0
v_mfma_f32_16x16x32_bf16 v[140:143], a[160:163], a[236:239], v[140:143]
s_add_u32 s69, s69, s95
ds_read_b64_tr_b16 v[198:199], v9 offset:2048
buffer_load_dwordx4 a[0:3], v1, s[44:47], s69 offen sc1
v_mfma_f32_16x16x32_bf16 v[144:147], a[160:163], a[240:243], v[144:147]
ds_read_b64_tr_b16 v[200:201], v10 offset:0
buffer_load_dwordx4 a[4:7], v1, s[44:47], s69 offen offset:1024 sc1
v_mfma_f32_16x16x32_bf16 v[148:151], a[160:163], a[244:247], v[148:151]
ds_read_b64_tr_b16 v[202:203], v10 offset:2048
v_cvt_pk_bf16_f32 v128, v128, v129
v_cvt_pk_bf16_f32 v129, v130, v131
v_mfma_f32_16x16x32_bf16 v[152:155], a[160:163], a[248:251], v[152:155]
ds_read_b64_tr_b16 v[204:205], v11 offset:0
buffer_store_dwordx2 v[128:129], v166, s[44:47], s80 offen sc1
v_mfma_f32_16x16x32_bf16 v[156:159], a[160:163], a[252:255], v[156:159]
ds_read_b64_tr_b16 v[206:207], v11 offset:2048
buffer_load_dwordx4 a[8:11], v1, s[44:47], s69 offen offset:2048 sc1
v_mfma_f32_16x16x32_bf16 v[132:135], a[164:167], a[224:227], v[132:135]
ds_read_b64_tr_b16 v[208:209], v8 offset:4096
buffer_load_dwordx4 a[12:15], v1, s[44:47], s69 offen offset:3072 sc1
v_mfma_f32_16x16x32_bf16 v[136:139], a[164:167], a[228:231], v[136:139]
s_add_u32 s69, s69, 0x20000
ds_read_b64_tr_b16 v[210:211], v8 offset:6144
buffer_load_dwordx4 a[16:19], v1, s[44:47], s69 offen sc1
v_mfma_f32_16x16x32_bf16 v[140:143], a[164:167], a[232:235], v[140:143]
ds_read_b64_tr_b16 v[212:213], v9 offset:4096
buffer_load_dwordx4 a[20:23], v1, s[44:47], s69 offen offset:1024 sc1
v_mfma_f32_16x16x32_bf16 v[144:147], a[164:167], a[236:239], v[144:147]
ds_read_b64_tr_b16 v[214:215], v9 offset:6144
buffer_load_dwordx4 a[24:27], v1, s[44:47], s69 offen offset:2048 sc1
v_mfma_f32_16x16x32_bf16 v[148:151], a[164:167], a[240:243], v[148:151]
ds_read_b64_tr_b16 v[216:217], v10 offset:4096
buffer_load_dwordx4 a[28:31], v1, s[44:47], s69 offen offset:3072 sc1
v_mfma_f32_16x16x32_bf16 v[152:155], a[164:167], a[244:247], v[152:155]
s_add_u32 s69, s61, 1
ds_read_b64_tr_b16 v[218:219], v10 offset:6144
v_cvt_pk_bf16_f32 v132, v132, v133
v_cvt_pk_bf16_f32 v133, v134, v135
v_mfma_f32_16x16x32_bf16 v[156:159], a[164:167], a[248:251], v[156:159]
s_and_b32 s69, s69, 7
ds_read_b64_tr_b16 v[220:221], v11 offset:4096
buffer_store_dwordx2 v[132:133], v166, s[44:47], s80 offen offset:512 sc1
v_mfma_f32_16x16x32_bf16 v[136:139], a[168:171], a[224:227], v[136:139]
s_lshl_b32 s69, s69, 12
ds_read_b64_tr_b16 v[222:223], v11 offset:6144
v_mfma_f32_16x16x32_bf16 v[140:143], a[168:171], a[228:231], v[140:143]
s_add_u32 s69, s69, s95
ds_read_b64_tr_b16 v[224:225], v8 offset:8192
buffer_load_dwordx4 a[32:35], v1, s[44:47], s69 offen sc1
v_mfma_f32_16x16x32_bf16 v[144:147], a[168:171], a[232:235], v[144:147]
ds_read_b64_tr_b16 v[226:227], v8 offset:10240
buffer_load_dwordx4 a[36:39], v1, s[44:47], s69 offen offset:1024 sc1
v_mfma_f32_16x16x32_bf16 v[148:151], a[168:171], a[236:239], v[148:151]
ds_read_b64_tr_b16 v[228:229], v9 offset:8192
buffer_load_dwordx4 a[40:43], v1, s[44:47], s69 offen offset:2048 sc1
v_mfma_f32_16x16x32_bf16 v[152:155], a[168:171], a[240:243], v[152:155]
ds_read_b64_tr_b16 v[230:231], v9 offset:10240
buffer_load_dwordx4 a[44:47], v1, s[44:47], s69 offen offset:3072 sc1
v_mfma_f32_16x16x32_bf16 v[156:159], a[168:171], a[244:247], v[156:159]
s_add_u32 s69, s69, 0x20000
ds_read_b64_tr_b16 v[232:233], v10 offset:8192
v_cvt_pk_bf16_f32 v136, v136, v137
v_cvt_pk_bf16_f32 v137, v138, v139
v_mfma_f32_16x16x32_bf16 v[140:143], a[172:175], a[224:227], v[140:143]
ds_read_b64_tr_b16 v[234:235], v10 offset:10240
buffer_store_dwordx2 v[136:137], v166, s[44:47], s80 offen offset:1024 sc1
v_mfma_f32_16x16x32_bf16 v[144:147], a[172:175], a[228:231], v[144:147]
ds_read_b64_tr_b16 v[236:237], v11 offset:8192
buffer_load_dwordx4 a[48:51], v1, s[44:47], s69 offen sc1
v_mfma_f32_16x16x32_bf16 v[148:151], a[172:175], a[232:235], v[148:151]
ds_read_b64_tr_b16 v[238:239], v11 offset:10240
buffer_load_dwordx4 a[52:55], v1, s[44:47], s69 offen offset:1024 sc1
v_mfma_f32_16x16x32_bf16 v[152:155], a[172:175], a[236:239], v[152:155]
ds_read_b64_tr_b16 v[240:241], v8 offset:12288
buffer_load_dwordx4 a[56:59], v1, s[44:47], s69 offen offset:2048 sc1
v_mfma_f32_16x16x32_bf16 v[156:159], a[172:175], a[240:243], v[156:159]
ds_read_b64_tr_b16 v[242:243], v8 offset:14336
buffer_load_dwordx4 a[60:63], v1, s[44:47], s69 offen offset:3072 sc1
v_mfma_f32_16x16x32_bf16 v[144:147], a[176:179], a[224:227], v[144:147]
s_add_u32 s69, s61, 2
ds_read_b64_tr_b16 v[244:245], v9 offset:12288
v_cvt_pk_bf16_f32 v140, v140, v141
v_cvt_pk_bf16_f32 v141, v142, v143
v_mfma_f32_16x16x32_bf16 v[148:151], a[176:179], a[228:231], v[148:151]
s_and_b32 s69, s69, 7
ds_read_b64_tr_b16 v[246:247], v9 offset:14336
buffer_store_dwordx2 v[140:141], v166, s[44:47], s80 offen offset:1536 sc1
v_mfma_f32_16x16x32_bf16 v[152:155], a[176:179], a[232:235], v[152:155]
s_lshl_b32 s69, s69, 12
ds_read_b64_tr_b16 v[248:249], v10 offset:12288
v_mfma_f32_16x16x32_bf16 v[156:159], a[176:179], a[236:239], v[156:159]
s_add_u32 s69, s69, s95
ds_read_b64_tr_b16 v[250:251], v10 offset:14336
buffer_load_dwordx4 a[64:67], v1, s[44:47], s69 offen sc1
v_mfma_f32_16x16x32_bf16 v[148:151], a[180:183], a[224:227], v[148:151]
ds_read_b64_tr_b16 v[252:253], v11 offset:12288
buffer_load_dwordx4 a[68:71], v1, s[44:47], s69 offen offset:1024 sc1
v_mfma_f32_16x16x32_bf16 v[152:155], a[180:183], a[228:231], v[152:155]
ds_read_b64_tr_b16 v[254:255], v11 offset:14336
v_cvt_pk_bf16_f32 v144, v144, v145
v_cvt_pk_bf16_f32 v145, v146, v147
v_mfma_f32_16x16x32_bf16 v[156:159], a[180:183], a[232:235], v[156:159]
buffer_store_dwordx2 v[144:145], v166, s[44:47], s80 offen offset:2048 sc1
buffer_load_dwordx4 a[72:75], v1, s[44:47], s69 offen offset:2048 sc1
v_mfma_f32_16x16x32_bf16 v[152:155], a[184:187], a[224:227], v[152:155]
buffer_load_dwordx4 a[76:79], v1, s[44:47], s69 offen offset:3072 sc1
v_mfma_f32_16x16x32_bf16 v[156:159], a[184:187], a[228:231], v[156:159]
s_add_u32 s69, s69, 0x20000
buffer_load_dwordx4 a[80:83], v1, s[44:47], s69 offen sc1
buffer_load_dwordx4 a[84:87], v1, s[44:47], s69 offen offset:1024 sc1
v_mfma_f32_16x16x32_bf16 v[156:159], a[188:191], a[224:227], v[156:159]
buffer_load_dwordx4 a[88:91], v1, s[44:47], s69 offen offset:2048 sc1
buffer_load_dwordx4 a[92:95], v1, s[44:47], s69 offen offset:3072 sc1
v_cvt_pk_bf16_f32 v148, v148, v149
v_cvt_pk_bf16_f32 v149, v150, v151
buffer_store_dwordx2 v[148:149], v166, s[44:47], s80 offen offset:2560 sc1
v_cvt_pk_bf16_f32 v152, v152, v153
v_cvt_pk_bf16_f32 v153, v154, v155
buffer_store_dwordx2 v[152:153], v166, s[44:47], s80 offen offset:3072 sc1
v_cvt_pk_bf16_f32 v156, v156, v157
v_cvt_pk_bf16_f32 v157, v158, v159
buffer_store_dwordx2 v[156:157], v166, s[44:47], s80 offen offset:3584 sc1
s_waitcnt vmcnt(23) lgkmcnt(0)
s_barrier
v_mfma_f32_16x16x32_bf16 v[80:83], v[192:195], a[0:3], 0
ds_read_b64_tr_b16 v[128:129], v8 offset:16384
ds_read_b64_tr_b16 v[130:131], v8 offset:18432
s_add_u32 s71, s61, 4
s_and_b32 s71, s71, 7
s_lshl_b32 s71, s71, 18
s_add_u32 s71, s71, s94
s_add_u32 m0, s64, 98304
s_add_u32 s72, s71, 0
buffer_load_dwordx4 v4, s[24:27], s72 offen lds
v_mfma_f32_16x16x32_bf16 v[96:99], v[192:195], a[16:19], 0
ds_read_b64_tr_b16 v[132:133], v9 offset:16384
v_mfma_f32_16x16x32_bf16 v[100:103], v[196:199], a[16:19], 0
ds_read_b64_tr_b16 v[134:135], v9 offset:18432
s_add_u32 s72, s71, 15360
buffer_load_dwordx4 v4, s[24:27], s72 offen offset:1024 lds
v_mfma_f32_16x16x32_bf16 v[84:87], v[196:199], a[0:3], 0
ds_read_b64_tr_b16 v[136:137], v10 offset:16384
v_mfma_f32_16x16x32_bf16 v[88:91], v[200:203], a[0:3], 0
ds_read_b64_tr_b16 v[138:139], v10 offset:18432
ds_read_b64_tr_b16 v[140:141], v11 offset:16384
s_add_u32 s72, s71, 30720
buffer_load_dwordx4 v4, s[24:27], s72 offen offset:2048 lds
v_mfma_f32_16x16x32_bf16 v[104:107], v[200:203], a[16:19], 0
ds_read_b64_tr_b16 v[142:143], v11 offset:18432
v_mfma_f32_16x16x32_bf16 v[108:111], v[204:207], a[16:19], 0
ds_read_b64_tr_b16 v[144:145], v8 offset:20480
v_mfma_f32_16x16x32_bf16 v[92:95], v[204:207], a[0:3], 0
ds_read_b64_tr_b16 v[146:147], v8 offset:22528
s_add_u32 s72, s71, 46080
buffer_load_dwordx4 v4, s[24:27], s72 offen offset:3072 lds
v_mfma_f32_16x16x32_bf16 v[80:83], v[208:211], a[4:7], v[80:83]
ds_read_b64_tr_b16 v[148:149], v9 offset:20480
ds_read_b64_tr_b16 v[150:151], v9 offset:22528
v_mfma_f32_16x16x32_bf16 v[96:99], v[208:211], a[20:23], v[96:99]
ds_read_b64_tr_b16 v[152:153], v10 offset:20480
s_add_u32 s69, s61, 3
s_and_b32 s69, s69, 7
s_lshl_b32 s69, s69, 12
s_add_u32 s69, s69, s95
buffer_load_dwordx4 a[96:99], v1, s[44:47], s69 offen sc1
v_mfma_f32_16x16x32_bf16 v[100:103], v[212:215], a[20:23], v[100:103]
ds_read_b64_tr_b16 v[154:155], v10 offset:22528
v_mfma_f32_16x16x32_bf16 v[84:87], v[212:215], a[4:7], v[84:87]
ds_read_b64_tr_b16 v[156:157], v11 offset:20480
buffer_load_dwordx4 a[100:103], v1, s[44:47], s69 offen offset:1024 sc1
v_mfma_f32_16x16x32_bf16 v[88:91], v[216:219], a[4:7], v[88:91]
ds_read_b64_tr_b16 v[158:159], v11 offset:22528
v_mfma_f32_16x16x32_bf16 v[104:107], v[216:219], a[20:23], v[104:107]
ds_read_b64_tr_b16 v[160:161], v8 offset:24576
ds_read_b64_tr_b16 v[162:163], v8 offset:26624
v_mfma_f32_16x16x32_bf16 v[108:111], v[220:223], a[20:23], v[108:111]
ds_read_b64_tr_b16 v[164:165], v9 offset:24576
buffer_load_dwordx4 a[104:107], v1, s[44:47], s69 offen offset:2048 sc1
v_mfma_f32_16x16x32_bf16 v[92:95], v[220:223], a[4:7], v[92:95]
ds_read_b64_tr_b16 v[166:167], v9 offset:26624
v_mfma_f32_16x16x32_bf16 v[80:83], v[224:227], a[8:11], v[80:83]
ds_read_b64_tr_b16 v[168:169], v10 offset:24576
buffer_load_dwordx4 a[108:111], v1, s[44:47], s69 offen offset:3072 sc1
v_mfma_f32_16x16x32_bf16 v[96:99], v[224:227], a[24:27], v[96:99]
ds_read_b64_tr_b16 v[170:171], v10 offset:26624
ds_read_b64_tr_b16 v[172:173], v11 offset:24576
v_mfma_f32_16x16x32_bf16 v[100:103], v[228:231], a[24:27], v[100:103]
ds_read_b64_tr_b16 v[174:175], v11 offset:26624
s_add_u32 s69, s69, 0x20000
buffer_load_dwordx4 a[112:115], v1, s[44:47], s69 offen sc1
v_mfma_f32_16x16x32_bf16 v[84:87], v[228:231], a[8:11], v[84:87]
ds_read_b64_tr_b16 v[176:177], v8 offset:28672
v_mfma_f32_16x16x32_bf16 v[88:91], v[232:235], a[8:11], v[88:91]
ds_read_b64_tr_b16 v[178:179], v8 offset:30720
v_mfma_f32_16x16x32_bf16 v[104:107], v[232:235], a[24:27], v[104:107]
ds_read_b64_tr_b16 v[180:181], v9 offset:28672
ds_read_b64_tr_b16 v[182:183], v9 offset:30720
buffer_load_dwordx4 a[116:119], v1, s[44:47], s69 offen offset:1024 sc1
v_mfma_f32_16x16x32_bf16 v[108:111], v[236:239], a[24:27], v[108:111]
ds_read_b64_tr_b16 v[184:185], v10 offset:28672
v_mfma_f32_16x16x32_bf16 v[92:95], v[236:239], a[8:11], v[92:95]
ds_read_b64_tr_b16 v[186:187], v10 offset:30720
buffer_load_dwordx4 a[120:123], v1, s[44:47], s69 offen offset:2048 sc1
v_mfma_f32_16x16x32_bf16 v[80:83], v[240:243], a[12:15], v[80:83]
ds_read_b64_tr_b16 v[188:189], v11 offset:28672
v_mfma_f32_16x16x32_bf16 v[96:99], v[240:243], a[28:31], v[96:99]
ds_read_b64_tr_b16 v[190:191], v11 offset:30720
buffer_load_dwordx4 a[124:127], v1, s[44:47], s69 offen offset:3072 sc1
v_mfma_f32_16x16x32_bf16 v[100:103], v[244:247], a[28:31], v[100:103]
v_mfma_f32_16x16x32_bf16 v[84:87], v[244:247], a[12:15], v[84:87]
v_mfma_f32_16x16x32_bf16 v[88:91], v[248:251], a[12:15], v[88:91]
v_mfma_f32_16x16x32_bf16 v[104:107], v[248:251], a[28:31], v[104:107]
v_mfma_f32_16x16x32_bf16 v[108:111], v[252:255], a[28:31], v[108:111]
s_waitcnt vmcnt(25) lgkmcnt(0)
v_mfma_f32_16x16x32_bf16 v[92:95], v[252:255], a[12:15], v[92:95]
s_barrier
v_mfma_f32_16x16x32_bf16 v[80:83], v[128:131], a[32:35], v[80:83]
ds_read_b64_tr_b16 v[192:193], v8 offset:32768
ds_read_b64_tr_b16 v[194:195], v8 offset:34816
s_add_u32 s71, s61, 5
s_and_b32 s71, s71, 7
s_lshl_b32 s71, s71, 18
s_add_u32 s71, s71, s94
s_add_u32 m0, s64, 114688
s_add_u32 s72, s71, 0
buffer_load_dwordx4 v4, s[24:27], s72 offen lds
v_mfma_f32_16x16x32_bf16 v[96:99], v[128:131], a[48:51], v[96:99]
ds_read_b64_tr_b16 v[196:197], v9 offset:32768
v_mfma_f32_16x16x32_bf16 v[100:103], v[132:135], a[48:51], v[100:103]
ds_read_b64_tr_b16 v[198:199], v9 offset:34816
s_add_u32 s72, s71, 15360
buffer_load_dwordx4 v4, s[24:27], s72 offen offset:1024 lds
v_mfma_f32_16x16x32_bf16 v[84:87], v[132:135], a[32:35], v[84:87]
ds_read_b64_tr_b16 v[200:201], v10 offset:32768
v_mfma_f32_16x16x32_bf16 v[88:91], v[136:139], a[32:35], v[88:91]
ds_read_b64_tr_b16 v[202:203], v10 offset:34816
ds_read_b64_tr_b16 v[204:205], v11 offset:32768
s_add_u32 s72, s71, 30720
buffer_load_dwordx4 v4, s[24:27], s72 offen offset:2048 lds
v_mfma_f32_16x16x32_bf16 v[104:107], v[136:139], a[48:51], v[104:107]
ds_read_b64_tr_b16 v[206:207], v11 offset:34816
v_mfma_f32_16x16x32_bf16 v[108:111], v[140:143], a[48:51], v[108:111]
ds_read_b64_tr_b16 v[208:209], v8 offset:36864
v_mfma_f32_16x16x32_bf16 v[92:95], v[140:143], a[32:35], v[92:95]
ds_read_b64_tr_b16 v[210:211], v8 offset:38912
s_add_u32 s72, s71, 46080
buffer_load_dwordx4 v4, s[24:27], s72 offen offset:3072 lds
v_mfma_f32_16x16x32_bf16 v[80:83], v[144:147], a[36:39], v[80:83]
ds_read_b64_tr_b16 v[212:213], v9 offset:36864
ds_read_b64_tr_b16 v[214:215], v9 offset:38912
v_mfma_f32_16x16x32_bf16 v[96:99], v[144:147], a[52:55], v[96:99]
ds_read_b64_tr_b16 v[216:217], v10 offset:36864
s_add_u32 s69, s61, 4
s_and_b32 s69, s69, 7
s_lshl_b32 s69, s69, 12
s_add_u32 s69, s69, s95
buffer_load_dwordx4 a[0:3], v1, s[44:47], s69 offen sc1
v_mfma_f32_16x16x32_bf16 v[100:103], v[148:151], a[52:55], v[100:103]
ds_read_b64_tr_b16 v[218:219], v10 offset:38912
v_mfma_f32_16x16x32_bf16 v[84:87], v[148:151], a[36:39], v[84:87]
ds_read_b64_tr_b16 v[220:221], v11 offset:36864
buffer_load_dwordx4 a[4:7], v1, s[44:47], s69 offen offset:1024 sc1
v_mfma_f32_16x16x32_bf16 v[88:91], v[152:155], a[36:39], v[88:91]
ds_read_b64_tr_b16 v[222:223], v11 offset:38912
v_mfma_f32_16x16x32_bf16 v[104:107], v[152:155], a[52:55], v[104:107]
ds_read_b64_tr_b16 v[224:225], v8 offset:40960
ds_read_b64_tr_b16 v[226:227], v8 offset:43008
v_mfma_f32_16x16x32_bf16 v[108:111], v[156:159], a[52:55], v[108:111]
ds_read_b64_tr_b16 v[228:229], v9 offset:40960
buffer_load_dwordx4 a[8:11], v1, s[44:47], s69 offen offset:2048 sc1
v_mfma_f32_16x16x32_bf16 v[92:95], v[156:159], a[36:39], v[92:95]
ds_read_b64_tr_b16 v[230:231], v9 offset:43008
v_mfma_f32_16x16x32_bf16 v[80:83], v[160:163], a[40:43], v[80:83]
ds_read_b64_tr_b16 v[232:233], v10 offset:40960
buffer_load_dwordx4 a[12:15], v1, s[44:47], s69 offen offset:3072 sc1
v_mfma_f32_16x16x32_bf16 v[96:99], v[160:163], a[56:59], v[96:99]
ds_read_b64_tr_b16 v[234:235], v10 offset:43008
ds_read_b64_tr_b16 v[236:237], v11 offset:40960
v_mfma_f32_16x16x32_bf16 v[100:103], v[164:167], a[56:59], v[100:103]
ds_read_b64_tr_b16 v[238:239], v11 offset:43008
s_add_u32 s69, s69, 0x20000
buffer_load_dwordx4 a[16:19], v1, s[44:47], s69 offen sc1
v_mfma_f32_16x16x32_bf16 v[84:87], v[164:167], a[40:43], v[84:87]
ds_read_b64_tr_b16 v[240:241], v8 offset:45056
v_mfma_f32_16x16x32_bf16 v[88:91], v[168:171], a[40:43], v[88:91]
ds_read_b64_tr_b16 v[242:243], v8 offset:47104
v_mfma_f32_16x16x32_bf16 v[104:107], v[168:171], a[56:59], v[104:107]
ds_read_b64_tr_b16 v[244:245], v9 offset:45056
ds_read_b64_tr_b16 v[246:247], v9 offset:47104
buffer_load_dwordx4 a[20:23], v1, s[44:47], s69 offen offset:1024 sc1
v_mfma_f32_16x16x32_bf16 v[108:111], v[172:175], a[56:59], v[108:111]
ds_read_b64_tr_b16 v[248:249], v10 offset:45056
v_mfma_f32_16x16x32_bf16 v[92:95], v[172:175], a[40:43], v[92:95]
ds_read_b64_tr_b16 v[250:251], v10 offset:47104
buffer_load_dwordx4 a[24:27], v1, s[44:47], s69 offen offset:2048 sc1
v_mfma_f32_16x16x32_bf16 v[80:83], v[176:179], a[44:47], v[80:83]
ds_read_b64_tr_b16 v[252:253], v11 offset:45056
v_mfma_f32_16x16x32_bf16 v[96:99], v[176:179], a[60:63], v[96:99]
ds_read_b64_tr_b16 v[254:255], v11 offset:47104
buffer_load_dwordx4 a[28:31], v1, s[44:47], s69 offen offset:3072 sc1
v_mfma_f32_16x16x32_bf16 v[100:103], v[180:183], a[60:63], v[100:103]
v_mfma_f32_16x16x32_bf16 v[84:87], v[180:183], a[44:47], v[84:87]
v_mfma_f32_16x16x32_bf16 v[88:91], v[184:187], a[44:47], v[88:91]
v_mfma_f32_16x16x32_bf16 v[104:107], v[184:187], a[60:63], v[104:107]
v_mfma_f32_16x16x32_bf16 v[108:111], v[188:191], a[60:63], v[108:111]
s_waitcnt vmcnt(27) lgkmcnt(0)
v_mfma_f32_16x16x32_bf16 v[92:95], v[188:191], a[44:47], v[92:95]
s_barrier
v_mfma_f32_16x16x32_bf16 v[80:83], v[192:195], a[64:67], v[80:83]
ds_read_b64_tr_b16 v[128:129], v8 offset:49152
ds_read_b64_tr_b16 v[130:131], v8 offset:51200
s_add_u32 s71, s61, 6
s_and_b32 s71, s71, 7
s_lshl_b32 s71, s71, 18
s_add_u32 s71, s71, s94
s_add_u32 m0, s64, 131072
s_add_u32 s72, s71, 0
buffer_load_dwordx4 v4, s[24:27], s72 offen lds
v_mfma_f32_16x16x32_bf16 v[96:99], v[192:195], a[80:83], v[96:99]
ds_read_b64_tr_b16 v[132:133], v9 offset:49152
v_mfma_f32_16x16x32_bf16 v[100:103], v[196:199], a[80:83], v[100:103]
ds_read_b64_tr_b16 v[134:135], v9 offset:51200
s_add_u32 s72, s71, 15360
buffer_load_dwordx4 v4, s[24:27], s72 offen offset:1024 lds
v_mfma_f32_16x16x32_bf16 v[84:87], v[196:199], a[64:67], v[84:87]
ds_read_b64_tr_b16 v[136:137], v10 offset:49152
v_mfma_f32_16x16x32_bf16 v[88:91], v[200:203], a[64:67], v[88:91]
ds_read_b64_tr_b16 v[138:139], v10 offset:51200
ds_read_b64_tr_b16 v[140:141], v11 offset:49152
s_add_u32 s72, s71, 30720
buffer_load_dwordx4 v4, s[24:27], s72 offen offset:2048 lds
v_mfma_f32_16x16x32_bf16 v[104:107], v[200:203], a[80:83], v[104:107]
ds_read_b64_tr_b16 v[142:143], v11 offset:51200
v_mfma_f32_16x16x32_bf16 v[108:111], v[204:207], a[80:83], v[108:111]
ds_read_b64_tr_b16 v[144:145], v8 offset:53248
v_mfma_f32_16x16x32_bf16 v[92:95], v[204:207], a[64:67], v[92:95]
ds_read_b64_tr_b16 v[146:147], v8 offset:55296
s_add_u32 s72, s71, 46080
buffer_load_dwordx4 v4, s[24:27], s72 offen offset:3072 lds
v_mfma_f32_16x16x32_bf16 v[80:83], v[208:211], a[68:71], v[80:83]
ds_read_b64_tr_b16 v[148:149], v9 offset:53248
ds_read_b64_tr_b16 v[150:151], v9 offset:55296
v_mfma_f32_16x16x32_bf16 v[96:99], v[208:211], a[84:87], v[96:99]
ds_read_b64_tr_b16 v[152:153], v10 offset:53248
s_add_u32 s69, s61, 5
s_and_b32 s69, s69, 7
s_lshl_b32 s69, s69, 12
s_add_u32 s69, s69, s95
buffer_load_dwordx4 a[32:35], v1, s[44:47], s69 offen sc1
v_mfma_f32_16x16x32_bf16 v[100:103], v[212:215], a[84:87], v[100:103]
ds_read_b64_tr_b16 v[154:155], v10 offset:55296
v_mfma_f32_16x16x32_bf16 v[84:87], v[212:215], a[68:71], v[84:87]
ds_read_b64_tr_b16 v[156:157], v11 offset:53248
buffer_load_dwordx4 a[36:39], v1, s[44:47], s69 offen offset:1024 sc1
v_mfma_f32_16x16x32_bf16 v[88:91], v[216:219], a[68:71], v[88:91]
ds_read_b64_tr_b16 v[158:159], v11 offset:55296
v_mfma_f32_16x16x32_bf16 v[104:107], v[216:219], a[84:87], v[104:107]
ds_read_b64_tr_b16 v[160:161], v8 offset:57344
ds_read_b64_tr_b16 v[162:163], v8 offset:59392
v_mfma_f32_16x16x32_bf16 v[108:111], v[220:223], a[84:87], v[108:111]
ds_read_b64_tr_b16 v[164:165], v9 offset:57344
buffer_load_dwordx4 a[40:43], v1, s[44:47], s69 offen offset:2048 sc1
v_mfma_f32_16x16x32_bf16 v[92:95], v[220:223], a[68:71], v[92:95]
ds_read_b64_tr_b16 v[166:167], v9 offset:59392
v_mfma_f32_16x16x32_bf16 v[80:83], v[224:227], a[72:75], v[80:83]
ds_read_b64_tr_b16 v[168:169], v10 offset:57344
buffer_load_dwordx4 a[44:47], v1, s[44:47], s69 offen offset:3072 sc1
v_mfma_f32_16x16x32_bf16 v[96:99], v[224:227], a[88:91], v[96:99]
ds_read_b64_tr_b16 v[170:171], v10 offset:59392
ds_read_b64_tr_b16 v[172:173], v11 offset:57344
v_mfma_f32_16x16x32_bf16 v[100:103], v[228:231], a[88:91], v[100:103]
ds_read_b64_tr_b16 v[174:175], v11 offset:59392
s_add_u32 s69, s69, 0x20000
buffer_load_dwordx4 a[48:51], v1, s[44:47], s69 offen sc1
v_mfma_f32_16x16x32_bf16 v[84:87], v[228:231], a[72:75], v[84:87]
ds_read_b64_tr_b16 v[176:177], v8 offset:61440
v_mfma_f32_16x16x32_bf16 v[88:91], v[232:235], a[72:75], v[88:91]
ds_read_b64_tr_b16 v[178:179], v8 offset:63488
v_mfma_f32_16x16x32_bf16 v[104:107], v[232:235], a[88:91], v[104:107]
ds_read_b64_tr_b16 v[180:181], v9 offset:61440
ds_read_b64_tr_b16 v[182:183], v9 offset:63488
buffer_load_dwordx4 a[52:55], v1, s[44:47], s69 offen offset:1024 sc1
v_mfma_f32_16x16x32_bf16 v[108:111], v[236:239], a[88:91], v[108:111]
ds_read_b64_tr_b16 v[184:185], v10 offset:61440
v_mfma_f32_16x16x32_bf16 v[92:95], v[236:239], a[72:75], v[92:95]
ds_read_b64_tr_b16 v[186:187], v10 offset:63488
buffer_load_dwordx4 a[56:59], v1, s[44:47], s69 offen offset:2048 sc1
v_mfma_f32_16x16x32_bf16 v[80:83], v[240:243], a[76:79], v[80:83]
ds_read_b64_tr_b16 v[188:189], v11 offset:61440
v_mfma_f32_16x16x32_bf16 v[96:99], v[240:243], a[92:95], v[96:99]
ds_read_b64_tr_b16 v[190:191], v11 offset:63488
buffer_load_dwordx4 a[60:63], v1, s[44:47], s69 offen offset:3072 sc1
v_mfma_f32_16x16x32_bf16 v[100:103], v[244:247], a[92:95], v[100:103]
v_mfma_f32_16x16x32_bf16 v[84:87], v[244:247], a[76:79], v[84:87]
v_mfma_f32_16x16x32_bf16 v[88:91], v[248:251], a[76:79], v[88:91]
v_mfma_f32_16x16x32_bf16 v[104:107], v[248:251], a[92:95], v[104:107]
v_mfma_f32_16x16x32_bf16 v[108:111], v[252:255], a[92:95], v[108:111]
s_waitcnt vmcnt(24) lgkmcnt(0)
v_mfma_f32_16x16x32_bf16 v[92:95], v[252:255], a[76:79], v[92:95]
s_barrier
v_mfma_f32_16x16x32_bf16 v[80:83], v[128:131], a[96:99], v[80:83]
ds_read_b64_tr_b16 v[192:193], v8 offset:0
ds_read_b64_tr_b16 v[194:195], v8 offset:2048
s_add_u32 s71, s61, 7
s_and_b32 s71, s71, 7
s_lshl_b32 s71, s71, 18
s_add_u32 s71, s71, s94
s_add_u32 m0, s64, 147456
s_add_u32 s72, s71, 0
buffer_load_dwordx4 v4, s[24:27], s72 offen lds
v_or_b32 v112, s58, v0
v_mov_b32 v113, 3
v_min_u32 v112, 1, v112
v_lshlrev_b32 v112, 30, v112
buffer_store_dword v113, v112, s[44:47], s91 offen sc1
v_mfma_f32_16x16x32_bf16 v[96:99], v[128:131], a[112:115], v[96:99]
ds_read_b64_tr_b16 v[196:197], v9 offset:0
v_mfma_f32_16x16x32_bf16 v[100:103], v[132:135], a[112:115], v[100:103]
ds_read_b64_tr_b16 v[198:199], v9 offset:2048
s_add_u32 s72, s71, 15360
buffer_load_dwordx4 v4, s[24:27], s72 offen offset:1024 lds
v_mfma_f32_16x16x32_bf16 v[84:87], v[132:135], a[96:99], v[84:87]
ds_read_b64_tr_b16 v[200:201], v10 offset:0
v_mfma_f32_16x16x32_bf16 v[88:91], v[136:139], a[96:99], v[88:91]
ds_read_b64_tr_b16 v[202:203], v10 offset:2048
ds_read_b64_tr_b16 v[204:205], v11 offset:0
s_add_u32 s72, s71, 30720
buffer_load_dwordx4 v4, s[24:27], s72 offen offset:2048 lds
v_mfma_f32_16x16x32_bf16 v[104:107], v[136:139], a[112:115], v[104:107]
ds_read_b64_tr_b16 v[206:207], v11 offset:2048
v_mfma_f32_16x16x32_bf16 v[108:111], v[140:143], a[112:115], v[108:111]
ds_read_b64_tr_b16 v[208:209], v8 offset:4096
v_mfma_f32_16x16x32_bf16 v[92:95], v[140:143], a[96:99], v[92:95]
ds_read_b64_tr_b16 v[210:211], v8 offset:6144
s_add_u32 s72, s71, 46080
buffer_load_dwordx4 v4, s[24:27], s72 offen offset:3072 lds
v_mfma_f32_16x16x32_bf16 v[80:83], v[144:147], a[100:103], v[80:83]
ds_read_b64_tr_b16 v[212:213], v9 offset:4096
ds_read_b64_tr_b16 v[214:215], v9 offset:6144
v_mfma_f32_16x16x32_bf16 v[96:99], v[144:147], a[116:119], v[96:99]
ds_read_b64_tr_b16 v[216:217], v10 offset:4096
s_add_u32 s69, s61, 6
s_and_b32 s69, s69, 7
s_lshl_b32 s69, s69, 12
s_add_u32 s69, s69, s95
buffer_load_dwordx4 a[64:67], v1, s[44:47], s69 offen sc1
v_mfma_f32_16x16x32_bf16 v[100:103], v[148:151], a[116:119], v[100:103]
ds_read_b64_tr_b16 v[218:219], v10 offset:6144
v_mfma_f32_16x16x32_bf16 v[84:87], v[148:151], a[100:103], v[84:87]
ds_read_b64_tr_b16 v[220:221], v11 offset:4096
buffer_load_dwordx4 a[68:71], v1, s[44:47], s69 offen offset:1024 sc1
v_mfma_f32_16x16x32_bf16 v[88:91], v[152:155], a[100:103], v[88:91]
ds_read_b64_tr_b16 v[222:223], v11 offset:6144
v_mfma_f32_16x16x32_bf16 v[104:107], v[152:155], a[116:119], v[104:107]
ds_read_b64_tr_b16 v[224:225], v8 offset:8192
ds_read_b64_tr_b16 v[226:227], v8 offset:10240
v_mfma_f32_16x16x32_bf16 v[108:111], v[156:159], a[116:119], v[108:111]
ds_read_b64_tr_b16 v[228:229], v9 offset:8192
buffer_load_dwordx4 a[72:75], v1, s[44:47], s69 offen offset:2048 sc1
v_mfma_f32_16x16x32_bf16 v[92:95], v[156:159], a[100:103], v[92:95]
ds_read_b64_tr_b16 v[230:231], v9 offset:10240
v_mfma_f32_16x16x32_bf16 v[80:83], v[160:163], a[104:107], v[80:83]
ds_read_b64_tr_b16 v[232:233], v10 offset:8192
buffer_load_dwordx4 a[76:79], v1, s[44:47], s69 offen offset:3072 sc1
v_mfma_f32_16x16x32_bf16 v[96:99], v[160:163], a[120:123], v[96:99]
ds_read_b64_tr_b16 v[234:235], v10 offset:10240
ds_read_b64_tr_b16 v[236:237], v11 offset:8192
v_mfma_f32_16x16x32_bf16 v[100:103], v[164:167], a[120:123], v[100:103]
ds_read_b64_tr_b16 v[238:239], v11 offset:10240
s_add_u32 s69, s69, 0x20000
buffer_load_dwordx4 a[80:83], v1, s[44:47], s69 offen sc1
v_mfma_f32_16x16x32_bf16 v[84:87], v[164:167], a[104:107], v[84:87]
ds_read_b64_tr_b16 v[240:241], v8 offset:12288
v_mfma_f32_16x16x32_bf16 v[88:91], v[168:171], a[104:107], v[88:91]
ds_read_b64_tr_b16 v[242:243], v8 offset:14336
v_mfma_f32_16x16x32_bf16 v[104:107], v[168:171], a[120:123], v[104:107]
ds_read_b64_tr_b16 v[244:245], v9 offset:12288
ds_read_b64_tr_b16 v[246:247], v9 offset:14336
buffer_load_dwordx4 a[84:87], v1, s[44:47], s69 offen offset:1024 sc1
v_mfma_f32_16x16x32_bf16 v[108:111], v[172:175], a[120:123], v[108:111]
ds_read_b64_tr_b16 v[248:249], v10 offset:12288
v_mfma_f32_16x16x32_bf16 v[92:95], v[172:175], a[104:107], v[92:95]
ds_read_b64_tr_b16 v[250:251], v10 offset:14336
buffer_load_dwordx4 a[88:91], v1, s[44:47], s69 offen offset:2048 sc1
v_mfma_f32_16x16x32_bf16 v[80:83], v[176:179], a[108:111], v[80:83]
ds_read_b64_tr_b16 v[252:253], v11 offset:12288
v_mfma_f32_16x16x32_bf16 v[96:99], v[176:179], a[124:127], v[96:99]
ds_read_b64_tr_b16 v[254:255], v11 offset:14336
buffer_load_dwordx4 a[92:95], v1, s[44:47], s69 offen offset:3072 sc1
v_mfma_f32_16x16x32_bf16 v[100:103], v[180:183], a[124:127], v[100:103]
v_mfma_f32_16x16x32_bf16 v[84:87], v[180:183], a[108:111], v[84:87]
v_mfma_f32_16x16x32_bf16 v[88:91], v[184:187], a[108:111], v[88:91]
v_mfma_f32_16x16x32_bf16 v[104:107], v[184:187], a[124:127], v[104:107]
v_mfma_f32_16x16x32_bf16 v[108:111], v[188:191], a[124:127], v[108:111]
s_waitcnt vmcnt(25) lgkmcnt(0)
v_mfma_f32_16x16x32_bf16 v[92:95], v[188:191], a[108:111], v[92:95]
s_barrier
v_mfma_f32_16x16x32_bf16 v[80:83], v[192:195], a[0:3], v[80:83]
ds_read_b64_tr_b16 v[128:129], v8 offset:16384
ds_read_b64_tr_b16 v[130:131], v8 offset:18432
s_add_u32 s71, s61, 8
s_and_b32 s71, s71, 7
s_or_b32 s71, s71, 8
s_lshl_b32 s71, s71, 18
s_add_u32 s71, s71, s94
s_add_u32 m0, s64, 98304
s_add_u32 s72, s71, 0
buffer_load_dwordx4 v4, s[24:27], s72 offen lds
v_mfma_f32_16x16x32_bf16 v[96:99], v[192:195], a[16:19], v[96:99]
ds_read_b64_tr_b16 v[132:133], v9 offset:16384
v_mfma_f32_16x16x32_bf16 v[100:103], v[196:199], a[16:19], v[100:103]
ds_read_b64_tr_b16 v[134:135], v9 offset:18432
s_add_u32 s72, s71, 15360
buffer_load_dwordx4 v4, s[24:27], s72 offen offset:1024 lds
v_mfma_f32_16x16x32_bf16 v[84:87], v[196:199], a[0:3], v[84:87]
ds_read_b64_tr_b16 v[136:137], v10 offset:16384
v_mfma_f32_16x16x32_bf16 v[88:91], v[200:203], a[0:3], v[88:91]
ds_read_b64_tr_b16 v[138:139], v10 offset:18432
ds_read_b64_tr_b16 v[140:141], v11 offset:16384
s_add_u32 s72, s71, 30720
buffer_load_dwordx4 v4, s[24:27], s72 offen offset:2048 lds
v_mfma_f32_16x16x32_bf16 v[104:107], v[200:203], a[16:19], v[104:107]
ds_read_b64_tr_b16 v[142:143], v11 offset:18432
v_mfma_f32_16x16x32_bf16 v[108:111], v[204:207], a[16:19], v[108:111]
ds_read_b64_tr_b16 v[144:145], v8 offset:20480
v_mfma_f32_16x16x32_bf16 v[92:95], v[204:207], a[0:3], v[92:95]
ds_read_b64_tr_b16 v[146:147], v8 offset:22528
s_add_u32 s72, s71, 46080
buffer_load_dwordx4 v4, s[24:27], s72 offen offset:3072 lds
v_mfma_f32_16x16x32_bf16 v[80:83], v[208:211], a[4:7], v[80:83]
ds_read_b64_tr_b16 v[148:149], v9 offset:20480
ds_read_b64_tr_b16 v[150:151], v9 offset:22528
v_mfma_f32_16x16x32_bf16 v[96:99], v[208:211], a[20:23], v[96:99]
ds_read_b64_tr_b16 v[152:153], v10 offset:20480
s_add_u32 s69, s61, 7
s_and_b32 s69, s69, 7
s_lshl_b32 s69, s69, 12
s_add_u32 s69, s69, s95
buffer_load_dwordx4 a[96:99], v1, s[44:47], s69 offen sc1
v_mfma_f32_16x16x32_bf16 v[100:103], v[212:215], a[20:23], v[100:103]
ds_read_b64_tr_b16 v[154:155], v10 offset:22528
v_mfma_f32_16x16x32_bf16 v[84:87], v[212:215], a[4:7], v[84:87]
ds_read_b64_tr_b16 v[156:157], v11 offset:20480
buffer_load_dwordx4 a[100:103], v1, s[44:47], s69 offen offset:1024 sc1
v_mfma_f32_16x16x32_bf16 v[88:91], v[216:219], a[4:7], v[88:91]
ds_read_b64_tr_b16 v[158:159], v11 offset:22528
v_mfma_f32_16x16x32_bf16 v[104:107], v[216:219], a[20:23], v[104:107]
ds_read_b64_tr_b16 v[160:161], v8 offset:24576
ds_read_b64_tr_b16 v[162:163], v8 offset:26624
v_mfma_f32_16x16x32_bf16 v[108:111], v[220:223], a[20:23], v[108:111]
ds_read_b64_tr_b16 v[164:165], v9 offset:24576
buffer_load_dwordx4 a[104:107], v1, s[44:47], s69 offen offset:2048 sc1
v_mfma_f32_16x16x32_bf16 v[92:95], v[220:223], a[4:7], v[92:95]
ds_read_b64_tr_b16 v[166:167], v9 offset:26624
v_mfma_f32_16x16x32_bf16 v[80:83], v[224:227], a[8:11], v[80:83]
ds_read_b64_tr_b16 v[168:169], v10 offset:24576
buffer_load_dwordx4 a[108:111], v1, s[44:47], s69 offen offset:3072 sc1
v_mfma_f32_16x16x32_bf16 v[96:99], v[224:227], a[24:27], v[96:99]
ds_read_b64_tr_b16 v[170:171], v10 offset:26624
ds_read_b64_tr_b16 v[172:173], v11 offset:24576
v_mfma_f32_16x16x32_bf16 v[100:103], v[228:231], a[24:27], v[100:103]
ds_read_b64_tr_b16 v[174:175], v11 offset:26624
s_add_u32 s69, s69, 0x20000
buffer_load_dwordx4 a[112:115], v1, s[44:47], s69 offen sc1
v_mfma_f32_16x16x32_bf16 v[84:87], v[228:231], a[8:11], v[84:87]
ds_read_b64_tr_b16 v[176:177], v8 offset:28672
v_mfma_f32_16x16x32_bf16 v[88:91], v[232:235], a[8:11], v[88:91]
ds_read_b64_tr_b16 v[178:179], v8 offset:30720
v_mfma_f32_16x16x32_bf16 v[104:107], v[232:235], a[24:27], v[104:107]
ds_read_b64_tr_b16 v[180:181], v9 offset:28672
ds_read_b64_tr_b16 v[182:183], v9 offset:30720
buffer_load_dwordx4 a[116:119], v1, s[44:47], s69 offen offset:1024 sc1
v_mfma_f32_16x16x32_bf16 v[108:111], v[236:239], a[24:27], v[108:111]
ds_read_b64_tr_b16 v[184:185], v10 offset:28672
v_mfma_f32_16x16x32_bf16 v[92:95], v[236:239], a[8:11], v[92:95]
ds_read_b64_tr_b16 v[186:187], v10 offset:30720
buffer_load_dwordx4 a[120:123], v1, s[44:47], s69 offen offset:2048 sc1
v_mfma_f32_16x16x32_bf16 v[80:83], v[240:243], a[12:15], v[80:83]
ds_read_b64_tr_b16 v[188:189], v11 offset:28672
v_mfma_f32_16x16x32_bf16 v[96:99], v[240:243], a[28:31], v[96:99]
ds_read_b64_tr_b16 v[190:191], v11 offset:30720
buffer_load_dwordx4 a[124:127], v1, s[44:47], s69 offen offset:3072 sc1
v_mfma_f32_16x16x32_bf16 v[100:103], v[244:247], a[28:31], v[100:103]
v_mfma_f32_16x16x32_bf16 v[84:87], v[244:247], a[12:15], v[84:87]
v_mfma_f32_16x16x32_bf16 v[88:91], v[248:251], a[12:15], v[88:91]
v_mfma_f32_16x16x32_bf16 v[104:107], v[248:251], a[28:31], v[104:107]
v_mfma_f32_16x16x32_bf16 v[108:111], v[252:255], a[28:31], v[108:111]
s_waitcnt vmcnt(25) lgkmcnt(0)
v_mfma_f32_16x16x32_bf16 v[92:95], v[252:255], a[12:15], v[92:95]
s_barrier
v_mfma_f32_16x16x32_bf16 v[80:83], v[128:131], a[32:35], v[80:83]
ds_read_b64_tr_b16 v[192:193], v8 offset:32768
ds_read_b64_tr_b16 v[194:195], v8 offset:34816
s_add_u32 s71, s61, 9
s_and_b32 s71, s71, 7
s_or_b32 s71, s71, 8
s_lshl_b32 s71, s71, 18
s_add_u32 s71, s71, s94
s_add_u32 m0, s64, 114688
s_add_u32 s72, s71, 0
buffer_load_dwordx4 v4, s[24:27], s72 offen lds
v_mfma_f32_16x16x32_bf16 v[96:99], v[128:131], a[48:51], v[96:99]
ds_read_b64_tr_b16 v[196:197], v9 offset:32768
v_mfma_f32_16x16x32_bf16 v[100:103], v[132:135], a[48:51], v[100:103]
ds_read_b64_tr_b16 v[198:199], v9 offset:34816
s_add_u32 s72, s71, 15360
buffer_load_dwordx4 v4, s[24:27], s72 offen offset:1024 lds
v_mfma_f32_16x16x32_bf16 v[84:87], v[132:135], a[32:35], v[84:87]
ds_read_b64_tr_b16 v[200:201], v10 offset:32768
v_mfma_f32_16x16x32_bf16 v[88:91], v[136:139], a[32:35], v[88:91]
ds_read_b64_tr_b16 v[202:203], v10 offset:34816
ds_read_b64_tr_b16 v[204:205], v11 offset:32768
s_add_u32 s72, s71, 30720
buffer_load_dwordx4 v4, s[24:27], s72 offen offset:2048 lds
v_mfma_f32_16x16x32_bf16 v[104:107], v[136:139], a[48:51], v[104:107]
ds_read_b64_tr_b16 v[206:207], v11 offset:34816
v_mfma_f32_16x16x32_bf16 v[108:111], v[140:143], a[48:51], v[108:111]
ds_read_b64_tr_b16 v[208:209], v8 offset:36864
v_mfma_f32_16x16x32_bf16 v[92:95], v[140:143], a[32:35], v[92:95]
ds_read_b64_tr_b16 v[210:211], v8 offset:38912
s_add_u32 s72, s71, 46080
buffer_load_dwordx4 v4, s[24:27], s72 offen offset:3072 lds
v_mfma_f32_16x16x32_bf16 v[80:83], v[144:147], a[36:39], v[80:83]
ds_read_b64_tr_b16 v[212:213], v9 offset:36864
ds_read_b64_tr_b16 v[214:215], v9 offset:38912
v_mfma_f32_16x16x32_bf16 v[96:99], v[144:147], a[52:55], v[96:99]
ds_read_b64_tr_b16 v[216:217], v10 offset:36864
s_add_u32 s69, s61, 8
s_and_b32 s69, s69, 7
s_or_b32 s69, s69, 8
s_lshl_b32 s69, s69, 12
s_add_u32 s69, s69, s95
buffer_load_dwordx4 a[0:3], v1, s[44:47], s69 offen sc1
v_mfma_f32_16x16x32_bf16 v[100:103], v[148:151], a[52:55], v[100:103]
ds_read_b64_tr_b16 v[218:219], v10 offset:38912
v_mfma_f32_16x16x32_bf16 v[84:87], v[148:151], a[36:39], v[84:87]
ds_read_b64_tr_b16 v[220:221], v11 offset:36864
buffer_load_dwordx4 a[4:7], v1, s[44:47], s69 offen offset:1024 sc1
v_mfma_f32_16x16x32_bf16 v[88:91], v[152:155], a[36:39], v[88:91]
ds_read_b64_tr_b16 v[222:223], v11 offset:38912
v_mfma_f32_16x16x32_bf16 v[104:107], v[152:155], a[52:55], v[104:107]
ds_read_b64_tr_b16 v[224:225], v8 offset:40960
ds_read_b64_tr_b16 v[226:227], v8 offset:43008
v_mfma_f32_16x16x32_bf16 v[108:111], v[156:159], a[52:55], v[108:111]
ds_read_b64_tr_b16 v[228:229], v9 offset:40960
buffer_load_dwordx4 a[8:11], v1, s[44:47], s69 offen offset:2048 sc1
v_mfma_f32_16x16x32_bf16 v[92:95], v[156:159], a[36:39], v[92:95]
ds_read_b64_tr_b16 v[230:231], v9 offset:43008
v_mfma_f32_16x16x32_bf16 v[80:83], v[160:163], a[40:43], v[80:83]
ds_read_b64_tr_b16 v[232:233], v10 offset:40960
buffer_load_dwordx4 a[12:15], v1, s[44:47], s69 offen offset:3072 sc1
v_mfma_f32_16x16x32_bf16 v[96:99], v[160:163], a[56:59], v[96:99]
ds_read_b64_tr_b16 v[234:235], v10 offset:43008
ds_read_b64_tr_b16 v[236:237], v11 offset:40960
v_mfma_f32_16x16x32_bf16 v[100:103], v[164:167], a[56:59], v[100:103]
ds_read_b64_tr_b16 v[238:239], v11 offset:43008
s_add_u32 s69, s69, 0x20000
buffer_load_dwordx4 a[16:19], v1, s[44:47], s69 offen sc1
v_mfma_f32_16x16x32_bf16 v[84:87], v[164:167], a[40:43], v[84:87]
ds_read_b64_tr_b16 v[240:241], v8 offset:45056
v_mfma_f32_16x16x32_bf16 v[88:91], v[168:171], a[40:43], v[88:91]
ds_read_b64_tr_b16 v[242:243], v8 offset:47104
v_mfma_f32_16x16x32_bf16 v[104:107], v[168:171], a[56:59], v[104:107]
ds_read_b64_tr_b16 v[244:245], v9 offset:45056
ds_read_b64_tr_b16 v[246:247], v9 offset:47104
buffer_load_dwordx4 a[20:23], v1, s[44:47], s69 offen offset:1024 sc1
v_mfma_f32_16x16x32_bf16 v[108:111], v[172:175], a[56:59], v[108:111]
ds_read_b64_tr_b16 v[248:249], v10 offset:45056
v_mfma_f32_16x16x32_bf16 v[92:95], v[172:175], a[40:43], v[92:95]
ds_read_b64_tr_b16 v[250:251], v10 offset:47104
buffer_load_dwordx4 a[24:27], v1, s[44:47], s69 offen offset:2048 sc1
v_mfma_f32_16x16x32_bf16 v[80:83], v[176:179], a[44:47], v[80:83]
ds_read_b64_tr_b16 v[252:253], v11 offset:45056
v_mfma_f32_16x16x32_bf16 v[96:99], v[176:179], a[60:63], v[96:99]
ds_read_b64_tr_b16 v[254:255], v11 offset:47104
buffer_load_dwordx4 a[28:31], v1, s[44:47], s69 offen offset:3072 sc1
v_mfma_f32_16x16x32_bf16 v[100:103], v[180:183], a[60:63], v[100:103]
v_mfma_f32_16x16x32_bf16 v[84:87], v[180:183], a[44:47], v[84:87]
v_mfma_f32_16x16x32_bf16 v[88:91], v[184:187], a[44:47], v[88:91]
v_mfma_f32_16x16x32_bf16 v[104:107], v[184:187], a[60:63], v[104:107]
v_mfma_f32_16x16x32_bf16 v[108:111], v[188:191], a[60:63], v[108:111]
s_waitcnt vmcnt(24) lgkmcnt(0)
v_mfma_f32_16x16x32_bf16 v[92:95], v[188:191], a[44:47], v[92:95]
s_barrier
v_mfma_f32_16x16x32_bf16 v[80:83], v[192:195], a[64:67], v[80:83]
ds_read_b64_tr_b16 v[128:129], v8 offset:49152
ds_read_b64_tr_b16 v[130:131], v8 offset:51200
s_add_u32 s71, s61, 10
s_and_b32 s71, s71, 7
s_or_b32 s71, s71, 8
s_lshl_b32 s71, s71, 18
s_add_u32 s71, s71, s94
s_add_u32 m0, s64, 131072
s_add_u32 s72, s71, 0
buffer_load_dwordx4 v4, s[24:27], s72 offen lds
v_mfma_f32_16x16x32_bf16 v[96:99], v[192:195], a[80:83], v[96:99]
ds_read_b64_tr_b16 v[132:133], v9 offset:49152
v_mfma_f32_16x16x32_bf16 v[100:103], v[196:199], a[80:83], v[100:103]
ds_read_b64_tr_b16 v[134:135], v9 offset:51200
s_add_u32 s72, s71, 15360
buffer_load_dwordx4 v4, s[24:27], s72 offen offset:1024 lds
v_mfma_f32_16x16x32_bf16 v[84:87], v[196:199], a[64:67], v[84:87]
ds_read_b64_tr_b16 v[136:137], v10 offset:49152
v_mfma_f32_16x16x32_bf16 v[88:91], v[200:203], a[64:67], v[88:91]
ds_read_b64_tr_b16 v[138:139], v10 offset:51200
ds_read_b64_tr_b16 v[140:141], v11 offset:49152
s_add_u32 s72, s71, 30720
buffer_load_dwordx4 v4, s[24:27], s72 offen offset:2048 lds
v_mfma_f32_16x16x32_bf16 v[104:107], v[200:203], a[80:83], v[104:107]
ds_read_b64_tr_b16 v[142:143], v11 offset:51200
v_mfma_f32_16x16x32_bf16 v[108:111], v[204:207], a[80:83], v[108:111]
ds_read_b64_tr_b16 v[144:145], v8 offset:53248
v_mfma_f32_16x16x32_bf16 v[92:95], v[204:207], a[64:67], v[92:95]
ds_read_b64_tr_b16 v[146:147], v8 offset:55296
s_add_u32 s72, s71, 46080
buffer_load_dwordx4 v4, s[24:27], s72 offen offset:3072 lds
v_mfma_f32_16x16x32_bf16 v[80:83], v[208:211], a[68:71], v[80:83]
ds_read_b64_tr_b16 v[148:149], v9 offset:53248
ds_read_b64_tr_b16 v[150:151], v9 offset:55296
v_mfma_f32_16x16x32_bf16 v[96:99], v[208:211], a[84:87], v[96:99]
ds_read_b64_tr_b16 v[152:153], v10 offset:53248
s_add_u32 s69, s61, 9
s_and_b32 s69, s69, 7
s_or_b32 s69, s69, 8
s_lshl_b32 s69, s69, 12
s_add_u32 s69, s69, s95
buffer_load_dwordx4 a[32:35], v1, s[44:47], s69 offen sc1
v_mfma_f32_16x16x32_bf16 v[100:103], v[212:215], a[84:87], v[100:103]
ds_read_b64_tr_b16 v[154:155], v10 offset:55296
v_mfma_f32_16x16x32_bf16 v[84:87], v[212:215], a[68:71], v[84:87]
ds_read_b64_tr_b16 v[156:157], v11 offset:53248
buffer_load_dwordx4 a[36:39], v1, s[44:47], s69 offen offset:1024 sc1
v_mfma_f32_16x16x32_bf16 v[88:91], v[216:219], a[68:71], v[88:91]
ds_read_b64_tr_b16 v[158:159], v11 offset:55296
v_mfma_f32_16x16x32_bf16 v[104:107], v[216:219], a[84:87], v[104:107]
ds_read_b64_tr_b16 v[160:161], v8 offset:57344
ds_read_b64_tr_b16 v[162:163], v8 offset:59392
v_mfma_f32_16x16x32_bf16 v[108:111], v[220:223], a[84:87], v[108:111]
ds_read_b64_tr_b16 v[164:165], v9 offset:57344
buffer_load_dwordx4 a[40:43], v1, s[44:47], s69 offen offset:2048 sc1
v_mfma_f32_16x16x32_bf16 v[92:95], v[220:223], a[68:71], v[92:95]
ds_read_b64_tr_b16 v[166:167], v9 offset:59392
v_mfma_f32_16x16x32_bf16 v[80:83], v[224:227], a[72:75], v[80:83]
ds_read_b64_tr_b16 v[168:169], v10 offset:57344
buffer_load_dwordx4 a[44:47], v1, s[44:47], s69 offen offset:3072 sc1
v_mfma_f32_16x16x32_bf16 v[96:99], v[224:227], a[88:91], v[96:99]
ds_read_b64_tr_b16 v[170:171], v10 offset:59392
ds_read_b64_tr_b16 v[172:173], v11 offset:57344
v_mfma_f32_16x16x32_bf16 v[100:103], v[228:231], a[88:91], v[100:103]
ds_read_b64_tr_b16 v[174:175], v11 offset:59392
s_add_u32 s69, s69, 0x20000
buffer_load_dwordx4 a[48:51], v1, s[44:47], s69 offen sc1
v_mfma_f32_16x16x32_bf16 v[84:87], v[228:231], a[72:75], v[84:87]
ds_read_b64_tr_b16 v[176:177], v8 offset:61440
v_mfma_f32_16x16x32_bf16 v[88:91], v[232:235], a[72:75], v[88:91]
ds_read_b64_tr_b16 v[178:179], v8 offset:63488
v_mfma_f32_16x16x32_bf16 v[104:107], v[232:235], a[88:91], v[104:107]
ds_read_b64_tr_b16 v[180:181], v9 offset:61440
ds_read_b64_tr_b16 v[182:183], v9 offset:63488
buffer_load_dwordx4 a[52:55], v1, s[44:47], s69 offen offset:1024 sc1
v_mfma_f32_16x16x32_bf16 v[108:111], v[236:239], a[88:91], v[108:111]
ds_read_b64_tr_b16 v[184:185], v10 offset:61440
v_mfma_f32_16x16x32_bf16 v[92:95], v[236:239], a[72:75], v[92:95]
ds_read_b64_tr_b16 v[186:187], v10 offset:63488
buffer_load_dwordx4 a[56:59], v1, s[44:47], s69 offen offset:2048 sc1
v_mfma_f32_16x16x32_bf16 v[80:83], v[240:243], a[76:79], v[80:83]
ds_read_b64_tr_b16 v[188:189], v11 offset:61440
v_mfma_f32_16x16x32_bf16 v[96:99], v[240:243], a[92:95], v[96:99]
ds_read_b64_tr_b16 v[190:191], v11 offset:63488
buffer_load_dwordx4 a[60:63], v1, s[44:47], s69 offen offset:3072 sc1
v_mfma_f32_16x16x32_bf16 v[100:103], v[244:247], a[92:95], v[100:103]
v_mfma_f32_16x16x32_bf16 v[84:87], v[244:247], a[76:79], v[84:87]
v_mfma_f32_16x16x32_bf16 v[88:91], v[248:251], a[76:79], v[88:91]
v_mfma_f32_16x16x32_bf16 v[104:107], v[248:251], a[92:95], v[104:107]
v_mfma_f32_16x16x32_bf16 v[108:111], v[252:255], a[92:95], v[108:111]
s_waitcnt vmcnt(24) lgkmcnt(0)
v_mfma_f32_16x16x32_bf16 v[92:95], v[252:255], a[76:79], v[92:95]
s_barrier
v_mfma_f32_16x16x32_bf16 v[80:83], v[128:131], a[96:99], v[80:83]
ds_read_b64_tr_b16 v[192:193], v8 offset:0
ds_read_b64_tr_b16 v[194:195], v8 offset:2048
s_add_u32 s71, s61, 11
s_and_b32 s71, s71, 7
s_or_b32 s71, s71, 8
s_lshl_b32 s71, s71, 18
s_add_u32 s71, s71, s94
s_add_u32 m0, s64, 147456
s_add_u32 s72, s71, 0
buffer_load_dwordx4 v4, s[24:27], s72 offen lds
v_mfma_f32_16x16x32_bf16 v[96:99], v[128:131], a[112:115], v[96:99]
ds_read_b64_tr_b16 v[196:197], v9 offset:0
v_mfma_f32_16x16x32_bf16 v[100:103], v[132:135], a[112:115], v[100:103]
ds_read_b64_tr_b16 v[198:199], v9 offset:2048
s_add_u32 s72, s71, 15360
buffer_load_dwordx4 v4, s[24:27], s72 offen offset:1024 lds
v_mfma_f32_16x16x32_bf16 v[84:87], v[132:135], a[96:99], v[84:87]
ds_read_b64_tr_b16 v[200:201], v10 offset:0
v_mfma_f32_16x16x32_bf16 v[88:91], v[136:139], a[96:99], v[88:91]
ds_read_b64_tr_b16 v[202:203], v10 offset:2048
ds_read_b64_tr_b16 v[204:205], v11 offset:0
s_add_u32 s72, s71, 30720
buffer_load_dwordx4 v4, s[24:27], s72 offen offset:2048 lds
v_mfma_f32_16x16x32_bf16 v[104:107], v[136:139], a[112:115], v[104:107]
ds_read_b64_tr_b16 v[206:207], v11 offset:2048
v_mfma_f32_16x16x32_bf16 v[108:111], v[140:143], a[112:115], v[108:111]
ds_read_b64_tr_b16 v[208:209], v8 offset:4096
v_mfma_f32_16x16x32_bf16 v[92:95], v[140:143], a[96:99], v[92:95]
ds_read_b64_tr_b16 v[210:211], v8 offset:6144
s_add_u32 s72, s71, 46080
buffer_load_dwordx4 v4, s[24:27], s72 offen offset:3072 lds
v_mfma_f32_16x16x32_bf16 v[80:83], v[144:147], a[100:103], v[80:83]
ds_read_b64_tr_b16 v[212:213], v9 offset:4096
ds_read_b64_tr_b16 v[214:215], v9 offset:6144
v_mfma_f32_16x16x32_bf16 v[96:99], v[144:147], a[116:119], v[96:99]
ds_read_b64_tr_b16 v[216:217], v10 offset:4096
s_add_u32 s69, s61, 10
s_and_b32 s69, s69, 7
s_or_b32 s69, s69, 8
s_lshl_b32 s69, s69, 12
s_add_u32 s69, s69, s95
buffer_load_dwordx4 a[64:67], v1, s[44:47], s69 offen sc1
v_mfma_f32_16x16x32_bf16 v[100:103], v[148:151], a[116:119], v[100:103]
ds_read_b64_tr_b16 v[218:219], v10 offset:6144
v_mfma_f32_16x16x32_bf16 v[84:87], v[148:151], a[100:103], v[84:87]
ds_read_b64_tr_b16 v[220:221], v11 offset:4096
buffer_load_dwordx4 a[68:71], v1, s[44:47], s69 offen offset:1024 sc1
v_mfma_f32_16x16x32_bf16 v[88:91], v[152:155], a[100:103], v[88:91]
ds_read_b64_tr_b16 v[222:223], v11 offset:6144
v_mfma_f32_16x16x32_bf16 v[104:107], v[152:155], a[116:119], v[104:107]
ds_read_b64_tr_b16 v[224:225], v8 offset:8192
ds_read_b64_tr_b16 v[226:227], v8 offset:10240
v_mfma_f32_16x16x32_bf16 v[108:111], v[156:159], a[116:119], v[108:111]
ds_read_b64_tr_b16 v[228:229], v9 offset:8192
buffer_load_dwordx4 a[72:75], v1, s[44:47], s69 offen offset:2048 sc1
v_mfma_f32_16x16x32_bf16 v[92:95], v[156:159], a[100:103], v[92:95]
ds_read_b64_tr_b16 v[230:231], v9 offset:10240
v_mfma_f32_16x16x32_bf16 v[80:83], v[160:163], a[104:107], v[80:83]
ds_read_b64_tr_b16 v[232:233], v10 offset:8192
buffer_load_dwordx4 a[76:79], v1, s[44:47], s69 offen offset:3072 sc1
v_mfma_f32_16x16x32_bf16 v[96:99], v[160:163], a[120:123], v[96:99]
ds_read_b64_tr_b16 v[234:235], v10 offset:10240
ds_read_b64_tr_b16 v[236:237], v11 offset:8192
v_mfma_f32_16x16x32_bf16 v[100:103], v[164:167], a[120:123], v[100:103]
ds_read_b64_tr_b16 v[238:239], v11 offset:10240
s_add_u32 s69, s69, 0x20000
buffer_load_dwordx4 a[80:83], v1, s[44:47], s69 offen sc1
v_mfma_f32_16x16x32_bf16 v[84:87], v[164:167], a[104:107], v[84:87]
ds_read_b64_tr_b16 v[240:241], v8 offset:12288
v_mfma_f32_16x16x32_bf16 v[88:91], v[168:171], a[104:107], v[88:91]
ds_read_b64_tr_b16 v[242:243], v8 offset:14336
v_mfma_f32_16x16x32_bf16 v[104:107], v[168:171], a[120:123], v[104:107]
ds_read_b64_tr_b16 v[244:245], v9 offset:12288
ds_read_b64_tr_b16 v[246:247], v9 offset:14336
buffer_load_dwordx4 a[84:87], v1, s[44:47], s69 offen offset:1024 sc1
v_mfma_f32_16x16x32_bf16 v[108:111], v[172:175], a[120:123], v[108:111]
ds_read_b64_tr_b16 v[248:249], v10 offset:12288
v_mfma_f32_16x16x32_bf16 v[92:95], v[172:175], a[104:107], v[92:95]
ds_read_b64_tr_b16 v[250:251], v10 offset:14336
buffer_load_dwordx4 a[88:91], v1, s[44:47], s69 offen offset:2048 sc1
v_mfma_f32_16x16x32_bf16 v[80:83], v[176:179], a[108:111], v[80:83]
ds_read_b64_tr_b16 v[252:253], v11 offset:12288
v_mfma_f32_16x16x32_bf16 v[96:99], v[176:179], a[124:127], v[96:99]
ds_read_b64_tr_b16 v[254:255], v11 offset:14336
buffer_load_dwordx4 a[92:95], v1, s[44:47], s69 offen offset:3072 sc1
v_mfma_f32_16x16x32_bf16 v[100:103], v[180:183], a[124:127], v[100:103]
v_mfma_f32_16x16x32_bf16 v[84:87], v[180:183], a[108:111], v[84:87]
v_mfma_f32_16x16x32_bf16 v[88:91], v[184:187], a[108:111], v[88:91]
v_mfma_f32_16x16x32_bf16 v[104:107], v[184:187], a[124:127], v[104:107]
v_mfma_f32_16x16x32_bf16 v[108:111], v[188:191], a[124:127], v[108:111]
s_waitcnt vmcnt(24) lgkmcnt(0)
v_mfma_f32_16x16x32_bf16 v[92:95], v[188:191], a[108:111], v[92:95]
s_barrier
v_mfma_f32_16x16x32_bf16 v[80:83], v[192:195], a[0:3], v[80:83]
ds_read_b64_tr_b16 v[128:129], v8 offset:16384
ds_read_b64_tr_b16 v[130:131], v8 offset:18432
s_add_u32 s71, s61, 12
s_and_b32 s71, s71, 7
s_or_b32 s71, s71, 8
s_lshl_b32 s71, s71, 18
s_add_u32 s71, s71, s94
s_add_u32 m0, s64, 98304
s_add_u32 s72, s71, 0
buffer_load_dwordx4 v4, s[24:27], s72 offen lds
v_mfma_f32_16x16x32_bf16 v[96:99], v[192:195], a[16:19], v[96:99]
ds_read_b64_tr_b16 v[132:133], v9 offset:16384
v_mfma_f32_16x16x32_bf16 v[100:103], v[196:199], a[16:19], v[100:103]
ds_read_b64_tr_b16 v[134:135], v9 offset:18432
s_add_u32 s72, s71, 15360
buffer_load_dwordx4 v4, s[24:27], s72 offen offset:1024 lds
v_mfma_f32_16x16x32_bf16 v[84:87], v[196:199], a[0:3], v[84:87]
ds_read_b64_tr_b16 v[136:137], v10 offset:16384
v_mfma_f32_16x16x32_bf16 v[88:91], v[200:203], a[0:3], v[88:91]
ds_read_b64_tr_b16 v[138:139], v10 offset:18432
ds_read_b64_tr_b16 v[140:141], v11 offset:16384
s_add_u32 s72, s71, 30720
buffer_load_dwordx4 v4, s[24:27], s72 offen offset:2048 lds
v_mfma_f32_16x16x32_bf16 v[104:107], v[200:203], a[16:19], v[104:107]
ds_read_b64_tr_b16 v[142:143], v11 offset:18432
v_mfma_f32_16x16x32_bf16 v[108:111], v[204:207], a[16:19], v[108:111]
ds_read_b64_tr_b16 v[144:145], v8 offset:20480
v_mfma_f32_16x16x32_bf16 v[92:95], v[204:207], a[0:3], v[92:95]
ds_read_b64_tr_b16 v[146:147], v8 offset:22528
s_add_u32 s72, s71, 46080
buffer_load_dwordx4 v4, s[24:27], s72 offen offset:3072 lds
v_mfma_f32_16x16x32_bf16 v[80:83], v[208:211], a[4:7], v[80:83]
ds_read_b64_tr_b16 v[148:149], v9 offset:20480
ds_read_b64_tr_b16 v[150:151], v9 offset:22528
v_mfma_f32_16x16x32_bf16 v[96:99], v[208:211], a[20:23], v[96:99]
ds_read_b64_tr_b16 v[152:153], v10 offset:20480
s_add_u32 s69, s61, 11
s_and_b32 s69, s69, 7
s_or_b32 s69, s69, 8
s_lshl_b32 s69, s69, 12
s_add_u32 s69, s69, s95
buffer_load_dwordx4 a[96:99], v1, s[44:47], s69 offen sc1
v_mfma_f32_16x16x32_bf16 v[100:103], v[212:215], a[20:23], v[100:103]
ds_read_b64_tr_b16 v[154:155], v10 offset:22528
v_mfma_f32_16x16x32_bf16 v[84:87], v[212:215], a[4:7], v[84:87]
ds_read_b64_tr_b16 v[156:157], v11 offset:20480
buffer_load_dwordx4 a[100:103], v1, s[44:47], s69 offen offset:1024 sc1
v_mfma_f32_16x16x32_bf16 v[88:91], v[216:219], a[4:7], v[88:91]
ds_read_b64_tr_b16 v[158:159], v11 offset:22528
v_mfma_f32_16x16x32_bf16 v[104:107], v[216:219], a[20:23], v[104:107]
ds_read_b64_tr_b16 v[160:161], v8 offset:24576
ds_read_b64_tr_b16 v[162:163], v8 offset:26624
v_mfma_f32_16x16x32_bf16 v[108:111], v[220:223], a[20:23], v[108:111]
ds_read_b64_tr_b16 v[164:165], v9 offset:24576
buffer_load_dwordx4 a[104:107], v1, s[44:47], s69 offen offset:2048 sc1
v_mfma_f32_16x16x32_bf16 v[92:95], v[220:223], a[4:7], v[92:95]
ds_read_b64_tr_b16 v[166:167], v9 offset:26624
v_mfma_f32_16x16x32_bf16 v[80:83], v[224:227], a[8:11], v[80:83]
ds_read_b64_tr_b16 v[168:169], v10 offset:24576
buffer_load_dwordx4 a[108:111], v1, s[44:47], s69 offen offset:3072 sc1
v_mfma_f32_16x16x32_bf16 v[96:99], v[224:227], a[24:27], v[96:99]
ds_read_b64_tr_b16 v[170:171], v10 offset:26624
ds_read_b64_tr_b16 v[172:173], v11 offset:24576
v_mfma_f32_16x16x32_bf16 v[100:103], v[228:231], a[24:27], v[100:103]
ds_read_b64_tr_b16 v[174:175], v11 offset:26624
s_add_u32 s69, s69, 0x20000
buffer_load_dwordx4 a[112:115], v1, s[44:47], s69 offen sc1
v_mfma_f32_16x16x32_bf16 v[84:87], v[228:231], a[8:11], v[84:87]
ds_read_b64_tr_b16 v[176:177], v8 offset:28672
v_mfma_f32_16x16x32_bf16 v[88:91], v[232:235], a[8:11], v[88:91]
ds_read_b64_tr_b16 v[178:179], v8 offset:30720
v_mfma_f32_16x16x32_bf16 v[104:107], v[232:235], a[24:27], v[104:107]
ds_read_b64_tr_b16 v[180:181], v9 offset:28672
ds_read_b64_tr_b16 v[182:183], v9 offset:30720
buffer_load_dwordx4 a[116:119], v1, s[44:47], s69 offen offset:1024 sc1
v_mfma_f32_16x16x32_bf16 v[108:111], v[236:239], a[24:27], v[108:111]
ds_read_b64_tr_b16 v[184:185], v10 offset:28672
v_mfma_f32_16x16x32_bf16 v[92:95], v[236:239], a[8:11], v[92:95]
ds_read_b64_tr_b16 v[186:187], v10 offset:30720
buffer_load_dwordx4 a[120:123], v1, s[44:47], s69 offen offset:2048 sc1
v_mfma_f32_16x16x32_bf16 v[80:83], v[240:243], a[12:15], v[80:83]
ds_read_b64_tr_b16 v[188:189], v11 offset:28672
v_mfma_f32_16x16x32_bf16 v[96:99], v[240:243], a[28:31], v[96:99]
ds_read_b64_tr_b16 v[190:191], v11 offset:30720
buffer_load_dwordx4 a[124:127], v1, s[44:47], s69 offen offset:3072 sc1
v_mfma_f32_16x16x32_bf16 v[100:103], v[244:247], a[28:31], v[100:103]
v_mfma_f32_16x16x32_bf16 v[84:87], v[244:247], a[12:15], v[84:87]
v_mfma_f32_16x16x32_bf16 v[88:91], v[248:251], a[12:15], v[88:91]
v_mfma_f32_16x16x32_bf16 v[104:107], v[248:251], a[28:31], v[104:107]
v_mfma_f32_16x16x32_bf16 v[108:111], v[252:255], a[28:31], v[108:111]
s_waitcnt vmcnt(24) lgkmcnt(0)
v_mfma_f32_16x16x32_bf16 v[92:95], v[252:255], a[12:15], v[92:95]
s_barrier
v_mfma_f32_16x16x32_bf16 v[80:83], v[128:131], a[32:35], v[80:83]
ds_read_b64_tr_b16 v[192:193], v8 offset:32768
ds_read_b64_tr_b16 v[194:195], v8 offset:34816
s_add_u32 s71, s61, 13
s_and_b32 s71, s71, 7
s_or_b32 s71, s71, 8
s_lshl_b32 s71, s71, 18
s_add_u32 s71, s71, s94
s_add_u32 m0, s64, 114688
s_add_u32 s72, s71, 0
buffer_load_dwordx4 v4, s[24:27], s72 offen lds
v_mfma_f32_16x16x32_bf16 v[96:99], v[128:131], a[48:51], v[96:99]
ds_read_b64_tr_b16 v[196:197], v9 offset:32768
v_mfma_f32_16x16x32_bf16 v[100:103], v[132:135], a[48:51], v[100:103]
ds_read_b64_tr_b16 v[198:199], v9 offset:34816
s_add_u32 s72, s71, 15360
buffer_load_dwordx4 v4, s[24:27], s72 offen offset:1024 lds
v_mfma_f32_16x16x32_bf16 v[84:87], v[132:135], a[32:35], v[84:87]
ds_read_b64_tr_b16 v[200:201], v10 offset:32768
v_mfma_f32_16x16x32_bf16 v[88:91], v[136:139], a[32:35], v[88:91]
ds_read_b64_tr_b16 v[202:203], v10 offset:34816
ds_read_b64_tr_b16 v[204:205], v11 offset:32768
s_add_u32 s72, s71, 30720
buffer_load_dwordx4 v4, s[24:27], s72 offen offset:2048 lds
v_mfma_f32_16x16x32_bf16 v[104:107], v[136:139], a[48:51], v[104:107]
ds_read_b64_tr_b16 v[206:207], v11 offset:34816
v_mfma_f32_16x16x32_bf16 v[108:111], v[140:143], a[48:51], v[108:111]
ds_read_b64_tr_b16 v[208:209], v8 offset:36864
v_mfma_f32_16x16x32_bf16 v[92:95], v[140:143], a[32:35], v[92:95]
ds_read_b64_tr_b16 v[210:211], v8 offset:38912
s_add_u32 s72, s71, 46080
buffer_load_dwordx4 v4, s[24:27], s72 offen offset:3072 lds
v_mfma_f32_16x16x32_bf16 v[80:83], v[144:147], a[36:39], v[80:83]
ds_read_b64_tr_b16 v[212:213], v9 offset:36864
ds_read_b64_tr_b16 v[214:215], v9 offset:38912
v_mfma_f32_16x16x32_bf16 v[96:99], v[144:147], a[52:55], v[96:99]
ds_read_b64_tr_b16 v[216:217], v10 offset:36864
s_add_u32 s69, s61, 12
s_and_b32 s69, s69, 7
s_or_b32 s69, s69, 8
s_lshl_b32 s69, s69, 12
s_add_u32 s69, s69, s95
buffer_load_dwordx4 a[0:3], v1, s[44:47], s69 offen sc1
v_mfma_f32_16x16x32_bf16 v[100:103], v[148:151], a[52:55], v[100:103]
ds_read_b64_tr_b16 v[218:219], v10 offset:38912
v_mfma_f32_16x16x32_bf16 v[84:87], v[148:151], a[36:39], v[84:87]
ds_read_b64_tr_b16 v[220:221], v11 offset:36864
buffer_load_dwordx4 a[4:7], v1, s[44:47], s69 offen offset:1024 sc1
v_mfma_f32_16x16x32_bf16 v[88:91], v[152:155], a[36:39], v[88:91]
ds_read_b64_tr_b16 v[222:223], v11 offset:38912
v_mfma_f32_16x16x32_bf16 v[104:107], v[152:155], a[52:55], v[104:107]
ds_read_b64_tr_b16 v[224:225], v8 offset:40960
ds_read_b64_tr_b16 v[226:227], v8 offset:43008
v_mfma_f32_16x16x32_bf16 v[108:111], v[156:159], a[52:55], v[108:111]
ds_read_b64_tr_b16 v[228:229], v9 offset:40960
buffer_load_dwordx4 a[8:11], v1, s[44:47], s69 offen offset:2048 sc1
v_mfma_f32_16x16x32_bf16 v[92:95], v[156:159], a[36:39], v[92:95]
ds_read_b64_tr_b16 v[230:231], v9 offset:43008
v_mfma_f32_16x16x32_bf16 v[80:83], v[160:163], a[40:43], v[80:83]
ds_read_b64_tr_b16 v[232:233], v10 offset:40960
buffer_load_dwordx4 a[12:15], v1, s[44:47], s69 offen offset:3072 sc1
v_mfma_f32_16x16x32_bf16 v[96:99], v[160:163], a[56:59], v[96:99]
ds_read_b64_tr_b16 v[234:235], v10 offset:43008
ds_read_b64_tr_b16 v[236:237], v11 offset:40960
v_mfma_f32_16x16x32_bf16 v[100:103], v[164:167], a[56:59], v[100:103]
ds_read_b64_tr_b16 v[238:239], v11 offset:43008
s_add_u32 s69, s69, 0x20000
buffer_load_dwordx4 a[16:19], v1, s[44:47], s69 offen sc1
v_mfma_f32_16x16x32_bf16 v[84:87], v[164:167], a[40:43], v[84:87]
ds_read_b64_tr_b16 v[240:241], v8 offset:45056
v_mfma_f32_16x16x32_bf16 v[88:91], v[168:171], a[40:43], v[88:91]
ds_read_b64_tr_b16 v[242:243], v8 offset:47104
v_mfma_f32_16x16x32_bf16 v[104:107], v[168:171], a[56:59], v[104:107]
ds_read_b64_tr_b16 v[244:245], v9 offset:45056
ds_read_b64_tr_b16 v[246:247], v9 offset:47104
buffer_load_dwordx4 a[20:23], v1, s[44:47], s69 offen offset:1024 sc1
v_mfma_f32_16x16x32_bf16 v[108:111], v[172:175], a[56:59], v[108:111]
ds_read_b64_tr_b16 v[248:249], v10 offset:45056
v_mfma_f32_16x16x32_bf16 v[92:95], v[172:175], a[40:43], v[92:95]
ds_read_b64_tr_b16 v[250:251], v10 offset:47104
buffer_load_dwordx4 a[24:27], v1, s[44:47], s69 offen offset:2048 sc1
v_mfma_f32_16x16x32_bf16 v[80:83], v[176:179], a[44:47], v[80:83]
ds_read_b64_tr_b16 v[252:253], v11 offset:45056
v_mfma_f32_16x16x32_bf16 v[96:99], v[176:179], a[60:63], v[96:99]
ds_read_b64_tr_b16 v[254:255], v11 offset:47104
buffer_load_dwordx4 a[28:31], v1, s[44:47], s69 offen offset:3072 sc1
v_mfma_f32_16x16x32_bf16 v[100:103], v[180:183], a[60:63], v[100:103]
v_mfma_f32_16x16x32_bf16 v[84:87], v[180:183], a[44:47], v[84:87]
v_mfma_f32_16x16x32_bf16 v[88:91], v[184:187], a[44:47], v[88:91]
v_mfma_f32_16x16x32_bf16 v[104:107], v[184:187], a[60:63], v[104:107]
v_mfma_f32_16x16x32_bf16 v[108:111], v[188:191], a[60:63], v[108:111]
s_waitcnt vmcnt(24) lgkmcnt(0)
v_mfma_f32_16x16x32_bf16 v[92:95], v[188:191], a[44:47], v[92:95]
s_barrier
v_mfma_f32_16x16x32_bf16 v[80:83], v[192:195], a[64:67], v[80:83]
ds_read_b64_tr_b16 v[128:129], v8 offset:49152
ds_read_b64_tr_b16 v[130:131], v8 offset:51200
s_add_u32 s71, s61, 14
s_and_b32 s71, s71, 7
s_or_b32 s71, s71, 8
s_lshl_b32 s71, s71, 18
s_add_u32 s71, s71, s94
s_add_u32 m0, s64, 131072
s_add_u32 s72, s71, 0
buffer_load_dwordx4 v4, s[24:27], s72 offen lds
v_mfma_f32_16x16x32_bf16 v[96:99], v[192:195], a[80:83], v[96:99]
ds_read_b64_tr_b16 v[132:133], v9 offset:49152
v_mfma_f32_16x16x32_bf16 v[100:103], v[196:199], a[80:83], v[100:103]
ds_read_b64_tr_b16 v[134:135], v9 offset:51200
s_add_u32 s72, s71, 15360
buffer_load_dwordx4 v4, s[24:27], s72 offen offset:1024 lds
v_mfma_f32_16x16x32_bf16 v[84:87], v[196:199], a[64:67], v[84:87]
ds_read_b64_tr_b16 v[136:137], v10 offset:49152
v_mfma_f32_16x16x32_bf16 v[88:91], v[200:203], a[64:67], v[88:91]
ds_read_b64_tr_b16 v[138:139], v10 offset:51200
ds_read_b64_tr_b16 v[140:141], v11 offset:49152
s_add_u32 s72, s71, 30720
buffer_load_dwordx4 v4, s[24:27], s72 offen offset:2048 lds
v_mfma_f32_16x16x32_bf16 v[104:107], v[200:203], a[80:83], v[104:107]
ds_read_b64_tr_b16 v[142:143], v11 offset:51200
v_mfma_f32_16x16x32_bf16 v[108:111], v[204:207], a[80:83], v[108:111]
ds_read_b64_tr_b16 v[144:145], v8 offset:53248
v_mfma_f32_16x16x32_bf16 v[92:95], v[204:207], a[64:67], v[92:95]
ds_read_b64_tr_b16 v[146:147], v8 offset:55296
s_add_u32 s72, s71, 46080
buffer_load_dwordx4 v4, s[24:27], s72 offen offset:3072 lds
v_mfma_f32_16x16x32_bf16 v[80:83], v[208:211], a[68:71], v[80:83]
ds_read_b64_tr_b16 v[148:149], v9 offset:53248
ds_read_b64_tr_b16 v[150:151], v9 offset:55296
v_mfma_f32_16x16x32_bf16 v[96:99], v[208:211], a[84:87], v[96:99]
ds_read_b64_tr_b16 v[152:153], v10 offset:53248
s_add_u32 s69, s61, 13
s_and_b32 s69, s69, 7
s_or_b32 s69, s69, 8
s_lshl_b32 s69, s69, 12
s_add_u32 s69, s69, s95
buffer_load_dwordx4 a[32:35], v1, s[44:47], s69 offen sc1
v_mfma_f32_16x16x32_bf16 v[100:103], v[212:215], a[84:87], v[100:103]
ds_read_b64_tr_b16 v[154:155], v10 offset:55296
v_mfma_f32_16x16x32_bf16 v[84:87], v[212:215], a[68:71], v[84:87]
ds_read_b64_tr_b16 v[156:157], v11 offset:53248
buffer_load_dwordx4 a[36:39], v1, s[44:47], s69 offen offset:1024 sc1
v_mfma_f32_16x16x32_bf16 v[88:91], v[216:219], a[68:71], v[88:91]
ds_read_b64_tr_b16 v[158:159], v11 offset:55296
v_mfma_f32_16x16x32_bf16 v[104:107], v[216:219], a[84:87], v[104:107]
ds_read_b64_tr_b16 v[160:161], v8 offset:57344
ds_read_b64_tr_b16 v[162:163], v8 offset:59392
v_mfma_f32_16x16x32_bf16 v[108:111], v[220:223], a[84:87], v[108:111]
ds_read_b64_tr_b16 v[164:165], v9 offset:57344
buffer_load_dwordx4 a[40:43], v1, s[44:47], s69 offen offset:2048 sc1
v_mfma_f32_16x16x32_bf16 v[92:95], v[220:223], a[68:71], v[92:95]
ds_read_b64_tr_b16 v[166:167], v9 offset:59392
v_mfma_f32_16x16x32_bf16 v[80:83], v[224:227], a[72:75], v[80:83]
ds_read_b64_tr_b16 v[168:169], v10 offset:57344
buffer_load_dwordx4 a[44:47], v1, s[44:47], s69 offen offset:3072 sc1
v_mfma_f32_16x16x32_bf16 v[96:99], v[224:227], a[88:91], v[96:99]
ds_read_b64_tr_b16 v[170:171], v10 offset:59392
ds_read_b64_tr_b16 v[172:173], v11 offset:57344
v_mfma_f32_16x16x32_bf16 v[100:103], v[228:231], a[88:91], v[100:103]
ds_read_b64_tr_b16 v[174:175], v11 offset:59392
s_add_u32 s69, s69, 0x20000
buffer_load_dwordx4 a[48:51], v1, s[44:47], s69 offen sc1
v_mfma_f32_16x16x32_bf16 v[84:87], v[228:231], a[72:75], v[84:87]
ds_read_b64_tr_b16 v[176:177], v8 offset:61440
v_mfma_f32_16x16x32_bf16 v[88:91], v[232:235], a[72:75], v[88:91]
ds_read_b64_tr_b16 v[178:179], v8 offset:63488
v_mfma_f32_16x16x32_bf16 v[104:107], v[232:235], a[88:91], v[104:107]
ds_read_b64_tr_b16 v[180:181], v9 offset:61440
ds_read_b64_tr_b16 v[182:183], v9 offset:63488
buffer_load_dwordx4 a[52:55], v1, s[44:47], s69 offen offset:1024 sc1
v_mfma_f32_16x16x32_bf16 v[108:111], v[236:239], a[88:91], v[108:111]
ds_read_b64_tr_b16 v[184:185], v10 offset:61440
v_mfma_f32_16x16x32_bf16 v[92:95], v[236:239], a[72:75], v[92:95]
ds_read_b64_tr_b16 v[186:187], v10 offset:63488
buffer_load_dwordx4 a[56:59], v1, s[44:47], s69 offen offset:2048 sc1
v_mfma_f32_16x16x32_bf16 v[80:83], v[240:243], a[76:79], v[80:83]
ds_read_b64_tr_b16 v[188:189], v11 offset:61440
v_mfma_f32_16x16x32_bf16 v[96:99], v[240:243], a[92:95], v[96:99]
ds_read_b64_tr_b16 v[190:191], v11 offset:63488
buffer_load_dwordx4 a[60:63], v1, s[44:47], s69 offen offset:3072 sc1
v_mfma_f32_16x16x32_bf16 v[100:103], v[244:247], a[92:95], v[100:103]
v_mfma_f32_16x16x32_bf16 v[84:87], v[244:247], a[76:79], v[84:87]
v_mfma_f32_16x16x32_bf16 v[88:91], v[248:251], a[76:79], v[88:91]
v_mfma_f32_16x16x32_bf16 v[104:107], v[248:251], a[92:95], v[104:107]
v_mfma_f32_16x16x32_bf16 v[108:111], v[252:255], a[92:95], v[108:111]
s_waitcnt vmcnt(24) lgkmcnt(0)
v_mfma_f32_16x16x32_bf16 v[92:95], v[252:255], a[76:79], v[92:95]
s_barrier
v_mfma_f32_16x16x32_bf16 v[80:83], v[128:131], a[96:99], v[80:83]
ds_read_b64_tr_b16 v[192:193], v8 offset:0
ds_read_b64_tr_b16 v[194:195], v8 offset:2048
s_add_u32 s71, s61, 15
s_and_b32 s71, s71, 7
s_or_b32 s71, s71, 8
s_lshl_b32 s71, s71, 18
s_add_u32 s71, s71, s94
s_add_u32 m0, s64, 147456
s_add_u32 s72, s71, 0
buffer_load_dwordx4 v4, s[24:27], s72 offen lds
v_mfma_f32_16x16x32_bf16 v[96:99], v[128:131], a[112:115], v[96:99]
ds_read_b64_tr_b16 v[196:197], v9 offset:0
v_mfma_f32_16x16x32_bf16 v[100:103], v[132:135], a[112:115], v[100:103]
ds_read_b64_tr_b16 v[198:199], v9 offset:2048
s_add_u32 s72, s71, 15360
buffer_load_dwordx4 v4, s[24:27], s72 offen offset:1024 lds
v_mfma_f32_16x16x32_bf16 v[84:87], v[132:135], a[96:99], v[84:87]
ds_read_b64_tr_b16 v[200:201], v10 offset:0
v_mfma_f32_16x16x32_bf16 v[88:91], v[136:139], a[96:99], v[88:91]
ds_read_b64_tr_b16 v[202:203], v10 offset:2048
ds_read_b64_tr_b16 v[204:205], v11 offset:0
s_add_u32 s72, s71, 30720
buffer_load_dwordx4 v4, s[24:27], s72 offen offset:2048 lds
v_mfma_f32_16x16x32_bf16 v[104:107], v[136:139], a[112:115], v[104:107]
ds_read_b64_tr_b16 v[206:207], v11 offset:2048
v_mfma_f32_16x16x32_bf16 v[108:111], v[140:143], a[112:115], v[108:111]
ds_read_b64_tr_b16 v[208:209], v8 offset:4096
v_mfma_f32_16x16x32_bf16 v[92:95], v[140:143], a[96:99], v[92:95]
ds_read_b64_tr_b16 v[210:211], v8 offset:6144
s_add_u32 s72, s71, 46080
buffer_load_dwordx4 v4, s[24:27], s72 offen offset:3072 lds
v_mfma_f32_16x16x32_bf16 v[80:83], v[144:147], a[100:103], v[80:83]
ds_read_b64_tr_b16 v[212:213], v9 offset:4096
ds_read_b64_tr_b16 v[214:215], v9 offset:6144
v_mfma_f32_16x16x32_bf16 v[96:99], v[144:147], a[116:119], v[96:99]
ds_read_b64_tr_b16 v[216:217], v10 offset:4096
s_add_u32 s69, s61, 14
s_and_b32 s69, s69, 7
s_or_b32 s69, s69, 8
s_lshl_b32 s69, s69, 12
s_add_u32 s69, s69, s95
buffer_load_dwordx4 a[64:67], v1, s[44:47], s69 offen sc1
v_mfma_f32_16x16x32_bf16 v[100:103], v[148:151], a[116:119], v[100:103]
ds_read_b64_tr_b16 v[218:219], v10 offset:6144
v_mfma_f32_16x16x32_bf16 v[84:87], v[148:151], a[100:103], v[84:87]
ds_read_b64_tr_b16 v[220:221], v11 offset:4096
buffer_load_dwordx4 a[68:71], v1, s[44:47], s69 offen offset:1024 sc1
v_mfma_f32_16x16x32_bf16 v[88:91], v[152:155], a[100:103], v[88:91]
ds_read_b64_tr_b16 v[222:223], v11 offset:6144
v_mfma_f32_16x16x32_bf16 v[104:107], v[152:155], a[116:119], v[104:107]
ds_read_b64_tr_b16 v[224:225], v8 offset:8192
ds_read_b64_tr_b16 v[226:227], v8 offset:10240
v_mfma_f32_16x16x32_bf16 v[108:111], v[156:159], a[116:119], v[108:111]
ds_read_b64_tr_b16 v[228:229], v9 offset:8192
buffer_load_dwordx4 a[72:75], v1, s[44:47], s69 offen offset:2048 sc1
v_mfma_f32_16x16x32_bf16 v[92:95], v[156:159], a[100:103], v[92:95]
ds_read_b64_tr_b16 v[230:231], v9 offset:10240
v_mfma_f32_16x16x32_bf16 v[80:83], v[160:163], a[104:107], v[80:83]
ds_read_b64_tr_b16 v[232:233], v10 offset:8192
buffer_load_dwordx4 a[76:79], v1, s[44:47], s69 offen offset:3072 sc1
v_mfma_f32_16x16x32_bf16 v[96:99], v[160:163], a[120:123], v[96:99]
ds_read_b64_tr_b16 v[234:235], v10 offset:10240
ds_read_b64_tr_b16 v[236:237], v11 offset:8192
v_mfma_f32_16x16x32_bf16 v[100:103], v[164:167], a[120:123], v[100:103]
ds_read_b64_tr_b16 v[238:239], v11 offset:10240
s_add_u32 s69, s69, 0x20000
buffer_load_dwordx4 a[80:83], v1, s[44:47], s69 offen sc1
v_mfma_f32_16x16x32_bf16 v[84:87], v[164:167], a[104:107], v[84:87]
ds_read_b64_tr_b16 v[240:241], v8 offset:12288
v_mfma_f32_16x16x32_bf16 v[88:91], v[168:171], a[104:107], v[88:91]
ds_read_b64_tr_b16 v[242:243], v8 offset:14336
v_mfma_f32_16x16x32_bf16 v[104:107], v[168:171], a[120:123], v[104:107]
ds_read_b64_tr_b16 v[244:245], v9 offset:12288
ds_read_b64_tr_b16 v[246:247], v9 offset:14336
buffer_load_dwordx4 a[84:87], v1, s[44:47], s69 offen offset:1024 sc1
v_mfma_f32_16x16x32_bf16 v[108:111], v[172:175], a[120:123], v[108:111]
ds_read_b64_tr_b16 v[248:249], v10 offset:12288
v_mfma_f32_16x16x32_bf16 v[92:95], v[172:175], a[104:107], v[92:95]
ds_read_b64_tr_b16 v[250:251], v10 offset:14336
buffer_load_dwordx4 a[88:91], v1, s[44:47], s69 offen offset:2048 sc1
v_mfma_f32_16x16x32_bf16 v[80:83], v[176:179], a[108:111], v[80:83]
ds_read_b64_tr_b16 v[252:253], v11 offset:12288
v_mfma_f32_16x16x32_bf16 v[96:99], v[176:179], a[124:127], v[96:99]
ds_read_b64_tr_b16 v[254:255], v11 offset:14336
buffer_load_dwordx4 a[92:95], v1, s[44:47], s69 offen offset:3072 sc1
v_mfma_f32_16x16x32_bf16 v[100:103], v[180:183], a[124:127], v[100:103]
v_mfma_f32_16x16x32_bf16 v[84:87], v[180:183], a[108:111], v[84:87]
v_mfma_f32_16x16x32_bf16 v[88:91], v[184:187], a[108:111], v[88:91]
v_mfma_f32_16x16x32_bf16 v[104:107], v[184:187], a[124:127], v[104:107]
v_mfma_f32_16x16x32_bf16 v[108:111], v[188:191], a[124:127], v[108:111]
s_waitcnt vmcnt(24) lgkmcnt(0)
v_mfma_f32_16x16x32_bf16 v[92:95], v[188:191], a[108:111], v[92:95]
s_barrier
v_mfma_f32_16x16x32_bf16 v[80:83], v[192:195], a[0:3], v[80:83]
ds_read_b64_tr_b16 v[128:129], v8 offset:16384
ds_read_b64_tr_b16 v[130:131], v8 offset:18432
s_add_u32 s71, s61, 16
s_and_b32 s71, s71, 7
s_or_b32 s71, s71, 16
s_lshl_b32 s71, s71, 18
s_add_u32 s71, s71, s94
s_add_u32 m0, s64, 98304
s_add_u32 s72, s71, 0
buffer_load_dwordx4 v4, s[24:27], s72 offen lds
v_mfma_f32_16x16x32_bf16 v[96:99], v[192:195], a[16:19], v[96:99]
ds_read_b64_tr_b16 v[132:133], v9 offset:16384
v_mfma_f32_16x16x32_bf16 v[100:103], v[196:199], a[16:19], v[100:103]
ds_read_b64_tr_b16 v[134:135], v9 offset:18432
s_add_u32 s72, s71, 15360
buffer_load_dwordx4 v4, s[24:27], s72 offen offset:1024 lds
v_mfma_f32_16x16x32_bf16 v[84:87], v[196:199], a[0:3], v[84:87]
ds_read_b64_tr_b16 v[136:137], v10 offset:16384
v_mfma_f32_16x16x32_bf16 v[88:91], v[200:203], a[0:3], v[88:91]
ds_read_b64_tr_b16 v[138:139], v10 offset:18432
ds_read_b64_tr_b16 v[140:141], v11 offset:16384
s_add_u32 s72, s71, 30720
buffer_load_dwordx4 v4, s[24:27], s72 offen offset:2048 lds
v_mfma_f32_16x16x32_bf16 v[104:107], v[200:203], a[16:19], v[104:107]
ds_read_b64_tr_b16 v[142:143], v11 offset:18432
v_mfma_f32_16x16x32_bf16 v[108:111], v[204:207], a[16:19], v[108:111]
ds_read_b64_tr_b16 v[144:145], v8 offset:20480
v_mfma_f32_16x16x32_bf16 v[92:95], v[204:207], a[0:3], v[92:95]
ds_read_b64_tr_b16 v[146:147], v8 offset:22528
s_add_u32 s72, s71, 46080
buffer_load_dwordx4 v4, s[24:27], s72 offen offset:3072 lds
v_mfma_f32_16x16x32_bf16 v[80:83], v[208:211], a[4:7], v[80:83]
ds_read_b64_tr_b16 v[148:149], v9 offset:20480
ds_read_b64_tr_b16 v[150:151], v9 offset:22528
v_mfma_f32_16x16x32_bf16 v[96:99], v[208:211], a[20:23], v[96:99]
ds_read_b64_tr_b16 v[152:153], v10 offset:20480
s_add_u32 s69, s61, 15
s_and_b32 s69, s69, 7
s_or_b32 s69, s69, 8
s_lshl_b32 s69, s69, 12
s_add_u32 s69, s69, s95
buffer_load_dwordx4 a[96:99], v1, s[44:47], s69 offen sc1
v_mfma_f32_16x16x32_bf16 v[100:103], v[212:215], a[20:23], v[100:103]
ds_read_b64_tr_b16 v[154:155], v10 offset:22528
v_mfma_f32_16x16x32_bf16 v[84:87], v[212:215], a[4:7], v[84:87]
ds_read_b64_tr_b16 v[156:157], v11 offset:20480
buffer_load_dwordx4 a[100:103], v1, s[44:47], s69 offen offset:1024 sc1
v_mfma_f32_16x16x32_bf16 v[88:91], v[216:219], a[4:7], v[88:91]
ds_read_b64_tr_b16 v[158:159], v11 offset:22528
v_mfma_f32_16x16x32_bf16 v[104:107], v[216:219], a[20:23], v[104:107]
ds_read_b64_tr_b16 v[160:161], v8 offset:24576
ds_read_b64_tr_b16 v[162:163], v8 offset:26624
v_mfma_f32_16x16x32_bf16 v[108:111], v[220:223], a[20:23], v[108:111]
ds_read_b64_tr_b16 v[164:165], v9 offset:24576
buffer_load_dwordx4 a[104:107], v1, s[44:47], s69 offen offset:2048 sc1
v_mfma_f32_16x16x32_bf16 v[92:95], v[220:223], a[4:7], v[92:95]
ds_read_b64_tr_b16 v[166:167], v9 offset:26624
v_mfma_f32_16x16x32_bf16 v[80:83], v[224:227], a[8:11], v[80:83]
ds_read_b64_tr_b16 v[168:169], v10 offset:24576
buffer_load_dwordx4 a[108:111], v1, s[44:47], s69 offen offset:3072 sc1
v_mfma_f32_16x16x32_bf16 v[96:99], v[224:227], a[24:27], v[96:99]
ds_read_b64_tr_b16 v[170:171], v10 offset:26624
ds_read_b64_tr_b16 v[172:173], v11 offset:24576
v_mfma_f32_16x16x32_bf16 v[100:103], v[228:231], a[24:27], v[100:103]
ds_read_b64_tr_b16 v[174:175], v11 offset:26624
s_add_u32 s69, s69, 0x20000
buffer_load_dwordx4 a[112:115], v1, s[44:47], s69 offen sc1
v_mfma_f32_16x16x32_bf16 v[84:87], v[228:231], a[8:11], v[84:87]
ds_read_b64_tr_b16 v[176:177], v8 offset:28672
v_mfma_f32_16x16x32_bf16 v[88:91], v[232:235], a[8:11], v[88:91]
ds_read_b64_tr_b16 v[178:179], v8 offset:30720
v_mfma_f32_16x16x32_bf16 v[104:107], v[232:235], a[24:27], v[104:107]
ds_read_b64_tr_b16 v[180:181], v9 offset:28672
ds_read_b64_tr_b16 v[182:183], v9 offset:30720
buffer_load_dwordx4 a[116:119], v1, s[44:47], s69 offen offset:1024 sc1
v_mfma_f32_16x16x32_bf16 v[108:111], v[236:239], a[24:27], v[108:111]
ds_read_b64_tr_b16 v[184:185], v10 offset:28672
v_mfma_f32_16x16x32_bf16 v[92:95], v[236:239], a[8:11], v[92:95]
ds_read_b64_tr_b16 v[186:187], v10 offset:30720
buffer_load_dwordx4 a[120:123], v1, s[44:47], s69 offen offset:2048 sc1
v_mfma_f32_16x16x32_bf16 v[80:83], v[240:243], a[12:15], v[80:83]
ds_read_b64_tr_b16 v[188:189], v11 offset:28672
v_mfma_f32_16x16x32_bf16 v[96:99], v[240:243], a[28:31], v[96:99]
ds_read_b64_tr_b16 v[190:191], v11 offset:30720
buffer_load_dwordx4 a[124:127], v1, s[44:47], s69 offen offset:3072 sc1
v_mfma_f32_16x16x32_bf16 v[100:103], v[244:247], a[28:31], v[100:103]
v_mfma_f32_16x16x32_bf16 v[84:87], v[244:247], a[12:15], v[84:87]
v_mfma_f32_16x16x32_bf16 v[88:91], v[248:251], a[12:15], v[88:91]
v_mfma_f32_16x16x32_bf16 v[104:107], v[248:251], a[28:31], v[104:107]
v_mfma_f32_16x16x32_bf16 v[108:111], v[252:255], a[28:31], v[108:111]
s_waitcnt vmcnt(24) lgkmcnt(0)
v_mfma_f32_16x16x32_bf16 v[92:95], v[252:255], a[12:15], v[92:95]
s_barrier
v_mfma_f32_16x16x32_bf16 v[80:83], v[128:131], a[32:35], v[80:83]
ds_read_b64_tr_b16 v[192:193], v8 offset:32768
ds_read_b64_tr_b16 v[194:195], v8 offset:34816
s_add_u32 s71, s61, 17
s_and_b32 s71, s71, 7
s_or_b32 s71, s71, 16
s_lshl_b32 s71, s71, 18
s_add_u32 s71, s71, s94
s_add_u32 m0, s64, 114688
s_add_u32 s72, s71, 0
buffer_load_dwordx4 v4, s[24:27], s72 offen lds
v_mfma_f32_16x16x32_bf16 v[96:99], v[128:131], a[48:51], v[96:99]
ds_read_b64_tr_b16 v[196:197], v9 offset:32768
v_mfma_f32_16x16x32_bf16 v[100:103], v[132:135], a[48:51], v[100:103]
ds_read_b64_tr_b16 v[198:199], v9 offset:34816
s_add_u32 s72, s71, 15360
buffer_load_dwordx4 v4, s[24:27], s72 offen offset:1024 lds
v_mfma_f32_16x16x32_bf16 v[84:87], v[132:135], a[32:35], v[84:87]
ds_read_b64_tr_b16 v[200:201], v10 offset:32768
v_mfma_f32_16x16x32_bf16 v[88:91], v[136:139], a[32:35], v[88:91]
ds_read_b64_tr_b16 v[202:203], v10 offset:34816
ds_read_b64_tr_b16 v[204:205], v11 offset:32768
s_add_u32 s72, s71, 30720
buffer_load_dwordx4 v4, s[24:27], s72 offen offset:2048 lds
v_mfma_f32_16x16x32_bf16 v[104:107], v[136:139], a[48:51], v[104:107]
ds_read_b64_tr_b16 v[206:207], v11 offset:34816
v_mfma_f32_16x16x32_bf16 v[108:111], v[140:143], a[48:51], v[108:111]
ds_read_b64_tr_b16 v[208:209], v8 offset:36864
v_mfma_f32_16x16x32_bf16 v[92:95], v[140:143], a[32:35], v[92:95]
ds_read_b64_tr_b16 v[210:211], v8 offset:38912
s_add_u32 s72, s71, 46080
buffer_load_dwordx4 v4, s[24:27], s72 offen offset:3072 lds
v_mfma_f32_16x16x32_bf16 v[80:83], v[144:147], a[36:39], v[80:83]
ds_read_b64_tr_b16 v[212:213], v9 offset:36864
ds_read_b64_tr_b16 v[214:215], v9 offset:38912
v_mfma_f32_16x16x32_bf16 v[96:99], v[144:147], a[52:55], v[96:99]
ds_read_b64_tr_b16 v[216:217], v10 offset:36864
s_add_u32 s69, s61, 16
s_and_b32 s69, s69, 7
s_or_b32 s69, s69, 16
s_lshl_b32 s69, s69, 12
s_add_u32 s69, s69, s95
buffer_load_dwordx4 a[0:3], v1, s[44:47], s69 offen sc1
v_mfma_f32_16x16x32_bf16 v[100:103], v[148:151], a[52:55], v[100:103]
ds_read_b64_tr_b16 v[218:219], v10 offset:38912
v_mfma_f32_16x16x32_bf16 v[84:87], v[148:151], a[36:39], v[84:87]
ds_read_b64_tr_b16 v[220:221], v11 offset:36864
buffer_load_dwordx4 a[4:7], v1, s[44:47], s69 offen offset:1024 sc1
v_mfma_f32_16x16x32_bf16 v[88:91], v[152:155], a[36:39], v[88:91]
ds_read_b64_tr_b16 v[222:223], v11 offset:38912
v_mfma_f32_16x16x32_bf16 v[104:107], v[152:155], a[52:55], v[104:107]
ds_read_b64_tr_b16 v[224:225], v8 offset:40960
ds_read_b64_tr_b16 v[226:227], v8 offset:43008
v_mfma_f32_16x16x32_bf16 v[108:111], v[156:159], a[52:55], v[108:111]
ds_read_b64_tr_b16 v[228:229], v9 offset:40960
buffer_load_dwordx4 a[8:11], v1, s[44:47], s69 offen offset:2048 sc1
v_mfma_f32_16x16x32_bf16 v[92:95], v[156:159], a[36:39], v[92:95]
ds_read_b64_tr_b16 v[230:231], v9 offset:43008
v_mfma_f32_16x16x32_bf16 v[80:83], v[160:163], a[40:43], v[80:83]
ds_read_b64_tr_b16 v[232:233], v10 offset:40960
buffer_load_dwordx4 a[12:15], v1, s[44:47], s69 offen offset:3072 sc1
v_mfma_f32_16x16x32_bf16 v[96:99], v[160:163], a[56:59], v[96:99]
ds_read_b64_tr_b16 v[234:235], v10 offset:43008
ds_read_b64_tr_b16 v[236:237], v11 offset:40960
v_mfma_f32_16x16x32_bf16 v[100:103], v[164:167], a[56:59], v[100:103]
ds_read_b64_tr_b16 v[238:239], v11 offset:43008
s_add_u32 s69, s69, 0x20000
buffer_load_dwordx4 a[16:19], v1, s[44:47], s69 offen sc1
v_mfma_f32_16x16x32_bf16 v[84:87], v[164:167], a[40:43], v[84:87]
ds_read_b64_tr_b16 v[240:241], v8 offset:45056
v_mfma_f32_16x16x32_bf16 v[88:91], v[168:171], a[40:43], v[88:91]
ds_read_b64_tr_b16 v[242:243], v8 offset:47104
v_mfma_f32_16x16x32_bf16 v[104:107], v[168:171], a[56:59], v[104:107]
ds_read_b64_tr_b16 v[244:245], v9 offset:45056
ds_read_b64_tr_b16 v[246:247], v9 offset:47104
buffer_load_dwordx4 a[20:23], v1, s[44:47], s69 offen offset:1024 sc1
v_mfma_f32_16x16x32_bf16 v[108:111], v[172:175], a[56:59], v[108:111]
ds_read_b64_tr_b16 v[248:249], v10 offset:45056
v_mfma_f32_16x16x32_bf16 v[92:95], v[172:175], a[40:43], v[92:95]
ds_read_b64_tr_b16 v[250:251], v10 offset:47104
buffer_load_dwordx4 a[24:27], v1, s[44:47], s69 offen offset:2048 sc1
v_mfma_f32_16x16x32_bf16 v[80:83], v[176:179], a[44:47], v[80:83]
ds_read_b64_tr_b16 v[252:253], v11 offset:45056
v_mfma_f32_16x16x32_bf16 v[96:99], v[176:179], a[60:63], v[96:99]
ds_read_b64_tr_b16 v[254:255], v11 offset:47104
buffer_load_dwordx4 a[28:31], v1, s[44:47], s69 offen offset:3072 sc1
v_mfma_f32_16x16x32_bf16 v[100:103], v[180:183], a[60:63], v[100:103]
v_mfma_f32_16x16x32_bf16 v[84:87], v[180:183], a[44:47], v[84:87]
v_mfma_f32_16x16x32_bf16 v[88:91], v[184:187], a[44:47], v[88:91]
v_mfma_f32_16x16x32_bf16 v[104:107], v[184:187], a[60:63], v[104:107]
v_mfma_f32_16x16x32_bf16 v[108:111], v[188:191], a[60:63], v[108:111]
s_waitcnt vmcnt(24) lgkmcnt(0)
v_mfma_f32_16x16x32_bf16 v[92:95], v[188:191], a[44:47], v[92:95]
s_barrier
v_mfma_f32_16x16x32_bf16 v[80:83], v[192:195], a[64:67], v[80:83]
ds_read_b64_tr_b16 v[128:129], v8 offset:49152
ds_read_b64_tr_b16 v[130:131], v8 offset:51200
s_add_u32 s71, s61, 18
s_and_b32 s71, s71, 7
s_or_b32 s71, s71, 16
s_lshl_b32 s71, s71, 18
s_add_u32 s71, s71, s94
s_add_u32 m0, s64, 131072
s_add_u32 s72, s71, 0
buffer_load_dwordx4 v4, s[24:27], s72 offen lds
v_mfma_f32_16x16x32_bf16 v[96:99], v[192:195], a[80:83], v[96:99]
ds_read_b64_tr_b16 v[132:133], v9 offset:49152
v_mfma_f32_16x16x32_bf16 v[100:103], v[196:199], a[80:83], v[100:103]
ds_read_b64_tr_b16 v[134:135], v9 offset:51200
s_add_u32 s72, s71, 15360
buffer_load_dwordx4 v4, s[24:27], s72 offen offset:1024 lds
v_mfma_f32_16x16x32_bf16 v[84:87], v[196:199], a[64:67], v[84:87]
ds_read_b64_tr_b16 v[136:137], v10 offset:49152
v_mfma_f32_16x16x32_bf16 v[88:91], v[200:203], a[64:67], v[88:91]
ds_read_b64_tr_b16 v[138:139], v10 offset:51200
ds_read_b64_tr_b16 v[140:141], v11 offset:49152
s_add_u32 s72, s71, 30720
buffer_load_dwordx4 v4, s[24:27], s72 offen offset:2048 lds
v_mfma_f32_16x16x32_bf16 v[104:107], v[200:203], a[80:83], v[104:107]
ds_read_b64_tr_b16 v[142:143], v11 offset:51200
v_mfma_f32_16x16x32_bf16 v[108:111], v[204:207], a[80:83], v[108:111]
ds_read_b64_tr_b16 v[144:145], v8 offset:53248
v_mfma_f32_16x16x32_bf16 v[92:95], v[204:207], a[64:67], v[92:95]
ds_read_b64_tr_b16 v[146:147], v8 offset:55296
s_add_u32 s72, s71, 46080
buffer_load_dwordx4 v4, s[24:27], s72 offen offset:3072 lds
v_mfma_f32_16x16x32_bf16 v[80:83], v[208:211], a[68:71], v[80:83]
ds_read_b64_tr_b16 v[148:149], v9 offset:53248
ds_read_b64_tr_b16 v[150:151], v9 offset:55296
v_mfma_f32_16x16x32_bf16 v[96:99], v[208:211], a[84:87], v[96:99]
ds_read_b64_tr_b16 v[152:153], v10 offset:53248
s_add_u32 s69, s61, 17
s_and_b32 s69, s69, 7
s_or_b32 s69, s69, 16
s_lshl_b32 s69, s69, 12
s_add_u32 s69, s69, s95
buffer_load_dwordx4 a[32:35], v1, s[44:47], s69 offen sc1
v_mfma_f32_16x16x32_bf16 v[100:103], v[212:215], a[84:87], v[100:103]
ds_read_b64_tr_b16 v[154:155], v10 offset:55296
v_mfma_f32_16x16x32_bf16 v[84:87], v[212:215], a[68:71], v[84:87]
ds_read_b64_tr_b16 v[156:157], v11 offset:53248
buffer_load_dwordx4 a[36:39], v1, s[44:47], s69 offen offset:1024 sc1
v_mfma_f32_16x16x32_bf16 v[88:91], v[216:219], a[68:71], v[88:91]
ds_read_b64_tr_b16 v[158:159], v11 offset:55296
v_mfma_f32_16x16x32_bf16 v[104:107], v[216:219], a[84:87], v[104:107]
ds_read_b64_tr_b16 v[160:161], v8 offset:57344
ds_read_b64_tr_b16 v[162:163], v8 offset:59392
v_mfma_f32_16x16x32_bf16 v[108:111], v[220:223], a[84:87], v[108:111]
ds_read_b64_tr_b16 v[164:165], v9 offset:57344
buffer_load_dwordx4 a[40:43], v1, s[44:47], s69 offen offset:2048 sc1
v_mfma_f32_16x16x32_bf16 v[92:95], v[220:223], a[68:71], v[92:95]
ds_read_b64_tr_b16 v[166:167], v9 offset:59392
v_mfma_f32_16x16x32_bf16 v[80:83], v[224:227], a[72:75], v[80:83]
ds_read_b64_tr_b16 v[168:169], v10 offset:57344
buffer_load_dwordx4 a[44:47], v1, s[44:47], s69 offen offset:3072 sc1
v_mfma_f32_16x16x32_bf16 v[96:99], v[224:227], a[88:91], v[96:99]
ds_read_b64_tr_b16 v[170:171], v10 offset:59392
ds_read_b64_tr_b16 v[172:173], v11 offset:57344
v_mfma_f32_16x16x32_bf16 v[100:103], v[228:231], a[88:91], v[100:103]
ds_read_b64_tr_b16 v[174:175], v11 offset:59392
s_add_u32 s69, s69, 0x20000
buffer_load_dwordx4 a[48:51], v1, s[44:47], s69 offen sc1
v_mfma_f32_16x16x32_bf16 v[84:87], v[228:231], a[72:75], v[84:87]
ds_read_b64_tr_b16 v[176:177], v8 offset:61440
v_mfma_f32_16x16x32_bf16 v[88:91], v[232:235], a[72:75], v[88:91]
ds_read_b64_tr_b16 v[178:179], v8 offset:63488
v_mfma_f32_16x16x32_bf16 v[104:107], v[232:235], a[88:91], v[104:107]
ds_read_b64_tr_b16 v[180:181], v9 offset:61440
ds_read_b64_tr_b16 v[182:183], v9 offset:63488
buffer_load_dwordx4 a[52:55], v1, s[44:47], s69 offen offset:1024 sc1
v_mfma_f32_16x16x32_bf16 v[108:111], v[236:239], a[88:91], v[108:111]
ds_read_b64_tr_b16 v[184:185], v10 offset:61440
v_mfma_f32_16x16x32_bf16 v[92:95], v[236:239], a[72:75], v[92:95]
ds_read_b64_tr_b16 v[186:187], v10 offset:63488
buffer_load_dwordx4 a[56:59], v1, s[44:47], s69 offen offset:2048 sc1
v_mfma_f32_16x16x32_bf16 v[80:83], v[240:243], a[76:79], v[80:83]
ds_read_b64_tr_b16 v[188:189], v11 offset:61440
v_mfma_f32_16x16x32_bf16 v[96:99], v[240:243], a[92:95], v[96:99]
ds_read_b64_tr_b16 v[190:191], v11 offset:63488
buffer_load_dwordx4 a[60:63], v1, s[44:47], s69 offen offset:3072 sc1
v_mfma_f32_16x16x32_bf16 v[100:103], v[244:247], a[92:95], v[100:103]
v_mfma_f32_16x16x32_bf16 v[84:87], v[244:247], a[76:79], v[84:87]
v_mfma_f32_16x16x32_bf16 v[88:91], v[248:251], a[76:79], v[88:91]
v_mfma_f32_16x16x32_bf16 v[104:107], v[248:251], a[92:95], v[104:107]
v_mfma_f32_16x16x32_bf16 v[108:111], v[252:255], a[92:95], v[108:111]
s_waitcnt vmcnt(24) lgkmcnt(0)
v_mfma_f32_16x16x32_bf16 v[92:95], v[252:255], a[76:79], v[92:95]
s_barrier
v_mfma_f32_16x16x32_bf16 v[80:83], v[128:131], a[96:99], v[80:83]
ds_read_b64_tr_b16 v[192:193], v8 offset:0
ds_read_b64_tr_b16 v[194:195], v8 offset:2048
s_add_u32 s71, s61, 19
s_and_b32 s71, s71, 7
s_or_b32 s71, s71, 16
s_lshl_b32 s71, s71, 18
s_add_u32 s71, s71, s94
s_add_u32 m0, s64, 147456
s_add_u32 s72, s71, 0
buffer_load_dwordx4 v4, s[24:27], s72 offen lds
v_mfma_f32_16x16x32_bf16 v[96:99], v[128:131], a[112:115], v[96:99]
ds_read_b64_tr_b16 v[196:197], v9 offset:0
v_mfma_f32_16x16x32_bf16 v[100:103], v[132:135], a[112:115], v[100:103]
ds_read_b64_tr_b16 v[198:199], v9 offset:2048
s_add_u32 s72, s71, 15360
buffer_load_dwordx4 v4, s[24:27], s72 offen offset:1024 lds
v_mfma_f32_16x16x32_bf16 v[84:87], v[132:135], a[96:99], v[84:87]
ds_read_b64_tr_b16 v[200:201], v10 offset:0
v_mfma_f32_16x16x32_bf16 v[88:91], v[136:139], a[96:99], v[88:91]
ds_read_b64_tr_b16 v[202:203], v10 offset:2048
ds_read_b64_tr_b16 v[204:205], v11 offset:0
s_add_u32 s72, s71, 30720
buffer_load_dwordx4 v4, s[24:27], s72 offen offset:2048 lds
v_mfma_f32_16x16x32_bf16 v[104:107], v[136:139], a[112:115], v[104:107]
ds_read_b64_tr_b16 v[206:207], v11 offset:2048
v_mfma_f32_16x16x32_bf16 v[108:111], v[140:143], a[112:115], v[108:111]
ds_read_b64_tr_b16 v[208:209], v8 offset:4096
v_mfma_f32_16x16x32_bf16 v[92:95], v[140:143], a[96:99], v[92:95]
ds_read_b64_tr_b16 v[210:211], v8 offset:6144
s_add_u32 s72, s71, 46080
buffer_load_dwordx4 v4, s[24:27], s72 offen offset:3072 lds
v_mfma_f32_16x16x32_bf16 v[80:83], v[144:147], a[100:103], v[80:83]
ds_read_b64_tr_b16 v[212:213], v9 offset:4096
ds_read_b64_tr_b16 v[214:215], v9 offset:6144
v_mfma_f32_16x16x32_bf16 v[96:99], v[144:147], a[116:119], v[96:99]
ds_read_b64_tr_b16 v[216:217], v10 offset:4096
s_add_u32 s69, s61, 18
s_and_b32 s69, s69, 7
s_or_b32 s69, s69, 16
s_lshl_b32 s69, s69, 12
s_add_u32 s69, s69, s95
buffer_load_dwordx4 a[64:67], v1, s[44:47], s69 offen sc1
v_mfma_f32_16x16x32_bf16 v[100:103], v[148:151], a[116:119], v[100:103]
ds_read_b64_tr_b16 v[218:219], v10 offset:6144
v_mfma_f32_16x16x32_bf16 v[84:87], v[148:151], a[100:103], v[84:87]
ds_read_b64_tr_b16 v[220:221], v11 offset:4096
buffer_load_dwordx4 a[68:71], v1, s[44:47], s69 offen offset:1024 sc1
v_mfma_f32_16x16x32_bf16 v[88:91], v[152:155], a[100:103], v[88:91]
ds_read_b64_tr_b16 v[222:223], v11 offset:6144
v_mfma_f32_16x16x32_bf16 v[104:107], v[152:155], a[116:119], v[104:107]
ds_read_b64_tr_b16 v[224:225], v8 offset:8192
ds_read_b64_tr_b16 v[226:227], v8 offset:10240
v_mfma_f32_16x16x32_bf16 v[108:111], v[156:159], a[116:119], v[108:111]
ds_read_b64_tr_b16 v[228:229], v9 offset:8192
buffer_load_dwordx4 a[72:75], v1, s[44:47], s69 offen offset:2048 sc1
v_mfma_f32_16x16x32_bf16 v[92:95], v[156:159], a[100:103], v[92:95]
ds_read_b64_tr_b16 v[230:231], v9 offset:10240
v_mfma_f32_16x16x32_bf16 v[80:83], v[160:163], a[104:107], v[80:83]
ds_read_b64_tr_b16 v[232:233], v10 offset:8192
buffer_load_dwordx4 a[76:79], v1, s[44:47], s69 offen offset:3072 sc1
v_mfma_f32_16x16x32_bf16 v[96:99], v[160:163], a[120:123], v[96:99]
ds_read_b64_tr_b16 v[234:235], v10 offset:10240
ds_read_b64_tr_b16 v[236:237], v11 offset:8192
v_mfma_f32_16x16x32_bf16 v[100:103], v[164:167], a[120:123], v[100:103]
ds_read_b64_tr_b16 v[238:239], v11 offset:10240
s_add_u32 s69, s69, 0x20000
buffer_load_dwordx4 a[80:83], v1, s[44:47], s69 offen sc1
v_mfma_f32_16x16x32_bf16 v[84:87], v[164:167], a[104:107], v[84:87]
ds_read_b64_tr_b16 v[240:241], v8 offset:12288
v_mfma_f32_16x16x32_bf16 v[88:91], v[168:171], a[104:107], v[88:91]
ds_read_b64_tr_b16 v[242:243], v8 offset:14336
v_mfma_f32_16x16x32_bf16 v[104:107], v[168:171], a[120:123], v[104:107]
ds_read_b64_tr_b16 v[244:245], v9 offset:12288
ds_read_b64_tr_b16 v[246:247], v9 offset:14336
buffer_load_dwordx4 a[84:87], v1, s[44:47], s69 offen offset:1024 sc1
v_mfma_f32_16x16x32_bf16 v[108:111], v[172:175], a[120:123], v[108:111]
ds_read_b64_tr_b16 v[248:249], v10 offset:12288
v_mfma_f32_16x16x32_bf16 v[92:95], v[172:175], a[104:107], v[92:95]
ds_read_b64_tr_b16 v[250:251], v10 offset:14336
buffer_load_dwordx4 a[88:91], v1, s[44:47], s69 offen offset:2048 sc1
v_mfma_f32_16x16x32_bf16 v[80:83], v[176:179], a[108:111], v[80:83]
ds_read_b64_tr_b16 v[252:253], v11 offset:12288
v_mfma_f32_16x16x32_bf16 v[96:99], v[176:179], a[124:127], v[96:99]
ds_read_b64_tr_b16 v[254:255], v11 offset:14336
buffer_load_dwordx4 a[92:95], v1, s[44:47], s69 offen offset:3072 sc1
v_mfma_f32_16x16x32_bf16 v[100:103], v[180:183], a[124:127], v[100:103]
v_mfma_f32_16x16x32_bf16 v[84:87], v[180:183], a[108:111], v[84:87]
v_mfma_f32_16x16x32_bf16 v[88:91], v[184:187], a[108:111], v[88:91]
v_mfma_f32_16x16x32_bf16 v[104:107], v[184:187], a[124:127], v[104:107]
v_mfma_f32_16x16x32_bf16 v[108:111], v[188:191], a[124:127], v[108:111]
s_waitcnt vmcnt(24) lgkmcnt(0)
v_mfma_f32_16x16x32_bf16 v[92:95], v[188:191], a[108:111], v[92:95]
s_barrier
v_mfma_f32_16x16x32_bf16 v[80:83], v[192:195], a[0:3], v[80:83]
ds_read_b64_tr_b16 v[128:129], v8 offset:16384
ds_read_b64_tr_b16 v[130:131], v8 offset:18432
s_add_u32 s71, s61, 20
s_and_b32 s71, s71, 7
s_or_b32 s71, s71, 16
s_lshl_b32 s71, s71, 18
s_add_u32 s71, s71, s94
s_add_u32 m0, s64, 98304
s_add_u32 s72, s71, 0
buffer_load_dwordx4 v4, s[24:27], s72 offen lds
v_mfma_f32_16x16x32_bf16 v[96:99], v[192:195], a[16:19], v[96:99]
ds_read_b64_tr_b16 v[132:133], v9 offset:16384
v_mfma_f32_16x16x32_bf16 v[100:103], v[196:199], a[16:19], v[100:103]
ds_read_b64_tr_b16 v[134:135], v9 offset:18432
s_add_u32 s72, s71, 15360
buffer_load_dwordx4 v4, s[24:27], s72 offen offset:1024 lds
v_mfma_f32_16x16x32_bf16 v[84:87], v[196:199], a[0:3], v[84:87]
ds_read_b64_tr_b16 v[136:137], v10 offset:16384
v_mfma_f32_16x16x32_bf16 v[88:91], v[200:203], a[0:3], v[88:91]
ds_read_b64_tr_b16 v[138:139], v10 offset:18432
ds_read_b64_tr_b16 v[140:141], v11 offset:16384
s_add_u32 s72, s71, 30720
buffer_load_dwordx4 v4, s[24:27], s72 offen offset:2048 lds
v_mfma_f32_16x16x32_bf16 v[104:107], v[200:203], a[16:19], v[104:107]
ds_read_b64_tr_b16 v[142:143], v11 offset:18432
v_mfma_f32_16x16x32_bf16 v[108:111], v[204:207], a[16:19], v[108:111]
ds_read_b64_tr_b16 v[144:145], v8 offset:20480
v_mfma_f32_16x16x32_bf16 v[92:95], v[204:207], a[0:3], v[92:95]
ds_read_b64_tr_b16 v[146:147], v8 offset:22528
s_add_u32 s72, s71, 46080
buffer_load_dwordx4 v4, s[24:27], s72 offen offset:3072 lds
v_mfma_f32_16x16x32_bf16 v[80:83], v[208:211], a[4:7], v[80:83]
ds_read_b64_tr_b16 v[148:149], v9 offset:20480
ds_read_b64_tr_b16 v[150:151], v9 offset:22528
v_mfma_f32_16x16x32_bf16 v[96:99], v[208:211], a[20:23], v[96:99]
ds_read_b64_tr_b16 v[152:153], v10 offset:20480
s_add_u32 s69, s61, 19
s_and_b32 s69, s69, 7
s_or_b32 s69, s69, 16
s_lshl_b32 s69, s69, 12
s_add_u32 s69, s69, s95
buffer_load_dwordx4 a[96:99], v1, s[44:47], s69 offen sc1
v_mfma_f32_16x16x32_bf16 v[100:103], v[212:215], a[20:23], v[100:103]
ds_read_b64_tr_b16 v[154:155], v10 offset:22528
v_mfma_f32_16x16x32_bf16 v[84:87], v[212:215], a[4:7], v[84:87]
ds_read_b64_tr_b16 v[156:157], v11 offset:20480
buffer_load_dwordx4 a[100:103], v1, s[44:47], s69 offen offset:1024 sc1
v_mfma_f32_16x16x32_bf16 v[88:91], v[216:219], a[4:7], v[88:91]
ds_read_b64_tr_b16 v[158:159], v11 offset:22528
v_mfma_f32_16x16x32_bf16 v[104:107], v[216:219], a[20:23], v[104:107]
ds_read_b64_tr_b16 v[160:161], v8 offset:24576
ds_read_b64_tr_b16 v[162:163], v8 offset:26624
v_mfma_f32_16x16x32_bf16 v[108:111], v[220:223], a[20:23], v[108:111]
ds_read_b64_tr_b16 v[164:165], v9 offset:24576
buffer_load_dwordx4 a[104:107], v1, s[44:47], s69 offen offset:2048 sc1
v_mfma_f32_16x16x32_bf16 v[92:95], v[220:223], a[4:7], v[92:95]
ds_read_b64_tr_b16 v[166:167], v9 offset:26624
v_mfma_f32_16x16x32_bf16 v[80:83], v[224:227], a[8:11], v[80:83]
ds_read_b64_tr_b16 v[168:169], v10 offset:24576
buffer_load_dwordx4 a[108:111], v1, s[44:47], s69 offen offset:3072 sc1
v_mfma_f32_16x16x32_bf16 v[96:99], v[224:227], a[24:27], v[96:99]
ds_read_b64_tr_b16 v[170:171], v10 offset:26624
ds_read_b64_tr_b16 v[172:173], v11 offset:24576
v_mfma_f32_16x16x32_bf16 v[100:103], v[228:231], a[24:27], v[100:103]
ds_read_b64_tr_b16 v[174:175], v11 offset:26624
s_add_u32 s69, s69, 0x20000
buffer_load_dwordx4 a[112:115], v1, s[44:47], s69 offen sc1
v_mfma_f32_16x16x32_bf16 v[84:87], v[228:231], a[8:11], v[84:87]
ds_read_b64_tr_b16 v[176:177], v8 offset:28672
v_mfma_f32_16x16x32_bf16 v[88:91], v[232:235], a[8:11], v[88:91]
ds_read_b64_tr_b16 v[178:179], v8 offset:30720
v_mfma_f32_16x16x32_bf16 v[104:107], v[232:235], a[24:27], v[104:107]
ds_read_b64_tr_b16 v[180:181], v9 offset:28672
ds_read_b64_tr_b16 v[182:183], v9 offset:30720
buffer_load_dwordx4 a[116:119], v1, s[44:47], s69 offen offset:1024 sc1
v_mfma_f32_16x16x32_bf16 v[108:111], v[236:239], a[24:27], v[108:111]
ds_read_b64_tr_b16 v[184:185], v10 offset:28672
v_mfma_f32_16x16x32_bf16 v[92:95], v[236:239], a[8:11], v[92:95]
ds_read_b64_tr_b16 v[186:187], v10 offset:30720
buffer_load_dwordx4 a[120:123], v1, s[44:47], s69 offen offset:2048 sc1
v_mfma_f32_16x16x32_bf16 v[80:83], v[240:243], a[12:15], v[80:83]
ds_read_b64_tr_b16 v[188:189], v11 offset:28672
v_mfma_f32_16x16x32_bf16 v[96:99], v[240:243], a[28:31], v[96:99]
ds_read_b64_tr_b16 v[190:191], v11 offset:30720
buffer_load_dwordx4 a[124:127], v1, s[44:47], s69 offen offset:3072 sc1
v_mfma_f32_16x16x32_bf16 v[100:103], v[244:247], a[28:31], v[100:103]
v_mfma_f32_16x16x32_bf16 v[84:87], v[244:247], a[12:15], v[84:87]
v_mfma_f32_16x16x32_bf16 v[88:91], v[248:251], a[12:15], v[88:91]
v_mfma_f32_16x16x32_bf16 v[104:107], v[248:251], a[28:31], v[104:107]
v_mfma_f32_16x16x32_bf16 v[108:111], v[252:255], a[28:31], v[108:111]
s_waitcnt vmcnt(24) lgkmcnt(0)
v_mfma_f32_16x16x32_bf16 v[92:95], v[252:255], a[12:15], v[92:95]
s_barrier
v_mfma_f32_16x16x32_bf16 v[80:83], v[128:131], a[32:35], v[80:83]
ds_read_b64_tr_b16 v[192:193], v8 offset:32768
ds_read_b64_tr_b16 v[194:195], v8 offset:34816
s_add_u32 s71, s61, 21
s_and_b32 s71, s71, 7
s_or_b32 s71, s71, 16
s_lshl_b32 s71, s71, 18
s_add_u32 s71, s71, s94
s_add_u32 m0, s64, 114688
s_add_u32 s72, s71, 0
buffer_load_dwordx4 v4, s[24:27], s72 offen lds
v_mfma_f32_16x16x32_bf16 v[96:99], v[128:131], a[48:51], v[96:99]
ds_read_b64_tr_b16 v[196:197], v9 offset:32768
v_mfma_f32_16x16x32_bf16 v[100:103], v[132:135], a[48:51], v[100:103]
ds_read_b64_tr_b16 v[198:199], v9 offset:34816
s_add_u32 s72, s71, 15360
buffer_load_dwordx4 v4, s[24:27], s72 offen offset:1024 lds
v_mfma_f32_16x16x32_bf16 v[84:87], v[132:135], a[32:35], v[84:87]
ds_read_b64_tr_b16 v[200:201], v10 offset:32768
v_mfma_f32_16x16x32_bf16 v[88:91], v[136:139], a[32:35], v[88:91]
ds_read_b64_tr_b16 v[202:203], v10 offset:34816
ds_read_b64_tr_b16 v[204:205], v11 offset:32768
s_add_u32 s72, s71, 30720
buffer_load_dwordx4 v4, s[24:27], s72 offen offset:2048 lds
v_mfma_f32_16x16x32_bf16 v[104:107], v[136:139], a[48:51], v[104:107]
ds_read_b64_tr_b16 v[206:207], v11 offset:34816
v_mfma_f32_16x16x32_bf16 v[108:111], v[140:143], a[48:51], v[108:111]
ds_read_b64_tr_b16 v[208:209], v8 offset:36864
v_mfma_f32_16x16x32_bf16 v[92:95], v[140:143], a[32:35], v[92:95]
ds_read_b64_tr_b16 v[210:211], v8 offset:38912
s_add_u32 s72, s71, 46080
buffer_load_dwordx4 v4, s[24:27], s72 offen offset:3072 lds
v_mfma_f32_16x16x32_bf16 v[80:83], v[144:147], a[36:39], v[80:83]
ds_read_b64_tr_b16 v[212:213], v9 offset:36864
ds_read_b64_tr_b16 v[214:215], v9 offset:38912
v_mfma_f32_16x16x32_bf16 v[96:99], v[144:147], a[52:55], v[96:99]
ds_read_b64_tr_b16 v[216:217], v10 offset:36864
s_add_u32 s69, s61, 20
s_and_b32 s69, s69, 7
s_or_b32 s69, s69, 16
s_lshl_b32 s69, s69, 12
s_add_u32 s69, s69, s95
buffer_load_dwordx4 a[0:3], v1, s[44:47], s69 offen sc1
v_mfma_f32_16x16x32_bf16 v[100:103], v[148:151], a[52:55], v[100:103]
ds_read_b64_tr_b16 v[218:219], v10 offset:38912
v_mfma_f32_16x16x32_bf16 v[84:87], v[148:151], a[36:39], v[84:87]
ds_read_b64_tr_b16 v[220:221], v11 offset:36864
buffer_load_dwordx4 a[4:7], v1, s[44:47], s69 offen offset:1024 sc1
v_mfma_f32_16x16x32_bf16 v[88:91], v[152:155], a[36:39], v[88:91]
ds_read_b64_tr_b16 v[222:223], v11 offset:38912
v_mfma_f32_16x16x32_bf16 v[104:107], v[152:155], a[52:55], v[104:107]
ds_read_b64_tr_b16 v[224:225], v8 offset:40960
ds_read_b64_tr_b16 v[226:227], v8 offset:43008
v_mfma_f32_16x16x32_bf16 v[108:111], v[156:159], a[52:55], v[108:111]
ds_read_b64_tr_b16 v[228:229], v9 offset:40960
buffer_load_dwordx4 a[8:11], v1, s[44:47], s69 offen offset:2048 sc1
v_mfma_f32_16x16x32_bf16 v[92:95], v[156:159], a[36:39], v[92:95]
ds_read_b64_tr_b16 v[230:231], v9 offset:43008
v_mfma_f32_16x16x32_bf16 v[80:83], v[160:163], a[40:43], v[80:83]
ds_read_b64_tr_b16 v[232:233], v10 offset:40960
buffer_load_dwordx4 a[12:15], v1, s[44:47], s69 offen offset:3072 sc1
v_mfma_f32_16x16x32_bf16 v[96:99], v[160:163], a[56:59], v[96:99]
ds_read_b64_tr_b16 v[234:235], v10 offset:43008
ds_read_b64_tr_b16 v[236:237], v11 offset:40960
v_mfma_f32_16x16x32_bf16 v[100:103], v[164:167], a[56:59], v[100:103]
ds_read_b64_tr_b16 v[238:239], v11 offset:43008
s_add_u32 s69, s69, 0x20000
buffer_load_dwordx4 a[16:19], v1, s[44:47], s69 offen sc1
v_mfma_f32_16x16x32_bf16 v[84:87], v[164:167], a[40:43], v[84:87]
ds_read_b64_tr_b16 v[240:241], v8 offset:45056
v_mfma_f32_16x16x32_bf16 v[88:91], v[168:171], a[40:43], v[88:91]
ds_read_b64_tr_b16 v[242:243], v8 offset:47104
v_mfma_f32_16x16x32_bf16 v[104:107], v[168:171], a[56:59], v[104:107]
ds_read_b64_tr_b16 v[244:245], v9 offset:45056
ds_read_b64_tr_b16 v[246:247], v9 offset:47104
buffer_load_dwordx4 a[20:23], v1, s[44:47], s69 offen offset:1024 sc1
v_mfma_f32_16x16x32_bf16 v[108:111], v[172:175], a[56:59], v[108:111]
ds_read_b64_tr_b16 v[248:249], v10 offset:45056
v_mfma_f32_16x16x32_bf16 v[92:95], v[172:175], a[40:43], v[92:95]
ds_read_b64_tr_b16 v[250:251], v10 offset:47104
buffer_load_dwordx4 a[24:27], v1, s[44:47], s69 offen offset:2048 sc1
v_mfma_f32_16x16x32_bf16 v[80:83], v[176:179], a[44:47], v[80:83]
ds_read_b64_tr_b16 v[252:253], v11 offset:45056
v_mfma_f32_16x16x32_bf16 v[96:99], v[176:179], a[60:63], v[96:99]
ds_read_b64_tr_b16 v[254:255], v11 offset:47104
buffer_load_dwordx4 a[28:31], v1, s[44:47], s69 offen offset:3072 sc1
v_mfma_f32_16x16x32_bf16 v[100:103], v[180:183], a[60:63], v[100:103]
v_mfma_f32_16x16x32_bf16 v[84:87], v[180:183], a[44:47], v[84:87]
v_mfma_f32_16x16x32_bf16 v[88:91], v[184:187], a[44:47], v[88:91]
v_mfma_f32_16x16x32_bf16 v[104:107], v[184:187], a[60:63], v[104:107]
v_mfma_f32_16x16x32_bf16 v[108:111], v[188:191], a[60:63], v[108:111]
s_waitcnt vmcnt(24) lgkmcnt(0)
v_mfma_f32_16x16x32_bf16 v[92:95], v[188:191], a[44:47], v[92:95]
s_barrier
v_mfma_f32_16x16x32_bf16 v[80:83], v[192:195], a[64:67], v[80:83]
ds_read_b64_tr_b16 v[128:129], v8 offset:49152
ds_read_b64_tr_b16 v[130:131], v8 offset:51200
s_add_u32 s71, s61, 22
s_and_b32 s71, s71, 7
s_or_b32 s71, s71, 16
s_lshl_b32 s71, s71, 18
s_add_u32 s71, s71, s94
s_add_u32 m0, s64, 131072
s_add_u32 s72, s71, 0
buffer_load_dwordx4 v4, s[24:27], s72 offen lds
v_mfma_f32_16x16x32_bf16 v[96:99], v[192:195], a[80:83], v[96:99]
ds_read_b64_tr_b16 v[132:133], v9 offset:49152
v_mfma_f32_16x16x32_bf16 v[100:103], v[196:199], a[80:83], v[100:103]
ds_read_b64_tr_b16 v[134:135], v9 offset:51200
s_add_u32 s72, s71, 15360
buffer_load_dwordx4 v4, s[24:27], s72 offen offset:1024 lds
v_mfma_f32_16x16x32_bf16 v[84:87], v[196:199], a[64:67], v[84:87]
ds_read_b64_tr_b16 v[136:137], v10 offset:49152
v_mfma_f32_16x16x32_bf16 v[88:91], v[200:203], a[64:67], v[88:91]
ds_read_b64_tr_b16 v[138:139], v10 offset:51200
ds_read_b64_tr_b16 v[140:141], v11 offset:49152
s_add_u32 s72, s71, 30720
buffer_load_dwordx4 v4, s[24:27], s72 offen offset:2048 lds
v_mfma_f32_16x16x32_bf16 v[104:107], v[200:203], a[80:83], v[104:107]
ds_read_b64_tr_b16 v[142:143], v11 offset:51200
v_mfma_f32_16x16x32_bf16 v[108:111], v[204:207], a[80:83], v[108:111]
ds_read_b64_tr_b16 v[144:145], v8 offset:53248
v_mfma_f32_16x16x32_bf16 v[92:95], v[204:207], a[64:67], v[92:95]
ds_read_b64_tr_b16 v[146:147], v8 offset:55296
s_add_u32 s72, s71, 46080
buffer_load_dwordx4 v4, s[24:27], s72 offen offset:3072 lds
v_mfma_f32_16x16x32_bf16 v[80:83], v[208:211], a[68:71], v[80:83]
ds_read_b64_tr_b16 v[148:149], v9 offset:53248
ds_read_b64_tr_b16 v[150:151], v9 offset:55296
v_mfma_f32_16x16x32_bf16 v[96:99], v[208:211], a[84:87], v[96:99]
ds_read_b64_tr_b16 v[152:153], v10 offset:53248
s_add_u32 s69, s61, 21
s_and_b32 s69, s69, 7
s_or_b32 s69, s69, 16
s_lshl_b32 s69, s69, 12
s_add_u32 s69, s69, s95
buffer_load_dwordx4 a[32:35], v1, s[44:47], s69 offen sc1
v_mfma_f32_16x16x32_bf16 v[100:103], v[212:215], a[84:87], v[100:103]
ds_read_b64_tr_b16 v[154:155], v10 offset:55296
v_mfma_f32_16x16x32_bf16 v[84:87], v[212:215], a[68:71], v[84:87]
ds_read_b64_tr_b16 v[156:157], v11 offset:53248
buffer_load_dwordx4 a[36:39], v1, s[44:47], s69 offen offset:1024 sc1
v_mfma_f32_16x16x32_bf16 v[88:91], v[216:219], a[68:71], v[88:91]
ds_read_b64_tr_b16 v[158:159], v11 offset:55296
v_mfma_f32_16x16x32_bf16 v[104:107], v[216:219], a[84:87], v[104:107]
ds_read_b64_tr_b16 v[160:161], v8 offset:57344
ds_read_b64_tr_b16 v[162:163], v8 offset:59392
v_mfma_f32_16x16x32_bf16 v[108:111], v[220:223], a[84:87], v[108:111]
ds_read_b64_tr_b16 v[164:165], v9 offset:57344
buffer_load_dwordx4 a[40:43], v1, s[44:47], s69 offen offset:2048 sc1
v_mfma_f32_16x16x32_bf16 v[92:95], v[220:223], a[68:71], v[92:95]
ds_read_b64_tr_b16 v[166:167], v9 offset:59392
v_mfma_f32_16x16x32_bf16 v[80:83], v[224:227], a[72:75], v[80:83]
ds_read_b64_tr_b16 v[168:169], v10 offset:57344
buffer_load_dwordx4 a[44:47], v1, s[44:47], s69 offen offset:3072 sc1
v_mfma_f32_16x16x32_bf16 v[96:99], v[224:227], a[88:91], v[96:99]
ds_read_b64_tr_b16 v[170:171], v10 offset:59392
ds_read_b64_tr_b16 v[172:173], v11 offset:57344
v_mfma_f32_16x16x32_bf16 v[100:103], v[228:231], a[88:91], v[100:103]
ds_read_b64_tr_b16 v[174:175], v11 offset:59392
s_add_u32 s69, s69, 0x20000
buffer_load_dwordx4 a[48:51], v1, s[44:47], s69 offen sc1
v_mfma_f32_16x16x32_bf16 v[84:87], v[228:231], a[72:75], v[84:87]
ds_read_b64_tr_b16 v[176:177], v8 offset:61440
v_mfma_f32_16x16x32_bf16 v[88:91], v[232:235], a[72:75], v[88:91]
ds_read_b64_tr_b16 v[178:179], v8 offset:63488
v_mfma_f32_16x16x32_bf16 v[104:107], v[232:235], a[88:91], v[104:107]
ds_read_b64_tr_b16 v[180:181], v9 offset:61440
ds_read_b64_tr_b16 v[182:183], v9 offset:63488
buffer_load_dwordx4 a[52:55], v1, s[44:47], s69 offen offset:1024 sc1
v_mfma_f32_16x16x32_bf16 v[108:111], v[236:239], a[88:91], v[108:111]
ds_read_b64_tr_b16 v[184:185], v10 offset:61440
v_mfma_f32_16x16x32_bf16 v[92:95], v[236:239], a[72:75], v[92:95]
ds_read_b64_tr_b16 v[186:187], v10 offset:63488
buffer_load_dwordx4 a[56:59], v1, s[44:47], s69 offen offset:2048 sc1
v_mfma_f32_16x16x32_bf16 v[80:83], v[240:243], a[76:79], v[80:83]
ds_read_b64_tr_b16 v[188:189], v11 offset:61440
v_mfma_f32_16x16x32_bf16 v[96:99], v[240:243], a[92:95], v[96:99]
ds_read_b64_tr_b16 v[190:191], v11 offset:63488
buffer_load_dwordx4 a[60:63], v1, s[44:47], s69 offen offset:3072 sc1
v_mfma_f32_16x16x32_bf16 v[100:103], v[244:247], a[92:95], v[100:103]
v_mfma_f32_16x16x32_bf16 v[84:87], v[244:247], a[76:79], v[84:87]
v_mfma_f32_16x16x32_bf16 v[88:91], v[248:251], a[76:79], v[88:91]
v_mfma_f32_16x16x32_bf16 v[104:107], v[248:251], a[92:95], v[104:107]
v_mfma_f32_16x16x32_bf16 v[108:111], v[252:255], a[92:95], v[108:111]
s_waitcnt vmcnt(24) lgkmcnt(0)
v_mfma_f32_16x16x32_bf16 v[92:95], v[252:255], a[76:79], v[92:95]
s_barrier
v_mfma_f32_16x16x32_bf16 v[80:83], v[128:131], a[96:99], v[80:83]
ds_read_b64_tr_b16 v[192:193], v8 offset:0
ds_read_b64_tr_b16 v[194:195], v8 offset:2048
s_add_u32 s71, s61, 23
s_and_b32 s71, s71, 7
s_or_b32 s71, s71, 16
s_lshl_b32 s71, s71, 18
s_add_u32 s71, s71, s94
s_add_u32 m0, s64, 147456
s_add_u32 s72, s71, 0
buffer_load_dwordx4 v4, s[24:27], s72 offen lds
v_mfma_f32_16x16x32_bf16 v[96:99], v[128:131], a[112:115], v[96:99]
ds_read_b64_tr_b16 v[196:197], v9 offset:0
v_mfma_f32_16x16x32_bf16 v[100:103], v[132:135], a[112:115], v[100:103]
ds_read_b64_tr_b16 v[198:199], v9 offset:2048
s_add_u32 s72, s71, 15360
buffer_load_dwordx4 v4, s[24:27], s72 offen offset:1024 lds
v_mfma_f32_16x16x32_bf16 v[84:87], v[132:135], a[96:99], v[84:87]
ds_read_b64_tr_b16 v[200:201], v10 offset:0
v_mfma_f32_16x16x32_bf16 v[88:91], v[136:139], a[96:99], v[88:91]
ds_read_b64_tr_b16 v[202:203], v10 offset:2048
ds_read_b64_tr_b16 v[204:205], v11 offset:0
s_add_u32 s72, s71, 30720
buffer_load_dwordx4 v4, s[24:27], s72 offen offset:2048 lds
v_mfma_f32_16x16x32_bf16 v[104:107], v[136:139], a[112:115], v[104:107]
ds_read_b64_tr_b16 v[206:207], v11 offset:2048
v_mfma_f32_16x16x32_bf16 v[108:111], v[140:143], a[112:115], v[108:111]
ds_read_b64_tr_b16 v[208:209], v8 offset:4096
v_mfma_f32_16x16x32_bf16 v[92:95], v[140:143], a[96:99], v[92:95]
ds_read_b64_tr_b16 v[210:211], v8 offset:6144
s_add_u32 s72, s71, 46080
buffer_load_dwordx4 v4, s[24:27], s72 offen offset:3072 lds
v_mfma_f32_16x16x32_bf16 v[80:83], v[144:147], a[100:103], v[80:83]
ds_read_b64_tr_b16 v[212:213], v9 offset:4096
ds_read_b64_tr_b16 v[214:215], v9 offset:6144
v_mfma_f32_16x16x32_bf16 v[96:99], v[144:147], a[116:119], v[96:99]
ds_read_b64_tr_b16 v[216:217], v10 offset:4096
s_add_u32 s69, s61, 22
s_and_b32 s69, s69, 7
s_or_b32 s69, s69, 16
s_lshl_b32 s69, s69, 12
s_add_u32 s69, s69, s95
buffer_load_dwordx4 a[64:67], v1, s[44:47], s69 offen sc1
v_mfma_f32_16x16x32_bf16 v[100:103], v[148:151], a[116:119], v[100:103]
ds_read_b64_tr_b16 v[218:219], v10 offset:6144
v_mfma_f32_16x16x32_bf16 v[84:87], v[148:151], a[100:103], v[84:87]
ds_read_b64_tr_b16 v[220:221], v11 offset:4096
buffer_load_dwordx4 a[68:71], v1, s[44:47], s69 offen offset:1024 sc1
v_mfma_f32_16x16x32_bf16 v[88:91], v[152:155], a[100:103], v[88:91]
ds_read_b64_tr_b16 v[222:223], v11 offset:6144
v_mfma_f32_16x16x32_bf16 v[104:107], v[152:155], a[116:119], v[104:107]
ds_read_b64_tr_b16 v[224:225], v8 offset:8192
ds_read_b64_tr_b16 v[226:227], v8 offset:10240
v_mfma_f32_16x16x32_bf16 v[108:111], v[156:159], a[116:119], v[108:111]
ds_read_b64_tr_b16 v[228:229], v9 offset:8192
buffer_load_dwordx4 a[72:75], v1, s[44:47], s69 offen offset:2048 sc1
v_mfma_f32_16x16x32_bf16 v[92:95], v[156:159], a[100:103], v[92:95]
ds_read_b64_tr_b16 v[230:231], v9 offset:10240
v_mfma_f32_16x16x32_bf16 v[80:83], v[160:163], a[104:107], v[80:83]
ds_read_b64_tr_b16 v[232:233], v10 offset:8192
buffer_load_dwordx4 a[76:79], v1, s[44:47], s69 offen offset:3072 sc1
v_mfma_f32_16x16x32_bf16 v[96:99], v[160:163], a[120:123], v[96:99]
ds_read_b64_tr_b16 v[234:235], v10 offset:10240
ds_read_b64_tr_b16 v[236:237], v11 offset:8192
v_mfma_f32_16x16x32_bf16 v[100:103], v[164:167], a[120:123], v[100:103]
ds_read_b64_tr_b16 v[238:239], v11 offset:10240
s_add_u32 s69, s69, 0x20000
buffer_load_dwordx4 a[80:83], v1, s[44:47], s69 offen sc1
v_mfma_f32_16x16x32_bf16 v[84:87], v[164:167], a[104:107], v[84:87]
ds_read_b64_tr_b16 v[240:241], v8 offset:12288
v_mfma_f32_16x16x32_bf16 v[88:91], v[168:171], a[104:107], v[88:91]
ds_read_b64_tr_b16 v[242:243], v8 offset:14336
v_mfma_f32_16x16x32_bf16 v[104:107], v[168:171], a[120:123], v[104:107]
ds_read_b64_tr_b16 v[244:245], v9 offset:12288
ds_read_b64_tr_b16 v[246:247], v9 offset:14336
buffer_load_dwordx4 a[84:87], v1, s[44:47], s69 offen offset:1024 sc1
v_mfma_f32_16x16x32_bf16 v[108:111], v[172:175], a[120:123], v[108:111]
ds_read_b64_tr_b16 v[248:249], v10 offset:12288
v_mfma_f32_16x16x32_bf16 v[92:95], v[172:175], a[104:107], v[92:95]
ds_read_b64_tr_b16 v[250:251], v10 offset:14336
buffer_load_dwordx4 a[88:91], v1, s[44:47], s69 offen offset:2048 sc1
v_mfma_f32_16x16x32_bf16 v[80:83], v[176:179], a[108:111], v[80:83]
ds_read_b64_tr_b16 v[252:253], v11 offset:12288
v_mfma_f32_16x16x32_bf16 v[96:99], v[176:179], a[124:127], v[96:99]
ds_read_b64_tr_b16 v[254:255], v11 offset:14336
buffer_load_dwordx4 a[92:95], v1, s[44:47], s69 offen offset:3072 sc1
v_mfma_f32_16x16x32_bf16 v[100:103], v[180:183], a[124:127], v[100:103]
v_mfma_f32_16x16x32_bf16 v[84:87], v[180:183], a[108:111], v[84:87]
v_mfma_f32_16x16x32_bf16 v[88:91], v[184:187], a[108:111], v[88:91]
v_mfma_f32_16x16x32_bf16 v[104:107], v[184:187], a[124:127], v[104:107]
v_mfma_f32_16x16x32_bf16 v[108:111], v[188:191], a[124:127], v[108:111]
s_waitcnt vmcnt(24) lgkmcnt(0)
v_mfma_f32_16x16x32_bf16 v[92:95], v[188:191], a[108:111], v[92:95]
s_barrier
v_mfma_f32_16x16x32_bf16 v[80:83], v[192:195], a[0:3], v[80:83]
ds_read_b64_tr_b16 v[128:129], v8 offset:16384
ds_read_b64_tr_b16 v[130:131], v8 offset:18432
s_add_u32 s71, s61, 24
s_and_b32 s71, s71, 7
s_or_b32 s71, s71, 24
s_lshl_b32 s71, s71, 18
s_add_u32 s71, s71, s94
s_add_u32 m0, s64, 98304
s_add_u32 s72, s71, 0
buffer_load_dwordx4 v4, s[24:27], s72 offen lds
v_mfma_f32_16x16x32_bf16 v[96:99], v[192:195], a[16:19], v[96:99]
ds_read_b64_tr_b16 v[132:133], v9 offset:16384
v_mfma_f32_16x16x32_bf16 v[100:103], v[196:199], a[16:19], v[100:103]
ds_read_b64_tr_b16 v[134:135], v9 offset:18432
s_add_u32 s72, s71, 15360
buffer_load_dwordx4 v4, s[24:27], s72 offen offset:1024 lds
v_mfma_f32_16x16x32_bf16 v[84:87], v[196:199], a[0:3], v[84:87]
ds_read_b64_tr_b16 v[136:137], v10 offset:16384
v_mfma_f32_16x16x32_bf16 v[88:91], v[200:203], a[0:3], v[88:91]
ds_read_b64_tr_b16 v[138:139], v10 offset:18432
ds_read_b64_tr_b16 v[140:141], v11 offset:16384
s_add_u32 s72, s71, 30720
buffer_load_dwordx4 v4, s[24:27], s72 offen offset:2048 lds
v_mfma_f32_16x16x32_bf16 v[104:107], v[200:203], a[16:19], v[104:107]
ds_read_b64_tr_b16 v[142:143], v11 offset:18432
v_mfma_f32_16x16x32_bf16 v[108:111], v[204:207], a[16:19], v[108:111]
ds_read_b64_tr_b16 v[144:145], v8 offset:20480
v_mfma_f32_16x16x32_bf16 v[92:95], v[204:207], a[0:3], v[92:95]
ds_read_b64_tr_b16 v[146:147], v8 offset:22528
s_add_u32 s72, s71, 46080
buffer_load_dwordx4 v4, s[24:27], s72 offen offset:3072 lds
v_mfma_f32_16x16x32_bf16 v[80:83], v[208:211], a[4:7], v[80:83]
ds_read_b64_tr_b16 v[148:149], v9 offset:20480
ds_read_b64_tr_b16 v[150:151], v9 offset:22528
v_mfma_f32_16x16x32_bf16 v[96:99], v[208:211], a[20:23], v[96:99]
ds_read_b64_tr_b16 v[152:153], v10 offset:20480
s_add_u32 s69, s61, 23
s_and_b32 s69, s69, 7
s_or_b32 s69, s69, 16
s_lshl_b32 s69, s69, 12
s_add_u32 s69, s69, s95
buffer_load_dwordx4 a[96:99], v1, s[44:47], s69 offen sc1
v_mfma_f32_16x16x32_bf16 v[100:103], v[212:215], a[20:23], v[100:103]
ds_read_b64_tr_b16 v[154:155], v10 offset:22528
v_mfma_f32_16x16x32_bf16 v[84:87], v[212:215], a[4:7], v[84:87]
ds_read_b64_tr_b16 v[156:157], v11 offset:20480
buffer_load_dwordx4 a[100:103], v1, s[44:47], s69 offen offset:1024 sc1
v_mfma_f32_16x16x32_bf16 v[88:91], v[216:219], a[4:7], v[88:91]
ds_read_b64_tr_b16 v[158:159], v11 offset:22528
v_mfma_f32_16x16x32_bf16 v[104:107], v[216:219], a[20:23], v[104:107]
ds_read_b64_tr_b16 v[160:161], v8 offset:24576
ds_read_b64_tr_b16 v[162:163], v8 offset:26624
v_mfma_f32_16x16x32_bf16 v[108:111], v[220:223], a[20:23], v[108:111]
ds_read_b64_tr_b16 v[164:165], v9 offset:24576
buffer_load_dwordx4 a[104:107], v1, s[44:47], s69 offen offset:2048 sc1
v_mfma_f32_16x16x32_bf16 v[92:95], v[220:223], a[4:7], v[92:95]
ds_read_b64_tr_b16 v[166:167], v9 offset:26624
v_mfma_f32_16x16x32_bf16 v[80:83], v[224:227], a[8:11], v[80:83]
ds_read_b64_tr_b16 v[168:169], v10 offset:24576
buffer_load_dwordx4 a[108:111], v1, s[44:47], s69 offen offset:3072 sc1
v_mfma_f32_16x16x32_bf16 v[96:99], v[224:227], a[24:27], v[96:99]
ds_read_b64_tr_b16 v[170:171], v10 offset:26624
ds_read_b64_tr_b16 v[172:173], v11 offset:24576
v_mfma_f32_16x16x32_bf16 v[100:103], v[228:231], a[24:27], v[100:103]
ds_read_b64_tr_b16 v[174:175], v11 offset:26624
s_add_u32 s69, s69, 0x20000
buffer_load_dwordx4 a[112:115], v1, s[44:47], s69 offen sc1
v_mfma_f32_16x16x32_bf16 v[84:87], v[228:231], a[8:11], v[84:87]
ds_read_b64_tr_b16 v[176:177], v8 offset:28672
v_mfma_f32_16x16x32_bf16 v[88:91], v[232:235], a[8:11], v[88:91]
ds_read_b64_tr_b16 v[178:179], v8 offset:30720
v_mfma_f32_16x16x32_bf16 v[104:107], v[232:235], a[24:27], v[104:107]
ds_read_b64_tr_b16 v[180:181], v9 offset:28672
ds_read_b64_tr_b16 v[182:183], v9 offset:30720
buffer_load_dwordx4 a[116:119], v1, s[44:47], s69 offen offset:1024 sc1
v_mfma_f32_16x16x32_bf16 v[108:111], v[236:239], a[24:27], v[108:111]
ds_read_b64_tr_b16 v[184:185], v10 offset:28672
v_mfma_f32_16x16x32_bf16 v[92:95], v[236:239], a[8:11], v[92:95]
ds_read_b64_tr_b16 v[186:187], v10 offset:30720
buffer_load_dwordx4 a[120:123], v1, s[44:47], s69 offen offset:2048 sc1
v_mfma_f32_16x16x32_bf16 v[80:83], v[240:243], a[12:15], v[80:83]
ds_read_b64_tr_b16 v[188:189], v11 offset:28672
v_mfma_f32_16x16x32_bf16 v[96:99], v[240:243], a[28:31], v[96:99]
ds_read_b64_tr_b16 v[190:191], v11 offset:30720
buffer_load_dwordx4 a[124:127], v1, s[44:47], s69 offen offset:3072 sc1
v_mfma_f32_16x16x32_bf16 v[100:103], v[244:247], a[28:31], v[100:103]
v_mfma_f32_16x16x32_bf16 v[84:87], v[244:247], a[12:15], v[84:87]
v_mfma_f32_16x16x32_bf16 v[88:91], v[248:251], a[12:15], v[88:91]
v_mfma_f32_16x16x32_bf16 v[104:107], v[248:251], a[28:31], v[104:107]
v_mfma_f32_16x16x32_bf16 v[108:111], v[252:255], a[28:31], v[108:111]
s_waitcnt vmcnt(24) lgkmcnt(0)
v_mfma_f32_16x16x32_bf16 v[92:95], v[252:255], a[12:15], v[92:95]
s_barrier
v_mfma_f32_16x16x32_bf16 v[80:83], v[128:131], a[32:35], v[80:83]
ds_read_b64_tr_b16 v[192:193], v8 offset:32768
ds_read_b64_tr_b16 v[194:195], v8 offset:34816
s_add_u32 s71, s61, 25
s_and_b32 s71, s71, 7
s_or_b32 s71, s71, 24
s_lshl_b32 s71, s71, 18
s_add_u32 s71, s71, s94
s_add_u32 m0, s64, 114688
s_add_u32 s72, s71, 0
buffer_load_dwordx4 v4, s[24:27], s72 offen lds
v_mfma_f32_16x16x32_bf16 v[96:99], v[128:131], a[48:51], v[96:99]
ds_read_b64_tr_b16 v[196:197], v9 offset:32768
v_mfma_f32_16x16x32_bf16 v[100:103], v[132:135], a[48:51], v[100:103]
ds_read_b64_tr_b16 v[198:199], v9 offset:34816
s_add_u32 s72, s71, 15360
buffer_load_dwordx4 v4, s[24:27], s72 offen offset:1024 lds
v_mfma_f32_16x16x32_bf16 v[84:87], v[132:135], a[32:35], v[84:87]
ds_read_b64_tr_b16 v[200:201], v10 offset:32768
v_mfma_f32_16x16x32_bf16 v[88:91], v[136:139], a[32:35], v[88:91]
ds_read_b64_tr_b16 v[202:203], v10 offset:34816
ds_read_b64_tr_b16 v[204:205], v11 offset:32768
s_add_u32 s72, s71, 30720
buffer_load_dwordx4 v4, s[24:27], s72 offen offset:2048 lds
v_mfma_f32_16x16x32_bf16 v[104:107], v[136:139], a[48:51], v[104:107]
ds_read_b64_tr_b16 v[206:207], v11 offset:34816
v_mfma_f32_16x16x32_bf16 v[108:111], v[140:143], a[48:51], v[108:111]
ds_read_b64_tr_b16 v[208:209], v8 offset:36864
v_mfma_f32_16x16x32_bf16 v[92:95], v[140:143], a[32:35], v[92:95]
ds_read_b64_tr_b16 v[210:211], v8 offset:38912
s_add_u32 s72, s71, 46080
buffer_load_dwordx4 v4, s[24:27], s72 offen offset:3072 lds
v_mfma_f32_16x16x32_bf16 v[80:83], v[144:147], a[36:39], v[80:83]
ds_read_b64_tr_b16 v[212:213], v9 offset:36864
ds_read_b64_tr_b16 v[214:215], v9 offset:38912
v_mfma_f32_16x16x32_bf16 v[96:99], v[144:147], a[52:55], v[96:99]
ds_read_b64_tr_b16 v[216:217], v10 offset:36864
s_add_u32 s69, s61, 24
s_and_b32 s69, s69, 7
s_or_b32 s69, s69, 24
s_lshl_b32 s69, s69, 12
s_add_u32 s69, s69, s95
buffer_load_dwordx4 a[0:3], v1, s[44:47], s69 offen sc1
v_mfma_f32_16x16x32_bf16 v[100:103], v[148:151], a[52:55], v[100:103]
ds_read_b64_tr_b16 v[218:219], v10 offset:38912
v_mfma_f32_16x16x32_bf16 v[84:87], v[148:151], a[36:39], v[84:87]
ds_read_b64_tr_b16 v[220:221], v11 offset:36864
buffer_load_dwordx4 a[4:7], v1, s[44:47], s69 offen offset:1024 sc1
v_mfma_f32_16x16x32_bf16 v[88:91], v[152:155], a[36:39], v[88:91]
ds_read_b64_tr_b16 v[222:223], v11 offset:38912
v_mfma_f32_16x16x32_bf16 v[104:107], v[152:155], a[52:55], v[104:107]
ds_read_b64_tr_b16 v[224:225], v8 offset:40960
ds_read_b64_tr_b16 v[226:227], v8 offset:43008
v_mfma_f32_16x16x32_bf16 v[108:111], v[156:159], a[52:55], v[108:111]
ds_read_b64_tr_b16 v[228:229], v9 offset:40960
buffer_load_dwordx4 a[8:11], v1, s[44:47], s69 offen offset:2048 sc1
v_mfma_f32_16x16x32_bf16 v[92:95], v[156:159], a[36:39], v[92:95]
ds_read_b64_tr_b16 v[230:231], v9 offset:43008
v_mfma_f32_16x16x32_bf16 v[80:83], v[160:163], a[40:43], v[80:83]
ds_read_b64_tr_b16 v[232:233], v10 offset:40960
buffer_load_dwordx4 a[12:15], v1, s[44:47], s69 offen offset:3072 sc1
v_mfma_f32_16x16x32_bf16 v[96:99], v[160:163], a[56:59], v[96:99]
ds_read_b64_tr_b16 v[234:235], v10 offset:43008
ds_read_b64_tr_b16 v[236:237], v11 offset:40960
v_mfma_f32_16x16x32_bf16 v[100:103], v[164:167], a[56:59], v[100:103]
ds_read_b64_tr_b16 v[238:239], v11 offset:43008
s_add_u32 s69, s69, 0x20000
buffer_load_dwordx4 a[16:19], v1, s[44:47], s69 offen sc1
v_mfma_f32_16x16x32_bf16 v[84:87], v[164:167], a[40:43], v[84:87]
ds_read_b64_tr_b16 v[240:241], v8 offset:45056
v_mfma_f32_16x16x32_bf16 v[88:91], v[168:171], a[40:43], v[88:91]
ds_read_b64_tr_b16 v[242:243], v8 offset:47104
v_mfma_f32_16x16x32_bf16 v[104:107], v[168:171], a[56:59], v[104:107]
ds_read_b64_tr_b16 v[244:245], v9 offset:45056
ds_read_b64_tr_b16 v[246:247], v9 offset:47104
buffer_load_dwordx4 a[20:23], v1, s[44:47], s69 offen offset:1024 sc1
v_mfma_f32_16x16x32_bf16 v[108:111], v[172:175], a[56:59], v[108:111]
ds_read_b64_tr_b16 v[248:249], v10 offset:45056
v_mfma_f32_16x16x32_bf16 v[92:95], v[172:175], a[40:43], v[92:95]
ds_read_b64_tr_b16 v[250:251], v10 offset:47104
buffer_load_dwordx4 a[24:27], v1, s[44:47], s69 offen offset:2048 sc1
v_mfma_f32_16x16x32_bf16 v[80:83], v[176:179], a[44:47], v[80:83]
ds_read_b64_tr_b16 v[252:253], v11 offset:45056
v_mfma_f32_16x16x32_bf16 v[96:99], v[176:179], a[60:63], v[96:99]
ds_read_b64_tr_b16 v[254:255], v11 offset:47104
buffer_load_dwordx4 a[28:31], v1, s[44:47], s69 offen offset:3072 sc1
v_mfma_f32_16x16x32_bf16 v[100:103], v[180:183], a[60:63], v[100:103]
v_mfma_f32_16x16x32_bf16 v[84:87], v[180:183], a[44:47], v[84:87]
v_mfma_f32_16x16x32_bf16 v[88:91], v[184:187], a[44:47], v[88:91]
v_mfma_f32_16x16x32_bf16 v[104:107], v[184:187], a[60:63], v[104:107]
v_mfma_f32_16x16x32_bf16 v[108:111], v[188:191], a[60:63], v[108:111]
s_waitcnt vmcnt(24) lgkmcnt(0)
v_mfma_f32_16x16x32_bf16 v[92:95], v[188:191], a[44:47], v[92:95]
s_barrier
v_mfma_f32_16x16x32_bf16 v[80:83], v[192:195], a[64:67], v[80:83]
ds_read_b64_tr_b16 v[128:129], v8 offset:49152
ds_read_b64_tr_b16 v[130:131], v8 offset:51200
s_add_u32 s71, s61, 26
s_and_b32 s71, s71, 7
s_or_b32 s71, s71, 24
s_lshl_b32 s71, s71, 18
s_add_u32 s71, s71, s94
s_add_u32 m0, s64, 131072
s_add_u32 s72, s71, 0
buffer_load_dwordx4 v4, s[24:27], s72 offen lds
v_mfma_f32_16x16x32_bf16 v[96:99], v[192:195], a[80:83], v[96:99]
ds_read_b64_tr_b16 v[132:133], v9 offset:49152
v_mfma_f32_16x16x32_bf16 v[100:103], v[196:199], a[80:83], v[100:103]
ds_read_b64_tr_b16 v[134:135], v9 offset:51200
s_add_u32 s72, s71, 15360
buffer_load_dwordx4 v4, s[24:27], s72 offen offset:1024 lds
v_mfma_f32_16x16x32_bf16 v[84:87], v[196:199], a[64:67], v[84:87]
ds_read_b64_tr_b16 v[136:137], v10 offset:49152
v_mfma_f32_16x16x32_bf16 v[88:91], v[200:203], a[64:67], v[88:91]
ds_read_b64_tr_b16 v[138:139], v10 offset:51200
ds_read_b64_tr_b16 v[140:141], v11 offset:49152
s_add_u32 s72, s71, 30720
buffer_load_dwordx4 v4, s[24:27], s72 offen offset:2048 lds
v_mfma_f32_16x16x32_bf16 v[104:107], v[200:203], a[80:83], v[104:107]
ds_read_b64_tr_b16 v[142:143], v11 offset:51200
v_mfma_f32_16x16x32_bf16 v[108:111], v[204:207], a[80:83], v[108:111]
ds_read_b64_tr_b16 v[144:145], v8 offset:53248
v_mfma_f32_16x16x32_bf16 v[92:95], v[204:207], a[64:67], v[92:95]
ds_read_b64_tr_b16 v[146:147], v8 offset:55296
s_add_u32 s72, s71, 46080
buffer_load_dwordx4 v4, s[24:27], s72 offen offset:3072 lds
v_mfma_f32_16x16x32_bf16 v[80:83], v[208:211], a[68:71], v[80:83]
ds_read_b64_tr_b16 v[148:149], v9 offset:53248
ds_read_b64_tr_b16 v[150:151], v9 offset:55296
v_mfma_f32_16x16x32_bf16 v[96:99], v[208:211], a[84:87], v[96:99]
ds_read_b64_tr_b16 v[152:153], v10 offset:53248
s_add_u32 s69, s61, 25
s_and_b32 s69, s69, 7
s_or_b32 s69, s69, 24
s_lshl_b32 s69, s69, 12
s_add_u32 s69, s69, s95
buffer_load_dwordx4 a[32:35], v1, s[44:47], s69 offen sc1
v_mfma_f32_16x16x32_bf16 v[100:103], v[212:215], a[84:87], v[100:103]
ds_read_b64_tr_b16 v[154:155], v10 offset:55296
v_mfma_f32_16x16x32_bf16 v[84:87], v[212:215], a[68:71], v[84:87]
ds_read_b64_tr_b16 v[156:157], v11 offset:53248
buffer_load_dwordx4 a[36:39], v1, s[44:47], s69 offen offset:1024 sc1
v_mfma_f32_16x16x32_bf16 v[88:91], v[216:219], a[68:71], v[88:91]
ds_read_b64_tr_b16 v[158:159], v11 offset:55296
v_mfma_f32_16x16x32_bf16 v[104:107], v[216:219], a[84:87], v[104:107]
ds_read_b64_tr_b16 v[160:161], v8 offset:57344
ds_read_b64_tr_b16 v[162:163], v8 offset:59392
v_mfma_f32_16x16x32_bf16 v[108:111], v[220:223], a[84:87], v[108:111]
ds_read_b64_tr_b16 v[164:165], v9 offset:57344
buffer_load_dwordx4 a[40:43], v1, s[44:47], s69 offen offset:2048 sc1
v_mfma_f32_16x16x32_bf16 v[92:95], v[220:223], a[68:71], v[92:95]
ds_read_b64_tr_b16 v[166:167], v9 offset:59392
v_mfma_f32_16x16x32_bf16 v[80:83], v[224:227], a[72:75], v[80:83]
ds_read_b64_tr_b16 v[168:169], v10 offset:57344
buffer_load_dwordx4 a[44:47], v1, s[44:47], s69 offen offset:3072 sc1
v_mfma_f32_16x16x32_bf16 v[96:99], v[224:227], a[88:91], v[96:99]
ds_read_b64_tr_b16 v[170:171], v10 offset:59392
ds_read_b64_tr_b16 v[172:173], v11 offset:57344
v_mfma_f32_16x16x32_bf16 v[100:103], v[228:231], a[88:91], v[100:103]
ds_read_b64_tr_b16 v[174:175], v11 offset:59392
s_add_u32 s69, s69, 0x20000
buffer_load_dwordx4 a[48:51], v1, s[44:47], s69 offen sc1
v_mfma_f32_16x16x32_bf16 v[84:87], v[228:231], a[72:75], v[84:87]
ds_read_b64_tr_b16 v[176:177], v8 offset:61440
v_mfma_f32_16x16x32_bf16 v[88:91], v[232:235], a[72:75], v[88:91]
ds_read_b64_tr_b16 v[178:179], v8 offset:63488
v_mfma_f32_16x16x32_bf16 v[104:107], v[232:235], a[88:91], v[104:107]
ds_read_b64_tr_b16 v[180:181], v9 offset:61440
ds_read_b64_tr_b16 v[182:183], v9 offset:63488
buffer_load_dwordx4 a[52:55], v1, s[44:47], s69 offen offset:1024 sc1
v_mfma_f32_16x16x32_bf16 v[108:111], v[236:239], a[88:91], v[108:111]
ds_read_b64_tr_b16 v[184:185], v10 offset:61440
v_mfma_f32_16x16x32_bf16 v[92:95], v[236:239], a[72:75], v[92:95]
ds_read_b64_tr_b16 v[186:187], v10 offset:63488
buffer_load_dwordx4 a[56:59], v1, s[44:47], s69 offen offset:2048 sc1
v_mfma_f32_16x16x32_bf16 v[80:83], v[240:243], a[76:79], v[80:83]
ds_read_b64_tr_b16 v[188:189], v11 offset:61440
v_mfma_f32_16x16x32_bf16 v[96:99], v[240:243], a[92:95], v[96:99]
ds_read_b64_tr_b16 v[190:191], v11 offset:63488
buffer_load_dwordx4 a[60:63], v1, s[44:47], s69 offen offset:3072 sc1
v_mfma_f32_16x16x32_bf16 v[100:103], v[244:247], a[92:95], v[100:103]
v_mfma_f32_16x16x32_bf16 v[84:87], v[244:247], a[76:79], v[84:87]
v_mfma_f32_16x16x32_bf16 v[88:91], v[248:251], a[76:79], v[88:91]
v_mfma_f32_16x16x32_bf16 v[104:107], v[248:251], a[92:95], v[104:107]
v_mfma_f32_16x16x32_bf16 v[108:111], v[252:255], a[92:95], v[108:111]
s_waitcnt vmcnt(24) lgkmcnt(0)
v_mfma_f32_16x16x32_bf16 v[92:95], v[252:255], a[76:79], v[92:95]
s_barrier
v_mfma_f32_16x16x32_bf16 v[80:83], v[128:131], a[96:99], v[80:83]
ds_read_b64_tr_b16 v[192:193], v8 offset:0
ds_read_b64_tr_b16 v[194:195], v8 offset:2048
s_add_u32 s71, s61, 27
s_and_b32 s71, s71, 7
s_or_b32 s71, s71, 24
s_lshl_b32 s71, s71, 18
s_add_u32 s71, s71, s94
s_add_u32 m0, s64, 147456
s_add_u32 s72, s71, 0
buffer_load_dwordx4 v4, s[24:27], s72 offen lds
v_mfma_f32_16x16x32_bf16 v[96:99], v[128:131], a[112:115], v[96:99]
ds_read_b64_tr_b16 v[196:197], v9 offset:0
v_mfma_f32_16x16x32_bf16 v[100:103], v[132:135], a[112:115], v[100:103]
ds_read_b64_tr_b16 v[198:199], v9 offset:2048
s_add_u32 s72, s71, 15360
buffer_load_dwordx4 v4, s[24:27], s72 offen offset:1024 lds
v_mfma_f32_16x16x32_bf16 v[84:87], v[132:135], a[96:99], v[84:87]
ds_read_b64_tr_b16 v[200:201], v10 offset:0
v_mfma_f32_16x16x32_bf16 v[88:91], v[136:139], a[96:99], v[88:91]
ds_read_b64_tr_b16 v[202:203], v10 offset:2048
ds_read_b64_tr_b16 v[204:205], v11 offset:0
s_add_u32 s72, s71, 30720
buffer_load_dwordx4 v4, s[24:27], s72 offen offset:2048 lds
v_mfma_f32_16x16x32_bf16 v[104:107], v[136:139], a[112:115], v[104:107]
ds_read_b64_tr_b16 v[206:207], v11 offset:2048
v_mfma_f32_16x16x32_bf16 v[108:111], v[140:143], a[112:115], v[108:111]
ds_read_b64_tr_b16 v[208:209], v8 offset:4096
v_mfma_f32_16x16x32_bf16 v[92:95], v[140:143], a[96:99], v[92:95]
ds_read_b64_tr_b16 v[210:211], v8 offset:6144
s_add_u32 s72, s71, 46080
buffer_load_dwordx4 v4, s[24:27], s72 offen offset:3072 lds
v_mfma_f32_16x16x32_bf16 v[80:83], v[144:147], a[100:103], v[80:83]
ds_read_b64_tr_b16 v[212:213], v9 offset:4096
ds_read_b64_tr_b16 v[214:215], v9 offset:6144
v_mfma_f32_16x16x32_bf16 v[96:99], v[144:147], a[116:119], v[96:99]
ds_read_b64_tr_b16 v[216:217], v10 offset:4096
s_add_u32 s69, s61, 26
s_and_b32 s69, s69, 7
s_or_b32 s69, s69, 24
s_lshl_b32 s69, s69, 12
s_add_u32 s69, s69, s95
buffer_load_dwordx4 a[64:67], v1, s[44:47], s69 offen sc1
v_mfma_f32_16x16x32_bf16 v[100:103], v[148:151], a[116:119], v[100:103]
ds_read_b64_tr_b16 v[218:219], v10 offset:6144
v_mfma_f32_16x16x32_bf16 v[84:87], v[148:151], a[100:103], v[84:87]
ds_read_b64_tr_b16 v[220:221], v11 offset:4096
buffer_load_dwordx4 a[68:71], v1, s[44:47], s69 offen offset:1024 sc1
v_mfma_f32_16x16x32_bf16 v[88:91], v[152:155], a[100:103], v[88:91]
ds_read_b64_tr_b16 v[222:223], v11 offset:6144
v_mfma_f32_16x16x32_bf16 v[104:107], v[152:155], a[116:119], v[104:107]
ds_read_b64_tr_b16 v[224:225], v8 offset:8192
ds_read_b64_tr_b16 v[226:227], v8 offset:10240
v_mfma_f32_16x16x32_bf16 v[108:111], v[156:159], a[116:119], v[108:111]
ds_read_b64_tr_b16 v[228:229], v9 offset:8192
buffer_load_dwordx4 a[72:75], v1, s[44:47], s69 offen offset:2048 sc1
v_mfma_f32_16x16x32_bf16 v[92:95], v[156:159], a[100:103], v[92:95]
ds_read_b64_tr_b16 v[230:231], v9 offset:10240
v_mfma_f32_16x16x32_bf16 v[80:83], v[160:163], a[104:107], v[80:83]
ds_read_b64_tr_b16 v[232:233], v10 offset:8192
buffer_load_dwordx4 a[76:79], v1, s[44:47], s69 offen offset:3072 sc1
v_mfma_f32_16x16x32_bf16 v[96:99], v[160:163], a[120:123], v[96:99]
ds_read_b64_tr_b16 v[234:235], v10 offset:10240
ds_read_b64_tr_b16 v[236:237], v11 offset:8192
v_mfma_f32_16x16x32_bf16 v[100:103], v[164:167], a[120:123], v[100:103]
ds_read_b64_tr_b16 v[238:239], v11 offset:10240
s_add_u32 s69, s69, 0x20000
buffer_load_dwordx4 a[80:83], v1, s[44:47], s69 offen sc1
v_mfma_f32_16x16x32_bf16 v[84:87], v[164:167], a[104:107], v[84:87]
ds_read_b64_tr_b16 v[240:241], v8 offset:12288
v_mfma_f32_16x16x32_bf16 v[88:91], v[168:171], a[104:107], v[88:91]
ds_read_b64_tr_b16 v[242:243], v8 offset:14336
v_mfma_f32_16x16x32_bf16 v[104:107], v[168:171], a[120:123], v[104:107]
ds_read_b64_tr_b16 v[244:245], v9 offset:12288
ds_read_b64_tr_b16 v[246:247], v9 offset:14336
buffer_load_dwordx4 a[84:87], v1, s[44:47], s69 offen offset:1024 sc1
v_mfma_f32_16x16x32_bf16 v[108:111], v[172:175], a[120:123], v[108:111]
ds_read_b64_tr_b16 v[248:249], v10 offset:12288
v_mfma_f32_16x16x32_bf16 v[92:95], v[172:175], a[104:107], v[92:95]
ds_read_b64_tr_b16 v[250:251], v10 offset:14336
buffer_load_dwordx4 a[88:91], v1, s[44:47], s69 offen offset:2048 sc1
v_mfma_f32_16x16x32_bf16 v[80:83], v[176:179], a[108:111], v[80:83]
ds_read_b64_tr_b16 v[252:253], v11 offset:12288
v_mfma_f32_16x16x32_bf16 v[96:99], v[176:179], a[124:127], v[96:99]
ds_read_b64_tr_b16 v[254:255], v11 offset:14336
buffer_load_dwordx4 a[92:95], v1, s[44:47], s69 offen offset:3072 sc1
v_mfma_f32_16x16x32_bf16 v[100:103], v[180:183], a[124:127], v[100:103]
v_mfma_f32_16x16x32_bf16 v[84:87], v[180:183], a[108:111], v[84:87]
v_mfma_f32_16x16x32_bf16 v[88:91], v[184:187], a[108:111], v[88:91]
v_mfma_f32_16x16x32_bf16 v[104:107], v[184:187], a[124:127], v[104:107]
v_mfma_f32_16x16x32_bf16 v[108:111], v[188:191], a[124:127], v[108:111]
s_waitcnt vmcnt(24) lgkmcnt(0)
v_mfma_f32_16x16x32_bf16 v[92:95], v[188:191], a[108:111], v[92:95]
s_barrier
v_mfma_f32_16x16x32_bf16 v[80:83], v[192:195], a[0:3], v[80:83]
ds_read_b64_tr_b16 v[128:129], v8 offset:16384
ds_read_b64_tr_b16 v[130:131], v8 offset:18432
s_add_u32 s71, s61, 28
s_and_b32 s71, s71, 7
s_or_b32 s71, s71, 24
s_lshl_b32 s71, s71, 18
s_add_u32 s71, s71, s94
s_add_u32 m0, s64, 98304
s_add_u32 s72, s71, 0
buffer_load_dwordx4 v4, s[24:27], s72 offen lds
v_mfma_f32_16x16x32_bf16 v[96:99], v[192:195], a[16:19], v[96:99]
ds_read_b64_tr_b16 v[132:133], v9 offset:16384
v_mfma_f32_16x16x32_bf16 v[100:103], v[196:199], a[16:19], v[100:103]
ds_read_b64_tr_b16 v[134:135], v9 offset:18432
s_add_u32 s72, s71, 15360
buffer_load_dwordx4 v4, s[24:27], s72 offen offset:1024 lds
v_mfma_f32_16x16x32_bf16 v[84:87], v[196:199], a[0:3], v[84:87]
ds_read_b64_tr_b16 v[136:137], v10 offset:16384
v_mfma_f32_16x16x32_bf16 v[88:91], v[200:203], a[0:3], v[88:91]
ds_read_b64_tr_b16 v[138:139], v10 offset:18432
ds_read_b64_tr_b16 v[140:141], v11 offset:16384
s_add_u32 s72, s71, 30720
buffer_load_dwordx4 v4, s[24:27], s72 offen offset:2048 lds
v_mfma_f32_16x16x32_bf16 v[104:107], v[200:203], a[16:19], v[104:107]
ds_read_b64_tr_b16 v[142:143], v11 offset:18432
v_mfma_f32_16x16x32_bf16 v[108:111], v[204:207], a[16:19], v[108:111]
ds_read_b64_tr_b16 v[144:145], v8 offset:20480
v_mfma_f32_16x16x32_bf16 v[92:95], v[204:207], a[0:3], v[92:95]
ds_read_b64_tr_b16 v[146:147], v8 offset:22528
s_add_u32 s72, s71, 46080
buffer_load_dwordx4 v4, s[24:27], s72 offen offset:3072 lds
v_mfma_f32_16x16x32_bf16 v[80:83], v[208:211], a[4:7], v[80:83]
ds_read_b64_tr_b16 v[148:149], v9 offset:20480
ds_read_b64_tr_b16 v[150:151], v9 offset:22528
v_mfma_f32_16x16x32_bf16 v[96:99], v[208:211], a[20:23], v[96:99]
ds_read_b64_tr_b16 v[152:153], v10 offset:20480
s_add_u32 s69, s61, 27
s_and_b32 s69, s69, 7
s_or_b32 s69, s69, 24
s_lshl_b32 s69, s69, 12
s_add_u32 s69, s69, s95
buffer_load_dwordx4 a[96:99], v1, s[44:47], s69 offen sc1
v_mfma_f32_16x16x32_bf16 v[100:103], v[212:215], a[20:23], v[100:103]
ds_read_b64_tr_b16 v[154:155], v10 offset:22528
v_mfma_f32_16x16x32_bf16 v[84:87], v[212:215], a[4:7], v[84:87]
ds_read_b64_tr_b16 v[156:157], v11 offset:20480
buffer_load_dwordx4 a[100:103], v1, s[44:47], s69 offen offset:1024 sc1
v_mfma_f32_16x16x32_bf16 v[88:91], v[216:219], a[4:7], v[88:91]
ds_read_b64_tr_b16 v[158:159], v11 offset:22528
v_mfma_f32_16x16x32_bf16 v[104:107], v[216:219], a[20:23], v[104:107]
ds_read_b64_tr_b16 v[160:161], v8 offset:24576
ds_read_b64_tr_b16 v[162:163], v8 offset:26624
v_mfma_f32_16x16x32_bf16 v[108:111], v[220:223], a[20:23], v[108:111]
ds_read_b64_tr_b16 v[164:165], v9 offset:24576
buffer_load_dwordx4 a[104:107], v1, s[44:47], s69 offen offset:2048 sc1
v_mfma_f32_16x16x32_bf16 v[92:95], v[220:223], a[4:7], v[92:95]
ds_read_b64_tr_b16 v[166:167], v9 offset:26624
v_mfma_f32_16x16x32_bf16 v[80:83], v[224:227], a[8:11], v[80:83]
ds_read_b64_tr_b16 v[168:169], v10 offset:24576
buffer_load_dwordx4 a[108:111], v1, s[44:47], s69 offen offset:3072 sc1
v_mfma_f32_16x16x32_bf16 v[96:99], v[224:227], a[24:27], v[96:99]
ds_read_b64_tr_b16 v[170:171], v10 offset:26624
ds_read_b64_tr_b16 v[172:173], v11 offset:24576
v_mfma_f32_16x16x32_bf16 v[100:103], v[228:231], a[24:27], v[100:103]
ds_read_b64_tr_b16 v[174:175], v11 offset:26624
s_add_u32 s69, s69, 0x20000
buffer_load_dwordx4 a[112:115], v1, s[44:47], s69 offen sc1
v_mfma_f32_16x16x32_bf16 v[84:87], v[228:231], a[8:11], v[84:87]
ds_read_b64_tr_b16 v[176:177], v8 offset:28672
v_mfma_f32_16x16x32_bf16 v[88:91], v[232:235], a[8:11], v[88:91]
ds_read_b64_tr_b16 v[178:179], v8 offset:30720
v_mfma_f32_16x16x32_bf16 v[104:107], v[232:235], a[24:27], v[104:107]
ds_read_b64_tr_b16 v[180:181], v9 offset:28672
ds_read_b64_tr_b16 v[182:183], v9 offset:30720
buffer_load_dwordx4 a[116:119], v1, s[44:47], s69 offen offset:1024 sc1
v_mfma_f32_16x16x32_bf16 v[108:111], v[236:239], a[24:27], v[108:111]
ds_read_b64_tr_b16 v[184:185], v10 offset:28672
v_mfma_f32_16x16x32_bf16 v[92:95], v[236:239], a[8:11], v[92:95]
ds_read_b64_tr_b16 v[186:187], v10 offset:30720
buffer_load_dwordx4 a[120:123], v1, s[44:47], s69 offen offset:2048 sc1
v_mfma_f32_16x16x32_bf16 v[80:83], v[240:243], a[12:15], v[80:83]
ds_read_b64_tr_b16 v[188:189], v11 offset:28672
v_mfma_f32_16x16x32_bf16 v[96:99], v[240:243], a[28:31], v[96:99]
ds_read_b64_tr_b16 v[190:191], v11 offset:30720
buffer_load_dwordx4 a[124:127], v1, s[44:47], s69 offen offset:3072 sc1
v_mfma_f32_16x16x32_bf16 v[100:103], v[244:247], a[28:31], v[100:103]
v_mfma_f32_16x16x32_bf16 v[84:87], v[244:247], a[12:15], v[84:87]
v_mfma_f32_16x16x32_bf16 v[88:91], v[248:251], a[12:15], v[88:91]
v_mfma_f32_16x16x32_bf16 v[104:107], v[248:251], a[28:31], v[104:107]
v_mfma_f32_16x16x32_bf16 v[108:111], v[252:255], a[28:31], v[108:111]
s_waitcnt vmcnt(24) lgkmcnt(0)
v_mfma_f32_16x16x32_bf16 v[92:95], v[252:255], a[12:15], v[92:95]
s_barrier
v_mfma_f32_16x16x32_bf16 v[80:83], v[128:131], a[32:35], v[80:83]
ds_read_b64_tr_b16 v[192:193], v8 offset:32768
ds_read_b64_tr_b16 v[194:195], v8 offset:34816
s_add_u32 s71, s61, 29
s_and_b32 s71, s71, 7
s_or_b32 s71, s71, 24
s_lshl_b32 s71, s71, 18
s_add_u32 s71, s71, s94
s_add_u32 m0, s64, 114688
s_add_u32 s72, s71, 0
buffer_load_dwordx4 v4, s[24:27], s72 offen lds
s_lshl_b32 s74, s76, 11
s_add_u32 s74, s74, 0x3810000
v_and_b32 v2, 15, v0
v_lshlrev_b32 v2, 7, v2
buffer_load_dword v3, v2, s[44:47], s74 offen sc1
v_mfma_f32_16x16x32_bf16 v[96:99], v[128:131], a[48:51], v[96:99]
ds_read_b64_tr_b16 v[196:197], v9 offset:32768
v_mfma_f32_16x16x32_bf16 v[100:103], v[132:135], a[48:51], v[100:103]
ds_read_b64_tr_b16 v[198:199], v9 offset:34816
s_add_u32 s72, s71, 15360
buffer_load_dwordx4 v4, s[24:27], s72 offen offset:1024 lds
v_mfma_f32_16x16x32_bf16 v[84:87], v[132:135], a[32:35], v[84:87]
ds_read_b64_tr_b16 v[200:201], v10 offset:32768
v_mfma_f32_16x16x32_bf16 v[88:91], v[136:139], a[32:35], v[88:91]
ds_read_b64_tr_b16 v[202:203], v10 offset:34816
ds_read_b64_tr_b16 v[204:205], v11 offset:32768
s_add_u32 s72, s71, 30720
buffer_load_dwordx4 v4, s[24:27], s72 offen offset:2048 lds
v_mfma_f32_16x16x32_bf16 v[104:107], v[136:139], a[48:51], v[104:107]
ds_read_b64_tr_b16 v[206:207], v11 offset:34816
v_mfma_f32_16x16x32_bf16 v[108:111], v[140:143], a[48:51], v[108:111]
ds_read_b64_tr_b16 v[208:209], v8 offset:36864
v_mfma_f32_16x16x32_bf16 v[92:95], v[140:143], a[32:35], v[92:95]
ds_read_b64_tr_b16 v[210:211], v8 offset:38912
s_add_u32 s72, s71, 46080
buffer_load_dwordx4 v4, s[24:27], s72 offen offset:3072 lds
v_mfma_f32_16x16x32_bf16 v[80:83], v[144:147], a[36:39], v[80:83]
ds_read_b64_tr_b16 v[212:213], v9 offset:36864
ds_read_b64_tr_b16 v[214:215], v9 offset:38912
v_mfma_f32_16x16x32_bf16 v[96:99], v[144:147], a[52:55], v[96:99]
ds_read_b64_tr_b16 v[216:217], v10 offset:36864
s_add_u32 s69, s61, 28
s_and_b32 s69, s69, 7
s_or_b32 s69, s69, 24
s_lshl_b32 s69, s69, 12
s_add_u32 s69, s69, s95
buffer_load_dwordx4 a[0:3], v1, s[44:47], s69 offen sc1
v_mfma_f32_16x16x32_bf16 v[100:103], v[148:151], a[52:55], v[100:103]
ds_read_b64_tr_b16 v[218:219], v10 offset:38912
v_mfma_f32_16x16x32_bf16 v[84:87], v[148:151], a[36:39], v[84:87]
ds_read_b64_tr_b16 v[220:221], v11 offset:36864
buffer_load_dwordx4 a[4:7], v1, s[44:47], s69 offen offset:1024 sc1
v_mfma_f32_16x16x32_bf16 v[88:91], v[152:155], a[36:39], v[88:91]
ds_read_b64_tr_b16 v[222:223], v11 offset:38912
v_mfma_f32_16x16x32_bf16 v[104:107], v[152:155], a[52:55], v[104:107]
ds_read_b64_tr_b16 v[224:225], v8 offset:40960
ds_read_b64_tr_b16 v[226:227], v8 offset:43008
v_mfma_f32_16x16x32_bf16 v[108:111], v[156:159], a[52:55], v[108:111]
ds_read_b64_tr_b16 v[228:229], v9 offset:40960
buffer_load_dwordx4 a[8:11], v1, s[44:47], s69 offen offset:2048 sc1
v_mfma_f32_16x16x32_bf16 v[92:95], v[156:159], a[36:39], v[92:95]
ds_read_b64_tr_b16 v[230:231], v9 offset:43008
v_mfma_f32_16x16x32_bf16 v[80:83], v[160:163], a[40:43], v[80:83]
ds_read_b64_tr_b16 v[232:233], v10 offset:40960
buffer_load_dwordx4 a[12:15], v1, s[44:47], s69 offen offset:3072 sc1
v_mfma_f32_16x16x32_bf16 v[96:99], v[160:163], a[56:59], v[96:99]
ds_read_b64_tr_b16 v[234:235], v10 offset:43008
ds_read_b64_tr_b16 v[236:237], v11 offset:40960
v_mfma_f32_16x16x32_bf16 v[100:103], v[164:167], a[56:59], v[100:103]
ds_read_b64_tr_b16 v[238:239], v11 offset:43008
s_add_u32 s69, s69, 0x20000
buffer_load_dwordx4 a[16:19], v1, s[44:47], s69 offen sc1
v_mfma_f32_16x16x32_bf16 v[84:87], v[164:167], a[40:43], v[84:87]
ds_read_b64_tr_b16 v[240:241], v8 offset:45056
v_mfma_f32_16x16x32_bf16 v[88:91], v[168:171], a[40:43], v[88:91]
ds_read_b64_tr_b16 v[242:243], v8 offset:47104
v_mfma_f32_16x16x32_bf16 v[104:107], v[168:171], a[56:59], v[104:107]
ds_read_b64_tr_b16 v[244:245], v9 offset:45056
ds_read_b64_tr_b16 v[246:247], v9 offset:47104
buffer_load_dwordx4 a[20:23], v1, s[44:47], s69 offen offset:1024 sc1
v_mfma_f32_16x16x32_bf16 v[108:111], v[172:175], a[56:59], v[108:111]
ds_read_b64_tr_b16 v[248:249], v10 offset:45056
v_mfma_f32_16x16x32_bf16 v[92:95], v[172:175], a[40:43], v[92:95]
ds_read_b64_tr_b16 v[250:251], v10 offset:47104
buffer_load_dwordx4 a[24:27], v1, s[44:47], s69 offen offset:2048 sc1
v_mfma_f32_16x16x32_bf16 v[80:83], v[176:179], a[44:47], v[80:83]
ds_read_b64_tr_b16 v[252:253], v11 offset:45056
v_mfma_f32_16x16x32_bf16 v[96:99], v[176:179], a[60:63], v[96:99]
ds_read_b64_tr_b16 v[254:255], v11 offset:47104
buffer_load_dwordx4 a[28:31], v1, s[44:47], s69 offen offset:3072 sc1
v_mfma_f32_16x16x32_bf16 v[100:103], v[180:183], a[60:63], v[100:103]
v_mfma_f32_16x16x32_bf16 v[84:87], v[180:183], a[44:47], v[84:87]
v_mfma_f32_16x16x32_bf16 v[88:91], v[184:187], a[44:47], v[88:91]
v_mfma_f32_16x16x32_bf16 v[104:107], v[184:187], a[60:63], v[104:107]
v_mfma_f32_16x16x32_bf16 v[108:111], v[188:191], a[60:63], v[108:111]
s_waitcnt vmcnt(25) lgkmcnt(0)
v_mfma_f32_16x16x32_bf16 v[92:95], v[188:191], a[44:47], v[92:95]
s_barrier
v_mfma_f32_16x16x32_bf16 v[80:83], v[192:195], a[64:67], v[80:83]
ds_read_b64_tr_b16 v[128:129], v8 offset:49152
ds_read_b64_tr_b16 v[130:131], v8 offset:51200
s_add_u32 s71, s61, 30
s_and_b32 s71, s71, 7
s_or_b32 s71, s71, 24
s_lshl_b32 s71, s71, 18
s_add_u32 s71, s71, s94
s_add_u32 m0, s64, 131072
s_add_u32 s72, s71, 0
buffer_load_dwordx4 v4, s[24:27], s72 offen lds
v_mfma_f32_16x16x32_bf16 v[96:99], v[192:195], a[80:83], v[96:99]
ds_read_b64_tr_b16 v[132:133], v9 offset:49152
v_mfma_f32_16x16x32_bf16 v[100:103], v[196:199], a[80:83], v[100:103]
ds_read_b64_tr_b16 v[134:135], v9 offset:51200
s_add_u32 s72, s71, 15360
buffer_load_dwordx4 v4, s[24:27], s72 offen offset:1024 lds
v_mfma_f32_16x16x32_bf16 v[84:87], v[196:199], a[64:67], v[84:87]
ds_read_b64_tr_b16 v[136:137], v10 offset:49152
v_mfma_f32_16x16x32_bf16 v[88:91], v[200:203], a[64:67], v[88:91]
ds_read_b64_tr_b16 v[138:139], v10 offset:51200
ds_read_b64_tr_b16 v[140:141], v11 offset:49152
s_add_u32 s72, s71, 30720
buffer_load_dwordx4 v4, s[24:27], s72 offen offset:2048 lds
v_mfma_f32_16x16x32_bf16 v[104:107], v[200:203], a[80:83], v[104:107]
ds_read_b64_tr_b16 v[142:143], v11 offset:51200
v_mfma_f32_16x16x32_bf16 v[108:111], v[204:207], a[80:83], v[108:111]
ds_read_b64_tr_b16 v[144:145], v8 offset:53248
v_mfma_f32_16x16x32_bf16 v[92:95], v[204:207], a[64:67], v[92:95]
ds_read_b64_tr_b16 v[146:147], v8 offset:55296
s_add_u32 s72, s71, 46080
buffer_load_dwordx4 v4, s[24:27], s72 offen offset:3072 lds
v_mfma_f32_16x16x32_bf16 v[80:83], v[208:211], a[68:71], v[80:83]
ds_read_b64_tr_b16 v[148:149], v9 offset:53248
ds_read_b64_tr_b16 v[150:151], v9 offset:55296
v_mfma_f32_16x16x32_bf16 v[96:99], v[208:211], a[84:87], v[96:99]
ds_read_b64_tr_b16 v[152:153], v10 offset:53248
s_add_u32 s69, s61, 29
s_and_b32 s69, s69, 7
s_or_b32 s69, s69, 24
s_lshl_b32 s69, s69, 12
s_add_u32 s69, s69, s95
buffer_load_dwordx4 a[32:35], v1, s[44:47], s69 offen sc1
v_mfma_f32_16x16x32_bf16 v[100:103], v[212:215], a[84:87], v[100:103]
ds_read_b64_tr_b16 v[154:155], v10 offset:55296
v_mfma_f32_16x16x32_bf16 v[84:87], v[212:215], a[68:71], v[84:87]
ds_read_b64_tr_b16 v[156:157], v11 offset:53248
buffer_load_dwordx4 a[36:39], v1, s[44:47], s69 offen offset:1024 sc1
v_mfma_f32_16x16x32_bf16 v[88:91], v[216:219], a[68:71], v[88:91]
ds_read_b64_tr_b16 v[158:159], v11 offset:55296
v_mfma_f32_16x16x32_bf16 v[104:107], v[216:219], a[84:87], v[104:107]
ds_read_b64_tr_b16 v[160:161], v8 offset:57344
ds_read_b64_tr_b16 v[162:163], v8 offset:59392
v_mfma_f32_16x16x32_bf16 v[108:111], v[220:223], a[84:87], v[108:111]
ds_read_b64_tr_b16 v[164:165], v9 offset:57344
buffer_load_dwordx4 a[40:43], v1, s[44:47], s69 offen offset:2048 sc1
v_mfma_f32_16x16x32_bf16 v[92:95], v[220:223], a[68:71], v[92:95]
ds_read_b64_tr_b16 v[166:167], v9 offset:59392
v_mfma_f32_16x16x32_bf16 v[80:83], v[224:227], a[72:75], v[80:83]
ds_read_b64_tr_b16 v[168:169], v10 offset:57344
buffer_load_dwordx4 a[44:47], v1, s[44:47], s69 offen offset:3072 sc1
v_mfma_f32_16x16x32_bf16 v[96:99], v[224:227], a[88:91], v[96:99]
ds_read_b64_tr_b16 v[170:171], v10 offset:59392
ds_read_b64_tr_b16 v[172:173], v11 offset:57344
v_mfma_f32_16x16x32_bf16 v[100:103], v[228:231], a[88:91], v[100:103]
ds_read_b64_tr_b16 v[174:175], v11 offset:59392
s_add_u32 s69, s69, 0x20000
buffer_load_dwordx4 a[48:51], v1, s[44:47], s69 offen sc1
v_mfma_f32_16x16x32_bf16 v[84:87], v[228:231], a[72:75], v[84:87]
ds_read_b64_tr_b16 v[176:177], v8 offset:61440
v_mfma_f32_16x16x32_bf16 v[88:91], v[232:235], a[72:75], v[88:91]
ds_read_b64_tr_b16 v[178:179], v8 offset:63488
v_mfma_f32_16x16x32_bf16 v[104:107], v[232:235], a[88:91], v[104:107]
ds_read_b64_tr_b16 v[180:181], v9 offset:61440
ds_read_b64_tr_b16 v[182:183], v9 offset:63488
buffer_load_dwordx4 a[52:55], v1, s[44:47], s69 offen offset:1024 sc1
v_mfma_f32_16x16x32_bf16 v[108:111], v[236:239], a[88:91], v[108:111]
ds_read_b64_tr_b16 v[184:185], v10 offset:61440
v_mfma_f32_16x16x32_bf16 v[92:95], v[236:239], a[72:75], v[92:95]
ds_read_b64_tr_b16 v[186:187], v10 offset:63488
buffer_load_dwordx4 a[56:59], v1, s[44:47], s69 offen offset:2048 sc1
v_mfma_f32_16x16x32_bf16 v[80:83], v[240:243], a[76:79], v[80:83]
ds_read_b64_tr_b16 v[188:189], v11 offset:61440
v_mfma_f32_16x16x32_bf16 v[96:99], v[240:243], a[92:95], v[96:99]
ds_read_b64_tr_b16 v[190:191], v11 offset:63488
buffer_load_dwordx4 a[60:63], v1, s[44:47], s69 offen offset:3072 sc1
v_mfma_f32_16x16x32_bf16 v[100:103], v[244:247], a[92:95], v[100:103]
v_mfma_f32_16x16x32_bf16 v[84:87], v[244:247], a[76:79], v[84:87]
v_mfma_f32_16x16x32_bf16 v[88:91], v[248:251], a[76:79], v[88:91]
v_mfma_f32_16x16x32_bf16 v[104:107], v[248:251], a[92:95], v[104:107]
v_mfma_f32_16x16x32_bf16 v[108:111], v[252:255], a[92:95], v[108:111]
s_waitcnt vmcnt(25) lgkmcnt(0)
v_mfma_f32_16x16x32_bf16 v[92:95], v[252:255], a[76:79], v[92:95]
s_barrier
v_mfma_f32_16x16x32_bf16 v[80:83], v[128:131], a[96:99], v[80:83]
ds_read_b64_tr_b16 v[192:193], v8 offset:0
ds_read_b64_tr_b16 v[194:195], v8 offset:2048
s_add_u32 s71, s61, 31
s_and_b32 s71, s71, 7
s_or_b32 s71, s71, 24
s_lshl_b32 s71, s71, 18
s_add_u32 s71, s71, s94
s_add_u32 m0, s64, 147456
s_add_u32 s72, s71, 0
buffer_load_dwordx4 v4, s[24:27], s72 offen lds
v_mfma_f32_16x16x32_bf16 v[96:99], v[128:131], a[112:115], v[96:99]
ds_read_b64_tr_b16 v[196:197], v9 offset:0
v_mfma_f32_16x16x32_bf16 v[100:103], v[132:135], a[112:115], v[100:103]
ds_read_b64_tr_b16 v[198:199], v9 offset:2048
s_add_u32 s72, s71, 15360
buffer_load_dwordx4 v4, s[24:27], s72 offen offset:1024 lds
v_mfma_f32_16x16x32_bf16 v[84:87], v[132:135], a[96:99], v[84:87]
ds_read_b64_tr_b16 v[200:201], v10 offset:0
v_mfma_f32_16x16x32_bf16 v[88:91], v[136:139], a[96:99], v[88:91]
ds_read_b64_tr_b16 v[202:203], v10 offset:2048
ds_read_b64_tr_b16 v[204:205], v11 offset:0
s_add_u32 s72, s71, 30720
buffer_load_dwordx4 v4, s[24:27], s72 offen offset:2048 lds
v_mfma_f32_16x16x32_bf16 v[104:107], v[136:139], a[112:115], v[104:107]
ds_read_b64_tr_b16 v[206:207], v11 offset:2048
v_mfma_f32_16x16x32_bf16 v[108:111], v[140:143], a[112:115], v[108:111]
ds_read_b64_tr_b16 v[208:209], v8 offset:4096
v_mfma_f32_16x16x32_bf16 v[92:95], v[140:143], a[96:99], v[92:95]
ds_read_b64_tr_b16 v[210:211], v8 offset:6144
s_add_u32 s72, s71, 46080
buffer_load_dwordx4 v4, s[24:27], s72 offen offset:3072 lds
v_mfma_f32_16x16x32_bf16 v[80:83], v[144:147], a[100:103], v[80:83]
ds_read_b64_tr_b16 v[212:213], v9 offset:4096
ds_read_b64_tr_b16 v[214:215], v9 offset:6144
v_mfma_f32_16x16x32_bf16 v[96:99], v[144:147], a[116:119], v[96:99]
ds_read_b64_tr_b16 v[216:217], v10 offset:4096
s_add_u32 s69, s61, 30
s_and_b32 s69, s69, 7
s_or_b32 s69, s69, 24
s_lshl_b32 s69, s69, 12
s_add_u32 s69, s69, s95
buffer_load_dwordx4 a[64:67], v1, s[44:47], s69 offen sc1
v_mfma_f32_16x16x32_bf16 v[100:103], v[148:151], a[116:119], v[100:103]
ds_read_b64_tr_b16 v[218:219], v10 offset:6144
v_mfma_f32_16x16x32_bf16 v[84:87], v[148:151], a[100:103], v[84:87]
ds_read_b64_tr_b16 v[220:221], v11 offset:4096
buffer_load_dwordx4 a[68:71], v1, s[44:47], s69 offen offset:1024 sc1
v_mfma_f32_16x16x32_bf16 v[88:91], v[152:155], a[100:103], v[88:91]
ds_read_b64_tr_b16 v[222:223], v11 offset:6144
v_mfma_f32_16x16x32_bf16 v[104:107], v[152:155], a[116:119], v[104:107]
ds_read_b64_tr_b16 v[224:225], v8 offset:8192
ds_read_b64_tr_b16 v[226:227], v8 offset:10240
v_mfma_f32_16x16x32_bf16 v[108:111], v[156:159], a[116:119], v[108:111]
ds_read_b64_tr_b16 v[228:229], v9 offset:8192
buffer_load_dwordx4 a[72:75], v1, s[44:47], s69 offen offset:2048 sc1
v_mfma_f32_16x16x32_bf16 v[92:95], v[156:159], a[100:103], v[92:95]
ds_read_b64_tr_b16 v[230:231], v9 offset:10240
v_mfma_f32_16x16x32_bf16 v[80:83], v[160:163], a[104:107], v[80:83]
ds_read_b64_tr_b16 v[232:233], v10 offset:8192
buffer_load_dwordx4 a[76:79], v1, s[44:47], s69 offen offset:3072 sc1
v_mfma_f32_16x16x32_bf16 v[96:99], v[160:163], a[120:123], v[96:99]
ds_read_b64_tr_b16 v[234:235], v10 offset:10240
ds_read_b64_tr_b16 v[236:237], v11 offset:8192
v_mfma_f32_16x16x32_bf16 v[100:103], v[164:167], a[120:123], v[100:103]
ds_read_b64_tr_b16 v[238:239], v11 offset:10240
s_add_u32 s69, s69, 0x20000
buffer_load_dwordx4 a[80:83], v1, s[44:47], s69 offen sc1
v_mfma_f32_16x16x32_bf16 v[84:87], v[164:167], a[104:107], v[84:87]
ds_read_b64_tr_b16 v[240:241], v8 offset:12288
v_mfma_f32_16x16x32_bf16 v[88:91], v[168:171], a[104:107], v[88:91]
ds_read_b64_tr_b16 v[242:243], v8 offset:14336
v_mfma_f32_16x16x32_bf16 v[104:107], v[168:171], a[120:123], v[104:107]
ds_read_b64_tr_b16 v[244:245], v9 offset:12288
ds_read_b64_tr_b16 v[246:247], v9 offset:14336
buffer_load_dwordx4 a[84:87], v1, s[44:47], s69 offen offset:1024 sc1
v_mfma_f32_16x16x32_bf16 v[108:111], v[172:175], a[120:123], v[108:111]
ds_read_b64_tr_b16 v[248:249], v10 offset:12288
v_mfma_f32_16x16x32_bf16 v[92:95], v[172:175], a[104:107], v[92:95]
ds_read_b64_tr_b16 v[250:251], v10 offset:14336
buffer_load_dwordx4 a[88:91], v1, s[44:47], s69 offen offset:2048 sc1
v_mfma_f32_16x16x32_bf16 v[80:83], v[176:179], a[108:111], v[80:83]
ds_read_b64_tr_b16 v[252:253], v11 offset:12288
v_mfma_f32_16x16x32_bf16 v[96:99], v[176:179], a[124:127], v[96:99]
ds_read_b64_tr_b16 v[254:255], v11 offset:14336
buffer_load_dwordx4 a[92:95], v1, s[44:47], s69 offen offset:3072 sc1
v_mfma_f32_16x16x32_bf16 v[100:103], v[180:183], a[124:127], v[100:103]
v_mfma_f32_16x16x32_bf16 v[84:87], v[180:183], a[108:111], v[84:87]
v_mfma_f32_16x16x32_bf16 v[88:91], v[184:187], a[108:111], v[88:91]
v_mfma_f32_16x16x32_bf16 v[104:107], v[184:187], a[124:127], v[104:107]
v_mfma_f32_16x16x32_bf16 v[108:111], v[188:191], a[124:127], v[108:111]
s_waitcnt vmcnt(24) lgkmcnt(0)
v_mfma_f32_16x16x32_bf16 v[92:95], v[188:191], a[108:111], v[92:95]
s_barrier
v_mfma_f32_16x16x32_bf16 v[80:83], v[192:195], a[0:3], v[80:83]
ds_read_b64_tr_b16 v[128:129], v8 offset:16384
ds_read_b64_tr_b16 v[130:131], v8 offset:18432
s_add_u32 s69, s61, 31
s_and_b32 s69, s69, 7
s_or_b32 s69, s69, 24
s_lshl_b32 s69, s69, 12
s_add_u32 s69, s69, s95
buffer_load_dwordx4 a[96:99], v1, s[44:47], s69 offen sc1
v_mfma_f32_16x16x32_bf16 v[96:99], v[192:195], a[16:19], v[96:99]
ds_read_b64_tr_b16 v[132:133], v9 offset:16384
v_mfma_f32_16x16x32_bf16 v[100:103], v[196:199], a[16:19], v[100:103]
ds_read_b64_tr_b16 v[134:135], v9 offset:18432
buffer_load_dwordx4 a[100:103], v1, s[44:47], s69 offen offset:1024 sc1
v_mfma_f32_16x16x32_bf16 v[84:87], v[196:199], a[0:3], v[84:87]
ds_read_b64_tr_b16 v[136:137], v10 offset:16384
v_mfma_f32_16x16x32_bf16 v[88:91], v[200:203], a[0:3], v[88:91]
ds_read_b64_tr_b16 v[138:139], v10 offset:18432
ds_read_b64_tr_b16 v[140:141], v11 offset:16384
buffer_load_dwordx4 a[104:107], v1, s[44:47], s69 offen offset:2048 sc1
v_mfma_f32_16x16x32_bf16 v[104:107], v[200:203], a[16:19], v[104:107]
ds_read_b64_tr_b16 v[142:143], v11 offset:18432
v_mfma_f32_16x16x32_bf16 v[108:111], v[204:207], a[16:19], v[108:111]
ds_read_b64_tr_b16 v[144:145], v8 offset:20480
v_mfma_f32_16x16x32_bf16 v[92:95], v[204:207], a[0:3], v[92:95]
ds_read_b64_tr_b16 v[146:147], v8 offset:22528
buffer_load_dwordx4 a[108:111], v1, s[44:47], s69 offen offset:3072 sc1
v_mfma_f32_16x16x32_bf16 v[80:83], v[208:211], a[4:7], v[80:83]
ds_read_b64_tr_b16 v[148:149], v9 offset:20480
ds_read_b64_tr_b16 v[150:151], v9 offset:22528
v_mfma_f32_16x16x32_bf16 v[96:99], v[208:211], a[20:23], v[96:99]
ds_read_b64_tr_b16 v[152:153], v10 offset:20480
s_add_u32 s69, s69, 0x20000
buffer_load_dwordx4 a[112:115], v1, s[44:47], s69 offen sc1
v_mfma_f32_16x16x32_bf16 v[100:103], v[212:215], a[20:23], v[100:103]
ds_read_b64_tr_b16 v[154:155], v10 offset:22528
v_mfma_f32_16x16x32_bf16 v[84:87], v[212:215], a[4:7], v[84:87]
ds_read_b64_tr_b16 v[156:157], v11 offset:20480
buffer_load_dwordx4 a[116:119], v1, s[44:47], s69 offen offset:1024 sc1
v_mfma_f32_16x16x32_bf16 v[88:91], v[216:219], a[4:7], v[88:91]
ds_read_b64_tr_b16 v[158:159], v11 offset:22528
v_mfma_f32_16x16x32_bf16 v[104:107], v[216:219], a[20:23], v[104:107]
ds_read_b64_tr_b16 v[160:161], v8 offset:24576
ds_read_b64_tr_b16 v[162:163], v8 offset:26624
v_mfma_f32_16x16x32_bf16 v[108:111], v[220:223], a[20:23], v[108:111]
ds_read_b64_tr_b16 v[164:165], v9 offset:24576
buffer_load_dwordx4 a[120:123], v1, s[44:47], s69 offen offset:2048 sc1
v_mfma_f32_16x16x32_bf16 v[92:95], v[220:223], a[4:7], v[92:95]
ds_read_b64_tr_b16 v[166:167], v9 offset:26624
v_mfma_f32_16x16x32_bf16 v[80:83], v[224:227], a[8:11], v[80:83]
ds_read_b64_tr_b16 v[168:169], v10 offset:24576
buffer_load_dwordx4 a[124:127], v1, s[44:47], s69 offen offset:3072 sc1
v_mfma_f32_16x16x32_bf16 v[96:99], v[224:227], a[24:27], v[96:99]
ds_read_b64_tr_b16 v[170:171], v10 offset:26624
ds_read_b64_tr_b16 v[172:173], v11 offset:24576
v_mfma_f32_16x16x32_bf16 v[100:103], v[228:231], a[24:27], v[100:103]
ds_read_b64_tr_b16 v[174:175], v11 offset:26624
s_lshl_b32 s70, s75, 18
s_add_u32 s70, s70, s94
s_add_u32 m0, s64, 0
s_add_u32 s72, s70, 0
buffer_load_dwordx4 v4, s[4:7], s72 offen lds
v_mfma_f32_16x16x32_bf16 v[84:87], v[228:231], a[8:11], v[84:87]
ds_read_b64_tr_b16 v[176:177], v8 offset:28672
v_mfma_f32_16x16x32_bf16 v[88:91], v[232:235], a[8:11], v[88:91]
ds_read_b64_tr_b16 v[178:179], v8 offset:30720
v_mfma_f32_16x16x32_bf16 v[104:107], v[232:235], a[24:27], v[104:107]
ds_read_b64_tr_b16 v[180:181], v9 offset:28672
ds_read_b64_tr_b16 v[182:183], v9 offset:30720
s_add_u32 s72, s70, 15360
buffer_load_dwordx4 v4, s[4:7], s72 offen offset:1024 lds
v_mfma_f32_16x16x32_bf16 v[108:111], v[236:239], a[24:27], v[108:111]
ds_read_b64_tr_b16 v[184:185], v10 offset:28672
v_mfma_f32_16x16x32_bf16 v[92:95], v[236:239], a[8:11], v[92:95]
ds_read_b64_tr_b16 v[186:187], v10 offset:30720
s_add_u32 s72, s70, 30720
buffer_load_dwordx4 v4, s[4:7], s72 offen offset:2048 lds
v_mfma_f32_16x16x32_bf16 v[80:83], v[240:243], a[12:15], v[80:83]
ds_read_b64_tr_b16 v[188:189], v11 offset:28672
v_mfma_f32_16x16x32_bf16 v[96:99], v[240:243], a[28:31], v[96:99]
ds_read_b64_tr_b16 v[190:191], v11 offset:30720
s_add_u32 s72, s70, 46080
buffer_load_dwordx4 v4, s[4:7], s72 offen offset:3072 lds
v_mfma_f32_16x16x32_bf16 v[100:103], v[244:247], a[28:31], v[100:103]
v_mfma_f32_16x16x32_bf16 v[84:87], v[244:247], a[12:15], v[84:87]
v_mfma_f32_16x16x32_bf16 v[88:91], v[248:251], a[12:15], v[88:91]
v_mfma_f32_16x16x32_bf16 v[104:107], v[248:251], a[28:31], v[104:107]
s_waitcnt vmcnt(47)
v_cmp_gt_u32 vcc, 3, v3
s_cbranch_vccnz Lspin63
Lback64:
s_lshl_b32 s73, s76, 18
s_lshl_b32 s74, s58, 16
s_add_u32 s73, s73, s74
s_lshl_b32 s74, s75, 8
s_add_u32 s73, s73, s74
s_add_u32 s73, s73, 0x3400000
v_lshrrev_b32 v112, 4, v0
v_and_b32 v113, 15, v0
v_lshlrev_b32 v114, 4, v113
v_lshl_add_u32 v112, v112, 12, v114
s_add_u32 m0, s64, 16384
s_add_u32 s72, s73, 0
buffer_load_dwordx4 v112, s[44:47], s72 offen sc1 lds
s_add_u32 s72, s73, 15360
buffer_load_dwordx4 v112, s[44:47], s72 offen offset:1024 sc1 lds
s_add_u32 s72, s73, 30720
buffer_load_dwordx4 v112, s[44:47], s72 offen offset:2048 sc1 lds
s_add_u32 s72, s73, 46080
buffer_load_dwordx4 v112, s[44:47], s72 offen offset:3072 sc1 lds
s_lshl_b32 s73, s75, 9
s_lshl_b32 s74, s58, 7
s_add_u32 s73, s73, s74
s_add_u32 s73, s73, 0x3800000
v_lshlrev_b32 v113, 2, v113
buffer_load_dword v6, v113, s[44:47], s73 offen sc1
buffer_load_dword v7, v113, s[44:47], s73 offen offset:64 sc1
v_mfma_f32_16x16x32_bf16 v[108:111], v[252:255], a[28:31], v[108:111]
s_waitcnt vmcnt(30) lgkmcnt(0)
v_mfma_f32_16x16x32_bf16 v[92:95], v[252:255], a[12:15], v[92:95]
s_barrier
v_mfma_f32_16x16x32_bf16 v[80:83], v[128:131], a[32:35], v[80:83]
ds_read_b64_tr_b16 v[192:193], v8 offset:32768
ds_read_b64_tr_b16 v[194:195], v8 offset:34816
v_mfma_f32_16x16x32_bf16 v[96:99], v[128:131], a[48:51], v[96:99]
ds_read_b64_tr_b16 v[196:197], v9 offset:32768
v_mfma_f32_16x16x32_bf16 v[100:103], v[132:135], a[48:51], v[100:103]
ds_read_b64_tr_b16 v[198:199], v9 offset:34816
v_mfma_f32_16x16x32_bf16 v[84:87], v[132:135], a[32:35], v[84:87]
ds_read_b64_tr_b16 v[200:201], v10 offset:32768
v_mfma_f32_16x16x32_bf16 v[88:91], v[136:139], a[32:35], v[88:91]
ds_read_b64_tr_b16 v[202:203], v10 offset:34816
ds_read_b64_tr_b16 v[204:205], v11 offset:32768
v_mfma_f32_16x16x32_bf16 v[104:107], v[136:139], a[48:51], v[104:107]
ds_read_b64_tr_b16 v[206:207], v11 offset:34816
v_mfma_f32_16x16x32_bf16 v[108:111], v[140:143], a[48:51], v[108:111]
ds_read_b64_tr_b16 v[208:209], v8 offset:36864
v_mfma_f32_16x16x32_bf16 v[92:95], v[140:143], a[32:35], v[92:95]
ds_read_b64_tr_b16 v[210:211], v8 offset:38912
v_mfma_f32_16x16x32_bf16 v[80:83], v[144:147], a[36:39], v[80:83]
ds_read_b64_tr_b16 v[212:213], v9 offset:36864
ds_read_b64_tr_b16 v[214:215], v9 offset:38912
v_mfma_f32_16x16x32_bf16 v[96:99], v[144:147], a[52:55], v[96:99]
ds_read_b64_tr_b16 v[216:217], v10 offset:36864
v_mfma_f32_16x16x32_bf16 v[100:103], v[148:151], a[52:55], v[100:103]
ds_read_b64_tr_b16 v[218:219], v10 offset:38912
v_mfma_f32_16x16x32_bf16 v[84:87], v[148:151], a[36:39], v[84:87]
ds_read_b64_tr_b16 v[220:221], v11 offset:36864
v_mfma_f32_16x16x32_bf16 v[88:91], v[152:155], a[36:39], v[88:91]
ds_read_b64_tr_b16 v[222:223], v11 offset:38912
v_mfma_f32_16x16x32_bf16 v[104:107], v[152:155], a[52:55], v[104:107]
ds_read_b64_tr_b16 v[224:225], v8 offset:40960
ds_read_b64_tr_b16 v[226:227], v8 offset:43008
v_mfma_f32_16x16x32_bf16 v[108:111], v[156:159], a[52:55], v[108:111]
ds_read_b64_tr_b16 v[228:229], v9 offset:40960
v_mfma_f32_16x16x32_bf16 v[92:95], v[156:159], a[36:39], v[92:95]
ds_read_b64_tr_b16 v[230:231], v9 offset:43008
v_mfma_f32_16x16x32_bf16 v[80:83], v[160:163], a[40:43], v[80:83]
ds_read_b64_tr_b16 v[232:233], v10 offset:40960
v_mfma_f32_16x16x32_bf16 v[96:99], v[160:163], a[56:59], v[96:99]
ds_read_b64_tr_b16 v[234:235], v10 offset:43008
ds_read_b64_tr_b16 v[236:237], v11 offset:40960
v_mfma_f32_16x16x32_bf16 v[100:103], v[164:167], a[56:59], v[100:103]
ds_read_b64_tr_b16 v[238:239], v11 offset:43008
v_mfma_f32_16x16x32_bf16 v[84:87], v[164:167], a[40:43], v[84:87]
ds_read_b64_tr_b16 v[240:241], v8 offset:45056
v_mfma_f32_16x16x32_bf16 v[88:91], v[168:171], a[40:43], v[88:91]
ds_read_b64_tr_b16 v[242:243], v8 offset:47104
v_mfma_f32_16x16x32_bf16 v[104:107], v[168:171], a[56:59], v[104:107]
ds_read_b64_tr_b16 v[244:245], v9 offset:45056
ds_read_b64_tr_b16 v[246:247], v9 offset:47104
v_mfma_f32_16x16x32_bf16 v[108:111], v[172:175], a[56:59], v[108:111]
ds_read_b64_tr_b16 v[248:249], v10 offset:45056
v_mfma_f32_16x16x32_bf16 v[92:95], v[172:175], a[40:43], v[92:95]
ds_read_b64_tr_b16 v[250:251], v10 offset:47104
v_mfma_f32_16x16x32_bf16 v[80:83], v[176:179], a[44:47], v[80:83]
ds_read_b64_tr_b16 v[252:253], v11 offset:45056
v_mfma_f32_16x16x32_bf16 v[96:99], v[176:179], a[60:63], v[96:99]
ds_read_b64_tr_b16 v[254:255], v11 offset:47104
v_mfma_f32_16x16x32_bf16 v[100:103], v[180:183], a[60:63], v[100:103]
v_mfma_f32_16x16x32_bf16 v[84:87], v[180:183], a[44:47], v[84:87]
v_mfma_f32_16x16x32_bf16 v[88:91], v[184:187], a[44:47], v[88:91]
v_mfma_f32_16x16x32_bf16 v[104:107], v[184:187], a[60:63], v[104:107]
v_mfma_f32_16x16x32_bf16 v[108:111], v[188:191], a[60:63], v[108:111]
s_waitcnt vmcnt(0) lgkmcnt(0)
v_mfma_f32_16x16x32_bf16 v[92:95], v[188:191], a[44:47], v[92:95]
s_barrier
v_mfma_f32_16x16x32_bf16 v[80:83], v[192:195], a[64:67], v[80:83]
ds_read_b64_tr_b16 v[128:129], v8 offset:49152
ds_read_b64_tr_b16 v[130:131], v8 offset:51200
ds_read_b64 v[48:49], v12 offset:0
v_mfma_f32_16x16x32_bf16 v[96:99], v[192:195], a[80:83], v[96:99]
ds_read_b64_tr_b16 v[132:133], v9 offset:49152
ds_read_b64_tr_b16 v[64:65], v5 offset:0
v_mfma_f32_16x16x32_bf16 v[100:103], v[196:199], a[80:83], v[100:103]
ds_read_b64_tr_b16 v[134:135], v9 offset:51200
ds_read_b64 v[50:51], v13 offset:0
v_mfma_f32_16x16x32_bf16 v[84:87], v[196:199], a[64:67], v[84:87]
ds_read_b64_tr_b16 v[136:137], v10 offset:49152
ds_read_b64_tr_b16 v[66:67], v5 offset:4096
v_mfma_f32_16x16x32_bf16 v[88:91], v[200:203], a[64:67], v[88:91]
ds_read_b64_tr_b16 v[138:139], v10 offset:51200
ds_read_b64_tr_b16 v[140:141], v11 offset:49152
ds_read_b64 v[52:53], v14 offset:0
v_mfma_f32_16x16x32_bf16 v[104:107], v[200:203], a[80:83], v[104:107]
ds_read_b64_tr_b16 v[142:143], v11 offset:51200
ds_read_b64_tr_b16 v[68:69], v5 offset:8192
v_mfma_f32_16x16x32_bf16 v[108:111], v[204:207], a[80:83], v[108:111]
ds_read_b64_tr_b16 v[144:145], v8 offset:53248
ds_read_b64 v[54:55], v15 offset:0
v_mfma_f32_16x16x32_bf16 v[92:95], v[204:207], a[64:67], v[92:95]
ds_read_b64_tr_b16 v[146:147], v8 offset:55296
ds_read_b64_tr_b16 v[70:71], v5 offset:12288
v_mfma_f32_16x16x32_bf16 v[80:83], v[208:211], a[68:71], v[80:83]
ds_read_b64_tr_b16 v[148:149], v9 offset:53248
ds_read_b64_tr_b16 v[150:151], v9 offset:55296
ds_read_b64 v[56:57], v12 offset:2048
v_mfma_f32_16x16x32_bf16 v[96:99], v[208:211], a[84:87], v[96:99]
ds_read_b64_tr_b16 v[152:153], v10 offset:53248
ds_read_b64_tr_b16 v[72:73], v5 offset:8
v_mfma_f32_16x16x32_bf16 v[100:103], v[212:215], a[84:87], v[100:103]
ds_read_b64_tr_b16 v[154:155], v10 offset:55296
ds_read_b64 v[58:59], v13 offset:2048
v_mfma_f32_16x16x32_bf16 v[84:87], v[212:215], a[68:71], v[84:87]
ds_read_b64_tr_b16 v[156:157], v11 offset:53248
ds_read_b64_tr_b16 v[74:75], v5 offset:4104
v_mfma_f32_16x16x32_bf16 v[88:91], v[216:219], a[68:71], v[88:91]
ds_read_b64_tr_b16 v[158:159], v11 offset:55296
ds_read_b64 v[60:61], v14 offset:2048
v_mfma_f32_16x16x32_bf16 v[104:107], v[216:219], a[84:87], v[104:107]
ds_read_b64_tr_b16 v[160:161], v8 offset:57344
ds_read_b64_tr_b16 v[162:163], v8 offset:59392
ds_read_b64_tr_b16 v[76:77], v5 offset:8200
v_mfma_f32_16x16x32_bf16 v[108:111], v[220:223], a[84:87], v[108:111]
ds_read_b64_tr_b16 v[164:165], v9 offset:57344
ds_read_b64 v[62:63], v15 offset:2048
v_mfma_f32_16x16x32_bf16 v[92:95], v[220:223], a[68:71], v[92:95]
ds_read_b64_tr_b16 v[166:167], v9 offset:59392
ds_read_b64_tr_b16 v[78:79], v5 offset:12296
v_mfma_f32_16x16x32_bf16 v[80:83], v[224:227], a[72:75], v[80:83]
ds_read_b64_tr_b16 v[168:169], v10 offset:57344
v_mfma_f32_16x16x32_bf16 v[96:99], v[224:227], a[88:91], v[96:99]
ds_read_b64_tr_b16 v[170:171], v10 offset:59392
ds_read_b64_tr_b16 v[172:173], v11 offset:57344
v_mfma_f32_16x16x32_bf16 v[100:103], v[228:231], a[88:91], v[100:103]
ds_read_b64_tr_b16 v[174:175], v11 offset:59392
v_mfma_f32_16x16x32_bf16 v[84:87], v[228:231], a[72:75], v[84:87]
ds_read_b64_tr_b16 v[176:177], v8 offset:61440
v_mfma_f32_16x16x32_bf16 v[88:91], v[232:235], a[72:75], v[88:91]
ds_read_b64_tr_b16 v[178:179], v8 offset:63488
v_mfma_f32_16x16x32_bf16 v[104:107], v[232:235], a[88:91], v[104:107]
ds_read_b64_tr_b16 v[180:181], v9 offset:61440
ds_read_b64_tr_b16 v[182:183], v9 offset:63488
v_mfma_f32_16x16x32_bf16 v[108:111], v[236:239], a[88:91], v[108:111]
ds_read_b64_tr_b16 v[184:185], v10 offset:61440
v_mfma_f32_16x16x32_bf16 v[92:95], v[236:239], a[72:75], v[92:95]
ds_read_b64_tr_b16 v[186:187], v10 offset:63488
v_mfma_f32_16x16x32_bf16 v[80:83], v[240:243], a[76:79], v[80:83]
ds_read_b64_tr_b16 v[188:189], v11 offset:61440
v_mfma_f32_16x16x32_bf16 v[96:99], v[240:243], a[92:95], v[96:99]
ds_read_b64_tr_b16 v[190:191], v11 offset:63488
v_mfma_f32_16x16x32_bf16 v[100:103], v[244:247], a[92:95], v[100:103]
v_mfma_f32_16x16x32_bf16 v[84:87], v[244:247], a[76:79], v[84:87]
v_mfma_f32_16x16x32_bf16 v[88:91], v[248:251], a[76:79], v[88:91]
v_mfma_f32_16x16x32_bf16 v[104:107], v[248:251], a[92:95], v[104:107]
v_mfma_f32_16x16x32_bf16 v[108:111], v[252:255], a[92:95], v[108:111]
s_waitcnt vmcnt(10) lgkmcnt(0)
v_mfma_f32_16x16x32_bf16 v[92:95], v[252:255], a[76:79], v[92:95]
v_mfma_f32_16x16x32_bf16 v[80:83], v[128:131], a[96:99], v[80:83]
v_sub_f32 v112, 1.0, v6
v_sub_f32 v113, 1.0, v7
v_lshlrev_b32 v16, 16, v48
v_lshlrev_b32 v114, 16, v64
v_mfma_f32_16x16x32_bf16 v[96:99], v[128:131], a[112:115], v[96:99]
v_mul_f32 v16, v16, v112
v_mul_f32 v16, v16, v114
v_and_b32 v17, 0xffff0000, v48
v_and_b32 v115, 0xffff0000, v64
v_mfma_f32_16x16x32_bf16 v[100:103], v[132:135], a[112:115], v[100:103]
v_mul_f32 v17, v17, v112
v_mul_f32 v17, v17, v115
v_lshlrev_b32 v18, 16, v49
v_lshlrev_b32 v114, 16, v65
v_mfma_f32_16x16x32_bf16 v[84:87], v[132:135], a[96:99], v[84:87]
v_mul_f32 v18, v18, v112
v_mul_f32 v18, v18, v114
v_and_b32 v19, 0xffff0000, v49
v_and_b32 v115, 0xffff0000, v65
v_mfma_f32_16x16x32_bf16 v[88:91], v[136:139], a[96:99], v[88:91]
v_mul_f32 v19, v19, v112
v_mul_f32 v19, v19, v115
v_lshlrev_b32 v20, 16, v50
v_lshlrev_b32 v114, 16, v66
v_mfma_f32_16x16x32_bf16 v[104:107], v[136:139], a[112:115], v[104:107]
v_mul_f32 v20, v20, v112
v_mul_f32 v20, v20, v114
v_and_b32 v21, 0xffff0000, v50
v_and_b32 v115, 0xffff0000, v66
v_mfma_f32_16x16x32_bf16 v[108:111], v[140:143], a[112:115], v[108:111]
v_mul_f32 v21, v21, v112
v_mul_f32 v21, v21, v115
v_lshlrev_b32 v22, 16, v51
v_lshlrev_b32 v114, 16, v67
v_mfma_f32_16x16x32_bf16 v[92:95], v[140:143], a[96:99], v[92:95]
v_mul_f32 v22, v22, v112
v_mul_f32 v22, v22, v114
v_and_b32 v23, 0xffff0000, v51
v_and_b32 v115, 0xffff0000, v67
v_mfma_f32_16x16x32_bf16 v[80:83], v[144:147], a[100:103], v[80:83]
v_mul_f32 v23, v23, v112
v_mul_f32 v23, v23, v115
v_lshlrev_b32 v24, 16, v52
v_lshlrev_b32 v114, 16, v68
v_mfma_f32_16x16x32_bf16 v[96:99], v[144:147], a[116:119], v[96:99]
v_mul_f32 v24, v24, v112
v_mul_f32 v24, v24, v114
v_and_b32 v25, 0xffff0000, v52
v_and_b32 v115, 0xffff0000, v68
v_mfma_f32_16x16x32_bf16 v[100:103], v[148:151], a[116:119], v[100:103]
v_mul_f32 v25, v25, v112
v_mul_f32 v25, v25, v115
v_lshlrev_b32 v26, 16, v53
v_lshlrev_b32 v114, 16, v69
v_mfma_f32_16x16x32_bf16 v[84:87], v[148:151], a[100:103], v[84:87]
v_mul_f32 v26, v26, v112
v_mul_f32 v26, v26, v114
v_and_b32 v27, 0xffff0000, v53
v_and_b32 v115, 0xffff0000, v69
v_mfma_f32_16x16x32_bf16 v[88:91], v[152:155], a[100:103], v[88:91]
v_mul_f32 v27, v27, v112
v_mul_f32 v27, v27, v115
v_lshlrev_b32 v28, 16, v54
v_lshlrev_b32 v114, 16, v70
v_mfma_f32_16x16x32_bf16 v[104:107], v[152:155], a[116:119], v[104:107]
v_mul_f32 v28, v28, v112
v_mul_f32 v28, v28, v114
v_and_b32 v29, 0xffff0000, v54
v_and_b32 v115, 0xffff0000, v70
v_mfma_f32_16x16x32_bf16 v[108:111], v[156:159], a[116:119], v[108:111]
v_mul_f32 v29, v29, v112
v_mul_f32 v29, v29, v115
v_lshlrev_b32 v30, 16, v55
v_lshlrev_b32 v114, 16, v71
v_mfma_f32_16x16x32_bf16 v[92:95], v[156:159], a[100:103], v[92:95]
v_mul_f32 v30, v30, v112
v_mul_f32 v30, v30, v114
v_and_b32 v31, 0xffff0000, v55
v_and_b32 v115, 0xffff0000, v71
v_mfma_f32_16x16x32_bf16 v[80:83], v[160:163], a[104:107], v[80:83]
v_mul_f32 v31, v31, v112
v_mul_f32 v31, v31, v115
v_lshlrev_b32 v32, 16, v56
v_lshlrev_b32 v114, 16, v72
v_mfma_f32_16x16x32_bf16 v[96:99], v[160:163], a[120:123], v[96:99]
v_mul_f32 v32, v32, v113
v_mul_f32 v32, v32, v114
v_and_b32 v33, 0xffff0000, v56
v_and_b32 v115, 0xffff0000, v72
v_mfma_f32_16x16x32_bf16 v[100:103], v[164:167], a[120:123], v[100:103]
v_mul_f32 v33, v33, v113
v_mul_f32 v33, v33, v115
v_lshlrev_b32 v34, 16, v57
v_lshlrev_b32 v114, 16, v73
v_mfma_f32_16x16x32_bf16 v[84:87], v[164:167], a[104:107], v[84:87]
v_mul_f32 v34, v34, v113
v_mul_f32 v34, v34, v114
v_and_b32 v35, 0xffff0000, v57
v_and_b32 v115, 0xffff0000, v73
v_mfma_f32_16x16x32_bf16 v[88:91], v[168:171], a[104:107], v[88:91]
v_mul_f32 v35, v35, v113
v_mul_f32 v35, v35, v115
v_lshlrev_b32 v36, 16, v58
v_lshlrev_b32 v114, 16, v74
v_mfma_f32_16x16x32_bf16 v[104:107], v[168:171], a[120:123], v[104:107]
v_mul_f32 v36, v36, v113
v_mul_f32 v36, v36, v114
v_and_b32 v37, 0xffff0000, v58
v_and_b32 v115, 0xffff0000, v74
v_mfma_f32_16x16x32_bf16 v[108:111], v[172:175], a[120:123], v[108:111]
v_mul_f32 v37, v37, v113
v_mul_f32 v37, v37, v115
v_lshlrev_b32 v38, 16, v59
v_lshlrev_b32 v114, 16, v75
v_mfma_f32_16x16x32_bf16 v[92:95], v[172:175], a[104:107], v[92:95]
v_mul_f32 v38, v38, v113
v_mul_f32 v38, v38, v114
v_and_b32 v39, 0xffff0000, v59
v_and_b32 v115, 0xffff0000, v75
v_mfma_f32_16x16x32_bf16 v[80:83], v[176:179], a[108:111], v[80:83]
v_mul_f32 v39, v39, v113
v_mul_f32 v39, v39, v115
v_lshlrev_b32 v40, 16, v60
v_lshlrev_b32 v114, 16, v76
v_mfma_f32_16x16x32_bf16 v[96:99], v[176:179], a[124:127], v[96:99]
v_mul_f32 v40, v40, v113
v_mul_f32 v40, v40, v114
v_and_b32 v41, 0xffff0000, v60
v_and_b32 v115, 0xffff0000, v76
v_mfma_f32_16x16x32_bf16 v[100:103], v[180:183], a[124:127], v[100:103]
v_mul_f32 v41, v41, v113
v_mul_f32 v41, v41, v115
v_lshlrev_b32 v42, 16, v61
v_lshlrev_b32 v114, 16, v77
v_mfma_f32_16x16x32_bf16 v[84:87], v[180:183], a[108:111], v[84:87]
v_mul_f32 v42, v42, v113
v_mul_f32 v42, v42, v114
v_and_b32 v43, 0xffff0000, v61
v_and_b32 v115, 0xffff0000, v77
v_mfma_f32_16x16x32_bf16 v[88:91], v[184:187], a[108:111], v[88:91]
v_mul_f32 v43, v43, v113
v_mul_f32 v43, v43, v115
v_lshlrev_b32 v44, 16, v62
v_lshlrev_b32 v114, 16, v78
v_mfma_f32_16x16x32_bf16 v[104:107], v[184:187], a[124:127], v[104:107]
v_mul_f32 v44, v44, v113
v_mul_f32 v44, v44, v114
v_and_b32 v45, 0xffff0000, v62
v_and_b32 v115, 0xffff0000, v78
v_mfma_f32_16x16x32_bf16 v[108:111], v[188:191], a[124:127], v[108:111]
v_mul_f32 v45, v45, v113
v_mul_f32 v45, v45, v115
v_lshlrev_b32 v46, 16, v63
v_lshlrev_b32 v114, 16, v79
v_mfma_f32_16x16x32_bf16 v[92:95], v[188:191], a[108:111], v[92:95]
v_mul_f32 v46, v46, v113
v_mul_f32 v46, v46, v114
v_and_b32 v47, 0xffff0000, v63
v_and_b32 v115, 0xffff0000, v79
v_mul_f32 v47, v47, v113
v_mul_f32 v47, v47, v115
v_fma_f32 v16, v80, v6, v16
v_fma_f32 v17, v81, v6, v17
v_fma_f32 v18, v82, v6, v18
v_fma_f32 v19, v83, v6, v19
v_cvt_pk_bf16_f32 v16, v16, v17
v_cvt_pk_bf16_f32 v17, v18, v19
ds_write_b64 v12, v[16:17] offset:0
v_fma_f32 v20, v84, v6, v20
v_fma_f32 v21, v85, v6, v21
v_fma_f32 v22, v86, v6, v22
v_fma_f32 v23, v87, v6, v23
v_cvt_pk_bf16_f32 v20, v20, v21
v_cvt_pk_bf16_f32 v21, v22, v23
ds_write_b64 v13, v[20:21] offset:0
v_fma_f32 v24, v88, v6, v24
v_fma_f32 v25, v89, v6, v25
v_fma_f32 v26, v90, v6, v26
v_fma_f32 v27, v91, v6, v27
v_cvt_pk_bf16_f32 v24, v24, v25
v_cvt_pk_bf16_f32 v25, v26, v27
ds_write_b64 v14, v[24:25] offset:0
v_fma_f32 v28, v92, v6, v28
v_fma_f32 v29, v93, v6, v29
v_fma_f32 v30, v94, v6, v30
v_fma_f32 v31, v95, v6, v31
v_cvt_pk_bf16_f32 v28, v28, v29
v_cvt_pk_bf16_f32 v29, v30, v31
ds_write_b64 v15, v[28:29] offset:0
v_fma_f32 v32, v96, v7, v32
v_fma_f32 v33, v97, v7, v33
v_fma_f32 v34, v98, v7, v34
v_fma_f32 v35, v99, v7, v35
v_cvt_pk_bf16_f32 v32, v32, v33
v_cvt_pk_bf16_f32 v33, v34, v35
ds_write_b64 v12, v[32:33] offset:2048
v_fma_f32 v36, v100, v7, v36
v_fma_f32 v37, v101, v7, v37
v_fma_f32 v38, v102, v7, v38
v_fma_f32 v39, v103, v7, v39
v_cvt_pk_bf16_f32 v36, v36, v37
v_cvt_pk_bf16_f32 v37, v38, v39
ds_write_b64 v13, v[36:37] offset:2048
v_fma_f32 v40, v104, v7, v40
v_fma_f32 v41, v105, v7, v41
v_fma_f32 v42, v106, v7, v42
v_fma_f32 v43, v107, v7, v43
v_cvt_pk_bf16_f32 v40, v40, v41
v_cvt_pk_bf16_f32 v41, v42, v43
ds_write_b64 v14, v[40:41] offset:2048
v_fma_f32 v44, v108, v7, v44
v_fma_f32 v45, v109, v7, v45
v_fma_f32 v46, v110, v7, v46
v_fma_f32 v47, v111, v7, v47
v_cvt_pk_bf16_f32 v44, v44, v45
v_cvt_pk_bf16_f32 v45, v46, v47
ds_write_b64 v15, v[44:45] offset:2048
v_add_u32 v112, s64, v1
ds_read_b128 v[48:51], v112 offset:0
ds_read_b128 v[52:55], v112 offset:1024
ds_read_b128 v[56:59], v112 offset:2048
ds_read_b128 v[60:63], v112 offset:3072
s_waitcnt lgkmcnt(3)
buffer_store_dwordx4 v[48:51], v4, s[40:43], s70 offen
s_add_u32 s70, s70, 0x4000
s_waitcnt lgkmcnt(2)
buffer_store_dwordx4 v[52:55], v4, s[40:43], s70 offen
s_add_u32 s70, s70, 0x4000
s_waitcnt lgkmcnt(1)
buffer_store_dwordx4 v[56:59], v4, s[40:43], s70 offen
s_add_u32 s70, s70, 0x4000
s_waitcnt lgkmcnt(0)
buffer_store_dwordx4 v[60:63], v4, s[40:43], s70 offen
s_add_u32 s70, s70, 0x4000
Lend:
s_endpgm
Lspin1:
s_mov_b32 s83, 262144
Lsl3:
s_sleep 2
buffer_load_dword v3, v2, s[48:51], 0 offen sc1
s_sub_u32 s83, s83, 1
s_cmp_eq_u32 s83, 0
s_waitcnt vmcnt(0)
s_cbranch_scc1 Lback2
v_cmp_gt_u32 vcc, 8, v3
s_cbranch_vccnz Lsl3
s_branch Lback2
Lspin4:
s_mov_b32 s83, 262144
Lsl6:
s_sleep 2
buffer_load_dword v3, v2, s[44:47], s75 offen sc1
s_sub_u32 s83, s83, 1
s_cmp_eq_u32 s83, 0
s_waitcnt vmcnt(0)
s_cbranch_scc1 Lback5
v_cmp_gt_u32 vcc, 1, v3
s_cbranch_vccnz Lsl6
s_branch Lback5
Lalt7:
v_mfma_f32_16x16x32_bf16 v[128:131], a[128:131], v[16:19], v[116:119]
v_mfma_f32_16x16x32_bf16 v[132:135], a[128:131], v[32:35], 0
v_mfma_f32_16x16x32_bf16 v[144:147], a[144:147], v[16:19], v[112:115]
v_mfma_f32_16x16x32_bf16 v[148:151], a[144:147], v[32:35], v[116:119]
s_branch Ljoin8
Lalt9:
s_cmp_eq_u32 s84, 1
s_cbranch_scc1 Ltri10
v_mfma_f32_16x16x32_bf16 v[160:163], a[160:163], v[16:19], v[112:115]
s_xor_b32 s74, s82, 0x10000
v_exp_f32 v128, v128
v_mfma_f32_16x16x32_bf16 v[164:167], a[160:163], v[32:35], v[112:115]
s_add_u32 s74, s74, s64
ds_read_b128 a[128:131], v2 offset:16384
ds_read_b128 a[144:147], v2 offset:20480
v_mfma_f32_16x16x32_bf16 v[176:179], a[176:179], v[16:19], v[112:115]
s_add_u32 s81, s81, 0x8000
v_exp_f32 v129, v129
v_mfma_f32_16x16x32_bf16 v[180:183], a[176:179], v[32:35], v[112:115]
s_add_u32 m0, s74, 16384
v_exp_f32 v130, v130
s_branch Ljoin11
Ltri10:
v_mfma_f32_16x16x32_bf16 v[160:163], a[160:163], v[16:19], v[96:99]
s_xor_b32 s74, s82, 0x10000
v_exp_f32 v128, v128
v_mfma_f32_16x16x32_bf16 v[164:167], a[160:163], v[32:35], v[84:87]
s_add_u32 s74, s74, s64
ds_read_b128 a[128:131], v2 offset:16384
ds_read_b128 a[144:147], v2 offset:20480
v_mfma_f32_16x16x32_bf16 v[176:179], a[176:179], v[16:19], v[112:115]
s_add_u32 s81, s81, 0x8000
v_exp_f32 v129, v129
v_mfma_f32_16x16x32_bf16 v[180:183], a[176:179], v[32:35], v[100:103]
s_add_u32 m0, s74, 16384
v_exp_f32 v130, v130
s_branch Ljoin11
Lalt12:
s_cmp_eq_u32 s84, 2
s_cbranch_scc1 Ltri13
v_mfma_f32_16x16x32_bf16 v[128:131], a[128:131], v[16:19], v[112:115]
s_add_u32 s82, s82, 0x8000
ds_read_b128 a[160:163], v2 offset:24576
v_mfma_f32_16x16x32_bf16 v[132:135], a[128:131], v[32:35], v[112:115]
s_and_b32 s82, s82, 0x1ffff
v_exp_f32 v160, v160
v_mfma_f32_16x16x32_bf16 v[144:147], a[144:147], v[16:19], v[112:115]
s_add_u32 m0, s74, 0
v_exp_f32 v161, v161
v_mfma_f32_16x16x32_bf16 v[148:151], a[144:147], v[32:35], v[112:115]
s_add_u32 s72, s81, 0
ds_read_b128 a[176:179], v2 offset:28672
v_cvt_pk_bf16_f32 v208, v160, v161
s_branch Ljoin14
Ltri13:
v_mfma_f32_16x16x32_bf16 v[128:131], a[128:131], v[16:19], v[96:99]
s_add_u32 s82, s82, 0x8000
ds_read_b128 a[160:163], v2 offset:24576
v_mfma_f32_16x16x32_bf16 v[132:135], a[128:131], v[32:35], v[84:87]
s_and_b32 s82, s82, 0x1ffff
v_exp_f32 v160, v160
v_mfma_f32_16x16x32_bf16 v[144:147], a[144:147], v[16:19], v[112:115]
s_add_u32 m0, s74, 0
v_exp_f32 v161, v161
v_mfma_f32_16x16x32_bf16 v[148:151], a[144:147], v[32:35], v[100:103]
s_add_u32 s72, s81, 0
ds_read_b128 a[176:179], v2 offset:28672
v_cvt_pk_bf16_f32 v208, v160, v161
s_branch Ljoin14
Lalt15:
s_cmp_eq_u32 s58, 0
s_cbranch_scc1 Ltri16
v_mfma_f32_16x16x32_bf16 v[128:131], a[128:131], v[16:19], v[112:115]
s_add_u32 s82, s82, 0x8000
ds_read_b128 a[160:163], v2 offset:24576
v_mfma_f32_16x16x32_bf16 v[132:135], a[128:131], v[32:35], v[112:115]
s_and_b32 s82, s82, 0x1ffff
v_exp_f32 v160, v160
v_mfma_f32_16x16x32_bf16 v[144:147], a[144:147], v[16:19], v[112:115]
s_add_u32 m0, s74, 0
v_exp_f32 v161, v161
v_mfma_f32_16x16x32_bf16 v[148:151], a[144:147], v[32:35], v[112:115]
s_add_u32 s72, s81, 0
ds_read_b128 a[176:179], v2 offset:28672
v_cvt_pk_bf16_f32 v208, v160, v161
s_branch Ljoin17
Ltri16:
v_mfma_f32_16x16x32_bf16 v[128:131], a[128:131], v[16:19], v[96:99]
s_add_u32 s82, s82, 0x8000
ds_read_b128 a[160:163], v2 offset:24576
v_mfma_f32_16x16x32_bf16 v[132:135], a[128:131], v[32:35], v[84:87]
s_and_b32 s82, s82, 0x1ffff
v_exp_f32 v160, v160
v_mfma_f32_16x16x32_bf16 v[144:147], a[144:147], v[16:19], v[112:115]
s_add_u32 m0, s74, 0
v_exp_f32 v161, v161
v_mfma_f32_16x16x32_bf16 v[148:151], a[144:147], v[32:35], v[100:103]
s_add_u32 s72, s81, 0
ds_read_b128 a[176:179], v2 offset:28672
v_cvt_pk_bf16_f32 v208, v160, v161
s_branch Ljoin17
Lalt18:
s_cmp_eq_u32 s58, 1
s_cbranch_scc1 Ltri19
v_mfma_f32_16x16x32_bf16 v[160:163], a[160:163], v[16:19], v[112:115]
s_xor_b32 s74, s82, 0x10000
v_exp_f32 v128, v128
v_mfma_f32_16x16x32_bf16 v[164:167], a[160:163], v[32:35], v[112:115]
s_add_u32 s74, s74, s64
ds_read_b128 a[128:131], v2 offset:16384
v_mfma_f32_16x16x32_bf16 v[176:179], a[176:179], v[16:19], v[112:115]
s_add_u32 s81, s81, 0x8000
v_exp_f32 v129, v129
v_mfma_f32_16x16x32_bf16 v[180:183], a[176:179], v[32:35], v[112:115]
s_add_u32 m0, s74, 16384
v_exp_f32 v130, v130
s_branch Ljoin20
Ltri19:
v_mfma_f32_16x16x32_bf16 v[160:163], a[160:163], v[16:19], v[96:99]
s_xor_b32 s74, s82, 0x10000
v_exp_f32 v128, v128
v_mfma_f32_16x16x32_bf16 v[164:167], a[160:163], v[32:35], v[84:87]
s_add_u32 s74, s74, s64
ds_read_b128 a[128:131], v2 offset:16384
v_mfma_f32_16x16x32_bf16 v[176:179], a[176:179], v[16:19], v[112:115]
s_add_u32 s81, s81, 0x8000
v_exp_f32 v129, v129
v_mfma_f32_16x16x32_bf16 v[180:183], a[176:179], v[32:35], v[100:103]
s_add_u32 m0, s74, 16384
v_exp_f32 v130, v130
s_branch Ljoin20
Lalt21:
s_cmp_eq_u32 s58, 2
s_cbranch_scc1 Ltri22
v_mfma_f32_16x16x32_bf16 v[128:131], a[128:131], v[16:19], v[112:115]
s_add_u32 s82, s82, 0x8000
ds_read_b128 a[160:163], v2 offset:24576
v_mfma_f32_16x16x32_bf16 v[132:135], a[128:131], v[32:35], v[112:115]
s_and_b32 s82, s82, 0x1ffff
v_exp_f32 v160, v160
v_mfma_f32_16x16x32_bf16 v[144:147], a[144:147], v[16:19], v[112:115]
s_add_u32 m0, s74, 0
v_exp_f32 v161, v161
v_mfma_f32_16x16x32_bf16 v[148:151], a[144:147], v[32:35], v[112:115]
s_add_u32 s72, s81, 0
ds_read_b128 a[176:179], v2 offset:28672
v_cvt_pk_bf16_f32 v208, v160, v161
s_branch Ljoin23
Ltri22:
v_mfma_f32_16x16x32_bf16 v[128:131], a[128:131], v[16:19], v[96:99]
s_add_u32 s82, s82, 0x8000
ds_read_b128 a[160:163], v2 offset:24576
v_mfma_f32_16x16x32_bf16 v[132:135], a[128:131], v[32:35], v[84:87]
s_and_b32 s82, s82, 0x1ffff
v_exp_f32 v160, v160
v_mfma_f32_16x16x32_bf16 v[144:147], a[144:147], v[16:19], v[112:115]
s_add_u32 m0, s74, 0
v_exp_f32 v161, v161
v_mfma_f32_16x16x32_bf16 v[148:151], a[144:147], v[32:35], v[100:103]
s_add_u32 s72, s81, 0
ds_read_b128 a[176:179], v2 offset:28672
v_cvt_pk_bf16_f32 v208, v160, v161
s_branch Ljoin23
Lalt24:
s_cmp_eq_u32 s58, 3
s_cbranch_scc1 Ltri25
v_mfma_f32_16x16x32_bf16 v[160:163], a[160:163], v[16:19], v[112:115]
s_xor_b32 s74, s82, 0x10000
v_exp_f32 v128, v128
v_mfma_f32_16x16x32_bf16 v[164:167], a[160:163], v[32:35], v[112:115]
s_add_u32 s74, s74, s64
ds_read_b128 a[128:131], v2 offset:16384
v_mfma_f32_16x16x32_bf16 v[176:179], a[176:179], v[16:19], v[112:115]
s_add_u32 s81, s81, 0x8000
v_exp_f32 v129, v129
v_mfma_f32_16x16x32_bf16 v[180:183], a[176:179], v[32:35], v[112:115]
s_add_u32 m0, s74, 16384
v_exp_f32 v130, v130
s_branch Ljoin26
Ltri25:
v_mfma_f32_16x16x32_bf16 v[160:163], a[160:163], v[16:19], v[96:99]
s_xor_b32 s74, s82, 0x10000
v_exp_f32 v128, v128
v_mfma_f32_16x16x32_bf16 v[164:167], a[160:163], v[32:35], v[84:87]
s_add_u32 s74, s74, s64
ds_read_b128 a[128:131], v2 offset:16384
v_mfma_f32_16x16x32_bf16 v[176:179], a[176:179], v[16:19], v[112:115]
s_add_u32 s81, s81, 0x8000
v_exp_f32 v129, v129
v_mfma_f32_16x16x32_bf16 v[180:183], a[176:179], v[32:35], v[100:103]
s_add_u32 m0, s74, 16384
v_exp_f32 v130, v130
s_branch Ljoin26
Lalt27:
s_cmp_eq_u32 s85, 0
s_cbranch_scc1 Ltri28
v_mfma_f32_16x16x32_bf16 v[136:139], a[128:131], v[48:51], v[112:115]
s_add_u32 s82, s82, 0x8000
ds_read_b128 a[160:163], v2 offset:24576
ds_read_b128 a[176:179], v2 offset:28672
v_mfma_f32_16x16x32_bf16 v[140:143], a[128:131], v[64:67], v[112:115]
s_and_b32 s82, s82, 0x1ffff
v_exp_f32 v160, v160
v_mfma_f32_16x16x32_bf16 v[152:155], a[144:147], v[48:51], v[112:115]
s_add_u32 m0, s74, 0
v_exp_f32 v161, v161
v_mfma_f32_16x16x32_bf16 v[156:159], a[144:147], v[64:67], v[112:115]
s_add_u32 s72, s81, 0
v_exp_f32 v162, v162
s_branch Ljoin29
Ltri28:
v_mfma_f32_16x16x32_bf16 v[136:139], a[128:131], v[48:51], v[104:107]
s_add_u32 s82, s82, 0x8000
ds_read_b128 a[160:163], v2 offset:24576
ds_read_b128 a[176:179], v2 offset:28672
v_mfma_f32_16x16x32_bf16 v[140:143], a[128:131], v[64:67], v[92:95]
s_and_b32 s82, s82, 0x1ffff
v_exp_f32 v160, v160
v_mfma_f32_16x16x32_bf16 v[152:155], a[144:147], v[48:51], v[112:115]
s_add_u32 m0, s74, 0
v_exp_f32 v161, v161
v_mfma_f32_16x16x32_bf16 v[156:159], a[144:147], v[64:67], v[108:111]
s_add_u32 s72, s81, 0
v_exp_f32 v162, v162
s_branch Ljoin29
Lalt30:
s_cmp_eq_u32 s85, 1
s_cbranch_scc1 Ltri31
v_mfma_f32_16x16x32_bf16 v[168:171], a[160:163], v[48:51], v[112:115]
s_xor_b32 s74, s82, 0x10000
v_exp_f32 v136, v136
v_mfma_f32_16x16x32_bf16 v[172:175], a[160:163], v[64:67], v[112:115]
s_add_u32 s74, s74, s64
ds_read_b128 a[128:131], v2 offset:16384
v_mfma_f32_16x16x32_bf16 v[184:187], a[176:179], v[48:51], v[112:115]
s_add_u32 s81, s81, 0x8000
v_exp_f32 v137, v137
v_mfma_f32_16x16x32_bf16 v[188:191], a[176:179], v[64:67], v[112:115]
s_add_u32 m0, s74, 16384
ds_read_b128 a[144:147], v2 offset:20480
v_cvt_pk_bf16_f32 v200, v136, v137
s_branch Ljoin32
Ltri31:
v_mfma_f32_16x16x32_bf16 v[168:171], a[160:163], v[48:51], v[104:107]
s_xor_b32 s74, s82, 0x10000
v_exp_f32 v136, v136
v_mfma_f32_16x16x32_bf16 v[172:175], a[160:163], v[64:67], v[92:95]
s_add_u32 s74, s74, s64
ds_read_b128 a[128:131], v2 offset:16384
v_mfma_f32_16x16x32_bf16 v[184:187], a[176:179], v[48:51], v[112:115]
s_add_u32 s81, s81, 0x8000
v_exp_f32 v137, v137
v_mfma_f32_16x16x32_bf16 v[188:191], a[176:179], v[64:67], v[108:111]
s_add_u32 m0, s74, 16384
ds_read_b128 a[144:147], v2 offset:20480
v_cvt_pk_bf16_f32 v200, v136, v137
s_branch Ljoin32
Lalt33:
s_cmp_eq_u32 s85, 2
s_cbranch_scc1 Ltri34
v_mfma_f32_16x16x32_bf16 v[136:139], a[128:131], v[48:51], v[112:115]
s_add_u32 s82, s82, 0x8000
ds_read_b128 a[160:163], v2 offset:24576
ds_read_b128 a[176:179], v2 offset:28672
v_mfma_f32_16x16x32_bf16 v[140:143], a[128:131], v[64:67], v[112:115]
s_and_b32 s82, s82, 0x1ffff
v_exp_f32 v168, v168
v_mfma_f32_16x16x32_bf16 v[152:155], a[144:147], v[48:51], v[112:115]
s_add_u32 m0, s74, 0
v_exp_f32 v169, v169
v_mfma_f32_16x16x32_bf16 v[156:159], a[144:147], v[64:67], v[112:115]
s_add_u32 s72, s81, 0
ds_read_b128 a[164:167], v2 offset:25600
v_cvt_pk_bf16_f32 v216, v168, v169
s_branch Ljoin35
Ltri34:
v_mfma_f32_16x16x32_bf16 v[136:139], a[128:131], v[48:51], v[104:107]
s_add_u32 s82, s82, 0x8000
ds_read_b128 a[160:163], v2 offset:24576
ds_read_b128 a[176:179], v2 offset:28672
v_mfma_f32_16x16x32_bf16 v[140:143], a[128:131], v[64:67], v[92:95]
s_and_b32 s82, s82, 0x1ffff
v_exp_f32 v168, v168
v_mfma_f32_16x16x32_bf16 v[152:155], a[144:147], v[48:51], v[112:115]
s_add_u32 m0, s74, 0
v_exp_f32 v169, v169
v_mfma_f32_16x16x32_bf16 v[156:159], a[144:147], v[64:67], v[108:111]
s_add_u32 s72, s81, 0
ds_read_b128 a[164:167], v2 offset:25600
v_cvt_pk_bf16_f32 v216, v168, v169
s_branch Ljoin35
Lalt36:
s_cmp_eq_u32 s58, 0
s_cbranch_scc1 Ltri37
v_mfma_f32_16x16x32_bf16 v[136:139], a[128:131], v[48:51], v[112:115]
s_add_u32 s82, s82, 0x8000
ds_read_b128 a[160:163], v2 offset:24576
v_mfma_f32_16x16x32_bf16 v[140:143], a[128:131], v[64:67], v[112:115]
s_and_b32 s82, s82, 0x1ffff
v_exp_f32 v168, v168
v_mfma_f32_16x16x32_bf16 v[152:155], a[144:147], v[48:51], v[112:115]
ds_read_b128 a[176:179], v2 offset:28672
v_mfma_f32_16x16x32_bf16 v[156:159], a[144:147], v[64:67], v[112:115]
v_exp_f32 v169, v169
s_branch Ljoin38
Ltri37:
v_mfma_f32_16x16x32_bf16 v[136:139], a[128:131], v[48:51], v[104:107]
s_add_u32 s82, s82, 0x8000
ds_read_b128 a[160:163], v2 offset:24576
v_mfma_f32_16x16x32_bf16 v[140:143], a[128:131], v[64:67], v[92:95]
s_and_b32 s82, s82, 0x1ffff
v_exp_f32 v168, v168
v_mfma_f32_16x16x32_bf16 v[152:155], a[144:147], v[48:51], v[112:115]
ds_read_b128 a[176:179], v2 offset:28672
v_mfma_f32_16x16x32_bf16 v[156:159], a[144:147], v[64:67], v[108:111]
v_exp_f32 v169, v169
s_branch Ljoin38
Lalt39:
s_cmp_eq_u32 s58, 1
s_cbranch_scc1 Ltri40
v_mfma_f32_16x16x32_bf16 v[168:171], a[160:163], v[48:51], v[112:115]
v_exp_f32 v136, v136
v_mfma_f32_16x16x32_bf16 v[172:175], a[160:163], v[64:67], v[112:115]
ds_read_b128 a[128:131], v2 offset:16384
v_mfma_f32_16x16x32_bf16 v[184:187], a[176:179], v[48:51], v[112:115]
v_exp_f32 v137, v137
v_mfma_f32_16x16x32_bf16 v[188:191], a[176:179], v[64:67], v[112:115]
ds_read_b128 a[144:147], v2 offset:20480
v_cvt_pk_bf16_f32 v200, v136, v137
s_branch Ljoin41
Ltri40:
v_mfma_f32_16x16x32_bf16 v[168:171], a[160:163], v[48:51], v[104:107]
v_exp_f32 v136, v136
v_mfma_f32_16x16x32_bf16 v[172:175], a[160:163], v[64:67], v[92:95]
ds_read_b128 a[128:131], v2 offset:16384
v_mfma_f32_16x16x32_bf16 v[184:187], a[176:179], v[48:51], v[112:115]
v_exp_f32 v137, v137
v_mfma_f32_16x16x32_bf16 v[188:191], a[176:179], v[64:67], v[108:111]
ds_read_b128 a[144:147], v2 offset:20480
v_cvt_pk_bf16_f32 v200, v136, v137
s_branch Ljoin41
Lalt42:
s_cmp_eq_u32 s58, 2
s_cbranch_scc1 Ltri43
v_mfma_f32_16x16x32_bf16 v[136:139], a[128:131], v[48:51], v[112:115]
s_add_u32 s82, s82, 0x8000
ds_read_b128 a[160:163], v2 offset:24576
v_mfma_f32_16x16x32_bf16 v[140:143], a[128:131], v[64:67], v[112:115]
s_and_b32 s82, s82, 0x1ffff
v_exp_f32 v168, v168
v_mfma_f32_16x16x32_bf16 v[152:155], a[144:147], v[48:51], v[112:115]
ds_read_b128 a[176:179], v2 offset:28672
v_mfma_f32_16x16x32_bf16 v[156:159], a[144:147], v[64:67], v[112:115]
v_exp_f32 v169, v169
s_branch Ljoin44
Ltri43:
v_mfma_f32_16x16x32_bf16 v[136:139], a[128:131], v[48:51], v[104:107]
s_add_u32 s82, s82, 0x8000
ds_read_b128 a[160:163], v2 offset:24576
v_mfma_f32_16x16x32_bf16 v[140:143], a[128:131], v[64:67], v[92:95]
s_and_b32 s82, s82, 0x1ffff
v_exp_f32 v168, v168
v_mfma_f32_16x16x32_bf16 v[152:155], a[144:147], v[48:51], v[112:115]
ds_read_b128 a[176:179], v2 offset:28672
v_mfma_f32_16x16x32_bf16 v[156:159], a[144:147], v[64:67], v[108:111]
v_exp_f32 v169, v169
s_branch Ljoin44
Lalt45:
s_cmp_eq_u32 s58, 3
s_cbranch_scc1 Ltri46
v_mfma_f32_16x16x32_bf16 v[168:171], a[160:163], v[48:51], v[112:115]
v_exp_f32 v136, v136
v_mfma_f32_16x16x32_bf16 v[172:175], a[160:163], v[64:67], v[112:115]
ds_read_b128 a[192:195], v2 offset:0
v_mfma_f32_16x16x32_bf16 v[184:187], a[176:179], v[48:51], v[112:115]
v_exp_f32 v137, v137
v_mfma_f32_16x16x32_bf16 v[188:191], a[176:179], v[64:67], v[112:115]
v_exp_f32 v138, v138
s_branch Ljoin47
Ltri46:
v_mfma_f32_16x16x32_bf16 v[168:171], a[160:163], v[48:51], v[104:107]
v_exp_f32 v136, v136
v_mfma_f32_16x16x32_bf16 v[172:175], a[160:163], v[64:67], v[92:95]
ds_read_b128 a[192:195], v2 offset:0
v_mfma_f32_16x16x32_bf16 v[184:187], a[176:179], v[48:51], v[112:115]
v_exp_f32 v137, v137
v_mfma_f32_16x16x32_bf16 v[188:191], a[176:179], v[64:67], v[108:111]
v_exp_f32 v138, v138
s_branch Ljoin47
Lslow:
s_waitcnt vmcnt(0) lgkmcnt(0)
s_barrier
s_mov_b32 s86, 1
s_lshl_b32 s81, s59, 20
s_add_u32 s81, s81, s64
s_sub_u32 s81, s81, 0x4000
s_mov_b32 s83, 0
s_lshl_b32 s75, s60, 2
s_sub_u32 s76, 64, s75
s_sub_u32 s75, s76, 4
s_add_u32 s75, s75, s58
v_mov_b32 v2, v1
v_lshrrev_b32 v240, 4, v0
v_and_b32 v241, 15, v0
v_lshlrev_b32 v240, 2, v240
v_sub_u32 v240, v241, v240
v_mov_b32 v112, 0xff800000
v_mov_b32 v113, 0xff800000
v_mov_b32 v114, 0xff800000
v_mov_b32 v115, 0xff800000
v_cmp_gt_i32 vcc, 0, v240
v_mov_b32 v120, 0x3f803f80
s_nop 0
v_cndmask_b32 v116, 0, v112, vcc
v_cmp_gt_i32 vcc, 1, v240
v_mov_b32 v121, 0x3f803f80
s_nop 0
v_cndmask_b32 v117, 0, v112, vcc
v_cmp_gt_i32 vcc, 2, v240
v_mov_b32 v122, 0x3f803f80
s_nop 0
v_cndmask_b32 v118, 0, v112, vcc
v_cmp_gt_i32 vcc, 3, v240
v_mov_b32 v123, 0x3f803f80
s_nop 0
v_cndmask_b32 v119, 0, v112, vcc
Lslow1:
s_add_u32 m0, s64, 16384
s_add_u32 s72, s81, 16384
buffer_load_dwordx4 v1, s[44:47], s72 offen sc1 lds
buffer_load_dwordx4 v1, s[44:47], s72 offen offset:1024 sc1 lds
buffer_load_dwordx4 v1, s[44:47], s72 offen offset:2048 sc1 lds
buffer_load_dwordx4 v1, s[44:47], s72 offen offset:3072 sc1 lds
s_add_u32 s81, s81, 0x8000
s_waitcnt vmcnt(0)
s_barrier
ds_read_b128 a[128:131], v2 offset:16384
ds_read_b128 a[144:147], v2 offset:20480
ds_read_b128 a[132:135], v2 offset:17408
ds_read_b128 a[148:151], v2 offset:21504
ds_read_b128 a[136:139], v2 offset:18432
ds_read_b128 a[152:155], v2 offset:22528
ds_read_b128 a[140:143], v2 offset:19456
ds_read_b128 a[156:159], v2 offset:23552
s_waitcnt lgkmcnt(0)
s_cmp_lt_u32 s84, s83
s_cbranch_scc1 Lsa48
s_cmp_eq_u32 s84, s83
s_cbranch_scc1 Lst49
v_mfma_f32_16x16x32_bf16 v[128:131], a[128:131], v[16:19], 0
v_mfma_f32_16x16x32_bf16 v[132:135], a[128:131], v[32:35], 0
v_mfma_f32_16x16x32_bf16 v[144:147], a[144:147], v[16:19], 0
v_mfma_f32_16x16x32_bf16 v[148:151], a[144:147], v[32:35], 0
s_branch Lsj50
Lst49:
v_mfma_f32_16x16x32_bf16 v[128:131], a[128:131], v[16:19], v[116:119]
v_mfma_f32_16x16x32_bf16 v[132:135], a[128:131], v[32:35], 0
v_mfma_f32_16x16x32_bf16 v[144:147], a[144:147], v[16:19], v[112:115]
v_mfma_f32_16x16x32_bf16 v[148:151], a[144:147], v[32:35], v[116:119]
Lsj50:
v_mfma_f32_16x16x32_bf16 v[128:131], a[132:135], v[20:23], v[128:131]
v_mfma_f32_16x16x32_bf16 v[132:135], a[132:135], v[36:39], v[132:135]
v_mfma_f32_16x16x32_bf16 v[148:151], a[148:151], v[36:39], v[148:151]
v_mfma_f32_16x16x32_bf16 v[144:147], a[148:151], v[20:23], v[144:147]
v_mfma_f32_16x16x32_bf16 v[132:135], a[136:139], v[40:43], v[132:135]
v_mfma_f32_16x16x32_bf16 v[128:131], a[136:139], v[24:27], v[128:131]
v_mfma_f32_16x16x32_bf16 v[144:147], a[152:155], v[24:27], v[144:147]
v_mfma_f32_16x16x32_bf16 v[148:151], a[152:155], v[40:43], v[148:151]
v_mfma_f32_16x16x32_bf16 v[128:131], a[140:143], v[28:31], v[128:131]
v_mfma_f32_16x16x32_bf16 v[132:135], a[140:143], v[44:47], v[132:135]
v_mfma_f32_16x16x32_bf16 v[148:151], a[156:159], v[44:47], v[148:151]
v_mfma_f32_16x16x32_bf16 v[144:147], a[156:159], v[28:31], v[144:147]
s_nop 7
v_max3_f32 v124, v124, v128, v129
v_max3_f32 v124, v124, v130, v131
v_max3_f32 v124, v124, v144, v145
v_max3_f32 v124, v124, v146, v147
v_max3_f32 v125, v125, v132, v133
v_max3_f32 v125, v125, v134, v135
v_max3_f32 v125, v125, v148, v149
v_max3_f32 v125, v125, v150, v151
Lsa48:
s_cmp_lt_u32 s75, s83
s_cbranch_scc1 Lsa51
s_cmp_eq_u32 s75, s83
s_cbranch_scc1 Lst52
v_mfma_f32_16x16x32_bf16 v[136:139], a[128:131], v[48:51], 0
v_mfma_f32_16x16x32_bf16 v[140:143], a[128:131], v[64:67], 0
v_mfma_f32_16x16x32_bf16 v[152:155], a[144:147], v[48:51], 0
v_mfma_f32_16x16x32_bf16 v[156:159], a[144:147], v[64:67], 0
s_branch Lsj53
Lst52:
v_mfma_f32_16x16x32_bf16 v[136:139], a[128:131], v[48:51], v[116:119]
v_mfma_f32_16x16x32_bf16 v[140:143], a[128:131], v[64:67], 0
v_mfma_f32_16x16x32_bf16 v[152:155], a[144:147], v[48:51], v[112:115]
v_mfma_f32_16x16x32_bf16 v[156:159], a[144:147], v[64:67], v[116:119]
Lsj53:
v_mfma_f32_16x16x32_bf16 v[136:139], a[132:135], v[52:55], v[136:139]
v_mfma_f32_16x16x32_bf16 v[140:143], a[132:135], v[68:71], v[140:143]
v_mfma_f32_16x16x32_bf16 v[156:159], a[148:151], v[68:71], v[156:159]
v_mfma_f32_16x16x32_bf16 v[152:155], a[148:151], v[52:55], v[152:155]
v_mfma_f32_16x16x32_bf16 v[140:143], a[136:139], v[72:75], v[140:143]
v_mfma_f32_16x16x32_bf16 v[136:139], a[136:139], v[56:59], v[136:139]
v_mfma_f32_16x16x32_bf16 v[152:155], a[152:155], v[56:59], v[152:155]
v_mfma_f32_16x16x32_bf16 v[156:159], a[152:155], v[72:75], v[156:159]
v_mfma_f32_16x16x32_bf16 v[136:139], a[140:143], v[60:63], v[136:139]
v_mfma_f32_16x16x32_bf16 v[140:143], a[140:143], v[76:79], v[140:143]
v_mfma_f32_16x16x32_bf16 v[156:159], a[156:159], v[76:79], v[156:159]
v_mfma_f32_16x16x32_bf16 v[152:155], a[156:159], v[60:63], v[152:155]
s_nop 7
v_max3_f32 v126, v126, v136, v137
v_max3_f32 v126, v126, v138, v139
v_max3_f32 v126, v126, v152, v153
v_max3_f32 v126, v126, v154, v155
v_max3_f32 v127, v127, v140, v141
v_max3_f32 v127, v127, v142, v143
v_max3_f32 v127, v127, v156, v157
v_max3_f32 v127, v127, v158, v159
Lsa51:
s_add_u32 s83, s83, 1
ds_read_b128 a[128:131], v2 offset:24576
ds_read_b128 a[144:147], v2 offset:28672
ds_read_b128 a[132:135], v2 offset:25600
ds_read_b128 a[148:151], v2 offset:29696
ds_read_b128 a[136:139], v2 offset:26624
ds_read_b128 a[152:155], v2 offset:30720
ds_read_b128 a[140:143], v2 offset:27648
ds_read_b128 a[156:159], v2 offset:31744
s_waitcnt lgkmcnt(0)
s_cmp_lt_u32 s84, s83
s_cbranch_scc1 Lsa54
s_cmp_eq_u32 s84, s83
s_cbranch_scc1 Lst55
v_mfma_f32_16x16x32_bf16 v[128:131], a[128:131], v[16:19], 0
v_mfma_f32_16x16x32_bf16 v[132:135], a[128:131], v[32:35], 0
v_mfma_f32_16x16x32_bf16 v[144:147], a[144:147], v[16:19], 0
v_mfma_f32_16x16x32_bf16 v[148:151], a[144:147], v[32:35], 0
s_branch Lsj56
Lst55:
v_mfma_f32_16x16x32_bf16 v[128:131], a[128:131], v[16:19], v[116:119]
v_mfma_f32_16x16x32_bf16 v[132:135], a[128:131], v[32:35], 0
v_mfma_f32_16x16x32_bf16 v[144:147], a[144:147], v[16:19], v[112:115]
v_mfma_f32_16x16x32_bf16 v[148:151], a[144:147], v[32:35], v[116:119]
Lsj56:
v_mfma_f32_16x16x32_bf16 v[128:131], a[132:135], v[20:23], v[128:131]
v_mfma_f32_16x16x32_bf16 v[132:135], a[132:135], v[36:39], v[132:135]
v_mfma_f32_16x16x32_bf16 v[148:151], a[148:151], v[36:39], v[148:151]
v_mfma_f32_16x16x32_bf16 v[144:147], a[148:151], v[20:23], v[144:147]
v_mfma_f32_16x16x32_bf16 v[132:135], a[136:139], v[40:43], v[132:135]
v_mfma_f32_16x16x32_bf16 v[128:131], a[136:139], v[24:27], v[128:131]
v_mfma_f32_16x16x32_bf16 v[144:147], a[152:155], v[24:27], v[144:147]
v_mfma_f32_16x16x32_bf16 v[148:151], a[152:155], v[40:43], v[148:151]
v_mfma_f32_16x16x32_bf16 v[128:131], a[140:143], v[28:31], v[128:131]
v_mfma_f32_16x16x32_bf16 v[132:135], a[140:143], v[44:47], v[132:135]
v_mfma_f32_16x16x32_bf16 v[148:151], a[156:159], v[44:47], v[148:151]
v_mfma_f32_16x16x32_bf16 v[144:147], a[156:159], v[28:31], v[144:147]
s_nop 7
v_max3_f32 v124, v124, v128, v129
v_max3_f32 v124, v124, v130, v131
v_max3_f32 v124, v124, v144, v145
v_max3_f32 v124, v124, v146, v147
v_max3_f32 v125, v125, v132, v133
v_max3_f32 v125, v125, v134, v135
v_max3_f32 v125, v125, v148, v149
v_max3_f32 v125, v125, v150, v151
Lsa54:
s_cmp_lt_u32 s75, s83
s_cbranch_scc1 Lsa57
s_cmp_eq_u32 s75, s83
s_cbranch_scc1 Lst58
v_mfma_f32_16x16x32_bf16 v[136:139], a[128:131], v[48:51], 0
v_mfma_f32_16x16x32_bf16 v[140:143], a[128:131], v[64:67], 0
v_mfma_f32_16x16x32_bf16 v[152:155], a[144:147], v[48:51], 0
v_mfma_f32_16x16x32_bf16 v[156:159], a[144:147], v[64:67], 0
s_branch Lsj59
Lst58:
v_mfma_f32_16x16x32_bf16 v[136:139], a[128:131], v[48:51], v[116:119]
v_mfma_f32_16x16x32_bf16 v[140:143], a[128:131], v[64:67], 0
v_mfma_f32_16x16x32_bf16 v[152:155], a[144:147], v[48:51], v[112:115]
v_mfma_f32_16x16x32_bf16 v[156:159], a[144:147], v[64:67], v[116:119]
Lsj59:
v_mfma_f32_16x16x32_bf16 v[136:139], a[132:135], v[52:55], v[136:139]
v_mfma_f32_16x16x32_bf16 v[140:143], a[132:135], v[68:71], v[140:143]
v_mfma_f32_16x16x32_bf16 v[156:159], a[148:151], v[68:71], v[156:159]
v_mfma_f32_16x16x32_bf16 v[152:155], a[148:151], v[52:55], v[152:155]
v_mfma_f32_16x16x32_bf16 v[140:143], a[136:139], v[72:75], v[140:143]
v_mfma_f32_16x16x32_bf16 v[136:139], a[136:139], v[56:59], v[136:139]
v_mfma_f32_16x16x32_bf16 v[152:155], a[152:155], v[56:59], v[152:155]
v_mfma_f32_16x16x32_bf16 v[156:159], a[152:155], v[72:75], v[156:159]
v_mfma_f32_16x16x32_bf16 v[136:139], a[140:143], v[60:63], v[136:139]
v_mfma_f32_16x16x32_bf16 v[140:143], a[140:143], v[76:79], v[140:143]
v_mfma_f32_16x16x32_bf16 v[156:159], a[156:159], v[76:79], v[156:159]
v_mfma_f32_16x16x32_bf16 v[152:155], a[156:159], v[60:63], v[152:155]
s_nop 7
v_max3_f32 v126, v126, v136, v137
v_max3_f32 v126, v126, v138, v139
v_max3_f32 v126, v126, v152, v153
v_max3_f32 v126, v126, v154, v155
v_max3_f32 v127, v127, v140, v141
v_max3_f32 v127, v127, v142, v143
v_max3_f32 v127, v127, v156, v157
v_max3_f32 v127, v127, v158, v159
Lsa57:
s_add_u32 s83, s83, 1
s_barrier
s_cmp_lt_u32 s83, s76
s_cbranch_scc1 Lslow1
s_lshl_b32 s81, s59, 20
s_add_u32 s81, s81, s64
s_sub_u32 s81, s81, 0x4000
s_add_u32 m0, s64, 49152
s_add_u32 s72, s81, 16384
buffer_load_dwordx4 v1, s[44:47], s72 offen sc1 lds
buffer_load_dwordx4 v1, s[44:47], s72 offen offset:1024 sc1 lds
buffer_load_dwordx4 v1, s[44:47], s72 offen offset:2048 sc1 lds
buffer_load_dwordx4 v1, s[44:47], s72 offen offset:3072 sc1 lds
s_add_u32 s81, s81, 0x8000
s_add_u32 m0, s64, 81920
s_add_u32 s72, s81, 16384
buffer_load_dwordx4 v1, s[44:47], s72 offen sc1 lds
buffer_load_dwordx4 v1, s[44:47], s72 offen offset:1024 sc1 lds
buffer_load_dwordx4 v1, s[44:47], s72 offen offset:2048 sc1 lds
buffer_load_dwordx4 v1, s[44:47], s72 offen offset:3072 sc1 lds
s_add_u32 m0, s64, 65536
s_add_u32 s72, s81, 0
buffer_load_dwordx4 v1, s[44:47], s72 offen sc1 lds
buffer_load_dwordx4 v1, s[44:47], s72 offen offset:1024 sc1 lds
buffer_load_dwordx4 v1, s[44:47], s72 offen offset:2048 sc1 lds
buffer_load_dwordx4 v1, s[44:47], s72 offen offset:3072 sc1 lds
s_add_u32 s81, s81, 0x8000
s_add_u32 m0, s64, 114688
s_add_u32 s72, s81, 16384
buffer_load_dwordx4 v1, s[44:47], s72 offen sc1 lds
buffer_load_dwordx4 v1, s[44:47], s72 offen offset:1024 sc1 lds
buffer_load_dwordx4 v1, s[44:47], s72 offen offset:2048 sc1 lds
buffer_load_dwordx4 v1, s[44:47], s72 offen offset:3072 sc1 lds
s_add_u32 m0, s64, 98304
s_add_u32 s72, s81, 0
buffer_load_dwordx4 v1, s[44:47], s72 offen sc1 lds
buffer_load_dwordx4 v1, s[44:47], s72 offen offset:1024 sc1 lds
buffer_load_dwordx4 v1, s[44:47], s72 offen offset:2048 sc1 lds
buffer_load_dwordx4 v1, s[44:47], s72 offen offset:3072 sc1 lds
v_add_u32 v2, 0x8000, v1
s_waitcnt vmcnt(16)
s_barrier
ds_read_b128 a[128:131], v2 offset:16384
ds_read_b128 a[144:147], v2 offset:20480
ds_read_b128 a[132:135], v2 offset:17408
ds_read_b128 a[148:151], v2 offset:21504
ds_read_b128 a[136:139], v2 offset:18432
ds_read_b128 a[152:155], v2 offset:22528
ds_read_b128 a[140:143], v2 offset:19456
ds_read_b128 a[156:159], v2 offset:23552
s_branch Lattn
Lspin60:
s_mov_b32 s83, 262144
Lsl62:
s_sleep 2
buffer_load_dword v3, v2, s[44:47], s74 offen sc1
s_sub_u32 s83, s83, 1
s_cmp_eq_u32 s83, 0
s_waitcnt vmcnt(0)
s_cbranch_scc1 Lback61
v_cmp_gt_u32 vcc, 2, v3
s_cbranch_vccnz Lsl62
s_branch Lback61
Lspin63:
s_mov_b32 s83, 262144
Lsl65:
s_sleep 2
buffer_load_dword v3, v2, s[44:47], s74 offen sc1
s_sub_u32 s83, s83, 1
s_cmp_eq_u32 s83, 0
s_waitcnt vmcnt(0)
s_cbranch_scc1 Lback64
v_cmp_gt_u32 vcc, 3, v3
s_cbranch_vccnz Lsl65
s_branch Lback64
Lcode_end:
s_endpgm
.section .rodata,"a"
.p2align 6
.amdhsa_kernel gated_mix__compressed_kv_cla__ssm_conv_h3__prompt_kernel
  .amdhsa_next_free_vgpr 512
  .amdhsa_next_free_sgpr 102
  .amdhsa_accum_offset 256
  .amdhsa_group_segment_fixed_size 0
  .amdhsa_kernarg_size 128
  .amdhsa_user_sgpr_count 2
  .amdhsa_user_sgpr_kernarg_segment_ptr 1
  .amdhsa_system_sgpr_workgroup_id_x 1
  .amdhsa_float_denorm_mode_32 3
.end_amdhsa_kernel
```

```asm
; @launch grid=(256,1,1) block=(256,1,1) lds=163840
.amdgcn_target "amdgcn-amd-amdhsa--gfx950"
.text
.globl gated_mix__compressed_kv_cla__ssm_conv_h3__prompt_kernel
.p2align 8
.type gated_mix__compressed_kv_cla__ssm_conv_h3__prompt_kernel,@function
gated_mix__compressed_kv_cla__ssm_conv_h3__prompt_kernel:
s_cmp_ge_u32 s2, 256
s_cbranch_scc1 Lend
s_load_dwordx2 s[8:9], s[0:1], 8
s_load_dwordx2 s[16:17], s[0:1], 24
s_load_dwordx2 s[20:21], s[0:1], 32
s_load_dwordx2 s[4:5], s[0:1], 0
s_load_dwordx2 s[12:13], s[0:1], 16
s_load_dwordx2 s[24:25], s[0:1], 40
s_load_dwordx2 s[28:29], s[0:1], 56
s_load_dwordx2 s[32:33], s[0:1], 64
s_load_dwordx2 s[52:53], s[0:1], 72
s_load_dwordx2 s[36:37], s[0:1], 80
s_load_dwordx2 s[54:55], s[0:1], 88
s_load_dwordx2 s[56:57], s[0:1], 96
s_load_dwordx2 s[40:41], s[0:1], 104
s_load_dwordx2 s[48:49], s[0:1], 112
s_load_dwordx2 s[44:45], s[0:1], 120
s_getpc_b64 s[98:99]
Lpc0:
s_lshr_b32 s75, s2, 3
v_lshrrev_b32 v26, 3, v0
s_lshl_b32 s73, s75, 12
v_lshlrev_b32 v26, 7, v26
v_add_u32 v26, s73, v26
v_min_u32 v26, Lcode_end-Lpc0, v26
global_load_dword v31, v26, s[98:99]
v_lshrrev_b32 v26, 6, v0
v_and_b32 v0, 63, v0
s_and_b32 s73, s2, 7
v_readfirstlane_b32 s58, v26
s_lshr_b32 s65, s75, 3
s_and_b32 s60, s75, 7
s_lshl_b32 s59, s73, 2
s_add_u32 s59, s59, s65
s_lshl_b32 s61, s65, 1
s_lshl_b32 s63, s58, 13
s_lshl_b32 s64, s58, 12
s_lshl_b32 s67, s60, 18
s_lshl_b32 s76, s58, 16
s_add_u32 s67, s67, s76
s_lshl_b32 s66, s58, 17
s_lshl_b32 s73, s59, 8
s_add_u32 s66, s66, s73
v_lshrrev_b32 v26, 4, v0
v_and_b32 v27, 7, v0
v_xor_b32 v27, v27, v26
v_lshlrev_b32 v27, 4, v27
v_lshrrev_b32 v28, 3, v0
v_lshl_add_u32 v2, v28, 10, v27
v_xor_b32 v3, 64, v2
v_and_b32 v29, 15, v0
v_lshlrev_b32 v30, 1, v26
v_xor_b32 v30, v30, v29
v_lshlrev_b32 v30, 4, v30
v_lshl_add_u32 v6, v26, 13, v30
v_xor_b32 v7, 0x80, v6
s_mov_b32 s10, 0x200000
s_mov_b32 s11, 0x20000
s_mov_b32 s18, 0x400000
s_mov_b32 s19, 0x20000
s_mov_b32 s22, 0x400000
s_mov_b32 s23, 0x20000
s_waitcnt lgkmcnt(0)
s_add_u32 s73, s61, 0
s_and_b32 s73, s73, 7
s_lshl_b32 s69, s73, 7
s_add_u32 s69, s69, s67
s_lshl_b32 s71, s73, 19
s_add_u32 s71, s71, s66
s_add_u32 m0, s63, 65536
s_add_u32 s72, s69, 0
buffer_load_dwordx4 v2, s[8:11], s72 offen lds
s_add_u32 s72, s69, 7168
buffer_load_dwordx4 v3, s[8:11], s72 offen offset:1024 lds
s_add_u32 s72, s69, 14336
buffer_load_dwordx4 v2, s[8:11], s72 offen offset:2048 lds
s_add_u32 s72, s69, 21504
buffer_load_dwordx4 v3, s[8:11], s72 offen offset:3072 lds
s_add_u32 m0, s64, 0
s_add_u32 s72, s71, 0
buffer_load_dwordx4 v6, s[16:19], s72 offen lds
s_add_u32 s72, s71, 31744
buffer_load_dwordx4 v6, s[16:19], s72 offen offset:1024 lds
s_add_u32 s72, s71, 63488
buffer_load_dwordx4 v7, s[16:19], s72 offen offset:2048 lds
s_add_u32 s72, s71, 95232
buffer_load_dwordx4 v7, s[16:19], s72 offen offset:3072 lds
s_add_u32 m0, s63, 69632
s_add_u32 s72, s69, 32768
buffer_load_dwordx4 v2, s[8:11], s72 offen lds
s_add_u32 s72, s69, 39936
buffer_load_dwordx4 v3, s[8:11], s72 offen offset:1024 lds
s_add_u32 s72, s69, 47104
buffer_load_dwordx4 v2, s[8:11], s72 offen offset:2048 lds
s_add_u32 s72, s69, 54272
buffer_load_dwordx4 v3, s[8:11], s72 offen offset:3072 lds
s_add_u32 m0, s64, 16384
s_add_u32 s72, s71, 0
buffer_load_dwordx4 v6, s[20:23], s72 offen lds
s_add_u32 s72, s71, 31744
buffer_load_dwordx4 v6, s[20:23], s72 offen offset:1024 lds
s_add_u32 s72, s71, 63488
buffer_load_dwordx4 v7, s[20:23], s72 offen offset:2048 lds
s_add_u32 s72, s71, 95232
buffer_load_dwordx4 v7, s[20:23], s72 offen offset:3072 lds
s_lshl_b32 s73, s2, 2
s_add_u32 s73, s73, s58
s_lshl_b32 s73, s73, 11
v_lshrrev_b32 v124, 2, v0
v_lshlrev_b32 v124, 7, v124
v_add_u32 v124, s73, v124
s_lshl_b32 s73, s60, 2
s_add_u32 s73, s73, s58
s_lshl_b32 s73, s73, 13
s_lshl_b32 s74, s59, 8
s_add_u32 s73, s73, s74
v_lshrrev_b32 v125, 4, v0
v_lshlrev_b32 v125, 18, v125
v_bfe_u32 v126, v0, 3, 1
v_lshl_add_u32 v125, v126, 7, v125
v_add_u32 v125, s73, v125
s_add_u32 s80, s65, 0
s_and_b32 s80, s80, 3
s_lshl_b32 s80, s80, 20
buffer_load_dword v126, v125, s[16:19], s80 offen
buffer_load_dword v126, v125, s[20:23], s80 offen
buffer_load_dword v126, v124, s[8:11], 0 offen
s_add_u32 s73, s61, 1
s_and_b32 s73, s73, 7
s_lshl_b32 s69, s73, 7
s_add_u32 s69, s69, s67
s_lshl_b32 s71, s73, 19
s_add_u32 s71, s71, s66
s_add_u32 m0, s63, 98304
s_add_u32 s72, s69, 0
buffer_load_dwordx4 v2, s[8:11], s72 offen lds
s_add_u32 s72, s69, 7168
buffer_load_dwordx4 v3, s[8:11], s72 offen offset:1024 lds
s_add_u32 s72, s69, 14336
buffer_load_dwordx4 v2, s[8:11], s72 offen offset:2048 lds
s_add_u32 s72, s69, 21504
buffer_load_dwordx4 v3, s[8:11], s72 offen offset:3072 lds
s_mov_b32 s6, 0x400000
s_mov_b32 s7, 0x20000
s_mov_b32 s14, 0x800000
s_mov_b32 s15, 0x20000
s_mov_b32 s26, 0x800000
s_mov_b32 s27, 0x20000
s_mov_b32 s30, 0x400000
s_mov_b32 s31, 0x20000
s_mov_b32 s34, 0x400000
s_mov_b32 s35, 0x20000
s_mov_b32 s38, 0x400000
s_mov_b32 s39, 0x20000
s_mov_b32 s42, 0x400000
s_mov_b32 s43, 0x20000
s_mov_b32 s46, 0x8000000
s_mov_b32 s47, 0x20000
s_mov_b32 s50, 0x100
s_mov_b32 s51, 0x20000
v_lshl_add_u32 v4, v28, 11, v27
v_xor_b32 v5, 64, v4
v_lshlrev_b32 v1, 4, v0
s_sub_u32 s74, 15, s60
s_lshl_b32 s68, s74, 18
s_add_u32 s68, s68, s76
s_and_b32 s62, s60, 3
s_sub_u32 s62, 16, s62
s_lshl_b32 s91, s59, 3
s_add_u32 s91, s91, s60
s_lshl_b32 s93, s91, 2
s_add_u32 s93, s93, s58
s_lshl_b32 s91, s91, 7
s_add_u32 s91, s91, 0x3810000
s_lshl_b32 s75, s93, 1
s_and_b32 s75, s75, 0xffc
s_lshl_b32 s93, s93, 12
s_mul_i32 s92, s58, 21248
s_load_dwordx2 s[88:89], s[36:37], s93
s_load_dword s90, s[54:55], s75
v_or_b32 v29, s58, v0
v_mov_b32 v30, 0
v_min_u32 v29, 1, v29
v_lshlrev_b32 v29, 30, v29
buffer_store_dword v30, v29, s[44:47], s91 offen sc1
s_and_b32 s73, s2, 15
s_lshr_b32 s74, s2, 4
s_lshl_b32 s74, s74, 7
s_lshl_b32 s75, s58, 5
s_add_u32 s74, s74, s75
s_mov_b32 s75, 131072
v_lshrrev_b32 v29, 5, v0
v_lshlrev_b32 v29, 4, v29
v_add_u32 v29, s74, v29
v_and_b32 v30, 31, v0
s_lshl_b32 s73, s73, 5
v_add_u32 v30, s73, v30
v_lshlrev_b32 v26, 11, v29
v_lshl_add_u32 v26, v30, 2, v26
v_subrev_u32 v27, 0x1800, v26
v_and_b32 v29, 0x7f, v29
v_sub_u32 v29, 0x70, v29
v_lshlrev_b32 v29, 1, v29
v_and_b32 v32, 31, v0
v_mul_u32_u24 v32, 544, v32
v_add3_u32 v28, v32, v29, s75
v_lshlrev_b32 v30, 4, v30
s_lshl_b32 s73, s2, 14
s_lshl_b32 s74, s58, 12
s_add_u32 s76, s73, s74
v_and_b32 v29, 15, v0
v_lshrrev_b32 v32, 4, v0
v_lshrrev_b32 v24, 1, v29
v_xor_b32 v24, v24, v32
v_lshlrev_b32 v24, 4, v24
v_lshl_add_u32 v24, v29, 7, v24
s_add_u32 s73, s63, 131072
v_add_u32 v16, s73, v24
v_xor_b32 v17, 64, v16
v_subrev_u32 v18, 0x10000, v16
v_subrev_u32 v19, 0x10000, v17
s_lshr_b32 s73, s58, 1
s_lshl_b32 s74, s73, 14
s_add_u32 s74, s74, 0x10000
v_add_u32 v24, s74, v24
v_xor_b32 v25, 64, v24
v_lshrrev_b32 v8, 2, v29
v_and_b32 v9, 1, v32
v_lshl_add_u32 v9, v9, 2, v8
v_lshl_add_u32 v8, v32, 3, v8
v_lshlrev_b32 v8, 8, v8
v_lshl_add_u32 v8, v9, 5, v8
v_and_b32 v29, 3, v0
v_lshl_add_u32 v8, v29, 3, v8
s_and_b32 s74, s58, 1
s_lshl_b32 s75, s74, 7
v_xor_b32 v20, s75, v8
v_xor_b32 v9, 32, v8
v_xor_b32 v10, 64, v8
v_xor_b32 v11, 96, v8
v_xor_b32 v12, 128, v8
v_xor_b32 v13, 160, v8
v_xor_b32 v14, 192, v8
v_xor_b32 v15, 224, v8
v_xor_b32 v21, 32, v20
v_xor_b32 v22, 64, v20
v_xor_b32 v23, 96, v20
s_lshl_b32 s77, s59, 20
s_add_u32 s81, s77, s64
s_sub_u32 s81, s81, 0x4000
s_lshl_b32 s75, s60, 17
s_add_u32 s77, s77, s75
s_lshl_b32 s73, s73, 16
s_add_u32 s77, s77, s73
s_lshl_b32 s75, s74, 12
s_add_u32 s78, s77, s75
s_add_u32 s78, s78, 0x4000
s_lshl_b32 s75, s74, 11
s_add_u32 s77, s77, s75
s_mov_b32 s79, 0x3e0293ee
s_waitcnt vmcnt(8)
s_barrier
ds_read_b64_tr_b16 v[160:161], v20 offset:0
ds_read_b64_tr_b16 v[162:163], v20 offset:1024
ds_read_b128 v[128:131], v24 offset:0
ds_read_b128 v[132:135], v24 offset:2048
ds_read_b128 v[136:139], v24 offset:4096
ds_read_b128 v[140:143], v24 offset:6144
ds_read_b128 v[144:147], v24 offset:8192
ds_read_b128 v[148:151], v24 offset:10240
ds_read_b128 v[152:155], v24 offset:12288
ds_read_b128 v[156:159], v24 offset:14336
ds_read_b64_tr_b16 v[164:165], v21 offset:0
ds_read_b64_tr_b16 v[166:167], v21 offset:1024
ds_read_b64_tr_b16 v[168:169], v22 offset:0
ds_read_b64_tr_b16 v[170:171], v22 offset:1024
ds_read_b64_tr_b16 v[172:173], v23 offset:0
ds_read_b64_tr_b16 v[174:175], v23 offset:1024
ds_read_b64_tr_b16 v[176:177], v20 offset:16384
ds_read_b64_tr_b16 v[178:179], v20 offset:17408
ds_read_b64_tr_b16 v[180:181], v21 offset:16384
ds_read_b64_tr_b16 v[182:183], v21 offset:17408
ds_read_b64_tr_b16 v[184:185], v22 offset:16384
ds_read_b64_tr_b16 v[186:187], v22 offset:17408
ds_read_b64_tr_b16 v[188:189], v23 offset:16384
ds_read_b64_tr_b16 v[190:191], v23 offset:17408
s_waitcnt lgkmcnt(0)
v_mfma_f32_16x16x32_bf16 a[0:3], v[160:163], v[128:131], 0
s_add_u32 m0, s64, 32768
ds_read_b64_tr_b16 v[224:225], v20 offset:8192
v_mfma_f32_16x16x32_bf16 a[4:7], v[160:163], v[132:135], 0
s_add_u32 s72, s71, 0
buffer_load_dwordx4 v6, s[16:19], s72 offen lds
v_mfma_f32_16x16x32_bf16 a[8:11], v[160:163], v[136:139], 0
s_add_u32 s72, s71, 31744
buffer_load_dwordx4 v6, s[16:19], s72 offen offset:1024 lds
v_mfma_f32_16x16x32_bf16 a[12:15], v[160:163], v[140:143], 0
ds_read_b64_tr_b16 v[226:227], v20 offset:9216
v_mfma_f32_16x16x32_bf16 a[16:19], v[160:163], v[144:147], 0
s_add_u32 s72, s71, 63488
buffer_load_dwordx4 v7, s[16:19], s72 offen offset:2048 lds
v_mfma_f32_16x16x32_bf16 a[20:23], v[160:163], v[148:151], 0
ds_read_b128 v[192:195], v25 offset:0
v_mfma_f32_16x16x32_bf16 a[24:27], v[160:163], v[152:155], 0
s_add_u32 s72, s71, 95232
buffer_load_dwordx4 v7, s[16:19], s72 offen offset:3072 lds
v_mfma_f32_16x16x32_bf16 a[28:31], v[160:163], v[156:159], 0
ds_read_b128 v[196:199], v25 offset:2048
v_mfma_f32_16x16x32_bf16 a[60:63], v[164:167], v[156:159], 0
s_add_u32 m0, s63, 102400
ds_read_b128 v[200:203], v25 offset:4096
v_mfma_f32_16x16x32_bf16 a[56:59], v[164:167], v[152:155], 0
s_add_u32 s72, s69, 32768
buffer_load_dwordx4 v2, s[8:11], s72 offen lds
v_mfma_f32_16x16x32_bf16 a[52:55], v[164:167], v[148:151], 0
s_add_u32 s72, s69, 39936
buffer_load_dwordx4 v3, s[8:11], s72 offen offset:1024 lds
v_mfma_f32_16x16x32_bf16 a[48:51], v[164:167], v[144:147], 0
ds_read_b128 v[204:207], v25 offset:6144
v_mfma_f32_16x16x32_bf16 a[44:47], v[164:167], v[140:143], 0
s_add_u32 s72, s69, 47104
buffer_load_dwordx4 v2, s[8:11], s72 offen offset:2048 lds
v_mfma_f32_16x16x32_bf16 a[40:43], v[164:167], v[136:139], 0
ds_read_b128 v[208:211], v25 offset:8192
v_mfma_f32_16x16x32_bf16 a[36:39], v[164:167], v[132:135], 0
s_add_u32 s72, s69, 54272
buffer_load_dwordx4 v3, s[8:11], s72 offen offset:3072 lds
v_mfma_f32_16x16x32_bf16 a[32:35], v[164:167], v[128:131], 0
ds_read_b128 v[212:215], v25 offset:10240
v_mfma_f32_16x16x32_bf16 a[64:67], v[168:171], v[128:131], 0
s_add_u32 m0, s64, 49152
ds_read_b128 v[216:219], v25 offset:12288
v_mfma_f32_16x16x32_bf16 a[68:71], v[168:171], v[132:135], 0
s_add_u32 s72, s71, 0
buffer_load_dwordx4 v6, s[20:23], s72 offen lds
v_mfma_f32_16x16x32_bf16 a[72:75], v[168:171], v[136:139], 0
s_add_u32 s72, s71, 31744
buffer_load_dwordx4 v6, s[20:23], s72 offen offset:1024 lds
v_mfma_f32_16x16x32_bf16 a[76:79], v[168:171], v[140:143], 0
ds_read_b128 v[220:223], v25 offset:14336
v_mfma_f32_16x16x32_bf16 a[80:83], v[168:171], v[144:147], 0
s_add_u32 s72, s71, 63488
buffer_load_dwordx4 v7, s[20:23], s72 offen offset:2048 lds
v_mfma_f32_16x16x32_bf16 a[84:87], v[168:171], v[148:151], 0
ds_read_b64_tr_b16 v[228:229], v21 offset:8192
v_mfma_f32_16x16x32_bf16 a[88:91], v[168:171], v[152:155], 0
s_add_u32 s72, s71, 95232
buffer_load_dwordx4 v7, s[20:23], s72 offen offset:3072 lds
v_mfma_f32_16x16x32_bf16 a[92:95], v[168:171], v[156:159], 0
s_add_u32 s80, s65, 1
ds_read_b64_tr_b16 v[230:231], v21 offset:9216
v_mfma_f32_16x16x32_bf16 a[124:127], v[172:175], v[156:159], 0
s_and_b32 s80, s80, 3
ds_read_b64_tr_b16 v[232:233], v22 offset:8192
v_mfma_f32_16x16x32_bf16 a[120:123], v[172:175], v[152:155], 0
s_lshl_b32 s80, s80, 20
buffer_load_dword v126, v125, s[16:19], s80 offen
v_mfma_f32_16x16x32_bf16 a[116:119], v[172:175], v[148:151], 0
buffer_load_dword v126, v125, s[20:23], s80 offen
v_mfma_f32_16x16x32_bf16 a[112:115], v[172:175], v[144:147], 0
ds_read_b64_tr_b16 v[234:235], v22 offset:9216
v_mfma_f32_16x16x32_bf16 a[108:111], v[172:175], v[140:143], 0
ds_read_b64_tr_b16 v[236:237], v23 offset:8192
v_mfma_f32_16x16x32_bf16 a[104:107], v[172:175], v[136:139], 0
ds_read_b64_tr_b16 v[238:239], v23 offset:9216
v_mfma_f32_16x16x32_bf16 a[100:103], v[172:175], v[132:135], 0
ds_read_b64_tr_b16 v[240:241], v20 offset:24576
v_mfma_f32_16x16x32_bf16 a[96:99], v[172:175], v[128:131], 0
ds_read_b64_tr_b16 v[242:243], v20 offset:25600
v_mfma_f32_16x16x32_bf16 a[128:131], v[128:131], v[176:179], 0
ds_read_b64_tr_b16 v[244:245], v21 offset:24576
v_mfma_f32_16x16x32_bf16 a[132:135], v[132:135], v[176:179], 0
ds_read_b64_tr_b16 v[246:247], v21 offset:25600
v_mfma_f32_16x16x32_bf16 a[136:139], v[136:139], v[176:179], 0
ds_read_b64_tr_b16 v[248:249], v22 offset:24576
v_mfma_f32_16x16x32_bf16 a[140:143], v[140:143], v[176:179], 0
ds_read_b64_tr_b16 v[250:251], v22 offset:25600
v_mfma_f32_16x16x32_bf16 a[144:147], v[144:147], v[176:179], 0
ds_read_b64_tr_b16 v[252:253], v23 offset:24576
v_mfma_f32_16x16x32_bf16 a[148:151], v[148:151], v[176:179], 0
ds_read_b64_tr_b16 v[254:255], v23 offset:25600
v_mfma_f32_16x16x32_bf16 a[152:155], v[152:155], v[176:179], 0
v_mfma_f32_16x16x32_bf16 a[156:159], v[156:159], v[176:179], 0
v_mfma_f32_16x16x32_bf16 a[188:191], v[156:159], v[180:183], 0
v_mfma_f32_16x16x32_bf16 a[184:187], v[152:155], v[180:183], 0
v_mfma_f32_16x16x32_bf16 a[180:183], v[148:151], v[180:183], 0
v_mfma_f32_16x16x32_bf16 a[176:179], v[144:147], v[180:183], 0
v_mfma_f32_16x16x32_bf16 a[172:175], v[140:143], v[180:183], 0
v_mfma_f32_16x16x32_bf16 a[168:171], v[136:139], v[180:183], 0
v_mfma_f32_16x16x32_bf16 a[164:167], v[132:135], v[180:183], 0
v_mfma_f32_16x16x32_bf16 a[160:163], v[128:131], v[180:183], 0
v_mfma_f32_16x16x32_bf16 a[192:195], v[128:131], v[184:187], 0
v_mfma_f32_16x16x32_bf16 a[196:199], v[132:135], v[184:187], 0
v_mfma_f32_16x16x32_bf16 a[200:203], v[136:139], v[184:187], 0
v_mfma_f32_16x16x32_bf16 a[204:207], v[140:143], v[184:187], 0
v_mfma_f32_16x16x32_bf16 a[208:211], v[144:147], v[184:187], 0
v_mfma_f32_16x16x32_bf16 a[212:215], v[148:151], v[184:187], 0
v_mfma_f32_16x16x32_bf16 a[216:219], v[152:155], v[184:187], 0
v_mfma_f32_16x16x32_bf16 a[220:223], v[156:159], v[184:187], 0
v_mfma_f32_16x16x32_bf16 a[252:255], v[156:159], v[188:191], 0
v_mfma_f32_16x16x32_bf16 a[248:251], v[152:155], v[188:191], 0
v_mfma_f32_16x16x32_bf16 a[244:247], v[148:151], v[188:191], 0
v_mfma_f32_16x16x32_bf16 a[240:243], v[144:147], v[188:191], 0
v_mfma_f32_16x16x32_bf16 a[236:239], v[140:143], v[188:191], 0
v_mfma_f32_16x16x32_bf16 a[232:235], v[136:139], v[188:191], 0
v_mfma_f32_16x16x32_bf16 a[228:231], v[132:135], v[188:191], 0
s_waitcnt vmcnt(2) lgkmcnt(0)
v_mfma_f32_16x16x32_bf16 a[224:227], v[128:131], v[188:191], 0
s_barrier
v_mfma_f32_16x16x32_bf16 a[0:3], v[224:227], v[192:195], a[0:3]
s_add_u32 s73, s61, 2
ds_read_b64_tr_b16 v[160:161], v20 offset:32768
v_mfma_f32_16x16x32_bf16 a[4:7], v[224:227], v[196:199], a[4:7]
s_and_b32 s73, s73, 7
ds_read_b64_tr_b16 v[162:163], v20 offset:33792
v_mfma_f32_16x16x32_bf16 a[8:11], v[224:227], v[200:203], a[8:11]
s_lshl_b32 s69, s73, 7
ds_read_b128 v[128:131], v24 offset:32768
v_mfma_f32_16x16x32_bf16 a[12:15], v[224:227], v[204:207], a[12:15]
s_add_u32 s69, s69, s67
ds_read_b128 v[132:135], v24 offset:34816
v_mfma_f32_16x16x32_bf16 a[16:19], v[224:227], v[208:211], a[16:19]
s_lshl_b32 s71, s73, 19
ds_read_b128 v[136:139], v24 offset:36864
v_mfma_f32_16x16x32_bf16 a[20:23], v[224:227], v[212:215], a[20:23]
s_add_u32 s71, s71, s66
ds_read_b128 v[140:143], v24 offset:38912
v_mfma_f32_16x16x32_bf16 a[24:27], v[224:227], v[216:219], a[24:27]
s_add_u32 m0, s63, 65536
ds_read_b128 v[144:147], v24 offset:40960
v_mfma_f32_16x16x32_bf16 a[28:31], v[224:227], v[220:223], a[28:31]
s_add_u32 s72, s69, 0
buffer_load_dwordx4 v2, s[8:11], s72 offen lds
v_mfma_f32_16x16x32_bf16 a[60:63], v[228:231], v[220:223], a[60:63]
s_add_u32 s72, s69, 7168
buffer_load_dwordx4 v3, s[8:11], s72 offen offset:1024 lds
v_mfma_f32_16x16x32_bf16 a[56:59], v[228:231], v[216:219], a[56:59]
s_add_u32 s72, s69, 14336
buffer_load_dwordx4 v2, s[8:11], s72 offen offset:2048 lds
v_mfma_f32_16x16x32_bf16 a[52:55], v[228:231], v[212:215], a[52:55]
ds_read_b128 v[148:151], v24 offset:43008
v_mfma_f32_16x16x32_bf16 a[48:51], v[228:231], v[208:211], a[48:51]
ds_read_b128 v[152:155], v24 offset:45056
v_mfma_f32_16x16x32_bf16 a[44:47], v[228:231], v[204:207], a[44:47]
s_add_u32 s72, s69, 21504
buffer_load_dwordx4 v3, s[8:11], s72 offen offset:3072 lds
v_mfma_f32_16x16x32_bf16 a[40:43], v[228:231], v[200:203], a[40:43]
ds_read_b128 v[156:159], v24 offset:47104
v_mfma_f32_16x16x32_bf16 a[36:39], v[228:231], v[196:199], a[36:39]
ds_read_b64_tr_b16 v[164:165], v21 offset:32768
v_mfma_f32_16x16x32_bf16 a[32:35], v[228:231], v[192:195], a[32:35]
ds_read_b64_tr_b16 v[166:167], v21 offset:33792
v_mfma_f32_16x16x32_bf16 a[64:67], v[232:235], v[192:195], a[64:67]
ds_read_b64_tr_b16 v[168:169], v22 offset:32768
v_mfma_f32_16x16x32_bf16 a[68:71], v[232:235], v[196:199], a[68:71]
s_add_u32 m0, s64, 0
ds_read_b64_tr_b16 v[170:171], v22 offset:33792
v_mfma_f32_16x16x32_bf16 a[72:75], v[232:235], v[200:203], a[72:75]
s_add_u32 s72, s71, 0
buffer_load_dwordx4 v6, s[16:19], s72 offen lds
v_mfma_f32_16x16x32_bf16 a[76:79], v[232:235], v[204:207], a[76:79]
ds_read_b64_tr_b16 v[172:173], v23 offset:32768
v_mfma_f32_16x16x32_bf16 a[80:83], v[232:235], v[208:211], a[80:83]
ds_read_b64_tr_b16 v[174:175], v23 offset:33792
v_mfma_f32_16x16x32_bf16 a[84:87], v[232:235], v[212:215], a[84:87]
s_add_u32 s72, s71, 31744
buffer_load_dwordx4 v6, s[16:19], s72 offen offset:1024 lds
v_mfma_f32_16x16x32_bf16 a[88:91], v[232:235], v[216:219], a[88:91]
ds_read_b64_tr_b16 v[176:177], v20 offset:49152
v_mfma_f32_16x16x32_bf16 a[92:95], v[232:235], v[220:223], a[92:95]
ds_read_b64_tr_b16 v[178:179], v20 offset:50176
v_mfma_f32_16x16x32_bf16 a[124:127], v[236:239], v[220:223], a[124:127]
ds_read_b64_tr_b16 v[180:181], v21 offset:49152
v_mfma_f32_16x16x32_bf16 a[120:123], v[236:239], v[216:219], a[120:123]
s_add_u32 s72, s71, 63488
buffer_load_dwordx4 v7, s[16:19], s72 offen offset:2048 lds
v_mfma_f32_16x16x32_bf16 a[116:119], v[236:239], v[212:215], a[116:119]
ds_read_b64_tr_b16 v[182:183], v21 offset:50176
v_mfma_f32_16x16x32_bf16 a[112:115], v[236:239], v[208:211], a[112:115]
ds_read_b64_tr_b16 v[184:185], v22 offset:49152
v_mfma_f32_16x16x32_bf16 a[108:111], v[236:239], v[204:207], a[108:111]
ds_read_b64_tr_b16 v[186:187], v22 offset:50176
v_mfma_f32_16x16x32_bf16 a[104:107], v[236:239], v[200:203], a[104:107]
ds_read_b64_tr_b16 v[188:189], v23 offset:49152
v_mfma_f32_16x16x32_bf16 a[100:103], v[236:239], v[196:199], a[100:103]
s_add_u32 s72, s71, 95232
buffer_load_dwordx4 v7, s[16:19], s72 offen offset:3072 lds
v_mfma_f32_16x16x32_bf16 a[96:99], v[236:239], v[192:195], a[96:99]
ds_read_b64_tr_b16 v[190:191], v23 offset:50176
v_mfma_f32_16x16x32_bf16 a[128:131], v[192:195], v[240:243], a[128:131]
v_mfma_f32_16x16x32_bf16 a[132:135], v[196:199], v[240:243], a[132:135]
v_mfma_f32_16x16x32_bf16 a[136:139], v[200:203], v[240:243], a[136:139]
s_add_u32 m0, s63, 69632
v_mfma_f32_16x16x32_bf16 a[140:143], v[204:207], v[240:243], a[140:143]
s_add_u32 s72, s69, 32768
buffer_load_dwordx4 v2, s[8:11], s72 offen lds
v_mfma_f32_16x16x32_bf16 a[144:147], v[208:211], v[240:243], a[144:147]
v_mfma_f32_16x16x32_bf16 a[148:151], v[212:215], v[240:243], a[148:151]
v_mfma_f32_16x16x32_bf16 a[152:155], v[216:219], v[240:243], a[152:155]
s_add_u32 s72, s69, 39936
buffer_load_dwordx4 v3, s[8:11], s72 offen offset:1024 lds
v_mfma_f32_16x16x32_bf16 a[156:159], v[220:223], v[240:243], a[156:159]
v_mfma_f32_16x16x32_bf16 a[188:191], v[220:223], v[244:247], a[188:191]
v_mfma_f32_16x16x32_bf16 a[184:187], v[216:219], v[244:247], a[184:187]
v_mfma_f32_16x16x32_bf16 a[180:183], v[212:215], v[244:247], a[180:183]
v_mfma_f32_16x16x32_bf16 a[176:179], v[208:211], v[244:247], a[176:179]
s_add_u32 s72, s69, 47104
buffer_load_dwordx4 v2, s[8:11], s72 offen offset:2048 lds
v_mfma_f32_16x16x32_bf16 a[172:175], v[204:207], v[244:247], a[172:175]
v_mfma_f32_16x16x32_bf16 a[168:171], v[200:203], v[244:247], a[168:171]
v_mfma_f32_16x16x32_bf16 a[164:167], v[196:199], v[244:247], a[164:167]
v_mfma_f32_16x16x32_bf16 a[160:163], v[192:195], v[244:247], a[160:163]
s_add_u32 s72, s69, 54272
buffer_load_dwordx4 v3, s[8:11], s72 offen offset:3072 lds
v_mfma_f32_16x16x32_bf16 a[192:195], v[192:195], v[248:251], a[192:195]
v_mfma_f32_16x16x32_bf16 a[196:199], v[196:199], v[248:251], a[196:199]
v_mfma_f32_16x16x32_bf16 a[200:203], v[200:203], v[248:251], a[200:203]
v_mfma_f32_16x16x32_bf16 a[204:207], v[204:207], v[248:251], a[204:207]
s_add_u32 m0, s64, 16384
v_mfma_f32_16x16x32_bf16 a[208:211], v[208:211], v[248:251], a[208:211]
s_add_u32 s72, s71, 0
buffer_load_dwordx4 v6, s[20:23], s72 offen lds
v_mfma_f32_16x16x32_bf16 a[212:215], v[212:215], v[248:251], a[212:215]
v_mfma_f32_16x16x32_bf16 a[216:219], v[216:219], v[248:251], a[216:219]
v_mfma_f32_16x16x32_bf16 a[220:223], v[220:223], v[248:251], a[220:223]
v_mfma_f32_16x16x32_bf16 a[252:255], v[220:223], v[252:255], a[252:255]
s_add_u32 s72, s71, 31744
buffer_load_dwordx4 v6, s[20:23], s72 offen offset:1024 lds
v_mfma_f32_16x16x32_bf16 a[248:251], v[216:219], v[252:255], a[248:251]
v_mfma_f32_16x16x32_bf16 a[244:247], v[212:215], v[252:255], a[244:247]
v_mfma_f32_16x16x32_bf16 a[240:243], v[208:211], v[252:255], a[240:243]
v_mfma_f32_16x16x32_bf16 a[236:239], v[204:207], v[252:255], a[236:239]
s_add_u32 s72, s71, 63488
buffer_load_dwordx4 v7, s[20:23], s72 offen offset:2048 lds
v_mfma_f32_16x16x32_bf16 a[232:235], v[200:203], v[252:255], a[232:235]
v_mfma_f32_16x16x32_bf16 a[228:231], v[196:199], v[252:255], a[228:231]
v_mfma_f32_16x16x32_bf16 a[224:227], v[192:195], v[252:255], a[224:227]
s_waitcnt lgkmcnt(0)
v_mfma_f32_16x16x32_bf16 a[0:3], v[160:163], v[128:131], a[0:3]
s_add_u32 s72, s71, 95232
buffer_load_dwordx4 v7, s[20:23], s72 offen offset:3072 lds
v_mfma_f32_16x16x32_bf16 a[4:7], v[160:163], v[132:135], a[4:7]
s_add_u32 s80, s65, 2
ds_read_b64_tr_b16 v[224:225], v20 offset:40960
v_mfma_f32_16x16x32_bf16 a[8:11], v[160:163], v[136:139], a[8:11]
s_and_b32 s80, s80, 3
ds_read_b64_tr_b16 v[226:227], v20 offset:41984
v_mfma_f32_16x16x32_bf16 a[12:15], v[160:163], v[140:143], a[12:15]
s_lshl_b32 s80, s80, 20
buffer_load_dword v126, v125, s[16:19], s80 offen
v_mfma_f32_16x16x32_bf16 a[16:19], v[160:163], v[144:147], a[16:19]
buffer_load_dword v126, v125, s[20:23], s80 offen
v_mfma_f32_16x16x32_bf16 a[20:23], v[160:163], v[148:151], a[20:23]
global_load_dwordx4 v[68:71], v30, s[52:53]
v_mfma_f32_16x16x32_bf16 a[24:27], v[160:163], v[152:155], a[24:27]
buffer_load_dword v32, v27, s[28:31], 0 offen nt
v_mfma_f32_16x16x32_bf16 a[28:31], v[160:163], v[156:159], a[28:31]
buffer_load_dword v33, v27, s[28:31], 0 offen offset:2048 nt
v_mfma_f32_16x16x32_bf16 a[60:63], v[164:167], v[156:159], a[60:63]
ds_read_b128 v[192:195], v25 offset:32768
v_add_u32 v27, 0x1000, v27
v_mfma_f32_16x16x32_bf16 a[56:59], v[164:167], v[152:155], a[56:59]
buffer_load_dword v34, v27, s[28:31], 0 offen nt
v_mfma_f32_16x16x32_bf16 a[52:55], v[164:167], v[148:151], a[52:55]
s_mov_b32 s80, 0
buffer_load_dword v35, v26, s[28:31], s80 offen nt
v_mfma_f32_16x16x32_bf16 a[48:51], v[164:167], v[144:147], a[48:51]
buffer_load_dword v36, v26, s[28:31], s80 offen offset:2048 nt
v_mfma_f32_16x16x32_bf16 a[44:47], v[164:167], v[140:143], a[44:47]
s_mov_b32 s80, 4096
buffer_load_dword v37, v26, s[28:31], s80 offen nt
v_mfma_f32_16x16x32_bf16 a[40:43], v[164:167], v[136:139], a[40:43]
buffer_load_dword v38, v26, s[28:31], s80 offen offset:2048 nt
v_mfma_f32_16x16x32_bf16 a[36:39], v[164:167], v[132:135], a[36:39]
s_mov_b32 s80, 8192
buffer_load_dword v39, v26, s[28:31], s80 offen nt
v_mfma_f32_16x16x32_bf16 a[32:35], v[164:167], v[128:131], a[32:35]
buffer_load_dword v40, v26, s[28:31], s80 offen offset:2048 nt
v_mfma_f32_16x16x32_bf16 a[64:67], v[168:171], v[128:131], a[64:67]
s_mov_b32 s80, 12288
buffer_load_dword v41, v26, s[28:31], s80 offen nt
v_mfma_f32_16x16x32_bf16 a[68:71], v[168:171], v[132:135], a[68:71]
buffer_load_dword v42, v26, s[28:31], s80 offen offset:2048 nt
v_mfma_f32_16x16x32_bf16 a[72:75], v[168:171], v[136:139], a[72:75]
s_mov_b32 s80, 16384
buffer_load_dword v43, v26, s[28:31], s80 offen nt
v_mfma_f32_16x16x32_bf16 a[76:79], v[168:171], v[140:143], a[76:79]
buffer_load_dword v44, v26, s[28:31], s80 offen offset:2048 nt
v_mfma_f32_16x16x32_bf16 a[80:83], v[168:171], v[144:147], a[80:83]
s_mov_b32 s80, 20480
buffer_load_dword v45, v26, s[28:31], s80 offen nt
v_mfma_f32_16x16x32_bf16 a[84:87], v[168:171], v[148:151], a[84:87]
buffer_load_dword v46, v26, s[28:31], s80 offen offset:2048 nt
v_mfma_f32_16x16x32_bf16 a[88:91], v[168:171], v[152:155], a[88:91]
s_mov_b32 s80, 24576
buffer_load_dword v47, v26, s[28:31], s80 offen nt
v_mfma_f32_16x16x32_bf16 a[92:95], v[168:171], v[156:159], a[92:95]
buffer_load_dword v48, v26, s[28:31], s80 offen offset:2048 nt
v_mfma_f32_16x16x32_bf16 a[124:127], v[172:175], v[156:159], a[124:127]
s_mov_b32 s80, 28672
buffer_load_dword v49, v26, s[28:31], s80 offen nt
v_mfma_f32_16x16x32_bf16 a[120:123], v[172:175], v[152:155], a[120:123]
buffer_load_dword v50, v26, s[28:31], s80 offen offset:2048 nt
v_mfma_f32_16x16x32_bf16 a[116:119], v[172:175], v[148:151], a[116:119]
ds_read_b128 v[196:199], v25 offset:34816
v_mfma_f32_16x16x32_bf16 a[112:115], v[172:175], v[144:147], a[112:115]
ds_read_b128 v[200:203], v25 offset:36864
v_mfma_f32_16x16x32_bf16 a[108:111], v[172:175], v[140:143], a[108:111]
ds_read_b128 v[204:207], v25 offset:38912
v_mfma_f32_16x16x32_bf16 a[104:107], v[172:175], v[136:139], a[104:107]
ds_read_b128 v[208:211], v25 offset:40960
v_mfma_f32_16x16x32_bf16 a[100:103], v[172:175], v[132:135], a[100:103]
ds_read_b128 v[212:215], v25 offset:43008
v_mfma_f32_16x16x32_bf16 a[96:99], v[172:175], v[128:131], a[96:99]
ds_read_b128 v[216:219], v25 offset:45056
v_mfma_f32_16x16x32_bf16 a[128:131], v[128:131], v[176:179], a[128:131]
ds_read_b128 v[220:223], v25 offset:47104
v_mfma_f32_16x16x32_bf16 a[132:135], v[132:135], v[176:179], a[132:135]
ds_read_b64_tr_b16 v[228:229], v21 offset:40960
v_mfma_f32_16x16x32_bf16 a[136:139], v[136:139], v[176:179], a[136:139]
ds_read_b64_tr_b16 v[230:231], v21 offset:41984
v_mfma_f32_16x16x32_bf16 a[140:143], v[140:143], v[176:179], a[140:143]
ds_read_b64_tr_b16 v[232:233], v22 offset:40960
v_mfma_f32_16x16x32_bf16 a[144:147], v[144:147], v[176:179], a[144:147]
ds_read_b64_tr_b16 v[234:235], v22 offset:41984
v_mfma_f32_16x16x32_bf16 a[148:151], v[148:151], v[176:179], a[148:151]
ds_read_b64_tr_b16 v[236:237], v23 offset:40960
v_mfma_f32_16x16x32_bf16 a[152:155], v[152:155], v[176:179], a[152:155]
ds_read_b64_tr_b16 v[238:239], v23 offset:41984
v_mfma_f32_16x16x32_bf16 a[156:159], v[156:159], v[176:179], a[156:159]
ds_read_b64_tr_b16 v[240:241], v20 offset:57344
v_mfma_f32_16x16x32_bf16 a[188:191], v[156:159], v[180:183], a[188:191]
ds_read_b64_tr_b16 v[242:243], v20 offset:58368
v_mfma_f32_16x16x32_bf16 a[184:187], v[152:155], v[180:183], a[184:187]
ds_read_b64_tr_b16 v[244:245], v21 offset:57344
v_mfma_f32_16x16x32_bf16 a[180:183], v[148:151], v[180:183], a[180:183]
ds_read_b64_tr_b16 v[246:247], v21 offset:58368
v_mfma_f32_16x16x32_bf16 a[176:179], v[144:147], v[180:183], a[176:179]
ds_read_b64_tr_b16 v[248:249], v22 offset:57344
v_mfma_f32_16x16x32_bf16 a[172:175], v[140:143], v[180:183], a[172:175]
ds_read_b64_tr_b16 v[250:251], v22 offset:58368
v_mfma_f32_16x16x32_bf16 a[168:171], v[136:139], v[180:183], a[168:171]
ds_read_b64_tr_b16 v[252:253], v23 offset:57344
v_mfma_f32_16x16x32_bf16 a[164:167], v[132:135], v[180:183], a[164:167]
ds_read_b64_tr_b16 v[254:255], v23 offset:58368
v_mfma_f32_16x16x32_bf16 a[160:163], v[128:131], v[180:183], a[160:163]
v_mfma_f32_16x16x32_bf16 a[192:195], v[128:131], v[184:187], a[192:195]
v_mfma_f32_16x16x32_bf16 a[196:199], v[132:135], v[184:187], a[196:199]
v_mfma_f32_16x16x32_bf16 a[200:203], v[136:139], v[184:187], a[200:203]
v_mfma_f32_16x16x32_bf16 a[204:207], v[140:143], v[184:187], a[204:207]
v_mfma_f32_16x16x32_bf16 a[208:211], v[144:147], v[184:187], a[208:211]
v_mfma_f32_16x16x32_bf16 a[212:215], v[148:151], v[184:187], a[212:215]
v_mfma_f32_16x16x32_bf16 a[216:219], v[152:155], v[184:187], a[216:219]
v_mfma_f32_16x16x32_bf16 a[220:223], v[156:159], v[184:187], a[220:223]
v_mfma_f32_16x16x32_bf16 a[252:255], v[156:159], v[188:191], a[252:255]
v_mfma_f32_16x16x32_bf16 a[248:251], v[152:155], v[188:191], a[248:251]
v_mfma_f32_16x16x32_bf16 a[244:247], v[148:151], v[188:191], a[244:247]
v_mfma_f32_16x16x32_bf16 a[240:243], v[144:147], v[188:191], a[240:243]
v_mfma_f32_16x16x32_bf16 a[236:239], v[140:143], v[188:191], a[236:239]
v_mfma_f32_16x16x32_bf16 a[232:235], v[136:139], v[188:191], a[232:235]
v_mfma_f32_16x16x32_bf16 a[228:231], v[132:135], v[188:191], a[228:231]
s_waitcnt vmcnt(22) lgkmcnt(0)
v_mfma_f32_16x16x32_bf16 a[224:227], v[128:131], v[188:191], a[224:227]
s_barrier
v_mfma_f32_16x16x32_bf16 a[0:3], v[224:227], v[192:195], a[0:3]
s_add_u32 s73, s61, 3
ds_read_b64_tr_b16 v[160:161], v20 offset:0
v_mfma_f32_16x16x32_bf16 a[4:7], v[224:227], v[196:199], a[4:7]
s_and_b32 s73, s73, 7
ds_read_b64_tr_b16 v[162:163], v20 offset:1024
v_mfma_f32_16x16x32_bf16 a[8:11], v[224:227], v[200:203], a[8:11]
s_lshl_b32 s69, s73, 7
ds_read_b128 v[128:131], v24 offset:0
v_mfma_f32_16x16x32_bf16 a[12:15], v[224:227], v[204:207], a[12:15]
s_add_u32 s69, s69, s67
ds_read_b128 v[132:135], v24 offset:2048
v_mfma_f32_16x16x32_bf16 a[16:19], v[224:227], v[208:211], a[16:19]
s_lshl_b32 s71, s73, 19
ds_read_b128 v[136:139], v24 offset:4096
v_mfma_f32_16x16x32_bf16 a[20:23], v[224:227], v[212:215], a[20:23]
s_add_u32 s71, s71, s66
ds_read_b128 v[140:143], v24 offset:6144
v_mfma_f32_16x16x32_bf16 a[24:27], v[224:227], v[216:219], a[24:27]
s_add_u32 m0, s63, 98304
ds_read_b128 v[144:147], v24 offset:8192
v_mfma_f32_16x16x32_bf16 a[28:31], v[224:227], v[220:223], a[28:31]
s_add_u32 s72, s69, 0
buffer_load_dwordx4 v2, s[8:11], s72 offen lds
v_mfma_f32_16x16x32_bf16 a[60:63], v[228:231], v[220:223], a[60:63]
s_add_u32 s72, s69, 7168
buffer_load_dwordx4 v3, s[8:11], s72 offen offset:1024 lds
v_mfma_f32_16x16x32_bf16 a[56:59], v[228:231], v[216:219], a[56:59]
s_add_u32 s72, s69, 14336
buffer_load_dwordx4 v2, s[8:11], s72 offen offset:2048 lds
v_mfma_f32_16x16x32_bf16 a[52:55], v[228:231], v[212:215], a[52:55]
ds_read_b128 v[148:151], v24 offset:10240
v_mfma_f32_16x16x32_bf16 a[48:51], v[228:231], v[208:211], a[48:51]
ds_read_b128 v[152:155], v24 offset:12288
v_mfma_f32_16x16x32_bf16 a[44:47], v[228:231], v[204:207], a[44:47]
s_add_u32 s72, s69, 21504
buffer_load_dwordx4 v3, s[8:11], s72 offen offset:3072 lds
v_mfma_f32_16x16x32_bf16 a[40:43], v[228:231], v[200:203], a[40:43]
ds_read_b128 v[156:159], v24 offset:14336
v_mfma_f32_16x16x32_bf16 a[36:39], v[228:231], v[196:199], a[36:39]
ds_read_b64_tr_b16 v[164:165], v21 offset:0
v_mfma_f32_16x16x32_bf16 a[32:35], v[228:231], v[192:195], a[32:35]
ds_read_b64_tr_b16 v[166:167], v21 offset:1024
v_mfma_f32_16x16x32_bf16 a[64:67], v[232:235], v[192:195], a[64:67]
ds_read_b64_tr_b16 v[168:169], v22 offset:0
v_mfma_f32_16x16x32_bf16 a[68:71], v[232:235], v[196:199], a[68:71]
s_add_u32 m0, s64, 32768
ds_read_b64_tr_b16 v[170:171], v22 offset:1024
v_mfma_f32_16x16x32_bf16 a[72:75], v[232:235], v[200:203], a[72:75]
s_add_u32 s72, s71, 0
buffer_load_dwordx4 v6, s[16:19], s72 offen lds
v_mfma_f32_16x16x32_bf16 a[76:79], v[232:235], v[204:207], a[76:79]
ds_read_b64_tr_b16 v[172:173], v23 offset:0
v_mfma_f32_16x16x32_bf16 a[80:83], v[232:235], v[208:211], a[80:83]
ds_read_b64_tr_b16 v[174:175], v23 offset:1024
v_mfma_f32_16x16x32_bf16 a[84:87], v[232:235], v[212:215], a[84:87]
s_add_u32 s72, s71, 31744
buffer_load_dwordx4 v6, s[16:19], s72 offen offset:1024 lds
v_mfma_f32_16x16x32_bf16 a[88:91], v[232:235], v[216:219], a[88:91]
ds_read_b64_tr_b16 v[176:177], v20 offset:16384
v_mfma_f32_16x16x32_bf16 a[92:95], v[232:235], v[220:223], a[92:95]
ds_read_b64_tr_b16 v[178:179], v20 offset:17408
v_mfma_f32_16x16x32_bf16 a[124:127], v[236:239], v[220:223], a[124:127]
ds_read_b64_tr_b16 v[180:181], v21 offset:16384
v_mfma_f32_16x16x32_bf16 a[120:123], v[236:239], v[216:219], a[120:123]
s_add_u32 s72, s71, 63488
buffer_load_dwordx4 v7, s[16:19], s72 offen offset:2048 lds
v_mfma_f32_16x16x32_bf16 a[116:119], v[236:239], v[212:215], a[116:119]
ds_read_b64_tr_b16 v[182:183], v21 offset:17408
v_mfma_f32_16x16x32_bf16 a[112:115], v[236:239], v[208:211], a[112:115]
ds_read_b64_tr_b16 v[184:185], v22 offset:16384
v_mfma_f32_16x16x32_bf16 a[108:111], v[236:239], v[204:207], a[108:111]
ds_read_b64_tr_b16 v[186:187], v22 offset:17408
v_mfma_f32_16x16x32_bf16 a[104:107], v[236:239], v[200:203], a[104:107]
ds_read_b64_tr_b16 v[188:189], v23 offset:16384
v_mfma_f32_16x16x32_bf16 a[100:103], v[236:239], v[196:199], a[100:103]
s_add_u32 s72, s71, 95232
buffer_load_dwordx4 v7, s[16:19], s72 offen offset:3072 lds
v_mfma_f32_16x16x32_bf16 a[96:99], v[236:239], v[192:195], a[96:99]
ds_read_b64_tr_b16 v[190:191], v23 offset:17408
v_mfma_f32_16x16x32_bf16 a[128:131], v[192:195], v[240:243], a[128:131]
v_mfma_f32_16x16x32_bf16 a[132:135], v[196:199], v[240:243], a[132:135]
v_mfma_f32_16x16x32_bf16 a[136:139], v[200:203], v[240:243], a[136:139]
s_add_u32 m0, s63, 102400
v_mfma_f32_16x16x32_bf16 a[140:143], v[204:207], v[240:243], a[140:143]
s_add_u32 s72, s69, 32768
buffer_load_dwordx4 v2, s[8:11], s72 offen lds
v_mfma_f32_16x16x32_bf16 a[144:147], v[208:211], v[240:243], a[144:147]
v_mfma_f32_16x16x32_bf16 a[148:151], v[212:215], v[240:243], a[148:151]
v_mfma_f32_16x16x32_bf16 a[152:155], v[216:219], v[240:243], a[152:155]
s_add_u32 s72, s69, 39936
buffer_load_dwordx4 v3, s[8:11], s72 offen offset:1024 lds
v_mfma_f32_16x16x32_bf16 a[156:159], v[220:223], v[240:243], a[156:159]
v_mfma_f32_16x16x32_bf16 a[188:191], v[220:223], v[244:247], a[188:191]
v_mfma_f32_16x16x32_bf16 a[184:187], v[216:219], v[244:247], a[184:187]
v_mfma_f32_16x16x32_bf16 a[180:183], v[212:215], v[244:247], a[180:183]
v_mfma_f32_16x16x32_bf16 a[176:179], v[208:211], v[244:247], a[176:179]
s_add_u32 s72, s69, 47104
buffer_load_dwordx4 v2, s[8:11], s72 offen offset:2048 lds
v_mfma_f32_16x16x32_bf16 a[172:175], v[204:207], v[244:247], a[172:175]
v_mfma_f32_16x16x32_bf16 a[168:171], v[200:203], v[244:247], a[168:171]
v_mfma_f32_16x16x32_bf16 a[164:167], v[196:199], v[244:247], a[164:167]
v_mfma_f32_16x16x32_bf16 a[160:163], v[192:195], v[244:247], a[160:163]
s_add_u32 s72, s69, 54272
buffer_load_dwordx4 v3, s[8:11], s72 offen offset:3072 lds
v_mfma_f32_16x16x32_bf16 a[192:195], v[192:195], v[248:251], a[192:195]
v_mfma_f32_16x16x32_bf16 a[196:199], v[196:199], v[248:251], a[196:199]
v_mfma_f32_16x16x32_bf16 a[200:203], v[200:203], v[248:251], a[200:203]
v_mfma_f32_16x16x32_bf16 a[204:207], v[204:207], v[248:251], a[204:207]
s_add_u32 m0, s64, 49152
v_mfma_f32_16x16x32_bf16 a[208:211], v[208:211], v[248:251], a[208:211]
s_add_u32 s72, s71, 0
buffer_load_dwordx4 v6, s[20:23], s72 offen lds
v_mfma_f32_16x16x32_bf16 a[212:215], v[212:215], v[248:251], a[212:215]
v_mfma_f32_16x16x32_bf16 a[216:219], v[216:219], v[248:251], a[216:219]
v_mfma_f32_16x16x32_bf16 a[220:223], v[220:223], v[248:251], a[220:223]
v_mfma_f32_16x16x32_bf16 a[252:255], v[220:223], v[252:255], a[252:255]
s_add_u32 s72, s71, 31744
buffer_load_dwordx4 v6, s[20:23], s72 offen offset:1024 lds
v_mfma_f32_16x16x32_bf16 a[248:251], v[216:219], v[252:255], a[248:251]
v_mfma_f32_16x16x32_bf16 a[244:247], v[212:215], v[252:255], a[244:247]
v_mfma_f32_16x16x32_bf16 a[240:243], v[208:211], v[252:255], a[240:243]
v_mfma_f32_16x16x32_bf16 a[236:239], v[204:207], v[252:255], a[236:239]
s_add_u32 s72, s71, 63488
buffer_load_dwordx4 v7, s[20:23], s72 offen offset:2048 lds
v_mfma_f32_16x16x32_bf16 a[232:235], v[200:203], v[252:255], a[232:235]
v_mfma_f32_16x16x32_bf16 a[228:231], v[196:199], v[252:255], a[228:231]
v_mfma_f32_16x16x32_bf16 a[224:227], v[192:195], v[252:255], a[224:227]
s_waitcnt lgkmcnt(0)
v_mfma_f32_16x16x32_bf16 a[0:3], v[160:163], v[128:131], a[0:3]
s_add_u32 s72, s71, 95232
buffer_load_dwordx4 v7, s[20:23], s72 offen offset:3072 lds
v_mfma_f32_16x16x32_bf16 a[4:7], v[160:163], v[132:135], a[4:7]
s_add_u32 s80, s65, 3
ds_read_b64_tr_b16 v[224:225], v20 offset:8192
v_mfma_f32_16x16x32_bf16 a[8:11], v[160:163], v[136:139], a[8:11]
s_and_b32 s80, s80, 3
ds_read_b64_tr_b16 v[226:227], v20 offset:9216
v_mfma_f32_16x16x32_bf16 a[12:15], v[160:163], v[140:143], a[12:15]
s_lshl_b32 s80, s80, 20
buffer_load_dword v126, v125, s[16:19], s80 offen
v_mfma_f32_16x16x32_bf16 a[16:19], v[160:163], v[144:147], a[16:19]
buffer_load_dword v126, v125, s[20:23], s80 offen
v_mfma_f32_16x16x32_bf16 a[20:23], v[160:163], v[148:151], a[20:23]
s_mov_b32 s80, 0
buffer_load_dword v51, v26, s[32:35], s80 offen nt
v_mfma_f32_16x16x32_bf16 a[24:27], v[160:163], v[152:155], a[24:27]
buffer_load_dword v52, v26, s[32:35], s80 offen offset:2048 nt
v_mfma_f32_16x16x32_bf16 a[28:31], v[160:163], v[156:159], a[28:31]
s_mov_b32 s80, 4096
buffer_load_dword v53, v26, s[32:35], s80 offen nt
v_mfma_f32_16x16x32_bf16 a[60:63], v[164:167], v[156:159], a[60:63]
buffer_load_dword v54, v26, s[32:35], s80 offen offset:2048 nt
v_mfma_f32_16x16x32_bf16 a[56:59], v[164:167], v[152:155], a[56:59]
s_mov_b32 s80, 8192
buffer_load_dword v55, v26, s[32:35], s80 offen nt
v_mfma_f32_16x16x32_bf16 a[52:55], v[164:167], v[148:151], a[52:55]
buffer_load_dword v56, v26, s[32:35], s80 offen offset:2048 nt
v_mfma_f32_16x16x32_bf16 a[48:51], v[164:167], v[144:147], a[48:51]
s_mov_b32 s80, 12288
buffer_load_dword v57, v26, s[32:35], s80 offen nt
v_mfma_f32_16x16x32_bf16 a[44:47], v[164:167], v[140:143], a[44:47]
buffer_load_dword v58, v26, s[32:35], s80 offen offset:2048 nt
v_mfma_f32_16x16x32_bf16 a[40:43], v[164:167], v[136:139], a[40:43]
s_mov_b32 s80, 16384
buffer_load_dword v59, v26, s[32:35], s80 offen nt
v_mfma_f32_16x16x32_bf16 a[36:39], v[164:167], v[132:135], a[36:39]
buffer_load_dword v60, v26, s[32:35], s80 offen offset:2048 nt
v_mfma_f32_16x16x32_bf16 a[32:35], v[164:167], v[128:131], a[32:35]
s_mov_b32 s80, 20480
buffer_load_dword v61, v26, s[32:35], s80 offen nt
v_mfma_f32_16x16x32_bf16 a[64:67], v[168:171], v[128:131], a[64:67]
buffer_load_dword v62, v26, s[32:35], s80 offen offset:2048 nt
v_mfma_f32_16x16x32_bf16 a[68:71], v[168:171], v[132:135], a[68:71]
s_mov_b32 s80, 24576
buffer_load_dword v63, v26, s[32:35], s80 offen nt
v_mfma_f32_16x16x32_bf16 a[72:75], v[168:171], v[136:139], a[72:75]
buffer_load_dword v64, v26, s[32:35], s80 offen offset:2048 nt
v_mfma_f32_16x16x32_bf16 a[76:79], v[168:171], v[140:143], a[76:79]
s_mov_b32 s80, 28672
buffer_load_dword v65, v26, s[32:35], s80 offen nt
v_mfma_f32_16x16x32_bf16 a[80:83], v[168:171], v[144:147], a[80:83]
buffer_load_dword v66, v26, s[32:35], s80 offen offset:2048 nt
v_mfma_f32_16x16x32_bf16 a[84:87], v[168:171], v[148:151], a[84:87]
ds_read_b128 v[192:195], v25 offset:0
v_mfma_f32_16x16x32_bf16 a[88:91], v[168:171], v[152:155], a[88:91]
ds_read_b128 v[196:199], v25 offset:2048
v_mfma_f32_16x16x32_bf16 a[92:95], v[168:171], v[156:159], a[92:95]
ds_read_b128 v[200:203], v25 offset:4096
v_mfma_f32_16x16x32_bf16 a[124:127], v[172:175], v[156:159], a[124:127]
ds_read_b128 v[204:207], v25 offset:6144
v_mfma_f32_16x16x32_bf16 a[120:123], v[172:175], v[152:155], a[120:123]
ds_read_b128 v[208:211], v25 offset:8192
v_mfma_f32_16x16x32_bf16 a[116:119], v[172:175], v[148:151], a[116:119]
ds_read_b128 v[212:215], v25 offset:10240
v_mfma_f32_16x16x32_bf16 a[112:115], v[172:175], v[144:147], a[112:115]
ds_read_b128 v[216:219], v25 offset:12288
v_mfma_f32_16x16x32_bf16 a[108:111], v[172:175], v[140:143], a[108:111]
ds_read_b128 v[220:223], v25 offset:14336
v_mfma_f32_16x16x32_bf16 a[104:107], v[172:175], v[136:139], a[104:107]
ds_read_b64_tr_b16 v[228:229], v21 offset:8192
v_mfma_f32_16x16x32_bf16 a[100:103], v[172:175], v[132:135], a[100:103]
ds_read_b64_tr_b16 v[230:231], v21 offset:9216
v_mfma_f32_16x16x32_bf16 a[96:99], v[172:175], v[128:131], a[96:99]
ds_read_b64_tr_b16 v[232:233], v22 offset:8192
v_mfma_f32_16x16x32_bf16 a[128:131], v[128:131], v[176:179], a[128:131]
ds_read_b64_tr_b16 v[234:235], v22 offset:9216
v_mfma_f32_16x16x32_bf16 a[132:135], v[132:135], v[176:179], a[132:135]
ds_read_b64_tr_b16 v[236:237], v23 offset:8192
v_mfma_f32_16x16x32_bf16 a[136:139], v[136:139], v[176:179], a[136:139]
ds_read_b64_tr_b16 v[238:239], v23 offset:9216
v_mfma_f32_16x16x32_bf16 a[140:143], v[140:143], v[176:179], a[140:143]
ds_read_b64_tr_b16 v[240:241], v20 offset:24576
v_mfma_f32_16x16x32_bf16 a[144:147], v[144:147], v[176:179], a[144:147]
ds_read_b64_tr_b16 v[242:243], v20 offset:25600
v_mfma_f32_16x16x32_bf16 a[148:151], v[148:151], v[176:179], a[148:151]
ds_read_b64_tr_b16 v[244:245], v21 offset:24576
v_mfma_f32_16x16x32_bf16 a[152:155], v[152:155], v[176:179], a[152:155]
ds_read_b64_tr_b16 v[246:247], v21 offset:25600
v_mfma_f32_16x16x32_bf16 a[156:159], v[156:159], v[176:179], a[156:159]
ds_read_b64_tr_b16 v[248:249], v22 offset:24576
v_mfma_f32_16x16x32_bf16 a[188:191], v[156:159], v[180:183], a[188:191]
ds_read_b64_tr_b16 v[250:251], v22 offset:25600
v_mfma_f32_16x16x32_bf16 a[184:187], v[152:155], v[180:183], a[184:187]
ds_read_b64_tr_b16 v[252:253], v23 offset:24576
v_mfma_f32_16x16x32_bf16 a[180:183], v[148:151], v[180:183], a[180:183]
ds_read_b64_tr_b16 v[254:255], v23 offset:25600
v_mfma_f32_16x16x32_bf16 a[176:179], v[144:147], v[180:183], a[176:179]
v_mfma_f32_16x16x32_bf16 a[172:175], v[140:143], v[180:183], a[172:175]
v_mfma_f32_16x16x32_bf16 a[168:171], v[136:139], v[180:183], a[168:171]
v_mfma_f32_16x16x32_bf16 a[164:167], v[132:135], v[180:183], a[164:167]
v_mfma_f32_16x16x32_bf16 a[160:163], v[128:131], v[180:183], a[160:163]
v_mfma_f32_16x16x32_bf16 a[192:195], v[128:131], v[184:187], a[192:195]
v_mfma_f32_16x16x32_bf16 a[196:199], v[132:135], v[184:187], a[196:199]
v_mfma_f32_16x16x32_bf16 a[200:203], v[136:139], v[184:187], a[200:203]
v_mfma_f32_16x16x32_bf16 a[204:207], v[140:143], v[184:187], a[204:207]
v_mfma_f32_16x16x32_bf16 a[208:211], v[144:147], v[184:187], a[208:211]
v_mfma_f32_16x16x32_bf16 a[212:215], v[148:151], v[184:187], a[212:215]
v_mfma_f32_16x16x32_bf16 a[216:219], v[152:155], v[184:187], a[216:219]
v_mfma_f32_16x16x32_bf16 a[220:223], v[156:159], v[184:187], a[220:223]
v_mfma_f32_16x16x32_bf16 a[252:255], v[156:159], v[188:191], a[252:255]
v_mfma_f32_16x16x32_bf16 a[248:251], v[152:155], v[188:191], a[248:251]
v_mfma_f32_16x16x32_bf16 a[244:247], v[148:151], v[188:191], a[244:247]
v_mfma_f32_16x16x32_bf16 a[240:243], v[144:147], v[188:191], a[240:243]
v_mfma_f32_16x16x32_bf16 a[236:239], v[140:143], v[188:191], a[236:239]
v_mfma_f32_16x16x32_bf16 a[232:235], v[136:139], v[188:191], a[232:235]
v_mfma_f32_16x16x32_bf16 a[228:231], v[132:135], v[188:191], a[228:231]
s_waitcnt vmcnt(18) lgkmcnt(0)
v_mfma_f32_16x16x32_bf16 a[224:227], v[128:131], v[188:191], a[224:227]
s_barrier
v_mfma_f32_16x16x32_bf16 a[0:3], v[224:227], v[192:195], a[0:3]
s_add_u32 s73, s61, 4
ds_read_b64_tr_b16 v[160:161], v20 offset:32768
v_mfma_f32_16x16x32_bf16 a[4:7], v[224:227], v[196:199], a[4:7]
s_and_b32 s73, s73, 7
ds_read_b64_tr_b16 v[162:163], v20 offset:33792
v_mfma_f32_16x16x32_bf16 a[8:11], v[224:227], v[200:203], a[8:11]
s_lshl_b32 s69, s73, 7
ds_read_b128 v[128:131], v24 offset:32768
v_mfma_f32_16x16x32_bf16 a[12:15], v[224:227], v[204:207], a[12:15]
s_add_u32 s69, s69, s67
ds_read_b128 v[132:135], v24 offset:34816
v_mfma_f32_16x16x32_bf16 a[16:19], v[224:227], v[208:211], a[16:19]
s_lshl_b32 s71, s73, 19
ds_read_b128 v[136:139], v24 offset:36864
v_mfma_f32_16x16x32_bf16 a[20:23], v[224:227], v[212:215], a[20:23]
s_add_u32 s71, s71, s66
ds_read_b128 v[140:143], v24 offset:38912
v_mfma_f32_16x16x32_bf16 a[24:27], v[224:227], v[216:219], a[24:27]
s_add_u32 m0, s63, 65536
ds_read_b128 v[144:147], v24 offset:40960
v_mfma_f32_16x16x32_bf16 a[28:31], v[224:227], v[220:223], a[28:31]
s_add_u32 s72, s69, 0
buffer_load_dwordx4 v2, s[8:11], s72 offen lds
v_mfma_f32_16x16x32_bf16 a[60:63], v[228:231], v[220:223], a[60:63]
s_add_u32 s72, s69, 7168
buffer_load_dwordx4 v3, s[8:11], s72 offen offset:1024 lds
v_mfma_f32_16x16x32_bf16 a[56:59], v[228:231], v[216:219], a[56:59]
s_add_u32 s72, s69, 14336
buffer_load_dwordx4 v2, s[8:11], s72 offen offset:2048 lds
v_mfma_f32_16x16x32_bf16 a[52:55], v[228:231], v[212:215], a[52:55]
ds_read_b128 v[148:151], v24 offset:43008
v_mfma_f32_16x16x32_bf16 a[48:51], v[228:231], v[208:211], a[48:51]
ds_read_b128 v[152:155], v24 offset:45056
v_mfma_f32_16x16x32_bf16 a[44:47], v[228:231], v[204:207], a[44:47]
s_add_u32 s72, s69, 21504
buffer_load_dwordx4 v3, s[8:11], s72 offen offset:3072 lds
v_mfma_f32_16x16x32_bf16 a[40:43], v[228:231], v[200:203], a[40:43]
ds_read_b128 v[156:159], v24 offset:47104
v_mfma_f32_16x16x32_bf16 a[36:39], v[228:231], v[196:199], a[36:39]
ds_read_b64_tr_b16 v[164:165], v21 offset:32768
v_mfma_f32_16x16x32_bf16 a[32:35], v[228:231], v[192:195], a[32:35]
ds_read_b64_tr_b16 v[166:167], v21 offset:33792
v_mfma_f32_16x16x32_bf16 a[64:67], v[232:235], v[192:195], a[64:67]
ds_read_b64_tr_b16 v[168:169], v22 offset:32768
v_mfma_f32_16x16x32_bf16 a[68:71], v[232:235], v[196:199], a[68:71]
s_add_u32 m0, s64, 0
ds_read_b64_tr_b16 v[170:171], v22 offset:33792
v_mfma_f32_16x16x32_bf16 a[72:75], v[232:235], v[200:203], a[72:75]
s_add_u32 s72, s71, 0
buffer_load_dwordx4 v6, s[16:19], s72 offen lds
v_mfma_f32_16x16x32_bf16 a[76:79], v[232:235], v[204:207], a[76:79]
ds_read_b64_tr_b16 v[172:173], v23 offset:32768
v_mfma_f32_16x16x32_bf16 a[80:83], v[232:235], v[208:211], a[80:83]
ds_read_b64_tr_b16 v[174:175], v23 offset:33792
v_mfma_f32_16x16x32_bf16 a[84:87], v[232:235], v[212:215], a[84:87]
s_add_u32 s72, s71, 31744
buffer_load_dwordx4 v6, s[16:19], s72 offen offset:1024 lds
v_mfma_f32_16x16x32_bf16 a[88:91], v[232:235], v[216:219], a[88:91]
ds_read_b64_tr_b16 v[176:177], v20 offset:49152
v_mfma_f32_16x16x32_bf16 a[92:95], v[232:235], v[220:223], a[92:95]
ds_read_b64_tr_b16 v[178:179], v20 offset:50176
v_mfma_f32_16x16x32_bf16 a[124:127], v[236:239], v[220:223], a[124:127]
ds_read_b64_tr_b16 v[180:181], v21 offset:49152
v_mfma_f32_16x16x32_bf16 a[120:123], v[236:239], v[216:219], a[120:123]
s_add_u32 s72, s71, 63488
buffer_load_dwordx4 v7, s[16:19], s72 offen offset:2048 lds
v_mfma_f32_16x16x32_bf16 a[116:119], v[236:239], v[212:215], a[116:119]
ds_read_b64_tr_b16 v[182:183], v21 offset:50176
v_mfma_f32_16x16x32_bf16 a[112:115], v[236:239], v[208:211], a[112:115]
ds_read_b64_tr_b16 v[184:185], v22 offset:49152
v_mfma_f32_16x16x32_bf16 a[108:111], v[236:239], v[204:207], a[108:111]
ds_read_b64_tr_b16 v[186:187], v22 offset:50176
v_mfma_f32_16x16x32_bf16 a[104:107], v[236:239], v[200:203], a[104:107]
ds_read_b64_tr_b16 v[188:189], v23 offset:49152
v_mfma_f32_16x16x32_bf16 a[100:103], v[236:239], v[196:199], a[100:103]
s_add_u32 s72, s71, 95232
buffer_load_dwordx4 v7, s[16:19], s72 offen offset:3072 lds
v_mfma_f32_16x16x32_bf16 a[96:99], v[236:239], v[192:195], a[96:99]
ds_read_b64_tr_b16 v[190:191], v23 offset:50176
v_mfma_f32_16x16x32_bf16 a[128:131], v[192:195], v[240:243], a[128:131]
v_mfma_f32_16x16x32_bf16 a[132:135], v[196:199], v[240:243], a[132:135]
v_mfma_f32_16x16x32_bf16 a[136:139], v[200:203], v[240:243], a[136:139]
s_add_u32 m0, s63, 69632
v_mfma_f32_16x16x32_bf16 a[140:143], v[204:207], v[240:243], a[140:143]
s_add_u32 s72, s69, 32768
buffer_load_dwordx4 v2, s[8:11], s72 offen lds
v_mfma_f32_16x16x32_bf16 a[144:147], v[208:211], v[240:243], a[144:147]
v_mfma_f32_16x16x32_bf16 a[148:151], v[212:215], v[240:243], a[148:151]
v_mfma_f32_16x16x32_bf16 a[152:155], v[216:219], v[240:243], a[152:155]
s_add_u32 s72, s69, 39936
buffer_load_dwordx4 v3, s[8:11], s72 offen offset:1024 lds
v_mfma_f32_16x16x32_bf16 a[156:159], v[220:223], v[240:243], a[156:159]
v_mfma_f32_16x16x32_bf16 a[188:191], v[220:223], v[244:247], a[188:191]
v_mfma_f32_16x16x32_bf16 a[184:187], v[216:219], v[244:247], a[184:187]
v_mfma_f32_16x16x32_bf16 a[180:183], v[212:215], v[244:247], a[180:183]
v_mfma_f32_16x16x32_bf16 a[176:179], v[208:211], v[244:247], a[176:179]
s_add_u32 s72, s69, 47104
buffer_load_dwordx4 v2, s[8:11], s72 offen offset:2048 lds
v_mfma_f32_16x16x32_bf16 a[172:175], v[204:207], v[244:247], a[172:175]
v_mfma_f32_16x16x32_bf16 a[168:171], v[200:203], v[244:247], a[168:171]
v_mfma_f32_16x16x32_bf16 a[164:167], v[196:199], v[244:247], a[164:167]
v_mfma_f32_16x16x32_bf16 a[160:163], v[192:195], v[244:247], a[160:163]
s_add_u32 s72, s69, 54272
buffer_load_dwordx4 v3, s[8:11], s72 offen offset:3072 lds
v_mfma_f32_16x16x32_bf16 a[192:195], v[192:195], v[248:251], a[192:195]
v_mfma_f32_16x16x32_bf16 a[196:199], v[196:199], v[248:251], a[196:199]
v_mfma_f32_16x16x32_bf16 a[200:203], v[200:203], v[248:251], a[200:203]
v_mfma_f32_16x16x32_bf16 a[204:207], v[204:207], v[248:251], a[204:207]
s_add_u32 m0, s64, 16384
v_mfma_f32_16x16x32_bf16 a[208:211], v[208:211], v[248:251], a[208:211]
s_add_u32 s72, s71, 0
buffer_load_dwordx4 v6, s[20:23], s72 offen lds
v_mfma_f32_16x16x32_bf16 a[212:215], v[212:215], v[248:251], a[212:215]
v_mfma_f32_16x16x32_bf16 a[216:219], v[216:219], v[248:251], a[216:219]
v_mfma_f32_16x16x32_bf16 a[220:223], v[220:223], v[248:251], a[220:223]
v_mfma_f32_16x16x32_bf16 a[252:255], v[220:223], v[252:255], a[252:255]
s_add_u32 s72, s71, 31744
buffer_load_dwordx4 v6, s[20:23], s72 offen offset:1024 lds
v_mfma_f32_16x16x32_bf16 a[248:251], v[216:219], v[252:255], a[248:251]
v_mfma_f32_16x16x32_bf16 a[244:247], v[212:215], v[252:255], a[244:247]
v_mfma_f32_16x16x32_bf16 a[240:243], v[208:211], v[252:255], a[240:243]
v_mfma_f32_16x16x32_bf16 a[236:239], v[204:207], v[252:255], a[236:239]
s_add_u32 s72, s71, 63488
buffer_load_dwordx4 v7, s[20:23], s72 offen offset:2048 lds
v_mfma_f32_16x16x32_bf16 a[232:235], v[200:203], v[252:255], a[232:235]
v_mfma_f32_16x16x32_bf16 a[228:231], v[196:199], v[252:255], a[228:231]
v_mfma_f32_16x16x32_bf16 a[224:227], v[192:195], v[252:255], a[224:227]
s_waitcnt lgkmcnt(0)
v_mfma_f32_16x16x32_bf16 a[0:3], v[160:163], v[128:131], a[0:3]
s_add_u32 s72, s71, 95232
buffer_load_dwordx4 v7, s[20:23], s72 offen offset:3072 lds
v_mfma_f32_16x16x32_bf16 a[4:7], v[160:163], v[132:135], a[4:7]
buffer_load_dwordx4 v[108:111], v1, s[4:7], s76 offen
v_mfma_f32_16x16x32_bf16 a[8:11], v[160:163], v[136:139], a[8:11]
buffer_load_dwordx4 v[112:115], v1, s[4:7], s76 offen offset:1024
v_mfma_f32_16x16x32_bf16 a[12:15], v[160:163], v[140:143], a[12:15]
buffer_load_dwordx4 v[116:119], v1, s[4:7], s76 offen offset:2048
v_mfma_f32_16x16x32_bf16 a[16:19], v[160:163], v[144:147], a[16:19]
buffer_load_dwordx4 v[120:123], v1, s[4:7], s76 offen offset:3072
v_mfma_f32_16x16x32_bf16 a[20:23], v[160:163], v[148:151], a[20:23]
ds_read_b64_tr_b16 v[224:225], v20 offset:40960
v_mfma_f32_16x16x32_bf16 a[24:27], v[160:163], v[152:155], a[24:27]
v_mfma_f32_16x16x32_bf16 a[28:31], v[160:163], v[156:159], a[28:31]
ds_read_b64_tr_b16 v[226:227], v20 offset:41984
v_mfma_f32_16x16x32_bf16 a[60:63], v[164:167], v[156:159], a[60:63]
v_mfma_f32_16x16x32_bf16 a[56:59], v[164:167], v[152:155], a[56:59]
ds_read_b128 v[192:195], v25 offset:32768
v_mfma_f32_16x16x32_bf16 a[52:55], v[164:167], v[148:151], a[52:55]
v_mfma_f32_16x16x32_bf16 a[48:51], v[164:167], v[144:147], a[48:51]
ds_read_b128 v[196:199], v25 offset:34816
v_mfma_f32_16x16x32_bf16 a[44:47], v[164:167], v[140:143], a[44:47]
v_mfma_f32_16x16x32_bf16 a[40:43], v[164:167], v[136:139], a[40:43]
ds_read_b128 v[200:203], v25 offset:36864
v_mfma_f32_16x16x32_bf16 a[36:39], v[164:167], v[132:135], a[36:39]
v_mfma_f32_16x16x32_bf16 a[32:35], v[164:167], v[128:131], a[32:35]
ds_read_b128 v[204:207], v25 offset:38912
v_mfma_f32_16x16x32_bf16 a[64:67], v[168:171], v[128:131], a[64:67]
v_mfma_f32_16x16x32_bf16 a[68:71], v[168:171], v[132:135], a[68:71]
ds_read_b128 v[208:211], v25 offset:40960
v_mfma_f32_16x16x32_bf16 a[72:75], v[168:171], v[136:139], a[72:75]
v_mfma_f32_16x16x32_bf16 a[76:79], v[168:171], v[140:143], a[76:79]
ds_read_b128 v[212:215], v25 offset:43008
v_mfma_f32_16x16x32_bf16 a[80:83], v[168:171], v[144:147], a[80:83]
v_mfma_f32_16x16x32_bf16 a[84:87], v[168:171], v[148:151], a[84:87]
ds_read_b128 v[216:219], v25 offset:45056
v_mfma_f32_16x16x32_bf16 a[88:91], v[168:171], v[152:155], a[88:91]
v_mfma_f32_16x16x32_bf16 a[92:95], v[168:171], v[156:159], a[92:95]
ds_read_b128 v[220:223], v25 offset:47104
v_mfma_f32_16x16x32_bf16 a[124:127], v[172:175], v[156:159], a[124:127]
v_mfma_f32_16x16x32_bf16 a[120:123], v[172:175], v[152:155], a[120:123]
ds_read_b64_tr_b16 v[228:229], v21 offset:40960
v_mfma_f32_16x16x32_bf16 a[116:119], v[172:175], v[148:151], a[116:119]
v_mfma_f32_16x16x32_bf16 a[112:115], v[172:175], v[144:147], a[112:115]
ds_read_b64_tr_b16 v[230:231], v21 offset:41984
v_mfma_f32_16x16x32_bf16 a[108:111], v[172:175], v[140:143], a[108:111]
v_mfma_f32_16x16x32_bf16 a[104:107], v[172:175], v[136:139], a[104:107]
ds_read_b64_tr_b16 v[232:233], v22 offset:40960
v_mfma_f32_16x16x32_bf16 a[100:103], v[172:175], v[132:135], a[100:103]
v_mfma_f32_16x16x32_bf16 a[96:99], v[172:175], v[128:131], a[96:99]
ds_read_b64_tr_b16 v[234:235], v22 offset:41984
v_mfma_f32_16x16x32_bf16 a[128:131], v[128:131], v[176:179], a[128:131]
v_mfma_f32_16x16x32_bf16 a[132:135], v[132:135], v[176:179], a[132:135]
ds_read_b64_tr_b16 v[236:237], v23 offset:40960
v_mfma_f32_16x16x32_bf16 a[136:139], v[136:139], v[176:179], a[136:139]
v_mfma_f32_16x16x32_bf16 a[140:143], v[140:143], v[176:179], a[140:143]
ds_read_b64_tr_b16 v[238:239], v23 offset:41984
v_mfma_f32_16x16x32_bf16 a[144:147], v[144:147], v[176:179], a[144:147]
v_mfma_f32_16x16x32_bf16 a[148:151], v[148:151], v[176:179], a[148:151]
ds_read_b64_tr_b16 v[240:241], v20 offset:57344
v_mfma_f32_16x16x32_bf16 a[152:155], v[152:155], v[176:179], a[152:155]
v_mfma_f32_16x16x32_bf16 a[156:159], v[156:159], v[176:179], a[156:159]
ds_read_b64_tr_b16 v[242:243], v20 offset:58368
v_mfma_f32_16x16x32_bf16 a[188:191], v[156:159], v[180:183], a[188:191]
v_mfma_f32_16x16x32_bf16 a[184:187], v[152:155], v[180:183], a[184:187]
ds_read_b64_tr_b16 v[244:245], v21 offset:57344
v_mfma_f32_16x16x32_bf16 a[180:183], v[148:151], v[180:183], a[180:183]
v_mfma_f32_16x16x32_bf16 a[176:179], v[144:147], v[180:183], a[176:179]
ds_read_b64_tr_b16 v[246:247], v21 offset:58368
v_mfma_f32_16x16x32_bf16 a[172:175], v[140:143], v[180:183], a[172:175]
v_mfma_f32_16x16x32_bf16 a[168:171], v[136:139], v[180:183], a[168:171]
ds_read_b64_tr_b16 v[248:249], v22 offset:57344
v_mfma_f32_16x16x32_bf16 a[164:167], v[132:135], v[180:183], a[164:167]
v_mfma_f32_16x16x32_bf16 a[160:163], v[128:131], v[180:183], a[160:163]
ds_read_b64_tr_b16 v[250:251], v22 offset:58368
v_mfma_f32_16x16x32_bf16 a[192:195], v[128:131], v[184:187], a[192:195]
v_mfma_f32_16x16x32_bf16 a[196:199], v[132:135], v[184:187], a[196:199]
ds_read_b64_tr_b16 v[252:253], v23 offset:57344
v_mfma_f32_16x16x32_bf16 a[200:203], v[136:139], v[184:187], a[200:203]
v_mfma_f32_16x16x32_bf16 a[204:207], v[140:143], v[184:187], a[204:207]
ds_read_b64_tr_b16 v[254:255], v23 offset:58368
v_mfma_f32_16x16x32_bf16 a[208:211], v[144:147], v[184:187], a[208:211]
v_mfma_f32_16x16x32_bf16 a[212:215], v[148:151], v[184:187], a[212:215]
v_mfma_f32_16x16x32_bf16 a[216:219], v[152:155], v[184:187], a[216:219]
v_mfma_f32_16x16x32_bf16 a[220:223], v[156:159], v[184:187], a[220:223]
v_mfma_f32_16x16x32_bf16 a[252:255], v[156:159], v[188:191], a[252:255]
v_mfma_f32_16x16x32_bf16 a[248:251], v[152:155], v[188:191], a[248:251]
v_mfma_f32_16x16x32_bf16 a[244:247], v[148:151], v[188:191], a[244:247]
v_mfma_f32_16x16x32_bf16 a[240:243], v[144:147], v[188:191], a[240:243]
v_mfma_f32_16x16x32_bf16 a[236:239], v[140:143], v[188:191], a[236:239]
v_mfma_f32_16x16x32_bf16 a[232:235], v[136:139], v[188:191], a[232:235]
v_mfma_f32_16x16x32_bf16 a[228:231], v[132:135], v[188:191], a[228:231]
s_waitcnt vmcnt(4) lgkmcnt(0)
v_mfma_f32_16x16x32_bf16 a[224:227], v[128:131], v[188:191], a[224:227]
s_barrier
v_mfma_f32_16x16x32_bf16 a[0:3], v[224:227], v[192:195], a[0:3]
s_add_u32 s73, s61, 5
ds_read_b64_tr_b16 v[160:161], v20 offset:0
v_mfma_f32_16x16x32_bf16 a[4:7], v[224:227], v[196:199], a[4:7]
s_and_b32 s73, s73, 7
ds_read_b64_tr_b16 v[162:163], v20 offset:1024
v_mfma_f32_16x16x32_bf16 a[8:11], v[224:227], v[200:203], a[8:11]
s_lshl_b32 s69, s73, 7
ds_read_b128 v[128:131], v24 offset:0
v_mfma_f32_16x16x32_bf16 a[12:15], v[224:227], v[204:207], a[12:15]
s_add_u32 s69, s69, s67
ds_read_b128 v[132:135], v24 offset:2048
v_mfma_f32_16x16x32_bf16 a[16:19], v[224:227], v[208:211], a[16:19]
s_lshl_b32 s71, s73, 19
ds_read_b128 v[136:139], v24 offset:4096
v_mfma_f32_16x16x32_bf16 a[20:23], v[224:227], v[212:215], a[20:23]
s_add_u32 s71, s71, s66
ds_read_b128 v[140:143], v24 offset:6144
v_mfma_f32_16x16x32_bf16 a[24:27], v[224:227], v[216:219], a[24:27]
s_add_u32 m0, s63, 98304
ds_read_b128 v[144:147], v24 offset:8192
v_mfma_f32_16x16x32_bf16 a[28:31], v[224:227], v[220:223], a[28:31]
s_add_u32 s72, s69, 0
buffer_load_dwordx4 v2, s[8:11], s72 offen lds
v_mfma_f32_16x16x32_bf16 a[60:63], v[228:231], v[220:223], a[60:63]
s_add_u32 s72, s69, 7168
buffer_load_dwordx4 v3, s[8:11], s72 offen offset:1024 lds
v_mfma_f32_16x16x32_bf16 a[56:59], v[228:231], v[216:219], a[56:59]
s_add_u32 s72, s69, 14336
buffer_load_dwordx4 v2, s[8:11], s72 offen offset:2048 lds
v_mfma_f32_16x16x32_bf16 a[52:55], v[228:231], v[212:215], a[52:55]
s_waitcnt vmcnt(23)
ds_read_b128 v[148:151], v24 offset:10240
v_lshlrev_b32 v72, 16, v68
v_mfma_f32_16x16x32_bf16 a[48:51], v[228:231], v[208:211], a[48:51]
ds_read_b128 v[152:155], v24 offset:12288
v_and_b32 v73, 0xffff0000, v68
v_mfma_f32_16x16x32_bf16 a[44:47], v[228:231], v[204:207], a[44:47]
s_add_u32 s72, s69, 21504
buffer_load_dwordx4 v3, s[8:11], s72 offen offset:3072 lds
v_mfma_f32_16x16x32_bf16 a[40:43], v[228:231], v[200:203], a[40:43]
ds_read_b128 v[156:159], v24 offset:14336
v_lshlrev_b32 v74, 16, v69
v_mfma_f32_16x16x32_bf16 a[36:39], v[228:231], v[196:199], a[36:39]
ds_read_b64_tr_b16 v[164:165], v21 offset:0
v_and_b32 v75, 0xffff0000, v69
v_mfma_f32_16x16x32_bf16 a[32:35], v[228:231], v[192:195], a[32:35]
ds_read_b64_tr_b16 v[166:167], v21 offset:1024
v_lshlrev_b32 v76, 16, v32
v_mfma_f32_16x16x32_bf16 a[64:67], v[232:235], v[192:195], a[64:67]
ds_read_b64_tr_b16 v[168:169], v22 offset:0
v_lshlrev_b32 v77, 16, v33
v_mfma_f32_16x16x32_bf16 a[68:71], v[232:235], v[196:199], a[68:71]
s_add_u32 m0, s64, 32768
ds_read_b64_tr_b16 v[170:171], v22 offset:1024
v_lshlrev_b32 v78, 16, v34
v_mfma_f32_16x16x32_bf16 a[72:75], v[232:235], v[200:203], a[72:75]
s_add_u32 s72, s71, 0
buffer_load_dwordx4 v6, s[16:19], s72 offen lds
v_mfma_f32_16x16x32_bf16 a[76:79], v[232:235], v[204:207], a[76:79]
ds_read_b64_tr_b16 v[172:173], v23 offset:0
v_lshlrev_b32 v79, 16, v35
v_mfma_f32_16x16x32_bf16 a[80:83], v[232:235], v[208:211], a[80:83]
ds_read_b64_tr_b16 v[174:175], v23 offset:1024
v_lshlrev_b32 v80, 16, v36
v_mfma_f32_16x16x32_bf16 a[84:87], v[232:235], v[212:215], a[84:87]
s_add_u32 s72, s71, 31744
buffer_load_dwordx4 v6, s[16:19], s72 offen offset:1024 lds
v_mfma_f32_16x16x32_bf16 a[88:91], v[232:235], v[216:219], a[88:91]
ds_read_b64_tr_b16 v[176:177], v20 offset:16384
v_lshlrev_b32 v81, 16, v37
v_mfma_f32_16x16x32_bf16 a[92:95], v[232:235], v[220:223], a[92:95]
ds_read_b64_tr_b16 v[178:179], v20 offset:17408
v_lshlrev_b32 v82, 16, v38
v_mfma_f32_16x16x32_bf16 a[124:127], v[236:239], v[220:223], a[124:127]
ds_read_b64_tr_b16 v[180:181], v21 offset:16384
v_lshlrev_b32 v83, 16, v39
v_mfma_f32_16x16x32_bf16 a[120:123], v[236:239], v[216:219], a[120:123]
s_add_u32 s72, s71, 63488
buffer_load_dwordx4 v7, s[16:19], s72 offen offset:2048 lds
v_mfma_f32_16x16x32_bf16 a[116:119], v[236:239], v[212:215], a[116:119]
ds_read_b64_tr_b16 v[182:183], v21 offset:17408
v_lshlrev_b32 v84, 16, v40
v_mfma_f32_16x16x32_bf16 a[112:115], v[236:239], v[208:211], a[112:115]
ds_read_b64_tr_b16 v[184:185], v22 offset:16384
v_lshlrev_b32 v85, 16, v41
v_mfma_f32_16x16x32_bf16 a[108:111], v[236:239], v[204:207], a[108:111]
ds_read_b64_tr_b16 v[186:187], v22 offset:17408
v_lshlrev_b32 v86, 16, v42
v_mfma_f32_16x16x32_bf16 a[104:107], v[236:239], v[200:203], a[104:107]
ds_read_b64_tr_b16 v[188:189], v23 offset:16384
v_lshlrev_b32 v87, 16, v43
v_mfma_f32_16x16x32_bf16 a[100:103], v[236:239], v[196:199], a[100:103]
s_add_u32 s72, s71, 95232
buffer_load_dwordx4 v7, s[16:19], s72 offen offset:3072 lds
v_mfma_f32_16x16x32_bf16 a[96:99], v[236:239], v[192:195], a[96:99]
ds_read_b64_tr_b16 v[190:191], v23 offset:17408
v_lshlrev_b32 v88, 16, v44
v_mfma_f32_16x16x32_bf16 a[128:131], v[192:195], v[240:243], a[128:131]
v_lshlrev_b32 v89, 16, v45
v_lshlrev_b32 v90, 16, v46
v_mfma_f32_16x16x32_bf16 a[132:135], v[196:199], v[240:243], a[132:135]
v_lshlrev_b32 v91, 16, v47
v_lshlrev_b32 v92, 16, v48
v_mfma_f32_16x16x32_bf16 a[136:139], v[200:203], v[240:243], a[136:139]
s_add_u32 m0, s63, 102400
v_lshlrev_b32 v93, 16, v49
v_lshlrev_b32 v94, 16, v50
v_mfma_f32_16x16x32_bf16 a[140:143], v[204:207], v[240:243], a[140:143]
s_add_u32 s72, s69, 32768
buffer_load_dwordx4 v2, s[8:11], s72 offen lds
v_mfma_f32_16x16x32_bf16 a[144:147], v[208:211], v[240:243], a[144:147]
v_mul_f32 v95, v75, v91
v_lshlrev_b32 v97, 16, v66
v_mfma_f32_16x16x32_bf16 a[148:151], v[212:215], v[240:243], a[148:151]
v_fmac_f32 v95, v74, v92
v_fmac_f32 v95, v73, v93
v_mfma_f32_16x16x32_bf16 a[152:155], v[216:219], v[240:243], a[152:155]
s_add_u32 s72, s69, 39936
buffer_load_dwordx4 v3, s[8:11], s72 offen offset:1024 lds
v_mfma_f32_16x16x32_bf16 a[156:159], v[220:223], v[240:243], a[156:159]
v_fmac_f32 v95, v72, v94
v_mul_f32 v95, v95, v97
v_mfma_f32_16x16x32_bf16 a[188:191], v[220:223], v[244:247], a[188:191]
v_mul_f32 v96, v75, v90
v_lshlrev_b32 v97, 16, v65
v_mfma_f32_16x16x32_bf16 a[184:187], v[216:219], v[244:247], a[184:187]
v_fmac_f32 v96, v74, v91
v_fmac_f32 v96, v73, v92
v_mfma_f32_16x16x32_bf16 a[180:183], v[212:215], v[244:247], a[180:183]
v_fmac_f32 v96, v72, v93
v_mul_f32 v96, v96, v97
v_mfma_f32_16x16x32_bf16 a[176:179], v[208:211], v[244:247], a[176:179]
s_add_u32 s72, s69, 47104
buffer_load_dwordx4 v2, s[8:11], s72 offen offset:2048 lds
v_mfma_f32_16x16x32_bf16 a[172:175], v[204:207], v[244:247], a[172:175]
v_cvt_pk_bf16_f32 v100, v95, v96
v_mul_f32 v95, v75, v89
v_mfma_f32_16x16x32_bf16 a[168:171], v[200:203], v[244:247], a[168:171]
v_lshlrev_b32 v97, 16, v64
v_fmac_f32 v95, v74, v90
v_mfma_f32_16x16x32_bf16 a[164:167], v[196:199], v[244:247], a[164:167]
v_fmac_f32 v95, v73, v91
v_fmac_f32 v95, v72, v92
v_mfma_f32_16x16x32_bf16 a[160:163], v[192:195], v[244:247], a[160:163]
s_add_u32 s72, s69, 54272
buffer_load_dwordx4 v3, s[8:11], s72 offen offset:3072 lds
v_mfma_f32_16x16x32_bf16 a[192:195], v[192:195], v[248:251], a[192:195]
v_mul_f32 v95, v95, v97
v_mul_f32 v96, v75, v88
v_mfma_f32_16x16x32_bf16 a[196:199], v[196:199], v[248:251], a[196:199]
v_lshlrev_b32 v97, 16, v63
v_fmac_f32 v96, v74, v89
v_mfma_f32_16x16x32_bf16 a[200:203], v[200:203], v[248:251], a[200:203]
v_fmac_f32 v96, v73, v90
v_fmac_f32 v96, v72, v91
v_mfma_f32_16x16x32_bf16 a[204:207], v[204:207], v[248:251], a[204:207]
s_add_u32 m0, s64, 49152
v_mul_f32 v96, v96, v97
v_cvt_pk_bf16_f32 v101, v95, v96
v_mfma_f32_16x16x32_bf16 a[208:211], v[208:211], v[248:251], a[208:211]
s_add_u32 s72, s71, 0
buffer_load_dwordx4 v6, s[20:23], s72 offen lds
v_mfma_f32_16x16x32_bf16 a[212:215], v[212:215], v[248:251], a[212:215]
v_mul_f32 v95, v75, v87
v_lshlrev_b32 v97, 16, v62
v_mfma_f32_16x16x32_bf16 a[216:219], v[216:219], v[248:251], a[216:219]
v_fmac_f32 v95, v74, v88
v_fmac_f32 v95, v73, v89
v_mfma_f32_16x16x32_bf16 a[220:223], v[220:223], v[248:251], a[220:223]
v_fmac_f32 v95, v72, v90
v_mul_f32 v95, v95, v97
v_mfma_f32_16x16x32_bf16 a[252:255], v[220:223], v[252:255], a[252:255]
s_add_u32 s72, s71, 31744
buffer_load_dwordx4 v6, s[20:23], s72 offen offset:1024 lds
v_mfma_f32_16x16x32_bf16 a[248:251], v[216:219], v[252:255], a[248:251]
v_mul_f32 v96, v75, v86
v_lshlrev_b32 v97, 16, v61
v_mfma_f32_16x16x32_bf16 a[244:247], v[212:215], v[252:255], a[244:247]
v_fmac_f32 v96, v74, v87
v_fmac_f32 v96, v73, v88
v_mfma_f32_16x16x32_bf16 a[240:243], v[208:211], v[252:255], a[240:243]
v_fmac_f32 v96, v72, v89
v_mul_f32 v96, v96, v97
v_mfma_f32_16x16x32_bf16 a[236:239], v[204:207], v[252:255], a[236:239]
s_add_u32 s72, s71, 63488
buffer_load_dwordx4 v7, s[20:23], s72 offen offset:2048 lds
v_mfma_f32_16x16x32_bf16 a[232:235], v[200:203], v[252:255], a[232:235]
v_cvt_pk_bf16_f32 v102, v95, v96
v_mul_f32 v95, v75, v85
v_mfma_f32_16x16x32_bf16 a[228:231], v[196:199], v[252:255], a[228:231]
v_lshlrev_b32 v97, 16, v60
v_fmac_f32 v95, v74, v86
v_mfma_f32_16x16x32_bf16 a[224:227], v[192:195], v[252:255], a[224:227]
s_waitcnt lgkmcnt(0)
v_fmac_f32 v95, v73, v87
v_fmac_f32 v95, v72, v88
v_mfma_f32_16x16x32_bf16 a[0:3], v[160:163], v[128:131], a[0:3]
s_add_u32 s72, s71, 95232
buffer_load_dwordx4 v7, s[20:23], s72 offen offset:3072 lds
v_mfma_f32_16x16x32_bf16 a[4:7], v[160:163], v[132:135], a[4:7]
s_mov_b32 s80, 0x0
buffer_load_dword v126, v125, s[12:15], s80 offen
v_mfma_f32_16x16x32_bf16 a[8:11], v[160:163], v[136:139], a[8:11]
s_mov_b32 s80, 0x100000
buffer_load_dword v126, v125, s[12:15], s80 offen
v_mfma_f32_16x16x32_bf16 a[12:15], v[160:163], v[140:143], a[12:15]
s_mov_b32 s80, 0x200000
buffer_load_dword v126, v125, s[12:15], s80 offen
v_mfma_f32_16x16x32_bf16 a[16:19], v[160:163], v[144:147], a[16:19]
s_mov_b32 s80, 0x300000
buffer_load_dword v126, v125, s[12:15], s80 offen
v_mfma_f32_16x16x32_bf16 a[20:23], v[160:163], v[148:151], a[20:23]
ds_read_b64_tr_b16 v[224:225], v20 offset:8192
v_mul_f32 v95, v95, v97
v_mfma_f32_16x16x32_bf16 a[24:27], v[160:163], v[152:155], a[24:27]
v_mul_f32 v96, v75, v84
v_lshlrev_b32 v97, 16, v59
v_mfma_f32_16x16x32_bf16 a[28:31], v[160:163], v[156:159], a[28:31]
ds_read_b64_tr_b16 v[226:227], v20 offset:9216
v_fmac_f32 v96, v74, v85
v_mfma_f32_16x16x32_bf16 a[60:63], v[164:167], v[156:159], a[60:63]
v_fmac_f32 v96, v73, v86
v_fmac_f32 v96, v72, v87
v_mfma_f32_16x16x32_bf16 a[56:59], v[164:167], v[152:155], a[56:59]
ds_read_b128 v[192:195], v25 offset:0
v_mul_f32 v96, v96, v97
v_mfma_f32_16x16x32_bf16 a[52:55], v[164:167], v[148:151], a[52:55]
v_cvt_pk_bf16_f32 v103, v95, v96
v_mfma_f32_16x16x32_bf16 a[48:51], v[164:167], v[144:147], a[48:51]
ds_read_b128 v[196:199], v25 offset:2048
ds_write_b128 v28, v[100:103] offset:0
v_mfma_f32_16x16x32_bf16 a[44:47], v[164:167], v[140:143], a[44:47]
v_mul_f32 v95, v75, v83
v_lshlrev_b32 v97, 16, v58
v_mfma_f32_16x16x32_bf16 a[40:43], v[164:167], v[136:139], a[40:43]
ds_read_b128 v[200:203], v25 offset:4096
v_fmac_f32 v95, v74, v84
v_mfma_f32_16x16x32_bf16 a[36:39], v[164:167], v[132:135], a[36:39]
v_fmac_f32 v95, v73, v85
v_fmac_f32 v95, v72, v86
v_mfma_f32_16x16x32_bf16 a[32:35], v[164:167], v[128:131], a[32:35]
ds_read_b128 v[204:207], v25 offset:6144
v_mul_f32 v95, v95, v97
v_mfma_f32_16x16x32_bf16 a[64:67], v[168:171], v[128:131], a[64:67]
v_mul_f32 v96, v75, v82
v_lshlrev_b32 v97, 16, v57
v_mfma_f32_16x16x32_bf16 a[68:71], v[168:171], v[132:135], a[68:71]
ds_read_b128 v[208:211], v25 offset:8192
v_fmac_f32 v96, v74, v83
v_mfma_f32_16x16x32_bf16 a[72:75], v[168:171], v[136:139], a[72:75]
v_fmac_f32 v96, v73, v84
v_fmac_f32 v96, v72, v85
v_mfma_f32_16x16x32_bf16 a[76:79], v[168:171], v[140:143], a[76:79]
ds_read_b128 v[212:215], v25 offset:10240
v_mul_f32 v96, v96, v97
v_mfma_f32_16x16x32_bf16 a[80:83], v[168:171], v[144:147], a[80:83]
v_cvt_pk_bf16_f32 v104, v95, v96
v_mul_f32 v95, v75, v81
v_mfma_f32_16x16x32_bf16 a[84:87], v[168:171], v[148:151], a[84:87]
ds_read_b128 v[216:219], v25 offset:12288
v_lshlrev_b32 v97, 16, v56
v_mfma_f32_16x16x32_bf16 a[88:91], v[168:171], v[152:155], a[88:91]
v_fmac_f32 v95, v74, v82
v_fmac_f32 v95, v73, v83
v_mfma_f32_16x16x32_bf16 a[92:95], v[168:171], v[156:159], a[92:95]
ds_read_b128 v[220:223], v25 offset:14336
v_fmac_f32 v95, v72, v84
v_mfma_f32_16x16x32_bf16 a[124:127], v[172:175], v[156:159], a[124:127]
v_mul_f32 v95, v95, v97
v_mul_f32 v96, v75, v80
v_mfma_f32_16x16x32_bf16 a[120:123], v[172:175], v[152:155], a[120:123]
ds_read_b64_tr_b16 v[228:229], v21 offset:8192
v_lshlrev_b32 v97, 16, v55
v_mfma_f32_16x16x32_bf16 a[116:119], v[172:175], v[148:151], a[116:119]
v_fmac_f32 v96, v74, v81
v_fmac_f32 v96, v73, v82
v_mfma_f32_16x16x32_bf16 a[112:115], v[172:175], v[144:147], a[112:115]
ds_read_b64_tr_b16 v[230:231], v21 offset:9216
v_fmac_f32 v96, v72, v83
v_mfma_f32_16x16x32_bf16 a[108:111], v[172:175], v[140:143], a[108:111]
v_mul_f32 v96, v96, v97
v_cvt_pk_bf16_f32 v105, v95, v96
v_mfma_f32_16x16x32_bf16 a[104:107], v[172:175], v[136:139], a[104:107]
ds_read_b64_tr_b16 v[232:233], v22 offset:8192
v_mul_f32 v95, v75, v79
v_mfma_f32_16x16x32_bf16 a[100:103], v[172:175], v[132:135], a[100:103]
v_lshlrev_b32 v97, 16, v54
v_fmac_f32 v95, v74, v80
v_mfma_f32_16x16x32_bf16 a[96:99], v[172:175], v[128:131], a[96:99]
ds_read_b64_tr_b16 v[234:235], v22 offset:9216
v_fmac_f32 v95, v73, v81
v_mfma_f32_16x16x32_bf16 a[128:131], v[128:131], v[176:179], a[128:131]
v_fmac_f32 v95, v72, v82
v_mul_f32 v95, v95, v97
v_mfma_f32_16x16x32_bf16 a[132:135], v[132:135], v[176:179], a[132:135]
ds_read_b64_tr_b16 v[236:237], v23 offset:8192
v_mul_f32 v96, v75, v78
v_mfma_f32_16x16x32_bf16 a[136:139], v[136:139], v[176:179], a[136:139]
v_lshlrev_b32 v97, 16, v53
v_fmac_f32 v96, v74, v79
v_mfma_f32_16x16x32_bf16 a[140:143], v[140:143], v[176:179], a[140:143]
ds_read_b64_tr_b16 v[238:239], v23 offset:9216
v_fmac_f32 v96, v73, v80
v_mfma_f32_16x16x32_bf16 a[144:147], v[144:147], v[176:179], a[144:147]
v_fmac_f32 v96, v72, v81
v_mul_f32 v96, v96, v97
v_mfma_f32_16x16x32_bf16 a[148:151], v[148:151], v[176:179], a[148:151]
ds_read_b64_tr_b16 v[240:241], v20 offset:24576
v_cvt_pk_bf16_f32 v106, v95, v96
v_mfma_f32_16x16x32_bf16 a[152:155], v[152:155], v[176:179], a[152:155]
v_mul_f32 v95, v75, v77
v_lshlrev_b32 v97, 16, v52
v_mfma_f32_16x16x32_bf16 a[156:159], v[156:159], v[176:179], a[156:159]
ds_read_b64_tr_b16 v[242:243], v20 offset:25600
v_fmac_f32 v95, v74, v78
v_mfma_f32_16x16x32_bf16 a[188:191], v[156:159], v[180:183], a[188:191]
v_fmac_f32 v95, v73, v79
v_fmac_f32 v95, v72, v80
v_mfma_f32_16x16x32_bf16 a[184:187], v[152:155], v[180:183], a[184:187]
ds_read_b64_tr_b16 v[244:245], v21 offset:24576
v_mul_f32 v95, v95, v97
v_mfma_f32_16x16x32_bf16 a[180:183], v[148:151], v[180:183], a[180:183]
v_mul_f32 v96, v75, v76
v_lshlrev_b32 v97, 16, v51
v_mfma_f32_16x16x32_bf16 a[176:179], v[144:147], v[180:183], a[176:179]
ds_read_b64_tr_b16 v[246:247], v21 offset:25600
v_fmac_f32 v96, v74, v77
v_mfma_f32_16x16x32_bf16 a[172:175], v[140:143], v[180:183], a[172:175]
v_fmac_f32 v96, v73, v78
v_fmac_f32 v96, v72, v79
v_mfma_f32_16x16x32_bf16 a[168:171], v[136:139], v[180:183], a[168:171]
ds_read_b64_tr_b16 v[248:249], v22 offset:24576
v_mul_f32 v96, v96, v97
v_mfma_f32_16x16x32_bf16 a[164:167], v[132:135], v[180:183], a[164:167]
v_cvt_pk_bf16_f32 v107, v95, v96
v_mfma_f32_16x16x32_bf16 a[160:163], v[128:131], v[180:183], a[160:163]
ds_read_b64_tr_b16 v[250:251], v22 offset:25600
ds_write_b128 v28, v[104:107] offset:16
v_mfma_f32_16x16x32_bf16 a[192:195], v[128:131], v[184:187], a[192:195]
global_load_dwordx4 v[84:87], v1, s[56:57]
v_mfma_f32_16x16x32_bf16 a[196:199], v[132:135], v[184:187], a[196:199]
ds_read_b64_tr_b16 v[252:253], v23 offset:24576
v_mfma_f32_16x16x32_bf16 a[200:203], v[136:139], v[184:187], a[200:203]
global_load_dwordx4 v[88:91], v1, s[56:57] offset:1024
v_mfma_f32_16x16x32_bf16 a[204:207], v[140:143], v[184:187], a[204:207]
ds_read_b64_tr_b16 v[254:255], v23 offset:25600
v_lshlrev_b32 v72, 16, v70
v_mfma_f32_16x16x32_bf16 a[208:211], v[144:147], v[184:187], a[208:211]
v_and_b32 v73, 0xffff0000, v70
v_lshlrev_b32 v74, 16, v71
v_mfma_f32_16x16x32_bf16 a[212:215], v[148:151], v[184:187], a[212:215]
v_and_b32 v75, 0xffff0000, v71
v_and_b32 v32, 0xffff0000, v32
v_mfma_f32_16x16x32_bf16 a[216:219], v[152:155], v[184:187], a[216:219]
v_and_b32 v33, 0xffff0000, v33
v_and_b32 v34, 0xffff0000, v34
v_mfma_f32_16x16x32_bf16 a[220:223], v[156:159], v[184:187], a[220:223]
v_and_b32 v35, 0xffff0000, v35
v_and_b32 v36, 0xffff0000, v36
v_mfma_f32_16x16x32_bf16 a[252:255], v[156:159], v[188:191], a[252:255]
v_and_b32 v37, 0xffff0000, v37
v_and_b32 v38, 0xffff0000, v38
v_mfma_f32_16x16x32_bf16 a[248:251], v[152:155], v[188:191], a[248:251]
v_and_b32 v39, 0xffff0000, v39
v_and_b32 v40, 0xffff0000, v40
v_mfma_f32_16x16x32_bf16 a[244:247], v[148:151], v[188:191], a[244:247]
v_and_b32 v41, 0xffff0000, v41
v_and_b32 v42, 0xffff0000, v42
v_mfma_f32_16x16x32_bf16 a[240:243], v[144:147], v[188:191], a[240:243]
v_and_b32 v43, 0xffff0000, v43
v_and_b32 v44, 0xffff0000, v44
v_mfma_f32_16x16x32_bf16 a[236:239], v[140:143], v[188:191], a[236:239]
v_and_b32 v45, 0xffff0000, v45
v_and_b32 v46, 0xffff0000, v46
v_mfma_f32_16x16x32_bf16 a[232:235], v[136:139], v[188:191], a[232:235]
v_and_b32 v47, 0xffff0000, v47
v_and_b32 v48, 0xffff0000, v48
v_mfma_f32_16x16x32_bf16 a[228:231], v[132:135], v[188:191], a[228:231]
s_waitcnt vmcnt(6) lgkmcnt(0)
v_and_b32 v49, 0xffff0000, v49
v_and_b32 v50, 0xffff0000, v50
v_mfma_f32_16x16x32_bf16 a[224:227], v[128:131], v[188:191], a[224:227]
s_barrier
v_mul_f32 v95, v75, v47
v_and_b32 v97, 0xffff0000, v66
v_mfma_f32_16x16x32_bf16 a[0:3], v[224:227], v[192:195], a[0:3]
s_add_u32 s73, s61, 6
ds_read_b64_tr_b16 v[160:161], v20 offset:32768
v_fmac_f32 v95, v74, v48
v_mfma_f32_16x16x32_bf16 a[4:7], v[224:227], v[196:199], a[4:7]
s_and_b32 s73, s73, 7
ds_read_b64_tr_b16 v[162:163], v20 offset:33792
v_fmac_f32 v95, v73, v49
v_mfma_f32_16x16x32_bf16 a[8:11], v[224:227], v[200:203], a[8:11]
s_lshl_b32 s69, s73, 7
ds_read_b128 v[128:131], v24 offset:32768
v_fmac_f32 v95, v72, v50
v_mfma_f32_16x16x32_bf16 a[12:15], v[224:227], v[204:207], a[12:15]
s_add_u32 s69, s69, s67
ds_read_b128 v[132:135], v24 offset:34816
v_mul_f32 v95, v95, v97
v_mfma_f32_16x16x32_bf16 a[16:19], v[224:227], v[208:211], a[16:19]
s_lshl_b32 s71, s73, 19
ds_read_b128 v[136:139], v24 offset:36864
v_mul_f32 v96, v75, v46
v_mfma_f32_16x16x32_bf16 a[20:23], v[224:227], v[212:215], a[20:23]
s_add_u32 s71, s71, s66
ds_read_b128 v[140:143], v24 offset:38912
v_and_b32 v97, 0xffff0000, v65
v_mfma_f32_16x16x32_bf16 a[24:27], v[224:227], v[216:219], a[24:27]
s_add_u32 m0, s63, 65536
ds_read_b128 v[144:147], v24 offset:40960
v_fmac_f32 v96, v74, v47
v_mfma_f32_16x16x32_bf16 a[28:31], v[224:227], v[220:223], a[28:31]
s_add_u32 s72, s69, 0
buffer_load_dwordx4 v2, s[8:11], s72 offen lds
v_mfma_f32_16x16x32_bf16 a[60:63], v[228:231], v[220:223], a[60:63]
s_add_u32 s72, s69, 7168
buffer_load_dwordx4 v3, s[8:11], s72 offen offset:1024 lds
v_mfma_f32_16x16x32_bf16 a[56:59], v[228:231], v[216:219], a[56:59]
s_add_u32 s72, s69, 14336
buffer_load_dwordx4 v2, s[8:11], s72 offen offset:2048 lds
v_mfma_f32_16x16x32_bf16 a[52:55], v[228:231], v[212:215], a[52:55]
ds_read_b128 v[148:151], v24 offset:43008
v_fmac_f32 v96, v73, v48
v_mfma_f32_16x16x32_bf16 a[48:51], v[228:231], v[208:211], a[48:51]
ds_read_b128 v[152:155], v24 offset:45056
v_fmac_f32 v96, v72, v49
v_mfma_f32_16x16x32_bf16 a[44:47], v[228:231], v[204:207], a[44:47]
s_add_u32 s72, s69, 21504
buffer_load_dwordx4 v3, s[8:11], s72 offen offset:3072 lds
v_mfma_f32_16x16x32_bf16 a[40:43], v[228:231], v[200:203], a[40:43]
ds_read_b128 v[156:159], v24 offset:47104
v_mul_f32 v96, v96, v97
v_mfma_f32_16x16x32_bf16 a[36:39], v[228:231], v[196:199], a[36:39]
ds_read_b64_tr_b16 v[164:165], v21 offset:32768
v_cvt_pk_bf16_f32 v100, v95, v96
v_mfma_f32_16x16x32_bf16 a[32:35], v[228:231], v[192:195], a[32:35]
ds_read_b64_tr_b16 v[166:167], v21 offset:33792
v_mul_f32 v95, v75, v45
v_mfma_f32_16x16x32_bf16 a[64:67], v[232:235], v[192:195], a[64:67]
ds_read_b64_tr_b16 v[168:169], v22 offset:32768
v_and_b32 v97, 0xffff0000, v64
v_mfma_f32_16x16x32_bf16 a[68:71], v[232:235], v[196:199], a[68:71]
s_add_u32 m0, s64, 0
ds_read_b64_tr_b16 v[170:171], v22 offset:33792
v_fmac_f32 v95, v74, v46
v_mfma_f32_16x16x32_bf16 a[72:75], v[232:235], v[200:203], a[72:75]
s_add_u32 s72, s71, 0
buffer_load_dwordx4 v6, s[16:19], s72 offen lds
v_mfma_f32_16x16x32_bf16 a[76:79], v[232:235], v[204:207], a[76:79]
ds_read_b64_tr_b16 v[172:173], v23 offset:32768
v_fmac_f32 v95, v73, v47
v_mfma_f32_16x16x32_bf16 a[80:83], v[232:235], v[208:211], a[80:83]
ds_read_b64_tr_b16 v[174:175], v23 offset:33792
v_fmac_f32 v95, v72, v48
v_mfma_f32_16x16x32_bf16 a[84:87], v[232:235], v[212:215], a[84:87]
s_add_u32 s72, s71, 31744
buffer_load_dwordx4 v6, s[16:19], s72 offen offset:1024 lds
v_mfma_f32_16x16x32_bf16 a[88:91], v[232:235], v[216:219], a[88:91]
ds_read_b64_tr_b16 v[176:177], v20 offset:49152
v_mul_f32 v95, v95, v97
v_mfma_f32_16x16x32_bf16 a[92:95], v[232:235], v[220:223], a[92:95]
ds_read_b64_tr_b16 v[178:179], v20 offset:50176
v_mul_f32 v96, v75, v44
v_mfma_f32_16x16x32_bf16 a[124:127], v[236:239], v[220:223], a[124:127]
ds_read_b64_tr_b16 v[180:181], v21 offset:49152
v_and_b32 v97, 0xffff0000, v63
v_mfma_f32_16x16x32_bf16 a[120:123], v[236:239], v[216:219], a[120:123]
s_add_u32 s72, s71, 63488
buffer_load_dwordx4 v7, s[16:19], s72 offen offset:2048 lds
v_mfma_f32_16x16x32_bf16 a[116:119], v[236:239], v[212:215], a[116:119]
ds_read_b64_tr_b16 v[182:183], v21 offset:50176
v_fmac_f32 v96, v74, v45
v_mfma_f32_16x16x32_bf16 a[112:115], v[236:239], v[208:211], a[112:115]
ds_read_b64_tr_b16 v[184:185], v22 offset:49152
v_fmac_f32 v96, v73, v46
v_mfma_f32_16x16x32_bf16 a[108:111], v[236:239], v[204:207], a[108:111]
ds_read_b64_tr_b16 v[186:187], v22 offset:50176
v_fmac_f32 v96, v72, v47
v_mfma_f32_16x16x32_bf16 a[104:107], v[236:239], v[200:203], a[104:107]
ds_read_b64_tr_b16 v[188:189], v23 offset:49152
v_mul_f32 v96, v96, v97
v_mfma_f32_16x16x32_bf16 a[100:103], v[236:239], v[196:199], a[100:103]
s_add_u32 s72, s71, 95232
buffer_load_dwordx4 v7, s[16:19], s72 offen offset:3072 lds
v_mfma_f32_16x16x32_bf16 a[96:99], v[236:239], v[192:195], a[96:99]
ds_read_b64_tr_b16 v[190:191], v23 offset:50176
v_cvt_pk_bf16_f32 v101, v95, v96
v_mfma_f32_16x16x32_bf16 a[128:131], v[192:195], v[240:243], a[128:131]
v_mul_f32 v95, v75, v43
v_and_b32 v97, 0xffff0000, v62
v_mfma_f32_16x16x32_bf16 a[132:135], v[196:199], v[240:243], a[132:135]
v_fmac_f32 v95, v74, v44
v_fmac_f32 v95, v73, v45
v_mfma_f32_16x16x32_bf16 a[136:139], v[200:203], v[240:243], a[136:139]
s_add_u32 m0, s63, 69632
v_fmac_f32 v95, v72, v46
v_mul_f32 v95, v95, v97
v_mfma_f32_16x16x32_bf16 a[140:143], v[204:207], v[240:243], a[140:143]
s_add_u32 s72, s69, 32768
buffer_load_dwordx4 v2, s[8:11], s72 offen lds
v_mfma_f32_16x16x32_bf16 a[144:147], v[208:211], v[240:243], a[144:147]
v_mul_f32 v96, v75, v42
v_and_b32 v97, 0xffff0000, v61
v_mfma_f32_16x16x32_bf16 a[148:151], v[212:215], v[240:243], a[148:151]
v_fmac_f32 v96, v74, v43
v_fmac_f32 v96, v73, v44
v_mfma_f32_16x16x32_bf16 a[152:155], v[216:219], v[240:243], a[152:155]
s_add_u32 s72, s69, 39936
buffer_load_dwordx4 v3, s[8:11], s72 offen offset:1024 lds
v_mfma_f32_16x16x32_bf16 a[156:159], v[220:223], v[240:243], a[156:159]
v_fmac_f32 v96, v72, v45
v_mul_f32 v96, v96, v97
v_mfma_f32_16x16x32_bf16 a[188:191], v[220:223], v[244:247], a[188:191]
v_cvt_pk_bf16_f32 v102, v95, v96
v_mul_f32 v95, v75, v41
v_mfma_f32_16x16x32_bf16 a[184:187], v[216:219], v[244:247], a[184:187]
v_and_b32 v97, 0xffff0000, v60
v_fmac_f32 v95, v74, v42
v_mfma_f32_16x16x32_bf16 a[180:183], v[212:215], v[244:247], a[180:183]
v_fmac_f32 v95, v73, v43
v_fmac_f32 v95, v72, v44
v_mfma_f32_16x16x32_bf16 a[176:179], v[208:211], v[244:247], a[176:179]
s_add_u32 s72, s69, 47104
buffer_load_dwordx4 v2, s[8:11], s72 offen offset:2048 lds
v_mfma_f32_16x16x32_bf16 a[172:175], v[204:207], v[244:247], a[172:175]
v_mul_f32 v95, v95, v97
v_mul_f32 v96, v75, v40
v_mfma_f32_16x16x32_bf16 a[168:171], v[200:203], v[244:247], a[168:171]
v_and_b32 v97, 0xffff0000, v59
v_fmac_f32 v96, v74, v41
v_mfma_f32_16x16x32_bf16 a[164:167], v[196:199], v[244:247], a[164:167]
v_fmac_f32 v96, v73, v42
v_fmac_f32 v96, v72, v43
v_mfma_f32_16x16x32_bf16 a[160:163], v[192:195], v[244:247], a[160:163]
s_add_u32 s72, s69, 54272
buffer_load_dwordx4 v3, s[8:11], s72 offen offset:3072 lds
v_mfma_f32_16x16x32_bf16 a[192:195], v[192:195], v[248:251], a[192:195]
v_mul_f32 v96, v96, v97
v_cvt_pk_bf16_f32 v103, v95, v96
v_mfma_f32_16x16x32_bf16 a[196:199], v[196:199], v[248:251], a[196:199]
ds_write_b128 v28, v[100:103] offset:272
v_mul_f32 v95, v75, v39
v_mfma_f32_16x16x32_bf16 a[200:203], v[200:203], v[248:251], a[200:203]
v_and_b32 v97, 0xffff0000, v58
v_fmac_f32 v95, v74, v40
v_mfma_f32_16x16x32_bf16 a[204:207], v[204:207], v[248:251], a[204:207]
s_add_u32 m0, s64, 16384
v_fmac_f32 v95, v73, v41
v_fmac_f32 v95, v72, v42
v_mfma_f32_16x16x32_bf16 a[208:211], v[208:211], v[248:251], a[208:211]
s_add_u32 s72, s71, 0
buffer_load_dwordx4 v6, s[20:23], s72 offen lds
v_mfma_f32_16x16x32_bf16 a[212:215], v[212:215], v[248:251], a[212:215]
v_mul_f32 v95, v95, v97
v_mul_f32 v96, v75, v38
v_mfma_f32_16x16x32_bf16 a[216:219], v[216:219], v[248:251], a[216:219]
v_and_b32 v97, 0xffff0000, v57
v_fmac_f32 v96, v74, v39
v_mfma_f32_16x16x32_bf16 a[220:223], v[220:223], v[248:251], a[220:223]
v_fmac_f32 v96, v73, v40
v_fmac_f32 v96, v72, v41
v_mfma_f32_16x16x32_bf16 a[252:255], v[220:223], v[252:255], a[252:255]
s_add_u32 s72, s71, 31744
buffer_load_dwordx4 v6, s[20:23], s72 offen offset:1024 lds
v_mfma_f32_16x16x32_bf16 a[248:251], v[216:219], v[252:255], a[248:251]
v_mul_f32 v96, v96, v97
v_cvt_pk_bf16_f32 v104, v95, v96
v_mfma_f32_16x16x32_bf16 a[244:247], v[212:215], v[252:255], a[244:247]
v_mul_f32 v95, v75, v37
v_and_b32 v97, 0xffff0000, v56
v_mfma_f32_16x16x32_bf16 a[240:243], v[208:211], v[252:255], a[240:243]
v_fmac_f32 v95, v74, v38
v_fmac_f32 v95, v73, v39
v_mfma_f32_16x16x32_bf16 a[236:239], v[204:207], v[252:255], a[236:239]
s_add_u32 s72, s71, 63488
buffer_load_dwordx4 v7, s[20:23], s72 offen offset:2048 lds
v_mfma_f32_16x16x32_bf16 a[232:235], v[200:203], v[252:255], a[232:235]
v_fmac_f32 v95, v72, v40
v_mul_f32 v95, v95, v97
v_mfma_f32_16x16x32_bf16 a[228:231], v[196:199], v[252:255], a[228:231]
v_mul_f32 v96, v75, v36
v_and_b32 v97, 0xffff0000, v55
v_mfma_f32_16x16x32_bf16 a[224:227], v[192:195], v[252:255], a[224:227]
s_waitcnt lgkmcnt(0)
v_fmac_f32 v96, v74, v37
v_fmac_f32 v96, v73, v38
v_mfma_f32_16x16x32_bf16 a[0:3], v[160:163], v[128:131], a[0:3]
s_add_u32 s72, s71, 95232
buffer_load_dwordx4 v7, s[20:23], s72 offen offset:3072 lds
v_mfma_f32_16x16x32_bf16 a[4:7], v[160:163], v[132:135], a[4:7]
s_mov_b32 s80, 0x400000
buffer_load_dword v126, v125, s[12:15], s80 offen
v_mfma_f32_16x16x32_bf16 a[8:11], v[160:163], v[136:139], a[8:11]
s_mov_b32 s80, 0x500000
buffer_load_dword v126, v125, s[12:15], s80 offen
v_mfma_f32_16x16x32_bf16 a[12:15], v[160:163], v[140:143], a[12:15]
s_mov_b32 s80, 0x600000
buffer_load_dword v126, v125, s[12:15], s80 offen
v_mfma_f32_16x16x32_bf16 a[16:19], v[160:163], v[144:147], a[16:19]
s_mov_b32 s80, 0x700000
buffer_load_dword v126, v125, s[12:15], s80 offen
v_mfma_f32_16x16x32_bf16 a[20:23], v[160:163], v[148:151], a[20:23]
ds_read_b64_tr_b16 v[224:225], v20 offset:40960
v_fmac_f32 v96, v72, v39
v_mfma_f32_16x16x32_bf16 a[24:27], v[160:163], v[152:155], a[24:27]
v_mul_f32 v96, v96, v97
v_cvt_pk_bf16_f32 v105, v95, v96
v_mfma_f32_16x16x32_bf16 a[28:31], v[160:163], v[156:159], a[28:31]
ds_read_b64_tr_b16 v[226:227], v20 offset:41984
v_mul_f32 v95, v75, v35
v_mfma_f32_16x16x32_bf16 a[60:63], v[164:167], v[156:159], a[60:63]
v_and_b32 v97, 0xffff0000, v54
v_fmac_f32 v95, v74, v36
v_mfma_f32_16x16x32_bf16 a[56:59], v[164:167], v[152:155], a[56:59]
ds_read_b128 v[192:195], v25 offset:32768
v_fmac_f32 v95, v73, v37
v_mfma_f32_16x16x32_bf16 a[52:55], v[164:167], v[148:151], a[52:55]
v_fmac_f32 v95, v72, v38
v_mul_f32 v95, v95, v97
v_mfma_f32_16x16x32_bf16 a[48:51], v[164:167], v[144:147], a[48:51]
ds_read_b128 v[196:199], v25 offset:34816
v_mul_f32 v96, v75, v34
v_mfma_f32_16x16x32_bf16 a[44:47], v[164:167], v[140:143], a[44:47]
v_and_b32 v97, 0xffff0000, v53
v_fmac_f32 v96, v74, v35
v_mfma_f32_16x16x32_bf16 a[40:43], v[164:167], v[136:139], a[40:43]
ds_read_b128 v[200:203], v25 offset:36864
v_fmac_f32 v96, v73, v36
v_mfma_f32_16x16x32_bf16 a[36:39], v[164:167], v[132:135], a[36:39]
v_fmac_f32 v96, v72, v37
v_mul_f32 v96, v96, v97
v_mfma_f32_16x16x32_bf16 a[32:35], v[164:167], v[128:131], a[32:35]
ds_read_b128 v[204:207], v25 offset:38912
v_cvt_pk_bf16_f32 v106, v95, v96
v_mfma_f32_16x16x32_bf16 a[64:67], v[168:171], v[128:131], a[64:67]
v_mul_f32 v95, v75, v33
v_and_b32 v97, 0xffff0000, v52
v_mfma_f32_16x16x32_bf16 a[68:71], v[168:171], v[132:135], a[68:71]
ds_read_b128 v[208:211], v25 offset:40960
v_fmac_f32 v95, v74, v34
v_mfma_f32_16x16x32_bf16 a[72:75], v[168:171], v[136:139], a[72:75]
v_fmac_f32 v95, v73, v35
v_fmac_f32 v95, v72, v36
v_mfma_f32_16x16x32_bf16 a[76:79], v[168:171], v[140:143], a[76:79]
ds_read_b128 v[212:215], v25 offset:43008
v_mul_f32 v95, v95, v97
v_mfma_f32_16x16x32_bf16 a[80:83], v[168:171], v[144:147], a[80:83]
v_mul_f32 v96, v75, v32
v_and_b32 v97, 0xffff0000, v51
v_mfma_f32_16x16x32_bf16 a[84:87], v[168:171], v[148:151], a[84:87]
ds_read_b128 v[216:219], v25 offset:45056
v_fmac_f32 v96, v74, v33
v_mfma_f32_16x16x32_bf16 a[88:91], v[168:171], v[152:155], a[88:91]
v_fmac_f32 v96, v73, v34
v_fmac_f32 v96, v72, v35
v_mfma_f32_16x16x32_bf16 a[92:95], v[168:171], v[156:159], a[92:95]
ds_read_b128 v[220:223], v25 offset:47104
v_mul_f32 v96, v96, v97
v_mfma_f32_16x16x32_bf16 a[124:127], v[172:175], v[156:159], a[124:127]
v_cvt_pk_bf16_f32 v107, v95, v96
v_mfma_f32_16x16x32_bf16 a[120:123], v[172:175], v[152:155], a[120:123]
ds_read_b64_tr_b16 v[228:229], v21 offset:40960
ds_write_b128 v28, v[104:107] offset:288
v_mfma_f32_16x16x32_bf16 a[116:119], v[172:175], v[148:151], a[116:119]
v_mfma_f32_16x16x32_bf16 a[112:115], v[172:175], v[144:147], a[112:115]
ds_read_b64_tr_b16 v[230:231], v21 offset:41984
v_mfma_f32_16x16x32_bf16 a[108:111], v[172:175], v[140:143], a[108:111]
v_mfma_f32_16x16x32_bf16 a[104:107], v[172:175], v[136:139], a[104:107]
ds_read_b64_tr_b16 v[232:233], v22 offset:40960
v_mfma_f32_16x16x32_bf16 a[100:103], v[172:175], v[132:135], a[100:103]
v_mfma_f32_16x16x32_bf16 a[96:99], v[172:175], v[128:131], a[96:99]
ds_read_b64_tr_b16 v[234:235], v22 offset:41984
v_mfma_f32_16x16x32_bf16 a[128:131], v[128:131], v[176:179], a[128:131]
v_mfma_f32_16x16x32_bf16 a[132:135], v[132:135], v[176:179], a[132:135]
ds_read_b64_tr_b16 v[236:237], v23 offset:40960
v_mfma_f32_16x16x32_bf16 a[136:139], v[136:139], v[176:179], a[136:139]
v_mfma_f32_16x16x32_bf16 a[140:143], v[140:143], v[176:179], a[140:143]
ds_read_b64_tr_b16 v[238:239], v23 offset:41984
v_mfma_f32_16x16x32_bf16 a[144:147], v[144:147], v[176:179], a[144:147]
v_mfma_f32_16x16x32_bf16 a[148:151], v[148:151], v[176:179], a[148:151]
ds_read_b64_tr_b16 v[240:241], v20 offset:57344
v_mfma_f32_16x16x32_bf16 a[152:155], v[152:155], v[176:179], a[152:155]
v_mfma_f32_16x16x32_bf16 a[156:159], v[156:159], v[176:179], a[156:159]
ds_read_b64_tr_b16 v[242:243], v20 offset:58368
v_mfma_f32_16x16x32_bf16 a[188:191], v[156:159], v[180:183], a[188:191]
v_mfma_f32_16x16x32_bf16 a[184:187], v[152:155], v[180:183], a[184:187]
ds_read_b64_tr_b16 v[244:245], v21 offset:57344
v_mfma_f32_16x16x32_bf16 a[180:183], v[148:151], v[180:183], a[180:183]
v_mfma_f32_16x16x32_bf16 a[176:179], v[144:147], v[180:183], a[176:179]
ds_read_b64_tr_b16 v[246:247], v21 offset:58368
v_mfma_f32_16x16x32_bf16 a[172:175], v[140:143], v[180:183], a[172:175]
v_mfma_f32_16x16x32_bf16 a[168:171], v[136:139], v[180:183], a[168:171]
ds_read_b64_tr_b16 v[248:249], v22 offset:57344
v_mfma_f32_16x16x32_bf16 a[164:167], v[132:135], v[180:183], a[164:167]
v_mfma_f32_16x16x32_bf16 a[160:163], v[128:131], v[180:183], a[160:163]
ds_read_b64_tr_b16 v[250:251], v22 offset:58368
v_mfma_f32_16x16x32_bf16 a[192:195], v[128:131], v[184:187], a[192:195]
v_mfma_f32_16x16x32_bf16 a[196:199], v[132:135], v[184:187], a[196:199]
ds_read_b64_tr_b16 v[252:253], v23 offset:57344
v_mfma_f32_16x16x32_bf16 a[200:203], v[136:139], v[184:187], a[200:203]
v_mfma_f32_16x16x32_bf16 a[204:207], v[140:143], v[184:187], a[204:207]
ds_read_b64_tr_b16 v[254:255], v23 offset:58368
v_mfma_f32_16x16x32_bf16 a[208:211], v[144:147], v[184:187], a[208:211]
v_mfma_f32_16x16x32_bf16 a[212:215], v[148:151], v[184:187], a[212:215]
v_mfma_f32_16x16x32_bf16 a[216:219], v[152:155], v[184:187], a[216:219]
v_mfma_f32_16x16x32_bf16 a[220:223], v[156:159], v[184:187], a[220:223]
v_mfma_f32_16x16x32_bf16 a[252:255], v[156:159], v[188:191], a[252:255]
v_mfma_f32_16x16x32_bf16 a[248:251], v[152:155], v[188:191], a[248:251]
v_mfma_f32_16x16x32_bf16 a[244:247], v[148:151], v[188:191], a[244:247]
v_mfma_f32_16x16x32_bf16 a[240:243], v[144:147], v[188:191], a[240:243]
v_mfma_f32_16x16x32_bf16 a[236:239], v[140:143], v[188:191], a[236:239]
v_mfma_f32_16x16x32_bf16 a[232:235], v[136:139], v[188:191], a[232:235]
v_mfma_f32_16x16x32_bf16 a[228:231], v[132:135], v[188:191], a[228:231]
s_waitcnt vmcnt(4) lgkmcnt(0)
v_mfma_f32_16x16x32_bf16 a[224:227], v[128:131], v[188:191], a[224:227]
s_barrier
v_mfma_f32_16x16x32_bf16 a[0:3], v[224:227], v[192:195], a[0:3]
s_add_u32 s73, s61, 7
ds_read_b64_tr_b16 v[160:161], v20 offset:0
v_mfma_f32_16x16x32_bf16 a[4:7], v[224:227], v[196:199], a[4:7]
s_and_b32 s73, s73, 7
ds_read_b64_tr_b16 v[162:163], v20 offset:1024
v_mfma_f32_16x16x32_bf16 a[8:11], v[224:227], v[200:203], a[8:11]
s_lshl_b32 s69, s73, 7
ds_read_b128 v[128:131], v24 offset:0
v_mfma_f32_16x16x32_bf16 a[12:15], v[224:227], v[204:207], a[12:15]
s_add_u32 s69, s69, s67
ds_read_b128 v[132:135], v24 offset:2048
v_mfma_f32_16x16x32_bf16 a[16:19], v[224:227], v[208:211], a[16:19]
s_lshl_b32 s71, s73, 19
ds_read_b128 v[136:139], v24 offset:4096
v_mfma_f32_16x16x32_bf16 a[20:23], v[224:227], v[212:215], a[20:23]
s_add_u32 s71, s71, s66
ds_read_b128 v[140:143], v24 offset:6144
v_mfma_f32_16x16x32_bf16 a[24:27], v[224:227], v[216:219], a[24:27]
s_add_u32 m0, s63, 98304
ds_read_b128 v[144:147], v24 offset:8192
v_mfma_f32_16x16x32_bf16 a[28:31], v[224:227], v[220:223], a[28:31]
s_add_u32 s72, s69, 0
buffer_load_dwordx4 v2, s[8:11], s72 offen lds
v_mfma_f32_16x16x32_bf16 a[60:63], v[228:231], v[220:223], a[60:63]
s_add_u32 s72, s69, 7168
buffer_load_dwordx4 v3, s[8:11], s72 offen offset:1024 lds
v_mfma_f32_16x16x32_bf16 a[56:59], v[228:231], v[216:219], a[56:59]
s_add_u32 s72, s69, 14336
buffer_load_dwordx4 v2, s[8:11], s72 offen offset:2048 lds
v_mfma_f32_16x16x32_bf16 a[52:55], v[228:231], v[212:215], a[52:55]
s_mul_i32 s74, s58, 4352
ds_read_b128 v[148:151], v24 offset:10240
v_mfma_f32_16x16x32_bf16 a[48:51], v[228:231], v[208:211], a[48:51]
s_add_u32 s74, s74, 131072
ds_read_b128 v[152:155], v24 offset:12288
v_lshrrev_b32 v26, 4, v0
v_mfma_f32_16x16x32_bf16 a[44:47], v[228:231], v[204:207], a[44:47]
s_add_u32 s72, s69, 21504
buffer_load_dwordx4 v3, s[8:11], s72 offen offset:3072 lds
v_mfma_f32_16x16x32_bf16 a[40:43], v[228:231], v[200:203], a[40:43]
ds_read_b128 v[156:159], v24 offset:14336
v_and_b32 v27, 15, v0
v_mfma_f32_16x16x32_bf16 a[36:39], v[228:231], v[196:199], a[36:39]
ds_read_b64_tr_b16 v[164:165], v21 offset:0
v_lshlrev_b32 v27, 4, v27
v_mfma_f32_16x16x32_bf16 a[32:35], v[228:231], v[192:195], a[32:35]
ds_read_b64_tr_b16 v[166:167], v21 offset:1024
v_mul_u32_u24 v28, 272, v26
v_mfma_f32_16x16x32_bf16 a[64:67], v[232:235], v[192:195], a[64:67]
ds_read_b64_tr_b16 v[168:169], v22 offset:0
v_add3_u32 v28, v28, v27, s74
v_mfma_f32_16x16x32_bf16 a[68:71], v[232:235], v[196:199], a[68:71]
s_add_u32 m0, s64, 32768
ds_read_b64_tr_b16 v[170:171], v22 offset:1024
v_lshl_add_u32 v26, v26, 12, v27
v_mfma_f32_16x16x32_bf16 a[72:75], v[232:235], v[200:203], a[72:75]
s_add_u32 s72, s71, 0
buffer_load_dwordx4 v6, s[16:19], s72 offen lds
v_mfma_f32_16x16x32_bf16 a[76:79], v[232:235], v[204:207], a[76:79]
ds_read_b64_tr_b16 v[172:173], v23 offset:0
ds_read_b128 v[32:35], v28 offset:0
v_mfma_f32_16x16x32_bf16 a[80:83], v[232:235], v[208:211], a[80:83]
ds_read_b64_tr_b16 v[174:175], v23 offset:1024
ds_read_b128 v[36:39], v28 offset:1088
v_mfma_f32_16x16x32_bf16 a[84:87], v[232:235], v[212:215], a[84:87]
s_add_u32 s72, s71, 31744
buffer_load_dwordx4 v6, s[16:19], s72 offen offset:1024 lds
v_mfma_f32_16x16x32_bf16 a[88:91], v[232:235], v[216:219], a[88:91]
ds_read_b64_tr_b16 v[176:177], v20 offset:16384
ds_read_b128 v[40:43], v28 offset:2176
v_mfma_f32_16x16x32_bf16 a[92:95], v[232:235], v[220:223], a[92:95]
ds_read_b64_tr_b16 v[178:179], v20 offset:17408
ds_read_b128 v[44:47], v28 offset:3264
v_mfma_f32_16x16x32_bf16 a[124:127], v[236:239], v[220:223], a[124:127]
s_and_b32 s74, s2, 15
ds_read_b64_tr_b16 v[180:181], v21 offset:16384
v_mfma_f32_16x16x32_bf16 a[120:123], v[236:239], v[216:219], a[120:123]
s_add_u32 s72, s71, 63488
buffer_load_dwordx4 v7, s[16:19], s72 offen offset:2048 lds
v_mfma_f32_16x16x32_bf16 a[116:119], v[236:239], v[212:215], a[116:119]
s_lshl_b32 s74, s74, 2
ds_read_b64_tr_b16 v[182:183], v21 offset:17408
v_mfma_f32_16x16x32_bf16 a[112:115], v[236:239], v[208:211], a[112:115]
s_add_u32 s74, s74, s58
ds_read_b64_tr_b16 v[184:185], v22 offset:16384
v_mfma_f32_16x16x32_bf16 a[108:111], v[236:239], v[204:207], a[108:111]
s_lshl_b32 s74, s74, 16
ds_read_b64_tr_b16 v[186:187], v22 offset:17408
v_mfma_f32_16x16x32_bf16 a[104:107], v[236:239], v[200:203], a[104:107]
s_lshr_b32 s75, s2, 4
ds_read_b64_tr_b16 v[188:189], v23 offset:16384
v_mfma_f32_16x16x32_bf16 a[100:103], v[236:239], v[196:199], a[100:103]
s_add_u32 s72, s71, 95232
buffer_load_dwordx4 v7, s[16:19], s72 offen offset:3072 lds
v_mfma_f32_16x16x32_bf16 a[96:99], v[236:239], v[192:195], a[96:99]
s_lshl_b32 s75, s75, 8
ds_read_b64_tr_b16 v[190:191], v23 offset:17408
v_mfma_f32_16x16x32_bf16 a[128:131], v[192:195], v[240:243], a[128:131]
s_sub_u32 s74, s74, s75
v_mfma_f32_16x16x32_bf16 a[132:135], v[196:199], v[240:243], a[132:135]
s_add_u32 s74, s74, 0x3000f00
v_mfma_f32_16x16x32_bf16 a[136:139], v[200:203], v[240:243], a[136:139]
s_add_u32 m0, s63, 102400
v_mfma_f32_16x16x32_bf16 a[140:143], v[204:207], v[240:243], a[140:143]
s_add_u32 s72, s69, 32768
buffer_load_dwordx4 v2, s[8:11], s72 offen lds
v_mfma_f32_16x16x32_bf16 a[144:147], v[208:211], v[240:243], a[144:147]
s_waitcnt lgkmcnt(6)
buffer_store_dwordx4 v[32:35], v26, s[44:47], s74 offen sc1
v_mfma_f32_16x16x32_bf16 a[148:151], v[212:215], v[240:243], a[148:151]
s_add_u32 s74, s74, 0x4000
buffer_store_dwordx4 v[36:39], v26, s[44:47], s74 offen sc1
v_mfma_f32_16x16x32_bf16 a[152:155], v[216:219], v[240:243], a[152:155]
s_add_u32 s72, s69, 39936
buffer_load_dwordx4 v3, s[8:11], s72 offen offset:1024 lds
v_mfma_f32_16x16x32_bf16 a[156:159], v[220:223], v[240:243], a[156:159]
s_add_u32 s74, s74, 0x4000
buffer_store_dwordx4 v[40:43], v26, s[44:47], s74 offen sc1
v_mfma_f32_16x16x32_bf16 a[188:191], v[220:223], v[244:247], a[188:191]
s_add_u32 s74, s74, 0x4000
buffer_store_dwordx4 v[44:47], v26, s[44:47], s74 offen sc1
v_mfma_f32_16x16x32_bf16 a[184:187], v[216:219], v[244:247], a[184:187]
s_waitcnt vmcnt(34)
v_lshlrev_b32 v78, 16, v84
v_lshlrev_b32 v79, 16, v108
v_mfma_f32_16x16x32_bf16 a[180:183], v[212:215], v[244:247], a[180:183]
v_mul_f32 v76, v78, v79
v_lshlrev_b32 v80, 16, v116
v_mfma_f32_16x16x32_bf16 a[176:179], v[208:211], v[244:247], a[176:179]
s_add_u32 s72, s69, 47104
buffer_load_dwordx4 v2, s[8:11], s72 offen offset:2048 lds
v_mfma_f32_16x16x32_bf16 a[172:175], v[204:207], v[244:247], a[172:175]
v_mul_f32 v77, v78, v80
v_and_b32 v78, 0xffff0000, v84
v_mfma_f32_16x16x32_bf16 a[168:171], v[200:203], v[244:247], a[168:171]
v_and_b32 v79, 0xffff0000, v108
v_fmac_f32 v76, v78, v79
v_mfma_f32_16x16x32_bf16 a[164:167], v[196:199], v[244:247], a[164:167]
v_and_b32 v80, 0xffff0000, v116
v_fmac_f32 v77, v78, v80
v_mfma_f32_16x16x32_bf16 a[160:163], v[192:195], v[244:247], a[160:163]
s_add_u32 s72, s69, 54272
buffer_load_dwordx4 v3, s[8:11], s72 offen offset:3072 lds
v_mfma_f32_16x16x32_bf16 a[192:195], v[192:195], v[248:251], a[192:195]
v_lshlrev_b32 v78, 16, v85
v_lshlrev_b32 v79, 16, v109
v_mfma_f32_16x16x32_bf16 a[196:199], v[196:199], v[248:251], a[196:199]
v_fmac_f32 v76, v78, v79
v_lshlrev_b32 v80, 16, v117
v_mfma_f32_16x16x32_bf16 a[200:203], v[200:203], v[248:251], a[200:203]
v_fmac_f32 v77, v78, v80
v_and_b32 v78, 0xffff0000, v85
v_mfma_f32_16x16x32_bf16 a[204:207], v[204:207], v[248:251], a[204:207]
s_add_u32 m0, s64, 49152
v_and_b32 v79, 0xffff0000, v109
v_fmac_f32 v76, v78, v79
v_mfma_f32_16x16x32_bf16 a[208:211], v[208:211], v[248:251], a[208:211]
s_add_u32 s72, s71, 0
buffer_load_dwordx4 v6, s[20:23], s72 offen lds
v_mfma_f32_16x16x32_bf16 a[212:215], v[212:215], v[248:251], a[212:215]
v_and_b32 v80, 0xffff0000, v117
v_fmac_f32 v77, v78, v80
v_mfma_f32_16x16x32_bf16 a[216:219], v[216:219], v[248:251], a[216:219]
v_lshlrev_b32 v78, 16, v86
v_lshlrev_b32 v79, 16, v110
v_mfma_f32_16x16x32_bf16 a[220:223], v[220:223], v[248:251], a[220:223]
v_fmac_f32 v76, v78, v79
v_lshlrev_b32 v80, 16, v118
v_mfma_f32_16x16x32_bf16 a[252:255], v[220:223], v[252:255], a[252:255]
s_add_u32 s72, s71, 31744
buffer_load_dwordx4 v6, s[20:23], s72 offen offset:1024 lds
v_mfma_f32_16x16x32_bf16 a[248:251], v[216:219], v[252:255], a[248:251]
v_fmac_f32 v77, v78, v80
v_and_b32 v78, 0xffff0000, v86
v_mfma_f32_16x16x32_bf16 a[244:247], v[212:215], v[252:255], a[244:247]
v_and_b32 v79, 0xffff0000, v110
v_fmac_f32 v76, v78, v79
v_mfma_f32_16x16x32_bf16 a[240:243], v[208:211], v[252:255], a[240:243]
v_and_b32 v80, 0xffff0000, v118
v_fmac_f32 v77, v78, v80
v_mfma_f32_16x16x32_bf16 a[236:239], v[204:207], v[252:255], a[236:239]
s_add_u32 s72, s71, 63488
buffer_load_dwordx4 v7, s[20:23], s72 offen offset:2048 lds
v_mfma_f32_16x16x32_bf16 a[232:235], v[200:203], v[252:255], a[232:235]
v_lshlrev_b32 v78, 16, v87
v_lshlrev_b32 v79, 16, v111
v_mfma_f32_16x16x32_bf16 a[228:231], v[196:199], v[252:255], a[228:231]
v_fmac_f32 v76, v78, v79
v_lshlrev_b32 v80, 16, v119
v_mfma_f32_16x16x32_bf16 a[224:227], v[192:195], v[252:255], a[224:227]
s_waitcnt lgkmcnt(0)
v_fmac_f32 v77, v78, v80
v_and_b32 v78, 0xffff0000, v87
v_mfma_f32_16x16x32_bf16 a[0:3], v[160:163], v[128:131], a[0:3]
s_add_u32 s72, s71, 95232
buffer_load_dwordx4 v7, s[20:23], s72 offen offset:3072 lds
v_mfma_f32_16x16x32_bf16 a[4:7], v[160:163], v[132:135], a[4:7]
ds_read_b64_tr_b16 v[224:225], v20 offset:8192
v_and_b32 v79, 0xffff0000, v111
v_mfma_f32_16x16x32_bf16 a[8:11], v[160:163], v[136:139], a[8:11]
v_fmac_f32 v76, v78, v79
v_and_b32 v80, 0xffff0000, v119
v_mfma_f32_16x16x32_bf16 a[12:15], v[160:163], v[140:143], a[12:15]
ds_read_b64_tr_b16 v[226:227], v20 offset:9216
v_fmac_f32 v77, v78, v80
v_mfma_f32_16x16x32_bf16 a[16:19], v[160:163], v[144:147], a[16:19]
v_lshlrev_b32 v78, 16, v88
v_lshlrev_b32 v79, 16, v112
v_mfma_f32_16x16x32_bf16 a[20:23], v[160:163], v[148:151], a[20:23]
ds_read_b128 v[192:195], v25 offset:0
v_fmac_f32 v76, v78, v79
v_mfma_f32_16x16x32_bf16 a[24:27], v[160:163], v[152:155], a[24:27]
v_lshlrev_b32 v80, 16, v120
v_fmac_f32 v77, v78, v80
v_mfma_f32_16x16x32_bf16 a[28:31], v[160:163], v[156:159], a[28:31]
ds_read_b128 v[196:199], v25 offset:2048
v_and_b32 v78, 0xffff0000, v88
v_mfma_f32_16x16x32_bf16 a[60:63], v[164:167], v[156:159], a[60:63]
v_and_b32 v79, 0xffff0000, v112
v_fmac_f32 v76, v78, v79
v_mfma_f32_16x16x32_bf16 a[56:59], v[164:167], v[152:155], a[56:59]
ds_read_b128 v[200:203], v25 offset:4096
v_and_b32 v80, 0xffff0000, v120
v_mfma_f32_16x16x32_bf16 a[52:55], v[164:167], v[148:151], a[52:55]
v_fmac_f32 v77, v78, v80
v_lshlrev_b32 v78, 16, v89
v_mfma_f32_16x16x32_bf16 a[48:51], v[164:167], v[144:147], a[48:51]
ds_read_b128 v[204:207], v25 offset:6144
v_lshlrev_b32 v79, 16, v113
v_mfma_f32_16x16x32_bf16 a[44:47], v[164:167], v[140:143], a[44:47]
v_fmac_f32 v76, v78, v79
v_lshlrev_b32 v80, 16, v121
v_mfma_f32_16x16x32_bf16 a[40:43], v[164:167], v[136:139], a[40:43]
ds_read_b128 v[208:211], v25 offset:8192
v_fmac_f32 v77, v78, v80
v_mfma_f32_16x16x32_bf16 a[36:39], v[164:167], v[132:135], a[36:39]
v_and_b32 v78, 0xffff0000, v89
v_and_b32 v79, 0xffff0000, v113
v_mfma_f32_16x16x32_bf16 a[32:35], v[164:167], v[128:131], a[32:35]
ds_read_b128 v[212:215], v25 offset:10240
v_fmac_f32 v76, v78, v79
v_mfma_f32_16x16x32_bf16 a[64:67], v[168:171], v[128:131], a[64:67]
v_and_b32 v80, 0xffff0000, v121
v_fmac_f32 v77, v78, v80
v_mfma_f32_16x16x32_bf16 a[68:71], v[168:171], v[132:135], a[68:71]
ds_read_b128 v[216:219], v25 offset:12288
v_lshlrev_b32 v78, 16, v90
v_mfma_f32_16x16x32_bf16 a[72:75], v[168:171], v[136:139], a[72:75]
v_lshlrev_b32 v79, 16, v114
v_fmac_f32 v76, v78, v79
v_mfma_f32_16x16x32_bf16 a[76:79], v[168:171], v[140:143], a[76:79]
ds_read_b128 v[220:223], v25 offset:14336
v_lshlrev_b32 v80, 16, v122
v_mfma_f32_16x16x32_bf16 a[80:83], v[168:171], v[144:147], a[80:83]
s_lshr_b32 s75, s93, 5
v_fmac_f32 v77, v78, v80
v_and_b32 v78, 0xffff0000, v90
v_mfma_f32_16x16x32_bf16 a[84:87], v[168:171], v[148:151], a[84:87]
s_and_b32 s75, s75, 0x3f80
ds_read_b64_tr_b16 v[228:229], v21 offset:8192
v_and_b32 v79, 0xffff0000, v114
v_mfma_f32_16x16x32_bf16 a[88:91], v[168:171], v[152:155], a[88:91]
s_add_u32 s75, s75, LcB0-Lpc0
v_lshrrev_b32 v2, 6, v0
v_lshlrev_b32 v2, 7, v2
v_mfma_f32_16x16x32_bf16 a[92:95], v[168:171], v[156:159], a[92:95]
v_add_u32 v2, s75, v2
v_min_u32 v2, Lcode_end-Lpc0, v2
v_mfma_f32_16x16x32_bf16 a[124:127], v[172:175], v[156:159], a[124:127]
global_load_dword v3, v2, s[98:99]
v_mfma_f32_16x16x32_bf16 a[120:123], v[172:175], v[152:155], a[120:123]
ds_read_b64_tr_b16 v[230:231], v21 offset:9216
v_fmac_f32 v76, v78, v79
v_mfma_f32_16x16x32_bf16 a[116:119], v[172:175], v[148:151], a[116:119]
v_and_b32 v80, 0xffff0000, v122
v_fmac_f32 v77, v78, v80
v_mfma_f32_16x16x32_bf16 a[112:115], v[172:175], v[144:147], a[112:115]
ds_read_b64_tr_b16 v[232:233], v22 offset:8192
v_lshlrev_b32 v78, 16, v91
v_mfma_f32_16x16x32_bf16 a[108:111], v[172:175], v[140:143], a[108:111]
v_lshlrev_b32 v79, 16, v115
v_fmac_f32 v76, v78, v79
v_mfma_f32_16x16x32_bf16 a[104:107], v[172:175], v[136:139], a[104:107]
ds_read_b64_tr_b16 v[234:235], v22 offset:9216
v_lshlrev_b32 v80, 16, v123
v_mfma_f32_16x16x32_bf16 a[100:103], v[172:175], v[132:135], a[100:103]
v_fmac_f32 v77, v78, v80
v_and_b32 v78, 0xffff0000, v91
v_mfma_f32_16x16x32_bf16 a[96:99], v[172:175], v[128:131], a[96:99]
ds_read_b64_tr_b16 v[236:237], v23 offset:8192
v_and_b32 v79, 0xffff0000, v115
v_mfma_f32_16x16x32_bf16 a[128:131], v[128:131], v[176:179], a[128:131]
v_fmac_f32 v76, v78, v79
v_and_b32 v80, 0xffff0000, v123
v_mfma_f32_16x16x32_bf16 a[132:135], v[132:135], v[176:179], a[132:135]
ds_read_b64_tr_b16 v[238:239], v23 offset:9216
v_fmac_f32 v77, v78, v80
v_mfma_f32_16x16x32_bf16 a[136:139], v[136:139], v[176:179], a[136:139]
v_add_f32_dpp v76, v76, v76 row_ror:8 row_mask:0xf bank_mask:0xf
v_add_f32_dpp v77, v77, v77 row_ror:8 row_mask:0xf bank_mask:0xf
v_mfma_f32_16x16x32_bf16 a[140:143], v[140:143], v[176:179], a[140:143]
ds_read_b64_tr_b16 v[240:241], v20 offset:24576
v_add_f32_dpp v76, v76, v76 row_ror:4 row_mask:0xf bank_mask:0xf
v_mfma_f32_16x16x32_bf16 a[144:147], v[144:147], v[176:179], a[144:147]
v_add_f32_dpp v77, v77, v77 row_ror:4 row_mask:0xf bank_mask:0xf
v_add_f32_dpp v76, v76, v76 row_ror:2 row_mask:0xf bank_mask:0xf
v_mfma_f32_16x16x32_bf16 a[148:151], v[148:151], v[176:179], a[148:151]
ds_read_b64_tr_b16 v[242:243], v20 offset:25600
v_add_f32_dpp v77, v77, v77 row_ror:2 row_mask:0xf bank_mask:0xf
v_mfma_f32_16x16x32_bf16 a[152:155], v[152:155], v[176:179], a[152:155]
v_add_f32_dpp v76, v76, v76 row_ror:1 row_mask:0xf bank_mask:0xf
v_add_f32_dpp v77, v77, v77 row_ror:1 row_mask:0xf bank_mask:0xf
v_mfma_f32_16x16x32_bf16 a[156:159], v[156:159], v[176:179], a[156:159]
ds_read_b64_tr_b16 v[244:245], v21 offset:24576
v_mov_b32 v78, v76
v_mfma_f32_16x16x32_bf16 a[188:191], v[156:159], v[180:183], a[188:191]
v_mov_b32 v79, v77
v_permlane16_swap_b32 v76, v78
v_mfma_f32_16x16x32_bf16 a[184:187], v[152:155], v[180:183], a[184:187]
ds_read_b64_tr_b16 v[246:247], v21 offset:25600
v_permlane16_swap_b32 v77, v79
v_mfma_f32_16x16x32_bf16 a[180:183], v[148:151], v[180:183], a[180:183]
v_add_f32 v76, v76, v78
v_add_f32 v77, v77, v79
v_mfma_f32_16x16x32_bf16 a[176:179], v[144:147], v[180:183], a[176:179]
ds_read_b64_tr_b16 v[248:249], v22 offset:24576
v_mov_b32 v78, v76
v_mfma_f32_16x16x32_bf16 a[172:175], v[140:143], v[180:183], a[172:175]
v_mov_b32 v79, v77
v_permlane32_swap_b32 v76, v78
v_mfma_f32_16x16x32_bf16 a[168:171], v[136:139], v[180:183], a[168:171]
ds_read_b64_tr_b16 v[250:251], v22 offset:25600
v_permlane32_swap_b32 v77, v79
v_mfma_f32_16x16x32_bf16 a[164:167], v[132:135], v[180:183], a[164:167]
v_add_f32 v76, v76, v78
v_add_f32 v77, v77, v79
v_mfma_f32_16x16x32_bf16 a[160:163], v[128:131], v[180:183], a[160:163]
ds_read_b64_tr_b16 v[252:253], v23 offset:24576
v_mul_f32 v76, 0xbfb8aa3b, v76
v_mfma_f32_16x16x32_bf16 a[192:195], v[128:131], v[184:187], a[192:195]
v_mul_f32 v77, 0xbfb8aa3b, v77
v_mfma_f32_16x16x32_bf16 a[196:199], v[132:135], v[184:187], a[196:199]
ds_read_b64_tr_b16 v[254:255], v23 offset:25600
v_mfma_f32_16x16x32_bf16 a[200:203], v[136:139], v[184:187], a[200:203]
v_exp_f32 v76, v76
v_mfma_f32_16x16x32_bf16 a[204:207], v[140:143], v[184:187], a[204:207]
v_exp_f32 v77, v77
v_mfma_f32_16x16x32_bf16 a[208:211], v[144:147], v[184:187], a[208:211]
v_add_f32 v76, 1.0, v76
v_add_f32 v77, 1.0, v77
v_mfma_f32_16x16x32_bf16 a[212:215], v[148:151], v[184:187], a[212:215]
v_rcp_f32 v76, v76
v_mfma_f32_16x16x32_bf16 a[216:219], v[152:155], v[184:187], a[216:219]
v_rcp_f32 v77, v77
v_mfma_f32_16x16x32_bf16 a[220:223], v[156:159], v[184:187], a[220:223]
s_lshr_b32 s80, s76, 9
v_mfma_f32_16x16x32_bf16 a[252:255], v[156:159], v[188:191], a[252:255]
s_add_u32 s80, s80, 0x3800000
v_min_u32 v78, 1, v0
v_lshlrev_b32 v78, 30, v78
v_mfma_f32_16x16x32_bf16 a[248:251], v[152:155], v[188:191], a[248:251]
buffer_store_dwordx2 v[76:77], v78, s[44:47], s80 offen sc1
v_mfma_f32_16x16x32_bf16 a[244:247], v[148:151], v[188:191], a[244:247]
v_mfma_f32_16x16x32_bf16 a[240:243], v[144:147], v[188:191], a[240:243]
v_mfma_f32_16x16x32_bf16 a[236:239], v[140:143], v[188:191], a[236:239]
v_mfma_f32_16x16x32_bf16 a[232:235], v[136:139], v[188:191], a[232:235]
v_mfma_f32_16x16x32_bf16 a[228:231], v[132:135], v[188:191], a[228:231]
s_waitcnt vmcnt(2) lgkmcnt(0)
v_mfma_f32_16x16x32_bf16 a[224:227], v[128:131], v[188:191], a[224:227]
s_barrier
v_mfma_f32_16x16x32_bf16 a[0:3], v[224:227], v[192:195], a[0:3]
s_add_u32 s73, s62, 0
ds_read_b64_tr_b16 v[160:161], v20 offset:32768
v_mfma_f32_16x16x32_bf16 a[4:7], v[224:227], v[196:199], a[4:7]
s_add_u32 s70, s73, s65
ds_read_b64_tr_b16 v[162:163], v20 offset:33792
v_mfma_f32_16x16x32_bf16 a[8:11], v[224:227], v[200:203], a[8:11]
s_and_b32 s70, s70, 3
ds_read_b128 v[128:131], v24 offset:32768
v_mfma_f32_16x16x32_bf16 a[12:15], v[224:227], v[204:207], a[12:15]
s_and_b32 s73, s73, 12
ds_read_b128 v[132:135], v24 offset:34816
v_mfma_f32_16x16x32_bf16 a[16:19], v[224:227], v[208:211], a[16:19]
s_or_b32 s73, s73, s70
ds_read_b128 v[136:139], v24 offset:36864
v_mfma_f32_16x16x32_bf16 a[20:23], v[224:227], v[212:215], a[20:23]
s_lshl_b32 s71, s73, 19
ds_read_b128 v[140:143], v24 offset:38912
v_mfma_f32_16x16x32_bf16 a[24:27], v[224:227], v[216:219], a[24:27]
s_add_u32 s71, s71, s66
ds_read_b128 v[144:147], v24 offset:40960
v_mfma_f32_16x16x32_bf16 a[28:31], v[224:227], v[220:223], a[28:31]
s_lshl_b32 s73, s73, 7
ds_read_b128 v[148:151], v24 offset:43008
v_mfma_f32_16x16x32_bf16 a[60:63], v[228:231], v[220:223], a[60:63]
s_add_u32 s69, s73, s67
ds_read_b128 v[152:155], v24 offset:45056
v_mfma_f32_16x16x32_bf16 a[56:59], v[228:231], v[216:219], a[56:59]
s_add_u32 s70, s73, s68
ds_read_b128 v[156:159], v24 offset:47104
v_mfma_f32_16x16x32_bf16 a[52:55], v[228:231], v[212:215], a[52:55]
s_add_u32 m0, s64, 0
ds_read_b64_tr_b16 v[164:165], v21 offset:32768
v_mfma_f32_16x16x32_bf16 a[48:51], v[228:231], v[208:211], a[48:51]
s_add_u32 s72, s71, 0
buffer_load_dwordx4 v6, s[12:15], s72 offen lds
v_mfma_f32_16x16x32_bf16 a[44:47], v[228:231], v[204:207], a[44:47]
s_add_u32 s72, s71, 31744
buffer_load_dwordx4 v6, s[12:15], s72 offen offset:1024 lds
v_mfma_f32_16x16x32_bf16 a[40:43], v[228:231], v[200:203], a[40:43]
s_add_u32 s72, s71, 63488
buffer_load_dwordx4 v7, s[12:15], s72 offen offset:2048 lds
v_mfma_f32_16x16x32_bf16 a[36:39], v[228:231], v[196:199], a[36:39]
ds_read_b64_tr_b16 v[166:167], v21 offset:33792
v_mfma_f32_16x16x32_bf16 a[32:35], v[228:231], v[192:195], a[32:35]
s_add_u32 s72, s71, 95232
buffer_load_dwordx4 v7, s[12:15], s72 offen offset:3072 lds
v_mfma_f32_16x16x32_bf16 a[64:67], v[232:235], v[192:195], a[64:67]
ds_read_b64_tr_b16 v[168:169], v22 offset:32768
v_mfma_f32_16x16x32_bf16 a[68:71], v[232:235], v[196:199], a[68:71]
ds_read_b64_tr_b16 v[170:171], v22 offset:33792
v_mfma_f32_16x16x32_bf16 a[72:75], v[232:235], v[200:203], a[72:75]
ds_read_b64_tr_b16 v[172:173], v23 offset:32768
v_mfma_f32_16x16x32_bf16 a[76:79], v[232:235], v[204:207], a[76:79]
ds_read_b64_tr_b16 v[174:175], v23 offset:33792
v_mfma_f32_16x16x32_bf16 a[80:83], v[232:235], v[208:211], a[80:83]
s_add_u32 m0, s63, 131072
ds_read_b64_tr_b16 v[176:177], v20 offset:49152
v_mfma_f32_16x16x32_bf16 a[84:87], v[232:235], v[212:215], a[84:87]
s_add_u32 s72, s69, 0
buffer_load_dwordx4 v4, s[4:7], s72 offen lds
v_mfma_f32_16x16x32_bf16 a[88:91], v[232:235], v[216:219], a[88:91]
ds_read_b64_tr_b16 v[178:179], v20 offset:50176
v_mfma_f32_16x16x32_bf16 a[92:95], v[232:235], v[220:223], a[92:95]
ds_read_b64_tr_b16 v[180:181], v21 offset:49152
v_mfma_f32_16x16x32_bf16 a[124:127], v[236:239], v[220:223], a[124:127]
ds_read_b64_tr_b16 v[182:183], v21 offset:50176
v_mfma_f32_16x16x32_bf16 a[120:123], v[236:239], v[216:219], a[120:123]
s_add_u32 s72, s69, 15360
buffer_load_dwordx4 v5, s[4:7], s72 offen offset:1024 lds
v_mfma_f32_16x16x32_bf16 a[116:119], v[236:239], v[212:215], a[116:119]
ds_read_b64_tr_b16 v[184:185], v22 offset:49152
v_mfma_f32_16x16x32_bf16 a[112:115], v[236:239], v[208:211], a[112:115]
ds_read_b64_tr_b16 v[186:187], v22 offset:50176
v_mfma_f32_16x16x32_bf16 a[108:111], v[236:239], v[204:207], a[108:111]
ds_read_b64_tr_b16 v[188:189], v23 offset:49152
v_mfma_f32_16x16x32_bf16 a[104:107], v[236:239], v[200:203], a[104:107]
ds_read_b64_tr_b16 v[190:191], v23 offset:50176
v_mfma_f32_16x16x32_bf16 a[100:103], v[236:239], v[196:199], a[100:103]
s_add_u32 s72, s69, 30720
buffer_load_dwordx4 v4, s[4:7], s72 offen offset:2048 lds
v_mfma_f32_16x16x32_bf16 a[96:99], v[236:239], v[192:195], a[96:99]
v_mfma_f32_16x16x32_bf16 a[128:131], v[192:195], v[240:243], a[128:131]
v_mfma_f32_16x16x32_bf16 a[132:135], v[196:199], v[240:243], a[132:135]
v_mfma_f32_16x16x32_bf16 a[136:139], v[200:203], v[240:243], a[136:139]
v_mfma_f32_16x16x32_bf16 a[140:143], v[204:207], v[240:243], a[140:143]
s_add_u32 s72, s69, 46080
buffer_load_dwordx4 v5, s[4:7], s72 offen offset:3072 lds
v_mfma_f32_16x16x32_bf16 a[144:147], v[208:211], v[240:243], a[144:147]
v_mfma_f32_16x16x32_bf16 a[148:151], v[212:215], v[240:243], a[148:151]
v_mfma_f32_16x16x32_bf16 a[152:155], v[216:219], v[240:243], a[152:155]
v_mfma_f32_16x16x32_bf16 a[156:159], v[220:223], v[240:243], a[156:159]
v_mfma_f32_16x16x32_bf16 a[188:191], v[220:223], v[244:247], a[188:191]
s_add_u32 m0, s63, 135168
v_mfma_f32_16x16x32_bf16 a[184:187], v[216:219], v[244:247], a[184:187]
s_add_u32 s72, s70, 0
buffer_load_dwordx4 v4, s[4:7], s72 offen lds
v_mfma_f32_16x16x32_bf16 a[180:183], v[212:215], v[244:247], a[180:183]
v_mfma_f32_16x16x32_bf16 a[176:179], v[208:211], v[244:247], a[176:179]
v_mfma_f32_16x16x32_bf16 a[172:175], v[204:207], v[244:247], a[172:175]
v_mfma_f32_16x16x32_bf16 a[168:171], v[200:203], v[244:247], a[168:171]
s_add_u32 s72, s70, 15360
buffer_load_dwordx4 v5, s[4:7], s72 offen offset:1024 lds
v_mfma_f32_16x16x32_bf16 a[164:167], v[196:199], v[244:247], a[164:167]
v_mfma_f32_16x16x32_bf16 a[160:163], v[192:195], v[244:247], a[160:163]
v_mfma_f32_16x16x32_bf16 a[192:195], v[192:195], v[248:251], a[192:195]
v_mfma_f32_16x16x32_bf16 a[196:199], v[196:199], v[248:251], a[196:199]
v_mfma_f32_16x16x32_bf16 a[200:203], v[200:203], v[248:251], a[200:203]
s_add_u32 s72, s70, 30720
buffer_load_dwordx4 v4, s[4:7], s72 offen offset:2048 lds
v_mfma_f32_16x16x32_bf16 a[204:207], v[204:207], v[248:251], a[204:207]
v_mfma_f32_16x16x32_bf16 a[208:211], v[208:211], v[248:251], a[208:211]
v_mfma_f32_16x16x32_bf16 a[212:215], v[212:215], v[248:251], a[212:215]
v_mfma_f32_16x16x32_bf16 a[216:219], v[216:219], v[248:251], a[216:219]
v_mfma_f32_16x16x32_bf16 a[220:223], v[220:223], v[248:251], a[220:223]
s_add_u32 s72, s70, 46080
buffer_load_dwordx4 v5, s[4:7], s72 offen offset:3072 lds
v_mfma_f32_16x16x32_bf16 a[252:255], v[220:223], v[252:255], a[252:255]
v_mfma_f32_16x16x32_bf16 a[248:251], v[216:219], v[252:255], a[248:251]
v_mfma_f32_16x16x32_bf16 a[244:247], v[212:215], v[252:255], a[244:247]
v_mfma_f32_16x16x32_bf16 a[240:243], v[208:211], v[252:255], a[240:243]
v_mfma_f32_16x16x32_bf16 a[236:239], v[204:207], v[252:255], a[236:239]
s_add_u32 s73, s62, 1
v_mfma_f32_16x16x32_bf16 a[232:235], v[200:203], v[252:255], a[232:235]
s_add_u32 s70, s73, s65
v_mfma_f32_16x16x32_bf16 a[228:231], v[196:199], v[252:255], a[228:231]
s_and_b32 s70, s70, 3
v_mfma_f32_16x16x32_bf16 a[224:227], v[192:195], v[252:255], a[224:227]
s_waitcnt lgkmcnt(0)
v_mfma_f32_16x16x32_bf16 a[0:3], v[160:163], v[128:131], a[0:3]
s_and_b32 s73, s73, 12
ds_read_b64_tr_b16 v[224:225], v20 offset:40960
v_mfma_f32_16x16x32_bf16 a[4:7], v[160:163], v[132:135], a[4:7]
s_or_b32 s73, s73, s70
ds_read_b64_tr_b16 v[226:227], v20 offset:41984
v_mfma_f32_16x16x32_bf16 a[8:11], v[160:163], v[136:139], a[8:11]
s_lshl_b32 s71, s73, 19
ds_read_b128 v[192:195], v25 offset:32768
v_mfma_f32_16x16x32_bf16 a[12:15], v[160:163], v[140:143], a[12:15]
s_add_u32 s71, s71, s66
ds_read_b128 v[196:199], v25 offset:34816
v_mfma_f32_16x16x32_bf16 a[16:19], v[160:163], v[144:147], a[16:19]
s_lshl_b32 s73, s73, 7
ds_read_b128 v[200:203], v25 offset:36864
v_mfma_f32_16x16x32_bf16 a[20:23], v[160:163], v[148:151], a[20:23]
s_add_u32 s69, s73, s67
ds_read_b128 v[204:207], v25 offset:38912
v_mfma_f32_16x16x32_bf16 a[24:27], v[160:163], v[152:155], a[24:27]
s_add_u32 s70, s73, s68
ds_read_b128 v[208:211], v25 offset:40960
v_mfma_f32_16x16x32_bf16 a[28:31], v[160:163], v[156:159], a[28:31]
s_add_u32 m0, s64, 16384
ds_read_b128 v[212:215], v25 offset:43008
v_mfma_f32_16x16x32_bf16 a[60:63], v[164:167], v[156:159], a[60:63]
s_add_u32 s72, s71, 0
buffer_load_dwordx4 v6, s[12:15], s72 offen lds
v_mfma_f32_16x16x32_bf16 a[56:59], v[164:167], v[152:155], a[56:59]
s_add_u32 s72, s71, 31744
buffer_load_dwordx4 v6, s[12:15], s72 offen offset:1024 lds
v_mfma_f32_16x16x32_bf16 a[52:55], v[164:167], v[148:151], a[52:55]
s_add_u32 s72, s71, 63488
buffer_load_dwordx4 v7, s[12:15], s72 offen offset:2048 lds
v_mfma_f32_16x16x32_bf16 a[48:51], v[164:167], v[144:147], a[48:51]
s_add_u32 s72, s71, 95232
buffer_load_dwordx4 v7, s[12:15], s72 offen offset:3072 lds
v_mfma_f32_16x16x32_bf16 a[44:47], v[164:167], v[140:143], a[44:47]
ds_read_b128 v[216:219], v25 offset:45056
v_mfma_f32_16x16x32_bf16 a[40:43], v[164:167], v[136:139], a[40:43]
ds_read_b128 v[220:223], v25 offset:47104
v_mfma_f32_16x16x32_bf16 a[36:39], v[164:167], v[132:135], a[36:39]
ds_read_b64_tr_b16 v[228:229], v21 offset:40960
v_mfma_f32_16x16x32_bf16 a[32:35], v[164:167], v[128:131], a[32:35]
ds_read_b64_tr_b16 v[230:231], v21 offset:41984
v_mfma_f32_16x16x32_bf16 a[64:67], v[168:171], v[128:131], a[64:67]
s_add_u32 m0, s63, 65536
ds_read_b64_tr_b16 v[232:233], v22 offset:40960
v_mfma_f32_16x16x32_bf16 a[68:71], v[168:171], v[132:135], a[68:71]
s_add_u32 s72, s69, 0
buffer_load_dwordx4 v4, s[4:7], s72 offen lds
v_mfma_f32_16x16x32_bf16 a[72:75], v[168:171], v[136:139], a[72:75]
ds_read_b64_tr_b16 v[234:235], v22 offset:41984
v_mfma_f32_16x16x32_bf16 a[76:79], v[168:171], v[140:143], a[76:79]
ds_read_b64_tr_b16 v[236:237], v23 offset:40960
v_mfma_f32_16x16x32_bf16 a[80:83], v[168:171], v[144:147], a[80:83]
ds_read_b64_tr_b16 v[238:239], v23 offset:41984
v_mfma_f32_16x16x32_bf16 a[84:87], v[168:171], v[148:151], a[84:87]
s_add_u32 s72, s69, 15360
buffer_load_dwordx4 v5, s[4:7], s72 offen offset:1024 lds
v_mfma_f32_16x16x32_bf16 a[88:91], v[168:171], v[152:155], a[88:91]
ds_read_b64_tr_b16 v[240:241], v20 offset:57344
v_mfma_f32_16x16x32_bf16 a[92:95], v[168:171], v[156:159], a[92:95]
ds_read_b64_tr_b16 v[242:243], v20 offset:58368
v_mfma_f32_16x16x32_bf16 a[124:127], v[172:175], v[156:159], a[124:127]
ds_read_b64_tr_b16 v[244:245], v21 offset:57344
v_mfma_f32_16x16x32_bf16 a[120:123], v[172:175], v[152:155], a[120:123]
ds_read_b64_tr_b16 v[246:247], v21 offset:58368
v_mfma_f32_16x16x32_bf16 a[116:119], v[172:175], v[148:151], a[116:119]
s_add_u32 s72, s69, 30720
buffer_load_dwordx4 v4, s[4:7], s72 offen offset:2048 lds
v_mfma_f32_16x16x32_bf16 a[112:115], v[172:175], v[144:147], a[112:115]
ds_read_b64_tr_b16 v[248:249], v22 offset:57344
v_mfma_f32_16x16x32_bf16 a[108:111], v[172:175], v[140:143], a[108:111]
ds_read_b64_tr_b16 v[250:251], v22 offset:58368
v_mfma_f32_16x16x32_bf16 a[104:107], v[172:175], v[136:139], a[104:107]
ds_read_b64_tr_b16 v[252:253], v23 offset:57344
v_mfma_f32_16x16x32_bf16 a[100:103], v[172:175], v[132:135], a[100:103]
ds_read_b64_tr_b16 v[254:255], v23 offset:58368
v_mfma_f32_16x16x32_bf16 a[96:99], v[172:175], v[128:131], a[96:99]
s_add_u32 s72, s69, 46080
buffer_load_dwordx4 v5, s[4:7], s72 offen offset:3072 lds
v_mfma_f32_16x16x32_bf16 a[128:131], v[128:131], v[176:179], a[128:131]
v_mfma_f32_16x16x32_bf16 a[132:135], v[132:135], v[176:179], a[132:135]
v_mfma_f32_16x16x32_bf16 a[136:139], v[136:139], v[176:179], a[136:139]
v_mfma_f32_16x16x32_bf16 a[140:143], v[140:143], v[176:179], a[140:143]
v_mfma_f32_16x16x32_bf16 a[144:147], v[144:147], v[176:179], a[144:147]
s_add_u32 m0, s63, 69632
v_mfma_f32_16x16x32_bf16 a[148:151], v[148:151], v[176:179], a[148:151]
s_add_u32 s72, s70, 0
buffer_load_dwordx4 v4, s[4:7], s72 offen lds
v_mfma_f32_16x16x32_bf16 a[152:155], v[152:155], v[176:179], a[152:155]
v_mfma_f32_16x16x32_bf16 a[156:159], v[156:159], v[176:179], a[156:159]
v_mfma_f32_16x16x32_bf16 a[188:191], v[156:159], v[180:183], a[188:191]
v_mfma_f32_16x16x32_bf16 a[184:187], v[152:155], v[180:183], a[184:187]
s_add_u32 s72, s70, 15360
buffer_load_dwordx4 v5, s[4:7], s72 offen offset:1024 lds
v_mfma_f32_16x16x32_bf16 a[180:183], v[148:151], v[180:183], a[180:183]
v_mfma_f32_16x16x32_bf16 a[176:179], v[144:147], v[180:183], a[176:179]
v_mfma_f32_16x16x32_bf16 a[172:175], v[140:143], v[180:183], a[172:175]
v_mfma_f32_16x16x32_bf16 a[168:171], v[136:139], v[180:183], a[168:171]
v_mfma_f32_16x16x32_bf16 a[164:167], v[132:135], v[180:183], a[164:167]
s_add_u32 s72, s70, 30720
buffer_load_dwordx4 v4, s[4:7], s72 offen offset:2048 lds
v_mfma_f32_16x16x32_bf16 a[160:163], v[128:131], v[180:183], a[160:163]
v_mfma_f32_16x16x32_bf16 a[192:195], v[128:131], v[184:187], a[192:195]
v_mfma_f32_16x16x32_bf16 a[196:199], v[132:135], v[184:187], a[196:199]
v_mfma_f32_16x16x32_bf16 a[200:203], v[136:139], v[184:187], a[200:203]
v_mfma_f32_16x16x32_bf16 a[204:207], v[140:143], v[184:187], a[204:207]
s_add_u32 s72, s70, 46080
buffer_load_dwordx4 v5, s[4:7], s72 offen offset:3072 lds
v_mfma_f32_16x16x32_bf16 a[208:211], v[144:147], v[184:187], a[208:211]
v_mfma_f32_16x16x32_bf16 a[212:215], v[148:151], v[184:187], a[212:215]
v_mfma_f32_16x16x32_bf16 a[216:219], v[152:155], v[184:187], a[216:219]
v_mfma_f32_16x16x32_bf16 a[220:223], v[156:159], v[184:187], a[220:223]
v_mfma_f32_16x16x32_bf16 a[252:255], v[156:159], v[188:191], a[252:255]
v_mfma_f32_16x16x32_bf16 a[248:251], v[152:155], v[188:191], a[248:251]
v_mfma_f32_16x16x32_bf16 a[244:247], v[148:151], v[188:191], a[244:247]
v_mfma_f32_16x16x32_bf16 a[240:243], v[144:147], v[188:191], a[240:243]
v_mfma_f32_16x16x32_bf16 a[236:239], v[140:143], v[188:191], a[236:239]
v_mfma_f32_16x16x32_bf16 a[232:235], v[136:139], v[188:191], a[232:235]
v_mfma_f32_16x16x32_bf16 a[228:231], v[132:135], v[188:191], a[228:231]
s_waitcnt vmcnt(12) lgkmcnt(0)
v_mfma_f32_16x16x32_bf16 a[224:227], v[128:131], v[188:191], a[224:227]
s_barrier
LcB0:
v_mfma_f32_16x16x32_bf16 a[0:3], v[224:227], v[192:195], a[0:3]
s_add_u32 s73, s62, 2
ds_read_b64_tr_b16 v[32:33], v8 offset:0
v_mfma_f32_16x16x32_bf16 a[4:7], v[224:227], v[196:199], a[4:7]
s_add_u32 s70, s73, s65
ds_read_b64_tr_b16 v[34:35], v8 offset:1024
v_mfma_f32_16x16x32_bf16 a[8:11], v[224:227], v[200:203], a[8:11]
s_and_b32 s70, s70, 3
ds_read_b128 v[64:67], v16 offset:0
v_mfma_f32_16x16x32_bf16 a[12:15], v[224:227], v[204:207], a[12:15]
s_and_b32 s73, s73, 12
ds_read_b128 v[68:71], v16 offset:2048
v_mfma_f32_16x16x32_bf16 a[16:19], v[224:227], v[208:211], a[16:19]
s_or_b32 s73, s73, s70
ds_read_b128 v[72:75], v16 offset:4096
v_mfma_f32_16x16x32_bf16 a[20:23], v[224:227], v[212:215], a[20:23]
s_lshl_b32 s71, s73, 19
ds_read_b128 v[76:79], v16 offset:6144
v_mfma_f32_16x16x32_bf16 a[24:27], v[224:227], v[216:219], a[24:27]
s_add_u32 s71, s71, s66
ds_read_b64_tr_b16 v[36:37], v9 offset:0
v_mfma_f32_16x16x32_bf16 a[28:31], v[224:227], v[220:223], a[28:31]
s_lshl_b32 s73, s73, 7
ds_read_b64_tr_b16 v[38:39], v9 offset:1024
v_mfma_f32_16x16x32_bf16 a[60:63], v[228:231], v[220:223], a[60:63]
s_add_u32 s69, s73, s67
ds_read_b64_tr_b16 v[40:41], v10 offset:0
v_mfma_f32_16x16x32_bf16 a[56:59], v[228:231], v[216:219], a[56:59]
s_add_u32 s70, s73, s68
ds_read_b64_tr_b16 v[42:43], v10 offset:1024
v_mfma_f32_16x16x32_bf16 a[52:55], v[228:231], v[212:215], a[52:55]
s_add_u32 m0, s64, 32768
ds_read_b64_tr_b16 v[44:45], v11 offset:0
v_mfma_f32_16x16x32_bf16 a[48:51], v[228:231], v[208:211], a[48:51]
s_add_u32 s72, s71, 0
buffer_load_dwordx4 v6, s[12:15], s72 offen lds
v_mfma_f32_16x16x32_bf16 a[44:47], v[228:231], v[204:207], a[44:47]
s_add_u32 s72, s71, 31744
buffer_load_dwordx4 v6, s[12:15], s72 offen offset:1024 lds
v_mfma_f32_16x16x32_bf16 a[40:43], v[228:231], v[200:203], a[40:43]
s_add_u32 s72, s71, 63488
buffer_load_dwordx4 v7, s[12:15], s72 offen offset:2048 lds
v_mfma_f32_16x16x32_bf16 a[36:39], v[228:231], v[196:199], a[36:39]
s_lshl_b32 s80, s59, 2
ds_read_b64_tr_b16 v[46:47], v11 offset:1024
v_or_b32 v26, s58, v0
v_mfma_f32_16x16x32_bf16 a[32:35], v[228:231], v[192:195], a[32:35]
s_add_u32 s72, s71, 95232
buffer_load_dwordx4 v7, s[12:15], s72 offen offset:3072 lds
v_mfma_f32_16x16x32_bf16 a[64:67], v[232:235], v[192:195], a[64:67]
ds_read_b64_tr_b16 v[48:49], v12 offset:0
v_mov_b32 v27, 1
v_mfma_f32_16x16x32_bf16 a[68:71], v[232:235], v[196:199], a[68:71]
ds_read_b64_tr_b16 v[50:51], v12 offset:1024
v_lshlrev_b32 v26, 8, v26
v_mfma_f32_16x16x32_bf16 a[72:75], v[232:235], v[200:203], a[72:75]
ds_read_b64_tr_b16 v[52:53], v13 offset:0
v_mfma_f32_16x16x32_bf16 a[76:79], v[232:235], v[204:207], a[76:79]
ds_read_b64_tr_b16 v[54:55], v13 offset:1024
v_mfma_f32_16x16x32_bf16 a[80:83], v[232:235], v[208:211], a[80:83]
s_add_u32 m0, s63, 98304
ds_read_b64_tr_b16 v[56:57], v14 offset:0
v_mfma_f32_16x16x32_bf16 a[84:87], v[232:235], v[212:215], a[84:87]
s_add_u32 s72, s69, 0
buffer_load_dwordx4 v4, s[4:7], s72 offen lds
v_mfma_f32_16x16x32_bf16 a[88:91], v[232:235], v[216:219], a[88:91]
ds_read_b64_tr_b16 v[58:59], v14 offset:1024
v_mfma_f32_16x16x32_bf16 a[92:95], v[232:235], v[220:223], a[92:95]
ds_read_b64_tr_b16 v[60:61], v15 offset:0
v_mfma_f32_16x16x32_bf16 a[124:127], v[236:239], v[220:223], a[124:127]
ds_read_b64_tr_b16 v[62:63], v15 offset:1024
v_mfma_f32_16x16x32_bf16 a[120:123], v[236:239], v[216:219], a[120:123]
s_add_u32 s72, s69, 15360
buffer_load_dwordx4 v5, s[4:7], s72 offen offset:1024 lds
v_mfma_f32_16x16x32_bf16 a[116:119], v[236:239], v[212:215], a[116:119]
buffer_atomic_add v27, v26, s[48:51], s80 offen sc1
v_mfma_f32_16x16x32_bf16 a[112:115], v[236:239], v[208:211], a[112:115]
v_mfma_f32_16x16x32_bf16 a[108:111], v[236:239], v[204:207], a[108:111]
v_mfma_f32_16x16x32_bf16 a[104:107], v[236:239], v[200:203], a[104:107]
v_mfma_f32_16x16x32_bf16 a[100:103], v[236:239], v[196:199], a[100:103]
s_add_u32 s72, s69, 30720
buffer_load_dwordx4 v4, s[4:7], s72 offen offset:2048 lds
v_mfma_f32_16x16x32_bf16 a[96:99], v[236:239], v[192:195], a[96:99]
v_mfma_f32_16x16x32_bf16 a[128:131], v[192:195], v[240:243], a[128:131]
v_mfma_f32_16x16x32_bf16 a[132:135], v[196:199], v[240:243], a[132:135]
v_mfma_f32_16x16x32_bf16 a[136:139], v[200:203], v[240:243], a[136:139]
v_mfma_f32_16x16x32_bf16 a[140:143], v[204:207], v[240:243], a[140:143]
s_add_u32 s72, s69, 46080
buffer_load_dwordx4 v5, s[4:7], s72 offen offset:3072 lds
v_mfma_f32_16x16x32_bf16 a[144:147], v[208:211], v[240:243], a[144:147]
v_mfma_f32_16x16x32_bf16 a[148:151], v[212:215], v[240:243], a[148:151]
v_mfma_f32_16x16x32_bf16 a[152:155], v[216:219], v[240:243], a[152:155]
v_mfma_f32_16x16x32_bf16 a[156:159], v[220:223], v[240:243], a[156:159]
v_mfma_f32_16x16x32_bf16 a[188:191], v[220:223], v[244:247], a[188:191]
s_add_u32 m0, s63, 102400
v_mfma_f32_16x16x32_bf16 a[184:187], v[216:219], v[244:247], a[184:187]
s_add_u32 s72, s70, 0
buffer_load_dwordx4 v4, s[4:7], s72 offen lds
v_mfma_f32_16x16x32_bf16 a[180:183], v[212:215], v[244:247], a[180:183]
v_mfma_f32_16x16x32_bf16 a[176:179], v[208:211], v[244:247], a[176:179]
v_mfma_f32_16x16x32_bf16 a[172:175], v[204:207], v[244:247], a[172:175]
v_mfma_f32_16x16x32_bf16 a[168:171], v[200:203], v[244:247], a[168:171]
s_add_u32 s72, s70, 15360
buffer_load_dwordx4 v5, s[4:7], s72 offen offset:1024 lds
v_mfma_f32_16x16x32_bf16 a[164:167], v[196:199], v[244:247], a[164:167]
v_mfma_f32_16x16x32_bf16 a[160:163], v[192:195], v[244:247], a[160:163]
v_mfma_f32_16x16x32_bf16 a[192:195], v[192:195], v[248:251], a[192:195]
v_mfma_f32_16x16x32_bf16 a[196:199], v[196:199], v[248:251], a[196:199]
v_mfma_f32_16x16x32_bf16 a[200:203], v[200:203], v[248:251], a[200:203]
s_add_u32 s72, s70, 30720
buffer_load_dwordx4 v4, s[4:7], s72 offen offset:2048 lds
v_mfma_f32_16x16x32_bf16 a[204:207], v[204:207], v[248:251], a[204:207]
v_mfma_f32_16x16x32_bf16 a[208:211], v[208:211], v[248:251], a[208:211]
v_mfma_f32_16x16x32_bf16 a[212:215], v[212:215], v[248:251], a[212:215]
v_mfma_f32_16x16x32_bf16 a[216:219], v[216:219], v[248:251], a[216:219]
v_mfma_f32_16x16x32_bf16 a[220:223], v[220:223], v[248:251], a[220:223]
s_add_u32 s72, s70, 46080
buffer_load_dwordx4 v5, s[4:7], s72 offen offset:3072 lds
v_mfma_f32_16x16x32_bf16 a[252:255], v[220:223], v[252:255], a[252:255]
v_mfma_f32_16x16x32_bf16 a[248:251], v[216:219], v[252:255], a[248:251]
v_mfma_f32_16x16x32_bf16 a[244:247], v[212:215], v[252:255], a[244:247]
v_mfma_f32_16x16x32_bf16 a[240:243], v[208:211], v[252:255], a[240:243]
v_mfma_f32_16x16x32_bf16 a[236:239], v[204:207], v[252:255], a[236:239]
v_mfma_f32_16x16x32_bf16 a[232:235], v[200:203], v[252:255], a[232:235]
v_mfma_f32_16x16x32_bf16 a[228:231], v[196:199], v[252:255], a[228:231]
v_mfma_f32_16x16x32_bf16 a[224:227], v[192:195], v[252:255], a[224:227]
s_waitcnt lgkmcnt(0)
v_mfma_f32_16x16x32_bf16 v[128:131], v[32:35], v[64:67], 0
ds_read_b64_tr_b16 v[80:81], v8 offset:8192
ds_read_b64_tr_b16 v[82:83], v8 offset:9216
v_mfma_f32_16x16x32_bf16 v[132:135], v[32:35], v[68:71], 0
ds_read_b128 v[112:115], v17 offset:0
ds_read_b128 v[116:119], v17 offset:2048
v_mfma_f32_16x16x32_bf16 v[136:139], v[32:35], v[72:75], 0
ds_read_b128 v[120:123], v17 offset:4096
ds_read_b128 v[124:127], v17 offset:6144
v_mfma_f32_16x16x32_bf16 v[140:143], v[32:35], v[76:79], 0
ds_read_b64_tr_b16 v[84:85], v9 offset:8192
ds_read_b64_tr_b16 v[86:87], v9 offset:9216
v_mfma_f32_16x16x32_bf16 v[156:159], v[36:39], v[76:79], 0
ds_read_b64_tr_b16 v[88:89], v10 offset:8192
v_accvgpr_read_b32 v20, a0
v_mfma_f32_16x16x32_bf16 v[152:155], v[36:39], v[72:75], 0
ds_read_b64_tr_b16 v[90:91], v10 offset:9216
v_accvgpr_read_b32 v28, a1
v_mfma_f32_16x16x32_bf16 v[148:151], v[36:39], v[68:71], 0
ds_read_b64_tr_b16 v[92:93], v11 offset:8192
v_accvgpr_read_b32 v21, a2
v_mfma_f32_16x16x32_bf16 v[144:147], v[36:39], v[64:67], 0
ds_read_b64_tr_b16 v[94:95], v11 offset:9216
v_accvgpr_read_b32 v29, a3
v_mfma_f32_16x16x32_bf16 v[160:163], v[40:43], v[64:67], 0
s_add_u32 s80, s77, 0
ds_read_b64_tr_b16 v[96:97], v12 offset:8192
v_accvgpr_read_b32 v22, a32
v_mfma_f32_16x16x32_bf16 v[164:167], v[40:43], v[68:71], 0
ds_read_b64_tr_b16 v[98:99], v12 offset:9216
v_accvgpr_read_b32 v30, a33
v_mfma_f32_16x16x32_bf16 v[168:171], v[40:43], v[72:75], 0
ds_read_b64_tr_b16 v[100:101], v13 offset:8192
v_accvgpr_read_b32 v23, a34
v_mfma_f32_16x16x32_bf16 v[172:175], v[40:43], v[76:79], 0
ds_read_b64_tr_b16 v[102:103], v13 offset:9216
v_accvgpr_read_b32 v31, a35
v_mfma_f32_16x16x32_bf16 v[188:191], v[44:47], v[76:79], 0
ds_read_b64_tr_b16 v[104:105], v14 offset:8192
v_mul_f32 v20, s79, v20
v_mfma_f32_16x16x32_bf16 v[184:187], v[44:47], v[72:75], 0
ds_read_b64_tr_b16 v[106:107], v14 offset:9216
v_mul_f32 v28, s79, v28
v_mfma_f32_16x16x32_bf16 v[180:183], v[44:47], v[68:71], 0
ds_read_b64_tr_b16 v[108:109], v15 offset:8192
v_mul_f32 v21, s79, v21
v_mfma_f32_16x16x32_bf16 v[176:179], v[44:47], v[64:67], 0
ds_read_b64_tr_b16 v[110:111], v15 offset:9216
v_mul_f32 v29, s79, v29
v_mfma_f32_16x16x32_bf16 v[192:195], v[48:51], v[64:67], 0
v_mul_f32 v22, s79, v22
v_mul_f32 v30, s79, v30
v_mfma_f32_16x16x32_bf16 v[196:199], v[48:51], v[68:71], 0
v_mul_f32 v23, s79, v23
v_mul_f32 v31, s79, v31
v_mfma_f32_16x16x32_bf16 v[200:203], v[48:51], v[72:75], 0
v_cvt_pk_bf16_f32 v20, v20, v28
v_cvt_pk_bf16_f32 v21, v21, v29
v_mfma_f32_16x16x32_bf16 v[204:207], v[48:51], v[76:79], 0
v_cvt_pk_bf16_f32 v22, v22, v30
v_cvt_pk_bf16_f32 v23, v23, v31
v_mfma_f32_16x16x32_bf16 v[220:223], v[52:55], v[76:79], 0
buffer_store_dwordx4 v[20:23], v1, s[44:47], s80 offen sc1
v_mfma_f32_16x16x32_bf16 v[216:219], v[52:55], v[72:75], 0
v_mfma_f32_16x16x32_bf16 v[212:215], v[52:55], v[68:71], 0
v_mfma_f32_16x16x32_bf16 v[208:211], v[52:55], v[64:67], 0
v_mfma_f32_16x16x32_bf16 v[224:227], v[56:59], v[64:67], 0
v_mfma_f32_16x16x32_bf16 v[228:231], v[56:59], v[68:71], 0
v_accvgpr_read_b32 v24, a128
v_accvgpr_read_b32 v28, a129
v_mfma_f32_16x16x32_bf16 v[232:235], v[56:59], v[72:75], 0
v_accvgpr_read_b32 v25, a130
v_accvgpr_read_b32 v29, a131
v_mfma_f32_16x16x32_bf16 v[236:239], v[56:59], v[76:79], 0
s_add_u32 s80, s78, 0
v_accvgpr_read_b32 v26, a132
v_accvgpr_read_b32 v30, a133
v_mfma_f32_16x16x32_bf16 v[252:255], v[60:63], v[76:79], 0
v_accvgpr_read_b32 v27, a134
v_accvgpr_read_b32 v31, a135
v_mfma_f32_16x16x32_bf16 v[248:251], v[60:63], v[72:75], 0
v_cvt_pk_bf16_f32 v24, v24, v28
v_cvt_pk_bf16_f32 v25, v25, v29
v_mfma_f32_16x16x32_bf16 v[244:247], v[60:63], v[68:71], 0
s_waitcnt vmcnt(14) lgkmcnt(0)
v_cvt_pk_bf16_f32 v26, v26, v30
v_cvt_pk_bf16_f32 v27, v27, v31
v_mfma_f32_16x16x32_bf16 v[240:243], v[60:63], v[64:67], 0
s_barrier
buffer_store_dwordx4 v[24:27], v1, s[44:47], s80 offen sc1
v_mfma_f32_16x16x32_bf16 v[128:131], v[80:83], v[112:115], v[128:131]
s_add_u32 s73, s62, 3
ds_read_b64_tr_b16 v[32:33], v8 offset:16384
ds_read_b64_tr_b16 v[34:35], v8 offset:17408
v_mfma_f32_16x16x32_bf16 v[132:135], v[80:83], v[116:119], v[132:135]
s_add_u32 s70, s73, s65
ds_read_b128 v[64:67], v18 offset:0
ds_read_b128 v[68:71], v18 offset:2048
v_mfma_f32_16x16x32_bf16 v[136:139], v[80:83], v[120:123], v[136:139]
s_and_b32 s70, s70, 3
ds_read_b128 v[72:75], v18 offset:4096
ds_read_b128 v[76:79], v18 offset:6144
v_mfma_f32_16x16x32_bf16 v[140:143], v[80:83], v[124:127], v[140:143]
s_and_b32 s73, s73, 12
ds_read_b64_tr_b16 v[36:37], v9 offset:16384
ds_read_b64_tr_b16 v[38:39], v9 offset:17408
v_mfma_f32_16x16x32_bf16 v[156:159], v[84:87], v[124:127], v[156:159]
s_or_b32 s73, s73, s70
ds_read_b64_tr_b16 v[40:41], v10 offset:16384
v_mfma_f32_16x16x32_bf16 v[152:155], v[84:87], v[120:123], v[152:155]
s_lshl_b32 s71, s73, 19
ds_read_b64_tr_b16 v[42:43], v10 offset:17408
v_mfma_f32_16x16x32_bf16 v[148:151], v[84:87], v[116:119], v[148:151]
s_add_u32 s71, s71, s66
ds_read_b64_tr_b16 v[44:45], v11 offset:16384
v_mfma_f32_16x16x32_bf16 v[144:147], v[84:87], v[112:115], v[144:147]
s_lshl_b32 s73, s73, 7
ds_read_b64_tr_b16 v[46:47], v11 offset:17408
v_mfma_f32_16x16x32_bf16 v[160:163], v[88:91], v[112:115], v[160:163]
s_add_u32 s69, s73, s67
ds_read_b64_tr_b16 v[48:49], v12 offset:16384
v_mfma_f32_16x16x32_bf16 v[164:167], v[88:91], v[116:119], v[164:167]
s_add_u32 s70, s73, s68
ds_read_b64_tr_b16 v[50:51], v12 offset:17408
v_mfma_f32_16x16x32_bf16 v[168:171], v[88:91], v[120:123], v[168:171]
s_add_u32 m0, s64, 0
ds_read_b64_tr_b16 v[52:53], v13 offset:16384
v_mfma_f32_16x16x32_bf16 v[172:175], v[88:91], v[124:127], v[172:175]
s_add_u32 s72, s71, 0
buffer_load_dwordx4 v6, s[12:15], s72 offen lds
v_mfma_f32_16x16x32_bf16 v[188:191], v[92:95], v[124:127], v[188:191]
s_add_u32 s72, s71, 31744
buffer_load_dwordx4 v6, s[12:15], s72 offen offset:1024 lds
v_mfma_f32_16x16x32_bf16 v[184:187], v[92:95], v[120:123], v[184:187]
s_add_u32 s72, s71, 63488
buffer_load_dwordx4 v7, s[12:15], s72 offen offset:2048 lds
v_mfma_f32_16x16x32_bf16 v[180:183], v[92:95], v[116:119], v[180:183]
s_add_u32 s72, s71, 95232
buffer_load_dwordx4 v7, s[12:15], s72 offen offset:3072 lds
v_mfma_f32_16x16x32_bf16 v[176:179], v[92:95], v[112:115], v[176:179]
ds_read_b64_tr_b16 v[54:55], v13 offset:17408
v_mfma_f32_16x16x32_bf16 v[192:195], v[96:99], v[112:115], v[192:195]
ds_read_b64_tr_b16 v[56:57], v14 offset:16384
v_mfma_f32_16x16x32_bf16 v[196:199], v[96:99], v[116:119], v[196:199]
ds_read_b64_tr_b16 v[58:59], v14 offset:17408
v_accvgpr_read_b32 v20, a4
v_mfma_f32_16x16x32_bf16 v[200:203], v[96:99], v[120:123], v[200:203]
ds_read_b64_tr_b16 v[60:61], v15 offset:16384
v_accvgpr_read_b32 v28, a5
v_mfma_f32_16x16x32_bf16 v[204:207], v[96:99], v[124:127], v[204:207]
s_add_u32 m0, s63, 131072
ds_read_b64_tr_b16 v[62:63], v15 offset:17408
v_accvgpr_read_b32 v21, a6
v_mfma_f32_16x16x32_bf16 v[220:223], v[100:103], v[124:127], v[220:223]
s_add_u32 s72, s69, 0
buffer_load_dwordx4 v4, s[4:7], s72 offen lds
v_mfma_f32_16x16x32_bf16 v[216:219], v[100:103], v[120:123], v[216:219]
v_accvgpr_read_b32 v29, a7
v_mfma_f32_16x16x32_bf16 v[212:215], v[100:103], v[116:119], v[212:215]
s_add_u32 s80, s77, 4096
v_accvgpr_read_b32 v22, a36
v_accvgpr_read_b32 v30, a37
v_mfma_f32_16x16x32_bf16 v[208:211], v[100:103], v[112:115], v[208:211]
v_accvgpr_read_b32 v23, a38
v_accvgpr_read_b32 v31, a39
v_mfma_f32_16x16x32_bf16 v[224:227], v[104:107], v[112:115], v[224:227]
s_add_u32 s72, s69, 15360
buffer_load_dwordx4 v5, s[4:7], s72 offen offset:1024 lds
v_mfma_f32_16x16x32_bf16 v[228:231], v[104:107], v[116:119], v[228:231]
v_mul_f32 v20, s79, v20
v_mul_f32 v28, s79, v28
v_mfma_f32_16x16x32_bf16 v[232:235], v[104:107], v[120:123], v[232:235]
v_mul_f32 v21, s79, v21
v_mul_f32 v29, s79, v29
v_mfma_f32_16x16x32_bf16 v[236:239], v[104:107], v[124:127], v[236:239]
v_mul_f32 v22, s79, v22
v_mul_f32 v30, s79, v30
v_mfma_f32_16x16x32_bf16 v[252:255], v[108:111], v[124:127], v[252:255]
v_mul_f32 v23, s79, v23
v_mul_f32 v31, s79, v31
v_mfma_f32_16x16x32_bf16 v[248:251], v[108:111], v[120:123], v[248:251]
s_add_u32 s72, s69, 30720
buffer_load_dwordx4 v4, s[4:7], s72 offen offset:2048 lds
v_mfma_f32_16x16x32_bf16 v[244:247], v[108:111], v[116:119], v[244:247]
v_cvt_pk_bf16_f32 v20, v20, v28
v_cvt_pk_bf16_f32 v21, v21, v29
v_mfma_f32_16x16x32_bf16 v[240:243], v[108:111], v[112:115], v[240:243]
s_waitcnt lgkmcnt(0)
v_cvt_pk_bf16_f32 v22, v22, v30
v_cvt_pk_bf16_f32 v23, v23, v31
v_mfma_f32_16x16x32_bf16 v[128:131], v[32:35], v[64:67], v[128:131]
ds_read_b64_tr_b16 v[80:81], v8 offset:24576
ds_read_b64_tr_b16 v[82:83], v8 offset:25600
v_mfma_f32_16x16x32_bf16 v[132:135], v[32:35], v[68:71], v[132:135]
ds_read_b128 v[112:115], v19 offset:0
ds_read_b128 v[116:119], v19 offset:2048
v_mfma_f32_16x16x32_bf16 v[136:139], v[32:35], v[72:75], v[136:139]
s_add_u32 s72, s69, 46080
buffer_load_dwordx4 v5, s[4:7], s72 offen offset:3072 lds
v_mfma_f32_16x16x32_bf16 v[140:143], v[32:35], v[76:79], v[140:143]
ds_read_b128 v[120:123], v19 offset:4096
ds_read_b128 v[124:127], v19 offset:6144
v_mfma_f32_16x16x32_bf16 v[156:159], v[36:39], v[76:79], v[156:159]
ds_read_b64_tr_b16 v[84:85], v9 offset:24576
ds_read_b64_tr_b16 v[86:87], v9 offset:25600
v_mfma_f32_16x16x32_bf16 v[152:155], v[36:39], v[72:75], v[152:155]
ds_read_b64_tr_b16 v[88:89], v10 offset:24576
v_mfma_f32_16x16x32_bf16 v[148:151], v[36:39], v[68:71], v[148:151]
ds_read_b64_tr_b16 v[90:91], v10 offset:25600
v_mfma_f32_16x16x32_bf16 v[144:147], v[36:39], v[64:67], v[144:147]
s_add_u32 m0, s63, 135168
ds_read_b64_tr_b16 v[92:93], v11 offset:24576
v_mfma_f32_16x16x32_bf16 v[160:163], v[40:43], v[64:67], v[160:163]
s_add_u32 s72, s70, 0
buffer_load_dwordx4 v4, s[4:7], s72 offen lds
v_mfma_f32_16x16x32_bf16 v[164:167], v[40:43], v[68:71], v[164:167]
ds_read_b64_tr_b16 v[94:95], v11 offset:25600
v_mfma_f32_16x16x32_bf16 v[168:171], v[40:43], v[72:75], v[168:171]
ds_read_b64_tr_b16 v[96:97], v12 offset:24576
v_mfma_f32_16x16x32_bf16 v[172:175], v[40:43], v[76:79], v[172:175]
ds_read_b64_tr_b16 v[98:99], v12 offset:25600
v_mfma_f32_16x16x32_bf16 v[188:191], v[44:47], v[76:79], v[188:191]
s_add_u32 s72, s70, 15360
buffer_load_dwordx4 v5, s[4:7], s72 offen offset:1024 lds
v_mfma_f32_16x16x32_bf16 v[184:187], v[44:47], v[72:75], v[184:187]
ds_read_b64_tr_b16 v[100:101], v13 offset:24576
v_mfma_f32_16x16x32_bf16 v[180:183], v[44:47], v[68:71], v[180:183]
ds_read_b64_tr_b16 v[102:103], v13 offset:25600
v_mfma_f32_16x16x32_bf16 v[176:179], v[44:47], v[64:67], v[176:179]
ds_read_b64_tr_b16 v[104:105], v14 offset:24576
v_mfma_f32_16x16x32_bf16 v[192:195], v[48:51], v[64:67], v[192:195]
ds_read_b64_tr_b16 v[106:107], v14 offset:25600
v_mfma_f32_16x16x32_bf16 v[196:199], v[48:51], v[68:71], v[196:199]
s_add_u32 s72, s70, 30720
buffer_load_dwordx4 v4, s[4:7], s72 offen offset:2048 lds
v_mfma_f32_16x16x32_bf16 v[200:203], v[48:51], v[72:75], v[200:203]
ds_read_b64_tr_b16 v[108:109], v15 offset:24576
v_mfma_f32_16x16x32_bf16 v[204:207], v[48:51], v[76:79], v[204:207]
ds_read_b64_tr_b16 v[110:111], v15 offset:25600
v_mfma_f32_16x16x32_bf16 v[220:223], v[52:55], v[76:79], v[220:223]
buffer_store_dwordx4 v[20:23], v1, s[44:47], s80 offen sc1
v_mfma_f32_16x16x32_bf16 v[216:219], v[52:55], v[72:75], v[216:219]
v_accvgpr_read_b32 v24, a136
v_accvgpr_read_b32 v28, a137
v_mfma_f32_16x16x32_bf16 v[212:215], v[52:55], v[68:71], v[212:215]
s_add_u32 s72, s70, 46080
buffer_load_dwordx4 v5, s[4:7], s72 offen offset:3072 lds
v_mfma_f32_16x16x32_bf16 v[208:211], v[52:55], v[64:67], v[208:211]
v_accvgpr_read_b32 v25, a138
v_accvgpr_read_b32 v29, a139
v_mfma_f32_16x16x32_bf16 v[224:227], v[56:59], v[64:67], v[224:227]
s_add_u32 s80, s78, 8192
v_accvgpr_read_b32 v26, a140
v_accvgpr_read_b32 v30, a141
v_mfma_f32_16x16x32_bf16 v[228:231], v[56:59], v[68:71], v[228:231]
v_accvgpr_read_b32 v27, a142
v_accvgpr_read_b32 v31, a143
v_mfma_f32_16x16x32_bf16 v[232:235], v[56:59], v[72:75], v[232:235]
v_cvt_pk_bf16_f32 v24, v24, v28
v_cvt_pk_bf16_f32 v25, v25, v29
v_mfma_f32_16x16x32_bf16 v[236:239], v[56:59], v[76:79], v[236:239]
v_cvt_pk_bf16_f32 v26, v26, v30
v_cvt_pk_bf16_f32 v27, v27, v31
v_mfma_f32_16x16x32_bf16 v[252:255], v[60:63], v[76:79], v[252:255]
buffer_store_dwordx4 v[24:27], v1, s[44:47], s80 offen sc1
v_mfma_f32_16x16x32_bf16 v[248:251], v[60:63], v[72:75], v[248:251]
v_mfma_f32_16x16x32_bf16 v[244:247], v[60:63], v[68:71], v[244:247]
s_waitcnt vmcnt(16) lgkmcnt(0)
v_mfma_f32_16x16x32_bf16 v[240:243], v[60:63], v[64:67], v[240:243]
s_barrier
v_mfma_f32_16x16x32_bf16 v[128:131], v[80:83], v[112:115], v[128:131]
s_add_u32 s73, s62, 4
ds_read_b64_tr_b16 v[32:33], v8 offset:32768
ds_read_b64_tr_b16 v[34:35], v8 offset:33792
v_mfma_f32_16x16x32_bf16 v[132:135], v[80:83], v[116:119], v[132:135]
s_add_u32 s70, s73, s65
ds_read_b128 v[64:67], v18 offset:32768
ds_read_b128 v[68:71], v18 offset:34816
v_mfma_f32_16x16x32_bf16 v[136:139], v[80:83], v[120:123], v[136:139]
s_and_b32 s70, s70, 3
ds_read_b128 v[72:75], v18 offset:36864
ds_read_b128 v[76:79], v18 offset:38912
v_mfma_f32_16x16x32_bf16 v[140:143], v[80:83], v[124:127], v[140:143]
s_and_b32 s73, s73, 12
ds_read_b64_tr_b16 v[36:37], v9 offset:32768
ds_read_b64_tr_b16 v[38:39], v9 offset:33792
v_mfma_f32_16x16x32_bf16 v[156:159], v[84:87], v[124:127], v[156:159]
s_or_b32 s73, s73, s70
ds_read_b64_tr_b16 v[40:41], v10 offset:32768
v_accvgpr_read_b32 v20, a8
v_mfma_f32_16x16x32_bf16 v[152:155], v[84:87], v[120:123], v[152:155]
s_lshl_b32 s71, s73, 19
ds_read_b64_tr_b16 v[42:43], v10 offset:33792
v_accvgpr_read_b32 v28, a9
v_mfma_f32_16x16x32_bf16 v[148:151], v[84:87], v[116:119], v[148:151]
s_add_u32 s71, s71, s66
ds_read_b64_tr_b16 v[44:45], v11 offset:32768
v_accvgpr_read_b32 v21, a10
v_mfma_f32_16x16x32_bf16 v[144:147], v[84:87], v[112:115], v[144:147]
s_lshl_b32 s73, s73, 7
ds_read_b64_tr_b16 v[46:47], v11 offset:33792
v_accvgpr_read_b32 v29, a11
v_mfma_f32_16x16x32_bf16 v[160:163], v[88:91], v[112:115], v[160:163]
s_add_u32 s69, s73, s67
ds_read_b64_tr_b16 v[48:49], v12 offset:32768
v_mfma_f32_16x16x32_bf16 v[164:167], v[88:91], v[116:119], v[164:167]
s_add_u32 s70, s73, s68
ds_read_b64_tr_b16 v[50:51], v12 offset:33792
v_mfma_f32_16x16x32_bf16 v[168:171], v[88:91], v[120:123], v[168:171]
s_add_u32 m0, s64, 16384
ds_read_b64_tr_b16 v[52:53], v13 offset:32768
v_mfma_f32_16x16x32_bf16 v[172:175], v[88:91], v[124:127], v[172:175]
s_add_u32 s72, s71, 0
buffer_load_dwordx4 v6, s[12:15], s72 offen lds
v_mfma_f32_16x16x32_bf16 v[188:191], v[92:95], v[124:127], v[188:191]
s_add_u32 s72, s71, 31744
buffer_load_dwordx4 v6, s[12:15], s72 offen offset:1024 lds
v_mfma_f32_16x16x32_bf16 v[184:187], v[92:95], v[120:123], v[184:187]
s_add_u32 s72, s71, 63488
buffer_load_dwordx4 v7, s[12:15], s72 offen offset:2048 lds
v_mfma_f32_16x16x32_bf16 v[180:183], v[92:95], v[116:119], v[180:183]
s_add_u32 s72, s71, 95232
buffer_load_dwordx4 v7, s[12:15], s72 offen offset:3072 lds
v_mfma_f32_16x16x32_bf16 v[176:179], v[92:95], v[112:115], v[176:179]
s_add_u32 s80, s77, 8192
ds_read_b64_tr_b16 v[54:55], v13 offset:33792
v_accvgpr_read_b32 v22, a40
v_mfma_f32_16x16x32_bf16 v[192:195], v[96:99], v[112:115], v[192:195]
ds_read_b64_tr_b16 v[56:57], v14 offset:32768
v_accvgpr_read_b32 v30, a41
v_mfma_f32_16x16x32_bf16 v[196:199], v[96:99], v[116:119], v[196:199]
ds_read_b64_tr_b16 v[58:59], v14 offset:33792
v_accvgpr_read_b32 v23, a42
v_mfma_f32_16x16x32_bf16 v[200:203], v[96:99], v[120:123], v[200:203]
ds_read_b64_tr_b16 v[60:61], v15 offset:32768
v_accvgpr_read_b32 v31, a43
v_mfma_f32_16x16x32_bf16 v[204:207], v[96:99], v[124:127], v[204:207]
s_add_u32 m0, s63, 65536
ds_read_b64_tr_b16 v[62:63], v15 offset:33792
v_mul_f32 v20, s79, v20
v_mfma_f32_16x16x32_bf16 v[220:223], v[100:103], v[124:127], v[220:223]
s_add_u32 s72, s69, 0
buffer_load_dwordx4 v4, s[4:7], s72 offen lds
v_mfma_f32_16x16x32_bf16 v[216:219], v[100:103], v[120:123], v[216:219]
v_mul_f32 v28, s79, v28
v_mul_f32 v21, s79, v21
v_mfma_f32_16x16x32_bf16 v[212:215], v[100:103], v[116:119], v[212:215]
v_mul_f32 v29, s79, v29
v_mul_f32 v22, s79, v22
v_mfma_f32_16x16x32_bf16 v[208:211], v[100:103], v[112:115], v[208:211]
v_mul_f32 v30, s79, v30
v_mul_f32 v23, s79, v23
v_mfma_f32_16x16x32_bf16 v[224:227], v[104:107], v[112:115], v[224:227]
s_add_u32 s72, s69, 15360
buffer_load_dwordx4 v5, s[4:7], s72 offen offset:1024 lds
v_mfma_f32_16x16x32_bf16 v[228:231], v[104:107], v[116:119], v[228:231]
v_mul_f32 v31, s79, v31
v_cvt_pk_bf16_f32 v20, v20, v28
v_mfma_f32_16x16x32_bf16 v[232:235], v[104:107], v[120:123], v[232:235]
v_cvt_pk_bf16_f32 v21, v21, v29
v_cvt_pk_bf16_f32 v22, v22, v30
v_mfma_f32_16x16x32_bf16 v[236:239], v[104:107], v[124:127], v[236:239]
v_cvt_pk_bf16_f32 v23, v23, v31
v_mfma_f32_16x16x32_bf16 v[252:255], v[108:111], v[124:127], v[252:255]
buffer_store_dwordx4 v[20:23], v1, s[44:47], s80 offen sc1
v_mfma_f32_16x16x32_bf16 v[248:251], v[108:111], v[120:123], v[248:251]
s_add_u32 s72, s69, 30720
buffer_load_dwordx4 v4, s[4:7], s72 offen offset:2048 lds
v_mfma_f32_16x16x32_bf16 v[244:247], v[108:111], v[116:119], v[244:247]
v_accvgpr_read_b32 v24, a144
v_accvgpr_read_b32 v28, a145
v_mfma_f32_16x16x32_bf16 v[240:243], v[108:111], v[112:115], v[240:243]
s_waitcnt lgkmcnt(0)
v_accvgpr_read_b32 v25, a146
v_accvgpr_read_b32 v29, a147
v_mfma_f32_16x16x32_bf16 v[128:131], v[32:35], v[64:67], v[128:131]
s_add_u32 s80, s78, 32768
ds_read_b64_tr_b16 v[80:81], v8 offset:40960
ds_read_b64_tr_b16 v[82:83], v8 offset:41984
v_mfma_f32_16x16x32_bf16 v[132:135], v[32:35], v[68:71], v[132:135]
ds_read_b128 v[112:115], v19 offset:32768
ds_read_b128 v[116:119], v19 offset:34816
v_mfma_f32_16x16x32_bf16 v[136:139], v[32:35], v[72:75], v[136:139]
s_add_u32 s72, s69, 46080
buffer_load_dwordx4 v5, s[4:7], s72 offen offset:3072 lds
v_mfma_f32_16x16x32_bf16 v[140:143], v[32:35], v[76:79], v[140:143]
ds_read_b128 v[120:123], v19 offset:36864
ds_read_b128 v[124:127], v19 offset:38912
v_mfma_f32_16x16x32_bf16 v[156:159], v[36:39], v[76:79], v[156:159]
ds_read_b64_tr_b16 v[84:85], v9 offset:40960
ds_read_b64_tr_b16 v[86:87], v9 offset:41984
v_mfma_f32_16x16x32_bf16 v[152:155], v[36:39], v[72:75], v[152:155]
ds_read_b64_tr_b16 v[88:89], v10 offset:40960
v_accvgpr_read_b32 v26, a148
v_mfma_f32_16x16x32_bf16 v[148:151], v[36:39], v[68:71], v[148:151]
ds_read_b64_tr_b16 v[90:91], v10 offset:41984
v_accvgpr_read_b32 v30, a149
v_mfma_f32_16x16x32_bf16 v[144:147], v[36:39], v[64:67], v[144:147]
s_add_u32 m0, s63, 69632
ds_read_b64_tr_b16 v[92:93], v11 offset:40960
v_accvgpr_read_b32 v27, a150
v_mfma_f32_16x16x32_bf16 v[160:163], v[40:43], v[64:67], v[160:163]
s_add_u32 s72, s70, 0
buffer_load_dwordx4 v4, s[4:7], s72 offen lds
v_mfma_f32_16x16x32_bf16 v[164:167], v[40:43], v[68:71], v[164:167]
ds_read_b64_tr_b16 v[94:95], v11 offset:41984
v_accvgpr_read_b32 v31, a151
v_mfma_f32_16x16x32_bf16 v[168:171], v[40:43], v[72:75], v[168:171]
ds_read_b64_tr_b16 v[96:97], v12 offset:40960
v_cvt_pk_bf16_f32 v24, v24, v28
v_mfma_f32_16x16x32_bf16 v[172:175], v[40:43], v[76:79], v[172:175]
ds_read_b64_tr_b16 v[98:99], v12 offset:41984
v_cvt_pk_bf16_f32 v25, v25, v29
v_mfma_f32_16x16x32_bf16 v[188:191], v[44:47], v[76:79], v[188:191]
s_add_u32 s72, s70, 15360
buffer_load_dwordx4 v5, s[4:7], s72 offen offset:1024 lds
v_mfma_f32_16x16x32_bf16 v[184:187], v[44:47], v[72:75], v[184:187]
ds_read_b64_tr_b16 v[100:101], v13 offset:40960
v_cvt_pk_bf16_f32 v26, v26, v30
v_mfma_f32_16x16x32_bf16 v[180:183], v[44:47], v[68:71], v[180:183]
ds_read_b64_tr_b16 v[102:103], v13 offset:41984
v_cvt_pk_bf16_f32 v27, v27, v31
v_mfma_f32_16x16x32_bf16 v[176:179], v[44:47], v[64:67], v[176:179]
ds_read_b64_tr_b16 v[104:105], v14 offset:40960
v_mfma_f32_16x16x32_bf16 v[192:195], v[48:51], v[64:67], v[192:195]
ds_read_b64_tr_b16 v[106:107], v14 offset:41984
v_mfma_f32_16x16x32_bf16 v[196:199], v[48:51], v[68:71], v[196:199]
s_add_u32 s72, s70, 30720
buffer_load_dwordx4 v4, s[4:7], s72 offen offset:2048 lds
v_mfma_f32_16x16x32_bf16 v[200:203], v[48:51], v[72:75], v[200:203]
ds_read_b64_tr_b16 v[108:109], v15 offset:40960
v_mfma_f32_16x16x32_bf16 v[204:207], v[48:51], v[76:79], v[204:207]
ds_read_b64_tr_b16 v[110:111], v15 offset:41984
v_mfma_f32_16x16x32_bf16 v[220:223], v[52:55], v[76:79], v[220:223]
buffer_store_dwordx4 v[24:27], v1, s[44:47], s80 offen sc1
v_mfma_f32_16x16x32_bf16 v[216:219], v[52:55], v[72:75], v[216:219]
v_accvgpr_read_b32 v20, a12
v_accvgpr_read_b32 v28, a13
v_mfma_f32_16x16x32_bf16 v[212:215], v[52:55], v[68:71], v[212:215]
s_add_u32 s72, s70, 46080
buffer_load_dwordx4 v5, s[4:7], s72 offen offset:3072 lds
v_mfma_f32_16x16x32_bf16 v[208:211], v[52:55], v[64:67], v[208:211]
v_accvgpr_read_b32 v21, a14
v_accvgpr_read_b32 v29, a15
v_mfma_f32_16x16x32_bf16 v[224:227], v[56:59], v[64:67], v[224:227]
s_add_u32 s80, s77, 12288
v_accvgpr_read_b32 v22, a44
v_accvgpr_read_b32 v30, a45
v_mfma_f32_16x16x32_bf16 v[228:231], v[56:59], v[68:71], v[228:231]
v_accvgpr_read_b32 v23, a46
v_accvgpr_read_b32 v31, a47
v_mfma_f32_16x16x32_bf16 v[232:235], v[56:59], v[72:75], v[232:235]
v_mul_f32 v20, s79, v20
v_mul_f32 v28, s79, v28
v_mfma_f32_16x16x32_bf16 v[236:239], v[56:59], v[76:79], v[236:239]
v_mul_f32 v21, s79, v21
v_mul_f32 v29, s79, v29
v_mfma_f32_16x16x32_bf16 v[252:255], v[60:63], v[76:79], v[252:255]
v_mul_f32 v22, s79, v22
v_mul_f32 v30, s79, v30
v_mfma_f32_16x16x32_bf16 v[248:251], v[60:63], v[72:75], v[248:251]
v_mul_f32 v23, s79, v23
v_mul_f32 v31, s79, v31
v_mfma_f32_16x16x32_bf16 v[244:247], v[60:63], v[68:71], v[244:247]
s_waitcnt vmcnt(15) lgkmcnt(0)
v_cvt_pk_bf16_f32 v20, v20, v28
v_cvt_pk_bf16_f32 v21, v21, v29
v_mfma_f32_16x16x32_bf16 v[240:243], v[60:63], v[64:67], v[240:243]
s_barrier
v_cvt_pk_bf16_f32 v22, v22, v30
v_cvt_pk_bf16_f32 v23, v23, v31
v_mfma_f32_16x16x32_bf16 v[128:131], v[80:83], v[112:115], v[128:131]
s_add_u32 s73, s62, 5
ds_read_b64_tr_b16 v[32:33], v8 offset:0
ds_read_b64_tr_b16 v[34:35], v8 offset:1024
v_mfma_f32_16x16x32_bf16 v[132:135], v[80:83], v[116:119], v[132:135]
s_add_u32 s70, s73, s65
ds_read_b128 v[64:67], v16 offset:0
ds_read_b128 v[68:71], v16 offset:2048
v_mfma_f32_16x16x32_bf16 v[136:139], v[80:83], v[120:123], v[136:139]
s_and_b32 s70, s70, 3
ds_read_b128 v[72:75], v16 offset:4096
ds_read_b128 v[76:79], v16 offset:6144
v_mfma_f32_16x16x32_bf16 v[140:143], v[80:83], v[124:127], v[140:143]
s_and_b32 s73, s73, 12
ds_read_b64_tr_b16 v[36:37], v9 offset:0
ds_read_b64_tr_b16 v[38:39], v9 offset:1024
v_mfma_f32_16x16x32_bf16 v[156:159], v[84:87], v[124:127], v[156:159]
s_or_b32 s73, s73, s70
ds_read_b64_tr_b16 v[40:41], v10 offset:0
v_mfma_f32_16x16x32_bf16 v[152:155], v[84:87], v[120:123], v[152:155]
s_lshl_b32 s71, s73, 19
ds_read_b64_tr_b16 v[42:43], v10 offset:1024
v_mfma_f32_16x16x32_bf16 v[148:151], v[84:87], v[116:119], v[148:151]
s_add_u32 s71, s71, s66
ds_read_b64_tr_b16 v[44:45], v11 offset:0
v_mfma_f32_16x16x32_bf16 v[144:147], v[84:87], v[112:115], v[144:147]
s_lshl_b32 s73, s73, 7
ds_read_b64_tr_b16 v[46:47], v11 offset:1024
v_mfma_f32_16x16x32_bf16 v[160:163], v[88:91], v[112:115], v[160:163]
s_add_u32 s69, s73, s67
ds_read_b64_tr_b16 v[48:49], v12 offset:0
v_mfma_f32_16x16x32_bf16 v[164:167], v[88:91], v[116:119], v[164:167]
s_add_u32 s70, s73, s68
ds_read_b64_tr_b16 v[50:51], v12 offset:1024
v_mfma_f32_16x16x32_bf16 v[168:171], v[88:91], v[120:123], v[168:171]
s_add_u32 m0, s64, 32768
ds_read_b64_tr_b16 v[52:53], v13 offset:0
v_mfma_f32_16x16x32_bf16 v[172:175], v[88:91], v[124:127], v[172:175]
s_add_u32 s72, s71, 0
buffer_load_dwordx4 v6, s[12:15], s72 offen lds
v_mfma_f32_16x16x32_bf16 v[188:191], v[92:95], v[124:127], v[188:191]
s_add_u32 s72, s71, 31744
buffer_load_dwordx4 v6, s[12:15], s72 offen offset:1024 lds
v_mfma_f32_16x16x32_bf16 v[184:187], v[92:95], v[120:123], v[184:187]
s_add_u32 s72, s71, 63488
buffer_load_dwordx4 v7, s[12:15], s72 offen offset:2048 lds
v_mfma_f32_16x16x32_bf16 v[180:183], v[92:95], v[116:119], v[180:183]
s_add_u32 s72, s71, 95232
buffer_load_dwordx4 v7, s[12:15], s72 offen offset:3072 lds
v_mfma_f32_16x16x32_bf16 v[176:179], v[92:95], v[112:115], v[176:179]
ds_read_b64_tr_b16 v[54:55], v13 offset:1024
v_mfma_f32_16x16x32_bf16 v[192:195], v[96:99], v[112:115], v[192:195]
ds_read_b64_tr_b16 v[56:57], v14 offset:0
v_mfma_f32_16x16x32_bf16 v[196:199], v[96:99], v[116:119], v[196:199]
ds_read_b64_tr_b16 v[58:59], v14 offset:1024
v_mfma_f32_16x16x32_bf16 v[200:203], v[96:99], v[120:123], v[200:203]
ds_read_b64_tr_b16 v[60:61], v15 offset:0
v_mfma_f32_16x16x32_bf16 v[204:207], v[96:99], v[124:127], v[204:207]
s_add_u32 m0, s63, 98304
ds_read_b64_tr_b16 v[62:63], v15 offset:1024
v_mfma_f32_16x16x32_bf16 v[220:223], v[100:103], v[124:127], v[220:223]
s_add_u32 s72, s69, 0
buffer_load_dwordx4 v4, s[4:7], s72 offen lds
v_mfma_f32_16x16x32_bf16 v[216:219], v[100:103], v[120:123], v[216:219]
buffer_store_dwordx4 v[20:23], v1, s[44:47], s80 offen sc1
v_mfma_f32_16x16x32_bf16 v[212:215], v[100:103], v[116:119], v[212:215]
v_accvgpr_read_b32 v24, a152
v_accvgpr_read_b32 v28, a153
v_mfma_f32_16x16x32_bf16 v[208:211], v[100:103], v[112:115], v[208:211]
v_accvgpr_read_b32 v25, a154
v_accvgpr_read_b32 v29, a155
v_mfma_f32_16x16x32_bf16 v[224:227], v[104:107], v[112:115], v[224:227]
s_add_u32 s72, s69, 15360
buffer_load_dwordx4 v5, s[4:7], s72 offen offset:1024 lds
v_mfma_f32_16x16x32_bf16 v[228:231], v[104:107], v[116:119], v[228:231]
s_add_u32 s80, s78, 40960
v_accvgpr_read_b32 v26, a156
v_accvgpr_read_b32 v30, a157
v_mfma_f32_16x16x32_bf16 v[232:235], v[104:107], v[120:123], v[232:235]
v_accvgpr_read_b32 v27, a158
v_accvgpr_read_b32 v31, a159
v_mfma_f32_16x16x32_bf16 v[236:239], v[104:107], v[124:127], v[236:239]
v_cvt_pk_bf16_f32 v24, v24, v28
v_cvt_pk_bf16_f32 v25, v25, v29
v_mfma_f32_16x16x32_bf16 v[252:255], v[108:111], v[124:127], v[252:255]
v_cvt_pk_bf16_f32 v26, v26, v30
v_cvt_pk_bf16_f32 v27, v27, v31
v_mfma_f32_16x16x32_bf16 v[248:251], v[108:111], v[120:123], v[248:251]
s_add_u32 s72, s69, 30720
buffer_load_dwordx4 v4, s[4:7], s72 offen offset:2048 lds
v_mfma_f32_16x16x32_bf16 v[244:247], v[108:111], v[116:119], v[244:247]
buffer_store_dwordx4 v[24:27], v1, s[44:47], s80 offen sc1
v_mfma_f32_16x16x32_bf16 v[240:243], v[108:111], v[112:115], v[240:243]
s_waitcnt lgkmcnt(0)
v_mfma_f32_16x16x32_bf16 v[128:131], v[32:35], v[64:67], v[128:131]
ds_read_b64_tr_b16 v[80:81], v8 offset:8192
ds_read_b64_tr_b16 v[82:83], v8 offset:9216
v_mfma_f32_16x16x32_bf16 v[132:135], v[32:35], v[68:71], v[132:135]
ds_read_b128 v[112:115], v17 offset:0
ds_read_b128 v[116:119], v17 offset:2048
v_mfma_f32_16x16x32_bf16 v[136:139], v[32:35], v[72:75], v[136:139]
s_add_u32 s72, s69, 46080
buffer_load_dwordx4 v5, s[4:7], s72 offen offset:3072 lds
v_mfma_f32_16x16x32_bf16 v[140:143], v[32:35], v[76:79], v[140:143]
ds_read_b128 v[120:123], v17 offset:4096
ds_read_b128 v[124:127], v17 offset:6144
v_mfma_f32_16x16x32_bf16 v[156:159], v[36:39], v[76:79], v[156:159]
ds_read_b64_tr_b16 v[84:85], v9 offset:8192
ds_read_b64_tr_b16 v[86:87], v9 offset:9216
v_mfma_f32_16x16x32_bf16 v[152:155], v[36:39], v[72:75], v[152:155]
ds_read_b64_tr_b16 v[88:89], v10 offset:8192
v_accvgpr_read_b32 v20, a16
v_mfma_f32_16x16x32_bf16 v[148:151], v[36:39], v[68:71], v[148:151]
ds_read_b64_tr_b16 v[90:91], v10 offset:9216
v_accvgpr_read_b32 v28, a17
v_mfma_f32_16x16x32_bf16 v[144:147], v[36:39], v[64:67], v[144:147]
s_add_u32 m0, s63, 102400
ds_read_b64_tr_b16 v[92:93], v11 offset:8192
v_accvgpr_read_b32 v21, a18
v_mfma_f32_16x16x32_bf16 v[160:163], v[40:43], v[64:67], v[160:163]
s_add_u32 s72, s70, 0
buffer_load_dwordx4 v4, s[4:7], s72 offen lds
v_mfma_f32_16x16x32_bf16 v[164:167], v[40:43], v[68:71], v[164:167]
ds_read_b64_tr_b16 v[94:95], v11 offset:9216
v_accvgpr_read_b32 v29, a19
v_mfma_f32_16x16x32_bf16 v[168:171], v[40:43], v[72:75], v[168:171]
s_add_u32 s80, s77, 32768
ds_read_b64_tr_b16 v[96:97], v12 offset:8192
v_accvgpr_read_b32 v22, a48
v_mfma_f32_16x16x32_bf16 v[172:175], v[40:43], v[76:79], v[172:175]
ds_read_b64_tr_b16 v[98:99], v12 offset:9216
v_accvgpr_read_b32 v30, a49
v_mfma_f32_16x16x32_bf16 v[188:191], v[44:47], v[76:79], v[188:191]
s_add_u32 s72, s70, 15360
buffer_load_dwordx4 v5, s[4:7], s72 offen offset:1024 lds
v_mfma_f32_16x16x32_bf16 v[184:187], v[44:47], v[72:75], v[184:187]
ds_read_b64_tr_b16 v[100:101], v13 offset:8192
v_accvgpr_read_b32 v23, a50
v_mfma_f32_16x16x32_bf16 v[180:183], v[44:47], v[68:71], v[180:183]
ds_read_b64_tr_b16 v[102:103], v13 offset:9216
v_accvgpr_read_b32 v31, a51
v_mfma_f32_16x16x32_bf16 v[176:179], v[44:47], v[64:67], v[176:179]
ds_read_b64_tr_b16 v[104:105], v14 offset:8192
v_mul_f32 v20, s79, v20
v_mfma_f32_16x16x32_bf16 v[192:195], v[48:51], v[64:67], v[192:195]
ds_read_b64_tr_b16 v[106:107], v14 offset:9216
v_mul_f32 v28, s79, v28
v_mfma_f32_16x16x32_bf16 v[196:199], v[48:51], v[68:71], v[196:199]
s_add_u32 s72, s70, 30720
buffer_load_dwordx4 v4, s[4:7], s72 offen offset:2048 lds
v_mfma_f32_16x16x32_bf16 v[200:203], v[48:51], v[72:75], v[200:203]
ds_read_b64_tr_b16 v[108:109], v15 offset:8192
v_mul_f32 v21, s79, v21
v_mfma_f32_16x16x32_bf16 v[204:207], v[48:51], v[76:79], v[204:207]
ds_read_b64_tr_b16 v[110:111], v15 offset:9216
v_mul_f32 v29, s79, v29
v_mfma_f32_16x16x32_bf16 v[220:223], v[52:55], v[76:79], v[220:223]
v_mul_f32 v22, s79, v22
v_mul_f32 v30, s79, v30
v_mfma_f32_16x16x32_bf16 v[216:219], v[52:55], v[72:75], v[216:219]
v_mul_f32 v23, s79, v23
v_mul_f32 v31, s79, v31
v_mfma_f32_16x16x32_bf16 v[212:215], v[52:55], v[68:71], v[212:215]
s_add_u32 s72, s70, 46080
buffer_load_dwordx4 v5, s[4:7], s72 offen offset:3072 lds
v_mfma_f32_16x16x32_bf16 v[208:211], v[52:55], v[64:67], v[208:211]
v_cvt_pk_bf16_f32 v20, v20, v28
v_cvt_pk_bf16_f32 v21, v21, v29
v_mfma_f32_16x16x32_bf16 v[224:227], v[56:59], v[64:67], v[224:227]
v_cvt_pk_bf16_f32 v22, v22, v30
v_cvt_pk_bf16_f32 v23, v23, v31
v_mfma_f32_16x16x32_bf16 v[228:231], v[56:59], v[68:71], v[228:231]
buffer_store_dwordx4 v[20:23], v1, s[44:47], s80 offen sc1
v_mfma_f32_16x16x32_bf16 v[232:235], v[56:59], v[72:75], v[232:235]
v_accvgpr_read_b32 v24, a160
v_accvgpr_read_b32 v28, a161
v_mfma_f32_16x16x32_bf16 v[236:239], v[56:59], v[76:79], v[236:239]
v_accvgpr_read_b32 v25, a162
v_accvgpr_read_b32 v29, a163
v_mfma_f32_16x16x32_bf16 v[252:255], v[60:63], v[76:79], v[252:255]
s_add_u32 s80, s78, 1024
v_accvgpr_read_b32 v26, a164
v_accvgpr_read_b32 v30, a165
v_mfma_f32_16x16x32_bf16 v[248:251], v[60:63], v[72:75], v[248:251]
v_accvgpr_read_b32 v27, a166
v_accvgpr_read_b32 v31, a167
v_mfma_f32_16x16x32_bf16 v[244:247], v[60:63], v[68:71], v[244:247]
s_waitcnt vmcnt(15) lgkmcnt(0)
v_cvt_pk_bf16_f32 v24, v24, v28
v_cvt_pk_bf16_f32 v25, v25, v29
v_mfma_f32_16x16x32_bf16 v[240:243], v[60:63], v[64:67], v[240:243]
s_barrier
v_cvt_pk_bf16_f32 v26, v26, v30
v_cvt_pk_bf16_f32 v27, v27, v31
v_mfma_f32_16x16x32_bf16 v[128:131], v[80:83], v[112:115], v[128:131]
s_add_u32 s73, s62, 6
ds_read_b64_tr_b16 v[32:33], v8 offset:16384
ds_read_b64_tr_b16 v[34:35], v8 offset:17408
v_mfma_f32_16x16x32_bf16 v[132:135], v[80:83], v[116:119], v[132:135]
s_add_u32 s70, s73, s65
ds_read_b128 v[64:67], v18 offset:0
ds_read_b128 v[68:71], v18 offset:2048
v_mfma_f32_16x16x32_bf16 v[136:139], v[80:83], v[120:123], v[136:139]
s_and_b32 s70, s70, 3
ds_read_b128 v[72:75], v18 offset:4096
ds_read_b128 v[76:79], v18 offset:6144
v_mfma_f32_16x16x32_bf16 v[140:143], v[80:83], v[124:127], v[140:143]
s_and_b32 s73, s73, 12
ds_read_b64_tr_b16 v[36:37], v9 offset:16384
ds_read_b64_tr_b16 v[38:39], v9 offset:17408
v_mfma_f32_16x16x32_bf16 v[156:159], v[84:87], v[124:127], v[156:159]
s_or_b32 s73, s73, s70
ds_read_b64_tr_b16 v[40:41], v10 offset:16384
v_mfma_f32_16x16x32_bf16 v[152:155], v[84:87], v[120:123], v[152:155]
s_lshl_b32 s71, s73, 19
ds_read_b64_tr_b16 v[42:43], v10 offset:17408
v_mfma_f32_16x16x32_bf16 v[148:151], v[84:87], v[116:119], v[148:151]
s_add_u32 s71, s71, s66
ds_read_b64_tr_b16 v[44:45], v11 offset:16384
v_mfma_f32_16x16x32_bf16 v[144:147], v[84:87], v[112:115], v[144:147]
s_lshl_b32 s73, s73, 7
ds_read_b64_tr_b16 v[46:47], v11 offset:17408
v_mfma_f32_16x16x32_bf16 v[160:163], v[88:91], v[112:115], v[160:163]
s_add_u32 s69, s73, s67
ds_read_b64_tr_b16 v[48:49], v12 offset:16384
v_mfma_f32_16x16x32_bf16 v[164:167], v[88:91], v[116:119], v[164:167]
s_add_u32 s70, s73, s68
ds_read_b64_tr_b16 v[50:51], v12 offset:17408
v_mfma_f32_16x16x32_bf16 v[168:171], v[88:91], v[120:123], v[168:171]
s_add_u32 m0, s64, 0
ds_read_b64_tr_b16 v[52:53], v13 offset:16384
v_mfma_f32_16x16x32_bf16 v[172:175], v[88:91], v[124:127], v[172:175]
s_add_u32 s72, s71, 0
buffer_load_dwordx4 v6, s[12:15], s72 offen lds
v_mfma_f32_16x16x32_bf16 v[188:191], v[92:95], v[124:127], v[188:191]
s_add_u32 s72, s71, 31744
buffer_load_dwordx4 v6, s[12:15], s72 offen offset:1024 lds
v_mfma_f32_16x16x32_bf16 v[184:187], v[92:95], v[120:123], v[184:187]
s_add_u32 s72, s71, 63488
buffer_load_dwordx4 v7, s[12:15], s72 offen offset:2048 lds
v_mfma_f32_16x16x32_bf16 v[180:183], v[92:95], v[116:119], v[180:183]
s_add_u32 s72, s71, 95232
buffer_load_dwordx4 v7, s[12:15], s72 offen offset:3072 lds
v_mfma_f32_16x16x32_bf16 v[176:179], v[92:95], v[112:115], v[176:179]
ds_read_b64_tr_b16 v[54:55], v13 offset:17408
v_mfma_f32_16x16x32_bf16 v[192:195], v[96:99], v[112:115], v[192:195]
ds_read_b64_tr_b16 v[56:57], v14 offset:16384
v_mfma_f32_16x16x32_bf16 v[196:199], v[96:99], v[116:119], v[196:199]
ds_read_b64_tr_b16 v[58:59], v14 offset:17408
v_mfma_f32_16x16x32_bf16 v[200:203], v[96:99], v[120:123], v[200:203]
ds_read_b64_tr_b16 v[60:61], v15 offset:16384
v_mfma_f32_16x16x32_bf16 v[204:207], v[96:99], v[124:127], v[204:207]
s_add_u32 m0, s63, 131072
ds_read_b64_tr_b16 v[62:63], v15 offset:17408
v_mfma_f32_16x16x32_bf16 v[220:223], v[100:103], v[124:127], v[220:223]
s_add_u32 s72, s69, 0
buffer_load_dwordx4 v4, s[4:7], s72 offen lds
v_mfma_f32_16x16x32_bf16 v[216:219], v[100:103], v[120:123], v[216:219]
buffer_store_dwordx4 v[24:27], v1, s[44:47], s80 offen sc1
v_mfma_f32_16x16x32_bf16 v[212:215], v[100:103], v[116:119], v[212:215]
v_accvgpr_read_b32 v20, a20
v_accvgpr_read_b32 v28, a21
v_mfma_f32_16x16x32_bf16 v[208:211], v[100:103], v[112:115], v[208:211]
v_accvgpr_read_b32 v21, a22
v_accvgpr_read_b32 v29, a23
v_mfma_f32_16x16x32_bf16 v[224:227], v[104:107], v[112:115], v[224:227]
s_add_u32 s72, s69, 15360
buffer_load_dwordx4 v5, s[4:7], s72 offen offset:1024 lds
v_mfma_f32_16x16x32_bf16 v[228:231], v[104:107], v[116:119], v[228:231]
s_add_u32 s80, s77, 36864
v_accvgpr_read_b32 v22, a52
v_accvgpr_read_b32 v30, a53
v_mfma_f32_16x16x32_bf16 v[232:235], v[104:107], v[120:123], v[232:235]
v_accvgpr_read_b32 v23, a54
v_accvgpr_read_b32 v31, a55
v_mfma_f32_16x16x32_bf16 v[236:239], v[104:107], v[124:127], v[236:239]
v_mul_f32 v20, s79, v20
v_mul_f32 v28, s79, v28
v_mfma_f32_16x16x32_bf16 v[252:255], v[108:111], v[124:127], v[252:255]
v_mul_f32 v21, s79, v21
v_mul_f32 v29, s79, v29
v_mfma_f32_16x16x32_bf16 v[248:251], v[108:111], v[120:123], v[248:251]
s_add_u32 s72, s69, 30720
buffer_load_dwordx4 v4, s[4:7], s72 offen offset:2048 lds
v_mfma_f32_16x16x32_bf16 v[244:247], v[108:111], v[116:119], v[244:247]
v_mul_f32 v22, s79, v22
v_mul_f32 v30, s79, v30
v_mfma_f32_16x16x32_bf16 v[240:243], v[108:111], v[112:115], v[240:243]
s_waitcnt lgkmcnt(0)
v_mul_f32 v23, s79, v23
v_mul_f32 v31, s79, v31
v_mfma_f32_16x16x32_bf16 v[128:131], v[32:35], v[64:67], v[128:131]
ds_read_b64_tr_b16 v[80:81], v8 offset:24576
ds_read_b64_tr_b16 v[82:83], v8 offset:25600
v_mfma_f32_16x16x32_bf16 v[132:135], v[32:35], v[68:71], v[132:135]
ds_read_b128 v[112:115], v19 offset:0
ds_read_b128 v[116:119], v19 offset:2048
v_mfma_f32_16x16x32_bf16 v[136:139], v[32:35], v[72:75], v[136:139]
s_add_u32 s72, s69, 46080
buffer_load_dwordx4 v5, s[4:7], s72 offen offset:3072 lds
v_mfma_f32_16x16x32_bf16 v[140:143], v[32:35], v[76:79], v[140:143]
ds_read_b128 v[120:123], v19 offset:4096
ds_read_b128 v[124:127], v19 offset:6144
v_mfma_f32_16x16x32_bf16 v[156:159], v[36:39], v[76:79], v[156:159]
ds_read_b64_tr_b16 v[84:85], v9 offset:24576
ds_read_b64_tr_b16 v[86:87], v9 offset:25600
v_mfma_f32_16x16x32_bf16 v[152:155], v[36:39], v[72:75], v[152:155]
ds_read_b64_tr_b16 v[88:89], v10 offset:24576
v_cvt_pk_bf16_f32 v20, v20, v28
v_mfma_f32_16x16x32_bf16 v[148:151], v[36:39], v[68:71], v[148:151]
ds_read_b64_tr_b16 v[90:91], v10 offset:25600
v_cvt_pk_bf16_f32 v21, v21, v29
v_mfma_f32_16x16x32_bf16 v[144:147], v[36:39], v[64:67], v[144:147]
s_add_u32 m0, s63, 135168
ds_read_b64_tr_b16 v[92:93], v11 offset:24576
v_cvt_pk_bf16_f32 v22, v22, v30
v_mfma_f32_16x16x32_bf16 v[160:163], v[40:43], v[64:67], v[160:163]
s_add_u32 s72, s70, 0
buffer_load_dwordx4 v4, s[4:7], s72 offen lds
v_mfma_f32_16x16x32_bf16 v[164:167], v[40:43], v[68:71], v[164:167]
ds_read_b64_tr_b16 v[94:95], v11 offset:25600
v_cvt_pk_bf16_f32 v23, v23, v31
v_mfma_f32_16x16x32_bf16 v[168:171], v[40:43], v[72:75], v[168:171]
ds_read_b64_tr_b16 v[96:97], v12 offset:24576
v_mfma_f32_16x16x32_bf16 v[172:175], v[40:43], v[76:79], v[172:175]
ds_read_b64_tr_b16 v[98:99], v12 offset:25600
v_mfma_f32_16x16x32_bf16 v[188:191], v[44:47], v[76:79], v[188:191]
s_add_u32 s72, s70, 15360
buffer_load_dwordx4 v5, s[4:7], s72 offen offset:1024 lds
v_mfma_f32_16x16x32_bf16 v[184:187], v[44:47], v[72:75], v[184:187]
ds_read_b64_tr_b16 v[100:101], v13 offset:24576
v_mfma_f32_16x16x32_bf16 v[180:183], v[44:47], v[68:71], v[180:183]
ds_read_b64_tr_b16 v[102:103], v13 offset:25600
v_mfma_f32_16x16x32_bf16 v[176:179], v[44:47], v[64:67], v[176:179]
ds_read_b64_tr_b16 v[104:105], v14 offset:24576
v_mfma_f32_16x16x32_bf16 v[192:195], v[48:51], v[64:67], v[192:195]
ds_read_b64_tr_b16 v[106:107], v14 offset:25600
v_mfma_f32_16x16x32_bf16 v[196:199], v[48:51], v[68:71], v[196:199]
s_add_u32 s72, s70, 30720
buffer_load_dwordx4 v4, s[4:7], s72 offen offset:2048 lds
v_mfma_f32_16x16x32_bf16 v[200:203], v[48:51], v[72:75], v[200:203]
ds_read_b64_tr_b16 v[108:109], v15 offset:24576
v_mfma_f32_16x16x32_bf16 v[204:207], v[48:51], v[76:79], v[204:207]
ds_read_b64_tr_b16 v[110:111], v15 offset:25600
v_mfma_f32_16x16x32_bf16 v[220:223], v[52:55], v[76:79], v[220:223]
buffer_store_dwordx4 v[20:23], v1, s[44:47], s80 offen sc1
v_mfma_f32_16x16x32_bf16 v[216:219], v[52:55], v[72:75], v[216:219]
v_accvgpr_read_b32 v24, a168
v_accvgpr_read_b32 v28, a169
v_mfma_f32_16x16x32_bf16 v[212:215], v[52:55], v[68:71], v[212:215]
s_add_u32 s72, s70, 46080
buffer_load_dwordx4 v5, s[4:7], s72 offen offset:3072 lds
v_mfma_f32_16x16x32_bf16 v[208:211], v[52:55], v[64:67], v[208:211]
v_accvgpr_read_b32 v25, a170
v_accvgpr_read_b32 v29, a171
v_mfma_f32_16x16x32_bf16 v[224:227], v[56:59], v[64:67], v[224:227]
s_add_u32 s80, s78, 9216
v_accvgpr_read_b32 v26, a172
v_accvgpr_read_b32 v30, a173
v_mfma_f32_16x16x32_bf16 v[228:231], v[56:59], v[68:71], v[228:231]
v_accvgpr_read_b32 v27, a174
v_accvgpr_read_b32 v31, a175
v_mfma_f32_16x16x32_bf16 v[232:235], v[56:59], v[72:75], v[232:235]
v_cvt_pk_bf16_f32 v24, v24, v28
v_cvt_pk_bf16_f32 v25, v25, v29
v_mfma_f32_16x16x32_bf16 v[236:239], v[56:59], v[76:79], v[236:239]
v_cvt_pk_bf16_f32 v26, v26, v30
v_cvt_pk_bf16_f32 v27, v27, v31
v_mfma_f32_16x16x32_bf16 v[252:255], v[60:63], v[76:79], v[252:255]
buffer_store_dwordx4 v[24:27], v1, s[44:47], s80 offen sc1
v_mfma_f32_16x16x32_bf16 v[248:251], v[60:63], v[72:75], v[248:251]
v_mfma_f32_16x16x32_bf16 v[244:247], v[60:63], v[68:71], v[244:247]
s_waitcnt vmcnt(16) lgkmcnt(0)
v_mfma_f32_16x16x32_bf16 v[240:243], v[60:63], v[64:67], v[240:243]
s_barrier
v_mfma_f32_16x16x32_bf16 v[128:131], v[80:83], v[112:115], v[128:131]
s_add_u32 s73, s62, 7
ds_read_b64_tr_b16 v[32:33], v8 offset:32768
ds_read_b64_tr_b16 v[34:35], v8 offset:33792
v_mfma_f32_16x16x32_bf16 v[132:135], v[80:83], v[116:119], v[132:135]
s_add_u32 s70, s73, s65
ds_read_b128 v[64:67], v18 offset:32768
ds_read_b128 v[68:71], v18 offset:34816
v_mfma_f32_16x16x32_bf16 v[136:139], v[80:83], v[120:123], v[136:139]
s_and_b32 s70, s70, 3
ds_read_b128 v[72:75], v18 offset:36864
ds_read_b128 v[76:79], v18 offset:38912
v_mfma_f32_16x16x32_bf16 v[140:143], v[80:83], v[124:127], v[140:143]
s_and_b32 s73, s73, 12
ds_read_b64_tr_b16 v[36:37], v9 offset:32768
ds_read_b64_tr_b16 v[38:39], v9 offset:33792
v_mfma_f32_16x16x32_bf16 v[156:159], v[84:87], v[124:127], v[156:159]
s_or_b32 s73, s73, s70
ds_read_b64_tr_b16 v[40:41], v10 offset:32768
v_accvgpr_read_b32 v20, a24
v_mfma_f32_16x16x32_bf16 v[152:155], v[84:87], v[120:123], v[152:155]
s_lshl_b32 s71, s73, 19
ds_read_b64_tr_b16 v[42:43], v10 offset:33792
v_accvgpr_read_b32 v28, a25
v_mfma_f32_16x16x32_bf16 v[148:151], v[84:87], v[116:119], v[148:151]
s_add_u32 s71, s71, s66
ds_read_b64_tr_b16 v[44:45], v11 offset:32768
v_accvgpr_read_b32 v21, a26
v_mfma_f32_16x16x32_bf16 v[144:147], v[84:87], v[112:115], v[144:147]
s_lshl_b32 s73, s73, 7
ds_read_b64_tr_b16 v[46:47], v11 offset:33792
v_accvgpr_read_b32 v29, a27
v_mfma_f32_16x16x32_bf16 v[160:163], v[88:91], v[112:115], v[160:163]
s_add_u32 s69, s73, s67
ds_read_b64_tr_b16 v[48:49], v12 offset:32768
v_mfma_f32_16x16x32_bf16 v[164:167], v[88:91], v[116:119], v[164:167]
s_add_u32 s70, s73, s68
ds_read_b64_tr_b16 v[50:51], v12 offset:33792
v_mfma_f32_16x16x32_bf16 v[168:171], v[88:91], v[120:123], v[168:171]
s_add_u32 m0, s64, 16384
ds_read_b64_tr_b16 v[52:53], v13 offset:32768
v_mfma_f32_16x16x32_bf16 v[172:175], v[88:91], v[124:127], v[172:175]
s_add_u32 s72, s71, 0
buffer_load_dwordx4 v6, s[12:15], s72 offen lds
v_mfma_f32_16x16x32_bf16 v[188:191], v[92:95], v[124:127], v[188:191]
s_add_u32 s72, s71, 31744
buffer_load_dwordx4 v6, s[12:15], s72 offen offset:1024 lds
v_mfma_f32_16x16x32_bf16 v[184:187], v[92:95], v[120:123], v[184:187]
s_add_u32 s72, s71, 63488
buffer_load_dwordx4 v7, s[12:15], s72 offen offset:2048 lds
v_mfma_f32_16x16x32_bf16 v[180:183], v[92:95], v[116:119], v[180:183]
s_add_u32 s72, s71, 95232
buffer_load_dwordx4 v7, s[12:15], s72 offen offset:3072 lds
v_mfma_f32_16x16x32_bf16 v[176:179], v[92:95], v[112:115], v[176:179]
s_add_u32 s80, s77, 40960
ds_read_b64_tr_b16 v[54:55], v13 offset:33792
v_accvgpr_read_b32 v22, a56
v_mfma_f32_16x16x32_bf16 v[192:195], v[96:99], v[112:115], v[192:195]
ds_read_b64_tr_b16 v[56:57], v14 offset:32768
v_accvgpr_read_b32 v30, a57
v_mfma_f32_16x16x32_bf16 v[196:199], v[96:99], v[116:119], v[196:199]
ds_read_b64_tr_b16 v[58:59], v14 offset:33792
v_accvgpr_read_b32 v23, a58
v_mfma_f32_16x16x32_bf16 v[200:203], v[96:99], v[120:123], v[200:203]
ds_read_b64_tr_b16 v[60:61], v15 offset:32768
v_accvgpr_read_b32 v31, a59
v_mfma_f32_16x16x32_bf16 v[204:207], v[96:99], v[124:127], v[204:207]
s_add_u32 m0, s63, 65536
ds_read_b64_tr_b16 v[62:63], v15 offset:33792
v_mul_f32 v20, s79, v20
v_mfma_f32_16x16x32_bf16 v[220:223], v[100:103], v[124:127], v[220:223]
s_add_u32 s72, s69, 0
buffer_load_dwordx4 v4, s[4:7], s72 offen lds
v_mfma_f32_16x16x32_bf16 v[216:219], v[100:103], v[120:123], v[216:219]
v_mul_f32 v28, s79, v28
v_mul_f32 v21, s79, v21
v_mfma_f32_16x16x32_bf16 v[212:215], v[100:103], v[116:119], v[212:215]
v_mul_f32 v29, s79, v29
v_mul_f32 v22, s79, v22
v_mfma_f32_16x16x32_bf16 v[208:211], v[100:103], v[112:115], v[208:211]
v_mul_f32 v30, s79, v30
v_mul_f32 v23, s79, v23
v_mfma_f32_16x16x32_bf16 v[224:227], v[104:107], v[112:115], v[224:227]
s_add_u32 s72, s69, 15360
buffer_load_dwordx4 v5, s[4:7], s72 offen offset:1024 lds
v_mfma_f32_16x16x32_bf16 v[228:231], v[104:107], v[116:119], v[228:231]
v_mul_f32 v31, s79, v31
v_cvt_pk_bf16_f32 v20, v20, v28
v_mfma_f32_16x16x32_bf16 v[232:235], v[104:107], v[120:123], v[232:235]
v_cvt_pk_bf16_f32 v21, v21, v29
v_cvt_pk_bf16_f32 v22, v22, v30
v_mfma_f32_16x16x32_bf16 v[236:239], v[104:107], v[124:127], v[236:239]
v_cvt_pk_bf16_f32 v23, v23, v31
v_mfma_f32_16x16x32_bf16 v[252:255], v[108:111], v[124:127], v[252:255]
buffer_store_dwordx4 v[20:23], v1, s[44:47], s80 offen sc1
v_mfma_f32_16x16x32_bf16 v[248:251], v[108:111], v[120:123], v[248:251]
s_add_u32 s72, s69, 30720
buffer_load_dwordx4 v4, s[4:7], s72 offen offset:2048 lds
v_mfma_f32_16x16x32_bf16 v[244:247], v[108:111], v[116:119], v[244:247]
v_accvgpr_read_b32 v24, a176
v_accvgpr_read_b32 v28, a177
v_mfma_f32_16x16x32_bf16 v[240:243], v[108:111], v[112:115], v[240:243]
s_waitcnt lgkmcnt(0)
v_accvgpr_read_b32 v25, a178
v_accvgpr_read_b32 v29, a179
v_mfma_f32_16x16x32_bf16 v[128:131], v[32:35], v[64:67], v[128:131]
s_lshr_b32 s75, s93, 4
ds_read_b64_tr_b16 v[80:81], v8 offset:40960
ds_read_b64_tr_b16 v[82:83], v8 offset:41984
v_mfma_f32_16x16x32_bf16 v[132:135], v[32:35], v[68:71], v[132:135]
s_and_b32 s75, s75, 0x7f00
ds_read_b128 v[112:115], v19 offset:32768
ds_read_b128 v[116:119], v19 offset:34816
v_mfma_f32_16x16x32_bf16 v[136:139], v[32:35], v[72:75], v[136:139]
s_add_u32 s72, s69, 46080
buffer_load_dwordx4 v5, s[4:7], s72 offen offset:3072 lds
v_mfma_f32_16x16x32_bf16 v[140:143], v[32:35], v[76:79], v[140:143]
s_add_u32 s75, s75, LcB1-Lpc0
v_lshrrev_b32 v2, 5, v0
v_lshlrev_b32 v2, 7, v2
v_mfma_f32_16x16x32_bf16 v[156:159], v[36:39], v[76:79], v[156:159]
s_add_u32 s80, s78, 33792
v_add_u32 v2, s75, v2
v_min_u32 v2, Lcode_end-Lpc0, v2
v_mfma_f32_16x16x32_bf16 v[152:155], v[36:39], v[72:75], v[152:155]
global_load_dword v3, v2, s[98:99]
v_mfma_f32_16x16x32_bf16 v[148:151], v[36:39], v[68:71], v[148:151]
ds_read_b128 v[120:123], v19 offset:36864
ds_read_b128 v[124:127], v19 offset:38912
v_mfma_f32_16x16x32_bf16 v[144:147], v[36:39], v[64:67], v[144:147]
s_add_u32 m0, s63, 69632
ds_read_b64_tr_b16 v[84:85], v9 offset:40960
ds_read_b64_tr_b16 v[86:87], v9 offset:41984
v_mfma_f32_16x16x32_bf16 v[160:163], v[40:43], v[64:67], v[160:163]
s_add_u32 s72, s70, 0
buffer_load_dwordx4 v4, s[4:7], s72 offen lds
v_mfma_f32_16x16x32_bf16 v[164:167], v[40:43], v[68:71], v[164:167]
ds_read_b64_tr_b16 v[88:89], v10 offset:40960
v_accvgpr_read_b32 v26, a180
v_mfma_f32_16x16x32_bf16 v[168:171], v[40:43], v[72:75], v[168:171]
ds_read_b64_tr_b16 v[90:91], v10 offset:41984
v_accvgpr_read_b32 v30, a181
v_mfma_f32_16x16x32_bf16 v[172:175], v[40:43], v[76:79], v[172:175]
ds_read_b64_tr_b16 v[92:93], v11 offset:40960
v_accvgpr_read_b32 v27, a182
v_mfma_f32_16x16x32_bf16 v[188:191], v[44:47], v[76:79], v[188:191]
s_add_u32 s72, s70, 15360
buffer_load_dwordx4 v5, s[4:7], s72 offen offset:1024 lds
v_mfma_f32_16x16x32_bf16 v[184:187], v[44:47], v[72:75], v[184:187]
ds_read_b64_tr_b16 v[94:95], v11 offset:41984
v_accvgpr_read_b32 v31, a183
v_mfma_f32_16x16x32_bf16 v[180:183], v[44:47], v[68:71], v[180:183]
ds_read_b64_tr_b16 v[96:97], v12 offset:40960
v_cvt_pk_bf16_f32 v24, v24, v28
v_mfma_f32_16x16x32_bf16 v[176:179], v[44:47], v[64:67], v[176:179]
ds_read_b64_tr_b16 v[98:99], v12 offset:41984
v_cvt_pk_bf16_f32 v25, v25, v29
v_mfma_f32_16x16x32_bf16 v[192:195], v[48:51], v[64:67], v[192:195]
ds_read_b64_tr_b16 v[100:101], v13 offset:40960
v_cvt_pk_bf16_f32 v26, v26, v30
v_mfma_f32_16x16x32_bf16 v[196:199], v[48:51], v[68:71], v[196:199]
s_add_u32 s72, s70, 30720
buffer_load_dwordx4 v4, s[4:7], s72 offen offset:2048 lds
v_mfma_f32_16x16x32_bf16 v[200:203], v[48:51], v[72:75], v[200:203]
ds_read_b64_tr_b16 v[102:103], v13 offset:41984
v_cvt_pk_bf16_f32 v27, v27, v31
v_mfma_f32_16x16x32_bf16 v[204:207], v[48:51], v[76:79], v[204:207]
ds_read_b64_tr_b16 v[104:105], v14 offset:40960
v_mfma_f32_16x16x32_bf16 v[220:223], v[52:55], v[76:79], v[220:223]
ds_read_b64_tr_b16 v[106:107], v14 offset:41984
v_mfma_f32_16x16x32_bf16 v[216:219], v[52:55], v[72:75], v[216:219]
ds_read_b64_tr_b16 v[108:109], v15 offset:40960
v_mfma_f32_16x16x32_bf16 v[212:215], v[52:55], v[68:71], v[212:215]
s_add_u32 s72, s70, 46080
buffer_load_dwordx4 v5, s[4:7], s72 offen offset:3072 lds
v_mfma_f32_16x16x32_bf16 v[208:211], v[52:55], v[64:67], v[208:211]
ds_read_b64_tr_b16 v[110:111], v15 offset:41984
v_mfma_f32_16x16x32_bf16 v[224:227], v[56:59], v[64:67], v[224:227]
buffer_store_dwordx4 v[24:27], v1, s[44:47], s80 offen sc1
v_mfma_f32_16x16x32_bf16 v[228:231], v[56:59], v[68:71], v[228:231]
v_accvgpr_read_b32 v20, a28
v_accvgpr_read_b32 v28, a29
v_mfma_f32_16x16x32_bf16 v[232:235], v[56:59], v[72:75], v[232:235]
v_accvgpr_read_b32 v21, a30
v_accvgpr_read_b32 v29, a31
v_mfma_f32_16x16x32_bf16 v[236:239], v[56:59], v[76:79], v[236:239]
s_add_u32 s80, s77, 45056
v_accvgpr_read_b32 v22, a60
v_accvgpr_read_b32 v30, a61
v_mfma_f32_16x16x32_bf16 v[252:255], v[60:63], v[76:79], v[252:255]
v_accvgpr_read_b32 v23, a62
v_accvgpr_read_b32 v31, a63
v_mfma_f32_16x16x32_bf16 v[248:251], v[60:63], v[72:75], v[248:251]
v_mul_f32 v20, s79, v20
v_mul_f32 v28, s79, v28
v_mfma_f32_16x16x32_bf16 v[244:247], v[60:63], v[68:71], v[244:247]
s_waitcnt vmcnt(16) lgkmcnt(0)
v_mul_f32 v21, s79, v21
v_mul_f32 v29, s79, v29
v_mfma_f32_16x16x32_bf16 v[240:243], v[60:63], v[64:67], v[240:243]
s_barrier
v_mul_f32 v22, s79, v22
v_mul_f32 v30, s79, v30
v_mfma_f32_16x16x32_bf16 v[128:131], v[80:83], v[112:115], v[128:131]
s_add_u32 s73, s62, 8
ds_read_b64_tr_b16 v[32:33], v8 offset:0
ds_read_b64_tr_b16 v[34:35], v8 offset:1024
v_mfma_f32_16x16x32_bf16 v[132:135], v[80:83], v[116:119], v[132:135]
s_add_u32 s70, s73, s65
ds_read_b128 v[64:67], v16 offset:0
ds_read_b128 v[68:71], v16 offset:2048
v_mfma_f32_16x16x32_bf16 v[136:139], v[80:83], v[120:123], v[136:139]
s_and_b32 s70, s70, 3
ds_read_b128 v[72:75], v16 offset:4096
ds_read_b128 v[76:79], v16 offset:6144
v_mfma_f32_16x16x32_bf16 v[140:143], v[80:83], v[124:127], v[140:143]
s_and_b32 s73, s73, 12
ds_read_b64_tr_b16 v[36:37], v9 offset:0
ds_read_b64_tr_b16 v[38:39], v9 offset:1024
v_mfma_f32_16x16x32_bf16 v[156:159], v[84:87], v[124:127], v[156:159]
s_or_b32 s73, s73, s70
ds_read_b64_tr_b16 v[40:41], v10 offset:0
v_mul_f32 v23, s79, v23
v_mfma_f32_16x16x32_bf16 v[152:155], v[84:87], v[120:123], v[152:155]
s_lshl_b32 s71, s73, 19
ds_read_b64_tr_b16 v[42:43], v10 offset:1024
v_mul_f32 v31, s79, v31
v_mfma_f32_16x16x32_bf16 v[148:151], v[84:87], v[116:119], v[148:151]
s_add_u32 s71, s71, s66
ds_read_b64_tr_b16 v[44:45], v11 offset:0
v_cvt_pk_bf16_f32 v20, v20, v28
v_mfma_f32_16x16x32_bf16 v[144:147], v[84:87], v[112:115], v[144:147]
s_lshl_b32 s73, s73, 7
ds_read_b64_tr_b16 v[46:47], v11 offset:1024
v_cvt_pk_bf16_f32 v21, v21, v29
v_mfma_f32_16x16x32_bf16 v[160:163], v[88:91], v[112:115], v[160:163]
s_add_u32 s69, s73, s67
ds_read_b64_tr_b16 v[48:49], v12 offset:0
v_cvt_pk_bf16_f32 v22, v22, v30
v_mfma_f32_16x16x32_bf16 v[164:167], v[88:91], v[116:119], v[164:167]
s_add_u32 s70, s73, s68
ds_read_b64_tr_b16 v[50:51], v12 offset:1024
v_cvt_pk_bf16_f32 v23, v23, v31
v_mfma_f32_16x16x32_bf16 v[168:171], v[88:91], v[120:123], v[168:171]
s_add_u32 m0, s64, 32768
ds_read_b64_tr_b16 v[52:53], v13 offset:0
v_mfma_f32_16x16x32_bf16 v[172:175], v[88:91], v[124:127], v[172:175]
s_add_u32 s72, s71, 0
buffer_load_dwordx4 v6, s[12:15], s72 offen lds
v_mfma_f32_16x16x32_bf16 v[188:191], v[92:95], v[124:127], v[188:191]
s_add_u32 s72, s71, 31744
buffer_load_dwordx4 v6, s[12:15], s72 offen offset:1024 lds
v_mfma_f32_16x16x32_bf16 v[184:187], v[92:95], v[120:123], v[184:187]
s_add_u32 s72, s71, 63488
buffer_load_dwordx4 v7, s[12:15], s72 offen offset:2048 lds
v_mfma_f32_16x16x32_bf16 v[180:183], v[92:95], v[116:119], v[180:183]
s_add_u32 s72, s71, 95232
buffer_load_dwordx4 v7, s[12:15], s72 offen offset:3072 lds
v_mfma_f32_16x16x32_bf16 v[176:179], v[92:95], v[112:115], v[176:179]
ds_read_b64_tr_b16 v[54:55], v13 offset:1024
v_mfma_f32_16x16x32_bf16 v[192:195], v[96:99], v[112:115], v[192:195]
ds_read_b64_tr_b16 v[56:57], v14 offset:0
v_mfma_f32_16x16x32_bf16 v[196:199], v[96:99], v[116:119], v[196:199]
ds_read_b64_tr_b16 v[58:59], v14 offset:1024
v_mfma_f32_16x16x32_bf16 v[200:203], v[96:99], v[120:123], v[200:203]
ds_read_b64_tr_b16 v[60:61], v15 offset:0
v_mfma_f32_16x16x32_bf16 v[204:207], v[96:99], v[124:127], v[204:207]
s_add_u32 m0, s63, 98304
ds_read_b64_tr_b16 v[62:63], v15 offset:1024
v_mfma_f32_16x16x32_bf16 v[220:223], v[100:103], v[124:127], v[220:223]
s_add_u32 s72, s69, 0
buffer_load_dwordx4 v4, s[4:7], s72 offen lds
v_mfma_f32_16x16x32_bf16 v[216:219], v[100:103], v[120:123], v[216:219]
buffer_store_dwordx4 v[20:23], v1, s[44:47], s80 offen sc1
v_mfma_f32_16x16x32_bf16 v[212:215], v[100:103], v[116:119], v[212:215]
v_accvgpr_read_b32 v24, a184
v_accvgpr_read_b32 v28, a185
v_mfma_f32_16x16x32_bf16 v[208:211], v[100:103], v[112:115], v[208:211]
v_accvgpr_read_b32 v25, a186
v_accvgpr_read_b32 v29, a187
v_mfma_f32_16x16x32_bf16 v[224:227], v[104:107], v[112:115], v[224:227]
s_add_u32 s72, s69, 15360
buffer_load_dwordx4 v5, s[4:7], s72 offen offset:1024 lds
v_mfma_f32_16x16x32_bf16 v[228:231], v[104:107], v[116:119], v[228:231]
s_add_u32 s80, s78, 41984
v_accvgpr_read_b32 v26, a188
v_accvgpr_read_b32 v30, a189
v_mfma_f32_16x16x32_bf16 v[232:235], v[104:107], v[120:123], v[232:235]
v_accvgpr_read_b32 v27, a190
v_accvgpr_read_b32 v31, a191
v_mfma_f32_16x16x32_bf16 v[236:239], v[104:107], v[124:127], v[236:239]
v_cvt_pk_bf16_f32 v24, v24, v28
v_cvt_pk_bf16_f32 v25, v25, v29
v_mfma_f32_16x16x32_bf16 v[252:255], v[108:111], v[124:127], v[252:255]
v_cvt_pk_bf16_f32 v26, v26, v30
v_cvt_pk_bf16_f32 v27, v27, v31
v_mfma_f32_16x16x32_bf16 v[248:251], v[108:111], v[120:123], v[248:251]
s_add_u32 s72, s69, 30720
buffer_load_dwordx4 v4, s[4:7], s72 offen offset:2048 lds
v_mfma_f32_16x16x32_bf16 v[244:247], v[108:111], v[116:119], v[244:247]
buffer_store_dwordx4 v[24:27], v1, s[44:47], s80 offen sc1
v_mfma_f32_16x16x32_bf16 v[240:243], v[108:111], v[112:115], v[240:243]
s_waitcnt lgkmcnt(0)
v_mfma_f32_16x16x32_bf16 v[128:131], v[32:35], v[64:67], v[128:131]
ds_read_b64_tr_b16 v[80:81], v8 offset:8192
ds_read_b64_tr_b16 v[82:83], v8 offset:9216
v_mfma_f32_16x16x32_bf16 v[132:135], v[32:35], v[68:71], v[132:135]
ds_read_b128 v[112:115], v17 offset:0
ds_read_b128 v[116:119], v17 offset:2048
v_mfma_f32_16x16x32_bf16 v[136:139], v[32:35], v[72:75], v[136:139]
s_add_u32 s72, s69, 46080
buffer_load_dwordx4 v5, s[4:7], s72 offen offset:3072 lds
v_mfma_f32_16x16x32_bf16 v[140:143], v[32:35], v[76:79], v[140:143]
ds_read_b128 v[120:123], v17 offset:4096
ds_read_b128 v[124:127], v17 offset:6144
v_mfma_f32_16x16x32_bf16 v[156:159], v[36:39], v[76:79], v[156:159]
ds_read_b64_tr_b16 v[84:85], v9 offset:8192
ds_read_b64_tr_b16 v[86:87], v9 offset:9216
v_mfma_f32_16x16x32_bf16 v[152:155], v[36:39], v[72:75], v[152:155]
ds_read_b64_tr_b16 v[88:89], v10 offset:8192
v_accvgpr_read_b32 v20, a64
v_mfma_f32_16x16x32_bf16 v[148:151], v[36:39], v[68:71], v[148:151]
ds_read_b64_tr_b16 v[90:91], v10 offset:9216
v_accvgpr_read_b32 v28, a65
v_mfma_f32_16x16x32_bf16 v[144:147], v[36:39], v[64:67], v[144:147]
s_add_u32 m0, s63, 102400
ds_read_b64_tr_b16 v[92:93], v11 offset:8192
v_accvgpr_read_b32 v21, a66
v_mfma_f32_16x16x32_bf16 v[160:163], v[40:43], v[64:67], v[160:163]
s_add_u32 s72, s70, 0
buffer_load_dwordx4 v4, s[4:7], s72 offen lds
v_mfma_f32_16x16x32_bf16 v[164:167], v[40:43], v[68:71], v[164:167]
ds_read_b64_tr_b16 v[94:95], v11 offset:9216
v_accvgpr_read_b32 v29, a67
v_mfma_f32_16x16x32_bf16 v[168:171], v[40:43], v[72:75], v[168:171]
s_add_u32 s80, s77, 1024
ds_read_b64_tr_b16 v[96:97], v12 offset:8192
v_accvgpr_read_b32 v22, a96
v_mfma_f32_16x16x32_bf16 v[172:175], v[40:43], v[76:79], v[172:175]
ds_read_b64_tr_b16 v[98:99], v12 offset:9216
v_accvgpr_read_b32 v30, a97
v_mfma_f32_16x16x32_bf16 v[188:191], v[44:47], v[76:79], v[188:191]
s_add_u32 s72, s70, 15360
buffer_load_dwordx4 v5, s[4:7], s72 offen offset:1024 lds
v_mfma_f32_16x16x32_bf16 v[184:187], v[44:47], v[72:75], v[184:187]
ds_read_b64_tr_b16 v[100:101], v13 offset:8192
v_accvgpr_read_b32 v23, a98
v_mfma_f32_16x16x32_bf16 v[180:183], v[44:47], v[68:71], v[180:183]
ds_read_b64_tr_b16 v[102:103], v13 offset:9216
v_accvgpr_read_b32 v31, a99
v_mfma_f32_16x16x32_bf16 v[176:179], v[44:47], v[64:67], v[176:179]
ds_read_b64_tr_b16 v[104:105], v14 offset:8192
v_mul_f32 v20, s79, v20
v_mfma_f32_16x16x32_bf16 v[192:195], v[48:51], v[64:67], v[192:195]
ds_read_b64_tr_b16 v[106:107], v14 offset:9216
v_mul_f32 v28, s79, v28
v_mfma_f32_16x16x32_bf16 v[196:199], v[48:51], v[68:71], v[196:199]
s_add_u32 s72, s70, 30720
buffer_load_dwordx4 v4, s[4:7], s72 offen offset:2048 lds
v_mfma_f32_16x16x32_bf16 v[200:203], v[48:51], v[72:75], v[200:203]
ds_read_b64_tr_b16 v[108:109], v15 offset:8192
v_mul_f32 v21, s79, v21
v_mfma_f32_16x16x32_bf16 v[204:207], v[48:51], v[76:79], v[204:207]
ds_read_b64_tr_b16 v[110:111], v15 offset:9216
v_mul_f32 v29, s79, v29
v_mfma_f32_16x16x32_bf16 v[220:223], v[52:55], v[76:79], v[220:223]
v_mul_f32 v22, s79, v22
v_mul_f32 v30, s79, v30
v_mfma_f32_16x16x32_bf16 v[216:219], v[52:55], v[72:75], v[216:219]
v_mul_f32 v23, s79, v23
v_mul_f32 v31, s79, v31
v_mfma_f32_16x16x32_bf16 v[212:215], v[52:55], v[68:71], v[212:215]
s_add_u32 s72, s70, 46080
buffer_load_dwordx4 v5, s[4:7], s72 offen offset:3072 lds
v_mfma_f32_16x16x32_bf16 v[208:211], v[52:55], v[64:67], v[208:211]
v_cvt_pk_bf16_f32 v20, v20, v28
v_cvt_pk_bf16_f32 v21, v21, v29
v_mfma_f32_16x16x32_bf16 v[224:227], v[56:59], v[64:67], v[224:227]
v_cvt_pk_bf16_f32 v22, v22, v30
v_cvt_pk_bf16_f32 v23, v23, v31
v_mfma_f32_16x16x32_bf16 v[228:231], v[56:59], v[68:71], v[228:231]
buffer_store_dwordx4 v[20:23], v1, s[44:47], s80 offen sc1
v_mfma_f32_16x16x32_bf16 v[232:235], v[56:59], v[72:75], v[232:235]
v_accvgpr_read_b32 v24, a192
v_accvgpr_read_b32 v28, a193
v_mfma_f32_16x16x32_bf16 v[236:239], v[56:59], v[76:79], v[236:239]
v_accvgpr_read_b32 v25, a194
v_accvgpr_read_b32 v29, a195
v_mfma_f32_16x16x32_bf16 v[252:255], v[60:63], v[76:79], v[252:255]
s_add_u32 s80, s78, 2048
v_accvgpr_read_b32 v26, a196
v_accvgpr_read_b32 v30, a197
v_mfma_f32_16x16x32_bf16 v[248:251], v[60:63], v[72:75], v[248:251]
v_accvgpr_read_b32 v27, a198
v_accvgpr_read_b32 v31, a199
v_mfma_f32_16x16x32_bf16 v[244:247], v[60:63], v[68:71], v[244:247]
s_waitcnt vmcnt(16) lgkmcnt(0)
v_cvt_pk_bf16_f32 v24, v24, v28
v_cvt_pk_bf16_f32 v25, v25, v29
v_mfma_f32_16x16x32_bf16 v[240:243], v[60:63], v[64:67], v[240:243]
s_barrier
v_cvt_pk_bf16_f32 v26, v26, v30
v_cvt_pk_bf16_f32 v27, v27, v31
v_mfma_f32_16x16x32_bf16 v[128:131], v[80:83], v[112:115], v[128:131]
s_add_u32 s73, s62, 9
ds_read_b64_tr_b16 v[32:33], v8 offset:16384
ds_read_b64_tr_b16 v[34:35], v8 offset:17408
v_mfma_f32_16x16x32_bf16 v[132:135], v[80:83], v[116:119], v[132:135]
s_add_u32 s70, s73, s65
ds_read_b128 v[64:67], v18 offset:0
ds_read_b128 v[68:71], v18 offset:2048
v_mfma_f32_16x16x32_bf16 v[136:139], v[80:83], v[120:123], v[136:139]
s_and_b32 s70, s70, 3
ds_read_b128 v[72:75], v18 offset:4096
ds_read_b128 v[76:79], v18 offset:6144
v_mfma_f32_16x16x32_bf16 v[140:143], v[80:83], v[124:127], v[140:143]
s_and_b32 s73, s73, 12
ds_read_b64_tr_b16 v[36:37], v9 offset:16384
ds_read_b64_tr_b16 v[38:39], v9 offset:17408
v_mfma_f32_16x16x32_bf16 v[156:159], v[84:87], v[124:127], v[156:159]
s_or_b32 s73, s73, s70
ds_read_b64_tr_b16 v[40:41], v10 offset:16384
v_mfma_f32_16x16x32_bf16 v[152:155], v[84:87], v[120:123], v[152:155]
s_lshl_b32 s71, s73, 19
ds_read_b64_tr_b16 v[42:43], v10 offset:17408
v_mfma_f32_16x16x32_bf16 v[148:151], v[84:87], v[116:119], v[148:151]
s_add_u32 s71, s71, s66
ds_read_b64_tr_b16 v[44:45], v11 offset:16384
v_mfma_f32_16x16x32_bf16 v[144:147], v[84:87], v[112:115], v[144:147]
s_lshl_b32 s73, s73, 7
ds_read_b64_tr_b16 v[46:47], v11 offset:17408
v_mfma_f32_16x16x32_bf16 v[160:163], v[88:91], v[112:115], v[160:163]
s_add_u32 s69, s73, s67
ds_read_b64_tr_b16 v[48:49], v12 offset:16384
v_mfma_f32_16x16x32_bf16 v[164:167], v[88:91], v[116:119], v[164:167]
s_add_u32 s70, s73, s68
ds_read_b64_tr_b16 v[50:51], v12 offset:17408
v_mfma_f32_16x16x32_bf16 v[168:171], v[88:91], v[120:123], v[168:171]
s_add_u32 m0, s64, 0
ds_read_b64_tr_b16 v[52:53], v13 offset:16384
v_mfma_f32_16x16x32_bf16 v[172:175], v[88:91], v[124:127], v[172:175]
s_add_u32 s72, s71, 0
buffer_load_dwordx4 v6, s[12:15], s72 offen lds
v_mfma_f32_16x16x32_bf16 v[188:191], v[92:95], v[124:127], v[188:191]
s_add_u32 s72, s71, 31744
buffer_load_dwordx4 v6, s[12:15], s72 offen offset:1024 lds
v_mfma_f32_16x16x32_bf16 v[184:187], v[92:95], v[120:123], v[184:187]
s_add_u32 s72, s71, 63488
buffer_load_dwordx4 v7, s[12:15], s72 offen offset:2048 lds
v_mfma_f32_16x16x32_bf16 v[180:183], v[92:95], v[116:119], v[180:183]
s_add_u32 s72, s71, 95232
buffer_load_dwordx4 v7, s[12:15], s72 offen offset:3072 lds
v_mfma_f32_16x16x32_bf16 v[176:179], v[92:95], v[112:115], v[176:179]
ds_read_b64_tr_b16 v[54:55], v13 offset:17408
v_mfma_f32_16x16x32_bf16 v[192:195], v[96:99], v[112:115], v[192:195]
ds_read_b64_tr_b16 v[56:57], v14 offset:16384
v_mfma_f32_16x16x32_bf16 v[196:199], v[96:99], v[116:119], v[196:199]
ds_read_b64_tr_b16 v[58:59], v14 offset:17408
v_mfma_f32_16x16x32_bf16 v[200:203], v[96:99], v[120:123], v[200:203]
ds_read_b64_tr_b16 v[60:61], v15 offset:16384
v_mfma_f32_16x16x32_bf16 v[204:207], v[96:99], v[124:127], v[204:207]
s_add_u32 m0, s63, 131072
ds_read_b64_tr_b16 v[62:63], v15 offset:17408
v_mfma_f32_16x16x32_bf16 v[220:223], v[100:103], v[124:127], v[220:223]
s_add_u32 s72, s69, 0
buffer_load_dwordx4 v4, s[4:7], s72 offen lds
v_mfma_f32_16x16x32_bf16 v[216:219], v[100:103], v[120:123], v[216:219]
buffer_store_dwordx4 v[24:27], v1, s[44:47], s80 offen sc1
v_mfma_f32_16x16x32_bf16 v[212:215], v[100:103], v[116:119], v[212:215]
v_accvgpr_read_b32 v20, a68
v_accvgpr_read_b32 v28, a69
v_mfma_f32_16x16x32_bf16 v[208:211], v[100:103], v[112:115], v[208:211]
v_accvgpr_read_b32 v21, a70
v_accvgpr_read_b32 v29, a71
v_mfma_f32_16x16x32_bf16 v[224:227], v[104:107], v[112:115], v[224:227]
s_add_u32 s72, s69, 15360
buffer_load_dwordx4 v5, s[4:7], s72 offen offset:1024 lds
v_mfma_f32_16x16x32_bf16 v[228:231], v[104:107], v[116:119], v[228:231]
s_add_u32 s80, s77, 5120
v_accvgpr_read_b32 v22, a100
v_accvgpr_read_b32 v30, a101
v_mfma_f32_16x16x32_bf16 v[232:235], v[104:107], v[120:123], v[232:235]
v_accvgpr_read_b32 v23, a102
v_accvgpr_read_b32 v31, a103
v_mfma_f32_16x16x32_bf16 v[236:239], v[104:107], v[124:127], v[236:239]
v_mul_f32 v20, s79, v20
v_mul_f32 v28, s79, v28
v_mfma_f32_16x16x32_bf16 v[252:255], v[108:111], v[124:127], v[252:255]
v_mul_f32 v21, s79, v21
v_mul_f32 v29, s79, v29
v_mfma_f32_16x16x32_bf16 v[248:251], v[108:111], v[120:123], v[248:251]
s_add_u32 s72, s69, 30720
buffer_load_dwordx4 v4, s[4:7], s72 offen offset:2048 lds
v_mfma_f32_16x16x32_bf16 v[244:247], v[108:111], v[116:119], v[244:247]
v_mul_f32 v22, s79, v22
v_mul_f32 v30, s79, v30
v_mfma_f32_16x16x32_bf16 v[240:243], v[108:111], v[112:115], v[240:243]
s_waitcnt lgkmcnt(0)
v_mul_f32 v23, s79, v23
v_mul_f32 v31, s79, v31
v_mfma_f32_16x16x32_bf16 v[128:131], v[32:35], v[64:67], v[128:131]
ds_read_b64_tr_b16 v[80:81], v8 offset:24576
ds_read_b64_tr_b16 v[82:83], v8 offset:25600
v_mfma_f32_16x16x32_bf16 v[132:135], v[32:35], v[68:71], v[132:135]
ds_read_b128 v[112:115], v19 offset:0
ds_read_b128 v[116:119], v19 offset:2048
v_mfma_f32_16x16x32_bf16 v[136:139], v[32:35], v[72:75], v[136:139]
s_add_u32 s72, s69, 46080
buffer_load_dwordx4 v5, s[4:7], s72 offen offset:3072 lds
v_mfma_f32_16x16x32_bf16 v[140:143], v[32:35], v[76:79], v[140:143]
ds_read_b128 v[120:123], v19 offset:4096
ds_read_b128 v[124:127], v19 offset:6144
v_mfma_f32_16x16x32_bf16 v[156:159], v[36:39], v[76:79], v[156:159]
ds_read_b64_tr_b16 v[84:85], v9 offset:24576
ds_read_b64_tr_b16 v[86:87], v9 offset:25600
v_mfma_f32_16x16x32_bf16 v[152:155], v[36:39], v[72:75], v[152:155]
ds_read_b64_tr_b16 v[88:89], v10 offset:24576
v_cvt_pk_bf16_f32 v20, v20, v28
v_mfma_f32_16x16x32_bf16 v[148:151], v[36:39], v[68:71], v[148:151]
ds_read_b64_tr_b16 v[90:91], v10 offset:25600
v_cvt_pk_bf16_f32 v21, v21, v29
v_mfma_f32_16x16x32_bf16 v[144:147], v[36:39], v[64:67], v[144:147]
s_add_u32 m0, s63, 135168
ds_read_b64_tr_b16 v[92:93], v11 offset:24576
v_cvt_pk_bf16_f32 v22, v22, v30
v_mfma_f32_16x16x32_bf16 v[160:163], v[40:43], v[64:67], v[160:163]
s_add_u32 s72, s70, 0
buffer_load_dwordx4 v4, s[4:7], s72 offen lds
v_mfma_f32_16x16x32_bf16 v[164:167], v[40:43], v[68:71], v[164:167]
ds_read_b64_tr_b16 v[94:95], v11 offset:25600
v_cvt_pk_bf16_f32 v23, v23, v31
v_mfma_f32_16x16x32_bf16 v[168:171], v[40:43], v[72:75], v[168:171]
ds_read_b64_tr_b16 v[96:97], v12 offset:24576
v_mfma_f32_16x16x32_bf16 v[172:175], v[40:43], v[76:79], v[172:175]
ds_read_b64_tr_b16 v[98:99], v12 offset:25600
v_mfma_f32_16x16x32_bf16 v[188:191], v[44:47], v[76:79], v[188:191]
s_add_u32 s72, s70, 15360
buffer_load_dwordx4 v5, s[4:7], s72 offen offset:1024 lds
v_mfma_f32_16x16x32_bf16 v[184:187], v[44:47], v[72:75], v[184:187]
ds_read_b64_tr_b16 v[100:101], v13 offset:24576
v_mfma_f32_16x16x32_bf16 v[180:183], v[44:47], v[68:71], v[180:183]
ds_read_b64_tr_b16 v[102:103], v13 offset:25600
v_mfma_f32_16x16x32_bf16 v[176:179], v[44:47], v[64:67], v[176:179]
ds_read_b64_tr_b16 v[104:105], v14 offset:24576
v_mfma_f32_16x16x32_bf16 v[192:195], v[48:51], v[64:67], v[192:195]
ds_read_b64_tr_b16 v[106:107], v14 offset:25600
v_mfma_f32_16x16x32_bf16 v[196:199], v[48:51], v[68:71], v[196:199]
s_add_u32 s72, s70, 30720
buffer_load_dwordx4 v4, s[4:7], s72 offen offset:2048 lds
v_mfma_f32_16x16x32_bf16 v[200:203], v[48:51], v[72:75], v[200:203]
ds_read_b64_tr_b16 v[108:109], v15 offset:24576
v_mfma_f32_16x16x32_bf16 v[204:207], v[48:51], v[76:79], v[204:207]
ds_read_b64_tr_b16 v[110:111], v15 offset:25600
v_mfma_f32_16x16x32_bf16 v[220:223], v[52:55], v[76:79], v[220:223]
buffer_store_dwordx4 v[20:23], v1, s[44:47], s80 offen sc1
v_mfma_f32_16x16x32_bf16 v[216:219], v[52:55], v[72:75], v[216:219]
v_accvgpr_read_b32 v24, a200
v_accvgpr_read_b32 v28, a201
v_mfma_f32_16x16x32_bf16 v[212:215], v[52:55], v[68:71], v[212:215]
s_add_u32 s72, s70, 46080
buffer_load_dwordx4 v5, s[4:7], s72 offen offset:3072 lds
v_mfma_f32_16x16x32_bf16 v[208:211], v[52:55], v[64:67], v[208:211]
v_accvgpr_read_b32 v25, a202
v_accvgpr_read_b32 v29, a203
v_mfma_f32_16x16x32_bf16 v[224:227], v[56:59], v[64:67], v[224:227]
s_add_u32 s80, s78, 10240
v_accvgpr_read_b32 v26, a204
v_accvgpr_read_b32 v30, a205
v_mfma_f32_16x16x32_bf16 v[228:231], v[56:59], v[68:71], v[228:231]
v_accvgpr_read_b32 v27, a206
v_accvgpr_read_b32 v31, a207
v_mfma_f32_16x16x32_bf16 v[232:235], v[56:59], v[72:75], v[232:235]
v_cvt_pk_bf16_f32 v24, v24, v28
v_cvt_pk_bf16_f32 v25, v25, v29
v_mfma_f32_16x16x32_bf16 v[236:239], v[56:59], v[76:79], v[236:239]
v_cvt_pk_bf16_f32 v26, v26, v30
v_cvt_pk_bf16_f32 v27, v27, v31
v_mfma_f32_16x16x32_bf16 v[252:255], v[60:63], v[76:79], v[252:255]
buffer_store_dwordx4 v[24:27], v1, s[44:47], s80 offen sc1
v_mfma_f32_16x16x32_bf16 v[248:251], v[60:63], v[72:75], v[248:251]
v_mfma_f32_16x16x32_bf16 v[244:247], v[60:63], v[68:71], v[244:247]
s_waitcnt vmcnt(16) lgkmcnt(0)
v_mfma_f32_16x16x32_bf16 v[240:243], v[60:63], v[64:67], v[240:243]
s_barrier
v_mfma_f32_16x16x32_bf16 v[128:131], v[80:83], v[112:115], v[128:131]
s_add_u32 s73, s62, 10
ds_read_b64_tr_b16 v[32:33], v8 offset:32768
ds_read_b64_tr_b16 v[34:35], v8 offset:33792
v_mfma_f32_16x16x32_bf16 v[132:135], v[80:83], v[116:119], v[132:135]
s_add_u32 s70, s73, s65
ds_read_b128 v[64:67], v18 offset:32768
ds_read_b128 v[68:71], v18 offset:34816
v_mfma_f32_16x16x32_bf16 v[136:139], v[80:83], v[120:123], v[136:139]
s_and_b32 s70, s70, 3
ds_read_b128 v[72:75], v18 offset:36864
ds_read_b128 v[76:79], v18 offset:38912
v_mfma_f32_16x16x32_bf16 v[140:143], v[80:83], v[124:127], v[140:143]
s_and_b32 s73, s73, 12
ds_read_b64_tr_b16 v[36:37], v9 offset:32768
ds_read_b64_tr_b16 v[38:39], v9 offset:33792
v_mfma_f32_16x16x32_bf16 v[156:159], v[84:87], v[124:127], v[156:159]
s_or_b32 s73, s73, s70
ds_read_b64_tr_b16 v[40:41], v10 offset:32768
v_accvgpr_read_b32 v20, a72
v_mfma_f32_16x16x32_bf16 v[152:155], v[84:87], v[120:123], v[152:155]
s_lshl_b32 s71, s73, 19
ds_read_b64_tr_b16 v[42:43], v10 offset:33792
v_accvgpr_read_b32 v28, a73
v_mfma_f32_16x16x32_bf16 v[148:151], v[84:87], v[116:119], v[148:151]
s_add_u32 s71, s71, s66
ds_read_b64_tr_b16 v[44:45], v11 offset:32768
v_accvgpr_read_b32 v21, a74
v_mfma_f32_16x16x32_bf16 v[144:147], v[84:87], v[112:115], v[144:147]
s_lshl_b32 s73, s73, 7
ds_read_b64_tr_b16 v[46:47], v11 offset:33792
v_accvgpr_read_b32 v29, a75
v_mfma_f32_16x16x32_bf16 v[160:163], v[88:91], v[112:115], v[160:163]
s_add_u32 s69, s73, s67
ds_read_b64_tr_b16 v[48:49], v12 offset:32768
v_mfma_f32_16x16x32_bf16 v[164:167], v[88:91], v[116:119], v[164:167]
s_add_u32 s70, s73, s68
ds_read_b64_tr_b16 v[50:51], v12 offset:33792
v_mfma_f32_16x16x32_bf16 v[168:171], v[88:91], v[120:123], v[168:171]
s_add_u32 m0, s64, 16384
ds_read_b64_tr_b16 v[52:53], v13 offset:32768
v_mfma_f32_16x16x32_bf16 v[172:175], v[88:91], v[124:127], v[172:175]
s_add_u32 s72, s71, 0
buffer_load_dwordx4 v6, s[12:15], s72 offen lds
v_mfma_f32_16x16x32_bf16 v[188:191], v[92:95], v[124:127], v[188:191]
s_add_u32 s72, s71, 31744
buffer_load_dwordx4 v6, s[12:15], s72 offen offset:1024 lds
v_mfma_f32_16x16x32_bf16 v[184:187], v[92:95], v[120:123], v[184:187]
s_add_u32 s72, s71, 63488
buffer_load_dwordx4 v7, s[12:15], s72 offen offset:2048 lds
v_mfma_f32_16x16x32_bf16 v[180:183], v[92:95], v[116:119], v[180:183]
s_add_u32 s72, s71, 95232
buffer_load_dwordx4 v7, s[12:15], s72 offen offset:3072 lds
v_mfma_f32_16x16x32_bf16 v[176:179], v[92:95], v[112:115], v[176:179]
s_add_u32 s80, s77, 9216
ds_read_b64_tr_b16 v[54:55], v13 offset:33792
v_accvgpr_read_b32 v22, a104
v_mfma_f32_16x16x32_bf16 v[192:195], v[96:99], v[112:115], v[192:195]
ds_read_b64_tr_b16 v[56:57], v14 offset:32768
v_accvgpr_read_b32 v30, a105
v_mfma_f32_16x16x32_bf16 v[196:199], v[96:99], v[116:119], v[196:199]
ds_read_b64_tr_b16 v[58:59], v14 offset:33792
v_accvgpr_read_b32 v23, a106
v_mfma_f32_16x16x32_bf16 v[200:203], v[96:99], v[120:123], v[200:203]
ds_read_b64_tr_b16 v[60:61], v15 offset:32768
v_accvgpr_read_b32 v31, a107
v_mfma_f32_16x16x32_bf16 v[204:207], v[96:99], v[124:127], v[204:207]
s_add_u32 m0, s63, 65536
ds_read_b64_tr_b16 v[62:63], v15 offset:33792
v_mul_f32 v20, s79, v20
v_mfma_f32_16x16x32_bf16 v[220:223], v[100:103], v[124:127], v[220:223]
s_add_u32 s72, s69, 0
buffer_load_dwordx4 v4, s[4:7], s72 offen lds
v_mfma_f32_16x16x32_bf16 v[216:219], v[100:103], v[120:123], v[216:219]
v_mul_f32 v28, s79, v28
v_mul_f32 v21, s79, v21
v_mfma_f32_16x16x32_bf16 v[212:215], v[100:103], v[116:119], v[212:215]
v_mul_f32 v29, s79, v29
v_mul_f32 v22, s79, v22
v_mfma_f32_16x16x32_bf16 v[208:211], v[100:103], v[112:115], v[208:211]
v_mul_f32 v30, s79, v30
v_mul_f32 v23, s79, v23
v_mfma_f32_16x16x32_bf16 v[224:227], v[104:107], v[112:115], v[224:227]
s_add_u32 s72, s69, 15360
buffer_load_dwordx4 v5, s[4:7], s72 offen offset:1024 lds
v_mfma_f32_16x16x32_bf16 v[228:231], v[104:107], v[116:119], v[228:231]
v_mul_f32 v31, s79, v31
v_cvt_pk_bf16_f32 v20, v20, v28
v_mfma_f32_16x16x32_bf16 v[232:235], v[104:107], v[120:123], v[232:235]
v_cvt_pk_bf16_f32 v21, v21, v29
v_cvt_pk_bf16_f32 v22, v22, v30
v_mfma_f32_16x16x32_bf16 v[236:239], v[104:107], v[124:127], v[236:239]
v_cvt_pk_bf16_f32 v23, v23, v31
v_mfma_f32_16x16x32_bf16 v[252:255], v[108:111], v[124:127], v[252:255]
buffer_store_dwordx4 v[20:23], v1, s[44:47], s80 offen sc1
v_mfma_f32_16x16x32_bf16 v[248:251], v[108:111], v[120:123], v[248:251]
s_add_u32 s72, s69, 30720
buffer_load_dwordx4 v4, s[4:7], s72 offen offset:2048 lds
v_mfma_f32_16x16x32_bf16 v[244:247], v[108:111], v[116:119], v[244:247]
v_accvgpr_read_b32 v24, a208
v_accvgpr_read_b32 v28, a209
v_mfma_f32_16x16x32_bf16 v[240:243], v[108:111], v[112:115], v[240:243]
s_waitcnt lgkmcnt(0)
v_accvgpr_read_b32 v25, a210
v_accvgpr_read_b32 v29, a211
LcB1:
v_mfma_f32_16x16x32_bf16 v[128:131], v[32:35], v[64:67], v[128:131]
s_add_u32 s80, s78, 34816
ds_read_b64_tr_b16 v[80:81], v8 offset:40960
ds_read_b64_tr_b16 v[82:83], v8 offset:41984
v_mfma_f32_16x16x32_bf16 v[132:135], v[32:35], v[68:71], v[132:135]
ds_read_b128 v[112:115], v19 offset:32768
ds_read_b128 v[116:119], v19 offset:34816
v_mfma_f32_16x16x32_bf16 v[136:139], v[32:35], v[72:75], v[136:139]
s_add_u32 s72, s69, 46080
buffer_load_dwordx4 v5, s[4:7], s72 offen offset:3072 lds
v_mfma_f32_16x16x32_bf16 v[140:143], v[32:35], v[76:79], v[140:143]
ds_read_b128 v[120:123], v19 offset:36864
ds_read_b128 v[124:127], v19 offset:38912
v_mfma_f32_16x16x32_bf16 v[156:159], v[36:39], v[76:79], v[156:159]
ds_read_b64_tr_b16 v[84:85], v9 offset:40960
ds_read_b64_tr_b16 v[86:87], v9 offset:41984
v_mfma_f32_16x16x32_bf16 v[152:155], v[36:39], v[72:75], v[152:155]
ds_read_b64_tr_b16 v[88:89], v10 offset:40960
v_accvgpr_read_b32 v26, a212
v_mfma_f32_16x16x32_bf16 v[148:151], v[36:39], v[68:71], v[148:151]
ds_read_b64_tr_b16 v[90:91], v10 offset:41984
v_accvgpr_read_b32 v30, a213
v_mfma_f32_16x16x32_bf16 v[144:147], v[36:39], v[64:67], v[144:147]
s_add_u32 m0, s63, 69632
ds_read_b64_tr_b16 v[92:93], v11 offset:40960
v_accvgpr_read_b32 v27, a214
v_mfma_f32_16x16x32_bf16 v[160:163], v[40:43], v[64:67], v[160:163]
s_add_u32 s72, s70, 0
buffer_load_dwordx4 v4, s[4:7], s72 offen lds
v_mfma_f32_16x16x32_bf16 v[164:167], v[40:43], v[68:71], v[164:167]
ds_read_b64_tr_b16 v[94:95], v11 offset:41984
v_accvgpr_read_b32 v31, a215
v_mfma_f32_16x16x32_bf16 v[168:171], v[40:43], v[72:75], v[168:171]
ds_read_b64_tr_b16 v[96:97], v12 offset:40960
v_cvt_pk_bf16_f32 v24, v24, v28
v_mfma_f32_16x16x32_bf16 v[172:175], v[40:43], v[76:79], v[172:175]
ds_read_b64_tr_b16 v[98:99], v12 offset:41984
v_cvt_pk_bf16_f32 v25, v25, v29
v_mfma_f32_16x16x32_bf16 v[188:191], v[44:47], v[76:79], v[188:191]
s_add_u32 s72, s70, 15360
buffer_load_dwordx4 v5, s[4:7], s72 offen offset:1024 lds
v_mfma_f32_16x16x32_bf16 v[184:187], v[44:47], v[72:75], v[184:187]
ds_read_b64_tr_b16 v[100:101], v13 offset:40960
v_cvt_pk_bf16_f32 v26, v26, v30
v_mfma_f32_16x16x32_bf16 v[180:183], v[44:47], v[68:71], v[180:183]
ds_read_b64_tr_b16 v[102:103], v13 offset:41984
v_cvt_pk_bf16_f32 v27, v27, v31
v_mfma_f32_16x16x32_bf16 v[176:179], v[44:47], v[64:67], v[176:179]
ds_read_b64_tr_b16 v[104:105], v14 offset:40960
v_mfma_f32_16x16x32_bf16 v[192:195], v[48:51], v[64:67], v[192:195]
ds_read_b64_tr_b16 v[106:107], v14 offset:41984
v_mfma_f32_16x16x32_bf16 v[196:199], v[48:51], v[68:71], v[196:199]
s_add_u32 s72, s70, 30720
buffer_load_dwordx4 v4, s[4:7], s72 offen offset:2048 lds
v_mfma_f32_16x16x32_bf16 v[200:203], v[48:51], v[72:75], v[200:203]
ds_read_b64_tr_b16 v[108:109], v15 offset:40960
v_mfma_f32_16x16x32_bf16 v[204:207], v[48:51], v[76:79], v[204:207]
ds_read_b64_tr_b16 v[110:111], v15 offset:41984
v_mfma_f32_16x16x32_bf16 v[220:223], v[52:55], v[76:79], v[220:223]
buffer_store_dwordx4 v[24:27], v1, s[44:47], s80 offen sc1
v_mfma_f32_16x16x32_bf16 v[216:219], v[52:55], v[72:75], v[216:219]
v_accvgpr_read_b32 v20, a76
v_accvgpr_read_b32 v28, a77
v_mfma_f32_16x16x32_bf16 v[212:215], v[52:55], v[68:71], v[212:215]
s_add_u32 s72, s70, 46080
buffer_load_dwordx4 v5, s[4:7], s72 offen offset:3072 lds
v_mfma_f32_16x16x32_bf16 v[208:211], v[52:55], v[64:67], v[208:211]
v_accvgpr_read_b32 v21, a78
v_accvgpr_read_b32 v29, a79
v_mfma_f32_16x16x32_bf16 v[224:227], v[56:59], v[64:67], v[224:227]
s_add_u32 s80, s77, 13312
v_accvgpr_read_b32 v22, a108
v_accvgpr_read_b32 v30, a109
v_mfma_f32_16x16x32_bf16 v[228:231], v[56:59], v[68:71], v[228:231]
v_accvgpr_read_b32 v23, a110
v_accvgpr_read_b32 v31, a111
v_mfma_f32_16x16x32_bf16 v[232:235], v[56:59], v[72:75], v[232:235]
v_mul_f32 v20, s79, v20
v_mul_f32 v28, s79, v28
v_mfma_f32_16x16x32_bf16 v[236:239], v[56:59], v[76:79], v[236:239]
v_mul_f32 v21, s79, v21
v_mul_f32 v29, s79, v29
v_mfma_f32_16x16x32_bf16 v[252:255], v[60:63], v[76:79], v[252:255]
v_mul_f32 v22, s79, v22
v_mul_f32 v30, s79, v30
v_mfma_f32_16x16x32_bf16 v[248:251], v[60:63], v[72:75], v[248:251]
v_mul_f32 v23, s79, v23
v_mul_f32 v31, s79, v31
v_mfma_f32_16x16x32_bf16 v[244:247], v[60:63], v[68:71], v[244:247]
s_waitcnt vmcnt(15) lgkmcnt(0)
v_cvt_pk_bf16_f32 v20, v20, v28
v_cvt_pk_bf16_f32 v21, v21, v29
v_mfma_f32_16x16x32_bf16 v[240:243], v[60:63], v[64:67], v[240:243]
s_barrier
v_cvt_pk_bf16_f32 v22, v22, v30
v_cvt_pk_bf16_f32 v23, v23, v31
v_mfma_f32_16x16x32_bf16 v[128:131], v[80:83], v[112:115], v[128:131]
s_add_u32 s73, s62, 11
ds_read_b64_tr_b16 v[32:33], v8 offset:0
ds_read_b64_tr_b16 v[34:35], v8 offset:1024
v_mfma_f32_16x16x32_bf16 v[132:135], v[80:83], v[116:119], v[132:135]
s_add_u32 s70, s73, s65
ds_read_b128 v[64:67], v16 offset:0
ds_read_b128 v[68:71], v16 offset:2048
v_mfma_f32_16x16x32_bf16 v[136:139], v[80:83], v[120:123], v[136:139]
s_and_b32 s70, s70, 3
ds_read_b128 v[72:75], v16 offset:4096
ds_read_b128 v[76:79], v16 offset:6144
v_mfma_f32_16x16x32_bf16 v[140:143], v[80:83], v[124:127], v[140:143]
s_and_b32 s73, s73, 12
ds_read_b64_tr_b16 v[36:37], v9 offset:0
ds_read_b64_tr_b16 v[38:39], v9 offset:1024
v_mfma_f32_16x16x32_bf16 v[156:159], v[84:87], v[124:127], v[156:159]
s_or_b32 s73, s73, s70
ds_read_b64_tr_b16 v[40:41], v10 offset:0
v_mfma_f32_16x16x32_bf16 v[152:155], v[84:87], v[120:123], v[152:155]
s_lshl_b32 s71, s73, 19
ds_read_b64_tr_b16 v[42:43], v10 offset:1024
v_mfma_f32_16x16x32_bf16 v[148:151], v[84:87], v[116:119], v[148:151]
s_add_u32 s71, s71, s66
ds_read_b64_tr_b16 v[44:45], v11 offset:0
v_mfma_f32_16x16x32_bf16 v[144:147], v[84:87], v[112:115], v[144:147]
s_lshl_b32 s73, s73, 7
ds_read_b64_tr_b16 v[46:47], v11 offset:1024
v_mfma_f32_16x16x32_bf16 v[160:163], v[88:91], v[112:115], v[160:163]
s_add_u32 s69, s73, s67
ds_read_b64_tr_b16 v[48:49], v12 offset:0
v_mfma_f32_16x16x32_bf16 v[164:167], v[88:91], v[116:119], v[164:167]
s_add_u32 s70, s73, s68
ds_read_b64_tr_b16 v[50:51], v12 offset:1024
v_mfma_f32_16x16x32_bf16 v[168:171], v[88:91], v[120:123], v[168:171]
s_add_u32 m0, s64, 32768
ds_read_b64_tr_b16 v[52:53], v13 offset:0
v_mfma_f32_16x16x32_bf16 v[172:175], v[88:91], v[124:127], v[172:175]
s_add_u32 s72, s71, 0
buffer_load_dwordx4 v6, s[12:15], s72 offen lds
v_mfma_f32_16x16x32_bf16 v[188:191], v[92:95], v[124:127], v[188:191]
s_add_u32 s72, s71, 31744
buffer_load_dwordx4 v6, s[12:15], s72 offen offset:1024 lds
v_mfma_f32_16x16x32_bf16 v[184:187], v[92:95], v[120:123], v[184:187]
s_add_u32 s72, s71, 63488
buffer_load_dwordx4 v7, s[12:15], s72 offen offset:2048 lds
v_mfma_f32_16x16x32_bf16 v[180:183], v[92:95], v[116:119], v[180:183]
s_add_u32 s72, s71, 95232
buffer_load_dwordx4 v7, s[12:15], s72 offen offset:3072 lds
v_mfma_f32_16x16x32_bf16 v[176:179], v[92:95], v[112:115], v[176:179]
ds_read_b64_tr_b16 v[54:55], v13 offset:1024
v_mfma_f32_16x16x32_bf16 v[192:195], v[96:99], v[112:115], v[192:195]
ds_read_b64_tr_b16 v[56:57], v14 offset:0
v_mfma_f32_16x16x32_bf16 v[196:199], v[96:99], v[116:119], v[196:199]
ds_read_b64_tr_b16 v[58:59], v14 offset:1024
v_mfma_f32_16x16x32_bf16 v[200:203], v[96:99], v[120:123], v[200:203]
ds_read_b64_tr_b16 v[60:61], v15 offset:0
v_mfma_f32_16x16x32_bf16 v[204:207], v[96:99], v[124:127], v[204:207]
s_add_u32 m0, s63, 98304
ds_read_b64_tr_b16 v[62:63], v15 offset:1024
v_mfma_f32_16x16x32_bf16 v[220:223], v[100:103], v[124:127], v[220:223]
s_add_u32 s72, s69, 0
buffer_load_dwordx4 v4, s[4:7], s72 offen lds
v_mfma_f32_16x16x32_bf16 v[216:219], v[100:103], v[120:123], v[216:219]
buffer_store_dwordx4 v[20:23], v1, s[44:47], s80 offen sc1
v_mfma_f32_16x16x32_bf16 v[212:215], v[100:103], v[116:119], v[212:215]
v_accvgpr_read_b32 v24, a216
v_accvgpr_read_b32 v28, a217
v_mfma_f32_16x16x32_bf16 v[208:211], v[100:103], v[112:115], v[208:211]
v_accvgpr_read_b32 v25, a218
v_accvgpr_read_b32 v29, a219
v_mfma_f32_16x16x32_bf16 v[224:227], v[104:107], v[112:115], v[224:227]
s_add_u32 s72, s69, 15360
buffer_load_dwordx4 v5, s[4:7], s72 offen offset:1024 lds
v_mfma_f32_16x16x32_bf16 v[228:231], v[104:107], v[116:119], v[228:231]
s_add_u32 s80, s78, 43008
v_accvgpr_read_b32 v26, a220
v_accvgpr_read_b32 v30, a221
v_mfma_f32_16x16x32_bf16 v[232:235], v[104:107], v[120:123], v[232:235]
v_accvgpr_read_b32 v27, a222
v_accvgpr_read_b32 v31, a223
v_mfma_f32_16x16x32_bf16 v[236:239], v[104:107], v[124:127], v[236:239]
v_cvt_pk_bf16_f32 v24, v24, v28
v_cvt_pk_bf16_f32 v25, v25, v29
v_mfma_f32_16x16x32_bf16 v[252:255], v[108:111], v[124:127], v[252:255]
v_cvt_pk_bf16_f32 v26, v26, v30
v_cvt_pk_bf16_f32 v27, v27, v31
v_mfma_f32_16x16x32_bf16 v[248:251], v[108:111], v[120:123], v[248:251]
s_add_u32 s72, s69, 30720
buffer_load_dwordx4 v4, s[4:7], s72 offen offset:2048 lds
v_mfma_f32_16x16x32_bf16 v[244:247], v[108:111], v[116:119], v[244:247]
buffer_store_dwordx4 v[24:27], v1, s[44:47], s80 offen sc1
v_mfma_f32_16x16x32_bf16 v[240:243], v[108:111], v[112:115], v[240:243]
s_waitcnt lgkmcnt(0)
v_mfma_f32_16x16x32_bf16 v[128:131], v[32:35], v[64:67], v[128:131]
ds_read_b64_tr_b16 v[80:81], v8 offset:8192
ds_read_b64_tr_b16 v[82:83], v8 offset:9216
v_mfma_f32_16x16x32_bf16 v[132:135], v[32:35], v[68:71], v[132:135]
ds_read_b128 v[112:115], v17 offset:0
ds_read_b128 v[116:119], v17 offset:2048
v_mfma_f32_16x16x32_bf16 v[136:139], v[32:35], v[72:75], v[136:139]
s_add_u32 s72, s69, 46080
buffer_load_dwordx4 v5, s[4:7], s72 offen offset:3072 lds
v_mfma_f32_16x16x32_bf16 v[140:143], v[32:35], v[76:79], v[140:143]
ds_read_b128 v[120:123], v17 offset:4096
ds_read_b128 v[124:127], v17 offset:6144
v_mfma_f32_16x16x32_bf16 v[156:159], v[36:39], v[76:79], v[156:159]
ds_read_b64_tr_b16 v[84:85], v9 offset:8192
ds_read_b64_tr_b16 v[86:87], v9 offset:9216
v_mfma_f32_16x16x32_bf16 v[152:155], v[36:39], v[72:75], v[152:155]
ds_read_b64_tr_b16 v[88:89], v10 offset:8192
v_accvgpr_read_b32 v20, a80
v_mfma_f32_16x16x32_bf16 v[148:151], v[36:39], v[68:71], v[148:151]
ds_read_b64_tr_b16 v[90:91], v10 offset:9216
v_accvgpr_read_b32 v28, a81
v_mfma_f32_16x16x32_bf16 v[144:147], v[36:39], v[64:67], v[144:147]
s_add_u32 m0, s63, 102400
ds_read_b64_tr_b16 v[92:93], v11 offset:8192
v_accvgpr_read_b32 v21, a82
v_mfma_f32_16x16x32_bf16 v[160:163], v[40:43], v[64:67], v[160:163]
s_add_u32 s72, s70, 0
buffer_load_dwordx4 v4, s[4:7], s72 offen lds
v_mfma_f32_16x16x32_bf16 v[164:167], v[40:43], v[68:71], v[164:167]
ds_read_b64_tr_b16 v[94:95], v11 offset:9216
v_accvgpr_read_b32 v29, a83
v_mfma_f32_16x16x32_bf16 v[168:171], v[40:43], v[72:75], v[168:171]
s_add_u32 s80, s77, 33792
ds_read_b64_tr_b16 v[96:97], v12 offset:8192
v_accvgpr_read_b32 v22, a112
v_mfma_f32_16x16x32_bf16 v[172:175], v[40:43], v[76:79], v[172:175]
ds_read_b64_tr_b16 v[98:99], v12 offset:9216
v_accvgpr_read_b32 v30, a113
v_mfma_f32_16x16x32_bf16 v[188:191], v[44:47], v[76:79], v[188:191]
s_add_u32 s72, s70, 15360
buffer_load_dwordx4 v5, s[4:7], s72 offen offset:1024 lds
v_mfma_f32_16x16x32_bf16 v[184:187], v[44:47], v[72:75], v[184:187]
ds_read_b64_tr_b16 v[100:101], v13 offset:8192
v_accvgpr_read_b32 v23, a114
v_mfma_f32_16x16x32_bf16 v[180:183], v[44:47], v[68:71], v[180:183]
ds_read_b64_tr_b16 v[102:103], v13 offset:9216
v_accvgpr_read_b32 v31, a115
v_mfma_f32_16x16x32_bf16 v[176:179], v[44:47], v[64:67], v[176:179]
ds_read_b64_tr_b16 v[104:105], v14 offset:8192
v_mul_f32 v20, s79, v20
v_mfma_f32_16x16x32_bf16 v[192:195], v[48:51], v[64:67], v[192:195]
ds_read_b64_tr_b16 v[106:107], v14 offset:9216
v_mul_f32 v28, s79, v28
v_mfma_f32_16x16x32_bf16 v[196:199], v[48:51], v[68:71], v[196:199]
s_add_u32 s72, s70, 30720
buffer_load_dwordx4 v4, s[4:7], s72 offen offset:2048 lds
v_mfma_f32_16x16x32_bf16 v[200:203], v[48:51], v[72:75], v[200:203]
ds_read_b64_tr_b16 v[108:109], v15 offset:8192
v_mul_f32 v21, s79, v21
v_mfma_f32_16x16x32_bf16 v[204:207], v[48:51], v[76:79], v[204:207]
ds_read_b64_tr_b16 v[110:111], v15 offset:9216
v_mul_f32 v29, s79, v29
v_mfma_f32_16x16x32_bf16 v[220:223], v[52:55], v[76:79], v[220:223]
v_mul_f32 v22, s79, v22
v_mul_f32 v30, s79, v30
v_mfma_f32_16x16x32_bf16 v[216:219], v[52:55], v[72:75], v[216:219]
v_mul_f32 v23, s79, v23
v_mul_f32 v31, s79, v31
v_mfma_f32_16x16x32_bf16 v[212:215], v[52:55], v[68:71], v[212:215]
s_add_u32 s72, s70, 46080
buffer_load_dwordx4 v5, s[4:7], s72 offen offset:3072 lds
v_mfma_f32_16x16x32_bf16 v[208:211], v[52:55], v[64:67], v[208:211]
v_cvt_pk_bf16_f32 v20, v20, v28
v_cvt_pk_bf16_f32 v21, v21, v29
v_mfma_f32_16x16x32_bf16 v[224:227], v[56:59], v[64:67], v[224:227]
v_cvt_pk_bf16_f32 v22, v22, v30
v_cvt_pk_bf16_f32 v23, v23, v31
v_mfma_f32_16x16x32_bf16 v[228:231], v[56:59], v[68:71], v[228:231]
buffer_store_dwordx4 v[20:23], v1, s[44:47], s80 offen sc1
v_mfma_f32_16x16x32_bf16 v[232:235], v[56:59], v[72:75], v[232:235]
v_accvgpr_read_b32 v24, a224
v_accvgpr_read_b32 v28, a225
v_mfma_f32_16x16x32_bf16 v[236:239], v[56:59], v[76:79], v[236:239]
v_accvgpr_read_b32 v25, a226
v_accvgpr_read_b32 v29, a227
v_mfma_f32_16x16x32_bf16 v[252:255], v[60:63], v[76:79], v[252:255]
s_add_u32 s80, s78, 3072
v_accvgpr_read_b32 v26, a228
v_accvgpr_read_b32 v30, a229
v_mfma_f32_16x16x32_bf16 v[248:251], v[60:63], v[72:75], v[248:251]
v_accvgpr_read_b32 v27, a230
v_accvgpr_read_b32 v31, a231
v_mfma_f32_16x16x32_bf16 v[244:247], v[60:63], v[68:71], v[244:247]
s_waitcnt vmcnt(15) lgkmcnt(0)
v_cvt_pk_bf16_f32 v24, v24, v28
v_cvt_pk_bf16_f32 v25, v25, v29
v_mfma_f32_16x16x32_bf16 v[240:243], v[60:63], v[64:67], v[240:243]
s_barrier
v_cvt_pk_bf16_f32 v26, v26, v30
v_cvt_pk_bf16_f32 v27, v27, v31
v_mfma_f32_16x16x32_bf16 v[128:131], v[80:83], v[112:115], v[128:131]
s_add_u32 s73, s62, 12
ds_read_b64_tr_b16 v[32:33], v8 offset:16384
ds_read_b64_tr_b16 v[34:35], v8 offset:17408
v_mfma_f32_16x16x32_bf16 v[132:135], v[80:83], v[116:119], v[132:135]
s_add_u32 s70, s73, s65
ds_read_b128 v[64:67], v18 offset:0
ds_read_b128 v[68:71], v18 offset:2048
v_mfma_f32_16x16x32_bf16 v[136:139], v[80:83], v[120:123], v[136:139]
s_and_b32 s70, s70, 3
ds_read_b128 v[72:75], v18 offset:4096
ds_read_b128 v[76:79], v18 offset:6144
v_mfma_f32_16x16x32_bf16 v[140:143], v[80:83], v[124:127], v[140:143]
s_and_b32 s73, s73, 12
ds_read_b64_tr_b16 v[36:37], v9 offset:16384
ds_read_b64_tr_b16 v[38:39], v9 offset:17408
v_mfma_f32_16x16x32_bf16 v[156:159], v[84:87], v[124:127], v[156:159]
s_or_b32 s73, s73, s70
ds_read_b64_tr_b16 v[40:41], v10 offset:16384
v_mfma_f32_16x16x32_bf16 v[152:155], v[84:87], v[120:123], v[152:155]
s_lshl_b32 s71, s73, 19
ds_read_b64_tr_b16 v[42:43], v10 offset:17408
v_mfma_f32_16x16x32_bf16 v[148:151], v[84:87], v[116:119], v[148:151]
s_add_u32 s71, s71, s66
ds_read_b64_tr_b16 v[44:45], v11 offset:16384
v_mfma_f32_16x16x32_bf16 v[144:147], v[84:87], v[112:115], v[144:147]
s_lshl_b32 s73, s73, 7
ds_read_b64_tr_b16 v[46:47], v11 offset:17408
v_mfma_f32_16x16x32_bf16 v[160:163], v[88:91], v[112:115], v[160:163]
s_add_u32 s69, s73, s67
ds_read_b64_tr_b16 v[48:49], v12 offset:16384
v_mfma_f32_16x16x32_bf16 v[164:167], v[88:91], v[116:119], v[164:167]
s_add_u32 s70, s73, s68
ds_read_b64_tr_b16 v[50:51], v12 offset:17408
v_mfma_f32_16x16x32_bf16 v[168:171], v[88:91], v[120:123], v[168:171]
s_add_u32 m0, s64, 0
ds_read_b64_tr_b16 v[52:53], v13 offset:16384
v_mfma_f32_16x16x32_bf16 v[172:175], v[88:91], v[124:127], v[172:175]
s_add_u32 s72, s71, 0
buffer_load_dwordx4 v6, s[12:15], s72 offen lds
v_mfma_f32_16x16x32_bf16 v[188:191], v[92:95], v[124:127], v[188:191]
s_add_u32 s72, s71, 31744
buffer_load_dwordx4 v6, s[12:15], s72 offen offset:1024 lds
v_mfma_f32_16x16x32_bf16 v[184:187], v[92:95], v[120:123], v[184:187]
s_add_u32 s72, s71, 63488
buffer_load_dwordx4 v7, s[12:15], s72 offen offset:2048 lds
v_mfma_f32_16x16x32_bf16 v[180:183], v[92:95], v[116:119], v[180:183]
s_add_u32 s72, s71, 95232
buffer_load_dwordx4 v7, s[12:15], s72 offen offset:3072 lds
v_mfma_f32_16x16x32_bf16 v[176:179], v[92:95], v[112:115], v[176:179]
ds_read_b64_tr_b16 v[54:55], v13 offset:17408
v_mfma_f32_16x16x32_bf16 v[192:195], v[96:99], v[112:115], v[192:195]
ds_read_b64_tr_b16 v[56:57], v14 offset:16384
v_mfma_f32_16x16x32_bf16 v[196:199], v[96:99], v[116:119], v[196:199]
ds_read_b64_tr_b16 v[58:59], v14 offset:17408
v_mfma_f32_16x16x32_bf16 v[200:203], v[96:99], v[120:123], v[200:203]
ds_read_b64_tr_b16 v[60:61], v15 offset:16384
v_mfma_f32_16x16x32_bf16 v[204:207], v[96:99], v[124:127], v[204:207]
s_add_u32 m0, s63, 131072
ds_read_b64_tr_b16 v[62:63], v15 offset:17408
v_mfma_f32_16x16x32_bf16 v[220:223], v[100:103], v[124:127], v[220:223]
s_add_u32 s72, s69, 0
buffer_load_dwordx4 v4, s[4:7], s72 offen lds
v_mfma_f32_16x16x32_bf16 v[216:219], v[100:103], v[120:123], v[216:219]
buffer_store_dwordx4 v[24:27], v1, s[44:47], s80 offen sc1
v_mfma_f32_16x16x32_bf16 v[212:215], v[100:103], v[116:119], v[212:215]
v_accvgpr_read_b32 v20, a84
v_accvgpr_read_b32 v28, a85
v_mfma_f32_16x16x32_bf16 v[208:211], v[100:103], v[112:115], v[208:211]
v_accvgpr_read_b32 v21, a86
v_accvgpr_read_b32 v29, a87
v_mfma_f32_16x16x32_bf16 v[224:227], v[104:107], v[112:115], v[224:227]
s_add_u32 s72, s69, 15360
buffer_load_dwordx4 v5, s[4:7], s72 offen offset:1024 lds
v_mfma_f32_16x16x32_bf16 v[228:231], v[104:107], v[116:119], v[228:231]
s_add_u32 s80, s77, 37888
v_accvgpr_read_b32 v22, a116
v_accvgpr_read_b32 v30, a117
v_mfma_f32_16x16x32_bf16 v[232:235], v[104:107], v[120:123], v[232:235]
v_accvgpr_read_b32 v23, a118
v_accvgpr_read_b32 v31, a119
v_mfma_f32_16x16x32_bf16 v[236:239], v[104:107], v[124:127], v[236:239]
v_mul_f32 v20, s79, v20
v_mul_f32 v28, s79, v28
v_mfma_f32_16x16x32_bf16 v[252:255], v[108:111], v[124:127], v[252:255]
v_mul_f32 v21, s79, v21
v_mul_f32 v29, s79, v29
v_mfma_f32_16x16x32_bf16 v[248:251], v[108:111], v[120:123], v[248:251]
s_add_u32 s72, s69, 30720
buffer_load_dwordx4 v4, s[4:7], s72 offen offset:2048 lds
v_mfma_f32_16x16x32_bf16 v[244:247], v[108:111], v[116:119], v[244:247]
v_mul_f32 v22, s79, v22
v_mul_f32 v30, s79, v30
v_mfma_f32_16x16x32_bf16 v[240:243], v[108:111], v[112:115], v[240:243]
s_waitcnt lgkmcnt(0)
v_mul_f32 v23, s79, v23
v_mul_f32 v31, s79, v31
v_mfma_f32_16x16x32_bf16 v[128:131], v[32:35], v[64:67], v[128:131]
ds_read_b64_tr_b16 v[80:81], v8 offset:24576
ds_read_b64_tr_b16 v[82:83], v8 offset:25600
v_mfma_f32_16x16x32_bf16 v[132:135], v[32:35], v[68:71], v[132:135]
ds_read_b128 v[112:115], v19 offset:0
ds_read_b128 v[116:119], v19 offset:2048
v_mfma_f32_16x16x32_bf16 v[136:139], v[32:35], v[72:75], v[136:139]
s_add_u32 s72, s69, 46080
buffer_load_dwordx4 v5, s[4:7], s72 offen offset:3072 lds
v_mfma_f32_16x16x32_bf16 v[140:143], v[32:35], v[76:79], v[140:143]
ds_read_b128 v[120:123], v19 offset:4096
ds_read_b128 v[124:127], v19 offset:6144
v_mfma_f32_16x16x32_bf16 v[156:159], v[36:39], v[76:79], v[156:159]
ds_read_b64_tr_b16 v[84:85], v9 offset:24576
ds_read_b64_tr_b16 v[86:87], v9 offset:25600
v_mfma_f32_16x16x32_bf16 v[152:155], v[36:39], v[72:75], v[152:155]
ds_read_b64_tr_b16 v[88:89], v10 offset:24576
v_cvt_pk_bf16_f32 v20, v20, v28
v_mfma_f32_16x16x32_bf16 v[148:151], v[36:39], v[68:71], v[148:151]
ds_read_b64_tr_b16 v[90:91], v10 offset:25600
v_cvt_pk_bf16_f32 v21, v21, v29
v_mfma_f32_16x16x32_bf16 v[144:147], v[36:39], v[64:67], v[144:147]
s_add_u32 m0, s63, 135168
ds_read_b64_tr_b16 v[92:93], v11 offset:24576
v_cvt_pk_bf16_f32 v22, v22, v30
v_mfma_f32_16x16x32_bf16 v[160:163], v[40:43], v[64:67], v[160:163]
s_add_u32 s72, s70, 0
buffer_load_dwordx4 v4, s[4:7], s72 offen lds
v_mfma_f32_16x16x32_bf16 v[164:167], v[40:43], v[68:71], v[164:167]
ds_read_b64_tr_b16 v[94:95], v11 offset:25600
v_cvt_pk_bf16_f32 v23, v23, v31
v_mfma_f32_16x16x32_bf16 v[168:171], v[40:43], v[72:75], v[168:171]
ds_read_b64_tr_b16 v[96:97], v12 offset:24576
v_mfma_f32_16x16x32_bf16 v[172:175], v[40:43], v[76:79], v[172:175]
ds_read_b64_tr_b16 v[98:99], v12 offset:25600
v_mfma_f32_16x16x32_bf16 v[188:191], v[44:47], v[76:79], v[188:191]
s_add_u32 s72, s70, 15360
buffer_load_dwordx4 v5, s[4:7], s72 offen offset:1024 lds
v_mfma_f32_16x16x32_bf16 v[184:187], v[44:47], v[72:75], v[184:187]
ds_read_b64_tr_b16 v[100:101], v13 offset:24576
v_mfma_f32_16x16x32_bf16 v[180:183], v[44:47], v[68:71], v[180:183]
ds_read_b64_tr_b16 v[102:103], v13 offset:25600
v_mfma_f32_16x16x32_bf16 v[176:179], v[44:47], v[64:67], v[176:179]
ds_read_b64_tr_b16 v[104:105], v14 offset:24576
v_mfma_f32_16x16x32_bf16 v[192:195], v[48:51], v[64:67], v[192:195]
ds_read_b64_tr_b16 v[106:107], v14 offset:25600
v_mfma_f32_16x16x32_bf16 v[196:199], v[48:51], v[68:71], v[196:199]
s_add_u32 s72, s70, 30720
buffer_load_dwordx4 v4, s[4:7], s72 offen offset:2048 lds
v_mfma_f32_16x16x32_bf16 v[200:203], v[48:51], v[72:75], v[200:203]
ds_read_b64_tr_b16 v[108:109], v15 offset:24576
v_mfma_f32_16x16x32_bf16 v[204:207], v[48:51], v[76:79], v[204:207]
ds_read_b64_tr_b16 v[110:111], v15 offset:25600
v_mfma_f32_16x16x32_bf16 v[220:223], v[52:55], v[76:79], v[220:223]
buffer_store_dwordx4 v[20:23], v1, s[44:47], s80 offen sc1
v_mfma_f32_16x16x32_bf16 v[216:219], v[52:55], v[72:75], v[216:219]
v_accvgpr_read_b32 v24, a232
v_accvgpr_read_b32 v28, a233
v_mfma_f32_16x16x32_bf16 v[212:215], v[52:55], v[68:71], v[212:215]
s_add_u32 s72, s70, 46080
buffer_load_dwordx4 v5, s[4:7], s72 offen offset:3072 lds
v_mfma_f32_16x16x32_bf16 v[208:211], v[52:55], v[64:67], v[208:211]
v_accvgpr_read_b32 v25, a234
v_accvgpr_read_b32 v29, a235
v_mfma_f32_16x16x32_bf16 v[224:227], v[56:59], v[64:67], v[224:227]
s_add_u32 s80, s78, 11264
v_accvgpr_read_b32 v26, a236
v_accvgpr_read_b32 v30, a237
v_mfma_f32_16x16x32_bf16 v[228:231], v[56:59], v[68:71], v[228:231]
v_accvgpr_read_b32 v27, a238
v_accvgpr_read_b32 v31, a239
v_mfma_f32_16x16x32_bf16 v[232:235], v[56:59], v[72:75], v[232:235]
v_cvt_pk_bf16_f32 v24, v24, v28
v_cvt_pk_bf16_f32 v25, v25, v29
v_mfma_f32_16x16x32_bf16 v[236:239], v[56:59], v[76:79], v[236:239]
v_cvt_pk_bf16_f32 v26, v26, v30
v_cvt_pk_bf16_f32 v27, v27, v31
v_mfma_f32_16x16x32_bf16 v[252:255], v[60:63], v[76:79], v[252:255]
buffer_store_dwordx4 v[24:27], v1, s[44:47], s80 offen sc1
v_mfma_f32_16x16x32_bf16 v[248:251], v[60:63], v[72:75], v[248:251]
v_mfma_f32_16x16x32_bf16 v[244:247], v[60:63], v[68:71], v[244:247]
s_waitcnt vmcnt(16) lgkmcnt(0)
v_mfma_f32_16x16x32_bf16 v[240:243], v[60:63], v[64:67], v[240:243]
s_barrier
v_mfma_f32_16x16x32_bf16 v[128:131], v[80:83], v[112:115], v[128:131]
s_add_u32 s73, s62, 13
ds_read_b64_tr_b16 v[32:33], v8 offset:32768
ds_read_b64_tr_b16 v[34:35], v8 offset:33792
v_mfma_f32_16x16x32_bf16 v[132:135], v[80:83], v[116:119], v[132:135]
s_add_u32 s70, s73, s65
ds_read_b128 v[64:67], v18 offset:32768
ds_read_b128 v[68:71], v18 offset:34816
v_mfma_f32_16x16x32_bf16 v[136:139], v[80:83], v[120:123], v[136:139]
s_and_b32 s70, s70, 3
v_and_b32 v2, 31, v0
v_lshlrev_b32 v2, 2, v2
v_mfma_f32_16x16x32_bf16 v[140:143], v[80:83], v[124:127], v[140:143]
s_and_b32 s73, s73, 12
buffer_load_dword v3, v2, s[48:51], 0 offen sc1
v_mfma_f32_16x16x32_bf16 v[156:159], v[84:87], v[124:127], v[156:159]
s_or_b32 s73, s73, s70
ds_read_b128 v[72:75], v18 offset:36864
ds_read_b128 v[76:79], v18 offset:38912
v_mfma_f32_16x16x32_bf16 v[152:155], v[84:87], v[120:123], v[152:155]
s_lshl_b32 s71, s73, 19
ds_read_b64_tr_b16 v[36:37], v9 offset:32768
ds_read_b64_tr_b16 v[38:39], v9 offset:33792
v_mfma_f32_16x16x32_bf16 v[148:151], v[84:87], v[116:119], v[148:151]
s_add_u32 s71, s71, s66
ds_read_b64_tr_b16 v[40:41], v10 offset:32768
v_accvgpr_read_b32 v20, a88
v_mfma_f32_16x16x32_bf16 v[144:147], v[84:87], v[112:115], v[144:147]
s_lshl_b32 s73, s73, 7
ds_read_b64_tr_b16 v[42:43], v10 offset:33792
v_accvgpr_read_b32 v28, a89
v_mfma_f32_16x16x32_bf16 v[160:163], v[88:91], v[112:115], v[160:163]
s_add_u32 s69, s73, s67
ds_read_b64_tr_b16 v[44:45], v11 offset:32768
v_accvgpr_read_b32 v21, a90
v_mfma_f32_16x16x32_bf16 v[164:167], v[88:91], v[116:119], v[164:167]
s_add_u32 s70, s73, s68
ds_read_b64_tr_b16 v[46:47], v11 offset:33792
v_accvgpr_read_b32 v29, a91
v_mfma_f32_16x16x32_bf16 v[168:171], v[88:91], v[120:123], v[168:171]
s_add_u32 m0, s64, 16384
ds_read_b64_tr_b16 v[48:49], v12 offset:32768
v_mfma_f32_16x16x32_bf16 v[172:175], v[88:91], v[124:127], v[172:175]
s_add_u32 s72, s71, 0
buffer_load_dwordx4 v6, s[12:15], s72 offen lds
v_mfma_f32_16x16x32_bf16 v[188:191], v[92:95], v[124:127], v[188:191]
s_add_u32 s72, s71, 31744
buffer_load_dwordx4 v6, s[12:15], s72 offen offset:1024 lds
v_mfma_f32_16x16x32_bf16 v[184:187], v[92:95], v[120:123], v[184:187]
s_add_u32 s72, s71, 63488
buffer_load_dwordx4 v7, s[12:15], s72 offen offset:2048 lds
v_mfma_f32_16x16x32_bf16 v[180:183], v[92:95], v[116:119], v[180:183]
s_add_u32 s72, s71, 95232
buffer_load_dwordx4 v7, s[12:15], s72 offen offset:3072 lds
v_mfma_f32_16x16x32_bf16 v[176:179], v[92:95], v[112:115], v[176:179]
s_add_u32 s80, s77, 41984
ds_read_b64_tr_b16 v[50:51], v12 offset:33792
v_accvgpr_read_b32 v22, a120
v_mfma_f32_16x16x32_bf16 v[192:195], v[96:99], v[112:115], v[192:195]
ds_read_b64_tr_b16 v[52:53], v13 offset:32768
v_accvgpr_read_b32 v30, a121
v_mfma_f32_16x16x32_bf16 v[196:199], v[96:99], v[116:119], v[196:199]
ds_read_b64_tr_b16 v[54:55], v13 offset:33792
v_accvgpr_read_b32 v23, a122
v_mfma_f32_16x16x32_bf16 v[200:203], v[96:99], v[120:123], v[200:203]
ds_read_b64_tr_b16 v[56:57], v14 offset:32768
v_accvgpr_read_b32 v31, a123
v_mfma_f32_16x16x32_bf16 v[204:207], v[96:99], v[124:127], v[204:207]
s_add_u32 m0, s63, 65536
ds_read_b64_tr_b16 v[58:59], v14 offset:33792
v_mul_f32 v20, s79, v20
v_mfma_f32_16x16x32_bf16 v[220:223], v[100:103], v[124:127], v[220:223]
s_add_u32 s72, s69, 0
buffer_load_dwordx4 v4, s[4:7], s72 offen lds
v_mfma_f32_16x16x32_bf16 v[216:219], v[100:103], v[120:123], v[216:219]
ds_read_b64_tr_b16 v[60:61], v15 offset:32768
v_mul_f32 v28, s79, v28
v_mfma_f32_16x16x32_bf16 v[212:215], v[100:103], v[116:119], v[212:215]
ds_read_b64_tr_b16 v[62:63], v15 offset:33792
v_mul_f32 v21, s79, v21
v_mfma_f32_16x16x32_bf16 v[208:211], v[100:103], v[112:115], v[208:211]
v_mul_f32 v29, s79, v29
v_mul_f32 v22, s79, v22
v_mfma_f32_16x16x32_bf16 v[224:227], v[104:107], v[112:115], v[224:227]
s_add_u32 s72, s69, 15360
buffer_load_dwordx4 v5, s[4:7], s72 offen offset:1024 lds
v_mfma_f32_16x16x32_bf16 v[228:231], v[104:107], v[116:119], v[228:231]
v_mul_f32 v30, s79, v30
v_mul_f32 v23, s79, v23
v_mfma_f32_16x16x32_bf16 v[232:235], v[104:107], v[120:123], v[232:235]
v_mul_f32 v31, s79, v31
v_cvt_pk_bf16_f32 v20, v20, v28
v_mfma_f32_16x16x32_bf16 v[236:239], v[104:107], v[124:127], v[236:239]
v_cvt_pk_bf16_f32 v21, v21, v29
v_cvt_pk_bf16_f32 v22, v22, v30
v_mfma_f32_16x16x32_bf16 v[252:255], v[108:111], v[124:127], v[252:255]
v_cvt_pk_bf16_f32 v23, v23, v31
v_mfma_f32_16x16x32_bf16 v[248:251], v[108:111], v[120:123], v[248:251]
s_add_u32 s72, s69, 30720
buffer_load_dwordx4 v4, s[4:7], s72 offen offset:2048 lds
v_mfma_f32_16x16x32_bf16 v[244:247], v[108:111], v[116:119], v[244:247]
buffer_store_dwordx4 v[20:23], v1, s[44:47], s80 offen sc1
v_mfma_f32_16x16x32_bf16 v[240:243], v[108:111], v[112:115], v[240:243]
s_waitcnt lgkmcnt(0)
v_accvgpr_read_b32 v24, a240
v_accvgpr_read_b32 v28, a241
v_mfma_f32_16x16x32_bf16 v[128:131], v[32:35], v[64:67], v[128:131]
ds_read_b64_tr_b16 v[80:81], v8 offset:40960
ds_read_b64_tr_b16 v[82:83], v8 offset:41984
v_mfma_f32_16x16x32_bf16 v[132:135], v[32:35], v[68:71], v[132:135]
ds_read_b128 v[112:115], v19 offset:32768
ds_read_b128 v[116:119], v19 offset:34816
v_mfma_f32_16x16x32_bf16 v[136:139], v[32:35], v[72:75], v[136:139]
s_add_u32 s72, s69, 46080
buffer_load_dwordx4 v5, s[4:7], s72 offen offset:3072 lds
v_mfma_f32_16x16x32_bf16 v[140:143], v[32:35], v[76:79], v[140:143]
ds_read_b128 v[120:123], v19 offset:36864
ds_read_b128 v[124:127], v19 offset:38912
v_mfma_f32_16x16x32_bf16 v[156:159], v[36:39], v[76:79], v[156:159]
ds_read_b64_tr_b16 v[84:85], v9 offset:40960
ds_read_b64_tr_b16 v[86:87], v9 offset:41984
v_mfma_f32_16x16x32_bf16 v[152:155], v[36:39], v[72:75], v[152:155]
ds_read_b64_tr_b16 v[88:89], v10 offset:40960
v_accvgpr_read_b32 v25, a242
v_mfma_f32_16x16x32_bf16 v[148:151], v[36:39], v[68:71], v[148:151]
ds_read_b64_tr_b16 v[90:91], v10 offset:41984
v_accvgpr_read_b32 v29, a243
v_mfma_f32_16x16x32_bf16 v[144:147], v[36:39], v[64:67], v[144:147]
s_add_u32 m0, s63, 69632
ds_read_b64_tr_b16 v[92:93], v11 offset:40960
v_mfma_f32_16x16x32_bf16 v[160:163], v[40:43], v[64:67], v[160:163]
s_add_u32 s72, s70, 0
buffer_load_dwordx4 v4, s[4:7], s72 offen lds
v_mfma_f32_16x16x32_bf16 v[164:167], v[40:43], v[68:71], v[164:167]
s_add_u32 s80, s78, 35840
ds_read_b64_tr_b16 v[94:95], v11 offset:41984
v_accvgpr_read_b32 v26, a244
v_mfma_f32_16x16x32_bf16 v[168:171], v[40:43], v[72:75], v[168:171]
ds_read_b64_tr_b16 v[96:97], v12 offset:40960
v_accvgpr_read_b32 v30, a245
v_mfma_f32_16x16x32_bf16 v[172:175], v[40:43], v[76:79], v[172:175]
ds_read_b64_tr_b16 v[98:99], v12 offset:41984
v_accvgpr_read_b32 v27, a246
v_mfma_f32_16x16x32_bf16 v[188:191], v[44:47], v[76:79], v[188:191]
s_add_u32 s72, s70, 15360
buffer_load_dwordx4 v5, s[4:7], s72 offen offset:1024 lds
v_mfma_f32_16x16x32_bf16 v[184:187], v[44:47], v[72:75], v[184:187]
ds_read_b64_tr_b16 v[100:101], v13 offset:40960
v_accvgpr_read_b32 v31, a247
v_mfma_f32_16x16x32_bf16 v[180:183], v[44:47], v[68:71], v[180:183]
ds_read_b64_tr_b16 v[102:103], v13 offset:41984
v_cvt_pk_bf16_f32 v24, v24, v28
v_mfma_f32_16x16x32_bf16 v[176:179], v[44:47], v[64:67], v[176:179]
ds_read_b64_tr_b16 v[104:105], v14 offset:40960
v_cvt_pk_bf16_f32 v25, v25, v29
v_mfma_f32_16x16x32_bf16 v[192:195], v[48:51], v[64:67], v[192:195]
ds_read_b64_tr_b16 v[106:107], v14 offset:41984
v_cvt_pk_bf16_f32 v26, v26, v30
v_mfma_f32_16x16x32_bf16 v[196:199], v[48:51], v[68:71], v[196:199]
s_add_u32 s72, s70, 30720
buffer_load_dwordx4 v4, s[4:7], s72 offen offset:2048 lds
v_mfma_f32_16x16x32_bf16 v[200:203], v[48:51], v[72:75], v[200:203]
ds_read_b64_tr_b16 v[108:109], v15 offset:40960
v_cvt_pk_bf16_f32 v27, v27, v31
v_mfma_f32_16x16x32_bf16 v[204:207], v[48:51], v[76:79], v[204:207]
ds_read_b64_tr_b16 v[110:111], v15 offset:41984
v_mfma_f32_16x16x32_bf16 v[220:223], v[52:55], v[76:79], v[220:223]
buffer_store_dwordx4 v[24:27], v1, s[44:47], s80 offen sc1
v_mfma_f32_16x16x32_bf16 v[216:219], v[52:55], v[72:75], v[216:219]
v_accvgpr_read_b32 v20, a92
v_accvgpr_read_b32 v28, a93
v_mfma_f32_16x16x32_bf16 v[212:215], v[52:55], v[68:71], v[212:215]
s_add_u32 s72, s70, 46080
buffer_load_dwordx4 v5, s[4:7], s72 offen offset:3072 lds
v_mfma_f32_16x16x32_bf16 v[208:211], v[52:55], v[64:67], v[208:211]
v_accvgpr_read_b32 v21, a94
v_accvgpr_read_b32 v29, a95
v_mfma_f32_16x16x32_bf16 v[224:227], v[56:59], v[64:67], v[224:227]
s_add_u32 s80, s77, 46080
v_accvgpr_read_b32 v22, a124
v_accvgpr_read_b32 v30, a125
v_mfma_f32_16x16x32_bf16 v[228:231], v[56:59], v[68:71], v[228:231]
v_accvgpr_read_b32 v23, a126
v_accvgpr_read_b32 v31, a127
v_mfma_f32_16x16x32_bf16 v[232:235], v[56:59], v[72:75], v[232:235]
v_mul_f32 v20, s79, v20
v_mul_f32 v28, s79, v28
v_mfma_f32_16x16x32_bf16 v[236:239], v[56:59], v[76:79], v[236:239]
v_mul_f32 v21, s79, v21
v_mul_f32 v29, s79, v29
v_mfma_f32_16x16x32_bf16 v[252:255], v[60:63], v[76:79], v[252:255]
v_mul_f32 v22, s79, v22
v_mul_f32 v30, s79, v30
v_mfma_f32_16x16x32_bf16 v[248:251], v[60:63], v[72:75], v[248:251]
v_mul_f32 v23, s79, v23
v_mul_f32 v31, s79, v31
v_mfma_f32_16x16x32_bf16 v[244:247], v[60:63], v[68:71], v[244:247]
s_waitcnt vmcnt(16) lgkmcnt(0)
v_cvt_pk_bf16_f32 v20, v20, v28
v_cvt_pk_bf16_f32 v21, v21, v29
v_mfma_f32_16x16x32_bf16 v[240:243], v[60:63], v[64:67], v[240:243]
s_barrier
v_cvt_pk_bf16_f32 v22, v22, v30
v_cvt_pk_bf16_f32 v23, v23, v31
v_mfma_f32_16x16x32_bf16 v[128:131], v[80:83], v[112:115], v[128:131]
s_add_u32 s73, s62, 14
ds_read_b64_tr_b16 v[32:33], v8 offset:0
ds_read_b64_tr_b16 v[34:35], v8 offset:1024
v_mfma_f32_16x16x32_bf16 v[132:135], v[80:83], v[116:119], v[132:135]
s_add_u32 s70, s73, s65
ds_read_b128 v[64:67], v16 offset:0
ds_read_b128 v[68:71], v16 offset:2048
v_mfma_f32_16x16x32_bf16 v[136:139], v[80:83], v[120:123], v[136:139]
s_and_b32 s70, s70, 3
ds_read_b128 v[72:75], v16 offset:4096
ds_read_b128 v[76:79], v16 offset:6144
v_mfma_f32_16x16x32_bf16 v[140:143], v[80:83], v[124:127], v[140:143]
s_and_b32 s73, s73, 12
ds_read_b64_tr_b16 v[36:37], v9 offset:0
ds_read_b64_tr_b16 v[38:39], v9 offset:1024
v_mfma_f32_16x16x32_bf16 v[156:159], v[84:87], v[124:127], v[156:159]
s_or_b32 s73, s73, s70
ds_read_b64_tr_b16 v[40:41], v10 offset:0
v_mfma_f32_16x16x32_bf16 v[152:155], v[84:87], v[120:123], v[152:155]
s_lshl_b32 s71, s73, 19
ds_read_b64_tr_b16 v[42:43], v10 offset:1024
v_mfma_f32_16x16x32_bf16 v[148:151], v[84:87], v[116:119], v[148:151]
s_add_u32 s71, s71, s66
ds_read_b64_tr_b16 v[44:45], v11 offset:0
v_mfma_f32_16x16x32_bf16 v[144:147], v[84:87], v[112:115], v[144:147]
s_lshl_b32 s73, s73, 7
ds_read_b64_tr_b16 v[46:47], v11 offset:1024
v_mfma_f32_16x16x32_bf16 v[160:163], v[88:91], v[112:115], v[160:163]
s_add_u32 s69, s73, s67
ds_read_b64_tr_b16 v[48:49], v12 offset:0
v_mfma_f32_16x16x32_bf16 v[164:167], v[88:91], v[116:119], v[164:167]
s_add_u32 s70, s73, s68
ds_read_b64_tr_b16 v[50:51], v12 offset:1024
v_mfma_f32_16x16x32_bf16 v[168:171], v[88:91], v[120:123], v[168:171]
s_add_u32 m0, s64, 32768
ds_read_b64_tr_b16 v[52:53], v13 offset:0
v_mfma_f32_16x16x32_bf16 v[172:175], v[88:91], v[124:127], v[172:175]
s_add_u32 s72, s71, 0
buffer_load_dwordx4 v6, s[12:15], s72 offen lds
v_mfma_f32_16x16x32_bf16 v[188:191], v[92:95], v[124:127], v[188:191]
s_add_u32 s72, s71, 31744
buffer_load_dwordx4 v6, s[12:15], s72 offen offset:1024 lds
v_mfma_f32_16x16x32_bf16 v[184:187], v[92:95], v[120:123], v[184:187]
s_add_u32 s72, s71, 63488
buffer_load_dwordx4 v7, s[12:15], s72 offen offset:2048 lds
v_mfma_f32_16x16x32_bf16 v[180:183], v[92:95], v[116:119], v[180:183]
s_add_u32 s72, s71, 95232
buffer_load_dwordx4 v7, s[12:15], s72 offen offset:3072 lds
v_mfma_f32_16x16x32_bf16 v[176:179], v[92:95], v[112:115], v[176:179]
ds_read_b64_tr_b16 v[54:55], v13 offset:1024
v_mfma_f32_16x16x32_bf16 v[192:195], v[96:99], v[112:115], v[192:195]
ds_read_b64_tr_b16 v[56:57], v14 offset:0
v_mfma_f32_16x16x32_bf16 v[196:199], v[96:99], v[116:119], v[196:199]
ds_read_b64_tr_b16 v[58:59], v14 offset:1024
v_mfma_f32_16x16x32_bf16 v[200:203], v[96:99], v[120:123], v[200:203]
ds_read_b64_tr_b16 v[60:61], v15 offset:0
v_mfma_f32_16x16x32_bf16 v[204:207], v[96:99], v[124:127], v[204:207]
s_add_u32 m0, s63, 98304
ds_read_b64_tr_b16 v[62:63], v15 offset:1024
v_mfma_f32_16x16x32_bf16 v[220:223], v[100:103], v[124:127], v[220:223]
s_add_u32 s72, s69, 0
buffer_load_dwordx4 v4, s[4:7], s72 offen lds
v_mfma_f32_16x16x32_bf16 v[216:219], v[100:103], v[120:123], v[216:219]
buffer_store_dwordx4 v[20:23], v1, s[44:47], s80 offen sc1
v_mfma_f32_16x16x32_bf16 v[212:215], v[100:103], v[116:119], v[212:215]
v_accvgpr_read_b32 v24, a248
v_accvgpr_read_b32 v28, a249
v_mfma_f32_16x16x32_bf16 v[208:211], v[100:103], v[112:115], v[208:211]
v_accvgpr_read_b32 v25, a250
v_accvgpr_read_b32 v29, a251
v_mfma_f32_16x16x32_bf16 v[224:227], v[104:107], v[112:115], v[224:227]
s_add_u32 s72, s69, 15360
buffer_load_dwordx4 v5, s[4:7], s72 offen offset:1024 lds
v_mfma_f32_16x16x32_bf16 v[228:231], v[104:107], v[116:119], v[228:231]
s_add_u32 s80, s78, 44032
v_accvgpr_read_b32 v26, a252
v_accvgpr_read_b32 v30, a253
v_mfma_f32_16x16x32_bf16 v[232:235], v[104:107], v[120:123], v[232:235]
v_accvgpr_read_b32 v27, a254
v_accvgpr_read_b32 v31, a255
v_mfma_f32_16x16x32_bf16 v[236:239], v[104:107], v[124:127], v[236:239]
v_cvt_pk_bf16_f32 v24, v24, v28
v_cvt_pk_bf16_f32 v25, v25, v29
v_mfma_f32_16x16x32_bf16 v[252:255], v[108:111], v[124:127], v[252:255]
v_cvt_pk_bf16_f32 v26, v26, v30
v_cvt_pk_bf16_f32 v27, v27, v31
v_mfma_f32_16x16x32_bf16 v[248:251], v[108:111], v[120:123], v[248:251]
s_add_u32 s72, s69, 30720
buffer_load_dwordx4 v4, s[4:7], s72 offen offset:2048 lds
v_mfma_f32_16x16x32_bf16 v[244:247], v[108:111], v[116:119], v[244:247]
buffer_store_dwordx4 v[24:27], v1, s[44:47], s80 offen sc1
v_mfma_f32_16x16x32_bf16 v[240:243], v[108:111], v[112:115], v[240:243]
s_waitcnt lgkmcnt(0)
v_mfma_f32_16x16x32_bf16 v[128:131], v[32:35], v[64:67], v[128:131]
ds_read_b64_tr_b16 v[80:81], v8 offset:8192
ds_read_b64_tr_b16 v[82:83], v8 offset:9216
v_mfma_f32_16x16x32_bf16 v[132:135], v[32:35], v[68:71], v[132:135]
ds_read_b128 v[112:115], v17 offset:0
ds_read_b128 v[116:119], v17 offset:2048
v_mfma_f32_16x16x32_bf16 v[136:139], v[32:35], v[72:75], v[136:139]
s_add_u32 s72, s69, 46080
buffer_load_dwordx4 v5, s[4:7], s72 offen offset:3072 lds
v_mfma_f32_16x16x32_bf16 v[140:143], v[32:35], v[76:79], v[140:143]
ds_read_b128 v[120:123], v17 offset:4096
ds_read_b128 v[124:127], v17 offset:6144
v_mfma_f32_16x16x32_bf16 v[156:159], v[36:39], v[76:79], v[156:159]
ds_read_b64_tr_b16 v[84:85], v9 offset:8192
ds_read_b64_tr_b16 v[86:87], v9 offset:9216
v_mfma_f32_16x16x32_bf16 v[152:155], v[36:39], v[72:75], v[152:155]
ds_read_b64_tr_b16 v[88:89], v10 offset:8192
v_mfma_f32_16x16x32_bf16 v[148:151], v[36:39], v[68:71], v[148:151]
ds_read_b64_tr_b16 v[90:91], v10 offset:9216
v_mfma_f32_16x16x32_bf16 v[144:147], v[36:39], v[64:67], v[144:147]
s_add_u32 m0, s63, 102400
ds_read_b64_tr_b16 v[92:93], v11 offset:8192
v_mfma_f32_16x16x32_bf16 v[160:163], v[40:43], v[64:67], v[160:163]
s_add_u32 s72, s70, 0
buffer_load_dwordx4 v4, s[4:7], s72 offen lds
v_mfma_f32_16x16x32_bf16 v[164:167], v[40:43], v[68:71], v[164:167]
ds_read_b64_tr_b16 v[94:95], v11 offset:9216
v_mfma_f32_16x16x32_bf16 v[168:171], v[40:43], v[72:75], v[168:171]
ds_read_b64_tr_b16 v[96:97], v12 offset:8192
v_mfma_f32_16x16x32_bf16 v[172:175], v[40:43], v[76:79], v[172:175]
ds_read_b64_tr_b16 v[98:99], v12 offset:9216
v_mfma_f32_16x16x32_bf16 v[188:191], v[44:47], v[76:79], v[188:191]
s_add_u32 s72, s70, 15360
buffer_load_dwordx4 v5, s[4:7], s72 offen offset:1024 lds
v_mfma_f32_16x16x32_bf16 v[184:187], v[44:47], v[72:75], v[184:187]
ds_read_b64_tr_b16 v[100:101], v13 offset:8192
v_mfma_f32_16x16x32_bf16 v[180:183], v[44:47], v[68:71], v[180:183]
ds_read_b64_tr_b16 v[102:103], v13 offset:9216
v_mfma_f32_16x16x32_bf16 v[176:179], v[44:47], v[64:67], v[176:179]
ds_read_b64_tr_b16 v[104:105], v14 offset:8192
v_mfma_f32_16x16x32_bf16 v[192:195], v[48:51], v[64:67], v[192:195]
ds_read_b64_tr_b16 v[106:107], v14 offset:9216
v_mfma_f32_16x16x32_bf16 v[196:199], v[48:51], v[68:71], v[196:199]
s_add_u32 s72, s70, 30720
buffer_load_dwordx4 v4, s[4:7], s72 offen offset:2048 lds
v_mfma_f32_16x16x32_bf16 v[200:203], v[48:51], v[72:75], v[200:203]
ds_read_b64_tr_b16 v[108:109], v15 offset:8192
v_mfma_f32_16x16x32_bf16 v[204:207], v[48:51], v[76:79], v[204:207]
ds_read_b64_tr_b16 v[110:111], v15 offset:9216
v_mfma_f32_16x16x32_bf16 v[220:223], v[52:55], v[76:79], v[220:223]
v_mfma_f32_16x16x32_bf16 v[216:219], v[52:55], v[72:75], v[216:219]
v_mfma_f32_16x16x32_bf16 v[212:215], v[52:55], v[68:71], v[212:215]
s_add_u32 s72, s70, 46080
buffer_load_dwordx4 v5, s[4:7], s72 offen offset:3072 lds
v_mfma_f32_16x16x32_bf16 v[208:211], v[52:55], v[64:67], v[208:211]
v_mfma_f32_16x16x32_bf16 v[224:227], v[56:59], v[64:67], v[224:227]
v_mfma_f32_16x16x32_bf16 v[228:231], v[56:59], v[68:71], v[228:231]
v_mfma_f32_16x16x32_bf16 v[232:235], v[56:59], v[72:75], v[232:235]
v_mfma_f32_16x16x32_bf16 v[236:239], v[56:59], v[76:79], v[236:239]
v_mfma_f32_16x16x32_bf16 v[252:255], v[60:63], v[76:79], v[252:255]
v_mfma_f32_16x16x32_bf16 v[248:251], v[60:63], v[72:75], v[248:251]
v_mfma_f32_16x16x32_bf16 v[244:247], v[60:63], v[68:71], v[244:247]
s_waitcnt vmcnt(5) lgkmcnt(0)
v_mfma_f32_16x16x32_bf16 v[240:243], v[60:63], v[64:67], v[240:243]
s_barrier
v_mfma_f32_16x16x32_bf16 v[128:131], v[80:83], v[112:115], v[128:131]
s_add_u32 s73, s62, 15
s_waitcnt vmcnt(28)
v_cmp_gt_u32 vcc, 8, v3
s_cbranch_vccnz Lspin1
Lback2:
v_mfma_f32_16x16x32_bf16 v[132:135], v[80:83], v[116:119], v[132:135]
s_add_u32 s70, s73, s65
ds_read_b64_tr_b16 v[32:33], v8 offset:16384
ds_read_b64_tr_b16 v[34:35], v8 offset:17408
v_mfma_f32_16x16x32_bf16 v[136:139], v[80:83], v[120:123], v[136:139]
s_and_b32 s70, s70, 3
ds_read_b128 v[64:67], v18 offset:0
ds_read_b128 v[68:71], v18 offset:2048
v_mfma_f32_16x16x32_bf16 v[140:143], v[80:83], v[124:127], v[140:143]
s_and_b32 s73, s73, 12
ds_read_b128 v[72:75], v18 offset:4096
ds_read_b128 v[76:79], v18 offset:6144
v_mfma_f32_16x16x32_bf16 v[156:159], v[84:87], v[124:127], v[156:159]
s_or_b32 s73, s73, s70
ds_read_b64_tr_b16 v[36:37], v9 offset:16384
ds_read_b64_tr_b16 v[38:39], v9 offset:17408
v_mfma_f32_16x16x32_bf16 v[152:155], v[84:87], v[120:123], v[152:155]
s_lshl_b32 s71, s73, 19
ds_read_b64_tr_b16 v[40:41], v10 offset:16384
v_or_b32 v20, s58, v0
v_mfma_f32_16x16x32_bf16 v[148:151], v[84:87], v[116:119], v[148:151]
s_add_u32 s71, s71, s66
ds_read_b64_tr_b16 v[42:43], v10 offset:17408
v_mov_b32 v21, 1
v_mfma_f32_16x16x32_bf16 v[144:147], v[84:87], v[112:115], v[144:147]
s_lshl_b32 s73, s73, 7
ds_read_b64_tr_b16 v[44:45], v11 offset:16384
v_min_u32 v20, 1, v20
v_mfma_f32_16x16x32_bf16 v[160:163], v[88:91], v[112:115], v[160:163]
s_add_u32 s69, s73, s67
ds_read_b64_tr_b16 v[46:47], v11 offset:17408
v_lshlrev_b32 v20, 30, v20
v_mfma_f32_16x16x32_bf16 v[164:167], v[88:91], v[116:119], v[164:167]
s_add_u32 s70, s73, s68
ds_read_b64_tr_b16 v[48:49], v12 offset:16384
v_mfma_f32_16x16x32_bf16 v[168:171], v[88:91], v[120:123], v[168:171]
s_add_u32 m0, s64, 0
ds_read_b64_tr_b16 v[50:51], v12 offset:17408
v_mfma_f32_16x16x32_bf16 v[172:175], v[88:91], v[124:127], v[172:175]
s_add_u32 s72, s71, 0
buffer_load_dwordx4 v6, s[12:15], s72 offen lds
v_mfma_f32_16x16x32_bf16 v[188:191], v[92:95], v[124:127], v[188:191]
s_add_u32 s72, s71, 31744
buffer_load_dwordx4 v6, s[12:15], s72 offen offset:1024 lds
v_mfma_f32_16x16x32_bf16 v[184:187], v[92:95], v[120:123], v[184:187]
s_add_u32 s72, s71, 63488
buffer_load_dwordx4 v7, s[12:15], s72 offen offset:2048 lds
v_mfma_f32_16x16x32_bf16 v[180:183], v[92:95], v[116:119], v[180:183]
s_add_u32 s72, s71, 95232
buffer_load_dwordx4 v7, s[12:15], s72 offen offset:3072 lds
v_mfma_f32_16x16x32_bf16 v[176:179], v[92:95], v[112:115], v[176:179]
ds_read_b64_tr_b16 v[52:53], v13 offset:16384
v_mfma_f32_16x16x32_bf16 v[192:195], v[96:99], v[112:115], v[192:195]
ds_read_b64_tr_b16 v[54:55], v13 offset:17408
v_mfma_f32_16x16x32_bf16 v[196:199], v[96:99], v[116:119], v[196:199]
ds_read_b64_tr_b16 v[56:57], v14 offset:16384
v_mfma_f32_16x16x32_bf16 v[200:203], v[96:99], v[120:123], v[200:203]
ds_read_b64_tr_b16 v[58:59], v14 offset:17408
v_mfma_f32_16x16x32_bf16 v[204:207], v[96:99], v[124:127], v[204:207]
s_add_u32 m0, s63, 131072
ds_read_b64_tr_b16 v[60:61], v15 offset:16384
v_mfma_f32_16x16x32_bf16 v[220:223], v[100:103], v[124:127], v[220:223]
s_add_u32 s72, s69, 0
buffer_load_dwordx4 v4, s[4:7], s72 offen lds
v_mfma_f32_16x16x32_bf16 v[216:219], v[100:103], v[120:123], v[216:219]
ds_read_b64_tr_b16 v[62:63], v15 offset:17408
v_mfma_f32_16x16x32_bf16 v[212:215], v[100:103], v[116:119], v[212:215]
buffer_store_dword v21, v20, s[44:47], s91 offen sc1
v_mfma_f32_16x16x32_bf16 v[208:211], v[100:103], v[112:115], v[208:211]
v_mfma_f32_16x16x32_bf16 v[224:227], v[104:107], v[112:115], v[224:227]
s_add_u32 s72, s69, 15360
buffer_load_dwordx4 v5, s[4:7], s72 offen offset:1024 lds
v_mfma_f32_16x16x32_bf16 v[228:231], v[104:107], v[116:119], v[228:231]
v_mfma_f32_16x16x32_bf16 v[232:235], v[104:107], v[120:123], v[232:235]
v_mfma_f32_16x16x32_bf16 v[236:239], v[104:107], v[124:127], v[236:239]
v_mfma_f32_16x16x32_bf16 v[252:255], v[108:111], v[124:127], v[252:255]
v_mfma_f32_16x16x32_bf16 v[248:251], v[108:111], v[120:123], v[248:251]
s_add_u32 s72, s69, 30720
buffer_load_dwordx4 v4, s[4:7], s72 offen offset:2048 lds
v_mfma_f32_16x16x32_bf16 v[244:247], v[108:111], v[116:119], v[244:247]
v_mfma_f32_16x16x32_bf16 v[240:243], v[108:111], v[112:115], v[240:243]
s_waitcnt lgkmcnt(0)
v_mfma_f32_16x16x32_bf16 v[128:131], v[32:35], v[64:67], v[128:131]
ds_read_b64_tr_b16 v[80:81], v8 offset:24576
ds_read_b64_tr_b16 v[82:83], v8 offset:25600
v_mfma_f32_16x16x32_bf16 v[132:135], v[32:35], v[68:71], v[132:135]
ds_read_b128 v[112:115], v19 offset:0
ds_read_b128 v[116:119], v19 offset:2048
v_mfma_f32_16x16x32_bf16 v[136:139], v[32:35], v[72:75], v[136:139]
s_add_u32 s72, s69, 46080
buffer_load_dwordx4 v5, s[4:7], s72 offen offset:3072 lds
v_mfma_f32_16x16x32_bf16 v[140:143], v[32:35], v[76:79], v[140:143]
ds_read_b128 v[120:123], v19 offset:4096
ds_read_b128 v[124:127], v19 offset:6144
v_mfma_f32_16x16x32_bf16 v[156:159], v[36:39], v[76:79], v[156:159]
ds_read_b64_tr_b16 v[84:85], v9 offset:24576
ds_read_b64_tr_b16 v[86:87], v9 offset:25600
v_mfma_f32_16x16x32_bf16 v[152:155], v[36:39], v[72:75], v[152:155]
ds_read_b64_tr_b16 v[88:89], v10 offset:24576
v_mfma_f32_16x16x32_bf16 v[148:151], v[36:39], v[68:71], v[148:151]
ds_read_b64_tr_b16 v[90:91], v10 offset:25600
v_mfma_f32_16x16x32_bf16 v[144:147], v[36:39], v[64:67], v[144:147]
s_add_u32 m0, s63, 135168
ds_read_b64_tr_b16 v[92:93], v11 offset:24576
v_mfma_f32_16x16x32_bf16 v[160:163], v[40:43], v[64:67], v[160:163]
s_add_u32 s72, s70, 0
buffer_load_dwordx4 v4, s[4:7], s72 offen lds
v_mfma_f32_16x16x32_bf16 v[164:167], v[40:43], v[68:71], v[164:167]
ds_read_b64_tr_b16 v[94:95], v11 offset:25600
v_mfma_f32_16x16x32_bf16 v[168:171], v[40:43], v[72:75], v[168:171]
ds_read_b64_tr_b16 v[96:97], v12 offset:24576
v_mfma_f32_16x16x32_bf16 v[172:175], v[40:43], v[76:79], v[172:175]
ds_read_b64_tr_b16 v[98:99], v12 offset:25600
v_mfma_f32_16x16x32_bf16 v[188:191], v[44:47], v[76:79], v[188:191]
s_add_u32 s72, s70, 15360
buffer_load_dwordx4 v5, s[4:7], s72 offen offset:1024 lds
v_mfma_f32_16x16x32_bf16 v[184:187], v[44:47], v[72:75], v[184:187]
ds_read_b64_tr_b16 v[100:101], v13 offset:24576
v_mfma_f32_16x16x32_bf16 v[180:183], v[44:47], v[68:71], v[180:183]
ds_read_b64_tr_b16 v[102:103], v13 offset:25600
v_mfma_f32_16x16x32_bf16 v[176:179], v[44:47], v[64:67], v[176:179]
ds_read_b64_tr_b16 v[104:105], v14 offset:24576
v_mfma_f32_16x16x32_bf16 v[192:195], v[48:51], v[64:67], v[192:195]
ds_read_b64_tr_b16 v[106:107], v14 offset:25600
v_mfma_f32_16x16x32_bf16 v[196:199], v[48:51], v[68:71], v[196:199]
s_add_u32 s72, s70, 30720
buffer_load_dwordx4 v4, s[4:7], s72 offen offset:2048 lds
v_mfma_f32_16x16x32_bf16 v[200:203], v[48:51], v[72:75], v[200:203]
ds_read_b64_tr_b16 v[108:109], v15 offset:24576
v_mfma_f32_16x16x32_bf16 v[204:207], v[48:51], v[76:79], v[204:207]
ds_read_b64_tr_b16 v[110:111], v15 offset:25600
v_mfma_f32_16x16x32_bf16 v[220:223], v[52:55], v[76:79], v[220:223]
v_mfma_f32_16x16x32_bf16 v[216:219], v[52:55], v[72:75], v[216:219]
v_mfma_f32_16x16x32_bf16 v[212:215], v[52:55], v[68:71], v[212:215]
s_add_u32 s72, s70, 46080
buffer_load_dwordx4 v5, s[4:7], s72 offen offset:3072 lds
v_mfma_f32_16x16x32_bf16 v[208:211], v[52:55], v[64:67], v[208:211]
v_mfma_f32_16x16x32_bf16 v[224:227], v[56:59], v[64:67], v[224:227]
v_mfma_f32_16x16x32_bf16 v[228:231], v[56:59], v[68:71], v[228:231]
v_mfma_f32_16x16x32_bf16 v[232:235], v[56:59], v[72:75], v[232:235]
v_mfma_f32_16x16x32_bf16 v[236:239], v[56:59], v[76:79], v[236:239]
v_mfma_f32_16x16x32_bf16 v[252:255], v[60:63], v[76:79], v[252:255]
v_mfma_f32_16x16x32_bf16 v[248:251], v[60:63], v[72:75], v[248:251]
v_mfma_f32_16x16x32_bf16 v[244:247], v[60:63], v[68:71], v[244:247]
s_waitcnt vmcnt(13) lgkmcnt(0)
v_mfma_f32_16x16x32_bf16 v[240:243], v[60:63], v[64:67], v[240:243]
s_barrier
v_mfma_f32_16x16x32_bf16 v[128:131], v[80:83], v[112:115], v[128:131]
ds_read_b64_tr_b16 v[32:33], v8 offset:32768
ds_read_b64_tr_b16 v[34:35], v8 offset:33792
v_mfma_f32_16x16x32_bf16 v[132:135], v[80:83], v[116:119], v[132:135]
ds_read_b128 v[64:67], v18 offset:32768
ds_read_b128 v[68:71], v18 offset:34816
v_mfma_f32_16x16x32_bf16 v[136:139], v[80:83], v[120:123], v[136:139]
ds_read_b128 v[72:75], v18 offset:36864
ds_read_b128 v[76:79], v18 offset:38912
v_mfma_f32_16x16x32_bf16 v[140:143], v[80:83], v[124:127], v[140:143]
ds_read_b64_tr_b16 v[36:37], v9 offset:32768
ds_read_b64_tr_b16 v[38:39], v9 offset:33792
v_mfma_f32_16x16x32_bf16 v[156:159], v[84:87], v[124:127], v[156:159]
ds_read_b64_tr_b16 v[40:41], v10 offset:32768
v_mfma_f32_16x16x32_bf16 v[152:155], v[84:87], v[120:123], v[152:155]
ds_read_b64_tr_b16 v[42:43], v10 offset:33792
v_mfma_f32_16x16x32_bf16 v[148:151], v[84:87], v[116:119], v[148:151]
ds_read_b64_tr_b16 v[44:45], v11 offset:32768
v_mfma_f32_16x16x32_bf16 v[144:147], v[84:87], v[112:115], v[144:147]
ds_read_b64_tr_b16 v[46:47], v11 offset:33792
v_mfma_f32_16x16x32_bf16 v[160:163], v[88:91], v[112:115], v[160:163]
ds_read_b64_tr_b16 v[48:49], v12 offset:32768
v_mfma_f32_16x16x32_bf16 v[164:167], v[88:91], v[116:119], v[164:167]
ds_read_b64_tr_b16 v[50:51], v12 offset:33792
v_mfma_f32_16x16x32_bf16 v[168:171], v[88:91], v[120:123], v[168:171]
ds_read_b64_tr_b16 v[52:53], v13 offset:32768
v_mfma_f32_16x16x32_bf16 v[172:175], v[88:91], v[124:127], v[172:175]
ds_read_b64_tr_b16 v[54:55], v13 offset:33792
v_mfma_f32_16x16x32_bf16 v[188:191], v[92:95], v[124:127], v[188:191]
ds_read_b64_tr_b16 v[56:57], v14 offset:32768
v_mfma_f32_16x16x32_bf16 v[184:187], v[92:95], v[120:123], v[184:187]
ds_read_b64_tr_b16 v[58:59], v14 offset:33792
v_mfma_f32_16x16x32_bf16 v[180:183], v[92:95], v[116:119], v[180:183]
ds_read_b64_tr_b16 v[60:61], v15 offset:32768
v_mfma_f32_16x16x32_bf16 v[176:179], v[92:95], v[112:115], v[176:179]
ds_read_b64_tr_b16 v[62:63], v15 offset:33792
v_mfma_f32_16x16x32_bf16 v[192:195], v[96:99], v[112:115], v[192:195]
v_mfma_f32_16x16x32_bf16 v[196:199], v[96:99], v[116:119], v[196:199]
v_mfma_f32_16x16x32_bf16 v[200:203], v[96:99], v[120:123], v[200:203]
v_mfma_f32_16x16x32_bf16 v[204:207], v[96:99], v[124:127], v[204:207]
v_mfma_f32_16x16x32_bf16 v[220:223], v[100:103], v[124:127], v[220:223]
v_mfma_f32_16x16x32_bf16 v[216:219], v[100:103], v[120:123], v[216:219]
v_mfma_f32_16x16x32_bf16 v[212:215], v[100:103], v[116:119], v[212:215]
v_mfma_f32_16x16x32_bf16 v[208:211], v[100:103], v[112:115], v[208:211]
v_mfma_f32_16x16x32_bf16 v[224:227], v[104:107], v[112:115], v[224:227]
s_and_b32 s75, s91, 0xfffffc7f
v_and_b32 v2, 7, v0
v_lshlrev_b32 v2, 7, v2
v_mfma_f32_16x16x32_bf16 v[228:231], v[104:107], v[116:119], v[228:231]
buffer_load_dword v3, v2, s[44:47], s75 offen sc1
v_mfma_f32_16x16x32_bf16 v[232:235], v[104:107], v[120:123], v[232:235]
v_mfma_f32_16x16x32_bf16 v[236:239], v[104:107], v[124:127], v[236:239]
v_mfma_f32_16x16x32_bf16 v[252:255], v[108:111], v[124:127], v[252:255]
v_mfma_f32_16x16x32_bf16 v[248:251], v[108:111], v[120:123], v[248:251]
v_mfma_f32_16x16x32_bf16 v[244:247], v[108:111], v[116:119], v[244:247]
v_mfma_f32_16x16x32_bf16 v[240:243], v[108:111], v[112:115], v[240:243]
s_waitcnt lgkmcnt(0)
v_mfma_f32_16x16x32_bf16 v[128:131], v[32:35], v[64:67], v[128:131]
ds_read_b64_tr_b16 v[80:81], v8 offset:40960
ds_read_b64_tr_b16 v[82:83], v8 offset:41984
v_mfma_f32_16x16x32_bf16 v[132:135], v[32:35], v[68:71], v[132:135]
ds_read_b128 v[112:115], v19 offset:32768
ds_read_b128 v[116:119], v19 offset:34816
v_mfma_f32_16x16x32_bf16 v[136:139], v[32:35], v[72:75], v[136:139]
ds_read_b128 v[120:123], v19 offset:36864
ds_read_b128 v[124:127], v19 offset:38912
v_mfma_f32_16x16x32_bf16 v[140:143], v[32:35], v[76:79], v[140:143]
ds_read_b64_tr_b16 v[84:85], v9 offset:40960
ds_read_b64_tr_b16 v[86:87], v9 offset:41984
v_mfma_f32_16x16x32_bf16 v[156:159], v[36:39], v[76:79], v[156:159]
ds_read_b64_tr_b16 v[88:89], v10 offset:40960
v_mfma_f32_16x16x32_bf16 v[152:155], v[36:39], v[72:75], v[152:155]
ds_read_b64_tr_b16 v[90:91], v10 offset:41984
v_mfma_f32_16x16x32_bf16 v[148:151], v[36:39], v[68:71], v[148:151]
ds_read_b64_tr_b16 v[92:93], v11 offset:40960
v_mfma_f32_16x16x32_bf16 v[144:147], v[36:39], v[64:67], v[144:147]
ds_read_b64_tr_b16 v[94:95], v11 offset:41984
v_mfma_f32_16x16x32_bf16 v[160:163], v[40:43], v[64:67], v[160:163]
ds_read_b64_tr_b16 v[96:97], v12 offset:40960
v_mfma_f32_16x16x32_bf16 v[164:167], v[40:43], v[68:71], v[164:167]
ds_read_b64_tr_b16 v[98:99], v12 offset:41984
v_mfma_f32_16x16x32_bf16 v[168:171], v[40:43], v[72:75], v[168:171]
ds_read_b64_tr_b16 v[100:101], v13 offset:40960
v_mfma_f32_16x16x32_bf16 v[172:175], v[40:43], v[76:79], v[172:175]
ds_read_b64_tr_b16 v[102:103], v13 offset:41984
v_mfma_f32_16x16x32_bf16 v[188:191], v[44:47], v[76:79], v[188:191]
ds_read_b64_tr_b16 v[104:105], v14 offset:40960
v_mfma_f32_16x16x32_bf16 v[184:187], v[44:47], v[72:75], v[184:187]
ds_read_b64_tr_b16 v[106:107], v14 offset:41984
v_mfma_f32_16x16x32_bf16 v[180:183], v[44:47], v[68:71], v[180:183]
ds_read_b64_tr_b16 v[108:109], v15 offset:40960
v_mfma_f32_16x16x32_bf16 v[176:179], v[44:47], v[64:67], v[176:179]
ds_read_b64_tr_b16 v[110:111], v15 offset:41984
v_mfma_f32_16x16x32_bf16 v[192:195], v[48:51], v[64:67], v[192:195]
v_mfma_f32_16x16x32_bf16 v[196:199], v[48:51], v[68:71], v[196:199]
v_mfma_f32_16x16x32_bf16 v[200:203], v[48:51], v[72:75], v[200:203]
v_mfma_f32_16x16x32_bf16 v[204:207], v[48:51], v[76:79], v[204:207]
v_mfma_f32_16x16x32_bf16 v[220:223], v[52:55], v[76:79], v[220:223]
v_mfma_f32_16x16x32_bf16 v[216:219], v[52:55], v[72:75], v[216:219]
v_mfma_f32_16x16x32_bf16 v[212:215], v[52:55], v[68:71], v[212:215]
v_mfma_f32_16x16x32_bf16 v[208:211], v[52:55], v[64:67], v[208:211]
v_mfma_f32_16x16x32_bf16 v[224:227], v[56:59], v[64:67], v[224:227]
v_mfma_f32_16x16x32_bf16 v[228:231], v[56:59], v[68:71], v[228:231]
v_mfma_f32_16x16x32_bf16 v[232:235], v[56:59], v[72:75], v[232:235]
v_mfma_f32_16x16x32_bf16 v[236:239], v[56:59], v[76:79], v[236:239]
v_mfma_f32_16x16x32_bf16 v[252:255], v[60:63], v[76:79], v[252:255]
v_mfma_f32_16x16x32_bf16 v[248:251], v[60:63], v[72:75], v[248:251]
v_mfma_f32_16x16x32_bf16 v[244:247], v[60:63], v[68:71], v[244:247]
s_waitcnt vmcnt(1) lgkmcnt(0)
v_mfma_f32_16x16x32_bf16 v[240:243], v[60:63], v[64:67], v[240:243]
s_barrier
v_mfma_f32_16x16x32_bf16 v[128:131], v[80:83], v[112:115], v[128:131]
s_waitcnt vmcnt(0)
v_cmp_gt_u32 vcc, 1, v3
s_cbranch_vccnz Lspin4
Lback5:
v_mfma_f32_16x16x32_bf16 v[132:135], v[80:83], v[116:119], v[132:135]
s_add_u32 m0, s64, 49152
ds_read_b64_tr_b16 v[32:33], v8 offset:0
ds_read_b64_tr_b16 v[34:35], v8 offset:1024
v_mfma_f32_16x16x32_bf16 v[136:139], v[80:83], v[120:123], v[136:139]
s_add_u32 s72, s81, 16384
buffer_load_dwordx4 v1, s[44:47], s72 offen sc1 lds
v_mfma_f32_16x16x32_bf16 v[140:143], v[80:83], v[124:127], v[140:143]
ds_read_b128 v[64:67], v16 offset:0
ds_read_b128 v[68:71], v16 offset:2048
v_mfma_f32_16x16x32_bf16 v[156:159], v[84:87], v[124:127], v[156:159]
buffer_load_dwordx4 v1, s[44:47], s72 offen offset:1024 sc1 lds
v_mfma_f32_16x16x32_bf16 v[152:155], v[84:87], v[120:123], v[152:155]
ds_read_b128 v[72:75], v16 offset:4096
ds_read_b128 v[76:79], v16 offset:6144
v_mfma_f32_16x16x32_bf16 v[148:151], v[84:87], v[116:119], v[148:151]
ds_read_b64_tr_b16 v[36:37], v9 offset:0
ds_read_b64_tr_b16 v[38:39], v9 offset:1024
v_mfma_f32_16x16x32_bf16 v[144:147], v[84:87], v[112:115], v[144:147]
ds_read_b64_tr_b16 v[40:41], v10 offset:0
v_mfma_f32_16x16x32_bf16 v[160:163], v[88:91], v[112:115], v[160:163]
buffer_load_dwordx4 v1, s[44:47], s72 offen offset:2048 sc1 lds
v_mfma_f32_16x16x32_bf16 v[164:167], v[88:91], v[116:119], v[164:167]
ds_read_b64_tr_b16 v[42:43], v10 offset:1024
v_mfma_f32_16x16x32_bf16 v[168:171], v[88:91], v[120:123], v[168:171]
ds_read_b64_tr_b16 v[44:45], v11 offset:0
v_mfma_f32_16x16x32_bf16 v[172:175], v[88:91], v[124:127], v[172:175]
buffer_load_dwordx4 v1, s[44:47], s72 offen offset:3072 sc1 lds
v_mfma_f32_16x16x32_bf16 v[188:191], v[92:95], v[124:127], v[188:191]
ds_read_b64_tr_b16 v[46:47], v11 offset:1024
v_mfma_f32_16x16x32_bf16 v[184:187], v[92:95], v[120:123], v[184:187]
ds_read_b64_tr_b16 v[48:49], v12 offset:0
v_mfma_f32_16x16x32_bf16 v[180:183], v[92:95], v[116:119], v[180:183]
ds_read_b64_tr_b16 v[50:51], v12 offset:1024
v_mfma_f32_16x16x32_bf16 v[176:179], v[92:95], v[112:115], v[176:179]
s_add_u32 s81, s81, 0x8000
ds_read_b64_tr_b16 v[52:53], v13 offset:0
v_mfma_f32_16x16x32_bf16 v[192:195], v[96:99], v[112:115], v[192:195]
s_add_u32 m0, s64, 81920
ds_read_b64_tr_b16 v[54:55], v13 offset:1024
v_mfma_f32_16x16x32_bf16 v[196:199], v[96:99], v[116:119], v[196:199]
s_add_u32 s72, s81, 16384
buffer_load_dwordx4 v1, s[44:47], s72 offen sc1 lds
v_mfma_f32_16x16x32_bf16 v[200:203], v[96:99], v[120:123], v[200:203]
buffer_load_dwordx4 v1, s[44:47], s72 offen offset:1024 sc1 lds
v_mfma_f32_16x16x32_bf16 v[204:207], v[96:99], v[124:127], v[204:207]
ds_read_b64_tr_b16 v[56:57], v14 offset:0
v_mfma_f32_16x16x32_bf16 v[220:223], v[100:103], v[124:127], v[220:223]
ds_read_b64_tr_b16 v[58:59], v14 offset:1024
v_mfma_f32_16x16x32_bf16 v[216:219], v[100:103], v[120:123], v[216:219]
ds_read_b64_tr_b16 v[60:61], v15 offset:0
v_mfma_f32_16x16x32_bf16 v[212:215], v[100:103], v[116:119], v[212:215]
buffer_load_dwordx4 v1, s[44:47], s72 offen offset:2048 sc1 lds
v_mfma_f32_16x16x32_bf16 v[208:211], v[100:103], v[112:115], v[208:211]
ds_read_b64_tr_b16 v[62:63], v15 offset:1024
v_mfma_f32_16x16x32_bf16 v[224:227], v[104:107], v[112:115], v[224:227]
v_mfma_f32_16x16x32_bf16 v[228:231], v[104:107], v[116:119], v[228:231]
buffer_load_dwordx4 v1, s[44:47], s72 offen offset:3072 sc1 lds
v_mfma_f32_16x16x32_bf16 v[232:235], v[104:107], v[120:123], v[232:235]
v_mfma_f32_16x16x32_bf16 v[236:239], v[104:107], v[124:127], v[236:239]
v_mfma_f32_16x16x32_bf16 v[252:255], v[108:111], v[124:127], v[252:255]
v_mfma_f32_16x16x32_bf16 v[248:251], v[108:111], v[120:123], v[248:251]
s_add_u32 m0, s64, 65536
v_mfma_f32_16x16x32_bf16 v[244:247], v[108:111], v[116:119], v[244:247]
s_add_u32 s72, s81, 0
buffer_load_dwordx4 v1, s[44:47], s72 offen sc1 lds
v_mfma_f32_16x16x32_bf16 v[240:243], v[108:111], v[112:115], v[240:243]
s_waitcnt lgkmcnt(0)
v_mfma_f32_16x16x32_bf16 v[128:131], v[32:35], v[64:67], v[128:131]
buffer_load_dwordx4 v1, s[44:47], s72 offen offset:1024 sc1 lds
v_mfma_f32_16x16x32_bf16 v[132:135], v[32:35], v[68:71], v[132:135]
ds_read_b64_tr_b16 v[80:81], v8 offset:8192
v_add_u32 v2, 0x8000, v1
v_mfma_f32_16x16x32_bf16 v[136:139], v[32:35], v[72:75], v[136:139]
ds_read_b64_tr_b16 v[82:83], v8 offset:9216
ds_read_b128 v[112:115], v17 offset:0
v_mfma_f32_16x16x32_bf16 v[140:143], v[32:35], v[76:79], v[140:143]
ds_read_b128 v[116:119], v17 offset:2048
ds_read_b128 v[120:123], v17 offset:4096
v_mfma_f32_16x16x32_bf16 v[156:159], v[36:39], v[76:79], v[156:159]
buffer_load_dwordx4 v1, s[44:47], s72 offen offset:2048 sc1 lds
v_mfma_f32_16x16x32_bf16 v[152:155], v[36:39], v[72:75], v[152:155]
ds_read_b128 v[124:127], v17 offset:6144
ds_read_b64_tr_b16 v[84:85], v9 offset:8192
v_mfma_f32_16x16x32_bf16 v[148:151], v[36:39], v[68:71], v[148:151]
ds_read_b64_tr_b16 v[86:87], v9 offset:9216
v_mfma_f32_16x16x32_bf16 v[144:147], v[36:39], v[64:67], v[144:147]
ds_read_b64_tr_b16 v[88:89], v10 offset:8192
v_mfma_f32_16x16x32_bf16 v[160:163], v[40:43], v[64:67], v[160:163]
buffer_load_dwordx4 v1, s[44:47], s72 offen offset:3072 sc1 lds
v_mfma_f32_16x16x32_bf16 v[164:167], v[40:43], v[68:71], v[164:167]
ds_read_b64_tr_b16 v[90:91], v10 offset:9216
v_mfma_f32_16x16x32_bf16 v[168:171], v[40:43], v[72:75], v[168:171]
ds_read_b64_tr_b16 v[92:93], v11 offset:8192
v_mfma_f32_16x16x32_bf16 v[172:175], v[40:43], v[76:79], v[172:175]
s_add_u32 s81, s81, 0x8000
ds_read_b64_tr_b16 v[94:95], v11 offset:9216
v_mfma_f32_16x16x32_bf16 v[188:191], v[44:47], v[76:79], v[188:191]
s_add_u32 m0, s64, 114688
ds_read_b64_tr_b16 v[96:97], v12 offset:8192
v_mfma_f32_16x16x32_bf16 v[184:187], v[44:47], v[72:75], v[184:187]
s_add_u32 s72, s81, 16384
buffer_load_dwordx4 v1, s[44:47], s72 offen sc1 lds
v_mfma_f32_16x16x32_bf16 v[180:183], v[44:47], v[68:71], v[180:183]
ds_read_b64_tr_b16 v[98:99], v12 offset:9216
v_mfma_f32_16x16x32_bf16 v[176:179], v[44:47], v[64:67], v[176:179]
buffer_load_dwordx4 v1, s[44:47], s72 offen offset:1024 sc1 lds
v_mfma_f32_16x16x32_bf16 v[192:195], v[48:51], v[64:67], v[192:195]
ds_read_b64_tr_b16 v[100:101], v13 offset:8192
v_mfma_f32_16x16x32_bf16 v[196:199], v[48:51], v[68:71], v[196:199]
ds_read_b64_tr_b16 v[102:103], v13 offset:9216
v_mfma_f32_16x16x32_bf16 v[200:203], v[48:51], v[72:75], v[200:203]
buffer_load_dwordx4 v1, s[44:47], s72 offen offset:2048 sc1 lds
v_mfma_f32_16x16x32_bf16 v[204:207], v[48:51], v[76:79], v[204:207]
ds_read_b64_tr_b16 v[104:105], v14 offset:8192
v_mfma_f32_16x16x32_bf16 v[220:223], v[52:55], v[76:79], v[220:223]
ds_read_b64_tr_b16 v[106:107], v14 offset:9216
v_mfma_f32_16x16x32_bf16 v[216:219], v[52:55], v[72:75], v[216:219]
ds_read_b64_tr_b16 v[108:109], v15 offset:8192
v_mfma_f32_16x16x32_bf16 v[212:215], v[52:55], v[68:71], v[212:215]
buffer_load_dwordx4 v1, s[44:47], s72 offen offset:3072 sc1 lds
v_mfma_f32_16x16x32_bf16 v[208:211], v[52:55], v[64:67], v[208:211]
ds_read_b64_tr_b16 v[110:111], v15 offset:9216
v_mfma_f32_16x16x32_bf16 v[224:227], v[56:59], v[64:67], v[224:227]
v_mfma_f32_16x16x32_bf16 v[228:231], v[56:59], v[68:71], v[228:231]
s_add_u32 m0, s64, 98304
v_mfma_f32_16x16x32_bf16 v[232:235], v[56:59], v[72:75], v[232:235]
s_add_u32 s72, s81, 0
buffer_load_dwordx4 v1, s[44:47], s72 offen sc1 lds
v_mfma_f32_16x16x32_bf16 v[236:239], v[56:59], v[76:79], v[236:239]
v_mfma_f32_16x16x32_bf16 v[252:255], v[60:63], v[76:79], v[252:255]
v_mfma_f32_16x16x32_bf16 v[248:251], v[60:63], v[72:75], v[248:251]
buffer_load_dwordx4 v1, s[44:47], s72 offen offset:1024 sc1 lds
v_mfma_f32_16x16x32_bf16 v[244:247], v[60:63], v[68:71], v[244:247]
s_waitcnt vmcnt(14) lgkmcnt(0)
v_mfma_f32_16x16x32_bf16 v[240:243], v[60:63], v[64:67], v[240:243]
s_barrier
v_mfma_f32_16x16x32_bf16 v[128:131], v[80:83], v[112:115], v[128:131]
buffer_load_dwordx4 v1, s[44:47], s72 offen offset:2048 sc1 lds
v_mfma_f32_16x16x32_bf16 v[132:135], v[80:83], v[116:119], v[132:135]
ds_read_b128 a[128:131], v2 offset:16384
v_mfma_f32_16x16x32_bf16 v[136:139], v[80:83], v[120:123], v[136:139]
ds_read_b128 a[144:147], v2 offset:20480
v_mfma_f32_16x16x32_bf16 v[140:143], v[80:83], v[124:127], v[140:143]
ds_read_b128 a[132:135], v2 offset:17408
v_mfma_f32_16x16x32_bf16 v[156:159], v[84:87], v[124:127], v[156:159]
buffer_load_dwordx4 v1, s[44:47], s72 offen offset:3072 sc1 lds
v_mfma_f32_16x16x32_bf16 v[152:155], v[84:87], v[120:123], v[152:155]
ds_read_b128 a[148:151], v2 offset:21504
v_mfma_f32_16x16x32_bf16 v[148:151], v[84:87], v[116:119], v[148:151]
ds_read_b128 a[136:139], v2 offset:18432
v_mfma_f32_16x16x32_bf16 v[144:147], v[84:87], v[112:115], v[144:147]
ds_read_b128 a[152:155], v2 offset:22528
v_mfma_f32_16x16x32_bf16 v[160:163], v[88:91], v[112:115], v[160:163]
ds_read_b128 a[140:143], v2 offset:19456
v_mfma_f32_16x16x32_bf16 v[164:167], v[88:91], v[116:119], v[164:167]
ds_read_b128 a[156:159], v2 offset:23552
v_mfma_f32_16x16x32_bf16 v[168:171], v[88:91], v[120:123], v[168:171]
v_mfma_f32_16x16x32_bf16 v[172:175], v[88:91], v[124:127], v[172:175]
v_mfma_f32_16x16x32_bf16 v[188:191], v[92:95], v[124:127], v[188:191]
v_cvt_pk_bf16_f32 v64, v140, v141
v_cvt_pk_bf16_f32 v65, v142, v143
v_mfma_f32_16x16x32_bf16 v[184:187], v[92:95], v[120:123], v[184:187]
v_cvt_pk_bf16_f32 v66, v156, v157
v_cvt_pk_bf16_f32 v67, v158, v159
v_mfma_f32_16x16x32_bf16 v[180:183], v[92:95], v[116:119], v[180:183]
v_cvt_pk_bf16_f32 v48, v136, v137
v_cvt_pk_bf16_f32 v49, v138, v139
v_mfma_f32_16x16x32_bf16 v[176:179], v[92:95], v[112:115], v[176:179]
v_cvt_pk_bf16_f32 v50, v152, v153
v_cvt_pk_bf16_f32 v51, v154, v155
v_mfma_f32_16x16x32_bf16 v[192:195], v[96:99], v[112:115], v[192:195]
v_cvt_pk_bf16_f32 v32, v132, v133
v_cvt_pk_bf16_f32 v33, v134, v135
v_mfma_f32_16x16x32_bf16 v[196:199], v[96:99], v[116:119], v[196:199]
v_cvt_pk_bf16_f32 v34, v148, v149
v_cvt_pk_bf16_f32 v35, v150, v151
v_mfma_f32_16x16x32_bf16 v[200:203], v[96:99], v[120:123], v[200:203]
v_cvt_pk_bf16_f32 v16, v128, v129
v_cvt_pk_bf16_f32 v17, v130, v131
v_mfma_f32_16x16x32_bf16 v[204:207], v[96:99], v[124:127], v[204:207]
v_cvt_pk_bf16_f32 v18, v144, v145
v_cvt_pk_bf16_f32 v19, v146, v147
v_mfma_f32_16x16x32_bf16 v[220:223], v[100:103], v[124:127], v[220:223]
v_cvt_pk_bf16_f32 v68, v172, v173
v_cvt_pk_bf16_f32 v69, v174, v175
v_mfma_f32_16x16x32_bf16 v[216:219], v[100:103], v[120:123], v[216:219]
v_cvt_pk_bf16_f32 v70, v188, v189
v_cvt_pk_bf16_f32 v71, v190, v191
v_mfma_f32_16x16x32_bf16 v[212:215], v[100:103], v[116:119], v[212:215]
v_cvt_pk_bf16_f32 v52, v168, v169
v_cvt_pk_bf16_f32 v53, v170, v171
v_mfma_f32_16x16x32_bf16 v[208:211], v[100:103], v[112:115], v[208:211]
v_cvt_pk_bf16_f32 v54, v184, v185
v_cvt_pk_bf16_f32 v55, v186, v187
v_mfma_f32_16x16x32_bf16 v[224:227], v[104:107], v[112:115], v[224:227]
v_cvt_pk_bf16_f32 v36, v164, v165
v_cvt_pk_bf16_f32 v37, v166, v167
v_mfma_f32_16x16x32_bf16 v[228:231], v[104:107], v[116:119], v[228:231]
v_cvt_pk_bf16_f32 v38, v180, v181
v_cvt_pk_bf16_f32 v39, v182, v183
v_mfma_f32_16x16x32_bf16 v[232:235], v[104:107], v[120:123], v[232:235]
v_cvt_pk_bf16_f32 v20, v160, v161
v_cvt_pk_bf16_f32 v21, v162, v163
v_mfma_f32_16x16x32_bf16 v[236:239], v[104:107], v[124:127], v[236:239]
v_cvt_pk_bf16_f32 v22, v176, v177
v_cvt_pk_bf16_f32 v23, v178, v179
v_mfma_f32_16x16x32_bf16 v[252:255], v[108:111], v[124:127], v[252:255]
v_cvt_pk_bf16_f32 v72, v204, v205
v_cvt_pk_bf16_f32 v73, v206, v207
v_mfma_f32_16x16x32_bf16 v[248:251], v[108:111], v[120:123], v[248:251]
v_cvt_pk_bf16_f32 v74, v220, v221
v_cvt_pk_bf16_f32 v75, v222, v223
v_mfma_f32_16x16x32_bf16 v[244:247], v[108:111], v[116:119], v[244:247]
v_cvt_pk_bf16_f32 v56, v200, v201
v_cvt_pk_bf16_f32 v57, v202, v203
v_mfma_f32_16x16x32_bf16 v[240:243], v[108:111], v[112:115], v[240:243]
v_cvt_pk_bf16_f32 v58, v216, v217
v_cvt_pk_bf16_f32 v59, v218, v219
v_cvt_pk_bf16_f32 v40, v196, v197
v_cvt_pk_bf16_f32 v41, v198, v199
v_cvt_pk_bf16_f32 v42, v212, v213
v_cvt_pk_bf16_f32 v43, v214, v215
v_cvt_pk_bf16_f32 v24, v192, v193
v_cvt_pk_bf16_f32 v25, v194, v195
v_cvt_pk_bf16_f32 v26, v208, v209
v_cvt_pk_bf16_f32 v27, v210, v211
v_cvt_pk_bf16_f32 v76, v236, v237
v_cvt_pk_bf16_f32 v77, v238, v239
v_cvt_pk_bf16_f32 v78, v252, v253
v_cvt_pk_bf16_f32 v79, v254, v255
v_cvt_pk_bf16_f32 v60, v232, v233
v_cvt_pk_bf16_f32 v61, v234, v235
v_cvt_pk_bf16_f32 v62, v248, v249
v_cvt_pk_bf16_f32 v63, v250, v251
v_cvt_pk_bf16_f32 v44, v228, v229
v_cvt_pk_bf16_f32 v45, v230, v231
v_cvt_pk_bf16_f32 v46, v244, v245
v_cvt_pk_bf16_f32 v47, v246, v247
v_cvt_pk_bf16_f32 v28, v224, v225
v_cvt_pk_bf16_f32 v29, v226, v227
v_cvt_pk_bf16_f32 v30, v240, v241
v_cvt_pk_bf16_f32 v31, v242, v243
v_mov_b32 v124, 0xff800000
v_mov_b32 v125, 0xff800000
v_mov_b32 v126, 0xff800000
v_mov_b32 v127, 0xff800000
s_lshl_b32 s84, s60, 2
s_add_u32 s84, s84, s58
s_lshl_b32 s85, s60, 3
s_sub_u32 s85, s58, s85
s_add_u32 s85, s85, 56
s_mov_b32 s86, 0
s_add_u32 s61, s61, s60
Lattn:
s_mov_b32 s82, 0x10000
s_waitcnt lgkmcnt(0)
v_mfma_f32_16x16x32_bf16 v[136:139], a[128:131], v[48:51], 0
ds_read_b128 a[160:163], v2 offset:24576
v_lshrrev_b32 v240, 4, v0
v_mfma_f32_16x16x32_bf16 v[140:143], a[128:131], v[64:67], 0
ds_read_b128 a[176:179], v2 offset:28672
v_and_b32 v241, 15, v0
v_mfma_f32_16x16x32_bf16 v[152:155], a[144:147], v[48:51], 0
ds_read_b128 a[164:167], v2 offset:25600
v_lshlrev_b32 v240, 2, v240
v_mfma_f32_16x16x32_bf16 v[156:159], a[144:147], v[64:67], 0
ds_read_b128 a[180:183], v2 offset:29696
v_sub_u32 v240, v241, v240
v_mfma_f32_16x16x32_bf16 v[136:139], a[132:135], v[52:55], v[136:139]
ds_read_b128 a[168:171], v2 offset:26624
v_mov_b32 v112, 0xff800000
v_mfma_f32_16x16x32_bf16 v[140:143], a[132:135], v[68:71], v[140:143]
ds_read_b128 a[184:187], v2 offset:30720
v_mov_b32 v113, 0xff800000
v_mfma_f32_16x16x32_bf16 v[156:159], a[148:151], v[68:71], v[156:159]
ds_read_b128 a[172:175], v2 offset:27648
v_mov_b32 v114, 0xff800000
v_mfma_f32_16x16x32_bf16 v[152:155], a[148:151], v[52:55], v[152:155]
ds_read_b128 a[188:191], v2 offset:31744
v_mov_b32 v115, 0xff800000
v_mfma_f32_16x16x32_bf16 v[140:143], a[136:139], v[72:75], v[140:143]
v_cmp_gt_i32 vcc, 0, v240
v_mov_b32 v120, 0x3f803f80
v_mfma_f32_16x16x32_bf16 v[136:139], a[136:139], v[56:59], v[136:139]
v_cndmask_b32 v116, 0, v112, vcc
v_cmp_gt_i32 vcc, 1, v240
v_mfma_f32_16x16x32_bf16 v[152:155], a[152:155], v[56:59], v[152:155]
v_mov_b32 v121, 0x3f803f80
v_cndmask_b32 v117, 0, v112, vcc
v_mfma_f32_16x16x32_bf16 v[156:159], a[152:155], v[72:75], v[156:159]
v_cmp_gt_i32 vcc, 2, v240
v_mov_b32 v122, 0x3f803f80
v_mfma_f32_16x16x32_bf16 v[136:139], a[140:143], v[60:63], v[136:139]
v_cndmask_b32 v118, 0, v112, vcc
v_cmp_gt_i32 vcc, 3, v240
v_mfma_f32_16x16x32_bf16 v[140:143], a[140:143], v[76:79], v[140:143]
v_mov_b32 v123, 0x3f803f80
v_cndmask_b32 v119, 0, v112, vcc
v_mfma_f32_16x16x32_bf16 v[156:159], a[156:159], v[76:79], v[156:159]
v_mfma_f32_16x16x32_bf16 v[152:155], a[156:159], v[60:63], v[152:155]
s_cmp_eq_u32 s84, 0
s_cbranch_scc1 Lalt7
v_mfma_f32_16x16x32_bf16 v[128:131], a[128:131], v[16:19], 0
v_mfma_f32_16x16x32_bf16 v[132:135], a[128:131], v[32:35], 0
v_mfma_f32_16x16x32_bf16 v[144:147], a[144:147], v[16:19], 0
v_mfma_f32_16x16x32_bf16 v[148:151], a[144:147], v[32:35], 0
Ljoin8:
v_mfma_f32_16x16x32_bf16 v[128:131], a[132:135], v[20:23], v[128:131]
v_mfma_f32_16x16x32_bf16 v[132:135], a[132:135], v[36:39], v[132:135]
v_max3_f32 v240, v136, v137, v126
v_max3_f32 v242, v140, v141, v127
v_mfma_f32_16x16x32_bf16 v[148:151], a[148:151], v[36:39], v[148:151]
v_max3_f32 v240, v240, v138, v139
v_max3_f32 v242, v242, v142, v143
v_mfma_f32_16x16x32_bf16 v[144:147], a[148:151], v[20:23], v[144:147]
v_max3_f32 v240, v240, v152, v153
v_max3_f32 v242, v242, v156, v157
v_mfma_f32_16x16x32_bf16 v[132:135], a[136:139], v[40:43], v[132:135]
v_max3_f32 v240, v240, v154, v155
v_max3_f32 v242, v242, v158, v159
v_mfma_f32_16x16x32_bf16 v[128:131], a[136:139], v[24:27], v[128:131]
v_mov_b32 v241, v240
v_mov_b32 v243, v242
v_mfma_f32_16x16x32_bf16 v[144:147], a[152:155], v[24:27], v[144:147]
v_permlane16_swap_b32 v240, v241
v_permlane16_swap_b32 v242, v243
v_mfma_f32_16x16x32_bf16 v[148:151], a[152:155], v[40:43], v[148:151]
v_max_f32 v240, v240, v241
v_max_f32 v242, v242, v243
v_mfma_f32_16x16x32_bf16 v[128:131], a[140:143], v[28:31], v[128:131]
v_mov_b32 v241, v240
v_mov_b32 v243, v242
v_mfma_f32_16x16x32_bf16 v[132:135], a[140:143], v[44:47], v[132:135]
v_permlane32_swap_b32 v240, v241
v_permlane32_swap_b32 v242, v243
v_mfma_f32_16x16x32_bf16 v[148:151], a[156:159], v[44:47], v[148:151]
v_max_f32 v240, v240, v241
v_max_f32 v242, v242, v243
v_mfma_f32_16x16x32_bf16 v[144:147], a[156:159], v[28:31], v[144:147]
v_sub_f32 v88, 0, v240
v_sub_f32 v89, 0, v240
v_sub_f32 v90, 0, v240
v_sub_f32 v91, 0, v240
v_sub_f32 v104, v116, v240
v_sub_f32 v105, v117, v240
v_sub_f32 v106, v118, v240
v_sub_f32 v107, v119, v240
v_sub_f32 v136, v136, v240
v_sub_f32 v137, v137, v240
v_sub_f32 v138, v138, v240
v_sub_f32 v139, v139, v240
v_sub_f32 v152, v152, v240
v_sub_f32 v153, v153, v240
v_sub_f32 v154, v154, v240
v_sub_f32 v155, v155, v240
v_sub_f32 v92, 0, v242
v_sub_f32 v93, 0, v242
v_sub_f32 v94, 0, v242
v_sub_f32 v95, 0, v242
v_sub_f32 v108, v116, v242
v_sub_f32 v109, v117, v242
v_sub_f32 v110, v118, v242
v_sub_f32 v111, v119, v242
v_sub_f32 v140, v140, v242
v_sub_f32 v141, v141, v242
v_sub_f32 v142, v142, v242
v_sub_f32 v143, v143, v242
v_sub_f32 v156, v156, v242
v_sub_f32 v157, v157, v242
v_sub_f32 v158, v158, v242
v_sub_f32 v159, v159, v242
v_max3_f32 v240, v128, v129, v124
v_max3_f32 v242, v132, v133, v125
v_max3_f32 v240, v240, v130, v131
v_max3_f32 v242, v242, v134, v135
v_max3_f32 v240, v240, v144, v145
v_max3_f32 v242, v242, v148, v149
v_max3_f32 v240, v240, v146, v147
v_max3_f32 v242, v242, v150, v151
v_mov_b32 v241, v240
v_mov_b32 v243, v242
s_nop 0
v_permlane16_swap_b32 v240, v241
v_permlane16_swap_b32 v242, v243
v_max_f32 v240, v240, v241
v_max_f32 v242, v242, v243
v_mov_b32 v241, v240
v_mov_b32 v243, v242
s_nop 0
v_permlane32_swap_b32 v240, v241
v_permlane32_swap_b32 v242, v243
v_max_f32 v240, v240, v241
v_max_f32 v242, v242, v243
v_sub_f32 v80, 0, v240
v_sub_f32 v81, 0, v240
v_sub_f32 v82, 0, v240
v_sub_f32 v83, 0, v240
v_sub_f32 v96, v116, v240
v_sub_f32 v97, v117, v240
v_sub_f32 v98, v118, v240
v_sub_f32 v99, v119, v240
v_sub_f32 v128, v128, v240
v_sub_f32 v129, v129, v240
v_sub_f32 v130, v130, v240
v_sub_f32 v131, v131, v240
v_sub_f32 v144, v144, v240
v_sub_f32 v145, v145, v240
v_sub_f32 v146, v146, v240
v_sub_f32 v147, v147, v240
v_sub_f32 v84, 0, v242
v_sub_f32 v85, 0, v242
v_sub_f32 v86, 0, v242
v_sub_f32 v87, 0, v242
v_sub_f32 v100, v116, v242
v_sub_f32 v101, v117, v242
v_sub_f32 v102, v118, v242
v_sub_f32 v103, v119, v242
v_sub_f32 v132, v132, v242
v_sub_f32 v133, v133, v242
v_sub_f32 v134, v134, v242
v_sub_f32 v135, v135, v242
v_sub_f32 v148, v148, v242
v_sub_f32 v149, v149, v242
v_sub_f32 v150, v150, v242
v_sub_f32 v151, v151, v242
v_lshrrev_b32 v3, 1, v0
v_lshlrev_b32 v3, 7, v3
v_add_u32 v2, s82, v1
s_waitcnt vmcnt(8) lgkmcnt(0)
s_barrier
s_cmp_le_u32 s84, 1
s_cbranch_scc1 Lalt9
v_mfma_f32_16x16x32_bf16 v[160:163], a[160:163], v[16:19], v[80:83]
s_xor_b32 s74, s82, 0x10000
v_exp_f32 v128, v128
v_mfma_f32_16x16x32_bf16 v[164:167], a[160:163], v[32:35], v[84:87]
s_add_u32 s74, s74, s64
ds_read_b128 a[128:131], v2 offset:16384
ds_read_b128 a[144:147], v2 offset:20480
v_mfma_f32_16x16x32_bf16 v[176:179], a[176:179], v[16:19], v[80:83]
s_add_u32 s81, s81, 0x8000
v_exp_f32 v129, v129
v_mfma_f32_16x16x32_bf16 v[180:183], a[176:179], v[32:35], v[84:87]
s_add_u32 m0, s74, 16384
v_exp_f32 v130, v130
Ljoin11:
v_mfma_f32_16x16x32_bf16 v[168:171], a[160:163], v[48:51], v[88:91]
s_add_u32 s72, s81, 16384
v_exp_f32 v131, v131
v_mfma_f32_16x16x32_bf16 v[172:175], a[160:163], v[64:67], v[92:95]
v_exp_f32 v144, v144
v_mfma_f32_16x16x32_bf16 v[184:187], a[176:179], v[48:51], v[88:91]
ds_read_b128 a[132:135], v2 offset:17408
ds_read_b128 a[148:151], v2 offset:21504
v_mfma_f32_16x16x32_bf16 v[188:191], a[176:179], v[64:67], v[92:95]
ds_read_b128 a[136:139], v2 offset:18432
ds_read_b128 a[152:155], v2 offset:22528
v_mfma_f32_16x16x32_bf16 v[160:163], a[164:167], v[20:23], v[160:163]
ds_read_b128 a[140:143], v2 offset:19456
ds_read_b128 a[156:159], v2 offset:23552
v_mfma_f32_16x16x32_bf16 v[164:167], a[164:167], v[36:39], v[164:167]
ds_read_b128 a[192:195], v2 offset:0
ds_read_b128 a[196:199], v2 offset:1024
v_mfma_f32_16x16x32_bf16 v[168:171], a[164:167], v[52:55], v[168:171]
ds_read_b128 a[200:203], v2 offset:2048
ds_read_b128 a[204:207], v2 offset:3072
v_mfma_f32_16x16x32_bf16 v[172:175], a[164:167], v[68:71], v[172:175]
ds_read_b128 a[208:211], v2 offset:4096
ds_read_b128 a[212:215], v2 offset:5120
v_mfma_f32_16x16x32_bf16 v[188:191], a[180:183], v[68:71], v[188:191]
ds_read_b128 a[216:219], v2 offset:6144
ds_read_b128 a[220:223], v2 offset:7168
v_mfma_f32_16x16x32_bf16 v[184:187], a[180:183], v[52:55], v[184:187]
v_cvt_pk_bf16_f32 v192, v128, v129
v_cvt_pk_bf16_f32 v193, v130, v131
v_mfma_f32_16x16x32_bf16 v[180:183], a[180:183], v[36:39], v[180:183]
buffer_load_dwordx4 v1, s[44:47], s72 offen sc1 lds
v_mfma_f32_16x16x32_bf16 v[176:179], a[180:183], v[20:23], v[176:179]
v_exp_f32 v145, v145
v_mfma_f32_16x16x32_bf16 v[172:175], a[168:171], v[72:75], v[172:175]
v_exp_f32 v146, v146
v_mfma_f32_16x16x32_bf16 v[168:171], a[168:171], v[56:59], v[168:171]
v_exp_f32 v147, v147
v_mfma_f32_16x16x32_bf16 v[164:167], a[168:171], v[40:43], v[164:167]
v_exp_f32 v132, v132
v_mfma_f32_16x16x32_bf16 v[160:163], a[168:171], v[24:27], v[160:163]
v_cvt_pk_bf16_f32 v194, v144, v145
v_cvt_pk_bf16_f32 v195, v146, v147
v_mfma_f32_16x16x32_bf16 v[176:179], a[184:187], v[24:27], v[176:179]
v_exp_f32 v133, v133
v_mfma_f32_16x16x32_bf16 v[180:183], a[184:187], v[40:43], v[180:183]
v_exp_f32 v134, v134
v_mfma_f32_16x16x32_bf16 v[184:187], a[184:187], v[56:59], v[184:187]
v_exp_f32 v135, v135
v_mfma_f32_16x16x32_bf16 v[188:191], a[184:187], v[72:75], v[188:191]
v_exp_f32 v148, v148
v_mfma_f32_16x16x32_bf16 v[160:163], a[172:175], v[28:31], v[160:163]
v_cvt_pk_bf16_f32 v196, v132, v133
v_cvt_pk_bf16_f32 v197, v134, v135
v_mfma_f32_16x16x32_bf16 v[164:167], a[172:175], v[44:47], v[164:167]
buffer_load_dwordx4 v1, s[44:47], s72 offen offset:1024 sc1 lds
v_mfma_f32_16x16x32_bf16 v[168:171], a[172:175], v[60:63], v[168:171]
v_exp_f32 v149, v149
v_mfma_f32_16x16x32_bf16 v[172:175], a[172:175], v[76:79], v[172:175]
v_exp_f32 v150, v150
v_mfma_f32_16x16x32_bf16 v[188:191], a[188:191], v[76:79], v[188:191]
v_exp_f32 v151, v151
v_mfma_f32_16x16x32_bf16 v[184:187], a[188:191], v[60:63], v[184:187]
buffer_load_dwordx4 v1, s[44:47], s72 offen offset:2048 sc1 lds
v_mfma_f32_16x16x32_bf16 v[180:183], a[188:191], v[44:47], v[180:183]
buffer_load_dwordx4 v1, s[44:47], s72 offen offset:3072 sc1 lds
v_mfma_f32_16x16x32_bf16 v[176:179], a[188:191], v[28:31], v[176:179]
s_waitcnt lgkmcnt(8)
v_exp_f32 v136, v136
v_cvt_pk_bf16_f32 v198, v148, v149
v_cvt_pk_bf16_f32 v199, v150, v151
v_exp_f32 v137, v137
v_exp_f32 v138, v138
v_cvt_pk_bf16_f32 v200, v136, v137
v_exp_f32 v139, v139
v_exp_f32 v152, v152
v_cvt_pk_bf16_f32 v201, v138, v139
v_exp_f32 v153, v153
v_exp_f32 v154, v154
v_cvt_pk_bf16_f32 v202, v152, v153
v_exp_f32 v155, v155
v_exp_f32 v140, v140
v_cvt_pk_bf16_f32 v203, v154, v155
v_exp_f32 v141, v141
v_exp_f32 v142, v142
v_cvt_pk_bf16_f32 v204, v140, v141
v_exp_f32 v143, v143
v_exp_f32 v156, v156
v_cvt_pk_bf16_f32 v205, v142, v143
v_exp_f32 v157, v157
v_exp_f32 v158, v158
v_cvt_pk_bf16_f32 v206, v156, v157
v_exp_f32 v159, v159
s_nop 0
v_cvt_pk_bf16_f32 v207, v158, v159
s_cmp_le_u32 s84, 2
s_cbranch_scc1 Lalt12
v_mfma_f32_16x16x32_bf16 v[128:131], a[128:131], v[16:19], v[80:83]
s_add_u32 s82, s82, 0x8000
ds_read_b128 a[160:163], v2 offset:24576
v_mfma_f32_16x16x32_bf16 v[132:135], a[128:131], v[32:35], v[84:87]
s_and_b32 s82, s82, 0x1ffff
v_exp_f32 v160, v160
v_mfma_f32_16x16x32_bf16 v[144:147], a[144:147], v[16:19], v[80:83]
s_lshl_b32 s73, s93, 1
v_exp_f32 v161, v161
v_mfma_f32_16x16x32_bf16 v[148:151], a[144:147], v[32:35], v[84:87]
ds_read_b128 a[176:179], v2 offset:28672
v_cvt_pk_bf16_f32 v208, v160, v161
Ljoin14:
v_mfma_f32_16x16x32_bf16 v[136:139], a[128:131], v[48:51], v[88:91]
v_exp_f32 v162, v162
v_mfma_f32_16x16x32_bf16 v[140:143], a[128:131], v[64:67], v[92:95]
v_exp_f32 v163, v163
v_mfma_f32_16x16x32_bf16 v[152:155], a[144:147], v[48:51], v[88:91]
buffer_load_dword v4, v3, s[24:27], s73 offen
v_mfma_f32_16x16x32_bf16 v[156:159], a[144:147], v[64:67], v[92:95]
s_add_u32 m0, s74, 0
ds_read_b128 a[164:167], v2 offset:25600
v_cvt_pk_bf16_f32 v209, v162, v163
v_mfma_f32_16x16x32_bf16 v[128:131], a[132:135], v[20:23], v[128:131]
s_add_u32 s72, s81, 0
v_exp_f32 v176, v176
v_mfma_f32_16x16x32_bf16 v[132:135], a[132:135], v[36:39], v[132:135]
v_exp_f32 v177, v177
v_mfma_f32_16x16x32_bf16 v[136:139], a[132:135], v[52:55], v[136:139]
ds_read_b128 a[180:183], v2 offset:29696
v_cvt_pk_bf16_f32 v210, v176, v177
v_mfma_f32_16x16x32_bf16 v[140:143], a[132:135], v[68:71], v[140:143]
v_exp_f32 v178, v178
v_mfma_f32_16x16x32_bf16 v[156:159], a[148:151], v[68:71], v[156:159]
v_exp_f32 v179, v179
v_mfma_f32_16x16x32_bf16 v[152:155], a[148:151], v[52:55], v[152:155]
ds_read_b128 a[168:171], v2 offset:26624
v_cvt_pk_bf16_f32 v211, v178, v179
v_mfma_f32_16x16x32_bf16 v[148:151], a[148:151], v[36:39], v[148:151]
v_exp_f32 v164, v164
v_mfma_f32_16x16x32_bf16 v[144:147], a[148:151], v[20:23], v[144:147]
v_exp_f32 v165, v165
v_mfma_f32_16x16x32_bf16 v[140:143], a[136:139], v[72:75], v[140:143]
ds_read_b128 a[184:187], v2 offset:30720
v_cvt_pk_bf16_f32 v212, v164, v165
v_mfma_f32_16x16x32_bf16 v[136:139], a[136:139], v[56:59], v[136:139]
v_exp_f32 v166, v166
v_mfma_f32_16x16x32_bf16 v[132:135], a[136:139], v[40:43], v[132:135]
buffer_load_dwordx4 v1, s[44:47], s72 offen sc1 lds
v_mfma_f32_16x16x32_bf16 v[128:131], a[136:139], v[24:27], v[128:131]
v_exp_f32 v167, v167
v_mfma_f32_16x16x32_bf16 v[144:147], a[152:155], v[24:27], v[144:147]
ds_read_b128 a[172:175], v2 offset:27648
v_cvt_pk_bf16_f32 v213, v166, v167
v_mfma_f32_16x16x32_bf16 v[148:151], a[152:155], v[40:43], v[148:151]
v_exp_f32 v180, v180
v_mfma_f32_16x16x32_bf16 v[152:155], a[152:155], v[56:59], v[152:155]
v_exp_f32 v181, v181
v_mfma_f32_16x16x32_bf16 v[156:159], a[152:155], v[72:75], v[156:159]
ds_read_b128 a[188:191], v2 offset:31744
v_cvt_pk_bf16_f32 v214, v180, v181
v_mfma_f32_16x16x32_bf16 v[128:131], a[140:143], v[28:31], v[128:131]
v_exp_f32 v182, v182
v_mfma_f32_16x16x32_bf16 v[132:135], a[140:143], v[44:47], v[132:135]
v_exp_f32 v183, v183
v_mfma_f32_16x16x32_bf16 v[136:139], a[140:143], v[60:63], v[136:139]
ds_read_b128 a[224:227], v2 offset:8192
v_cvt_pk_bf16_f32 v215, v182, v183
v_mfma_f32_16x16x32_bf16 v[140:143], a[140:143], v[76:79], v[140:143]
v_exp_f32 v168, v168
v_mfma_f32_16x16x32_bf16 v[156:159], a[156:159], v[76:79], v[156:159]
buffer_load_dwordx4 v1, s[44:47], s72 offen offset:1024 sc1 lds
v_mfma_f32_16x16x32_bf16 v[152:155], a[156:159], v[60:63], v[152:155]
v_exp_f32 v169, v169
v_mfma_f32_16x16x32_bf16 v[148:151], a[156:159], v[44:47], v[148:151]
ds_read_b128 a[228:231], v2 offset:9216
v_cvt_pk_bf16_f32 v216, v168, v169
v_mfma_f32_16x16x32_bf16 v[144:147], a[156:159], v[28:31], v[144:147]
s_waitcnt lgkmcnt(10)
v_exp_f32 v170, v170
v_mfma_f32_16x16x32_bf16 a[0:3], a[192:195], v[192:195], 0
v_exp_f32 v171, v171
v_mfma_f32_16x16x32_bf16 a[32:35], a[192:195], v[196:199], 0
ds_read_b128 a[232:235], v2 offset:10240
v_cvt_pk_bf16_f32 v217, v170, v171
v_mfma_f32_16x16x32_bf16 a[64:67], a[192:195], v[200:203], 0
v_exp_f32 v184, v184
v_mfma_f32_16x16x32_bf16 a[96:99], a[192:195], v[204:207], 0
v_exp_f32 v185, v185
v_mfma_f32_16x16x32_bf16 a[100:103], a[196:199], v[204:207], 0
ds_read_b128 a[236:239], v2 offset:11264
v_cvt_pk_bf16_f32 v218, v184, v185
v_mfma_f32_16x16x32_bf16 a[68:71], a[196:199], v[200:203], 0
v_exp_f32 v186, v186
v_mfma_f32_16x16x32_bf16 a[36:39], a[196:199], v[196:199], 0
buffer_load_dwordx4 v1, s[44:47], s72 offen offset:2048 sc1 lds
v_mfma_f32_16x16x32_bf16 a[4:7], a[196:199], v[192:195], 0
v_exp_f32 v187, v187
v_mfma_f32_16x16x32_bf16 a[8:11], a[200:203], v[192:195], 0
ds_read_b128 a[240:243], v2 offset:12288
v_cvt_pk_bf16_f32 v219, v186, v187
v_mfma_f32_16x16x32_bf16 a[40:43], a[200:203], v[196:199], 0
v_exp_f32 v172, v172
v_mfma_f32_16x16x32_bf16 a[72:75], a[200:203], v[200:203], 0
v_exp_f32 v173, v173
v_mfma_f32_16x16x32_bf16 a[104:107], a[200:203], v[204:207], 0
ds_read_b128 a[244:247], v2 offset:13312
v_cvt_pk_bf16_f32 v220, v172, v173
v_mfma_f32_16x16x32_bf16 a[108:111], a[204:207], v[204:207], 0
v_exp_f32 v174, v174
v_mfma_f32_16x16x32_bf16 a[76:79], a[204:207], v[200:203], 0
v_exp_f32 v175, v175
v_mfma_f32_16x16x32_bf16 a[44:47], a[204:207], v[196:199], 0
ds_read_b128 a[248:251], v2 offset:14336
v_cvt_pk_bf16_f32 v221, v174, v175
v_mfma_f32_16x16x32_bf16 a[12:15], a[204:207], v[192:195], 0
v_exp_f32 v188, v188
v_mfma_f32_16x16x32_bf16 a[16:19], a[208:211], v[192:195], 0
v_exp_f32 v189, v189
v_mfma_f32_16x16x32_bf16 a[48:51], a[208:211], v[196:199], 0
buffer_load_dwordx4 v1, s[44:47], s72 offen offset:3072 sc1 lds
v_mfma_f32_16x16x32_bf16 a[80:83], a[208:211], v[200:203], 0
ds_read_b128 a[252:255], v2 offset:15360
v_cvt_pk_bf16_f32 v222, v188, v189
v_mfma_f32_16x16x32_bf16 a[112:115], a[208:211], v[204:207], 0
v_exp_f32 v190, v190
v_mfma_f32_16x16x32_bf16 a[116:119], a[212:215], v[204:207], 0
v_exp_f32 v191, v191
v_mfma_f32_16x16x32_bf16 a[84:87], a[212:215], v[200:203], 0
v_cvt_pk_bf16_f32 v223, v190, v191
v_add_u32 v2, s82, v1
v_mfma_f32_16x16x32_bf16 a[52:55], a[212:215], v[196:199], 0
v_mfma_f32_16x16x32_bf16 a[20:23], a[212:215], v[192:195], 0
v_mfma_f32_16x16x32_bf16 a[24:27], a[216:219], v[192:195], 0
v_mfma_f32_16x16x32_bf16 a[56:59], a[216:219], v[196:199], 0
v_mfma_f32_16x16x32_bf16 a[88:91], a[216:219], v[200:203], 0
v_mfma_f32_16x16x32_bf16 a[120:123], a[216:219], v[204:207], 0
v_mfma_f32_16x16x32_bf16 a[124:127], a[220:223], v[204:207], 0
v_mfma_f32_16x16x32_bf16 a[92:95], a[220:223], v[200:203], 0
v_mfma_f32_16x16x32_bf16 a[60:63], a[220:223], v[196:199], 0
v_mfma_f32_16x16x32_bf16 a[28:31], a[220:223], v[192:195], 0
v_mfma_f32_16x16x32_bf16 v[224:227], v[120:123], v[192:195], 0
v_mfma_f32_16x16x32_bf16 v[228:231], v[120:123], v[196:199], 0
v_mfma_f32_16x16x32_bf16 v[232:235], v[120:123], v[200:203], 0
s_waitcnt vmcnt(9) lgkmcnt(8)
v_mfma_f32_16x16x32_bf16 v[236:239], v[120:123], v[204:207], 0
s_barrier
s_cmp_eq_u32 s60, 0
s_cbranch_scc1 LLT3
s_lshl_b32 s83, s60, 1
s_sub_u32 s83, 2, s83
s_cmp_eq_u32 s83, 0
s_cbranch_scc1 LLT1
LloopI:
v_mfma_f32_16x16x32_bf16 v[160:163], a[160:163], v[16:19], v[80:83]
s_xor_b32 s74, s82, 0x10000
v_exp_f32 v128, v128
v_mfma_f32_16x16x32_bf16 v[164:167], a[160:163], v[32:35], v[84:87]
s_add_u32 s74, s74, s64
ds_read_b128 a[128:131], v2 offset:16384
v_mfma_f32_16x16x32_bf16 v[168:171], a[160:163], v[48:51], v[88:91]
s_add_u32 s81, s81, 0x8000
v_exp_f32 v129, v129
v_mfma_f32_16x16x32_bf16 v[172:175], a[160:163], v[64:67], v[92:95]
s_add_u32 m0, s74, 16384
v_exp_f32 v130, v130
v_mfma_f32_16x16x32_bf16 v[176:179], a[176:179], v[16:19], v[80:83]
s_add_u32 s72, s81, 16384
ds_read_b128 a[144:147], v2 offset:20480
v_cvt_pk_bf16_f32 v192, v128, v129
v_mfma_f32_16x16x32_bf16 v[180:183], a[176:179], v[32:35], v[84:87]
v_exp_f32 v131, v131
v_mfma_f32_16x16x32_bf16 v[184:187], a[176:179], v[48:51], v[88:91]
v_exp_f32 v144, v144
v_mfma_f32_16x16x32_bf16 v[188:191], a[176:179], v[64:67], v[92:95]
ds_read_b128 a[132:135], v2 offset:17408
v_cvt_pk_bf16_f32 v193, v130, v131
v_mfma_f32_16x16x32_bf16 v[160:163], a[164:167], v[20:23], v[160:163]
buffer_load_dwordx4 v1, s[44:47], s72 offen sc1 lds
v_mfma_f32_16x16x32_bf16 v[164:167], a[164:167], v[36:39], v[164:167]
v_exp_f32 v145, v145
v_mfma_f32_16x16x32_bf16 v[168:171], a[164:167], v[52:55], v[168:171]
v_exp_f32 v146, v146
v_mfma_f32_16x16x32_bf16 v[172:175], a[164:167], v[68:71], v[172:175]
ds_read_b128 a[148:151], v2 offset:21504
v_cvt_pk_bf16_f32 v194, v144, v145
v_mfma_f32_16x16x32_bf16 v[188:191], a[180:183], v[68:71], v[188:191]
v_exp_f32 v147, v147
v_mfma_f32_16x16x32_bf16 v[184:187], a[180:183], v[52:55], v[184:187]
v_exp_f32 v132, v132
v_mfma_f32_16x16x32_bf16 v[180:183], a[180:183], v[36:39], v[180:183]
ds_read_b128 a[136:139], v2 offset:18432
v_cvt_pk_bf16_f32 v195, v146, v147
v_mfma_f32_16x16x32_bf16 v[176:179], a[180:183], v[20:23], v[176:179]
v_exp_f32 v133, v133
v_mfma_f32_16x16x32_bf16 v[172:175], a[168:171], v[72:75], v[172:175]
v_exp_f32 v134, v134
v_mfma_f32_16x16x32_bf16 v[168:171], a[168:171], v[56:59], v[168:171]
ds_read_b128 a[152:155], v2 offset:22528
v_cvt_pk_bf16_f32 v196, v132, v133
v_mfma_f32_16x16x32_bf16 v[164:167], a[168:171], v[40:43], v[164:167]
v_exp_f32 v135, v135
v_mfma_f32_16x16x32_bf16 v[160:163], a[168:171], v[24:27], v[160:163]
v_exp_f32 v148, v148
v_mfma_f32_16x16x32_bf16 v[176:179], a[184:187], v[24:27], v[176:179]
ds_read_b128 a[140:143], v2 offset:19456
v_cvt_pk_bf16_f32 v197, v134, v135
v_mfma_f32_16x16x32_bf16 v[180:183], a[184:187], v[40:43], v[180:183]
buffer_load_dwordx4 v1, s[44:47], s72 offen offset:1024 sc1 lds
v_mfma_f32_16x16x32_bf16 v[184:187], a[184:187], v[56:59], v[184:187]
v_exp_f32 v149, v149
v_mfma_f32_16x16x32_bf16 v[188:191], a[184:187], v[72:75], v[188:191]
v_exp_f32 v150, v150
v_mfma_f32_16x16x32_bf16 v[160:163], a[172:175], v[28:31], v[160:163]
ds_read_b128 a[156:159], v2 offset:23552
v_cvt_pk_bf16_f32 v198, v148, v149
v_mfma_f32_16x16x32_bf16 v[164:167], a[172:175], v[44:47], v[164:167]
v_exp_f32 v151, v151
v_mfma_f32_16x16x32_bf16 v[168:171], a[172:175], v[60:63], v[168:171]
v_exp_f32 v136, v136
v_mfma_f32_16x16x32_bf16 v[172:175], a[172:175], v[76:79], v[172:175]
ds_read_b128 a[192:195], v2 offset:0
v_cvt_pk_bf16_f32 v199, v150, v151
v_mfma_f32_16x16x32_bf16 v[188:191], a[188:191], v[76:79], v[188:191]
v_exp_f32 v137, v137
v_mfma_f32_16x16x32_bf16 v[184:187], a[188:191], v[60:63], v[184:187]
v_exp_f32 v138, v138
v_mfma_f32_16x16x32_bf16 v[180:183], a[188:191], v[44:47], v[180:183]
ds_read_b128 a[196:199], v2 offset:1024
v_cvt_pk_bf16_f32 v200, v136, v137
v_mfma_f32_16x16x32_bf16 v[176:179], a[188:191], v[28:31], v[176:179]
s_waitcnt lgkmcnt(10)
v_exp_f32 v139, v139
v_mfma_f32_16x16x32_bf16 a[0:3], a[224:227], v[208:211], a[0:3]
v_exp_f32 v152, v152
v_mfma_f32_16x16x32_bf16 a[32:35], a[224:227], v[212:215], a[32:35]
ds_read_b128 a[200:203], v2 offset:2048
v_cvt_pk_bf16_f32 v201, v138, v139
v_mfma_f32_16x16x32_bf16 a[64:67], a[224:227], v[216:219], a[64:67]
buffer_load_dwordx4 v1, s[44:47], s72 offen offset:2048 sc1 lds
v_mfma_f32_16x16x32_bf16 a[96:99], a[224:227], v[220:223], a[96:99]
v_exp_f32 v153, v153
v_mfma_f32_16x16x32_bf16 a[100:103], a[228:231], v[220:223], a[100:103]
v_exp_f32 v154, v154
v_mfma_f32_16x16x32_bf16 a[68:71], a[228:231], v[216:219], a[68:71]
ds_read_b128 a[204:207], v2 offset:3072
v_cvt_pk_bf16_f32 v202, v152, v153
v_mfma_f32_16x16x32_bf16 a[36:39], a[228:231], v[212:215], a[36:39]
v_exp_f32 v155, v155
v_mfma_f32_16x16x32_bf16 a[4:7], a[228:231], v[208:211], a[4:7]
v_exp_f32 v140, v140
v_mfma_f32_16x16x32_bf16 a[8:11], a[232:235], v[208:211], a[8:11]
ds_read_b128 a[208:211], v2 offset:4096
v_cvt_pk_bf16_f32 v203, v154, v155
v_mfma_f32_16x16x32_bf16 a[40:43], a[232:235], v[212:215], a[40:43]
v_exp_f32 v141, v141
v_mfma_f32_16x16x32_bf16 a[72:75], a[232:235], v[216:219], a[72:75]
v_exp_f32 v142, v142
v_mfma_f32_16x16x32_bf16 a[104:107], a[232:235], v[220:223], a[104:107]
ds_read_b128 a[212:215], v2 offset:5120
v_cvt_pk_bf16_f32 v204, v140, v141
v_mfma_f32_16x16x32_bf16 a[108:111], a[236:239], v[220:223], a[108:111]
v_exp_f32 v143, v143
v_mfma_f32_16x16x32_bf16 a[76:79], a[236:239], v[216:219], a[76:79]
v_exp_f32 v156, v156
v_mfma_f32_16x16x32_bf16 a[44:47], a[236:239], v[212:215], a[44:47]
ds_read_b128 a[216:219], v2 offset:6144
v_cvt_pk_bf16_f32 v205, v142, v143
v_mfma_f32_16x16x32_bf16 a[12:15], a[236:239], v[208:211], a[12:15]
buffer_load_dwordx4 v1, s[44:47], s72 offen offset:3072 sc1 lds
v_mfma_f32_16x16x32_bf16 a[16:19], a[240:243], v[208:211], a[16:19]
v_exp_f32 v157, v157
v_mfma_f32_16x16x32_bf16 a[48:51], a[240:243], v[212:215], a[48:51]
v_exp_f32 v158, v158
v_mfma_f32_16x16x32_bf16 a[80:83], a[240:243], v[216:219], a[80:83]
ds_read_b128 a[220:223], v2 offset:7168
v_cvt_pk_bf16_f32 v206, v156, v157
v_mfma_f32_16x16x32_bf16 a[112:115], a[240:243], v[220:223], a[112:115]
v_exp_f32 v159, v159
v_mfma_f32_16x16x32_bf16 a[116:119], a[244:247], v[220:223], a[116:119]
v_cvt_pk_bf16_f32 v207, v158, v159
v_mfma_f32_16x16x32_bf16 a[84:87], a[244:247], v[216:219], a[84:87]
v_mfma_f32_16x16x32_bf16 a[52:55], a[244:247], v[212:215], a[52:55]
v_mfma_f32_16x16x32_bf16 a[20:23], a[244:247], v[208:211], a[20:23]
v_mfma_f32_16x16x32_bf16 a[24:27], a[248:251], v[208:211], a[24:27]
v_mfma_f32_16x16x32_bf16 a[56:59], a[248:251], v[212:215], a[56:59]
v_mfma_f32_16x16x32_bf16 a[88:91], a[248:251], v[216:219], a[88:91]
v_mfma_f32_16x16x32_bf16 a[120:123], a[248:251], v[220:223], a[120:123]
v_mfma_f32_16x16x32_bf16 a[124:127], a[252:255], v[220:223], a[124:127]
v_mfma_f32_16x16x32_bf16 a[92:95], a[252:255], v[216:219], a[92:95]
v_mfma_f32_16x16x32_bf16 a[60:63], a[252:255], v[212:215], a[60:63]
v_mfma_f32_16x16x32_bf16 a[28:31], a[252:255], v[208:211], a[28:31]
v_mfma_f32_16x16x32_bf16 v[224:227], v[120:123], v[208:211], v[224:227]
v_mfma_f32_16x16x32_bf16 v[228:231], v[120:123], v[212:215], v[228:231]
v_mfma_f32_16x16x32_bf16 v[232:235], v[120:123], v[216:219], v[232:235]
v_mfma_f32_16x16x32_bf16 v[236:239], v[120:123], v[220:223], v[236:239]
s_waitcnt lgkmcnt(8)
v_mfma_f32_16x16x32_bf16 v[128:131], a[128:131], v[16:19], v[80:83]
s_add_u32 s82, s82, 0x8000
ds_read_b128 a[160:163], v2 offset:24576
v_mfma_f32_16x16x32_bf16 v[132:135], a[128:131], v[32:35], v[84:87]
s_and_b32 s82, s82, 0x1ffff
v_exp_f32 v160, v160
v_mfma_f32_16x16x32_bf16 v[136:139], a[128:131], v[48:51], v[88:91]
s_add_u32 m0, s74, 0
v_exp_f32 v161, v161
v_mfma_f32_16x16x32_bf16 v[140:143], a[128:131], v[64:67], v[92:95]
s_add_u32 s72, s81, 0
ds_read_b128 a[176:179], v2 offset:28672
v_cvt_pk_bf16_f32 v208, v160, v161
v_mfma_f32_16x16x32_bf16 v[144:147], a[144:147], v[16:19], v[80:83]
v_exp_f32 v162, v162
v_mfma_f32_16x16x32_bf16 v[148:151], a[144:147], v[32:35], v[84:87]
v_exp_f32 v163, v163
v_mfma_f32_16x16x32_bf16 v[152:155], a[144:147], v[48:51], v[88:91]
ds_read_b128 a[164:167], v2 offset:25600
v_cvt_pk_bf16_f32 v209, v162, v163
v_mfma_f32_16x16x32_bf16 v[156:159], a[144:147], v[64:67], v[92:95]
v_exp_f32 v176, v176
v_mfma_f32_16x16x32_bf16 v[128:131], a[132:135], v[20:23], v[128:131]
buffer_load_dwordx4 v1, s[44:47], s72 offen sc1 lds
v_mfma_f32_16x16x32_bf16 v[132:135], a[132:135], v[36:39], v[132:135]
v_exp_f32 v177, v177
v_mfma_f32_16x16x32_bf16 v[136:139], a[132:135], v[52:55], v[136:139]
ds_read_b128 a[180:183], v2 offset:29696
v_cvt_pk_bf16_f32 v210, v176, v177
v_mfma_f32_16x16x32_bf16 v[140:143], a[132:135], v[68:71], v[140:143]
v_exp_f32 v178, v178
v_mfma_f32_16x16x32_bf16 v[156:159], a[148:151], v[68:71], v[156:159]
v_exp_f32 v179, v179
v_mfma_f32_16x16x32_bf16 v[152:155], a[148:151], v[52:55], v[152:155]
ds_read_b128 a[168:171], v2 offset:26624
v_cvt_pk_bf16_f32 v211, v178, v179
v_mfma_f32_16x16x32_bf16 v[148:151], a[148:151], v[36:39], v[148:151]
v_exp_f32 v164, v164
v_mfma_f32_16x16x32_bf16 v[144:147], a[148:151], v[20:23], v[144:147]
v_exp_f32 v165, v165
v_mfma_f32_16x16x32_bf16 v[140:143], a[136:139], v[72:75], v[140:143]
ds_read_b128 a[184:187], v2 offset:30720
v_cvt_pk_bf16_f32 v212, v164, v165
v_mfma_f32_16x16x32_bf16 v[136:139], a[136:139], v[56:59], v[136:139]
v_exp_f32 v166, v166
v_mfma_f32_16x16x32_bf16 v[132:135], a[136:139], v[40:43], v[132:135]
v_exp_f32 v167, v167
v_mfma_f32_16x16x32_bf16 v[128:131], a[136:139], v[24:27], v[128:131]
ds_read_b128 a[172:175], v2 offset:27648
v_cvt_pk_bf16_f32 v213, v166, v167
v_mfma_f32_16x16x32_bf16 v[144:147], a[152:155], v[24:27], v[144:147]
v_exp_f32 v180, v180
v_mfma_f32_16x16x32_bf16 v[148:151], a[152:155], v[40:43], v[148:151]
buffer_load_dwordx4 v1, s[44:47], s72 offen offset:1024 sc1 lds
v_mfma_f32_16x16x32_bf16 v[152:155], a[152:155], v[56:59], v[152:155]
v_exp_f32 v181, v181
v_mfma_f32_16x16x32_bf16 v[156:159], a[152:155], v[72:75], v[156:159]
ds_read_b128 a[188:191], v2 offset:31744
v_cvt_pk_bf16_f32 v214, v180, v181
v_mfma_f32_16x16x32_bf16 v[128:131], a[140:143], v[28:31], v[128:131]
v_exp_f32 v182, v182
v_mfma_f32_16x16x32_bf16 v[132:135], a[140:143], v[44:47], v[132:135]
v_exp_f32 v183, v183
v_mfma_f32_16x16x32_bf16 v[136:139], a[140:143], v[60:63], v[136:139]
ds_read_b128 a[224:227], v2 offset:8192
v_cvt_pk_bf16_f32 v215, v182, v183
v_mfma_f32_16x16x32_bf16 v[140:143], a[140:143], v[76:79], v[140:143]
v_exp_f32 v168, v168
v_mfma_f32_16x16x32_bf16 v[156:159], a[156:159], v[76:79], v[156:159]
v_exp_f32 v169, v169
v_mfma_f32_16x16x32_bf16 v[152:155], a[156:159], v[60:63], v[152:155]
ds_read_b128 a[228:231], v2 offset:9216
v_cvt_pk_bf16_f32 v216, v168, v169
v_mfma_f32_16x16x32_bf16 v[148:151], a[156:159], v[44:47], v[148:151]
v_exp_f32 v170, v170
v_mfma_f32_16x16x32_bf16 v[144:147], a[156:159], v[28:31], v[144:147]
s_waitcnt lgkmcnt(10)
v_exp_f32 v171, v171
v_mfma_f32_16x16x32_bf16 a[0:3], a[192:195], v[192:195], a[0:3]
ds_read_b128 a[232:235], v2 offset:10240
v_cvt_pk_bf16_f32 v217, v170, v171
v_mfma_f32_16x16x32_bf16 a[32:35], a[192:195], v[196:199], a[32:35]
v_exp_f32 v184, v184
v_mfma_f32_16x16x32_bf16 a[64:67], a[192:195], v[200:203], a[64:67]
buffer_load_dwordx4 v1, s[44:47], s72 offen offset:2048 sc1 lds
v_mfma_f32_16x16x32_bf16 a[96:99], a[192:195], v[204:207], a[96:99]
v_exp_f32 v185, v185
v_mfma_f32_16x16x32_bf16 a[100:103], a[196:199], v[204:207], a[100:103]
ds_read_b128 a[236:239], v2 offset:11264
v_cvt_pk_bf16_f32 v218, v184, v185
v_mfma_f32_16x16x32_bf16 a[68:71], a[196:199], v[200:203], a[68:71]
v_exp_f32 v186, v186
v_mfma_f32_16x16x32_bf16 a[36:39], a[196:199], v[196:199], a[36:39]
v_exp_f32 v187, v187
v_mfma_f32_16x16x32_bf16 a[4:7], a[196:199], v[192:195], a[4:7]
ds_read_b128 a[240:243], v2 offset:12288
v_cvt_pk_bf16_f32 v219, v186, v187
v_mfma_f32_16x16x32_bf16 a[8:11], a[200:203], v[192:195], a[8:11]
v_exp_f32 v172, v172
v_mfma_f32_16x16x32_bf16 a[40:43], a[200:203], v[196:199], a[40:43]
v_exp_f32 v173, v173
v_mfma_f32_16x16x32_bf16 a[72:75], a[200:203], v[200:203], a[72:75]
ds_read_b128 a[244:247], v2 offset:13312
v_cvt_pk_bf16_f32 v220, v172, v173
v_mfma_f32_16x16x32_bf16 a[104:107], a[200:203], v[204:207], a[104:107]
v_exp_f32 v174, v174
v_mfma_f32_16x16x32_bf16 a[108:111], a[204:207], v[204:207], a[108:111]
v_exp_f32 v175, v175
v_mfma_f32_16x16x32_bf16 a[76:79], a[204:207], v[200:203], a[76:79]
ds_read_b128 a[248:251], v2 offset:14336
v_cvt_pk_bf16_f32 v221, v174, v175
v_mfma_f32_16x16x32_bf16 a[44:47], a[204:207], v[196:199], a[44:47]
v_exp_f32 v188, v188
v_mfma_f32_16x16x32_bf16 a[12:15], a[204:207], v[192:195], a[12:15]
buffer_load_dwordx4 v1, s[44:47], s72 offen offset:3072 sc1 lds
v_mfma_f32_16x16x32_bf16 a[16:19], a[208:211], v[192:195], a[16:19]
v_exp_f32 v189, v189
v_mfma_f32_16x16x32_bf16 a[48:51], a[208:211], v[196:199], a[48:51]
ds_read_b128 a[252:255], v2 offset:15360
v_cvt_pk_bf16_f32 v222, v188, v189
v_mfma_f32_16x16x32_bf16 a[80:83], a[208:211], v[200:203], a[80:83]
v_exp_f32 v190, v190
v_mfma_f32_16x16x32_bf16 a[112:115], a[208:211], v[204:207], a[112:115]
v_exp_f32 v191, v191
v_mfma_f32_16x16x32_bf16 a[116:119], a[212:215], v[204:207], a[116:119]
v_cvt_pk_bf16_f32 v223, v190, v191
v_add_u32 v2, s82, v1
v_mfma_f32_16x16x32_bf16 a[84:87], a[212:215], v[200:203], a[84:87]
v_mfma_f32_16x16x32_bf16 a[52:55], a[212:215], v[196:199], a[52:55]
v_mfma_f32_16x16x32_bf16 a[20:23], a[212:215], v[192:195], a[20:23]
v_mfma_f32_16x16x32_bf16 a[24:27], a[216:219], v[192:195], a[24:27]
v_mfma_f32_16x16x32_bf16 a[56:59], a[216:219], v[196:199], a[56:59]
v_mfma_f32_16x16x32_bf16 a[88:91], a[216:219], v[200:203], a[88:91]
v_mfma_f32_16x16x32_bf16 a[120:123], a[216:219], v[204:207], a[120:123]
v_mfma_f32_16x16x32_bf16 a[124:127], a[220:223], v[204:207], a[124:127]
v_mfma_f32_16x16x32_bf16 a[92:95], a[220:223], v[200:203], a[92:95]
v_mfma_f32_16x16x32_bf16 a[60:63], a[220:223], v[196:199], a[60:63]
v_mfma_f32_16x16x32_bf16 a[28:31], a[220:223], v[192:195], a[28:31]
v_mfma_f32_16x16x32_bf16 v[224:227], v[120:123], v[192:195], v[224:227]
v_mfma_f32_16x16x32_bf16 v[228:231], v[120:123], v[196:199], v[228:231]
s_waitcnt vmcnt(8) lgkmcnt(8)
v_mfma_f32_16x16x32_bf16 v[232:235], v[120:123], v[200:203], v[232:235]
s_barrier
v_mfma_f32_16x16x32_bf16 v[236:239], v[120:123], v[204:207], v[236:239]
s_add_u32 s83, s83, 1
s_cbranch_scc0 LloopI
LLT1:
v_mfma_f32_16x16x32_bf16 v[160:163], a[160:163], v[16:19], v[80:83]
s_xor_b32 s74, s82, 0x10000
v_exp_f32 v128, v128
v_mfma_f32_16x16x32_bf16 v[164:167], a[160:163], v[32:35], v[84:87]
s_add_u32 s74, s74, s64
ds_read_b128 a[128:131], v2 offset:16384
v_mfma_f32_16x16x32_bf16 v[168:171], a[160:163], v[48:51], v[88:91]
s_add_u32 s81, s81, 0x8000
v_exp_f32 v129, v129
v_mfma_f32_16x16x32_bf16 v[172:175], a[160:163], v[64:67], v[92:95]
s_add_u32 m0, s74, 16384
v_exp_f32 v130, v130
v_mfma_f32_16x16x32_bf16 v[176:179], a[176:179], v[16:19], v[80:83]
s_add_u32 s72, s81, 16384
ds_read_b128 a[144:147], v2 offset:20480
v_cvt_pk_bf16_f32 v192, v128, v129
v_mfma_f32_16x16x32_bf16 v[180:183], a[176:179], v[32:35], v[84:87]
v_exp_f32 v131, v131
v_mfma_f32_16x16x32_bf16 v[184:187], a[176:179], v[48:51], v[88:91]
v_exp_f32 v144, v144
v_mfma_f32_16x16x32_bf16 v[188:191], a[176:179], v[64:67], v[92:95]
ds_read_b128 a[132:135], v2 offset:17408
v_cvt_pk_bf16_f32 v193, v130, v131
v_mfma_f32_16x16x32_bf16 v[160:163], a[164:167], v[20:23], v[160:163]
buffer_load_dwordx4 v1, s[44:47], s72 offen sc1 lds
v_mfma_f32_16x16x32_bf16 v[164:167], a[164:167], v[36:39], v[164:167]
v_exp_f32 v145, v145
v_mfma_f32_16x16x32_bf16 v[168:171], a[164:167], v[52:55], v[168:171]
v_exp_f32 v146, v146
v_mfma_f32_16x16x32_bf16 v[172:175], a[164:167], v[68:71], v[172:175]
ds_read_b128 a[148:151], v2 offset:21504
v_cvt_pk_bf16_f32 v194, v144, v145
v_mfma_f32_16x16x32_bf16 v[188:191], a[180:183], v[68:71], v[188:191]
v_exp_f32 v147, v147
v_mfma_f32_16x16x32_bf16 v[184:187], a[180:183], v[52:55], v[184:187]
v_exp_f32 v132, v132
v_mfma_f32_16x16x32_bf16 v[180:183], a[180:183], v[36:39], v[180:183]
ds_read_b128 a[136:139], v2 offset:18432
v_cvt_pk_bf16_f32 v195, v146, v147
v_mfma_f32_16x16x32_bf16 v[176:179], a[180:183], v[20:23], v[176:179]
v_exp_f32 v133, v133
v_mfma_f32_16x16x32_bf16 v[172:175], a[168:171], v[72:75], v[172:175]
v_exp_f32 v134, v134
v_mfma_f32_16x16x32_bf16 v[168:171], a[168:171], v[56:59], v[168:171]
ds_read_b128 a[152:155], v2 offset:22528
v_cvt_pk_bf16_f32 v196, v132, v133
v_mfma_f32_16x16x32_bf16 v[164:167], a[168:171], v[40:43], v[164:167]
v_exp_f32 v135, v135
v_mfma_f32_16x16x32_bf16 v[160:163], a[168:171], v[24:27], v[160:163]
v_exp_f32 v148, v148
v_mfma_f32_16x16x32_bf16 v[176:179], a[184:187], v[24:27], v[176:179]
ds_read_b128 a[140:143], v2 offset:19456
v_cvt_pk_bf16_f32 v197, v134, v135
v_mfma_f32_16x16x32_bf16 v[180:183], a[184:187], v[40:43], v[180:183]
buffer_load_dwordx4 v1, s[44:47], s72 offen offset:1024 sc1 lds
v_mfma_f32_16x16x32_bf16 v[184:187], a[184:187], v[56:59], v[184:187]
v_exp_f32 v149, v149
v_mfma_f32_16x16x32_bf16 v[188:191], a[184:187], v[72:75], v[188:191]
v_exp_f32 v150, v150
v_mfma_f32_16x16x32_bf16 v[160:163], a[172:175], v[28:31], v[160:163]
ds_read_b128 a[156:159], v2 offset:23552
v_cvt_pk_bf16_f32 v198, v148, v149
v_mfma_f32_16x16x32_bf16 v[164:167], a[172:175], v[44:47], v[164:167]
v_exp_f32 v151, v151
v_mfma_f32_16x16x32_bf16 v[168:171], a[172:175], v[60:63], v[168:171]
v_exp_f32 v136, v136
v_mfma_f32_16x16x32_bf16 v[172:175], a[172:175], v[76:79], v[172:175]
ds_read_b128 a[192:195], v2 offset:0
v_cvt_pk_bf16_f32 v199, v150, v151
v_mfma_f32_16x16x32_bf16 v[188:191], a[188:191], v[76:79], v[188:191]
v_exp_f32 v137, v137
v_mfma_f32_16x16x32_bf16 v[184:187], a[188:191], v[60:63], v[184:187]
v_exp_f32 v138, v138
v_mfma_f32_16x16x32_bf16 v[180:183], a[188:191], v[44:47], v[180:183]
ds_read_b128 a[196:199], v2 offset:1024
v_cvt_pk_bf16_f32 v200, v136, v137
v_mfma_f32_16x16x32_bf16 v[176:179], a[188:191], v[28:31], v[176:179]
s_waitcnt lgkmcnt(10)
v_exp_f32 v139, v139
v_mfma_f32_16x16x32_bf16 a[0:3], a[224:227], v[208:211], a[0:3]
v_exp_f32 v152, v152
v_mfma_f32_16x16x32_bf16 a[32:35], a[224:227], v[212:215], a[32:35]
ds_read_b128 a[200:203], v2 offset:2048
v_cvt_pk_bf16_f32 v201, v138, v139
v_mfma_f32_16x16x32_bf16 a[64:67], a[224:227], v[216:219], a[64:67]
buffer_load_dwordx4 v1, s[44:47], s72 offen offset:2048 sc1 lds
v_mfma_f32_16x16x32_bf16 a[96:99], a[224:227], v[220:223], a[96:99]
v_exp_f32 v153, v153
v_mfma_f32_16x16x32_bf16 a[100:103], a[228:231], v[220:223], a[100:103]
v_exp_f32 v154, v154
v_mfma_f32_16x16x32_bf16 a[68:71], a[228:231], v[216:219], a[68:71]
ds_read_b128 a[204:207], v2 offset:3072
v_cvt_pk_bf16_f32 v202, v152, v153
v_mfma_f32_16x16x32_bf16 a[36:39], a[228:231], v[212:215], a[36:39]
v_exp_f32 v155, v155
v_mfma_f32_16x16x32_bf16 a[4:7], a[228:231], v[208:211], a[4:7]
v_exp_f32 v140, v140
v_mfma_f32_16x16x32_bf16 a[8:11], a[232:235], v[208:211], a[8:11]
ds_read_b128 a[208:211], v2 offset:4096
v_cvt_pk_bf16_f32 v203, v154, v155
v_mfma_f32_16x16x32_bf16 a[40:43], a[232:235], v[212:215], a[40:43]
v_exp_f32 v141, v141
v_mfma_f32_16x16x32_bf16 a[72:75], a[232:235], v[216:219], a[72:75]
v_exp_f32 v142, v142
v_mfma_f32_16x16x32_bf16 a[104:107], a[232:235], v[220:223], a[104:107]
ds_read_b128 a[212:215], v2 offset:5120
v_cvt_pk_bf16_f32 v204, v140, v141
v_mfma_f32_16x16x32_bf16 a[108:111], a[236:239], v[220:223], a[108:111]
v_exp_f32 v143, v143
v_mfma_f32_16x16x32_bf16 a[76:79], a[236:239], v[216:219], a[76:79]
v_exp_f32 v156, v156
v_mfma_f32_16x16x32_bf16 a[44:47], a[236:239], v[212:215], a[44:47]
ds_read_b128 a[216:219], v2 offset:6144
v_cvt_pk_bf16_f32 v205, v142, v143
v_mfma_f32_16x16x32_bf16 a[12:15], a[236:239], v[208:211], a[12:15]
buffer_load_dwordx4 v1, s[44:47], s72 offen offset:3072 sc1 lds
v_mfma_f32_16x16x32_bf16 a[16:19], a[240:243], v[208:211], a[16:19]
v_exp_f32 v157, v157
v_mfma_f32_16x16x32_bf16 a[48:51], a[240:243], v[212:215], a[48:51]
v_exp_f32 v158, v158
v_mfma_f32_16x16x32_bf16 a[80:83], a[240:243], v[216:219], a[80:83]
ds_read_b128 a[220:223], v2 offset:7168
v_cvt_pk_bf16_f32 v206, v156, v157
v_mfma_f32_16x16x32_bf16 a[112:115], a[240:243], v[220:223], a[112:115]
v_exp_f32 v159, v159
v_mfma_f32_16x16x32_bf16 a[116:119], a[244:247], v[220:223], a[116:119]
v_cvt_pk_bf16_f32 v207, v158, v159
v_mfma_f32_16x16x32_bf16 a[84:87], a[244:247], v[216:219], a[84:87]
v_mfma_f32_16x16x32_bf16 a[52:55], a[244:247], v[212:215], a[52:55]
v_mfma_f32_16x16x32_bf16 a[20:23], a[244:247], v[208:211], a[20:23]
v_mfma_f32_16x16x32_bf16 a[24:27], a[248:251], v[208:211], a[24:27]
v_mfma_f32_16x16x32_bf16 a[56:59], a[248:251], v[212:215], a[56:59]
v_mfma_f32_16x16x32_bf16 a[88:91], a[248:251], v[216:219], a[88:91]
v_mfma_f32_16x16x32_bf16 a[120:123], a[248:251], v[220:223], a[120:123]
v_mfma_f32_16x16x32_bf16 a[124:127], a[252:255], v[220:223], a[124:127]
v_mfma_f32_16x16x32_bf16 a[92:95], a[252:255], v[216:219], a[92:95]
v_mfma_f32_16x16x32_bf16 a[60:63], a[252:255], v[212:215], a[60:63]
v_mfma_f32_16x16x32_bf16 a[28:31], a[252:255], v[208:211], a[28:31]
v_mfma_f32_16x16x32_bf16 v[224:227], v[120:123], v[208:211], v[224:227]
v_mfma_f32_16x16x32_bf16 v[228:231], v[120:123], v[212:215], v[228:231]
v_mfma_f32_16x16x32_bf16 v[232:235], v[120:123], v[216:219], v[232:235]
v_mfma_f32_16x16x32_bf16 v[236:239], v[120:123], v[220:223], v[236:239]
s_waitcnt lgkmcnt(8)
s_cmp_le_u32 s58, 0
s_cbranch_scc1 Lalt15
v_mfma_f32_16x16x32_bf16 v[128:131], a[128:131], v[16:19], v[80:83]
s_add_u32 s82, s82, 0x8000
ds_read_b128 a[160:163], v2 offset:24576
v_mfma_f32_16x16x32_bf16 v[132:135], a[128:131], v[32:35], v[84:87]
s_and_b32 s82, s82, 0x1ffff
v_exp_f32 v160, v160
v_mfma_f32_16x16x32_bf16 v[144:147], a[144:147], v[16:19], v[80:83]
s_add_u32 m0, s74, 0
v_exp_f32 v161, v161
v_mfma_f32_16x16x32_bf16 v[148:151], a[144:147], v[32:35], v[84:87]
s_add_u32 s72, s81, 0
ds_read_b128 a[176:179], v2 offset:28672
v_cvt_pk_bf16_f32 v208, v160, v161
Ljoin17:
v_mfma_f32_16x16x32_bf16 v[136:139], a[128:131], v[48:51], v[88:91]
v_exp_f32 v162, v162
v_mfma_f32_16x16x32_bf16 v[140:143], a[128:131], v[64:67], v[92:95]
v_exp_f32 v163, v163
v_mfma_f32_16x16x32_bf16 v[152:155], a[144:147], v[48:51], v[88:91]
ds_read_b128 a[164:167], v2 offset:25600
v_cvt_pk_bf16_f32 v209, v162, v163
v_mfma_f32_16x16x32_bf16 v[156:159], a[144:147], v[64:67], v[92:95]
v_exp_f32 v176, v176
v_mfma_f32_16x16x32_bf16 v[128:131], a[132:135], v[20:23], v[128:131]
buffer_load_dwordx4 v1, s[44:47], s72 offen sc1 lds
v_mfma_f32_16x16x32_bf16 v[132:135], a[132:135], v[36:39], v[132:135]
v_exp_f32 v177, v177
v_mfma_f32_16x16x32_bf16 v[136:139], a[132:135], v[52:55], v[136:139]
ds_read_b128 a[180:183], v2 offset:29696
v_cvt_pk_bf16_f32 v210, v176, v177
v_mfma_f32_16x16x32_bf16 v[140:143], a[132:135], v[68:71], v[140:143]
v_exp_f32 v178, v178
v_mfma_f32_16x16x32_bf16 v[156:159], a[148:151], v[68:71], v[156:159]
v_exp_f32 v179, v179
v_mfma_f32_16x16x32_bf16 v[152:155], a[148:151], v[52:55], v[152:155]
ds_read_b128 a[168:171], v2 offset:26624
v_cvt_pk_bf16_f32 v211, v178, v179
v_mfma_f32_16x16x32_bf16 v[148:151], a[148:151], v[36:39], v[148:151]
v_exp_f32 v164, v164
v_mfma_f32_16x16x32_bf16 v[144:147], a[148:151], v[20:23], v[144:147]
v_exp_f32 v165, v165
v_mfma_f32_16x16x32_bf16 v[140:143], a[136:139], v[72:75], v[140:143]
ds_read_b128 a[184:187], v2 offset:30720
v_cvt_pk_bf16_f32 v212, v164, v165
v_mfma_f32_16x16x32_bf16 v[136:139], a[136:139], v[56:59], v[136:139]
v_exp_f32 v166, v166
v_mfma_f32_16x16x32_bf16 v[132:135], a[136:139], v[40:43], v[132:135]
v_exp_f32 v167, v167
v_mfma_f32_16x16x32_bf16 v[128:131], a[136:139], v[24:27], v[128:131]
ds_read_b128 a[172:175], v2 offset:27648
v_cvt_pk_bf16_f32 v213, v166, v167
v_mfma_f32_16x16x32_bf16 v[144:147], a[152:155], v[24:27], v[144:147]
v_exp_f32 v180, v180
v_mfma_f32_16x16x32_bf16 v[148:151], a[152:155], v[40:43], v[148:151]
buffer_load_dwordx4 v1, s[44:47], s72 offen offset:1024 sc1 lds
v_mfma_f32_16x16x32_bf16 v[152:155], a[152:155], v[56:59], v[152:155]
v_exp_f32 v181, v181
v_mfma_f32_16x16x32_bf16 v[156:159], a[152:155], v[72:75], v[156:159]
ds_read_b128 a[188:191], v2 offset:31744
v_cvt_pk_bf16_f32 v214, v180, v181
v_mfma_f32_16x16x32_bf16 v[128:131], a[140:143], v[28:31], v[128:131]
v_exp_f32 v182, v182
v_mfma_f32_16x16x32_bf16 v[132:135], a[140:143], v[44:47], v[132:135]
v_exp_f32 v183, v183
v_mfma_f32_16x16x32_bf16 v[136:139], a[140:143], v[60:63], v[136:139]
ds_read_b128 a[224:227], v2 offset:8192
v_cvt_pk_bf16_f32 v215, v182, v183
v_mfma_f32_16x16x32_bf16 v[140:143], a[140:143], v[76:79], v[140:143]
v_exp_f32 v168, v168
v_mfma_f32_16x16x32_bf16 v[156:159], a[156:159], v[76:79], v[156:159]
v_exp_f32 v169, v169
v_mfma_f32_16x16x32_bf16 v[152:155], a[156:159], v[60:63], v[152:155]
ds_read_b128 a[228:231], v2 offset:9216
v_cvt_pk_bf16_f32 v216, v168, v169
v_mfma_f32_16x16x32_bf16 v[148:151], a[156:159], v[44:47], v[148:151]
v_exp_f32 v170, v170
v_mfma_f32_16x16x32_bf16 v[144:147], a[156:159], v[28:31], v[144:147]
s_waitcnt lgkmcnt(10)
v_exp_f32 v171, v171
v_mfma_f32_16x16x32_bf16 a[0:3], a[192:195], v[192:195], a[0:3]
ds_read_b128 a[232:235], v2 offset:10240
v_cvt_pk_bf16_f32 v217, v170, v171
v_mfma_f32_16x16x32_bf16 a[32:35], a[192:195], v[196:199], a[32:35]
v_exp_f32 v184, v184
v_mfma_f32_16x16x32_bf16 a[64:67], a[192:195], v[200:203], a[64:67]
buffer_load_dwordx4 v1, s[44:47], s72 offen offset:2048 sc1 lds
v_mfma_f32_16x16x32_bf16 a[96:99], a[192:195], v[204:207], a[96:99]
v_exp_f32 v185, v185
v_mfma_f32_16x16x32_bf16 a[100:103], a[196:199], v[204:207], a[100:103]
ds_read_b128 a[236:239], v2 offset:11264
v_cvt_pk_bf16_f32 v218, v184, v185
v_mfma_f32_16x16x32_bf16 a[68:71], a[196:199], v[200:203], a[68:71]
v_exp_f32 v186, v186
v_mfma_f32_16x16x32_bf16 a[36:39], a[196:199], v[196:199], a[36:39]
v_exp_f32 v187, v187
v_mfma_f32_16x16x32_bf16 a[4:7], a[196:199], v[192:195], a[4:7]
ds_read_b128 a[240:243], v2 offset:12288
v_cvt_pk_bf16_f32 v219, v186, v187
v_mfma_f32_16x16x32_bf16 a[8:11], a[200:203], v[192:195], a[8:11]
v_exp_f32 v172, v172
v_mfma_f32_16x16x32_bf16 a[40:43], a[200:203], v[196:199], a[40:43]
v_exp_f32 v173, v173
v_mfma_f32_16x16x32_bf16 a[72:75], a[200:203], v[200:203], a[72:75]
ds_read_b128 a[244:247], v2 offset:13312
v_cvt_pk_bf16_f32 v220, v172, v173
v_mfma_f32_16x16x32_bf16 a[104:107], a[200:203], v[204:207], a[104:107]
v_exp_f32 v174, v174
v_mfma_f32_16x16x32_bf16 a[108:111], a[204:207], v[204:207], a[108:111]
v_exp_f32 v175, v175
v_mfma_f32_16x16x32_bf16 a[76:79], a[204:207], v[200:203], a[76:79]
ds_read_b128 a[248:251], v2 offset:14336
v_cvt_pk_bf16_f32 v221, v174, v175
v_mfma_f32_16x16x32_bf16 a[44:47], a[204:207], v[196:199], a[44:47]
v_exp_f32 v188, v188
v_mfma_f32_16x16x32_bf16 a[12:15], a[204:207], v[192:195], a[12:15]
buffer_load_dwordx4 v1, s[44:47], s72 offen offset:3072 sc1 lds
v_mfma_f32_16x16x32_bf16 a[16:19], a[208:211], v[192:195], a[16:19]
v_exp_f32 v189, v189
v_mfma_f32_16x16x32_bf16 a[48:51], a[208:211], v[196:199], a[48:51]
ds_read_b128 a[252:255], v2 offset:15360
v_cvt_pk_bf16_f32 v222, v188, v189
v_mfma_f32_16x16x32_bf16 a[80:83], a[208:211], v[200:203], a[80:83]
v_exp_f32 v190, v190
v_mfma_f32_16x16x32_bf16 a[112:115], a[208:211], v[204:207], a[112:115]
v_exp_f32 v191, v191
v_mfma_f32_16x16x32_bf16 a[116:119], a[212:215], v[204:207], a[116:119]
v_cvt_pk_bf16_f32 v223, v190, v191
v_add_u32 v2, s82, v1
v_mfma_f32_16x16x32_bf16 a[84:87], a[212:215], v[200:203], a[84:87]
v_mfma_f32_16x16x32_bf16 a[52:55], a[212:215], v[196:199], a[52:55]
v_mfma_f32_16x16x32_bf16 a[20:23], a[212:215], v[192:195], a[20:23]
v_mfma_f32_16x16x32_bf16 a[24:27], a[216:219], v[192:195], a[24:27]
v_mfma_f32_16x16x32_bf16 a[56:59], a[216:219], v[196:199], a[56:59]
v_mfma_f32_16x16x32_bf16 a[88:91], a[216:219], v[200:203], a[88:91]
v_mfma_f32_16x16x32_bf16 a[120:123], a[216:219], v[204:207], a[120:123]
v_mfma_f32_16x16x32_bf16 a[124:127], a[220:223], v[204:207], a[124:127]
v_mfma_f32_16x16x32_bf16 a[92:95], a[220:223], v[200:203], a[92:95]
v_mfma_f32_16x16x32_bf16 a[60:63], a[220:223], v[196:199], a[60:63]
v_mfma_f32_16x16x32_bf16 a[28:31], a[220:223], v[192:195], a[28:31]
v_mfma_f32_16x16x32_bf16 v[224:227], v[120:123], v[192:195], v[224:227]
v_mfma_f32_16x16x32_bf16 v[228:231], v[120:123], v[196:199], v[228:231]
v_mfma_f32_16x16x32_bf16 v[232:235], v[120:123], v[200:203], v[232:235]
s_waitcnt vmcnt(8) lgkmcnt(8)
v_mfma_f32_16x16x32_bf16 v[236:239], v[120:123], v[204:207], v[236:239]
s_barrier
s_cmp_le_u32 s58, 1
s_cbranch_scc1 Lalt18
v_mfma_f32_16x16x32_bf16 v[160:163], a[160:163], v[16:19], v[80:83]
s_xor_b32 s74, s82, 0x10000
v_exp_f32 v128, v128
v_mfma_f32_16x16x32_bf16 v[164:167], a[160:163], v[32:35], v[84:87]
s_add_u32 s74, s74, s64
ds_read_b128 a[128:131], v2 offset:16384
v_mfma_f32_16x16x32_bf16 v[176:179], a[176:179], v[16:19], v[80:83]
s_add_u32 s81, s81, 0x8000
v_exp_f32 v129, v129
v_mfma_f32_16x16x32_bf16 v[180:183], a[176:179], v[32:35], v[84:87]
s_add_u32 m0, s74, 16384
v_exp_f32 v130, v130
Ljoin20:
v_mfma_f32_16x16x32_bf16 v[168:171], a[160:163], v[48:51], v[88:91]
s_add_u32 s72, s81, 16384
ds_read_b128 a[144:147], v2 offset:20480
v_cvt_pk_bf16_f32 v192, v128, v129
v_mfma_f32_16x16x32_bf16 v[172:175], a[160:163], v[64:67], v[92:95]
v_exp_f32 v131, v131
v_mfma_f32_16x16x32_bf16 v[184:187], a[176:179], v[48:51], v[88:91]
v_exp_f32 v144, v144
v_mfma_f32_16x16x32_bf16 v[188:191], a[176:179], v[64:67], v[92:95]
ds_read_b128 a[132:135], v2 offset:17408
v_cvt_pk_bf16_f32 v193, v130, v131
v_mfma_f32_16x16x32_bf16 v[160:163], a[164:167], v[20:23], v[160:163]
buffer_load_dwordx4 v1, s[44:47], s72 offen sc1 lds
v_mfma_f32_16x16x32_bf16 v[164:167], a[164:167], v[36:39], v[164:167]
v_exp_f32 v145, v145
v_mfma_f32_16x16x32_bf16 v[168:171], a[164:167], v[52:55], v[168:171]
v_exp_f32 v146, v146
v_mfma_f32_16x16x32_bf16 v[172:175], a[164:167], v[68:71], v[172:175]
ds_read_b128 a[148:151], v2 offset:21504
v_cvt_pk_bf16_f32 v194, v144, v145
v_mfma_f32_16x16x32_bf16 v[188:191], a[180:183], v[68:71], v[188:191]
v_exp_f32 v147, v147
v_mfma_f32_16x16x32_bf16 v[184:187], a[180:183], v[52:55], v[184:187]
v_exp_f32 v132, v132
v_mfma_f32_16x16x32_bf16 v[180:183], a[180:183], v[36:39], v[180:183]
ds_read_b128 a[136:139], v2 offset:18432
v_cvt_pk_bf16_f32 v195, v146, v147
v_mfma_f32_16x16x32_bf16 v[176:179], a[180:183], v[20:23], v[176:179]
v_exp_f32 v133, v133
v_mfma_f32_16x16x32_bf16 v[172:175], a[168:171], v[72:75], v[172:175]
v_exp_f32 v134, v134
v_mfma_f32_16x16x32_bf16 v[168:171], a[168:171], v[56:59], v[168:171]
ds_read_b128 a[152:155], v2 offset:22528
v_cvt_pk_bf16_f32 v196, v132, v133
v_mfma_f32_16x16x32_bf16 v[164:167], a[168:171], v[40:43], v[164:167]
v_exp_f32 v135, v135
v_mfma_f32_16x16x32_bf16 v[160:163], a[168:171], v[24:27], v[160:163]
v_exp_f32 v148, v148
v_mfma_f32_16x16x32_bf16 v[176:179], a[184:187], v[24:27], v[176:179]
ds_read_b128 a[140:143], v2 offset:19456
v_cvt_pk_bf16_f32 v197, v134, v135
v_mfma_f32_16x16x32_bf16 v[180:183], a[184:187], v[40:43], v[180:183]
buffer_load_dwordx4 v1, s[44:47], s72 offen offset:1024 sc1 lds
v_mfma_f32_16x16x32_bf16 v[184:187], a[184:187], v[56:59], v[184:187]
v_exp_f32 v149, v149
v_mfma_f32_16x16x32_bf16 v[188:191], a[184:187], v[72:75], v[188:191]
v_exp_f32 v150, v150
v_mfma_f32_16x16x32_bf16 v[160:163], a[172:175], v[28:31], v[160:163]
ds_read_b128 a[156:159], v2 offset:23552
v_cvt_pk_bf16_f32 v198, v148, v149
v_mfma_f32_16x16x32_bf16 v[164:167], a[172:175], v[44:47], v[164:167]
v_exp_f32 v151, v151
v_mfma_f32_16x16x32_bf16 v[168:171], a[172:175], v[60:63], v[168:171]
v_exp_f32 v136, v136
v_mfma_f32_16x16x32_bf16 v[172:175], a[172:175], v[76:79], v[172:175]
ds_read_b128 a[192:195], v2 offset:0
v_cvt_pk_bf16_f32 v199, v150, v151
v_mfma_f32_16x16x32_bf16 v[188:191], a[188:191], v[76:79], v[188:191]
v_exp_f32 v137, v137
v_mfma_f32_16x16x32_bf16 v[184:187], a[188:191], v[60:63], v[184:187]
v_exp_f32 v138, v138
v_mfma_f32_16x16x32_bf16 v[180:183], a[188:191], v[44:47], v[180:183]
ds_read_b128 a[196:199], v2 offset:1024
v_cvt_pk_bf16_f32 v200, v136, v137
v_mfma_f32_16x16x32_bf16 v[176:179], a[188:191], v[28:31], v[176:179]
s_waitcnt lgkmcnt(10)
v_exp_f32 v139, v139
v_mfma_f32_16x16x32_bf16 a[0:3], a[224:227], v[208:211], a[0:3]
v_exp_f32 v152, v152
v_mfma_f32_16x16x32_bf16 a[32:35], a[224:227], v[212:215], a[32:35]
ds_read_b128 a[200:203], v2 offset:2048
v_cvt_pk_bf16_f32 v201, v138, v139
v_mfma_f32_16x16x32_bf16 a[64:67], a[224:227], v[216:219], a[64:67]
buffer_load_dwordx4 v1, s[44:47], s72 offen offset:2048 sc1 lds
v_mfma_f32_16x16x32_bf16 a[96:99], a[224:227], v[220:223], a[96:99]
v_exp_f32 v153, v153
v_mfma_f32_16x16x32_bf16 a[100:103], a[228:231], v[220:223], a[100:103]
v_exp_f32 v154, v154
v_mfma_f32_16x16x32_bf16 a[68:71], a[228:231], v[216:219], a[68:71]
ds_read_b128 a[204:207], v2 offset:3072
v_cvt_pk_bf16_f32 v202, v152, v153
v_mfma_f32_16x16x32_bf16 a[36:39], a[228:231], v[212:215], a[36:39]
v_exp_f32 v155, v155
v_mfma_f32_16x16x32_bf16 a[4:7], a[228:231], v[208:211], a[4:7]
v_exp_f32 v140, v140
v_mfma_f32_16x16x32_bf16 a[8:11], a[232:235], v[208:211], a[8:11]
ds_read_b128 a[208:211], v2 offset:4096
v_cvt_pk_bf16_f32 v203, v154, v155
v_mfma_f32_16x16x32_bf16 a[40:43], a[232:235], v[212:215], a[40:43]
v_exp_f32 v141, v141
v_mfma_f32_16x16x32_bf16 a[72:75], a[232:235], v[216:219], a[72:75]
v_exp_f32 v142, v142
v_mfma_f32_16x16x32_bf16 a[104:107], a[232:235], v[220:223], a[104:107]
ds_read_b128 a[212:215], v2 offset:5120
v_cvt_pk_bf16_f32 v204, v140, v141
v_mfma_f32_16x16x32_bf16 a[108:111], a[236:239], v[220:223], a[108:111]
v_exp_f32 v143, v143
v_mfma_f32_16x16x32_bf16 a[76:79], a[236:239], v[216:219], a[76:79]
v_exp_f32 v156, v156
v_mfma_f32_16x16x32_bf16 a[44:47], a[236:239], v[212:215], a[44:47]
ds_read_b128 a[216:219], v2 offset:6144
v_cvt_pk_bf16_f32 v205, v142, v143
v_mfma_f32_16x16x32_bf16 a[12:15], a[236:239], v[208:211], a[12:15]
buffer_load_dwordx4 v1, s[44:47], s72 offen offset:3072 sc1 lds
v_mfma_f32_16x16x32_bf16 a[16:19], a[240:243], v[208:211], a[16:19]
v_exp_f32 v157, v157
v_mfma_f32_16x16x32_bf16 a[48:51], a[240:243], v[212:215], a[48:51]
v_exp_f32 v158, v158
v_mfma_f32_16x16x32_bf16 a[80:83], a[240:243], v[216:219], a[80:83]
ds_read_b128 a[220:223], v2 offset:7168
v_cvt_pk_bf16_f32 v206, v156, v157
v_mfma_f32_16x16x32_bf16 a[112:115], a[240:243], v[220:223], a[112:115]
v_exp_f32 v159, v159
v_mfma_f32_16x16x32_bf16 a[116:119], a[244:247], v[220:223], a[116:119]
v_cvt_pk_bf16_f32 v207, v158, v159
v_mfma_f32_16x16x32_bf16 a[84:87], a[244:247], v[216:219], a[84:87]
v_mfma_f32_16x16x32_bf16 a[52:55], a[244:247], v[212:215], a[52:55]
v_mfma_f32_16x16x32_bf16 a[20:23], a[244:247], v[208:211], a[20:23]
v_mfma_f32_16x16x32_bf16 a[24:27], a[248:251], v[208:211], a[24:27]
v_mfma_f32_16x16x32_bf16 a[56:59], a[248:251], v[212:215], a[56:59]
v_mfma_f32_16x16x32_bf16 a[88:91], a[248:251], v[216:219], a[88:91]
v_mfma_f32_16x16x32_bf16 a[120:123], a[248:251], v[220:223], a[120:123]
v_mfma_f32_16x16x32_bf16 a[124:127], a[252:255], v[220:223], a[124:127]
v_mfma_f32_16x16x32_bf16 a[92:95], a[252:255], v[216:219], a[92:95]
v_mfma_f32_16x16x32_bf16 a[60:63], a[252:255], v[212:215], a[60:63]
v_mfma_f32_16x16x32_bf16 a[28:31], a[252:255], v[208:211], a[28:31]
v_mfma_f32_16x16x32_bf16 v[224:227], v[120:123], v[208:211], v[224:227]
v_mfma_f32_16x16x32_bf16 v[228:231], v[120:123], v[212:215], v[228:231]
v_mfma_f32_16x16x32_bf16 v[232:235], v[120:123], v[216:219], v[232:235]
v_mfma_f32_16x16x32_bf16 v[236:239], v[120:123], v[220:223], v[236:239]
s_waitcnt lgkmcnt(8)
s_cmp_le_u32 s58, 2
s_cbranch_scc1 Lalt21
v_mfma_f32_16x16x32_bf16 v[128:131], a[128:131], v[16:19], v[80:83]
s_add_u32 s82, s82, 0x8000
ds_read_b128 a[160:163], v2 offset:24576
v_mfma_f32_16x16x32_bf16 v[132:135], a[128:131], v[32:35], v[84:87]
s_and_b32 s82, s82, 0x1ffff
v_exp_f32 v160, v160
v_mfma_f32_16x16x32_bf16 v[144:147], a[144:147], v[16:19], v[80:83]
s_add_u32 m0, s74, 0
v_exp_f32 v161, v161
v_mfma_f32_16x16x32_bf16 v[148:151], a[144:147], v[32:35], v[84:87]
s_add_u32 s72, s81, 0
ds_read_b128 a[176:179], v2 offset:28672
v_cvt_pk_bf16_f32 v208, v160, v161
Ljoin23:
v_mfma_f32_16x16x32_bf16 v[136:139], a[128:131], v[48:51], v[88:91]
v_exp_f32 v162, v162
v_mfma_f32_16x16x32_bf16 v[140:143], a[128:131], v[64:67], v[92:95]
v_exp_f32 v163, v163
v_mfma_f32_16x16x32_bf16 v[152:155], a[144:147], v[48:51], v[88:91]
ds_read_b128 a[164:167], v2 offset:25600
v_cvt_pk_bf16_f32 v209, v162, v163
v_mfma_f32_16x16x32_bf16 v[156:159], a[144:147], v[64:67], v[92:95]
v_exp_f32 v176, v176
v_mfma_f32_16x16x32_bf16 v[128:131], a[132:135], v[20:23], v[128:131]
buffer_load_dwordx4 v1, s[44:47], s72 offen sc1 lds
v_mfma_f32_16x16x32_bf16 v[132:135], a[132:135], v[36:39], v[132:135]
v_exp_f32 v177, v177
v_mfma_f32_16x16x32_bf16 v[136:139], a[132:135], v[52:55], v[136:139]
ds_read_b128 a[180:183], v2 offset:29696
v_cvt_pk_bf16_f32 v210, v176, v177
v_mfma_f32_16x16x32_bf16 v[140:143], a[132:135], v[68:71], v[140:143]
v_exp_f32 v178, v178
v_mfma_f32_16x16x32_bf16 v[156:159], a[148:151], v[68:71], v[156:159]
v_exp_f32 v179, v179
v_mfma_f32_16x16x32_bf16 v[152:155], a[148:151], v[52:55], v[152:155]
ds_read_b128 a[168:171], v2 offset:26624
v_cvt_pk_bf16_f32 v211, v178, v179
v_mfma_f32_16x16x32_bf16 v[148:151], a[148:151], v[36:39], v[148:151]
v_exp_f32 v164, v164
v_mfma_f32_16x16x32_bf16 v[144:147], a[148:151], v[20:23], v[144:147]
v_exp_f32 v165, v165
v_mfma_f32_16x16x32_bf16 v[140:143], a[136:139], v[72:75], v[140:143]
ds_read_b128 a[184:187], v2 offset:30720
v_cvt_pk_bf16_f32 v212, v164, v165
v_mfma_f32_16x16x32_bf16 v[136:139], a[136:139], v[56:59], v[136:139]
v_exp_f32 v166, v166
v_mfma_f32_16x16x32_bf16 v[132:135], a[136:139], v[40:43], v[132:135]
v_exp_f32 v167, v167
v_mfma_f32_16x16x32_bf16 v[128:131], a[136:139], v[24:27], v[128:131]
ds_read_b128 a[172:175], v2 offset:27648
v_cvt_pk_bf16_f32 v213, v166, v167
v_mfma_f32_16x16x32_bf16 v[144:147], a[152:155], v[24:27], v[144:147]
v_exp_f32 v180, v180
v_mfma_f32_16x16x32_bf16 v[148:151], a[152:155], v[40:43], v[148:151]
buffer_load_dwordx4 v1, s[44:47], s72 offen offset:1024 sc1 lds
v_mfma_f32_16x16x32_bf16 v[152:155], a[152:155], v[56:59], v[152:155]
v_exp_f32 v181, v181
v_mfma_f32_16x16x32_bf16 v[156:159], a[152:155], v[72:75], v[156:159]
ds_read_b128 a[188:191], v2 offset:31744
v_cvt_pk_bf16_f32 v214, v180, v181
v_mfma_f32_16x16x32_bf16 v[128:131], a[140:143], v[28:31], v[128:131]
v_exp_f32 v182, v182
v_mfma_f32_16x16x32_bf16 v[132:135], a[140:143], v[44:47], v[132:135]
v_exp_f32 v183, v183
v_mfma_f32_16x16x32_bf16 v[136:139], a[140:143], v[60:63], v[136:139]
ds_read_b128 a[224:227], v2 offset:8192
v_cvt_pk_bf16_f32 v215, v182, v183
v_mfma_f32_16x16x32_bf16 v[140:143], a[140:143], v[76:79], v[140:143]
v_exp_f32 v168, v168
v_mfma_f32_16x16x32_bf16 v[156:159], a[156:159], v[76:79], v[156:159]
v_exp_f32 v169, v169
v_mfma_f32_16x16x32_bf16 v[152:155], a[156:159], v[60:63], v[152:155]
ds_read_b128 a[228:231], v2 offset:9216
v_cvt_pk_bf16_f32 v216, v168, v169
v_mfma_f32_16x16x32_bf16 v[148:151], a[156:159], v[44:47], v[148:151]
v_exp_f32 v170, v170
v_mfma_f32_16x16x32_bf16 v[144:147], a[156:159], v[28:31], v[144:147]
s_waitcnt lgkmcnt(10)
v_exp_f32 v171, v171
v_mfma_f32_16x16x32_bf16 a[0:3], a[192:195], v[192:195], a[0:3]
ds_read_b128 a[232:235], v2 offset:10240
v_cvt_pk_bf16_f32 v217, v170, v171
v_mfma_f32_16x16x32_bf16 a[32:35], a[192:195], v[196:199], a[32:35]
v_exp_f32 v184, v184
v_mfma_f32_16x16x32_bf16 a[64:67], a[192:195], v[200:203], a[64:67]
buffer_load_dwordx4 v1, s[44:47], s72 offen offset:2048 sc1 lds
v_mfma_f32_16x16x32_bf16 a[96:99], a[192:195], v[204:207], a[96:99]
v_exp_f32 v185, v185
v_mfma_f32_16x16x32_bf16 a[100:103], a[196:199], v[204:207], a[100:103]
ds_read_b128 a[236:239], v2 offset:11264
v_cvt_pk_bf16_f32 v218, v184, v185
v_mfma_f32_16x16x32_bf16 a[68:71], a[196:199], v[200:203], a[68:71]
v_exp_f32 v186, v186
v_mfma_f32_16x16x32_bf16 a[36:39], a[196:199], v[196:199], a[36:39]
v_exp_f32 v187, v187
v_mfma_f32_16x16x32_bf16 a[4:7], a[196:199], v[192:195], a[4:7]
ds_read_b128 a[240:243], v2 offset:12288
v_cvt_pk_bf16_f32 v219, v186, v187
v_mfma_f32_16x16x32_bf16 a[8:11], a[200:203], v[192:195], a[8:11]
v_exp_f32 v172, v172
v_mfma_f32_16x16x32_bf16 a[40:43], a[200:203], v[196:199], a[40:43]
v_exp_f32 v173, v173
v_mfma_f32_16x16x32_bf16 a[72:75], a[200:203], v[200:203], a[72:75]
ds_read_b128 a[244:247], v2 offset:13312
v_cvt_pk_bf16_f32 v220, v172, v173
v_mfma_f32_16x16x32_bf16 a[104:107], a[200:203], v[204:207], a[104:107]
v_exp_f32 v174, v174
v_mfma_f32_16x16x32_bf16 a[108:111], a[204:207], v[204:207], a[108:111]
v_exp_f32 v175, v175
v_mfma_f32_16x16x32_bf16 a[76:79], a[204:207], v[200:203], a[76:79]
ds_read_b128 a[248:251], v2 offset:14336
v_cvt_pk_bf16_f32 v221, v174, v175
v_mfma_f32_16x16x32_bf16 a[44:47], a[204:207], v[196:199], a[44:47]
v_exp_f32 v188, v188
v_mfma_f32_16x16x32_bf16 a[12:15], a[204:207], v[192:195], a[12:15]
buffer_load_dwordx4 v1, s[44:47], s72 offen offset:3072 sc1 lds
v_mfma_f32_16x16x32_bf16 a[16:19], a[208:211], v[192:195], a[16:19]
v_exp_f32 v189, v189
v_mfma_f32_16x16x32_bf16 a[48:51], a[208:211], v[196:199], a[48:51]
ds_read_b128 a[252:255], v2 offset:15360
v_cvt_pk_bf16_f32 v222, v188, v189
v_mfma_f32_16x16x32_bf16 a[80:83], a[208:211], v[200:203], a[80:83]
v_exp_f32 v190, v190
v_mfma_f32_16x16x32_bf16 a[112:115], a[208:211], v[204:207], a[112:115]
v_exp_f32 v191, v191
v_mfma_f32_16x16x32_bf16 a[116:119], a[212:215], v[204:207], a[116:119]
v_cvt_pk_bf16_f32 v223, v190, v191
v_add_u32 v2, s82, v1
v_mfma_f32_16x16x32_bf16 a[84:87], a[212:215], v[200:203], a[84:87]
v_mfma_f32_16x16x32_bf16 a[52:55], a[212:215], v[196:199], a[52:55]
v_mfma_f32_16x16x32_bf16 a[20:23], a[212:215], v[192:195], a[20:23]
v_mfma_f32_16x16x32_bf16 a[24:27], a[216:219], v[192:195], a[24:27]
v_mfma_f32_16x16x32_bf16 a[56:59], a[216:219], v[196:199], a[56:59]
v_mfma_f32_16x16x32_bf16 a[88:91], a[216:219], v[200:203], a[88:91]
v_mfma_f32_16x16x32_bf16 a[120:123], a[216:219], v[204:207], a[120:123]
v_mfma_f32_16x16x32_bf16 a[124:127], a[220:223], v[204:207], a[124:127]
v_mfma_f32_16x16x32_bf16 a[92:95], a[220:223], v[200:203], a[92:95]
v_mfma_f32_16x16x32_bf16 a[60:63], a[220:223], v[196:199], a[60:63]
v_mfma_f32_16x16x32_bf16 a[28:31], a[220:223], v[192:195], a[28:31]
v_mfma_f32_16x16x32_bf16 v[224:227], v[120:123], v[192:195], v[224:227]
v_mfma_f32_16x16x32_bf16 v[228:231], v[120:123], v[196:199], v[228:231]
v_mfma_f32_16x16x32_bf16 v[232:235], v[120:123], v[200:203], v[232:235]
s_waitcnt vmcnt(8) lgkmcnt(8)
v_mfma_f32_16x16x32_bf16 v[236:239], v[120:123], v[204:207], v[236:239]
s_barrier
LLT3:
s_cmp_le_u32 s58, 3
s_cbranch_scc1 Lalt24
v_mfma_f32_16x16x32_bf16 v[160:163], a[160:163], v[16:19], v[80:83]
s_lshl_b32 s73, s93, 1
v_exp_f32 v128, v128
v_mfma_f32_16x16x32_bf16 v[164:167], a[160:163], v[32:35], v[84:87]
s_add_u32 s73, s73, 0x1000
ds_read_b128 a[128:131], v2 offset:16384
v_mfma_f32_16x16x32_bf16 v[176:179], a[176:179], v[16:19], v[80:83]
v_exp_f32 v129, v129
v_mfma_f32_16x16x32_bf16 v[180:183], a[176:179], v[32:35], v[84:87]
v_exp_f32 v130, v130
Ljoin26:
v_mfma_f32_16x16x32_bf16 v[168:171], a[160:163], v[48:51], v[88:91]
ds_read_b128 a[144:147], v2 offset:20480
v_cvt_pk_bf16_f32 v192, v128, v129
v_mfma_f32_16x16x32_bf16 v[172:175], a[160:163], v[64:67], v[92:95]
v_exp_f32 v131, v131
v_mfma_f32_16x16x32_bf16 v[184:187], a[176:179], v[48:51], v[88:91]
buffer_load_dword v4, v3, s[24:27], s73 offen
v_mfma_f32_16x16x32_bf16 v[188:191], a[176:179], v[64:67], v[92:95]
v_exp_f32 v144, v144
v_mfma_f32_16x16x32_bf16 v[160:163], a[164:167], v[20:23], v[160:163]
ds_read_b128 a[132:135], v2 offset:17408
v_cvt_pk_bf16_f32 v193, v130, v131
v_mfma_f32_16x16x32_bf16 v[164:167], a[164:167], v[36:39], v[164:167]
v_exp_f32 v145, v145
v_mfma_f32_16x16x32_bf16 v[168:171], a[164:167], v[52:55], v[168:171]
v_exp_f32 v146, v146
v_mfma_f32_16x16x32_bf16 v[172:175], a[164:167], v[68:71], v[172:175]
ds_read_b128 a[148:151], v2 offset:21504
v_cvt_pk_bf16_f32 v194, v144, v145
v_mfma_f32_16x16x32_bf16 v[188:191], a[180:183], v[68:71], v[188:191]
v_exp_f32 v147, v147
v_mfma_f32_16x16x32_bf16 v[184:187], a[180:183], v[52:55], v[184:187]
v_exp_f32 v132, v132
v_mfma_f32_16x16x32_bf16 v[180:183], a[180:183], v[36:39], v[180:183]
ds_read_b128 a[136:139], v2 offset:18432
v_cvt_pk_bf16_f32 v195, v146, v147
v_mfma_f32_16x16x32_bf16 v[176:179], a[180:183], v[20:23], v[176:179]
buffer_load_dword v4, v3, s[36:39], s93 offen
v_mfma_f32_16x16x32_bf16 v[172:175], a[168:171], v[72:75], v[172:175]
s_xor_b32 s74, s82, 0x10000
v_exp_f32 v133, v133
v_mfma_f32_16x16x32_bf16 v[168:171], a[168:171], v[56:59], v[168:171]
s_add_u32 s74, s74, s64
v_exp_f32 v134, v134
v_mfma_f32_16x16x32_bf16 v[164:167], a[168:171], v[40:43], v[164:167]
s_add_u32 s81, s81, 0x8000
ds_read_b128 a[152:155], v2 offset:22528
v_cvt_pk_bf16_f32 v196, v132, v133
v_mfma_f32_16x16x32_bf16 v[160:163], a[168:171], v[24:27], v[160:163]
s_add_u32 m0, s74, 16384
v_exp_f32 v135, v135
v_mfma_f32_16x16x32_bf16 v[176:179], a[184:187], v[24:27], v[176:179]
s_add_u32 s72, s81, 16384
v_exp_f32 v148, v148
v_mfma_f32_16x16x32_bf16 v[180:183], a[184:187], v[40:43], v[180:183]
ds_read_b128 a[140:143], v2 offset:19456
v_cvt_pk_bf16_f32 v197, v134, v135
v_mfma_f32_16x16x32_bf16 v[184:187], a[184:187], v[56:59], v[184:187]
v_exp_f32 v149, v149
v_mfma_f32_16x16x32_bf16 v[188:191], a[184:187], v[72:75], v[188:191]
buffer_load_dwordx4 v1, s[44:47], s72 offen sc1 lds
v_mfma_f32_16x16x32_bf16 v[160:163], a[172:175], v[28:31], v[160:163]
v_exp_f32 v150, v150
v_mfma_f32_16x16x32_bf16 v[164:167], a[172:175], v[44:47], v[164:167]
ds_read_b128 a[156:159], v2 offset:23552
v_cvt_pk_bf16_f32 v198, v148, v149
v_mfma_f32_16x16x32_bf16 v[168:171], a[172:175], v[60:63], v[168:171]
v_exp_f32 v151, v151
v_mfma_f32_16x16x32_bf16 v[172:175], a[172:175], v[76:79], v[172:175]
v_exp_f32 v136, v136
v_mfma_f32_16x16x32_bf16 v[188:191], a[188:191], v[76:79], v[188:191]
ds_read_b128 a[192:195], v2 offset:0
v_cvt_pk_bf16_f32 v199, v150, v151
v_mfma_f32_16x16x32_bf16 v[184:187], a[188:191], v[60:63], v[184:187]
v_exp_f32 v137, v137
v_mfma_f32_16x16x32_bf16 v[180:183], a[188:191], v[44:47], v[180:183]
v_exp_f32 v138, v138
v_mfma_f32_16x16x32_bf16 v[176:179], a[188:191], v[28:31], v[176:179]
s_waitcnt lgkmcnt(9)
ds_read_b128 a[196:199], v2 offset:1024
v_cvt_pk_bf16_f32 v200, v136, v137
v_mfma_f32_16x16x32_bf16 a[0:3], a[224:227], v[208:211], a[0:3]
v_exp_f32 v139, v139
v_mfma_f32_16x16x32_bf16 a[32:35], a[224:227], v[212:215], a[32:35]
buffer_load_dwordx4 v1, s[44:47], s72 offen offset:1024 sc1 lds
v_mfma_f32_16x16x32_bf16 a[64:67], a[224:227], v[216:219], a[64:67]
v_exp_f32 v152, v152
v_mfma_f32_16x16x32_bf16 a[96:99], a[224:227], v[220:223], a[96:99]
ds_read_b128 a[200:203], v2 offset:2048
v_cvt_pk_bf16_f32 v201, v138, v139
v_mfma_f32_16x16x32_bf16 a[100:103], a[228:231], v[220:223], a[100:103]
v_exp_f32 v153, v153
v_mfma_f32_16x16x32_bf16 a[68:71], a[228:231], v[216:219], a[68:71]
v_exp_f32 v154, v154
v_mfma_f32_16x16x32_bf16 a[36:39], a[228:231], v[212:215], a[36:39]
ds_read_b128 a[204:207], v2 offset:3072
v_cvt_pk_bf16_f32 v202, v152, v153
v_mfma_f32_16x16x32_bf16 a[4:7], a[228:231], v[208:211], a[4:7]
v_exp_f32 v155, v155
v_mfma_f32_16x16x32_bf16 a[8:11], a[232:235], v[208:211], a[8:11]
v_exp_f32 v140, v140
v_mfma_f32_16x16x32_bf16 a[40:43], a[232:235], v[212:215], a[40:43]
ds_read_b128 a[208:211], v2 offset:4096
v_cvt_pk_bf16_f32 v203, v154, v155
v_mfma_f32_16x16x32_bf16 a[72:75], a[232:235], v[216:219], a[72:75]
buffer_load_dwordx4 v1, s[44:47], s72 offen offset:2048 sc1 lds
v_mfma_f32_16x16x32_bf16 a[104:107], a[232:235], v[220:223], a[104:107]
v_exp_f32 v141, v141
v_mfma_f32_16x16x32_bf16 a[108:111], a[236:239], v[220:223], a[108:111]
v_exp_f32 v142, v142
v_mfma_f32_16x16x32_bf16 a[76:79], a[236:239], v[216:219], a[76:79]
ds_read_b128 a[212:215], v2 offset:5120
v_cvt_pk_bf16_f32 v204, v140, v141
v_mfma_f32_16x16x32_bf16 a[44:47], a[236:239], v[212:215], a[44:47]
v_exp_f32 v143, v143
v_mfma_f32_16x16x32_bf16 a[12:15], a[236:239], v[208:211], a[12:15]
v_exp_f32 v156, v156
v_mfma_f32_16x16x32_bf16 a[16:19], a[240:243], v[208:211], a[16:19]
ds_read_b128 a[216:219], v2 offset:6144
v_cvt_pk_bf16_f32 v205, v142, v143
v_mfma_f32_16x16x32_bf16 a[48:51], a[240:243], v[212:215], a[48:51]
v_exp_f32 v157, v157
v_mfma_f32_16x16x32_bf16 a[80:83], a[240:243], v[216:219], a[80:83]
buffer_load_dwordx4 v1, s[44:47], s72 offen offset:3072 sc1 lds
v_mfma_f32_16x16x32_bf16 a[112:115], a[240:243], v[220:223], a[112:115]
v_exp_f32 v158, v158
v_mfma_f32_16x16x32_bf16 a[116:119], a[244:247], v[220:223], a[116:119]
ds_read_b128 a[220:223], v2 offset:7168
v_cvt_pk_bf16_f32 v206, v156, v157
v_mfma_f32_16x16x32_bf16 a[84:87], a[244:247], v[216:219], a[84:87]
v_exp_f32 v159, v159
v_mfma_f32_16x16x32_bf16 a[52:55], a[244:247], v[212:215], a[52:55]
v_cvt_pk_bf16_f32 v207, v158, v159
v_mfma_f32_16x16x32_bf16 a[20:23], a[244:247], v[208:211], a[20:23]
v_mfma_f32_16x16x32_bf16 a[24:27], a[248:251], v[208:211], a[24:27]
v_mfma_f32_16x16x32_bf16 a[56:59], a[248:251], v[212:215], a[56:59]
v_mfma_f32_16x16x32_bf16 a[88:91], a[248:251], v[216:219], a[88:91]
v_mfma_f32_16x16x32_bf16 a[120:123], a[248:251], v[220:223], a[120:123]
v_mfma_f32_16x16x32_bf16 a[124:127], a[252:255], v[220:223], a[124:127]
v_mfma_f32_16x16x32_bf16 a[92:95], a[252:255], v[216:219], a[92:95]
v_mfma_f32_16x16x32_bf16 a[60:63], a[252:255], v[212:215], a[60:63]
v_mfma_f32_16x16x32_bf16 a[28:31], a[252:255], v[208:211], a[28:31]
v_mfma_f32_16x16x32_bf16 v[224:227], v[120:123], v[208:211], v[224:227]
v_mfma_f32_16x16x32_bf16 v[228:231], v[120:123], v[212:215], v[228:231]
v_mfma_f32_16x16x32_bf16 v[232:235], v[120:123], v[216:219], v[232:235]
v_mfma_f32_16x16x32_bf16 v[236:239], v[120:123], v[220:223], v[236:239]
s_waitcnt lgkmcnt(8)
s_cmp_le_u32 s85, 0
s_cbranch_scc1 Lalt27
v_mfma_f32_16x16x32_bf16 v[136:139], a[128:131], v[48:51], v[88:91]
s_add_u32 s82, s82, 0x8000
ds_read_b128 a[160:163], v2 offset:24576
ds_read_b128 a[176:179], v2 offset:28672
v_mfma_f32_16x16x32_bf16 v[140:143], a[128:131], v[64:67], v[92:95]
s_and_b32 s82, s82, 0x1ffff
v_exp_f32 v160, v160
v_mfma_f32_16x16x32_bf16 v[152:155], a[144:147], v[48:51], v[88:91]
s_add_u32 m0, s74, 0
v_exp_f32 v161, v161
v_mfma_f32_16x16x32_bf16 v[156:159], a[144:147], v[64:67], v[92:95]
s_add_u32 s72, s81, 0
v_exp_f32 v162, v162
Ljoin29:
v_mfma_f32_16x16x32_bf16 v[136:139], a[132:135], v[52:55], v[136:139]
v_exp_f32 v163, v163
v_mfma_f32_16x16x32_bf16 v[140:143], a[132:135], v[68:71], v[140:143]
ds_read_b128 a[164:167], v2 offset:25600
v_cvt_pk_bf16_f32 v208, v160, v161
v_mfma_f32_16x16x32_bf16 v[156:159], a[148:151], v[68:71], v[156:159]
v_exp_f32 v176, v176
v_mfma_f32_16x16x32_bf16 v[152:155], a[148:151], v[52:55], v[152:155]
buffer_load_dwordx4 v1, s[44:47], s72 offen sc1 lds
v_mfma_f32_16x16x32_bf16 v[140:143], a[136:139], v[72:75], v[140:143]
v_exp_f32 v177, v177
v_mfma_f32_16x16x32_bf16 v[136:139], a[136:139], v[56:59], v[136:139]
ds_read_b128 a[180:183], v2 offset:29696
v_cvt_pk_bf16_f32 v209, v162, v163
v_mfma_f32_16x16x32_bf16 v[152:155], a[152:155], v[56:59], v[152:155]
v_exp_f32 v178, v178
v_mfma_f32_16x16x32_bf16 v[156:159], a[152:155], v[72:75], v[156:159]
v_exp_f32 v179, v179
v_mfma_f32_16x16x32_bf16 v[136:139], a[140:143], v[60:63], v[136:139]
ds_read_b128 a[168:171], v2 offset:26624
v_cvt_pk_bf16_f32 v210, v176, v177
v_mfma_f32_16x16x32_bf16 v[140:143], a[140:143], v[76:79], v[140:143]
v_exp_f32 v164, v164
v_mfma_f32_16x16x32_bf16 v[156:159], a[156:159], v[76:79], v[156:159]
v_exp_f32 v165, v165
v_mfma_f32_16x16x32_bf16 v[152:155], a[156:159], v[60:63], v[152:155]
s_waitcnt lgkmcnt(5)
ds_read_b128 a[184:187], v2 offset:30720
v_cvt_pk_bf16_f32 v211, v178, v179
v_mfma_f32_16x16x32_bf16 a[0:3], a[192:195], v[192:195], a[0:3]
v_exp_f32 v166, v166
v_mfma_f32_16x16x32_bf16 a[32:35], a[192:195], v[196:199], a[32:35]
v_exp_f32 v167, v167
v_mfma_f32_16x16x32_bf16 a[64:67], a[192:195], v[200:203], a[64:67]
ds_read_b128 a[172:175], v2 offset:27648
v_cvt_pk_bf16_f32 v212, v164, v165
v_mfma_f32_16x16x32_bf16 a[96:99], a[192:195], v[204:207], a[96:99]
v_exp_f32 v180, v180
v_mfma_f32_16x16x32_bf16 a[100:103], a[196:199], v[204:207], a[100:103]
buffer_load_dwordx4 v1, s[44:47], s72 offen offset:1024 sc1 lds
v_mfma_f32_16x16x32_bf16 a[68:71], a[196:199], v[200:203], a[68:71]
v_exp_f32 v181, v181
v_mfma_f32_16x16x32_bf16 a[36:39], a[196:199], v[196:199], a[36:39]
ds_read_b128 a[188:191], v2 offset:31744
v_cvt_pk_bf16_f32 v213, v166, v167
v_mfma_f32_16x16x32_bf16 a[4:7], a[196:199], v[192:195], a[4:7]
v_exp_f32 v182, v182
v_mfma_f32_16x16x32_bf16 a[8:11], a[200:203], v[192:195], a[8:11]
v_exp_f32 v183, v183
v_mfma_f32_16x16x32_bf16 a[40:43], a[200:203], v[196:199], a[40:43]
ds_read_b128 a[224:227], v2 offset:8192
v_cvt_pk_bf16_f32 v214, v180, v181
v_mfma_f32_16x16x32_bf16 a[72:75], a[200:203], v[200:203], a[72:75]
v_exp_f32 v168, v168
v_mfma_f32_16x16x32_bf16 a[104:107], a[200:203], v[204:207], a[104:107]
v_exp_f32 v169, v169
v_mfma_f32_16x16x32_bf16 a[108:111], a[204:207], v[204:207], a[108:111]
ds_read_b128 a[228:231], v2 offset:9216
v_cvt_pk_bf16_f32 v215, v182, v183
v_mfma_f32_16x16x32_bf16 a[76:79], a[204:207], v[200:203], a[76:79]
v_exp_f32 v170, v170
v_mfma_f32_16x16x32_bf16 a[44:47], a[204:207], v[196:199], a[44:47]
v_exp_f32 v171, v171
v_mfma_f32_16x16x32_bf16 a[12:15], a[204:207], v[192:195], a[12:15]
ds_read_b128 a[232:235], v2 offset:10240
v_cvt_pk_bf16_f32 v216, v168, v169
v_mfma_f32_16x16x32_bf16 a[16:19], a[208:211], v[192:195], a[16:19]
v_exp_f32 v184, v184
v_mfma_f32_16x16x32_bf16 a[48:51], a[208:211], v[196:199], a[48:51]
buffer_load_dwordx4 v1, s[44:47], s72 offen offset:2048 sc1 lds
v_mfma_f32_16x16x32_bf16 a[80:83], a[208:211], v[200:203], a[80:83]
v_exp_f32 v185, v185
v_mfma_f32_16x16x32_bf16 a[112:115], a[208:211], v[204:207], a[112:115]
ds_read_b128 a[236:239], v2 offset:11264
v_cvt_pk_bf16_f32 v217, v170, v171
v_mfma_f32_16x16x32_bf16 a[116:119], a[212:215], v[204:207], a[116:119]
v_exp_f32 v186, v186
v_mfma_f32_16x16x32_bf16 a[84:87], a[212:215], v[200:203], a[84:87]
v_exp_f32 v187, v187
v_mfma_f32_16x16x32_bf16 a[52:55], a[212:215], v[196:199], a[52:55]
ds_read_b128 a[240:243], v2 offset:12288
v_cvt_pk_bf16_f32 v218, v184, v185
v_mfma_f32_16x16x32_bf16 a[20:23], a[212:215], v[192:195], a[20:23]
v_exp_f32 v172, v172
v_mfma_f32_16x16x32_bf16 a[24:27], a[216:219], v[192:195], a[24:27]
v_exp_f32 v173, v173
v_mfma_f32_16x16x32_bf16 a[56:59], a[216:219], v[196:199], a[56:59]
ds_read_b128 a[244:247], v2 offset:13312
v_cvt_pk_bf16_f32 v219, v186, v187
v_mfma_f32_16x16x32_bf16 a[88:91], a[216:219], v[200:203], a[88:91]
v_exp_f32 v174, v174
v_mfma_f32_16x16x32_bf16 a[120:123], a[216:219], v[204:207], a[120:123]
v_exp_f32 v175, v175
v_mfma_f32_16x16x32_bf16 a[124:127], a[220:223], v[204:207], a[124:127]
ds_read_b128 a[248:251], v2 offset:14336
v_cvt_pk_bf16_f32 v220, v172, v173
v_mfma_f32_16x16x32_bf16 a[92:95], a[220:223], v[200:203], a[92:95]
v_exp_f32 v188, v188
v_mfma_f32_16x16x32_bf16 a[60:63], a[220:223], v[196:199], a[60:63]
buffer_load_dwordx4 v1, s[44:47], s72 offen offset:3072 sc1 lds
v_mfma_f32_16x16x32_bf16 a[28:31], a[220:223], v[192:195], a[28:31]
v_exp_f32 v189, v189
v_mfma_f32_16x16x32_bf16 v[224:227], v[120:123], v[192:195], v[224:227]
ds_read_b128 a[252:255], v2 offset:15360
v_cvt_pk_bf16_f32 v221, v174, v175
v_mfma_f32_16x16x32_bf16 v[228:231], v[120:123], v[196:199], v[228:231]
v_exp_f32 v190, v190
v_mfma_f32_16x16x32_bf16 v[232:235], v[120:123], v[200:203], v[232:235]
s_waitcnt vmcnt(10) lgkmcnt(8)
v_exp_f32 v191, v191
v_mfma_f32_16x16x32_bf16 v[236:239], v[120:123], v[204:207], v[236:239]
s_barrier
v_cvt_pk_bf16_f32 v222, v188, v189
v_cvt_pk_bf16_f32 v223, v190, v191
v_add_u32 v2, s82, v1
s_cmp_le_u32 s85, 1
s_cbranch_scc1 Lalt30
v_mfma_f32_16x16x32_bf16 v[168:171], a[160:163], v[48:51], v[88:91]
s_xor_b32 s74, s82, 0x10000
v_exp_f32 v136, v136
v_mfma_f32_16x16x32_bf16 v[172:175], a[160:163], v[64:67], v[92:95]
s_add_u32 s74, s74, s64
ds_read_b128 a[128:131], v2 offset:16384
v_mfma_f32_16x16x32_bf16 v[184:187], a[176:179], v[48:51], v[88:91]
s_add_u32 s81, s81, 0x8000
v_exp_f32 v137, v137
v_mfma_f32_16x16x32_bf16 v[188:191], a[176:179], v[64:67], v[92:95]
s_add_u32 m0, s74, 16384
ds_read_b128 a[144:147], v2 offset:20480
v_cvt_pk_bf16_f32 v200, v136, v137
Ljoin32:
v_mfma_f32_16x16x32_bf16 v[168:171], a[164:167], v[52:55], v[168:171]
s_add_u32 s72, s81, 16384
v_exp_f32 v138, v138
v_mfma_f32_16x16x32_bf16 v[172:175], a[164:167], v[68:71], v[172:175]
ds_read_b128 a[132:135], v2 offset:17408
v_mfma_f32_16x16x32_bf16 v[188:191], a[180:183], v[68:71], v[188:191]
buffer_load_dwordx4 v1, s[44:47], s72 offen sc1 lds
v_mfma_f32_16x16x32_bf16 v[184:187], a[180:183], v[52:55], v[184:187]
v_exp_f32 v139, v139
v_mfma_f32_16x16x32_bf16 v[172:175], a[168:171], v[72:75], v[172:175]
ds_read_b128 a[148:151], v2 offset:21504
v_cvt_pk_bf16_f32 v201, v138, v139
v_mfma_f32_16x16x32_bf16 v[168:171], a[168:171], v[56:59], v[168:171]
v_exp_f32 v152, v152
v_mfma_f32_16x16x32_bf16 v[184:187], a[184:187], v[56:59], v[184:187]
ds_read_b128 a[136:139], v2 offset:18432
v_mfma_f32_16x16x32_bf16 v[188:191], a[184:187], v[72:75], v[188:191]
v_exp_f32 v153, v153
v_mfma_f32_16x16x32_bf16 v[168:171], a[172:175], v[60:63], v[168:171]
ds_read_b128 a[152:155], v2 offset:22528
v_cvt_pk_bf16_f32 v202, v152, v153
v_mfma_f32_16x16x32_bf16 v[172:175], a[172:175], v[76:79], v[172:175]
v_exp_f32 v154, v154
v_mfma_f32_16x16x32_bf16 v[188:191], a[188:191], v[76:79], v[188:191]
ds_read_b128 a[140:143], v2 offset:19456
v_mfma_f32_16x16x32_bf16 v[184:187], a[188:191], v[60:63], v[184:187]
s_waitcnt lgkmcnt(7)
buffer_load_dwordx4 v1, s[44:47], s72 offen offset:1024 sc1 lds
v_mfma_f32_16x16x32_bf16 a[0:3], a[224:227], v[208:211], a[0:3]
v_exp_f32 v155, v155
v_mfma_f32_16x16x32_bf16 a[32:35], a[224:227], v[212:215], a[32:35]
ds_read_b128 a[156:159], v2 offset:23552
v_cvt_pk_bf16_f32 v203, v154, v155
v_mfma_f32_16x16x32_bf16 a[64:67], a[224:227], v[216:219], a[64:67]
v_exp_f32 v140, v140
v_mfma_f32_16x16x32_bf16 a[96:99], a[224:227], v[220:223], a[96:99]
ds_read_b128 a[192:195], v2 offset:0
v_mfma_f32_16x16x32_bf16 a[100:103], a[228:231], v[220:223], a[100:103]
v_exp_f32 v141, v141
v_mfma_f32_16x16x32_bf16 a[68:71], a[228:231], v[216:219], a[68:71]
ds_read_b128 a[196:199], v2 offset:1024
v_cvt_pk_bf16_f32 v204, v140, v141
v_mfma_f32_16x16x32_bf16 a[36:39], a[228:231], v[212:215], a[36:39]
v_exp_f32 v142, v142
v_mfma_f32_16x16x32_bf16 a[4:7], a[228:231], v[208:211], a[4:7]
ds_read_b128 a[200:203], v2 offset:2048
v_mfma_f32_16x16x32_bf16 a[8:11], a[232:235], v[208:211], a[8:11]
buffer_load_dwordx4 v1, s[44:47], s72 offen offset:2048 sc1 lds
v_mfma_f32_16x16x32_bf16 a[40:43], a[232:235], v[212:215], a[40:43]
v_exp_f32 v143, v143
v_mfma_f32_16x16x32_bf16 a[72:75], a[232:235], v[216:219], a[72:75]
ds_read_b128 a[204:207], v2 offset:3072
v_cvt_pk_bf16_f32 v205, v142, v143
v_mfma_f32_16x16x32_bf16 a[104:107], a[232:235], v[220:223], a[104:107]
v_exp_f32 v156, v156
v_mfma_f32_16x16x32_bf16 a[108:111], a[236:239], v[220:223], a[108:111]
ds_read_b128 a[208:211], v2 offset:4096
v_mfma_f32_16x16x32_bf16 a[76:79], a[236:239], v[216:219], a[76:79]
v_exp_f32 v157, v157
v_mfma_f32_16x16x32_bf16 a[44:47], a[236:239], v[212:215], a[44:47]
ds_read_b128 a[212:215], v2 offset:5120
v_cvt_pk_bf16_f32 v206, v156, v157
v_mfma_f32_16x16x32_bf16 a[12:15], a[236:239], v[208:211], a[12:15]
v_exp_f32 v158, v158
v_mfma_f32_16x16x32_bf16 a[16:19], a[240:243], v[208:211], a[16:19]
ds_read_b128 a[216:219], v2 offset:6144
v_mfma_f32_16x16x32_bf16 a[48:51], a[240:243], v[212:215], a[48:51]
buffer_load_dwordx4 v1, s[44:47], s72 offen offset:3072 sc1 lds
v_mfma_f32_16x16x32_bf16 a[80:83], a[240:243], v[216:219], a[80:83]
v_exp_f32 v159, v159
v_mfma_f32_16x16x32_bf16 a[112:115], a[240:243], v[220:223], a[112:115]
ds_read_b128 a[220:223], v2 offset:7168
v_cvt_pk_bf16_f32 v207, v158, v159
v_mfma_f32_16x16x32_bf16 a[116:119], a[244:247], v[220:223], a[116:119]
v_mfma_f32_16x16x32_bf16 a[84:87], a[244:247], v[216:219], a[84:87]
v_mfma_f32_16x16x32_bf16 a[52:55], a[244:247], v[212:215], a[52:55]
v_mfma_f32_16x16x32_bf16 a[20:23], a[244:247], v[208:211], a[20:23]
v_mfma_f32_16x16x32_bf16 a[24:27], a[248:251], v[208:211], a[24:27]
v_mfma_f32_16x16x32_bf16 a[56:59], a[248:251], v[212:215], a[56:59]
v_mfma_f32_16x16x32_bf16 a[88:91], a[248:251], v[216:219], a[88:91]
v_mfma_f32_16x16x32_bf16 a[120:123], a[248:251], v[220:223], a[120:123]
v_mfma_f32_16x16x32_bf16 a[124:127], a[252:255], v[220:223], a[124:127]
v_mfma_f32_16x16x32_bf16 a[92:95], a[252:255], v[216:219], a[92:95]
v_mfma_f32_16x16x32_bf16 a[60:63], a[252:255], v[212:215], a[60:63]
v_mfma_f32_16x16x32_bf16 a[28:31], a[252:255], v[208:211], a[28:31]
v_mfma_f32_16x16x32_bf16 v[224:227], v[120:123], v[208:211], v[224:227]
v_mfma_f32_16x16x32_bf16 v[228:231], v[120:123], v[212:215], v[228:231]
v_mfma_f32_16x16x32_bf16 v[232:235], v[120:123], v[216:219], v[232:235]
v_mfma_f32_16x16x32_bf16 v[236:239], v[120:123], v[220:223], v[236:239]
s_waitcnt lgkmcnt(8)
s_nop 3
v_rcp_f32 v224, v224
v_rcp_f32 v228, v228
s_lshl_b32 s73, s59, 12
s_add_u32 s73, s73, 0x2000000
s_lshl_b32 s69, s67, 2
s_add_u32 s69, s69, s73
v_mov_b32 v225, v224
v_accvgpr_read_b32 v240, a0
v_accvgpr_read_b32 v241, a1
v_accvgpr_read_b32 v242, a2
v_accvgpr_read_b32 v243, a3
v_accvgpr_read_b32 v244, a4
v_accvgpr_read_b32 v245, a5
v_accvgpr_read_b32 v246, a6
v_accvgpr_read_b32 v247, a7
v_pk_mul_f32 v[240:241], v[240:241], v[224:225]
v_pk_mul_f32 v[242:243], v[242:243], v[224:225]
v_pk_mul_f32 v[244:245], v[244:245], v[224:225]
v_pk_mul_f32 v[246:247], v[246:247], v[224:225]
v_cvt_pk_bf16_f32 v240, v240, v241
v_cvt_pk_bf16_f32 v241, v242, v243
v_cvt_pk_bf16_f32 v242, v244, v245
v_cvt_pk_bf16_f32 v243, v246, v247
buffer_store_dwordx4 v[240:243], v1, s[44:47], s69 offen sc1
v_accvgpr_read_b32 v248, a8
v_accvgpr_read_b32 v249, a9
v_accvgpr_read_b32 v250, a10
v_accvgpr_read_b32 v251, a11
v_accvgpr_read_b32 v252, a12
v_accvgpr_read_b32 v253, a13
v_accvgpr_read_b32 v254, a14
v_accvgpr_read_b32 v255, a15
v_pk_mul_f32 v[248:249], v[248:249], v[224:225]
v_pk_mul_f32 v[250:251], v[250:251], v[224:225]
v_pk_mul_f32 v[252:253], v[252:253], v[224:225]
v_pk_mul_f32 v[254:255], v[254:255], v[224:225]
v_cvt_pk_bf16_f32 v248, v248, v249
v_cvt_pk_bf16_f32 v249, v250, v251
v_cvt_pk_bf16_f32 v250, v252, v253
v_cvt_pk_bf16_f32 v251, v254, v255
buffer_store_dwordx4 v[248:251], v1, s[44:47], s69 offen offset:1024 sc1
v_accvgpr_read_b32 v240, a16
v_accvgpr_read_b32 v241, a17
v_accvgpr_read_b32 v242, a18
v_accvgpr_read_b32 v243, a19
v_accvgpr_read_b32 v244, a20
v_accvgpr_read_b32 v245, a21
v_accvgpr_read_b32 v246, a22
v_accvgpr_read_b32 v247, a23
v_pk_mul_f32 v[240:241], v[240:241], v[224:225]
v_pk_mul_f32 v[242:243], v[242:243], v[224:225]
v_pk_mul_f32 v[244:245], v[244:245], v[224:225]
v_pk_mul_f32 v[246:247], v[246:247], v[224:225]
v_cvt_pk_bf16_f32 v240, v240, v241
v_cvt_pk_bf16_f32 v241, v242, v243
v_cvt_pk_bf16_f32 v242, v244, v245
v_cvt_pk_bf16_f32 v243, v246, v247
buffer_store_dwordx4 v[240:243], v1, s[44:47], s69 offen offset:2048 sc1
v_accvgpr_read_b32 v248, a24
v_accvgpr_read_b32 v249, a25
v_accvgpr_read_b32 v250, a26
v_accvgpr_read_b32 v251, a27
v_accvgpr_read_b32 v252, a28
v_accvgpr_read_b32 v253, a29
v_accvgpr_read_b32 v254, a30
v_accvgpr_read_b32 v255, a31
v_pk_mul_f32 v[248:249], v[248:249], v[224:225]
v_pk_mul_f32 v[250:251], v[250:251], v[224:225]
v_pk_mul_f32 v[252:253], v[252:253], v[224:225]
v_pk_mul_f32 v[254:255], v[254:255], v[224:225]
v_cvt_pk_bf16_f32 v248, v248, v249
v_cvt_pk_bf16_f32 v249, v250, v251
v_cvt_pk_bf16_f32 v250, v252, v253
v_cvt_pk_bf16_f32 v251, v254, v255
buffer_store_dwordx4 v[248:251], v1, s[44:47], s69 offen offset:3072 sc1
s_add_u32 s69, s69, 0x20000
v_mov_b32 v229, v228
v_accvgpr_read_b32 v240, a32
v_accvgpr_read_b32 v241, a33
v_accvgpr_read_b32 v242, a34
v_accvgpr_read_b32 v243, a35
v_accvgpr_read_b32 v244, a36
v_accvgpr_read_b32 v245, a37
v_accvgpr_read_b32 v246, a38
v_accvgpr_read_b32 v247, a39
v_pk_mul_f32 v[240:241], v[240:241], v[228:229]
v_pk_mul_f32 v[242:243], v[242:243], v[228:229]
v_pk_mul_f32 v[244:245], v[244:245], v[228:229]
v_pk_mul_f32 v[246:247], v[246:247], v[228:229]
v_cvt_pk_bf16_f32 v240, v240, v241
v_cvt_pk_bf16_f32 v241, v242, v243
v_cvt_pk_bf16_f32 v242, v244, v245
v_cvt_pk_bf16_f32 v243, v246, v247
buffer_store_dwordx4 v[240:243], v1, s[44:47], s69 offen sc1
v_accvgpr_read_b32 v248, a40
v_accvgpr_read_b32 v249, a41
v_accvgpr_read_b32 v250, a42
v_accvgpr_read_b32 v251, a43
v_accvgpr_read_b32 v252, a44
v_accvgpr_read_b32 v253, a45
v_accvgpr_read_b32 v254, a46
v_accvgpr_read_b32 v255, a47
v_pk_mul_f32 v[248:249], v[248:249], v[228:229]
v_pk_mul_f32 v[250:251], v[250:251], v[228:229]
v_pk_mul_f32 v[252:253], v[252:253], v[228:229]
v_pk_mul_f32 v[254:255], v[254:255], v[228:229]
v_cvt_pk_bf16_f32 v248, v248, v249
v_cvt_pk_bf16_f32 v249, v250, v251
v_cvt_pk_bf16_f32 v250, v252, v253
v_cvt_pk_bf16_f32 v251, v254, v255
buffer_store_dwordx4 v[248:251], v1, s[44:47], s69 offen offset:1024 sc1
v_accvgpr_read_b32 v240, a48
v_accvgpr_read_b32 v241, a49
v_accvgpr_read_b32 v242, a50
v_accvgpr_read_b32 v243, a51
v_accvgpr_read_b32 v244, a52
v_accvgpr_read_b32 v245, a53
v_accvgpr_read_b32 v246, a54
v_accvgpr_read_b32 v247, a55
v_pk_mul_f32 v[240:241], v[240:241], v[228:229]
v_pk_mul_f32 v[242:243], v[242:243], v[228:229]
v_pk_mul_f32 v[244:245], v[244:245], v[228:229]
v_pk_mul_f32 v[246:247], v[246:247], v[228:229]
v_cvt_pk_bf16_f32 v240, v240, v241
v_cvt_pk_bf16_f32 v241, v242, v243
v_cvt_pk_bf16_f32 v242, v244, v245
v_cvt_pk_bf16_f32 v243, v246, v247
buffer_store_dwordx4 v[240:243], v1, s[44:47], s69 offen offset:2048 sc1
v_accvgpr_read_b32 v248, a56
v_accvgpr_read_b32 v249, a57
v_accvgpr_read_b32 v250, a58
v_accvgpr_read_b32 v251, a59
v_accvgpr_read_b32 v252, a60
v_accvgpr_read_b32 v253, a61
v_accvgpr_read_b32 v254, a62
v_accvgpr_read_b32 v255, a63
v_pk_mul_f32 v[248:249], v[248:249], v[228:229]
v_pk_mul_f32 v[250:251], v[250:251], v[228:229]
v_pk_mul_f32 v[252:253], v[252:253], v[228:229]
v_pk_mul_f32 v[254:255], v[254:255], v[228:229]
v_cvt_pk_bf16_f32 v248, v248, v249
v_cvt_pk_bf16_f32 v249, v250, v251
v_cvt_pk_bf16_f32 v250, v252, v253
v_cvt_pk_bf16_f32 v251, v254, v255
buffer_store_dwordx4 v[248:251], v1, s[44:47], s69 offen offset:3072 sc1
s_cmp_le_u32 s85, 2
s_cbranch_scc1 Lalt33
v_mfma_f32_16x16x32_bf16 v[136:139], a[128:131], v[48:51], v[88:91]
s_add_u32 s82, s82, 0x8000
ds_read_b128 a[160:163], v2 offset:24576
ds_read_b128 a[176:179], v2 offset:28672
v_mfma_f32_16x16x32_bf16 v[140:143], a[128:131], v[64:67], v[92:95]
s_and_b32 s82, s82, 0x1ffff
v_exp_f32 v168, v168
v_mfma_f32_16x16x32_bf16 v[152:155], a[144:147], v[48:51], v[88:91]
s_add_u32 m0, s74, 0
v_exp_f32 v169, v169
v_mfma_f32_16x16x32_bf16 v[156:159], a[144:147], v[64:67], v[92:95]
s_add_u32 s72, s81, 0
ds_read_b128 a[164:167], v2 offset:25600
v_cvt_pk_bf16_f32 v216, v168, v169
Ljoin35:
v_mfma_f32_16x16x32_bf16 v[136:139], a[132:135], v[52:55], v[136:139]
v_exp_f32 v170, v170
v_mfma_f32_16x16x32_bf16 v[140:143], a[132:135], v[68:71], v[140:143]
buffer_load_dwordx4 v1, s[44:47], s72 offen sc1 lds
v_mfma_f32_16x16x32_bf16 v[156:159], a[148:151], v[68:71], v[156:159]
ds_read_b128 a[180:183], v2 offset:29696
ds_read_b128 a[168:171], v2 offset:26624
v_mfma_f32_16x16x32_bf16 v[152:155], a[148:151], v[52:55], v[152:155]
v_exp_f32 v171, v171
v_mfma_f32_16x16x32_bf16 v[140:143], a[136:139], v[72:75], v[140:143]
v_exp_f32 v184, v184
v_mfma_f32_16x16x32_bf16 v[136:139], a[136:139], v[56:59], v[136:139]
ds_read_b128 a[184:187], v2 offset:30720
v_cvt_pk_bf16_f32 v217, v170, v171
v_mfma_f32_16x16x32_bf16 v[152:155], a[152:155], v[56:59], v[152:155]
v_exp_f32 v185, v185
v_mfma_f32_16x16x32_bf16 v[156:159], a[152:155], v[72:75], v[156:159]
ds_read_b128 a[172:175], v2 offset:27648
v_cvt_pk_bf16_f32 v218, v184, v185
v_mfma_f32_16x16x32_bf16 v[136:139], a[140:143], v[60:63], v[136:139]
v_exp_f32 v186, v186
v_mfma_f32_16x16x32_bf16 v[140:143], a[140:143], v[76:79], v[140:143]
buffer_load_dwordx4 v1, s[44:47], s72 offen offset:1024 sc1 lds
v_mfma_f32_16x16x32_bf16 v[156:159], a[156:159], v[76:79], v[156:159]
ds_read_b128 a[188:191], v2 offset:31744
ds_read_b128 a[224:227], v2 offset:8192
v_mfma_f32_16x16x32_bf16 v[152:155], a[156:159], v[60:63], v[152:155]
s_waitcnt lgkmcnt(9)
v_exp_f32 v187, v187
v_mfma_f32_16x16x32_bf16 a[64:67], a[192:195], v[200:203], a[64:67]
v_exp_f32 v172, v172
v_mfma_f32_16x16x32_bf16 a[96:99], a[192:195], v[204:207], a[96:99]
ds_read_b128 a[228:231], v2 offset:9216
v_cvt_pk_bf16_f32 v219, v186, v187
v_mfma_f32_16x16x32_bf16 a[100:103], a[196:199], v[204:207], a[100:103]
v_exp_f32 v173, v173
v_mfma_f32_16x16x32_bf16 a[68:71], a[196:199], v[200:203], a[68:71]
ds_read_b128 a[232:235], v2 offset:10240
v_cvt_pk_bf16_f32 v220, v172, v173
v_mfma_f32_16x16x32_bf16 a[72:75], a[200:203], v[200:203], a[72:75]
v_exp_f32 v174, v174
v_mfma_f32_16x16x32_bf16 a[104:107], a[200:203], v[204:207], a[104:107]
buffer_load_dwordx4 v1, s[44:47], s72 offen offset:2048 sc1 lds
v_mfma_f32_16x16x32_bf16 a[108:111], a[204:207], v[204:207], a[108:111]
ds_read_b128 a[236:239], v2 offset:11264
v_mfma_f32_16x16x32_bf16 a[76:79], a[204:207], v[200:203], a[76:79]
v_exp_f32 v175, v175
v_mfma_f32_16x16x32_bf16 a[80:83], a[208:211], v[200:203], a[80:83]
ds_read_b128 a[240:243], v2 offset:12288
v_cvt_pk_bf16_f32 v221, v174, v175
v_mfma_f32_16x16x32_bf16 a[112:115], a[208:211], v[204:207], a[112:115]
v_exp_f32 v188, v188
v_mfma_f32_16x16x32_bf16 a[116:119], a[212:215], v[204:207], a[116:119]
ds_read_b128 a[244:247], v2 offset:13312
v_mfma_f32_16x16x32_bf16 a[84:87], a[212:215], v[200:203], a[84:87]
v_exp_f32 v189, v189
v_mfma_f32_16x16x32_bf16 a[88:91], a[216:219], v[200:203], a[88:91]
ds_read_b128 a[248:251], v2 offset:14336
v_cvt_pk_bf16_f32 v222, v188, v189
v_mfma_f32_16x16x32_bf16 a[120:123], a[216:219], v[204:207], a[120:123]
buffer_load_dwordx4 v1, s[44:47], s72 offen offset:3072 sc1 lds
v_mfma_f32_16x16x32_bf16 a[124:127], a[220:223], v[204:207], a[124:127]
v_exp_f32 v190, v190
v_mfma_f32_16x16x32_bf16 a[92:95], a[220:223], v[200:203], a[92:95]
ds_read_b128 a[252:255], v2 offset:15360
v_add_u32 v2, s82, v1
v_mfma_f32_16x16x32_bf16 v[232:235], v[120:123], v[200:203], v[232:235]
s_waitcnt vmcnt(16) lgkmcnt(8)
v_exp_f32 v191, v191
v_mfma_f32_16x16x32_bf16 v[236:239], v[120:123], v[204:207], v[236:239]
s_barrier
v_cvt_pk_bf16_f32 v223, v190, v191
s_cmp_eq_u32 s60, 7
s_cbranch_scc1 LHT3
s_lshl_b32 s83, s60, 2
s_sub_u32 s83, s83, 26
LloopII:
v_mfma_f32_16x16x32_bf16 v[168:171], a[160:163], v[48:51], v[88:91]
s_xor_b32 s74, s82, 0x10000
v_exp_f32 v136, v136
v_mfma_f32_16x16x32_bf16 v[172:175], a[160:163], v[64:67], v[92:95]
s_add_u32 s74, s74, s64
ds_read_b128 a[128:131], v2 offset:16384
ds_read_b128 a[144:147], v2 offset:20480
v_mfma_f32_16x16x32_bf16 v[184:187], a[176:179], v[48:51], v[88:91]
s_add_u32 s81, s81, 0x8000
v_exp_f32 v137, v137
v_mfma_f32_16x16x32_bf16 v[188:191], a[176:179], v[64:67], v[92:95]
s_add_u32 m0, s74, 16384
v_exp_f32 v138, v138
v_mfma_f32_16x16x32_bf16 v[168:171], a[164:167], v[52:55], v[168:171]
s_add_u32 s72, s81, 16384
ds_read_b128 a[132:135], v2 offset:17408
v_cvt_pk_bf16_f32 v200, v136, v137
v_mfma_f32_16x16x32_bf16 v[172:175], a[164:167], v[68:71], v[172:175]
buffer_load_dwordx4 v1, s[44:47], s72 offen sc1 lds
v_mfma_f32_16x16x32_bf16 v[188:191], a[180:183], v[68:71], v[188:191]
v_exp_f32 v139, v139
v_mfma_f32_16x16x32_bf16 v[184:187], a[180:183], v[52:55], v[184:187]
ds_read_b128 a[148:151], v2 offset:21504
v_cvt_pk_bf16_f32 v201, v138, v139
v_mfma_f32_16x16x32_bf16 v[172:175], a[168:171], v[72:75], v[172:175]
v_exp_f32 v152, v152
v_mfma_f32_16x16x32_bf16 v[168:171], a[168:171], v[56:59], v[168:171]
ds_read_b128 a[136:139], v2 offset:18432
ds_read_b128 a[152:155], v2 offset:22528
v_mfma_f32_16x16x32_bf16 v[184:187], a[184:187], v[56:59], v[184:187]
v_exp_f32 v153, v153
v_mfma_f32_16x16x32_bf16 v[188:191], a[184:187], v[72:75], v[188:191]
v_exp_f32 v154, v154
v_mfma_f32_16x16x32_bf16 v[168:171], a[172:175], v[60:63], v[168:171]
ds_read_b128 a[140:143], v2 offset:19456
v_cvt_pk_bf16_f32 v202, v152, v153
v_mfma_f32_16x16x32_bf16 v[172:175], a[172:175], v[76:79], v[172:175]
buffer_load_dwordx4 v1, s[44:47], s72 offen offset:1024 sc1 lds
v_mfma_f32_16x16x32_bf16 v[188:191], a[188:191], v[76:79], v[188:191]
v_exp_f32 v155, v155
v_mfma_f32_16x16x32_bf16 v[184:187], a[188:191], v[60:63], v[184:187]
s_waitcnt lgkmcnt(7)
ds_read_b128 a[156:159], v2 offset:23552
v_cvt_pk_bf16_f32 v203, v154, v155
v_mfma_f32_16x16x32_bf16 a[64:67], a[224:227], v[216:219], a[64:67]
v_exp_f32 v140, v140
v_mfma_f32_16x16x32_bf16 a[96:99], a[224:227], v[220:223], a[96:99]
ds_read_b128 a[192:195], v2 offset:0
ds_read_b128 a[196:199], v2 offset:1024
v_mfma_f32_16x16x32_bf16 a[100:103], a[228:231], v[220:223], a[100:103]
v_exp_f32 v141, v141
v_mfma_f32_16x16x32_bf16 a[68:71], a[228:231], v[216:219], a[68:71]
v_exp_f32 v142, v142
v_mfma_f32_16x16x32_bf16 a[72:75], a[232:235], v[216:219], a[72:75]
ds_read_b128 a[200:203], v2 offset:2048
v_cvt_pk_bf16_f32 v204, v140, v141
v_mfma_f32_16x16x32_bf16 a[104:107], a[232:235], v[220:223], a[104:107]
buffer_load_dwordx4 v1, s[44:47], s72 offen offset:2048 sc1 lds
v_mfma_f32_16x16x32_bf16 a[108:111], a[236:239], v[220:223], a[108:111]
v_exp_f32 v143, v143
v_mfma_f32_16x16x32_bf16 a[76:79], a[236:239], v[216:219], a[76:79]
ds_read_b128 a[204:207], v2 offset:3072
v_cvt_pk_bf16_f32 v205, v142, v143
v_mfma_f32_16x16x32_bf16 a[80:83], a[240:243], v[216:219], a[80:83]
v_exp_f32 v156, v156
v_mfma_f32_16x16x32_bf16 a[112:115], a[240:243], v[220:223], a[112:115]
ds_read_b128 a[208:211], v2 offset:4096
v_mfma_f32_16x16x32_bf16 a[116:119], a[244:247], v[220:223], a[116:119]
v_exp_f32 v157, v157
v_mfma_f32_16x16x32_bf16 a[84:87], a[244:247], v[216:219], a[84:87]
ds_read_b128 a[212:215], v2 offset:5120
v_cvt_pk_bf16_f32 v206, v156, v157
v_mfma_f32_16x16x32_bf16 a[88:91], a[248:251], v[216:219], a[88:91]
v_exp_f32 v158, v158
v_mfma_f32_16x16x32_bf16 a[120:123], a[248:251], v[220:223], a[120:123]
ds_read_b128 a[216:219], v2 offset:6144
v_mfma_f32_16x16x32_bf16 a[124:127], a[252:255], v[220:223], a[124:127]
buffer_load_dwordx4 v1, s[44:47], s72 offen offset:3072 sc1 lds
v_mfma_f32_16x16x32_bf16 a[92:95], a[252:255], v[216:219], a[92:95]
v_exp_f32 v159, v159
v_mfma_f32_16x16x32_bf16 v[232:235], v[120:123], v[216:219], v[232:235]
ds_read_b128 a[220:223], v2 offset:7168
v_cvt_pk_bf16_f32 v207, v158, v159
v_mfma_f32_16x16x32_bf16 v[236:239], v[120:123], v[220:223], v[236:239]
s_waitcnt lgkmcnt(8)
v_mfma_f32_16x16x32_bf16 v[136:139], a[128:131], v[48:51], v[88:91]
s_add_u32 s82, s82, 0x8000
ds_read_b128 a[160:163], v2 offset:24576
ds_read_b128 a[176:179], v2 offset:28672
v_mfma_f32_16x16x32_bf16 v[140:143], a[128:131], v[64:67], v[92:95]
s_and_b32 s82, s82, 0x1ffff
v_exp_f32 v168, v168
v_mfma_f32_16x16x32_bf16 v[152:155], a[144:147], v[48:51], v[88:91]
s_add_u32 m0, s74, 0
v_exp_f32 v169, v169
v_mfma_f32_16x16x32_bf16 v[156:159], a[144:147], v[64:67], v[92:95]
s_add_u32 s72, s81, 0
ds_read_b128 a[164:167], v2 offset:25600
v_cvt_pk_bf16_f32 v216, v168, v169
v_mfma_f32_16x16x32_bf16 v[136:139], a[132:135], v[52:55], v[136:139]
v_exp_f32 v170, v170
v_mfma_f32_16x16x32_bf16 v[140:143], a[132:135], v[68:71], v[140:143]
buffer_load_dwordx4 v1, s[44:47], s72 offen sc1 lds
v_mfma_f32_16x16x32_bf16 v[156:159], a[148:151], v[68:71], v[156:159]
ds_read_b128 a[180:183], v2 offset:29696
ds_read_b128 a[168:171], v2 offset:26624
v_mfma_f32_16x16x32_bf16 v[152:155], a[148:151], v[52:55], v[152:155]
v_exp_f32 v171, v171
v_mfma_f32_16x16x32_bf16 v[140:143], a[136:139], v[72:75], v[140:143]
v_exp_f32 v184, v184
v_mfma_f32_16x16x32_bf16 v[136:139], a[136:139], v[56:59], v[136:139]
ds_read_b128 a[184:187], v2 offset:30720
v_cvt_pk_bf16_f32 v217, v170, v171
v_mfma_f32_16x16x32_bf16 v[152:155], a[152:155], v[56:59], v[152:155]
v_exp_f32 v185, v185
v_mfma_f32_16x16x32_bf16 v[156:159], a[152:155], v[72:75], v[156:159]
ds_read_b128 a[172:175], v2 offset:27648
v_cvt_pk_bf16_f32 v218, v184, v185
v_mfma_f32_16x16x32_bf16 v[136:139], a[140:143], v[60:63], v[136:139]
buffer_load_dwordx4 v1, s[44:47], s72 offen offset:1024 sc1 lds
v_mfma_f32_16x16x32_bf16 v[140:143], a[140:143], v[76:79], v[140:143]
v_exp_f32 v186, v186
v_mfma_f32_16x16x32_bf16 v[156:159], a[156:159], v[76:79], v[156:159]
ds_read_b128 a[188:191], v2 offset:31744
ds_read_b128 a[224:227], v2 offset:8192
v_mfma_f32_16x16x32_bf16 v[152:155], a[156:159], v[60:63], v[152:155]
s_waitcnt lgkmcnt(9)
v_exp_f32 v187, v187
v_mfma_f32_16x16x32_bf16 a[64:67], a[192:195], v[200:203], a[64:67]
v_exp_f32 v172, v172
v_mfma_f32_16x16x32_bf16 a[96:99], a[192:195], v[204:207], a[96:99]
ds_read_b128 a[228:231], v2 offset:9216
v_cvt_pk_bf16_f32 v219, v186, v187
v_mfma_f32_16x16x32_bf16 a[100:103], a[196:199], v[204:207], a[100:103]
v_exp_f32 v173, v173
v_mfma_f32_16x16x32_bf16 a[68:71], a[196:199], v[200:203], a[68:71]
ds_read_b128 a[232:235], v2 offset:10240
v_cvt_pk_bf16_f32 v220, v172, v173
v_mfma_f32_16x16x32_bf16 a[72:75], a[200:203], v[200:203], a[72:75]
buffer_load_dwordx4 v1, s[44:47], s72 offen offset:2048 sc1 lds
v_mfma_f32_16x16x32_bf16 a[104:107], a[200:203], v[204:207], a[104:107]
v_exp_f32 v174, v174
v_mfma_f32_16x16x32_bf16 a[108:111], a[204:207], v[204:207], a[108:111]
ds_read_b128 a[236:239], v2 offset:11264
v_mfma_f32_16x16x32_bf16 a[76:79], a[204:207], v[200:203], a[76:79]
v_exp_f32 v175, v175
v_mfma_f32_16x16x32_bf16 a[80:83], a[208:211], v[200:203], a[80:83]
ds_read_b128 a[240:243], v2 offset:12288
v_cvt_pk_bf16_f32 v221, v174, v175
v_mfma_f32_16x16x32_bf16 a[112:115], a[208:211], v[204:207], a[112:115]
v_exp_f32 v188, v188
v_mfma_f32_16x16x32_bf16 a[116:119], a[212:215], v[204:207], a[116:119]
ds_read_b128 a[244:247], v2 offset:13312
v_mfma_f32_16x16x32_bf16 a[84:87], a[212:215], v[200:203], a[84:87]
v_exp_f32 v189, v189
v_mfma_f32_16x16x32_bf16 a[88:91], a[216:219], v[200:203], a[88:91]
ds_read_b128 a[248:251], v2 offset:14336
v_cvt_pk_bf16_f32 v222, v188, v189
v_mfma_f32_16x16x32_bf16 a[120:123], a[216:219], v[204:207], a[120:123]
buffer_load_dwordx4 v1, s[44:47], s72 offen offset:3072 sc1 lds
v_mfma_f32_16x16x32_bf16 a[124:127], a[220:223], v[204:207], a[124:127]
ds_read_b128 a[252:255], v2 offset:15360
v_add_u32 v2, s82, v1
v_mfma_f32_16x16x32_bf16 a[92:95], a[220:223], v[200:203], a[92:95]
s_waitcnt vmcnt(8) lgkmcnt(8)
v_exp_f32 v190, v190
v_mfma_f32_16x16x32_bf16 v[232:235], v[120:123], v[200:203], v[232:235]
s_barrier
v_exp_f32 v191, v191
v_mfma_f32_16x16x32_bf16 v[236:239], v[120:123], v[204:207], v[236:239]
s_add_u32 s83, s83, 1
v_cvt_pk_bf16_f32 v223, v190, v191
s_cbranch_scc0 LloopII
v_mfma_f32_16x16x32_bf16 v[168:171], a[160:163], v[48:51], v[88:91]
s_xor_b32 s74, s82, 0x10000
v_exp_f32 v136, v136
v_mfma_f32_16x16x32_bf16 v[172:175], a[160:163], v[64:67], v[92:95]
s_add_u32 s74, s74, s64
ds_read_b128 a[128:131], v2 offset:16384
ds_read_b128 a[144:147], v2 offset:20480
v_mfma_f32_16x16x32_bf16 v[184:187], a[176:179], v[48:51], v[88:91]
s_add_u32 s81, s81, 0x8000
v_exp_f32 v137, v137
v_mfma_f32_16x16x32_bf16 v[188:191], a[176:179], v[64:67], v[92:95]
s_add_u32 m0, s74, 0
v_exp_f32 v138, v138
v_mfma_f32_16x16x32_bf16 v[168:171], a[164:167], v[52:55], v[168:171]
s_add_u32 s72, s81, 0
ds_read_b128 a[132:135], v2 offset:17408
v_cvt_pk_bf16_f32 v200, v136, v137
v_mfma_f32_16x16x32_bf16 v[172:175], a[164:167], v[68:71], v[172:175]
buffer_load_dwordx4 v1, s[44:47], s72 offen sc1 lds
v_mfma_f32_16x16x32_bf16 v[188:191], a[180:183], v[68:71], v[188:191]
v_exp_f32 v139, v139
v_mfma_f32_16x16x32_bf16 v[184:187], a[180:183], v[52:55], v[184:187]
ds_read_b128 a[148:151], v2 offset:21504
v_cvt_pk_bf16_f32 v201, v138, v139
v_mfma_f32_16x16x32_bf16 v[172:175], a[168:171], v[72:75], v[172:175]
v_exp_f32 v152, v152
v_mfma_f32_16x16x32_bf16 v[168:171], a[168:171], v[56:59], v[168:171]
ds_read_b128 a[136:139], v2 offset:18432
ds_read_b128 a[152:155], v2 offset:22528
v_mfma_f32_16x16x32_bf16 v[184:187], a[184:187], v[56:59], v[184:187]
v_exp_f32 v153, v153
v_mfma_f32_16x16x32_bf16 v[188:191], a[184:187], v[72:75], v[188:191]
v_exp_f32 v154, v154
v_mfma_f32_16x16x32_bf16 v[168:171], a[172:175], v[60:63], v[168:171]
ds_read_b128 a[140:143], v2 offset:19456
v_cvt_pk_bf16_f32 v202, v152, v153
v_mfma_f32_16x16x32_bf16 v[172:175], a[172:175], v[76:79], v[172:175]
buffer_load_dwordx4 v1, s[44:47], s72 offen offset:1024 sc1 lds
v_mfma_f32_16x16x32_bf16 v[188:191], a[188:191], v[76:79], v[188:191]
v_exp_f32 v155, v155
v_mfma_f32_16x16x32_bf16 v[184:187], a[188:191], v[60:63], v[184:187]
s_waitcnt lgkmcnt(7)
ds_read_b128 a[156:159], v2 offset:23552
v_cvt_pk_bf16_f32 v203, v154, v155
v_mfma_f32_16x16x32_bf16 a[64:67], a[224:227], v[216:219], a[64:67]
v_exp_f32 v140, v140
v_mfma_f32_16x16x32_bf16 a[96:99], a[224:227], v[220:223], a[96:99]
ds_read_b128 a[192:195], v2 offset:0
ds_read_b128 a[196:199], v2 offset:1024
v_mfma_f32_16x16x32_bf16 a[100:103], a[228:231], v[220:223], a[100:103]
v_exp_f32 v141, v141
v_mfma_f32_16x16x32_bf16 a[68:71], a[228:231], v[216:219], a[68:71]
v_exp_f32 v142, v142
v_mfma_f32_16x16x32_bf16 a[72:75], a[232:235], v[216:219], a[72:75]
ds_read_b128 a[200:203], v2 offset:2048
v_cvt_pk_bf16_f32 v204, v140, v141
v_mfma_f32_16x16x32_bf16 a[104:107], a[232:235], v[220:223], a[104:107]
buffer_load_dwordx4 v1, s[44:47], s72 offen offset:2048 sc1 lds
v_mfma_f32_16x16x32_bf16 a[108:111], a[236:239], v[220:223], a[108:111]
v_exp_f32 v143, v143
v_mfma_f32_16x16x32_bf16 a[76:79], a[236:239], v[216:219], a[76:79]
ds_read_b128 a[204:207], v2 offset:3072
v_cvt_pk_bf16_f32 v205, v142, v143
v_mfma_f32_16x16x32_bf16 a[80:83], a[240:243], v[216:219], a[80:83]
v_exp_f32 v156, v156
v_mfma_f32_16x16x32_bf16 a[112:115], a[240:243], v[220:223], a[112:115]
ds_read_b128 a[208:211], v2 offset:4096
v_mfma_f32_16x16x32_bf16 a[116:119], a[244:247], v[220:223], a[116:119]
v_exp_f32 v157, v157
v_mfma_f32_16x16x32_bf16 a[84:87], a[244:247], v[216:219], a[84:87]
ds_read_b128 a[212:215], v2 offset:5120
v_cvt_pk_bf16_f32 v206, v156, v157
v_mfma_f32_16x16x32_bf16 a[88:91], a[248:251], v[216:219], a[88:91]
v_exp_f32 v158, v158
v_mfma_f32_16x16x32_bf16 a[120:123], a[248:251], v[220:223], a[120:123]
ds_read_b128 a[216:219], v2 offset:6144
v_mfma_f32_16x16x32_bf16 a[124:127], a[252:255], v[220:223], a[124:127]
buffer_load_dwordx4 v1, s[44:47], s72 offen offset:3072 sc1 lds
v_mfma_f32_16x16x32_bf16 a[92:95], a[252:255], v[216:219], a[92:95]
v_exp_f32 v159, v159
v_mfma_f32_16x16x32_bf16 v[232:235], v[120:123], v[216:219], v[232:235]
ds_read_b128 a[220:223], v2 offset:7168
v_cvt_pk_bf16_f32 v207, v158, v159
v_mfma_f32_16x16x32_bf16 v[236:239], v[120:123], v[220:223], v[236:239]
s_waitcnt lgkmcnt(8)
s_cmp_le_u32 s58, 0
s_cbranch_scc1 Lalt36
v_mfma_f32_16x16x32_bf16 v[136:139], a[128:131], v[48:51], v[88:91]
s_add_u32 s82, s82, 0x8000
ds_read_b128 a[160:163], v2 offset:24576
v_mfma_f32_16x16x32_bf16 v[140:143], a[128:131], v[64:67], v[92:95]
s_and_b32 s82, s82, 0x1ffff
v_exp_f32 v168, v168
v_mfma_f32_16x16x32_bf16 v[152:155], a[144:147], v[48:51], v[88:91]
ds_read_b128 a[176:179], v2 offset:28672
v_mfma_f32_16x16x32_bf16 v[156:159], a[144:147], v[64:67], v[92:95]
v_exp_f32 v169, v169
Ljoin38:
v_mfma_f32_16x16x32_bf16 v[136:139], a[132:135], v[52:55], v[136:139]
ds_read_b128 a[164:167], v2 offset:25600
v_cvt_pk_bf16_f32 v216, v168, v169
v_mfma_f32_16x16x32_bf16 v[140:143], a[132:135], v[68:71], v[140:143]
v_exp_f32 v170, v170
v_mfma_f32_16x16x32_bf16 v[156:159], a[148:151], v[68:71], v[156:159]
ds_read_b128 a[180:183], v2 offset:29696
v_mfma_f32_16x16x32_bf16 v[152:155], a[148:151], v[52:55], v[152:155]
v_exp_f32 v171, v171
v_mfma_f32_16x16x32_bf16 v[140:143], a[136:139], v[72:75], v[140:143]
ds_read_b128 a[168:171], v2 offset:26624
v_cvt_pk_bf16_f32 v217, v170, v171
v_mfma_f32_16x16x32_bf16 v[136:139], a[136:139], v[56:59], v[136:139]
v_exp_f32 v184, v184
v_mfma_f32_16x16x32_bf16 v[152:155], a[152:155], v[56:59], v[152:155]
ds_read_b128 a[184:187], v2 offset:30720
v_mfma_f32_16x16x32_bf16 v[156:159], a[152:155], v[72:75], v[156:159]
v_exp_f32 v185, v185
v_mfma_f32_16x16x32_bf16 v[136:139], a[140:143], v[60:63], v[136:139]
ds_read_b128 a[172:175], v2 offset:27648
v_cvt_pk_bf16_f32 v218, v184, v185
v_mfma_f32_16x16x32_bf16 v[140:143], a[140:143], v[76:79], v[140:143]
v_exp_f32 v186, v186
v_mfma_f32_16x16x32_bf16 v[156:159], a[156:159], v[76:79], v[156:159]
ds_read_b128 a[188:191], v2 offset:31744
v_mfma_f32_16x16x32_bf16 v[152:155], a[156:159], v[60:63], v[152:155]
s_waitcnt lgkmcnt(8)
v_exp_f32 v187, v187
v_mfma_f32_16x16x32_bf16 a[64:67], a[192:195], v[200:203], a[64:67]
ds_read_b128 a[224:227], v2 offset:8192
v_cvt_pk_bf16_f32 v219, v186, v187
v_mfma_f32_16x16x32_bf16 a[96:99], a[192:195], v[204:207], a[96:99]
v_exp_f32 v172, v172
v_mfma_f32_16x16x32_bf16 a[100:103], a[196:199], v[204:207], a[100:103]
ds_read_b128 a[228:231], v2 offset:9216
v_mfma_f32_16x16x32_bf16 a[68:71], a[196:199], v[200:203], a[68:71]
v_exp_f32 v173, v173
v_mfma_f32_16x16x32_bf16 a[72:75], a[200:203], v[200:203], a[72:75]
ds_read_b128 a[232:235], v2 offset:10240
v_cvt_pk_bf16_f32 v220, v172, v173
v_mfma_f32_16x16x32_bf16 a[104:107], a[200:203], v[204:207], a[104:107]
v_exp_f32 v174, v174
v_mfma_f32_16x16x32_bf16 a[108:111], a[204:207], v[204:207], a[108:111]
ds_read_b128 a[236:239], v2 offset:11264
v_mfma_f32_16x16x32_bf16 a[76:79], a[204:207], v[200:203], a[76:79]
v_exp_f32 v175, v175
v_mfma_f32_16x16x32_bf16 a[80:83], a[208:211], v[200:203], a[80:83]
ds_read_b128 a[240:243], v2 offset:12288
v_cvt_pk_bf16_f32 v221, v174, v175
v_mfma_f32_16x16x32_bf16 a[112:115], a[208:211], v[204:207], a[112:115]
v_exp_f32 v188, v188
v_mfma_f32_16x16x32_bf16 a[116:119], a[212:215], v[204:207], a[116:119]
ds_read_b128 a[244:247], v2 offset:13312
v_mfma_f32_16x16x32_bf16 a[84:87], a[212:215], v[200:203], a[84:87]
v_exp_f32 v189, v189
v_mfma_f32_16x16x32_bf16 a[88:91], a[216:219], v[200:203], a[88:91]
ds_read_b128 a[248:251], v2 offset:14336
v_cvt_pk_bf16_f32 v222, v188, v189
v_mfma_f32_16x16x32_bf16 a[120:123], a[216:219], v[204:207], a[120:123]
v_exp_f32 v190, v190
v_mfma_f32_16x16x32_bf16 a[124:127], a[220:223], v[204:207], a[124:127]
ds_read_b128 a[252:255], v2 offset:15360
v_add_u32 v2, s82, v1
v_mfma_f32_16x16x32_bf16 a[92:95], a[220:223], v[200:203], a[92:95]
v_exp_f32 v191, v191
v_mfma_f32_16x16x32_bf16 v[232:235], v[120:123], v[200:203], v[232:235]
s_waitcnt vmcnt(4) lgkmcnt(8)
v_cvt_pk_bf16_f32 v223, v190, v191
v_mfma_f32_16x16x32_bf16 v[236:239], v[120:123], v[204:207], v[236:239]
s_barrier
s_cmp_le_u32 s58, 1
s_cbranch_scc1 Lalt39
v_mfma_f32_16x16x32_bf16 v[168:171], a[160:163], v[48:51], v[88:91]
v_exp_f32 v136, v136
v_mfma_f32_16x16x32_bf16 v[172:175], a[160:163], v[64:67], v[92:95]
ds_read_b128 a[128:131], v2 offset:16384
v_mfma_f32_16x16x32_bf16 v[184:187], a[176:179], v[48:51], v[88:91]
v_exp_f32 v137, v137
v_mfma_f32_16x16x32_bf16 v[188:191], a[176:179], v[64:67], v[92:95]
ds_read_b128 a[144:147], v2 offset:20480
v_cvt_pk_bf16_f32 v200, v136, v137
Ljoin41:
v_mfma_f32_16x16x32_bf16 v[168:171], a[164:167], v[52:55], v[168:171]
v_exp_f32 v138, v138
v_mfma_f32_16x16x32_bf16 v[172:175], a[164:167], v[68:71], v[172:175]
ds_read_b128 a[132:135], v2 offset:17408
v_mfma_f32_16x16x32_bf16 v[188:191], a[180:183], v[68:71], v[188:191]
v_exp_f32 v139, v139
v_mfma_f32_16x16x32_bf16 v[184:187], a[180:183], v[52:55], v[184:187]
ds_read_b128 a[148:151], v2 offset:21504
v_cvt_pk_bf16_f32 v201, v138, v139
v_mfma_f32_16x16x32_bf16 v[172:175], a[168:171], v[72:75], v[172:175]
v_exp_f32 v152, v152
v_mfma_f32_16x16x32_bf16 v[168:171], a[168:171], v[56:59], v[168:171]
ds_read_b128 a[136:139], v2 offset:18432
v_mfma_f32_16x16x32_bf16 v[184:187], a[184:187], v[56:59], v[184:187]
v_exp_f32 v153, v153
v_mfma_f32_16x16x32_bf16 v[188:191], a[184:187], v[72:75], v[188:191]
ds_read_b128 a[152:155], v2 offset:22528
v_cvt_pk_bf16_f32 v202, v152, v153
v_mfma_f32_16x16x32_bf16 v[168:171], a[172:175], v[60:63], v[168:171]
v_exp_f32 v154, v154
v_mfma_f32_16x16x32_bf16 v[172:175], a[172:175], v[76:79], v[172:175]
ds_read_b128 a[140:143], v2 offset:19456
v_mfma_f32_16x16x32_bf16 v[188:191], a[188:191], v[76:79], v[188:191]
v_exp_f32 v155, v155
v_mfma_f32_16x16x32_bf16 v[184:187], a[188:191], v[60:63], v[184:187]
s_waitcnt lgkmcnt(7)
ds_read_b128 a[156:159], v2 offset:23552
v_cvt_pk_bf16_f32 v203, v154, v155
v_mfma_f32_16x16x32_bf16 a[64:67], a[224:227], v[216:219], a[64:67]
v_exp_f32 v140, v140
v_mfma_f32_16x16x32_bf16 a[96:99], a[224:227], v[220:223], a[96:99]
ds_read_b128 a[192:195], v2 offset:0
v_mfma_f32_16x16x32_bf16 a[100:103], a[228:231], v[220:223], a[100:103]
v_exp_f32 v141, v141
v_mfma_f32_16x16x32_bf16 a[68:71], a[228:231], v[216:219], a[68:71]
ds_read_b128 a[196:199], v2 offset:1024
v_cvt_pk_bf16_f32 v204, v140, v141
v_mfma_f32_16x16x32_bf16 a[72:75], a[232:235], v[216:219], a[72:75]
v_exp_f32 v142, v142
v_mfma_f32_16x16x32_bf16 a[104:107], a[232:235], v[220:223], a[104:107]
ds_read_b128 a[200:203], v2 offset:2048
v_mfma_f32_16x16x32_bf16 a[108:111], a[236:239], v[220:223], a[108:111]
v_exp_f32 v143, v143
v_mfma_f32_16x16x32_bf16 a[76:79], a[236:239], v[216:219], a[76:79]
ds_read_b128 a[204:207], v2 offset:3072
v_cvt_pk_bf16_f32 v205, v142, v143
v_mfma_f32_16x16x32_bf16 a[80:83], a[240:243], v[216:219], a[80:83]
v_exp_f32 v156, v156
v_mfma_f32_16x16x32_bf16 a[112:115], a[240:243], v[220:223], a[112:115]
ds_read_b128 a[208:211], v2 offset:4096
v_mfma_f32_16x16x32_bf16 a[116:119], a[244:247], v[220:223], a[116:119]
v_exp_f32 v157, v157
v_mfma_f32_16x16x32_bf16 a[84:87], a[244:247], v[216:219], a[84:87]
ds_read_b128 a[212:215], v2 offset:5120
v_cvt_pk_bf16_f32 v206, v156, v157
v_mfma_f32_16x16x32_bf16 a[88:91], a[248:251], v[216:219], a[88:91]
v_exp_f32 v158, v158
v_mfma_f32_16x16x32_bf16 a[120:123], a[248:251], v[220:223], a[120:123]
ds_read_b128 a[216:219], v2 offset:6144
v_mfma_f32_16x16x32_bf16 a[124:127], a[252:255], v[220:223], a[124:127]
v_exp_f32 v159, v159
v_mfma_f32_16x16x32_bf16 a[92:95], a[252:255], v[216:219], a[92:95]
ds_read_b128 a[220:223], v2 offset:7168
v_cvt_pk_bf16_f32 v207, v158, v159
v_mfma_f32_16x16x32_bf16 v[232:235], v[120:123], v[216:219], v[232:235]
v_mfma_f32_16x16x32_bf16 v[236:239], v[120:123], v[220:223], v[236:239]
s_waitcnt lgkmcnt(8)
s_cmp_le_u32 s58, 2
s_cbranch_scc1 Lalt42
v_mfma_f32_16x16x32_bf16 v[136:139], a[128:131], v[48:51], v[88:91]
s_add_u32 s82, s82, 0x8000
ds_read_b128 a[160:163], v2 offset:24576
v_mfma_f32_16x16x32_bf16 v[140:143], a[128:131], v[64:67], v[92:95]
s_and_b32 s82, s82, 0x1ffff
v_exp_f32 v168, v168
v_mfma_f32_16x16x32_bf16 v[152:155], a[144:147], v[48:51], v[88:91]
ds_read_b128 a[176:179], v2 offset:28672
v_mfma_f32_16x16x32_bf16 v[156:159], a[144:147], v[64:67], v[92:95]
v_exp_f32 v169, v169
Ljoin44:
v_mfma_f32_16x16x32_bf16 v[136:139], a[132:135], v[52:55], v[136:139]
ds_read_b128 a[164:167], v2 offset:25600
v_cvt_pk_bf16_f32 v216, v168, v169
v_mfma_f32_16x16x32_bf16 v[140:143], a[132:135], v[68:71], v[140:143]
v_exp_f32 v170, v170
v_mfma_f32_16x16x32_bf16 v[156:159], a[148:151], v[68:71], v[156:159]
ds_read_b128 a[180:183], v2 offset:29696
v_mfma_f32_16x16x32_bf16 v[152:155], a[148:151], v[52:55], v[152:155]
v_exp_f32 v171, v171
v_mfma_f32_16x16x32_bf16 v[140:143], a[136:139], v[72:75], v[140:143]
ds_read_b128 a[168:171], v2 offset:26624
v_cvt_pk_bf16_f32 v217, v170, v171
v_mfma_f32_16x16x32_bf16 v[136:139], a[136:139], v[56:59], v[136:139]
v_exp_f32 v184, v184
v_mfma_f32_16x16x32_bf16 v[152:155], a[152:155], v[56:59], v[152:155]
ds_read_b128 a[184:187], v2 offset:30720
v_mfma_f32_16x16x32_bf16 v[156:159], a[152:155], v[72:75], v[156:159]
v_exp_f32 v185, v185
v_mfma_f32_16x16x32_bf16 v[136:139], a[140:143], v[60:63], v[136:139]
ds_read_b128 a[172:175], v2 offset:27648
v_cvt_pk_bf16_f32 v218, v184, v185
v_mfma_f32_16x16x32_bf16 v[140:143], a[140:143], v[76:79], v[140:143]
v_exp_f32 v186, v186
v_mfma_f32_16x16x32_bf16 v[156:159], a[156:159], v[76:79], v[156:159]
ds_read_b128 a[188:191], v2 offset:31744
v_mfma_f32_16x16x32_bf16 v[152:155], a[156:159], v[60:63], v[152:155]
s_waitcnt lgkmcnt(8)
v_exp_f32 v187, v187
v_mfma_f32_16x16x32_bf16 a[64:67], a[192:195], v[200:203], a[64:67]
ds_read_b128 a[224:227], v2 offset:8192
v_cvt_pk_bf16_f32 v219, v186, v187
v_mfma_f32_16x16x32_bf16 a[96:99], a[192:195], v[204:207], a[96:99]
v_exp_f32 v172, v172
v_mfma_f32_16x16x32_bf16 a[100:103], a[196:199], v[204:207], a[100:103]
ds_read_b128 a[228:231], v2 offset:9216
v_mfma_f32_16x16x32_bf16 a[68:71], a[196:199], v[200:203], a[68:71]
v_exp_f32 v173, v173
v_mfma_f32_16x16x32_bf16 a[72:75], a[200:203], v[200:203], a[72:75]
ds_read_b128 a[232:235], v2 offset:10240
v_cvt_pk_bf16_f32 v220, v172, v173
v_mfma_f32_16x16x32_bf16 a[104:107], a[200:203], v[204:207], a[104:107]
v_exp_f32 v174, v174
v_mfma_f32_16x16x32_bf16 a[108:111], a[204:207], v[204:207], a[108:111]
ds_read_b128 a[236:239], v2 offset:11264
v_mfma_f32_16x16x32_bf16 a[76:79], a[204:207], v[200:203], a[76:79]
v_exp_f32 v175, v175
v_mfma_f32_16x16x32_bf16 a[80:83], a[208:211], v[200:203], a[80:83]
ds_read_b128 a[240:243], v2 offset:12288
v_cvt_pk_bf16_f32 v221, v174, v175
v_mfma_f32_16x16x32_bf16 a[112:115], a[208:211], v[204:207], a[112:115]
v_exp_f32 v188, v188
v_mfma_f32_16x16x32_bf16 a[116:119], a[212:215], v[204:207], a[116:119]
ds_read_b128 a[244:247], v2 offset:13312
v_mfma_f32_16x16x32_bf16 a[84:87], a[212:215], v[200:203], a[84:87]
v_exp_f32 v189, v189
v_mfma_f32_16x16x32_bf16 a[88:91], a[216:219], v[200:203], a[88:91]
ds_read_b128 a[248:251], v2 offset:14336
v_cvt_pk_bf16_f32 v222, v188, v189
v_mfma_f32_16x16x32_bf16 a[120:123], a[216:219], v[204:207], a[120:123]
v_exp_f32 v190, v190
v_mfma_f32_16x16x32_bf16 a[124:127], a[220:223], v[204:207], a[124:127]
ds_read_b128 a[252:255], v2 offset:15360
v_add_u32 v2, s82, v1
v_mfma_f32_16x16x32_bf16 a[92:95], a[220:223], v[200:203], a[92:95]
v_exp_f32 v191, v191
v_mfma_f32_16x16x32_bf16 v[232:235], v[120:123], v[200:203], v[232:235]
s_waitcnt vmcnt(0) lgkmcnt(8)
v_cvt_pk_bf16_f32 v223, v190, v191
v_mfma_f32_16x16x32_bf16 v[236:239], v[120:123], v[204:207], v[236:239]
s_barrier
LHT3:
s_cmp_le_u32 s58, 3
s_cbranch_scc1 Lalt45
v_mfma_f32_16x16x32_bf16 v[168:171], a[160:163], v[48:51], v[88:91]
v_exp_f32 v136, v136
v_mfma_f32_16x16x32_bf16 v[172:175], a[160:163], v[64:67], v[92:95]
ds_read_b128 a[192:195], v2 offset:0
v_mfma_f32_16x16x32_bf16 v[184:187], a[176:179], v[48:51], v[88:91]
v_exp_f32 v137, v137
v_mfma_f32_16x16x32_bf16 v[188:191], a[176:179], v[64:67], v[92:95]
v_exp_f32 v138, v138
Ljoin47:
v_mfma_f32_16x16x32_bf16 v[168:171], a[164:167], v[52:55], v[168:171]
ds_read_b128 a[196:199], v2 offset:1024
v_cvt_pk_bf16_f32 v200, v136, v137
v_mfma_f32_16x16x32_bf16 v[172:175], a[164:167], v[68:71], v[172:175]
v_exp_f32 v139, v139
v_mfma_f32_16x16x32_bf16 v[188:191], a[180:183], v[68:71], v[188:191]
v_exp_f32 v152, v152
v_mfma_f32_16x16x32_bf16 v[184:187], a[180:183], v[52:55], v[184:187]
ds_read_b128 a[200:203], v2 offset:2048
v_cvt_pk_bf16_f32 v201, v138, v139
v_mfma_f32_16x16x32_bf16 v[172:175], a[168:171], v[72:75], v[172:175]
v_exp_f32 v153, v153
v_mfma_f32_16x16x32_bf16 v[168:171], a[168:171], v[56:59], v[168:171]
v_exp_f32 v154, v154
v_mfma_f32_16x16x32_bf16 v[184:187], a[184:187], v[56:59], v[184:187]
ds_read_b128 a[204:207], v2 offset:3072
v_cvt_pk_bf16_f32 v202, v152, v153
v_mfma_f32_16x16x32_bf16 v[188:191], a[184:187], v[72:75], v[188:191]
v_exp_f32 v155, v155
v_mfma_f32_16x16x32_bf16 v[168:171], a[172:175], v[60:63], v[168:171]
v_exp_f32 v140, v140
v_mfma_f32_16x16x32_bf16 v[172:175], a[172:175], v[76:79], v[172:175]
ds_read_b128 a[208:211], v2 offset:4096
v_cvt_pk_bf16_f32 v203, v154, v155
v_mfma_f32_16x16x32_bf16 v[188:191], a[188:191], v[76:79], v[188:191]
v_exp_f32 v141, v141
v_mfma_f32_16x16x32_bf16 v[184:187], a[188:191], v[60:63], v[184:187]
s_waitcnt lgkmcnt(5)
v_exp_f32 v142, v142
v_mfma_f32_16x16x32_bf16 a[64:67], a[224:227], v[216:219], a[64:67]
ds_read_b128 a[212:215], v2 offset:5120
v_cvt_pk_bf16_f32 v204, v140, v141
v_mfma_f32_16x16x32_bf16 a[96:99], a[224:227], v[220:223], a[96:99]
v_exp_f32 v143, v143
v_mfma_f32_16x16x32_bf16 a[100:103], a[228:231], v[220:223], a[100:103]
v_exp_f32 v156, v156
v_mfma_f32_16x16x32_bf16 a[68:71], a[228:231], v[216:219], a[68:71]
ds_read_b128 a[216:219], v2 offset:6144
v_cvt_pk_bf16_f32 v205, v142, v143
v_mfma_f32_16x16x32_bf16 a[72:75], a[232:235], v[216:219], a[72:75]
v_exp_f32 v157, v157
v_mfma_f32_16x16x32_bf16 a[104:107], a[232:235], v[220:223], a[104:107]
v_exp_f32 v158, v158
v_mfma_f32_16x16x32_bf16 a[108:111], a[236:239], v[220:223], a[108:111]
ds_read_b128 a[220:223], v2 offset:7168
v_cvt_pk_bf16_f32 v206, v156, v157
v_mfma_f32_16x16x32_bf16 a[76:79], a[236:239], v[216:219], a[76:79]
v_exp_f32 v159, v159
v_mfma_f32_16x16x32_bf16 a[80:83], a[240:243], v[216:219], a[80:83]
v_cvt_pk_bf16_f32 v207, v158, v159
v_mfma_f32_16x16x32_bf16 a[112:115], a[240:243], v[220:223], a[112:115]
v_mfma_f32_16x16x32_bf16 a[116:119], a[244:247], v[220:223], a[116:119]
v_mfma_f32_16x16x32_bf16 a[84:87], a[244:247], v[216:219], a[84:87]
v_mfma_f32_16x16x32_bf16 a[88:91], a[248:251], v[216:219], a[88:91]
v_mfma_f32_16x16x32_bf16 a[120:123], a[248:251], v[220:223], a[120:123]
v_mfma_f32_16x16x32_bf16 a[124:127], a[252:255], v[220:223], a[124:127]
v_mfma_f32_16x16x32_bf16 a[92:95], a[252:255], v[216:219], a[92:95]
v_mfma_f32_16x16x32_bf16 v[232:235], v[120:123], v[216:219], v[232:235]
v_mfma_f32_16x16x32_bf16 v[236:239], v[120:123], v[220:223], v[236:239]
s_waitcnt lgkmcnt(0)
v_mfma_f32_16x16x32_bf16 a[64:67], a[192:195], v[200:203], a[64:67]
s_add_u32 s82, s82, 0x8000
ds_read_b128 a[224:227], v2 offset:8192
ds_read_b128 a[228:231], v2 offset:9216
v_mfma_f32_16x16x32_bf16 a[96:99], a[192:195], v[204:207], a[96:99]
s_and_b32 s82, s82, 0x1ffff
v_exp_f32 v168, v168
v_mfma_f32_16x16x32_bf16 a[100:103], a[196:199], v[204:207], a[100:103]
v_exp_f32 v169, v169
v_mfma_f32_16x16x32_bf16 a[68:71], a[196:199], v[200:203], a[68:71]
v_exp_f32 v170, v170
v_mfma_f32_16x16x32_bf16 a[72:75], a[200:203], v[200:203], a[72:75]
v_exp_f32 v171, v171
v_mfma_f32_16x16x32_bf16 a[104:107], a[200:203], v[204:207], a[104:107]
ds_read_b128 a[232:235], v2 offset:10240
ds_read_b128 a[236:239], v2 offset:11264
v_mfma_f32_16x16x32_bf16 a[108:111], a[204:207], v[204:207], a[108:111]
v_exp_f32 v184, v184
v_mfma_f32_16x16x32_bf16 a[76:79], a[204:207], v[200:203], a[76:79]
ds_read_b128 a[240:243], v2 offset:12288
ds_read_b128 a[244:247], v2 offset:13312
v_mfma_f32_16x16x32_bf16 a[80:83], a[208:211], v[200:203], a[80:83]
ds_read_b128 a[248:251], v2 offset:14336
ds_read_b128 a[252:255], v2 offset:15360
v_mfma_f32_16x16x32_bf16 a[112:115], a[208:211], v[204:207], a[112:115]
v_cvt_pk_bf16_f32 v216, v168, v169
v_cvt_pk_bf16_f32 v217, v170, v171
v_mfma_f32_16x16x32_bf16 a[116:119], a[212:215], v[204:207], a[116:119]
v_exp_f32 v185, v185
v_mfma_f32_16x16x32_bf16 a[84:87], a[212:215], v[200:203], a[84:87]
v_exp_f32 v186, v186
v_mfma_f32_16x16x32_bf16 a[88:91], a[216:219], v[200:203], a[88:91]
v_exp_f32 v187, v187
v_mfma_f32_16x16x32_bf16 a[120:123], a[216:219], v[204:207], a[120:123]
v_exp_f32 v172, v172
v_mfma_f32_16x16x32_bf16 a[124:127], a[220:223], v[204:207], a[124:127]
v_cvt_pk_bf16_f32 v218, v184, v185
v_cvt_pk_bf16_f32 v219, v186, v187
v_mfma_f32_16x16x32_bf16 a[92:95], a[220:223], v[200:203], a[92:95]
v_exp_f32 v173, v173
v_mfma_f32_16x16x32_bf16 v[232:235], v[120:123], v[200:203], v[232:235]
s_waitcnt vmcnt(0) lgkmcnt(0)
v_exp_f32 v174, v174
v_mfma_f32_16x16x32_bf16 v[236:239], v[120:123], v[204:207], v[236:239]
s_barrier
v_exp_f32 v175, v175
v_add_u32 v2, s82, v1
v_cvt_pk_bf16_f32 v220, v172, v173
v_exp_f32 v188, v188
v_cvt_pk_bf16_f32 v221, v174, v175
v_exp_f32 v189, v189
v_exp_f32 v190, v190
v_cvt_pk_bf16_f32 v222, v188, v189
v_exp_f32 v191, v191
s_nop 0
v_cvt_pk_bf16_f32 v223, v190, v191
v_mfma_f32_16x16x32_bf16 a[64:67], a[224:227], v[216:219], a[64:67]
s_add_u32 m0, s92, 16640
v_mfma_f32_16x16x32_bf16 a[96:99], a[224:227], v[220:223], a[96:99]
s_add_u32 s72, s93, 0x3000000
buffer_load_dwordx4 v1, s[44:47], s72 offen sc1 lds
v_mfma_f32_16x16x32_bf16 a[100:103], a[228:231], v[220:223], a[100:103]
buffer_load_dwordx4 v1, s[44:47], s72 offen offset:1024 sc1 lds
v_mfma_f32_16x16x32_bf16 a[68:71], a[228:231], v[216:219], a[68:71]
buffer_load_dwordx4 v1, s[44:47], s72 offen offset:2048 sc1 lds
v_mfma_f32_16x16x32_bf16 a[72:75], a[232:235], v[216:219], a[72:75]
buffer_load_dwordx4 v1, s[44:47], s72 offen offset:3072 sc1 lds
v_mfma_f32_16x16x32_bf16 a[104:107], a[232:235], v[220:223], a[104:107]
s_add_u32 m0, s92, 32
v_mfma_f32_16x16x32_bf16 a[108:111], a[236:239], v[220:223], a[108:111]
s_add_u32 s72, s93, 0
buffer_load_dwordx4 v1, s[36:39], s72 offen lds
v_mfma_f32_16x16x32_bf16 a[76:79], a[236:239], v[216:219], a[76:79]
buffer_load_dwordx4 v1, s[36:39], s72 offen offset:1024 lds
v_mfma_f32_16x16x32_bf16 a[80:83], a[240:243], v[216:219], a[80:83]
buffer_load_dwordx4 v1, s[36:39], s72 offen offset:2048 lds
v_mfma_f32_16x16x32_bf16 a[112:115], a[240:243], v[220:223], a[112:115]
buffer_load_dwordx4 v1, s[36:39], s72 offen offset:3072 lds
v_mfma_f32_16x16x32_bf16 a[116:119], a[244:247], v[220:223], a[116:119]
s_add_u32 m0, s92, 4192
v_mfma_f32_16x16x32_bf16 a[84:87], a[244:247], v[216:219], a[84:87]
s_add_u32 s72, s93, 2
buffer_load_dwordx4 v1, s[36:39], s72 offen lds
v_mfma_f32_16x16x32_bf16 a[88:91], a[248:251], v[216:219], a[88:91]
buffer_load_dwordx4 v1, s[36:39], s72 offen offset:1024 lds
v_mfma_f32_16x16x32_bf16 a[120:123], a[248:251], v[220:223], a[120:123]
buffer_load_dwordx4 v1, s[36:39], s72 offen offset:2048 lds
v_mfma_f32_16x16x32_bf16 a[124:127], a[252:255], v[220:223], a[124:127]
buffer_load_dwordx4 v1, s[36:39], s72 offen offset:3072 lds
v_mfma_f32_16x16x32_bf16 a[92:95], a[252:255], v[216:219], a[92:95]
s_add_u32 m0, s92, 8352
v_mfma_f32_16x16x32_bf16 v[232:235], v[120:123], v[216:219], v[232:235]
s_add_u32 s72, s93, 4
buffer_load_dwordx4 v1, s[36:39], s72 offen lds
v_mfma_f32_16x16x32_bf16 v[236:239], v[120:123], v[220:223], v[236:239]
buffer_load_dwordx4 v1, s[36:39], s72 offen offset:1024 lds
buffer_load_dwordx4 v1, s[36:39], s72 offen offset:2048 lds
buffer_load_dwordx4 v1, s[36:39], s72 offen offset:3072 lds
s_add_u32 m0, s92, 12512
s_add_u32 s72, s93, 6
buffer_load_dwordx4 v1, s[36:39], s72 offen lds
buffer_load_dwordx4 v1, s[36:39], s72 offen offset:1024 lds
buffer_load_dwordx4 v1, s[36:39], s72 offen offset:2048 lds
buffer_load_dwordx4 v1, s[36:39], s72 offen offset:3072 lds
v_rcp_f32 v232, v232
v_rcp_f32 v236, v236
s_lshl_b32 s73, s59, 12
s_add_u32 s73, s73, 0x2000000
s_lshl_b32 s69, s68, 2
s_add_u32 s69, s69, s73
v_mov_b32 v233, v232
v_accvgpr_read_b32 v240, a64
v_accvgpr_read_b32 v241, a65
v_accvgpr_read_b32 v242, a66
v_accvgpr_read_b32 v243, a67
v_accvgpr_read_b32 v244, a68
v_accvgpr_read_b32 v245, a69
v_accvgpr_read_b32 v246, a70
v_accvgpr_read_b32 v247, a71
v_pk_mul_f32 v[240:241], v[240:241], v[232:233]
v_pk_mul_f32 v[242:243], v[242:243], v[232:233]
v_pk_mul_f32 v[244:245], v[244:245], v[232:233]
v_pk_mul_f32 v[246:247], v[246:247], v[232:233]
v_cvt_pk_bf16_f32 v240, v240, v241
v_cvt_pk_bf16_f32 v241, v242, v243
v_cvt_pk_bf16_f32 v242, v244, v245
v_cvt_pk_bf16_f32 v243, v246, v247
buffer_store_dwordx4 v[240:243], v1, s[44:47], s69 offen sc1
v_accvgpr_read_b32 v248, a72
v_accvgpr_read_b32 v249, a73
v_accvgpr_read_b32 v250, a74
v_accvgpr_read_b32 v251, a75
v_accvgpr_read_b32 v252, a76
v_accvgpr_read_b32 v253, a77
v_accvgpr_read_b32 v254, a78
v_accvgpr_read_b32 v255, a79
v_pk_mul_f32 v[248:249], v[248:249], v[232:233]
v_pk_mul_f32 v[250:251], v[250:251], v[232:233]
v_pk_mul_f32 v[252:253], v[252:253], v[232:233]
v_pk_mul_f32 v[254:255], v[254:255], v[232:233]
v_cvt_pk_bf16_f32 v248, v248, v249
v_cvt_pk_bf16_f32 v249, v250, v251
v_cvt_pk_bf16_f32 v250, v252, v253
v_cvt_pk_bf16_f32 v251, v254, v255
buffer_store_dwordx4 v[248:251], v1, s[44:47], s69 offen offset:1024 sc1
v_accvgpr_read_b32 v240, a80
v_accvgpr_read_b32 v241, a81
v_accvgpr_read_b32 v242, a82
v_accvgpr_read_b32 v243, a83
v_accvgpr_read_b32 v244, a84
v_accvgpr_read_b32 v245, a85
v_accvgpr_read_b32 v246, a86
v_accvgpr_read_b32 v247, a87
v_pk_mul_f32 v[240:241], v[240:241], v[232:233]
v_pk_mul_f32 v[242:243], v[242:243], v[232:233]
v_pk_mul_f32 v[244:245], v[244:245], v[232:233]
v_pk_mul_f32 v[246:247], v[246:247], v[232:233]
v_cvt_pk_bf16_f32 v240, v240, v241
v_cvt_pk_bf16_f32 v241, v242, v243
v_cvt_pk_bf16_f32 v242, v244, v245
v_cvt_pk_bf16_f32 v243, v246, v247
buffer_store_dwordx4 v[240:243], v1, s[44:47], s69 offen offset:2048 sc1
v_accvgpr_read_b32 v248, a88
v_accvgpr_read_b32 v249, a89
v_accvgpr_read_b32 v250, a90
v_accvgpr_read_b32 v251, a91
v_accvgpr_read_b32 v252, a92
v_accvgpr_read_b32 v253, a93
v_accvgpr_read_b32 v254, a94
v_accvgpr_read_b32 v255, a95
v_pk_mul_f32 v[248:249], v[248:249], v[232:233]
v_pk_mul_f32 v[250:251], v[250:251], v[232:233]
v_pk_mul_f32 v[252:253], v[252:253], v[232:233]
v_pk_mul_f32 v[254:255], v[254:255], v[232:233]
v_cvt_pk_bf16_f32 v248, v248, v249
v_cvt_pk_bf16_f32 v249, v250, v251
v_cvt_pk_bf16_f32 v250, v252, v253
v_cvt_pk_bf16_f32 v251, v254, v255
buffer_store_dwordx4 v[248:251], v1, s[44:47], s69 offen offset:3072 sc1
s_add_u32 s69, s69, 0x20000
v_mov_b32 v237, v236
v_accvgpr_read_b32 v240, a96
v_accvgpr_read_b32 v241, a97
v_accvgpr_read_b32 v242, a98
v_accvgpr_read_b32 v243, a99
v_accvgpr_read_b32 v244, a100
v_accvgpr_read_b32 v245, a101
v_accvgpr_read_b32 v246, a102
v_accvgpr_read_b32 v247, a103
v_pk_mul_f32 v[240:241], v[240:241], v[236:237]
v_pk_mul_f32 v[242:243], v[242:243], v[236:237]
v_pk_mul_f32 v[244:245], v[244:245], v[236:237]
v_pk_mul_f32 v[246:247], v[246:247], v[236:237]
v_cvt_pk_bf16_f32 v240, v240, v241
v_cvt_pk_bf16_f32 v241, v242, v243
v_cvt_pk_bf16_f32 v242, v244, v245
v_cvt_pk_bf16_f32 v243, v246, v247
buffer_store_dwordx4 v[240:243], v1, s[44:47], s69 offen sc1
v_accvgpr_read_b32 v248, a104
v_accvgpr_read_b32 v249, a105
v_accvgpr_read_b32 v250, a106
v_accvgpr_read_b32 v251, a107
v_accvgpr_read_b32 v252, a108
v_accvgpr_read_b32 v253, a109
v_accvgpr_read_b32 v254, a110
v_accvgpr_read_b32 v255, a111
v_pk_mul_f32 v[248:249], v[248:249], v[236:237]
v_pk_mul_f32 v[250:251], v[250:251], v[236:237]
v_pk_mul_f32 v[252:253], v[252:253], v[236:237]
v_pk_mul_f32 v[254:255], v[254:255], v[236:237]
v_cvt_pk_bf16_f32 v248, v248, v249
v_cvt_pk_bf16_f32 v249, v250, v251
v_cvt_pk_bf16_f32 v250, v252, v253
v_cvt_pk_bf16_f32 v251, v254, v255
buffer_store_dwordx4 v[248:251], v1, s[44:47], s69 offen offset:1024 sc1
v_accvgpr_read_b32 v240, a112
v_accvgpr_read_b32 v241, a113
v_accvgpr_read_b32 v242, a114
v_accvgpr_read_b32 v243, a115
v_accvgpr_read_b32 v244, a116
v_accvgpr_read_b32 v245, a117
v_accvgpr_read_b32 v246, a118
v_accvgpr_read_b32 v247, a119
v_pk_mul_f32 v[240:241], v[240:241], v[236:237]
v_pk_mul_f32 v[242:243], v[242:243], v[236:237]
v_pk_mul_f32 v[244:245], v[244:245], v[236:237]
v_pk_mul_f32 v[246:247], v[246:247], v[236:237]
v_cvt_pk_bf16_f32 v240, v240, v241
v_cvt_pk_bf16_f32 v241, v242, v243
v_cvt_pk_bf16_f32 v242, v244, v245
v_cvt_pk_bf16_f32 v243, v246, v247
buffer_store_dwordx4 v[240:243], v1, s[44:47], s69 offen offset:2048 sc1
v_accvgpr_read_b32 v248, a120
v_accvgpr_read_b32 v249, a121
v_accvgpr_read_b32 v250, a122
v_accvgpr_read_b32 v251, a123
v_accvgpr_read_b32 v252, a124
v_accvgpr_read_b32 v253, a125
v_accvgpr_read_b32 v254, a126
v_accvgpr_read_b32 v255, a127
v_pk_mul_f32 v[248:249], v[248:249], v[236:237]
v_pk_mul_f32 v[250:251], v[250:251], v[236:237]
v_pk_mul_f32 v[252:253], v[252:253], v[236:237]
v_pk_mul_f32 v[254:255], v[254:255], v[236:237]
v_cvt_pk_bf16_f32 v248, v248, v249
v_cvt_pk_bf16_f32 v249, v250, v251
v_cvt_pk_bf16_f32 v250, v252, v253
v_cvt_pk_bf16_f32 v251, v254, v255
buffer_store_dwordx4 v[248:251], v1, s[44:47], s69 offen offset:3072 sc1
s_mov_b32 s73, 0x5d800000
v_add_f32 v224, v226, v230
v_add_f32 v225, v234, v238
v_add_f32 v224, v224, v225
v_cmp_nlt_f32 vcc, v224, s73
s_cmp_lg_u64 vcc, 0
s_cselect_b32 s73, 1, 0
s_lshl_b32 s74, s58, 2
s_add_u32 s74, s74, 90112
v_mov_b32 v224, s73
v_mov_b32 v225, s74
ds_write_b32 v225, v224
v_bfe_u32 v128, v0, 2, 2
v_and_b32 v129, 3, v0
v_mul_u32_u24 v130, 4160, v128
v_lshl_add_u32 v130, v129, 3, v130
v_add_u32 v130, s92, v130
v_lshlrev_b32 v128, 4, v128
v_sub_u32 v128, 48, v128
v_lshlrev_b64 v[132:133], 16, s[88:89]
v_cmp_eq_u32 vcc, 3, v129
v_lshlrev_b64 v[132:133], v128, v[132:133]
v_mov_b32 v134, 0
v_mov_b32 v135, 0
v_cndmask_b32 v132, 0, v132, vcc
v_cndmask_b32 v133, 0, v133, vcc
s_add_u32 s73, s92, 20736
v_lshlrev_b32 v131, 3, v0
v_add_u32 v131, s73, v131
ds_write_b64 v130, v[132:133]
ds_write_b64 v131, v[134:135]
v_and_b32 v128, 15, v0
v_lshrrev_b32 v129, 4, v0
v_add_u32 v136, 1, v128
v_and_b32 v137, 3, v136
v_lshrrev_b32 v136, 2, v136
v_mul_u32_u24 v137, 4160, v137
v_lshl_add_u32 v137, v136, 3, v137
v_lshl_add_u32 v137, v129, 4, v137
v_add_u32 v164, s92, v137
s_add_u32 s73, s92, 17120
v_lshlrev_b32 v136, 5, v128
v_sub_u32 v136, s73, v136
v_lshl_add_u32 v165, v129, 4, v136
v_lshrrev_b32 v136, 3, v128
v_and_b32 v137, 7, v0
v_lshlrev_b32 v137, 3, v137
v_lshl_add_u32 v137, v136, 8, v137
v_lshl_add_u32 v166, v129, 6, v137
s_and_b32 s73, s58, 1
s_lshl_b32 s73, s73, 4
s_lshr_b32 s73, s90, s73
s_and_b32 s73, s73, 0xffff
v_lshl_add_u32 v136, v129, 3, v128
v_sub_u32 v136, 15, v136
v_and_b32 v137, 1, v136
v_lshlrev_b32 v137, 4, v137
v_lshlrev_b32 v137, v137, s73
v_lshrrev_b32 v136, 1, v136
v_cmp_eq_u32 vcc, 0, v136
s_nop 1
v_cndmask_b32 v160, 0, v137, vcc
v_cmp_eq_u32 vcc, 1, v136
s_nop 1
v_cndmask_b32 v161, 0, v137, vcc
v_cmp_eq_u32 vcc, 2, v136
s_nop 1
v_cndmask_b32 v162, 0, v137, vcc
v_cmp_eq_u32 vcc, 3, v136
s_nop 1
v_cndmask_b32 v163, 0, v137, vcc
s_lshr_b32 s75, s59, 3
s_lshl_b32 s75, s75, 2
s_and_b32 s73, s59, 3
s_add_u32 s75, s75, s73
s_lshl_b32 s76, s59, 1
s_and_b32 s76, s76, 8
s_add_u32 s76, s76, s60
s_lshl_b32 s94, s58, 16
s_lshl_b32 s73, s76, 7
s_add_u32 s94, s94, s73
s_lshl_b32 s95, s75, 20
s_lshl_b32 s73, s58, 18
s_add_u32 s95, s95, s73
s_add_u32 s95, s95, 0x2000000
v_lshlrev_b32 v136, 1, v129
v_and_b32 v137, 7, v0
v_xor_b32 v137, v137, v136
v_lshlrev_b32 v137, 4, v137
v_lshrrev_b32 v136, 3, v0
v_lshl_add_u32 v4, v136, 11, v137
s_add_u32 s71, s61, 0
s_and_b32 s71, s71, 3
s_lshl_b32 s71, s71, 18
s_add_u32 s71, s71, s94
s_add_u32 m0, s64, 98304
s_add_u32 s72, s71, 0
buffer_load_dwordx4 v4, s[24:27], s72 offen lds
s_add_u32 s72, s71, 15360
buffer_load_dwordx4 v4, s[24:27], s72 offen offset:1024 lds
s_add_u32 s72, s71, 30720
buffer_load_dwordx4 v4, s[24:27], s72 offen offset:2048 lds
s_add_u32 s72, s71, 46080
buffer_load_dwordx4 v4, s[24:27], s72 offen offset:3072 lds
s_waitcnt vmcnt(12) lgkmcnt(0)
ds_read_b128 a[192:195], v165 offset:3584
ds_read_b64 a[128:129], v164 offset:0
ds_read_b64 a[130:131], v164 offset:8
ds_read_b128 a[196:199], v165 offset:3072
ds_read_b64 a[132:133], v164 offset:512
ds_read_b64 a[134:135], v164 offset:520
ds_read_b128 a[200:203], v165 offset:2560
ds_read_b64 a[136:137], v164 offset:1024
ds_read_b64 a[138:139], v164 offset:1032
ds_read_b128 a[204:207], v165 offset:2048
ds_read_b64 a[140:141], v164 offset:1536
ds_read_b64 a[142:143], v164 offset:1544
ds_read_b128 a[208:211], v165 offset:1536
ds_read_b64 a[144:145], v164 offset:2048
ds_read_b64 a[146:147], v164 offset:2056
ds_read_b128 a[212:215], v165 offset:1024
ds_read_b64 a[148:149], v164 offset:2560
ds_read_b64 a[150:151], v164 offset:2568
ds_read_b128 a[216:219], v165 offset:512
ds_read_b64 a[152:153], v164 offset:3072
ds_read_b64 a[154:155], v164 offset:3080
ds_read_b128 a[220:223], v165 offset:0
ds_read_b64 a[156:157], v164 offset:3584
ds_read_b64 a[158:159], v164 offset:3592
s_waitcnt lgkmcnt(0)
v_mfma_f32_16x16x32_bf16 v[128:131], v[160:163], a[192:195], 0
s_add_u32 s71, s61, 1
ds_read_b128 a[224:227], v165 offset:3648
v_mfma_f32_16x16x32_bf16 v[132:135], v[160:163], a[196:199], 0
s_and_b32 s71, s71, 3
ds_read_b64 a[160:161], v164 offset:64
v_mfma_f32_16x16x32_bf16 v[136:139], v[160:163], a[200:203], 0
s_lshl_b32 s71, s71, 18
ds_read_b64 a[162:163], v164 offset:72
v_mfma_f32_16x16x32_bf16 v[140:143], v[160:163], a[204:207], 0
s_add_u32 s71, s71, s94
ds_read_b128 a[228:231], v165 offset:3136
v_mfma_f32_16x16x32_bf16 v[144:147], v[160:163], a[208:211], 0
s_add_u32 m0, s64, 114688
ds_read_b64 a[164:165], v164 offset:576
v_mfma_f32_16x16x32_bf16 v[148:151], v[160:163], a[212:215], 0
s_add_u32 s72, s71, 0
ds_read_b64 a[166:167], v164 offset:584
v_mfma_f32_16x16x32_bf16 v[152:155], v[160:163], a[216:219], 0
ds_read_b128 a[232:235], v165 offset:2624
v_mfma_f32_16x16x32_bf16 v[156:159], v[160:163], a[220:223], 0
ds_read_b64 a[168:169], v164 offset:1088
v_mfma_f32_16x16x32_bf16 v[128:131], a[128:131], a[192:195], v[128:131]
ds_read_b64 a[170:171], v164 offset:1096
v_mfma_f32_16x16x32_bf16 v[132:135], a[128:131], a[196:199], v[132:135]
ds_read_b128 a[236:239], v165 offset:2112
v_mfma_f32_16x16x32_bf16 v[136:139], a[128:131], a[200:203], v[136:139]
ds_read_b64 a[172:173], v164 offset:1600
v_mfma_f32_16x16x32_bf16 v[140:143], a[128:131], a[204:207], v[140:143]
ds_read_b64 a[174:175], v164 offset:1608
v_mfma_f32_16x16x32_bf16 v[144:147], a[128:131], a[208:211], v[144:147]
ds_read_b128 a[240:243], v165 offset:1600
v_mfma_f32_16x16x32_bf16 v[148:151], a[128:131], a[212:215], v[148:151]
ds_read_b64 a[176:177], v164 offset:2112
v_mfma_f32_16x16x32_bf16 v[152:155], a[128:131], a[216:219], v[152:155]
ds_read_b64 a[178:179], v164 offset:2120
v_mfma_f32_16x16x32_bf16 v[156:159], a[128:131], a[220:223], v[156:159]
ds_read_b128 a[244:247], v165 offset:1088
v_mfma_f32_16x16x32_bf16 v[132:135], a[132:135], a[192:195], v[132:135]
ds_read_b64 a[180:181], v164 offset:2624
v_mfma_f32_16x16x32_bf16 v[136:139], a[132:135], a[196:199], v[136:139]
ds_read_b64 a[182:183], v164 offset:2632
v_mfma_f32_16x16x32_bf16 v[140:143], a[132:135], a[200:203], v[140:143]
ds_read_b128 a[248:251], v165 offset:576
v_mfma_f32_16x16x32_bf16 v[144:147], a[132:135], a[204:207], v[144:147]
ds_read_b64 a[184:185], v164 offset:3136
v_mfma_f32_16x16x32_bf16 v[148:151], a[132:135], a[208:211], v[148:151]
ds_read_b64 a[186:187], v164 offset:3144
v_mfma_f32_16x16x32_bf16 v[152:155], a[132:135], a[212:215], v[152:155]
ds_read_b128 a[252:255], v165 offset:64
v_mfma_f32_16x16x32_bf16 v[156:159], a[132:135], a[216:219], v[156:159]
ds_read_b64 a[188:189], v164 offset:3648
v_mfma_f32_16x16x32_bf16 v[136:139], a[136:139], a[192:195], v[136:139]
ds_read_b64 a[190:191], v164 offset:3656
v_mfma_f32_16x16x32_bf16 v[140:143], a[136:139], a[196:199], v[140:143]
buffer_load_dwordx4 v4, s[24:27], s72 offen lds
v_mfma_f32_16x16x32_bf16 v[144:147], a[136:139], a[200:203], v[144:147]
s_add_u32 s72, s71, 15360
buffer_load_dwordx4 v4, s[24:27], s72 offen offset:1024 lds
v_mfma_f32_16x16x32_bf16 v[148:151], a[136:139], a[204:207], v[148:151]
v_mfma_f32_16x16x32_bf16 v[152:155], a[136:139], a[208:211], v[152:155]
v_mfma_f32_16x16x32_bf16 v[156:159], a[136:139], a[212:215], v[156:159]
v_mfma_f32_16x16x32_bf16 v[140:143], a[140:143], a[192:195], v[140:143]
v_mfma_f32_16x16x32_bf16 v[144:147], a[140:143], a[196:199], v[144:147]
v_mfma_f32_16x16x32_bf16 v[148:151], a[140:143], a[200:203], v[148:151]
v_mfma_f32_16x16x32_bf16 v[152:155], a[140:143], a[204:207], v[152:155]
v_mfma_f32_16x16x32_bf16 v[156:159], a[140:143], a[208:211], v[156:159]
v_mfma_f32_16x16x32_bf16 v[144:147], a[144:147], a[192:195], v[144:147]
v_mfma_f32_16x16x32_bf16 v[148:151], a[144:147], a[196:199], v[148:151]
v_mfma_f32_16x16x32_bf16 v[152:155], a[144:147], a[200:203], v[152:155]
s_add_u32 s72, s71, 30720
buffer_load_dwordx4 v4, s[24:27], s72 offen offset:2048 lds
v_mfma_f32_16x16x32_bf16 v[156:159], a[144:147], a[204:207], v[156:159]
v_mfma_f32_16x16x32_bf16 v[148:151], a[148:151], a[192:195], v[148:151]
v_mfma_f32_16x16x32_bf16 v[152:155], a[148:151], a[196:199], v[152:155]
v_mfma_f32_16x16x32_bf16 v[156:159], a[148:151], a[200:203], v[156:159]
v_mfma_f32_16x16x32_bf16 v[152:155], a[152:155], a[192:195], v[152:155]
v_mfma_f32_16x16x32_bf16 v[156:159], a[152:155], a[196:199], v[156:159]
v_mfma_f32_16x16x32_bf16 v[156:159], a[156:159], a[192:195], v[156:159]
s_waitcnt lgkmcnt(0)
v_mfma_f32_16x16x32_bf16 v[128:131], a[160:163], a[224:227], v[128:131]
ds_read_b128 a[192:195], v165 offset:3712
v_mfma_f32_16x16x32_bf16 v[132:135], a[160:163], a[228:231], v[132:135]
ds_read_b64 a[128:129], v164 offset:128
v_mfma_f32_16x16x32_bf16 v[136:139], a[160:163], a[232:235], v[136:139]
ds_read_b64 a[130:131], v164 offset:136
v_mfma_f32_16x16x32_bf16 v[140:143], a[160:163], a[236:239], v[140:143]
ds_read_b128 a[196:199], v165 offset:3200
v_mfma_f32_16x16x32_bf16 v[144:147], a[160:163], a[240:243], v[144:147]
ds_read_b64 a[132:133], v164 offset:640
v_mfma_f32_16x16x32_bf16 v[148:151], a[160:163], a[244:247], v[148:151]
ds_read_b64 a[134:135], v164 offset:648
v_mfma_f32_16x16x32_bf16 v[152:155], a[160:163], a[248:251], v[152:155]
ds_read_b128 a[200:203], v165 offset:2688
v_mfma_f32_16x16x32_bf16 v[156:159], a[160:163], a[252:255], v[156:159]
ds_read_b64 a[136:137], v164 offset:1152
v_mfma_f32_16x16x32_bf16 v[132:135], a[164:167], a[224:227], v[132:135]
ds_read_b64 a[138:139], v164 offset:1160
v_mfma_f32_16x16x32_bf16 v[136:139], a[164:167], a[228:231], v[136:139]
ds_read_b128 a[204:207], v165 offset:2176
v_mfma_f32_16x16x32_bf16 v[140:143], a[164:167], a[232:235], v[140:143]
s_add_u32 s72, s71, 46080
ds_read_b64 a[140:141], v164 offset:1664
v_mfma_f32_16x16x32_bf16 v[144:147], a[164:167], a[236:239], v[144:147]
ds_read_b64 a[142:143], v164 offset:1672
v_mfma_f32_16x16x32_bf16 v[148:151], a[164:167], a[240:243], v[148:151]
ds_read_b128 a[208:211], v165 offset:1664
v_mfma_f32_16x16x32_bf16 v[152:155], a[164:167], a[244:247], v[152:155]
ds_read_b64 a[144:145], v164 offset:2176
v_mfma_f32_16x16x32_bf16 v[156:159], a[164:167], a[248:251], v[156:159]
ds_read_b64 a[146:147], v164 offset:2184
v_mfma_f32_16x16x32_bf16 v[136:139], a[168:171], a[224:227], v[136:139]
ds_read_b128 a[212:215], v165 offset:1152
v_mfma_f32_16x16x32_bf16 v[140:143], a[168:171], a[228:231], v[140:143]
ds_read_b64 a[148:149], v164 offset:2688
v_mfma_f32_16x16x32_bf16 v[144:147], a[168:171], a[232:235], v[144:147]
ds_read_b64 a[150:151], v164 offset:2696
v_mfma_f32_16x16x32_bf16 v[148:151], a[168:171], a[236:239], v[148:151]
ds_read_b128 a[216:219], v165 offset:640
v_mfma_f32_16x16x32_bf16 v[152:155], a[168:171], a[240:243], v[152:155]
ds_read_b64 a[152:153], v164 offset:3200
v_mfma_f32_16x16x32_bf16 v[156:159], a[168:171], a[244:247], v[156:159]
ds_read_b64 a[154:155], v164 offset:3208
v_mfma_f32_16x16x32_bf16 v[140:143], a[172:175], a[224:227], v[140:143]
ds_read_b128 a[220:223], v165 offset:128
v_mfma_f32_16x16x32_bf16 v[144:147], a[172:175], a[228:231], v[144:147]
ds_read_b64 a[156:157], v164 offset:3712
v_mfma_f32_16x16x32_bf16 v[148:151], a[172:175], a[232:235], v[148:151]
ds_read_b64 a[158:159], v164 offset:3720
v_mfma_f32_16x16x32_bf16 v[152:155], a[172:175], a[236:239], v[152:155]
buffer_load_dwordx4 v4, s[24:27], s72 offen offset:3072 lds
v_mfma_f32_16x16x32_bf16 v[156:159], a[172:175], a[240:243], v[156:159]
v_mfma_f32_16x16x32_bf16 v[144:147], a[176:179], a[224:227], v[144:147]
v_mfma_f32_16x16x32_bf16 v[148:151], a[176:179], a[228:231], v[148:151]
v_mfma_f32_16x16x32_bf16 v[152:155], a[176:179], a[232:235], v[152:155]
s_add_u32 s71, s61, 2
v_mfma_f32_16x16x32_bf16 v[156:159], a[176:179], a[236:239], v[156:159]
s_and_b32 s71, s71, 3
v_mfma_f32_16x16x32_bf16 v[148:151], a[180:183], a[224:227], v[148:151]
s_lshl_b32 s71, s71, 18
v_mfma_f32_16x16x32_bf16 v[152:155], a[180:183], a[228:231], v[152:155]
s_add_u32 s71, s71, s94
v_mfma_f32_16x16x32_bf16 v[156:159], a[180:183], a[232:235], v[156:159]
s_add_u32 m0, s64, 131072
v_mfma_f32_16x16x32_bf16 v[152:155], a[184:187], a[224:227], v[152:155]
s_add_u32 s72, s71, 0
buffer_load_dwordx4 v4, s[24:27], s72 offen lds
v_mfma_f32_16x16x32_bf16 v[156:159], a[184:187], a[228:231], v[156:159]
v_mfma_f32_16x16x32_bf16 v[156:159], a[188:191], a[224:227], v[156:159]
s_waitcnt lgkmcnt(0)
v_mfma_f32_16x16x32_bf16 v[128:131], a[128:131], a[192:195], v[128:131]
ds_read_b128 a[224:227], v165 offset:3776
v_mfma_f32_16x16x32_bf16 v[132:135], a[128:131], a[196:199], v[132:135]
ds_read_b64 a[160:161], v164 offset:192
v_mfma_f32_16x16x32_bf16 v[136:139], a[128:131], a[200:203], v[136:139]
ds_read_b64 a[162:163], v164 offset:200
v_mfma_f32_16x16x32_bf16 v[140:143], a[128:131], a[204:207], v[140:143]
ds_read_b128 a[228:231], v165 offset:3264
v_mfma_f32_16x16x32_bf16 v[144:147], a[128:131], a[208:211], v[144:147]
ds_read_b64 a[164:165], v164 offset:704
v_mfma_f32_16x16x32_bf16 v[148:151], a[128:131], a[212:215], v[148:151]
ds_read_b64 a[166:167], v164 offset:712
v_mfma_f32_16x16x32_bf16 v[152:155], a[128:131], a[216:219], v[152:155]
ds_read_b128 a[232:235], v165 offset:2752
v_mfma_f32_16x16x32_bf16 v[156:159], a[128:131], a[220:223], v[156:159]
ds_read_b64 a[168:169], v164 offset:1216
v_mfma_f32_16x16x32_bf16 v[132:135], a[132:135], a[192:195], v[132:135]
ds_read_b64 a[170:171], v164 offset:1224
v_mfma_f32_16x16x32_bf16 v[136:139], a[132:135], a[196:199], v[136:139]
ds_read_b128 a[236:239], v165 offset:2240
v_mfma_f32_16x16x32_bf16 v[140:143], a[132:135], a[200:203], v[140:143]
s_add_u32 s72, s71, 15360
ds_read_b64 a[172:173], v164 offset:1728
v_mfma_f32_16x16x32_bf16 v[144:147], a[132:135], a[204:207], v[144:147]
ds_read_b64 a[174:175], v164 offset:1736
v_mfma_f32_16x16x32_bf16 v[148:151], a[132:135], a[208:211], v[148:151]
ds_read_b128 a[240:243], v165 offset:1728
v_mfma_f32_16x16x32_bf16 v[152:155], a[132:135], a[212:215], v[152:155]
ds_read_b64 a[176:177], v164 offset:2240
v_mfma_f32_16x16x32_bf16 v[156:159], a[132:135], a[216:219], v[156:159]
ds_read_b64 a[178:179], v164 offset:2248
v_mfma_f32_16x16x32_bf16 v[136:139], a[136:139], a[192:195], v[136:139]
ds_read_b128 a[244:247], v165 offset:1216
v_mfma_f32_16x16x32_bf16 v[140:143], a[136:139], a[196:199], v[140:143]
ds_read_b64 a[180:181], v164 offset:2752
v_mfma_f32_16x16x32_bf16 v[144:147], a[136:139], a[200:203], v[144:147]
ds_read_b64 a[182:183], v164 offset:2760
v_mfma_f32_16x16x32_bf16 v[148:151], a[136:139], a[204:207], v[148:151]
ds_read_b128 a[248:251], v165 offset:704
v_mfma_f32_16x16x32_bf16 v[152:155], a[136:139], a[208:211], v[152:155]
ds_read_b64 a[184:185], v164 offset:3264
v_mfma_f32_16x16x32_bf16 v[156:159], a[136:139], a[212:215], v[156:159]
ds_read_b64 a[186:187], v164 offset:3272
v_mfma_f32_16x16x32_bf16 v[140:143], a[140:143], a[192:195], v[140:143]
ds_read_b128 a[252:255], v165 offset:192
v_mfma_f32_16x16x32_bf16 v[144:147], a[140:143], a[196:199], v[144:147]
ds_read_b64 a[188:189], v164 offset:3776
v_mfma_f32_16x16x32_bf16 v[148:151], a[140:143], a[200:203], v[148:151]
ds_read_b64 a[190:191], v164 offset:3784
v_mfma_f32_16x16x32_bf16 v[152:155], a[140:143], a[204:207], v[152:155]
buffer_load_dwordx4 v4, s[24:27], s72 offen offset:1024 lds
v_mfma_f32_16x16x32_bf16 v[156:159], a[140:143], a[208:211], v[156:159]
v_mfma_f32_16x16x32_bf16 v[144:147], a[144:147], a[192:195], v[144:147]
v_mfma_f32_16x16x32_bf16 v[148:151], a[144:147], a[196:199], v[148:151]
v_mfma_f32_16x16x32_bf16 v[152:155], a[144:147], a[200:203], v[152:155]
s_add_u32 s72, s71, 30720
buffer_load_dwordx4 v4, s[24:27], s72 offen offset:2048 lds
v_mfma_f32_16x16x32_bf16 v[156:159], a[144:147], a[204:207], v[156:159]
v_mfma_f32_16x16x32_bf16 v[148:151], a[148:151], a[192:195], v[148:151]
v_mfma_f32_16x16x32_bf16 v[152:155], a[148:151], a[196:199], v[152:155]
v_mfma_f32_16x16x32_bf16 v[156:159], a[148:151], a[200:203], v[156:159]
v_mfma_f32_16x16x32_bf16 v[152:155], a[152:155], a[192:195], v[152:155]
s_waitcnt vmcnt(7)
v_mfma_f32_16x16x32_bf16 v[156:159], a[152:155], a[196:199], v[156:159]
s_barrier
v_mfma_f32_16x16x32_bf16 v[156:159], a[156:159], a[192:195], v[156:159]
s_waitcnt lgkmcnt(0)
v_mfma_f32_16x16x32_bf16 v[128:131], a[160:163], a[224:227], v[128:131]
ds_read_b128 a[192:195], v165 offset:3840
v_mov_b32 v244, 90112
v_mfma_f32_16x16x32_bf16 v[132:135], a[160:163], a[228:231], v[132:135]
ds_read_b64 a[128:129], v164 offset:256
ds_read_b128 v[240:243], v244
v_mfma_f32_16x16x32_bf16 v[136:139], a[160:163], a[232:235], v[136:139]
ds_read_b64 a[130:131], v164 offset:264
v_mfma_f32_16x16x32_bf16 v[140:143], a[160:163], a[236:239], v[140:143]
ds_read_b128 a[196:199], v165 offset:3328
v_mfma_f32_16x16x32_bf16 v[144:147], a[160:163], a[240:243], v[144:147]
ds_read_b64 a[132:133], v164 offset:768
v_mfma_f32_16x16x32_bf16 v[148:151], a[160:163], a[244:247], v[148:151]
ds_read_b64 a[134:135], v164 offset:776
v_mfma_f32_16x16x32_bf16 v[152:155], a[160:163], a[248:251], v[152:155]
ds_read_b128 a[200:203], v165 offset:2816
v_mfma_f32_16x16x32_bf16 v[156:159], a[160:163], a[252:255], v[156:159]
ds_read_b64 a[136:137], v164 offset:1280
v_mfma_f32_16x16x32_bf16 v[132:135], a[164:167], a[224:227], v[132:135]
ds_read_b64 a[138:139], v164 offset:1288
v_mfma_f32_16x16x32_bf16 v[136:139], a[164:167], a[228:231], v[136:139]
s_waitcnt lgkmcnt(7)
ds_read_b128 a[204:207], v165 offset:2304
v_or3_b32 v240, v240, v241, v242
v_mfma_f32_16x16x32_bf16 v[140:143], a[164:167], a[232:235], v[140:143]
s_add_u32 s72, s71, 46080
ds_read_b64 a[140:141], v164 offset:1792
v_or_b32 v240, v240, v243
v_mfma_f32_16x16x32_bf16 v[144:147], a[164:167], a[236:239], v[144:147]
ds_read_b64 a[142:143], v164 offset:1800
v_cmp_lt_u32 vcc, s86, v240
s_cbranch_vccnz Lslow
v_mfma_f32_16x16x32_bf16 v[148:151], a[164:167], a[240:243], v[148:151]
ds_read_b128 a[208:211], v165 offset:1792
v_or_b32 v240, s58, v0
v_mfma_f32_16x16x32_bf16 v[152:155], a[164:167], a[244:247], v[152:155]
ds_read_b64 a[144:145], v164 offset:2304
v_mov_b32 v241, 2
v_mfma_f32_16x16x32_bf16 v[156:159], a[164:167], a[248:251], v[156:159]
ds_read_b64 a[146:147], v164 offset:2312
v_min_u32 v240, 1, v240
v_mfma_f32_16x16x32_bf16 v[136:139], a[168:171], a[224:227], v[136:139]
ds_read_b128 a[212:215], v165 offset:1280
v_lshlrev_b32 v240, 30, v240
v_mfma_f32_16x16x32_bf16 v[140:143], a[168:171], a[228:231], v[140:143]
ds_read_b64 a[148:149], v164 offset:2816
v_mfma_f32_16x16x32_bf16 v[144:147], a[168:171], a[232:235], v[144:147]
ds_read_b64 a[150:151], v164 offset:2824
v_mfma_f32_16x16x32_bf16 v[148:151], a[168:171], a[236:239], v[148:151]
ds_read_b128 a[216:219], v165 offset:768
v_mfma_f32_16x16x32_bf16 v[152:155], a[168:171], a[240:243], v[152:155]
ds_read_b64 a[152:153], v164 offset:3328
v_mfma_f32_16x16x32_bf16 v[156:159], a[168:171], a[244:247], v[156:159]
ds_read_b64 a[154:155], v164 offset:3336
v_mfma_f32_16x16x32_bf16 v[140:143], a[172:175], a[224:227], v[140:143]
ds_read_b128 a[220:223], v165 offset:256
v_mfma_f32_16x16x32_bf16 v[144:147], a[172:175], a[228:231], v[144:147]
ds_read_b64 a[156:157], v164 offset:3840
v_mfma_f32_16x16x32_bf16 v[148:151], a[172:175], a[232:235], v[148:151]
ds_read_b64 a[158:159], v164 offset:3848
v_mfma_f32_16x16x32_bf16 v[152:155], a[172:175], a[236:239], v[152:155]
buffer_store_dword v241, v240, s[44:47], s91 offen sc1
v_mfma_f32_16x16x32_bf16 v[156:159], a[172:175], a[240:243], v[156:159]
v_and_b32 v112, 15, v0
v_lshrrev_b32 v113, 2, v0
v_mfma_f32_16x16x32_bf16 v[144:147], a[176:179], a[224:227], v[144:147]
v_bfe_u32 v114, v0, 3, 2
v_and_b32 v115, 3, v0
v_mfma_f32_16x16x32_bf16 v[148:151], a[176:179], a[228:231], v[148:151]
v_lshlrev_b32 v8, 7, v113
v_lshl_add_u32 v8, v114, 5, v8
v_mfma_f32_16x16x32_bf16 v[152:155], a[176:179], a[232:235], v[152:155]
v_lshl_add_u32 v8, v115, 3, v8
v_add_u32 v8, 98304, v8
v_mfma_f32_16x16x32_bf16 v[156:159], a[176:179], a[236:239], v[156:159]
v_xor_b32 v9, 32, v8
v_xor_b32 v10, 64, v8
v_mfma_f32_16x16x32_bf16 v[148:151], a[180:183], a[224:227], v[148:151]
v_xor_b32 v11, 0x60, v8
v_lshlrev_b32 v5, 8, v113
v_mfma_f32_16x16x32_bf16 v[152:155], a[180:183], a[228:231], v[152:155]
v_lshl_add_u32 v5, v115, 6, v5
v_mfma_f32_16x16x32_bf16 v[156:159], a[180:183], a[232:235], v[156:159]
s_lshl_b32 s73, s58, 4
buffer_load_dwordx4 v4, s[24:27], s72 offen offset:3072 lds
v_mfma_f32_16x16x32_bf16 v[152:155], a[184:187], a[224:227], v[152:155]
s_add_u32 s73, s73, 0x4000
v_add_u32 v5, s73, v5
v_bfe_u32 v114, v0, 1, 2
v_mfma_f32_16x16x32_bf16 v[156:159], a[184:187], a[228:231], v[156:159]
s_add_u32 s71, s61, 3
v_lshrrev_b32 v115, 4, v0
v_lshlrev_b32 v12, 7, v112
v_mfma_f32_16x16x32_bf16 v[156:159], a[188:191], a[224:227], v[156:159]
s_waitcnt lgkmcnt(0)
v_lshl_add_u32 v12, v114, 5, v12
v_lshl_add_u32 v12, v115, 3, v12
v_mfma_f32_16x16x32_bf16 v[128:131], a[128:131], a[192:195], v[128:131]
s_and_b32 s71, s71, 3
ds_read_b128 a[224:227], v165 offset:3904
v_add_u32 v12, s64, v12
v_mfma_f32_16x16x32_bf16 v[132:135], a[128:131], a[196:199], v[132:135]
s_lshl_b32 s71, s71, 18
ds_read_b64 a[160:161], v164 offset:320
v_xor_b32 v13, 32, v12
v_mfma_f32_16x16x32_bf16 v[136:139], a[128:131], a[200:203], v[136:139]
s_add_u32 s71, s71, s94
ds_read_b64 a[162:163], v164 offset:328
v_xor_b32 v14, 64, v12
v_mfma_f32_16x16x32_bf16 v[140:143], a[128:131], a[204:207], v[140:143]
s_add_u32 m0, s64, 147456
ds_read_b128 a[228:231], v165 offset:3392
v_xor_b32 v15, 0x60, v12
v_mfma_f32_16x16x32_bf16 v[144:147], a[128:131], a[208:211], v[144:147]
s_add_u32 s72, s71, 0
ds_read_b64 a[164:165], v164 offset:832
v_mfma_f32_16x16x32_bf16 v[148:151], a[128:131], a[212:215], v[148:151]
ds_read_b64 a[166:167], v164 offset:840
v_mfma_f32_16x16x32_bf16 v[152:155], a[128:131], a[216:219], v[152:155]
ds_read_b128 a[232:235], v165 offset:2880
v_mfma_f32_16x16x32_bf16 v[156:159], a[128:131], a[220:223], v[156:159]
ds_read_b64 a[168:169], v164 offset:1344
v_mfma_f32_16x16x32_bf16 v[132:135], a[132:135], a[192:195], v[132:135]
ds_read_b64 a[170:171], v164 offset:1352
v_mfma_f32_16x16x32_bf16 v[136:139], a[132:135], a[196:199], v[136:139]
ds_read_b128 a[236:239], v165 offset:2368
v_mfma_f32_16x16x32_bf16 v[140:143], a[132:135], a[200:203], v[140:143]
ds_read_b64 a[172:173], v164 offset:1856
v_mfma_f32_16x16x32_bf16 v[144:147], a[132:135], a[204:207], v[144:147]
ds_read_b64 a[174:175], v164 offset:1864
v_mfma_f32_16x16x32_bf16 v[148:151], a[132:135], a[208:211], v[148:151]
ds_read_b128 a[240:243], v165 offset:1856
v_mfma_f32_16x16x32_bf16 v[152:155], a[132:135], a[212:215], v[152:155]
ds_read_b64 a[176:177], v164 offset:2368
v_mfma_f32_16x16x32_bf16 v[156:159], a[132:135], a[216:219], v[156:159]
ds_read_b64 a[178:179], v164 offset:2376
v_mfma_f32_16x16x32_bf16 v[136:139], a[136:139], a[192:195], v[136:139]
ds_read_b128 a[244:247], v165 offset:1344
v_mfma_f32_16x16x32_bf16 v[140:143], a[136:139], a[196:199], v[140:143]
ds_read_b64 a[180:181], v164 offset:2880
v_mfma_f32_16x16x32_bf16 v[144:147], a[136:139], a[200:203], v[144:147]
ds_read_b64 a[182:183], v164 offset:2888
v_mfma_f32_16x16x32_bf16 v[148:151], a[136:139], a[204:207], v[148:151]
ds_read_b128 a[248:251], v165 offset:832
v_mfma_f32_16x16x32_bf16 v[152:155], a[136:139], a[208:211], v[152:155]
ds_read_b64 a[184:185], v164 offset:3392
v_mfma_f32_16x16x32_bf16 v[156:159], a[136:139], a[212:215], v[156:159]
ds_read_b64 a[186:187], v164 offset:3400
v_mfma_f32_16x16x32_bf16 v[140:143], a[140:143], a[192:195], v[140:143]
ds_read_b128 a[252:255], v165 offset:320
v_mfma_f32_16x16x32_bf16 v[144:147], a[140:143], a[196:199], v[144:147]
ds_read_b64 a[188:189], v164 offset:3904
v_mfma_f32_16x16x32_bf16 v[148:151], a[140:143], a[200:203], v[148:151]
ds_read_b64 a[190:191], v164 offset:3912
v_mfma_f32_16x16x32_bf16 v[152:155], a[140:143], a[204:207], v[152:155]
buffer_load_dwordx4 v4, s[24:27], s72 offen lds
v_mfma_f32_16x16x32_bf16 v[156:159], a[140:143], a[208:211], v[156:159]
s_add_u32 s72, s71, 15360
buffer_load_dwordx4 v4, s[24:27], s72 offen offset:1024 lds
v_mfma_f32_16x16x32_bf16 v[144:147], a[144:147], a[192:195], v[144:147]
v_mfma_f32_16x16x32_bf16 v[148:151], a[144:147], a[196:199], v[148:151]
v_mfma_f32_16x16x32_bf16 v[152:155], a[144:147], a[200:203], v[152:155]
s_add_u32 s72, s71, 30720
buffer_load_dwordx4 v4, s[24:27], s72 offen offset:2048 lds
v_mfma_f32_16x16x32_bf16 v[156:159], a[144:147], a[204:207], v[156:159]
v_mfma_f32_16x16x32_bf16 v[148:151], a[148:151], a[192:195], v[148:151]
v_mfma_f32_16x16x32_bf16 v[152:155], a[148:151], a[196:199], v[152:155]
v_mfma_f32_16x16x32_bf16 v[156:159], a[148:151], a[200:203], v[156:159]
v_mfma_f32_16x16x32_bf16 v[152:155], a[152:155], a[192:195], v[152:155]
v_mfma_f32_16x16x32_bf16 v[156:159], a[152:155], a[196:199], v[156:159]
v_mfma_f32_16x16x32_bf16 v[156:159], a[156:159], a[192:195], v[156:159]
s_waitcnt lgkmcnt(0)
v_mfma_f32_16x16x32_bf16 v[128:131], a[160:163], a[224:227], v[128:131]
ds_read_b128 a[192:195], v165 offset:3968
v_mfma_f32_16x16x32_bf16 v[132:135], a[160:163], a[228:231], v[132:135]
ds_read_b64 a[128:129], v164 offset:384
v_mfma_f32_16x16x32_bf16 v[136:139], a[160:163], a[232:235], v[136:139]
ds_read_b64 a[130:131], v164 offset:392
v_mfma_f32_16x16x32_bf16 v[140:143], a[160:163], a[236:239], v[140:143]
ds_read_b128 a[196:199], v165 offset:3456
v_mfma_f32_16x16x32_bf16 v[144:147], a[160:163], a[240:243], v[144:147]
ds_read_b64 a[132:133], v164 offset:896
v_mfma_f32_16x16x32_bf16 v[148:151], a[160:163], a[244:247], v[148:151]
ds_read_b64 a[134:135], v164 offset:904
v_mfma_f32_16x16x32_bf16 v[152:155], a[160:163], a[248:251], v[152:155]
ds_read_b128 a[200:203], v165 offset:2944
v_mfma_f32_16x16x32_bf16 v[156:159], a[160:163], a[252:255], v[156:159]
ds_read_b64 a[136:137], v164 offset:1408
v_mfma_f32_16x16x32_bf16 v[132:135], a[164:167], a[224:227], v[132:135]
ds_read_b64 a[138:139], v164 offset:1416
v_mfma_f32_16x16x32_bf16 v[136:139], a[164:167], a[228:231], v[136:139]
ds_read_b128 a[204:207], v165 offset:2432
v_mfma_f32_16x16x32_bf16 v[140:143], a[164:167], a[232:235], v[140:143]
s_add_u32 s72, s71, 46080
ds_read_b64 a[140:141], v164 offset:1920
v_mfma_f32_16x16x32_bf16 v[144:147], a[164:167], a[236:239], v[144:147]
ds_read_b64 a[142:143], v164 offset:1928
v_mfma_f32_16x16x32_bf16 v[148:151], a[164:167], a[240:243], v[148:151]
ds_read_b128 a[208:211], v165 offset:1920
v_mfma_f32_16x16x32_bf16 v[152:155], a[164:167], a[244:247], v[152:155]
ds_read_b64 a[144:145], v164 offset:2432
v_mfma_f32_16x16x32_bf16 v[156:159], a[164:167], a[248:251], v[156:159]
ds_read_b64 a[146:147], v164 offset:2440
v_mfma_f32_16x16x32_bf16 v[136:139], a[168:171], a[224:227], v[136:139]
ds_read_b128 a[212:215], v165 offset:1408
v_mfma_f32_16x16x32_bf16 v[140:143], a[168:171], a[228:231], v[140:143]
ds_read_b64 a[148:149], v164 offset:2944
v_mfma_f32_16x16x32_bf16 v[144:147], a[168:171], a[232:235], v[144:147]
ds_read_b64 a[150:151], v164 offset:2952
v_mfma_f32_16x16x32_bf16 v[148:151], a[168:171], a[236:239], v[148:151]
ds_read_b128 a[216:219], v165 offset:896
v_mfma_f32_16x16x32_bf16 v[152:155], a[168:171], a[240:243], v[152:155]
ds_read_b64 a[152:153], v164 offset:3456
v_mfma_f32_16x16x32_bf16 v[156:159], a[168:171], a[244:247], v[156:159]
ds_read_b64 a[154:155], v164 offset:3464
v_mfma_f32_16x16x32_bf16 v[140:143], a[172:175], a[224:227], v[140:143]
ds_read_b128 a[220:223], v165 offset:384
v_mfma_f32_16x16x32_bf16 v[144:147], a[172:175], a[228:231], v[144:147]
ds_read_b64 a[156:157], v164 offset:3968
v_mfma_f32_16x16x32_bf16 v[148:151], a[172:175], a[232:235], v[148:151]
ds_read_b64 a[158:159], v164 offset:3976
v_mfma_f32_16x16x32_bf16 v[152:155], a[172:175], a[236:239], v[152:155]
buffer_load_dwordx4 v4, s[24:27], s72 offen offset:3072 lds
v_mfma_f32_16x16x32_bf16 v[156:159], a[172:175], a[240:243], v[156:159]
v_mfma_f32_16x16x32_bf16 v[144:147], a[176:179], a[224:227], v[144:147]
v_mfma_f32_16x16x32_bf16 v[148:151], a[176:179], a[228:231], v[148:151]
v_mfma_f32_16x16x32_bf16 v[152:155], a[176:179], a[232:235], v[152:155]
v_mfma_f32_16x16x32_bf16 v[156:159], a[176:179], a[236:239], v[156:159]
v_mfma_f32_16x16x32_bf16 v[148:151], a[180:183], a[224:227], v[148:151]
v_mfma_f32_16x16x32_bf16 v[152:155], a[180:183], a[228:231], v[152:155]
v_mfma_f32_16x16x32_bf16 v[156:159], a[180:183], a[232:235], v[156:159]
v_mfma_f32_16x16x32_bf16 v[152:155], a[184:187], a[224:227], v[152:155]
v_mfma_f32_16x16x32_bf16 v[156:159], a[184:187], a[228:231], v[156:159]
v_mfma_f32_16x16x32_bf16 v[156:159], a[188:191], a[224:227], v[156:159]
s_waitcnt lgkmcnt(0)
v_mfma_f32_16x16x32_bf16 v[128:131], a[128:131], a[192:195], v[128:131]
s_add_u32 s80, s93, 0x3400000
ds_read_b128 a[224:227], v165 offset:4032
v_mfma_f32_16x16x32_bf16 v[132:135], a[128:131], a[196:199], v[132:135]
s_sub_u32 s74, 15, s75
ds_read_b64 a[160:161], v164 offset:448
v_mfma_f32_16x16x32_bf16 v[136:139], a[128:131], a[200:203], v[136:139]
s_min_u32 s74, s74, s75
ds_read_b64 a[162:163], v164 offset:456
v_mfma_f32_16x16x32_bf16 v[140:143], a[128:131], a[204:207], v[140:143]
s_lshl_b32 s74, s74, 7
ds_read_b128 a[228:231], v165 offset:3520
v_mfma_f32_16x16x32_bf16 v[144:147], a[128:131], a[208:211], v[144:147]
s_add_u32 s74, s74, 0x3810000
ds_read_b64 a[164:165], v164 offset:960
v_and_b32 v2, 31, v0
v_mfma_f32_16x16x32_bf16 v[148:151], a[128:131], a[212:215], v[148:151]
ds_read_b64 a[166:167], v164 offset:968
v_lshlrev_b32 v2, 10, v2
v_mfma_f32_16x16x32_bf16 v[152:155], a[128:131], a[216:219], v[152:155]
ds_read_b128 a[232:235], v165 offset:3008
v_mfma_f32_16x16x32_bf16 v[156:159], a[128:131], a[220:223], v[156:159]
ds_read_b64 a[168:169], v164 offset:1472
v_mfma_f32_16x16x32_bf16 v[132:135], a[132:135], a[192:195], v[132:135]
ds_read_b64 a[170:171], v164 offset:1480
v_mfma_f32_16x16x32_bf16 v[136:139], a[132:135], a[196:199], v[136:139]
ds_read_b128 a[236:239], v165 offset:2496
v_mfma_f32_16x16x32_bf16 v[140:143], a[132:135], a[200:203], v[140:143]
ds_read_b64 a[172:173], v164 offset:1984
v_mfma_f32_16x16x32_bf16 v[144:147], a[132:135], a[204:207], v[144:147]
ds_read_b64 a[174:175], v164 offset:1992
v_mfma_f32_16x16x32_bf16 v[148:151], a[132:135], a[208:211], v[148:151]
ds_read_b128 a[240:243], v165 offset:1984
v_mfma_f32_16x16x32_bf16 v[152:155], a[132:135], a[212:215], v[152:155]
ds_read_b64 a[176:177], v164 offset:2496
v_mfma_f32_16x16x32_bf16 v[156:159], a[132:135], a[216:219], v[156:159]
ds_read_b64 a[178:179], v164 offset:2504
v_mfma_f32_16x16x32_bf16 v[136:139], a[136:139], a[192:195], v[136:139]
ds_read_b128 a[244:247], v165 offset:1472
v_mfma_f32_16x16x32_bf16 v[140:143], a[136:139], a[196:199], v[140:143]
ds_read_b64 a[180:181], v164 offset:3008
v_mfma_f32_16x16x32_bf16 v[144:147], a[136:139], a[200:203], v[144:147]
ds_read_b64 a[182:183], v164 offset:3016
v_mfma_f32_16x16x32_bf16 v[148:151], a[136:139], a[204:207], v[148:151]
ds_read_b128 a[248:251], v165 offset:960
v_mfma_f32_16x16x32_bf16 v[152:155], a[136:139], a[208:211], v[152:155]
ds_read_b64 a[184:185], v164 offset:3520
v_mfma_f32_16x16x32_bf16 v[156:159], a[136:139], a[212:215], v[156:159]
ds_read_b64 a[186:187], v164 offset:3528
v_mfma_f32_16x16x32_bf16 v[140:143], a[140:143], a[192:195], v[140:143]
ds_read_b128 a[252:255], v165 offset:448
v_mfma_f32_16x16x32_bf16 v[144:147], a[140:143], a[196:199], v[144:147]
ds_read_b64 a[188:189], v164 offset:4032
v_mfma_f32_16x16x32_bf16 v[148:151], a[140:143], a[200:203], v[148:151]
ds_read_b64 a[190:191], v164 offset:4040
v_mfma_f32_16x16x32_bf16 v[152:155], a[140:143], a[204:207], v[152:155]
buffer_load_dword v3, v2, s[44:47], s74 offen sc1
v_mfma_f32_16x16x32_bf16 v[156:159], a[140:143], a[208:211], v[156:159]
v_mfma_f32_16x16x32_bf16 v[144:147], a[144:147], a[192:195], v[144:147]
v_mfma_f32_16x16x32_bf16 v[148:151], a[144:147], a[196:199], v[148:151]
v_mfma_f32_16x16x32_bf16 v[152:155], a[144:147], a[200:203], v[152:155]
v_mfma_f32_16x16x32_bf16 v[156:159], a[144:147], a[204:207], v[156:159]
v_mfma_f32_16x16x32_bf16 v[148:151], a[148:151], a[192:195], v[148:151]
v_mfma_f32_16x16x32_bf16 v[152:155], a[148:151], a[196:199], v[152:155]
v_mfma_f32_16x16x32_bf16 v[156:159], a[148:151], a[200:203], v[156:159]
v_mfma_f32_16x16x32_bf16 v[152:155], a[152:155], a[192:195], v[152:155]
v_mfma_f32_16x16x32_bf16 v[156:159], a[152:155], a[196:199], v[156:159]
v_mfma_f32_16x16x32_bf16 v[156:159], a[156:159], a[192:195], v[156:159]
s_waitcnt lgkmcnt(0)
s_waitcnt vmcnt(0)
v_cmp_gt_u32 vcc, 2, v3
s_cbranch_vccnz Lspin60
Lback61:
v_mfma_f32_16x16x32_bf16 v[128:131], a[160:163], a[224:227], v[128:131]
s_add_u32 s69, s61, 0
ds_read_b64_tr_b16 v[192:193], v8 offset:0
v_mfma_f32_16x16x32_bf16 v[132:135], a[160:163], a[228:231], v[132:135]
s_and_b32 s69, s69, 3
ds_read_b64_tr_b16 v[194:195], v8 offset:2048
v_mfma_f32_16x16x32_bf16 v[136:139], a[160:163], a[232:235], v[136:139]
s_lshl_b32 s69, s69, 12
ds_read_b64_tr_b16 v[196:197], v9 offset:0
v_mfma_f32_16x16x32_bf16 v[140:143], a[160:163], a[236:239], v[140:143]
s_add_u32 s69, s69, s95
ds_read_b64_tr_b16 v[198:199], v9 offset:2048
buffer_load_dwordx4 a[0:3], v1, s[44:47], s69 offen sc1
v_mfma_f32_16x16x32_bf16 v[144:147], a[160:163], a[240:243], v[144:147]
ds_read_b64_tr_b16 v[200:201], v10 offset:0
buffer_load_dwordx4 a[4:7], v1, s[44:47], s69 offen offset:1024 sc1
v_mfma_f32_16x16x32_bf16 v[148:151], a[160:163], a[244:247], v[148:151]
ds_read_b64_tr_b16 v[202:203], v10 offset:2048
v_cvt_pk_bf16_f32 v128, v128, v129
v_cvt_pk_bf16_f32 v129, v130, v131
v_mfma_f32_16x16x32_bf16 v[152:155], a[160:163], a[248:251], v[152:155]
ds_read_b64_tr_b16 v[204:205], v11 offset:0
buffer_store_dwordx2 v[128:129], v166, s[44:47], s80 offen sc1
v_mfma_f32_16x16x32_bf16 v[156:159], a[160:163], a[252:255], v[156:159]
ds_read_b64_tr_b16 v[206:207], v11 offset:2048
buffer_load_dwordx4 a[8:11], v1, s[44:47], s69 offen offset:2048 sc1
v_mfma_f32_16x16x32_bf16 v[132:135], a[164:167], a[224:227], v[132:135]
ds_read_b64_tr_b16 v[208:209], v8 offset:4096
buffer_load_dwordx4 a[12:15], v1, s[44:47], s69 offen offset:3072 sc1
v_mfma_f32_16x16x32_bf16 v[136:139], a[164:167], a[228:231], v[136:139]
s_add_u32 s69, s69, 0x20000
ds_read_b64_tr_b16 v[210:211], v8 offset:6144
buffer_load_dwordx4 a[16:19], v1, s[44:47], s69 offen sc1
v_mfma_f32_16x16x32_bf16 v[140:143], a[164:167], a[232:235], v[140:143]
ds_read_b64_tr_b16 v[212:213], v9 offset:4096
buffer_load_dwordx4 a[20:23], v1, s[44:47], s69 offen offset:1024 sc1
v_mfma_f32_16x16x32_bf16 v[144:147], a[164:167], a[236:239], v[144:147]
ds_read_b64_tr_b16 v[214:215], v9 offset:6144
buffer_load_dwordx4 a[24:27], v1, s[44:47], s69 offen offset:2048 sc1
v_mfma_f32_16x16x32_bf16 v[148:151], a[164:167], a[240:243], v[148:151]
ds_read_b64_tr_b16 v[216:217], v10 offset:4096
buffer_load_dwordx4 a[28:31], v1, s[44:47], s69 offen offset:3072 sc1
v_mfma_f32_16x16x32_bf16 v[152:155], a[164:167], a[244:247], v[152:155]
s_add_u32 s69, s61, 1
ds_read_b64_tr_b16 v[218:219], v10 offset:6144
v_cvt_pk_bf16_f32 v132, v132, v133
v_cvt_pk_bf16_f32 v133, v134, v135
v_mfma_f32_16x16x32_bf16 v[156:159], a[164:167], a[248:251], v[156:159]
s_and_b32 s69, s69, 3
ds_read_b64_tr_b16 v[220:221], v11 offset:4096
buffer_store_dwordx2 v[132:133], v166, s[44:47], s80 offen offset:512 sc1
v_mfma_f32_16x16x32_bf16 v[136:139], a[168:171], a[224:227], v[136:139]
s_lshl_b32 s69, s69, 12
ds_read_b64_tr_b16 v[222:223], v11 offset:6144
v_mfma_f32_16x16x32_bf16 v[140:143], a[168:171], a[228:231], v[140:143]
s_add_u32 s69, s69, s95
ds_read_b64_tr_b16 v[224:225], v8 offset:8192
buffer_load_dwordx4 a[32:35], v1, s[44:47], s69 offen sc1
v_mfma_f32_16x16x32_bf16 v[144:147], a[168:171], a[232:235], v[144:147]
ds_read_b64_tr_b16 v[226:227], v8 offset:10240
buffer_load_dwordx4 a[36:39], v1, s[44:47], s69 offen offset:1024 sc1
v_mfma_f32_16x16x32_bf16 v[148:151], a[168:171], a[236:239], v[148:151]
ds_read_b64_tr_b16 v[228:229], v9 offset:8192
buffer_load_dwordx4 a[40:43], v1, s[44:47], s69 offen offset:2048 sc1
v_mfma_f32_16x16x32_bf16 v[152:155], a[168:171], a[240:243], v[152:155]
ds_read_b64_tr_b16 v[230:231], v9 offset:10240
buffer_load_dwordx4 a[44:47], v1, s[44:47], s69 offen offset:3072 sc1
v_mfma_f32_16x16x32_bf16 v[156:159], a[168:171], a[244:247], v[156:159]
s_add_u32 s69, s69, 0x20000
ds_read_b64_tr_b16 v[232:233], v10 offset:8192
v_cvt_pk_bf16_f32 v136, v136, v137
v_cvt_pk_bf16_f32 v137, v138, v139
v_mfma_f32_16x16x32_bf16 v[140:143], a[172:175], a[224:227], v[140:143]
ds_read_b64_tr_b16 v[234:235], v10 offset:10240
buffer_store_dwordx2 v[136:137], v166, s[44:47], s80 offen offset:1024 sc1
v_mfma_f32_16x16x32_bf16 v[144:147], a[172:175], a[228:231], v[144:147]
ds_read_b64_tr_b16 v[236:237], v11 offset:8192
buffer_load_dwordx4 a[48:51], v1, s[44:47], s69 offen sc1
v_mfma_f32_16x16x32_bf16 v[148:151], a[172:175], a[232:235], v[148:151]
ds_read_b64_tr_b16 v[238:239], v11 offset:10240
buffer_load_dwordx4 a[52:55], v1, s[44:47], s69 offen offset:1024 sc1
v_mfma_f32_16x16x32_bf16 v[152:155], a[172:175], a[236:239], v[152:155]
ds_read_b64_tr_b16 v[240:241], v8 offset:12288
buffer_load_dwordx4 a[56:59], v1, s[44:47], s69 offen offset:2048 sc1
v_mfma_f32_16x16x32_bf16 v[156:159], a[172:175], a[240:243], v[156:159]
ds_read_b64_tr_b16 v[242:243], v8 offset:14336
buffer_load_dwordx4 a[60:63], v1, s[44:47], s69 offen offset:3072 sc1
v_mfma_f32_16x16x32_bf16 v[144:147], a[176:179], a[224:227], v[144:147]
s_add_u32 s69, s61, 2
ds_read_b64_tr_b16 v[244:245], v9 offset:12288
v_cvt_pk_bf16_f32 v140, v140, v141
v_cvt_pk_bf16_f32 v141, v142, v143
v_mfma_f32_16x16x32_bf16 v[148:151], a[176:179], a[228:231], v[148:151]
s_and_b32 s69, s69, 3
ds_read_b64_tr_b16 v[246:247], v9 offset:14336
buffer_store_dwordx2 v[140:141], v166, s[44:47], s80 offen offset:1536 sc1
v_mfma_f32_16x16x32_bf16 v[152:155], a[176:179], a[232:235], v[152:155]
s_lshl_b32 s69, s69, 12
ds_read_b64_tr_b16 v[248:249], v10 offset:12288
v_mfma_f32_16x16x32_bf16 v[156:159], a[176:179], a[236:239], v[156:159]
s_add_u32 s69, s69, s95
ds_read_b64_tr_b16 v[250:251], v10 offset:14336
buffer_load_dwordx4 a[64:67], v1, s[44:47], s69 offen sc1
v_mfma_f32_16x16x32_bf16 v[148:151], a[180:183], a[224:227], v[148:151]
ds_read_b64_tr_b16 v[252:253], v11 offset:12288
buffer_load_dwordx4 a[68:71], v1, s[44:47], s69 offen offset:1024 sc1
v_mfma_f32_16x16x32_bf16 v[152:155], a[180:183], a[228:231], v[152:155]
ds_read_b64_tr_b16 v[254:255], v11 offset:14336
v_cvt_pk_bf16_f32 v144, v144, v145
v_cvt_pk_bf16_f32 v145, v146, v147
v_mfma_f32_16x16x32_bf16 v[156:159], a[180:183], a[232:235], v[156:159]
buffer_store_dwordx2 v[144:145], v166, s[44:47], s80 offen offset:2048 sc1
buffer_load_dwordx4 a[72:75], v1, s[44:47], s69 offen offset:2048 sc1
v_mfma_f32_16x16x32_bf16 v[152:155], a[184:187], a[224:227], v[152:155]
buffer_load_dwordx4 a[76:79], v1, s[44:47], s69 offen offset:3072 sc1
v_mfma_f32_16x16x32_bf16 v[156:159], a[184:187], a[228:231], v[156:159]
s_add_u32 s69, s69, 0x20000
buffer_load_dwordx4 a[80:83], v1, s[44:47], s69 offen sc1
buffer_load_dwordx4 a[84:87], v1, s[44:47], s69 offen offset:1024 sc1
v_mfma_f32_16x16x32_bf16 v[156:159], a[188:191], a[224:227], v[156:159]
buffer_load_dwordx4 a[88:91], v1, s[44:47], s69 offen offset:2048 sc1
buffer_load_dwordx4 a[92:95], v1, s[44:47], s69 offen offset:3072 sc1
v_cvt_pk_bf16_f32 v148, v148, v149
v_cvt_pk_bf16_f32 v149, v150, v151
buffer_store_dwordx2 v[148:149], v166, s[44:47], s80 offen offset:2560 sc1
v_cvt_pk_bf16_f32 v152, v152, v153
v_cvt_pk_bf16_f32 v153, v154, v155
buffer_store_dwordx2 v[152:153], v166, s[44:47], s80 offen offset:3072 sc1
v_cvt_pk_bf16_f32 v156, v156, v157
v_cvt_pk_bf16_f32 v157, v158, v159
buffer_store_dwordx2 v[156:157], v166, s[44:47], s80 offen offset:3584 sc1
s_waitcnt vmcnt(23) lgkmcnt(0)
s_barrier
v_mfma_f32_16x16x32_bf16 v[80:83], v[192:195], a[0:3], 0
ds_read_b64_tr_b16 v[128:129], v8 offset:16384
ds_read_b64_tr_b16 v[130:131], v8 offset:18432
s_add_u32 s71, s61, 4
s_and_b32 s71, s71, 3
s_or_b32 s71, s71, 4
s_lshl_b32 s71, s71, 18
s_add_u32 s71, s71, s94
s_add_u32 m0, s64, 98304
s_add_u32 s72, s71, 0
buffer_load_dwordx4 v4, s[24:27], s72 offen lds
v_mfma_f32_16x16x32_bf16 v[96:99], v[192:195], a[16:19], 0
ds_read_b64_tr_b16 v[132:133], v9 offset:16384
v_mfma_f32_16x16x32_bf16 v[100:103], v[196:199], a[16:19], 0
ds_read_b64_tr_b16 v[134:135], v9 offset:18432
s_add_u32 s72, s71, 15360
buffer_load_dwordx4 v4, s[24:27], s72 offen offset:1024 lds
v_mfma_f32_16x16x32_bf16 v[84:87], v[196:199], a[0:3], 0
ds_read_b64_tr_b16 v[136:137], v10 offset:16384
v_mfma_f32_16x16x32_bf16 v[88:91], v[200:203], a[0:3], 0
ds_read_b64_tr_b16 v[138:139], v10 offset:18432
ds_read_b64_tr_b16 v[140:141], v11 offset:16384
s_add_u32 s72, s71, 30720
buffer_load_dwordx4 v4, s[24:27], s72 offen offset:2048 lds
v_mfma_f32_16x16x32_bf16 v[104:107], v[200:203], a[16:19], 0
ds_read_b64_tr_b16 v[142:143], v11 offset:18432
v_mfma_f32_16x16x32_bf16 v[108:111], v[204:207], a[16:19], 0
ds_read_b64_tr_b16 v[144:145], v8 offset:20480
v_mfma_f32_16x16x32_bf16 v[92:95], v[204:207], a[0:3], 0
ds_read_b64_tr_b16 v[146:147], v8 offset:22528
s_add_u32 s72, s71, 46080
buffer_load_dwordx4 v4, s[24:27], s72 offen offset:3072 lds
v_mfma_f32_16x16x32_bf16 v[80:83], v[208:211], a[4:7], v[80:83]
ds_read_b64_tr_b16 v[148:149], v9 offset:20480
ds_read_b64_tr_b16 v[150:151], v9 offset:22528
v_mfma_f32_16x16x32_bf16 v[96:99], v[208:211], a[20:23], v[96:99]
ds_read_b64_tr_b16 v[152:153], v10 offset:20480
s_add_u32 s69, s61, 3
s_and_b32 s69, s69, 3
s_lshl_b32 s69, s69, 12
s_add_u32 s69, s69, s95
buffer_load_dwordx4 a[96:99], v1, s[44:47], s69 offen sc1
v_mfma_f32_16x16x32_bf16 v[100:103], v[212:215], a[20:23], v[100:103]
ds_read_b64_tr_b16 v[154:155], v10 offset:22528
v_mfma_f32_16x16x32_bf16 v[84:87], v[212:215], a[4:7], v[84:87]
ds_read_b64_tr_b16 v[156:157], v11 offset:20480
buffer_load_dwordx4 a[100:103], v1, s[44:47], s69 offen offset:1024 sc1
v_mfma_f32_16x16x32_bf16 v[88:91], v[216:219], a[4:7], v[88:91]
ds_read_b64_tr_b16 v[158:159], v11 offset:22528
v_mfma_f32_16x16x32_bf16 v[104:107], v[216:219], a[20:23], v[104:107]
ds_read_b64_tr_b16 v[160:161], v8 offset:24576
ds_read_b64_tr_b16 v[162:163], v8 offset:26624
v_mfma_f32_16x16x32_bf16 v[108:111], v[220:223], a[20:23], v[108:111]
ds_read_b64_tr_b16 v[164:165], v9 offset:24576
buffer_load_dwordx4 a[104:107], v1, s[44:47], s69 offen offset:2048 sc1
v_mfma_f32_16x16x32_bf16 v[92:95], v[220:223], a[4:7], v[92:95]
ds_read_b64_tr_b16 v[166:167], v9 offset:26624
v_mfma_f32_16x16x32_bf16 v[80:83], v[224:227], a[8:11], v[80:83]
ds_read_b64_tr_b16 v[168:169], v10 offset:24576
buffer_load_dwordx4 a[108:111], v1, s[44:47], s69 offen offset:3072 sc1
v_mfma_f32_16x16x32_bf16 v[96:99], v[224:227], a[24:27], v[96:99]
ds_read_b64_tr_b16 v[170:171], v10 offset:26624
ds_read_b64_tr_b16 v[172:173], v11 offset:24576
v_mfma_f32_16x16x32_bf16 v[100:103], v[228:231], a[24:27], v[100:103]
ds_read_b64_tr_b16 v[174:175], v11 offset:26624
s_add_u32 s69, s69, 0x20000
buffer_load_dwordx4 a[112:115], v1, s[44:47], s69 offen sc1
v_mfma_f32_16x16x32_bf16 v[84:87], v[228:231], a[8:11], v[84:87]
ds_read_b64_tr_b16 v[176:177], v8 offset:28672
v_mfma_f32_16x16x32_bf16 v[88:91], v[232:235], a[8:11], v[88:91]
ds_read_b64_tr_b16 v[178:179], v8 offset:30720
v_mfma_f32_16x16x32_bf16 v[104:107], v[232:235], a[24:27], v[104:107]
ds_read_b64_tr_b16 v[180:181], v9 offset:28672
ds_read_b64_tr_b16 v[182:183], v9 offset:30720
buffer_load_dwordx4 a[116:119], v1, s[44:47], s69 offen offset:1024 sc1
v_mfma_f32_16x16x32_bf16 v[108:111], v[236:239], a[24:27], v[108:111]
ds_read_b64_tr_b16 v[184:185], v10 offset:28672
v_mfma_f32_16x16x32_bf16 v[92:95], v[236:239], a[8:11], v[92:95]
ds_read_b64_tr_b16 v[186:187], v10 offset:30720
buffer_load_dwordx4 a[120:123], v1, s[44:47], s69 offen offset:2048 sc1
v_mfma_f32_16x16x32_bf16 v[80:83], v[240:243], a[12:15], v[80:83]
ds_read_b64_tr_b16 v[188:189], v11 offset:28672
v_mfma_f32_16x16x32_bf16 v[96:99], v[240:243], a[28:31], v[96:99]
ds_read_b64_tr_b16 v[190:191], v11 offset:30720
buffer_load_dwordx4 a[124:127], v1, s[44:47], s69 offen offset:3072 sc1
v_mfma_f32_16x16x32_bf16 v[100:103], v[244:247], a[28:31], v[100:103]
v_mfma_f32_16x16x32_bf16 v[84:87], v[244:247], a[12:15], v[84:87]
v_mfma_f32_16x16x32_bf16 v[88:91], v[248:251], a[12:15], v[88:91]
v_mfma_f32_16x16x32_bf16 v[104:107], v[248:251], a[28:31], v[104:107]
v_mfma_f32_16x16x32_bf16 v[108:111], v[252:255], a[28:31], v[108:111]
s_waitcnt vmcnt(25) lgkmcnt(0)
v_mfma_f32_16x16x32_bf16 v[92:95], v[252:255], a[12:15], v[92:95]
s_barrier
v_mfma_f32_16x16x32_bf16 v[80:83], v[128:131], a[32:35], v[80:83]
ds_read_b64_tr_b16 v[192:193], v8 offset:32768
ds_read_b64_tr_b16 v[194:195], v8 offset:34816
s_add_u32 s71, s61, 5
s_and_b32 s71, s71, 3
s_or_b32 s71, s71, 4
s_lshl_b32 s71, s71, 18
s_add_u32 s71, s71, s94
s_add_u32 m0, s64, 114688
s_add_u32 s72, s71, 0
buffer_load_dwordx4 v4, s[24:27], s72 offen lds
v_mfma_f32_16x16x32_bf16 v[96:99], v[128:131], a[48:51], v[96:99]
ds_read_b64_tr_b16 v[196:197], v9 offset:32768
v_mfma_f32_16x16x32_bf16 v[100:103], v[132:135], a[48:51], v[100:103]
ds_read_b64_tr_b16 v[198:199], v9 offset:34816
s_add_u32 s72, s71, 15360
buffer_load_dwordx4 v4, s[24:27], s72 offen offset:1024 lds
v_mfma_f32_16x16x32_bf16 v[84:87], v[132:135], a[32:35], v[84:87]
ds_read_b64_tr_b16 v[200:201], v10 offset:32768
v_mfma_f32_16x16x32_bf16 v[88:91], v[136:139], a[32:35], v[88:91]
ds_read_b64_tr_b16 v[202:203], v10 offset:34816
ds_read_b64_tr_b16 v[204:205], v11 offset:32768
s_add_u32 s72, s71, 30720
buffer_load_dwordx4 v4, s[24:27], s72 offen offset:2048 lds
v_mfma_f32_16x16x32_bf16 v[104:107], v[136:139], a[48:51], v[104:107]
ds_read_b64_tr_b16 v[206:207], v11 offset:34816
v_mfma_f32_16x16x32_bf16 v[108:111], v[140:143], a[48:51], v[108:111]
ds_read_b64_tr_b16 v[208:209], v8 offset:36864
v_mfma_f32_16x16x32_bf16 v[92:95], v[140:143], a[32:35], v[92:95]
ds_read_b64_tr_b16 v[210:211], v8 offset:38912
s_add_u32 s72, s71, 46080
buffer_load_dwordx4 v4, s[24:27], s72 offen offset:3072 lds
v_mfma_f32_16x16x32_bf16 v[80:83], v[144:147], a[36:39], v[80:83]
ds_read_b64_tr_b16 v[212:213], v9 offset:36864
ds_read_b64_tr_b16 v[214:215], v9 offset:38912
v_mfma_f32_16x16x32_bf16 v[96:99], v[144:147], a[52:55], v[96:99]
ds_read_b64_tr_b16 v[216:217], v10 offset:36864
s_add_u32 s69, s61, 4
s_and_b32 s69, s69, 3
s_or_b32 s69, s69, 4
s_lshl_b32 s69, s69, 12
s_add_u32 s69, s69, s95
buffer_load_dwordx4 a[0:3], v1, s[44:47], s69 offen sc1
v_mfma_f32_16x16x32_bf16 v[100:103], v[148:151], a[52:55], v[100:103]
ds_read_b64_tr_b16 v[218:219], v10 offset:38912
v_mfma_f32_16x16x32_bf16 v[84:87], v[148:151], a[36:39], v[84:87]
ds_read_b64_tr_b16 v[220:221], v11 offset:36864
buffer_load_dwordx4 a[4:7], v1, s[44:47], s69 offen offset:1024 sc1
v_mfma_f32_16x16x32_bf16 v[88:91], v[152:155], a[36:39], v[88:91]
ds_read_b64_tr_b16 v[222:223], v11 offset:38912
v_mfma_f32_16x16x32_bf16 v[104:107], v[152:155], a[52:55], v[104:107]
ds_read_b64_tr_b16 v[224:225], v8 offset:40960
ds_read_b64_tr_b16 v[226:227], v8 offset:43008
v_mfma_f32_16x16x32_bf16 v[108:111], v[156:159], a[52:55], v[108:111]
ds_read_b64_tr_b16 v[228:229], v9 offset:40960
buffer_load_dwordx4 a[8:11], v1, s[44:47], s69 offen offset:2048 sc1
v_mfma_f32_16x16x32_bf16 v[92:95], v[156:159], a[36:39], v[92:95]
ds_read_b64_tr_b16 v[230:231], v9 offset:43008
v_mfma_f32_16x16x32_bf16 v[80:83], v[160:163], a[40:43], v[80:83]
ds_read_b64_tr_b16 v[232:233], v10 offset:40960
buffer_load_dwordx4 a[12:15], v1, s[44:47], s69 offen offset:3072 sc1
v_mfma_f32_16x16x32_bf16 v[96:99], v[160:163], a[56:59], v[96:99]
ds_read_b64_tr_b16 v[234:235], v10 offset:43008
ds_read_b64_tr_b16 v[236:237], v11 offset:40960
v_mfma_f32_16x16x32_bf16 v[100:103], v[164:167], a[56:59], v[100:103]
ds_read_b64_tr_b16 v[238:239], v11 offset:43008
s_add_u32 s69, s69, 0x20000
buffer_load_dwordx4 a[16:19], v1, s[44:47], s69 offen sc1
v_mfma_f32_16x16x32_bf16 v[84:87], v[164:167], a[40:43], v[84:87]
ds_read_b64_tr_b16 v[240:241], v8 offset:45056
v_mfma_f32_16x16x32_bf16 v[88:91], v[168:171], a[40:43], v[88:91]
ds_read_b64_tr_b16 v[242:243], v8 offset:47104
v_mfma_f32_16x16x32_bf16 v[104:107], v[168:171], a[56:59], v[104:107]
ds_read_b64_tr_b16 v[244:245], v9 offset:45056
ds_read_b64_tr_b16 v[246:247], v9 offset:47104
buffer_load_dwordx4 a[20:23], v1, s[44:47], s69 offen offset:1024 sc1
v_mfma_f32_16x16x32_bf16 v[108:111], v[172:175], a[56:59], v[108:111]
ds_read_b64_tr_b16 v[248:249], v10 offset:45056
v_mfma_f32_16x16x32_bf16 v[92:95], v[172:175], a[40:43], v[92:95]
ds_read_b64_tr_b16 v[250:251], v10 offset:47104
buffer_load_dwordx4 a[24:27], v1, s[44:47], s69 offen offset:2048 sc1
v_mfma_f32_16x16x32_bf16 v[80:83], v[176:179], a[44:47], v[80:83]
ds_read_b64_tr_b16 v[252:253], v11 offset:45056
v_mfma_f32_16x16x32_bf16 v[96:99], v[176:179], a[60:63], v[96:99]
ds_read_b64_tr_b16 v[254:255], v11 offset:47104
buffer_load_dwordx4 a[28:31], v1, s[44:47], s69 offen offset:3072 sc1
v_mfma_f32_16x16x32_bf16 v[100:103], v[180:183], a[60:63], v[100:103]
v_mfma_f32_16x16x32_bf16 v[84:87], v[180:183], a[44:47], v[84:87]
v_mfma_f32_16x16x32_bf16 v[88:91], v[184:187], a[44:47], v[88:91]
v_mfma_f32_16x16x32_bf16 v[104:107], v[184:187], a[60:63], v[104:107]
v_mfma_f32_16x16x32_bf16 v[108:111], v[188:191], a[60:63], v[108:111]
s_waitcnt vmcnt(27) lgkmcnt(0)
v_mfma_f32_16x16x32_bf16 v[92:95], v[188:191], a[44:47], v[92:95]
s_barrier
v_mfma_f32_16x16x32_bf16 v[80:83], v[192:195], a[64:67], v[80:83]
ds_read_b64_tr_b16 v[128:129], v8 offset:49152
ds_read_b64_tr_b16 v[130:131], v8 offset:51200
s_add_u32 s71, s61, 6
s_and_b32 s71, s71, 3
s_or_b32 s71, s71, 4
s_lshl_b32 s71, s71, 18
s_add_u32 s71, s71, s94
s_add_u32 m0, s64, 131072
s_add_u32 s72, s71, 0
buffer_load_dwordx4 v4, s[24:27], s72 offen lds
v_mfma_f32_16x16x32_bf16 v[96:99], v[192:195], a[80:83], v[96:99]
ds_read_b64_tr_b16 v[132:133], v9 offset:49152
v_mfma_f32_16x16x32_bf16 v[100:103], v[196:199], a[80:83], v[100:103]
ds_read_b64_tr_b16 v[134:135], v9 offset:51200
s_add_u32 s72, s71, 15360
buffer_load_dwordx4 v4, s[24:27], s72 offen offset:1024 lds
v_mfma_f32_16x16x32_bf16 v[84:87], v[196:199], a[64:67], v[84:87]
ds_read_b64_tr_b16 v[136:137], v10 offset:49152
v_mfma_f32_16x16x32_bf16 v[88:91], v[200:203], a[64:67], v[88:91]
ds_read_b64_tr_b16 v[138:139], v10 offset:51200
ds_read_b64_tr_b16 v[140:141], v11 offset:49152
s_add_u32 s72, s71, 30720
buffer_load_dwordx4 v4, s[24:27], s72 offen offset:2048 lds
v_mfma_f32_16x16x32_bf16 v[104:107], v[200:203], a[80:83], v[104:107]
ds_read_b64_tr_b16 v[142:143], v11 offset:51200
v_mfma_f32_16x16x32_bf16 v[108:111], v[204:207], a[80:83], v[108:111]
ds_read_b64_tr_b16 v[144:145], v8 offset:53248
v_mfma_f32_16x16x32_bf16 v[92:95], v[204:207], a[64:67], v[92:95]
ds_read_b64_tr_b16 v[146:147], v8 offset:55296
s_add_u32 s72, s71, 46080
buffer_load_dwordx4 v4, s[24:27], s72 offen offset:3072 lds
v_mfma_f32_16x16x32_bf16 v[80:83], v[208:211], a[68:71], v[80:83]
ds_read_b64_tr_b16 v[148:149], v9 offset:53248
ds_read_b64_tr_b16 v[150:151], v9 offset:55296
v_mfma_f32_16x16x32_bf16 v[96:99], v[208:211], a[84:87], v[96:99]
ds_read_b64_tr_b16 v[152:153], v10 offset:53248
s_add_u32 s69, s61, 5
s_and_b32 s69, s69, 3
s_or_b32 s69, s69, 4
s_lshl_b32 s69, s69, 12
s_add_u32 s69, s69, s95
buffer_load_dwordx4 a[32:35], v1, s[44:47], s69 offen sc1
v_mfma_f32_16x16x32_bf16 v[100:103], v[212:215], a[84:87], v[100:103]
ds_read_b64_tr_b16 v[154:155], v10 offset:55296
v_mfma_f32_16x16x32_bf16 v[84:87], v[212:215], a[68:71], v[84:87]
ds_read_b64_tr_b16 v[156:157], v11 offset:53248
buffer_load_dwordx4 a[36:39], v1, s[44:47], s69 offen offset:1024 sc1
v_mfma_f32_16x16x32_bf16 v[88:91], v[216:219], a[68:71], v[88:91]
ds_read_b64_tr_b16 v[158:159], v11 offset:55296
v_mfma_f32_16x16x32_bf16 v[104:107], v[216:219], a[84:87], v[104:107]
ds_read_b64_tr_b16 v[160:161], v8 offset:57344
ds_read_b64_tr_b16 v[162:163], v8 offset:59392
v_mfma_f32_16x16x32_bf16 v[108:111], v[220:223], a[84:87], v[108:111]
ds_read_b64_tr_b16 v[164:165], v9 offset:57344
buffer_load_dwordx4 a[40:43], v1, s[44:47], s69 offen offset:2048 sc1
v_mfma_f32_16x16x32_bf16 v[92:95], v[220:223], a[68:71], v[92:95]
ds_read_b64_tr_b16 v[166:167], v9 offset:59392
v_mfma_f32_16x16x32_bf16 v[80:83], v[224:227], a[72:75], v[80:83]
ds_read_b64_tr_b16 v[168:169], v10 offset:57344
buffer_load_dwordx4 a[44:47], v1, s[44:47], s69 offen offset:3072 sc1
v_mfma_f32_16x16x32_bf16 v[96:99], v[224:227], a[88:91], v[96:99]
ds_read_b64_tr_b16 v[170:171], v10 offset:59392
ds_read_b64_tr_b16 v[172:173], v11 offset:57344
v_mfma_f32_16x16x32_bf16 v[100:103], v[228:231], a[88:91], v[100:103]
ds_read_b64_tr_b16 v[174:175], v11 offset:59392
s_add_u32 s69, s69, 0x20000
buffer_load_dwordx4 a[48:51], v1, s[44:47], s69 offen sc1
v_mfma_f32_16x16x32_bf16 v[84:87], v[228:231], a[72:75], v[84:87]
ds_read_b64_tr_b16 v[176:177], v8 offset:61440
v_mfma_f32_16x16x32_bf16 v[88:91], v[232:235], a[72:75], v[88:91]
ds_read_b64_tr_b16 v[178:179], v8 offset:63488
v_mfma_f32_16x16x32_bf16 v[104:107], v[232:235], a[88:91], v[104:107]
ds_read_b64_tr_b16 v[180:181], v9 offset:61440
ds_read_b64_tr_b16 v[182:183], v9 offset:63488
buffer_load_dwordx4 a[52:55], v1, s[44:47], s69 offen offset:1024 sc1
v_mfma_f32_16x16x32_bf16 v[108:111], v[236:239], a[88:91], v[108:111]
ds_read_b64_tr_b16 v[184:185], v10 offset:61440
v_mfma_f32_16x16x32_bf16 v[92:95], v[236:239], a[72:75], v[92:95]
ds_read_b64_tr_b16 v[186:187], v10 offset:63488
buffer_load_dwordx4 a[56:59], v1, s[44:47], s69 offen offset:2048 sc1
v_mfma_f32_16x16x32_bf16 v[80:83], v[240:243], a[76:79], v[80:83]
ds_read_b64_tr_b16 v[188:189], v11 offset:61440
v_mfma_f32_16x16x32_bf16 v[96:99], v[240:243], a[92:95], v[96:99]
ds_read_b64_tr_b16 v[190:191], v11 offset:63488
buffer_load_dwordx4 a[60:63], v1, s[44:47], s69 offen offset:3072 sc1
v_mfma_f32_16x16x32_bf16 v[100:103], v[244:247], a[92:95], v[100:103]
v_mfma_f32_16x16x32_bf16 v[84:87], v[244:247], a[76:79], v[84:87]
v_mfma_f32_16x16x32_bf16 v[88:91], v[248:251], a[76:79], v[88:91]
v_mfma_f32_16x16x32_bf16 v[104:107], v[248:251], a[92:95], v[104:107]
v_mfma_f32_16x16x32_bf16 v[108:111], v[252:255], a[92:95], v[108:111]
s_waitcnt vmcnt(24) lgkmcnt(0)
v_mfma_f32_16x16x32_bf16 v[92:95], v[252:255], a[76:79], v[92:95]
s_barrier
v_mfma_f32_16x16x32_bf16 v[80:83], v[128:131], a[96:99], v[80:83]
ds_read_b64_tr_b16 v[192:193], v8 offset:0
ds_read_b64_tr_b16 v[194:195], v8 offset:2048
s_add_u32 s71, s61, 7
s_and_b32 s71, s71, 3
s_or_b32 s71, s71, 4
s_lshl_b32 s71, s71, 18
s_add_u32 s71, s71, s94
s_add_u32 m0, s64, 147456
s_add_u32 s72, s71, 0
buffer_load_dwordx4 v4, s[24:27], s72 offen lds
v_or_b32 v112, s58, v0
v_mov_b32 v113, 3
v_min_u32 v112, 1, v112
v_lshlrev_b32 v112, 30, v112
buffer_store_dword v113, v112, s[44:47], s91 offen sc1
v_mfma_f32_16x16x32_bf16 v[96:99], v[128:131], a[112:115], v[96:99]
ds_read_b64_tr_b16 v[196:197], v9 offset:0
v_mfma_f32_16x16x32_bf16 v[100:103], v[132:135], a[112:115], v[100:103]
ds_read_b64_tr_b16 v[198:199], v9 offset:2048
s_add_u32 s72, s71, 15360
buffer_load_dwordx4 v4, s[24:27], s72 offen offset:1024 lds
v_mfma_f32_16x16x32_bf16 v[84:87], v[132:135], a[96:99], v[84:87]
ds_read_b64_tr_b16 v[200:201], v10 offset:0
v_mfma_f32_16x16x32_bf16 v[88:91], v[136:139], a[96:99], v[88:91]
ds_read_b64_tr_b16 v[202:203], v10 offset:2048
ds_read_b64_tr_b16 v[204:205], v11 offset:0
s_add_u32 s72, s71, 30720
buffer_load_dwordx4 v4, s[24:27], s72 offen offset:2048 lds
v_mfma_f32_16x16x32_bf16 v[104:107], v[136:139], a[112:115], v[104:107]
ds_read_b64_tr_b16 v[206:207], v11 offset:2048
v_mfma_f32_16x16x32_bf16 v[108:111], v[140:143], a[112:115], v[108:111]
ds_read_b64_tr_b16 v[208:209], v8 offset:4096
v_mfma_f32_16x16x32_bf16 v[92:95], v[140:143], a[96:99], v[92:95]
ds_read_b64_tr_b16 v[210:211], v8 offset:6144
s_add_u32 s72, s71, 46080
buffer_load_dwordx4 v4, s[24:27], s72 offen offset:3072 lds
v_mfma_f32_16x16x32_bf16 v[80:83], v[144:147], a[100:103], v[80:83]
ds_read_b64_tr_b16 v[212:213], v9 offset:4096
ds_read_b64_tr_b16 v[214:215], v9 offset:6144
v_mfma_f32_16x16x32_bf16 v[96:99], v[144:147], a[116:119], v[96:99]
ds_read_b64_tr_b16 v[216:217], v10 offset:4096
s_add_u32 s69, s61, 6
s_and_b32 s69, s69, 3
s_or_b32 s69, s69, 4
s_lshl_b32 s69, s69, 12
s_add_u32 s69, s69, s95
buffer_load_dwordx4 a[64:67], v1, s[44:47], s69 offen sc1
v_mfma_f32_16x16x32_bf16 v[100:103], v[148:151], a[116:119], v[100:103]
ds_read_b64_tr_b16 v[218:219], v10 offset:6144
v_mfma_f32_16x16x32_bf16 v[84:87], v[148:151], a[100:103], v[84:87]
ds_read_b64_tr_b16 v[220:221], v11 offset:4096
buffer_load_dwordx4 a[68:71], v1, s[44:47], s69 offen offset:1024 sc1
v_mfma_f32_16x16x32_bf16 v[88:91], v[152:155], a[100:103], v[88:91]
ds_read_b64_tr_b16 v[222:223], v11 offset:6144
v_mfma_f32_16x16x32_bf16 v[104:107], v[152:155], a[116:119], v[104:107]
ds_read_b64_tr_b16 v[224:225], v8 offset:8192
ds_read_b64_tr_b16 v[226:227], v8 offset:10240
v_mfma_f32_16x16x32_bf16 v[108:111], v[156:159], a[116:119], v[108:111]
ds_read_b64_tr_b16 v[228:229], v9 offset:8192
buffer_load_dwordx4 a[72:75], v1, s[44:47], s69 offen offset:2048 sc1
v_mfma_f32_16x16x32_bf16 v[92:95], v[156:159], a[100:103], v[92:95]
ds_read_b64_tr_b16 v[230:231], v9 offset:10240
v_mfma_f32_16x16x32_bf16 v[80:83], v[160:163], a[104:107], v[80:83]
ds_read_b64_tr_b16 v[232:233], v10 offset:8192
buffer_load_dwordx4 a[76:79], v1, s[44:47], s69 offen offset:3072 sc1
v_mfma_f32_16x16x32_bf16 v[96:99], v[160:163], a[120:123], v[96:99]
ds_read_b64_tr_b16 v[234:235], v10 offset:10240
ds_read_b64_tr_b16 v[236:237], v11 offset:8192
v_mfma_f32_16x16x32_bf16 v[100:103], v[164:167], a[120:123], v[100:103]
ds_read_b64_tr_b16 v[238:239], v11 offset:10240
s_add_u32 s69, s69, 0x20000
buffer_load_dwordx4 a[80:83], v1, s[44:47], s69 offen sc1
v_mfma_f32_16x16x32_bf16 v[84:87], v[164:167], a[104:107], v[84:87]
ds_read_b64_tr_b16 v[240:241], v8 offset:12288
v_mfma_f32_16x16x32_bf16 v[88:91], v[168:171], a[104:107], v[88:91]
ds_read_b64_tr_b16 v[242:243], v8 offset:14336
v_mfma_f32_16x16x32_bf16 v[104:107], v[168:171], a[120:123], v[104:107]
ds_read_b64_tr_b16 v[244:245], v9 offset:12288
ds_read_b64_tr_b16 v[246:247], v9 offset:14336
buffer_load_dwordx4 a[84:87], v1, s[44:47], s69 offen offset:1024 sc1
v_mfma_f32_16x16x32_bf16 v[108:111], v[172:175], a[120:123], v[108:111]
ds_read_b64_tr_b16 v[248:249], v10 offset:12288
v_mfma_f32_16x16x32_bf16 v[92:95], v[172:175], a[104:107], v[92:95]
ds_read_b64_tr_b16 v[250:251], v10 offset:14336
buffer_load_dwordx4 a[88:91], v1, s[44:47], s69 offen offset:2048 sc1
v_mfma_f32_16x16x32_bf16 v[80:83], v[176:179], a[108:111], v[80:83]
ds_read_b64_tr_b16 v[252:253], v11 offset:12288
v_mfma_f32_16x16x32_bf16 v[96:99], v[176:179], a[124:127], v[96:99]
ds_read_b64_tr_b16 v[254:255], v11 offset:14336
buffer_load_dwordx4 a[92:95], v1, s[44:47], s69 offen offset:3072 sc1
v_mfma_f32_16x16x32_bf16 v[100:103], v[180:183], a[124:127], v[100:103]
v_mfma_f32_16x16x32_bf16 v[84:87], v[180:183], a[108:111], v[84:87]
v_mfma_f32_16x16x32_bf16 v[88:91], v[184:187], a[108:111], v[88:91]
v_mfma_f32_16x16x32_bf16 v[104:107], v[184:187], a[124:127], v[104:107]
v_mfma_f32_16x16x32_bf16 v[108:111], v[188:191], a[124:127], v[108:111]
s_waitcnt vmcnt(25) lgkmcnt(0)
v_mfma_f32_16x16x32_bf16 v[92:95], v[188:191], a[108:111], v[92:95]
s_barrier
v_mfma_f32_16x16x32_bf16 v[80:83], v[192:195], a[0:3], v[80:83]
ds_read_b64_tr_b16 v[128:129], v8 offset:16384
ds_read_b64_tr_b16 v[130:131], v8 offset:18432
s_add_u32 s71, s61, 8
s_and_b32 s71, s71, 3
s_or_b32 s71, s71, 8
s_lshl_b32 s71, s71, 18
s_add_u32 s71, s71, s94
s_add_u32 m0, s64, 98304
s_add_u32 s72, s71, 0
buffer_load_dwordx4 v4, s[24:27], s72 offen lds
v_mfma_f32_16x16x32_bf16 v[96:99], v[192:195], a[16:19], v[96:99]
ds_read_b64_tr_b16 v[132:133], v9 offset:16384
v_mfma_f32_16x16x32_bf16 v[100:103], v[196:199], a[16:19], v[100:103]
ds_read_b64_tr_b16 v[134:135], v9 offset:18432
s_add_u32 s72, s71, 15360
buffer_load_dwordx4 v4, s[24:27], s72 offen offset:1024 lds
v_mfma_f32_16x16x32_bf16 v[84:87], v[196:199], a[0:3], v[84:87]
ds_read_b64_tr_b16 v[136:137], v10 offset:16384
v_mfma_f32_16x16x32_bf16 v[88:91], v[200:203], a[0:3], v[88:91]
ds_read_b64_tr_b16 v[138:139], v10 offset:18432
ds_read_b64_tr_b16 v[140:141], v11 offset:16384
s_add_u32 s72, s71, 30720
buffer_load_dwordx4 v4, s[24:27], s72 offen offset:2048 lds
v_mfma_f32_16x16x32_bf16 v[104:107], v[200:203], a[16:19], v[104:107]
ds_read_b64_tr_b16 v[142:143], v11 offset:18432
v_mfma_f32_16x16x32_bf16 v[108:111], v[204:207], a[16:19], v[108:111]
ds_read_b64_tr_b16 v[144:145], v8 offset:20480
v_mfma_f32_16x16x32_bf16 v[92:95], v[204:207], a[0:3], v[92:95]
ds_read_b64_tr_b16 v[146:147], v8 offset:22528
s_add_u32 s72, s71, 46080
buffer_load_dwordx4 v4, s[24:27], s72 offen offset:3072 lds
v_mfma_f32_16x16x32_bf16 v[80:83], v[208:211], a[4:7], v[80:83]
ds_read_b64_tr_b16 v[148:149], v9 offset:20480
ds_read_b64_tr_b16 v[150:151], v9 offset:22528
v_mfma_f32_16x16x32_bf16 v[96:99], v[208:211], a[20:23], v[96:99]
ds_read_b64_tr_b16 v[152:153], v10 offset:20480
s_add_u32 s69, s61, 7
s_and_b32 s69, s69, 3
s_or_b32 s69, s69, 4
s_lshl_b32 s69, s69, 12
s_add_u32 s69, s69, s95
buffer_load_dwordx4 a[96:99], v1, s[44:47], s69 offen sc1
v_mfma_f32_16x16x32_bf16 v[100:103], v[212:215], a[20:23], v[100:103]
ds_read_b64_tr_b16 v[154:155], v10 offset:22528
v_mfma_f32_16x16x32_bf16 v[84:87], v[212:215], a[4:7], v[84:87]
ds_read_b64_tr_b16 v[156:157], v11 offset:20480
buffer_load_dwordx4 a[100:103], v1, s[44:47], s69 offen offset:1024 sc1
v_mfma_f32_16x16x32_bf16 v[88:91], v[216:219], a[4:7], v[88:91]
ds_read_b64_tr_b16 v[158:159], v11 offset:22528
v_mfma_f32_16x16x32_bf16 v[104:107], v[216:219], a[20:23], v[104:107]
ds_read_b64_tr_b16 v[160:161], v8 offset:24576
ds_read_b64_tr_b16 v[162:163], v8 offset:26624
v_mfma_f32_16x16x32_bf16 v[108:111], v[220:223], a[20:23], v[108:111]
ds_read_b64_tr_b16 v[164:165], v9 offset:24576
buffer_load_dwordx4 a[104:107], v1, s[44:47], s69 offen offset:2048 sc1
v_mfma_f32_16x16x32_bf16 v[92:95], v[220:223], a[4:7], v[92:95]
ds_read_b64_tr_b16 v[166:167], v9 offset:26624
v_mfma_f32_16x16x32_bf16 v[80:83], v[224:227], a[8:11], v[80:83]
ds_read_b64_tr_b16 v[168:169], v10 offset:24576
buffer_load_dwordx4 a[108:111], v1, s[44:47], s69 offen offset:3072 sc1
v_mfma_f32_16x16x32_bf16 v[96:99], v[224:227], a[24:27], v[96:99]
ds_read_b64_tr_b16 v[170:171], v10 offset:26624
ds_read_b64_tr_b16 v[172:173], v11 offset:24576
v_mfma_f32_16x16x32_bf16 v[100:103], v[228:231], a[24:27], v[100:103]
ds_read_b64_tr_b16 v[174:175], v11 offset:26624
s_add_u32 s69, s69, 0x20000
buffer_load_dwordx4 a[112:115], v1, s[44:47], s69 offen sc1
v_mfma_f32_16x16x32_bf16 v[84:87], v[228:231], a[8:11], v[84:87]
ds_read_b64_tr_b16 v[176:177], v8 offset:28672
v_mfma_f32_16x16x32_bf16 v[88:91], v[232:235], a[8:11], v[88:91]
ds_read_b64_tr_b16 v[178:179], v8 offset:30720
v_mfma_f32_16x16x32_bf16 v[104:107], v[232:235], a[24:27], v[104:107]
ds_read_b64_tr_b16 v[180:181], v9 offset:28672
ds_read_b64_tr_b16 v[182:183], v9 offset:30720
buffer_load_dwordx4 a[116:119], v1, s[44:47], s69 offen offset:1024 sc1
v_mfma_f32_16x16x32_bf16 v[108:111], v[236:239], a[24:27], v[108:111]
ds_read_b64_tr_b16 v[184:185], v10 offset:28672
v_mfma_f32_16x16x32_bf16 v[92:95], v[236:239], a[8:11], v[92:95]
ds_read_b64_tr_b16 v[186:187], v10 offset:30720
buffer_load_dwordx4 a[120:123], v1, s[44:47], s69 offen offset:2048 sc1
v_mfma_f32_16x16x32_bf16 v[80:83], v[240:243], a[12:15], v[80:83]
ds_read_b64_tr_b16 v[188:189], v11 offset:28672
v_mfma_f32_16x16x32_bf16 v[96:99], v[240:243], a[28:31], v[96:99]
ds_read_b64_tr_b16 v[190:191], v11 offset:30720
buffer_load_dwordx4 a[124:127], v1, s[44:47], s69 offen offset:3072 sc1
v_mfma_f32_16x16x32_bf16 v[100:103], v[244:247], a[28:31], v[100:103]
v_mfma_f32_16x16x32_bf16 v[84:87], v[244:247], a[12:15], v[84:87]
v_mfma_f32_16x16x32_bf16 v[88:91], v[248:251], a[12:15], v[88:91]
v_mfma_f32_16x16x32_bf16 v[104:107], v[248:251], a[28:31], v[104:107]
v_mfma_f32_16x16x32_bf16 v[108:111], v[252:255], a[28:31], v[108:111]
s_waitcnt vmcnt(25) lgkmcnt(0)
v_mfma_f32_16x16x32_bf16 v[92:95], v[252:255], a[12:15], v[92:95]
s_barrier
v_mfma_f32_16x16x32_bf16 v[80:83], v[128:131], a[32:35], v[80:83]
ds_read_b64_tr_b16 v[192:193], v8 offset:32768
ds_read_b64_tr_b16 v[194:195], v8 offset:34816
s_add_u32 s71, s61, 9
s_and_b32 s71, s71, 3
s_or_b32 s71, s71, 8
s_lshl_b32 s71, s71, 18
s_add_u32 s71, s71, s94
s_add_u32 m0, s64, 114688
s_add_u32 s72, s71, 0
buffer_load_dwordx4 v4, s[24:27], s72 offen lds
v_mfma_f32_16x16x32_bf16 v[96:99], v[128:131], a[48:51], v[96:99]
ds_read_b64_tr_b16 v[196:197], v9 offset:32768
v_mfma_f32_16x16x32_bf16 v[100:103], v[132:135], a[48:51], v[100:103]
ds_read_b64_tr_b16 v[198:199], v9 offset:34816
s_add_u32 s72, s71, 15360
buffer_load_dwordx4 v4, s[24:27], s72 offen offset:1024 lds
v_mfma_f32_16x16x32_bf16 v[84:87], v[132:135], a[32:35], v[84:87]
ds_read_b64_tr_b16 v[200:201], v10 offset:32768
v_mfma_f32_16x16x32_bf16 v[88:91], v[136:139], a[32:35], v[88:91]
ds_read_b64_tr_b16 v[202:203], v10 offset:34816
ds_read_b64_tr_b16 v[204:205], v11 offset:32768
s_add_u32 s72, s71, 30720
buffer_load_dwordx4 v4, s[24:27], s72 offen offset:2048 lds
v_mfma_f32_16x16x32_bf16 v[104:107], v[136:139], a[48:51], v[104:107]
ds_read_b64_tr_b16 v[206:207], v11 offset:34816
v_mfma_f32_16x16x32_bf16 v[108:111], v[140:143], a[48:51], v[108:111]
ds_read_b64_tr_b16 v[208:209], v8 offset:36864
v_mfma_f32_16x16x32_bf16 v[92:95], v[140:143], a[32:35], v[92:95]
ds_read_b64_tr_b16 v[210:211], v8 offset:38912
s_add_u32 s72, s71, 46080
buffer_load_dwordx4 v4, s[24:27], s72 offen offset:3072 lds
v_mfma_f32_16x16x32_bf16 v[80:83], v[144:147], a[36:39], v[80:83]
ds_read_b64_tr_b16 v[212:213], v9 offset:36864
ds_read_b64_tr_b16 v[214:215], v9 offset:38912
v_mfma_f32_16x16x32_bf16 v[96:99], v[144:147], a[52:55], v[96:99]
ds_read_b64_tr_b16 v[216:217], v10 offset:36864
s_add_u32 s69, s61, 8
s_and_b32 s69, s69, 3
s_or_b32 s69, s69, 8
s_lshl_b32 s69, s69, 12
s_add_u32 s69, s69, s95
buffer_load_dwordx4 a[0:3], v1, s[44:47], s69 offen sc1
v_mfma_f32_16x16x32_bf16 v[100:103], v[148:151], a[52:55], v[100:103]
ds_read_b64_tr_b16 v[218:219], v10 offset:38912
v_mfma_f32_16x16x32_bf16 v[84:87], v[148:151], a[36:39], v[84:87]
ds_read_b64_tr_b16 v[220:221], v11 offset:36864
buffer_load_dwordx4 a[4:7], v1, s[44:47], s69 offen offset:1024 sc1
v_mfma_f32_16x16x32_bf16 v[88:91], v[152:155], a[36:39], v[88:91]
ds_read_b64_tr_b16 v[222:223], v11 offset:38912
v_mfma_f32_16x16x32_bf16 v[104:107], v[152:155], a[52:55], v[104:107]
ds_read_b64_tr_b16 v[224:225], v8 offset:40960
ds_read_b64_tr_b16 v[226:227], v8 offset:43008
v_mfma_f32_16x16x32_bf16 v[108:111], v[156:159], a[52:55], v[108:111]
ds_read_b64_tr_b16 v[228:229], v9 offset:40960
buffer_load_dwordx4 a[8:11], v1, s[44:47], s69 offen offset:2048 sc1
v_mfma_f32_16x16x32_bf16 v[92:95], v[156:159], a[36:39], v[92:95]
ds_read_b64_tr_b16 v[230:231], v9 offset:43008
v_mfma_f32_16x16x32_bf16 v[80:83], v[160:163], a[40:43], v[80:83]
ds_read_b64_tr_b16 v[232:233], v10 offset:40960
buffer_load_dwordx4 a[12:15], v1, s[44:47], s69 offen offset:3072 sc1
v_mfma_f32_16x16x32_bf16 v[96:99], v[160:163], a[56:59], v[96:99]
ds_read_b64_tr_b16 v[234:235], v10 offset:43008
ds_read_b64_tr_b16 v[236:237], v11 offset:40960
v_mfma_f32_16x16x32_bf16 v[100:103], v[164:167], a[56:59], v[100:103]
ds_read_b64_tr_b16 v[238:239], v11 offset:43008
s_add_u32 s69, s69, 0x20000
buffer_load_dwordx4 a[16:19], v1, s[44:47], s69 offen sc1
v_mfma_f32_16x16x32_bf16 v[84:87], v[164:167], a[40:43], v[84:87]
ds_read_b64_tr_b16 v[240:241], v8 offset:45056
v_mfma_f32_16x16x32_bf16 v[88:91], v[168:171], a[40:43], v[88:91]
ds_read_b64_tr_b16 v[242:243], v8 offset:47104
v_mfma_f32_16x16x32_bf16 v[104:107], v[168:171], a[56:59], v[104:107]
ds_read_b64_tr_b16 v[244:245], v9 offset:45056
ds_read_b64_tr_b16 v[246:247], v9 offset:47104
buffer_load_dwordx4 a[20:23], v1, s[44:47], s69 offen offset:1024 sc1
v_mfma_f32_16x16x32_bf16 v[108:111], v[172:175], a[56:59], v[108:111]
ds_read_b64_tr_b16 v[248:249], v10 offset:45056
v_mfma_f32_16x16x32_bf16 v[92:95], v[172:175], a[40:43], v[92:95]
ds_read_b64_tr_b16 v[250:251], v10 offset:47104
buffer_load_dwordx4 a[24:27], v1, s[44:47], s69 offen offset:2048 sc1
v_mfma_f32_16x16x32_bf16 v[80:83], v[176:179], a[44:47], v[80:83]
ds_read_b64_tr_b16 v[252:253], v11 offset:45056
v_mfma_f32_16x16x32_bf16 v[96:99], v[176:179], a[60:63], v[96:99]
ds_read_b64_tr_b16 v[254:255], v11 offset:47104
buffer_load_dwordx4 a[28:31], v1, s[44:47], s69 offen offset:3072 sc1
v_mfma_f32_16x16x32_bf16 v[100:103], v[180:183], a[60:63], v[100:103]
v_mfma_f32_16x16x32_bf16 v[84:87], v[180:183], a[44:47], v[84:87]
v_mfma_f32_16x16x32_bf16 v[88:91], v[184:187], a[44:47], v[88:91]
v_mfma_f32_16x16x32_bf16 v[104:107], v[184:187], a[60:63], v[104:107]
v_mfma_f32_16x16x32_bf16 v[108:111], v[188:191], a[60:63], v[108:111]
s_waitcnt vmcnt(24) lgkmcnt(0)
v_mfma_f32_16x16x32_bf16 v[92:95], v[188:191], a[44:47], v[92:95]
s_barrier
v_mfma_f32_16x16x32_bf16 v[80:83], v[192:195], a[64:67], v[80:83]
ds_read_b64_tr_b16 v[128:129], v8 offset:49152
ds_read_b64_tr_b16 v[130:131], v8 offset:51200
s_add_u32 s71, s61, 10
s_and_b32 s71, s71, 3
s_or_b32 s71, s71, 8
s_lshl_b32 s71, s71, 18
s_add_u32 s71, s71, s94
s_add_u32 m0, s64, 131072
s_add_u32 s72, s71, 0
buffer_load_dwordx4 v4, s[24:27], s72 offen lds
v_mfma_f32_16x16x32_bf16 v[96:99], v[192:195], a[80:83], v[96:99]
ds_read_b64_tr_b16 v[132:133], v9 offset:49152
v_mfma_f32_16x16x32_bf16 v[100:103], v[196:199], a[80:83], v[100:103]
ds_read_b64_tr_b16 v[134:135], v9 offset:51200
s_add_u32 s72, s71, 15360
buffer_load_dwordx4 v4, s[24:27], s72 offen offset:1024 lds
v_mfma_f32_16x16x32_bf16 v[84:87], v[196:199], a[64:67], v[84:87]
ds_read_b64_tr_b16 v[136:137], v10 offset:49152
v_mfma_f32_16x16x32_bf16 v[88:91], v[200:203], a[64:67], v[88:91]
ds_read_b64_tr_b16 v[138:139], v10 offset:51200
ds_read_b64_tr_b16 v[140:141], v11 offset:49152
s_add_u32 s72, s71, 30720
buffer_load_dwordx4 v4, s[24:27], s72 offen offset:2048 lds
v_mfma_f32_16x16x32_bf16 v[104:107], v[200:203], a[80:83], v[104:107]
ds_read_b64_tr_b16 v[142:143], v11 offset:51200
v_mfma_f32_16x16x32_bf16 v[108:111], v[204:207], a[80:83], v[108:111]
ds_read_b64_tr_b16 v[144:145], v8 offset:53248
v_mfma_f32_16x16x32_bf16 v[92:95], v[204:207], a[64:67], v[92:95]
ds_read_b64_tr_b16 v[146:147], v8 offset:55296
s_add_u32 s72, s71, 46080
buffer_load_dwordx4 v4, s[24:27], s72 offen offset:3072 lds
v_mfma_f32_16x16x32_bf16 v[80:83], v[208:211], a[68:71], v[80:83]
ds_read_b64_tr_b16 v[148:149], v9 offset:53248
ds_read_b64_tr_b16 v[150:151], v9 offset:55296
v_mfma_f32_16x16x32_bf16 v[96:99], v[208:211], a[84:87], v[96:99]
ds_read_b64_tr_b16 v[152:153], v10 offset:53248
s_add_u32 s69, s61, 9
s_and_b32 s69, s69, 3
s_or_b32 s69, s69, 8
s_lshl_b32 s69, s69, 12
s_add_u32 s69, s69, s95
buffer_load_dwordx4 a[32:35], v1, s[44:47], s69 offen sc1
v_mfma_f32_16x16x32_bf16 v[100:103], v[212:215], a[84:87], v[100:103]
ds_read_b64_tr_b16 v[154:155], v10 offset:55296
v_mfma_f32_16x16x32_bf16 v[84:87], v[212:215], a[68:71], v[84:87]
ds_read_b64_tr_b16 v[156:157], v11 offset:53248
buffer_load_dwordx4 a[36:39], v1, s[44:47], s69 offen offset:1024 sc1
v_mfma_f32_16x16x32_bf16 v[88:91], v[216:219], a[68:71], v[88:91]
ds_read_b64_tr_b16 v[158:159], v11 offset:55296
v_mfma_f32_16x16x32_bf16 v[104:107], v[216:219], a[84:87], v[104:107]
ds_read_b64_tr_b16 v[160:161], v8 offset:57344
ds_read_b64_tr_b16 v[162:163], v8 offset:59392
v_mfma_f32_16x16x32_bf16 v[108:111], v[220:223], a[84:87], v[108:111]
ds_read_b64_tr_b16 v[164:165], v9 offset:57344
buffer_load_dwordx4 a[40:43], v1, s[44:47], s69 offen offset:2048 sc1
v_mfma_f32_16x16x32_bf16 v[92:95], v[220:223], a[68:71], v[92:95]
ds_read_b64_tr_b16 v[166:167], v9 offset:59392
v_mfma_f32_16x16x32_bf16 v[80:83], v[224:227], a[72:75], v[80:83]
ds_read_b64_tr_b16 v[168:169], v10 offset:57344
buffer_load_dwordx4 a[44:47], v1, s[44:47], s69 offen offset:3072 sc1
v_mfma_f32_16x16x32_bf16 v[96:99], v[224:227], a[88:91], v[96:99]
ds_read_b64_tr_b16 v[170:171], v10 offset:59392
ds_read_b64_tr_b16 v[172:173], v11 offset:57344
v_mfma_f32_16x16x32_bf16 v[100:103], v[228:231], a[88:91], v[100:103]
ds_read_b64_tr_b16 v[174:175], v11 offset:59392
s_add_u32 s69, s69, 0x20000
buffer_load_dwordx4 a[48:51], v1, s[44:47], s69 offen sc1
v_mfma_f32_16x16x32_bf16 v[84:87], v[228:231], a[72:75], v[84:87]
ds_read_b64_tr_b16 v[176:177], v8 offset:61440
v_mfma_f32_16x16x32_bf16 v[88:91], v[232:235], a[72:75], v[88:91]
ds_read_b64_tr_b16 v[178:179], v8 offset:63488
v_mfma_f32_16x16x32_bf16 v[104:107], v[232:235], a[88:91], v[104:107]
ds_read_b64_tr_b16 v[180:181], v9 offset:61440
ds_read_b64_tr_b16 v[182:183], v9 offset:63488
buffer_load_dwordx4 a[52:55], v1, s[44:47], s69 offen offset:1024 sc1
v_mfma_f32_16x16x32_bf16 v[108:111], v[236:239], a[88:91], v[108:111]
ds_read_b64_tr_b16 v[184:185], v10 offset:61440
v_mfma_f32_16x16x32_bf16 v[92:95], v[236:239], a[72:75], v[92:95]
ds_read_b64_tr_b16 v[186:187], v10 offset:63488
buffer_load_dwordx4 a[56:59], v1, s[44:47], s69 offen offset:2048 sc1
v_mfma_f32_16x16x32_bf16 v[80:83], v[240:243], a[76:79], v[80:83]
ds_read_b64_tr_b16 v[188:189], v11 offset:61440
v_mfma_f32_16x16x32_bf16 v[96:99], v[240:243], a[92:95], v[96:99]
ds_read_b64_tr_b16 v[190:191], v11 offset:63488
buffer_load_dwordx4 a[60:63], v1, s[44:47], s69 offen offset:3072 sc1
v_mfma_f32_16x16x32_bf16 v[100:103], v[244:247], a[92:95], v[100:103]
v_mfma_f32_16x16x32_bf16 v[84:87], v[244:247], a[76:79], v[84:87]
v_mfma_f32_16x16x32_bf16 v[88:91], v[248:251], a[76:79], v[88:91]
v_mfma_f32_16x16x32_bf16 v[104:107], v[248:251], a[92:95], v[104:107]
v_mfma_f32_16x16x32_bf16 v[108:111], v[252:255], a[92:95], v[108:111]
s_waitcnt vmcnt(24) lgkmcnt(0)
v_mfma_f32_16x16x32_bf16 v[92:95], v[252:255], a[76:79], v[92:95]
s_barrier
v_mfma_f32_16x16x32_bf16 v[80:83], v[128:131], a[96:99], v[80:83]
ds_read_b64_tr_b16 v[192:193], v8 offset:0
ds_read_b64_tr_b16 v[194:195], v8 offset:2048
s_add_u32 s71, s61, 11
s_and_b32 s71, s71, 3
s_or_b32 s71, s71, 8
s_lshl_b32 s71, s71, 18
s_add_u32 s71, s71, s94
s_add_u32 m0, s64, 147456
s_add_u32 s72, s71, 0
buffer_load_dwordx4 v4, s[24:27], s72 offen lds
v_mfma_f32_16x16x32_bf16 v[96:99], v[128:131], a[112:115], v[96:99]
ds_read_b64_tr_b16 v[196:197], v9 offset:0
v_mfma_f32_16x16x32_bf16 v[100:103], v[132:135], a[112:115], v[100:103]
ds_read_b64_tr_b16 v[198:199], v9 offset:2048
s_add_u32 s72, s71, 15360
buffer_load_dwordx4 v4, s[24:27], s72 offen offset:1024 lds
v_mfma_f32_16x16x32_bf16 v[84:87], v[132:135], a[96:99], v[84:87]
ds_read_b64_tr_b16 v[200:201], v10 offset:0
v_mfma_f32_16x16x32_bf16 v[88:91], v[136:139], a[96:99], v[88:91]
ds_read_b64_tr_b16 v[202:203], v10 offset:2048
ds_read_b64_tr_b16 v[204:205], v11 offset:0
s_add_u32 s72, s71, 30720
buffer_load_dwordx4 v4, s[24:27], s72 offen offset:2048 lds
v_mfma_f32_16x16x32_bf16 v[104:107], v[136:139], a[112:115], v[104:107]
ds_read_b64_tr_b16 v[206:207], v11 offset:2048
v_mfma_f32_16x16x32_bf16 v[108:111], v[140:143], a[112:115], v[108:111]
ds_read_b64_tr_b16 v[208:209], v8 offset:4096
v_mfma_f32_16x16x32_bf16 v[92:95], v[140:143], a[96:99], v[92:95]
ds_read_b64_tr_b16 v[210:211], v8 offset:6144
s_add_u32 s72, s71, 46080
buffer_load_dwordx4 v4, s[24:27], s72 offen offset:3072 lds
v_mfma_f32_16x16x32_bf16 v[80:83], v[144:147], a[100:103], v[80:83]
ds_read_b64_tr_b16 v[212:213], v9 offset:4096
ds_read_b64_tr_b16 v[214:215], v9 offset:6144
v_mfma_f32_16x16x32_bf16 v[96:99], v[144:147], a[116:119], v[96:99]
ds_read_b64_tr_b16 v[216:217], v10 offset:4096
s_add_u32 s69, s61, 10
s_and_b32 s69, s69, 3
s_or_b32 s69, s69, 8
s_lshl_b32 s69, s69, 12
s_add_u32 s69, s69, s95
buffer_load_dwordx4 a[64:67], v1, s[44:47], s69 offen sc1
v_mfma_f32_16x16x32_bf16 v[100:103], v[148:151], a[116:119], v[100:103]
ds_read_b64_tr_b16 v[218:219], v10 offset:6144
v_mfma_f32_16x16x32_bf16 v[84:87], v[148:151], a[100:103], v[84:87]
ds_read_b64_tr_b16 v[220:221], v11 offset:4096
buffer_load_dwordx4 a[68:71], v1, s[44:47], s69 offen offset:1024 sc1
v_mfma_f32_16x16x32_bf16 v[88:91], v[152:155], a[100:103], v[88:91]
ds_read_b64_tr_b16 v[222:223], v11 offset:6144
v_mfma_f32_16x16x32_bf16 v[104:107], v[152:155], a[116:119], v[104:107]
ds_read_b64_tr_b16 v[224:225], v8 offset:8192
ds_read_b64_tr_b16 v[226:227], v8 offset:10240
v_mfma_f32_16x16x32_bf16 v[108:111], v[156:159], a[116:119], v[108:111]
ds_read_b64_tr_b16 v[228:229], v9 offset:8192
buffer_load_dwordx4 a[72:75], v1, s[44:47], s69 offen offset:2048 sc1
v_mfma_f32_16x16x32_bf16 v[92:95], v[156:159], a[100:103], v[92:95]
ds_read_b64_tr_b16 v[230:231], v9 offset:10240
v_mfma_f32_16x16x32_bf16 v[80:83], v[160:163], a[104:107], v[80:83]
ds_read_b64_tr_b16 v[232:233], v10 offset:8192
buffer_load_dwordx4 a[76:79], v1, s[44:47], s69 offen offset:3072 sc1
v_mfma_f32_16x16x32_bf16 v[96:99], v[160:163], a[120:123], v[96:99]
ds_read_b64_tr_b16 v[234:235], v10 offset:10240
ds_read_b64_tr_b16 v[236:237], v11 offset:8192
v_mfma_f32_16x16x32_bf16 v[100:103], v[164:167], a[120:123], v[100:103]
ds_read_b64_tr_b16 v[238:239], v11 offset:10240
s_add_u32 s69, s69, 0x20000
buffer_load_dwordx4 a[80:83], v1, s[44:47], s69 offen sc1
v_mfma_f32_16x16x32_bf16 v[84:87], v[164:167], a[104:107], v[84:87]
ds_read_b64_tr_b16 v[240:241], v8 offset:12288
v_mfma_f32_16x16x32_bf16 v[88:91], v[168:171], a[104:107], v[88:91]
ds_read_b64_tr_b16 v[242:243], v8 offset:14336
v_mfma_f32_16x16x32_bf16 v[104:107], v[168:171], a[120:123], v[104:107]
ds_read_b64_tr_b16 v[244:245], v9 offset:12288
ds_read_b64_tr_b16 v[246:247], v9 offset:14336
buffer_load_dwordx4 a[84:87], v1, s[44:47], s69 offen offset:1024 sc1
v_mfma_f32_16x16x32_bf16 v[108:111], v[172:175], a[120:123], v[108:111]
ds_read_b64_tr_b16 v[248:249], v10 offset:12288
v_mfma_f32_16x16x32_bf16 v[92:95], v[172:175], a[104:107], v[92:95]
ds_read_b64_tr_b16 v[250:251], v10 offset:14336
buffer_load_dwordx4 a[88:91], v1, s[44:47], s69 offen offset:2048 sc1
v_mfma_f32_16x16x32_bf16 v[80:83], v[176:179], a[108:111], v[80:83]
ds_read_b64_tr_b16 v[252:253], v11 offset:12288
v_mfma_f32_16x16x32_bf16 v[96:99], v[176:179], a[124:127], v[96:99]
ds_read_b64_tr_b16 v[254:255], v11 offset:14336
buffer_load_dwordx4 a[92:95], v1, s[44:47], s69 offen offset:3072 sc1
v_mfma_f32_16x16x32_bf16 v[100:103], v[180:183], a[124:127], v[100:103]
v_mfma_f32_16x16x32_bf16 v[84:87], v[180:183], a[108:111], v[84:87]
v_mfma_f32_16x16x32_bf16 v[88:91], v[184:187], a[108:111], v[88:91]
v_mfma_f32_16x16x32_bf16 v[104:107], v[184:187], a[124:127], v[104:107]
v_mfma_f32_16x16x32_bf16 v[108:111], v[188:191], a[124:127], v[108:111]
s_waitcnt vmcnt(24) lgkmcnt(0)
v_mfma_f32_16x16x32_bf16 v[92:95], v[188:191], a[108:111], v[92:95]
s_barrier
v_mfma_f32_16x16x32_bf16 v[80:83], v[192:195], a[0:3], v[80:83]
ds_read_b64_tr_b16 v[128:129], v8 offset:16384
ds_read_b64_tr_b16 v[130:131], v8 offset:18432
s_add_u32 s71, s61, 12
s_and_b32 s71, s71, 3
s_or_b32 s71, s71, 12
s_lshl_b32 s71, s71, 18
s_add_u32 s71, s71, s94
s_add_u32 m0, s64, 98304
s_add_u32 s72, s71, 0
buffer_load_dwordx4 v4, s[24:27], s72 offen lds
v_mfma_f32_16x16x32_bf16 v[96:99], v[192:195], a[16:19], v[96:99]
ds_read_b64_tr_b16 v[132:133], v9 offset:16384
v_mfma_f32_16x16x32_bf16 v[100:103], v[196:199], a[16:19], v[100:103]
ds_read_b64_tr_b16 v[134:135], v9 offset:18432
s_add_u32 s72, s71, 15360
buffer_load_dwordx4 v4, s[24:27], s72 offen offset:1024 lds
v_mfma_f32_16x16x32_bf16 v[84:87], v[196:199], a[0:3], v[84:87]
ds_read_b64_tr_b16 v[136:137], v10 offset:16384
v_mfma_f32_16x16x32_bf16 v[88:91], v[200:203], a[0:3], v[88:91]
ds_read_b64_tr_b16 v[138:139], v10 offset:18432
ds_read_b64_tr_b16 v[140:141], v11 offset:16384
s_add_u32 s72, s71, 30720
buffer_load_dwordx4 v4, s[24:27], s72 offen offset:2048 lds
v_mfma_f32_16x16x32_bf16 v[104:107], v[200:203], a[16:19], v[104:107]
ds_read_b64_tr_b16 v[142:143], v11 offset:18432
v_mfma_f32_16x16x32_bf16 v[108:111], v[204:207], a[16:19], v[108:111]
ds_read_b64_tr_b16 v[144:145], v8 offset:20480
v_mfma_f32_16x16x32_bf16 v[92:95], v[204:207], a[0:3], v[92:95]
ds_read_b64_tr_b16 v[146:147], v8 offset:22528
s_add_u32 s72, s71, 46080
buffer_load_dwordx4 v4, s[24:27], s72 offen offset:3072 lds
v_mfma_f32_16x16x32_bf16 v[80:83], v[208:211], a[4:7], v[80:83]
ds_read_b64_tr_b16 v[148:149], v9 offset:20480
ds_read_b64_tr_b16 v[150:151], v9 offset:22528
v_mfma_f32_16x16x32_bf16 v[96:99], v[208:211], a[20:23], v[96:99]
ds_read_b64_tr_b16 v[152:153], v10 offset:20480
s_add_u32 s69, s61, 11
s_and_b32 s69, s69, 3
s_or_b32 s69, s69, 8
s_lshl_b32 s69, s69, 12
s_add_u32 s69, s69, s95
buffer_load_dwordx4 a[96:99], v1, s[44:47], s69 offen sc1
v_mfma_f32_16x16x32_bf16 v[100:103], v[212:215], a[20:23], v[100:103]
ds_read_b64_tr_b16 v[154:155], v10 offset:22528
v_mfma_f32_16x16x32_bf16 v[84:87], v[212:215], a[4:7], v[84:87]
ds_read_b64_tr_b16 v[156:157], v11 offset:20480
buffer_load_dwordx4 a[100:103], v1, s[44:47], s69 offen offset:1024 sc1
v_mfma_f32_16x16x32_bf16 v[88:91], v[216:219], a[4:7], v[88:91]
ds_read_b64_tr_b16 v[158:159], v11 offset:22528
v_mfma_f32_16x16x32_bf16 v[104:107], v[216:219], a[20:23], v[104:107]
ds_read_b64_tr_b16 v[160:161], v8 offset:24576
ds_read_b64_tr_b16 v[162:163], v8 offset:26624
v_mfma_f32_16x16x32_bf16 v[108:111], v[220:223], a[20:23], v[108:111]
ds_read_b64_tr_b16 v[164:165], v9 offset:24576
buffer_load_dwordx4 a[104:107], v1, s[44:47], s69 offen offset:2048 sc1
v_mfma_f32_16x16x32_bf16 v[92:95], v[220:223], a[4:7], v[92:95]
ds_read_b64_tr_b16 v[166:167], v9 offset:26624
v_mfma_f32_16x16x32_bf16 v[80:83], v[224:227], a[8:11], v[80:83]
ds_read_b64_tr_b16 v[168:169], v10 offset:24576
buffer_load_dwordx4 a[108:111], v1, s[44:47], s69 offen offset:3072 sc1
v_mfma_f32_16x16x32_bf16 v[96:99], v[224:227], a[24:27], v[96:99]
ds_read_b64_tr_b16 v[170:171], v10 offset:26624
ds_read_b64_tr_b16 v[172:173], v11 offset:24576
v_mfma_f32_16x16x32_bf16 v[100:103], v[228:231], a[24:27], v[100:103]
ds_read_b64_tr_b16 v[174:175], v11 offset:26624
s_add_u32 s69, s69, 0x20000
buffer_load_dwordx4 a[112:115], v1, s[44:47], s69 offen sc1
v_mfma_f32_16x16x32_bf16 v[84:87], v[228:231], a[8:11], v[84:87]
ds_read_b64_tr_b16 v[176:177], v8 offset:28672
v_mfma_f32_16x16x32_bf16 v[88:91], v[232:235], a[8:11], v[88:91]
ds_read_b64_tr_b16 v[178:179], v8 offset:30720
v_mfma_f32_16x16x32_bf16 v[104:107], v[232:235], a[24:27], v[104:107]
ds_read_b64_tr_b16 v[180:181], v9 offset:28672
ds_read_b64_tr_b16 v[182:183], v9 offset:30720
buffer_load_dwordx4 a[116:119], v1, s[44:47], s69 offen offset:1024 sc1
v_mfma_f32_16x16x32_bf16 v[108:111], v[236:239], a[24:27], v[108:111]
ds_read_b64_tr_b16 v[184:185], v10 offset:28672
v_mfma_f32_16x16x32_bf16 v[92:95], v[236:239], a[8:11], v[92:95]
ds_read_b64_tr_b16 v[186:187], v10 offset:30720
buffer_load_dwordx4 a[120:123], v1, s[44:47], s69 offen offset:2048 sc1
v_mfma_f32_16x16x32_bf16 v[80:83], v[240:243], a[12:15], v[80:83]
ds_read_b64_tr_b16 v[188:189], v11 offset:28672
v_mfma_f32_16x16x32_bf16 v[96:99], v[240:243], a[28:31], v[96:99]
ds_read_b64_tr_b16 v[190:191], v11 offset:30720
buffer_load_dwordx4 a[124:127], v1, s[44:47], s69 offen offset:3072 sc1
v_mfma_f32_16x16x32_bf16 v[100:103], v[244:247], a[28:31], v[100:103]
v_mfma_f32_16x16x32_bf16 v[84:87], v[244:247], a[12:15], v[84:87]
v_mfma_f32_16x16x32_bf16 v[88:91], v[248:251], a[12:15], v[88:91]
v_mfma_f32_16x16x32_bf16 v[104:107], v[248:251], a[28:31], v[104:107]
v_mfma_f32_16x16x32_bf16 v[108:111], v[252:255], a[28:31], v[108:111]
s_waitcnt vmcnt(24) lgkmcnt(0)
v_mfma_f32_16x16x32_bf16 v[92:95], v[252:255], a[12:15], v[92:95]
s_barrier
v_mfma_f32_16x16x32_bf16 v[80:83], v[128:131], a[32:35], v[80:83]
ds_read_b64_tr_b16 v[192:193], v8 offset:32768
ds_read_b64_tr_b16 v[194:195], v8 offset:34816
s_add_u32 s71, s61, 13
s_and_b32 s71, s71, 3
s_or_b32 s71, s71, 12
s_lshl_b32 s71, s71, 18
s_add_u32 s71, s71, s94
s_add_u32 m0, s64, 114688
s_add_u32 s72, s71, 0
buffer_load_dwordx4 v4, s[24:27], s72 offen lds
v_mfma_f32_16x16x32_bf16 v[96:99], v[128:131], a[48:51], v[96:99]
ds_read_b64_tr_b16 v[196:197], v9 offset:32768
v_mfma_f32_16x16x32_bf16 v[100:103], v[132:135], a[48:51], v[100:103]
ds_read_b64_tr_b16 v[198:199], v9 offset:34816
s_add_u32 s72, s71, 15360
buffer_load_dwordx4 v4, s[24:27], s72 offen offset:1024 lds
v_mfma_f32_16x16x32_bf16 v[84:87], v[132:135], a[32:35], v[84:87]
ds_read_b64_tr_b16 v[200:201], v10 offset:32768
v_mfma_f32_16x16x32_bf16 v[88:91], v[136:139], a[32:35], v[88:91]
ds_read_b64_tr_b16 v[202:203], v10 offset:34816
ds_read_b64_tr_b16 v[204:205], v11 offset:32768
s_add_u32 s72, s71, 30720
buffer_load_dwordx4 v4, s[24:27], s72 offen offset:2048 lds
v_mfma_f32_16x16x32_bf16 v[104:107], v[136:139], a[48:51], v[104:107]
ds_read_b64_tr_b16 v[206:207], v11 offset:34816
v_mfma_f32_16x16x32_bf16 v[108:111], v[140:143], a[48:51], v[108:111]
ds_read_b64_tr_b16 v[208:209], v8 offset:36864
v_mfma_f32_16x16x32_bf16 v[92:95], v[140:143], a[32:35], v[92:95]
ds_read_b64_tr_b16 v[210:211], v8 offset:38912
s_add_u32 s72, s71, 46080
buffer_load_dwordx4 v4, s[24:27], s72 offen offset:3072 lds
v_mfma_f32_16x16x32_bf16 v[80:83], v[144:147], a[36:39], v[80:83]
ds_read_b64_tr_b16 v[212:213], v9 offset:36864
ds_read_b64_tr_b16 v[214:215], v9 offset:38912
v_mfma_f32_16x16x32_bf16 v[96:99], v[144:147], a[52:55], v[96:99]
ds_read_b64_tr_b16 v[216:217], v10 offset:36864
s_add_u32 s69, s61, 12
s_and_b32 s69, s69, 3
s_or_b32 s69, s69, 12
s_lshl_b32 s69, s69, 12
s_add_u32 s69, s69, s95
buffer_load_dwordx4 a[0:3], v1, s[44:47], s69 offen sc1
v_mfma_f32_16x16x32_bf16 v[100:103], v[148:151], a[52:55], v[100:103]
ds_read_b64_tr_b16 v[218:219], v10 offset:38912
v_mfma_f32_16x16x32_bf16 v[84:87], v[148:151], a[36:39], v[84:87]
ds_read_b64_tr_b16 v[220:221], v11 offset:36864
buffer_load_dwordx4 a[4:7], v1, s[44:47], s69 offen offset:1024 sc1
v_mfma_f32_16x16x32_bf16 v[88:91], v[152:155], a[36:39], v[88:91]
ds_read_b64_tr_b16 v[222:223], v11 offset:38912
v_mfma_f32_16x16x32_bf16 v[104:107], v[152:155], a[52:55], v[104:107]
ds_read_b64_tr_b16 v[224:225], v8 offset:40960
ds_read_b64_tr_b16 v[226:227], v8 offset:43008
v_mfma_f32_16x16x32_bf16 v[108:111], v[156:159], a[52:55], v[108:111]
ds_read_b64_tr_b16 v[228:229], v9 offset:40960
buffer_load_dwordx4 a[8:11], v1, s[44:47], s69 offen offset:2048 sc1
v_mfma_f32_16x16x32_bf16 v[92:95], v[156:159], a[36:39], v[92:95]
ds_read_b64_tr_b16 v[230:231], v9 offset:43008
v_mfma_f32_16x16x32_bf16 v[80:83], v[160:163], a[40:43], v[80:83]
ds_read_b64_tr_b16 v[232:233], v10 offset:40960
buffer_load_dwordx4 a[12:15], v1, s[44:47], s69 offen offset:3072 sc1
v_mfma_f32_16x16x32_bf16 v[96:99], v[160:163], a[56:59], v[96:99]
ds_read_b64_tr_b16 v[234:235], v10 offset:43008
ds_read_b64_tr_b16 v[236:237], v11 offset:40960
v_mfma_f32_16x16x32_bf16 v[100:103], v[164:167], a[56:59], v[100:103]
ds_read_b64_tr_b16 v[238:239], v11 offset:43008
s_add_u32 s69, s69, 0x20000
buffer_load_dwordx4 a[16:19], v1, s[44:47], s69 offen sc1
v_mfma_f32_16x16x32_bf16 v[84:87], v[164:167], a[40:43], v[84:87]
ds_read_b64_tr_b16 v[240:241], v8 offset:45056
v_mfma_f32_16x16x32_bf16 v[88:91], v[168:171], a[40:43], v[88:91]
ds_read_b64_tr_b16 v[242:243], v8 offset:47104
v_mfma_f32_16x16x32_bf16 v[104:107], v[168:171], a[56:59], v[104:107]
ds_read_b64_tr_b16 v[244:245], v9 offset:45056
ds_read_b64_tr_b16 v[246:247], v9 offset:47104
buffer_load_dwordx4 a[20:23], v1, s[44:47], s69 offen offset:1024 sc1
v_mfma_f32_16x16x32_bf16 v[108:111], v[172:175], a[56:59], v[108:111]
ds_read_b64_tr_b16 v[248:249], v10 offset:45056
v_mfma_f32_16x16x32_bf16 v[92:95], v[172:175], a[40:43], v[92:95]
ds_read_b64_tr_b16 v[250:251], v10 offset:47104
buffer_load_dwordx4 a[24:27], v1, s[44:47], s69 offen offset:2048 sc1
v_mfma_f32_16x16x32_bf16 v[80:83], v[176:179], a[44:47], v[80:83]
ds_read_b64_tr_b16 v[252:253], v11 offset:45056
v_mfma_f32_16x16x32_bf16 v[96:99], v[176:179], a[60:63], v[96:99]
ds_read_b64_tr_b16 v[254:255], v11 offset:47104
buffer_load_dwordx4 a[28:31], v1, s[44:47], s69 offen offset:3072 sc1
v_mfma_f32_16x16x32_bf16 v[100:103], v[180:183], a[60:63], v[100:103]
v_mfma_f32_16x16x32_bf16 v[84:87], v[180:183], a[44:47], v[84:87]
v_mfma_f32_16x16x32_bf16 v[88:91], v[184:187], a[44:47], v[88:91]
v_mfma_f32_16x16x32_bf16 v[104:107], v[184:187], a[60:63], v[104:107]
v_mfma_f32_16x16x32_bf16 v[108:111], v[188:191], a[60:63], v[108:111]
s_waitcnt vmcnt(24) lgkmcnt(0)
v_mfma_f32_16x16x32_bf16 v[92:95], v[188:191], a[44:47], v[92:95]
s_barrier
v_mfma_f32_16x16x32_bf16 v[80:83], v[192:195], a[64:67], v[80:83]
ds_read_b64_tr_b16 v[128:129], v8 offset:49152
ds_read_b64_tr_b16 v[130:131], v8 offset:51200
s_add_u32 s71, s61, 14
s_and_b32 s71, s71, 3
s_or_b32 s71, s71, 12
s_lshl_b32 s71, s71, 18
s_add_u32 s71, s71, s94
s_add_u32 m0, s64, 131072
s_add_u32 s72, s71, 0
buffer_load_dwordx4 v4, s[24:27], s72 offen lds
v_mfma_f32_16x16x32_bf16 v[96:99], v[192:195], a[80:83], v[96:99]
ds_read_b64_tr_b16 v[132:133], v9 offset:49152
v_mfma_f32_16x16x32_bf16 v[100:103], v[196:199], a[80:83], v[100:103]
ds_read_b64_tr_b16 v[134:135], v9 offset:51200
s_add_u32 s72, s71, 15360
buffer_load_dwordx4 v4, s[24:27], s72 offen offset:1024 lds
v_mfma_f32_16x16x32_bf16 v[84:87], v[196:199], a[64:67], v[84:87]
ds_read_b64_tr_b16 v[136:137], v10 offset:49152
v_mfma_f32_16x16x32_bf16 v[88:91], v[200:203], a[64:67], v[88:91]
ds_read_b64_tr_b16 v[138:139], v10 offset:51200
ds_read_b64_tr_b16 v[140:141], v11 offset:49152
s_add_u32 s72, s71, 30720
buffer_load_dwordx4 v4, s[24:27], s72 offen offset:2048 lds
v_mfma_f32_16x16x32_bf16 v[104:107], v[200:203], a[80:83], v[104:107]
ds_read_b64_tr_b16 v[142:143], v11 offset:51200
v_mfma_f32_16x16x32_bf16 v[108:111], v[204:207], a[80:83], v[108:111]
ds_read_b64_tr_b16 v[144:145], v8 offset:53248
v_mfma_f32_16x16x32_bf16 v[92:95], v[204:207], a[64:67], v[92:95]
ds_read_b64_tr_b16 v[146:147], v8 offset:55296
s_add_u32 s72, s71, 46080
buffer_load_dwordx4 v4, s[24:27], s72 offen offset:3072 lds
v_mfma_f32_16x16x32_bf16 v[80:83], v[208:211], a[68:71], v[80:83]
ds_read_b64_tr_b16 v[148:149], v9 offset:53248
ds_read_b64_tr_b16 v[150:151], v9 offset:55296
v_mfma_f32_16x16x32_bf16 v[96:99], v[208:211], a[84:87], v[96:99]
ds_read_b64_tr_b16 v[152:153], v10 offset:53248
s_add_u32 s69, s61, 13
s_and_b32 s69, s69, 3
s_or_b32 s69, s69, 12
s_lshl_b32 s69, s69, 12
s_add_u32 s69, s69, s95
buffer_load_dwordx4 a[32:35], v1, s[44:47], s69 offen sc1
v_mfma_f32_16x16x32_bf16 v[100:103], v[212:215], a[84:87], v[100:103]
ds_read_b64_tr_b16 v[154:155], v10 offset:55296
v_mfma_f32_16x16x32_bf16 v[84:87], v[212:215], a[68:71], v[84:87]
ds_read_b64_tr_b16 v[156:157], v11 offset:53248
buffer_load_dwordx4 a[36:39], v1, s[44:47], s69 offen offset:1024 sc1
v_mfma_f32_16x16x32_bf16 v[88:91], v[216:219], a[68:71], v[88:91]
ds_read_b64_tr_b16 v[158:159], v11 offset:55296
v_mfma_f32_16x16x32_bf16 v[104:107], v[216:219], a[84:87], v[104:107]
ds_read_b64_tr_b16 v[160:161], v8 offset:57344
ds_read_b64_tr_b16 v[162:163], v8 offset:59392
v_mfma_f32_16x16x32_bf16 v[108:111], v[220:223], a[84:87], v[108:111]
ds_read_b64_tr_b16 v[164:165], v9 offset:57344
buffer_load_dwordx4 a[40:43], v1, s[44:47], s69 offen offset:2048 sc1
v_mfma_f32_16x16x32_bf16 v[92:95], v[220:223], a[68:71], v[92:95]
ds_read_b64_tr_b16 v[166:167], v9 offset:59392
v_mfma_f32_16x16x32_bf16 v[80:83], v[224:227], a[72:75], v[80:83]
ds_read_b64_tr_b16 v[168:169], v10 offset:57344
buffer_load_dwordx4 a[44:47], v1, s[44:47], s69 offen offset:3072 sc1
v_mfma_f32_16x16x32_bf16 v[96:99], v[224:227], a[88:91], v[96:99]
ds_read_b64_tr_b16 v[170:171], v10 offset:59392
ds_read_b64_tr_b16 v[172:173], v11 offset:57344
v_mfma_f32_16x16x32_bf16 v[100:103], v[228:231], a[88:91], v[100:103]
ds_read_b64_tr_b16 v[174:175], v11 offset:59392
s_add_u32 s69, s69, 0x20000
buffer_load_dwordx4 a[48:51], v1, s[44:47], s69 offen sc1
v_mfma_f32_16x16x32_bf16 v[84:87], v[228:231], a[72:75], v[84:87]
ds_read_b64_tr_b16 v[176:177], v8 offset:61440
v_mfma_f32_16x16x32_bf16 v[88:91], v[232:235], a[72:75], v[88:91]
ds_read_b64_tr_b16 v[178:179], v8 offset:63488
v_mfma_f32_16x16x32_bf16 v[104:107], v[232:235], a[88:91], v[104:107]
ds_read_b64_tr_b16 v[180:181], v9 offset:61440
ds_read_b64_tr_b16 v[182:183], v9 offset:63488
buffer_load_dwordx4 a[52:55], v1, s[44:47], s69 offen offset:1024 sc1
v_mfma_f32_16x16x32_bf16 v[108:111], v[236:239], a[88:91], v[108:111]
ds_read_b64_tr_b16 v[184:185], v10 offset:61440
v_mfma_f32_16x16x32_bf16 v[92:95], v[236:239], a[72:75], v[92:95]
ds_read_b64_tr_b16 v[186:187], v10 offset:63488
buffer_load_dwordx4 a[56:59], v1, s[44:47], s69 offen offset:2048 sc1
v_mfma_f32_16x16x32_bf16 v[80:83], v[240:243], a[76:79], v[80:83]
ds_read_b64_tr_b16 v[188:189], v11 offset:61440
v_mfma_f32_16x16x32_bf16 v[96:99], v[240:243], a[92:95], v[96:99]
ds_read_b64_tr_b16 v[190:191], v11 offset:63488
buffer_load_dwordx4 a[60:63], v1, s[44:47], s69 offen offset:3072 sc1
v_mfma_f32_16x16x32_bf16 v[100:103], v[244:247], a[92:95], v[100:103]
v_mfma_f32_16x16x32_bf16 v[84:87], v[244:247], a[76:79], v[84:87]
v_mfma_f32_16x16x32_bf16 v[88:91], v[248:251], a[76:79], v[88:91]
v_mfma_f32_16x16x32_bf16 v[104:107], v[248:251], a[92:95], v[104:107]
v_mfma_f32_16x16x32_bf16 v[108:111], v[252:255], a[92:95], v[108:111]
s_waitcnt vmcnt(24) lgkmcnt(0)
v_mfma_f32_16x16x32_bf16 v[92:95], v[252:255], a[76:79], v[92:95]
s_barrier
v_mfma_f32_16x16x32_bf16 v[80:83], v[128:131], a[96:99], v[80:83]
ds_read_b64_tr_b16 v[192:193], v8 offset:0
ds_read_b64_tr_b16 v[194:195], v8 offset:2048
s_add_u32 s71, s61, 15
s_and_b32 s71, s71, 3
s_or_b32 s71, s71, 12
s_lshl_b32 s71, s71, 18
s_add_u32 s71, s71, s94
s_add_u32 m0, s64, 147456
s_add_u32 s72, s71, 0
buffer_load_dwordx4 v4, s[24:27], s72 offen lds
v_mfma_f32_16x16x32_bf16 v[96:99], v[128:131], a[112:115], v[96:99]
ds_read_b64_tr_b16 v[196:197], v9 offset:0
v_mfma_f32_16x16x32_bf16 v[100:103], v[132:135], a[112:115], v[100:103]
ds_read_b64_tr_b16 v[198:199], v9 offset:2048
s_add_u32 s72, s71, 15360
buffer_load_dwordx4 v4, s[24:27], s72 offen offset:1024 lds
v_mfma_f32_16x16x32_bf16 v[84:87], v[132:135], a[96:99], v[84:87]
ds_read_b64_tr_b16 v[200:201], v10 offset:0
v_mfma_f32_16x16x32_bf16 v[88:91], v[136:139], a[96:99], v[88:91]
ds_read_b64_tr_b16 v[202:203], v10 offset:2048
ds_read_b64_tr_b16 v[204:205], v11 offset:0
s_add_u32 s72, s71, 30720
buffer_load_dwordx4 v4, s[24:27], s72 offen offset:2048 lds
v_mfma_f32_16x16x32_bf16 v[104:107], v[136:139], a[112:115], v[104:107]
ds_read_b64_tr_b16 v[206:207], v11 offset:2048
v_mfma_f32_16x16x32_bf16 v[108:111], v[140:143], a[112:115], v[108:111]
ds_read_b64_tr_b16 v[208:209], v8 offset:4096
v_mfma_f32_16x16x32_bf16 v[92:95], v[140:143], a[96:99], v[92:95]
ds_read_b64_tr_b16 v[210:211], v8 offset:6144
s_add_u32 s72, s71, 46080
buffer_load_dwordx4 v4, s[24:27], s72 offen offset:3072 lds
v_mfma_f32_16x16x32_bf16 v[80:83], v[144:147], a[100:103], v[80:83]
ds_read_b64_tr_b16 v[212:213], v9 offset:4096
ds_read_b64_tr_b16 v[214:215], v9 offset:6144
v_mfma_f32_16x16x32_bf16 v[96:99], v[144:147], a[116:119], v[96:99]
ds_read_b64_tr_b16 v[216:217], v10 offset:4096
s_add_u32 s69, s61, 14
s_and_b32 s69, s69, 3
s_or_b32 s69, s69, 12
s_lshl_b32 s69, s69, 12
s_add_u32 s69, s69, s95
buffer_load_dwordx4 a[64:67], v1, s[44:47], s69 offen sc1
v_mfma_f32_16x16x32_bf16 v[100:103], v[148:151], a[116:119], v[100:103]
ds_read_b64_tr_b16 v[218:219], v10 offset:6144
v_mfma_f32_16x16x32_bf16 v[84:87], v[148:151], a[100:103], v[84:87]
ds_read_b64_tr_b16 v[220:221], v11 offset:4096
buffer_load_dwordx4 a[68:71], v1, s[44:47], s69 offen offset:1024 sc1
v_mfma_f32_16x16x32_bf16 v[88:91], v[152:155], a[100:103], v[88:91]
ds_read_b64_tr_b16 v[222:223], v11 offset:6144
v_mfma_f32_16x16x32_bf16 v[104:107], v[152:155], a[116:119], v[104:107]
ds_read_b64_tr_b16 v[224:225], v8 offset:8192
ds_read_b64_tr_b16 v[226:227], v8 offset:10240
v_mfma_f32_16x16x32_bf16 v[108:111], v[156:159], a[116:119], v[108:111]
ds_read_b64_tr_b16 v[228:229], v9 offset:8192
buffer_load_dwordx4 a[72:75], v1, s[44:47], s69 offen offset:2048 sc1
v_mfma_f32_16x16x32_bf16 v[92:95], v[156:159], a[100:103], v[92:95]
ds_read_b64_tr_b16 v[230:231], v9 offset:10240
v_mfma_f32_16x16x32_bf16 v[80:83], v[160:163], a[104:107], v[80:83]
ds_read_b64_tr_b16 v[232:233], v10 offset:8192
buffer_load_dwordx4 a[76:79], v1, s[44:47], s69 offen offset:3072 sc1
v_mfma_f32_16x16x32_bf16 v[96:99], v[160:163], a[120:123], v[96:99]
ds_read_b64_tr_b16 v[234:235], v10 offset:10240
ds_read_b64_tr_b16 v[236:237], v11 offset:8192
v_mfma_f32_16x16x32_bf16 v[100:103], v[164:167], a[120:123], v[100:103]
ds_read_b64_tr_b16 v[238:239], v11 offset:10240
s_add_u32 s69, s69, 0x20000
buffer_load_dwordx4 a[80:83], v1, s[44:47], s69 offen sc1
v_mfma_f32_16x16x32_bf16 v[84:87], v[164:167], a[104:107], v[84:87]
ds_read_b64_tr_b16 v[240:241], v8 offset:12288
v_mfma_f32_16x16x32_bf16 v[88:91], v[168:171], a[104:107], v[88:91]
ds_read_b64_tr_b16 v[242:243], v8 offset:14336
v_mfma_f32_16x16x32_bf16 v[104:107], v[168:171], a[120:123], v[104:107]
ds_read_b64_tr_b16 v[244:245], v9 offset:12288
ds_read_b64_tr_b16 v[246:247], v9 offset:14336
buffer_load_dwordx4 a[84:87], v1, s[44:47], s69 offen offset:1024 sc1
v_mfma_f32_16x16x32_bf16 v[108:111], v[172:175], a[120:123], v[108:111]
ds_read_b64_tr_b16 v[248:249], v10 offset:12288
v_mfma_f32_16x16x32_bf16 v[92:95], v[172:175], a[104:107], v[92:95]
ds_read_b64_tr_b16 v[250:251], v10 offset:14336
buffer_load_dwordx4 a[88:91], v1, s[44:47], s69 offen offset:2048 sc1
v_mfma_f32_16x16x32_bf16 v[80:83], v[176:179], a[108:111], v[80:83]
ds_read_b64_tr_b16 v[252:253], v11 offset:12288
v_mfma_f32_16x16x32_bf16 v[96:99], v[176:179], a[124:127], v[96:99]
ds_read_b64_tr_b16 v[254:255], v11 offset:14336
buffer_load_dwordx4 a[92:95], v1, s[44:47], s69 offen offset:3072 sc1
v_mfma_f32_16x16x32_bf16 v[100:103], v[180:183], a[124:127], v[100:103]
v_mfma_f32_16x16x32_bf16 v[84:87], v[180:183], a[108:111], v[84:87]
v_mfma_f32_16x16x32_bf16 v[88:91], v[184:187], a[108:111], v[88:91]
v_mfma_f32_16x16x32_bf16 v[104:107], v[184:187], a[124:127], v[104:107]
v_mfma_f32_16x16x32_bf16 v[108:111], v[188:191], a[124:127], v[108:111]
s_waitcnt vmcnt(24) lgkmcnt(0)
v_mfma_f32_16x16x32_bf16 v[92:95], v[188:191], a[108:111], v[92:95]
s_barrier
v_mfma_f32_16x16x32_bf16 v[80:83], v[192:195], a[0:3], v[80:83]
ds_read_b64_tr_b16 v[128:129], v8 offset:16384
ds_read_b64_tr_b16 v[130:131], v8 offset:18432
s_add_u32 s71, s61, 16
s_and_b32 s71, s71, 3
s_or_b32 s71, s71, 16
s_lshl_b32 s71, s71, 18
s_add_u32 s71, s71, s94
s_add_u32 m0, s64, 98304
s_add_u32 s72, s71, 0
buffer_load_dwordx4 v4, s[24:27], s72 offen lds
v_mfma_f32_16x16x32_bf16 v[96:99], v[192:195], a[16:19], v[96:99]
ds_read_b64_tr_b16 v[132:133], v9 offset:16384
v_mfma_f32_16x16x32_bf16 v[100:103], v[196:199], a[16:19], v[100:103]
ds_read_b64_tr_b16 v[134:135], v9 offset:18432
s_add_u32 s72, s71, 15360
buffer_load_dwordx4 v4, s[24:27], s72 offen offset:1024 lds
v_mfma_f32_16x16x32_bf16 v[84:87], v[196:199], a[0:3], v[84:87]
ds_read_b64_tr_b16 v[136:137], v10 offset:16384
v_mfma_f32_16x16x32_bf16 v[88:91], v[200:203], a[0:3], v[88:91]
ds_read_b64_tr_b16 v[138:139], v10 offset:18432
ds_read_b64_tr_b16 v[140:141], v11 offset:16384
s_add_u32 s72, s71, 30720
buffer_load_dwordx4 v4, s[24:27], s72 offen offset:2048 lds
v_mfma_f32_16x16x32_bf16 v[104:107], v[200:203], a[16:19], v[104:107]
ds_read_b64_tr_b16 v[142:143], v11 offset:18432
v_mfma_f32_16x16x32_bf16 v[108:111], v[204:207], a[16:19], v[108:111]
ds_read_b64_tr_b16 v[144:145], v8 offset:20480
v_mfma_f32_16x16x32_bf16 v[92:95], v[204:207], a[0:3], v[92:95]
ds_read_b64_tr_b16 v[146:147], v8 offset:22528
s_add_u32 s72, s71, 46080
buffer_load_dwordx4 v4, s[24:27], s72 offen offset:3072 lds
v_mfma_f32_16x16x32_bf16 v[80:83], v[208:211], a[4:7], v[80:83]
ds_read_b64_tr_b16 v[148:149], v9 offset:20480
ds_read_b64_tr_b16 v[150:151], v9 offset:22528
v_mfma_f32_16x16x32_bf16 v[96:99], v[208:211], a[20:23], v[96:99]
ds_read_b64_tr_b16 v[152:153], v10 offset:20480
s_add_u32 s69, s61, 15
s_and_b32 s69, s69, 3
s_or_b32 s69, s69, 12
s_lshl_b32 s69, s69, 12
s_add_u32 s69, s69, s95
buffer_load_dwordx4 a[96:99], v1, s[44:47], s69 offen sc1
v_mfma_f32_16x16x32_bf16 v[100:103], v[212:215], a[20:23], v[100:103]
ds_read_b64_tr_b16 v[154:155], v10 offset:22528
v_mfma_f32_16x16x32_bf16 v[84:87], v[212:215], a[4:7], v[84:87]
ds_read_b64_tr_b16 v[156:157], v11 offset:20480
buffer_load_dwordx4 a[100:103], v1, s[44:47], s69 offen offset:1024 sc1
v_mfma_f32_16x16x32_bf16 v[88:91], v[216:219], a[4:7], v[88:91]
ds_read_b64_tr_b16 v[158:159], v11 offset:22528
v_mfma_f32_16x16x32_bf16 v[104:107], v[216:219], a[20:23], v[104:107]
ds_read_b64_tr_b16 v[160:161], v8 offset:24576
ds_read_b64_tr_b16 v[162:163], v8 offset:26624
v_mfma_f32_16x16x32_bf16 v[108:111], v[220:223], a[20:23], v[108:111]
ds_read_b64_tr_b16 v[164:165], v9 offset:24576
buffer_load_dwordx4 a[104:107], v1, s[44:47], s69 offen offset:2048 sc1
v_mfma_f32_16x16x32_bf16 v[92:95], v[220:223], a[4:7], v[92:95]
ds_read_b64_tr_b16 v[166:167], v9 offset:26624
v_mfma_f32_16x16x32_bf16 v[80:83], v[224:227], a[8:11], v[80:83]
ds_read_b64_tr_b16 v[168:169], v10 offset:24576
buffer_load_dwordx4 a[108:111], v1, s[44:47], s69 offen offset:3072 sc1
v_mfma_f32_16x16x32_bf16 v[96:99], v[224:227], a[24:27], v[96:99]
ds_read_b64_tr_b16 v[170:171], v10 offset:26624
ds_read_b64_tr_b16 v[172:173], v11 offset:24576
v_mfma_f32_16x16x32_bf16 v[100:103], v[228:231], a[24:27], v[100:103]
ds_read_b64_tr_b16 v[174:175], v11 offset:26624
s_add_u32 s69, s69, 0x20000
buffer_load_dwordx4 a[112:115], v1, s[44:47], s69 offen sc1
v_mfma_f32_16x16x32_bf16 v[84:87], v[228:231], a[8:11], v[84:87]
ds_read_b64_tr_b16 v[176:177], v8 offset:28672
v_mfma_f32_16x16x32_bf16 v[88:91], v[232:235], a[8:11], v[88:91]
ds_read_b64_tr_b16 v[178:179], v8 offset:30720
v_mfma_f32_16x16x32_bf16 v[104:107], v[232:235], a[24:27], v[104:107]
ds_read_b64_tr_b16 v[180:181], v9 offset:28672
ds_read_b64_tr_b16 v[182:183], v9 offset:30720
buffer_load_dwordx4 a[116:119], v1, s[44:47], s69 offen offset:1024 sc1
v_mfma_f32_16x16x32_bf16 v[108:111], v[236:239], a[24:27], v[108:111]
ds_read_b64_tr_b16 v[184:185], v10 offset:28672
v_mfma_f32_16x16x32_bf16 v[92:95], v[236:239], a[8:11], v[92:95]
ds_read_b64_tr_b16 v[186:187], v10 offset:30720
buffer_load_dwordx4 a[120:123], v1, s[44:47], s69 offen offset:2048 sc1
v_mfma_f32_16x16x32_bf16 v[80:83], v[240:243], a[12:15], v[80:83]
ds_read_b64_tr_b16 v[188:189], v11 offset:28672
v_mfma_f32_16x16x32_bf16 v[96:99], v[240:243], a[28:31], v[96:99]
ds_read_b64_tr_b16 v[190:191], v11 offset:30720
buffer_load_dwordx4 a[124:127], v1, s[44:47], s69 offen offset:3072 sc1
v_mfma_f32_16x16x32_bf16 v[100:103], v[244:247], a[28:31], v[100:103]
v_mfma_f32_16x16x32_bf16 v[84:87], v[244:247], a[12:15], v[84:87]
v_mfma_f32_16x16x32_bf16 v[88:91], v[248:251], a[12:15], v[88:91]
v_mfma_f32_16x16x32_bf16 v[104:107], v[248:251], a[28:31], v[104:107]
v_mfma_f32_16x16x32_bf16 v[108:111], v[252:255], a[28:31], v[108:111]
s_waitcnt vmcnt(24) lgkmcnt(0)
v_mfma_f32_16x16x32_bf16 v[92:95], v[252:255], a[12:15], v[92:95]
s_barrier
v_mfma_f32_16x16x32_bf16 v[80:83], v[128:131], a[32:35], v[80:83]
ds_read_b64_tr_b16 v[192:193], v8 offset:32768
ds_read_b64_tr_b16 v[194:195], v8 offset:34816
s_add_u32 s71, s61, 17
s_and_b32 s71, s71, 3
s_or_b32 s71, s71, 16
s_lshl_b32 s71, s71, 18
s_add_u32 s71, s71, s94
s_add_u32 m0, s64, 114688
s_add_u32 s72, s71, 0
buffer_load_dwordx4 v4, s[24:27], s72 offen lds
v_mfma_f32_16x16x32_bf16 v[96:99], v[128:131], a[48:51], v[96:99]
ds_read_b64_tr_b16 v[196:197], v9 offset:32768
v_mfma_f32_16x16x32_bf16 v[100:103], v[132:135], a[48:51], v[100:103]
ds_read_b64_tr_b16 v[198:199], v9 offset:34816
s_add_u32 s72, s71, 15360
buffer_load_dwordx4 v4, s[24:27], s72 offen offset:1024 lds
v_mfma_f32_16x16x32_bf16 v[84:87], v[132:135], a[32:35], v[84:87]
ds_read_b64_tr_b16 v[200:201], v10 offset:32768
v_mfma_f32_16x16x32_bf16 v[88:91], v[136:139], a[32:35], v[88:91]
ds_read_b64_tr_b16 v[202:203], v10 offset:34816
ds_read_b64_tr_b16 v[204:205], v11 offset:32768
s_add_u32 s72, s71, 30720
buffer_load_dwordx4 v4, s[24:27], s72 offen offset:2048 lds
v_mfma_f32_16x16x32_bf16 v[104:107], v[136:139], a[48:51], v[104:107]
ds_read_b64_tr_b16 v[206:207], v11 offset:34816
v_mfma_f32_16x16x32_bf16 v[108:111], v[140:143], a[48:51], v[108:111]
ds_read_b64_tr_b16 v[208:209], v8 offset:36864
v_mfma_f32_16x16x32_bf16 v[92:95], v[140:143], a[32:35], v[92:95]
ds_read_b64_tr_b16 v[210:211], v8 offset:38912
s_add_u32 s72, s71, 46080
buffer_load_dwordx4 v4, s[24:27], s72 offen offset:3072 lds
v_mfma_f32_16x16x32_bf16 v[80:83], v[144:147], a[36:39], v[80:83]
ds_read_b64_tr_b16 v[212:213], v9 offset:36864
ds_read_b64_tr_b16 v[214:215], v9 offset:38912
v_mfma_f32_16x16x32_bf16 v[96:99], v[144:147], a[52:55], v[96:99]
ds_read_b64_tr_b16 v[216:217], v10 offset:36864
s_add_u32 s69, s61, 16
s_and_b32 s69, s69, 3
s_or_b32 s69, s69, 16
s_lshl_b32 s69, s69, 12
s_add_u32 s69, s69, s95
buffer_load_dwordx4 a[0:3], v1, s[44:47], s69 offen sc1
v_mfma_f32_16x16x32_bf16 v[100:103], v[148:151], a[52:55], v[100:103]
ds_read_b64_tr_b16 v[218:219], v10 offset:38912
v_mfma_f32_16x16x32_bf16 v[84:87], v[148:151], a[36:39], v[84:87]
ds_read_b64_tr_b16 v[220:221], v11 offset:36864
buffer_load_dwordx4 a[4:7], v1, s[44:47], s69 offen offset:1024 sc1
v_mfma_f32_16x16x32_bf16 v[88:91], v[152:155], a[36:39], v[88:91]
ds_read_b64_tr_b16 v[222:223], v11 offset:38912
v_mfma_f32_16x16x32_bf16 v[104:107], v[152:155], a[52:55], v[104:107]
ds_read_b64_tr_b16 v[224:225], v8 offset:40960
ds_read_b64_tr_b16 v[226:227], v8 offset:43008
v_mfma_f32_16x16x32_bf16 v[108:111], v[156:159], a[52:55], v[108:111]
ds_read_b64_tr_b16 v[228:229], v9 offset:40960
buffer_load_dwordx4 a[8:11], v1, s[44:47], s69 offen offset:2048 sc1
v_mfma_f32_16x16x32_bf16 v[92:95], v[156:159], a[36:39], v[92:95]
ds_read_b64_tr_b16 v[230:231], v9 offset:43008
v_mfma_f32_16x16x32_bf16 v[80:83], v[160:163], a[40:43], v[80:83]
ds_read_b64_tr_b16 v[232:233], v10 offset:40960
buffer_load_dwordx4 a[12:15], v1, s[44:47], s69 offen offset:3072 sc1
v_mfma_f32_16x16x32_bf16 v[96:99], v[160:163], a[56:59], v[96:99]
ds_read_b64_tr_b16 v[234:235], v10 offset:43008
ds_read_b64_tr_b16 v[236:237], v11 offset:40960
v_mfma_f32_16x16x32_bf16 v[100:103], v[164:167], a[56:59], v[100:103]
ds_read_b64_tr_b16 v[238:239], v11 offset:43008
s_add_u32 s69, s69, 0x20000
buffer_load_dwordx4 a[16:19], v1, s[44:47], s69 offen sc1
v_mfma_f32_16x16x32_bf16 v[84:87], v[164:167], a[40:43], v[84:87]
ds_read_b64_tr_b16 v[240:241], v8 offset:45056
v_mfma_f32_16x16x32_bf16 v[88:91], v[168:171], a[40:43], v[88:91]
ds_read_b64_tr_b16 v[242:243], v8 offset:47104
v_mfma_f32_16x16x32_bf16 v[104:107], v[168:171], a[56:59], v[104:107]
ds_read_b64_tr_b16 v[244:245], v9 offset:45056
ds_read_b64_tr_b16 v[246:247], v9 offset:47104
buffer_load_dwordx4 a[20:23], v1, s[44:47], s69 offen offset:1024 sc1
v_mfma_f32_16x16x32_bf16 v[108:111], v[172:175], a[56:59], v[108:111]
ds_read_b64_tr_b16 v[248:249], v10 offset:45056
v_mfma_f32_16x16x32_bf16 v[92:95], v[172:175], a[40:43], v[92:95]
ds_read_b64_tr_b16 v[250:251], v10 offset:47104
buffer_load_dwordx4 a[24:27], v1, s[44:47], s69 offen offset:2048 sc1
v_mfma_f32_16x16x32_bf16 v[80:83], v[176:179], a[44:47], v[80:83]
ds_read_b64_tr_b16 v[252:253], v11 offset:45056
v_mfma_f32_16x16x32_bf16 v[96:99], v[176:179], a[60:63], v[96:99]
ds_read_b64_tr_b16 v[254:255], v11 offset:47104
buffer_load_dwordx4 a[28:31], v1, s[44:47], s69 offen offset:3072 sc1
v_mfma_f32_16x16x32_bf16 v[100:103], v[180:183], a[60:63], v[100:103]
v_mfma_f32_16x16x32_bf16 v[84:87], v[180:183], a[44:47], v[84:87]
v_mfma_f32_16x16x32_bf16 v[88:91], v[184:187], a[44:47], v[88:91]
v_mfma_f32_16x16x32_bf16 v[104:107], v[184:187], a[60:63], v[104:107]
v_mfma_f32_16x16x32_bf16 v[108:111], v[188:191], a[60:63], v[108:111]
s_waitcnt vmcnt(24) lgkmcnt(0)
v_mfma_f32_16x16x32_bf16 v[92:95], v[188:191], a[44:47], v[92:95]
s_barrier
v_mfma_f32_16x16x32_bf16 v[80:83], v[192:195], a[64:67], v[80:83]
ds_read_b64_tr_b16 v[128:129], v8 offset:49152
ds_read_b64_tr_b16 v[130:131], v8 offset:51200
s_add_u32 s71, s61, 18
s_and_b32 s71, s71, 3
s_or_b32 s71, s71, 16
s_lshl_b32 s71, s71, 18
s_add_u32 s71, s71, s94
s_add_u32 m0, s64, 131072
s_add_u32 s72, s71, 0
buffer_load_dwordx4 v4, s[24:27], s72 offen lds
v_mfma_f32_16x16x32_bf16 v[96:99], v[192:195], a[80:83], v[96:99]
ds_read_b64_tr_b16 v[132:133], v9 offset:49152
v_mfma_f32_16x16x32_bf16 v[100:103], v[196:199], a[80:83], v[100:103]
ds_read_b64_tr_b16 v[134:135], v9 offset:51200
s_add_u32 s72, s71, 15360
buffer_load_dwordx4 v4, s[24:27], s72 offen offset:1024 lds
v_mfma_f32_16x16x32_bf16 v[84:87], v[196:199], a[64:67], v[84:87]
ds_read_b64_tr_b16 v[136:137], v10 offset:49152
v_mfma_f32_16x16x32_bf16 v[88:91], v[200:203], a[64:67], v[88:91]
ds_read_b64_tr_b16 v[138:139], v10 offset:51200
ds_read_b64_tr_b16 v[140:141], v11 offset:49152
s_add_u32 s72, s71, 30720
buffer_load_dwordx4 v4, s[24:27], s72 offen offset:2048 lds
v_mfma_f32_16x16x32_bf16 v[104:107], v[200:203], a[80:83], v[104:107]
ds_read_b64_tr_b16 v[142:143], v11 offset:51200
v_mfma_f32_16x16x32_bf16 v[108:111], v[204:207], a[80:83], v[108:111]
ds_read_b64_tr_b16 v[144:145], v8 offset:53248
v_mfma_f32_16x16x32_bf16 v[92:95], v[204:207], a[64:67], v[92:95]
ds_read_b64_tr_b16 v[146:147], v8 offset:55296
s_add_u32 s72, s71, 46080
buffer_load_dwordx4 v4, s[24:27], s72 offen offset:3072 lds
v_mfma_f32_16x16x32_bf16 v[80:83], v[208:211], a[68:71], v[80:83]
ds_read_b64_tr_b16 v[148:149], v9 offset:53248
ds_read_b64_tr_b16 v[150:151], v9 offset:55296
v_mfma_f32_16x16x32_bf16 v[96:99], v[208:211], a[84:87], v[96:99]
ds_read_b64_tr_b16 v[152:153], v10 offset:53248
s_add_u32 s69, s61, 17
s_and_b32 s69, s69, 3
s_or_b32 s69, s69, 16
s_lshl_b32 s69, s69, 12
s_add_u32 s69, s69, s95
buffer_load_dwordx4 a[32:35], v1, s[44:47], s69 offen sc1
v_mfma_f32_16x16x32_bf16 v[100:103], v[212:215], a[84:87], v[100:103]
ds_read_b64_tr_b16 v[154:155], v10 offset:55296
v_mfma_f32_16x16x32_bf16 v[84:87], v[212:215], a[68:71], v[84:87]
ds_read_b64_tr_b16 v[156:157], v11 offset:53248
buffer_load_dwordx4 a[36:39], v1, s[44:47], s69 offen offset:1024 sc1
v_mfma_f32_16x16x32_bf16 v[88:91], v[216:219], a[68:71], v[88:91]
ds_read_b64_tr_b16 v[158:159], v11 offset:55296
v_mfma_f32_16x16x32_bf16 v[104:107], v[216:219], a[84:87], v[104:107]
ds_read_b64_tr_b16 v[160:161], v8 offset:57344
ds_read_b64_tr_b16 v[162:163], v8 offset:59392
v_mfma_f32_16x16x32_bf16 v[108:111], v[220:223], a[84:87], v[108:111]
ds_read_b64_tr_b16 v[164:165], v9 offset:57344
buffer_load_dwordx4 a[40:43], v1, s[44:47], s69 offen offset:2048 sc1
v_mfma_f32_16x16x32_bf16 v[92:95], v[220:223], a[68:71], v[92:95]
ds_read_b64_tr_b16 v[166:167], v9 offset:59392
v_mfma_f32_16x16x32_bf16 v[80:83], v[224:227], a[72:75], v[80:83]
ds_read_b64_tr_b16 v[168:169], v10 offset:57344
buffer_load_dwordx4 a[44:47], v1, s[44:47], s69 offen offset:3072 sc1
v_mfma_f32_16x16x32_bf16 v[96:99], v[224:227], a[88:91], v[96:99]
ds_read_b64_tr_b16 v[170:171], v10 offset:59392
ds_read_b64_tr_b16 v[172:173], v11 offset:57344
v_mfma_f32_16x16x32_bf16 v[100:103], v[228:231], a[88:91], v[100:103]
ds_read_b64_tr_b16 v[174:175], v11 offset:59392
s_add_u32 s69, s69, 0x20000
buffer_load_dwordx4 a[48:51], v1, s[44:47], s69 offen sc1
v_mfma_f32_16x16x32_bf16 v[84:87], v[228:231], a[72:75], v[84:87]
ds_read_b64_tr_b16 v[176:177], v8 offset:61440
v_mfma_f32_16x16x32_bf16 v[88:91], v[232:235], a[72:75], v[88:91]
ds_read_b64_tr_b16 v[178:179], v8 offset:63488
v_mfma_f32_16x16x32_bf16 v[104:107], v[232:235], a[88:91], v[104:107]
ds_read_b64_tr_b16 v[180:181], v9 offset:61440
ds_read_b64_tr_b16 v[182:183], v9 offset:63488
buffer_load_dwordx4 a[52:55], v1, s[44:47], s69 offen offset:1024 sc1
v_mfma_f32_16x16x32_bf16 v[108:111], v[236:239], a[88:91], v[108:111]
ds_read_b64_tr_b16 v[184:185], v10 offset:61440
v_mfma_f32_16x16x32_bf16 v[92:95], v[236:239], a[72:75], v[92:95]
ds_read_b64_tr_b16 v[186:187], v10 offset:63488
buffer_load_dwordx4 a[56:59], v1, s[44:47], s69 offen offset:2048 sc1
v_mfma_f32_16x16x32_bf16 v[80:83], v[240:243], a[76:79], v[80:83]
ds_read_b64_tr_b16 v[188:189], v11 offset:61440
v_mfma_f32_16x16x32_bf16 v[96:99], v[240:243], a[92:95], v[96:99]
ds_read_b64_tr_b16 v[190:191], v11 offset:63488
buffer_load_dwordx4 a[60:63], v1, s[44:47], s69 offen offset:3072 sc1
v_mfma_f32_16x16x32_bf16 v[100:103], v[244:247], a[92:95], v[100:103]
v_mfma_f32_16x16x32_bf16 v[84:87], v[244:247], a[76:79], v[84:87]
v_mfma_f32_16x16x32_bf16 v[88:91], v[248:251], a[76:79], v[88:91]
v_mfma_f32_16x16x32_bf16 v[104:107], v[248:251], a[92:95], v[104:107]
v_mfma_f32_16x16x32_bf16 v[108:111], v[252:255], a[92:95], v[108:111]
s_waitcnt vmcnt(24) lgkmcnt(0)
v_mfma_f32_16x16x32_bf16 v[92:95], v[252:255], a[76:79], v[92:95]
s_barrier
v_mfma_f32_16x16x32_bf16 v[80:83], v[128:131], a[96:99], v[80:83]
ds_read_b64_tr_b16 v[192:193], v8 offset:0
ds_read_b64_tr_b16 v[194:195], v8 offset:2048
s_add_u32 s71, s61, 19
s_and_b32 s71, s71, 3
s_or_b32 s71, s71, 16
s_lshl_b32 s71, s71, 18
s_add_u32 s71, s71, s94
s_add_u32 m0, s64, 147456
s_add_u32 s72, s71, 0
buffer_load_dwordx4 v4, s[24:27], s72 offen lds
v_mfma_f32_16x16x32_bf16 v[96:99], v[128:131], a[112:115], v[96:99]
ds_read_b64_tr_b16 v[196:197], v9 offset:0
v_mfma_f32_16x16x32_bf16 v[100:103], v[132:135], a[112:115], v[100:103]
ds_read_b64_tr_b16 v[198:199], v9 offset:2048
s_add_u32 s72, s71, 15360
buffer_load_dwordx4 v4, s[24:27], s72 offen offset:1024 lds
v_mfma_f32_16x16x32_bf16 v[84:87], v[132:135], a[96:99], v[84:87]
ds_read_b64_tr_b16 v[200:201], v10 offset:0
v_mfma_f32_16x16x32_bf16 v[88:91], v[136:139], a[96:99], v[88:91]
ds_read_b64_tr_b16 v[202:203], v10 offset:2048
ds_read_b64_tr_b16 v[204:205], v11 offset:0
s_add_u32 s72, s71, 30720
buffer_load_dwordx4 v4, s[24:27], s72 offen offset:2048 lds
v_mfma_f32_16x16x32_bf16 v[104:107], v[136:139], a[112:115], v[104:107]
ds_read_b64_tr_b16 v[206:207], v11 offset:2048
v_mfma_f32_16x16x32_bf16 v[108:111], v[140:143], a[112:115], v[108:111]
ds_read_b64_tr_b16 v[208:209], v8 offset:4096
v_mfma_f32_16x16x32_bf16 v[92:95], v[140:143], a[96:99], v[92:95]
ds_read_b64_tr_b16 v[210:211], v8 offset:6144
s_add_u32 s72, s71, 46080
buffer_load_dwordx4 v4, s[24:27], s72 offen offset:3072 lds
v_mfma_f32_16x16x32_bf16 v[80:83], v[144:147], a[100:103], v[80:83]
ds_read_b64_tr_b16 v[212:213], v9 offset:4096
ds_read_b64_tr_b16 v[214:215], v9 offset:6144
v_mfma_f32_16x16x32_bf16 v[96:99], v[144:147], a[116:119], v[96:99]
ds_read_b64_tr_b16 v[216:217], v10 offset:4096
s_add_u32 s69, s61, 18
s_and_b32 s69, s69, 3
s_or_b32 s69, s69, 16
s_lshl_b32 s69, s69, 12
s_add_u32 s69, s69, s95
buffer_load_dwordx4 a[64:67], v1, s[44:47], s69 offen sc1
v_mfma_f32_16x16x32_bf16 v[100:103], v[148:151], a[116:119], v[100:103]
ds_read_b64_tr_b16 v[218:219], v10 offset:6144
v_mfma_f32_16x16x32_bf16 v[84:87], v[148:151], a[100:103], v[84:87]
ds_read_b64_tr_b16 v[220:221], v11 offset:4096
buffer_load_dwordx4 a[68:71], v1, s[44:47], s69 offen offset:1024 sc1
v_mfma_f32_16x16x32_bf16 v[88:91], v[152:155], a[100:103], v[88:91]
ds_read_b64_tr_b16 v[222:223], v11 offset:6144
v_mfma_f32_16x16x32_bf16 v[104:107], v[152:155], a[116:119], v[104:107]
ds_read_b64_tr_b16 v[224:225], v8 offset:8192
ds_read_b64_tr_b16 v[226:227], v8 offset:10240
v_mfma_f32_16x16x32_bf16 v[108:111], v[156:159], a[116:119], v[108:111]
ds_read_b64_tr_b16 v[228:229], v9 offset:8192
buffer_load_dwordx4 a[72:75], v1, s[44:47], s69 offen offset:2048 sc1
v_mfma_f32_16x16x32_bf16 v[92:95], v[156:159], a[100:103], v[92:95]
ds_read_b64_tr_b16 v[230:231], v9 offset:10240
v_mfma_f32_16x16x32_bf16 v[80:83], v[160:163], a[104:107], v[80:83]
ds_read_b64_tr_b16 v[232:233], v10 offset:8192
buffer_load_dwordx4 a[76:79], v1, s[44:47], s69 offen offset:3072 sc1
v_mfma_f32_16x16x32_bf16 v[96:99], v[160:163], a[120:123], v[96:99]
ds_read_b64_tr_b16 v[234:235], v10 offset:10240
ds_read_b64_tr_b16 v[236:237], v11 offset:8192
v_mfma_f32_16x16x32_bf16 v[100:103], v[164:167], a[120:123], v[100:103]
ds_read_b64_tr_b16 v[238:239], v11 offset:10240
s_add_u32 s69, s69, 0x20000
buffer_load_dwordx4 a[80:83], v1, s[44:47], s69 offen sc1
v_mfma_f32_16x16x32_bf16 v[84:87], v[164:167], a[104:107], v[84:87]
ds_read_b64_tr_b16 v[240:241], v8 offset:12288
v_mfma_f32_16x16x32_bf16 v[88:91], v[168:171], a[104:107], v[88:91]
ds_read_b64_tr_b16 v[242:243], v8 offset:14336
v_mfma_f32_16x16x32_bf16 v[104:107], v[168:171], a[120:123], v[104:107]
ds_read_b64_tr_b16 v[244:245], v9 offset:12288
ds_read_b64_tr_b16 v[246:247], v9 offset:14336
buffer_load_dwordx4 a[84:87], v1, s[44:47], s69 offen offset:1024 sc1
v_mfma_f32_16x16x32_bf16 v[108:111], v[172:175], a[120:123], v[108:111]
ds_read_b64_tr_b16 v[248:249], v10 offset:12288
v_mfma_f32_16x16x32_bf16 v[92:95], v[172:175], a[104:107], v[92:95]
ds_read_b64_tr_b16 v[250:251], v10 offset:14336
buffer_load_dwordx4 a[88:91], v1, s[44:47], s69 offen offset:2048 sc1
v_mfma_f32_16x16x32_bf16 v[80:83], v[176:179], a[108:111], v[80:83]
ds_read_b64_tr_b16 v[252:253], v11 offset:12288
v_mfma_f32_16x16x32_bf16 v[96:99], v[176:179], a[124:127], v[96:99]
ds_read_b64_tr_b16 v[254:255], v11 offset:14336
buffer_load_dwordx4 a[92:95], v1, s[44:47], s69 offen offset:3072 sc1
v_mfma_f32_16x16x32_bf16 v[100:103], v[180:183], a[124:127], v[100:103]
v_mfma_f32_16x16x32_bf16 v[84:87], v[180:183], a[108:111], v[84:87]
v_mfma_f32_16x16x32_bf16 v[88:91], v[184:187], a[108:111], v[88:91]
v_mfma_f32_16x16x32_bf16 v[104:107], v[184:187], a[124:127], v[104:107]
v_mfma_f32_16x16x32_bf16 v[108:111], v[188:191], a[124:127], v[108:111]
s_waitcnt vmcnt(24) lgkmcnt(0)
v_mfma_f32_16x16x32_bf16 v[92:95], v[188:191], a[108:111], v[92:95]
s_barrier
v_mfma_f32_16x16x32_bf16 v[80:83], v[192:195], a[0:3], v[80:83]
ds_read_b64_tr_b16 v[128:129], v8 offset:16384
ds_read_b64_tr_b16 v[130:131], v8 offset:18432
s_add_u32 s71, s61, 20
s_and_b32 s71, s71, 3
s_or_b32 s71, s71, 20
s_lshl_b32 s71, s71, 18
s_add_u32 s71, s71, s94
s_add_u32 m0, s64, 98304
s_add_u32 s72, s71, 0
buffer_load_dwordx4 v4, s[24:27], s72 offen lds
v_mfma_f32_16x16x32_bf16 v[96:99], v[192:195], a[16:19], v[96:99]
ds_read_b64_tr_b16 v[132:133], v9 offset:16384
v_mfma_f32_16x16x32_bf16 v[100:103], v[196:199], a[16:19], v[100:103]
ds_read_b64_tr_b16 v[134:135], v9 offset:18432
s_add_u32 s72, s71, 15360
buffer_load_dwordx4 v4, s[24:27], s72 offen offset:1024 lds
v_mfma_f32_16x16x32_bf16 v[84:87], v[196:199], a[0:3], v[84:87]
ds_read_b64_tr_b16 v[136:137], v10 offset:16384
v_mfma_f32_16x16x32_bf16 v[88:91], v[200:203], a[0:3], v[88:91]
ds_read_b64_tr_b16 v[138:139], v10 offset:18432
ds_read_b64_tr_b16 v[140:141], v11 offset:16384
s_add_u32 s72, s71, 30720
buffer_load_dwordx4 v4, s[24:27], s72 offen offset:2048 lds
v_mfma_f32_16x16x32_bf16 v[104:107], v[200:203], a[16:19], v[104:107]
ds_read_b64_tr_b16 v[142:143], v11 offset:18432
v_mfma_f32_16x16x32_bf16 v[108:111], v[204:207], a[16:19], v[108:111]
ds_read_b64_tr_b16 v[144:145], v8 offset:20480
v_mfma_f32_16x16x32_bf16 v[92:95], v[204:207], a[0:3], v[92:95]
ds_read_b64_tr_b16 v[146:147], v8 offset:22528
s_add_u32 s72, s71, 46080
buffer_load_dwordx4 v4, s[24:27], s72 offen offset:3072 lds
v_mfma_f32_16x16x32_bf16 v[80:83], v[208:211], a[4:7], v[80:83]
ds_read_b64_tr_b16 v[148:149], v9 offset:20480
ds_read_b64_tr_b16 v[150:151], v9 offset:22528
v_mfma_f32_16x16x32_bf16 v[96:99], v[208:211], a[20:23], v[96:99]
ds_read_b64_tr_b16 v[152:153], v10 offset:20480
s_add_u32 s69, s61, 19
s_and_b32 s69, s69, 3
s_or_b32 s69, s69, 16
s_lshl_b32 s69, s69, 12
s_add_u32 s69, s69, s95
buffer_load_dwordx4 a[96:99], v1, s[44:47], s69 offen sc1
v_mfma_f32_16x16x32_bf16 v[100:103], v[212:215], a[20:23], v[100:103]
ds_read_b64_tr_b16 v[154:155], v10 offset:22528
v_mfma_f32_16x16x32_bf16 v[84:87], v[212:215], a[4:7], v[84:87]
ds_read_b64_tr_b16 v[156:157], v11 offset:20480
buffer_load_dwordx4 a[100:103], v1, s[44:47], s69 offen offset:1024 sc1
v_mfma_f32_16x16x32_bf16 v[88:91], v[216:219], a[4:7], v[88:91]
ds_read_b64_tr_b16 v[158:159], v11 offset:22528
v_mfma_f32_16x16x32_bf16 v[104:107], v[216:219], a[20:23], v[104:107]
ds_read_b64_tr_b16 v[160:161], v8 offset:24576
ds_read_b64_tr_b16 v[162:163], v8 offset:26624
v_mfma_f32_16x16x32_bf16 v[108:111], v[220:223], a[20:23], v[108:111]
ds_read_b64_tr_b16 v[164:165], v9 offset:24576
buffer_load_dwordx4 a[104:107], v1, s[44:47], s69 offen offset:2048 sc1
v_mfma_f32_16x16x32_bf16 v[92:95], v[220:223], a[4:7], v[92:95]
ds_read_b64_tr_b16 v[166:167], v9 offset:26624
v_mfma_f32_16x16x32_bf16 v[80:83], v[224:227], a[8:11], v[80:83]
ds_read_b64_tr_b16 v[168:169], v10 offset:24576
buffer_load_dwordx4 a[108:111], v1, s[44:47], s69 offen offset:3072 sc1
v_mfma_f32_16x16x32_bf16 v[96:99], v[224:227], a[24:27], v[96:99]
ds_read_b64_tr_b16 v[170:171], v10 offset:26624
ds_read_b64_tr_b16 v[172:173], v11 offset:24576
v_mfma_f32_16x16x32_bf16 v[100:103], v[228:231], a[24:27], v[100:103]
ds_read_b64_tr_b16 v[174:175], v11 offset:26624
s_add_u32 s69, s69, 0x20000
buffer_load_dwordx4 a[112:115], v1, s[44:47], s69 offen sc1
v_mfma_f32_16x16x32_bf16 v[84:87], v[228:231], a[8:11], v[84:87]
ds_read_b64_tr_b16 v[176:177], v8 offset:28672
v_mfma_f32_16x16x32_bf16 v[88:91], v[232:235], a[8:11], v[88:91]
ds_read_b64_tr_b16 v[178:179], v8 offset:30720
v_mfma_f32_16x16x32_bf16 v[104:107], v[232:235], a[24:27], v[104:107]
ds_read_b64_tr_b16 v[180:181], v9 offset:28672
ds_read_b64_tr_b16 v[182:183], v9 offset:30720
buffer_load_dwordx4 a[116:119], v1, s[44:47], s69 offen offset:1024 sc1
v_mfma_f32_16x16x32_bf16 v[108:111], v[236:239], a[24:27], v[108:111]
ds_read_b64_tr_b16 v[184:185], v10 offset:28672
v_mfma_f32_16x16x32_bf16 v[92:95], v[236:239], a[8:11], v[92:95]
ds_read_b64_tr_b16 v[186:187], v10 offset:30720
buffer_load_dwordx4 a[120:123], v1, s[44:47], s69 offen offset:2048 sc1
v_mfma_f32_16x16x32_bf16 v[80:83], v[240:243], a[12:15], v[80:83]
ds_read_b64_tr_b16 v[188:189], v11 offset:28672
v_mfma_f32_16x16x32_bf16 v[96:99], v[240:243], a[28:31], v[96:99]
ds_read_b64_tr_b16 v[190:191], v11 offset:30720
buffer_load_dwordx4 a[124:127], v1, s[44:47], s69 offen offset:3072 sc1
v_mfma_f32_16x16x32_bf16 v[100:103], v[244:247], a[28:31], v[100:103]
v_mfma_f32_16x16x32_bf16 v[84:87], v[244:247], a[12:15], v[84:87]
v_mfma_f32_16x16x32_bf16 v[88:91], v[248:251], a[12:15], v[88:91]
v_mfma_f32_16x16x32_bf16 v[104:107], v[248:251], a[28:31], v[104:107]
v_mfma_f32_16x16x32_bf16 v[108:111], v[252:255], a[28:31], v[108:111]
s_waitcnt vmcnt(24) lgkmcnt(0)
v_mfma_f32_16x16x32_bf16 v[92:95], v[252:255], a[12:15], v[92:95]
s_barrier
v_mfma_f32_16x16x32_bf16 v[80:83], v[128:131], a[32:35], v[80:83]
ds_read_b64_tr_b16 v[192:193], v8 offset:32768
ds_read_b64_tr_b16 v[194:195], v8 offset:34816
s_add_u32 s71, s61, 21
s_and_b32 s71, s71, 3
s_or_b32 s71, s71, 20
s_lshl_b32 s71, s71, 18
s_add_u32 s71, s71, s94
s_add_u32 m0, s64, 114688
s_add_u32 s72, s71, 0
buffer_load_dwordx4 v4, s[24:27], s72 offen lds
v_mfma_f32_16x16x32_bf16 v[96:99], v[128:131], a[48:51], v[96:99]
ds_read_b64_tr_b16 v[196:197], v9 offset:32768
v_mfma_f32_16x16x32_bf16 v[100:103], v[132:135], a[48:51], v[100:103]
ds_read_b64_tr_b16 v[198:199], v9 offset:34816
s_add_u32 s72, s71, 15360
buffer_load_dwordx4 v4, s[24:27], s72 offen offset:1024 lds
v_mfma_f32_16x16x32_bf16 v[84:87], v[132:135], a[32:35], v[84:87]
ds_read_b64_tr_b16 v[200:201], v10 offset:32768
v_mfma_f32_16x16x32_bf16 v[88:91], v[136:139], a[32:35], v[88:91]
ds_read_b64_tr_b16 v[202:203], v10 offset:34816
ds_read_b64_tr_b16 v[204:205], v11 offset:32768
s_add_u32 s72, s71, 30720
buffer_load_dwordx4 v4, s[24:27], s72 offen offset:2048 lds
v_mfma_f32_16x16x32_bf16 v[104:107], v[136:139], a[48:51], v[104:107]
ds_read_b64_tr_b16 v[206:207], v11 offset:34816
v_mfma_f32_16x16x32_bf16 v[108:111], v[140:143], a[48:51], v[108:111]
ds_read_b64_tr_b16 v[208:209], v8 offset:36864
v_mfma_f32_16x16x32_bf16 v[92:95], v[140:143], a[32:35], v[92:95]
ds_read_b64_tr_b16 v[210:211], v8 offset:38912
s_add_u32 s72, s71, 46080
buffer_load_dwordx4 v4, s[24:27], s72 offen offset:3072 lds
v_mfma_f32_16x16x32_bf16 v[80:83], v[144:147], a[36:39], v[80:83]
ds_read_b64_tr_b16 v[212:213], v9 offset:36864
ds_read_b64_tr_b16 v[214:215], v9 offset:38912
v_mfma_f32_16x16x32_bf16 v[96:99], v[144:147], a[52:55], v[96:99]
ds_read_b64_tr_b16 v[216:217], v10 offset:36864
s_add_u32 s69, s61, 20
s_and_b32 s69, s69, 3
s_or_b32 s69, s69, 20
s_lshl_b32 s69, s69, 12
s_add_u32 s69, s69, s95
buffer_load_dwordx4 a[0:3], v1, s[44:47], s69 offen sc1
v_mfma_f32_16x16x32_bf16 v[100:103], v[148:151], a[52:55], v[100:103]
ds_read_b64_tr_b16 v[218:219], v10 offset:38912
v_mfma_f32_16x16x32_bf16 v[84:87], v[148:151], a[36:39], v[84:87]
ds_read_b64_tr_b16 v[220:221], v11 offset:36864
buffer_load_dwordx4 a[4:7], v1, s[44:47], s69 offen offset:1024 sc1
v_mfma_f32_16x16x32_bf16 v[88:91], v[152:155], a[36:39], v[88:91]
ds_read_b64_tr_b16 v[222:223], v11 offset:38912
v_mfma_f32_16x16x32_bf16 v[104:107], v[152:155], a[52:55], v[104:107]
ds_read_b64_tr_b16 v[224:225], v8 offset:40960
ds_read_b64_tr_b16 v[226:227], v8 offset:43008
v_mfma_f32_16x16x32_bf16 v[108:111], v[156:159], a[52:55], v[108:111]
ds_read_b64_tr_b16 v[228:229], v9 offset:40960
buffer_load_dwordx4 a[8:11], v1, s[44:47], s69 offen offset:2048 sc1
v_mfma_f32_16x16x32_bf16 v[92:95], v[156:159], a[36:39], v[92:95]
ds_read_b64_tr_b16 v[230:231], v9 offset:43008
v_mfma_f32_16x16x32_bf16 v[80:83], v[160:163], a[40:43], v[80:83]
ds_read_b64_tr_b16 v[232:233], v10 offset:40960
buffer_load_dwordx4 a[12:15], v1, s[44:47], s69 offen offset:3072 sc1
v_mfma_f32_16x16x32_bf16 v[96:99], v[160:163], a[56:59], v[96:99]
ds_read_b64_tr_b16 v[234:235], v10 offset:43008
ds_read_b64_tr_b16 v[236:237], v11 offset:40960
v_mfma_f32_16x16x32_bf16 v[100:103], v[164:167], a[56:59], v[100:103]
ds_read_b64_tr_b16 v[238:239], v11 offset:43008
s_add_u32 s69, s69, 0x20000
buffer_load_dwordx4 a[16:19], v1, s[44:47], s69 offen sc1
v_mfma_f32_16x16x32_bf16 v[84:87], v[164:167], a[40:43], v[84:87]
ds_read_b64_tr_b16 v[240:241], v8 offset:45056
v_mfma_f32_16x16x32_bf16 v[88:91], v[168:171], a[40:43], v[88:91]
ds_read_b64_tr_b16 v[242:243], v8 offset:47104
v_mfma_f32_16x16x32_bf16 v[104:107], v[168:171], a[56:59], v[104:107]
ds_read_b64_tr_b16 v[244:245], v9 offset:45056
ds_read_b64_tr_b16 v[246:247], v9 offset:47104
buffer_load_dwordx4 a[20:23], v1, s[44:47], s69 offen offset:1024 sc1
v_mfma_f32_16x16x32_bf16 v[108:111], v[172:175], a[56:59], v[108:111]
ds_read_b64_tr_b16 v[248:249], v10 offset:45056
v_mfma_f32_16x16x32_bf16 v[92:95], v[172:175], a[40:43], v[92:95]
ds_read_b64_tr_b16 v[250:251], v10 offset:47104
buffer_load_dwordx4 a[24:27], v1, s[44:47], s69 offen offset:2048 sc1
v_mfma_f32_16x16x32_bf16 v[80:83], v[176:179], a[44:47], v[80:83]
ds_read_b64_tr_b16 v[252:253], v11 offset:45056
v_mfma_f32_16x16x32_bf16 v[96:99], v[176:179], a[60:63], v[96:99]
ds_read_b64_tr_b16 v[254:255], v11 offset:47104
buffer_load_dwordx4 a[28:31], v1, s[44:47], s69 offen offset:3072 sc1
v_mfma_f32_16x16x32_bf16 v[100:103], v[180:183], a[60:63], v[100:103]
v_mfma_f32_16x16x32_bf16 v[84:87], v[180:183], a[44:47], v[84:87]
v_mfma_f32_16x16x32_bf16 v[88:91], v[184:187], a[44:47], v[88:91]
v_mfma_f32_16x16x32_bf16 v[104:107], v[184:187], a[60:63], v[104:107]
v_mfma_f32_16x16x32_bf16 v[108:111], v[188:191], a[60:63], v[108:111]
s_waitcnt vmcnt(24) lgkmcnt(0)
v_mfma_f32_16x16x32_bf16 v[92:95], v[188:191], a[44:47], v[92:95]
s_barrier
v_mfma_f32_16x16x32_bf16 v[80:83], v[192:195], a[64:67], v[80:83]
ds_read_b64_tr_b16 v[128:129], v8 offset:49152
ds_read_b64_tr_b16 v[130:131], v8 offset:51200
s_add_u32 s71, s61, 22
s_and_b32 s71, s71, 3
s_or_b32 s71, s71, 20
s_lshl_b32 s71, s71, 18
s_add_u32 s71, s71, s94
s_add_u32 m0, s64, 131072
s_add_u32 s72, s71, 0
buffer_load_dwordx4 v4, s[24:27], s72 offen lds
v_mfma_f32_16x16x32_bf16 v[96:99], v[192:195], a[80:83], v[96:99]
ds_read_b64_tr_b16 v[132:133], v9 offset:49152
v_mfma_f32_16x16x32_bf16 v[100:103], v[196:199], a[80:83], v[100:103]
ds_read_b64_tr_b16 v[134:135], v9 offset:51200
s_add_u32 s72, s71, 15360
buffer_load_dwordx4 v4, s[24:27], s72 offen offset:1024 lds
v_mfma_f32_16x16x32_bf16 v[84:87], v[196:199], a[64:67], v[84:87]
ds_read_b64_tr_b16 v[136:137], v10 offset:49152
v_mfma_f32_16x16x32_bf16 v[88:91], v[200:203], a[64:67], v[88:91]
ds_read_b64_tr_b16 v[138:139], v10 offset:51200
ds_read_b64_tr_b16 v[140:141], v11 offset:49152
s_add_u32 s72, s71, 30720
buffer_load_dwordx4 v4, s[24:27], s72 offen offset:2048 lds
v_mfma_f32_16x16x32_bf16 v[104:107], v[200:203], a[80:83], v[104:107]
ds_read_b64_tr_b16 v[142:143], v11 offset:51200
v_mfma_f32_16x16x32_bf16 v[108:111], v[204:207], a[80:83], v[108:111]
ds_read_b64_tr_b16 v[144:145], v8 offset:53248
v_mfma_f32_16x16x32_bf16 v[92:95], v[204:207], a[64:67], v[92:95]
ds_read_b64_tr_b16 v[146:147], v8 offset:55296
s_add_u32 s72, s71, 46080
buffer_load_dwordx4 v4, s[24:27], s72 offen offset:3072 lds
v_mfma_f32_16x16x32_bf16 v[80:83], v[208:211], a[68:71], v[80:83]
ds_read_b64_tr_b16 v[148:149], v9 offset:53248
ds_read_b64_tr_b16 v[150:151], v9 offset:55296
v_mfma_f32_16x16x32_bf16 v[96:99], v[208:211], a[84:87], v[96:99]
ds_read_b64_tr_b16 v[152:153], v10 offset:53248
s_add_u32 s69, s61, 21
s_and_b32 s69, s69, 3
s_or_b32 s69, s69, 20
s_lshl_b32 s69, s69, 12
s_add_u32 s69, s69, s95
buffer_load_dwordx4 a[32:35], v1, s[44:47], s69 offen sc1
v_mfma_f32_16x16x32_bf16 v[100:103], v[212:215], a[84:87], v[100:103]
ds_read_b64_tr_b16 v[154:155], v10 offset:55296
v_mfma_f32_16x16x32_bf16 v[84:87], v[212:215], a[68:71], v[84:87]
ds_read_b64_tr_b16 v[156:157], v11 offset:53248
buffer_load_dwordx4 a[36:39], v1, s[44:47], s69 offen offset:1024 sc1
v_mfma_f32_16x16x32_bf16 v[88:91], v[216:219], a[68:71], v[88:91]
ds_read_b64_tr_b16 v[158:159], v11 offset:55296
v_mfma_f32_16x16x32_bf16 v[104:107], v[216:219], a[84:87], v[104:107]
ds_read_b64_tr_b16 v[160:161], v8 offset:57344
ds_read_b64_tr_b16 v[162:163], v8 offset:59392
v_mfma_f32_16x16x32_bf16 v[108:111], v[220:223], a[84:87], v[108:111]
ds_read_b64_tr_b16 v[164:165], v9 offset:57344
buffer_load_dwordx4 a[40:43], v1, s[44:47], s69 offen offset:2048 sc1
v_mfma_f32_16x16x32_bf16 v[92:95], v[220:223], a[68:71], v[92:95]
ds_read_b64_tr_b16 v[166:167], v9 offset:59392
v_mfma_f32_16x16x32_bf16 v[80:83], v[224:227], a[72:75], v[80:83]
ds_read_b64_tr_b16 v[168:169], v10 offset:57344
buffer_load_dwordx4 a[44:47], v1, s[44:47], s69 offen offset:3072 sc1
v_mfma_f32_16x16x32_bf16 v[96:99], v[224:227], a[88:91], v[96:99]
ds_read_b64_tr_b16 v[170:171], v10 offset:59392
ds_read_b64_tr_b16 v[172:173], v11 offset:57344
v_mfma_f32_16x16x32_bf16 v[100:103], v[228:231], a[88:91], v[100:103]
ds_read_b64_tr_b16 v[174:175], v11 offset:59392
s_add_u32 s69, s69, 0x20000
buffer_load_dwordx4 a[48:51], v1, s[44:47], s69 offen sc1
v_mfma_f32_16x16x32_bf16 v[84:87], v[228:231], a[72:75], v[84:87]
ds_read_b64_tr_b16 v[176:177], v8 offset:61440
v_mfma_f32_16x16x32_bf16 v[88:91], v[232:235], a[72:75], v[88:91]
ds_read_b64_tr_b16 v[178:179], v8 offset:63488
v_mfma_f32_16x16x32_bf16 v[104:107], v[232:235], a[88:91], v[104:107]
ds_read_b64_tr_b16 v[180:181], v9 offset:61440
ds_read_b64_tr_b16 v[182:183], v9 offset:63488
buffer_load_dwordx4 a[52:55], v1, s[44:47], s69 offen offset:1024 sc1
v_mfma_f32_16x16x32_bf16 v[108:111], v[236:239], a[88:91], v[108:111]
ds_read_b64_tr_b16 v[184:185], v10 offset:61440
v_mfma_f32_16x16x32_bf16 v[92:95], v[236:239], a[72:75], v[92:95]
ds_read_b64_tr_b16 v[186:187], v10 offset:63488
buffer_load_dwordx4 a[56:59], v1, s[44:47], s69 offen offset:2048 sc1
v_mfma_f32_16x16x32_bf16 v[80:83], v[240:243], a[76:79], v[80:83]
ds_read_b64_tr_b16 v[188:189], v11 offset:61440
v_mfma_f32_16x16x32_bf16 v[96:99], v[240:243], a[92:95], v[96:99]
ds_read_b64_tr_b16 v[190:191], v11 offset:63488
buffer_load_dwordx4 a[60:63], v1, s[44:47], s69 offen offset:3072 sc1
v_mfma_f32_16x16x32_bf16 v[100:103], v[244:247], a[92:95], v[100:103]
v_mfma_f32_16x16x32_bf16 v[84:87], v[244:247], a[76:79], v[84:87]
v_mfma_f32_16x16x32_bf16 v[88:91], v[248:251], a[76:79], v[88:91]
v_mfma_f32_16x16x32_bf16 v[104:107], v[248:251], a[92:95], v[104:107]
v_mfma_f32_16x16x32_bf16 v[108:111], v[252:255], a[92:95], v[108:111]
s_waitcnt vmcnt(24) lgkmcnt(0)
v_mfma_f32_16x16x32_bf16 v[92:95], v[252:255], a[76:79], v[92:95]
s_barrier
v_mfma_f32_16x16x32_bf16 v[80:83], v[128:131], a[96:99], v[80:83]
ds_read_b64_tr_b16 v[192:193], v8 offset:0
ds_read_b64_tr_b16 v[194:195], v8 offset:2048
s_add_u32 s71, s61, 23
s_and_b32 s71, s71, 3
s_or_b32 s71, s71, 20
s_lshl_b32 s71, s71, 18
s_add_u32 s71, s71, s94
s_add_u32 m0, s64, 147456
s_add_u32 s72, s71, 0
buffer_load_dwordx4 v4, s[24:27], s72 offen lds
v_mfma_f32_16x16x32_bf16 v[96:99], v[128:131], a[112:115], v[96:99]
ds_read_b64_tr_b16 v[196:197], v9 offset:0
v_mfma_f32_16x16x32_bf16 v[100:103], v[132:135], a[112:115], v[100:103]
ds_read_b64_tr_b16 v[198:199], v9 offset:2048
s_add_u32 s72, s71, 15360
buffer_load_dwordx4 v4, s[24:27], s72 offen offset:1024 lds
v_mfma_f32_16x16x32_bf16 v[84:87], v[132:135], a[96:99], v[84:87]
ds_read_b64_tr_b16 v[200:201], v10 offset:0
v_mfma_f32_16x16x32_bf16 v[88:91], v[136:139], a[96:99], v[88:91]
ds_read_b64_tr_b16 v[202:203], v10 offset:2048
ds_read_b64_tr_b16 v[204:205], v11 offset:0
s_add_u32 s72, s71, 30720
buffer_load_dwordx4 v4, s[24:27], s72 offen offset:2048 lds
v_mfma_f32_16x16x32_bf16 v[104:107], v[136:139], a[112:115], v[104:107]
ds_read_b64_tr_b16 v[206:207], v11 offset:2048
v_mfma_f32_16x16x32_bf16 v[108:111], v[140:143], a[112:115], v[108:111]
ds_read_b64_tr_b16 v[208:209], v8 offset:4096
v_mfma_f32_16x16x32_bf16 v[92:95], v[140:143], a[96:99], v[92:95]
ds_read_b64_tr_b16 v[210:211], v8 offset:6144
s_add_u32 s72, s71, 46080
buffer_load_dwordx4 v4, s[24:27], s72 offen offset:3072 lds
v_mfma_f32_16x16x32_bf16 v[80:83], v[144:147], a[100:103], v[80:83]
ds_read_b64_tr_b16 v[212:213], v9 offset:4096
ds_read_b64_tr_b16 v[214:215], v9 offset:6144
v_mfma_f32_16x16x32_bf16 v[96:99], v[144:147], a[116:119], v[96:99]
ds_read_b64_tr_b16 v[216:217], v10 offset:4096
s_add_u32 s69, s61, 22
s_and_b32 s69, s69, 3
s_or_b32 s69, s69, 20
s_lshl_b32 s69, s69, 12
s_add_u32 s69, s69, s95
buffer_load_dwordx4 a[64:67], v1, s[44:47], s69 offen sc1
v_mfma_f32_16x16x32_bf16 v[100:103], v[148:151], a[116:119], v[100:103]
ds_read_b64_tr_b16 v[218:219], v10 offset:6144
v_mfma_f32_16x16x32_bf16 v[84:87], v[148:151], a[100:103], v[84:87]
ds_read_b64_tr_b16 v[220:221], v11 offset:4096
buffer_load_dwordx4 a[68:71], v1, s[44:47], s69 offen offset:1024 sc1
v_mfma_f32_16x16x32_bf16 v[88:91], v[152:155], a[100:103], v[88:91]
ds_read_b64_tr_b16 v[222:223], v11 offset:6144
v_mfma_f32_16x16x32_bf16 v[104:107], v[152:155], a[116:119], v[104:107]
ds_read_b64_tr_b16 v[224:225], v8 offset:8192
ds_read_b64_tr_b16 v[226:227], v8 offset:10240
v_mfma_f32_16x16x32_bf16 v[108:111], v[156:159], a[116:119], v[108:111]
ds_read_b64_tr_b16 v[228:229], v9 offset:8192
buffer_load_dwordx4 a[72:75], v1, s[44:47], s69 offen offset:2048 sc1
v_mfma_f32_16x16x32_bf16 v[92:95], v[156:159], a[100:103], v[92:95]
ds_read_b64_tr_b16 v[230:231], v9 offset:10240
v_mfma_f32_16x16x32_bf16 v[80:83], v[160:163], a[104:107], v[80:83]
ds_read_b64_tr_b16 v[232:233], v10 offset:8192
buffer_load_dwordx4 a[76:79], v1, s[44:47], s69 offen offset:3072 sc1
v_mfma_f32_16x16x32_bf16 v[96:99], v[160:163], a[120:123], v[96:99]
ds_read_b64_tr_b16 v[234:235], v10 offset:10240
ds_read_b64_tr_b16 v[236:237], v11 offset:8192
v_mfma_f32_16x16x32_bf16 v[100:103], v[164:167], a[120:123], v[100:103]
ds_read_b64_tr_b16 v[238:239], v11 offset:10240
s_add_u32 s69, s69, 0x20000
buffer_load_dwordx4 a[80:83], v1, s[44:47], s69 offen sc1
v_mfma_f32_16x16x32_bf16 v[84:87], v[164:167], a[104:107], v[84:87]
ds_read_b64_tr_b16 v[240:241], v8 offset:12288
v_mfma_f32_16x16x32_bf16 v[88:91], v[168:171], a[104:107], v[88:91]
ds_read_b64_tr_b16 v[242:243], v8 offset:14336
v_mfma_f32_16x16x32_bf16 v[104:107], v[168:171], a[120:123], v[104:107]
ds_read_b64_tr_b16 v[244:245], v9 offset:12288
ds_read_b64_tr_b16 v[246:247], v9 offset:14336
buffer_load_dwordx4 a[84:87], v1, s[44:47], s69 offen offset:1024 sc1
v_mfma_f32_16x16x32_bf16 v[108:111], v[172:175], a[120:123], v[108:111]
ds_read_b64_tr_b16 v[248:249], v10 offset:12288
v_mfma_f32_16x16x32_bf16 v[92:95], v[172:175], a[104:107], v[92:95]
ds_read_b64_tr_b16 v[250:251], v10 offset:14336
buffer_load_dwordx4 a[88:91], v1, s[44:47], s69 offen offset:2048 sc1
v_mfma_f32_16x16x32_bf16 v[80:83], v[176:179], a[108:111], v[80:83]
ds_read_b64_tr_b16 v[252:253], v11 offset:12288
v_mfma_f32_16x16x32_bf16 v[96:99], v[176:179], a[124:127], v[96:99]
ds_read_b64_tr_b16 v[254:255], v11 offset:14336
buffer_load_dwordx4 a[92:95], v1, s[44:47], s69 offen offset:3072 sc1
v_mfma_f32_16x16x32_bf16 v[100:103], v[180:183], a[124:127], v[100:103]
v_mfma_f32_16x16x32_bf16 v[84:87], v[180:183], a[108:111], v[84:87]
v_mfma_f32_16x16x32_bf16 v[88:91], v[184:187], a[108:111], v[88:91]
v_mfma_f32_16x16x32_bf16 v[104:107], v[184:187], a[124:127], v[104:107]
v_mfma_f32_16x16x32_bf16 v[108:111], v[188:191], a[124:127], v[108:111]
s_waitcnt vmcnt(24) lgkmcnt(0)
v_mfma_f32_16x16x32_bf16 v[92:95], v[188:191], a[108:111], v[92:95]
s_barrier
v_mfma_f32_16x16x32_bf16 v[80:83], v[192:195], a[0:3], v[80:83]
ds_read_b64_tr_b16 v[128:129], v8 offset:16384
ds_read_b64_tr_b16 v[130:131], v8 offset:18432
s_add_u32 s71, s61, 24
s_and_b32 s71, s71, 3
s_or_b32 s71, s71, 24
s_lshl_b32 s71, s71, 18
s_add_u32 s71, s71, s94
s_add_u32 m0, s64, 98304
s_add_u32 s72, s71, 0
buffer_load_dwordx4 v4, s[24:27], s72 offen lds
v_mfma_f32_16x16x32_bf16 v[96:99], v[192:195], a[16:19], v[96:99]
ds_read_b64_tr_b16 v[132:133], v9 offset:16384
v_mfma_f32_16x16x32_bf16 v[100:103], v[196:199], a[16:19], v[100:103]
ds_read_b64_tr_b16 v[134:135], v9 offset:18432
s_add_u32 s72, s71, 15360
buffer_load_dwordx4 v4, s[24:27], s72 offen offset:1024 lds
v_mfma_f32_16x16x32_bf16 v[84:87], v[196:199], a[0:3], v[84:87]
ds_read_b64_tr_b16 v[136:137], v10 offset:16384
v_mfma_f32_16x16x32_bf16 v[88:91], v[200:203], a[0:3], v[88:91]
ds_read_b64_tr_b16 v[138:139], v10 offset:18432
ds_read_b64_tr_b16 v[140:141], v11 offset:16384
s_add_u32 s72, s71, 30720
buffer_load_dwordx4 v4, s[24:27], s72 offen offset:2048 lds
v_mfma_f32_16x16x32_bf16 v[104:107], v[200:203], a[16:19], v[104:107]
ds_read_b64_tr_b16 v[142:143], v11 offset:18432
v_mfma_f32_16x16x32_bf16 v[108:111], v[204:207], a[16:19], v[108:111]
ds_read_b64_tr_b16 v[144:145], v8 offset:20480
v_mfma_f32_16x16x32_bf16 v[92:95], v[204:207], a[0:3], v[92:95]
ds_read_b64_tr_b16 v[146:147], v8 offset:22528
s_add_u32 s72, s71, 46080
buffer_load_dwordx4 v4, s[24:27], s72 offen offset:3072 lds
v_mfma_f32_16x16x32_bf16 v[80:83], v[208:211], a[4:7], v[80:83]
ds_read_b64_tr_b16 v[148:149], v9 offset:20480
ds_read_b64_tr_b16 v[150:151], v9 offset:22528
v_mfma_f32_16x16x32_bf16 v[96:99], v[208:211], a[20:23], v[96:99]
ds_read_b64_tr_b16 v[152:153], v10 offset:20480
s_add_u32 s69, s61, 23
s_and_b32 s69, s69, 3
s_or_b32 s69, s69, 20
s_lshl_b32 s69, s69, 12
s_add_u32 s69, s69, s95
buffer_load_dwordx4 a[96:99], v1, s[44:47], s69 offen sc1
v_mfma_f32_16x16x32_bf16 v[100:103], v[212:215], a[20:23], v[100:103]
ds_read_b64_tr_b16 v[154:155], v10 offset:22528
v_mfma_f32_16x16x32_bf16 v[84:87], v[212:215], a[4:7], v[84:87]
ds_read_b64_tr_b16 v[156:157], v11 offset:20480
buffer_load_dwordx4 a[100:103], v1, s[44:47], s69 offen offset:1024 sc1
v_mfma_f32_16x16x32_bf16 v[88:91], v[216:219], a[4:7], v[88:91]
ds_read_b64_tr_b16 v[158:159], v11 offset:22528
v_mfma_f32_16x16x32_bf16 v[104:107], v[216:219], a[20:23], v[104:107]
ds_read_b64_tr_b16 v[160:161], v8 offset:24576
ds_read_b64_tr_b16 v[162:163], v8 offset:26624
v_mfma_f32_16x16x32_bf16 v[108:111], v[220:223], a[20:23], v[108:111]
ds_read_b64_tr_b16 v[164:165], v9 offset:24576
buffer_load_dwordx4 a[104:107], v1, s[44:47], s69 offen offset:2048 sc1
v_mfma_f32_16x16x32_bf16 v[92:95], v[220:223], a[4:7], v[92:95]
ds_read_b64_tr_b16 v[166:167], v9 offset:26624
v_mfma_f32_16x16x32_bf16 v[80:83], v[224:227], a[8:11], v[80:83]
ds_read_b64_tr_b16 v[168:169], v10 offset:24576
buffer_load_dwordx4 a[108:111], v1, s[44:47], s69 offen offset:3072 sc1
v_mfma_f32_16x16x32_bf16 v[96:99], v[224:227], a[24:27], v[96:99]
ds_read_b64_tr_b16 v[170:171], v10 offset:26624
ds_read_b64_tr_b16 v[172:173], v11 offset:24576
v_mfma_f32_16x16x32_bf16 v[100:103], v[228:231], a[24:27], v[100:103]
ds_read_b64_tr_b16 v[174:175], v11 offset:26624
s_add_u32 s69, s69, 0x20000
buffer_load_dwordx4 a[112:115], v1, s[44:47], s69 offen sc1
v_mfma_f32_16x16x32_bf16 v[84:87], v[228:231], a[8:11], v[84:87]
ds_read_b64_tr_b16 v[176:177], v8 offset:28672
v_mfma_f32_16x16x32_bf16 v[88:91], v[232:235], a[8:11], v[88:91]
ds_read_b64_tr_b16 v[178:179], v8 offset:30720
v_mfma_f32_16x16x32_bf16 v[104:107], v[232:235], a[24:27], v[104:107]
ds_read_b64_tr_b16 v[180:181], v9 offset:28672
ds_read_b64_tr_b16 v[182:183], v9 offset:30720
buffer_load_dwordx4 a[116:119], v1, s[44:47], s69 offen offset:1024 sc1
v_mfma_f32_16x16x32_bf16 v[108:111], v[236:239], a[24:27], v[108:111]
ds_read_b64_tr_b16 v[184:185], v10 offset:28672
v_mfma_f32_16x16x32_bf16 v[92:95], v[236:239], a[8:11], v[92:95]
ds_read_b64_tr_b16 v[186:187], v10 offset:30720
buffer_load_dwordx4 a[120:123], v1, s[44:47], s69 offen offset:2048 sc1
v_mfma_f32_16x16x32_bf16 v[80:83], v[240:243], a[12:15], v[80:83]
ds_read_b64_tr_b16 v[188:189], v11 offset:28672
v_mfma_f32_16x16x32_bf16 v[96:99], v[240:243], a[28:31], v[96:99]
ds_read_b64_tr_b16 v[190:191], v11 offset:30720
buffer_load_dwordx4 a[124:127], v1, s[44:47], s69 offen offset:3072 sc1
v_mfma_f32_16x16x32_bf16 v[100:103], v[244:247], a[28:31], v[100:103]
v_mfma_f32_16x16x32_bf16 v[84:87], v[244:247], a[12:15], v[84:87]
v_mfma_f32_16x16x32_bf16 v[88:91], v[248:251], a[12:15], v[88:91]
v_mfma_f32_16x16x32_bf16 v[104:107], v[248:251], a[28:31], v[104:107]
v_mfma_f32_16x16x32_bf16 v[108:111], v[252:255], a[28:31], v[108:111]
s_waitcnt vmcnt(24) lgkmcnt(0)
v_mfma_f32_16x16x32_bf16 v[92:95], v[252:255], a[12:15], v[92:95]
s_barrier
v_mfma_f32_16x16x32_bf16 v[80:83], v[128:131], a[32:35], v[80:83]
ds_read_b64_tr_b16 v[192:193], v8 offset:32768
ds_read_b64_tr_b16 v[194:195], v8 offset:34816
s_add_u32 s71, s61, 25
s_and_b32 s71, s71, 3
s_or_b32 s71, s71, 24
s_lshl_b32 s71, s71, 18
s_add_u32 s71, s71, s94
s_add_u32 m0, s64, 114688
s_add_u32 s72, s71, 0
buffer_load_dwordx4 v4, s[24:27], s72 offen lds
v_mfma_f32_16x16x32_bf16 v[96:99], v[128:131], a[48:51], v[96:99]
ds_read_b64_tr_b16 v[196:197], v9 offset:32768
v_mfma_f32_16x16x32_bf16 v[100:103], v[132:135], a[48:51], v[100:103]
ds_read_b64_tr_b16 v[198:199], v9 offset:34816
s_add_u32 s72, s71, 15360
buffer_load_dwordx4 v4, s[24:27], s72 offen offset:1024 lds
v_mfma_f32_16x16x32_bf16 v[84:87], v[132:135], a[32:35], v[84:87]
ds_read_b64_tr_b16 v[200:201], v10 offset:32768
v_mfma_f32_16x16x32_bf16 v[88:91], v[136:139], a[32:35], v[88:91]
ds_read_b64_tr_b16 v[202:203], v10 offset:34816
ds_read_b64_tr_b16 v[204:205], v11 offset:32768
s_add_u32 s72, s71, 30720
buffer_load_dwordx4 v4, s[24:27], s72 offen offset:2048 lds
v_mfma_f32_16x16x32_bf16 v[104:107], v[136:139], a[48:51], v[104:107]
ds_read_b64_tr_b16 v[206:207], v11 offset:34816
v_mfma_f32_16x16x32_bf16 v[108:111], v[140:143], a[48:51], v[108:111]
ds_read_b64_tr_b16 v[208:209], v8 offset:36864
v_mfma_f32_16x16x32_bf16 v[92:95], v[140:143], a[32:35], v[92:95]
ds_read_b64_tr_b16 v[210:211], v8 offset:38912
s_add_u32 s72, s71, 46080
buffer_load_dwordx4 v4, s[24:27], s72 offen offset:3072 lds
v_mfma_f32_16x16x32_bf16 v[80:83], v[144:147], a[36:39], v[80:83]
ds_read_b64_tr_b16 v[212:213], v9 offset:36864
ds_read_b64_tr_b16 v[214:215], v9 offset:38912
v_mfma_f32_16x16x32_bf16 v[96:99], v[144:147], a[52:55], v[96:99]
ds_read_b64_tr_b16 v[216:217], v10 offset:36864
s_add_u32 s69, s61, 24
s_and_b32 s69, s69, 3
s_or_b32 s69, s69, 24
s_lshl_b32 s69, s69, 12
s_add_u32 s69, s69, s95
buffer_load_dwordx4 a[0:3], v1, s[44:47], s69 offen sc1
v_mfma_f32_16x16x32_bf16 v[100:103], v[148:151], a[52:55], v[100:103]
ds_read_b64_tr_b16 v[218:219], v10 offset:38912
v_mfma_f32_16x16x32_bf16 v[84:87], v[148:151], a[36:39], v[84:87]
ds_read_b64_tr_b16 v[220:221], v11 offset:36864
buffer_load_dwordx4 a[4:7], v1, s[44:47], s69 offen offset:1024 sc1
v_mfma_f32_16x16x32_bf16 v[88:91], v[152:155], a[36:39], v[88:91]
ds_read_b64_tr_b16 v[222:223], v11 offset:38912
v_mfma_f32_16x16x32_bf16 v[104:107], v[152:155], a[52:55], v[104:107]
ds_read_b64_tr_b16 v[224:225], v8 offset:40960
ds_read_b64_tr_b16 v[226:227], v8 offset:43008
v_mfma_f32_16x16x32_bf16 v[108:111], v[156:159], a[52:55], v[108:111]
ds_read_b64_tr_b16 v[228:229], v9 offset:40960
buffer_load_dwordx4 a[8:11], v1, s[44:47], s69 offen offset:2048 sc1
v_mfma_f32_16x16x32_bf16 v[92:95], v[156:159], a[36:39], v[92:95]
ds_read_b64_tr_b16 v[230:231], v9 offset:43008
v_mfma_f32_16x16x32_bf16 v[80:83], v[160:163], a[40:43], v[80:83]
ds_read_b64_tr_b16 v[232:233], v10 offset:40960
buffer_load_dwordx4 a[12:15], v1, s[44:47], s69 offen offset:3072 sc1
v_mfma_f32_16x16x32_bf16 v[96:99], v[160:163], a[56:59], v[96:99]
ds_read_b64_tr_b16 v[234:235], v10 offset:43008
ds_read_b64_tr_b16 v[236:237], v11 offset:40960
v_mfma_f32_16x16x32_bf16 v[100:103], v[164:167], a[56:59], v[100:103]
ds_read_b64_tr_b16 v[238:239], v11 offset:43008
s_add_u32 s69, s69, 0x20000
buffer_load_dwordx4 a[16:19], v1, s[44:47], s69 offen sc1
v_mfma_f32_16x16x32_bf16 v[84:87], v[164:167], a[40:43], v[84:87]
ds_read_b64_tr_b16 v[240:241], v8 offset:45056
v_mfma_f32_16x16x32_bf16 v[88:91], v[168:171], a[40:43], v[88:91]
ds_read_b64_tr_b16 v[242:243], v8 offset:47104
v_mfma_f32_16x16x32_bf16 v[104:107], v[168:171], a[56:59], v[104:107]
ds_read_b64_tr_b16 v[244:245], v9 offset:45056
ds_read_b64_tr_b16 v[246:247], v9 offset:47104
buffer_load_dwordx4 a[20:23], v1, s[44:47], s69 offen offset:1024 sc1
v_mfma_f32_16x16x32_bf16 v[108:111], v[172:175], a[56:59], v[108:111]
ds_read_b64_tr_b16 v[248:249], v10 offset:45056
v_mfma_f32_16x16x32_bf16 v[92:95], v[172:175], a[40:43], v[92:95]
ds_read_b64_tr_b16 v[250:251], v10 offset:47104
buffer_load_dwordx4 a[24:27], v1, s[44:47], s69 offen offset:2048 sc1
v_mfma_f32_16x16x32_bf16 v[80:83], v[176:179], a[44:47], v[80:83]
ds_read_b64_tr_b16 v[252:253], v11 offset:45056
v_mfma_f32_16x16x32_bf16 v[96:99], v[176:179], a[60:63], v[96:99]
ds_read_b64_tr_b16 v[254:255], v11 offset:47104
buffer_load_dwordx4 a[28:31], v1, s[44:47], s69 offen offset:3072 sc1
v_mfma_f32_16x16x32_bf16 v[100:103], v[180:183], a[60:63], v[100:103]
v_mfma_f32_16x16x32_bf16 v[84:87], v[180:183], a[44:47], v[84:87]
v_mfma_f32_16x16x32_bf16 v[88:91], v[184:187], a[44:47], v[88:91]
v_mfma_f32_16x16x32_bf16 v[104:107], v[184:187], a[60:63], v[104:107]
v_mfma_f32_16x16x32_bf16 v[108:111], v[188:191], a[60:63], v[108:111]
s_waitcnt vmcnt(24) lgkmcnt(0)
v_mfma_f32_16x16x32_bf16 v[92:95], v[188:191], a[44:47], v[92:95]
s_barrier
v_mfma_f32_16x16x32_bf16 v[80:83], v[192:195], a[64:67], v[80:83]
ds_read_b64_tr_b16 v[128:129], v8 offset:49152
ds_read_b64_tr_b16 v[130:131], v8 offset:51200
s_add_u32 s71, s61, 26
s_and_b32 s71, s71, 3
s_or_b32 s71, s71, 24
s_lshl_b32 s71, s71, 18
s_add_u32 s71, s71, s94
s_add_u32 m0, s64, 131072
s_add_u32 s72, s71, 0
buffer_load_dwordx4 v4, s[24:27], s72 offen lds
v_mfma_f32_16x16x32_bf16 v[96:99], v[192:195], a[80:83], v[96:99]
ds_read_b64_tr_b16 v[132:133], v9 offset:49152
v_mfma_f32_16x16x32_bf16 v[100:103], v[196:199], a[80:83], v[100:103]
ds_read_b64_tr_b16 v[134:135], v9 offset:51200
s_add_u32 s72, s71, 15360
buffer_load_dwordx4 v4, s[24:27], s72 offen offset:1024 lds
v_mfma_f32_16x16x32_bf16 v[84:87], v[196:199], a[64:67], v[84:87]
ds_read_b64_tr_b16 v[136:137], v10 offset:49152
v_mfma_f32_16x16x32_bf16 v[88:91], v[200:203], a[64:67], v[88:91]
ds_read_b64_tr_b16 v[138:139], v10 offset:51200
ds_read_b64_tr_b16 v[140:141], v11 offset:49152
s_add_u32 s72, s71, 30720
buffer_load_dwordx4 v4, s[24:27], s72 offen offset:2048 lds
v_mfma_f32_16x16x32_bf16 v[104:107], v[200:203], a[80:83], v[104:107]
ds_read_b64_tr_b16 v[142:143], v11 offset:51200
v_mfma_f32_16x16x32_bf16 v[108:111], v[204:207], a[80:83], v[108:111]
ds_read_b64_tr_b16 v[144:145], v8 offset:53248
v_mfma_f32_16x16x32_bf16 v[92:95], v[204:207], a[64:67], v[92:95]
ds_read_b64_tr_b16 v[146:147], v8 offset:55296
s_add_u32 s72, s71, 46080
buffer_load_dwordx4 v4, s[24:27], s72 offen offset:3072 lds
v_mfma_f32_16x16x32_bf16 v[80:83], v[208:211], a[68:71], v[80:83]
ds_read_b64_tr_b16 v[148:149], v9 offset:53248
ds_read_b64_tr_b16 v[150:151], v9 offset:55296
v_mfma_f32_16x16x32_bf16 v[96:99], v[208:211], a[84:87], v[96:99]
ds_read_b64_tr_b16 v[152:153], v10 offset:53248
s_add_u32 s69, s61, 25
s_and_b32 s69, s69, 3
s_or_b32 s69, s69, 24
s_lshl_b32 s69, s69, 12
s_add_u32 s69, s69, s95
buffer_load_dwordx4 a[32:35], v1, s[44:47], s69 offen sc1
v_mfma_f32_16x16x32_bf16 v[100:103], v[212:215], a[84:87], v[100:103]
ds_read_b64_tr_b16 v[154:155], v10 offset:55296
v_mfma_f32_16x16x32_bf16 v[84:87], v[212:215], a[68:71], v[84:87]
ds_read_b64_tr_b16 v[156:157], v11 offset:53248
buffer_load_dwordx4 a[36:39], v1, s[44:47], s69 offen offset:1024 sc1
v_mfma_f32_16x16x32_bf16 v[88:91], v[216:219], a[68:71], v[88:91]
ds_read_b64_tr_b16 v[158:159], v11 offset:55296
v_mfma_f32_16x16x32_bf16 v[104:107], v[216:219], a[84:87], v[104:107]
ds_read_b64_tr_b16 v[160:161], v8 offset:57344
ds_read_b64_tr_b16 v[162:163], v8 offset:59392
v_mfma_f32_16x16x32_bf16 v[108:111], v[220:223], a[84:87], v[108:111]
ds_read_b64_tr_b16 v[164:165], v9 offset:57344
buffer_load_dwordx4 a[40:43], v1, s[44:47], s69 offen offset:2048 sc1
v_mfma_f32_16x16x32_bf16 v[92:95], v[220:223], a[68:71], v[92:95]
ds_read_b64_tr_b16 v[166:167], v9 offset:59392
v_mfma_f32_16x16x32_bf16 v[80:83], v[224:227], a[72:75], v[80:83]
ds_read_b64_tr_b16 v[168:169], v10 offset:57344
buffer_load_dwordx4 a[44:47], v1, s[44:47], s69 offen offset:3072 sc1
v_mfma_f32_16x16x32_bf16 v[96:99], v[224:227], a[88:91], v[96:99]
ds_read_b64_tr_b16 v[170:171], v10 offset:59392
ds_read_b64_tr_b16 v[172:173], v11 offset:57344
v_mfma_f32_16x16x32_bf16 v[100:103], v[228:231], a[88:91], v[100:103]
ds_read_b64_tr_b16 v[174:175], v11 offset:59392
s_add_u32 s69, s69, 0x20000
buffer_load_dwordx4 a[48:51], v1, s[44:47], s69 offen sc1
v_mfma_f32_16x16x32_bf16 v[84:87], v[228:231], a[72:75], v[84:87]
ds_read_b64_tr_b16 v[176:177], v8 offset:61440
v_mfma_f32_16x16x32_bf16 v[88:91], v[232:235], a[72:75], v[88:91]
ds_read_b64_tr_b16 v[178:179], v8 offset:63488
v_mfma_f32_16x16x32_bf16 v[104:107], v[232:235], a[88:91], v[104:107]
ds_read_b64_tr_b16 v[180:181], v9 offset:61440
ds_read_b64_tr_b16 v[182:183], v9 offset:63488
buffer_load_dwordx4 a[52:55], v1, s[44:47], s69 offen offset:1024 sc1
v_mfma_f32_16x16x32_bf16 v[108:111], v[236:239], a[88:91], v[108:111]
ds_read_b64_tr_b16 v[184:185], v10 offset:61440
v_mfma_f32_16x16x32_bf16 v[92:95], v[236:239], a[72:75], v[92:95]
ds_read_b64_tr_b16 v[186:187], v10 offset:63488
buffer_load_dwordx4 a[56:59], v1, s[44:47], s69 offen offset:2048 sc1
v_mfma_f32_16x16x32_bf16 v[80:83], v[240:243], a[76:79], v[80:83]
ds_read_b64_tr_b16 v[188:189], v11 offset:61440
v_mfma_f32_16x16x32_bf16 v[96:99], v[240:243], a[92:95], v[96:99]
ds_read_b64_tr_b16 v[190:191], v11 offset:63488
buffer_load_dwordx4 a[60:63], v1, s[44:47], s69 offen offset:3072 sc1
v_mfma_f32_16x16x32_bf16 v[100:103], v[244:247], a[92:95], v[100:103]
v_mfma_f32_16x16x32_bf16 v[84:87], v[244:247], a[76:79], v[84:87]
v_mfma_f32_16x16x32_bf16 v[88:91], v[248:251], a[76:79], v[88:91]
v_mfma_f32_16x16x32_bf16 v[104:107], v[248:251], a[92:95], v[104:107]
v_mfma_f32_16x16x32_bf16 v[108:111], v[252:255], a[92:95], v[108:111]
s_waitcnt vmcnt(24) lgkmcnt(0)
v_mfma_f32_16x16x32_bf16 v[92:95], v[252:255], a[76:79], v[92:95]
s_barrier
v_mfma_f32_16x16x32_bf16 v[80:83], v[128:131], a[96:99], v[80:83]
ds_read_b64_tr_b16 v[192:193], v8 offset:0
ds_read_b64_tr_b16 v[194:195], v8 offset:2048
s_add_u32 s71, s61, 27
s_and_b32 s71, s71, 3
s_or_b32 s71, s71, 24
s_lshl_b32 s71, s71, 18
s_add_u32 s71, s71, s94
s_add_u32 m0, s64, 147456
s_add_u32 s72, s71, 0
buffer_load_dwordx4 v4, s[24:27], s72 offen lds
v_mfma_f32_16x16x32_bf16 v[96:99], v[128:131], a[112:115], v[96:99]
ds_read_b64_tr_b16 v[196:197], v9 offset:0
v_mfma_f32_16x16x32_bf16 v[100:103], v[132:135], a[112:115], v[100:103]
ds_read_b64_tr_b16 v[198:199], v9 offset:2048
s_add_u32 s72, s71, 15360
buffer_load_dwordx4 v4, s[24:27], s72 offen offset:1024 lds
v_mfma_f32_16x16x32_bf16 v[84:87], v[132:135], a[96:99], v[84:87]
ds_read_b64_tr_b16 v[200:201], v10 offset:0
v_mfma_f32_16x16x32_bf16 v[88:91], v[136:139], a[96:99], v[88:91]
ds_read_b64_tr_b16 v[202:203], v10 offset:2048
ds_read_b64_tr_b16 v[204:205], v11 offset:0
s_add_u32 s72, s71, 30720
buffer_load_dwordx4 v4, s[24:27], s72 offen offset:2048 lds
v_mfma_f32_16x16x32_bf16 v[104:107], v[136:139], a[112:115], v[104:107]
ds_read_b64_tr_b16 v[206:207], v11 offset:2048
v_mfma_f32_16x16x32_bf16 v[108:111], v[140:143], a[112:115], v[108:111]
ds_read_b64_tr_b16 v[208:209], v8 offset:4096
v_mfma_f32_16x16x32_bf16 v[92:95], v[140:143], a[96:99], v[92:95]
ds_read_b64_tr_b16 v[210:211], v8 offset:6144
s_add_u32 s72, s71, 46080
buffer_load_dwordx4 v4, s[24:27], s72 offen offset:3072 lds
v_mfma_f32_16x16x32_bf16 v[80:83], v[144:147], a[100:103], v[80:83]
ds_read_b64_tr_b16 v[212:213], v9 offset:4096
ds_read_b64_tr_b16 v[214:215], v9 offset:6144
v_mfma_f32_16x16x32_bf16 v[96:99], v[144:147], a[116:119], v[96:99]
ds_read_b64_tr_b16 v[216:217], v10 offset:4096
s_add_u32 s69, s61, 26
s_and_b32 s69, s69, 3
s_or_b32 s69, s69, 24
s_lshl_b32 s69, s69, 12
s_add_u32 s69, s69, s95
buffer_load_dwordx4 a[64:67], v1, s[44:47], s69 offen sc1
v_mfma_f32_16x16x32_bf16 v[100:103], v[148:151], a[116:119], v[100:103]
ds_read_b64_tr_b16 v[218:219], v10 offset:6144
v_mfma_f32_16x16x32_bf16 v[84:87], v[148:151], a[100:103], v[84:87]
ds_read_b64_tr_b16 v[220:221], v11 offset:4096
buffer_load_dwordx4 a[68:71], v1, s[44:47], s69 offen offset:1024 sc1
v_mfma_f32_16x16x32_bf16 v[88:91], v[152:155], a[100:103], v[88:91]
ds_read_b64_tr_b16 v[222:223], v11 offset:6144
v_mfma_f32_16x16x32_bf16 v[104:107], v[152:155], a[116:119], v[104:107]
ds_read_b64_tr_b16 v[224:225], v8 offset:8192
ds_read_b64_tr_b16 v[226:227], v8 offset:10240
v_mfma_f32_16x16x32_bf16 v[108:111], v[156:159], a[116:119], v[108:111]
ds_read_b64_tr_b16 v[228:229], v9 offset:8192
buffer_load_dwordx4 a[72:75], v1, s[44:47], s69 offen offset:2048 sc1
v_mfma_f32_16x16x32_bf16 v[92:95], v[156:159], a[100:103], v[92:95]
ds_read_b64_tr_b16 v[230:231], v9 offset:10240
v_mfma_f32_16x16x32_bf16 v[80:83], v[160:163], a[104:107], v[80:83]
ds_read_b64_tr_b16 v[232:233], v10 offset:8192
buffer_load_dwordx4 a[76:79], v1, s[44:47], s69 offen offset:3072 sc1
v_mfma_f32_16x16x32_bf16 v[96:99], v[160:163], a[120:123], v[96:99]
ds_read_b64_tr_b16 v[234:235], v10 offset:10240
ds_read_b64_tr_b16 v[236:237], v11 offset:8192
v_mfma_f32_16x16x32_bf16 v[100:103], v[164:167], a[120:123], v[100:103]
ds_read_b64_tr_b16 v[238:239], v11 offset:10240
s_add_u32 s69, s69, 0x20000
buffer_load_dwordx4 a[80:83], v1, s[44:47], s69 offen sc1
v_mfma_f32_16x16x32_bf16 v[84:87], v[164:167], a[104:107], v[84:87]
ds_read_b64_tr_b16 v[240:241], v8 offset:12288
v_mfma_f32_16x16x32_bf16 v[88:91], v[168:171], a[104:107], v[88:91]
ds_read_b64_tr_b16 v[242:243], v8 offset:14336
v_mfma_f32_16x16x32_bf16 v[104:107], v[168:171], a[120:123], v[104:107]
ds_read_b64_tr_b16 v[244:245], v9 offset:12288
ds_read_b64_tr_b16 v[246:247], v9 offset:14336
buffer_load_dwordx4 a[84:87], v1, s[44:47], s69 offen offset:1024 sc1
v_mfma_f32_16x16x32_bf16 v[108:111], v[172:175], a[120:123], v[108:111]
ds_read_b64_tr_b16 v[248:249], v10 offset:12288
v_mfma_f32_16x16x32_bf16 v[92:95], v[172:175], a[104:107], v[92:95]
ds_read_b64_tr_b16 v[250:251], v10 offset:14336
buffer_load_dwordx4 a[88:91], v1, s[44:47], s69 offen offset:2048 sc1
v_mfma_f32_16x16x32_bf16 v[80:83], v[176:179], a[108:111], v[80:83]
ds_read_b64_tr_b16 v[252:253], v11 offset:12288
v_mfma_f32_16x16x32_bf16 v[96:99], v[176:179], a[124:127], v[96:99]
ds_read_b64_tr_b16 v[254:255], v11 offset:14336
buffer_load_dwordx4 a[92:95], v1, s[44:47], s69 offen offset:3072 sc1
v_mfma_f32_16x16x32_bf16 v[100:103], v[180:183], a[124:127], v[100:103]
v_mfma_f32_16x16x32_bf16 v[84:87], v[180:183], a[108:111], v[84:87]
v_mfma_f32_16x16x32_bf16 v[88:91], v[184:187], a[108:111], v[88:91]
v_mfma_f32_16x16x32_bf16 v[104:107], v[184:187], a[124:127], v[104:107]
v_mfma_f32_16x16x32_bf16 v[108:111], v[188:191], a[124:127], v[108:111]
s_waitcnt vmcnt(24) lgkmcnt(0)
v_mfma_f32_16x16x32_bf16 v[92:95], v[188:191], a[108:111], v[92:95]
s_barrier
v_mfma_f32_16x16x32_bf16 v[80:83], v[192:195], a[0:3], v[80:83]
ds_read_b64_tr_b16 v[128:129], v8 offset:16384
ds_read_b64_tr_b16 v[130:131], v8 offset:18432
s_add_u32 s71, s61, 28
s_and_b32 s71, s71, 3
s_or_b32 s71, s71, 28
s_lshl_b32 s71, s71, 18
s_add_u32 s71, s71, s94
s_add_u32 m0, s64, 98304
s_add_u32 s72, s71, 0
buffer_load_dwordx4 v4, s[24:27], s72 offen lds
v_mfma_f32_16x16x32_bf16 v[96:99], v[192:195], a[16:19], v[96:99]
ds_read_b64_tr_b16 v[132:133], v9 offset:16384
v_mfma_f32_16x16x32_bf16 v[100:103], v[196:199], a[16:19], v[100:103]
ds_read_b64_tr_b16 v[134:135], v9 offset:18432
s_add_u32 s72, s71, 15360
buffer_load_dwordx4 v4, s[24:27], s72 offen offset:1024 lds
v_mfma_f32_16x16x32_bf16 v[84:87], v[196:199], a[0:3], v[84:87]
ds_read_b64_tr_b16 v[136:137], v10 offset:16384
v_mfma_f32_16x16x32_bf16 v[88:91], v[200:203], a[0:3], v[88:91]
ds_read_b64_tr_b16 v[138:139], v10 offset:18432
ds_read_b64_tr_b16 v[140:141], v11 offset:16384
s_add_u32 s72, s71, 30720
buffer_load_dwordx4 v4, s[24:27], s72 offen offset:2048 lds
v_mfma_f32_16x16x32_bf16 v[104:107], v[200:203], a[16:19], v[104:107]
ds_read_b64_tr_b16 v[142:143], v11 offset:18432
v_mfma_f32_16x16x32_bf16 v[108:111], v[204:207], a[16:19], v[108:111]
ds_read_b64_tr_b16 v[144:145], v8 offset:20480
v_mfma_f32_16x16x32_bf16 v[92:95], v[204:207], a[0:3], v[92:95]
ds_read_b64_tr_b16 v[146:147], v8 offset:22528
s_add_u32 s72, s71, 46080
buffer_load_dwordx4 v4, s[24:27], s72 offen offset:3072 lds
v_mfma_f32_16x16x32_bf16 v[80:83], v[208:211], a[4:7], v[80:83]
ds_read_b64_tr_b16 v[148:149], v9 offset:20480
ds_read_b64_tr_b16 v[150:151], v9 offset:22528
v_mfma_f32_16x16x32_bf16 v[96:99], v[208:211], a[20:23], v[96:99]
ds_read_b64_tr_b16 v[152:153], v10 offset:20480
s_add_u32 s69, s61, 27
s_and_b32 s69, s69, 3
s_or_b32 s69, s69, 24
s_lshl_b32 s69, s69, 12
s_add_u32 s69, s69, s95
buffer_load_dwordx4 a[96:99], v1, s[44:47], s69 offen sc1
v_mfma_f32_16x16x32_bf16 v[100:103], v[212:215], a[20:23], v[100:103]
ds_read_b64_tr_b16 v[154:155], v10 offset:22528
v_mfma_f32_16x16x32_bf16 v[84:87], v[212:215], a[4:7], v[84:87]
ds_read_b64_tr_b16 v[156:157], v11 offset:20480
buffer_load_dwordx4 a[100:103], v1, s[44:47], s69 offen offset:1024 sc1
v_mfma_f32_16x16x32_bf16 v[88:91], v[216:219], a[4:7], v[88:91]
ds_read_b64_tr_b16 v[158:159], v11 offset:22528
v_mfma_f32_16x16x32_bf16 v[104:107], v[216:219], a[20:23], v[104:107]
ds_read_b64_tr_b16 v[160:161], v8 offset:24576
ds_read_b64_tr_b16 v[162:163], v8 offset:26624
v_mfma_f32_16x16x32_bf16 v[108:111], v[220:223], a[20:23], v[108:111]
ds_read_b64_tr_b16 v[164:165], v9 offset:24576
buffer_load_dwordx4 a[104:107], v1, s[44:47], s69 offen offset:2048 sc1
v_mfma_f32_16x16x32_bf16 v[92:95], v[220:223], a[4:7], v[92:95]
ds_read_b64_tr_b16 v[166:167], v9 offset:26624
v_mfma_f32_16x16x32_bf16 v[80:83], v[224:227], a[8:11], v[80:83]
ds_read_b64_tr_b16 v[168:169], v10 offset:24576
buffer_load_dwordx4 a[108:111], v1, s[44:47], s69 offen offset:3072 sc1
v_mfma_f32_16x16x32_bf16 v[96:99], v[224:227], a[24:27], v[96:99]
ds_read_b64_tr_b16 v[170:171], v10 offset:26624
ds_read_b64_tr_b16 v[172:173], v11 offset:24576
v_mfma_f32_16x16x32_bf16 v[100:103], v[228:231], a[24:27], v[100:103]
ds_read_b64_tr_b16 v[174:175], v11 offset:26624
s_add_u32 s69, s69, 0x20000
buffer_load_dwordx4 a[112:115], v1, s[44:47], s69 offen sc1
v_mfma_f32_16x16x32_bf16 v[84:87], v[228:231], a[8:11], v[84:87]
ds_read_b64_tr_b16 v[176:177], v8 offset:28672
v_mfma_f32_16x16x32_bf16 v[88:91], v[232:235], a[8:11], v[88:91]
ds_read_b64_tr_b16 v[178:179], v8 offset:30720
v_mfma_f32_16x16x32_bf16 v[104:107], v[232:235], a[24:27], v[104:107]
ds_read_b64_tr_b16 v[180:181], v9 offset:28672
ds_read_b64_tr_b16 v[182:183], v9 offset:30720
buffer_load_dwordx4 a[116:119], v1, s[44:47], s69 offen offset:1024 sc1
v_mfma_f32_16x16x32_bf16 v[108:111], v[236:239], a[24:27], v[108:111]
ds_read_b64_tr_b16 v[184:185], v10 offset:28672
v_mfma_f32_16x16x32_bf16 v[92:95], v[236:239], a[8:11], v[92:95]
ds_read_b64_tr_b16 v[186:187], v10 offset:30720
buffer_load_dwordx4 a[120:123], v1, s[44:47], s69 offen offset:2048 sc1
v_mfma_f32_16x16x32_bf16 v[80:83], v[240:243], a[12:15], v[80:83]
ds_read_b64_tr_b16 v[188:189], v11 offset:28672
v_mfma_f32_16x16x32_bf16 v[96:99], v[240:243], a[28:31], v[96:99]
ds_read_b64_tr_b16 v[190:191], v11 offset:30720
buffer_load_dwordx4 a[124:127], v1, s[44:47], s69 offen offset:3072 sc1
v_mfma_f32_16x16x32_bf16 v[100:103], v[244:247], a[28:31], v[100:103]
v_mfma_f32_16x16x32_bf16 v[84:87], v[244:247], a[12:15], v[84:87]
v_mfma_f32_16x16x32_bf16 v[88:91], v[248:251], a[12:15], v[88:91]
v_mfma_f32_16x16x32_bf16 v[104:107], v[248:251], a[28:31], v[104:107]
v_mfma_f32_16x16x32_bf16 v[108:111], v[252:255], a[28:31], v[108:111]
s_waitcnt vmcnt(24) lgkmcnt(0)
v_mfma_f32_16x16x32_bf16 v[92:95], v[252:255], a[12:15], v[92:95]
s_barrier
v_mfma_f32_16x16x32_bf16 v[80:83], v[128:131], a[32:35], v[80:83]
ds_read_b64_tr_b16 v[192:193], v8 offset:32768
ds_read_b64_tr_b16 v[194:195], v8 offset:34816
s_add_u32 s71, s61, 29
s_and_b32 s71, s71, 3
s_or_b32 s71, s71, 28
s_lshl_b32 s71, s71, 18
s_add_u32 s71, s71, s94
s_add_u32 m0, s64, 114688
s_add_u32 s72, s71, 0
buffer_load_dwordx4 v4, s[24:27], s72 offen lds
s_lshl_b32 s74, s76, 11
s_add_u32 s74, s74, 0x3810000
v_and_b32 v2, 15, v0
v_lshlrev_b32 v2, 7, v2
buffer_load_dword v3, v2, s[44:47], s74 offen sc1
v_mfma_f32_16x16x32_bf16 v[96:99], v[128:131], a[48:51], v[96:99]
ds_read_b64_tr_b16 v[196:197], v9 offset:32768
v_mfma_f32_16x16x32_bf16 v[100:103], v[132:135], a[48:51], v[100:103]
ds_read_b64_tr_b16 v[198:199], v9 offset:34816
s_add_u32 s72, s71, 15360
buffer_load_dwordx4 v4, s[24:27], s72 offen offset:1024 lds
v_mfma_f32_16x16x32_bf16 v[84:87], v[132:135], a[32:35], v[84:87]
ds_read_b64_tr_b16 v[200:201], v10 offset:32768
v_mfma_f32_16x16x32_bf16 v[88:91], v[136:139], a[32:35], v[88:91]
ds_read_b64_tr_b16 v[202:203], v10 offset:34816
ds_read_b64_tr_b16 v[204:205], v11 offset:32768
s_add_u32 s72, s71, 30720
buffer_load_dwordx4 v4, s[24:27], s72 offen offset:2048 lds
v_mfma_f32_16x16x32_bf16 v[104:107], v[136:139], a[48:51], v[104:107]
ds_read_b64_tr_b16 v[206:207], v11 offset:34816
v_mfma_f32_16x16x32_bf16 v[108:111], v[140:143], a[48:51], v[108:111]
ds_read_b64_tr_b16 v[208:209], v8 offset:36864
v_mfma_f32_16x16x32_bf16 v[92:95], v[140:143], a[32:35], v[92:95]
ds_read_b64_tr_b16 v[210:211], v8 offset:38912
s_add_u32 s72, s71, 46080
buffer_load_dwordx4 v4, s[24:27], s72 offen offset:3072 lds
v_mfma_f32_16x16x32_bf16 v[80:83], v[144:147], a[36:39], v[80:83]
ds_read_b64_tr_b16 v[212:213], v9 offset:36864
ds_read_b64_tr_b16 v[214:215], v9 offset:38912
v_mfma_f32_16x16x32_bf16 v[96:99], v[144:147], a[52:55], v[96:99]
ds_read_b64_tr_b16 v[216:217], v10 offset:36864
s_add_u32 s69, s61, 28
s_and_b32 s69, s69, 3
s_or_b32 s69, s69, 28
s_lshl_b32 s69, s69, 12
s_add_u32 s69, s69, s95
buffer_load_dwordx4 a[0:3], v1, s[44:47], s69 offen sc1
v_mfma_f32_16x16x32_bf16 v[100:103], v[148:151], a[52:55], v[100:103]
ds_read_b64_tr_b16 v[218:219], v10 offset:38912
v_mfma_f32_16x16x32_bf16 v[84:87], v[148:151], a[36:39], v[84:87]
ds_read_b64_tr_b16 v[220:221], v11 offset:36864
buffer_load_dwordx4 a[4:7], v1, s[44:47], s69 offen offset:1024 sc1
v_mfma_f32_16x16x32_bf16 v[88:91], v[152:155], a[36:39], v[88:91]
ds_read_b64_tr_b16 v[222:223], v11 offset:38912
v_mfma_f32_16x16x32_bf16 v[104:107], v[152:155], a[52:55], v[104:107]
ds_read_b64_tr_b16 v[224:225], v8 offset:40960
ds_read_b64_tr_b16 v[226:227], v8 offset:43008
v_mfma_f32_16x16x32_bf16 v[108:111], v[156:159], a[52:55], v[108:111]
ds_read_b64_tr_b16 v[228:229], v9 offset:40960
buffer_load_dwordx4 a[8:11], v1, s[44:47], s69 offen offset:2048 sc1
v_mfma_f32_16x16x32_bf16 v[92:95], v[156:159], a[36:39], v[92:95]
ds_read_b64_tr_b16 v[230:231], v9 offset:43008
v_mfma_f32_16x16x32_bf16 v[80:83], v[160:163], a[40:43], v[80:83]
ds_read_b64_tr_b16 v[232:233], v10 offset:40960
buffer_load_dwordx4 a[12:15], v1, s[44:47], s69 offen offset:3072 sc1
v_mfma_f32_16x16x32_bf16 v[96:99], v[160:163], a[56:59], v[96:99]
ds_read_b64_tr_b16 v[234:235], v10 offset:43008
ds_read_b64_tr_b16 v[236:237], v11 offset:40960
v_mfma_f32_16x16x32_bf16 v[100:103], v[164:167], a[56:59], v[100:103]
ds_read_b64_tr_b16 v[238:239], v11 offset:43008
s_add_u32 s69, s69, 0x20000
buffer_load_dwordx4 a[16:19], v1, s[44:47], s69 offen sc1
v_mfma_f32_16x16x32_bf16 v[84:87], v[164:167], a[40:43], v[84:87]
ds_read_b64_tr_b16 v[240:241], v8 offset:45056
v_mfma_f32_16x16x32_bf16 v[88:91], v[168:171], a[40:43], v[88:91]
ds_read_b64_tr_b16 v[242:243], v8 offset:47104
v_mfma_f32_16x16x32_bf16 v[104:107], v[168:171], a[56:59], v[104:107]
ds_read_b64_tr_b16 v[244:245], v9 offset:45056
ds_read_b64_tr_b16 v[246:247], v9 offset:47104
buffer_load_dwordx4 a[20:23], v1, s[44:47], s69 offen offset:1024 sc1
v_mfma_f32_16x16x32_bf16 v[108:111], v[172:175], a[56:59], v[108:111]
ds_read_b64_tr_b16 v[248:249], v10 offset:45056
v_mfma_f32_16x16x32_bf16 v[92:95], v[172:175], a[40:43], v[92:95]
ds_read_b64_tr_b16 v[250:251], v10 offset:47104
buffer_load_dwordx4 a[24:27], v1, s[44:47], s69 offen offset:2048 sc1
v_mfma_f32_16x16x32_bf16 v[80:83], v[176:179], a[44:47], v[80:83]
ds_read_b64_tr_b16 v[252:253], v11 offset:45056
v_mfma_f32_16x16x32_bf16 v[96:99], v[176:179], a[60:63], v[96:99]
ds_read_b64_tr_b16 v[254:255], v11 offset:47104
buffer_load_dwordx4 a[28:31], v1, s[44:47], s69 offen offset:3072 sc1
v_mfma_f32_16x16x32_bf16 v[100:103], v[180:183], a[60:63], v[100:103]
v_mfma_f32_16x16x32_bf16 v[84:87], v[180:183], a[44:47], v[84:87]
v_mfma_f32_16x16x32_bf16 v[88:91], v[184:187], a[44:47], v[88:91]
v_mfma_f32_16x16x32_bf16 v[104:107], v[184:187], a[60:63], v[104:107]
v_mfma_f32_16x16x32_bf16 v[108:111], v[188:191], a[60:63], v[108:111]
s_waitcnt vmcnt(25) lgkmcnt(0)
v_mfma_f32_16x16x32_bf16 v[92:95], v[188:191], a[44:47], v[92:95]
s_barrier
v_mfma_f32_16x16x32_bf16 v[80:83], v[192:195], a[64:67], v[80:83]
ds_read_b64_tr_b16 v[128:129], v8 offset:49152
ds_read_b64_tr_b16 v[130:131], v8 offset:51200
s_add_u32 s71, s61, 30
s_and_b32 s71, s71, 3
s_or_b32 s71, s71, 28
s_lshl_b32 s71, s71, 18
s_add_u32 s71, s71, s94
s_add_u32 m0, s64, 131072
s_add_u32 s72, s71, 0
buffer_load_dwordx4 v4, s[24:27], s72 offen lds
v_mfma_f32_16x16x32_bf16 v[96:99], v[192:195], a[80:83], v[96:99]
ds_read_b64_tr_b16 v[132:133], v9 offset:49152
v_mfma_f32_16x16x32_bf16 v[100:103], v[196:199], a[80:83], v[100:103]
ds_read_b64_tr_b16 v[134:135], v9 offset:51200
s_add_u32 s72, s71, 15360
buffer_load_dwordx4 v4, s[24:27], s72 offen offset:1024 lds
v_mfma_f32_16x16x32_bf16 v[84:87], v[196:199], a[64:67], v[84:87]
ds_read_b64_tr_b16 v[136:137], v10 offset:49152
v_mfma_f32_16x16x32_bf16 v[88:91], v[200:203], a[64:67], v[88:91]
ds_read_b64_tr_b16 v[138:139], v10 offset:51200
ds_read_b64_tr_b16 v[140:141], v11 offset:49152
s_add_u32 s72, s71, 30720
buffer_load_dwordx4 v4, s[24:27], s72 offen offset:2048 lds
v_mfma_f32_16x16x32_bf16 v[104:107], v[200:203], a[80:83], v[104:107]
ds_read_b64_tr_b16 v[142:143], v11 offset:51200
v_mfma_f32_16x16x32_bf16 v[108:111], v[204:207], a[80:83], v[108:111]
ds_read_b64_tr_b16 v[144:145], v8 offset:53248
v_mfma_f32_16x16x32_bf16 v[92:95], v[204:207], a[64:67], v[92:95]
ds_read_b64_tr_b16 v[146:147], v8 offset:55296
s_add_u32 s72, s71, 46080
buffer_load_dwordx4 v4, s[24:27], s72 offen offset:3072 lds
v_mfma_f32_16x16x32_bf16 v[80:83], v[208:211], a[68:71], v[80:83]
ds_read_b64_tr_b16 v[148:149], v9 offset:53248
ds_read_b64_tr_b16 v[150:151], v9 offset:55296
v_mfma_f32_16x16x32_bf16 v[96:99], v[208:211], a[84:87], v[96:99]
ds_read_b64_tr_b16 v[152:153], v10 offset:53248
s_add_u32 s69, s61, 29
s_and_b32 s69, s69, 3
s_or_b32 s69, s69, 28
s_lshl_b32 s69, s69, 12
s_add_u32 s69, s69, s95
buffer_load_dwordx4 a[32:35], v1, s[44:47], s69 offen sc1
v_mfma_f32_16x16x32_bf16 v[100:103], v[212:215], a[84:87], v[100:103]
ds_read_b64_tr_b16 v[154:155], v10 offset:55296
v_mfma_f32_16x16x32_bf16 v[84:87], v[212:215], a[68:71], v[84:87]
ds_read_b64_tr_b16 v[156:157], v11 offset:53248
buffer_load_dwordx4 a[36:39], v1, s[44:47], s69 offen offset:1024 sc1
v_mfma_f32_16x16x32_bf16 v[88:91], v[216:219], a[68:71], v[88:91]
ds_read_b64_tr_b16 v[158:159], v11 offset:55296
v_mfma_f32_16x16x32_bf16 v[104:107], v[216:219], a[84:87], v[104:107]
ds_read_b64_tr_b16 v[160:161], v8 offset:57344
ds_read_b64_tr_b16 v[162:163], v8 offset:59392
v_mfma_f32_16x16x32_bf16 v[108:111], v[220:223], a[84:87], v[108:111]
ds_read_b64_tr_b16 v[164:165], v9 offset:57344
buffer_load_dwordx4 a[40:43], v1, s[44:47], s69 offen offset:2048 sc1
v_mfma_f32_16x16x32_bf16 v[92:95], v[220:223], a[68:71], v[92:95]
ds_read_b64_tr_b16 v[166:167], v9 offset:59392
v_mfma_f32_16x16x32_bf16 v[80:83], v[224:227], a[72:75], v[80:83]
ds_read_b64_tr_b16 v[168:169], v10 offset:57344
buffer_load_dwordx4 a[44:47], v1, s[44:47], s69 offen offset:3072 sc1
v_mfma_f32_16x16x32_bf16 v[96:99], v[224:227], a[88:91], v[96:99]
ds_read_b64_tr_b16 v[170:171], v10 offset:59392
ds_read_b64_tr_b16 v[172:173], v11 offset:57344
v_mfma_f32_16x16x32_bf16 v[100:103], v[228:231], a[88:91], v[100:103]
ds_read_b64_tr_b16 v[174:175], v11 offset:59392
s_add_u32 s69, s69, 0x20000
buffer_load_dwordx4 a[48:51], v1, s[44:47], s69 offen sc1
v_mfma_f32_16x16x32_bf16 v[84:87], v[228:231], a[72:75], v[84:87]
ds_read_b64_tr_b16 v[176:177], v8 offset:61440
v_mfma_f32_16x16x32_bf16 v[88:91], v[232:235], a[72:75], v[88:91]
ds_read_b64_tr_b16 v[178:179], v8 offset:63488
v_mfma_f32_16x16x32_bf16 v[104:107], v[232:235], a[88:91], v[104:107]
ds_read_b64_tr_b16 v[180:181], v9 offset:61440
ds_read_b64_tr_b16 v[182:183], v9 offset:63488
buffer_load_dwordx4 a[52:55], v1, s[44:47], s69 offen offset:1024 sc1
v_mfma_f32_16x16x32_bf16 v[108:111], v[236:239], a[88:91], v[108:111]
ds_read_b64_tr_b16 v[184:185], v10 offset:61440
v_mfma_f32_16x16x32_bf16 v[92:95], v[236:239], a[72:75], v[92:95]
ds_read_b64_tr_b16 v[186:187], v10 offset:63488
buffer_load_dwordx4 a[56:59], v1, s[44:47], s69 offen offset:2048 sc1
v_mfma_f32_16x16x32_bf16 v[80:83], v[240:243], a[76:79], v[80:83]
ds_read_b64_tr_b16 v[188:189], v11 offset:61440
v_mfma_f32_16x16x32_bf16 v[96:99], v[240:243], a[92:95], v[96:99]
ds_read_b64_tr_b16 v[190:191], v11 offset:63488
buffer_load_dwordx4 a[60:63], v1, s[44:47], s69 offen offset:3072 sc1
v_mfma_f32_16x16x32_bf16 v[100:103], v[244:247], a[92:95], v[100:103]
v_mfma_f32_16x16x32_bf16 v[84:87], v[244:247], a[76:79], v[84:87]
v_mfma_f32_16x16x32_bf16 v[88:91], v[248:251], a[76:79], v[88:91]
v_mfma_f32_16x16x32_bf16 v[104:107], v[248:251], a[92:95], v[104:107]
v_mfma_f32_16x16x32_bf16 v[108:111], v[252:255], a[92:95], v[108:111]
s_waitcnt vmcnt(25) lgkmcnt(0)
v_mfma_f32_16x16x32_bf16 v[92:95], v[252:255], a[76:79], v[92:95]
s_barrier
v_mfma_f32_16x16x32_bf16 v[80:83], v[128:131], a[96:99], v[80:83]
ds_read_b64_tr_b16 v[192:193], v8 offset:0
ds_read_b64_tr_b16 v[194:195], v8 offset:2048
s_add_u32 s71, s61, 31
s_and_b32 s71, s71, 3
s_or_b32 s71, s71, 28
s_lshl_b32 s71, s71, 18
s_add_u32 s71, s71, s94
s_add_u32 m0, s64, 147456
s_add_u32 s72, s71, 0
buffer_load_dwordx4 v4, s[24:27], s72 offen lds
v_mfma_f32_16x16x32_bf16 v[96:99], v[128:131], a[112:115], v[96:99]
ds_read_b64_tr_b16 v[196:197], v9 offset:0
v_mfma_f32_16x16x32_bf16 v[100:103], v[132:135], a[112:115], v[100:103]
ds_read_b64_tr_b16 v[198:199], v9 offset:2048
s_add_u32 s72, s71, 15360
buffer_load_dwordx4 v4, s[24:27], s72 offen offset:1024 lds
v_mfma_f32_16x16x32_bf16 v[84:87], v[132:135], a[96:99], v[84:87]
ds_read_b64_tr_b16 v[200:201], v10 offset:0
v_mfma_f32_16x16x32_bf16 v[88:91], v[136:139], a[96:99], v[88:91]
ds_read_b64_tr_b16 v[202:203], v10 offset:2048
ds_read_b64_tr_b16 v[204:205], v11 offset:0
s_add_u32 s72, s71, 30720
buffer_load_dwordx4 v4, s[24:27], s72 offen offset:2048 lds
v_mfma_f32_16x16x32_bf16 v[104:107], v[136:139], a[112:115], v[104:107]
ds_read_b64_tr_b16 v[206:207], v11 offset:2048
v_mfma_f32_16x16x32_bf16 v[108:111], v[140:143], a[112:115], v[108:111]
ds_read_b64_tr_b16 v[208:209], v8 offset:4096
v_mfma_f32_16x16x32_bf16 v[92:95], v[140:143], a[96:99], v[92:95]
ds_read_b64_tr_b16 v[210:211], v8 offset:6144
s_add_u32 s72, s71, 46080
buffer_load_dwordx4 v4, s[24:27], s72 offen offset:3072 lds
v_mfma_f32_16x16x32_bf16 v[80:83], v[144:147], a[100:103], v[80:83]
ds_read_b64_tr_b16 v[212:213], v9 offset:4096
ds_read_b64_tr_b16 v[214:215], v9 offset:6144
v_mfma_f32_16x16x32_bf16 v[96:99], v[144:147], a[116:119], v[96:99]
ds_read_b64_tr_b16 v[216:217], v10 offset:4096
s_add_u32 s69, s61, 30
s_and_b32 s69, s69, 3
s_or_b32 s69, s69, 28
s_lshl_b32 s69, s69, 12
s_add_u32 s69, s69, s95
buffer_load_dwordx4 a[64:67], v1, s[44:47], s69 offen sc1
v_mfma_f32_16x16x32_bf16 v[100:103], v[148:151], a[116:119], v[100:103]
ds_read_b64_tr_b16 v[218:219], v10 offset:6144
v_mfma_f32_16x16x32_bf16 v[84:87], v[148:151], a[100:103], v[84:87]
ds_read_b64_tr_b16 v[220:221], v11 offset:4096
buffer_load_dwordx4 a[68:71], v1, s[44:47], s69 offen offset:1024 sc1
v_mfma_f32_16x16x32_bf16 v[88:91], v[152:155], a[100:103], v[88:91]
ds_read_b64_tr_b16 v[222:223], v11 offset:6144
v_mfma_f32_16x16x32_bf16 v[104:107], v[152:155], a[116:119], v[104:107]
ds_read_b64_tr_b16 v[224:225], v8 offset:8192
ds_read_b64_tr_b16 v[226:227], v8 offset:10240
v_mfma_f32_16x16x32_bf16 v[108:111], v[156:159], a[116:119], v[108:111]
ds_read_b64_tr_b16 v[228:229], v9 offset:8192
buffer_load_dwordx4 a[72:75], v1, s[44:47], s69 offen offset:2048 sc1
v_mfma_f32_16x16x32_bf16 v[92:95], v[156:159], a[100:103], v[92:95]
ds_read_b64_tr_b16 v[230:231], v9 offset:10240
v_mfma_f32_16x16x32_bf16 v[80:83], v[160:163], a[104:107], v[80:83]
ds_read_b64_tr_b16 v[232:233], v10 offset:8192
buffer_load_dwordx4 a[76:79], v1, s[44:47], s69 offen offset:3072 sc1
v_mfma_f32_16x16x32_bf16 v[96:99], v[160:163], a[120:123], v[96:99]
ds_read_b64_tr_b16 v[234:235], v10 offset:10240
ds_read_b64_tr_b16 v[236:237], v11 offset:8192
v_mfma_f32_16x16x32_bf16 v[100:103], v[164:167], a[120:123], v[100:103]
ds_read_b64_tr_b16 v[238:239], v11 offset:10240
s_add_u32 s69, s69, 0x20000
buffer_load_dwordx4 a[80:83], v1, s[44:47], s69 offen sc1
v_mfma_f32_16x16x32_bf16 v[84:87], v[164:167], a[104:107], v[84:87]
ds_read_b64_tr_b16 v[240:241], v8 offset:12288
v_mfma_f32_16x16x32_bf16 v[88:91], v[168:171], a[104:107], v[88:91]
ds_read_b64_tr_b16 v[242:243], v8 offset:14336
v_mfma_f32_16x16x32_bf16 v[104:107], v[168:171], a[120:123], v[104:107]
ds_read_b64_tr_b16 v[244:245], v9 offset:12288
ds_read_b64_tr_b16 v[246:247], v9 offset:14336
buffer_load_dwordx4 a[84:87], v1, s[44:47], s69 offen offset:1024 sc1
v_mfma_f32_16x16x32_bf16 v[108:111], v[172:175], a[120:123], v[108:111]
ds_read_b64_tr_b16 v[248:249], v10 offset:12288
v_mfma_f32_16x16x32_bf16 v[92:95], v[172:175], a[104:107], v[92:95]
ds_read_b64_tr_b16 v[250:251], v10 offset:14336
buffer_load_dwordx4 a[88:91], v1, s[44:47], s69 offen offset:2048 sc1
v_mfma_f32_16x16x32_bf16 v[80:83], v[176:179], a[108:111], v[80:83]
ds_read_b64_tr_b16 v[252:253], v11 offset:12288
v_mfma_f32_16x16x32_bf16 v[96:99], v[176:179], a[124:127], v[96:99]
ds_read_b64_tr_b16 v[254:255], v11 offset:14336
buffer_load_dwordx4 a[92:95], v1, s[44:47], s69 offen offset:3072 sc1
v_mfma_f32_16x16x32_bf16 v[100:103], v[180:183], a[124:127], v[100:103]
v_mfma_f32_16x16x32_bf16 v[84:87], v[180:183], a[108:111], v[84:87]
v_mfma_f32_16x16x32_bf16 v[88:91], v[184:187], a[108:111], v[88:91]
v_mfma_f32_16x16x32_bf16 v[104:107], v[184:187], a[124:127], v[104:107]
v_mfma_f32_16x16x32_bf16 v[108:111], v[188:191], a[124:127], v[108:111]
s_waitcnt vmcnt(24) lgkmcnt(0)
v_mfma_f32_16x16x32_bf16 v[92:95], v[188:191], a[108:111], v[92:95]
s_barrier
v_mfma_f32_16x16x32_bf16 v[80:83], v[192:195], a[0:3], v[80:83]
ds_read_b64_tr_b16 v[128:129], v8 offset:16384
ds_read_b64_tr_b16 v[130:131], v8 offset:18432
s_add_u32 s69, s61, 31
s_and_b32 s69, s69, 3
s_or_b32 s69, s69, 28
s_lshl_b32 s69, s69, 12
s_add_u32 s69, s69, s95
buffer_load_dwordx4 a[96:99], v1, s[44:47], s69 offen sc1
v_mfma_f32_16x16x32_bf16 v[96:99], v[192:195], a[16:19], v[96:99]
ds_read_b64_tr_b16 v[132:133], v9 offset:16384
v_mfma_f32_16x16x32_bf16 v[100:103], v[196:199], a[16:19], v[100:103]
ds_read_b64_tr_b16 v[134:135], v9 offset:18432
buffer_load_dwordx4 a[100:103], v1, s[44:47], s69 offen offset:1024 sc1
v_mfma_f32_16x16x32_bf16 v[84:87], v[196:199], a[0:3], v[84:87]
ds_read_b64_tr_b16 v[136:137], v10 offset:16384
v_mfma_f32_16x16x32_bf16 v[88:91], v[200:203], a[0:3], v[88:91]
ds_read_b64_tr_b16 v[138:139], v10 offset:18432
ds_read_b64_tr_b16 v[140:141], v11 offset:16384
buffer_load_dwordx4 a[104:107], v1, s[44:47], s69 offen offset:2048 sc1
v_mfma_f32_16x16x32_bf16 v[104:107], v[200:203], a[16:19], v[104:107]
ds_read_b64_tr_b16 v[142:143], v11 offset:18432
v_mfma_f32_16x16x32_bf16 v[108:111], v[204:207], a[16:19], v[108:111]
ds_read_b64_tr_b16 v[144:145], v8 offset:20480
v_mfma_f32_16x16x32_bf16 v[92:95], v[204:207], a[0:3], v[92:95]
ds_read_b64_tr_b16 v[146:147], v8 offset:22528
buffer_load_dwordx4 a[108:111], v1, s[44:47], s69 offen offset:3072 sc1
v_mfma_f32_16x16x32_bf16 v[80:83], v[208:211], a[4:7], v[80:83]
ds_read_b64_tr_b16 v[148:149], v9 offset:20480
ds_read_b64_tr_b16 v[150:151], v9 offset:22528
v_mfma_f32_16x16x32_bf16 v[96:99], v[208:211], a[20:23], v[96:99]
ds_read_b64_tr_b16 v[152:153], v10 offset:20480
s_add_u32 s69, s69, 0x20000
buffer_load_dwordx4 a[112:115], v1, s[44:47], s69 offen sc1
v_mfma_f32_16x16x32_bf16 v[100:103], v[212:215], a[20:23], v[100:103]
ds_read_b64_tr_b16 v[154:155], v10 offset:22528
v_mfma_f32_16x16x32_bf16 v[84:87], v[212:215], a[4:7], v[84:87]
ds_read_b64_tr_b16 v[156:157], v11 offset:20480
buffer_load_dwordx4 a[116:119], v1, s[44:47], s69 offen offset:1024 sc1
v_mfma_f32_16x16x32_bf16 v[88:91], v[216:219], a[4:7], v[88:91]
ds_read_b64_tr_b16 v[158:159], v11 offset:22528
v_mfma_f32_16x16x32_bf16 v[104:107], v[216:219], a[20:23], v[104:107]
ds_read_b64_tr_b16 v[160:161], v8 offset:24576
ds_read_b64_tr_b16 v[162:163], v8 offset:26624
v_mfma_f32_16x16x32_bf16 v[108:111], v[220:223], a[20:23], v[108:111]
ds_read_b64_tr_b16 v[164:165], v9 offset:24576
buffer_load_dwordx4 a[120:123], v1, s[44:47], s69 offen offset:2048 sc1
v_mfma_f32_16x16x32_bf16 v[92:95], v[220:223], a[4:7], v[92:95]
ds_read_b64_tr_b16 v[166:167], v9 offset:26624
v_mfma_f32_16x16x32_bf16 v[80:83], v[224:227], a[8:11], v[80:83]
ds_read_b64_tr_b16 v[168:169], v10 offset:24576
buffer_load_dwordx4 a[124:127], v1, s[44:47], s69 offen offset:3072 sc1
v_mfma_f32_16x16x32_bf16 v[96:99], v[224:227], a[24:27], v[96:99]
ds_read_b64_tr_b16 v[170:171], v10 offset:26624
ds_read_b64_tr_b16 v[172:173], v11 offset:24576
v_mfma_f32_16x16x32_bf16 v[100:103], v[228:231], a[24:27], v[100:103]
ds_read_b64_tr_b16 v[174:175], v11 offset:26624
s_lshl_b32 s70, s75, 18
s_add_u32 s70, s70, s94
s_add_u32 m0, s64, 0
s_add_u32 s72, s70, 0
buffer_load_dwordx4 v4, s[4:7], s72 offen lds
v_mfma_f32_16x16x32_bf16 v[84:87], v[228:231], a[8:11], v[84:87]
ds_read_b64_tr_b16 v[176:177], v8 offset:28672
v_mfma_f32_16x16x32_bf16 v[88:91], v[232:235], a[8:11], v[88:91]
ds_read_b64_tr_b16 v[178:179], v8 offset:30720
v_mfma_f32_16x16x32_bf16 v[104:107], v[232:235], a[24:27], v[104:107]
ds_read_b64_tr_b16 v[180:181], v9 offset:28672
ds_read_b64_tr_b16 v[182:183], v9 offset:30720
s_add_u32 s72, s70, 15360
buffer_load_dwordx4 v4, s[4:7], s72 offen offset:1024 lds
v_mfma_f32_16x16x32_bf16 v[108:111], v[236:239], a[24:27], v[108:111]
ds_read_b64_tr_b16 v[184:185], v10 offset:28672
v_mfma_f32_16x16x32_bf16 v[92:95], v[236:239], a[8:11], v[92:95]
ds_read_b64_tr_b16 v[186:187], v10 offset:30720
s_add_u32 s72, s70, 30720
buffer_load_dwordx4 v4, s[4:7], s72 offen offset:2048 lds
v_mfma_f32_16x16x32_bf16 v[80:83], v[240:243], a[12:15], v[80:83]
ds_read_b64_tr_b16 v[188:189], v11 offset:28672
v_mfma_f32_16x16x32_bf16 v[96:99], v[240:243], a[28:31], v[96:99]
ds_read_b64_tr_b16 v[190:191], v11 offset:30720
s_add_u32 s72, s70, 46080
buffer_load_dwordx4 v4, s[4:7], s72 offen offset:3072 lds
v_mfma_f32_16x16x32_bf16 v[100:103], v[244:247], a[28:31], v[100:103]
v_mfma_f32_16x16x32_bf16 v[84:87], v[244:247], a[12:15], v[84:87]
v_mfma_f32_16x16x32_bf16 v[88:91], v[248:251], a[12:15], v[88:91]
v_mfma_f32_16x16x32_bf16 v[104:107], v[248:251], a[28:31], v[104:107]
s_waitcnt vmcnt(47)
v_cmp_gt_u32 vcc, 3, v3
s_cbranch_vccnz Lspin63
Lback64:
s_lshl_b32 s73, s76, 18
s_lshl_b32 s74, s58, 16
s_add_u32 s73, s73, s74
s_lshl_b32 s74, s75, 8
s_add_u32 s73, s73, s74
s_add_u32 s73, s73, 0x3400000
v_lshrrev_b32 v112, 4, v0
v_and_b32 v113, 15, v0
v_lshlrev_b32 v114, 4, v113
v_lshl_add_u32 v112, v112, 12, v114
s_add_u32 m0, s64, 16384
s_add_u32 s72, s73, 0
buffer_load_dwordx4 v112, s[44:47], s72 offen sc1 lds
s_add_u32 s72, s73, 15360
buffer_load_dwordx4 v112, s[44:47], s72 offen offset:1024 sc1 lds
s_add_u32 s72, s73, 30720
buffer_load_dwordx4 v112, s[44:47], s72 offen offset:2048 sc1 lds
s_add_u32 s72, s73, 46080
buffer_load_dwordx4 v112, s[44:47], s72 offen offset:3072 sc1 lds
s_lshl_b32 s73, s75, 9
s_lshl_b32 s74, s58, 7
s_add_u32 s73, s73, s74
s_add_u32 s73, s73, 0x3800000
v_lshlrev_b32 v113, 2, v113
buffer_load_dword v6, v113, s[44:47], s73 offen sc1
buffer_load_dword v7, v113, s[44:47], s73 offen offset:64 sc1
v_mfma_f32_16x16x32_bf16 v[108:111], v[252:255], a[28:31], v[108:111]
s_waitcnt vmcnt(30) lgkmcnt(0)
v_mfma_f32_16x16x32_bf16 v[92:95], v[252:255], a[12:15], v[92:95]
s_barrier
v_mfma_f32_16x16x32_bf16 v[80:83], v[128:131], a[32:35], v[80:83]
ds_read_b64_tr_b16 v[192:193], v8 offset:32768
ds_read_b64_tr_b16 v[194:195], v8 offset:34816
v_mfma_f32_16x16x32_bf16 v[96:99], v[128:131], a[48:51], v[96:99]
ds_read_b64_tr_b16 v[196:197], v9 offset:32768
v_mfma_f32_16x16x32_bf16 v[100:103], v[132:135], a[48:51], v[100:103]
ds_read_b64_tr_b16 v[198:199], v9 offset:34816
v_mfma_f32_16x16x32_bf16 v[84:87], v[132:135], a[32:35], v[84:87]
ds_read_b64_tr_b16 v[200:201], v10 offset:32768
v_mfma_f32_16x16x32_bf16 v[88:91], v[136:139], a[32:35], v[88:91]
ds_read_b64_tr_b16 v[202:203], v10 offset:34816
ds_read_b64_tr_b16 v[204:205], v11 offset:32768
v_mfma_f32_16x16x32_bf16 v[104:107], v[136:139], a[48:51], v[104:107]
ds_read_b64_tr_b16 v[206:207], v11 offset:34816
v_mfma_f32_16x16x32_bf16 v[108:111], v[140:143], a[48:51], v[108:111]
ds_read_b64_tr_b16 v[208:209], v8 offset:36864
v_mfma_f32_16x16x32_bf16 v[92:95], v[140:143], a[32:35], v[92:95]
ds_read_b64_tr_b16 v[210:211], v8 offset:38912
v_mfma_f32_16x16x32_bf16 v[80:83], v[144:147], a[36:39], v[80:83]
ds_read_b64_tr_b16 v[212:213], v9 offset:36864
ds_read_b64_tr_b16 v[214:215], v9 offset:38912
v_mfma_f32_16x16x32_bf16 v[96:99], v[144:147], a[52:55], v[96:99]
ds_read_b64_tr_b16 v[216:217], v10 offset:36864
v_mfma_f32_16x16x32_bf16 v[100:103], v[148:151], a[52:55], v[100:103]
ds_read_b64_tr_b16 v[218:219], v10 offset:38912
v_mfma_f32_16x16x32_bf16 v[84:87], v[148:151], a[36:39], v[84:87]
ds_read_b64_tr_b16 v[220:221], v11 offset:36864
v_mfma_f32_16x16x32_bf16 v[88:91], v[152:155], a[36:39], v[88:91]
ds_read_b64_tr_b16 v[222:223], v11 offset:38912
v_mfma_f32_16x16x32_bf16 v[104:107], v[152:155], a[52:55], v[104:107]
ds_read_b64_tr_b16 v[224:225], v8 offset:40960
ds_read_b64_tr_b16 v[226:227], v8 offset:43008
v_mfma_f32_16x16x32_bf16 v[108:111], v[156:159], a[52:55], v[108:111]
ds_read_b64_tr_b16 v[228:229], v9 offset:40960
v_mfma_f32_16x16x32_bf16 v[92:95], v[156:159], a[36:39], v[92:95]
ds_read_b64_tr_b16 v[230:231], v9 offset:43008
v_mfma_f32_16x16x32_bf16 v[80:83], v[160:163], a[40:43], v[80:83]
ds_read_b64_tr_b16 v[232:233], v10 offset:40960
v_mfma_f32_16x16x32_bf16 v[96:99], v[160:163], a[56:59], v[96:99]
ds_read_b64_tr_b16 v[234:235], v10 offset:43008
ds_read_b64_tr_b16 v[236:237], v11 offset:40960
v_mfma_f32_16x16x32_bf16 v[100:103], v[164:167], a[56:59], v[100:103]
ds_read_b64_tr_b16 v[238:239], v11 offset:43008
v_mfma_f32_16x16x32_bf16 v[84:87], v[164:167], a[40:43], v[84:87]
ds_read_b64_tr_b16 v[240:241], v8 offset:45056
v_mfma_f32_16x16x32_bf16 v[88:91], v[168:171], a[40:43], v[88:91]
ds_read_b64_tr_b16 v[242:243], v8 offset:47104
v_mfma_f32_16x16x32_bf16 v[104:107], v[168:171], a[56:59], v[104:107]
ds_read_b64_tr_b16 v[244:245], v9 offset:45056
ds_read_b64_tr_b16 v[246:247], v9 offset:47104
v_mfma_f32_16x16x32_bf16 v[108:111], v[172:175], a[56:59], v[108:111]
ds_read_b64_tr_b16 v[248:249], v10 offset:45056
v_mfma_f32_16x16x32_bf16 v[92:95], v[172:175], a[40:43], v[92:95]
ds_read_b64_tr_b16 v[250:251], v10 offset:47104
v_mfma_f32_16x16x32_bf16 v[80:83], v[176:179], a[44:47], v[80:83]
ds_read_b64_tr_b16 v[252:253], v11 offset:45056
v_mfma_f32_16x16x32_bf16 v[96:99], v[176:179], a[60:63], v[96:99]
ds_read_b64_tr_b16 v[254:255], v11 offset:47104
v_mfma_f32_16x16x32_bf16 v[100:103], v[180:183], a[60:63], v[100:103]
v_mfma_f32_16x16x32_bf16 v[84:87], v[180:183], a[44:47], v[84:87]
v_mfma_f32_16x16x32_bf16 v[88:91], v[184:187], a[44:47], v[88:91]
v_mfma_f32_16x16x32_bf16 v[104:107], v[184:187], a[60:63], v[104:107]
v_mfma_f32_16x16x32_bf16 v[108:111], v[188:191], a[60:63], v[108:111]
s_waitcnt vmcnt(0) lgkmcnt(0)
v_mfma_f32_16x16x32_bf16 v[92:95], v[188:191], a[44:47], v[92:95]
s_barrier
v_mfma_f32_16x16x32_bf16 v[80:83], v[192:195], a[64:67], v[80:83]
ds_read_b64_tr_b16 v[128:129], v8 offset:49152
ds_read_b64_tr_b16 v[130:131], v8 offset:51200
ds_read_b64 v[48:49], v12 offset:0
v_mfma_f32_16x16x32_bf16 v[96:99], v[192:195], a[80:83], v[96:99]
ds_read_b64_tr_b16 v[132:133], v9 offset:49152
ds_read_b64_tr_b16 v[64:65], v5 offset:0
v_mfma_f32_16x16x32_bf16 v[100:103], v[196:199], a[80:83], v[100:103]
ds_read_b64_tr_b16 v[134:135], v9 offset:51200
ds_read_b64 v[50:51], v13 offset:0
v_mfma_f32_16x16x32_bf16 v[84:87], v[196:199], a[64:67], v[84:87]
ds_read_b64_tr_b16 v[136:137], v10 offset:49152
ds_read_b64_tr_b16 v[66:67], v5 offset:4096
v_mfma_f32_16x16x32_bf16 v[88:91], v[200:203], a[64:67], v[88:91]
ds_read_b64_tr_b16 v[138:139], v10 offset:51200
ds_read_b64_tr_b16 v[140:141], v11 offset:49152
ds_read_b64 v[52:53], v14 offset:0
v_mfma_f32_16x16x32_bf16 v[104:107], v[200:203], a[80:83], v[104:107]
ds_read_b64_tr_b16 v[142:143], v11 offset:51200
ds_read_b64_tr_b16 v[68:69], v5 offset:8192
v_mfma_f32_16x16x32_bf16 v[108:111], v[204:207], a[80:83], v[108:111]
ds_read_b64_tr_b16 v[144:145], v8 offset:53248
ds_read_b64 v[54:55], v15 offset:0
v_mfma_f32_16x16x32_bf16 v[92:95], v[204:207], a[64:67], v[92:95]
ds_read_b64_tr_b16 v[146:147], v8 offset:55296
ds_read_b64_tr_b16 v[70:71], v5 offset:12288
v_mfma_f32_16x16x32_bf16 v[80:83], v[208:211], a[68:71], v[80:83]
ds_read_b64_tr_b16 v[148:149], v9 offset:53248
ds_read_b64_tr_b16 v[150:151], v9 offset:55296
ds_read_b64 v[56:57], v12 offset:2048
v_mfma_f32_16x16x32_bf16 v[96:99], v[208:211], a[84:87], v[96:99]
ds_read_b64_tr_b16 v[152:153], v10 offset:53248
ds_read_b64_tr_b16 v[72:73], v5 offset:8
v_mfma_f32_16x16x32_bf16 v[100:103], v[212:215], a[84:87], v[100:103]
ds_read_b64_tr_b16 v[154:155], v10 offset:55296
ds_read_b64 v[58:59], v13 offset:2048
v_mfma_f32_16x16x32_bf16 v[84:87], v[212:215], a[68:71], v[84:87]
ds_read_b64_tr_b16 v[156:157], v11 offset:53248
ds_read_b64_tr_b16 v[74:75], v5 offset:4104
v_mfma_f32_16x16x32_bf16 v[88:91], v[216:219], a[68:71], v[88:91]
ds_read_b64_tr_b16 v[158:159], v11 offset:55296
ds_read_b64 v[60:61], v14 offset:2048
v_mfma_f32_16x16x32_bf16 v[104:107], v[216:219], a[84:87], v[104:107]
ds_read_b64_tr_b16 v[160:161], v8 offset:57344
ds_read_b64_tr_b16 v[162:163], v8 offset:59392
ds_read_b64_tr_b16 v[76:77], v5 offset:8200
v_mfma_f32_16x16x32_bf16 v[108:111], v[220:223], a[84:87], v[108:111]
ds_read_b64_tr_b16 v[164:165], v9 offset:57344
ds_read_b64 v[62:63], v15 offset:2048
v_mfma_f32_16x16x32_bf16 v[92:95], v[220:223], a[68:71], v[92:95]
ds_read_b64_tr_b16 v[166:167], v9 offset:59392
ds_read_b64_tr_b16 v[78:79], v5 offset:12296
v_mfma_f32_16x16x32_bf16 v[80:83], v[224:227], a[72:75], v[80:83]
ds_read_b64_tr_b16 v[168:169], v10 offset:57344
v_mfma_f32_16x16x32_bf16 v[96:99], v[224:227], a[88:91], v[96:99]
ds_read_b64_tr_b16 v[170:171], v10 offset:59392
ds_read_b64_tr_b16 v[172:173], v11 offset:57344
v_mfma_f32_16x16x32_bf16 v[100:103], v[228:231], a[88:91], v[100:103]
ds_read_b64_tr_b16 v[174:175], v11 offset:59392
v_mfma_f32_16x16x32_bf16 v[84:87], v[228:231], a[72:75], v[84:87]
ds_read_b64_tr_b16 v[176:177], v8 offset:61440
v_mfma_f32_16x16x32_bf16 v[88:91], v[232:235], a[72:75], v[88:91]
ds_read_b64_tr_b16 v[178:179], v8 offset:63488
v_mfma_f32_16x16x32_bf16 v[104:107], v[232:235], a[88:91], v[104:107]
ds_read_b64_tr_b16 v[180:181], v9 offset:61440
ds_read_b64_tr_b16 v[182:183], v9 offset:63488
v_mfma_f32_16x16x32_bf16 v[108:111], v[236:239], a[88:91], v[108:111]
ds_read_b64_tr_b16 v[184:185], v10 offset:61440
v_mfma_f32_16x16x32_bf16 v[92:95], v[236:239], a[72:75], v[92:95]
ds_read_b64_tr_b16 v[186:187], v10 offset:63488
v_mfma_f32_16x16x32_bf16 v[80:83], v[240:243], a[76:79], v[80:83]
ds_read_b64_tr_b16 v[188:189], v11 offset:61440
v_mfma_f32_16x16x32_bf16 v[96:99], v[240:243], a[92:95], v[96:99]
ds_read_b64_tr_b16 v[190:191], v11 offset:63488
v_mfma_f32_16x16x32_bf16 v[100:103], v[244:247], a[92:95], v[100:103]
v_mfma_f32_16x16x32_bf16 v[84:87], v[244:247], a[76:79], v[84:87]
v_mfma_f32_16x16x32_bf16 v[88:91], v[248:251], a[76:79], v[88:91]
v_mfma_f32_16x16x32_bf16 v[104:107], v[248:251], a[92:95], v[104:107]
v_mfma_f32_16x16x32_bf16 v[108:111], v[252:255], a[92:95], v[108:111]
s_waitcnt vmcnt(10) lgkmcnt(0)
v_mfma_f32_16x16x32_bf16 v[92:95], v[252:255], a[76:79], v[92:95]
v_mfma_f32_16x16x32_bf16 v[80:83], v[128:131], a[96:99], v[80:83]
v_sub_f32 v112, 1.0, v6
v_sub_f32 v113, 1.0, v7
v_lshlrev_b32 v16, 16, v48
v_lshlrev_b32 v114, 16, v64
v_mfma_f32_16x16x32_bf16 v[96:99], v[128:131], a[112:115], v[96:99]
v_mul_f32 v16, v16, v112
v_mul_f32 v16, v16, v114
v_and_b32 v17, 0xffff0000, v48
v_and_b32 v115, 0xffff0000, v64
v_mfma_f32_16x16x32_bf16 v[100:103], v[132:135], a[112:115], v[100:103]
v_mul_f32 v17, v17, v112
v_mul_f32 v17, v17, v115
v_lshlrev_b32 v18, 16, v49
v_lshlrev_b32 v114, 16, v65
v_mfma_f32_16x16x32_bf16 v[84:87], v[132:135], a[96:99], v[84:87]
v_mul_f32 v18, v18, v112
v_mul_f32 v18, v18, v114
v_and_b32 v19, 0xffff0000, v49
v_and_b32 v115, 0xffff0000, v65
v_mfma_f32_16x16x32_bf16 v[88:91], v[136:139], a[96:99], v[88:91]
v_mul_f32 v19, v19, v112
v_mul_f32 v19, v19, v115
v_lshlrev_b32 v20, 16, v50
v_lshlrev_b32 v114, 16, v66
v_mfma_f32_16x16x32_bf16 v[104:107], v[136:139], a[112:115], v[104:107]
v_mul_f32 v20, v20, v112
v_mul_f32 v20, v20, v114
v_and_b32 v21, 0xffff0000, v50
v_and_b32 v115, 0xffff0000, v66
v_mfma_f32_16x16x32_bf16 v[108:111], v[140:143], a[112:115], v[108:111]
v_mul_f32 v21, v21, v112
v_mul_f32 v21, v21, v115
v_lshlrev_b32 v22, 16, v51
v_lshlrev_b32 v114, 16, v67
v_mfma_f32_16x16x32_bf16 v[92:95], v[140:143], a[96:99], v[92:95]
v_mul_f32 v22, v22, v112
v_mul_f32 v22, v22, v114
v_and_b32 v23, 0xffff0000, v51
v_and_b32 v115, 0xffff0000, v67
v_mfma_f32_16x16x32_bf16 v[80:83], v[144:147], a[100:103], v[80:83]
v_mul_f32 v23, v23, v112
v_mul_f32 v23, v23, v115
v_lshlrev_b32 v24, 16, v52
v_lshlrev_b32 v114, 16, v68
v_mfma_f32_16x16x32_bf16 v[96:99], v[144:147], a[116:119], v[96:99]
v_mul_f32 v24, v24, v112
v_mul_f32 v24, v24, v114
v_and_b32 v25, 0xffff0000, v52
v_and_b32 v115, 0xffff0000, v68
v_mfma_f32_16x16x32_bf16 v[100:103], v[148:151], a[116:119], v[100:103]
v_mul_f32 v25, v25, v112
v_mul_f32 v25, v25, v115
v_lshlrev_b32 v26, 16, v53
v_lshlrev_b32 v114, 16, v69
v_mfma_f32_16x16x32_bf16 v[84:87], v[148:151], a[100:103], v[84:87]
v_mul_f32 v26, v26, v112
v_mul_f32 v26, v26, v114
v_and_b32 v27, 0xffff0000, v53
v_and_b32 v115, 0xffff0000, v69
v_mfma_f32_16x16x32_bf16 v[88:91], v[152:155], a[100:103], v[88:91]
v_mul_f32 v27, v27, v112
v_mul_f32 v27, v27, v115
v_lshlrev_b32 v28, 16, v54
v_lshlrev_b32 v114, 16, v70
v_mfma_f32_16x16x32_bf16 v[104:107], v[152:155], a[116:119], v[104:107]
v_mul_f32 v28, v28, v112
v_mul_f32 v28, v28, v114
v_and_b32 v29, 0xffff0000, v54
v_and_b32 v115, 0xffff0000, v70
v_mfma_f32_16x16x32_bf16 v[108:111], v[156:159], a[116:119], v[108:111]
v_mul_f32 v29, v29, v112
v_mul_f32 v29, v29, v115
v_lshlrev_b32 v30, 16, v55
v_lshlrev_b32 v114, 16, v71
v_mfma_f32_16x16x32_bf16 v[92:95], v[156:159], a[100:103], v[92:95]
v_mul_f32 v30, v30, v112
v_mul_f32 v30, v30, v114
v_and_b32 v31, 0xffff0000, v55
v_and_b32 v115, 0xffff0000, v71
v_mfma_f32_16x16x32_bf16 v[80:83], v[160:163], a[104:107], v[80:83]
v_mul_f32 v31, v31, v112
v_mul_f32 v31, v31, v115
v_lshlrev_b32 v32, 16, v56
v_lshlrev_b32 v114, 16, v72
v_mfma_f32_16x16x32_bf16 v[96:99], v[160:163], a[120:123], v[96:99]
v_mul_f32 v32, v32, v113
v_mul_f32 v32, v32, v114
v_and_b32 v33, 0xffff0000, v56
v_and_b32 v115, 0xffff0000, v72
v_mfma_f32_16x16x32_bf16 v[100:103], v[164:167], a[120:123], v[100:103]
v_mul_f32 v33, v33, v113
v_mul_f32 v33, v33, v115
v_lshlrev_b32 v34, 16, v57
v_lshlrev_b32 v114, 16, v73
v_mfma_f32_16x16x32_bf16 v[84:87], v[164:167], a[104:107], v[84:87]
v_mul_f32 v34, v34, v113
v_mul_f32 v34, v34, v114
v_and_b32 v35, 0xffff0000, v57
v_and_b32 v115, 0xffff0000, v73
v_mfma_f32_16x16x32_bf16 v[88:91], v[168:171], a[104:107], v[88:91]
v_mul_f32 v35, v35, v113
v_mul_f32 v35, v35, v115
v_lshlrev_b32 v36, 16, v58
v_lshlrev_b32 v114, 16, v74
v_mfma_f32_16x16x32_bf16 v[104:107], v[168:171], a[120:123], v[104:107]
v_mul_f32 v36, v36, v113
v_mul_f32 v36, v36, v114
v_and_b32 v37, 0xffff0000, v58
v_and_b32 v115, 0xffff0000, v74
v_mfma_f32_16x16x32_bf16 v[108:111], v[172:175], a[120:123], v[108:111]
v_mul_f32 v37, v37, v113
v_mul_f32 v37, v37, v115
v_lshlrev_b32 v38, 16, v59
v_lshlrev_b32 v114, 16, v75
v_mfma_f32_16x16x32_bf16 v[92:95], v[172:175], a[104:107], v[92:95]
v_mul_f32 v38, v38, v113
v_mul_f32 v38, v38, v114
v_and_b32 v39, 0xffff0000, v59
v_and_b32 v115, 0xffff0000, v75
v_mfma_f32_16x16x32_bf16 v[80:83], v[176:179], a[108:111], v[80:83]
v_mul_f32 v39, v39, v113
v_mul_f32 v39, v39, v115
v_lshlrev_b32 v40, 16, v60
v_lshlrev_b32 v114, 16, v76
v_mfma_f32_16x16x32_bf16 v[96:99], v[176:179], a[124:127], v[96:99]
v_mul_f32 v40, v40, v113
v_mul_f32 v40, v40, v114
v_and_b32 v41, 0xffff0000, v60
v_and_b32 v115, 0xffff0000, v76
v_mfma_f32_16x16x32_bf16 v[100:103], v[180:183], a[124:127], v[100:103]
v_mul_f32 v41, v41, v113
v_mul_f32 v41, v41, v115
v_lshlrev_b32 v42, 16, v61
v_lshlrev_b32 v114, 16, v77
v_mfma_f32_16x16x32_bf16 v[84:87], v[180:183], a[108:111], v[84:87]
v_mul_f32 v42, v42, v113
v_mul_f32 v42, v42, v114
v_and_b32 v43, 0xffff0000, v61
v_and_b32 v115, 0xffff0000, v77
v_mfma_f32_16x16x32_bf16 v[88:91], v[184:187], a[108:111], v[88:91]
v_mul_f32 v43, v43, v113
v_mul_f32 v43, v43, v115
v_lshlrev_b32 v44, 16, v62
v_lshlrev_b32 v114, 16, v78
v_mfma_f32_16x16x32_bf16 v[104:107], v[184:187], a[124:127], v[104:107]
v_mul_f32 v44, v44, v113
v_mul_f32 v44, v44, v114
v_and_b32 v45, 0xffff0000, v62
v_and_b32 v115, 0xffff0000, v78
v_mfma_f32_16x16x32_bf16 v[108:111], v[188:191], a[124:127], v[108:111]
v_mul_f32 v45, v45, v113
v_mul_f32 v45, v45, v115
v_lshlrev_b32 v46, 16, v63
v_lshlrev_b32 v114, 16, v79
v_mfma_f32_16x16x32_bf16 v[92:95], v[188:191], a[108:111], v[92:95]
v_mul_f32 v46, v46, v113
v_mul_f32 v46, v46, v114
v_and_b32 v47, 0xffff0000, v63
v_and_b32 v115, 0xffff0000, v79
v_mul_f32 v47, v47, v113
v_mul_f32 v47, v47, v115
v_fma_f32 v16, v80, v6, v16
v_fma_f32 v17, v81, v6, v17
v_fma_f32 v18, v82, v6, v18
v_fma_f32 v19, v83, v6, v19
v_cvt_pk_bf16_f32 v16, v16, v17
v_cvt_pk_bf16_f32 v17, v18, v19
ds_write_b64 v12, v[16:17] offset:0
v_fma_f32 v20, v84, v6, v20
v_fma_f32 v21, v85, v6, v21
v_fma_f32 v22, v86, v6, v22
v_fma_f32 v23, v87, v6, v23
v_cvt_pk_bf16_f32 v20, v20, v21
v_cvt_pk_bf16_f32 v21, v22, v23
ds_write_b64 v13, v[20:21] offset:0
v_fma_f32 v24, v88, v6, v24
v_fma_f32 v25, v89, v6, v25
v_fma_f32 v26, v90, v6, v26
v_fma_f32 v27, v91, v6, v27
v_cvt_pk_bf16_f32 v24, v24, v25
v_cvt_pk_bf16_f32 v25, v26, v27
ds_write_b64 v14, v[24:25] offset:0
v_fma_f32 v28, v92, v6, v28
v_fma_f32 v29, v93, v6, v29
v_fma_f32 v30, v94, v6, v30
v_fma_f32 v31, v95, v6, v31
v_cvt_pk_bf16_f32 v28, v28, v29
v_cvt_pk_bf16_f32 v29, v30, v31
ds_write_b64 v15, v[28:29] offset:0
v_fma_f32 v32, v96, v7, v32
v_fma_f32 v33, v97, v7, v33
v_fma_f32 v34, v98, v7, v34
v_fma_f32 v35, v99, v7, v35
v_cvt_pk_bf16_f32 v32, v32, v33
v_cvt_pk_bf16_f32 v33, v34, v35
ds_write_b64 v12, v[32:33] offset:2048
v_fma_f32 v36, v100, v7, v36
v_fma_f32 v37, v101, v7, v37
v_fma_f32 v38, v102, v7, v38
v_fma_f32 v39, v103, v7, v39
v_cvt_pk_bf16_f32 v36, v36, v37
v_cvt_pk_bf16_f32 v37, v38, v39
ds_write_b64 v13, v[36:37] offset:2048
v_fma_f32 v40, v104, v7, v40
v_fma_f32 v41, v105, v7, v41
v_fma_f32 v42, v106, v7, v42
v_fma_f32 v43, v107, v7, v43
v_cvt_pk_bf16_f32 v40, v40, v41
v_cvt_pk_bf16_f32 v41, v42, v43
ds_write_b64 v14, v[40:41] offset:2048
v_fma_f32 v44, v108, v7, v44
v_fma_f32 v45, v109, v7, v45
v_fma_f32 v46, v110, v7, v46
v_fma_f32 v47, v111, v7, v47
v_cvt_pk_bf16_f32 v44, v44, v45
v_cvt_pk_bf16_f32 v45, v46, v47
ds_write_b64 v15, v[44:45] offset:2048
v_add_u32 v112, s64, v1
ds_read_b128 v[48:51], v112 offset:0
ds_read_b128 v[52:55], v112 offset:1024
ds_read_b128 v[56:59], v112 offset:2048
ds_read_b128 v[60:63], v112 offset:3072
s_waitcnt lgkmcnt(3)
buffer_store_dwordx4 v[48:51], v4, s[40:43], s70 offen
s_add_u32 s70, s70, 0x4000
s_waitcnt lgkmcnt(2)
buffer_store_dwordx4 v[52:55], v4, s[40:43], s70 offen
s_add_u32 s70, s70, 0x4000
s_waitcnt lgkmcnt(1)
buffer_store_dwordx4 v[56:59], v4, s[40:43], s70 offen
s_add_u32 s70, s70, 0x4000
s_waitcnt lgkmcnt(0)
buffer_store_dwordx4 v[60:63], v4, s[40:43], s70 offen
s_add_u32 s70, s70, 0x4000
Lend:
s_endpgm
Lspin1:
s_mov_b32 s83, 262144
Lsl3:
s_sleep 2
buffer_load_dword v3, v2, s[48:51], 0 offen sc1
s_sub_u32 s83, s83, 1
s_cmp_eq_u32 s83, 0
s_waitcnt vmcnt(0)
s_cbranch_scc1 Lback2
v_cmp_gt_u32 vcc, 8, v3
s_cbranch_vccnz Lsl3
s_branch Lback2
Lspin4:
s_mov_b32 s83, 262144
Lsl6:
s_sleep 2
buffer_load_dword v3, v2, s[44:47], s75 offen sc1
s_sub_u32 s83, s83, 1
s_cmp_eq_u32 s83, 0
s_waitcnt vmcnt(0)
s_cbranch_scc1 Lback5
v_cmp_gt_u32 vcc, 1, v3
s_cbranch_vccnz Lsl6
s_branch Lback5
Lalt7:
v_mfma_f32_16x16x32_bf16 v[128:131], a[128:131], v[16:19], v[116:119]
v_mfma_f32_16x16x32_bf16 v[132:135], a[128:131], v[32:35], 0
v_mfma_f32_16x16x32_bf16 v[144:147], a[144:147], v[16:19], v[112:115]
v_mfma_f32_16x16x32_bf16 v[148:151], a[144:147], v[32:35], v[116:119]
s_branch Ljoin8
Lalt9:
s_cmp_eq_u32 s84, 1
s_cbranch_scc1 Ltri10
v_mfma_f32_16x16x32_bf16 v[160:163], a[160:163], v[16:19], v[112:115]
s_xor_b32 s74, s82, 0x10000
v_exp_f32 v128, v128
v_mfma_f32_16x16x32_bf16 v[164:167], a[160:163], v[32:35], v[112:115]
s_add_u32 s74, s74, s64
ds_read_b128 a[128:131], v2 offset:16384
ds_read_b128 a[144:147], v2 offset:20480
v_mfma_f32_16x16x32_bf16 v[176:179], a[176:179], v[16:19], v[112:115]
s_add_u32 s81, s81, 0x8000
v_exp_f32 v129, v129
v_mfma_f32_16x16x32_bf16 v[180:183], a[176:179], v[32:35], v[112:115]
s_add_u32 m0, s74, 16384
v_exp_f32 v130, v130
s_branch Ljoin11
Ltri10:
v_mfma_f32_16x16x32_bf16 v[160:163], a[160:163], v[16:19], v[96:99]
s_xor_b32 s74, s82, 0x10000
v_exp_f32 v128, v128
v_mfma_f32_16x16x32_bf16 v[164:167], a[160:163], v[32:35], v[84:87]
s_add_u32 s74, s74, s64
ds_read_b128 a[128:131], v2 offset:16384
ds_read_b128 a[144:147], v2 offset:20480
v_mfma_f32_16x16x32_bf16 v[176:179], a[176:179], v[16:19], v[112:115]
s_add_u32 s81, s81, 0x8000
v_exp_f32 v129, v129
v_mfma_f32_16x16x32_bf16 v[180:183], a[176:179], v[32:35], v[100:103]
s_add_u32 m0, s74, 16384
v_exp_f32 v130, v130
s_branch Ljoin11
Lalt12:
s_cmp_eq_u32 s84, 2
s_cbranch_scc1 Ltri13
v_mfma_f32_16x16x32_bf16 v[128:131], a[128:131], v[16:19], v[112:115]
s_add_u32 s82, s82, 0x8000
ds_read_b128 a[160:163], v2 offset:24576
v_mfma_f32_16x16x32_bf16 v[132:135], a[128:131], v[32:35], v[112:115]
s_and_b32 s82, s82, 0x1ffff
v_exp_f32 v160, v160
v_mfma_f32_16x16x32_bf16 v[144:147], a[144:147], v[16:19], v[112:115]
s_lshl_b32 s73, s93, 1
v_exp_f32 v161, v161
v_mfma_f32_16x16x32_bf16 v[148:151], a[144:147], v[32:35], v[112:115]
ds_read_b128 a[176:179], v2 offset:28672
v_cvt_pk_bf16_f32 v208, v160, v161
s_branch Ljoin14
Ltri13:
v_mfma_f32_16x16x32_bf16 v[128:131], a[128:131], v[16:19], v[96:99]
s_add_u32 s82, s82, 0x8000
ds_read_b128 a[160:163], v2 offset:24576
v_mfma_f32_16x16x32_bf16 v[132:135], a[128:131], v[32:35], v[84:87]
s_and_b32 s82, s82, 0x1ffff
v_exp_f32 v160, v160
v_mfma_f32_16x16x32_bf16 v[144:147], a[144:147], v[16:19], v[112:115]
s_lshl_b32 s73, s93, 1
v_exp_f32 v161, v161
v_mfma_f32_16x16x32_bf16 v[148:151], a[144:147], v[32:35], v[100:103]
ds_read_b128 a[176:179], v2 offset:28672
v_cvt_pk_bf16_f32 v208, v160, v161
s_branch Ljoin14
Lalt15:
s_cmp_eq_u32 s58, 0
s_cbranch_scc1 Ltri16
v_mfma_f32_16x16x32_bf16 v[128:131], a[128:131], v[16:19], v[112:115]
s_add_u32 s82, s82, 0x8000
ds_read_b128 a[160:163], v2 offset:24576
v_mfma_f32_16x16x32_bf16 v[132:135], a[128:131], v[32:35], v[112:115]
s_and_b32 s82, s82, 0x1ffff
v_exp_f32 v160, v160
v_mfma_f32_16x16x32_bf16 v[144:147], a[144:147], v[16:19], v[112:115]
s_add_u32 m0, s74, 0
v_exp_f32 v161, v161
v_mfma_f32_16x16x32_bf16 v[148:151], a[144:147], v[32:35], v[112:115]
s_add_u32 s72, s81, 0
ds_read_b128 a[176:179], v2 offset:28672
v_cvt_pk_bf16_f32 v208, v160, v161
s_branch Ljoin17
Ltri16:
v_mfma_f32_16x16x32_bf16 v[128:131], a[128:131], v[16:19], v[96:99]
s_add_u32 s82, s82, 0x8000
ds_read_b128 a[160:163], v2 offset:24576
v_mfma_f32_16x16x32_bf16 v[132:135], a[128:131], v[32:35], v[84:87]
s_and_b32 s82, s82, 0x1ffff
v_exp_f32 v160, v160
v_mfma_f32_16x16x32_bf16 v[144:147], a[144:147], v[16:19], v[112:115]
s_add_u32 m0, s74, 0
v_exp_f32 v161, v161
v_mfma_f32_16x16x32_bf16 v[148:151], a[144:147], v[32:35], v[100:103]
s_add_u32 s72, s81, 0
ds_read_b128 a[176:179], v2 offset:28672
v_cvt_pk_bf16_f32 v208, v160, v161
s_branch Ljoin17
Lalt18:
s_cmp_eq_u32 s58, 1
s_cbranch_scc1 Ltri19
v_mfma_f32_16x16x32_bf16 v[160:163], a[160:163], v[16:19], v[112:115]
s_xor_b32 s74, s82, 0x10000
v_exp_f32 v128, v128
v_mfma_f32_16x16x32_bf16 v[164:167], a[160:163], v[32:35], v[112:115]
s_add_u32 s74, s74, s64
ds_read_b128 a[128:131], v2 offset:16384
v_mfma_f32_16x16x32_bf16 v[176:179], a[176:179], v[16:19], v[112:115]
s_add_u32 s81, s81, 0x8000
v_exp_f32 v129, v129
v_mfma_f32_16x16x32_bf16 v[180:183], a[176:179], v[32:35], v[112:115]
s_add_u32 m0, s74, 16384
v_exp_f32 v130, v130
s_branch Ljoin20
Ltri19:
v_mfma_f32_16x16x32_bf16 v[160:163], a[160:163], v[16:19], v[96:99]
s_xor_b32 s74, s82, 0x10000
v_exp_f32 v128, v128
v_mfma_f32_16x16x32_bf16 v[164:167], a[160:163], v[32:35], v[84:87]
s_add_u32 s74, s74, s64
ds_read_b128 a[128:131], v2 offset:16384
v_mfma_f32_16x16x32_bf16 v[176:179], a[176:179], v[16:19], v[112:115]
s_add_u32 s81, s81, 0x8000
v_exp_f32 v129, v129
v_mfma_f32_16x16x32_bf16 v[180:183], a[176:179], v[32:35], v[100:103]
s_add_u32 m0, s74, 16384
v_exp_f32 v130, v130
s_branch Ljoin20
Lalt21:
s_cmp_eq_u32 s58, 2
s_cbranch_scc1 Ltri22
v_mfma_f32_16x16x32_bf16 v[128:131], a[128:131], v[16:19], v[112:115]
s_add_u32 s82, s82, 0x8000
ds_read_b128 a[160:163], v2 offset:24576
v_mfma_f32_16x16x32_bf16 v[132:135], a[128:131], v[32:35], v[112:115]
s_and_b32 s82, s82, 0x1ffff
v_exp_f32 v160, v160
v_mfma_f32_16x16x32_bf16 v[144:147], a[144:147], v[16:19], v[112:115]
s_add_u32 m0, s74, 0
v_exp_f32 v161, v161
v_mfma_f32_16x16x32_bf16 v[148:151], a[144:147], v[32:35], v[112:115]
s_add_u32 s72, s81, 0
ds_read_b128 a[176:179], v2 offset:28672
v_cvt_pk_bf16_f32 v208, v160, v161
s_branch Ljoin23
Ltri22:
v_mfma_f32_16x16x32_bf16 v[128:131], a[128:131], v[16:19], v[96:99]
s_add_u32 s82, s82, 0x8000
ds_read_b128 a[160:163], v2 offset:24576
v_mfma_f32_16x16x32_bf16 v[132:135], a[128:131], v[32:35], v[84:87]
s_and_b32 s82, s82, 0x1ffff
v_exp_f32 v160, v160
v_mfma_f32_16x16x32_bf16 v[144:147], a[144:147], v[16:19], v[112:115]
s_add_u32 m0, s74, 0
v_exp_f32 v161, v161
v_mfma_f32_16x16x32_bf16 v[148:151], a[144:147], v[32:35], v[100:103]
s_add_u32 s72, s81, 0
ds_read_b128 a[176:179], v2 offset:28672
v_cvt_pk_bf16_f32 v208, v160, v161
s_branch Ljoin23
Lalt24:
s_cmp_eq_u32 s58, 3
s_cbranch_scc1 Ltri25
v_mfma_f32_16x16x32_bf16 v[160:163], a[160:163], v[16:19], v[112:115]
s_lshl_b32 s73, s93, 1
v_exp_f32 v128, v128
v_mfma_f32_16x16x32_bf16 v[164:167], a[160:163], v[32:35], v[112:115]
s_add_u32 s73, s73, 0x1000
ds_read_b128 a[128:131], v2 offset:16384
v_mfma_f32_16x16x32_bf16 v[176:179], a[176:179], v[16:19], v[112:115]
v_exp_f32 v129, v129
v_mfma_f32_16x16x32_bf16 v[180:183], a[176:179], v[32:35], v[112:115]
v_exp_f32 v130, v130
s_branch Ljoin26
Ltri25:
v_mfma_f32_16x16x32_bf16 v[160:163], a[160:163], v[16:19], v[96:99]
s_lshl_b32 s73, s93, 1
v_exp_f32 v128, v128
v_mfma_f32_16x16x32_bf16 v[164:167], a[160:163], v[32:35], v[84:87]
s_add_u32 s73, s73, 0x1000
ds_read_b128 a[128:131], v2 offset:16384
v_mfma_f32_16x16x32_bf16 v[176:179], a[176:179], v[16:19], v[112:115]
v_exp_f32 v129, v129
v_mfma_f32_16x16x32_bf16 v[180:183], a[176:179], v[32:35], v[100:103]
v_exp_f32 v130, v130
s_branch Ljoin26
Lalt27:
s_cmp_eq_u32 s85, 0
s_cbranch_scc1 Ltri28
v_mfma_f32_16x16x32_bf16 v[136:139], a[128:131], v[48:51], v[112:115]
s_add_u32 s82, s82, 0x8000
ds_read_b128 a[160:163], v2 offset:24576
ds_read_b128 a[176:179], v2 offset:28672
v_mfma_f32_16x16x32_bf16 v[140:143], a[128:131], v[64:67], v[112:115]
s_and_b32 s82, s82, 0x1ffff
v_exp_f32 v160, v160
v_mfma_f32_16x16x32_bf16 v[152:155], a[144:147], v[48:51], v[112:115]
s_add_u32 m0, s74, 0
v_exp_f32 v161, v161
v_mfma_f32_16x16x32_bf16 v[156:159], a[144:147], v[64:67], v[112:115]
s_add_u32 s72, s81, 0
v_exp_f32 v162, v162
s_branch Ljoin29
Ltri28:
v_mfma_f32_16x16x32_bf16 v[136:139], a[128:131], v[48:51], v[104:107]
s_add_u32 s82, s82, 0x8000
ds_read_b128 a[160:163], v2 offset:24576
ds_read_b128 a[176:179], v2 offset:28672
v_mfma_f32_16x16x32_bf16 v[140:143], a[128:131], v[64:67], v[92:95]
s_and_b32 s82, s82, 0x1ffff
v_exp_f32 v160, v160
v_mfma_f32_16x16x32_bf16 v[152:155], a[144:147], v[48:51], v[112:115]
s_add_u32 m0, s74, 0
v_exp_f32 v161, v161
v_mfma_f32_16x16x32_bf16 v[156:159], a[144:147], v[64:67], v[108:111]
s_add_u32 s72, s81, 0
v_exp_f32 v162, v162
s_branch Ljoin29
Lalt30:
s_cmp_eq_u32 s85, 1
s_cbranch_scc1 Ltri31
v_mfma_f32_16x16x32_bf16 v[168:171], a[160:163], v[48:51], v[112:115]
s_xor_b32 s74, s82, 0x10000
v_exp_f32 v136, v136
v_mfma_f32_16x16x32_bf16 v[172:175], a[160:163], v[64:67], v[112:115]
s_add_u32 s74, s74, s64
ds_read_b128 a[128:131], v2 offset:16384
v_mfma_f32_16x16x32_bf16 v[184:187], a[176:179], v[48:51], v[112:115]
s_add_u32 s81, s81, 0x8000
v_exp_f32 v137, v137
v_mfma_f32_16x16x32_bf16 v[188:191], a[176:179], v[64:67], v[112:115]
s_add_u32 m0, s74, 16384
ds_read_b128 a[144:147], v2 offset:20480
v_cvt_pk_bf16_f32 v200, v136, v137
s_branch Ljoin32
Ltri31:
v_mfma_f32_16x16x32_bf16 v[168:171], a[160:163], v[48:51], v[104:107]
s_xor_b32 s74, s82, 0x10000
v_exp_f32 v136, v136
v_mfma_f32_16x16x32_bf16 v[172:175], a[160:163], v[64:67], v[92:95]
s_add_u32 s74, s74, s64
ds_read_b128 a[128:131], v2 offset:16384
v_mfma_f32_16x16x32_bf16 v[184:187], a[176:179], v[48:51], v[112:115]
s_add_u32 s81, s81, 0x8000
v_exp_f32 v137, v137
v_mfma_f32_16x16x32_bf16 v[188:191], a[176:179], v[64:67], v[108:111]
s_add_u32 m0, s74, 16384
ds_read_b128 a[144:147], v2 offset:20480
v_cvt_pk_bf16_f32 v200, v136, v137
s_branch Ljoin32
Lalt33:
s_cmp_eq_u32 s85, 2
s_cbranch_scc1 Ltri34
v_mfma_f32_16x16x32_bf16 v[136:139], a[128:131], v[48:51], v[112:115]
s_add_u32 s82, s82, 0x8000
ds_read_b128 a[160:163], v2 offset:24576
ds_read_b128 a[176:179], v2 offset:28672
v_mfma_f32_16x16x32_bf16 v[140:143], a[128:131], v[64:67], v[112:115]
s_and_b32 s82, s82, 0x1ffff
v_exp_f32 v168, v168
v_mfma_f32_16x16x32_bf16 v[152:155], a[144:147], v[48:51], v[112:115]
s_add_u32 m0, s74, 0
v_exp_f32 v169, v169
v_mfma_f32_16x16x32_bf16 v[156:159], a[144:147], v[64:67], v[112:115]
s_add_u32 s72, s81, 0
ds_read_b128 a[164:167], v2 offset:25600
v_cvt_pk_bf16_f32 v216, v168, v169
s_branch Ljoin35
Ltri34:
v_mfma_f32_16x16x32_bf16 v[136:139], a[128:131], v[48:51], v[104:107]
s_add_u32 s82, s82, 0x8000
ds_read_b128 a[160:163], v2 offset:24576
ds_read_b128 a[176:179], v2 offset:28672
v_mfma_f32_16x16x32_bf16 v[140:143], a[128:131], v[64:67], v[92:95]
s_and_b32 s82, s82, 0x1ffff
v_exp_f32 v168, v168
v_mfma_f32_16x16x32_bf16 v[152:155], a[144:147], v[48:51], v[112:115]
s_add_u32 m0, s74, 0
v_exp_f32 v169, v169
v_mfma_f32_16x16x32_bf16 v[156:159], a[144:147], v[64:67], v[108:111]
s_add_u32 s72, s81, 0
ds_read_b128 a[164:167], v2 offset:25600
v_cvt_pk_bf16_f32 v216, v168, v169
s_branch Ljoin35
Lalt36:
s_cmp_eq_u32 s58, 0
s_cbranch_scc1 Ltri37
v_mfma_f32_16x16x32_bf16 v[136:139], a[128:131], v[48:51], v[112:115]
s_add_u32 s82, s82, 0x8000
ds_read_b128 a[160:163], v2 offset:24576
v_mfma_f32_16x16x32_bf16 v[140:143], a[128:131], v[64:67], v[112:115]
s_and_b32 s82, s82, 0x1ffff
v_exp_f32 v168, v168
v_mfma_f32_16x16x32_bf16 v[152:155], a[144:147], v[48:51], v[112:115]
ds_read_b128 a[176:179], v2 offset:28672
v_mfma_f32_16x16x32_bf16 v[156:159], a[144:147], v[64:67], v[112:115]
v_exp_f32 v169, v169
s_branch Ljoin38
Ltri37:
v_mfma_f32_16x16x32_bf16 v[136:139], a[128:131], v[48:51], v[104:107]
s_add_u32 s82, s82, 0x8000
ds_read_b128 a[160:163], v2 offset:24576
v_mfma_f32_16x16x32_bf16 v[140:143], a[128:131], v[64:67], v[92:95]
s_and_b32 s82, s82, 0x1ffff
v_exp_f32 v168, v168
v_mfma_f32_16x16x32_bf16 v[152:155], a[144:147], v[48:51], v[112:115]
ds_read_b128 a[176:179], v2 offset:28672
v_mfma_f32_16x16x32_bf16 v[156:159], a[144:147], v[64:67], v[108:111]
v_exp_f32 v169, v169
s_branch Ljoin38
Lalt39:
s_cmp_eq_u32 s58, 1
s_cbranch_scc1 Ltri40
v_mfma_f32_16x16x32_bf16 v[168:171], a[160:163], v[48:51], v[112:115]
v_exp_f32 v136, v136
v_mfma_f32_16x16x32_bf16 v[172:175], a[160:163], v[64:67], v[112:115]
ds_read_b128 a[128:131], v2 offset:16384
v_mfma_f32_16x16x32_bf16 v[184:187], a[176:179], v[48:51], v[112:115]
v_exp_f32 v137, v137
v_mfma_f32_16x16x32_bf16 v[188:191], a[176:179], v[64:67], v[112:115]
ds_read_b128 a[144:147], v2 offset:20480
v_cvt_pk_bf16_f32 v200, v136, v137
s_branch Ljoin41
Ltri40:
v_mfma_f32_16x16x32_bf16 v[168:171], a[160:163], v[48:51], v[104:107]
v_exp_f32 v136, v136
v_mfma_f32_16x16x32_bf16 v[172:175], a[160:163], v[64:67], v[92:95]
ds_read_b128 a[128:131], v2 offset:16384
v_mfma_f32_16x16x32_bf16 v[184:187], a[176:179], v[48:51], v[112:115]
v_exp_f32 v137, v137
v_mfma_f32_16x16x32_bf16 v[188:191], a[176:179], v[64:67], v[108:111]
ds_read_b128 a[144:147], v2 offset:20480
v_cvt_pk_bf16_f32 v200, v136, v137
s_branch Ljoin41
Lalt42:
s_cmp_eq_u32 s58, 2
s_cbranch_scc1 Ltri43
v_mfma_f32_16x16x32_bf16 v[136:139], a[128:131], v[48:51], v[112:115]
s_add_u32 s82, s82, 0x8000
ds_read_b128 a[160:163], v2 offset:24576
v_mfma_f32_16x16x32_bf16 v[140:143], a[128:131], v[64:67], v[112:115]
s_and_b32 s82, s82, 0x1ffff
v_exp_f32 v168, v168
v_mfma_f32_16x16x32_bf16 v[152:155], a[144:147], v[48:51], v[112:115]
ds_read_b128 a[176:179], v2 offset:28672
v_mfma_f32_16x16x32_bf16 v[156:159], a[144:147], v[64:67], v[112:115]
v_exp_f32 v169, v169
s_branch Ljoin44
Ltri43:
v_mfma_f32_16x16x32_bf16 v[136:139], a[128:131], v[48:51], v[104:107]
s_add_u32 s82, s82, 0x8000
ds_read_b128 a[160:163], v2 offset:24576
v_mfma_f32_16x16x32_bf16 v[140:143], a[128:131], v[64:67], v[92:95]
s_and_b32 s82, s82, 0x1ffff
v_exp_f32 v168, v168
v_mfma_f32_16x16x32_bf16 v[152:155], a[144:147], v[48:51], v[112:115]
ds_read_b128 a[176:179], v2 offset:28672
v_mfma_f32_16x16x32_bf16 v[156:159], a[144:147], v[64:67], v[108:111]
v_exp_f32 v169, v169
s_branch Ljoin44
Lalt45:
s_cmp_eq_u32 s58, 3
s_cbranch_scc1 Ltri46
v_mfma_f32_16x16x32_bf16 v[168:171], a[160:163], v[48:51], v[112:115]
v_exp_f32 v136, v136
v_mfma_f32_16x16x32_bf16 v[172:175], a[160:163], v[64:67], v[112:115]
ds_read_b128 a[192:195], v2 offset:0
v_mfma_f32_16x16x32_bf16 v[184:187], a[176:179], v[48:51], v[112:115]
v_exp_f32 v137, v137
v_mfma_f32_16x16x32_bf16 v[188:191], a[176:179], v[64:67], v[112:115]
v_exp_f32 v138, v138
s_branch Ljoin47
Ltri46:
v_mfma_f32_16x16x32_bf16 v[168:171], a[160:163], v[48:51], v[104:107]
v_exp_f32 v136, v136
v_mfma_f32_16x16x32_bf16 v[172:175], a[160:163], v[64:67], v[92:95]
ds_read_b128 a[192:195], v2 offset:0
v_mfma_f32_16x16x32_bf16 v[184:187], a[176:179], v[48:51], v[112:115]
v_exp_f32 v137, v137
v_mfma_f32_16x16x32_bf16 v[188:191], a[176:179], v[64:67], v[108:111]
v_exp_f32 v138, v138
s_branch Ljoin47
Lslow:
s_waitcnt vmcnt(0) lgkmcnt(0)
s_barrier
s_mov_b32 s86, 1
s_lshl_b32 s81, s59, 20
s_add_u32 s81, s81, s64
s_sub_u32 s81, s81, 0x4000
s_mov_b32 s83, 0
s_lshl_b32 s75, s60, 2
s_sub_u32 s76, 64, s75
s_sub_u32 s75, s76, 4
s_add_u32 s75, s75, s58
v_mov_b32 v2, v1
v_lshrrev_b32 v240, 4, v0
v_and_b32 v241, 15, v0
v_lshlrev_b32 v240, 2, v240
v_sub_u32 v240, v241, v240
v_mov_b32 v112, 0xff800000
v_mov_b32 v113, 0xff800000
v_mov_b32 v114, 0xff800000
v_mov_b32 v115, 0xff800000
v_cmp_gt_i32 vcc, 0, v240
v_mov_b32 v120, 0x3f803f80
s_nop 0
v_cndmask_b32 v116, 0, v112, vcc
v_cmp_gt_i32 vcc, 1, v240
v_mov_b32 v121, 0x3f803f80
s_nop 0
v_cndmask_b32 v117, 0, v112, vcc
v_cmp_gt_i32 vcc, 2, v240
v_mov_b32 v122, 0x3f803f80
s_nop 0
v_cndmask_b32 v118, 0, v112, vcc
v_cmp_gt_i32 vcc, 3, v240
v_mov_b32 v123, 0x3f803f80
s_nop 0
v_cndmask_b32 v119, 0, v112, vcc
Lslow1:
s_add_u32 m0, s64, 16384
s_add_u32 s72, s81, 16384
buffer_load_dwordx4 v1, s[44:47], s72 offen sc1 lds
buffer_load_dwordx4 v1, s[44:47], s72 offen offset:1024 sc1 lds
buffer_load_dwordx4 v1, s[44:47], s72 offen offset:2048 sc1 lds
buffer_load_dwordx4 v1, s[44:47], s72 offen offset:3072 sc1 lds
s_add_u32 s81, s81, 0x8000
s_waitcnt vmcnt(0)
s_barrier
ds_read_b128 a[128:131], v2 offset:16384
ds_read_b128 a[144:147], v2 offset:20480
ds_read_b128 a[132:135], v2 offset:17408
ds_read_b128 a[148:151], v2 offset:21504
ds_read_b128 a[136:139], v2 offset:18432
ds_read_b128 a[152:155], v2 offset:22528
ds_read_b128 a[140:143], v2 offset:19456
ds_read_b128 a[156:159], v2 offset:23552
s_waitcnt lgkmcnt(0)
s_cmp_lt_u32 s84, s83
s_cbranch_scc1 Lsa48
s_cmp_eq_u32 s84, s83
s_cbranch_scc1 Lst49
v_mfma_f32_16x16x32_bf16 v[128:131], a[128:131], v[16:19], 0
v_mfma_f32_16x16x32_bf16 v[132:135], a[128:131], v[32:35], 0
v_mfma_f32_16x16x32_bf16 v[144:147], a[144:147], v[16:19], 0
v_mfma_f32_16x16x32_bf16 v[148:151], a[144:147], v[32:35], 0
s_branch Lsj50
Lst49:
v_mfma_f32_16x16x32_bf16 v[128:131], a[128:131], v[16:19], v[116:119]
v_mfma_f32_16x16x32_bf16 v[132:135], a[128:131], v[32:35], 0
v_mfma_f32_16x16x32_bf16 v[144:147], a[144:147], v[16:19], v[112:115]
v_mfma_f32_16x16x32_bf16 v[148:151], a[144:147], v[32:35], v[116:119]
Lsj50:
v_mfma_f32_16x16x32_bf16 v[128:131], a[132:135], v[20:23], v[128:131]
v_mfma_f32_16x16x32_bf16 v[132:135], a[132:135], v[36:39], v[132:135]
v_mfma_f32_16x16x32_bf16 v[148:151], a[148:151], v[36:39], v[148:151]
v_mfma_f32_16x16x32_bf16 v[144:147], a[148:151], v[20:23], v[144:147]
v_mfma_f32_16x16x32_bf16 v[132:135], a[136:139], v[40:43], v[132:135]
v_mfma_f32_16x16x32_bf16 v[128:131], a[136:139], v[24:27], v[128:131]
v_mfma_f32_16x16x32_bf16 v[144:147], a[152:155], v[24:27], v[144:147]
v_mfma_f32_16x16x32_bf16 v[148:151], a[152:155], v[40:43], v[148:151]
v_mfma_f32_16x16x32_bf16 v[128:131], a[140:143], v[28:31], v[128:131]
v_mfma_f32_16x16x32_bf16 v[132:135], a[140:143], v[44:47], v[132:135]
v_mfma_f32_16x16x32_bf16 v[148:151], a[156:159], v[44:47], v[148:151]
v_mfma_f32_16x16x32_bf16 v[144:147], a[156:159], v[28:31], v[144:147]
s_nop 7
v_max3_f32 v124, v124, v128, v129
v_max3_f32 v124, v124, v130, v131
v_max3_f32 v124, v124, v144, v145
v_max3_f32 v124, v124, v146, v147
v_max3_f32 v125, v125, v132, v133
v_max3_f32 v125, v125, v134, v135
v_max3_f32 v125, v125, v148, v149
v_max3_f32 v125, v125, v150, v151
Lsa48:
s_cmp_lt_u32 s75, s83
s_cbranch_scc1 Lsa51
s_cmp_eq_u32 s75, s83
s_cbranch_scc1 Lst52
v_mfma_f32_16x16x32_bf16 v[136:139], a[128:131], v[48:51], 0
v_mfma_f32_16x16x32_bf16 v[140:143], a[128:131], v[64:67], 0
v_mfma_f32_16x16x32_bf16 v[152:155], a[144:147], v[48:51], 0
v_mfma_f32_16x16x32_bf16 v[156:159], a[144:147], v[64:67], 0
s_branch Lsj53
Lst52:
v_mfma_f32_16x16x32_bf16 v[136:139], a[128:131], v[48:51], v[116:119]
v_mfma_f32_16x16x32_bf16 v[140:143], a[128:131], v[64:67], 0
v_mfma_f32_16x16x32_bf16 v[152:155], a[144:147], v[48:51], v[112:115]
v_mfma_f32_16x16x32_bf16 v[156:159], a[144:147], v[64:67], v[116:119]
Lsj53:
v_mfma_f32_16x16x32_bf16 v[136:139], a[132:135], v[52:55], v[136:139]
v_mfma_f32_16x16x32_bf16 v[140:143], a[132:135], v[68:71], v[140:143]
v_mfma_f32_16x16x32_bf16 v[156:159], a[148:151], v[68:71], v[156:159]
v_mfma_f32_16x16x32_bf16 v[152:155], a[148:151], v[52:55], v[152:155]
v_mfma_f32_16x16x32_bf16 v[140:143], a[136:139], v[72:75], v[140:143]
v_mfma_f32_16x16x32_bf16 v[136:139], a[136:139], v[56:59], v[136:139]
v_mfma_f32_16x16x32_bf16 v[152:155], a[152:155], v[56:59], v[152:155]
v_mfma_f32_16x16x32_bf16 v[156:159], a[152:155], v[72:75], v[156:159]
v_mfma_f32_16x16x32_bf16 v[136:139], a[140:143], v[60:63], v[136:139]
v_mfma_f32_16x16x32_bf16 v[140:143], a[140:143], v[76:79], v[140:143]
v_mfma_f32_16x16x32_bf16 v[156:159], a[156:159], v[76:79], v[156:159]
v_mfma_f32_16x16x32_bf16 v[152:155], a[156:159], v[60:63], v[152:155]
s_nop 7
v_max3_f32 v126, v126, v136, v137
v_max3_f32 v126, v126, v138, v139
v_max3_f32 v126, v126, v152, v153
v_max3_f32 v126, v126, v154, v155
v_max3_f32 v127, v127, v140, v141
v_max3_f32 v127, v127, v142, v143
v_max3_f32 v127, v127, v156, v157
v_max3_f32 v127, v127, v158, v159
Lsa51:
s_add_u32 s83, s83, 1
ds_read_b128 a[128:131], v2 offset:24576
ds_read_b128 a[144:147], v2 offset:28672
ds_read_b128 a[132:135], v2 offset:25600
ds_read_b128 a[148:151], v2 offset:29696
ds_read_b128 a[136:139], v2 offset:26624
ds_read_b128 a[152:155], v2 offset:30720
ds_read_b128 a[140:143], v2 offset:27648
ds_read_b128 a[156:159], v2 offset:31744
s_waitcnt lgkmcnt(0)
s_cmp_lt_u32 s84, s83
s_cbranch_scc1 Lsa54
s_cmp_eq_u32 s84, s83
s_cbranch_scc1 Lst55
v_mfma_f32_16x16x32_bf16 v[128:131], a[128:131], v[16:19], 0
v_mfma_f32_16x16x32_bf16 v[132:135], a[128:131], v[32:35], 0
v_mfma_f32_16x16x32_bf16 v[144:147], a[144:147], v[16:19], 0
v_mfma_f32_16x16x32_bf16 v[148:151], a[144:147], v[32:35], 0
s_branch Lsj56
Lst55:
v_mfma_f32_16x16x32_bf16 v[128:131], a[128:131], v[16:19], v[116:119]
v_mfma_f32_16x16x32_bf16 v[132:135], a[128:131], v[32:35], 0
v_mfma_f32_16x16x32_bf16 v[144:147], a[144:147], v[16:19], v[112:115]
v_mfma_f32_16x16x32_bf16 v[148:151], a[144:147], v[32:35], v[116:119]
Lsj56:
v_mfma_f32_16x16x32_bf16 v[128:131], a[132:135], v[20:23], v[128:131]
v_mfma_f32_16x16x32_bf16 v[132:135], a[132:135], v[36:39], v[132:135]
v_mfma_f32_16x16x32_bf16 v[148:151], a[148:151], v[36:39], v[148:151]
v_mfma_f32_16x16x32_bf16 v[144:147], a[148:151], v[20:23], v[144:147]
v_mfma_f32_16x16x32_bf16 v[132:135], a[136:139], v[40:43], v[132:135]
v_mfma_f32_16x16x32_bf16 v[128:131], a[136:139], v[24:27], v[128:131]
v_mfma_f32_16x16x32_bf16 v[144:147], a[152:155], v[24:27], v[144:147]
v_mfma_f32_16x16x32_bf16 v[148:151], a[152:155], v[40:43], v[148:151]
v_mfma_f32_16x16x32_bf16 v[128:131], a[140:143], v[28:31], v[128:131]
v_mfma_f32_16x16x32_bf16 v[132:135], a[140:143], v[44:47], v[132:135]
v_mfma_f32_16x16x32_bf16 v[148:151], a[156:159], v[44:47], v[148:151]
v_mfma_f32_16x16x32_bf16 v[144:147], a[156:159], v[28:31], v[144:147]
s_nop 7
v_max3_f32 v124, v124, v128, v129
v_max3_f32 v124, v124, v130, v131
v_max3_f32 v124, v124, v144, v145
v_max3_f32 v124, v124, v146, v147
v_max3_f32 v125, v125, v132, v133
v_max3_f32 v125, v125, v134, v135
v_max3_f32 v125, v125, v148, v149
v_max3_f32 v125, v125, v150, v151
Lsa54:
s_cmp_lt_u32 s75, s83
s_cbranch_scc1 Lsa57
s_cmp_eq_u32 s75, s83
s_cbranch_scc1 Lst58
v_mfma_f32_16x16x32_bf16 v[136:139], a[128:131], v[48:51], 0
v_mfma_f32_16x16x32_bf16 v[140:143], a[128:131], v[64:67], 0
v_mfma_f32_16x16x32_bf16 v[152:155], a[144:147], v[48:51], 0
v_mfma_f32_16x16x32_bf16 v[156:159], a[144:147], v[64:67], 0
s_branch Lsj59
Lst58:
v_mfma_f32_16x16x32_bf16 v[136:139], a[128:131], v[48:51], v[116:119]
v_mfma_f32_16x16x32_bf16 v[140:143], a[128:131], v[64:67], 0
v_mfma_f32_16x16x32_bf16 v[152:155], a[144:147], v[48:51], v[112:115]
v_mfma_f32_16x16x32_bf16 v[156:159], a[144:147], v[64:67], v[116:119]
Lsj59:
v_mfma_f32_16x16x32_bf16 v[136:139], a[132:135], v[52:55], v[136:139]
v_mfma_f32_16x16x32_bf16 v[140:143], a[132:135], v[68:71], v[140:143]
v_mfma_f32_16x16x32_bf16 v[156:159], a[148:151], v[68:71], v[156:159]
v_mfma_f32_16x16x32_bf16 v[152:155], a[148:151], v[52:55], v[152:155]
v_mfma_f32_16x16x32_bf16 v[140:143], a[136:139], v[72:75], v[140:143]
v_mfma_f32_16x16x32_bf16 v[136:139], a[136:139], v[56:59], v[136:139]
v_mfma_f32_16x16x32_bf16 v[152:155], a[152:155], v[56:59], v[152:155]
v_mfma_f32_16x16x32_bf16 v[156:159], a[152:155], v[72:75], v[156:159]
v_mfma_f32_16x16x32_bf16 v[136:139], a[140:143], v[60:63], v[136:139]
v_mfma_f32_16x16x32_bf16 v[140:143], a[140:143], v[76:79], v[140:143]
v_mfma_f32_16x16x32_bf16 v[156:159], a[156:159], v[76:79], v[156:159]
v_mfma_f32_16x16x32_bf16 v[152:155], a[156:159], v[60:63], v[152:155]
s_nop 7
v_max3_f32 v126, v126, v136, v137
v_max3_f32 v126, v126, v138, v139
v_max3_f32 v126, v126, v152, v153
v_max3_f32 v126, v126, v154, v155
v_max3_f32 v127, v127, v140, v141
v_max3_f32 v127, v127, v142, v143
v_max3_f32 v127, v127, v156, v157
v_max3_f32 v127, v127, v158, v159
Lsa57:
s_add_u32 s83, s83, 1
s_barrier
s_cmp_lt_u32 s83, s76
s_cbranch_scc1 Lslow1
s_lshl_b32 s81, s59, 20
s_add_u32 s81, s81, s64
s_sub_u32 s81, s81, 0x4000
s_add_u32 m0, s64, 49152
s_add_u32 s72, s81, 16384
buffer_load_dwordx4 v1, s[44:47], s72 offen sc1 lds
buffer_load_dwordx4 v1, s[44:47], s72 offen offset:1024 sc1 lds
buffer_load_dwordx4 v1, s[44:47], s72 offen offset:2048 sc1 lds
buffer_load_dwordx4 v1, s[44:47], s72 offen offset:3072 sc1 lds
s_add_u32 s81, s81, 0x8000
s_add_u32 m0, s64, 81920
s_add_u32 s72, s81, 16384
buffer_load_dwordx4 v1, s[44:47], s72 offen sc1 lds
buffer_load_dwordx4 v1, s[44:47], s72 offen offset:1024 sc1 lds
buffer_load_dwordx4 v1, s[44:47], s72 offen offset:2048 sc1 lds
buffer_load_dwordx4 v1, s[44:47], s72 offen offset:3072 sc1 lds
s_add_u32 m0, s64, 65536
s_add_u32 s72, s81, 0
buffer_load_dwordx4 v1, s[44:47], s72 offen sc1 lds
buffer_load_dwordx4 v1, s[44:47], s72 offen offset:1024 sc1 lds
buffer_load_dwordx4 v1, s[44:47], s72 offen offset:2048 sc1 lds
buffer_load_dwordx4 v1, s[44:47], s72 offen offset:3072 sc1 lds
s_add_u32 s81, s81, 0x8000
s_add_u32 m0, s64, 114688
s_add_u32 s72, s81, 16384
buffer_load_dwordx4 v1, s[44:47], s72 offen sc1 lds
buffer_load_dwordx4 v1, s[44:47], s72 offen offset:1024 sc1 lds
buffer_load_dwordx4 v1, s[44:47], s72 offen offset:2048 sc1 lds
buffer_load_dwordx4 v1, s[44:47], s72 offen offset:3072 sc1 lds
s_add_u32 m0, s64, 98304
s_add_u32 s72, s81, 0
buffer_load_dwordx4 v1, s[44:47], s72 offen sc1 lds
buffer_load_dwordx4 v1, s[44:47], s72 offen offset:1024 sc1 lds
buffer_load_dwordx4 v1, s[44:47], s72 offen offset:2048 sc1 lds
buffer_load_dwordx4 v1, s[44:47], s72 offen offset:3072 sc1 lds
v_add_u32 v2, 0x8000, v1
s_waitcnt vmcnt(16)
s_barrier
ds_read_b128 a[128:131], v2 offset:16384
ds_read_b128 a[144:147], v2 offset:20480
ds_read_b128 a[132:135], v2 offset:17408
ds_read_b128 a[148:151], v2 offset:21504
ds_read_b128 a[136:139], v2 offset:18432
ds_read_b128 a[152:155], v2 offset:22528
ds_read_b128 a[140:143], v2 offset:19456
ds_read_b128 a[156:159], v2 offset:23552
s_branch Lattn
Lspin60:
s_mov_b32 s83, 262144
Lsl62:
s_sleep 2
buffer_load_dword v3, v2, s[44:47], s74 offen sc1
s_sub_u32 s83, s83, 1
s_cmp_eq_u32 s83, 0
s_waitcnt vmcnt(0)
s_cbranch_scc1 Lback61
v_cmp_gt_u32 vcc, 2, v3
s_cbranch_vccnz Lsl62
s_branch Lback61
Lspin63:
s_mov_b32 s83, 262144
Lsl65:
s_sleep 2
buffer_load_dword v3, v2, s[44:47], s74 offen sc1
s_sub_u32 s83, s83, 1
s_cmp_eq_u32 s83, 0
s_waitcnt vmcnt(0)
s_cbranch_scc1 Lback64
v_cmp_gt_u32 vcc, 3, v3
s_cbranch_vccnz Lsl65
s_branch Lback64
Lcode_end:
s_endpgm
.section .rodata,"a"
.p2align 6
.amdhsa_kernel gated_mix__compressed_kv_cla__ssm_conv_h3__prompt_kernel
  .amdhsa_next_free_vgpr 512
  .amdhsa_next_free_sgpr 102
  .amdhsa_accum_offset 256
  .amdhsa_group_segment_fixed_size 0
  .amdhsa_kernarg_size 128
  .amdhsa_user_sgpr_count 2
  .amdhsa_user_sgpr_kernarg_segment_ptr 1
  .amdhsa_system_sgpr_workgroup_id_x 1
  .amdhsa_float_denorm_mode_32 3
.end_amdhsa_kernel
```

```asm
; @launch grid=(256,1,1) block=(256,1,1) lds=163840
.amdgcn_target "amdgcn-amd-amdhsa--gfx950"
.text
.globl gated_mix__compressed_kv_cla__ssm_conv_h3__prompt_kernel
.p2align 8
.type gated_mix__compressed_kv_cla__ssm_conv_h3__prompt_kernel,@function
gated_mix__compressed_kv_cla__ssm_conv_h3__prompt_kernel:
s_cmp_ge_u32 s2, 256
s_cbranch_scc1 Lend
s_load_dwordx2 s[8:9], s[0:1], 8
s_load_dwordx2 s[16:17], s[0:1], 24
s_load_dwordx2 s[20:21], s[0:1], 32
s_load_dwordx2 s[4:5], s[0:1], 0
s_load_dwordx2 s[12:13], s[0:1], 16
s_load_dwordx2 s[24:25], s[0:1], 40
s_load_dwordx2 s[28:29], s[0:1], 56
s_load_dwordx2 s[32:33], s[0:1], 64
s_load_dwordx2 s[52:53], s[0:1], 72
s_load_dwordx2 s[36:37], s[0:1], 80
s_load_dwordx2 s[54:55], s[0:1], 88
s_load_dwordx2 s[56:57], s[0:1], 96
s_load_dwordx2 s[40:41], s[0:1], 104
s_load_dwordx2 s[48:49], s[0:1], 112
s_load_dwordx2 s[44:45], s[0:1], 120
s_getpc_b64 s[98:99]
Lpc0:
s_lshr_b32 s75, s2, 3
v_lshrrev_b32 v26, 3, v0
s_lshl_b32 s73, s75, 12
v_lshlrev_b32 v26, 7, v26
v_add_u32 v26, s73, v26
v_min_u32 v26, Lcode_end-Lpc0, v26
global_load_dword v31, v26, s[98:99]
v_lshrrev_b32 v26, 6, v0
v_and_b32 v0, 63, v0
s_and_b32 s73, s2, 7
v_readfirstlane_b32 s58, v26
s_lshr_b32 s65, s75, 3
s_and_b32 s60, s75, 7
s_lshl_b32 s59, s73, 2
s_add_u32 s59, s59, s65
s_lshl_b32 s61, s65, 1
s_lshl_b32 s63, s58, 13
s_lshl_b32 s64, s58, 12
s_lshl_b32 s67, s60, 18
s_lshl_b32 s76, s58, 16
s_add_u32 s67, s67, s76
s_lshl_b32 s66, s58, 17
s_lshl_b32 s73, s59, 8
s_add_u32 s66, s66, s73
v_lshrrev_b32 v26, 4, v0
v_and_b32 v27, 7, v0
v_xor_b32 v27, v27, v26
v_lshlrev_b32 v27, 4, v27
v_lshrrev_b32 v28, 3, v0
v_lshl_add_u32 v2, v28, 10, v27
v_xor_b32 v3, 64, v2
v_and_b32 v29, 15, v0
v_lshlrev_b32 v30, 1, v26
v_xor_b32 v30, v30, v29
v_lshlrev_b32 v30, 4, v30
v_lshl_add_u32 v6, v26, 13, v30
v_xor_b32 v7, 0x80, v6
s_mov_b32 s10, 0x200000
s_mov_b32 s11, 0x20000
s_mov_b32 s18, 0x400000
s_mov_b32 s19, 0x20000
s_mov_b32 s22, 0x400000
s_mov_b32 s23, 0x20000
s_waitcnt lgkmcnt(0)
s_add_u32 s73, s61, 0
s_and_b32 s73, s73, 7
s_lshl_b32 s69, s73, 7
s_add_u32 s69, s69, s67
s_lshl_b32 s71, s73, 19
s_add_u32 s71, s71, s66
s_add_u32 m0, s63, 65536
s_add_u32 s72, s69, 0
buffer_load_dwordx4 v2, s[8:11], s72 offen lds
s_add_u32 s72, s69, 7168
buffer_load_dwordx4 v3, s[8:11], s72 offen offset:1024 lds
s_add_u32 s72, s69, 14336
buffer_load_dwordx4 v2, s[8:11], s72 offen offset:2048 lds
s_add_u32 s72, s69, 21504
buffer_load_dwordx4 v3, s[8:11], s72 offen offset:3072 lds
s_add_u32 m0, s64, 0
s_add_u32 s72, s71, 0
buffer_load_dwordx4 v6, s[16:19], s72 offen lds
s_add_u32 s72, s71, 31744
buffer_load_dwordx4 v6, s[16:19], s72 offen offset:1024 lds
s_add_u32 s72, s71, 63488
buffer_load_dwordx4 v7, s[16:19], s72 offen offset:2048 lds
s_add_u32 s72, s71, 95232
buffer_load_dwordx4 v7, s[16:19], s72 offen offset:3072 lds
s_add_u32 m0, s63, 69632
s_add_u32 s72, s69, 32768
buffer_load_dwordx4 v2, s[8:11], s72 offen lds
s_add_u32 s72, s69, 39936
buffer_load_dwordx4 v3, s[8:11], s72 offen offset:1024 lds
s_add_u32 s72, s69, 47104
buffer_load_dwordx4 v2, s[8:11], s72 offen offset:2048 lds
s_add_u32 s72, s69, 54272
buffer_load_dwordx4 v3, s[8:11], s72 offen offset:3072 lds
s_add_u32 m0, s64, 16384
s_add_u32 s72, s71, 0
buffer_load_dwordx4 v6, s[20:23], s72 offen lds
s_add_u32 s72, s71, 31744
buffer_load_dwordx4 v6, s[20:23], s72 offen offset:1024 lds
s_add_u32 s72, s71, 63488
buffer_load_dwordx4 v7, s[20:23], s72 offen offset:2048 lds
s_add_u32 s72, s71, 95232
buffer_load_dwordx4 v7, s[20:23], s72 offen offset:3072 lds
s_lshl_b32 s73, s2, 2
s_add_u32 s73, s73, s58
s_lshl_b32 s73, s73, 11
v_lshrrev_b32 v124, 2, v0
v_lshlrev_b32 v124, 7, v124
v_add_u32 v124, s73, v124
s_lshl_b32 s73, s60, 2
s_add_u32 s73, s73, s58
s_lshl_b32 s73, s73, 13
s_lshl_b32 s74, s59, 8
s_add_u32 s73, s73, s74
v_lshrrev_b32 v125, 4, v0
v_lshlrev_b32 v125, 18, v125
v_bfe_u32 v126, v0, 3, 1
v_lshl_add_u32 v125, v126, 7, v125
v_add_u32 v125, s73, v125
s_add_u32 s80, s65, 0
s_and_b32 s80, s80, 3
s_lshl_b32 s80, s80, 20
buffer_load_dword v126, v125, s[16:19], s80 offen
buffer_load_dword v126, v125, s[20:23], s80 offen
buffer_load_dword v126, v124, s[8:11], 0 offen
s_add_u32 s73, s61, 1
s_and_b32 s73, s73, 7
s_lshl_b32 s69, s73, 7
s_add_u32 s69, s69, s67
s_lshl_b32 s71, s73, 19
s_add_u32 s71, s71, s66
s_add_u32 m0, s63, 98304
s_add_u32 s72, s69, 0
buffer_load_dwordx4 v2, s[8:11], s72 offen lds
s_add_u32 s72, s69, 7168
buffer_load_dwordx4 v3, s[8:11], s72 offen offset:1024 lds
s_add_u32 s72, s69, 14336
buffer_load_dwordx4 v2, s[8:11], s72 offen offset:2048 lds
s_add_u32 s72, s69, 21504
buffer_load_dwordx4 v3, s[8:11], s72 offen offset:3072 lds
s_mov_b32 s6, 0x400000
s_mov_b32 s7, 0x20000
s_mov_b32 s14, 0x800000
s_mov_b32 s15, 0x20000
s_mov_b32 s26, 0x800000
s_mov_b32 s27, 0x20000
s_mov_b32 s30, 0x400000
s_mov_b32 s31, 0x20000
s_mov_b32 s34, 0x400000
s_mov_b32 s35, 0x20000
s_mov_b32 s38, 0x400000
s_mov_b32 s39, 0x20000
s_mov_b32 s42, 0x400000
s_mov_b32 s43, 0x20000
s_mov_b32 s46, 0x8000000
s_mov_b32 s47, 0x20000
s_mov_b32 s50, 0x100
s_mov_b32 s51, 0x20000
v_lshl_add_u32 v4, v28, 11, v27
v_xor_b32 v5, 64, v4
v_lshlrev_b32 v1, 4, v0
s_sub_u32 s74, 15, s60
s_lshl_b32 s68, s74, 18
s_add_u32 s68, s68, s76
s_and_b32 s62, s60, 3
s_sub_u32 s62, 16, s62
s_lshl_b32 s91, s59, 3
s_add_u32 s91, s91, s60
s_lshl_b32 s93, s91, 2
s_add_u32 s93, s93, s58
s_lshl_b32 s91, s91, 7
s_add_u32 s91, s91, 0x3810000
s_lshl_b32 s75, s93, 1
s_and_b32 s75, s75, 0xffc
s_lshl_b32 s93, s93, 12
s_mul_i32 s92, s58, 12480
s_load_dwordx2 s[88:89], s[36:37], s93
s_load_dword s90, s[54:55], s75
v_or_b32 v29, s58, v0
v_mov_b32 v30, 0
v_min_u32 v29, 1, v29
v_lshlrev_b32 v29, 30, v29
buffer_store_dword v30, v29, s[44:47], s91 offen sc1
s_and_b32 s73, s2, 15
s_lshr_b32 s74, s2, 4
s_lshl_b32 s74, s74, 7
s_lshl_b32 s75, s58, 5
s_add_u32 s74, s74, s75
s_mov_b32 s75, 131072
v_lshrrev_b32 v29, 5, v0
v_lshlrev_b32 v29, 4, v29
v_add_u32 v29, s74, v29
v_and_b32 v30, 31, v0
s_lshl_b32 s73, s73, 5
v_add_u32 v30, s73, v30
v_lshlrev_b32 v26, 11, v29
v_lshl_add_u32 v26, v30, 2, v26
v_subrev_u32 v27, 0x1800, v26
v_and_b32 v29, 0x7f, v29
v_sub_u32 v29, 0x70, v29
v_lshlrev_b32 v29, 1, v29
v_and_b32 v32, 31, v0
v_mul_u32_u24 v32, 544, v32
v_add3_u32 v28, v32, v29, s75
v_lshlrev_b32 v30, 4, v30
s_lshl_b32 s73, s2, 14
s_lshl_b32 s74, s58, 12
s_add_u32 s76, s73, s74
v_and_b32 v29, 15, v0
v_lshrrev_b32 v32, 4, v0
v_lshrrev_b32 v24, 1, v29
v_xor_b32 v24, v24, v32
v_lshlrev_b32 v24, 4, v24
v_lshl_add_u32 v24, v29, 7, v24
s_add_u32 s73, s63, 131072
v_add_u32 v16, s73, v24
v_xor_b32 v17, 64, v16
v_subrev_u32 v18, 0x10000, v16
v_subrev_u32 v19, 0x10000, v17
s_lshr_b32 s73, s58, 1
s_lshl_b32 s74, s73, 14
s_add_u32 s74, s74, 0x10000
v_add_u32 v24, s74, v24
v_xor_b32 v25, 64, v24
v_lshrrev_b32 v8, 2, v29
v_and_b32 v9, 1, v32
v_lshl_add_u32 v9, v9, 2, v8
v_lshl_add_u32 v8, v32, 3, v8
v_lshlrev_b32 v8, 8, v8
v_lshl_add_u32 v8, v9, 5, v8
v_and_b32 v29, 3, v0
v_lshl_add_u32 v8, v29, 3, v8
s_and_b32 s74, s58, 1
s_lshl_b32 s75, s74, 7
v_xor_b32 v20, s75, v8
v_xor_b32 v9, 32, v8
v_xor_b32 v10, 64, v8
v_xor_b32 v11, 96, v8
v_xor_b32 v12, 128, v8
v_xor_b32 v13, 160, v8
v_xor_b32 v14, 192, v8
v_xor_b32 v15, 224, v8
v_xor_b32 v21, 32, v20
v_xor_b32 v22, 64, v20
v_xor_b32 v23, 96, v20
s_lshl_b32 s77, s59, 20
s_add_u32 s81, s77, s64
s_sub_u32 s81, s81, 0x4000
s_lshl_b32 s75, s60, 17
s_add_u32 s77, s77, s75
s_lshl_b32 s73, s73, 16
s_add_u32 s77, s77, s73
s_lshl_b32 s75, s74, 12
s_add_u32 s78, s77, s75
s_add_u32 s78, s78, 0x4000
s_lshl_b32 s75, s74, 11
s_add_u32 s77, s77, s75
s_mov_b32 s79, 0x3e0293ee
s_waitcnt vmcnt(8)
s_barrier
ds_read_b64_tr_b16 v[160:161], v20 offset:0
ds_read_b64_tr_b16 v[162:163], v20 offset:1024
ds_read_b128 v[128:131], v24 offset:0
ds_read_b128 v[132:135], v24 offset:2048
ds_read_b128 v[136:139], v24 offset:4096
ds_read_b128 v[140:143], v24 offset:6144
ds_read_b128 v[144:147], v24 offset:8192
ds_read_b128 v[148:151], v24 offset:10240
ds_read_b128 v[152:155], v24 offset:12288
ds_read_b128 v[156:159], v24 offset:14336
ds_read_b64_tr_b16 v[164:165], v21 offset:0
ds_read_b64_tr_b16 v[166:167], v21 offset:1024
ds_read_b64_tr_b16 v[168:169], v22 offset:0
ds_read_b64_tr_b16 v[170:171], v22 offset:1024
ds_read_b64_tr_b16 v[172:173], v23 offset:0
ds_read_b64_tr_b16 v[174:175], v23 offset:1024
ds_read_b64_tr_b16 v[176:177], v20 offset:16384
ds_read_b64_tr_b16 v[178:179], v20 offset:17408
ds_read_b64_tr_b16 v[180:181], v21 offset:16384
ds_read_b64_tr_b16 v[182:183], v21 offset:17408
ds_read_b64_tr_b16 v[184:185], v22 offset:16384
ds_read_b64_tr_b16 v[186:187], v22 offset:17408
ds_read_b64_tr_b16 v[188:189], v23 offset:16384
ds_read_b64_tr_b16 v[190:191], v23 offset:17408
s_waitcnt lgkmcnt(0)
v_mfma_f32_16x16x32_bf16 a[0:3], v[160:163], v[128:131], 0
s_add_u32 m0, s64, 32768
ds_read_b64_tr_b16 v[224:225], v20 offset:8192
v_mfma_f32_16x16x32_bf16 a[4:7], v[160:163], v[132:135], 0
s_add_u32 s72, s71, 0
buffer_load_dwordx4 v6, s[16:19], s72 offen lds
v_mfma_f32_16x16x32_bf16 a[8:11], v[160:163], v[136:139], 0
s_add_u32 s72, s71, 31744
buffer_load_dwordx4 v6, s[16:19], s72 offen offset:1024 lds
v_mfma_f32_16x16x32_bf16 a[12:15], v[160:163], v[140:143], 0
ds_read_b64_tr_b16 v[226:227], v20 offset:9216
v_mfma_f32_16x16x32_bf16 a[16:19], v[160:163], v[144:147], 0
s_add_u32 s72, s71, 63488
buffer_load_dwordx4 v7, s[16:19], s72 offen offset:2048 lds
v_mfma_f32_16x16x32_bf16 a[20:23], v[160:163], v[148:151], 0
ds_read_b128 v[192:195], v25 offset:0
v_mfma_f32_16x16x32_bf16 a[24:27], v[160:163], v[152:155], 0
s_add_u32 s72, s71, 95232
buffer_load_dwordx4 v7, s[16:19], s72 offen offset:3072 lds
v_mfma_f32_16x16x32_bf16 a[28:31], v[160:163], v[156:159], 0
ds_read_b128 v[196:199], v25 offset:2048
v_mfma_f32_16x16x32_bf16 a[60:63], v[164:167], v[156:159], 0
s_add_u32 m0, s63, 102400
ds_read_b128 v[200:203], v25 offset:4096
v_mfma_f32_16x16x32_bf16 a[56:59], v[164:167], v[152:155], 0
s_add_u32 s72, s69, 32768
buffer_load_dwordx4 v2, s[8:11], s72 offen lds
v_mfma_f32_16x16x32_bf16 a[52:55], v[164:167], v[148:151], 0
s_add_u32 s72, s69, 39936
buffer_load_dwordx4 v3, s[8:11], s72 offen offset:1024 lds
v_mfma_f32_16x16x32_bf16 a[48:51], v[164:167], v[144:147], 0
ds_read_b128 v[204:207], v25 offset:6144
v_mfma_f32_16x16x32_bf16 a[44:47], v[164:167], v[140:143], 0
s_add_u32 s72, s69, 47104
buffer_load_dwordx4 v2, s[8:11], s72 offen offset:2048 lds
v_mfma_f32_16x16x32_bf16 a[40:43], v[164:167], v[136:139], 0
ds_read_b128 v[208:211], v25 offset:8192
v_mfma_f32_16x16x32_bf16 a[36:39], v[164:167], v[132:135], 0
s_add_u32 s72, s69, 54272
buffer_load_dwordx4 v3, s[8:11], s72 offen offset:3072 lds
v_mfma_f32_16x16x32_bf16 a[32:35], v[164:167], v[128:131], 0
ds_read_b128 v[212:215], v25 offset:10240
v_mfma_f32_16x16x32_bf16 a[64:67], v[168:171], v[128:131], 0
s_add_u32 m0, s64, 49152
ds_read_b128 v[216:219], v25 offset:12288
v_mfma_f32_16x16x32_bf16 a[68:71], v[168:171], v[132:135], 0
s_add_u32 s72, s71, 0
buffer_load_dwordx4 v6, s[20:23], s72 offen lds
v_mfma_f32_16x16x32_bf16 a[72:75], v[168:171], v[136:139], 0
s_add_u32 s72, s71, 31744
buffer_load_dwordx4 v6, s[20:23], s72 offen offset:1024 lds
v_mfma_f32_16x16x32_bf16 a[76:79], v[168:171], v[140:143], 0
ds_read_b128 v[220:223], v25 offset:14336
v_mfma_f32_16x16x32_bf16 a[80:83], v[168:171], v[144:147], 0
s_add_u32 s72, s71, 63488
buffer_load_dwordx4 v7, s[20:23], s72 offen offset:2048 lds
v_mfma_f32_16x16x32_bf16 a[84:87], v[168:171], v[148:151], 0
ds_read_b64_tr_b16 v[228:229], v21 offset:8192
v_mfma_f32_16x16x32_bf16 a[88:91], v[168:171], v[152:155], 0
s_add_u32 s72, s71, 95232
buffer_load_dwordx4 v7, s[20:23], s72 offen offset:3072 lds
v_mfma_f32_16x16x32_bf16 a[92:95], v[168:171], v[156:159], 0
s_add_u32 s80, s65, 1
ds_read_b64_tr_b16 v[230:231], v21 offset:9216
v_mfma_f32_16x16x32_bf16 a[124:127], v[172:175], v[156:159], 0
s_and_b32 s80, s80, 3
ds_read_b64_tr_b16 v[232:233], v22 offset:8192
v_mfma_f32_16x16x32_bf16 a[120:123], v[172:175], v[152:155], 0
s_lshl_b32 s80, s80, 20
buffer_load_dword v126, v125, s[16:19], s80 offen
v_mfma_f32_16x16x32_bf16 a[116:119], v[172:175], v[148:151], 0
buffer_load_dword v126, v125, s[20:23], s80 offen
v_mfma_f32_16x16x32_bf16 a[112:115], v[172:175], v[144:147], 0
ds_read_b64_tr_b16 v[234:235], v22 offset:9216
v_mfma_f32_16x16x32_bf16 a[108:111], v[172:175], v[140:143], 0
ds_read_b64_tr_b16 v[236:237], v23 offset:8192
v_mfma_f32_16x16x32_bf16 a[104:107], v[172:175], v[136:139], 0
ds_read_b64_tr_b16 v[238:239], v23 offset:9216
v_mfma_f32_16x16x32_bf16 a[100:103], v[172:175], v[132:135], 0
ds_read_b64_tr_b16 v[240:241], v20 offset:24576
v_mfma_f32_16x16x32_bf16 a[96:99], v[172:175], v[128:131], 0
ds_read_b64_tr_b16 v[242:243], v20 offset:25600
v_mfma_f32_16x16x32_bf16 a[128:131], v[128:131], v[176:179], 0
ds_read_b64_tr_b16 v[244:245], v21 offset:24576
v_mfma_f32_16x16x32_bf16 a[132:135], v[132:135], v[176:179], 0
ds_read_b64_tr_b16 v[246:247], v21 offset:25600
v_mfma_f32_16x16x32_bf16 a[136:139], v[136:139], v[176:179], 0
ds_read_b64_tr_b16 v[248:249], v22 offset:24576
v_mfma_f32_16x16x32_bf16 a[140:143], v[140:143], v[176:179], 0
ds_read_b64_tr_b16 v[250:251], v22 offset:25600
v_mfma_f32_16x16x32_bf16 a[144:147], v[144:147], v[176:179], 0
ds_read_b64_tr_b16 v[252:253], v23 offset:24576
v_mfma_f32_16x16x32_bf16 a[148:151], v[148:151], v[176:179], 0
ds_read_b64_tr_b16 v[254:255], v23 offset:25600
v_mfma_f32_16x16x32_bf16 a[152:155], v[152:155], v[176:179], 0
v_mfma_f32_16x16x32_bf16 a[156:159], v[156:159], v[176:179], 0
v_mfma_f32_16x16x32_bf16 a[188:191], v[156:159], v[180:183], 0
v_mfma_f32_16x16x32_bf16 a[184:187], v[152:155], v[180:183], 0
v_mfma_f32_16x16x32_bf16 a[180:183], v[148:151], v[180:183], 0
v_mfma_f32_16x16x32_bf16 a[176:179], v[144:147], v[180:183], 0
v_mfma_f32_16x16x32_bf16 a[172:175], v[140:143], v[180:183], 0
v_mfma_f32_16x16x32_bf16 a[168:171], v[136:139], v[180:183], 0
v_mfma_f32_16x16x32_bf16 a[164:167], v[132:135], v[180:183], 0
v_mfma_f32_16x16x32_bf16 a[160:163], v[128:131], v[180:183], 0
v_mfma_f32_16x16x32_bf16 a[192:195], v[128:131], v[184:187], 0
v_mfma_f32_16x16x32_bf16 a[196:199], v[132:135], v[184:187], 0
v_mfma_f32_16x16x32_bf16 a[200:203], v[136:139], v[184:187], 0
v_mfma_f32_16x16x32_bf16 a[204:207], v[140:143], v[184:187], 0
v_mfma_f32_16x16x32_bf16 a[208:211], v[144:147], v[184:187], 0
v_mfma_f32_16x16x32_bf16 a[212:215], v[148:151], v[184:187], 0
v_mfma_f32_16x16x32_bf16 a[216:219], v[152:155], v[184:187], 0
v_mfma_f32_16x16x32_bf16 a[220:223], v[156:159], v[184:187], 0
v_mfma_f32_16x16x32_bf16 a[252:255], v[156:159], v[188:191], 0
v_mfma_f32_16x16x32_bf16 a[248:251], v[152:155], v[188:191], 0
v_mfma_f32_16x16x32_bf16 a[244:247], v[148:151], v[188:191], 0
v_mfma_f32_16x16x32_bf16 a[240:243], v[144:147], v[188:191], 0
v_mfma_f32_16x16x32_bf16 a[236:239], v[140:143], v[188:191], 0
v_mfma_f32_16x16x32_bf16 a[232:235], v[136:139], v[188:191], 0
v_mfma_f32_16x16x32_bf16 a[228:231], v[132:135], v[188:191], 0
s_waitcnt vmcnt(2) lgkmcnt(0)
v_mfma_f32_16x16x32_bf16 a[224:227], v[128:131], v[188:191], 0
s_barrier
v_mfma_f32_16x16x32_bf16 a[0:3], v[224:227], v[192:195], a[0:3]
s_add_u32 s73, s61, 2
ds_read_b64_tr_b16 v[160:161], v20 offset:32768
v_mfma_f32_16x16x32_bf16 a[4:7], v[224:227], v[196:199], a[4:7]
s_and_b32 s73, s73, 7
ds_read_b64_tr_b16 v[162:163], v20 offset:33792
v_mfma_f32_16x16x32_bf16 a[8:11], v[224:227], v[200:203], a[8:11]
s_lshl_b32 s69, s73, 7
ds_read_b128 v[128:131], v24 offset:32768
v_mfma_f32_16x16x32_bf16 a[12:15], v[224:227], v[204:207], a[12:15]
s_add_u32 s69, s69, s67
ds_read_b128 v[132:135], v24 offset:34816
v_mfma_f32_16x16x32_bf16 a[16:19], v[224:227], v[208:211], a[16:19]
s_lshl_b32 s71, s73, 19
ds_read_b128 v[136:139], v24 offset:36864
v_mfma_f32_16x16x32_bf16 a[20:23], v[224:227], v[212:215], a[20:23]
s_add_u32 s71, s71, s66
ds_read_b128 v[140:143], v24 offset:38912
v_mfma_f32_16x16x32_bf16 a[24:27], v[224:227], v[216:219], a[24:27]
s_add_u32 m0, s63, 65536
ds_read_b128 v[144:147], v24 offset:40960
v_mfma_f32_16x16x32_bf16 a[28:31], v[224:227], v[220:223], a[28:31]
s_add_u32 s72, s69, 0
buffer_load_dwordx4 v2, s[8:11], s72 offen lds
v_mfma_f32_16x16x32_bf16 a[60:63], v[228:231], v[220:223], a[60:63]
s_add_u32 s72, s69, 7168
buffer_load_dwordx4 v3, s[8:11], s72 offen offset:1024 lds
v_mfma_f32_16x16x32_bf16 a[56:59], v[228:231], v[216:219], a[56:59]
s_add_u32 s72, s69, 14336
buffer_load_dwordx4 v2, s[8:11], s72 offen offset:2048 lds
v_mfma_f32_16x16x32_bf16 a[52:55], v[228:231], v[212:215], a[52:55]
ds_read_b128 v[148:151], v24 offset:43008
v_mfma_f32_16x16x32_bf16 a[48:51], v[228:231], v[208:211], a[48:51]
ds_read_b128 v[152:155], v24 offset:45056
v_mfma_f32_16x16x32_bf16 a[44:47], v[228:231], v[204:207], a[44:47]
s_add_u32 s72, s69, 21504
buffer_load_dwordx4 v3, s[8:11], s72 offen offset:3072 lds
v_mfma_f32_16x16x32_bf16 a[40:43], v[228:231], v[200:203], a[40:43]
ds_read_b128 v[156:159], v24 offset:47104
v_mfma_f32_16x16x32_bf16 a[36:39], v[228:231], v[196:199], a[36:39]
ds_read_b64_tr_b16 v[164:165], v21 offset:32768
v_mfma_f32_16x16x32_bf16 a[32:35], v[228:231], v[192:195], a[32:35]
ds_read_b64_tr_b16 v[166:167], v21 offset:33792
v_mfma_f32_16x16x32_bf16 a[64:67], v[232:235], v[192:195], a[64:67]
ds_read_b64_tr_b16 v[168:169], v22 offset:32768
v_mfma_f32_16x16x32_bf16 a[68:71], v[232:235], v[196:199], a[68:71]
s_add_u32 m0, s64, 0
ds_read_b64_tr_b16 v[170:171], v22 offset:33792
v_mfma_f32_16x16x32_bf16 a[72:75], v[232:235], v[200:203], a[72:75]
s_add_u32 s72, s71, 0
buffer_load_dwordx4 v6, s[16:19], s72 offen lds
v_mfma_f32_16x16x32_bf16 a[76:79], v[232:235], v[204:207], a[76:79]
ds_read_b64_tr_b16 v[172:173], v23 offset:32768
v_mfma_f32_16x16x32_bf16 a[80:83], v[232:235], v[208:211], a[80:83]
ds_read_b64_tr_b16 v[174:175], v23 offset:33792
v_mfma_f32_16x16x32_bf16 a[84:87], v[232:235], v[212:215], a[84:87]
s_add_u32 s72, s71, 31744
buffer_load_dwordx4 v6, s[16:19], s72 offen offset:1024 lds
v_mfma_f32_16x16x32_bf16 a[88:91], v[232:235], v[216:219], a[88:91]
ds_read_b64_tr_b16 v[176:177], v20 offset:49152
v_mfma_f32_16x16x32_bf16 a[92:95], v[232:235], v[220:223], a[92:95]
ds_read_b64_tr_b16 v[178:179], v20 offset:50176
v_mfma_f32_16x16x32_bf16 a[124:127], v[236:239], v[220:223], a[124:127]
ds_read_b64_tr_b16 v[180:181], v21 offset:49152
v_mfma_f32_16x16x32_bf16 a[120:123], v[236:239], v[216:219], a[120:123]
s_add_u32 s72, s71, 63488
buffer_load_dwordx4 v7, s[16:19], s72 offen offset:2048 lds
v_mfma_f32_16x16x32_bf16 a[116:119], v[236:239], v[212:215], a[116:119]
ds_read_b64_tr_b16 v[182:183], v21 offset:50176
v_mfma_f32_16x16x32_bf16 a[112:115], v[236:239], v[208:211], a[112:115]
ds_read_b64_tr_b16 v[184:185], v22 offset:49152
v_mfma_f32_16x16x32_bf16 a[108:111], v[236:239], v[204:207], a[108:111]
ds_read_b64_tr_b16 v[186:187], v22 offset:50176
v_mfma_f32_16x16x32_bf16 a[104:107], v[236:239], v[200:203], a[104:107]
ds_read_b64_tr_b16 v[188:189], v23 offset:49152
v_mfma_f32_16x16x32_bf16 a[100:103], v[236:239], v[196:199], a[100:103]
s_add_u32 s72, s71, 95232
buffer_load_dwordx4 v7, s[16:19], s72 offen offset:3072 lds
v_mfma_f32_16x16x32_bf16 a[96:99], v[236:239], v[192:195], a[96:99]
ds_read_b64_tr_b16 v[190:191], v23 offset:50176
v_mfma_f32_16x16x32_bf16 a[128:131], v[192:195], v[240:243], a[128:131]
v_mfma_f32_16x16x32_bf16 a[132:135], v[196:199], v[240:243], a[132:135]
v_mfma_f32_16x16x32_bf16 a[136:139], v[200:203], v[240:243], a[136:139]
s_add_u32 m0, s63, 69632
v_mfma_f32_16x16x32_bf16 a[140:143], v[204:207], v[240:243], a[140:143]
s_add_u32 s72, s69, 32768
buffer_load_dwordx4 v2, s[8:11], s72 offen lds
v_mfma_f32_16x16x32_bf16 a[144:147], v[208:211], v[240:243], a[144:147]
v_mfma_f32_16x16x32_bf16 a[148:151], v[212:215], v[240:243], a[148:151]
v_mfma_f32_16x16x32_bf16 a[152:155], v[216:219], v[240:243], a[152:155]
s_add_u32 s72, s69, 39936
buffer_load_dwordx4 v3, s[8:11], s72 offen offset:1024 lds
v_mfma_f32_16x16x32_bf16 a[156:159], v[220:223], v[240:243], a[156:159]
v_mfma_f32_16x16x32_bf16 a[188:191], v[220:223], v[244:247], a[188:191]
v_mfma_f32_16x16x32_bf16 a[184:187], v[216:219], v[244:247], a[184:187]
v_mfma_f32_16x16x32_bf16 a[180:183], v[212:215], v[244:247], a[180:183]
v_mfma_f32_16x16x32_bf16 a[176:179], v[208:211], v[244:247], a[176:179]
s_add_u32 s72, s69, 47104
buffer_load_dwordx4 v2, s[8:11], s72 offen offset:2048 lds
v_mfma_f32_16x16x32_bf16 a[172:175], v[204:207], v[244:247], a[172:175]
v_mfma_f32_16x16x32_bf16 a[168:171], v[200:203], v[244:247], a[168:171]
v_mfma_f32_16x16x32_bf16 a[164:167], v[196:199], v[244:247], a[164:167]
v_mfma_f32_16x16x32_bf16 a[160:163], v[192:195], v[244:247], a[160:163]
s_add_u32 s72, s69, 54272
buffer_load_dwordx4 v3, s[8:11], s72 offen offset:3072 lds
v_mfma_f32_16x16x32_bf16 a[192:195], v[192:195], v[248:251], a[192:195]
v_mfma_f32_16x16x32_bf16 a[196:199], v[196:199], v[248:251], a[196:199]
v_mfma_f32_16x16x32_bf16 a[200:203], v[200:203], v[248:251], a[200:203]
v_mfma_f32_16x16x32_bf16 a[204:207], v[204:207], v[248:251], a[204:207]
s_add_u32 m0, s64, 16384
v_mfma_f32_16x16x32_bf16 a[208:211], v[208:211], v[248:251], a[208:211]
s_add_u32 s72, s71, 0
buffer_load_dwordx4 v6, s[20:23], s72 offen lds
v_mfma_f32_16x16x32_bf16 a[212:215], v[212:215], v[248:251], a[212:215]
v_mfma_f32_16x16x32_bf16 a[216:219], v[216:219], v[248:251], a[216:219]
v_mfma_f32_16x16x32_bf16 a[220:223], v[220:223], v[248:251], a[220:223]
v_mfma_f32_16x16x32_bf16 a[252:255], v[220:223], v[252:255], a[252:255]
s_add_u32 s72, s71, 31744
buffer_load_dwordx4 v6, s[20:23], s72 offen offset:1024 lds
v_mfma_f32_16x16x32_bf16 a[248:251], v[216:219], v[252:255], a[248:251]
v_mfma_f32_16x16x32_bf16 a[244:247], v[212:215], v[252:255], a[244:247]
v_mfma_f32_16x16x32_bf16 a[240:243], v[208:211], v[252:255], a[240:243]
v_mfma_f32_16x16x32_bf16 a[236:239], v[204:207], v[252:255], a[236:239]
s_add_u32 s72, s71, 63488
buffer_load_dwordx4 v7, s[20:23], s72 offen offset:2048 lds
v_mfma_f32_16x16x32_bf16 a[232:235], v[200:203], v[252:255], a[232:235]
v_mfma_f32_16x16x32_bf16 a[228:231], v[196:199], v[252:255], a[228:231]
v_mfma_f32_16x16x32_bf16 a[224:227], v[192:195], v[252:255], a[224:227]
s_waitcnt lgkmcnt(0)
v_mfma_f32_16x16x32_bf16 a[0:3], v[160:163], v[128:131], a[0:3]
s_add_u32 s72, s71, 95232
buffer_load_dwordx4 v7, s[20:23], s72 offen offset:3072 lds
v_mfma_f32_16x16x32_bf16 a[4:7], v[160:163], v[132:135], a[4:7]
s_add_u32 s80, s65, 2
ds_read_b64_tr_b16 v[224:225], v20 offset:40960
v_mfma_f32_16x16x32_bf16 a[8:11], v[160:163], v[136:139], a[8:11]
s_and_b32 s80, s80, 3
ds_read_b64_tr_b16 v[226:227], v20 offset:41984
v_mfma_f32_16x16x32_bf16 a[12:15], v[160:163], v[140:143], a[12:15]
s_lshl_b32 s80, s80, 20
buffer_load_dword v126, v125, s[16:19], s80 offen
v_mfma_f32_16x16x32_bf16 a[16:19], v[160:163], v[144:147], a[16:19]
buffer_load_dword v126, v125, s[20:23], s80 offen
v_mfma_f32_16x16x32_bf16 a[20:23], v[160:163], v[148:151], a[20:23]
global_load_dwordx4 v[68:71], v30, s[52:53]
v_mfma_f32_16x16x32_bf16 a[24:27], v[160:163], v[152:155], a[24:27]
buffer_load_dword v32, v27, s[28:31], 0 offen nt
v_mfma_f32_16x16x32_bf16 a[28:31], v[160:163], v[156:159], a[28:31]
buffer_load_dword v33, v27, s[28:31], 0 offen offset:2048 nt
v_mfma_f32_16x16x32_bf16 a[60:63], v[164:167], v[156:159], a[60:63]
ds_read_b128 v[192:195], v25 offset:32768
v_add_u32 v27, 0x1000, v27
v_mfma_f32_16x16x32_bf16 a[56:59], v[164:167], v[152:155], a[56:59]
buffer_load_dword v34, v27, s[28:31], 0 offen nt
v_mfma_f32_16x16x32_bf16 a[52:55], v[164:167], v[148:151], a[52:55]
s_mov_b32 s80, 0
buffer_load_dword v35, v26, s[28:31], s80 offen nt
v_mfma_f32_16x16x32_bf16 a[48:51], v[164:167], v[144:147], a[48:51]
buffer_load_dword v36, v26, s[28:31], s80 offen offset:2048 nt
v_mfma_f32_16x16x32_bf16 a[44:47], v[164:167], v[140:143], a[44:47]
s_mov_b32 s80, 4096
buffer_load_dword v37, v26, s[28:31], s80 offen nt
v_mfma_f32_16x16x32_bf16 a[40:43], v[164:167], v[136:139], a[40:43]
buffer_load_dword v38, v26, s[28:31], s80 offen offset:2048 nt
v_mfma_f32_16x16x32_bf16 a[36:39], v[164:167], v[132:135], a[36:39]
s_mov_b32 s80, 8192
buffer_load_dword v39, v26, s[28:31], s80 offen nt
v_mfma_f32_16x16x32_bf16 a[32:35], v[164:167], v[128:131], a[32:35]
buffer_load_dword v40, v26, s[28:31], s80 offen offset:2048 nt
v_mfma_f32_16x16x32_bf16 a[64:67], v[168:171], v[128:131], a[64:67]
s_mov_b32 s80, 12288
buffer_load_dword v41, v26, s[28:31], s80 offen nt
v_mfma_f32_16x16x32_bf16 a[68:71], v[168:171], v[132:135], a[68:71]
buffer_load_dword v42, v26, s[28:31], s80 offen offset:2048 nt
v_mfma_f32_16x16x32_bf16 a[72:75], v[168:171], v[136:139], a[72:75]
s_mov_b32 s80, 16384
buffer_load_dword v43, v26, s[28:31], s80 offen nt
v_mfma_f32_16x16x32_bf16 a[76:79], v[168:171], v[140:143], a[76:79]
buffer_load_dword v44, v26, s[28:31], s80 offen offset:2048 nt
v_mfma_f32_16x16x32_bf16 a[80:83], v[168:171], v[144:147], a[80:83]
s_mov_b32 s80, 20480
buffer_load_dword v45, v26, s[28:31], s80 offen nt
v_mfma_f32_16x16x32_bf16 a[84:87], v[168:171], v[148:151], a[84:87]
buffer_load_dword v46, v26, s[28:31], s80 offen offset:2048 nt
v_mfma_f32_16x16x32_bf16 a[88:91], v[168:171], v[152:155], a[88:91]
s_mov_b32 s80, 24576
buffer_load_dword v47, v26, s[28:31], s80 offen nt
v_mfma_f32_16x16x32_bf16 a[92:95], v[168:171], v[156:159], a[92:95]
buffer_load_dword v48, v26, s[28:31], s80 offen offset:2048 nt
v_mfma_f32_16x16x32_bf16 a[124:127], v[172:175], v[156:159], a[124:127]
s_mov_b32 s80, 28672
buffer_load_dword v49, v26, s[28:31], s80 offen nt
v_mfma_f32_16x16x32_bf16 a[120:123], v[172:175], v[152:155], a[120:123]
buffer_load_dword v50, v26, s[28:31], s80 offen offset:2048 nt
v_mfma_f32_16x16x32_bf16 a[116:119], v[172:175], v[148:151], a[116:119]
ds_read_b128 v[196:199], v25 offset:34816
v_mfma_f32_16x16x32_bf16 a[112:115], v[172:175], v[144:147], a[112:115]
ds_read_b128 v[200:203], v25 offset:36864
v_mfma_f32_16x16x32_bf16 a[108:111], v[172:175], v[140:143], a[108:111]
ds_read_b128 v[204:207], v25 offset:38912
v_mfma_f32_16x16x32_bf16 a[104:107], v[172:175], v[136:139], a[104:107]
ds_read_b128 v[208:211], v25 offset:40960
v_mfma_f32_16x16x32_bf16 a[100:103], v[172:175], v[132:135], a[100:103]
ds_read_b128 v[212:215], v25 offset:43008
v_mfma_f32_16x16x32_bf16 a[96:99], v[172:175], v[128:131], a[96:99]
ds_read_b128 v[216:219], v25 offset:45056
v_mfma_f32_16x16x32_bf16 a[128:131], v[128:131], v[176:179], a[128:131]
ds_read_b128 v[220:223], v25 offset:47104
v_mfma_f32_16x16x32_bf16 a[132:135], v[132:135], v[176:179], a[132:135]
ds_read_b64_tr_b16 v[228:229], v21 offset:40960
v_mfma_f32_16x16x32_bf16 a[136:139], v[136:139], v[176:179], a[136:139]
ds_read_b64_tr_b16 v[230:231], v21 offset:41984
v_mfma_f32_16x16x32_bf16 a[140:143], v[140:143], v[176:179], a[140:143]
ds_read_b64_tr_b16 v[232:233], v22 offset:40960
v_mfma_f32_16x16x32_bf16 a[144:147], v[144:147], v[176:179], a[144:147]
ds_read_b64_tr_b16 v[234:235], v22 offset:41984
v_mfma_f32_16x16x32_bf16 a[148:151], v[148:151], v[176:179], a[148:151]
ds_read_b64_tr_b16 v[236:237], v23 offset:40960
v_mfma_f32_16x16x32_bf16 a[152:155], v[152:155], v[176:179], a[152:155]
ds_read_b64_tr_b16 v[238:239], v23 offset:41984
v_mfma_f32_16x16x32_bf16 a[156:159], v[156:159], v[176:179], a[156:159]
ds_read_b64_tr_b16 v[240:241], v20 offset:57344
v_mfma_f32_16x16x32_bf16 a[188:191], v[156:159], v[180:183], a[188:191]
ds_read_b64_tr_b16 v[242:243], v20 offset:58368
v_mfma_f32_16x16x32_bf16 a[184:187], v[152:155], v[180:183], a[184:187]
ds_read_b64_tr_b16 v[244:245], v21 offset:57344
v_mfma_f32_16x16x32_bf16 a[180:183], v[148:151], v[180:183], a[180:183]
ds_read_b64_tr_b16 v[246:247], v21 offset:58368
v_mfma_f32_16x16x32_bf16 a[176:179], v[144:147], v[180:183], a[176:179]
ds_read_b64_tr_b16 v[248:249], v22 offset:57344
v_mfma_f32_16x16x32_bf16 a[172:175], v[140:143], v[180:183], a[172:175]
ds_read_b64_tr_b16 v[250:251], v22 offset:58368
v_mfma_f32_16x16x32_bf16 a[168:171], v[136:139], v[180:183], a[168:171]
ds_read_b64_tr_b16 v[252:253], v23 offset:57344
v_mfma_f32_16x16x32_bf16 a[164:167], v[132:135], v[180:183], a[164:167]
ds_read_b64_tr_b16 v[254:255], v23 offset:58368
v_mfma_f32_16x16x32_bf16 a[160:163], v[128:131], v[180:183], a[160:163]
v_mfma_f32_16x16x32_bf16 a[192:195], v[128:131], v[184:187], a[192:195]
v_mfma_f32_16x16x32_bf16 a[196:199], v[132:135], v[184:187], a[196:199]
v_mfma_f32_16x16x32_bf16 a[200:203], v[136:139], v[184:187], a[200:203]
v_mfma_f32_16x16x32_bf16 a[204:207], v[140:143], v[184:187], a[204:207]
v_mfma_f32_16x16x32_bf16 a[208:211], v[144:147], v[184:187], a[208:211]
v_mfma_f32_16x16x32_bf16 a[212:215], v[148:151], v[184:187], a[212:215]
v_mfma_f32_16x16x32_bf16 a[216:219], v[152:155], v[184:187], a[216:219]
v_mfma_f32_16x16x32_bf16 a[220:223], v[156:159], v[184:187], a[220:223]
v_mfma_f32_16x16x32_bf16 a[252:255], v[156:159], v[188:191], a[252:255]
v_mfma_f32_16x16x32_bf16 a[248:251], v[152:155], v[188:191], a[248:251]
v_mfma_f32_16x16x32_bf16 a[244:247], v[148:151], v[188:191], a[244:247]
v_mfma_f32_16x16x32_bf16 a[240:243], v[144:147], v[188:191], a[240:243]
v_mfma_f32_16x16x32_bf16 a[236:239], v[140:143], v[188:191], a[236:239]
v_mfma_f32_16x16x32_bf16 a[232:235], v[136:139], v[188:191], a[232:235]
v_mfma_f32_16x16x32_bf16 a[228:231], v[132:135], v[188:191], a[228:231]
s_waitcnt vmcnt(22) lgkmcnt(0)
v_mfma_f32_16x16x32_bf16 a[224:227], v[128:131], v[188:191], a[224:227]
s_barrier
v_mfma_f32_16x16x32_bf16 a[0:3], v[224:227], v[192:195], a[0:3]
s_add_u32 s73, s61, 3
ds_read_b64_tr_b16 v[160:161], v20 offset:0
v_mfma_f32_16x16x32_bf16 a[4:7], v[224:227], v[196:199], a[4:7]
s_and_b32 s73, s73, 7
ds_read_b64_tr_b16 v[162:163], v20 offset:1024
v_mfma_f32_16x16x32_bf16 a[8:11], v[224:227], v[200:203], a[8:11]
s_lshl_b32 s69, s73, 7
ds_read_b128 v[128:131], v24 offset:0
v_mfma_f32_16x16x32_bf16 a[12:15], v[224:227], v[204:207], a[12:15]
s_add_u32 s69, s69, s67
ds_read_b128 v[132:135], v24 offset:2048
v_mfma_f32_16x16x32_bf16 a[16:19], v[224:227], v[208:211], a[16:19]
s_lshl_b32 s71, s73, 19
ds_read_b128 v[136:139], v24 offset:4096
v_mfma_f32_16x16x32_bf16 a[20:23], v[224:227], v[212:215], a[20:23]
s_add_u32 s71, s71, s66
ds_read_b128 v[140:143], v24 offset:6144
v_mfma_f32_16x16x32_bf16 a[24:27], v[224:227], v[216:219], a[24:27]
s_add_u32 m0, s63, 98304
ds_read_b128 v[144:147], v24 offset:8192
v_mfma_f32_16x16x32_bf16 a[28:31], v[224:227], v[220:223], a[28:31]
s_add_u32 s72, s69, 0
buffer_load_dwordx4 v2, s[8:11], s72 offen lds
v_mfma_f32_16x16x32_bf16 a[60:63], v[228:231], v[220:223], a[60:63]
s_add_u32 s72, s69, 7168
buffer_load_dwordx4 v3, s[8:11], s72 offen offset:1024 lds
v_mfma_f32_16x16x32_bf16 a[56:59], v[228:231], v[216:219], a[56:59]
s_add_u32 s72, s69, 14336
buffer_load_dwordx4 v2, s[8:11], s72 offen offset:2048 lds
v_mfma_f32_16x16x32_bf16 a[52:55], v[228:231], v[212:215], a[52:55]
ds_read_b128 v[148:151], v24 offset:10240
v_mfma_f32_16x16x32_bf16 a[48:51], v[228:231], v[208:211], a[48:51]
ds_read_b128 v[152:155], v24 offset:12288
v_mfma_f32_16x16x32_bf16 a[44:47], v[228:231], v[204:207], a[44:47]
s_add_u32 s72, s69, 21504
buffer_load_dwordx4 v3, s[8:11], s72 offen offset:3072 lds
v_mfma_f32_16x16x32_bf16 a[40:43], v[228:231], v[200:203], a[40:43]
ds_read_b128 v[156:159], v24 offset:14336
v_mfma_f32_16x16x32_bf16 a[36:39], v[228:231], v[196:199], a[36:39]
ds_read_b64_tr_b16 v[164:165], v21 offset:0
v_mfma_f32_16x16x32_bf16 a[32:35], v[228:231], v[192:195], a[32:35]
ds_read_b64_tr_b16 v[166:167], v21 offset:1024
v_mfma_f32_16x16x32_bf16 a[64:67], v[232:235], v[192:195], a[64:67]
ds_read_b64_tr_b16 v[168:169], v22 offset:0
v_mfma_f32_16x16x32_bf16 a[68:71], v[232:235], v[196:199], a[68:71]
s_add_u32 m0, s64, 32768
ds_read_b64_tr_b16 v[170:171], v22 offset:1024
v_mfma_f32_16x16x32_bf16 a[72:75], v[232:235], v[200:203], a[72:75]
s_add_u32 s72, s71, 0
buffer_load_dwordx4 v6, s[16:19], s72 offen lds
v_mfma_f32_16x16x32_bf16 a[76:79], v[232:235], v[204:207], a[76:79]
ds_read_b64_tr_b16 v[172:173], v23 offset:0
v_mfma_f32_16x16x32_bf16 a[80:83], v[232:235], v[208:211], a[80:83]
ds_read_b64_tr_b16 v[174:175], v23 offset:1024
v_mfma_f32_16x16x32_bf16 a[84:87], v[232:235], v[212:215], a[84:87]
s_add_u32 s72, s71, 31744
buffer_load_dwordx4 v6, s[16:19], s72 offen offset:1024 lds
v_mfma_f32_16x16x32_bf16 a[88:91], v[232:235], v[216:219], a[88:91]
ds_read_b64_tr_b16 v[176:177], v20 offset:16384
v_mfma_f32_16x16x32_bf16 a[92:95], v[232:235], v[220:223], a[92:95]
ds_read_b64_tr_b16 v[178:179], v20 offset:17408
v_mfma_f32_16x16x32_bf16 a[124:127], v[236:239], v[220:223], a[124:127]
ds_read_b64_tr_b16 v[180:181], v21 offset:16384
v_mfma_f32_16x16x32_bf16 a[120:123], v[236:239], v[216:219], a[120:123]
s_add_u32 s72, s71, 63488
buffer_load_dwordx4 v7, s[16:19], s72 offen offset:2048 lds
v_mfma_f32_16x16x32_bf16 a[116:119], v[236:239], v[212:215], a[116:119]
ds_read_b64_tr_b16 v[182:183], v21 offset:17408
v_mfma_f32_16x16x32_bf16 a[112:115], v[236:239], v[208:211], a[112:115]
ds_read_b64_tr_b16 v[184:185], v22 offset:16384
v_mfma_f32_16x16x32_bf16 a[108:111], v[236:239], v[204:207], a[108:111]
ds_read_b64_tr_b16 v[186:187], v22 offset:17408
v_mfma_f32_16x16x32_bf16 a[104:107], v[236:239], v[200:203], a[104:107]
ds_read_b64_tr_b16 v[188:189], v23 offset:16384
v_mfma_f32_16x16x32_bf16 a[100:103], v[236:239], v[196:199], a[100:103]
s_add_u32 s72, s71, 95232
buffer_load_dwordx4 v7, s[16:19], s72 offen offset:3072 lds
v_mfma_f32_16x16x32_bf16 a[96:99], v[236:239], v[192:195], a[96:99]
ds_read_b64_tr_b16 v[190:191], v23 offset:17408
v_mfma_f32_16x16x32_bf16 a[128:131], v[192:195], v[240:243], a[128:131]
v_mfma_f32_16x16x32_bf16 a[132:135], v[196:199], v[240:243], a[132:135]
v_mfma_f32_16x16x32_bf16 a[136:139], v[200:203], v[240:243], a[136:139]
s_add_u32 m0, s63, 102400
v_mfma_f32_16x16x32_bf16 a[140:143], v[204:207], v[240:243], a[140:143]
s_add_u32 s72, s69, 32768
buffer_load_dwordx4 v2, s[8:11], s72 offen lds
v_mfma_f32_16x16x32_bf16 a[144:147], v[208:211], v[240:243], a[144:147]
v_mfma_f32_16x16x32_bf16 a[148:151], v[212:215], v[240:243], a[148:151]
v_mfma_f32_16x16x32_bf16 a[152:155], v[216:219], v[240:243], a[152:155]
s_add_u32 s72, s69, 39936
buffer_load_dwordx4 v3, s[8:11], s72 offen offset:1024 lds
v_mfma_f32_16x16x32_bf16 a[156:159], v[220:223], v[240:243], a[156:159]
v_mfma_f32_16x16x32_bf16 a[188:191], v[220:223], v[244:247], a[188:191]
v_mfma_f32_16x16x32_bf16 a[184:187], v[216:219], v[244:247], a[184:187]
v_mfma_f32_16x16x32_bf16 a[180:183], v[212:215], v[244:247], a[180:183]
v_mfma_f32_16x16x32_bf16 a[176:179], v[208:211], v[244:247], a[176:179]
s_add_u32 s72, s69, 47104
buffer_load_dwordx4 v2, s[8:11], s72 offen offset:2048 lds
v_mfma_f32_16x16x32_bf16 a[172:175], v[204:207], v[244:247], a[172:175]
v_mfma_f32_16x16x32_bf16 a[168:171], v[200:203], v[244:247], a[168:171]
v_mfma_f32_16x16x32_bf16 a[164:167], v[196:199], v[244:247], a[164:167]
v_mfma_f32_16x16x32_bf16 a[160:163], v[192:195], v[244:247], a[160:163]
s_add_u32 s72, s69, 54272
buffer_load_dwordx4 v3, s[8:11], s72 offen offset:3072 lds
v_mfma_f32_16x16x32_bf16 a[192:195], v[192:195], v[248:251], a[192:195]
v_mfma_f32_16x16x32_bf16 a[196:199], v[196:199], v[248:251], a[196:199]
v_mfma_f32_16x16x32_bf16 a[200:203], v[200:203], v[248:251], a[200:203]
v_mfma_f32_16x16x32_bf16 a[204:207], v[204:207], v[248:251], a[204:207]
s_add_u32 m0, s64, 49152
v_mfma_f32_16x16x32_bf16 a[208:211], v[208:211], v[248:251], a[208:211]
s_add_u32 s72, s71, 0
buffer_load_dwordx4 v6, s[20:23], s72 offen lds
v_mfma_f32_16x16x32_bf16 a[212:215], v[212:215], v[248:251], a[212:215]
v_mfma_f32_16x16x32_bf16 a[216:219], v[216:219], v[248:251], a[216:219]
v_mfma_f32_16x16x32_bf16 a[220:223], v[220:223], v[248:251], a[220:223]
v_mfma_f32_16x16x32_bf16 a[252:255], v[220:223], v[252:255], a[252:255]
s_add_u32 s72, s71, 31744
buffer_load_dwordx4 v6, s[20:23], s72 offen offset:1024 lds
v_mfma_f32_16x16x32_bf16 a[248:251], v[216:219], v[252:255], a[248:251]
v_mfma_f32_16x16x32_bf16 a[244:247], v[212:215], v[252:255], a[244:247]
v_mfma_f32_16x16x32_bf16 a[240:243], v[208:211], v[252:255], a[240:243]
v_mfma_f32_16x16x32_bf16 a[236:239], v[204:207], v[252:255], a[236:239]
s_add_u32 s72, s71, 63488
buffer_load_dwordx4 v7, s[20:23], s72 offen offset:2048 lds
v_mfma_f32_16x16x32_bf16 a[232:235], v[200:203], v[252:255], a[232:235]
v_mfma_f32_16x16x32_bf16 a[228:231], v[196:199], v[252:255], a[228:231]
v_mfma_f32_16x16x32_bf16 a[224:227], v[192:195], v[252:255], a[224:227]
s_waitcnt lgkmcnt(0)
v_mfma_f32_16x16x32_bf16 a[0:3], v[160:163], v[128:131], a[0:3]
s_add_u32 s72, s71, 95232
buffer_load_dwordx4 v7, s[20:23], s72 offen offset:3072 lds
v_mfma_f32_16x16x32_bf16 a[4:7], v[160:163], v[132:135], a[4:7]
s_add_u32 s80, s65, 3
ds_read_b64_tr_b16 v[224:225], v20 offset:8192
v_mfma_f32_16x16x32_bf16 a[8:11], v[160:163], v[136:139], a[8:11]
s_and_b32 s80, s80, 3
ds_read_b64_tr_b16 v[226:227], v20 offset:9216
v_mfma_f32_16x16x32_bf16 a[12:15], v[160:163], v[140:143], a[12:15]
s_lshl_b32 s80, s80, 20
buffer_load_dword v126, v125, s[16:19], s80 offen
v_mfma_f32_16x16x32_bf16 a[16:19], v[160:163], v[144:147], a[16:19]
buffer_load_dword v126, v125, s[20:23], s80 offen
v_mfma_f32_16x16x32_bf16 a[20:23], v[160:163], v[148:151], a[20:23]
s_mov_b32 s80, 0
buffer_load_dword v51, v26, s[32:35], s80 offen nt
v_mfma_f32_16x16x32_bf16 a[24:27], v[160:163], v[152:155], a[24:27]
buffer_load_dword v52, v26, s[32:35], s80 offen offset:2048 nt
v_mfma_f32_16x16x32_bf16 a[28:31], v[160:163], v[156:159], a[28:31]
s_mov_b32 s80, 4096
buffer_load_dword v53, v26, s[32:35], s80 offen nt
v_mfma_f32_16x16x32_bf16 a[60:63], v[164:167], v[156:159], a[60:63]
buffer_load_dword v54, v26, s[32:35], s80 offen offset:2048 nt
v_mfma_f32_16x16x32_bf16 a[56:59], v[164:167], v[152:155], a[56:59]
s_mov_b32 s80, 8192
buffer_load_dword v55, v26, s[32:35], s80 offen nt
v_mfma_f32_16x16x32_bf16 a[52:55], v[164:167], v[148:151], a[52:55]
buffer_load_dword v56, v26, s[32:35], s80 offen offset:2048 nt
v_mfma_f32_16x16x32_bf16 a[48:51], v[164:167], v[144:147], a[48:51]
s_mov_b32 s80, 12288
buffer_load_dword v57, v26, s[32:35], s80 offen nt
v_mfma_f32_16x16x32_bf16 a[44:47], v[164:167], v[140:143], a[44:47]
buffer_load_dword v58, v26, s[32:35], s80 offen offset:2048 nt
v_mfma_f32_16x16x32_bf16 a[40:43], v[164:167], v[136:139], a[40:43]
s_mov_b32 s80, 16384
buffer_load_dword v59, v26, s[32:35], s80 offen nt
v_mfma_f32_16x16x32_bf16 a[36:39], v[164:167], v[132:135], a[36:39]
buffer_load_dword v60, v26, s[32:35], s80 offen offset:2048 nt
v_mfma_f32_16x16x32_bf16 a[32:35], v[164:167], v[128:131], a[32:35]
s_mov_b32 s80, 20480
buffer_load_dword v61, v26, s[32:35], s80 offen nt
v_mfma_f32_16x16x32_bf16 a[64:67], v[168:171], v[128:131], a[64:67]
buffer_load_dword v62, v26, s[32:35], s80 offen offset:2048 nt
v_mfma_f32_16x16x32_bf16 a[68:71], v[168:171], v[132:135], a[68:71]
s_mov_b32 s80, 24576
buffer_load_dword v63, v26, s[32:35], s80 offen nt
v_mfma_f32_16x16x32_bf16 a[72:75], v[168:171], v[136:139], a[72:75]
buffer_load_dword v64, v26, s[32:35], s80 offen offset:2048 nt
v_mfma_f32_16x16x32_bf16 a[76:79], v[168:171], v[140:143], a[76:79]
s_mov_b32 s80, 28672
buffer_load_dword v65, v26, s[32:35], s80 offen nt
v_mfma_f32_16x16x32_bf16 a[80:83], v[168:171], v[144:147], a[80:83]
buffer_load_dword v66, v26, s[32:35], s80 offen offset:2048 nt
v_mfma_f32_16x16x32_bf16 a[84:87], v[168:171], v[148:151], a[84:87]
ds_read_b128 v[192:195], v25 offset:0
v_mfma_f32_16x16x32_bf16 a[88:91], v[168:171], v[152:155], a[88:91]
ds_read_b128 v[196:199], v25 offset:2048
v_mfma_f32_16x16x32_bf16 a[92:95], v[168:171], v[156:159], a[92:95]
ds_read_b128 v[200:203], v25 offset:4096
v_mfma_f32_16x16x32_bf16 a[124:127], v[172:175], v[156:159], a[124:127]
ds_read_b128 v[204:207], v25 offset:6144
v_mfma_f32_16x16x32_bf16 a[120:123], v[172:175], v[152:155], a[120:123]
ds_read_b128 v[208:211], v25 offset:8192
v_mfma_f32_16x16x32_bf16 a[116:119], v[172:175], v[148:151], a[116:119]
ds_read_b128 v[212:215], v25 offset:10240
v_mfma_f32_16x16x32_bf16 a[112:115], v[172:175], v[144:147], a[112:115]
ds_read_b128 v[216:219], v25 offset:12288
v_mfma_f32_16x16x32_bf16 a[108:111], v[172:175], v[140:143], a[108:111]
ds_read_b128 v[220:223], v25 offset:14336
v_mfma_f32_16x16x32_bf16 a[104:107], v[172:175], v[136:139], a[104:107]
ds_read_b64_tr_b16 v[228:229], v21 offset:8192
v_mfma_f32_16x16x32_bf16 a[100:103], v[172:175], v[132:135], a[100:103]
ds_read_b64_tr_b16 v[230:231], v21 offset:9216
v_mfma_f32_16x16x32_bf16 a[96:99], v[172:175], v[128:131], a[96:99]
ds_read_b64_tr_b16 v[232:233], v22 offset:8192
v_mfma_f32_16x16x32_bf16 a[128:131], v[128:131], v[176:179], a[128:131]
ds_read_b64_tr_b16 v[234:235], v22 offset:9216
v_mfma_f32_16x16x32_bf16 a[132:135], v[132:135], v[176:179], a[132:135]
ds_read_b64_tr_b16 v[236:237], v23 offset:8192
v_mfma_f32_16x16x32_bf16 a[136:139], v[136:139], v[176:179], a[136:139]
ds_read_b64_tr_b16 v[238:239], v23 offset:9216
v_mfma_f32_16x16x32_bf16 a[140:143], v[140:143], v[176:179], a[140:143]
ds_read_b64_tr_b16 v[240:241], v20 offset:24576
v_mfma_f32_16x16x32_bf16 a[144:147], v[144:147], v[176:179], a[144:147]
ds_read_b64_tr_b16 v[242:243], v20 offset:25600
v_mfma_f32_16x16x32_bf16 a[148:151], v[148:151], v[176:179], a[148:151]
ds_read_b64_tr_b16 v[244:245], v21 offset:24576
v_mfma_f32_16x16x32_bf16 a[152:155], v[152:155], v[176:179], a[152:155]
ds_read_b64_tr_b16 v[246:247], v21 offset:25600
v_mfma_f32_16x16x32_bf16 a[156:159], v[156:159], v[176:179], a[156:159]
ds_read_b64_tr_b16 v[248:249], v22 offset:24576
v_mfma_f32_16x16x32_bf16 a[188:191], v[156:159], v[180:183], a[188:191]
ds_read_b64_tr_b16 v[250:251], v22 offset:25600
v_mfma_f32_16x16x32_bf16 a[184:187], v[152:155], v[180:183], a[184:187]
ds_read_b64_tr_b16 v[252:253], v23 offset:24576
v_mfma_f32_16x16x32_bf16 a[180:183], v[148:151], v[180:183], a[180:183]
ds_read_b64_tr_b16 v[254:255], v23 offset:25600
v_mfma_f32_16x16x32_bf16 a[176:179], v[144:147], v[180:183], a[176:179]
v_mfma_f32_16x16x32_bf16 a[172:175], v[140:143], v[180:183], a[172:175]
v_mfma_f32_16x16x32_bf16 a[168:171], v[136:139], v[180:183], a[168:171]
v_mfma_f32_16x16x32_bf16 a[164:167], v[132:135], v[180:183], a[164:167]
v_mfma_f32_16x16x32_bf16 a[160:163], v[128:131], v[180:183], a[160:163]
v_mfma_f32_16x16x32_bf16 a[192:195], v[128:131], v[184:187], a[192:195]
v_mfma_f32_16x16x32_bf16 a[196:199], v[132:135], v[184:187], a[196:199]
v_mfma_f32_16x16x32_bf16 a[200:203], v[136:139], v[184:187], a[200:203]
v_mfma_f32_16x16x32_bf16 a[204:207], v[140:143], v[184:187], a[204:207]
v_mfma_f32_16x16x32_bf16 a[208:211], v[144:147], v[184:187], a[208:211]
v_mfma_f32_16x16x32_bf16 a[212:215], v[148:151], v[184:187], a[212:215]
v_mfma_f32_16x16x32_bf16 a[216:219], v[152:155], v[184:187], a[216:219]
v_mfma_f32_16x16x32_bf16 a[220:223], v[156:159], v[184:187], a[220:223]
v_mfma_f32_16x16x32_bf16 a[252:255], v[156:159], v[188:191], a[252:255]
v_mfma_f32_16x16x32_bf16 a[248:251], v[152:155], v[188:191], a[248:251]
v_mfma_f32_16x16x32_bf16 a[244:247], v[148:151], v[188:191], a[244:247]
v_mfma_f32_16x16x32_bf16 a[240:243], v[144:147], v[188:191], a[240:243]
v_mfma_f32_16x16x32_bf16 a[236:239], v[140:143], v[188:191], a[236:239]
v_mfma_f32_16x16x32_bf16 a[232:235], v[136:139], v[188:191], a[232:235]
v_mfma_f32_16x16x32_bf16 a[228:231], v[132:135], v[188:191], a[228:231]
s_waitcnt vmcnt(18) lgkmcnt(0)
v_mfma_f32_16x16x32_bf16 a[224:227], v[128:131], v[188:191], a[224:227]
s_barrier
v_mfma_f32_16x16x32_bf16 a[0:3], v[224:227], v[192:195], a[0:3]
s_add_u32 s73, s61, 4
ds_read_b64_tr_b16 v[160:161], v20 offset:32768
v_mfma_f32_16x16x32_bf16 a[4:7], v[224:227], v[196:199], a[4:7]
s_and_b32 s73, s73, 7
ds_read_b64_tr_b16 v[162:163], v20 offset:33792
v_mfma_f32_16x16x32_bf16 a[8:11], v[224:227], v[200:203], a[8:11]
s_lshl_b32 s69, s73, 7
ds_read_b128 v[128:131], v24 offset:32768
v_mfma_f32_16x16x32_bf16 a[12:15], v[224:227], v[204:207], a[12:15]
s_add_u32 s69, s69, s67
ds_read_b128 v[132:135], v24 offset:34816
v_mfma_f32_16x16x32_bf16 a[16:19], v[224:227], v[208:211], a[16:19]
s_lshl_b32 s71, s73, 19
ds_read_b128 v[136:139], v24 offset:36864
v_mfma_f32_16x16x32_bf16 a[20:23], v[224:227], v[212:215], a[20:23]
s_add_u32 s71, s71, s66
ds_read_b128 v[140:143], v24 offset:38912
v_mfma_f32_16x16x32_bf16 a[24:27], v[224:227], v[216:219], a[24:27]
s_add_u32 m0, s63, 65536
ds_read_b128 v[144:147], v24 offset:40960
v_mfma_f32_16x16x32_bf16 a[28:31], v[224:227], v[220:223], a[28:31]
s_add_u32 s72, s69, 0
buffer_load_dwordx4 v2, s[8:11], s72 offen lds
v_mfma_f32_16x16x32_bf16 a[60:63], v[228:231], v[220:223], a[60:63]
s_add_u32 s72, s69, 7168
buffer_load_dwordx4 v3, s[8:11], s72 offen offset:1024 lds
v_mfma_f32_16x16x32_bf16 a[56:59], v[228:231], v[216:219], a[56:59]
s_add_u32 s72, s69, 14336
buffer_load_dwordx4 v2, s[8:11], s72 offen offset:2048 lds
v_mfma_f32_16x16x32_bf16 a[52:55], v[228:231], v[212:215], a[52:55]
ds_read_b128 v[148:151], v24 offset:43008
v_mfma_f32_16x16x32_bf16 a[48:51], v[228:231], v[208:211], a[48:51]
ds_read_b128 v[152:155], v24 offset:45056
v_mfma_f32_16x16x32_bf16 a[44:47], v[228:231], v[204:207], a[44:47]
s_add_u32 s72, s69, 21504
buffer_load_dwordx4 v3, s[8:11], s72 offen offset:3072 lds
v_mfma_f32_16x16x32_bf16 a[40:43], v[228:231], v[200:203], a[40:43]
ds_read_b128 v[156:159], v24 offset:47104
v_mfma_f32_16x16x32_bf16 a[36:39], v[228:231], v[196:199], a[36:39]
ds_read_b64_tr_b16 v[164:165], v21 offset:32768
v_mfma_f32_16x16x32_bf16 a[32:35], v[228:231], v[192:195], a[32:35]
ds_read_b64_tr_b16 v[166:167], v21 offset:33792
v_mfma_f32_16x16x32_bf16 a[64:67], v[232:235], v[192:195], a[64:67]
ds_read_b64_tr_b16 v[168:169], v22 offset:32768
v_mfma_f32_16x16x32_bf16 a[68:71], v[232:235], v[196:199], a[68:71]
s_add_u32 m0, s64, 0
ds_read_b64_tr_b16 v[170:171], v22 offset:33792
v_mfma_f32_16x16x32_bf16 a[72:75], v[232:235], v[200:203], a[72:75]
s_add_u32 s72, s71, 0
buffer_load_dwordx4 v6, s[16:19], s72 offen lds
v_mfma_f32_16x16x32_bf16 a[76:79], v[232:235], v[204:207], a[76:79]
ds_read_b64_tr_b16 v[172:173], v23 offset:32768
v_mfma_f32_16x16x32_bf16 a[80:83], v[232:235], v[208:211], a[80:83]
ds_read_b64_tr_b16 v[174:175], v23 offset:33792
v_mfma_f32_16x16x32_bf16 a[84:87], v[232:235], v[212:215], a[84:87]
s_add_u32 s72, s71, 31744
buffer_load_dwordx4 v6, s[16:19], s72 offen offset:1024 lds
v_mfma_f32_16x16x32_bf16 a[88:91], v[232:235], v[216:219], a[88:91]
ds_read_b64_tr_b16 v[176:177], v20 offset:49152
v_mfma_f32_16x16x32_bf16 a[92:95], v[232:235], v[220:223], a[92:95]
ds_read_b64_tr_b16 v[178:179], v20 offset:50176
v_mfma_f32_16x16x32_bf16 a[124:127], v[236:239], v[220:223], a[124:127]
ds_read_b64_tr_b16 v[180:181], v21 offset:49152
v_mfma_f32_16x16x32_bf16 a[120:123], v[236:239], v[216:219], a[120:123]
s_add_u32 s72, s71, 63488
buffer_load_dwordx4 v7, s[16:19], s72 offen offset:2048 lds
v_mfma_f32_16x16x32_bf16 a[116:119], v[236:239], v[212:215], a[116:119]
ds_read_b64_tr_b16 v[182:183], v21 offset:50176
v_mfma_f32_16x16x32_bf16 a[112:115], v[236:239], v[208:211], a[112:115]
ds_read_b64_tr_b16 v[184:185], v22 offset:49152
v_mfma_f32_16x16x32_bf16 a[108:111], v[236:239], v[204:207], a[108:111]
ds_read_b64_tr_b16 v[186:187], v22 offset:50176
v_mfma_f32_16x16x32_bf16 a[104:107], v[236:239], v[200:203], a[104:107]
ds_read_b64_tr_b16 v[188:189], v23 offset:49152
v_mfma_f32_16x16x32_bf16 a[100:103], v[236:239], v[196:199], a[100:103]
s_add_u32 s72, s71, 95232
buffer_load_dwordx4 v7, s[16:19], s72 offen offset:3072 lds
v_mfma_f32_16x16x32_bf16 a[96:99], v[236:239], v[192:195], a[96:99]
ds_read_b64_tr_b16 v[190:191], v23 offset:50176
v_mfma_f32_16x16x32_bf16 a[128:131], v[192:195], v[240:243], a[128:131]
v_mfma_f32_16x16x32_bf16 a[132:135], v[196:199], v[240:243], a[132:135]
v_mfma_f32_16x16x32_bf16 a[136:139], v[200:203], v[240:243], a[136:139]
s_add_u32 m0, s63, 69632
v_mfma_f32_16x16x32_bf16 a[140:143], v[204:207], v[240:243], a[140:143]
s_add_u32 s72, s69, 32768
buffer_load_dwordx4 v2, s[8:11], s72 offen lds
v_mfma_f32_16x16x32_bf16 a[144:147], v[208:211], v[240:243], a[144:147]
v_mfma_f32_16x16x32_bf16 a[148:151], v[212:215], v[240:243], a[148:151]
v_mfma_f32_16x16x32_bf16 a[152:155], v[216:219], v[240:243], a[152:155]
s_add_u32 s72, s69, 39936
buffer_load_dwordx4 v3, s[8:11], s72 offen offset:1024 lds
v_mfma_f32_16x16x32_bf16 a[156:159], v[220:223], v[240:243], a[156:159]
v_mfma_f32_16x16x32_bf16 a[188:191], v[220:223], v[244:247], a[188:191]
v_mfma_f32_16x16x32_bf16 a[184:187], v[216:219], v[244:247], a[184:187]
v_mfma_f32_16x16x32_bf16 a[180:183], v[212:215], v[244:247], a[180:183]
v_mfma_f32_16x16x32_bf16 a[176:179], v[208:211], v[244:247], a[176:179]
s_add_u32 s72, s69, 47104
buffer_load_dwordx4 v2, s[8:11], s72 offen offset:2048 lds
v_mfma_f32_16x16x32_bf16 a[172:175], v[204:207], v[244:247], a[172:175]
v_mfma_f32_16x16x32_bf16 a[168:171], v[200:203], v[244:247], a[168:171]
v_mfma_f32_16x16x32_bf16 a[164:167], v[196:199], v[244:247], a[164:167]
v_mfma_f32_16x16x32_bf16 a[160:163], v[192:195], v[244:247], a[160:163]
s_add_u32 s72, s69, 54272
buffer_load_dwordx4 v3, s[8:11], s72 offen offset:3072 lds
v_mfma_f32_16x16x32_bf16 a[192:195], v[192:195], v[248:251], a[192:195]
v_mfma_f32_16x16x32_bf16 a[196:199], v[196:199], v[248:251], a[196:199]
v_mfma_f32_16x16x32_bf16 a[200:203], v[200:203], v[248:251], a[200:203]
v_mfma_f32_16x16x32_bf16 a[204:207], v[204:207], v[248:251], a[204:207]
s_add_u32 m0, s64, 16384
v_mfma_f32_16x16x32_bf16 a[208:211], v[208:211], v[248:251], a[208:211]
s_add_u32 s72, s71, 0
buffer_load_dwordx4 v6, s[20:23], s72 offen lds
v_mfma_f32_16x16x32_bf16 a[212:215], v[212:215], v[248:251], a[212:215]
v_mfma_f32_16x16x32_bf16 a[216:219], v[216:219], v[248:251], a[216:219]
v_mfma_f32_16x16x32_bf16 a[220:223], v[220:223], v[248:251], a[220:223]
v_mfma_f32_16x16x32_bf16 a[252:255], v[220:223], v[252:255], a[252:255]
s_add_u32 s72, s71, 31744
buffer_load_dwordx4 v6, s[20:23], s72 offen offset:1024 lds
v_mfma_f32_16x16x32_bf16 a[248:251], v[216:219], v[252:255], a[248:251]
v_mfma_f32_16x16x32_bf16 a[244:247], v[212:215], v[252:255], a[244:247]
v_mfma_f32_16x16x32_bf16 a[240:243], v[208:211], v[252:255], a[240:243]
v_mfma_f32_16x16x32_bf16 a[236:239], v[204:207], v[252:255], a[236:239]
s_add_u32 s72, s71, 63488
buffer_load_dwordx4 v7, s[20:23], s72 offen offset:2048 lds
v_mfma_f32_16x16x32_bf16 a[232:235], v[200:203], v[252:255], a[232:235]
v_mfma_f32_16x16x32_bf16 a[228:231], v[196:199], v[252:255], a[228:231]
v_mfma_f32_16x16x32_bf16 a[224:227], v[192:195], v[252:255], a[224:227]
s_waitcnt lgkmcnt(0)
v_mfma_f32_16x16x32_bf16 a[0:3], v[160:163], v[128:131], a[0:3]
s_add_u32 s72, s71, 95232
buffer_load_dwordx4 v7, s[20:23], s72 offen offset:3072 lds
v_mfma_f32_16x16x32_bf16 a[4:7], v[160:163], v[132:135], a[4:7]
buffer_load_dwordx4 v[108:111], v1, s[4:7], s76 offen
v_mfma_f32_16x16x32_bf16 a[8:11], v[160:163], v[136:139], a[8:11]
buffer_load_dwordx4 v[112:115], v1, s[4:7], s76 offen offset:1024
v_mfma_f32_16x16x32_bf16 a[12:15], v[160:163], v[140:143], a[12:15]
buffer_load_dwordx4 v[116:119], v1, s[4:7], s76 offen offset:2048
v_mfma_f32_16x16x32_bf16 a[16:19], v[160:163], v[144:147], a[16:19]
buffer_load_dwordx4 v[120:123], v1, s[4:7], s76 offen offset:3072
v_mfma_f32_16x16x32_bf16 a[20:23], v[160:163], v[148:151], a[20:23]
ds_read_b64_tr_b16 v[224:225], v20 offset:40960
v_mfma_f32_16x16x32_bf16 a[24:27], v[160:163], v[152:155], a[24:27]
v_mfma_f32_16x16x32_bf16 a[28:31], v[160:163], v[156:159], a[28:31]
ds_read_b64_tr_b16 v[226:227], v20 offset:41984
v_mfma_f32_16x16x32_bf16 a[60:63], v[164:167], v[156:159], a[60:63]
v_mfma_f32_16x16x32_bf16 a[56:59], v[164:167], v[152:155], a[56:59]
ds_read_b128 v[192:195], v25 offset:32768
v_mfma_f32_16x16x32_bf16 a[52:55], v[164:167], v[148:151], a[52:55]
v_mfma_f32_16x16x32_bf16 a[48:51], v[164:167], v[144:147], a[48:51]
ds_read_b128 v[196:199], v25 offset:34816
v_mfma_f32_16x16x32_bf16 a[44:47], v[164:167], v[140:143], a[44:47]
v_mfma_f32_16x16x32_bf16 a[40:43], v[164:167], v[136:139], a[40:43]
ds_read_b128 v[200:203], v25 offset:36864
v_mfma_f32_16x16x32_bf16 a[36:39], v[164:167], v[132:135], a[36:39]
v_mfma_f32_16x16x32_bf16 a[32:35], v[164:167], v[128:131], a[32:35]
ds_read_b128 v[204:207], v25 offset:38912
v_mfma_f32_16x16x32_bf16 a[64:67], v[168:171], v[128:131], a[64:67]
v_mfma_f32_16x16x32_bf16 a[68:71], v[168:171], v[132:135], a[68:71]
ds_read_b128 v[208:211], v25 offset:40960
v_mfma_f32_16x16x32_bf16 a[72:75], v[168:171], v[136:139], a[72:75]
v_mfma_f32_16x16x32_bf16 a[76:79], v[168:171], v[140:143], a[76:79]
ds_read_b128 v[212:215], v25 offset:43008
v_mfma_f32_16x16x32_bf16 a[80:83], v[168:171], v[144:147], a[80:83]
v_mfma_f32_16x16x32_bf16 a[84:87], v[168:171], v[148:151], a[84:87]
ds_read_b128 v[216:219], v25 offset:45056
v_mfma_f32_16x16x32_bf16 a[88:91], v[168:171], v[152:155], a[88:91]
v_mfma_f32_16x16x32_bf16 a[92:95], v[168:171], v[156:159], a[92:95]
ds_read_b128 v[220:223], v25 offset:47104
v_mfma_f32_16x16x32_bf16 a[124:127], v[172:175], v[156:159], a[124:127]
v_mfma_f32_16x16x32_bf16 a[120:123], v[172:175], v[152:155], a[120:123]
ds_read_b64_tr_b16 v[228:229], v21 offset:40960
v_mfma_f32_16x16x32_bf16 a[116:119], v[172:175], v[148:151], a[116:119]
v_mfma_f32_16x16x32_bf16 a[112:115], v[172:175], v[144:147], a[112:115]
ds_read_b64_tr_b16 v[230:231], v21 offset:41984
v_mfma_f32_16x16x32_bf16 a[108:111], v[172:175], v[140:143], a[108:111]
v_mfma_f32_16x16x32_bf16 a[104:107], v[172:175], v[136:139], a[104:107]
ds_read_b64_tr_b16 v[232:233], v22 offset:40960
v_mfma_f32_16x16x32_bf16 a[100:103], v[172:175], v[132:135], a[100:103]
v_mfma_f32_16x16x32_bf16 a[96:99], v[172:175], v[128:131], a[96:99]
ds_read_b64_tr_b16 v[234:235], v22 offset:41984
v_mfma_f32_16x16x32_bf16 a[128:131], v[128:131], v[176:179], a[128:131]
v_mfma_f32_16x16x32_bf16 a[132:135], v[132:135], v[176:179], a[132:135]
ds_read_b64_tr_b16 v[236:237], v23 offset:40960
v_mfma_f32_16x16x32_bf16 a[136:139], v[136:139], v[176:179], a[136:139]
v_mfma_f32_16x16x32_bf16 a[140:143], v[140:143], v[176:179], a[140:143]
ds_read_b64_tr_b16 v[238:239], v23 offset:41984
v_mfma_f32_16x16x32_bf16 a[144:147], v[144:147], v[176:179], a[144:147]
v_mfma_f32_16x16x32_bf16 a[148:151], v[148:151], v[176:179], a[148:151]
ds_read_b64_tr_b16 v[240:241], v20 offset:57344
v_mfma_f32_16x16x32_bf16 a[152:155], v[152:155], v[176:179], a[152:155]
v_mfma_f32_16x16x32_bf16 a[156:159], v[156:159], v[176:179], a[156:159]
ds_read_b64_tr_b16 v[242:243], v20 offset:58368
v_mfma_f32_16x16x32_bf16 a[188:191], v[156:159], v[180:183], a[188:191]
v_mfma_f32_16x16x32_bf16 a[184:187], v[152:155], v[180:183], a[184:187]
ds_read_b64_tr_b16 v[244:245], v21 offset:57344
v_mfma_f32_16x16x32_bf16 a[180:183], v[148:151], v[180:183], a[180:183]
v_mfma_f32_16x16x32_bf16 a[176:179], v[144:147], v[180:183], a[176:179]
ds_read_b64_tr_b16 v[246:247], v21 offset:58368
v_mfma_f32_16x16x32_bf16 a[172:175], v[140:143], v[180:183], a[172:175]
v_mfma_f32_16x16x32_bf16 a[168:171], v[136:139], v[180:183], a[168:171]
ds_read_b64_tr_b16 v[248:249], v22 offset:57344
v_mfma_f32_16x16x32_bf16 a[164:167], v[132:135], v[180:183], a[164:167]
v_mfma_f32_16x16x32_bf16 a[160:163], v[128:131], v[180:183], a[160:163]
ds_read_b64_tr_b16 v[250:251], v22 offset:58368
v_mfma_f32_16x16x32_bf16 a[192:195], v[128:131], v[184:187], a[192:195]
v_mfma_f32_16x16x32_bf16 a[196:199], v[132:135], v[184:187], a[196:199]
ds_read_b64_tr_b16 v[252:253], v23 offset:57344
v_mfma_f32_16x16x32_bf16 a[200:203], v[136:139], v[184:187], a[200:203]
v_mfma_f32_16x16x32_bf16 a[204:207], v[140:143], v[184:187], a[204:207]
ds_read_b64_tr_b16 v[254:255], v23 offset:58368
v_mfma_f32_16x16x32_bf16 a[208:211], v[144:147], v[184:187], a[208:211]
v_mfma_f32_16x16x32_bf16 a[212:215], v[148:151], v[184:187], a[212:215]
v_mfma_f32_16x16x32_bf16 a[216:219], v[152:155], v[184:187], a[216:219]
v_mfma_f32_16x16x32_bf16 a[220:223], v[156:159], v[184:187], a[220:223]
v_mfma_f32_16x16x32_bf16 a[252:255], v[156:159], v[188:191], a[252:255]
v_mfma_f32_16x16x32_bf16 a[248:251], v[152:155], v[188:191], a[248:251]
v_mfma_f32_16x16x32_bf16 a[244:247], v[148:151], v[188:191], a[244:247]
v_mfma_f32_16x16x32_bf16 a[240:243], v[144:147], v[188:191], a[240:243]
v_mfma_f32_16x16x32_bf16 a[236:239], v[140:143], v[188:191], a[236:239]
v_mfma_f32_16x16x32_bf16 a[232:235], v[136:139], v[188:191], a[232:235]
v_mfma_f32_16x16x32_bf16 a[228:231], v[132:135], v[188:191], a[228:231]
s_waitcnt vmcnt(4) lgkmcnt(0)
v_mfma_f32_16x16x32_bf16 a[224:227], v[128:131], v[188:191], a[224:227]
s_barrier
v_mfma_f32_16x16x32_bf16 a[0:3], v[224:227], v[192:195], a[0:3]
s_add_u32 s73, s61, 5
ds_read_b64_tr_b16 v[160:161], v20 offset:0
v_mfma_f32_16x16x32_bf16 a[4:7], v[224:227], v[196:199], a[4:7]
s_and_b32 s73, s73, 7
ds_read_b64_tr_b16 v[162:163], v20 offset:1024
v_mfma_f32_16x16x32_bf16 a[8:11], v[224:227], v[200:203], a[8:11]
s_lshl_b32 s69, s73, 7
ds_read_b128 v[128:131], v24 offset:0
v_mfma_f32_16x16x32_bf16 a[12:15], v[224:227], v[204:207], a[12:15]
s_add_u32 s69, s69, s67
ds_read_b128 v[132:135], v24 offset:2048
v_mfma_f32_16x16x32_bf16 a[16:19], v[224:227], v[208:211], a[16:19]
s_lshl_b32 s71, s73, 19
ds_read_b128 v[136:139], v24 offset:4096
v_mfma_f32_16x16x32_bf16 a[20:23], v[224:227], v[212:215], a[20:23]
s_add_u32 s71, s71, s66
ds_read_b128 v[140:143], v24 offset:6144
v_mfma_f32_16x16x32_bf16 a[24:27], v[224:227], v[216:219], a[24:27]
s_add_u32 m0, s63, 98304
ds_read_b128 v[144:147], v24 offset:8192
v_mfma_f32_16x16x32_bf16 a[28:31], v[224:227], v[220:223], a[28:31]
s_add_u32 s72, s69, 0
buffer_load_dwordx4 v2, s[8:11], s72 offen lds
v_mfma_f32_16x16x32_bf16 a[60:63], v[228:231], v[220:223], a[60:63]
s_add_u32 s72, s69, 7168
buffer_load_dwordx4 v3, s[8:11], s72 offen offset:1024 lds
v_mfma_f32_16x16x32_bf16 a[56:59], v[228:231], v[216:219], a[56:59]
s_add_u32 s72, s69, 14336
buffer_load_dwordx4 v2, s[8:11], s72 offen offset:2048 lds
v_mfma_f32_16x16x32_bf16 a[52:55], v[228:231], v[212:215], a[52:55]
s_waitcnt vmcnt(23)
ds_read_b128 v[148:151], v24 offset:10240
v_lshlrev_b32 v72, 16, v68
v_mfma_f32_16x16x32_bf16 a[48:51], v[228:231], v[208:211], a[48:51]
ds_read_b128 v[152:155], v24 offset:12288
v_and_b32 v73, 0xffff0000, v68
v_mfma_f32_16x16x32_bf16 a[44:47], v[228:231], v[204:207], a[44:47]
s_add_u32 s72, s69, 21504
buffer_load_dwordx4 v3, s[8:11], s72 offen offset:3072 lds
v_mfma_f32_16x16x32_bf16 a[40:43], v[228:231], v[200:203], a[40:43]
ds_read_b128 v[156:159], v24 offset:14336
v_lshlrev_b32 v74, 16, v69
v_mfma_f32_16x16x32_bf16 a[36:39], v[228:231], v[196:199], a[36:39]
ds_read_b64_tr_b16 v[164:165], v21 offset:0
v_and_b32 v75, 0xffff0000, v69
v_mfma_f32_16x16x32_bf16 a[32:35], v[228:231], v[192:195], a[32:35]
ds_read_b64_tr_b16 v[166:167], v21 offset:1024
v_lshlrev_b32 v76, 16, v32
v_mfma_f32_16x16x32_bf16 a[64:67], v[232:235], v[192:195], a[64:67]
ds_read_b64_tr_b16 v[168:169], v22 offset:0
v_lshlrev_b32 v77, 16, v33
v_mfma_f32_16x16x32_bf16 a[68:71], v[232:235], v[196:199], a[68:71]
s_add_u32 m0, s64, 32768
ds_read_b64_tr_b16 v[170:171], v22 offset:1024
v_lshlrev_b32 v78, 16, v34
v_mfma_f32_16x16x32_bf16 a[72:75], v[232:235], v[200:203], a[72:75]
s_add_u32 s72, s71, 0
buffer_load_dwordx4 v6, s[16:19], s72 offen lds
v_mfma_f32_16x16x32_bf16 a[76:79], v[232:235], v[204:207], a[76:79]
ds_read_b64_tr_b16 v[172:173], v23 offset:0
v_lshlrev_b32 v79, 16, v35
v_mfma_f32_16x16x32_bf16 a[80:83], v[232:235], v[208:211], a[80:83]
ds_read_b64_tr_b16 v[174:175], v23 offset:1024
v_lshlrev_b32 v80, 16, v36
v_mfma_f32_16x16x32_bf16 a[84:87], v[232:235], v[212:215], a[84:87]
s_add_u32 s72, s71, 31744
buffer_load_dwordx4 v6, s[16:19], s72 offen offset:1024 lds
v_mfma_f32_16x16x32_bf16 a[88:91], v[232:235], v[216:219], a[88:91]
ds_read_b64_tr_b16 v[176:177], v20 offset:16384
v_lshlrev_b32 v81, 16, v37
v_mfma_f32_16x16x32_bf16 a[92:95], v[232:235], v[220:223], a[92:95]
ds_read_b64_tr_b16 v[178:179], v20 offset:17408
v_lshlrev_b32 v82, 16, v38
v_mfma_f32_16x16x32_bf16 a[124:127], v[236:239], v[220:223], a[124:127]
ds_read_b64_tr_b16 v[180:181], v21 offset:16384
v_lshlrev_b32 v83, 16, v39
v_mfma_f32_16x16x32_bf16 a[120:123], v[236:239], v[216:219], a[120:123]
s_add_u32 s72, s71, 63488
buffer_load_dwordx4 v7, s[16:19], s72 offen offset:2048 lds
v_mfma_f32_16x16x32_bf16 a[116:119], v[236:239], v[212:215], a[116:119]
ds_read_b64_tr_b16 v[182:183], v21 offset:17408
v_lshlrev_b32 v84, 16, v40
v_mfma_f32_16x16x32_bf16 a[112:115], v[236:239], v[208:211], a[112:115]
ds_read_b64_tr_b16 v[184:185], v22 offset:16384
v_lshlrev_b32 v85, 16, v41
v_mfma_f32_16x16x32_bf16 a[108:111], v[236:239], v[204:207], a[108:111]
ds_read_b64_tr_b16 v[186:187], v22 offset:17408
v_lshlrev_b32 v86, 16, v42
v_mfma_f32_16x16x32_bf16 a[104:107], v[236:239], v[200:203], a[104:107]
ds_read_b64_tr_b16 v[188:189], v23 offset:16384
v_lshlrev_b32 v87, 16, v43
v_mfma_f32_16x16x32_bf16 a[100:103], v[236:239], v[196:199], a[100:103]
s_add_u32 s72, s71, 95232
buffer_load_dwordx4 v7, s[16:19], s72 offen offset:3072 lds
v_mfma_f32_16x16x32_bf16 a[96:99], v[236:239], v[192:195], a[96:99]
ds_read_b64_tr_b16 v[190:191], v23 offset:17408
v_lshlrev_b32 v88, 16, v44
v_mfma_f32_16x16x32_bf16 a[128:131], v[192:195], v[240:243], a[128:131]
v_lshlrev_b32 v89, 16, v45
v_lshlrev_b32 v90, 16, v46
v_mfma_f32_16x16x32_bf16 a[132:135], v[196:199], v[240:243], a[132:135]
v_lshlrev_b32 v91, 16, v47
v_lshlrev_b32 v92, 16, v48
v_mfma_f32_16x16x32_bf16 a[136:139], v[200:203], v[240:243], a[136:139]
s_add_u32 m0, s63, 102400
v_lshlrev_b32 v93, 16, v49
v_lshlrev_b32 v94, 16, v50
v_mfma_f32_16x16x32_bf16 a[140:143], v[204:207], v[240:243], a[140:143]
s_add_u32 s72, s69, 32768
buffer_load_dwordx4 v2, s[8:11], s72 offen lds
v_mfma_f32_16x16x32_bf16 a[144:147], v[208:211], v[240:243], a[144:147]
v_mul_f32 v95, v75, v91
v_lshlrev_b32 v97, 16, v66
v_mfma_f32_16x16x32_bf16 a[148:151], v[212:215], v[240:243], a[148:151]
v_fmac_f32 v95, v74, v92
v_fmac_f32 v95, v73, v93
v_mfma_f32_16x16x32_bf16 a[152:155], v[216:219], v[240:243], a[152:155]
s_add_u32 s72, s69, 39936
buffer_load_dwordx4 v3, s[8:11], s72 offen offset:1024 lds
v_mfma_f32_16x16x32_bf16 a[156:159], v[220:223], v[240:243], a[156:159]
v_fmac_f32 v95, v72, v94
v_mul_f32 v95, v95, v97
v_mfma_f32_16x16x32_bf16 a[188:191], v[220:223], v[244:247], a[188:191]
v_mul_f32 v96, v75, v90
v_lshlrev_b32 v97, 16, v65
v_mfma_f32_16x16x32_bf16 a[184:187], v[216:219], v[244:247], a[184:187]
v_fmac_f32 v96, v74, v91
v_fmac_f32 v96, v73, v92
v_mfma_f32_16x16x32_bf16 a[180:183], v[212:215], v[244:247], a[180:183]
v_fmac_f32 v96, v72, v93
v_mul_f32 v96, v96, v97
v_mfma_f32_16x16x32_bf16 a[176:179], v[208:211], v[244:247], a[176:179]
s_add_u32 s72, s69, 47104
buffer_load_dwordx4 v2, s[8:11], s72 offen offset:2048 lds
v_mfma_f32_16x16x32_bf16 a[172:175], v[204:207], v[244:247], a[172:175]
v_cvt_pk_bf16_f32 v100, v95, v96
v_mul_f32 v95, v75, v89
v_mfma_f32_16x16x32_bf16 a[168:171], v[200:203], v[244:247], a[168:171]
v_lshlrev_b32 v97, 16, v64
v_fmac_f32 v95, v74, v90
v_mfma_f32_16x16x32_bf16 a[164:167], v[196:199], v[244:247], a[164:167]
v_fmac_f32 v95, v73, v91
v_fmac_f32 v95, v72, v92
v_mfma_f32_16x16x32_bf16 a[160:163], v[192:195], v[244:247], a[160:163]
s_add_u32 s72, s69, 54272
buffer_load_dwordx4 v3, s[8:11], s72 offen offset:3072 lds
v_mfma_f32_16x16x32_bf16 a[192:195], v[192:195], v[248:251], a[192:195]
v_mul_f32 v95, v95, v97
v_mul_f32 v96, v75, v88
v_mfma_f32_16x16x32_bf16 a[196:199], v[196:199], v[248:251], a[196:199]
v_lshlrev_b32 v97, 16, v63
v_fmac_f32 v96, v74, v89
v_mfma_f32_16x16x32_bf16 a[200:203], v[200:203], v[248:251], a[200:203]
v_fmac_f32 v96, v73, v90
v_fmac_f32 v96, v72, v91
v_mfma_f32_16x16x32_bf16 a[204:207], v[204:207], v[248:251], a[204:207]
s_add_u32 m0, s64, 49152
v_mul_f32 v96, v96, v97
v_cvt_pk_bf16_f32 v101, v95, v96
v_mfma_f32_16x16x32_bf16 a[208:211], v[208:211], v[248:251], a[208:211]
s_add_u32 s72, s71, 0
buffer_load_dwordx4 v6, s[20:23], s72 offen lds
v_mfma_f32_16x16x32_bf16 a[212:215], v[212:215], v[248:251], a[212:215]
v_mul_f32 v95, v75, v87
v_lshlrev_b32 v97, 16, v62
v_mfma_f32_16x16x32_bf16 a[216:219], v[216:219], v[248:251], a[216:219]
v_fmac_f32 v95, v74, v88
v_fmac_f32 v95, v73, v89
v_mfma_f32_16x16x32_bf16 a[220:223], v[220:223], v[248:251], a[220:223]
v_fmac_f32 v95, v72, v90
v_mul_f32 v95, v95, v97
v_mfma_f32_16x16x32_bf16 a[252:255], v[220:223], v[252:255], a[252:255]
s_add_u32 s72, s71, 31744
buffer_load_dwordx4 v6, s[20:23], s72 offen offset:1024 lds
v_mfma_f32_16x16x32_bf16 a[248:251], v[216:219], v[252:255], a[248:251]
v_mul_f32 v96, v75, v86
v_lshlrev_b32 v97, 16, v61
v_mfma_f32_16x16x32_bf16 a[244:247], v[212:215], v[252:255], a[244:247]
v_fmac_f32 v96, v74, v87
v_fmac_f32 v96, v73, v88
v_mfma_f32_16x16x32_bf16 a[240:243], v[208:211], v[252:255], a[240:243]
v_fmac_f32 v96, v72, v89
v_mul_f32 v96, v96, v97
v_mfma_f32_16x16x32_bf16 a[236:239], v[204:207], v[252:255], a[236:239]
s_add_u32 s72, s71, 63488
buffer_load_dwordx4 v7, s[20:23], s72 offen offset:2048 lds
v_mfma_f32_16x16x32_bf16 a[232:235], v[200:203], v[252:255], a[232:235]
v_cvt_pk_bf16_f32 v102, v95, v96
v_mul_f32 v95, v75, v85
v_mfma_f32_16x16x32_bf16 a[228:231], v[196:199], v[252:255], a[228:231]
v_lshlrev_b32 v97, 16, v60
v_fmac_f32 v95, v74, v86
v_mfma_f32_16x16x32_bf16 a[224:227], v[192:195], v[252:255], a[224:227]
s_waitcnt lgkmcnt(0)
v_fmac_f32 v95, v73, v87
v_fmac_f32 v95, v72, v88
v_mfma_f32_16x16x32_bf16 a[0:3], v[160:163], v[128:131], a[0:3]
s_add_u32 s72, s71, 95232
buffer_load_dwordx4 v7, s[20:23], s72 offen offset:3072 lds
v_mfma_f32_16x16x32_bf16 a[4:7], v[160:163], v[132:135], a[4:7]
s_mov_b32 s80, 0x0
buffer_load_dword v126, v125, s[12:15], s80 offen
v_mfma_f32_16x16x32_bf16 a[8:11], v[160:163], v[136:139], a[8:11]
s_mov_b32 s80, 0x100000
buffer_load_dword v126, v125, s[12:15], s80 offen
v_mfma_f32_16x16x32_bf16 a[12:15], v[160:163], v[140:143], a[12:15]
s_mov_b32 s80, 0x200000
buffer_load_dword v126, v125, s[12:15], s80 offen
v_mfma_f32_16x16x32_bf16 a[16:19], v[160:163], v[144:147], a[16:19]
s_mov_b32 s80, 0x300000
buffer_load_dword v126, v125, s[12:15], s80 offen
v_mfma_f32_16x16x32_bf16 a[20:23], v[160:163], v[148:151], a[20:23]
ds_read_b64_tr_b16 v[224:225], v20 offset:8192
v_mul_f32 v95, v95, v97
v_mfma_f32_16x16x32_bf16 a[24:27], v[160:163], v[152:155], a[24:27]
v_mul_f32 v96, v75, v84
v_lshlrev_b32 v97, 16, v59
v_mfma_f32_16x16x32_bf16 a[28:31], v[160:163], v[156:159], a[28:31]
ds_read_b64_tr_b16 v[226:227], v20 offset:9216
v_fmac_f32 v96, v74, v85
v_mfma_f32_16x16x32_bf16 a[60:63], v[164:167], v[156:159], a[60:63]
v_fmac_f32 v96, v73, v86
v_fmac_f32 v96, v72, v87
v_mfma_f32_16x16x32_bf16 a[56:59], v[164:167], v[152:155], a[56:59]
ds_read_b128 v[192:195], v25 offset:0
v_mul_f32 v96, v96, v97
v_mfma_f32_16x16x32_bf16 a[52:55], v[164:167], v[148:151], a[52:55]
v_cvt_pk_bf16_f32 v103, v95, v96
v_mfma_f32_16x16x32_bf16 a[48:51], v[164:167], v[144:147], a[48:51]
ds_read_b128 v[196:199], v25 offset:2048
ds_write_b128 v28, v[100:103] offset:0
v_mfma_f32_16x16x32_bf16 a[44:47], v[164:167], v[140:143], a[44:47]
v_mul_f32 v95, v75, v83
v_lshlrev_b32 v97, 16, v58
v_mfma_f32_16x16x32_bf16 a[40:43], v[164:167], v[136:139], a[40:43]
ds_read_b128 v[200:203], v25 offset:4096
v_fmac_f32 v95, v74, v84
v_mfma_f32_16x16x32_bf16 a[36:39], v[164:167], v[132:135], a[36:39]
v_fmac_f32 v95, v73, v85
v_fmac_f32 v95, v72, v86
v_mfma_f32_16x16x32_bf16 a[32:35], v[164:167], v[128:131], a[32:35]
ds_read_b128 v[204:207], v25 offset:6144
v_mul_f32 v95, v95, v97
v_mfma_f32_16x16x32_bf16 a[64:67], v[168:171], v[128:131], a[64:67]
v_mul_f32 v96, v75, v82
v_lshlrev_b32 v97, 16, v57
v_mfma_f32_16x16x32_bf16 a[68:71], v[168:171], v[132:135], a[68:71]
ds_read_b128 v[208:211], v25 offset:8192
v_fmac_f32 v96, v74, v83
v_mfma_f32_16x16x32_bf16 a[72:75], v[168:171], v[136:139], a[72:75]
v_fmac_f32 v96, v73, v84
v_fmac_f32 v96, v72, v85
v_mfma_f32_16x16x32_bf16 a[76:79], v[168:171], v[140:143], a[76:79]
ds_read_b128 v[212:215], v25 offset:10240
v_mul_f32 v96, v96, v97
v_mfma_f32_16x16x32_bf16 a[80:83], v[168:171], v[144:147], a[80:83]
v_cvt_pk_bf16_f32 v104, v95, v96
v_mul_f32 v95, v75, v81
v_mfma_f32_16x16x32_bf16 a[84:87], v[168:171], v[148:151], a[84:87]
ds_read_b128 v[216:219], v25 offset:12288
v_lshlrev_b32 v97, 16, v56
v_mfma_f32_16x16x32_bf16 a[88:91], v[168:171], v[152:155], a[88:91]
v_fmac_f32 v95, v74, v82
v_fmac_f32 v95, v73, v83
v_mfma_f32_16x16x32_bf16 a[92:95], v[168:171], v[156:159], a[92:95]
ds_read_b128 v[220:223], v25 offset:14336
v_fmac_f32 v95, v72, v84
v_mfma_f32_16x16x32_bf16 a[124:127], v[172:175], v[156:159], a[124:127]
v_mul_f32 v95, v95, v97
v_mul_f32 v96, v75, v80
v_mfma_f32_16x16x32_bf16 a[120:123], v[172:175], v[152:155], a[120:123]
ds_read_b64_tr_b16 v[228:229], v21 offset:8192
v_lshlrev_b32 v97, 16, v55
v_mfma_f32_16x16x32_bf16 a[116:119], v[172:175], v[148:151], a[116:119]
v_fmac_f32 v96, v74, v81
v_fmac_f32 v96, v73, v82
v_mfma_f32_16x16x32_bf16 a[112:115], v[172:175], v[144:147], a[112:115]
ds_read_b64_tr_b16 v[230:231], v21 offset:9216
v_fmac_f32 v96, v72, v83
v_mfma_f32_16x16x32_bf16 a[108:111], v[172:175], v[140:143], a[108:111]
v_mul_f32 v96, v96, v97
v_cvt_pk_bf16_f32 v105, v95, v96
v_mfma_f32_16x16x32_bf16 a[104:107], v[172:175], v[136:139], a[104:107]
ds_read_b64_tr_b16 v[232:233], v22 offset:8192
v_mul_f32 v95, v75, v79
v_mfma_f32_16x16x32_bf16 a[100:103], v[172:175], v[132:135], a[100:103]
v_lshlrev_b32 v97, 16, v54
v_fmac_f32 v95, v74, v80
v_mfma_f32_16x16x32_bf16 a[96:99], v[172:175], v[128:131], a[96:99]
ds_read_b64_tr_b16 v[234:235], v22 offset:9216
v_fmac_f32 v95, v73, v81
v_mfma_f32_16x16x32_bf16 a[128:131], v[128:131], v[176:179], a[128:131]
v_fmac_f32 v95, v72, v82
v_mul_f32 v95, v95, v97
v_mfma_f32_16x16x32_bf16 a[132:135], v[132:135], v[176:179], a[132:135]
ds_read_b64_tr_b16 v[236:237], v23 offset:8192
v_mul_f32 v96, v75, v78
v_mfma_f32_16x16x32_bf16 a[136:139], v[136:139], v[176:179], a[136:139]
v_lshlrev_b32 v97, 16, v53
v_fmac_f32 v96, v74, v79
v_mfma_f32_16x16x32_bf16 a[140:143], v[140:143], v[176:179], a[140:143]
ds_read_b64_tr_b16 v[238:239], v23 offset:9216
v_fmac_f32 v96, v73, v80
v_mfma_f32_16x16x32_bf16 a[144:147], v[144:147], v[176:179], a[144:147]
v_fmac_f32 v96, v72, v81
v_mul_f32 v96, v96, v97
v_mfma_f32_16x16x32_bf16 a[148:151], v[148:151], v[176:179], a[148:151]
ds_read_b64_tr_b16 v[240:241], v20 offset:24576
v_cvt_pk_bf16_f32 v106, v95, v96
v_mfma_f32_16x16x32_bf16 a[152:155], v[152:155], v[176:179], a[152:155]
v_mul_f32 v95, v75, v77
v_lshlrev_b32 v97, 16, v52
v_mfma_f32_16x16x32_bf16 a[156:159], v[156:159], v[176:179], a[156:159]
ds_read_b64_tr_b16 v[242:243], v20 offset:25600
v_fmac_f32 v95, v74, v78
v_mfma_f32_16x16x32_bf16 a[188:191], v[156:159], v[180:183], a[188:191]
v_fmac_f32 v95, v73, v79
v_fmac_f32 v95, v72, v80
v_mfma_f32_16x16x32_bf16 a[184:187], v[152:155], v[180:183], a[184:187]
ds_read_b64_tr_b16 v[244:245], v21 offset:24576
v_mul_f32 v95, v95, v97
v_mfma_f32_16x16x32_bf16 a[180:183], v[148:151], v[180:183], a[180:183]
v_mul_f32 v96, v75, v76
v_lshlrev_b32 v97, 16, v51
v_mfma_f32_16x16x32_bf16 a[176:179], v[144:147], v[180:183], a[176:179]
ds_read_b64_tr_b16 v[246:247], v21 offset:25600
v_fmac_f32 v96, v74, v77
v_mfma_f32_16x16x32_bf16 a[172:175], v[140:143], v[180:183], a[172:175]
v_fmac_f32 v96, v73, v78
v_fmac_f32 v96, v72, v79
v_mfma_f32_16x16x32_bf16 a[168:171], v[136:139], v[180:183], a[168:171]
ds_read_b64_tr_b16 v[248:249], v22 offset:24576
v_mul_f32 v96, v96, v97
v_mfma_f32_16x16x32_bf16 a[164:167], v[132:135], v[180:183], a[164:167]
v_cvt_pk_bf16_f32 v107, v95, v96
v_mfma_f32_16x16x32_bf16 a[160:163], v[128:131], v[180:183], a[160:163]
ds_read_b64_tr_b16 v[250:251], v22 offset:25600
ds_write_b128 v28, v[104:107] offset:16
v_mfma_f32_16x16x32_bf16 a[192:195], v[128:131], v[184:187], a[192:195]
global_load_dwordx4 v[84:87], v1, s[56:57]
v_mfma_f32_16x16x32_bf16 a[196:199], v[132:135], v[184:187], a[196:199]
ds_read_b64_tr_b16 v[252:253], v23 offset:24576
v_mfma_f32_16x16x32_bf16 a[200:203], v[136:139], v[184:187], a[200:203]
global_load_dwordx4 v[88:91], v1, s[56:57] offset:1024
v_mfma_f32_16x16x32_bf16 a[204:207], v[140:143], v[184:187], a[204:207]
ds_read_b64_tr_b16 v[254:255], v23 offset:25600
v_lshlrev_b32 v72, 16, v70
v_mfma_f32_16x16x32_bf16 a[208:211], v[144:147], v[184:187], a[208:211]
v_and_b32 v73, 0xffff0000, v70
v_lshlrev_b32 v74, 16, v71
v_mfma_f32_16x16x32_bf16 a[212:215], v[148:151], v[184:187], a[212:215]
v_and_b32 v75, 0xffff0000, v71
v_and_b32 v32, 0xffff0000, v32
v_mfma_f32_16x16x32_bf16 a[216:219], v[152:155], v[184:187], a[216:219]
v_and_b32 v33, 0xffff0000, v33
v_and_b32 v34, 0xffff0000, v34
v_mfma_f32_16x16x32_bf16 a[220:223], v[156:159], v[184:187], a[220:223]
v_and_b32 v35, 0xffff0000, v35
v_and_b32 v36, 0xffff0000, v36
v_mfma_f32_16x16x32_bf16 a[252:255], v[156:159], v[188:191], a[252:255]
v_and_b32 v37, 0xffff0000, v37
v_and_b32 v38, 0xffff0000, v38
v_mfma_f32_16x16x32_bf16 a[248:251], v[152:155], v[188:191], a[248:251]
v_and_b32 v39, 0xffff0000, v39
v_and_b32 v40, 0xffff0000, v40
v_mfma_f32_16x16x32_bf16 a[244:247], v[148:151], v[188:191], a[244:247]
v_and_b32 v41, 0xffff0000, v41
v_and_b32 v42, 0xffff0000, v42
v_mfma_f32_16x16x32_bf16 a[240:243], v[144:147], v[188:191], a[240:243]
v_and_b32 v43, 0xffff0000, v43
v_and_b32 v44, 0xffff0000, v44
v_mfma_f32_16x16x32_bf16 a[236:239], v[140:143], v[188:191], a[236:239]
v_and_b32 v45, 0xffff0000, v45
v_and_b32 v46, 0xffff0000, v46
v_mfma_f32_16x16x32_bf16 a[232:235], v[136:139], v[188:191], a[232:235]
v_and_b32 v47, 0xffff0000, v47
v_and_b32 v48, 0xffff0000, v48
v_mfma_f32_16x16x32_bf16 a[228:231], v[132:135], v[188:191], a[228:231]
s_waitcnt vmcnt(6) lgkmcnt(0)
v_and_b32 v49, 0xffff0000, v49
v_and_b32 v50, 0xffff0000, v50
v_mfma_f32_16x16x32_bf16 a[224:227], v[128:131], v[188:191], a[224:227]
s_barrier
v_mul_f32 v95, v75, v47
v_and_b32 v97, 0xffff0000, v66
v_mfma_f32_16x16x32_bf16 a[0:3], v[224:227], v[192:195], a[0:3]
s_add_u32 s73, s61, 6
ds_read_b64_tr_b16 v[160:161], v20 offset:32768
v_fmac_f32 v95, v74, v48
v_mfma_f32_16x16x32_bf16 a[4:7], v[224:227], v[196:199], a[4:7]
s_and_b32 s73, s73, 7
ds_read_b64_tr_b16 v[162:163], v20 offset:33792
v_fmac_f32 v95, v73, v49
v_mfma_f32_16x16x32_bf16 a[8:11], v[224:227], v[200:203], a[8:11]
s_lshl_b32 s69, s73, 7
ds_read_b128 v[128:131], v24 offset:32768
v_fmac_f32 v95, v72, v50
v_mfma_f32_16x16x32_bf16 a[12:15], v[224:227], v[204:207], a[12:15]
s_add_u32 s69, s69, s67
ds_read_b128 v[132:135], v24 offset:34816
v_mul_f32 v95, v95, v97
v_mfma_f32_16x16x32_bf16 a[16:19], v[224:227], v[208:211], a[16:19]
s_lshl_b32 s71, s73, 19
ds_read_b128 v[136:139], v24 offset:36864
v_mul_f32 v96, v75, v46
v_mfma_f32_16x16x32_bf16 a[20:23], v[224:227], v[212:215], a[20:23]
s_add_u32 s71, s71, s66
ds_read_b128 v[140:143], v24 offset:38912
v_and_b32 v97, 0xffff0000, v65
v_mfma_f32_16x16x32_bf16 a[24:27], v[224:227], v[216:219], a[24:27]
s_add_u32 m0, s63, 65536
ds_read_b128 v[144:147], v24 offset:40960
v_fmac_f32 v96, v74, v47
v_mfma_f32_16x16x32_bf16 a[28:31], v[224:227], v[220:223], a[28:31]
s_add_u32 s72, s69, 0
buffer_load_dwordx4 v2, s[8:11], s72 offen lds
v_mfma_f32_16x16x32_bf16 a[60:63], v[228:231], v[220:223], a[60:63]
s_add_u32 s72, s69, 7168
buffer_load_dwordx4 v3, s[8:11], s72 offen offset:1024 lds
v_mfma_f32_16x16x32_bf16 a[56:59], v[228:231], v[216:219], a[56:59]
s_add_u32 s72, s69, 14336
buffer_load_dwordx4 v2, s[8:11], s72 offen offset:2048 lds
v_mfma_f32_16x16x32_bf16 a[52:55], v[228:231], v[212:215], a[52:55]
ds_read_b128 v[148:151], v24 offset:43008
v_fmac_f32 v96, v73, v48
v_mfma_f32_16x16x32_bf16 a[48:51], v[228:231], v[208:211], a[48:51]
ds_read_b128 v[152:155], v24 offset:45056
v_fmac_f32 v96, v72, v49
v_mfma_f32_16x16x32_bf16 a[44:47], v[228:231], v[204:207], a[44:47]
s_add_u32 s72, s69, 21504
buffer_load_dwordx4 v3, s[8:11], s72 offen offset:3072 lds
v_mfma_f32_16x16x32_bf16 a[40:43], v[228:231], v[200:203], a[40:43]
ds_read_b128 v[156:159], v24 offset:47104
v_mul_f32 v96, v96, v97
v_mfma_f32_16x16x32_bf16 a[36:39], v[228:231], v[196:199], a[36:39]
ds_read_b64_tr_b16 v[164:165], v21 offset:32768
v_cvt_pk_bf16_f32 v100, v95, v96
v_mfma_f32_16x16x32_bf16 a[32:35], v[228:231], v[192:195], a[32:35]
ds_read_b64_tr_b16 v[166:167], v21 offset:33792
v_mul_f32 v95, v75, v45
v_mfma_f32_16x16x32_bf16 a[64:67], v[232:235], v[192:195], a[64:67]
ds_read_b64_tr_b16 v[168:169], v22 offset:32768
v_and_b32 v97, 0xffff0000, v64
v_mfma_f32_16x16x32_bf16 a[68:71], v[232:235], v[196:199], a[68:71]
s_add_u32 m0, s64, 0
ds_read_b64_tr_b16 v[170:171], v22 offset:33792
v_fmac_f32 v95, v74, v46
v_mfma_f32_16x16x32_bf16 a[72:75], v[232:235], v[200:203], a[72:75]
s_add_u32 s72, s71, 0
buffer_load_dwordx4 v6, s[16:19], s72 offen lds
v_mfma_f32_16x16x32_bf16 a[76:79], v[232:235], v[204:207], a[76:79]
ds_read_b64_tr_b16 v[172:173], v23 offset:32768
v_fmac_f32 v95, v73, v47
v_mfma_f32_16x16x32_bf16 a[80:83], v[232:235], v[208:211], a[80:83]
ds_read_b64_tr_b16 v[174:175], v23 offset:33792
v_fmac_f32 v95, v72, v48
v_mfma_f32_16x16x32_bf16 a[84:87], v[232:235], v[212:215], a[84:87]
s_add_u32 s72, s71, 31744
buffer_load_dwordx4 v6, s[16:19], s72 offen offset:1024 lds
v_mfma_f32_16x16x32_bf16 a[88:91], v[232:235], v[216:219], a[88:91]
ds_read_b64_tr_b16 v[176:177], v20 offset:49152
v_mul_f32 v95, v95, v97
v_mfma_f32_16x16x32_bf16 a[92:95], v[232:235], v[220:223], a[92:95]
ds_read_b64_tr_b16 v[178:179], v20 offset:50176
v_mul_f32 v96, v75, v44
v_mfma_f32_16x16x32_bf16 a[124:127], v[236:239], v[220:223], a[124:127]
ds_read_b64_tr_b16 v[180:181], v21 offset:49152
v_and_b32 v97, 0xffff0000, v63
v_mfma_f32_16x16x32_bf16 a[120:123], v[236:239], v[216:219], a[120:123]
s_add_u32 s72, s71, 63488
buffer_load_dwordx4 v7, s[16:19], s72 offen offset:2048 lds
v_mfma_f32_16x16x32_bf16 a[116:119], v[236:239], v[212:215], a[116:119]
ds_read_b64_tr_b16 v[182:183], v21 offset:50176
v_fmac_f32 v96, v74, v45
v_mfma_f32_16x16x32_bf16 a[112:115], v[236:239], v[208:211], a[112:115]
ds_read_b64_tr_b16 v[184:185], v22 offset:49152
v_fmac_f32 v96, v73, v46
v_mfma_f32_16x16x32_bf16 a[108:111], v[236:239], v[204:207], a[108:111]
ds_read_b64_tr_b16 v[186:187], v22 offset:50176
v_fmac_f32 v96, v72, v47
v_mfma_f32_16x16x32_bf16 a[104:107], v[236:239], v[200:203], a[104:107]
ds_read_b64_tr_b16 v[188:189], v23 offset:49152
v_mul_f32 v96, v96, v97
v_mfma_f32_16x16x32_bf16 a[100:103], v[236:239], v[196:199], a[100:103]
s_add_u32 s72, s71, 95232
buffer_load_dwordx4 v7, s[16:19], s72 offen offset:3072 lds
v_mfma_f32_16x16x32_bf16 a[96:99], v[236:239], v[192:195], a[96:99]
ds_read_b64_tr_b16 v[190:191], v23 offset:50176
v_cvt_pk_bf16_f32 v101, v95, v96
v_mfma_f32_16x16x32_bf16 a[128:131], v[192:195], v[240:243], a[128:131]
v_mul_f32 v95, v75, v43
v_and_b32 v97, 0xffff0000, v62
v_mfma_f32_16x16x32_bf16 a[132:135], v[196:199], v[240:243], a[132:135]
v_fmac_f32 v95, v74, v44
v_fmac_f32 v95, v73, v45
v_mfma_f32_16x16x32_bf16 a[136:139], v[200:203], v[240:243], a[136:139]
s_add_u32 m0, s63, 69632
v_fmac_f32 v95, v72, v46
v_mul_f32 v95, v95, v97
v_mfma_f32_16x16x32_bf16 a[140:143], v[204:207], v[240:243], a[140:143]
s_add_u32 s72, s69, 32768
buffer_load_dwordx4 v2, s[8:11], s72 offen lds
v_mfma_f32_16x16x32_bf16 a[144:147], v[208:211], v[240:243], a[144:147]
v_mul_f32 v96, v75, v42
v_and_b32 v97, 0xffff0000, v61
v_mfma_f32_16x16x32_bf16 a[148:151], v[212:215], v[240:243], a[148:151]
v_fmac_f32 v96, v74, v43
v_fmac_f32 v96, v73, v44
v_mfma_f32_16x16x32_bf16 a[152:155], v[216:219], v[240:243], a[152:155]
s_add_u32 s72, s69, 39936
buffer_load_dwordx4 v3, s[8:11], s72 offen offset:1024 lds
v_mfma_f32_16x16x32_bf16 a[156:159], v[220:223], v[240:243], a[156:159]
v_fmac_f32 v96, v72, v45
v_mul_f32 v96, v96, v97
v_mfma_f32_16x16x32_bf16 a[188:191], v[220:223], v[244:247], a[188:191]
v_cvt_pk_bf16_f32 v102, v95, v96
v_mul_f32 v95, v75, v41
v_mfma_f32_16x16x32_bf16 a[184:187], v[216:219], v[244:247], a[184:187]
v_and_b32 v97, 0xffff0000, v60
v_fmac_f32 v95, v74, v42
v_mfma_f32_16x16x32_bf16 a[180:183], v[212:215], v[244:247], a[180:183]
v_fmac_f32 v95, v73, v43
v_fmac_f32 v95, v72, v44
v_mfma_f32_16x16x32_bf16 a[176:179], v[208:211], v[244:247], a[176:179]
s_add_u32 s72, s69, 47104
buffer_load_dwordx4 v2, s[8:11], s72 offen offset:2048 lds
v_mfma_f32_16x16x32_bf16 a[172:175], v[204:207], v[244:247], a[172:175]
v_mul_f32 v95, v95, v97
v_mul_f32 v96, v75, v40
v_mfma_f32_16x16x32_bf16 a[168:171], v[200:203], v[244:247], a[168:171]
v_and_b32 v97, 0xffff0000, v59
v_fmac_f32 v96, v74, v41
v_mfma_f32_16x16x32_bf16 a[164:167], v[196:199], v[244:247], a[164:167]
v_fmac_f32 v96, v73, v42
v_fmac_f32 v96, v72, v43
v_mfma_f32_16x16x32_bf16 a[160:163], v[192:195], v[244:247], a[160:163]
s_add_u32 s72, s69, 54272
buffer_load_dwordx4 v3, s[8:11], s72 offen offset:3072 lds
v_mfma_f32_16x16x32_bf16 a[192:195], v[192:195], v[248:251], a[192:195]
v_mul_f32 v96, v96, v97
v_cvt_pk_bf16_f32 v103, v95, v96
v_mfma_f32_16x16x32_bf16 a[196:199], v[196:199], v[248:251], a[196:199]
ds_write_b128 v28, v[100:103] offset:272
v_mul_f32 v95, v75, v39
v_mfma_f32_16x16x32_bf16 a[200:203], v[200:203], v[248:251], a[200:203]
v_and_b32 v97, 0xffff0000, v58
v_fmac_f32 v95, v74, v40
v_mfma_f32_16x16x32_bf16 a[204:207], v[204:207], v[248:251], a[204:207]
s_add_u32 m0, s64, 16384
v_fmac_f32 v95, v73, v41
v_fmac_f32 v95, v72, v42
v_mfma_f32_16x16x32_bf16 a[208:211], v[208:211], v[248:251], a[208:211]
s_add_u32 s72, s71, 0
buffer_load_dwordx4 v6, s[20:23], s72 offen lds
v_mfma_f32_16x16x32_bf16 a[212:215], v[212:215], v[248:251], a[212:215]
v_mul_f32 v95, v95, v97
v_mul_f32 v96, v75, v38
v_mfma_f32_16x16x32_bf16 a[216:219], v[216:219], v[248:251], a[216:219]
v_and_b32 v97, 0xffff0000, v57
v_fmac_f32 v96, v74, v39
v_mfma_f32_16x16x32_bf16 a[220:223], v[220:223], v[248:251], a[220:223]
v_fmac_f32 v96, v73, v40
v_fmac_f32 v96, v72, v41
v_mfma_f32_16x16x32_bf16 a[252:255], v[220:223], v[252:255], a[252:255]
s_add_u32 s72, s71, 31744
buffer_load_dwordx4 v6, s[20:23], s72 offen offset:1024 lds
v_mfma_f32_16x16x32_bf16 a[248:251], v[216:219], v[252:255], a[248:251]
v_mul_f32 v96, v96, v97
v_cvt_pk_bf16_f32 v104, v95, v96
v_mfma_f32_16x16x32_bf16 a[244:247], v[212:215], v[252:255], a[244:247]
v_mul_f32 v95, v75, v37
v_and_b32 v97, 0xffff0000, v56
v_mfma_f32_16x16x32_bf16 a[240:243], v[208:211], v[252:255], a[240:243]
v_fmac_f32 v95, v74, v38
v_fmac_f32 v95, v73, v39
v_mfma_f32_16x16x32_bf16 a[236:239], v[204:207], v[252:255], a[236:239]
s_add_u32 s72, s71, 63488
buffer_load_dwordx4 v7, s[20:23], s72 offen offset:2048 lds
v_mfma_f32_16x16x32_bf16 a[232:235], v[200:203], v[252:255], a[232:235]
v_fmac_f32 v95, v72, v40
v_mul_f32 v95, v95, v97
v_mfma_f32_16x16x32_bf16 a[228:231], v[196:199], v[252:255], a[228:231]
v_mul_f32 v96, v75, v36
v_and_b32 v97, 0xffff0000, v55
v_mfma_f32_16x16x32_bf16 a[224:227], v[192:195], v[252:255], a[224:227]
s_waitcnt lgkmcnt(0)
v_fmac_f32 v96, v74, v37
v_fmac_f32 v96, v73, v38
v_mfma_f32_16x16x32_bf16 a[0:3], v[160:163], v[128:131], a[0:3]
s_add_u32 s72, s71, 95232
buffer_load_dwordx4 v7, s[20:23], s72 offen offset:3072 lds
v_mfma_f32_16x16x32_bf16 a[4:7], v[160:163], v[132:135], a[4:7]
s_mov_b32 s80, 0x400000
buffer_load_dword v126, v125, s[12:15], s80 offen
v_mfma_f32_16x16x32_bf16 a[8:11], v[160:163], v[136:139], a[8:11]
s_mov_b32 s80, 0x500000
buffer_load_dword v126, v125, s[12:15], s80 offen
v_mfma_f32_16x16x32_bf16 a[12:15], v[160:163], v[140:143], a[12:15]
s_mov_b32 s80, 0x600000
buffer_load_dword v126, v125, s[12:15], s80 offen
v_mfma_f32_16x16x32_bf16 a[16:19], v[160:163], v[144:147], a[16:19]
s_mov_b32 s80, 0x700000
buffer_load_dword v126, v125, s[12:15], s80 offen
v_mfma_f32_16x16x32_bf16 a[20:23], v[160:163], v[148:151], a[20:23]
ds_read_b64_tr_b16 v[224:225], v20 offset:40960
v_fmac_f32 v96, v72, v39
v_mfma_f32_16x16x32_bf16 a[24:27], v[160:163], v[152:155], a[24:27]
v_mul_f32 v96, v96, v97
v_cvt_pk_bf16_f32 v105, v95, v96
v_mfma_f32_16x16x32_bf16 a[28:31], v[160:163], v[156:159], a[28:31]
ds_read_b64_tr_b16 v[226:227], v20 offset:41984
v_mul_f32 v95, v75, v35
v_mfma_f32_16x16x32_bf16 a[60:63], v[164:167], v[156:159], a[60:63]
v_and_b32 v97, 0xffff0000, v54
v_fmac_f32 v95, v74, v36
v_mfma_f32_16x16x32_bf16 a[56:59], v[164:167], v[152:155], a[56:59]
ds_read_b128 v[192:195], v25 offset:32768
v_fmac_f32 v95, v73, v37
v_mfma_f32_16x16x32_bf16 a[52:55], v[164:167], v[148:151], a[52:55]
v_fmac_f32 v95, v72, v38
v_mul_f32 v95, v95, v97
v_mfma_f32_16x16x32_bf16 a[48:51], v[164:167], v[144:147], a[48:51]
ds_read_b128 v[196:199], v25 offset:34816
v_mul_f32 v96, v75, v34
v_mfma_f32_16x16x32_bf16 a[44:47], v[164:167], v[140:143], a[44:47]
v_and_b32 v97, 0xffff0000, v53
v_fmac_f32 v96, v74, v35
v_mfma_f32_16x16x32_bf16 a[40:43], v[164:167], v[136:139], a[40:43]
ds_read_b128 v[200:203], v25 offset:36864
v_fmac_f32 v96, v73, v36
v_mfma_f32_16x16x32_bf16 a[36:39], v[164:167], v[132:135], a[36:39]
v_fmac_f32 v96, v72, v37
v_mul_f32 v96, v96, v97
v_mfma_f32_16x16x32_bf16 a[32:35], v[164:167], v[128:131], a[32:35]
ds_read_b128 v[204:207], v25 offset:38912
v_cvt_pk_bf16_f32 v106, v95, v96
v_mfma_f32_16x16x32_bf16 a[64:67], v[168:171], v[128:131], a[64:67]
v_mul_f32 v95, v75, v33
v_and_b32 v97, 0xffff0000, v52
v_mfma_f32_16x16x32_bf16 a[68:71], v[168:171], v[132:135], a[68:71]
ds_read_b128 v[208:211], v25 offset:40960
v_fmac_f32 v95, v74, v34
v_mfma_f32_16x16x32_bf16 a[72:75], v[168:171], v[136:139], a[72:75]
v_fmac_f32 v95, v73, v35
v_fmac_f32 v95, v72, v36
v_mfma_f32_16x16x32_bf16 a[76:79], v[168:171], v[140:143], a[76:79]
ds_read_b128 v[212:215], v25 offset:43008
v_mul_f32 v95, v95, v97
v_mfma_f32_16x16x32_bf16 a[80:83], v[168:171], v[144:147], a[80:83]
v_mul_f32 v96, v75, v32
v_and_b32 v97, 0xffff0000, v51
v_mfma_f32_16x16x32_bf16 a[84:87], v[168:171], v[148:151], a[84:87]
ds_read_b128 v[216:219], v25 offset:45056
v_fmac_f32 v96, v74, v33
v_mfma_f32_16x16x32_bf16 a[88:91], v[168:171], v[152:155], a[88:91]
v_fmac_f32 v96, v73, v34
v_fmac_f32 v96, v72, v35
v_mfma_f32_16x16x32_bf16 a[92:95], v[168:171], v[156:159], a[92:95]
ds_read_b128 v[220:223], v25 offset:47104
v_mul_f32 v96, v96, v97
v_mfma_f32_16x16x32_bf16 a[124:127], v[172:175], v[156:159], a[124:127]
v_cvt_pk_bf16_f32 v107, v95, v96
v_mfma_f32_16x16x32_bf16 a[120:123], v[172:175], v[152:155], a[120:123]
ds_read_b64_tr_b16 v[228:229], v21 offset:40960
ds_write_b128 v28, v[104:107] offset:288
v_mfma_f32_16x16x32_bf16 a[116:119], v[172:175], v[148:151], a[116:119]
v_mfma_f32_16x16x32_bf16 a[112:115], v[172:175], v[144:147], a[112:115]
ds_read_b64_tr_b16 v[230:231], v21 offset:41984
v_mfma_f32_16x16x32_bf16 a[108:111], v[172:175], v[140:143], a[108:111]
v_mfma_f32_16x16x32_bf16 a[104:107], v[172:175], v[136:139], a[104:107]
ds_read_b64_tr_b16 v[232:233], v22 offset:40960
v_mfma_f32_16x16x32_bf16 a[100:103], v[172:175], v[132:135], a[100:103]
v_mfma_f32_16x16x32_bf16 a[96:99], v[172:175], v[128:131], a[96:99]
ds_read_b64_tr_b16 v[234:235], v22 offset:41984
v_mfma_f32_16x16x32_bf16 a[128:131], v[128:131], v[176:179], a[128:131]
v_mfma_f32_16x16x32_bf16 a[132:135], v[132:135], v[176:179], a[132:135]
ds_read_b64_tr_b16 v[236:237], v23 offset:40960
v_mfma_f32_16x16x32_bf16 a[136:139], v[136:139], v[176:179], a[136:139]
v_mfma_f32_16x16x32_bf16 a[140:143], v[140:143], v[176:179], a[140:143]
ds_read_b64_tr_b16 v[238:239], v23 offset:41984
v_mfma_f32_16x16x32_bf16 a[144:147], v[144:147], v[176:179], a[144:147]
v_mfma_f32_16x16x32_bf16 a[148:151], v[148:151], v[176:179], a[148:151]
ds_read_b64_tr_b16 v[240:241], v20 offset:57344
v_mfma_f32_16x16x32_bf16 a[152:155], v[152:155], v[176:179], a[152:155]
v_mfma_f32_16x16x32_bf16 a[156:159], v[156:159], v[176:179], a[156:159]
ds_read_b64_tr_b16 v[242:243], v20 offset:58368
v_mfma_f32_16x16x32_bf16 a[188:191], v[156:159], v[180:183], a[188:191]
v_mfma_f32_16x16x32_bf16 a[184:187], v[152:155], v[180:183], a[184:187]
ds_read_b64_tr_b16 v[244:245], v21 offset:57344
v_mfma_f32_16x16x32_bf16 a[180:183], v[148:151], v[180:183], a[180:183]
v_mfma_f32_16x16x32_bf16 a[176:179], v[144:147], v[180:183], a[176:179]
ds_read_b64_tr_b16 v[246:247], v21 offset:58368
v_mfma_f32_16x16x32_bf16 a[172:175], v[140:143], v[180:183], a[172:175]
v_mfma_f32_16x16x32_bf16 a[168:171], v[136:139], v[180:183], a[168:171]
ds_read_b64_tr_b16 v[248:249], v22 offset:57344
v_mfma_f32_16x16x32_bf16 a[164:167], v[132:135], v[180:183], a[164:167]
v_mfma_f32_16x16x32_bf16 a[160:163], v[128:131], v[180:183], a[160:163]
ds_read_b64_tr_b16 v[250:251], v22 offset:58368
v_mfma_f32_16x16x32_bf16 a[192:195], v[128:131], v[184:187], a[192:195]
v_mfma_f32_16x16x32_bf16 a[196:199], v[132:135], v[184:187], a[196:199]
ds_read_b64_tr_b16 v[252:253], v23 offset:57344
v_mfma_f32_16x16x32_bf16 a[200:203], v[136:139], v[184:187], a[200:203]
v_mfma_f32_16x16x32_bf16 a[204:207], v[140:143], v[184:187], a[204:207]
ds_read_b64_tr_b16 v[254:255], v23 offset:58368
v_mfma_f32_16x16x32_bf16 a[208:211], v[144:147], v[184:187], a[208:211]
v_mfma_f32_16x16x32_bf16 a[212:215], v[148:151], v[184:187], a[212:215]
v_mfma_f32_16x16x32_bf16 a[216:219], v[152:155], v[184:187], a[216:219]
v_mfma_f32_16x16x32_bf16 a[220:223], v[156:159], v[184:187], a[220:223]
v_mfma_f32_16x16x32_bf16 a[252:255], v[156:159], v[188:191], a[252:255]
v_mfma_f32_16x16x32_bf16 a[248:251], v[152:155], v[188:191], a[248:251]
v_mfma_f32_16x16x32_bf16 a[244:247], v[148:151], v[188:191], a[244:247]
v_mfma_f32_16x16x32_bf16 a[240:243], v[144:147], v[188:191], a[240:243]
v_mfma_f32_16x16x32_bf16 a[236:239], v[140:143], v[188:191], a[236:239]
v_mfma_f32_16x16x32_bf16 a[232:235], v[136:139], v[188:191], a[232:235]
v_mfma_f32_16x16x32_bf16 a[228:231], v[132:135], v[188:191], a[228:231]
s_waitcnt vmcnt(4) lgkmcnt(0)
v_mfma_f32_16x16x32_bf16 a[224:227], v[128:131], v[188:191], a[224:227]
s_barrier
v_mfma_f32_16x16x32_bf16 a[0:3], v[224:227], v[192:195], a[0:3]
s_add_u32 s73, s61, 7
ds_read_b64_tr_b16 v[160:161], v20 offset:0
v_mfma_f32_16x16x32_bf16 a[4:7], v[224:227], v[196:199], a[4:7]
s_and_b32 s73, s73, 7
ds_read_b64_tr_b16 v[162:163], v20 offset:1024
v_mfma_f32_16x16x32_bf16 a[8:11], v[224:227], v[200:203], a[8:11]
s_lshl_b32 s69, s73, 7
ds_read_b128 v[128:131], v24 offset:0
v_mfma_f32_16x16x32_bf16 a[12:15], v[224:227], v[204:207], a[12:15]
s_add_u32 s69, s69, s67
ds_read_b128 v[132:135], v24 offset:2048
v_mfma_f32_16x16x32_bf16 a[16:19], v[224:227], v[208:211], a[16:19]
s_lshl_b32 s71, s73, 19
ds_read_b128 v[136:139], v24 offset:4096
v_mfma_f32_16x16x32_bf16 a[20:23], v[224:227], v[212:215], a[20:23]
s_add_u32 s71, s71, s66
ds_read_b128 v[140:143], v24 offset:6144
v_mfma_f32_16x16x32_bf16 a[24:27], v[224:227], v[216:219], a[24:27]
s_add_u32 m0, s63, 98304
ds_read_b128 v[144:147], v24 offset:8192
v_mfma_f32_16x16x32_bf16 a[28:31], v[224:227], v[220:223], a[28:31]
s_add_u32 s72, s69, 0
buffer_load_dwordx4 v2, s[8:11], s72 offen lds
v_mfma_f32_16x16x32_bf16 a[60:63], v[228:231], v[220:223], a[60:63]
s_add_u32 s72, s69, 7168
buffer_load_dwordx4 v3, s[8:11], s72 offen offset:1024 lds
v_mfma_f32_16x16x32_bf16 a[56:59], v[228:231], v[216:219], a[56:59]
s_add_u32 s72, s69, 14336
buffer_load_dwordx4 v2, s[8:11], s72 offen offset:2048 lds
v_mfma_f32_16x16x32_bf16 a[52:55], v[228:231], v[212:215], a[52:55]
s_mul_i32 s74, s58, 4352
ds_read_b128 v[148:151], v24 offset:10240
v_mfma_f32_16x16x32_bf16 a[48:51], v[228:231], v[208:211], a[48:51]
s_add_u32 s74, s74, 131072
ds_read_b128 v[152:155], v24 offset:12288
v_lshrrev_b32 v26, 4, v0
v_mfma_f32_16x16x32_bf16 a[44:47], v[228:231], v[204:207], a[44:47]
s_add_u32 s72, s69, 21504
buffer_load_dwordx4 v3, s[8:11], s72 offen offset:3072 lds
v_mfma_f32_16x16x32_bf16 a[40:43], v[228:231], v[200:203], a[40:43]
ds_read_b128 v[156:159], v24 offset:14336
v_and_b32 v27, 15, v0
v_mfma_f32_16x16x32_bf16 a[36:39], v[228:231], v[196:199], a[36:39]
ds_read_b64_tr_b16 v[164:165], v21 offset:0
v_lshlrev_b32 v27, 4, v27
v_mfma_f32_16x16x32_bf16 a[32:35], v[228:231], v[192:195], a[32:35]
ds_read_b64_tr_b16 v[166:167], v21 offset:1024
v_mul_u32_u24 v28, 272, v26
v_mfma_f32_16x16x32_bf16 a[64:67], v[232:235], v[192:195], a[64:67]
ds_read_b64_tr_b16 v[168:169], v22 offset:0
v_add3_u32 v28, v28, v27, s74
v_mfma_f32_16x16x32_bf16 a[68:71], v[232:235], v[196:199], a[68:71]
s_add_u32 m0, s64, 32768
ds_read_b64_tr_b16 v[170:171], v22 offset:1024
v_lshl_add_u32 v26, v26, 12, v27
v_mfma_f32_16x16x32_bf16 a[72:75], v[232:235], v[200:203], a[72:75]
s_add_u32 s72, s71, 0
buffer_load_dwordx4 v6, s[16:19], s72 offen lds
v_mfma_f32_16x16x32_bf16 a[76:79], v[232:235], v[204:207], a[76:79]
ds_read_b64_tr_b16 v[172:173], v23 offset:0
ds_read_b128 v[32:35], v28 offset:0
v_mfma_f32_16x16x32_bf16 a[80:83], v[232:235], v[208:211], a[80:83]
ds_read_b64_tr_b16 v[174:175], v23 offset:1024
ds_read_b128 v[36:39], v28 offset:1088
v_mfma_f32_16x16x32_bf16 a[84:87], v[232:235], v[212:215], a[84:87]
s_add_u32 s72, s71, 31744
buffer_load_dwordx4 v6, s[16:19], s72 offen offset:1024 lds
v_mfma_f32_16x16x32_bf16 a[88:91], v[232:235], v[216:219], a[88:91]
ds_read_b64_tr_b16 v[176:177], v20 offset:16384
ds_read_b128 v[40:43], v28 offset:2176
v_mfma_f32_16x16x32_bf16 a[92:95], v[232:235], v[220:223], a[92:95]
ds_read_b64_tr_b16 v[178:179], v20 offset:17408
ds_read_b128 v[44:47], v28 offset:3264
v_mfma_f32_16x16x32_bf16 a[124:127], v[236:239], v[220:223], a[124:127]
s_and_b32 s74, s2, 15
ds_read_b64_tr_b16 v[180:181], v21 offset:16384
v_mfma_f32_16x16x32_bf16 a[120:123], v[236:239], v[216:219], a[120:123]
s_add_u32 s72, s71, 63488
buffer_load_dwordx4 v7, s[16:19], s72 offen offset:2048 lds
v_mfma_f32_16x16x32_bf16 a[116:119], v[236:239], v[212:215], a[116:119]
s_lshl_b32 s74, s74, 2
ds_read_b64_tr_b16 v[182:183], v21 offset:17408
v_mfma_f32_16x16x32_bf16 a[112:115], v[236:239], v[208:211], a[112:115]
s_add_u32 s74, s74, s58
ds_read_b64_tr_b16 v[184:185], v22 offset:16384
v_mfma_f32_16x16x32_bf16 a[108:111], v[236:239], v[204:207], a[108:111]
s_lshl_b32 s74, s74, 16
ds_read_b64_tr_b16 v[186:187], v22 offset:17408
v_mfma_f32_16x16x32_bf16 a[104:107], v[236:239], v[200:203], a[104:107]
s_lshr_b32 s75, s2, 4
ds_read_b64_tr_b16 v[188:189], v23 offset:16384
v_mfma_f32_16x16x32_bf16 a[100:103], v[236:239], v[196:199], a[100:103]
s_add_u32 s72, s71, 95232
buffer_load_dwordx4 v7, s[16:19], s72 offen offset:3072 lds
v_mfma_f32_16x16x32_bf16 a[96:99], v[236:239], v[192:195], a[96:99]
s_lshl_b32 s75, s75, 8
ds_read_b64_tr_b16 v[190:191], v23 offset:17408
v_mfma_f32_16x16x32_bf16 a[128:131], v[192:195], v[240:243], a[128:131]
s_sub_u32 s74, s74, s75
v_mfma_f32_16x16x32_bf16 a[132:135], v[196:199], v[240:243], a[132:135]
s_add_u32 s74, s74, 0x3000f00
v_mfma_f32_16x16x32_bf16 a[136:139], v[200:203], v[240:243], a[136:139]
s_add_u32 m0, s63, 102400
v_mfma_f32_16x16x32_bf16 a[140:143], v[204:207], v[240:243], a[140:143]
s_add_u32 s72, s69, 32768
buffer_load_dwordx4 v2, s[8:11], s72 offen lds
v_mfma_f32_16x16x32_bf16 a[144:147], v[208:211], v[240:243], a[144:147]
s_waitcnt lgkmcnt(6)
buffer_store_dwordx4 v[32:35], v26, s[44:47], s74 offen sc1
v_mfma_f32_16x16x32_bf16 a[148:151], v[212:215], v[240:243], a[148:151]
s_add_u32 s74, s74, 0x4000
buffer_store_dwordx4 v[36:39], v26, s[44:47], s74 offen sc1
v_mfma_f32_16x16x32_bf16 a[152:155], v[216:219], v[240:243], a[152:155]
s_add_u32 s72, s69, 39936
buffer_load_dwordx4 v3, s[8:11], s72 offen offset:1024 lds
v_mfma_f32_16x16x32_bf16 a[156:159], v[220:223], v[240:243], a[156:159]
s_add_u32 s74, s74, 0x4000
buffer_store_dwordx4 v[40:43], v26, s[44:47], s74 offen sc1
v_mfma_f32_16x16x32_bf16 a[188:191], v[220:223], v[244:247], a[188:191]
s_add_u32 s74, s74, 0x4000
buffer_store_dwordx4 v[44:47], v26, s[44:47], s74 offen sc1
v_mfma_f32_16x16x32_bf16 a[184:187], v[216:219], v[244:247], a[184:187]
s_waitcnt vmcnt(34)
v_lshlrev_b32 v78, 16, v84
v_lshlrev_b32 v79, 16, v108
v_mfma_f32_16x16x32_bf16 a[180:183], v[212:215], v[244:247], a[180:183]
v_mul_f32 v76, v78, v79
v_lshlrev_b32 v80, 16, v116
v_mfma_f32_16x16x32_bf16 a[176:179], v[208:211], v[244:247], a[176:179]
s_add_u32 s72, s69, 47104
buffer_load_dwordx4 v2, s[8:11], s72 offen offset:2048 lds
v_mfma_f32_16x16x32_bf16 a[172:175], v[204:207], v[244:247], a[172:175]
v_mul_f32 v77, v78, v80
v_and_b32 v78, 0xffff0000, v84
v_mfma_f32_16x16x32_bf16 a[168:171], v[200:203], v[244:247], a[168:171]
v_and_b32 v79, 0xffff0000, v108
v_fmac_f32 v76, v78, v79
v_mfma_f32_16x16x32_bf16 a[164:167], v[196:199], v[244:247], a[164:167]
v_and_b32 v80, 0xffff0000, v116
v_fmac_f32 v77, v78, v80
v_mfma_f32_16x16x32_bf16 a[160:163], v[192:195], v[244:247], a[160:163]
s_add_u32 s72, s69, 54272
buffer_load_dwordx4 v3, s[8:11], s72 offen offset:3072 lds
v_mfma_f32_16x16x32_bf16 a[192:195], v[192:195], v[248:251], a[192:195]
v_lshlrev_b32 v78, 16, v85
v_lshlrev_b32 v79, 16, v109
v_mfma_f32_16x16x32_bf16 a[196:199], v[196:199], v[248:251], a[196:199]
v_fmac_f32 v76, v78, v79
v_lshlrev_b32 v80, 16, v117
v_mfma_f32_16x16x32_bf16 a[200:203], v[200:203], v[248:251], a[200:203]
v_fmac_f32 v77, v78, v80
v_and_b32 v78, 0xffff0000, v85
v_mfma_f32_16x16x32_bf16 a[204:207], v[204:207], v[248:251], a[204:207]
s_add_u32 m0, s64, 49152
v_and_b32 v79, 0xffff0000, v109
v_fmac_f32 v76, v78, v79
v_mfma_f32_16x16x32_bf16 a[208:211], v[208:211], v[248:251], a[208:211]
s_add_u32 s72, s71, 0
buffer_load_dwordx4 v6, s[20:23], s72 offen lds
v_mfma_f32_16x16x32_bf16 a[212:215], v[212:215], v[248:251], a[212:215]
v_and_b32 v80, 0xffff0000, v117
v_fmac_f32 v77, v78, v80
v_mfma_f32_16x16x32_bf16 a[216:219], v[216:219], v[248:251], a[216:219]
v_lshlrev_b32 v78, 16, v86
v_lshlrev_b32 v79, 16, v110
v_mfma_f32_16x16x32_bf16 a[220:223], v[220:223], v[248:251], a[220:223]
v_fmac_f32 v76, v78, v79
v_lshlrev_b32 v80, 16, v118
v_mfma_f32_16x16x32_bf16 a[252:255], v[220:223], v[252:255], a[252:255]
s_add_u32 s72, s71, 31744
buffer_load_dwordx4 v6, s[20:23], s72 offen offset:1024 lds
v_mfma_f32_16x16x32_bf16 a[248:251], v[216:219], v[252:255], a[248:251]
v_fmac_f32 v77, v78, v80
v_and_b32 v78, 0xffff0000, v86
v_mfma_f32_16x16x32_bf16 a[244:247], v[212:215], v[252:255], a[244:247]
v_and_b32 v79, 0xffff0000, v110
v_fmac_f32 v76, v78, v79
v_mfma_f32_16x16x32_bf16 a[240:243], v[208:211], v[252:255], a[240:243]
v_and_b32 v80, 0xffff0000, v118
v_fmac_f32 v77, v78, v80
v_mfma_f32_16x16x32_bf16 a[236:239], v[204:207], v[252:255], a[236:239]
s_add_u32 s72, s71, 63488
buffer_load_dwordx4 v7, s[20:23], s72 offen offset:2048 lds
v_mfma_f32_16x16x32_bf16 a[232:235], v[200:203], v[252:255], a[232:235]
v_lshlrev_b32 v78, 16, v87
v_lshlrev_b32 v79, 16, v111
v_mfma_f32_16x16x32_bf16 a[228:231], v[196:199], v[252:255], a[228:231]
v_fmac_f32 v76, v78, v79
v_lshlrev_b32 v80, 16, v119
v_mfma_f32_16x16x32_bf16 a[224:227], v[192:195], v[252:255], a[224:227]
s_waitcnt lgkmcnt(0)
v_fmac_f32 v77, v78, v80
v_and_b32 v78, 0xffff0000, v87
v_mfma_f32_16x16x32_bf16 a[0:3], v[160:163], v[128:131], a[0:3]
s_add_u32 s72, s71, 95232
buffer_load_dwordx4 v7, s[20:23], s72 offen offset:3072 lds
v_mfma_f32_16x16x32_bf16 a[4:7], v[160:163], v[132:135], a[4:7]
ds_read_b64_tr_b16 v[224:225], v20 offset:8192
v_and_b32 v79, 0xffff0000, v111
v_mfma_f32_16x16x32_bf16 a[8:11], v[160:163], v[136:139], a[8:11]
v_fmac_f32 v76, v78, v79
v_and_b32 v80, 0xffff0000, v119
v_mfma_f32_16x16x32_bf16 a[12:15], v[160:163], v[140:143], a[12:15]
ds_read_b64_tr_b16 v[226:227], v20 offset:9216
v_fmac_f32 v77, v78, v80
v_mfma_f32_16x16x32_bf16 a[16:19], v[160:163], v[144:147], a[16:19]
v_lshlrev_b32 v78, 16, v88
v_lshlrev_b32 v79, 16, v112
v_mfma_f32_16x16x32_bf16 a[20:23], v[160:163], v[148:151], a[20:23]
ds_read_b128 v[192:195], v25 offset:0
v_fmac_f32 v76, v78, v79
v_mfma_f32_16x16x32_bf16 a[24:27], v[160:163], v[152:155], a[24:27]
v_lshlrev_b32 v80, 16, v120
v_fmac_f32 v77, v78, v80
v_mfma_f32_16x16x32_bf16 a[28:31], v[160:163], v[156:159], a[28:31]
ds_read_b128 v[196:199], v25 offset:2048
v_and_b32 v78, 0xffff0000, v88
v_mfma_f32_16x16x32_bf16 a[60:63], v[164:167], v[156:159], a[60:63]
v_and_b32 v79, 0xffff0000, v112
v_fmac_f32 v76, v78, v79
v_mfma_f32_16x16x32_bf16 a[56:59], v[164:167], v[152:155], a[56:59]
ds_read_b128 v[200:203], v25 offset:4096
v_and_b32 v80, 0xffff0000, v120
v_mfma_f32_16x16x32_bf16 a[52:55], v[164:167], v[148:151], a[52:55]
v_fmac_f32 v77, v78, v80
v_lshlrev_b32 v78, 16, v89
v_mfma_f32_16x16x32_bf16 a[48:51], v[164:167], v[144:147], a[48:51]
ds_read_b128 v[204:207], v25 offset:6144
v_lshlrev_b32 v79, 16, v113
v_mfma_f32_16x16x32_bf16 a[44:47], v[164:167], v[140:143], a[44:47]
v_fmac_f32 v76, v78, v79
v_lshlrev_b32 v80, 16, v121
v_mfma_f32_16x16x32_bf16 a[40:43], v[164:167], v[136:139], a[40:43]
ds_read_b128 v[208:211], v25 offset:8192
v_fmac_f32 v77, v78, v80
v_mfma_f32_16x16x32_bf16 a[36:39], v[164:167], v[132:135], a[36:39]
v_and_b32 v78, 0xffff0000, v89
v_and_b32 v79, 0xffff0000, v113
v_mfma_f32_16x16x32_bf16 a[32:35], v[164:167], v[128:131], a[32:35]
ds_read_b128 v[212:215], v25 offset:10240
v_fmac_f32 v76, v78, v79
v_mfma_f32_16x16x32_bf16 a[64:67], v[168:171], v[128:131], a[64:67]
v_and_b32 v80, 0xffff0000, v121
v_fmac_f32 v77, v78, v80
v_mfma_f32_16x16x32_bf16 a[68:71], v[168:171], v[132:135], a[68:71]
ds_read_b128 v[216:219], v25 offset:12288
v_lshlrev_b32 v78, 16, v90
v_mfma_f32_16x16x32_bf16 a[72:75], v[168:171], v[136:139], a[72:75]
v_lshlrev_b32 v79, 16, v114
v_fmac_f32 v76, v78, v79
v_mfma_f32_16x16x32_bf16 a[76:79], v[168:171], v[140:143], a[76:79]
ds_read_b128 v[220:223], v25 offset:14336
v_lshlrev_b32 v80, 16, v122
v_mfma_f32_16x16x32_bf16 a[80:83], v[168:171], v[144:147], a[80:83]
s_lshr_b32 s75, s93, 5
v_fmac_f32 v77, v78, v80
v_and_b32 v78, 0xffff0000, v90
v_mfma_f32_16x16x32_bf16 a[84:87], v[168:171], v[148:151], a[84:87]
s_and_b32 s75, s75, 0x3f80
ds_read_b64_tr_b16 v[228:229], v21 offset:8192
v_and_b32 v79, 0xffff0000, v114
v_mfma_f32_16x16x32_bf16 a[88:91], v[168:171], v[152:155], a[88:91]
s_add_u32 s75, s75, LcB0-Lpc0
v_lshrrev_b32 v2, 6, v0
v_lshlrev_b32 v2, 7, v2
v_mfma_f32_16x16x32_bf16 a[92:95], v[168:171], v[156:159], a[92:95]
v_add_u32 v2, s75, v2
v_min_u32 v2, Lcode_end-Lpc0, v2
v_mfma_f32_16x16x32_bf16 a[124:127], v[172:175], v[156:159], a[124:127]
global_load_dword v3, v2, s[98:99]
v_mfma_f32_16x16x32_bf16 a[120:123], v[172:175], v[152:155], a[120:123]
ds_read_b64_tr_b16 v[230:231], v21 offset:9216
v_fmac_f32 v76, v78, v79
v_mfma_f32_16x16x32_bf16 a[116:119], v[172:175], v[148:151], a[116:119]
v_and_b32 v80, 0xffff0000, v122
v_fmac_f32 v77, v78, v80
v_mfma_f32_16x16x32_bf16 a[112:115], v[172:175], v[144:147], a[112:115]
ds_read_b64_tr_b16 v[232:233], v22 offset:8192
v_lshlrev_b32 v78, 16, v91
v_mfma_f32_16x16x32_bf16 a[108:111], v[172:175], v[140:143], a[108:111]
v_lshlrev_b32 v79, 16, v115
v_fmac_f32 v76, v78, v79
v_mfma_f32_16x16x32_bf16 a[104:107], v[172:175], v[136:139], a[104:107]
ds_read_b64_tr_b16 v[234:235], v22 offset:9216
v_lshlrev_b32 v80, 16, v123
v_mfma_f32_16x16x32_bf16 a[100:103], v[172:175], v[132:135], a[100:103]
v_fmac_f32 v77, v78, v80
v_and_b32 v78, 0xffff0000, v91
v_mfma_f32_16x16x32_bf16 a[96:99], v[172:175], v[128:131], a[96:99]
ds_read_b64_tr_b16 v[236:237], v23 offset:8192
v_and_b32 v79, 0xffff0000, v115
v_mfma_f32_16x16x32_bf16 a[128:131], v[128:131], v[176:179], a[128:131]
v_fmac_f32 v76, v78, v79
v_and_b32 v80, 0xffff0000, v123
v_mfma_f32_16x16x32_bf16 a[132:135], v[132:135], v[176:179], a[132:135]
ds_read_b64_tr_b16 v[238:239], v23 offset:9216
v_fmac_f32 v77, v78, v80
v_mfma_f32_16x16x32_bf16 a[136:139], v[136:139], v[176:179], a[136:139]
v_add_f32_dpp v76, v76, v76 row_ror:8 row_mask:0xf bank_mask:0xf
v_add_f32_dpp v77, v77, v77 row_ror:8 row_mask:0xf bank_mask:0xf
v_mfma_f32_16x16x32_bf16 a[140:143], v[140:143], v[176:179], a[140:143]
ds_read_b64_tr_b16 v[240:241], v20 offset:24576
v_add_f32_dpp v76, v76, v76 row_ror:4 row_mask:0xf bank_mask:0xf
v_mfma_f32_16x16x32_bf16 a[144:147], v[144:147], v[176:179], a[144:147]
v_add_f32_dpp v77, v77, v77 row_ror:4 row_mask:0xf bank_mask:0xf
v_add_f32_dpp v76, v76, v76 row_ror:2 row_mask:0xf bank_mask:0xf
v_mfma_f32_16x16x32_bf16 a[148:151], v[148:151], v[176:179], a[148:151]
ds_read_b64_tr_b16 v[242:243], v20 offset:25600
v_add_f32_dpp v77, v77, v77 row_ror:2 row_mask:0xf bank_mask:0xf
v_mfma_f32_16x16x32_bf16 a[152:155], v[152:155], v[176:179], a[152:155]
v_add_f32_dpp v76, v76, v76 row_ror:1 row_mask:0xf bank_mask:0xf
v_add_f32_dpp v77, v77, v77 row_ror:1 row_mask:0xf bank_mask:0xf
v_mfma_f32_16x16x32_bf16 a[156:159], v[156:159], v[176:179], a[156:159]
ds_read_b64_tr_b16 v[244:245], v21 offset:24576
v_mov_b32 v78, v76
v_mfma_f32_16x16x32_bf16 a[188:191], v[156:159], v[180:183], a[188:191]
v_mov_b32 v79, v77
v_permlane16_swap_b32 v76, v78
v_mfma_f32_16x16x32_bf16 a[184:187], v[152:155], v[180:183], a[184:187]
ds_read_b64_tr_b16 v[246:247], v21 offset:25600
v_permlane16_swap_b32 v77, v79
v_mfma_f32_16x16x32_bf16 a[180:183], v[148:151], v[180:183], a[180:183]
v_add_f32 v76, v76, v78
v_add_f32 v77, v77, v79
v_mfma_f32_16x16x32_bf16 a[176:179], v[144:147], v[180:183], a[176:179]
ds_read_b64_tr_b16 v[248:249], v22 offset:24576
v_mov_b32 v78, v76
v_mfma_f32_16x16x32_bf16 a[172:175], v[140:143], v[180:183], a[172:175]
v_mov_b32 v79, v77
v_permlane32_swap_b32 v76, v78
v_mfma_f32_16x16x32_bf16 a[168:171], v[136:139], v[180:183], a[168:171]
ds_read_b64_tr_b16 v[250:251], v22 offset:25600
v_permlane32_swap_b32 v77, v79
v_mfma_f32_16x16x32_bf16 a[164:167], v[132:135], v[180:183], a[164:167]
v_add_f32 v76, v76, v78
v_add_f32 v77, v77, v79
v_mfma_f32_16x16x32_bf16 a[160:163], v[128:131], v[180:183], a[160:163]
ds_read_b64_tr_b16 v[252:253], v23 offset:24576
v_mul_f32 v76, 0xbfb8aa3b, v76
v_mfma_f32_16x16x32_bf16 a[192:195], v[128:131], v[184:187], a[192:195]
v_mul_f32 v77, 0xbfb8aa3b, v77
v_mfma_f32_16x16x32_bf16 a[196:199], v[132:135], v[184:187], a[196:199]
ds_read_b64_tr_b16 v[254:255], v23 offset:25600
v_mfma_f32_16x16x32_bf16 a[200:203], v[136:139], v[184:187], a[200:203]
v_exp_f32 v76, v76
v_mfma_f32_16x16x32_bf16 a[204:207], v[140:143], v[184:187], a[204:207]
v_exp_f32 v77, v77
v_mfma_f32_16x16x32_bf16 a[208:211], v[144:147], v[184:187], a[208:211]
v_add_f32 v76, 1.0, v76
v_add_f32 v77, 1.0, v77
v_mfma_f32_16x16x32_bf16 a[212:215], v[148:151], v[184:187], a[212:215]
v_rcp_f32 v76, v76
v_mfma_f32_16x16x32_bf16 a[216:219], v[152:155], v[184:187], a[216:219]
v_rcp_f32 v77, v77
v_mfma_f32_16x16x32_bf16 a[220:223], v[156:159], v[184:187], a[220:223]
s_lshr_b32 s80, s76, 9
v_mfma_f32_16x16x32_bf16 a[252:255], v[156:159], v[188:191], a[252:255]
s_add_u32 s80, s80, 0x3800000
v_min_u32 v78, 1, v0
v_lshlrev_b32 v78, 30, v78
v_mfma_f32_16x16x32_bf16 a[248:251], v[152:155], v[188:191], a[248:251]
buffer_store_dwordx2 v[76:77], v78, s[44:47], s80 offen sc1
v_mfma_f32_16x16x32_bf16 a[244:247], v[148:151], v[188:191], a[244:247]
v_mfma_f32_16x16x32_bf16 a[240:243], v[144:147], v[188:191], a[240:243]
v_mfma_f32_16x16x32_bf16 a[236:239], v[140:143], v[188:191], a[236:239]
v_mfma_f32_16x16x32_bf16 a[232:235], v[136:139], v[188:191], a[232:235]
v_mfma_f32_16x16x32_bf16 a[228:231], v[132:135], v[188:191], a[228:231]
s_waitcnt vmcnt(2) lgkmcnt(0)
v_mfma_f32_16x16x32_bf16 a[224:227], v[128:131], v[188:191], a[224:227]
s_barrier
v_mfma_f32_16x16x32_bf16 a[0:3], v[224:227], v[192:195], a[0:3]
s_add_u32 s73, s62, 0
ds_read_b64_tr_b16 v[160:161], v20 offset:32768
v_mfma_f32_16x16x32_bf16 a[4:7], v[224:227], v[196:199], a[4:7]
s_add_u32 s70, s73, s65
ds_read_b64_tr_b16 v[162:163], v20 offset:33792
v_mfma_f32_16x16x32_bf16 a[8:11], v[224:227], v[200:203], a[8:11]
s_and_b32 s70, s70, 3
ds_read_b128 v[128:131], v24 offset:32768
v_mfma_f32_16x16x32_bf16 a[12:15], v[224:227], v[204:207], a[12:15]
s_and_b32 s73, s73, 12
ds_read_b128 v[132:135], v24 offset:34816
v_mfma_f32_16x16x32_bf16 a[16:19], v[224:227], v[208:211], a[16:19]
s_or_b32 s73, s73, s70
ds_read_b128 v[136:139], v24 offset:36864
v_mfma_f32_16x16x32_bf16 a[20:23], v[224:227], v[212:215], a[20:23]
s_lshl_b32 s71, s73, 19
ds_read_b128 v[140:143], v24 offset:38912
v_mfma_f32_16x16x32_bf16 a[24:27], v[224:227], v[216:219], a[24:27]
s_add_u32 s71, s71, s66
ds_read_b128 v[144:147], v24 offset:40960
v_mfma_f32_16x16x32_bf16 a[28:31], v[224:227], v[220:223], a[28:31]
s_lshl_b32 s73, s73, 7
ds_read_b128 v[148:151], v24 offset:43008
v_mfma_f32_16x16x32_bf16 a[60:63], v[228:231], v[220:223], a[60:63]
s_add_u32 s69, s73, s67
ds_read_b128 v[152:155], v24 offset:45056
v_mfma_f32_16x16x32_bf16 a[56:59], v[228:231], v[216:219], a[56:59]
s_add_u32 s70, s73, s68
ds_read_b128 v[156:159], v24 offset:47104
v_mfma_f32_16x16x32_bf16 a[52:55], v[228:231], v[212:215], a[52:55]
s_add_u32 m0, s64, 0
ds_read_b64_tr_b16 v[164:165], v21 offset:32768
v_mfma_f32_16x16x32_bf16 a[48:51], v[228:231], v[208:211], a[48:51]
s_add_u32 s72, s71, 0
buffer_load_dwordx4 v6, s[12:15], s72 offen lds
v_mfma_f32_16x16x32_bf16 a[44:47], v[228:231], v[204:207], a[44:47]
s_add_u32 s72, s71, 31744
buffer_load_dwordx4 v6, s[12:15], s72 offen offset:1024 lds
v_mfma_f32_16x16x32_bf16 a[40:43], v[228:231], v[200:203], a[40:43]
s_add_u32 s72, s71, 63488
buffer_load_dwordx4 v7, s[12:15], s72 offen offset:2048 lds
v_mfma_f32_16x16x32_bf16 a[36:39], v[228:231], v[196:199], a[36:39]
ds_read_b64_tr_b16 v[166:167], v21 offset:33792
v_mfma_f32_16x16x32_bf16 a[32:35], v[228:231], v[192:195], a[32:35]
s_add_u32 s72, s71, 95232
buffer_load_dwordx4 v7, s[12:15], s72 offen offset:3072 lds
v_mfma_f32_16x16x32_bf16 a[64:67], v[232:235], v[192:195], a[64:67]
ds_read_b64_tr_b16 v[168:169], v22 offset:32768
v_mfma_f32_16x16x32_bf16 a[68:71], v[232:235], v[196:199], a[68:71]
ds_read_b64_tr_b16 v[170:171], v22 offset:33792
v_mfma_f32_16x16x32_bf16 a[72:75], v[232:235], v[200:203], a[72:75]
ds_read_b64_tr_b16 v[172:173], v23 offset:32768
v_mfma_f32_16x16x32_bf16 a[76:79], v[232:235], v[204:207], a[76:79]
ds_read_b64_tr_b16 v[174:175], v23 offset:33792
v_mfma_f32_16x16x32_bf16 a[80:83], v[232:235], v[208:211], a[80:83]
s_add_u32 m0, s63, 131072
ds_read_b64_tr_b16 v[176:177], v20 offset:49152
v_mfma_f32_16x16x32_bf16 a[84:87], v[232:235], v[212:215], a[84:87]
s_add_u32 s72, s69, 0
buffer_load_dwordx4 v4, s[4:7], s72 offen lds
v_mfma_f32_16x16x32_bf16 a[88:91], v[232:235], v[216:219], a[88:91]
ds_read_b64_tr_b16 v[178:179], v20 offset:50176
v_mfma_f32_16x16x32_bf16 a[92:95], v[232:235], v[220:223], a[92:95]
ds_read_b64_tr_b16 v[180:181], v21 offset:49152
v_mfma_f32_16x16x32_bf16 a[124:127], v[236:239], v[220:223], a[124:127]
ds_read_b64_tr_b16 v[182:183], v21 offset:50176
v_mfma_f32_16x16x32_bf16 a[120:123], v[236:239], v[216:219], a[120:123]
s_add_u32 s72, s69, 15360
buffer_load_dwordx4 v5, s[4:7], s72 offen offset:1024 lds
v_mfma_f32_16x16x32_bf16 a[116:119], v[236:239], v[212:215], a[116:119]
ds_read_b64_tr_b16 v[184:185], v22 offset:49152
v_mfma_f32_16x16x32_bf16 a[112:115], v[236:239], v[208:211], a[112:115]
ds_read_b64_tr_b16 v[186:187], v22 offset:50176
v_mfma_f32_16x16x32_bf16 a[108:111], v[236:239], v[204:207], a[108:111]
ds_read_b64_tr_b16 v[188:189], v23 offset:49152
v_mfma_f32_16x16x32_bf16 a[104:107], v[236:239], v[200:203], a[104:107]
ds_read_b64_tr_b16 v[190:191], v23 offset:50176
v_mfma_f32_16x16x32_bf16 a[100:103], v[236:239], v[196:199], a[100:103]
s_add_u32 s72, s69, 30720
buffer_load_dwordx4 v4, s[4:7], s72 offen offset:2048 lds
v_mfma_f32_16x16x32_bf16 a[96:99], v[236:239], v[192:195], a[96:99]
v_mfma_f32_16x16x32_bf16 a[128:131], v[192:195], v[240:243], a[128:131]
v_mfma_f32_16x16x32_bf16 a[132:135], v[196:199], v[240:243], a[132:135]
v_mfma_f32_16x16x32_bf16 a[136:139], v[200:203], v[240:243], a[136:139]
v_mfma_f32_16x16x32_bf16 a[140:143], v[204:207], v[240:243], a[140:143]
s_add_u32 s72, s69, 46080
buffer_load_dwordx4 v5, s[4:7], s72 offen offset:3072 lds
v_mfma_f32_16x16x32_bf16 a[144:147], v[208:211], v[240:243], a[144:147]
v_mfma_f32_16x16x32_bf16 a[148:151], v[212:215], v[240:243], a[148:151]
v_mfma_f32_16x16x32_bf16 a[152:155], v[216:219], v[240:243], a[152:155]
v_mfma_f32_16x16x32_bf16 a[156:159], v[220:223], v[240:243], a[156:159]
v_mfma_f32_16x16x32_bf16 a[188:191], v[220:223], v[244:247], a[188:191]
s_add_u32 m0, s63, 135168
v_mfma_f32_16x16x32_bf16 a[184:187], v[216:219], v[244:247], a[184:187]
s_add_u32 s72, s70, 0
buffer_load_dwordx4 v4, s[4:7], s72 offen lds
v_mfma_f32_16x16x32_bf16 a[180:183], v[212:215], v[244:247], a[180:183]
v_mfma_f32_16x16x32_bf16 a[176:179], v[208:211], v[244:247], a[176:179]
v_mfma_f32_16x16x32_bf16 a[172:175], v[204:207], v[244:247], a[172:175]
v_mfma_f32_16x16x32_bf16 a[168:171], v[200:203], v[244:247], a[168:171]
s_add_u32 s72, s70, 15360
buffer_load_dwordx4 v5, s[4:7], s72 offen offset:1024 lds
v_mfma_f32_16x16x32_bf16 a[164:167], v[196:199], v[244:247], a[164:167]
v_mfma_f32_16x16x32_bf16 a[160:163], v[192:195], v[244:247], a[160:163]
v_mfma_f32_16x16x32_bf16 a[192:195], v[192:195], v[248:251], a[192:195]
v_mfma_f32_16x16x32_bf16 a[196:199], v[196:199], v[248:251], a[196:199]
v_mfma_f32_16x16x32_bf16 a[200:203], v[200:203], v[248:251], a[200:203]
s_add_u32 s72, s70, 30720
buffer_load_dwordx4 v4, s[4:7], s72 offen offset:2048 lds
v_mfma_f32_16x16x32_bf16 a[204:207], v[204:207], v[248:251], a[204:207]
v_mfma_f32_16x16x32_bf16 a[208:211], v[208:211], v[248:251], a[208:211]
v_mfma_f32_16x16x32_bf16 a[212:215], v[212:215], v[248:251], a[212:215]
v_mfma_f32_16x16x32_bf16 a[216:219], v[216:219], v[248:251], a[216:219]
v_mfma_f32_16x16x32_bf16 a[220:223], v[220:223], v[248:251], a[220:223]
s_add_u32 s72, s70, 46080
buffer_load_dwordx4 v5, s[4:7], s72 offen offset:3072 lds
v_mfma_f32_16x16x32_bf16 a[252:255], v[220:223], v[252:255], a[252:255]
v_mfma_f32_16x16x32_bf16 a[248:251], v[216:219], v[252:255], a[248:251]
v_mfma_f32_16x16x32_bf16 a[244:247], v[212:215], v[252:255], a[244:247]
v_mfma_f32_16x16x32_bf16 a[240:243], v[208:211], v[252:255], a[240:243]
v_mfma_f32_16x16x32_bf16 a[236:239], v[204:207], v[252:255], a[236:239]
s_add_u32 s73, s62, 1
v_mfma_f32_16x16x32_bf16 a[232:235], v[200:203], v[252:255], a[232:235]
s_add_u32 s70, s73, s65
v_mfma_f32_16x16x32_bf16 a[228:231], v[196:199], v[252:255], a[228:231]
s_and_b32 s70, s70, 3
v_mfma_f32_16x16x32_bf16 a[224:227], v[192:195], v[252:255], a[224:227]
s_waitcnt lgkmcnt(0)
v_mfma_f32_16x16x32_bf16 a[0:3], v[160:163], v[128:131], a[0:3]
s_and_b32 s73, s73, 12
ds_read_b64_tr_b16 v[224:225], v20 offset:40960
v_mfma_f32_16x16x32_bf16 a[4:7], v[160:163], v[132:135], a[4:7]
s_or_b32 s73, s73, s70
ds_read_b64_tr_b16 v[226:227], v20 offset:41984
v_mfma_f32_16x16x32_bf16 a[8:11], v[160:163], v[136:139], a[8:11]
s_lshl_b32 s71, s73, 19
ds_read_b128 v[192:195], v25 offset:32768
v_mfma_f32_16x16x32_bf16 a[12:15], v[160:163], v[140:143], a[12:15]
s_add_u32 s71, s71, s66
ds_read_b128 v[196:199], v25 offset:34816
v_mfma_f32_16x16x32_bf16 a[16:19], v[160:163], v[144:147], a[16:19]
s_lshl_b32 s73, s73, 7
ds_read_b128 v[200:203], v25 offset:36864
v_mfma_f32_16x16x32_bf16 a[20:23], v[160:163], v[148:151], a[20:23]
s_add_u32 s69, s73, s67
ds_read_b128 v[204:207], v25 offset:38912
v_mfma_f32_16x16x32_bf16 a[24:27], v[160:163], v[152:155], a[24:27]
s_add_u32 s70, s73, s68
ds_read_b128 v[208:211], v25 offset:40960
v_mfma_f32_16x16x32_bf16 a[28:31], v[160:163], v[156:159], a[28:31]
s_add_u32 m0, s64, 16384
ds_read_b128 v[212:215], v25 offset:43008
v_mfma_f32_16x16x32_bf16 a[60:63], v[164:167], v[156:159], a[60:63]
s_add_u32 s72, s71, 0
buffer_load_dwordx4 v6, s[12:15], s72 offen lds
v_mfma_f32_16x16x32_bf16 a[56:59], v[164:167], v[152:155], a[56:59]
s_add_u32 s72, s71, 31744
buffer_load_dwordx4 v6, s[12:15], s72 offen offset:1024 lds
v_mfma_f32_16x16x32_bf16 a[52:55], v[164:167], v[148:151], a[52:55]
s_add_u32 s72, s71, 63488
buffer_load_dwordx4 v7, s[12:15], s72 offen offset:2048 lds
v_mfma_f32_16x16x32_bf16 a[48:51], v[164:167], v[144:147], a[48:51]
s_add_u32 s72, s71, 95232
buffer_load_dwordx4 v7, s[12:15], s72 offen offset:3072 lds
v_mfma_f32_16x16x32_bf16 a[44:47], v[164:167], v[140:143], a[44:47]
ds_read_b128 v[216:219], v25 offset:45056
v_mfma_f32_16x16x32_bf16 a[40:43], v[164:167], v[136:139], a[40:43]
ds_read_b128 v[220:223], v25 offset:47104
v_mfma_f32_16x16x32_bf16 a[36:39], v[164:167], v[132:135], a[36:39]
ds_read_b64_tr_b16 v[228:229], v21 offset:40960
v_mfma_f32_16x16x32_bf16 a[32:35], v[164:167], v[128:131], a[32:35]
ds_read_b64_tr_b16 v[230:231], v21 offset:41984
v_mfma_f32_16x16x32_bf16 a[64:67], v[168:171], v[128:131], a[64:67]
s_add_u32 m0, s63, 65536
ds_read_b64_tr_b16 v[232:233], v22 offset:40960
v_mfma_f32_16x16x32_bf16 a[68:71], v[168:171], v[132:135], a[68:71]
s_add_u32 s72, s69, 0
buffer_load_dwordx4 v4, s[4:7], s72 offen lds
v_mfma_f32_16x16x32_bf16 a[72:75], v[168:171], v[136:139], a[72:75]
ds_read_b64_tr_b16 v[234:235], v22 offset:41984
v_mfma_f32_16x16x32_bf16 a[76:79], v[168:171], v[140:143], a[76:79]
ds_read_b64_tr_b16 v[236:237], v23 offset:40960
v_mfma_f32_16x16x32_bf16 a[80:83], v[168:171], v[144:147], a[80:83]
ds_read_b64_tr_b16 v[238:239], v23 offset:41984
v_mfma_f32_16x16x32_bf16 a[84:87], v[168:171], v[148:151], a[84:87]
s_add_u32 s72, s69, 15360
buffer_load_dwordx4 v5, s[4:7], s72 offen offset:1024 lds
v_mfma_f32_16x16x32_bf16 a[88:91], v[168:171], v[152:155], a[88:91]
ds_read_b64_tr_b16 v[240:241], v20 offset:57344
v_mfma_f32_16x16x32_bf16 a[92:95], v[168:171], v[156:159], a[92:95]
ds_read_b64_tr_b16 v[242:243], v20 offset:58368
v_mfma_f32_16x16x32_bf16 a[124:127], v[172:175], v[156:159], a[124:127]
ds_read_b64_tr_b16 v[244:245], v21 offset:57344
v_mfma_f32_16x16x32_bf16 a[120:123], v[172:175], v[152:155], a[120:123]
ds_read_b64_tr_b16 v[246:247], v21 offset:58368
v_mfma_f32_16x16x32_bf16 a[116:119], v[172:175], v[148:151], a[116:119]
s_add_u32 s72, s69, 30720
buffer_load_dwordx4 v4, s[4:7], s72 offen offset:2048 lds
v_mfma_f32_16x16x32_bf16 a[112:115], v[172:175], v[144:147], a[112:115]
ds_read_b64_tr_b16 v[248:249], v22 offset:57344
v_mfma_f32_16x16x32_bf16 a[108:111], v[172:175], v[140:143], a[108:111]
ds_read_b64_tr_b16 v[250:251], v22 offset:58368
v_mfma_f32_16x16x32_bf16 a[104:107], v[172:175], v[136:139], a[104:107]
ds_read_b64_tr_b16 v[252:253], v23 offset:57344
v_mfma_f32_16x16x32_bf16 a[100:103], v[172:175], v[132:135], a[100:103]
ds_read_b64_tr_b16 v[254:255], v23 offset:58368
v_mfma_f32_16x16x32_bf16 a[96:99], v[172:175], v[128:131], a[96:99]
s_add_u32 s72, s69, 46080
buffer_load_dwordx4 v5, s[4:7], s72 offen offset:3072 lds
v_mfma_f32_16x16x32_bf16 a[128:131], v[128:131], v[176:179], a[128:131]
v_mfma_f32_16x16x32_bf16 a[132:135], v[132:135], v[176:179], a[132:135]
v_mfma_f32_16x16x32_bf16 a[136:139], v[136:139], v[176:179], a[136:139]
v_mfma_f32_16x16x32_bf16 a[140:143], v[140:143], v[176:179], a[140:143]
v_mfma_f32_16x16x32_bf16 a[144:147], v[144:147], v[176:179], a[144:147]
s_add_u32 m0, s63, 69632
v_mfma_f32_16x16x32_bf16 a[148:151], v[148:151], v[176:179], a[148:151]
s_add_u32 s72, s70, 0
buffer_load_dwordx4 v4, s[4:7], s72 offen lds
v_mfma_f32_16x16x32_bf16 a[152:155], v[152:155], v[176:179], a[152:155]
v_mfma_f32_16x16x32_bf16 a[156:159], v[156:159], v[176:179], a[156:159]
v_mfma_f32_16x16x32_bf16 a[188:191], v[156:159], v[180:183], a[188:191]
v_mfma_f32_16x16x32_bf16 a[184:187], v[152:155], v[180:183], a[184:187]
s_add_u32 s72, s70, 15360
buffer_load_dwordx4 v5, s[4:7], s72 offen offset:1024 lds
v_mfma_f32_16x16x32_bf16 a[180:183], v[148:151], v[180:183], a[180:183]
v_mfma_f32_16x16x32_bf16 a[176:179], v[144:147], v[180:183], a[176:179]
v_mfma_f32_16x16x32_bf16 a[172:175], v[140:143], v[180:183], a[172:175]
v_mfma_f32_16x16x32_bf16 a[168:171], v[136:139], v[180:183], a[168:171]
v_mfma_f32_16x16x32_bf16 a[164:167], v[132:135], v[180:183], a[164:167]
s_add_u32 s72, s70, 30720
buffer_load_dwordx4 v4, s[4:7], s72 offen offset:2048 lds
v_mfma_f32_16x16x32_bf16 a[160:163], v[128:131], v[180:183], a[160:163]
v_mfma_f32_16x16x32_bf16 a[192:195], v[128:131], v[184:187], a[192:195]
v_mfma_f32_16x16x32_bf16 a[196:199], v[132:135], v[184:187], a[196:199]
v_mfma_f32_16x16x32_bf16 a[200:203], v[136:139], v[184:187], a[200:203]
v_mfma_f32_16x16x32_bf16 a[204:207], v[140:143], v[184:187], a[204:207]
s_add_u32 s72, s70, 46080
buffer_load_dwordx4 v5, s[4:7], s72 offen offset:3072 lds
v_mfma_f32_16x16x32_bf16 a[208:211], v[144:147], v[184:187], a[208:211]
v_mfma_f32_16x16x32_bf16 a[212:215], v[148:151], v[184:187], a[212:215]
v_mfma_f32_16x16x32_bf16 a[216:219], v[152:155], v[184:187], a[216:219]
v_mfma_f32_16x16x32_bf16 a[220:223], v[156:159], v[184:187], a[220:223]
v_mfma_f32_16x16x32_bf16 a[252:255], v[156:159], v[188:191], a[252:255]
v_mfma_f32_16x16x32_bf16 a[248:251], v[152:155], v[188:191], a[248:251]
v_mfma_f32_16x16x32_bf16 a[244:247], v[148:151], v[188:191], a[244:247]
v_mfma_f32_16x16x32_bf16 a[240:243], v[144:147], v[188:191], a[240:243]
v_mfma_f32_16x16x32_bf16 a[236:239], v[140:143], v[188:191], a[236:239]
v_mfma_f32_16x16x32_bf16 a[232:235], v[136:139], v[188:191], a[232:235]
v_mfma_f32_16x16x32_bf16 a[228:231], v[132:135], v[188:191], a[228:231]
s_waitcnt vmcnt(12) lgkmcnt(0)
v_mfma_f32_16x16x32_bf16 a[224:227], v[128:131], v[188:191], a[224:227]
s_barrier
LcB0:
v_mfma_f32_16x16x32_bf16 a[0:3], v[224:227], v[192:195], a[0:3]
s_add_u32 s73, s62, 2
ds_read_b64_tr_b16 v[32:33], v8 offset:0
v_mfma_f32_16x16x32_bf16 a[4:7], v[224:227], v[196:199], a[4:7]
s_add_u32 s70, s73, s65
ds_read_b64_tr_b16 v[34:35], v8 offset:1024
v_mfma_f32_16x16x32_bf16 a[8:11], v[224:227], v[200:203], a[8:11]
s_and_b32 s70, s70, 3
ds_read_b128 v[64:67], v16 offset:0
v_mfma_f32_16x16x32_bf16 a[12:15], v[224:227], v[204:207], a[12:15]
s_and_b32 s73, s73, 12
ds_read_b128 v[68:71], v16 offset:2048
v_mfma_f32_16x16x32_bf16 a[16:19], v[224:227], v[208:211], a[16:19]
s_or_b32 s73, s73, s70
ds_read_b128 v[72:75], v16 offset:4096
v_mfma_f32_16x16x32_bf16 a[20:23], v[224:227], v[212:215], a[20:23]
s_lshl_b32 s71, s73, 19
ds_read_b128 v[76:79], v16 offset:6144
v_mfma_f32_16x16x32_bf16 a[24:27], v[224:227], v[216:219], a[24:27]
s_add_u32 s71, s71, s66
ds_read_b64_tr_b16 v[36:37], v9 offset:0
v_mfma_f32_16x16x32_bf16 a[28:31], v[224:227], v[220:223], a[28:31]
s_lshl_b32 s73, s73, 7
ds_read_b64_tr_b16 v[38:39], v9 offset:1024
v_mfma_f32_16x16x32_bf16 a[60:63], v[228:231], v[220:223], a[60:63]
s_add_u32 s69, s73, s67
ds_read_b64_tr_b16 v[40:41], v10 offset:0
v_mfma_f32_16x16x32_bf16 a[56:59], v[228:231], v[216:219], a[56:59]
s_add_u32 s70, s73, s68
ds_read_b64_tr_b16 v[42:43], v10 offset:1024
v_mfma_f32_16x16x32_bf16 a[52:55], v[228:231], v[212:215], a[52:55]
s_add_u32 m0, s64, 32768
ds_read_b64_tr_b16 v[44:45], v11 offset:0
v_mfma_f32_16x16x32_bf16 a[48:51], v[228:231], v[208:211], a[48:51]
s_add_u32 s72, s71, 0
buffer_load_dwordx4 v6, s[12:15], s72 offen lds
v_mfma_f32_16x16x32_bf16 a[44:47], v[228:231], v[204:207], a[44:47]
s_add_u32 s72, s71, 31744
buffer_load_dwordx4 v6, s[12:15], s72 offen offset:1024 lds
v_mfma_f32_16x16x32_bf16 a[40:43], v[228:231], v[200:203], a[40:43]
s_add_u32 s72, s71, 63488
buffer_load_dwordx4 v7, s[12:15], s72 offen offset:2048 lds
v_mfma_f32_16x16x32_bf16 a[36:39], v[228:231], v[196:199], a[36:39]
s_lshl_b32 s80, s59, 2
ds_read_b64_tr_b16 v[46:47], v11 offset:1024
v_or_b32 v26, s58, v0
v_mfma_f32_16x16x32_bf16 a[32:35], v[228:231], v[192:195], a[32:35]
s_add_u32 s72, s71, 95232
buffer_load_dwordx4 v7, s[12:15], s72 offen offset:3072 lds
v_mfma_f32_16x16x32_bf16 a[64:67], v[232:235], v[192:195], a[64:67]
ds_read_b64_tr_b16 v[48:49], v12 offset:0
v_mov_b32 v27, 1
v_mfma_f32_16x16x32_bf16 a[68:71], v[232:235], v[196:199], a[68:71]
ds_read_b64_tr_b16 v[50:51], v12 offset:1024
v_lshlrev_b32 v26, 8, v26
v_mfma_f32_16x16x32_bf16 a[72:75], v[232:235], v[200:203], a[72:75]
ds_read_b64_tr_b16 v[52:53], v13 offset:0
v_mfma_f32_16x16x32_bf16 a[76:79], v[232:235], v[204:207], a[76:79]
ds_read_b64_tr_b16 v[54:55], v13 offset:1024
v_mfma_f32_16x16x32_bf16 a[80:83], v[232:235], v[208:211], a[80:83]
s_add_u32 m0, s63, 98304
ds_read_b64_tr_b16 v[56:57], v14 offset:0
v_mfma_f32_16x16x32_bf16 a[84:87], v[232:235], v[212:215], a[84:87]
s_add_u32 s72, s69, 0
buffer_load_dwordx4 v4, s[4:7], s72 offen lds
v_mfma_f32_16x16x32_bf16 a[88:91], v[232:235], v[216:219], a[88:91]
ds_read_b64_tr_b16 v[58:59], v14 offset:1024
v_mfma_f32_16x16x32_bf16 a[92:95], v[232:235], v[220:223], a[92:95]
ds_read_b64_tr_b16 v[60:61], v15 offset:0
v_mfma_f32_16x16x32_bf16 a[124:127], v[236:239], v[220:223], a[124:127]
ds_read_b64_tr_b16 v[62:63], v15 offset:1024
v_mfma_f32_16x16x32_bf16 a[120:123], v[236:239], v[216:219], a[120:123]
s_add_u32 s72, s69, 15360
buffer_load_dwordx4 v5, s[4:7], s72 offen offset:1024 lds
v_mfma_f32_16x16x32_bf16 a[116:119], v[236:239], v[212:215], a[116:119]
buffer_atomic_add v27, v26, s[48:51], s80 offen sc1
v_mfma_f32_16x16x32_bf16 a[112:115], v[236:239], v[208:211], a[112:115]
v_mfma_f32_16x16x32_bf16 a[108:111], v[236:239], v[204:207], a[108:111]
v_mfma_f32_16x16x32_bf16 a[104:107], v[236:239], v[200:203], a[104:107]
v_mfma_f32_16x16x32_bf16 a[100:103], v[236:239], v[196:199], a[100:103]
s_add_u32 s72, s69, 30720
buffer_load_dwordx4 v4, s[4:7], s72 offen offset:2048 lds
v_mfma_f32_16x16x32_bf16 a[96:99], v[236:239], v[192:195], a[96:99]
v_mfma_f32_16x16x32_bf16 a[128:131], v[192:195], v[240:243], a[128:131]
v_mfma_f32_16x16x32_bf16 a[132:135], v[196:199], v[240:243], a[132:135]
v_mfma_f32_16x16x32_bf16 a[136:139], v[200:203], v[240:243], a[136:139]
v_mfma_f32_16x16x32_bf16 a[140:143], v[204:207], v[240:243], a[140:143]
s_add_u32 s72, s69, 46080
buffer_load_dwordx4 v5, s[4:7], s72 offen offset:3072 lds
v_mfma_f32_16x16x32_bf16 a[144:147], v[208:211], v[240:243], a[144:147]
v_mfma_f32_16x16x32_bf16 a[148:151], v[212:215], v[240:243], a[148:151]
v_mfma_f32_16x16x32_bf16 a[152:155], v[216:219], v[240:243], a[152:155]
v_mfma_f32_16x16x32_bf16 a[156:159], v[220:223], v[240:243], a[156:159]
v_mfma_f32_16x16x32_bf16 a[188:191], v[220:223], v[244:247], a[188:191]
s_add_u32 m0, s63, 102400
v_mfma_f32_16x16x32_bf16 a[184:187], v[216:219], v[244:247], a[184:187]
s_add_u32 s72, s70, 0
buffer_load_dwordx4 v4, s[4:7], s72 offen lds
v_mfma_f32_16x16x32_bf16 a[180:183], v[212:215], v[244:247], a[180:183]
v_mfma_f32_16x16x32_bf16 a[176:179], v[208:211], v[244:247], a[176:179]
v_mfma_f32_16x16x32_bf16 a[172:175], v[204:207], v[244:247], a[172:175]
v_mfma_f32_16x16x32_bf16 a[168:171], v[200:203], v[244:247], a[168:171]
s_add_u32 s72, s70, 15360
buffer_load_dwordx4 v5, s[4:7], s72 offen offset:1024 lds
v_mfma_f32_16x16x32_bf16 a[164:167], v[196:199], v[244:247], a[164:167]
v_mfma_f32_16x16x32_bf16 a[160:163], v[192:195], v[244:247], a[160:163]
v_mfma_f32_16x16x32_bf16 a[192:195], v[192:195], v[248:251], a[192:195]
v_mfma_f32_16x16x32_bf16 a[196:199], v[196:199], v[248:251], a[196:199]
v_mfma_f32_16x16x32_bf16 a[200:203], v[200:203], v[248:251], a[200:203]
s_add_u32 s72, s70, 30720
buffer_load_dwordx4 v4, s[4:7], s72 offen offset:2048 lds
v_mfma_f32_16x16x32_bf16 a[204:207], v[204:207], v[248:251], a[204:207]
v_mfma_f32_16x16x32_bf16 a[208:211], v[208:211], v[248:251], a[208:211]
v_mfma_f32_16x16x32_bf16 a[212:215], v[212:215], v[248:251], a[212:215]
v_mfma_f32_16x16x32_bf16 a[216:219], v[216:219], v[248:251], a[216:219]
v_mfma_f32_16x16x32_bf16 a[220:223], v[220:223], v[248:251], a[220:223]
s_add_u32 s72, s70, 46080
buffer_load_dwordx4 v5, s[4:7], s72 offen offset:3072 lds
v_mfma_f32_16x16x32_bf16 a[252:255], v[220:223], v[252:255], a[252:255]
v_mfma_f32_16x16x32_bf16 a[248:251], v[216:219], v[252:255], a[248:251]
v_mfma_f32_16x16x32_bf16 a[244:247], v[212:215], v[252:255], a[244:247]
v_mfma_f32_16x16x32_bf16 a[240:243], v[208:211], v[252:255], a[240:243]
v_mfma_f32_16x16x32_bf16 a[236:239], v[204:207], v[252:255], a[236:239]
v_mfma_f32_16x16x32_bf16 a[232:235], v[200:203], v[252:255], a[232:235]
v_mfma_f32_16x16x32_bf16 a[228:231], v[196:199], v[252:255], a[228:231]
v_mfma_f32_16x16x32_bf16 a[224:227], v[192:195], v[252:255], a[224:227]
s_waitcnt lgkmcnt(0)
v_mfma_f32_16x16x32_bf16 v[128:131], v[32:35], v[64:67], 0
ds_read_b64_tr_b16 v[80:81], v8 offset:8192
ds_read_b64_tr_b16 v[82:83], v8 offset:9216
v_mfma_f32_16x16x32_bf16 v[132:135], v[32:35], v[68:71], 0
ds_read_b128 v[112:115], v17 offset:0
ds_read_b128 v[116:119], v17 offset:2048
v_mfma_f32_16x16x32_bf16 v[136:139], v[32:35], v[72:75], 0
ds_read_b128 v[120:123], v17 offset:4096
ds_read_b128 v[124:127], v17 offset:6144
v_mfma_f32_16x16x32_bf16 v[140:143], v[32:35], v[76:79], 0
ds_read_b64_tr_b16 v[84:85], v9 offset:8192
ds_read_b64_tr_b16 v[86:87], v9 offset:9216
v_mfma_f32_16x16x32_bf16 v[156:159], v[36:39], v[76:79], 0
ds_read_b64_tr_b16 v[88:89], v10 offset:8192
v_accvgpr_read_b32 v20, a0
v_mfma_f32_16x16x32_bf16 v[152:155], v[36:39], v[72:75], 0
ds_read_b64_tr_b16 v[90:91], v10 offset:9216
v_accvgpr_read_b32 v28, a1
v_mfma_f32_16x16x32_bf16 v[148:151], v[36:39], v[68:71], 0
ds_read_b64_tr_b16 v[92:93], v11 offset:8192
v_accvgpr_read_b32 v21, a2
v_mfma_f32_16x16x32_bf16 v[144:147], v[36:39], v[64:67], 0
ds_read_b64_tr_b16 v[94:95], v11 offset:9216
v_accvgpr_read_b32 v29, a3
v_mfma_f32_16x16x32_bf16 v[160:163], v[40:43], v[64:67], 0
s_add_u32 s80, s77, 0
ds_read_b64_tr_b16 v[96:97], v12 offset:8192
v_accvgpr_read_b32 v22, a32
v_mfma_f32_16x16x32_bf16 v[164:167], v[40:43], v[68:71], 0
ds_read_b64_tr_b16 v[98:99], v12 offset:9216
v_accvgpr_read_b32 v30, a33
v_mfma_f32_16x16x32_bf16 v[168:171], v[40:43], v[72:75], 0
ds_read_b64_tr_b16 v[100:101], v13 offset:8192
v_accvgpr_read_b32 v23, a34
v_mfma_f32_16x16x32_bf16 v[172:175], v[40:43], v[76:79], 0
ds_read_b64_tr_b16 v[102:103], v13 offset:9216
v_accvgpr_read_b32 v31, a35
v_mfma_f32_16x16x32_bf16 v[188:191], v[44:47], v[76:79], 0
ds_read_b64_tr_b16 v[104:105], v14 offset:8192
v_mul_f32 v20, s79, v20
v_mfma_f32_16x16x32_bf16 v[184:187], v[44:47], v[72:75], 0
ds_read_b64_tr_b16 v[106:107], v14 offset:9216
v_mul_f32 v28, s79, v28
v_mfma_f32_16x16x32_bf16 v[180:183], v[44:47], v[68:71], 0
ds_read_b64_tr_b16 v[108:109], v15 offset:8192
v_mul_f32 v21, s79, v21
v_mfma_f32_16x16x32_bf16 v[176:179], v[44:47], v[64:67], 0
ds_read_b64_tr_b16 v[110:111], v15 offset:9216
v_mul_f32 v29, s79, v29
v_mfma_f32_16x16x32_bf16 v[192:195], v[48:51], v[64:67], 0
v_mul_f32 v22, s79, v22
v_mul_f32 v30, s79, v30
v_mfma_f32_16x16x32_bf16 v[196:199], v[48:51], v[68:71], 0
v_mul_f32 v23, s79, v23
v_mul_f32 v31, s79, v31
v_mfma_f32_16x16x32_bf16 v[200:203], v[48:51], v[72:75], 0
v_cvt_pk_bf16_f32 v20, v20, v28
v_cvt_pk_bf16_f32 v21, v21, v29
v_mfma_f32_16x16x32_bf16 v[204:207], v[48:51], v[76:79], 0
v_cvt_pk_bf16_f32 v22, v22, v30
v_cvt_pk_bf16_f32 v23, v23, v31
v_mfma_f32_16x16x32_bf16 v[220:223], v[52:55], v[76:79], 0
buffer_store_dwordx4 v[20:23], v1, s[44:47], s80 offen sc1
v_mfma_f32_16x16x32_bf16 v[216:219], v[52:55], v[72:75], 0
v_mfma_f32_16x16x32_bf16 v[212:215], v[52:55], v[68:71], 0
v_mfma_f32_16x16x32_bf16 v[208:211], v[52:55], v[64:67], 0
v_mfma_f32_16x16x32_bf16 v[224:227], v[56:59], v[64:67], 0
v_mfma_f32_16x16x32_bf16 v[228:231], v[56:59], v[68:71], 0
v_accvgpr_read_b32 v24, a128
v_accvgpr_read_b32 v28, a129
v_mfma_f32_16x16x32_bf16 v[232:235], v[56:59], v[72:75], 0
v_accvgpr_read_b32 v25, a130
v_accvgpr_read_b32 v29, a131
v_mfma_f32_16x16x32_bf16 v[236:239], v[56:59], v[76:79], 0
s_add_u32 s80, s78, 0
v_accvgpr_read_b32 v26, a132
v_accvgpr_read_b32 v30, a133
v_mfma_f32_16x16x32_bf16 v[252:255], v[60:63], v[76:79], 0
v_accvgpr_read_b32 v27, a134
v_accvgpr_read_b32 v31, a135
v_mfma_f32_16x16x32_bf16 v[248:251], v[60:63], v[72:75], 0
v_cvt_pk_bf16_f32 v24, v24, v28
v_cvt_pk_bf16_f32 v25, v25, v29
v_mfma_f32_16x16x32_bf16 v[244:247], v[60:63], v[68:71], 0
s_waitcnt vmcnt(14) lgkmcnt(0)
v_cvt_pk_bf16_f32 v26, v26, v30
v_cvt_pk_bf16_f32 v27, v27, v31
v_mfma_f32_16x16x32_bf16 v[240:243], v[60:63], v[64:67], 0
s_barrier
buffer_store_dwordx4 v[24:27], v1, s[44:47], s80 offen sc1
v_mfma_f32_16x16x32_bf16 v[128:131], v[80:83], v[112:115], v[128:131]
s_add_u32 s73, s62, 3
ds_read_b64_tr_b16 v[32:33], v8 offset:16384
ds_read_b64_tr_b16 v[34:35], v8 offset:17408
v_mfma_f32_16x16x32_bf16 v[132:135], v[80:83], v[116:119], v[132:135]
s_add_u32 s70, s73, s65
ds_read_b128 v[64:67], v18 offset:0
ds_read_b128 v[68:71], v18 offset:2048
v_mfma_f32_16x16x32_bf16 v[136:139], v[80:83], v[120:123], v[136:139]
s_and_b32 s70, s70, 3
ds_read_b128 v[72:75], v18 offset:4096
ds_read_b128 v[76:79], v18 offset:6144
v_mfma_f32_16x16x32_bf16 v[140:143], v[80:83], v[124:127], v[140:143]
s_and_b32 s73, s73, 12
ds_read_b64_tr_b16 v[36:37], v9 offset:16384
ds_read_b64_tr_b16 v[38:39], v9 offset:17408
v_mfma_f32_16x16x32_bf16 v[156:159], v[84:87], v[124:127], v[156:159]
s_or_b32 s73, s73, s70
ds_read_b64_tr_b16 v[40:41], v10 offset:16384
v_mfma_f32_16x16x32_bf16 v[152:155], v[84:87], v[120:123], v[152:155]
s_lshl_b32 s71, s73, 19
ds_read_b64_tr_b16 v[42:43], v10 offset:17408
v_mfma_f32_16x16x32_bf16 v[148:151], v[84:87], v[116:119], v[148:151]
s_add_u32 s71, s71, s66
ds_read_b64_tr_b16 v[44:45], v11 offset:16384
v_mfma_f32_16x16x32_bf16 v[144:147], v[84:87], v[112:115], v[144:147]
s_lshl_b32 s73, s73, 7
ds_read_b64_tr_b16 v[46:47], v11 offset:17408
v_mfma_f32_16x16x32_bf16 v[160:163], v[88:91], v[112:115], v[160:163]
s_add_u32 s69, s73, s67
ds_read_b64_tr_b16 v[48:49], v12 offset:16384
v_mfma_f32_16x16x32_bf16 v[164:167], v[88:91], v[116:119], v[164:167]
s_add_u32 s70, s73, s68
ds_read_b64_tr_b16 v[50:51], v12 offset:17408
v_mfma_f32_16x16x32_bf16 v[168:171], v[88:91], v[120:123], v[168:171]
s_add_u32 m0, s64, 0
ds_read_b64_tr_b16 v[52:53], v13 offset:16384
v_mfma_f32_16x16x32_bf16 v[172:175], v[88:91], v[124:127], v[172:175]
s_add_u32 s72, s71, 0
buffer_load_dwordx4 v6, s[12:15], s72 offen lds
v_mfma_f32_16x16x32_bf16 v[188:191], v[92:95], v[124:127], v[188:191]
s_add_u32 s72, s71, 31744
buffer_load_dwordx4 v6, s[12:15], s72 offen offset:1024 lds
v_mfma_f32_16x16x32_bf16 v[184:187], v[92:95], v[120:123], v[184:187]
s_add_u32 s72, s71, 63488
buffer_load_dwordx4 v7, s[12:15], s72 offen offset:2048 lds
v_mfma_f32_16x16x32_bf16 v[180:183], v[92:95], v[116:119], v[180:183]
s_add_u32 s72, s71, 95232
buffer_load_dwordx4 v7, s[12:15], s72 offen offset:3072 lds
v_mfma_f32_16x16x32_bf16 v[176:179], v[92:95], v[112:115], v[176:179]
ds_read_b64_tr_b16 v[54:55], v13 offset:17408
v_mfma_f32_16x16x32_bf16 v[192:195], v[96:99], v[112:115], v[192:195]
ds_read_b64_tr_b16 v[56:57], v14 offset:16384
v_mfma_f32_16x16x32_bf16 v[196:199], v[96:99], v[116:119], v[196:199]
ds_read_b64_tr_b16 v[58:59], v14 offset:17408
v_accvgpr_read_b32 v20, a4
v_mfma_f32_16x16x32_bf16 v[200:203], v[96:99], v[120:123], v[200:203]
ds_read_b64_tr_b16 v[60:61], v15 offset:16384
v_accvgpr_read_b32 v28, a5
v_mfma_f32_16x16x32_bf16 v[204:207], v[96:99], v[124:127], v[204:207]
s_add_u32 m0, s63, 131072
ds_read_b64_tr_b16 v[62:63], v15 offset:17408
v_accvgpr_read_b32 v21, a6
v_mfma_f32_16x16x32_bf16 v[220:223], v[100:103], v[124:127], v[220:223]
s_add_u32 s72, s69, 0
buffer_load_dwordx4 v4, s[4:7], s72 offen lds
v_mfma_f32_16x16x32_bf16 v[216:219], v[100:103], v[120:123], v[216:219]
v_accvgpr_read_b32 v29, a7
v_mfma_f32_16x16x32_bf16 v[212:215], v[100:103], v[116:119], v[212:215]
s_add_u32 s80, s77, 4096
v_accvgpr_read_b32 v22, a36
v_accvgpr_read_b32 v30, a37
v_mfma_f32_16x16x32_bf16 v[208:211], v[100:103], v[112:115], v[208:211]
v_accvgpr_read_b32 v23, a38
v_accvgpr_read_b32 v31, a39
v_mfma_f32_16x16x32_bf16 v[224:227], v[104:107], v[112:115], v[224:227]
s_add_u32 s72, s69, 15360
buffer_load_dwordx4 v5, s[4:7], s72 offen offset:1024 lds
v_mfma_f32_16x16x32_bf16 v[228:231], v[104:107], v[116:119], v[228:231]
v_mul_f32 v20, s79, v20
v_mul_f32 v28, s79, v28
v_mfma_f32_16x16x32_bf16 v[232:235], v[104:107], v[120:123], v[232:235]
v_mul_f32 v21, s79, v21
v_mul_f32 v29, s79, v29
v_mfma_f32_16x16x32_bf16 v[236:239], v[104:107], v[124:127], v[236:239]
v_mul_f32 v22, s79, v22
v_mul_f32 v30, s79, v30
v_mfma_f32_16x16x32_bf16 v[252:255], v[108:111], v[124:127], v[252:255]
v_mul_f32 v23, s79, v23
v_mul_f32 v31, s79, v31
v_mfma_f32_16x16x32_bf16 v[248:251], v[108:111], v[120:123], v[248:251]
s_add_u32 s72, s69, 30720
buffer_load_dwordx4 v4, s[4:7], s72 offen offset:2048 lds
v_mfma_f32_16x16x32_bf16 v[244:247], v[108:111], v[116:119], v[244:247]
v_cvt_pk_bf16_f32 v20, v20, v28
v_cvt_pk_bf16_f32 v21, v21, v29
v_mfma_f32_16x16x32_bf16 v[240:243], v[108:111], v[112:115], v[240:243]
s_waitcnt lgkmcnt(0)
v_cvt_pk_bf16_f32 v22, v22, v30
v_cvt_pk_bf16_f32 v23, v23, v31
v_mfma_f32_16x16x32_bf16 v[128:131], v[32:35], v[64:67], v[128:131]
ds_read_b64_tr_b16 v[80:81], v8 offset:24576
ds_read_b64_tr_b16 v[82:83], v8 offset:25600
v_mfma_f32_16x16x32_bf16 v[132:135], v[32:35], v[68:71], v[132:135]
ds_read_b128 v[112:115], v19 offset:0
ds_read_b128 v[116:119], v19 offset:2048
v_mfma_f32_16x16x32_bf16 v[136:139], v[32:35], v[72:75], v[136:139]
s_add_u32 s72, s69, 46080
buffer_load_dwordx4 v5, s[4:7], s72 offen offset:3072 lds
v_mfma_f32_16x16x32_bf16 v[140:143], v[32:35], v[76:79], v[140:143]
ds_read_b128 v[120:123], v19 offset:4096
ds_read_b128 v[124:127], v19 offset:6144
v_mfma_f32_16x16x32_bf16 v[156:159], v[36:39], v[76:79], v[156:159]
ds_read_b64_tr_b16 v[84:85], v9 offset:24576
ds_read_b64_tr_b16 v[86:87], v9 offset:25600
v_mfma_f32_16x16x32_bf16 v[152:155], v[36:39], v[72:75], v[152:155]
ds_read_b64_tr_b16 v[88:89], v10 offset:24576
v_mfma_f32_16x16x32_bf16 v[148:151], v[36:39], v[68:71], v[148:151]
ds_read_b64_tr_b16 v[90:91], v10 offset:25600
v_mfma_f32_16x16x32_bf16 v[144:147], v[36:39], v[64:67], v[144:147]
s_add_u32 m0, s63, 135168
ds_read_b64_tr_b16 v[92:93], v11 offset:24576
v_mfma_f32_16x16x32_bf16 v[160:163], v[40:43], v[64:67], v[160:163]
s_add_u32 s72, s70, 0
buffer_load_dwordx4 v4, s[4:7], s72 offen lds
v_mfma_f32_16x16x32_bf16 v[164:167], v[40:43], v[68:71], v[164:167]
ds_read_b64_tr_b16 v[94:95], v11 offset:25600
v_mfma_f32_16x16x32_bf16 v[168:171], v[40:43], v[72:75], v[168:171]
ds_read_b64_tr_b16 v[96:97], v12 offset:24576
v_mfma_f32_16x16x32_bf16 v[172:175], v[40:43], v[76:79], v[172:175]
ds_read_b64_tr_b16 v[98:99], v12 offset:25600
v_mfma_f32_16x16x32_bf16 v[188:191], v[44:47], v[76:79], v[188:191]
s_add_u32 s72, s70, 15360
buffer_load_dwordx4 v5, s[4:7], s72 offen offset:1024 lds
v_mfma_f32_16x16x32_bf16 v[184:187], v[44:47], v[72:75], v[184:187]
ds_read_b64_tr_b16 v[100:101], v13 offset:24576
v_mfma_f32_16x16x32_bf16 v[180:183], v[44:47], v[68:71], v[180:183]
ds_read_b64_tr_b16 v[102:103], v13 offset:25600
v_mfma_f32_16x16x32_bf16 v[176:179], v[44:47], v[64:67], v[176:179]
ds_read_b64_tr_b16 v[104:105], v14 offset:24576
v_mfma_f32_16x16x32_bf16 v[192:195], v[48:51], v[64:67], v[192:195]
ds_read_b64_tr_b16 v[106:107], v14 offset:25600
v_mfma_f32_16x16x32_bf16 v[196:199], v[48:51], v[68:71], v[196:199]
s_add_u32 s72, s70, 30720
buffer_load_dwordx4 v4, s[4:7], s72 offen offset:2048 lds
v_mfma_f32_16x16x32_bf16 v[200:203], v[48:51], v[72:75], v[200:203]
ds_read_b64_tr_b16 v[108:109], v15 offset:24576
v_mfma_f32_16x16x32_bf16 v[204:207], v[48:51], v[76:79], v[204:207]
ds_read_b64_tr_b16 v[110:111], v15 offset:25600
v_mfma_f32_16x16x32_bf16 v[220:223], v[52:55], v[76:79], v[220:223]
buffer_store_dwordx4 v[20:23], v1, s[44:47], s80 offen sc1
v_mfma_f32_16x16x32_bf16 v[216:219], v[52:55], v[72:75], v[216:219]
v_accvgpr_read_b32 v24, a136
v_accvgpr_read_b32 v28, a137
v_mfma_f32_16x16x32_bf16 v[212:215], v[52:55], v[68:71], v[212:215]
s_add_u32 s72, s70, 46080
buffer_load_dwordx4 v5, s[4:7], s72 offen offset:3072 lds
v_mfma_f32_16x16x32_bf16 v[208:211], v[52:55], v[64:67], v[208:211]
v_accvgpr_read_b32 v25, a138
v_accvgpr_read_b32 v29, a139
v_mfma_f32_16x16x32_bf16 v[224:227], v[56:59], v[64:67], v[224:227]
s_add_u32 s80, s78, 8192
v_accvgpr_read_b32 v26, a140
v_accvgpr_read_b32 v30, a141
v_mfma_f32_16x16x32_bf16 v[228:231], v[56:59], v[68:71], v[228:231]
v_accvgpr_read_b32 v27, a142
v_accvgpr_read_b32 v31, a143
v_mfma_f32_16x16x32_bf16 v[232:235], v[56:59], v[72:75], v[232:235]
v_cvt_pk_bf16_f32 v24, v24, v28
v_cvt_pk_bf16_f32 v25, v25, v29
v_mfma_f32_16x16x32_bf16 v[236:239], v[56:59], v[76:79], v[236:239]
v_cvt_pk_bf16_f32 v26, v26, v30
v_cvt_pk_bf16_f32 v27, v27, v31
v_mfma_f32_16x16x32_bf16 v[252:255], v[60:63], v[76:79], v[252:255]
buffer_store_dwordx4 v[24:27], v1, s[44:47], s80 offen sc1
v_mfma_f32_16x16x32_bf16 v[248:251], v[60:63], v[72:75], v[248:251]
v_mfma_f32_16x16x32_bf16 v[244:247], v[60:63], v[68:71], v[244:247]
s_waitcnt vmcnt(16) lgkmcnt(0)
v_mfma_f32_16x16x32_bf16 v[240:243], v[60:63], v[64:67], v[240:243]
s_barrier
v_mfma_f32_16x16x32_bf16 v[128:131], v[80:83], v[112:115], v[128:131]
s_add_u32 s73, s62, 4
ds_read_b64_tr_b16 v[32:33], v8 offset:32768
ds_read_b64_tr_b16 v[34:35], v8 offset:33792
v_mfma_f32_16x16x32_bf16 v[132:135], v[80:83], v[116:119], v[132:135]
s_add_u32 s70, s73, s65
ds_read_b128 v[64:67], v18 offset:32768
ds_read_b128 v[68:71], v18 offset:34816
v_mfma_f32_16x16x32_bf16 v[136:139], v[80:83], v[120:123], v[136:139]
s_and_b32 s70, s70, 3
ds_read_b128 v[72:75], v18 offset:36864
ds_read_b128 v[76:79], v18 offset:38912
v_mfma_f32_16x16x32_bf16 v[140:143], v[80:83], v[124:127], v[140:143]
s_and_b32 s73, s73, 12
ds_read_b64_tr_b16 v[36:37], v9 offset:32768
ds_read_b64_tr_b16 v[38:39], v9 offset:33792
v_mfma_f32_16x16x32_bf16 v[156:159], v[84:87], v[124:127], v[156:159]
s_or_b32 s73, s73, s70
ds_read_b64_tr_b16 v[40:41], v10 offset:32768
v_accvgpr_read_b32 v20, a8
v_mfma_f32_16x16x32_bf16 v[152:155], v[84:87], v[120:123], v[152:155]
s_lshl_b32 s71, s73, 19
ds_read_b64_tr_b16 v[42:43], v10 offset:33792
v_accvgpr_read_b32 v28, a9
v_mfma_f32_16x16x32_bf16 v[148:151], v[84:87], v[116:119], v[148:151]
s_add_u32 s71, s71, s66
ds_read_b64_tr_b16 v[44:45], v11 offset:32768
v_accvgpr_read_b32 v21, a10
v_mfma_f32_16x16x32_bf16 v[144:147], v[84:87], v[112:115], v[144:147]
s_lshl_b32 s73, s73, 7
ds_read_b64_tr_b16 v[46:47], v11 offset:33792
v_accvgpr_read_b32 v29, a11
v_mfma_f32_16x16x32_bf16 v[160:163], v[88:91], v[112:115], v[160:163]
s_add_u32 s69, s73, s67
ds_read_b64_tr_b16 v[48:49], v12 offset:32768
v_mfma_f32_16x16x32_bf16 v[164:167], v[88:91], v[116:119], v[164:167]
s_add_u32 s70, s73, s68
ds_read_b64_tr_b16 v[50:51], v12 offset:33792
v_mfma_f32_16x16x32_bf16 v[168:171], v[88:91], v[120:123], v[168:171]
s_add_u32 m0, s64, 16384
ds_read_b64_tr_b16 v[52:53], v13 offset:32768
v_mfma_f32_16x16x32_bf16 v[172:175], v[88:91], v[124:127], v[172:175]
s_add_u32 s72, s71, 0
buffer_load_dwordx4 v6, s[12:15], s72 offen lds
v_mfma_f32_16x16x32_bf16 v[188:191], v[92:95], v[124:127], v[188:191]
s_add_u32 s72, s71, 31744
buffer_load_dwordx4 v6, s[12:15], s72 offen offset:1024 lds
v_mfma_f32_16x16x32_bf16 v[184:187], v[92:95], v[120:123], v[184:187]
s_add_u32 s72, s71, 63488
buffer_load_dwordx4 v7, s[12:15], s72 offen offset:2048 lds
v_mfma_f32_16x16x32_bf16 v[180:183], v[92:95], v[116:119], v[180:183]
s_add_u32 s72, s71, 95232
buffer_load_dwordx4 v7, s[12:15], s72 offen offset:3072 lds
v_mfma_f32_16x16x32_bf16 v[176:179], v[92:95], v[112:115], v[176:179]
s_add_u32 s80, s77, 8192
ds_read_b64_tr_b16 v[54:55], v13 offset:33792
v_accvgpr_read_b32 v22, a40
v_mfma_f32_16x16x32_bf16 v[192:195], v[96:99], v[112:115], v[192:195]
ds_read_b64_tr_b16 v[56:57], v14 offset:32768
v_accvgpr_read_b32 v30, a41
v_mfma_f32_16x16x32_bf16 v[196:199], v[96:99], v[116:119], v[196:199]
ds_read_b64_tr_b16 v[58:59], v14 offset:33792
v_accvgpr_read_b32 v23, a42
v_mfma_f32_16x16x32_bf16 v[200:203], v[96:99], v[120:123], v[200:203]
ds_read_b64_tr_b16 v[60:61], v15 offset:32768
v_accvgpr_read_b32 v31, a43
v_mfma_f32_16x16x32_bf16 v[204:207], v[96:99], v[124:127], v[204:207]
s_add_u32 m0, s63, 65536
ds_read_b64_tr_b16 v[62:63], v15 offset:33792
v_mul_f32 v20, s79, v20
v_mfma_f32_16x16x32_bf16 v[220:223], v[100:103], v[124:127], v[220:223]
s_add_u32 s72, s69, 0
buffer_load_dwordx4 v4, s[4:7], s72 offen lds
v_mfma_f32_16x16x32_bf16 v[216:219], v[100:103], v[120:123], v[216:219]
v_mul_f32 v28, s79, v28
v_mul_f32 v21, s79, v21
v_mfma_f32_16x16x32_bf16 v[212:215], v[100:103], v[116:119], v[212:215]
v_mul_f32 v29, s79, v29
v_mul_f32 v22, s79, v22
v_mfma_f32_16x16x32_bf16 v[208:211], v[100:103], v[112:115], v[208:211]
v_mul_f32 v30, s79, v30
v_mul_f32 v23, s79, v23
v_mfma_f32_16x16x32_bf16 v[224:227], v[104:107], v[112:115], v[224:227]
s_add_u32 s72, s69, 15360
buffer_load_dwordx4 v5, s[4:7], s72 offen offset:1024 lds
v_mfma_f32_16x16x32_bf16 v[228:231], v[104:107], v[116:119], v[228:231]
v_mul_f32 v31, s79, v31
v_cvt_pk_bf16_f32 v20, v20, v28
v_mfma_f32_16x16x32_bf16 v[232:235], v[104:107], v[120:123], v[232:235]
v_cvt_pk_bf16_f32 v21, v21, v29
v_cvt_pk_bf16_f32 v22, v22, v30
v_mfma_f32_16x16x32_bf16 v[236:239], v[104:107], v[124:127], v[236:239]
v_cvt_pk_bf16_f32 v23, v23, v31
v_mfma_f32_16x16x32_bf16 v[252:255], v[108:111], v[124:127], v[252:255]
buffer_store_dwordx4 v[20:23], v1, s[44:47], s80 offen sc1
v_mfma_f32_16x16x32_bf16 v[248:251], v[108:111], v[120:123], v[248:251]
s_add_u32 s72, s69, 30720
buffer_load_dwordx4 v4, s[4:7], s72 offen offset:2048 lds
v_mfma_f32_16x16x32_bf16 v[244:247], v[108:111], v[116:119], v[244:247]
v_accvgpr_read_b32 v24, a144
v_accvgpr_read_b32 v28, a145
v_mfma_f32_16x16x32_bf16 v[240:243], v[108:111], v[112:115], v[240:243]
s_waitcnt lgkmcnt(0)
v_accvgpr_read_b32 v25, a146
v_accvgpr_read_b32 v29, a147
v_mfma_f32_16x16x32_bf16 v[128:131], v[32:35], v[64:67], v[128:131]
s_add_u32 s80, s78, 32768
ds_read_b64_tr_b16 v[80:81], v8 offset:40960
ds_read_b64_tr_b16 v[82:83], v8 offset:41984
v_mfma_f32_16x16x32_bf16 v[132:135], v[32:35], v[68:71], v[132:135]
ds_read_b128 v[112:115], v19 offset:32768
ds_read_b128 v[116:119], v19 offset:34816
v_mfma_f32_16x16x32_bf16 v[136:139], v[32:35], v[72:75], v[136:139]
s_add_u32 s72, s69, 46080
buffer_load_dwordx4 v5, s[4:7], s72 offen offset:3072 lds
v_mfma_f32_16x16x32_bf16 v[140:143], v[32:35], v[76:79], v[140:143]
ds_read_b128 v[120:123], v19 offset:36864
ds_read_b128 v[124:127], v19 offset:38912
v_mfma_f32_16x16x32_bf16 v[156:159], v[36:39], v[76:79], v[156:159]
ds_read_b64_tr_b16 v[84:85], v9 offset:40960
ds_read_b64_tr_b16 v[86:87], v9 offset:41984
v_mfma_f32_16x16x32_bf16 v[152:155], v[36:39], v[72:75], v[152:155]
ds_read_b64_tr_b16 v[88:89], v10 offset:40960
v_accvgpr_read_b32 v26, a148
v_mfma_f32_16x16x32_bf16 v[148:151], v[36:39], v[68:71], v[148:151]
ds_read_b64_tr_b16 v[90:91], v10 offset:41984
v_accvgpr_read_b32 v30, a149
v_mfma_f32_16x16x32_bf16 v[144:147], v[36:39], v[64:67], v[144:147]
s_add_u32 m0, s63, 69632
ds_read_b64_tr_b16 v[92:93], v11 offset:40960
v_accvgpr_read_b32 v27, a150
v_mfma_f32_16x16x32_bf16 v[160:163], v[40:43], v[64:67], v[160:163]
s_add_u32 s72, s70, 0
buffer_load_dwordx4 v4, s[4:7], s72 offen lds
v_mfma_f32_16x16x32_bf16 v[164:167], v[40:43], v[68:71], v[164:167]
ds_read_b64_tr_b16 v[94:95], v11 offset:41984
v_accvgpr_read_b32 v31, a151
v_mfma_f32_16x16x32_bf16 v[168:171], v[40:43], v[72:75], v[168:171]
ds_read_b64_tr_b16 v[96:97], v12 offset:40960
v_cvt_pk_bf16_f32 v24, v24, v28
v_mfma_f32_16x16x32_bf16 v[172:175], v[40:43], v[76:79], v[172:175]
ds_read_b64_tr_b16 v[98:99], v12 offset:41984
v_cvt_pk_bf16_f32 v25, v25, v29
v_mfma_f32_16x16x32_bf16 v[188:191], v[44:47], v[76:79], v[188:191]
s_add_u32 s72, s70, 15360
buffer_load_dwordx4 v5, s[4:7], s72 offen offset:1024 lds
v_mfma_f32_16x16x32_bf16 v[184:187], v[44:47], v[72:75], v[184:187]
ds_read_b64_tr_b16 v[100:101], v13 offset:40960
v_cvt_pk_bf16_f32 v26, v26, v30
v_mfma_f32_16x16x32_bf16 v[180:183], v[44:47], v[68:71], v[180:183]
ds_read_b64_tr_b16 v[102:103], v13 offset:41984
v_cvt_pk_bf16_f32 v27, v27, v31
v_mfma_f32_16x16x32_bf16 v[176:179], v[44:47], v[64:67], v[176:179]
ds_read_b64_tr_b16 v[104:105], v14 offset:40960
v_mfma_f32_16x16x32_bf16 v[192:195], v[48:51], v[64:67], v[192:195]
ds_read_b64_tr_b16 v[106:107], v14 offset:41984
v_mfma_f32_16x16x32_bf16 v[196:199], v[48:51], v[68:71], v[196:199]
s_add_u32 s72, s70, 30720
buffer_load_dwordx4 v4, s[4:7], s72 offen offset:2048 lds
v_mfma_f32_16x16x32_bf16 v[200:203], v[48:51], v[72:75], v[200:203]
ds_read_b64_tr_b16 v[108:109], v15 offset:40960
v_mfma_f32_16x16x32_bf16 v[204:207], v[48:51], v[76:79], v[204:207]
ds_read_b64_tr_b16 v[110:111], v15 offset:41984
v_mfma_f32_16x16x32_bf16 v[220:223], v[52:55], v[76:79], v[220:223]
buffer_store_dwordx4 v[24:27], v1, s[44:47], s80 offen sc1
v_mfma_f32_16x16x32_bf16 v[216:219], v[52:55], v[72:75], v[216:219]
v_accvgpr_read_b32 v20, a12
v_accvgpr_read_b32 v28, a13
v_mfma_f32_16x16x32_bf16 v[212:215], v[52:55], v[68:71], v[212:215]
s_add_u32 s72, s70, 46080
buffer_load_dwordx4 v5, s[4:7], s72 offen offset:3072 lds
v_mfma_f32_16x16x32_bf16 v[208:211], v[52:55], v[64:67], v[208:211]
v_accvgpr_read_b32 v21, a14
v_accvgpr_read_b32 v29, a15
v_mfma_f32_16x16x32_bf16 v[224:227], v[56:59], v[64:67], v[224:227]
s_add_u32 s80, s77, 12288
v_accvgpr_read_b32 v22, a44
v_accvgpr_read_b32 v30, a45
v_mfma_f32_16x16x32_bf16 v[228:231], v[56:59], v[68:71], v[228:231]
v_accvgpr_read_b32 v23, a46
v_accvgpr_read_b32 v31, a47
v_mfma_f32_16x16x32_bf16 v[232:235], v[56:59], v[72:75], v[232:235]
v_mul_f32 v20, s79, v20
v_mul_f32 v28, s79, v28
v_mfma_f32_16x16x32_bf16 v[236:239], v[56:59], v[76:79], v[236:239]
v_mul_f32 v21, s79, v21
v_mul_f32 v29, s79, v29
v_mfma_f32_16x16x32_bf16 v[252:255], v[60:63], v[76:79], v[252:255]
v_mul_f32 v22, s79, v22
v_mul_f32 v30, s79, v30
v_mfma_f32_16x16x32_bf16 v[248:251], v[60:63], v[72:75], v[248:251]
v_mul_f32 v23, s79, v23
v_mul_f32 v31, s79, v31
v_mfma_f32_16x16x32_bf16 v[244:247], v[60:63], v[68:71], v[244:247]
s_waitcnt vmcnt(15) lgkmcnt(0)
v_cvt_pk_bf16_f32 v20, v20, v28
v_cvt_pk_bf16_f32 v21, v21, v29
v_mfma_f32_16x16x32_bf16 v[240:243], v[60:63], v[64:67], v[240:243]
s_barrier
v_cvt_pk_bf16_f32 v22, v22, v30
v_cvt_pk_bf16_f32 v23, v23, v31
v_mfma_f32_16x16x32_bf16 v[128:131], v[80:83], v[112:115], v[128:131]
s_add_u32 s73, s62, 5
ds_read_b64_tr_b16 v[32:33], v8 offset:0
ds_read_b64_tr_b16 v[34:35], v8 offset:1024
v_mfma_f32_16x16x32_bf16 v[132:135], v[80:83], v[116:119], v[132:135]
s_add_u32 s70, s73, s65
ds_read_b128 v[64:67], v16 offset:0
ds_read_b128 v[68:71], v16 offset:2048
v_mfma_f32_16x16x32_bf16 v[136:139], v[80:83], v[120:123], v[136:139]
s_and_b32 s70, s70, 3
ds_read_b128 v[72:75], v16 offset:4096
ds_read_b128 v[76:79], v16 offset:6144
v_mfma_f32_16x16x32_bf16 v[140:143], v[80:83], v[124:127], v[140:143]
s_and_b32 s73, s73, 12
ds_read_b64_tr_b16 v[36:37], v9 offset:0
ds_read_b64_tr_b16 v[38:39], v9 offset:1024
v_mfma_f32_16x16x32_bf16 v[156:159], v[84:87], v[124:127], v[156:159]
s_or_b32 s73, s73, s70
ds_read_b64_tr_b16 v[40:41], v10 offset:0
v_mfma_f32_16x16x32_bf16 v[152:155], v[84:87], v[120:123], v[152:155]
s_lshl_b32 s71, s73, 19
ds_read_b64_tr_b16 v[42:43], v10 offset:1024
v_mfma_f32_16x16x32_bf16 v[148:151], v[84:87], v[116:119], v[148:151]
s_add_u32 s71, s71, s66
ds_read_b64_tr_b16 v[44:45], v11 offset:0
v_mfma_f32_16x16x32_bf16 v[144:147], v[84:87], v[112:115], v[144:147]
s_lshl_b32 s73, s73, 7
ds_read_b64_tr_b16 v[46:47], v11 offset:1024
v_mfma_f32_16x16x32_bf16 v[160:163], v[88:91], v[112:115], v[160:163]
s_add_u32 s69, s73, s67
ds_read_b64_tr_b16 v[48:49], v12 offset:0
v_mfma_f32_16x16x32_bf16 v[164:167], v[88:91], v[116:119], v[164:167]
s_add_u32 s70, s73, s68
ds_read_b64_tr_b16 v[50:51], v12 offset:1024
v_mfma_f32_16x16x32_bf16 v[168:171], v[88:91], v[120:123], v[168:171]
s_add_u32 m0, s64, 32768
ds_read_b64_tr_b16 v[52:53], v13 offset:0
v_mfma_f32_16x16x32_bf16 v[172:175], v[88:91], v[124:127], v[172:175]
s_add_u32 s72, s71, 0
buffer_load_dwordx4 v6, s[12:15], s72 offen lds
v_mfma_f32_16x16x32_bf16 v[188:191], v[92:95], v[124:127], v[188:191]
s_add_u32 s72, s71, 31744
buffer_load_dwordx4 v6, s[12:15], s72 offen offset:1024 lds
v_mfma_f32_16x16x32_bf16 v[184:187], v[92:95], v[120:123], v[184:187]
s_add_u32 s72, s71, 63488
buffer_load_dwordx4 v7, s[12:15], s72 offen offset:2048 lds
v_mfma_f32_16x16x32_bf16 v[180:183], v[92:95], v[116:119], v[180:183]
s_add_u32 s72, s71, 95232
buffer_load_dwordx4 v7, s[12:15], s72 offen offset:3072 lds
v_mfma_f32_16x16x32_bf16 v[176:179], v[92:95], v[112:115], v[176:179]
ds_read_b64_tr_b16 v[54:55], v13 offset:1024
v_mfma_f32_16x16x32_bf16 v[192:195], v[96:99], v[112:115], v[192:195]
ds_read_b64_tr_b16 v[56:57], v14 offset:0
v_mfma_f32_16x16x32_bf16 v[196:199], v[96:99], v[116:119], v[196:199]
ds_read_b64_tr_b16 v[58:59], v14 offset:1024
v_mfma_f32_16x16x32_bf16 v[200:203], v[96:99], v[120:123], v[200:203]
ds_read_b64_tr_b16 v[60:61], v15 offset:0
v_mfma_f32_16x16x32_bf16 v[204:207], v[96:99], v[124:127], v[204:207]
s_add_u32 m0, s63, 98304
ds_read_b64_tr_b16 v[62:63], v15 offset:1024
v_mfma_f32_16x16x32_bf16 v[220:223], v[100:103], v[124:127], v[220:223]
s_add_u32 s72, s69, 0
buffer_load_dwordx4 v4, s[4:7], s72 offen lds
v_mfma_f32_16x16x32_bf16 v[216:219], v[100:103], v[120:123], v[216:219]
buffer_store_dwordx4 v[20:23], v1, s[44:47], s80 offen sc1
v_mfma_f32_16x16x32_bf16 v[212:215], v[100:103], v[116:119], v[212:215]
v_accvgpr_read_b32 v24, a152
v_accvgpr_read_b32 v28, a153
v_mfma_f32_16x16x32_bf16 v[208:211], v[100:103], v[112:115], v[208:211]
v_accvgpr_read_b32 v25, a154
v_accvgpr_read_b32 v29, a155
v_mfma_f32_16x16x32_bf16 v[224:227], v[104:107], v[112:115], v[224:227]
s_add_u32 s72, s69, 15360
buffer_load_dwordx4 v5, s[4:7], s72 offen offset:1024 lds
v_mfma_f32_16x16x32_bf16 v[228:231], v[104:107], v[116:119], v[228:231]
s_add_u32 s80, s78, 40960
v_accvgpr_read_b32 v26, a156
v_accvgpr_read_b32 v30, a157
v_mfma_f32_16x16x32_bf16 v[232:235], v[104:107], v[120:123], v[232:235]
v_accvgpr_read_b32 v27, a158
v_accvgpr_read_b32 v31, a159
v_mfma_f32_16x16x32_bf16 v[236:239], v[104:107], v[124:127], v[236:239]
v_cvt_pk_bf16_f32 v24, v24, v28
v_cvt_pk_bf16_f32 v25, v25, v29
v_mfma_f32_16x16x32_bf16 v[252:255], v[108:111], v[124:127], v[252:255]
v_cvt_pk_bf16_f32 v26, v26, v30
v_cvt_pk_bf16_f32 v27, v27, v31
v_mfma_f32_16x16x32_bf16 v[248:251], v[108:111], v[120:123], v[248:251]
s_add_u32 s72, s69, 30720
buffer_load_dwordx4 v4, s[4:7], s72 offen offset:2048 lds
v_mfma_f32_16x16x32_bf16 v[244:247], v[108:111], v[116:119], v[244:247]
buffer_store_dwordx4 v[24:27], v1, s[44:47], s80 offen sc1
v_mfma_f32_16x16x32_bf16 v[240:243], v[108:111], v[112:115], v[240:243]
s_waitcnt lgkmcnt(0)
v_mfma_f32_16x16x32_bf16 v[128:131], v[32:35], v[64:67], v[128:131]
ds_read_b64_tr_b16 v[80:81], v8 offset:8192
ds_read_b64_tr_b16 v[82:83], v8 offset:9216
v_mfma_f32_16x16x32_bf16 v[132:135], v[32:35], v[68:71], v[132:135]
ds_read_b128 v[112:115], v17 offset:0
ds_read_b128 v[116:119], v17 offset:2048
v_mfma_f32_16x16x32_bf16 v[136:139], v[32:35], v[72:75], v[136:139]
s_add_u32 s72, s69, 46080
buffer_load_dwordx4 v5, s[4:7], s72 offen offset:3072 lds
v_mfma_f32_16x16x32_bf16 v[140:143], v[32:35], v[76:79], v[140:143]
ds_read_b128 v[120:123], v17 offset:4096
ds_read_b128 v[124:127], v17 offset:6144
v_mfma_f32_16x16x32_bf16 v[156:159], v[36:39], v[76:79], v[156:159]
ds_read_b64_tr_b16 v[84:85], v9 offset:8192
ds_read_b64_tr_b16 v[86:87], v9 offset:9216
v_mfma_f32_16x16x32_bf16 v[152:155], v[36:39], v[72:75], v[152:155]
ds_read_b64_tr_b16 v[88:89], v10 offset:8192
v_accvgpr_read_b32 v20, a16
v_mfma_f32_16x16x32_bf16 v[148:151], v[36:39], v[68:71], v[148:151]
ds_read_b64_tr_b16 v[90:91], v10 offset:9216
v_accvgpr_read_b32 v28, a17
v_mfma_f32_16x16x32_bf16 v[144:147], v[36:39], v[64:67], v[144:147]
s_add_u32 m0, s63, 102400
ds_read_b64_tr_b16 v[92:93], v11 offset:8192
v_accvgpr_read_b32 v21, a18
v_mfma_f32_16x16x32_bf16 v[160:163], v[40:43], v[64:67], v[160:163]
s_add_u32 s72, s70, 0
buffer_load_dwordx4 v4, s[4:7], s72 offen lds
v_mfma_f32_16x16x32_bf16 v[164:167], v[40:43], v[68:71], v[164:167]
ds_read_b64_tr_b16 v[94:95], v11 offset:9216
v_accvgpr_read_b32 v29, a19
v_mfma_f32_16x16x32_bf16 v[168:171], v[40:43], v[72:75], v[168:171]
s_add_u32 s80, s77, 32768
ds_read_b64_tr_b16 v[96:97], v12 offset:8192
v_accvgpr_read_b32 v22, a48
v_mfma_f32_16x16x32_bf16 v[172:175], v[40:43], v[76:79], v[172:175]
ds_read_b64_tr_b16 v[98:99], v12 offset:9216
v_accvgpr_read_b32 v30, a49
v_mfma_f32_16x16x32_bf16 v[188:191], v[44:47], v[76:79], v[188:191]
s_add_u32 s72, s70, 15360
buffer_load_dwordx4 v5, s[4:7], s72 offen offset:1024 lds
v_mfma_f32_16x16x32_bf16 v[184:187], v[44:47], v[72:75], v[184:187]
ds_read_b64_tr_b16 v[100:101], v13 offset:8192
v_accvgpr_read_b32 v23, a50
v_mfma_f32_16x16x32_bf16 v[180:183], v[44:47], v[68:71], v[180:183]
ds_read_b64_tr_b16 v[102:103], v13 offset:9216
v_accvgpr_read_b32 v31, a51
v_mfma_f32_16x16x32_bf16 v[176:179], v[44:47], v[64:67], v[176:179]
ds_read_b64_tr_b16 v[104:105], v14 offset:8192
v_mul_f32 v20, s79, v20
v_mfma_f32_16x16x32_bf16 v[192:195], v[48:51], v[64:67], v[192:195]
ds_read_b64_tr_b16 v[106:107], v14 offset:9216
v_mul_f32 v28, s79, v28
v_mfma_f32_16x16x32_bf16 v[196:199], v[48:51], v[68:71], v[196:199]
s_add_u32 s72, s70, 30720
buffer_load_dwordx4 v4, s[4:7], s72 offen offset:2048 lds
v_mfma_f32_16x16x32_bf16 v[200:203], v[48:51], v[72:75], v[200:203]
ds_read_b64_tr_b16 v[108:109], v15 offset:8192
v_mul_f32 v21, s79, v21
v_mfma_f32_16x16x32_bf16 v[204:207], v[48:51], v[76:79], v[204:207]
ds_read_b64_tr_b16 v[110:111], v15 offset:9216
v_mul_f32 v29, s79, v29
v_mfma_f32_16x16x32_bf16 v[220:223], v[52:55], v[76:79], v[220:223]
v_mul_f32 v22, s79, v22
v_mul_f32 v30, s79, v30
v_mfma_f32_16x16x32_bf16 v[216:219], v[52:55], v[72:75], v[216:219]
v_mul_f32 v23, s79, v23
v_mul_f32 v31, s79, v31
v_mfma_f32_16x16x32_bf16 v[212:215], v[52:55], v[68:71], v[212:215]
s_add_u32 s72, s70, 46080
buffer_load_dwordx4 v5, s[4:7], s72 offen offset:3072 lds
v_mfma_f32_16x16x32_bf16 v[208:211], v[52:55], v[64:67], v[208:211]
v_cvt_pk_bf16_f32 v20, v20, v28
v_cvt_pk_bf16_f32 v21, v21, v29
v_mfma_f32_16x16x32_bf16 v[224:227], v[56:59], v[64:67], v[224:227]
v_cvt_pk_bf16_f32 v22, v22, v30
v_cvt_pk_bf16_f32 v23, v23, v31
v_mfma_f32_16x16x32_bf16 v[228:231], v[56:59], v[68:71], v[228:231]
buffer_store_dwordx4 v[20:23], v1, s[44:47], s80 offen sc1
v_mfma_f32_16x16x32_bf16 v[232:235], v[56:59], v[72:75], v[232:235]
v_accvgpr_read_b32 v24, a160
v_accvgpr_read_b32 v28, a161
v_mfma_f32_16x16x32_bf16 v[236:239], v[56:59], v[76:79], v[236:239]
v_accvgpr_read_b32 v25, a162
v_accvgpr_read_b32 v29, a163
v_mfma_f32_16x16x32_bf16 v[252:255], v[60:63], v[76:79], v[252:255]
s_add_u32 s80, s78, 1024
v_accvgpr_read_b32 v26, a164
v_accvgpr_read_b32 v30, a165
v_mfma_f32_16x16x32_bf16 v[248:251], v[60:63], v[72:75], v[248:251]
v_accvgpr_read_b32 v27, a166
v_accvgpr_read_b32 v31, a167
v_mfma_f32_16x16x32_bf16 v[244:247], v[60:63], v[68:71], v[244:247]
s_waitcnt vmcnt(15) lgkmcnt(0)
v_cvt_pk_bf16_f32 v24, v24, v28
v_cvt_pk_bf16_f32 v25, v25, v29
v_mfma_f32_16x16x32_bf16 v[240:243], v[60:63], v[64:67], v[240:243]
s_barrier
v_cvt_pk_bf16_f32 v26, v26, v30
v_cvt_pk_bf16_f32 v27, v27, v31
v_mfma_f32_16x16x32_bf16 v[128:131], v[80:83], v[112:115], v[128:131]
s_add_u32 s73, s62, 6
ds_read_b64_tr_b16 v[32:33], v8 offset:16384
ds_read_b64_tr_b16 v[34:35], v8 offset:17408
v_mfma_f32_16x16x32_bf16 v[132:135], v[80:83], v[116:119], v[132:135]
s_add_u32 s70, s73, s65
ds_read_b128 v[64:67], v18 offset:0
ds_read_b128 v[68:71], v18 offset:2048
v_mfma_f32_16x16x32_bf16 v[136:139], v[80:83], v[120:123], v[136:139]
s_and_b32 s70, s70, 3
ds_read_b128 v[72:75], v18 offset:4096
ds_read_b128 v[76:79], v18 offset:6144
v_mfma_f32_16x16x32_bf16 v[140:143], v[80:83], v[124:127], v[140:143]
s_and_b32 s73, s73, 12
ds_read_b64_tr_b16 v[36:37], v9 offset:16384
ds_read_b64_tr_b16 v[38:39], v9 offset:17408
v_mfma_f32_16x16x32_bf16 v[156:159], v[84:87], v[124:127], v[156:159]
s_or_b32 s73, s73, s70
ds_read_b64_tr_b16 v[40:41], v10 offset:16384
v_mfma_f32_16x16x32_bf16 v[152:155], v[84:87], v[120:123], v[152:155]
s_lshl_b32 s71, s73, 19
ds_read_b64_tr_b16 v[42:43], v10 offset:17408
v_mfma_f32_16x16x32_bf16 v[148:151], v[84:87], v[116:119], v[148:151]
s_add_u32 s71, s71, s66
ds_read_b64_tr_b16 v[44:45], v11 offset:16384
v_mfma_f32_16x16x32_bf16 v[144:147], v[84:87], v[112:115], v[144:147]
s_lshl_b32 s73, s73, 7
ds_read_b64_tr_b16 v[46:47], v11 offset:17408
v_mfma_f32_16x16x32_bf16 v[160:163], v[88:91], v[112:115], v[160:163]
s_add_u32 s69, s73, s67
ds_read_b64_tr_b16 v[48:49], v12 offset:16384
v_mfma_f32_16x16x32_bf16 v[164:167], v[88:91], v[116:119], v[164:167]
s_add_u32 s70, s73, s68
ds_read_b64_tr_b16 v[50:51], v12 offset:17408
v_mfma_f32_16x16x32_bf16 v[168:171], v[88:91], v[120:123], v[168:171]
s_add_u32 m0, s64, 0
ds_read_b64_tr_b16 v[52:53], v13 offset:16384
v_mfma_f32_16x16x32_bf16 v[172:175], v[88:91], v[124:127], v[172:175]
s_add_u32 s72, s71, 0
buffer_load_dwordx4 v6, s[12:15], s72 offen lds
v_mfma_f32_16x16x32_bf16 v[188:191], v[92:95], v[124:127], v[188:191]
s_add_u32 s72, s71, 31744
buffer_load_dwordx4 v6, s[12:15], s72 offen offset:1024 lds
v_mfma_f32_16x16x32_bf16 v[184:187], v[92:95], v[120:123], v[184:187]
s_add_u32 s72, s71, 63488
buffer_load_dwordx4 v7, s[12:15], s72 offen offset:2048 lds
v_mfma_f32_16x16x32_bf16 v[180:183], v[92:95], v[116:119], v[180:183]
s_add_u32 s72, s71, 95232
buffer_load_dwordx4 v7, s[12:15], s72 offen offset:3072 lds
v_mfma_f32_16x16x32_bf16 v[176:179], v[92:95], v[112:115], v[176:179]
ds_read_b64_tr_b16 v[54:55], v13 offset:17408
v_mfma_f32_16x16x32_bf16 v[192:195], v[96:99], v[112:115], v[192:195]
ds_read_b64_tr_b16 v[56:57], v14 offset:16384
v_mfma_f32_16x16x32_bf16 v[196:199], v[96:99], v[116:119], v[196:199]
ds_read_b64_tr_b16 v[58:59], v14 offset:17408
v_mfma_f32_16x16x32_bf16 v[200:203], v[96:99], v[120:123], v[200:203]
ds_read_b64_tr_b16 v[60:61], v15 offset:16384
v_mfma_f32_16x16x32_bf16 v[204:207], v[96:99], v[124:127], v[204:207]
s_add_u32 m0, s63, 131072
ds_read_b64_tr_b16 v[62:63], v15 offset:17408
v_mfma_f32_16x16x32_bf16 v[220:223], v[100:103], v[124:127], v[220:223]
s_add_u32 s72, s69, 0
buffer_load_dwordx4 v4, s[4:7], s72 offen lds
v_mfma_f32_16x16x32_bf16 v[216:219], v[100:103], v[120:123], v[216:219]
buffer_store_dwordx4 v[24:27], v1, s[44:47], s80 offen sc1
v_mfma_f32_16x16x32_bf16 v[212:215], v[100:103], v[116:119], v[212:215]
v_accvgpr_read_b32 v20, a20
v_accvgpr_read_b32 v28, a21
v_mfma_f32_16x16x32_bf16 v[208:211], v[100:103], v[112:115], v[208:211]
v_accvgpr_read_b32 v21, a22
v_accvgpr_read_b32 v29, a23
v_mfma_f32_16x16x32_bf16 v[224:227], v[104:107], v[112:115], v[224:227]
s_add_u32 s72, s69, 15360
buffer_load_dwordx4 v5, s[4:7], s72 offen offset:1024 lds
v_mfma_f32_16x16x32_bf16 v[228:231], v[104:107], v[116:119], v[228:231]
s_add_u32 s80, s77, 36864
v_accvgpr_read_b32 v22, a52
v_accvgpr_read_b32 v30, a53
v_mfma_f32_16x16x32_bf16 v[232:235], v[104:107], v[120:123], v[232:235]
v_accvgpr_read_b32 v23, a54
v_accvgpr_read_b32 v31, a55
v_mfma_f32_16x16x32_bf16 v[236:239], v[104:107], v[124:127], v[236:239]
v_mul_f32 v20, s79, v20
v_mul_f32 v28, s79, v28
v_mfma_f32_16x16x32_bf16 v[252:255], v[108:111], v[124:127], v[252:255]
v_mul_f32 v21, s79, v21
v_mul_f32 v29, s79, v29
v_mfma_f32_16x16x32_bf16 v[248:251], v[108:111], v[120:123], v[248:251]
s_add_u32 s72, s69, 30720
buffer_load_dwordx4 v4, s[4:7], s72 offen offset:2048 lds
v_mfma_f32_16x16x32_bf16 v[244:247], v[108:111], v[116:119], v[244:247]
v_mul_f32 v22, s79, v22
v_mul_f32 v30, s79, v30
v_mfma_f32_16x16x32_bf16 v[240:243], v[108:111], v[112:115], v[240:243]
s_waitcnt lgkmcnt(0)
v_mul_f32 v23, s79, v23
v_mul_f32 v31, s79, v31
v_mfma_f32_16x16x32_bf16 v[128:131], v[32:35], v[64:67], v[128:131]
ds_read_b64_tr_b16 v[80:81], v8 offset:24576
ds_read_b64_tr_b16 v[82:83], v8 offset:25600
v_mfma_f32_16x16x32_bf16 v[132:135], v[32:35], v[68:71], v[132:135]
ds_read_b128 v[112:115], v19 offset:0
ds_read_b128 v[116:119], v19 offset:2048
v_mfma_f32_16x16x32_bf16 v[136:139], v[32:35], v[72:75], v[136:139]
s_add_u32 s72, s69, 46080
buffer_load_dwordx4 v5, s[4:7], s72 offen offset:3072 lds
v_mfma_f32_16x16x32_bf16 v[140:143], v[32:35], v[76:79], v[140:143]
ds_read_b128 v[120:123], v19 offset:4096
ds_read_b128 v[124:127], v19 offset:6144
v_mfma_f32_16x16x32_bf16 v[156:159], v[36:39], v[76:79], v[156:159]
ds_read_b64_tr_b16 v[84:85], v9 offset:24576
ds_read_b64_tr_b16 v[86:87], v9 offset:25600
v_mfma_f32_16x16x32_bf16 v[152:155], v[36:39], v[72:75], v[152:155]
ds_read_b64_tr_b16 v[88:89], v10 offset:24576
v_cvt_pk_bf16_f32 v20, v20, v28
v_mfma_f32_16x16x32_bf16 v[148:151], v[36:39], v[68:71], v[148:151]
ds_read_b64_tr_b16 v[90:91], v10 offset:25600
v_cvt_pk_bf16_f32 v21, v21, v29
v_mfma_f32_16x16x32_bf16 v[144:147], v[36:39], v[64:67], v[144:147]
s_add_u32 m0, s63, 135168
ds_read_b64_tr_b16 v[92:93], v11 offset:24576
v_cvt_pk_bf16_f32 v22, v22, v30
v_mfma_f32_16x16x32_bf16 v[160:163], v[40:43], v[64:67], v[160:163]
s_add_u32 s72, s70, 0
buffer_load_dwordx4 v4, s[4:7], s72 offen lds
v_mfma_f32_16x16x32_bf16 v[164:167], v[40:43], v[68:71], v[164:167]
ds_read_b64_tr_b16 v[94:95], v11 offset:25600
v_cvt_pk_bf16_f32 v23, v23, v31
v_mfma_f32_16x16x32_bf16 v[168:171], v[40:43], v[72:75], v[168:171]
ds_read_b64_tr_b16 v[96:97], v12 offset:24576
v_mfma_f32_16x16x32_bf16 v[172:175], v[40:43], v[76:79], v[172:175]
ds_read_b64_tr_b16 v[98:99], v12 offset:25600
v_mfma_f32_16x16x32_bf16 v[188:191], v[44:47], v[76:79], v[188:191]
s_add_u32 s72, s70, 15360
buffer_load_dwordx4 v5, s[4:7], s72 offen offset:1024 lds
v_mfma_f32_16x16x32_bf16 v[184:187], v[44:47], v[72:75], v[184:187]
ds_read_b64_tr_b16 v[100:101], v13 offset:24576
v_mfma_f32_16x16x32_bf16 v[180:183], v[44:47], v[68:71], v[180:183]
ds_read_b64_tr_b16 v[102:103], v13 offset:25600
v_mfma_f32_16x16x32_bf16 v[176:179], v[44:47], v[64:67], v[176:179]
ds_read_b64_tr_b16 v[104:105], v14 offset:24576
v_mfma_f32_16x16x32_bf16 v[192:195], v[48:51], v[64:67], v[192:195]
ds_read_b64_tr_b16 v[106:107], v14 offset:25600
v_mfma_f32_16x16x32_bf16 v[196:199], v[48:51], v[68:71], v[196:199]
s_add_u32 s72, s70, 30720
buffer_load_dwordx4 v4, s[4:7], s72 offen offset:2048 lds
v_mfma_f32_16x16x32_bf16 v[200:203], v[48:51], v[72:75], v[200:203]
ds_read_b64_tr_b16 v[108:109], v15 offset:24576
v_mfma_f32_16x16x32_bf16 v[204:207], v[48:51], v[76:79], v[204:207]
ds_read_b64_tr_b16 v[110:111], v15 offset:25600
v_mfma_f32_16x16x32_bf16 v[220:223], v[52:55], v[76:79], v[220:223]
buffer_store_dwordx4 v[20:23], v1, s[44:47], s80 offen sc1
v_mfma_f32_16x16x32_bf16 v[216:219], v[52:55], v[72:75], v[216:219]
v_accvgpr_read_b32 v24, a168
v_accvgpr_read_b32 v28, a169
v_mfma_f32_16x16x32_bf16 v[212:215], v[52:55], v[68:71], v[212:215]
s_add_u32 s72, s70, 46080
buffer_load_dwordx4 v5, s[4:7], s72 offen offset:3072 lds
v_mfma_f32_16x16x32_bf16 v[208:211], v[52:55], v[64:67], v[208:211]
v_accvgpr_read_b32 v25, a170
v_accvgpr_read_b32 v29, a171
v_mfma_f32_16x16x32_bf16 v[224:227], v[56:59], v[64:67], v[224:227]
s_add_u32 s80, s78, 9216
v_accvgpr_read_b32 v26, a172
v_accvgpr_read_b32 v30, a173
v_mfma_f32_16x16x32_bf16 v[228:231], v[56:59], v[68:71], v[228:231]
v_accvgpr_read_b32 v27, a174
v_accvgpr_read_b32 v31, a175
v_mfma_f32_16x16x32_bf16 v[232:235], v[56:59], v[72:75], v[232:235]
v_cvt_pk_bf16_f32 v24, v24, v28
v_cvt_pk_bf16_f32 v25, v25, v29
v_mfma_f32_16x16x32_bf16 v[236:239], v[56:59], v[76:79], v[236:239]
v_cvt_pk_bf16_f32 v26, v26, v30
v_cvt_pk_bf16_f32 v27, v27, v31
v_mfma_f32_16x16x32_bf16 v[252:255], v[60:63], v[76:79], v[252:255]
buffer_store_dwordx4 v[24:27], v1, s[44:47], s80 offen sc1
v_mfma_f32_16x16x32_bf16 v[248:251], v[60:63], v[72:75], v[248:251]
v_mfma_f32_16x16x32_bf16 v[244:247], v[60:63], v[68:71], v[244:247]
s_waitcnt vmcnt(16) lgkmcnt(0)
v_mfma_f32_16x16x32_bf16 v[240:243], v[60:63], v[64:67], v[240:243]
s_barrier
v_mfma_f32_16x16x32_bf16 v[128:131], v[80:83], v[112:115], v[128:131]
s_add_u32 s73, s62, 7
ds_read_b64_tr_b16 v[32:33], v8 offset:32768
ds_read_b64_tr_b16 v[34:35], v8 offset:33792
v_mfma_f32_16x16x32_bf16 v[132:135], v[80:83], v[116:119], v[132:135]
s_add_u32 s70, s73, s65
ds_read_b128 v[64:67], v18 offset:32768
ds_read_b128 v[68:71], v18 offset:34816
v_mfma_f32_16x16x32_bf16 v[136:139], v[80:83], v[120:123], v[136:139]
s_and_b32 s70, s70, 3
ds_read_b128 v[72:75], v18 offset:36864
ds_read_b128 v[76:79], v18 offset:38912
v_mfma_f32_16x16x32_bf16 v[140:143], v[80:83], v[124:127], v[140:143]
s_and_b32 s73, s73, 12
ds_read_b64_tr_b16 v[36:37], v9 offset:32768
ds_read_b64_tr_b16 v[38:39], v9 offset:33792
v_mfma_f32_16x16x32_bf16 v[156:159], v[84:87], v[124:127], v[156:159]
s_or_b32 s73, s73, s70
ds_read_b64_tr_b16 v[40:41], v10 offset:32768
v_accvgpr_read_b32 v20, a24
v_mfma_f32_16x16x32_bf16 v[152:155], v[84:87], v[120:123], v[152:155]
s_lshl_b32 s71, s73, 19
ds_read_b64_tr_b16 v[42:43], v10 offset:33792
v_accvgpr_read_b32 v28, a25
v_mfma_f32_16x16x32_bf16 v[148:151], v[84:87], v[116:119], v[148:151]
s_add_u32 s71, s71, s66
ds_read_b64_tr_b16 v[44:45], v11 offset:32768
v_accvgpr_read_b32 v21, a26
v_mfma_f32_16x16x32_bf16 v[144:147], v[84:87], v[112:115], v[144:147]
s_lshl_b32 s73, s73, 7
ds_read_b64_tr_b16 v[46:47], v11 offset:33792
v_accvgpr_read_b32 v29, a27
v_mfma_f32_16x16x32_bf16 v[160:163], v[88:91], v[112:115], v[160:163]
s_add_u32 s69, s73, s67
ds_read_b64_tr_b16 v[48:49], v12 offset:32768
v_mfma_f32_16x16x32_bf16 v[164:167], v[88:91], v[116:119], v[164:167]
s_add_u32 s70, s73, s68
ds_read_b64_tr_b16 v[50:51], v12 offset:33792
v_mfma_f32_16x16x32_bf16 v[168:171], v[88:91], v[120:123], v[168:171]
s_add_u32 m0, s64, 16384
ds_read_b64_tr_b16 v[52:53], v13 offset:32768
v_mfma_f32_16x16x32_bf16 v[172:175], v[88:91], v[124:127], v[172:175]
s_add_u32 s72, s71, 0
buffer_load_dwordx4 v6, s[12:15], s72 offen lds
v_mfma_f32_16x16x32_bf16 v[188:191], v[92:95], v[124:127], v[188:191]
s_add_u32 s72, s71, 31744
buffer_load_dwordx4 v6, s[12:15], s72 offen offset:1024 lds
v_mfma_f32_16x16x32_bf16 v[184:187], v[92:95], v[120:123], v[184:187]
s_add_u32 s72, s71, 63488
buffer_load_dwordx4 v7, s[12:15], s72 offen offset:2048 lds
v_mfma_f32_16x16x32_bf16 v[180:183], v[92:95], v[116:119], v[180:183]
s_add_u32 s72, s71, 95232
buffer_load_dwordx4 v7, s[12:15], s72 offen offset:3072 lds
v_mfma_f32_16x16x32_bf16 v[176:179], v[92:95], v[112:115], v[176:179]
s_add_u32 s80, s77, 40960
ds_read_b64_tr_b16 v[54:55], v13 offset:33792
v_accvgpr_read_b32 v22, a56
v_mfma_f32_16x16x32_bf16 v[192:195], v[96:99], v[112:115], v[192:195]
ds_read_b64_tr_b16 v[56:57], v14 offset:32768
v_accvgpr_read_b32 v30, a57
v_mfma_f32_16x16x32_bf16 v[196:199], v[96:99], v[116:119], v[196:199]
ds_read_b64_tr_b16 v[58:59], v14 offset:33792
v_accvgpr_read_b32 v23, a58
v_mfma_f32_16x16x32_bf16 v[200:203], v[96:99], v[120:123], v[200:203]
ds_read_b64_tr_b16 v[60:61], v15 offset:32768
v_accvgpr_read_b32 v31, a59
v_mfma_f32_16x16x32_bf16 v[204:207], v[96:99], v[124:127], v[204:207]
s_add_u32 m0, s63, 65536
ds_read_b64_tr_b16 v[62:63], v15 offset:33792
v_mul_f32 v20, s79, v20
v_mfma_f32_16x16x32_bf16 v[220:223], v[100:103], v[124:127], v[220:223]
s_add_u32 s72, s69, 0
buffer_load_dwordx4 v4, s[4:7], s72 offen lds
v_mfma_f32_16x16x32_bf16 v[216:219], v[100:103], v[120:123], v[216:219]
v_mul_f32 v28, s79, v28
v_mul_f32 v21, s79, v21
v_mfma_f32_16x16x32_bf16 v[212:215], v[100:103], v[116:119], v[212:215]
v_mul_f32 v29, s79, v29
v_mul_f32 v22, s79, v22
v_mfma_f32_16x16x32_bf16 v[208:211], v[100:103], v[112:115], v[208:211]
v_mul_f32 v30, s79, v30
v_mul_f32 v23, s79, v23
v_mfma_f32_16x16x32_bf16 v[224:227], v[104:107], v[112:115], v[224:227]
s_add_u32 s72, s69, 15360
buffer_load_dwordx4 v5, s[4:7], s72 offen offset:1024 lds
v_mfma_f32_16x16x32_bf16 v[228:231], v[104:107], v[116:119], v[228:231]
v_mul_f32 v31, s79, v31
v_cvt_pk_bf16_f32 v20, v20, v28
v_mfma_f32_16x16x32_bf16 v[232:235], v[104:107], v[120:123], v[232:235]
v_cvt_pk_bf16_f32 v21, v21, v29
v_cvt_pk_bf16_f32 v22, v22, v30
v_mfma_f32_16x16x32_bf16 v[236:239], v[104:107], v[124:127], v[236:239]
v_cvt_pk_bf16_f32 v23, v23, v31
v_mfma_f32_16x16x32_bf16 v[252:255], v[108:111], v[124:127], v[252:255]
buffer_store_dwordx4 v[20:23], v1, s[44:47], s80 offen sc1
v_mfma_f32_16x16x32_bf16 v[248:251], v[108:111], v[120:123], v[248:251]
s_add_u32 s72, s69, 30720
buffer_load_dwordx4 v4, s[4:7], s72 offen offset:2048 lds
v_mfma_f32_16x16x32_bf16 v[244:247], v[108:111], v[116:119], v[244:247]
v_accvgpr_read_b32 v24, a176
v_accvgpr_read_b32 v28, a177
v_mfma_f32_16x16x32_bf16 v[240:243], v[108:111], v[112:115], v[240:243]
s_waitcnt lgkmcnt(0)
v_accvgpr_read_b32 v25, a178
v_accvgpr_read_b32 v29, a179
v_mfma_f32_16x16x32_bf16 v[128:131], v[32:35], v[64:67], v[128:131]
s_lshr_b32 s75, s93, 4
ds_read_b64_tr_b16 v[80:81], v8 offset:40960
ds_read_b64_tr_b16 v[82:83], v8 offset:41984
v_mfma_f32_16x16x32_bf16 v[132:135], v[32:35], v[68:71], v[132:135]
s_and_b32 s75, s75, 0x7f00
ds_read_b128 v[112:115], v19 offset:32768
ds_read_b128 v[116:119], v19 offset:34816
v_mfma_f32_16x16x32_bf16 v[136:139], v[32:35], v[72:75], v[136:139]
s_add_u32 s72, s69, 46080
buffer_load_dwordx4 v5, s[4:7], s72 offen offset:3072 lds
v_mfma_f32_16x16x32_bf16 v[140:143], v[32:35], v[76:79], v[140:143]
s_add_u32 s75, s75, LcB1-Lpc0
v_lshrrev_b32 v2, 5, v0
v_lshlrev_b32 v2, 7, v2
v_mfma_f32_16x16x32_bf16 v[156:159], v[36:39], v[76:79], v[156:159]
s_add_u32 s80, s78, 33792
v_add_u32 v2, s75, v2
v_min_u32 v2, Lcode_end-Lpc0, v2
v_mfma_f32_16x16x32_bf16 v[152:155], v[36:39], v[72:75], v[152:155]
global_load_dword v3, v2, s[98:99]
v_mfma_f32_16x16x32_bf16 v[148:151], v[36:39], v[68:71], v[148:151]
ds_read_b128 v[120:123], v19 offset:36864
ds_read_b128 v[124:127], v19 offset:38912
v_mfma_f32_16x16x32_bf16 v[144:147], v[36:39], v[64:67], v[144:147]
s_add_u32 m0, s63, 69632
ds_read_b64_tr_b16 v[84:85], v9 offset:40960
ds_read_b64_tr_b16 v[86:87], v9 offset:41984
v_mfma_f32_16x16x32_bf16 v[160:163], v[40:43], v[64:67], v[160:163]
s_add_u32 s72, s70, 0
buffer_load_dwordx4 v4, s[4:7], s72 offen lds
v_mfma_f32_16x16x32_bf16 v[164:167], v[40:43], v[68:71], v[164:167]
ds_read_b64_tr_b16 v[88:89], v10 offset:40960
v_accvgpr_read_b32 v26, a180
v_mfma_f32_16x16x32_bf16 v[168:171], v[40:43], v[72:75], v[168:171]
ds_read_b64_tr_b16 v[90:91], v10 offset:41984
v_accvgpr_read_b32 v30, a181
v_mfma_f32_16x16x32_bf16 v[172:175], v[40:43], v[76:79], v[172:175]
ds_read_b64_tr_b16 v[92:93], v11 offset:40960
v_accvgpr_read_b32 v27, a182
v_mfma_f32_16x16x32_bf16 v[188:191], v[44:47], v[76:79], v[188:191]
s_add_u32 s72, s70, 15360
buffer_load_dwordx4 v5, s[4:7], s72 offen offset:1024 lds
v_mfma_f32_16x16x32_bf16 v[184:187], v[44:47], v[72:75], v[184:187]
ds_read_b64_tr_b16 v[94:95], v11 offset:41984
v_accvgpr_read_b32 v31, a183
v_mfma_f32_16x16x32_bf16 v[180:183], v[44:47], v[68:71], v[180:183]
ds_read_b64_tr_b16 v[96:97], v12 offset:40960
v_cvt_pk_bf16_f32 v24, v24, v28
v_mfma_f32_16x16x32_bf16 v[176:179], v[44:47], v[64:67], v[176:179]
ds_read_b64_tr_b16 v[98:99], v12 offset:41984
v_cvt_pk_bf16_f32 v25, v25, v29
v_mfma_f32_16x16x32_bf16 v[192:195], v[48:51], v[64:67], v[192:195]
ds_read_b64_tr_b16 v[100:101], v13 offset:40960
v_cvt_pk_bf16_f32 v26, v26, v30
v_mfma_f32_16x16x32_bf16 v[196:199], v[48:51], v[68:71], v[196:199]
s_add_u32 s72, s70, 30720
buffer_load_dwordx4 v4, s[4:7], s72 offen offset:2048 lds
v_mfma_f32_16x16x32_bf16 v[200:203], v[48:51], v[72:75], v[200:203]
ds_read_b64_tr_b16 v[102:103], v13 offset:41984
v_cvt_pk_bf16_f32 v27, v27, v31
v_mfma_f32_16x16x32_bf16 v[204:207], v[48:51], v[76:79], v[204:207]
ds_read_b64_tr_b16 v[104:105], v14 offset:40960
v_mfma_f32_16x16x32_bf16 v[220:223], v[52:55], v[76:79], v[220:223]
ds_read_b64_tr_b16 v[106:107], v14 offset:41984
v_mfma_f32_16x16x32_bf16 v[216:219], v[52:55], v[72:75], v[216:219]
ds_read_b64_tr_b16 v[108:109], v15 offset:40960
v_mfma_f32_16x16x32_bf16 v[212:215], v[52:55], v[68:71], v[212:215]
s_add_u32 s72, s70, 46080
buffer_load_dwordx4 v5, s[4:7], s72 offen offset:3072 lds
v_mfma_f32_16x16x32_bf16 v[208:211], v[52:55], v[64:67], v[208:211]
ds_read_b64_tr_b16 v[110:111], v15 offset:41984
v_mfma_f32_16x16x32_bf16 v[224:227], v[56:59], v[64:67], v[224:227]
buffer_store_dwordx4 v[24:27], v1, s[44:47], s80 offen sc1
v_mfma_f32_16x16x32_bf16 v[228:231], v[56:59], v[68:71], v[228:231]
v_accvgpr_read_b32 v20, a28
v_accvgpr_read_b32 v28, a29
v_mfma_f32_16x16x32_bf16 v[232:235], v[56:59], v[72:75], v[232:235]
v_accvgpr_read_b32 v21, a30
v_accvgpr_read_b32 v29, a31
v_mfma_f32_16x16x32_bf16 v[236:239], v[56:59], v[76:79], v[236:239]
s_add_u32 s80, s77, 45056
v_accvgpr_read_b32 v22, a60
v_accvgpr_read_b32 v30, a61
v_mfma_f32_16x16x32_bf16 v[252:255], v[60:63], v[76:79], v[252:255]
v_accvgpr_read_b32 v23, a62
v_accvgpr_read_b32 v31, a63
v_mfma_f32_16x16x32_bf16 v[248:251], v[60:63], v[72:75], v[248:251]
v_mul_f32 v20, s79, v20
v_mul_f32 v28, s79, v28
v_mfma_f32_16x16x32_bf16 v[244:247], v[60:63], v[68:71], v[244:247]
s_waitcnt vmcnt(16) lgkmcnt(0)
v_mul_f32 v21, s79, v21
v_mul_f32 v29, s79, v29
v_mfma_f32_16x16x32_bf16 v[240:243], v[60:63], v[64:67], v[240:243]
s_barrier
v_mul_f32 v22, s79, v22
v_mul_f32 v30, s79, v30
v_mfma_f32_16x16x32_bf16 v[128:131], v[80:83], v[112:115], v[128:131]
s_add_u32 s73, s62, 8
ds_read_b64_tr_b16 v[32:33], v8 offset:0
ds_read_b64_tr_b16 v[34:35], v8 offset:1024
v_mfma_f32_16x16x32_bf16 v[132:135], v[80:83], v[116:119], v[132:135]
s_add_u32 s70, s73, s65
ds_read_b128 v[64:67], v16 offset:0
ds_read_b128 v[68:71], v16 offset:2048
v_mfma_f32_16x16x32_bf16 v[136:139], v[80:83], v[120:123], v[136:139]
s_and_b32 s70, s70, 3
ds_read_b128 v[72:75], v16 offset:4096
ds_read_b128 v[76:79], v16 offset:6144
v_mfma_f32_16x16x32_bf16 v[140:143], v[80:83], v[124:127], v[140:143]
s_and_b32 s73, s73, 12
ds_read_b64_tr_b16 v[36:37], v9 offset:0
ds_read_b64_tr_b16 v[38:39], v9 offset:1024
v_mfma_f32_16x16x32_bf16 v[156:159], v[84:87], v[124:127], v[156:159]
s_or_b32 s73, s73, s70
ds_read_b64_tr_b16 v[40:41], v10 offset:0
v_mul_f32 v23, s79, v23
v_mfma_f32_16x16x32_bf16 v[152:155], v[84:87], v[120:123], v[152:155]
s_lshl_b32 s71, s73, 19
ds_read_b64_tr_b16 v[42:43], v10 offset:1024
v_mul_f32 v31, s79, v31
v_mfma_f32_16x16x32_bf16 v[148:151], v[84:87], v[116:119], v[148:151]
s_add_u32 s71, s71, s66
ds_read_b64_tr_b16 v[44:45], v11 offset:0
v_cvt_pk_bf16_f32 v20, v20, v28
v_mfma_f32_16x16x32_bf16 v[144:147], v[84:87], v[112:115], v[144:147]
s_lshl_b32 s73, s73, 7
ds_read_b64_tr_b16 v[46:47], v11 offset:1024
v_cvt_pk_bf16_f32 v21, v21, v29
v_mfma_f32_16x16x32_bf16 v[160:163], v[88:91], v[112:115], v[160:163]
s_add_u32 s69, s73, s67
ds_read_b64_tr_b16 v[48:49], v12 offset:0
v_cvt_pk_bf16_f32 v22, v22, v30
v_mfma_f32_16x16x32_bf16 v[164:167], v[88:91], v[116:119], v[164:167]
s_add_u32 s70, s73, s68
ds_read_b64_tr_b16 v[50:51], v12 offset:1024
v_cvt_pk_bf16_f32 v23, v23, v31
v_mfma_f32_16x16x32_bf16 v[168:171], v[88:91], v[120:123], v[168:171]
s_add_u32 m0, s64, 32768
ds_read_b64_tr_b16 v[52:53], v13 offset:0
v_mfma_f32_16x16x32_bf16 v[172:175], v[88:91], v[124:127], v[172:175]
s_add_u32 s72, s71, 0
buffer_load_dwordx4 v6, s[12:15], s72 offen lds
v_mfma_f32_16x16x32_bf16 v[188:191], v[92:95], v[124:127], v[188:191]
s_add_u32 s72, s71, 31744
buffer_load_dwordx4 v6, s[12:15], s72 offen offset:1024 lds
v_mfma_f32_16x16x32_bf16 v[184:187], v[92:95], v[120:123], v[184:187]
s_add_u32 s72, s71, 63488
buffer_load_dwordx4 v7, s[12:15], s72 offen offset:2048 lds
v_mfma_f32_16x16x32_bf16 v[180:183], v[92:95], v[116:119], v[180:183]
s_add_u32 s72, s71, 95232
buffer_load_dwordx4 v7, s[12:15], s72 offen offset:3072 lds
v_mfma_f32_16x16x32_bf16 v[176:179], v[92:95], v[112:115], v[176:179]
ds_read_b64_tr_b16 v[54:55], v13 offset:1024
v_mfma_f32_16x16x32_bf16 v[192:195], v[96:99], v[112:115], v[192:195]
ds_read_b64_tr_b16 v[56:57], v14 offset:0
v_mfma_f32_16x16x32_bf16 v[196:199], v[96:99], v[116:119], v[196:199]
ds_read_b64_tr_b16 v[58:59], v14 offset:1024
v_mfma_f32_16x16x32_bf16 v[200:203], v[96:99], v[120:123], v[200:203]
ds_read_b64_tr_b16 v[60:61], v15 offset:0
v_mfma_f32_16x16x32_bf16 v[204:207], v[96:99], v[124:127], v[204:207]
s_add_u32 m0, s63, 98304
ds_read_b64_tr_b16 v[62:63], v15 offset:1024
v_mfma_f32_16x16x32_bf16 v[220:223], v[100:103], v[124:127], v[220:223]
s_add_u32 s72, s69, 0
buffer_load_dwordx4 v4, s[4:7], s72 offen lds
v_mfma_f32_16x16x32_bf16 v[216:219], v[100:103], v[120:123], v[216:219]
buffer_store_dwordx4 v[20:23], v1, s[44:47], s80 offen sc1
v_mfma_f32_16x16x32_bf16 v[212:215], v[100:103], v[116:119], v[212:215]
v_accvgpr_read_b32 v24, a184
v_accvgpr_read_b32 v28, a185
v_mfma_f32_16x16x32_bf16 v[208:211], v[100:103], v[112:115], v[208:211]
v_accvgpr_read_b32 v25, a186
v_accvgpr_read_b32 v29, a187
v_mfma_f32_16x16x32_bf16 v[224:227], v[104:107], v[112:115], v[224:227]
s_add_u32 s72, s69, 15360
buffer_load_dwordx4 v5, s[4:7], s72 offen offset:1024 lds
v_mfma_f32_16x16x32_bf16 v[228:231], v[104:107], v[116:119], v[228:231]
s_add_u32 s80, s78, 41984
v_accvgpr_read_b32 v26, a188
v_accvgpr_read_b32 v30, a189
v_mfma_f32_16x16x32_bf16 v[232:235], v[104:107], v[120:123], v[232:235]
v_accvgpr_read_b32 v27, a190
v_accvgpr_read_b32 v31, a191
v_mfma_f32_16x16x32_bf16 v[236:239], v[104:107], v[124:127], v[236:239]
v_cvt_pk_bf16_f32 v24, v24, v28
v_cvt_pk_bf16_f32 v25, v25, v29
v_mfma_f32_16x16x32_bf16 v[252:255], v[108:111], v[124:127], v[252:255]
v_cvt_pk_bf16_f32 v26, v26, v30
v_cvt_pk_bf16_f32 v27, v27, v31
v_mfma_f32_16x16x32_bf16 v[248:251], v[108:111], v[120:123], v[248:251]
s_add_u32 s72, s69, 30720
buffer_load_dwordx4 v4, s[4:7], s72 offen offset:2048 lds
v_mfma_f32_16x16x32_bf16 v[244:247], v[108:111], v[116:119], v[244:247]
buffer_store_dwordx4 v[24:27], v1, s[44:47], s80 offen sc1
v_mfma_f32_16x16x32_bf16 v[240:243], v[108:111], v[112:115], v[240:243]
s_waitcnt lgkmcnt(0)
v_mfma_f32_16x16x32_bf16 v[128:131], v[32:35], v[64:67], v[128:131]
ds_read_b64_tr_b16 v[80:81], v8 offset:8192
ds_read_b64_tr_b16 v[82:83], v8 offset:9216
v_mfma_f32_16x16x32_bf16 v[132:135], v[32:35], v[68:71], v[132:135]
ds_read_b128 v[112:115], v17 offset:0
ds_read_b128 v[116:119], v17 offset:2048
v_mfma_f32_16x16x32_bf16 v[136:139], v[32:35], v[72:75], v[136:139]
s_add_u32 s72, s69, 46080
buffer_load_dwordx4 v5, s[4:7], s72 offen offset:3072 lds
v_mfma_f32_16x16x32_bf16 v[140:143], v[32:35], v[76:79], v[140:143]
ds_read_b128 v[120:123], v17 offset:4096
ds_read_b128 v[124:127], v17 offset:6144
v_mfma_f32_16x16x32_bf16 v[156:159], v[36:39], v[76:79], v[156:159]
ds_read_b64_tr_b16 v[84:85], v9 offset:8192
ds_read_b64_tr_b16 v[86:87], v9 offset:9216
v_mfma_f32_16x16x32_bf16 v[152:155], v[36:39], v[72:75], v[152:155]
ds_read_b64_tr_b16 v[88:89], v10 offset:8192
v_accvgpr_read_b32 v20, a64
v_mfma_f32_16x16x32_bf16 v[148:151], v[36:39], v[68:71], v[148:151]
ds_read_b64_tr_b16 v[90:91], v10 offset:9216
v_accvgpr_read_b32 v28, a65
v_mfma_f32_16x16x32_bf16 v[144:147], v[36:39], v[64:67], v[144:147]
s_add_u32 m0, s63, 102400
ds_read_b64_tr_b16 v[92:93], v11 offset:8192
v_accvgpr_read_b32 v21, a66
v_mfma_f32_16x16x32_bf16 v[160:163], v[40:43], v[64:67], v[160:163]
s_add_u32 s72, s70, 0
buffer_load_dwordx4 v4, s[4:7], s72 offen lds
v_mfma_f32_16x16x32_bf16 v[164:167], v[40:43], v[68:71], v[164:167]
ds_read_b64_tr_b16 v[94:95], v11 offset:9216
v_accvgpr_read_b32 v29, a67
v_mfma_f32_16x16x32_bf16 v[168:171], v[40:43], v[72:75], v[168:171]
s_add_u32 s80, s77, 1024
ds_read_b64_tr_b16 v[96:97], v12 offset:8192
v_accvgpr_read_b32 v22, a96
v_mfma_f32_16x16x32_bf16 v[172:175], v[40:43], v[76:79], v[172:175]
ds_read_b64_tr_b16 v[98:99], v12 offset:9216
v_accvgpr_read_b32 v30, a97
v_mfma_f32_16x16x32_bf16 v[188:191], v[44:47], v[76:79], v[188:191]
s_add_u32 s72, s70, 15360
buffer_load_dwordx4 v5, s[4:7], s72 offen offset:1024 lds
v_mfma_f32_16x16x32_bf16 v[184:187], v[44:47], v[72:75], v[184:187]
ds_read_b64_tr_b16 v[100:101], v13 offset:8192
v_accvgpr_read_b32 v23, a98
v_mfma_f32_16x16x32_bf16 v[180:183], v[44:47], v[68:71], v[180:183]
ds_read_b64_tr_b16 v[102:103], v13 offset:9216
v_accvgpr_read_b32 v31, a99
v_mfma_f32_16x16x32_bf16 v[176:179], v[44:47], v[64:67], v[176:179]
ds_read_b64_tr_b16 v[104:105], v14 offset:8192
v_mul_f32 v20, s79, v20
v_mfma_f32_16x16x32_bf16 v[192:195], v[48:51], v[64:67], v[192:195]
ds_read_b64_tr_b16 v[106:107], v14 offset:9216
v_mul_f32 v28, s79, v28
v_mfma_f32_16x16x32_bf16 v[196:199], v[48:51], v[68:71], v[196:199]
s_add_u32 s72, s70, 30720
buffer_load_dwordx4 v4, s[4:7], s72 offen offset:2048 lds
v_mfma_f32_16x16x32_bf16 v[200:203], v[48:51], v[72:75], v[200:203]
ds_read_b64_tr_b16 v[108:109], v15 offset:8192
v_mul_f32 v21, s79, v21
v_mfma_f32_16x16x32_bf16 v[204:207], v[48:51], v[76:79], v[204:207]
ds_read_b64_tr_b16 v[110:111], v15 offset:9216
v_mul_f32 v29, s79, v29
v_mfma_f32_16x16x32_bf16 v[220:223], v[52:55], v[76:79], v[220:223]
v_mul_f32 v22, s79, v22
v_mul_f32 v30, s79, v30
v_mfma_f32_16x16x32_bf16 v[216:219], v[52:55], v[72:75], v[216:219]
v_mul_f32 v23, s79, v23
v_mul_f32 v31, s79, v31
v_mfma_f32_16x16x32_bf16 v[212:215], v[52:55], v[68:71], v[212:215]
s_add_u32 s72, s70, 46080
buffer_load_dwordx4 v5, s[4:7], s72 offen offset:3072 lds
v_mfma_f32_16x16x32_bf16 v[208:211], v[52:55], v[64:67], v[208:211]
v_cvt_pk_bf16_f32 v20, v20, v28
v_cvt_pk_bf16_f32 v21, v21, v29
v_mfma_f32_16x16x32_bf16 v[224:227], v[56:59], v[64:67], v[224:227]
v_cvt_pk_bf16_f32 v22, v22, v30
v_cvt_pk_bf16_f32 v23, v23, v31
v_mfma_f32_16x16x32_bf16 v[228:231], v[56:59], v[68:71], v[228:231]
buffer_store_dwordx4 v[20:23], v1, s[44:47], s80 offen sc1
v_mfma_f32_16x16x32_bf16 v[232:235], v[56:59], v[72:75], v[232:235]
v_accvgpr_read_b32 v24, a192
v_accvgpr_read_b32 v28, a193
v_mfma_f32_16x16x32_bf16 v[236:239], v[56:59], v[76:79], v[236:239]
v_accvgpr_read_b32 v25, a194
v_accvgpr_read_b32 v29, a195
v_mfma_f32_16x16x32_bf16 v[252:255], v[60:63], v[76:79], v[252:255]
s_add_u32 s80, s78, 2048
v_accvgpr_read_b32 v26, a196
v_accvgpr_read_b32 v30, a197
v_mfma_f32_16x16x32_bf16 v[248:251], v[60:63], v[72:75], v[248:251]
v_accvgpr_read_b32 v27, a198
v_accvgpr_read_b32 v31, a199
v_mfma_f32_16x16x32_bf16 v[244:247], v[60:63], v[68:71], v[244:247]
s_waitcnt vmcnt(16) lgkmcnt(0)
v_cvt_pk_bf16_f32 v24, v24, v28
v_cvt_pk_bf16_f32 v25, v25, v29
v_mfma_f32_16x16x32_bf16 v[240:243], v[60:63], v[64:67], v[240:243]
s_barrier
v_cvt_pk_bf16_f32 v26, v26, v30
v_cvt_pk_bf16_f32 v27, v27, v31
v_mfma_f32_16x16x32_bf16 v[128:131], v[80:83], v[112:115], v[128:131]
s_add_u32 s73, s62, 9
ds_read_b64_tr_b16 v[32:33], v8 offset:16384
ds_read_b64_tr_b16 v[34:35], v8 offset:17408
v_mfma_f32_16x16x32_bf16 v[132:135], v[80:83], v[116:119], v[132:135]
s_add_u32 s70, s73, s65
ds_read_b128 v[64:67], v18 offset:0
ds_read_b128 v[68:71], v18 offset:2048
v_mfma_f32_16x16x32_bf16 v[136:139], v[80:83], v[120:123], v[136:139]
s_and_b32 s70, s70, 3
ds_read_b128 v[72:75], v18 offset:4096
ds_read_b128 v[76:79], v18 offset:6144
v_mfma_f32_16x16x32_bf16 v[140:143], v[80:83], v[124:127], v[140:143]
s_and_b32 s73, s73, 12
ds_read_b64_tr_b16 v[36:37], v9 offset:16384
ds_read_b64_tr_b16 v[38:39], v9 offset:17408
v_mfma_f32_16x16x32_bf16 v[156:159], v[84:87], v[124:127], v[156:159]
s_or_b32 s73, s73, s70
ds_read_b64_tr_b16 v[40:41], v10 offset:16384
v_mfma_f32_16x16x32_bf16 v[152:155], v[84:87], v[120:123], v[152:155]
s_lshl_b32 s71, s73, 19
ds_read_b64_tr_b16 v[42:43], v10 offset:17408
v_mfma_f32_16x16x32_bf16 v[148:151], v[84:87], v[116:119], v[148:151]
s_add_u32 s71, s71, s66
ds_read_b64_tr_b16 v[44:45], v11 offset:16384
v_mfma_f32_16x16x32_bf16 v[144:147], v[84:87], v[112:115], v[144:147]
s_lshl_b32 s73, s73, 7
ds_read_b64_tr_b16 v[46:47], v11 offset:17408
v_mfma_f32_16x16x32_bf16 v[160:163], v[88:91], v[112:115], v[160:163]
s_add_u32 s69, s73, s67
ds_read_b64_tr_b16 v[48:49], v12 offset:16384
v_mfma_f32_16x16x32_bf16 v[164:167], v[88:91], v[116:119], v[164:167]
s_add_u32 s70, s73, s68
ds_read_b64_tr_b16 v[50:51], v12 offset:17408
v_mfma_f32_16x16x32_bf16 v[168:171], v[88:91], v[120:123], v[168:171]
s_add_u32 m0, s64, 0
ds_read_b64_tr_b16 v[52:53], v13 offset:16384
v_mfma_f32_16x16x32_bf16 v[172:175], v[88:91], v[124:127], v[172:175]
s_add_u32 s72, s71, 0
buffer_load_dwordx4 v6, s[12:15], s72 offen lds
v_mfma_f32_16x16x32_bf16 v[188:191], v[92:95], v[124:127], v[188:191]
s_add_u32 s72, s71, 31744
buffer_load_dwordx4 v6, s[12:15], s72 offen offset:1024 lds
v_mfma_f32_16x16x32_bf16 v[184:187], v[92:95], v[120:123], v[184:187]
s_add_u32 s72, s71, 63488
buffer_load_dwordx4 v7, s[12:15], s72 offen offset:2048 lds
v_mfma_f32_16x16x32_bf16 v[180:183], v[92:95], v[116:119], v[180:183]
s_add_u32 s72, s71, 95232
buffer_load_dwordx4 v7, s[12:15], s72 offen offset:3072 lds
v_mfma_f32_16x16x32_bf16 v[176:179], v[92:95], v[112:115], v[176:179]
ds_read_b64_tr_b16 v[54:55], v13 offset:17408
v_mfma_f32_16x16x32_bf16 v[192:195], v[96:99], v[112:115], v[192:195]
ds_read_b64_tr_b16 v[56:57], v14 offset:16384
v_mfma_f32_16x16x32_bf16 v[196:199], v[96:99], v[116:119], v[196:199]
ds_read_b64_tr_b16 v[58:59], v14 offset:17408
v_mfma_f32_16x16x32_bf16 v[200:203], v[96:99], v[120:123], v[200:203]
ds_read_b64_tr_b16 v[60:61], v15 offset:16384
v_mfma_f32_16x16x32_bf16 v[204:207], v[96:99], v[124:127], v[204:207]
s_add_u32 m0, s63, 131072
ds_read_b64_tr_b16 v[62:63], v15 offset:17408
v_mfma_f32_16x16x32_bf16 v[220:223], v[100:103], v[124:127], v[220:223]
s_add_u32 s72, s69, 0
buffer_load_dwordx4 v4, s[4:7], s72 offen lds
v_mfma_f32_16x16x32_bf16 v[216:219], v[100:103], v[120:123], v[216:219]
buffer_store_dwordx4 v[24:27], v1, s[44:47], s80 offen sc1
v_mfma_f32_16x16x32_bf16 v[212:215], v[100:103], v[116:119], v[212:215]
v_accvgpr_read_b32 v20, a68
v_accvgpr_read_b32 v28, a69
v_mfma_f32_16x16x32_bf16 v[208:211], v[100:103], v[112:115], v[208:211]
v_accvgpr_read_b32 v21, a70
v_accvgpr_read_b32 v29, a71
v_mfma_f32_16x16x32_bf16 v[224:227], v[104:107], v[112:115], v[224:227]
s_add_u32 s72, s69, 15360
buffer_load_dwordx4 v5, s[4:7], s72 offen offset:1024 lds
v_mfma_f32_16x16x32_bf16 v[228:231], v[104:107], v[116:119], v[228:231]
s_add_u32 s80, s77, 5120
v_accvgpr_read_b32 v22, a100
v_accvgpr_read_b32 v30, a101
v_mfma_f32_16x16x32_bf16 v[232:235], v[104:107], v[120:123], v[232:235]
v_accvgpr_read_b32 v23, a102
v_accvgpr_read_b32 v31, a103
v_mfma_f32_16x16x32_bf16 v[236:239], v[104:107], v[124:127], v[236:239]
v_mul_f32 v20, s79, v20
v_mul_f32 v28, s79, v28
v_mfma_f32_16x16x32_bf16 v[252:255], v[108:111], v[124:127], v[252:255]
v_mul_f32 v21, s79, v21
v_mul_f32 v29, s79, v29
v_mfma_f32_16x16x32_bf16 v[248:251], v[108:111], v[120:123], v[248:251]
s_add_u32 s72, s69, 30720
buffer_load_dwordx4 v4, s[4:7], s72 offen offset:2048 lds
v_mfma_f32_16x16x32_bf16 v[244:247], v[108:111], v[116:119], v[244:247]
v_mul_f32 v22, s79, v22
v_mul_f32 v30, s79, v30
v_mfma_f32_16x16x32_bf16 v[240:243], v[108:111], v[112:115], v[240:243]
s_waitcnt lgkmcnt(0)
v_mul_f32 v23, s79, v23
v_mul_f32 v31, s79, v31
v_mfma_f32_16x16x32_bf16 v[128:131], v[32:35], v[64:67], v[128:131]
ds_read_b64_tr_b16 v[80:81], v8 offset:24576
ds_read_b64_tr_b16 v[82:83], v8 offset:25600
v_mfma_f32_16x16x32_bf16 v[132:135], v[32:35], v[68:71], v[132:135]
ds_read_b128 v[112:115], v19 offset:0
ds_read_b128 v[116:119], v19 offset:2048
v_mfma_f32_16x16x32_bf16 v[136:139], v[32:35], v[72:75], v[136:139]
s_add_u32 s72, s69, 46080
buffer_load_dwordx4 v5, s[4:7], s72 offen offset:3072 lds
v_mfma_f32_16x16x32_bf16 v[140:143], v[32:35], v[76:79], v[140:143]
ds_read_b128 v[120:123], v19 offset:4096
ds_read_b128 v[124:127], v19 offset:6144
v_mfma_f32_16x16x32_bf16 v[156:159], v[36:39], v[76:79], v[156:159]
ds_read_b64_tr_b16 v[84:85], v9 offset:24576
ds_read_b64_tr_b16 v[86:87], v9 offset:25600
v_mfma_f32_16x16x32_bf16 v[152:155], v[36:39], v[72:75], v[152:155]
ds_read_b64_tr_b16 v[88:89], v10 offset:24576
v_cvt_pk_bf16_f32 v20, v20, v28
v_mfma_f32_16x16x32_bf16 v[148:151], v[36:39], v[68:71], v[148:151]
ds_read_b64_tr_b16 v[90:91], v10 offset:25600
v_cvt_pk_bf16_f32 v21, v21, v29
v_mfma_f32_16x16x32_bf16 v[144:147], v[36:39], v[64:67], v[144:147]
s_add_u32 m0, s63, 135168
ds_read_b64_tr_b16 v[92:93], v11 offset:24576
v_cvt_pk_bf16_f32 v22, v22, v30
v_mfma_f32_16x16x32_bf16 v[160:163], v[40:43], v[64:67], v[160:163]
s_add_u32 s72, s70, 0
buffer_load_dwordx4 v4, s[4:7], s72 offen lds
v_mfma_f32_16x16x32_bf16 v[164:167], v[40:43], v[68:71], v[164:167]
ds_read_b64_tr_b16 v[94:95], v11 offset:25600
v_cvt_pk_bf16_f32 v23, v23, v31
v_mfma_f32_16x16x32_bf16 v[168:171], v[40:43], v[72:75], v[168:171]
ds_read_b64_tr_b16 v[96:97], v12 offset:24576
v_mfma_f32_16x16x32_bf16 v[172:175], v[40:43], v[76:79], v[172:175]
ds_read_b64_tr_b16 v[98:99], v12 offset:25600
v_mfma_f32_16x16x32_bf16 v[188:191], v[44:47], v[76:79], v[188:191]
s_add_u32 s72, s70, 15360
buffer_load_dwordx4 v5, s[4:7], s72 offen offset:1024 lds
v_mfma_f32_16x16x32_bf16 v[184:187], v[44:47], v[72:75], v[184:187]
ds_read_b64_tr_b16 v[100:101], v13 offset:24576
v_mfma_f32_16x16x32_bf16 v[180:183], v[44:47], v[68:71], v[180:183]
ds_read_b64_tr_b16 v[102:103], v13 offset:25600
v_mfma_f32_16x16x32_bf16 v[176:179], v[44:47], v[64:67], v[176:179]
ds_read_b64_tr_b16 v[104:105], v14 offset:24576
v_mfma_f32_16x16x32_bf16 v[192:195], v[48:51], v[64:67], v[192:195]
ds_read_b64_tr_b16 v[106:107], v14 offset:25600
v_mfma_f32_16x16x32_bf16 v[196:199], v[48:51], v[68:71], v[196:199]
s_add_u32 s72, s70, 30720
buffer_load_dwordx4 v4, s[4:7], s72 offen offset:2048 lds
v_mfma_f32_16x16x32_bf16 v[200:203], v[48:51], v[72:75], v[200:203]
ds_read_b64_tr_b16 v[108:109], v15 offset:24576
v_mfma_f32_16x16x32_bf16 v[204:207], v[48:51], v[76:79], v[204:207]
ds_read_b64_tr_b16 v[110:111], v15 offset:25600
v_mfma_f32_16x16x32_bf16 v[220:223], v[52:55], v[76:79], v[220:223]
buffer_store_dwordx4 v[20:23], v1, s[44:47], s80 offen sc1
v_mfma_f32_16x16x32_bf16 v[216:219], v[52:55], v[72:75], v[216:219]
v_accvgpr_read_b32 v24, a200
v_accvgpr_read_b32 v28, a201
v_mfma_f32_16x16x32_bf16 v[212:215], v[52:55], v[68:71], v[212:215]
s_add_u32 s72, s70, 46080
buffer_load_dwordx4 v5, s[4:7], s72 offen offset:3072 lds
v_mfma_f32_16x16x32_bf16 v[208:211], v[52:55], v[64:67], v[208:211]
v_accvgpr_read_b32 v25, a202
v_accvgpr_read_b32 v29, a203
v_mfma_f32_16x16x32_bf16 v[224:227], v[56:59], v[64:67], v[224:227]
s_add_u32 s80, s78, 10240
v_accvgpr_read_b32 v26, a204
v_accvgpr_read_b32 v30, a205
v_mfma_f32_16x16x32_bf16 v[228:231], v[56:59], v[68:71], v[228:231]
v_accvgpr_read_b32 v27, a206
v_accvgpr_read_b32 v31, a207
v_mfma_f32_16x16x32_bf16 v[232:235], v[56:59], v[72:75], v[232:235]
v_cvt_pk_bf16_f32 v24, v24, v28
v_cvt_pk_bf16_f32 v25, v25, v29
v_mfma_f32_16x16x32_bf16 v[236:239], v[56:59], v[76:79], v[236:239]
v_cvt_pk_bf16_f32 v26, v26, v30
v_cvt_pk_bf16_f32 v27, v27, v31
v_mfma_f32_16x16x32_bf16 v[252:255], v[60:63], v[76:79], v[252:255]
buffer_store_dwordx4 v[24:27], v1, s[44:47], s80 offen sc1
v_mfma_f32_16x16x32_bf16 v[248:251], v[60:63], v[72:75], v[248:251]
v_mfma_f32_16x16x32_bf16 v[244:247], v[60:63], v[68:71], v[244:247]
s_waitcnt vmcnt(16) lgkmcnt(0)
v_mfma_f32_16x16x32_bf16 v[240:243], v[60:63], v[64:67], v[240:243]
s_barrier
v_mfma_f32_16x16x32_bf16 v[128:131], v[80:83], v[112:115], v[128:131]
s_add_u32 s73, s62, 10
ds_read_b64_tr_b16 v[32:33], v8 offset:32768
ds_read_b64_tr_b16 v[34:35], v8 offset:33792
v_mfma_f32_16x16x32_bf16 v[132:135], v[80:83], v[116:119], v[132:135]
s_add_u32 s70, s73, s65
ds_read_b128 v[64:67], v18 offset:32768
ds_read_b128 v[68:71], v18 offset:34816
v_mfma_f32_16x16x32_bf16 v[136:139], v[80:83], v[120:123], v[136:139]
s_and_b32 s70, s70, 3
ds_read_b128 v[72:75], v18 offset:36864
ds_read_b128 v[76:79], v18 offset:38912
v_mfma_f32_16x16x32_bf16 v[140:143], v[80:83], v[124:127], v[140:143]
s_and_b32 s73, s73, 12
ds_read_b64_tr_b16 v[36:37], v9 offset:32768
ds_read_b64_tr_b16 v[38:39], v9 offset:33792
v_mfma_f32_16x16x32_bf16 v[156:159], v[84:87], v[124:127], v[156:159]
s_or_b32 s73, s73, s70
ds_read_b64_tr_b16 v[40:41], v10 offset:32768
v_accvgpr_read_b32 v20, a72
v_mfma_f32_16x16x32_bf16 v[152:155], v[84:87], v[120:123], v[152:155]
s_lshl_b32 s71, s73, 19
ds_read_b64_tr_b16 v[42:43], v10 offset:33792
v_accvgpr_read_b32 v28, a73
v_mfma_f32_16x16x32_bf16 v[148:151], v[84:87], v[116:119], v[148:151]
s_add_u32 s71, s71, s66
ds_read_b64_tr_b16 v[44:45], v11 offset:32768
v_accvgpr_read_b32 v21, a74
v_mfma_f32_16x16x32_bf16 v[144:147], v[84:87], v[112:115], v[144:147]
s_lshl_b32 s73, s73, 7
ds_read_b64_tr_b16 v[46:47], v11 offset:33792
v_accvgpr_read_b32 v29, a75
v_mfma_f32_16x16x32_bf16 v[160:163], v[88:91], v[112:115], v[160:163]
s_add_u32 s69, s73, s67
ds_read_b64_tr_b16 v[48:49], v12 offset:32768
v_mfma_f32_16x16x32_bf16 v[164:167], v[88:91], v[116:119], v[164:167]
s_add_u32 s70, s73, s68
ds_read_b64_tr_b16 v[50:51], v12 offset:33792
v_mfma_f32_16x16x32_bf16 v[168:171], v[88:91], v[120:123], v[168:171]
s_add_u32 m0, s64, 16384
ds_read_b64_tr_b16 v[52:53], v13 offset:32768
v_mfma_f32_16x16x32_bf16 v[172:175], v[88:91], v[124:127], v[172:175]
s_add_u32 s72, s71, 0
buffer_load_dwordx4 v6, s[12:15], s72 offen lds
v_mfma_f32_16x16x32_bf16 v[188:191], v[92:95], v[124:127], v[188:191]
s_add_u32 s72, s71, 31744
buffer_load_dwordx4 v6, s[12:15], s72 offen offset:1024 lds
v_mfma_f32_16x16x32_bf16 v[184:187], v[92:95], v[120:123], v[184:187]
s_add_u32 s72, s71, 63488
buffer_load_dwordx4 v7, s[12:15], s72 offen offset:2048 lds
v_mfma_f32_16x16x32_bf16 v[180:183], v[92:95], v[116:119], v[180:183]
s_add_u32 s72, s71, 95232
buffer_load_dwordx4 v7, s[12:15], s72 offen offset:3072 lds
v_mfma_f32_16x16x32_bf16 v[176:179], v[92:95], v[112:115], v[176:179]
s_add_u32 s80, s77, 9216
ds_read_b64_tr_b16 v[54:55], v13 offset:33792
v_accvgpr_read_b32 v22, a104
v_mfma_f32_16x16x32_bf16 v[192:195], v[96:99], v[112:115], v[192:195]
ds_read_b64_tr_b16 v[56:57], v14 offset:32768
v_accvgpr_read_b32 v30, a105
v_mfma_f32_16x16x32_bf16 v[196:199], v[96:99], v[116:119], v[196:199]
ds_read_b64_tr_b16 v[58:59], v14 offset:33792
v_accvgpr_read_b32 v23, a106
v_mfma_f32_16x16x32_bf16 v[200:203], v[96:99], v[120:123], v[200:203]
ds_read_b64_tr_b16 v[60:61], v15 offset:32768
v_accvgpr_read_b32 v31, a107
v_mfma_f32_16x16x32_bf16 v[204:207], v[96:99], v[124:127], v[204:207]
s_add_u32 m0, s63, 65536
ds_read_b64_tr_b16 v[62:63], v15 offset:33792
v_mul_f32 v20, s79, v20
v_mfma_f32_16x16x32_bf16 v[220:223], v[100:103], v[124:127], v[220:223]
s_add_u32 s72, s69, 0
buffer_load_dwordx4 v4, s[4:7], s72 offen lds
v_mfma_f32_16x16x32_bf16 v[216:219], v[100:103], v[120:123], v[216:219]
v_mul_f32 v28, s79, v28
v_mul_f32 v21, s79, v21
v_mfma_f32_16x16x32_bf16 v[212:215], v[100:103], v[116:119], v[212:215]
v_mul_f32 v29, s79, v29
v_mul_f32 v22, s79, v22
v_mfma_f32_16x16x32_bf16 v[208:211], v[100:103], v[112:115], v[208:211]
v_mul_f32 v30, s79, v30
v_mul_f32 v23, s79, v23
v_mfma_f32_16x16x32_bf16 v[224:227], v[104:107], v[112:115], v[224:227]
s_add_u32 s72, s69, 15360
buffer_load_dwordx4 v5, s[4:7], s72 offen offset:1024 lds
v_mfma_f32_16x16x32_bf16 v[228:231], v[104:107], v[116:119], v[228:231]
v_mul_f32 v31, s79, v31
v_cvt_pk_bf16_f32 v20, v20, v28
v_mfma_f32_16x16x32_bf16 v[232:235], v[104:107], v[120:123], v[232:235]
v_cvt_pk_bf16_f32 v21, v21, v29
v_cvt_pk_bf16_f32 v22, v22, v30
v_mfma_f32_16x16x32_bf16 v[236:239], v[104:107], v[124:127], v[236:239]
v_cvt_pk_bf16_f32 v23, v23, v31
v_mfma_f32_16x16x32_bf16 v[252:255], v[108:111], v[124:127], v[252:255]
buffer_store_dwordx4 v[20:23], v1, s[44:47], s80 offen sc1
v_mfma_f32_16x16x32_bf16 v[248:251], v[108:111], v[120:123], v[248:251]
s_add_u32 s72, s69, 30720
buffer_load_dwordx4 v4, s[4:7], s72 offen offset:2048 lds
v_mfma_f32_16x16x32_bf16 v[244:247], v[108:111], v[116:119], v[244:247]
v_accvgpr_read_b32 v24, a208
v_accvgpr_read_b32 v28, a209
v_mfma_f32_16x16x32_bf16 v[240:243], v[108:111], v[112:115], v[240:243]
s_waitcnt lgkmcnt(0)
v_accvgpr_read_b32 v25, a210
v_accvgpr_read_b32 v29, a211
LcB1:
v_mfma_f32_16x16x32_bf16 v[128:131], v[32:35], v[64:67], v[128:131]
s_add_u32 s80, s78, 34816
ds_read_b64_tr_b16 v[80:81], v8 offset:40960
ds_read_b64_tr_b16 v[82:83], v8 offset:41984
v_mfma_f32_16x16x32_bf16 v[132:135], v[32:35], v[68:71], v[132:135]
ds_read_b128 v[112:115], v19 offset:32768
ds_read_b128 v[116:119], v19 offset:34816
v_mfma_f32_16x16x32_bf16 v[136:139], v[32:35], v[72:75], v[136:139]
s_add_u32 s72, s69, 46080
buffer_load_dwordx4 v5, s[4:7], s72 offen offset:3072 lds
v_mfma_f32_16x16x32_bf16 v[140:143], v[32:35], v[76:79], v[140:143]
ds_read_b128 v[120:123], v19 offset:36864
ds_read_b128 v[124:127], v19 offset:38912
v_mfma_f32_16x16x32_bf16 v[156:159], v[36:39], v[76:79], v[156:159]
ds_read_b64_tr_b16 v[84:85], v9 offset:40960
ds_read_b64_tr_b16 v[86:87], v9 offset:41984
v_mfma_f32_16x16x32_bf16 v[152:155], v[36:39], v[72:75], v[152:155]
ds_read_b64_tr_b16 v[88:89], v10 offset:40960
v_accvgpr_read_b32 v26, a212
v_mfma_f32_16x16x32_bf16 v[148:151], v[36:39], v[68:71], v[148:151]
ds_read_b64_tr_b16 v[90:91], v10 offset:41984
v_accvgpr_read_b32 v30, a213
v_mfma_f32_16x16x32_bf16 v[144:147], v[36:39], v[64:67], v[144:147]
s_add_u32 m0, s63, 69632
ds_read_b64_tr_b16 v[92:93], v11 offset:40960
v_accvgpr_read_b32 v27, a214
v_mfma_f32_16x16x32_bf16 v[160:163], v[40:43], v[64:67], v[160:163]
s_add_u32 s72, s70, 0
buffer_load_dwordx4 v4, s[4:7], s72 offen lds
v_mfma_f32_16x16x32_bf16 v[164:167], v[40:43], v[68:71], v[164:167]
ds_read_b64_tr_b16 v[94:95], v11 offset:41984
v_accvgpr_read_b32 v31, a215
v_mfma_f32_16x16x32_bf16 v[168:171], v[40:43], v[72:75], v[168:171]
ds_read_b64_tr_b16 v[96:97], v12 offset:40960
v_cvt_pk_bf16_f32 v24, v24, v28
v_mfma_f32_16x16x32_bf16 v[172:175], v[40:43], v[76:79], v[172:175]
ds_read_b64_tr_b16 v[98:99], v12 offset:41984
v_cvt_pk_bf16_f32 v25, v25, v29
v_mfma_f32_16x16x32_bf16 v[188:191], v[44:47], v[76:79], v[188:191]
s_add_u32 s72, s70, 15360
buffer_load_dwordx4 v5, s[4:7], s72 offen offset:1024 lds
v_mfma_f32_16x16x32_bf16 v[184:187], v[44:47], v[72:75], v[184:187]
ds_read_b64_tr_b16 v[100:101], v13 offset:40960
v_cvt_pk_bf16_f32 v26, v26, v30
v_mfma_f32_16x16x32_bf16 v[180:183], v[44:47], v[68:71], v[180:183]
ds_read_b64_tr_b16 v[102:103], v13 offset:41984
v_cvt_pk_bf16_f32 v27, v27, v31
v_mfma_f32_16x16x32_bf16 v[176:179], v[44:47], v[64:67], v[176:179]
ds_read_b64_tr_b16 v[104:105], v14 offset:40960
v_mfma_f32_16x16x32_bf16 v[192:195], v[48:51], v[64:67], v[192:195]
ds_read_b64_tr_b16 v[106:107], v14 offset:41984
v_mfma_f32_16x16x32_bf16 v[196:199], v[48:51], v[68:71], v[196:199]
s_add_u32 s72, s70, 30720
buffer_load_dwordx4 v4, s[4:7], s72 offen offset:2048 lds
v_mfma_f32_16x16x32_bf16 v[200:203], v[48:51], v[72:75], v[200:203]
ds_read_b64_tr_b16 v[108:109], v15 offset:40960
v_mfma_f32_16x16x32_bf16 v[204:207], v[48:51], v[76:79], v[204:207]
ds_read_b64_tr_b16 v[110:111], v15 offset:41984
v_mfma_f32_16x16x32_bf16 v[220:223], v[52:55], v[76:79], v[220:223]
buffer_store_dwordx4 v[24:27], v1, s[44:47], s80 offen sc1
v_mfma_f32_16x16x32_bf16 v[216:219], v[52:55], v[72:75], v[216:219]
v_accvgpr_read_b32 v20, a76
v_accvgpr_read_b32 v28, a77
v_mfma_f32_16x16x32_bf16 v[212:215], v[52:55], v[68:71], v[212:215]
s_add_u32 s72, s70, 46080
buffer_load_dwordx4 v5, s[4:7], s72 offen offset:3072 lds
v_mfma_f32_16x16x32_bf16 v[208:211], v[52:55], v[64:67], v[208:211]
v_accvgpr_read_b32 v21, a78
v_accvgpr_read_b32 v29, a79
v_mfma_f32_16x16x32_bf16 v[224:227], v[56:59], v[64:67], v[224:227]
s_add_u32 s80, s77, 13312
v_accvgpr_read_b32 v22, a108
v_accvgpr_read_b32 v30, a109
v_mfma_f32_16x16x32_bf16 v[228:231], v[56:59], v[68:71], v[228:231]
v_accvgpr_read_b32 v23, a110
v_accvgpr_read_b32 v31, a111
v_mfma_f32_16x16x32_bf16 v[232:235], v[56:59], v[72:75], v[232:235]
v_mul_f32 v20, s79, v20
v_mul_f32 v28, s79, v28
v_mfma_f32_16x16x32_bf16 v[236:239], v[56:59], v[76:79], v[236:239]
v_mul_f32 v21, s79, v21
v_mul_f32 v29, s79, v29
v_mfma_f32_16x16x32_bf16 v[252:255], v[60:63], v[76:79], v[252:255]
v_mul_f32 v22, s79, v22
v_mul_f32 v30, s79, v30
v_mfma_f32_16x16x32_bf16 v[248:251], v[60:63], v[72:75], v[248:251]
v_mul_f32 v23, s79, v23
v_mul_f32 v31, s79, v31
v_mfma_f32_16x16x32_bf16 v[244:247], v[60:63], v[68:71], v[244:247]
s_waitcnt vmcnt(15) lgkmcnt(0)
v_cvt_pk_bf16_f32 v20, v20, v28
v_cvt_pk_bf16_f32 v21, v21, v29
v_mfma_f32_16x16x32_bf16 v[240:243], v[60:63], v[64:67], v[240:243]
s_barrier
v_cvt_pk_bf16_f32 v22, v22, v30
v_cvt_pk_bf16_f32 v23, v23, v31
v_mfma_f32_16x16x32_bf16 v[128:131], v[80:83], v[112:115], v[128:131]
s_add_u32 s73, s62, 11
ds_read_b64_tr_b16 v[32:33], v8 offset:0
ds_read_b64_tr_b16 v[34:35], v8 offset:1024
v_mfma_f32_16x16x32_bf16 v[132:135], v[80:83], v[116:119], v[132:135]
s_add_u32 s70, s73, s65
ds_read_b128 v[64:67], v16 offset:0
ds_read_b128 v[68:71], v16 offset:2048
v_mfma_f32_16x16x32_bf16 v[136:139], v[80:83], v[120:123], v[136:139]
s_and_b32 s70, s70, 3
ds_read_b128 v[72:75], v16 offset:4096
ds_read_b128 v[76:79], v16 offset:6144
v_mfma_f32_16x16x32_bf16 v[140:143], v[80:83], v[124:127], v[140:143]
s_and_b32 s73, s73, 12
ds_read_b64_tr_b16 v[36:37], v9 offset:0
ds_read_b64_tr_b16 v[38:39], v9 offset:1024
v_mfma_f32_16x16x32_bf16 v[156:159], v[84:87], v[124:127], v[156:159]
s_or_b32 s73, s73, s70
ds_read_b64_tr_b16 v[40:41], v10 offset:0
v_mfma_f32_16x16x32_bf16 v[152:155], v[84:87], v[120:123], v[152:155]
s_lshl_b32 s71, s73, 19
ds_read_b64_tr_b16 v[42:43], v10 offset:1024
v_mfma_f32_16x16x32_bf16 v[148:151], v[84:87], v[116:119], v[148:151]
s_add_u32 s71, s71, s66
ds_read_b64_tr_b16 v[44:45], v11 offset:0
v_mfma_f32_16x16x32_bf16 v[144:147], v[84:87], v[112:115], v[144:147]
s_lshl_b32 s73, s73, 7
ds_read_b64_tr_b16 v[46:47], v11 offset:1024
v_mfma_f32_16x16x32_bf16 v[160:163], v[88:91], v[112:115], v[160:163]
s_add_u32 s69, s73, s67
ds_read_b64_tr_b16 v[48:49], v12 offset:0
v_mfma_f32_16x16x32_bf16 v[164:167], v[88:91], v[116:119], v[164:167]
s_add_u32 s70, s73, s68
ds_read_b64_tr_b16 v[50:51], v12 offset:1024
v_mfma_f32_16x16x32_bf16 v[168:171], v[88:91], v[120:123], v[168:171]
s_add_u32 m0, s64, 32768
ds_read_b64_tr_b16 v[52:53], v13 offset:0
v_mfma_f32_16x16x32_bf16 v[172:175], v[88:91], v[124:127], v[172:175]
s_add_u32 s72, s71, 0
buffer_load_dwordx4 v6, s[12:15], s72 offen lds
v_mfma_f32_16x16x32_bf16 v[188:191], v[92:95], v[124:127], v[188:191]
s_add_u32 s72, s71, 31744
buffer_load_dwordx4 v6, s[12:15], s72 offen offset:1024 lds
v_mfma_f32_16x16x32_bf16 v[184:187], v[92:95], v[120:123], v[184:187]
s_add_u32 s72, s71, 63488
buffer_load_dwordx4 v7, s[12:15], s72 offen offset:2048 lds
v_mfma_f32_16x16x32_bf16 v[180:183], v[92:95], v[116:119], v[180:183]
s_add_u32 s72, s71, 95232
buffer_load_dwordx4 v7, s[12:15], s72 offen offset:3072 lds
v_mfma_f32_16x16x32_bf16 v[176:179], v[92:95], v[112:115], v[176:179]
ds_read_b64_tr_b16 v[54:55], v13 offset:1024
v_mfma_f32_16x16x32_bf16 v[192:195], v[96:99], v[112:115], v[192:195]
ds_read_b64_tr_b16 v[56:57], v14 offset:0
v_mfma_f32_16x16x32_bf16 v[196:199], v[96:99], v[116:119], v[196:199]
ds_read_b64_tr_b16 v[58:59], v14 offset:1024
v_mfma_f32_16x16x32_bf16 v[200:203], v[96:99], v[120:123], v[200:203]
ds_read_b64_tr_b16 v[60:61], v15 offset:0
v_mfma_f32_16x16x32_bf16 v[204:207], v[96:99], v[124:127], v[204:207]
s_add_u32 m0, s63, 98304
ds_read_b64_tr_b16 v[62:63], v15 offset:1024
v_mfma_f32_16x16x32_bf16 v[220:223], v[100:103], v[124:127], v[220:223]
s_add_u32 s72, s69, 0
buffer_load_dwordx4 v4, s[4:7], s72 offen lds
v_mfma_f32_16x16x32_bf16 v[216:219], v[100:103], v[120:123], v[216:219]
buffer_store_dwordx4 v[20:23], v1, s[44:47], s80 offen sc1
v_mfma_f32_16x16x32_bf16 v[212:215], v[100:103], v[116:119], v[212:215]
v_accvgpr_read_b32 v24, a216
v_accvgpr_read_b32 v28, a217
v_mfma_f32_16x16x32_bf16 v[208:211], v[100:103], v[112:115], v[208:211]
v_accvgpr_read_b32 v25, a218
v_accvgpr_read_b32 v29, a219
v_mfma_f32_16x16x32_bf16 v[224:227], v[104:107], v[112:115], v[224:227]
s_add_u32 s72, s69, 15360
buffer_load_dwordx4 v5, s[4:7], s72 offen offset:1024 lds
v_mfma_f32_16x16x32_bf16 v[228:231], v[104:107], v[116:119], v[228:231]
s_add_u32 s80, s78, 43008
v_accvgpr_read_b32 v26, a220
v_accvgpr_read_b32 v30, a221
v_mfma_f32_16x16x32_bf16 v[232:235], v[104:107], v[120:123], v[232:235]
v_accvgpr_read_b32 v27, a222
v_accvgpr_read_b32 v31, a223
v_mfma_f32_16x16x32_bf16 v[236:239], v[104:107], v[124:127], v[236:239]
v_cvt_pk_bf16_f32 v24, v24, v28
v_cvt_pk_bf16_f32 v25, v25, v29
v_mfma_f32_16x16x32_bf16 v[252:255], v[108:111], v[124:127], v[252:255]
v_cvt_pk_bf16_f32 v26, v26, v30
v_cvt_pk_bf16_f32 v27, v27, v31
v_mfma_f32_16x16x32_bf16 v[248:251], v[108:111], v[120:123], v[248:251]
s_add_u32 s72, s69, 30720
buffer_load_dwordx4 v4, s[4:7], s72 offen offset:2048 lds
v_mfma_f32_16x16x32_bf16 v[244:247], v[108:111], v[116:119], v[244:247]
buffer_store_dwordx4 v[24:27], v1, s[44:47], s80 offen sc1
v_mfma_f32_16x16x32_bf16 v[240:243], v[108:111], v[112:115], v[240:243]
s_waitcnt lgkmcnt(0)
v_mfma_f32_16x16x32_bf16 v[128:131], v[32:35], v[64:67], v[128:131]
ds_read_b64_tr_b16 v[80:81], v8 offset:8192
ds_read_b64_tr_b16 v[82:83], v8 offset:9216
v_mfma_f32_16x16x32_bf16 v[132:135], v[32:35], v[68:71], v[132:135]
ds_read_b128 v[112:115], v17 offset:0
ds_read_b128 v[116:119], v17 offset:2048
v_mfma_f32_16x16x32_bf16 v[136:139], v[32:35], v[72:75], v[136:139]
s_add_u32 s72, s69, 46080
buffer_load_dwordx4 v5, s[4:7], s72 offen offset:3072 lds
v_mfma_f32_16x16x32_bf16 v[140:143], v[32:35], v[76:79], v[140:143]
ds_read_b128 v[120:123], v17 offset:4096
ds_read_b128 v[124:127], v17 offset:6144
v_mfma_f32_16x16x32_bf16 v[156:159], v[36:39], v[76:79], v[156:159]
ds_read_b64_tr_b16 v[84:85], v9 offset:8192
ds_read_b64_tr_b16 v[86:87], v9 offset:9216
v_mfma_f32_16x16x32_bf16 v[152:155], v[36:39], v[72:75], v[152:155]
ds_read_b64_tr_b16 v[88:89], v10 offset:8192
v_accvgpr_read_b32 v20, a80
v_mfma_f32_16x16x32_bf16 v[148:151], v[36:39], v[68:71], v[148:151]
ds_read_b64_tr_b16 v[90:91], v10 offset:9216
v_accvgpr_read_b32 v28, a81
v_mfma_f32_16x16x32_bf16 v[144:147], v[36:39], v[64:67], v[144:147]
s_add_u32 m0, s63, 102400
ds_read_b64_tr_b16 v[92:93], v11 offset:8192
v_accvgpr_read_b32 v21, a82
v_mfma_f32_16x16x32_bf16 v[160:163], v[40:43], v[64:67], v[160:163]
s_add_u32 s72, s70, 0
buffer_load_dwordx4 v4, s[4:7], s72 offen lds
v_mfma_f32_16x16x32_bf16 v[164:167], v[40:43], v[68:71], v[164:167]
ds_read_b64_tr_b16 v[94:95], v11 offset:9216
v_accvgpr_read_b32 v29, a83
v_mfma_f32_16x16x32_bf16 v[168:171], v[40:43], v[72:75], v[168:171]
s_add_u32 s80, s77, 33792
ds_read_b64_tr_b16 v[96:97], v12 offset:8192
v_accvgpr_read_b32 v22, a112
v_mfma_f32_16x16x32_bf16 v[172:175], v[40:43], v[76:79], v[172:175]
ds_read_b64_tr_b16 v[98:99], v12 offset:9216
v_accvgpr_read_b32 v30, a113
v_mfma_f32_16x16x32_bf16 v[188:191], v[44:47], v[76:79], v[188:191]
s_add_u32 s72, s70, 15360
buffer_load_dwordx4 v5, s[4:7], s72 offen offset:1024 lds
v_mfma_f32_16x16x32_bf16 v[184:187], v[44:47], v[72:75], v[184:187]
ds_read_b64_tr_b16 v[100:101], v13 offset:8192
v_accvgpr_read_b32 v23, a114
v_mfma_f32_16x16x32_bf16 v[180:183], v[44:47], v[68:71], v[180:183]
ds_read_b64_tr_b16 v[102:103], v13 offset:9216
v_accvgpr_read_b32 v31, a115
v_mfma_f32_16x16x32_bf16 v[176:179], v[44:47], v[64:67], v[176:179]
ds_read_b64_tr_b16 v[104:105], v14 offset:8192
v_mul_f32 v20, s79, v20
v_mfma_f32_16x16x32_bf16 v[192:195], v[48:51], v[64:67], v[192:195]
ds_read_b64_tr_b16 v[106:107], v14 offset:9216
v_mul_f32 v28, s79, v28
v_mfma_f32_16x16x32_bf16 v[196:199], v[48:51], v[68:71], v[196:199]
s_add_u32 s72, s70, 30720
buffer_load_dwordx4 v4, s[4:7], s72 offen offset:2048 lds
v_mfma_f32_16x16x32_bf16 v[200:203], v[48:51], v[72:75], v[200:203]
ds_read_b64_tr_b16 v[108:109], v15 offset:8192
v_mul_f32 v21, s79, v21
v_mfma_f32_16x16x32_bf16 v[204:207], v[48:51], v[76:79], v[204:207]
ds_read_b64_tr_b16 v[110:111], v15 offset:9216
v_mul_f32 v29, s79, v29
v_mfma_f32_16x16x32_bf16 v[220:223], v[52:55], v[76:79], v[220:223]
v_mul_f32 v22, s79, v22
v_mul_f32 v30, s79, v30
v_mfma_f32_16x16x32_bf16 v[216:219], v[52:55], v[72:75], v[216:219]
v_mul_f32 v23, s79, v23
v_mul_f32 v31, s79, v31
v_mfma_f32_16x16x32_bf16 v[212:215], v[52:55], v[68:71], v[212:215]
s_add_u32 s72, s70, 46080
buffer_load_dwordx4 v5, s[4:7], s72 offen offset:3072 lds
v_mfma_f32_16x16x32_bf16 v[208:211], v[52:55], v[64:67], v[208:211]
v_cvt_pk_bf16_f32 v20, v20, v28
v_cvt_pk_bf16_f32 v21, v21, v29
v_mfma_f32_16x16x32_bf16 v[224:227], v[56:59], v[64:67], v[224:227]
v_cvt_pk_bf16_f32 v22, v22, v30
v_cvt_pk_bf16_f32 v23, v23, v31
v_mfma_f32_16x16x32_bf16 v[228:231], v[56:59], v[68:71], v[228:231]
buffer_store_dwordx4 v[20:23], v1, s[44:47], s80 offen sc1
v_mfma_f32_16x16x32_bf16 v[232:235], v[56:59], v[72:75], v[232:235]
v_accvgpr_read_b32 v24, a224
v_accvgpr_read_b32 v28, a225
v_mfma_f32_16x16x32_bf16 v[236:239], v[56:59], v[76:79], v[236:239]
v_accvgpr_read_b32 v25, a226
v_accvgpr_read_b32 v29, a227
v_mfma_f32_16x16x32_bf16 v[252:255], v[60:63], v[76:79], v[252:255]
s_add_u32 s80, s78, 3072
v_accvgpr_read_b32 v26, a228
v_accvgpr_read_b32 v30, a229
v_mfma_f32_16x16x32_bf16 v[248:251], v[60:63], v[72:75], v[248:251]
v_accvgpr_read_b32 v27, a230
v_accvgpr_read_b32 v31, a231
v_mfma_f32_16x16x32_bf16 v[244:247], v[60:63], v[68:71], v[244:247]
s_waitcnt vmcnt(15) lgkmcnt(0)
v_cvt_pk_bf16_f32 v24, v24, v28
v_cvt_pk_bf16_f32 v25, v25, v29
v_mfma_f32_16x16x32_bf16 v[240:243], v[60:63], v[64:67], v[240:243]
s_barrier
v_cvt_pk_bf16_f32 v26, v26, v30
v_cvt_pk_bf16_f32 v27, v27, v31
v_mfma_f32_16x16x32_bf16 v[128:131], v[80:83], v[112:115], v[128:131]
s_add_u32 s73, s62, 12
ds_read_b64_tr_b16 v[32:33], v8 offset:16384
ds_read_b64_tr_b16 v[34:35], v8 offset:17408
v_mfma_f32_16x16x32_bf16 v[132:135], v[80:83], v[116:119], v[132:135]
s_add_u32 s70, s73, s65
ds_read_b128 v[64:67], v18 offset:0
ds_read_b128 v[68:71], v18 offset:2048
v_mfma_f32_16x16x32_bf16 v[136:139], v[80:83], v[120:123], v[136:139]
s_and_b32 s70, s70, 3
ds_read_b128 v[72:75], v18 offset:4096
ds_read_b128 v[76:79], v18 offset:6144
v_mfma_f32_16x16x32_bf16 v[140:143], v[80:83], v[124:127], v[140:143]
s_and_b32 s73, s73, 12
ds_read_b64_tr_b16 v[36:37], v9 offset:16384
ds_read_b64_tr_b16 v[38:39], v9 offset:17408
v_mfma_f32_16x16x32_bf16 v[156:159], v[84:87], v[124:127], v[156:159]
s_or_b32 s73, s73, s70
ds_read_b64_tr_b16 v[40:41], v10 offset:16384
v_mfma_f32_16x16x32_bf16 v[152:155], v[84:87], v[120:123], v[152:155]
s_lshl_b32 s71, s73, 19
ds_read_b64_tr_b16 v[42:43], v10 offset:17408
v_mfma_f32_16x16x32_bf16 v[148:151], v[84:87], v[116:119], v[148:151]
s_add_u32 s71, s71, s66
ds_read_b64_tr_b16 v[44:45], v11 offset:16384
v_mfma_f32_16x16x32_bf16 v[144:147], v[84:87], v[112:115], v[144:147]
s_lshl_b32 s73, s73, 7
ds_read_b64_tr_b16 v[46:47], v11 offset:17408
v_mfma_f32_16x16x32_bf16 v[160:163], v[88:91], v[112:115], v[160:163]
s_add_u32 s69, s73, s67
ds_read_b64_tr_b16 v[48:49], v12 offset:16384
v_mfma_f32_16x16x32_bf16 v[164:167], v[88:91], v[116:119], v[164:167]
s_add_u32 s70, s73, s68
ds_read_b64_tr_b16 v[50:51], v12 offset:17408
v_mfma_f32_16x16x32_bf16 v[168:171], v[88:91], v[120:123], v[168:171]
s_add_u32 m0, s64, 0
ds_read_b64_tr_b16 v[52:53], v13 offset:16384
v_mfma_f32_16x16x32_bf16 v[172:175], v[88:91], v[124:127], v[172:175]
s_add_u32 s72, s71, 0
buffer_load_dwordx4 v6, s[12:15], s72 offen lds
v_mfma_f32_16x16x32_bf16 v[188:191], v[92:95], v[124:127], v[188:191]
s_add_u32 s72, s71, 31744
buffer_load_dwordx4 v6, s[12:15], s72 offen offset:1024 lds
v_mfma_f32_16x16x32_bf16 v[184:187], v[92:95], v[120:123], v[184:187]
s_add_u32 s72, s71, 63488
buffer_load_dwordx4 v7, s[12:15], s72 offen offset:2048 lds
v_mfma_f32_16x16x32_bf16 v[180:183], v[92:95], v[116:119], v[180:183]
s_add_u32 s72, s71, 95232
buffer_load_dwordx4 v7, s[12:15], s72 offen offset:3072 lds
v_mfma_f32_16x16x32_bf16 v[176:179], v[92:95], v[112:115], v[176:179]
ds_read_b64_tr_b16 v[54:55], v13 offset:17408
v_mfma_f32_16x16x32_bf16 v[192:195], v[96:99], v[112:115], v[192:195]
ds_read_b64_tr_b16 v[56:57], v14 offset:16384
v_mfma_f32_16x16x32_bf16 v[196:199], v[96:99], v[116:119], v[196:199]
ds_read_b64_tr_b16 v[58:59], v14 offset:17408
v_mfma_f32_16x16x32_bf16 v[200:203], v[96:99], v[120:123], v[200:203]
ds_read_b64_tr_b16 v[60:61], v15 offset:16384
v_mfma_f32_16x16x32_bf16 v[204:207], v[96:99], v[124:127], v[204:207]
s_add_u32 m0, s63, 131072
ds_read_b64_tr_b16 v[62:63], v15 offset:17408
v_mfma_f32_16x16x32_bf16 v[220:223], v[100:103], v[124:127], v[220:223]
s_add_u32 s72, s69, 0
buffer_load_dwordx4 v4, s[4:7], s72 offen lds
v_mfma_f32_16x16x32_bf16 v[216:219], v[100:103], v[120:123], v[216:219]
buffer_store_dwordx4 v[24:27], v1, s[44:47], s80 offen sc1
v_mfma_f32_16x16x32_bf16 v[212:215], v[100:103], v[116:119], v[212:215]
v_accvgpr_read_b32 v20, a84
v_accvgpr_read_b32 v28, a85
v_mfma_f32_16x16x32_bf16 v[208:211], v[100:103], v[112:115], v[208:211]
v_accvgpr_read_b32 v21, a86
v_accvgpr_read_b32 v29, a87
v_mfma_f32_16x16x32_bf16 v[224:227], v[104:107], v[112:115], v[224:227]
s_add_u32 s72, s69, 15360
buffer_load_dwordx4 v5, s[4:7], s72 offen offset:1024 lds
v_mfma_f32_16x16x32_bf16 v[228:231], v[104:107], v[116:119], v[228:231]
s_add_u32 s80, s77, 37888
v_accvgpr_read_b32 v22, a116
v_accvgpr_read_b32 v30, a117
v_mfma_f32_16x16x32_bf16 v[232:235], v[104:107], v[120:123], v[232:235]
v_accvgpr_read_b32 v23, a118
v_accvgpr_read_b32 v31, a119
v_mfma_f32_16x16x32_bf16 v[236:239], v[104:107], v[124:127], v[236:239]
v_mul_f32 v20, s79, v20
v_mul_f32 v28, s79, v28
v_mfma_f32_16x16x32_bf16 v[252:255], v[108:111], v[124:127], v[252:255]
v_mul_f32 v21, s79, v21
v_mul_f32 v29, s79, v29
v_mfma_f32_16x16x32_bf16 v[248:251], v[108:111], v[120:123], v[248:251]
s_add_u32 s72, s69, 30720
buffer_load_dwordx4 v4, s[4:7], s72 offen offset:2048 lds
v_mfma_f32_16x16x32_bf16 v[244:247], v[108:111], v[116:119], v[244:247]
v_mul_f32 v22, s79, v22
v_mul_f32 v30, s79, v30
v_mfma_f32_16x16x32_bf16 v[240:243], v[108:111], v[112:115], v[240:243]
s_waitcnt lgkmcnt(0)
v_mul_f32 v23, s79, v23
v_mul_f32 v31, s79, v31
v_mfma_f32_16x16x32_bf16 v[128:131], v[32:35], v[64:67], v[128:131]
ds_read_b64_tr_b16 v[80:81], v8 offset:24576
ds_read_b64_tr_b16 v[82:83], v8 offset:25600
v_mfma_f32_16x16x32_bf16 v[132:135], v[32:35], v[68:71], v[132:135]
ds_read_b128 v[112:115], v19 offset:0
ds_read_b128 v[116:119], v19 offset:2048
v_mfma_f32_16x16x32_bf16 v[136:139], v[32:35], v[72:75], v[136:139]
s_add_u32 s72, s69, 46080
buffer_load_dwordx4 v5, s[4:7], s72 offen offset:3072 lds
v_mfma_f32_16x16x32_bf16 v[140:143], v[32:35], v[76:79], v[140:143]
ds_read_b128 v[120:123], v19 offset:4096
ds_read_b128 v[124:127], v19 offset:6144
v_mfma_f32_16x16x32_bf16 v[156:159], v[36:39], v[76:79], v[156:159]
ds_read_b64_tr_b16 v[84:85], v9 offset:24576
ds_read_b64_tr_b16 v[86:87], v9 offset:25600
v_mfma_f32_16x16x32_bf16 v[152:155], v[36:39], v[72:75], v[152:155]
ds_read_b64_tr_b16 v[88:89], v10 offset:24576
v_cvt_pk_bf16_f32 v20, v20, v28
v_mfma_f32_16x16x32_bf16 v[148:151], v[36:39], v[68:71], v[148:151]
ds_read_b64_tr_b16 v[90:91], v10 offset:25600
v_cvt_pk_bf16_f32 v21, v21, v29
v_mfma_f32_16x16x32_bf16 v[144:147], v[36:39], v[64:67], v[144:147]
s_add_u32 m0, s63, 135168
ds_read_b64_tr_b16 v[92:93], v11 offset:24576
v_cvt_pk_bf16_f32 v22, v22, v30
v_mfma_f32_16x16x32_bf16 v[160:163], v[40:43], v[64:67], v[160:163]
s_add_u32 s72, s70, 0
buffer_load_dwordx4 v4, s[4:7], s72 offen lds
v_mfma_f32_16x16x32_bf16 v[164:167], v[40:43], v[68:71], v[164:167]
ds_read_b64_tr_b16 v[94:95], v11 offset:25600
v_cvt_pk_bf16_f32 v23, v23, v31
v_mfma_f32_16x16x32_bf16 v[168:171], v[40:43], v[72:75], v[168:171]
ds_read_b64_tr_b16 v[96:97], v12 offset:24576
v_mfma_f32_16x16x32_bf16 v[172:175], v[40:43], v[76:79], v[172:175]
ds_read_b64_tr_b16 v[98:99], v12 offset:25600
v_mfma_f32_16x16x32_bf16 v[188:191], v[44:47], v[76:79], v[188:191]
s_add_u32 s72, s70, 15360
buffer_load_dwordx4 v5, s[4:7], s72 offen offset:1024 lds
v_mfma_f32_16x16x32_bf16 v[184:187], v[44:47], v[72:75], v[184:187]
ds_read_b64_tr_b16 v[100:101], v13 offset:24576
v_mfma_f32_16x16x32_bf16 v[180:183], v[44:47], v[68:71], v[180:183]
ds_read_b64_tr_b16 v[102:103], v13 offset:25600
v_mfma_f32_16x16x32_bf16 v[176:179], v[44:47], v[64:67], v[176:179]
ds_read_b64_tr_b16 v[104:105], v14 offset:24576
v_mfma_f32_16x16x32_bf16 v[192:195], v[48:51], v[64:67], v[192:195]
ds_read_b64_tr_b16 v[106:107], v14 offset:25600
v_mfma_f32_16x16x32_bf16 v[196:199], v[48:51], v[68:71], v[196:199]
s_add_u32 s72, s70, 30720
buffer_load_dwordx4 v4, s[4:7], s72 offen offset:2048 lds
v_mfma_f32_16x16x32_bf16 v[200:203], v[48:51], v[72:75], v[200:203]
ds_read_b64_tr_b16 v[108:109], v15 offset:24576
v_mfma_f32_16x16x32_bf16 v[204:207], v[48:51], v[76:79], v[204:207]
ds_read_b64_tr_b16 v[110:111], v15 offset:25600
v_mfma_f32_16x16x32_bf16 v[220:223], v[52:55], v[76:79], v[220:223]
buffer_store_dwordx4 v[20:23], v1, s[44:47], s80 offen sc1
v_mfma_f32_16x16x32_bf16 v[216:219], v[52:55], v[72:75], v[216:219]
v_accvgpr_read_b32 v24, a232
v_accvgpr_read_b32 v28, a233
v_mfma_f32_16x16x32_bf16 v[212:215], v[52:55], v[68:71], v[212:215]
s_add_u32 s72, s70, 46080
buffer_load_dwordx4 v5, s[4:7], s72 offen offset:3072 lds
v_mfma_f32_16x16x32_bf16 v[208:211], v[52:55], v[64:67], v[208:211]
v_accvgpr_read_b32 v25, a234
v_accvgpr_read_b32 v29, a235
v_mfma_f32_16x16x32_bf16 v[224:227], v[56:59], v[64:67], v[224:227]
s_add_u32 s80, s78, 11264
v_accvgpr_read_b32 v26, a236
v_accvgpr_read_b32 v30, a237
v_mfma_f32_16x16x32_bf16 v[228:231], v[56:59], v[68:71], v[228:231]
v_accvgpr_read_b32 v27, a238
v_accvgpr_read_b32 v31, a239
v_mfma_f32_16x16x32_bf16 v[232:235], v[56:59], v[72:75], v[232:235]
v_cvt_pk_bf16_f32 v24, v24, v28
v_cvt_pk_bf16_f32 v25, v25, v29
v_mfma_f32_16x16x32_bf16 v[236:239], v[56:59], v[76:79], v[236:239]
v_cvt_pk_bf16_f32 v26, v26, v30
v_cvt_pk_bf16_f32 v27, v27, v31
v_mfma_f32_16x16x32_bf16 v[252:255], v[60:63], v[76:79], v[252:255]
buffer_store_dwordx4 v[24:27], v1, s[44:47], s80 offen sc1
v_mfma_f32_16x16x32_bf16 v[248:251], v[60:63], v[72:75], v[248:251]
v_mfma_f32_16x16x32_bf16 v[244:247], v[60:63], v[68:71], v[244:247]
s_waitcnt vmcnt(16) lgkmcnt(0)
v_mfma_f32_16x16x32_bf16 v[240:243], v[60:63], v[64:67], v[240:243]
s_barrier
v_mfma_f32_16x16x32_bf16 v[128:131], v[80:83], v[112:115], v[128:131]
s_add_u32 s73, s62, 13
ds_read_b64_tr_b16 v[32:33], v8 offset:32768
ds_read_b64_tr_b16 v[34:35], v8 offset:33792
v_mfma_f32_16x16x32_bf16 v[132:135], v[80:83], v[116:119], v[132:135]
s_add_u32 s70, s73, s65
ds_read_b128 v[64:67], v18 offset:32768
ds_read_b128 v[68:71], v18 offset:34816
v_mfma_f32_16x16x32_bf16 v[136:139], v[80:83], v[120:123], v[136:139]
s_and_b32 s70, s70, 3
v_and_b32 v2, 31, v0
v_lshlrev_b32 v2, 2, v2
v_mfma_f32_16x16x32_bf16 v[140:143], v[80:83], v[124:127], v[140:143]
s_and_b32 s73, s73, 12
buffer_load_dword v3, v2, s[48:51], 0 offen sc1
v_mfma_f32_16x16x32_bf16 v[156:159], v[84:87], v[124:127], v[156:159]
s_or_b32 s73, s73, s70
ds_read_b128 v[72:75], v18 offset:36864
ds_read_b128 v[76:79], v18 offset:38912
v_mfma_f32_16x16x32_bf16 v[152:155], v[84:87], v[120:123], v[152:155]
s_lshl_b32 s71, s73, 19
ds_read_b64_tr_b16 v[36:37], v9 offset:32768
ds_read_b64_tr_b16 v[38:39], v9 offset:33792
v_mfma_f32_16x16x32_bf16 v[148:151], v[84:87], v[116:119], v[148:151]
s_add_u32 s71, s71, s66
ds_read_b64_tr_b16 v[40:41], v10 offset:32768
v_accvgpr_read_b32 v20, a88
v_mfma_f32_16x16x32_bf16 v[144:147], v[84:87], v[112:115], v[144:147]
s_lshl_b32 s73, s73, 7
ds_read_b64_tr_b16 v[42:43], v10 offset:33792
v_accvgpr_read_b32 v28, a89
v_mfma_f32_16x16x32_bf16 v[160:163], v[88:91], v[112:115], v[160:163]
s_add_u32 s69, s73, s67
ds_read_b64_tr_b16 v[44:45], v11 offset:32768
v_accvgpr_read_b32 v21, a90
v_mfma_f32_16x16x32_bf16 v[164:167], v[88:91], v[116:119], v[164:167]
s_add_u32 s70, s73, s68
ds_read_b64_tr_b16 v[46:47], v11 offset:33792
v_accvgpr_read_b32 v29, a91
v_mfma_f32_16x16x32_bf16 v[168:171], v[88:91], v[120:123], v[168:171]
s_add_u32 m0, s64, 16384
ds_read_b64_tr_b16 v[48:49], v12 offset:32768
v_mfma_f32_16x16x32_bf16 v[172:175], v[88:91], v[124:127], v[172:175]
s_add_u32 s72, s71, 0
buffer_load_dwordx4 v6, s[12:15], s72 offen lds
v_mfma_f32_16x16x32_bf16 v[188:191], v[92:95], v[124:127], v[188:191]
s_add_u32 s72, s71, 31744
buffer_load_dwordx4 v6, s[12:15], s72 offen offset:1024 lds
v_mfma_f32_16x16x32_bf16 v[184:187], v[92:95], v[120:123], v[184:187]
s_add_u32 s72, s71, 63488
buffer_load_dwordx4 v7, s[12:15], s72 offen offset:2048 lds
v_mfma_f32_16x16x32_bf16 v[180:183], v[92:95], v[116:119], v[180:183]
s_add_u32 s72, s71, 95232
buffer_load_dwordx4 v7, s[12:15], s72 offen offset:3072 lds
v_mfma_f32_16x16x32_bf16 v[176:179], v[92:95], v[112:115], v[176:179]
s_add_u32 s80, s77, 41984
ds_read_b64_tr_b16 v[50:51], v12 offset:33792
v_accvgpr_read_b32 v22, a120
v_mfma_f32_16x16x32_bf16 v[192:195], v[96:99], v[112:115], v[192:195]
ds_read_b64_tr_b16 v[52:53], v13 offset:32768
v_accvgpr_read_b32 v30, a121
v_mfma_f32_16x16x32_bf16 v[196:199], v[96:99], v[116:119], v[196:199]
ds_read_b64_tr_b16 v[54:55], v13 offset:33792
v_accvgpr_read_b32 v23, a122
v_mfma_f32_16x16x32_bf16 v[200:203], v[96:99], v[120:123], v[200:203]
ds_read_b64_tr_b16 v[56:57], v14 offset:32768
v_accvgpr_read_b32 v31, a123
v_mfma_f32_16x16x32_bf16 v[204:207], v[96:99], v[124:127], v[204:207]
s_add_u32 m0, s63, 65536
ds_read_b64_tr_b16 v[58:59], v14 offset:33792
v_mul_f32 v20, s79, v20
v_mfma_f32_16x16x32_bf16 v[220:223], v[100:103], v[124:127], v[220:223]
s_add_u32 s72, s69, 0
buffer_load_dwordx4 v4, s[4:7], s72 offen lds
v_mfma_f32_16x16x32_bf16 v[216:219], v[100:103], v[120:123], v[216:219]
ds_read_b64_tr_b16 v[60:61], v15 offset:32768
v_mul_f32 v28, s79, v28
v_mfma_f32_16x16x32_bf16 v[212:215], v[100:103], v[116:119], v[212:215]
ds_read_b64_tr_b16 v[62:63], v15 offset:33792
v_mul_f32 v21, s79, v21
v_mfma_f32_16x16x32_bf16 v[208:211], v[100:103], v[112:115], v[208:211]
v_mul_f32 v29, s79, v29
v_mul_f32 v22, s79, v22
v_mfma_f32_16x16x32_bf16 v[224:227], v[104:107], v[112:115], v[224:227]
s_add_u32 s72, s69, 15360
buffer_load_dwordx4 v5, s[4:7], s72 offen offset:1024 lds
v_mfma_f32_16x16x32_bf16 v[228:231], v[104:107], v[116:119], v[228:231]
v_mul_f32 v30, s79, v30
v_mul_f32 v23, s79, v23
v_mfma_f32_16x16x32_bf16 v[232:235], v[104:107], v[120:123], v[232:235]
v_mul_f32 v31, s79, v31
v_cvt_pk_bf16_f32 v20, v20, v28
v_mfma_f32_16x16x32_bf16 v[236:239], v[104:107], v[124:127], v[236:239]
v_cvt_pk_bf16_f32 v21, v21, v29
v_cvt_pk_bf16_f32 v22, v22, v30
v_mfma_f32_16x16x32_bf16 v[252:255], v[108:111], v[124:127], v[252:255]
v_cvt_pk_bf16_f32 v23, v23, v31
v_mfma_f32_16x16x32_bf16 v[248:251], v[108:111], v[120:123], v[248:251]
s_add_u32 s72, s69, 30720
buffer_load_dwordx4 v4, s[4:7], s72 offen offset:2048 lds
v_mfma_f32_16x16x32_bf16 v[244:247], v[108:111], v[116:119], v[244:247]
buffer_store_dwordx4 v[20:23], v1, s[44:47], s80 offen sc1
v_mfma_f32_16x16x32_bf16 v[240:243], v[108:111], v[112:115], v[240:243]
s_waitcnt lgkmcnt(0)
v_accvgpr_read_b32 v24, a240
v_accvgpr_read_b32 v28, a241
v_mfma_f32_16x16x32_bf16 v[128:131], v[32:35], v[64:67], v[128:131]
ds_read_b64_tr_b16 v[80:81], v8 offset:40960
ds_read_b64_tr_b16 v[82:83], v8 offset:41984
v_mfma_f32_16x16x32_bf16 v[132:135], v[32:35], v[68:71], v[132:135]
ds_read_b128 v[112:115], v19 offset:32768
ds_read_b128 v[116:119], v19 offset:34816
v_mfma_f32_16x16x32_bf16 v[136:139], v[32:35], v[72:75], v[136:139]
s_add_u32 s72, s69, 46080
buffer_load_dwordx4 v5, s[4:7], s72 offen offset:3072 lds
v_mfma_f32_16x16x32_bf16 v[140:143], v[32:35], v[76:79], v[140:143]
ds_read_b128 v[120:123], v19 offset:36864
ds_read_b128 v[124:127], v19 offset:38912
v_mfma_f32_16x16x32_bf16 v[156:159], v[36:39], v[76:79], v[156:159]
ds_read_b64_tr_b16 v[84:85], v9 offset:40960
ds_read_b64_tr_b16 v[86:87], v9 offset:41984
v_mfma_f32_16x16x32_bf16 v[152:155], v[36:39], v[72:75], v[152:155]
ds_read_b64_tr_b16 v[88:89], v10 offset:40960
v_accvgpr_read_b32 v25, a242
v_mfma_f32_16x16x32_bf16 v[148:151], v[36:39], v[68:71], v[148:151]
ds_read_b64_tr_b16 v[90:91], v10 offset:41984
v_accvgpr_read_b32 v29, a243
v_mfma_f32_16x16x32_bf16 v[144:147], v[36:39], v[64:67], v[144:147]
s_add_u32 m0, s63, 69632
ds_read_b64_tr_b16 v[92:93], v11 offset:40960
v_mfma_f32_16x16x32_bf16 v[160:163], v[40:43], v[64:67], v[160:163]
s_add_u32 s72, s70, 0
buffer_load_dwordx4 v4, s[4:7], s72 offen lds
v_mfma_f32_16x16x32_bf16 v[164:167], v[40:43], v[68:71], v[164:167]
s_add_u32 s80, s78, 35840
ds_read_b64_tr_b16 v[94:95], v11 offset:41984
v_accvgpr_read_b32 v26, a244
v_mfma_f32_16x16x32_bf16 v[168:171], v[40:43], v[72:75], v[168:171]
ds_read_b64_tr_b16 v[96:97], v12 offset:40960
v_accvgpr_read_b32 v30, a245
v_mfma_f32_16x16x32_bf16 v[172:175], v[40:43], v[76:79], v[172:175]
ds_read_b64_tr_b16 v[98:99], v12 offset:41984
v_accvgpr_read_b32 v27, a246
v_mfma_f32_16x16x32_bf16 v[188:191], v[44:47], v[76:79], v[188:191]
s_add_u32 s72, s70, 15360
buffer_load_dwordx4 v5, s[4:7], s72 offen offset:1024 lds
v_mfma_f32_16x16x32_bf16 v[184:187], v[44:47], v[72:75], v[184:187]
ds_read_b64_tr_b16 v[100:101], v13 offset:40960
v_accvgpr_read_b32 v31, a247
v_mfma_f32_16x16x32_bf16 v[180:183], v[44:47], v[68:71], v[180:183]
ds_read_b64_tr_b16 v[102:103], v13 offset:41984
v_cvt_pk_bf16_f32 v24, v24, v28
v_mfma_f32_16x16x32_bf16 v[176:179], v[44:47], v[64:67], v[176:179]
ds_read_b64_tr_b16 v[104:105], v14 offset:40960
v_cvt_pk_bf16_f32 v25, v25, v29
v_mfma_f32_16x16x32_bf16 v[192:195], v[48:51], v[64:67], v[192:195]
ds_read_b64_tr_b16 v[106:107], v14 offset:41984
v_cvt_pk_bf16_f32 v26, v26, v30
v_mfma_f32_16x16x32_bf16 v[196:199], v[48:51], v[68:71], v[196:199]
s_add_u32 s72, s70, 30720
buffer_load_dwordx4 v4, s[4:7], s72 offen offset:2048 lds
v_mfma_f32_16x16x32_bf16 v[200:203], v[48:51], v[72:75], v[200:203]
ds_read_b64_tr_b16 v[108:109], v15 offset:40960
v_cvt_pk_bf16_f32 v27, v27, v31
v_mfma_f32_16x16x32_bf16 v[204:207], v[48:51], v[76:79], v[204:207]
ds_read_b64_tr_b16 v[110:111], v15 offset:41984
v_mfma_f32_16x16x32_bf16 v[220:223], v[52:55], v[76:79], v[220:223]
buffer_store_dwordx4 v[24:27], v1, s[44:47], s80 offen sc1
v_mfma_f32_16x16x32_bf16 v[216:219], v[52:55], v[72:75], v[216:219]
v_accvgpr_read_b32 v20, a92
v_accvgpr_read_b32 v28, a93
v_mfma_f32_16x16x32_bf16 v[212:215], v[52:55], v[68:71], v[212:215]
s_add_u32 s72, s70, 46080
buffer_load_dwordx4 v5, s[4:7], s72 offen offset:3072 lds
v_mfma_f32_16x16x32_bf16 v[208:211], v[52:55], v[64:67], v[208:211]
v_accvgpr_read_b32 v21, a94
v_accvgpr_read_b32 v29, a95
v_mfma_f32_16x16x32_bf16 v[224:227], v[56:59], v[64:67], v[224:227]
s_add_u32 s80, s77, 46080
v_accvgpr_read_b32 v22, a124
v_accvgpr_read_b32 v30, a125
v_mfma_f32_16x16x32_bf16 v[228:231], v[56:59], v[68:71], v[228:231]
v_accvgpr_read_b32 v23, a126
v_accvgpr_read_b32 v31, a127
v_mfma_f32_16x16x32_bf16 v[232:235], v[56:59], v[72:75], v[232:235]
v_mul_f32 v20, s79, v20
v_mul_f32 v28, s79, v28
v_mfma_f32_16x16x32_bf16 v[236:239], v[56:59], v[76:79], v[236:239]
v_mul_f32 v21, s79, v21
v_mul_f32 v29, s79, v29
v_mfma_f32_16x16x32_bf16 v[252:255], v[60:63], v[76:79], v[252:255]
v_mul_f32 v22, s79, v22
v_mul_f32 v30, s79, v30
v_mfma_f32_16x16x32_bf16 v[248:251], v[60:63], v[72:75], v[248:251]
v_mul_f32 v23, s79, v23
v_mul_f32 v31, s79, v31
v_mfma_f32_16x16x32_bf16 v[244:247], v[60:63], v[68:71], v[244:247]
s_waitcnt vmcnt(16) lgkmcnt(0)
v_cvt_pk_bf16_f32 v20, v20, v28
v_cvt_pk_bf16_f32 v21, v21, v29
v_mfma_f32_16x16x32_bf16 v[240:243], v[60:63], v[64:67], v[240:243]
s_barrier
v_cvt_pk_bf16_f32 v22, v22, v30
v_cvt_pk_bf16_f32 v23, v23, v31
v_mfma_f32_16x16x32_bf16 v[128:131], v[80:83], v[112:115], v[128:131]
s_add_u32 s73, s62, 14
ds_read_b64_tr_b16 v[32:33], v8 offset:0
ds_read_b64_tr_b16 v[34:35], v8 offset:1024
v_mfma_f32_16x16x32_bf16 v[132:135], v[80:83], v[116:119], v[132:135]
s_add_u32 s70, s73, s65
ds_read_b128 v[64:67], v16 offset:0
ds_read_b128 v[68:71], v16 offset:2048
v_mfma_f32_16x16x32_bf16 v[136:139], v[80:83], v[120:123], v[136:139]
s_and_b32 s70, s70, 3
ds_read_b128 v[72:75], v16 offset:4096
ds_read_b128 v[76:79], v16 offset:6144
v_mfma_f32_16x16x32_bf16 v[140:143], v[80:83], v[124:127], v[140:143]
s_and_b32 s73, s73, 12
ds_read_b64_tr_b16 v[36:37], v9 offset:0
ds_read_b64_tr_b16 v[38:39], v9 offset:1024
v_mfma_f32_16x16x32_bf16 v[156:159], v[84:87], v[124:127], v[156:159]
s_or_b32 s73, s73, s70
ds_read_b64_tr_b16 v[40:41], v10 offset:0
v_mfma_f32_16x16x32_bf16 v[152:155], v[84:87], v[120:123], v[152:155]
s_lshl_b32 s71, s73, 19
ds_read_b64_tr_b16 v[42:43], v10 offset:1024
v_mfma_f32_16x16x32_bf16 v[148:151], v[84:87], v[116:119], v[148:151]
s_add_u32 s71, s71, s66
ds_read_b64_tr_b16 v[44:45], v11 offset:0
v_mfma_f32_16x16x32_bf16 v[144:147], v[84:87], v[112:115], v[144:147]
s_lshl_b32 s73, s73, 7
ds_read_b64_tr_b16 v[46:47], v11 offset:1024
v_mfma_f32_16x16x32_bf16 v[160:163], v[88:91], v[112:115], v[160:163]
s_add_u32 s69, s73, s67
ds_read_b64_tr_b16 v[48:49], v12 offset:0
v_mfma_f32_16x16x32_bf16 v[164:167], v[88:91], v[116:119], v[164:167]
s_add_u32 s70, s73, s68
ds_read_b64_tr_b16 v[50:51], v12 offset:1024
v_mfma_f32_16x16x32_bf16 v[168:171], v[88:91], v[120:123], v[168:171]
s_add_u32 m0, s64, 32768
ds_read_b64_tr_b16 v[52:53], v13 offset:0
v_mfma_f32_16x16x32_bf16 v[172:175], v[88:91], v[124:127], v[172:175]
s_add_u32 s72, s71, 0
buffer_load_dwordx4 v6, s[12:15], s72 offen lds
v_mfma_f32_16x16x32_bf16 v[188:191], v[92:95], v[124:127], v[188:191]
s_add_u32 s72, s71, 31744
buffer_load_dwordx4 v6, s[12:15], s72 offen offset:1024 lds
v_mfma_f32_16x16x32_bf16 v[184:187], v[92:95], v[120:123], v[184:187]
s_add_u32 s72, s71, 63488
buffer_load_dwordx4 v7, s[12:15], s72 offen offset:2048 lds
v_mfma_f32_16x16x32_bf16 v[180:183], v[92:95], v[116:119], v[180:183]
s_add_u32 s72, s71, 95232
buffer_load_dwordx4 v7, s[12:15], s72 offen offset:3072 lds
v_mfma_f32_16x16x32_bf16 v[176:179], v[92:95], v[112:115], v[176:179]
ds_read_b64_tr_b16 v[54:55], v13 offset:1024
v_mfma_f32_16x16x32_bf16 v[192:195], v[96:99], v[112:115], v[192:195]
ds_read_b64_tr_b16 v[56:57], v14 offset:0
v_mfma_f32_16x16x32_bf16 v[196:199], v[96:99], v[116:119], v[196:199]
ds_read_b64_tr_b16 v[58:59], v14 offset:1024
v_mfma_f32_16x16x32_bf16 v[200:203], v[96:99], v[120:123], v[200:203]
ds_read_b64_tr_b16 v[60:61], v15 offset:0
v_mfma_f32_16x16x32_bf16 v[204:207], v[96:99], v[124:127], v[204:207]
s_add_u32 m0, s63, 98304
ds_read_b64_tr_b16 v[62:63], v15 offset:1024
v_mfma_f32_16x16x32_bf16 v[220:223], v[100:103], v[124:127], v[220:223]
s_add_u32 s72, s69, 0
buffer_load_dwordx4 v4, s[4:7], s72 offen lds
v_mfma_f32_16x16x32_bf16 v[216:219], v[100:103], v[120:123], v[216:219]
buffer_store_dwordx4 v[20:23], v1, s[44:47], s80 offen sc1
v_mfma_f32_16x16x32_bf16 v[212:215], v[100:103], v[116:119], v[212:215]
v_accvgpr_read_b32 v24, a248
v_accvgpr_read_b32 v28, a249
v_mfma_f32_16x16x32_bf16 v[208:211], v[100:103], v[112:115], v[208:211]
v_accvgpr_read_b32 v25, a250
v_accvgpr_read_b32 v29, a251
v_mfma_f32_16x16x32_bf16 v[224:227], v[104:107], v[112:115], v[224:227]
s_add_u32 s72, s69, 15360
buffer_load_dwordx4 v5, s[4:7], s72 offen offset:1024 lds
v_mfma_f32_16x16x32_bf16 v[228:231], v[104:107], v[116:119], v[228:231]
s_add_u32 s80, s78, 44032
v_accvgpr_read_b32 v26, a252
v_accvgpr_read_b32 v30, a253
v_mfma_f32_16x16x32_bf16 v[232:235], v[104:107], v[120:123], v[232:235]
v_accvgpr_read_b32 v27, a254
v_accvgpr_read_b32 v31, a255
v_mfma_f32_16x16x32_bf16 v[236:239], v[104:107], v[124:127], v[236:239]
v_cvt_pk_bf16_f32 v24, v24, v28
v_cvt_pk_bf16_f32 v25, v25, v29
v_mfma_f32_16x16x32_bf16 v[252:255], v[108:111], v[124:127], v[252:255]
v_cvt_pk_bf16_f32 v26, v26, v30
v_cvt_pk_bf16_f32 v27, v27, v31
v_mfma_f32_16x16x32_bf16 v[248:251], v[108:111], v[120:123], v[248:251]
s_add_u32 s72, s69, 30720
buffer_load_dwordx4 v4, s[4:7], s72 offen offset:2048 lds
v_mfma_f32_16x16x32_bf16 v[244:247], v[108:111], v[116:119], v[244:247]
buffer_store_dwordx4 v[24:27], v1, s[44:47], s80 offen sc1
v_mfma_f32_16x16x32_bf16 v[240:243], v[108:111], v[112:115], v[240:243]
s_waitcnt lgkmcnt(0)
v_mfma_f32_16x16x32_bf16 v[128:131], v[32:35], v[64:67], v[128:131]
ds_read_b64_tr_b16 v[80:81], v8 offset:8192
ds_read_b64_tr_b16 v[82:83], v8 offset:9216
v_mfma_f32_16x16x32_bf16 v[132:135], v[32:35], v[68:71], v[132:135]
ds_read_b128 v[112:115], v17 offset:0
ds_read_b128 v[116:119], v17 offset:2048
v_mfma_f32_16x16x32_bf16 v[136:139], v[32:35], v[72:75], v[136:139]
s_add_u32 s72, s69, 46080
buffer_load_dwordx4 v5, s[4:7], s72 offen offset:3072 lds
v_mfma_f32_16x16x32_bf16 v[140:143], v[32:35], v[76:79], v[140:143]
ds_read_b128 v[120:123], v17 offset:4096
ds_read_b128 v[124:127], v17 offset:6144
v_mfma_f32_16x16x32_bf16 v[156:159], v[36:39], v[76:79], v[156:159]
ds_read_b64_tr_b16 v[84:85], v9 offset:8192
ds_read_b64_tr_b16 v[86:87], v9 offset:9216
v_mfma_f32_16x16x32_bf16 v[152:155], v[36:39], v[72:75], v[152:155]
ds_read_b64_tr_b16 v[88:89], v10 offset:8192
v_mfma_f32_16x16x32_bf16 v[148:151], v[36:39], v[68:71], v[148:151]
ds_read_b64_tr_b16 v[90:91], v10 offset:9216
v_mfma_f32_16x16x32_bf16 v[144:147], v[36:39], v[64:67], v[144:147]
s_add_u32 m0, s63, 102400
ds_read_b64_tr_b16 v[92:93], v11 offset:8192
v_mfma_f32_16x16x32_bf16 v[160:163], v[40:43], v[64:67], v[160:163]
s_add_u32 s72, s70, 0
buffer_load_dwordx4 v4, s[4:7], s72 offen lds
v_mfma_f32_16x16x32_bf16 v[164:167], v[40:43], v[68:71], v[164:167]
ds_read_b64_tr_b16 v[94:95], v11 offset:9216
v_mfma_f32_16x16x32_bf16 v[168:171], v[40:43], v[72:75], v[168:171]
ds_read_b64_tr_b16 v[96:97], v12 offset:8192
v_mfma_f32_16x16x32_bf16 v[172:175], v[40:43], v[76:79], v[172:175]
ds_read_b64_tr_b16 v[98:99], v12 offset:9216
v_mfma_f32_16x16x32_bf16 v[188:191], v[44:47], v[76:79], v[188:191]
s_add_u32 s72, s70, 15360
buffer_load_dwordx4 v5, s[4:7], s72 offen offset:1024 lds
v_mfma_f32_16x16x32_bf16 v[184:187], v[44:47], v[72:75], v[184:187]
ds_read_b64_tr_b16 v[100:101], v13 offset:8192
v_mfma_f32_16x16x32_bf16 v[180:183], v[44:47], v[68:71], v[180:183]
ds_read_b64_tr_b16 v[102:103], v13 offset:9216
v_mfma_f32_16x16x32_bf16 v[176:179], v[44:47], v[64:67], v[176:179]
ds_read_b64_tr_b16 v[104:105], v14 offset:8192
v_mfma_f32_16x16x32_bf16 v[192:195], v[48:51], v[64:67], v[192:195]
ds_read_b64_tr_b16 v[106:107], v14 offset:9216
v_mfma_f32_16x16x32_bf16 v[196:199], v[48:51], v[68:71], v[196:199]
s_add_u32 s72, s70, 30720
buffer_load_dwordx4 v4, s[4:7], s72 offen offset:2048 lds
v_mfma_f32_16x16x32_bf16 v[200:203], v[48:51], v[72:75], v[200:203]
ds_read_b64_tr_b16 v[108:109], v15 offset:8192
v_mfma_f32_16x16x32_bf16 v[204:207], v[48:51], v[76:79], v[204:207]
ds_read_b64_tr_b16 v[110:111], v15 offset:9216
v_mfma_f32_16x16x32_bf16 v[220:223], v[52:55], v[76:79], v[220:223]
v_mfma_f32_16x16x32_bf16 v[216:219], v[52:55], v[72:75], v[216:219]
v_mfma_f32_16x16x32_bf16 v[212:215], v[52:55], v[68:71], v[212:215]
s_add_u32 s72, s70, 46080
buffer_load_dwordx4 v5, s[4:7], s72 offen offset:3072 lds
v_mfma_f32_16x16x32_bf16 v[208:211], v[52:55], v[64:67], v[208:211]
v_mfma_f32_16x16x32_bf16 v[224:227], v[56:59], v[64:67], v[224:227]
v_mfma_f32_16x16x32_bf16 v[228:231], v[56:59], v[68:71], v[228:231]
v_mfma_f32_16x16x32_bf16 v[232:235], v[56:59], v[72:75], v[232:235]
v_mfma_f32_16x16x32_bf16 v[236:239], v[56:59], v[76:79], v[236:239]
v_mfma_f32_16x16x32_bf16 v[252:255], v[60:63], v[76:79], v[252:255]
v_mfma_f32_16x16x32_bf16 v[248:251], v[60:63], v[72:75], v[248:251]
v_mfma_f32_16x16x32_bf16 v[244:247], v[60:63], v[68:71], v[244:247]
s_waitcnt vmcnt(5) lgkmcnt(0)
v_mfma_f32_16x16x32_bf16 v[240:243], v[60:63], v[64:67], v[240:243]
s_barrier
v_mfma_f32_16x16x32_bf16 v[128:131], v[80:83], v[112:115], v[128:131]
s_add_u32 s73, s62, 15
s_waitcnt vmcnt(28)
v_cmp_gt_u32 vcc, 8, v3
s_cbranch_vccnz Lspin1
Lback2:
v_mfma_f32_16x16x32_bf16 v[132:135], v[80:83], v[116:119], v[132:135]
s_add_u32 s70, s73, s65
ds_read_b64_tr_b16 v[32:33], v8 offset:16384
ds_read_b64_tr_b16 v[34:35], v8 offset:17408
v_mfma_f32_16x16x32_bf16 v[136:139], v[80:83], v[120:123], v[136:139]
s_and_b32 s70, s70, 3
ds_read_b128 v[64:67], v18 offset:0
ds_read_b128 v[68:71], v18 offset:2048
v_mfma_f32_16x16x32_bf16 v[140:143], v[80:83], v[124:127], v[140:143]
s_and_b32 s73, s73, 12
ds_read_b128 v[72:75], v18 offset:4096
ds_read_b128 v[76:79], v18 offset:6144
v_mfma_f32_16x16x32_bf16 v[156:159], v[84:87], v[124:127], v[156:159]
s_or_b32 s73, s73, s70
ds_read_b64_tr_b16 v[36:37], v9 offset:16384
ds_read_b64_tr_b16 v[38:39], v9 offset:17408
v_mfma_f32_16x16x32_bf16 v[152:155], v[84:87], v[120:123], v[152:155]
s_lshl_b32 s71, s73, 19
ds_read_b64_tr_b16 v[40:41], v10 offset:16384
v_or_b32 v20, s58, v0
v_mfma_f32_16x16x32_bf16 v[148:151], v[84:87], v[116:119], v[148:151]
s_add_u32 s71, s71, s66
ds_read_b64_tr_b16 v[42:43], v10 offset:17408
v_mov_b32 v21, 1
v_mfma_f32_16x16x32_bf16 v[144:147], v[84:87], v[112:115], v[144:147]
s_lshl_b32 s73, s73, 7
ds_read_b64_tr_b16 v[44:45], v11 offset:16384
v_min_u32 v20, 1, v20
v_mfma_f32_16x16x32_bf16 v[160:163], v[88:91], v[112:115], v[160:163]
s_add_u32 s69, s73, s67
ds_read_b64_tr_b16 v[46:47], v11 offset:17408
v_lshlrev_b32 v20, 30, v20
v_mfma_f32_16x16x32_bf16 v[164:167], v[88:91], v[116:119], v[164:167]
s_add_u32 s70, s73, s68
ds_read_b64_tr_b16 v[48:49], v12 offset:16384
v_mfma_f32_16x16x32_bf16 v[168:171], v[88:91], v[120:123], v[168:171]
s_add_u32 m0, s64, 0
ds_read_b64_tr_b16 v[50:51], v12 offset:17408
v_mfma_f32_16x16x32_bf16 v[172:175], v[88:91], v[124:127], v[172:175]
s_add_u32 s72, s71, 0
buffer_load_dwordx4 v6, s[12:15], s72 offen lds
v_mfma_f32_16x16x32_bf16 v[188:191], v[92:95], v[124:127], v[188:191]
s_add_u32 s72, s71, 31744
buffer_load_dwordx4 v6, s[12:15], s72 offen offset:1024 lds
v_mfma_f32_16x16x32_bf16 v[184:187], v[92:95], v[120:123], v[184:187]
s_add_u32 s72, s71, 63488
buffer_load_dwordx4 v7, s[12:15], s72 offen offset:2048 lds
v_mfma_f32_16x16x32_bf16 v[180:183], v[92:95], v[116:119], v[180:183]
s_add_u32 s72, s71, 95232
buffer_load_dwordx4 v7, s[12:15], s72 offen offset:3072 lds
v_mfma_f32_16x16x32_bf16 v[176:179], v[92:95], v[112:115], v[176:179]
ds_read_b64_tr_b16 v[52:53], v13 offset:16384
v_mfma_f32_16x16x32_bf16 v[192:195], v[96:99], v[112:115], v[192:195]
ds_read_b64_tr_b16 v[54:55], v13 offset:17408
v_mfma_f32_16x16x32_bf16 v[196:199], v[96:99], v[116:119], v[196:199]
ds_read_b64_tr_b16 v[56:57], v14 offset:16384
v_mfma_f32_16x16x32_bf16 v[200:203], v[96:99], v[120:123], v[200:203]
ds_read_b64_tr_b16 v[58:59], v14 offset:17408
v_mfma_f32_16x16x32_bf16 v[204:207], v[96:99], v[124:127], v[204:207]
s_add_u32 m0, s63, 131072
ds_read_b64_tr_b16 v[60:61], v15 offset:16384
v_mfma_f32_16x16x32_bf16 v[220:223], v[100:103], v[124:127], v[220:223]
s_add_u32 s72, s69, 0
buffer_load_dwordx4 v4, s[4:7], s72 offen lds
v_mfma_f32_16x16x32_bf16 v[216:219], v[100:103], v[120:123], v[216:219]
ds_read_b64_tr_b16 v[62:63], v15 offset:17408
v_mfma_f32_16x16x32_bf16 v[212:215], v[100:103], v[116:119], v[212:215]
buffer_store_dword v21, v20, s[44:47], s91 offen sc1
v_mfma_f32_16x16x32_bf16 v[208:211], v[100:103], v[112:115], v[208:211]
v_mfma_f32_16x16x32_bf16 v[224:227], v[104:107], v[112:115], v[224:227]
s_add_u32 s72, s69, 15360
buffer_load_dwordx4 v5, s[4:7], s72 offen offset:1024 lds
v_mfma_f32_16x16x32_bf16 v[228:231], v[104:107], v[116:119], v[228:231]
v_mfma_f32_16x16x32_bf16 v[232:235], v[104:107], v[120:123], v[232:235]
v_mfma_f32_16x16x32_bf16 v[236:239], v[104:107], v[124:127], v[236:239]
v_mfma_f32_16x16x32_bf16 v[252:255], v[108:111], v[124:127], v[252:255]
v_mfma_f32_16x16x32_bf16 v[248:251], v[108:111], v[120:123], v[248:251]
s_add_u32 s72, s69, 30720
buffer_load_dwordx4 v4, s[4:7], s72 offen offset:2048 lds
v_mfma_f32_16x16x32_bf16 v[244:247], v[108:111], v[116:119], v[244:247]
v_mfma_f32_16x16x32_bf16 v[240:243], v[108:111], v[112:115], v[240:243]
s_waitcnt lgkmcnt(0)
v_mfma_f32_16x16x32_bf16 v[128:131], v[32:35], v[64:67], v[128:131]
ds_read_b64_tr_b16 v[80:81], v8 offset:24576
ds_read_b64_tr_b16 v[82:83], v8 offset:25600
v_mfma_f32_16x16x32_bf16 v[132:135], v[32:35], v[68:71], v[132:135]
ds_read_b128 v[112:115], v19 offset:0
ds_read_b128 v[116:119], v19 offset:2048
v_mfma_f32_16x16x32_bf16 v[136:139], v[32:35], v[72:75], v[136:139]
s_add_u32 s72, s69, 46080
buffer_load_dwordx4 v5, s[4:7], s72 offen offset:3072 lds
v_mfma_f32_16x16x32_bf16 v[140:143], v[32:35], v[76:79], v[140:143]
ds_read_b128 v[120:123], v19 offset:4096
ds_read_b128 v[124:127], v19 offset:6144
v_mfma_f32_16x16x32_bf16 v[156:159], v[36:39], v[76:79], v[156:159]
ds_read_b64_tr_b16 v[84:85], v9 offset:24576
ds_read_b64_tr_b16 v[86:87], v9 offset:25600
v_mfma_f32_16x16x32_bf16 v[152:155], v[36:39], v[72:75], v[152:155]
ds_read_b64_tr_b16 v[88:89], v10 offset:24576
v_mfma_f32_16x16x32_bf16 v[148:151], v[36:39], v[68:71], v[148:151]
ds_read_b64_tr_b16 v[90:91], v10 offset:25600
v_mfma_f32_16x16x32_bf16 v[144:147], v[36:39], v[64:67], v[144:147]
s_add_u32 m0, s63, 135168
ds_read_b64_tr_b16 v[92:93], v11 offset:24576
v_mfma_f32_16x16x32_bf16 v[160:163], v[40:43], v[64:67], v[160:163]
s_add_u32 s72, s70, 0
buffer_load_dwordx4 v4, s[4:7], s72 offen lds
v_mfma_f32_16x16x32_bf16 v[164:167], v[40:43], v[68:71], v[164:167]
ds_read_b64_tr_b16 v[94:95], v11 offset:25600
v_mfma_f32_16x16x32_bf16 v[168:171], v[40:43], v[72:75], v[168:171]
ds_read_b64_tr_b16 v[96:97], v12 offset:24576
v_mfma_f32_16x16x32_bf16 v[172:175], v[40:43], v[76:79], v[172:175]
ds_read_b64_tr_b16 v[98:99], v12 offset:25600
v_mfma_f32_16x16x32_bf16 v[188:191], v[44:47], v[76:79], v[188:191]
s_add_u32 s72, s70, 15360
buffer_load_dwordx4 v5, s[4:7], s72 offen offset:1024 lds
v_mfma_f32_16x16x32_bf16 v[184:187], v[44:47], v[72:75], v[184:187]
ds_read_b64_tr_b16 v[100:101], v13 offset:24576
v_mfma_f32_16x16x32_bf16 v[180:183], v[44:47], v[68:71], v[180:183]
ds_read_b64_tr_b16 v[102:103], v13 offset:25600
v_mfma_f32_16x16x32_bf16 v[176:179], v[44:47], v[64:67], v[176:179]
ds_read_b64_tr_b16 v[104:105], v14 offset:24576
v_mfma_f32_16x16x32_bf16 v[192:195], v[48:51], v[64:67], v[192:195]
ds_read_b64_tr_b16 v[106:107], v14 offset:25600
v_mfma_f32_16x16x32_bf16 v[196:199], v[48:51], v[68:71], v[196:199]
s_add_u32 s72, s70, 30720
buffer_load_dwordx4 v4, s[4:7], s72 offen offset:2048 lds
v_mfma_f32_16x16x32_bf16 v[200:203], v[48:51], v[72:75], v[200:203]
ds_read_b64_tr_b16 v[108:109], v15 offset:24576
v_mfma_f32_16x16x32_bf16 v[204:207], v[48:51], v[76:79], v[204:207]
ds_read_b64_tr_b16 v[110:111], v15 offset:25600
v_mfma_f32_16x16x32_bf16 v[220:223], v[52:55], v[76:79], v[220:223]
v_mfma_f32_16x16x32_bf16 v[216:219], v[52:55], v[72:75], v[216:219]
v_mfma_f32_16x16x32_bf16 v[212:215], v[52:55], v[68:71], v[212:215]
s_add_u32 s72, s70, 46080
buffer_load_dwordx4 v5, s[4:7], s72 offen offset:3072 lds
v_mfma_f32_16x16x32_bf16 v[208:211], v[52:55], v[64:67], v[208:211]
v_mfma_f32_16x16x32_bf16 v[224:227], v[56:59], v[64:67], v[224:227]
v_mfma_f32_16x16x32_bf16 v[228:231], v[56:59], v[68:71], v[228:231]
v_mfma_f32_16x16x32_bf16 v[232:235], v[56:59], v[72:75], v[232:235]
v_mfma_f32_16x16x32_bf16 v[236:239], v[56:59], v[76:79], v[236:239]
v_mfma_f32_16x16x32_bf16 v[252:255], v[60:63], v[76:79], v[252:255]
v_mfma_f32_16x16x32_bf16 v[248:251], v[60:63], v[72:75], v[248:251]
v_mfma_f32_16x16x32_bf16 v[244:247], v[60:63], v[68:71], v[244:247]
s_waitcnt vmcnt(13) lgkmcnt(0)
v_mfma_f32_16x16x32_bf16 v[240:243], v[60:63], v[64:67], v[240:243]
s_barrier
v_mfma_f32_16x16x32_bf16 v[128:131], v[80:83], v[112:115], v[128:131]
ds_read_b64_tr_b16 v[32:33], v8 offset:32768
ds_read_b64_tr_b16 v[34:35], v8 offset:33792
v_mfma_f32_16x16x32_bf16 v[132:135], v[80:83], v[116:119], v[132:135]
ds_read_b128 v[64:67], v18 offset:32768
ds_read_b128 v[68:71], v18 offset:34816
v_mfma_f32_16x16x32_bf16 v[136:139], v[80:83], v[120:123], v[136:139]
ds_read_b128 v[72:75], v18 offset:36864
ds_read_b128 v[76:79], v18 offset:38912
v_mfma_f32_16x16x32_bf16 v[140:143], v[80:83], v[124:127], v[140:143]
ds_read_b64_tr_b16 v[36:37], v9 offset:32768
ds_read_b64_tr_b16 v[38:39], v9 offset:33792
v_mfma_f32_16x16x32_bf16 v[156:159], v[84:87], v[124:127], v[156:159]
ds_read_b64_tr_b16 v[40:41], v10 offset:32768
v_mfma_f32_16x16x32_bf16 v[152:155], v[84:87], v[120:123], v[152:155]
ds_read_b64_tr_b16 v[42:43], v10 offset:33792
v_mfma_f32_16x16x32_bf16 v[148:151], v[84:87], v[116:119], v[148:151]
ds_read_b64_tr_b16 v[44:45], v11 offset:32768
v_mfma_f32_16x16x32_bf16 v[144:147], v[84:87], v[112:115], v[144:147]
ds_read_b64_tr_b16 v[46:47], v11 offset:33792
v_mfma_f32_16x16x32_bf16 v[160:163], v[88:91], v[112:115], v[160:163]
ds_read_b64_tr_b16 v[48:49], v12 offset:32768
v_mfma_f32_16x16x32_bf16 v[164:167], v[88:91], v[116:119], v[164:167]
ds_read_b64_tr_b16 v[50:51], v12 offset:33792
v_mfma_f32_16x16x32_bf16 v[168:171], v[88:91], v[120:123], v[168:171]
ds_read_b64_tr_b16 v[52:53], v13 offset:32768
v_mfma_f32_16x16x32_bf16 v[172:175], v[88:91], v[124:127], v[172:175]
ds_read_b64_tr_b16 v[54:55], v13 offset:33792
v_mfma_f32_16x16x32_bf16 v[188:191], v[92:95], v[124:127], v[188:191]
ds_read_b64_tr_b16 v[56:57], v14 offset:32768
v_mfma_f32_16x16x32_bf16 v[184:187], v[92:95], v[120:123], v[184:187]
ds_read_b64_tr_b16 v[58:59], v14 offset:33792
v_mfma_f32_16x16x32_bf16 v[180:183], v[92:95], v[116:119], v[180:183]
ds_read_b64_tr_b16 v[60:61], v15 offset:32768
v_mfma_f32_16x16x32_bf16 v[176:179], v[92:95], v[112:115], v[176:179]
ds_read_b64_tr_b16 v[62:63], v15 offset:33792
v_mfma_f32_16x16x32_bf16 v[192:195], v[96:99], v[112:115], v[192:195]
v_mfma_f32_16x16x32_bf16 v[196:199], v[96:99], v[116:119], v[196:199]
v_mfma_f32_16x16x32_bf16 v[200:203], v[96:99], v[120:123], v[200:203]
v_mfma_f32_16x16x32_bf16 v[204:207], v[96:99], v[124:127], v[204:207]
v_mfma_f32_16x16x32_bf16 v[220:223], v[100:103], v[124:127], v[220:223]
v_mfma_f32_16x16x32_bf16 v[216:219], v[100:103], v[120:123], v[216:219]
v_mfma_f32_16x16x32_bf16 v[212:215], v[100:103], v[116:119], v[212:215]
v_mfma_f32_16x16x32_bf16 v[208:211], v[100:103], v[112:115], v[208:211]
v_mfma_f32_16x16x32_bf16 v[224:227], v[104:107], v[112:115], v[224:227]
s_and_b32 s75, s91, 0xfffffc7f
v_lshrrev_b32 v2, 3, v0
v_lshlrev_b32 v2, 7, v2
v_mfma_f32_16x16x32_bf16 v[228:231], v[104:107], v[116:119], v[228:231]
buffer_load_dword v3, v2, s[44:47], s75 offen sc1
v_mfma_f32_16x16x32_bf16 v[232:235], v[104:107], v[120:123], v[232:235]
v_mfma_f32_16x16x32_bf16 v[236:239], v[104:107], v[124:127], v[236:239]
v_mfma_f32_16x16x32_bf16 v[252:255], v[108:111], v[124:127], v[252:255]
v_mfma_f32_16x16x32_bf16 v[248:251], v[108:111], v[120:123], v[248:251]
v_mfma_f32_16x16x32_bf16 v[244:247], v[108:111], v[116:119], v[244:247]
v_mfma_f32_16x16x32_bf16 v[240:243], v[108:111], v[112:115], v[240:243]
s_waitcnt lgkmcnt(0)
v_mfma_f32_16x16x32_bf16 v[128:131], v[32:35], v[64:67], v[128:131]
ds_read_b64_tr_b16 v[80:81], v8 offset:40960
ds_read_b64_tr_b16 v[82:83], v8 offset:41984
v_mfma_f32_16x16x32_bf16 v[132:135], v[32:35], v[68:71], v[132:135]
ds_read_b128 v[112:115], v19 offset:32768
ds_read_b128 v[116:119], v19 offset:34816
v_mfma_f32_16x16x32_bf16 v[136:139], v[32:35], v[72:75], v[136:139]
ds_read_b128 v[120:123], v19 offset:36864
ds_read_b128 v[124:127], v19 offset:38912
v_mfma_f32_16x16x32_bf16 v[140:143], v[32:35], v[76:79], v[140:143]
ds_read_b64_tr_b16 v[84:85], v9 offset:40960
ds_read_b64_tr_b16 v[86:87], v9 offset:41984
v_mfma_f32_16x16x32_bf16 v[156:159], v[36:39], v[76:79], v[156:159]
ds_read_b64_tr_b16 v[88:89], v10 offset:40960
v_mfma_f32_16x16x32_bf16 v[152:155], v[36:39], v[72:75], v[152:155]
ds_read_b64_tr_b16 v[90:91], v10 offset:41984
v_mfma_f32_16x16x32_bf16 v[148:151], v[36:39], v[68:71], v[148:151]
ds_read_b64_tr_b16 v[92:93], v11 offset:40960
v_mfma_f32_16x16x32_bf16 v[144:147], v[36:39], v[64:67], v[144:147]
ds_read_b64_tr_b16 v[94:95], v11 offset:41984
v_mfma_f32_16x16x32_bf16 v[160:163], v[40:43], v[64:67], v[160:163]
ds_read_b64_tr_b16 v[96:97], v12 offset:40960
v_mfma_f32_16x16x32_bf16 v[164:167], v[40:43], v[68:71], v[164:167]
ds_read_b64_tr_b16 v[98:99], v12 offset:41984
v_mfma_f32_16x16x32_bf16 v[168:171], v[40:43], v[72:75], v[168:171]
ds_read_b64_tr_b16 v[100:101], v13 offset:40960
v_mfma_f32_16x16x32_bf16 v[172:175], v[40:43], v[76:79], v[172:175]
ds_read_b64_tr_b16 v[102:103], v13 offset:41984
v_mfma_f32_16x16x32_bf16 v[188:191], v[44:47], v[76:79], v[188:191]
ds_read_b64_tr_b16 v[104:105], v14 offset:40960
v_mfma_f32_16x16x32_bf16 v[184:187], v[44:47], v[72:75], v[184:187]
ds_read_b64_tr_b16 v[106:107], v14 offset:41984
v_mfma_f32_16x16x32_bf16 v[180:183], v[44:47], v[68:71], v[180:183]
ds_read_b64_tr_b16 v[108:109], v15 offset:40960
v_mfma_f32_16x16x32_bf16 v[176:179], v[44:47], v[64:67], v[176:179]
ds_read_b64_tr_b16 v[110:111], v15 offset:41984
v_mfma_f32_16x16x32_bf16 v[192:195], v[48:51], v[64:67], v[192:195]
v_mfma_f32_16x16x32_bf16 v[196:199], v[48:51], v[68:71], v[196:199]
v_mfma_f32_16x16x32_bf16 v[200:203], v[48:51], v[72:75], v[200:203]
v_mfma_f32_16x16x32_bf16 v[204:207], v[48:51], v[76:79], v[204:207]
v_mfma_f32_16x16x32_bf16 v[220:223], v[52:55], v[76:79], v[220:223]
v_mfma_f32_16x16x32_bf16 v[216:219], v[52:55], v[72:75], v[216:219]
v_mfma_f32_16x16x32_bf16 v[212:215], v[52:55], v[68:71], v[212:215]
v_mfma_f32_16x16x32_bf16 v[208:211], v[52:55], v[64:67], v[208:211]
v_mfma_f32_16x16x32_bf16 v[224:227], v[56:59], v[64:67], v[224:227]
v_mfma_f32_16x16x32_bf16 v[228:231], v[56:59], v[68:71], v[228:231]
v_mfma_f32_16x16x32_bf16 v[232:235], v[56:59], v[72:75], v[232:235]
v_mfma_f32_16x16x32_bf16 v[236:239], v[56:59], v[76:79], v[236:239]
v_mfma_f32_16x16x32_bf16 v[252:255], v[60:63], v[76:79], v[252:255]
v_mfma_f32_16x16x32_bf16 v[248:251], v[60:63], v[72:75], v[248:251]
v_mfma_f32_16x16x32_bf16 v[244:247], v[60:63], v[68:71], v[244:247]
s_waitcnt vmcnt(1) lgkmcnt(0)
v_mfma_f32_16x16x32_bf16 v[240:243], v[60:63], v[64:67], v[240:243]
s_barrier
v_mfma_f32_16x16x32_bf16 v[128:131], v[80:83], v[112:115], v[128:131]
s_waitcnt vmcnt(0)
v_cmp_gt_u32 vcc, 1, v3
s_cbranch_vccnz Lspin4
Lback5:
v_mfma_f32_16x16x32_bf16 v[132:135], v[80:83], v[116:119], v[132:135]
s_add_u32 m0, s64, 49152
ds_read_b64_tr_b16 v[32:33], v8 offset:0
ds_read_b64_tr_b16 v[34:35], v8 offset:1024
v_mfma_f32_16x16x32_bf16 v[136:139], v[80:83], v[120:123], v[136:139]
s_add_u32 s72, s81, 16384
buffer_load_dwordx4 v1, s[44:47], s72 offen sc1 lds
v_mfma_f32_16x16x32_bf16 v[140:143], v[80:83], v[124:127], v[140:143]
ds_read_b128 v[64:67], v16 offset:0
ds_read_b128 v[68:71], v16 offset:2048
v_mfma_f32_16x16x32_bf16 v[156:159], v[84:87], v[124:127], v[156:159]
buffer_load_dwordx4 v1, s[44:47], s72 offen offset:1024 sc1 lds
v_mfma_f32_16x16x32_bf16 v[152:155], v[84:87], v[120:123], v[152:155]
ds_read_b128 v[72:75], v16 offset:4096
ds_read_b128 v[76:79], v16 offset:6144
v_mfma_f32_16x16x32_bf16 v[148:151], v[84:87], v[116:119], v[148:151]
ds_read_b64_tr_b16 v[36:37], v9 offset:0
ds_read_b64_tr_b16 v[38:39], v9 offset:1024
v_mfma_f32_16x16x32_bf16 v[144:147], v[84:87], v[112:115], v[144:147]
ds_read_b64_tr_b16 v[40:41], v10 offset:0
v_mfma_f32_16x16x32_bf16 v[160:163], v[88:91], v[112:115], v[160:163]
buffer_load_dwordx4 v1, s[44:47], s72 offen offset:2048 sc1 lds
v_mfma_f32_16x16x32_bf16 v[164:167], v[88:91], v[116:119], v[164:167]
ds_read_b64_tr_b16 v[42:43], v10 offset:1024
v_mfma_f32_16x16x32_bf16 v[168:171], v[88:91], v[120:123], v[168:171]
ds_read_b64_tr_b16 v[44:45], v11 offset:0
v_mfma_f32_16x16x32_bf16 v[172:175], v[88:91], v[124:127], v[172:175]
buffer_load_dwordx4 v1, s[44:47], s72 offen offset:3072 sc1 lds
v_mfma_f32_16x16x32_bf16 v[188:191], v[92:95], v[124:127], v[188:191]
ds_read_b64_tr_b16 v[46:47], v11 offset:1024
v_mfma_f32_16x16x32_bf16 v[184:187], v[92:95], v[120:123], v[184:187]
ds_read_b64_tr_b16 v[48:49], v12 offset:0
v_mfma_f32_16x16x32_bf16 v[180:183], v[92:95], v[116:119], v[180:183]
ds_read_b64_tr_b16 v[50:51], v12 offset:1024
v_mfma_f32_16x16x32_bf16 v[176:179], v[92:95], v[112:115], v[176:179]
s_add_u32 s81, s81, 0x8000
ds_read_b64_tr_b16 v[52:53], v13 offset:0
v_mfma_f32_16x16x32_bf16 v[192:195], v[96:99], v[112:115], v[192:195]
s_add_u32 m0, s64, 81920
ds_read_b64_tr_b16 v[54:55], v13 offset:1024
v_mfma_f32_16x16x32_bf16 v[196:199], v[96:99], v[116:119], v[196:199]
s_add_u32 s72, s81, 16384
buffer_load_dwordx4 v1, s[44:47], s72 offen sc1 lds
v_mfma_f32_16x16x32_bf16 v[200:203], v[96:99], v[120:123], v[200:203]
buffer_load_dwordx4 v1, s[44:47], s72 offen offset:1024 sc1 lds
v_mfma_f32_16x16x32_bf16 v[204:207], v[96:99], v[124:127], v[204:207]
ds_read_b64_tr_b16 v[56:57], v14 offset:0
v_mfma_f32_16x16x32_bf16 v[220:223], v[100:103], v[124:127], v[220:223]
ds_read_b64_tr_b16 v[58:59], v14 offset:1024
v_mfma_f32_16x16x32_bf16 v[216:219], v[100:103], v[120:123], v[216:219]
ds_read_b64_tr_b16 v[60:61], v15 offset:0
v_mfma_f32_16x16x32_bf16 v[212:215], v[100:103], v[116:119], v[212:215]
buffer_load_dwordx4 v1, s[44:47], s72 offen offset:2048 sc1 lds
v_mfma_f32_16x16x32_bf16 v[208:211], v[100:103], v[112:115], v[208:211]
ds_read_b64_tr_b16 v[62:63], v15 offset:1024
v_mfma_f32_16x16x32_bf16 v[224:227], v[104:107], v[112:115], v[224:227]
v_mfma_f32_16x16x32_bf16 v[228:231], v[104:107], v[116:119], v[228:231]
buffer_load_dwordx4 v1, s[44:47], s72 offen offset:3072 sc1 lds
v_mfma_f32_16x16x32_bf16 v[232:235], v[104:107], v[120:123], v[232:235]
v_mfma_f32_16x16x32_bf16 v[236:239], v[104:107], v[124:127], v[236:239]
v_mfma_f32_16x16x32_bf16 v[252:255], v[108:111], v[124:127], v[252:255]
v_mfma_f32_16x16x32_bf16 v[248:251], v[108:111], v[120:123], v[248:251]
s_add_u32 m0, s64, 65536
v_mfma_f32_16x16x32_bf16 v[244:247], v[108:111], v[116:119], v[244:247]
s_add_u32 s72, s81, 0
buffer_load_dwordx4 v1, s[44:47], s72 offen sc1 lds
v_mfma_f32_16x16x32_bf16 v[240:243], v[108:111], v[112:115], v[240:243]
s_waitcnt lgkmcnt(0)
v_mfma_f32_16x16x32_bf16 v[128:131], v[32:35], v[64:67], v[128:131]
buffer_load_dwordx4 v1, s[44:47], s72 offen offset:1024 sc1 lds
v_mfma_f32_16x16x32_bf16 v[132:135], v[32:35], v[68:71], v[132:135]
ds_read_b64_tr_b16 v[80:81], v8 offset:8192
v_add_u32 v2, 0x8000, v1
v_mfma_f32_16x16x32_bf16 v[136:139], v[32:35], v[72:75], v[136:139]
ds_read_b64_tr_b16 v[82:83], v8 offset:9216
ds_read_b128 v[112:115], v17 offset:0
v_mfma_f32_16x16x32_bf16 v[140:143], v[32:35], v[76:79], v[140:143]
ds_read_b128 v[116:119], v17 offset:2048
ds_read_b128 v[120:123], v17 offset:4096
v_mfma_f32_16x16x32_bf16 v[156:159], v[36:39], v[76:79], v[156:159]
buffer_load_dwordx4 v1, s[44:47], s72 offen offset:2048 sc1 lds
v_mfma_f32_16x16x32_bf16 v[152:155], v[36:39], v[72:75], v[152:155]
ds_read_b128 v[124:127], v17 offset:6144
ds_read_b64_tr_b16 v[84:85], v9 offset:8192
v_mfma_f32_16x16x32_bf16 v[148:151], v[36:39], v[68:71], v[148:151]
ds_read_b64_tr_b16 v[86:87], v9 offset:9216
v_mfma_f32_16x16x32_bf16 v[144:147], v[36:39], v[64:67], v[144:147]
ds_read_b64_tr_b16 v[88:89], v10 offset:8192
v_mfma_f32_16x16x32_bf16 v[160:163], v[40:43], v[64:67], v[160:163]
buffer_load_dwordx4 v1, s[44:47], s72 offen offset:3072 sc1 lds
v_mfma_f32_16x16x32_bf16 v[164:167], v[40:43], v[68:71], v[164:167]
ds_read_b64_tr_b16 v[90:91], v10 offset:9216
v_mfma_f32_16x16x32_bf16 v[168:171], v[40:43], v[72:75], v[168:171]
ds_read_b64_tr_b16 v[92:93], v11 offset:8192
v_mfma_f32_16x16x32_bf16 v[172:175], v[40:43], v[76:79], v[172:175]
s_add_u32 s81, s81, 0x8000
ds_read_b64_tr_b16 v[94:95], v11 offset:9216
v_mfma_f32_16x16x32_bf16 v[188:191], v[44:47], v[76:79], v[188:191]
s_add_u32 m0, s64, 114688
ds_read_b64_tr_b16 v[96:97], v12 offset:8192
v_mfma_f32_16x16x32_bf16 v[184:187], v[44:47], v[72:75], v[184:187]
s_add_u32 s72, s81, 16384
buffer_load_dwordx4 v1, s[44:47], s72 offen sc1 lds
v_mfma_f32_16x16x32_bf16 v[180:183], v[44:47], v[68:71], v[180:183]
ds_read_b64_tr_b16 v[98:99], v12 offset:9216
v_mfma_f32_16x16x32_bf16 v[176:179], v[44:47], v[64:67], v[176:179]
buffer_load_dwordx4 v1, s[44:47], s72 offen offset:1024 sc1 lds
v_mfma_f32_16x16x32_bf16 v[192:195], v[48:51], v[64:67], v[192:195]
ds_read_b64_tr_b16 v[100:101], v13 offset:8192
v_mfma_f32_16x16x32_bf16 v[196:199], v[48:51], v[68:71], v[196:199]
ds_read_b64_tr_b16 v[102:103], v13 offset:9216
v_mfma_f32_16x16x32_bf16 v[200:203], v[48:51], v[72:75], v[200:203]
buffer_load_dwordx4 v1, s[44:47], s72 offen offset:2048 sc1 lds
v_mfma_f32_16x16x32_bf16 v[204:207], v[48:51], v[76:79], v[204:207]
ds_read_b64_tr_b16 v[104:105], v14 offset:8192
v_mfma_f32_16x16x32_bf16 v[220:223], v[52:55], v[76:79], v[220:223]
ds_read_b64_tr_b16 v[106:107], v14 offset:9216
v_mfma_f32_16x16x32_bf16 v[216:219], v[52:55], v[72:75], v[216:219]
ds_read_b64_tr_b16 v[108:109], v15 offset:8192
v_mfma_f32_16x16x32_bf16 v[212:215], v[52:55], v[68:71], v[212:215]
buffer_load_dwordx4 v1, s[44:47], s72 offen offset:3072 sc1 lds
v_mfma_f32_16x16x32_bf16 v[208:211], v[52:55], v[64:67], v[208:211]
ds_read_b64_tr_b16 v[110:111], v15 offset:9216
v_mfma_f32_16x16x32_bf16 v[224:227], v[56:59], v[64:67], v[224:227]
v_mfma_f32_16x16x32_bf16 v[228:231], v[56:59], v[68:71], v[228:231]
s_add_u32 m0, s64, 98304
v_mfma_f32_16x16x32_bf16 v[232:235], v[56:59], v[72:75], v[232:235]
s_add_u32 s72, s81, 0
buffer_load_dwordx4 v1, s[44:47], s72 offen sc1 lds
v_mfma_f32_16x16x32_bf16 v[236:239], v[56:59], v[76:79], v[236:239]
v_mfma_f32_16x16x32_bf16 v[252:255], v[60:63], v[76:79], v[252:255]
v_mfma_f32_16x16x32_bf16 v[248:251], v[60:63], v[72:75], v[248:251]
buffer_load_dwordx4 v1, s[44:47], s72 offen offset:1024 sc1 lds
v_mfma_f32_16x16x32_bf16 v[244:247], v[60:63], v[68:71], v[244:247]
s_waitcnt vmcnt(14) lgkmcnt(0)
v_mfma_f32_16x16x32_bf16 v[240:243], v[60:63], v[64:67], v[240:243]
s_barrier
v_mfma_f32_16x16x32_bf16 v[128:131], v[80:83], v[112:115], v[128:131]
buffer_load_dwordx4 v1, s[44:47], s72 offen offset:2048 sc1 lds
v_mfma_f32_16x16x32_bf16 v[132:135], v[80:83], v[116:119], v[132:135]
ds_read_b128 a[128:131], v2 offset:16384
v_mfma_f32_16x16x32_bf16 v[136:139], v[80:83], v[120:123], v[136:139]
ds_read_b128 a[144:147], v2 offset:20480
v_mfma_f32_16x16x32_bf16 v[140:143], v[80:83], v[124:127], v[140:143]
ds_read_b128 a[132:135], v2 offset:17408
v_mfma_f32_16x16x32_bf16 v[156:159], v[84:87], v[124:127], v[156:159]
buffer_load_dwordx4 v1, s[44:47], s72 offen offset:3072 sc1 lds
v_mfma_f32_16x16x32_bf16 v[152:155], v[84:87], v[120:123], v[152:155]
ds_read_b128 a[148:151], v2 offset:21504
v_mfma_f32_16x16x32_bf16 v[148:151], v[84:87], v[116:119], v[148:151]
ds_read_b128 a[136:139], v2 offset:18432
v_mfma_f32_16x16x32_bf16 v[144:147], v[84:87], v[112:115], v[144:147]
ds_read_b128 a[152:155], v2 offset:22528
v_mfma_f32_16x16x32_bf16 v[160:163], v[88:91], v[112:115], v[160:163]
ds_read_b128 a[140:143], v2 offset:19456
v_mfma_f32_16x16x32_bf16 v[164:167], v[88:91], v[116:119], v[164:167]
ds_read_b128 a[156:159], v2 offset:23552
v_mfma_f32_16x16x32_bf16 v[168:171], v[88:91], v[120:123], v[168:171]
v_mfma_f32_16x16x32_bf16 v[172:175], v[88:91], v[124:127], v[172:175]
v_mfma_f32_16x16x32_bf16 v[188:191], v[92:95], v[124:127], v[188:191]
v_cvt_pk_bf16_f32 v64, v140, v141
v_cvt_pk_bf16_f32 v65, v142, v143
v_mfma_f32_16x16x32_bf16 v[184:187], v[92:95], v[120:123], v[184:187]
v_cvt_pk_bf16_f32 v66, v156, v157
v_cvt_pk_bf16_f32 v67, v158, v159
v_mfma_f32_16x16x32_bf16 v[180:183], v[92:95], v[116:119], v[180:183]
v_cvt_pk_bf16_f32 v48, v136, v137
v_cvt_pk_bf16_f32 v49, v138, v139
v_mfma_f32_16x16x32_bf16 v[176:179], v[92:95], v[112:115], v[176:179]
v_cvt_pk_bf16_f32 v50, v152, v153
v_cvt_pk_bf16_f32 v51, v154, v155
v_mfma_f32_16x16x32_bf16 v[192:195], v[96:99], v[112:115], v[192:195]
v_cvt_pk_bf16_f32 v32, v132, v133
v_cvt_pk_bf16_f32 v33, v134, v135
v_mfma_f32_16x16x32_bf16 v[196:199], v[96:99], v[116:119], v[196:199]
v_cvt_pk_bf16_f32 v34, v148, v149
v_cvt_pk_bf16_f32 v35, v150, v151
v_mfma_f32_16x16x32_bf16 v[200:203], v[96:99], v[120:123], v[200:203]
v_cvt_pk_bf16_f32 v16, v128, v129
v_cvt_pk_bf16_f32 v17, v130, v131
v_mfma_f32_16x16x32_bf16 v[204:207], v[96:99], v[124:127], v[204:207]
v_cvt_pk_bf16_f32 v18, v144, v145
v_cvt_pk_bf16_f32 v19, v146, v147
v_mfma_f32_16x16x32_bf16 v[220:223], v[100:103], v[124:127], v[220:223]
v_cvt_pk_bf16_f32 v68, v172, v173
v_cvt_pk_bf16_f32 v69, v174, v175
v_mfma_f32_16x16x32_bf16 v[216:219], v[100:103], v[120:123], v[216:219]
v_cvt_pk_bf16_f32 v70, v188, v189
v_cvt_pk_bf16_f32 v71, v190, v191
v_mfma_f32_16x16x32_bf16 v[212:215], v[100:103], v[116:119], v[212:215]
v_cvt_pk_bf16_f32 v52, v168, v169
v_cvt_pk_bf16_f32 v53, v170, v171
v_mfma_f32_16x16x32_bf16 v[208:211], v[100:103], v[112:115], v[208:211]
v_cvt_pk_bf16_f32 v54, v184, v185
v_cvt_pk_bf16_f32 v55, v186, v187
v_mfma_f32_16x16x32_bf16 v[224:227], v[104:107], v[112:115], v[224:227]
v_cvt_pk_bf16_f32 v36, v164, v165
v_cvt_pk_bf16_f32 v37, v166, v167
v_mfma_f32_16x16x32_bf16 v[228:231], v[104:107], v[116:119], v[228:231]
v_cvt_pk_bf16_f32 v38, v180, v181
v_cvt_pk_bf16_f32 v39, v182, v183
v_mfma_f32_16x16x32_bf16 v[232:235], v[104:107], v[120:123], v[232:235]
v_cvt_pk_bf16_f32 v20, v160, v161
v_cvt_pk_bf16_f32 v21, v162, v163
v_mfma_f32_16x16x32_bf16 v[236:239], v[104:107], v[124:127], v[236:239]
v_cvt_pk_bf16_f32 v22, v176, v177
v_cvt_pk_bf16_f32 v23, v178, v179
v_mfma_f32_16x16x32_bf16 v[252:255], v[108:111], v[124:127], v[252:255]
v_cvt_pk_bf16_f32 v72, v204, v205
v_cvt_pk_bf16_f32 v73, v206, v207
v_mfma_f32_16x16x32_bf16 v[248:251], v[108:111], v[120:123], v[248:251]
v_cvt_pk_bf16_f32 v74, v220, v221
v_cvt_pk_bf16_f32 v75, v222, v223
v_mfma_f32_16x16x32_bf16 v[244:247], v[108:111], v[116:119], v[244:247]
v_cvt_pk_bf16_f32 v56, v200, v201
v_cvt_pk_bf16_f32 v57, v202, v203
v_mfma_f32_16x16x32_bf16 v[240:243], v[108:111], v[112:115], v[240:243]
v_cvt_pk_bf16_f32 v58, v216, v217
v_cvt_pk_bf16_f32 v59, v218, v219
v_cvt_pk_bf16_f32 v40, v196, v197
v_cvt_pk_bf16_f32 v41, v198, v199
v_cvt_pk_bf16_f32 v42, v212, v213
v_cvt_pk_bf16_f32 v43, v214, v215
v_cvt_pk_bf16_f32 v24, v192, v193
v_cvt_pk_bf16_f32 v25, v194, v195
v_cvt_pk_bf16_f32 v26, v208, v209
v_cvt_pk_bf16_f32 v27, v210, v211
v_cvt_pk_bf16_f32 v76, v236, v237
v_cvt_pk_bf16_f32 v77, v238, v239
v_cvt_pk_bf16_f32 v78, v252, v253
v_cvt_pk_bf16_f32 v79, v254, v255
v_cvt_pk_bf16_f32 v60, v232, v233
v_cvt_pk_bf16_f32 v61, v234, v235
v_cvt_pk_bf16_f32 v62, v248, v249
v_cvt_pk_bf16_f32 v63, v250, v251
v_cvt_pk_bf16_f32 v44, v228, v229
v_cvt_pk_bf16_f32 v45, v230, v231
v_cvt_pk_bf16_f32 v46, v244, v245
v_cvt_pk_bf16_f32 v47, v246, v247
v_cvt_pk_bf16_f32 v28, v224, v225
v_cvt_pk_bf16_f32 v29, v226, v227
v_cvt_pk_bf16_f32 v30, v240, v241
v_cvt_pk_bf16_f32 v31, v242, v243
v_mov_b32 v124, 0xff800000
v_mov_b32 v125, 0xff800000
v_mov_b32 v126, 0xff800000
v_mov_b32 v127, 0xff800000
s_lshl_b32 s84, s60, 2
s_add_u32 s84, s84, s58
s_lshl_b32 s85, s60, 3
s_sub_u32 s85, s58, s85
s_add_u32 s85, s85, 56
s_mov_b32 s86, 0
s_add_u32 s61, s65, s60
s_and_b32 s73, s60, 1
s_lshl_b32 s73, s73, 16
s_add_u32 s77, s73, s64
s_xor_b32 s73, s73, 0x10000
s_add_u32 s92, s92, s73
s_mul_i32 s62, s58, 4608
s_add_u32 s62, s62, 143104
s_add_u32 s73, s73, 49920
s_cmp_eq_u32 s58, 0
s_cselect_b32 s62, s73, s62
s_mul_i32 s66, s58, 4160
s_sub_u32 s66, 143552, s66
Lattn:
s_mov_b32 s82, 0x10000
s_waitcnt lgkmcnt(0)
v_mfma_f32_16x16x32_bf16 v[136:139], a[128:131], v[48:51], 0
ds_read_b128 a[160:163], v2 offset:24576
v_lshrrev_b32 v240, 4, v0
v_mfma_f32_16x16x32_bf16 v[140:143], a[128:131], v[64:67], 0
ds_read_b128 a[176:179], v2 offset:28672
v_and_b32 v241, 15, v0
v_mfma_f32_16x16x32_bf16 v[152:155], a[144:147], v[48:51], 0
ds_read_b128 a[164:167], v2 offset:25600
v_lshlrev_b32 v240, 2, v240
v_mfma_f32_16x16x32_bf16 v[156:159], a[144:147], v[64:67], 0
ds_read_b128 a[180:183], v2 offset:29696
v_sub_u32 v240, v241, v240
v_mfma_f32_16x16x32_bf16 v[136:139], a[132:135], v[52:55], v[136:139]
ds_read_b128 a[168:171], v2 offset:26624
v_mov_b32 v112, 0xff800000
v_mfma_f32_16x16x32_bf16 v[140:143], a[132:135], v[68:71], v[140:143]
ds_read_b128 a[184:187], v2 offset:30720
v_mov_b32 v113, 0xff800000
v_mfma_f32_16x16x32_bf16 v[156:159], a[148:151], v[68:71], v[156:159]
ds_read_b128 a[172:175], v2 offset:27648
v_mov_b32 v114, 0xff800000
v_mfma_f32_16x16x32_bf16 v[152:155], a[148:151], v[52:55], v[152:155]
ds_read_b128 a[188:191], v2 offset:31744
v_mov_b32 v115, 0xff800000
v_mfma_f32_16x16x32_bf16 v[140:143], a[136:139], v[72:75], v[140:143]
v_cmp_gt_i32 vcc, 0, v240
v_mov_b32 v120, 0x3f803f80
v_mfma_f32_16x16x32_bf16 v[136:139], a[136:139], v[56:59], v[136:139]
v_cndmask_b32 v116, 0, v112, vcc
v_cmp_gt_i32 vcc, 1, v240
v_mfma_f32_16x16x32_bf16 v[152:155], a[152:155], v[56:59], v[152:155]
v_mov_b32 v121, 0x3f803f80
v_cndmask_b32 v117, 0, v112, vcc
v_mfma_f32_16x16x32_bf16 v[156:159], a[152:155], v[72:75], v[156:159]
v_cmp_gt_i32 vcc, 2, v240
v_mov_b32 v122, 0x3f803f80
v_mfma_f32_16x16x32_bf16 v[136:139], a[140:143], v[60:63], v[136:139]
v_cndmask_b32 v118, 0, v112, vcc
v_cmp_gt_i32 vcc, 3, v240
v_mfma_f32_16x16x32_bf16 v[140:143], a[140:143], v[76:79], v[140:143]
v_mov_b32 v123, 0x3f803f80
v_cndmask_b32 v119, 0, v112, vcc
v_mfma_f32_16x16x32_bf16 v[156:159], a[156:159], v[76:79], v[156:159]
v_mfma_f32_16x16x32_bf16 v[152:155], a[156:159], v[60:63], v[152:155]
s_cmp_eq_u32 s84, 0
s_cbranch_scc1 Lalt7
v_mfma_f32_16x16x32_bf16 v[128:131], a[128:131], v[16:19], 0
v_mfma_f32_16x16x32_bf16 v[132:135], a[128:131], v[32:35], 0
v_mfma_f32_16x16x32_bf16 v[144:147], a[144:147], v[16:19], 0
v_mfma_f32_16x16x32_bf16 v[148:151], a[144:147], v[32:35], 0
Ljoin8:
v_mfma_f32_16x16x32_bf16 v[128:131], a[132:135], v[20:23], v[128:131]
v_mfma_f32_16x16x32_bf16 v[132:135], a[132:135], v[36:39], v[132:135]
v_max3_f32 v240, v136, v137, v126
v_max3_f32 v242, v140, v141, v127
v_mfma_f32_16x16x32_bf16 v[148:151], a[148:151], v[36:39], v[148:151]
v_max3_f32 v240, v240, v138, v139
v_max3_f32 v242, v242, v142, v143
v_mfma_f32_16x16x32_bf16 v[144:147], a[148:151], v[20:23], v[144:147]
v_max3_f32 v240, v240, v152, v153
v_max3_f32 v242, v242, v156, v157
v_mfma_f32_16x16x32_bf16 v[132:135], a[136:139], v[40:43], v[132:135]
v_max3_f32 v240, v240, v154, v155
v_max3_f32 v242, v242, v158, v159
v_mfma_f32_16x16x32_bf16 v[128:131], a[136:139], v[24:27], v[128:131]
v_mov_b32 v241, v240
v_mov_b32 v243, v242
v_mfma_f32_16x16x32_bf16 v[144:147], a[152:155], v[24:27], v[144:147]
v_permlane16_swap_b32 v240, v241
v_permlane16_swap_b32 v242, v243
v_mfma_f32_16x16x32_bf16 v[148:151], a[152:155], v[40:43], v[148:151]
v_max_f32 v240, v240, v241
v_max_f32 v242, v242, v243
v_mfma_f32_16x16x32_bf16 v[128:131], a[140:143], v[28:31], v[128:131]
v_mov_b32 v241, v240
v_mov_b32 v243, v242
v_mfma_f32_16x16x32_bf16 v[132:135], a[140:143], v[44:47], v[132:135]
v_permlane32_swap_b32 v240, v241
v_permlane32_swap_b32 v242, v243
v_mfma_f32_16x16x32_bf16 v[148:151], a[156:159], v[44:47], v[148:151]
v_max_f32 v240, v240, v241
v_max_f32 v242, v242, v243
v_mfma_f32_16x16x32_bf16 v[144:147], a[156:159], v[28:31], v[144:147]
v_sub_f32 v88, 0, v240
v_sub_f32 v89, 0, v240
v_sub_f32 v90, 0, v240
v_sub_f32 v91, 0, v240
v_sub_f32 v104, v116, v240
v_sub_f32 v105, v117, v240
v_sub_f32 v106, v118, v240
v_sub_f32 v107, v119, v240
v_sub_f32 v136, v136, v240
v_sub_f32 v137, v137, v240
v_sub_f32 v138, v138, v240
v_sub_f32 v139, v139, v240
v_sub_f32 v152, v152, v240
v_sub_f32 v153, v153, v240
v_sub_f32 v154, v154, v240
v_sub_f32 v155, v155, v240
v_sub_f32 v92, 0, v242
v_sub_f32 v93, 0, v242
v_sub_f32 v94, 0, v242
v_sub_f32 v95, 0, v242
v_sub_f32 v108, v116, v242
v_sub_f32 v109, v117, v242
v_sub_f32 v110, v118, v242
v_sub_f32 v111, v119, v242
v_sub_f32 v140, v140, v242
v_sub_f32 v141, v141, v242
v_sub_f32 v142, v142, v242
v_sub_f32 v143, v143, v242
v_sub_f32 v156, v156, v242
v_sub_f32 v157, v157, v242
v_sub_f32 v158, v158, v242
v_sub_f32 v159, v159, v242
v_max3_f32 v240, v128, v129, v124
v_max3_f32 v242, v132, v133, v125
v_max3_f32 v240, v240, v130, v131
v_max3_f32 v242, v242, v134, v135
v_max3_f32 v240, v240, v144, v145
v_max3_f32 v242, v242, v148, v149
v_max3_f32 v240, v240, v146, v147
v_max3_f32 v242, v242, v150, v151
v_mov_b32 v241, v240
v_mov_b32 v243, v242
s_nop 0
v_permlane16_swap_b32 v240, v241
v_permlane16_swap_b32 v242, v243
v_max_f32 v240, v240, v241
v_max_f32 v242, v242, v243
v_mov_b32 v241, v240
v_mov_b32 v243, v242
s_nop 0
v_permlane32_swap_b32 v240, v241
v_permlane32_swap_b32 v242, v243
v_max_f32 v240, v240, v241
v_max_f32 v242, v242, v243
v_sub_f32 v80, 0, v240
v_sub_f32 v81, 0, v240
v_sub_f32 v82, 0, v240
v_sub_f32 v83, 0, v240
v_sub_f32 v96, v116, v240
v_sub_f32 v97, v117, v240
v_sub_f32 v98, v118, v240
v_sub_f32 v99, v119, v240
v_sub_f32 v128, v128, v240
v_sub_f32 v129, v129, v240
v_sub_f32 v130, v130, v240
v_sub_f32 v131, v131, v240
v_sub_f32 v144, v144, v240
v_sub_f32 v145, v145, v240
v_sub_f32 v146, v146, v240
v_sub_f32 v147, v147, v240
v_sub_f32 v84, 0, v242
v_sub_f32 v85, 0, v242
v_sub_f32 v86, 0, v242
v_sub_f32 v87, 0, v242
v_sub_f32 v100, v116, v242
v_sub_f32 v101, v117, v242
v_sub_f32 v102, v118, v242
v_sub_f32 v103, v119, v242
v_sub_f32 v132, v132, v242
v_sub_f32 v133, v133, v242
v_sub_f32 v134, v134, v242
v_sub_f32 v135, v135, v242
v_sub_f32 v148, v148, v242
v_sub_f32 v149, v149, v242
v_sub_f32 v150, v150, v242
v_sub_f32 v151, v151, v242
v_lshrrev_b32 v3, 1, v0
v_lshlrev_b32 v3, 7, v3
v_add_u32 v2, s82, v1
s_waitcnt vmcnt(8) lgkmcnt(0)
s_barrier
s_cmp_le_u32 s84, 1
s_cbranch_scc1 Lalt9
v_mfma_f32_16x16x32_bf16 v[160:163], a[160:163], v[16:19], v[80:83]
s_xor_b32 s74, s82, 0x10000
v_exp_f32 v128, v128
v_mfma_f32_16x16x32_bf16 v[164:167], a[160:163], v[32:35], v[84:87]
s_add_u32 s74, s74, s64
ds_read_b128 a[128:131], v2 offset:16384
ds_read_b128 a[144:147], v2 offset:20480
v_mfma_f32_16x16x32_bf16 v[176:179], a[176:179], v[16:19], v[80:83]
s_add_u32 s81, s81, 0x8000
v_exp_f32 v129, v129
v_mfma_f32_16x16x32_bf16 v[180:183], a[176:179], v[32:35], v[84:87]
s_add_u32 m0, s74, 16384
v_exp_f32 v130, v130
Ljoin11:
v_mfma_f32_16x16x32_bf16 v[168:171], a[160:163], v[48:51], v[88:91]
s_add_u32 s72, s81, 16384
v_exp_f32 v131, v131
v_mfma_f32_16x16x32_bf16 v[172:175], a[160:163], v[64:67], v[92:95]
v_exp_f32 v144, v144
v_mfma_f32_16x16x32_bf16 v[184:187], a[176:179], v[48:51], v[88:91]
ds_read_b128 a[132:135], v2 offset:17408
ds_read_b128 a[148:151], v2 offset:21504
v_mfma_f32_16x16x32_bf16 v[188:191], a[176:179], v[64:67], v[92:95]
ds_read_b128 a[136:139], v2 offset:18432
ds_read_b128 a[152:155], v2 offset:22528
v_mfma_f32_16x16x32_bf16 v[160:163], a[164:167], v[20:23], v[160:163]
ds_read_b128 a[140:143], v2 offset:19456
ds_read_b128 a[156:159], v2 offset:23552
v_mfma_f32_16x16x32_bf16 v[164:167], a[164:167], v[36:39], v[164:167]
ds_read_b128 a[192:195], v2 offset:0
ds_read_b128 a[196:199], v2 offset:1024
v_mfma_f32_16x16x32_bf16 v[168:171], a[164:167], v[52:55], v[168:171]
ds_read_b128 a[200:203], v2 offset:2048
ds_read_b128 a[204:207], v2 offset:3072
v_mfma_f32_16x16x32_bf16 v[172:175], a[164:167], v[68:71], v[172:175]
ds_read_b128 a[208:211], v2 offset:4096
ds_read_b128 a[212:215], v2 offset:5120
v_mfma_f32_16x16x32_bf16 v[188:191], a[180:183], v[68:71], v[188:191]
ds_read_b128 a[216:219], v2 offset:6144
ds_read_b128 a[220:223], v2 offset:7168
v_mfma_f32_16x16x32_bf16 v[184:187], a[180:183], v[52:55], v[184:187]
v_cvt_pk_bf16_f32 v192, v128, v129
v_cvt_pk_bf16_f32 v193, v130, v131
v_mfma_f32_16x16x32_bf16 v[180:183], a[180:183], v[36:39], v[180:183]
buffer_load_dwordx4 v1, s[44:47], s72 offen sc1 lds
v_mfma_f32_16x16x32_bf16 v[176:179], a[180:183], v[20:23], v[176:179]
v_exp_f32 v145, v145
v_mfma_f32_16x16x32_bf16 v[172:175], a[168:171], v[72:75], v[172:175]
v_exp_f32 v146, v146
v_mfma_f32_16x16x32_bf16 v[168:171], a[168:171], v[56:59], v[168:171]
v_exp_f32 v147, v147
v_mfma_f32_16x16x32_bf16 v[164:167], a[168:171], v[40:43], v[164:167]
v_exp_f32 v132, v132
v_mfma_f32_16x16x32_bf16 v[160:163], a[168:171], v[24:27], v[160:163]
v_cvt_pk_bf16_f32 v194, v144, v145
v_cvt_pk_bf16_f32 v195, v146, v147
v_mfma_f32_16x16x32_bf16 v[176:179], a[184:187], v[24:27], v[176:179]
v_exp_f32 v133, v133
v_mfma_f32_16x16x32_bf16 v[180:183], a[184:187], v[40:43], v[180:183]
v_exp_f32 v134, v134
v_mfma_f32_16x16x32_bf16 v[184:187], a[184:187], v[56:59], v[184:187]
v_exp_f32 v135, v135
v_mfma_f32_16x16x32_bf16 v[188:191], a[184:187], v[72:75], v[188:191]
v_exp_f32 v148, v148
v_mfma_f32_16x16x32_bf16 v[160:163], a[172:175], v[28:31], v[160:163]
v_cvt_pk_bf16_f32 v196, v132, v133
v_cvt_pk_bf16_f32 v197, v134, v135
v_mfma_f32_16x16x32_bf16 v[164:167], a[172:175], v[44:47], v[164:167]
buffer_load_dwordx4 v1, s[44:47], s72 offen offset:1024 sc1 lds
v_mfma_f32_16x16x32_bf16 v[168:171], a[172:175], v[60:63], v[168:171]
v_exp_f32 v149, v149
v_mfma_f32_16x16x32_bf16 v[172:175], a[172:175], v[76:79], v[172:175]
v_exp_f32 v150, v150
v_mfma_f32_16x16x32_bf16 v[188:191], a[188:191], v[76:79], v[188:191]
v_exp_f32 v151, v151
v_mfma_f32_16x16x32_bf16 v[184:187], a[188:191], v[60:63], v[184:187]
buffer_load_dwordx4 v1, s[44:47], s72 offen offset:2048 sc1 lds
v_mfma_f32_16x16x32_bf16 v[180:183], a[188:191], v[44:47], v[180:183]
buffer_load_dwordx4 v1, s[44:47], s72 offen offset:3072 sc1 lds
v_mfma_f32_16x16x32_bf16 v[176:179], a[188:191], v[28:31], v[176:179]
s_waitcnt lgkmcnt(8)
v_exp_f32 v136, v136
v_cvt_pk_bf16_f32 v198, v148, v149
v_cvt_pk_bf16_f32 v199, v150, v151
v_exp_f32 v137, v137
v_exp_f32 v138, v138
v_cvt_pk_bf16_f32 v200, v136, v137
v_exp_f32 v139, v139
v_exp_f32 v152, v152
v_cvt_pk_bf16_f32 v201, v138, v139
v_exp_f32 v153, v153
v_exp_f32 v154, v154
v_cvt_pk_bf16_f32 v202, v152, v153
v_exp_f32 v155, v155
v_exp_f32 v140, v140
v_cvt_pk_bf16_f32 v203, v154, v155
v_exp_f32 v141, v141
v_exp_f32 v142, v142
v_cvt_pk_bf16_f32 v204, v140, v141
v_exp_f32 v143, v143
v_exp_f32 v156, v156
v_cvt_pk_bf16_f32 v205, v142, v143
v_exp_f32 v157, v157
v_exp_f32 v158, v158
v_cvt_pk_bf16_f32 v206, v156, v157
v_exp_f32 v159, v159
s_nop 0
v_cvt_pk_bf16_f32 v207, v158, v159
s_cmp_le_u32 s84, 2
s_cbranch_scc1 Lalt12
v_mfma_f32_16x16x32_bf16 v[128:131], a[128:131], v[16:19], v[80:83]
s_add_u32 s82, s82, 0x8000
ds_read_b128 a[160:163], v2 offset:24576
v_mfma_f32_16x16x32_bf16 v[132:135], a[128:131], v[32:35], v[84:87]
s_and_b32 s82, s82, 0x1ffff
v_exp_f32 v160, v160
v_mfma_f32_16x16x32_bf16 v[144:147], a[144:147], v[16:19], v[80:83]
s_lshl_b32 s75, s93, 1
v_exp_f32 v161, v161
v_mfma_f32_16x16x32_bf16 v[148:151], a[144:147], v[32:35], v[84:87]
ds_read_b128 a[176:179], v2 offset:28672
v_cvt_pk_bf16_f32 v208, v160, v161
Ljoin14:
v_mfma_f32_16x16x32_bf16 v[136:139], a[128:131], v[48:51], v[88:91]
v_exp_f32 v162, v162
v_mfma_f32_16x16x32_bf16 v[140:143], a[128:131], v[64:67], v[92:95]
v_exp_f32 v163, v163
v_mfma_f32_16x16x32_bf16 v[152:155], a[144:147], v[48:51], v[88:91]
buffer_load_dword v4, v3, s[24:27], s75 offen
v_mfma_f32_16x16x32_bf16 v[156:159], a[144:147], v[64:67], v[92:95]
s_add_u32 m0, s74, 0
ds_read_b128 a[164:167], v2 offset:25600
v_cvt_pk_bf16_f32 v209, v162, v163
v_mfma_f32_16x16x32_bf16 v[128:131], a[132:135], v[20:23], v[128:131]
s_add_u32 s72, s81, 0
v_exp_f32 v176, v176
v_mfma_f32_16x16x32_bf16 v[132:135], a[132:135], v[36:39], v[132:135]
v_exp_f32 v177, v177
v_mfma_f32_16x16x32_bf16 v[136:139], a[132:135], v[52:55], v[136:139]
ds_read_b128 a[180:183], v2 offset:29696
v_cvt_pk_bf16_f32 v210, v176, v177
v_mfma_f32_16x16x32_bf16 v[140:143], a[132:135], v[68:71], v[140:143]
v_exp_f32 v178, v178
v_mfma_f32_16x16x32_bf16 v[156:159], a[148:151], v[68:71], v[156:159]
v_exp_f32 v179, v179
v_mfma_f32_16x16x32_bf16 v[152:155], a[148:151], v[52:55], v[152:155]
ds_read_b128 a[168:171], v2 offset:26624
v_cvt_pk_bf16_f32 v211, v178, v179
v_mfma_f32_16x16x32_bf16 v[148:151], a[148:151], v[36:39], v[148:151]
v_exp_f32 v164, v164
v_mfma_f32_16x16x32_bf16 v[144:147], a[148:151], v[20:23], v[144:147]
v_exp_f32 v165, v165
v_mfma_f32_16x16x32_bf16 v[140:143], a[136:139], v[72:75], v[140:143]
ds_read_b128 a[184:187], v2 offset:30720
v_cvt_pk_bf16_f32 v212, v164, v165
v_mfma_f32_16x16x32_bf16 v[136:139], a[136:139], v[56:59], v[136:139]
v_exp_f32 v166, v166
v_mfma_f32_16x16x32_bf16 v[132:135], a[136:139], v[40:43], v[132:135]
buffer_load_dwordx4 v1, s[44:47], s72 offen sc1 lds
v_mfma_f32_16x16x32_bf16 v[128:131], a[136:139], v[24:27], v[128:131]
v_exp_f32 v167, v167
v_mfma_f32_16x16x32_bf16 v[144:147], a[152:155], v[24:27], v[144:147]
ds_read_b128 a[172:175], v2 offset:27648
v_cvt_pk_bf16_f32 v213, v166, v167
v_mfma_f32_16x16x32_bf16 v[148:151], a[152:155], v[40:43], v[148:151]
v_exp_f32 v180, v180
v_mfma_f32_16x16x32_bf16 v[152:155], a[152:155], v[56:59], v[152:155]
v_exp_f32 v181, v181
v_mfma_f32_16x16x32_bf16 v[156:159], a[152:155], v[72:75], v[156:159]
ds_read_b128 a[188:191], v2 offset:31744
v_cvt_pk_bf16_f32 v214, v180, v181
v_mfma_f32_16x16x32_bf16 v[128:131], a[140:143], v[28:31], v[128:131]
v_exp_f32 v182, v182
v_mfma_f32_16x16x32_bf16 v[132:135], a[140:143], v[44:47], v[132:135]
v_exp_f32 v183, v183
v_mfma_f32_16x16x32_bf16 v[136:139], a[140:143], v[60:63], v[136:139]
ds_read_b128 a[224:227], v2 offset:8192
v_cvt_pk_bf16_f32 v215, v182, v183
v_mfma_f32_16x16x32_bf16 v[140:143], a[140:143], v[76:79], v[140:143]
v_exp_f32 v168, v168
v_mfma_f32_16x16x32_bf16 v[156:159], a[156:159], v[76:79], v[156:159]
buffer_load_dwordx4 v1, s[44:47], s72 offen offset:1024 sc1 lds
v_mfma_f32_16x16x32_bf16 v[152:155], a[156:159], v[60:63], v[152:155]
v_exp_f32 v169, v169
v_mfma_f32_16x16x32_bf16 v[148:151], a[156:159], v[44:47], v[148:151]
ds_read_b128 a[228:231], v2 offset:9216
v_cvt_pk_bf16_f32 v216, v168, v169
v_mfma_f32_16x16x32_bf16 v[144:147], a[156:159], v[28:31], v[144:147]
s_waitcnt lgkmcnt(10)
v_exp_f32 v170, v170
v_mfma_f32_16x16x32_bf16 a[0:3], a[192:195], v[192:195], 0
v_exp_f32 v171, v171
v_mfma_f32_16x16x32_bf16 a[32:35], a[192:195], v[196:199], 0
ds_read_b128 a[232:235], v2 offset:10240
v_cvt_pk_bf16_f32 v217, v170, v171
v_mfma_f32_16x16x32_bf16 a[64:67], a[192:195], v[200:203], 0
v_exp_f32 v184, v184
v_mfma_f32_16x16x32_bf16 a[96:99], a[192:195], v[204:207], 0
v_exp_f32 v185, v185
v_mfma_f32_16x16x32_bf16 a[100:103], a[196:199], v[204:207], 0
ds_read_b128 a[236:239], v2 offset:11264
v_cvt_pk_bf16_f32 v218, v184, v185
v_mfma_f32_16x16x32_bf16 a[68:71], a[196:199], v[200:203], 0
v_exp_f32 v186, v186
v_mfma_f32_16x16x32_bf16 a[36:39], a[196:199], v[196:199], 0
buffer_load_dwordx4 v1, s[44:47], s72 offen offset:2048 sc1 lds
v_mfma_f32_16x16x32_bf16 a[4:7], a[196:199], v[192:195], 0
v_exp_f32 v187, v187
v_mfma_f32_16x16x32_bf16 a[8:11], a[200:203], v[192:195], 0
ds_read_b128 a[240:243], v2 offset:12288
v_cvt_pk_bf16_f32 v219, v186, v187
v_mfma_f32_16x16x32_bf16 a[40:43], a[200:203], v[196:199], 0
v_exp_f32 v172, v172
v_mfma_f32_16x16x32_bf16 a[72:75], a[200:203], v[200:203], 0
v_exp_f32 v173, v173
v_mfma_f32_16x16x32_bf16 a[104:107], a[200:203], v[204:207], 0
ds_read_b128 a[244:247], v2 offset:13312
v_cvt_pk_bf16_f32 v220, v172, v173
v_mfma_f32_16x16x32_bf16 a[108:111], a[204:207], v[204:207], 0
v_exp_f32 v174, v174
v_mfma_f32_16x16x32_bf16 a[76:79], a[204:207], v[200:203], 0
v_exp_f32 v175, v175
v_mfma_f32_16x16x32_bf16 a[44:47], a[204:207], v[196:199], 0
ds_read_b128 a[248:251], v2 offset:14336
v_cvt_pk_bf16_f32 v221, v174, v175
v_mfma_f32_16x16x32_bf16 a[12:15], a[204:207], v[192:195], 0
v_exp_f32 v188, v188
v_mfma_f32_16x16x32_bf16 a[16:19], a[208:211], v[192:195], 0
v_exp_f32 v189, v189
v_mfma_f32_16x16x32_bf16 a[48:51], a[208:211], v[196:199], 0
buffer_load_dwordx4 v1, s[44:47], s72 offen offset:3072 sc1 lds
v_mfma_f32_16x16x32_bf16 a[80:83], a[208:211], v[200:203], 0
ds_read_b128 a[252:255], v2 offset:15360
v_cvt_pk_bf16_f32 v222, v188, v189
v_mfma_f32_16x16x32_bf16 a[112:115], a[208:211], v[204:207], 0
v_exp_f32 v190, v190
v_mfma_f32_16x16x32_bf16 a[116:119], a[212:215], v[204:207], 0
v_exp_f32 v191, v191
v_mfma_f32_16x16x32_bf16 a[84:87], a[212:215], v[200:203], 0
v_cvt_pk_bf16_f32 v223, v190, v191
v_add_u32 v2, s82, v1
v_mfma_f32_16x16x32_bf16 a[52:55], a[212:215], v[196:199], 0
v_and_b32 v240, 15, v0
v_lshrrev_b32 v241, 4, v0
v_mfma_f32_16x16x32_bf16 a[20:23], a[212:215], v[192:195], 0
v_add_u32 v248, 1, v240
v_and_b32 v249, 3, v248
v_mfma_f32_16x16x32_bf16 a[24:27], a[216:219], v[192:195], 0
v_lshrrev_b32 v248, 2, v248
v_mfma_f32_16x16x32_bf16 a[56:59], a[216:219], v[196:199], 0
s_sub_u32 s73, s92, 4160
v_mov_b32 v250, s66
v_max_u32 v6, 1, v249
v_mfma_f32_16x16x32_bf16 a[88:91], a[216:219], v[200:203], 0
v_cmp_ne_u32 vcc, 1, v249
v_mul_u32_u24 v6, 4160, v6
v_mfma_f32_16x16x32_bf16 a[120:123], a[216:219], v[204:207], 0
v_add_u32 v6, s73, v6
v_cndmask_b32 v6, v250, v6, vcc
v_mfma_f32_16x16x32_bf16 a[124:127], a[220:223], v[204:207], 0
v_bfe_u32 v251, v0, 2, 2
v_lshl_add_u32 v6, v248, 3, v6
v_mfma_f32_16x16x32_bf16 a[92:95], a[220:223], v[200:203], 0
v_lshl_add_u32 v6, v241, 4, v6
v_max_u32 v5, 1, v251
v_mfma_f32_16x16x32_bf16 a[60:63], a[220:223], v[196:199], 0
v_cmp_ne_u32 vcc, 1, v251
v_mul_u32_u24 v5, 4160, v5
v_mfma_f32_16x16x32_bf16 a[28:31], a[220:223], v[192:195], 0
v_add_u32 v5, s73, v5
v_cndmask_b32 v5, v250, v5, vcc
v_mfma_f32_16x16x32_bf16 v[224:227], v[120:123], v[192:195], 0
s_add_u32 s73, s62, 480
v_lshlrev_b32 v248, 5, v240
v_sub_u32 v248, s73, v248
v_mfma_f32_16x16x32_bf16 v[228:231], v[120:123], v[196:199], 0
v_lshl_add_u32 v7, v241, 4, v248
v_mfma_f32_16x16x32_bf16 v[232:235], v[120:123], v[200:203], 0
s_waitcnt vmcnt(9) lgkmcnt(8)
v_mfma_f32_16x16x32_bf16 v[236:239], v[120:123], v[204:207], 0
s_barrier
s_cmp_eq_u32 s60, 0
s_cbranch_scc1 LLT3
s_lshl_b32 s83, s60, 1
s_sub_u32 s83, 2, s83
s_cmp_eq_u32 s83, 0
s_cbranch_scc1 LLT1
LloopI:
v_mfma_f32_16x16x32_bf16 v[160:163], a[160:163], v[16:19], v[80:83]
s_xor_b32 s74, s82, 0x10000
v_exp_f32 v128, v128
v_mfma_f32_16x16x32_bf16 v[164:167], a[160:163], v[32:35], v[84:87]
s_add_u32 s74, s74, s64
ds_read_b128 a[128:131], v2 offset:16384
v_mfma_f32_16x16x32_bf16 v[168:171], a[160:163], v[48:51], v[88:91]
s_add_u32 s81, s81, 0x8000
v_exp_f32 v129, v129
v_mfma_f32_16x16x32_bf16 v[172:175], a[160:163], v[64:67], v[92:95]
s_add_u32 m0, s74, 16384
v_exp_f32 v130, v130
v_mfma_f32_16x16x32_bf16 v[176:179], a[176:179], v[16:19], v[80:83]
s_add_u32 s72, s81, 16384
ds_read_b128 a[144:147], v2 offset:20480
v_cvt_pk_bf16_f32 v192, v128, v129
v_mfma_f32_16x16x32_bf16 v[180:183], a[176:179], v[32:35], v[84:87]
v_exp_f32 v131, v131
v_mfma_f32_16x16x32_bf16 v[184:187], a[176:179], v[48:51], v[88:91]
v_exp_f32 v144, v144
v_mfma_f32_16x16x32_bf16 v[188:191], a[176:179], v[64:67], v[92:95]
ds_read_b128 a[132:135], v2 offset:17408
v_cvt_pk_bf16_f32 v193, v130, v131
v_mfma_f32_16x16x32_bf16 v[160:163], a[164:167], v[20:23], v[160:163]
buffer_load_dwordx4 v1, s[44:47], s72 offen sc1 lds
v_mfma_f32_16x16x32_bf16 v[164:167], a[164:167], v[36:39], v[164:167]
v_exp_f32 v145, v145
v_mfma_f32_16x16x32_bf16 v[168:171], a[164:167], v[52:55], v[168:171]
v_exp_f32 v146, v146
v_mfma_f32_16x16x32_bf16 v[172:175], a[164:167], v[68:71], v[172:175]
ds_read_b128 a[148:151], v2 offset:21504
v_cvt_pk_bf16_f32 v194, v144, v145
v_mfma_f32_16x16x32_bf16 v[188:191], a[180:183], v[68:71], v[188:191]
v_exp_f32 v147, v147
v_mfma_f32_16x16x32_bf16 v[184:187], a[180:183], v[52:55], v[184:187]
v_exp_f32 v132, v132
v_mfma_f32_16x16x32_bf16 v[180:183], a[180:183], v[36:39], v[180:183]
ds_read_b128 a[136:139], v2 offset:18432
v_cvt_pk_bf16_f32 v195, v146, v147
v_mfma_f32_16x16x32_bf16 v[176:179], a[180:183], v[20:23], v[176:179]
v_exp_f32 v133, v133
v_mfma_f32_16x16x32_bf16 v[172:175], a[168:171], v[72:75], v[172:175]
v_exp_f32 v134, v134
v_mfma_f32_16x16x32_bf16 v[168:171], a[168:171], v[56:59], v[168:171]
ds_read_b128 a[152:155], v2 offset:22528
v_cvt_pk_bf16_f32 v196, v132, v133
v_mfma_f32_16x16x32_bf16 v[164:167], a[168:171], v[40:43], v[164:167]
v_exp_f32 v135, v135
v_mfma_f32_16x16x32_bf16 v[160:163], a[168:171], v[24:27], v[160:163]
v_exp_f32 v148, v148
v_mfma_f32_16x16x32_bf16 v[176:179], a[184:187], v[24:27], v[176:179]
ds_read_b128 a[140:143], v2 offset:19456
v_cvt_pk_bf16_f32 v197, v134, v135
v_mfma_f32_16x16x32_bf16 v[180:183], a[184:187], v[40:43], v[180:183]
buffer_load_dwordx4 v1, s[44:47], s72 offen offset:1024 sc1 lds
v_mfma_f32_16x16x32_bf16 v[184:187], a[184:187], v[56:59], v[184:187]
v_exp_f32 v149, v149
v_mfma_f32_16x16x32_bf16 v[188:191], a[184:187], v[72:75], v[188:191]
v_exp_f32 v150, v150
v_mfma_f32_16x16x32_bf16 v[160:163], a[172:175], v[28:31], v[160:163]
ds_read_b128 a[156:159], v2 offset:23552
v_cvt_pk_bf16_f32 v198, v148, v149
v_mfma_f32_16x16x32_bf16 v[164:167], a[172:175], v[44:47], v[164:167]
v_exp_f32 v151, v151
v_mfma_f32_16x16x32_bf16 v[168:171], a[172:175], v[60:63], v[168:171]
v_exp_f32 v136, v136
v_mfma_f32_16x16x32_bf16 v[172:175], a[172:175], v[76:79], v[172:175]
ds_read_b128 a[192:195], v2 offset:0
v_cvt_pk_bf16_f32 v199, v150, v151
v_mfma_f32_16x16x32_bf16 v[188:191], a[188:191], v[76:79], v[188:191]
v_exp_f32 v137, v137
v_mfma_f32_16x16x32_bf16 v[184:187], a[188:191], v[60:63], v[184:187]
v_exp_f32 v138, v138
v_mfma_f32_16x16x32_bf16 v[180:183], a[188:191], v[44:47], v[180:183]
ds_read_b128 a[196:199], v2 offset:1024
v_cvt_pk_bf16_f32 v200, v136, v137
v_mfma_f32_16x16x32_bf16 v[176:179], a[188:191], v[28:31], v[176:179]
s_waitcnt lgkmcnt(10)
v_exp_f32 v139, v139
v_mfma_f32_16x16x32_bf16 a[0:3], a[224:227], v[208:211], a[0:3]
v_exp_f32 v152, v152
v_mfma_f32_16x16x32_bf16 a[32:35], a[224:227], v[212:215], a[32:35]
ds_read_b128 a[200:203], v2 offset:2048
v_cvt_pk_bf16_f32 v201, v138, v139
v_mfma_f32_16x16x32_bf16 a[64:67], a[224:227], v[216:219], a[64:67]
buffer_load_dwordx4 v1, s[44:47], s72 offen offset:2048 sc1 lds
v_mfma_f32_16x16x32_bf16 a[96:99], a[224:227], v[220:223], a[96:99]
v_exp_f32 v153, v153
v_mfma_f32_16x16x32_bf16 a[100:103], a[228:231], v[220:223], a[100:103]
v_exp_f32 v154, v154
v_mfma_f32_16x16x32_bf16 a[68:71], a[228:231], v[216:219], a[68:71]
ds_read_b128 a[204:207], v2 offset:3072
v_cvt_pk_bf16_f32 v202, v152, v153
v_mfma_f32_16x16x32_bf16 a[36:39], a[228:231], v[212:215], a[36:39]
v_exp_f32 v155, v155
v_mfma_f32_16x16x32_bf16 a[4:7], a[228:231], v[208:211], a[4:7]
v_exp_f32 v140, v140
v_mfma_f32_16x16x32_bf16 a[8:11], a[232:235], v[208:211], a[8:11]
ds_read_b128 a[208:211], v2 offset:4096
v_cvt_pk_bf16_f32 v203, v154, v155
v_mfma_f32_16x16x32_bf16 a[40:43], a[232:235], v[212:215], a[40:43]
v_exp_f32 v141, v141
v_mfma_f32_16x16x32_bf16 a[72:75], a[232:235], v[216:219], a[72:75]
v_exp_f32 v142, v142
v_mfma_f32_16x16x32_bf16 a[104:107], a[232:235], v[220:223], a[104:107]
ds_read_b128 a[212:215], v2 offset:5120
v_cvt_pk_bf16_f32 v204, v140, v141
v_mfma_f32_16x16x32_bf16 a[108:111], a[236:239], v[220:223], a[108:111]
v_exp_f32 v143, v143
v_mfma_f32_16x16x32_bf16 a[76:79], a[236:239], v[216:219], a[76:79]
v_exp_f32 v156, v156
v_mfma_f32_16x16x32_bf16 a[44:47], a[236:239], v[212:215], a[44:47]
ds_read_b128 a[216:219], v2 offset:6144
v_cvt_pk_bf16_f32 v205, v142, v143
v_mfma_f32_16x16x32_bf16 a[12:15], a[236:239], v[208:211], a[12:15]
buffer_load_dwordx4 v1, s[44:47], s72 offen offset:3072 sc1 lds
v_mfma_f32_16x16x32_bf16 a[16:19], a[240:243], v[208:211], a[16:19]
v_exp_f32 v157, v157
v_mfma_f32_16x16x32_bf16 a[48:51], a[240:243], v[212:215], a[48:51]
v_exp_f32 v158, v158
v_mfma_f32_16x16x32_bf16 a[80:83], a[240:243], v[216:219], a[80:83]
ds_read_b128 a[220:223], v2 offset:7168
v_cvt_pk_bf16_f32 v206, v156, v157
v_mfma_f32_16x16x32_bf16 a[112:115], a[240:243], v[220:223], a[112:115]
v_exp_f32 v159, v159
v_mfma_f32_16x16x32_bf16 a[116:119], a[244:247], v[220:223], a[116:119]
v_cvt_pk_bf16_f32 v207, v158, v159
v_mfma_f32_16x16x32_bf16 a[84:87], a[244:247], v[216:219], a[84:87]
v_mfma_f32_16x16x32_bf16 a[52:55], a[244:247], v[212:215], a[52:55]
v_mfma_f32_16x16x32_bf16 a[20:23], a[244:247], v[208:211], a[20:23]
v_mfma_f32_16x16x32_bf16 a[24:27], a[248:251], v[208:211], a[24:27]
v_mfma_f32_16x16x32_bf16 a[56:59], a[248:251], v[212:215], a[56:59]
v_mfma_f32_16x16x32_bf16 a[88:91], a[248:251], v[216:219], a[88:91]
v_mfma_f32_16x16x32_bf16 a[120:123], a[248:251], v[220:223], a[120:123]
v_mfma_f32_16x16x32_bf16 a[124:127], a[252:255], v[220:223], a[124:127]
v_mfma_f32_16x16x32_bf16 a[92:95], a[252:255], v[216:219], a[92:95]
v_mfma_f32_16x16x32_bf16 a[60:63], a[252:255], v[212:215], a[60:63]
v_mfma_f32_16x16x32_bf16 a[28:31], a[252:255], v[208:211], a[28:31]
v_mfma_f32_16x16x32_bf16 v[224:227], v[120:123], v[208:211], v[224:227]
v_mfma_f32_16x16x32_bf16 v[228:231], v[120:123], v[212:215], v[228:231]
v_mfma_f32_16x16x32_bf16 v[232:235], v[120:123], v[216:219], v[232:235]
v_mfma_f32_16x16x32_bf16 v[236:239], v[120:123], v[220:223], v[236:239]
s_waitcnt lgkmcnt(8)
v_mfma_f32_16x16x32_bf16 v[128:131], a[128:131], v[16:19], v[80:83]
s_add_u32 s82, s82, 0x8000
ds_read_b128 a[160:163], v2 offset:24576
v_mfma_f32_16x16x32_bf16 v[132:135], a[128:131], v[32:35], v[84:87]
s_and_b32 s82, s82, 0x1ffff
v_exp_f32 v160, v160
v_mfma_f32_16x16x32_bf16 v[136:139], a[128:131], v[48:51], v[88:91]
s_add_u32 m0, s74, 0
v_exp_f32 v161, v161
v_mfma_f32_16x16x32_bf16 v[140:143], a[128:131], v[64:67], v[92:95]
s_add_u32 s72, s81, 0
ds_read_b128 a[176:179], v2 offset:28672
v_cvt_pk_bf16_f32 v208, v160, v161
v_mfma_f32_16x16x32_bf16 v[144:147], a[144:147], v[16:19], v[80:83]
v_exp_f32 v162, v162
v_mfma_f32_16x16x32_bf16 v[148:151], a[144:147], v[32:35], v[84:87]
v_exp_f32 v163, v163
v_mfma_f32_16x16x32_bf16 v[152:155], a[144:147], v[48:51], v[88:91]
ds_read_b128 a[164:167], v2 offset:25600
v_cvt_pk_bf16_f32 v209, v162, v163
v_mfma_f32_16x16x32_bf16 v[156:159], a[144:147], v[64:67], v[92:95]
v_exp_f32 v176, v176
v_mfma_f32_16x16x32_bf16 v[128:131], a[132:135], v[20:23], v[128:131]
buffer_load_dwordx4 v1, s[44:47], s72 offen sc1 lds
v_mfma_f32_16x16x32_bf16 v[132:135], a[132:135], v[36:39], v[132:135]
v_exp_f32 v177, v177
v_mfma_f32_16x16x32_bf16 v[136:139], a[132:135], v[52:55], v[136:139]
ds_read_b128 a[180:183], v2 offset:29696
v_cvt_pk_bf16_f32 v210, v176, v177
v_mfma_f32_16x16x32_bf16 v[140:143], a[132:135], v[68:71], v[140:143]
v_exp_f32 v178, v178
v_mfma_f32_16x16x32_bf16 v[156:159], a[148:151], v[68:71], v[156:159]
v_exp_f32 v179, v179
v_mfma_f32_16x16x32_bf16 v[152:155], a[148:151], v[52:55], v[152:155]
ds_read_b128 a[168:171], v2 offset:26624
v_cvt_pk_bf16_f32 v211, v178, v179
v_mfma_f32_16x16x32_bf16 v[148:151], a[148:151], v[36:39], v[148:151]
v_exp_f32 v164, v164
v_mfma_f32_16x16x32_bf16 v[144:147], a[148:151], v[20:23], v[144:147]
v_exp_f32 v165, v165
v_mfma_f32_16x16x32_bf16 v[140:143], a[136:139], v[72:75], v[140:143]
ds_read_b128 a[184:187], v2 offset:30720
v_cvt_pk_bf16_f32 v212, v164, v165
v_mfma_f32_16x16x32_bf16 v[136:139], a[136:139], v[56:59], v[136:139]
v_exp_f32 v166, v166
v_mfma_f32_16x16x32_bf16 v[132:135], a[136:139], v[40:43], v[132:135]
v_exp_f32 v167, v167
v_mfma_f32_16x16x32_bf16 v[128:131], a[136:139], v[24:27], v[128:131]
ds_read_b128 a[172:175], v2 offset:27648
v_cvt_pk_bf16_f32 v213, v166, v167
v_mfma_f32_16x16x32_bf16 v[144:147], a[152:155], v[24:27], v[144:147]
v_exp_f32 v180, v180
v_mfma_f32_16x16x32_bf16 v[148:151], a[152:155], v[40:43], v[148:151]
buffer_load_dwordx4 v1, s[44:47], s72 offen offset:1024 sc1 lds
v_mfma_f32_16x16x32_bf16 v[152:155], a[152:155], v[56:59], v[152:155]
v_exp_f32 v181, v181
v_mfma_f32_16x16x32_bf16 v[156:159], a[152:155], v[72:75], v[156:159]
ds_read_b128 a[188:191], v2 offset:31744
v_cvt_pk_bf16_f32 v214, v180, v181
v_mfma_f32_16x16x32_bf16 v[128:131], a[140:143], v[28:31], v[128:131]
v_exp_f32 v182, v182
v_mfma_f32_16x16x32_bf16 v[132:135], a[140:143], v[44:47], v[132:135]
v_exp_f32 v183, v183
v_mfma_f32_16x16x32_bf16 v[136:139], a[140:143], v[60:63], v[136:139]
ds_read_b128 a[224:227], v2 offset:8192
v_cvt_pk_bf16_f32 v215, v182, v183
v_mfma_f32_16x16x32_bf16 v[140:143], a[140:143], v[76:79], v[140:143]
v_exp_f32 v168, v168
v_mfma_f32_16x16x32_bf16 v[156:159], a[156:159], v[76:79], v[156:159]
v_exp_f32 v169, v169
v_mfma_f32_16x16x32_bf16 v[152:155], a[156:159], v[60:63], v[152:155]
ds_read_b128 a[228:231], v2 offset:9216
v_cvt_pk_bf16_f32 v216, v168, v169
v_mfma_f32_16x16x32_bf16 v[148:151], a[156:159], v[44:47], v[148:151]
v_exp_f32 v170, v170
v_mfma_f32_16x16x32_bf16 v[144:147], a[156:159], v[28:31], v[144:147]
s_waitcnt lgkmcnt(10)
v_exp_f32 v171, v171
v_mfma_f32_16x16x32_bf16 a[0:3], a[192:195], v[192:195], a[0:3]
ds_read_b128 a[232:235], v2 offset:10240
v_cvt_pk_bf16_f32 v217, v170, v171
v_mfma_f32_16x16x32_bf16 a[32:35], a[192:195], v[196:199], a[32:35]
v_exp_f32 v184, v184
v_mfma_f32_16x16x32_bf16 a[64:67], a[192:195], v[200:203], a[64:67]
buffer_load_dwordx4 v1, s[44:47], s72 offen offset:2048 sc1 lds
v_mfma_f32_16x16x32_bf16 a[96:99], a[192:195], v[204:207], a[96:99]
v_exp_f32 v185, v185
v_mfma_f32_16x16x32_bf16 a[100:103], a[196:199], v[204:207], a[100:103]
ds_read_b128 a[236:239], v2 offset:11264
v_cvt_pk_bf16_f32 v218, v184, v185
v_mfma_f32_16x16x32_bf16 a[68:71], a[196:199], v[200:203], a[68:71]
v_exp_f32 v186, v186
v_mfma_f32_16x16x32_bf16 a[36:39], a[196:199], v[196:199], a[36:39]
v_exp_f32 v187, v187
v_mfma_f32_16x16x32_bf16 a[4:7], a[196:199], v[192:195], a[4:7]
ds_read_b128 a[240:243], v2 offset:12288
v_cvt_pk_bf16_f32 v219, v186, v187
v_mfma_f32_16x16x32_bf16 a[8:11], a[200:203], v[192:195], a[8:11]
v_exp_f32 v172, v172
v_mfma_f32_16x16x32_bf16 a[40:43], a[200:203], v[196:199], a[40:43]
v_exp_f32 v173, v173
v_mfma_f32_16x16x32_bf16 a[72:75], a[200:203], v[200:203], a[72:75]
ds_read_b128 a[244:247], v2 offset:13312
v_cvt_pk_bf16_f32 v220, v172, v173
v_mfma_f32_16x16x32_bf16 a[104:107], a[200:203], v[204:207], a[104:107]
v_exp_f32 v174, v174
v_mfma_f32_16x16x32_bf16 a[108:111], a[204:207], v[204:207], a[108:111]
v_exp_f32 v175, v175
v_mfma_f32_16x16x32_bf16 a[76:79], a[204:207], v[200:203], a[76:79]
ds_read_b128 a[248:251], v2 offset:14336
v_cvt_pk_bf16_f32 v221, v174, v175
v_mfma_f32_16x16x32_bf16 a[44:47], a[204:207], v[196:199], a[44:47]
v_exp_f32 v188, v188
v_mfma_f32_16x16x32_bf16 a[12:15], a[204:207], v[192:195], a[12:15]
buffer_load_dwordx4 v1, s[44:47], s72 offen offset:3072 sc1 lds
v_mfma_f32_16x16x32_bf16 a[16:19], a[208:211], v[192:195], a[16:19]
v_exp_f32 v189, v189
v_mfma_f32_16x16x32_bf16 a[48:51], a[208:211], v[196:199], a[48:51]
ds_read_b128 a[252:255], v2 offset:15360
v_cvt_pk_bf16_f32 v222, v188, v189
v_mfma_f32_16x16x32_bf16 a[80:83], a[208:211], v[200:203], a[80:83]
v_exp_f32 v190, v190
v_mfma_f32_16x16x32_bf16 a[112:115], a[208:211], v[204:207], a[112:115]
v_exp_f32 v191, v191
v_mfma_f32_16x16x32_bf16 a[116:119], a[212:215], v[204:207], a[116:119]
v_cvt_pk_bf16_f32 v223, v190, v191
v_add_u32 v2, s82, v1
v_mfma_f32_16x16x32_bf16 a[84:87], a[212:215], v[200:203], a[84:87]
v_mfma_f32_16x16x32_bf16 a[52:55], a[212:215], v[196:199], a[52:55]
v_mfma_f32_16x16x32_bf16 a[20:23], a[212:215], v[192:195], a[20:23]
v_mfma_f32_16x16x32_bf16 a[24:27], a[216:219], v[192:195], a[24:27]
v_mfma_f32_16x16x32_bf16 a[56:59], a[216:219], v[196:199], a[56:59]
v_mfma_f32_16x16x32_bf16 a[88:91], a[216:219], v[200:203], a[88:91]
v_mfma_f32_16x16x32_bf16 a[120:123], a[216:219], v[204:207], a[120:123]
v_mfma_f32_16x16x32_bf16 a[124:127], a[220:223], v[204:207], a[124:127]
v_mfma_f32_16x16x32_bf16 a[92:95], a[220:223], v[200:203], a[92:95]
v_mfma_f32_16x16x32_bf16 a[60:63], a[220:223], v[196:199], a[60:63]
v_mfma_f32_16x16x32_bf16 a[28:31], a[220:223], v[192:195], a[28:31]
v_mfma_f32_16x16x32_bf16 v[224:227], v[120:123], v[192:195], v[224:227]
v_mfma_f32_16x16x32_bf16 v[228:231], v[120:123], v[196:199], v[228:231]
s_waitcnt vmcnt(8) lgkmcnt(8)
v_mfma_f32_16x16x32_bf16 v[232:235], v[120:123], v[200:203], v[232:235]
s_barrier
v_mfma_f32_16x16x32_bf16 v[236:239], v[120:123], v[204:207], v[236:239]
s_add_u32 s83, s83, 1
s_cbranch_scc0 LloopI
LLT1:
v_mfma_f32_16x16x32_bf16 v[160:163], a[160:163], v[16:19], v[80:83]
s_xor_b32 s74, s82, 0x10000
v_exp_f32 v128, v128
v_mfma_f32_16x16x32_bf16 v[164:167], a[160:163], v[32:35], v[84:87]
s_add_u32 s74, s74, s64
ds_read_b128 a[128:131], v2 offset:16384
v_mfma_f32_16x16x32_bf16 v[168:171], a[160:163], v[48:51], v[88:91]
s_add_u32 s81, s81, 0x8000
v_exp_f32 v129, v129
v_mfma_f32_16x16x32_bf16 v[172:175], a[160:163], v[64:67], v[92:95]
s_add_u32 m0, s74, 16384
v_exp_f32 v130, v130
v_mfma_f32_16x16x32_bf16 v[176:179], a[176:179], v[16:19], v[80:83]
s_add_u32 s72, s81, 16384
ds_read_b128 a[144:147], v2 offset:20480
v_cvt_pk_bf16_f32 v192, v128, v129
v_mfma_f32_16x16x32_bf16 v[180:183], a[176:179], v[32:35], v[84:87]
v_exp_f32 v131, v131
v_mfma_f32_16x16x32_bf16 v[184:187], a[176:179], v[48:51], v[88:91]
v_exp_f32 v144, v144
v_mfma_f32_16x16x32_bf16 v[188:191], a[176:179], v[64:67], v[92:95]
ds_read_b128 a[132:135], v2 offset:17408
v_cvt_pk_bf16_f32 v193, v130, v131
v_mfma_f32_16x16x32_bf16 v[160:163], a[164:167], v[20:23], v[160:163]
buffer_load_dwordx4 v1, s[44:47], s72 offen sc1 lds
v_mfma_f32_16x16x32_bf16 v[164:167], a[164:167], v[36:39], v[164:167]
v_exp_f32 v145, v145
v_mfma_f32_16x16x32_bf16 v[168:171], a[164:167], v[52:55], v[168:171]
v_exp_f32 v146, v146
v_mfma_f32_16x16x32_bf16 v[172:175], a[164:167], v[68:71], v[172:175]
ds_read_b128 a[148:151], v2 offset:21504
v_cvt_pk_bf16_f32 v194, v144, v145
v_mfma_f32_16x16x32_bf16 v[188:191], a[180:183], v[68:71], v[188:191]
v_exp_f32 v147, v147
v_mfma_f32_16x16x32_bf16 v[184:187], a[180:183], v[52:55], v[184:187]
v_exp_f32 v132, v132
v_mfma_f32_16x16x32_bf16 v[180:183], a[180:183], v[36:39], v[180:183]
ds_read_b128 a[136:139], v2 offset:18432
v_cvt_pk_bf16_f32 v195, v146, v147
v_mfma_f32_16x16x32_bf16 v[176:179], a[180:183], v[20:23], v[176:179]
v_exp_f32 v133, v133
v_mfma_f32_16x16x32_bf16 v[172:175], a[168:171], v[72:75], v[172:175]
v_exp_f32 v134, v134
v_mfma_f32_16x16x32_bf16 v[168:171], a[168:171], v[56:59], v[168:171]
ds_read_b128 a[152:155], v2 offset:22528
v_cvt_pk_bf16_f32 v196, v132, v133
v_mfma_f32_16x16x32_bf16 v[164:167], a[168:171], v[40:43], v[164:167]
v_exp_f32 v135, v135
v_mfma_f32_16x16x32_bf16 v[160:163], a[168:171], v[24:27], v[160:163]
v_exp_f32 v148, v148
v_mfma_f32_16x16x32_bf16 v[176:179], a[184:187], v[24:27], v[176:179]
ds_read_b128 a[140:143], v2 offset:19456
v_cvt_pk_bf16_f32 v197, v134, v135
v_mfma_f32_16x16x32_bf16 v[180:183], a[184:187], v[40:43], v[180:183]
buffer_load_dwordx4 v1, s[44:47], s72 offen offset:1024 sc1 lds
v_mfma_f32_16x16x32_bf16 v[184:187], a[184:187], v[56:59], v[184:187]
v_exp_f32 v149, v149
v_mfma_f32_16x16x32_bf16 v[188:191], a[184:187], v[72:75], v[188:191]
v_exp_f32 v150, v150
v_mfma_f32_16x16x32_bf16 v[160:163], a[172:175], v[28:31], v[160:163]
ds_read_b128 a[156:159], v2 offset:23552
v_cvt_pk_bf16_f32 v198, v148, v149
v_mfma_f32_16x16x32_bf16 v[164:167], a[172:175], v[44:47], v[164:167]
v_exp_f32 v151, v151
v_mfma_f32_16x16x32_bf16 v[168:171], a[172:175], v[60:63], v[168:171]
v_exp_f32 v136, v136
v_mfma_f32_16x16x32_bf16 v[172:175], a[172:175], v[76:79], v[172:175]
ds_read_b128 a[192:195], v2 offset:0
v_cvt_pk_bf16_f32 v199, v150, v151
v_mfma_f32_16x16x32_bf16 v[188:191], a[188:191], v[76:79], v[188:191]
v_exp_f32 v137, v137
v_mfma_f32_16x16x32_bf16 v[184:187], a[188:191], v[60:63], v[184:187]
v_exp_f32 v138, v138
v_mfma_f32_16x16x32_bf16 v[180:183], a[188:191], v[44:47], v[180:183]
ds_read_b128 a[196:199], v2 offset:1024
v_cvt_pk_bf16_f32 v200, v136, v137
v_mfma_f32_16x16x32_bf16 v[176:179], a[188:191], v[28:31], v[176:179]
s_waitcnt lgkmcnt(10)
v_exp_f32 v139, v139
v_mfma_f32_16x16x32_bf16 a[0:3], a[224:227], v[208:211], a[0:3]
v_exp_f32 v152, v152
v_mfma_f32_16x16x32_bf16 a[32:35], a[224:227], v[212:215], a[32:35]
ds_read_b128 a[200:203], v2 offset:2048
v_cvt_pk_bf16_f32 v201, v138, v139
v_mfma_f32_16x16x32_bf16 a[64:67], a[224:227], v[216:219], a[64:67]
buffer_load_dwordx4 v1, s[44:47], s72 offen offset:2048 sc1 lds
v_mfma_f32_16x16x32_bf16 a[96:99], a[224:227], v[220:223], a[96:99]
v_exp_f32 v153, v153
v_mfma_f32_16x16x32_bf16 a[100:103], a[228:231], v[220:223], a[100:103]
v_exp_f32 v154, v154
v_mfma_f32_16x16x32_bf16 a[68:71], a[228:231], v[216:219], a[68:71]
ds_read_b128 a[204:207], v2 offset:3072
v_cvt_pk_bf16_f32 v202, v152, v153
v_mfma_f32_16x16x32_bf16 a[36:39], a[228:231], v[212:215], a[36:39]
v_exp_f32 v155, v155
v_mfma_f32_16x16x32_bf16 a[4:7], a[228:231], v[208:211], a[4:7]
v_exp_f32 v140, v140
v_mfma_f32_16x16x32_bf16 a[8:11], a[232:235], v[208:211], a[8:11]
ds_read_b128 a[208:211], v2 offset:4096
v_cvt_pk_bf16_f32 v203, v154, v155
v_mfma_f32_16x16x32_bf16 a[40:43], a[232:235], v[212:215], a[40:43]
v_exp_f32 v141, v141
v_mfma_f32_16x16x32_bf16 a[72:75], a[232:235], v[216:219], a[72:75]
v_exp_f32 v142, v142
v_mfma_f32_16x16x32_bf16 a[104:107], a[232:235], v[220:223], a[104:107]
ds_read_b128 a[212:215], v2 offset:5120
v_cvt_pk_bf16_f32 v204, v140, v141
v_mfma_f32_16x16x32_bf16 a[108:111], a[236:239], v[220:223], a[108:111]
v_exp_f32 v143, v143
v_mfma_f32_16x16x32_bf16 a[76:79], a[236:239], v[216:219], a[76:79]
v_exp_f32 v156, v156
v_mfma_f32_16x16x32_bf16 a[44:47], a[236:239], v[212:215], a[44:47]
ds_read_b128 a[216:219], v2 offset:6144
v_cvt_pk_bf16_f32 v205, v142, v143
v_mfma_f32_16x16x32_bf16 a[12:15], a[236:239], v[208:211], a[12:15]
buffer_load_dwordx4 v1, s[44:47], s72 offen offset:3072 sc1 lds
v_mfma_f32_16x16x32_bf16 a[16:19], a[240:243], v[208:211], a[16:19]
v_exp_f32 v157, v157
v_mfma_f32_16x16x32_bf16 a[48:51], a[240:243], v[212:215], a[48:51]
v_exp_f32 v158, v158
v_mfma_f32_16x16x32_bf16 a[80:83], a[240:243], v[216:219], a[80:83]
ds_read_b128 a[220:223], v2 offset:7168
v_cvt_pk_bf16_f32 v206, v156, v157
v_mfma_f32_16x16x32_bf16 a[112:115], a[240:243], v[220:223], a[112:115]
v_exp_f32 v159, v159
v_mfma_f32_16x16x32_bf16 a[116:119], a[244:247], v[220:223], a[116:119]
v_cvt_pk_bf16_f32 v207, v158, v159
v_mfma_f32_16x16x32_bf16 a[84:87], a[244:247], v[216:219], a[84:87]
v_mfma_f32_16x16x32_bf16 a[52:55], a[244:247], v[212:215], a[52:55]
v_mfma_f32_16x16x32_bf16 a[20:23], a[244:247], v[208:211], a[20:23]
v_mfma_f32_16x16x32_bf16 a[24:27], a[248:251], v[208:211], a[24:27]
v_mfma_f32_16x16x32_bf16 a[56:59], a[248:251], v[212:215], a[56:59]
v_mfma_f32_16x16x32_bf16 a[88:91], a[248:251], v[216:219], a[88:91]
v_mfma_f32_16x16x32_bf16 a[120:123], a[248:251], v[220:223], a[120:123]
v_mfma_f32_16x16x32_bf16 a[124:127], a[252:255], v[220:223], a[124:127]
v_mfma_f32_16x16x32_bf16 a[92:95], a[252:255], v[216:219], a[92:95]
v_mfma_f32_16x16x32_bf16 a[60:63], a[252:255], v[212:215], a[60:63]
v_mfma_f32_16x16x32_bf16 a[28:31], a[252:255], v[208:211], a[28:31]
v_mfma_f32_16x16x32_bf16 v[224:227], v[120:123], v[208:211], v[224:227]
v_mfma_f32_16x16x32_bf16 v[228:231], v[120:123], v[212:215], v[228:231]
v_mfma_f32_16x16x32_bf16 v[232:235], v[120:123], v[216:219], v[232:235]
v_mfma_f32_16x16x32_bf16 v[236:239], v[120:123], v[220:223], v[236:239]
s_waitcnt lgkmcnt(8)
s_cmp_le_u32 s58, 0
s_cbranch_scc1 Lalt15
v_mfma_f32_16x16x32_bf16 v[128:131], a[128:131], v[16:19], v[80:83]
s_add_u32 s82, s82, 0x8000
ds_read_b128 a[160:163], v2 offset:24576
v_mfma_f32_16x16x32_bf16 v[132:135], a[128:131], v[32:35], v[84:87]
s_and_b32 s82, s82, 0x1ffff
v_exp_f32 v160, v160
v_mfma_f32_16x16x32_bf16 v[144:147], a[144:147], v[16:19], v[80:83]
s_add_u32 m0, s74, 0
v_exp_f32 v161, v161
v_mfma_f32_16x16x32_bf16 v[148:151], a[144:147], v[32:35], v[84:87]
s_add_u32 s72, s81, 0
ds_read_b128 a[176:179], v2 offset:28672
v_cvt_pk_bf16_f32 v208, v160, v161
Ljoin17:
v_mfma_f32_16x16x32_bf16 v[136:139], a[128:131], v[48:51], v[88:91]
v_exp_f32 v162, v162
v_mfma_f32_16x16x32_bf16 v[140:143], a[128:131], v[64:67], v[92:95]
v_exp_f32 v163, v163
v_mfma_f32_16x16x32_bf16 v[152:155], a[144:147], v[48:51], v[88:91]
ds_read_b128 a[164:167], v2 offset:25600
v_cvt_pk_bf16_f32 v209, v162, v163
v_mfma_f32_16x16x32_bf16 v[156:159], a[144:147], v[64:67], v[92:95]
v_exp_f32 v176, v176
v_mfma_f32_16x16x32_bf16 v[128:131], a[132:135], v[20:23], v[128:131]
buffer_load_dwordx4 v1, s[44:47], s72 offen sc1 lds
v_mfma_f32_16x16x32_bf16 v[132:135], a[132:135], v[36:39], v[132:135]
v_exp_f32 v177, v177
v_mfma_f32_16x16x32_bf16 v[136:139], a[132:135], v[52:55], v[136:139]
ds_read_b128 a[180:183], v2 offset:29696
v_cvt_pk_bf16_f32 v210, v176, v177
v_mfma_f32_16x16x32_bf16 v[140:143], a[132:135], v[68:71], v[140:143]
v_exp_f32 v178, v178
v_mfma_f32_16x16x32_bf16 v[156:159], a[148:151], v[68:71], v[156:159]
v_exp_f32 v179, v179
v_mfma_f32_16x16x32_bf16 v[152:155], a[148:151], v[52:55], v[152:155]
ds_read_b128 a[168:171], v2 offset:26624
v_cvt_pk_bf16_f32 v211, v178, v179
v_mfma_f32_16x16x32_bf16 v[148:151], a[148:151], v[36:39], v[148:151]
v_exp_f32 v164, v164
v_mfma_f32_16x16x32_bf16 v[144:147], a[148:151], v[20:23], v[144:147]
v_exp_f32 v165, v165
v_mfma_f32_16x16x32_bf16 v[140:143], a[136:139], v[72:75], v[140:143]
ds_read_b128 a[184:187], v2 offset:30720
v_cvt_pk_bf16_f32 v212, v164, v165
v_mfma_f32_16x16x32_bf16 v[136:139], a[136:139], v[56:59], v[136:139]
v_exp_f32 v166, v166
v_mfma_f32_16x16x32_bf16 v[132:135], a[136:139], v[40:43], v[132:135]
v_exp_f32 v167, v167
v_mfma_f32_16x16x32_bf16 v[128:131], a[136:139], v[24:27], v[128:131]
ds_read_b128 a[172:175], v2 offset:27648
v_cvt_pk_bf16_f32 v213, v166, v167
v_mfma_f32_16x16x32_bf16 v[144:147], a[152:155], v[24:27], v[144:147]
v_exp_f32 v180, v180
v_mfma_f32_16x16x32_bf16 v[148:151], a[152:155], v[40:43], v[148:151]
buffer_load_dwordx4 v1, s[44:47], s72 offen offset:1024 sc1 lds
v_mfma_f32_16x16x32_bf16 v[152:155], a[152:155], v[56:59], v[152:155]
v_exp_f32 v181, v181
v_mfma_f32_16x16x32_bf16 v[156:159], a[152:155], v[72:75], v[156:159]
ds_read_b128 a[188:191], v2 offset:31744
v_cvt_pk_bf16_f32 v214, v180, v181
v_mfma_f32_16x16x32_bf16 v[128:131], a[140:143], v[28:31], v[128:131]
v_exp_f32 v182, v182
v_mfma_f32_16x16x32_bf16 v[132:135], a[140:143], v[44:47], v[132:135]
v_exp_f32 v183, v183
v_mfma_f32_16x16x32_bf16 v[136:139], a[140:143], v[60:63], v[136:139]
ds_read_b128 a[224:227], v2 offset:8192
v_cvt_pk_bf16_f32 v215, v182, v183
v_mfma_f32_16x16x32_bf16 v[140:143], a[140:143], v[76:79], v[140:143]
v_exp_f32 v168, v168
v_mfma_f32_16x16x32_bf16 v[156:159], a[156:159], v[76:79], v[156:159]
v_exp_f32 v169, v169
v_mfma_f32_16x16x32_bf16 v[152:155], a[156:159], v[60:63], v[152:155]
ds_read_b128 a[228:231], v2 offset:9216
v_cvt_pk_bf16_f32 v216, v168, v169
v_mfma_f32_16x16x32_bf16 v[148:151], a[156:159], v[44:47], v[148:151]
v_exp_f32 v170, v170
v_mfma_f32_16x16x32_bf16 v[144:147], a[156:159], v[28:31], v[144:147]
s_waitcnt lgkmcnt(10)
v_exp_f32 v171, v171
v_mfma_f32_16x16x32_bf16 a[0:3], a[192:195], v[192:195], a[0:3]
ds_read_b128 a[232:235], v2 offset:10240
v_cvt_pk_bf16_f32 v217, v170, v171
v_mfma_f32_16x16x32_bf16 a[32:35], a[192:195], v[196:199], a[32:35]
v_exp_f32 v184, v184
v_mfma_f32_16x16x32_bf16 a[64:67], a[192:195], v[200:203], a[64:67]
buffer_load_dwordx4 v1, s[44:47], s72 offen offset:2048 sc1 lds
v_mfma_f32_16x16x32_bf16 a[96:99], a[192:195], v[204:207], a[96:99]
v_exp_f32 v185, v185
v_mfma_f32_16x16x32_bf16 a[100:103], a[196:199], v[204:207], a[100:103]
ds_read_b128 a[236:239], v2 offset:11264
v_cvt_pk_bf16_f32 v218, v184, v185
v_mfma_f32_16x16x32_bf16 a[68:71], a[196:199], v[200:203], a[68:71]
v_exp_f32 v186, v186
v_mfma_f32_16x16x32_bf16 a[36:39], a[196:199], v[196:199], a[36:39]
v_exp_f32 v187, v187
v_mfma_f32_16x16x32_bf16 a[4:7], a[196:199], v[192:195], a[4:7]
ds_read_b128 a[240:243], v2 offset:12288
v_cvt_pk_bf16_f32 v219, v186, v187
v_mfma_f32_16x16x32_bf16 a[8:11], a[200:203], v[192:195], a[8:11]
v_exp_f32 v172, v172
v_mfma_f32_16x16x32_bf16 a[40:43], a[200:203], v[196:199], a[40:43]
v_exp_f32 v173, v173
v_mfma_f32_16x16x32_bf16 a[72:75], a[200:203], v[200:203], a[72:75]
ds_read_b128 a[244:247], v2 offset:13312
v_cvt_pk_bf16_f32 v220, v172, v173
v_mfma_f32_16x16x32_bf16 a[104:107], a[200:203], v[204:207], a[104:107]
v_exp_f32 v174, v174
v_mfma_f32_16x16x32_bf16 a[108:111], a[204:207], v[204:207], a[108:111]
v_exp_f32 v175, v175
v_mfma_f32_16x16x32_bf16 a[76:79], a[204:207], v[200:203], a[76:79]
ds_read_b128 a[248:251], v2 offset:14336
v_cvt_pk_bf16_f32 v221, v174, v175
v_mfma_f32_16x16x32_bf16 a[44:47], a[204:207], v[196:199], a[44:47]
v_exp_f32 v188, v188
v_mfma_f32_16x16x32_bf16 a[12:15], a[204:207], v[192:195], a[12:15]
buffer_load_dwordx4 v1, s[44:47], s72 offen offset:3072 sc1 lds
v_mfma_f32_16x16x32_bf16 a[16:19], a[208:211], v[192:195], a[16:19]
v_exp_f32 v189, v189
v_mfma_f32_16x16x32_bf16 a[48:51], a[208:211], v[196:199], a[48:51]
ds_read_b128 a[252:255], v2 offset:15360
v_cvt_pk_bf16_f32 v222, v188, v189
v_mfma_f32_16x16x32_bf16 a[80:83], a[208:211], v[200:203], a[80:83]
v_exp_f32 v190, v190
v_mfma_f32_16x16x32_bf16 a[112:115], a[208:211], v[204:207], a[112:115]
v_exp_f32 v191, v191
v_mfma_f32_16x16x32_bf16 a[116:119], a[212:215], v[204:207], a[116:119]
v_cvt_pk_bf16_f32 v223, v190, v191
v_add_u32 v2, s82, v1
v_mfma_f32_16x16x32_bf16 a[84:87], a[212:215], v[200:203], a[84:87]
v_mfma_f32_16x16x32_bf16 a[52:55], a[212:215], v[196:199], a[52:55]
v_mfma_f32_16x16x32_bf16 a[20:23], a[212:215], v[192:195], a[20:23]
v_mfma_f32_16x16x32_bf16 a[24:27], a[216:219], v[192:195], a[24:27]
v_mfma_f32_16x16x32_bf16 a[56:59], a[216:219], v[196:199], a[56:59]
v_mfma_f32_16x16x32_bf16 a[88:91], a[216:219], v[200:203], a[88:91]
v_mfma_f32_16x16x32_bf16 a[120:123], a[216:219], v[204:207], a[120:123]
v_mfma_f32_16x16x32_bf16 a[124:127], a[220:223], v[204:207], a[124:127]
v_mfma_f32_16x16x32_bf16 a[92:95], a[220:223], v[200:203], a[92:95]
v_mfma_f32_16x16x32_bf16 a[60:63], a[220:223], v[196:199], a[60:63]
v_mfma_f32_16x16x32_bf16 a[28:31], a[220:223], v[192:195], a[28:31]
v_mfma_f32_16x16x32_bf16 v[224:227], v[120:123], v[192:195], v[224:227]
v_mfma_f32_16x16x32_bf16 v[228:231], v[120:123], v[196:199], v[228:231]
v_mfma_f32_16x16x32_bf16 v[232:235], v[120:123], v[200:203], v[232:235]
s_waitcnt vmcnt(8) lgkmcnt(8)
v_mfma_f32_16x16x32_bf16 v[236:239], v[120:123], v[204:207], v[236:239]
s_barrier
s_cmp_le_u32 s58, 1
s_cbranch_scc1 Lalt18
v_mfma_f32_16x16x32_bf16 v[160:163], a[160:163], v[16:19], v[80:83]
s_xor_b32 s74, s82, 0x10000
v_exp_f32 v128, v128
v_mfma_f32_16x16x32_bf16 v[164:167], a[160:163], v[32:35], v[84:87]
s_add_u32 s74, s74, s64
ds_read_b128 a[128:131], v2 offset:16384
v_mfma_f32_16x16x32_bf16 v[176:179], a[176:179], v[16:19], v[80:83]
s_add_u32 s81, s81, 0x8000
v_exp_f32 v129, v129
v_mfma_f32_16x16x32_bf16 v[180:183], a[176:179], v[32:35], v[84:87]
s_add_u32 m0, s74, 16384
v_exp_f32 v130, v130
Ljoin20:
v_mfma_f32_16x16x32_bf16 v[168:171], a[160:163], v[48:51], v[88:91]
s_add_u32 s72, s81, 16384
ds_read_b128 a[144:147], v2 offset:20480
v_cvt_pk_bf16_f32 v192, v128, v129
v_mfma_f32_16x16x32_bf16 v[172:175], a[160:163], v[64:67], v[92:95]
v_exp_f32 v131, v131
v_mfma_f32_16x16x32_bf16 v[184:187], a[176:179], v[48:51], v[88:91]
v_exp_f32 v144, v144
v_mfma_f32_16x16x32_bf16 v[188:191], a[176:179], v[64:67], v[92:95]
ds_read_b128 a[132:135], v2 offset:17408
v_cvt_pk_bf16_f32 v193, v130, v131
v_mfma_f32_16x16x32_bf16 v[160:163], a[164:167], v[20:23], v[160:163]
buffer_load_dwordx4 v1, s[44:47], s72 offen sc1 lds
v_mfma_f32_16x16x32_bf16 v[164:167], a[164:167], v[36:39], v[164:167]
v_exp_f32 v145, v145
v_mfma_f32_16x16x32_bf16 v[168:171], a[164:167], v[52:55], v[168:171]
v_exp_f32 v146, v146
v_mfma_f32_16x16x32_bf16 v[172:175], a[164:167], v[68:71], v[172:175]
ds_read_b128 a[148:151], v2 offset:21504
v_cvt_pk_bf16_f32 v194, v144, v145
v_mfma_f32_16x16x32_bf16 v[188:191], a[180:183], v[68:71], v[188:191]
v_exp_f32 v147, v147
v_mfma_f32_16x16x32_bf16 v[184:187], a[180:183], v[52:55], v[184:187]
v_exp_f32 v132, v132
v_mfma_f32_16x16x32_bf16 v[180:183], a[180:183], v[36:39], v[180:183]
ds_read_b128 a[136:139], v2 offset:18432
v_cvt_pk_bf16_f32 v195, v146, v147
v_mfma_f32_16x16x32_bf16 v[176:179], a[180:183], v[20:23], v[176:179]
v_exp_f32 v133, v133
v_mfma_f32_16x16x32_bf16 v[172:175], a[168:171], v[72:75], v[172:175]
v_exp_f32 v134, v134
v_mfma_f32_16x16x32_bf16 v[168:171], a[168:171], v[56:59], v[168:171]
ds_read_b128 a[152:155], v2 offset:22528
v_cvt_pk_bf16_f32 v196, v132, v133
v_mfma_f32_16x16x32_bf16 v[164:167], a[168:171], v[40:43], v[164:167]
v_exp_f32 v135, v135
v_mfma_f32_16x16x32_bf16 v[160:163], a[168:171], v[24:27], v[160:163]
v_exp_f32 v148, v148
v_mfma_f32_16x16x32_bf16 v[176:179], a[184:187], v[24:27], v[176:179]
ds_read_b128 a[140:143], v2 offset:19456
v_cvt_pk_bf16_f32 v197, v134, v135
v_mfma_f32_16x16x32_bf16 v[180:183], a[184:187], v[40:43], v[180:183]
buffer_load_dwordx4 v1, s[44:47], s72 offen offset:1024 sc1 lds
v_mfma_f32_16x16x32_bf16 v[184:187], a[184:187], v[56:59], v[184:187]
v_exp_f32 v149, v149
v_mfma_f32_16x16x32_bf16 v[188:191], a[184:187], v[72:75], v[188:191]
v_exp_f32 v150, v150
v_mfma_f32_16x16x32_bf16 v[160:163], a[172:175], v[28:31], v[160:163]
ds_read_b128 a[156:159], v2 offset:23552
v_cvt_pk_bf16_f32 v198, v148, v149
v_mfma_f32_16x16x32_bf16 v[164:167], a[172:175], v[44:47], v[164:167]
v_exp_f32 v151, v151
v_mfma_f32_16x16x32_bf16 v[168:171], a[172:175], v[60:63], v[168:171]
v_exp_f32 v136, v136
v_mfma_f32_16x16x32_bf16 v[172:175], a[172:175], v[76:79], v[172:175]
ds_read_b128 a[192:195], v2 offset:0
v_cvt_pk_bf16_f32 v199, v150, v151
v_mfma_f32_16x16x32_bf16 v[188:191], a[188:191], v[76:79], v[188:191]
v_exp_f32 v137, v137
v_mfma_f32_16x16x32_bf16 v[184:187], a[188:191], v[60:63], v[184:187]
v_exp_f32 v138, v138
v_mfma_f32_16x16x32_bf16 v[180:183], a[188:191], v[44:47], v[180:183]
ds_read_b128 a[196:199], v2 offset:1024
v_cvt_pk_bf16_f32 v200, v136, v137
v_mfma_f32_16x16x32_bf16 v[176:179], a[188:191], v[28:31], v[176:179]
s_waitcnt lgkmcnt(10)
v_exp_f32 v139, v139
v_mfma_f32_16x16x32_bf16 a[0:3], a[224:227], v[208:211], a[0:3]
v_exp_f32 v152, v152
v_mfma_f32_16x16x32_bf16 a[32:35], a[224:227], v[212:215], a[32:35]
ds_read_b128 a[200:203], v2 offset:2048
v_cvt_pk_bf16_f32 v201, v138, v139
v_mfma_f32_16x16x32_bf16 a[64:67], a[224:227], v[216:219], a[64:67]
buffer_load_dwordx4 v1, s[44:47], s72 offen offset:2048 sc1 lds
v_mfma_f32_16x16x32_bf16 a[96:99], a[224:227], v[220:223], a[96:99]
v_exp_f32 v153, v153
v_mfma_f32_16x16x32_bf16 a[100:103], a[228:231], v[220:223], a[100:103]
v_exp_f32 v154, v154
v_mfma_f32_16x16x32_bf16 a[68:71], a[228:231], v[216:219], a[68:71]
ds_read_b128 a[204:207], v2 offset:3072
v_cvt_pk_bf16_f32 v202, v152, v153
v_mfma_f32_16x16x32_bf16 a[36:39], a[228:231], v[212:215], a[36:39]
v_exp_f32 v155, v155
v_mfma_f32_16x16x32_bf16 a[4:7], a[228:231], v[208:211], a[4:7]
v_exp_f32 v140, v140
v_mfma_f32_16x16x32_bf16 a[8:11], a[232:235], v[208:211], a[8:11]
ds_read_b128 a[208:211], v2 offset:4096
v_cvt_pk_bf16_f32 v203, v154, v155
v_mfma_f32_16x16x32_bf16 a[40:43], a[232:235], v[212:215], a[40:43]
v_exp_f32 v141, v141
v_mfma_f32_16x16x32_bf16 a[72:75], a[232:235], v[216:219], a[72:75]
v_exp_f32 v142, v142
v_mfma_f32_16x16x32_bf16 a[104:107], a[232:235], v[220:223], a[104:107]
ds_read_b128 a[212:215], v2 offset:5120
v_cvt_pk_bf16_f32 v204, v140, v141
v_mfma_f32_16x16x32_bf16 a[108:111], a[236:239], v[220:223], a[108:111]
v_exp_f32 v143, v143
v_mfma_f32_16x16x32_bf16 a[76:79], a[236:239], v[216:219], a[76:79]
v_exp_f32 v156, v156
v_mfma_f32_16x16x32_bf16 a[44:47], a[236:239], v[212:215], a[44:47]
ds_read_b128 a[216:219], v2 offset:6144
v_cvt_pk_bf16_f32 v205, v142, v143
v_mfma_f32_16x16x32_bf16 a[12:15], a[236:239], v[208:211], a[12:15]
buffer_load_dwordx4 v1, s[44:47], s72 offen offset:3072 sc1 lds
v_mfma_f32_16x16x32_bf16 a[16:19], a[240:243], v[208:211], a[16:19]
v_exp_f32 v157, v157
v_mfma_f32_16x16x32_bf16 a[48:51], a[240:243], v[212:215], a[48:51]
v_exp_f32 v158, v158
v_mfma_f32_16x16x32_bf16 a[80:83], a[240:243], v[216:219], a[80:83]
ds_read_b128 a[220:223], v2 offset:7168
v_cvt_pk_bf16_f32 v206, v156, v157
v_mfma_f32_16x16x32_bf16 a[112:115], a[240:243], v[220:223], a[112:115]
v_exp_f32 v159, v159
v_mfma_f32_16x16x32_bf16 a[116:119], a[244:247], v[220:223], a[116:119]
v_cvt_pk_bf16_f32 v207, v158, v159
v_mfma_f32_16x16x32_bf16 a[84:87], a[244:247], v[216:219], a[84:87]
v_mfma_f32_16x16x32_bf16 a[52:55], a[244:247], v[212:215], a[52:55]
v_mfma_f32_16x16x32_bf16 a[20:23], a[244:247], v[208:211], a[20:23]
v_mfma_f32_16x16x32_bf16 a[24:27], a[248:251], v[208:211], a[24:27]
v_mfma_f32_16x16x32_bf16 a[56:59], a[248:251], v[212:215], a[56:59]
v_mfma_f32_16x16x32_bf16 a[88:91], a[248:251], v[216:219], a[88:91]
v_mfma_f32_16x16x32_bf16 a[120:123], a[248:251], v[220:223], a[120:123]
v_mfma_f32_16x16x32_bf16 a[124:127], a[252:255], v[220:223], a[124:127]
v_mfma_f32_16x16x32_bf16 a[92:95], a[252:255], v[216:219], a[92:95]
v_mfma_f32_16x16x32_bf16 a[60:63], a[252:255], v[212:215], a[60:63]
v_mfma_f32_16x16x32_bf16 a[28:31], a[252:255], v[208:211], a[28:31]
v_mfma_f32_16x16x32_bf16 v[224:227], v[120:123], v[208:211], v[224:227]
v_mfma_f32_16x16x32_bf16 v[228:231], v[120:123], v[212:215], v[228:231]
v_mfma_f32_16x16x32_bf16 v[232:235], v[120:123], v[216:219], v[232:235]
v_mfma_f32_16x16x32_bf16 v[236:239], v[120:123], v[220:223], v[236:239]
s_waitcnt lgkmcnt(8)
s_cmp_le_u32 s58, 2
s_cbranch_scc1 Lalt21
v_mfma_f32_16x16x32_bf16 v[128:131], a[128:131], v[16:19], v[80:83]
s_add_u32 s82, s82, 0x8000
ds_read_b128 a[160:163], v2 offset:24576
v_mfma_f32_16x16x32_bf16 v[132:135], a[128:131], v[32:35], v[84:87]
s_and_b32 s82, s82, 0x1ffff
v_exp_f32 v160, v160
v_mfma_f32_16x16x32_bf16 v[144:147], a[144:147], v[16:19], v[80:83]
s_add_u32 m0, s74, 0
v_exp_f32 v161, v161
v_mfma_f32_16x16x32_bf16 v[148:151], a[144:147], v[32:35], v[84:87]
s_add_u32 s72, s81, 0
ds_read_b128 a[176:179], v2 offset:28672
v_cvt_pk_bf16_f32 v208, v160, v161
Ljoin23:
v_mfma_f32_16x16x32_bf16 v[136:139], a[128:131], v[48:51], v[88:91]
v_exp_f32 v162, v162
v_mfma_f32_16x16x32_bf16 v[140:143], a[128:131], v[64:67], v[92:95]
v_exp_f32 v163, v163
v_mfma_f32_16x16x32_bf16 v[152:155], a[144:147], v[48:51], v[88:91]
ds_read_b128 a[164:167], v2 offset:25600
v_cvt_pk_bf16_f32 v209, v162, v163
v_mfma_f32_16x16x32_bf16 v[156:159], a[144:147], v[64:67], v[92:95]
v_exp_f32 v176, v176
v_mfma_f32_16x16x32_bf16 v[128:131], a[132:135], v[20:23], v[128:131]
buffer_load_dwordx4 v1, s[44:47], s72 offen sc1 lds
v_mfma_f32_16x16x32_bf16 v[132:135], a[132:135], v[36:39], v[132:135]
v_exp_f32 v177, v177
v_mfma_f32_16x16x32_bf16 v[136:139], a[132:135], v[52:55], v[136:139]
ds_read_b128 a[180:183], v2 offset:29696
v_cvt_pk_bf16_f32 v210, v176, v177
v_mfma_f32_16x16x32_bf16 v[140:143], a[132:135], v[68:71], v[140:143]
v_exp_f32 v178, v178
v_mfma_f32_16x16x32_bf16 v[156:159], a[148:151], v[68:71], v[156:159]
v_exp_f32 v179, v179
v_mfma_f32_16x16x32_bf16 v[152:155], a[148:151], v[52:55], v[152:155]
ds_read_b128 a[168:171], v2 offset:26624
v_cvt_pk_bf16_f32 v211, v178, v179
v_mfma_f32_16x16x32_bf16 v[148:151], a[148:151], v[36:39], v[148:151]
v_exp_f32 v164, v164
v_mfma_f32_16x16x32_bf16 v[144:147], a[148:151], v[20:23], v[144:147]
v_exp_f32 v165, v165
v_mfma_f32_16x16x32_bf16 v[140:143], a[136:139], v[72:75], v[140:143]
ds_read_b128 a[184:187], v2 offset:30720
v_cvt_pk_bf16_f32 v212, v164, v165
v_mfma_f32_16x16x32_bf16 v[136:139], a[136:139], v[56:59], v[136:139]
v_exp_f32 v166, v166
v_mfma_f32_16x16x32_bf16 v[132:135], a[136:139], v[40:43], v[132:135]
v_exp_f32 v167, v167
v_mfma_f32_16x16x32_bf16 v[128:131], a[136:139], v[24:27], v[128:131]
ds_read_b128 a[172:175], v2 offset:27648
v_cvt_pk_bf16_f32 v213, v166, v167
v_mfma_f32_16x16x32_bf16 v[144:147], a[152:155], v[24:27], v[144:147]
v_exp_f32 v180, v180
v_mfma_f32_16x16x32_bf16 v[148:151], a[152:155], v[40:43], v[148:151]
buffer_load_dwordx4 v1, s[44:47], s72 offen offset:1024 sc1 lds
v_mfma_f32_16x16x32_bf16 v[152:155], a[152:155], v[56:59], v[152:155]
v_exp_f32 v181, v181
v_mfma_f32_16x16x32_bf16 v[156:159], a[152:155], v[72:75], v[156:159]
ds_read_b128 a[188:191], v2 offset:31744
v_cvt_pk_bf16_f32 v214, v180, v181
v_mfma_f32_16x16x32_bf16 v[128:131], a[140:143], v[28:31], v[128:131]
v_exp_f32 v182, v182
v_mfma_f32_16x16x32_bf16 v[132:135], a[140:143], v[44:47], v[132:135]
v_exp_f32 v183, v183
v_mfma_f32_16x16x32_bf16 v[136:139], a[140:143], v[60:63], v[136:139]
ds_read_b128 a[224:227], v2 offset:8192
v_cvt_pk_bf16_f32 v215, v182, v183
v_mfma_f32_16x16x32_bf16 v[140:143], a[140:143], v[76:79], v[140:143]
v_exp_f32 v168, v168
v_mfma_f32_16x16x32_bf16 v[156:159], a[156:159], v[76:79], v[156:159]
v_exp_f32 v169, v169
v_mfma_f32_16x16x32_bf16 v[152:155], a[156:159], v[60:63], v[152:155]
ds_read_b128 a[228:231], v2 offset:9216
v_cvt_pk_bf16_f32 v216, v168, v169
v_mfma_f32_16x16x32_bf16 v[148:151], a[156:159], v[44:47], v[148:151]
v_exp_f32 v170, v170
v_mfma_f32_16x16x32_bf16 v[144:147], a[156:159], v[28:31], v[144:147]
s_waitcnt lgkmcnt(10)
v_exp_f32 v171, v171
v_mfma_f32_16x16x32_bf16 a[0:3], a[192:195], v[192:195], a[0:3]
ds_read_b128 a[232:235], v2 offset:10240
v_cvt_pk_bf16_f32 v217, v170, v171
v_mfma_f32_16x16x32_bf16 a[32:35], a[192:195], v[196:199], a[32:35]
v_exp_f32 v184, v184
v_mfma_f32_16x16x32_bf16 a[64:67], a[192:195], v[200:203], a[64:67]
buffer_load_dwordx4 v1, s[44:47], s72 offen offset:2048 sc1 lds
v_mfma_f32_16x16x32_bf16 a[96:99], a[192:195], v[204:207], a[96:99]
v_exp_f32 v185, v185
v_mfma_f32_16x16x32_bf16 a[100:103], a[196:199], v[204:207], a[100:103]
ds_read_b128 a[236:239], v2 offset:11264
v_cvt_pk_bf16_f32 v218, v184, v185
v_mfma_f32_16x16x32_bf16 a[68:71], a[196:199], v[200:203], a[68:71]
v_exp_f32 v186, v186
v_mfma_f32_16x16x32_bf16 a[36:39], a[196:199], v[196:199], a[36:39]
v_exp_f32 v187, v187
v_mfma_f32_16x16x32_bf16 a[4:7], a[196:199], v[192:195], a[4:7]
ds_read_b128 a[240:243], v2 offset:12288
v_cvt_pk_bf16_f32 v219, v186, v187
v_mfma_f32_16x16x32_bf16 a[8:11], a[200:203], v[192:195], a[8:11]
v_exp_f32 v172, v172
v_mfma_f32_16x16x32_bf16 a[40:43], a[200:203], v[196:199], a[40:43]
v_exp_f32 v173, v173
v_mfma_f32_16x16x32_bf16 a[72:75], a[200:203], v[200:203], a[72:75]
ds_read_b128 a[244:247], v2 offset:13312
v_cvt_pk_bf16_f32 v220, v172, v173
v_mfma_f32_16x16x32_bf16 a[104:107], a[200:203], v[204:207], a[104:107]
v_exp_f32 v174, v174
v_mfma_f32_16x16x32_bf16 a[108:111], a[204:207], v[204:207], a[108:111]
v_exp_f32 v175, v175
v_mfma_f32_16x16x32_bf16 a[76:79], a[204:207], v[200:203], a[76:79]
ds_read_b128 a[248:251], v2 offset:14336
v_cvt_pk_bf16_f32 v221, v174, v175
v_mfma_f32_16x16x32_bf16 a[44:47], a[204:207], v[196:199], a[44:47]
v_exp_f32 v188, v188
v_mfma_f32_16x16x32_bf16 a[12:15], a[204:207], v[192:195], a[12:15]
buffer_load_dwordx4 v1, s[44:47], s72 offen offset:3072 sc1 lds
v_mfma_f32_16x16x32_bf16 a[16:19], a[208:211], v[192:195], a[16:19]
v_exp_f32 v189, v189
v_mfma_f32_16x16x32_bf16 a[48:51], a[208:211], v[196:199], a[48:51]
ds_read_b128 a[252:255], v2 offset:15360
v_cvt_pk_bf16_f32 v222, v188, v189
v_mfma_f32_16x16x32_bf16 a[80:83], a[208:211], v[200:203], a[80:83]
v_exp_f32 v190, v190
v_mfma_f32_16x16x32_bf16 a[112:115], a[208:211], v[204:207], a[112:115]
v_exp_f32 v191, v191
v_mfma_f32_16x16x32_bf16 a[116:119], a[212:215], v[204:207], a[116:119]
v_cvt_pk_bf16_f32 v223, v190, v191
v_add_u32 v2, s82, v1
v_mfma_f32_16x16x32_bf16 a[84:87], a[212:215], v[200:203], a[84:87]
v_mfma_f32_16x16x32_bf16 a[52:55], a[212:215], v[196:199], a[52:55]
v_mfma_f32_16x16x32_bf16 a[20:23], a[212:215], v[192:195], a[20:23]
v_mfma_f32_16x16x32_bf16 a[24:27], a[216:219], v[192:195], a[24:27]
v_mfma_f32_16x16x32_bf16 a[56:59], a[216:219], v[196:199], a[56:59]
v_mfma_f32_16x16x32_bf16 a[88:91], a[216:219], v[200:203], a[88:91]
v_mfma_f32_16x16x32_bf16 a[120:123], a[216:219], v[204:207], a[120:123]
v_mfma_f32_16x16x32_bf16 a[124:127], a[220:223], v[204:207], a[124:127]
v_mfma_f32_16x16x32_bf16 a[92:95], a[220:223], v[200:203], a[92:95]
v_mfma_f32_16x16x32_bf16 a[60:63], a[220:223], v[196:199], a[60:63]
v_mfma_f32_16x16x32_bf16 a[28:31], a[220:223], v[192:195], a[28:31]
v_mfma_f32_16x16x32_bf16 v[224:227], v[120:123], v[192:195], v[224:227]
v_mfma_f32_16x16x32_bf16 v[228:231], v[120:123], v[196:199], v[228:231]
v_mfma_f32_16x16x32_bf16 v[232:235], v[120:123], v[200:203], v[232:235]
s_waitcnt vmcnt(8) lgkmcnt(8)
v_mfma_f32_16x16x32_bf16 v[236:239], v[120:123], v[204:207], v[236:239]
s_barrier
LLT3:
s_cmp_le_u32 s58, 3
s_cbranch_scc1 Lalt24
v_mfma_f32_16x16x32_bf16 v[160:163], a[160:163], v[16:19], v[80:83]
s_lshl_b32 s75, s93, 1
v_exp_f32 v128, v128
v_mfma_f32_16x16x32_bf16 v[164:167], a[160:163], v[32:35], v[84:87]
s_add_u32 s75, s75, 0x1000
ds_read_b128 a[128:131], v2 offset:16384
v_mfma_f32_16x16x32_bf16 v[176:179], a[176:179], v[16:19], v[80:83]
v_exp_f32 v129, v129
v_mfma_f32_16x16x32_bf16 v[180:183], a[176:179], v[32:35], v[84:87]
v_exp_f32 v130, v130
Ljoin26:
v_mfma_f32_16x16x32_bf16 v[168:171], a[160:163], v[48:51], v[88:91]
s_and_b32 s73, s58, 1
ds_read_b128 a[144:147], v2 offset:20480
v_cvt_pk_bf16_f32 v192, v128, v129
v_mfma_f32_16x16x32_bf16 v[172:175], a[160:163], v[64:67], v[92:95]
s_lshl_b32 s73, s73, 4
v_exp_f32 v131, v131
v_mfma_f32_16x16x32_bf16 v[184:187], a[176:179], v[48:51], v[88:91]
s_lshr_b32 s73, s90, s73
buffer_load_dword v4, v3, s[24:27], s75 offen
v_mfma_f32_16x16x32_bf16 v[188:191], a[176:179], v[64:67], v[92:95]
s_and_b32 s73, s73, 0xffff
v_exp_f32 v144, v144
v_mfma_f32_16x16x32_bf16 v[160:163], a[164:167], v[20:23], v[160:163]
ds_read_b128 a[132:135], v2 offset:17408
v_cvt_pk_bf16_f32 v193, v130, v131
v_mfma_f32_16x16x32_bf16 v[164:167], a[164:167], v[36:39], v[164:167]
v_exp_f32 v145, v145
v_mfma_f32_16x16x32_bf16 v[168:171], a[164:167], v[52:55], v[168:171]
v_exp_f32 v146, v146
v_mfma_f32_16x16x32_bf16 v[172:175], a[164:167], v[68:71], v[172:175]
ds_read_b128 a[148:151], v2 offset:21504
v_cvt_pk_bf16_f32 v194, v144, v145
v_mfma_f32_16x16x32_bf16 v[188:191], a[180:183], v[68:71], v[188:191]
v_exp_f32 v147, v147
v_mfma_f32_16x16x32_bf16 v[184:187], a[180:183], v[52:55], v[184:187]
v_exp_f32 v132, v132
v_mfma_f32_16x16x32_bf16 v[180:183], a[180:183], v[36:39], v[180:183]
ds_read_b128 a[136:139], v2 offset:18432
v_cvt_pk_bf16_f32 v195, v146, v147
v_mfma_f32_16x16x32_bf16 v[176:179], a[180:183], v[20:23], v[176:179]
buffer_load_dword v4, v3, s[36:39], s93 offen
v_mfma_f32_16x16x32_bf16 v[172:175], a[168:171], v[72:75], v[172:175]
s_xor_b32 s74, s82, 0x10000
v_exp_f32 v133, v133
v_mfma_f32_16x16x32_bf16 v[168:171], a[168:171], v[56:59], v[168:171]
s_add_u32 s74, s74, s64
v_exp_f32 v134, v134
v_mfma_f32_16x16x32_bf16 v[164:167], a[168:171], v[40:43], v[164:167]
s_add_u32 s81, s81, 0x8000
ds_read_b128 a[152:155], v2 offset:22528
v_cvt_pk_bf16_f32 v196, v132, v133
v_mfma_f32_16x16x32_bf16 v[160:163], a[168:171], v[24:27], v[160:163]
s_add_u32 m0, s74, 16384
v_exp_f32 v135, v135
v_mfma_f32_16x16x32_bf16 v[176:179], a[184:187], v[24:27], v[176:179]
s_add_u32 s72, s81, 16384
v_exp_f32 v148, v148
v_mfma_f32_16x16x32_bf16 v[180:183], a[184:187], v[40:43], v[180:183]
ds_read_b128 a[140:143], v2 offset:19456
v_cvt_pk_bf16_f32 v197, v134, v135
v_mfma_f32_16x16x32_bf16 v[184:187], a[184:187], v[56:59], v[184:187]
v_exp_f32 v149, v149
v_mfma_f32_16x16x32_bf16 v[188:191], a[184:187], v[72:75], v[188:191]
buffer_load_dwordx4 v1, s[44:47], s72 offen sc1 lds
v_mfma_f32_16x16x32_bf16 v[160:163], a[172:175], v[28:31], v[160:163]
v_exp_f32 v150, v150
v_mfma_f32_16x16x32_bf16 v[164:167], a[172:175], v[44:47], v[164:167]
ds_read_b128 a[156:159], v2 offset:23552
v_cvt_pk_bf16_f32 v198, v148, v149
v_mfma_f32_16x16x32_bf16 v[168:171], a[172:175], v[60:63], v[168:171]
v_exp_f32 v151, v151
v_mfma_f32_16x16x32_bf16 v[172:175], a[172:175], v[76:79], v[172:175]
v_exp_f32 v136, v136
v_mfma_f32_16x16x32_bf16 v[188:191], a[188:191], v[76:79], v[188:191]
ds_read_b128 a[192:195], v2 offset:0
v_cvt_pk_bf16_f32 v199, v150, v151
v_mfma_f32_16x16x32_bf16 v[184:187], a[188:191], v[60:63], v[184:187]
v_exp_f32 v137, v137
v_mfma_f32_16x16x32_bf16 v[180:183], a[188:191], v[44:47], v[180:183]
v_exp_f32 v138, v138
v_mfma_f32_16x16x32_bf16 v[176:179], a[188:191], v[28:31], v[176:179]
s_waitcnt lgkmcnt(9)
ds_read_b128 a[196:199], v2 offset:1024
v_cvt_pk_bf16_f32 v200, v136, v137
v_mfma_f32_16x16x32_bf16 a[0:3], a[224:227], v[208:211], a[0:3]
v_exp_f32 v139, v139
v_mfma_f32_16x16x32_bf16 a[32:35], a[224:227], v[212:215], a[32:35]
buffer_load_dwordx4 v1, s[44:47], s72 offen offset:1024 sc1 lds
v_mfma_f32_16x16x32_bf16 a[64:67], a[224:227], v[216:219], a[64:67]
v_exp_f32 v152, v152
v_mfma_f32_16x16x32_bf16 a[96:99], a[224:227], v[220:223], a[96:99]
ds_read_b128 a[200:203], v2 offset:2048
v_cvt_pk_bf16_f32 v201, v138, v139
v_mfma_f32_16x16x32_bf16 a[100:103], a[228:231], v[220:223], a[100:103]
v_exp_f32 v153, v153
v_mfma_f32_16x16x32_bf16 a[68:71], a[228:231], v[216:219], a[68:71]
v_exp_f32 v154, v154
v_mfma_f32_16x16x32_bf16 a[36:39], a[228:231], v[212:215], a[36:39]
ds_read_b128 a[204:207], v2 offset:3072
v_cvt_pk_bf16_f32 v202, v152, v153
v_mfma_f32_16x16x32_bf16 a[4:7], a[228:231], v[208:211], a[4:7]
v_exp_f32 v155, v155
v_mfma_f32_16x16x32_bf16 a[8:11], a[232:235], v[208:211], a[8:11]
v_exp_f32 v140, v140
v_mfma_f32_16x16x32_bf16 a[40:43], a[232:235], v[212:215], a[40:43]
ds_read_b128 a[208:211], v2 offset:4096
v_cvt_pk_bf16_f32 v203, v154, v155
v_mfma_f32_16x16x32_bf16 a[72:75], a[232:235], v[216:219], a[72:75]
buffer_load_dwordx4 v1, s[44:47], s72 offen offset:2048 sc1 lds
v_mfma_f32_16x16x32_bf16 a[104:107], a[232:235], v[220:223], a[104:107]
v_exp_f32 v141, v141
v_mfma_f32_16x16x32_bf16 a[108:111], a[236:239], v[220:223], a[108:111]
v_exp_f32 v142, v142
v_mfma_f32_16x16x32_bf16 a[76:79], a[236:239], v[216:219], a[76:79]
ds_read_b128 a[212:215], v2 offset:5120
v_cvt_pk_bf16_f32 v204, v140, v141
v_mfma_f32_16x16x32_bf16 a[44:47], a[236:239], v[212:215], a[44:47]
v_exp_f32 v143, v143
v_mfma_f32_16x16x32_bf16 a[12:15], a[236:239], v[208:211], a[12:15]
v_exp_f32 v156, v156
v_mfma_f32_16x16x32_bf16 a[16:19], a[240:243], v[208:211], a[16:19]
ds_read_b128 a[216:219], v2 offset:6144
v_cvt_pk_bf16_f32 v205, v142, v143
v_mfma_f32_16x16x32_bf16 a[48:51], a[240:243], v[212:215], a[48:51]
v_exp_f32 v157, v157
v_mfma_f32_16x16x32_bf16 a[80:83], a[240:243], v[216:219], a[80:83]
buffer_load_dwordx4 v1, s[44:47], s72 offen offset:3072 sc1 lds
v_mfma_f32_16x16x32_bf16 a[112:115], a[240:243], v[220:223], a[112:115]
v_exp_f32 v158, v158
v_mfma_f32_16x16x32_bf16 a[116:119], a[244:247], v[220:223], a[116:119]
ds_read_b128 a[220:223], v2 offset:7168
v_cvt_pk_bf16_f32 v206, v156, v157
v_mfma_f32_16x16x32_bf16 a[84:87], a[244:247], v[216:219], a[84:87]
v_exp_f32 v159, v159
v_mfma_f32_16x16x32_bf16 a[52:55], a[244:247], v[212:215], a[52:55]
v_cvt_pk_bf16_f32 v207, v158, v159
v_lshl_add_u32 v248, v241, 3, v240
v_mfma_f32_16x16x32_bf16 a[20:23], a[244:247], v[208:211], a[20:23]
v_sub_u32 v248, 15, v248
v_and_b32 v249, 1, v248
v_mfma_f32_16x16x32_bf16 a[24:27], a[248:251], v[208:211], a[24:27]
v_lshlrev_b32 v249, 4, v249
v_lshlrev_b32 v249, v249, s73
v_mfma_f32_16x16x32_bf16 a[56:59], a[248:251], v[212:215], a[56:59]
v_lshrrev_b32 v248, 1, v248
v_and_b32 v241, 3, v0
v_mfma_f32_16x16x32_bf16 a[88:91], a[248:251], v[216:219], a[88:91]
v_cmp_eq_u32 vcc, 0, v248
v_lshl_add_u32 v5, v241, 3, v5
v_mfma_f32_16x16x32_bf16 a[120:123], a[248:251], v[220:223], a[120:123]
v_cndmask_b32 v8, 0, v249, vcc
v_cmp_eq_u32 vcc, 1, v248
v_mfma_f32_16x16x32_bf16 a[124:127], a[252:255], v[220:223], a[124:127]
v_lshlrev_b32 v240, 4, v251
v_cndmask_b32 v9, 0, v249, vcc
v_mfma_f32_16x16x32_bf16 a[92:95], a[252:255], v[216:219], a[92:95]
v_cmp_eq_u32 vcc, 2, v248
v_sub_u32 v240, 48, v240
v_mfma_f32_16x16x32_bf16 a[60:63], a[252:255], v[212:215], a[60:63]
v_lshlrev_b64 v[12:13], 16, s[88:89]
v_cndmask_b32 v10, 0, v249, vcc
v_mfma_f32_16x16x32_bf16 a[28:31], a[252:255], v[208:211], a[28:31]
v_cmp_eq_u32 vcc, 3, v248
v_lshlrev_b64 v[12:13], v240, v[12:13]
v_mfma_f32_16x16x32_bf16 v[224:227], v[120:123], v[208:211], v[224:227]
v_cndmask_b32 v11, 0, v249, vcc
v_cmp_eq_u32 vcc, 3, v241
v_mfma_f32_16x16x32_bf16 v[228:231], v[120:123], v[212:215], v[228:231]
s_add_u32 s73, s62, 4096
v_lshl_add_u32 v14, v0, 3, s73
v_cndmask_b32 v12, 0, v12, vcc
v_mfma_f32_16x16x32_bf16 v[232:235], v[120:123], v[216:219], v[232:235]
v_cndmask_b32 v13, 0, v13, vcc
v_mfma_f32_16x16x32_bf16 v[236:239], v[120:123], v[220:223], v[236:239]
s_waitcnt lgkmcnt(8)
s_cmp_le_u32 s85, 0
s_cbranch_scc1 Lalt27
v_mfma_f32_16x16x32_bf16 v[136:139], a[128:131], v[48:51], v[88:91]
s_add_u32 s82, s82, 0x8000
ds_read_b128 a[160:163], v2 offset:24576
ds_read_b128 a[176:179], v2 offset:28672
v_mfma_f32_16x16x32_bf16 v[140:143], a[128:131], v[64:67], v[92:95]
s_and_b32 s82, s82, 0x1ffff
v_exp_f32 v160, v160
v_mfma_f32_16x16x32_bf16 v[152:155], a[144:147], v[48:51], v[88:91]
s_add_u32 m0, s74, 0
v_exp_f32 v161, v161
v_mfma_f32_16x16x32_bf16 v[156:159], a[144:147], v[64:67], v[92:95]
s_add_u32 s72, s81, 0
v_exp_f32 v162, v162
Ljoin29:
v_mfma_f32_16x16x32_bf16 v[136:139], a[132:135], v[52:55], v[136:139]
v_exp_f32 v163, v163
v_mfma_f32_16x16x32_bf16 v[140:143], a[132:135], v[68:71], v[140:143]
ds_read_b128 a[164:167], v2 offset:25600
v_cvt_pk_bf16_f32 v208, v160, v161
v_mfma_f32_16x16x32_bf16 v[156:159], a[148:151], v[68:71], v[156:159]
v_exp_f32 v176, v176
v_mfma_f32_16x16x32_bf16 v[152:155], a[148:151], v[52:55], v[152:155]
buffer_load_dwordx4 v1, s[44:47], s72 offen sc1 lds
v_mfma_f32_16x16x32_bf16 v[140:143], a[136:139], v[72:75], v[140:143]
v_exp_f32 v177, v177
v_mfma_f32_16x16x32_bf16 v[136:139], a[136:139], v[56:59], v[136:139]
ds_read_b128 a[180:183], v2 offset:29696
v_cvt_pk_bf16_f32 v209, v162, v163
v_mfma_f32_16x16x32_bf16 v[152:155], a[152:155], v[56:59], v[152:155]
v_exp_f32 v178, v178
v_mfma_f32_16x16x32_bf16 v[156:159], a[152:155], v[72:75], v[156:159]
v_exp_f32 v179, v179
v_mfma_f32_16x16x32_bf16 v[136:139], a[140:143], v[60:63], v[136:139]
ds_read_b128 a[168:171], v2 offset:26624
v_cvt_pk_bf16_f32 v210, v176, v177
v_mfma_f32_16x16x32_bf16 v[140:143], a[140:143], v[76:79], v[140:143]
v_exp_f32 v164, v164
v_mfma_f32_16x16x32_bf16 v[156:159], a[156:159], v[76:79], v[156:159]
v_exp_f32 v165, v165
v_mfma_f32_16x16x32_bf16 v[152:155], a[156:159], v[60:63], v[152:155]
s_waitcnt lgkmcnt(5)
ds_read_b128 a[184:187], v2 offset:30720
v_cvt_pk_bf16_f32 v211, v178, v179
v_mfma_f32_16x16x32_bf16 a[0:3], a[192:195], v[192:195], a[0:3]
v_exp_f32 v166, v166
v_mfma_f32_16x16x32_bf16 a[32:35], a[192:195], v[196:199], a[32:35]
v_exp_f32 v167, v167
v_mfma_f32_16x16x32_bf16 a[64:67], a[192:195], v[200:203], a[64:67]
ds_read_b128 a[172:175], v2 offset:27648
v_cvt_pk_bf16_f32 v212, v164, v165
v_mfma_f32_16x16x32_bf16 a[96:99], a[192:195], v[204:207], a[96:99]
v_exp_f32 v180, v180
v_mfma_f32_16x16x32_bf16 a[100:103], a[196:199], v[204:207], a[100:103]
buffer_load_dwordx4 v1, s[44:47], s72 offen offset:1024 sc1 lds
v_mfma_f32_16x16x32_bf16 a[68:71], a[196:199], v[200:203], a[68:71]
v_exp_f32 v181, v181
v_mfma_f32_16x16x32_bf16 a[36:39], a[196:199], v[196:199], a[36:39]
ds_read_b128 a[188:191], v2 offset:31744
v_cvt_pk_bf16_f32 v213, v166, v167
v_mfma_f32_16x16x32_bf16 a[4:7], a[196:199], v[192:195], a[4:7]
v_exp_f32 v182, v182
v_mfma_f32_16x16x32_bf16 a[8:11], a[200:203], v[192:195], a[8:11]
v_exp_f32 v183, v183
v_mfma_f32_16x16x32_bf16 a[40:43], a[200:203], v[196:199], a[40:43]
ds_read_b128 a[224:227], v2 offset:8192
v_cvt_pk_bf16_f32 v214, v180, v181
v_mfma_f32_16x16x32_bf16 a[72:75], a[200:203], v[200:203], a[72:75]
v_exp_f32 v168, v168
v_mfma_f32_16x16x32_bf16 a[104:107], a[200:203], v[204:207], a[104:107]
v_exp_f32 v169, v169
v_mfma_f32_16x16x32_bf16 a[108:111], a[204:207], v[204:207], a[108:111]
ds_read_b128 a[228:231], v2 offset:9216
v_cvt_pk_bf16_f32 v215, v182, v183
v_mfma_f32_16x16x32_bf16 a[76:79], a[204:207], v[200:203], a[76:79]
v_exp_f32 v170, v170
v_mfma_f32_16x16x32_bf16 a[44:47], a[204:207], v[196:199], a[44:47]
v_exp_f32 v171, v171
v_mfma_f32_16x16x32_bf16 a[12:15], a[204:207], v[192:195], a[12:15]
ds_read_b128 a[232:235], v2 offset:10240
v_cvt_pk_bf16_f32 v216, v168, v169
v_mfma_f32_16x16x32_bf16 a[16:19], a[208:211], v[192:195], a[16:19]
v_exp_f32 v184, v184
v_mfma_f32_16x16x32_bf16 a[48:51], a[208:211], v[196:199], a[48:51]
buffer_load_dwordx4 v1, s[44:47], s72 offen offset:2048 sc1 lds
v_mfma_f32_16x16x32_bf16 a[80:83], a[208:211], v[200:203], a[80:83]
v_exp_f32 v185, v185
v_mfma_f32_16x16x32_bf16 a[112:115], a[208:211], v[204:207], a[112:115]
ds_read_b128 a[236:239], v2 offset:11264
v_cvt_pk_bf16_f32 v217, v170, v171
v_mfma_f32_16x16x32_bf16 a[116:119], a[212:215], v[204:207], a[116:119]
v_exp_f32 v186, v186
v_mfma_f32_16x16x32_bf16 a[84:87], a[212:215], v[200:203], a[84:87]
v_exp_f32 v187, v187
v_mfma_f32_16x16x32_bf16 a[52:55], a[212:215], v[196:199], a[52:55]
ds_read_b128 a[240:243], v2 offset:12288
v_cvt_pk_bf16_f32 v218, v184, v185
v_mfma_f32_16x16x32_bf16 a[20:23], a[212:215], v[192:195], a[20:23]
v_exp_f32 v172, v172
v_mfma_f32_16x16x32_bf16 a[24:27], a[216:219], v[192:195], a[24:27]
v_exp_f32 v173, v173
v_mfma_f32_16x16x32_bf16 a[56:59], a[216:219], v[196:199], a[56:59]
ds_read_b128 a[244:247], v2 offset:13312
v_cvt_pk_bf16_f32 v219, v186, v187
v_mfma_f32_16x16x32_bf16 a[88:91], a[216:219], v[200:203], a[88:91]
v_exp_f32 v174, v174
v_mfma_f32_16x16x32_bf16 a[120:123], a[216:219], v[204:207], a[120:123]
v_exp_f32 v175, v175
v_mfma_f32_16x16x32_bf16 a[124:127], a[220:223], v[204:207], a[124:127]
ds_read_b128 a[248:251], v2 offset:14336
v_cvt_pk_bf16_f32 v220, v172, v173
v_mfma_f32_16x16x32_bf16 a[92:95], a[220:223], v[200:203], a[92:95]
v_exp_f32 v188, v188
v_mfma_f32_16x16x32_bf16 a[60:63], a[220:223], v[196:199], a[60:63]
buffer_load_dwordx4 v1, s[44:47], s72 offen offset:3072 sc1 lds
v_mfma_f32_16x16x32_bf16 a[28:31], a[220:223], v[192:195], a[28:31]
v_exp_f32 v189, v189
v_mfma_f32_16x16x32_bf16 v[224:227], v[120:123], v[192:195], v[224:227]
ds_read_b128 a[252:255], v2 offset:15360
v_cvt_pk_bf16_f32 v221, v174, v175
v_mfma_f32_16x16x32_bf16 v[228:231], v[120:123], v[196:199], v[228:231]
v_exp_f32 v190, v190
v_mfma_f32_16x16x32_bf16 v[232:235], v[120:123], v[200:203], v[232:235]
s_waitcnt vmcnt(10) lgkmcnt(0)
v_exp_f32 v191, v191
v_mfma_f32_16x16x32_bf16 v[236:239], v[120:123], v[204:207], v[236:239]
s_barrier
v_cvt_pk_bf16_f32 v222, v188, v189
v_cvt_pk_bf16_f32 v223, v190, v191
v_add_u32 v2, s82, v1
s_cmp_eq_u32 s60, 7
s_cbranch_scc1 LLT4x
v_mfma_f32_16x16x32_bf16 v[168:171], a[160:163], v[48:51], v[88:91]
s_xor_b32 s74, s82, 0x10000
v_exp_f32 v136, v136
v_mfma_f32_16x16x32_bf16 v[172:175], a[160:163], v[64:67], v[92:95]
s_add_u32 s74, s74, s64
ds_read_b128 a[128:131], v2 offset:16384
v_mfma_f32_16x16x32_bf16 v[184:187], a[176:179], v[48:51], v[88:91]
s_add_u32 s81, s81, 0x8000
v_exp_f32 v137, v137
v_mfma_f32_16x16x32_bf16 v[188:191], a[176:179], v[64:67], v[92:95]
s_add_u32 m0, s74, 16384
ds_read_b128 a[144:147], v2 offset:20480
v_cvt_pk_bf16_f32 v200, v136, v137
v_mfma_f32_16x16x32_bf16 v[168:171], a[164:167], v[52:55], v[168:171]
s_add_u32 s72, s81, 16384
v_exp_f32 v138, v138
v_mfma_f32_16x16x32_bf16 v[172:175], a[164:167], v[68:71], v[172:175]
ds_read_b128 a[132:135], v2 offset:17408
v_mfma_f32_16x16x32_bf16 v[188:191], a[180:183], v[68:71], v[188:191]
buffer_load_dwordx4 v1, s[44:47], s72 offen sc1 lds
v_mfma_f32_16x16x32_bf16 v[184:187], a[180:183], v[52:55], v[184:187]
v_exp_f32 v139, v139
v_mfma_f32_16x16x32_bf16 v[172:175], a[168:171], v[72:75], v[172:175]
ds_read_b128 a[148:151], v2 offset:21504
v_cvt_pk_bf16_f32 v201, v138, v139
v_mfma_f32_16x16x32_bf16 v[168:171], a[168:171], v[56:59], v[168:171]
v_exp_f32 v152, v152
v_mfma_f32_16x16x32_bf16 v[184:187], a[184:187], v[56:59], v[184:187]
ds_read_b128 a[136:139], v2 offset:18432
v_mfma_f32_16x16x32_bf16 v[188:191], a[184:187], v[72:75], v[188:191]
v_exp_f32 v153, v153
v_mfma_f32_16x16x32_bf16 v[168:171], a[172:175], v[60:63], v[168:171]
ds_read_b128 a[152:155], v2 offset:22528
v_cvt_pk_bf16_f32 v202, v152, v153
v_mfma_f32_16x16x32_bf16 v[172:175], a[172:175], v[76:79], v[172:175]
v_exp_f32 v154, v154
v_mfma_f32_16x16x32_bf16 v[188:191], a[188:191], v[76:79], v[188:191]
ds_read_b128 a[140:143], v2 offset:19456
v_mfma_f32_16x16x32_bf16 v[184:187], a[188:191], v[60:63], v[184:187]
s_waitcnt lgkmcnt(7)
buffer_load_dwordx4 v1, s[44:47], s72 offen offset:1024 sc1 lds
v_mfma_f32_16x16x32_bf16 a[0:3], a[224:227], v[208:211], a[0:3]
v_exp_f32 v155, v155
v_mfma_f32_16x16x32_bf16 a[32:35], a[224:227], v[212:215], a[32:35]
ds_read_b128 a[156:159], v2 offset:23552
v_cvt_pk_bf16_f32 v203, v154, v155
v_mfma_f32_16x16x32_bf16 a[64:67], a[224:227], v[216:219], a[64:67]
v_exp_f32 v140, v140
v_mfma_f32_16x16x32_bf16 a[96:99], a[224:227], v[220:223], a[96:99]
ds_read_b128 a[192:195], v2 offset:0
v_mfma_f32_16x16x32_bf16 a[100:103], a[228:231], v[220:223], a[100:103]
v_exp_f32 v141, v141
v_mfma_f32_16x16x32_bf16 a[68:71], a[228:231], v[216:219], a[68:71]
ds_read_b128 a[196:199], v2 offset:1024
v_cvt_pk_bf16_f32 v204, v140, v141
v_mfma_f32_16x16x32_bf16 a[36:39], a[228:231], v[212:215], a[36:39]
v_exp_f32 v142, v142
v_mfma_f32_16x16x32_bf16 a[4:7], a[228:231], v[208:211], a[4:7]
ds_read_b128 a[200:203], v2 offset:2048
v_mfma_f32_16x16x32_bf16 a[8:11], a[232:235], v[208:211], a[8:11]
buffer_load_dwordx4 v1, s[44:47], s72 offen offset:2048 sc1 lds
v_mfma_f32_16x16x32_bf16 a[40:43], a[232:235], v[212:215], a[40:43]
v_exp_f32 v143, v143
v_mfma_f32_16x16x32_bf16 a[72:75], a[232:235], v[216:219], a[72:75]
ds_read_b128 a[204:207], v2 offset:3072
v_cvt_pk_bf16_f32 v205, v142, v143
v_mfma_f32_16x16x32_bf16 a[104:107], a[232:235], v[220:223], a[104:107]
v_exp_f32 v156, v156
v_mfma_f32_16x16x32_bf16 a[108:111], a[236:239], v[220:223], a[108:111]
ds_read_b128 a[208:211], v2 offset:4096
v_mfma_f32_16x16x32_bf16 a[76:79], a[236:239], v[216:219], a[76:79]
v_exp_f32 v157, v157
v_mfma_f32_16x16x32_bf16 a[44:47], a[236:239], v[212:215], a[44:47]
ds_read_b128 a[212:215], v2 offset:5120
v_cvt_pk_bf16_f32 v206, v156, v157
v_mfma_f32_16x16x32_bf16 a[12:15], a[236:239], v[208:211], a[12:15]
v_exp_f32 v158, v158
v_mfma_f32_16x16x32_bf16 a[16:19], a[240:243], v[208:211], a[16:19]
ds_read_b128 a[216:219], v2 offset:6144
v_mfma_f32_16x16x32_bf16 a[48:51], a[240:243], v[212:215], a[48:51]
buffer_load_dwordx4 v1, s[44:47], s72 offen offset:3072 sc1 lds
v_mfma_f32_16x16x32_bf16 a[80:83], a[240:243], v[216:219], a[80:83]
v_exp_f32 v159, v159
v_mfma_f32_16x16x32_bf16 a[112:115], a[240:243], v[220:223], a[112:115]
ds_read_b128 a[220:223], v2 offset:7168
v_cvt_pk_bf16_f32 v207, v158, v159
v_mfma_f32_16x16x32_bf16 a[116:119], a[244:247], v[220:223], a[116:119]
v_mfma_f32_16x16x32_bf16 a[84:87], a[244:247], v[216:219], a[84:87]
v_mfma_f32_16x16x32_bf16 a[52:55], a[244:247], v[212:215], a[52:55]
v_mfma_f32_16x16x32_bf16 a[20:23], a[244:247], v[208:211], a[20:23]
v_mfma_f32_16x16x32_bf16 a[24:27], a[248:251], v[208:211], a[24:27]
v_mfma_f32_16x16x32_bf16 a[56:59], a[248:251], v[212:215], a[56:59]
v_mfma_f32_16x16x32_bf16 a[88:91], a[248:251], v[216:219], a[88:91]
v_mfma_f32_16x16x32_bf16 a[120:123], a[248:251], v[220:223], a[120:123]
v_mfma_f32_16x16x32_bf16 a[124:127], a[252:255], v[220:223], a[124:127]
v_mfma_f32_16x16x32_bf16 a[92:95], a[252:255], v[216:219], a[92:95]
v_mfma_f32_16x16x32_bf16 a[60:63], a[252:255], v[212:215], a[60:63]
v_mfma_f32_16x16x32_bf16 a[28:31], a[252:255], v[208:211], a[28:31]
v_mfma_f32_16x16x32_bf16 v[224:227], v[120:123], v[208:211], v[224:227]
v_mfma_f32_16x16x32_bf16 v[228:231], v[120:123], v[212:215], v[228:231]
v_mfma_f32_16x16x32_bf16 v[232:235], v[120:123], v[216:219], v[232:235]
v_mfma_f32_16x16x32_bf16 v[236:239], v[120:123], v[220:223], v[236:239]
s_waitcnt lgkmcnt(8)
s_nop 3
v_rcp_f32 v224, v224
v_rcp_f32 v228, v228
s_lshl_b32 s73, s59, 12
s_add_u32 s73, s73, 0x2000000
s_lshl_b32 s70, s67, 2
s_add_u32 s70, s70, s73
v_mov_b32 v225, v224
v_accvgpr_read_b32 v240, a0
v_accvgpr_read_b32 v241, a1
v_accvgpr_read_b32 v242, a2
v_accvgpr_read_b32 v243, a3
v_accvgpr_read_b32 v244, a4
v_accvgpr_read_b32 v245, a5
v_accvgpr_read_b32 v246, a6
v_accvgpr_read_b32 v247, a7
v_pk_mul_f32 v[240:241], v[240:241], v[224:225]
v_pk_mul_f32 v[242:243], v[242:243], v[224:225]
v_pk_mul_f32 v[244:245], v[244:245], v[224:225]
v_pk_mul_f32 v[246:247], v[246:247], v[224:225]
v_cvt_pk_bf16_f32 v128, v240, v241
v_cvt_pk_bf16_f32 v129, v242, v243
v_cvt_pk_bf16_f32 v130, v244, v245
v_cvt_pk_bf16_f32 v131, v246, v247
v_accvgpr_read_b32 v248, a8
v_accvgpr_read_b32 v249, a9
v_accvgpr_read_b32 v250, a10
v_accvgpr_read_b32 v251, a11
v_accvgpr_read_b32 v252, a12
v_accvgpr_read_b32 v253, a13
v_accvgpr_read_b32 v254, a14
v_accvgpr_read_b32 v255, a15
v_pk_mul_f32 v[248:249], v[248:249], v[224:225]
v_pk_mul_f32 v[250:251], v[250:251], v[224:225]
v_pk_mul_f32 v[252:253], v[252:253], v[224:225]
v_pk_mul_f32 v[254:255], v[254:255], v[224:225]
v_cvt_pk_bf16_f32 v144, v248, v249
v_cvt_pk_bf16_f32 v145, v250, v251
v_cvt_pk_bf16_f32 v146, v252, v253
v_cvt_pk_bf16_f32 v147, v254, v255
v_accvgpr_read_b32 v240, a16
v_accvgpr_read_b32 v241, a17
v_accvgpr_read_b32 v242, a18
v_accvgpr_read_b32 v243, a19
v_accvgpr_read_b32 v244, a20
v_accvgpr_read_b32 v245, a21
v_accvgpr_read_b32 v246, a22
v_accvgpr_read_b32 v247, a23
v_pk_mul_f32 v[240:241], v[240:241], v[224:225]
v_pk_mul_f32 v[242:243], v[242:243], v[224:225]
v_pk_mul_f32 v[244:245], v[244:245], v[224:225]
v_pk_mul_f32 v[246:247], v[246:247], v[224:225]
v_cvt_pk_bf16_f32 v160, v240, v241
v_cvt_pk_bf16_f32 v161, v242, v243
v_cvt_pk_bf16_f32 v162, v244, v245
v_cvt_pk_bf16_f32 v163, v246, v247
v_accvgpr_read_b32 v248, a24
v_accvgpr_read_b32 v249, a25
v_accvgpr_read_b32 v250, a26
v_accvgpr_read_b32 v251, a27
v_accvgpr_read_b32 v252, a28
v_accvgpr_read_b32 v253, a29
v_accvgpr_read_b32 v254, a30
v_accvgpr_read_b32 v255, a31
v_pk_mul_f32 v[248:249], v[248:249], v[224:225]
v_pk_mul_f32 v[250:251], v[250:251], v[224:225]
v_pk_mul_f32 v[252:253], v[252:253], v[224:225]
v_pk_mul_f32 v[254:255], v[254:255], v[224:225]
v_cvt_pk_bf16_f32 v176, v248, v249
v_cvt_pk_bf16_f32 v177, v250, v251
v_cvt_pk_bf16_f32 v178, v252, v253
v_cvt_pk_bf16_f32 v179, v254, v255
v_mov_b32 v229, v228
v_accvgpr_read_b32 v240, a32
v_accvgpr_read_b32 v241, a33
v_accvgpr_read_b32 v242, a34
v_accvgpr_read_b32 v243, a35
v_accvgpr_read_b32 v244, a36
v_accvgpr_read_b32 v245, a37
v_accvgpr_read_b32 v246, a38
v_accvgpr_read_b32 v247, a39
v_pk_mul_f32 v[240:241], v[240:241], v[228:229]
v_pk_mul_f32 v[242:243], v[242:243], v[228:229]
v_pk_mul_f32 v[244:245], v[244:245], v[228:229]
v_pk_mul_f32 v[246:247], v[246:247], v[228:229]
v_cvt_pk_bf16_f32 v132, v240, v241
v_cvt_pk_bf16_f32 v133, v242, v243
v_cvt_pk_bf16_f32 v134, v244, v245
v_cvt_pk_bf16_f32 v135, v246, v247
v_accvgpr_read_b32 v248, a40
v_accvgpr_read_b32 v249, a41
v_accvgpr_read_b32 v250, a42
v_accvgpr_read_b32 v251, a43
v_accvgpr_read_b32 v252, a44
v_accvgpr_read_b32 v253, a45
v_accvgpr_read_b32 v254, a46
v_accvgpr_read_b32 v255, a47
v_pk_mul_f32 v[248:249], v[248:249], v[228:229]
v_pk_mul_f32 v[250:251], v[250:251], v[228:229]
v_pk_mul_f32 v[252:253], v[252:253], v[228:229]
v_pk_mul_f32 v[254:255], v[254:255], v[228:229]
v_cvt_pk_bf16_f32 v148, v248, v249
v_cvt_pk_bf16_f32 v149, v250, v251
v_cvt_pk_bf16_f32 v150, v252, v253
v_cvt_pk_bf16_f32 v151, v254, v255
v_accvgpr_read_b32 v240, a48
v_accvgpr_read_b32 v241, a49
v_accvgpr_read_b32 v242, a50
v_accvgpr_read_b32 v243, a51
v_accvgpr_read_b32 v244, a52
v_accvgpr_read_b32 v245, a53
v_accvgpr_read_b32 v246, a54
v_accvgpr_read_b32 v247, a55
v_pk_mul_f32 v[240:241], v[240:241], v[228:229]
v_pk_mul_f32 v[242:243], v[242:243], v[228:229]
v_pk_mul_f32 v[244:245], v[244:245], v[228:229]
v_pk_mul_f32 v[246:247], v[246:247], v[228:229]
v_cvt_pk_bf16_f32 v164, v240, v241
v_cvt_pk_bf16_f32 v165, v242, v243
v_cvt_pk_bf16_f32 v166, v244, v245
v_cvt_pk_bf16_f32 v167, v246, v247
v_accvgpr_read_b32 v248, a56
v_accvgpr_read_b32 v249, a57
v_accvgpr_read_b32 v250, a58
v_accvgpr_read_b32 v251, a59
v_accvgpr_read_b32 v252, a60
v_accvgpr_read_b32 v253, a61
v_accvgpr_read_b32 v254, a62
v_accvgpr_read_b32 v255, a63
v_pk_mul_f32 v[248:249], v[248:249], v[228:229]
v_pk_mul_f32 v[250:251], v[250:251], v[228:229]
v_pk_mul_f32 v[252:253], v[252:253], v[228:229]
v_pk_mul_f32 v[254:255], v[254:255], v[228:229]
v_cvt_pk_bf16_f32 v180, v248, v249
v_cvt_pk_bf16_f32 v181, v250, v251
v_cvt_pk_bf16_f32 v182, v252, v253
v_cvt_pk_bf16_f32 v183, v254, v255
v_mfma_f32_16x16x32_bf16 v[136:139], a[128:131], v[48:51], v[88:91]
s_add_u32 s82, s82, 0x8000
ds_read_b128 a[160:163], v2 offset:24576
ds_read_b128 a[176:179], v2 offset:28672
v_mfma_f32_16x16x32_bf16 v[140:143], a[128:131], v[64:67], v[92:95]
s_and_b32 s82, s82, 0x1ffff
v_exp_f32 v168, v168
v_mfma_f32_16x16x32_bf16 v[152:155], a[144:147], v[48:51], v[88:91]
s_add_u32 m0, s74, 0
v_exp_f32 v169, v169
v_mfma_f32_16x16x32_bf16 v[156:159], a[144:147], v[64:67], v[92:95]
s_add_u32 s72, s81, 0
buffer_load_dwordx4 v1, s[44:47], s72 offen sc1 lds
v_mfma_f32_16x16x32_bf16 v[136:139], a[132:135], v[52:55], v[136:139]
ds_read_b128 a[164:167], v2 offset:25600
v_cvt_pk_bf16_f32 v216, v168, v169
v_mfma_f32_16x16x32_bf16 v[140:143], a[132:135], v[68:71], v[140:143]
v_exp_f32 v170, v170
v_mfma_f32_16x16x32_bf16 v[156:159], a[148:151], v[68:71], v[156:159]
ds_read_b128 a[180:183], v2 offset:29696
ds_read_b128 a[168:171], v2 offset:26624
v_mfma_f32_16x16x32_bf16 v[152:155], a[148:151], v[52:55], v[152:155]
v_exp_f32 v171, v171
v_mfma_f32_16x16x32_bf16 v[140:143], a[136:139], v[72:75], v[140:143]
v_exp_f32 v184, v184
v_mfma_f32_16x16x32_bf16 v[136:139], a[136:139], v[56:59], v[136:139]
buffer_store_dwordx4 v[128:131], v1, s[44:47], s70 offen sc1
v_mfma_f32_16x16x32_bf16 v[152:155], a[152:155], v[56:59], v[152:155]
ds_read_b128 a[184:187], v2 offset:30720
v_cvt_pk_bf16_f32 v217, v170, v171
v_mfma_f32_16x16x32_bf16 v[156:159], a[152:155], v[72:75], v[156:159]
v_exp_f32 v185, v185
v_mfma_f32_16x16x32_bf16 v[136:139], a[140:143], v[60:63], v[136:139]
ds_read_b128 a[172:175], v2 offset:27648
v_cvt_pk_bf16_f32 v218, v184, v185
v_mfma_f32_16x16x32_bf16 v[140:143], a[140:143], v[76:79], v[140:143]
v_exp_f32 v186, v186
v_mfma_f32_16x16x32_bf16 v[156:159], a[156:159], v[76:79], v[156:159]
buffer_load_dwordx4 v1, s[44:47], s72 offen offset:1024 sc1 lds
v_mfma_f32_16x16x32_bf16 v[152:155], a[156:159], v[60:63], v[152:155]
s_waitcnt lgkmcnt(7)
ds_read_b128 a[188:191], v2 offset:31744
ds_read_b128 a[224:227], v2 offset:8192
v_mfma_f32_16x16x32_bf16 a[64:67], a[192:195], v[200:203], a[64:67]
v_exp_f32 v187, v187
v_mfma_f32_16x16x32_bf16 a[96:99], a[192:195], v[204:207], a[96:99]
v_exp_f32 v172, v172
v_mfma_f32_16x16x32_bf16 a[100:103], a[196:199], v[204:207], a[100:103]
ds_read_b128 a[228:231], v2 offset:9216
v_cvt_pk_bf16_f32 v219, v186, v187
v_mfma_f32_16x16x32_bf16 a[68:71], a[196:199], v[200:203], a[68:71]
v_exp_f32 v173, v173
v_mfma_f32_16x16x32_bf16 a[72:75], a[200:203], v[200:203], a[72:75]
buffer_store_dwordx4 v[144:147], v1, s[44:47], s70 offen offset:1024 sc1
v_mfma_f32_16x16x32_bf16 a[104:107], a[200:203], v[204:207], a[104:107]
ds_read_b128 a[232:235], v2 offset:10240
v_cvt_pk_bf16_f32 v220, v172, v173
v_mfma_f32_16x16x32_bf16 a[108:111], a[204:207], v[204:207], a[108:111]
v_exp_f32 v174, v174
v_mfma_f32_16x16x32_bf16 a[76:79], a[204:207], v[200:203], a[76:79]
ds_read_b128 a[236:239], v2 offset:11264
ds_read_b128 a[240:243], v2 offset:12288
v_mfma_f32_16x16x32_bf16 a[80:83], a[208:211], v[200:203], a[80:83]
v_exp_f32 v175, v175
v_mfma_f32_16x16x32_bf16 a[112:115], a[208:211], v[204:207], a[112:115]
buffer_load_dwordx4 v1, s[44:47], s72 offen offset:2048 sc1 lds
v_mfma_f32_16x16x32_bf16 a[116:119], a[212:215], v[204:207], a[116:119]
v_exp_f32 v188, v188
v_mfma_f32_16x16x32_bf16 a[84:87], a[212:215], v[200:203], a[84:87]
ds_read_b128 a[244:247], v2 offset:13312
v_cvt_pk_bf16_f32 v221, v174, v175
v_mfma_f32_16x16x32_bf16 a[88:91], a[216:219], v[200:203], a[88:91]
v_exp_f32 v189, v189
v_mfma_f32_16x16x32_bf16 a[120:123], a[216:219], v[204:207], a[120:123]
ds_read_b128 a[248:251], v2 offset:14336
ds_read_b128 a[252:255], v2 offset:15360
v_mfma_f32_16x16x32_bf16 a[124:127], a[220:223], v[204:207], a[124:127]
v_exp_f32 v190, v190
v_mfma_f32_16x16x32_bf16 a[92:95], a[220:223], v[200:203], a[92:95]
buffer_load_dwordx4 v1, s[44:47], s72 offen offset:3072 sc1 lds
v_mfma_f32_16x16x32_bf16 v[232:235], v[120:123], v[200:203], v[232:235]
s_waitcnt vmcnt(10) lgkmcnt(8)
v_exp_f32 v191, v191
v_mfma_f32_16x16x32_bf16 v[236:239], v[120:123], v[204:207], v[236:239]
s_barrier
v_cvt_pk_bf16_f32 v222, v188, v189
v_cvt_pk_bf16_f32 v223, v190, v191
v_add_u32 v2, s82, v1
v_mfma_f32_16x16x32_bf16 v[168:171], a[160:163], v[48:51], v[88:91]
s_xor_b32 s74, s82, 0x10000
v_exp_f32 v136, v136
v_mfma_f32_16x16x32_bf16 v[172:175], a[160:163], v[64:67], v[92:95]
s_add_u32 s74, s74, s64
ds_read_b128 a[128:131], v2 offset:16384
ds_read_b128 a[144:147], v2 offset:20480
v_mfma_f32_16x16x32_bf16 v[184:187], a[176:179], v[48:51], v[88:91]
s_add_u32 s81, s81, 0x8000
v_exp_f32 v137, v137
v_mfma_f32_16x16x32_bf16 v[188:191], a[176:179], v[64:67], v[92:95]
s_add_u32 m0, s74, 16384
v_exp_f32 v138, v138
v_mfma_f32_16x16x32_bf16 v[168:171], a[164:167], v[52:55], v[168:171]
s_add_u32 s72, s81, 16384
buffer_load_dwordx4 v1, s[44:47], s72 offen sc1 lds
v_mfma_f32_16x16x32_bf16 v[172:175], a[164:167], v[68:71], v[172:175]
ds_read_b128 a[132:135], v2 offset:17408
v_cvt_pk_bf16_f32 v200, v136, v137
v_mfma_f32_16x16x32_bf16 v[188:191], a[180:183], v[68:71], v[188:191]
v_exp_f32 v139, v139
v_mfma_f32_16x16x32_bf16 v[184:187], a[180:183], v[52:55], v[184:187]
ds_read_b128 a[148:151], v2 offset:21504
v_cvt_pk_bf16_f32 v201, v138, v139
v_mfma_f32_16x16x32_bf16 v[172:175], a[168:171], v[72:75], v[172:175]
buffer_store_dwordx4 v[160:163], v1, s[44:47], s70 offen offset:2048 sc1
v_mfma_f32_16x16x32_bf16 v[168:171], a[168:171], v[56:59], v[168:171]
v_exp_f32 v152, v152
v_mfma_f32_16x16x32_bf16 v[184:187], a[184:187], v[56:59], v[184:187]
ds_read_b128 a[136:139], v2 offset:18432
ds_read_b128 a[152:155], v2 offset:22528
v_mfma_f32_16x16x32_bf16 v[188:191], a[184:187], v[72:75], v[188:191]
v_exp_f32 v153, v153
v_mfma_f32_16x16x32_bf16 v[168:171], a[172:175], v[60:63], v[168:171]
buffer_load_dwordx4 v1, s[44:47], s72 offen offset:1024 sc1 lds
v_mfma_f32_16x16x32_bf16 v[172:175], a[172:175], v[76:79], v[172:175]
v_exp_f32 v154, v154
v_mfma_f32_16x16x32_bf16 v[188:191], a[188:191], v[76:79], v[188:191]
ds_read_b128 a[140:143], v2 offset:19456
v_cvt_pk_bf16_f32 v202, v152, v153
v_mfma_f32_16x16x32_bf16 v[184:187], a[188:191], v[60:63], v[184:187]
s_waitcnt lgkmcnt(7)
v_exp_f32 v155, v155
v_mfma_f32_16x16x32_bf16 a[64:67], a[224:227], v[216:219], a[64:67]
ds_read_b128 a[156:159], v2 offset:23552
v_cvt_pk_bf16_f32 v203, v154, v155
v_mfma_f32_16x16x32_bf16 a[96:99], a[224:227], v[220:223], a[96:99]
v_exp_f32 v140, v140
v_mfma_f32_16x16x32_bf16 a[100:103], a[228:231], v[220:223], a[100:103]
ds_read_b128 a[192:195], v2 offset:0
ds_read_b128 a[196:199], v2 offset:1024
v_mfma_f32_16x16x32_bf16 a[68:71], a[228:231], v[216:219], a[68:71]
buffer_store_dwordx4 v[176:179], v1, s[44:47], s70 offen offset:3072 sc1
v_mfma_f32_16x16x32_bf16 a[72:75], a[232:235], v[216:219], a[72:75]
v_exp_f32 v141, v141
v_mfma_f32_16x16x32_bf16 a[104:107], a[232:235], v[220:223], a[104:107]
v_exp_f32 v142, v142
v_mfma_f32_16x16x32_bf16 a[108:111], a[236:239], v[220:223], a[108:111]
ds_read_b128 a[200:203], v2 offset:2048
ds_read_b128 a[204:207], v2 offset:3072
v_mfma_f32_16x16x32_bf16 a[76:79], a[236:239], v[216:219], a[76:79]
buffer_load_dwordx4 v1, s[44:47], s72 offen offset:2048 sc1 lds
v_mfma_f32_16x16x32_bf16 a[80:83], a[240:243], v[216:219], a[80:83]
s_add_u32 s70, s70, 0x20000
v_exp_f32 v143, v143
v_mfma_f32_16x16x32_bf16 a[112:115], a[240:243], v[220:223], a[112:115]
v_exp_f32 v156, v156
v_mfma_f32_16x16x32_bf16 a[116:119], a[244:247], v[220:223], a[116:119]
ds_read_b128 a[208:211], v2 offset:4096
ds_read_b128 a[212:215], v2 offset:5120
v_mfma_f32_16x16x32_bf16 a[84:87], a[244:247], v[216:219], a[84:87]
ds_read_b128 a[216:219], v2 offset:6144
ds_read_b128 a[220:223], v2 offset:7168
v_mfma_f32_16x16x32_bf16 a[88:91], a[248:251], v[216:219], a[88:91]
v_cvt_pk_bf16_f32 v204, v140, v141
v_cvt_pk_bf16_f32 v205, v142, v143
v_mfma_f32_16x16x32_bf16 a[120:123], a[248:251], v[220:223], a[120:123]
buffer_store_dwordx4 v[132:135], v1, s[44:47], s70 offen sc1
v_mfma_f32_16x16x32_bf16 a[124:127], a[252:255], v[220:223], a[124:127]
v_exp_f32 v157, v157
v_mfma_f32_16x16x32_bf16 a[92:95], a[252:255], v[216:219], a[92:95]
v_exp_f32 v158, v158
v_mfma_f32_16x16x32_bf16 v[232:235], v[120:123], v[216:219], v[232:235]
buffer_load_dwordx4 v1, s[44:47], s72 offen offset:3072 sc1 lds
v_mfma_f32_16x16x32_bf16 v[236:239], v[120:123], v[220:223], v[236:239]
s_waitcnt lgkmcnt(8)
v_exp_f32 v159, v159
v_cvt_pk_bf16_f32 v206, v156, v157
v_cvt_pk_bf16_f32 v207, v158, v159
v_mfma_f32_16x16x32_bf16 v[136:139], a[128:131], v[48:51], v[88:91]
s_add_u32 s82, s82, 0x8000
ds_read_b128 a[160:163], v2 offset:24576
ds_read_b128 a[176:179], v2 offset:28672
v_mfma_f32_16x16x32_bf16 v[140:143], a[128:131], v[64:67], v[92:95]
s_and_b32 s82, s82, 0x1ffff
v_exp_f32 v168, v168
v_mfma_f32_16x16x32_bf16 v[152:155], a[144:147], v[48:51], v[88:91]
s_add_u32 m0, s74, 0
v_exp_f32 v169, v169
v_mfma_f32_16x16x32_bf16 v[156:159], a[144:147], v[64:67], v[92:95]
s_add_u32 s72, s81, 0
buffer_load_dwordx4 v1, s[44:47], s72 offen sc1 lds
v_mfma_f32_16x16x32_bf16 v[136:139], a[132:135], v[52:55], v[136:139]
ds_read_b128 a[164:167], v2 offset:25600
v_cvt_pk_bf16_f32 v216, v168, v169
v_mfma_f32_16x16x32_bf16 v[140:143], a[132:135], v[68:71], v[140:143]
v_exp_f32 v170, v170
v_mfma_f32_16x16x32_bf16 v[156:159], a[148:151], v[68:71], v[156:159]
ds_read_b128 a[180:183], v2 offset:29696
ds_read_b128 a[168:171], v2 offset:26624
v_mfma_f32_16x16x32_bf16 v[152:155], a[148:151], v[52:55], v[152:155]
v_exp_f32 v171, v171
v_mfma_f32_16x16x32_bf16 v[140:143], a[136:139], v[72:75], v[140:143]
buffer_store_dwordx4 v[148:151], v1, s[44:47], s70 offen offset:1024 sc1
v_mfma_f32_16x16x32_bf16 v[136:139], a[136:139], v[56:59], v[136:139]
v_exp_f32 v184, v184
v_mfma_f32_16x16x32_bf16 v[152:155], a[152:155], v[56:59], v[152:155]
ds_read_b128 a[184:187], v2 offset:30720
v_cvt_pk_bf16_f32 v217, v170, v171
v_mfma_f32_16x16x32_bf16 v[156:159], a[152:155], v[72:75], v[156:159]
v_exp_f32 v185, v185
v_mfma_f32_16x16x32_bf16 v[136:139], a[140:143], v[60:63], v[136:139]
buffer_load_dwordx4 v1, s[44:47], s72 offen offset:1024 sc1 lds
v_mfma_f32_16x16x32_bf16 v[140:143], a[140:143], v[76:79], v[140:143]
ds_read_b128 a[172:175], v2 offset:27648
v_cvt_pk_bf16_f32 v218, v184, v185
v_mfma_f32_16x16x32_bf16 v[156:159], a[156:159], v[76:79], v[156:159]
v_exp_f32 v186, v186
v_mfma_f32_16x16x32_bf16 v[152:155], a[156:159], v[60:63], v[152:155]
s_waitcnt lgkmcnt(7)
ds_read_b128 a[188:191], v2 offset:31744
ds_read_b128 a[224:227], v2 offset:8192
v_mfma_f32_16x16x32_bf16 a[64:67], a[192:195], v[200:203], a[64:67]
v_exp_f32 v187, v187
v_mfma_f32_16x16x32_bf16 a[96:99], a[192:195], v[204:207], a[96:99]
buffer_store_dwordx4 v[164:167], v1, s[44:47], s70 offen offset:2048 sc1
v_mfma_f32_16x16x32_bf16 a[100:103], a[196:199], v[204:207], a[100:103]
v_exp_f32 v172, v172
v_mfma_f32_16x16x32_bf16 a[68:71], a[196:199], v[200:203], a[68:71]
ds_read_b128 a[228:231], v2 offset:9216
v_cvt_pk_bf16_f32 v219, v186, v187
v_mfma_f32_16x16x32_bf16 a[72:75], a[200:203], v[200:203], a[72:75]
v_exp_f32 v173, v173
v_mfma_f32_16x16x32_bf16 a[104:107], a[200:203], v[204:207], a[104:107]
ds_read_b128 a[232:235], v2 offset:10240
ds_read_b128 a[236:239], v2 offset:11264
v_mfma_f32_16x16x32_bf16 a[108:111], a[204:207], v[204:207], a[108:111]
v_exp_f32 v174, v174
v_mfma_f32_16x16x32_bf16 a[76:79], a[204:207], v[200:203], a[76:79]
buffer_load_dwordx4 v1, s[44:47], s72 offen offset:2048 sc1 lds
v_mfma_f32_16x16x32_bf16 a[80:83], a[208:211], v[200:203], a[80:83]
v_exp_f32 v175, v175
v_mfma_f32_16x16x32_bf16 a[112:115], a[208:211], v[204:207], a[112:115]
ds_read_b128 a[240:243], v2 offset:12288
ds_read_b128 a[244:247], v2 offset:13312
v_mfma_f32_16x16x32_bf16 a[116:119], a[212:215], v[204:207], a[116:119]
v_exp_f32 v188, v188
v_mfma_f32_16x16x32_bf16 a[84:87], a[212:215], v[200:203], a[84:87]
ds_read_b128 a[248:251], v2 offset:14336
ds_read_b128 a[252:255], v2 offset:15360
v_mfma_f32_16x16x32_bf16 a[88:91], a[216:219], v[200:203], a[88:91]
v_cvt_pk_bf16_f32 v220, v172, v173
v_cvt_pk_bf16_f32 v221, v174, v175
v_mfma_f32_16x16x32_bf16 a[120:123], a[216:219], v[204:207], a[120:123]
buffer_store_dwordx4 v[180:183], v1, s[44:47], s70 offen offset:3072 sc1
v_mfma_f32_16x16x32_bf16 a[124:127], a[220:223], v[204:207], a[124:127]
v_exp_f32 v189, v189
v_mfma_f32_16x16x32_bf16 a[92:95], a[220:223], v[200:203], a[92:95]
buffer_load_dwordx4 v1, s[44:47], s72 offen offset:3072 sc1 lds
v_mfma_f32_16x16x32_bf16 v[232:235], v[120:123], v[200:203], v[232:235]
s_waitcnt vmcnt(14) lgkmcnt(8)
v_exp_f32 v190, v190
v_mfma_f32_16x16x32_bf16 v[236:239], v[120:123], v[204:207], v[236:239]
s_barrier
v_exp_f32 v191, v191
v_add_u32 v2, s82, v1
v_cvt_pk_bf16_f32 v222, v188, v189
v_cvt_pk_bf16_f32 v223, v190, v191
s_lshl_b32 s83, s60, 2
s_sub_u32 s83, s83, 25
LloopII:
v_mfma_f32_16x16x32_bf16 v[168:171], a[160:163], v[48:51], v[88:91]
s_xor_b32 s74, s82, 0x10000
v_exp_f32 v136, v136
v_mfma_f32_16x16x32_bf16 v[172:175], a[160:163], v[64:67], v[92:95]
s_add_u32 s74, s74, s64
ds_read_b128 a[128:131], v2 offset:16384
ds_read_b128 a[144:147], v2 offset:20480
v_mfma_f32_16x16x32_bf16 v[184:187], a[176:179], v[48:51], v[88:91]
s_add_u32 s81, s81, 0x8000
v_exp_f32 v137, v137
v_mfma_f32_16x16x32_bf16 v[188:191], a[176:179], v[64:67], v[92:95]
s_add_u32 m0, s74, 16384
v_exp_f32 v138, v138
v_mfma_f32_16x16x32_bf16 v[168:171], a[164:167], v[52:55], v[168:171]
s_add_u32 s72, s81, 16384
ds_read_b128 a[132:135], v2 offset:17408
v_cvt_pk_bf16_f32 v200, v136, v137
v_mfma_f32_16x16x32_bf16 v[172:175], a[164:167], v[68:71], v[172:175]
buffer_load_dwordx4 v1, s[44:47], s72 offen sc1 lds
v_mfma_f32_16x16x32_bf16 v[188:191], a[180:183], v[68:71], v[188:191]
v_exp_f32 v139, v139
v_mfma_f32_16x16x32_bf16 v[184:187], a[180:183], v[52:55], v[184:187]
ds_read_b128 a[148:151], v2 offset:21504
v_cvt_pk_bf16_f32 v201, v138, v139
v_mfma_f32_16x16x32_bf16 v[172:175], a[168:171], v[72:75], v[172:175]
v_exp_f32 v152, v152
v_mfma_f32_16x16x32_bf16 v[168:171], a[168:171], v[56:59], v[168:171]
ds_read_b128 a[136:139], v2 offset:18432
ds_read_b128 a[152:155], v2 offset:22528
v_mfma_f32_16x16x32_bf16 v[184:187], a[184:187], v[56:59], v[184:187]
v_exp_f32 v153, v153
v_mfma_f32_16x16x32_bf16 v[188:191], a[184:187], v[72:75], v[188:191]
v_exp_f32 v154, v154
v_mfma_f32_16x16x32_bf16 v[168:171], a[172:175], v[60:63], v[168:171]
ds_read_b128 a[140:143], v2 offset:19456
v_cvt_pk_bf16_f32 v202, v152, v153
v_mfma_f32_16x16x32_bf16 v[172:175], a[172:175], v[76:79], v[172:175]
buffer_load_dwordx4 v1, s[44:47], s72 offen offset:1024 sc1 lds
v_mfma_f32_16x16x32_bf16 v[188:191], a[188:191], v[76:79], v[188:191]
v_exp_f32 v155, v155
v_mfma_f32_16x16x32_bf16 v[184:187], a[188:191], v[60:63], v[184:187]
s_waitcnt lgkmcnt(7)
ds_read_b128 a[156:159], v2 offset:23552
v_cvt_pk_bf16_f32 v203, v154, v155
v_mfma_f32_16x16x32_bf16 a[64:67], a[224:227], v[216:219], a[64:67]
v_exp_f32 v140, v140
v_mfma_f32_16x16x32_bf16 a[96:99], a[224:227], v[220:223], a[96:99]
ds_read_b128 a[192:195], v2 offset:0
ds_read_b128 a[196:199], v2 offset:1024
v_mfma_f32_16x16x32_bf16 a[100:103], a[228:231], v[220:223], a[100:103]
v_exp_f32 v141, v141
v_mfma_f32_16x16x32_bf16 a[68:71], a[228:231], v[216:219], a[68:71]
v_exp_f32 v142, v142
v_mfma_f32_16x16x32_bf16 a[72:75], a[232:235], v[216:219], a[72:75]
ds_read_b128 a[200:203], v2 offset:2048
v_cvt_pk_bf16_f32 v204, v140, v141
v_mfma_f32_16x16x32_bf16 a[104:107], a[232:235], v[220:223], a[104:107]
buffer_load_dwordx4 v1, s[44:47], s72 offen offset:2048 sc1 lds
v_mfma_f32_16x16x32_bf16 a[108:111], a[236:239], v[220:223], a[108:111]
v_exp_f32 v143, v143
v_mfma_f32_16x16x32_bf16 a[76:79], a[236:239], v[216:219], a[76:79]
ds_read_b128 a[204:207], v2 offset:3072
v_cvt_pk_bf16_f32 v205, v142, v143
v_mfma_f32_16x16x32_bf16 a[80:83], a[240:243], v[216:219], a[80:83]
v_exp_f32 v156, v156
v_mfma_f32_16x16x32_bf16 a[112:115], a[240:243], v[220:223], a[112:115]
ds_read_b128 a[208:211], v2 offset:4096
v_mfma_f32_16x16x32_bf16 a[116:119], a[244:247], v[220:223], a[116:119]
v_exp_f32 v157, v157
v_mfma_f32_16x16x32_bf16 a[84:87], a[244:247], v[216:219], a[84:87]
ds_read_b128 a[212:215], v2 offset:5120
v_cvt_pk_bf16_f32 v206, v156, v157
v_mfma_f32_16x16x32_bf16 a[88:91], a[248:251], v[216:219], a[88:91]
v_exp_f32 v158, v158
v_mfma_f32_16x16x32_bf16 a[120:123], a[248:251], v[220:223], a[120:123]
ds_read_b128 a[216:219], v2 offset:6144
v_mfma_f32_16x16x32_bf16 a[124:127], a[252:255], v[220:223], a[124:127]
buffer_load_dwordx4 v1, s[44:47], s72 offen offset:3072 sc1 lds
v_mfma_f32_16x16x32_bf16 a[92:95], a[252:255], v[216:219], a[92:95]
v_exp_f32 v159, v159
v_mfma_f32_16x16x32_bf16 v[232:235], v[120:123], v[216:219], v[232:235]
ds_read_b128 a[220:223], v2 offset:7168
v_cvt_pk_bf16_f32 v207, v158, v159
v_mfma_f32_16x16x32_bf16 v[236:239], v[120:123], v[220:223], v[236:239]
s_waitcnt lgkmcnt(8)
v_mfma_f32_16x16x32_bf16 v[136:139], a[128:131], v[48:51], v[88:91]
s_add_u32 s82, s82, 0x8000
ds_read_b128 a[160:163], v2 offset:24576
ds_read_b128 a[176:179], v2 offset:28672
v_mfma_f32_16x16x32_bf16 v[140:143], a[128:131], v[64:67], v[92:95]
s_and_b32 s82, s82, 0x1ffff
v_exp_f32 v168, v168
v_mfma_f32_16x16x32_bf16 v[152:155], a[144:147], v[48:51], v[88:91]
s_add_u32 m0, s74, 0
v_exp_f32 v169, v169
v_mfma_f32_16x16x32_bf16 v[156:159], a[144:147], v[64:67], v[92:95]
s_add_u32 s72, s81, 0
ds_read_b128 a[164:167], v2 offset:25600
v_cvt_pk_bf16_f32 v216, v168, v169
v_mfma_f32_16x16x32_bf16 v[136:139], a[132:135], v[52:55], v[136:139]
v_exp_f32 v170, v170
v_mfma_f32_16x16x32_bf16 v[140:143], a[132:135], v[68:71], v[140:143]
buffer_load_dwordx4 v1, s[44:47], s72 offen sc1 lds
v_mfma_f32_16x16x32_bf16 v[156:159], a[148:151], v[68:71], v[156:159]
ds_read_b128 a[180:183], v2 offset:29696
ds_read_b128 a[168:171], v2 offset:26624
v_mfma_f32_16x16x32_bf16 v[152:155], a[148:151], v[52:55], v[152:155]
v_exp_f32 v171, v171
v_mfma_f32_16x16x32_bf16 v[140:143], a[136:139], v[72:75], v[140:143]
v_exp_f32 v184, v184
v_mfma_f32_16x16x32_bf16 v[136:139], a[136:139], v[56:59], v[136:139]
ds_read_b128 a[184:187], v2 offset:30720
v_cvt_pk_bf16_f32 v217, v170, v171
v_mfma_f32_16x16x32_bf16 v[152:155], a[152:155], v[56:59], v[152:155]
v_exp_f32 v185, v185
v_mfma_f32_16x16x32_bf16 v[156:159], a[152:155], v[72:75], v[156:159]
ds_read_b128 a[172:175], v2 offset:27648
v_cvt_pk_bf16_f32 v218, v184, v185
v_mfma_f32_16x16x32_bf16 v[136:139], a[140:143], v[60:63], v[136:139]
buffer_load_dwordx4 v1, s[44:47], s72 offen offset:1024 sc1 lds
v_mfma_f32_16x16x32_bf16 v[140:143], a[140:143], v[76:79], v[140:143]
v_exp_f32 v186, v186
v_mfma_f32_16x16x32_bf16 v[156:159], a[156:159], v[76:79], v[156:159]
ds_read_b128 a[188:191], v2 offset:31744
ds_read_b128 a[224:227], v2 offset:8192
v_mfma_f32_16x16x32_bf16 v[152:155], a[156:159], v[60:63], v[152:155]
s_waitcnt lgkmcnt(9)
v_exp_f32 v187, v187
v_mfma_f32_16x16x32_bf16 a[64:67], a[192:195], v[200:203], a[64:67]
v_exp_f32 v172, v172
v_mfma_f32_16x16x32_bf16 a[96:99], a[192:195], v[204:207], a[96:99]
ds_read_b128 a[228:231], v2 offset:9216
v_cvt_pk_bf16_f32 v219, v186, v187
v_mfma_f32_16x16x32_bf16 a[100:103], a[196:199], v[204:207], a[100:103]
v_exp_f32 v173, v173
v_mfma_f32_16x16x32_bf16 a[68:71], a[196:199], v[200:203], a[68:71]
ds_read_b128 a[232:235], v2 offset:10240
v_cvt_pk_bf16_f32 v220, v172, v173
v_mfma_f32_16x16x32_bf16 a[72:75], a[200:203], v[200:203], a[72:75]
buffer_load_dwordx4 v1, s[44:47], s72 offen offset:2048 sc1 lds
v_mfma_f32_16x16x32_bf16 a[104:107], a[200:203], v[204:207], a[104:107]
v_exp_f32 v174, v174
v_mfma_f32_16x16x32_bf16 a[108:111], a[204:207], v[204:207], a[108:111]
ds_read_b128 a[236:239], v2 offset:11264
v_mfma_f32_16x16x32_bf16 a[76:79], a[204:207], v[200:203], a[76:79]
v_exp_f32 v175, v175
v_mfma_f32_16x16x32_bf16 a[80:83], a[208:211], v[200:203], a[80:83]
ds_read_b128 a[240:243], v2 offset:12288
v_cvt_pk_bf16_f32 v221, v174, v175
v_mfma_f32_16x16x32_bf16 a[112:115], a[208:211], v[204:207], a[112:115]
v_exp_f32 v188, v188
v_mfma_f32_16x16x32_bf16 a[116:119], a[212:215], v[204:207], a[116:119]
ds_read_b128 a[244:247], v2 offset:13312
v_mfma_f32_16x16x32_bf16 a[84:87], a[212:215], v[200:203], a[84:87]
v_exp_f32 v189, v189
v_mfma_f32_16x16x32_bf16 a[88:91], a[216:219], v[200:203], a[88:91]
ds_read_b128 a[248:251], v2 offset:14336
v_cvt_pk_bf16_f32 v222, v188, v189
v_mfma_f32_16x16x32_bf16 a[120:123], a[216:219], v[204:207], a[120:123]
buffer_load_dwordx4 v1, s[44:47], s72 offen offset:3072 sc1 lds
v_mfma_f32_16x16x32_bf16 a[124:127], a[220:223], v[204:207], a[124:127]
ds_read_b128 a[252:255], v2 offset:15360
v_add_u32 v2, s82, v1
v_mfma_f32_16x16x32_bf16 a[92:95], a[220:223], v[200:203], a[92:95]
s_waitcnt vmcnt(8) lgkmcnt(8)
v_exp_f32 v190, v190
v_mfma_f32_16x16x32_bf16 v[232:235], v[120:123], v[200:203], v[232:235]
s_barrier
v_exp_f32 v191, v191
v_mfma_f32_16x16x32_bf16 v[236:239], v[120:123], v[204:207], v[236:239]
s_add_u32 s83, s83, 1
v_cvt_pk_bf16_f32 v223, v190, v191
s_cbranch_scc0 LloopII
v_mfma_f32_16x16x32_bf16 v[168:171], a[160:163], v[48:51], v[88:91]
s_xor_b32 s74, s82, 0x10000
v_exp_f32 v136, v136
v_mfma_f32_16x16x32_bf16 v[172:175], a[160:163], v[64:67], v[92:95]
s_add_u32 s74, s74, s64
ds_read_b128 a[128:131], v2 offset:16384
ds_read_b128 a[144:147], v2 offset:20480
v_mfma_f32_16x16x32_bf16 v[184:187], a[176:179], v[48:51], v[88:91]
s_add_u32 s81, s81, 0x8000
v_exp_f32 v137, v137
v_mfma_f32_16x16x32_bf16 v[188:191], a[176:179], v[64:67], v[92:95]
s_add_u32 m0, s74, 0
v_exp_f32 v138, v138
v_mfma_f32_16x16x32_bf16 v[168:171], a[164:167], v[52:55], v[168:171]
s_add_u32 s72, s81, 0
ds_read_b128 a[132:135], v2 offset:17408
v_cvt_pk_bf16_f32 v200, v136, v137
v_mfma_f32_16x16x32_bf16 v[172:175], a[164:167], v[68:71], v[172:175]
buffer_load_dwordx4 v1, s[44:47], s72 offen sc1 lds
v_mfma_f32_16x16x32_bf16 v[188:191], a[180:183], v[68:71], v[188:191]
v_exp_f32 v139, v139
v_mfma_f32_16x16x32_bf16 v[184:187], a[180:183], v[52:55], v[184:187]
ds_read_b128 a[148:151], v2 offset:21504
v_cvt_pk_bf16_f32 v201, v138, v139
v_mfma_f32_16x16x32_bf16 v[172:175], a[168:171], v[72:75], v[172:175]
v_exp_f32 v152, v152
v_mfma_f32_16x16x32_bf16 v[168:171], a[168:171], v[56:59], v[168:171]
ds_read_b128 a[136:139], v2 offset:18432
ds_read_b128 a[152:155], v2 offset:22528
v_mfma_f32_16x16x32_bf16 v[184:187], a[184:187], v[56:59], v[184:187]
v_exp_f32 v153, v153
v_mfma_f32_16x16x32_bf16 v[188:191], a[184:187], v[72:75], v[188:191]
v_exp_f32 v154, v154
v_mfma_f32_16x16x32_bf16 v[168:171], a[172:175], v[60:63], v[168:171]
ds_read_b128 a[140:143], v2 offset:19456
v_cvt_pk_bf16_f32 v202, v152, v153
v_mfma_f32_16x16x32_bf16 v[172:175], a[172:175], v[76:79], v[172:175]
buffer_load_dwordx4 v1, s[44:47], s72 offen offset:1024 sc1 lds
v_mfma_f32_16x16x32_bf16 v[188:191], a[188:191], v[76:79], v[188:191]
v_exp_f32 v155, v155
v_mfma_f32_16x16x32_bf16 v[184:187], a[188:191], v[60:63], v[184:187]
s_waitcnt lgkmcnt(7)
ds_read_b128 a[156:159], v2 offset:23552
v_cvt_pk_bf16_f32 v203, v154, v155
v_mfma_f32_16x16x32_bf16 a[64:67], a[224:227], v[216:219], a[64:67]
v_exp_f32 v140, v140
v_mfma_f32_16x16x32_bf16 a[96:99], a[224:227], v[220:223], a[96:99]
ds_read_b128 a[192:195], v2 offset:0
ds_read_b128 a[196:199], v2 offset:1024
v_mfma_f32_16x16x32_bf16 a[100:103], a[228:231], v[220:223], a[100:103]
v_exp_f32 v141, v141
v_mfma_f32_16x16x32_bf16 a[68:71], a[228:231], v[216:219], a[68:71]
v_exp_f32 v142, v142
v_mfma_f32_16x16x32_bf16 a[72:75], a[232:235], v[216:219], a[72:75]
ds_read_b128 a[200:203], v2 offset:2048
v_cvt_pk_bf16_f32 v204, v140, v141
v_mfma_f32_16x16x32_bf16 a[104:107], a[232:235], v[220:223], a[104:107]
buffer_load_dwordx4 v1, s[44:47], s72 offen offset:2048 sc1 lds
v_mfma_f32_16x16x32_bf16 a[108:111], a[236:239], v[220:223], a[108:111]
v_exp_f32 v143, v143
v_mfma_f32_16x16x32_bf16 a[76:79], a[236:239], v[216:219], a[76:79]
ds_read_b128 a[204:207], v2 offset:3072
v_cvt_pk_bf16_f32 v205, v142, v143
v_mfma_f32_16x16x32_bf16 a[80:83], a[240:243], v[216:219], a[80:83]
v_exp_f32 v156, v156
v_mfma_f32_16x16x32_bf16 a[112:115], a[240:243], v[220:223], a[112:115]
ds_read_b128 a[208:211], v2 offset:4096
v_mfma_f32_16x16x32_bf16 a[116:119], a[244:247], v[220:223], a[116:119]
v_exp_f32 v157, v157
v_mfma_f32_16x16x32_bf16 a[84:87], a[244:247], v[216:219], a[84:87]
ds_read_b128 a[212:215], v2 offset:5120
v_cvt_pk_bf16_f32 v206, v156, v157
v_mfma_f32_16x16x32_bf16 a[88:91], a[248:251], v[216:219], a[88:91]
v_exp_f32 v158, v158
v_mfma_f32_16x16x32_bf16 a[120:123], a[248:251], v[220:223], a[120:123]
ds_read_b128 a[216:219], v2 offset:6144
v_mfma_f32_16x16x32_bf16 a[124:127], a[252:255], v[220:223], a[124:127]
buffer_load_dwordx4 v1, s[44:47], s72 offen offset:3072 sc1 lds
v_mfma_f32_16x16x32_bf16 a[92:95], a[252:255], v[216:219], a[92:95]
v_exp_f32 v159, v159
v_mfma_f32_16x16x32_bf16 v[232:235], v[120:123], v[216:219], v[232:235]
ds_read_b128 a[220:223], v2 offset:7168
v_cvt_pk_bf16_f32 v207, v158, v159
v_mfma_f32_16x16x32_bf16 v[236:239], v[120:123], v[220:223], v[236:239]
s_waitcnt lgkmcnt(8)
s_cmp_le_u32 s58, 0
s_cbranch_scc1 Lalt30
v_mfma_f32_16x16x32_bf16 v[136:139], a[128:131], v[48:51], v[88:91]
s_add_u32 s82, s82, 0x8000
ds_read_b128 a[160:163], v2 offset:24576
ds_read_b128 a[176:179], v2 offset:28672
v_mfma_f32_16x16x32_bf16 v[140:143], a[128:131], v[64:67], v[92:95]
s_and_b32 s82, s82, 0x1ffff
v_exp_f32 v168, v168
v_mfma_f32_16x16x32_bf16 v[152:155], a[144:147], v[48:51], v[88:91]
s_add_u32 m0, s66, 32
v_exp_f32 v169, v169
v_mfma_f32_16x16x32_bf16 v[156:159], a[144:147], v[64:67], v[92:95]
s_add_u32 s72, s93, 0x2
ds_read_b128 a[164:167], v2 offset:25600
v_cvt_pk_bf16_f32 v216, v168, v169
Ljoin32:
v_mfma_f32_16x16x32_bf16 v[136:139], a[132:135], v[52:55], v[136:139]
v_exp_f32 v170, v170
v_mfma_f32_16x16x32_bf16 v[140:143], a[132:135], v[68:71], v[140:143]
buffer_load_dwordx4 v1, s[36:39], s72 offen lds
v_mfma_f32_16x16x32_bf16 v[156:159], a[148:151], v[68:71], v[156:159]
ds_read_b128 a[180:183], v2 offset:29696
ds_read_b128 a[168:171], v2 offset:26624
v_mfma_f32_16x16x32_bf16 v[152:155], a[148:151], v[52:55], v[152:155]
v_exp_f32 v171, v171
v_mfma_f32_16x16x32_bf16 v[140:143], a[136:139], v[72:75], v[140:143]
v_exp_f32 v184, v184
v_mfma_f32_16x16x32_bf16 v[136:139], a[136:139], v[56:59], v[136:139]
ds_read_b128 a[184:187], v2 offset:30720
v_cvt_pk_bf16_f32 v217, v170, v171
v_mfma_f32_16x16x32_bf16 v[152:155], a[152:155], v[56:59], v[152:155]
v_exp_f32 v185, v185
v_mfma_f32_16x16x32_bf16 v[156:159], a[152:155], v[72:75], v[156:159]
ds_read_b128 a[172:175], v2 offset:27648
v_cvt_pk_bf16_f32 v218, v184, v185
v_mfma_f32_16x16x32_bf16 v[136:139], a[140:143], v[60:63], v[136:139]
v_exp_f32 v186, v186
v_mfma_f32_16x16x32_bf16 v[140:143], a[140:143], v[76:79], v[140:143]
buffer_load_dwordx4 v1, s[36:39], s72 offen offset:1024 lds
v_mfma_f32_16x16x32_bf16 v[156:159], a[156:159], v[76:79], v[156:159]
ds_read_b128 a[188:191], v2 offset:31744
ds_read_b128 a[224:227], v2 offset:8192
v_mfma_f32_16x16x32_bf16 v[152:155], a[156:159], v[60:63], v[152:155]
s_waitcnt lgkmcnt(9)
v_exp_f32 v187, v187
v_mfma_f32_16x16x32_bf16 a[64:67], a[192:195], v[200:203], a[64:67]
v_exp_f32 v172, v172
v_mfma_f32_16x16x32_bf16 a[96:99], a[192:195], v[204:207], a[96:99]
ds_read_b128 a[228:231], v2 offset:9216
v_cvt_pk_bf16_f32 v219, v186, v187
v_mfma_f32_16x16x32_bf16 a[100:103], a[196:199], v[204:207], a[100:103]
v_exp_f32 v173, v173
v_mfma_f32_16x16x32_bf16 a[68:71], a[196:199], v[200:203], a[68:71]
ds_read_b128 a[232:235], v2 offset:10240
v_cvt_pk_bf16_f32 v220, v172, v173
v_mfma_f32_16x16x32_bf16 a[72:75], a[200:203], v[200:203], a[72:75]
v_exp_f32 v174, v174
v_mfma_f32_16x16x32_bf16 a[104:107], a[200:203], v[204:207], a[104:107]
buffer_load_dwordx4 v1, s[36:39], s72 offen offset:2048 lds
v_mfma_f32_16x16x32_bf16 a[108:111], a[204:207], v[204:207], a[108:111]
ds_read_b128 a[236:239], v2 offset:11264
v_mfma_f32_16x16x32_bf16 a[76:79], a[204:207], v[200:203], a[76:79]
v_exp_f32 v175, v175
v_mfma_f32_16x16x32_bf16 a[80:83], a[208:211], v[200:203], a[80:83]
ds_read_b128 a[240:243], v2 offset:12288
v_cvt_pk_bf16_f32 v221, v174, v175
v_mfma_f32_16x16x32_bf16 a[112:115], a[208:211], v[204:207], a[112:115]
v_exp_f32 v188, v188
v_mfma_f32_16x16x32_bf16 a[116:119], a[212:215], v[204:207], a[116:119]
ds_read_b128 a[244:247], v2 offset:13312
v_mfma_f32_16x16x32_bf16 a[84:87], a[212:215], v[200:203], a[84:87]
v_exp_f32 v189, v189
v_mfma_f32_16x16x32_bf16 a[88:91], a[216:219], v[200:203], a[88:91]
ds_read_b128 a[248:251], v2 offset:14336
v_cvt_pk_bf16_f32 v222, v188, v189
v_mfma_f32_16x16x32_bf16 a[120:123], a[216:219], v[204:207], a[120:123]
buffer_load_dwordx4 v1, s[36:39], s72 offen offset:3072 lds
v_mfma_f32_16x16x32_bf16 a[124:127], a[220:223], v[204:207], a[124:127]
v_exp_f32 v190, v190
v_mfma_f32_16x16x32_bf16 a[92:95], a[220:223], v[200:203], a[92:95]
ds_read_b128 a[252:255], v2 offset:15360
v_add_u32 v2, s82, v1
v_mfma_f32_16x16x32_bf16 v[232:235], v[120:123], v[200:203], v[232:235]
s_waitcnt vmcnt(8) lgkmcnt(0)
v_exp_f32 v191, v191
v_mfma_f32_16x16x32_bf16 v[236:239], v[120:123], v[204:207], v[236:239]
s_barrier
v_cvt_pk_bf16_f32 v223, v190, v191
s_cmp_le_u32 s58, 1
s_cbranch_scc1 Lalt33
v_mfma_f32_16x16x32_bf16 v[168:171], a[160:163], v[48:51], v[88:91]
s_add_u32 m0, s92, 8352
v_exp_f32 v136, v136
v_mfma_f32_16x16x32_bf16 v[172:175], a[160:163], v[64:67], v[92:95]
s_add_u32 s72, s93, 0x6
ds_read_b128 a[128:131], v2 offset:16384
ds_read_b128 a[144:147], v2 offset:20480
v_mfma_f32_16x16x32_bf16 v[184:187], a[176:179], v[48:51], v[88:91]
v_exp_f32 v137, v137
v_mfma_f32_16x16x32_bf16 v[188:191], a[176:179], v[64:67], v[92:95]
buffer_load_dwordx4 v1, s[36:39], s72 offen lds
Ljoin35:
v_mfma_f32_16x16x32_bf16 v[168:171], a[164:167], v[52:55], v[168:171]
v_exp_f32 v138, v138
v_mfma_f32_16x16x32_bf16 v[172:175], a[164:167], v[68:71], v[172:175]
ds_read_b128 a[132:135], v2 offset:17408
v_cvt_pk_bf16_f32 v200, v136, v137
v_mfma_f32_16x16x32_bf16 v[188:191], a[180:183], v[68:71], v[188:191]
v_exp_f32 v139, v139
v_mfma_f32_16x16x32_bf16 v[184:187], a[180:183], v[52:55], v[184:187]
ds_read_b128 a[148:151], v2 offset:21504
v_cvt_pk_bf16_f32 v201, v138, v139
v_mfma_f32_16x16x32_bf16 v[172:175], a[168:171], v[72:75], v[172:175]
v_exp_f32 v152, v152
v_mfma_f32_16x16x32_bf16 v[168:171], a[168:171], v[56:59], v[168:171]
ds_read_b128 a[136:139], v2 offset:18432
ds_read_b128 a[152:155], v2 offset:22528
v_mfma_f32_16x16x32_bf16 v[184:187], a[184:187], v[56:59], v[184:187]
v_exp_f32 v153, v153
v_mfma_f32_16x16x32_bf16 v[188:191], a[184:187], v[72:75], v[188:191]
buffer_load_dwordx4 v1, s[36:39], s72 offen offset:1024 lds
v_mfma_f32_16x16x32_bf16 v[168:171], a[172:175], v[60:63], v[168:171]
v_exp_f32 v154, v154
v_mfma_f32_16x16x32_bf16 v[172:175], a[172:175], v[76:79], v[172:175]
ds_read_b128 a[140:143], v2 offset:19456
v_cvt_pk_bf16_f32 v202, v152, v153
v_mfma_f32_16x16x32_bf16 v[188:191], a[188:191], v[76:79], v[188:191]
v_exp_f32 v155, v155
v_mfma_f32_16x16x32_bf16 v[184:187], a[188:191], v[60:63], v[184:187]
s_waitcnt lgkmcnt(7)
ds_read_b128 a[156:159], v2 offset:23552
v_cvt_pk_bf16_f32 v203, v154, v155
v_mfma_f32_16x16x32_bf16 a[64:67], a[224:227], v[216:219], a[64:67]
v_exp_f32 v140, v140
v_mfma_f32_16x16x32_bf16 a[96:99], a[224:227], v[220:223], a[96:99]
ds_read_b128 a[192:195], v2 offset:0
ds_read_b128 a[196:199], v2 offset:1024
v_mfma_f32_16x16x32_bf16 a[100:103], a[228:231], v[220:223], a[100:103]
buffer_load_dwordx4 v1, s[36:39], s72 offen offset:2048 lds
v_mfma_f32_16x16x32_bf16 a[68:71], a[228:231], v[216:219], a[68:71]
v_exp_f32 v141, v141
v_mfma_f32_16x16x32_bf16 a[72:75], a[232:235], v[216:219], a[72:75]
v_exp_f32 v142, v142
v_mfma_f32_16x16x32_bf16 a[104:107], a[232:235], v[220:223], a[104:107]
ds_read_b128 a[200:203], v2 offset:2048
v_cvt_pk_bf16_f32 v204, v140, v141
v_mfma_f32_16x16x32_bf16 a[108:111], a[236:239], v[220:223], a[108:111]
v_exp_f32 v143, v143
v_mfma_f32_16x16x32_bf16 a[76:79], a[236:239], v[216:219], a[76:79]
ds_read_b128 a[204:207], v2 offset:3072
v_cvt_pk_bf16_f32 v205, v142, v143
v_mfma_f32_16x16x32_bf16 a[80:83], a[240:243], v[216:219], a[80:83]
buffer_load_dwordx4 v1, s[36:39], s72 offen offset:3072 lds
v_mfma_f32_16x16x32_bf16 a[112:115], a[240:243], v[220:223], a[112:115]
s_add_u32 m0, s62, 0
v_exp_f32 v156, v156
v_mfma_f32_16x16x32_bf16 a[116:119], a[244:247], v[220:223], a[116:119]
s_add_u32 s72, s93, 0x3000000
ds_read_b128 a[208:211], v2 offset:4096
ds_read_b128 a[212:215], v2 offset:5120
v_mfma_f32_16x16x32_bf16 a[84:87], a[244:247], v[216:219], a[84:87]
v_exp_f32 v157, v157
v_mfma_f32_16x16x32_bf16 a[88:91], a[248:251], v[216:219], a[88:91]
v_exp_f32 v158, v158
v_mfma_f32_16x16x32_bf16 a[120:123], a[248:251], v[220:223], a[120:123]
ds_read_b128 a[216:219], v2 offset:6144
v_cvt_pk_bf16_f32 v206, v156, v157
v_mfma_f32_16x16x32_bf16 a[124:127], a[252:255], v[220:223], a[124:127]
buffer_load_dwordx4 v1, s[44:47], s72 offen sc1 lds
v_mfma_f32_16x16x32_bf16 a[92:95], a[252:255], v[216:219], a[92:95]
v_exp_f32 v159, v159
v_mfma_f32_16x16x32_bf16 v[232:235], v[120:123], v[216:219], v[232:235]
ds_read_b128 a[220:223], v2 offset:7168
v_cvt_pk_bf16_f32 v207, v158, v159
v_mfma_f32_16x16x32_bf16 v[236:239], v[120:123], v[220:223], v[236:239]
s_waitcnt lgkmcnt(8)
s_cmp_le_u32 s58, 2
s_cbranch_scc1 Lalt36
v_mfma_f32_16x16x32_bf16 v[136:139], a[128:131], v[48:51], v[88:91]
s_add_u32 s82, s82, 0x8000
ds_read_b128 a[160:163], v2 offset:24576
ds_read_b128 a[176:179], v2 offset:28672
v_mfma_f32_16x16x32_bf16 v[140:143], a[128:131], v[64:67], v[92:95]
s_and_b32 s82, s82, 0x1ffff
v_exp_f32 v168, v168
v_mfma_f32_16x16x32_bf16 v[152:155], a[144:147], v[48:51], v[88:91]
v_exp_f32 v169, v169
v_mfma_f32_16x16x32_bf16 v[156:159], a[144:147], v[64:67], v[92:95]
buffer_load_dwordx4 v1, s[44:47], s72 offen offset:1024 sc1 lds
Ljoin38:
v_mfma_f32_16x16x32_bf16 v[136:139], a[132:135], v[52:55], v[136:139]
ds_read_b128 a[164:167], v2 offset:25600
v_cvt_pk_bf16_f32 v216, v168, v169
v_mfma_f32_16x16x32_bf16 v[140:143], a[132:135], v[68:71], v[140:143]
v_exp_f32 v170, v170
v_mfma_f32_16x16x32_bf16 v[156:159], a[148:151], v[68:71], v[156:159]
ds_read_b128 a[180:183], v2 offset:29696
ds_read_b128 a[168:171], v2 offset:26624
v_mfma_f32_16x16x32_bf16 v[152:155], a[148:151], v[52:55], v[152:155]
v_exp_f32 v171, v171
v_mfma_f32_16x16x32_bf16 v[140:143], a[136:139], v[72:75], v[140:143]
v_exp_f32 v184, v184
v_mfma_f32_16x16x32_bf16 v[136:139], a[136:139], v[56:59], v[136:139]
ds_read_b128 a[184:187], v2 offset:30720
v_cvt_pk_bf16_f32 v217, v170, v171
v_mfma_f32_16x16x32_bf16 v[152:155], a[152:155], v[56:59], v[152:155]
buffer_load_dwordx4 v1, s[44:47], s72 offen offset:2048 sc1 lds
v_mfma_f32_16x16x32_bf16 v[156:159], a[152:155], v[72:75], v[156:159]
v_exp_f32 v185, v185
v_mfma_f32_16x16x32_bf16 v[136:139], a[140:143], v[60:63], v[136:139]
ds_read_b128 a[172:175], v2 offset:27648
v_cvt_pk_bf16_f32 v218, v184, v185
v_mfma_f32_16x16x32_bf16 v[140:143], a[140:143], v[76:79], v[140:143]
v_exp_f32 v186, v186
v_mfma_f32_16x16x32_bf16 v[156:159], a[156:159], v[76:79], v[156:159]
ds_read_b128 a[188:191], v2 offset:31744
ds_read_b128 a[224:227], v2 offset:8192
v_mfma_f32_16x16x32_bf16 v[152:155], a[156:159], v[60:63], v[152:155]
s_waitcnt lgkmcnt(9)
v_exp_f32 v187, v187
v_mfma_f32_16x16x32_bf16 a[64:67], a[192:195], v[200:203], a[64:67]
v_exp_f32 v172, v172
v_mfma_f32_16x16x32_bf16 a[96:99], a[192:195], v[204:207], a[96:99]
buffer_load_dwordx4 v1, s[44:47], s72 offen offset:3072 sc1 lds
v_mfma_f32_16x16x32_bf16 a[100:103], a[196:199], v[204:207], a[100:103]
s_add_u32 m0, s92, 32
ds_read_b128 a[228:231], v2 offset:9216
v_cvt_pk_bf16_f32 v219, v186, v187
v_mfma_f32_16x16x32_bf16 a[68:71], a[196:199], v[200:203], a[68:71]
s_add_u32 s72, s93, 0x0
v_exp_f32 v173, v173
v_mfma_f32_16x16x32_bf16 a[72:75], a[200:203], v[200:203], a[72:75]
ds_read_b128 a[232:235], v2 offset:10240
v_cvt_pk_bf16_f32 v220, v172, v173
v_mfma_f32_16x16x32_bf16 a[104:107], a[200:203], v[204:207], a[104:107]
v_exp_f32 v174, v174
v_mfma_f32_16x16x32_bf16 a[108:111], a[204:207], v[204:207], a[108:111]
ds_read_b128 a[236:239], v2 offset:11264
ds_read_b128 a[240:243], v2 offset:12288
v_mfma_f32_16x16x32_bf16 a[76:79], a[204:207], v[200:203], a[76:79]
v_exp_f32 v175, v175
v_mfma_f32_16x16x32_bf16 a[80:83], a[208:211], v[200:203], a[80:83]
buffer_load_dwordx4 v1, s[36:39], s72 offen lds
v_mfma_f32_16x16x32_bf16 a[112:115], a[208:211], v[204:207], a[112:115]
v_exp_f32 v188, v188
v_mfma_f32_16x16x32_bf16 a[116:119], a[212:215], v[204:207], a[116:119]
ds_read_b128 a[244:247], v2 offset:13312
v_cvt_pk_bf16_f32 v221, v174, v175
v_mfma_f32_16x16x32_bf16 a[84:87], a[212:215], v[200:203], a[84:87]
v_exp_f32 v189, v189
v_mfma_f32_16x16x32_bf16 a[88:91], a[216:219], v[200:203], a[88:91]
ds_read_b128 a[248:251], v2 offset:14336
v_cvt_pk_bf16_f32 v222, v188, v189
v_mfma_f32_16x16x32_bf16 a[120:123], a[216:219], v[204:207], a[120:123]
v_exp_f32 v190, v190
v_mfma_f32_16x16x32_bf16 a[124:127], a[220:223], v[204:207], a[124:127]
buffer_load_dwordx4 v1, s[36:39], s72 offen offset:1024 lds
v_mfma_f32_16x16x32_bf16 a[92:95], a[220:223], v[200:203], a[92:95]
ds_read_b128 a[252:255], v2 offset:15360
v_add_u32 v2, s82, v1
v_mfma_f32_16x16x32_bf16 v[232:235], v[120:123], v[200:203], v[232:235]
s_waitcnt vmcnt(14) lgkmcnt(8)
v_exp_f32 v191, v191
v_mfma_f32_16x16x32_bf16 v[236:239], v[120:123], v[204:207], v[236:239]
s_barrier
v_cvt_pk_bf16_f32 v223, v190, v191
LHT3:
s_cmp_le_u32 s58, 3
s_cbranch_scc1 Lalt45
v_mfma_f32_16x16x32_bf16 v[168:171], a[160:163], v[48:51], v[88:91]
v_exp_f32 v136, v136
v_mfma_f32_16x16x32_bf16 v[172:175], a[160:163], v[64:67], v[92:95]
ds_read_b128 a[192:195], v2 offset:0
v_mfma_f32_16x16x32_bf16 v[184:187], a[176:179], v[48:51], v[88:91]
v_exp_f32 v137, v137
v_mfma_f32_16x16x32_bf16 v[188:191], a[176:179], v[64:67], v[92:95]
buffer_load_dwordx4 v1, s[36:39], s72 offen offset:2048 lds
Ljoin47:
v_mfma_f32_16x16x32_bf16 v[168:171], a[164:167], v[52:55], v[168:171]
v_exp_f32 v138, v138
v_mfma_f32_16x16x32_bf16 v[172:175], a[164:167], v[68:71], v[172:175]
ds_read_b128 a[196:199], v2 offset:1024
v_cvt_pk_bf16_f32 v200, v136, v137
v_mfma_f32_16x16x32_bf16 v[188:191], a[180:183], v[68:71], v[188:191]
v_exp_f32 v139, v139
v_mfma_f32_16x16x32_bf16 v[184:187], a[180:183], v[52:55], v[184:187]
v_exp_f32 v152, v152
v_mfma_f32_16x16x32_bf16 v[172:175], a[168:171], v[72:75], v[172:175]
ds_read_b128 a[200:203], v2 offset:2048
v_cvt_pk_bf16_f32 v201, v138, v139
v_mfma_f32_16x16x32_bf16 v[168:171], a[168:171], v[56:59], v[168:171]
buffer_load_dwordx4 v1, s[36:39], s72 offen offset:3072 lds
v_mfma_f32_16x16x32_bf16 v[184:187], a[184:187], v[56:59], v[184:187]
s_add_u32 m0, s92, 4192
v_exp_f32 v153, v153
v_mfma_f32_16x16x32_bf16 v[188:191], a[184:187], v[72:75], v[188:191]
s_add_u32 s72, s93, 0x4
v_exp_f32 v154, v154
v_mfma_f32_16x16x32_bf16 v[168:171], a[172:175], v[60:63], v[168:171]
ds_read_b128 a[204:207], v2 offset:3072
v_cvt_pk_bf16_f32 v202, v152, v153
v_mfma_f32_16x16x32_bf16 v[172:175], a[172:175], v[76:79], v[172:175]
buffer_load_dwordx4 v1, s[36:39], s72 offen lds
v_mfma_f32_16x16x32_bf16 v[188:191], a[188:191], v[76:79], v[188:191]
v_exp_f32 v155, v155
v_mfma_f32_16x16x32_bf16 v[184:187], a[188:191], v[60:63], v[184:187]
s_waitcnt lgkmcnt(4)
v_exp_f32 v140, v140
v_mfma_f32_16x16x32_bf16 a[64:67], a[224:227], v[216:219], a[64:67]
ds_read_b128 a[208:211], v2 offset:4096
v_cvt_pk_bf16_f32 v203, v154, v155
v_mfma_f32_16x16x32_bf16 a[96:99], a[224:227], v[220:223], a[96:99]
v_exp_f32 v141, v141
v_mfma_f32_16x16x32_bf16 a[100:103], a[228:231], v[220:223], a[100:103]
buffer_load_dwordx4 v1, s[36:39], s72 offen offset:1024 lds
v_mfma_f32_16x16x32_bf16 a[68:71], a[228:231], v[216:219], a[68:71]
v_exp_f32 v142, v142
v_mfma_f32_16x16x32_bf16 a[72:75], a[232:235], v[216:219], a[72:75]
ds_read_b128 a[212:215], v2 offset:5120
v_cvt_pk_bf16_f32 v204, v140, v141
v_mfma_f32_16x16x32_bf16 a[104:107], a[232:235], v[220:223], a[104:107]
v_exp_f32 v143, v143
v_mfma_f32_16x16x32_bf16 a[108:111], a[236:239], v[220:223], a[108:111]
v_exp_f32 v156, v156
v_mfma_f32_16x16x32_bf16 a[76:79], a[236:239], v[216:219], a[76:79]
ds_read_b128 a[216:219], v2 offset:6144
v_cvt_pk_bf16_f32 v205, v142, v143
v_mfma_f32_16x16x32_bf16 a[80:83], a[240:243], v[216:219], a[80:83]
buffer_load_dwordx4 v1, s[36:39], s72 offen offset:2048 lds
v_mfma_f32_16x16x32_bf16 a[112:115], a[240:243], v[220:223], a[112:115]
v_exp_f32 v157, v157
v_mfma_f32_16x16x32_bf16 a[116:119], a[244:247], v[220:223], a[116:119]
v_exp_f32 v158, v158
v_mfma_f32_16x16x32_bf16 a[84:87], a[244:247], v[216:219], a[84:87]
ds_read_b128 a[220:223], v2 offset:7168
v_cvt_pk_bf16_f32 v206, v156, v157
v_mfma_f32_16x16x32_bf16 a[88:91], a[248:251], v[216:219], a[88:91]
buffer_load_dwordx4 v1, s[36:39], s72 offen offset:3072 lds
v_mfma_f32_16x16x32_bf16 a[120:123], a[248:251], v[220:223], a[120:123]
v_exp_f32 v159, v159
v_mfma_f32_16x16x32_bf16 a[124:127], a[252:255], v[220:223], a[124:127]
v_cvt_pk_bf16_f32 v207, v158, v159
v_mfma_f32_16x16x32_bf16 a[92:95], a[252:255], v[216:219], a[92:95]
v_mfma_f32_16x16x32_bf16 v[232:235], v[120:123], v[216:219], v[232:235]
v_mfma_f32_16x16x32_bf16 v[236:239], v[120:123], v[220:223], v[236:239]
s_waitcnt lgkmcnt(0)
v_mfma_f32_16x16x32_bf16 a[64:67], a[192:195], v[200:203], a[64:67]
s_add_u32 s82, s82, 0x8000
ds_read_b128 a[224:227], v2 offset:8192
ds_read_b128 a[228:231], v2 offset:9216
v_mfma_f32_16x16x32_bf16 a[96:99], a[192:195], v[204:207], a[96:99]
s_and_b32 s82, s82, 0x1ffff
v_exp_f32 v168, v168
v_mfma_f32_16x16x32_bf16 a[100:103], a[196:199], v[204:207], a[100:103]
v_exp_f32 v169, v169
v_mfma_f32_16x16x32_bf16 a[68:71], a[196:199], v[200:203], a[68:71]
v_exp_f32 v170, v170
v_mfma_f32_16x16x32_bf16 a[72:75], a[200:203], v[200:203], a[72:75]
v_exp_f32 v171, v171
v_mfma_f32_16x16x32_bf16 a[104:107], a[200:203], v[204:207], a[104:107]
ds_read_b128 a[232:235], v2 offset:10240
ds_read_b128 a[236:239], v2 offset:11264
v_mfma_f32_16x16x32_bf16 a[108:111], a[204:207], v[204:207], a[108:111]
v_exp_f32 v184, v184
v_mfma_f32_16x16x32_bf16 a[76:79], a[204:207], v[200:203], a[76:79]
ds_read_b128 a[240:243], v2 offset:12288
ds_read_b128 a[244:247], v2 offset:13312
v_mfma_f32_16x16x32_bf16 a[80:83], a[208:211], v[200:203], a[80:83]
ds_read_b128 a[248:251], v2 offset:14336
ds_read_b128 a[252:255], v2 offset:15360
v_mfma_f32_16x16x32_bf16 a[112:115], a[208:211], v[204:207], a[112:115]
v_cvt_pk_bf16_f32 v216, v168, v169
v_cvt_pk_bf16_f32 v217, v170, v171
v_mfma_f32_16x16x32_bf16 a[116:119], a[212:215], v[204:207], a[116:119]
v_exp_f32 v185, v185
v_mfma_f32_16x16x32_bf16 a[84:87], a[212:215], v[200:203], a[84:87]
v_exp_f32 v186, v186
v_mfma_f32_16x16x32_bf16 a[88:91], a[216:219], v[200:203], a[88:91]
v_exp_f32 v187, v187
v_mfma_f32_16x16x32_bf16 a[120:123], a[216:219], v[204:207], a[120:123]
v_exp_f32 v172, v172
v_mfma_f32_16x16x32_bf16 a[124:127], a[220:223], v[204:207], a[124:127]
v_cvt_pk_bf16_f32 v218, v184, v185
v_cvt_pk_bf16_f32 v219, v186, v187
v_mfma_f32_16x16x32_bf16 a[92:95], a[220:223], v[200:203], a[92:95]
v_exp_f32 v173, v173
v_mfma_f32_16x16x32_bf16 v[232:235], v[120:123], v[200:203], v[232:235]
s_waitcnt lgkmcnt(0)
v_exp_f32 v174, v174
v_mfma_f32_16x16x32_bf16 v[236:239], v[120:123], v[204:207], v[236:239]
s_barrier
v_exp_f32 v175, v175
v_add_u32 v2, s82, v1
v_cvt_pk_bf16_f32 v220, v172, v173
v_exp_f32 v188, v188
v_cvt_pk_bf16_f32 v221, v174, v175
v_exp_f32 v189, v189
v_exp_f32 v190, v190
v_cvt_pk_bf16_f32 v222, v188, v189
v_exp_f32 v191, v191
s_nop 0
v_cvt_pk_bf16_f32 v223, v190, v191
v_mfma_f32_16x16x32_bf16 a[64:67], a[224:227], v[216:219], a[64:67]
s_lshr_b32 s75, s59, 3
ds_write_b64 v5, v[12:13]
v_mov_b32 v240, 0
v_mfma_f32_16x16x32_bf16 a[96:99], a[224:227], v[220:223], a[96:99]
s_lshl_b32 s75, s75, 2
v_mov_b32 v241, 0
v_lshrrev_b32 v15, 4, v0
v_mfma_f32_16x16x32_bf16 a[100:103], a[228:231], v[220:223], a[100:103]
s_add_u32 s75, s75, s65
ds_write_b64 v14, v[240:241]
v_lshlrev_b32 v15, 1, v15
v_mfma_f32_16x16x32_bf16 a[68:71], a[228:231], v[216:219], a[68:71]
s_waitcnt vmcnt(0)
ds_read_b128 a[192:195], v7 offset:3584
ds_read_b64 a[128:129], v6 offset:0
v_mfma_f32_16x16x32_bf16 a[72:75], a[232:235], v[216:219], a[72:75]
s_lshl_b32 s76, s59, 1
ds_read_b64 a[130:131], v6 offset:8
ds_read_b128 a[196:199], v7 offset:3072
v_mfma_f32_16x16x32_bf16 a[104:107], a[232:235], v[220:223], a[104:107]
s_and_b32 s76, s76, 8
ds_read_b64 a[132:133], v6 offset:512
ds_read_b64 a[134:135], v6 offset:520
v_mfma_f32_16x16x32_bf16 a[108:111], a[236:239], v[220:223], a[108:111]
s_add_u32 s76, s76, s60
ds_read_b128 a[200:203], v7 offset:2560
ds_read_b64 a[136:137], v6 offset:1024
v_mfma_f32_16x16x32_bf16 a[76:79], a[236:239], v[216:219], a[76:79]
s_lshl_b32 s94, s58, 16
ds_read_b64 a[138:139], v6 offset:1032
ds_read_b128 a[204:207], v7 offset:2048
v_mfma_f32_16x16x32_bf16 a[80:83], a[240:243], v[216:219], a[80:83]
s_lshl_b32 s74, s76, 7
ds_read_b64 a[140:141], v6 offset:1536
ds_read_b64 a[142:143], v6 offset:1544
v_mfma_f32_16x16x32_bf16 a[112:115], a[240:243], v[220:223], a[112:115]
s_add_u32 s94, s94, s74
ds_read_b128 a[208:211], v7 offset:1536
ds_read_b64 a[144:145], v6 offset:2048
v_mfma_f32_16x16x32_bf16 a[116:119], a[244:247], v[220:223], a[116:119]
s_lshl_b32 s95, s75, 20
ds_read_b64 a[146:147], v6 offset:2056
ds_read_b128 a[212:215], v7 offset:1024
v_mfma_f32_16x16x32_bf16 a[84:87], a[244:247], v[216:219], a[84:87]
s_lshl_b32 s74, s58, 18
ds_read_b64 a[148:149], v6 offset:2560
ds_read_b64 a[150:151], v6 offset:2568
v_mfma_f32_16x16x32_bf16 a[88:91], a[248:251], v[216:219], a[88:91]
s_add_u32 s95, s95, s74
ds_read_b128 a[216:219], v7 offset:512
ds_read_b64 a[152:153], v6 offset:3072
v_mfma_f32_16x16x32_bf16 a[120:123], a[248:251], v[220:223], a[120:123]
s_add_u32 s95, s95, 0x2000000
ds_read_b64 a[154:155], v6 offset:3080
ds_read_b128 a[220:223], v7 offset:0
v_mfma_f32_16x16x32_bf16 a[124:127], a[252:255], v[220:223], a[124:127]
s_sub_u32 s74, 15, s75
ds_read_b64 a[156:157], v6 offset:3584
ds_read_b64 a[158:159], v6 offset:3592
v_mfma_f32_16x16x32_bf16 a[92:95], a[252:255], v[216:219], a[92:95]
s_min_u32 s74, s74, s75
v_and_b32 v4, 7, v0
v_xor_b32 v15, v15, v4
v_mfma_f32_16x16x32_bf16 v[232:235], v[120:123], v[216:219], v[232:235]
s_lshl_b32 s74, s74, 7
v_lshlrev_b32 v15, 4, v15
v_lshrrev_b32 v4, 3, v0
v_mfma_f32_16x16x32_bf16 v[236:239], v[120:123], v[220:223], v[236:239]
s_add_u32 s74, s74, 0x3810000
s_waitcnt lgkmcnt(0)
v_lshl_add_u32 v15, v4, 11, v15
v_mfma_f32_16x16x32_bf16 v[128:131], v[8:11], a[192:195], 0
s_add_u32 s78, s59, 4
v_mfma_f32_16x16x32_bf16 v[132:135], v[8:11], a[196:199], 0
s_and_b32 s78, s78, 28
v_mfma_f32_16x16x32_bf16 v[136:139], v[8:11], a[200:203], 0
s_add_u32 s79, s59, 8
ds_read_b128 a[224:227], v7 offset:3648
ds_read_b64 a[160:161], v6 offset:64
v_mfma_f32_16x16x32_bf16 v[140:143], v[8:11], a[204:207], 0
s_and_b32 s79, s79, 28
v_mfma_f32_16x16x32_bf16 v[144:147], v[8:11], a[208:211], 0
v_rcp_f32 v232, v232
v_mfma_f32_16x16x32_bf16 v[148:151], v[8:11], a[212:215], 0
ds_read_b64 a[162:163], v6 offset:72
ds_read_b128 a[228:231], v7 offset:3136
v_mfma_f32_16x16x32_bf16 v[152:155], v[8:11], a[216:219], 0
v_rcp_f32 v236, v236
v_mfma_f32_16x16x32_bf16 v[156:159], v[8:11], a[220:223], 0
s_lshl_b32 s73, s59, 12
v_mfma_f32_16x16x32_bf16 v[128:131], a[128:131], a[192:195], v[128:131]
s_add_u32 s73, s73, 0x2000000
ds_read_b64 a[164:165], v6 offset:576
ds_read_b64 a[166:167], v6 offset:584
v_mfma_f32_16x16x32_bf16 v[132:135], a[128:131], a[196:199], v[132:135]
s_lshl_b32 s70, s68, 2
v_mfma_f32_16x16x32_bf16 v[136:139], a[128:131], a[200:203], v[136:139]
s_add_u32 s71, s61, 0
v_mfma_f32_16x16x32_bf16 v[140:143], a[128:131], a[204:207], v[140:143]
s_and_b32 s71, s71, 3
ds_read_b128 a[232:235], v7 offset:2624
ds_read_b64 a[168:169], v6 offset:1088
v_mfma_f32_16x16x32_bf16 v[144:147], a[128:131], a[208:211], v[144:147]
s_add_u32 s71, s71, s78
v_mfma_f32_16x16x32_bf16 v[148:151], a[128:131], a[212:215], v[148:151]
s_lshl_b32 s71, s71, 18
v_mfma_f32_16x16x32_bf16 v[152:155], a[128:131], a[216:219], v[152:155]
s_add_u32 s71, s71, s94
ds_read_b64 a[170:171], v6 offset:1096
ds_read_b128 a[236:239], v7 offset:2112
v_mfma_f32_16x16x32_bf16 v[156:159], a[128:131], a[220:223], v[156:159]
s_add_u32 m0, s77, 0
v_mfma_f32_16x16x32_bf16 v[132:135], a[132:135], a[192:195], v[132:135]
s_add_u32 s72, s71, 0
buffer_load_dwordx4 v15, s[24:27], s72 offen lds
v_mfma_f32_16x16x32_bf16 v[136:139], a[132:135], a[196:199], v[136:139]
s_add_u32 s70, s70, s73
ds_read_b64 a[172:173], v6 offset:1600
ds_read_b64 a[174:175], v6 offset:1608
v_accvgpr_read_b32 v240, a64
v_mfma_f32_16x16x32_bf16 v[140:143], a[132:135], a[200:203], v[140:143]
v_accvgpr_read_b32 v241, a65
v_accvgpr_read_b32 v242, a66
v_accvgpr_read_b32 v243, a67
v_mfma_f32_16x16x32_bf16 v[144:147], a[132:135], a[204:207], v[144:147]
v_accvgpr_read_b32 v244, a68
v_accvgpr_read_b32 v245, a69
v_accvgpr_read_b32 v246, a70
v_mfma_f32_16x16x32_bf16 v[148:151], a[132:135], a[208:211], v[148:151]
s_add_u32 s72, s71, 15360
ds_read_b128 a[240:243], v7 offset:1600
ds_read_b64 a[176:177], v6 offset:2112
v_accvgpr_read_b32 v247, a71
v_mfma_f32_16x16x32_bf16 v[152:155], a[132:135], a[212:215], v[152:155]
buffer_load_dwordx4 v15, s[24:27], s72 offen offset:1024 lds
v_mul_f32 v240, v240, v232
v_mfma_f32_16x16x32_bf16 v[156:159], a[132:135], a[216:219], v[156:159]
v_mul_f32 v241, v241, v232
v_mul_f32 v242, v242, v232
v_mul_f32 v243, v243, v232
v_mfma_f32_16x16x32_bf16 v[136:139], a[136:139], a[192:195], v[136:139]
ds_read_b64 a[178:179], v6 offset:2120
ds_read_b128 a[244:247], v7 offset:1088
v_mul_f32 v244, v244, v232
v_mfma_f32_16x16x32_bf16 v[140:143], a[136:139], a[196:199], v[140:143]
v_mul_f32 v245, v245, v232
v_mul_f32 v246, v246, v232
v_mul_f32 v247, v247, v232
v_mfma_f32_16x16x32_bf16 v[144:147], a[136:139], a[200:203], v[144:147]
v_cvt_pk_bf16_f32 v240, v240, v241
v_cvt_pk_bf16_f32 v241, v242, v243
v_cvt_pk_bf16_f32 v242, v244, v245
v_mfma_f32_16x16x32_bf16 v[148:151], a[136:139], a[204:207], v[148:151]
ds_read_b64 a[180:181], v6 offset:2624
ds_read_b64 a[182:183], v6 offset:2632
v_cvt_pk_bf16_f32 v243, v246, v247
v_mfma_f32_16x16x32_bf16 v[152:155], a[136:139], a[208:211], v[152:155]
buffer_store_dwordx4 v[240:243], v1, s[44:47], s70 offen sc1
v_mfma_f32_16x16x32_bf16 v[156:159], a[136:139], a[212:215], v[156:159]
v_accvgpr_read_b32 v248, a72
v_accvgpr_read_b32 v249, a73
v_accvgpr_read_b32 v250, a74
v_mfma_f32_16x16x32_bf16 v[140:143], a[140:143], a[192:195], v[140:143]
ds_read_b128 a[248:251], v7 offset:576
ds_read_b64 a[184:185], v6 offset:3136
v_accvgpr_read_b32 v251, a75
v_mfma_f32_16x16x32_bf16 v[144:147], a[140:143], a[196:199], v[144:147]
s_add_u32 s72, s71, 30720
buffer_load_dwordx4 v15, s[24:27], s72 offen offset:2048 lds
v_accvgpr_read_b32 v252, a76
v_mfma_f32_16x16x32_bf16 v[148:151], a[140:143], a[200:203], v[148:151]
v_accvgpr_read_b32 v253, a77
v_accvgpr_read_b32 v254, a78
v_accvgpr_read_b32 v255, a79
v_mfma_f32_16x16x32_bf16 v[152:155], a[140:143], a[204:207], v[152:155]
ds_read_b64 a[186:187], v6 offset:3144
ds_read_b128 a[252:255], v7 offset:64
v_mul_f32 v248, v248, v232
v_mfma_f32_16x16x32_bf16 v[156:159], a[140:143], a[208:211], v[156:159]
v_mul_f32 v249, v249, v232
v_mul_f32 v250, v250, v232
v_mul_f32 v251, v251, v232
v_mfma_f32_16x16x32_bf16 v[144:147], a[144:147], a[192:195], v[144:147]
v_mul_f32 v252, v252, v232
v_mul_f32 v253, v253, v232
v_mul_f32 v254, v254, v232
v_mfma_f32_16x16x32_bf16 v[148:151], a[144:147], a[196:199], v[148:151]
ds_read_b64 a[188:189], v6 offset:3648
ds_read_b64 a[190:191], v6 offset:3656
v_mul_f32 v255, v255, v232
v_mfma_f32_16x16x32_bf16 v[152:155], a[144:147], a[200:203], v[152:155]
v_cvt_pk_bf16_f32 v248, v248, v249
v_cvt_pk_bf16_f32 v249, v250, v251
v_cvt_pk_bf16_f32 v250, v252, v253
v_mfma_f32_16x16x32_bf16 v[156:159], a[144:147], a[204:207], v[156:159]
v_cvt_pk_bf16_f32 v251, v254, v255
v_mfma_f32_16x16x32_bf16 v[148:151], a[148:151], a[192:195], v[148:151]
buffer_store_dwordx4 v[248:251], v1, s[44:47], s70 offen offset:1024 sc1
v_mfma_f32_16x16x32_bf16 v[152:155], a[148:151], a[196:199], v[152:155]
v_accvgpr_read_b32 v240, a80
v_accvgpr_read_b32 v241, a81
v_accvgpr_read_b32 v242, a82
v_mfma_f32_16x16x32_bf16 v[156:159], a[148:151], a[200:203], v[156:159]
s_add_u32 s72, s71, 46080
buffer_load_dwordx4 v15, s[24:27], s72 offen offset:3072 lds
v_accvgpr_read_b32 v243, a83
v_mfma_f32_16x16x32_bf16 v[152:155], a[152:155], a[192:195], v[152:155]
v_accvgpr_read_b32 v244, a84
v_accvgpr_read_b32 v245, a85
v_accvgpr_read_b32 v246, a86
v_mfma_f32_16x16x32_bf16 v[156:159], a[152:155], a[196:199], v[156:159]
v_accvgpr_read_b32 v247, a87
v_mul_f32 v240, v240, v232
v_mul_f32 v241, v241, v232
v_mfma_f32_16x16x32_bf16 v[156:159], a[156:159], a[192:195], v[156:159]
s_waitcnt lgkmcnt(0)
v_mul_f32 v242, v242, v232
v_mul_f32 v243, v243, v232
v_mul_f32 v244, v244, v232
v_mfma_f32_16x16x32_bf16 v[128:131], a[160:163], a[224:227], v[128:131]
ds_read_b128 a[192:195], v7 offset:3712
ds_read_b64 a[128:129], v6 offset:128
v_mul_f32 v245, v245, v232
v_mfma_f32_16x16x32_bf16 v[132:135], a[160:163], a[228:231], v[132:135]
v_mul_f32 v246, v246, v232
v_mul_f32 v247, v247, v232
v_cvt_pk_bf16_f32 v240, v240, v241
v_mfma_f32_16x16x32_bf16 v[136:139], a[160:163], a[232:235], v[136:139]
ds_read_b64 a[130:131], v6 offset:136
ds_read_b128 a[196:199], v7 offset:3200
v_cvt_pk_bf16_f32 v241, v242, v243
v_mfma_f32_16x16x32_bf16 v[140:143], a[160:163], a[236:239], v[140:143]
v_cvt_pk_bf16_f32 v242, v244, v245
v_cvt_pk_bf16_f32 v243, v246, v247
v_mfma_f32_16x16x32_bf16 v[144:147], a[160:163], a[240:243], v[144:147]
buffer_store_dwordx4 v[240:243], v1, s[44:47], s70 offen offset:2048 sc1
v_mfma_f32_16x16x32_bf16 v[148:151], a[160:163], a[244:247], v[148:151]
ds_read_b64 a[132:133], v6 offset:640
ds_read_b64 a[134:135], v6 offset:648
v_accvgpr_read_b32 v248, a88
v_mfma_f32_16x16x32_bf16 v[152:155], a[160:163], a[248:251], v[152:155]
s_add_u32 s71, s61, 1
v_accvgpr_read_b32 v249, a89
v_accvgpr_read_b32 v250, a90
v_accvgpr_read_b32 v251, a91
v_mfma_f32_16x16x32_bf16 v[156:159], a[160:163], a[252:255], v[156:159]
s_and_b32 s71, s71, 3
ds_read_b128 a[200:203], v7 offset:2688
ds_read_b64 a[136:137], v6 offset:1152
v_accvgpr_read_b32 v252, a92
v_mfma_f32_16x16x32_bf16 v[132:135], a[164:167], a[224:227], v[132:135]
s_add_u32 s71, s71, s78
v_accvgpr_read_b32 v253, a93
v_accvgpr_read_b32 v254, a94
v_accvgpr_read_b32 v255, a95
v_mfma_f32_16x16x32_bf16 v[136:139], a[164:167], a[228:231], v[136:139]
s_lshl_b32 s71, s71, 18
v_mul_f32 v248, v248, v232
v_mul_f32 v249, v249, v232
v_mul_f32 v250, v250, v232
v_mfma_f32_16x16x32_bf16 v[140:143], a[164:167], a[232:235], v[140:143]
s_add_u32 s71, s71, s94
ds_read_b64 a[138:139], v6 offset:1160
ds_read_b128 a[204:207], v7 offset:2176
v_mul_f32 v251, v251, v232
v_mfma_f32_16x16x32_bf16 v[144:147], a[164:167], a[236:239], v[144:147]
s_add_u32 m0, s77, 16384
v_mul_f32 v252, v252, v232
v_mul_f32 v253, v253, v232
v_mul_f32 v254, v254, v232
v_mfma_f32_16x16x32_bf16 v[148:151], a[164:167], a[240:243], v[148:151]
s_add_u32 s72, s71, 0
ds_read_b64 a[140:141], v6 offset:1664
ds_read_b64 a[142:143], v6 offset:1672
v_mul_f32 v255, v255, v232
v_mfma_f32_16x16x32_bf16 v[152:155], a[164:167], a[244:247], v[152:155]
buffer_load_dwordx4 v15, s[24:27], s72 offen lds
v_cvt_pk_bf16_f32 v248, v248, v249
v_mfma_f32_16x16x32_bf16 v[156:159], a[164:167], a[248:251], v[156:159]
v_cvt_pk_bf16_f32 v249, v250, v251
v_cvt_pk_bf16_f32 v250, v252, v253
v_cvt_pk_bf16_f32 v251, v254, v255
v_mfma_f32_16x16x32_bf16 v[136:139], a[168:171], a[224:227], v[136:139]
ds_read_b128 a[208:211], v7 offset:1664
ds_read_b64 a[144:145], v6 offset:2176
v_mfma_f32_16x16x32_bf16 v[140:143], a[168:171], a[228:231], v[140:143]
s_add_u32 s72, s71, 15360
buffer_load_dwordx4 v15, s[24:27], s72 offen offset:1024 lds
v_mfma_f32_16x16x32_bf16 v[144:147], a[168:171], a[232:235], v[144:147]
buffer_store_dwordx4 v[248:251], v1, s[44:47], s70 offen offset:3072 sc1
v_mfma_f32_16x16x32_bf16 v[148:151], a[168:171], a[236:239], v[148:151]
s_add_u32 s70, s70, 0x20000
ds_read_b64 a[146:147], v6 offset:2184
ds_read_b128 a[212:215], v7 offset:1152
v_accvgpr_read_b32 v240, a96
v_mfma_f32_16x16x32_bf16 v[152:155], a[168:171], a[240:243], v[152:155]
v_accvgpr_read_b32 v241, a97
v_accvgpr_read_b32 v242, a98
v_accvgpr_read_b32 v243, a99
v_mfma_f32_16x16x32_bf16 v[156:159], a[168:171], a[244:247], v[156:159]
ds_read_b64 a[148:149], v6 offset:2688
ds_read_b64 a[150:151], v6 offset:2696
v_accvgpr_read_b32 v244, a100
v_mfma_f32_16x16x32_bf16 v[140:143], a[172:175], a[224:227], v[140:143]
v_accvgpr_read_b32 v245, a101
v_accvgpr_read_b32 v246, a102
v_accvgpr_read_b32 v247, a103
v_mfma_f32_16x16x32_bf16 v[144:147], a[172:175], a[228:231], v[144:147]
v_mul_f32 v240, v240, v236
v_mul_f32 v241, v241, v236
v_mul_f32 v242, v242, v236
v_mfma_f32_16x16x32_bf16 v[148:151], a[172:175], a[232:235], v[148:151]
ds_read_b128 a[216:219], v7 offset:640
ds_read_b64 a[152:153], v6 offset:3200
v_mul_f32 v243, v243, v236
v_mfma_f32_16x16x32_bf16 v[152:155], a[172:175], a[236:239], v[152:155]
v_mul_f32 v244, v244, v236
v_mul_f32 v245, v245, v236
v_mul_f32 v246, v246, v236
v_mfma_f32_16x16x32_bf16 v[156:159], a[172:175], a[240:243], v[156:159]
ds_read_b64 a[154:155], v6 offset:3208
ds_read_b128 a[220:223], v7 offset:128
v_mul_f32 v247, v247, v236
v_mfma_f32_16x16x32_bf16 v[144:147], a[176:179], a[224:227], v[144:147]
s_add_u32 s72, s71, 30720
buffer_load_dwordx4 v15, s[24:27], s72 offen offset:2048 lds
v_cvt_pk_bf16_f32 v240, v240, v241
v_mfma_f32_16x16x32_bf16 v[148:151], a[176:179], a[228:231], v[148:151]
v_cvt_pk_bf16_f32 v241, v242, v243
v_cvt_pk_bf16_f32 v242, v244, v245
v_cvt_pk_bf16_f32 v243, v246, v247
v_mfma_f32_16x16x32_bf16 v[152:155], a[176:179], a[232:235], v[152:155]
ds_read_b64 a[156:157], v6 offset:3712
ds_read_b64 a[158:159], v6 offset:3720
v_mfma_f32_16x16x32_bf16 v[156:159], a[176:179], a[236:239], v[156:159]
buffer_store_dwordx4 v[240:243], v1, s[44:47], s70 offen sc1
v_mfma_f32_16x16x32_bf16 v[148:151], a[180:183], a[224:227], v[148:151]
v_accvgpr_read_b32 v248, a104
v_accvgpr_read_b32 v249, a105
v_accvgpr_read_b32 v250, a106
v_mfma_f32_16x16x32_bf16 v[152:155], a[180:183], a[228:231], v[152:155]
v_accvgpr_read_b32 v251, a107
v_accvgpr_read_b32 v252, a108
v_accvgpr_read_b32 v253, a109
v_mfma_f32_16x16x32_bf16 v[156:159], a[180:183], a[232:235], v[156:159]
v_accvgpr_read_b32 v254, a110
v_accvgpr_read_b32 v255, a111
v_mul_f32 v248, v248, v236
v_mfma_f32_16x16x32_bf16 v[152:155], a[184:187], a[224:227], v[152:155]
v_mul_f32 v249, v249, v236
v_mul_f32 v250, v250, v236
v_mul_f32 v251, v251, v236
v_mfma_f32_16x16x32_bf16 v[156:159], a[184:187], a[228:231], v[156:159]
v_mul_f32 v252, v252, v236
v_mul_f32 v253, v253, v236
v_mul_f32 v254, v254, v236
v_mfma_f32_16x16x32_bf16 v[156:159], a[188:191], a[224:227], v[156:159]
s_waitcnt lgkmcnt(0)
v_mul_f32 v255, v255, v236
v_cvt_pk_bf16_f32 v248, v248, v249
v_cvt_pk_bf16_f32 v249, v250, v251
v_mfma_f32_16x16x32_bf16 v[128:131], a[128:131], a[192:195], v[128:131]
s_add_u32 s72, s71, 46080
ds_read_b128 a[224:227], v7 offset:3776
ds_read_b64 a[160:161], v6 offset:192
v_cvt_pk_bf16_f32 v250, v252, v253
v_mfma_f32_16x16x32_bf16 v[132:135], a[128:131], a[196:199], v[132:135]
buffer_load_dwordx4 v15, s[24:27], s72 offen offset:3072 lds
v_cvt_pk_bf16_f32 v251, v254, v255
v_mfma_f32_16x16x32_bf16 v[136:139], a[128:131], a[200:203], v[136:139]
ds_read_b64 a[162:163], v6 offset:200
ds_read_b128 a[228:231], v7 offset:3264
v_mfma_f32_16x16x32_bf16 v[140:143], a[128:131], a[204:207], v[140:143]
buffer_store_dwordx4 v[248:251], v1, s[44:47], s70 offen offset:1024 sc1
v_mfma_f32_16x16x32_bf16 v[144:147], a[128:131], a[208:211], v[144:147]
v_accvgpr_read_b32 v240, a112
v_accvgpr_read_b32 v241, a113
v_accvgpr_read_b32 v242, a114
v_mfma_f32_16x16x32_bf16 v[148:151], a[128:131], a[212:215], v[148:151]
ds_read_b64 a[164:165], v6 offset:704
ds_read_b64 a[166:167], v6 offset:712
v_accvgpr_read_b32 v243, a115
v_mfma_f32_16x16x32_bf16 v[152:155], a[128:131], a[216:219], v[152:155]
v_accvgpr_read_b32 v244, a116
v_accvgpr_read_b32 v245, a117
v_accvgpr_read_b32 v246, a118
v_mfma_f32_16x16x32_bf16 v[156:159], a[128:131], a[220:223], v[156:159]
ds_read_b128 a[232:235], v7 offset:2752
ds_read_b64 a[168:169], v6 offset:1216
v_accvgpr_read_b32 v247, a119
v_mfma_f32_16x16x32_bf16 v[132:135], a[132:135], a[192:195], v[132:135]
v_mul_f32 v240, v240, v236
v_mul_f32 v241, v241, v236
v_mul_f32 v242, v242, v236
v_mfma_f32_16x16x32_bf16 v[136:139], a[132:135], a[196:199], v[136:139]
v_mul_f32 v243, v243, v236
v_mul_f32 v244, v244, v236
v_mul_f32 v245, v245, v236
v_mfma_f32_16x16x32_bf16 v[140:143], a[132:135], a[200:203], v[140:143]
s_add_u32 s71, s61, 2
ds_read_b64 a[170:171], v6 offset:1224
ds_read_b128 a[236:239], v7 offset:2240
v_mul_f32 v246, v246, v236
v_mfma_f32_16x16x32_bf16 v[144:147], a[132:135], a[204:207], v[144:147]
s_and_b32 s71, s71, 3
v_mul_f32 v247, v247, v236
v_cvt_pk_bf16_f32 v240, v240, v241
v_cvt_pk_bf16_f32 v241, v242, v243
v_mfma_f32_16x16x32_bf16 v[148:151], a[132:135], a[208:211], v[148:151]
s_add_u32 s71, s71, s78
ds_read_b64 a[172:173], v6 offset:1728
ds_read_b64 a[174:175], v6 offset:1736
v_cvt_pk_bf16_f32 v242, v244, v245
v_mfma_f32_16x16x32_bf16 v[152:155], a[132:135], a[212:215], v[152:155]
s_lshl_b32 s71, s71, 18
v_cvt_pk_bf16_f32 v243, v246, v247
v_mfma_f32_16x16x32_bf16 v[156:159], a[132:135], a[216:219], v[156:159]
s_add_u32 s71, s71, s94
buffer_store_dwordx4 v[240:243], v1, s[44:47], s70 offen offset:2048 sc1
v_mfma_f32_16x16x32_bf16 v[136:139], a[136:139], a[192:195], v[136:139]
s_add_u32 m0, s77, 32768
ds_read_b128 a[240:243], v7 offset:1728
ds_read_b64 a[176:177], v6 offset:2240
v_accvgpr_read_b32 v248, a120
v_mfma_f32_16x16x32_bf16 v[140:143], a[136:139], a[196:199], v[140:143]
s_add_u32 s72, s71, 0
buffer_load_dwordx4 v15, s[24:27], s72 offen lds
v_accvgpr_read_b32 v249, a121
v_mfma_f32_16x16x32_bf16 v[144:147], a[136:139], a[200:203], v[144:147]
v_accvgpr_read_b32 v250, a122
v_accvgpr_read_b32 v251, a123
v_accvgpr_read_b32 v252, a124
v_mfma_f32_16x16x32_bf16 v[148:151], a[136:139], a[204:207], v[148:151]
ds_read_b64 a[178:179], v6 offset:2248
ds_read_b128 a[244:247], v7 offset:1216
v_accvgpr_read_b32 v253, a125
v_mfma_f32_16x16x32_bf16 v[152:155], a[136:139], a[208:211], v[152:155]
v_accvgpr_read_b32 v254, a126
v_accvgpr_read_b32 v255, a127
v_mul_f32 v248, v248, v236
v_mfma_f32_16x16x32_bf16 v[156:159], a[136:139], a[212:215], v[156:159]
s_add_u32 s72, s71, 15360
ds_read_b64 a[180:181], v6 offset:2752
ds_read_b64 a[182:183], v6 offset:2760
v_mul_f32 v249, v249, v236
v_mfma_f32_16x16x32_bf16 v[140:143], a[140:143], a[192:195], v[140:143]
buffer_load_dwordx4 v15, s[24:27], s72 offen offset:1024 lds
v_mul_f32 v250, v250, v236
v_mfma_f32_16x16x32_bf16 v[144:147], a[140:143], a[196:199], v[144:147]
v_mul_f32 v251, v251, v236
v_mul_f32 v252, v252, v236
v_mul_f32 v253, v253, v236
v_mfma_f32_16x16x32_bf16 v[148:151], a[140:143], a[200:203], v[148:151]
ds_read_b128 a[248:251], v7 offset:704
ds_read_b64 a[184:185], v6 offset:3264
v_mul_f32 v254, v254, v236
v_mfma_f32_16x16x32_bf16 v[152:155], a[140:143], a[204:207], v[152:155]
v_mul_f32 v255, v255, v236
v_cvt_pk_bf16_f32 v248, v248, v249
v_cvt_pk_bf16_f32 v249, v250, v251
v_mfma_f32_16x16x32_bf16 v[156:159], a[140:143], a[208:211], v[156:159]
ds_read_b64 a[186:187], v6 offset:3272
ds_read_b128 a[252:255], v7 offset:192
v_cvt_pk_bf16_f32 v250, v252, v253
v_mfma_f32_16x16x32_bf16 v[144:147], a[144:147], a[192:195], v[144:147]
v_cvt_pk_bf16_f32 v251, v254, v255
v_mfma_f32_16x16x32_bf16 v[148:151], a[144:147], a[196:199], v[148:151]
buffer_store_dwordx4 v[248:251], v1, s[44:47], s70 offen offset:3072 sc1
v_mfma_f32_16x16x32_bf16 v[152:155], a[144:147], a[200:203], v[152:155]
s_mov_b32 s73, 0x5d800000
ds_read_b64 a[188:189], v6 offset:3776
ds_read_b64 a[190:191], v6 offset:3784
v_add_f32 v227, v226, v230
v_mfma_f32_16x16x32_bf16 v[156:159], a[144:147], a[204:207], v[156:159]
v_add_f32 v231, v234, v238
v_add_f32 v227, v227, v231
v_cmp_nlt_f32 vcc, v227, s73
v_mfma_f32_16x16x32_bf16 v[148:151], a[148:151], a[192:195], v[148:151]
s_add_u32 s72, s71, 30720
buffer_load_dwordx4 v15, s[24:27], s72 offen offset:2048 lds
v_mfma_f32_16x16x32_bf16 v[152:155], a[148:151], a[196:199], v[152:155]
s_lshl_b32 s73, s58, 2
v_mfma_f32_16x16x32_bf16 v[156:159], a[148:151], a[200:203], v[156:159]
s_add_u32 s73, s73, 163328
v_mov_b32 v231, s73
v_mfma_f32_16x16x32_bf16 v[152:155], a[152:155], a[192:195], v[152:155]
s_or_b32 s73, vcc_lo, vcc_hi
v_mfma_f32_16x16x32_bf16 v[156:159], a[152:155], a[196:199], v[156:159]
s_min_u32 s73, s73, 1
v_mov_b32 v227, s73
v_mfma_f32_16x16x32_bf16 v[156:159], a[156:159], a[192:195], v[156:159]
s_waitcnt lgkmcnt(0)
ds_write_b32 v231, v227
v_mfma_f32_16x16x32_bf16 v[128:131], a[160:163], a[224:227], v[128:131]
ds_read_b128 a[192:195], v7 offset:3840
ds_read_b64 a[128:129], v6 offset:256
v_mfma_f32_16x16x32_bf16 v[132:135], a[160:163], a[228:231], v[132:135]
v_mfma_f32_16x16x32_bf16 v[136:139], a[160:163], a[232:235], v[136:139]
ds_read_b64 a[130:131], v6 offset:264
ds_read_b128 a[196:199], v7 offset:3328
v_mfma_f32_16x16x32_bf16 v[140:143], a[160:163], a[236:239], v[140:143]
v_mfma_f32_16x16x32_bf16 v[144:147], a[160:163], a[240:243], v[144:147]
s_add_u32 s72, s71, 46080
buffer_load_dwordx4 v15, s[24:27], s72 offen offset:3072 lds
v_mfma_f32_16x16x32_bf16 v[148:151], a[160:163], a[244:247], v[148:151]
ds_read_b64 a[132:133], v6 offset:768
ds_read_b64 a[134:135], v6 offset:776
v_mfma_f32_16x16x32_bf16 v[152:155], a[160:163], a[248:251], v[152:155]
v_mfma_f32_16x16x32_bf16 v[156:159], a[160:163], a[252:255], v[156:159]
ds_read_b128 a[200:203], v7 offset:2816
ds_read_b64 a[136:137], v6 offset:1280
v_mfma_f32_16x16x32_bf16 v[132:135], a[164:167], a[224:227], v[132:135]
v_mfma_f32_16x16x32_bf16 v[136:139], a[164:167], a[228:231], v[136:139]
v_mfma_f32_16x16x32_bf16 v[140:143], a[164:167], a[232:235], v[140:143]
ds_read_b64 a[138:139], v6 offset:1288
ds_read_b128 a[204:207], v7 offset:2304
v_mfma_f32_16x16x32_bf16 v[144:147], a[164:167], a[236:239], v[144:147]
v_mfma_f32_16x16x32_bf16 v[148:151], a[164:167], a[240:243], v[148:151]
ds_read_b64 a[140:141], v6 offset:1792
ds_read_b64 a[142:143], v6 offset:1800
v_mfma_f32_16x16x32_bf16 v[152:155], a[164:167], a[244:247], v[152:155]
v_mfma_f32_16x16x32_bf16 v[156:159], a[164:167], a[248:251], v[156:159]
s_add_u32 s71, s61, 3
v_mfma_f32_16x16x32_bf16 v[136:139], a[168:171], a[224:227], v[136:139]
s_and_b32 s71, s71, 3
ds_read_b128 a[208:211], v7 offset:1792
ds_read_b64 a[144:145], v6 offset:2304
v_mfma_f32_16x16x32_bf16 v[140:143], a[168:171], a[228:231], v[140:143]
s_add_u32 s71, s71, s78
v_mfma_f32_16x16x32_bf16 v[144:147], a[168:171], a[232:235], v[144:147]
s_lshl_b32 s71, s71, 18
v_mfma_f32_16x16x32_bf16 v[148:151], a[168:171], a[236:239], v[148:151]
s_add_u32 s71, s71, s94
ds_read_b64 a[146:147], v6 offset:2312
ds_read_b128 a[212:215], v7 offset:1280
v_mfma_f32_16x16x32_bf16 v[152:155], a[168:171], a[240:243], v[152:155]
s_add_u32 m0, s77, 49152
v_mfma_f32_16x16x32_bf16 v[156:159], a[168:171], a[244:247], v[156:159]
s_add_u32 s72, s71, 0
ds_read_b64 a[148:149], v6 offset:2816
ds_read_b64 a[150:151], v6 offset:2824
v_mfma_f32_16x16x32_bf16 v[140:143], a[172:175], a[224:227], v[140:143]
s_waitcnt vmcnt(2) lgkmcnt(15)
buffer_load_dwordx4 v15, s[24:27], s72 offen lds
v_mfma_f32_16x16x32_bf16 v[144:147], a[172:175], a[228:231], v[144:147]
s_barrier
v_mov_b32 v244, 163328
v_mfma_f32_16x16x32_bf16 v[148:151], a[172:175], a[232:235], v[148:151]
ds_read_b128 a[216:219], v7 offset:768
ds_read_b64 a[152:153], v6 offset:3328
ds_read_b128 v[240:243], v244
v_mfma_f32_16x16x32_bf16 v[152:155], a[172:175], a[236:239], v[152:155]
s_add_u32 s72, s71, 15360
buffer_load_dwordx4 v15, s[24:27], s72 offen offset:1024 lds
v_mfma_f32_16x16x32_bf16 v[156:159], a[172:175], a[240:243], v[156:159]
ds_read_b64 a[154:155], v6 offset:3336
ds_read_b128 a[220:223], v7 offset:256
v_mfma_f32_16x16x32_bf16 v[144:147], a[176:179], a[224:227], v[144:147]
v_mfma_f32_16x16x32_bf16 v[148:151], a[176:179], a[228:231], v[148:151]
v_mfma_f32_16x16x32_bf16 v[152:155], a[176:179], a[232:235], v[152:155]
s_waitcnt lgkmcnt(2)
ds_read_b64 a[156:157], v6 offset:3840
ds_read_b64 a[158:159], v6 offset:3848
v_or3_b32 v240, v240, v241, v242
v_mfma_f32_16x16x32_bf16 v[156:159], a[176:179], a[236:239], v[156:159]
v_or_b32 v240, v240, v243
v_mfma_f32_16x16x32_bf16 v[148:151], a[180:183], a[224:227], v[148:151]
v_cmp_lt_u32 vcc, s86, v240
s_cbranch_vccnz Lslow
v_mfma_f32_16x16x32_bf16 v[152:155], a[180:183], a[228:231], v[152:155]
v_or_b32 v240, s58, v0
v_mov_b32 v241, 2
v_min_u32 v240, 1, v240
v_mfma_f32_16x16x32_bf16 v[156:159], a[180:183], a[232:235], v[156:159]
v_lshlrev_b32 v240, 30, v240
v_mfma_f32_16x16x32_bf16 v[152:155], a[184:187], a[224:227], v[152:155]
buffer_store_dword v241, v240, s[44:47], s91 offen sc1
v_mfma_f32_16x16x32_bf16 v[156:159], a[184:187], a[228:231], v[156:159]
s_add_u32 s72, s71, 30720
buffer_load_dwordx4 v15, s[24:27], s72 offen offset:2048 lds
v_mfma_f32_16x16x32_bf16 v[156:159], a[188:191], a[224:227], v[156:159]
s_waitcnt lgkmcnt(0)
v_mfma_f32_16x16x32_bf16 v[128:131], a[128:131], a[192:195], v[128:131]
s_add_u32 s80, s93, 0x3400000
ds_read_b128 a[224:227], v7 offset:3904
ds_read_b64 a[160:161], v6 offset:320
v_and_b32 v166, 7, v0
v_mfma_f32_16x16x32_bf16 v[132:135], a[128:131], a[196:199], v[132:135]
v_lshlrev_b32 v166, 4, v166
v_bfe_u32 v112, v0, 3, 1
v_lshl_add_u32 v166, v112, 8, v166
v_mfma_f32_16x16x32_bf16 v[136:139], a[128:131], a[200:203], v[136:139]
ds_read_b64 a[162:163], v6 offset:328
ds_read_b128 a[228:231], v7 offset:3392
v_bfe_u32 v112, v0, 4, 1
v_mfma_f32_16x16x32_bf16 v[140:143], a[128:131], a[204:207], v[140:143]
v_lshl_add_u32 v166, v112, 7, v166
v_lshrrev_b32 v112, 5, v0
v_lshl_add_u32 v166, v112, 9, v166
v_mfma_f32_16x16x32_bf16 v[144:147], a[128:131], a[208:211], v[144:147]
v_and_b32 v112, 15, v0
v_lshrrev_b32 v113, 2, v0
v_bfe_u32 v114, v0, 3, 2
v_mfma_f32_16x16x32_bf16 v[148:151], a[128:131], a[212:215], v[148:151]
ds_read_b64 a[164:165], v6 offset:832
ds_read_b64 a[166:167], v6 offset:840
v_and_b32 v115, 3, v0
v_mfma_f32_16x16x32_bf16 v[152:155], a[128:131], a[216:219], v[152:155]
v_lshlrev_b32 v8, 7, v113
v_lshl_add_u32 v8, v114, 5, v8
v_lshl_add_u32 v8, v115, 3, v8
v_mfma_f32_16x16x32_bf16 v[156:159], a[128:131], a[220:223], v[156:159]
ds_read_b128 a[232:235], v7 offset:2880
ds_read_b64 a[168:169], v6 offset:1344
v_add_u32 v8, s77, v8
v_mfma_f32_16x16x32_bf16 v[132:135], a[132:135], a[192:195], v[132:135]
s_add_u32 s72, s71, 46080
buffer_load_dwordx4 v15, s[24:27], s72 offen offset:3072 lds
v_subrev_u32 v8, s64, v8
v_mfma_f32_16x16x32_bf16 v[136:139], a[132:135], a[196:199], v[136:139]
v_xor_b32 v9, 32, v8
v_xor_b32 v10, 64, v8
v_xor_b32 v11, 0x60, v8
v_mfma_f32_16x16x32_bf16 v[140:143], a[132:135], a[200:203], v[140:143]
ds_read_b64 a[170:171], v6 offset:1352
ds_read_b128 a[236:239], v7 offset:2368
v_lshlrev_b32 v5, 8, v113
v_mfma_f32_16x16x32_bf16 v[144:147], a[132:135], a[204:207], v[144:147]
v_and_b32 v114, 1, v0
v_lshl_add_u32 v5, v114, 7, v5
v_bfe_u32 v114, v0, 1, 1
v_mfma_f32_16x16x32_bf16 v[148:151], a[132:135], a[208:211], v[148:151]
ds_read_b64 a[172:173], v6 offset:1856
ds_read_b64 a[174:175], v6 offset:1864
v_lshl_add_u32 v5, v114, 3, v5
v_mfma_f32_16x16x32_bf16 v[152:155], a[132:135], a[212:215], v[152:155]
v_mov_b32 v114, s58
v_lshl_add_u32 v5, v114, 5, v5
v_add_u32 v5, 147456, v5
v_mfma_f32_16x16x32_bf16 v[156:159], a[132:135], a[216:219], v[156:159]
v_bfe_u32 v114, v0, 1, 2
v_lshrrev_b32 v115, 4, v0
v_lshlrev_b32 v116, 7, v112
v_mfma_f32_16x16x32_bf16 v[136:139], a[136:139], a[192:195], v[136:139]
ds_read_b128 a[240:243], v7 offset:1856
ds_read_b64 a[176:177], v6 offset:2368
v_lshl_add_u32 v116, v114, 5, v116
v_mfma_f32_16x16x32_bf16 v[140:143], a[136:139], a[196:199], v[140:143]
v_lshl_add_u32 v116, v115, 3, v116
v_add_u32 v116, s64, v116
v_add_u32 v116, 131072, v116
v_mfma_f32_16x16x32_bf16 v[144:147], a[136:139], a[200:203], v[144:147]
v_xor_b32 v117, 32, v116
v_xor_b32 v118, 64, v116
v_xor_b32 v119, 0x60, v116
v_mfma_f32_16x16x32_bf16 v[148:151], a[136:139], a[204:207], v[148:151]
ds_read_b64 a[178:179], v6 offset:2376
ds_read_b128 a[244:247], v7 offset:1344
v_mfma_f32_16x16x32_bf16 v[152:155], a[136:139], a[208:211], v[152:155]
v_mfma_f32_16x16x32_bf16 v[156:159], a[136:139], a[212:215], v[156:159]
ds_read_b64 a[180:181], v6 offset:2880
ds_read_b64 a[182:183], v6 offset:2888
v_mfma_f32_16x16x32_bf16 v[140:143], a[140:143], a[192:195], v[140:143]
v_mfma_f32_16x16x32_bf16 v[144:147], a[140:143], a[196:199], v[144:147]
v_mfma_f32_16x16x32_bf16 v[148:151], a[140:143], a[200:203], v[148:151]
ds_read_b128 a[248:251], v7 offset:832
ds_read_b64 a[184:185], v6 offset:3392
v_mfma_f32_16x16x32_bf16 v[152:155], a[140:143], a[204:207], v[152:155]
v_mfma_f32_16x16x32_bf16 v[156:159], a[140:143], a[208:211], v[156:159]
ds_read_b64 a[186:187], v6 offset:3400
ds_read_b128 a[252:255], v7 offset:320
v_mfma_f32_16x16x32_bf16 v[144:147], a[144:147], a[192:195], v[144:147]
v_mfma_f32_16x16x32_bf16 v[148:151], a[144:147], a[196:199], v[148:151]
v_mfma_f32_16x16x32_bf16 v[152:155], a[144:147], a[200:203], v[152:155]
ds_read_b64 a[188:189], v6 offset:3904
ds_read_b64 a[190:191], v6 offset:3912
v_mfma_f32_16x16x32_bf16 v[156:159], a[144:147], a[204:207], v[156:159]
v_mfma_f32_16x16x32_bf16 v[148:151], a[148:151], a[192:195], v[148:151]
v_mfma_f32_16x16x32_bf16 v[152:155], a[148:151], a[196:199], v[152:155]
v_mfma_f32_16x16x32_bf16 v[156:159], a[148:151], a[200:203], v[156:159]
v_mfma_f32_16x16x32_bf16 v[152:155], a[152:155], a[192:195], v[152:155]
v_mfma_f32_16x16x32_bf16 v[156:159], a[152:155], a[196:199], v[156:159]
v_mfma_f32_16x16x32_bf16 v[156:159], a[156:159], a[192:195], v[156:159]
s_waitcnt lgkmcnt(0)
v_mfma_f32_16x16x32_bf16 v[128:131], a[160:163], a[224:227], v[128:131]
ds_read_b128 a[192:195], v7 offset:3968
ds_read_b64 a[128:129], v6 offset:384
v_mfma_f32_16x16x32_bf16 v[132:135], a[160:163], a[228:231], v[132:135]
v_mfma_f32_16x16x32_bf16 v[136:139], a[160:163], a[232:235], v[136:139]
ds_read_b64 a[130:131], v6 offset:392
ds_read_b128 a[196:199], v7 offset:3456
v_mfma_f32_16x16x32_bf16 v[140:143], a[160:163], a[236:239], v[140:143]
v_mfma_f32_16x16x32_bf16 v[144:147], a[160:163], a[240:243], v[144:147]
v_mfma_f32_16x16x32_bf16 v[148:151], a[160:163], a[244:247], v[148:151]
ds_read_b64 a[132:133], v6 offset:896
ds_read_b64 a[134:135], v6 offset:904
v_mfma_f32_16x16x32_bf16 v[152:155], a[160:163], a[248:251], v[152:155]
v_mfma_f32_16x16x32_bf16 v[156:159], a[160:163], a[252:255], v[156:159]
ds_read_b128 a[200:203], v7 offset:2944
ds_read_b64 a[136:137], v6 offset:1408
v_mfma_f32_16x16x32_bf16 v[132:135], a[164:167], a[224:227], v[132:135]
v_mfma_f32_16x16x32_bf16 v[136:139], a[164:167], a[228:231], v[136:139]
v_mfma_f32_16x16x32_bf16 v[140:143], a[164:167], a[232:235], v[140:143]
ds_read_b64 a[138:139], v6 offset:1416
ds_read_b128 a[204:207], v7 offset:2432
v_mfma_f32_16x16x32_bf16 v[144:147], a[164:167], a[236:239], v[144:147]
v_lshrrev_b32 v2, 4, v0
v_lshlrev_b32 v2, 10, v2
v_mfma_f32_16x16x32_bf16 v[148:151], a[164:167], a[240:243], v[148:151]
s_add_u32 s85, s59, 4
ds_read_b64 a[140:141], v6 offset:1920
ds_read_b64 a[142:143], v6 offset:1928
v_mfma_f32_16x16x32_bf16 v[152:155], a[164:167], a[244:247], v[152:155]
s_and_b32 s85, s85, 28
v_mfma_f32_16x16x32_bf16 v[156:159], a[164:167], a[248:251], v[156:159]
s_lshl_b32 s85, s85, 10
v_mfma_f32_16x16x32_bf16 v[136:139], a[168:171], a[224:227], v[136:139]
s_add_u32 s85, s85, s74
ds_read_b128 a[208:211], v7 offset:1920
ds_read_b64 a[144:145], v6 offset:2432
v_mfma_f32_16x16x32_bf16 v[140:143], a[168:171], a[228:231], v[140:143]
buffer_load_dword v3, v2, s[44:47], s85 offen sc1
v_mfma_f32_16x16x32_bf16 v[144:147], a[168:171], a[232:235], v[144:147]
v_mfma_f32_16x16x32_bf16 v[148:151], a[168:171], a[236:239], v[148:151]
ds_read_b64 a[146:147], v6 offset:2440
ds_read_b128 a[212:215], v7 offset:1408
v_mfma_f32_16x16x32_bf16 v[152:155], a[168:171], a[240:243], v[152:155]
v_mfma_f32_16x16x32_bf16 v[156:159], a[168:171], a[244:247], v[156:159]
ds_read_b64 a[148:149], v6 offset:2944
ds_read_b64 a[150:151], v6 offset:2952
v_mfma_f32_16x16x32_bf16 v[140:143], a[172:175], a[224:227], v[140:143]
v_mfma_f32_16x16x32_bf16 v[144:147], a[172:175], a[228:231], v[144:147]
v_mfma_f32_16x16x32_bf16 v[148:151], a[172:175], a[232:235], v[148:151]
ds_read_b128 a[216:219], v7 offset:896
ds_read_b64 a[152:153], v6 offset:3456
v_mfma_f32_16x16x32_bf16 v[152:155], a[172:175], a[236:239], v[152:155]
v_mfma_f32_16x16x32_bf16 v[156:159], a[172:175], a[240:243], v[156:159]
ds_read_b64 a[154:155], v6 offset:3464
ds_read_b128 a[220:223], v7 offset:384
v_mfma_f32_16x16x32_bf16 v[144:147], a[176:179], a[224:227], v[144:147]
v_mfma_f32_16x16x32_bf16 v[148:151], a[176:179], a[228:231], v[148:151]
v_mfma_f32_16x16x32_bf16 v[152:155], a[176:179], a[232:235], v[152:155]
ds_read_b64 a[156:157], v6 offset:3968
ds_read_b64 a[158:159], v6 offset:3976
v_mfma_f32_16x16x32_bf16 v[156:159], a[176:179], a[236:239], v[156:159]
v_mfma_f32_16x16x32_bf16 v[148:151], a[180:183], a[224:227], v[148:151]
v_mfma_f32_16x16x32_bf16 v[152:155], a[180:183], a[228:231], v[152:155]
v_mfma_f32_16x16x32_bf16 v[156:159], a[180:183], a[232:235], v[156:159]
v_mfma_f32_16x16x32_bf16 v[152:155], a[184:187], a[224:227], v[152:155]
v_mfma_f32_16x16x32_bf16 v[156:159], a[184:187], a[228:231], v[156:159]
v_mfma_f32_16x16x32_bf16 v[156:159], a[188:191], a[224:227], v[156:159]
s_waitcnt lgkmcnt(0)
v_mfma_f32_16x16x32_bf16 v[128:131], a[128:131], a[192:195], v[128:131]
ds_read_b128 a[224:227], v7 offset:4032
ds_read_b64 a[160:161], v6 offset:448
v_mfma_f32_16x16x32_bf16 v[132:135], a[128:131], a[196:199], v[132:135]
v_mfma_f32_16x16x32_bf16 v[136:139], a[128:131], a[200:203], v[136:139]
ds_read_b64 a[162:163], v6 offset:456
ds_read_b128 a[228:231], v7 offset:3520
v_mfma_f32_16x16x32_bf16 v[140:143], a[128:131], a[204:207], v[140:143]
v_mfma_f32_16x16x32_bf16 v[144:147], a[128:131], a[208:211], v[144:147]
v_mfma_f32_16x16x32_bf16 v[148:151], a[128:131], a[212:215], v[148:151]
ds_read_b64 a[164:165], v6 offset:960
ds_read_b64 a[166:167], v6 offset:968
v_mfma_f32_16x16x32_bf16 v[152:155], a[128:131], a[216:219], v[152:155]
v_mfma_f32_16x16x32_bf16 v[156:159], a[128:131], a[220:223], v[156:159]
ds_read_b128 a[232:235], v7 offset:3008
ds_read_b64 a[168:169], v6 offset:1472
v_mfma_f32_16x16x32_bf16 v[132:135], a[132:135], a[192:195], v[132:135]
v_mfma_f32_16x16x32_bf16 v[136:139], a[132:135], a[196:199], v[136:139]
v_mfma_f32_16x16x32_bf16 v[140:143], a[132:135], a[200:203], v[140:143]
ds_read_b64 a[170:171], v6 offset:1480
ds_read_b128 a[236:239], v7 offset:2496
v_mfma_f32_16x16x32_bf16 v[144:147], a[132:135], a[204:207], v[144:147]
v_mfma_f32_16x16x32_bf16 v[148:151], a[132:135], a[208:211], v[148:151]
ds_read_b64 a[172:173], v6 offset:1984
ds_read_b64 a[174:175], v6 offset:1992
v_mfma_f32_16x16x32_bf16 v[152:155], a[132:135], a[212:215], v[152:155]
v_mfma_f32_16x16x32_bf16 v[156:159], a[132:135], a[216:219], v[156:159]
v_mfma_f32_16x16x32_bf16 v[136:139], a[136:139], a[192:195], v[136:139]
ds_read_b128 a[240:243], v7 offset:1984
ds_read_b64 a[176:177], v6 offset:2496
v_mfma_f32_16x16x32_bf16 v[140:143], a[136:139], a[196:199], v[140:143]
v_mfma_f32_16x16x32_bf16 v[144:147], a[136:139], a[200:203], v[144:147]
v_mfma_f32_16x16x32_bf16 v[148:151], a[136:139], a[204:207], v[148:151]
ds_read_b64 a[178:179], v6 offset:2504
ds_read_b128 a[244:247], v7 offset:1472
v_mfma_f32_16x16x32_bf16 v[152:155], a[136:139], a[208:211], v[152:155]
v_mfma_f32_16x16x32_bf16 v[156:159], a[136:139], a[212:215], v[156:159]
ds_read_b64 a[180:181], v6 offset:3008
ds_read_b64 a[182:183], v6 offset:3016
v_mfma_f32_16x16x32_bf16 v[140:143], a[140:143], a[192:195], v[140:143]
v_mfma_f32_16x16x32_bf16 v[144:147], a[140:143], a[196:199], v[144:147]
v_mfma_f32_16x16x32_bf16 v[148:151], a[140:143], a[200:203], v[148:151]
ds_read_b128 a[248:251], v7 offset:960
ds_read_b64 a[184:185], v6 offset:3520
v_mfma_f32_16x16x32_bf16 v[152:155], a[140:143], a[204:207], v[152:155]
v_mfma_f32_16x16x32_bf16 v[156:159], a[140:143], a[208:211], v[156:159]
ds_read_b64 a[186:187], v6 offset:3528
ds_read_b128 a[252:255], v7 offset:448
s_waitcnt vmcnt(0)
v_cmp_gt_u32 vcc, 2, v3
s_cbranch_vccnz Lspin60
Lback61:
v_mfma_f32_16x16x32_bf16 v[144:147], a[144:147], a[192:195], v[144:147]
s_add_u32 s69, s61, 0
s_and_b32 s69, s69, 3
s_add_u32 s69, s69, s78
s_lshl_b32 s69, s69, 12
s_add_u32 s69, s69, s95
buffer_load_dwordx4 a[0:3], v1, s[44:47], s69 offen sc1
v_mfma_f32_16x16x32_bf16 v[148:151], a[144:147], a[196:199], v[148:151]
buffer_load_dwordx4 a[4:7], v1, s[44:47], s69 offen offset:1024 sc1
v_mfma_f32_16x16x32_bf16 v[152:155], a[144:147], a[200:203], v[152:155]
ds_read_b64 a[188:189], v6 offset:4032
ds_read_b64 a[190:191], v6 offset:4040
v_mfma_f32_16x16x32_bf16 v[156:159], a[144:147], a[204:207], v[156:159]
buffer_load_dwordx4 a[8:11], v1, s[44:47], s69 offen offset:2048 sc1
v_mfma_f32_16x16x32_bf16 v[148:151], a[148:151], a[192:195], v[148:151]
v_mfma_f32_16x16x32_bf16 v[152:155], a[148:151], a[196:199], v[152:155]
buffer_load_dwordx4 a[12:15], v1, s[44:47], s69 offen offset:3072 sc1
v_mfma_f32_16x16x32_bf16 v[156:159], a[148:151], a[200:203], v[156:159]
v_mfma_f32_16x16x32_bf16 v[152:155], a[152:155], a[192:195], v[152:155]
s_add_u32 s69, s69, 0x20000
buffer_load_dwordx4 a[16:19], v1, s[44:47], s69 offen sc1
v_mfma_f32_16x16x32_bf16 v[156:159], a[152:155], a[196:199], v[156:159]
buffer_load_dwordx4 a[20:23], v1, s[44:47], s69 offen offset:1024 sc1
v_mfma_f32_16x16x32_bf16 v[156:159], a[156:159], a[192:195], v[156:159]
s_waitcnt lgkmcnt(0)
v_mfma_f32_16x16x32_bf16 v[128:131], a[160:163], a[224:227], v[128:131]
ds_read_b64_tr_b16 v[192:193], v8 offset:0
buffer_load_dwordx4 a[24:27], v1, s[44:47], s69 offen offset:2048 sc1
v_mfma_f32_16x16x32_bf16 v[132:135], a[160:163], a[228:231], v[132:135]
ds_read_b64_tr_b16 v[194:195], v8 offset:2048
v_mfma_f32_16x16x32_bf16 v[136:139], a[160:163], a[232:235], v[136:139]
ds_read_b64_tr_b16 v[196:197], v9 offset:0
buffer_load_dwordx4 a[28:31], v1, s[44:47], s69 offen offset:3072 sc1
v_mfma_f32_16x16x32_bf16 v[140:143], a[160:163], a[236:239], v[140:143]
ds_read_b64_tr_b16 v[198:199], v9 offset:2048
v_mfma_f32_16x16x32_bf16 v[144:147], a[160:163], a[240:243], v[144:147]
ds_read_b64_tr_b16 v[200:201], v10 offset:0
s_add_u32 s69, s61, 1
s_and_b32 s69, s69, 3
s_add_u32 s69, s69, s78
s_lshl_b32 s69, s69, 12
s_add_u32 s69, s69, s95
buffer_load_dwordx4 a[32:35], v1, s[44:47], s69 offen sc1
v_mfma_f32_16x16x32_bf16 v[148:151], a[160:163], a[244:247], v[148:151]
ds_read_b64_tr_b16 v[202:203], v10 offset:2048
buffer_load_dwordx4 a[36:39], v1, s[44:47], s69 offen offset:1024 sc1
v_mfma_f32_16x16x32_bf16 v[152:155], a[160:163], a[248:251], v[152:155]
ds_read_b64_tr_b16 v[204:205], v11 offset:0
v_mfma_f32_16x16x32_bf16 v[156:159], a[160:163], a[252:255], v[156:159]
ds_read_b64_tr_b16 v[206:207], v11 offset:2048
buffer_load_dwordx4 a[40:43], v1, s[44:47], s69 offen offset:2048 sc1
v_mfma_f32_16x16x32_bf16 v[132:135], a[164:167], a[224:227], v[132:135]
ds_read_b64_tr_b16 v[208:209], v8 offset:4096
v_mfma_f32_16x16x32_bf16 v[136:139], a[164:167], a[228:231], v[136:139]
ds_read_b64_tr_b16 v[210:211], v8 offset:6144
buffer_load_dwordx4 a[44:47], v1, s[44:47], s69 offen offset:3072 sc1
v_mfma_f32_16x16x32_bf16 v[140:143], a[164:167], a[232:235], v[140:143]
ds_read_b64_tr_b16 v[212:213], v9 offset:4096
v_mfma_f32_16x16x32_bf16 v[144:147], a[164:167], a[236:239], v[144:147]
ds_read_b64_tr_b16 v[214:215], v9 offset:6144
s_add_u32 s69, s69, 0x20000
buffer_load_dwordx4 a[48:51], v1, s[44:47], s69 offen sc1
v_mfma_f32_16x16x32_bf16 v[148:151], a[164:167], a[240:243], v[148:151]
ds_read_b64_tr_b16 v[216:217], v10 offset:4096
buffer_load_dwordx4 a[52:55], v1, s[44:47], s69 offen offset:1024 sc1
v_mfma_f32_16x16x32_bf16 v[152:155], a[164:167], a[244:247], v[152:155]
ds_read_b64_tr_b16 v[218:219], v10 offset:6144
v_cvt_pk_bf16_f32 v128, v128, v129
v_cvt_pk_bf16_f32 v129, v130, v131
v_cvt_pk_bf16_f32 v130, v132, v133
v_mfma_f32_16x16x32_bf16 v[156:159], a[164:167], a[248:251], v[156:159]
ds_read_b64_tr_b16 v[220:221], v11 offset:4096
buffer_load_dwordx4 a[56:59], v1, s[44:47], s69 offen offset:2048 sc1
v_cvt_pk_bf16_f32 v131, v134, v135
v_mfma_f32_16x16x32_bf16 v[136:139], a[168:171], a[224:227], v[136:139]
ds_read_b64_tr_b16 v[222:223], v11 offset:6144
v_permlane32_swap_b32 v128, v130
v_permlane32_swap_b32 v129, v131
v_mfma_f32_16x16x32_bf16 v[140:143], a[168:171], a[228:231], v[140:143]
ds_read_b64_tr_b16 v[224:225], v8 offset:8192
buffer_load_dwordx4 a[60:63], v1, s[44:47], s69 offen offset:3072 sc1
v_mfma_f32_16x16x32_bf16 v[144:147], a[168:171], a[232:235], v[144:147]
ds_read_b64_tr_b16 v[226:227], v8 offset:10240
buffer_store_dwordx4 v[128:131], v166, s[44:47], s80 offen sc1
v_mfma_f32_16x16x32_bf16 v[148:151], a[168:171], a[236:239], v[148:151]
ds_read_b64_tr_b16 v[228:229], v9 offset:8192
s_add_u32 s85, s59, 8
s_and_b32 s85, s85, 28
s_lshl_b32 s85, s85, 10
s_add_u32 s85, s85, s74
buffer_load_dword v3, v2, s[44:47], s85 offen sc1
v_mfma_f32_16x16x32_bf16 v[152:155], a[168:171], a[240:243], v[152:155]
ds_read_b64_tr_b16 v[230:231], v9 offset:10240
s_add_u32 s69, s61, 2
s_and_b32 s69, s69, 3
s_add_u32 s69, s69, s78
s_lshl_b32 s69, s69, 12
s_add_u32 s69, s69, s95
buffer_load_dwordx4 a[64:67], v1, s[44:47], s69 offen sc1
v_mfma_f32_16x16x32_bf16 v[156:159], a[168:171], a[244:247], v[156:159]
ds_read_b64_tr_b16 v[232:233], v10 offset:8192
v_mfma_f32_16x16x32_bf16 v[140:143], a[172:175], a[224:227], v[140:143]
ds_read_b64_tr_b16 v[234:235], v10 offset:10240
buffer_load_dwordx4 a[68:71], v1, s[44:47], s69 offen offset:1024 sc1
v_mfma_f32_16x16x32_bf16 v[144:147], a[172:175], a[228:231], v[144:147]
ds_read_b64_tr_b16 v[236:237], v11 offset:8192
v_mfma_f32_16x16x32_bf16 v[148:151], a[172:175], a[232:235], v[148:151]
ds_read_b64_tr_b16 v[238:239], v11 offset:10240
buffer_load_dwordx4 a[72:75], v1, s[44:47], s69 offen offset:2048 sc1
v_mfma_f32_16x16x32_bf16 v[152:155], a[172:175], a[236:239], v[152:155]
ds_read_b64_tr_b16 v[240:241], v8 offset:12288
v_mfma_f32_16x16x32_bf16 v[156:159], a[172:175], a[240:243], v[156:159]
ds_read_b64_tr_b16 v[242:243], v8 offset:14336
buffer_load_dwordx4 a[76:79], v1, s[44:47], s69 offen offset:3072 sc1
v_mfma_f32_16x16x32_bf16 v[144:147], a[176:179], a[224:227], v[144:147]
ds_read_b64_tr_b16 v[244:245], v9 offset:12288
s_add_u32 s69, s69, 0x20000
buffer_load_dwordx4 a[80:83], v1, s[44:47], s69 offen sc1
v_mfma_f32_16x16x32_bf16 v[148:151], a[176:179], a[228:231], v[148:151]
ds_read_b64_tr_b16 v[246:247], v9 offset:14336
v_cvt_pk_bf16_f32 v136, v136, v137
v_cvt_pk_bf16_f32 v137, v138, v139
v_cvt_pk_bf16_f32 v138, v140, v141
v_mfma_f32_16x16x32_bf16 v[152:155], a[176:179], a[232:235], v[152:155]
ds_read_b64_tr_b16 v[248:249], v10 offset:12288
buffer_load_dwordx4 a[84:87], v1, s[44:47], s69 offen offset:1024 sc1
v_cvt_pk_bf16_f32 v139, v142, v143
v_mfma_f32_16x16x32_bf16 v[156:159], a[176:179], a[236:239], v[156:159]
ds_read_b64_tr_b16 v[250:251], v10 offset:14336
v_permlane32_swap_b32 v136, v138
v_permlane32_swap_b32 v137, v139
v_mfma_f32_16x16x32_bf16 v[148:151], a[180:183], a[224:227], v[148:151]
ds_read_b64_tr_b16 v[252:253], v11 offset:12288
buffer_load_dwordx4 a[88:91], v1, s[44:47], s69 offen offset:2048 sc1
v_mfma_f32_16x16x32_bf16 v[152:155], a[180:183], a[228:231], v[152:155]
ds_read_b64_tr_b16 v[254:255], v11 offset:14336
buffer_store_dwordx4 v[136:139], v166, s[44:47], s80 offen offset:1024 sc1
v_mfma_f32_16x16x32_bf16 v[156:159], a[180:183], a[232:235], v[156:159]
buffer_load_dwordx4 a[92:95], v1, s[44:47], s69 offen offset:3072 sc1
v_mfma_f32_16x16x32_bf16 v[152:155], a[184:187], a[224:227], v[152:155]
v_mfma_f32_16x16x32_bf16 v[156:159], a[184:187], a[228:231], v[156:159]
v_mfma_f32_16x16x32_bf16 v[156:159], a[188:191], a[224:227], v[156:159]
v_cvt_pk_bf16_f32 v144, v144, v145
v_cvt_pk_bf16_f32 v145, v146, v147
v_cvt_pk_bf16_f32 v146, v148, v149
v_cvt_pk_bf16_f32 v147, v150, v151
s_nop 0
v_permlane32_swap_b32 v144, v146
v_permlane32_swap_b32 v145, v147
buffer_store_dwordx4 v[144:147], v166, s[44:47], s80 offen offset:2048 sc1
v_cvt_pk_bf16_f32 v152, v152, v153
v_cvt_pk_bf16_f32 v153, v154, v155
v_cvt_pk_bf16_f32 v154, v156, v157
v_cvt_pk_bf16_f32 v155, v158, v159
s_nop 0
v_permlane32_swap_b32 v152, v154
v_permlane32_swap_b32 v153, v155
buffer_store_dwordx4 v[152:155], v166, s[44:47], s80 offen offset:3072 sc1
s_waitcnt vmcnt(21) lgkmcnt(0)
s_barrier
v_mfma_f32_16x16x32_bf16 v[80:83], v[192:195], a[0:3], 0
ds_read_b64_tr_b16 v[128:129], v8 offset:16384
ds_read_b64_tr_b16 v[130:131], v8 offset:18432
s_add_u32 s71, s61, 0
s_and_b32 s71, s71, 3
s_add_u32 s71, s71, s79
s_lshl_b32 s71, s71, 18
s_add_u32 s71, s71, s94
s_add_u32 m0, s77, 0
s_add_u32 s72, s71, 0
buffer_load_dwordx4 v15, s[24:27], s72 offen lds
v_mfma_f32_16x16x32_bf16 v[96:99], v[192:195], a[16:19], 0
ds_read_b64_tr_b16 v[132:133], v9 offset:16384
v_mfma_f32_16x16x32_bf16 v[100:103], v[196:199], a[16:19], 0
ds_read_b64_tr_b16 v[134:135], v9 offset:18432
s_add_u32 s72, s71, 15360
buffer_load_dwordx4 v15, s[24:27], s72 offen offset:1024 lds
v_mfma_f32_16x16x32_bf16 v[84:87], v[196:199], a[0:3], 0
ds_read_b64_tr_b16 v[136:137], v10 offset:16384
v_mfma_f32_16x16x32_bf16 v[88:91], v[200:203], a[0:3], 0
ds_read_b64_tr_b16 v[138:139], v10 offset:18432
ds_read_b64_tr_b16 v[140:141], v11 offset:16384
s_add_u32 s72, s71, 30720
buffer_load_dwordx4 v15, s[24:27], s72 offen offset:2048 lds
v_mfma_f32_16x16x32_bf16 v[104:107], v[200:203], a[16:19], 0
ds_read_b64_tr_b16 v[142:143], v11 offset:18432
v_mfma_f32_16x16x32_bf16 v[108:111], v[204:207], a[16:19], 0
ds_read_b64_tr_b16 v[144:145], v8 offset:20480
v_mfma_f32_16x16x32_bf16 v[92:95], v[204:207], a[0:3], 0
ds_read_b64_tr_b16 v[146:147], v8 offset:22528
s_add_u32 s72, s71, 46080
buffer_load_dwordx4 v15, s[24:27], s72 offen offset:3072 lds
v_mfma_f32_16x16x32_bf16 v[80:83], v[208:211], a[4:7], v[80:83]
ds_read_b64_tr_b16 v[148:149], v9 offset:20480
ds_read_b64_tr_b16 v[150:151], v9 offset:22528
v_mfma_f32_16x16x32_bf16 v[96:99], v[208:211], a[20:23], v[96:99]
ds_read_b64_tr_b16 v[152:153], v10 offset:20480
s_add_u32 s69, s61, 3
s_and_b32 s69, s69, 3
s_add_u32 s69, s69, s78
s_lshl_b32 s69, s69, 12
s_add_u32 s69, s69, s95
buffer_load_dwordx4 a[96:99], v1, s[44:47], s69 offen sc1
v_mfma_f32_16x16x32_bf16 v[100:103], v[212:215], a[20:23], v[100:103]
ds_read_b64_tr_b16 v[154:155], v10 offset:22528
v_mfma_f32_16x16x32_bf16 v[84:87], v[212:215], a[4:7], v[84:87]
ds_read_b64_tr_b16 v[156:157], v11 offset:20480
buffer_load_dwordx4 a[100:103], v1, s[44:47], s69 offen offset:1024 sc1
v_mfma_f32_16x16x32_bf16 v[88:91], v[216:219], a[4:7], v[88:91]
ds_read_b64_tr_b16 v[158:159], v11 offset:22528
v_mfma_f32_16x16x32_bf16 v[104:107], v[216:219], a[20:23], v[104:107]
ds_read_b64_tr_b16 v[160:161], v8 offset:24576
ds_read_b64_tr_b16 v[162:163], v8 offset:26624
v_mfma_f32_16x16x32_bf16 v[108:111], v[220:223], a[20:23], v[108:111]
ds_read_b64_tr_b16 v[164:165], v9 offset:24576
buffer_load_dwordx4 a[104:107], v1, s[44:47], s69 offen offset:2048 sc1
v_mfma_f32_16x16x32_bf16 v[92:95], v[220:223], a[4:7], v[92:95]
ds_read_b64_tr_b16 v[166:167], v9 offset:26624
v_mfma_f32_16x16x32_bf16 v[80:83], v[224:227], a[8:11], v[80:83]
ds_read_b64_tr_b16 v[168:169], v10 offset:24576
buffer_load_dwordx4 a[108:111], v1, s[44:47], s69 offen offset:3072 sc1
v_mfma_f32_16x16x32_bf16 v[96:99], v[224:227], a[24:27], v[96:99]
ds_read_b64_tr_b16 v[170:171], v10 offset:26624
ds_read_b64_tr_b16 v[172:173], v11 offset:24576
v_mfma_f32_16x16x32_bf16 v[100:103], v[228:231], a[24:27], v[100:103]
ds_read_b64_tr_b16 v[174:175], v11 offset:26624
s_add_u32 s69, s69, 0x20000
buffer_load_dwordx4 a[112:115], v1, s[44:47], s69 offen sc1
v_mfma_f32_16x16x32_bf16 v[84:87], v[228:231], a[8:11], v[84:87]
ds_read_b64_tr_b16 v[176:177], v8 offset:28672
v_mfma_f32_16x16x32_bf16 v[88:91], v[232:235], a[8:11], v[88:91]
ds_read_b64_tr_b16 v[178:179], v8 offset:30720
v_mfma_f32_16x16x32_bf16 v[104:107], v[232:235], a[24:27], v[104:107]
ds_read_b64_tr_b16 v[180:181], v9 offset:28672
ds_read_b64_tr_b16 v[182:183], v9 offset:30720
buffer_load_dwordx4 a[116:119], v1, s[44:47], s69 offen offset:1024 sc1
v_mfma_f32_16x16x32_bf16 v[108:111], v[236:239], a[24:27], v[108:111]
ds_read_b64_tr_b16 v[184:185], v10 offset:28672
v_mfma_f32_16x16x32_bf16 v[92:95], v[236:239], a[8:11], v[92:95]
ds_read_b64_tr_b16 v[186:187], v10 offset:30720
buffer_load_dwordx4 a[120:123], v1, s[44:47], s69 offen offset:2048 sc1
v_mfma_f32_16x16x32_bf16 v[80:83], v[240:243], a[12:15], v[80:83]
ds_read_b64_tr_b16 v[188:189], v11 offset:28672
v_mfma_f32_16x16x32_bf16 v[96:99], v[240:243], a[28:31], v[96:99]
ds_read_b64_tr_b16 v[190:191], v11 offset:30720
buffer_load_dwordx4 a[124:127], v1, s[44:47], s69 offen offset:3072 sc1
v_mfma_f32_16x16x32_bf16 v[100:103], v[244:247], a[28:31], v[100:103]
v_mfma_f32_16x16x32_bf16 v[84:87], v[244:247], a[12:15], v[84:87]
v_mfma_f32_16x16x32_bf16 v[88:91], v[248:251], a[12:15], v[88:91]
v_mfma_f32_16x16x32_bf16 v[104:107], v[248:251], a[28:31], v[104:107]
v_mfma_f32_16x16x32_bf16 v[108:111], v[252:255], a[28:31], v[108:111]
s_waitcnt vmcnt(25) lgkmcnt(0)
v_mfma_f32_16x16x32_bf16 v[92:95], v[252:255], a[12:15], v[92:95]
s_barrier
s_waitcnt vmcnt(23)
v_cmp_gt_u32 vcc, 2, v3
s_cbranch_vccnz Lspin63
Lback64:
v_mfma_f32_16x16x32_bf16 v[80:83], v[128:131], a[32:35], v[80:83]
ds_read_b64_tr_b16 v[192:193], v8 offset:32768
ds_read_b64_tr_b16 v[194:195], v8 offset:34816
s_add_u32 s71, s61, 1
s_and_b32 s71, s71, 3
s_add_u32 s71, s71, s79
s_lshl_b32 s71, s71, 18
s_add_u32 s71, s71, s94
s_add_u32 m0, s77, 16384
s_add_u32 s72, s71, 0
buffer_load_dwordx4 v15, s[24:27], s72 offen lds
v_mfma_f32_16x16x32_bf16 v[96:99], v[128:131], a[48:51], v[96:99]
ds_read_b64_tr_b16 v[196:197], v9 offset:32768
v_mfma_f32_16x16x32_bf16 v[100:103], v[132:135], a[48:51], v[100:103]
ds_read_b64_tr_b16 v[198:199], v9 offset:34816
s_add_u32 s72, s71, 15360
buffer_load_dwordx4 v15, s[24:27], s72 offen offset:1024 lds
v_mfma_f32_16x16x32_bf16 v[84:87], v[132:135], a[32:35], v[84:87]
ds_read_b64_tr_b16 v[200:201], v10 offset:32768
v_mfma_f32_16x16x32_bf16 v[88:91], v[136:139], a[32:35], v[88:91]
ds_read_b64_tr_b16 v[202:203], v10 offset:34816
ds_read_b64_tr_b16 v[204:205], v11 offset:32768
s_add_u32 s72, s71, 30720
buffer_load_dwordx4 v15, s[24:27], s72 offen offset:2048 lds
v_mfma_f32_16x16x32_bf16 v[104:107], v[136:139], a[48:51], v[104:107]
ds_read_b64_tr_b16 v[206:207], v11 offset:34816
v_mfma_f32_16x16x32_bf16 v[108:111], v[140:143], a[48:51], v[108:111]
ds_read_b64_tr_b16 v[208:209], v8 offset:36864
v_mfma_f32_16x16x32_bf16 v[92:95], v[140:143], a[32:35], v[92:95]
ds_read_b64_tr_b16 v[210:211], v8 offset:38912
s_add_u32 s72, s71, 46080
buffer_load_dwordx4 v15, s[24:27], s72 offen offset:3072 lds
v_mfma_f32_16x16x32_bf16 v[80:83], v[144:147], a[36:39], v[80:83]
ds_read_b64_tr_b16 v[212:213], v9 offset:36864
ds_read_b64_tr_b16 v[214:215], v9 offset:38912
v_mfma_f32_16x16x32_bf16 v[96:99], v[144:147], a[52:55], v[96:99]
ds_read_b64_tr_b16 v[216:217], v10 offset:36864
s_add_u32 s69, s61, 0
s_and_b32 s69, s69, 3
s_add_u32 s69, s69, s79
s_lshl_b32 s69, s69, 12
s_add_u32 s69, s69, s95
buffer_load_dwordx4 a[0:3], v1, s[44:47], s69 offen sc1
v_mfma_f32_16x16x32_bf16 v[100:103], v[148:151], a[52:55], v[100:103]
ds_read_b64_tr_b16 v[218:219], v10 offset:38912
v_mfma_f32_16x16x32_bf16 v[84:87], v[148:151], a[36:39], v[84:87]
ds_read_b64_tr_b16 v[220:221], v11 offset:36864
buffer_load_dwordx4 a[4:7], v1, s[44:47], s69 offen offset:1024 sc1
v_mfma_f32_16x16x32_bf16 v[88:91], v[152:155], a[36:39], v[88:91]
ds_read_b64_tr_b16 v[222:223], v11 offset:38912
v_mfma_f32_16x16x32_bf16 v[104:107], v[152:155], a[52:55], v[104:107]
ds_read_b64_tr_b16 v[224:225], v8 offset:40960
ds_read_b64_tr_b16 v[226:227], v8 offset:43008
v_mfma_f32_16x16x32_bf16 v[108:111], v[156:159], a[52:55], v[108:111]
ds_read_b64_tr_b16 v[228:229], v9 offset:40960
buffer_load_dwordx4 a[8:11], v1, s[44:47], s69 offen offset:2048 sc1
v_mfma_f32_16x16x32_bf16 v[92:95], v[156:159], a[36:39], v[92:95]
ds_read_b64_tr_b16 v[230:231], v9 offset:43008
v_mfma_f32_16x16x32_bf16 v[80:83], v[160:163], a[40:43], v[80:83]
ds_read_b64_tr_b16 v[232:233], v10 offset:40960
buffer_load_dwordx4 a[12:15], v1, s[44:47], s69 offen offset:3072 sc1
v_mfma_f32_16x16x32_bf16 v[96:99], v[160:163], a[56:59], v[96:99]
ds_read_b64_tr_b16 v[234:235], v10 offset:43008
ds_read_b64_tr_b16 v[236:237], v11 offset:40960
v_mfma_f32_16x16x32_bf16 v[100:103], v[164:167], a[56:59], v[100:103]
ds_read_b64_tr_b16 v[238:239], v11 offset:43008
s_add_u32 s69, s69, 0x20000
buffer_load_dwordx4 a[16:19], v1, s[44:47], s69 offen sc1
v_mfma_f32_16x16x32_bf16 v[84:87], v[164:167], a[40:43], v[84:87]
ds_read_b64_tr_b16 v[240:241], v8 offset:45056
v_mfma_f32_16x16x32_bf16 v[88:91], v[168:171], a[40:43], v[88:91]
ds_read_b64_tr_b16 v[242:243], v8 offset:47104
v_mfma_f32_16x16x32_bf16 v[104:107], v[168:171], a[56:59], v[104:107]
ds_read_b64_tr_b16 v[244:245], v9 offset:45056
ds_read_b64_tr_b16 v[246:247], v9 offset:47104
buffer_load_dwordx4 a[20:23], v1, s[44:47], s69 offen offset:1024 sc1
v_mfma_f32_16x16x32_bf16 v[108:111], v[172:175], a[56:59], v[108:111]
ds_read_b64_tr_b16 v[248:249], v10 offset:45056
v_mfma_f32_16x16x32_bf16 v[92:95], v[172:175], a[40:43], v[92:95]
ds_read_b64_tr_b16 v[250:251], v10 offset:47104
buffer_load_dwordx4 a[24:27], v1, s[44:47], s69 offen offset:2048 sc1
v_mfma_f32_16x16x32_bf16 v[80:83], v[176:179], a[44:47], v[80:83]
ds_read_b64_tr_b16 v[252:253], v11 offset:45056
v_mfma_f32_16x16x32_bf16 v[96:99], v[176:179], a[60:63], v[96:99]
ds_read_b64_tr_b16 v[254:255], v11 offset:47104
buffer_load_dwordx4 a[28:31], v1, s[44:47], s69 offen offset:3072 sc1
v_mfma_f32_16x16x32_bf16 v[100:103], v[180:183], a[60:63], v[100:103]
v_mfma_f32_16x16x32_bf16 v[84:87], v[180:183], a[44:47], v[84:87]
v_mfma_f32_16x16x32_bf16 v[88:91], v[184:187], a[44:47], v[88:91]
v_mfma_f32_16x16x32_bf16 v[104:107], v[184:187], a[60:63], v[104:107]
v_mfma_f32_16x16x32_bf16 v[108:111], v[188:191], a[60:63], v[108:111]
s_waitcnt vmcnt(26) lgkmcnt(0)
v_mfma_f32_16x16x32_bf16 v[92:95], v[188:191], a[44:47], v[92:95]
s_barrier
v_mfma_f32_16x16x32_bf16 v[80:83], v[192:195], a[64:67], v[80:83]
ds_read_b64_tr_b16 v[128:129], v8 offset:49152
ds_read_b64_tr_b16 v[130:131], v8 offset:51200
s_add_u32 s85, s59, 12
s_and_b32 s85, s85, 28
s_lshl_b32 s85, s85, 10
s_add_u32 s85, s85, s74
buffer_load_dword v3, v2, s[44:47], s85 offen sc1
v_mfma_f32_16x16x32_bf16 v[96:99], v[192:195], a[80:83], v[96:99]
ds_read_b64_tr_b16 v[132:133], v9 offset:49152
v_mfma_f32_16x16x32_bf16 v[100:103], v[196:199], a[80:83], v[100:103]
ds_read_b64_tr_b16 v[134:135], v9 offset:51200
s_add_u32 s71, s61, 2
s_and_b32 s71, s71, 3
s_add_u32 s71, s71, s79
s_lshl_b32 s71, s71, 18
s_add_u32 s71, s71, s94
s_add_u32 m0, s77, 32768
s_add_u32 s72, s71, 0
buffer_load_dwordx4 v15, s[24:27], s72 offen lds
v_mfma_f32_16x16x32_bf16 v[84:87], v[196:199], a[64:67], v[84:87]
ds_read_b64_tr_b16 v[136:137], v10 offset:49152
v_mfma_f32_16x16x32_bf16 v[88:91], v[200:203], a[64:67], v[88:91]
ds_read_b64_tr_b16 v[138:139], v10 offset:51200
ds_read_b64_tr_b16 v[140:141], v11 offset:49152
s_add_u32 s72, s71, 15360
buffer_load_dwordx4 v15, s[24:27], s72 offen offset:1024 lds
v_mfma_f32_16x16x32_bf16 v[104:107], v[200:203], a[80:83], v[104:107]
ds_read_b64_tr_b16 v[142:143], v11 offset:51200
v_mfma_f32_16x16x32_bf16 v[108:111], v[204:207], a[80:83], v[108:111]
ds_read_b64_tr_b16 v[144:145], v8 offset:53248
s_add_u32 s72, s71, 30720
buffer_load_dwordx4 v15, s[24:27], s72 offen offset:2048 lds
v_mfma_f32_16x16x32_bf16 v[92:95], v[204:207], a[64:67], v[92:95]
ds_read_b64_tr_b16 v[146:147], v8 offset:55296
v_mfma_f32_16x16x32_bf16 v[80:83], v[208:211], a[68:71], v[80:83]
ds_read_b64_tr_b16 v[148:149], v9 offset:53248
ds_read_b64_tr_b16 v[150:151], v9 offset:55296
s_add_u32 s72, s71, 46080
buffer_load_dwordx4 v15, s[24:27], s72 offen offset:3072 lds
v_mfma_f32_16x16x32_bf16 v[96:99], v[208:211], a[84:87], v[96:99]
ds_read_b64_tr_b16 v[152:153], v10 offset:53248
v_mfma_f32_16x16x32_bf16 v[100:103], v[212:215], a[84:87], v[100:103]
ds_read_b64_tr_b16 v[154:155], v10 offset:55296
s_add_u32 s69, s61, 1
s_and_b32 s69, s69, 3
s_add_u32 s69, s69, s79
s_lshl_b32 s69, s69, 12
s_add_u32 s69, s69, s95
buffer_load_dwordx4 a[32:35], v1, s[44:47], s69 offen sc1
v_mfma_f32_16x16x32_bf16 v[84:87], v[212:215], a[68:71], v[84:87]
ds_read_b64_tr_b16 v[156:157], v11 offset:53248
v_mfma_f32_16x16x32_bf16 v[88:91], v[216:219], a[68:71], v[88:91]
ds_read_b64_tr_b16 v[158:159], v11 offset:55296
buffer_load_dwordx4 a[36:39], v1, s[44:47], s69 offen offset:1024 sc1
v_mfma_f32_16x16x32_bf16 v[104:107], v[216:219], a[84:87], v[104:107]
ds_read_b64_tr_b16 v[160:161], v8 offset:57344
ds_read_b64_tr_b16 v[162:163], v8 offset:59392
v_mfma_f32_16x16x32_bf16 v[108:111], v[220:223], a[84:87], v[108:111]
ds_read_b64_tr_b16 v[164:165], v9 offset:57344
v_mfma_f32_16x16x32_bf16 v[92:95], v[220:223], a[68:71], v[92:95]
ds_read_b64_tr_b16 v[166:167], v9 offset:59392
buffer_load_dwordx4 a[40:43], v1, s[44:47], s69 offen offset:2048 sc1
v_mfma_f32_16x16x32_bf16 v[80:83], v[224:227], a[72:75], v[80:83]
ds_read_b64_tr_b16 v[168:169], v10 offset:57344
v_mfma_f32_16x16x32_bf16 v[96:99], v[224:227], a[88:91], v[96:99]
ds_read_b64_tr_b16 v[170:171], v10 offset:59392
ds_read_b64_tr_b16 v[172:173], v11 offset:57344
buffer_load_dwordx4 a[44:47], v1, s[44:47], s69 offen offset:3072 sc1
v_mfma_f32_16x16x32_bf16 v[100:103], v[228:231], a[88:91], v[100:103]
ds_read_b64_tr_b16 v[174:175], v11 offset:59392
v_mfma_f32_16x16x32_bf16 v[84:87], v[228:231], a[72:75], v[84:87]
ds_read_b64_tr_b16 v[176:177], v8 offset:61440
s_add_u32 s69, s69, 0x20000
buffer_load_dwordx4 a[48:51], v1, s[44:47], s69 offen sc1
v_mfma_f32_16x16x32_bf16 v[88:91], v[232:235], a[72:75], v[88:91]
ds_read_b64_tr_b16 v[178:179], v8 offset:63488
v_mfma_f32_16x16x32_bf16 v[104:107], v[232:235], a[88:91], v[104:107]
ds_read_b64_tr_b16 v[180:181], v9 offset:61440
ds_read_b64_tr_b16 v[182:183], v9 offset:63488
buffer_load_dwordx4 a[52:55], v1, s[44:47], s69 offen offset:1024 sc1
v_mfma_f32_16x16x32_bf16 v[108:111], v[236:239], a[88:91], v[108:111]
ds_read_b64_tr_b16 v[184:185], v10 offset:61440
v_mfma_f32_16x16x32_bf16 v[92:95], v[236:239], a[72:75], v[92:95]
ds_read_b64_tr_b16 v[186:187], v10 offset:63488
buffer_load_dwordx4 a[56:59], v1, s[44:47], s69 offen offset:2048 sc1
v_mfma_f32_16x16x32_bf16 v[80:83], v[240:243], a[76:79], v[80:83]
ds_read_b64_tr_b16 v[188:189], v11 offset:61440
v_mfma_f32_16x16x32_bf16 v[96:99], v[240:243], a[92:95], v[96:99]
ds_read_b64_tr_b16 v[190:191], v11 offset:63488
buffer_load_dwordx4 a[60:63], v1, s[44:47], s69 offen offset:3072 sc1
v_mfma_f32_16x16x32_bf16 v[100:103], v[244:247], a[92:95], v[100:103]
v_mfma_f32_16x16x32_bf16 v[84:87], v[244:247], a[76:79], v[84:87]
v_mfma_f32_16x16x32_bf16 v[88:91], v[248:251], a[76:79], v[88:91]
v_mfma_f32_16x16x32_bf16 v[104:107], v[248:251], a[92:95], v[104:107]
v_mfma_f32_16x16x32_bf16 v[108:111], v[252:255], a[92:95], v[108:111]
s_waitcnt vmcnt(25) lgkmcnt(0)
v_mfma_f32_16x16x32_bf16 v[92:95], v[252:255], a[76:79], v[92:95]
s_barrier
v_mfma_f32_16x16x32_bf16 v[80:83], v[128:131], a[96:99], v[80:83]
ds_read_b64_tr_b16 v[192:193], v8 offset:0
ds_read_b64_tr_b16 v[194:195], v8 offset:2048
s_add_u32 s71, s61, 3
s_and_b32 s71, s71, 3
s_add_u32 s71, s71, s79
s_lshl_b32 s71, s71, 18
s_add_u32 s71, s71, s94
s_add_u32 m0, s77, 49152
s_add_u32 s72, s71, 0
buffer_load_dwordx4 v15, s[24:27], s72 offen lds
v_or_b32 v112, s58, v0
v_mov_b32 v113, 3
v_min_u32 v112, 1, v112
v_lshlrev_b32 v112, 30, v112
buffer_store_dword v113, v112, s[44:47], s91 offen sc1
v_mfma_f32_16x16x32_bf16 v[96:99], v[128:131], a[112:115], v[96:99]
ds_read_b64_tr_b16 v[196:197], v9 offset:0
v_mfma_f32_16x16x32_bf16 v[100:103], v[132:135], a[112:115], v[100:103]
ds_read_b64_tr_b16 v[198:199], v9 offset:2048
s_add_u32 s72, s71, 15360
buffer_load_dwordx4 v15, s[24:27], s72 offen offset:1024 lds
v_mfma_f32_16x16x32_bf16 v[84:87], v[132:135], a[96:99], v[84:87]
ds_read_b64_tr_b16 v[200:201], v10 offset:0
v_mfma_f32_16x16x32_bf16 v[88:91], v[136:139], a[96:99], v[88:91]
ds_read_b64_tr_b16 v[202:203], v10 offset:2048
ds_read_b64_tr_b16 v[204:205], v11 offset:0
s_add_u32 s72, s71, 30720
buffer_load_dwordx4 v15, s[24:27], s72 offen offset:2048 lds
v_mfma_f32_16x16x32_bf16 v[104:107], v[136:139], a[112:115], v[104:107]
ds_read_b64_tr_b16 v[206:207], v11 offset:2048
v_mfma_f32_16x16x32_bf16 v[108:111], v[140:143], a[112:115], v[108:111]
ds_read_b64_tr_b16 v[208:209], v8 offset:4096
v_mfma_f32_16x16x32_bf16 v[92:95], v[140:143], a[96:99], v[92:95]
ds_read_b64_tr_b16 v[210:211], v8 offset:6144
s_add_u32 s72, s71, 46080
buffer_load_dwordx4 v15, s[24:27], s72 offen offset:3072 lds
v_mfma_f32_16x16x32_bf16 v[80:83], v[144:147], a[100:103], v[80:83]
ds_read_b64_tr_b16 v[212:213], v9 offset:4096
ds_read_b64_tr_b16 v[214:215], v9 offset:6144
v_mfma_f32_16x16x32_bf16 v[96:99], v[144:147], a[116:119], v[96:99]
ds_read_b64_tr_b16 v[216:217], v10 offset:4096
s_add_u32 s69, s61, 2
s_and_b32 s69, s69, 3
s_add_u32 s69, s69, s79
s_lshl_b32 s69, s69, 12
s_add_u32 s69, s69, s95
buffer_load_dwordx4 a[64:67], v1, s[44:47], s69 offen sc1
v_mfma_f32_16x16x32_bf16 v[100:103], v[148:151], a[116:119], v[100:103]
ds_read_b64_tr_b16 v[218:219], v10 offset:6144
v_mfma_f32_16x16x32_bf16 v[84:87], v[148:151], a[100:103], v[84:87]
ds_read_b64_tr_b16 v[220:221], v11 offset:4096
buffer_load_dwordx4 a[68:71], v1, s[44:47], s69 offen offset:1024 sc1
v_mfma_f32_16x16x32_bf16 v[88:91], v[152:155], a[100:103], v[88:91]
ds_read_b64_tr_b16 v[222:223], v11 offset:6144
v_mfma_f32_16x16x32_bf16 v[104:107], v[152:155], a[116:119], v[104:107]
ds_read_b64_tr_b16 v[224:225], v8 offset:8192
ds_read_b64_tr_b16 v[226:227], v8 offset:10240
v_mfma_f32_16x16x32_bf16 v[108:111], v[156:159], a[116:119], v[108:111]
ds_read_b64_tr_b16 v[228:229], v9 offset:8192
buffer_load_dwordx4 a[72:75], v1, s[44:47], s69 offen offset:2048 sc1
v_mfma_f32_16x16x32_bf16 v[92:95], v[156:159], a[100:103], v[92:95]
ds_read_b64_tr_b16 v[230:231], v9 offset:10240
v_mfma_f32_16x16x32_bf16 v[80:83], v[160:163], a[104:107], v[80:83]
ds_read_b64_tr_b16 v[232:233], v10 offset:8192
buffer_load_dwordx4 a[76:79], v1, s[44:47], s69 offen offset:3072 sc1
v_mfma_f32_16x16x32_bf16 v[96:99], v[160:163], a[120:123], v[96:99]
ds_read_b64_tr_b16 v[234:235], v10 offset:10240
ds_read_b64_tr_b16 v[236:237], v11 offset:8192
v_mfma_f32_16x16x32_bf16 v[100:103], v[164:167], a[120:123], v[100:103]
ds_read_b64_tr_b16 v[238:239], v11 offset:10240
s_add_u32 s69, s69, 0x20000
buffer_load_dwordx4 a[80:83], v1, s[44:47], s69 offen sc1
v_mfma_f32_16x16x32_bf16 v[84:87], v[164:167], a[104:107], v[84:87]
ds_read_b64_tr_b16 v[240:241], v8 offset:12288
v_mfma_f32_16x16x32_bf16 v[88:91], v[168:171], a[104:107], v[88:91]
ds_read_b64_tr_b16 v[242:243], v8 offset:14336
v_mfma_f32_16x16x32_bf16 v[104:107], v[168:171], a[120:123], v[104:107]
ds_read_b64_tr_b16 v[244:245], v9 offset:12288
ds_read_b64_tr_b16 v[246:247], v9 offset:14336
buffer_load_dwordx4 a[84:87], v1, s[44:47], s69 offen offset:1024 sc1
v_mfma_f32_16x16x32_bf16 v[108:111], v[172:175], a[120:123], v[108:111]
ds_read_b64_tr_b16 v[248:249], v10 offset:12288
v_mfma_f32_16x16x32_bf16 v[92:95], v[172:175], a[104:107], v[92:95]
ds_read_b64_tr_b16 v[250:251], v10 offset:14336
buffer_load_dwordx4 a[88:91], v1, s[44:47], s69 offen offset:2048 sc1
v_mfma_f32_16x16x32_bf16 v[80:83], v[176:179], a[108:111], v[80:83]
ds_read_b64_tr_b16 v[252:253], v11 offset:12288
v_mfma_f32_16x16x32_bf16 v[96:99], v[176:179], a[124:127], v[96:99]
ds_read_b64_tr_b16 v[254:255], v11 offset:14336
buffer_load_dwordx4 a[92:95], v1, s[44:47], s69 offen offset:3072 sc1
v_mfma_f32_16x16x32_bf16 v[100:103], v[180:183], a[124:127], v[100:103]
v_mfma_f32_16x16x32_bf16 v[84:87], v[180:183], a[108:111], v[84:87]
v_mfma_f32_16x16x32_bf16 v[88:91], v[184:187], a[108:111], v[88:91]
v_mfma_f32_16x16x32_bf16 v[104:107], v[184:187], a[124:127], v[104:107]
v_mfma_f32_16x16x32_bf16 v[108:111], v[188:191], a[124:127], v[108:111]
s_waitcnt vmcnt(26) lgkmcnt(0)
v_mfma_f32_16x16x32_bf16 v[92:95], v[188:191], a[108:111], v[92:95]
s_barrier
s_add_u32 s78, s59, 12
s_and_b32 s78, s78, 28
v_mfma_f32_16x16x32_bf16 v[80:83], v[192:195], a[0:3], v[80:83]
ds_read_b64_tr_b16 v[128:129], v8 offset:16384
ds_read_b64_tr_b16 v[130:131], v8 offset:18432
s_add_u32 s71, s61, 0
s_and_b32 s71, s71, 3
s_add_u32 s71, s71, s78
s_lshl_b32 s71, s71, 18
s_add_u32 s71, s71, s94
s_add_u32 m0, s77, 0
s_add_u32 s72, s71, 0
buffer_load_dwordx4 v15, s[24:27], s72 offen lds
v_mfma_f32_16x16x32_bf16 v[96:99], v[192:195], a[16:19], v[96:99]
ds_read_b64_tr_b16 v[132:133], v9 offset:16384
v_mfma_f32_16x16x32_bf16 v[100:103], v[196:199], a[16:19], v[100:103]
ds_read_b64_tr_b16 v[134:135], v9 offset:18432
s_add_u32 s72, s71, 15360
buffer_load_dwordx4 v15, s[24:27], s72 offen offset:1024 lds
v_mfma_f32_16x16x32_bf16 v[84:87], v[196:199], a[0:3], v[84:87]
ds_read_b64_tr_b16 v[136:137], v10 offset:16384
v_mfma_f32_16x16x32_bf16 v[88:91], v[200:203], a[0:3], v[88:91]
ds_read_b64_tr_b16 v[138:139], v10 offset:18432
ds_read_b64_tr_b16 v[140:141], v11 offset:16384
s_add_u32 s72, s71, 30720
buffer_load_dwordx4 v15, s[24:27], s72 offen offset:2048 lds
v_mfma_f32_16x16x32_bf16 v[104:107], v[200:203], a[16:19], v[104:107]
ds_read_b64_tr_b16 v[142:143], v11 offset:18432
v_mfma_f32_16x16x32_bf16 v[108:111], v[204:207], a[16:19], v[108:111]
ds_read_b64_tr_b16 v[144:145], v8 offset:20480
v_mfma_f32_16x16x32_bf16 v[92:95], v[204:207], a[0:3], v[92:95]
ds_read_b64_tr_b16 v[146:147], v8 offset:22528
s_add_u32 s72, s71, 46080
buffer_load_dwordx4 v15, s[24:27], s72 offen offset:3072 lds
v_mfma_f32_16x16x32_bf16 v[80:83], v[208:211], a[4:7], v[80:83]
ds_read_b64_tr_b16 v[148:149], v9 offset:20480
ds_read_b64_tr_b16 v[150:151], v9 offset:22528
v_mfma_f32_16x16x32_bf16 v[96:99], v[208:211], a[20:23], v[96:99]
ds_read_b64_tr_b16 v[152:153], v10 offset:20480
s_add_u32 s69, s61, 3
s_and_b32 s69, s69, 3
s_add_u32 s69, s69, s79
s_lshl_b32 s69, s69, 12
s_add_u32 s69, s69, s95
buffer_load_dwordx4 a[96:99], v1, s[44:47], s69 offen sc1
v_mfma_f32_16x16x32_bf16 v[100:103], v[212:215], a[20:23], v[100:103]
ds_read_b64_tr_b16 v[154:155], v10 offset:22528
v_mfma_f32_16x16x32_bf16 v[84:87], v[212:215], a[4:7], v[84:87]
ds_read_b64_tr_b16 v[156:157], v11 offset:20480
buffer_load_dwordx4 a[100:103], v1, s[44:47], s69 offen offset:1024 sc1
v_mfma_f32_16x16x32_bf16 v[88:91], v[216:219], a[4:7], v[88:91]
ds_read_b64_tr_b16 v[158:159], v11 offset:22528
v_mfma_f32_16x16x32_bf16 v[104:107], v[216:219], a[20:23], v[104:107]
ds_read_b64_tr_b16 v[160:161], v8 offset:24576
ds_read_b64_tr_b16 v[162:163], v8 offset:26624
v_mfma_f32_16x16x32_bf16 v[108:111], v[220:223], a[20:23], v[108:111]
ds_read_b64_tr_b16 v[164:165], v9 offset:24576
buffer_load_dwordx4 a[104:107], v1, s[44:47], s69 offen offset:2048 sc1
v_mfma_f32_16x16x32_bf16 v[92:95], v[220:223], a[4:7], v[92:95]
ds_read_b64_tr_b16 v[166:167], v9 offset:26624
v_mfma_f32_16x16x32_bf16 v[80:83], v[224:227], a[8:11], v[80:83]
ds_read_b64_tr_b16 v[168:169], v10 offset:24576
buffer_load_dwordx4 a[108:111], v1, s[44:47], s69 offen offset:3072 sc1
v_mfma_f32_16x16x32_bf16 v[96:99], v[224:227], a[24:27], v[96:99]
ds_read_b64_tr_b16 v[170:171], v10 offset:26624
ds_read_b64_tr_b16 v[172:173], v11 offset:24576
v_mfma_f32_16x16x32_bf16 v[100:103], v[228:231], a[24:27], v[100:103]
ds_read_b64_tr_b16 v[174:175], v11 offset:26624
s_add_u32 s69, s69, 0x20000
buffer_load_dwordx4 a[112:115], v1, s[44:47], s69 offen sc1
v_mfma_f32_16x16x32_bf16 v[84:87], v[228:231], a[8:11], v[84:87]
ds_read_b64_tr_b16 v[176:177], v8 offset:28672
v_mfma_f32_16x16x32_bf16 v[88:91], v[232:235], a[8:11], v[88:91]
ds_read_b64_tr_b16 v[178:179], v8 offset:30720
v_mfma_f32_16x16x32_bf16 v[104:107], v[232:235], a[24:27], v[104:107]
ds_read_b64_tr_b16 v[180:181], v9 offset:28672
ds_read_b64_tr_b16 v[182:183], v9 offset:30720
buffer_load_dwordx4 a[116:119], v1, s[44:47], s69 offen offset:1024 sc1
v_mfma_f32_16x16x32_bf16 v[108:111], v[236:239], a[24:27], v[108:111]
ds_read_b64_tr_b16 v[184:185], v10 offset:28672
v_mfma_f32_16x16x32_bf16 v[92:95], v[236:239], a[8:11], v[92:95]
ds_read_b64_tr_b16 v[186:187], v10 offset:30720
buffer_load_dwordx4 a[120:123], v1, s[44:47], s69 offen offset:2048 sc1
v_mfma_f32_16x16x32_bf16 v[80:83], v[240:243], a[12:15], v[80:83]
ds_read_b64_tr_b16 v[188:189], v11 offset:28672
v_mfma_f32_16x16x32_bf16 v[96:99], v[240:243], a[28:31], v[96:99]
ds_read_b64_tr_b16 v[190:191], v11 offset:30720
buffer_load_dwordx4 a[124:127], v1, s[44:47], s69 offen offset:3072 sc1
v_mfma_f32_16x16x32_bf16 v[100:103], v[244:247], a[28:31], v[100:103]
v_mfma_f32_16x16x32_bf16 v[84:87], v[244:247], a[12:15], v[84:87]
v_mfma_f32_16x16x32_bf16 v[88:91], v[248:251], a[12:15], v[88:91]
v_mfma_f32_16x16x32_bf16 v[104:107], v[248:251], a[28:31], v[104:107]
v_mfma_f32_16x16x32_bf16 v[108:111], v[252:255], a[28:31], v[108:111]
s_waitcnt vmcnt(25) lgkmcnt(0)
v_mfma_f32_16x16x32_bf16 v[92:95], v[252:255], a[12:15], v[92:95]
s_barrier
s_waitcnt vmcnt(37)
v_cmp_gt_u32 vcc, 2, v3
s_cbranch_vccnz Lspin66
Lback67:
v_mfma_f32_16x16x32_bf16 v[80:83], v[128:131], a[32:35], v[80:83]
ds_read_b64_tr_b16 v[192:193], v8 offset:32768
ds_read_b64_tr_b16 v[194:195], v8 offset:34816
s_add_u32 s71, s61, 1
s_and_b32 s71, s71, 3
s_add_u32 s71, s71, s78
s_lshl_b32 s71, s71, 18
s_add_u32 s71, s71, s94
s_add_u32 m0, s77, 16384
s_add_u32 s72, s71, 0
buffer_load_dwordx4 v15, s[24:27], s72 offen lds
v_mfma_f32_16x16x32_bf16 v[96:99], v[128:131], a[48:51], v[96:99]
ds_read_b64_tr_b16 v[196:197], v9 offset:32768
v_mfma_f32_16x16x32_bf16 v[100:103], v[132:135], a[48:51], v[100:103]
ds_read_b64_tr_b16 v[198:199], v9 offset:34816
s_add_u32 s72, s71, 15360
buffer_load_dwordx4 v15, s[24:27], s72 offen offset:1024 lds
v_mfma_f32_16x16x32_bf16 v[84:87], v[132:135], a[32:35], v[84:87]
ds_read_b64_tr_b16 v[200:201], v10 offset:32768
v_mfma_f32_16x16x32_bf16 v[88:91], v[136:139], a[32:35], v[88:91]
ds_read_b64_tr_b16 v[202:203], v10 offset:34816
ds_read_b64_tr_b16 v[204:205], v11 offset:32768
s_add_u32 s72, s71, 30720
buffer_load_dwordx4 v15, s[24:27], s72 offen offset:2048 lds
v_mfma_f32_16x16x32_bf16 v[104:107], v[136:139], a[48:51], v[104:107]
ds_read_b64_tr_b16 v[206:207], v11 offset:34816
v_mfma_f32_16x16x32_bf16 v[108:111], v[140:143], a[48:51], v[108:111]
ds_read_b64_tr_b16 v[208:209], v8 offset:36864
v_mfma_f32_16x16x32_bf16 v[92:95], v[140:143], a[32:35], v[92:95]
ds_read_b64_tr_b16 v[210:211], v8 offset:38912
s_add_u32 s72, s71, 46080
buffer_load_dwordx4 v15, s[24:27], s72 offen offset:3072 lds
v_mfma_f32_16x16x32_bf16 v[80:83], v[144:147], a[36:39], v[80:83]
ds_read_b64_tr_b16 v[212:213], v9 offset:36864
ds_read_b64_tr_b16 v[214:215], v9 offset:38912
v_mfma_f32_16x16x32_bf16 v[96:99], v[144:147], a[52:55], v[96:99]
ds_read_b64_tr_b16 v[216:217], v10 offset:36864
s_add_u32 s69, s61, 0
s_and_b32 s69, s69, 3
s_add_u32 s69, s69, s78
s_lshl_b32 s69, s69, 12
s_add_u32 s69, s69, s95
buffer_load_dwordx4 a[0:3], v1, s[44:47], s69 offen sc1
v_mfma_f32_16x16x32_bf16 v[100:103], v[148:151], a[52:55], v[100:103]
ds_read_b64_tr_b16 v[218:219], v10 offset:38912
v_mfma_f32_16x16x32_bf16 v[84:87], v[148:151], a[36:39], v[84:87]
ds_read_b64_tr_b16 v[220:221], v11 offset:36864
buffer_load_dwordx4 a[4:7], v1, s[44:47], s69 offen offset:1024 sc1
v_mfma_f32_16x16x32_bf16 v[88:91], v[152:155], a[36:39], v[88:91]
ds_read_b64_tr_b16 v[222:223], v11 offset:38912
v_mfma_f32_16x16x32_bf16 v[104:107], v[152:155], a[52:55], v[104:107]
ds_read_b64_tr_b16 v[224:225], v8 offset:40960
ds_read_b64_tr_b16 v[226:227], v8 offset:43008
v_mfma_f32_16x16x32_bf16 v[108:111], v[156:159], a[52:55], v[108:111]
ds_read_b64_tr_b16 v[228:229], v9 offset:40960
buffer_load_dwordx4 a[8:11], v1, s[44:47], s69 offen offset:2048 sc1
v_mfma_f32_16x16x32_bf16 v[92:95], v[156:159], a[36:39], v[92:95]
ds_read_b64_tr_b16 v[230:231], v9 offset:43008
v_mfma_f32_16x16x32_bf16 v[80:83], v[160:163], a[40:43], v[80:83]
ds_read_b64_tr_b16 v[232:233], v10 offset:40960
buffer_load_dwordx4 a[12:15], v1, s[44:47], s69 offen offset:3072 sc1
v_mfma_f32_16x16x32_bf16 v[96:99], v[160:163], a[56:59], v[96:99]
ds_read_b64_tr_b16 v[234:235], v10 offset:43008
ds_read_b64_tr_b16 v[236:237], v11 offset:40960
v_mfma_f32_16x16x32_bf16 v[100:103], v[164:167], a[56:59], v[100:103]
ds_read_b64_tr_b16 v[238:239], v11 offset:43008
s_add_u32 s69, s69, 0x20000
buffer_load_dwordx4 a[16:19], v1, s[44:47], s69 offen sc1
v_mfma_f32_16x16x32_bf16 v[84:87], v[164:167], a[40:43], v[84:87]
ds_read_b64_tr_b16 v[240:241], v8 offset:45056
v_mfma_f32_16x16x32_bf16 v[88:91], v[168:171], a[40:43], v[88:91]
ds_read_b64_tr_b16 v[242:243], v8 offset:47104
v_mfma_f32_16x16x32_bf16 v[104:107], v[168:171], a[56:59], v[104:107]
ds_read_b64_tr_b16 v[244:245], v9 offset:45056
ds_read_b64_tr_b16 v[246:247], v9 offset:47104
buffer_load_dwordx4 a[20:23], v1, s[44:47], s69 offen offset:1024 sc1
v_mfma_f32_16x16x32_bf16 v[108:111], v[172:175], a[56:59], v[108:111]
ds_read_b64_tr_b16 v[248:249], v10 offset:45056
v_mfma_f32_16x16x32_bf16 v[92:95], v[172:175], a[40:43], v[92:95]
ds_read_b64_tr_b16 v[250:251], v10 offset:47104
buffer_load_dwordx4 a[24:27], v1, s[44:47], s69 offen offset:2048 sc1
v_mfma_f32_16x16x32_bf16 v[80:83], v[176:179], a[44:47], v[80:83]
ds_read_b64_tr_b16 v[252:253], v11 offset:45056
v_mfma_f32_16x16x32_bf16 v[96:99], v[176:179], a[60:63], v[96:99]
ds_read_b64_tr_b16 v[254:255], v11 offset:47104
buffer_load_dwordx4 a[28:31], v1, s[44:47], s69 offen offset:3072 sc1
v_mfma_f32_16x16x32_bf16 v[100:103], v[180:183], a[60:63], v[100:103]
v_mfma_f32_16x16x32_bf16 v[84:87], v[180:183], a[44:47], v[84:87]
v_mfma_f32_16x16x32_bf16 v[88:91], v[184:187], a[44:47], v[88:91]
v_mfma_f32_16x16x32_bf16 v[104:107], v[184:187], a[60:63], v[104:107]
v_mfma_f32_16x16x32_bf16 v[108:111], v[188:191], a[60:63], v[108:111]
s_waitcnt vmcnt(24) lgkmcnt(0)
v_mfma_f32_16x16x32_bf16 v[92:95], v[188:191], a[44:47], v[92:95]
s_barrier
v_mfma_f32_16x16x32_bf16 v[80:83], v[192:195], a[64:67], v[80:83]
ds_read_b64_tr_b16 v[128:129], v8 offset:49152
ds_read_b64_tr_b16 v[130:131], v8 offset:51200
s_add_u32 s85, s59, 16
s_and_b32 s85, s85, 28
s_lshl_b32 s85, s85, 10
s_add_u32 s85, s85, s74
buffer_load_dword v3, v2, s[44:47], s85 offen sc1
v_mfma_f32_16x16x32_bf16 v[96:99], v[192:195], a[80:83], v[96:99]
ds_read_b64_tr_b16 v[132:133], v9 offset:49152
v_mfma_f32_16x16x32_bf16 v[100:103], v[196:199], a[80:83], v[100:103]
ds_read_b64_tr_b16 v[134:135], v9 offset:51200
s_add_u32 s71, s61, 2
s_and_b32 s71, s71, 3
s_add_u32 s71, s71, s78
s_lshl_b32 s71, s71, 18
s_add_u32 s71, s71, s94
s_add_u32 m0, s77, 32768
s_add_u32 s72, s71, 0
buffer_load_dwordx4 v15, s[24:27], s72 offen lds
v_mfma_f32_16x16x32_bf16 v[84:87], v[196:199], a[64:67], v[84:87]
ds_read_b64_tr_b16 v[136:137], v10 offset:49152
v_mfma_f32_16x16x32_bf16 v[88:91], v[200:203], a[64:67], v[88:91]
ds_read_b64_tr_b16 v[138:139], v10 offset:51200
ds_read_b64_tr_b16 v[140:141], v11 offset:49152
s_add_u32 s72, s71, 15360
buffer_load_dwordx4 v15, s[24:27], s72 offen offset:1024 lds
v_mfma_f32_16x16x32_bf16 v[104:107], v[200:203], a[80:83], v[104:107]
ds_read_b64_tr_b16 v[142:143], v11 offset:51200
v_mfma_f32_16x16x32_bf16 v[108:111], v[204:207], a[80:83], v[108:111]
ds_read_b64_tr_b16 v[144:145], v8 offset:53248
s_add_u32 s72, s71, 30720
buffer_load_dwordx4 v15, s[24:27], s72 offen offset:2048 lds
v_mfma_f32_16x16x32_bf16 v[92:95], v[204:207], a[64:67], v[92:95]
ds_read_b64_tr_b16 v[146:147], v8 offset:55296
v_mfma_f32_16x16x32_bf16 v[80:83], v[208:211], a[68:71], v[80:83]
ds_read_b64_tr_b16 v[148:149], v9 offset:53248
ds_read_b64_tr_b16 v[150:151], v9 offset:55296
s_add_u32 s72, s71, 46080
buffer_load_dwordx4 v15, s[24:27], s72 offen offset:3072 lds
v_mfma_f32_16x16x32_bf16 v[96:99], v[208:211], a[84:87], v[96:99]
ds_read_b64_tr_b16 v[152:153], v10 offset:53248
v_mfma_f32_16x16x32_bf16 v[100:103], v[212:215], a[84:87], v[100:103]
ds_read_b64_tr_b16 v[154:155], v10 offset:55296
s_add_u32 s69, s61, 1
s_and_b32 s69, s69, 3
s_add_u32 s69, s69, s78
s_lshl_b32 s69, s69, 12
s_add_u32 s69, s69, s95
buffer_load_dwordx4 a[32:35], v1, s[44:47], s69 offen sc1
v_mfma_f32_16x16x32_bf16 v[84:87], v[212:215], a[68:71], v[84:87]
ds_read_b64_tr_b16 v[156:157], v11 offset:53248
v_mfma_f32_16x16x32_bf16 v[88:91], v[216:219], a[68:71], v[88:91]
ds_read_b64_tr_b16 v[158:159], v11 offset:55296
buffer_load_dwordx4 a[36:39], v1, s[44:47], s69 offen offset:1024 sc1
v_mfma_f32_16x16x32_bf16 v[104:107], v[216:219], a[84:87], v[104:107]
ds_read_b64_tr_b16 v[160:161], v8 offset:57344
ds_read_b64_tr_b16 v[162:163], v8 offset:59392
v_mfma_f32_16x16x32_bf16 v[108:111], v[220:223], a[84:87], v[108:111]
ds_read_b64_tr_b16 v[164:165], v9 offset:57344
v_mfma_f32_16x16x32_bf16 v[92:95], v[220:223], a[68:71], v[92:95]
ds_read_b64_tr_b16 v[166:167], v9 offset:59392
buffer_load_dwordx4 a[40:43], v1, s[44:47], s69 offen offset:2048 sc1
v_mfma_f32_16x16x32_bf16 v[80:83], v[224:227], a[72:75], v[80:83]
ds_read_b64_tr_b16 v[168:169], v10 offset:57344
v_mfma_f32_16x16x32_bf16 v[96:99], v[224:227], a[88:91], v[96:99]
ds_read_b64_tr_b16 v[170:171], v10 offset:59392
ds_read_b64_tr_b16 v[172:173], v11 offset:57344
buffer_load_dwordx4 a[44:47], v1, s[44:47], s69 offen offset:3072 sc1
v_mfma_f32_16x16x32_bf16 v[100:103], v[228:231], a[88:91], v[100:103]
ds_read_b64_tr_b16 v[174:175], v11 offset:59392
v_mfma_f32_16x16x32_bf16 v[84:87], v[228:231], a[72:75], v[84:87]
ds_read_b64_tr_b16 v[176:177], v8 offset:61440
s_add_u32 s69, s69, 0x20000
buffer_load_dwordx4 a[48:51], v1, s[44:47], s69 offen sc1
v_mfma_f32_16x16x32_bf16 v[88:91], v[232:235], a[72:75], v[88:91]
ds_read_b64_tr_b16 v[178:179], v8 offset:63488
v_mfma_f32_16x16x32_bf16 v[104:107], v[232:235], a[88:91], v[104:107]
ds_read_b64_tr_b16 v[180:181], v9 offset:61440
ds_read_b64_tr_b16 v[182:183], v9 offset:63488
buffer_load_dwordx4 a[52:55], v1, s[44:47], s69 offen offset:1024 sc1
v_mfma_f32_16x16x32_bf16 v[108:111], v[236:239], a[88:91], v[108:111]
ds_read_b64_tr_b16 v[184:185], v10 offset:61440
v_mfma_f32_16x16x32_bf16 v[92:95], v[236:239], a[72:75], v[92:95]
ds_read_b64_tr_b16 v[186:187], v10 offset:63488
buffer_load_dwordx4 a[56:59], v1, s[44:47], s69 offen offset:2048 sc1
v_mfma_f32_16x16x32_bf16 v[80:83], v[240:243], a[76:79], v[80:83]
ds_read_b64_tr_b16 v[188:189], v11 offset:61440
v_mfma_f32_16x16x32_bf16 v[96:99], v[240:243], a[92:95], v[96:99]
ds_read_b64_tr_b16 v[190:191], v11 offset:63488
buffer_load_dwordx4 a[60:63], v1, s[44:47], s69 offen offset:3072 sc1
v_mfma_f32_16x16x32_bf16 v[100:103], v[244:247], a[92:95], v[100:103]
v_mfma_f32_16x16x32_bf16 v[84:87], v[244:247], a[76:79], v[84:87]
v_mfma_f32_16x16x32_bf16 v[88:91], v[248:251], a[76:79], v[88:91]
v_mfma_f32_16x16x32_bf16 v[104:107], v[248:251], a[92:95], v[104:107]
v_mfma_f32_16x16x32_bf16 v[108:111], v[252:255], a[92:95], v[108:111]
s_waitcnt vmcnt(25) lgkmcnt(0)
v_mfma_f32_16x16x32_bf16 v[92:95], v[252:255], a[76:79], v[92:95]
s_barrier
v_mfma_f32_16x16x32_bf16 v[80:83], v[128:131], a[96:99], v[80:83]
ds_read_b64_tr_b16 v[192:193], v8 offset:0
ds_read_b64_tr_b16 v[194:195], v8 offset:2048
s_add_u32 s71, s61, 3
s_and_b32 s71, s71, 3
s_add_u32 s71, s71, s78
s_lshl_b32 s71, s71, 18
s_add_u32 s71, s71, s94
s_add_u32 m0, s77, 49152
s_add_u32 s72, s71, 0
buffer_load_dwordx4 v15, s[24:27], s72 offen lds
v_mfma_f32_16x16x32_bf16 v[96:99], v[128:131], a[112:115], v[96:99]
ds_read_b64_tr_b16 v[196:197], v9 offset:0
v_mfma_f32_16x16x32_bf16 v[100:103], v[132:135], a[112:115], v[100:103]
ds_read_b64_tr_b16 v[198:199], v9 offset:2048
s_add_u32 s72, s71, 15360
buffer_load_dwordx4 v15, s[24:27], s72 offen offset:1024 lds
v_mfma_f32_16x16x32_bf16 v[84:87], v[132:135], a[96:99], v[84:87]
ds_read_b64_tr_b16 v[200:201], v10 offset:0
v_mfma_f32_16x16x32_bf16 v[88:91], v[136:139], a[96:99], v[88:91]
ds_read_b64_tr_b16 v[202:203], v10 offset:2048
ds_read_b64_tr_b16 v[204:205], v11 offset:0
s_add_u32 s72, s71, 30720
buffer_load_dwordx4 v15, s[24:27], s72 offen offset:2048 lds
v_mfma_f32_16x16x32_bf16 v[104:107], v[136:139], a[112:115], v[104:107]
ds_read_b64_tr_b16 v[206:207], v11 offset:2048
v_mfma_f32_16x16x32_bf16 v[108:111], v[140:143], a[112:115], v[108:111]
ds_read_b64_tr_b16 v[208:209], v8 offset:4096
v_mfma_f32_16x16x32_bf16 v[92:95], v[140:143], a[96:99], v[92:95]
ds_read_b64_tr_b16 v[210:211], v8 offset:6144
s_add_u32 s72, s71, 46080
buffer_load_dwordx4 v15, s[24:27], s72 offen offset:3072 lds
v_mfma_f32_16x16x32_bf16 v[80:83], v[144:147], a[100:103], v[80:83]
ds_read_b64_tr_b16 v[212:213], v9 offset:4096
ds_read_b64_tr_b16 v[214:215], v9 offset:6144
v_mfma_f32_16x16x32_bf16 v[96:99], v[144:147], a[116:119], v[96:99]
ds_read_b64_tr_b16 v[216:217], v10 offset:4096
s_add_u32 s69, s61, 2
s_and_b32 s69, s69, 3
s_add_u32 s69, s69, s78
s_lshl_b32 s69, s69, 12
s_add_u32 s69, s69, s95
buffer_load_dwordx4 a[64:67], v1, s[44:47], s69 offen sc1
v_mfma_f32_16x16x32_bf16 v[100:103], v[148:151], a[116:119], v[100:103]
ds_read_b64_tr_b16 v[218:219], v10 offset:6144
v_mfma_f32_16x16x32_bf16 v[84:87], v[148:151], a[100:103], v[84:87]
ds_read_b64_tr_b16 v[220:221], v11 offset:4096
buffer_load_dwordx4 a[68:71], v1, s[44:47], s69 offen offset:1024 sc1
v_mfma_f32_16x16x32_bf16 v[88:91], v[152:155], a[100:103], v[88:91]
ds_read_b64_tr_b16 v[222:223], v11 offset:6144
v_mfma_f32_16x16x32_bf16 v[104:107], v[152:155], a[116:119], v[104:107]
ds_read_b64_tr_b16 v[224:225], v8 offset:8192
ds_read_b64_tr_b16 v[226:227], v8 offset:10240
v_mfma_f32_16x16x32_bf16 v[108:111], v[156:159], a[116:119], v[108:111]
ds_read_b64_tr_b16 v[228:229], v9 offset:8192
buffer_load_dwordx4 a[72:75], v1, s[44:47], s69 offen offset:2048 sc1
v_mfma_f32_16x16x32_bf16 v[92:95], v[156:159], a[100:103], v[92:95]
ds_read_b64_tr_b16 v[230:231], v9 offset:10240
v_mfma_f32_16x16x32_bf16 v[80:83], v[160:163], a[104:107], v[80:83]
ds_read_b64_tr_b16 v[232:233], v10 offset:8192
buffer_load_dwordx4 a[76:79], v1, s[44:47], s69 offen offset:3072 sc1
v_mfma_f32_16x16x32_bf16 v[96:99], v[160:163], a[120:123], v[96:99]
ds_read_b64_tr_b16 v[234:235], v10 offset:10240
ds_read_b64_tr_b16 v[236:237], v11 offset:8192
v_mfma_f32_16x16x32_bf16 v[100:103], v[164:167], a[120:123], v[100:103]
ds_read_b64_tr_b16 v[238:239], v11 offset:10240
s_add_u32 s69, s69, 0x20000
buffer_load_dwordx4 a[80:83], v1, s[44:47], s69 offen sc1
v_mfma_f32_16x16x32_bf16 v[84:87], v[164:167], a[104:107], v[84:87]
ds_read_b64_tr_b16 v[240:241], v8 offset:12288
v_mfma_f32_16x16x32_bf16 v[88:91], v[168:171], a[104:107], v[88:91]
ds_read_b64_tr_b16 v[242:243], v8 offset:14336
v_mfma_f32_16x16x32_bf16 v[104:107], v[168:171], a[120:123], v[104:107]
ds_read_b64_tr_b16 v[244:245], v9 offset:12288
ds_read_b64_tr_b16 v[246:247], v9 offset:14336
buffer_load_dwordx4 a[84:87], v1, s[44:47], s69 offen offset:1024 sc1
v_mfma_f32_16x16x32_bf16 v[108:111], v[172:175], a[120:123], v[108:111]
ds_read_b64_tr_b16 v[248:249], v10 offset:12288
v_mfma_f32_16x16x32_bf16 v[92:95], v[172:175], a[104:107], v[92:95]
ds_read_b64_tr_b16 v[250:251], v10 offset:14336
buffer_load_dwordx4 a[88:91], v1, s[44:47], s69 offen offset:2048 sc1
v_mfma_f32_16x16x32_bf16 v[80:83], v[176:179], a[108:111], v[80:83]
ds_read_b64_tr_b16 v[252:253], v11 offset:12288
v_mfma_f32_16x16x32_bf16 v[96:99], v[176:179], a[124:127], v[96:99]
ds_read_b64_tr_b16 v[254:255], v11 offset:14336
buffer_load_dwordx4 a[92:95], v1, s[44:47], s69 offen offset:3072 sc1
v_mfma_f32_16x16x32_bf16 v[100:103], v[180:183], a[124:127], v[100:103]
v_mfma_f32_16x16x32_bf16 v[84:87], v[180:183], a[108:111], v[84:87]
v_mfma_f32_16x16x32_bf16 v[88:91], v[184:187], a[108:111], v[88:91]
v_mfma_f32_16x16x32_bf16 v[104:107], v[184:187], a[124:127], v[104:107]
v_mfma_f32_16x16x32_bf16 v[108:111], v[188:191], a[124:127], v[108:111]
s_waitcnt vmcnt(25) lgkmcnt(0)
v_mfma_f32_16x16x32_bf16 v[92:95], v[188:191], a[108:111], v[92:95]
s_barrier
s_add_u32 s79, s59, 16
s_and_b32 s79, s79, 28
v_mfma_f32_16x16x32_bf16 v[80:83], v[192:195], a[0:3], v[80:83]
ds_read_b64_tr_b16 v[128:129], v8 offset:16384
ds_read_b64_tr_b16 v[130:131], v8 offset:18432
s_add_u32 s71, s61, 0
s_and_b32 s71, s71, 3
s_add_u32 s71, s71, s79
s_lshl_b32 s71, s71, 18
s_add_u32 s71, s71, s94
s_add_u32 m0, s77, 0
s_add_u32 s72, s71, 0
buffer_load_dwordx4 v15, s[24:27], s72 offen lds
v_mfma_f32_16x16x32_bf16 v[96:99], v[192:195], a[16:19], v[96:99]
ds_read_b64_tr_b16 v[132:133], v9 offset:16384
v_mfma_f32_16x16x32_bf16 v[100:103], v[196:199], a[16:19], v[100:103]
ds_read_b64_tr_b16 v[134:135], v9 offset:18432
s_add_u32 s72, s71, 15360
buffer_load_dwordx4 v15, s[24:27], s72 offen offset:1024 lds
v_mfma_f32_16x16x32_bf16 v[84:87], v[196:199], a[0:3], v[84:87]
ds_read_b64_tr_b16 v[136:137], v10 offset:16384
v_mfma_f32_16x16x32_bf16 v[88:91], v[200:203], a[0:3], v[88:91]
ds_read_b64_tr_b16 v[138:139], v10 offset:18432
ds_read_b64_tr_b16 v[140:141], v11 offset:16384
s_add_u32 s72, s71, 30720
buffer_load_dwordx4 v15, s[24:27], s72 offen offset:2048 lds
v_mfma_f32_16x16x32_bf16 v[104:107], v[200:203], a[16:19], v[104:107]
ds_read_b64_tr_b16 v[142:143], v11 offset:18432
v_mfma_f32_16x16x32_bf16 v[108:111], v[204:207], a[16:19], v[108:111]
ds_read_b64_tr_b16 v[144:145], v8 offset:20480
v_mfma_f32_16x16x32_bf16 v[92:95], v[204:207], a[0:3], v[92:95]
ds_read_b64_tr_b16 v[146:147], v8 offset:22528
s_add_u32 s72, s71, 46080
buffer_load_dwordx4 v15, s[24:27], s72 offen offset:3072 lds
v_mfma_f32_16x16x32_bf16 v[80:83], v[208:211], a[4:7], v[80:83]
ds_read_b64_tr_b16 v[148:149], v9 offset:20480
ds_read_b64_tr_b16 v[150:151], v9 offset:22528
v_mfma_f32_16x16x32_bf16 v[96:99], v[208:211], a[20:23], v[96:99]
ds_read_b64_tr_b16 v[152:153], v10 offset:20480
s_add_u32 s69, s61, 3
s_and_b32 s69, s69, 3
s_add_u32 s69, s69, s78
s_lshl_b32 s69, s69, 12
s_add_u32 s69, s69, s95
buffer_load_dwordx4 a[96:99], v1, s[44:47], s69 offen sc1
v_mfma_f32_16x16x32_bf16 v[100:103], v[212:215], a[20:23], v[100:103]
ds_read_b64_tr_b16 v[154:155], v10 offset:22528
v_mfma_f32_16x16x32_bf16 v[84:87], v[212:215], a[4:7], v[84:87]
ds_read_b64_tr_b16 v[156:157], v11 offset:20480
buffer_load_dwordx4 a[100:103], v1, s[44:47], s69 offen offset:1024 sc1
v_mfma_f32_16x16x32_bf16 v[88:91], v[216:219], a[4:7], v[88:91]
ds_read_b64_tr_b16 v[158:159], v11 offset:22528
v_mfma_f32_16x16x32_bf16 v[104:107], v[216:219], a[20:23], v[104:107]
ds_read_b64_tr_b16 v[160:161], v8 offset:24576
ds_read_b64_tr_b16 v[162:163], v8 offset:26624
v_mfma_f32_16x16x32_bf16 v[108:111], v[220:223], a[20:23], v[108:111]
ds_read_b64_tr_b16 v[164:165], v9 offset:24576
buffer_load_dwordx4 a[104:107], v1, s[44:47], s69 offen offset:2048 sc1
v_mfma_f32_16x16x32_bf16 v[92:95], v[220:223], a[4:7], v[92:95]
ds_read_b64_tr_b16 v[166:167], v9 offset:26624
v_mfma_f32_16x16x32_bf16 v[80:83], v[224:227], a[8:11], v[80:83]
ds_read_b64_tr_b16 v[168:169], v10 offset:24576
buffer_load_dwordx4 a[108:111], v1, s[44:47], s69 offen offset:3072 sc1
v_mfma_f32_16x16x32_bf16 v[96:99], v[224:227], a[24:27], v[96:99]
ds_read_b64_tr_b16 v[170:171], v10 offset:26624
ds_read_b64_tr_b16 v[172:173], v11 offset:24576
v_mfma_f32_16x16x32_bf16 v[100:103], v[228:231], a[24:27], v[100:103]
ds_read_b64_tr_b16 v[174:175], v11 offset:26624
s_add_u32 s69, s69, 0x20000
buffer_load_dwordx4 a[112:115], v1, s[44:47], s69 offen sc1
v_mfma_f32_16x16x32_bf16 v[84:87], v[228:231], a[8:11], v[84:87]
ds_read_b64_tr_b16 v[176:177], v8 offset:28672
v_mfma_f32_16x16x32_bf16 v[88:91], v[232:235], a[8:11], v[88:91]
ds_read_b64_tr_b16 v[178:179], v8 offset:30720
v_mfma_f32_16x16x32_bf16 v[104:107], v[232:235], a[24:27], v[104:107]
ds_read_b64_tr_b16 v[180:181], v9 offset:28672
ds_read_b64_tr_b16 v[182:183], v9 offset:30720
buffer_load_dwordx4 a[116:119], v1, s[44:47], s69 offen offset:1024 sc1
v_mfma_f32_16x16x32_bf16 v[108:111], v[236:239], a[24:27], v[108:111]
ds_read_b64_tr_b16 v[184:185], v10 offset:28672
v_mfma_f32_16x16x32_bf16 v[92:95], v[236:239], a[8:11], v[92:95]
ds_read_b64_tr_b16 v[186:187], v10 offset:30720
buffer_load_dwordx4 a[120:123], v1, s[44:47], s69 offen offset:2048 sc1
v_mfma_f32_16x16x32_bf16 v[80:83], v[240:243], a[12:15], v[80:83]
ds_read_b64_tr_b16 v[188:189], v11 offset:28672
v_mfma_f32_16x16x32_bf16 v[96:99], v[240:243], a[28:31], v[96:99]
ds_read_b64_tr_b16 v[190:191], v11 offset:30720
buffer_load_dwordx4 a[124:127], v1, s[44:47], s69 offen offset:3072 sc1
v_mfma_f32_16x16x32_bf16 v[100:103], v[244:247], a[28:31], v[100:103]
v_mfma_f32_16x16x32_bf16 v[84:87], v[244:247], a[12:15], v[84:87]
v_mfma_f32_16x16x32_bf16 v[88:91], v[248:251], a[12:15], v[88:91]
v_mfma_f32_16x16x32_bf16 v[104:107], v[248:251], a[28:31], v[104:107]
v_mfma_f32_16x16x32_bf16 v[108:111], v[252:255], a[28:31], v[108:111]
s_waitcnt vmcnt(24) lgkmcnt(0)
v_mfma_f32_16x16x32_bf16 v[92:95], v[252:255], a[12:15], v[92:95]
s_barrier
s_waitcnt vmcnt(36)
v_cmp_gt_u32 vcc, 2, v3
s_cbranch_vccnz Lspin69
Lback70:
v_mfma_f32_16x16x32_bf16 v[80:83], v[128:131], a[32:35], v[80:83]
ds_read_b64_tr_b16 v[192:193], v8 offset:32768
ds_read_b64_tr_b16 v[194:195], v8 offset:34816
s_add_u32 s71, s61, 1
s_and_b32 s71, s71, 3
s_add_u32 s71, s71, s79
s_lshl_b32 s71, s71, 18
s_add_u32 s71, s71, s94
s_add_u32 m0, s77, 16384
s_add_u32 s72, s71, 0
buffer_load_dwordx4 v15, s[24:27], s72 offen lds
v_mfma_f32_16x16x32_bf16 v[96:99], v[128:131], a[48:51], v[96:99]
ds_read_b64_tr_b16 v[196:197], v9 offset:32768
v_mfma_f32_16x16x32_bf16 v[100:103], v[132:135], a[48:51], v[100:103]
ds_read_b64_tr_b16 v[198:199], v9 offset:34816
s_add_u32 s72, s71, 15360
buffer_load_dwordx4 v15, s[24:27], s72 offen offset:1024 lds
v_mfma_f32_16x16x32_bf16 v[84:87], v[132:135], a[32:35], v[84:87]
ds_read_b64_tr_b16 v[200:201], v10 offset:32768
v_mfma_f32_16x16x32_bf16 v[88:91], v[136:139], a[32:35], v[88:91]
ds_read_b64_tr_b16 v[202:203], v10 offset:34816
ds_read_b64_tr_b16 v[204:205], v11 offset:32768
s_add_u32 s72, s71, 30720
buffer_load_dwordx4 v15, s[24:27], s72 offen offset:2048 lds
v_mfma_f32_16x16x32_bf16 v[104:107], v[136:139], a[48:51], v[104:107]
ds_read_b64_tr_b16 v[206:207], v11 offset:34816
v_mfma_f32_16x16x32_bf16 v[108:111], v[140:143], a[48:51], v[108:111]
ds_read_b64_tr_b16 v[208:209], v8 offset:36864
v_mfma_f32_16x16x32_bf16 v[92:95], v[140:143], a[32:35], v[92:95]
ds_read_b64_tr_b16 v[210:211], v8 offset:38912
s_add_u32 s72, s71, 46080
buffer_load_dwordx4 v15, s[24:27], s72 offen offset:3072 lds
v_mfma_f32_16x16x32_bf16 v[80:83], v[144:147], a[36:39], v[80:83]
ds_read_b64_tr_b16 v[212:213], v9 offset:36864
ds_read_b64_tr_b16 v[214:215], v9 offset:38912
v_mfma_f32_16x16x32_bf16 v[96:99], v[144:147], a[52:55], v[96:99]
ds_read_b64_tr_b16 v[216:217], v10 offset:36864
s_add_u32 s69, s61, 0
s_and_b32 s69, s69, 3
s_add_u32 s69, s69, s79
s_lshl_b32 s69, s69, 12
s_add_u32 s69, s69, s95
buffer_load_dwordx4 a[0:3], v1, s[44:47], s69 offen sc1
v_mfma_f32_16x16x32_bf16 v[100:103], v[148:151], a[52:55], v[100:103]
ds_read_b64_tr_b16 v[218:219], v10 offset:38912
v_mfma_f32_16x16x32_bf16 v[84:87], v[148:151], a[36:39], v[84:87]
ds_read_b64_tr_b16 v[220:221], v11 offset:36864
buffer_load_dwordx4 a[4:7], v1, s[44:47], s69 offen offset:1024 sc1
v_mfma_f32_16x16x32_bf16 v[88:91], v[152:155], a[36:39], v[88:91]
ds_read_b64_tr_b16 v[222:223], v11 offset:38912
v_mfma_f32_16x16x32_bf16 v[104:107], v[152:155], a[52:55], v[104:107]
ds_read_b64_tr_b16 v[224:225], v8 offset:40960
ds_read_b64_tr_b16 v[226:227], v8 offset:43008
v_mfma_f32_16x16x32_bf16 v[108:111], v[156:159], a[52:55], v[108:111]
ds_read_b64_tr_b16 v[228:229], v9 offset:40960
buffer_load_dwordx4 a[8:11], v1, s[44:47], s69 offen offset:2048 sc1
v_mfma_f32_16x16x32_bf16 v[92:95], v[156:159], a[36:39], v[92:95]
ds_read_b64_tr_b16 v[230:231], v9 offset:43008
v_mfma_f32_16x16x32_bf16 v[80:83], v[160:163], a[40:43], v[80:83]
ds_read_b64_tr_b16 v[232:233], v10 offset:40960
buffer_load_dwordx4 a[12:15], v1, s[44:47], s69 offen offset:3072 sc1
v_mfma_f32_16x16x32_bf16 v[96:99], v[160:163], a[56:59], v[96:99]
ds_read_b64_tr_b16 v[234:235], v10 offset:43008
ds_read_b64_tr_b16 v[236:237], v11 offset:40960
v_mfma_f32_16x16x32_bf16 v[100:103], v[164:167], a[56:59], v[100:103]
ds_read_b64_tr_b16 v[238:239], v11 offset:43008
s_add_u32 s69, s69, 0x20000
buffer_load_dwordx4 a[16:19], v1, s[44:47], s69 offen sc1
v_mfma_f32_16x16x32_bf16 v[84:87], v[164:167], a[40:43], v[84:87]
ds_read_b64_tr_b16 v[240:241], v8 offset:45056
v_mfma_f32_16x16x32_bf16 v[88:91], v[168:171], a[40:43], v[88:91]
ds_read_b64_tr_b16 v[242:243], v8 offset:47104
v_mfma_f32_16x16x32_bf16 v[104:107], v[168:171], a[56:59], v[104:107]
ds_read_b64_tr_b16 v[244:245], v9 offset:45056
ds_read_b64_tr_b16 v[246:247], v9 offset:47104
buffer_load_dwordx4 a[20:23], v1, s[44:47], s69 offen offset:1024 sc1
v_mfma_f32_16x16x32_bf16 v[108:111], v[172:175], a[56:59], v[108:111]
ds_read_b64_tr_b16 v[248:249], v10 offset:45056
v_mfma_f32_16x16x32_bf16 v[92:95], v[172:175], a[40:43], v[92:95]
ds_read_b64_tr_b16 v[250:251], v10 offset:47104
buffer_load_dwordx4 a[24:27], v1, s[44:47], s69 offen offset:2048 sc1
v_mfma_f32_16x16x32_bf16 v[80:83], v[176:179], a[44:47], v[80:83]
ds_read_b64_tr_b16 v[252:253], v11 offset:45056
v_mfma_f32_16x16x32_bf16 v[96:99], v[176:179], a[60:63], v[96:99]
ds_read_b64_tr_b16 v[254:255], v11 offset:47104
buffer_load_dwordx4 a[28:31], v1, s[44:47], s69 offen offset:3072 sc1
v_mfma_f32_16x16x32_bf16 v[100:103], v[180:183], a[60:63], v[100:103]
v_mfma_f32_16x16x32_bf16 v[84:87], v[180:183], a[44:47], v[84:87]
v_mfma_f32_16x16x32_bf16 v[88:91], v[184:187], a[44:47], v[88:91]
v_mfma_f32_16x16x32_bf16 v[104:107], v[184:187], a[60:63], v[104:107]
v_mfma_f32_16x16x32_bf16 v[108:111], v[188:191], a[60:63], v[108:111]
s_waitcnt vmcnt(24) lgkmcnt(0)
v_mfma_f32_16x16x32_bf16 v[92:95], v[188:191], a[44:47], v[92:95]
s_barrier
v_mfma_f32_16x16x32_bf16 v[80:83], v[192:195], a[64:67], v[80:83]
ds_read_b64_tr_b16 v[128:129], v8 offset:49152
ds_read_b64_tr_b16 v[130:131], v8 offset:51200
s_add_u32 s85, s59, 20
s_and_b32 s85, s85, 28
s_lshl_b32 s85, s85, 10
s_add_u32 s85, s85, s74
buffer_load_dword v3, v2, s[44:47], s85 offen sc1
v_mfma_f32_16x16x32_bf16 v[96:99], v[192:195], a[80:83], v[96:99]
ds_read_b64_tr_b16 v[132:133], v9 offset:49152
v_mfma_f32_16x16x32_bf16 v[100:103], v[196:199], a[80:83], v[100:103]
ds_read_b64_tr_b16 v[134:135], v9 offset:51200
s_add_u32 s71, s61, 2
s_and_b32 s71, s71, 3
s_add_u32 s71, s71, s79
s_lshl_b32 s71, s71, 18
s_add_u32 s71, s71, s94
s_add_u32 m0, s77, 32768
s_add_u32 s72, s71, 0
buffer_load_dwordx4 v15, s[24:27], s72 offen lds
v_mfma_f32_16x16x32_bf16 v[84:87], v[196:199], a[64:67], v[84:87]
ds_read_b64_tr_b16 v[136:137], v10 offset:49152
v_mfma_f32_16x16x32_bf16 v[88:91], v[200:203], a[64:67], v[88:91]
ds_read_b64_tr_b16 v[138:139], v10 offset:51200
ds_read_b64_tr_b16 v[140:141], v11 offset:49152
s_add_u32 s72, s71, 15360
buffer_load_dwordx4 v15, s[24:27], s72 offen offset:1024 lds
v_mfma_f32_16x16x32_bf16 v[104:107], v[200:203], a[80:83], v[104:107]
ds_read_b64_tr_b16 v[142:143], v11 offset:51200
v_mfma_f32_16x16x32_bf16 v[108:111], v[204:207], a[80:83], v[108:111]
ds_read_b64_tr_b16 v[144:145], v8 offset:53248
s_add_u32 s72, s71, 30720
buffer_load_dwordx4 v15, s[24:27], s72 offen offset:2048 lds
v_mfma_f32_16x16x32_bf16 v[92:95], v[204:207], a[64:67], v[92:95]
ds_read_b64_tr_b16 v[146:147], v8 offset:55296
v_mfma_f32_16x16x32_bf16 v[80:83], v[208:211], a[68:71], v[80:83]
ds_read_b64_tr_b16 v[148:149], v9 offset:53248
ds_read_b64_tr_b16 v[150:151], v9 offset:55296
s_add_u32 s72, s71, 46080
buffer_load_dwordx4 v15, s[24:27], s72 offen offset:3072 lds
v_mfma_f32_16x16x32_bf16 v[96:99], v[208:211], a[84:87], v[96:99]
ds_read_b64_tr_b16 v[152:153], v10 offset:53248
v_mfma_f32_16x16x32_bf16 v[100:103], v[212:215], a[84:87], v[100:103]
ds_read_b64_tr_b16 v[154:155], v10 offset:55296
s_add_u32 s69, s61, 1
s_and_b32 s69, s69, 3
s_add_u32 s69, s69, s79
s_lshl_b32 s69, s69, 12
s_add_u32 s69, s69, s95
buffer_load_dwordx4 a[32:35], v1, s[44:47], s69 offen sc1
v_mfma_f32_16x16x32_bf16 v[84:87], v[212:215], a[68:71], v[84:87]
ds_read_b64_tr_b16 v[156:157], v11 offset:53248
v_mfma_f32_16x16x32_bf16 v[88:91], v[216:219], a[68:71], v[88:91]
ds_read_b64_tr_b16 v[158:159], v11 offset:55296
buffer_load_dwordx4 a[36:39], v1, s[44:47], s69 offen offset:1024 sc1
v_mfma_f32_16x16x32_bf16 v[104:107], v[216:219], a[84:87], v[104:107]
ds_read_b64_tr_b16 v[160:161], v8 offset:57344
ds_read_b64_tr_b16 v[162:163], v8 offset:59392
v_mfma_f32_16x16x32_bf16 v[108:111], v[220:223], a[84:87], v[108:111]
ds_read_b64_tr_b16 v[164:165], v9 offset:57344
v_mfma_f32_16x16x32_bf16 v[92:95], v[220:223], a[68:71], v[92:95]
ds_read_b64_tr_b16 v[166:167], v9 offset:59392
buffer_load_dwordx4 a[40:43], v1, s[44:47], s69 offen offset:2048 sc1
v_mfma_f32_16x16x32_bf16 v[80:83], v[224:227], a[72:75], v[80:83]
ds_read_b64_tr_b16 v[168:169], v10 offset:57344
v_mfma_f32_16x16x32_bf16 v[96:99], v[224:227], a[88:91], v[96:99]
ds_read_b64_tr_b16 v[170:171], v10 offset:59392
ds_read_b64_tr_b16 v[172:173], v11 offset:57344
buffer_load_dwordx4 a[44:47], v1, s[44:47], s69 offen offset:3072 sc1
v_mfma_f32_16x16x32_bf16 v[100:103], v[228:231], a[88:91], v[100:103]
ds_read_b64_tr_b16 v[174:175], v11 offset:59392
v_mfma_f32_16x16x32_bf16 v[84:87], v[228:231], a[72:75], v[84:87]
ds_read_b64_tr_b16 v[176:177], v8 offset:61440
s_add_u32 s69, s69, 0x20000
buffer_load_dwordx4 a[48:51], v1, s[44:47], s69 offen sc1
v_mfma_f32_16x16x32_bf16 v[88:91], v[232:235], a[72:75], v[88:91]
ds_read_b64_tr_b16 v[178:179], v8 offset:63488
v_mfma_f32_16x16x32_bf16 v[104:107], v[232:235], a[88:91], v[104:107]
ds_read_b64_tr_b16 v[180:181], v9 offset:61440
ds_read_b64_tr_b16 v[182:183], v9 offset:63488
buffer_load_dwordx4 a[52:55], v1, s[44:47], s69 offen offset:1024 sc1
v_mfma_f32_16x16x32_bf16 v[108:111], v[236:239], a[88:91], v[108:111]
ds_read_b64_tr_b16 v[184:185], v10 offset:61440
v_mfma_f32_16x16x32_bf16 v[92:95], v[236:239], a[72:75], v[92:95]
ds_read_b64_tr_b16 v[186:187], v10 offset:63488
buffer_load_dwordx4 a[56:59], v1, s[44:47], s69 offen offset:2048 sc1
v_mfma_f32_16x16x32_bf16 v[80:83], v[240:243], a[76:79], v[80:83]
ds_read_b64_tr_b16 v[188:189], v11 offset:61440
v_mfma_f32_16x16x32_bf16 v[96:99], v[240:243], a[92:95], v[96:99]
ds_read_b64_tr_b16 v[190:191], v11 offset:63488
buffer_load_dwordx4 a[60:63], v1, s[44:47], s69 offen offset:3072 sc1
v_mfma_f32_16x16x32_bf16 v[100:103], v[244:247], a[92:95], v[100:103]
v_mfma_f32_16x16x32_bf16 v[84:87], v[244:247], a[76:79], v[84:87]
v_mfma_f32_16x16x32_bf16 v[88:91], v[248:251], a[76:79], v[88:91]
v_mfma_f32_16x16x32_bf16 v[104:107], v[248:251], a[92:95], v[104:107]
v_mfma_f32_16x16x32_bf16 v[108:111], v[252:255], a[92:95], v[108:111]
s_waitcnt vmcnt(25) lgkmcnt(0)
v_mfma_f32_16x16x32_bf16 v[92:95], v[252:255], a[76:79], v[92:95]
s_barrier
v_mfma_f32_16x16x32_bf16 v[80:83], v[128:131], a[96:99], v[80:83]
ds_read_b64_tr_b16 v[192:193], v8 offset:0
ds_read_b64_tr_b16 v[194:195], v8 offset:2048
s_add_u32 s71, s61, 3
s_and_b32 s71, s71, 3
s_add_u32 s71, s71, s79
s_lshl_b32 s71, s71, 18
s_add_u32 s71, s71, s94
s_add_u32 m0, s77, 49152
s_add_u32 s72, s71, 0
buffer_load_dwordx4 v15, s[24:27], s72 offen lds
v_mfma_f32_16x16x32_bf16 v[96:99], v[128:131], a[112:115], v[96:99]
ds_read_b64_tr_b16 v[196:197], v9 offset:0
v_mfma_f32_16x16x32_bf16 v[100:103], v[132:135], a[112:115], v[100:103]
ds_read_b64_tr_b16 v[198:199], v9 offset:2048
s_add_u32 s72, s71, 15360
buffer_load_dwordx4 v15, s[24:27], s72 offen offset:1024 lds
v_mfma_f32_16x16x32_bf16 v[84:87], v[132:135], a[96:99], v[84:87]
ds_read_b64_tr_b16 v[200:201], v10 offset:0
v_mfma_f32_16x16x32_bf16 v[88:91], v[136:139], a[96:99], v[88:91]
ds_read_b64_tr_b16 v[202:203], v10 offset:2048
ds_read_b64_tr_b16 v[204:205], v11 offset:0
s_add_u32 s72, s71, 30720
buffer_load_dwordx4 v15, s[24:27], s72 offen offset:2048 lds
v_mfma_f32_16x16x32_bf16 v[104:107], v[136:139], a[112:115], v[104:107]
ds_read_b64_tr_b16 v[206:207], v11 offset:2048
v_mfma_f32_16x16x32_bf16 v[108:111], v[140:143], a[112:115], v[108:111]
ds_read_b64_tr_b16 v[208:209], v8 offset:4096
v_mfma_f32_16x16x32_bf16 v[92:95], v[140:143], a[96:99], v[92:95]
ds_read_b64_tr_b16 v[210:211], v8 offset:6144
s_add_u32 s72, s71, 46080
buffer_load_dwordx4 v15, s[24:27], s72 offen offset:3072 lds
v_mfma_f32_16x16x32_bf16 v[80:83], v[144:147], a[100:103], v[80:83]
ds_read_b64_tr_b16 v[212:213], v9 offset:4096
ds_read_b64_tr_b16 v[214:215], v9 offset:6144
v_mfma_f32_16x16x32_bf16 v[96:99], v[144:147], a[116:119], v[96:99]
ds_read_b64_tr_b16 v[216:217], v10 offset:4096
s_add_u32 s69, s61, 2
s_and_b32 s69, s69, 3
s_add_u32 s69, s69, s79
s_lshl_b32 s69, s69, 12
s_add_u32 s69, s69, s95
buffer_load_dwordx4 a[64:67], v1, s[44:47], s69 offen sc1
v_mfma_f32_16x16x32_bf16 v[100:103], v[148:151], a[116:119], v[100:103]
ds_read_b64_tr_b16 v[218:219], v10 offset:6144
v_mfma_f32_16x16x32_bf16 v[84:87], v[148:151], a[100:103], v[84:87]
ds_read_b64_tr_b16 v[220:221], v11 offset:4096
buffer_load_dwordx4 a[68:71], v1, s[44:47], s69 offen offset:1024 sc1
v_mfma_f32_16x16x32_bf16 v[88:91], v[152:155], a[100:103], v[88:91]
ds_read_b64_tr_b16 v[222:223], v11 offset:6144
v_mfma_f32_16x16x32_bf16 v[104:107], v[152:155], a[116:119], v[104:107]
ds_read_b64_tr_b16 v[224:225], v8 offset:8192
ds_read_b64_tr_b16 v[226:227], v8 offset:10240
v_mfma_f32_16x16x32_bf16 v[108:111], v[156:159], a[116:119], v[108:111]
ds_read_b64_tr_b16 v[228:229], v9 offset:8192
buffer_load_dwordx4 a[72:75], v1, s[44:47], s69 offen offset:2048 sc1
v_mfma_f32_16x16x32_bf16 v[92:95], v[156:159], a[100:103], v[92:95]
ds_read_b64_tr_b16 v[230:231], v9 offset:10240
v_mfma_f32_16x16x32_bf16 v[80:83], v[160:163], a[104:107], v[80:83]
ds_read_b64_tr_b16 v[232:233], v10 offset:8192
buffer_load_dwordx4 a[76:79], v1, s[44:47], s69 offen offset:3072 sc1
v_mfma_f32_16x16x32_bf16 v[96:99], v[160:163], a[120:123], v[96:99]
ds_read_b64_tr_b16 v[234:235], v10 offset:10240
ds_read_b64_tr_b16 v[236:237], v11 offset:8192
v_mfma_f32_16x16x32_bf16 v[100:103], v[164:167], a[120:123], v[100:103]
ds_read_b64_tr_b16 v[238:239], v11 offset:10240
s_add_u32 s69, s69, 0x20000
buffer_load_dwordx4 a[80:83], v1, s[44:47], s69 offen sc1
v_mfma_f32_16x16x32_bf16 v[84:87], v[164:167], a[104:107], v[84:87]
ds_read_b64_tr_b16 v[240:241], v8 offset:12288
v_mfma_f32_16x16x32_bf16 v[88:91], v[168:171], a[104:107], v[88:91]
ds_read_b64_tr_b16 v[242:243], v8 offset:14336
v_mfma_f32_16x16x32_bf16 v[104:107], v[168:171], a[120:123], v[104:107]
ds_read_b64_tr_b16 v[244:245], v9 offset:12288
ds_read_b64_tr_b16 v[246:247], v9 offset:14336
buffer_load_dwordx4 a[84:87], v1, s[44:47], s69 offen offset:1024 sc1
v_mfma_f32_16x16x32_bf16 v[108:111], v[172:175], a[120:123], v[108:111]
ds_read_b64_tr_b16 v[248:249], v10 offset:12288
v_mfma_f32_16x16x32_bf16 v[92:95], v[172:175], a[104:107], v[92:95]
ds_read_b64_tr_b16 v[250:251], v10 offset:14336
buffer_load_dwordx4 a[88:91], v1, s[44:47], s69 offen offset:2048 sc1
v_mfma_f32_16x16x32_bf16 v[80:83], v[176:179], a[108:111], v[80:83]
ds_read_b64_tr_b16 v[252:253], v11 offset:12288
v_mfma_f32_16x16x32_bf16 v[96:99], v[176:179], a[124:127], v[96:99]
ds_read_b64_tr_b16 v[254:255], v11 offset:14336
buffer_load_dwordx4 a[92:95], v1, s[44:47], s69 offen offset:3072 sc1
v_mfma_f32_16x16x32_bf16 v[100:103], v[180:183], a[124:127], v[100:103]
v_mfma_f32_16x16x32_bf16 v[84:87], v[180:183], a[108:111], v[84:87]
v_mfma_f32_16x16x32_bf16 v[88:91], v[184:187], a[108:111], v[88:91]
v_mfma_f32_16x16x32_bf16 v[104:107], v[184:187], a[124:127], v[104:107]
v_mfma_f32_16x16x32_bf16 v[108:111], v[188:191], a[124:127], v[108:111]
s_waitcnt vmcnt(25) lgkmcnt(0)
v_mfma_f32_16x16x32_bf16 v[92:95], v[188:191], a[108:111], v[92:95]
s_barrier
s_add_u32 s78, s59, 20
s_and_b32 s78, s78, 28
v_mfma_f32_16x16x32_bf16 v[80:83], v[192:195], a[0:3], v[80:83]
ds_read_b64_tr_b16 v[128:129], v8 offset:16384
ds_read_b64_tr_b16 v[130:131], v8 offset:18432
s_add_u32 s71, s61, 0
s_and_b32 s71, s71, 3
s_add_u32 s71, s71, s78
s_lshl_b32 s71, s71, 18
s_add_u32 s71, s71, s94
s_add_u32 m0, s77, 0
s_add_u32 s72, s71, 0
buffer_load_dwordx4 v15, s[24:27], s72 offen lds
v_mfma_f32_16x16x32_bf16 v[96:99], v[192:195], a[16:19], v[96:99]
ds_read_b64_tr_b16 v[132:133], v9 offset:16384
v_mfma_f32_16x16x32_bf16 v[100:103], v[196:199], a[16:19], v[100:103]
ds_read_b64_tr_b16 v[134:135], v9 offset:18432
s_add_u32 s72, s71, 15360
buffer_load_dwordx4 v15, s[24:27], s72 offen offset:1024 lds
v_mfma_f32_16x16x32_bf16 v[84:87], v[196:199], a[0:3], v[84:87]
ds_read_b64_tr_b16 v[136:137], v10 offset:16384
v_mfma_f32_16x16x32_bf16 v[88:91], v[200:203], a[0:3], v[88:91]
ds_read_b64_tr_b16 v[138:139], v10 offset:18432
ds_read_b64_tr_b16 v[140:141], v11 offset:16384
s_add_u32 s72, s71, 30720
buffer_load_dwordx4 v15, s[24:27], s72 offen offset:2048 lds
v_mfma_f32_16x16x32_bf16 v[104:107], v[200:203], a[16:19], v[104:107]
ds_read_b64_tr_b16 v[142:143], v11 offset:18432
v_mfma_f32_16x16x32_bf16 v[108:111], v[204:207], a[16:19], v[108:111]
ds_read_b64_tr_b16 v[144:145], v8 offset:20480
v_mfma_f32_16x16x32_bf16 v[92:95], v[204:207], a[0:3], v[92:95]
ds_read_b64_tr_b16 v[146:147], v8 offset:22528
s_add_u32 s72, s71, 46080
buffer_load_dwordx4 v15, s[24:27], s72 offen offset:3072 lds
v_mfma_f32_16x16x32_bf16 v[80:83], v[208:211], a[4:7], v[80:83]
ds_read_b64_tr_b16 v[148:149], v9 offset:20480
ds_read_b64_tr_b16 v[150:151], v9 offset:22528
v_mfma_f32_16x16x32_bf16 v[96:99], v[208:211], a[20:23], v[96:99]
ds_read_b64_tr_b16 v[152:153], v10 offset:20480
s_add_u32 s69, s61, 3
s_and_b32 s69, s69, 3
s_add_u32 s69, s69, s79
s_lshl_b32 s69, s69, 12
s_add_u32 s69, s69, s95
buffer_load_dwordx4 a[96:99], v1, s[44:47], s69 offen sc1
v_mfma_f32_16x16x32_bf16 v[100:103], v[212:215], a[20:23], v[100:103]
ds_read_b64_tr_b16 v[154:155], v10 offset:22528
v_mfma_f32_16x16x32_bf16 v[84:87], v[212:215], a[4:7], v[84:87]
ds_read_b64_tr_b16 v[156:157], v11 offset:20480
buffer_load_dwordx4 a[100:103], v1, s[44:47], s69 offen offset:1024 sc1
v_mfma_f32_16x16x32_bf16 v[88:91], v[216:219], a[4:7], v[88:91]
ds_read_b64_tr_b16 v[158:159], v11 offset:22528
v_mfma_f32_16x16x32_bf16 v[104:107], v[216:219], a[20:23], v[104:107]
ds_read_b64_tr_b16 v[160:161], v8 offset:24576
ds_read_b64_tr_b16 v[162:163], v8 offset:26624
v_mfma_f32_16x16x32_bf16 v[108:111], v[220:223], a[20:23], v[108:111]
ds_read_b64_tr_b16 v[164:165], v9 offset:24576
buffer_load_dwordx4 a[104:107], v1, s[44:47], s69 offen offset:2048 sc1
v_mfma_f32_16x16x32_bf16 v[92:95], v[220:223], a[4:7], v[92:95]
ds_read_b64_tr_b16 v[166:167], v9 offset:26624
v_mfma_f32_16x16x32_bf16 v[80:83], v[224:227], a[8:11], v[80:83]
ds_read_b64_tr_b16 v[168:169], v10 offset:24576
buffer_load_dwordx4 a[108:111], v1, s[44:47], s69 offen offset:3072 sc1
v_mfma_f32_16x16x32_bf16 v[96:99], v[224:227], a[24:27], v[96:99]
ds_read_b64_tr_b16 v[170:171], v10 offset:26624
ds_read_b64_tr_b16 v[172:173], v11 offset:24576
v_mfma_f32_16x16x32_bf16 v[100:103], v[228:231], a[24:27], v[100:103]
ds_read_b64_tr_b16 v[174:175], v11 offset:26624
s_add_u32 s69, s69, 0x20000
buffer_load_dwordx4 a[112:115], v1, s[44:47], s69 offen sc1
v_mfma_f32_16x16x32_bf16 v[84:87], v[228:231], a[8:11], v[84:87]
ds_read_b64_tr_b16 v[176:177], v8 offset:28672
v_mfma_f32_16x16x32_bf16 v[88:91], v[232:235], a[8:11], v[88:91]
ds_read_b64_tr_b16 v[178:179], v8 offset:30720
v_mfma_f32_16x16x32_bf16 v[104:107], v[232:235], a[24:27], v[104:107]
ds_read_b64_tr_b16 v[180:181], v9 offset:28672
ds_read_b64_tr_b16 v[182:183], v9 offset:30720
buffer_load_dwordx4 a[116:119], v1, s[44:47], s69 offen offset:1024 sc1
v_mfma_f32_16x16x32_bf16 v[108:111], v[236:239], a[24:27], v[108:111]
ds_read_b64_tr_b16 v[184:185], v10 offset:28672
v_mfma_f32_16x16x32_bf16 v[92:95], v[236:239], a[8:11], v[92:95]
ds_read_b64_tr_b16 v[186:187], v10 offset:30720
buffer_load_dwordx4 a[120:123], v1, s[44:47], s69 offen offset:2048 sc1
v_mfma_f32_16x16x32_bf16 v[80:83], v[240:243], a[12:15], v[80:83]
ds_read_b64_tr_b16 v[188:189], v11 offset:28672
v_mfma_f32_16x16x32_bf16 v[96:99], v[240:243], a[28:31], v[96:99]
ds_read_b64_tr_b16 v[190:191], v11 offset:30720
buffer_load_dwordx4 a[124:127], v1, s[44:47], s69 offen offset:3072 sc1
v_mfma_f32_16x16x32_bf16 v[100:103], v[244:247], a[28:31], v[100:103]
v_mfma_f32_16x16x32_bf16 v[84:87], v[244:247], a[12:15], v[84:87]
v_mfma_f32_16x16x32_bf16 v[88:91], v[248:251], a[12:15], v[88:91]
v_mfma_f32_16x16x32_bf16 v[104:107], v[248:251], a[28:31], v[104:107]
v_mfma_f32_16x16x32_bf16 v[108:111], v[252:255], a[28:31], v[108:111]
s_waitcnt vmcnt(24) lgkmcnt(0)
v_mfma_f32_16x16x32_bf16 v[92:95], v[252:255], a[12:15], v[92:95]
s_barrier
s_waitcnt vmcnt(36)
v_cmp_gt_u32 vcc, 2, v3
s_cbranch_vccnz Lspin72
Lback73:
v_mfma_f32_16x16x32_bf16 v[80:83], v[128:131], a[32:35], v[80:83]
ds_read_b64_tr_b16 v[192:193], v8 offset:32768
ds_read_b64_tr_b16 v[194:195], v8 offset:34816
s_add_u32 s71, s61, 1
s_and_b32 s71, s71, 3
s_add_u32 s71, s71, s78
s_lshl_b32 s71, s71, 18
s_add_u32 s71, s71, s94
s_add_u32 m0, s77, 16384
s_add_u32 s72, s71, 0
buffer_load_dwordx4 v15, s[24:27], s72 offen lds
v_mfma_f32_16x16x32_bf16 v[96:99], v[128:131], a[48:51], v[96:99]
ds_read_b64_tr_b16 v[196:197], v9 offset:32768
v_mfma_f32_16x16x32_bf16 v[100:103], v[132:135], a[48:51], v[100:103]
ds_read_b64_tr_b16 v[198:199], v9 offset:34816
s_add_u32 s72, s71, 15360
buffer_load_dwordx4 v15, s[24:27], s72 offen offset:1024 lds
v_mfma_f32_16x16x32_bf16 v[84:87], v[132:135], a[32:35], v[84:87]
ds_read_b64_tr_b16 v[200:201], v10 offset:32768
v_mfma_f32_16x16x32_bf16 v[88:91], v[136:139], a[32:35], v[88:91]
ds_read_b64_tr_b16 v[202:203], v10 offset:34816
ds_read_b64_tr_b16 v[204:205], v11 offset:32768
s_add_u32 s72, s71, 30720
buffer_load_dwordx4 v15, s[24:27], s72 offen offset:2048 lds
v_mfma_f32_16x16x32_bf16 v[104:107], v[136:139], a[48:51], v[104:107]
ds_read_b64_tr_b16 v[206:207], v11 offset:34816
v_mfma_f32_16x16x32_bf16 v[108:111], v[140:143], a[48:51], v[108:111]
ds_read_b64_tr_b16 v[208:209], v8 offset:36864
v_mfma_f32_16x16x32_bf16 v[92:95], v[140:143], a[32:35], v[92:95]
ds_read_b64_tr_b16 v[210:211], v8 offset:38912
s_add_u32 s72, s71, 46080
buffer_load_dwordx4 v15, s[24:27], s72 offen offset:3072 lds
v_mfma_f32_16x16x32_bf16 v[80:83], v[144:147], a[36:39], v[80:83]
ds_read_b64_tr_b16 v[212:213], v9 offset:36864
ds_read_b64_tr_b16 v[214:215], v9 offset:38912
v_mfma_f32_16x16x32_bf16 v[96:99], v[144:147], a[52:55], v[96:99]
ds_read_b64_tr_b16 v[216:217], v10 offset:36864
s_add_u32 s69, s61, 0
s_and_b32 s69, s69, 3
s_add_u32 s69, s69, s78
s_lshl_b32 s69, s69, 12
s_add_u32 s69, s69, s95
buffer_load_dwordx4 a[0:3], v1, s[44:47], s69 offen sc1
v_mfma_f32_16x16x32_bf16 v[100:103], v[148:151], a[52:55], v[100:103]
ds_read_b64_tr_b16 v[218:219], v10 offset:38912
v_mfma_f32_16x16x32_bf16 v[84:87], v[148:151], a[36:39], v[84:87]
ds_read_b64_tr_b16 v[220:221], v11 offset:36864
buffer_load_dwordx4 a[4:7], v1, s[44:47], s69 offen offset:1024 sc1
v_mfma_f32_16x16x32_bf16 v[88:91], v[152:155], a[36:39], v[88:91]
ds_read_b64_tr_b16 v[222:223], v11 offset:38912
v_mfma_f32_16x16x32_bf16 v[104:107], v[152:155], a[52:55], v[104:107]
ds_read_b64_tr_b16 v[224:225], v8 offset:40960
ds_read_b64_tr_b16 v[226:227], v8 offset:43008
v_mfma_f32_16x16x32_bf16 v[108:111], v[156:159], a[52:55], v[108:111]
ds_read_b64_tr_b16 v[228:229], v9 offset:40960
buffer_load_dwordx4 a[8:11], v1, s[44:47], s69 offen offset:2048 sc1
v_mfma_f32_16x16x32_bf16 v[92:95], v[156:159], a[36:39], v[92:95]
ds_read_b64_tr_b16 v[230:231], v9 offset:43008
v_mfma_f32_16x16x32_bf16 v[80:83], v[160:163], a[40:43], v[80:83]
ds_read_b64_tr_b16 v[232:233], v10 offset:40960
buffer_load_dwordx4 a[12:15], v1, s[44:47], s69 offen offset:3072 sc1
v_mfma_f32_16x16x32_bf16 v[96:99], v[160:163], a[56:59], v[96:99]
ds_read_b64_tr_b16 v[234:235], v10 offset:43008
ds_read_b64_tr_b16 v[236:237], v11 offset:40960
v_mfma_f32_16x16x32_bf16 v[100:103], v[164:167], a[56:59], v[100:103]
ds_read_b64_tr_b16 v[238:239], v11 offset:43008
s_add_u32 s69, s69, 0x20000
buffer_load_dwordx4 a[16:19], v1, s[44:47], s69 offen sc1
v_mfma_f32_16x16x32_bf16 v[84:87], v[164:167], a[40:43], v[84:87]
ds_read_b64_tr_b16 v[240:241], v8 offset:45056
v_mfma_f32_16x16x32_bf16 v[88:91], v[168:171], a[40:43], v[88:91]
ds_read_b64_tr_b16 v[242:243], v8 offset:47104
v_mfma_f32_16x16x32_bf16 v[104:107], v[168:171], a[56:59], v[104:107]
ds_read_b64_tr_b16 v[244:245], v9 offset:45056
ds_read_b64_tr_b16 v[246:247], v9 offset:47104
buffer_load_dwordx4 a[20:23], v1, s[44:47], s69 offen offset:1024 sc1
v_mfma_f32_16x16x32_bf16 v[108:111], v[172:175], a[56:59], v[108:111]
ds_read_b64_tr_b16 v[248:249], v10 offset:45056
v_mfma_f32_16x16x32_bf16 v[92:95], v[172:175], a[40:43], v[92:95]
ds_read_b64_tr_b16 v[250:251], v10 offset:47104
buffer_load_dwordx4 a[24:27], v1, s[44:47], s69 offen offset:2048 sc1
v_mfma_f32_16x16x32_bf16 v[80:83], v[176:179], a[44:47], v[80:83]
ds_read_b64_tr_b16 v[252:253], v11 offset:45056
v_mfma_f32_16x16x32_bf16 v[96:99], v[176:179], a[60:63], v[96:99]
ds_read_b64_tr_b16 v[254:255], v11 offset:47104
buffer_load_dwordx4 a[28:31], v1, s[44:47], s69 offen offset:3072 sc1
v_mfma_f32_16x16x32_bf16 v[100:103], v[180:183], a[60:63], v[100:103]
v_mfma_f32_16x16x32_bf16 v[84:87], v[180:183], a[44:47], v[84:87]
v_mfma_f32_16x16x32_bf16 v[88:91], v[184:187], a[44:47], v[88:91]
v_mfma_f32_16x16x32_bf16 v[104:107], v[184:187], a[60:63], v[104:107]
v_mfma_f32_16x16x32_bf16 v[108:111], v[188:191], a[60:63], v[108:111]
s_waitcnt vmcnt(24) lgkmcnt(0)
v_mfma_f32_16x16x32_bf16 v[92:95], v[188:191], a[44:47], v[92:95]
s_barrier
v_mfma_f32_16x16x32_bf16 v[80:83], v[192:195], a[64:67], v[80:83]
ds_read_b64_tr_b16 v[128:129], v8 offset:49152
ds_read_b64_tr_b16 v[130:131], v8 offset:51200
s_add_u32 s85, s59, 24
s_and_b32 s85, s85, 28
s_lshl_b32 s85, s85, 10
s_add_u32 s85, s85, s74
buffer_load_dword v3, v2, s[44:47], s85 offen sc1
v_mfma_f32_16x16x32_bf16 v[96:99], v[192:195], a[80:83], v[96:99]
ds_read_b64_tr_b16 v[132:133], v9 offset:49152
v_mfma_f32_16x16x32_bf16 v[100:103], v[196:199], a[80:83], v[100:103]
ds_read_b64_tr_b16 v[134:135], v9 offset:51200
s_add_u32 s71, s61, 2
s_and_b32 s71, s71, 3
s_add_u32 s71, s71, s78
s_lshl_b32 s71, s71, 18
s_add_u32 s71, s71, s94
s_add_u32 m0, s77, 32768
s_add_u32 s72, s71, 0
buffer_load_dwordx4 v15, s[24:27], s72 offen lds
v_mfma_f32_16x16x32_bf16 v[84:87], v[196:199], a[64:67], v[84:87]
ds_read_b64_tr_b16 v[136:137], v10 offset:49152
v_mfma_f32_16x16x32_bf16 v[88:91], v[200:203], a[64:67], v[88:91]
ds_read_b64_tr_b16 v[138:139], v10 offset:51200
ds_read_b64_tr_b16 v[140:141], v11 offset:49152
s_add_u32 s72, s71, 15360
buffer_load_dwordx4 v15, s[24:27], s72 offen offset:1024 lds
v_mfma_f32_16x16x32_bf16 v[104:107], v[200:203], a[80:83], v[104:107]
ds_read_b64_tr_b16 v[142:143], v11 offset:51200
v_mfma_f32_16x16x32_bf16 v[108:111], v[204:207], a[80:83], v[108:111]
ds_read_b64_tr_b16 v[144:145], v8 offset:53248
s_add_u32 s72, s71, 30720
buffer_load_dwordx4 v15, s[24:27], s72 offen offset:2048 lds
v_mfma_f32_16x16x32_bf16 v[92:95], v[204:207], a[64:67], v[92:95]
ds_read_b64_tr_b16 v[146:147], v8 offset:55296
v_mfma_f32_16x16x32_bf16 v[80:83], v[208:211], a[68:71], v[80:83]
ds_read_b64_tr_b16 v[148:149], v9 offset:53248
ds_read_b64_tr_b16 v[150:151], v9 offset:55296
s_add_u32 s72, s71, 46080
buffer_load_dwordx4 v15, s[24:27], s72 offen offset:3072 lds
v_mfma_f32_16x16x32_bf16 v[96:99], v[208:211], a[84:87], v[96:99]
ds_read_b64_tr_b16 v[152:153], v10 offset:53248
v_mfma_f32_16x16x32_bf16 v[100:103], v[212:215], a[84:87], v[100:103]
ds_read_b64_tr_b16 v[154:155], v10 offset:55296
s_add_u32 s69, s61, 1
s_and_b32 s69, s69, 3
s_add_u32 s69, s69, s78
s_lshl_b32 s69, s69, 12
s_add_u32 s69, s69, s95
buffer_load_dwordx4 a[32:35], v1, s[44:47], s69 offen sc1
v_mfma_f32_16x16x32_bf16 v[84:87], v[212:215], a[68:71], v[84:87]
ds_read_b64_tr_b16 v[156:157], v11 offset:53248
v_mfma_f32_16x16x32_bf16 v[88:91], v[216:219], a[68:71], v[88:91]
ds_read_b64_tr_b16 v[158:159], v11 offset:55296
buffer_load_dwordx4 a[36:39], v1, s[44:47], s69 offen offset:1024 sc1
v_mfma_f32_16x16x32_bf16 v[104:107], v[216:219], a[84:87], v[104:107]
ds_read_b64_tr_b16 v[160:161], v8 offset:57344
ds_read_b64_tr_b16 v[162:163], v8 offset:59392
v_mfma_f32_16x16x32_bf16 v[108:111], v[220:223], a[84:87], v[108:111]
ds_read_b64_tr_b16 v[164:165], v9 offset:57344
v_mfma_f32_16x16x32_bf16 v[92:95], v[220:223], a[68:71], v[92:95]
ds_read_b64_tr_b16 v[166:167], v9 offset:59392
buffer_load_dwordx4 a[40:43], v1, s[44:47], s69 offen offset:2048 sc1
v_mfma_f32_16x16x32_bf16 v[80:83], v[224:227], a[72:75], v[80:83]
ds_read_b64_tr_b16 v[168:169], v10 offset:57344
v_mfma_f32_16x16x32_bf16 v[96:99], v[224:227], a[88:91], v[96:99]
ds_read_b64_tr_b16 v[170:171], v10 offset:59392
ds_read_b64_tr_b16 v[172:173], v11 offset:57344
buffer_load_dwordx4 a[44:47], v1, s[44:47], s69 offen offset:3072 sc1
v_mfma_f32_16x16x32_bf16 v[100:103], v[228:231], a[88:91], v[100:103]
ds_read_b64_tr_b16 v[174:175], v11 offset:59392
v_mfma_f32_16x16x32_bf16 v[84:87], v[228:231], a[72:75], v[84:87]
ds_read_b64_tr_b16 v[176:177], v8 offset:61440
s_add_u32 s69, s69, 0x20000
buffer_load_dwordx4 a[48:51], v1, s[44:47], s69 offen sc1
v_mfma_f32_16x16x32_bf16 v[88:91], v[232:235], a[72:75], v[88:91]
ds_read_b64_tr_b16 v[178:179], v8 offset:63488
v_mfma_f32_16x16x32_bf16 v[104:107], v[232:235], a[88:91], v[104:107]
ds_read_b64_tr_b16 v[180:181], v9 offset:61440
ds_read_b64_tr_b16 v[182:183], v9 offset:63488
buffer_load_dwordx4 a[52:55], v1, s[44:47], s69 offen offset:1024 sc1
v_mfma_f32_16x16x32_bf16 v[108:111], v[236:239], a[88:91], v[108:111]
ds_read_b64_tr_b16 v[184:185], v10 offset:61440
v_mfma_f32_16x16x32_bf16 v[92:95], v[236:239], a[72:75], v[92:95]
ds_read_b64_tr_b16 v[186:187], v10 offset:63488
buffer_load_dwordx4 a[56:59], v1, s[44:47], s69 offen offset:2048 sc1
v_mfma_f32_16x16x32_bf16 v[80:83], v[240:243], a[76:79], v[80:83]
ds_read_b64_tr_b16 v[188:189], v11 offset:61440
v_mfma_f32_16x16x32_bf16 v[96:99], v[240:243], a[92:95], v[96:99]
ds_read_b64_tr_b16 v[190:191], v11 offset:63488
buffer_load_dwordx4 a[60:63], v1, s[44:47], s69 offen offset:3072 sc1
v_mfma_f32_16x16x32_bf16 v[100:103], v[244:247], a[92:95], v[100:103]
v_mfma_f32_16x16x32_bf16 v[84:87], v[244:247], a[76:79], v[84:87]
v_mfma_f32_16x16x32_bf16 v[88:91], v[248:251], a[76:79], v[88:91]
v_mfma_f32_16x16x32_bf16 v[104:107], v[248:251], a[92:95], v[104:107]
v_mfma_f32_16x16x32_bf16 v[108:111], v[252:255], a[92:95], v[108:111]
s_waitcnt vmcnt(25) lgkmcnt(0)
v_mfma_f32_16x16x32_bf16 v[92:95], v[252:255], a[76:79], v[92:95]
s_barrier
v_mfma_f32_16x16x32_bf16 v[80:83], v[128:131], a[96:99], v[80:83]
ds_read_b64_tr_b16 v[192:193], v8 offset:0
ds_read_b64_tr_b16 v[194:195], v8 offset:2048
s_add_u32 s71, s61, 3
s_and_b32 s71, s71, 3
s_add_u32 s71, s71, s78
s_lshl_b32 s71, s71, 18
s_add_u32 s71, s71, s94
s_add_u32 m0, s77, 49152
s_add_u32 s72, s71, 0
buffer_load_dwordx4 v15, s[24:27], s72 offen lds
v_mfma_f32_16x16x32_bf16 v[96:99], v[128:131], a[112:115], v[96:99]
ds_read_b64_tr_b16 v[196:197], v9 offset:0
v_mfma_f32_16x16x32_bf16 v[100:103], v[132:135], a[112:115], v[100:103]
ds_read_b64_tr_b16 v[198:199], v9 offset:2048
s_add_u32 s72, s71, 15360
buffer_load_dwordx4 v15, s[24:27], s72 offen offset:1024 lds
v_mfma_f32_16x16x32_bf16 v[84:87], v[132:135], a[96:99], v[84:87]
ds_read_b64_tr_b16 v[200:201], v10 offset:0
v_mfma_f32_16x16x32_bf16 v[88:91], v[136:139], a[96:99], v[88:91]
ds_read_b64_tr_b16 v[202:203], v10 offset:2048
ds_read_b64_tr_b16 v[204:205], v11 offset:0
s_add_u32 s72, s71, 30720
buffer_load_dwordx4 v15, s[24:27], s72 offen offset:2048 lds
v_mfma_f32_16x16x32_bf16 v[104:107], v[136:139], a[112:115], v[104:107]
ds_read_b64_tr_b16 v[206:207], v11 offset:2048
v_mfma_f32_16x16x32_bf16 v[108:111], v[140:143], a[112:115], v[108:111]
ds_read_b64_tr_b16 v[208:209], v8 offset:4096
v_mfma_f32_16x16x32_bf16 v[92:95], v[140:143], a[96:99], v[92:95]
ds_read_b64_tr_b16 v[210:211], v8 offset:6144
s_add_u32 s72, s71, 46080
buffer_load_dwordx4 v15, s[24:27], s72 offen offset:3072 lds
v_mfma_f32_16x16x32_bf16 v[80:83], v[144:147], a[100:103], v[80:83]
ds_read_b64_tr_b16 v[212:213], v9 offset:4096
ds_read_b64_tr_b16 v[214:215], v9 offset:6144
v_mfma_f32_16x16x32_bf16 v[96:99], v[144:147], a[116:119], v[96:99]
ds_read_b64_tr_b16 v[216:217], v10 offset:4096
s_add_u32 s69, s61, 2
s_and_b32 s69, s69, 3
s_add_u32 s69, s69, s78
s_lshl_b32 s69, s69, 12
s_add_u32 s69, s69, s95
buffer_load_dwordx4 a[64:67], v1, s[44:47], s69 offen sc1
v_mfma_f32_16x16x32_bf16 v[100:103], v[148:151], a[116:119], v[100:103]
ds_read_b64_tr_b16 v[218:219], v10 offset:6144
v_mfma_f32_16x16x32_bf16 v[84:87], v[148:151], a[100:103], v[84:87]
ds_read_b64_tr_b16 v[220:221], v11 offset:4096
buffer_load_dwordx4 a[68:71], v1, s[44:47], s69 offen offset:1024 sc1
v_mfma_f32_16x16x32_bf16 v[88:91], v[152:155], a[100:103], v[88:91]
ds_read_b64_tr_b16 v[222:223], v11 offset:6144
v_mfma_f32_16x16x32_bf16 v[104:107], v[152:155], a[116:119], v[104:107]
ds_read_b64_tr_b16 v[224:225], v8 offset:8192
ds_read_b64_tr_b16 v[226:227], v8 offset:10240
v_mfma_f32_16x16x32_bf16 v[108:111], v[156:159], a[116:119], v[108:111]
ds_read_b64_tr_b16 v[228:229], v9 offset:8192
buffer_load_dwordx4 a[72:75], v1, s[44:47], s69 offen offset:2048 sc1
v_mfma_f32_16x16x32_bf16 v[92:95], v[156:159], a[100:103], v[92:95]
ds_read_b64_tr_b16 v[230:231], v9 offset:10240
v_mfma_f32_16x16x32_bf16 v[80:83], v[160:163], a[104:107], v[80:83]
ds_read_b64_tr_b16 v[232:233], v10 offset:8192
buffer_load_dwordx4 a[76:79], v1, s[44:47], s69 offen offset:3072 sc1
v_mfma_f32_16x16x32_bf16 v[96:99], v[160:163], a[120:123], v[96:99]
ds_read_b64_tr_b16 v[234:235], v10 offset:10240
ds_read_b64_tr_b16 v[236:237], v11 offset:8192
v_mfma_f32_16x16x32_bf16 v[100:103], v[164:167], a[120:123], v[100:103]
ds_read_b64_tr_b16 v[238:239], v11 offset:10240
s_add_u32 s69, s69, 0x20000
buffer_load_dwordx4 a[80:83], v1, s[44:47], s69 offen sc1
v_mfma_f32_16x16x32_bf16 v[84:87], v[164:167], a[104:107], v[84:87]
ds_read_b64_tr_b16 v[240:241], v8 offset:12288
v_mfma_f32_16x16x32_bf16 v[88:91], v[168:171], a[104:107], v[88:91]
ds_read_b64_tr_b16 v[242:243], v8 offset:14336
v_mfma_f32_16x16x32_bf16 v[104:107], v[168:171], a[120:123], v[104:107]
ds_read_b64_tr_b16 v[244:245], v9 offset:12288
ds_read_b64_tr_b16 v[246:247], v9 offset:14336
buffer_load_dwordx4 a[84:87], v1, s[44:47], s69 offen offset:1024 sc1
v_mfma_f32_16x16x32_bf16 v[108:111], v[172:175], a[120:123], v[108:111]
ds_read_b64_tr_b16 v[248:249], v10 offset:12288
v_mfma_f32_16x16x32_bf16 v[92:95], v[172:175], a[104:107], v[92:95]
ds_read_b64_tr_b16 v[250:251], v10 offset:14336
buffer_load_dwordx4 a[88:91], v1, s[44:47], s69 offen offset:2048 sc1
v_mfma_f32_16x16x32_bf16 v[80:83], v[176:179], a[108:111], v[80:83]
ds_read_b64_tr_b16 v[252:253], v11 offset:12288
v_mfma_f32_16x16x32_bf16 v[96:99], v[176:179], a[124:127], v[96:99]
ds_read_b64_tr_b16 v[254:255], v11 offset:14336
buffer_load_dwordx4 a[92:95], v1, s[44:47], s69 offen offset:3072 sc1
v_mfma_f32_16x16x32_bf16 v[100:103], v[180:183], a[124:127], v[100:103]
v_mfma_f32_16x16x32_bf16 v[84:87], v[180:183], a[108:111], v[84:87]
v_mfma_f32_16x16x32_bf16 v[88:91], v[184:187], a[108:111], v[88:91]
v_mfma_f32_16x16x32_bf16 v[104:107], v[184:187], a[124:127], v[104:107]
v_mfma_f32_16x16x32_bf16 v[108:111], v[188:191], a[124:127], v[108:111]
s_waitcnt vmcnt(25) lgkmcnt(0)
v_mfma_f32_16x16x32_bf16 v[92:95], v[188:191], a[108:111], v[92:95]
s_barrier
s_add_u32 s79, s59, 24
s_and_b32 s79, s79, 28
v_mfma_f32_16x16x32_bf16 v[80:83], v[192:195], a[0:3], v[80:83]
ds_read_b64_tr_b16 v[128:129], v8 offset:16384
ds_read_b64_tr_b16 v[130:131], v8 offset:18432
s_add_u32 s71, s61, 0
s_and_b32 s71, s71, 3
s_add_u32 s71, s71, s79
s_lshl_b32 s71, s71, 18
s_add_u32 s71, s71, s94
s_add_u32 m0, s77, 0
s_add_u32 s72, s71, 0
buffer_load_dwordx4 v15, s[24:27], s72 offen lds
v_mfma_f32_16x16x32_bf16 v[96:99], v[192:195], a[16:19], v[96:99]
ds_read_b64_tr_b16 v[132:133], v9 offset:16384
v_mfma_f32_16x16x32_bf16 v[100:103], v[196:199], a[16:19], v[100:103]
ds_read_b64_tr_b16 v[134:135], v9 offset:18432
s_add_u32 s72, s71, 15360
buffer_load_dwordx4 v15, s[24:27], s72 offen offset:1024 lds
v_mfma_f32_16x16x32_bf16 v[84:87], v[196:199], a[0:3], v[84:87]
ds_read_b64_tr_b16 v[136:137], v10 offset:16384
v_mfma_f32_16x16x32_bf16 v[88:91], v[200:203], a[0:3], v[88:91]
ds_read_b64_tr_b16 v[138:139], v10 offset:18432
ds_read_b64_tr_b16 v[140:141], v11 offset:16384
s_add_u32 s72, s71, 30720
buffer_load_dwordx4 v15, s[24:27], s72 offen offset:2048 lds
v_mfma_f32_16x16x32_bf16 v[104:107], v[200:203], a[16:19], v[104:107]
ds_read_b64_tr_b16 v[142:143], v11 offset:18432
v_mfma_f32_16x16x32_bf16 v[108:111], v[204:207], a[16:19], v[108:111]
ds_read_b64_tr_b16 v[144:145], v8 offset:20480
v_mfma_f32_16x16x32_bf16 v[92:95], v[204:207], a[0:3], v[92:95]
ds_read_b64_tr_b16 v[146:147], v8 offset:22528
s_add_u32 s72, s71, 46080
buffer_load_dwordx4 v15, s[24:27], s72 offen offset:3072 lds
v_mfma_f32_16x16x32_bf16 v[80:83], v[208:211], a[4:7], v[80:83]
ds_read_b64_tr_b16 v[148:149], v9 offset:20480
ds_read_b64_tr_b16 v[150:151], v9 offset:22528
v_mfma_f32_16x16x32_bf16 v[96:99], v[208:211], a[20:23], v[96:99]
ds_read_b64_tr_b16 v[152:153], v10 offset:20480
s_add_u32 s69, s61, 3
s_and_b32 s69, s69, 3
s_add_u32 s69, s69, s78
s_lshl_b32 s69, s69, 12
s_add_u32 s69, s69, s95
buffer_load_dwordx4 a[96:99], v1, s[44:47], s69 offen sc1
v_mfma_f32_16x16x32_bf16 v[100:103], v[212:215], a[20:23], v[100:103]
ds_read_b64_tr_b16 v[154:155], v10 offset:22528
v_mfma_f32_16x16x32_bf16 v[84:87], v[212:215], a[4:7], v[84:87]
ds_read_b64_tr_b16 v[156:157], v11 offset:20480
buffer_load_dwordx4 a[100:103], v1, s[44:47], s69 offen offset:1024 sc1
v_mfma_f32_16x16x32_bf16 v[88:91], v[216:219], a[4:7], v[88:91]
ds_read_b64_tr_b16 v[158:159], v11 offset:22528
v_mfma_f32_16x16x32_bf16 v[104:107], v[216:219], a[20:23], v[104:107]
ds_read_b64_tr_b16 v[160:161], v8 offset:24576
ds_read_b64_tr_b16 v[162:163], v8 offset:26624
v_mfma_f32_16x16x32_bf16 v[108:111], v[220:223], a[20:23], v[108:111]
ds_read_b64_tr_b16 v[164:165], v9 offset:24576
buffer_load_dwordx4 a[104:107], v1, s[44:47], s69 offen offset:2048 sc1
v_mfma_f32_16x16x32_bf16 v[92:95], v[220:223], a[4:7], v[92:95]
ds_read_b64_tr_b16 v[166:167], v9 offset:26624
v_mfma_f32_16x16x32_bf16 v[80:83], v[224:227], a[8:11], v[80:83]
ds_read_b64_tr_b16 v[168:169], v10 offset:24576
buffer_load_dwordx4 a[108:111], v1, s[44:47], s69 offen offset:3072 sc1
v_mfma_f32_16x16x32_bf16 v[96:99], v[224:227], a[24:27], v[96:99]
ds_read_b64_tr_b16 v[170:171], v10 offset:26624
ds_read_b64_tr_b16 v[172:173], v11 offset:24576
v_mfma_f32_16x16x32_bf16 v[100:103], v[228:231], a[24:27], v[100:103]
ds_read_b64_tr_b16 v[174:175], v11 offset:26624
s_add_u32 s69, s69, 0x20000
buffer_load_dwordx4 a[112:115], v1, s[44:47], s69 offen sc1
v_mfma_f32_16x16x32_bf16 v[84:87], v[228:231], a[8:11], v[84:87]
ds_read_b64_tr_b16 v[176:177], v8 offset:28672
v_mfma_f32_16x16x32_bf16 v[88:91], v[232:235], a[8:11], v[88:91]
ds_read_b64_tr_b16 v[178:179], v8 offset:30720
v_mfma_f32_16x16x32_bf16 v[104:107], v[232:235], a[24:27], v[104:107]
ds_read_b64_tr_b16 v[180:181], v9 offset:28672
ds_read_b64_tr_b16 v[182:183], v9 offset:30720
buffer_load_dwordx4 a[116:119], v1, s[44:47], s69 offen offset:1024 sc1
v_mfma_f32_16x16x32_bf16 v[108:111], v[236:239], a[24:27], v[108:111]
ds_read_b64_tr_b16 v[184:185], v10 offset:28672
v_mfma_f32_16x16x32_bf16 v[92:95], v[236:239], a[8:11], v[92:95]
ds_read_b64_tr_b16 v[186:187], v10 offset:30720
buffer_load_dwordx4 a[120:123], v1, s[44:47], s69 offen offset:2048 sc1
v_mfma_f32_16x16x32_bf16 v[80:83], v[240:243], a[12:15], v[80:83]
ds_read_b64_tr_b16 v[188:189], v11 offset:28672
v_mfma_f32_16x16x32_bf16 v[96:99], v[240:243], a[28:31], v[96:99]
ds_read_b64_tr_b16 v[190:191], v11 offset:30720
buffer_load_dwordx4 a[124:127], v1, s[44:47], s69 offen offset:3072 sc1
v_mfma_f32_16x16x32_bf16 v[100:103], v[244:247], a[28:31], v[100:103]
v_mfma_f32_16x16x32_bf16 v[84:87], v[244:247], a[12:15], v[84:87]
v_mfma_f32_16x16x32_bf16 v[88:91], v[248:251], a[12:15], v[88:91]
v_mfma_f32_16x16x32_bf16 v[104:107], v[248:251], a[28:31], v[104:107]
v_mfma_f32_16x16x32_bf16 v[108:111], v[252:255], a[28:31], v[108:111]
s_waitcnt vmcnt(24) lgkmcnt(0)
v_mfma_f32_16x16x32_bf16 v[92:95], v[252:255], a[12:15], v[92:95]
s_barrier
s_waitcnt vmcnt(36)
v_cmp_gt_u32 vcc, 2, v3
s_cbranch_vccnz Lspin75
Lback76:
v_mfma_f32_16x16x32_bf16 v[80:83], v[128:131], a[32:35], v[80:83]
ds_read_b64_tr_b16 v[192:193], v8 offset:32768
ds_read_b64_tr_b16 v[194:195], v8 offset:34816
s_add_u32 s71, s61, 1
s_and_b32 s71, s71, 3
s_add_u32 s71, s71, s79
s_lshl_b32 s71, s71, 18
s_add_u32 s71, s71, s94
s_add_u32 m0, s77, 16384
s_add_u32 s72, s71, 0
buffer_load_dwordx4 v15, s[24:27], s72 offen lds
v_mfma_f32_16x16x32_bf16 v[96:99], v[128:131], a[48:51], v[96:99]
ds_read_b64_tr_b16 v[196:197], v9 offset:32768
v_mfma_f32_16x16x32_bf16 v[100:103], v[132:135], a[48:51], v[100:103]
ds_read_b64_tr_b16 v[198:199], v9 offset:34816
s_add_u32 s72, s71, 15360
buffer_load_dwordx4 v15, s[24:27], s72 offen offset:1024 lds
v_mfma_f32_16x16x32_bf16 v[84:87], v[132:135], a[32:35], v[84:87]
ds_read_b64_tr_b16 v[200:201], v10 offset:32768
v_mfma_f32_16x16x32_bf16 v[88:91], v[136:139], a[32:35], v[88:91]
ds_read_b64_tr_b16 v[202:203], v10 offset:34816
ds_read_b64_tr_b16 v[204:205], v11 offset:32768
s_add_u32 s72, s71, 30720
buffer_load_dwordx4 v15, s[24:27], s72 offen offset:2048 lds
v_mfma_f32_16x16x32_bf16 v[104:107], v[136:139], a[48:51], v[104:107]
ds_read_b64_tr_b16 v[206:207], v11 offset:34816
v_mfma_f32_16x16x32_bf16 v[108:111], v[140:143], a[48:51], v[108:111]
ds_read_b64_tr_b16 v[208:209], v8 offset:36864
v_mfma_f32_16x16x32_bf16 v[92:95], v[140:143], a[32:35], v[92:95]
ds_read_b64_tr_b16 v[210:211], v8 offset:38912
s_add_u32 s72, s71, 46080
buffer_load_dwordx4 v15, s[24:27], s72 offen offset:3072 lds
v_mfma_f32_16x16x32_bf16 v[80:83], v[144:147], a[36:39], v[80:83]
ds_read_b64_tr_b16 v[212:213], v9 offset:36864
ds_read_b64_tr_b16 v[214:215], v9 offset:38912
v_mfma_f32_16x16x32_bf16 v[96:99], v[144:147], a[52:55], v[96:99]
ds_read_b64_tr_b16 v[216:217], v10 offset:36864
s_add_u32 s69, s61, 0
s_and_b32 s69, s69, 3
s_add_u32 s69, s69, s79
s_lshl_b32 s69, s69, 12
s_add_u32 s69, s69, s95
buffer_load_dwordx4 a[0:3], v1, s[44:47], s69 offen sc1
v_mfma_f32_16x16x32_bf16 v[100:103], v[148:151], a[52:55], v[100:103]
ds_read_b64_tr_b16 v[218:219], v10 offset:38912
v_mfma_f32_16x16x32_bf16 v[84:87], v[148:151], a[36:39], v[84:87]
ds_read_b64_tr_b16 v[220:221], v11 offset:36864
buffer_load_dwordx4 a[4:7], v1, s[44:47], s69 offen offset:1024 sc1
v_mfma_f32_16x16x32_bf16 v[88:91], v[152:155], a[36:39], v[88:91]
ds_read_b64_tr_b16 v[222:223], v11 offset:38912
v_mfma_f32_16x16x32_bf16 v[104:107], v[152:155], a[52:55], v[104:107]
ds_read_b64_tr_b16 v[224:225], v8 offset:40960
ds_read_b64_tr_b16 v[226:227], v8 offset:43008
v_mfma_f32_16x16x32_bf16 v[108:111], v[156:159], a[52:55], v[108:111]
ds_read_b64_tr_b16 v[228:229], v9 offset:40960
buffer_load_dwordx4 a[8:11], v1, s[44:47], s69 offen offset:2048 sc1
v_mfma_f32_16x16x32_bf16 v[92:95], v[156:159], a[36:39], v[92:95]
ds_read_b64_tr_b16 v[230:231], v9 offset:43008
v_mfma_f32_16x16x32_bf16 v[80:83], v[160:163], a[40:43], v[80:83]
ds_read_b64_tr_b16 v[232:233], v10 offset:40960
buffer_load_dwordx4 a[12:15], v1, s[44:47], s69 offen offset:3072 sc1
v_mfma_f32_16x16x32_bf16 v[96:99], v[160:163], a[56:59], v[96:99]
ds_read_b64_tr_b16 v[234:235], v10 offset:43008
ds_read_b64_tr_b16 v[236:237], v11 offset:40960
v_mfma_f32_16x16x32_bf16 v[100:103], v[164:167], a[56:59], v[100:103]
ds_read_b64_tr_b16 v[238:239], v11 offset:43008
s_add_u32 s69, s69, 0x20000
buffer_load_dwordx4 a[16:19], v1, s[44:47], s69 offen sc1
v_mfma_f32_16x16x32_bf16 v[84:87], v[164:167], a[40:43], v[84:87]
ds_read_b64_tr_b16 v[240:241], v8 offset:45056
v_mfma_f32_16x16x32_bf16 v[88:91], v[168:171], a[40:43], v[88:91]
ds_read_b64_tr_b16 v[242:243], v8 offset:47104
v_mfma_f32_16x16x32_bf16 v[104:107], v[168:171], a[56:59], v[104:107]
ds_read_b64_tr_b16 v[244:245], v9 offset:45056
ds_read_b64_tr_b16 v[246:247], v9 offset:47104
buffer_load_dwordx4 a[20:23], v1, s[44:47], s69 offen offset:1024 sc1
v_mfma_f32_16x16x32_bf16 v[108:111], v[172:175], a[56:59], v[108:111]
ds_read_b64_tr_b16 v[248:249], v10 offset:45056
v_mfma_f32_16x16x32_bf16 v[92:95], v[172:175], a[40:43], v[92:95]
ds_read_b64_tr_b16 v[250:251], v10 offset:47104
buffer_load_dwordx4 a[24:27], v1, s[44:47], s69 offen offset:2048 sc1
v_mfma_f32_16x16x32_bf16 v[80:83], v[176:179], a[44:47], v[80:83]
ds_read_b64_tr_b16 v[252:253], v11 offset:45056
v_mfma_f32_16x16x32_bf16 v[96:99], v[176:179], a[60:63], v[96:99]
ds_read_b64_tr_b16 v[254:255], v11 offset:47104
buffer_load_dwordx4 a[28:31], v1, s[44:47], s69 offen offset:3072 sc1
v_mfma_f32_16x16x32_bf16 v[100:103], v[180:183], a[60:63], v[100:103]
v_mfma_f32_16x16x32_bf16 v[84:87], v[180:183], a[44:47], v[84:87]
v_mfma_f32_16x16x32_bf16 v[88:91], v[184:187], a[44:47], v[88:91]
v_mfma_f32_16x16x32_bf16 v[104:107], v[184:187], a[60:63], v[104:107]
v_mfma_f32_16x16x32_bf16 v[108:111], v[188:191], a[60:63], v[108:111]
s_waitcnt vmcnt(24) lgkmcnt(0)
v_mfma_f32_16x16x32_bf16 v[92:95], v[188:191], a[44:47], v[92:95]
s_barrier
v_mfma_f32_16x16x32_bf16 v[80:83], v[192:195], a[64:67], v[80:83]
ds_read_b64_tr_b16 v[128:129], v8 offset:49152
ds_read_b64_tr_b16 v[130:131], v8 offset:51200
s_add_u32 s85, s59, 28
s_and_b32 s85, s85, 28
s_lshl_b32 s85, s85, 10
s_add_u32 s85, s85, s74
buffer_load_dword v3, v2, s[44:47], s85 offen sc1
v_mfma_f32_16x16x32_bf16 v[96:99], v[192:195], a[80:83], v[96:99]
ds_read_b64_tr_b16 v[132:133], v9 offset:49152
v_mfma_f32_16x16x32_bf16 v[100:103], v[196:199], a[80:83], v[100:103]
ds_read_b64_tr_b16 v[134:135], v9 offset:51200
s_add_u32 s71, s61, 2
s_and_b32 s71, s71, 3
s_add_u32 s71, s71, s79
s_lshl_b32 s71, s71, 18
s_add_u32 s71, s71, s94
s_add_u32 m0, s77, 32768
s_add_u32 s72, s71, 0
buffer_load_dwordx4 v15, s[24:27], s72 offen lds
v_mfma_f32_16x16x32_bf16 v[84:87], v[196:199], a[64:67], v[84:87]
ds_read_b64_tr_b16 v[136:137], v10 offset:49152
v_mfma_f32_16x16x32_bf16 v[88:91], v[200:203], a[64:67], v[88:91]
ds_read_b64_tr_b16 v[138:139], v10 offset:51200
ds_read_b64_tr_b16 v[140:141], v11 offset:49152
s_add_u32 s72, s71, 15360
buffer_load_dwordx4 v15, s[24:27], s72 offen offset:1024 lds
v_mfma_f32_16x16x32_bf16 v[104:107], v[200:203], a[80:83], v[104:107]
ds_read_b64_tr_b16 v[142:143], v11 offset:51200
v_mfma_f32_16x16x32_bf16 v[108:111], v[204:207], a[80:83], v[108:111]
ds_read_b64_tr_b16 v[144:145], v8 offset:53248
s_add_u32 s72, s71, 30720
buffer_load_dwordx4 v15, s[24:27], s72 offen offset:2048 lds
v_mfma_f32_16x16x32_bf16 v[92:95], v[204:207], a[64:67], v[92:95]
ds_read_b64_tr_b16 v[146:147], v8 offset:55296
v_mfma_f32_16x16x32_bf16 v[80:83], v[208:211], a[68:71], v[80:83]
ds_read_b64_tr_b16 v[148:149], v9 offset:53248
ds_read_b64_tr_b16 v[150:151], v9 offset:55296
s_add_u32 s72, s71, 46080
buffer_load_dwordx4 v15, s[24:27], s72 offen offset:3072 lds
v_mfma_f32_16x16x32_bf16 v[96:99], v[208:211], a[84:87], v[96:99]
ds_read_b64_tr_b16 v[152:153], v10 offset:53248
v_mfma_f32_16x16x32_bf16 v[100:103], v[212:215], a[84:87], v[100:103]
ds_read_b64_tr_b16 v[154:155], v10 offset:55296
s_add_u32 s69, s61, 1
s_and_b32 s69, s69, 3
s_add_u32 s69, s69, s79
s_lshl_b32 s69, s69, 12
s_add_u32 s69, s69, s95
buffer_load_dwordx4 a[32:35], v1, s[44:47], s69 offen sc1
v_mfma_f32_16x16x32_bf16 v[84:87], v[212:215], a[68:71], v[84:87]
ds_read_b64_tr_b16 v[156:157], v11 offset:53248
v_mfma_f32_16x16x32_bf16 v[88:91], v[216:219], a[68:71], v[88:91]
ds_read_b64_tr_b16 v[158:159], v11 offset:55296
buffer_load_dwordx4 a[36:39], v1, s[44:47], s69 offen offset:1024 sc1
v_mfma_f32_16x16x32_bf16 v[104:107], v[216:219], a[84:87], v[104:107]
ds_read_b64_tr_b16 v[160:161], v8 offset:57344
ds_read_b64_tr_b16 v[162:163], v8 offset:59392
v_mfma_f32_16x16x32_bf16 v[108:111], v[220:223], a[84:87], v[108:111]
ds_read_b64_tr_b16 v[164:165], v9 offset:57344
v_mfma_f32_16x16x32_bf16 v[92:95], v[220:223], a[68:71], v[92:95]
ds_read_b64_tr_b16 v[166:167], v9 offset:59392
buffer_load_dwordx4 a[40:43], v1, s[44:47], s69 offen offset:2048 sc1
v_mfma_f32_16x16x32_bf16 v[80:83], v[224:227], a[72:75], v[80:83]
ds_read_b64_tr_b16 v[168:169], v10 offset:57344
v_mfma_f32_16x16x32_bf16 v[96:99], v[224:227], a[88:91], v[96:99]
ds_read_b64_tr_b16 v[170:171], v10 offset:59392
ds_read_b64_tr_b16 v[172:173], v11 offset:57344
buffer_load_dwordx4 a[44:47], v1, s[44:47], s69 offen offset:3072 sc1
v_mfma_f32_16x16x32_bf16 v[100:103], v[228:231], a[88:91], v[100:103]
ds_read_b64_tr_b16 v[174:175], v11 offset:59392
v_mfma_f32_16x16x32_bf16 v[84:87], v[228:231], a[72:75], v[84:87]
ds_read_b64_tr_b16 v[176:177], v8 offset:61440
s_add_u32 s69, s69, 0x20000
buffer_load_dwordx4 a[48:51], v1, s[44:47], s69 offen sc1
v_mfma_f32_16x16x32_bf16 v[88:91], v[232:235], a[72:75], v[88:91]
ds_read_b64_tr_b16 v[178:179], v8 offset:63488
v_mfma_f32_16x16x32_bf16 v[104:107], v[232:235], a[88:91], v[104:107]
ds_read_b64_tr_b16 v[180:181], v9 offset:61440
ds_read_b64_tr_b16 v[182:183], v9 offset:63488
buffer_load_dwordx4 a[52:55], v1, s[44:47], s69 offen offset:1024 sc1
v_mfma_f32_16x16x32_bf16 v[108:111], v[236:239], a[88:91], v[108:111]
ds_read_b64_tr_b16 v[184:185], v10 offset:61440
v_mfma_f32_16x16x32_bf16 v[92:95], v[236:239], a[72:75], v[92:95]
ds_read_b64_tr_b16 v[186:187], v10 offset:63488
buffer_load_dwordx4 a[56:59], v1, s[44:47], s69 offen offset:2048 sc1
v_mfma_f32_16x16x32_bf16 v[80:83], v[240:243], a[76:79], v[80:83]
ds_read_b64_tr_b16 v[188:189], v11 offset:61440
v_mfma_f32_16x16x32_bf16 v[96:99], v[240:243], a[92:95], v[96:99]
ds_read_b64_tr_b16 v[190:191], v11 offset:63488
buffer_load_dwordx4 a[60:63], v1, s[44:47], s69 offen offset:3072 sc1
v_mfma_f32_16x16x32_bf16 v[100:103], v[244:247], a[92:95], v[100:103]
v_mfma_f32_16x16x32_bf16 v[84:87], v[244:247], a[76:79], v[84:87]
v_mfma_f32_16x16x32_bf16 v[88:91], v[248:251], a[76:79], v[88:91]
v_mfma_f32_16x16x32_bf16 v[104:107], v[248:251], a[92:95], v[104:107]
v_mfma_f32_16x16x32_bf16 v[108:111], v[252:255], a[92:95], v[108:111]
s_waitcnt vmcnt(25) lgkmcnt(0)
v_mfma_f32_16x16x32_bf16 v[92:95], v[252:255], a[76:79], v[92:95]
s_barrier
v_mfma_f32_16x16x32_bf16 v[80:83], v[128:131], a[96:99], v[80:83]
ds_read_b64_tr_b16 v[192:193], v8 offset:0
ds_read_b64_tr_b16 v[194:195], v8 offset:2048
s_add_u32 s71, s61, 3
s_and_b32 s71, s71, 3
s_add_u32 s71, s71, s79
s_lshl_b32 s71, s71, 18
s_add_u32 s71, s71, s94
s_add_u32 m0, s77, 49152
s_add_u32 s72, s71, 0
buffer_load_dwordx4 v15, s[24:27], s72 offen lds
v_mfma_f32_16x16x32_bf16 v[96:99], v[128:131], a[112:115], v[96:99]
ds_read_b64_tr_b16 v[196:197], v9 offset:0
v_mfma_f32_16x16x32_bf16 v[100:103], v[132:135], a[112:115], v[100:103]
ds_read_b64_tr_b16 v[198:199], v9 offset:2048
s_add_u32 s72, s71, 15360
buffer_load_dwordx4 v15, s[24:27], s72 offen offset:1024 lds
v_mfma_f32_16x16x32_bf16 v[84:87], v[132:135], a[96:99], v[84:87]
ds_read_b64_tr_b16 v[200:201], v10 offset:0
v_mfma_f32_16x16x32_bf16 v[88:91], v[136:139], a[96:99], v[88:91]
ds_read_b64_tr_b16 v[202:203], v10 offset:2048
ds_read_b64_tr_b16 v[204:205], v11 offset:0
s_add_u32 s72, s71, 30720
buffer_load_dwordx4 v15, s[24:27], s72 offen offset:2048 lds
v_mfma_f32_16x16x32_bf16 v[104:107], v[136:139], a[112:115], v[104:107]
ds_read_b64_tr_b16 v[206:207], v11 offset:2048
v_mfma_f32_16x16x32_bf16 v[108:111], v[140:143], a[112:115], v[108:111]
ds_read_b64_tr_b16 v[208:209], v8 offset:4096
v_mfma_f32_16x16x32_bf16 v[92:95], v[140:143], a[96:99], v[92:95]
ds_read_b64_tr_b16 v[210:211], v8 offset:6144
s_add_u32 s72, s71, 46080
buffer_load_dwordx4 v15, s[24:27], s72 offen offset:3072 lds
v_mfma_f32_16x16x32_bf16 v[80:83], v[144:147], a[100:103], v[80:83]
ds_read_b64_tr_b16 v[212:213], v9 offset:4096
ds_read_b64_tr_b16 v[214:215], v9 offset:6144
v_mfma_f32_16x16x32_bf16 v[96:99], v[144:147], a[116:119], v[96:99]
ds_read_b64_tr_b16 v[216:217], v10 offset:4096
s_add_u32 s69, s61, 2
s_and_b32 s69, s69, 3
s_add_u32 s69, s69, s79
s_lshl_b32 s69, s69, 12
s_add_u32 s69, s69, s95
buffer_load_dwordx4 a[64:67], v1, s[44:47], s69 offen sc1
v_mfma_f32_16x16x32_bf16 v[100:103], v[148:151], a[116:119], v[100:103]
ds_read_b64_tr_b16 v[218:219], v10 offset:6144
v_mfma_f32_16x16x32_bf16 v[84:87], v[148:151], a[100:103], v[84:87]
ds_read_b64_tr_b16 v[220:221], v11 offset:4096
buffer_load_dwordx4 a[68:71], v1, s[44:47], s69 offen offset:1024 sc1
v_mfma_f32_16x16x32_bf16 v[88:91], v[152:155], a[100:103], v[88:91]
ds_read_b64_tr_b16 v[222:223], v11 offset:6144
v_mfma_f32_16x16x32_bf16 v[104:107], v[152:155], a[116:119], v[104:107]
ds_read_b64_tr_b16 v[224:225], v8 offset:8192
ds_read_b64_tr_b16 v[226:227], v8 offset:10240
v_mfma_f32_16x16x32_bf16 v[108:111], v[156:159], a[116:119], v[108:111]
ds_read_b64_tr_b16 v[228:229], v9 offset:8192
buffer_load_dwordx4 a[72:75], v1, s[44:47], s69 offen offset:2048 sc1
v_mfma_f32_16x16x32_bf16 v[92:95], v[156:159], a[100:103], v[92:95]
ds_read_b64_tr_b16 v[230:231], v9 offset:10240
v_mfma_f32_16x16x32_bf16 v[80:83], v[160:163], a[104:107], v[80:83]
ds_read_b64_tr_b16 v[232:233], v10 offset:8192
buffer_load_dwordx4 a[76:79], v1, s[44:47], s69 offen offset:3072 sc1
v_mfma_f32_16x16x32_bf16 v[96:99], v[160:163], a[120:123], v[96:99]
ds_read_b64_tr_b16 v[234:235], v10 offset:10240
ds_read_b64_tr_b16 v[236:237], v11 offset:8192
v_mfma_f32_16x16x32_bf16 v[100:103], v[164:167], a[120:123], v[100:103]
ds_read_b64_tr_b16 v[238:239], v11 offset:10240
s_add_u32 s69, s69, 0x20000
buffer_load_dwordx4 a[80:83], v1, s[44:47], s69 offen sc1
v_mfma_f32_16x16x32_bf16 v[84:87], v[164:167], a[104:107], v[84:87]
ds_read_b64_tr_b16 v[240:241], v8 offset:12288
v_mfma_f32_16x16x32_bf16 v[88:91], v[168:171], a[104:107], v[88:91]
ds_read_b64_tr_b16 v[242:243], v8 offset:14336
v_mfma_f32_16x16x32_bf16 v[104:107], v[168:171], a[120:123], v[104:107]
ds_read_b64_tr_b16 v[244:245], v9 offset:12288
ds_read_b64_tr_b16 v[246:247], v9 offset:14336
buffer_load_dwordx4 a[84:87], v1, s[44:47], s69 offen offset:1024 sc1
v_mfma_f32_16x16x32_bf16 v[108:111], v[172:175], a[120:123], v[108:111]
ds_read_b64_tr_b16 v[248:249], v10 offset:12288
v_mfma_f32_16x16x32_bf16 v[92:95], v[172:175], a[104:107], v[92:95]
ds_read_b64_tr_b16 v[250:251], v10 offset:14336
buffer_load_dwordx4 a[88:91], v1, s[44:47], s69 offen offset:2048 sc1
v_mfma_f32_16x16x32_bf16 v[80:83], v[176:179], a[108:111], v[80:83]
ds_read_b64_tr_b16 v[252:253], v11 offset:12288
v_mfma_f32_16x16x32_bf16 v[96:99], v[176:179], a[124:127], v[96:99]
ds_read_b64_tr_b16 v[254:255], v11 offset:14336
buffer_load_dwordx4 a[92:95], v1, s[44:47], s69 offen offset:3072 sc1
v_mfma_f32_16x16x32_bf16 v[100:103], v[180:183], a[124:127], v[100:103]
v_mfma_f32_16x16x32_bf16 v[84:87], v[180:183], a[108:111], v[84:87]
v_mfma_f32_16x16x32_bf16 v[88:91], v[184:187], a[108:111], v[88:91]
v_mfma_f32_16x16x32_bf16 v[104:107], v[184:187], a[124:127], v[104:107]
v_mfma_f32_16x16x32_bf16 v[108:111], v[188:191], a[124:127], v[108:111]
s_waitcnt vmcnt(25) lgkmcnt(0)
v_mfma_f32_16x16x32_bf16 v[92:95], v[188:191], a[108:111], v[92:95]
s_barrier
s_add_u32 s78, s59, 28
s_and_b32 s78, s78, 28
v_mfma_f32_16x16x32_bf16 v[80:83], v[192:195], a[0:3], v[80:83]
ds_read_b64_tr_b16 v[128:129], v8 offset:16384
ds_read_b64_tr_b16 v[130:131], v8 offset:18432
s_add_u32 s71, s61, 0
s_and_b32 s71, s71, 3
s_add_u32 s71, s71, s78
s_lshl_b32 s71, s71, 18
s_add_u32 s71, s71, s94
s_add_u32 m0, s77, 0
s_add_u32 s72, s71, 0
buffer_load_dwordx4 v15, s[24:27], s72 offen lds
v_mfma_f32_16x16x32_bf16 v[96:99], v[192:195], a[16:19], v[96:99]
ds_read_b64_tr_b16 v[132:133], v9 offset:16384
v_mfma_f32_16x16x32_bf16 v[100:103], v[196:199], a[16:19], v[100:103]
ds_read_b64_tr_b16 v[134:135], v9 offset:18432
s_add_u32 s72, s71, 15360
buffer_load_dwordx4 v15, s[24:27], s72 offen offset:1024 lds
v_mfma_f32_16x16x32_bf16 v[84:87], v[196:199], a[0:3], v[84:87]
ds_read_b64_tr_b16 v[136:137], v10 offset:16384
v_mfma_f32_16x16x32_bf16 v[88:91], v[200:203], a[0:3], v[88:91]
ds_read_b64_tr_b16 v[138:139], v10 offset:18432
ds_read_b64_tr_b16 v[140:141], v11 offset:16384
s_add_u32 s72, s71, 30720
buffer_load_dwordx4 v15, s[24:27], s72 offen offset:2048 lds
v_mfma_f32_16x16x32_bf16 v[104:107], v[200:203], a[16:19], v[104:107]
ds_read_b64_tr_b16 v[142:143], v11 offset:18432
v_mfma_f32_16x16x32_bf16 v[108:111], v[204:207], a[16:19], v[108:111]
ds_read_b64_tr_b16 v[144:145], v8 offset:20480
v_mfma_f32_16x16x32_bf16 v[92:95], v[204:207], a[0:3], v[92:95]
ds_read_b64_tr_b16 v[146:147], v8 offset:22528
s_add_u32 s72, s71, 46080
buffer_load_dwordx4 v15, s[24:27], s72 offen offset:3072 lds
v_mfma_f32_16x16x32_bf16 v[80:83], v[208:211], a[4:7], v[80:83]
ds_read_b64_tr_b16 v[148:149], v9 offset:20480
ds_read_b64_tr_b16 v[150:151], v9 offset:22528
v_mfma_f32_16x16x32_bf16 v[96:99], v[208:211], a[20:23], v[96:99]
ds_read_b64_tr_b16 v[152:153], v10 offset:20480
s_add_u32 s69, s61, 3
s_and_b32 s69, s69, 3
s_add_u32 s69, s69, s79
s_lshl_b32 s69, s69, 12
s_add_u32 s69, s69, s95
buffer_load_dwordx4 a[96:99], v1, s[44:47], s69 offen sc1
v_mfma_f32_16x16x32_bf16 v[100:103], v[212:215], a[20:23], v[100:103]
ds_read_b64_tr_b16 v[154:155], v10 offset:22528
v_mfma_f32_16x16x32_bf16 v[84:87], v[212:215], a[4:7], v[84:87]
ds_read_b64_tr_b16 v[156:157], v11 offset:20480
buffer_load_dwordx4 a[100:103], v1, s[44:47], s69 offen offset:1024 sc1
v_mfma_f32_16x16x32_bf16 v[88:91], v[216:219], a[4:7], v[88:91]
ds_read_b64_tr_b16 v[158:159], v11 offset:22528
v_mfma_f32_16x16x32_bf16 v[104:107], v[216:219], a[20:23], v[104:107]
ds_read_b64_tr_b16 v[160:161], v8 offset:24576
ds_read_b64_tr_b16 v[162:163], v8 offset:26624
v_mfma_f32_16x16x32_bf16 v[108:111], v[220:223], a[20:23], v[108:111]
ds_read_b64_tr_b16 v[164:165], v9 offset:24576
buffer_load_dwordx4 a[104:107], v1, s[44:47], s69 offen offset:2048 sc1
v_mfma_f32_16x16x32_bf16 v[92:95], v[220:223], a[4:7], v[92:95]
ds_read_b64_tr_b16 v[166:167], v9 offset:26624
v_mfma_f32_16x16x32_bf16 v[80:83], v[224:227], a[8:11], v[80:83]
ds_read_b64_tr_b16 v[168:169], v10 offset:24576
buffer_load_dwordx4 a[108:111], v1, s[44:47], s69 offen offset:3072 sc1
v_mfma_f32_16x16x32_bf16 v[96:99], v[224:227], a[24:27], v[96:99]
ds_read_b64_tr_b16 v[170:171], v10 offset:26624
ds_read_b64_tr_b16 v[172:173], v11 offset:24576
v_mfma_f32_16x16x32_bf16 v[100:103], v[228:231], a[24:27], v[100:103]
ds_read_b64_tr_b16 v[174:175], v11 offset:26624
s_add_u32 s69, s69, 0x20000
buffer_load_dwordx4 a[112:115], v1, s[44:47], s69 offen sc1
v_mfma_f32_16x16x32_bf16 v[84:87], v[228:231], a[8:11], v[84:87]
ds_read_b64_tr_b16 v[176:177], v8 offset:28672
v_mfma_f32_16x16x32_bf16 v[88:91], v[232:235], a[8:11], v[88:91]
ds_read_b64_tr_b16 v[178:179], v8 offset:30720
v_mfma_f32_16x16x32_bf16 v[104:107], v[232:235], a[24:27], v[104:107]
ds_read_b64_tr_b16 v[180:181], v9 offset:28672
ds_read_b64_tr_b16 v[182:183], v9 offset:30720
buffer_load_dwordx4 a[116:119], v1, s[44:47], s69 offen offset:1024 sc1
v_mfma_f32_16x16x32_bf16 v[108:111], v[236:239], a[24:27], v[108:111]
ds_read_b64_tr_b16 v[184:185], v10 offset:28672
v_mfma_f32_16x16x32_bf16 v[92:95], v[236:239], a[8:11], v[92:95]
ds_read_b64_tr_b16 v[186:187], v10 offset:30720
buffer_load_dwordx4 a[120:123], v1, s[44:47], s69 offen offset:2048 sc1
v_mfma_f32_16x16x32_bf16 v[80:83], v[240:243], a[12:15], v[80:83]
ds_read_b64_tr_b16 v[188:189], v11 offset:28672
v_mfma_f32_16x16x32_bf16 v[96:99], v[240:243], a[28:31], v[96:99]
ds_read_b64_tr_b16 v[190:191], v11 offset:30720
buffer_load_dwordx4 a[124:127], v1, s[44:47], s69 offen offset:3072 sc1
v_mfma_f32_16x16x32_bf16 v[100:103], v[244:247], a[28:31], v[100:103]
v_mfma_f32_16x16x32_bf16 v[84:87], v[244:247], a[12:15], v[84:87]
v_mfma_f32_16x16x32_bf16 v[88:91], v[248:251], a[12:15], v[88:91]
v_mfma_f32_16x16x32_bf16 v[104:107], v[248:251], a[28:31], v[104:107]
v_mfma_f32_16x16x32_bf16 v[108:111], v[252:255], a[28:31], v[108:111]
s_waitcnt vmcnt(24) lgkmcnt(0)
v_mfma_f32_16x16x32_bf16 v[92:95], v[252:255], a[12:15], v[92:95]
s_barrier
s_waitcnt vmcnt(36)
v_cmp_gt_u32 vcc, 2, v3
s_cbranch_vccnz Lspin78
Lback79:
v_mfma_f32_16x16x32_bf16 v[80:83], v[128:131], a[32:35], v[80:83]
ds_read_b64_tr_b16 v[192:193], v8 offset:32768
ds_read_b64_tr_b16 v[194:195], v8 offset:34816
s_add_u32 s71, s61, 1
s_and_b32 s71, s71, 3
s_add_u32 s71, s71, s78
s_lshl_b32 s71, s71, 18
s_add_u32 s71, s71, s94
s_add_u32 m0, s77, 16384
s_add_u32 s72, s71, 0
buffer_load_dwordx4 v15, s[24:27], s72 offen lds
v_mfma_f32_16x16x32_bf16 v[96:99], v[128:131], a[48:51], v[96:99]
ds_read_b64_tr_b16 v[196:197], v9 offset:32768
v_mfma_f32_16x16x32_bf16 v[100:103], v[132:135], a[48:51], v[100:103]
ds_read_b64_tr_b16 v[198:199], v9 offset:34816
s_add_u32 s72, s71, 15360
buffer_load_dwordx4 v15, s[24:27], s72 offen offset:1024 lds
v_mfma_f32_16x16x32_bf16 v[84:87], v[132:135], a[32:35], v[84:87]
ds_read_b64_tr_b16 v[200:201], v10 offset:32768
v_mfma_f32_16x16x32_bf16 v[88:91], v[136:139], a[32:35], v[88:91]
ds_read_b64_tr_b16 v[202:203], v10 offset:34816
ds_read_b64_tr_b16 v[204:205], v11 offset:32768
s_add_u32 s72, s71, 30720
buffer_load_dwordx4 v15, s[24:27], s72 offen offset:2048 lds
v_mfma_f32_16x16x32_bf16 v[104:107], v[136:139], a[48:51], v[104:107]
ds_read_b64_tr_b16 v[206:207], v11 offset:34816
v_mfma_f32_16x16x32_bf16 v[108:111], v[140:143], a[48:51], v[108:111]
ds_read_b64_tr_b16 v[208:209], v8 offset:36864
v_mfma_f32_16x16x32_bf16 v[92:95], v[140:143], a[32:35], v[92:95]
ds_read_b64_tr_b16 v[210:211], v8 offset:38912
s_add_u32 s72, s71, 46080
buffer_load_dwordx4 v15, s[24:27], s72 offen offset:3072 lds
v_mfma_f32_16x16x32_bf16 v[80:83], v[144:147], a[36:39], v[80:83]
ds_read_b64_tr_b16 v[212:213], v9 offset:36864
ds_read_b64_tr_b16 v[214:215], v9 offset:38912
v_mfma_f32_16x16x32_bf16 v[96:99], v[144:147], a[52:55], v[96:99]
ds_read_b64_tr_b16 v[216:217], v10 offset:36864
s_add_u32 s69, s61, 0
s_and_b32 s69, s69, 3
s_add_u32 s69, s69, s78
s_lshl_b32 s69, s69, 12
s_add_u32 s69, s69, s95
buffer_load_dwordx4 a[0:3], v1, s[44:47], s69 offen sc1
v_mfma_f32_16x16x32_bf16 v[100:103], v[148:151], a[52:55], v[100:103]
ds_read_b64_tr_b16 v[218:219], v10 offset:38912
v_mfma_f32_16x16x32_bf16 v[84:87], v[148:151], a[36:39], v[84:87]
ds_read_b64_tr_b16 v[220:221], v11 offset:36864
buffer_load_dwordx4 a[4:7], v1, s[44:47], s69 offen offset:1024 sc1
v_mfma_f32_16x16x32_bf16 v[88:91], v[152:155], a[36:39], v[88:91]
ds_read_b64_tr_b16 v[222:223], v11 offset:38912
v_mfma_f32_16x16x32_bf16 v[104:107], v[152:155], a[52:55], v[104:107]
ds_read_b64_tr_b16 v[224:225], v8 offset:40960
ds_read_b64_tr_b16 v[226:227], v8 offset:43008
v_mfma_f32_16x16x32_bf16 v[108:111], v[156:159], a[52:55], v[108:111]
ds_read_b64_tr_b16 v[228:229], v9 offset:40960
buffer_load_dwordx4 a[8:11], v1, s[44:47], s69 offen offset:2048 sc1
v_mfma_f32_16x16x32_bf16 v[92:95], v[156:159], a[36:39], v[92:95]
ds_read_b64_tr_b16 v[230:231], v9 offset:43008
v_mfma_f32_16x16x32_bf16 v[80:83], v[160:163], a[40:43], v[80:83]
ds_read_b64_tr_b16 v[232:233], v10 offset:40960
buffer_load_dwordx4 a[12:15], v1, s[44:47], s69 offen offset:3072 sc1
v_mfma_f32_16x16x32_bf16 v[96:99], v[160:163], a[56:59], v[96:99]
ds_read_b64_tr_b16 v[234:235], v10 offset:43008
ds_read_b64_tr_b16 v[236:237], v11 offset:40960
v_mfma_f32_16x16x32_bf16 v[100:103], v[164:167], a[56:59], v[100:103]
ds_read_b64_tr_b16 v[238:239], v11 offset:43008
s_add_u32 s69, s69, 0x20000
buffer_load_dwordx4 a[16:19], v1, s[44:47], s69 offen sc1
v_mfma_f32_16x16x32_bf16 v[84:87], v[164:167], a[40:43], v[84:87]
ds_read_b64_tr_b16 v[240:241], v8 offset:45056
v_mfma_f32_16x16x32_bf16 v[88:91], v[168:171], a[40:43], v[88:91]
ds_read_b64_tr_b16 v[242:243], v8 offset:47104
v_mfma_f32_16x16x32_bf16 v[104:107], v[168:171], a[56:59], v[104:107]
ds_read_b64_tr_b16 v[244:245], v9 offset:45056
ds_read_b64_tr_b16 v[246:247], v9 offset:47104
buffer_load_dwordx4 a[20:23], v1, s[44:47], s69 offen offset:1024 sc1
v_mfma_f32_16x16x32_bf16 v[108:111], v[172:175], a[56:59], v[108:111]
ds_read_b64_tr_b16 v[248:249], v10 offset:45056
v_mfma_f32_16x16x32_bf16 v[92:95], v[172:175], a[40:43], v[92:95]
ds_read_b64_tr_b16 v[250:251], v10 offset:47104
buffer_load_dwordx4 a[24:27], v1, s[44:47], s69 offen offset:2048 sc1
v_mfma_f32_16x16x32_bf16 v[80:83], v[176:179], a[44:47], v[80:83]
ds_read_b64_tr_b16 v[252:253], v11 offset:45056
v_mfma_f32_16x16x32_bf16 v[96:99], v[176:179], a[60:63], v[96:99]
ds_read_b64_tr_b16 v[254:255], v11 offset:47104
buffer_load_dwordx4 a[28:31], v1, s[44:47], s69 offen offset:3072 sc1
v_mfma_f32_16x16x32_bf16 v[100:103], v[180:183], a[60:63], v[100:103]
v_mfma_f32_16x16x32_bf16 v[84:87], v[180:183], a[44:47], v[84:87]
v_mfma_f32_16x16x32_bf16 v[88:91], v[184:187], a[44:47], v[88:91]
v_mfma_f32_16x16x32_bf16 v[104:107], v[184:187], a[60:63], v[104:107]
v_mfma_f32_16x16x32_bf16 v[108:111], v[188:191], a[60:63], v[108:111]
s_waitcnt vmcnt(24) lgkmcnt(0)
v_mfma_f32_16x16x32_bf16 v[92:95], v[188:191], a[44:47], v[92:95]
s_barrier
v_mfma_f32_16x16x32_bf16 v[80:83], v[192:195], a[64:67], v[80:83]
ds_read_b64_tr_b16 v[128:129], v8 offset:49152
ds_read_b64_tr_b16 v[130:131], v8 offset:51200
s_add_u32 s85, s59, 32
s_and_b32 s85, s85, 28
s_lshl_b32 s85, s85, 10
s_add_u32 s85, s85, s74
buffer_load_dword v3, v2, s[44:47], s85 offen sc1
v_mfma_f32_16x16x32_bf16 v[96:99], v[192:195], a[80:83], v[96:99]
ds_read_b64_tr_b16 v[132:133], v9 offset:49152
v_mfma_f32_16x16x32_bf16 v[100:103], v[196:199], a[80:83], v[100:103]
ds_read_b64_tr_b16 v[134:135], v9 offset:51200
s_add_u32 s71, s61, 2
s_and_b32 s71, s71, 3
s_add_u32 s71, s71, s78
s_lshl_b32 s71, s71, 18
s_add_u32 s71, s71, s94
s_add_u32 m0, s77, 32768
s_add_u32 s72, s71, 0
buffer_load_dwordx4 v15, s[24:27], s72 offen lds
v_mfma_f32_16x16x32_bf16 v[84:87], v[196:199], a[64:67], v[84:87]
ds_read_b64_tr_b16 v[136:137], v10 offset:49152
v_mfma_f32_16x16x32_bf16 v[88:91], v[200:203], a[64:67], v[88:91]
ds_read_b64_tr_b16 v[138:139], v10 offset:51200
ds_read_b64_tr_b16 v[140:141], v11 offset:49152
s_add_u32 s72, s71, 15360
buffer_load_dwordx4 v15, s[24:27], s72 offen offset:1024 lds
v_mfma_f32_16x16x32_bf16 v[104:107], v[200:203], a[80:83], v[104:107]
ds_read_b64_tr_b16 v[142:143], v11 offset:51200
v_mfma_f32_16x16x32_bf16 v[108:111], v[204:207], a[80:83], v[108:111]
ds_read_b64_tr_b16 v[144:145], v8 offset:53248
s_add_u32 s72, s71, 30720
buffer_load_dwordx4 v15, s[24:27], s72 offen offset:2048 lds
v_mfma_f32_16x16x32_bf16 v[92:95], v[204:207], a[64:67], v[92:95]
ds_read_b64_tr_b16 v[146:147], v8 offset:55296
v_mfma_f32_16x16x32_bf16 v[80:83], v[208:211], a[68:71], v[80:83]
ds_read_b64_tr_b16 v[148:149], v9 offset:53248
ds_read_b64_tr_b16 v[150:151], v9 offset:55296
s_add_u32 s72, s71, 46080
buffer_load_dwordx4 v15, s[24:27], s72 offen offset:3072 lds
v_mfma_f32_16x16x32_bf16 v[96:99], v[208:211], a[84:87], v[96:99]
ds_read_b64_tr_b16 v[152:153], v10 offset:53248
v_mfma_f32_16x16x32_bf16 v[100:103], v[212:215], a[84:87], v[100:103]
ds_read_b64_tr_b16 v[154:155], v10 offset:55296
s_add_u32 s69, s61, 1
s_and_b32 s69, s69, 3
s_add_u32 s69, s69, s78
s_lshl_b32 s69, s69, 12
s_add_u32 s69, s69, s95
buffer_load_dwordx4 a[32:35], v1, s[44:47], s69 offen sc1
v_mfma_f32_16x16x32_bf16 v[84:87], v[212:215], a[68:71], v[84:87]
ds_read_b64_tr_b16 v[156:157], v11 offset:53248
v_mfma_f32_16x16x32_bf16 v[88:91], v[216:219], a[68:71], v[88:91]
ds_read_b64_tr_b16 v[158:159], v11 offset:55296
buffer_load_dwordx4 a[36:39], v1, s[44:47], s69 offen offset:1024 sc1
v_mfma_f32_16x16x32_bf16 v[104:107], v[216:219], a[84:87], v[104:107]
ds_read_b64_tr_b16 v[160:161], v8 offset:57344
ds_read_b64_tr_b16 v[162:163], v8 offset:59392
v_mfma_f32_16x16x32_bf16 v[108:111], v[220:223], a[84:87], v[108:111]
ds_read_b64_tr_b16 v[164:165], v9 offset:57344
v_mfma_f32_16x16x32_bf16 v[92:95], v[220:223], a[68:71], v[92:95]
ds_read_b64_tr_b16 v[166:167], v9 offset:59392
buffer_load_dwordx4 a[40:43], v1, s[44:47], s69 offen offset:2048 sc1
v_mfma_f32_16x16x32_bf16 v[80:83], v[224:227], a[72:75], v[80:83]
ds_read_b64_tr_b16 v[168:169], v10 offset:57344
v_mfma_f32_16x16x32_bf16 v[96:99], v[224:227], a[88:91], v[96:99]
ds_read_b64_tr_b16 v[170:171], v10 offset:59392
ds_read_b64_tr_b16 v[172:173], v11 offset:57344
buffer_load_dwordx4 a[44:47], v1, s[44:47], s69 offen offset:3072 sc1
v_mfma_f32_16x16x32_bf16 v[100:103], v[228:231], a[88:91], v[100:103]
ds_read_b64_tr_b16 v[174:175], v11 offset:59392
v_mfma_f32_16x16x32_bf16 v[84:87], v[228:231], a[72:75], v[84:87]
ds_read_b64_tr_b16 v[176:177], v8 offset:61440
s_add_u32 s69, s69, 0x20000
buffer_load_dwordx4 a[48:51], v1, s[44:47], s69 offen sc1
v_mfma_f32_16x16x32_bf16 v[88:91], v[232:235], a[72:75], v[88:91]
ds_read_b64_tr_b16 v[178:179], v8 offset:63488
v_mfma_f32_16x16x32_bf16 v[104:107], v[232:235], a[88:91], v[104:107]
ds_read_b64_tr_b16 v[180:181], v9 offset:61440
ds_read_b64_tr_b16 v[182:183], v9 offset:63488
buffer_load_dwordx4 a[52:55], v1, s[44:47], s69 offen offset:1024 sc1
v_mfma_f32_16x16x32_bf16 v[108:111], v[236:239], a[88:91], v[108:111]
ds_read_b64_tr_b16 v[184:185], v10 offset:61440
v_mfma_f32_16x16x32_bf16 v[92:95], v[236:239], a[72:75], v[92:95]
ds_read_b64_tr_b16 v[186:187], v10 offset:63488
buffer_load_dwordx4 a[56:59], v1, s[44:47], s69 offen offset:2048 sc1
v_mfma_f32_16x16x32_bf16 v[80:83], v[240:243], a[76:79], v[80:83]
ds_read_b64_tr_b16 v[188:189], v11 offset:61440
v_mfma_f32_16x16x32_bf16 v[96:99], v[240:243], a[92:95], v[96:99]
ds_read_b64_tr_b16 v[190:191], v11 offset:63488
buffer_load_dwordx4 a[60:63], v1, s[44:47], s69 offen offset:3072 sc1
v_mfma_f32_16x16x32_bf16 v[100:103], v[244:247], a[92:95], v[100:103]
v_mfma_f32_16x16x32_bf16 v[84:87], v[244:247], a[76:79], v[84:87]
v_mfma_f32_16x16x32_bf16 v[88:91], v[248:251], a[76:79], v[88:91]
v_mfma_f32_16x16x32_bf16 v[104:107], v[248:251], a[92:95], v[104:107]
v_mfma_f32_16x16x32_bf16 v[108:111], v[252:255], a[92:95], v[108:111]
s_waitcnt vmcnt(25) lgkmcnt(0)
v_mfma_f32_16x16x32_bf16 v[92:95], v[252:255], a[76:79], v[92:95]
s_barrier
v_mfma_f32_16x16x32_bf16 v[80:83], v[128:131], a[96:99], v[80:83]
ds_read_b64_tr_b16 v[192:193], v8 offset:0
ds_read_b64_tr_b16 v[194:195], v8 offset:2048
s_add_u32 s71, s61, 3
s_and_b32 s71, s71, 3
s_add_u32 s71, s71, s78
s_lshl_b32 s71, s71, 18
s_add_u32 s71, s71, s94
s_add_u32 m0, s77, 49152
s_add_u32 s72, s71, 0
buffer_load_dwordx4 v15, s[24:27], s72 offen lds
v_mfma_f32_16x16x32_bf16 v[96:99], v[128:131], a[112:115], v[96:99]
ds_read_b64_tr_b16 v[196:197], v9 offset:0
v_mfma_f32_16x16x32_bf16 v[100:103], v[132:135], a[112:115], v[100:103]
ds_read_b64_tr_b16 v[198:199], v9 offset:2048
s_add_u32 s72, s71, 15360
buffer_load_dwordx4 v15, s[24:27], s72 offen offset:1024 lds
v_mfma_f32_16x16x32_bf16 v[84:87], v[132:135], a[96:99], v[84:87]
ds_read_b64_tr_b16 v[200:201], v10 offset:0
v_mfma_f32_16x16x32_bf16 v[88:91], v[136:139], a[96:99], v[88:91]
ds_read_b64_tr_b16 v[202:203], v10 offset:2048
ds_read_b64_tr_b16 v[204:205], v11 offset:0
s_add_u32 s72, s71, 30720
buffer_load_dwordx4 v15, s[24:27], s72 offen offset:2048 lds
v_mfma_f32_16x16x32_bf16 v[104:107], v[136:139], a[112:115], v[104:107]
ds_read_b64_tr_b16 v[206:207], v11 offset:2048
v_mfma_f32_16x16x32_bf16 v[108:111], v[140:143], a[112:115], v[108:111]
ds_read_b64_tr_b16 v[208:209], v8 offset:4096
v_mfma_f32_16x16x32_bf16 v[92:95], v[140:143], a[96:99], v[92:95]
ds_read_b64_tr_b16 v[210:211], v8 offset:6144
s_add_u32 s72, s71, 46080
buffer_load_dwordx4 v15, s[24:27], s72 offen offset:3072 lds
v_mfma_f32_16x16x32_bf16 v[80:83], v[144:147], a[100:103], v[80:83]
ds_read_b64_tr_b16 v[212:213], v9 offset:4096
ds_read_b64_tr_b16 v[214:215], v9 offset:6144
v_mfma_f32_16x16x32_bf16 v[96:99], v[144:147], a[116:119], v[96:99]
ds_read_b64_tr_b16 v[216:217], v10 offset:4096
s_add_u32 s69, s61, 2
s_and_b32 s69, s69, 3
s_add_u32 s69, s69, s78
s_lshl_b32 s69, s69, 12
s_add_u32 s69, s69, s95
buffer_load_dwordx4 a[64:67], v1, s[44:47], s69 offen sc1
v_mfma_f32_16x16x32_bf16 v[100:103], v[148:151], a[116:119], v[100:103]
ds_read_b64_tr_b16 v[218:219], v10 offset:6144
v_mfma_f32_16x16x32_bf16 v[84:87], v[148:151], a[100:103], v[84:87]
ds_read_b64_tr_b16 v[220:221], v11 offset:4096
buffer_load_dwordx4 a[68:71], v1, s[44:47], s69 offen offset:1024 sc1
v_mfma_f32_16x16x32_bf16 v[88:91], v[152:155], a[100:103], v[88:91]
ds_read_b64_tr_b16 v[222:223], v11 offset:6144
v_mfma_f32_16x16x32_bf16 v[104:107], v[152:155], a[116:119], v[104:107]
ds_read_b64_tr_b16 v[224:225], v8 offset:8192
ds_read_b64_tr_b16 v[226:227], v8 offset:10240
v_mfma_f32_16x16x32_bf16 v[108:111], v[156:159], a[116:119], v[108:111]
ds_read_b64_tr_b16 v[228:229], v9 offset:8192
buffer_load_dwordx4 a[72:75], v1, s[44:47], s69 offen offset:2048 sc1
v_mfma_f32_16x16x32_bf16 v[92:95], v[156:159], a[100:103], v[92:95]
ds_read_b64_tr_b16 v[230:231], v9 offset:10240
v_mfma_f32_16x16x32_bf16 v[80:83], v[160:163], a[104:107], v[80:83]
ds_read_b64_tr_b16 v[232:233], v10 offset:8192
buffer_load_dwordx4 a[76:79], v1, s[44:47], s69 offen offset:3072 sc1
v_mfma_f32_16x16x32_bf16 v[96:99], v[160:163], a[120:123], v[96:99]
ds_read_b64_tr_b16 v[234:235], v10 offset:10240
ds_read_b64_tr_b16 v[236:237], v11 offset:8192
v_mfma_f32_16x16x32_bf16 v[100:103], v[164:167], a[120:123], v[100:103]
ds_read_b64_tr_b16 v[238:239], v11 offset:10240
s_add_u32 s69, s69, 0x20000
buffer_load_dwordx4 a[80:83], v1, s[44:47], s69 offen sc1
v_mfma_f32_16x16x32_bf16 v[84:87], v[164:167], a[104:107], v[84:87]
ds_read_b64_tr_b16 v[240:241], v8 offset:12288
v_mfma_f32_16x16x32_bf16 v[88:91], v[168:171], a[104:107], v[88:91]
ds_read_b64_tr_b16 v[242:243], v8 offset:14336
v_mfma_f32_16x16x32_bf16 v[104:107], v[168:171], a[120:123], v[104:107]
ds_read_b64_tr_b16 v[244:245], v9 offset:12288
ds_read_b64_tr_b16 v[246:247], v9 offset:14336
buffer_load_dwordx4 a[84:87], v1, s[44:47], s69 offen offset:1024 sc1
v_mfma_f32_16x16x32_bf16 v[108:111], v[172:175], a[120:123], v[108:111]
ds_read_b64_tr_b16 v[248:249], v10 offset:12288
v_mfma_f32_16x16x32_bf16 v[92:95], v[172:175], a[104:107], v[92:95]
ds_read_b64_tr_b16 v[250:251], v10 offset:14336
buffer_load_dwordx4 a[88:91], v1, s[44:47], s69 offen offset:2048 sc1
v_mfma_f32_16x16x32_bf16 v[80:83], v[176:179], a[108:111], v[80:83]
ds_read_b64_tr_b16 v[252:253], v11 offset:12288
v_mfma_f32_16x16x32_bf16 v[96:99], v[176:179], a[124:127], v[96:99]
ds_read_b64_tr_b16 v[254:255], v11 offset:14336
buffer_load_dwordx4 a[92:95], v1, s[44:47], s69 offen offset:3072 sc1
v_mfma_f32_16x16x32_bf16 v[100:103], v[180:183], a[124:127], v[100:103]
v_mfma_f32_16x16x32_bf16 v[84:87], v[180:183], a[108:111], v[84:87]
v_mfma_f32_16x16x32_bf16 v[88:91], v[184:187], a[108:111], v[88:91]
v_mfma_f32_16x16x32_bf16 v[104:107], v[184:187], a[124:127], v[104:107]
v_mfma_f32_16x16x32_bf16 v[108:111], v[188:191], a[124:127], v[108:111]
s_waitcnt vmcnt(25) lgkmcnt(0)
v_mfma_f32_16x16x32_bf16 v[92:95], v[188:191], a[108:111], v[92:95]
s_barrier
s_add_u32 s79, s59, 32
s_and_b32 s79, s79, 28
v_mfma_f32_16x16x32_bf16 v[80:83], v[192:195], a[0:3], v[80:83]
ds_read_b64_tr_b16 v[128:129], v8 offset:16384
ds_read_b64_tr_b16 v[130:131], v8 offset:18432
s_add_u32 s71, s61, 0
s_and_b32 s71, s71, 3
s_add_u32 s71, s71, s79
s_lshl_b32 s71, s71, 18
s_add_u32 s71, s71, s94
s_add_u32 m0, s77, 0
s_add_u32 s72, s71, 0
buffer_load_dwordx4 v15, s[24:27], s72 offen lds
v_mfma_f32_16x16x32_bf16 v[96:99], v[192:195], a[16:19], v[96:99]
ds_read_b64_tr_b16 v[132:133], v9 offset:16384
v_mfma_f32_16x16x32_bf16 v[100:103], v[196:199], a[16:19], v[100:103]
ds_read_b64_tr_b16 v[134:135], v9 offset:18432
s_add_u32 s72, s71, 15360
buffer_load_dwordx4 v15, s[24:27], s72 offen offset:1024 lds
v_mfma_f32_16x16x32_bf16 v[84:87], v[196:199], a[0:3], v[84:87]
ds_read_b64_tr_b16 v[136:137], v10 offset:16384
v_mfma_f32_16x16x32_bf16 v[88:91], v[200:203], a[0:3], v[88:91]
ds_read_b64_tr_b16 v[138:139], v10 offset:18432
ds_read_b64_tr_b16 v[140:141], v11 offset:16384
s_add_u32 s72, s71, 30720
buffer_load_dwordx4 v15, s[24:27], s72 offen offset:2048 lds
v_mfma_f32_16x16x32_bf16 v[104:107], v[200:203], a[16:19], v[104:107]
ds_read_b64_tr_b16 v[142:143], v11 offset:18432
v_mfma_f32_16x16x32_bf16 v[108:111], v[204:207], a[16:19], v[108:111]
ds_read_b64_tr_b16 v[144:145], v8 offset:20480
v_mfma_f32_16x16x32_bf16 v[92:95], v[204:207], a[0:3], v[92:95]
ds_read_b64_tr_b16 v[146:147], v8 offset:22528
s_add_u32 s72, s71, 46080
buffer_load_dwordx4 v15, s[24:27], s72 offen offset:3072 lds
v_mfma_f32_16x16x32_bf16 v[80:83], v[208:211], a[4:7], v[80:83]
ds_read_b64_tr_b16 v[148:149], v9 offset:20480
ds_read_b64_tr_b16 v[150:151], v9 offset:22528
v_mfma_f32_16x16x32_bf16 v[96:99], v[208:211], a[20:23], v[96:99]
ds_read_b64_tr_b16 v[152:153], v10 offset:20480
s_add_u32 s69, s61, 3
s_and_b32 s69, s69, 3
s_add_u32 s69, s69, s78
s_lshl_b32 s69, s69, 12
s_add_u32 s69, s69, s95
buffer_load_dwordx4 a[96:99], v1, s[44:47], s69 offen sc1
v_mfma_f32_16x16x32_bf16 v[100:103], v[212:215], a[20:23], v[100:103]
ds_read_b64_tr_b16 v[154:155], v10 offset:22528
v_mfma_f32_16x16x32_bf16 v[84:87], v[212:215], a[4:7], v[84:87]
ds_read_b64_tr_b16 v[156:157], v11 offset:20480
buffer_load_dwordx4 a[100:103], v1, s[44:47], s69 offen offset:1024 sc1
v_mfma_f32_16x16x32_bf16 v[88:91], v[216:219], a[4:7], v[88:91]
ds_read_b64_tr_b16 v[158:159], v11 offset:22528
v_mfma_f32_16x16x32_bf16 v[104:107], v[216:219], a[20:23], v[104:107]
ds_read_b64_tr_b16 v[160:161], v8 offset:24576
ds_read_b64_tr_b16 v[162:163], v8 offset:26624
v_mfma_f32_16x16x32_bf16 v[108:111], v[220:223], a[20:23], v[108:111]
ds_read_b64_tr_b16 v[164:165], v9 offset:24576
buffer_load_dwordx4 a[104:107], v1, s[44:47], s69 offen offset:2048 sc1
v_mfma_f32_16x16x32_bf16 v[92:95], v[220:223], a[4:7], v[92:95]
ds_read_b64_tr_b16 v[166:167], v9 offset:26624
v_mfma_f32_16x16x32_bf16 v[80:83], v[224:227], a[8:11], v[80:83]
ds_read_b64_tr_b16 v[168:169], v10 offset:24576
buffer_load_dwordx4 a[108:111], v1, s[44:47], s69 offen offset:3072 sc1
v_mfma_f32_16x16x32_bf16 v[96:99], v[224:227], a[24:27], v[96:99]
ds_read_b64_tr_b16 v[170:171], v10 offset:26624
ds_read_b64_tr_b16 v[172:173], v11 offset:24576
v_mfma_f32_16x16x32_bf16 v[100:103], v[228:231], a[24:27], v[100:103]
ds_read_b64_tr_b16 v[174:175], v11 offset:26624
s_add_u32 s69, s69, 0x20000
buffer_load_dwordx4 a[112:115], v1, s[44:47], s69 offen sc1
v_mfma_f32_16x16x32_bf16 v[84:87], v[228:231], a[8:11], v[84:87]
ds_read_b64_tr_b16 v[176:177], v8 offset:28672
v_mfma_f32_16x16x32_bf16 v[88:91], v[232:235], a[8:11], v[88:91]
ds_read_b64_tr_b16 v[178:179], v8 offset:30720
v_mfma_f32_16x16x32_bf16 v[104:107], v[232:235], a[24:27], v[104:107]
ds_read_b64_tr_b16 v[180:181], v9 offset:28672
ds_read_b64_tr_b16 v[182:183], v9 offset:30720
buffer_load_dwordx4 a[116:119], v1, s[44:47], s69 offen offset:1024 sc1
v_mfma_f32_16x16x32_bf16 v[108:111], v[236:239], a[24:27], v[108:111]
ds_read_b64_tr_b16 v[184:185], v10 offset:28672
v_mfma_f32_16x16x32_bf16 v[92:95], v[236:239], a[8:11], v[92:95]
ds_read_b64_tr_b16 v[186:187], v10 offset:30720
buffer_load_dwordx4 a[120:123], v1, s[44:47], s69 offen offset:2048 sc1
v_mfma_f32_16x16x32_bf16 v[80:83], v[240:243], a[12:15], v[80:83]
ds_read_b64_tr_b16 v[188:189], v11 offset:28672
v_mfma_f32_16x16x32_bf16 v[96:99], v[240:243], a[28:31], v[96:99]
ds_read_b64_tr_b16 v[190:191], v11 offset:30720
buffer_load_dwordx4 a[124:127], v1, s[44:47], s69 offen offset:3072 sc1
v_mfma_f32_16x16x32_bf16 v[100:103], v[244:247], a[28:31], v[100:103]
v_mfma_f32_16x16x32_bf16 v[84:87], v[244:247], a[12:15], v[84:87]
v_mfma_f32_16x16x32_bf16 v[88:91], v[248:251], a[12:15], v[88:91]
v_mfma_f32_16x16x32_bf16 v[104:107], v[248:251], a[28:31], v[104:107]
v_mfma_f32_16x16x32_bf16 v[108:111], v[252:255], a[28:31], v[108:111]
s_waitcnt vmcnt(24) lgkmcnt(0)
v_mfma_f32_16x16x32_bf16 v[92:95], v[252:255], a[12:15], v[92:95]
s_barrier
s_waitcnt vmcnt(36)
v_cmp_gt_u32 vcc, 2, v3
s_cbranch_vccnz Lspin81
Lback82:
v_mfma_f32_16x16x32_bf16 v[80:83], v[128:131], a[32:35], v[80:83]
ds_read_b64_tr_b16 v[192:193], v8 offset:32768
ds_read_b64_tr_b16 v[194:195], v8 offset:34816
s_add_u32 s71, s61, 1
s_and_b32 s71, s71, 3
s_add_u32 s71, s71, s79
s_lshl_b32 s71, s71, 18
s_add_u32 s71, s71, s94
s_add_u32 m0, s77, 16384
s_add_u32 s72, s71, 0
buffer_load_dwordx4 v15, s[24:27], s72 offen lds
v_mfma_f32_16x16x32_bf16 v[96:99], v[128:131], a[48:51], v[96:99]
ds_read_b64_tr_b16 v[196:197], v9 offset:32768
v_mfma_f32_16x16x32_bf16 v[100:103], v[132:135], a[48:51], v[100:103]
ds_read_b64_tr_b16 v[198:199], v9 offset:34816
s_add_u32 s72, s71, 15360
buffer_load_dwordx4 v15, s[24:27], s72 offen offset:1024 lds
v_mfma_f32_16x16x32_bf16 v[84:87], v[132:135], a[32:35], v[84:87]
ds_read_b64_tr_b16 v[200:201], v10 offset:32768
v_mfma_f32_16x16x32_bf16 v[88:91], v[136:139], a[32:35], v[88:91]
ds_read_b64_tr_b16 v[202:203], v10 offset:34816
ds_read_b64_tr_b16 v[204:205], v11 offset:32768
s_add_u32 s72, s71, 30720
buffer_load_dwordx4 v15, s[24:27], s72 offen offset:2048 lds
v_mfma_f32_16x16x32_bf16 v[104:107], v[136:139], a[48:51], v[104:107]
ds_read_b64_tr_b16 v[206:207], v11 offset:34816
v_mfma_f32_16x16x32_bf16 v[108:111], v[140:143], a[48:51], v[108:111]
ds_read_b64_tr_b16 v[208:209], v8 offset:36864
v_mfma_f32_16x16x32_bf16 v[92:95], v[140:143], a[32:35], v[92:95]
ds_read_b64_tr_b16 v[210:211], v8 offset:38912
s_add_u32 s72, s71, 46080
buffer_load_dwordx4 v15, s[24:27], s72 offen offset:3072 lds
v_mfma_f32_16x16x32_bf16 v[80:83], v[144:147], a[36:39], v[80:83]
ds_read_b64_tr_b16 v[212:213], v9 offset:36864
ds_read_b64_tr_b16 v[214:215], v9 offset:38912
v_mfma_f32_16x16x32_bf16 v[96:99], v[144:147], a[52:55], v[96:99]
ds_read_b64_tr_b16 v[216:217], v10 offset:36864
s_add_u32 s69, s61, 0
s_and_b32 s69, s69, 3
s_add_u32 s69, s69, s79
s_lshl_b32 s69, s69, 12
s_add_u32 s69, s69, s95
buffer_load_dwordx4 a[0:3], v1, s[44:47], s69 offen sc1
v_mfma_f32_16x16x32_bf16 v[100:103], v[148:151], a[52:55], v[100:103]
ds_read_b64_tr_b16 v[218:219], v10 offset:38912
v_mfma_f32_16x16x32_bf16 v[84:87], v[148:151], a[36:39], v[84:87]
ds_read_b64_tr_b16 v[220:221], v11 offset:36864
buffer_load_dwordx4 a[4:7], v1, s[44:47], s69 offen offset:1024 sc1
v_mfma_f32_16x16x32_bf16 v[88:91], v[152:155], a[36:39], v[88:91]
ds_read_b64_tr_b16 v[222:223], v11 offset:38912
v_mfma_f32_16x16x32_bf16 v[104:107], v[152:155], a[52:55], v[104:107]
ds_read_b64_tr_b16 v[224:225], v8 offset:40960
ds_read_b64_tr_b16 v[226:227], v8 offset:43008
v_mfma_f32_16x16x32_bf16 v[108:111], v[156:159], a[52:55], v[108:111]
ds_read_b64_tr_b16 v[228:229], v9 offset:40960
buffer_load_dwordx4 a[8:11], v1, s[44:47], s69 offen offset:2048 sc1
v_mfma_f32_16x16x32_bf16 v[92:95], v[156:159], a[36:39], v[92:95]
ds_read_b64_tr_b16 v[230:231], v9 offset:43008
v_mfma_f32_16x16x32_bf16 v[80:83], v[160:163], a[40:43], v[80:83]
ds_read_b64_tr_b16 v[232:233], v10 offset:40960
buffer_load_dwordx4 a[12:15], v1, s[44:47], s69 offen offset:3072 sc1
v_mfma_f32_16x16x32_bf16 v[96:99], v[160:163], a[56:59], v[96:99]
ds_read_b64_tr_b16 v[234:235], v10 offset:43008
ds_read_b64_tr_b16 v[236:237], v11 offset:40960
v_mfma_f32_16x16x32_bf16 v[100:103], v[164:167], a[56:59], v[100:103]
ds_read_b64_tr_b16 v[238:239], v11 offset:43008
s_add_u32 s69, s69, 0x20000
buffer_load_dwordx4 a[16:19], v1, s[44:47], s69 offen sc1
v_mfma_f32_16x16x32_bf16 v[84:87], v[164:167], a[40:43], v[84:87]
ds_read_b64_tr_b16 v[240:241], v8 offset:45056
v_mfma_f32_16x16x32_bf16 v[88:91], v[168:171], a[40:43], v[88:91]
ds_read_b64_tr_b16 v[242:243], v8 offset:47104
v_mfma_f32_16x16x32_bf16 v[104:107], v[168:171], a[56:59], v[104:107]
ds_read_b64_tr_b16 v[244:245], v9 offset:45056
ds_read_b64_tr_b16 v[246:247], v9 offset:47104
buffer_load_dwordx4 a[20:23], v1, s[44:47], s69 offen offset:1024 sc1
v_mfma_f32_16x16x32_bf16 v[108:111], v[172:175], a[56:59], v[108:111]
ds_read_b64_tr_b16 v[248:249], v10 offset:45056
v_mfma_f32_16x16x32_bf16 v[92:95], v[172:175], a[40:43], v[92:95]
ds_read_b64_tr_b16 v[250:251], v10 offset:47104
buffer_load_dwordx4 a[24:27], v1, s[44:47], s69 offen offset:2048 sc1
v_mfma_f32_16x16x32_bf16 v[80:83], v[176:179], a[44:47], v[80:83]
ds_read_b64_tr_b16 v[252:253], v11 offset:45056
v_mfma_f32_16x16x32_bf16 v[96:99], v[176:179], a[60:63], v[96:99]
ds_read_b64_tr_b16 v[254:255], v11 offset:47104
buffer_load_dwordx4 a[28:31], v1, s[44:47], s69 offen offset:3072 sc1
v_mfma_f32_16x16x32_bf16 v[100:103], v[180:183], a[60:63], v[100:103]
v_mfma_f32_16x16x32_bf16 v[84:87], v[180:183], a[44:47], v[84:87]
v_mfma_f32_16x16x32_bf16 v[88:91], v[184:187], a[44:47], v[88:91]
v_mfma_f32_16x16x32_bf16 v[104:107], v[184:187], a[60:63], v[104:107]
v_mfma_f32_16x16x32_bf16 v[108:111], v[188:191], a[60:63], v[108:111]
s_waitcnt vmcnt(24) lgkmcnt(0)
v_mfma_f32_16x16x32_bf16 v[92:95], v[188:191], a[44:47], v[92:95]
s_barrier
v_mfma_f32_16x16x32_bf16 v[80:83], v[192:195], a[64:67], v[80:83]
ds_read_b64_tr_b16 v[128:129], v8 offset:49152
ds_read_b64_tr_b16 v[130:131], v8 offset:51200
s_add_u32 s71, s61, 2
s_and_b32 s71, s71, 3
s_add_u32 s71, s71, s79
s_lshl_b32 s71, s71, 18
s_add_u32 s71, s71, s94
s_add_u32 m0, s77, 32768
s_add_u32 s72, s71, 0
buffer_load_dwordx4 v15, s[24:27], s72 offen lds
s_lshl_b32 s74, s76, 11
s_add_u32 s74, s74, 0x3810000
v_lshrrev_b32 v2, 2, v0
v_lshlrev_b32 v2, 7, v2
buffer_load_dword v3, v2, s[44:47], s74 offen sc1
v_mfma_f32_16x16x32_bf16 v[96:99], v[192:195], a[80:83], v[96:99]
ds_read_b64_tr_b16 v[132:133], v9 offset:49152
v_mfma_f32_16x16x32_bf16 v[100:103], v[196:199], a[80:83], v[100:103]
ds_read_b64_tr_b16 v[134:135], v9 offset:51200
s_add_u32 s72, s71, 15360
buffer_load_dwordx4 v15, s[24:27], s72 offen offset:1024 lds
v_mfma_f32_16x16x32_bf16 v[84:87], v[196:199], a[64:67], v[84:87]
ds_read_b64_tr_b16 v[136:137], v10 offset:49152
v_mfma_f32_16x16x32_bf16 v[88:91], v[200:203], a[64:67], v[88:91]
ds_read_b64_tr_b16 v[138:139], v10 offset:51200
ds_read_b64_tr_b16 v[140:141], v11 offset:49152
s_add_u32 s72, s71, 30720
buffer_load_dwordx4 v15, s[24:27], s72 offen offset:2048 lds
v_mfma_f32_16x16x32_bf16 v[104:107], v[200:203], a[80:83], v[104:107]
ds_read_b64_tr_b16 v[142:143], v11 offset:51200
v_mfma_f32_16x16x32_bf16 v[108:111], v[204:207], a[80:83], v[108:111]
ds_read_b64_tr_b16 v[144:145], v8 offset:53248
v_mfma_f32_16x16x32_bf16 v[92:95], v[204:207], a[64:67], v[92:95]
ds_read_b64_tr_b16 v[146:147], v8 offset:55296
s_add_u32 s72, s71, 46080
buffer_load_dwordx4 v15, s[24:27], s72 offen offset:3072 lds
v_mfma_f32_16x16x32_bf16 v[80:83], v[208:211], a[68:71], v[80:83]
ds_read_b64_tr_b16 v[148:149], v9 offset:53248
ds_read_b64_tr_b16 v[150:151], v9 offset:55296
v_mfma_f32_16x16x32_bf16 v[96:99], v[208:211], a[84:87], v[96:99]
ds_read_b64_tr_b16 v[152:153], v10 offset:53248
s_add_u32 s69, s61, 1
s_and_b32 s69, s69, 3
s_add_u32 s69, s69, s79
s_lshl_b32 s69, s69, 12
s_add_u32 s69, s69, s95
buffer_load_dwordx4 a[32:35], v1, s[44:47], s69 offen sc1
v_mfma_f32_16x16x32_bf16 v[100:103], v[212:215], a[84:87], v[100:103]
ds_read_b64_tr_b16 v[154:155], v10 offset:55296
v_mfma_f32_16x16x32_bf16 v[84:87], v[212:215], a[68:71], v[84:87]
ds_read_b64_tr_b16 v[156:157], v11 offset:53248
buffer_load_dwordx4 a[36:39], v1, s[44:47], s69 offen offset:1024 sc1
v_mfma_f32_16x16x32_bf16 v[88:91], v[216:219], a[68:71], v[88:91]
ds_read_b64_tr_b16 v[158:159], v11 offset:55296
v_mfma_f32_16x16x32_bf16 v[104:107], v[216:219], a[84:87], v[104:107]
ds_read_b64_tr_b16 v[160:161], v8 offset:57344
ds_read_b64_tr_b16 v[162:163], v8 offset:59392
v_mfma_f32_16x16x32_bf16 v[108:111], v[220:223], a[84:87], v[108:111]
ds_read_b64_tr_b16 v[164:165], v9 offset:57344
buffer_load_dwordx4 a[40:43], v1, s[44:47], s69 offen offset:2048 sc1
v_mfma_f32_16x16x32_bf16 v[92:95], v[220:223], a[68:71], v[92:95]
ds_read_b64_tr_b16 v[166:167], v9 offset:59392
v_mfma_f32_16x16x32_bf16 v[80:83], v[224:227], a[72:75], v[80:83]
ds_read_b64_tr_b16 v[168:169], v10 offset:57344
buffer_load_dwordx4 a[44:47], v1, s[44:47], s69 offen offset:3072 sc1
v_mfma_f32_16x16x32_bf16 v[96:99], v[224:227], a[88:91], v[96:99]
ds_read_b64_tr_b16 v[170:171], v10 offset:59392
ds_read_b64_tr_b16 v[172:173], v11 offset:57344
v_mfma_f32_16x16x32_bf16 v[100:103], v[228:231], a[88:91], v[100:103]
ds_read_b64_tr_b16 v[174:175], v11 offset:59392
s_add_u32 s69, s69, 0x20000
buffer_load_dwordx4 a[48:51], v1, s[44:47], s69 offen sc1
v_mfma_f32_16x16x32_bf16 v[84:87], v[228:231], a[72:75], v[84:87]
ds_read_b64_tr_b16 v[176:177], v8 offset:61440
v_mfma_f32_16x16x32_bf16 v[88:91], v[232:235], a[72:75], v[88:91]
ds_read_b64_tr_b16 v[178:179], v8 offset:63488
v_mfma_f32_16x16x32_bf16 v[104:107], v[232:235], a[88:91], v[104:107]
ds_read_b64_tr_b16 v[180:181], v9 offset:61440
ds_read_b64_tr_b16 v[182:183], v9 offset:63488
buffer_load_dwordx4 a[52:55], v1, s[44:47], s69 offen offset:1024 sc1
v_mfma_f32_16x16x32_bf16 v[108:111], v[236:239], a[88:91], v[108:111]
ds_read_b64_tr_b16 v[184:185], v10 offset:61440
v_mfma_f32_16x16x32_bf16 v[92:95], v[236:239], a[72:75], v[92:95]
ds_read_b64_tr_b16 v[186:187], v10 offset:63488
buffer_load_dwordx4 a[56:59], v1, s[44:47], s69 offen offset:2048 sc1
v_mfma_f32_16x16x32_bf16 v[80:83], v[240:243], a[76:79], v[80:83]
ds_read_b64_tr_b16 v[188:189], v11 offset:61440
v_mfma_f32_16x16x32_bf16 v[96:99], v[240:243], a[92:95], v[96:99]
ds_read_b64_tr_b16 v[190:191], v11 offset:63488
buffer_load_dwordx4 a[60:63], v1, s[44:47], s69 offen offset:3072 sc1
v_mfma_f32_16x16x32_bf16 v[100:103], v[244:247], a[92:95], v[100:103]
v_mfma_f32_16x16x32_bf16 v[84:87], v[244:247], a[76:79], v[84:87]
v_mfma_f32_16x16x32_bf16 v[88:91], v[248:251], a[76:79], v[88:91]
v_mfma_f32_16x16x32_bf16 v[104:107], v[248:251], a[92:95], v[104:107]
v_mfma_f32_16x16x32_bf16 v[108:111], v[252:255], a[92:95], v[108:111]
s_waitcnt vmcnt(25) lgkmcnt(0)
v_mfma_f32_16x16x32_bf16 v[92:95], v[252:255], a[76:79], v[92:95]
s_barrier
v_mfma_f32_16x16x32_bf16 v[80:83], v[128:131], a[96:99], v[80:83]
ds_read_b64_tr_b16 v[192:193], v8 offset:0
ds_read_b64_tr_b16 v[194:195], v8 offset:2048
s_add_u32 s71, s61, 3
s_and_b32 s71, s71, 3
s_add_u32 s71, s71, s79
s_lshl_b32 s71, s71, 18
s_add_u32 s71, s71, s94
s_add_u32 m0, s77, 49152
s_add_u32 s72, s71, 0
buffer_load_dwordx4 v15, s[24:27], s72 offen lds
v_mfma_f32_16x16x32_bf16 v[96:99], v[128:131], a[112:115], v[96:99]
ds_read_b64_tr_b16 v[196:197], v9 offset:0
v_mfma_f32_16x16x32_bf16 v[100:103], v[132:135], a[112:115], v[100:103]
ds_read_b64_tr_b16 v[198:199], v9 offset:2048
s_add_u32 s72, s71, 15360
buffer_load_dwordx4 v15, s[24:27], s72 offen offset:1024 lds
v_mfma_f32_16x16x32_bf16 v[84:87], v[132:135], a[96:99], v[84:87]
ds_read_b64_tr_b16 v[200:201], v10 offset:0
v_mfma_f32_16x16x32_bf16 v[88:91], v[136:139], a[96:99], v[88:91]
ds_read_b64_tr_b16 v[202:203], v10 offset:2048
ds_read_b64_tr_b16 v[204:205], v11 offset:0
s_add_u32 s72, s71, 30720
buffer_load_dwordx4 v15, s[24:27], s72 offen offset:2048 lds
v_mfma_f32_16x16x32_bf16 v[104:107], v[136:139], a[112:115], v[104:107]
ds_read_b64_tr_b16 v[206:207], v11 offset:2048
v_mfma_f32_16x16x32_bf16 v[108:111], v[140:143], a[112:115], v[108:111]
ds_read_b64_tr_b16 v[208:209], v8 offset:4096
v_mfma_f32_16x16x32_bf16 v[92:95], v[140:143], a[96:99], v[92:95]
ds_read_b64_tr_b16 v[210:211], v8 offset:6144
s_add_u32 s72, s71, 46080
buffer_load_dwordx4 v15, s[24:27], s72 offen offset:3072 lds
v_mfma_f32_16x16x32_bf16 v[80:83], v[144:147], a[100:103], v[80:83]
ds_read_b64_tr_b16 v[212:213], v9 offset:4096
ds_read_b64_tr_b16 v[214:215], v9 offset:6144
v_mfma_f32_16x16x32_bf16 v[96:99], v[144:147], a[116:119], v[96:99]
ds_read_b64_tr_b16 v[216:217], v10 offset:4096
s_add_u32 s69, s61, 2
s_and_b32 s69, s69, 3
s_add_u32 s69, s69, s79
s_lshl_b32 s69, s69, 12
s_add_u32 s69, s69, s95
buffer_load_dwordx4 a[64:67], v1, s[44:47], s69 offen sc1
v_mfma_f32_16x16x32_bf16 v[100:103], v[148:151], a[116:119], v[100:103]
ds_read_b64_tr_b16 v[218:219], v10 offset:6144
v_mfma_f32_16x16x32_bf16 v[84:87], v[148:151], a[100:103], v[84:87]
ds_read_b64_tr_b16 v[220:221], v11 offset:4096
buffer_load_dwordx4 a[68:71], v1, s[44:47], s69 offen offset:1024 sc1
v_mfma_f32_16x16x32_bf16 v[88:91], v[152:155], a[100:103], v[88:91]
ds_read_b64_tr_b16 v[222:223], v11 offset:6144
v_mfma_f32_16x16x32_bf16 v[104:107], v[152:155], a[116:119], v[104:107]
ds_read_b64_tr_b16 v[224:225], v8 offset:8192
ds_read_b64_tr_b16 v[226:227], v8 offset:10240
v_mfma_f32_16x16x32_bf16 v[108:111], v[156:159], a[116:119], v[108:111]
ds_read_b64_tr_b16 v[228:229], v9 offset:8192
buffer_load_dwordx4 a[72:75], v1, s[44:47], s69 offen offset:2048 sc1
v_mfma_f32_16x16x32_bf16 v[92:95], v[156:159], a[100:103], v[92:95]
ds_read_b64_tr_b16 v[230:231], v9 offset:10240
v_mfma_f32_16x16x32_bf16 v[80:83], v[160:163], a[104:107], v[80:83]
ds_read_b64_tr_b16 v[232:233], v10 offset:8192
buffer_load_dwordx4 a[76:79], v1, s[44:47], s69 offen offset:3072 sc1
v_mfma_f32_16x16x32_bf16 v[96:99], v[160:163], a[120:123], v[96:99]
ds_read_b64_tr_b16 v[234:235], v10 offset:10240
ds_read_b64_tr_b16 v[236:237], v11 offset:8192
v_mfma_f32_16x16x32_bf16 v[100:103], v[164:167], a[120:123], v[100:103]
ds_read_b64_tr_b16 v[238:239], v11 offset:10240
s_add_u32 s69, s69, 0x20000
buffer_load_dwordx4 a[80:83], v1, s[44:47], s69 offen sc1
v_mfma_f32_16x16x32_bf16 v[84:87], v[164:167], a[104:107], v[84:87]
ds_read_b64_tr_b16 v[240:241], v8 offset:12288
v_mfma_f32_16x16x32_bf16 v[88:91], v[168:171], a[104:107], v[88:91]
ds_read_b64_tr_b16 v[242:243], v8 offset:14336
v_mfma_f32_16x16x32_bf16 v[104:107], v[168:171], a[120:123], v[104:107]
ds_read_b64_tr_b16 v[244:245], v9 offset:12288
ds_read_b64_tr_b16 v[246:247], v9 offset:14336
buffer_load_dwordx4 a[84:87], v1, s[44:47], s69 offen offset:1024 sc1
v_mfma_f32_16x16x32_bf16 v[108:111], v[172:175], a[120:123], v[108:111]
ds_read_b64_tr_b16 v[248:249], v10 offset:12288
v_mfma_f32_16x16x32_bf16 v[92:95], v[172:175], a[104:107], v[92:95]
ds_read_b64_tr_b16 v[250:251], v10 offset:14336
buffer_load_dwordx4 a[88:91], v1, s[44:47], s69 offen offset:2048 sc1
v_mfma_f32_16x16x32_bf16 v[80:83], v[176:179], a[108:111], v[80:83]
ds_read_b64_tr_b16 v[252:253], v11 offset:12288
v_mfma_f32_16x16x32_bf16 v[96:99], v[176:179], a[124:127], v[96:99]
ds_read_b64_tr_b16 v[254:255], v11 offset:14336
buffer_load_dwordx4 a[92:95], v1, s[44:47], s69 offen offset:3072 sc1
v_mfma_f32_16x16x32_bf16 v[100:103], v[180:183], a[124:127], v[100:103]
v_mfma_f32_16x16x32_bf16 v[84:87], v[180:183], a[108:111], v[84:87]
v_mfma_f32_16x16x32_bf16 v[88:91], v[184:187], a[108:111], v[88:91]
v_mfma_f32_16x16x32_bf16 v[104:107], v[184:187], a[124:127], v[104:107]
v_mfma_f32_16x16x32_bf16 v[108:111], v[188:191], a[124:127], v[108:111]
s_waitcnt vmcnt(25) lgkmcnt(0)
v_mfma_f32_16x16x32_bf16 v[92:95], v[188:191], a[108:111], v[92:95]
s_barrier
v_mfma_f32_16x16x32_bf16 v[80:83], v[192:195], a[0:3], v[80:83]
ds_read_b64_tr_b16 v[128:129], v8 offset:16384
ds_read_b64_tr_b16 v[130:131], v8 offset:18432
s_add_u32 s69, s61, 3
s_and_b32 s69, s69, 3
s_add_u32 s69, s69, s79
s_lshl_b32 s69, s69, 12
s_add_u32 s69, s69, s95
buffer_load_dwordx4 a[96:99], v1, s[44:47], s69 offen sc1
v_mfma_f32_16x16x32_bf16 v[96:99], v[192:195], a[16:19], v[96:99]
ds_read_b64_tr_b16 v[132:133], v9 offset:16384
v_mfma_f32_16x16x32_bf16 v[100:103], v[196:199], a[16:19], v[100:103]
ds_read_b64_tr_b16 v[134:135], v9 offset:18432
buffer_load_dwordx4 a[100:103], v1, s[44:47], s69 offen offset:1024 sc1
v_mfma_f32_16x16x32_bf16 v[84:87], v[196:199], a[0:3], v[84:87]
ds_read_b64_tr_b16 v[136:137], v10 offset:16384
v_mfma_f32_16x16x32_bf16 v[88:91], v[200:203], a[0:3], v[88:91]
ds_read_b64_tr_b16 v[138:139], v10 offset:18432
ds_read_b64_tr_b16 v[140:141], v11 offset:16384
buffer_load_dwordx4 a[104:107], v1, s[44:47], s69 offen offset:2048 sc1
v_mfma_f32_16x16x32_bf16 v[104:107], v[200:203], a[16:19], v[104:107]
ds_read_b64_tr_b16 v[142:143], v11 offset:18432
v_mfma_f32_16x16x32_bf16 v[108:111], v[204:207], a[16:19], v[108:111]
ds_read_b64_tr_b16 v[144:145], v8 offset:20480
v_mfma_f32_16x16x32_bf16 v[92:95], v[204:207], a[0:3], v[92:95]
ds_read_b64_tr_b16 v[146:147], v8 offset:22528
buffer_load_dwordx4 a[108:111], v1, s[44:47], s69 offen offset:3072 sc1
v_mfma_f32_16x16x32_bf16 v[80:83], v[208:211], a[4:7], v[80:83]
ds_read_b64_tr_b16 v[148:149], v9 offset:20480
ds_read_b64_tr_b16 v[150:151], v9 offset:22528
v_mfma_f32_16x16x32_bf16 v[96:99], v[208:211], a[20:23], v[96:99]
ds_read_b64_tr_b16 v[152:153], v10 offset:20480
s_add_u32 s69, s69, 0x20000
buffer_load_dwordx4 a[112:115], v1, s[44:47], s69 offen sc1
v_mfma_f32_16x16x32_bf16 v[100:103], v[212:215], a[20:23], v[100:103]
ds_read_b64_tr_b16 v[154:155], v10 offset:22528
v_mfma_f32_16x16x32_bf16 v[84:87], v[212:215], a[4:7], v[84:87]
ds_read_b64_tr_b16 v[156:157], v11 offset:20480
buffer_load_dwordx4 a[116:119], v1, s[44:47], s69 offen offset:1024 sc1
v_mfma_f32_16x16x32_bf16 v[88:91], v[216:219], a[4:7], v[88:91]
ds_read_b64_tr_b16 v[158:159], v11 offset:22528
v_mfma_f32_16x16x32_bf16 v[104:107], v[216:219], a[20:23], v[104:107]
ds_read_b64_tr_b16 v[160:161], v8 offset:24576
ds_read_b64_tr_b16 v[162:163], v8 offset:26624
v_mfma_f32_16x16x32_bf16 v[108:111], v[220:223], a[20:23], v[108:111]
ds_read_b64_tr_b16 v[164:165], v9 offset:24576
buffer_load_dwordx4 a[120:123], v1, s[44:47], s69 offen offset:2048 sc1
v_mfma_f32_16x16x32_bf16 v[92:95], v[220:223], a[4:7], v[92:95]
ds_read_b64_tr_b16 v[166:167], v9 offset:26624
v_mfma_f32_16x16x32_bf16 v[80:83], v[224:227], a[8:11], v[80:83]
ds_read_b64_tr_b16 v[168:169], v10 offset:24576
buffer_load_dwordx4 a[124:127], v1, s[44:47], s69 offen offset:3072 sc1
v_mfma_f32_16x16x32_bf16 v[96:99], v[224:227], a[24:27], v[96:99]
ds_read_b64_tr_b16 v[170:171], v10 offset:26624
ds_read_b64_tr_b16 v[172:173], v11 offset:24576
v_mfma_f32_16x16x32_bf16 v[100:103], v[228:231], a[24:27], v[100:103]
ds_read_b64_tr_b16 v[174:175], v11 offset:26624
s_lshl_b32 s70, s75, 18
s_add_u32 s70, s70, s94
s_add_u32 m0, s64, 131072
s_add_u32 s72, s70, 0
buffer_load_dwordx4 v15, s[4:7], s72 offen lds
v_mfma_f32_16x16x32_bf16 v[84:87], v[228:231], a[8:11], v[84:87]
ds_read_b64_tr_b16 v[176:177], v8 offset:28672
v_mfma_f32_16x16x32_bf16 v[88:91], v[232:235], a[8:11], v[88:91]
ds_read_b64_tr_b16 v[178:179], v8 offset:30720
v_mfma_f32_16x16x32_bf16 v[104:107], v[232:235], a[24:27], v[104:107]
ds_read_b64_tr_b16 v[180:181], v9 offset:28672
ds_read_b64_tr_b16 v[182:183], v9 offset:30720
s_add_u32 s72, s70, 15360
buffer_load_dwordx4 v15, s[4:7], s72 offen offset:1024 lds
v_mfma_f32_16x16x32_bf16 v[108:111], v[236:239], a[24:27], v[108:111]
ds_read_b64_tr_b16 v[184:185], v10 offset:28672
v_mfma_f32_16x16x32_bf16 v[92:95], v[236:239], a[8:11], v[92:95]
ds_read_b64_tr_b16 v[186:187], v10 offset:30720
s_add_u32 s72, s70, 30720
buffer_load_dwordx4 v15, s[4:7], s72 offen offset:2048 lds
v_mfma_f32_16x16x32_bf16 v[80:83], v[240:243], a[12:15], v[80:83]
ds_read_b64_tr_b16 v[188:189], v11 offset:28672
v_mfma_f32_16x16x32_bf16 v[96:99], v[240:243], a[28:31], v[96:99]
ds_read_b64_tr_b16 v[190:191], v11 offset:30720
s_add_u32 s72, s70, 46080
buffer_load_dwordx4 v15, s[4:7], s72 offen offset:3072 lds
v_mfma_f32_16x16x32_bf16 v[100:103], v[244:247], a[28:31], v[100:103]
v_mfma_f32_16x16x32_bf16 v[84:87], v[244:247], a[12:15], v[84:87]
v_mfma_f32_16x16x32_bf16 v[88:91], v[248:251], a[12:15], v[88:91]
v_mfma_f32_16x16x32_bf16 v[104:107], v[248:251], a[28:31], v[104:107]
s_waitcnt vmcnt(35)
v_cmp_gt_u32 vcc, 3, v3
s_cbranch_vccnz Lspin84
Lback85:
s_lshl_b32 s73, s76, 18
s_lshl_b32 s74, s58, 16
s_add_u32 s73, s73, s74
s_lshl_b32 s74, s75, 8
s_add_u32 s73, s73, s74
s_add_u32 s73, s73, 0x3400000
v_lshrrev_b32 v112, 4, v0
v_and_b32 v113, 15, v0
v_lshlrev_b32 v114, 4, v113
v_lshl_add_u32 v112, v112, 12, v114
s_add_u32 m0, s64, 147456
s_add_u32 s72, s73, 0
buffer_load_dwordx4 v112, s[44:47], s72 offen sc1 lds
s_add_u32 s72, s73, 15360
buffer_load_dwordx4 v112, s[44:47], s72 offen offset:1024 sc1 lds
s_add_u32 s72, s73, 30720
buffer_load_dwordx4 v112, s[44:47], s72 offen offset:2048 sc1 lds
s_add_u32 s72, s73, 46080
buffer_load_dwordx4 v112, s[44:47], s72 offen offset:3072 sc1 lds
s_lshl_b32 s73, s75, 9
s_lshl_b32 s74, s58, 7
s_add_u32 s73, s73, s74
s_add_u32 s73, s73, 0x3800000
v_lshlrev_b32 v113, 2, v113
buffer_load_dword v6, v113, s[44:47], s73 offen sc1
buffer_load_dword v7, v113, s[44:47], s73 offen offset:64 sc1
v_mfma_f32_16x16x32_bf16 v[108:111], v[252:255], a[28:31], v[108:111]
s_waitcnt vmcnt(30) lgkmcnt(0)
v_mfma_f32_16x16x32_bf16 v[92:95], v[252:255], a[12:15], v[92:95]
s_barrier
v_mfma_f32_16x16x32_bf16 v[80:83], v[128:131], a[32:35], v[80:83]
ds_read_b64_tr_b16 v[192:193], v8 offset:32768
ds_read_b64_tr_b16 v[194:195], v8 offset:34816
v_mfma_f32_16x16x32_bf16 v[96:99], v[128:131], a[48:51], v[96:99]
ds_read_b64_tr_b16 v[196:197], v9 offset:32768
v_mfma_f32_16x16x32_bf16 v[100:103], v[132:135], a[48:51], v[100:103]
ds_read_b64_tr_b16 v[198:199], v9 offset:34816
v_mfma_f32_16x16x32_bf16 v[84:87], v[132:135], a[32:35], v[84:87]
ds_read_b64_tr_b16 v[200:201], v10 offset:32768
v_mfma_f32_16x16x32_bf16 v[88:91], v[136:139], a[32:35], v[88:91]
ds_read_b64_tr_b16 v[202:203], v10 offset:34816
ds_read_b64_tr_b16 v[204:205], v11 offset:32768
v_mfma_f32_16x16x32_bf16 v[104:107], v[136:139], a[48:51], v[104:107]
ds_read_b64_tr_b16 v[206:207], v11 offset:34816
v_mfma_f32_16x16x32_bf16 v[108:111], v[140:143], a[48:51], v[108:111]
ds_read_b64_tr_b16 v[208:209], v8 offset:36864
v_mfma_f32_16x16x32_bf16 v[92:95], v[140:143], a[32:35], v[92:95]
ds_read_b64_tr_b16 v[210:211], v8 offset:38912
v_mfma_f32_16x16x32_bf16 v[80:83], v[144:147], a[36:39], v[80:83]
ds_read_b64_tr_b16 v[212:213], v9 offset:36864
ds_read_b64_tr_b16 v[214:215], v9 offset:38912
v_mfma_f32_16x16x32_bf16 v[96:99], v[144:147], a[52:55], v[96:99]
ds_read_b64_tr_b16 v[216:217], v10 offset:36864
v_mfma_f32_16x16x32_bf16 v[100:103], v[148:151], a[52:55], v[100:103]
ds_read_b64_tr_b16 v[218:219], v10 offset:38912
v_mfma_f32_16x16x32_bf16 v[84:87], v[148:151], a[36:39], v[84:87]
ds_read_b64_tr_b16 v[220:221], v11 offset:36864
v_mfma_f32_16x16x32_bf16 v[88:91], v[152:155], a[36:39], v[88:91]
ds_read_b64_tr_b16 v[222:223], v11 offset:38912
v_mfma_f32_16x16x32_bf16 v[104:107], v[152:155], a[52:55], v[104:107]
ds_read_b64_tr_b16 v[224:225], v8 offset:40960
ds_read_b64_tr_b16 v[226:227], v8 offset:43008
v_mfma_f32_16x16x32_bf16 v[108:111], v[156:159], a[52:55], v[108:111]
ds_read_b64_tr_b16 v[228:229], v9 offset:40960
v_mfma_f32_16x16x32_bf16 v[92:95], v[156:159], a[36:39], v[92:95]
ds_read_b64_tr_b16 v[230:231], v9 offset:43008
v_mfma_f32_16x16x32_bf16 v[80:83], v[160:163], a[40:43], v[80:83]
ds_read_b64_tr_b16 v[232:233], v10 offset:40960
v_mfma_f32_16x16x32_bf16 v[96:99], v[160:163], a[56:59], v[96:99]
ds_read_b64_tr_b16 v[234:235], v10 offset:43008
ds_read_b64_tr_b16 v[236:237], v11 offset:40960
v_mfma_f32_16x16x32_bf16 v[100:103], v[164:167], a[56:59], v[100:103]
ds_read_b64_tr_b16 v[238:239], v11 offset:43008
v_mfma_f32_16x16x32_bf16 v[84:87], v[164:167], a[40:43], v[84:87]
ds_read_b64_tr_b16 v[240:241], v8 offset:45056
v_mfma_f32_16x16x32_bf16 v[88:91], v[168:171], a[40:43], v[88:91]
ds_read_b64_tr_b16 v[242:243], v8 offset:47104
v_mfma_f32_16x16x32_bf16 v[104:107], v[168:171], a[56:59], v[104:107]
ds_read_b64_tr_b16 v[244:245], v9 offset:45056
ds_read_b64_tr_b16 v[246:247], v9 offset:47104
v_mfma_f32_16x16x32_bf16 v[108:111], v[172:175], a[56:59], v[108:111]
ds_read_b64_tr_b16 v[248:249], v10 offset:45056
v_mfma_f32_16x16x32_bf16 v[92:95], v[172:175], a[40:43], v[92:95]
ds_read_b64_tr_b16 v[250:251], v10 offset:47104
v_mfma_f32_16x16x32_bf16 v[80:83], v[176:179], a[44:47], v[80:83]
ds_read_b64_tr_b16 v[252:253], v11 offset:45056
v_mfma_f32_16x16x32_bf16 v[96:99], v[176:179], a[60:63], v[96:99]
ds_read_b64_tr_b16 v[254:255], v11 offset:47104
v_mfma_f32_16x16x32_bf16 v[100:103], v[180:183], a[60:63], v[100:103]
v_mfma_f32_16x16x32_bf16 v[84:87], v[180:183], a[44:47], v[84:87]
v_mfma_f32_16x16x32_bf16 v[88:91], v[184:187], a[44:47], v[88:91]
v_mfma_f32_16x16x32_bf16 v[104:107], v[184:187], a[60:63], v[104:107]
v_mfma_f32_16x16x32_bf16 v[108:111], v[188:191], a[60:63], v[108:111]
s_waitcnt vmcnt(0) lgkmcnt(0)
v_mfma_f32_16x16x32_bf16 v[92:95], v[188:191], a[44:47], v[92:95]
s_barrier
v_mfma_f32_16x16x32_bf16 v[80:83], v[192:195], a[64:67], v[80:83]
ds_read_b64_tr_b16 v[128:129], v8 offset:49152
ds_read_b64_tr_b16 v[130:131], v8 offset:51200
ds_read_b64 v[48:49], v116 offset:0
v_mfma_f32_16x16x32_bf16 v[96:99], v[192:195], a[80:83], v[96:99]
ds_read_b64_tr_b16 v[132:133], v9 offset:49152
ds_read_b64_tr_b16 v[64:65], v5 offset:0
v_mfma_f32_16x16x32_bf16 v[100:103], v[196:199], a[80:83], v[100:103]
ds_read_b64_tr_b16 v[134:135], v9 offset:51200
ds_read_b64 v[50:51], v117 offset:0
v_mfma_f32_16x16x32_bf16 v[84:87], v[196:199], a[64:67], v[84:87]
ds_read_b64_tr_b16 v[136:137], v10 offset:49152
ds_read_b64_tr_b16 v[66:67], v5 offset:4096
v_mfma_f32_16x16x32_bf16 v[88:91], v[200:203], a[64:67], v[88:91]
ds_read_b64_tr_b16 v[138:139], v10 offset:51200
ds_read_b64_tr_b16 v[140:141], v11 offset:49152
ds_read_b64 v[52:53], v118 offset:0
v_mfma_f32_16x16x32_bf16 v[104:107], v[200:203], a[80:83], v[104:107]
ds_read_b64_tr_b16 v[142:143], v11 offset:51200
ds_read_b64_tr_b16 v[68:69], v5 offset:8192
v_mfma_f32_16x16x32_bf16 v[108:111], v[204:207], a[80:83], v[108:111]
ds_read_b64_tr_b16 v[144:145], v8 offset:53248
ds_read_b64 v[54:55], v119 offset:0
v_mfma_f32_16x16x32_bf16 v[92:95], v[204:207], a[64:67], v[92:95]
ds_read_b64_tr_b16 v[146:147], v8 offset:55296
ds_read_b64_tr_b16 v[70:71], v5 offset:12288
v_mfma_f32_16x16x32_bf16 v[80:83], v[208:211], a[68:71], v[80:83]
ds_read_b64_tr_b16 v[148:149], v9 offset:53248
ds_read_b64_tr_b16 v[150:151], v9 offset:55296
ds_read_b64 v[56:57], v116 offset:2048
v_mfma_f32_16x16x32_bf16 v[96:99], v[208:211], a[84:87], v[96:99]
ds_read_b64_tr_b16 v[152:153], v10 offset:53248
ds_read_b64_tr_b16 v[72:73], v5 offset:16
v_mfma_f32_16x16x32_bf16 v[100:103], v[212:215], a[84:87], v[100:103]
ds_read_b64_tr_b16 v[154:155], v10 offset:55296
ds_read_b64 v[58:59], v117 offset:2048
v_mfma_f32_16x16x32_bf16 v[84:87], v[212:215], a[68:71], v[84:87]
ds_read_b64_tr_b16 v[156:157], v11 offset:53248
ds_read_b64_tr_b16 v[74:75], v5 offset:4112
v_mfma_f32_16x16x32_bf16 v[88:91], v[216:219], a[68:71], v[88:91]
ds_read_b64_tr_b16 v[158:159], v11 offset:55296
ds_read_b64 v[60:61], v118 offset:2048
v_mfma_f32_16x16x32_bf16 v[104:107], v[216:219], a[84:87], v[104:107]
ds_read_b64_tr_b16 v[160:161], v8 offset:57344
ds_read_b64_tr_b16 v[162:163], v8 offset:59392
ds_read_b64_tr_b16 v[76:77], v5 offset:8208
v_mfma_f32_16x16x32_bf16 v[108:111], v[220:223], a[84:87], v[108:111]
ds_read_b64_tr_b16 v[164:165], v9 offset:57344
ds_read_b64 v[62:63], v119 offset:2048
v_mfma_f32_16x16x32_bf16 v[92:95], v[220:223], a[68:71], v[92:95]
ds_read_b64_tr_b16 v[166:167], v9 offset:59392
ds_read_b64_tr_b16 v[78:79], v5 offset:12304
v_mfma_f32_16x16x32_bf16 v[80:83], v[224:227], a[72:75], v[80:83]
ds_read_b64_tr_b16 v[168:169], v10 offset:57344
v_mfma_f32_16x16x32_bf16 v[96:99], v[224:227], a[88:91], v[96:99]
ds_read_b64_tr_b16 v[170:171], v10 offset:59392
ds_read_b64_tr_b16 v[172:173], v11 offset:57344
v_mfma_f32_16x16x32_bf16 v[100:103], v[228:231], a[88:91], v[100:103]
ds_read_b64_tr_b16 v[174:175], v11 offset:59392
v_mfma_f32_16x16x32_bf16 v[84:87], v[228:231], a[72:75], v[84:87]
ds_read_b64_tr_b16 v[176:177], v8 offset:61440
v_mfma_f32_16x16x32_bf16 v[88:91], v[232:235], a[72:75], v[88:91]
ds_read_b64_tr_b16 v[178:179], v8 offset:63488
v_mfma_f32_16x16x32_bf16 v[104:107], v[232:235], a[88:91], v[104:107]
ds_read_b64_tr_b16 v[180:181], v9 offset:61440
ds_read_b64_tr_b16 v[182:183], v9 offset:63488
v_mfma_f32_16x16x32_bf16 v[108:111], v[236:239], a[88:91], v[108:111]
ds_read_b64_tr_b16 v[184:185], v10 offset:61440
v_mfma_f32_16x16x32_bf16 v[92:95], v[236:239], a[72:75], v[92:95]
ds_read_b64_tr_b16 v[186:187], v10 offset:63488
v_mfma_f32_16x16x32_bf16 v[80:83], v[240:243], a[76:79], v[80:83]
ds_read_b64_tr_b16 v[188:189], v11 offset:61440
v_mfma_f32_16x16x32_bf16 v[96:99], v[240:243], a[92:95], v[96:99]
ds_read_b64_tr_b16 v[190:191], v11 offset:63488
v_mfma_f32_16x16x32_bf16 v[100:103], v[244:247], a[92:95], v[100:103]
v_mfma_f32_16x16x32_bf16 v[84:87], v[244:247], a[76:79], v[84:87]
v_mfma_f32_16x16x32_bf16 v[88:91], v[248:251], a[76:79], v[88:91]
v_mfma_f32_16x16x32_bf16 v[104:107], v[248:251], a[92:95], v[104:107]
v_mfma_f32_16x16x32_bf16 v[108:111], v[252:255], a[92:95], v[108:111]
s_waitcnt vmcnt(10) lgkmcnt(0)
v_mfma_f32_16x16x32_bf16 v[92:95], v[252:255], a[76:79], v[92:95]
v_mfma_f32_16x16x32_bf16 v[80:83], v[128:131], a[96:99], v[80:83]
v_sub_f32 v112, 1.0, v6
v_sub_f32 v113, 1.0, v7
v_lshlrev_b32 v16, 16, v48
v_lshlrev_b32 v114, 16, v64
v_mfma_f32_16x16x32_bf16 v[96:99], v[128:131], a[112:115], v[96:99]
v_mul_f32 v16, v16, v112
v_mul_f32 v16, v16, v114
v_and_b32 v17, 0xffff0000, v48
v_and_b32 v115, 0xffff0000, v64
v_mfma_f32_16x16x32_bf16 v[100:103], v[132:135], a[112:115], v[100:103]
v_mul_f32 v17, v17, v112
v_mul_f32 v17, v17, v115
v_lshlrev_b32 v18, 16, v49
v_lshlrev_b32 v114, 16, v65
v_mfma_f32_16x16x32_bf16 v[84:87], v[132:135], a[96:99], v[84:87]
v_mul_f32 v18, v18, v112
v_mul_f32 v18, v18, v114
v_and_b32 v19, 0xffff0000, v49
v_and_b32 v115, 0xffff0000, v65
v_mfma_f32_16x16x32_bf16 v[88:91], v[136:139], a[96:99], v[88:91]
v_mul_f32 v19, v19, v112
v_mul_f32 v19, v19, v115
v_lshlrev_b32 v20, 16, v50
v_lshlrev_b32 v114, 16, v66
v_mfma_f32_16x16x32_bf16 v[104:107], v[136:139], a[112:115], v[104:107]
v_mul_f32 v20, v20, v112
v_mul_f32 v20, v20, v114
v_and_b32 v21, 0xffff0000, v50
v_and_b32 v115, 0xffff0000, v66
v_mfma_f32_16x16x32_bf16 v[108:111], v[140:143], a[112:115], v[108:111]
v_mul_f32 v21, v21, v112
v_mul_f32 v21, v21, v115
v_lshlrev_b32 v22, 16, v51
v_lshlrev_b32 v114, 16, v67
v_mfma_f32_16x16x32_bf16 v[92:95], v[140:143], a[96:99], v[92:95]
v_mul_f32 v22, v22, v112
v_mul_f32 v22, v22, v114
v_and_b32 v23, 0xffff0000, v51
v_and_b32 v115, 0xffff0000, v67
v_mfma_f32_16x16x32_bf16 v[80:83], v[144:147], a[100:103], v[80:83]
v_mul_f32 v23, v23, v112
v_mul_f32 v23, v23, v115
v_lshlrev_b32 v24, 16, v52
v_lshlrev_b32 v114, 16, v68
v_mfma_f32_16x16x32_bf16 v[96:99], v[144:147], a[116:119], v[96:99]
v_mul_f32 v24, v24, v112
v_mul_f32 v24, v24, v114
v_and_b32 v25, 0xffff0000, v52
v_and_b32 v115, 0xffff0000, v68
v_mfma_f32_16x16x32_bf16 v[100:103], v[148:151], a[116:119], v[100:103]
v_mul_f32 v25, v25, v112
v_mul_f32 v25, v25, v115
v_lshlrev_b32 v26, 16, v53
v_lshlrev_b32 v114, 16, v69
v_mfma_f32_16x16x32_bf16 v[84:87], v[148:151], a[100:103], v[84:87]
v_mul_f32 v26, v26, v112
v_mul_f32 v26, v26, v114
v_and_b32 v27, 0xffff0000, v53
v_and_b32 v115, 0xffff0000, v69
v_mfma_f32_16x16x32_bf16 v[88:91], v[152:155], a[100:103], v[88:91]
v_mul_f32 v27, v27, v112
v_mul_f32 v27, v27, v115
v_lshlrev_b32 v28, 16, v54
v_lshlrev_b32 v114, 16, v70
v_mfma_f32_16x16x32_bf16 v[104:107], v[152:155], a[116:119], v[104:107]
v_mul_f32 v28, v28, v112
v_mul_f32 v28, v28, v114
v_and_b32 v29, 0xffff0000, v54
v_and_b32 v115, 0xffff0000, v70
v_mfma_f32_16x16x32_bf16 v[108:111], v[156:159], a[116:119], v[108:111]
v_mul_f32 v29, v29, v112
v_mul_f32 v29, v29, v115
v_lshlrev_b32 v30, 16, v55
v_lshlrev_b32 v114, 16, v71
v_mfma_f32_16x16x32_bf16 v[92:95], v[156:159], a[100:103], v[92:95]
v_mul_f32 v30, v30, v112
v_mul_f32 v30, v30, v114
v_and_b32 v31, 0xffff0000, v55
v_and_b32 v115, 0xffff0000, v71
v_mfma_f32_16x16x32_bf16 v[80:83], v[160:163], a[104:107], v[80:83]
v_mul_f32 v31, v31, v112
v_mul_f32 v31, v31, v115
v_lshlrev_b32 v32, 16, v56
v_lshlrev_b32 v114, 16, v72
v_mfma_f32_16x16x32_bf16 v[96:99], v[160:163], a[120:123], v[96:99]
v_mul_f32 v32, v32, v113
v_mul_f32 v32, v32, v114
v_and_b32 v33, 0xffff0000, v56
v_and_b32 v115, 0xffff0000, v72
v_mfma_f32_16x16x32_bf16 v[100:103], v[164:167], a[120:123], v[100:103]
v_mul_f32 v33, v33, v113
v_mul_f32 v33, v33, v115
v_lshlrev_b32 v34, 16, v57
v_lshlrev_b32 v114, 16, v73
v_mfma_f32_16x16x32_bf16 v[84:87], v[164:167], a[104:107], v[84:87]
v_mul_f32 v34, v34, v113
v_mul_f32 v34, v34, v114
v_and_b32 v35, 0xffff0000, v57
v_and_b32 v115, 0xffff0000, v73
v_mfma_f32_16x16x32_bf16 v[88:91], v[168:171], a[104:107], v[88:91]
v_mul_f32 v35, v35, v113
v_mul_f32 v35, v35, v115
v_lshlrev_b32 v36, 16, v58
v_lshlrev_b32 v114, 16, v74
v_mfma_f32_16x16x32_bf16 v[104:107], v[168:171], a[120:123], v[104:107]
v_mul_f32 v36, v36, v113
v_mul_f32 v36, v36, v114
v_and_b32 v37, 0xffff0000, v58
v_and_b32 v115, 0xffff0000, v74
v_mfma_f32_16x16x32_bf16 v[108:111], v[172:175], a[120:123], v[108:111]
v_mul_f32 v37, v37, v113
v_mul_f32 v37, v37, v115
v_lshlrev_b32 v38, 16, v59
v_lshlrev_b32 v114, 16, v75
v_mfma_f32_16x16x32_bf16 v[92:95], v[172:175], a[104:107], v[92:95]
v_mul_f32 v38, v38, v113
v_mul_f32 v38, v38, v114
v_and_b32 v39, 0xffff0000, v59
v_and_b32 v115, 0xffff0000, v75
v_mfma_f32_16x16x32_bf16 v[80:83], v[176:179], a[108:111], v[80:83]
v_mul_f32 v39, v39, v113
v_mul_f32 v39, v39, v115
v_lshlrev_b32 v40, 16, v60
v_lshlrev_b32 v114, 16, v76
v_mfma_f32_16x16x32_bf16 v[96:99], v[176:179], a[124:127], v[96:99]
v_mul_f32 v40, v40, v113
v_mul_f32 v40, v40, v114
v_and_b32 v41, 0xffff0000, v60
v_and_b32 v115, 0xffff0000, v76
v_mfma_f32_16x16x32_bf16 v[100:103], v[180:183], a[124:127], v[100:103]
v_mul_f32 v41, v41, v113
v_mul_f32 v41, v41, v115
v_lshlrev_b32 v42, 16, v61
v_lshlrev_b32 v114, 16, v77
v_mfma_f32_16x16x32_bf16 v[84:87], v[180:183], a[108:111], v[84:87]
v_mul_f32 v42, v42, v113
v_mul_f32 v42, v42, v114
v_and_b32 v43, 0xffff0000, v61
v_and_b32 v115, 0xffff0000, v77
v_mfma_f32_16x16x32_bf16 v[88:91], v[184:187], a[108:111], v[88:91]
v_mul_f32 v43, v43, v113
v_mul_f32 v43, v43, v115
v_lshlrev_b32 v44, 16, v62
v_lshlrev_b32 v114, 16, v78
v_mfma_f32_16x16x32_bf16 v[104:107], v[184:187], a[124:127], v[104:107]
v_mul_f32 v44, v44, v113
v_mul_f32 v44, v44, v114
v_and_b32 v45, 0xffff0000, v62
v_and_b32 v115, 0xffff0000, v78
v_mfma_f32_16x16x32_bf16 v[108:111], v[188:191], a[124:127], v[108:111]
v_mul_f32 v45, v45, v113
v_mul_f32 v45, v45, v115
v_lshlrev_b32 v46, 16, v63
v_lshlrev_b32 v114, 16, v79
v_mfma_f32_16x16x32_bf16 v[92:95], v[188:191], a[108:111], v[92:95]
v_mul_f32 v46, v46, v113
v_mul_f32 v46, v46, v114
v_and_b32 v47, 0xffff0000, v63
v_and_b32 v115, 0xffff0000, v79
v_mul_f32 v47, v47, v113
v_mul_f32 v47, v47, v115
v_fma_f32 v16, v80, v6, v16
v_fma_f32 v17, v81, v6, v17
v_fma_f32 v18, v82, v6, v18
v_fma_f32 v19, v83, v6, v19
v_cvt_pk_bf16_f32 v16, v16, v17
v_cvt_pk_bf16_f32 v17, v18, v19
ds_write_b64 v116, v[16:17] offset:0
v_fma_f32 v20, v84, v6, v20
v_fma_f32 v21, v85, v6, v21
v_fma_f32 v22, v86, v6, v22
v_fma_f32 v23, v87, v6, v23
v_cvt_pk_bf16_f32 v20, v20, v21
v_cvt_pk_bf16_f32 v21, v22, v23
ds_write_b64 v117, v[20:21] offset:0
v_fma_f32 v24, v88, v6, v24
v_fma_f32 v25, v89, v6, v25
v_fma_f32 v26, v90, v6, v26
v_fma_f32 v27, v91, v6, v27
v_cvt_pk_bf16_f32 v24, v24, v25
v_cvt_pk_bf16_f32 v25, v26, v27
ds_write_b64 v118, v[24:25] offset:0
v_fma_f32 v28, v92, v6, v28
v_fma_f32 v29, v93, v6, v29
v_fma_f32 v30, v94, v6, v30
v_fma_f32 v31, v95, v6, v31
v_cvt_pk_bf16_f32 v28, v28, v29
v_cvt_pk_bf16_f32 v29, v30, v31
ds_write_b64 v119, v[28:29] offset:0
v_fma_f32 v32, v96, v7, v32
v_fma_f32 v33, v97, v7, v33
v_fma_f32 v34, v98, v7, v34
v_fma_f32 v35, v99, v7, v35
v_cvt_pk_bf16_f32 v32, v32, v33
v_cvt_pk_bf16_f32 v33, v34, v35
ds_write_b64 v116, v[32:33] offset:2048
v_fma_f32 v36, v100, v7, v36
v_fma_f32 v37, v101, v7, v37
v_fma_f32 v38, v102, v7, v38
v_fma_f32 v39, v103, v7, v39
v_cvt_pk_bf16_f32 v36, v36, v37
v_cvt_pk_bf16_f32 v37, v38, v39
ds_write_b64 v117, v[36:37] offset:2048
v_fma_f32 v40, v104, v7, v40
v_fma_f32 v41, v105, v7, v41
v_fma_f32 v42, v106, v7, v42
v_fma_f32 v43, v107, v7, v43
v_cvt_pk_bf16_f32 v40, v40, v41
v_cvt_pk_bf16_f32 v41, v42, v43
ds_write_b64 v118, v[40:41] offset:2048
v_fma_f32 v44, v108, v7, v44
v_fma_f32 v45, v109, v7, v45
v_fma_f32 v46, v110, v7, v46
v_fma_f32 v47, v111, v7, v47
v_cvt_pk_bf16_f32 v44, v44, v45
v_cvt_pk_bf16_f32 v45, v46, v47
ds_write_b64 v119, v[44:45] offset:2048
s_add_u32 s73, s64, 131072
v_add_u32 v112, s73, v1
ds_read_b128 v[48:51], v112 offset:0
ds_read_b128 v[52:55], v112 offset:1024
ds_read_b128 v[56:59], v112 offset:2048
ds_read_b128 v[60:63], v112 offset:3072
s_waitcnt lgkmcnt(3)
buffer_store_dwordx4 v[48:51], v15, s[40:43], s70 offen sc1
s_add_u32 s70, s70, 0x4000
s_waitcnt lgkmcnt(2)
buffer_store_dwordx4 v[52:55], v15, s[40:43], s70 offen sc1
s_add_u32 s70, s70, 0x4000
s_waitcnt lgkmcnt(1)
buffer_store_dwordx4 v[56:59], v15, s[40:43], s70 offen sc1
s_add_u32 s70, s70, 0x4000
s_waitcnt lgkmcnt(0)
buffer_store_dwordx4 v[60:63], v15, s[40:43], s70 offen sc1
s_add_u32 s70, s70, 0x4000
Lend:
s_endpgm
Lspin1:
s_mov_b32 s83, 262144
Lsl3:
s_sleep 2
buffer_load_dword v3, v2, s[48:51], 0 offen sc1
s_sub_u32 s83, s83, 1
s_cmp_eq_u32 s83, 0
s_waitcnt vmcnt(0)
s_cbranch_scc1 Lback2
v_cmp_gt_u32 vcc, 8, v3
s_cbranch_vccnz Lsl3
s_branch Lback2
Lspin4:
s_mov_b32 s83, 262144
Lsl6:
s_sleep 2
buffer_load_dword v3, v2, s[44:47], s75 offen sc1
s_sub_u32 s83, s83, 1
s_cmp_eq_u32 s83, 0
s_waitcnt vmcnt(0)
s_cbranch_scc1 Lback5
v_cmp_gt_u32 vcc, 1, v3
s_cbranch_vccnz Lsl6
s_branch Lback5
Lalt7:
v_mfma_f32_16x16x32_bf16 v[128:131], a[128:131], v[16:19], v[116:119]
v_mfma_f32_16x16x32_bf16 v[132:135], a[128:131], v[32:35], 0
v_mfma_f32_16x16x32_bf16 v[144:147], a[144:147], v[16:19], v[112:115]
v_mfma_f32_16x16x32_bf16 v[148:151], a[144:147], v[32:35], v[116:119]
s_branch Ljoin8
Lalt9:
s_cmp_eq_u32 s84, 1
s_cbranch_scc1 Ltri10
v_mfma_f32_16x16x32_bf16 v[160:163], a[160:163], v[16:19], v[112:115]
s_xor_b32 s74, s82, 0x10000
v_exp_f32 v128, v128
v_mfma_f32_16x16x32_bf16 v[164:167], a[160:163], v[32:35], v[112:115]
s_add_u32 s74, s74, s64
ds_read_b128 a[128:131], v2 offset:16384
ds_read_b128 a[144:147], v2 offset:20480
v_mfma_f32_16x16x32_bf16 v[176:179], a[176:179], v[16:19], v[112:115]
s_add_u32 s81, s81, 0x8000
v_exp_f32 v129, v129
v_mfma_f32_16x16x32_bf16 v[180:183], a[176:179], v[32:35], v[112:115]
s_add_u32 m0, s74, 16384
v_exp_f32 v130, v130
s_branch Ljoin11
Ltri10:
v_mfma_f32_16x16x32_bf16 v[160:163], a[160:163], v[16:19], v[96:99]
s_xor_b32 s74, s82, 0x10000
v_exp_f32 v128, v128
v_mfma_f32_16x16x32_bf16 v[164:167], a[160:163], v[32:35], v[84:87]
s_add_u32 s74, s74, s64
ds_read_b128 a[128:131], v2 offset:16384
ds_read_b128 a[144:147], v2 offset:20480
v_mfma_f32_16x16x32_bf16 v[176:179], a[176:179], v[16:19], v[112:115]
s_add_u32 s81, s81, 0x8000
v_exp_f32 v129, v129
v_mfma_f32_16x16x32_bf16 v[180:183], a[176:179], v[32:35], v[100:103]
s_add_u32 m0, s74, 16384
v_exp_f32 v130, v130
s_branch Ljoin11
Lalt12:
s_cmp_eq_u32 s84, 2
s_cbranch_scc1 Ltri13
v_mfma_f32_16x16x32_bf16 v[128:131], a[128:131], v[16:19], v[112:115]
s_add_u32 s82, s82, 0x8000
ds_read_b128 a[160:163], v2 offset:24576
v_mfma_f32_16x16x32_bf16 v[132:135], a[128:131], v[32:35], v[112:115]
s_and_b32 s82, s82, 0x1ffff
v_exp_f32 v160, v160
v_mfma_f32_16x16x32_bf16 v[144:147], a[144:147], v[16:19], v[112:115]
s_lshl_b32 s75, s93, 1
v_exp_f32 v161, v161
v_mfma_f32_16x16x32_bf16 v[148:151], a[144:147], v[32:35], v[112:115]
ds_read_b128 a[176:179], v2 offset:28672
v_cvt_pk_bf16_f32 v208, v160, v161
s_branch Ljoin14
Ltri13:
v_mfma_f32_16x16x32_bf16 v[128:131], a[128:131], v[16:19], v[96:99]
s_add_u32 s82, s82, 0x8000
ds_read_b128 a[160:163], v2 offset:24576
v_mfma_f32_16x16x32_bf16 v[132:135], a[128:131], v[32:35], v[84:87]
s_and_b32 s82, s82, 0x1ffff
v_exp_f32 v160, v160
v_mfma_f32_16x16x32_bf16 v[144:147], a[144:147], v[16:19], v[112:115]
s_lshl_b32 s75, s93, 1
v_exp_f32 v161, v161
v_mfma_f32_16x16x32_bf16 v[148:151], a[144:147], v[32:35], v[100:103]
ds_read_b128 a[176:179], v2 offset:28672
v_cvt_pk_bf16_f32 v208, v160, v161
s_branch Ljoin14
Lalt15:
s_cmp_eq_u32 s58, 0
s_cbranch_scc1 Ltri16
v_mfma_f32_16x16x32_bf16 v[128:131], a[128:131], v[16:19], v[112:115]
s_add_u32 s82, s82, 0x8000
ds_read_b128 a[160:163], v2 offset:24576
v_mfma_f32_16x16x32_bf16 v[132:135], a[128:131], v[32:35], v[112:115]
s_and_b32 s82, s82, 0x1ffff
v_exp_f32 v160, v160
v_mfma_f32_16x16x32_bf16 v[144:147], a[144:147], v[16:19], v[112:115]
s_add_u32 m0, s74, 0
v_exp_f32 v161, v161
v_mfma_f32_16x16x32_bf16 v[148:151], a[144:147], v[32:35], v[112:115]
s_add_u32 s72, s81, 0
ds_read_b128 a[176:179], v2 offset:28672
v_cvt_pk_bf16_f32 v208, v160, v161
s_branch Ljoin17
Ltri16:
v_mfma_f32_16x16x32_bf16 v[128:131], a[128:131], v[16:19], v[96:99]
s_add_u32 s82, s82, 0x8000
ds_read_b128 a[160:163], v2 offset:24576
v_mfma_f32_16x16x32_bf16 v[132:135], a[128:131], v[32:35], v[84:87]
s_and_b32 s82, s82, 0x1ffff
v_exp_f32 v160, v160
v_mfma_f32_16x16x32_bf16 v[144:147], a[144:147], v[16:19], v[112:115]
s_add_u32 m0, s74, 0
v_exp_f32 v161, v161
v_mfma_f32_16x16x32_bf16 v[148:151], a[144:147], v[32:35], v[100:103]
s_add_u32 s72, s81, 0
ds_read_b128 a[176:179], v2 offset:28672
v_cvt_pk_bf16_f32 v208, v160, v161
s_branch Ljoin17
Lalt18:
s_cmp_eq_u32 s58, 1
s_cbranch_scc1 Ltri19
v_mfma_f32_16x16x32_bf16 v[160:163], a[160:163], v[16:19], v[112:115]
s_xor_b32 s74, s82, 0x10000
v_exp_f32 v128, v128
v_mfma_f32_16x16x32_bf16 v[164:167], a[160:163], v[32:35], v[112:115]
s_add_u32 s74, s74, s64
ds_read_b128 a[128:131], v2 offset:16384
v_mfma_f32_16x16x32_bf16 v[176:179], a[176:179], v[16:19], v[112:115]
s_add_u32 s81, s81, 0x8000
v_exp_f32 v129, v129
v_mfma_f32_16x16x32_bf16 v[180:183], a[176:179], v[32:35], v[112:115]
s_add_u32 m0, s74, 16384
v_exp_f32 v130, v130
s_branch Ljoin20
Ltri19:
v_mfma_f32_16x16x32_bf16 v[160:163], a[160:163], v[16:19], v[96:99]
s_xor_b32 s74, s82, 0x10000
v_exp_f32 v128, v128
v_mfma_f32_16x16x32_bf16 v[164:167], a[160:163], v[32:35], v[84:87]
s_add_u32 s74, s74, s64
ds_read_b128 a[128:131], v2 offset:16384
v_mfma_f32_16x16x32_bf16 v[176:179], a[176:179], v[16:19], v[112:115]
s_add_u32 s81, s81, 0x8000
v_exp_f32 v129, v129
v_mfma_f32_16x16x32_bf16 v[180:183], a[176:179], v[32:35], v[100:103]
s_add_u32 m0, s74, 16384
v_exp_f32 v130, v130
s_branch Ljoin20
Lalt21:
s_cmp_eq_u32 s58, 2
s_cbranch_scc1 Ltri22
v_mfma_f32_16x16x32_bf16 v[128:131], a[128:131], v[16:19], v[112:115]
s_add_u32 s82, s82, 0x8000
ds_read_b128 a[160:163], v2 offset:24576
v_mfma_f32_16x16x32_bf16 v[132:135], a[128:131], v[32:35], v[112:115]
s_and_b32 s82, s82, 0x1ffff
v_exp_f32 v160, v160
v_mfma_f32_16x16x32_bf16 v[144:147], a[144:147], v[16:19], v[112:115]
s_add_u32 m0, s74, 0
v_exp_f32 v161, v161
v_mfma_f32_16x16x32_bf16 v[148:151], a[144:147], v[32:35], v[112:115]
s_add_u32 s72, s81, 0
ds_read_b128 a[176:179], v2 offset:28672
v_cvt_pk_bf16_f32 v208, v160, v161
s_branch Ljoin23
Ltri22:
v_mfma_f32_16x16x32_bf16 v[128:131], a[128:131], v[16:19], v[96:99]
s_add_u32 s82, s82, 0x8000
ds_read_b128 a[160:163], v2 offset:24576
v_mfma_f32_16x16x32_bf16 v[132:135], a[128:131], v[32:35], v[84:87]
s_and_b32 s82, s82, 0x1ffff
v_exp_f32 v160, v160
v_mfma_f32_16x16x32_bf16 v[144:147], a[144:147], v[16:19], v[112:115]
s_add_u32 m0, s74, 0
v_exp_f32 v161, v161
v_mfma_f32_16x16x32_bf16 v[148:151], a[144:147], v[32:35], v[100:103]
s_add_u32 s72, s81, 0
ds_read_b128 a[176:179], v2 offset:28672
v_cvt_pk_bf16_f32 v208, v160, v161
s_branch Ljoin23
Lalt24:
s_cmp_eq_u32 s58, 3
s_cbranch_scc1 Ltri25
v_mfma_f32_16x16x32_bf16 v[160:163], a[160:163], v[16:19], v[112:115]
s_lshl_b32 s75, s93, 1
v_exp_f32 v128, v128
v_mfma_f32_16x16x32_bf16 v[164:167], a[160:163], v[32:35], v[112:115]
s_add_u32 s75, s75, 0x1000
ds_read_b128 a[128:131], v2 offset:16384
v_mfma_f32_16x16x32_bf16 v[176:179], a[176:179], v[16:19], v[112:115]
v_exp_f32 v129, v129
v_mfma_f32_16x16x32_bf16 v[180:183], a[176:179], v[32:35], v[112:115]
v_exp_f32 v130, v130
s_branch Ljoin26
Ltri25:
v_mfma_f32_16x16x32_bf16 v[160:163], a[160:163], v[16:19], v[96:99]
s_lshl_b32 s75, s93, 1
v_exp_f32 v128, v128
v_mfma_f32_16x16x32_bf16 v[164:167], a[160:163], v[32:35], v[84:87]
s_add_u32 s75, s75, 0x1000
ds_read_b128 a[128:131], v2 offset:16384
v_mfma_f32_16x16x32_bf16 v[176:179], a[176:179], v[16:19], v[112:115]
v_exp_f32 v129, v129
v_mfma_f32_16x16x32_bf16 v[180:183], a[176:179], v[32:35], v[100:103]
v_exp_f32 v130, v130
s_branch Ljoin26
Lalt27:
s_cmp_eq_u32 s85, 0
s_cbranch_scc1 Ltri28
v_mfma_f32_16x16x32_bf16 v[136:139], a[128:131], v[48:51], v[112:115]
s_add_u32 s82, s82, 0x8000
ds_read_b128 a[160:163], v2 offset:24576
ds_read_b128 a[176:179], v2 offset:28672
v_mfma_f32_16x16x32_bf16 v[140:143], a[128:131], v[64:67], v[112:115]
s_and_b32 s82, s82, 0x1ffff
v_exp_f32 v160, v160
v_mfma_f32_16x16x32_bf16 v[152:155], a[144:147], v[48:51], v[112:115]
s_add_u32 m0, s74, 0
v_exp_f32 v161, v161
v_mfma_f32_16x16x32_bf16 v[156:159], a[144:147], v[64:67], v[112:115]
s_add_u32 s72, s81, 0
v_exp_f32 v162, v162
s_branch Ljoin29
Ltri28:
v_mfma_f32_16x16x32_bf16 v[136:139], a[128:131], v[48:51], v[104:107]
s_add_u32 s82, s82, 0x8000
ds_read_b128 a[160:163], v2 offset:24576
ds_read_b128 a[176:179], v2 offset:28672
v_mfma_f32_16x16x32_bf16 v[140:143], a[128:131], v[64:67], v[92:95]
s_and_b32 s82, s82, 0x1ffff
v_exp_f32 v160, v160
v_mfma_f32_16x16x32_bf16 v[152:155], a[144:147], v[48:51], v[112:115]
s_add_u32 m0, s74, 0
v_exp_f32 v161, v161
v_mfma_f32_16x16x32_bf16 v[156:159], a[144:147], v[64:67], v[108:111]
s_add_u32 s72, s81, 0
v_exp_f32 v162, v162
s_branch Ljoin29
Lalt30:
s_cmp_eq_u32 s58, 0
s_cbranch_scc1 Ltri31
v_mfma_f32_16x16x32_bf16 v[136:139], a[128:131], v[48:51], v[112:115]
s_add_u32 s82, s82, 0x8000
ds_read_b128 a[160:163], v2 offset:24576
ds_read_b128 a[176:179], v2 offset:28672
v_mfma_f32_16x16x32_bf16 v[140:143], a[128:131], v[64:67], v[112:115]
s_and_b32 s82, s82, 0x1ffff
v_exp_f32 v168, v168
v_mfma_f32_16x16x32_bf16 v[152:155], a[144:147], v[48:51], v[112:115]
s_add_u32 m0, s66, 32
v_exp_f32 v169, v169
v_mfma_f32_16x16x32_bf16 v[156:159], a[144:147], v[64:67], v[112:115]
s_add_u32 s72, s93, 0x2
ds_read_b128 a[164:167], v2 offset:25600
v_cvt_pk_bf16_f32 v216, v168, v169
s_branch Ljoin32
Ltri31:
v_mfma_f32_16x16x32_bf16 v[136:139], a[128:131], v[48:51], v[104:107]
s_add_u32 s82, s82, 0x8000
ds_read_b128 a[160:163], v2 offset:24576
ds_read_b128 a[176:179], v2 offset:28672
v_mfma_f32_16x16x32_bf16 v[140:143], a[128:131], v[64:67], v[92:95]
s_and_b32 s82, s82, 0x1ffff
v_exp_f32 v168, v168
v_mfma_f32_16x16x32_bf16 v[152:155], a[144:147], v[48:51], v[112:115]
s_add_u32 m0, s66, 32
v_exp_f32 v169, v169
v_mfma_f32_16x16x32_bf16 v[156:159], a[144:147], v[64:67], v[108:111]
s_add_u32 s72, s93, 0x2
ds_read_b128 a[164:167], v2 offset:25600
v_cvt_pk_bf16_f32 v216, v168, v169
s_branch Ljoin32
Lalt33:
s_cmp_eq_u32 s58, 1
s_cbranch_scc1 Ltri34
v_mfma_f32_16x16x32_bf16 v[168:171], a[160:163], v[48:51], v[112:115]
s_add_u32 m0, s92, 8352
v_exp_f32 v136, v136
v_mfma_f32_16x16x32_bf16 v[172:175], a[160:163], v[64:67], v[112:115]
s_add_u32 s72, s93, 0x6
ds_read_b128 a[128:131], v2 offset:16384
ds_read_b128 a[144:147], v2 offset:20480
v_mfma_f32_16x16x32_bf16 v[184:187], a[176:179], v[48:51], v[112:115]
v_exp_f32 v137, v137
v_mfma_f32_16x16x32_bf16 v[188:191], a[176:179], v[64:67], v[112:115]
buffer_load_dwordx4 v1, s[36:39], s72 offen lds
s_branch Ljoin35
Ltri34:
v_mfma_f32_16x16x32_bf16 v[168:171], a[160:163], v[48:51], v[104:107]
s_add_u32 m0, s92, 8352
v_exp_f32 v136, v136
v_mfma_f32_16x16x32_bf16 v[172:175], a[160:163], v[64:67], v[92:95]
s_add_u32 s72, s93, 0x6
ds_read_b128 a[128:131], v2 offset:16384
ds_read_b128 a[144:147], v2 offset:20480
v_mfma_f32_16x16x32_bf16 v[184:187], a[176:179], v[48:51], v[112:115]
v_exp_f32 v137, v137
v_mfma_f32_16x16x32_bf16 v[188:191], a[176:179], v[64:67], v[108:111]
buffer_load_dwordx4 v1, s[36:39], s72 offen lds
s_branch Ljoin35
Lalt36:
s_cmp_eq_u32 s58, 2
s_cbranch_scc1 Ltri37
v_mfma_f32_16x16x32_bf16 v[136:139], a[128:131], v[48:51], v[112:115]
s_add_u32 s82, s82, 0x8000
ds_read_b128 a[160:163], v2 offset:24576
ds_read_b128 a[176:179], v2 offset:28672
v_mfma_f32_16x16x32_bf16 v[140:143], a[128:131], v[64:67], v[112:115]
s_and_b32 s82, s82, 0x1ffff
v_exp_f32 v168, v168
v_mfma_f32_16x16x32_bf16 v[152:155], a[144:147], v[48:51], v[112:115]
v_exp_f32 v169, v169
v_mfma_f32_16x16x32_bf16 v[156:159], a[144:147], v[64:67], v[112:115]
buffer_load_dwordx4 v1, s[44:47], s72 offen offset:1024 sc1 lds
s_branch Ljoin38
Ltri37:
v_mfma_f32_16x16x32_bf16 v[136:139], a[128:131], v[48:51], v[104:107]
s_add_u32 s82, s82, 0x8000
ds_read_b128 a[160:163], v2 offset:24576
ds_read_b128 a[176:179], v2 offset:28672
v_mfma_f32_16x16x32_bf16 v[140:143], a[128:131], v[64:67], v[92:95]
s_and_b32 s82, s82, 0x1ffff
v_exp_f32 v168, v168
v_mfma_f32_16x16x32_bf16 v[152:155], a[144:147], v[48:51], v[112:115]
v_exp_f32 v169, v169
v_mfma_f32_16x16x32_bf16 v[156:159], a[144:147], v[64:67], v[108:111]
buffer_load_dwordx4 v1, s[44:47], s72 offen offset:1024 sc1 lds
s_branch Ljoin38
Lalt39:
s_cmp_eq_u32 s85, 1
s_cbranch_scc1 Ltri40
v_mfma_f32_16x16x32_bf16 v[168:171], a[160:163], v[48:51], v[112:115]
s_add_u32 m0, s66, 32
v_exp_f32 v136, v136
v_mfma_f32_16x16x32_bf16 v[172:175], a[160:163], v[64:67], v[112:115]
s_add_u32 s72, s93, 0x2
ds_read_b128 a[128:131], v2 offset:16384
v_mfma_f32_16x16x32_bf16 v[184:187], a[176:179], v[48:51], v[112:115]
v_exp_f32 v137, v137
v_mfma_f32_16x16x32_bf16 v[188:191], a[176:179], v[64:67], v[112:115]
ds_read_b128 a[144:147], v2 offset:20480
v_cvt_pk_bf16_f32 v200, v136, v137
s_branch Ljoin41
Ltri40:
v_mfma_f32_16x16x32_bf16 v[168:171], a[160:163], v[48:51], v[104:107]
s_add_u32 m0, s66, 32
v_exp_f32 v136, v136
v_mfma_f32_16x16x32_bf16 v[172:175], a[160:163], v[64:67], v[92:95]
s_add_u32 s72, s93, 0x2
ds_read_b128 a[128:131], v2 offset:16384
v_mfma_f32_16x16x32_bf16 v[184:187], a[176:179], v[48:51], v[112:115]
v_exp_f32 v137, v137
v_mfma_f32_16x16x32_bf16 v[188:191], a[176:179], v[64:67], v[108:111]
ds_read_b128 a[144:147], v2 offset:20480
v_cvt_pk_bf16_f32 v200, v136, v137
s_branch Ljoin41
Lalt42:
s_cmp_eq_u32 s85, 2
s_cbranch_scc1 Ltri43
v_mfma_f32_16x16x32_bf16 v[136:139], a[128:131], v[48:51], v[112:115]
s_add_u32 s82, s82, 0x8000
ds_read_b128 a[160:163], v2 offset:24576
ds_read_b128 a[176:179], v2 offset:28672
v_mfma_f32_16x16x32_bf16 v[140:143], a[128:131], v[64:67], v[112:115]
s_and_b32 s82, s82, 0x1ffff
v_exp_f32 v168, v168
v_mfma_f32_16x16x32_bf16 v[152:155], a[144:147], v[48:51], v[112:115]
v_exp_f32 v169, v169
v_mfma_f32_16x16x32_bf16 v[156:159], a[144:147], v[64:67], v[112:115]
buffer_load_dwordx4 v1, s[44:47], s72 offen offset:1024 sc1 lds
s_branch Ljoin44
Ltri43:
v_mfma_f32_16x16x32_bf16 v[136:139], a[128:131], v[48:51], v[104:107]
s_add_u32 s82, s82, 0x8000
ds_read_b128 a[160:163], v2 offset:24576
ds_read_b128 a[176:179], v2 offset:28672
v_mfma_f32_16x16x32_bf16 v[140:143], a[128:131], v[64:67], v[92:95]
s_and_b32 s82, s82, 0x1ffff
v_exp_f32 v168, v168
v_mfma_f32_16x16x32_bf16 v[152:155], a[144:147], v[48:51], v[112:115]
v_exp_f32 v169, v169
v_mfma_f32_16x16x32_bf16 v[156:159], a[144:147], v[64:67], v[108:111]
buffer_load_dwordx4 v1, s[44:47], s72 offen offset:1024 sc1 lds
s_branch Ljoin44
LLT4x:
s_cmp_le_u32 s85, 1
s_cbranch_scc1 Lalt39
v_mfma_f32_16x16x32_bf16 v[168:171], a[160:163], v[48:51], v[88:91]
s_add_u32 m0, s66, 32
v_exp_f32 v136, v136
v_mfma_f32_16x16x32_bf16 v[172:175], a[160:163], v[64:67], v[92:95]
s_add_u32 s72, s93, 0x2
ds_read_b128 a[128:131], v2 offset:16384
v_mfma_f32_16x16x32_bf16 v[184:187], a[176:179], v[48:51], v[88:91]
v_exp_f32 v137, v137
v_mfma_f32_16x16x32_bf16 v[188:191], a[176:179], v[64:67], v[92:95]
ds_read_b128 a[144:147], v2 offset:20480
v_cvt_pk_bf16_f32 v200, v136, v137
Ljoin41:
v_mfma_f32_16x16x32_bf16 v[168:171], a[164:167], v[52:55], v[168:171]
buffer_load_dwordx4 v1, s[36:39], s72 offen lds
v_mfma_f32_16x16x32_bf16 v[172:175], a[164:167], v[68:71], v[172:175]
v_exp_f32 v138, v138
v_mfma_f32_16x16x32_bf16 v[188:191], a[180:183], v[68:71], v[188:191]
ds_read_b128 a[132:135], v2 offset:17408
v_mfma_f32_16x16x32_bf16 v[184:187], a[180:183], v[52:55], v[184:187]
buffer_load_dwordx4 v1, s[36:39], s72 offen offset:1024 lds
v_mfma_f32_16x16x32_bf16 v[172:175], a[168:171], v[72:75], v[172:175]
v_exp_f32 v139, v139
v_mfma_f32_16x16x32_bf16 v[168:171], a[168:171], v[56:59], v[168:171]
ds_read_b128 a[148:151], v2 offset:21504
v_cvt_pk_bf16_f32 v201, v138, v139
v_mfma_f32_16x16x32_bf16 v[184:187], a[184:187], v[56:59], v[184:187]
v_exp_f32 v152, v152
v_mfma_f32_16x16x32_bf16 v[188:191], a[184:187], v[72:75], v[188:191]
ds_read_b128 a[136:139], v2 offset:18432
v_mfma_f32_16x16x32_bf16 v[168:171], a[172:175], v[60:63], v[168:171]
buffer_load_dwordx4 v1, s[36:39], s72 offen offset:2048 lds
v_mfma_f32_16x16x32_bf16 v[172:175], a[172:175], v[76:79], v[172:175]
v_exp_f32 v153, v153
v_mfma_f32_16x16x32_bf16 v[188:191], a[188:191], v[76:79], v[188:191]
ds_read_b128 a[152:155], v2 offset:22528
v_cvt_pk_bf16_f32 v202, v152, v153
v_mfma_f32_16x16x32_bf16 v[184:187], a[188:191], v[60:63], v[184:187]
s_waitcnt lgkmcnt(6)
v_exp_f32 v154, v154
v_mfma_f32_16x16x32_bf16 a[0:3], a[224:227], v[208:211], a[0:3]
ds_read_b128 a[140:143], v2 offset:19456
v_mfma_f32_16x16x32_bf16 a[32:35], a[224:227], v[212:215], a[32:35]
buffer_load_dwordx4 v1, s[36:39], s72 offen offset:3072 lds
v_mfma_f32_16x16x32_bf16 a[64:67], a[224:227], v[216:219], a[64:67]
s_add_u32 m0, s92, 8352
v_exp_f32 v155, v155
v_mfma_f32_16x16x32_bf16 a[96:99], a[224:227], v[220:223], a[96:99]
s_add_u32 s72, s93, 0x6
ds_read_b128 a[156:159], v2 offset:23552
v_cvt_pk_bf16_f32 v203, v154, v155
v_mfma_f32_16x16x32_bf16 a[100:103], a[228:231], v[220:223], a[100:103]
v_exp_f32 v140, v140
v_mfma_f32_16x16x32_bf16 a[68:71], a[228:231], v[216:219], a[68:71]
ds_read_b128 a[192:195], v2 offset:0
v_mfma_f32_16x16x32_bf16 a[36:39], a[228:231], v[212:215], a[36:39]
buffer_load_dwordx4 v1, s[36:39], s72 offen lds
v_mfma_f32_16x16x32_bf16 a[4:7], a[228:231], v[208:211], a[4:7]
v_exp_f32 v141, v141
v_mfma_f32_16x16x32_bf16 a[8:11], a[232:235], v[208:211], a[8:11]
ds_read_b128 a[196:199], v2 offset:1024
v_cvt_pk_bf16_f32 v204, v140, v141
v_mfma_f32_16x16x32_bf16 a[40:43], a[232:235], v[212:215], a[40:43]
buffer_load_dwordx4 v1, s[36:39], s72 offen offset:1024 lds
v_mfma_f32_16x16x32_bf16 a[72:75], a[232:235], v[216:219], a[72:75]
v_exp_f32 v142, v142
v_mfma_f32_16x16x32_bf16 a[104:107], a[232:235], v[220:223], a[104:107]
ds_read_b128 a[200:203], v2 offset:2048
v_mfma_f32_16x16x32_bf16 a[108:111], a[236:239], v[220:223], a[108:111]
v_exp_f32 v143, v143
v_mfma_f32_16x16x32_bf16 a[76:79], a[236:239], v[216:219], a[76:79]
ds_read_b128 a[204:207], v2 offset:3072
v_cvt_pk_bf16_f32 v205, v142, v143
v_mfma_f32_16x16x32_bf16 a[44:47], a[236:239], v[212:215], a[44:47]
buffer_load_dwordx4 v1, s[36:39], s72 offen offset:2048 lds
v_mfma_f32_16x16x32_bf16 a[12:15], a[236:239], v[208:211], a[12:15]
v_exp_f32 v156, v156
v_mfma_f32_16x16x32_bf16 a[16:19], a[240:243], v[208:211], a[16:19]
ds_read_b128 a[208:211], v2 offset:4096
v_mfma_f32_16x16x32_bf16 a[48:51], a[240:243], v[212:215], a[48:51]
v_exp_f32 v157, v157
v_mfma_f32_16x16x32_bf16 a[80:83], a[240:243], v[216:219], a[80:83]
ds_read_b128 a[212:215], v2 offset:5120
v_cvt_pk_bf16_f32 v206, v156, v157
v_mfma_f32_16x16x32_bf16 a[112:115], a[240:243], v[220:223], a[112:115]
buffer_load_dwordx4 v1, s[36:39], s72 offen offset:3072 lds
v_mfma_f32_16x16x32_bf16 a[116:119], a[244:247], v[220:223], a[116:119]
s_add_u32 m0, s62, 0
v_exp_f32 v158, v158
v_mfma_f32_16x16x32_bf16 a[84:87], a[244:247], v[216:219], a[84:87]
s_add_u32 s72, s93, 0x3000000
ds_read_b128 a[216:219], v2 offset:6144
v_mfma_f32_16x16x32_bf16 a[52:55], a[244:247], v[212:215], a[52:55]
v_exp_f32 v159, v159
v_mfma_f32_16x16x32_bf16 a[20:23], a[244:247], v[208:211], a[20:23]
ds_read_b128 a[220:223], v2 offset:7168
v_cvt_pk_bf16_f32 v207, v158, v159
v_mfma_f32_16x16x32_bf16 a[24:27], a[248:251], v[208:211], a[24:27]
buffer_load_dwordx4 v1, s[44:47], s72 offen sc1 lds
v_mfma_f32_16x16x32_bf16 a[56:59], a[248:251], v[212:215], a[56:59]
v_mfma_f32_16x16x32_bf16 a[88:91], a[248:251], v[216:219], a[88:91]
v_mfma_f32_16x16x32_bf16 a[120:123], a[248:251], v[220:223], a[120:123]
v_mfma_f32_16x16x32_bf16 a[124:127], a[252:255], v[220:223], a[124:127]
v_mfma_f32_16x16x32_bf16 a[92:95], a[252:255], v[216:219], a[92:95]
v_mfma_f32_16x16x32_bf16 a[60:63], a[252:255], v[212:215], a[60:63]
v_mfma_f32_16x16x32_bf16 a[28:31], a[252:255], v[208:211], a[28:31]
v_mfma_f32_16x16x32_bf16 v[224:227], v[120:123], v[208:211], v[224:227]
v_mfma_f32_16x16x32_bf16 v[228:231], v[120:123], v[212:215], v[228:231]
v_mfma_f32_16x16x32_bf16 v[232:235], v[120:123], v[216:219], v[232:235]
v_mfma_f32_16x16x32_bf16 v[236:239], v[120:123], v[220:223], v[236:239]
s_waitcnt lgkmcnt(8)
s_nop 3
v_rcp_f32 v224, v224
v_rcp_f32 v228, v228
s_lshl_b32 s73, s59, 12
s_add_u32 s73, s73, 0x2000000
s_lshl_b32 s70, s67, 2
s_add_u32 s70, s70, s73
v_mov_b32 v225, v224
v_accvgpr_read_b32 v240, a0
v_accvgpr_read_b32 v241, a1
v_accvgpr_read_b32 v242, a2
v_accvgpr_read_b32 v243, a3
v_accvgpr_read_b32 v244, a4
v_accvgpr_read_b32 v245, a5
v_accvgpr_read_b32 v246, a6
v_accvgpr_read_b32 v247, a7
v_pk_mul_f32 v[240:241], v[240:241], v[224:225]
v_pk_mul_f32 v[242:243], v[242:243], v[224:225]
v_pk_mul_f32 v[244:245], v[244:245], v[224:225]
v_pk_mul_f32 v[246:247], v[246:247], v[224:225]
v_cvt_pk_bf16_f32 v240, v240, v241
v_cvt_pk_bf16_f32 v241, v242, v243
v_cvt_pk_bf16_f32 v242, v244, v245
v_cvt_pk_bf16_f32 v243, v246, v247
buffer_store_dwordx4 v[240:243], v1, s[44:47], s70 offen sc1
v_accvgpr_read_b32 v248, a8
v_accvgpr_read_b32 v249, a9
v_accvgpr_read_b32 v250, a10
v_accvgpr_read_b32 v251, a11
v_accvgpr_read_b32 v252, a12
v_accvgpr_read_b32 v253, a13
v_accvgpr_read_b32 v254, a14
v_accvgpr_read_b32 v255, a15
v_pk_mul_f32 v[248:249], v[248:249], v[224:225]
v_pk_mul_f32 v[250:251], v[250:251], v[224:225]
v_pk_mul_f32 v[252:253], v[252:253], v[224:225]
v_pk_mul_f32 v[254:255], v[254:255], v[224:225]
v_cvt_pk_bf16_f32 v248, v248, v249
v_cvt_pk_bf16_f32 v249, v250, v251
v_cvt_pk_bf16_f32 v250, v252, v253
v_cvt_pk_bf16_f32 v251, v254, v255
buffer_store_dwordx4 v[248:251], v1, s[44:47], s70 offen offset:1024 sc1
v_accvgpr_read_b32 v240, a16
v_accvgpr_read_b32 v241, a17
v_accvgpr_read_b32 v242, a18
v_accvgpr_read_b32 v243, a19
v_accvgpr_read_b32 v244, a20
v_accvgpr_read_b32 v245, a21
v_accvgpr_read_b32 v246, a22
v_accvgpr_read_b32 v247, a23
v_pk_mul_f32 v[240:241], v[240:241], v[224:225]
v_pk_mul_f32 v[242:243], v[242:243], v[224:225]
v_pk_mul_f32 v[244:245], v[244:245], v[224:225]
v_pk_mul_f32 v[246:247], v[246:247], v[224:225]
v_cvt_pk_bf16_f32 v240, v240, v241
v_cvt_pk_bf16_f32 v241, v242, v243
v_cvt_pk_bf16_f32 v242, v244, v245
v_cvt_pk_bf16_f32 v243, v246, v247
buffer_store_dwordx4 v[240:243], v1, s[44:47], s70 offen offset:2048 sc1
v_accvgpr_read_b32 v248, a24
v_accvgpr_read_b32 v249, a25
v_accvgpr_read_b32 v250, a26
v_accvgpr_read_b32 v251, a27
v_accvgpr_read_b32 v252, a28
v_accvgpr_read_b32 v253, a29
v_accvgpr_read_b32 v254, a30
v_accvgpr_read_b32 v255, a31
v_pk_mul_f32 v[248:249], v[248:249], v[224:225]
v_pk_mul_f32 v[250:251], v[250:251], v[224:225]
v_pk_mul_f32 v[252:253], v[252:253], v[224:225]
v_pk_mul_f32 v[254:255], v[254:255], v[224:225]
v_cvt_pk_bf16_f32 v248, v248, v249
v_cvt_pk_bf16_f32 v249, v250, v251
v_cvt_pk_bf16_f32 v250, v252, v253
v_cvt_pk_bf16_f32 v251, v254, v255
buffer_store_dwordx4 v[248:251], v1, s[44:47], s70 offen offset:3072 sc1
s_add_u32 s70, s70, 0x20000
v_mov_b32 v229, v228
v_accvgpr_read_b32 v240, a32
v_accvgpr_read_b32 v241, a33
v_accvgpr_read_b32 v242, a34
v_accvgpr_read_b32 v243, a35
v_accvgpr_read_b32 v244, a36
v_accvgpr_read_b32 v245, a37
v_accvgpr_read_b32 v246, a38
v_accvgpr_read_b32 v247, a39
v_pk_mul_f32 v[240:241], v[240:241], v[228:229]
v_pk_mul_f32 v[242:243], v[242:243], v[228:229]
v_pk_mul_f32 v[244:245], v[244:245], v[228:229]
v_pk_mul_f32 v[246:247], v[246:247], v[228:229]
v_cvt_pk_bf16_f32 v240, v240, v241
v_cvt_pk_bf16_f32 v241, v242, v243
v_cvt_pk_bf16_f32 v242, v244, v245
v_cvt_pk_bf16_f32 v243, v246, v247
buffer_store_dwordx4 v[240:243], v1, s[44:47], s70 offen sc1
v_accvgpr_read_b32 v248, a40
v_accvgpr_read_b32 v249, a41
v_accvgpr_read_b32 v250, a42
v_accvgpr_read_b32 v251, a43
v_accvgpr_read_b32 v252, a44
v_accvgpr_read_b32 v253, a45
v_accvgpr_read_b32 v254, a46
v_accvgpr_read_b32 v255, a47
v_pk_mul_f32 v[248:249], v[248:249], v[228:229]
v_pk_mul_f32 v[250:251], v[250:251], v[228:229]
v_pk_mul_f32 v[252:253], v[252:253], v[228:229]
v_pk_mul_f32 v[254:255], v[254:255], v[228:229]
v_cvt_pk_bf16_f32 v248, v248, v249
v_cvt_pk_bf16_f32 v249, v250, v251
v_cvt_pk_bf16_f32 v250, v252, v253
v_cvt_pk_bf16_f32 v251, v254, v255
buffer_store_dwordx4 v[248:251], v1, s[44:47], s70 offen offset:1024 sc1
v_accvgpr_read_b32 v240, a48
v_accvgpr_read_b32 v241, a49
v_accvgpr_read_b32 v242, a50
v_accvgpr_read_b32 v243, a51
v_accvgpr_read_b32 v244, a52
v_accvgpr_read_b32 v245, a53
v_accvgpr_read_b32 v246, a54
v_accvgpr_read_b32 v247, a55
v_pk_mul_f32 v[240:241], v[240:241], v[228:229]
v_pk_mul_f32 v[242:243], v[242:243], v[228:229]
v_pk_mul_f32 v[244:245], v[244:245], v[228:229]
v_pk_mul_f32 v[246:247], v[246:247], v[228:229]
v_cvt_pk_bf16_f32 v240, v240, v241
v_cvt_pk_bf16_f32 v241, v242, v243
v_cvt_pk_bf16_f32 v242, v244, v245
v_cvt_pk_bf16_f32 v243, v246, v247
buffer_store_dwordx4 v[240:243], v1, s[44:47], s70 offen offset:2048 sc1
v_accvgpr_read_b32 v248, a56
v_accvgpr_read_b32 v249, a57
v_accvgpr_read_b32 v250, a58
v_accvgpr_read_b32 v251, a59
v_accvgpr_read_b32 v252, a60
v_accvgpr_read_b32 v253, a61
v_accvgpr_read_b32 v254, a62
v_accvgpr_read_b32 v255, a63
v_pk_mul_f32 v[248:249], v[248:249], v[228:229]
v_pk_mul_f32 v[250:251], v[250:251], v[228:229]
v_pk_mul_f32 v[252:253], v[252:253], v[228:229]
v_pk_mul_f32 v[254:255], v[254:255], v[228:229]
v_cvt_pk_bf16_f32 v248, v248, v249
v_cvt_pk_bf16_f32 v249, v250, v251
v_cvt_pk_bf16_f32 v250, v252, v253
v_cvt_pk_bf16_f32 v251, v254, v255
buffer_store_dwordx4 v[248:251], v1, s[44:47], s70 offen offset:3072 sc1
s_cmp_le_u32 s85, 2
s_cbranch_scc1 Lalt42
v_mfma_f32_16x16x32_bf16 v[136:139], a[128:131], v[48:51], v[88:91]
s_add_u32 s82, s82, 0x8000
ds_read_b128 a[160:163], v2 offset:24576
ds_read_b128 a[176:179], v2 offset:28672
v_mfma_f32_16x16x32_bf16 v[140:143], a[128:131], v[64:67], v[92:95]
s_and_b32 s82, s82, 0x1ffff
v_exp_f32 v168, v168
v_mfma_f32_16x16x32_bf16 v[152:155], a[144:147], v[48:51], v[88:91]
v_exp_f32 v169, v169
v_mfma_f32_16x16x32_bf16 v[156:159], a[144:147], v[64:67], v[92:95]
buffer_load_dwordx4 v1, s[44:47], s72 offen offset:1024 sc1 lds
Ljoin44:
v_mfma_f32_16x16x32_bf16 v[136:139], a[132:135], v[52:55], v[136:139]
ds_read_b128 a[164:167], v2 offset:25600
v_cvt_pk_bf16_f32 v216, v168, v169
v_mfma_f32_16x16x32_bf16 v[140:143], a[132:135], v[68:71], v[140:143]
v_exp_f32 v170, v170
v_mfma_f32_16x16x32_bf16 v[156:159], a[148:151], v[68:71], v[156:159]
ds_read_b128 a[180:183], v2 offset:29696
ds_read_b128 a[168:171], v2 offset:26624
v_mfma_f32_16x16x32_bf16 v[152:155], a[148:151], v[52:55], v[152:155]
v_exp_f32 v171, v171
v_mfma_f32_16x16x32_bf16 v[140:143], a[136:139], v[72:75], v[140:143]
v_exp_f32 v184, v184
v_mfma_f32_16x16x32_bf16 v[136:139], a[136:139], v[56:59], v[136:139]
ds_read_b128 a[184:187], v2 offset:30720
v_cvt_pk_bf16_f32 v217, v170, v171
v_mfma_f32_16x16x32_bf16 v[152:155], a[152:155], v[56:59], v[152:155]
buffer_load_dwordx4 v1, s[44:47], s72 offen offset:2048 sc1 lds
v_mfma_f32_16x16x32_bf16 v[156:159], a[152:155], v[72:75], v[156:159]
v_exp_f32 v185, v185
v_mfma_f32_16x16x32_bf16 v[136:139], a[140:143], v[60:63], v[136:139]
ds_read_b128 a[172:175], v2 offset:27648
v_cvt_pk_bf16_f32 v218, v184, v185
v_mfma_f32_16x16x32_bf16 v[140:143], a[140:143], v[76:79], v[140:143]
v_exp_f32 v186, v186
v_mfma_f32_16x16x32_bf16 v[156:159], a[156:159], v[76:79], v[156:159]
ds_read_b128 a[188:191], v2 offset:31744
ds_read_b128 a[224:227], v2 offset:8192
v_mfma_f32_16x16x32_bf16 v[152:155], a[156:159], v[60:63], v[152:155]
s_waitcnt lgkmcnt(9)
v_exp_f32 v187, v187
v_mfma_f32_16x16x32_bf16 a[64:67], a[192:195], v[200:203], a[64:67]
v_exp_f32 v172, v172
v_mfma_f32_16x16x32_bf16 a[96:99], a[192:195], v[204:207], a[96:99]
buffer_load_dwordx4 v1, s[44:47], s72 offen offset:3072 sc1 lds
v_mfma_f32_16x16x32_bf16 a[100:103], a[196:199], v[204:207], a[100:103]
s_add_u32 m0, s92, 32
ds_read_b128 a[228:231], v2 offset:9216
v_cvt_pk_bf16_f32 v219, v186, v187
v_mfma_f32_16x16x32_bf16 a[68:71], a[196:199], v[200:203], a[68:71]
s_add_u32 s72, s93, 0x0
v_exp_f32 v173, v173
v_mfma_f32_16x16x32_bf16 a[72:75], a[200:203], v[200:203], a[72:75]
ds_read_b128 a[232:235], v2 offset:10240
v_cvt_pk_bf16_f32 v220, v172, v173
v_mfma_f32_16x16x32_bf16 a[104:107], a[200:203], v[204:207], a[104:107]
v_exp_f32 v174, v174
v_mfma_f32_16x16x32_bf16 a[108:111], a[204:207], v[204:207], a[108:111]
ds_read_b128 a[236:239], v2 offset:11264
ds_read_b128 a[240:243], v2 offset:12288
v_mfma_f32_16x16x32_bf16 a[76:79], a[204:207], v[200:203], a[76:79]
v_exp_f32 v175, v175
v_mfma_f32_16x16x32_bf16 a[80:83], a[208:211], v[200:203], a[80:83]
buffer_load_dwordx4 v1, s[36:39], s72 offen lds
v_mfma_f32_16x16x32_bf16 a[112:115], a[208:211], v[204:207], a[112:115]
v_exp_f32 v188, v188
v_mfma_f32_16x16x32_bf16 a[116:119], a[212:215], v[204:207], a[116:119]
ds_read_b128 a[244:247], v2 offset:13312
v_cvt_pk_bf16_f32 v221, v174, v175
v_mfma_f32_16x16x32_bf16 a[84:87], a[212:215], v[200:203], a[84:87]
v_exp_f32 v189, v189
v_mfma_f32_16x16x32_bf16 a[88:91], a[216:219], v[200:203], a[88:91]
ds_read_b128 a[248:251], v2 offset:14336
v_cvt_pk_bf16_f32 v222, v188, v189
v_mfma_f32_16x16x32_bf16 a[120:123], a[216:219], v[204:207], a[120:123]
v_exp_f32 v190, v190
v_mfma_f32_16x16x32_bf16 a[124:127], a[220:223], v[204:207], a[124:127]
buffer_load_dwordx4 v1, s[36:39], s72 offen offset:1024 lds
v_mfma_f32_16x16x32_bf16 a[92:95], a[220:223], v[200:203], a[92:95]
ds_read_b128 a[252:255], v2 offset:15360
v_add_u32 v2, s82, v1
v_mfma_f32_16x16x32_bf16 v[232:235], v[120:123], v[200:203], v[232:235]
s_waitcnt vmcnt(22) lgkmcnt(8)
v_exp_f32 v191, v191
v_mfma_f32_16x16x32_bf16 v[236:239], v[120:123], v[204:207], v[236:239]
s_barrier
v_cvt_pk_bf16_f32 v223, v190, v191
s_branch LHT3
Lalt45:
s_cmp_eq_u32 s58, 3
s_cbranch_scc1 Ltri46
v_mfma_f32_16x16x32_bf16 v[168:171], a[160:163], v[48:51], v[112:115]
v_exp_f32 v136, v136
v_mfma_f32_16x16x32_bf16 v[172:175], a[160:163], v[64:67], v[112:115]
ds_read_b128 a[192:195], v2 offset:0
v_mfma_f32_16x16x32_bf16 v[184:187], a[176:179], v[48:51], v[112:115]
v_exp_f32 v137, v137
v_mfma_f32_16x16x32_bf16 v[188:191], a[176:179], v[64:67], v[112:115]
buffer_load_dwordx4 v1, s[36:39], s72 offen offset:2048 lds
s_branch Ljoin47
Ltri46:
v_mfma_f32_16x16x32_bf16 v[168:171], a[160:163], v[48:51], v[104:107]
v_exp_f32 v136, v136
v_mfma_f32_16x16x32_bf16 v[172:175], a[160:163], v[64:67], v[92:95]
ds_read_b128 a[192:195], v2 offset:0
v_mfma_f32_16x16x32_bf16 v[184:187], a[176:179], v[48:51], v[112:115]
v_exp_f32 v137, v137
v_mfma_f32_16x16x32_bf16 v[188:191], a[176:179], v[64:67], v[108:111]
buffer_load_dwordx4 v1, s[36:39], s72 offen offset:2048 lds
s_branch Ljoin47
Lslow:
s_waitcnt vmcnt(0) lgkmcnt(0)
s_barrier
s_mov_b32 s86, 1
s_lshl_b32 s81, s59, 20
s_add_u32 s81, s81, s64
s_sub_u32 s81, s81, 0x4000
s_mov_b32 s83, 0
s_lshl_b32 s75, s60, 2
s_sub_u32 s76, 64, s75
s_sub_u32 s75, s76, 4
s_add_u32 s75, s75, s58
v_mov_b32 v2, v1
v_lshrrev_b32 v240, 4, v0
v_and_b32 v241, 15, v0
v_lshlrev_b32 v240, 2, v240
v_sub_u32 v240, v241, v240
v_mov_b32 v112, 0xff800000
v_mov_b32 v113, 0xff800000
v_mov_b32 v114, 0xff800000
v_mov_b32 v115, 0xff800000
v_cmp_gt_i32 vcc, 0, v240
v_mov_b32 v120, 0x3f803f80
s_nop 0
v_cndmask_b32 v116, 0, v112, vcc
v_cmp_gt_i32 vcc, 1, v240
v_mov_b32 v121, 0x3f803f80
s_nop 0
v_cndmask_b32 v117, 0, v112, vcc
v_cmp_gt_i32 vcc, 2, v240
v_mov_b32 v122, 0x3f803f80
s_nop 0
v_cndmask_b32 v118, 0, v112, vcc
v_cmp_gt_i32 vcc, 3, v240
v_mov_b32 v123, 0x3f803f80
s_nop 0
v_cndmask_b32 v119, 0, v112, vcc
Lslow1:
s_add_u32 m0, s64, 16384
s_add_u32 s72, s81, 16384
buffer_load_dwordx4 v1, s[44:47], s72 offen sc1 lds
buffer_load_dwordx4 v1, s[44:47], s72 offen offset:1024 sc1 lds
buffer_load_dwordx4 v1, s[44:47], s72 offen offset:2048 sc1 lds
buffer_load_dwordx4 v1, s[44:47], s72 offen offset:3072 sc1 lds
s_add_u32 s81, s81, 0x8000
s_waitcnt vmcnt(0)
s_barrier
ds_read_b128 a[128:131], v2 offset:16384
ds_read_b128 a[144:147], v2 offset:20480
ds_read_b128 a[132:135], v2 offset:17408
ds_read_b128 a[148:151], v2 offset:21504
ds_read_b128 a[136:139], v2 offset:18432
ds_read_b128 a[152:155], v2 offset:22528
ds_read_b128 a[140:143], v2 offset:19456
ds_read_b128 a[156:159], v2 offset:23552
s_waitcnt lgkmcnt(0)
s_cmp_lt_u32 s84, s83
s_cbranch_scc1 Lsa48
s_cmp_eq_u32 s84, s83
s_cbranch_scc1 Lst49
v_mfma_f32_16x16x32_bf16 v[128:131], a[128:131], v[16:19], 0
v_mfma_f32_16x16x32_bf16 v[132:135], a[128:131], v[32:35], 0
v_mfma_f32_16x16x32_bf16 v[144:147], a[144:147], v[16:19], 0
v_mfma_f32_16x16x32_bf16 v[148:151], a[144:147], v[32:35], 0
s_branch Lsj50
Lst49:
v_mfma_f32_16x16x32_bf16 v[128:131], a[128:131], v[16:19], v[116:119]
v_mfma_f32_16x16x32_bf16 v[132:135], a[128:131], v[32:35], 0
v_mfma_f32_16x16x32_bf16 v[144:147], a[144:147], v[16:19], v[112:115]
v_mfma_f32_16x16x32_bf16 v[148:151], a[144:147], v[32:35], v[116:119]
Lsj50:
v_mfma_f32_16x16x32_bf16 v[128:131], a[132:135], v[20:23], v[128:131]
v_mfma_f32_16x16x32_bf16 v[132:135], a[132:135], v[36:39], v[132:135]
v_mfma_f32_16x16x32_bf16 v[148:151], a[148:151], v[36:39], v[148:151]
v_mfma_f32_16x16x32_bf16 v[144:147], a[148:151], v[20:23], v[144:147]
v_mfma_f32_16x16x32_bf16 v[132:135], a[136:139], v[40:43], v[132:135]
v_mfma_f32_16x16x32_bf16 v[128:131], a[136:139], v[24:27], v[128:131]
v_mfma_f32_16x16x32_bf16 v[144:147], a[152:155], v[24:27], v[144:147]
v_mfma_f32_16x16x32_bf16 v[148:151], a[152:155], v[40:43], v[148:151]
v_mfma_f32_16x16x32_bf16 v[128:131], a[140:143], v[28:31], v[128:131]
v_mfma_f32_16x16x32_bf16 v[132:135], a[140:143], v[44:47], v[132:135]
v_mfma_f32_16x16x32_bf16 v[148:151], a[156:159], v[44:47], v[148:151]
v_mfma_f32_16x16x32_bf16 v[144:147], a[156:159], v[28:31], v[144:147]
s_nop 7
v_max3_f32 v124, v124, v128, v129
v_max3_f32 v124, v124, v130, v131
v_max3_f32 v124, v124, v144, v145
v_max3_f32 v124, v124, v146, v147
v_max3_f32 v125, v125, v132, v133
v_max3_f32 v125, v125, v134, v135
v_max3_f32 v125, v125, v148, v149
v_max3_f32 v125, v125, v150, v151
Lsa48:
s_cmp_lt_u32 s75, s83
s_cbranch_scc1 Lsa51
s_cmp_eq_u32 s75, s83
s_cbranch_scc1 Lst52
v_mfma_f32_16x16x32_bf16 v[136:139], a[128:131], v[48:51], 0
v_mfma_f32_16x16x32_bf16 v[140:143], a[128:131], v[64:67], 0
v_mfma_f32_16x16x32_bf16 v[152:155], a[144:147], v[48:51], 0
v_mfma_f32_16x16x32_bf16 v[156:159], a[144:147], v[64:67], 0
s_branch Lsj53
Lst52:
v_mfma_f32_16x16x32_bf16 v[136:139], a[128:131], v[48:51], v[116:119]
v_mfma_f32_16x16x32_bf16 v[140:143], a[128:131], v[64:67], 0
v_mfma_f32_16x16x32_bf16 v[152:155], a[144:147], v[48:51], v[112:115]
v_mfma_f32_16x16x32_bf16 v[156:159], a[144:147], v[64:67], v[116:119]
Lsj53:
v_mfma_f32_16x16x32_bf16 v[136:139], a[132:135], v[52:55], v[136:139]
v_mfma_f32_16x16x32_bf16 v[140:143], a[132:135], v[68:71], v[140:143]
v_mfma_f32_16x16x32_bf16 v[156:159], a[148:151], v[68:71], v[156:159]
v_mfma_f32_16x16x32_bf16 v[152:155], a[148:151], v[52:55], v[152:155]
v_mfma_f32_16x16x32_bf16 v[140:143], a[136:139], v[72:75], v[140:143]
v_mfma_f32_16x16x32_bf16 v[136:139], a[136:139], v[56:59], v[136:139]
v_mfma_f32_16x16x32_bf16 v[152:155], a[152:155], v[56:59], v[152:155]
v_mfma_f32_16x16x32_bf16 v[156:159], a[152:155], v[72:75], v[156:159]
v_mfma_f32_16x16x32_bf16 v[136:139], a[140:143], v[60:63], v[136:139]
v_mfma_f32_16x16x32_bf16 v[140:143], a[140:143], v[76:79], v[140:143]
v_mfma_f32_16x16x32_bf16 v[156:159], a[156:159], v[76:79], v[156:159]
v_mfma_f32_16x16x32_bf16 v[152:155], a[156:159], v[60:63], v[152:155]
s_nop 7
v_max3_f32 v126, v126, v136, v137
v_max3_f32 v126, v126, v138, v139
v_max3_f32 v126, v126, v152, v153
v_max3_f32 v126, v126, v154, v155
v_max3_f32 v127, v127, v140, v141
v_max3_f32 v127, v127, v142, v143
v_max3_f32 v127, v127, v156, v157
v_max3_f32 v127, v127, v158, v159
Lsa51:
s_add_u32 s83, s83, 1
ds_read_b128 a[128:131], v2 offset:24576
ds_read_b128 a[144:147], v2 offset:28672
ds_read_b128 a[132:135], v2 offset:25600
ds_read_b128 a[148:151], v2 offset:29696
ds_read_b128 a[136:139], v2 offset:26624
ds_read_b128 a[152:155], v2 offset:30720
ds_read_b128 a[140:143], v2 offset:27648
ds_read_b128 a[156:159], v2 offset:31744
s_waitcnt lgkmcnt(0)
s_cmp_lt_u32 s84, s83
s_cbranch_scc1 Lsa54
s_cmp_eq_u32 s84, s83
s_cbranch_scc1 Lst55
v_mfma_f32_16x16x32_bf16 v[128:131], a[128:131], v[16:19], 0
v_mfma_f32_16x16x32_bf16 v[132:135], a[128:131], v[32:35], 0
v_mfma_f32_16x16x32_bf16 v[144:147], a[144:147], v[16:19], 0
v_mfma_f32_16x16x32_bf16 v[148:151], a[144:147], v[32:35], 0
s_branch Lsj56
Lst55:
v_mfma_f32_16x16x32_bf16 v[128:131], a[128:131], v[16:19], v[116:119]
v_mfma_f32_16x16x32_bf16 v[132:135], a[128:131], v[32:35], 0
v_mfma_f32_16x16x32_bf16 v[144:147], a[144:147], v[16:19], v[112:115]
v_mfma_f32_16x16x32_bf16 v[148:151], a[144:147], v[32:35], v[116:119]
Lsj56:
v_mfma_f32_16x16x32_bf16 v[128:131], a[132:135], v[20:23], v[128:131]
v_mfma_f32_16x16x32_bf16 v[132:135], a[132:135], v[36:39], v[132:135]
v_mfma_f32_16x16x32_bf16 v[148:151], a[148:151], v[36:39], v[148:151]
v_mfma_f32_16x16x32_bf16 v[144:147], a[148:151], v[20:23], v[144:147]
v_mfma_f32_16x16x32_bf16 v[132:135], a[136:139], v[40:43], v[132:135]
v_mfma_f32_16x16x32_bf16 v[128:131], a[136:139], v[24:27], v[128:131]
v_mfma_f32_16x16x32_bf16 v[144:147], a[152:155], v[24:27], v[144:147]
v_mfma_f32_16x16x32_bf16 v[148:151], a[152:155], v[40:43], v[148:151]
v_mfma_f32_16x16x32_bf16 v[128:131], a[140:143], v[28:31], v[128:131]
v_mfma_f32_16x16x32_bf16 v[132:135], a[140:143], v[44:47], v[132:135]
v_mfma_f32_16x16x32_bf16 v[148:151], a[156:159], v[44:47], v[148:151]
v_mfma_f32_16x16x32_bf16 v[144:147], a[156:159], v[28:31], v[144:147]
s_nop 7
v_max3_f32 v124, v124, v128, v129
v_max3_f32 v124, v124, v130, v131
v_max3_f32 v124, v124, v144, v145
v_max3_f32 v124, v124, v146, v147
v_max3_f32 v125, v125, v132, v133
v_max3_f32 v125, v125, v134, v135
v_max3_f32 v125, v125, v148, v149
v_max3_f32 v125, v125, v150, v151
Lsa54:
s_cmp_lt_u32 s75, s83
s_cbranch_scc1 Lsa57
s_cmp_eq_u32 s75, s83
s_cbranch_scc1 Lst58
v_mfma_f32_16x16x32_bf16 v[136:139], a[128:131], v[48:51], 0
v_mfma_f32_16x16x32_bf16 v[140:143], a[128:131], v[64:67], 0
v_mfma_f32_16x16x32_bf16 v[152:155], a[144:147], v[48:51], 0
v_mfma_f32_16x16x32_bf16 v[156:159], a[144:147], v[64:67], 0
s_branch Lsj59
Lst58:
v_mfma_f32_16x16x32_bf16 v[136:139], a[128:131], v[48:51], v[116:119]
v_mfma_f32_16x16x32_bf16 v[140:143], a[128:131], v[64:67], 0
v_mfma_f32_16x16x32_bf16 v[152:155], a[144:147], v[48:51], v[112:115]
v_mfma_f32_16x16x32_bf16 v[156:159], a[144:147], v[64:67], v[116:119]
Lsj59:
v_mfma_f32_16x16x32_bf16 v[136:139], a[132:135], v[52:55], v[136:139]
v_mfma_f32_16x16x32_bf16 v[140:143], a[132:135], v[68:71], v[140:143]
v_mfma_f32_16x16x32_bf16 v[156:159], a[148:151], v[68:71], v[156:159]
v_mfma_f32_16x16x32_bf16 v[152:155], a[148:151], v[52:55], v[152:155]
v_mfma_f32_16x16x32_bf16 v[140:143], a[136:139], v[72:75], v[140:143]
v_mfma_f32_16x16x32_bf16 v[136:139], a[136:139], v[56:59], v[136:139]
v_mfma_f32_16x16x32_bf16 v[152:155], a[152:155], v[56:59], v[152:155]
v_mfma_f32_16x16x32_bf16 v[156:159], a[152:155], v[72:75], v[156:159]
v_mfma_f32_16x16x32_bf16 v[136:139], a[140:143], v[60:63], v[136:139]
v_mfma_f32_16x16x32_bf16 v[140:143], a[140:143], v[76:79], v[140:143]
v_mfma_f32_16x16x32_bf16 v[156:159], a[156:159], v[76:79], v[156:159]
v_mfma_f32_16x16x32_bf16 v[152:155], a[156:159], v[60:63], v[152:155]
s_nop 7
v_max3_f32 v126, v126, v136, v137
v_max3_f32 v126, v126, v138, v139
v_max3_f32 v126, v126, v152, v153
v_max3_f32 v126, v126, v154, v155
v_max3_f32 v127, v127, v140, v141
v_max3_f32 v127, v127, v142, v143
v_max3_f32 v127, v127, v156, v157
v_max3_f32 v127, v127, v158, v159
Lsa57:
s_add_u32 s83, s83, 1
s_barrier
s_cmp_lt_u32 s83, s76
s_cbranch_scc1 Lslow1
s_lshl_b32 s81, s59, 20
s_add_u32 s81, s81, s64
s_sub_u32 s81, s81, 0x4000
s_add_u32 m0, s64, 49152
s_add_u32 s72, s81, 16384
buffer_load_dwordx4 v1, s[44:47], s72 offen sc1 lds
buffer_load_dwordx4 v1, s[44:47], s72 offen offset:1024 sc1 lds
buffer_load_dwordx4 v1, s[44:47], s72 offen offset:2048 sc1 lds
buffer_load_dwordx4 v1, s[44:47], s72 offen offset:3072 sc1 lds
s_add_u32 s81, s81, 0x8000
s_add_u32 m0, s64, 81920
s_add_u32 s72, s81, 16384
buffer_load_dwordx4 v1, s[44:47], s72 offen sc1 lds
buffer_load_dwordx4 v1, s[44:47], s72 offen offset:1024 sc1 lds
buffer_load_dwordx4 v1, s[44:47], s72 offen offset:2048 sc1 lds
buffer_load_dwordx4 v1, s[44:47], s72 offen offset:3072 sc1 lds
s_add_u32 m0, s64, 65536
s_add_u32 s72, s81, 0
buffer_load_dwordx4 v1, s[44:47], s72 offen sc1 lds
buffer_load_dwordx4 v1, s[44:47], s72 offen offset:1024 sc1 lds
buffer_load_dwordx4 v1, s[44:47], s72 offen offset:2048 sc1 lds
buffer_load_dwordx4 v1, s[44:47], s72 offen offset:3072 sc1 lds
s_add_u32 s81, s81, 0x8000
s_add_u32 m0, s64, 114688
s_add_u32 s72, s81, 16384
buffer_load_dwordx4 v1, s[44:47], s72 offen sc1 lds
buffer_load_dwordx4 v1, s[44:47], s72 offen offset:1024 sc1 lds
buffer_load_dwordx4 v1, s[44:47], s72 offen offset:2048 sc1 lds
buffer_load_dwordx4 v1, s[44:47], s72 offen offset:3072 sc1 lds
s_add_u32 m0, s64, 98304
s_add_u32 s72, s81, 0
buffer_load_dwordx4 v1, s[44:47], s72 offen sc1 lds
buffer_load_dwordx4 v1, s[44:47], s72 offen offset:1024 sc1 lds
buffer_load_dwordx4 v1, s[44:47], s72 offen offset:2048 sc1 lds
buffer_load_dwordx4 v1, s[44:47], s72 offen offset:3072 sc1 lds
v_add_u32 v2, 0x8000, v1
s_waitcnt vmcnt(16)
s_barrier
ds_read_b128 a[128:131], v2 offset:16384
ds_read_b128 a[144:147], v2 offset:20480
ds_read_b128 a[132:135], v2 offset:17408
ds_read_b128 a[148:151], v2 offset:21504
ds_read_b128 a[136:139], v2 offset:18432
ds_read_b128 a[152:155], v2 offset:22528
ds_read_b128 a[140:143], v2 offset:19456
ds_read_b128 a[156:159], v2 offset:23552
s_branch Lattn
Lspin60:
s_mov_b32 s83, 262144
Lsl62:
s_sleep 2
buffer_load_dword v3, v2, s[44:47], s85 offen sc1
s_sub_u32 s83, s83, 1
s_cmp_eq_u32 s83, 0
s_waitcnt vmcnt(0)
s_cbranch_scc1 Lback61
v_cmp_gt_u32 vcc, 2, v3
s_cbranch_vccnz Lsl62
s_branch Lback61
Lspin63:
s_mov_b32 s83, 262144
Lsl65:
s_sleep 2
buffer_load_dword v3, v2, s[44:47], s85 offen sc1
s_sub_u32 s83, s83, 1
s_cmp_eq_u32 s83, 0
s_waitcnt vmcnt(0)
s_cbranch_scc1 Lback64
v_cmp_gt_u32 vcc, 2, v3
s_cbranch_vccnz Lsl65
s_branch Lback64
Lspin66:
s_mov_b32 s83, 262144
Lsl68:
s_sleep 2
buffer_load_dword v3, v2, s[44:47], s85 offen sc1
s_sub_u32 s83, s83, 1
s_cmp_eq_u32 s83, 0
s_waitcnt vmcnt(0)
s_cbranch_scc1 Lback67
v_cmp_gt_u32 vcc, 2, v3
s_cbranch_vccnz Lsl68
s_branch Lback67
Lspin69:
s_mov_b32 s83, 262144
Lsl71:
s_sleep 2
buffer_load_dword v3, v2, s[44:47], s85 offen sc1
s_sub_u32 s83, s83, 1
s_cmp_eq_u32 s83, 0
s_waitcnt vmcnt(0)
s_cbranch_scc1 Lback70
v_cmp_gt_u32 vcc, 2, v3
s_cbranch_vccnz Lsl71
s_branch Lback70
Lspin72:
s_mov_b32 s83, 262144
Lsl74:
s_sleep 2
buffer_load_dword v3, v2, s[44:47], s85 offen sc1
s_sub_u32 s83, s83, 1
s_cmp_eq_u32 s83, 0
s_waitcnt vmcnt(0)
s_cbranch_scc1 Lback73
v_cmp_gt_u32 vcc, 2, v3
s_cbranch_vccnz Lsl74
s_branch Lback73
Lspin75:
s_mov_b32 s83, 262144
Lsl77:
s_sleep 2
buffer_load_dword v3, v2, s[44:47], s85 offen sc1
s_sub_u32 s83, s83, 1
s_cmp_eq_u32 s83, 0
s_waitcnt vmcnt(0)
s_cbranch_scc1 Lback76
v_cmp_gt_u32 vcc, 2, v3
s_cbranch_vccnz Lsl77
s_branch Lback76
Lspin78:
s_mov_b32 s83, 262144
Lsl80:
s_sleep 2
buffer_load_dword v3, v2, s[44:47], s85 offen sc1
s_sub_u32 s83, s83, 1
s_cmp_eq_u32 s83, 0
s_waitcnt vmcnt(0)
s_cbranch_scc1 Lback79
v_cmp_gt_u32 vcc, 2, v3
s_cbranch_vccnz Lsl80
s_branch Lback79
Lspin81:
s_mov_b32 s83, 262144
Lsl83:
s_sleep 2
buffer_load_dword v3, v2, s[44:47], s85 offen sc1
s_sub_u32 s83, s83, 1
s_cmp_eq_u32 s83, 0
s_waitcnt vmcnt(0)
s_cbranch_scc1 Lback82
v_cmp_gt_u32 vcc, 2, v3
s_cbranch_vccnz Lsl83
s_branch Lback82
Lspin84:
s_mov_b32 s83, 262144
Lsl86:
s_sleep 2
buffer_load_dword v3, v2, s[44:47], s74 offen sc1
s_sub_u32 s83, s83, 1
s_cmp_eq_u32 s83, 0
s_waitcnt vmcnt(0)
s_cbranch_scc1 Lback85
v_cmp_gt_u32 vcc, 3, v3
s_cbranch_vccnz Lsl86
s_branch Lback85
Lcode_end:
s_endpgm
.section .rodata,"a"
.p2align 6
.amdhsa_kernel gated_mix__compressed_kv_cla__ssm_conv_h3__prompt_kernel
  .amdhsa_next_free_vgpr 512
  .amdhsa_next_free_sgpr 102
  .amdhsa_accum_offset 256
  .amdhsa_group_segment_fixed_size 0
  .amdhsa_kernarg_size 128
  .amdhsa_user_sgpr_count 2
  .amdhsa_user_sgpr_kernarg_segment_ptr 1
  .amdhsa_system_sgpr_workgroup_id_x 1
  .amdhsa_float_denorm_mode_32 3
.end_amdhsa_kernel
```

```asm
; @launch grid=(256,1,1) block=(256,1,1) lds=163840
.amdgcn_target "amdgcn-amd-amdhsa--gfx950"
.text
.globl gated_mix__compressed_kv_cla__ssm_conv_h3__prompt_kernel
.p2align 8
.type gated_mix__compressed_kv_cla__ssm_conv_h3__prompt_kernel,@function
gated_mix__compressed_kv_cla__ssm_conv_h3__prompt_kernel:
s_cmp_ge_u32 s2, 256
s_cbranch_scc1 Lend
s_load_dwordx2 s[8:9], s[0:1], 8
s_load_dwordx2 s[16:17], s[0:1], 24
s_load_dwordx2 s[20:21], s[0:1], 32
s_load_dwordx2 s[4:5], s[0:1], 0
s_load_dwordx2 s[12:13], s[0:1], 16
s_load_dwordx2 s[24:25], s[0:1], 40
s_load_dwordx2 s[28:29], s[0:1], 56
s_load_dwordx2 s[32:33], s[0:1], 64
s_load_dwordx2 s[52:53], s[0:1], 72
s_load_dwordx2 s[36:37], s[0:1], 80
s_load_dwordx2 s[54:55], s[0:1], 88
s_load_dwordx2 s[56:57], s[0:1], 96
s_load_dwordx2 s[40:41], s[0:1], 104
s_load_dwordx2 s[48:49], s[0:1], 112
s_load_dwordx2 s[44:45], s[0:1], 120
s_getpc_b64 s[98:99]
Lpc0:
s_lshr_b32 s75, s2, 3
v_lshrrev_b32 v26, 3, v0
s_lshl_b32 s73, s75, 12
v_lshlrev_b32 v26, 7, v26
v_add_u32 v26, s73, v26
v_min_u32 v26, Lcode_end-Lpc0, v26
global_load_dword v31, v26, s[98:99]
v_lshrrev_b32 v26, 6, v0
v_and_b32 v0, 63, v0
s_and_b32 s73, s2, 7
v_readfirstlane_b32 s58, v26
s_lshr_b32 s65, s75, 3
s_and_b32 s60, s75, 7
s_lshl_b32 s59, s73, 2
s_add_u32 s59, s59, s65
s_lshl_b32 s61, s65, 1
s_lshl_b32 s63, s58, 13
s_lshl_b32 s64, s58, 12
s_lshl_b32 s67, s60, 18
s_lshl_b32 s76, s58, 16
s_add_u32 s67, s67, s76
s_lshl_b32 s66, s58, 17
s_lshl_b32 s73, s59, 8
s_add_u32 s66, s66, s73
v_lshrrev_b32 v26, 4, v0
v_and_b32 v27, 7, v0
v_xor_b32 v27, v27, v26
v_lshlrev_b32 v27, 4, v27
v_lshrrev_b32 v28, 3, v0
v_lshl_add_u32 v2, v28, 10, v27
v_xor_b32 v3, 64, v2
v_and_b32 v29, 15, v0
v_lshlrev_b32 v30, 1, v26
v_xor_b32 v30, v30, v29
v_lshlrev_b32 v30, 4, v30
v_lshl_add_u32 v6, v26, 13, v30
v_xor_b32 v7, 0x80, v6
s_mov_b32 s10, 0x200000
s_mov_b32 s11, 0x20000
s_mov_b32 s18, 0x400000
s_mov_b32 s19, 0x20000
s_mov_b32 s22, 0x400000
s_mov_b32 s23, 0x20000
s_lshl_b32 s73, s2, 2
s_add_u32 s73, s73, s58
s_lshl_b32 s73, s73, 11
v_lshrrev_b32 v124, 2, v0
v_lshlrev_b32 v124, 7, v124
v_add_u32 v124, s73, v124
s_lshl_b32 s73, s60, 2
s_add_u32 s73, s73, s58
s_lshl_b32 s73, s73, 13
s_lshl_b32 s74, s59, 8
s_add_u32 s73, s73, s74
v_lshrrev_b32 v125, 4, v0
v_lshlrev_b32 v125, 18, v125
v_bfe_u32 v126, v0, 3, 1
v_lshl_add_u32 v125, v126, 7, v125
v_add_u32 v125, s73, v125
s_waitcnt lgkmcnt(0)
s_add_u32 s73, s61, 0
s_and_b32 s73, s73, 7
s_lshl_b32 s69, s73, 7
s_add_u32 s69, s69, s67
s_lshl_b32 s71, s73, 19
s_add_u32 s71, s71, s66
s_add_u32 m0, s63, 65536
s_add_u32 s72, s69, 0
buffer_load_dwordx4 v2, s[8:11], s72 offen lds
s_add_u32 s72, s69, 7168
buffer_load_dwordx4 v3, s[8:11], s72 offen offset:1024 lds
s_add_u32 s72, s69, 14336
buffer_load_dwordx4 v2, s[8:11], s72 offen offset:2048 lds
s_add_u32 s72, s69, 21504
buffer_load_dwordx4 v3, s[8:11], s72 offen offset:3072 lds
s_add_u32 m0, s64, 0
s_add_u32 s72, s71, 0
buffer_load_dwordx4 v6, s[16:19], s72 offen lds
s_add_u32 s72, s71, 31744
buffer_load_dwordx4 v6, s[16:19], s72 offen offset:1024 lds
s_add_u32 s72, s71, 63488
buffer_load_dwordx4 v7, s[16:19], s72 offen offset:2048 lds
s_add_u32 s72, s71, 95232
buffer_load_dwordx4 v7, s[16:19], s72 offen offset:3072 lds
s_add_u32 m0, s63, 69632
s_add_u32 s72, s69, 32768
buffer_load_dwordx4 v2, s[8:11], s72 offen lds
s_add_u32 s72, s69, 39936
buffer_load_dwordx4 v3, s[8:11], s72 offen offset:1024 lds
s_add_u32 s72, s69, 47104
buffer_load_dwordx4 v2, s[8:11], s72 offen offset:2048 lds
s_add_u32 s72, s69, 54272
buffer_load_dwordx4 v3, s[8:11], s72 offen offset:3072 lds
s_add_u32 m0, s64, 16384
s_add_u32 s72, s71, 0
buffer_load_dwordx4 v6, s[20:23], s72 offen lds
s_add_u32 s72, s71, 31744
buffer_load_dwordx4 v6, s[20:23], s72 offen offset:1024 lds
s_add_u32 s72, s71, 63488
buffer_load_dwordx4 v7, s[20:23], s72 offen offset:2048 lds
s_add_u32 s72, s71, 95232
buffer_load_dwordx4 v7, s[20:23], s72 offen offset:3072 lds
s_add_u32 s80, s65, 0
s_and_b32 s80, s80, 3
s_lshl_b32 s80, s80, 20
buffer_load_dword v126, v125, s[16:19], s80 offen
buffer_load_dword v126, v125, s[20:23], s80 offen
buffer_load_dword v126, v124, s[8:11], 0 offen
s_add_u32 s73, s61, 1
s_and_b32 s73, s73, 7
s_lshl_b32 s69, s73, 7
s_add_u32 s69, s69, s67
s_lshl_b32 s71, s73, 19
s_add_u32 s71, s71, s66
s_add_u32 m0, s63, 98304
s_add_u32 s72, s69, 0
buffer_load_dwordx4 v2, s[8:11], s72 offen lds
s_add_u32 s72, s69, 7168
buffer_load_dwordx4 v3, s[8:11], s72 offen offset:1024 lds
s_add_u32 s72, s69, 14336
buffer_load_dwordx4 v2, s[8:11], s72 offen offset:2048 lds
s_add_u32 s72, s69, 21504
buffer_load_dwordx4 v3, s[8:11], s72 offen offset:3072 lds
s_mov_b32 s6, 0x400000
s_mov_b32 s7, 0x20000
s_mov_b32 s14, 0x800000
s_mov_b32 s15, 0x20000
s_mov_b32 s26, 0x800000
s_mov_b32 s27, 0x20000
s_mov_b32 s30, 0x400000
s_mov_b32 s31, 0x20000
s_mov_b32 s34, 0x400000
s_mov_b32 s35, 0x20000
s_mov_b32 s38, 0x400000
s_mov_b32 s39, 0x20000
s_mov_b32 s42, 0x400000
s_mov_b32 s43, 0x20000
s_mov_b32 s46, 0x5000000
s_mov_b32 s47, 0x20000
s_mov_b32 s50, 0x100
s_mov_b32 s51, 0x20000
v_lshl_add_u32 v4, v28, 11, v27
v_xor_b32 v5, 64, v4
v_lshlrev_b32 v1, 4, v0
s_sub_u32 s74, 15, s60
s_lshl_b32 s68, s74, 18
s_add_u32 s68, s68, s76
s_and_b32 s62, s60, 3
s_sub_u32 s62, 16, s62
s_lshl_b32 s91, s59, 3
s_add_u32 s91, s91, s60
s_lshl_b32 s93, s91, 2
s_add_u32 s93, s93, s58
s_lshl_b32 s91, s91, 7
s_add_u32 s91, s91, 0x3810000
s_lshl_b32 s75, s93, 1
s_and_b32 s75, s75, 0xffc
s_lshl_b32 s93, s93, 12
s_mul_i32 s92, s58, 12480
s_load_dwordx2 s[88:89], s[36:37], s93
s_load_dword s90, s[54:55], s75
v_or_b32 v29, s58, v0
v_mov_b32 v30, 0
v_min_u32 v29, 1, v29
v_lshlrev_b32 v29, 30, v29
buffer_store_dword v30, v29, s[44:47], s91 offen sc1
s_and_b32 s73, s2, 15
s_lshr_b32 s74, s2, 4
s_lshl_b32 s74, s74, 7
s_lshl_b32 s75, s58, 5
s_add_u32 s74, s74, s75
s_mov_b32 s75, 131072
v_lshrrev_b32 v29, 5, v0
v_lshlrev_b32 v29, 4, v29
v_add_u32 v29, s74, v29
v_and_b32 v30, 31, v0
s_lshl_b32 s73, s73, 5
v_add_u32 v30, s73, v30
v_lshlrev_b32 v26, 11, v29
v_lshl_add_u32 v26, v30, 2, v26
v_subrev_u32 v27, 0x1800, v26
v_and_b32 v29, 0x7f, v29
v_sub_u32 v29, 0x70, v29
v_lshlrev_b32 v29, 1, v29
v_and_b32 v32, 31, v0
v_mul_u32_u24 v32, 544, v32
v_add3_u32 v28, v32, v29, s75
v_lshlrev_b32 v30, 4, v30
s_lshl_b32 s73, s2, 14
s_lshl_b32 s74, s58, 12
s_add_u32 s76, s73, s74
v_and_b32 v29, 15, v0
v_lshrrev_b32 v32, 4, v0
v_lshrrev_b32 v24, 1, v29
v_xor_b32 v24, v24, v32
v_lshlrev_b32 v24, 4, v24
v_lshl_add_u32 v24, v29, 7, v24
s_add_u32 s73, s63, 131072
v_add_u32 v16, s73, v24
v_xor_b32 v17, 64, v16
v_subrev_u32 v18, 0x10000, v16
v_subrev_u32 v19, 0x10000, v17
s_lshr_b32 s73, s58, 1
s_lshl_b32 s74, s73, 14
s_add_u32 s74, s74, 0x10000
v_add_u32 v24, s74, v24
v_xor_b32 v25, 64, v24
v_lshrrev_b32 v8, 2, v29
v_and_b32 v9, 1, v32
v_lshl_add_u32 v9, v9, 2, v8
v_lshl_add_u32 v8, v32, 3, v8
v_lshlrev_b32 v8, 8, v8
v_lshl_add_u32 v8, v9, 5, v8
v_and_b32 v29, 3, v0
v_lshl_add_u32 v8, v29, 3, v8
s_and_b32 s74, s58, 1
s_lshl_b32 s75, s74, 7
v_xor_b32 v20, s75, v8
v_xor_b32 v9, 32, v8
v_xor_b32 v10, 64, v8
v_xor_b32 v11, 96, v8
v_xor_b32 v12, 128, v8
v_xor_b32 v13, 160, v8
v_xor_b32 v14, 192, v8
v_xor_b32 v15, 224, v8
v_xor_b32 v21, 32, v20
v_xor_b32 v22, 64, v20
v_xor_b32 v23, 96, v20
s_lshl_b32 s77, s59, 20
s_add_u32 s81, s77, s64
s_sub_u32 s81, s81, 0x4000
s_lshl_b32 s75, s60, 17
s_add_u32 s77, s77, s75
s_lshl_b32 s73, s73, 16
s_add_u32 s77, s77, s73
s_lshl_b32 s75, s74, 12
s_add_u32 s78, s77, s75
s_add_u32 s78, s78, 0x4000
s_lshl_b32 s75, s74, 11
s_add_u32 s77, s77, s75
s_mov_b32 s79, 0x3e0293ee
s_waitcnt vmcnt(8)
s_barrier
ds_read_b64_tr_b16 v[160:161], v20 offset:0
ds_read_b64_tr_b16 v[162:163], v20 offset:1024
ds_read_b128 v[128:131], v24 offset:0
ds_read_b128 v[132:135], v24 offset:2048
ds_read_b128 v[136:139], v24 offset:4096
ds_read_b128 v[140:143], v24 offset:6144
ds_read_b128 v[144:147], v24 offset:8192
ds_read_b128 v[148:151], v24 offset:10240
ds_read_b128 v[152:155], v24 offset:12288
ds_read_b128 v[156:159], v24 offset:14336
ds_read_b64_tr_b16 v[164:165], v21 offset:0
ds_read_b64_tr_b16 v[166:167], v21 offset:1024
ds_read_b64_tr_b16 v[168:169], v22 offset:0
ds_read_b64_tr_b16 v[170:171], v22 offset:1024
ds_read_b64_tr_b16 v[172:173], v23 offset:0
ds_read_b64_tr_b16 v[174:175], v23 offset:1024
ds_read_b64_tr_b16 v[176:177], v20 offset:16384
ds_read_b64_tr_b16 v[178:179], v20 offset:17408
ds_read_b64_tr_b16 v[180:181], v21 offset:16384
ds_read_b64_tr_b16 v[182:183], v21 offset:17408
ds_read_b64_tr_b16 v[184:185], v22 offset:16384
ds_read_b64_tr_b16 v[186:187], v22 offset:17408
ds_read_b64_tr_b16 v[188:189], v23 offset:16384
ds_read_b64_tr_b16 v[190:191], v23 offset:17408
s_waitcnt lgkmcnt(0)
v_mfma_f32_16x16x32_bf16 a[0:3], v[160:163], v[128:131], 0
s_add_u32 m0, s64, 32768
ds_read_b64_tr_b16 v[224:225], v20 offset:8192
v_mfma_f32_16x16x32_bf16 a[4:7], v[160:163], v[132:135], 0
s_add_u32 s72, s71, 0
buffer_load_dwordx4 v6, s[16:19], s72 offen lds
v_mfma_f32_16x16x32_bf16 a[8:11], v[160:163], v[136:139], 0
s_add_u32 s72, s71, 31744
buffer_load_dwordx4 v6, s[16:19], s72 offen offset:1024 lds
v_mfma_f32_16x16x32_bf16 a[12:15], v[160:163], v[140:143], 0
ds_read_b64_tr_b16 v[226:227], v20 offset:9216
v_mfma_f32_16x16x32_bf16 a[16:19], v[160:163], v[144:147], 0
s_add_u32 s72, s71, 63488
buffer_load_dwordx4 v7, s[16:19], s72 offen offset:2048 lds
v_mfma_f32_16x16x32_bf16 a[20:23], v[160:163], v[148:151], 0
ds_read_b128 v[192:195], v25 offset:0
v_mfma_f32_16x16x32_bf16 a[24:27], v[160:163], v[152:155], 0
s_add_u32 s72, s71, 95232
buffer_load_dwordx4 v7, s[16:19], s72 offen offset:3072 lds
v_mfma_f32_16x16x32_bf16 a[28:31], v[160:163], v[156:159], 0
ds_read_b128 v[196:199], v25 offset:2048
v_mfma_f32_16x16x32_bf16 a[60:63], v[164:167], v[156:159], 0
s_add_u32 m0, s63, 102400
ds_read_b128 v[200:203], v25 offset:4096
v_mfma_f32_16x16x32_bf16 a[56:59], v[164:167], v[152:155], 0
s_add_u32 s72, s69, 32768
buffer_load_dwordx4 v2, s[8:11], s72 offen lds
v_mfma_f32_16x16x32_bf16 a[52:55], v[164:167], v[148:151], 0
s_add_u32 s72, s69, 39936
buffer_load_dwordx4 v3, s[8:11], s72 offen offset:1024 lds
v_mfma_f32_16x16x32_bf16 a[48:51], v[164:167], v[144:147], 0
ds_read_b128 v[204:207], v25 offset:6144
v_mfma_f32_16x16x32_bf16 a[44:47], v[164:167], v[140:143], 0
s_add_u32 s72, s69, 47104
buffer_load_dwordx4 v2, s[8:11], s72 offen offset:2048 lds
v_mfma_f32_16x16x32_bf16 a[40:43], v[164:167], v[136:139], 0
ds_read_b128 v[208:211], v25 offset:8192
v_mfma_f32_16x16x32_bf16 a[36:39], v[164:167], v[132:135], 0
s_add_u32 s72, s69, 54272
buffer_load_dwordx4 v3, s[8:11], s72 offen offset:3072 lds
v_mfma_f32_16x16x32_bf16 a[32:35], v[164:167], v[128:131], 0
ds_read_b128 v[212:215], v25 offset:10240
v_mfma_f32_16x16x32_bf16 a[64:67], v[168:171], v[128:131], 0
s_add_u32 m0, s64, 49152
ds_read_b128 v[216:219], v25 offset:12288
v_mfma_f32_16x16x32_bf16 a[68:71], v[168:171], v[132:135], 0
s_add_u32 s72, s71, 0
buffer_load_dwordx4 v6, s[20:23], s72 offen lds
v_mfma_f32_16x16x32_bf16 a[72:75], v[168:171], v[136:139], 0
s_add_u32 s72, s71, 31744
buffer_load_dwordx4 v6, s[20:23], s72 offen offset:1024 lds
v_mfma_f32_16x16x32_bf16 a[76:79], v[168:171], v[140:143], 0
ds_read_b128 v[220:223], v25 offset:14336
v_mfma_f32_16x16x32_bf16 a[80:83], v[168:171], v[144:147], 0
s_add_u32 s72, s71, 63488
buffer_load_dwordx4 v7, s[20:23], s72 offen offset:2048 lds
v_mfma_f32_16x16x32_bf16 a[84:87], v[168:171], v[148:151], 0
ds_read_b64_tr_b16 v[228:229], v21 offset:8192
v_mfma_f32_16x16x32_bf16 a[88:91], v[168:171], v[152:155], 0
s_add_u32 s72, s71, 95232
buffer_load_dwordx4 v7, s[20:23], s72 offen offset:3072 lds
v_mfma_f32_16x16x32_bf16 a[92:95], v[168:171], v[156:159], 0
s_add_u32 s80, s65, 1
ds_read_b64_tr_b16 v[230:231], v21 offset:9216
v_mfma_f32_16x16x32_bf16 a[124:127], v[172:175], v[156:159], 0
s_and_b32 s80, s80, 3
ds_read_b64_tr_b16 v[232:233], v22 offset:8192
v_mfma_f32_16x16x32_bf16 a[120:123], v[172:175], v[152:155], 0
s_lshl_b32 s80, s80, 20
buffer_load_dword v126, v125, s[16:19], s80 offen
v_mfma_f32_16x16x32_bf16 a[116:119], v[172:175], v[148:151], 0
buffer_load_dword v126, v125, s[20:23], s80 offen
v_mfma_f32_16x16x32_bf16 a[112:115], v[172:175], v[144:147], 0
ds_read_b64_tr_b16 v[234:235], v22 offset:9216
v_mfma_f32_16x16x32_bf16 a[108:111], v[172:175], v[140:143], 0
ds_read_b64_tr_b16 v[236:237], v23 offset:8192
v_mfma_f32_16x16x32_bf16 a[104:107], v[172:175], v[136:139], 0
ds_read_b64_tr_b16 v[238:239], v23 offset:9216
v_mfma_f32_16x16x32_bf16 a[100:103], v[172:175], v[132:135], 0
ds_read_b64_tr_b16 v[240:241], v20 offset:24576
v_mfma_f32_16x16x32_bf16 a[96:99], v[172:175], v[128:131], 0
ds_read_b64_tr_b16 v[242:243], v20 offset:25600
v_mfma_f32_16x16x32_bf16 a[128:131], v[128:131], v[176:179], 0
ds_read_b64_tr_b16 v[244:245], v21 offset:24576
v_mfma_f32_16x16x32_bf16 a[132:135], v[132:135], v[176:179], 0
ds_read_b64_tr_b16 v[246:247], v21 offset:25600
v_mfma_f32_16x16x32_bf16 a[136:139], v[136:139], v[176:179], 0
ds_read_b64_tr_b16 v[248:249], v22 offset:24576
v_mfma_f32_16x16x32_bf16 a[140:143], v[140:143], v[176:179], 0
ds_read_b64_tr_b16 v[250:251], v22 offset:25600
v_mfma_f32_16x16x32_bf16 a[144:147], v[144:147], v[176:179], 0
ds_read_b64_tr_b16 v[252:253], v23 offset:24576
v_mfma_f32_16x16x32_bf16 a[148:151], v[148:151], v[176:179], 0
ds_read_b64_tr_b16 v[254:255], v23 offset:25600
v_mfma_f32_16x16x32_bf16 a[152:155], v[152:155], v[176:179], 0
v_mfma_f32_16x16x32_bf16 a[156:159], v[156:159], v[176:179], 0
v_mfma_f32_16x16x32_bf16 a[188:191], v[156:159], v[180:183], 0
v_mfma_f32_16x16x32_bf16 a[184:187], v[152:155], v[180:183], 0
v_mfma_f32_16x16x32_bf16 a[180:183], v[148:151], v[180:183], 0
v_mfma_f32_16x16x32_bf16 a[176:179], v[144:147], v[180:183], 0
v_mfma_f32_16x16x32_bf16 a[172:175], v[140:143], v[180:183], 0
v_mfma_f32_16x16x32_bf16 a[168:171], v[136:139], v[180:183], 0
v_mfma_f32_16x16x32_bf16 a[164:167], v[132:135], v[180:183], 0
v_mfma_f32_16x16x32_bf16 a[160:163], v[128:131], v[180:183], 0
v_mfma_f32_16x16x32_bf16 a[192:195], v[128:131], v[184:187], 0
v_mfma_f32_16x16x32_bf16 a[196:199], v[132:135], v[184:187], 0
v_mfma_f32_16x16x32_bf16 a[200:203], v[136:139], v[184:187], 0
v_mfma_f32_16x16x32_bf16 a[204:207], v[140:143], v[184:187], 0
v_mfma_f32_16x16x32_bf16 a[208:211], v[144:147], v[184:187], 0
v_mfma_f32_16x16x32_bf16 a[212:215], v[148:151], v[184:187], 0
v_mfma_f32_16x16x32_bf16 a[216:219], v[152:155], v[184:187], 0
v_mfma_f32_16x16x32_bf16 a[220:223], v[156:159], v[184:187], 0
v_mfma_f32_16x16x32_bf16 a[252:255], v[156:159], v[188:191], 0
v_mfma_f32_16x16x32_bf16 a[248:251], v[152:155], v[188:191], 0
v_mfma_f32_16x16x32_bf16 a[244:247], v[148:151], v[188:191], 0
v_mfma_f32_16x16x32_bf16 a[240:243], v[144:147], v[188:191], 0
v_mfma_f32_16x16x32_bf16 a[236:239], v[140:143], v[188:191], 0
v_mfma_f32_16x16x32_bf16 a[232:235], v[136:139], v[188:191], 0
v_mfma_f32_16x16x32_bf16 a[228:231], v[132:135], v[188:191], 0
s_waitcnt vmcnt(2) lgkmcnt(0)
v_mfma_f32_16x16x32_bf16 a[224:227], v[128:131], v[188:191], 0
s_barrier
v_mfma_f32_16x16x32_bf16 a[0:3], v[224:227], v[192:195], a[0:3]
s_add_u32 s73, s61, 2
ds_read_b64_tr_b16 v[160:161], v20 offset:32768
v_mfma_f32_16x16x32_bf16 a[4:7], v[224:227], v[196:199], a[4:7]
s_and_b32 s73, s73, 7
ds_read_b64_tr_b16 v[162:163], v20 offset:33792
v_mfma_f32_16x16x32_bf16 a[8:11], v[224:227], v[200:203], a[8:11]
s_lshl_b32 s69, s73, 7
ds_read_b128 v[128:131], v24 offset:32768
v_mfma_f32_16x16x32_bf16 a[12:15], v[224:227], v[204:207], a[12:15]
s_add_u32 s69, s69, s67
ds_read_b128 v[132:135], v24 offset:34816
v_mfma_f32_16x16x32_bf16 a[16:19], v[224:227], v[208:211], a[16:19]
s_lshl_b32 s71, s73, 19
ds_read_b128 v[136:139], v24 offset:36864
v_mfma_f32_16x16x32_bf16 a[20:23], v[224:227], v[212:215], a[20:23]
s_add_u32 s71, s71, s66
ds_read_b128 v[140:143], v24 offset:38912
v_mfma_f32_16x16x32_bf16 a[24:27], v[224:227], v[216:219], a[24:27]
s_add_u32 m0, s63, 65536
ds_read_b128 v[144:147], v24 offset:40960
v_mfma_f32_16x16x32_bf16 a[28:31], v[224:227], v[220:223], a[28:31]
s_add_u32 s72, s69, 0
buffer_load_dwordx4 v2, s[8:11], s72 offen lds
v_mfma_f32_16x16x32_bf16 a[60:63], v[228:231], v[220:223], a[60:63]
s_add_u32 s72, s69, 7168
buffer_load_dwordx4 v3, s[8:11], s72 offen offset:1024 lds
v_mfma_f32_16x16x32_bf16 a[56:59], v[228:231], v[216:219], a[56:59]
s_add_u32 s72, s69, 14336
buffer_load_dwordx4 v2, s[8:11], s72 offen offset:2048 lds
v_mfma_f32_16x16x32_bf16 a[52:55], v[228:231], v[212:215], a[52:55]
ds_read_b128 v[148:151], v24 offset:43008
v_mfma_f32_16x16x32_bf16 a[48:51], v[228:231], v[208:211], a[48:51]
ds_read_b128 v[152:155], v24 offset:45056
v_mfma_f32_16x16x32_bf16 a[44:47], v[228:231], v[204:207], a[44:47]
s_add_u32 s72, s69, 21504
buffer_load_dwordx4 v3, s[8:11], s72 offen offset:3072 lds
v_mfma_f32_16x16x32_bf16 a[40:43], v[228:231], v[200:203], a[40:43]
ds_read_b128 v[156:159], v24 offset:47104
v_mfma_f32_16x16x32_bf16 a[36:39], v[228:231], v[196:199], a[36:39]
ds_read_b64_tr_b16 v[164:165], v21 offset:32768
v_mfma_f32_16x16x32_bf16 a[32:35], v[228:231], v[192:195], a[32:35]
ds_read_b64_tr_b16 v[166:167], v21 offset:33792
v_mfma_f32_16x16x32_bf16 a[64:67], v[232:235], v[192:195], a[64:67]
ds_read_b64_tr_b16 v[168:169], v22 offset:32768
v_mfma_f32_16x16x32_bf16 a[68:71], v[232:235], v[196:199], a[68:71]
s_add_u32 m0, s64, 0
ds_read_b64_tr_b16 v[170:171], v22 offset:33792
v_mfma_f32_16x16x32_bf16 a[72:75], v[232:235], v[200:203], a[72:75]
s_add_u32 s72, s71, 0
buffer_load_dwordx4 v6, s[16:19], s72 offen lds
v_mfma_f32_16x16x32_bf16 a[76:79], v[232:235], v[204:207], a[76:79]
ds_read_b64_tr_b16 v[172:173], v23 offset:32768
v_mfma_f32_16x16x32_bf16 a[80:83], v[232:235], v[208:211], a[80:83]
ds_read_b64_tr_b16 v[174:175], v23 offset:33792
v_mfma_f32_16x16x32_bf16 a[84:87], v[232:235], v[212:215], a[84:87]
s_add_u32 s72, s71, 31744
buffer_load_dwordx4 v6, s[16:19], s72 offen offset:1024 lds
v_mfma_f32_16x16x32_bf16 a[88:91], v[232:235], v[216:219], a[88:91]
ds_read_b64_tr_b16 v[176:177], v20 offset:49152
v_mfma_f32_16x16x32_bf16 a[92:95], v[232:235], v[220:223], a[92:95]
ds_read_b64_tr_b16 v[178:179], v20 offset:50176
v_mfma_f32_16x16x32_bf16 a[124:127], v[236:239], v[220:223], a[124:127]
ds_read_b64_tr_b16 v[180:181], v21 offset:49152
v_mfma_f32_16x16x32_bf16 a[120:123], v[236:239], v[216:219], a[120:123]
s_add_u32 s72, s71, 63488
buffer_load_dwordx4 v7, s[16:19], s72 offen offset:2048 lds
v_mfma_f32_16x16x32_bf16 a[116:119], v[236:239], v[212:215], a[116:119]
ds_read_b64_tr_b16 v[182:183], v21 offset:50176
v_mfma_f32_16x16x32_bf16 a[112:115], v[236:239], v[208:211], a[112:115]
ds_read_b64_tr_b16 v[184:185], v22 offset:49152
v_mfma_f32_16x16x32_bf16 a[108:111], v[236:239], v[204:207], a[108:111]
ds_read_b64_tr_b16 v[186:187], v22 offset:50176
v_mfma_f32_16x16x32_bf16 a[104:107], v[236:239], v[200:203], a[104:107]
ds_read_b64_tr_b16 v[188:189], v23 offset:49152
v_mfma_f32_16x16x32_bf16 a[100:103], v[236:239], v[196:199], a[100:103]
s_add_u32 s72, s71, 95232
buffer_load_dwordx4 v7, s[16:19], s72 offen offset:3072 lds
v_mfma_f32_16x16x32_bf16 a[96:99], v[236:239], v[192:195], a[96:99]
ds_read_b64_tr_b16 v[190:191], v23 offset:50176
v_mfma_f32_16x16x32_bf16 a[128:131], v[192:195], v[240:243], a[128:131]
v_mfma_f32_16x16x32_bf16 a[132:135], v[196:199], v[240:243], a[132:135]
v_mfma_f32_16x16x32_bf16 a[136:139], v[200:203], v[240:243], a[136:139]
s_add_u32 m0, s63, 69632
v_mfma_f32_16x16x32_bf16 a[140:143], v[204:207], v[240:243], a[140:143]
s_add_u32 s72, s69, 32768
buffer_load_dwordx4 v2, s[8:11], s72 offen lds
v_mfma_f32_16x16x32_bf16 a[144:147], v[208:211], v[240:243], a[144:147]
v_mfma_f32_16x16x32_bf16 a[148:151], v[212:215], v[240:243], a[148:151]
v_mfma_f32_16x16x32_bf16 a[152:155], v[216:219], v[240:243], a[152:155]
s_add_u32 s72, s69, 39936
buffer_load_dwordx4 v3, s[8:11], s72 offen offset:1024 lds
v_mfma_f32_16x16x32_bf16 a[156:159], v[220:223], v[240:243], a[156:159]
v_mfma_f32_16x16x32_bf16 a[188:191], v[220:223], v[244:247], a[188:191]
v_mfma_f32_16x16x32_bf16 a[184:187], v[216:219], v[244:247], a[184:187]
v_mfma_f32_16x16x32_bf16 a[180:183], v[212:215], v[244:247], a[180:183]
v_mfma_f32_16x16x32_bf16 a[176:179], v[208:211], v[244:247], a[176:179]
s_add_u32 s72, s69, 47104
buffer_load_dwordx4 v2, s[8:11], s72 offen offset:2048 lds
v_mfma_f32_16x16x32_bf16 a[172:175], v[204:207], v[244:247], a[172:175]
v_mfma_f32_16x16x32_bf16 a[168:171], v[200:203], v[244:247], a[168:171]
v_mfma_f32_16x16x32_bf16 a[164:167], v[196:199], v[244:247], a[164:167]
v_mfma_f32_16x16x32_bf16 a[160:163], v[192:195], v[244:247], a[160:163]
s_add_u32 s72, s69, 54272
buffer_load_dwordx4 v3, s[8:11], s72 offen offset:3072 lds
v_mfma_f32_16x16x32_bf16 a[192:195], v[192:195], v[248:251], a[192:195]
v_mfma_f32_16x16x32_bf16 a[196:199], v[196:199], v[248:251], a[196:199]
v_mfma_f32_16x16x32_bf16 a[200:203], v[200:203], v[248:251], a[200:203]
v_mfma_f32_16x16x32_bf16 a[204:207], v[204:207], v[248:251], a[204:207]
s_add_u32 m0, s64, 16384
v_mfma_f32_16x16x32_bf16 a[208:211], v[208:211], v[248:251], a[208:211]
s_add_u32 s72, s71, 0
buffer_load_dwordx4 v6, s[20:23], s72 offen lds
v_mfma_f32_16x16x32_bf16 a[212:215], v[212:215], v[248:251], a[212:215]
v_mfma_f32_16x16x32_bf16 a[216:219], v[216:219], v[248:251], a[216:219]
v_mfma_f32_16x16x32_bf16 a[220:223], v[220:223], v[248:251], a[220:223]
v_mfma_f32_16x16x32_bf16 a[252:255], v[220:223], v[252:255], a[252:255]
s_add_u32 s72, s71, 31744
buffer_load_dwordx4 v6, s[20:23], s72 offen offset:1024 lds
v_mfma_f32_16x16x32_bf16 a[248:251], v[216:219], v[252:255], a[248:251]
v_mfma_f32_16x16x32_bf16 a[244:247], v[212:215], v[252:255], a[244:247]
v_mfma_f32_16x16x32_bf16 a[240:243], v[208:211], v[252:255], a[240:243]
v_mfma_f32_16x16x32_bf16 a[236:239], v[204:207], v[252:255], a[236:239]
s_add_u32 s72, s71, 63488
buffer_load_dwordx4 v7, s[20:23], s72 offen offset:2048 lds
v_mfma_f32_16x16x32_bf16 a[232:235], v[200:203], v[252:255], a[232:235]
v_mfma_f32_16x16x32_bf16 a[228:231], v[196:199], v[252:255], a[228:231]
v_mfma_f32_16x16x32_bf16 a[224:227], v[192:195], v[252:255], a[224:227]
s_waitcnt lgkmcnt(0)
v_mfma_f32_16x16x32_bf16 a[0:3], v[160:163], v[128:131], a[0:3]
s_add_u32 s72, s71, 95232
buffer_load_dwordx4 v7, s[20:23], s72 offen offset:3072 lds
v_mfma_f32_16x16x32_bf16 a[4:7], v[160:163], v[132:135], a[4:7]
s_add_u32 s80, s65, 2
ds_read_b64_tr_b16 v[224:225], v20 offset:40960
v_mfma_f32_16x16x32_bf16 a[8:11], v[160:163], v[136:139], a[8:11]
s_and_b32 s80, s80, 3
ds_read_b64_tr_b16 v[226:227], v20 offset:41984
v_mfma_f32_16x16x32_bf16 a[12:15], v[160:163], v[140:143], a[12:15]
s_lshl_b32 s80, s80, 20
buffer_load_dword v126, v125, s[16:19], s80 offen
v_mfma_f32_16x16x32_bf16 a[16:19], v[160:163], v[144:147], a[16:19]
buffer_load_dword v126, v125, s[20:23], s80 offen
v_mfma_f32_16x16x32_bf16 a[20:23], v[160:163], v[148:151], a[20:23]
global_load_dwordx4 v[68:71], v30, s[52:53]
v_mfma_f32_16x16x32_bf16 a[24:27], v[160:163], v[152:155], a[24:27]
buffer_load_dword v32, v27, s[28:31], 0 offen nt
v_mfma_f32_16x16x32_bf16 a[28:31], v[160:163], v[156:159], a[28:31]
buffer_load_dword v33, v27, s[28:31], 0 offen offset:2048 nt
v_mfma_f32_16x16x32_bf16 a[60:63], v[164:167], v[156:159], a[60:63]
ds_read_b128 v[192:195], v25 offset:32768
v_add_u32 v27, 0x1000, v27
v_mfma_f32_16x16x32_bf16 a[56:59], v[164:167], v[152:155], a[56:59]
buffer_load_dword v34, v27, s[28:31], 0 offen nt
v_mfma_f32_16x16x32_bf16 a[52:55], v[164:167], v[148:151], a[52:55]
s_mov_b32 s80, 0
buffer_load_dword v35, v26, s[28:31], s80 offen nt
v_mfma_f32_16x16x32_bf16 a[48:51], v[164:167], v[144:147], a[48:51]
buffer_load_dword v36, v26, s[28:31], s80 offen offset:2048 nt
v_mfma_f32_16x16x32_bf16 a[44:47], v[164:167], v[140:143], a[44:47]
s_mov_b32 s80, 4096
buffer_load_dword v37, v26, s[28:31], s80 offen nt
v_mfma_f32_16x16x32_bf16 a[40:43], v[164:167], v[136:139], a[40:43]
buffer_load_dword v38, v26, s[28:31], s80 offen offset:2048 nt
v_mfma_f32_16x16x32_bf16 a[36:39], v[164:167], v[132:135], a[36:39]
s_mov_b32 s80, 8192
buffer_load_dword v39, v26, s[28:31], s80 offen nt
v_mfma_f32_16x16x32_bf16 a[32:35], v[164:167], v[128:131], a[32:35]
buffer_load_dword v40, v26, s[28:31], s80 offen offset:2048 nt
v_mfma_f32_16x16x32_bf16 a[64:67], v[168:171], v[128:131], a[64:67]
s_mov_b32 s80, 12288
buffer_load_dword v41, v26, s[28:31], s80 offen nt
v_mfma_f32_16x16x32_bf16 a[68:71], v[168:171], v[132:135], a[68:71]
buffer_load_dword v42, v26, s[28:31], s80 offen offset:2048 nt
v_mfma_f32_16x16x32_bf16 a[72:75], v[168:171], v[136:139], a[72:75]
s_mov_b32 s80, 16384
buffer_load_dword v43, v26, s[28:31], s80 offen nt
v_mfma_f32_16x16x32_bf16 a[76:79], v[168:171], v[140:143], a[76:79]
buffer_load_dword v44, v26, s[28:31], s80 offen offset:2048 nt
v_mfma_f32_16x16x32_bf16 a[80:83], v[168:171], v[144:147], a[80:83]
s_mov_b32 s80, 20480
buffer_load_dword v45, v26, s[28:31], s80 offen nt
v_mfma_f32_16x16x32_bf16 a[84:87], v[168:171], v[148:151], a[84:87]
buffer_load_dword v46, v26, s[28:31], s80 offen offset:2048 nt
v_mfma_f32_16x16x32_bf16 a[88:91], v[168:171], v[152:155], a[88:91]
s_mov_b32 s80, 24576
buffer_load_dword v47, v26, s[28:31], s80 offen nt
v_mfma_f32_16x16x32_bf16 a[92:95], v[168:171], v[156:159], a[92:95]
buffer_load_dword v48, v26, s[28:31], s80 offen offset:2048 nt
v_mfma_f32_16x16x32_bf16 a[124:127], v[172:175], v[156:159], a[124:127]
s_mov_b32 s80, 28672
buffer_load_dword v49, v26, s[28:31], s80 offen nt
v_mfma_f32_16x16x32_bf16 a[120:123], v[172:175], v[152:155], a[120:123]
buffer_load_dword v50, v26, s[28:31], s80 offen offset:2048 nt
v_mfma_f32_16x16x32_bf16 a[116:119], v[172:175], v[148:151], a[116:119]
ds_read_b128 v[196:199], v25 offset:34816
v_mfma_f32_16x16x32_bf16 a[112:115], v[172:175], v[144:147], a[112:115]
ds_read_b128 v[200:203], v25 offset:36864
v_mfma_f32_16x16x32_bf16 a[108:111], v[172:175], v[140:143], a[108:111]
ds_read_b128 v[204:207], v25 offset:38912
v_mfma_f32_16x16x32_bf16 a[104:107], v[172:175], v[136:139], a[104:107]
ds_read_b128 v[208:211], v25 offset:40960
v_mfma_f32_16x16x32_bf16 a[100:103], v[172:175], v[132:135], a[100:103]
ds_read_b128 v[212:215], v25 offset:43008
v_mfma_f32_16x16x32_bf16 a[96:99], v[172:175], v[128:131], a[96:99]
ds_read_b128 v[216:219], v25 offset:45056
v_mfma_f32_16x16x32_bf16 a[128:131], v[128:131], v[176:179], a[128:131]
ds_read_b128 v[220:223], v25 offset:47104
v_mfma_f32_16x16x32_bf16 a[132:135], v[132:135], v[176:179], a[132:135]
ds_read_b64_tr_b16 v[228:229], v21 offset:40960
v_mfma_f32_16x16x32_bf16 a[136:139], v[136:139], v[176:179], a[136:139]
ds_read_b64_tr_b16 v[230:231], v21 offset:41984
v_mfma_f32_16x16x32_bf16 a[140:143], v[140:143], v[176:179], a[140:143]
ds_read_b64_tr_b16 v[232:233], v22 offset:40960
v_mfma_f32_16x16x32_bf16 a[144:147], v[144:147], v[176:179], a[144:147]
ds_read_b64_tr_b16 v[234:235], v22 offset:41984
v_mfma_f32_16x16x32_bf16 a[148:151], v[148:151], v[176:179], a[148:151]
ds_read_b64_tr_b16 v[236:237], v23 offset:40960
v_mfma_f32_16x16x32_bf16 a[152:155], v[152:155], v[176:179], a[152:155]
ds_read_b64_tr_b16 v[238:239], v23 offset:41984
v_mfma_f32_16x16x32_bf16 a[156:159], v[156:159], v[176:179], a[156:159]
ds_read_b64_tr_b16 v[240:241], v20 offset:57344
v_mfma_f32_16x16x32_bf16 a[188:191], v[156:159], v[180:183], a[188:191]
ds_read_b64_tr_b16 v[242:243], v20 offset:58368
v_mfma_f32_16x16x32_bf16 a[184:187], v[152:155], v[180:183], a[184:187]
ds_read_b64_tr_b16 v[244:245], v21 offset:57344
v_mfma_f32_16x16x32_bf16 a[180:183], v[148:151], v[180:183], a[180:183]
ds_read_b64_tr_b16 v[246:247], v21 offset:58368
v_mfma_f32_16x16x32_bf16 a[176:179], v[144:147], v[180:183], a[176:179]
ds_read_b64_tr_b16 v[248:249], v22 offset:57344
v_mfma_f32_16x16x32_bf16 a[172:175], v[140:143], v[180:183], a[172:175]
ds_read_b64_tr_b16 v[250:251], v22 offset:58368
v_mfma_f32_16x16x32_bf16 a[168:171], v[136:139], v[180:183], a[168:171]
ds_read_b64_tr_b16 v[252:253], v23 offset:57344
v_mfma_f32_16x16x32_bf16 a[164:167], v[132:135], v[180:183], a[164:167]
ds_read_b64_tr_b16 v[254:255], v23 offset:58368
v_mfma_f32_16x16x32_bf16 a[160:163], v[128:131], v[180:183], a[160:163]
v_mfma_f32_16x16x32_bf16 a[192:195], v[128:131], v[184:187], a[192:195]
v_mfma_f32_16x16x32_bf16 a[196:199], v[132:135], v[184:187], a[196:199]
v_mfma_f32_16x16x32_bf16 a[200:203], v[136:139], v[184:187], a[200:203]
v_mfma_f32_16x16x32_bf16 a[204:207], v[140:143], v[184:187], a[204:207]
v_mfma_f32_16x16x32_bf16 a[208:211], v[144:147], v[184:187], a[208:211]
v_mfma_f32_16x16x32_bf16 a[212:215], v[148:151], v[184:187], a[212:215]
v_mfma_f32_16x16x32_bf16 a[216:219], v[152:155], v[184:187], a[216:219]
v_mfma_f32_16x16x32_bf16 a[220:223], v[156:159], v[184:187], a[220:223]
v_mfma_f32_16x16x32_bf16 a[252:255], v[156:159], v[188:191], a[252:255]
v_mfma_f32_16x16x32_bf16 a[248:251], v[152:155], v[188:191], a[248:251]
v_mfma_f32_16x16x32_bf16 a[244:247], v[148:151], v[188:191], a[244:247]
v_mfma_f32_16x16x32_bf16 a[240:243], v[144:147], v[188:191], a[240:243]
v_mfma_f32_16x16x32_bf16 a[236:239], v[140:143], v[188:191], a[236:239]
v_mfma_f32_16x16x32_bf16 a[232:235], v[136:139], v[188:191], a[232:235]
v_mfma_f32_16x16x32_bf16 a[228:231], v[132:135], v[188:191], a[228:231]
s_waitcnt vmcnt(22) lgkmcnt(0)
v_mfma_f32_16x16x32_bf16 a[224:227], v[128:131], v[188:191], a[224:227]
s_barrier
v_mfma_f32_16x16x32_bf16 a[0:3], v[224:227], v[192:195], a[0:3]
s_add_u32 s73, s61, 3
ds_read_b64_tr_b16 v[160:161], v20 offset:0
v_mfma_f32_16x16x32_bf16 a[4:7], v[224:227], v[196:199], a[4:7]
s_and_b32 s73, s73, 7
ds_read_b64_tr_b16 v[162:163], v20 offset:1024
v_mfma_f32_16x16x32_bf16 a[8:11], v[224:227], v[200:203], a[8:11]
s_lshl_b32 s69, s73, 7
ds_read_b128 v[128:131], v24 offset:0
v_mfma_f32_16x16x32_bf16 a[12:15], v[224:227], v[204:207], a[12:15]
s_add_u32 s69, s69, s67
ds_read_b128 v[132:135], v24 offset:2048
v_mfma_f32_16x16x32_bf16 a[16:19], v[224:227], v[208:211], a[16:19]
s_lshl_b32 s71, s73, 19
ds_read_b128 v[136:139], v24 offset:4096
v_mfma_f32_16x16x32_bf16 a[20:23], v[224:227], v[212:215], a[20:23]
s_add_u32 s71, s71, s66
ds_read_b128 v[140:143], v24 offset:6144
v_mfma_f32_16x16x32_bf16 a[24:27], v[224:227], v[216:219], a[24:27]
s_add_u32 m0, s63, 98304
ds_read_b128 v[144:147], v24 offset:8192
v_mfma_f32_16x16x32_bf16 a[28:31], v[224:227], v[220:223], a[28:31]
s_add_u32 s72, s69, 0
buffer_load_dwordx4 v2, s[8:11], s72 offen lds
v_mfma_f32_16x16x32_bf16 a[60:63], v[228:231], v[220:223], a[60:63]
s_add_u32 s72, s69, 7168
buffer_load_dwordx4 v3, s[8:11], s72 offen offset:1024 lds
v_mfma_f32_16x16x32_bf16 a[56:59], v[228:231], v[216:219], a[56:59]
s_add_u32 s72, s69, 14336
buffer_load_dwordx4 v2, s[8:11], s72 offen offset:2048 lds
v_mfma_f32_16x16x32_bf16 a[52:55], v[228:231], v[212:215], a[52:55]
ds_read_b128 v[148:151], v24 offset:10240
v_mfma_f32_16x16x32_bf16 a[48:51], v[228:231], v[208:211], a[48:51]
ds_read_b128 v[152:155], v24 offset:12288
v_mfma_f32_16x16x32_bf16 a[44:47], v[228:231], v[204:207], a[44:47]
s_add_u32 s72, s69, 21504
buffer_load_dwordx4 v3, s[8:11], s72 offen offset:3072 lds
v_mfma_f32_16x16x32_bf16 a[40:43], v[228:231], v[200:203], a[40:43]
ds_read_b128 v[156:159], v24 offset:14336
v_mfma_f32_16x16x32_bf16 a[36:39], v[228:231], v[196:199], a[36:39]
ds_read_b64_tr_b16 v[164:165], v21 offset:0
v_mfma_f32_16x16x32_bf16 a[32:35], v[228:231], v[192:195], a[32:35]
ds_read_b64_tr_b16 v[166:167], v21 offset:1024
v_mfma_f32_16x16x32_bf16 a[64:67], v[232:235], v[192:195], a[64:67]
ds_read_b64_tr_b16 v[168:169], v22 offset:0
v_mfma_f32_16x16x32_bf16 a[68:71], v[232:235], v[196:199], a[68:71]
s_add_u32 m0, s64, 32768
ds_read_b64_tr_b16 v[170:171], v22 offset:1024
v_mfma_f32_16x16x32_bf16 a[72:75], v[232:235], v[200:203], a[72:75]
s_add_u32 s72, s71, 0
buffer_load_dwordx4 v6, s[16:19], s72 offen lds
v_mfma_f32_16x16x32_bf16 a[76:79], v[232:235], v[204:207], a[76:79]
ds_read_b64_tr_b16 v[172:173], v23 offset:0
v_mfma_f32_16x16x32_bf16 a[80:83], v[232:235], v[208:211], a[80:83]
ds_read_b64_tr_b16 v[174:175], v23 offset:1024
v_mfma_f32_16x16x32_bf16 a[84:87], v[232:235], v[212:215], a[84:87]
s_add_u32 s72, s71, 31744
buffer_load_dwordx4 v6, s[16:19], s72 offen offset:1024 lds
v_mfma_f32_16x16x32_bf16 a[88:91], v[232:235], v[216:219], a[88:91]
ds_read_b64_tr_b16 v[176:177], v20 offset:16384
v_mfma_f32_16x16x32_bf16 a[92:95], v[232:235], v[220:223], a[92:95]
ds_read_b64_tr_b16 v[178:179], v20 offset:17408
v_mfma_f32_16x16x32_bf16 a[124:127], v[236:239], v[220:223], a[124:127]
ds_read_b64_tr_b16 v[180:181], v21 offset:16384
v_mfma_f32_16x16x32_bf16 a[120:123], v[236:239], v[216:219], a[120:123]
s_add_u32 s72, s71, 63488
buffer_load_dwordx4 v7, s[16:19], s72 offen offset:2048 lds
v_mfma_f32_16x16x32_bf16 a[116:119], v[236:239], v[212:215], a[116:119]
ds_read_b64_tr_b16 v[182:183], v21 offset:17408
v_mfma_f32_16x16x32_bf16 a[112:115], v[236:239], v[208:211], a[112:115]
ds_read_b64_tr_b16 v[184:185], v22 offset:16384
v_mfma_f32_16x16x32_bf16 a[108:111], v[236:239], v[204:207], a[108:111]
ds_read_b64_tr_b16 v[186:187], v22 offset:17408
v_mfma_f32_16x16x32_bf16 a[104:107], v[236:239], v[200:203], a[104:107]
ds_read_b64_tr_b16 v[188:189], v23 offset:16384
v_mfma_f32_16x16x32_bf16 a[100:103], v[236:239], v[196:199], a[100:103]
s_add_u32 s72, s71, 95232
buffer_load_dwordx4 v7, s[16:19], s72 offen offset:3072 lds
v_mfma_f32_16x16x32_bf16 a[96:99], v[236:239], v[192:195], a[96:99]
ds_read_b64_tr_b16 v[190:191], v23 offset:17408
v_mfma_f32_16x16x32_bf16 a[128:131], v[192:195], v[240:243], a[128:131]
v_mfma_f32_16x16x32_bf16 a[132:135], v[196:199], v[240:243], a[132:135]
v_mfma_f32_16x16x32_bf16 a[136:139], v[200:203], v[240:243], a[136:139]
s_add_u32 m0, s63, 102400
v_mfma_f32_16x16x32_bf16 a[140:143], v[204:207], v[240:243], a[140:143]
s_add_u32 s72, s69, 32768
buffer_load_dwordx4 v2, s[8:11], s72 offen lds
v_mfma_f32_16x16x32_bf16 a[144:147], v[208:211], v[240:243], a[144:147]
v_mfma_f32_16x16x32_bf16 a[148:151], v[212:215], v[240:243], a[148:151]
v_mfma_f32_16x16x32_bf16 a[152:155], v[216:219], v[240:243], a[152:155]
s_add_u32 s72, s69, 39936
buffer_load_dwordx4 v3, s[8:11], s72 offen offset:1024 lds
v_mfma_f32_16x16x32_bf16 a[156:159], v[220:223], v[240:243], a[156:159]
v_mfma_f32_16x16x32_bf16 a[188:191], v[220:223], v[244:247], a[188:191]
v_mfma_f32_16x16x32_bf16 a[184:187], v[216:219], v[244:247], a[184:187]
v_mfma_f32_16x16x32_bf16 a[180:183], v[212:215], v[244:247], a[180:183]
v_mfma_f32_16x16x32_bf16 a[176:179], v[208:211], v[244:247], a[176:179]
s_add_u32 s72, s69, 47104
buffer_load_dwordx4 v2, s[8:11], s72 offen offset:2048 lds
v_mfma_f32_16x16x32_bf16 a[172:175], v[204:207], v[244:247], a[172:175]
v_mfma_f32_16x16x32_bf16 a[168:171], v[200:203], v[244:247], a[168:171]
v_mfma_f32_16x16x32_bf16 a[164:167], v[196:199], v[244:247], a[164:167]
v_mfma_f32_16x16x32_bf16 a[160:163], v[192:195], v[244:247], a[160:163]
s_add_u32 s72, s69, 54272
buffer_load_dwordx4 v3, s[8:11], s72 offen offset:3072 lds
v_mfma_f32_16x16x32_bf16 a[192:195], v[192:195], v[248:251], a[192:195]
v_mfma_f32_16x16x32_bf16 a[196:199], v[196:199], v[248:251], a[196:199]
v_mfma_f32_16x16x32_bf16 a[200:203], v[200:203], v[248:251], a[200:203]
v_mfma_f32_16x16x32_bf16 a[204:207], v[204:207], v[248:251], a[204:207]
s_add_u32 m0, s64, 49152
v_mfma_f32_16x16x32_bf16 a[208:211], v[208:211], v[248:251], a[208:211]
s_add_u32 s72, s71, 0
buffer_load_dwordx4 v6, s[20:23], s72 offen lds
v_mfma_f32_16x16x32_bf16 a[212:215], v[212:215], v[248:251], a[212:215]
v_mfma_f32_16x16x32_bf16 a[216:219], v[216:219], v[248:251], a[216:219]
v_mfma_f32_16x16x32_bf16 a[220:223], v[220:223], v[248:251], a[220:223]
v_mfma_f32_16x16x32_bf16 a[252:255], v[220:223], v[252:255], a[252:255]
s_add_u32 s72, s71, 31744
buffer_load_dwordx4 v6, s[20:23], s72 offen offset:1024 lds
v_mfma_f32_16x16x32_bf16 a[248:251], v[216:219], v[252:255], a[248:251]
v_mfma_f32_16x16x32_bf16 a[244:247], v[212:215], v[252:255], a[244:247]
v_mfma_f32_16x16x32_bf16 a[240:243], v[208:211], v[252:255], a[240:243]
v_mfma_f32_16x16x32_bf16 a[236:239], v[204:207], v[252:255], a[236:239]
s_add_u32 s72, s71, 63488
buffer_load_dwordx4 v7, s[20:23], s72 offen offset:2048 lds
v_mfma_f32_16x16x32_bf16 a[232:235], v[200:203], v[252:255], a[232:235]
v_mfma_f32_16x16x32_bf16 a[228:231], v[196:199], v[252:255], a[228:231]
v_mfma_f32_16x16x32_bf16 a[224:227], v[192:195], v[252:255], a[224:227]
s_waitcnt lgkmcnt(0)
v_mfma_f32_16x16x32_bf16 a[0:3], v[160:163], v[128:131], a[0:3]
s_add_u32 s72, s71, 95232
buffer_load_dwordx4 v7, s[20:23], s72 offen offset:3072 lds
v_mfma_f32_16x16x32_bf16 a[4:7], v[160:163], v[132:135], a[4:7]
s_add_u32 s80, s65, 3
ds_read_b64_tr_b16 v[224:225], v20 offset:8192
v_mfma_f32_16x16x32_bf16 a[8:11], v[160:163], v[136:139], a[8:11]
s_and_b32 s80, s80, 3
ds_read_b64_tr_b16 v[226:227], v20 offset:9216
v_mfma_f32_16x16x32_bf16 a[12:15], v[160:163], v[140:143], a[12:15]
s_lshl_b32 s80, s80, 20
buffer_load_dword v126, v125, s[16:19], s80 offen
v_mfma_f32_16x16x32_bf16 a[16:19], v[160:163], v[144:147], a[16:19]
buffer_load_dword v126, v125, s[20:23], s80 offen
v_mfma_f32_16x16x32_bf16 a[20:23], v[160:163], v[148:151], a[20:23]
s_mov_b32 s80, 0
buffer_load_dword v51, v26, s[32:35], s80 offen nt
v_mfma_f32_16x16x32_bf16 a[24:27], v[160:163], v[152:155], a[24:27]
buffer_load_dword v52, v26, s[32:35], s80 offen offset:2048 nt
v_mfma_f32_16x16x32_bf16 a[28:31], v[160:163], v[156:159], a[28:31]
s_mov_b32 s80, 4096
buffer_load_dword v53, v26, s[32:35], s80 offen nt
v_mfma_f32_16x16x32_bf16 a[60:63], v[164:167], v[156:159], a[60:63]
buffer_load_dword v54, v26, s[32:35], s80 offen offset:2048 nt
v_mfma_f32_16x16x32_bf16 a[56:59], v[164:167], v[152:155], a[56:59]
s_mov_b32 s80, 8192
buffer_load_dword v55, v26, s[32:35], s80 offen nt
v_mfma_f32_16x16x32_bf16 a[52:55], v[164:167], v[148:151], a[52:55]
buffer_load_dword v56, v26, s[32:35], s80 offen offset:2048 nt
v_mfma_f32_16x16x32_bf16 a[48:51], v[164:167], v[144:147], a[48:51]
s_mov_b32 s80, 12288
buffer_load_dword v57, v26, s[32:35], s80 offen nt
v_mfma_f32_16x16x32_bf16 a[44:47], v[164:167], v[140:143], a[44:47]
buffer_load_dword v58, v26, s[32:35], s80 offen offset:2048 nt
v_mfma_f32_16x16x32_bf16 a[40:43], v[164:167], v[136:139], a[40:43]
s_mov_b32 s80, 16384
buffer_load_dword v59, v26, s[32:35], s80 offen nt
v_mfma_f32_16x16x32_bf16 a[36:39], v[164:167], v[132:135], a[36:39]
buffer_load_dword v60, v26, s[32:35], s80 offen offset:2048 nt
v_mfma_f32_16x16x32_bf16 a[32:35], v[164:167], v[128:131], a[32:35]
s_mov_b32 s80, 20480
buffer_load_dword v61, v26, s[32:35], s80 offen nt
v_mfma_f32_16x16x32_bf16 a[64:67], v[168:171], v[128:131], a[64:67]
buffer_load_dword v62, v26, s[32:35], s80 offen offset:2048 nt
v_mfma_f32_16x16x32_bf16 a[68:71], v[168:171], v[132:135], a[68:71]
s_mov_b32 s80, 24576
buffer_load_dword v63, v26, s[32:35], s80 offen nt
v_mfma_f32_16x16x32_bf16 a[72:75], v[168:171], v[136:139], a[72:75]
buffer_load_dword v64, v26, s[32:35], s80 offen offset:2048 nt
v_mfma_f32_16x16x32_bf16 a[76:79], v[168:171], v[140:143], a[76:79]
s_mov_b32 s80, 28672
buffer_load_dword v65, v26, s[32:35], s80 offen nt
v_mfma_f32_16x16x32_bf16 a[80:83], v[168:171], v[144:147], a[80:83]
buffer_load_dword v66, v26, s[32:35], s80 offen offset:2048 nt
v_mfma_f32_16x16x32_bf16 a[84:87], v[168:171], v[148:151], a[84:87]
ds_read_b128 v[192:195], v25 offset:0
v_mfma_f32_16x16x32_bf16 a[88:91], v[168:171], v[152:155], a[88:91]
ds_read_b128 v[196:199], v25 offset:2048
v_mfma_f32_16x16x32_bf16 a[92:95], v[168:171], v[156:159], a[92:95]
ds_read_b128 v[200:203], v25 offset:4096
v_mfma_f32_16x16x32_bf16 a[124:127], v[172:175], v[156:159], a[124:127]
ds_read_b128 v[204:207], v25 offset:6144
v_mfma_f32_16x16x32_bf16 a[120:123], v[172:175], v[152:155], a[120:123]
ds_read_b128 v[208:211], v25 offset:8192
v_mfma_f32_16x16x32_bf16 a[116:119], v[172:175], v[148:151], a[116:119]
ds_read_b128 v[212:215], v25 offset:10240
v_mfma_f32_16x16x32_bf16 a[112:115], v[172:175], v[144:147], a[112:115]
ds_read_b128 v[216:219], v25 offset:12288
v_mfma_f32_16x16x32_bf16 a[108:111], v[172:175], v[140:143], a[108:111]
ds_read_b128 v[220:223], v25 offset:14336
v_mfma_f32_16x16x32_bf16 a[104:107], v[172:175], v[136:139], a[104:107]
ds_read_b64_tr_b16 v[228:229], v21 offset:8192
v_mfma_f32_16x16x32_bf16 a[100:103], v[172:175], v[132:135], a[100:103]
ds_read_b64_tr_b16 v[230:231], v21 offset:9216
v_mfma_f32_16x16x32_bf16 a[96:99], v[172:175], v[128:131], a[96:99]
ds_read_b64_tr_b16 v[232:233], v22 offset:8192
v_mfma_f32_16x16x32_bf16 a[128:131], v[128:131], v[176:179], a[128:131]
ds_read_b64_tr_b16 v[234:235], v22 offset:9216
v_mfma_f32_16x16x32_bf16 a[132:135], v[132:135], v[176:179], a[132:135]
ds_read_b64_tr_b16 v[236:237], v23 offset:8192
v_mfma_f32_16x16x32_bf16 a[136:139], v[136:139], v[176:179], a[136:139]
ds_read_b64_tr_b16 v[238:239], v23 offset:9216
v_mfma_f32_16x16x32_bf16 a[140:143], v[140:143], v[176:179], a[140:143]
ds_read_b64_tr_b16 v[240:241], v20 offset:24576
v_mfma_f32_16x16x32_bf16 a[144:147], v[144:147], v[176:179], a[144:147]
ds_read_b64_tr_b16 v[242:243], v20 offset:25600
v_mfma_f32_16x16x32_bf16 a[148:151], v[148:151], v[176:179], a[148:151]
ds_read_b64_tr_b16 v[244:245], v21 offset:24576
v_mfma_f32_16x16x32_bf16 a[152:155], v[152:155], v[176:179], a[152:155]
ds_read_b64_tr_b16 v[246:247], v21 offset:25600
v_mfma_f32_16x16x32_bf16 a[156:159], v[156:159], v[176:179], a[156:159]
ds_read_b64_tr_b16 v[248:249], v22 offset:24576
v_mfma_f32_16x16x32_bf16 a[188:191], v[156:159], v[180:183], a[188:191]
ds_read_b64_tr_b16 v[250:251], v22 offset:25600
v_mfma_f32_16x16x32_bf16 a[184:187], v[152:155], v[180:183], a[184:187]
ds_read_b64_tr_b16 v[252:253], v23 offset:24576
v_mfma_f32_16x16x32_bf16 a[180:183], v[148:151], v[180:183], a[180:183]
ds_read_b64_tr_b16 v[254:255], v23 offset:25600
v_mfma_f32_16x16x32_bf16 a[176:179], v[144:147], v[180:183], a[176:179]
v_mfma_f32_16x16x32_bf16 a[172:175], v[140:143], v[180:183], a[172:175]
v_mfma_f32_16x16x32_bf16 a[168:171], v[136:139], v[180:183], a[168:171]
v_mfma_f32_16x16x32_bf16 a[164:167], v[132:135], v[180:183], a[164:167]
v_mfma_f32_16x16x32_bf16 a[160:163], v[128:131], v[180:183], a[160:163]
v_mfma_f32_16x16x32_bf16 a[192:195], v[128:131], v[184:187], a[192:195]
v_mfma_f32_16x16x32_bf16 a[196:199], v[132:135], v[184:187], a[196:199]
v_mfma_f32_16x16x32_bf16 a[200:203], v[136:139], v[184:187], a[200:203]
v_mfma_f32_16x16x32_bf16 a[204:207], v[140:143], v[184:187], a[204:207]
v_mfma_f32_16x16x32_bf16 a[208:211], v[144:147], v[184:187], a[208:211]
v_mfma_f32_16x16x32_bf16 a[212:215], v[148:151], v[184:187], a[212:215]
v_mfma_f32_16x16x32_bf16 a[216:219], v[152:155], v[184:187], a[216:219]
v_mfma_f32_16x16x32_bf16 a[220:223], v[156:159], v[184:187], a[220:223]
v_mfma_f32_16x16x32_bf16 a[252:255], v[156:159], v[188:191], a[252:255]
v_mfma_f32_16x16x32_bf16 a[248:251], v[152:155], v[188:191], a[248:251]
v_mfma_f32_16x16x32_bf16 a[244:247], v[148:151], v[188:191], a[244:247]
v_mfma_f32_16x16x32_bf16 a[240:243], v[144:147], v[188:191], a[240:243]
v_mfma_f32_16x16x32_bf16 a[236:239], v[140:143], v[188:191], a[236:239]
v_mfma_f32_16x16x32_bf16 a[232:235], v[136:139], v[188:191], a[232:235]
v_mfma_f32_16x16x32_bf16 a[228:231], v[132:135], v[188:191], a[228:231]
s_waitcnt vmcnt(18) lgkmcnt(0)
v_mfma_f32_16x16x32_bf16 a[224:227], v[128:131], v[188:191], a[224:227]
s_barrier
v_mfma_f32_16x16x32_bf16 a[0:3], v[224:227], v[192:195], a[0:3]
s_add_u32 s73, s61, 4
ds_read_b64_tr_b16 v[160:161], v20 offset:32768
v_mfma_f32_16x16x32_bf16 a[4:7], v[224:227], v[196:199], a[4:7]
s_and_b32 s73, s73, 7
ds_read_b64_tr_b16 v[162:163], v20 offset:33792
v_mfma_f32_16x16x32_bf16 a[8:11], v[224:227], v[200:203], a[8:11]
s_lshl_b32 s69, s73, 7
ds_read_b128 v[128:131], v24 offset:32768
v_mfma_f32_16x16x32_bf16 a[12:15], v[224:227], v[204:207], a[12:15]
s_add_u32 s69, s69, s67
ds_read_b128 v[132:135], v24 offset:34816
v_mfma_f32_16x16x32_bf16 a[16:19], v[224:227], v[208:211], a[16:19]
s_lshl_b32 s71, s73, 19
ds_read_b128 v[136:139], v24 offset:36864
v_mfma_f32_16x16x32_bf16 a[20:23], v[224:227], v[212:215], a[20:23]
s_add_u32 s71, s71, s66
ds_read_b128 v[140:143], v24 offset:38912
v_mfma_f32_16x16x32_bf16 a[24:27], v[224:227], v[216:219], a[24:27]
s_add_u32 m0, s63, 65536
ds_read_b128 v[144:147], v24 offset:40960
v_mfma_f32_16x16x32_bf16 a[28:31], v[224:227], v[220:223], a[28:31]
s_add_u32 s72, s69, 0
buffer_load_dwordx4 v2, s[8:11], s72 offen lds
v_mfma_f32_16x16x32_bf16 a[60:63], v[228:231], v[220:223], a[60:63]
s_add_u32 s72, s69, 7168
buffer_load_dwordx4 v3, s[8:11], s72 offen offset:1024 lds
v_mfma_f32_16x16x32_bf16 a[56:59], v[228:231], v[216:219], a[56:59]
s_add_u32 s72, s69, 14336
buffer_load_dwordx4 v2, s[8:11], s72 offen offset:2048 lds
v_mfma_f32_16x16x32_bf16 a[52:55], v[228:231], v[212:215], a[52:55]
ds_read_b128 v[148:151], v24 offset:43008
v_mfma_f32_16x16x32_bf16 a[48:51], v[228:231], v[208:211], a[48:51]
ds_read_b128 v[152:155], v24 offset:45056
v_mfma_f32_16x16x32_bf16 a[44:47], v[228:231], v[204:207], a[44:47]
s_add_u32 s72, s69, 21504
buffer_load_dwordx4 v3, s[8:11], s72 offen offset:3072 lds
v_mfma_f32_16x16x32_bf16 a[40:43], v[228:231], v[200:203], a[40:43]
ds_read_b128 v[156:159], v24 offset:47104
v_mfma_f32_16x16x32_bf16 a[36:39], v[228:231], v[196:199], a[36:39]
ds_read_b64_tr_b16 v[164:165], v21 offset:32768
v_mfma_f32_16x16x32_bf16 a[32:35], v[228:231], v[192:195], a[32:35]
ds_read_b64_tr_b16 v[166:167], v21 offset:33792
v_mfma_f32_16x16x32_bf16 a[64:67], v[232:235], v[192:195], a[64:67]
ds_read_b64_tr_b16 v[168:169], v22 offset:32768
v_mfma_f32_16x16x32_bf16 a[68:71], v[232:235], v[196:199], a[68:71]
s_add_u32 m0, s64, 0
ds_read_b64_tr_b16 v[170:171], v22 offset:33792
v_mfma_f32_16x16x32_bf16 a[72:75], v[232:235], v[200:203], a[72:75]
s_add_u32 s72, s71, 0
buffer_load_dwordx4 v6, s[16:19], s72 offen lds
v_mfma_f32_16x16x32_bf16 a[76:79], v[232:235], v[204:207], a[76:79]
ds_read_b64_tr_b16 v[172:173], v23 offset:32768
v_mfma_f32_16x16x32_bf16 a[80:83], v[232:235], v[208:211], a[80:83]
ds_read_b64_tr_b16 v[174:175], v23 offset:33792
v_mfma_f32_16x16x32_bf16 a[84:87], v[232:235], v[212:215], a[84:87]
s_add_u32 s72, s71, 31744
buffer_load_dwordx4 v6, s[16:19], s72 offen offset:1024 lds
v_mfma_f32_16x16x32_bf16 a[88:91], v[232:235], v[216:219], a[88:91]
ds_read_b64_tr_b16 v[176:177], v20 offset:49152
v_mfma_f32_16x16x32_bf16 a[92:95], v[232:235], v[220:223], a[92:95]
ds_read_b64_tr_b16 v[178:179], v20 offset:50176
v_mfma_f32_16x16x32_bf16 a[124:127], v[236:239], v[220:223], a[124:127]
ds_read_b64_tr_b16 v[180:181], v21 offset:49152
v_mfma_f32_16x16x32_bf16 a[120:123], v[236:239], v[216:219], a[120:123]
s_add_u32 s72, s71, 63488
buffer_load_dwordx4 v7, s[16:19], s72 offen offset:2048 lds
v_mfma_f32_16x16x32_bf16 a[116:119], v[236:239], v[212:215], a[116:119]
ds_read_b64_tr_b16 v[182:183], v21 offset:50176
v_mfma_f32_16x16x32_bf16 a[112:115], v[236:239], v[208:211], a[112:115]
ds_read_b64_tr_b16 v[184:185], v22 offset:49152
v_mfma_f32_16x16x32_bf16 a[108:111], v[236:239], v[204:207], a[108:111]
ds_read_b64_tr_b16 v[186:187], v22 offset:50176
v_mfma_f32_16x16x32_bf16 a[104:107], v[236:239], v[200:203], a[104:107]
ds_read_b64_tr_b16 v[188:189], v23 offset:49152
v_mfma_f32_16x16x32_bf16 a[100:103], v[236:239], v[196:199], a[100:103]
s_add_u32 s72, s71, 95232
buffer_load_dwordx4 v7, s[16:19], s72 offen offset:3072 lds
v_mfma_f32_16x16x32_bf16 a[96:99], v[236:239], v[192:195], a[96:99]
ds_read_b64_tr_b16 v[190:191], v23 offset:50176
v_mfma_f32_16x16x32_bf16 a[128:131], v[192:195], v[240:243], a[128:131]
v_mfma_f32_16x16x32_bf16 a[132:135], v[196:199], v[240:243], a[132:135]
v_mfma_f32_16x16x32_bf16 a[136:139], v[200:203], v[240:243], a[136:139]
s_add_u32 m0, s63, 69632
v_mfma_f32_16x16x32_bf16 a[140:143], v[204:207], v[240:243], a[140:143]
s_add_u32 s72, s69, 32768
buffer_load_dwordx4 v2, s[8:11], s72 offen lds
v_mfma_f32_16x16x32_bf16 a[144:147], v[208:211], v[240:243], a[144:147]
v_mfma_f32_16x16x32_bf16 a[148:151], v[212:215], v[240:243], a[148:151]
v_mfma_f32_16x16x32_bf16 a[152:155], v[216:219], v[240:243], a[152:155]
s_add_u32 s72, s69, 39936
buffer_load_dwordx4 v3, s[8:11], s72 offen offset:1024 lds
v_mfma_f32_16x16x32_bf16 a[156:159], v[220:223], v[240:243], a[156:159]
v_mfma_f32_16x16x32_bf16 a[188:191], v[220:223], v[244:247], a[188:191]
v_mfma_f32_16x16x32_bf16 a[184:187], v[216:219], v[244:247], a[184:187]
v_mfma_f32_16x16x32_bf16 a[180:183], v[212:215], v[244:247], a[180:183]
v_mfma_f32_16x16x32_bf16 a[176:179], v[208:211], v[244:247], a[176:179]
s_add_u32 s72, s69, 47104
buffer_load_dwordx4 v2, s[8:11], s72 offen offset:2048 lds
v_mfma_f32_16x16x32_bf16 a[172:175], v[204:207], v[244:247], a[172:175]
v_mfma_f32_16x16x32_bf16 a[168:171], v[200:203], v[244:247], a[168:171]
v_mfma_f32_16x16x32_bf16 a[164:167], v[196:199], v[244:247], a[164:167]
v_mfma_f32_16x16x32_bf16 a[160:163], v[192:195], v[244:247], a[160:163]
s_add_u32 s72, s69, 54272
buffer_load_dwordx4 v3, s[8:11], s72 offen offset:3072 lds
v_mfma_f32_16x16x32_bf16 a[192:195], v[192:195], v[248:251], a[192:195]
v_mfma_f32_16x16x32_bf16 a[196:199], v[196:199], v[248:251], a[196:199]
v_mfma_f32_16x16x32_bf16 a[200:203], v[200:203], v[248:251], a[200:203]
v_mfma_f32_16x16x32_bf16 a[204:207], v[204:207], v[248:251], a[204:207]
s_add_u32 m0, s64, 16384
v_mfma_f32_16x16x32_bf16 a[208:211], v[208:211], v[248:251], a[208:211]
s_add_u32 s72, s71, 0
buffer_load_dwordx4 v6, s[20:23], s72 offen lds
v_mfma_f32_16x16x32_bf16 a[212:215], v[212:215], v[248:251], a[212:215]
v_mfma_f32_16x16x32_bf16 a[216:219], v[216:219], v[248:251], a[216:219]
v_mfma_f32_16x16x32_bf16 a[220:223], v[220:223], v[248:251], a[220:223]
v_mfma_f32_16x16x32_bf16 a[252:255], v[220:223], v[252:255], a[252:255]
s_add_u32 s72, s71, 31744
buffer_load_dwordx4 v6, s[20:23], s72 offen offset:1024 lds
v_mfma_f32_16x16x32_bf16 a[248:251], v[216:219], v[252:255], a[248:251]
v_mfma_f32_16x16x32_bf16 a[244:247], v[212:215], v[252:255], a[244:247]
v_mfma_f32_16x16x32_bf16 a[240:243], v[208:211], v[252:255], a[240:243]
v_mfma_f32_16x16x32_bf16 a[236:239], v[204:207], v[252:255], a[236:239]
s_add_u32 s72, s71, 63488
buffer_load_dwordx4 v7, s[20:23], s72 offen offset:2048 lds
v_mfma_f32_16x16x32_bf16 a[232:235], v[200:203], v[252:255], a[232:235]
v_mfma_f32_16x16x32_bf16 a[228:231], v[196:199], v[252:255], a[228:231]
v_mfma_f32_16x16x32_bf16 a[224:227], v[192:195], v[252:255], a[224:227]
s_waitcnt lgkmcnt(0)
v_mfma_f32_16x16x32_bf16 a[0:3], v[160:163], v[128:131], a[0:3]
s_add_u32 s72, s71, 95232
buffer_load_dwordx4 v7, s[20:23], s72 offen offset:3072 lds
v_mfma_f32_16x16x32_bf16 a[4:7], v[160:163], v[132:135], a[4:7]
buffer_load_dwordx4 v[108:111], v1, s[4:7], s76 offen
v_mfma_f32_16x16x32_bf16 a[8:11], v[160:163], v[136:139], a[8:11]
buffer_load_dwordx4 v[112:115], v1, s[4:7], s76 offen offset:1024
v_mfma_f32_16x16x32_bf16 a[12:15], v[160:163], v[140:143], a[12:15]
buffer_load_dwordx4 v[116:119], v1, s[4:7], s76 offen offset:2048
v_mfma_f32_16x16x32_bf16 a[16:19], v[160:163], v[144:147], a[16:19]
buffer_load_dwordx4 v[120:123], v1, s[4:7], s76 offen offset:3072
v_mfma_f32_16x16x32_bf16 a[20:23], v[160:163], v[148:151], a[20:23]
ds_read_b64_tr_b16 v[224:225], v20 offset:40960
v_mfma_f32_16x16x32_bf16 a[24:27], v[160:163], v[152:155], a[24:27]
v_mfma_f32_16x16x32_bf16 a[28:31], v[160:163], v[156:159], a[28:31]
ds_read_b64_tr_b16 v[226:227], v20 offset:41984
v_mfma_f32_16x16x32_bf16 a[60:63], v[164:167], v[156:159], a[60:63]
v_mfma_f32_16x16x32_bf16 a[56:59], v[164:167], v[152:155], a[56:59]
ds_read_b128 v[192:195], v25 offset:32768
v_mfma_f32_16x16x32_bf16 a[52:55], v[164:167], v[148:151], a[52:55]
v_mfma_f32_16x16x32_bf16 a[48:51], v[164:167], v[144:147], a[48:51]
ds_read_b128 v[196:199], v25 offset:34816
v_mfma_f32_16x16x32_bf16 a[44:47], v[164:167], v[140:143], a[44:47]
v_mfma_f32_16x16x32_bf16 a[40:43], v[164:167], v[136:139], a[40:43]
ds_read_b128 v[200:203], v25 offset:36864
v_mfma_f32_16x16x32_bf16 a[36:39], v[164:167], v[132:135], a[36:39]
v_mfma_f32_16x16x32_bf16 a[32:35], v[164:167], v[128:131], a[32:35]
ds_read_b128 v[204:207], v25 offset:38912
v_mfma_f32_16x16x32_bf16 a[64:67], v[168:171], v[128:131], a[64:67]
v_mfma_f32_16x16x32_bf16 a[68:71], v[168:171], v[132:135], a[68:71]
ds_read_b128 v[208:211], v25 offset:40960
v_mfma_f32_16x16x32_bf16 a[72:75], v[168:171], v[136:139], a[72:75]
v_mfma_f32_16x16x32_bf16 a[76:79], v[168:171], v[140:143], a[76:79]
ds_read_b128 v[212:215], v25 offset:43008
v_mfma_f32_16x16x32_bf16 a[80:83], v[168:171], v[144:147], a[80:83]
v_mfma_f32_16x16x32_bf16 a[84:87], v[168:171], v[148:151], a[84:87]
ds_read_b128 v[216:219], v25 offset:45056
v_mfma_f32_16x16x32_bf16 a[88:91], v[168:171], v[152:155], a[88:91]
v_mfma_f32_16x16x32_bf16 a[92:95], v[168:171], v[156:159], a[92:95]
ds_read_b128 v[220:223], v25 offset:47104
v_mfma_f32_16x16x32_bf16 a[124:127], v[172:175], v[156:159], a[124:127]
v_mfma_f32_16x16x32_bf16 a[120:123], v[172:175], v[152:155], a[120:123]
ds_read_b64_tr_b16 v[228:229], v21 offset:40960
v_mfma_f32_16x16x32_bf16 a[116:119], v[172:175], v[148:151], a[116:119]
v_mfma_f32_16x16x32_bf16 a[112:115], v[172:175], v[144:147], a[112:115]
ds_read_b64_tr_b16 v[230:231], v21 offset:41984
v_mfma_f32_16x16x32_bf16 a[108:111], v[172:175], v[140:143], a[108:111]
v_mfma_f32_16x16x32_bf16 a[104:107], v[172:175], v[136:139], a[104:107]
ds_read_b64_tr_b16 v[232:233], v22 offset:40960
v_mfma_f32_16x16x32_bf16 a[100:103], v[172:175], v[132:135], a[100:103]
v_mfma_f32_16x16x32_bf16 a[96:99], v[172:175], v[128:131], a[96:99]
ds_read_b64_tr_b16 v[234:235], v22 offset:41984
v_mfma_f32_16x16x32_bf16 a[128:131], v[128:131], v[176:179], a[128:131]
v_mfma_f32_16x16x32_bf16 a[132:135], v[132:135], v[176:179], a[132:135]
ds_read_b64_tr_b16 v[236:237], v23 offset:40960
v_mfma_f32_16x16x32_bf16 a[136:139], v[136:139], v[176:179], a[136:139]
v_mfma_f32_16x16x32_bf16 a[140:143], v[140:143], v[176:179], a[140:143]
ds_read_b64_tr_b16 v[238:239], v23 offset:41984
v_mfma_f32_16x16x32_bf16 a[144:147], v[144:147], v[176:179], a[144:147]
v_mfma_f32_16x16x32_bf16 a[148:151], v[148:151], v[176:179], a[148:151]
ds_read_b64_tr_b16 v[240:241], v20 offset:57344
v_mfma_f32_16x16x32_bf16 a[152:155], v[152:155], v[176:179], a[152:155]
v_mfma_f32_16x16x32_bf16 a[156:159], v[156:159], v[176:179], a[156:159]
ds_read_b64_tr_b16 v[242:243], v20 offset:58368
v_mfma_f32_16x16x32_bf16 a[188:191], v[156:159], v[180:183], a[188:191]
v_mfma_f32_16x16x32_bf16 a[184:187], v[152:155], v[180:183], a[184:187]
ds_read_b64_tr_b16 v[244:245], v21 offset:57344
v_mfma_f32_16x16x32_bf16 a[180:183], v[148:151], v[180:183], a[180:183]
v_mfma_f32_16x16x32_bf16 a[176:179], v[144:147], v[180:183], a[176:179]
ds_read_b64_tr_b16 v[246:247], v21 offset:58368
v_mfma_f32_16x16x32_bf16 a[172:175], v[140:143], v[180:183], a[172:175]
v_mfma_f32_16x16x32_bf16 a[168:171], v[136:139], v[180:183], a[168:171]
ds_read_b64_tr_b16 v[248:249], v22 offset:57344
v_mfma_f32_16x16x32_bf16 a[164:167], v[132:135], v[180:183], a[164:167]
v_mfma_f32_16x16x32_bf16 a[160:163], v[128:131], v[180:183], a[160:163]
ds_read_b64_tr_b16 v[250:251], v22 offset:58368
v_mfma_f32_16x16x32_bf16 a[192:195], v[128:131], v[184:187], a[192:195]
v_mfma_f32_16x16x32_bf16 a[196:199], v[132:135], v[184:187], a[196:199]
ds_read_b64_tr_b16 v[252:253], v23 offset:57344
v_mfma_f32_16x16x32_bf16 a[200:203], v[136:139], v[184:187], a[200:203]
v_mfma_f32_16x16x32_bf16 a[204:207], v[140:143], v[184:187], a[204:207]
ds_read_b64_tr_b16 v[254:255], v23 offset:58368
v_mfma_f32_16x16x32_bf16 a[208:211], v[144:147], v[184:187], a[208:211]
v_mfma_f32_16x16x32_bf16 a[212:215], v[148:151], v[184:187], a[212:215]
v_mfma_f32_16x16x32_bf16 a[216:219], v[152:155], v[184:187], a[216:219]
v_mfma_f32_16x16x32_bf16 a[220:223], v[156:159], v[184:187], a[220:223]
v_mfma_f32_16x16x32_bf16 a[252:255], v[156:159], v[188:191], a[252:255]
v_mfma_f32_16x16x32_bf16 a[248:251], v[152:155], v[188:191], a[248:251]
v_mfma_f32_16x16x32_bf16 a[244:247], v[148:151], v[188:191], a[244:247]
v_mfma_f32_16x16x32_bf16 a[240:243], v[144:147], v[188:191], a[240:243]
v_mfma_f32_16x16x32_bf16 a[236:239], v[140:143], v[188:191], a[236:239]
v_mfma_f32_16x16x32_bf16 a[232:235], v[136:139], v[188:191], a[232:235]
v_mfma_f32_16x16x32_bf16 a[228:231], v[132:135], v[188:191], a[228:231]
s_waitcnt vmcnt(4) lgkmcnt(0)
v_mfma_f32_16x16x32_bf16 a[224:227], v[128:131], v[188:191], a[224:227]
s_barrier
v_mfma_f32_16x16x32_bf16 a[0:3], v[224:227], v[192:195], a[0:3]
s_add_u32 s73, s61, 5
ds_read_b64_tr_b16 v[160:161], v20 offset:0
v_mfma_f32_16x16x32_bf16 a[4:7], v[224:227], v[196:199], a[4:7]
s_and_b32 s73, s73, 7
ds_read_b64_tr_b16 v[162:163], v20 offset:1024
v_mfma_f32_16x16x32_bf16 a[8:11], v[224:227], v[200:203], a[8:11]
s_lshl_b32 s69, s73, 7
ds_read_b128 v[128:131], v24 offset:0
v_mfma_f32_16x16x32_bf16 a[12:15], v[224:227], v[204:207], a[12:15]
s_add_u32 s69, s69, s67
ds_read_b128 v[132:135], v24 offset:2048
v_mfma_f32_16x16x32_bf16 a[16:19], v[224:227], v[208:211], a[16:19]
s_lshl_b32 s71, s73, 19
ds_read_b128 v[136:139], v24 offset:4096
v_mfma_f32_16x16x32_bf16 a[20:23], v[224:227], v[212:215], a[20:23]
s_add_u32 s71, s71, s66
ds_read_b128 v[140:143], v24 offset:6144
v_mfma_f32_16x16x32_bf16 a[24:27], v[224:227], v[216:219], a[24:27]
s_add_u32 m0, s63, 98304
ds_read_b128 v[144:147], v24 offset:8192
v_mfma_f32_16x16x32_bf16 a[28:31], v[224:227], v[220:223], a[28:31]
s_add_u32 s72, s69, 0
buffer_load_dwordx4 v2, s[8:11], s72 offen lds
v_mfma_f32_16x16x32_bf16 a[60:63], v[228:231], v[220:223], a[60:63]
s_add_u32 s72, s69, 7168
buffer_load_dwordx4 v3, s[8:11], s72 offen offset:1024 lds
v_mfma_f32_16x16x32_bf16 a[56:59], v[228:231], v[216:219], a[56:59]
s_add_u32 s72, s69, 14336
buffer_load_dwordx4 v2, s[8:11], s72 offen offset:2048 lds
v_mfma_f32_16x16x32_bf16 a[52:55], v[228:231], v[212:215], a[52:55]
s_waitcnt vmcnt(23)
ds_read_b128 v[148:151], v24 offset:10240
v_lshlrev_b32 v72, 16, v68
v_mfma_f32_16x16x32_bf16 a[48:51], v[228:231], v[208:211], a[48:51]
ds_read_b128 v[152:155], v24 offset:12288
v_and_b32 v73, 0xffff0000, v68
v_mfma_f32_16x16x32_bf16 a[44:47], v[228:231], v[204:207], a[44:47]
s_add_u32 s72, s69, 21504
buffer_load_dwordx4 v3, s[8:11], s72 offen offset:3072 lds
v_mfma_f32_16x16x32_bf16 a[40:43], v[228:231], v[200:203], a[40:43]
ds_read_b128 v[156:159], v24 offset:14336
v_lshlrev_b32 v74, 16, v69
v_mfma_f32_16x16x32_bf16 a[36:39], v[228:231], v[196:199], a[36:39]
ds_read_b64_tr_b16 v[164:165], v21 offset:0
v_and_b32 v75, 0xffff0000, v69
v_mfma_f32_16x16x32_bf16 a[32:35], v[228:231], v[192:195], a[32:35]
ds_read_b64_tr_b16 v[166:167], v21 offset:1024
v_lshlrev_b32 v76, 16, v32
v_mfma_f32_16x16x32_bf16 a[64:67], v[232:235], v[192:195], a[64:67]
ds_read_b64_tr_b16 v[168:169], v22 offset:0
v_lshlrev_b32 v77, 16, v33
v_mfma_f32_16x16x32_bf16 a[68:71], v[232:235], v[196:199], a[68:71]
s_add_u32 m0, s64, 32768
ds_read_b64_tr_b16 v[170:171], v22 offset:1024
v_lshlrev_b32 v78, 16, v34
v_mfma_f32_16x16x32_bf16 a[72:75], v[232:235], v[200:203], a[72:75]
s_add_u32 s72, s71, 0
buffer_load_dwordx4 v6, s[16:19], s72 offen lds
v_mfma_f32_16x16x32_bf16 a[76:79], v[232:235], v[204:207], a[76:79]
ds_read_b64_tr_b16 v[172:173], v23 offset:0
v_lshlrev_b32 v79, 16, v35
v_mfma_f32_16x16x32_bf16 a[80:83], v[232:235], v[208:211], a[80:83]
ds_read_b64_tr_b16 v[174:175], v23 offset:1024
v_lshlrev_b32 v80, 16, v36
v_mfma_f32_16x16x32_bf16 a[84:87], v[232:235], v[212:215], a[84:87]
s_add_u32 s72, s71, 31744
buffer_load_dwordx4 v6, s[16:19], s72 offen offset:1024 lds
v_mfma_f32_16x16x32_bf16 a[88:91], v[232:235], v[216:219], a[88:91]
ds_read_b64_tr_b16 v[176:177], v20 offset:16384
v_lshlrev_b32 v81, 16, v37
v_mfma_f32_16x16x32_bf16 a[92:95], v[232:235], v[220:223], a[92:95]
ds_read_b64_tr_b16 v[178:179], v20 offset:17408
v_lshlrev_b32 v82, 16, v38
v_mfma_f32_16x16x32_bf16 a[124:127], v[236:239], v[220:223], a[124:127]
ds_read_b64_tr_b16 v[180:181], v21 offset:16384
v_lshlrev_b32 v83, 16, v39
v_mfma_f32_16x16x32_bf16 a[120:123], v[236:239], v[216:219], a[120:123]
s_add_u32 s72, s71, 63488
buffer_load_dwordx4 v7, s[16:19], s72 offen offset:2048 lds
v_mfma_f32_16x16x32_bf16 a[116:119], v[236:239], v[212:215], a[116:119]
ds_read_b64_tr_b16 v[182:183], v21 offset:17408
v_lshlrev_b32 v84, 16, v40
v_mfma_f32_16x16x32_bf16 a[112:115], v[236:239], v[208:211], a[112:115]
ds_read_b64_tr_b16 v[184:185], v22 offset:16384
v_lshlrev_b32 v85, 16, v41
v_mfma_f32_16x16x32_bf16 a[108:111], v[236:239], v[204:207], a[108:111]
ds_read_b64_tr_b16 v[186:187], v22 offset:17408
v_lshlrev_b32 v86, 16, v42
v_mfma_f32_16x16x32_bf16 a[104:107], v[236:239], v[200:203], a[104:107]
ds_read_b64_tr_b16 v[188:189], v23 offset:16384
v_lshlrev_b32 v87, 16, v43
v_mfma_f32_16x16x32_bf16 a[100:103], v[236:239], v[196:199], a[100:103]
s_add_u32 s72, s71, 95232
buffer_load_dwordx4 v7, s[16:19], s72 offen offset:3072 lds
v_mfma_f32_16x16x32_bf16 a[96:99], v[236:239], v[192:195], a[96:99]
ds_read_b64_tr_b16 v[190:191], v23 offset:17408
v_lshlrev_b32 v88, 16, v44
v_mfma_f32_16x16x32_bf16 a[128:131], v[192:195], v[240:243], a[128:131]
v_lshlrev_b32 v89, 16, v45
v_lshlrev_b32 v90, 16, v46
v_mfma_f32_16x16x32_bf16 a[132:135], v[196:199], v[240:243], a[132:135]
v_lshlrev_b32 v91, 16, v47
v_lshlrev_b32 v92, 16, v48
v_mfma_f32_16x16x32_bf16 a[136:139], v[200:203], v[240:243], a[136:139]
s_add_u32 m0, s63, 102400
v_lshlrev_b32 v93, 16, v49
v_lshlrev_b32 v94, 16, v50
v_mfma_f32_16x16x32_bf16 a[140:143], v[204:207], v[240:243], a[140:143]
s_add_u32 s72, s69, 32768
buffer_load_dwordx4 v2, s[8:11], s72 offen lds
v_mfma_f32_16x16x32_bf16 a[144:147], v[208:211], v[240:243], a[144:147]
v_mul_f32 v95, v75, v91
v_lshlrev_b32 v97, 16, v66
v_mfma_f32_16x16x32_bf16 a[148:151], v[212:215], v[240:243], a[148:151]
v_fmac_f32 v95, v74, v92
v_fmac_f32 v95, v73, v93
v_mfma_f32_16x16x32_bf16 a[152:155], v[216:219], v[240:243], a[152:155]
s_add_u32 s72, s69, 39936
buffer_load_dwordx4 v3, s[8:11], s72 offen offset:1024 lds
v_mfma_f32_16x16x32_bf16 a[156:159], v[220:223], v[240:243], a[156:159]
v_fmac_f32 v95, v72, v94
v_mul_f32 v95, v95, v97
v_mfma_f32_16x16x32_bf16 a[188:191], v[220:223], v[244:247], a[188:191]
v_mul_f32 v96, v75, v90
v_lshlrev_b32 v97, 16, v65
v_mfma_f32_16x16x32_bf16 a[184:187], v[216:219], v[244:247], a[184:187]
v_fmac_f32 v96, v74, v91
v_fmac_f32 v96, v73, v92
v_mfma_f32_16x16x32_bf16 a[180:183], v[212:215], v[244:247], a[180:183]
v_fmac_f32 v96, v72, v93
v_mul_f32 v96, v96, v97
v_mfma_f32_16x16x32_bf16 a[176:179], v[208:211], v[244:247], a[176:179]
s_add_u32 s72, s69, 47104
buffer_load_dwordx4 v2, s[8:11], s72 offen offset:2048 lds
v_mfma_f32_16x16x32_bf16 a[172:175], v[204:207], v[244:247], a[172:175]
v_cvt_pk_bf16_f32 v100, v95, v96
v_mul_f32 v95, v75, v89
v_mfma_f32_16x16x32_bf16 a[168:171], v[200:203], v[244:247], a[168:171]
v_lshlrev_b32 v97, 16, v64
v_fmac_f32 v95, v74, v90
v_mfma_f32_16x16x32_bf16 a[164:167], v[196:199], v[244:247], a[164:167]
v_fmac_f32 v95, v73, v91
v_fmac_f32 v95, v72, v92
v_mfma_f32_16x16x32_bf16 a[160:163], v[192:195], v[244:247], a[160:163]
s_add_u32 s72, s69, 54272
buffer_load_dwordx4 v3, s[8:11], s72 offen offset:3072 lds
v_mfma_f32_16x16x32_bf16 a[192:195], v[192:195], v[248:251], a[192:195]
v_mul_f32 v95, v95, v97
v_mul_f32 v96, v75, v88
v_mfma_f32_16x16x32_bf16 a[196:199], v[196:199], v[248:251], a[196:199]
v_lshlrev_b32 v97, 16, v63
v_fmac_f32 v96, v74, v89
v_mfma_f32_16x16x32_bf16 a[200:203], v[200:203], v[248:251], a[200:203]
v_fmac_f32 v96, v73, v90
v_fmac_f32 v96, v72, v91
v_mfma_f32_16x16x32_bf16 a[204:207], v[204:207], v[248:251], a[204:207]
s_add_u32 m0, s64, 49152
v_mul_f32 v96, v96, v97
v_cvt_pk_bf16_f32 v101, v95, v96
v_mfma_f32_16x16x32_bf16 a[208:211], v[208:211], v[248:251], a[208:211]
s_add_u32 s72, s71, 0
buffer_load_dwordx4 v6, s[20:23], s72 offen lds
v_mfma_f32_16x16x32_bf16 a[212:215], v[212:215], v[248:251], a[212:215]
v_mul_f32 v95, v75, v87
v_lshlrev_b32 v97, 16, v62
v_mfma_f32_16x16x32_bf16 a[216:219], v[216:219], v[248:251], a[216:219]
v_fmac_f32 v95, v74, v88
v_fmac_f32 v95, v73, v89
v_mfma_f32_16x16x32_bf16 a[220:223], v[220:223], v[248:251], a[220:223]
v_fmac_f32 v95, v72, v90
v_mul_f32 v95, v95, v97
v_mfma_f32_16x16x32_bf16 a[252:255], v[220:223], v[252:255], a[252:255]
s_add_u32 s72, s71, 31744
buffer_load_dwordx4 v6, s[20:23], s72 offen offset:1024 lds
v_mfma_f32_16x16x32_bf16 a[248:251], v[216:219], v[252:255], a[248:251]
v_mul_f32 v96, v75, v86
v_lshlrev_b32 v97, 16, v61
v_mfma_f32_16x16x32_bf16 a[244:247], v[212:215], v[252:255], a[244:247]
v_fmac_f32 v96, v74, v87
v_fmac_f32 v96, v73, v88
v_mfma_f32_16x16x32_bf16 a[240:243], v[208:211], v[252:255], a[240:243]
v_fmac_f32 v96, v72, v89
v_mul_f32 v96, v96, v97
v_mfma_f32_16x16x32_bf16 a[236:239], v[204:207], v[252:255], a[236:239]
s_add_u32 s72, s71, 63488
buffer_load_dwordx4 v7, s[20:23], s72 offen offset:2048 lds
v_mfma_f32_16x16x32_bf16 a[232:235], v[200:203], v[252:255], a[232:235]
v_cvt_pk_bf16_f32 v102, v95, v96
v_mul_f32 v95, v75, v85
v_mfma_f32_16x16x32_bf16 a[228:231], v[196:199], v[252:255], a[228:231]
v_lshlrev_b32 v97, 16, v60
v_fmac_f32 v95, v74, v86
v_mfma_f32_16x16x32_bf16 a[224:227], v[192:195], v[252:255], a[224:227]
s_waitcnt lgkmcnt(0)
v_fmac_f32 v95, v73, v87
v_fmac_f32 v95, v72, v88
v_mfma_f32_16x16x32_bf16 a[0:3], v[160:163], v[128:131], a[0:3]
s_add_u32 s72, s71, 95232
buffer_load_dwordx4 v7, s[20:23], s72 offen offset:3072 lds
v_mfma_f32_16x16x32_bf16 a[4:7], v[160:163], v[132:135], a[4:7]
s_mov_b32 s80, 0x0
buffer_load_dword v126, v125, s[12:15], s80 offen
v_mfma_f32_16x16x32_bf16 a[8:11], v[160:163], v[136:139], a[8:11]
s_mov_b32 s80, 0x100000
buffer_load_dword v126, v125, s[12:15], s80 offen
v_mfma_f32_16x16x32_bf16 a[12:15], v[160:163], v[140:143], a[12:15]
s_mov_b32 s80, 0x200000
buffer_load_dword v126, v125, s[12:15], s80 offen
v_mfma_f32_16x16x32_bf16 a[16:19], v[160:163], v[144:147], a[16:19]
s_mov_b32 s80, 0x300000
buffer_load_dword v126, v125, s[12:15], s80 offen
v_mfma_f32_16x16x32_bf16 a[20:23], v[160:163], v[148:151], a[20:23]
ds_read_b64_tr_b16 v[224:225], v20 offset:8192
v_mul_f32 v95, v95, v97
v_mfma_f32_16x16x32_bf16 a[24:27], v[160:163], v[152:155], a[24:27]
v_mul_f32 v96, v75, v84
v_lshlrev_b32 v97, 16, v59
v_mfma_f32_16x16x32_bf16 a[28:31], v[160:163], v[156:159], a[28:31]
ds_read_b64_tr_b16 v[226:227], v20 offset:9216
v_fmac_f32 v96, v74, v85
v_mfma_f32_16x16x32_bf16 a[60:63], v[164:167], v[156:159], a[60:63]
v_fmac_f32 v96, v73, v86
v_fmac_f32 v96, v72, v87
v_mfma_f32_16x16x32_bf16 a[56:59], v[164:167], v[152:155], a[56:59]
ds_read_b128 v[192:195], v25 offset:0
v_mul_f32 v96, v96, v97
v_mfma_f32_16x16x32_bf16 a[52:55], v[164:167], v[148:151], a[52:55]
v_cvt_pk_bf16_f32 v103, v95, v96
v_mfma_f32_16x16x32_bf16 a[48:51], v[164:167], v[144:147], a[48:51]
ds_read_b128 v[196:199], v25 offset:2048
ds_write_b128 v28, v[100:103] offset:0
v_mfma_f32_16x16x32_bf16 a[44:47], v[164:167], v[140:143], a[44:47]
v_mul_f32 v95, v75, v83
v_lshlrev_b32 v97, 16, v58
v_mfma_f32_16x16x32_bf16 a[40:43], v[164:167], v[136:139], a[40:43]
ds_read_b128 v[200:203], v25 offset:4096
v_fmac_f32 v95, v74, v84
v_mfma_f32_16x16x32_bf16 a[36:39], v[164:167], v[132:135], a[36:39]
v_fmac_f32 v95, v73, v85
v_fmac_f32 v95, v72, v86
v_mfma_f32_16x16x32_bf16 a[32:35], v[164:167], v[128:131], a[32:35]
ds_read_b128 v[204:207], v25 offset:6144
v_mul_f32 v95, v95, v97
v_mfma_f32_16x16x32_bf16 a[64:67], v[168:171], v[128:131], a[64:67]
v_mul_f32 v96, v75, v82
v_lshlrev_b32 v97, 16, v57
v_mfma_f32_16x16x32_bf16 a[68:71], v[168:171], v[132:135], a[68:71]
ds_read_b128 v[208:211], v25 offset:8192
v_fmac_f32 v96, v74, v83
v_mfma_f32_16x16x32_bf16 a[72:75], v[168:171], v[136:139], a[72:75]
v_fmac_f32 v96, v73, v84
v_fmac_f32 v96, v72, v85
v_mfma_f32_16x16x32_bf16 a[76:79], v[168:171], v[140:143], a[76:79]
ds_read_b128 v[212:215], v25 offset:10240
v_mul_f32 v96, v96, v97
v_mfma_f32_16x16x32_bf16 a[80:83], v[168:171], v[144:147], a[80:83]
v_cvt_pk_bf16_f32 v104, v95, v96
v_mul_f32 v95, v75, v81
v_mfma_f32_16x16x32_bf16 a[84:87], v[168:171], v[148:151], a[84:87]
ds_read_b128 v[216:219], v25 offset:12288
v_lshlrev_b32 v97, 16, v56
v_mfma_f32_16x16x32_bf16 a[88:91], v[168:171], v[152:155], a[88:91]
v_fmac_f32 v95, v74, v82
v_fmac_f32 v95, v73, v83
v_mfma_f32_16x16x32_bf16 a[92:95], v[168:171], v[156:159], a[92:95]
ds_read_b128 v[220:223], v25 offset:14336
v_fmac_f32 v95, v72, v84
v_mfma_f32_16x16x32_bf16 a[124:127], v[172:175], v[156:159], a[124:127]
v_mul_f32 v95, v95, v97
v_mul_f32 v96, v75, v80
v_mfma_f32_16x16x32_bf16 a[120:123], v[172:175], v[152:155], a[120:123]
ds_read_b64_tr_b16 v[228:229], v21 offset:8192
v_lshlrev_b32 v97, 16, v55
v_mfma_f32_16x16x32_bf16 a[116:119], v[172:175], v[148:151], a[116:119]
v_fmac_f32 v96, v74, v81
v_fmac_f32 v96, v73, v82
v_mfma_f32_16x16x32_bf16 a[112:115], v[172:175], v[144:147], a[112:115]
ds_read_b64_tr_b16 v[230:231], v21 offset:9216
v_fmac_f32 v96, v72, v83
v_mfma_f32_16x16x32_bf16 a[108:111], v[172:175], v[140:143], a[108:111]
v_mul_f32 v96, v96, v97
v_cvt_pk_bf16_f32 v105, v95, v96
v_mfma_f32_16x16x32_bf16 a[104:107], v[172:175], v[136:139], a[104:107]
ds_read_b64_tr_b16 v[232:233], v22 offset:8192
v_mul_f32 v95, v75, v79
v_mfma_f32_16x16x32_bf16 a[100:103], v[172:175], v[132:135], a[100:103]
v_lshlrev_b32 v97, 16, v54
v_fmac_f32 v95, v74, v80
v_mfma_f32_16x16x32_bf16 a[96:99], v[172:175], v[128:131], a[96:99]
ds_read_b64_tr_b16 v[234:235], v22 offset:9216
v_fmac_f32 v95, v73, v81
v_mfma_f32_16x16x32_bf16 a[128:131], v[128:131], v[176:179], a[128:131]
v_fmac_f32 v95, v72, v82
v_mul_f32 v95, v95, v97
v_mfma_f32_16x16x32_bf16 a[132:135], v[132:135], v[176:179], a[132:135]
ds_read_b64_tr_b16 v[236:237], v23 offset:8192
v_mul_f32 v96, v75, v78
v_mfma_f32_16x16x32_bf16 a[136:139], v[136:139], v[176:179], a[136:139]
v_lshlrev_b32 v97, 16, v53
v_fmac_f32 v96, v74, v79
v_mfma_f32_16x16x32_bf16 a[140:143], v[140:143], v[176:179], a[140:143]
ds_read_b64_tr_b16 v[238:239], v23 offset:9216
v_fmac_f32 v96, v73, v80
v_mfma_f32_16x16x32_bf16 a[144:147], v[144:147], v[176:179], a[144:147]
v_fmac_f32 v96, v72, v81
v_mul_f32 v96, v96, v97
v_mfma_f32_16x16x32_bf16 a[148:151], v[148:151], v[176:179], a[148:151]
ds_read_b64_tr_b16 v[240:241], v20 offset:24576
v_cvt_pk_bf16_f32 v106, v95, v96
v_mfma_f32_16x16x32_bf16 a[152:155], v[152:155], v[176:179], a[152:155]
v_mul_f32 v95, v75, v77
v_lshlrev_b32 v97, 16, v52
v_mfma_f32_16x16x32_bf16 a[156:159], v[156:159], v[176:179], a[156:159]
ds_read_b64_tr_b16 v[242:243], v20 offset:25600
v_fmac_f32 v95, v74, v78
v_mfma_f32_16x16x32_bf16 a[188:191], v[156:159], v[180:183], a[188:191]
v_fmac_f32 v95, v73, v79
v_fmac_f32 v95, v72, v80
v_mfma_f32_16x16x32_bf16 a[184:187], v[152:155], v[180:183], a[184:187]
ds_read_b64_tr_b16 v[244:245], v21 offset:24576
v_mul_f32 v95, v95, v97
v_mfma_f32_16x16x32_bf16 a[180:183], v[148:151], v[180:183], a[180:183]
v_mul_f32 v96, v75, v76
v_lshlrev_b32 v97, 16, v51
v_mfma_f32_16x16x32_bf16 a[176:179], v[144:147], v[180:183], a[176:179]
ds_read_b64_tr_b16 v[246:247], v21 offset:25600
v_fmac_f32 v96, v74, v77
v_mfma_f32_16x16x32_bf16 a[172:175], v[140:143], v[180:183], a[172:175]
v_fmac_f32 v96, v73, v78
v_fmac_f32 v96, v72, v79
v_mfma_f32_16x16x32_bf16 a[168:171], v[136:139], v[180:183], a[168:171]
ds_read_b64_tr_b16 v[248:249], v22 offset:24576
v_mul_f32 v96, v96, v97
v_mfma_f32_16x16x32_bf16 a[164:167], v[132:135], v[180:183], a[164:167]
v_cvt_pk_bf16_f32 v107, v95, v96
v_mfma_f32_16x16x32_bf16 a[160:163], v[128:131], v[180:183], a[160:163]
ds_read_b64_tr_b16 v[250:251], v22 offset:25600
ds_write_b128 v28, v[104:107] offset:16
v_mfma_f32_16x16x32_bf16 a[192:195], v[128:131], v[184:187], a[192:195]
global_load_dwordx4 v[84:87], v1, s[56:57]
v_mfma_f32_16x16x32_bf16 a[196:199], v[132:135], v[184:187], a[196:199]
ds_read_b64_tr_b16 v[252:253], v23 offset:24576
v_mfma_f32_16x16x32_bf16 a[200:203], v[136:139], v[184:187], a[200:203]
global_load_dwordx4 v[88:91], v1, s[56:57] offset:1024
v_mfma_f32_16x16x32_bf16 a[204:207], v[140:143], v[184:187], a[204:207]
ds_read_b64_tr_b16 v[254:255], v23 offset:25600
v_lshlrev_b32 v72, 16, v70
v_mfma_f32_16x16x32_bf16 a[208:211], v[144:147], v[184:187], a[208:211]
v_and_b32 v73, 0xffff0000, v70
v_lshlrev_b32 v74, 16, v71
v_mfma_f32_16x16x32_bf16 a[212:215], v[148:151], v[184:187], a[212:215]
v_and_b32 v75, 0xffff0000, v71
v_and_b32 v32, 0xffff0000, v32
v_mfma_f32_16x16x32_bf16 a[216:219], v[152:155], v[184:187], a[216:219]
v_and_b32 v33, 0xffff0000, v33
v_and_b32 v34, 0xffff0000, v34
v_mfma_f32_16x16x32_bf16 a[220:223], v[156:159], v[184:187], a[220:223]
v_and_b32 v35, 0xffff0000, v35
v_and_b32 v36, 0xffff0000, v36
v_mfma_f32_16x16x32_bf16 a[252:255], v[156:159], v[188:191], a[252:255]
v_and_b32 v37, 0xffff0000, v37
v_and_b32 v38, 0xffff0000, v38
v_mfma_f32_16x16x32_bf16 a[248:251], v[152:155], v[188:191], a[248:251]
v_and_b32 v39, 0xffff0000, v39
v_and_b32 v40, 0xffff0000, v40
v_mfma_f32_16x16x32_bf16 a[244:247], v[148:151], v[188:191], a[244:247]
v_and_b32 v41, 0xffff0000, v41
v_and_b32 v42, 0xffff0000, v42
v_mfma_f32_16x16x32_bf16 a[240:243], v[144:147], v[188:191], a[240:243]
v_and_b32 v43, 0xffff0000, v43
v_and_b32 v44, 0xffff0000, v44
v_mfma_f32_16x16x32_bf16 a[236:239], v[140:143], v[188:191], a[236:239]
v_and_b32 v45, 0xffff0000, v45
v_and_b32 v46, 0xffff0000, v46
v_mfma_f32_16x16x32_bf16 a[232:235], v[136:139], v[188:191], a[232:235]
v_and_b32 v47, 0xffff0000, v47
v_and_b32 v48, 0xffff0000, v48
v_mfma_f32_16x16x32_bf16 a[228:231], v[132:135], v[188:191], a[228:231]
s_waitcnt vmcnt(6) lgkmcnt(0)
v_and_b32 v49, 0xffff0000, v49
v_and_b32 v50, 0xffff0000, v50
v_mfma_f32_16x16x32_bf16 a[224:227], v[128:131], v[188:191], a[224:227]
s_barrier
v_mul_f32 v95, v75, v47
v_and_b32 v97, 0xffff0000, v66
v_mfma_f32_16x16x32_bf16 a[0:3], v[224:227], v[192:195], a[0:3]
s_add_u32 s73, s61, 6
ds_read_b64_tr_b16 v[160:161], v20 offset:32768
v_fmac_f32 v95, v74, v48
v_mfma_f32_16x16x32_bf16 a[4:7], v[224:227], v[196:199], a[4:7]
s_and_b32 s73, s73, 7
ds_read_b64_tr_b16 v[162:163], v20 offset:33792
v_fmac_f32 v95, v73, v49
v_mfma_f32_16x16x32_bf16 a[8:11], v[224:227], v[200:203], a[8:11]
s_lshl_b32 s69, s73, 7
ds_read_b128 v[128:131], v24 offset:32768
v_fmac_f32 v95, v72, v50
v_mfma_f32_16x16x32_bf16 a[12:15], v[224:227], v[204:207], a[12:15]
s_add_u32 s69, s69, s67
ds_read_b128 v[132:135], v24 offset:34816
v_mul_f32 v95, v95, v97
v_mfma_f32_16x16x32_bf16 a[16:19], v[224:227], v[208:211], a[16:19]
s_lshl_b32 s71, s73, 19
ds_read_b128 v[136:139], v24 offset:36864
v_mul_f32 v96, v75, v46
v_mfma_f32_16x16x32_bf16 a[20:23], v[224:227], v[212:215], a[20:23]
s_add_u32 s71, s71, s66
ds_read_b128 v[140:143], v24 offset:38912
v_and_b32 v97, 0xffff0000, v65
v_mfma_f32_16x16x32_bf16 a[24:27], v[224:227], v[216:219], a[24:27]
s_add_u32 m0, s63, 65536
ds_read_b128 v[144:147], v24 offset:40960
v_fmac_f32 v96, v74, v47
v_mfma_f32_16x16x32_bf16 a[28:31], v[224:227], v[220:223], a[28:31]
s_add_u32 s72, s69, 0
buffer_load_dwordx4 v2, s[8:11], s72 offen lds
v_mfma_f32_16x16x32_bf16 a[60:63], v[228:231], v[220:223], a[60:63]
s_add_u32 s72, s69, 7168
buffer_load_dwordx4 v3, s[8:11], s72 offen offset:1024 lds
v_mfma_f32_16x16x32_bf16 a[56:59], v[228:231], v[216:219], a[56:59]
s_add_u32 s72, s69, 14336
buffer_load_dwordx4 v2, s[8:11], s72 offen offset:2048 lds
v_mfma_f32_16x16x32_bf16 a[52:55], v[228:231], v[212:215], a[52:55]
ds_read_b128 v[148:151], v24 offset:43008
v_fmac_f32 v96, v73, v48
v_mfma_f32_16x16x32_bf16 a[48:51], v[228:231], v[208:211], a[48:51]
ds_read_b128 v[152:155], v24 offset:45056
v_fmac_f32 v96, v72, v49
v_mfma_f32_16x16x32_bf16 a[44:47], v[228:231], v[204:207], a[44:47]
s_add_u32 s72, s69, 21504
buffer_load_dwordx4 v3, s[8:11], s72 offen offset:3072 lds
v_mfma_f32_16x16x32_bf16 a[40:43], v[228:231], v[200:203], a[40:43]
ds_read_b128 v[156:159], v24 offset:47104
v_mul_f32 v96, v96, v97
v_mfma_f32_16x16x32_bf16 a[36:39], v[228:231], v[196:199], a[36:39]
ds_read_b64_tr_b16 v[164:165], v21 offset:32768
v_cvt_pk_bf16_f32 v100, v95, v96
v_mfma_f32_16x16x32_bf16 a[32:35], v[228:231], v[192:195], a[32:35]
ds_read_b64_tr_b16 v[166:167], v21 offset:33792
v_mul_f32 v95, v75, v45
v_mfma_f32_16x16x32_bf16 a[64:67], v[232:235], v[192:195], a[64:67]
ds_read_b64_tr_b16 v[168:169], v22 offset:32768
v_and_b32 v97, 0xffff0000, v64
v_mfma_f32_16x16x32_bf16 a[68:71], v[232:235], v[196:199], a[68:71]
s_add_u32 m0, s64, 0
ds_read_b64_tr_b16 v[170:171], v22 offset:33792
v_fmac_f32 v95, v74, v46
v_mfma_f32_16x16x32_bf16 a[72:75], v[232:235], v[200:203], a[72:75]
s_add_u32 s72, s71, 0
buffer_load_dwordx4 v6, s[16:19], s72 offen lds
v_mfma_f32_16x16x32_bf16 a[76:79], v[232:235], v[204:207], a[76:79]
ds_read_b64_tr_b16 v[172:173], v23 offset:32768
v_fmac_f32 v95, v73, v47
v_mfma_f32_16x16x32_bf16 a[80:83], v[232:235], v[208:211], a[80:83]
ds_read_b64_tr_b16 v[174:175], v23 offset:33792
v_fmac_f32 v95, v72, v48
v_mfma_f32_16x16x32_bf16 a[84:87], v[232:235], v[212:215], a[84:87]
s_add_u32 s72, s71, 31744
buffer_load_dwordx4 v6, s[16:19], s72 offen offset:1024 lds
v_mfma_f32_16x16x32_bf16 a[88:91], v[232:235], v[216:219], a[88:91]
ds_read_b64_tr_b16 v[176:177], v20 offset:49152
v_mul_f32 v95, v95, v97
v_mfma_f32_16x16x32_bf16 a[92:95], v[232:235], v[220:223], a[92:95]
ds_read_b64_tr_b16 v[178:179], v20 offset:50176
v_mul_f32 v96, v75, v44
v_mfma_f32_16x16x32_bf16 a[124:127], v[236:239], v[220:223], a[124:127]
ds_read_b64_tr_b16 v[180:181], v21 offset:49152
v_and_b32 v97, 0xffff0000, v63
v_mfma_f32_16x16x32_bf16 a[120:123], v[236:239], v[216:219], a[120:123]
s_add_u32 s72, s71, 63488
buffer_load_dwordx4 v7, s[16:19], s72 offen offset:2048 lds
v_mfma_f32_16x16x32_bf16 a[116:119], v[236:239], v[212:215], a[116:119]
ds_read_b64_tr_b16 v[182:183], v21 offset:50176
v_fmac_f32 v96, v74, v45
v_mfma_f32_16x16x32_bf16 a[112:115], v[236:239], v[208:211], a[112:115]
ds_read_b64_tr_b16 v[184:185], v22 offset:49152
v_fmac_f32 v96, v73, v46
v_mfma_f32_16x16x32_bf16 a[108:111], v[236:239], v[204:207], a[108:111]
ds_read_b64_tr_b16 v[186:187], v22 offset:50176
v_fmac_f32 v96, v72, v47
v_mfma_f32_16x16x32_bf16 a[104:107], v[236:239], v[200:203], a[104:107]
ds_read_b64_tr_b16 v[188:189], v23 offset:49152
v_mul_f32 v96, v96, v97
v_mfma_f32_16x16x32_bf16 a[100:103], v[236:239], v[196:199], a[100:103]
s_add_u32 s72, s71, 95232
buffer_load_dwordx4 v7, s[16:19], s72 offen offset:3072 lds
v_mfma_f32_16x16x32_bf16 a[96:99], v[236:239], v[192:195], a[96:99]
ds_read_b64_tr_b16 v[190:191], v23 offset:50176
v_cvt_pk_bf16_f32 v101, v95, v96
v_mfma_f32_16x16x32_bf16 a[128:131], v[192:195], v[240:243], a[128:131]
v_mul_f32 v95, v75, v43
v_and_b32 v97, 0xffff0000, v62
v_mfma_f32_16x16x32_bf16 a[132:135], v[196:199], v[240:243], a[132:135]
v_fmac_f32 v95, v74, v44
v_fmac_f32 v95, v73, v45
v_mfma_f32_16x16x32_bf16 a[136:139], v[200:203], v[240:243], a[136:139]
s_add_u32 m0, s63, 69632
v_fmac_f32 v95, v72, v46
v_mul_f32 v95, v95, v97
v_mfma_f32_16x16x32_bf16 a[140:143], v[204:207], v[240:243], a[140:143]
s_add_u32 s72, s69, 32768
buffer_load_dwordx4 v2, s[8:11], s72 offen lds
v_mfma_f32_16x16x32_bf16 a[144:147], v[208:211], v[240:243], a[144:147]
v_mul_f32 v96, v75, v42
v_and_b32 v97, 0xffff0000, v61
v_mfma_f32_16x16x32_bf16 a[148:151], v[212:215], v[240:243], a[148:151]
v_fmac_f32 v96, v74, v43
v_fmac_f32 v96, v73, v44
v_mfma_f32_16x16x32_bf16 a[152:155], v[216:219], v[240:243], a[152:155]
s_add_u32 s72, s69, 39936
buffer_load_dwordx4 v3, s[8:11], s72 offen offset:1024 lds
v_mfma_f32_16x16x32_bf16 a[156:159], v[220:223], v[240:243], a[156:159]
v_fmac_f32 v96, v72, v45
v_mul_f32 v96, v96, v97
v_mfma_f32_16x16x32_bf16 a[188:191], v[220:223], v[244:247], a[188:191]
v_cvt_pk_bf16_f32 v102, v95, v96
v_mul_f32 v95, v75, v41
v_mfma_f32_16x16x32_bf16 a[184:187], v[216:219], v[244:247], a[184:187]
v_and_b32 v97, 0xffff0000, v60
v_fmac_f32 v95, v74, v42
v_mfma_f32_16x16x32_bf16 a[180:183], v[212:215], v[244:247], a[180:183]
v_fmac_f32 v95, v73, v43
v_fmac_f32 v95, v72, v44
v_mfma_f32_16x16x32_bf16 a[176:179], v[208:211], v[244:247], a[176:179]
s_add_u32 s72, s69, 47104
buffer_load_dwordx4 v2, s[8:11], s72 offen offset:2048 lds
v_mfma_f32_16x16x32_bf16 a[172:175], v[204:207], v[244:247], a[172:175]
v_mul_f32 v95, v95, v97
v_mul_f32 v96, v75, v40
v_mfma_f32_16x16x32_bf16 a[168:171], v[200:203], v[244:247], a[168:171]
v_and_b32 v97, 0xffff0000, v59
v_fmac_f32 v96, v74, v41
v_mfma_f32_16x16x32_bf16 a[164:167], v[196:199], v[244:247], a[164:167]
v_fmac_f32 v96, v73, v42
v_fmac_f32 v96, v72, v43
v_mfma_f32_16x16x32_bf16 a[160:163], v[192:195], v[244:247], a[160:163]
s_add_u32 s72, s69, 54272
buffer_load_dwordx4 v3, s[8:11], s72 offen offset:3072 lds
v_mfma_f32_16x16x32_bf16 a[192:195], v[192:195], v[248:251], a[192:195]
v_mul_f32 v96, v96, v97
v_cvt_pk_bf16_f32 v103, v95, v96
v_mfma_f32_16x16x32_bf16 a[196:199], v[196:199], v[248:251], a[196:199]
ds_write_b128 v28, v[100:103] offset:272
v_mul_f32 v95, v75, v39
v_mfma_f32_16x16x32_bf16 a[200:203], v[200:203], v[248:251], a[200:203]
v_and_b32 v97, 0xffff0000, v58
v_fmac_f32 v95, v74, v40
v_mfma_f32_16x16x32_bf16 a[204:207], v[204:207], v[248:251], a[204:207]
s_add_u32 m0, s64, 16384
v_fmac_f32 v95, v73, v41
v_fmac_f32 v95, v72, v42
v_mfma_f32_16x16x32_bf16 a[208:211], v[208:211], v[248:251], a[208:211]
s_add_u32 s72, s71, 0
buffer_load_dwordx4 v6, s[20:23], s72 offen lds
v_mfma_f32_16x16x32_bf16 a[212:215], v[212:215], v[248:251], a[212:215]
v_mul_f32 v95, v95, v97
v_mul_f32 v96, v75, v38
v_mfma_f32_16x16x32_bf16 a[216:219], v[216:219], v[248:251], a[216:219]
v_and_b32 v97, 0xffff0000, v57
v_fmac_f32 v96, v74, v39
v_mfma_f32_16x16x32_bf16 a[220:223], v[220:223], v[248:251], a[220:223]
v_fmac_f32 v96, v73, v40
v_fmac_f32 v96, v72, v41
v_mfma_f32_16x16x32_bf16 a[252:255], v[220:223], v[252:255], a[252:255]
s_add_u32 s72, s71, 31744
buffer_load_dwordx4 v6, s[20:23], s72 offen offset:1024 lds
v_mfma_f32_16x16x32_bf16 a[248:251], v[216:219], v[252:255], a[248:251]
v_mul_f32 v96, v96, v97
v_cvt_pk_bf16_f32 v104, v95, v96
v_mfma_f32_16x16x32_bf16 a[244:247], v[212:215], v[252:255], a[244:247]
v_mul_f32 v95, v75, v37
v_and_b32 v97, 0xffff0000, v56
v_mfma_f32_16x16x32_bf16 a[240:243], v[208:211], v[252:255], a[240:243]
v_fmac_f32 v95, v74, v38
v_fmac_f32 v95, v73, v39
v_mfma_f32_16x16x32_bf16 a[236:239], v[204:207], v[252:255], a[236:239]
s_add_u32 s72, s71, 63488
buffer_load_dwordx4 v7, s[20:23], s72 offen offset:2048 lds
v_mfma_f32_16x16x32_bf16 a[232:235], v[200:203], v[252:255], a[232:235]
v_fmac_f32 v95, v72, v40
v_mul_f32 v95, v95, v97
v_mfma_f32_16x16x32_bf16 a[228:231], v[196:199], v[252:255], a[228:231]
v_mul_f32 v96, v75, v36
v_and_b32 v97, 0xffff0000, v55
v_mfma_f32_16x16x32_bf16 a[224:227], v[192:195], v[252:255], a[224:227]
s_waitcnt lgkmcnt(0)
v_fmac_f32 v96, v74, v37
v_fmac_f32 v96, v73, v38
v_mfma_f32_16x16x32_bf16 a[0:3], v[160:163], v[128:131], a[0:3]
s_add_u32 s72, s71, 95232
buffer_load_dwordx4 v7, s[20:23], s72 offen offset:3072 lds
v_mfma_f32_16x16x32_bf16 a[4:7], v[160:163], v[132:135], a[4:7]
s_mov_b32 s80, 0x400000
buffer_load_dword v126, v125, s[12:15], s80 offen
v_mfma_f32_16x16x32_bf16 a[8:11], v[160:163], v[136:139], a[8:11]
s_mov_b32 s80, 0x500000
buffer_load_dword v126, v125, s[12:15], s80 offen
v_mfma_f32_16x16x32_bf16 a[12:15], v[160:163], v[140:143], a[12:15]
s_mov_b32 s80, 0x600000
buffer_load_dword v126, v125, s[12:15], s80 offen
v_mfma_f32_16x16x32_bf16 a[16:19], v[160:163], v[144:147], a[16:19]
s_mov_b32 s80, 0x700000
buffer_load_dword v126, v125, s[12:15], s80 offen
v_mfma_f32_16x16x32_bf16 a[20:23], v[160:163], v[148:151], a[20:23]
ds_read_b64_tr_b16 v[224:225], v20 offset:40960
v_fmac_f32 v96, v72, v39
v_mfma_f32_16x16x32_bf16 a[24:27], v[160:163], v[152:155], a[24:27]
v_mul_f32 v96, v96, v97
v_cvt_pk_bf16_f32 v105, v95, v96
v_mfma_f32_16x16x32_bf16 a[28:31], v[160:163], v[156:159], a[28:31]
ds_read_b64_tr_b16 v[226:227], v20 offset:41984
v_mul_f32 v95, v75, v35
v_mfma_f32_16x16x32_bf16 a[60:63], v[164:167], v[156:159], a[60:63]
v_and_b32 v97, 0xffff0000, v54
v_fmac_f32 v95, v74, v36
v_mfma_f32_16x16x32_bf16 a[56:59], v[164:167], v[152:155], a[56:59]
ds_read_b128 v[192:195], v25 offset:32768
v_fmac_f32 v95, v73, v37
v_mfma_f32_16x16x32_bf16 a[52:55], v[164:167], v[148:151], a[52:55]
v_fmac_f32 v95, v72, v38
v_mul_f32 v95, v95, v97
v_mfma_f32_16x16x32_bf16 a[48:51], v[164:167], v[144:147], a[48:51]
ds_read_b128 v[196:199], v25 offset:34816
v_mul_f32 v96, v75, v34
v_mfma_f32_16x16x32_bf16 a[44:47], v[164:167], v[140:143], a[44:47]
v_and_b32 v97, 0xffff0000, v53
v_fmac_f32 v96, v74, v35
v_mfma_f32_16x16x32_bf16 a[40:43], v[164:167], v[136:139], a[40:43]
ds_read_b128 v[200:203], v25 offset:36864
v_fmac_f32 v96, v73, v36
v_mfma_f32_16x16x32_bf16 a[36:39], v[164:167], v[132:135], a[36:39]
v_fmac_f32 v96, v72, v37
v_mul_f32 v96, v96, v97
v_mfma_f32_16x16x32_bf16 a[32:35], v[164:167], v[128:131], a[32:35]
ds_read_b128 v[204:207], v25 offset:38912
v_cvt_pk_bf16_f32 v106, v95, v96
v_mfma_f32_16x16x32_bf16 a[64:67], v[168:171], v[128:131], a[64:67]
v_mul_f32 v95, v75, v33
v_and_b32 v97, 0xffff0000, v52
v_mfma_f32_16x16x32_bf16 a[68:71], v[168:171], v[132:135], a[68:71]
ds_read_b128 v[208:211], v25 offset:40960
v_fmac_f32 v95, v74, v34
v_mfma_f32_16x16x32_bf16 a[72:75], v[168:171], v[136:139], a[72:75]
v_fmac_f32 v95, v73, v35
v_fmac_f32 v95, v72, v36
v_mfma_f32_16x16x32_bf16 a[76:79], v[168:171], v[140:143], a[76:79]
ds_read_b128 v[212:215], v25 offset:43008
v_mul_f32 v95, v95, v97
v_mfma_f32_16x16x32_bf16 a[80:83], v[168:171], v[144:147], a[80:83]
v_mul_f32 v96, v75, v32
v_and_b32 v97, 0xffff0000, v51
v_mfma_f32_16x16x32_bf16 a[84:87], v[168:171], v[148:151], a[84:87]
ds_read_b128 v[216:219], v25 offset:45056
v_fmac_f32 v96, v74, v33
v_mfma_f32_16x16x32_bf16 a[88:91], v[168:171], v[152:155], a[88:91]
v_fmac_f32 v96, v73, v34
v_fmac_f32 v96, v72, v35
v_mfma_f32_16x16x32_bf16 a[92:95], v[168:171], v[156:159], a[92:95]
ds_read_b128 v[220:223], v25 offset:47104
v_mul_f32 v96, v96, v97
v_mfma_f32_16x16x32_bf16 a[124:127], v[172:175], v[156:159], a[124:127]
v_cvt_pk_bf16_f32 v107, v95, v96
v_mfma_f32_16x16x32_bf16 a[120:123], v[172:175], v[152:155], a[120:123]
ds_read_b64_tr_b16 v[228:229], v21 offset:40960
ds_write_b128 v28, v[104:107] offset:288
v_mfma_f32_16x16x32_bf16 a[116:119], v[172:175], v[148:151], a[116:119]
v_mfma_f32_16x16x32_bf16 a[112:115], v[172:175], v[144:147], a[112:115]
ds_read_b64_tr_b16 v[230:231], v21 offset:41984
v_mfma_f32_16x16x32_bf16 a[108:111], v[172:175], v[140:143], a[108:111]
v_mfma_f32_16x16x32_bf16 a[104:107], v[172:175], v[136:139], a[104:107]
ds_read_b64_tr_b16 v[232:233], v22 offset:40960
v_mfma_f32_16x16x32_bf16 a[100:103], v[172:175], v[132:135], a[100:103]
v_mfma_f32_16x16x32_bf16 a[96:99], v[172:175], v[128:131], a[96:99]
ds_read_b64_tr_b16 v[234:235], v22 offset:41984
v_mfma_f32_16x16x32_bf16 a[128:131], v[128:131], v[176:179], a[128:131]
v_mfma_f32_16x16x32_bf16 a[132:135], v[132:135], v[176:179], a[132:135]
ds_read_b64_tr_b16 v[236:237], v23 offset:40960
v_mfma_f32_16x16x32_bf16 a[136:139], v[136:139], v[176:179], a[136:139]
v_mfma_f32_16x16x32_bf16 a[140:143], v[140:143], v[176:179], a[140:143]
ds_read_b64_tr_b16 v[238:239], v23 offset:41984
v_mfma_f32_16x16x32_bf16 a[144:147], v[144:147], v[176:179], a[144:147]
v_mfma_f32_16x16x32_bf16 a[148:151], v[148:151], v[176:179], a[148:151]
ds_read_b64_tr_b16 v[240:241], v20 offset:57344
v_mfma_f32_16x16x32_bf16 a[152:155], v[152:155], v[176:179], a[152:155]
v_mfma_f32_16x16x32_bf16 a[156:159], v[156:159], v[176:179], a[156:159]
ds_read_b64_tr_b16 v[242:243], v20 offset:58368
v_mfma_f32_16x16x32_bf16 a[188:191], v[156:159], v[180:183], a[188:191]
v_mfma_f32_16x16x32_bf16 a[184:187], v[152:155], v[180:183], a[184:187]
ds_read_b64_tr_b16 v[244:245], v21 offset:57344
v_mfma_f32_16x16x32_bf16 a[180:183], v[148:151], v[180:183], a[180:183]
v_mfma_f32_16x16x32_bf16 a[176:179], v[144:147], v[180:183], a[176:179]
ds_read_b64_tr_b16 v[246:247], v21 offset:58368
v_mfma_f32_16x16x32_bf16 a[172:175], v[140:143], v[180:183], a[172:175]
v_mfma_f32_16x16x32_bf16 a[168:171], v[136:139], v[180:183], a[168:171]
ds_read_b64_tr_b16 v[248:249], v22 offset:57344
v_mfma_f32_16x16x32_bf16 a[164:167], v[132:135], v[180:183], a[164:167]
v_mfma_f32_16x16x32_bf16 a[160:163], v[128:131], v[180:183], a[160:163]
ds_read_b64_tr_b16 v[250:251], v22 offset:58368
v_mfma_f32_16x16x32_bf16 a[192:195], v[128:131], v[184:187], a[192:195]
v_mfma_f32_16x16x32_bf16 a[196:199], v[132:135], v[184:187], a[196:199]
ds_read_b64_tr_b16 v[252:253], v23 offset:57344
v_mfma_f32_16x16x32_bf16 a[200:203], v[136:139], v[184:187], a[200:203]
v_mfma_f32_16x16x32_bf16 a[204:207], v[140:143], v[184:187], a[204:207]
ds_read_b64_tr_b16 v[254:255], v23 offset:58368
v_mfma_f32_16x16x32_bf16 a[208:211], v[144:147], v[184:187], a[208:211]
v_mfma_f32_16x16x32_bf16 a[212:215], v[148:151], v[184:187], a[212:215]
v_mfma_f32_16x16x32_bf16 a[216:219], v[152:155], v[184:187], a[216:219]
v_mfma_f32_16x16x32_bf16 a[220:223], v[156:159], v[184:187], a[220:223]
v_mfma_f32_16x16x32_bf16 a[252:255], v[156:159], v[188:191], a[252:255]
v_mfma_f32_16x16x32_bf16 a[248:251], v[152:155], v[188:191], a[248:251]
v_mfma_f32_16x16x32_bf16 a[244:247], v[148:151], v[188:191], a[244:247]
v_mfma_f32_16x16x32_bf16 a[240:243], v[144:147], v[188:191], a[240:243]
v_mfma_f32_16x16x32_bf16 a[236:239], v[140:143], v[188:191], a[236:239]
v_mfma_f32_16x16x32_bf16 a[232:235], v[136:139], v[188:191], a[232:235]
v_mfma_f32_16x16x32_bf16 a[228:231], v[132:135], v[188:191], a[228:231]
s_waitcnt vmcnt(4) lgkmcnt(0)
v_mfma_f32_16x16x32_bf16 a[224:227], v[128:131], v[188:191], a[224:227]
s_barrier
v_mfma_f32_16x16x32_bf16 a[0:3], v[224:227], v[192:195], a[0:3]
s_add_u32 s73, s61, 7
ds_read_b64_tr_b16 v[160:161], v20 offset:0
v_mfma_f32_16x16x32_bf16 a[4:7], v[224:227], v[196:199], a[4:7]
s_and_b32 s73, s73, 7
ds_read_b64_tr_b16 v[162:163], v20 offset:1024
v_mfma_f32_16x16x32_bf16 a[8:11], v[224:227], v[200:203], a[8:11]
s_lshl_b32 s69, s73, 7
ds_read_b128 v[128:131], v24 offset:0
v_mfma_f32_16x16x32_bf16 a[12:15], v[224:227], v[204:207], a[12:15]
s_add_u32 s69, s69, s67
ds_read_b128 v[132:135], v24 offset:2048
v_mfma_f32_16x16x32_bf16 a[16:19], v[224:227], v[208:211], a[16:19]
s_lshl_b32 s71, s73, 19
ds_read_b128 v[136:139], v24 offset:4096
v_mfma_f32_16x16x32_bf16 a[20:23], v[224:227], v[212:215], a[20:23]
s_add_u32 s71, s71, s66
ds_read_b128 v[140:143], v24 offset:6144
v_mfma_f32_16x16x32_bf16 a[24:27], v[224:227], v[216:219], a[24:27]
s_add_u32 m0, s63, 98304
ds_read_b128 v[144:147], v24 offset:8192
v_mfma_f32_16x16x32_bf16 a[28:31], v[224:227], v[220:223], a[28:31]
s_add_u32 s72, s69, 0
buffer_load_dwordx4 v2, s[8:11], s72 offen lds
v_mfma_f32_16x16x32_bf16 a[60:63], v[228:231], v[220:223], a[60:63]
s_add_u32 s72, s69, 7168
buffer_load_dwordx4 v3, s[8:11], s72 offen offset:1024 lds
v_mfma_f32_16x16x32_bf16 a[56:59], v[228:231], v[216:219], a[56:59]
s_add_u32 s72, s69, 14336
buffer_load_dwordx4 v2, s[8:11], s72 offen offset:2048 lds
v_mfma_f32_16x16x32_bf16 a[52:55], v[228:231], v[212:215], a[52:55]
s_mul_i32 s74, s58, 4352
ds_read_b128 v[148:151], v24 offset:10240
v_mfma_f32_16x16x32_bf16 a[48:51], v[228:231], v[208:211], a[48:51]
s_add_u32 s74, s74, 131072
ds_read_b128 v[152:155], v24 offset:12288
v_lshrrev_b32 v26, 4, v0
v_mfma_f32_16x16x32_bf16 a[44:47], v[228:231], v[204:207], a[44:47]
s_add_u32 s72, s69, 21504
buffer_load_dwordx4 v3, s[8:11], s72 offen offset:3072 lds
v_mfma_f32_16x16x32_bf16 a[40:43], v[228:231], v[200:203], a[40:43]
ds_read_b128 v[156:159], v24 offset:14336
v_and_b32 v27, 15, v0
v_mfma_f32_16x16x32_bf16 a[36:39], v[228:231], v[196:199], a[36:39]
ds_read_b64_tr_b16 v[164:165], v21 offset:0
v_lshlrev_b32 v27, 4, v27
v_mfma_f32_16x16x32_bf16 a[32:35], v[228:231], v[192:195], a[32:35]
ds_read_b64_tr_b16 v[166:167], v21 offset:1024
v_mul_u32_u24 v28, 272, v26
v_mfma_f32_16x16x32_bf16 a[64:67], v[232:235], v[192:195], a[64:67]
ds_read_b64_tr_b16 v[168:169], v22 offset:0
v_add3_u32 v28, v28, v27, s74
v_mfma_f32_16x16x32_bf16 a[68:71], v[232:235], v[196:199], a[68:71]
s_add_u32 m0, s64, 32768
ds_read_b64_tr_b16 v[170:171], v22 offset:1024
v_lshl_add_u32 v26, v26, 12, v27
v_mfma_f32_16x16x32_bf16 a[72:75], v[232:235], v[200:203], a[72:75]
s_add_u32 s72, s71, 0
buffer_load_dwordx4 v6, s[16:19], s72 offen lds
v_mfma_f32_16x16x32_bf16 a[76:79], v[232:235], v[204:207], a[76:79]
ds_read_b64_tr_b16 v[172:173], v23 offset:0
ds_read_b128 v[32:35], v28 offset:0
v_mfma_f32_16x16x32_bf16 a[80:83], v[232:235], v[208:211], a[80:83]
ds_read_b64_tr_b16 v[174:175], v23 offset:1024
ds_read_b128 v[36:39], v28 offset:1088
v_mfma_f32_16x16x32_bf16 a[84:87], v[232:235], v[212:215], a[84:87]
s_add_u32 s72, s71, 31744
buffer_load_dwordx4 v6, s[16:19], s72 offen offset:1024 lds
v_mfma_f32_16x16x32_bf16 a[88:91], v[232:235], v[216:219], a[88:91]
ds_read_b64_tr_b16 v[176:177], v20 offset:16384
ds_read_b128 v[40:43], v28 offset:2176
v_mfma_f32_16x16x32_bf16 a[92:95], v[232:235], v[220:223], a[92:95]
ds_read_b64_tr_b16 v[178:179], v20 offset:17408
ds_read_b128 v[44:47], v28 offset:3264
v_mfma_f32_16x16x32_bf16 a[124:127], v[236:239], v[220:223], a[124:127]
s_and_b32 s74, s2, 15
ds_read_b64_tr_b16 v[180:181], v21 offset:16384
v_mfma_f32_16x16x32_bf16 a[120:123], v[236:239], v[216:219], a[120:123]
s_add_u32 s72, s71, 63488
buffer_load_dwordx4 v7, s[16:19], s72 offen offset:2048 lds
v_mfma_f32_16x16x32_bf16 a[116:119], v[236:239], v[212:215], a[116:119]
s_lshl_b32 s74, s74, 2
ds_read_b64_tr_b16 v[182:183], v21 offset:17408
v_mfma_f32_16x16x32_bf16 a[112:115], v[236:239], v[208:211], a[112:115]
s_add_u32 s74, s74, s58
ds_read_b64_tr_b16 v[184:185], v22 offset:16384
v_mfma_f32_16x16x32_bf16 a[108:111], v[236:239], v[204:207], a[108:111]
s_lshl_b32 s74, s74, 16
ds_read_b64_tr_b16 v[186:187], v22 offset:17408
v_mfma_f32_16x16x32_bf16 a[104:107], v[236:239], v[200:203], a[104:107]
s_lshr_b32 s75, s2, 4
ds_read_b64_tr_b16 v[188:189], v23 offset:16384
v_mfma_f32_16x16x32_bf16 a[100:103], v[236:239], v[196:199], a[100:103]
s_add_u32 s72, s71, 95232
buffer_load_dwordx4 v7, s[16:19], s72 offen offset:3072 lds
v_mfma_f32_16x16x32_bf16 a[96:99], v[236:239], v[192:195], a[96:99]
s_lshl_b32 s75, s75, 8
ds_read_b64_tr_b16 v[190:191], v23 offset:17408
v_mfma_f32_16x16x32_bf16 a[128:131], v[192:195], v[240:243], a[128:131]
s_sub_u32 s74, s74, s75
v_mfma_f32_16x16x32_bf16 a[132:135], v[196:199], v[240:243], a[132:135]
s_add_u32 s74, s74, 0x3000f00
v_mfma_f32_16x16x32_bf16 a[136:139], v[200:203], v[240:243], a[136:139]
s_add_u32 m0, s63, 102400
v_mfma_f32_16x16x32_bf16 a[140:143], v[204:207], v[240:243], a[140:143]
s_add_u32 s72, s69, 32768
buffer_load_dwordx4 v2, s[8:11], s72 offen lds
v_mfma_f32_16x16x32_bf16 a[144:147], v[208:211], v[240:243], a[144:147]
s_waitcnt lgkmcnt(6)
buffer_store_dwordx4 v[32:35], v26, s[44:47], s74 offen sc1
v_mfma_f32_16x16x32_bf16 a[148:151], v[212:215], v[240:243], a[148:151]
s_add_u32 s74, s74, 0x4000
buffer_store_dwordx4 v[36:39], v26, s[44:47], s74 offen sc1
v_mfma_f32_16x16x32_bf16 a[152:155], v[216:219], v[240:243], a[152:155]
s_add_u32 s72, s69, 39936
buffer_load_dwordx4 v3, s[8:11], s72 offen offset:1024 lds
v_mfma_f32_16x16x32_bf16 a[156:159], v[220:223], v[240:243], a[156:159]
s_add_u32 s74, s74, 0x4000
buffer_store_dwordx4 v[40:43], v26, s[44:47], s74 offen sc1
v_mfma_f32_16x16x32_bf16 a[188:191], v[220:223], v[244:247], a[188:191]
s_add_u32 s74, s74, 0x4000
buffer_store_dwordx4 v[44:47], v26, s[44:47], s74 offen sc1
v_mfma_f32_16x16x32_bf16 a[184:187], v[216:219], v[244:247], a[184:187]
s_waitcnt vmcnt(34)
v_lshlrev_b32 v78, 16, v84
v_lshlrev_b32 v79, 16, v108
v_mfma_f32_16x16x32_bf16 a[180:183], v[212:215], v[244:247], a[180:183]
v_mul_f32 v76, v78, v79
v_lshlrev_b32 v80, 16, v116
v_mfma_f32_16x16x32_bf16 a[176:179], v[208:211], v[244:247], a[176:179]
s_add_u32 s72, s69, 47104
buffer_load_dwordx4 v2, s[8:11], s72 offen offset:2048 lds
v_mfma_f32_16x16x32_bf16 a[172:175], v[204:207], v[244:247], a[172:175]
v_mul_f32 v77, v78, v80
v_and_b32 v78, 0xffff0000, v84
v_mfma_f32_16x16x32_bf16 a[168:171], v[200:203], v[244:247], a[168:171]
v_and_b32 v79, 0xffff0000, v108
v_fmac_f32 v76, v78, v79
v_mfma_f32_16x16x32_bf16 a[164:167], v[196:199], v[244:247], a[164:167]
v_and_b32 v80, 0xffff0000, v116
v_fmac_f32 v77, v78, v80
v_mfma_f32_16x16x32_bf16 a[160:163], v[192:195], v[244:247], a[160:163]
s_add_u32 s72, s69, 54272
buffer_load_dwordx4 v3, s[8:11], s72 offen offset:3072 lds
v_mfma_f32_16x16x32_bf16 a[192:195], v[192:195], v[248:251], a[192:195]
v_lshlrev_b32 v78, 16, v85
v_lshlrev_b32 v79, 16, v109
v_mfma_f32_16x16x32_bf16 a[196:199], v[196:199], v[248:251], a[196:199]
v_fmac_f32 v76, v78, v79
v_lshlrev_b32 v80, 16, v117
v_mfma_f32_16x16x32_bf16 a[200:203], v[200:203], v[248:251], a[200:203]
v_fmac_f32 v77, v78, v80
v_and_b32 v78, 0xffff0000, v85
v_mfma_f32_16x16x32_bf16 a[204:207], v[204:207], v[248:251], a[204:207]
s_add_u32 m0, s64, 49152
v_and_b32 v79, 0xffff0000, v109
v_fmac_f32 v76, v78, v79
v_mfma_f32_16x16x32_bf16 a[208:211], v[208:211], v[248:251], a[208:211]
s_add_u32 s72, s71, 0
buffer_load_dwordx4 v6, s[20:23], s72 offen lds
v_mfma_f32_16x16x32_bf16 a[212:215], v[212:215], v[248:251], a[212:215]
v_and_b32 v80, 0xffff0000, v117
v_fmac_f32 v77, v78, v80
v_mfma_f32_16x16x32_bf16 a[216:219], v[216:219], v[248:251], a[216:219]
v_lshlrev_b32 v78, 16, v86
v_lshlrev_b32 v79, 16, v110
v_mfma_f32_16x16x32_bf16 a[220:223], v[220:223], v[248:251], a[220:223]
v_fmac_f32 v76, v78, v79
v_lshlrev_b32 v80, 16, v118
v_mfma_f32_16x16x32_bf16 a[252:255], v[220:223], v[252:255], a[252:255]
s_add_u32 s72, s71, 31744
buffer_load_dwordx4 v6, s[20:23], s72 offen offset:1024 lds
v_mfma_f32_16x16x32_bf16 a[248:251], v[216:219], v[252:255], a[248:251]
v_fmac_f32 v77, v78, v80
v_and_b32 v78, 0xffff0000, v86
v_mfma_f32_16x16x32_bf16 a[244:247], v[212:215], v[252:255], a[244:247]
v_and_b32 v79, 0xffff0000, v110
v_fmac_f32 v76, v78, v79
v_mfma_f32_16x16x32_bf16 a[240:243], v[208:211], v[252:255], a[240:243]
v_and_b32 v80, 0xffff0000, v118
v_fmac_f32 v77, v78, v80
v_mfma_f32_16x16x32_bf16 a[236:239], v[204:207], v[252:255], a[236:239]
s_add_u32 s72, s71, 63488
buffer_load_dwordx4 v7, s[20:23], s72 offen offset:2048 lds
v_mfma_f32_16x16x32_bf16 a[232:235], v[200:203], v[252:255], a[232:235]
v_lshlrev_b32 v78, 16, v87
v_lshlrev_b32 v79, 16, v111
v_mfma_f32_16x16x32_bf16 a[228:231], v[196:199], v[252:255], a[228:231]
v_fmac_f32 v76, v78, v79
v_lshlrev_b32 v80, 16, v119
v_mfma_f32_16x16x32_bf16 a[224:227], v[192:195], v[252:255], a[224:227]
s_waitcnt lgkmcnt(0)
v_fmac_f32 v77, v78, v80
v_and_b32 v78, 0xffff0000, v87
v_mfma_f32_16x16x32_bf16 a[0:3], v[160:163], v[128:131], a[0:3]
s_add_u32 s72, s71, 95232
buffer_load_dwordx4 v7, s[20:23], s72 offen offset:3072 lds
v_mfma_f32_16x16x32_bf16 a[4:7], v[160:163], v[132:135], a[4:7]
ds_read_b64_tr_b16 v[224:225], v20 offset:8192
v_and_b32 v79, 0xffff0000, v111
v_mfma_f32_16x16x32_bf16 a[8:11], v[160:163], v[136:139], a[8:11]
v_fmac_f32 v76, v78, v79
v_and_b32 v80, 0xffff0000, v119
v_mfma_f32_16x16x32_bf16 a[12:15], v[160:163], v[140:143], a[12:15]
ds_read_b64_tr_b16 v[226:227], v20 offset:9216
v_fmac_f32 v77, v78, v80
v_mfma_f32_16x16x32_bf16 a[16:19], v[160:163], v[144:147], a[16:19]
v_lshlrev_b32 v78, 16, v88
v_lshlrev_b32 v79, 16, v112
v_mfma_f32_16x16x32_bf16 a[20:23], v[160:163], v[148:151], a[20:23]
ds_read_b128 v[192:195], v25 offset:0
v_fmac_f32 v76, v78, v79
v_mfma_f32_16x16x32_bf16 a[24:27], v[160:163], v[152:155], a[24:27]
v_lshlrev_b32 v80, 16, v120
v_fmac_f32 v77, v78, v80
v_mfma_f32_16x16x32_bf16 a[28:31], v[160:163], v[156:159], a[28:31]
ds_read_b128 v[196:199], v25 offset:2048
v_and_b32 v78, 0xffff0000, v88
v_mfma_f32_16x16x32_bf16 a[60:63], v[164:167], v[156:159], a[60:63]
v_and_b32 v79, 0xffff0000, v112
v_fmac_f32 v76, v78, v79
v_mfma_f32_16x16x32_bf16 a[56:59], v[164:167], v[152:155], a[56:59]
ds_read_b128 v[200:203], v25 offset:4096
v_and_b32 v80, 0xffff0000, v120
v_mfma_f32_16x16x32_bf16 a[52:55], v[164:167], v[148:151], a[52:55]
v_fmac_f32 v77, v78, v80
v_lshlrev_b32 v78, 16, v89
v_mfma_f32_16x16x32_bf16 a[48:51], v[164:167], v[144:147], a[48:51]
ds_read_b128 v[204:207], v25 offset:6144
v_lshlrev_b32 v79, 16, v113
v_mfma_f32_16x16x32_bf16 a[44:47], v[164:167], v[140:143], a[44:47]
v_fmac_f32 v76, v78, v79
v_lshlrev_b32 v80, 16, v121
v_mfma_f32_16x16x32_bf16 a[40:43], v[164:167], v[136:139], a[40:43]
ds_read_b128 v[208:211], v25 offset:8192
v_fmac_f32 v77, v78, v80
v_mfma_f32_16x16x32_bf16 a[36:39], v[164:167], v[132:135], a[36:39]
v_and_b32 v78, 0xffff0000, v89
v_and_b32 v79, 0xffff0000, v113
v_mfma_f32_16x16x32_bf16 a[32:35], v[164:167], v[128:131], a[32:35]
ds_read_b128 v[212:215], v25 offset:10240
v_fmac_f32 v76, v78, v79
v_mfma_f32_16x16x32_bf16 a[64:67], v[168:171], v[128:131], a[64:67]
v_and_b32 v80, 0xffff0000, v121
v_fmac_f32 v77, v78, v80
v_mfma_f32_16x16x32_bf16 a[68:71], v[168:171], v[132:135], a[68:71]
ds_read_b128 v[216:219], v25 offset:12288
v_lshlrev_b32 v78, 16, v90
v_mfma_f32_16x16x32_bf16 a[72:75], v[168:171], v[136:139], a[72:75]
v_lshlrev_b32 v79, 16, v114
v_fmac_f32 v76, v78, v79
v_mfma_f32_16x16x32_bf16 a[76:79], v[168:171], v[140:143], a[76:79]
ds_read_b128 v[220:223], v25 offset:14336
v_lshlrev_b32 v80, 16, v122
v_mfma_f32_16x16x32_bf16 a[80:83], v[168:171], v[144:147], a[80:83]
s_lshr_b32 s75, s93, 5
v_fmac_f32 v77, v78, v80
v_and_b32 v78, 0xffff0000, v90
v_mfma_f32_16x16x32_bf16 a[84:87], v[168:171], v[148:151], a[84:87]
s_and_b32 s75, s75, 0x3f80
ds_read_b64_tr_b16 v[228:229], v21 offset:8192
v_and_b32 v79, 0xffff0000, v114
v_mfma_f32_16x16x32_bf16 a[88:91], v[168:171], v[152:155], a[88:91]
s_add_u32 s75, s75, LcB0-Lpc0
v_lshrrev_b32 v2, 6, v0
v_lshlrev_b32 v2, 7, v2
v_mfma_f32_16x16x32_bf16 a[92:95], v[168:171], v[156:159], a[92:95]
v_add_u32 v2, s75, v2
v_min_u32 v2, Lcode_end-Lpc0, v2
v_mfma_f32_16x16x32_bf16 a[124:127], v[172:175], v[156:159], a[124:127]
global_load_dword v3, v2, s[98:99]
v_mfma_f32_16x16x32_bf16 a[120:123], v[172:175], v[152:155], a[120:123]
ds_read_b64_tr_b16 v[230:231], v21 offset:9216
v_fmac_f32 v76, v78, v79
v_mfma_f32_16x16x32_bf16 a[116:119], v[172:175], v[148:151], a[116:119]
v_and_b32 v80, 0xffff0000, v122
v_fmac_f32 v77, v78, v80
v_mfma_f32_16x16x32_bf16 a[112:115], v[172:175], v[144:147], a[112:115]
ds_read_b64_tr_b16 v[232:233], v22 offset:8192
v_lshlrev_b32 v78, 16, v91
v_mfma_f32_16x16x32_bf16 a[108:111], v[172:175], v[140:143], a[108:111]
v_lshlrev_b32 v79, 16, v115
v_fmac_f32 v76, v78, v79
v_mfma_f32_16x16x32_bf16 a[104:107], v[172:175], v[136:139], a[104:107]
ds_read_b64_tr_b16 v[234:235], v22 offset:9216
v_lshlrev_b32 v80, 16, v123
v_mfma_f32_16x16x32_bf16 a[100:103], v[172:175], v[132:135], a[100:103]
v_fmac_f32 v77, v78, v80
v_and_b32 v78, 0xffff0000, v91
v_mfma_f32_16x16x32_bf16 a[96:99], v[172:175], v[128:131], a[96:99]
ds_read_b64_tr_b16 v[236:237], v23 offset:8192
v_and_b32 v79, 0xffff0000, v115
v_mfma_f32_16x16x32_bf16 a[128:131], v[128:131], v[176:179], a[128:131]
v_fmac_f32 v76, v78, v79
v_and_b32 v80, 0xffff0000, v123
v_mfma_f32_16x16x32_bf16 a[132:135], v[132:135], v[176:179], a[132:135]
ds_read_b64_tr_b16 v[238:239], v23 offset:9216
v_fmac_f32 v77, v78, v80
v_mfma_f32_16x16x32_bf16 a[136:139], v[136:139], v[176:179], a[136:139]
v_add_f32_dpp v76, v76, v76 row_ror:8 row_mask:0xf bank_mask:0xf
v_add_f32_dpp v77, v77, v77 row_ror:8 row_mask:0xf bank_mask:0xf
v_mfma_f32_16x16x32_bf16 a[140:143], v[140:143], v[176:179], a[140:143]
ds_read_b64_tr_b16 v[240:241], v20 offset:24576
v_add_f32_dpp v76, v76, v76 row_ror:4 row_mask:0xf bank_mask:0xf
v_mfma_f32_16x16x32_bf16 a[144:147], v[144:147], v[176:179], a[144:147]
v_add_f32_dpp v77, v77, v77 row_ror:4 row_mask:0xf bank_mask:0xf
v_add_f32_dpp v76, v76, v76 row_ror:2 row_mask:0xf bank_mask:0xf
v_mfma_f32_16x16x32_bf16 a[148:151], v[148:151], v[176:179], a[148:151]
ds_read_b64_tr_b16 v[242:243], v20 offset:25600
v_add_f32_dpp v77, v77, v77 row_ror:2 row_mask:0xf bank_mask:0xf
v_mfma_f32_16x16x32_bf16 a[152:155], v[152:155], v[176:179], a[152:155]
v_add_f32_dpp v76, v76, v76 row_ror:1 row_mask:0xf bank_mask:0xf
v_add_f32_dpp v77, v77, v77 row_ror:1 row_mask:0xf bank_mask:0xf
v_mfma_f32_16x16x32_bf16 a[156:159], v[156:159], v[176:179], a[156:159]
ds_read_b64_tr_b16 v[244:245], v21 offset:24576
v_mov_b32 v78, v76
v_mfma_f32_16x16x32_bf16 a[188:191], v[156:159], v[180:183], a[188:191]
v_mov_b32 v79, v77
v_permlane16_swap_b32 v76, v78
v_mfma_f32_16x16x32_bf16 a[184:187], v[152:155], v[180:183], a[184:187]
ds_read_b64_tr_b16 v[246:247], v21 offset:25600
v_permlane16_swap_b32 v77, v79
v_mfma_f32_16x16x32_bf16 a[180:183], v[148:151], v[180:183], a[180:183]
v_add_f32 v76, v76, v78
v_add_f32 v77, v77, v79
v_mfma_f32_16x16x32_bf16 a[176:179], v[144:147], v[180:183], a[176:179]
ds_read_b64_tr_b16 v[248:249], v22 offset:24576
v_mov_b32 v78, v76
v_mfma_f32_16x16x32_bf16 a[172:175], v[140:143], v[180:183], a[172:175]
v_mov_b32 v79, v77
v_permlane32_swap_b32 v76, v78
v_mfma_f32_16x16x32_bf16 a[168:171], v[136:139], v[180:183], a[168:171]
ds_read_b64_tr_b16 v[250:251], v22 offset:25600
v_permlane32_swap_b32 v77, v79
v_mfma_f32_16x16x32_bf16 a[164:167], v[132:135], v[180:183], a[164:167]
v_add_f32 v76, v76, v78
v_add_f32 v77, v77, v79
v_mfma_f32_16x16x32_bf16 a[160:163], v[128:131], v[180:183], a[160:163]
ds_read_b64_tr_b16 v[252:253], v23 offset:24576
v_mul_f32 v76, 0xbfb8aa3b, v76
v_mfma_f32_16x16x32_bf16 a[192:195], v[128:131], v[184:187], a[192:195]
v_mul_f32 v77, 0xbfb8aa3b, v77
v_mfma_f32_16x16x32_bf16 a[196:199], v[132:135], v[184:187], a[196:199]
ds_read_b64_tr_b16 v[254:255], v23 offset:25600
v_mfma_f32_16x16x32_bf16 a[200:203], v[136:139], v[184:187], a[200:203]
v_exp_f32 v76, v76
v_mfma_f32_16x16x32_bf16 a[204:207], v[140:143], v[184:187], a[204:207]
v_exp_f32 v77, v77
v_mfma_f32_16x16x32_bf16 a[208:211], v[144:147], v[184:187], a[208:211]
v_add_f32 v76, 1.0, v76
v_add_f32 v77, 1.0, v77
v_mfma_f32_16x16x32_bf16 a[212:215], v[148:151], v[184:187], a[212:215]
v_rcp_f32 v76, v76
v_mfma_f32_16x16x32_bf16 a[216:219], v[152:155], v[184:187], a[216:219]
v_rcp_f32 v77, v77
v_mfma_f32_16x16x32_bf16 a[220:223], v[156:159], v[184:187], a[220:223]
s_lshr_b32 s80, s76, 9
v_mfma_f32_16x16x32_bf16 a[252:255], v[156:159], v[188:191], a[252:255]
s_add_u32 s80, s80, 0x3800000
v_min_u32 v78, 1, v0
v_lshlrev_b32 v78, 30, v78
v_mfma_f32_16x16x32_bf16 a[248:251], v[152:155], v[188:191], a[248:251]
buffer_store_dwordx2 v[76:77], v78, s[44:47], s80 offen sc1
v_mfma_f32_16x16x32_bf16 a[244:247], v[148:151], v[188:191], a[244:247]
v_mfma_f32_16x16x32_bf16 a[240:243], v[144:147], v[188:191], a[240:243]
v_mfma_f32_16x16x32_bf16 a[236:239], v[140:143], v[188:191], a[236:239]
v_mfma_f32_16x16x32_bf16 a[232:235], v[136:139], v[188:191], a[232:235]
v_mfma_f32_16x16x32_bf16 a[228:231], v[132:135], v[188:191], a[228:231]
s_waitcnt vmcnt(2) lgkmcnt(0)
v_mfma_f32_16x16x32_bf16 a[224:227], v[128:131], v[188:191], a[224:227]
s_barrier
v_mfma_f32_16x16x32_bf16 a[0:3], v[224:227], v[192:195], a[0:3]
s_add_u32 s73, s62, 0
ds_read_b64_tr_b16 v[160:161], v20 offset:32768
v_mfma_f32_16x16x32_bf16 a[4:7], v[224:227], v[196:199], a[4:7]
s_add_u32 s70, s73, s65
ds_read_b64_tr_b16 v[162:163], v20 offset:33792
v_mfma_f32_16x16x32_bf16 a[8:11], v[224:227], v[200:203], a[8:11]
s_and_b32 s70, s70, 3
ds_read_b128 v[128:131], v24 offset:32768
v_mfma_f32_16x16x32_bf16 a[12:15], v[224:227], v[204:207], a[12:15]
s_and_b32 s73, s73, 12
ds_read_b128 v[132:135], v24 offset:34816
v_mfma_f32_16x16x32_bf16 a[16:19], v[224:227], v[208:211], a[16:19]
s_or_b32 s73, s73, s70
ds_read_b128 v[136:139], v24 offset:36864
v_mfma_f32_16x16x32_bf16 a[20:23], v[224:227], v[212:215], a[20:23]
s_lshl_b32 s71, s73, 19
ds_read_b128 v[140:143], v24 offset:38912
v_mfma_f32_16x16x32_bf16 a[24:27], v[224:227], v[216:219], a[24:27]
s_add_u32 s71, s71, s66
ds_read_b128 v[144:147], v24 offset:40960
v_mfma_f32_16x16x32_bf16 a[28:31], v[224:227], v[220:223], a[28:31]
s_lshl_b32 s73, s73, 7
ds_read_b128 v[148:151], v24 offset:43008
v_mfma_f32_16x16x32_bf16 a[60:63], v[228:231], v[220:223], a[60:63]
s_add_u32 s69, s73, s67
ds_read_b128 v[152:155], v24 offset:45056
v_mfma_f32_16x16x32_bf16 a[56:59], v[228:231], v[216:219], a[56:59]
s_add_u32 s70, s73, s68
ds_read_b128 v[156:159], v24 offset:47104
v_mfma_f32_16x16x32_bf16 a[52:55], v[228:231], v[212:215], a[52:55]
s_add_u32 m0, s64, 0
ds_read_b64_tr_b16 v[164:165], v21 offset:32768
v_mfma_f32_16x16x32_bf16 a[48:51], v[228:231], v[208:211], a[48:51]
s_add_u32 s72, s71, 0
buffer_load_dwordx4 v6, s[12:15], s72 offen lds
v_mfma_f32_16x16x32_bf16 a[44:47], v[228:231], v[204:207], a[44:47]
s_add_u32 s72, s71, 31744
buffer_load_dwordx4 v6, s[12:15], s72 offen offset:1024 lds
v_mfma_f32_16x16x32_bf16 a[40:43], v[228:231], v[200:203], a[40:43]
s_add_u32 s72, s71, 63488
buffer_load_dwordx4 v7, s[12:15], s72 offen offset:2048 lds
v_mfma_f32_16x16x32_bf16 a[36:39], v[228:231], v[196:199], a[36:39]
ds_read_b64_tr_b16 v[166:167], v21 offset:33792
v_mfma_f32_16x16x32_bf16 a[32:35], v[228:231], v[192:195], a[32:35]
s_add_u32 s72, s71, 95232
buffer_load_dwordx4 v7, s[12:15], s72 offen offset:3072 lds
v_mfma_f32_16x16x32_bf16 a[64:67], v[232:235], v[192:195], a[64:67]
ds_read_b64_tr_b16 v[168:169], v22 offset:32768
v_mfma_f32_16x16x32_bf16 a[68:71], v[232:235], v[196:199], a[68:71]
ds_read_b64_tr_b16 v[170:171], v22 offset:33792
v_mfma_f32_16x16x32_bf16 a[72:75], v[232:235], v[200:203], a[72:75]
ds_read_b64_tr_b16 v[172:173], v23 offset:32768
v_mfma_f32_16x16x32_bf16 a[76:79], v[232:235], v[204:207], a[76:79]
ds_read_b64_tr_b16 v[174:175], v23 offset:33792
v_mfma_f32_16x16x32_bf16 a[80:83], v[232:235], v[208:211], a[80:83]
s_add_u32 m0, s63, 131072
ds_read_b64_tr_b16 v[176:177], v20 offset:49152
v_mfma_f32_16x16x32_bf16 a[84:87], v[232:235], v[212:215], a[84:87]
s_add_u32 s72, s69, 0
buffer_load_dwordx4 v4, s[4:7], s72 offen lds
v_mfma_f32_16x16x32_bf16 a[88:91], v[232:235], v[216:219], a[88:91]
ds_read_b64_tr_b16 v[178:179], v20 offset:50176
v_mfma_f32_16x16x32_bf16 a[92:95], v[232:235], v[220:223], a[92:95]
ds_read_b64_tr_b16 v[180:181], v21 offset:49152
v_mfma_f32_16x16x32_bf16 a[124:127], v[236:239], v[220:223], a[124:127]
ds_read_b64_tr_b16 v[182:183], v21 offset:50176
v_mfma_f32_16x16x32_bf16 a[120:123], v[236:239], v[216:219], a[120:123]
s_add_u32 s72, s69, 15360
buffer_load_dwordx4 v5, s[4:7], s72 offen offset:1024 lds
v_mfma_f32_16x16x32_bf16 a[116:119], v[236:239], v[212:215], a[116:119]
ds_read_b64_tr_b16 v[184:185], v22 offset:49152
v_mfma_f32_16x16x32_bf16 a[112:115], v[236:239], v[208:211], a[112:115]
ds_read_b64_tr_b16 v[186:187], v22 offset:50176
v_mfma_f32_16x16x32_bf16 a[108:111], v[236:239], v[204:207], a[108:111]
ds_read_b64_tr_b16 v[188:189], v23 offset:49152
v_mfma_f32_16x16x32_bf16 a[104:107], v[236:239], v[200:203], a[104:107]
ds_read_b64_tr_b16 v[190:191], v23 offset:50176
v_mfma_f32_16x16x32_bf16 a[100:103], v[236:239], v[196:199], a[100:103]
s_add_u32 s72, s69, 30720
buffer_load_dwordx4 v4, s[4:7], s72 offen offset:2048 lds
v_mfma_f32_16x16x32_bf16 a[96:99], v[236:239], v[192:195], a[96:99]
v_mfma_f32_16x16x32_bf16 a[128:131], v[192:195], v[240:243], a[128:131]
v_mfma_f32_16x16x32_bf16 a[132:135], v[196:199], v[240:243], a[132:135]
v_mfma_f32_16x16x32_bf16 a[136:139], v[200:203], v[240:243], a[136:139]
v_mfma_f32_16x16x32_bf16 a[140:143], v[204:207], v[240:243], a[140:143]
s_add_u32 s72, s69, 46080
buffer_load_dwordx4 v5, s[4:7], s72 offen offset:3072 lds
v_mfma_f32_16x16x32_bf16 a[144:147], v[208:211], v[240:243], a[144:147]
v_mfma_f32_16x16x32_bf16 a[148:151], v[212:215], v[240:243], a[148:151]
v_mfma_f32_16x16x32_bf16 a[152:155], v[216:219], v[240:243], a[152:155]
v_mfma_f32_16x16x32_bf16 a[156:159], v[220:223], v[240:243], a[156:159]
v_mfma_f32_16x16x32_bf16 a[188:191], v[220:223], v[244:247], a[188:191]
s_add_u32 m0, s63, 135168
v_mfma_f32_16x16x32_bf16 a[184:187], v[216:219], v[244:247], a[184:187]
s_add_u32 s72, s70, 0
buffer_load_dwordx4 v4, s[4:7], s72 offen lds
v_mfma_f32_16x16x32_bf16 a[180:183], v[212:215], v[244:247], a[180:183]
v_mfma_f32_16x16x32_bf16 a[176:179], v[208:211], v[244:247], a[176:179]
v_mfma_f32_16x16x32_bf16 a[172:175], v[204:207], v[244:247], a[172:175]
v_mfma_f32_16x16x32_bf16 a[168:171], v[200:203], v[244:247], a[168:171]
s_add_u32 s72, s70, 15360
buffer_load_dwordx4 v5, s[4:7], s72 offen offset:1024 lds
v_mfma_f32_16x16x32_bf16 a[164:167], v[196:199], v[244:247], a[164:167]
v_mfma_f32_16x16x32_bf16 a[160:163], v[192:195], v[244:247], a[160:163]
v_mfma_f32_16x16x32_bf16 a[192:195], v[192:195], v[248:251], a[192:195]
v_mfma_f32_16x16x32_bf16 a[196:199], v[196:199], v[248:251], a[196:199]
v_mfma_f32_16x16x32_bf16 a[200:203], v[200:203], v[248:251], a[200:203]
s_add_u32 s72, s70, 30720
buffer_load_dwordx4 v4, s[4:7], s72 offen offset:2048 lds
v_mfma_f32_16x16x32_bf16 a[204:207], v[204:207], v[248:251], a[204:207]
v_mfma_f32_16x16x32_bf16 a[208:211], v[208:211], v[248:251], a[208:211]
v_mfma_f32_16x16x32_bf16 a[212:215], v[212:215], v[248:251], a[212:215]
v_mfma_f32_16x16x32_bf16 a[216:219], v[216:219], v[248:251], a[216:219]
v_mfma_f32_16x16x32_bf16 a[220:223], v[220:223], v[248:251], a[220:223]
s_add_u32 s72, s70, 46080
buffer_load_dwordx4 v5, s[4:7], s72 offen offset:3072 lds
v_mfma_f32_16x16x32_bf16 a[252:255], v[220:223], v[252:255], a[252:255]
v_mfma_f32_16x16x32_bf16 a[248:251], v[216:219], v[252:255], a[248:251]
v_mfma_f32_16x16x32_bf16 a[244:247], v[212:215], v[252:255], a[244:247]
v_mfma_f32_16x16x32_bf16 a[240:243], v[208:211], v[252:255], a[240:243]
v_mfma_f32_16x16x32_bf16 a[236:239], v[204:207], v[252:255], a[236:239]
s_add_u32 s73, s62, 1
v_mfma_f32_16x16x32_bf16 a[232:235], v[200:203], v[252:255], a[232:235]
s_add_u32 s70, s73, s65
v_mfma_f32_16x16x32_bf16 a[228:231], v[196:199], v[252:255], a[228:231]
s_and_b32 s70, s70, 3
v_mfma_f32_16x16x32_bf16 a[224:227], v[192:195], v[252:255], a[224:227]
s_waitcnt lgkmcnt(0)
v_mfma_f32_16x16x32_bf16 a[0:3], v[160:163], v[128:131], a[0:3]
s_and_b32 s73, s73, 12
ds_read_b64_tr_b16 v[224:225], v20 offset:40960
v_mfma_f32_16x16x32_bf16 a[4:7], v[160:163], v[132:135], a[4:7]
s_or_b32 s73, s73, s70
ds_read_b64_tr_b16 v[226:227], v20 offset:41984
v_mfma_f32_16x16x32_bf16 a[8:11], v[160:163], v[136:139], a[8:11]
s_lshl_b32 s71, s73, 19
ds_read_b128 v[192:195], v25 offset:32768
v_mfma_f32_16x16x32_bf16 a[12:15], v[160:163], v[140:143], a[12:15]
s_add_u32 s71, s71, s66
ds_read_b128 v[196:199], v25 offset:34816
v_mfma_f32_16x16x32_bf16 a[16:19], v[160:163], v[144:147], a[16:19]
s_lshl_b32 s73, s73, 7
ds_read_b128 v[200:203], v25 offset:36864
v_mfma_f32_16x16x32_bf16 a[20:23], v[160:163], v[148:151], a[20:23]
s_add_u32 s69, s73, s67
ds_read_b128 v[204:207], v25 offset:38912
v_mfma_f32_16x16x32_bf16 a[24:27], v[160:163], v[152:155], a[24:27]
s_add_u32 s70, s73, s68
ds_read_b128 v[208:211], v25 offset:40960
v_mfma_f32_16x16x32_bf16 a[28:31], v[160:163], v[156:159], a[28:31]
s_add_u32 m0, s64, 16384
ds_read_b128 v[212:215], v25 offset:43008
v_mfma_f32_16x16x32_bf16 a[60:63], v[164:167], v[156:159], a[60:63]
s_add_u32 s72, s71, 0
buffer_load_dwordx4 v6, s[12:15], s72 offen lds
v_mfma_f32_16x16x32_bf16 a[56:59], v[164:167], v[152:155], a[56:59]
s_add_u32 s72, s71, 31744
buffer_load_dwordx4 v6, s[12:15], s72 offen offset:1024 lds
v_mfma_f32_16x16x32_bf16 a[52:55], v[164:167], v[148:151], a[52:55]
s_add_u32 s72, s71, 63488
buffer_load_dwordx4 v7, s[12:15], s72 offen offset:2048 lds
v_mfma_f32_16x16x32_bf16 a[48:51], v[164:167], v[144:147], a[48:51]
s_add_u32 s72, s71, 95232
buffer_load_dwordx4 v7, s[12:15], s72 offen offset:3072 lds
v_mfma_f32_16x16x32_bf16 a[44:47], v[164:167], v[140:143], a[44:47]
ds_read_b128 v[216:219], v25 offset:45056
v_mfma_f32_16x16x32_bf16 a[40:43], v[164:167], v[136:139], a[40:43]
ds_read_b128 v[220:223], v25 offset:47104
v_mfma_f32_16x16x32_bf16 a[36:39], v[164:167], v[132:135], a[36:39]
ds_read_b64_tr_b16 v[228:229], v21 offset:40960
v_mfma_f32_16x16x32_bf16 a[32:35], v[164:167], v[128:131], a[32:35]
ds_read_b64_tr_b16 v[230:231], v21 offset:41984
v_mfma_f32_16x16x32_bf16 a[64:67], v[168:171], v[128:131], a[64:67]
s_add_u32 m0, s63, 65536
ds_read_b64_tr_b16 v[232:233], v22 offset:40960
v_mfma_f32_16x16x32_bf16 a[68:71], v[168:171], v[132:135], a[68:71]
s_add_u32 s72, s69, 0
buffer_load_dwordx4 v4, s[4:7], s72 offen lds
v_mfma_f32_16x16x32_bf16 a[72:75], v[168:171], v[136:139], a[72:75]
ds_read_b64_tr_b16 v[234:235], v22 offset:41984
v_mfma_f32_16x16x32_bf16 a[76:79], v[168:171], v[140:143], a[76:79]
ds_read_b64_tr_b16 v[236:237], v23 offset:40960
v_mfma_f32_16x16x32_bf16 a[80:83], v[168:171], v[144:147], a[80:83]
ds_read_b64_tr_b16 v[238:239], v23 offset:41984
v_mfma_f32_16x16x32_bf16 a[84:87], v[168:171], v[148:151], a[84:87]
s_add_u32 s72, s69, 15360
buffer_load_dwordx4 v5, s[4:7], s72 offen offset:1024 lds
v_mfma_f32_16x16x32_bf16 a[88:91], v[168:171], v[152:155], a[88:91]
ds_read_b64_tr_b16 v[240:241], v20 offset:57344
v_mfma_f32_16x16x32_bf16 a[92:95], v[168:171], v[156:159], a[92:95]
ds_read_b64_tr_b16 v[242:243], v20 offset:58368
v_mfma_f32_16x16x32_bf16 a[124:127], v[172:175], v[156:159], a[124:127]
ds_read_b64_tr_b16 v[244:245], v21 offset:57344
v_mfma_f32_16x16x32_bf16 a[120:123], v[172:175], v[152:155], a[120:123]
ds_read_b64_tr_b16 v[246:247], v21 offset:58368
v_mfma_f32_16x16x32_bf16 a[116:119], v[172:175], v[148:151], a[116:119]
s_add_u32 s72, s69, 30720
buffer_load_dwordx4 v4, s[4:7], s72 offen offset:2048 lds
v_mfma_f32_16x16x32_bf16 a[112:115], v[172:175], v[144:147], a[112:115]
ds_read_b64_tr_b16 v[248:249], v22 offset:57344
v_mfma_f32_16x16x32_bf16 a[108:111], v[172:175], v[140:143], a[108:111]
ds_read_b64_tr_b16 v[250:251], v22 offset:58368
v_mfma_f32_16x16x32_bf16 a[104:107], v[172:175], v[136:139], a[104:107]
ds_read_b64_tr_b16 v[252:253], v23 offset:57344
v_mfma_f32_16x16x32_bf16 a[100:103], v[172:175], v[132:135], a[100:103]
ds_read_b64_tr_b16 v[254:255], v23 offset:58368
v_mfma_f32_16x16x32_bf16 a[96:99], v[172:175], v[128:131], a[96:99]
s_add_u32 s72, s69, 46080
buffer_load_dwordx4 v5, s[4:7], s72 offen offset:3072 lds
v_mfma_f32_16x16x32_bf16 a[128:131], v[128:131], v[176:179], a[128:131]
v_mfma_f32_16x16x32_bf16 a[132:135], v[132:135], v[176:179], a[132:135]
v_mfma_f32_16x16x32_bf16 a[136:139], v[136:139], v[176:179], a[136:139]
v_mfma_f32_16x16x32_bf16 a[140:143], v[140:143], v[176:179], a[140:143]
v_mfma_f32_16x16x32_bf16 a[144:147], v[144:147], v[176:179], a[144:147]
s_add_u32 m0, s63, 69632
v_mfma_f32_16x16x32_bf16 a[148:151], v[148:151], v[176:179], a[148:151]
s_add_u32 s72, s70, 0
buffer_load_dwordx4 v4, s[4:7], s72 offen lds
v_mfma_f32_16x16x32_bf16 a[152:155], v[152:155], v[176:179], a[152:155]
v_mfma_f32_16x16x32_bf16 a[156:159], v[156:159], v[176:179], a[156:159]
v_mfma_f32_16x16x32_bf16 a[188:191], v[156:159], v[180:183], a[188:191]
v_mfma_f32_16x16x32_bf16 a[184:187], v[152:155], v[180:183], a[184:187]
s_add_u32 s72, s70, 15360
buffer_load_dwordx4 v5, s[4:7], s72 offen offset:1024 lds
v_mfma_f32_16x16x32_bf16 a[180:183], v[148:151], v[180:183], a[180:183]
v_mfma_f32_16x16x32_bf16 a[176:179], v[144:147], v[180:183], a[176:179]
v_mfma_f32_16x16x32_bf16 a[172:175], v[140:143], v[180:183], a[172:175]
v_mfma_f32_16x16x32_bf16 a[168:171], v[136:139], v[180:183], a[168:171]
v_mfma_f32_16x16x32_bf16 a[164:167], v[132:135], v[180:183], a[164:167]
s_add_u32 s72, s70, 30720
buffer_load_dwordx4 v4, s[4:7], s72 offen offset:2048 lds
v_mfma_f32_16x16x32_bf16 a[160:163], v[128:131], v[180:183], a[160:163]
v_mfma_f32_16x16x32_bf16 a[192:195], v[128:131], v[184:187], a[192:195]
v_mfma_f32_16x16x32_bf16 a[196:199], v[132:135], v[184:187], a[196:199]
v_mfma_f32_16x16x32_bf16 a[200:203], v[136:139], v[184:187], a[200:203]
v_mfma_f32_16x16x32_bf16 a[204:207], v[140:143], v[184:187], a[204:207]
s_add_u32 s72, s70, 46080
buffer_load_dwordx4 v5, s[4:7], s72 offen offset:3072 lds
v_mfma_f32_16x16x32_bf16 a[208:211], v[144:147], v[184:187], a[208:211]
v_mfma_f32_16x16x32_bf16 a[212:215], v[148:151], v[184:187], a[212:215]
v_mfma_f32_16x16x32_bf16 a[216:219], v[152:155], v[184:187], a[216:219]
v_mfma_f32_16x16x32_bf16 a[220:223], v[156:159], v[184:187], a[220:223]
v_mfma_f32_16x16x32_bf16 a[252:255], v[156:159], v[188:191], a[252:255]
v_mfma_f32_16x16x32_bf16 a[248:251], v[152:155], v[188:191], a[248:251]
v_mfma_f32_16x16x32_bf16 a[244:247], v[148:151], v[188:191], a[244:247]
v_mfma_f32_16x16x32_bf16 a[240:243], v[144:147], v[188:191], a[240:243]
v_mfma_f32_16x16x32_bf16 a[236:239], v[140:143], v[188:191], a[236:239]
v_mfma_f32_16x16x32_bf16 a[232:235], v[136:139], v[188:191], a[232:235]
v_mfma_f32_16x16x32_bf16 a[228:231], v[132:135], v[188:191], a[228:231]
s_waitcnt vmcnt(12) lgkmcnt(0)
v_mfma_f32_16x16x32_bf16 a[224:227], v[128:131], v[188:191], a[224:227]
s_barrier
LcB0:
v_mfma_f32_16x16x32_bf16 a[0:3], v[224:227], v[192:195], a[0:3]
s_add_u32 s73, s62, 2
ds_read_b64_tr_b16 v[32:33], v8 offset:0
v_mfma_f32_16x16x32_bf16 a[4:7], v[224:227], v[196:199], a[4:7]
s_add_u32 s70, s73, s65
ds_read_b64_tr_b16 v[34:35], v8 offset:1024
v_mfma_f32_16x16x32_bf16 a[8:11], v[224:227], v[200:203], a[8:11]
s_and_b32 s70, s70, 3
ds_read_b128 v[64:67], v16 offset:0
v_mfma_f32_16x16x32_bf16 a[12:15], v[224:227], v[204:207], a[12:15]
s_and_b32 s73, s73, 12
ds_read_b128 v[68:71], v16 offset:2048
v_mfma_f32_16x16x32_bf16 a[16:19], v[224:227], v[208:211], a[16:19]
s_or_b32 s73, s73, s70
ds_read_b128 v[72:75], v16 offset:4096
v_mfma_f32_16x16x32_bf16 a[20:23], v[224:227], v[212:215], a[20:23]
s_lshl_b32 s71, s73, 19
ds_read_b128 v[76:79], v16 offset:6144
v_mfma_f32_16x16x32_bf16 a[24:27], v[224:227], v[216:219], a[24:27]
s_add_u32 s71, s71, s66
ds_read_b64_tr_b16 v[36:37], v9 offset:0
v_mfma_f32_16x16x32_bf16 a[28:31], v[224:227], v[220:223], a[28:31]
s_lshl_b32 s73, s73, 7
ds_read_b64_tr_b16 v[38:39], v9 offset:1024
v_mfma_f32_16x16x32_bf16 a[60:63], v[228:231], v[220:223], a[60:63]
s_add_u32 s69, s73, s67
ds_read_b64_tr_b16 v[40:41], v10 offset:0
v_mfma_f32_16x16x32_bf16 a[56:59], v[228:231], v[216:219], a[56:59]
s_add_u32 s70, s73, s68
ds_read_b64_tr_b16 v[42:43], v10 offset:1024
v_mfma_f32_16x16x32_bf16 a[52:55], v[228:231], v[212:215], a[52:55]
s_add_u32 m0, s64, 32768
ds_read_b64_tr_b16 v[44:45], v11 offset:0
v_mfma_f32_16x16x32_bf16 a[48:51], v[228:231], v[208:211], a[48:51]
s_add_u32 s72, s71, 0
buffer_load_dwordx4 v6, s[12:15], s72 offen lds
v_mfma_f32_16x16x32_bf16 a[44:47], v[228:231], v[204:207], a[44:47]
s_add_u32 s72, s71, 31744
buffer_load_dwordx4 v6, s[12:15], s72 offen offset:1024 lds
v_mfma_f32_16x16x32_bf16 a[40:43], v[228:231], v[200:203], a[40:43]
s_add_u32 s72, s71, 63488
buffer_load_dwordx4 v7, s[12:15], s72 offen offset:2048 lds
v_mfma_f32_16x16x32_bf16 a[36:39], v[228:231], v[196:199], a[36:39]
s_lshl_b32 s80, s59, 2
ds_read_b64_tr_b16 v[46:47], v11 offset:1024
v_or_b32 v26, s58, v0
v_mfma_f32_16x16x32_bf16 a[32:35], v[228:231], v[192:195], a[32:35]
s_add_u32 s72, s71, 95232
buffer_load_dwordx4 v7, s[12:15], s72 offen offset:3072 lds
v_mfma_f32_16x16x32_bf16 a[64:67], v[232:235], v[192:195], a[64:67]
ds_read_b64_tr_b16 v[48:49], v12 offset:0
v_mov_b32 v27, 1
v_mfma_f32_16x16x32_bf16 a[68:71], v[232:235], v[196:199], a[68:71]
ds_read_b64_tr_b16 v[50:51], v12 offset:1024
v_lshlrev_b32 v26, 8, v26
v_mfma_f32_16x16x32_bf16 a[72:75], v[232:235], v[200:203], a[72:75]
ds_read_b64_tr_b16 v[52:53], v13 offset:0
v_mfma_f32_16x16x32_bf16 a[76:79], v[232:235], v[204:207], a[76:79]
ds_read_b64_tr_b16 v[54:55], v13 offset:1024
v_mfma_f32_16x16x32_bf16 a[80:83], v[232:235], v[208:211], a[80:83]
s_add_u32 m0, s63, 98304
ds_read_b64_tr_b16 v[56:57], v14 offset:0
v_mfma_f32_16x16x32_bf16 a[84:87], v[232:235], v[212:215], a[84:87]
s_add_u32 s72, s69, 0
buffer_load_dwordx4 v4, s[4:7], s72 offen lds
v_mfma_f32_16x16x32_bf16 a[88:91], v[232:235], v[216:219], a[88:91]
ds_read_b64_tr_b16 v[58:59], v14 offset:1024
v_mfma_f32_16x16x32_bf16 a[92:95], v[232:235], v[220:223], a[92:95]
ds_read_b64_tr_b16 v[60:61], v15 offset:0
v_mfma_f32_16x16x32_bf16 a[124:127], v[236:239], v[220:223], a[124:127]
ds_read_b64_tr_b16 v[62:63], v15 offset:1024
v_mfma_f32_16x16x32_bf16 a[120:123], v[236:239], v[216:219], a[120:123]
s_add_u32 s72, s69, 15360
buffer_load_dwordx4 v5, s[4:7], s72 offen offset:1024 lds
v_mfma_f32_16x16x32_bf16 a[116:119], v[236:239], v[212:215], a[116:119]
buffer_atomic_add v27, v26, s[48:51], s80 offen sc1
v_mfma_f32_16x16x32_bf16 a[112:115], v[236:239], v[208:211], a[112:115]
v_mfma_f32_16x16x32_bf16 a[108:111], v[236:239], v[204:207], a[108:111]
v_mfma_f32_16x16x32_bf16 a[104:107], v[236:239], v[200:203], a[104:107]
v_mfma_f32_16x16x32_bf16 a[100:103], v[236:239], v[196:199], a[100:103]
s_add_u32 s72, s69, 30720
buffer_load_dwordx4 v4, s[4:7], s72 offen offset:2048 lds
v_mfma_f32_16x16x32_bf16 a[96:99], v[236:239], v[192:195], a[96:99]
v_mfma_f32_16x16x32_bf16 a[128:131], v[192:195], v[240:243], a[128:131]
v_mfma_f32_16x16x32_bf16 a[132:135], v[196:199], v[240:243], a[132:135]
v_mfma_f32_16x16x32_bf16 a[136:139], v[200:203], v[240:243], a[136:139]
v_mfma_f32_16x16x32_bf16 a[140:143], v[204:207], v[240:243], a[140:143]
s_add_u32 s72, s69, 46080
buffer_load_dwordx4 v5, s[4:7], s72 offen offset:3072 lds
v_mfma_f32_16x16x32_bf16 a[144:147], v[208:211], v[240:243], a[144:147]
v_mfma_f32_16x16x32_bf16 a[148:151], v[212:215], v[240:243], a[148:151]
v_mfma_f32_16x16x32_bf16 a[152:155], v[216:219], v[240:243], a[152:155]
v_mfma_f32_16x16x32_bf16 a[156:159], v[220:223], v[240:243], a[156:159]
v_mfma_f32_16x16x32_bf16 a[188:191], v[220:223], v[244:247], a[188:191]
s_add_u32 m0, s63, 102400
v_mfma_f32_16x16x32_bf16 a[184:187], v[216:219], v[244:247], a[184:187]
s_add_u32 s72, s70, 0
buffer_load_dwordx4 v4, s[4:7], s72 offen lds
v_mfma_f32_16x16x32_bf16 a[180:183], v[212:215], v[244:247], a[180:183]
v_mfma_f32_16x16x32_bf16 a[176:179], v[208:211], v[244:247], a[176:179]
v_mfma_f32_16x16x32_bf16 a[172:175], v[204:207], v[244:247], a[172:175]
v_mfma_f32_16x16x32_bf16 a[168:171], v[200:203], v[244:247], a[168:171]
s_add_u32 s72, s70, 15360
buffer_load_dwordx4 v5, s[4:7], s72 offen offset:1024 lds
v_mfma_f32_16x16x32_bf16 a[164:167], v[196:199], v[244:247], a[164:167]
v_mfma_f32_16x16x32_bf16 a[160:163], v[192:195], v[244:247], a[160:163]
v_mfma_f32_16x16x32_bf16 a[192:195], v[192:195], v[248:251], a[192:195]
v_mfma_f32_16x16x32_bf16 a[196:199], v[196:199], v[248:251], a[196:199]
v_mfma_f32_16x16x32_bf16 a[200:203], v[200:203], v[248:251], a[200:203]
s_add_u32 s72, s70, 30720
buffer_load_dwordx4 v4, s[4:7], s72 offen offset:2048 lds
v_mfma_f32_16x16x32_bf16 a[204:207], v[204:207], v[248:251], a[204:207]
v_mfma_f32_16x16x32_bf16 a[208:211], v[208:211], v[248:251], a[208:211]
v_mfma_f32_16x16x32_bf16 a[212:215], v[212:215], v[248:251], a[212:215]
v_mfma_f32_16x16x32_bf16 a[216:219], v[216:219], v[248:251], a[216:219]
v_mfma_f32_16x16x32_bf16 a[220:223], v[220:223], v[248:251], a[220:223]
s_add_u32 s72, s70, 46080
buffer_load_dwordx4 v5, s[4:7], s72 offen offset:3072 lds
v_mfma_f32_16x16x32_bf16 a[252:255], v[220:223], v[252:255], a[252:255]
v_mfma_f32_16x16x32_bf16 a[248:251], v[216:219], v[252:255], a[248:251]
v_mfma_f32_16x16x32_bf16 a[244:247], v[212:215], v[252:255], a[244:247]
v_mfma_f32_16x16x32_bf16 a[240:243], v[208:211], v[252:255], a[240:243]
v_mfma_f32_16x16x32_bf16 a[236:239], v[204:207], v[252:255], a[236:239]
v_mfma_f32_16x16x32_bf16 a[232:235], v[200:203], v[252:255], a[232:235]
v_mfma_f32_16x16x32_bf16 a[228:231], v[196:199], v[252:255], a[228:231]
v_mfma_f32_16x16x32_bf16 a[224:227], v[192:195], v[252:255], a[224:227]
s_waitcnt lgkmcnt(0)
v_mfma_f32_16x16x32_bf16 v[128:131], v[32:35], v[64:67], 0
ds_read_b64_tr_b16 v[80:81], v8 offset:8192
ds_read_b64_tr_b16 v[82:83], v8 offset:9216
v_mfma_f32_16x16x32_bf16 v[132:135], v[32:35], v[68:71], 0
ds_read_b128 v[112:115], v17 offset:0
ds_read_b128 v[116:119], v17 offset:2048
v_mfma_f32_16x16x32_bf16 v[136:139], v[32:35], v[72:75], 0
ds_read_b128 v[120:123], v17 offset:4096
ds_read_b128 v[124:127], v17 offset:6144
v_mfma_f32_16x16x32_bf16 v[140:143], v[32:35], v[76:79], 0
ds_read_b64_tr_b16 v[84:85], v9 offset:8192
ds_read_b64_tr_b16 v[86:87], v9 offset:9216
v_mfma_f32_16x16x32_bf16 v[156:159], v[36:39], v[76:79], 0
ds_read_b64_tr_b16 v[88:89], v10 offset:8192
v_accvgpr_read_b32 v20, a0
v_mfma_f32_16x16x32_bf16 v[152:155], v[36:39], v[72:75], 0
ds_read_b64_tr_b16 v[90:91], v10 offset:9216
v_accvgpr_read_b32 v28, a1
v_mfma_f32_16x16x32_bf16 v[148:151], v[36:39], v[68:71], 0
ds_read_b64_tr_b16 v[92:93], v11 offset:8192
v_accvgpr_read_b32 v21, a2
v_mfma_f32_16x16x32_bf16 v[144:147], v[36:39], v[64:67], 0
ds_read_b64_tr_b16 v[94:95], v11 offset:9216
v_accvgpr_read_b32 v29, a3
v_mfma_f32_16x16x32_bf16 v[160:163], v[40:43], v[64:67], 0
s_add_u32 s80, s77, 0
ds_read_b64_tr_b16 v[96:97], v12 offset:8192
v_accvgpr_read_b32 v22, a32
v_mfma_f32_16x16x32_bf16 v[164:167], v[40:43], v[68:71], 0
ds_read_b64_tr_b16 v[98:99], v12 offset:9216
v_accvgpr_read_b32 v30, a33
v_mfma_f32_16x16x32_bf16 v[168:171], v[40:43], v[72:75], 0
ds_read_b64_tr_b16 v[100:101], v13 offset:8192
v_accvgpr_read_b32 v23, a34
v_mfma_f32_16x16x32_bf16 v[172:175], v[40:43], v[76:79], 0
ds_read_b64_tr_b16 v[102:103], v13 offset:9216
v_accvgpr_read_b32 v31, a35
v_mfma_f32_16x16x32_bf16 v[188:191], v[44:47], v[76:79], 0
ds_read_b64_tr_b16 v[104:105], v14 offset:8192
v_mul_f32 v20, s79, v20
v_mfma_f32_16x16x32_bf16 v[184:187], v[44:47], v[72:75], 0
ds_read_b64_tr_b16 v[106:107], v14 offset:9216
v_mul_f32 v28, s79, v28
v_mfma_f32_16x16x32_bf16 v[180:183], v[44:47], v[68:71], 0
ds_read_b64_tr_b16 v[108:109], v15 offset:8192
v_mul_f32 v21, s79, v21
v_mfma_f32_16x16x32_bf16 v[176:179], v[44:47], v[64:67], 0
ds_read_b64_tr_b16 v[110:111], v15 offset:9216
v_mul_f32 v29, s79, v29
v_mfma_f32_16x16x32_bf16 v[192:195], v[48:51], v[64:67], 0
v_mul_f32 v22, s79, v22
v_mul_f32 v30, s79, v30
v_mfma_f32_16x16x32_bf16 v[196:199], v[48:51], v[68:71], 0
v_mul_f32 v23, s79, v23
v_mul_f32 v31, s79, v31
v_mfma_f32_16x16x32_bf16 v[200:203], v[48:51], v[72:75], 0
v_cvt_pk_bf16_f32 v20, v20, v28
v_cvt_pk_bf16_f32 v21, v21, v29
v_mfma_f32_16x16x32_bf16 v[204:207], v[48:51], v[76:79], 0
v_cvt_pk_bf16_f32 v22, v22, v30
v_cvt_pk_bf16_f32 v23, v23, v31
v_mfma_f32_16x16x32_bf16 v[220:223], v[52:55], v[76:79], 0
buffer_store_dwordx4 v[20:23], v1, s[44:47], s80 offen sc1
v_mfma_f32_16x16x32_bf16 v[216:219], v[52:55], v[72:75], 0
v_mfma_f32_16x16x32_bf16 v[212:215], v[52:55], v[68:71], 0
v_mfma_f32_16x16x32_bf16 v[208:211], v[52:55], v[64:67], 0
v_mfma_f32_16x16x32_bf16 v[224:227], v[56:59], v[64:67], 0
v_mfma_f32_16x16x32_bf16 v[228:231], v[56:59], v[68:71], 0
v_accvgpr_read_b32 v24, a128
v_accvgpr_read_b32 v28, a129
v_mfma_f32_16x16x32_bf16 v[232:235], v[56:59], v[72:75], 0
v_accvgpr_read_b32 v25, a130
v_accvgpr_read_b32 v29, a131
v_mfma_f32_16x16x32_bf16 v[236:239], v[56:59], v[76:79], 0
s_add_u32 s80, s78, 0
v_accvgpr_read_b32 v26, a132
v_accvgpr_read_b32 v30, a133
v_mfma_f32_16x16x32_bf16 v[252:255], v[60:63], v[76:79], 0
v_accvgpr_read_b32 v27, a134
v_accvgpr_read_b32 v31, a135
v_mfma_f32_16x16x32_bf16 v[248:251], v[60:63], v[72:75], 0
v_cvt_pk_bf16_f32 v24, v24, v28
v_cvt_pk_bf16_f32 v25, v25, v29
v_mfma_f32_16x16x32_bf16 v[244:247], v[60:63], v[68:71], 0
s_waitcnt vmcnt(14) lgkmcnt(0)
v_cvt_pk_bf16_f32 v26, v26, v30
v_cvt_pk_bf16_f32 v27, v27, v31
v_mfma_f32_16x16x32_bf16 v[240:243], v[60:63], v[64:67], 0
s_barrier
buffer_store_dwordx4 v[24:27], v1, s[44:47], s80 offen sc1
v_mfma_f32_16x16x32_bf16 v[128:131], v[80:83], v[112:115], v[128:131]
s_add_u32 s73, s62, 3
ds_read_b64_tr_b16 v[32:33], v8 offset:16384
ds_read_b64_tr_b16 v[34:35], v8 offset:17408
v_mfma_f32_16x16x32_bf16 v[132:135], v[80:83], v[116:119], v[132:135]
s_add_u32 s70, s73, s65
ds_read_b128 v[64:67], v18 offset:0
ds_read_b128 v[68:71], v18 offset:2048
v_mfma_f32_16x16x32_bf16 v[136:139], v[80:83], v[120:123], v[136:139]
s_and_b32 s70, s70, 3
ds_read_b128 v[72:75], v18 offset:4096
ds_read_b128 v[76:79], v18 offset:6144
v_mfma_f32_16x16x32_bf16 v[140:143], v[80:83], v[124:127], v[140:143]
s_and_b32 s73, s73, 12
ds_read_b64_tr_b16 v[36:37], v9 offset:16384
ds_read_b64_tr_b16 v[38:39], v9 offset:17408
v_mfma_f32_16x16x32_bf16 v[156:159], v[84:87], v[124:127], v[156:159]
s_or_b32 s73, s73, s70
ds_read_b64_tr_b16 v[40:41], v10 offset:16384
v_mfma_f32_16x16x32_bf16 v[152:155], v[84:87], v[120:123], v[152:155]
s_lshl_b32 s71, s73, 19
ds_read_b64_tr_b16 v[42:43], v10 offset:17408
v_mfma_f32_16x16x32_bf16 v[148:151], v[84:87], v[116:119], v[148:151]
s_add_u32 s71, s71, s66
ds_read_b64_tr_b16 v[44:45], v11 offset:16384
v_mfma_f32_16x16x32_bf16 v[144:147], v[84:87], v[112:115], v[144:147]
s_lshl_b32 s73, s73, 7
ds_read_b64_tr_b16 v[46:47], v11 offset:17408
v_mfma_f32_16x16x32_bf16 v[160:163], v[88:91], v[112:115], v[160:163]
s_add_u32 s69, s73, s67
ds_read_b64_tr_b16 v[48:49], v12 offset:16384
v_mfma_f32_16x16x32_bf16 v[164:167], v[88:91], v[116:119], v[164:167]
s_add_u32 s70, s73, s68
ds_read_b64_tr_b16 v[50:51], v12 offset:17408
v_mfma_f32_16x16x32_bf16 v[168:171], v[88:91], v[120:123], v[168:171]
s_add_u32 m0, s64, 0
ds_read_b64_tr_b16 v[52:53], v13 offset:16384
v_mfma_f32_16x16x32_bf16 v[172:175], v[88:91], v[124:127], v[172:175]
s_add_u32 s72, s71, 0
buffer_load_dwordx4 v6, s[12:15], s72 offen lds
v_mfma_f32_16x16x32_bf16 v[188:191], v[92:95], v[124:127], v[188:191]
s_add_u32 s72, s71, 31744
buffer_load_dwordx4 v6, s[12:15], s72 offen offset:1024 lds
v_mfma_f32_16x16x32_bf16 v[184:187], v[92:95], v[120:123], v[184:187]
s_add_u32 s72, s71, 63488
buffer_load_dwordx4 v7, s[12:15], s72 offen offset:2048 lds
v_mfma_f32_16x16x32_bf16 v[180:183], v[92:95], v[116:119], v[180:183]
s_add_u32 s72, s71, 95232
buffer_load_dwordx4 v7, s[12:15], s72 offen offset:3072 lds
v_mfma_f32_16x16x32_bf16 v[176:179], v[92:95], v[112:115], v[176:179]
ds_read_b64_tr_b16 v[54:55], v13 offset:17408
v_mfma_f32_16x16x32_bf16 v[192:195], v[96:99], v[112:115], v[192:195]
ds_read_b64_tr_b16 v[56:57], v14 offset:16384
v_mfma_f32_16x16x32_bf16 v[196:199], v[96:99], v[116:119], v[196:199]
ds_read_b64_tr_b16 v[58:59], v14 offset:17408
v_accvgpr_read_b32 v20, a4
v_mfma_f32_16x16x32_bf16 v[200:203], v[96:99], v[120:123], v[200:203]
ds_read_b64_tr_b16 v[60:61], v15 offset:16384
v_accvgpr_read_b32 v28, a5
v_mfma_f32_16x16x32_bf16 v[204:207], v[96:99], v[124:127], v[204:207]
s_add_u32 m0, s63, 131072
ds_read_b64_tr_b16 v[62:63], v15 offset:17408
v_accvgpr_read_b32 v21, a6
v_mfma_f32_16x16x32_bf16 v[220:223], v[100:103], v[124:127], v[220:223]
s_add_u32 s72, s69, 0
buffer_load_dwordx4 v4, s[4:7], s72 offen lds
v_mfma_f32_16x16x32_bf16 v[216:219], v[100:103], v[120:123], v[216:219]
v_accvgpr_read_b32 v29, a7
v_mfma_f32_16x16x32_bf16 v[212:215], v[100:103], v[116:119], v[212:215]
s_add_u32 s80, s77, 4096
v_accvgpr_read_b32 v22, a36
v_accvgpr_read_b32 v30, a37
v_mfma_f32_16x16x32_bf16 v[208:211], v[100:103], v[112:115], v[208:211]
v_accvgpr_read_b32 v23, a38
v_accvgpr_read_b32 v31, a39
v_mfma_f32_16x16x32_bf16 v[224:227], v[104:107], v[112:115], v[224:227]
s_add_u32 s72, s69, 15360
buffer_load_dwordx4 v5, s[4:7], s72 offen offset:1024 lds
v_mfma_f32_16x16x32_bf16 v[228:231], v[104:107], v[116:119], v[228:231]
v_mul_f32 v20, s79, v20
v_mul_f32 v28, s79, v28
v_mfma_f32_16x16x32_bf16 v[232:235], v[104:107], v[120:123], v[232:235]
v_mul_f32 v21, s79, v21
v_mul_f32 v29, s79, v29
v_mfma_f32_16x16x32_bf16 v[236:239], v[104:107], v[124:127], v[236:239]
v_mul_f32 v22, s79, v22
v_mul_f32 v30, s79, v30
v_mfma_f32_16x16x32_bf16 v[252:255], v[108:111], v[124:127], v[252:255]
v_mul_f32 v23, s79, v23
v_mul_f32 v31, s79, v31
v_mfma_f32_16x16x32_bf16 v[248:251], v[108:111], v[120:123], v[248:251]
s_add_u32 s72, s69, 30720
buffer_load_dwordx4 v4, s[4:7], s72 offen offset:2048 lds
v_mfma_f32_16x16x32_bf16 v[244:247], v[108:111], v[116:119], v[244:247]
v_cvt_pk_bf16_f32 v20, v20, v28
v_cvt_pk_bf16_f32 v21, v21, v29
v_mfma_f32_16x16x32_bf16 v[240:243], v[108:111], v[112:115], v[240:243]
s_waitcnt lgkmcnt(0)
v_cvt_pk_bf16_f32 v22, v22, v30
v_cvt_pk_bf16_f32 v23, v23, v31
v_mfma_f32_16x16x32_bf16 v[128:131], v[32:35], v[64:67], v[128:131]
ds_read_b64_tr_b16 v[80:81], v8 offset:24576
ds_read_b64_tr_b16 v[82:83], v8 offset:25600
v_mfma_f32_16x16x32_bf16 v[132:135], v[32:35], v[68:71], v[132:135]
ds_read_b128 v[112:115], v19 offset:0
ds_read_b128 v[116:119], v19 offset:2048
v_mfma_f32_16x16x32_bf16 v[136:139], v[32:35], v[72:75], v[136:139]
s_add_u32 s72, s69, 46080
buffer_load_dwordx4 v5, s[4:7], s72 offen offset:3072 lds
v_mfma_f32_16x16x32_bf16 v[140:143], v[32:35], v[76:79], v[140:143]
ds_read_b128 v[120:123], v19 offset:4096
ds_read_b128 v[124:127], v19 offset:6144
v_mfma_f32_16x16x32_bf16 v[156:159], v[36:39], v[76:79], v[156:159]
ds_read_b64_tr_b16 v[84:85], v9 offset:24576
ds_read_b64_tr_b16 v[86:87], v9 offset:25600
v_mfma_f32_16x16x32_bf16 v[152:155], v[36:39], v[72:75], v[152:155]
ds_read_b64_tr_b16 v[88:89], v10 offset:24576
v_mfma_f32_16x16x32_bf16 v[148:151], v[36:39], v[68:71], v[148:151]
ds_read_b64_tr_b16 v[90:91], v10 offset:25600
v_mfma_f32_16x16x32_bf16 v[144:147], v[36:39], v[64:67], v[144:147]
s_add_u32 m0, s63, 135168
ds_read_b64_tr_b16 v[92:93], v11 offset:24576
v_mfma_f32_16x16x32_bf16 v[160:163], v[40:43], v[64:67], v[160:163]
s_add_u32 s72, s70, 0
buffer_load_dwordx4 v4, s[4:7], s72 offen lds
v_mfma_f32_16x16x32_bf16 v[164:167], v[40:43], v[68:71], v[164:167]
ds_read_b64_tr_b16 v[94:95], v11 offset:25600
v_mfma_f32_16x16x32_bf16 v[168:171], v[40:43], v[72:75], v[168:171]
ds_read_b64_tr_b16 v[96:97], v12 offset:24576
v_mfma_f32_16x16x32_bf16 v[172:175], v[40:43], v[76:79], v[172:175]
ds_read_b64_tr_b16 v[98:99], v12 offset:25600
v_mfma_f32_16x16x32_bf16 v[188:191], v[44:47], v[76:79], v[188:191]
s_add_u32 s72, s70, 15360
buffer_load_dwordx4 v5, s[4:7], s72 offen offset:1024 lds
v_mfma_f32_16x16x32_bf16 v[184:187], v[44:47], v[72:75], v[184:187]
ds_read_b64_tr_b16 v[100:101], v13 offset:24576
v_mfma_f32_16x16x32_bf16 v[180:183], v[44:47], v[68:71], v[180:183]
ds_read_b64_tr_b16 v[102:103], v13 offset:25600
v_mfma_f32_16x16x32_bf16 v[176:179], v[44:47], v[64:67], v[176:179]
ds_read_b64_tr_b16 v[104:105], v14 offset:24576
v_mfma_f32_16x16x32_bf16 v[192:195], v[48:51], v[64:67], v[192:195]
ds_read_b64_tr_b16 v[106:107], v14 offset:25600
v_mfma_f32_16x16x32_bf16 v[196:199], v[48:51], v[68:71], v[196:199]
s_add_u32 s72, s70, 30720
buffer_load_dwordx4 v4, s[4:7], s72 offen offset:2048 lds
v_mfma_f32_16x16x32_bf16 v[200:203], v[48:51], v[72:75], v[200:203]
ds_read_b64_tr_b16 v[108:109], v15 offset:24576
v_mfma_f32_16x16x32_bf16 v[204:207], v[48:51], v[76:79], v[204:207]
ds_read_b64_tr_b16 v[110:111], v15 offset:25600
v_mfma_f32_16x16x32_bf16 v[220:223], v[52:55], v[76:79], v[220:223]
buffer_store_dwordx4 v[20:23], v1, s[44:47], s80 offen sc1
v_mfma_f32_16x16x32_bf16 v[216:219], v[52:55], v[72:75], v[216:219]
v_accvgpr_read_b32 v24, a136
v_accvgpr_read_b32 v28, a137
v_mfma_f32_16x16x32_bf16 v[212:215], v[52:55], v[68:71], v[212:215]
s_add_u32 s72, s70, 46080
buffer_load_dwordx4 v5, s[4:7], s72 offen offset:3072 lds
v_mfma_f32_16x16x32_bf16 v[208:211], v[52:55], v[64:67], v[208:211]
v_accvgpr_read_b32 v25, a138
v_accvgpr_read_b32 v29, a139
v_mfma_f32_16x16x32_bf16 v[224:227], v[56:59], v[64:67], v[224:227]
s_add_u32 s80, s78, 8192
v_accvgpr_read_b32 v26, a140
v_accvgpr_read_b32 v30, a141
v_mfma_f32_16x16x32_bf16 v[228:231], v[56:59], v[68:71], v[228:231]
v_accvgpr_read_b32 v27, a142
v_accvgpr_read_b32 v31, a143
v_mfma_f32_16x16x32_bf16 v[232:235], v[56:59], v[72:75], v[232:235]
v_cvt_pk_bf16_f32 v24, v24, v28
v_cvt_pk_bf16_f32 v25, v25, v29
v_mfma_f32_16x16x32_bf16 v[236:239], v[56:59], v[76:79], v[236:239]
v_cvt_pk_bf16_f32 v26, v26, v30
v_cvt_pk_bf16_f32 v27, v27, v31
v_mfma_f32_16x16x32_bf16 v[252:255], v[60:63], v[76:79], v[252:255]
buffer_store_dwordx4 v[24:27], v1, s[44:47], s80 offen sc1
v_mfma_f32_16x16x32_bf16 v[248:251], v[60:63], v[72:75], v[248:251]
v_mfma_f32_16x16x32_bf16 v[244:247], v[60:63], v[68:71], v[244:247]
s_waitcnt vmcnt(16) lgkmcnt(0)
v_mfma_f32_16x16x32_bf16 v[240:243], v[60:63], v[64:67], v[240:243]
s_barrier
v_mfma_f32_16x16x32_bf16 v[128:131], v[80:83], v[112:115], v[128:131]
s_add_u32 s73, s62, 4
ds_read_b64_tr_b16 v[32:33], v8 offset:32768
ds_read_b64_tr_b16 v[34:35], v8 offset:33792
v_mfma_f32_16x16x32_bf16 v[132:135], v[80:83], v[116:119], v[132:135]
s_add_u32 s70, s73, s65
ds_read_b128 v[64:67], v18 offset:32768
ds_read_b128 v[68:71], v18 offset:34816
v_mfma_f32_16x16x32_bf16 v[136:139], v[80:83], v[120:123], v[136:139]
s_and_b32 s70, s70, 3
ds_read_b128 v[72:75], v18 offset:36864
ds_read_b128 v[76:79], v18 offset:38912
v_mfma_f32_16x16x32_bf16 v[140:143], v[80:83], v[124:127], v[140:143]
s_and_b32 s73, s73, 12
ds_read_b64_tr_b16 v[36:37], v9 offset:32768
ds_read_b64_tr_b16 v[38:39], v9 offset:33792
v_mfma_f32_16x16x32_bf16 v[156:159], v[84:87], v[124:127], v[156:159]
s_or_b32 s73, s73, s70
ds_read_b64_tr_b16 v[40:41], v10 offset:32768
v_accvgpr_read_b32 v20, a8
v_mfma_f32_16x16x32_bf16 v[152:155], v[84:87], v[120:123], v[152:155]
s_lshl_b32 s71, s73, 19
ds_read_b64_tr_b16 v[42:43], v10 offset:33792
v_accvgpr_read_b32 v28, a9
v_mfma_f32_16x16x32_bf16 v[148:151], v[84:87], v[116:119], v[148:151]
s_add_u32 s71, s71, s66
ds_read_b64_tr_b16 v[44:45], v11 offset:32768
v_accvgpr_read_b32 v21, a10
v_mfma_f32_16x16x32_bf16 v[144:147], v[84:87], v[112:115], v[144:147]
s_lshl_b32 s73, s73, 7
ds_read_b64_tr_b16 v[46:47], v11 offset:33792
v_accvgpr_read_b32 v29, a11
v_mfma_f32_16x16x32_bf16 v[160:163], v[88:91], v[112:115], v[160:163]
s_add_u32 s69, s73, s67
ds_read_b64_tr_b16 v[48:49], v12 offset:32768
v_mfma_f32_16x16x32_bf16 v[164:167], v[88:91], v[116:119], v[164:167]
s_add_u32 s70, s73, s68
ds_read_b64_tr_b16 v[50:51], v12 offset:33792
v_mfma_f32_16x16x32_bf16 v[168:171], v[88:91], v[120:123], v[168:171]
s_add_u32 m0, s64, 16384
ds_read_b64_tr_b16 v[52:53], v13 offset:32768
v_mfma_f32_16x16x32_bf16 v[172:175], v[88:91], v[124:127], v[172:175]
s_add_u32 s72, s71, 0
buffer_load_dwordx4 v6, s[12:15], s72 offen lds
v_mfma_f32_16x16x32_bf16 v[188:191], v[92:95], v[124:127], v[188:191]
s_add_u32 s72, s71, 31744
buffer_load_dwordx4 v6, s[12:15], s72 offen offset:1024 lds
v_mfma_f32_16x16x32_bf16 v[184:187], v[92:95], v[120:123], v[184:187]
s_add_u32 s72, s71, 63488
buffer_load_dwordx4 v7, s[12:15], s72 offen offset:2048 lds
v_mfma_f32_16x16x32_bf16 v[180:183], v[92:95], v[116:119], v[180:183]
s_add_u32 s72, s71, 95232
buffer_load_dwordx4 v7, s[12:15], s72 offen offset:3072 lds
v_mfma_f32_16x16x32_bf16 v[176:179], v[92:95], v[112:115], v[176:179]
s_add_u32 s80, s77, 8192
ds_read_b64_tr_b16 v[54:55], v13 offset:33792
v_accvgpr_read_b32 v22, a40
v_mfma_f32_16x16x32_bf16 v[192:195], v[96:99], v[112:115], v[192:195]
ds_read_b64_tr_b16 v[56:57], v14 offset:32768
v_accvgpr_read_b32 v30, a41
v_mfma_f32_16x16x32_bf16 v[196:199], v[96:99], v[116:119], v[196:199]
ds_read_b64_tr_b16 v[58:59], v14 offset:33792
v_accvgpr_read_b32 v23, a42
v_mfma_f32_16x16x32_bf16 v[200:203], v[96:99], v[120:123], v[200:203]
ds_read_b64_tr_b16 v[60:61], v15 offset:32768
v_accvgpr_read_b32 v31, a43
v_mfma_f32_16x16x32_bf16 v[204:207], v[96:99], v[124:127], v[204:207]
s_add_u32 m0, s63, 65536
ds_read_b64_tr_b16 v[62:63], v15 offset:33792
v_mul_f32 v20, s79, v20
v_mfma_f32_16x16x32_bf16 v[220:223], v[100:103], v[124:127], v[220:223]
s_add_u32 s72, s69, 0
buffer_load_dwordx4 v4, s[4:7], s72 offen lds
v_mfma_f32_16x16x32_bf16 v[216:219], v[100:103], v[120:123], v[216:219]
v_mul_f32 v28, s79, v28
v_mul_f32 v21, s79, v21
v_mfma_f32_16x16x32_bf16 v[212:215], v[100:103], v[116:119], v[212:215]
v_mul_f32 v29, s79, v29
v_mul_f32 v22, s79, v22
v_mfma_f32_16x16x32_bf16 v[208:211], v[100:103], v[112:115], v[208:211]
v_mul_f32 v30, s79, v30
v_mul_f32 v23, s79, v23
v_mfma_f32_16x16x32_bf16 v[224:227], v[104:107], v[112:115], v[224:227]
s_add_u32 s72, s69, 15360
buffer_load_dwordx4 v5, s[4:7], s72 offen offset:1024 lds
v_mfma_f32_16x16x32_bf16 v[228:231], v[104:107], v[116:119], v[228:231]
v_mul_f32 v31, s79, v31
v_cvt_pk_bf16_f32 v20, v20, v28
v_mfma_f32_16x16x32_bf16 v[232:235], v[104:107], v[120:123], v[232:235]
v_cvt_pk_bf16_f32 v21, v21, v29
v_cvt_pk_bf16_f32 v22, v22, v30
v_mfma_f32_16x16x32_bf16 v[236:239], v[104:107], v[124:127], v[236:239]
v_cvt_pk_bf16_f32 v23, v23, v31
v_mfma_f32_16x16x32_bf16 v[252:255], v[108:111], v[124:127], v[252:255]
buffer_store_dwordx4 v[20:23], v1, s[44:47], s80 offen sc1
v_mfma_f32_16x16x32_bf16 v[248:251], v[108:111], v[120:123], v[248:251]
s_add_u32 s72, s69, 30720
buffer_load_dwordx4 v4, s[4:7], s72 offen offset:2048 lds
v_mfma_f32_16x16x32_bf16 v[244:247], v[108:111], v[116:119], v[244:247]
v_accvgpr_read_b32 v24, a144
v_accvgpr_read_b32 v28, a145
v_mfma_f32_16x16x32_bf16 v[240:243], v[108:111], v[112:115], v[240:243]
s_waitcnt lgkmcnt(0)
v_accvgpr_read_b32 v25, a146
v_accvgpr_read_b32 v29, a147
v_mfma_f32_16x16x32_bf16 v[128:131], v[32:35], v[64:67], v[128:131]
s_add_u32 s80, s78, 32768
ds_read_b64_tr_b16 v[80:81], v8 offset:40960
ds_read_b64_tr_b16 v[82:83], v8 offset:41984
v_mfma_f32_16x16x32_bf16 v[132:135], v[32:35], v[68:71], v[132:135]
ds_read_b128 v[112:115], v19 offset:32768
ds_read_b128 v[116:119], v19 offset:34816
v_mfma_f32_16x16x32_bf16 v[136:139], v[32:35], v[72:75], v[136:139]
s_add_u32 s72, s69, 46080
buffer_load_dwordx4 v5, s[4:7], s72 offen offset:3072 lds
v_mfma_f32_16x16x32_bf16 v[140:143], v[32:35], v[76:79], v[140:143]
ds_read_b128 v[120:123], v19 offset:36864
ds_read_b128 v[124:127], v19 offset:38912
v_mfma_f32_16x16x32_bf16 v[156:159], v[36:39], v[76:79], v[156:159]
ds_read_b64_tr_b16 v[84:85], v9 offset:40960
ds_read_b64_tr_b16 v[86:87], v9 offset:41984
v_mfma_f32_16x16x32_bf16 v[152:155], v[36:39], v[72:75], v[152:155]
ds_read_b64_tr_b16 v[88:89], v10 offset:40960
v_accvgpr_read_b32 v26, a148
v_mfma_f32_16x16x32_bf16 v[148:151], v[36:39], v[68:71], v[148:151]
ds_read_b64_tr_b16 v[90:91], v10 offset:41984
v_accvgpr_read_b32 v30, a149
v_mfma_f32_16x16x32_bf16 v[144:147], v[36:39], v[64:67], v[144:147]
s_add_u32 m0, s63, 69632
ds_read_b64_tr_b16 v[92:93], v11 offset:40960
v_accvgpr_read_b32 v27, a150
v_mfma_f32_16x16x32_bf16 v[160:163], v[40:43], v[64:67], v[160:163]
s_add_u32 s72, s70, 0
buffer_load_dwordx4 v4, s[4:7], s72 offen lds
v_mfma_f32_16x16x32_bf16 v[164:167], v[40:43], v[68:71], v[164:167]
ds_read_b64_tr_b16 v[94:95], v11 offset:41984
v_accvgpr_read_b32 v31, a151
v_mfma_f32_16x16x32_bf16 v[168:171], v[40:43], v[72:75], v[168:171]
ds_read_b64_tr_b16 v[96:97], v12 offset:40960
v_cvt_pk_bf16_f32 v24, v24, v28
v_mfma_f32_16x16x32_bf16 v[172:175], v[40:43], v[76:79], v[172:175]
ds_read_b64_tr_b16 v[98:99], v12 offset:41984
v_cvt_pk_bf16_f32 v25, v25, v29
v_mfma_f32_16x16x32_bf16 v[188:191], v[44:47], v[76:79], v[188:191]
s_add_u32 s72, s70, 15360
buffer_load_dwordx4 v5, s[4:7], s72 offen offset:1024 lds
v_mfma_f32_16x16x32_bf16 v[184:187], v[44:47], v[72:75], v[184:187]
ds_read_b64_tr_b16 v[100:101], v13 offset:40960
v_cvt_pk_bf16_f32 v26, v26, v30
v_mfma_f32_16x16x32_bf16 v[180:183], v[44:47], v[68:71], v[180:183]
ds_read_b64_tr_b16 v[102:103], v13 offset:41984
v_cvt_pk_bf16_f32 v27, v27, v31
v_mfma_f32_16x16x32_bf16 v[176:179], v[44:47], v[64:67], v[176:179]
ds_read_b64_tr_b16 v[104:105], v14 offset:40960
v_mfma_f32_16x16x32_bf16 v[192:195], v[48:51], v[64:67], v[192:195]
ds_read_b64_tr_b16 v[106:107], v14 offset:41984
v_mfma_f32_16x16x32_bf16 v[196:199], v[48:51], v[68:71], v[196:199]
s_add_u32 s72, s70, 30720
buffer_load_dwordx4 v4, s[4:7], s72 offen offset:2048 lds
v_mfma_f32_16x16x32_bf16 v[200:203], v[48:51], v[72:75], v[200:203]
ds_read_b64_tr_b16 v[108:109], v15 offset:40960
v_mfma_f32_16x16x32_bf16 v[204:207], v[48:51], v[76:79], v[204:207]
ds_read_b64_tr_b16 v[110:111], v15 offset:41984
v_mfma_f32_16x16x32_bf16 v[220:223], v[52:55], v[76:79], v[220:223]
buffer_store_dwordx4 v[24:27], v1, s[44:47], s80 offen sc1
v_mfma_f32_16x16x32_bf16 v[216:219], v[52:55], v[72:75], v[216:219]
v_accvgpr_read_b32 v20, a12
v_accvgpr_read_b32 v28, a13
v_mfma_f32_16x16x32_bf16 v[212:215], v[52:55], v[68:71], v[212:215]
s_add_u32 s72, s70, 46080
buffer_load_dwordx4 v5, s[4:7], s72 offen offset:3072 lds
v_mfma_f32_16x16x32_bf16 v[208:211], v[52:55], v[64:67], v[208:211]
v_accvgpr_read_b32 v21, a14
v_accvgpr_read_b32 v29, a15
v_mfma_f32_16x16x32_bf16 v[224:227], v[56:59], v[64:67], v[224:227]
s_add_u32 s80, s77, 12288
v_accvgpr_read_b32 v22, a44
v_accvgpr_read_b32 v30, a45
v_mfma_f32_16x16x32_bf16 v[228:231], v[56:59], v[68:71], v[228:231]
v_accvgpr_read_b32 v23, a46
v_accvgpr_read_b32 v31, a47
v_mfma_f32_16x16x32_bf16 v[232:235], v[56:59], v[72:75], v[232:235]
v_mul_f32 v20, s79, v20
v_mul_f32 v28, s79, v28
v_mfma_f32_16x16x32_bf16 v[236:239], v[56:59], v[76:79], v[236:239]
v_mul_f32 v21, s79, v21
v_mul_f32 v29, s79, v29
v_mfma_f32_16x16x32_bf16 v[252:255], v[60:63], v[76:79], v[252:255]
v_mul_f32 v22, s79, v22
v_mul_f32 v30, s79, v30
v_mfma_f32_16x16x32_bf16 v[248:251], v[60:63], v[72:75], v[248:251]
v_mul_f32 v23, s79, v23
v_mul_f32 v31, s79, v31
v_mfma_f32_16x16x32_bf16 v[244:247], v[60:63], v[68:71], v[244:247]
s_waitcnt vmcnt(15) lgkmcnt(0)
v_cvt_pk_bf16_f32 v20, v20, v28
v_cvt_pk_bf16_f32 v21, v21, v29
v_mfma_f32_16x16x32_bf16 v[240:243], v[60:63], v[64:67], v[240:243]
s_barrier
v_cvt_pk_bf16_f32 v22, v22, v30
v_cvt_pk_bf16_f32 v23, v23, v31
v_mfma_f32_16x16x32_bf16 v[128:131], v[80:83], v[112:115], v[128:131]
s_add_u32 s73, s62, 5
ds_read_b64_tr_b16 v[32:33], v8 offset:0
ds_read_b64_tr_b16 v[34:35], v8 offset:1024
v_mfma_f32_16x16x32_bf16 v[132:135], v[80:83], v[116:119], v[132:135]
s_add_u32 s70, s73, s65
ds_read_b128 v[64:67], v16 offset:0
ds_read_b128 v[68:71], v16 offset:2048
v_mfma_f32_16x16x32_bf16 v[136:139], v[80:83], v[120:123], v[136:139]
s_and_b32 s70, s70, 3
ds_read_b128 v[72:75], v16 offset:4096
ds_read_b128 v[76:79], v16 offset:6144
v_mfma_f32_16x16x32_bf16 v[140:143], v[80:83], v[124:127], v[140:143]
s_and_b32 s73, s73, 12
ds_read_b64_tr_b16 v[36:37], v9 offset:0
ds_read_b64_tr_b16 v[38:39], v9 offset:1024
v_mfma_f32_16x16x32_bf16 v[156:159], v[84:87], v[124:127], v[156:159]
s_or_b32 s73, s73, s70
ds_read_b64_tr_b16 v[40:41], v10 offset:0
v_mfma_f32_16x16x32_bf16 v[152:155], v[84:87], v[120:123], v[152:155]
s_lshl_b32 s71, s73, 19
ds_read_b64_tr_b16 v[42:43], v10 offset:1024
v_mfma_f32_16x16x32_bf16 v[148:151], v[84:87], v[116:119], v[148:151]
s_add_u32 s71, s71, s66
ds_read_b64_tr_b16 v[44:45], v11 offset:0
v_mfma_f32_16x16x32_bf16 v[144:147], v[84:87], v[112:115], v[144:147]
s_lshl_b32 s73, s73, 7
ds_read_b64_tr_b16 v[46:47], v11 offset:1024
v_mfma_f32_16x16x32_bf16 v[160:163], v[88:91], v[112:115], v[160:163]
s_add_u32 s69, s73, s67
ds_read_b64_tr_b16 v[48:49], v12 offset:0
v_mfma_f32_16x16x32_bf16 v[164:167], v[88:91], v[116:119], v[164:167]
s_add_u32 s70, s73, s68
ds_read_b64_tr_b16 v[50:51], v12 offset:1024
v_mfma_f32_16x16x32_bf16 v[168:171], v[88:91], v[120:123], v[168:171]
s_add_u32 m0, s64, 32768
ds_read_b64_tr_b16 v[52:53], v13 offset:0
v_mfma_f32_16x16x32_bf16 v[172:175], v[88:91], v[124:127], v[172:175]
s_add_u32 s72, s71, 0
buffer_load_dwordx4 v6, s[12:15], s72 offen lds
v_mfma_f32_16x16x32_bf16 v[188:191], v[92:95], v[124:127], v[188:191]
s_add_u32 s72, s71, 31744
buffer_load_dwordx4 v6, s[12:15], s72 offen offset:1024 lds
v_mfma_f32_16x16x32_bf16 v[184:187], v[92:95], v[120:123], v[184:187]
s_add_u32 s72, s71, 63488
buffer_load_dwordx4 v7, s[12:15], s72 offen offset:2048 lds
v_mfma_f32_16x16x32_bf16 v[180:183], v[92:95], v[116:119], v[180:183]
s_add_u32 s72, s71, 95232
buffer_load_dwordx4 v7, s[12:15], s72 offen offset:3072 lds
v_mfma_f32_16x16x32_bf16 v[176:179], v[92:95], v[112:115], v[176:179]
ds_read_b64_tr_b16 v[54:55], v13 offset:1024
v_mfma_f32_16x16x32_bf16 v[192:195], v[96:99], v[112:115], v[192:195]
ds_read_b64_tr_b16 v[56:57], v14 offset:0
v_mfma_f32_16x16x32_bf16 v[196:199], v[96:99], v[116:119], v[196:199]
ds_read_b64_tr_b16 v[58:59], v14 offset:1024
v_mfma_f32_16x16x32_bf16 v[200:203], v[96:99], v[120:123], v[200:203]
ds_read_b64_tr_b16 v[60:61], v15 offset:0
v_mfma_f32_16x16x32_bf16 v[204:207], v[96:99], v[124:127], v[204:207]
s_add_u32 m0, s63, 98304
ds_read_b64_tr_b16 v[62:63], v15 offset:1024
v_mfma_f32_16x16x32_bf16 v[220:223], v[100:103], v[124:127], v[220:223]
s_add_u32 s72, s69, 0
buffer_load_dwordx4 v4, s[4:7], s72 offen lds
v_mfma_f32_16x16x32_bf16 v[216:219], v[100:103], v[120:123], v[216:219]
buffer_store_dwordx4 v[20:23], v1, s[44:47], s80 offen sc1
v_mfma_f32_16x16x32_bf16 v[212:215], v[100:103], v[116:119], v[212:215]
v_accvgpr_read_b32 v24, a152
v_accvgpr_read_b32 v28, a153
v_mfma_f32_16x16x32_bf16 v[208:211], v[100:103], v[112:115], v[208:211]
v_accvgpr_read_b32 v25, a154
v_accvgpr_read_b32 v29, a155
v_mfma_f32_16x16x32_bf16 v[224:227], v[104:107], v[112:115], v[224:227]
s_add_u32 s72, s69, 15360
buffer_load_dwordx4 v5, s[4:7], s72 offen offset:1024 lds
v_mfma_f32_16x16x32_bf16 v[228:231], v[104:107], v[116:119], v[228:231]
s_add_u32 s80, s78, 40960
v_accvgpr_read_b32 v26, a156
v_accvgpr_read_b32 v30, a157
v_mfma_f32_16x16x32_bf16 v[232:235], v[104:107], v[120:123], v[232:235]
v_accvgpr_read_b32 v27, a158
v_accvgpr_read_b32 v31, a159
v_mfma_f32_16x16x32_bf16 v[236:239], v[104:107], v[124:127], v[236:239]
v_cvt_pk_bf16_f32 v24, v24, v28
v_cvt_pk_bf16_f32 v25, v25, v29
v_mfma_f32_16x16x32_bf16 v[252:255], v[108:111], v[124:127], v[252:255]
v_cvt_pk_bf16_f32 v26, v26, v30
v_cvt_pk_bf16_f32 v27, v27, v31
v_mfma_f32_16x16x32_bf16 v[248:251], v[108:111], v[120:123], v[248:251]
s_add_u32 s72, s69, 30720
buffer_load_dwordx4 v4, s[4:7], s72 offen offset:2048 lds
v_mfma_f32_16x16x32_bf16 v[244:247], v[108:111], v[116:119], v[244:247]
buffer_store_dwordx4 v[24:27], v1, s[44:47], s80 offen sc1
v_mfma_f32_16x16x32_bf16 v[240:243], v[108:111], v[112:115], v[240:243]
s_waitcnt lgkmcnt(0)
v_mfma_f32_16x16x32_bf16 v[128:131], v[32:35], v[64:67], v[128:131]
ds_read_b64_tr_b16 v[80:81], v8 offset:8192
ds_read_b64_tr_b16 v[82:83], v8 offset:9216
v_mfma_f32_16x16x32_bf16 v[132:135], v[32:35], v[68:71], v[132:135]
ds_read_b128 v[112:115], v17 offset:0
ds_read_b128 v[116:119], v17 offset:2048
v_mfma_f32_16x16x32_bf16 v[136:139], v[32:35], v[72:75], v[136:139]
s_add_u32 s72, s69, 46080
buffer_load_dwordx4 v5, s[4:7], s72 offen offset:3072 lds
v_mfma_f32_16x16x32_bf16 v[140:143], v[32:35], v[76:79], v[140:143]
ds_read_b128 v[120:123], v17 offset:4096
ds_read_b128 v[124:127], v17 offset:6144
v_mfma_f32_16x16x32_bf16 v[156:159], v[36:39], v[76:79], v[156:159]
ds_read_b64_tr_b16 v[84:85], v9 offset:8192
ds_read_b64_tr_b16 v[86:87], v9 offset:9216
v_mfma_f32_16x16x32_bf16 v[152:155], v[36:39], v[72:75], v[152:155]
ds_read_b64_tr_b16 v[88:89], v10 offset:8192
v_accvgpr_read_b32 v20, a16
v_mfma_f32_16x16x32_bf16 v[148:151], v[36:39], v[68:71], v[148:151]
ds_read_b64_tr_b16 v[90:91], v10 offset:9216
v_accvgpr_read_b32 v28, a17
v_mfma_f32_16x16x32_bf16 v[144:147], v[36:39], v[64:67], v[144:147]
s_add_u32 m0, s63, 102400
ds_read_b64_tr_b16 v[92:93], v11 offset:8192
v_accvgpr_read_b32 v21, a18
v_mfma_f32_16x16x32_bf16 v[160:163], v[40:43], v[64:67], v[160:163]
s_add_u32 s72, s70, 0
buffer_load_dwordx4 v4, s[4:7], s72 offen lds
v_mfma_f32_16x16x32_bf16 v[164:167], v[40:43], v[68:71], v[164:167]
ds_read_b64_tr_b16 v[94:95], v11 offset:9216
v_accvgpr_read_b32 v29, a19
v_mfma_f32_16x16x32_bf16 v[168:171], v[40:43], v[72:75], v[168:171]
s_add_u32 s80, s77, 32768
ds_read_b64_tr_b16 v[96:97], v12 offset:8192
v_accvgpr_read_b32 v22, a48
v_mfma_f32_16x16x32_bf16 v[172:175], v[40:43], v[76:79], v[172:175]
ds_read_b64_tr_b16 v[98:99], v12 offset:9216
v_accvgpr_read_b32 v30, a49
v_mfma_f32_16x16x32_bf16 v[188:191], v[44:47], v[76:79], v[188:191]
s_add_u32 s72, s70, 15360
buffer_load_dwordx4 v5, s[4:7], s72 offen offset:1024 lds
v_mfma_f32_16x16x32_bf16 v[184:187], v[44:47], v[72:75], v[184:187]
ds_read_b64_tr_b16 v[100:101], v13 offset:8192
v_accvgpr_read_b32 v23, a50
v_mfma_f32_16x16x32_bf16 v[180:183], v[44:47], v[68:71], v[180:183]
ds_read_b64_tr_b16 v[102:103], v13 offset:9216
v_accvgpr_read_b32 v31, a51
v_mfma_f32_16x16x32_bf16 v[176:179], v[44:47], v[64:67], v[176:179]
ds_read_b64_tr_b16 v[104:105], v14 offset:8192
v_mul_f32 v20, s79, v20
v_mfma_f32_16x16x32_bf16 v[192:195], v[48:51], v[64:67], v[192:195]
ds_read_b64_tr_b16 v[106:107], v14 offset:9216
v_mul_f32 v28, s79, v28
v_mfma_f32_16x16x32_bf16 v[196:199], v[48:51], v[68:71], v[196:199]
s_add_u32 s72, s70, 30720
buffer_load_dwordx4 v4, s[4:7], s72 offen offset:2048 lds
v_mfma_f32_16x16x32_bf16 v[200:203], v[48:51], v[72:75], v[200:203]
ds_read_b64_tr_b16 v[108:109], v15 offset:8192
v_mul_f32 v21, s79, v21
v_mfma_f32_16x16x32_bf16 v[204:207], v[48:51], v[76:79], v[204:207]
ds_read_b64_tr_b16 v[110:111], v15 offset:9216
v_mul_f32 v29, s79, v29
v_mfma_f32_16x16x32_bf16 v[220:223], v[52:55], v[76:79], v[220:223]
v_mul_f32 v22, s79, v22
v_mul_f32 v30, s79, v30
v_mfma_f32_16x16x32_bf16 v[216:219], v[52:55], v[72:75], v[216:219]
v_mul_f32 v23, s79, v23
v_mul_f32 v31, s79, v31
v_mfma_f32_16x16x32_bf16 v[212:215], v[52:55], v[68:71], v[212:215]
s_add_u32 s72, s70, 46080
buffer_load_dwordx4 v5, s[4:7], s72 offen offset:3072 lds
v_mfma_f32_16x16x32_bf16 v[208:211], v[52:55], v[64:67], v[208:211]
v_cvt_pk_bf16_f32 v20, v20, v28
v_cvt_pk_bf16_f32 v21, v21, v29
v_mfma_f32_16x16x32_bf16 v[224:227], v[56:59], v[64:67], v[224:227]
v_cvt_pk_bf16_f32 v22, v22, v30
v_cvt_pk_bf16_f32 v23, v23, v31
v_mfma_f32_16x16x32_bf16 v[228:231], v[56:59], v[68:71], v[228:231]
buffer_store_dwordx4 v[20:23], v1, s[44:47], s80 offen sc1
v_mfma_f32_16x16x32_bf16 v[232:235], v[56:59], v[72:75], v[232:235]
v_accvgpr_read_b32 v24, a160
v_accvgpr_read_b32 v28, a161
v_mfma_f32_16x16x32_bf16 v[236:239], v[56:59], v[76:79], v[236:239]
v_accvgpr_read_b32 v25, a162
v_accvgpr_read_b32 v29, a163
v_mfma_f32_16x16x32_bf16 v[252:255], v[60:63], v[76:79], v[252:255]
s_add_u32 s80, s78, 1024
v_accvgpr_read_b32 v26, a164
v_accvgpr_read_b32 v30, a165
v_mfma_f32_16x16x32_bf16 v[248:251], v[60:63], v[72:75], v[248:251]
v_accvgpr_read_b32 v27, a166
v_accvgpr_read_b32 v31, a167
v_mfma_f32_16x16x32_bf16 v[244:247], v[60:63], v[68:71], v[244:247]
s_waitcnt vmcnt(15) lgkmcnt(0)
v_cvt_pk_bf16_f32 v24, v24, v28
v_cvt_pk_bf16_f32 v25, v25, v29
v_mfma_f32_16x16x32_bf16 v[240:243], v[60:63], v[64:67], v[240:243]
s_barrier
v_cvt_pk_bf16_f32 v26, v26, v30
v_cvt_pk_bf16_f32 v27, v27, v31
v_mfma_f32_16x16x32_bf16 v[128:131], v[80:83], v[112:115], v[128:131]
s_add_u32 s73, s62, 6
ds_read_b64_tr_b16 v[32:33], v8 offset:16384
ds_read_b64_tr_b16 v[34:35], v8 offset:17408
v_mfma_f32_16x16x32_bf16 v[132:135], v[80:83], v[116:119], v[132:135]
s_add_u32 s70, s73, s65
ds_read_b128 v[64:67], v18 offset:0
ds_read_b128 v[68:71], v18 offset:2048
v_mfma_f32_16x16x32_bf16 v[136:139], v[80:83], v[120:123], v[136:139]
s_and_b32 s70, s70, 3
ds_read_b128 v[72:75], v18 offset:4096
ds_read_b128 v[76:79], v18 offset:6144
v_mfma_f32_16x16x32_bf16 v[140:143], v[80:83], v[124:127], v[140:143]
s_and_b32 s73, s73, 12
ds_read_b64_tr_b16 v[36:37], v9 offset:16384
ds_read_b64_tr_b16 v[38:39], v9 offset:17408
v_mfma_f32_16x16x32_bf16 v[156:159], v[84:87], v[124:127], v[156:159]
s_or_b32 s73, s73, s70
ds_read_b64_tr_b16 v[40:41], v10 offset:16384
v_mfma_f32_16x16x32_bf16 v[152:155], v[84:87], v[120:123], v[152:155]
s_lshl_b32 s71, s73, 19
ds_read_b64_tr_b16 v[42:43], v10 offset:17408
v_mfma_f32_16x16x32_bf16 v[148:151], v[84:87], v[116:119], v[148:151]
s_add_u32 s71, s71, s66
ds_read_b64_tr_b16 v[44:45], v11 offset:16384
v_mfma_f32_16x16x32_bf16 v[144:147], v[84:87], v[112:115], v[144:147]
s_lshl_b32 s73, s73, 7
ds_read_b64_tr_b16 v[46:47], v11 offset:17408
v_mfma_f32_16x16x32_bf16 v[160:163], v[88:91], v[112:115], v[160:163]
s_add_u32 s69, s73, s67
ds_read_b64_tr_b16 v[48:49], v12 offset:16384
v_mfma_f32_16x16x32_bf16 v[164:167], v[88:91], v[116:119], v[164:167]
s_add_u32 s70, s73, s68
ds_read_b64_tr_b16 v[50:51], v12 offset:17408
v_mfma_f32_16x16x32_bf16 v[168:171], v[88:91], v[120:123], v[168:171]
s_add_u32 m0, s64, 0
ds_read_b64_tr_b16 v[52:53], v13 offset:16384
v_mfma_f32_16x16x32_bf16 v[172:175], v[88:91], v[124:127], v[172:175]
s_add_u32 s72, s71, 0
buffer_load_dwordx4 v6, s[12:15], s72 offen lds
v_mfma_f32_16x16x32_bf16 v[188:191], v[92:95], v[124:127], v[188:191]
s_add_u32 s72, s71, 31744
buffer_load_dwordx4 v6, s[12:15], s72 offen offset:1024 lds
v_mfma_f32_16x16x32_bf16 v[184:187], v[92:95], v[120:123], v[184:187]
s_add_u32 s72, s71, 63488
buffer_load_dwordx4 v7, s[12:15], s72 offen offset:2048 lds
v_mfma_f32_16x16x32_bf16 v[180:183], v[92:95], v[116:119], v[180:183]
s_add_u32 s72, s71, 95232
buffer_load_dwordx4 v7, s[12:15], s72 offen offset:3072 lds
v_mfma_f32_16x16x32_bf16 v[176:179], v[92:95], v[112:115], v[176:179]
ds_read_b64_tr_b16 v[54:55], v13 offset:17408
v_mfma_f32_16x16x32_bf16 v[192:195], v[96:99], v[112:115], v[192:195]
ds_read_b64_tr_b16 v[56:57], v14 offset:16384
v_mfma_f32_16x16x32_bf16 v[196:199], v[96:99], v[116:119], v[196:199]
ds_read_b64_tr_b16 v[58:59], v14 offset:17408
v_mfma_f32_16x16x32_bf16 v[200:203], v[96:99], v[120:123], v[200:203]
ds_read_b64_tr_b16 v[60:61], v15 offset:16384
v_mfma_f32_16x16x32_bf16 v[204:207], v[96:99], v[124:127], v[204:207]
s_add_u32 m0, s63, 131072
ds_read_b64_tr_b16 v[62:63], v15 offset:17408
v_mfma_f32_16x16x32_bf16 v[220:223], v[100:103], v[124:127], v[220:223]
s_add_u32 s72, s69, 0
buffer_load_dwordx4 v4, s[4:7], s72 offen lds
v_mfma_f32_16x16x32_bf16 v[216:219], v[100:103], v[120:123], v[216:219]
buffer_store_dwordx4 v[24:27], v1, s[44:47], s80 offen sc1
v_mfma_f32_16x16x32_bf16 v[212:215], v[100:103], v[116:119], v[212:215]
v_accvgpr_read_b32 v20, a20
v_accvgpr_read_b32 v28, a21
v_mfma_f32_16x16x32_bf16 v[208:211], v[100:103], v[112:115], v[208:211]
v_accvgpr_read_b32 v21, a22
v_accvgpr_read_b32 v29, a23
v_mfma_f32_16x16x32_bf16 v[224:227], v[104:107], v[112:115], v[224:227]
s_add_u32 s72, s69, 15360
buffer_load_dwordx4 v5, s[4:7], s72 offen offset:1024 lds
v_mfma_f32_16x16x32_bf16 v[228:231], v[104:107], v[116:119], v[228:231]
s_add_u32 s80, s77, 36864
v_accvgpr_read_b32 v22, a52
v_accvgpr_read_b32 v30, a53
v_mfma_f32_16x16x32_bf16 v[232:235], v[104:107], v[120:123], v[232:235]
v_accvgpr_read_b32 v23, a54
v_accvgpr_read_b32 v31, a55
v_mfma_f32_16x16x32_bf16 v[236:239], v[104:107], v[124:127], v[236:239]
v_mul_f32 v20, s79, v20
v_mul_f32 v28, s79, v28
v_mfma_f32_16x16x32_bf16 v[252:255], v[108:111], v[124:127], v[252:255]
v_mul_f32 v21, s79, v21
v_mul_f32 v29, s79, v29
v_mfma_f32_16x16x32_bf16 v[248:251], v[108:111], v[120:123], v[248:251]
s_add_u32 s72, s69, 30720
buffer_load_dwordx4 v4, s[4:7], s72 offen offset:2048 lds
v_mfma_f32_16x16x32_bf16 v[244:247], v[108:111], v[116:119], v[244:247]
v_mul_f32 v22, s79, v22
v_mul_f32 v30, s79, v30
v_mfma_f32_16x16x32_bf16 v[240:243], v[108:111], v[112:115], v[240:243]
s_waitcnt lgkmcnt(0)
v_mul_f32 v23, s79, v23
v_mul_f32 v31, s79, v31
v_mfma_f32_16x16x32_bf16 v[128:131], v[32:35], v[64:67], v[128:131]
ds_read_b64_tr_b16 v[80:81], v8 offset:24576
ds_read_b64_tr_b16 v[82:83], v8 offset:25600
v_mfma_f32_16x16x32_bf16 v[132:135], v[32:35], v[68:71], v[132:135]
ds_read_b128 v[112:115], v19 offset:0
ds_read_b128 v[116:119], v19 offset:2048
v_mfma_f32_16x16x32_bf16 v[136:139], v[32:35], v[72:75], v[136:139]
s_add_u32 s72, s69, 46080
buffer_load_dwordx4 v5, s[4:7], s72 offen offset:3072 lds
v_mfma_f32_16x16x32_bf16 v[140:143], v[32:35], v[76:79], v[140:143]
ds_read_b128 v[120:123], v19 offset:4096
ds_read_b128 v[124:127], v19 offset:6144
v_mfma_f32_16x16x32_bf16 v[156:159], v[36:39], v[76:79], v[156:159]
ds_read_b64_tr_b16 v[84:85], v9 offset:24576
ds_read_b64_tr_b16 v[86:87], v9 offset:25600
v_mfma_f32_16x16x32_bf16 v[152:155], v[36:39], v[72:75], v[152:155]
ds_read_b64_tr_b16 v[88:89], v10 offset:24576
v_cvt_pk_bf16_f32 v20, v20, v28
v_mfma_f32_16x16x32_bf16 v[148:151], v[36:39], v[68:71], v[148:151]
ds_read_b64_tr_b16 v[90:91], v10 offset:25600
v_cvt_pk_bf16_f32 v21, v21, v29
v_mfma_f32_16x16x32_bf16 v[144:147], v[36:39], v[64:67], v[144:147]
s_add_u32 m0, s63, 135168
ds_read_b64_tr_b16 v[92:93], v11 offset:24576
v_cvt_pk_bf16_f32 v22, v22, v30
v_mfma_f32_16x16x32_bf16 v[160:163], v[40:43], v[64:67], v[160:163]
s_add_u32 s72, s70, 0
buffer_load_dwordx4 v4, s[4:7], s72 offen lds
v_mfma_f32_16x16x32_bf16 v[164:167], v[40:43], v[68:71], v[164:167]
ds_read_b64_tr_b16 v[94:95], v11 offset:25600
v_cvt_pk_bf16_f32 v23, v23, v31
v_mfma_f32_16x16x32_bf16 v[168:171], v[40:43], v[72:75], v[168:171]
ds_read_b64_tr_b16 v[96:97], v12 offset:24576
v_mfma_f32_16x16x32_bf16 v[172:175], v[40:43], v[76:79], v[172:175]
ds_read_b64_tr_b16 v[98:99], v12 offset:25600
v_mfma_f32_16x16x32_bf16 v[188:191], v[44:47], v[76:79], v[188:191]
s_add_u32 s72, s70, 15360
buffer_load_dwordx4 v5, s[4:7], s72 offen offset:1024 lds
v_mfma_f32_16x16x32_bf16 v[184:187], v[44:47], v[72:75], v[184:187]
ds_read_b64_tr_b16 v[100:101], v13 offset:24576
v_mfma_f32_16x16x32_bf16 v[180:183], v[44:47], v[68:71], v[180:183]
ds_read_b64_tr_b16 v[102:103], v13 offset:25600
v_mfma_f32_16x16x32_bf16 v[176:179], v[44:47], v[64:67], v[176:179]
ds_read_b64_tr_b16 v[104:105], v14 offset:24576
v_mfma_f32_16x16x32_bf16 v[192:195], v[48:51], v[64:67], v[192:195]
ds_read_b64_tr_b16 v[106:107], v14 offset:25600
v_mfma_f32_16x16x32_bf16 v[196:199], v[48:51], v[68:71], v[196:199]
s_add_u32 s72, s70, 30720
buffer_load_dwordx4 v4, s[4:7], s72 offen offset:2048 lds
v_mfma_f32_16x16x32_bf16 v[200:203], v[48:51], v[72:75], v[200:203]
ds_read_b64_tr_b16 v[108:109], v15 offset:24576
v_mfma_f32_16x16x32_bf16 v[204:207], v[48:51], v[76:79], v[204:207]
ds_read_b64_tr_b16 v[110:111], v15 offset:25600
v_mfma_f32_16x16x32_bf16 v[220:223], v[52:55], v[76:79], v[220:223]
buffer_store_dwordx4 v[20:23], v1, s[44:47], s80 offen sc1
v_mfma_f32_16x16x32_bf16 v[216:219], v[52:55], v[72:75], v[216:219]
v_accvgpr_read_b32 v24, a168
v_accvgpr_read_b32 v28, a169
v_mfma_f32_16x16x32_bf16 v[212:215], v[52:55], v[68:71], v[212:215]
s_add_u32 s72, s70, 46080
buffer_load_dwordx4 v5, s[4:7], s72 offen offset:3072 lds
v_mfma_f32_16x16x32_bf16 v[208:211], v[52:55], v[64:67], v[208:211]
v_accvgpr_read_b32 v25, a170
v_accvgpr_read_b32 v29, a171
v_mfma_f32_16x16x32_bf16 v[224:227], v[56:59], v[64:67], v[224:227]
s_add_u32 s80, s78, 9216
v_accvgpr_read_b32 v26, a172
v_accvgpr_read_b32 v30, a173
v_mfma_f32_16x16x32_bf16 v[228:231], v[56:59], v[68:71], v[228:231]
v_accvgpr_read_b32 v27, a174
v_accvgpr_read_b32 v31, a175
v_mfma_f32_16x16x32_bf16 v[232:235], v[56:59], v[72:75], v[232:235]
v_cvt_pk_bf16_f32 v24, v24, v28
v_cvt_pk_bf16_f32 v25, v25, v29
v_mfma_f32_16x16x32_bf16 v[236:239], v[56:59], v[76:79], v[236:239]
v_cvt_pk_bf16_f32 v26, v26, v30
v_cvt_pk_bf16_f32 v27, v27, v31
v_mfma_f32_16x16x32_bf16 v[252:255], v[60:63], v[76:79], v[252:255]
buffer_store_dwordx4 v[24:27], v1, s[44:47], s80 offen sc1
v_mfma_f32_16x16x32_bf16 v[248:251], v[60:63], v[72:75], v[248:251]
v_mfma_f32_16x16x32_bf16 v[244:247], v[60:63], v[68:71], v[244:247]
s_waitcnt vmcnt(16) lgkmcnt(0)
v_mfma_f32_16x16x32_bf16 v[240:243], v[60:63], v[64:67], v[240:243]
s_barrier
v_mfma_f32_16x16x32_bf16 v[128:131], v[80:83], v[112:115], v[128:131]
s_add_u32 s73, s62, 7
ds_read_b64_tr_b16 v[32:33], v8 offset:32768
ds_read_b64_tr_b16 v[34:35], v8 offset:33792
v_mfma_f32_16x16x32_bf16 v[132:135], v[80:83], v[116:119], v[132:135]
s_add_u32 s70, s73, s65
ds_read_b128 v[64:67], v18 offset:32768
ds_read_b128 v[68:71], v18 offset:34816
v_mfma_f32_16x16x32_bf16 v[136:139], v[80:83], v[120:123], v[136:139]
s_and_b32 s70, s70, 3
ds_read_b128 v[72:75], v18 offset:36864
ds_read_b128 v[76:79], v18 offset:38912
v_mfma_f32_16x16x32_bf16 v[140:143], v[80:83], v[124:127], v[140:143]
s_and_b32 s73, s73, 12
ds_read_b64_tr_b16 v[36:37], v9 offset:32768
ds_read_b64_tr_b16 v[38:39], v9 offset:33792
v_mfma_f32_16x16x32_bf16 v[156:159], v[84:87], v[124:127], v[156:159]
s_or_b32 s73, s73, s70
ds_read_b64_tr_b16 v[40:41], v10 offset:32768
v_accvgpr_read_b32 v20, a24
v_mfma_f32_16x16x32_bf16 v[152:155], v[84:87], v[120:123], v[152:155]
s_lshl_b32 s71, s73, 19
ds_read_b64_tr_b16 v[42:43], v10 offset:33792
v_accvgpr_read_b32 v28, a25
v_mfma_f32_16x16x32_bf16 v[148:151], v[84:87], v[116:119], v[148:151]
s_add_u32 s71, s71, s66
ds_read_b64_tr_b16 v[44:45], v11 offset:32768
v_accvgpr_read_b32 v21, a26
v_mfma_f32_16x16x32_bf16 v[144:147], v[84:87], v[112:115], v[144:147]
s_lshl_b32 s73, s73, 7
ds_read_b64_tr_b16 v[46:47], v11 offset:33792
v_accvgpr_read_b32 v29, a27
v_mfma_f32_16x16x32_bf16 v[160:163], v[88:91], v[112:115], v[160:163]
s_add_u32 s69, s73, s67
ds_read_b64_tr_b16 v[48:49], v12 offset:32768
v_mfma_f32_16x16x32_bf16 v[164:167], v[88:91], v[116:119], v[164:167]
s_add_u32 s70, s73, s68
ds_read_b64_tr_b16 v[50:51], v12 offset:33792
v_mfma_f32_16x16x32_bf16 v[168:171], v[88:91], v[120:123], v[168:171]
s_add_u32 m0, s64, 16384
ds_read_b64_tr_b16 v[52:53], v13 offset:32768
v_mfma_f32_16x16x32_bf16 v[172:175], v[88:91], v[124:127], v[172:175]
s_add_u32 s72, s71, 0
buffer_load_dwordx4 v6, s[12:15], s72 offen lds
v_mfma_f32_16x16x32_bf16 v[188:191], v[92:95], v[124:127], v[188:191]
s_add_u32 s72, s71, 31744
buffer_load_dwordx4 v6, s[12:15], s72 offen offset:1024 lds
v_mfma_f32_16x16x32_bf16 v[184:187], v[92:95], v[120:123], v[184:187]
s_add_u32 s72, s71, 63488
buffer_load_dwordx4 v7, s[12:15], s72 offen offset:2048 lds
v_mfma_f32_16x16x32_bf16 v[180:183], v[92:95], v[116:119], v[180:183]
s_add_u32 s72, s71, 95232
buffer_load_dwordx4 v7, s[12:15], s72 offen offset:3072 lds
v_mfma_f32_16x16x32_bf16 v[176:179], v[92:95], v[112:115], v[176:179]
s_add_u32 s80, s77, 40960
ds_read_b64_tr_b16 v[54:55], v13 offset:33792
v_accvgpr_read_b32 v22, a56
v_mfma_f32_16x16x32_bf16 v[192:195], v[96:99], v[112:115], v[192:195]
ds_read_b64_tr_b16 v[56:57], v14 offset:32768
v_accvgpr_read_b32 v30, a57
v_mfma_f32_16x16x32_bf16 v[196:199], v[96:99], v[116:119], v[196:199]
ds_read_b64_tr_b16 v[58:59], v14 offset:33792
v_accvgpr_read_b32 v23, a58
v_mfma_f32_16x16x32_bf16 v[200:203], v[96:99], v[120:123], v[200:203]
ds_read_b64_tr_b16 v[60:61], v15 offset:32768
v_accvgpr_read_b32 v31, a59
v_mfma_f32_16x16x32_bf16 v[204:207], v[96:99], v[124:127], v[204:207]
s_add_u32 m0, s63, 65536
ds_read_b64_tr_b16 v[62:63], v15 offset:33792
v_mul_f32 v20, s79, v20
v_mfma_f32_16x16x32_bf16 v[220:223], v[100:103], v[124:127], v[220:223]
s_add_u32 s72, s69, 0
buffer_load_dwordx4 v4, s[4:7], s72 offen lds
v_mfma_f32_16x16x32_bf16 v[216:219], v[100:103], v[120:123], v[216:219]
v_mul_f32 v28, s79, v28
v_mul_f32 v21, s79, v21
v_mfma_f32_16x16x32_bf16 v[212:215], v[100:103], v[116:119], v[212:215]
v_mul_f32 v29, s79, v29
v_mul_f32 v22, s79, v22
v_mfma_f32_16x16x32_bf16 v[208:211], v[100:103], v[112:115], v[208:211]
v_mul_f32 v30, s79, v30
v_mul_f32 v23, s79, v23
v_mfma_f32_16x16x32_bf16 v[224:227], v[104:107], v[112:115], v[224:227]
s_add_u32 s72, s69, 15360
buffer_load_dwordx4 v5, s[4:7], s72 offen offset:1024 lds
v_mfma_f32_16x16x32_bf16 v[228:231], v[104:107], v[116:119], v[228:231]
v_mul_f32 v31, s79, v31
v_cvt_pk_bf16_f32 v20, v20, v28
v_mfma_f32_16x16x32_bf16 v[232:235], v[104:107], v[120:123], v[232:235]
v_cvt_pk_bf16_f32 v21, v21, v29
v_cvt_pk_bf16_f32 v22, v22, v30
v_mfma_f32_16x16x32_bf16 v[236:239], v[104:107], v[124:127], v[236:239]
v_cvt_pk_bf16_f32 v23, v23, v31
v_mfma_f32_16x16x32_bf16 v[252:255], v[108:111], v[124:127], v[252:255]
buffer_store_dwordx4 v[20:23], v1, s[44:47], s80 offen sc1
v_mfma_f32_16x16x32_bf16 v[248:251], v[108:111], v[120:123], v[248:251]
s_add_u32 s72, s69, 30720
buffer_load_dwordx4 v4, s[4:7], s72 offen offset:2048 lds
v_mfma_f32_16x16x32_bf16 v[244:247], v[108:111], v[116:119], v[244:247]
v_accvgpr_read_b32 v24, a176
v_accvgpr_read_b32 v28, a177
v_mfma_f32_16x16x32_bf16 v[240:243], v[108:111], v[112:115], v[240:243]
s_waitcnt lgkmcnt(0)
v_accvgpr_read_b32 v25, a178
v_accvgpr_read_b32 v29, a179
v_mfma_f32_16x16x32_bf16 v[128:131], v[32:35], v[64:67], v[128:131]
s_lshr_b32 s75, s93, 4
ds_read_b64_tr_b16 v[80:81], v8 offset:40960
ds_read_b64_tr_b16 v[82:83], v8 offset:41984
v_mfma_f32_16x16x32_bf16 v[132:135], v[32:35], v[68:71], v[132:135]
s_and_b32 s75, s75, 0x7f00
ds_read_b128 v[112:115], v19 offset:32768
ds_read_b128 v[116:119], v19 offset:34816
v_mfma_f32_16x16x32_bf16 v[136:139], v[32:35], v[72:75], v[136:139]
s_add_u32 s72, s69, 46080
buffer_load_dwordx4 v5, s[4:7], s72 offen offset:3072 lds
v_mfma_f32_16x16x32_bf16 v[140:143], v[32:35], v[76:79], v[140:143]
s_add_u32 s75, s75, LcB1-Lpc0
v_lshrrev_b32 v2, 5, v0
v_lshlrev_b32 v2, 7, v2
v_mfma_f32_16x16x32_bf16 v[156:159], v[36:39], v[76:79], v[156:159]
s_add_u32 s80, s78, 33792
v_add_u32 v2, s75, v2
v_min_u32 v2, Lcode_end-Lpc0, v2
v_mfma_f32_16x16x32_bf16 v[152:155], v[36:39], v[72:75], v[152:155]
global_load_dword v3, v2, s[98:99]
v_mfma_f32_16x16x32_bf16 v[148:151], v[36:39], v[68:71], v[148:151]
ds_read_b128 v[120:123], v19 offset:36864
ds_read_b128 v[124:127], v19 offset:38912
v_mfma_f32_16x16x32_bf16 v[144:147], v[36:39], v[64:67], v[144:147]
s_add_u32 m0, s63, 69632
ds_read_b64_tr_b16 v[84:85], v9 offset:40960
ds_read_b64_tr_b16 v[86:87], v9 offset:41984
v_mfma_f32_16x16x32_bf16 v[160:163], v[40:43], v[64:67], v[160:163]
s_add_u32 s72, s70, 0
buffer_load_dwordx4 v4, s[4:7], s72 offen lds
v_mfma_f32_16x16x32_bf16 v[164:167], v[40:43], v[68:71], v[164:167]
ds_read_b64_tr_b16 v[88:89], v10 offset:40960
v_accvgpr_read_b32 v26, a180
v_mfma_f32_16x16x32_bf16 v[168:171], v[40:43], v[72:75], v[168:171]
ds_read_b64_tr_b16 v[90:91], v10 offset:41984
v_accvgpr_read_b32 v30, a181
v_mfma_f32_16x16x32_bf16 v[172:175], v[40:43], v[76:79], v[172:175]
ds_read_b64_tr_b16 v[92:93], v11 offset:40960
v_accvgpr_read_b32 v27, a182
v_mfma_f32_16x16x32_bf16 v[188:191], v[44:47], v[76:79], v[188:191]
s_add_u32 s72, s70, 15360
buffer_load_dwordx4 v5, s[4:7], s72 offen offset:1024 lds
v_mfma_f32_16x16x32_bf16 v[184:187], v[44:47], v[72:75], v[184:187]
ds_read_b64_tr_b16 v[94:95], v11 offset:41984
v_accvgpr_read_b32 v31, a183
v_mfma_f32_16x16x32_bf16 v[180:183], v[44:47], v[68:71], v[180:183]
ds_read_b64_tr_b16 v[96:97], v12 offset:40960
v_cvt_pk_bf16_f32 v24, v24, v28
v_mfma_f32_16x16x32_bf16 v[176:179], v[44:47], v[64:67], v[176:179]
ds_read_b64_tr_b16 v[98:99], v12 offset:41984
v_cvt_pk_bf16_f32 v25, v25, v29
v_mfma_f32_16x16x32_bf16 v[192:195], v[48:51], v[64:67], v[192:195]
ds_read_b64_tr_b16 v[100:101], v13 offset:40960
v_cvt_pk_bf16_f32 v26, v26, v30
v_mfma_f32_16x16x32_bf16 v[196:199], v[48:51], v[68:71], v[196:199]
s_add_u32 s72, s70, 30720
buffer_load_dwordx4 v4, s[4:7], s72 offen offset:2048 lds
v_mfma_f32_16x16x32_bf16 v[200:203], v[48:51], v[72:75], v[200:203]
ds_read_b64_tr_b16 v[102:103], v13 offset:41984
v_cvt_pk_bf16_f32 v27, v27, v31
v_mfma_f32_16x16x32_bf16 v[204:207], v[48:51], v[76:79], v[204:207]
ds_read_b64_tr_b16 v[104:105], v14 offset:40960
v_mfma_f32_16x16x32_bf16 v[220:223], v[52:55], v[76:79], v[220:223]
ds_read_b64_tr_b16 v[106:107], v14 offset:41984
v_mfma_f32_16x16x32_bf16 v[216:219], v[52:55], v[72:75], v[216:219]
ds_read_b64_tr_b16 v[108:109], v15 offset:40960
v_mfma_f32_16x16x32_bf16 v[212:215], v[52:55], v[68:71], v[212:215]
s_add_u32 s72, s70, 46080
buffer_load_dwordx4 v5, s[4:7], s72 offen offset:3072 lds
v_mfma_f32_16x16x32_bf16 v[208:211], v[52:55], v[64:67], v[208:211]
ds_read_b64_tr_b16 v[110:111], v15 offset:41984
v_mfma_f32_16x16x32_bf16 v[224:227], v[56:59], v[64:67], v[224:227]
buffer_store_dwordx4 v[24:27], v1, s[44:47], s80 offen sc1
v_mfma_f32_16x16x32_bf16 v[228:231], v[56:59], v[68:71], v[228:231]
v_accvgpr_read_b32 v20, a28
v_accvgpr_read_b32 v28, a29
v_mfma_f32_16x16x32_bf16 v[232:235], v[56:59], v[72:75], v[232:235]
v_accvgpr_read_b32 v21, a30
v_accvgpr_read_b32 v29, a31
v_mfma_f32_16x16x32_bf16 v[236:239], v[56:59], v[76:79], v[236:239]
s_add_u32 s80, s77, 45056
v_accvgpr_read_b32 v22, a60
v_accvgpr_read_b32 v30, a61
v_mfma_f32_16x16x32_bf16 v[252:255], v[60:63], v[76:79], v[252:255]
v_accvgpr_read_b32 v23, a62
v_accvgpr_read_b32 v31, a63
v_mfma_f32_16x16x32_bf16 v[248:251], v[60:63], v[72:75], v[248:251]
v_mul_f32 v20, s79, v20
v_mul_f32 v28, s79, v28
v_mfma_f32_16x16x32_bf16 v[244:247], v[60:63], v[68:71], v[244:247]
s_waitcnt vmcnt(16) lgkmcnt(0)
v_mul_f32 v21, s79, v21
v_mul_f32 v29, s79, v29
v_mfma_f32_16x16x32_bf16 v[240:243], v[60:63], v[64:67], v[240:243]
s_barrier
v_mul_f32 v22, s79, v22
v_mul_f32 v30, s79, v30
v_mfma_f32_16x16x32_bf16 v[128:131], v[80:83], v[112:115], v[128:131]
s_add_u32 s73, s62, 8
ds_read_b64_tr_b16 v[32:33], v8 offset:0
ds_read_b64_tr_b16 v[34:35], v8 offset:1024
v_mfma_f32_16x16x32_bf16 v[132:135], v[80:83], v[116:119], v[132:135]
s_add_u32 s70, s73, s65
ds_read_b128 v[64:67], v16 offset:0
ds_read_b128 v[68:71], v16 offset:2048
v_mfma_f32_16x16x32_bf16 v[136:139], v[80:83], v[120:123], v[136:139]
s_and_b32 s70, s70, 3
ds_read_b128 v[72:75], v16 offset:4096
ds_read_b128 v[76:79], v16 offset:6144
v_mfma_f32_16x16x32_bf16 v[140:143], v[80:83], v[124:127], v[140:143]
s_and_b32 s73, s73, 12
ds_read_b64_tr_b16 v[36:37], v9 offset:0
ds_read_b64_tr_b16 v[38:39], v9 offset:1024
v_mfma_f32_16x16x32_bf16 v[156:159], v[84:87], v[124:127], v[156:159]
s_or_b32 s73, s73, s70
ds_read_b64_tr_b16 v[40:41], v10 offset:0
v_mul_f32 v23, s79, v23
v_mfma_f32_16x16x32_bf16 v[152:155], v[84:87], v[120:123], v[152:155]
s_lshl_b32 s71, s73, 19
ds_read_b64_tr_b16 v[42:43], v10 offset:1024
v_mul_f32 v31, s79, v31
v_mfma_f32_16x16x32_bf16 v[148:151], v[84:87], v[116:119], v[148:151]
s_add_u32 s71, s71, s66
ds_read_b64_tr_b16 v[44:45], v11 offset:0
v_cvt_pk_bf16_f32 v20, v20, v28
v_mfma_f32_16x16x32_bf16 v[144:147], v[84:87], v[112:115], v[144:147]
s_lshl_b32 s73, s73, 7
ds_read_b64_tr_b16 v[46:47], v11 offset:1024
v_cvt_pk_bf16_f32 v21, v21, v29
v_mfma_f32_16x16x32_bf16 v[160:163], v[88:91], v[112:115], v[160:163]
s_add_u32 s69, s73, s67
ds_read_b64_tr_b16 v[48:49], v12 offset:0
v_cvt_pk_bf16_f32 v22, v22, v30
v_mfma_f32_16x16x32_bf16 v[164:167], v[88:91], v[116:119], v[164:167]
s_add_u32 s70, s73, s68
ds_read_b64_tr_b16 v[50:51], v12 offset:1024
v_cvt_pk_bf16_f32 v23, v23, v31
v_mfma_f32_16x16x32_bf16 v[168:171], v[88:91], v[120:123], v[168:171]
s_add_u32 m0, s64, 32768
ds_read_b64_tr_b16 v[52:53], v13 offset:0
v_mfma_f32_16x16x32_bf16 v[172:175], v[88:91], v[124:127], v[172:175]
s_add_u32 s72, s71, 0
buffer_load_dwordx4 v6, s[12:15], s72 offen lds
v_mfma_f32_16x16x32_bf16 v[188:191], v[92:95], v[124:127], v[188:191]
s_add_u32 s72, s71, 31744
buffer_load_dwordx4 v6, s[12:15], s72 offen offset:1024 lds
v_mfma_f32_16x16x32_bf16 v[184:187], v[92:95], v[120:123], v[184:187]
s_add_u32 s72, s71, 63488
buffer_load_dwordx4 v7, s[12:15], s72 offen offset:2048 lds
v_mfma_f32_16x16x32_bf16 v[180:183], v[92:95], v[116:119], v[180:183]
s_add_u32 s72, s71, 95232
buffer_load_dwordx4 v7, s[12:15], s72 offen offset:3072 lds
v_mfma_f32_16x16x32_bf16 v[176:179], v[92:95], v[112:115], v[176:179]
ds_read_b64_tr_b16 v[54:55], v13 offset:1024
v_mfma_f32_16x16x32_bf16 v[192:195], v[96:99], v[112:115], v[192:195]
ds_read_b64_tr_b16 v[56:57], v14 offset:0
v_mfma_f32_16x16x32_bf16 v[196:199], v[96:99], v[116:119], v[196:199]
ds_read_b64_tr_b16 v[58:59], v14 offset:1024
v_mfma_f32_16x16x32_bf16 v[200:203], v[96:99], v[120:123], v[200:203]
ds_read_b64_tr_b16 v[60:61], v15 offset:0
v_mfma_f32_16x16x32_bf16 v[204:207], v[96:99], v[124:127], v[204:207]
s_add_u32 m0, s63, 98304
ds_read_b64_tr_b16 v[62:63], v15 offset:1024
v_mfma_f32_16x16x32_bf16 v[220:223], v[100:103], v[124:127], v[220:223]
s_add_u32 s72, s69, 0
buffer_load_dwordx4 v4, s[4:7], s72 offen lds
v_mfma_f32_16x16x32_bf16 v[216:219], v[100:103], v[120:123], v[216:219]
buffer_store_dwordx4 v[20:23], v1, s[44:47], s80 offen sc1
v_mfma_f32_16x16x32_bf16 v[212:215], v[100:103], v[116:119], v[212:215]
v_accvgpr_read_b32 v24, a184
v_accvgpr_read_b32 v28, a185
v_mfma_f32_16x16x32_bf16 v[208:211], v[100:103], v[112:115], v[208:211]
v_accvgpr_read_b32 v25, a186
v_accvgpr_read_b32 v29, a187
v_mfma_f32_16x16x32_bf16 v[224:227], v[104:107], v[112:115], v[224:227]
s_add_u32 s72, s69, 15360
buffer_load_dwordx4 v5, s[4:7], s72 offen offset:1024 lds
v_mfma_f32_16x16x32_bf16 v[228:231], v[104:107], v[116:119], v[228:231]
s_add_u32 s80, s78, 41984
v_accvgpr_read_b32 v26, a188
v_accvgpr_read_b32 v30, a189
v_mfma_f32_16x16x32_bf16 v[232:235], v[104:107], v[120:123], v[232:235]
v_accvgpr_read_b32 v27, a190
v_accvgpr_read_b32 v31, a191
v_mfma_f32_16x16x32_bf16 v[236:239], v[104:107], v[124:127], v[236:239]
v_cvt_pk_bf16_f32 v24, v24, v28
v_cvt_pk_bf16_f32 v25, v25, v29
v_mfma_f32_16x16x32_bf16 v[252:255], v[108:111], v[124:127], v[252:255]
v_cvt_pk_bf16_f32 v26, v26, v30
v_cvt_pk_bf16_f32 v27, v27, v31
v_mfma_f32_16x16x32_bf16 v[248:251], v[108:111], v[120:123], v[248:251]
s_add_u32 s72, s69, 30720
buffer_load_dwordx4 v4, s[4:7], s72 offen offset:2048 lds
v_mfma_f32_16x16x32_bf16 v[244:247], v[108:111], v[116:119], v[244:247]
buffer_store_dwordx4 v[24:27], v1, s[44:47], s80 offen sc1
v_mfma_f32_16x16x32_bf16 v[240:243], v[108:111], v[112:115], v[240:243]
s_waitcnt lgkmcnt(0)
v_mfma_f32_16x16x32_bf16 v[128:131], v[32:35], v[64:67], v[128:131]
ds_read_b64_tr_b16 v[80:81], v8 offset:8192
ds_read_b64_tr_b16 v[82:83], v8 offset:9216
v_mfma_f32_16x16x32_bf16 v[132:135], v[32:35], v[68:71], v[132:135]
ds_read_b128 v[112:115], v17 offset:0
ds_read_b128 v[116:119], v17 offset:2048
v_mfma_f32_16x16x32_bf16 v[136:139], v[32:35], v[72:75], v[136:139]
s_add_u32 s72, s69, 46080
buffer_load_dwordx4 v5, s[4:7], s72 offen offset:3072 lds
v_mfma_f32_16x16x32_bf16 v[140:143], v[32:35], v[76:79], v[140:143]
ds_read_b128 v[120:123], v17 offset:4096
ds_read_b128 v[124:127], v17 offset:6144
v_mfma_f32_16x16x32_bf16 v[156:159], v[36:39], v[76:79], v[156:159]
ds_read_b64_tr_b16 v[84:85], v9 offset:8192
ds_read_b64_tr_b16 v[86:87], v9 offset:9216
v_mfma_f32_16x16x32_bf16 v[152:155], v[36:39], v[72:75], v[152:155]
ds_read_b64_tr_b16 v[88:89], v10 offset:8192
v_accvgpr_read_b32 v20, a64
v_mfma_f32_16x16x32_bf16 v[148:151], v[36:39], v[68:71], v[148:151]
ds_read_b64_tr_b16 v[90:91], v10 offset:9216
v_accvgpr_read_b32 v28, a65
v_mfma_f32_16x16x32_bf16 v[144:147], v[36:39], v[64:67], v[144:147]
s_add_u32 m0, s63, 102400
ds_read_b64_tr_b16 v[92:93], v11 offset:8192
v_accvgpr_read_b32 v21, a66
v_mfma_f32_16x16x32_bf16 v[160:163], v[40:43], v[64:67], v[160:163]
s_add_u32 s72, s70, 0
buffer_load_dwordx4 v4, s[4:7], s72 offen lds
v_mfma_f32_16x16x32_bf16 v[164:167], v[40:43], v[68:71], v[164:167]
ds_read_b64_tr_b16 v[94:95], v11 offset:9216
v_accvgpr_read_b32 v29, a67
v_mfma_f32_16x16x32_bf16 v[168:171], v[40:43], v[72:75], v[168:171]
s_add_u32 s80, s77, 1024
ds_read_b64_tr_b16 v[96:97], v12 offset:8192
v_accvgpr_read_b32 v22, a96
v_mfma_f32_16x16x32_bf16 v[172:175], v[40:43], v[76:79], v[172:175]
ds_read_b64_tr_b16 v[98:99], v12 offset:9216
v_accvgpr_read_b32 v30, a97
v_mfma_f32_16x16x32_bf16 v[188:191], v[44:47], v[76:79], v[188:191]
s_add_u32 s72, s70, 15360
buffer_load_dwordx4 v5, s[4:7], s72 offen offset:1024 lds
v_mfma_f32_16x16x32_bf16 v[184:187], v[44:47], v[72:75], v[184:187]
ds_read_b64_tr_b16 v[100:101], v13 offset:8192
v_accvgpr_read_b32 v23, a98
v_mfma_f32_16x16x32_bf16 v[180:183], v[44:47], v[68:71], v[180:183]
ds_read_b64_tr_b16 v[102:103], v13 offset:9216
v_accvgpr_read_b32 v31, a99
v_mfma_f32_16x16x32_bf16 v[176:179], v[44:47], v[64:67], v[176:179]
ds_read_b64_tr_b16 v[104:105], v14 offset:8192
v_mul_f32 v20, s79, v20
v_mfma_f32_16x16x32_bf16 v[192:195], v[48:51], v[64:67], v[192:195]
ds_read_b64_tr_b16 v[106:107], v14 offset:9216
v_mul_f32 v28, s79, v28
v_mfma_f32_16x16x32_bf16 v[196:199], v[48:51], v[68:71], v[196:199]
s_add_u32 s72, s70, 30720
buffer_load_dwordx4 v4, s[4:7], s72 offen offset:2048 lds
v_mfma_f32_16x16x32_bf16 v[200:203], v[48:51], v[72:75], v[200:203]
ds_read_b64_tr_b16 v[108:109], v15 offset:8192
v_mul_f32 v21, s79, v21
v_mfma_f32_16x16x32_bf16 v[204:207], v[48:51], v[76:79], v[204:207]
ds_read_b64_tr_b16 v[110:111], v15 offset:9216
v_mul_f32 v29, s79, v29
v_mfma_f32_16x16x32_bf16 v[220:223], v[52:55], v[76:79], v[220:223]
v_mul_f32 v22, s79, v22
v_mul_f32 v30, s79, v30
v_mfma_f32_16x16x32_bf16 v[216:219], v[52:55], v[72:75], v[216:219]
v_mul_f32 v23, s79, v23
v_mul_f32 v31, s79, v31
v_mfma_f32_16x16x32_bf16 v[212:215], v[52:55], v[68:71], v[212:215]
s_add_u32 s72, s70, 46080
buffer_load_dwordx4 v5, s[4:7], s72 offen offset:3072 lds
v_mfma_f32_16x16x32_bf16 v[208:211], v[52:55], v[64:67], v[208:211]
v_cvt_pk_bf16_f32 v20, v20, v28
v_cvt_pk_bf16_f32 v21, v21, v29
v_mfma_f32_16x16x32_bf16 v[224:227], v[56:59], v[64:67], v[224:227]
v_cvt_pk_bf16_f32 v22, v22, v30
v_cvt_pk_bf16_f32 v23, v23, v31
v_mfma_f32_16x16x32_bf16 v[228:231], v[56:59], v[68:71], v[228:231]
buffer_store_dwordx4 v[20:23], v1, s[44:47], s80 offen sc1
v_mfma_f32_16x16x32_bf16 v[232:235], v[56:59], v[72:75], v[232:235]
v_accvgpr_read_b32 v24, a192
v_accvgpr_read_b32 v28, a193
v_mfma_f32_16x16x32_bf16 v[236:239], v[56:59], v[76:79], v[236:239]
v_accvgpr_read_b32 v25, a194
v_accvgpr_read_b32 v29, a195
v_mfma_f32_16x16x32_bf16 v[252:255], v[60:63], v[76:79], v[252:255]
s_add_u32 s80, s78, 2048
v_accvgpr_read_b32 v26, a196
v_accvgpr_read_b32 v30, a197
v_mfma_f32_16x16x32_bf16 v[248:251], v[60:63], v[72:75], v[248:251]
v_accvgpr_read_b32 v27, a198
v_accvgpr_read_b32 v31, a199
v_mfma_f32_16x16x32_bf16 v[244:247], v[60:63], v[68:71], v[244:247]
s_waitcnt vmcnt(16) lgkmcnt(0)
v_cvt_pk_bf16_f32 v24, v24, v28
v_cvt_pk_bf16_f32 v25, v25, v29
v_mfma_f32_16x16x32_bf16 v[240:243], v[60:63], v[64:67], v[240:243]
s_barrier
v_cvt_pk_bf16_f32 v26, v26, v30
v_cvt_pk_bf16_f32 v27, v27, v31
v_mfma_f32_16x16x32_bf16 v[128:131], v[80:83], v[112:115], v[128:131]
s_add_u32 s73, s62, 9
ds_read_b64_tr_b16 v[32:33], v8 offset:16384
ds_read_b64_tr_b16 v[34:35], v8 offset:17408
v_mfma_f32_16x16x32_bf16 v[132:135], v[80:83], v[116:119], v[132:135]
s_add_u32 s70, s73, s65
ds_read_b128 v[64:67], v18 offset:0
ds_read_b128 v[68:71], v18 offset:2048
v_mfma_f32_16x16x32_bf16 v[136:139], v[80:83], v[120:123], v[136:139]
s_and_b32 s70, s70, 3
ds_read_b128 v[72:75], v18 offset:4096
ds_read_b128 v[76:79], v18 offset:6144
v_mfma_f32_16x16x32_bf16 v[140:143], v[80:83], v[124:127], v[140:143]
s_and_b32 s73, s73, 12
ds_read_b64_tr_b16 v[36:37], v9 offset:16384
ds_read_b64_tr_b16 v[38:39], v9 offset:17408
v_mfma_f32_16x16x32_bf16 v[156:159], v[84:87], v[124:127], v[156:159]
s_or_b32 s73, s73, s70
ds_read_b64_tr_b16 v[40:41], v10 offset:16384
v_mfma_f32_16x16x32_bf16 v[152:155], v[84:87], v[120:123], v[152:155]
s_lshl_b32 s71, s73, 19
ds_read_b64_tr_b16 v[42:43], v10 offset:17408
v_mfma_f32_16x16x32_bf16 v[148:151], v[84:87], v[116:119], v[148:151]
s_add_u32 s71, s71, s66
ds_read_b64_tr_b16 v[44:45], v11 offset:16384
v_mfma_f32_16x16x32_bf16 v[144:147], v[84:87], v[112:115], v[144:147]
s_lshl_b32 s73, s73, 7
ds_read_b64_tr_b16 v[46:47], v11 offset:17408
v_mfma_f32_16x16x32_bf16 v[160:163], v[88:91], v[112:115], v[160:163]
s_add_u32 s69, s73, s67
ds_read_b64_tr_b16 v[48:49], v12 offset:16384
v_mfma_f32_16x16x32_bf16 v[164:167], v[88:91], v[116:119], v[164:167]
s_add_u32 s70, s73, s68
ds_read_b64_tr_b16 v[50:51], v12 offset:17408
v_mfma_f32_16x16x32_bf16 v[168:171], v[88:91], v[120:123], v[168:171]
s_add_u32 m0, s64, 0
ds_read_b64_tr_b16 v[52:53], v13 offset:16384
v_mfma_f32_16x16x32_bf16 v[172:175], v[88:91], v[124:127], v[172:175]
s_add_u32 s72, s71, 0
buffer_load_dwordx4 v6, s[12:15], s72 offen lds
v_mfma_f32_16x16x32_bf16 v[188:191], v[92:95], v[124:127], v[188:191]
s_add_u32 s72, s71, 31744
buffer_load_dwordx4 v6, s[12:15], s72 offen offset:1024 lds
v_mfma_f32_16x16x32_bf16 v[184:187], v[92:95], v[120:123], v[184:187]
s_add_u32 s72, s71, 63488
buffer_load_dwordx4 v7, s[12:15], s72 offen offset:2048 lds
v_mfma_f32_16x16x32_bf16 v[180:183], v[92:95], v[116:119], v[180:183]
s_add_u32 s72, s71, 95232
buffer_load_dwordx4 v7, s[12:15], s72 offen offset:3072 lds
v_mfma_f32_16x16x32_bf16 v[176:179], v[92:95], v[112:115], v[176:179]
ds_read_b64_tr_b16 v[54:55], v13 offset:17408
v_mfma_f32_16x16x32_bf16 v[192:195], v[96:99], v[112:115], v[192:195]
ds_read_b64_tr_b16 v[56:57], v14 offset:16384
v_mfma_f32_16x16x32_bf16 v[196:199], v[96:99], v[116:119], v[196:199]
ds_read_b64_tr_b16 v[58:59], v14 offset:17408
v_mfma_f32_16x16x32_bf16 v[200:203], v[96:99], v[120:123], v[200:203]
ds_read_b64_tr_b16 v[60:61], v15 offset:16384
v_mfma_f32_16x16x32_bf16 v[204:207], v[96:99], v[124:127], v[204:207]
s_add_u32 m0, s63, 131072
ds_read_b64_tr_b16 v[62:63], v15 offset:17408
v_mfma_f32_16x16x32_bf16 v[220:223], v[100:103], v[124:127], v[220:223]
s_add_u32 s72, s69, 0
buffer_load_dwordx4 v4, s[4:7], s72 offen lds
v_mfma_f32_16x16x32_bf16 v[216:219], v[100:103], v[120:123], v[216:219]
buffer_store_dwordx4 v[24:27], v1, s[44:47], s80 offen sc1
v_mfma_f32_16x16x32_bf16 v[212:215], v[100:103], v[116:119], v[212:215]
v_accvgpr_read_b32 v20, a68
v_accvgpr_read_b32 v28, a69
v_mfma_f32_16x16x32_bf16 v[208:211], v[100:103], v[112:115], v[208:211]
v_accvgpr_read_b32 v21, a70
v_accvgpr_read_b32 v29, a71
v_mfma_f32_16x16x32_bf16 v[224:227], v[104:107], v[112:115], v[224:227]
s_add_u32 s72, s69, 15360
buffer_load_dwordx4 v5, s[4:7], s72 offen offset:1024 lds
v_mfma_f32_16x16x32_bf16 v[228:231], v[104:107], v[116:119], v[228:231]
s_add_u32 s80, s77, 5120
v_accvgpr_read_b32 v22, a100
v_accvgpr_read_b32 v30, a101
v_mfma_f32_16x16x32_bf16 v[232:235], v[104:107], v[120:123], v[232:235]
v_accvgpr_read_b32 v23, a102
v_accvgpr_read_b32 v31, a103
v_mfma_f32_16x16x32_bf16 v[236:239], v[104:107], v[124:127], v[236:239]
v_mul_f32 v20, s79, v20
v_mul_f32 v28, s79, v28
v_mfma_f32_16x16x32_bf16 v[252:255], v[108:111], v[124:127], v[252:255]
v_mul_f32 v21, s79, v21
v_mul_f32 v29, s79, v29
v_mfma_f32_16x16x32_bf16 v[248:251], v[108:111], v[120:123], v[248:251]
s_add_u32 s72, s69, 30720
buffer_load_dwordx4 v4, s[4:7], s72 offen offset:2048 lds
v_mfma_f32_16x16x32_bf16 v[244:247], v[108:111], v[116:119], v[244:247]
v_mul_f32 v22, s79, v22
v_mul_f32 v30, s79, v30
v_mfma_f32_16x16x32_bf16 v[240:243], v[108:111], v[112:115], v[240:243]
s_waitcnt lgkmcnt(0)
v_mul_f32 v23, s79, v23
v_mul_f32 v31, s79, v31
v_mfma_f32_16x16x32_bf16 v[128:131], v[32:35], v[64:67], v[128:131]
ds_read_b64_tr_b16 v[80:81], v8 offset:24576
ds_read_b64_tr_b16 v[82:83], v8 offset:25600
v_mfma_f32_16x16x32_bf16 v[132:135], v[32:35], v[68:71], v[132:135]
ds_read_b128 v[112:115], v19 offset:0
ds_read_b128 v[116:119], v19 offset:2048
v_mfma_f32_16x16x32_bf16 v[136:139], v[32:35], v[72:75], v[136:139]
s_add_u32 s72, s69, 46080
buffer_load_dwordx4 v5, s[4:7], s72 offen offset:3072 lds
v_mfma_f32_16x16x32_bf16 v[140:143], v[32:35], v[76:79], v[140:143]
ds_read_b128 v[120:123], v19 offset:4096
ds_read_b128 v[124:127], v19 offset:6144
v_mfma_f32_16x16x32_bf16 v[156:159], v[36:39], v[76:79], v[156:159]
ds_read_b64_tr_b16 v[84:85], v9 offset:24576
ds_read_b64_tr_b16 v[86:87], v9 offset:25600
v_mfma_f32_16x16x32_bf16 v[152:155], v[36:39], v[72:75], v[152:155]
ds_read_b64_tr_b16 v[88:89], v10 offset:24576
v_cvt_pk_bf16_f32 v20, v20, v28
v_mfma_f32_16x16x32_bf16 v[148:151], v[36:39], v[68:71], v[148:151]
ds_read_b64_tr_b16 v[90:91], v10 offset:25600
v_cvt_pk_bf16_f32 v21, v21, v29
v_mfma_f32_16x16x32_bf16 v[144:147], v[36:39], v[64:67], v[144:147]
s_add_u32 m0, s63, 135168
ds_read_b64_tr_b16 v[92:93], v11 offset:24576
v_cvt_pk_bf16_f32 v22, v22, v30
v_mfma_f32_16x16x32_bf16 v[160:163], v[40:43], v[64:67], v[160:163]
s_add_u32 s72, s70, 0
buffer_load_dwordx4 v4, s[4:7], s72 offen lds
v_mfma_f32_16x16x32_bf16 v[164:167], v[40:43], v[68:71], v[164:167]
ds_read_b64_tr_b16 v[94:95], v11 offset:25600
v_cvt_pk_bf16_f32 v23, v23, v31
v_mfma_f32_16x16x32_bf16 v[168:171], v[40:43], v[72:75], v[168:171]
ds_read_b64_tr_b16 v[96:97], v12 offset:24576
v_mfma_f32_16x16x32_bf16 v[172:175], v[40:43], v[76:79], v[172:175]
ds_read_b64_tr_b16 v[98:99], v12 offset:25600
v_mfma_f32_16x16x32_bf16 v[188:191], v[44:47], v[76:79], v[188:191]
s_add_u32 s72, s70, 15360
buffer_load_dwordx4 v5, s[4:7], s72 offen offset:1024 lds
v_mfma_f32_16x16x32_bf16 v[184:187], v[44:47], v[72:75], v[184:187]
ds_read_b64_tr_b16 v[100:101], v13 offset:24576
v_mfma_f32_16x16x32_bf16 v[180:183], v[44:47], v[68:71], v[180:183]
ds_read_b64_tr_b16 v[102:103], v13 offset:25600
v_mfma_f32_16x16x32_bf16 v[176:179], v[44:47], v[64:67], v[176:179]
ds_read_b64_tr_b16 v[104:105], v14 offset:24576
v_mfma_f32_16x16x32_bf16 v[192:195], v[48:51], v[64:67], v[192:195]
ds_read_b64_tr_b16 v[106:107], v14 offset:25600
v_mfma_f32_16x16x32_bf16 v[196:199], v[48:51], v[68:71], v[196:199]
s_add_u32 s72, s70, 30720
buffer_load_dwordx4 v4, s[4:7], s72 offen offset:2048 lds
v_mfma_f32_16x16x32_bf16 v[200:203], v[48:51], v[72:75], v[200:203]
ds_read_b64_tr_b16 v[108:109], v15 offset:24576
v_mfma_f32_16x16x32_bf16 v[204:207], v[48:51], v[76:79], v[204:207]
ds_read_b64_tr_b16 v[110:111], v15 offset:25600
v_mfma_f32_16x16x32_bf16 v[220:223], v[52:55], v[76:79], v[220:223]
buffer_store_dwordx4 v[20:23], v1, s[44:47], s80 offen sc1
v_mfma_f32_16x16x32_bf16 v[216:219], v[52:55], v[72:75], v[216:219]
v_accvgpr_read_b32 v24, a200
v_accvgpr_read_b32 v28, a201
v_mfma_f32_16x16x32_bf16 v[212:215], v[52:55], v[68:71], v[212:215]
s_add_u32 s72, s70, 46080
buffer_load_dwordx4 v5, s[4:7], s72 offen offset:3072 lds
v_mfma_f32_16x16x32_bf16 v[208:211], v[52:55], v[64:67], v[208:211]
v_accvgpr_read_b32 v25, a202
v_accvgpr_read_b32 v29, a203
v_mfma_f32_16x16x32_bf16 v[224:227], v[56:59], v[64:67], v[224:227]
s_add_u32 s80, s78, 10240
v_accvgpr_read_b32 v26, a204
v_accvgpr_read_b32 v30, a205
v_mfma_f32_16x16x32_bf16 v[228:231], v[56:59], v[68:71], v[228:231]
v_accvgpr_read_b32 v27, a206
v_accvgpr_read_b32 v31, a207
v_mfma_f32_16x16x32_bf16 v[232:235], v[56:59], v[72:75], v[232:235]
v_cvt_pk_bf16_f32 v24, v24, v28
v_cvt_pk_bf16_f32 v25, v25, v29
v_mfma_f32_16x16x32_bf16 v[236:239], v[56:59], v[76:79], v[236:239]
v_cvt_pk_bf16_f32 v26, v26, v30
v_cvt_pk_bf16_f32 v27, v27, v31
v_mfma_f32_16x16x32_bf16 v[252:255], v[60:63], v[76:79], v[252:255]
buffer_store_dwordx4 v[24:27], v1, s[44:47], s80 offen sc1
v_mfma_f32_16x16x32_bf16 v[248:251], v[60:63], v[72:75], v[248:251]
v_mfma_f32_16x16x32_bf16 v[244:247], v[60:63], v[68:71], v[244:247]
s_waitcnt vmcnt(16) lgkmcnt(0)
v_mfma_f32_16x16x32_bf16 v[240:243], v[60:63], v[64:67], v[240:243]
s_barrier
v_mfma_f32_16x16x32_bf16 v[128:131], v[80:83], v[112:115], v[128:131]
s_add_u32 s73, s62, 10
ds_read_b64_tr_b16 v[32:33], v8 offset:32768
ds_read_b64_tr_b16 v[34:35], v8 offset:33792
v_mfma_f32_16x16x32_bf16 v[132:135], v[80:83], v[116:119], v[132:135]
s_add_u32 s70, s73, s65
ds_read_b128 v[64:67], v18 offset:32768
ds_read_b128 v[68:71], v18 offset:34816
v_mfma_f32_16x16x32_bf16 v[136:139], v[80:83], v[120:123], v[136:139]
s_and_b32 s70, s70, 3
ds_read_b128 v[72:75], v18 offset:36864
ds_read_b128 v[76:79], v18 offset:38912
v_mfma_f32_16x16x32_bf16 v[140:143], v[80:83], v[124:127], v[140:143]
s_and_b32 s73, s73, 12
ds_read_b64_tr_b16 v[36:37], v9 offset:32768
ds_read_b64_tr_b16 v[38:39], v9 offset:33792
v_mfma_f32_16x16x32_bf16 v[156:159], v[84:87], v[124:127], v[156:159]
s_or_b32 s73, s73, s70
ds_read_b64_tr_b16 v[40:41], v10 offset:32768
v_accvgpr_read_b32 v20, a72
v_mfma_f32_16x16x32_bf16 v[152:155], v[84:87], v[120:123], v[152:155]
s_lshl_b32 s71, s73, 19
ds_read_b64_tr_b16 v[42:43], v10 offset:33792
v_accvgpr_read_b32 v28, a73
v_mfma_f32_16x16x32_bf16 v[148:151], v[84:87], v[116:119], v[148:151]
s_add_u32 s71, s71, s66
ds_read_b64_tr_b16 v[44:45], v11 offset:32768
v_accvgpr_read_b32 v21, a74
v_mfma_f32_16x16x32_bf16 v[144:147], v[84:87], v[112:115], v[144:147]
s_lshl_b32 s73, s73, 7
ds_read_b64_tr_b16 v[46:47], v11 offset:33792
v_accvgpr_read_b32 v29, a75
v_mfma_f32_16x16x32_bf16 v[160:163], v[88:91], v[112:115], v[160:163]
s_add_u32 s69, s73, s67
ds_read_b64_tr_b16 v[48:49], v12 offset:32768
v_mfma_f32_16x16x32_bf16 v[164:167], v[88:91], v[116:119], v[164:167]
s_add_u32 s70, s73, s68
ds_read_b64_tr_b16 v[50:51], v12 offset:33792
v_mfma_f32_16x16x32_bf16 v[168:171], v[88:91], v[120:123], v[168:171]
s_add_u32 m0, s64, 16384
ds_read_b64_tr_b16 v[52:53], v13 offset:32768
v_mfma_f32_16x16x32_bf16 v[172:175], v[88:91], v[124:127], v[172:175]
s_add_u32 s72, s71, 0
buffer_load_dwordx4 v6, s[12:15], s72 offen lds
v_mfma_f32_16x16x32_bf16 v[188:191], v[92:95], v[124:127], v[188:191]
s_add_u32 s72, s71, 31744
buffer_load_dwordx4 v6, s[12:15], s72 offen offset:1024 lds
v_mfma_f32_16x16x32_bf16 v[184:187], v[92:95], v[120:123], v[184:187]
s_add_u32 s72, s71, 63488
buffer_load_dwordx4 v7, s[12:15], s72 offen offset:2048 lds
v_mfma_f32_16x16x32_bf16 v[180:183], v[92:95], v[116:119], v[180:183]
s_add_u32 s72, s71, 95232
buffer_load_dwordx4 v7, s[12:15], s72 offen offset:3072 lds
v_mfma_f32_16x16x32_bf16 v[176:179], v[92:95], v[112:115], v[176:179]
s_add_u32 s80, s77, 9216
ds_read_b64_tr_b16 v[54:55], v13 offset:33792
v_accvgpr_read_b32 v22, a104
v_mfma_f32_16x16x32_bf16 v[192:195], v[96:99], v[112:115], v[192:195]
ds_read_b64_tr_b16 v[56:57], v14 offset:32768
v_accvgpr_read_b32 v30, a105
v_mfma_f32_16x16x32_bf16 v[196:199], v[96:99], v[116:119], v[196:199]
ds_read_b64_tr_b16 v[58:59], v14 offset:33792
v_accvgpr_read_b32 v23, a106
v_mfma_f32_16x16x32_bf16 v[200:203], v[96:99], v[120:123], v[200:203]
ds_read_b64_tr_b16 v[60:61], v15 offset:32768
v_accvgpr_read_b32 v31, a107
v_mfma_f32_16x16x32_bf16 v[204:207], v[96:99], v[124:127], v[204:207]
s_add_u32 m0, s63, 65536
ds_read_b64_tr_b16 v[62:63], v15 offset:33792
v_mul_f32 v20, s79, v20
v_mfma_f32_16x16x32_bf16 v[220:223], v[100:103], v[124:127], v[220:223]
s_add_u32 s72, s69, 0
buffer_load_dwordx4 v4, s[4:7], s72 offen lds
v_mfma_f32_16x16x32_bf16 v[216:219], v[100:103], v[120:123], v[216:219]
v_mul_f32 v28, s79, v28
v_mul_f32 v21, s79, v21
v_mfma_f32_16x16x32_bf16 v[212:215], v[100:103], v[116:119], v[212:215]
v_mul_f32 v29, s79, v29
v_mul_f32 v22, s79, v22
v_mfma_f32_16x16x32_bf16 v[208:211], v[100:103], v[112:115], v[208:211]
v_mul_f32 v30, s79, v30
v_mul_f32 v23, s79, v23
v_mfma_f32_16x16x32_bf16 v[224:227], v[104:107], v[112:115], v[224:227]
s_add_u32 s72, s69, 15360
buffer_load_dwordx4 v5, s[4:7], s72 offen offset:1024 lds
v_mfma_f32_16x16x32_bf16 v[228:231], v[104:107], v[116:119], v[228:231]
v_mul_f32 v31, s79, v31
v_cvt_pk_bf16_f32 v20, v20, v28
v_mfma_f32_16x16x32_bf16 v[232:235], v[104:107], v[120:123], v[232:235]
v_cvt_pk_bf16_f32 v21, v21, v29
v_cvt_pk_bf16_f32 v22, v22, v30
v_mfma_f32_16x16x32_bf16 v[236:239], v[104:107], v[124:127], v[236:239]
v_cvt_pk_bf16_f32 v23, v23, v31
v_mfma_f32_16x16x32_bf16 v[252:255], v[108:111], v[124:127], v[252:255]
buffer_store_dwordx4 v[20:23], v1, s[44:47], s80 offen sc1
v_mfma_f32_16x16x32_bf16 v[248:251], v[108:111], v[120:123], v[248:251]
s_add_u32 s72, s69, 30720
buffer_load_dwordx4 v4, s[4:7], s72 offen offset:2048 lds
v_mfma_f32_16x16x32_bf16 v[244:247], v[108:111], v[116:119], v[244:247]
v_accvgpr_read_b32 v24, a208
v_accvgpr_read_b32 v28, a209
v_mfma_f32_16x16x32_bf16 v[240:243], v[108:111], v[112:115], v[240:243]
s_waitcnt lgkmcnt(0)
v_accvgpr_read_b32 v25, a210
v_accvgpr_read_b32 v29, a211
LcB1:
v_mfma_f32_16x16x32_bf16 v[128:131], v[32:35], v[64:67], v[128:131]
s_add_u32 s80, s78, 34816
ds_read_b64_tr_b16 v[80:81], v8 offset:40960
ds_read_b64_tr_b16 v[82:83], v8 offset:41984
v_mfma_f32_16x16x32_bf16 v[132:135], v[32:35], v[68:71], v[132:135]
ds_read_b128 v[112:115], v19 offset:32768
ds_read_b128 v[116:119], v19 offset:34816
v_mfma_f32_16x16x32_bf16 v[136:139], v[32:35], v[72:75], v[136:139]
s_add_u32 s72, s69, 46080
buffer_load_dwordx4 v5, s[4:7], s72 offen offset:3072 lds
v_mfma_f32_16x16x32_bf16 v[140:143], v[32:35], v[76:79], v[140:143]
ds_read_b128 v[120:123], v19 offset:36864
ds_read_b128 v[124:127], v19 offset:38912
v_mfma_f32_16x16x32_bf16 v[156:159], v[36:39], v[76:79], v[156:159]
ds_read_b64_tr_b16 v[84:85], v9 offset:40960
ds_read_b64_tr_b16 v[86:87], v9 offset:41984
v_mfma_f32_16x16x32_bf16 v[152:155], v[36:39], v[72:75], v[152:155]
ds_read_b64_tr_b16 v[88:89], v10 offset:40960
v_accvgpr_read_b32 v26, a212
v_mfma_f32_16x16x32_bf16 v[148:151], v[36:39], v[68:71], v[148:151]
ds_read_b64_tr_b16 v[90:91], v10 offset:41984
v_accvgpr_read_b32 v30, a213
v_mfma_f32_16x16x32_bf16 v[144:147], v[36:39], v[64:67], v[144:147]
s_add_u32 m0, s63, 69632
ds_read_b64_tr_b16 v[92:93], v11 offset:40960
v_accvgpr_read_b32 v27, a214
v_mfma_f32_16x16x32_bf16 v[160:163], v[40:43], v[64:67], v[160:163]
s_add_u32 s72, s70, 0
buffer_load_dwordx4 v4, s[4:7], s72 offen lds
v_mfma_f32_16x16x32_bf16 v[164:167], v[40:43], v[68:71], v[164:167]
ds_read_b64_tr_b16 v[94:95], v11 offset:41984
v_accvgpr_read_b32 v31, a215
v_mfma_f32_16x16x32_bf16 v[168:171], v[40:43], v[72:75], v[168:171]
ds_read_b64_tr_b16 v[96:97], v12 offset:40960
v_cvt_pk_bf16_f32 v24, v24, v28
v_mfma_f32_16x16x32_bf16 v[172:175], v[40:43], v[76:79], v[172:175]
ds_read_b64_tr_b16 v[98:99], v12 offset:41984
v_cvt_pk_bf16_f32 v25, v25, v29
v_mfma_f32_16x16x32_bf16 v[188:191], v[44:47], v[76:79], v[188:191]
s_add_u32 s72, s70, 15360
buffer_load_dwordx4 v5, s[4:7], s72 offen offset:1024 lds
v_mfma_f32_16x16x32_bf16 v[184:187], v[44:47], v[72:75], v[184:187]
ds_read_b64_tr_b16 v[100:101], v13 offset:40960
v_cvt_pk_bf16_f32 v26, v26, v30
v_mfma_f32_16x16x32_bf16 v[180:183], v[44:47], v[68:71], v[180:183]
ds_read_b64_tr_b16 v[102:103], v13 offset:41984
v_cvt_pk_bf16_f32 v27, v27, v31
v_mfma_f32_16x16x32_bf16 v[176:179], v[44:47], v[64:67], v[176:179]
ds_read_b64_tr_b16 v[104:105], v14 offset:40960
v_mfma_f32_16x16x32_bf16 v[192:195], v[48:51], v[64:67], v[192:195]
ds_read_b64_tr_b16 v[106:107], v14 offset:41984
v_mfma_f32_16x16x32_bf16 v[196:199], v[48:51], v[68:71], v[196:199]
s_add_u32 s72, s70, 30720
buffer_load_dwordx4 v4, s[4:7], s72 offen offset:2048 lds
v_mfma_f32_16x16x32_bf16 v[200:203], v[48:51], v[72:75], v[200:203]
ds_read_b64_tr_b16 v[108:109], v15 offset:40960
v_mfma_f32_16x16x32_bf16 v[204:207], v[48:51], v[76:79], v[204:207]
ds_read_b64_tr_b16 v[110:111], v15 offset:41984
v_mfma_f32_16x16x32_bf16 v[220:223], v[52:55], v[76:79], v[220:223]
buffer_store_dwordx4 v[24:27], v1, s[44:47], s80 offen sc1
v_mfma_f32_16x16x32_bf16 v[216:219], v[52:55], v[72:75], v[216:219]
v_accvgpr_read_b32 v20, a76
v_accvgpr_read_b32 v28, a77
v_mfma_f32_16x16x32_bf16 v[212:215], v[52:55], v[68:71], v[212:215]
s_add_u32 s72, s70, 46080
buffer_load_dwordx4 v5, s[4:7], s72 offen offset:3072 lds
v_mfma_f32_16x16x32_bf16 v[208:211], v[52:55], v[64:67], v[208:211]
v_accvgpr_read_b32 v21, a78
v_accvgpr_read_b32 v29, a79
v_mfma_f32_16x16x32_bf16 v[224:227], v[56:59], v[64:67], v[224:227]
s_add_u32 s80, s77, 13312
v_accvgpr_read_b32 v22, a108
v_accvgpr_read_b32 v30, a109
v_mfma_f32_16x16x32_bf16 v[228:231], v[56:59], v[68:71], v[228:231]
v_accvgpr_read_b32 v23, a110
v_accvgpr_read_b32 v31, a111
v_mfma_f32_16x16x32_bf16 v[232:235], v[56:59], v[72:75], v[232:235]
v_mul_f32 v20, s79, v20
v_mul_f32 v28, s79, v28
v_mfma_f32_16x16x32_bf16 v[236:239], v[56:59], v[76:79], v[236:239]
v_mul_f32 v21, s79, v21
v_mul_f32 v29, s79, v29
v_mfma_f32_16x16x32_bf16 v[252:255], v[60:63], v[76:79], v[252:255]
v_mul_f32 v22, s79, v22
v_mul_f32 v30, s79, v30
v_mfma_f32_16x16x32_bf16 v[248:251], v[60:63], v[72:75], v[248:251]
v_mul_f32 v23, s79, v23
v_mul_f32 v31, s79, v31
v_mfma_f32_16x16x32_bf16 v[244:247], v[60:63], v[68:71], v[244:247]
s_waitcnt vmcnt(15) lgkmcnt(0)
v_cvt_pk_bf16_f32 v20, v20, v28
v_cvt_pk_bf16_f32 v21, v21, v29
v_mfma_f32_16x16x32_bf16 v[240:243], v[60:63], v[64:67], v[240:243]
s_barrier
v_cvt_pk_bf16_f32 v22, v22, v30
v_cvt_pk_bf16_f32 v23, v23, v31
v_mfma_f32_16x16x32_bf16 v[128:131], v[80:83], v[112:115], v[128:131]
s_add_u32 s73, s62, 11
ds_read_b64_tr_b16 v[32:33], v8 offset:0
ds_read_b64_tr_b16 v[34:35], v8 offset:1024
v_mfma_f32_16x16x32_bf16 v[132:135], v[80:83], v[116:119], v[132:135]
s_add_u32 s70, s73, s65
ds_read_b128 v[64:67], v16 offset:0
ds_read_b128 v[68:71], v16 offset:2048
v_mfma_f32_16x16x32_bf16 v[136:139], v[80:83], v[120:123], v[136:139]
s_and_b32 s70, s70, 3
ds_read_b128 v[72:75], v16 offset:4096
ds_read_b128 v[76:79], v16 offset:6144
v_mfma_f32_16x16x32_bf16 v[140:143], v[80:83], v[124:127], v[140:143]
s_and_b32 s73, s73, 12
ds_read_b64_tr_b16 v[36:37], v9 offset:0
ds_read_b64_tr_b16 v[38:39], v9 offset:1024
v_mfma_f32_16x16x32_bf16 v[156:159], v[84:87], v[124:127], v[156:159]
s_or_b32 s73, s73, s70
ds_read_b64_tr_b16 v[40:41], v10 offset:0
v_mfma_f32_16x16x32_bf16 v[152:155], v[84:87], v[120:123], v[152:155]
s_lshl_b32 s71, s73, 19
ds_read_b64_tr_b16 v[42:43], v10 offset:1024
v_mfma_f32_16x16x32_bf16 v[148:151], v[84:87], v[116:119], v[148:151]
s_add_u32 s71, s71, s66
ds_read_b64_tr_b16 v[44:45], v11 offset:0
v_mfma_f32_16x16x32_bf16 v[144:147], v[84:87], v[112:115], v[144:147]
s_lshl_b32 s73, s73, 7
ds_read_b64_tr_b16 v[46:47], v11 offset:1024
v_mfma_f32_16x16x32_bf16 v[160:163], v[88:91], v[112:115], v[160:163]
s_add_u32 s69, s73, s67
ds_read_b64_tr_b16 v[48:49], v12 offset:0
v_mfma_f32_16x16x32_bf16 v[164:167], v[88:91], v[116:119], v[164:167]
s_add_u32 s70, s73, s68
ds_read_b64_tr_b16 v[50:51], v12 offset:1024
v_mfma_f32_16x16x32_bf16 v[168:171], v[88:91], v[120:123], v[168:171]
s_add_u32 m0, s64, 32768
ds_read_b64_tr_b16 v[52:53], v13 offset:0
v_mfma_f32_16x16x32_bf16 v[172:175], v[88:91], v[124:127], v[172:175]
s_add_u32 s72, s71, 0
buffer_load_dwordx4 v6, s[12:15], s72 offen lds
v_mfma_f32_16x16x32_bf16 v[188:191], v[92:95], v[124:127], v[188:191]
s_add_u32 s72, s71, 31744
buffer_load_dwordx4 v6, s[12:15], s72 offen offset:1024 lds
v_mfma_f32_16x16x32_bf16 v[184:187], v[92:95], v[120:123], v[184:187]
s_add_u32 s72, s71, 63488
buffer_load_dwordx4 v7, s[12:15], s72 offen offset:2048 lds
v_mfma_f32_16x16x32_bf16 v[180:183], v[92:95], v[116:119], v[180:183]
s_add_u32 s72, s71, 95232
buffer_load_dwordx4 v7, s[12:15], s72 offen offset:3072 lds
v_mfma_f32_16x16x32_bf16 v[176:179], v[92:95], v[112:115], v[176:179]
ds_read_b64_tr_b16 v[54:55], v13 offset:1024
v_mfma_f32_16x16x32_bf16 v[192:195], v[96:99], v[112:115], v[192:195]
ds_read_b64_tr_b16 v[56:57], v14 offset:0
v_mfma_f32_16x16x32_bf16 v[196:199], v[96:99], v[116:119], v[196:199]
ds_read_b64_tr_b16 v[58:59], v14 offset:1024
v_mfma_f32_16x16x32_bf16 v[200:203], v[96:99], v[120:123], v[200:203]
ds_read_b64_tr_b16 v[60:61], v15 offset:0
v_mfma_f32_16x16x32_bf16 v[204:207], v[96:99], v[124:127], v[204:207]
s_add_u32 m0, s63, 98304
ds_read_b64_tr_b16 v[62:63], v15 offset:1024
v_mfma_f32_16x16x32_bf16 v[220:223], v[100:103], v[124:127], v[220:223]
s_add_u32 s72, s69, 0
buffer_load_dwordx4 v4, s[4:7], s72 offen lds
v_mfma_f32_16x16x32_bf16 v[216:219], v[100:103], v[120:123], v[216:219]
buffer_store_dwordx4 v[20:23], v1, s[44:47], s80 offen sc1
v_mfma_f32_16x16x32_bf16 v[212:215], v[100:103], v[116:119], v[212:215]
v_accvgpr_read_b32 v24, a216
v_accvgpr_read_b32 v28, a217
v_mfma_f32_16x16x32_bf16 v[208:211], v[100:103], v[112:115], v[208:211]
v_accvgpr_read_b32 v25, a218
v_accvgpr_read_b32 v29, a219
v_mfma_f32_16x16x32_bf16 v[224:227], v[104:107], v[112:115], v[224:227]
s_add_u32 s72, s69, 15360
buffer_load_dwordx4 v5, s[4:7], s72 offen offset:1024 lds
v_mfma_f32_16x16x32_bf16 v[228:231], v[104:107], v[116:119], v[228:231]
s_add_u32 s80, s78, 43008
v_accvgpr_read_b32 v26, a220
v_accvgpr_read_b32 v30, a221
v_mfma_f32_16x16x32_bf16 v[232:235], v[104:107], v[120:123], v[232:235]
v_accvgpr_read_b32 v27, a222
v_accvgpr_read_b32 v31, a223
v_mfma_f32_16x16x32_bf16 v[236:239], v[104:107], v[124:127], v[236:239]
v_cvt_pk_bf16_f32 v24, v24, v28
v_cvt_pk_bf16_f32 v25, v25, v29
v_mfma_f32_16x16x32_bf16 v[252:255], v[108:111], v[124:127], v[252:255]
v_cvt_pk_bf16_f32 v26, v26, v30
v_cvt_pk_bf16_f32 v27, v27, v31
v_mfma_f32_16x16x32_bf16 v[248:251], v[108:111], v[120:123], v[248:251]
s_add_u32 s72, s69, 30720
buffer_load_dwordx4 v4, s[4:7], s72 offen offset:2048 lds
v_mfma_f32_16x16x32_bf16 v[244:247], v[108:111], v[116:119], v[244:247]
buffer_store_dwordx4 v[24:27], v1, s[44:47], s80 offen sc1
v_mfma_f32_16x16x32_bf16 v[240:243], v[108:111], v[112:115], v[240:243]
s_waitcnt lgkmcnt(0)
v_mfma_f32_16x16x32_bf16 v[128:131], v[32:35], v[64:67], v[128:131]
ds_read_b64_tr_b16 v[80:81], v8 offset:8192
ds_read_b64_tr_b16 v[82:83], v8 offset:9216
v_mfma_f32_16x16x32_bf16 v[132:135], v[32:35], v[68:71], v[132:135]
ds_read_b128 v[112:115], v17 offset:0
ds_read_b128 v[116:119], v17 offset:2048
v_mfma_f32_16x16x32_bf16 v[136:139], v[32:35], v[72:75], v[136:139]
s_add_u32 s72, s69, 46080
buffer_load_dwordx4 v5, s[4:7], s72 offen offset:3072 lds
v_mfma_f32_16x16x32_bf16 v[140:143], v[32:35], v[76:79], v[140:143]
ds_read_b128 v[120:123], v17 offset:4096
ds_read_b128 v[124:127], v17 offset:6144
v_mfma_f32_16x16x32_bf16 v[156:159], v[36:39], v[76:79], v[156:159]
ds_read_b64_tr_b16 v[84:85], v9 offset:8192
ds_read_b64_tr_b16 v[86:87], v9 offset:9216
v_mfma_f32_16x16x32_bf16 v[152:155], v[36:39], v[72:75], v[152:155]
ds_read_b64_tr_b16 v[88:89], v10 offset:8192
v_accvgpr_read_b32 v20, a80
v_mfma_f32_16x16x32_bf16 v[148:151], v[36:39], v[68:71], v[148:151]
ds_read_b64_tr_b16 v[90:91], v10 offset:9216
v_accvgpr_read_b32 v28, a81
v_mfma_f32_16x16x32_bf16 v[144:147], v[36:39], v[64:67], v[144:147]
s_add_u32 m0, s63, 102400
ds_read_b64_tr_b16 v[92:93], v11 offset:8192
v_accvgpr_read_b32 v21, a82
v_mfma_f32_16x16x32_bf16 v[160:163], v[40:43], v[64:67], v[160:163]
s_add_u32 s72, s70, 0
buffer_load_dwordx4 v4, s[4:7], s72 offen lds
v_mfma_f32_16x16x32_bf16 v[164:167], v[40:43], v[68:71], v[164:167]
ds_read_b64_tr_b16 v[94:95], v11 offset:9216
v_accvgpr_read_b32 v29, a83
v_mfma_f32_16x16x32_bf16 v[168:171], v[40:43], v[72:75], v[168:171]
s_add_u32 s80, s77, 33792
ds_read_b64_tr_b16 v[96:97], v12 offset:8192
v_accvgpr_read_b32 v22, a112
v_mfma_f32_16x16x32_bf16 v[172:175], v[40:43], v[76:79], v[172:175]
ds_read_b64_tr_b16 v[98:99], v12 offset:9216
v_accvgpr_read_b32 v30, a113
v_mfma_f32_16x16x32_bf16 v[188:191], v[44:47], v[76:79], v[188:191]
s_add_u32 s72, s70, 15360
buffer_load_dwordx4 v5, s[4:7], s72 offen offset:1024 lds
v_mfma_f32_16x16x32_bf16 v[184:187], v[44:47], v[72:75], v[184:187]
ds_read_b64_tr_b16 v[100:101], v13 offset:8192
v_accvgpr_read_b32 v23, a114
v_mfma_f32_16x16x32_bf16 v[180:183], v[44:47], v[68:71], v[180:183]
ds_read_b64_tr_b16 v[102:103], v13 offset:9216
v_accvgpr_read_b32 v31, a115
v_mfma_f32_16x16x32_bf16 v[176:179], v[44:47], v[64:67], v[176:179]
ds_read_b64_tr_b16 v[104:105], v14 offset:8192
v_mul_f32 v20, s79, v20
v_mfma_f32_16x16x32_bf16 v[192:195], v[48:51], v[64:67], v[192:195]
ds_read_b64_tr_b16 v[106:107], v14 offset:9216
v_mul_f32 v28, s79, v28
v_mfma_f32_16x16x32_bf16 v[196:199], v[48:51], v[68:71], v[196:199]
s_add_u32 s72, s70, 30720
buffer_load_dwordx4 v4, s[4:7], s72 offen offset:2048 lds
v_mfma_f32_16x16x32_bf16 v[200:203], v[48:51], v[72:75], v[200:203]
ds_read_b64_tr_b16 v[108:109], v15 offset:8192
v_mul_f32 v21, s79, v21
v_mfma_f32_16x16x32_bf16 v[204:207], v[48:51], v[76:79], v[204:207]
ds_read_b64_tr_b16 v[110:111], v15 offset:9216
v_mul_f32 v29, s79, v29
v_mfma_f32_16x16x32_bf16 v[220:223], v[52:55], v[76:79], v[220:223]
v_mul_f32 v22, s79, v22
v_mul_f32 v30, s79, v30
v_mfma_f32_16x16x32_bf16 v[216:219], v[52:55], v[72:75], v[216:219]
v_mul_f32 v23, s79, v23
v_mul_f32 v31, s79, v31
v_mfma_f32_16x16x32_bf16 v[212:215], v[52:55], v[68:71], v[212:215]
s_add_u32 s72, s70, 46080
buffer_load_dwordx4 v5, s[4:7], s72 offen offset:3072 lds
v_mfma_f32_16x16x32_bf16 v[208:211], v[52:55], v[64:67], v[208:211]
v_cvt_pk_bf16_f32 v20, v20, v28
v_cvt_pk_bf16_f32 v21, v21, v29
v_mfma_f32_16x16x32_bf16 v[224:227], v[56:59], v[64:67], v[224:227]
v_cvt_pk_bf16_f32 v22, v22, v30
v_cvt_pk_bf16_f32 v23, v23, v31
v_mfma_f32_16x16x32_bf16 v[228:231], v[56:59], v[68:71], v[228:231]
buffer_store_dwordx4 v[20:23], v1, s[44:47], s80 offen sc1
v_mfma_f32_16x16x32_bf16 v[232:235], v[56:59], v[72:75], v[232:235]
v_accvgpr_read_b32 v24, a224
v_accvgpr_read_b32 v28, a225
v_mfma_f32_16x16x32_bf16 v[236:239], v[56:59], v[76:79], v[236:239]
v_accvgpr_read_b32 v25, a226
v_accvgpr_read_b32 v29, a227
v_mfma_f32_16x16x32_bf16 v[252:255], v[60:63], v[76:79], v[252:255]
s_add_u32 s80, s78, 3072
v_accvgpr_read_b32 v26, a228
v_accvgpr_read_b32 v30, a229
v_mfma_f32_16x16x32_bf16 v[248:251], v[60:63], v[72:75], v[248:251]
v_accvgpr_read_b32 v27, a230
v_accvgpr_read_b32 v31, a231
v_mfma_f32_16x16x32_bf16 v[244:247], v[60:63], v[68:71], v[244:247]
s_waitcnt vmcnt(15) lgkmcnt(0)
v_cvt_pk_bf16_f32 v24, v24, v28
v_cvt_pk_bf16_f32 v25, v25, v29
v_mfma_f32_16x16x32_bf16 v[240:243], v[60:63], v[64:67], v[240:243]
s_barrier
v_cvt_pk_bf16_f32 v26, v26, v30
v_cvt_pk_bf16_f32 v27, v27, v31
v_mfma_f32_16x16x32_bf16 v[128:131], v[80:83], v[112:115], v[128:131]
s_add_u32 s73, s62, 12
ds_read_b64_tr_b16 v[32:33], v8 offset:16384
ds_read_b64_tr_b16 v[34:35], v8 offset:17408
v_mfma_f32_16x16x32_bf16 v[132:135], v[80:83], v[116:119], v[132:135]
s_add_u32 s70, s73, s65
ds_read_b128 v[64:67], v18 offset:0
ds_read_b128 v[68:71], v18 offset:2048
v_mfma_f32_16x16x32_bf16 v[136:139], v[80:83], v[120:123], v[136:139]
s_and_b32 s70, s70, 3
ds_read_b128 v[72:75], v18 offset:4096
ds_read_b128 v[76:79], v18 offset:6144
v_mfma_f32_16x16x32_bf16 v[140:143], v[80:83], v[124:127], v[140:143]
s_and_b32 s73, s73, 12
ds_read_b64_tr_b16 v[36:37], v9 offset:16384
ds_read_b64_tr_b16 v[38:39], v9 offset:17408
v_mfma_f32_16x16x32_bf16 v[156:159], v[84:87], v[124:127], v[156:159]
s_or_b32 s73, s73, s70
ds_read_b64_tr_b16 v[40:41], v10 offset:16384
v_mfma_f32_16x16x32_bf16 v[152:155], v[84:87], v[120:123], v[152:155]
s_lshl_b32 s71, s73, 19
ds_read_b64_tr_b16 v[42:43], v10 offset:17408
v_mfma_f32_16x16x32_bf16 v[148:151], v[84:87], v[116:119], v[148:151]
s_add_u32 s71, s71, s66
ds_read_b64_tr_b16 v[44:45], v11 offset:16384
v_mfma_f32_16x16x32_bf16 v[144:147], v[84:87], v[112:115], v[144:147]
s_lshl_b32 s73, s73, 7
ds_read_b64_tr_b16 v[46:47], v11 offset:17408
v_mfma_f32_16x16x32_bf16 v[160:163], v[88:91], v[112:115], v[160:163]
s_add_u32 s69, s73, s67
ds_read_b64_tr_b16 v[48:49], v12 offset:16384
v_mfma_f32_16x16x32_bf16 v[164:167], v[88:91], v[116:119], v[164:167]
s_add_u32 s70, s73, s68
ds_read_b64_tr_b16 v[50:51], v12 offset:17408
v_mfma_f32_16x16x32_bf16 v[168:171], v[88:91], v[120:123], v[168:171]
s_add_u32 m0, s64, 0
ds_read_b64_tr_b16 v[52:53], v13 offset:16384
v_mfma_f32_16x16x32_bf16 v[172:175], v[88:91], v[124:127], v[172:175]
s_add_u32 s72, s71, 0
buffer_load_dwordx4 v6, s[12:15], s72 offen lds
v_mfma_f32_16x16x32_bf16 v[188:191], v[92:95], v[124:127], v[188:191]
s_add_u32 s72, s71, 31744
buffer_load_dwordx4 v6, s[12:15], s72 offen offset:1024 lds
v_mfma_f32_16x16x32_bf16 v[184:187], v[92:95], v[120:123], v[184:187]
s_add_u32 s72, s71, 63488
buffer_load_dwordx4 v7, s[12:15], s72 offen offset:2048 lds
v_mfma_f32_16x16x32_bf16 v[180:183], v[92:95], v[116:119], v[180:183]
s_add_u32 s72, s71, 95232
buffer_load_dwordx4 v7, s[12:15], s72 offen offset:3072 lds
v_mfma_f32_16x16x32_bf16 v[176:179], v[92:95], v[112:115], v[176:179]
ds_read_b64_tr_b16 v[54:55], v13 offset:17408
v_mfma_f32_16x16x32_bf16 v[192:195], v[96:99], v[112:115], v[192:195]
ds_read_b64_tr_b16 v[56:57], v14 offset:16384
v_mfma_f32_16x16x32_bf16 v[196:199], v[96:99], v[116:119], v[196:199]
ds_read_b64_tr_b16 v[58:59], v14 offset:17408
v_mfma_f32_16x16x32_bf16 v[200:203], v[96:99], v[120:123], v[200:203]
ds_read_b64_tr_b16 v[60:61], v15 offset:16384
v_mfma_f32_16x16x32_bf16 v[204:207], v[96:99], v[124:127], v[204:207]
s_add_u32 m0, s63, 131072
ds_read_b64_tr_b16 v[62:63], v15 offset:17408
v_mfma_f32_16x16x32_bf16 v[220:223], v[100:103], v[124:127], v[220:223]
s_add_u32 s72, s69, 0
buffer_load_dwordx4 v4, s[4:7], s72 offen lds
v_mfma_f32_16x16x32_bf16 v[216:219], v[100:103], v[120:123], v[216:219]
buffer_store_dwordx4 v[24:27], v1, s[44:47], s80 offen sc1
v_mfma_f32_16x16x32_bf16 v[212:215], v[100:103], v[116:119], v[212:215]
v_accvgpr_read_b32 v20, a84
v_accvgpr_read_b32 v28, a85
v_mfma_f32_16x16x32_bf16 v[208:211], v[100:103], v[112:115], v[208:211]
v_accvgpr_read_b32 v21, a86
v_accvgpr_read_b32 v29, a87
v_mfma_f32_16x16x32_bf16 v[224:227], v[104:107], v[112:115], v[224:227]
s_add_u32 s72, s69, 15360
buffer_load_dwordx4 v5, s[4:7], s72 offen offset:1024 lds
v_mfma_f32_16x16x32_bf16 v[228:231], v[104:107], v[116:119], v[228:231]
s_add_u32 s80, s77, 37888
v_accvgpr_read_b32 v22, a116
v_accvgpr_read_b32 v30, a117
v_mfma_f32_16x16x32_bf16 v[232:235], v[104:107], v[120:123], v[232:235]
v_accvgpr_read_b32 v23, a118
v_accvgpr_read_b32 v31, a119
v_mfma_f32_16x16x32_bf16 v[236:239], v[104:107], v[124:127], v[236:239]
v_mul_f32 v20, s79, v20
v_mul_f32 v28, s79, v28
v_mfma_f32_16x16x32_bf16 v[252:255], v[108:111], v[124:127], v[252:255]
v_mul_f32 v21, s79, v21
v_mul_f32 v29, s79, v29
v_mfma_f32_16x16x32_bf16 v[248:251], v[108:111], v[120:123], v[248:251]
s_add_u32 s72, s69, 30720
buffer_load_dwordx4 v4, s[4:7], s72 offen offset:2048 lds
v_mfma_f32_16x16x32_bf16 v[244:247], v[108:111], v[116:119], v[244:247]
v_mul_f32 v22, s79, v22
v_mul_f32 v30, s79, v30
v_mfma_f32_16x16x32_bf16 v[240:243], v[108:111], v[112:115], v[240:243]
s_waitcnt lgkmcnt(0)
v_mul_f32 v23, s79, v23
v_mul_f32 v31, s79, v31
v_mfma_f32_16x16x32_bf16 v[128:131], v[32:35], v[64:67], v[128:131]
ds_read_b64_tr_b16 v[80:81], v8 offset:24576
ds_read_b64_tr_b16 v[82:83], v8 offset:25600
v_mfma_f32_16x16x32_bf16 v[132:135], v[32:35], v[68:71], v[132:135]
ds_read_b128 v[112:115], v19 offset:0
ds_read_b128 v[116:119], v19 offset:2048
v_mfma_f32_16x16x32_bf16 v[136:139], v[32:35], v[72:75], v[136:139]
s_add_u32 s72, s69, 46080
buffer_load_dwordx4 v5, s[4:7], s72 offen offset:3072 lds
v_mfma_f32_16x16x32_bf16 v[140:143], v[32:35], v[76:79], v[140:143]
ds_read_b128 v[120:123], v19 offset:4096
ds_read_b128 v[124:127], v19 offset:6144
v_mfma_f32_16x16x32_bf16 v[156:159], v[36:39], v[76:79], v[156:159]
ds_read_b64_tr_b16 v[84:85], v9 offset:24576
ds_read_b64_tr_b16 v[86:87], v9 offset:25600
v_mfma_f32_16x16x32_bf16 v[152:155], v[36:39], v[72:75], v[152:155]
ds_read_b64_tr_b16 v[88:89], v10 offset:24576
v_cvt_pk_bf16_f32 v20, v20, v28
v_mfma_f32_16x16x32_bf16 v[148:151], v[36:39], v[68:71], v[148:151]
ds_read_b64_tr_b16 v[90:91], v10 offset:25600
v_cvt_pk_bf16_f32 v21, v21, v29
v_mfma_f32_16x16x32_bf16 v[144:147], v[36:39], v[64:67], v[144:147]
s_add_u32 m0, s63, 135168
ds_read_b64_tr_b16 v[92:93], v11 offset:24576
v_cvt_pk_bf16_f32 v22, v22, v30
v_mfma_f32_16x16x32_bf16 v[160:163], v[40:43], v[64:67], v[160:163]
s_add_u32 s72, s70, 0
buffer_load_dwordx4 v4, s[4:7], s72 offen lds
v_mfma_f32_16x16x32_bf16 v[164:167], v[40:43], v[68:71], v[164:167]
ds_read_b64_tr_b16 v[94:95], v11 offset:25600
v_cvt_pk_bf16_f32 v23, v23, v31
v_mfma_f32_16x16x32_bf16 v[168:171], v[40:43], v[72:75], v[168:171]
ds_read_b64_tr_b16 v[96:97], v12 offset:24576
v_mfma_f32_16x16x32_bf16 v[172:175], v[40:43], v[76:79], v[172:175]
ds_read_b64_tr_b16 v[98:99], v12 offset:25600
v_mfma_f32_16x16x32_bf16 v[188:191], v[44:47], v[76:79], v[188:191]
s_add_u32 s72, s70, 15360
buffer_load_dwordx4 v5, s[4:7], s72 offen offset:1024 lds
v_mfma_f32_16x16x32_bf16 v[184:187], v[44:47], v[72:75], v[184:187]
ds_read_b64_tr_b16 v[100:101], v13 offset:24576
v_mfma_f32_16x16x32_bf16 v[180:183], v[44:47], v[68:71], v[180:183]
ds_read_b64_tr_b16 v[102:103], v13 offset:25600
v_mfma_f32_16x16x32_bf16 v[176:179], v[44:47], v[64:67], v[176:179]
ds_read_b64_tr_b16 v[104:105], v14 offset:24576
v_mfma_f32_16x16x32_bf16 v[192:195], v[48:51], v[64:67], v[192:195]
ds_read_b64_tr_b16 v[106:107], v14 offset:25600
v_mfma_f32_16x16x32_bf16 v[196:199], v[48:51], v[68:71], v[196:199]
s_add_u32 s72, s70, 30720
buffer_load_dwordx4 v4, s[4:7], s72 offen offset:2048 lds
v_mfma_f32_16x16x32_bf16 v[200:203], v[48:51], v[72:75], v[200:203]
ds_read_b64_tr_b16 v[108:109], v15 offset:24576
v_mfma_f32_16x16x32_bf16 v[204:207], v[48:51], v[76:79], v[204:207]
ds_read_b64_tr_b16 v[110:111], v15 offset:25600
v_mfma_f32_16x16x32_bf16 v[220:223], v[52:55], v[76:79], v[220:223]
buffer_store_dwordx4 v[20:23], v1, s[44:47], s80 offen sc1
v_mfma_f32_16x16x32_bf16 v[216:219], v[52:55], v[72:75], v[216:219]
v_accvgpr_read_b32 v24, a232
v_accvgpr_read_b32 v28, a233
v_mfma_f32_16x16x32_bf16 v[212:215], v[52:55], v[68:71], v[212:215]
s_add_u32 s72, s70, 46080
buffer_load_dwordx4 v5, s[4:7], s72 offen offset:3072 lds
v_mfma_f32_16x16x32_bf16 v[208:211], v[52:55], v[64:67], v[208:211]
v_accvgpr_read_b32 v25, a234
v_accvgpr_read_b32 v29, a235
v_mfma_f32_16x16x32_bf16 v[224:227], v[56:59], v[64:67], v[224:227]
s_add_u32 s80, s78, 11264
v_accvgpr_read_b32 v26, a236
v_accvgpr_read_b32 v30, a237
v_mfma_f32_16x16x32_bf16 v[228:231], v[56:59], v[68:71], v[228:231]
v_accvgpr_read_b32 v27, a238
v_accvgpr_read_b32 v31, a239
v_mfma_f32_16x16x32_bf16 v[232:235], v[56:59], v[72:75], v[232:235]
v_cvt_pk_bf16_f32 v24, v24, v28
v_cvt_pk_bf16_f32 v25, v25, v29
v_mfma_f32_16x16x32_bf16 v[236:239], v[56:59], v[76:79], v[236:239]
v_cvt_pk_bf16_f32 v26, v26, v30
v_cvt_pk_bf16_f32 v27, v27, v31
v_mfma_f32_16x16x32_bf16 v[252:255], v[60:63], v[76:79], v[252:255]
buffer_store_dwordx4 v[24:27], v1, s[44:47], s80 offen sc1
v_mfma_f32_16x16x32_bf16 v[248:251], v[60:63], v[72:75], v[248:251]
v_mfma_f32_16x16x32_bf16 v[244:247], v[60:63], v[68:71], v[244:247]
s_waitcnt vmcnt(16) lgkmcnt(0)
v_mfma_f32_16x16x32_bf16 v[240:243], v[60:63], v[64:67], v[240:243]
s_barrier
v_mfma_f32_16x16x32_bf16 v[128:131], v[80:83], v[112:115], v[128:131]
s_add_u32 s73, s62, 13
ds_read_b64_tr_b16 v[32:33], v8 offset:32768
ds_read_b64_tr_b16 v[34:35], v8 offset:33792
v_mfma_f32_16x16x32_bf16 v[132:135], v[80:83], v[116:119], v[132:135]
s_add_u32 s70, s73, s65
ds_read_b128 v[64:67], v18 offset:32768
ds_read_b128 v[68:71], v18 offset:34816
v_mfma_f32_16x16x32_bf16 v[136:139], v[80:83], v[120:123], v[136:139]
s_and_b32 s70, s70, 3
v_and_b32 v2, 31, v0
v_lshlrev_b32 v2, 2, v2
v_mfma_f32_16x16x32_bf16 v[140:143], v[80:83], v[124:127], v[140:143]
s_and_b32 s73, s73, 12
buffer_load_dword v3, v2, s[48:51], 0 offen sc1
v_mfma_f32_16x16x32_bf16 v[156:159], v[84:87], v[124:127], v[156:159]
s_or_b32 s73, s73, s70
ds_read_b128 v[72:75], v18 offset:36864
ds_read_b128 v[76:79], v18 offset:38912
v_mfma_f32_16x16x32_bf16 v[152:155], v[84:87], v[120:123], v[152:155]
s_lshl_b32 s71, s73, 19
ds_read_b64_tr_b16 v[36:37], v9 offset:32768
ds_read_b64_tr_b16 v[38:39], v9 offset:33792
v_mfma_f32_16x16x32_bf16 v[148:151], v[84:87], v[116:119], v[148:151]
s_add_u32 s71, s71, s66
ds_read_b64_tr_b16 v[40:41], v10 offset:32768
v_accvgpr_read_b32 v20, a88
v_mfma_f32_16x16x32_bf16 v[144:147], v[84:87], v[112:115], v[144:147]
s_lshl_b32 s73, s73, 7
ds_read_b64_tr_b16 v[42:43], v10 offset:33792
v_accvgpr_read_b32 v28, a89
v_mfma_f32_16x16x32_bf16 v[160:163], v[88:91], v[112:115], v[160:163]
s_add_u32 s69, s73, s67
ds_read_b64_tr_b16 v[44:45], v11 offset:32768
v_accvgpr_read_b32 v21, a90
v_mfma_f32_16x16x32_bf16 v[164:167], v[88:91], v[116:119], v[164:167]
s_add_u32 s70, s73, s68
ds_read_b64_tr_b16 v[46:47], v11 offset:33792
v_accvgpr_read_b32 v29, a91
v_mfma_f32_16x16x32_bf16 v[168:171], v[88:91], v[120:123], v[168:171]
s_add_u32 m0, s64, 16384
ds_read_b64_tr_b16 v[48:49], v12 offset:32768
v_mfma_f32_16x16x32_bf16 v[172:175], v[88:91], v[124:127], v[172:175]
s_add_u32 s72, s71, 0
buffer_load_dwordx4 v6, s[12:15], s72 offen lds
v_mfma_f32_16x16x32_bf16 v[188:191], v[92:95], v[124:127], v[188:191]
s_add_u32 s72, s71, 31744
buffer_load_dwordx4 v6, s[12:15], s72 offen offset:1024 lds
v_mfma_f32_16x16x32_bf16 v[184:187], v[92:95], v[120:123], v[184:187]
s_add_u32 s72, s71, 63488
buffer_load_dwordx4 v7, s[12:15], s72 offen offset:2048 lds
v_mfma_f32_16x16x32_bf16 v[180:183], v[92:95], v[116:119], v[180:183]
s_add_u32 s72, s71, 95232
buffer_load_dwordx4 v7, s[12:15], s72 offen offset:3072 lds
v_mfma_f32_16x16x32_bf16 v[176:179], v[92:95], v[112:115], v[176:179]
s_add_u32 s80, s77, 41984
ds_read_b64_tr_b16 v[50:51], v12 offset:33792
v_accvgpr_read_b32 v22, a120
v_mfma_f32_16x16x32_bf16 v[192:195], v[96:99], v[112:115], v[192:195]
ds_read_b64_tr_b16 v[52:53], v13 offset:32768
v_accvgpr_read_b32 v30, a121
v_mfma_f32_16x16x32_bf16 v[196:199], v[96:99], v[116:119], v[196:199]
ds_read_b64_tr_b16 v[54:55], v13 offset:33792
v_accvgpr_read_b32 v23, a122
v_mfma_f32_16x16x32_bf16 v[200:203], v[96:99], v[120:123], v[200:203]
ds_read_b64_tr_b16 v[56:57], v14 offset:32768
v_accvgpr_read_b32 v31, a123
v_mfma_f32_16x16x32_bf16 v[204:207], v[96:99], v[124:127], v[204:207]
s_add_u32 m0, s63, 65536
ds_read_b64_tr_b16 v[58:59], v14 offset:33792
v_mul_f32 v20, s79, v20
v_mfma_f32_16x16x32_bf16 v[220:223], v[100:103], v[124:127], v[220:223]
s_add_u32 s72, s69, 0
buffer_load_dwordx4 v4, s[4:7], s72 offen lds
v_mfma_f32_16x16x32_bf16 v[216:219], v[100:103], v[120:123], v[216:219]
ds_read_b64_tr_b16 v[60:61], v15 offset:32768
v_mul_f32 v28, s79, v28
v_mfma_f32_16x16x32_bf16 v[212:215], v[100:103], v[116:119], v[212:215]
ds_read_b64_tr_b16 v[62:63], v15 offset:33792
v_mul_f32 v21, s79, v21
v_mfma_f32_16x16x32_bf16 v[208:211], v[100:103], v[112:115], v[208:211]
v_mul_f32 v29, s79, v29
v_mul_f32 v22, s79, v22
v_mfma_f32_16x16x32_bf16 v[224:227], v[104:107], v[112:115], v[224:227]
s_add_u32 s72, s69, 15360
buffer_load_dwordx4 v5, s[4:7], s72 offen offset:1024 lds
v_mfma_f32_16x16x32_bf16 v[228:231], v[104:107], v[116:119], v[228:231]
v_mul_f32 v30, s79, v30
v_mul_f32 v23, s79, v23
v_mfma_f32_16x16x32_bf16 v[232:235], v[104:107], v[120:123], v[232:235]
v_mul_f32 v31, s79, v31
v_cvt_pk_bf16_f32 v20, v20, v28
v_mfma_f32_16x16x32_bf16 v[236:239], v[104:107], v[124:127], v[236:239]
v_cvt_pk_bf16_f32 v21, v21, v29
v_cvt_pk_bf16_f32 v22, v22, v30
v_mfma_f32_16x16x32_bf16 v[252:255], v[108:111], v[124:127], v[252:255]
v_cvt_pk_bf16_f32 v23, v23, v31
v_mfma_f32_16x16x32_bf16 v[248:251], v[108:111], v[120:123], v[248:251]
s_add_u32 s72, s69, 30720
buffer_load_dwordx4 v4, s[4:7], s72 offen offset:2048 lds
v_mfma_f32_16x16x32_bf16 v[244:247], v[108:111], v[116:119], v[244:247]
buffer_store_dwordx4 v[20:23], v1, s[44:47], s80 offen sc1
v_mfma_f32_16x16x32_bf16 v[240:243], v[108:111], v[112:115], v[240:243]
s_waitcnt lgkmcnt(0)
v_accvgpr_read_b32 v24, a240
v_accvgpr_read_b32 v28, a241
v_mfma_f32_16x16x32_bf16 v[128:131], v[32:35], v[64:67], v[128:131]
ds_read_b64_tr_b16 v[80:81], v8 offset:40960
ds_read_b64_tr_b16 v[82:83], v8 offset:41984
v_mfma_f32_16x16x32_bf16 v[132:135], v[32:35], v[68:71], v[132:135]
ds_read_b128 v[112:115], v19 offset:32768
ds_read_b128 v[116:119], v19 offset:34816
v_mfma_f32_16x16x32_bf16 v[136:139], v[32:35], v[72:75], v[136:139]
s_add_u32 s72, s69, 46080
buffer_load_dwordx4 v5, s[4:7], s72 offen offset:3072 lds
v_mfma_f32_16x16x32_bf16 v[140:143], v[32:35], v[76:79], v[140:143]
ds_read_b128 v[120:123], v19 offset:36864
ds_read_b128 v[124:127], v19 offset:38912
v_mfma_f32_16x16x32_bf16 v[156:159], v[36:39], v[76:79], v[156:159]
ds_read_b64_tr_b16 v[84:85], v9 offset:40960
ds_read_b64_tr_b16 v[86:87], v9 offset:41984
v_mfma_f32_16x16x32_bf16 v[152:155], v[36:39], v[72:75], v[152:155]
ds_read_b64_tr_b16 v[88:89], v10 offset:40960
v_accvgpr_read_b32 v25, a242
v_mfma_f32_16x16x32_bf16 v[148:151], v[36:39], v[68:71], v[148:151]
ds_read_b64_tr_b16 v[90:91], v10 offset:41984
v_accvgpr_read_b32 v29, a243
v_mfma_f32_16x16x32_bf16 v[144:147], v[36:39], v[64:67], v[144:147]
s_add_u32 m0, s63, 69632
ds_read_b64_tr_b16 v[92:93], v11 offset:40960
v_mfma_f32_16x16x32_bf16 v[160:163], v[40:43], v[64:67], v[160:163]
s_add_u32 s72, s70, 0
buffer_load_dwordx4 v4, s[4:7], s72 offen lds
v_mfma_f32_16x16x32_bf16 v[164:167], v[40:43], v[68:71], v[164:167]
s_add_u32 s80, s78, 35840
ds_read_b64_tr_b16 v[94:95], v11 offset:41984
v_accvgpr_read_b32 v26, a244
v_mfma_f32_16x16x32_bf16 v[168:171], v[40:43], v[72:75], v[168:171]
ds_read_b64_tr_b16 v[96:97], v12 offset:40960
v_accvgpr_read_b32 v30, a245
v_mfma_f32_16x16x32_bf16 v[172:175], v[40:43], v[76:79], v[172:175]
ds_read_b64_tr_b16 v[98:99], v12 offset:41984
v_accvgpr_read_b32 v27, a246
v_mfma_f32_16x16x32_bf16 v[188:191], v[44:47], v[76:79], v[188:191]
s_add_u32 s72, s70, 15360
buffer_load_dwordx4 v5, s[4:7], s72 offen offset:1024 lds
v_mfma_f32_16x16x32_bf16 v[184:187], v[44:47], v[72:75], v[184:187]
ds_read_b64_tr_b16 v[100:101], v13 offset:40960
v_accvgpr_read_b32 v31, a247
v_mfma_f32_16x16x32_bf16 v[180:183], v[44:47], v[68:71], v[180:183]
ds_read_b64_tr_b16 v[102:103], v13 offset:41984
v_cvt_pk_bf16_f32 v24, v24, v28
v_mfma_f32_16x16x32_bf16 v[176:179], v[44:47], v[64:67], v[176:179]
ds_read_b64_tr_b16 v[104:105], v14 offset:40960
v_cvt_pk_bf16_f32 v25, v25, v29
v_mfma_f32_16x16x32_bf16 v[192:195], v[48:51], v[64:67], v[192:195]
ds_read_b64_tr_b16 v[106:107], v14 offset:41984
v_cvt_pk_bf16_f32 v26, v26, v30
v_mfma_f32_16x16x32_bf16 v[196:199], v[48:51], v[68:71], v[196:199]
s_add_u32 s72, s70, 30720
buffer_load_dwordx4 v4, s[4:7], s72 offen offset:2048 lds
v_mfma_f32_16x16x32_bf16 v[200:203], v[48:51], v[72:75], v[200:203]
ds_read_b64_tr_b16 v[108:109], v15 offset:40960
v_cvt_pk_bf16_f32 v27, v27, v31
v_mfma_f32_16x16x32_bf16 v[204:207], v[48:51], v[76:79], v[204:207]
ds_read_b64_tr_b16 v[110:111], v15 offset:41984
v_mfma_f32_16x16x32_bf16 v[220:223], v[52:55], v[76:79], v[220:223]
buffer_store_dwordx4 v[24:27], v1, s[44:47], s80 offen sc1
v_mfma_f32_16x16x32_bf16 v[216:219], v[52:55], v[72:75], v[216:219]
v_accvgpr_read_b32 v20, a92
v_accvgpr_read_b32 v28, a93
v_mfma_f32_16x16x32_bf16 v[212:215], v[52:55], v[68:71], v[212:215]
s_add_u32 s72, s70, 46080
buffer_load_dwordx4 v5, s[4:7], s72 offen offset:3072 lds
v_mfma_f32_16x16x32_bf16 v[208:211], v[52:55], v[64:67], v[208:211]
v_accvgpr_read_b32 v21, a94
v_accvgpr_read_b32 v29, a95
v_mfma_f32_16x16x32_bf16 v[224:227], v[56:59], v[64:67], v[224:227]
s_add_u32 s80, s77, 46080
v_accvgpr_read_b32 v22, a124
v_accvgpr_read_b32 v30, a125
v_mfma_f32_16x16x32_bf16 v[228:231], v[56:59], v[68:71], v[228:231]
v_accvgpr_read_b32 v23, a126
v_accvgpr_read_b32 v31, a127
v_mfma_f32_16x16x32_bf16 v[232:235], v[56:59], v[72:75], v[232:235]
v_mul_f32 v20, s79, v20
v_mul_f32 v28, s79, v28
v_mfma_f32_16x16x32_bf16 v[236:239], v[56:59], v[76:79], v[236:239]
v_mul_f32 v21, s79, v21
v_mul_f32 v29, s79, v29
v_mfma_f32_16x16x32_bf16 v[252:255], v[60:63], v[76:79], v[252:255]
v_mul_f32 v22, s79, v22
v_mul_f32 v30, s79, v30
v_mfma_f32_16x16x32_bf16 v[248:251], v[60:63], v[72:75], v[248:251]
v_mul_f32 v23, s79, v23
v_mul_f32 v31, s79, v31
v_mfma_f32_16x16x32_bf16 v[244:247], v[60:63], v[68:71], v[244:247]
s_waitcnt vmcnt(16) lgkmcnt(0)
v_cvt_pk_bf16_f32 v20, v20, v28
v_cvt_pk_bf16_f32 v21, v21, v29
v_mfma_f32_16x16x32_bf16 v[240:243], v[60:63], v[64:67], v[240:243]
s_barrier
v_cvt_pk_bf16_f32 v22, v22, v30
v_cvt_pk_bf16_f32 v23, v23, v31
v_mfma_f32_16x16x32_bf16 v[128:131], v[80:83], v[112:115], v[128:131]
s_add_u32 s73, s62, 14
ds_read_b64_tr_b16 v[32:33], v8 offset:0
ds_read_b64_tr_b16 v[34:35], v8 offset:1024
v_mfma_f32_16x16x32_bf16 v[132:135], v[80:83], v[116:119], v[132:135]
s_add_u32 s70, s73, s65
ds_read_b128 v[64:67], v16 offset:0
ds_read_b128 v[68:71], v16 offset:2048
v_mfma_f32_16x16x32_bf16 v[136:139], v[80:83], v[120:123], v[136:139]
s_and_b32 s70, s70, 3
ds_read_b128 v[72:75], v16 offset:4096
ds_read_b128 v[76:79], v16 offset:6144
v_mfma_f32_16x16x32_bf16 v[140:143], v[80:83], v[124:127], v[140:143]
s_and_b32 s73, s73, 12
ds_read_b64_tr_b16 v[36:37], v9 offset:0
ds_read_b64_tr_b16 v[38:39], v9 offset:1024
v_mfma_f32_16x16x32_bf16 v[156:159], v[84:87], v[124:127], v[156:159]
s_or_b32 s73, s73, s70
ds_read_b64_tr_b16 v[40:41], v10 offset:0
v_mfma_f32_16x16x32_bf16 v[152:155], v[84:87], v[120:123], v[152:155]
s_lshl_b32 s71, s73, 19
ds_read_b64_tr_b16 v[42:43], v10 offset:1024
v_mfma_f32_16x16x32_bf16 v[148:151], v[84:87], v[116:119], v[148:151]
s_add_u32 s71, s71, s66
ds_read_b64_tr_b16 v[44:45], v11 offset:0
v_mfma_f32_16x16x32_bf16 v[144:147], v[84:87], v[112:115], v[144:147]
s_lshl_b32 s73, s73, 7
ds_read_b64_tr_b16 v[46:47], v11 offset:1024
v_mfma_f32_16x16x32_bf16 v[160:163], v[88:91], v[112:115], v[160:163]
s_add_u32 s69, s73, s67
ds_read_b64_tr_b16 v[48:49], v12 offset:0
v_mfma_f32_16x16x32_bf16 v[164:167], v[88:91], v[116:119], v[164:167]
s_add_u32 s70, s73, s68
ds_read_b64_tr_b16 v[50:51], v12 offset:1024
v_mfma_f32_16x16x32_bf16 v[168:171], v[88:91], v[120:123], v[168:171]
s_add_u32 m0, s64, 32768
ds_read_b64_tr_b16 v[52:53], v13 offset:0
v_mfma_f32_16x16x32_bf16 v[172:175], v[88:91], v[124:127], v[172:175]
s_add_u32 s72, s71, 0
buffer_load_dwordx4 v6, s[12:15], s72 offen lds
v_mfma_f32_16x16x32_bf16 v[188:191], v[92:95], v[124:127], v[188:191]
s_add_u32 s72, s71, 31744
buffer_load_dwordx4 v6, s[12:15], s72 offen offset:1024 lds
v_mfma_f32_16x16x32_bf16 v[184:187], v[92:95], v[120:123], v[184:187]
s_add_u32 s72, s71, 63488
buffer_load_dwordx4 v7, s[12:15], s72 offen offset:2048 lds
v_mfma_f32_16x16x32_bf16 v[180:183], v[92:95], v[116:119], v[180:183]
s_add_u32 s72, s71, 95232
buffer_load_dwordx4 v7, s[12:15], s72 offen offset:3072 lds
v_mfma_f32_16x16x32_bf16 v[176:179], v[92:95], v[112:115], v[176:179]
ds_read_b64_tr_b16 v[54:55], v13 offset:1024
v_mfma_f32_16x16x32_bf16 v[192:195], v[96:99], v[112:115], v[192:195]
ds_read_b64_tr_b16 v[56:57], v14 offset:0
v_mfma_f32_16x16x32_bf16 v[196:199], v[96:99], v[116:119], v[196:199]
ds_read_b64_tr_b16 v[58:59], v14 offset:1024
v_mfma_f32_16x16x32_bf16 v[200:203], v[96:99], v[120:123], v[200:203]
ds_read_b64_tr_b16 v[60:61], v15 offset:0
v_mfma_f32_16x16x32_bf16 v[204:207], v[96:99], v[124:127], v[204:207]
s_add_u32 m0, s63, 98304
ds_read_b64_tr_b16 v[62:63], v15 offset:1024
v_mfma_f32_16x16x32_bf16 v[220:223], v[100:103], v[124:127], v[220:223]
s_add_u32 s72, s69, 0
buffer_load_dwordx4 v4, s[4:7], s72 offen lds
v_mfma_f32_16x16x32_bf16 v[216:219], v[100:103], v[120:123], v[216:219]
buffer_store_dwordx4 v[20:23], v1, s[44:47], s80 offen sc1
v_mfma_f32_16x16x32_bf16 v[212:215], v[100:103], v[116:119], v[212:215]
v_accvgpr_read_b32 v24, a248
v_accvgpr_read_b32 v28, a249
v_mfma_f32_16x16x32_bf16 v[208:211], v[100:103], v[112:115], v[208:211]
v_accvgpr_read_b32 v25, a250
v_accvgpr_read_b32 v29, a251
v_mfma_f32_16x16x32_bf16 v[224:227], v[104:107], v[112:115], v[224:227]
s_add_u32 s72, s69, 15360
buffer_load_dwordx4 v5, s[4:7], s72 offen offset:1024 lds
v_mfma_f32_16x16x32_bf16 v[228:231], v[104:107], v[116:119], v[228:231]
s_add_u32 s80, s78, 44032
v_accvgpr_read_b32 v26, a252
v_accvgpr_read_b32 v30, a253
v_mfma_f32_16x16x32_bf16 v[232:235], v[104:107], v[120:123], v[232:235]
v_accvgpr_read_b32 v27, a254
v_accvgpr_read_b32 v31, a255
v_mfma_f32_16x16x32_bf16 v[236:239], v[104:107], v[124:127], v[236:239]
v_cvt_pk_bf16_f32 v24, v24, v28
v_cvt_pk_bf16_f32 v25, v25, v29
v_mfma_f32_16x16x32_bf16 v[252:255], v[108:111], v[124:127], v[252:255]
v_cvt_pk_bf16_f32 v26, v26, v30
v_cvt_pk_bf16_f32 v27, v27, v31
v_mfma_f32_16x16x32_bf16 v[248:251], v[108:111], v[120:123], v[248:251]
s_add_u32 s72, s69, 30720
buffer_load_dwordx4 v4, s[4:7], s72 offen offset:2048 lds
v_mfma_f32_16x16x32_bf16 v[244:247], v[108:111], v[116:119], v[244:247]
buffer_store_dwordx4 v[24:27], v1, s[44:47], s80 offen sc1
v_mfma_f32_16x16x32_bf16 v[240:243], v[108:111], v[112:115], v[240:243]
s_waitcnt lgkmcnt(0)
v_mfma_f32_16x16x32_bf16 v[128:131], v[32:35], v[64:67], v[128:131]
ds_read_b64_tr_b16 v[80:81], v8 offset:8192
ds_read_b64_tr_b16 v[82:83], v8 offset:9216
v_mfma_f32_16x16x32_bf16 v[132:135], v[32:35], v[68:71], v[132:135]
ds_read_b128 v[112:115], v17 offset:0
ds_read_b128 v[116:119], v17 offset:2048
v_mfma_f32_16x16x32_bf16 v[136:139], v[32:35], v[72:75], v[136:139]
s_add_u32 s72, s69, 46080
buffer_load_dwordx4 v5, s[4:7], s72 offen offset:3072 lds
v_mfma_f32_16x16x32_bf16 v[140:143], v[32:35], v[76:79], v[140:143]
ds_read_b128 v[120:123], v17 offset:4096
ds_read_b128 v[124:127], v17 offset:6144
v_mfma_f32_16x16x32_bf16 v[156:159], v[36:39], v[76:79], v[156:159]
ds_read_b64_tr_b16 v[84:85], v9 offset:8192
ds_read_b64_tr_b16 v[86:87], v9 offset:9216
v_mfma_f32_16x16x32_bf16 v[152:155], v[36:39], v[72:75], v[152:155]
ds_read_b64_tr_b16 v[88:89], v10 offset:8192
v_mfma_f32_16x16x32_bf16 v[148:151], v[36:39], v[68:71], v[148:151]
ds_read_b64_tr_b16 v[90:91], v10 offset:9216
v_mfma_f32_16x16x32_bf16 v[144:147], v[36:39], v[64:67], v[144:147]
s_add_u32 m0, s63, 102400
ds_read_b64_tr_b16 v[92:93], v11 offset:8192
v_mfma_f32_16x16x32_bf16 v[160:163], v[40:43], v[64:67], v[160:163]
s_add_u32 s72, s70, 0
buffer_load_dwordx4 v4, s[4:7], s72 offen lds
v_mfma_f32_16x16x32_bf16 v[164:167], v[40:43], v[68:71], v[164:167]
ds_read_b64_tr_b16 v[94:95], v11 offset:9216
v_mfma_f32_16x16x32_bf16 v[168:171], v[40:43], v[72:75], v[168:171]
ds_read_b64_tr_b16 v[96:97], v12 offset:8192
v_mfma_f32_16x16x32_bf16 v[172:175], v[40:43], v[76:79], v[172:175]
ds_read_b64_tr_b16 v[98:99], v12 offset:9216
v_mfma_f32_16x16x32_bf16 v[188:191], v[44:47], v[76:79], v[188:191]
s_add_u32 s72, s70, 15360
buffer_load_dwordx4 v5, s[4:7], s72 offen offset:1024 lds
v_mfma_f32_16x16x32_bf16 v[184:187], v[44:47], v[72:75], v[184:187]
ds_read_b64_tr_b16 v[100:101], v13 offset:8192
v_mfma_f32_16x16x32_bf16 v[180:183], v[44:47], v[68:71], v[180:183]
ds_read_b64_tr_b16 v[102:103], v13 offset:9216
v_mfma_f32_16x16x32_bf16 v[176:179], v[44:47], v[64:67], v[176:179]
ds_read_b64_tr_b16 v[104:105], v14 offset:8192
v_mfma_f32_16x16x32_bf16 v[192:195], v[48:51], v[64:67], v[192:195]
ds_read_b64_tr_b16 v[106:107], v14 offset:9216
v_mfma_f32_16x16x32_bf16 v[196:199], v[48:51], v[68:71], v[196:199]
s_add_u32 s72, s70, 30720
buffer_load_dwordx4 v4, s[4:7], s72 offen offset:2048 lds
v_mfma_f32_16x16x32_bf16 v[200:203], v[48:51], v[72:75], v[200:203]
ds_read_b64_tr_b16 v[108:109], v15 offset:8192
v_mfma_f32_16x16x32_bf16 v[204:207], v[48:51], v[76:79], v[204:207]
ds_read_b64_tr_b16 v[110:111], v15 offset:9216
v_mfma_f32_16x16x32_bf16 v[220:223], v[52:55], v[76:79], v[220:223]
v_mfma_f32_16x16x32_bf16 v[216:219], v[52:55], v[72:75], v[216:219]
v_mfma_f32_16x16x32_bf16 v[212:215], v[52:55], v[68:71], v[212:215]
s_add_u32 s72, s70, 46080
buffer_load_dwordx4 v5, s[4:7], s72 offen offset:3072 lds
v_mfma_f32_16x16x32_bf16 v[208:211], v[52:55], v[64:67], v[208:211]
v_mfma_f32_16x16x32_bf16 v[224:227], v[56:59], v[64:67], v[224:227]
v_mfma_f32_16x16x32_bf16 v[228:231], v[56:59], v[68:71], v[228:231]
v_mfma_f32_16x16x32_bf16 v[232:235], v[56:59], v[72:75], v[232:235]
v_mfma_f32_16x16x32_bf16 v[236:239], v[56:59], v[76:79], v[236:239]
v_mfma_f32_16x16x32_bf16 v[252:255], v[60:63], v[76:79], v[252:255]
v_mfma_f32_16x16x32_bf16 v[248:251], v[60:63], v[72:75], v[248:251]
v_mfma_f32_16x16x32_bf16 v[244:247], v[60:63], v[68:71], v[244:247]
s_waitcnt vmcnt(5) lgkmcnt(0)
v_mfma_f32_16x16x32_bf16 v[240:243], v[60:63], v[64:67], v[240:243]
s_barrier
v_mfma_f32_16x16x32_bf16 v[128:131], v[80:83], v[112:115], v[128:131]
s_add_u32 s73, s62, 15
s_waitcnt vmcnt(28)
v_cmp_gt_u32 vcc, 8, v3
s_cbranch_vccnz Lspin1
Lback2:
v_mfma_f32_16x16x32_bf16 v[132:135], v[80:83], v[116:119], v[132:135]
s_add_u32 s70, s73, s65
ds_read_b64_tr_b16 v[32:33], v8 offset:16384
ds_read_b64_tr_b16 v[34:35], v8 offset:17408
v_mfma_f32_16x16x32_bf16 v[136:139], v[80:83], v[120:123], v[136:139]
s_and_b32 s70, s70, 3
ds_read_b128 v[64:67], v18 offset:0
ds_read_b128 v[68:71], v18 offset:2048
v_mfma_f32_16x16x32_bf16 v[140:143], v[80:83], v[124:127], v[140:143]
s_and_b32 s73, s73, 12
ds_read_b128 v[72:75], v18 offset:4096
ds_read_b128 v[76:79], v18 offset:6144
v_mfma_f32_16x16x32_bf16 v[156:159], v[84:87], v[124:127], v[156:159]
s_or_b32 s73, s73, s70
ds_read_b64_tr_b16 v[36:37], v9 offset:16384
ds_read_b64_tr_b16 v[38:39], v9 offset:17408
v_mfma_f32_16x16x32_bf16 v[152:155], v[84:87], v[120:123], v[152:155]
s_lshl_b32 s71, s73, 19
ds_read_b64_tr_b16 v[40:41], v10 offset:16384
v_or_b32 v20, s58, v0
v_mfma_f32_16x16x32_bf16 v[148:151], v[84:87], v[116:119], v[148:151]
s_add_u32 s71, s71, s66
ds_read_b64_tr_b16 v[42:43], v10 offset:17408
v_mov_b32 v21, 1
v_mfma_f32_16x16x32_bf16 v[144:147], v[84:87], v[112:115], v[144:147]
s_lshl_b32 s73, s73, 7
ds_read_b64_tr_b16 v[44:45], v11 offset:16384
v_min_u32 v20, 1, v20
v_mfma_f32_16x16x32_bf16 v[160:163], v[88:91], v[112:115], v[160:163]
s_add_u32 s69, s73, s67
ds_read_b64_tr_b16 v[46:47], v11 offset:17408
v_lshlrev_b32 v20, 30, v20
v_mfma_f32_16x16x32_bf16 v[164:167], v[88:91], v[116:119], v[164:167]
s_add_u32 s70, s73, s68
ds_read_b64_tr_b16 v[48:49], v12 offset:16384
v_mfma_f32_16x16x32_bf16 v[168:171], v[88:91], v[120:123], v[168:171]
s_add_u32 m0, s64, 0
ds_read_b64_tr_b16 v[50:51], v12 offset:17408
v_mfma_f32_16x16x32_bf16 v[172:175], v[88:91], v[124:127], v[172:175]
s_add_u32 s72, s71, 0
buffer_load_dwordx4 v6, s[12:15], s72 offen lds
v_mfma_f32_16x16x32_bf16 v[188:191], v[92:95], v[124:127], v[188:191]
s_add_u32 s72, s71, 31744
buffer_load_dwordx4 v6, s[12:15], s72 offen offset:1024 lds
v_mfma_f32_16x16x32_bf16 v[184:187], v[92:95], v[120:123], v[184:187]
s_add_u32 s72, s71, 63488
buffer_load_dwordx4 v7, s[12:15], s72 offen offset:2048 lds
v_mfma_f32_16x16x32_bf16 v[180:183], v[92:95], v[116:119], v[180:183]
s_add_u32 s72, s71, 95232
buffer_load_dwordx4 v7, s[12:15], s72 offen offset:3072 lds
v_mfma_f32_16x16x32_bf16 v[176:179], v[92:95], v[112:115], v[176:179]
ds_read_b64_tr_b16 v[52:53], v13 offset:16384
v_mfma_f32_16x16x32_bf16 v[192:195], v[96:99], v[112:115], v[192:195]
ds_read_b64_tr_b16 v[54:55], v13 offset:17408
v_mfma_f32_16x16x32_bf16 v[196:199], v[96:99], v[116:119], v[196:199]
ds_read_b64_tr_b16 v[56:57], v14 offset:16384
v_mfma_f32_16x16x32_bf16 v[200:203], v[96:99], v[120:123], v[200:203]
ds_read_b64_tr_b16 v[58:59], v14 offset:17408
v_mfma_f32_16x16x32_bf16 v[204:207], v[96:99], v[124:127], v[204:207]
s_add_u32 m0, s63, 131072
ds_read_b64_tr_b16 v[60:61], v15 offset:16384
v_mfma_f32_16x16x32_bf16 v[220:223], v[100:103], v[124:127], v[220:223]
s_add_u32 s72, s69, 0
buffer_load_dwordx4 v4, s[4:7], s72 offen lds
v_mfma_f32_16x16x32_bf16 v[216:219], v[100:103], v[120:123], v[216:219]
ds_read_b64_tr_b16 v[62:63], v15 offset:17408
v_mfma_f32_16x16x32_bf16 v[212:215], v[100:103], v[116:119], v[212:215]
buffer_store_dword v21, v20, s[44:47], s91 offen sc1
v_mfma_f32_16x16x32_bf16 v[208:211], v[100:103], v[112:115], v[208:211]
v_mfma_f32_16x16x32_bf16 v[224:227], v[104:107], v[112:115], v[224:227]
s_add_u32 s72, s69, 15360
buffer_load_dwordx4 v5, s[4:7], s72 offen offset:1024 lds
v_mfma_f32_16x16x32_bf16 v[228:231], v[104:107], v[116:119], v[228:231]
v_mfma_f32_16x16x32_bf16 v[232:235], v[104:107], v[120:123], v[232:235]
v_mfma_f32_16x16x32_bf16 v[236:239], v[104:107], v[124:127], v[236:239]
v_mfma_f32_16x16x32_bf16 v[252:255], v[108:111], v[124:127], v[252:255]
v_mfma_f32_16x16x32_bf16 v[248:251], v[108:111], v[120:123], v[248:251]
s_add_u32 s72, s69, 30720
buffer_load_dwordx4 v4, s[4:7], s72 offen offset:2048 lds
v_mfma_f32_16x16x32_bf16 v[244:247], v[108:111], v[116:119], v[244:247]
v_mfma_f32_16x16x32_bf16 v[240:243], v[108:111], v[112:115], v[240:243]
s_waitcnt lgkmcnt(0)
v_mfma_f32_16x16x32_bf16 v[128:131], v[32:35], v[64:67], v[128:131]
ds_read_b64_tr_b16 v[80:81], v8 offset:24576
ds_read_b64_tr_b16 v[82:83], v8 offset:25600
v_mfma_f32_16x16x32_bf16 v[132:135], v[32:35], v[68:71], v[132:135]
ds_read_b128 v[112:115], v19 offset:0
ds_read_b128 v[116:119], v19 offset:2048
v_mfma_f32_16x16x32_bf16 v[136:139], v[32:35], v[72:75], v[136:139]
s_add_u32 s72, s69, 46080
buffer_load_dwordx4 v5, s[4:7], s72 offen offset:3072 lds
v_mfma_f32_16x16x32_bf16 v[140:143], v[32:35], v[76:79], v[140:143]
ds_read_b128 v[120:123], v19 offset:4096
ds_read_b128 v[124:127], v19 offset:6144
v_mfma_f32_16x16x32_bf16 v[156:159], v[36:39], v[76:79], v[156:159]
ds_read_b64_tr_b16 v[84:85], v9 offset:24576
ds_read_b64_tr_b16 v[86:87], v9 offset:25600
v_mfma_f32_16x16x32_bf16 v[152:155], v[36:39], v[72:75], v[152:155]
ds_read_b64_tr_b16 v[88:89], v10 offset:24576
v_mfma_f32_16x16x32_bf16 v[148:151], v[36:39], v[68:71], v[148:151]
ds_read_b64_tr_b16 v[90:91], v10 offset:25600
v_mfma_f32_16x16x32_bf16 v[144:147], v[36:39], v[64:67], v[144:147]
s_add_u32 m0, s63, 135168
ds_read_b64_tr_b16 v[92:93], v11 offset:24576
v_mfma_f32_16x16x32_bf16 v[160:163], v[40:43], v[64:67], v[160:163]
s_add_u32 s72, s70, 0
buffer_load_dwordx4 v4, s[4:7], s72 offen lds
v_mfma_f32_16x16x32_bf16 v[164:167], v[40:43], v[68:71], v[164:167]
ds_read_b64_tr_b16 v[94:95], v11 offset:25600
v_mfma_f32_16x16x32_bf16 v[168:171], v[40:43], v[72:75], v[168:171]
ds_read_b64_tr_b16 v[96:97], v12 offset:24576
v_mfma_f32_16x16x32_bf16 v[172:175], v[40:43], v[76:79], v[172:175]
ds_read_b64_tr_b16 v[98:99], v12 offset:25600
v_mfma_f32_16x16x32_bf16 v[188:191], v[44:47], v[76:79], v[188:191]
s_add_u32 s72, s70, 15360
buffer_load_dwordx4 v5, s[4:7], s72 offen offset:1024 lds
v_mfma_f32_16x16x32_bf16 v[184:187], v[44:47], v[72:75], v[184:187]
ds_read_b64_tr_b16 v[100:101], v13 offset:24576
v_mfma_f32_16x16x32_bf16 v[180:183], v[44:47], v[68:71], v[180:183]
ds_read_b64_tr_b16 v[102:103], v13 offset:25600
v_mfma_f32_16x16x32_bf16 v[176:179], v[44:47], v[64:67], v[176:179]
ds_read_b64_tr_b16 v[104:105], v14 offset:24576
v_mfma_f32_16x16x32_bf16 v[192:195], v[48:51], v[64:67], v[192:195]
ds_read_b64_tr_b16 v[106:107], v14 offset:25600
v_mfma_f32_16x16x32_bf16 v[196:199], v[48:51], v[68:71], v[196:199]
s_add_u32 s72, s70, 30720
buffer_load_dwordx4 v4, s[4:7], s72 offen offset:2048 lds
v_mfma_f32_16x16x32_bf16 v[200:203], v[48:51], v[72:75], v[200:203]
ds_read_b64_tr_b16 v[108:109], v15 offset:24576
v_mfma_f32_16x16x32_bf16 v[204:207], v[48:51], v[76:79], v[204:207]
ds_read_b64_tr_b16 v[110:111], v15 offset:25600
v_mfma_f32_16x16x32_bf16 v[220:223], v[52:55], v[76:79], v[220:223]
v_mfma_f32_16x16x32_bf16 v[216:219], v[52:55], v[72:75], v[216:219]
v_mfma_f32_16x16x32_bf16 v[212:215], v[52:55], v[68:71], v[212:215]
s_add_u32 s72, s70, 46080
buffer_load_dwordx4 v5, s[4:7], s72 offen offset:3072 lds
v_mfma_f32_16x16x32_bf16 v[208:211], v[52:55], v[64:67], v[208:211]
v_mfma_f32_16x16x32_bf16 v[224:227], v[56:59], v[64:67], v[224:227]
v_mfma_f32_16x16x32_bf16 v[228:231], v[56:59], v[68:71], v[228:231]
v_mfma_f32_16x16x32_bf16 v[232:235], v[56:59], v[72:75], v[232:235]
v_mfma_f32_16x16x32_bf16 v[236:239], v[56:59], v[76:79], v[236:239]
v_mfma_f32_16x16x32_bf16 v[252:255], v[60:63], v[76:79], v[252:255]
v_mfma_f32_16x16x32_bf16 v[248:251], v[60:63], v[72:75], v[248:251]
v_mfma_f32_16x16x32_bf16 v[244:247], v[60:63], v[68:71], v[244:247]
s_waitcnt vmcnt(13) lgkmcnt(0)
v_mfma_f32_16x16x32_bf16 v[240:243], v[60:63], v[64:67], v[240:243]
s_barrier
v_mfma_f32_16x16x32_bf16 v[128:131], v[80:83], v[112:115], v[128:131]
ds_read_b64_tr_b16 v[32:33], v8 offset:32768
ds_read_b64_tr_b16 v[34:35], v8 offset:33792
v_mfma_f32_16x16x32_bf16 v[132:135], v[80:83], v[116:119], v[132:135]
ds_read_b128 v[64:67], v18 offset:32768
ds_read_b128 v[68:71], v18 offset:34816
v_mfma_f32_16x16x32_bf16 v[136:139], v[80:83], v[120:123], v[136:139]
ds_read_b128 v[72:75], v18 offset:36864
ds_read_b128 v[76:79], v18 offset:38912
v_mfma_f32_16x16x32_bf16 v[140:143], v[80:83], v[124:127], v[140:143]
ds_read_b64_tr_b16 v[36:37], v9 offset:32768
ds_read_b64_tr_b16 v[38:39], v9 offset:33792
v_mfma_f32_16x16x32_bf16 v[156:159], v[84:87], v[124:127], v[156:159]
ds_read_b64_tr_b16 v[40:41], v10 offset:32768
v_mfma_f32_16x16x32_bf16 v[152:155], v[84:87], v[120:123], v[152:155]
ds_read_b64_tr_b16 v[42:43], v10 offset:33792
v_mfma_f32_16x16x32_bf16 v[148:151], v[84:87], v[116:119], v[148:151]
ds_read_b64_tr_b16 v[44:45], v11 offset:32768
v_mfma_f32_16x16x32_bf16 v[144:147], v[84:87], v[112:115], v[144:147]
ds_read_b64_tr_b16 v[46:47], v11 offset:33792
v_mfma_f32_16x16x32_bf16 v[160:163], v[88:91], v[112:115], v[160:163]
ds_read_b64_tr_b16 v[48:49], v12 offset:32768
v_mfma_f32_16x16x32_bf16 v[164:167], v[88:91], v[116:119], v[164:167]
ds_read_b64_tr_b16 v[50:51], v12 offset:33792
v_mfma_f32_16x16x32_bf16 v[168:171], v[88:91], v[120:123], v[168:171]
ds_read_b64_tr_b16 v[52:53], v13 offset:32768
v_mfma_f32_16x16x32_bf16 v[172:175], v[88:91], v[124:127], v[172:175]
ds_read_b64_tr_b16 v[54:55], v13 offset:33792
v_mfma_f32_16x16x32_bf16 v[188:191], v[92:95], v[124:127], v[188:191]
ds_read_b64_tr_b16 v[56:57], v14 offset:32768
v_mfma_f32_16x16x32_bf16 v[184:187], v[92:95], v[120:123], v[184:187]
ds_read_b64_tr_b16 v[58:59], v14 offset:33792
v_mfma_f32_16x16x32_bf16 v[180:183], v[92:95], v[116:119], v[180:183]
ds_read_b64_tr_b16 v[60:61], v15 offset:32768
v_mfma_f32_16x16x32_bf16 v[176:179], v[92:95], v[112:115], v[176:179]
ds_read_b64_tr_b16 v[62:63], v15 offset:33792
v_mfma_f32_16x16x32_bf16 v[192:195], v[96:99], v[112:115], v[192:195]
v_mfma_f32_16x16x32_bf16 v[196:199], v[96:99], v[116:119], v[196:199]
v_mfma_f32_16x16x32_bf16 v[200:203], v[96:99], v[120:123], v[200:203]
v_mfma_f32_16x16x32_bf16 v[204:207], v[96:99], v[124:127], v[204:207]
v_mfma_f32_16x16x32_bf16 v[220:223], v[100:103], v[124:127], v[220:223]
v_mfma_f32_16x16x32_bf16 v[216:219], v[100:103], v[120:123], v[216:219]
v_mfma_f32_16x16x32_bf16 v[212:215], v[100:103], v[116:119], v[212:215]
v_mfma_f32_16x16x32_bf16 v[208:211], v[100:103], v[112:115], v[208:211]
v_mfma_f32_16x16x32_bf16 v[224:227], v[104:107], v[112:115], v[224:227]
s_and_b32 s75, s91, 0xfffffc7f
v_lshrrev_b32 v2, 3, v0
v_lshlrev_b32 v2, 7, v2
v_mfma_f32_16x16x32_bf16 v[228:231], v[104:107], v[116:119], v[228:231]
buffer_load_dword v3, v2, s[44:47], s75 offen sc1
v_mfma_f32_16x16x32_bf16 v[232:235], v[104:107], v[120:123], v[232:235]
v_mfma_f32_16x16x32_bf16 v[236:239], v[104:107], v[124:127], v[236:239]
v_mfma_f32_16x16x32_bf16 v[252:255], v[108:111], v[124:127], v[252:255]
v_mfma_f32_16x16x32_bf16 v[248:251], v[108:111], v[120:123], v[248:251]
v_mfma_f32_16x16x32_bf16 v[244:247], v[108:111], v[116:119], v[244:247]
v_mfma_f32_16x16x32_bf16 v[240:243], v[108:111], v[112:115], v[240:243]
s_waitcnt lgkmcnt(0)
v_mfma_f32_16x16x32_bf16 v[128:131], v[32:35], v[64:67], v[128:131]
ds_read_b64_tr_b16 v[80:81], v8 offset:40960
ds_read_b64_tr_b16 v[82:83], v8 offset:41984
v_mfma_f32_16x16x32_bf16 v[132:135], v[32:35], v[68:71], v[132:135]
ds_read_b128 v[112:115], v19 offset:32768
ds_read_b128 v[116:119], v19 offset:34816
v_mfma_f32_16x16x32_bf16 v[136:139], v[32:35], v[72:75], v[136:139]
ds_read_b128 v[120:123], v19 offset:36864
ds_read_b128 v[124:127], v19 offset:38912
v_mfma_f32_16x16x32_bf16 v[140:143], v[32:35], v[76:79], v[140:143]
ds_read_b64_tr_b16 v[84:85], v9 offset:40960
ds_read_b64_tr_b16 v[86:87], v9 offset:41984
v_mfma_f32_16x16x32_bf16 v[156:159], v[36:39], v[76:79], v[156:159]
ds_read_b64_tr_b16 v[88:89], v10 offset:40960
v_mfma_f32_16x16x32_bf16 v[152:155], v[36:39], v[72:75], v[152:155]
ds_read_b64_tr_b16 v[90:91], v10 offset:41984
v_mfma_f32_16x16x32_bf16 v[148:151], v[36:39], v[68:71], v[148:151]
ds_read_b64_tr_b16 v[92:93], v11 offset:40960
v_mfma_f32_16x16x32_bf16 v[144:147], v[36:39], v[64:67], v[144:147]
ds_read_b64_tr_b16 v[94:95], v11 offset:41984
v_mfma_f32_16x16x32_bf16 v[160:163], v[40:43], v[64:67], v[160:163]
ds_read_b64_tr_b16 v[96:97], v12 offset:40960
v_mfma_f32_16x16x32_bf16 v[164:167], v[40:43], v[68:71], v[164:167]
ds_read_b64_tr_b16 v[98:99], v12 offset:41984
v_mfma_f32_16x16x32_bf16 v[168:171], v[40:43], v[72:75], v[168:171]
ds_read_b64_tr_b16 v[100:101], v13 offset:40960
v_mfma_f32_16x16x32_bf16 v[172:175], v[40:43], v[76:79], v[172:175]
ds_read_b64_tr_b16 v[102:103], v13 offset:41984
v_mfma_f32_16x16x32_bf16 v[188:191], v[44:47], v[76:79], v[188:191]
ds_read_b64_tr_b16 v[104:105], v14 offset:40960
v_mfma_f32_16x16x32_bf16 v[184:187], v[44:47], v[72:75], v[184:187]
ds_read_b64_tr_b16 v[106:107], v14 offset:41984
v_mfma_f32_16x16x32_bf16 v[180:183], v[44:47], v[68:71], v[180:183]
ds_read_b64_tr_b16 v[108:109], v15 offset:40960
v_mfma_f32_16x16x32_bf16 v[176:179], v[44:47], v[64:67], v[176:179]
ds_read_b64_tr_b16 v[110:111], v15 offset:41984
v_mfma_f32_16x16x32_bf16 v[192:195], v[48:51], v[64:67], v[192:195]
v_mfma_f32_16x16x32_bf16 v[196:199], v[48:51], v[68:71], v[196:199]
v_mfma_f32_16x16x32_bf16 v[200:203], v[48:51], v[72:75], v[200:203]
v_mfma_f32_16x16x32_bf16 v[204:207], v[48:51], v[76:79], v[204:207]
v_mfma_f32_16x16x32_bf16 v[220:223], v[52:55], v[76:79], v[220:223]
v_mfma_f32_16x16x32_bf16 v[216:219], v[52:55], v[72:75], v[216:219]
v_mfma_f32_16x16x32_bf16 v[212:215], v[52:55], v[68:71], v[212:215]
v_mfma_f32_16x16x32_bf16 v[208:211], v[52:55], v[64:67], v[208:211]
v_mfma_f32_16x16x32_bf16 v[224:227], v[56:59], v[64:67], v[224:227]
v_mfma_f32_16x16x32_bf16 v[228:231], v[56:59], v[68:71], v[228:231]
v_mfma_f32_16x16x32_bf16 v[232:235], v[56:59], v[72:75], v[232:235]
v_mfma_f32_16x16x32_bf16 v[236:239], v[56:59], v[76:79], v[236:239]
v_mfma_f32_16x16x32_bf16 v[252:255], v[60:63], v[76:79], v[252:255]
v_mfma_f32_16x16x32_bf16 v[248:251], v[60:63], v[72:75], v[248:251]
v_mfma_f32_16x16x32_bf16 v[244:247], v[60:63], v[68:71], v[244:247]
s_waitcnt vmcnt(1) lgkmcnt(0)
v_mfma_f32_16x16x32_bf16 v[240:243], v[60:63], v[64:67], v[240:243]
s_barrier
v_mfma_f32_16x16x32_bf16 v[128:131], v[80:83], v[112:115], v[128:131]
s_waitcnt vmcnt(0)
v_cmp_gt_u32 vcc, 1, v3
s_cbranch_vccnz Lspin4
Lback5:
v_mfma_f32_16x16x32_bf16 v[132:135], v[80:83], v[116:119], v[132:135]
s_add_u32 m0, s64, 49152
ds_read_b64_tr_b16 v[32:33], v8 offset:0
ds_read_b64_tr_b16 v[34:35], v8 offset:1024
v_mfma_f32_16x16x32_bf16 v[136:139], v[80:83], v[120:123], v[136:139]
s_add_u32 s72, s81, 16384
buffer_load_dwordx4 v1, s[44:47], s72 offen sc1 lds
v_mfma_f32_16x16x32_bf16 v[140:143], v[80:83], v[124:127], v[140:143]
ds_read_b128 v[64:67], v16 offset:0
ds_read_b128 v[68:71], v16 offset:2048
v_mfma_f32_16x16x32_bf16 v[156:159], v[84:87], v[124:127], v[156:159]
buffer_load_dwordx4 v1, s[44:47], s72 offen offset:1024 sc1 lds
v_mfma_f32_16x16x32_bf16 v[152:155], v[84:87], v[120:123], v[152:155]
ds_read_b128 v[72:75], v16 offset:4096
ds_read_b128 v[76:79], v16 offset:6144
v_mfma_f32_16x16x32_bf16 v[148:151], v[84:87], v[116:119], v[148:151]
ds_read_b64_tr_b16 v[36:37], v9 offset:0
ds_read_b64_tr_b16 v[38:39], v9 offset:1024
v_mfma_f32_16x16x32_bf16 v[144:147], v[84:87], v[112:115], v[144:147]
ds_read_b64_tr_b16 v[40:41], v10 offset:0
v_mfma_f32_16x16x32_bf16 v[160:163], v[88:91], v[112:115], v[160:163]
buffer_load_dwordx4 v1, s[44:47], s72 offen offset:2048 sc1 lds
v_mfma_f32_16x16x32_bf16 v[164:167], v[88:91], v[116:119], v[164:167]
ds_read_b64_tr_b16 v[42:43], v10 offset:1024
v_mfma_f32_16x16x32_bf16 v[168:171], v[88:91], v[120:123], v[168:171]
ds_read_b64_tr_b16 v[44:45], v11 offset:0
v_mfma_f32_16x16x32_bf16 v[172:175], v[88:91], v[124:127], v[172:175]
buffer_load_dwordx4 v1, s[44:47], s72 offen offset:3072 sc1 lds
v_mfma_f32_16x16x32_bf16 v[188:191], v[92:95], v[124:127], v[188:191]
ds_read_b64_tr_b16 v[46:47], v11 offset:1024
v_mfma_f32_16x16x32_bf16 v[184:187], v[92:95], v[120:123], v[184:187]
ds_read_b64_tr_b16 v[48:49], v12 offset:0
v_mfma_f32_16x16x32_bf16 v[180:183], v[92:95], v[116:119], v[180:183]
ds_read_b64_tr_b16 v[50:51], v12 offset:1024
v_mfma_f32_16x16x32_bf16 v[176:179], v[92:95], v[112:115], v[176:179]
s_add_u32 s81, s81, 0x8000
ds_read_b64_tr_b16 v[52:53], v13 offset:0
v_mfma_f32_16x16x32_bf16 v[192:195], v[96:99], v[112:115], v[192:195]
s_add_u32 m0, s64, 81920
ds_read_b64_tr_b16 v[54:55], v13 offset:1024
v_mfma_f32_16x16x32_bf16 v[196:199], v[96:99], v[116:119], v[196:199]
s_add_u32 s72, s81, 16384
buffer_load_dwordx4 v1, s[44:47], s72 offen sc1 lds
v_mfma_f32_16x16x32_bf16 v[200:203], v[96:99], v[120:123], v[200:203]
buffer_load_dwordx4 v1, s[44:47], s72 offen offset:1024 sc1 lds
v_mfma_f32_16x16x32_bf16 v[204:207], v[96:99], v[124:127], v[204:207]
ds_read_b64_tr_b16 v[56:57], v14 offset:0
v_mfma_f32_16x16x32_bf16 v[220:223], v[100:103], v[124:127], v[220:223]
ds_read_b64_tr_b16 v[58:59], v14 offset:1024
v_mfma_f32_16x16x32_bf16 v[216:219], v[100:103], v[120:123], v[216:219]
ds_read_b64_tr_b16 v[60:61], v15 offset:0
v_mfma_f32_16x16x32_bf16 v[212:215], v[100:103], v[116:119], v[212:215]
buffer_load_dwordx4 v1, s[44:47], s72 offen offset:2048 sc1 lds
v_mfma_f32_16x16x32_bf16 v[208:211], v[100:103], v[112:115], v[208:211]
ds_read_b64_tr_b16 v[62:63], v15 offset:1024
v_mfma_f32_16x16x32_bf16 v[224:227], v[104:107], v[112:115], v[224:227]
v_mfma_f32_16x16x32_bf16 v[228:231], v[104:107], v[116:119], v[228:231]
buffer_load_dwordx4 v1, s[44:47], s72 offen offset:3072 sc1 lds
v_mfma_f32_16x16x32_bf16 v[232:235], v[104:107], v[120:123], v[232:235]
v_mfma_f32_16x16x32_bf16 v[236:239], v[104:107], v[124:127], v[236:239]
v_mfma_f32_16x16x32_bf16 v[252:255], v[108:111], v[124:127], v[252:255]
v_mfma_f32_16x16x32_bf16 v[248:251], v[108:111], v[120:123], v[248:251]
s_add_u32 m0, s64, 65536
v_mfma_f32_16x16x32_bf16 v[244:247], v[108:111], v[116:119], v[244:247]
s_add_u32 s72, s81, 0
buffer_load_dwordx4 v1, s[44:47], s72 offen sc1 lds
v_mfma_f32_16x16x32_bf16 v[240:243], v[108:111], v[112:115], v[240:243]
s_waitcnt lgkmcnt(0)
v_mfma_f32_16x16x32_bf16 v[128:131], v[32:35], v[64:67], v[128:131]
buffer_load_dwordx4 v1, s[44:47], s72 offen offset:1024 sc1 lds
v_mfma_f32_16x16x32_bf16 v[132:135], v[32:35], v[68:71], v[132:135]
ds_read_b64_tr_b16 v[80:81], v8 offset:8192
v_add_u32 v2, 0x8000, v1
v_mfma_f32_16x16x32_bf16 v[136:139], v[32:35], v[72:75], v[136:139]
ds_read_b64_tr_b16 v[82:83], v8 offset:9216
ds_read_b128 v[112:115], v17 offset:0
v_mfma_f32_16x16x32_bf16 v[140:143], v[32:35], v[76:79], v[140:143]
ds_read_b128 v[116:119], v17 offset:2048
ds_read_b128 v[120:123], v17 offset:4096
v_mfma_f32_16x16x32_bf16 v[156:159], v[36:39], v[76:79], v[156:159]
buffer_load_dwordx4 v1, s[44:47], s72 offen offset:2048 sc1 lds
v_mfma_f32_16x16x32_bf16 v[152:155], v[36:39], v[72:75], v[152:155]
ds_read_b128 v[124:127], v17 offset:6144
ds_read_b64_tr_b16 v[84:85], v9 offset:8192
v_mfma_f32_16x16x32_bf16 v[148:151], v[36:39], v[68:71], v[148:151]
ds_read_b64_tr_b16 v[86:87], v9 offset:9216
v_mfma_f32_16x16x32_bf16 v[144:147], v[36:39], v[64:67], v[144:147]
ds_read_b64_tr_b16 v[88:89], v10 offset:8192
v_mfma_f32_16x16x32_bf16 v[160:163], v[40:43], v[64:67], v[160:163]
buffer_load_dwordx4 v1, s[44:47], s72 offen offset:3072 sc1 lds
v_mfma_f32_16x16x32_bf16 v[164:167], v[40:43], v[68:71], v[164:167]
ds_read_b64_tr_b16 v[90:91], v10 offset:9216
v_mfma_f32_16x16x32_bf16 v[168:171], v[40:43], v[72:75], v[168:171]
ds_read_b64_tr_b16 v[92:93], v11 offset:8192
v_mfma_f32_16x16x32_bf16 v[172:175], v[40:43], v[76:79], v[172:175]
s_add_u32 s81, s81, 0x8000
ds_read_b64_tr_b16 v[94:95], v11 offset:9216
v_mfma_f32_16x16x32_bf16 v[188:191], v[44:47], v[76:79], v[188:191]
s_add_u32 m0, s64, 114688
ds_read_b64_tr_b16 v[96:97], v12 offset:8192
v_mfma_f32_16x16x32_bf16 v[184:187], v[44:47], v[72:75], v[184:187]
s_add_u32 s72, s81, 16384
buffer_load_dwordx4 v1, s[44:47], s72 offen sc1 lds
v_mfma_f32_16x16x32_bf16 v[180:183], v[44:47], v[68:71], v[180:183]
ds_read_b64_tr_b16 v[98:99], v12 offset:9216
v_mfma_f32_16x16x32_bf16 v[176:179], v[44:47], v[64:67], v[176:179]
buffer_load_dwordx4 v1, s[44:47], s72 offen offset:1024 sc1 lds
v_mfma_f32_16x16x32_bf16 v[192:195], v[48:51], v[64:67], v[192:195]
ds_read_b64_tr_b16 v[100:101], v13 offset:8192
v_mfma_f32_16x16x32_bf16 v[196:199], v[48:51], v[68:71], v[196:199]
ds_read_b64_tr_b16 v[102:103], v13 offset:9216
v_mfma_f32_16x16x32_bf16 v[200:203], v[48:51], v[72:75], v[200:203]
buffer_load_dwordx4 v1, s[44:47], s72 offen offset:2048 sc1 lds
v_mfma_f32_16x16x32_bf16 v[204:207], v[48:51], v[76:79], v[204:207]
ds_read_b64_tr_b16 v[104:105], v14 offset:8192
v_mfma_f32_16x16x32_bf16 v[220:223], v[52:55], v[76:79], v[220:223]
ds_read_b64_tr_b16 v[106:107], v14 offset:9216
v_mfma_f32_16x16x32_bf16 v[216:219], v[52:55], v[72:75], v[216:219]
ds_read_b64_tr_b16 v[108:109], v15 offset:8192
v_mfma_f32_16x16x32_bf16 v[212:215], v[52:55], v[68:71], v[212:215]
buffer_load_dwordx4 v1, s[44:47], s72 offen offset:3072 sc1 lds
v_mfma_f32_16x16x32_bf16 v[208:211], v[52:55], v[64:67], v[208:211]
ds_read_b64_tr_b16 v[110:111], v15 offset:9216
v_mfma_f32_16x16x32_bf16 v[224:227], v[56:59], v[64:67], v[224:227]
v_mfma_f32_16x16x32_bf16 v[228:231], v[56:59], v[68:71], v[228:231]
s_add_u32 m0, s64, 98304
v_mfma_f32_16x16x32_bf16 v[232:235], v[56:59], v[72:75], v[232:235]
s_add_u32 s72, s81, 0
buffer_load_dwordx4 v1, s[44:47], s72 offen sc1 lds
v_mfma_f32_16x16x32_bf16 v[236:239], v[56:59], v[76:79], v[236:239]
v_mfma_f32_16x16x32_bf16 v[252:255], v[60:63], v[76:79], v[252:255]
v_mfma_f32_16x16x32_bf16 v[248:251], v[60:63], v[72:75], v[248:251]
buffer_load_dwordx4 v1, s[44:47], s72 offen offset:1024 sc1 lds
v_mfma_f32_16x16x32_bf16 v[244:247], v[60:63], v[68:71], v[244:247]
s_waitcnt vmcnt(14) lgkmcnt(0)
v_mfma_f32_16x16x32_bf16 v[240:243], v[60:63], v[64:67], v[240:243]
s_barrier
v_mfma_f32_16x16x32_bf16 v[128:131], v[80:83], v[112:115], v[128:131]
buffer_load_dwordx4 v1, s[44:47], s72 offen offset:2048 sc1 lds
v_mfma_f32_16x16x32_bf16 v[132:135], v[80:83], v[116:119], v[132:135]
ds_read_b128 a[128:131], v2 offset:16384
v_mfma_f32_16x16x32_bf16 v[136:139], v[80:83], v[120:123], v[136:139]
ds_read_b128 a[132:135], v2 offset:17408
v_mfma_f32_16x16x32_bf16 v[140:143], v[80:83], v[124:127], v[140:143]
ds_read_b128 a[136:139], v2 offset:18432
v_mfma_f32_16x16x32_bf16 v[156:159], v[84:87], v[124:127], v[156:159]
buffer_load_dwordx4 v1, s[44:47], s72 offen offset:3072 sc1 lds
v_mfma_f32_16x16x32_bf16 v[152:155], v[84:87], v[120:123], v[152:155]
ds_read_b128 a[140:143], v2 offset:19456
v_mfma_f32_16x16x32_bf16 v[148:151], v[84:87], v[116:119], v[148:151]
ds_read_b128 a[144:147], v2 offset:20480
v_mfma_f32_16x16x32_bf16 v[144:147], v[84:87], v[112:115], v[144:147]
ds_read_b128 a[148:151], v2 offset:21504
v_mfma_f32_16x16x32_bf16 v[160:163], v[88:91], v[112:115], v[160:163]
ds_read_b128 a[152:155], v2 offset:22528
v_mfma_f32_16x16x32_bf16 v[164:167], v[88:91], v[116:119], v[164:167]
ds_read_b128 a[156:159], v2 offset:23552
v_mfma_f32_16x16x32_bf16 v[168:171], v[88:91], v[120:123], v[168:171]
v_mfma_f32_16x16x32_bf16 v[172:175], v[88:91], v[124:127], v[172:175]
v_mfma_f32_16x16x32_bf16 v[188:191], v[92:95], v[124:127], v[188:191]
v_cvt_pk_bf16_f32 v64, v140, v141
v_cvt_pk_bf16_f32 v65, v142, v143
v_mfma_f32_16x16x32_bf16 v[184:187], v[92:95], v[120:123], v[184:187]
v_cvt_pk_bf16_f32 v66, v156, v157
v_cvt_pk_bf16_f32 v67, v158, v159
v_mfma_f32_16x16x32_bf16 v[180:183], v[92:95], v[116:119], v[180:183]
v_cvt_pk_bf16_f32 v48, v136, v137
v_cvt_pk_bf16_f32 v49, v138, v139
v_mfma_f32_16x16x32_bf16 v[176:179], v[92:95], v[112:115], v[176:179]
v_cvt_pk_bf16_f32 v50, v152, v153
v_cvt_pk_bf16_f32 v51, v154, v155
v_mfma_f32_16x16x32_bf16 v[192:195], v[96:99], v[112:115], v[192:195]
v_cvt_pk_bf16_f32 v32, v132, v133
v_cvt_pk_bf16_f32 v33, v134, v135
v_mfma_f32_16x16x32_bf16 v[196:199], v[96:99], v[116:119], v[196:199]
v_cvt_pk_bf16_f32 v34, v148, v149
v_cvt_pk_bf16_f32 v35, v150, v151
v_mfma_f32_16x16x32_bf16 v[200:203], v[96:99], v[120:123], v[200:203]
v_cvt_pk_bf16_f32 v16, v128, v129
v_cvt_pk_bf16_f32 v17, v130, v131
v_mfma_f32_16x16x32_bf16 v[204:207], v[96:99], v[124:127], v[204:207]
v_cvt_pk_bf16_f32 v18, v144, v145
v_cvt_pk_bf16_f32 v19, v146, v147
v_mfma_f32_16x16x32_bf16 v[220:223], v[100:103], v[124:127], v[220:223]
v_cvt_pk_bf16_f32 v68, v172, v173
v_cvt_pk_bf16_f32 v69, v174, v175
v_mfma_f32_16x16x32_bf16 v[216:219], v[100:103], v[120:123], v[216:219]
v_cvt_pk_bf16_f32 v70, v188, v189
v_cvt_pk_bf16_f32 v71, v190, v191
v_mfma_f32_16x16x32_bf16 v[212:215], v[100:103], v[116:119], v[212:215]
v_cvt_pk_bf16_f32 v52, v168, v169
v_cvt_pk_bf16_f32 v53, v170, v171
v_mfma_f32_16x16x32_bf16 v[208:211], v[100:103], v[112:115], v[208:211]
v_cvt_pk_bf16_f32 v54, v184, v185
v_cvt_pk_bf16_f32 v55, v186, v187
v_mfma_f32_16x16x32_bf16 v[224:227], v[104:107], v[112:115], v[224:227]
v_cvt_pk_bf16_f32 v36, v164, v165
v_cvt_pk_bf16_f32 v37, v166, v167
v_mfma_f32_16x16x32_bf16 v[228:231], v[104:107], v[116:119], v[228:231]
v_cvt_pk_bf16_f32 v38, v180, v181
v_cvt_pk_bf16_f32 v39, v182, v183
v_mfma_f32_16x16x32_bf16 v[232:235], v[104:107], v[120:123], v[232:235]
v_cvt_pk_bf16_f32 v20, v160, v161
v_cvt_pk_bf16_f32 v21, v162, v163
v_mfma_f32_16x16x32_bf16 v[236:239], v[104:107], v[124:127], v[236:239]
v_cvt_pk_bf16_f32 v22, v176, v177
v_cvt_pk_bf16_f32 v23, v178, v179
v_mfma_f32_16x16x32_bf16 v[252:255], v[108:111], v[124:127], v[252:255]
v_cvt_pk_bf16_f32 v72, v204, v205
v_cvt_pk_bf16_f32 v73, v206, v207
v_mfma_f32_16x16x32_bf16 v[248:251], v[108:111], v[120:123], v[248:251]
v_cvt_pk_bf16_f32 v74, v220, v221
v_cvt_pk_bf16_f32 v75, v222, v223
v_mfma_f32_16x16x32_bf16 v[244:247], v[108:111], v[116:119], v[244:247]
v_cvt_pk_bf16_f32 v56, v200, v201
v_cvt_pk_bf16_f32 v57, v202, v203
v_mfma_f32_16x16x32_bf16 v[240:243], v[108:111], v[112:115], v[240:243]
v_cvt_pk_bf16_f32 v58, v216, v217
v_cvt_pk_bf16_f32 v59, v218, v219
v_cvt_pk_bf16_f32 v40, v196, v197
v_cvt_pk_bf16_f32 v41, v198, v199
v_cvt_pk_bf16_f32 v42, v212, v213
v_cvt_pk_bf16_f32 v43, v214, v215
v_cvt_pk_bf16_f32 v24, v192, v193
v_cvt_pk_bf16_f32 v25, v194, v195
v_cvt_pk_bf16_f32 v26, v208, v209
v_cvt_pk_bf16_f32 v27, v210, v211
v_cvt_pk_bf16_f32 v76, v236, v237
v_cvt_pk_bf16_f32 v77, v238, v239
v_cvt_pk_bf16_f32 v78, v252, v253
v_cvt_pk_bf16_f32 v79, v254, v255
v_cvt_pk_bf16_f32 v60, v232, v233
v_cvt_pk_bf16_f32 v61, v234, v235
v_cvt_pk_bf16_f32 v62, v248, v249
v_cvt_pk_bf16_f32 v63, v250, v251
v_cvt_pk_bf16_f32 v44, v228, v229
v_cvt_pk_bf16_f32 v45, v230, v231
v_cvt_pk_bf16_f32 v46, v244, v245
v_cvt_pk_bf16_f32 v47, v246, v247
v_cvt_pk_bf16_f32 v28, v224, v225
v_cvt_pk_bf16_f32 v29, v226, v227
v_cvt_pk_bf16_f32 v30, v240, v241
v_cvt_pk_bf16_f32 v31, v242, v243
v_mov_b32 v124, 0xff800000
v_mov_b32 v125, 0xff800000
v_mov_b32 v126, 0xff800000
v_mov_b32 v127, 0xff800000
s_lshl_b32 s84, s60, 2
s_add_u32 s84, s84, s58
s_lshl_b32 s85, s60, 3
s_sub_u32 s85, s58, s85
s_add_u32 s85, s85, 56
s_mov_b32 s86, 0
s_add_u32 s61, s65, s60
s_and_b32 s73, s60, 1
s_lshl_b32 s73, s73, 16
s_add_u32 s77, s73, s64
s_xor_b32 s73, s73, 0x10000
s_add_u32 s92, s92, s73
s_mul_i32 s62, s58, 4608
s_add_u32 s62, s62, 143104
s_add_u32 s73, s73, 49920
s_cmp_eq_u32 s58, 0
s_cselect_b32 s62, s73, s62
s_mul_i32 s66, s58, 4160
s_sub_u32 s66, 143552, s66
Lattn:
s_mov_b32 s82, 0x10000
s_waitcnt lgkmcnt(0)
v_mfma_f32_16x16x32_bf16 v[136:139], a[128:131], v[48:51], 0
ds_read_b128 a[160:163], v2 offset:24576
v_lshrrev_b32 v240, 4, v0
v_mfma_f32_16x16x32_bf16 v[136:139], a[132:135], v[52:55], v[136:139]
ds_read_b128 a[164:167], v2 offset:25600
v_and_b32 v241, 15, v0
v_mfma_f32_16x16x32_bf16 v[136:139], a[136:139], v[56:59], v[136:139]
ds_read_b128 a[168:171], v2 offset:26624
v_lshlrev_b32 v240, 2, v240
v_mfma_f32_16x16x32_bf16 v[136:139], a[140:143], v[60:63], v[136:139]
ds_read_b128 a[172:175], v2 offset:27648
v_sub_u32 v240, v241, v240
v_mfma_f32_16x16x32_bf16 v[140:143], a[140:143], v[76:79], 0
ds_read_b128 a[176:179], v2 offset:28672
v_mov_b32 v112, 0xff800000
v_mfma_f32_16x16x32_bf16 v[140:143], a[136:139], v[72:75], v[140:143]
ds_read_b128 a[180:183], v2 offset:29696
v_mov_b32 v113, 0xff800000
v_mfma_f32_16x16x32_bf16 v[140:143], a[132:135], v[68:71], v[140:143]
ds_read_b128 a[184:187], v2 offset:30720
v_mov_b32 v114, 0xff800000
v_mfma_f32_16x16x32_bf16 v[140:143], a[128:131], v[64:67], v[140:143]
ds_read_b128 a[188:191], v2 offset:31744
v_mov_b32 v115, 0xff800000
v_mfma_f32_16x16x32_bf16 v[156:159], a[144:147], v[64:67], 0
v_cmp_gt_i32 vcc, 0, v240
v_mov_b32 v120, 0x3f803f80
v_mfma_f32_16x16x32_bf16 v[156:159], a[148:151], v[68:71], v[156:159]
v_cndmask_b32 v116, 0, v112, vcc
v_cmp_gt_i32 vcc, 1, v240
v_mfma_f32_16x16x32_bf16 v[156:159], a[152:155], v[72:75], v[156:159]
v_mov_b32 v121, 0x3f803f80
v_cndmask_b32 v117, 0, v112, vcc
v_mfma_f32_16x16x32_bf16 v[156:159], a[156:159], v[76:79], v[156:159]
v_cmp_gt_i32 vcc, 2, v240
v_mov_b32 v122, 0x3f803f80
v_mfma_f32_16x16x32_bf16 v[152:155], a[156:159], v[60:63], 0
v_cndmask_b32 v118, 0, v112, vcc
v_cmp_gt_i32 vcc, 3, v240
v_mfma_f32_16x16x32_bf16 v[152:155], a[152:155], v[56:59], v[152:155]
v_mov_b32 v123, 0x3f803f80
v_cndmask_b32 v119, 0, v112, vcc
v_mfma_f32_16x16x32_bf16 v[152:155], a[148:151], v[52:55], v[152:155]
v_mfma_f32_16x16x32_bf16 v[152:155], a[144:147], v[48:51], v[152:155]
s_cmp_eq_u32 s84, 0
s_cbranch_scc1 Lalt7
v_mfma_f32_16x16x32_bf16 v[128:131], a[128:131], v[16:19], 0
v_mfma_f32_16x16x32_bf16 v[132:135], a[128:131], v[32:35], 0
v_mfma_f32_16x16x32_bf16 v[144:147], a[144:147], v[16:19], 0
v_mfma_f32_16x16x32_bf16 v[148:151], a[144:147], v[32:35], 0
s_branch Ljoin8
Lalt7:
v_mfma_f32_16x16x32_bf16 v[128:131], a[128:131], v[16:19], v[116:119]
v_mfma_f32_16x16x32_bf16 v[132:135], a[128:131], v[32:35], 0
v_mfma_f32_16x16x32_bf16 v[144:147], a[144:147], v[16:19], v[112:115]
v_mfma_f32_16x16x32_bf16 v[148:151], a[144:147], v[32:35], v[116:119]
Ljoin8:
v_mfma_f32_16x16x32_bf16 v[128:131], a[132:135], v[20:23], v[128:131]
v_mfma_f32_16x16x32_bf16 v[128:131], a[136:139], v[24:27], v[128:131]
v_max3_f32 v240, v136, v137, v126
v_max3_f32 v242, v140, v141, v127
v_mfma_f32_16x16x32_bf16 v[128:131], a[140:143], v[28:31], v[128:131]
v_max3_f32 v240, v240, v138, v139
v_max3_f32 v242, v242, v142, v143
v_mfma_f32_16x16x32_bf16 v[132:135], a[140:143], v[44:47], v[132:135]
v_max3_f32 v240, v240, v152, v153
v_max3_f32 v242, v242, v156, v157
v_mfma_f32_16x16x32_bf16 v[132:135], a[136:139], v[40:43], v[132:135]
v_max3_f32 v240, v240, v154, v155
v_max3_f32 v242, v242, v158, v159
v_mfma_f32_16x16x32_bf16 v[132:135], a[132:135], v[36:39], v[132:135]
v_mov_b32 v241, v240
v_mov_b32 v243, v242
v_mfma_f32_16x16x32_bf16 v[148:151], a[148:151], v[36:39], v[148:151]
v_permlane16_swap_b32 v240, v241
v_permlane16_swap_b32 v242, v243
v_mfma_f32_16x16x32_bf16 v[148:151], a[152:155], v[40:43], v[148:151]
v_max_f32 v240, v240, v241
v_max_f32 v242, v242, v243
v_mfma_f32_16x16x32_bf16 v[148:151], a[156:159], v[44:47], v[148:151]
v_mov_b32 v241, v240
v_mov_b32 v243, v242
v_mfma_f32_16x16x32_bf16 v[144:147], a[156:159], v[28:31], v[144:147]
v_permlane32_swap_b32 v240, v241
v_permlane32_swap_b32 v242, v243
v_mfma_f32_16x16x32_bf16 v[144:147], a[152:155], v[24:27], v[144:147]
v_max_f32 v240, v240, v241
v_max_f32 v242, v242, v243
v_mfma_f32_16x16x32_bf16 v[144:147], a[148:151], v[20:23], v[144:147]
v_sub_f32 v88, 0, v240
v_sub_f32 v89, 0, v240
v_sub_f32 v90, 0, v240
v_sub_f32 v91, 0, v240
v_sub_f32 v104, v116, v240
v_sub_f32 v105, v117, v240
v_sub_f32 v106, v118, v240
v_sub_f32 v107, v119, v240
v_sub_f32 v136, v136, v240
v_sub_f32 v137, v137, v240
v_sub_f32 v138, v138, v240
v_sub_f32 v139, v139, v240
v_sub_f32 v152, v152, v240
v_sub_f32 v153, v153, v240
v_sub_f32 v154, v154, v240
v_sub_f32 v155, v155, v240
v_sub_f32 v92, 0, v242
v_sub_f32 v93, 0, v242
v_sub_f32 v94, 0, v242
v_sub_f32 v95, 0, v242
v_sub_f32 v108, v116, v242
v_sub_f32 v109, v117, v242
v_sub_f32 v110, v118, v242
v_sub_f32 v111, v119, v242
v_sub_f32 v140, v140, v242
v_sub_f32 v141, v141, v242
v_sub_f32 v142, v142, v242
v_sub_f32 v143, v143, v242
v_sub_f32 v156, v156, v242
v_sub_f32 v157, v157, v242
v_sub_f32 v158, v158, v242
v_sub_f32 v159, v159, v242
v_max3_f32 v240, v128, v129, v124
v_max3_f32 v242, v132, v133, v125
v_max3_f32 v240, v240, v130, v131
v_max3_f32 v242, v242, v134, v135
v_max3_f32 v240, v240, v144, v145
v_max3_f32 v242, v242, v148, v149
v_max3_f32 v240, v240, v146, v147
v_max3_f32 v242, v242, v150, v151
v_mov_b32 v241, v240
v_mov_b32 v243, v242
s_nop 0
v_permlane16_swap_b32 v240, v241
v_permlane16_swap_b32 v242, v243
v_max_f32 v240, v240, v241
v_max_f32 v242, v242, v243
v_mov_b32 v241, v240
v_mov_b32 v243, v242
s_nop 0
v_permlane32_swap_b32 v240, v241
v_permlane32_swap_b32 v242, v243
v_max_f32 v240, v240, v241
v_max_f32 v242, v242, v243
v_sub_f32 v80, 0, v240
v_sub_f32 v81, 0, v240
v_sub_f32 v82, 0, v240
v_sub_f32 v83, 0, v240
v_sub_f32 v96, v116, v240
v_sub_f32 v97, v117, v240
v_sub_f32 v98, v118, v240
v_sub_f32 v99, v119, v240
v_sub_f32 v128, v128, v240
v_sub_f32 v129, v129, v240
v_sub_f32 v130, v130, v240
v_sub_f32 v131, v131, v240
v_sub_f32 v144, v144, v240
v_sub_f32 v145, v145, v240
v_sub_f32 v146, v146, v240
v_sub_f32 v147, v147, v240
v_sub_f32 v84, 0, v242
v_sub_f32 v85, 0, v242
v_sub_f32 v86, 0, v242
v_sub_f32 v87, 0, v242
v_sub_f32 v100, v116, v242
v_sub_f32 v101, v117, v242
v_sub_f32 v102, v118, v242
v_sub_f32 v103, v119, v242
v_sub_f32 v132, v132, v242
v_sub_f32 v133, v133, v242
v_sub_f32 v134, v134, v242
v_sub_f32 v135, v135, v242
v_sub_f32 v148, v148, v242
v_sub_f32 v149, v149, v242
v_sub_f32 v150, v150, v242
v_sub_f32 v151, v151, v242
v_lshrrev_b32 v3, 1, v0
v_lshlrev_b32 v3, 7, v3
v_add_u32 v2, s82, v1
s_waitcnt vmcnt(8) lgkmcnt(0)
s_barrier
s_cmp_eq_u32 s84, 1
s_cbranch_scc1 Ltri10
s_cmp_gt_u32 s84, 1
s_cbranch_scc1 Lalt9
v_mfma_f32_16x16x32_bf16 v[160:163], a[160:163], v[16:19], v[112:115]
s_xor_b32 s74, s82, 0x10000
v_exp_f32 v128, v128
v_mfma_f32_16x16x32_bf16 v[164:167], a[160:163], v[32:35], v[112:115]
s_add_u32 s74, s74, s64
ds_read_b128 a[128:131], v2 offset:16384
ds_read_b128 a[132:135], v2 offset:17408
v_mfma_f32_16x16x32_bf16 v[176:179], a[176:179], v[16:19], v[112:115]
s_add_u32 s81, s81, 0x8000
v_exp_f32 v129, v129
v_mfma_f32_16x16x32_bf16 v[180:183], a[176:179], v[32:35], v[112:115]
s_add_u32 m0, s74, 16384
v_exp_f32 v130, v130
s_branch Ljoin11
Lalt9:
v_mfma_f32_16x16x32_bf16 v[160:163], a[160:163], v[16:19], v[80:83]
s_xor_b32 s74, s82, 0x10000
v_exp_f32 v128, v128
v_mfma_f32_16x16x32_bf16 v[164:167], a[160:163], v[32:35], v[84:87]
s_add_u32 s74, s74, s64
ds_read_b128 a[128:131], v2 offset:16384
ds_read_b128 a[132:135], v2 offset:17408
v_mfma_f32_16x16x32_bf16 v[176:179], a[176:179], v[16:19], v[80:83]
s_add_u32 s81, s81, 0x8000
v_exp_f32 v129, v129
v_mfma_f32_16x16x32_bf16 v[180:183], a[176:179], v[32:35], v[84:87]
s_add_u32 m0, s74, 16384
v_exp_f32 v130, v130
s_branch Ljoin11
Ltri10:
v_mfma_f32_16x16x32_bf16 v[160:163], a[160:163], v[16:19], v[96:99]
s_xor_b32 s74, s82, 0x10000
v_exp_f32 v128, v128
v_mfma_f32_16x16x32_bf16 v[164:167], a[160:163], v[32:35], v[84:87]
s_add_u32 s74, s74, s64
ds_read_b128 a[128:131], v2 offset:16384
ds_read_b128 a[132:135], v2 offset:17408
v_mfma_f32_16x16x32_bf16 v[176:179], a[176:179], v[16:19], v[112:115]
s_add_u32 s81, s81, 0x8000
v_exp_f32 v129, v129
v_mfma_f32_16x16x32_bf16 v[180:183], a[176:179], v[32:35], v[100:103]
s_add_u32 m0, s74, 16384
v_exp_f32 v130, v130
Ljoin11:
v_mfma_f32_16x16x32_bf16 v[160:163], a[164:167], v[20:23], v[160:163]
s_add_u32 s72, s81, 16384
v_exp_f32 v131, v131
v_mfma_f32_16x16x32_bf16 v[160:163], a[168:171], v[24:27], v[160:163]
v_exp_f32 v144, v144
v_mfma_f32_16x16x32_bf16 v[160:163], a[172:175], v[28:31], v[160:163]
ds_read_b128 a[136:139], v2 offset:18432
ds_read_b128 a[140:143], v2 offset:19456
v_mfma_f32_16x16x32_bf16 v[164:167], a[172:175], v[44:47], v[164:167]
ds_read_b128 a[144:147], v2 offset:20480
ds_read_b128 a[148:151], v2 offset:21504
v_mfma_f32_16x16x32_bf16 v[164:167], a[168:171], v[40:43], v[164:167]
ds_read_b128 a[152:155], v2 offset:22528
ds_read_b128 a[156:159], v2 offset:23552
v_mfma_f32_16x16x32_bf16 v[164:167], a[164:167], v[36:39], v[164:167]
ds_read_b128 a[192:195], v2 offset:0
ds_read_b128 a[196:199], v2 offset:1024
v_mfma_f32_16x16x32_bf16 v[168:171], a[160:163], v[48:51], v[88:91]
ds_read_b128 a[200:203], v2 offset:2048
ds_read_b128 a[204:207], v2 offset:3072
v_mfma_f32_16x16x32_bf16 v[168:171], a[164:167], v[52:55], v[168:171]
ds_read_b128 a[208:211], v2 offset:4096
ds_read_b128 a[212:215], v2 offset:5120
v_mfma_f32_16x16x32_bf16 v[168:171], a[168:171], v[56:59], v[168:171]
ds_read_b128 a[216:219], v2 offset:6144
ds_read_b128 a[220:223], v2 offset:7168
v_mfma_f32_16x16x32_bf16 v[168:171], a[172:175], v[60:63], v[168:171]
v_cvt_pk_bf16_f32 v192, v128, v129
v_cvt_pk_bf16_f32 v193, v130, v131
v_mfma_f32_16x16x32_bf16 v[172:175], a[172:175], v[76:79], v[92:95]
buffer_load_dwordx4 v1, s[44:47], s72 offen sc1 lds
v_mfma_f32_16x16x32_bf16 v[172:175], a[168:171], v[72:75], v[172:175]
v_exp_f32 v145, v145
v_mfma_f32_16x16x32_bf16 v[172:175], a[164:167], v[68:71], v[172:175]
v_exp_f32 v146, v146
v_mfma_f32_16x16x32_bf16 v[172:175], a[160:163], v[64:67], v[172:175]
v_exp_f32 v147, v147
v_mfma_f32_16x16x32_bf16 v[188:191], a[176:179], v[64:67], v[92:95]
v_exp_f32 v132, v132
v_mfma_f32_16x16x32_bf16 v[188:191], a[180:183], v[68:71], v[188:191]
v_cvt_pk_bf16_f32 v194, v144, v145
v_cvt_pk_bf16_f32 v195, v146, v147
v_mfma_f32_16x16x32_bf16 v[188:191], a[184:187], v[72:75], v[188:191]
v_exp_f32 v133, v133
v_mfma_f32_16x16x32_bf16 v[188:191], a[188:191], v[76:79], v[188:191]
v_exp_f32 v134, v134
v_mfma_f32_16x16x32_bf16 v[184:187], a[188:191], v[60:63], v[88:91]
v_exp_f32 v135, v135
v_mfma_f32_16x16x32_bf16 v[184:187], a[184:187], v[56:59], v[184:187]
v_exp_f32 v148, v148
v_mfma_f32_16x16x32_bf16 v[184:187], a[180:183], v[52:55], v[184:187]
v_cvt_pk_bf16_f32 v196, v132, v133
v_cvt_pk_bf16_f32 v197, v134, v135
v_mfma_f32_16x16x32_bf16 v[184:187], a[176:179], v[48:51], v[184:187]
buffer_load_dwordx4 v1, s[44:47], s72 offen offset:1024 sc1 lds
v_mfma_f32_16x16x32_bf16 v[180:183], a[180:183], v[36:39], v[180:183]
v_exp_f32 v149, v149
v_mfma_f32_16x16x32_bf16 v[180:183], a[184:187], v[40:43], v[180:183]
v_exp_f32 v150, v150
v_mfma_f32_16x16x32_bf16 v[180:183], a[188:191], v[44:47], v[180:183]
v_exp_f32 v151, v151
v_mfma_f32_16x16x32_bf16 v[176:179], a[188:191], v[28:31], v[176:179]
buffer_load_dwordx4 v1, s[44:47], s72 offen offset:2048 sc1 lds
v_mfma_f32_16x16x32_bf16 v[176:179], a[184:187], v[24:27], v[176:179]
buffer_load_dwordx4 v1, s[44:47], s72 offen offset:3072 sc1 lds
v_mfma_f32_16x16x32_bf16 v[176:179], a[180:183], v[20:23], v[176:179]
s_waitcnt lgkmcnt(8)
v_exp_f32 v136, v136
v_cvt_pk_bf16_f32 v198, v148, v149
v_cvt_pk_bf16_f32 v199, v150, v151
v_exp_f32 v137, v137
v_exp_f32 v138, v138
v_cvt_pk_bf16_f32 v200, v136, v137
v_exp_f32 v139, v139
v_exp_f32 v152, v152
v_cvt_pk_bf16_f32 v201, v138, v139
v_exp_f32 v153, v153
v_exp_f32 v154, v154
v_cvt_pk_bf16_f32 v202, v152, v153
v_exp_f32 v155, v155
v_exp_f32 v140, v140
v_cvt_pk_bf16_f32 v203, v154, v155
v_exp_f32 v141, v141
v_exp_f32 v142, v142
v_cvt_pk_bf16_f32 v204, v140, v141
v_exp_f32 v143, v143
v_exp_f32 v156, v156
v_cvt_pk_bf16_f32 v205, v142, v143
v_exp_f32 v157, v157
v_exp_f32 v158, v158
v_cvt_pk_bf16_f32 v206, v156, v157
v_exp_f32 v159, v159
s_nop 0
v_cvt_pk_bf16_f32 v207, v158, v159
s_cmp_eq_u32 s84, 2
s_cbranch_scc1 Ltri13
s_cmp_gt_u32 s84, 2
s_cbranch_scc1 Lalt12
v_mfma_f32_16x16x32_bf16 v[128:131], a[128:131], v[16:19], v[112:115]
s_add_u32 s82, s82, 0x8000
ds_read_b128 a[160:163], v2 offset:24576
v_mfma_f32_16x16x32_bf16 v[132:135], a[128:131], v[32:35], v[112:115]
s_and_b32 s82, s82, 0x1ffff
v_exp_f32 v160, v160
v_mfma_f32_16x16x32_bf16 v[144:147], a[144:147], v[16:19], v[112:115]
s_add_u32 m0, s74, 0
v_exp_f32 v161, v161
v_mfma_f32_16x16x32_bf16 v[148:151], a[144:147], v[32:35], v[112:115]
s_add_u32 s72, s81, 0
ds_read_b128 a[164:167], v2 offset:25600
v_cvt_pk_bf16_f32 v208, v160, v161
s_branch Ljoin14
Lalt12:
v_mfma_f32_16x16x32_bf16 v[128:131], a[128:131], v[16:19], v[80:83]
s_add_u32 s82, s82, 0x8000
ds_read_b128 a[160:163], v2 offset:24576
v_mfma_f32_16x16x32_bf16 v[132:135], a[128:131], v[32:35], v[84:87]
s_and_b32 s82, s82, 0x1ffff
v_exp_f32 v160, v160
v_mfma_f32_16x16x32_bf16 v[144:147], a[144:147], v[16:19], v[80:83]
s_add_u32 m0, s74, 0
v_exp_f32 v161, v161
v_mfma_f32_16x16x32_bf16 v[148:151], a[144:147], v[32:35], v[84:87]
s_add_u32 s72, s81, 0
ds_read_b128 a[164:167], v2 offset:25600
v_cvt_pk_bf16_f32 v208, v160, v161
s_branch Ljoin14
Ltri13:
v_mfma_f32_16x16x32_bf16 v[128:131], a[128:131], v[16:19], v[96:99]
s_add_u32 s82, s82, 0x8000
ds_read_b128 a[160:163], v2 offset:24576
v_mfma_f32_16x16x32_bf16 v[132:135], a[128:131], v[32:35], v[84:87]
s_and_b32 s82, s82, 0x1ffff
v_exp_f32 v160, v160
v_mfma_f32_16x16x32_bf16 v[144:147], a[144:147], v[16:19], v[112:115]
s_add_u32 m0, s74, 0
v_exp_f32 v161, v161
v_mfma_f32_16x16x32_bf16 v[148:151], a[144:147], v[32:35], v[100:103]
s_add_u32 s72, s81, 0
ds_read_b128 a[164:167], v2 offset:25600
v_cvt_pk_bf16_f32 v208, v160, v161
Ljoin14:
v_mfma_f32_16x16x32_bf16 v[128:131], a[132:135], v[20:23], v[128:131]
v_exp_f32 v162, v162
v_mfma_f32_16x16x32_bf16 v[128:131], a[136:139], v[24:27], v[128:131]
v_exp_f32 v163, v163
v_mfma_f32_16x16x32_bf16 v[128:131], a[140:143], v[28:31], v[128:131]
buffer_load_dwordx4 v1, s[44:47], s72 offen sc1 lds
v_mfma_f32_16x16x32_bf16 v[132:135], a[140:143], v[44:47], v[132:135]
ds_read_b128 a[168:171], v2 offset:26624
v_cvt_pk_bf16_f32 v209, v162, v163
v_mfma_f32_16x16x32_bf16 v[132:135], a[136:139], v[40:43], v[132:135]
v_exp_f32 v176, v176
v_mfma_f32_16x16x32_bf16 v[132:135], a[132:135], v[36:39], v[132:135]
v_exp_f32 v177, v177
v_mfma_f32_16x16x32_bf16 v[136:139], a[128:131], v[48:51], v[88:91]
ds_read_b128 a[172:175], v2 offset:27648
v_cvt_pk_bf16_f32 v210, v176, v177
v_mfma_f32_16x16x32_bf16 v[136:139], a[132:135], v[52:55], v[136:139]
v_exp_f32 v178, v178
v_mfma_f32_16x16x32_bf16 v[136:139], a[136:139], v[56:59], v[136:139]
v_exp_f32 v179, v179
v_mfma_f32_16x16x32_bf16 v[136:139], a[140:143], v[60:63], v[136:139]
ds_read_b128 a[176:179], v2 offset:28672
v_cvt_pk_bf16_f32 v211, v178, v179
v_mfma_f32_16x16x32_bf16 v[140:143], a[140:143], v[76:79], v[92:95]
v_exp_f32 v164, v164
v_mfma_f32_16x16x32_bf16 v[140:143], a[136:139], v[72:75], v[140:143]
v_exp_f32 v165, v165
v_mfma_f32_16x16x32_bf16 v[140:143], a[132:135], v[68:71], v[140:143]
ds_read_b128 a[180:183], v2 offset:29696
v_cvt_pk_bf16_f32 v212, v164, v165
v_mfma_f32_16x16x32_bf16 v[140:143], a[128:131], v[64:67], v[140:143]
v_exp_f32 v166, v166
v_mfma_f32_16x16x32_bf16 v[156:159], a[144:147], v[64:67], v[92:95]
buffer_load_dwordx4 v1, s[44:47], s72 offen offset:1024 sc1 lds
v_mfma_f32_16x16x32_bf16 v[156:159], a[148:151], v[68:71], v[156:159]
v_exp_f32 v167, v167
v_mfma_f32_16x16x32_bf16 v[156:159], a[152:155], v[72:75], v[156:159]
ds_read_b128 a[184:187], v2 offset:30720
v_cvt_pk_bf16_f32 v213, v166, v167
v_mfma_f32_16x16x32_bf16 v[156:159], a[156:159], v[76:79], v[156:159]
v_exp_f32 v180, v180
v_mfma_f32_16x16x32_bf16 v[152:155], a[156:159], v[60:63], v[88:91]
v_exp_f32 v181, v181
v_mfma_f32_16x16x32_bf16 v[152:155], a[152:155], v[56:59], v[152:155]
ds_read_b128 a[188:191], v2 offset:31744
v_cvt_pk_bf16_f32 v214, v180, v181
v_mfma_f32_16x16x32_bf16 v[152:155], a[148:151], v[52:55], v[152:155]
v_exp_f32 v182, v182
v_mfma_f32_16x16x32_bf16 v[152:155], a[144:147], v[48:51], v[152:155]
v_exp_f32 v183, v183
v_mfma_f32_16x16x32_bf16 v[148:151], a[148:151], v[36:39], v[148:151]
ds_read_b128 a[224:227], v2 offset:8192
v_cvt_pk_bf16_f32 v215, v182, v183
v_mfma_f32_16x16x32_bf16 v[148:151], a[152:155], v[40:43], v[148:151]
v_exp_f32 v168, v168
v_mfma_f32_16x16x32_bf16 v[148:151], a[156:159], v[44:47], v[148:151]
buffer_load_dwordx4 v1, s[44:47], s72 offen offset:2048 sc1 lds
v_mfma_f32_16x16x32_bf16 v[144:147], a[156:159], v[28:31], v[144:147]
v_exp_f32 v169, v169
v_mfma_f32_16x16x32_bf16 v[144:147], a[152:155], v[24:27], v[144:147]
ds_read_b128 a[228:231], v2 offset:9216
v_cvt_pk_bf16_f32 v216, v168, v169
v_mfma_f32_16x16x32_bf16 v[144:147], a[148:151], v[20:23], v[144:147]
s_waitcnt lgkmcnt(10)
v_exp_f32 v170, v170
v_mfma_f32_16x16x32_bf16 a[0:3], a[192:195], v[192:195], 0
v_exp_f32 v171, v171
v_mfma_f32_16x16x32_bf16 a[32:35], a[192:195], v[196:199], 0
ds_read_b128 a[232:235], v2 offset:10240
v_cvt_pk_bf16_f32 v217, v170, v171
v_mfma_f32_16x16x32_bf16 a[64:67], a[192:195], v[200:203], 0
v_exp_f32 v184, v184
v_mfma_f32_16x16x32_bf16 a[96:99], a[192:195], v[204:207], 0
v_exp_f32 v185, v185
v_mfma_f32_16x16x32_bf16 a[100:103], a[196:199], v[204:207], 0
ds_read_b128 a[236:239], v2 offset:11264
v_cvt_pk_bf16_f32 v218, v184, v185
v_mfma_f32_16x16x32_bf16 a[68:71], a[196:199], v[200:203], 0
v_exp_f32 v186, v186
v_mfma_f32_16x16x32_bf16 a[36:39], a[196:199], v[196:199], 0
buffer_load_dwordx4 v1, s[44:47], s72 offen offset:3072 sc1 lds
v_mfma_f32_16x16x32_bf16 a[4:7], a[196:199], v[192:195], 0
v_exp_f32 v187, v187
v_mfma_f32_16x16x32_bf16 a[8:11], a[200:203], v[192:195], 0
ds_read_b128 a[240:243], v2 offset:12288
v_cvt_pk_bf16_f32 v219, v186, v187
v_mfma_f32_16x16x32_bf16 a[40:43], a[200:203], v[196:199], 0
v_exp_f32 v172, v172
v_mfma_f32_16x16x32_bf16 a[72:75], a[200:203], v[200:203], 0
v_exp_f32 v173, v173
v_mfma_f32_16x16x32_bf16 a[104:107], a[200:203], v[204:207], 0
ds_read_b128 a[244:247], v2 offset:13312
v_cvt_pk_bf16_f32 v220, v172, v173
v_mfma_f32_16x16x32_bf16 a[108:111], a[204:207], v[204:207], 0
v_exp_f32 v174, v174
v_mfma_f32_16x16x32_bf16 a[76:79], a[204:207], v[200:203], 0
v_exp_f32 v175, v175
v_mfma_f32_16x16x32_bf16 a[44:47], a[204:207], v[196:199], 0
ds_read_b128 a[248:251], v2 offset:14336
v_cvt_pk_bf16_f32 v221, v174, v175
v_mfma_f32_16x16x32_bf16 a[12:15], a[204:207], v[192:195], 0
v_exp_f32 v188, v188
v_mfma_f32_16x16x32_bf16 a[16:19], a[208:211], v[192:195], 0
v_exp_f32 v189, v189
v_mfma_f32_16x16x32_bf16 a[48:51], a[208:211], v[196:199], 0
buffer_load_dword v4, v3, s[36:39], s93 offen
v_mfma_f32_16x16x32_bf16 a[80:83], a[208:211], v[200:203], 0
ds_read_b128 a[252:255], v2 offset:15360
v_cvt_pk_bf16_f32 v222, v188, v189
v_mfma_f32_16x16x32_bf16 a[112:115], a[208:211], v[204:207], 0
v_exp_f32 v190, v190
v_mfma_f32_16x16x32_bf16 a[116:119], a[212:215], v[204:207], 0
v_exp_f32 v191, v191
v_mfma_f32_16x16x32_bf16 a[84:87], a[212:215], v[200:203], 0
v_cvt_pk_bf16_f32 v223, v190, v191
v_add_u32 v2, s82, v1
v_mfma_f32_16x16x32_bf16 a[52:55], a[212:215], v[196:199], 0
v_and_b32 v240, 15, v0
v_lshrrev_b32 v241, 4, v0
v_mfma_f32_16x16x32_bf16 a[20:23], a[212:215], v[192:195], 0
v_add_u32 v248, 1, v240
v_and_b32 v249, 3, v248
v_mfma_f32_16x16x32_bf16 a[24:27], a[216:219], v[192:195], 0
v_lshrrev_b32 v248, 2, v248
v_mfma_f32_16x16x32_bf16 a[56:59], a[216:219], v[196:199], 0
s_sub_u32 s73, s92, 4160
v_mov_b32 v250, s66
v_max_u32 v6, 1, v249
v_mfma_f32_16x16x32_bf16 a[88:91], a[216:219], v[200:203], 0
v_cmp_ne_u32 vcc, 1, v249
v_mul_u32_u24 v6, 4160, v6
v_mfma_f32_16x16x32_bf16 a[120:123], a[216:219], v[204:207], 0
v_add_u32 v6, s73, v6
v_cndmask_b32 v6, v250, v6, vcc
v_mfma_f32_16x16x32_bf16 a[124:127], a[220:223], v[204:207], 0
v_bfe_u32 v251, v0, 2, 2
v_lshl_add_u32 v6, v248, 3, v6
v_mfma_f32_16x16x32_bf16 a[92:95], a[220:223], v[200:203], 0
v_lshl_add_u32 v6, v241, 4, v6
v_max_u32 v5, 1, v251
v_mfma_f32_16x16x32_bf16 a[60:63], a[220:223], v[196:199], 0
v_cmp_ne_u32 vcc, 1, v251
v_mul_u32_u24 v5, 4160, v5
v_mfma_f32_16x16x32_bf16 a[28:31], a[220:223], v[192:195], 0
v_add_u32 v5, s73, v5
v_cndmask_b32 v5, v250, v5, vcc
v_mfma_f32_16x16x32_bf16 v[224:227], v[120:123], v[192:195], 0
s_add_u32 s73, s62, 480
v_lshlrev_b32 v248, 5, v240
v_sub_u32 v248, s73, v248
v_mfma_f32_16x16x32_bf16 v[228:231], v[120:123], v[196:199], 0
v_lshl_add_u32 v7, v241, 4, v248
v_mfma_f32_16x16x32_bf16 v[232:235], v[120:123], v[200:203], 0
s_waitcnt vmcnt(9) lgkmcnt(8)
v_mfma_f32_16x16x32_bf16 v[236:239], v[120:123], v[204:207], 0
s_barrier
s_cmp_eq_u32 s60, 0
s_cbranch_scc1 LLT3
s_lshl_b32 s75, s59, 4
s_and_b32 s76, s84, 15
s_add_u32 s75, s75, s76
s_lshl_b32 s75, s75, 14
s_cmp_ge_u32 s60, 4
s_cselect_b32 s75, s75, 0x40001000
s_lshl_b32 s83, s60, 1
s_sub_u32 s83, 2, s83
s_cmp_eq_u32 s83, 0
s_cbranch_scc1 LLT1
.p2align 5
s_nop 0
s_nop 0
LloopI:
v_mfma_f32_16x16x32_bf16 v[160:163], a[160:163], v[16:19], v[80:83]
s_xor_b32 s74, s82, 0x10000
v_exp_f32 v128, v128
v_mfma_f32_16x16x32_bf16 v[160:163], a[164:167], v[20:23], v[160:163]
s_add_u32 s74, s74, s64
ds_read_b128 a[128:131], v2 offset:16384
v_mfma_f32_16x16x32_bf16 v[160:163], a[168:171], v[24:27], v[160:163]
s_add_u32 s81, s81, 0x8000
v_exp_f32 v129, v129
v_mfma_f32_16x16x32_bf16 v[160:163], a[172:175], v[28:31], v[160:163]
s_add_u32 m0, s74, 16384
v_exp_f32 v130, v130
v_mfma_f32_16x16x32_bf16 v[164:167], a[172:175], v[44:47], v[84:87]
s_add_u32 s72, s81, 16384
ds_read_b128 a[132:135], v2 offset:17408
v_cvt_pk_bf16_f32 v192, v128, v129
v_mfma_f32_16x16x32_bf16 v[164:167], a[168:171], v[40:43], v[164:167]
v_exp_f32 v131, v131
v_mfma_f32_16x16x32_bf16 v[164:167], a[164:167], v[36:39], v[164:167]
v_exp_f32 v144, v144
v_mfma_f32_16x16x32_bf16 v[164:167], a[160:163], v[32:35], v[164:167]
ds_read_b128 a[136:139], v2 offset:18432
v_cvt_pk_bf16_f32 v193, v130, v131
v_mfma_f32_16x16x32_bf16 v[168:171], a[160:163], v[48:51], v[88:91]
buffer_load_dwordx4 v1, s[44:47], s72 offen sc1 lds
v_mfma_f32_16x16x32_bf16 v[168:171], a[164:167], v[52:55], v[168:171]
v_exp_f32 v145, v145
v_mfma_f32_16x16x32_bf16 v[168:171], a[168:171], v[56:59], v[168:171]
v_exp_f32 v146, v146
v_mfma_f32_16x16x32_bf16 v[168:171], a[172:175], v[60:63], v[168:171]
ds_read_b128 a[140:143], v2 offset:19456
v_cvt_pk_bf16_f32 v194, v144, v145
v_mfma_f32_16x16x32_bf16 v[172:175], a[172:175], v[76:79], v[92:95]
v_exp_f32 v147, v147
v_mfma_f32_16x16x32_bf16 v[172:175], a[168:171], v[72:75], v[172:175]
v_exp_f32 v132, v132
v_mfma_f32_16x16x32_bf16 v[172:175], a[164:167], v[68:71], v[172:175]
ds_read_b128 a[144:147], v2 offset:20480
v_cvt_pk_bf16_f32 v195, v146, v147
v_mfma_f32_16x16x32_bf16 v[172:175], a[160:163], v[64:67], v[172:175]
v_exp_f32 v133, v133
v_mfma_f32_16x16x32_bf16 v[188:191], a[176:179], v[64:67], v[92:95]
v_exp_f32 v134, v134
v_mfma_f32_16x16x32_bf16 v[188:191], a[180:183], v[68:71], v[188:191]
ds_read_b128 a[148:151], v2 offset:21504
v_cvt_pk_bf16_f32 v196, v132, v133
v_mfma_f32_16x16x32_bf16 v[188:191], a[184:187], v[72:75], v[188:191]
v_exp_f32 v135, v135
v_mfma_f32_16x16x32_bf16 v[188:191], a[188:191], v[76:79], v[188:191]
v_exp_f32 v148, v148
v_mfma_f32_16x16x32_bf16 v[184:187], a[188:191], v[60:63], v[88:91]
ds_read_b128 a[152:155], v2 offset:22528
v_cvt_pk_bf16_f32 v197, v134, v135
v_mfma_f32_16x16x32_bf16 v[184:187], a[184:187], v[56:59], v[184:187]
buffer_load_dwordx4 v1, s[44:47], s72 offen offset:1024 sc1 lds
v_mfma_f32_16x16x32_bf16 v[184:187], a[180:183], v[52:55], v[184:187]
v_exp_f32 v149, v149
v_mfma_f32_16x16x32_bf16 v[184:187], a[176:179], v[48:51], v[184:187]
v_exp_f32 v150, v150
v_mfma_f32_16x16x32_bf16 v[180:183], a[176:179], v[32:35], v[84:87]
ds_read_b128 a[156:159], v2 offset:23552
v_cvt_pk_bf16_f32 v198, v148, v149
v_mfma_f32_16x16x32_bf16 v[180:183], a[180:183], v[36:39], v[180:183]
v_exp_f32 v151, v151
v_mfma_f32_16x16x32_bf16 v[180:183], a[184:187], v[40:43], v[180:183]
v_exp_f32 v136, v136
v_mfma_f32_16x16x32_bf16 v[180:183], a[188:191], v[44:47], v[180:183]
ds_read_b128 a[192:195], v2 offset:0
v_cvt_pk_bf16_f32 v199, v150, v151
v_mfma_f32_16x16x32_bf16 v[176:179], a[188:191], v[28:31], v[80:83]
v_exp_f32 v137, v137
v_mfma_f32_16x16x32_bf16 v[176:179], a[184:187], v[24:27], v[176:179]
v_exp_f32 v138, v138
v_mfma_f32_16x16x32_bf16 v[176:179], a[180:183], v[20:23], v[176:179]
ds_read_b128 a[196:199], v2 offset:1024
v_cvt_pk_bf16_f32 v200, v136, v137
v_mfma_f32_16x16x32_bf16 v[176:179], a[176:179], v[16:19], v[176:179]
s_waitcnt lgkmcnt(10)
v_exp_f32 v139, v139
v_mfma_f32_16x16x32_bf16 a[0:3], a[224:227], v[208:211], a[0:3]
v_exp_f32 v152, v152
v_mfma_f32_16x16x32_bf16 a[32:35], a[224:227], v[212:215], a[32:35]
ds_read_b128 a[200:203], v2 offset:2048
v_cvt_pk_bf16_f32 v201, v138, v139
v_mfma_f32_16x16x32_bf16 a[64:67], a[224:227], v[216:219], a[64:67]
buffer_load_dwordx4 v1, s[44:47], s72 offen offset:2048 sc1 lds
v_mfma_f32_16x16x32_bf16 a[96:99], a[224:227], v[220:223], a[96:99]
v_exp_f32 v153, v153
v_mfma_f32_16x16x32_bf16 a[100:103], a[228:231], v[220:223], a[100:103]
v_exp_f32 v154, v154
v_mfma_f32_16x16x32_bf16 a[68:71], a[228:231], v[216:219], a[68:71]
ds_read_b128 a[204:207], v2 offset:3072
v_cvt_pk_bf16_f32 v202, v152, v153
v_mfma_f32_16x16x32_bf16 a[36:39], a[228:231], v[212:215], a[36:39]
v_exp_f32 v155, v155
v_mfma_f32_16x16x32_bf16 a[4:7], a[228:231], v[208:211], a[4:7]
v_exp_f32 v140, v140
v_mfma_f32_16x16x32_bf16 a[8:11], a[232:235], v[208:211], a[8:11]
ds_read_b128 a[208:211], v2 offset:4096
v_cvt_pk_bf16_f32 v203, v154, v155
v_mfma_f32_16x16x32_bf16 a[40:43], a[232:235], v[212:215], a[40:43]
v_exp_f32 v141, v141
v_mfma_f32_16x16x32_bf16 a[72:75], a[232:235], v[216:219], a[72:75]
v_exp_f32 v142, v142
v_mfma_f32_16x16x32_bf16 a[104:107], a[232:235], v[220:223], a[104:107]
ds_read_b128 a[212:215], v2 offset:5120
v_cvt_pk_bf16_f32 v204, v140, v141
v_mfma_f32_16x16x32_bf16 a[108:111], a[236:239], v[220:223], a[108:111]
v_exp_f32 v143, v143
v_mfma_f32_16x16x32_bf16 a[76:79], a[236:239], v[216:219], a[76:79]
v_exp_f32 v156, v156
v_mfma_f32_16x16x32_bf16 a[44:47], a[236:239], v[212:215], a[44:47]
ds_read_b128 a[216:219], v2 offset:6144
v_cvt_pk_bf16_f32 v205, v142, v143
v_mfma_f32_16x16x32_bf16 a[12:15], a[236:239], v[208:211], a[12:15]
buffer_load_dwordx4 v1, s[44:47], s72 offen offset:3072 sc1 lds
v_mfma_f32_16x16x32_bf16 a[16:19], a[240:243], v[208:211], a[16:19]
v_exp_f32 v157, v157
v_mfma_f32_16x16x32_bf16 a[48:51], a[240:243], v[212:215], a[48:51]
v_exp_f32 v158, v158
v_mfma_f32_16x16x32_bf16 a[80:83], a[240:243], v[216:219], a[80:83]
ds_read_b128 a[220:223], v2 offset:7168
v_cvt_pk_bf16_f32 v206, v156, v157
v_mfma_f32_16x16x32_bf16 a[112:115], a[240:243], v[220:223], a[112:115]
v_exp_f32 v159, v159
v_mfma_f32_16x16x32_bf16 a[116:119], a[244:247], v[220:223], a[116:119]
v_cvt_pk_bf16_f32 v207, v158, v159
v_add_u32 v15, s75, v3
v_mfma_f32_16x16x32_bf16 a[84:87], a[244:247], v[216:219], a[84:87]
v_mfma_f32_16x16x32_bf16 a[52:55], a[244:247], v[212:215], a[52:55]
v_mfma_f32_16x16x32_bf16 a[20:23], a[244:247], v[208:211], a[20:23]
v_mfma_f32_16x16x32_bf16 a[24:27], a[248:251], v[208:211], a[24:27]
v_mfma_f32_16x16x32_bf16 a[56:59], a[248:251], v[212:215], a[56:59]
v_mfma_f32_16x16x32_bf16 a[88:91], a[248:251], v[216:219], a[88:91]
v_mfma_f32_16x16x32_bf16 a[120:123], a[248:251], v[220:223], a[120:123]
v_mfma_f32_16x16x32_bf16 a[124:127], a[252:255], v[220:223], a[124:127]
v_mfma_f32_16x16x32_bf16 a[92:95], a[252:255], v[216:219], a[92:95]
v_mfma_f32_16x16x32_bf16 a[60:63], a[252:255], v[212:215], a[60:63]
v_mfma_f32_16x16x32_bf16 a[28:31], a[252:255], v[208:211], a[28:31]
v_mfma_f32_16x16x32_bf16 v[224:227], v[120:123], v[208:211], v[224:227]
v_mfma_f32_16x16x32_bf16 v[228:231], v[120:123], v[212:215], v[228:231]
v_mfma_f32_16x16x32_bf16 v[232:235], v[120:123], v[216:219], v[232:235]
v_mfma_f32_16x16x32_bf16 v[236:239], v[120:123], v[220:223], v[236:239]
s_waitcnt lgkmcnt(8)
v_mfma_f32_16x16x32_bf16 v[128:131], a[128:131], v[16:19], v[80:83]
s_add_u32 s82, s82, 0x8000
ds_read_b128 a[160:163], v2 offset:24576
v_mfma_f32_16x16x32_bf16 v[128:131], a[132:135], v[20:23], v[128:131]
s_and_b32 s82, s82, 0x1ffff
v_exp_f32 v160, v160
v_mfma_f32_16x16x32_bf16 v[128:131], a[136:139], v[24:27], v[128:131]
s_add_u32 m0, s74, 0
v_exp_f32 v161, v161
v_mfma_f32_16x16x32_bf16 v[128:131], a[140:143], v[28:31], v[128:131]
s_add_u32 s72, s81, 0
ds_read_b128 a[164:167], v2 offset:25600
v_cvt_pk_bf16_f32 v208, v160, v161
v_mfma_f32_16x16x32_bf16 v[132:135], a[140:143], v[44:47], v[84:87]
v_exp_f32 v162, v162
v_mfma_f32_16x16x32_bf16 v[132:135], a[136:139], v[40:43], v[132:135]
v_exp_f32 v163, v163
v_mfma_f32_16x16x32_bf16 v[132:135], a[132:135], v[36:39], v[132:135]
buffer_load_dwordx4 v1, s[44:47], s72 offen sc1 lds
v_mfma_f32_16x16x32_bf16 v[132:135], a[128:131], v[32:35], v[132:135]
ds_read_b128 a[168:171], v2 offset:26624
v_cvt_pk_bf16_f32 v209, v162, v163
v_mfma_f32_16x16x32_bf16 v[136:139], a[128:131], v[48:51], v[88:91]
v_exp_f32 v176, v176
v_mfma_f32_16x16x32_bf16 v[136:139], a[132:135], v[52:55], v[136:139]
v_exp_f32 v177, v177
v_mfma_f32_16x16x32_bf16 v[136:139], a[136:139], v[56:59], v[136:139]
ds_read_b128 a[172:175], v2 offset:27648
v_cvt_pk_bf16_f32 v210, v176, v177
v_mfma_f32_16x16x32_bf16 v[136:139], a[140:143], v[60:63], v[136:139]
v_exp_f32 v178, v178
v_mfma_f32_16x16x32_bf16 v[140:143], a[140:143], v[76:79], v[92:95]
v_exp_f32 v179, v179
v_mfma_f32_16x16x32_bf16 v[140:143], a[136:139], v[72:75], v[140:143]
ds_read_b128 a[176:179], v2 offset:28672
v_cvt_pk_bf16_f32 v211, v178, v179
v_mfma_f32_16x16x32_bf16 v[140:143], a[132:135], v[68:71], v[140:143]
v_exp_f32 v164, v164
v_mfma_f32_16x16x32_bf16 v[140:143], a[128:131], v[64:67], v[140:143]
v_exp_f32 v165, v165
v_mfma_f32_16x16x32_bf16 v[156:159], a[144:147], v[64:67], v[92:95]
ds_read_b128 a[180:183], v2 offset:29696
v_cvt_pk_bf16_f32 v212, v164, v165
v_mfma_f32_16x16x32_bf16 v[156:159], a[148:151], v[68:71], v[156:159]
buffer_load_dwordx4 v1, s[44:47], s72 offen offset:1024 sc1 lds
v_mfma_f32_16x16x32_bf16 v[156:159], a[152:155], v[72:75], v[156:159]
v_exp_f32 v166, v166
v_mfma_f32_16x16x32_bf16 v[156:159], a[156:159], v[76:79], v[156:159]
v_exp_f32 v167, v167
v_mfma_f32_16x16x32_bf16 v[152:155], a[156:159], v[60:63], v[88:91]
ds_read_b128 a[184:187], v2 offset:30720
v_cvt_pk_bf16_f32 v213, v166, v167
v_mfma_f32_16x16x32_bf16 v[152:155], a[152:155], v[56:59], v[152:155]
v_exp_f32 v180, v180
v_mfma_f32_16x16x32_bf16 v[152:155], a[148:151], v[52:55], v[152:155]
v_exp_f32 v181, v181
v_mfma_f32_16x16x32_bf16 v[152:155], a[144:147], v[48:51], v[152:155]
ds_read_b128 a[188:191], v2 offset:31744
v_cvt_pk_bf16_f32 v214, v180, v181
v_mfma_f32_16x16x32_bf16 v[148:151], a[144:147], v[32:35], v[84:87]
v_exp_f32 v182, v182
v_mfma_f32_16x16x32_bf16 v[148:151], a[148:151], v[36:39], v[148:151]
v_exp_f32 v183, v183
v_mfma_f32_16x16x32_bf16 v[148:151], a[152:155], v[40:43], v[148:151]
ds_read_b128 a[224:227], v2 offset:8192
v_cvt_pk_bf16_f32 v215, v182, v183
v_mfma_f32_16x16x32_bf16 v[148:151], a[156:159], v[44:47], v[148:151]
v_exp_f32 v168, v168
v_mfma_f32_16x16x32_bf16 v[144:147], a[156:159], v[28:31], v[80:83]
buffer_load_dwordx4 v1, s[44:47], s72 offen offset:2048 sc1 lds
v_mfma_f32_16x16x32_bf16 v[144:147], a[152:155], v[24:27], v[144:147]
v_exp_f32 v169, v169
v_mfma_f32_16x16x32_bf16 v[144:147], a[148:151], v[20:23], v[144:147]
ds_read_b128 a[228:231], v2 offset:9216
v_cvt_pk_bf16_f32 v216, v168, v169
v_mfma_f32_16x16x32_bf16 v[144:147], a[144:147], v[16:19], v[144:147]
s_waitcnt lgkmcnt(10)
v_exp_f32 v170, v170
v_mfma_f32_16x16x32_bf16 a[0:3], a[192:195], v[192:195], a[0:3]
v_exp_f32 v171, v171
v_mfma_f32_16x16x32_bf16 a[32:35], a[192:195], v[196:199], a[32:35]
ds_read_b128 a[232:235], v2 offset:10240
v_cvt_pk_bf16_f32 v217, v170, v171
v_mfma_f32_16x16x32_bf16 a[64:67], a[192:195], v[200:203], a[64:67]
v_exp_f32 v184, v184
v_mfma_f32_16x16x32_bf16 a[96:99], a[192:195], v[204:207], a[96:99]
v_exp_f32 v185, v185
v_mfma_f32_16x16x32_bf16 a[100:103], a[196:199], v[204:207], a[100:103]
ds_read_b128 a[236:239], v2 offset:11264
v_cvt_pk_bf16_f32 v218, v184, v185
v_mfma_f32_16x16x32_bf16 a[68:71], a[196:199], v[200:203], a[68:71]
v_exp_f32 v186, v186
v_mfma_f32_16x16x32_bf16 a[36:39], a[196:199], v[196:199], a[36:39]
buffer_load_dwordx4 v1, s[44:47], s72 offen offset:3072 sc1 lds
v_mfma_f32_16x16x32_bf16 a[4:7], a[196:199], v[192:195], a[4:7]
s_add_u32 s75, s75, 0x1000
v_exp_f32 v187, v187
v_mfma_f32_16x16x32_bf16 a[8:11], a[200:203], v[192:195], a[8:11]
s_and_b32 s76, s75, 0x3000
ds_read_b128 a[240:243], v2 offset:12288
v_cvt_pk_bf16_f32 v219, v186, v187
v_mfma_f32_16x16x32_bf16 a[40:43], a[200:203], v[196:199], a[40:43]
s_cselect_b32 s75, s75, 0x40001000
v_exp_f32 v172, v172
v_mfma_f32_16x16x32_bf16 a[72:75], a[200:203], v[200:203], a[72:75]
v_exp_f32 v173, v173
v_mfma_f32_16x16x32_bf16 a[104:107], a[200:203], v[204:207], a[104:107]
ds_read_b128 a[244:247], v2 offset:13312
v_cvt_pk_bf16_f32 v220, v172, v173
v_mfma_f32_16x16x32_bf16 a[108:111], a[204:207], v[204:207], a[108:111]
v_exp_f32 v174, v174
v_mfma_f32_16x16x32_bf16 a[76:79], a[204:207], v[200:203], a[76:79]
v_exp_f32 v175, v175
v_mfma_f32_16x16x32_bf16 a[44:47], a[204:207], v[196:199], a[44:47]
ds_read_b128 a[248:251], v2 offset:14336
v_cvt_pk_bf16_f32 v221, v174, v175
v_mfma_f32_16x16x32_bf16 a[12:15], a[204:207], v[192:195], a[12:15]
v_exp_f32 v188, v188
v_mfma_f32_16x16x32_bf16 a[16:19], a[208:211], v[192:195], a[16:19]
buffer_load_dword v4, v15, s[24:27], 0 offen
v_mfma_f32_16x16x32_bf16 a[48:51], a[208:211], v[196:199], a[48:51]
v_exp_f32 v189, v189
v_mfma_f32_16x16x32_bf16 a[80:83], a[208:211], v[200:203], a[80:83]
ds_read_b128 a[252:255], v2 offset:15360
v_cvt_pk_bf16_f32 v222, v188, v189
v_mfma_f32_16x16x32_bf16 a[112:115], a[208:211], v[204:207], a[112:115]
v_exp_f32 v190, v190
v_mfma_f32_16x16x32_bf16 a[116:119], a[212:215], v[204:207], a[116:119]
v_exp_f32 v191, v191
v_mfma_f32_16x16x32_bf16 a[84:87], a[212:215], v[200:203], a[84:87]
v_cvt_pk_bf16_f32 v223, v190, v191
v_add_u32 v2, s82, v1
v_mfma_f32_16x16x32_bf16 a[52:55], a[212:215], v[196:199], a[52:55]
v_mfma_f32_16x16x32_bf16 a[20:23], a[212:215], v[192:195], a[20:23]
v_mfma_f32_16x16x32_bf16 a[24:27], a[216:219], v[192:195], a[24:27]
v_mfma_f32_16x16x32_bf16 a[56:59], a[216:219], v[196:199], a[56:59]
v_mfma_f32_16x16x32_bf16 a[88:91], a[216:219], v[200:203], a[88:91]
v_mfma_f32_16x16x32_bf16 a[120:123], a[216:219], v[204:207], a[120:123]
v_mfma_f32_16x16x32_bf16 a[124:127], a[220:223], v[204:207], a[124:127]
v_mfma_f32_16x16x32_bf16 a[92:95], a[220:223], v[200:203], a[92:95]
v_mfma_f32_16x16x32_bf16 a[60:63], a[220:223], v[196:199], a[60:63]
v_mfma_f32_16x16x32_bf16 a[28:31], a[220:223], v[192:195], a[28:31]
v_mfma_f32_16x16x32_bf16 v[224:227], v[120:123], v[192:195], v[224:227]
s_waitcnt vmcnt(9) lgkmcnt(8)
v_mfma_f32_16x16x32_bf16 v[228:231], v[120:123], v[196:199], v[228:231]
s_barrier
v_mfma_f32_16x16x32_bf16 v[232:235], v[120:123], v[200:203], v[232:235]
s_add_u32 s83, s83, 1
v_mfma_f32_16x16x32_bf16 v[236:239], v[120:123], v[204:207], v[236:239]
s_cbranch_scc0 LloopI
LLT1:
v_mfma_f32_16x16x32_bf16 v[160:163], a[160:163], v[16:19], v[80:83]
s_xor_b32 s74, s82, 0x10000
v_exp_f32 v128, v128
v_mfma_f32_16x16x32_bf16 v[160:163], a[164:167], v[20:23], v[160:163]
s_add_u32 s74, s74, s64
ds_read_b128 a[128:131], v2 offset:16384
v_mfma_f32_16x16x32_bf16 v[160:163], a[168:171], v[24:27], v[160:163]
s_add_u32 s81, s81, 0x8000
v_exp_f32 v129, v129
v_mfma_f32_16x16x32_bf16 v[160:163], a[172:175], v[28:31], v[160:163]
s_add_u32 m0, s74, 16384
v_exp_f32 v130, v130
v_mfma_f32_16x16x32_bf16 v[164:167], a[172:175], v[44:47], v[84:87]
s_add_u32 s72, s81, 16384
ds_read_b128 a[132:135], v2 offset:17408
v_cvt_pk_bf16_f32 v192, v128, v129
v_mfma_f32_16x16x32_bf16 v[164:167], a[168:171], v[40:43], v[164:167]
v_exp_f32 v131, v131
v_mfma_f32_16x16x32_bf16 v[164:167], a[164:167], v[36:39], v[164:167]
v_exp_f32 v144, v144
v_mfma_f32_16x16x32_bf16 v[164:167], a[160:163], v[32:35], v[164:167]
ds_read_b128 a[136:139], v2 offset:18432
v_cvt_pk_bf16_f32 v193, v130, v131
v_mfma_f32_16x16x32_bf16 v[168:171], a[160:163], v[48:51], v[88:91]
buffer_load_dwordx4 v1, s[44:47], s72 offen sc1 lds
v_mfma_f32_16x16x32_bf16 v[168:171], a[164:167], v[52:55], v[168:171]
v_exp_f32 v145, v145
v_mfma_f32_16x16x32_bf16 v[168:171], a[168:171], v[56:59], v[168:171]
v_exp_f32 v146, v146
v_mfma_f32_16x16x32_bf16 v[168:171], a[172:175], v[60:63], v[168:171]
ds_read_b128 a[140:143], v2 offset:19456
v_cvt_pk_bf16_f32 v194, v144, v145
v_mfma_f32_16x16x32_bf16 v[172:175], a[172:175], v[76:79], v[92:95]
v_exp_f32 v147, v147
v_mfma_f32_16x16x32_bf16 v[172:175], a[168:171], v[72:75], v[172:175]
v_exp_f32 v132, v132
v_mfma_f32_16x16x32_bf16 v[172:175], a[164:167], v[68:71], v[172:175]
ds_read_b128 a[144:147], v2 offset:20480
v_cvt_pk_bf16_f32 v195, v146, v147
v_mfma_f32_16x16x32_bf16 v[172:175], a[160:163], v[64:67], v[172:175]
v_exp_f32 v133, v133
v_mfma_f32_16x16x32_bf16 v[188:191], a[176:179], v[64:67], v[92:95]
v_exp_f32 v134, v134
v_mfma_f32_16x16x32_bf16 v[188:191], a[180:183], v[68:71], v[188:191]
ds_read_b128 a[148:151], v2 offset:21504
v_cvt_pk_bf16_f32 v196, v132, v133
v_mfma_f32_16x16x32_bf16 v[188:191], a[184:187], v[72:75], v[188:191]
v_exp_f32 v135, v135
v_mfma_f32_16x16x32_bf16 v[188:191], a[188:191], v[76:79], v[188:191]
v_exp_f32 v148, v148
v_mfma_f32_16x16x32_bf16 v[184:187], a[188:191], v[60:63], v[88:91]
ds_read_b128 a[152:155], v2 offset:22528
v_cvt_pk_bf16_f32 v197, v134, v135
v_mfma_f32_16x16x32_bf16 v[184:187], a[184:187], v[56:59], v[184:187]
buffer_load_dwordx4 v1, s[44:47], s72 offen offset:1024 sc1 lds
v_mfma_f32_16x16x32_bf16 v[184:187], a[180:183], v[52:55], v[184:187]
v_exp_f32 v149, v149
v_mfma_f32_16x16x32_bf16 v[184:187], a[176:179], v[48:51], v[184:187]
v_exp_f32 v150, v150
v_mfma_f32_16x16x32_bf16 v[180:183], a[176:179], v[32:35], v[84:87]
ds_read_b128 a[156:159], v2 offset:23552
v_cvt_pk_bf16_f32 v198, v148, v149
v_mfma_f32_16x16x32_bf16 v[180:183], a[180:183], v[36:39], v[180:183]
v_exp_f32 v151, v151
v_mfma_f32_16x16x32_bf16 v[180:183], a[184:187], v[40:43], v[180:183]
v_exp_f32 v136, v136
v_mfma_f32_16x16x32_bf16 v[180:183], a[188:191], v[44:47], v[180:183]
ds_read_b128 a[192:195], v2 offset:0
v_cvt_pk_bf16_f32 v199, v150, v151
v_mfma_f32_16x16x32_bf16 v[176:179], a[188:191], v[28:31], v[80:83]
v_exp_f32 v137, v137
v_mfma_f32_16x16x32_bf16 v[176:179], a[184:187], v[24:27], v[176:179]
v_exp_f32 v138, v138
v_mfma_f32_16x16x32_bf16 v[176:179], a[180:183], v[20:23], v[176:179]
ds_read_b128 a[196:199], v2 offset:1024
v_cvt_pk_bf16_f32 v200, v136, v137
v_mfma_f32_16x16x32_bf16 v[176:179], a[176:179], v[16:19], v[176:179]
s_waitcnt lgkmcnt(10)
v_exp_f32 v139, v139
v_mfma_f32_16x16x32_bf16 a[0:3], a[224:227], v[208:211], a[0:3]
v_exp_f32 v152, v152
v_mfma_f32_16x16x32_bf16 a[32:35], a[224:227], v[212:215], a[32:35]
ds_read_b128 a[200:203], v2 offset:2048
v_cvt_pk_bf16_f32 v201, v138, v139
v_mfma_f32_16x16x32_bf16 a[64:67], a[224:227], v[216:219], a[64:67]
buffer_load_dwordx4 v1, s[44:47], s72 offen offset:2048 sc1 lds
v_mfma_f32_16x16x32_bf16 a[96:99], a[224:227], v[220:223], a[96:99]
v_exp_f32 v153, v153
v_mfma_f32_16x16x32_bf16 a[100:103], a[228:231], v[220:223], a[100:103]
v_exp_f32 v154, v154
v_mfma_f32_16x16x32_bf16 a[68:71], a[228:231], v[216:219], a[68:71]
ds_read_b128 a[204:207], v2 offset:3072
v_cvt_pk_bf16_f32 v202, v152, v153
v_mfma_f32_16x16x32_bf16 a[36:39], a[228:231], v[212:215], a[36:39]
v_exp_f32 v155, v155
v_mfma_f32_16x16x32_bf16 a[4:7], a[228:231], v[208:211], a[4:7]
v_exp_f32 v140, v140
v_mfma_f32_16x16x32_bf16 a[8:11], a[232:235], v[208:211], a[8:11]
ds_read_b128 a[208:211], v2 offset:4096
v_cvt_pk_bf16_f32 v203, v154, v155
v_mfma_f32_16x16x32_bf16 a[40:43], a[232:235], v[212:215], a[40:43]
v_exp_f32 v141, v141
v_mfma_f32_16x16x32_bf16 a[72:75], a[232:235], v[216:219], a[72:75]
v_exp_f32 v142, v142
v_mfma_f32_16x16x32_bf16 a[104:107], a[232:235], v[220:223], a[104:107]
ds_read_b128 a[212:215], v2 offset:5120
v_cvt_pk_bf16_f32 v204, v140, v141
v_mfma_f32_16x16x32_bf16 a[108:111], a[236:239], v[220:223], a[108:111]
v_exp_f32 v143, v143
v_mfma_f32_16x16x32_bf16 a[76:79], a[236:239], v[216:219], a[76:79]
v_exp_f32 v156, v156
v_mfma_f32_16x16x32_bf16 a[44:47], a[236:239], v[212:215], a[44:47]
ds_read_b128 a[216:219], v2 offset:6144
v_cvt_pk_bf16_f32 v205, v142, v143
v_mfma_f32_16x16x32_bf16 a[12:15], a[236:239], v[208:211], a[12:15]
buffer_load_dwordx4 v1, s[44:47], s72 offen offset:3072 sc1 lds
v_mfma_f32_16x16x32_bf16 a[16:19], a[240:243], v[208:211], a[16:19]
v_exp_f32 v157, v157
v_mfma_f32_16x16x32_bf16 a[48:51], a[240:243], v[212:215], a[48:51]
v_exp_f32 v158, v158
v_mfma_f32_16x16x32_bf16 a[80:83], a[240:243], v[216:219], a[80:83]
ds_read_b128 a[220:223], v2 offset:7168
v_cvt_pk_bf16_f32 v206, v156, v157
v_mfma_f32_16x16x32_bf16 a[112:115], a[240:243], v[220:223], a[112:115]
v_exp_f32 v159, v159
v_mfma_f32_16x16x32_bf16 a[116:119], a[244:247], v[220:223], a[116:119]
v_cvt_pk_bf16_f32 v207, v158, v159
v_mfma_f32_16x16x32_bf16 a[84:87], a[244:247], v[216:219], a[84:87]
v_mfma_f32_16x16x32_bf16 a[52:55], a[244:247], v[212:215], a[52:55]
v_mfma_f32_16x16x32_bf16 a[20:23], a[244:247], v[208:211], a[20:23]
v_mfma_f32_16x16x32_bf16 a[24:27], a[248:251], v[208:211], a[24:27]
v_mfma_f32_16x16x32_bf16 a[56:59], a[248:251], v[212:215], a[56:59]
v_mfma_f32_16x16x32_bf16 a[88:91], a[248:251], v[216:219], a[88:91]
v_mfma_f32_16x16x32_bf16 a[120:123], a[248:251], v[220:223], a[120:123]
v_mfma_f32_16x16x32_bf16 a[124:127], a[252:255], v[220:223], a[124:127]
v_mfma_f32_16x16x32_bf16 a[92:95], a[252:255], v[216:219], a[92:95]
v_mfma_f32_16x16x32_bf16 a[60:63], a[252:255], v[212:215], a[60:63]
v_mfma_f32_16x16x32_bf16 a[28:31], a[252:255], v[208:211], a[28:31]
v_mfma_f32_16x16x32_bf16 v[224:227], v[120:123], v[208:211], v[224:227]
v_mfma_f32_16x16x32_bf16 v[228:231], v[120:123], v[212:215], v[228:231]
v_mfma_f32_16x16x32_bf16 v[232:235], v[120:123], v[216:219], v[232:235]
v_mfma_f32_16x16x32_bf16 v[236:239], v[120:123], v[220:223], v[236:239]
s_waitcnt lgkmcnt(8)
s_cmp_eq_u32 s58, 0
s_cbranch_scc1 Ltri16
v_mfma_f32_16x16x32_bf16 v[128:131], a[128:131], v[16:19], v[80:83]
s_add_u32 s82, s82, 0x8000
ds_read_b128 a[160:163], v2 offset:24576
v_mfma_f32_16x16x32_bf16 v[132:135], a[128:131], v[32:35], v[84:87]
s_and_b32 s82, s82, 0x1ffff
v_exp_f32 v160, v160
v_mfma_f32_16x16x32_bf16 v[144:147], a[144:147], v[16:19], v[80:83]
s_add_u32 m0, s74, 0
v_exp_f32 v161, v161
v_mfma_f32_16x16x32_bf16 v[148:151], a[144:147], v[32:35], v[84:87]
s_add_u32 s72, s81, 0
ds_read_b128 a[164:167], v2 offset:25600
v_cvt_pk_bf16_f32 v208, v160, v161
s_branch Ljoin17
Ltri16:
v_mfma_f32_16x16x32_bf16 v[128:131], a[128:131], v[16:19], v[96:99]
s_add_u32 s82, s82, 0x8000
ds_read_b128 a[160:163], v2 offset:24576
v_mfma_f32_16x16x32_bf16 v[132:135], a[128:131], v[32:35], v[84:87]
s_and_b32 s82, s82, 0x1ffff
v_exp_f32 v160, v160
v_mfma_f32_16x16x32_bf16 v[144:147], a[144:147], v[16:19], v[112:115]
s_add_u32 m0, s74, 0
v_exp_f32 v161, v161
v_mfma_f32_16x16x32_bf16 v[148:151], a[144:147], v[32:35], v[100:103]
s_add_u32 s72, s81, 0
ds_read_b128 a[164:167], v2 offset:25600
v_cvt_pk_bf16_f32 v208, v160, v161
Ljoin17:
v_mfma_f32_16x16x32_bf16 v[128:131], a[132:135], v[20:23], v[128:131]
v_exp_f32 v162, v162
v_mfma_f32_16x16x32_bf16 v[128:131], a[136:139], v[24:27], v[128:131]
v_exp_f32 v163, v163
v_mfma_f32_16x16x32_bf16 v[128:131], a[140:143], v[28:31], v[128:131]
ds_read_b128 a[168:171], v2 offset:26624
v_cvt_pk_bf16_f32 v209, v162, v163
v_mfma_f32_16x16x32_bf16 v[132:135], a[140:143], v[44:47], v[132:135]
v_exp_f32 v176, v176
v_mfma_f32_16x16x32_bf16 v[132:135], a[136:139], v[40:43], v[132:135]
buffer_load_dwordx4 v1, s[44:47], s72 offen sc1 lds
v_mfma_f32_16x16x32_bf16 v[132:135], a[132:135], v[36:39], v[132:135]
v_exp_f32 v177, v177
v_mfma_f32_16x16x32_bf16 v[136:139], a[128:131], v[48:51], v[88:91]
ds_read_b128 a[172:175], v2 offset:27648
v_cvt_pk_bf16_f32 v210, v176, v177
v_mfma_f32_16x16x32_bf16 v[136:139], a[132:135], v[52:55], v[136:139]
v_exp_f32 v178, v178
v_mfma_f32_16x16x32_bf16 v[136:139], a[136:139], v[56:59], v[136:139]
v_exp_f32 v179, v179
v_mfma_f32_16x16x32_bf16 v[136:139], a[140:143], v[60:63], v[136:139]
ds_read_b128 a[176:179], v2 offset:28672
v_cvt_pk_bf16_f32 v211, v178, v179
v_mfma_f32_16x16x32_bf16 v[140:143], a[140:143], v[76:79], v[92:95]
v_exp_f32 v164, v164
v_mfma_f32_16x16x32_bf16 v[140:143], a[136:139], v[72:75], v[140:143]
v_exp_f32 v165, v165
v_mfma_f32_16x16x32_bf16 v[140:143], a[132:135], v[68:71], v[140:143]
ds_read_b128 a[180:183], v2 offset:29696
v_cvt_pk_bf16_f32 v212, v164, v165
v_mfma_f32_16x16x32_bf16 v[140:143], a[128:131], v[64:67], v[140:143]
v_exp_f32 v166, v166
v_mfma_f32_16x16x32_bf16 v[156:159], a[144:147], v[64:67], v[92:95]
v_exp_f32 v167, v167
v_mfma_f32_16x16x32_bf16 v[156:159], a[148:151], v[68:71], v[156:159]
ds_read_b128 a[184:187], v2 offset:30720
v_cvt_pk_bf16_f32 v213, v166, v167
v_mfma_f32_16x16x32_bf16 v[156:159], a[152:155], v[72:75], v[156:159]
v_exp_f32 v180, v180
v_mfma_f32_16x16x32_bf16 v[156:159], a[156:159], v[76:79], v[156:159]
buffer_load_dwordx4 v1, s[44:47], s72 offen offset:1024 sc1 lds
v_mfma_f32_16x16x32_bf16 v[152:155], a[156:159], v[60:63], v[88:91]
v_exp_f32 v181, v181
v_mfma_f32_16x16x32_bf16 v[152:155], a[152:155], v[56:59], v[152:155]
ds_read_b128 a[188:191], v2 offset:31744
v_cvt_pk_bf16_f32 v214, v180, v181
v_mfma_f32_16x16x32_bf16 v[152:155], a[148:151], v[52:55], v[152:155]
v_exp_f32 v182, v182
v_mfma_f32_16x16x32_bf16 v[152:155], a[144:147], v[48:51], v[152:155]
v_exp_f32 v183, v183
v_mfma_f32_16x16x32_bf16 v[148:151], a[148:151], v[36:39], v[148:151]
ds_read_b128 a[224:227], v2 offset:8192
v_cvt_pk_bf16_f32 v215, v182, v183
v_mfma_f32_16x16x32_bf16 v[148:151], a[152:155], v[40:43], v[148:151]
v_exp_f32 v168, v168
v_mfma_f32_16x16x32_bf16 v[148:151], a[156:159], v[44:47], v[148:151]
v_exp_f32 v169, v169
v_mfma_f32_16x16x32_bf16 v[144:147], a[156:159], v[28:31], v[144:147]
ds_read_b128 a[228:231], v2 offset:9216
v_cvt_pk_bf16_f32 v216, v168, v169
v_mfma_f32_16x16x32_bf16 v[144:147], a[152:155], v[24:27], v[144:147]
v_exp_f32 v170, v170
v_mfma_f32_16x16x32_bf16 v[144:147], a[148:151], v[20:23], v[144:147]
s_waitcnt lgkmcnt(10)
v_exp_f32 v171, v171
v_mfma_f32_16x16x32_bf16 a[0:3], a[192:195], v[192:195], a[0:3]
ds_read_b128 a[232:235], v2 offset:10240
v_cvt_pk_bf16_f32 v217, v170, v171
v_mfma_f32_16x16x32_bf16 a[32:35], a[192:195], v[196:199], a[32:35]
v_exp_f32 v184, v184
v_mfma_f32_16x16x32_bf16 a[64:67], a[192:195], v[200:203], a[64:67]
buffer_load_dwordx4 v1, s[44:47], s72 offen offset:2048 sc1 lds
v_mfma_f32_16x16x32_bf16 a[96:99], a[192:195], v[204:207], a[96:99]
v_exp_f32 v185, v185
v_mfma_f32_16x16x32_bf16 a[100:103], a[196:199], v[204:207], a[100:103]
ds_read_b128 a[236:239], v2 offset:11264
v_cvt_pk_bf16_f32 v218, v184, v185
v_mfma_f32_16x16x32_bf16 a[68:71], a[196:199], v[200:203], a[68:71]
v_exp_f32 v186, v186
v_mfma_f32_16x16x32_bf16 a[36:39], a[196:199], v[196:199], a[36:39]
v_exp_f32 v187, v187
v_mfma_f32_16x16x32_bf16 a[4:7], a[196:199], v[192:195], a[4:7]
ds_read_b128 a[240:243], v2 offset:12288
v_cvt_pk_bf16_f32 v219, v186, v187
v_mfma_f32_16x16x32_bf16 a[8:11], a[200:203], v[192:195], a[8:11]
v_exp_f32 v172, v172
v_mfma_f32_16x16x32_bf16 a[40:43], a[200:203], v[196:199], a[40:43]
v_exp_f32 v173, v173
v_mfma_f32_16x16x32_bf16 a[72:75], a[200:203], v[200:203], a[72:75]
ds_read_b128 a[244:247], v2 offset:13312
v_cvt_pk_bf16_f32 v220, v172, v173
v_mfma_f32_16x16x32_bf16 a[104:107], a[200:203], v[204:207], a[104:107]
v_exp_f32 v174, v174
v_mfma_f32_16x16x32_bf16 a[108:111], a[204:207], v[204:207], a[108:111]
v_exp_f32 v175, v175
v_mfma_f32_16x16x32_bf16 a[76:79], a[204:207], v[200:203], a[76:79]
ds_read_b128 a[248:251], v2 offset:14336
v_cvt_pk_bf16_f32 v221, v174, v175
v_mfma_f32_16x16x32_bf16 a[44:47], a[204:207], v[196:199], a[44:47]
v_exp_f32 v188, v188
v_mfma_f32_16x16x32_bf16 a[12:15], a[204:207], v[192:195], a[12:15]
buffer_load_dwordx4 v1, s[44:47], s72 offen offset:3072 sc1 lds
v_mfma_f32_16x16x32_bf16 a[16:19], a[208:211], v[192:195], a[16:19]
v_exp_f32 v189, v189
v_mfma_f32_16x16x32_bf16 a[48:51], a[208:211], v[196:199], a[48:51]
ds_read_b128 a[252:255], v2 offset:15360
v_cvt_pk_bf16_f32 v222, v188, v189
v_mfma_f32_16x16x32_bf16 a[80:83], a[208:211], v[200:203], a[80:83]
v_exp_f32 v190, v190
v_mfma_f32_16x16x32_bf16 a[112:115], a[208:211], v[204:207], a[112:115]
v_exp_f32 v191, v191
v_mfma_f32_16x16x32_bf16 a[116:119], a[212:215], v[204:207], a[116:119]
v_cvt_pk_bf16_f32 v223, v190, v191
v_add_u32 v2, s82, v1
v_mfma_f32_16x16x32_bf16 a[84:87], a[212:215], v[200:203], a[84:87]
v_mfma_f32_16x16x32_bf16 a[52:55], a[212:215], v[196:199], a[52:55]
v_mfma_f32_16x16x32_bf16 a[20:23], a[212:215], v[192:195], a[20:23]
v_mfma_f32_16x16x32_bf16 a[24:27], a[216:219], v[192:195], a[24:27]
v_mfma_f32_16x16x32_bf16 a[56:59], a[216:219], v[196:199], a[56:59]
v_mfma_f32_16x16x32_bf16 a[88:91], a[216:219], v[200:203], a[88:91]
v_mfma_f32_16x16x32_bf16 a[120:123], a[216:219], v[204:207], a[120:123]
v_mfma_f32_16x16x32_bf16 a[124:127], a[220:223], v[204:207], a[124:127]
v_mfma_f32_16x16x32_bf16 a[92:95], a[220:223], v[200:203], a[92:95]
v_mfma_f32_16x16x32_bf16 a[60:63], a[220:223], v[196:199], a[60:63]
v_mfma_f32_16x16x32_bf16 a[28:31], a[220:223], v[192:195], a[28:31]
v_mfma_f32_16x16x32_bf16 v[224:227], v[120:123], v[192:195], v[224:227]
v_mfma_f32_16x16x32_bf16 v[228:231], v[120:123], v[196:199], v[228:231]
v_mfma_f32_16x16x32_bf16 v[232:235], v[120:123], v[200:203], v[232:235]
s_waitcnt vmcnt(8) lgkmcnt(8)
v_mfma_f32_16x16x32_bf16 v[236:239], v[120:123], v[204:207], v[236:239]
s_barrier
s_cmp_eq_u32 s58, 1
s_cbranch_scc1 Ltri19
s_cmp_gt_u32 s58, 1
s_cbranch_scc1 Lalt18
v_mfma_f32_16x16x32_bf16 v[160:163], a[160:163], v[16:19], v[112:115]
s_xor_b32 s74, s82, 0x10000
v_exp_f32 v128, v128
v_mfma_f32_16x16x32_bf16 v[164:167], a[160:163], v[32:35], v[112:115]
s_add_u32 s74, s74, s64
ds_read_b128 a[128:131], v2 offset:16384
v_mfma_f32_16x16x32_bf16 v[176:179], a[176:179], v[16:19], v[112:115]
s_add_u32 s81, s81, 0x8000
v_exp_f32 v129, v129
v_mfma_f32_16x16x32_bf16 v[180:183], a[176:179], v[32:35], v[112:115]
s_add_u32 m0, s74, 16384
v_exp_f32 v130, v130
s_branch Ljoin20
Lalt18:
v_mfma_f32_16x16x32_bf16 v[160:163], a[160:163], v[16:19], v[80:83]
s_xor_b32 s74, s82, 0x10000
v_exp_f32 v128, v128
v_mfma_f32_16x16x32_bf16 v[164:167], a[160:163], v[32:35], v[84:87]
s_add_u32 s74, s74, s64
ds_read_b128 a[128:131], v2 offset:16384
v_mfma_f32_16x16x32_bf16 v[176:179], a[176:179], v[16:19], v[80:83]
s_add_u32 s81, s81, 0x8000
v_exp_f32 v129, v129
v_mfma_f32_16x16x32_bf16 v[180:183], a[176:179], v[32:35], v[84:87]
s_add_u32 m0, s74, 16384
v_exp_f32 v130, v130
s_branch Ljoin20
Ltri19:
v_mfma_f32_16x16x32_bf16 v[160:163], a[160:163], v[16:19], v[96:99]
s_xor_b32 s74, s82, 0x10000
v_exp_f32 v128, v128
v_mfma_f32_16x16x32_bf16 v[164:167], a[160:163], v[32:35], v[84:87]
s_add_u32 s74, s74, s64
ds_read_b128 a[128:131], v2 offset:16384
v_mfma_f32_16x16x32_bf16 v[176:179], a[176:179], v[16:19], v[112:115]
s_add_u32 s81, s81, 0x8000
v_exp_f32 v129, v129
v_mfma_f32_16x16x32_bf16 v[180:183], a[176:179], v[32:35], v[100:103]
s_add_u32 m0, s74, 16384
v_exp_f32 v130, v130
Ljoin20:
v_mfma_f32_16x16x32_bf16 v[160:163], a[164:167], v[20:23], v[160:163]
s_add_u32 s72, s81, 16384
ds_read_b128 a[132:135], v2 offset:17408
v_cvt_pk_bf16_f32 v192, v128, v129
v_mfma_f32_16x16x32_bf16 v[160:163], a[168:171], v[24:27], v[160:163]
v_exp_f32 v131, v131
v_mfma_f32_16x16x32_bf16 v[160:163], a[172:175], v[28:31], v[160:163]
v_exp_f32 v144, v144
v_mfma_f32_16x16x32_bf16 v[164:167], a[172:175], v[44:47], v[164:167]
ds_read_b128 a[136:139], v2 offset:18432
v_cvt_pk_bf16_f32 v193, v130, v131
v_mfma_f32_16x16x32_bf16 v[164:167], a[168:171], v[40:43], v[164:167]
buffer_load_dwordx4 v1, s[44:47], s72 offen sc1 lds
v_mfma_f32_16x16x32_bf16 v[164:167], a[164:167], v[36:39], v[164:167]
v_exp_f32 v145, v145
v_mfma_f32_16x16x32_bf16 v[168:171], a[160:163], v[48:51], v[88:91]
v_exp_f32 v146, v146
v_mfma_f32_16x16x32_bf16 v[168:171], a[164:167], v[52:55], v[168:171]
ds_read_b128 a[140:143], v2 offset:19456
v_cvt_pk_bf16_f32 v194, v144, v145
v_mfma_f32_16x16x32_bf16 v[168:171], a[168:171], v[56:59], v[168:171]
v_exp_f32 v147, v147
v_mfma_f32_16x16x32_bf16 v[168:171], a[172:175], v[60:63], v[168:171]
v_exp_f32 v132, v132
v_mfma_f32_16x16x32_bf16 v[172:175], a[172:175], v[76:79], v[92:95]
ds_read_b128 a[144:147], v2 offset:20480
v_cvt_pk_bf16_f32 v195, v146, v147
v_mfma_f32_16x16x32_bf16 v[172:175], a[168:171], v[72:75], v[172:175]
v_exp_f32 v133, v133
v_mfma_f32_16x16x32_bf16 v[172:175], a[164:167], v[68:71], v[172:175]
v_exp_f32 v134, v134
v_mfma_f32_16x16x32_bf16 v[172:175], a[160:163], v[64:67], v[172:175]
ds_read_b128 a[148:151], v2 offset:21504
v_cvt_pk_bf16_f32 v196, v132, v133
v_mfma_f32_16x16x32_bf16 v[188:191], a[176:179], v[64:67], v[92:95]
v_exp_f32 v135, v135
v_mfma_f32_16x16x32_bf16 v[188:191], a[180:183], v[68:71], v[188:191]
v_exp_f32 v148, v148
v_mfma_f32_16x16x32_bf16 v[188:191], a[184:187], v[72:75], v[188:191]
ds_read_b128 a[152:155], v2 offset:22528
v_cvt_pk_bf16_f32 v197, v134, v135
v_mfma_f32_16x16x32_bf16 v[188:191], a[188:191], v[76:79], v[188:191]
buffer_load_dwordx4 v1, s[44:47], s72 offen offset:1024 sc1 lds
v_mfma_f32_16x16x32_bf16 v[184:187], a[188:191], v[60:63], v[88:91]
v_exp_f32 v149, v149
v_mfma_f32_16x16x32_bf16 v[184:187], a[184:187], v[56:59], v[184:187]
v_exp_f32 v150, v150
v_mfma_f32_16x16x32_bf16 v[184:187], a[180:183], v[52:55], v[184:187]
ds_read_b128 a[156:159], v2 offset:23552
v_cvt_pk_bf16_f32 v198, v148, v149
v_mfma_f32_16x16x32_bf16 v[184:187], a[176:179], v[48:51], v[184:187]
v_exp_f32 v151, v151
v_mfma_f32_16x16x32_bf16 v[180:183], a[180:183], v[36:39], v[180:183]
v_exp_f32 v136, v136
v_mfma_f32_16x16x32_bf16 v[180:183], a[184:187], v[40:43], v[180:183]
ds_read_b128 a[192:195], v2 offset:0
v_cvt_pk_bf16_f32 v199, v150, v151
v_mfma_f32_16x16x32_bf16 v[180:183], a[188:191], v[44:47], v[180:183]
v_exp_f32 v137, v137
v_mfma_f32_16x16x32_bf16 v[176:179], a[188:191], v[28:31], v[176:179]
v_exp_f32 v138, v138
v_mfma_f32_16x16x32_bf16 v[176:179], a[184:187], v[24:27], v[176:179]
ds_read_b128 a[196:199], v2 offset:1024
v_cvt_pk_bf16_f32 v200, v136, v137
v_mfma_f32_16x16x32_bf16 v[176:179], a[180:183], v[20:23], v[176:179]
s_waitcnt lgkmcnt(10)
v_exp_f32 v139, v139
v_mfma_f32_16x16x32_bf16 a[0:3], a[224:227], v[208:211], a[0:3]
v_exp_f32 v152, v152
v_mfma_f32_16x16x32_bf16 a[32:35], a[224:227], v[212:215], a[32:35]
ds_read_b128 a[200:203], v2 offset:2048
v_cvt_pk_bf16_f32 v201, v138, v139
v_mfma_f32_16x16x32_bf16 a[64:67], a[224:227], v[216:219], a[64:67]
buffer_load_dwordx4 v1, s[44:47], s72 offen offset:2048 sc1 lds
v_mfma_f32_16x16x32_bf16 a[96:99], a[224:227], v[220:223], a[96:99]
v_exp_f32 v153, v153
v_mfma_f32_16x16x32_bf16 a[100:103], a[228:231], v[220:223], a[100:103]
v_exp_f32 v154, v154
v_mfma_f32_16x16x32_bf16 a[68:71], a[228:231], v[216:219], a[68:71]
ds_read_b128 a[204:207], v2 offset:3072
v_cvt_pk_bf16_f32 v202, v152, v153
v_mfma_f32_16x16x32_bf16 a[36:39], a[228:231], v[212:215], a[36:39]
v_exp_f32 v155, v155
v_mfma_f32_16x16x32_bf16 a[4:7], a[228:231], v[208:211], a[4:7]
v_exp_f32 v140, v140
v_mfma_f32_16x16x32_bf16 a[8:11], a[232:235], v[208:211], a[8:11]
ds_read_b128 a[208:211], v2 offset:4096
v_cvt_pk_bf16_f32 v203, v154, v155
v_mfma_f32_16x16x32_bf16 a[40:43], a[232:235], v[212:215], a[40:43]
v_exp_f32 v141, v141
v_mfma_f32_16x16x32_bf16 a[72:75], a[232:235], v[216:219], a[72:75]
v_exp_f32 v142, v142
v_mfma_f32_16x16x32_bf16 a[104:107], a[232:235], v[220:223], a[104:107]
ds_read_b128 a[212:215], v2 offset:5120
v_cvt_pk_bf16_f32 v204, v140, v141
v_mfma_f32_16x16x32_bf16 a[108:111], a[236:239], v[220:223], a[108:111]
v_exp_f32 v143, v143
v_mfma_f32_16x16x32_bf16 a[76:79], a[236:239], v[216:219], a[76:79]
v_exp_f32 v156, v156
v_mfma_f32_16x16x32_bf16 a[44:47], a[236:239], v[212:215], a[44:47]
ds_read_b128 a[216:219], v2 offset:6144
v_cvt_pk_bf16_f32 v205, v142, v143
v_mfma_f32_16x16x32_bf16 a[12:15], a[236:239], v[208:211], a[12:15]
buffer_load_dwordx4 v1, s[44:47], s72 offen offset:3072 sc1 lds
v_mfma_f32_16x16x32_bf16 a[16:19], a[240:243], v[208:211], a[16:19]
v_exp_f32 v157, v157
v_mfma_f32_16x16x32_bf16 a[48:51], a[240:243], v[212:215], a[48:51]
v_exp_f32 v158, v158
v_mfma_f32_16x16x32_bf16 a[80:83], a[240:243], v[216:219], a[80:83]
ds_read_b128 a[220:223], v2 offset:7168
v_cvt_pk_bf16_f32 v206, v156, v157
v_mfma_f32_16x16x32_bf16 a[112:115], a[240:243], v[220:223], a[112:115]
v_exp_f32 v159, v159
v_mfma_f32_16x16x32_bf16 a[116:119], a[244:247], v[220:223], a[116:119]
v_cvt_pk_bf16_f32 v207, v158, v159
v_mfma_f32_16x16x32_bf16 a[84:87], a[244:247], v[216:219], a[84:87]
v_mfma_f32_16x16x32_bf16 a[52:55], a[244:247], v[212:215], a[52:55]
v_mfma_f32_16x16x32_bf16 a[20:23], a[244:247], v[208:211], a[20:23]
v_mfma_f32_16x16x32_bf16 a[24:27], a[248:251], v[208:211], a[24:27]
v_mfma_f32_16x16x32_bf16 a[56:59], a[248:251], v[212:215], a[56:59]
v_mfma_f32_16x16x32_bf16 a[88:91], a[248:251], v[216:219], a[88:91]
v_mfma_f32_16x16x32_bf16 a[120:123], a[248:251], v[220:223], a[120:123]
v_mfma_f32_16x16x32_bf16 a[124:127], a[252:255], v[220:223], a[124:127]
v_mfma_f32_16x16x32_bf16 a[92:95], a[252:255], v[216:219], a[92:95]
v_mfma_f32_16x16x32_bf16 a[60:63], a[252:255], v[212:215], a[60:63]
v_mfma_f32_16x16x32_bf16 a[28:31], a[252:255], v[208:211], a[28:31]
v_mfma_f32_16x16x32_bf16 v[224:227], v[120:123], v[208:211], v[224:227]
v_mfma_f32_16x16x32_bf16 v[228:231], v[120:123], v[212:215], v[228:231]
v_mfma_f32_16x16x32_bf16 v[232:235], v[120:123], v[216:219], v[232:235]
v_mfma_f32_16x16x32_bf16 v[236:239], v[120:123], v[220:223], v[236:239]
s_waitcnt lgkmcnt(8)
s_cmp_eq_u32 s58, 2
s_cbranch_scc1 Ltri22
s_cmp_gt_u32 s58, 2
s_cbranch_scc1 Lalt21
v_mfma_f32_16x16x32_bf16 v[128:131], a[128:131], v[16:19], v[112:115]
s_add_u32 s82, s82, 0x8000
ds_read_b128 a[160:163], v2 offset:24576
v_mfma_f32_16x16x32_bf16 v[132:135], a[128:131], v[32:35], v[112:115]
s_and_b32 s82, s82, 0x1ffff
v_exp_f32 v160, v160
v_mfma_f32_16x16x32_bf16 v[144:147], a[144:147], v[16:19], v[112:115]
s_add_u32 m0, s74, 0
v_exp_f32 v161, v161
v_mfma_f32_16x16x32_bf16 v[148:151], a[144:147], v[32:35], v[112:115]
s_add_u32 s72, s81, 0
ds_read_b128 a[164:167], v2 offset:25600
v_cvt_pk_bf16_f32 v208, v160, v161
s_branch Ljoin23
Lalt21:
v_mfma_f32_16x16x32_bf16 v[128:131], a[128:131], v[16:19], v[80:83]
s_add_u32 s82, s82, 0x8000
ds_read_b128 a[160:163], v2 offset:24576
v_mfma_f32_16x16x32_bf16 v[132:135], a[128:131], v[32:35], v[84:87]
s_and_b32 s82, s82, 0x1ffff
v_exp_f32 v160, v160
v_mfma_f32_16x16x32_bf16 v[144:147], a[144:147], v[16:19], v[80:83]
s_add_u32 m0, s74, 0
v_exp_f32 v161, v161
v_mfma_f32_16x16x32_bf16 v[148:151], a[144:147], v[32:35], v[84:87]
s_add_u32 s72, s81, 0
ds_read_b128 a[164:167], v2 offset:25600
v_cvt_pk_bf16_f32 v208, v160, v161
s_branch Ljoin23
Ltri22:
v_mfma_f32_16x16x32_bf16 v[128:131], a[128:131], v[16:19], v[96:99]
s_add_u32 s82, s82, 0x8000
ds_read_b128 a[160:163], v2 offset:24576
v_mfma_f32_16x16x32_bf16 v[132:135], a[128:131], v[32:35], v[84:87]
s_and_b32 s82, s82, 0x1ffff
v_exp_f32 v160, v160
v_mfma_f32_16x16x32_bf16 v[144:147], a[144:147], v[16:19], v[112:115]
s_add_u32 m0, s74, 0
v_exp_f32 v161, v161
v_mfma_f32_16x16x32_bf16 v[148:151], a[144:147], v[32:35], v[100:103]
s_add_u32 s72, s81, 0
ds_read_b128 a[164:167], v2 offset:25600
v_cvt_pk_bf16_f32 v208, v160, v161
Ljoin23:
v_mfma_f32_16x16x32_bf16 v[128:131], a[132:135], v[20:23], v[128:131]
v_exp_f32 v162, v162
v_mfma_f32_16x16x32_bf16 v[128:131], a[136:139], v[24:27], v[128:131]
v_exp_f32 v163, v163
v_mfma_f32_16x16x32_bf16 v[128:131], a[140:143], v[28:31], v[128:131]
ds_read_b128 a[168:171], v2 offset:26624
v_cvt_pk_bf16_f32 v209, v162, v163
v_mfma_f32_16x16x32_bf16 v[132:135], a[140:143], v[44:47], v[132:135]
v_exp_f32 v176, v176
v_mfma_f32_16x16x32_bf16 v[132:135], a[136:139], v[40:43], v[132:135]
buffer_load_dwordx4 v1, s[44:47], s72 offen sc1 lds
v_mfma_f32_16x16x32_bf16 v[132:135], a[132:135], v[36:39], v[132:135]
v_exp_f32 v177, v177
v_mfma_f32_16x16x32_bf16 v[136:139], a[128:131], v[48:51], v[88:91]
ds_read_b128 a[172:175], v2 offset:27648
v_cvt_pk_bf16_f32 v210, v176, v177
v_mfma_f32_16x16x32_bf16 v[136:139], a[132:135], v[52:55], v[136:139]
v_exp_f32 v178, v178
v_mfma_f32_16x16x32_bf16 v[136:139], a[136:139], v[56:59], v[136:139]
v_exp_f32 v179, v179
v_mfma_f32_16x16x32_bf16 v[136:139], a[140:143], v[60:63], v[136:139]
ds_read_b128 a[176:179], v2 offset:28672
v_cvt_pk_bf16_f32 v211, v178, v179
v_mfma_f32_16x16x32_bf16 v[140:143], a[140:143], v[76:79], v[92:95]
v_exp_f32 v164, v164
v_mfma_f32_16x16x32_bf16 v[140:143], a[136:139], v[72:75], v[140:143]
v_exp_f32 v165, v165
v_mfma_f32_16x16x32_bf16 v[140:143], a[132:135], v[68:71], v[140:143]
ds_read_b128 a[180:183], v2 offset:29696
v_cvt_pk_bf16_f32 v212, v164, v165
v_mfma_f32_16x16x32_bf16 v[140:143], a[128:131], v[64:67], v[140:143]
v_exp_f32 v166, v166
v_mfma_f32_16x16x32_bf16 v[156:159], a[144:147], v[64:67], v[92:95]
v_exp_f32 v167, v167
v_mfma_f32_16x16x32_bf16 v[156:159], a[148:151], v[68:71], v[156:159]
ds_read_b128 a[184:187], v2 offset:30720
v_cvt_pk_bf16_f32 v213, v166, v167
v_mfma_f32_16x16x32_bf16 v[156:159], a[152:155], v[72:75], v[156:159]
v_exp_f32 v180, v180
v_mfma_f32_16x16x32_bf16 v[156:159], a[156:159], v[76:79], v[156:159]
buffer_load_dwordx4 v1, s[44:47], s72 offen offset:1024 sc1 lds
v_mfma_f32_16x16x32_bf16 v[152:155], a[156:159], v[60:63], v[88:91]
v_exp_f32 v181, v181
v_mfma_f32_16x16x32_bf16 v[152:155], a[152:155], v[56:59], v[152:155]
ds_read_b128 a[188:191], v2 offset:31744
v_cvt_pk_bf16_f32 v214, v180, v181
v_mfma_f32_16x16x32_bf16 v[152:155], a[148:151], v[52:55], v[152:155]
v_exp_f32 v182, v182
v_mfma_f32_16x16x32_bf16 v[152:155], a[144:147], v[48:51], v[152:155]
v_exp_f32 v183, v183
v_mfma_f32_16x16x32_bf16 v[148:151], a[148:151], v[36:39], v[148:151]
ds_read_b128 a[224:227], v2 offset:8192
v_cvt_pk_bf16_f32 v215, v182, v183
v_mfma_f32_16x16x32_bf16 v[148:151], a[152:155], v[40:43], v[148:151]
v_exp_f32 v168, v168
v_mfma_f32_16x16x32_bf16 v[148:151], a[156:159], v[44:47], v[148:151]
v_exp_f32 v169, v169
v_mfma_f32_16x16x32_bf16 v[144:147], a[156:159], v[28:31], v[144:147]
ds_read_b128 a[228:231], v2 offset:9216
v_cvt_pk_bf16_f32 v216, v168, v169
v_mfma_f32_16x16x32_bf16 v[144:147], a[152:155], v[24:27], v[144:147]
v_exp_f32 v170, v170
v_mfma_f32_16x16x32_bf16 v[144:147], a[148:151], v[20:23], v[144:147]
s_waitcnt lgkmcnt(10)
v_exp_f32 v171, v171
v_mfma_f32_16x16x32_bf16 a[0:3], a[192:195], v[192:195], a[0:3]
ds_read_b128 a[232:235], v2 offset:10240
v_cvt_pk_bf16_f32 v217, v170, v171
v_mfma_f32_16x16x32_bf16 a[32:35], a[192:195], v[196:199], a[32:35]
v_exp_f32 v184, v184
v_mfma_f32_16x16x32_bf16 a[64:67], a[192:195], v[200:203], a[64:67]
buffer_load_dwordx4 v1, s[44:47], s72 offen offset:2048 sc1 lds
v_mfma_f32_16x16x32_bf16 a[96:99], a[192:195], v[204:207], a[96:99]
v_exp_f32 v185, v185
v_mfma_f32_16x16x32_bf16 a[100:103], a[196:199], v[204:207], a[100:103]
ds_read_b128 a[236:239], v2 offset:11264
v_cvt_pk_bf16_f32 v218, v184, v185
v_mfma_f32_16x16x32_bf16 a[68:71], a[196:199], v[200:203], a[68:71]
v_exp_f32 v186, v186
v_mfma_f32_16x16x32_bf16 a[36:39], a[196:199], v[196:199], a[36:39]
v_exp_f32 v187, v187
v_mfma_f32_16x16x32_bf16 a[4:7], a[196:199], v[192:195], a[4:7]
ds_read_b128 a[240:243], v2 offset:12288
v_cvt_pk_bf16_f32 v219, v186, v187
v_mfma_f32_16x16x32_bf16 a[8:11], a[200:203], v[192:195], a[8:11]
v_exp_f32 v172, v172
v_mfma_f32_16x16x32_bf16 a[40:43], a[200:203], v[196:199], a[40:43]
v_exp_f32 v173, v173
v_mfma_f32_16x16x32_bf16 a[72:75], a[200:203], v[200:203], a[72:75]
ds_read_b128 a[244:247], v2 offset:13312
v_cvt_pk_bf16_f32 v220, v172, v173
v_mfma_f32_16x16x32_bf16 a[104:107], a[200:203], v[204:207], a[104:107]
v_exp_f32 v174, v174
v_mfma_f32_16x16x32_bf16 a[108:111], a[204:207], v[204:207], a[108:111]
v_exp_f32 v175, v175
v_mfma_f32_16x16x32_bf16 a[76:79], a[204:207], v[200:203], a[76:79]
ds_read_b128 a[248:251], v2 offset:14336
v_cvt_pk_bf16_f32 v221, v174, v175
v_mfma_f32_16x16x32_bf16 a[44:47], a[204:207], v[196:199], a[44:47]
v_exp_f32 v188, v188
v_mfma_f32_16x16x32_bf16 a[12:15], a[204:207], v[192:195], a[12:15]
buffer_load_dwordx4 v1, s[44:47], s72 offen offset:3072 sc1 lds
v_mfma_f32_16x16x32_bf16 a[16:19], a[208:211], v[192:195], a[16:19]
v_exp_f32 v189, v189
v_mfma_f32_16x16x32_bf16 a[48:51], a[208:211], v[196:199], a[48:51]
ds_read_b128 a[252:255], v2 offset:15360
v_cvt_pk_bf16_f32 v222, v188, v189
v_mfma_f32_16x16x32_bf16 a[80:83], a[208:211], v[200:203], a[80:83]
v_exp_f32 v190, v190
v_mfma_f32_16x16x32_bf16 a[112:115], a[208:211], v[204:207], a[112:115]
v_exp_f32 v191, v191
v_mfma_f32_16x16x32_bf16 a[116:119], a[212:215], v[204:207], a[116:119]
v_cvt_pk_bf16_f32 v223, v190, v191
v_add_u32 v2, s82, v1
v_mfma_f32_16x16x32_bf16 a[84:87], a[212:215], v[200:203], a[84:87]
v_mfma_f32_16x16x32_bf16 a[52:55], a[212:215], v[196:199], a[52:55]
v_mfma_f32_16x16x32_bf16 a[20:23], a[212:215], v[192:195], a[20:23]
v_mfma_f32_16x16x32_bf16 a[24:27], a[216:219], v[192:195], a[24:27]
v_mfma_f32_16x16x32_bf16 a[56:59], a[216:219], v[196:199], a[56:59]
v_mfma_f32_16x16x32_bf16 a[88:91], a[216:219], v[200:203], a[88:91]
v_mfma_f32_16x16x32_bf16 a[120:123], a[216:219], v[204:207], a[120:123]
v_mfma_f32_16x16x32_bf16 a[124:127], a[220:223], v[204:207], a[124:127]
v_mfma_f32_16x16x32_bf16 a[92:95], a[220:223], v[200:203], a[92:95]
v_mfma_f32_16x16x32_bf16 a[60:63], a[220:223], v[196:199], a[60:63]
v_mfma_f32_16x16x32_bf16 a[28:31], a[220:223], v[192:195], a[28:31]
v_mfma_f32_16x16x32_bf16 v[224:227], v[120:123], v[192:195], v[224:227]
v_mfma_f32_16x16x32_bf16 v[228:231], v[120:123], v[196:199], v[228:231]
v_mfma_f32_16x16x32_bf16 v[232:235], v[120:123], v[200:203], v[232:235]
s_waitcnt vmcnt(8) lgkmcnt(8)
v_mfma_f32_16x16x32_bf16 v[236:239], v[120:123], v[204:207], v[236:239]
s_barrier
LLT3:
s_cmp_eq_u32 s58, 3
s_cbranch_scc1 Ltri25
v_mfma_f32_16x16x32_bf16 v[160:163], a[160:163], v[16:19], v[112:115]
s_xor_b32 s74, s82, 0x10000
v_exp_f32 v128, v128
v_mfma_f32_16x16x32_bf16 v[164:167], a[160:163], v[32:35], v[112:115]
s_add_u32 s74, s74, s64
ds_read_b128 a[128:131], v2 offset:16384
v_mfma_f32_16x16x32_bf16 v[176:179], a[176:179], v[16:19], v[112:115]
s_add_u32 s81, s81, 0x8000
v_exp_f32 v129, v129
v_mfma_f32_16x16x32_bf16 v[180:183], a[176:179], v[32:35], v[112:115]
s_add_u32 m0, s74, 16384
v_exp_f32 v130, v130
s_branch Ljoin26
Lalt24:
Ltri25:
v_mfma_f32_16x16x32_bf16 v[160:163], a[160:163], v[16:19], v[96:99]
s_xor_b32 s74, s82, 0x10000
v_exp_f32 v128, v128
v_mfma_f32_16x16x32_bf16 v[164:167], a[160:163], v[32:35], v[84:87]
s_add_u32 s74, s74, s64
ds_read_b128 a[128:131], v2 offset:16384
v_mfma_f32_16x16x32_bf16 v[176:179], a[176:179], v[16:19], v[112:115]
s_add_u32 s81, s81, 0x8000
v_exp_f32 v129, v129
v_mfma_f32_16x16x32_bf16 v[180:183], a[176:179], v[32:35], v[100:103]
s_add_u32 m0, s74, 16384
v_exp_f32 v130, v130
Ljoin26:
v_mfma_f32_16x16x32_bf16 v[160:163], a[164:167], v[20:23], v[160:163]
s_add_u32 s72, s81, 16384
ds_read_b128 a[132:135], v2 offset:17408
v_cvt_pk_bf16_f32 v192, v128, v129
v_mfma_f32_16x16x32_bf16 v[160:163], a[168:171], v[24:27], v[160:163]
s_and_b32 s73, s58, 1
v_exp_f32 v131, v131
v_mfma_f32_16x16x32_bf16 v[160:163], a[172:175], v[28:31], v[160:163]
s_lshl_b32 s73, s73, 4
v_exp_f32 v144, v144
v_mfma_f32_16x16x32_bf16 v[164:167], a[172:175], v[44:47], v[164:167]
s_lshr_b32 s73, s90, s73
ds_read_b128 a[136:139], v2 offset:18432
v_cvt_pk_bf16_f32 v193, v130, v131
v_mfma_f32_16x16x32_bf16 v[164:167], a[168:171], v[40:43], v[164:167]
s_and_b32 s73, s73, 0xffff
buffer_load_dwordx4 v1, s[44:47], s72 offen sc1 lds
v_mfma_f32_16x16x32_bf16 v[164:167], a[164:167], v[36:39], v[164:167]
v_exp_f32 v145, v145
v_mfma_f32_16x16x32_bf16 v[168:171], a[160:163], v[48:51], v[88:91]
v_exp_f32 v146, v146
v_mfma_f32_16x16x32_bf16 v[168:171], a[164:167], v[52:55], v[168:171]
ds_read_b128 a[140:143], v2 offset:19456
v_cvt_pk_bf16_f32 v194, v144, v145
v_mfma_f32_16x16x32_bf16 v[168:171], a[168:171], v[56:59], v[168:171]
v_exp_f32 v147, v147
v_mfma_f32_16x16x32_bf16 v[168:171], a[172:175], v[60:63], v[168:171]
v_exp_f32 v132, v132
v_mfma_f32_16x16x32_bf16 v[172:175], a[172:175], v[76:79], v[92:95]
ds_read_b128 a[144:147], v2 offset:20480
v_cvt_pk_bf16_f32 v195, v146, v147
v_mfma_f32_16x16x32_bf16 v[172:175], a[168:171], v[72:75], v[172:175]
v_exp_f32 v133, v133
v_mfma_f32_16x16x32_bf16 v[172:175], a[164:167], v[68:71], v[172:175]
v_exp_f32 v134, v134
v_mfma_f32_16x16x32_bf16 v[172:175], a[160:163], v[64:67], v[172:175]
ds_read_b128 a[148:151], v2 offset:21504
v_cvt_pk_bf16_f32 v196, v132, v133
v_mfma_f32_16x16x32_bf16 v[188:191], a[176:179], v[64:67], v[92:95]
v_exp_f32 v135, v135
v_mfma_f32_16x16x32_bf16 v[188:191], a[180:183], v[68:71], v[188:191]
v_exp_f32 v148, v148
v_mfma_f32_16x16x32_bf16 v[188:191], a[184:187], v[72:75], v[188:191]
ds_read_b128 a[152:155], v2 offset:22528
v_cvt_pk_bf16_f32 v197, v134, v135
v_mfma_f32_16x16x32_bf16 v[188:191], a[188:191], v[76:79], v[188:191]
buffer_load_dwordx4 v1, s[44:47], s72 offen offset:1024 sc1 lds
v_mfma_f32_16x16x32_bf16 v[184:187], a[188:191], v[60:63], v[88:91]
v_exp_f32 v149, v149
v_mfma_f32_16x16x32_bf16 v[184:187], a[184:187], v[56:59], v[184:187]
v_exp_f32 v150, v150
v_mfma_f32_16x16x32_bf16 v[184:187], a[180:183], v[52:55], v[184:187]
ds_read_b128 a[156:159], v2 offset:23552
v_cvt_pk_bf16_f32 v198, v148, v149
v_mfma_f32_16x16x32_bf16 v[184:187], a[176:179], v[48:51], v[184:187]
v_exp_f32 v151, v151
v_mfma_f32_16x16x32_bf16 v[180:183], a[180:183], v[36:39], v[180:183]
v_exp_f32 v136, v136
v_mfma_f32_16x16x32_bf16 v[180:183], a[184:187], v[40:43], v[180:183]
ds_read_b128 a[192:195], v2 offset:0
v_cvt_pk_bf16_f32 v199, v150, v151
v_mfma_f32_16x16x32_bf16 v[180:183], a[188:191], v[44:47], v[180:183]
v_exp_f32 v137, v137
v_mfma_f32_16x16x32_bf16 v[176:179], a[188:191], v[28:31], v[176:179]
v_exp_f32 v138, v138
v_mfma_f32_16x16x32_bf16 v[176:179], a[184:187], v[24:27], v[176:179]
ds_read_b128 a[196:199], v2 offset:1024
v_cvt_pk_bf16_f32 v200, v136, v137
v_mfma_f32_16x16x32_bf16 v[176:179], a[180:183], v[20:23], v[176:179]
s_waitcnt lgkmcnt(10)
v_exp_f32 v139, v139
v_mfma_f32_16x16x32_bf16 a[0:3], a[224:227], v[208:211], a[0:3]
v_exp_f32 v152, v152
v_mfma_f32_16x16x32_bf16 a[32:35], a[224:227], v[212:215], a[32:35]
ds_read_b128 a[200:203], v2 offset:2048
v_cvt_pk_bf16_f32 v201, v138, v139
v_mfma_f32_16x16x32_bf16 a[64:67], a[224:227], v[216:219], a[64:67]
buffer_load_dwordx4 v1, s[44:47], s72 offen offset:2048 sc1 lds
v_mfma_f32_16x16x32_bf16 a[96:99], a[224:227], v[220:223], a[96:99]
v_exp_f32 v153, v153
v_mfma_f32_16x16x32_bf16 a[100:103], a[228:231], v[220:223], a[100:103]
v_exp_f32 v154, v154
v_mfma_f32_16x16x32_bf16 a[68:71], a[228:231], v[216:219], a[68:71]
ds_read_b128 a[204:207], v2 offset:3072
v_cvt_pk_bf16_f32 v202, v152, v153
v_mfma_f32_16x16x32_bf16 a[36:39], a[228:231], v[212:215], a[36:39]
v_exp_f32 v155, v155
v_mfma_f32_16x16x32_bf16 a[4:7], a[228:231], v[208:211], a[4:7]
v_exp_f32 v140, v140
v_mfma_f32_16x16x32_bf16 a[8:11], a[232:235], v[208:211], a[8:11]
ds_read_b128 a[208:211], v2 offset:4096
v_cvt_pk_bf16_f32 v203, v154, v155
v_mfma_f32_16x16x32_bf16 a[40:43], a[232:235], v[212:215], a[40:43]
v_exp_f32 v141, v141
v_mfma_f32_16x16x32_bf16 a[72:75], a[232:235], v[216:219], a[72:75]
v_exp_f32 v142, v142
v_mfma_f32_16x16x32_bf16 a[104:107], a[232:235], v[220:223], a[104:107]
ds_read_b128 a[212:215], v2 offset:5120
v_cvt_pk_bf16_f32 v204, v140, v141
v_mfma_f32_16x16x32_bf16 a[108:111], a[236:239], v[220:223], a[108:111]
v_exp_f32 v143, v143
v_mfma_f32_16x16x32_bf16 a[76:79], a[236:239], v[216:219], a[76:79]
v_exp_f32 v156, v156
v_mfma_f32_16x16x32_bf16 a[44:47], a[236:239], v[212:215], a[44:47]
ds_read_b128 a[216:219], v2 offset:6144
v_cvt_pk_bf16_f32 v205, v142, v143
v_mfma_f32_16x16x32_bf16 a[12:15], a[236:239], v[208:211], a[12:15]
buffer_load_dwordx4 v1, s[44:47], s72 offen offset:3072 sc1 lds
v_mfma_f32_16x16x32_bf16 a[16:19], a[240:243], v[208:211], a[16:19]
v_exp_f32 v157, v157
v_mfma_f32_16x16x32_bf16 a[48:51], a[240:243], v[212:215], a[48:51]
v_exp_f32 v158, v158
v_mfma_f32_16x16x32_bf16 a[80:83], a[240:243], v[216:219], a[80:83]
ds_read_b128 a[220:223], v2 offset:7168
v_cvt_pk_bf16_f32 v206, v156, v157
v_mfma_f32_16x16x32_bf16 a[112:115], a[240:243], v[220:223], a[112:115]
v_exp_f32 v159, v159
v_mfma_f32_16x16x32_bf16 a[116:119], a[244:247], v[220:223], a[116:119]
v_cvt_pk_bf16_f32 v207, v158, v159
v_lshl_add_u32 v248, v241, 3, v240
v_mfma_f32_16x16x32_bf16 a[84:87], a[244:247], v[216:219], a[84:87]
v_sub_u32 v248, 15, v248
v_and_b32 v249, 1, v248
v_mfma_f32_16x16x32_bf16 a[52:55], a[244:247], v[212:215], a[52:55]
v_lshlrev_b32 v249, 4, v249
v_lshlrev_b32 v249, v249, s73
v_mfma_f32_16x16x32_bf16 a[20:23], a[244:247], v[208:211], a[20:23]
v_lshrrev_b32 v248, 1, v248
v_and_b32 v241, 3, v0
v_mfma_f32_16x16x32_bf16 a[24:27], a[248:251], v[208:211], a[24:27]
v_cmp_eq_u32 vcc, 0, v248
v_lshl_add_u32 v5, v241, 3, v5
v_mfma_f32_16x16x32_bf16 a[56:59], a[248:251], v[212:215], a[56:59]
v_cndmask_b32 v8, 0, v249, vcc
v_cmp_eq_u32 vcc, 1, v248
v_mfma_f32_16x16x32_bf16 a[88:91], a[248:251], v[216:219], a[88:91]
v_lshlrev_b32 v240, 4, v251
v_cndmask_b32 v9, 0, v249, vcc
v_mfma_f32_16x16x32_bf16 a[120:123], a[248:251], v[220:223], a[120:123]
v_cmp_eq_u32 vcc, 2, v248
v_sub_u32 v240, 48, v240
v_mfma_f32_16x16x32_bf16 a[124:127], a[252:255], v[220:223], a[124:127]
v_lshlrev_b64 v[12:13], 16, s[88:89]
v_cndmask_b32 v10, 0, v249, vcc
v_mfma_f32_16x16x32_bf16 a[92:95], a[252:255], v[216:219], a[92:95]
v_cmp_eq_u32 vcc, 3, v248
v_lshlrev_b64 v[12:13], v240, v[12:13]
v_mfma_f32_16x16x32_bf16 a[60:63], a[252:255], v[212:215], a[60:63]
v_cndmask_b32 v11, 0, v249, vcc
v_cmp_eq_u32 vcc, 3, v241
v_mfma_f32_16x16x32_bf16 a[28:31], a[252:255], v[208:211], a[28:31]
s_add_u32 s73, s62, 4096
v_lshl_add_u32 v14, v0, 3, s73
v_cndmask_b32 v12, 0, v12, vcc
v_mfma_f32_16x16x32_bf16 v[224:227], v[120:123], v[208:211], v[224:227]
v_cndmask_b32 v13, 0, v13, vcc
v_mfma_f32_16x16x32_bf16 v[228:231], v[120:123], v[212:215], v[228:231]
v_mfma_f32_16x16x32_bf16 v[232:235], v[120:123], v[216:219], v[232:235]
v_mfma_f32_16x16x32_bf16 v[236:239], v[120:123], v[220:223], v[236:239]
s_waitcnt lgkmcnt(8)
s_cmp_eq_u32 s85, 0
s_cbranch_scc1 Ltri28
v_mfma_f32_16x16x32_bf16 v[136:139], a[128:131], v[48:51], v[88:91]
s_add_u32 s82, s82, 0x8000
ds_read_b128 a[160:163], v2 offset:24576
ds_read_b128 a[164:167], v2 offset:25600
v_mfma_f32_16x16x32_bf16 v[140:143], a[128:131], v[64:67], v[92:95]
s_and_b32 s82, s82, 0x1ffff
v_exp_f32 v160, v160
v_mfma_f32_16x16x32_bf16 v[152:155], a[144:147], v[48:51], v[88:91]
s_add_u32 m0, s74, 0
v_exp_f32 v161, v161
v_mfma_f32_16x16x32_bf16 v[156:159], a[144:147], v[64:67], v[92:95]
s_add_u32 s72, s81, 0
v_exp_f32 v162, v162
s_branch Ljoin29
Ltri28:
v_mfma_f32_16x16x32_bf16 v[136:139], a[128:131], v[48:51], v[104:107]
s_add_u32 s82, s82, 0x8000
ds_read_b128 a[160:163], v2 offset:24576
ds_read_b128 a[164:167], v2 offset:25600
v_mfma_f32_16x16x32_bf16 v[140:143], a[128:131], v[64:67], v[92:95]
s_and_b32 s82, s82, 0x1ffff
v_exp_f32 v160, v160
v_mfma_f32_16x16x32_bf16 v[152:155], a[144:147], v[48:51], v[112:115]
s_add_u32 m0, s74, 0
v_exp_f32 v161, v161
v_mfma_f32_16x16x32_bf16 v[156:159], a[144:147], v[64:67], v[108:111]
s_add_u32 s72, s81, 0
v_exp_f32 v162, v162
Ljoin29:
v_mfma_f32_16x16x32_bf16 v[136:139], a[132:135], v[52:55], v[136:139]
v_exp_f32 v163, v163
v_mfma_f32_16x16x32_bf16 v[136:139], a[136:139], v[56:59], v[136:139]
ds_read_b128 a[168:171], v2 offset:26624
v_cvt_pk_bf16_f32 v208, v160, v161
v_mfma_f32_16x16x32_bf16 v[136:139], a[140:143], v[60:63], v[136:139]
v_exp_f32 v176, v176
v_mfma_f32_16x16x32_bf16 v[140:143], a[140:143], v[76:79], v[140:143]
buffer_load_dwordx4 v1, s[44:47], s72 offen sc1 lds
v_mfma_f32_16x16x32_bf16 v[140:143], a[136:139], v[72:75], v[140:143]
v_exp_f32 v177, v177
v_mfma_f32_16x16x32_bf16 v[140:143], a[132:135], v[68:71], v[140:143]
ds_read_b128 a[172:175], v2 offset:27648
v_cvt_pk_bf16_f32 v209, v162, v163
v_mfma_f32_16x16x32_bf16 v[156:159], a[148:151], v[68:71], v[156:159]
v_exp_f32 v178, v178
v_mfma_f32_16x16x32_bf16 v[156:159], a[152:155], v[72:75], v[156:159]
v_exp_f32 v179, v179
v_mfma_f32_16x16x32_bf16 v[156:159], a[156:159], v[76:79], v[156:159]
ds_read_b128 a[176:179], v2 offset:28672
v_cvt_pk_bf16_f32 v210, v176, v177
v_mfma_f32_16x16x32_bf16 v[152:155], a[156:159], v[60:63], v[152:155]
v_exp_f32 v164, v164
v_mfma_f32_16x16x32_bf16 v[152:155], a[152:155], v[56:59], v[152:155]
v_exp_f32 v165, v165
v_mfma_f32_16x16x32_bf16 v[152:155], a[148:151], v[52:55], v[152:155]
s_waitcnt lgkmcnt(5)
ds_read_b128 a[180:183], v2 offset:29696
v_cvt_pk_bf16_f32 v211, v178, v179
v_mfma_f32_16x16x32_bf16 a[0:3], a[192:195], v[192:195], a[0:3]
v_exp_f32 v166, v166
v_mfma_f32_16x16x32_bf16 a[32:35], a[192:195], v[196:199], a[32:35]
v_exp_f32 v167, v167
v_mfma_f32_16x16x32_bf16 a[64:67], a[192:195], v[200:203], a[64:67]
ds_read_b128 a[184:187], v2 offset:30720
v_cvt_pk_bf16_f32 v212, v164, v165
v_mfma_f32_16x16x32_bf16 a[96:99], a[192:195], v[204:207], a[96:99]
v_exp_f32 v180, v180
v_mfma_f32_16x16x32_bf16 a[100:103], a[196:199], v[204:207], a[100:103]
buffer_load_dwordx4 v1, s[44:47], s72 offen offset:1024 sc1 lds
v_mfma_f32_16x16x32_bf16 a[68:71], a[196:199], v[200:203], a[68:71]
v_exp_f32 v181, v181
v_mfma_f32_16x16x32_bf16 a[36:39], a[196:199], v[196:199], a[36:39]
ds_read_b128 a[188:191], v2 offset:31744
v_cvt_pk_bf16_f32 v213, v166, v167
v_mfma_f32_16x16x32_bf16 a[4:7], a[196:199], v[192:195], a[4:7]
v_exp_f32 v182, v182
v_mfma_f32_16x16x32_bf16 a[8:11], a[200:203], v[192:195], a[8:11]
v_exp_f32 v183, v183
v_mfma_f32_16x16x32_bf16 a[40:43], a[200:203], v[196:199], a[40:43]
ds_read_b128 a[224:227], v2 offset:8192
v_cvt_pk_bf16_f32 v214, v180, v181
v_mfma_f32_16x16x32_bf16 a[72:75], a[200:203], v[200:203], a[72:75]
v_exp_f32 v168, v168
v_mfma_f32_16x16x32_bf16 a[104:107], a[200:203], v[204:207], a[104:107]
v_exp_f32 v169, v169
v_mfma_f32_16x16x32_bf16 a[108:111], a[204:207], v[204:207], a[108:111]
ds_read_b128 a[228:231], v2 offset:9216
v_cvt_pk_bf16_f32 v215, v182, v183
v_mfma_f32_16x16x32_bf16 a[76:79], a[204:207], v[200:203], a[76:79]
v_exp_f32 v170, v170
v_mfma_f32_16x16x32_bf16 a[44:47], a[204:207], v[196:199], a[44:47]
v_exp_f32 v171, v171
v_mfma_f32_16x16x32_bf16 a[12:15], a[204:207], v[192:195], a[12:15]
ds_read_b128 a[232:235], v2 offset:10240
v_cvt_pk_bf16_f32 v216, v168, v169
v_mfma_f32_16x16x32_bf16 a[16:19], a[208:211], v[192:195], a[16:19]
v_exp_f32 v184, v184
v_mfma_f32_16x16x32_bf16 a[48:51], a[208:211], v[196:199], a[48:51]
buffer_load_dwordx4 v1, s[44:47], s72 offen offset:2048 sc1 lds
v_mfma_f32_16x16x32_bf16 a[80:83], a[208:211], v[200:203], a[80:83]
v_exp_f32 v185, v185
v_mfma_f32_16x16x32_bf16 a[112:115], a[208:211], v[204:207], a[112:115]
ds_read_b128 a[236:239], v2 offset:11264
v_cvt_pk_bf16_f32 v217, v170, v171
v_mfma_f32_16x16x32_bf16 a[116:119], a[212:215], v[204:207], a[116:119]
v_exp_f32 v186, v186
v_mfma_f32_16x16x32_bf16 a[84:87], a[212:215], v[200:203], a[84:87]
v_exp_f32 v187, v187
v_mfma_f32_16x16x32_bf16 a[52:55], a[212:215], v[196:199], a[52:55]
ds_read_b128 a[240:243], v2 offset:12288
v_cvt_pk_bf16_f32 v218, v184, v185
v_mfma_f32_16x16x32_bf16 a[20:23], a[212:215], v[192:195], a[20:23]
v_exp_f32 v172, v172
v_mfma_f32_16x16x32_bf16 a[24:27], a[216:219], v[192:195], a[24:27]
v_exp_f32 v173, v173
v_mfma_f32_16x16x32_bf16 a[56:59], a[216:219], v[196:199], a[56:59]
ds_read_b128 a[244:247], v2 offset:13312
v_cvt_pk_bf16_f32 v219, v186, v187
v_mfma_f32_16x16x32_bf16 a[88:91], a[216:219], v[200:203], a[88:91]
v_exp_f32 v174, v174
v_mfma_f32_16x16x32_bf16 a[120:123], a[216:219], v[204:207], a[120:123]
v_exp_f32 v175, v175
v_mfma_f32_16x16x32_bf16 a[124:127], a[220:223], v[204:207], a[124:127]
ds_read_b128 a[248:251], v2 offset:14336
v_cvt_pk_bf16_f32 v220, v172, v173
v_mfma_f32_16x16x32_bf16 a[92:95], a[220:223], v[200:203], a[92:95]
v_exp_f32 v188, v188
v_mfma_f32_16x16x32_bf16 a[60:63], a[220:223], v[196:199], a[60:63]
buffer_load_dwordx4 v1, s[44:47], s72 offen offset:3072 sc1 lds
v_mfma_f32_16x16x32_bf16 a[28:31], a[220:223], v[192:195], a[28:31]
v_exp_f32 v189, v189
v_mfma_f32_16x16x32_bf16 v[224:227], v[120:123], v[192:195], v[224:227]
ds_read_b128 a[252:255], v2 offset:15360
v_cvt_pk_bf16_f32 v221, v174, v175
v_mfma_f32_16x16x32_bf16 v[228:231], v[120:123], v[196:199], v[228:231]
v_exp_f32 v190, v190
v_mfma_f32_16x16x32_bf16 v[232:235], v[120:123], v[200:203], v[232:235]
s_waitcnt vmcnt(8) lgkmcnt(0)
v_exp_f32 v191, v191
v_mfma_f32_16x16x32_bf16 v[236:239], v[120:123], v[204:207], v[236:239]
s_barrier
v_cvt_pk_bf16_f32 v222, v188, v189
v_cvt_pk_bf16_f32 v223, v190, v191
v_add_u32 v2, s82, v1
s_cmp_eq_u32 s60, 7
s_cbranch_scc1 LLT4x
v_mfma_f32_16x16x32_bf16 v[168:171], a[160:163], v[48:51], v[88:91]
s_xor_b32 s74, s82, 0x10000
v_exp_f32 v136, v136
v_mfma_f32_16x16x32_bf16 v[168:171], a[164:167], v[52:55], v[168:171]
s_add_u32 s74, s74, s64
ds_read_b128 a[128:131], v2 offset:16384
v_mfma_f32_16x16x32_bf16 v[168:171], a[168:171], v[56:59], v[168:171]
s_add_u32 s81, s81, 0x8000
v_exp_f32 v137, v137
v_mfma_f32_16x16x32_bf16 v[168:171], a[172:175], v[60:63], v[168:171]
s_add_u32 m0, s74, 16384
ds_read_b128 a[132:135], v2 offset:17408
v_cvt_pk_bf16_f32 v200, v136, v137
v_mfma_f32_16x16x32_bf16 v[172:175], a[172:175], v[76:79], v[92:95]
s_add_u32 s72, s81, 16384
buffer_load_dwordx4 v1, s[44:47], s72 offen sc1 lds
v_mfma_f32_16x16x32_bf16 v[172:175], a[168:171], v[72:75], v[172:175]
v_exp_f32 v138, v138
v_mfma_f32_16x16x32_bf16 v[172:175], a[164:167], v[68:71], v[172:175]
ds_read_b128 a[136:139], v2 offset:18432
v_lshrrev_b32 v15, 4, v0
v_mfma_f32_16x16x32_bf16 v[172:175], a[160:163], v[64:67], v[172:175]
v_exp_f32 v139, v139
v_mfma_f32_16x16x32_bf16 v[188:191], a[176:179], v[64:67], v[92:95]
ds_read_b128 a[140:143], v2 offset:19456
v_cvt_pk_bf16_f32 v201, v138, v139
v_mfma_f32_16x16x32_bf16 v[188:191], a[180:183], v[68:71], v[188:191]
buffer_load_dwordx4 v1, s[44:47], s72 offen offset:1024 sc1 lds
v_mfma_f32_16x16x32_bf16 v[188:191], a[184:187], v[72:75], v[188:191]
v_exp_f32 v152, v152
v_mfma_f32_16x16x32_bf16 v[188:191], a[188:191], v[76:79], v[188:191]
ds_read_b128 a[144:147], v2 offset:20480
v_lshlrev_b32 v15, 1, v15
v_mfma_f32_16x16x32_bf16 v[184:187], a[188:191], v[60:63], v[88:91]
v_exp_f32 v153, v153
v_mfma_f32_16x16x32_bf16 v[184:187], a[184:187], v[56:59], v[184:187]
ds_read_b128 a[148:151], v2 offset:21504
v_cvt_pk_bf16_f32 v202, v152, v153
v_mfma_f32_16x16x32_bf16 v[184:187], a[180:183], v[52:55], v[184:187]
buffer_load_dwordx4 v1, s[44:47], s72 offen offset:2048 sc1 lds
v_mfma_f32_16x16x32_bf16 v[184:187], a[176:179], v[48:51], v[184:187]
s_waitcnt lgkmcnt(6)
v_exp_f32 v154, v154
v_mfma_f32_16x16x32_bf16 a[0:3], a[224:227], v[208:211], a[0:3]
ds_read_b128 a[152:155], v2 offset:22528
v_and_b32 v240, 7, v0
v_mfma_f32_16x16x32_bf16 a[32:35], a[224:227], v[212:215], a[32:35]
v_exp_f32 v155, v155
v_mfma_f32_16x16x32_bf16 a[64:67], a[224:227], v[216:219], a[64:67]
ds_read_b128 a[156:159], v2 offset:23552
v_cvt_pk_bf16_f32 v203, v154, v155
v_mfma_f32_16x16x32_bf16 a[96:99], a[224:227], v[220:223], a[96:99]
buffer_load_dwordx4 v1, s[44:47], s72 offen offset:3072 sc1 lds
v_mfma_f32_16x16x32_bf16 a[100:103], a[228:231], v[220:223], a[100:103]
s_add_u32 m0, s66, 32
v_exp_f32 v140, v140
v_mfma_f32_16x16x32_bf16 a[68:71], a[228:231], v[216:219], a[68:71]
s_add_u32 s72, s93, 0x2
ds_read_b128 a[192:195], v2 offset:0
v_xor_b32 v15, v15, v240
v_mfma_f32_16x16x32_bf16 a[36:39], a[228:231], v[212:215], a[36:39]
v_exp_f32 v141, v141
v_mfma_f32_16x16x32_bf16 a[4:7], a[228:231], v[208:211], a[4:7]
ds_read_b128 a[196:199], v2 offset:1024
v_cvt_pk_bf16_f32 v204, v140, v141
v_mfma_f32_16x16x32_bf16 a[8:11], a[232:235], v[208:211], a[8:11]
buffer_load_dwordx4 v1, s[36:39], s72 offen lds
v_mfma_f32_16x16x32_bf16 a[40:43], a[232:235], v[212:215], a[40:43]
v_exp_f32 v142, v142
v_mfma_f32_16x16x32_bf16 a[72:75], a[232:235], v[216:219], a[72:75]
ds_read_b128 a[200:203], v2 offset:2048
v_lshlrev_b32 v15, 4, v15
v_mfma_f32_16x16x32_bf16 a[104:107], a[232:235], v[220:223], a[104:107]
v_exp_f32 v143, v143
v_mfma_f32_16x16x32_bf16 a[108:111], a[236:239], v[220:223], a[108:111]
ds_read_b128 a[204:207], v2 offset:3072
v_cvt_pk_bf16_f32 v205, v142, v143
v_mfma_f32_16x16x32_bf16 a[76:79], a[236:239], v[216:219], a[76:79]
buffer_load_dwordx4 v1, s[36:39], s72 offen offset:1024 lds
v_mfma_f32_16x16x32_bf16 a[44:47], a[236:239], v[212:215], a[44:47]
v_exp_f32 v156, v156
v_mfma_f32_16x16x32_bf16 a[12:15], a[236:239], v[208:211], a[12:15]
ds_read_b128 a[208:211], v2 offset:4096
v_lshrrev_b32 v240, 3, v0
v_mfma_f32_16x16x32_bf16 a[16:19], a[240:243], v[208:211], a[16:19]
v_exp_f32 v157, v157
v_mfma_f32_16x16x32_bf16 a[48:51], a[240:243], v[212:215], a[48:51]
ds_read_b128 a[212:215], v2 offset:5120
v_cvt_pk_bf16_f32 v206, v156, v157
v_mfma_f32_16x16x32_bf16 a[80:83], a[240:243], v[216:219], a[80:83]
buffer_load_dwordx4 v1, s[36:39], s72 offen offset:2048 lds
v_mfma_f32_16x16x32_bf16 a[112:115], a[240:243], v[220:223], a[112:115]
v_exp_f32 v158, v158
v_mfma_f32_16x16x32_bf16 a[116:119], a[244:247], v[220:223], a[116:119]
ds_read_b128 a[216:219], v2 offset:6144
v_lshl_add_u32 v15, v240, 11, v15
v_mfma_f32_16x16x32_bf16 a[84:87], a[244:247], v[216:219], a[84:87]
s_lshr_b32 s75, s59, 3
v_exp_f32 v159, v159
v_mfma_f32_16x16x32_bf16 a[52:55], a[244:247], v[212:215], a[52:55]
s_lshl_b32 s75, s75, 2
ds_read_b128 a[220:223], v2 offset:7168
v_cvt_pk_bf16_f32 v207, v158, v159
v_mfma_f32_16x16x32_bf16 a[20:23], a[244:247], v[208:211], a[20:23]
s_add_u32 s75, s75, s65
buffer_load_dwordx4 v1, s[36:39], s72 offen offset:3072 lds
v_mfma_f32_16x16x32_bf16 a[24:27], a[248:251], v[208:211], a[24:27]
s_lshl_b32 s76, s59, 1
v_mfma_f32_16x16x32_bf16 a[56:59], a[248:251], v[212:215], a[56:59]
s_and_b32 s76, s76, 8
v_mfma_f32_16x16x32_bf16 a[88:91], a[248:251], v[216:219], a[88:91]
s_add_u32 s76, s76, s60
v_mfma_f32_16x16x32_bf16 a[120:123], a[248:251], v[220:223], a[120:123]
s_lshl_b32 s94, s58, 16
v_mfma_f32_16x16x32_bf16 a[124:127], a[252:255], v[220:223], a[124:127]
s_lshl_b32 s80, s76, 7
v_mfma_f32_16x16x32_bf16 a[92:95], a[252:255], v[216:219], a[92:95]
s_add_u32 s94, s94, s80
v_mfma_f32_16x16x32_bf16 a[60:63], a[252:255], v[212:215], a[60:63]
s_lshl_b32 s80, s75, 18
v_mfma_f32_16x16x32_bf16 a[28:31], a[252:255], v[208:211], a[28:31]
s_add_u32 s80, s80, s94
v_mfma_f32_16x16x32_bf16 v[224:227], v[120:123], v[208:211], v[224:227]
v_mfma_f32_16x16x32_bf16 v[228:231], v[120:123], v[212:215], v[228:231]
v_mfma_f32_16x16x32_bf16 v[232:235], v[120:123], v[216:219], v[232:235]
v_mfma_f32_16x16x32_bf16 v[236:239], v[120:123], v[220:223], v[236:239]
s_waitcnt lgkmcnt(8)
s_nop 3
v_rcp_f32 v224, v224
v_rcp_f32 v228, v228
s_lshl_b32 s73, s59, 12
s_add_u32 s73, s73, 0x2000000
s_lshl_b32 s70, s67, 2
s_add_u32 s70, s70, s73
v_mov_b32 v225, v224
v_accvgpr_read_b32 v240, a0
v_accvgpr_read_b32 v241, a1
v_accvgpr_read_b32 v242, a2
v_accvgpr_read_b32 v243, a3
v_accvgpr_read_b32 v244, a4
v_accvgpr_read_b32 v245, a5
v_accvgpr_read_b32 v246, a6
v_accvgpr_read_b32 v247, a7
v_pk_mul_f32 v[240:241], v[240:241], v[224:225]
v_pk_mul_f32 v[242:243], v[242:243], v[224:225]
v_pk_mul_f32 v[244:245], v[244:245], v[224:225]
v_pk_mul_f32 v[246:247], v[246:247], v[224:225]
v_cvt_pk_bf16_f32 v128, v240, v241
v_cvt_pk_bf16_f32 v129, v242, v243
v_cvt_pk_bf16_f32 v130, v244, v245
v_cvt_pk_bf16_f32 v131, v246, v247
v_accvgpr_read_b32 v248, a8
v_accvgpr_read_b32 v249, a9
v_accvgpr_read_b32 v250, a10
v_accvgpr_read_b32 v251, a11
v_accvgpr_read_b32 v252, a12
v_accvgpr_read_b32 v253, a13
v_accvgpr_read_b32 v254, a14
v_accvgpr_read_b32 v255, a15
v_pk_mul_f32 v[248:249], v[248:249], v[224:225]
v_pk_mul_f32 v[250:251], v[250:251], v[224:225]
v_pk_mul_f32 v[252:253], v[252:253], v[224:225]
v_pk_mul_f32 v[254:255], v[254:255], v[224:225]
v_cvt_pk_bf16_f32 v144, v248, v249
v_cvt_pk_bf16_f32 v145, v250, v251
v_cvt_pk_bf16_f32 v146, v252, v253
v_cvt_pk_bf16_f32 v147, v254, v255
v_accvgpr_read_b32 v240, a16
v_accvgpr_read_b32 v241, a17
v_accvgpr_read_b32 v242, a18
v_accvgpr_read_b32 v243, a19
v_accvgpr_read_b32 v244, a20
v_accvgpr_read_b32 v245, a21
v_accvgpr_read_b32 v246, a22
v_accvgpr_read_b32 v247, a23
v_pk_mul_f32 v[240:241], v[240:241], v[224:225]
v_pk_mul_f32 v[242:243], v[242:243], v[224:225]
v_pk_mul_f32 v[244:245], v[244:245], v[224:225]
v_pk_mul_f32 v[246:247], v[246:247], v[224:225]
v_cvt_pk_bf16_f32 v160, v240, v241
v_cvt_pk_bf16_f32 v161, v242, v243
v_cvt_pk_bf16_f32 v162, v244, v245
v_cvt_pk_bf16_f32 v163, v246, v247
v_accvgpr_read_b32 v248, a24
v_accvgpr_read_b32 v249, a25
v_accvgpr_read_b32 v250, a26
v_accvgpr_read_b32 v251, a27
v_accvgpr_read_b32 v252, a28
v_accvgpr_read_b32 v253, a29
v_accvgpr_read_b32 v254, a30
v_accvgpr_read_b32 v255, a31
v_pk_mul_f32 v[248:249], v[248:249], v[224:225]
v_pk_mul_f32 v[250:251], v[250:251], v[224:225]
v_pk_mul_f32 v[252:253], v[252:253], v[224:225]
v_pk_mul_f32 v[254:255], v[254:255], v[224:225]
v_cvt_pk_bf16_f32 v176, v248, v249
v_cvt_pk_bf16_f32 v177, v250, v251
v_cvt_pk_bf16_f32 v178, v252, v253
v_cvt_pk_bf16_f32 v179, v254, v255
v_mov_b32 v229, v228
v_accvgpr_read_b32 v240, a32
v_accvgpr_read_b32 v241, a33
v_accvgpr_read_b32 v242, a34
v_accvgpr_read_b32 v243, a35
v_accvgpr_read_b32 v244, a36
v_accvgpr_read_b32 v245, a37
v_accvgpr_read_b32 v246, a38
v_accvgpr_read_b32 v247, a39
v_pk_mul_f32 v[240:241], v[240:241], v[228:229]
v_pk_mul_f32 v[242:243], v[242:243], v[228:229]
v_pk_mul_f32 v[244:245], v[244:245], v[228:229]
v_pk_mul_f32 v[246:247], v[246:247], v[228:229]
v_cvt_pk_bf16_f32 v132, v240, v241
v_cvt_pk_bf16_f32 v133, v242, v243
v_cvt_pk_bf16_f32 v134, v244, v245
v_cvt_pk_bf16_f32 v135, v246, v247
v_accvgpr_read_b32 v248, a40
v_accvgpr_read_b32 v249, a41
v_accvgpr_read_b32 v250, a42
v_accvgpr_read_b32 v251, a43
v_accvgpr_read_b32 v252, a44
v_accvgpr_read_b32 v253, a45
v_accvgpr_read_b32 v254, a46
v_accvgpr_read_b32 v255, a47
v_pk_mul_f32 v[248:249], v[248:249], v[228:229]
v_pk_mul_f32 v[250:251], v[250:251], v[228:229]
v_pk_mul_f32 v[252:253], v[252:253], v[228:229]
v_pk_mul_f32 v[254:255], v[254:255], v[228:229]
v_cvt_pk_bf16_f32 v148, v248, v249
v_cvt_pk_bf16_f32 v149, v250, v251
v_cvt_pk_bf16_f32 v150, v252, v253
v_cvt_pk_bf16_f32 v151, v254, v255
v_accvgpr_read_b32 v240, a48
v_accvgpr_read_b32 v241, a49
v_accvgpr_read_b32 v242, a50
v_accvgpr_read_b32 v243, a51
v_accvgpr_read_b32 v244, a52
v_accvgpr_read_b32 v245, a53
v_accvgpr_read_b32 v246, a54
v_accvgpr_read_b32 v247, a55
v_pk_mul_f32 v[240:241], v[240:241], v[228:229]
v_pk_mul_f32 v[242:243], v[242:243], v[228:229]
v_pk_mul_f32 v[244:245], v[244:245], v[228:229]
v_pk_mul_f32 v[246:247], v[246:247], v[228:229]
v_cvt_pk_bf16_f32 v164, v240, v241
v_cvt_pk_bf16_f32 v165, v242, v243
v_cvt_pk_bf16_f32 v166, v244, v245
v_cvt_pk_bf16_f32 v167, v246, v247
v_accvgpr_read_b32 v248, a56
v_accvgpr_read_b32 v249, a57
v_accvgpr_read_b32 v250, a58
v_accvgpr_read_b32 v251, a59
v_accvgpr_read_b32 v252, a60
v_accvgpr_read_b32 v253, a61
v_accvgpr_read_b32 v254, a62
v_accvgpr_read_b32 v255, a63
v_pk_mul_f32 v[248:249], v[248:249], v[228:229]
v_pk_mul_f32 v[250:251], v[250:251], v[228:229]
v_pk_mul_f32 v[252:253], v[252:253], v[228:229]
v_pk_mul_f32 v[254:255], v[254:255], v[228:229]
v_cvt_pk_bf16_f32 v180, v248, v249
v_cvt_pk_bf16_f32 v181, v250, v251
v_cvt_pk_bf16_f32 v182, v252, v253
v_cvt_pk_bf16_f32 v183, v254, v255
v_mfma_f32_16x16x32_bf16 v[136:139], a[128:131], v[48:51], v[88:91]
s_add_u32 s82, s82, 0x8000
ds_read_b128 a[160:163], v2 offset:24576
ds_read_b128 a[164:167], v2 offset:25600
v_mfma_f32_16x16x32_bf16 v[136:139], a[132:135], v[52:55], v[136:139]
s_and_b32 s82, s82, 0x1ffff
v_exp_f32 v168, v168
v_mfma_f32_16x16x32_bf16 v[136:139], a[136:139], v[56:59], v[136:139]
s_add_u32 m0, s74, 0
v_exp_f32 v169, v169
v_mfma_f32_16x16x32_bf16 v[136:139], a[140:143], v[60:63], v[136:139]
s_add_u32 s72, s81, 0
buffer_load_dwordx4 v1, s[44:47], s72 offen sc1 lds
v_mfma_f32_16x16x32_bf16 v[140:143], a[140:143], v[76:79], v[92:95]
ds_read_b128 a[168:171], v2 offset:26624
v_cvt_pk_bf16_f32 v216, v168, v169
v_mfma_f32_16x16x32_bf16 v[140:143], a[136:139], v[72:75], v[140:143]
v_exp_f32 v170, v170
v_mfma_f32_16x16x32_bf16 v[140:143], a[132:135], v[68:71], v[140:143]
ds_read_b128 a[172:175], v2 offset:27648
ds_read_b128 a[176:179], v2 offset:28672
v_mfma_f32_16x16x32_bf16 v[140:143], a[128:131], v[64:67], v[140:143]
v_exp_f32 v171, v171
v_mfma_f32_16x16x32_bf16 v[156:159], a[144:147], v[64:67], v[92:95]
v_exp_f32 v184, v184
v_mfma_f32_16x16x32_bf16 v[156:159], a[148:151], v[68:71], v[156:159]
buffer_store_dwordx4 v[128:131], v1, s[44:47], s70 offen sc1
v_mfma_f32_16x16x32_bf16 v[156:159], a[152:155], v[72:75], v[156:159]
ds_read_b128 a[180:183], v2 offset:29696
v_cvt_pk_bf16_f32 v217, v170, v171
v_mfma_f32_16x16x32_bf16 v[156:159], a[156:159], v[76:79], v[156:159]
v_exp_f32 v185, v185
v_mfma_f32_16x16x32_bf16 v[152:155], a[156:159], v[60:63], v[88:91]
ds_read_b128 a[184:187], v2 offset:30720
v_cvt_pk_bf16_f32 v218, v184, v185
v_mfma_f32_16x16x32_bf16 v[152:155], a[152:155], v[56:59], v[152:155]
v_exp_f32 v186, v186
v_mfma_f32_16x16x32_bf16 v[152:155], a[148:151], v[52:55], v[152:155]
buffer_load_dwordx4 v1, s[44:47], s72 offen offset:1024 sc1 lds
v_mfma_f32_16x16x32_bf16 v[152:155], a[144:147], v[48:51], v[152:155]
s_waitcnt lgkmcnt(7)
ds_read_b128 a[188:191], v2 offset:31744
ds_read_b128 a[224:227], v2 offset:8192
v_mfma_f32_16x16x32_bf16 a[64:67], a[192:195], v[200:203], a[64:67]
v_exp_f32 v187, v187
v_mfma_f32_16x16x32_bf16 a[96:99], a[192:195], v[204:207], a[96:99]
v_exp_f32 v172, v172
v_mfma_f32_16x16x32_bf16 a[100:103], a[196:199], v[204:207], a[100:103]
ds_read_b128 a[228:231], v2 offset:9216
v_cvt_pk_bf16_f32 v219, v186, v187
v_mfma_f32_16x16x32_bf16 a[68:71], a[196:199], v[200:203], a[68:71]
v_exp_f32 v173, v173
v_mfma_f32_16x16x32_bf16 a[72:75], a[200:203], v[200:203], a[72:75]
buffer_store_dwordx4 v[144:147], v1, s[44:47], s70 offen offset:1024 sc1
v_mfma_f32_16x16x32_bf16 a[104:107], a[200:203], v[204:207], a[104:107]
ds_read_b128 a[232:235], v2 offset:10240
v_cvt_pk_bf16_f32 v220, v172, v173
v_mfma_f32_16x16x32_bf16 a[108:111], a[204:207], v[204:207], a[108:111]
v_exp_f32 v174, v174
v_mfma_f32_16x16x32_bf16 a[76:79], a[204:207], v[200:203], a[76:79]
ds_read_b128 a[236:239], v2 offset:11264
ds_read_b128 a[240:243], v2 offset:12288
v_mfma_f32_16x16x32_bf16 a[80:83], a[208:211], v[200:203], a[80:83]
v_exp_f32 v175, v175
v_mfma_f32_16x16x32_bf16 a[112:115], a[208:211], v[204:207], a[112:115]
buffer_load_dwordx4 v1, s[44:47], s72 offen offset:2048 sc1 lds
v_mfma_f32_16x16x32_bf16 a[116:119], a[212:215], v[204:207], a[116:119]
v_exp_f32 v188, v188
v_mfma_f32_16x16x32_bf16 a[84:87], a[212:215], v[200:203], a[84:87]
ds_read_b128 a[244:247], v2 offset:13312
v_cvt_pk_bf16_f32 v221, v174, v175
v_mfma_f32_16x16x32_bf16 a[88:91], a[216:219], v[200:203], a[88:91]
v_exp_f32 v189, v189
v_mfma_f32_16x16x32_bf16 a[120:123], a[216:219], v[204:207], a[120:123]
ds_read_b128 a[248:251], v2 offset:14336
ds_read_b128 a[252:255], v2 offset:15360
v_mfma_f32_16x16x32_bf16 a[124:127], a[220:223], v[204:207], a[124:127]
v_exp_f32 v190, v190
v_mfma_f32_16x16x32_bf16 a[92:95], a[220:223], v[200:203], a[92:95]
buffer_load_dwordx4 v1, s[44:47], s72 offen offset:3072 sc1 lds
v_mfma_f32_16x16x32_bf16 v[232:235], v[120:123], v[200:203], v[232:235]
s_waitcnt vmcnt(14) lgkmcnt(8)
v_exp_f32 v191, v191
v_mfma_f32_16x16x32_bf16 v[236:239], v[120:123], v[204:207], v[236:239]
s_barrier
v_cvt_pk_bf16_f32 v222, v188, v189
v_cvt_pk_bf16_f32 v223, v190, v191
v_add_u32 v2, s82, v1
v_mfma_f32_16x16x32_bf16 v[168:171], a[160:163], v[48:51], v[88:91]
s_xor_b32 s74, s82, 0x10000
v_exp_f32 v136, v136
v_mfma_f32_16x16x32_bf16 v[168:171], a[164:167], v[52:55], v[168:171]
s_add_u32 s74, s74, s64
ds_read_b128 a[128:131], v2 offset:16384
ds_read_b128 a[132:135], v2 offset:17408
v_mfma_f32_16x16x32_bf16 v[168:171], a[168:171], v[56:59], v[168:171]
s_add_u32 s81, s81, 0x8000
v_exp_f32 v137, v137
v_mfma_f32_16x16x32_bf16 v[168:171], a[172:175], v[60:63], v[168:171]
s_add_u32 m0, s74, 16384
v_exp_f32 v138, v138
v_mfma_f32_16x16x32_bf16 v[172:175], a[172:175], v[76:79], v[92:95]
s_add_u32 s72, s81, 16384
buffer_load_dwordx4 v1, s[44:47], s72 offen sc1 lds
v_mfma_f32_16x16x32_bf16 v[172:175], a[168:171], v[72:75], v[172:175]
ds_read_b128 a[136:139], v2 offset:18432
v_cvt_pk_bf16_f32 v200, v136, v137
v_mfma_f32_16x16x32_bf16 v[172:175], a[164:167], v[68:71], v[172:175]
v_exp_f32 v139, v139
v_mfma_f32_16x16x32_bf16 v[172:175], a[160:163], v[64:67], v[172:175]
ds_read_b128 a[140:143], v2 offset:19456
v_cvt_pk_bf16_f32 v201, v138, v139
v_mfma_f32_16x16x32_bf16 v[188:191], a[176:179], v[64:67], v[92:95]
buffer_store_dwordx4 v[160:163], v1, s[44:47], s70 offen offset:2048 sc1
v_mfma_f32_16x16x32_bf16 v[188:191], a[180:183], v[68:71], v[188:191]
v_exp_f32 v152, v152
v_mfma_f32_16x16x32_bf16 v[188:191], a[184:187], v[72:75], v[188:191]
ds_read_b128 a[144:147], v2 offset:20480
ds_read_b128 a[148:151], v2 offset:21504
v_mfma_f32_16x16x32_bf16 v[188:191], a[188:191], v[76:79], v[188:191]
v_exp_f32 v153, v153
v_mfma_f32_16x16x32_bf16 v[184:187], a[188:191], v[60:63], v[88:91]
buffer_load_dwordx4 v1, s[44:47], s72 offen offset:1024 sc1 lds
v_mfma_f32_16x16x32_bf16 v[184:187], a[184:187], v[56:59], v[184:187]
v_exp_f32 v154, v154
v_mfma_f32_16x16x32_bf16 v[184:187], a[180:183], v[52:55], v[184:187]
ds_read_b128 a[152:155], v2 offset:22528
v_cvt_pk_bf16_f32 v202, v152, v153
v_mfma_f32_16x16x32_bf16 v[184:187], a[176:179], v[48:51], v[184:187]
s_waitcnt lgkmcnt(7)
v_exp_f32 v155, v155
v_mfma_f32_16x16x32_bf16 a[64:67], a[224:227], v[216:219], a[64:67]
ds_read_b128 a[156:159], v2 offset:23552
v_cvt_pk_bf16_f32 v203, v154, v155
v_mfma_f32_16x16x32_bf16 a[96:99], a[224:227], v[220:223], a[96:99]
v_exp_f32 v140, v140
v_mfma_f32_16x16x32_bf16 a[100:103], a[228:231], v[220:223], a[100:103]
ds_read_b128 a[192:195], v2 offset:0
ds_read_b128 a[196:199], v2 offset:1024
v_mfma_f32_16x16x32_bf16 a[68:71], a[228:231], v[216:219], a[68:71]
buffer_store_dwordx4 v[176:179], v1, s[44:47], s70 offen offset:3072 sc1
v_mfma_f32_16x16x32_bf16 a[72:75], a[232:235], v[216:219], a[72:75]
v_exp_f32 v141, v141
v_mfma_f32_16x16x32_bf16 a[104:107], a[232:235], v[220:223], a[104:107]
v_exp_f32 v142, v142
v_mfma_f32_16x16x32_bf16 a[108:111], a[236:239], v[220:223], a[108:111]
ds_read_b128 a[200:203], v2 offset:2048
ds_read_b128 a[204:207], v2 offset:3072
v_mfma_f32_16x16x32_bf16 a[76:79], a[236:239], v[216:219], a[76:79]
buffer_load_dwordx4 v1, s[44:47], s72 offen offset:2048 sc1 lds
v_mfma_f32_16x16x32_bf16 a[80:83], a[240:243], v[216:219], a[80:83]
s_add_u32 s70, s70, 0x20000
v_exp_f32 v143, v143
v_mfma_f32_16x16x32_bf16 a[112:115], a[240:243], v[220:223], a[112:115]
v_exp_f32 v156, v156
v_mfma_f32_16x16x32_bf16 a[116:119], a[244:247], v[220:223], a[116:119]
ds_read_b128 a[208:211], v2 offset:4096
ds_read_b128 a[212:215], v2 offset:5120
v_mfma_f32_16x16x32_bf16 a[84:87], a[244:247], v[216:219], a[84:87]
ds_read_b128 a[216:219], v2 offset:6144
ds_read_b128 a[220:223], v2 offset:7168
v_mfma_f32_16x16x32_bf16 a[88:91], a[248:251], v[216:219], a[88:91]
v_cvt_pk_bf16_f32 v204, v140, v141
v_cvt_pk_bf16_f32 v205, v142, v143
v_mfma_f32_16x16x32_bf16 a[120:123], a[248:251], v[220:223], a[120:123]
buffer_store_dwordx4 v[132:135], v1, s[44:47], s70 offen sc1
v_mfma_f32_16x16x32_bf16 a[124:127], a[252:255], v[220:223], a[124:127]
v_exp_f32 v157, v157
v_mfma_f32_16x16x32_bf16 a[92:95], a[252:255], v[216:219], a[92:95]
v_exp_f32 v158, v158
v_mfma_f32_16x16x32_bf16 v[232:235], v[120:123], v[216:219], v[232:235]
buffer_load_dwordx4 v1, s[44:47], s72 offen offset:3072 sc1 lds
v_mfma_f32_16x16x32_bf16 v[236:239], v[120:123], v[220:223], v[236:239]
s_waitcnt lgkmcnt(8)
v_exp_f32 v159, v159
v_cvt_pk_bf16_f32 v206, v156, v157
v_cvt_pk_bf16_f32 v207, v158, v159
v_mfma_f32_16x16x32_bf16 v[136:139], a[128:131], v[48:51], v[88:91]
s_add_u32 s82, s82, 0x8000
ds_read_b128 a[160:163], v2 offset:24576
ds_read_b128 a[164:167], v2 offset:25600
v_mfma_f32_16x16x32_bf16 v[136:139], a[132:135], v[52:55], v[136:139]
s_and_b32 s82, s82, 0x1ffff
v_exp_f32 v168, v168
v_mfma_f32_16x16x32_bf16 v[136:139], a[136:139], v[56:59], v[136:139]
s_add_u32 m0, s74, 0
v_exp_f32 v169, v169
v_mfma_f32_16x16x32_bf16 v[136:139], a[140:143], v[60:63], v[136:139]
s_add_u32 s72, s81, 0
buffer_load_dwordx4 v1, s[44:47], s72 offen sc1 lds
v_mfma_f32_16x16x32_bf16 v[140:143], a[140:143], v[76:79], v[92:95]
ds_read_b128 a[168:171], v2 offset:26624
v_cvt_pk_bf16_f32 v216, v168, v169
v_mfma_f32_16x16x32_bf16 v[140:143], a[136:139], v[72:75], v[140:143]
v_exp_f32 v170, v170
v_mfma_f32_16x16x32_bf16 v[140:143], a[132:135], v[68:71], v[140:143]
ds_read_b128 a[172:175], v2 offset:27648
ds_read_b128 a[176:179], v2 offset:28672
v_mfma_f32_16x16x32_bf16 v[140:143], a[128:131], v[64:67], v[140:143]
v_exp_f32 v171, v171
v_mfma_f32_16x16x32_bf16 v[156:159], a[144:147], v[64:67], v[92:95]
buffer_store_dwordx4 v[148:151], v1, s[44:47], s70 offen offset:1024 sc1
v_mfma_f32_16x16x32_bf16 v[156:159], a[148:151], v[68:71], v[156:159]
v_exp_f32 v184, v184
v_mfma_f32_16x16x32_bf16 v[156:159], a[152:155], v[72:75], v[156:159]
ds_read_b128 a[180:183], v2 offset:29696
v_cvt_pk_bf16_f32 v217, v170, v171
v_mfma_f32_16x16x32_bf16 v[156:159], a[156:159], v[76:79], v[156:159]
v_exp_f32 v185, v185
v_mfma_f32_16x16x32_bf16 v[152:155], a[156:159], v[60:63], v[88:91]
buffer_load_dwordx4 v1, s[44:47], s72 offen offset:1024 sc1 lds
v_mfma_f32_16x16x32_bf16 v[152:155], a[152:155], v[56:59], v[152:155]
ds_read_b128 a[184:187], v2 offset:30720
v_cvt_pk_bf16_f32 v218, v184, v185
v_mfma_f32_16x16x32_bf16 v[152:155], a[148:151], v[52:55], v[152:155]
v_exp_f32 v186, v186
v_mfma_f32_16x16x32_bf16 v[152:155], a[144:147], v[48:51], v[152:155]
s_waitcnt lgkmcnt(7)
ds_read_b128 a[188:191], v2 offset:31744
ds_read_b128 a[224:227], v2 offset:8192
v_mfma_f32_16x16x32_bf16 a[64:67], a[192:195], v[200:203], a[64:67]
v_exp_f32 v187, v187
v_mfma_f32_16x16x32_bf16 a[96:99], a[192:195], v[204:207], a[96:99]
buffer_store_dwordx4 v[164:167], v1, s[44:47], s70 offen offset:2048 sc1
v_mfma_f32_16x16x32_bf16 a[100:103], a[196:199], v[204:207], a[100:103]
v_exp_f32 v172, v172
v_mfma_f32_16x16x32_bf16 a[68:71], a[196:199], v[200:203], a[68:71]
ds_read_b128 a[228:231], v2 offset:9216
v_cvt_pk_bf16_f32 v219, v186, v187
v_mfma_f32_16x16x32_bf16 a[72:75], a[200:203], v[200:203], a[72:75]
v_exp_f32 v173, v173
v_mfma_f32_16x16x32_bf16 a[104:107], a[200:203], v[204:207], a[104:107]
ds_read_b128 a[232:235], v2 offset:10240
ds_read_b128 a[236:239], v2 offset:11264
v_mfma_f32_16x16x32_bf16 a[108:111], a[204:207], v[204:207], a[108:111]
v_exp_f32 v174, v174
v_mfma_f32_16x16x32_bf16 a[76:79], a[204:207], v[200:203], a[76:79]
buffer_load_dwordx4 v1, s[44:47], s72 offen offset:2048 sc1 lds
v_mfma_f32_16x16x32_bf16 a[80:83], a[208:211], v[200:203], a[80:83]
v_exp_f32 v175, v175
v_mfma_f32_16x16x32_bf16 a[112:115], a[208:211], v[204:207], a[112:115]
ds_read_b128 a[240:243], v2 offset:12288
ds_read_b128 a[244:247], v2 offset:13312
v_mfma_f32_16x16x32_bf16 a[116:119], a[212:215], v[204:207], a[116:119]
v_exp_f32 v188, v188
v_mfma_f32_16x16x32_bf16 a[84:87], a[212:215], v[200:203], a[84:87]
ds_read_b128 a[248:251], v2 offset:14336
ds_read_b128 a[252:255], v2 offset:15360
v_mfma_f32_16x16x32_bf16 a[88:91], a[216:219], v[200:203], a[88:91]
v_cvt_pk_bf16_f32 v220, v172, v173
v_cvt_pk_bf16_f32 v221, v174, v175
v_mfma_f32_16x16x32_bf16 a[120:123], a[216:219], v[204:207], a[120:123]
buffer_store_dwordx4 v[180:183], v1, s[44:47], s70 offen offset:3072 sc1
v_mfma_f32_16x16x32_bf16 a[124:127], a[220:223], v[204:207], a[124:127]
v_exp_f32 v189, v189
v_mfma_f32_16x16x32_bf16 a[92:95], a[220:223], v[200:203], a[92:95]
buffer_load_dwordx4 v1, s[44:47], s72 offen offset:3072 sc1 lds
v_mfma_f32_16x16x32_bf16 v[232:235], v[120:123], v[200:203], v[232:235]
s_waitcnt vmcnt(14) lgkmcnt(8)
v_exp_f32 v190, v190
v_mfma_f32_16x16x32_bf16 v[236:239], v[120:123], v[204:207], v[236:239]
s_barrier
v_exp_f32 v191, v191
v_add_u32 v2, s82, v1
v_cvt_pk_bf16_f32 v222, v188, v189
v_cvt_pk_bf16_f32 v223, v190, v191
s_lshl_b32 s83, s60, 2
s_sub_u32 s83, s83, 25
.p2align 5
s_nop 0
s_nop 0
LloopII:
v_mfma_f32_16x16x32_bf16 v[168:171], a[160:163], v[48:51], v[88:91]
s_xor_b32 s74, s82, 0x10000
v_exp_f32 v136, v136
v_mfma_f32_16x16x32_bf16 v[168:171], a[164:167], v[52:55], v[168:171]
s_add_u32 s74, s74, s64
ds_read_b128 a[128:131], v2 offset:16384
ds_read_b128 a[132:135], v2 offset:17408
v_mfma_f32_16x16x32_bf16 v[168:171], a[168:171], v[56:59], v[168:171]
s_add_u32 s81, s81, 0x8000
v_exp_f32 v137, v137
v_mfma_f32_16x16x32_bf16 v[168:171], a[172:175], v[60:63], v[168:171]
s_add_u32 m0, s74, 16384
v_exp_f32 v138, v138
v_mfma_f32_16x16x32_bf16 v[172:175], a[172:175], v[76:79], v[92:95]
s_add_u32 s72, s81, 16384
ds_read_b128 a[136:139], v2 offset:18432
v_cvt_pk_bf16_f32 v200, v136, v137
v_mfma_f32_16x16x32_bf16 v[172:175], a[168:171], v[72:75], v[172:175]
buffer_load_dwordx4 v1, s[44:47], s72 offen sc1 lds
v_mfma_f32_16x16x32_bf16 v[172:175], a[164:167], v[68:71], v[172:175]
v_exp_f32 v139, v139
v_mfma_f32_16x16x32_bf16 v[172:175], a[160:163], v[64:67], v[172:175]
ds_read_b128 a[140:143], v2 offset:19456
v_cvt_pk_bf16_f32 v201, v138, v139
v_mfma_f32_16x16x32_bf16 v[188:191], a[176:179], v[64:67], v[92:95]
v_exp_f32 v152, v152
v_mfma_f32_16x16x32_bf16 v[188:191], a[180:183], v[68:71], v[188:191]
ds_read_b128 a[144:147], v2 offset:20480
ds_read_b128 a[148:151], v2 offset:21504
v_mfma_f32_16x16x32_bf16 v[188:191], a[184:187], v[72:75], v[188:191]
v_exp_f32 v153, v153
v_mfma_f32_16x16x32_bf16 v[188:191], a[188:191], v[76:79], v[188:191]
v_exp_f32 v154, v154
v_mfma_f32_16x16x32_bf16 v[184:187], a[188:191], v[60:63], v[88:91]
ds_read_b128 a[152:155], v2 offset:22528
v_cvt_pk_bf16_f32 v202, v152, v153
v_mfma_f32_16x16x32_bf16 v[184:187], a[184:187], v[56:59], v[184:187]
buffer_load_dwordx4 v1, s[44:47], s72 offen offset:1024 sc1 lds
v_mfma_f32_16x16x32_bf16 v[184:187], a[180:183], v[52:55], v[184:187]
v_exp_f32 v155, v155
v_mfma_f32_16x16x32_bf16 v[184:187], a[176:179], v[48:51], v[184:187]
s_waitcnt lgkmcnt(7)
ds_read_b128 a[156:159], v2 offset:23552
v_cvt_pk_bf16_f32 v203, v154, v155
v_mfma_f32_16x16x32_bf16 a[64:67], a[224:227], v[216:219], a[64:67]
v_exp_f32 v140, v140
v_mfma_f32_16x16x32_bf16 a[96:99], a[224:227], v[220:223], a[96:99]
ds_read_b128 a[192:195], v2 offset:0
ds_read_b128 a[196:199], v2 offset:1024
v_mfma_f32_16x16x32_bf16 a[100:103], a[228:231], v[220:223], a[100:103]
v_exp_f32 v141, v141
v_mfma_f32_16x16x32_bf16 a[68:71], a[228:231], v[216:219], a[68:71]
v_exp_f32 v142, v142
v_mfma_f32_16x16x32_bf16 a[72:75], a[232:235], v[216:219], a[72:75]
ds_read_b128 a[200:203], v2 offset:2048
v_cvt_pk_bf16_f32 v204, v140, v141
v_mfma_f32_16x16x32_bf16 a[104:107], a[232:235], v[220:223], a[104:107]
buffer_load_dwordx4 v1, s[44:47], s72 offen offset:2048 sc1 lds
v_mfma_f32_16x16x32_bf16 a[108:111], a[236:239], v[220:223], a[108:111]
v_exp_f32 v143, v143
v_mfma_f32_16x16x32_bf16 a[76:79], a[236:239], v[216:219], a[76:79]
ds_read_b128 a[204:207], v2 offset:3072
v_cvt_pk_bf16_f32 v205, v142, v143
v_mfma_f32_16x16x32_bf16 a[80:83], a[240:243], v[216:219], a[80:83]
v_exp_f32 v156, v156
v_mfma_f32_16x16x32_bf16 a[112:115], a[240:243], v[220:223], a[112:115]
ds_read_b128 a[208:211], v2 offset:4096
v_mfma_f32_16x16x32_bf16 a[116:119], a[244:247], v[220:223], a[116:119]
v_exp_f32 v157, v157
v_mfma_f32_16x16x32_bf16 a[84:87], a[244:247], v[216:219], a[84:87]
ds_read_b128 a[212:215], v2 offset:5120
v_cvt_pk_bf16_f32 v206, v156, v157
v_mfma_f32_16x16x32_bf16 a[88:91], a[248:251], v[216:219], a[88:91]
v_exp_f32 v158, v158
v_mfma_f32_16x16x32_bf16 a[120:123], a[248:251], v[220:223], a[120:123]
ds_read_b128 a[216:219], v2 offset:6144
v_mfma_f32_16x16x32_bf16 a[124:127], a[252:255], v[220:223], a[124:127]
buffer_load_dwordx4 v1, s[44:47], s72 offen offset:3072 sc1 lds
v_mfma_f32_16x16x32_bf16 a[92:95], a[252:255], v[216:219], a[92:95]
v_exp_f32 v159, v159
v_mfma_f32_16x16x32_bf16 v[232:235], v[120:123], v[216:219], v[232:235]
ds_read_b128 a[220:223], v2 offset:7168
v_cvt_pk_bf16_f32 v207, v158, v159
v_mfma_f32_16x16x32_bf16 v[236:239], v[120:123], v[220:223], v[236:239]
s_waitcnt lgkmcnt(8)
v_mfma_f32_16x16x32_bf16 v[136:139], a[128:131], v[48:51], v[88:91]
s_add_u32 s82, s82, 0x8000
ds_read_b128 a[160:163], v2 offset:24576
ds_read_b128 a[164:167], v2 offset:25600
v_mfma_f32_16x16x32_bf16 v[136:139], a[132:135], v[52:55], v[136:139]
s_and_b32 s82, s82, 0x1ffff
v_exp_f32 v168, v168
v_mfma_f32_16x16x32_bf16 v[136:139], a[136:139], v[56:59], v[136:139]
s_add_u32 m0, s74, 0
v_exp_f32 v169, v169
v_mfma_f32_16x16x32_bf16 v[136:139], a[140:143], v[60:63], v[136:139]
s_add_u32 s72, s81, 0
ds_read_b128 a[168:171], v2 offset:26624
v_cvt_pk_bf16_f32 v216, v168, v169
v_mfma_f32_16x16x32_bf16 v[140:143], a[140:143], v[76:79], v[92:95]
v_exp_f32 v170, v170
v_mfma_f32_16x16x32_bf16 v[140:143], a[136:139], v[72:75], v[140:143]
buffer_load_dwordx4 v1, s[44:47], s72 offen sc1 lds
v_mfma_f32_16x16x32_bf16 v[140:143], a[132:135], v[68:71], v[140:143]
ds_read_b128 a[172:175], v2 offset:27648
ds_read_b128 a[176:179], v2 offset:28672
v_mfma_f32_16x16x32_bf16 v[140:143], a[128:131], v[64:67], v[140:143]
v_exp_f32 v171, v171
v_mfma_f32_16x16x32_bf16 v[156:159], a[144:147], v[64:67], v[92:95]
v_exp_f32 v184, v184
v_mfma_f32_16x16x32_bf16 v[156:159], a[148:151], v[68:71], v[156:159]
ds_read_b128 a[180:183], v2 offset:29696
v_cvt_pk_bf16_f32 v217, v170, v171
v_mfma_f32_16x16x32_bf16 v[156:159], a[152:155], v[72:75], v[156:159]
v_exp_f32 v185, v185
v_mfma_f32_16x16x32_bf16 v[156:159], a[156:159], v[76:79], v[156:159]
ds_read_b128 a[184:187], v2 offset:30720
v_cvt_pk_bf16_f32 v218, v184, v185
v_mfma_f32_16x16x32_bf16 v[152:155], a[156:159], v[60:63], v[88:91]
buffer_load_dwordx4 v1, s[44:47], s72 offen offset:1024 sc1 lds
v_mfma_f32_16x16x32_bf16 v[152:155], a[152:155], v[56:59], v[152:155]
v_exp_f32 v186, v186
v_mfma_f32_16x16x32_bf16 v[152:155], a[148:151], v[52:55], v[152:155]
ds_read_b128 a[188:191], v2 offset:31744
ds_read_b128 a[224:227], v2 offset:8192
v_mfma_f32_16x16x32_bf16 v[152:155], a[144:147], v[48:51], v[152:155]
s_waitcnt lgkmcnt(9)
v_exp_f32 v187, v187
v_mfma_f32_16x16x32_bf16 a[64:67], a[192:195], v[200:203], a[64:67]
v_exp_f32 v172, v172
v_mfma_f32_16x16x32_bf16 a[96:99], a[192:195], v[204:207], a[96:99]
ds_read_b128 a[228:231], v2 offset:9216
v_cvt_pk_bf16_f32 v219, v186, v187
v_mfma_f32_16x16x32_bf16 a[100:103], a[196:199], v[204:207], a[100:103]
v_exp_f32 v173, v173
v_mfma_f32_16x16x32_bf16 a[68:71], a[196:199], v[200:203], a[68:71]
ds_read_b128 a[232:235], v2 offset:10240
v_cvt_pk_bf16_f32 v220, v172, v173
v_mfma_f32_16x16x32_bf16 a[72:75], a[200:203], v[200:203], a[72:75]
buffer_load_dwordx4 v1, s[44:47], s72 offen offset:2048 sc1 lds
v_mfma_f32_16x16x32_bf16 a[104:107], a[200:203], v[204:207], a[104:107]
v_exp_f32 v174, v174
v_mfma_f32_16x16x32_bf16 a[108:111], a[204:207], v[204:207], a[108:111]
ds_read_b128 a[236:239], v2 offset:11264
ds_read_b128 a[240:243], v2 offset:12288
v_mfma_f32_16x16x32_bf16 a[76:79], a[204:207], v[200:203], a[76:79]
v_exp_f32 v175, v175
v_mfma_f32_16x16x32_bf16 a[80:83], a[208:211], v[200:203], a[80:83]
v_exp_f32 v188, v188
v_mfma_f32_16x16x32_bf16 a[112:115], a[208:211], v[204:207], a[112:115]
ds_read_b128 a[244:247], v2 offset:13312
v_cvt_pk_bf16_f32 v221, v174, v175
v_mfma_f32_16x16x32_bf16 a[116:119], a[212:215], v[204:207], a[116:119]
v_exp_f32 v189, v189
v_mfma_f32_16x16x32_bf16 a[84:87], a[212:215], v[200:203], a[84:87]
ds_read_b128 a[248:251], v2 offset:14336
v_cvt_pk_bf16_f32 v222, v188, v189
v_mfma_f32_16x16x32_bf16 a[88:91], a[216:219], v[200:203], a[88:91]
buffer_load_dwordx4 v1, s[44:47], s72 offen offset:3072 sc1 lds
v_mfma_f32_16x16x32_bf16 a[120:123], a[216:219], v[204:207], a[120:123]
ds_read_b128 a[252:255], v2 offset:15360
v_add_u32 v2, s82, v1
v_mfma_f32_16x16x32_bf16 a[124:127], a[220:223], v[204:207], a[124:127]
s_waitcnt vmcnt(8) lgkmcnt(8)
v_exp_f32 v190, v190
v_mfma_f32_16x16x32_bf16 a[92:95], a[220:223], v[200:203], a[92:95]
s_barrier
v_exp_f32 v191, v191
v_mfma_f32_16x16x32_bf16 v[232:235], v[120:123], v[200:203], v[232:235]
s_add_u32 s83, s83, 1
v_cvt_pk_bf16_f32 v223, v190, v191
v_mfma_f32_16x16x32_bf16 v[236:239], v[120:123], v[204:207], v[236:239]
s_cbranch_scc0 LloopII
v_mfma_f32_16x16x32_bf16 v[168:171], a[160:163], v[48:51], v[88:91]
s_xor_b32 s74, s82, 0x10000
v_exp_f32 v136, v136
v_mfma_f32_16x16x32_bf16 v[168:171], a[164:167], v[52:55], v[168:171]
s_add_u32 s74, s74, s64
ds_read_b128 a[128:131], v2 offset:16384
ds_read_b128 a[132:135], v2 offset:17408
v_mfma_f32_16x16x32_bf16 v[168:171], a[168:171], v[56:59], v[168:171]
s_add_u32 s81, s81, 0x8000
v_exp_f32 v137, v137
v_mfma_f32_16x16x32_bf16 v[168:171], a[172:175], v[60:63], v[168:171]
s_add_u32 m0, s74, 0
v_exp_f32 v138, v138
v_mfma_f32_16x16x32_bf16 v[172:175], a[172:175], v[76:79], v[92:95]
s_add_u32 s72, s81, 0
ds_read_b128 a[136:139], v2 offset:18432
v_cvt_pk_bf16_f32 v200, v136, v137
v_mfma_f32_16x16x32_bf16 v[172:175], a[168:171], v[72:75], v[172:175]
buffer_load_dwordx4 v1, s[44:47], s72 offen sc1 lds
v_mfma_f32_16x16x32_bf16 v[172:175], a[164:167], v[68:71], v[172:175]
v_exp_f32 v139, v139
v_mfma_f32_16x16x32_bf16 v[172:175], a[160:163], v[64:67], v[172:175]
ds_read_b128 a[140:143], v2 offset:19456
v_cvt_pk_bf16_f32 v201, v138, v139
v_mfma_f32_16x16x32_bf16 v[188:191], a[176:179], v[64:67], v[92:95]
v_exp_f32 v152, v152
v_mfma_f32_16x16x32_bf16 v[188:191], a[180:183], v[68:71], v[188:191]
ds_read_b128 a[144:147], v2 offset:20480
ds_read_b128 a[148:151], v2 offset:21504
v_mfma_f32_16x16x32_bf16 v[188:191], a[184:187], v[72:75], v[188:191]
v_exp_f32 v153, v153
v_mfma_f32_16x16x32_bf16 v[188:191], a[188:191], v[76:79], v[188:191]
v_exp_f32 v154, v154
v_mfma_f32_16x16x32_bf16 v[184:187], a[188:191], v[60:63], v[88:91]
ds_read_b128 a[152:155], v2 offset:22528
v_cvt_pk_bf16_f32 v202, v152, v153
v_mfma_f32_16x16x32_bf16 v[184:187], a[184:187], v[56:59], v[184:187]
buffer_load_dwordx4 v1, s[44:47], s72 offen offset:1024 sc1 lds
v_mfma_f32_16x16x32_bf16 v[184:187], a[180:183], v[52:55], v[184:187]
v_exp_f32 v155, v155
v_mfma_f32_16x16x32_bf16 v[184:187], a[176:179], v[48:51], v[184:187]
s_waitcnt lgkmcnt(7)
ds_read_b128 a[156:159], v2 offset:23552
v_cvt_pk_bf16_f32 v203, v154, v155
v_mfma_f32_16x16x32_bf16 a[64:67], a[224:227], v[216:219], a[64:67]
v_exp_f32 v140, v140
v_mfma_f32_16x16x32_bf16 a[96:99], a[224:227], v[220:223], a[96:99]
ds_read_b128 a[192:195], v2 offset:0
ds_read_b128 a[196:199], v2 offset:1024
v_mfma_f32_16x16x32_bf16 a[100:103], a[228:231], v[220:223], a[100:103]
v_exp_f32 v141, v141
v_mfma_f32_16x16x32_bf16 a[68:71], a[228:231], v[216:219], a[68:71]
v_exp_f32 v142, v142
v_mfma_f32_16x16x32_bf16 a[72:75], a[232:235], v[216:219], a[72:75]
ds_read_b128 a[200:203], v2 offset:2048
v_cvt_pk_bf16_f32 v204, v140, v141
v_mfma_f32_16x16x32_bf16 a[104:107], a[232:235], v[220:223], a[104:107]
buffer_load_dwordx4 v1, s[44:47], s72 offen offset:2048 sc1 lds
v_mfma_f32_16x16x32_bf16 a[108:111], a[236:239], v[220:223], a[108:111]
v_exp_f32 v143, v143
v_mfma_f32_16x16x32_bf16 a[76:79], a[236:239], v[216:219], a[76:79]
ds_read_b128 a[204:207], v2 offset:3072
v_cvt_pk_bf16_f32 v205, v142, v143
v_mfma_f32_16x16x32_bf16 a[80:83], a[240:243], v[216:219], a[80:83]
v_exp_f32 v156, v156
v_mfma_f32_16x16x32_bf16 a[112:115], a[240:243], v[220:223], a[112:115]
ds_read_b128 a[208:211], v2 offset:4096
v_mfma_f32_16x16x32_bf16 a[116:119], a[244:247], v[220:223], a[116:119]
v_exp_f32 v157, v157
v_mfma_f32_16x16x32_bf16 a[84:87], a[244:247], v[216:219], a[84:87]
ds_read_b128 a[212:215], v2 offset:5120
v_cvt_pk_bf16_f32 v206, v156, v157
v_mfma_f32_16x16x32_bf16 a[88:91], a[248:251], v[216:219], a[88:91]
v_exp_f32 v158, v158
v_mfma_f32_16x16x32_bf16 a[120:123], a[248:251], v[220:223], a[120:123]
ds_read_b128 a[216:219], v2 offset:6144
v_mfma_f32_16x16x32_bf16 a[124:127], a[252:255], v[220:223], a[124:127]
buffer_load_dwordx4 v1, s[44:47], s72 offen offset:3072 sc1 lds
v_mfma_f32_16x16x32_bf16 a[92:95], a[252:255], v[216:219], a[92:95]
v_exp_f32 v159, v159
v_mfma_f32_16x16x32_bf16 v[232:235], v[120:123], v[216:219], v[232:235]
ds_read_b128 a[220:223], v2 offset:7168
v_cvt_pk_bf16_f32 v207, v158, v159
v_mfma_f32_16x16x32_bf16 v[236:239], v[120:123], v[220:223], v[236:239]
s_waitcnt lgkmcnt(8)
s_cmp_eq_u32 s58, 0
s_cbranch_scc1 Ltri31
v_mfma_f32_16x16x32_bf16 v[136:139], a[128:131], v[48:51], v[88:91]
s_add_u32 s82, s82, 0x8000
ds_read_b128 a[160:163], v2 offset:24576
ds_read_b128 a[164:167], v2 offset:25600
v_mfma_f32_16x16x32_bf16 v[140:143], a[128:131], v[64:67], v[92:95]
s_and_b32 s82, s82, 0x1ffff
v_exp_f32 v168, v168
v_mfma_f32_16x16x32_bf16 v[152:155], a[144:147], v[48:51], v[88:91]
v_exp_f32 v169, v169
v_mfma_f32_16x16x32_bf16 v[156:159], a[144:147], v[64:67], v[92:95]
ds_read_b128 a[168:171], v2 offset:26624
v_cvt_pk_bf16_f32 v216, v168, v169
s_branch Ljoin32
Ltri31:
v_mfma_f32_16x16x32_bf16 v[136:139], a[128:131], v[48:51], v[104:107]
s_add_u32 s82, s82, 0x8000
ds_read_b128 a[160:163], v2 offset:24576
ds_read_b128 a[164:167], v2 offset:25600
v_mfma_f32_16x16x32_bf16 v[140:143], a[128:131], v[64:67], v[92:95]
s_and_b32 s82, s82, 0x1ffff
v_exp_f32 v168, v168
v_mfma_f32_16x16x32_bf16 v[152:155], a[144:147], v[48:51], v[112:115]
v_exp_f32 v169, v169
v_mfma_f32_16x16x32_bf16 v[156:159], a[144:147], v[64:67], v[108:111]
ds_read_b128 a[168:171], v2 offset:26624
v_cvt_pk_bf16_f32 v216, v168, v169
Ljoin32:
v_mfma_f32_16x16x32_bf16 v[136:139], a[132:135], v[52:55], v[136:139]
v_exp_f32 v170, v170
v_mfma_f32_16x16x32_bf16 v[136:139], a[136:139], v[56:59], v[136:139]
buffer_load_dwordx4 v[80:83], v15, s[4:7], s80 offen
v_mfma_f32_16x16x32_bf16 v[136:139], a[140:143], v[60:63], v[136:139]
s_add_u32 s80, s80, 0x4000
ds_read_b128 a[172:175], v2 offset:27648
ds_read_b128 a[176:179], v2 offset:28672
v_mfma_f32_16x16x32_bf16 v[140:143], a[140:143], v[76:79], v[140:143]
v_exp_f32 v171, v171
v_mfma_f32_16x16x32_bf16 v[140:143], a[136:139], v[72:75], v[140:143]
v_exp_f32 v184, v184
v_mfma_f32_16x16x32_bf16 v[140:143], a[132:135], v[68:71], v[140:143]
ds_read_b128 a[180:183], v2 offset:29696
v_cvt_pk_bf16_f32 v217, v170, v171
v_mfma_f32_16x16x32_bf16 v[156:159], a[148:151], v[68:71], v[156:159]
v_exp_f32 v185, v185
v_mfma_f32_16x16x32_bf16 v[156:159], a[152:155], v[72:75], v[156:159]
ds_read_b128 a[184:187], v2 offset:30720
v_cvt_pk_bf16_f32 v218, v184, v185
v_mfma_f32_16x16x32_bf16 v[156:159], a[156:159], v[76:79], v[156:159]
v_exp_f32 v186, v186
v_mfma_f32_16x16x32_bf16 v[152:155], a[156:159], v[60:63], v[152:155]
buffer_load_dwordx4 v[84:87], v15, s[4:7], s80 offen
v_mfma_f32_16x16x32_bf16 v[152:155], a[152:155], v[56:59], v[152:155]
s_add_u32 s80, s80, 0x4000
ds_read_b128 a[188:191], v2 offset:31744
ds_read_b128 a[224:227], v2 offset:8192
v_mfma_f32_16x16x32_bf16 v[152:155], a[148:151], v[52:55], v[152:155]
s_waitcnt lgkmcnt(9)
v_exp_f32 v187, v187
v_mfma_f32_16x16x32_bf16 a[64:67], a[192:195], v[200:203], a[64:67]
v_exp_f32 v172, v172
v_mfma_f32_16x16x32_bf16 a[96:99], a[192:195], v[204:207], a[96:99]
ds_read_b128 a[228:231], v2 offset:9216
v_cvt_pk_bf16_f32 v219, v186, v187
v_mfma_f32_16x16x32_bf16 a[100:103], a[196:199], v[204:207], a[100:103]
v_exp_f32 v173, v173
v_mfma_f32_16x16x32_bf16 a[68:71], a[196:199], v[200:203], a[68:71]
ds_read_b128 a[232:235], v2 offset:10240
v_cvt_pk_bf16_f32 v220, v172, v173
v_mfma_f32_16x16x32_bf16 a[72:75], a[200:203], v[200:203], a[72:75]
v_exp_f32 v174, v174
v_mfma_f32_16x16x32_bf16 a[104:107], a[200:203], v[204:207], a[104:107]
buffer_load_dwordx4 v[96:99], v15, s[4:7], s80 offen
v_mfma_f32_16x16x32_bf16 a[108:111], a[204:207], v[204:207], a[108:111]
s_add_u32 s80, s80, 0x4000
ds_read_b128 a[236:239], v2 offset:11264
v_mfma_f32_16x16x32_bf16 a[76:79], a[204:207], v[200:203], a[76:79]
v_exp_f32 v175, v175
v_mfma_f32_16x16x32_bf16 a[80:83], a[208:211], v[200:203], a[80:83]
ds_read_b128 a[240:243], v2 offset:12288
v_cvt_pk_bf16_f32 v221, v174, v175
v_mfma_f32_16x16x32_bf16 a[112:115], a[208:211], v[204:207], a[112:115]
v_exp_f32 v188, v188
v_mfma_f32_16x16x32_bf16 a[116:119], a[212:215], v[204:207], a[116:119]
ds_read_b128 a[244:247], v2 offset:13312
v_mfma_f32_16x16x32_bf16 a[84:87], a[212:215], v[200:203], a[84:87]
v_exp_f32 v189, v189
v_mfma_f32_16x16x32_bf16 a[88:91], a[216:219], v[200:203], a[88:91]
ds_read_b128 a[248:251], v2 offset:14336
v_cvt_pk_bf16_f32 v222, v188, v189
v_mfma_f32_16x16x32_bf16 a[120:123], a[216:219], v[204:207], a[120:123]
buffer_load_dwordx4 v[100:103], v15, s[4:7], s80 offen
v_mfma_f32_16x16x32_bf16 a[124:127], a[220:223], v[204:207], a[124:127]
v_exp_f32 v190, v190
v_mfma_f32_16x16x32_bf16 a[92:95], a[220:223], v[200:203], a[92:95]
ds_read_b128 a[252:255], v2 offset:15360
v_add_u32 v2, s82, v1
v_mfma_f32_16x16x32_bf16 v[232:235], v[120:123], v[200:203], v[232:235]
s_waitcnt vmcnt(8) lgkmcnt(0)
v_exp_f32 v191, v191
v_mfma_f32_16x16x32_bf16 v[236:239], v[120:123], v[204:207], v[236:239]
s_barrier
v_cvt_pk_bf16_f32 v223, v190, v191
s_cmp_eq_u32 s58, 1
s_cbranch_scc1 Ltri34
s_cmp_gt_u32 s58, 1
s_cbranch_scc1 Lalt33
v_mfma_f32_16x16x32_bf16 v[168:171], a[160:163], v[48:51], v[112:115]
s_add_u32 m0, s92, 8352
v_exp_f32 v136, v136
v_mfma_f32_16x16x32_bf16 v[172:175], a[160:163], v[64:67], v[112:115]
s_add_u32 s72, s93, 0x6
ds_read_b128 a[128:131], v2 offset:16384
ds_read_b128 a[132:135], v2 offset:17408
v_mfma_f32_16x16x32_bf16 v[184:187], a[176:179], v[48:51], v[112:115]
v_exp_f32 v137, v137
v_mfma_f32_16x16x32_bf16 v[188:191], a[176:179], v[64:67], v[112:115]
buffer_load_dwordx4 v1, s[36:39], s72 offen lds
s_branch Ljoin35
Lalt33:
v_mfma_f32_16x16x32_bf16 v[168:171], a[160:163], v[48:51], v[88:91]
s_add_u32 m0, s92, 8352
v_exp_f32 v136, v136
v_mfma_f32_16x16x32_bf16 v[172:175], a[160:163], v[64:67], v[92:95]
s_add_u32 s72, s93, 0x6
ds_read_b128 a[128:131], v2 offset:16384
ds_read_b128 a[132:135], v2 offset:17408
v_mfma_f32_16x16x32_bf16 v[184:187], a[176:179], v[48:51], v[88:91]
v_exp_f32 v137, v137
v_mfma_f32_16x16x32_bf16 v[188:191], a[176:179], v[64:67], v[92:95]
buffer_load_dwordx4 v1, s[36:39], s72 offen lds
s_branch Ljoin35
Ltri34:
v_mfma_f32_16x16x32_bf16 v[168:171], a[160:163], v[48:51], v[104:107]
s_add_u32 m0, s92, 8352
v_exp_f32 v136, v136
v_mfma_f32_16x16x32_bf16 v[172:175], a[160:163], v[64:67], v[92:95]
s_add_u32 s72, s93, 0x6
ds_read_b128 a[128:131], v2 offset:16384
ds_read_b128 a[132:135], v2 offset:17408
v_mfma_f32_16x16x32_bf16 v[184:187], a[176:179], v[48:51], v[112:115]
v_exp_f32 v137, v137
v_mfma_f32_16x16x32_bf16 v[188:191], a[176:179], v[64:67], v[108:111]
buffer_load_dwordx4 v1, s[36:39], s72 offen lds
Ljoin35:
v_mfma_f32_16x16x32_bf16 v[168:171], a[164:167], v[52:55], v[168:171]
v_exp_f32 v138, v138
v_mfma_f32_16x16x32_bf16 v[168:171], a[168:171], v[56:59], v[168:171]
ds_read_b128 a[136:139], v2 offset:18432
v_cvt_pk_bf16_f32 v200, v136, v137
v_mfma_f32_16x16x32_bf16 v[168:171], a[172:175], v[60:63], v[168:171]
v_exp_f32 v139, v139
v_mfma_f32_16x16x32_bf16 v[172:175], a[172:175], v[76:79], v[172:175]
ds_read_b128 a[140:143], v2 offset:19456
v_cvt_pk_bf16_f32 v201, v138, v139
v_mfma_f32_16x16x32_bf16 v[172:175], a[168:171], v[72:75], v[172:175]
v_exp_f32 v152, v152
v_mfma_f32_16x16x32_bf16 v[172:175], a[164:167], v[68:71], v[172:175]
ds_read_b128 a[144:147], v2 offset:20480
ds_read_b128 a[148:151], v2 offset:21504
v_mfma_f32_16x16x32_bf16 v[188:191], a[180:183], v[68:71], v[188:191]
v_exp_f32 v153, v153
v_mfma_f32_16x16x32_bf16 v[188:191], a[184:187], v[72:75], v[188:191]
buffer_load_dwordx4 v1, s[36:39], s72 offen offset:1024 lds
v_mfma_f32_16x16x32_bf16 v[188:191], a[188:191], v[76:79], v[188:191]
v_exp_f32 v154, v154
v_mfma_f32_16x16x32_bf16 v[184:187], a[188:191], v[60:63], v[184:187]
ds_read_b128 a[152:155], v2 offset:22528
v_cvt_pk_bf16_f32 v202, v152, v153
v_mfma_f32_16x16x32_bf16 v[184:187], a[184:187], v[56:59], v[184:187]
v_exp_f32 v155, v155
v_mfma_f32_16x16x32_bf16 v[184:187], a[180:183], v[52:55], v[184:187]
s_waitcnt lgkmcnt(7)
ds_read_b128 a[156:159], v2 offset:23552
v_cvt_pk_bf16_f32 v203, v154, v155
v_mfma_f32_16x16x32_bf16 a[64:67], a[224:227], v[216:219], a[64:67]
v_exp_f32 v140, v140
v_mfma_f32_16x16x32_bf16 a[96:99], a[224:227], v[220:223], a[96:99]
ds_read_b128 a[192:195], v2 offset:0
ds_read_b128 a[196:199], v2 offset:1024
v_mfma_f32_16x16x32_bf16 a[100:103], a[228:231], v[220:223], a[100:103]
buffer_load_dwordx4 v1, s[36:39], s72 offen offset:2048 lds
v_mfma_f32_16x16x32_bf16 a[68:71], a[228:231], v[216:219], a[68:71]
v_exp_f32 v141, v141
v_mfma_f32_16x16x32_bf16 a[72:75], a[232:235], v[216:219], a[72:75]
v_exp_f32 v142, v142
v_mfma_f32_16x16x32_bf16 a[104:107], a[232:235], v[220:223], a[104:107]
ds_read_b128 a[200:203], v2 offset:2048
v_cvt_pk_bf16_f32 v204, v140, v141
v_mfma_f32_16x16x32_bf16 a[108:111], a[236:239], v[220:223], a[108:111]
v_exp_f32 v143, v143
v_mfma_f32_16x16x32_bf16 a[76:79], a[236:239], v[216:219], a[76:79]
ds_read_b128 a[204:207], v2 offset:3072
v_cvt_pk_bf16_f32 v205, v142, v143
v_mfma_f32_16x16x32_bf16 a[80:83], a[240:243], v[216:219], a[80:83]
buffer_load_dwordx4 v1, s[36:39], s72 offen offset:3072 lds
v_mfma_f32_16x16x32_bf16 a[112:115], a[240:243], v[220:223], a[112:115]
s_add_u32 m0, s62, 0
v_exp_f32 v156, v156
v_mfma_f32_16x16x32_bf16 a[116:119], a[244:247], v[220:223], a[116:119]
s_add_u32 s72, s93, 0x3000000
ds_read_b128 a[208:211], v2 offset:4096
ds_read_b128 a[212:215], v2 offset:5120
v_mfma_f32_16x16x32_bf16 a[84:87], a[244:247], v[216:219], a[84:87]
v_exp_f32 v157, v157
v_mfma_f32_16x16x32_bf16 a[88:91], a[248:251], v[216:219], a[88:91]
v_exp_f32 v158, v158
v_mfma_f32_16x16x32_bf16 a[120:123], a[248:251], v[220:223], a[120:123]
ds_read_b128 a[216:219], v2 offset:6144
v_cvt_pk_bf16_f32 v206, v156, v157
v_mfma_f32_16x16x32_bf16 a[124:127], a[252:255], v[220:223], a[124:127]
buffer_load_dwordx4 v1, s[44:47], s72 offen sc1 lds
v_mfma_f32_16x16x32_bf16 a[92:95], a[252:255], v[216:219], a[92:95]
v_exp_f32 v159, v159
v_mfma_f32_16x16x32_bf16 v[232:235], v[120:123], v[216:219], v[232:235]
ds_read_b128 a[220:223], v2 offset:7168
v_cvt_pk_bf16_f32 v207, v158, v159
v_mfma_f32_16x16x32_bf16 v[236:239], v[120:123], v[220:223], v[236:239]
s_waitcnt lgkmcnt(8)
s_cmp_eq_u32 s58, 2
s_cbranch_scc1 Ltri37
s_cmp_gt_u32 s58, 2
s_cbranch_scc1 Lalt36
v_mfma_f32_16x16x32_bf16 v[136:139], a[128:131], v[48:51], v[112:115]
s_add_u32 s82, s82, 0x8000
ds_read_b128 a[160:163], v2 offset:24576
ds_read_b128 a[164:167], v2 offset:25600
v_mfma_f32_16x16x32_bf16 v[140:143], a[128:131], v[64:67], v[112:115]
s_and_b32 s82, s82, 0x1ffff
v_exp_f32 v168, v168
v_mfma_f32_16x16x32_bf16 v[152:155], a[144:147], v[48:51], v[112:115]
v_exp_f32 v169, v169
v_mfma_f32_16x16x32_bf16 v[156:159], a[144:147], v[64:67], v[112:115]
buffer_load_dwordx4 v1, s[44:47], s72 offen offset:1024 sc1 lds
s_branch Ljoin38
Lalt36:
v_mfma_f32_16x16x32_bf16 v[136:139], a[128:131], v[48:51], v[88:91]
s_add_u32 s82, s82, 0x8000
ds_read_b128 a[160:163], v2 offset:24576
ds_read_b128 a[164:167], v2 offset:25600
v_mfma_f32_16x16x32_bf16 v[140:143], a[128:131], v[64:67], v[92:95]
s_and_b32 s82, s82, 0x1ffff
v_exp_f32 v168, v168
v_mfma_f32_16x16x32_bf16 v[152:155], a[144:147], v[48:51], v[88:91]
v_exp_f32 v169, v169
v_mfma_f32_16x16x32_bf16 v[156:159], a[144:147], v[64:67], v[92:95]
buffer_load_dwordx4 v1, s[44:47], s72 offen offset:1024 sc1 lds
s_branch Ljoin38
Ltri37:
v_mfma_f32_16x16x32_bf16 v[136:139], a[128:131], v[48:51], v[104:107]
s_add_u32 s82, s82, 0x8000
ds_read_b128 a[160:163], v2 offset:24576
ds_read_b128 a[164:167], v2 offset:25600
v_mfma_f32_16x16x32_bf16 v[140:143], a[128:131], v[64:67], v[92:95]
s_and_b32 s82, s82, 0x1ffff
v_exp_f32 v168, v168
v_mfma_f32_16x16x32_bf16 v[152:155], a[144:147], v[48:51], v[112:115]
v_exp_f32 v169, v169
v_mfma_f32_16x16x32_bf16 v[156:159], a[144:147], v[64:67], v[108:111]
buffer_load_dwordx4 v1, s[44:47], s72 offen offset:1024 sc1 lds
Ljoin38:
v_mfma_f32_16x16x32_bf16 v[136:139], a[132:135], v[52:55], v[136:139]
ds_read_b128 a[168:171], v2 offset:26624
v_cvt_pk_bf16_f32 v216, v168, v169
v_mfma_f32_16x16x32_bf16 v[136:139], a[136:139], v[56:59], v[136:139]
v_exp_f32 v170, v170
v_mfma_f32_16x16x32_bf16 v[136:139], a[140:143], v[60:63], v[136:139]
ds_read_b128 a[172:175], v2 offset:27648
ds_read_b128 a[176:179], v2 offset:28672
v_mfma_f32_16x16x32_bf16 v[140:143], a[140:143], v[76:79], v[140:143]
v_exp_f32 v171, v171
v_mfma_f32_16x16x32_bf16 v[140:143], a[136:139], v[72:75], v[140:143]
v_exp_f32 v184, v184
v_mfma_f32_16x16x32_bf16 v[140:143], a[132:135], v[68:71], v[140:143]
ds_read_b128 a[180:183], v2 offset:29696
v_cvt_pk_bf16_f32 v217, v170, v171
v_mfma_f32_16x16x32_bf16 v[156:159], a[148:151], v[68:71], v[156:159]
buffer_load_dwordx4 v1, s[44:47], s72 offen offset:2048 sc1 lds
v_mfma_f32_16x16x32_bf16 v[156:159], a[152:155], v[72:75], v[156:159]
v_exp_f32 v185, v185
v_mfma_f32_16x16x32_bf16 v[156:159], a[156:159], v[76:79], v[156:159]
ds_read_b128 a[184:187], v2 offset:30720
v_cvt_pk_bf16_f32 v218, v184, v185
v_mfma_f32_16x16x32_bf16 v[152:155], a[156:159], v[60:63], v[152:155]
v_exp_f32 v186, v186
v_mfma_f32_16x16x32_bf16 v[152:155], a[152:155], v[56:59], v[152:155]
ds_read_b128 a[188:191], v2 offset:31744
ds_read_b128 a[224:227], v2 offset:8192
v_mfma_f32_16x16x32_bf16 v[152:155], a[148:151], v[52:55], v[152:155]
s_waitcnt lgkmcnt(9)
v_exp_f32 v187, v187
v_mfma_f32_16x16x32_bf16 a[64:67], a[192:195], v[200:203], a[64:67]
v_exp_f32 v172, v172
v_mfma_f32_16x16x32_bf16 a[96:99], a[192:195], v[204:207], a[96:99]
buffer_load_dwordx4 v1, s[44:47], s72 offen offset:3072 sc1 lds
v_mfma_f32_16x16x32_bf16 a[100:103], a[196:199], v[204:207], a[100:103]
s_add_u32 m0, s92, 32
ds_read_b128 a[228:231], v2 offset:9216
v_cvt_pk_bf16_f32 v219, v186, v187
v_mfma_f32_16x16x32_bf16 a[68:71], a[196:199], v[200:203], a[68:71]
s_add_u32 s72, s93, 0x0
v_exp_f32 v173, v173
v_mfma_f32_16x16x32_bf16 a[72:75], a[200:203], v[200:203], a[72:75]
ds_read_b128 a[232:235], v2 offset:10240
v_cvt_pk_bf16_f32 v220, v172, v173
v_mfma_f32_16x16x32_bf16 a[104:107], a[200:203], v[204:207], a[104:107]
v_exp_f32 v174, v174
v_mfma_f32_16x16x32_bf16 a[108:111], a[204:207], v[204:207], a[108:111]
ds_read_b128 a[236:239], v2 offset:11264
ds_read_b128 a[240:243], v2 offset:12288
v_mfma_f32_16x16x32_bf16 a[76:79], a[204:207], v[200:203], a[76:79]
v_exp_f32 v175, v175
v_mfma_f32_16x16x32_bf16 a[80:83], a[208:211], v[200:203], a[80:83]
buffer_load_dwordx4 v1, s[36:39], s72 offen lds
v_mfma_f32_16x16x32_bf16 a[112:115], a[208:211], v[204:207], a[112:115]
v_exp_f32 v188, v188
v_mfma_f32_16x16x32_bf16 a[116:119], a[212:215], v[204:207], a[116:119]
ds_read_b128 a[244:247], v2 offset:13312
v_cvt_pk_bf16_f32 v221, v174, v175
v_mfma_f32_16x16x32_bf16 a[84:87], a[212:215], v[200:203], a[84:87]
v_exp_f32 v189, v189
v_mfma_f32_16x16x32_bf16 a[88:91], a[216:219], v[200:203], a[88:91]
ds_read_b128 a[248:251], v2 offset:14336
v_cvt_pk_bf16_f32 v222, v188, v189
v_mfma_f32_16x16x32_bf16 a[120:123], a[216:219], v[204:207], a[120:123]
v_exp_f32 v190, v190
v_mfma_f32_16x16x32_bf16 a[124:127], a[220:223], v[204:207], a[124:127]
buffer_load_dwordx4 v1, s[36:39], s72 offen offset:1024 lds
v_mfma_f32_16x16x32_bf16 a[92:95], a[220:223], v[200:203], a[92:95]
ds_read_b128 a[252:255], v2 offset:15360
v_add_u32 v2, s82, v1
v_mfma_f32_16x16x32_bf16 v[232:235], v[120:123], v[200:203], v[232:235]
s_waitcnt vmcnt(14) lgkmcnt(8)
v_exp_f32 v191, v191
v_mfma_f32_16x16x32_bf16 v[236:239], v[120:123], v[204:207], v[236:239]
s_barrier
v_cvt_pk_bf16_f32 v223, v190, v191
LHT3:
s_cmp_eq_u32 s58, 3
s_cbranch_scc1 Ltri46
v_mfma_f32_16x16x32_bf16 v[168:171], a[160:163], v[48:51], v[112:115]
v_exp_f32 v136, v136
v_mfma_f32_16x16x32_bf16 v[172:175], a[160:163], v[64:67], v[112:115]
ds_read_b128 a[192:195], v2 offset:0
v_mfma_f32_16x16x32_bf16 v[184:187], a[176:179], v[48:51], v[112:115]
v_exp_f32 v137, v137
v_mfma_f32_16x16x32_bf16 v[188:191], a[176:179], v[64:67], v[112:115]
buffer_load_dwordx4 v1, s[36:39], s72 offen offset:2048 lds
s_branch Ljoin47
Lalt45:
Ltri46:
v_mfma_f32_16x16x32_bf16 v[168:171], a[160:163], v[48:51], v[104:107]
v_exp_f32 v136, v136
v_mfma_f32_16x16x32_bf16 v[172:175], a[160:163], v[64:67], v[92:95]
ds_read_b128 a[192:195], v2 offset:0
v_mfma_f32_16x16x32_bf16 v[184:187], a[176:179], v[48:51], v[112:115]
v_exp_f32 v137, v137
v_mfma_f32_16x16x32_bf16 v[188:191], a[176:179], v[64:67], v[108:111]
buffer_load_dwordx4 v1, s[36:39], s72 offen offset:2048 lds
Ljoin47:
v_mfma_f32_16x16x32_bf16 v[168:171], a[164:167], v[52:55], v[168:171]
v_exp_f32 v138, v138
v_mfma_f32_16x16x32_bf16 v[168:171], a[168:171], v[56:59], v[168:171]
ds_read_b128 a[196:199], v2 offset:1024
v_cvt_pk_bf16_f32 v200, v136, v137
v_mfma_f32_16x16x32_bf16 v[168:171], a[172:175], v[60:63], v[168:171]
v_exp_f32 v139, v139
v_mfma_f32_16x16x32_bf16 v[172:175], a[172:175], v[76:79], v[172:175]
v_exp_f32 v152, v152
v_mfma_f32_16x16x32_bf16 v[172:175], a[168:171], v[72:75], v[172:175]
ds_read_b128 a[200:203], v2 offset:2048
v_cvt_pk_bf16_f32 v201, v138, v139
v_mfma_f32_16x16x32_bf16 v[172:175], a[164:167], v[68:71], v[172:175]
buffer_load_dwordx4 v1, s[36:39], s72 offen offset:3072 lds
v_mfma_f32_16x16x32_bf16 v[188:191], a[180:183], v[68:71], v[188:191]
s_add_u32 m0, s92, 4192
v_exp_f32 v153, v153
v_mfma_f32_16x16x32_bf16 v[188:191], a[184:187], v[72:75], v[188:191]
s_add_u32 s72, s93, 0x4
v_exp_f32 v154, v154
v_mfma_f32_16x16x32_bf16 v[188:191], a[188:191], v[76:79], v[188:191]
ds_read_b128 a[204:207], v2 offset:3072
v_cvt_pk_bf16_f32 v202, v152, v153
v_mfma_f32_16x16x32_bf16 v[184:187], a[188:191], v[60:63], v[184:187]
buffer_load_dwordx4 v1, s[36:39], s72 offen lds
v_mfma_f32_16x16x32_bf16 v[184:187], a[184:187], v[56:59], v[184:187]
v_exp_f32 v155, v155
v_mfma_f32_16x16x32_bf16 v[184:187], a[180:183], v[52:55], v[184:187]
s_waitcnt lgkmcnt(4)
v_exp_f32 v140, v140
v_mfma_f32_16x16x32_bf16 a[64:67], a[224:227], v[216:219], a[64:67]
ds_read_b128 a[208:211], v2 offset:4096
v_cvt_pk_bf16_f32 v203, v154, v155
v_mfma_f32_16x16x32_bf16 a[96:99], a[224:227], v[220:223], a[96:99]
v_exp_f32 v141, v141
v_mfma_f32_16x16x32_bf16 a[100:103], a[228:231], v[220:223], a[100:103]
buffer_load_dwordx4 v1, s[36:39], s72 offen offset:1024 lds
v_mfma_f32_16x16x32_bf16 a[68:71], a[228:231], v[216:219], a[68:71]
v_exp_f32 v142, v142
v_mfma_f32_16x16x32_bf16 a[72:75], a[232:235], v[216:219], a[72:75]
ds_read_b128 a[212:215], v2 offset:5120
v_cvt_pk_bf16_f32 v204, v140, v141
v_mfma_f32_16x16x32_bf16 a[104:107], a[232:235], v[220:223], a[104:107]
v_exp_f32 v143, v143
v_mfma_f32_16x16x32_bf16 a[108:111], a[236:239], v[220:223], a[108:111]
v_exp_f32 v156, v156
v_mfma_f32_16x16x32_bf16 a[76:79], a[236:239], v[216:219], a[76:79]
ds_read_b128 a[216:219], v2 offset:6144
v_cvt_pk_bf16_f32 v205, v142, v143
v_mfma_f32_16x16x32_bf16 a[80:83], a[240:243], v[216:219], a[80:83]
buffer_load_dwordx4 v1, s[36:39], s72 offen offset:2048 lds
v_mfma_f32_16x16x32_bf16 a[112:115], a[240:243], v[220:223], a[112:115]
v_exp_f32 v157, v157
v_mfma_f32_16x16x32_bf16 a[116:119], a[244:247], v[220:223], a[116:119]
v_exp_f32 v158, v158
v_mfma_f32_16x16x32_bf16 a[84:87], a[244:247], v[216:219], a[84:87]
ds_read_b128 a[220:223], v2 offset:7168
v_cvt_pk_bf16_f32 v206, v156, v157
v_mfma_f32_16x16x32_bf16 a[88:91], a[248:251], v[216:219], a[88:91]
buffer_load_dwordx4 v1, s[36:39], s72 offen offset:3072 lds
v_mfma_f32_16x16x32_bf16 a[120:123], a[248:251], v[220:223], a[120:123]
v_exp_f32 v159, v159
v_mfma_f32_16x16x32_bf16 a[124:127], a[252:255], v[220:223], a[124:127]
v_cvt_pk_bf16_f32 v207, v158, v159
v_mfma_f32_16x16x32_bf16 a[92:95], a[252:255], v[216:219], a[92:95]
v_mfma_f32_16x16x32_bf16 v[232:235], v[120:123], v[216:219], v[232:235]
v_mfma_f32_16x16x32_bf16 v[236:239], v[120:123], v[220:223], v[236:239]
s_waitcnt lgkmcnt(0)
v_mfma_f32_16x16x32_bf16 a[64:67], a[192:195], v[200:203], a[64:67]
s_add_u32 s82, s82, 0x8000
ds_read_b128 a[224:227], v2 offset:8192
ds_read_b128 a[228:231], v2 offset:9216
v_mfma_f32_16x16x32_bf16 a[96:99], a[192:195], v[204:207], a[96:99]
s_and_b32 s82, s82, 0x1ffff
v_exp_f32 v168, v168
v_mfma_f32_16x16x32_bf16 a[100:103], a[196:199], v[204:207], a[100:103]
v_exp_f32 v169, v169
v_mfma_f32_16x16x32_bf16 a[68:71], a[196:199], v[200:203], a[68:71]
v_exp_f32 v170, v170
v_mfma_f32_16x16x32_bf16 a[72:75], a[200:203], v[200:203], a[72:75]
v_exp_f32 v171, v171
v_mfma_f32_16x16x32_bf16 a[104:107], a[200:203], v[204:207], a[104:107]
ds_read_b128 a[232:235], v2 offset:10240
ds_read_b128 a[236:239], v2 offset:11264
v_mfma_f32_16x16x32_bf16 a[108:111], a[204:207], v[204:207], a[108:111]
v_exp_f32 v184, v184
v_mfma_f32_16x16x32_bf16 a[76:79], a[204:207], v[200:203], a[76:79]
ds_read_b128 a[240:243], v2 offset:12288
ds_read_b128 a[244:247], v2 offset:13312
v_mfma_f32_16x16x32_bf16 a[80:83], a[208:211], v[200:203], a[80:83]
ds_read_b128 a[248:251], v2 offset:14336
ds_read_b128 a[252:255], v2 offset:15360
v_mfma_f32_16x16x32_bf16 a[112:115], a[208:211], v[204:207], a[112:115]
v_cvt_pk_bf16_f32 v216, v168, v169
v_cvt_pk_bf16_f32 v217, v170, v171
v_mfma_f32_16x16x32_bf16 a[116:119], a[212:215], v[204:207], a[116:119]
v_exp_f32 v185, v185
v_mfma_f32_16x16x32_bf16 a[84:87], a[212:215], v[200:203], a[84:87]
v_exp_f32 v186, v186
v_mfma_f32_16x16x32_bf16 a[88:91], a[216:219], v[200:203], a[88:91]
v_exp_f32 v187, v187
v_mfma_f32_16x16x32_bf16 a[120:123], a[216:219], v[204:207], a[120:123]
v_exp_f32 v172, v172
v_mfma_f32_16x16x32_bf16 a[124:127], a[220:223], v[204:207], a[124:127]
v_cvt_pk_bf16_f32 v218, v184, v185
v_cvt_pk_bf16_f32 v219, v186, v187
v_mfma_f32_16x16x32_bf16 a[92:95], a[220:223], v[200:203], a[92:95]
v_exp_f32 v173, v173
v_mfma_f32_16x16x32_bf16 v[232:235], v[120:123], v[200:203], v[232:235]
s_waitcnt lgkmcnt(0)
v_exp_f32 v174, v174
v_mfma_f32_16x16x32_bf16 v[236:239], v[120:123], v[204:207], v[236:239]
s_barrier
v_exp_f32 v175, v175
v_add_u32 v2, s82, v1
v_cvt_pk_bf16_f32 v220, v172, v173
v_exp_f32 v188, v188
v_cvt_pk_bf16_f32 v221, v174, v175
v_exp_f32 v189, v189
v_exp_f32 v190, v190
v_cvt_pk_bf16_f32 v222, v188, v189
v_exp_f32 v191, v191
s_nop 0
v_cvt_pk_bf16_f32 v223, v190, v191
v_mfma_f32_16x16x32_bf16 a[64:67], a[224:227], v[216:219], a[64:67]
s_lshl_b32 s95, s75, 20
ds_write_b64 v5, v[12:13]
v_mov_b32 v240, 0
v_mfma_f32_16x16x32_bf16 a[96:99], a[224:227], v[220:223], a[96:99]
s_lshl_b32 s74, s58, 18
v_mov_b32 v241, 0
v_mfma_f32_16x16x32_bf16 a[100:103], a[228:231], v[220:223], a[100:103]
s_add_u32 s95, s95, s74
ds_write_b64 v14, v[240:241]
v_mfma_f32_16x16x32_bf16 a[68:71], a[228:231], v[216:219], a[68:71]
s_waitcnt vmcnt(0)
ds_read_b128 a[192:195], v7 offset:3584
ds_read_b64 a[128:129], v6 offset:0
v_mfma_f32_16x16x32_bf16 a[72:75], a[232:235], v[216:219], a[72:75]
s_add_u32 s95, s95, 0x2000000
ds_read_b64 a[130:131], v6 offset:8
ds_read_b128 a[196:199], v7 offset:3072
v_mfma_f32_16x16x32_bf16 a[104:107], a[232:235], v[220:223], a[104:107]
s_sub_u32 s74, 15, s75
ds_read_b64 a[132:133], v6 offset:512
ds_read_b64 a[134:135], v6 offset:520
v_mfma_f32_16x16x32_bf16 a[108:111], a[236:239], v[220:223], a[108:111]
s_min_u32 s74, s74, s75
ds_read_b128 a[200:203], v7 offset:2560
ds_read_b64 a[136:137], v6 offset:1024
v_mfma_f32_16x16x32_bf16 a[76:79], a[236:239], v[216:219], a[76:79]
s_lshl_b32 s74, s74, 7
ds_read_b64 a[138:139], v6 offset:1032
ds_read_b128 a[204:207], v7 offset:2048
v_mfma_f32_16x16x32_bf16 a[80:83], a[240:243], v[216:219], a[80:83]
s_add_u32 s74, s74, 0x3810000
ds_read_b64 a[140:141], v6 offset:1536
ds_read_b64 a[142:143], v6 offset:1544
v_mfma_f32_16x16x32_bf16 a[112:115], a[240:243], v[220:223], a[112:115]
s_add_u32 s78, s59, 4
ds_read_b128 a[208:211], v7 offset:1536
ds_read_b64 a[144:145], v6 offset:2048
v_mfma_f32_16x16x32_bf16 a[116:119], a[244:247], v[220:223], a[116:119]
s_and_b32 s78, s78, 28
ds_read_b64 a[146:147], v6 offset:2056
ds_read_b128 a[212:215], v7 offset:1024
v_mfma_f32_16x16x32_bf16 a[84:87], a[244:247], v[216:219], a[84:87]
s_add_u32 s79, s59, 8
ds_read_b64 a[148:149], v6 offset:2560
ds_read_b64 a[150:151], v6 offset:2568
v_mfma_f32_16x16x32_bf16 a[88:91], a[248:251], v[216:219], a[88:91]
s_and_b32 s79, s79, 28
ds_read_b128 a[216:219], v7 offset:512
ds_read_b64 a[152:153], v6 offset:3072
v_mfma_f32_16x16x32_bf16 a[120:123], a[248:251], v[220:223], a[120:123]
ds_read_b64 a[154:155], v6 offset:3080
ds_read_b128 a[220:223], v7 offset:0
v_mfma_f32_16x16x32_bf16 a[124:127], a[252:255], v[220:223], a[124:127]
ds_read_b64 a[156:157], v6 offset:3584
ds_read_b64 a[158:159], v6 offset:3592
v_mfma_f32_16x16x32_bf16 a[92:95], a[252:255], v[216:219], a[92:95]
v_mfma_f32_16x16x32_bf16 v[232:235], v[120:123], v[216:219], v[232:235]
v_mfma_f32_16x16x32_bf16 v[236:239], v[120:123], v[220:223], v[236:239]
s_waitcnt lgkmcnt(0)
v_mfma_f32_16x16x32_bf16 v[128:131], v[8:11], a[192:195], 0
v_mfma_f32_16x16x32_bf16 v[128:131], a[128:131], a[192:195], v[128:131]
v_mfma_f32_16x16x32_bf16 v[132:135], v[8:11], a[196:199], 0
ds_read_b128 a[224:227], v7 offset:3648
ds_read_b64 a[160:161], v6 offset:64
v_mfma_f32_16x16x32_bf16 v[132:135], a[128:131], a[196:199], v[132:135]
v_mfma_f32_16x16x32_bf16 v[132:135], a[132:135], a[192:195], v[132:135]
v_rcp_f32 v232, v232
v_mfma_f32_16x16x32_bf16 v[136:139], v[8:11], a[200:203], 0
ds_read_b64 a[162:163], v6 offset:72
ds_read_b128 a[228:231], v7 offset:3136
v_mfma_f32_16x16x32_bf16 v[136:139], a[128:131], a[200:203], v[136:139]
v_rcp_f32 v236, v236
v_mfma_f32_16x16x32_bf16 v[136:139], a[132:135], a[196:199], v[136:139]
s_lshl_b32 s73, s59, 12
v_mfma_f32_16x16x32_bf16 v[136:139], a[136:139], a[192:195], v[136:139]
s_add_u32 s73, s73, 0x2000000
ds_read_b64 a[164:165], v6 offset:576
ds_read_b64 a[166:167], v6 offset:584
v_mfma_f32_16x16x32_bf16 v[140:143], v[8:11], a[204:207], 0
s_lshl_b32 s70, s68, 2
v_mfma_f32_16x16x32_bf16 v[140:143], a[128:131], a[204:207], v[140:143]
s_add_u32 s71, s61, 0
v_mfma_f32_16x16x32_bf16 v[140:143], a[132:135], a[200:203], v[140:143]
s_and_b32 s71, s71, 3
ds_read_b128 a[232:235], v7 offset:2624
ds_read_b64 a[168:169], v6 offset:1088
v_mfma_f32_16x16x32_bf16 v[140:143], a[136:139], a[196:199], v[140:143]
s_add_u32 s71, s71, s78
v_mfma_f32_16x16x32_bf16 v[140:143], a[140:143], a[192:195], v[140:143]
s_lshl_b32 s71, s71, 18
v_mfma_f32_16x16x32_bf16 v[144:147], v[8:11], a[208:211], 0
s_add_u32 s71, s71, s94
ds_read_b64 a[170:171], v6 offset:1096
ds_read_b128 a[236:239], v7 offset:2112
v_mfma_f32_16x16x32_bf16 v[144:147], a[128:131], a[208:211], v[144:147]
s_add_u32 m0, s77, 0
v_mfma_f32_16x16x32_bf16 v[144:147], a[132:135], a[204:207], v[144:147]
s_add_u32 s72, s71, 0
buffer_load_dwordx4 v15, s[24:27], s72 offen lds
v_mfma_f32_16x16x32_bf16 v[144:147], a[136:139], a[200:203], v[144:147]
s_add_u32 s70, s70, s73
ds_read_b64 a[172:173], v6 offset:1600
ds_read_b64 a[174:175], v6 offset:1608
v_accvgpr_read_b32 v240, a64
v_mfma_f32_16x16x32_bf16 v[144:147], a[140:143], a[196:199], v[144:147]
v_accvgpr_read_b32 v241, a65
v_accvgpr_read_b32 v242, a66
v_accvgpr_read_b32 v243, a67
v_mfma_f32_16x16x32_bf16 v[144:147], a[144:147], a[192:195], v[144:147]
v_accvgpr_read_b32 v244, a68
v_accvgpr_read_b32 v245, a69
v_accvgpr_read_b32 v246, a70
v_mfma_f32_16x16x32_bf16 v[148:151], v[8:11], a[212:215], 0
s_add_u32 s72, s71, 15360
ds_read_b128 a[240:243], v7 offset:1600
ds_read_b64 a[176:177], v6 offset:2112
v_accvgpr_read_b32 v247, a71
v_mfma_f32_16x16x32_bf16 v[148:151], a[128:131], a[212:215], v[148:151]
buffer_load_dwordx4 v15, s[24:27], s72 offen offset:1024 lds
v_mul_f32 v240, v240, v232
v_mfma_f32_16x16x32_bf16 v[148:151], a[132:135], a[208:211], v[148:151]
v_mul_f32 v241, v241, v232
v_mul_f32 v242, v242, v232
v_mul_f32 v243, v243, v232
v_mfma_f32_16x16x32_bf16 v[148:151], a[136:139], a[204:207], v[148:151]
ds_read_b64 a[178:179], v6 offset:2120
ds_read_b128 a[244:247], v7 offset:1088
v_mul_f32 v244, v244, v232
v_mfma_f32_16x16x32_bf16 v[148:151], a[140:143], a[200:203], v[148:151]
v_mul_f32 v245, v245, v232
v_mul_f32 v246, v246, v232
v_mul_f32 v247, v247, v232
v_mfma_f32_16x16x32_bf16 v[148:151], a[144:147], a[196:199], v[148:151]
v_cvt_pk_bf16_f32 v240, v240, v241
v_cvt_pk_bf16_f32 v241, v242, v243
v_cvt_pk_bf16_f32 v242, v244, v245
v_mfma_f32_16x16x32_bf16 v[148:151], a[148:151], a[192:195], v[148:151]
ds_read_b64 a[180:181], v6 offset:2624
ds_read_b64 a[182:183], v6 offset:2632
v_cvt_pk_bf16_f32 v243, v246, v247
v_mfma_f32_16x16x32_bf16 v[152:155], v[8:11], a[216:219], 0
buffer_store_dwordx4 v[240:243], v1, s[44:47], s70 offen sc1
v_mfma_f32_16x16x32_bf16 v[152:155], a[128:131], a[216:219], v[152:155]
v_accvgpr_read_b32 v248, a72
v_accvgpr_read_b32 v249, a73
v_accvgpr_read_b32 v250, a74
v_mfma_f32_16x16x32_bf16 v[152:155], a[132:135], a[212:215], v[152:155]
ds_read_b128 a[248:251], v7 offset:576
ds_read_b64 a[184:185], v6 offset:3136
v_accvgpr_read_b32 v251, a75
v_mfma_f32_16x16x32_bf16 v[152:155], a[136:139], a[208:211], v[152:155]
s_add_u32 s72, s71, 30720
buffer_load_dwordx4 v15, s[24:27], s72 offen offset:2048 lds
v_accvgpr_read_b32 v252, a76
v_mfma_f32_16x16x32_bf16 v[152:155], a[140:143], a[204:207], v[152:155]
v_accvgpr_read_b32 v253, a77
v_accvgpr_read_b32 v254, a78
v_accvgpr_read_b32 v255, a79
v_mfma_f32_16x16x32_bf16 v[152:155], a[144:147], a[200:203], v[152:155]
ds_read_b64 a[186:187], v6 offset:3144
ds_read_b128 a[252:255], v7 offset:64
v_mul_f32 v248, v248, v232
v_mfma_f32_16x16x32_bf16 v[152:155], a[148:151], a[196:199], v[152:155]
v_mul_f32 v249, v249, v232
v_mul_f32 v250, v250, v232
v_mul_f32 v251, v251, v232
v_mfma_f32_16x16x32_bf16 v[152:155], a[152:155], a[192:195], v[152:155]
v_mul_f32 v252, v252, v232
v_mul_f32 v253, v253, v232
v_mul_f32 v254, v254, v232
v_mfma_f32_16x16x32_bf16 v[156:159], v[8:11], a[220:223], 0
ds_read_b64 a[188:189], v6 offset:3648
ds_read_b64 a[190:191], v6 offset:3656
v_mul_f32 v255, v255, v232
v_mfma_f32_16x16x32_bf16 v[156:159], a[128:131], a[220:223], v[156:159]
v_cvt_pk_bf16_f32 v248, v248, v249
v_cvt_pk_bf16_f32 v249, v250, v251
v_cvt_pk_bf16_f32 v250, v252, v253
v_mfma_f32_16x16x32_bf16 v[156:159], a[132:135], a[216:219], v[156:159]
v_cvt_pk_bf16_f32 v251, v254, v255
v_mfma_f32_16x16x32_bf16 v[156:159], a[136:139], a[212:215], v[156:159]
buffer_store_dwordx4 v[248:251], v1, s[44:47], s70 offen offset:1024 sc1
v_mfma_f32_16x16x32_bf16 v[156:159], a[140:143], a[208:211], v[156:159]
v_accvgpr_read_b32 v240, a80
v_accvgpr_read_b32 v241, a81
v_accvgpr_read_b32 v242, a82
v_mfma_f32_16x16x32_bf16 v[156:159], a[144:147], a[204:207], v[156:159]
s_add_u32 s72, s71, 46080
buffer_load_dwordx4 v15, s[24:27], s72 offen offset:3072 lds
v_accvgpr_read_b32 v243, a83
v_mfma_f32_16x16x32_bf16 v[156:159], a[148:151], a[200:203], v[156:159]
v_accvgpr_read_b32 v244, a84
v_accvgpr_read_b32 v245, a85
v_accvgpr_read_b32 v246, a86
v_mfma_f32_16x16x32_bf16 v[156:159], a[152:155], a[196:199], v[156:159]
v_accvgpr_read_b32 v247, a87
v_mul_f32 v240, v240, v232
v_mul_f32 v241, v241, v232
v_mfma_f32_16x16x32_bf16 v[156:159], a[156:159], a[192:195], v[156:159]
s_waitcnt lgkmcnt(0)
v_mul_f32 v242, v242, v232
v_mul_f32 v243, v243, v232
v_mul_f32 v244, v244, v232
v_mfma_f32_16x16x32_bf16 v[128:131], a[160:163], a[224:227], v[128:131]
ds_read_b128 a[192:195], v7 offset:3712
ds_read_b64 a[128:129], v6 offset:128
v_mul_f32 v245, v245, v232
v_mfma_f32_16x16x32_bf16 v[132:135], a[164:167], a[224:227], v[132:135]
v_mul_f32 v246, v246, v232
v_mul_f32 v247, v247, v232
v_cvt_pk_bf16_f32 v240, v240, v241
v_mfma_f32_16x16x32_bf16 v[132:135], a[160:163], a[228:231], v[132:135]
ds_read_b64 a[130:131], v6 offset:136
ds_read_b128 a[196:199], v7 offset:3200
v_cvt_pk_bf16_f32 v241, v242, v243
v_mfma_f32_16x16x32_bf16 v[136:139], a[160:163], a[232:235], v[136:139]
v_cvt_pk_bf16_f32 v242, v244, v245
v_cvt_pk_bf16_f32 v243, v246, v247
v_mfma_f32_16x16x32_bf16 v[136:139], a[164:167], a[228:231], v[136:139]
buffer_store_dwordx4 v[240:243], v1, s[44:47], s70 offen offset:2048 sc1
v_mfma_f32_16x16x32_bf16 v[136:139], a[168:171], a[224:227], v[136:139]
ds_read_b64 a[132:133], v6 offset:640
ds_read_b64 a[134:135], v6 offset:648
v_accvgpr_read_b32 v248, a88
v_mfma_f32_16x16x32_bf16 v[140:143], a[172:175], a[224:227], v[140:143]
s_add_u32 s71, s61, 1
v_accvgpr_read_b32 v249, a89
v_accvgpr_read_b32 v250, a90
v_accvgpr_read_b32 v251, a91
v_mfma_f32_16x16x32_bf16 v[140:143], a[168:171], a[228:231], v[140:143]
s_and_b32 s71, s71, 3
ds_read_b128 a[200:203], v7 offset:2688
ds_read_b64 a[136:137], v6 offset:1152
v_accvgpr_read_b32 v252, a92
v_mfma_f32_16x16x32_bf16 v[140:143], a[164:167], a[232:235], v[140:143]
s_add_u32 s71, s71, s78
v_accvgpr_read_b32 v253, a93
v_accvgpr_read_b32 v254, a94
v_accvgpr_read_b32 v255, a95
v_mfma_f32_16x16x32_bf16 v[140:143], a[160:163], a[236:239], v[140:143]
s_lshl_b32 s71, s71, 18
v_mul_f32 v248, v248, v232
v_mul_f32 v249, v249, v232
v_mul_f32 v250, v250, v232
v_mfma_f32_16x16x32_bf16 v[144:147], a[160:163], a[240:243], v[144:147]
s_add_u32 s71, s71, s94
ds_read_b64 a[138:139], v6 offset:1160
ds_read_b128 a[204:207], v7 offset:2176
v_mul_f32 v251, v251, v232
v_mfma_f32_16x16x32_bf16 v[144:147], a[164:167], a[236:239], v[144:147]
s_add_u32 m0, s77, 16384
v_mul_f32 v252, v252, v232
v_mul_f32 v253, v253, v232
v_mul_f32 v254, v254, v232
v_mfma_f32_16x16x32_bf16 v[144:147], a[168:171], a[232:235], v[144:147]
s_add_u32 s72, s71, 0
ds_read_b64 a[140:141], v6 offset:1664
ds_read_b64 a[142:143], v6 offset:1672
v_mul_f32 v255, v255, v232
v_mfma_f32_16x16x32_bf16 v[144:147], a[172:175], a[228:231], v[144:147]
buffer_load_dwordx4 v15, s[24:27], s72 offen lds
v_cvt_pk_bf16_f32 v248, v248, v249
v_mfma_f32_16x16x32_bf16 v[144:147], a[176:179], a[224:227], v[144:147]
v_cvt_pk_bf16_f32 v249, v250, v251
v_cvt_pk_bf16_f32 v250, v252, v253
v_cvt_pk_bf16_f32 v251, v254, v255
v_mfma_f32_16x16x32_bf16 v[148:151], a[180:183], a[224:227], v[148:151]
ds_read_b128 a[208:211], v7 offset:1664
ds_read_b64 a[144:145], v6 offset:2176
v_mfma_f32_16x16x32_bf16 v[148:151], a[176:179], a[228:231], v[148:151]
s_add_u32 s72, s71, 15360
buffer_load_dwordx4 v15, s[24:27], s72 offen offset:1024 lds
v_mfma_f32_16x16x32_bf16 v[148:151], a[172:175], a[232:235], v[148:151]
buffer_store_dwordx4 v[248:251], v1, s[44:47], s70 offen offset:3072 sc1
v_mfma_f32_16x16x32_bf16 v[148:151], a[168:171], a[236:239], v[148:151]
s_add_u32 s70, s70, 0x20000
ds_read_b64 a[146:147], v6 offset:2184
ds_read_b128 a[212:215], v7 offset:1152
v_accvgpr_read_b32 v240, a96
v_mfma_f32_16x16x32_bf16 v[148:151], a[164:167], a[240:243], v[148:151]
v_accvgpr_read_b32 v241, a97
v_accvgpr_read_b32 v242, a98
v_accvgpr_read_b32 v243, a99
v_mfma_f32_16x16x32_bf16 v[148:151], a[160:163], a[244:247], v[148:151]
ds_read_b64 a[148:149], v6 offset:2688
ds_read_b64 a[150:151], v6 offset:2696
v_accvgpr_read_b32 v244, a100
v_mfma_f32_16x16x32_bf16 v[152:155], a[160:163], a[248:251], v[152:155]
v_accvgpr_read_b32 v245, a101
v_accvgpr_read_b32 v246, a102
v_accvgpr_read_b32 v247, a103
v_mfma_f32_16x16x32_bf16 v[152:155], a[164:167], a[244:247], v[152:155]
v_mul_f32 v240, v240, v236
v_mul_f32 v241, v241, v236
v_mul_f32 v242, v242, v236
v_mfma_f32_16x16x32_bf16 v[152:155], a[168:171], a[240:243], v[152:155]
ds_read_b128 a[216:219], v7 offset:640
ds_read_b64 a[152:153], v6 offset:3200
v_mul_f32 v243, v243, v236
v_mfma_f32_16x16x32_bf16 v[152:155], a[172:175], a[236:239], v[152:155]
v_mul_f32 v244, v244, v236
v_mul_f32 v245, v245, v236
v_mul_f32 v246, v246, v236
v_mfma_f32_16x16x32_bf16 v[152:155], a[176:179], a[232:235], v[152:155]
ds_read_b64 a[154:155], v6 offset:3208
ds_read_b128 a[220:223], v7 offset:128
v_mul_f32 v247, v247, v236
v_mfma_f32_16x16x32_bf16 v[152:155], a[180:183], a[228:231], v[152:155]
s_add_u32 s72, s71, 30720
buffer_load_dwordx4 v15, s[24:27], s72 offen offset:2048 lds
v_cvt_pk_bf16_f32 v240, v240, v241
v_mfma_f32_16x16x32_bf16 v[152:155], a[184:187], a[224:227], v[152:155]
v_cvt_pk_bf16_f32 v241, v242, v243
v_cvt_pk_bf16_f32 v242, v244, v245
v_cvt_pk_bf16_f32 v243, v246, v247
v_mfma_f32_16x16x32_bf16 v[156:159], a[188:191], a[224:227], v[156:159]
ds_read_b64 a[156:157], v6 offset:3712
ds_read_b64 a[158:159], v6 offset:3720
v_mfma_f32_16x16x32_bf16 v[156:159], a[184:187], a[228:231], v[156:159]
buffer_store_dwordx4 v[240:243], v1, s[44:47], s70 offen sc1
v_mfma_f32_16x16x32_bf16 v[156:159], a[180:183], a[232:235], v[156:159]
v_accvgpr_read_b32 v248, a104
v_accvgpr_read_b32 v249, a105
v_accvgpr_read_b32 v250, a106
v_mfma_f32_16x16x32_bf16 v[156:159], a[176:179], a[236:239], v[156:159]
v_accvgpr_read_b32 v251, a107
v_accvgpr_read_b32 v252, a108
v_accvgpr_read_b32 v253, a109
v_mfma_f32_16x16x32_bf16 v[156:159], a[172:175], a[240:243], v[156:159]
v_accvgpr_read_b32 v254, a110
v_accvgpr_read_b32 v255, a111
v_mul_f32 v248, v248, v236
v_mfma_f32_16x16x32_bf16 v[156:159], a[168:171], a[244:247], v[156:159]
v_mul_f32 v249, v249, v236
v_mul_f32 v250, v250, v236
v_mul_f32 v251, v251, v236
v_mfma_f32_16x16x32_bf16 v[156:159], a[164:167], a[248:251], v[156:159]
v_mul_f32 v252, v252, v236
v_mul_f32 v253, v253, v236
v_mul_f32 v254, v254, v236
v_mfma_f32_16x16x32_bf16 v[156:159], a[160:163], a[252:255], v[156:159]
s_waitcnt lgkmcnt(0)
v_mul_f32 v255, v255, v236
v_cvt_pk_bf16_f32 v248, v248, v249
v_cvt_pk_bf16_f32 v249, v250, v251
v_mfma_f32_16x16x32_bf16 v[128:131], a[128:131], a[192:195], v[128:131]
s_add_u32 s72, s71, 46080
ds_read_b128 a[224:227], v7 offset:3776
ds_read_b64 a[160:161], v6 offset:192
v_cvt_pk_bf16_f32 v250, v252, v253
v_mfma_f32_16x16x32_bf16 v[132:135], a[132:135], a[192:195], v[132:135]
buffer_load_dwordx4 v15, s[24:27], s72 offen offset:3072 lds
v_cvt_pk_bf16_f32 v251, v254, v255
v_mfma_f32_16x16x32_bf16 v[132:135], a[128:131], a[196:199], v[132:135]
ds_read_b64 a[162:163], v6 offset:200
ds_read_b128 a[228:231], v7 offset:3264
v_mfma_f32_16x16x32_bf16 v[136:139], a[128:131], a[200:203], v[136:139]
buffer_store_dwordx4 v[248:251], v1, s[44:47], s70 offen offset:1024 sc1
v_mfma_f32_16x16x32_bf16 v[136:139], a[132:135], a[196:199], v[136:139]
v_accvgpr_read_b32 v240, a112
v_accvgpr_read_b32 v241, a113
v_accvgpr_read_b32 v242, a114
v_mfma_f32_16x16x32_bf16 v[136:139], a[136:139], a[192:195], v[136:139]
ds_read_b64 a[164:165], v6 offset:704
ds_read_b64 a[166:167], v6 offset:712
v_accvgpr_read_b32 v243, a115
v_mfma_f32_16x16x32_bf16 v[140:143], a[140:143], a[192:195], v[140:143]
v_accvgpr_read_b32 v244, a116
v_accvgpr_read_b32 v245, a117
v_accvgpr_read_b32 v246, a118
v_mfma_f32_16x16x32_bf16 v[140:143], a[136:139], a[196:199], v[140:143]
ds_read_b128 a[232:235], v7 offset:2752
ds_read_b64 a[168:169], v6 offset:1216
v_accvgpr_read_b32 v247, a119
v_mfma_f32_16x16x32_bf16 v[140:143], a[132:135], a[200:203], v[140:143]
v_mul_f32 v240, v240, v236
v_mul_f32 v241, v241, v236
v_mul_f32 v242, v242, v236
v_mfma_f32_16x16x32_bf16 v[140:143], a[128:131], a[204:207], v[140:143]
v_mul_f32 v243, v243, v236
v_mul_f32 v244, v244, v236
v_mul_f32 v245, v245, v236
v_mfma_f32_16x16x32_bf16 v[144:147], a[128:131], a[208:211], v[144:147]
s_add_u32 s71, s61, 2
ds_read_b64 a[170:171], v6 offset:1224
ds_read_b128 a[236:239], v7 offset:2240
v_mul_f32 v246, v246, v236
v_mfma_f32_16x16x32_bf16 v[144:147], a[132:135], a[204:207], v[144:147]
s_and_b32 s71, s71, 3
v_mul_f32 v247, v247, v236
v_cvt_pk_bf16_f32 v240, v240, v241
v_cvt_pk_bf16_f32 v241, v242, v243
v_mfma_f32_16x16x32_bf16 v[144:147], a[136:139], a[200:203], v[144:147]
s_add_u32 s71, s71, s78
ds_read_b64 a[172:173], v6 offset:1728
ds_read_b64 a[174:175], v6 offset:1736
v_cvt_pk_bf16_f32 v242, v244, v245
v_mfma_f32_16x16x32_bf16 v[144:147], a[140:143], a[196:199], v[144:147]
s_lshl_b32 s71, s71, 18
v_cvt_pk_bf16_f32 v243, v246, v247
v_mfma_f32_16x16x32_bf16 v[144:147], a[144:147], a[192:195], v[144:147]
s_add_u32 s71, s71, s94
buffer_store_dwordx4 v[240:243], v1, s[44:47], s70 offen offset:2048 sc1
v_mfma_f32_16x16x32_bf16 v[148:151], a[148:151], a[192:195], v[148:151]
s_add_u32 m0, s77, 32768
ds_read_b128 a[240:243], v7 offset:1728
ds_read_b64 a[176:177], v6 offset:2240
v_accvgpr_read_b32 v248, a120
v_mfma_f32_16x16x32_bf16 v[148:151], a[144:147], a[196:199], v[148:151]
s_add_u32 s72, s71, 0
buffer_load_dwordx4 v15, s[24:27], s72 offen lds
v_accvgpr_read_b32 v249, a121
v_mfma_f32_16x16x32_bf16 v[148:151], a[140:143], a[200:203], v[148:151]
v_accvgpr_read_b32 v250, a122
v_accvgpr_read_b32 v251, a123
v_accvgpr_read_b32 v252, a124
v_mfma_f32_16x16x32_bf16 v[148:151], a[136:139], a[204:207], v[148:151]
ds_read_b64 a[178:179], v6 offset:2248
ds_read_b128 a[244:247], v7 offset:1216
v_accvgpr_read_b32 v253, a125
v_mfma_f32_16x16x32_bf16 v[148:151], a[132:135], a[208:211], v[148:151]
v_accvgpr_read_b32 v254, a126
v_accvgpr_read_b32 v255, a127
v_mul_f32 v248, v248, v236
v_mfma_f32_16x16x32_bf16 v[148:151], a[128:131], a[212:215], v[148:151]
s_add_u32 s72, s71, 15360
ds_read_b64 a[180:181], v6 offset:2752
ds_read_b64 a[182:183], v6 offset:2760
v_mul_f32 v249, v249, v236
v_mfma_f32_16x16x32_bf16 v[152:155], a[128:131], a[216:219], v[152:155]
buffer_load_dwordx4 v15, s[24:27], s72 offen offset:1024 lds
v_mul_f32 v250, v250, v236
v_mfma_f32_16x16x32_bf16 v[152:155], a[132:135], a[212:215], v[152:155]
v_mul_f32 v251, v251, v236
v_mul_f32 v252, v252, v236
v_mul_f32 v253, v253, v236
v_mfma_f32_16x16x32_bf16 v[152:155], a[136:139], a[208:211], v[152:155]
ds_read_b128 a[248:251], v7 offset:704
ds_read_b64 a[184:185], v6 offset:3264
v_mul_f32 v254, v254, v236
v_mfma_f32_16x16x32_bf16 v[152:155], a[140:143], a[204:207], v[152:155]
v_mul_f32 v255, v255, v236
v_cvt_pk_bf16_f32 v248, v248, v249
v_cvt_pk_bf16_f32 v249, v250, v251
v_mfma_f32_16x16x32_bf16 v[152:155], a[144:147], a[200:203], v[152:155]
ds_read_b64 a[186:187], v6 offset:3272
ds_read_b128 a[252:255], v7 offset:192
v_cvt_pk_bf16_f32 v250, v252, v253
v_mfma_f32_16x16x32_bf16 v[152:155], a[148:151], a[196:199], v[152:155]
v_cvt_pk_bf16_f32 v251, v254, v255
v_lshrrev_b32 v2, 4, v0
v_lshlrev_b32 v2, 10, v2
v_mfma_f32_16x16x32_bf16 v[152:155], a[152:155], a[192:195], v[152:155]
s_add_u32 s82, s59, 4
buffer_store_dwordx4 v[248:251], v1, s[44:47], s70 offen offset:3072 sc1
v_mfma_f32_16x16x32_bf16 v[156:159], a[156:159], a[192:195], v[156:159]
s_mov_b32 s73, 0x5d800000
ds_read_b64 a[188:189], v6 offset:3776
ds_read_b64 a[190:191], v6 offset:3784
v_add_f32 v227, v226, v230
v_mfma_f32_16x16x32_bf16 v[156:159], a[152:155], a[196:199], v[156:159]
s_and_b32 s82, s82, 28
v_add_f32 v231, v234, v238
v_add_f32 v227, v227, v231
v_cmp_nlt_f32 vcc, v227, s73
v_mfma_f32_16x16x32_bf16 v[156:159], a[148:151], a[200:203], v[156:159]
s_add_u32 s72, s71, 30720
buffer_load_dwordx4 v15, s[24:27], s72 offen offset:2048 lds
v_mfma_f32_16x16x32_bf16 v[156:159], a[144:147], a[204:207], v[156:159]
s_lshl_b32 s73, s58, 2
v_mfma_f32_16x16x32_bf16 v[156:159], a[140:143], a[208:211], v[156:159]
s_add_u32 s73, s73, 163328
v_mov_b32 v231, s73
v_mfma_f32_16x16x32_bf16 v[156:159], a[136:139], a[212:215], v[156:159]
s_or_b32 s73, vcc_lo, vcc_hi
v_mfma_f32_16x16x32_bf16 v[156:159], a[132:135], a[216:219], v[156:159]
s_min_u32 s73, s73, 1
v_mov_b32 v227, s73
v_mfma_f32_16x16x32_bf16 v[156:159], a[128:131], a[220:223], v[156:159]
s_waitcnt lgkmcnt(0)
ds_write_b32 v231, v227
v_mfma_f32_16x16x32_bf16 v[128:131], a[160:163], a[224:227], v[128:131]
s_lshl_b32 s82, s82, 10
ds_read_b128 a[192:195], v7 offset:3840
ds_read_b64 a[128:129], v6 offset:256
v_mfma_f32_16x16x32_bf16 v[132:135], a[164:167], a[224:227], v[132:135]
s_add_u32 s82, s82, s74
buffer_load_dword v3, v2, s[44:47], s82 offen sc1
v_mfma_f32_16x16x32_bf16 v[132:135], a[160:163], a[228:231], v[132:135]
ds_read_b64 a[130:131], v6 offset:264
ds_read_b128 a[196:199], v7 offset:3328
v_mfma_f32_16x16x32_bf16 v[136:139], a[160:163], a[232:235], v[136:139]
v_mfma_f32_16x16x32_bf16 v[136:139], a[164:167], a[228:231], v[136:139]
s_add_u32 s72, s71, 46080
buffer_load_dwordx4 v15, s[24:27], s72 offen offset:3072 lds
v_mfma_f32_16x16x32_bf16 v[136:139], a[168:171], a[224:227], v[136:139]
ds_read_b64 a[132:133], v6 offset:768
ds_read_b64 a[134:135], v6 offset:776
v_mfma_f32_16x16x32_bf16 v[140:143], a[172:175], a[224:227], v[140:143]
v_mfma_f32_16x16x32_bf16 v[140:143], a[168:171], a[228:231], v[140:143]
ds_read_b128 a[200:203], v7 offset:2816
ds_read_b64 a[136:137], v6 offset:1280
v_mfma_f32_16x16x32_bf16 v[140:143], a[164:167], a[232:235], v[140:143]
v_mfma_f32_16x16x32_bf16 v[140:143], a[160:163], a[236:239], v[140:143]
v_mfma_f32_16x16x32_bf16 v[144:147], a[160:163], a[240:243], v[144:147]
ds_read_b64 a[138:139], v6 offset:1288
ds_read_b128 a[204:207], v7 offset:2304
v_mfma_f32_16x16x32_bf16 v[144:147], a[164:167], a[236:239], v[144:147]
v_mfma_f32_16x16x32_bf16 v[144:147], a[168:171], a[232:235], v[144:147]
ds_read_b64 a[140:141], v6 offset:1792
ds_read_b64 a[142:143], v6 offset:1800
v_mfma_f32_16x16x32_bf16 v[144:147], a[172:175], a[228:231], v[144:147]
v_mfma_f32_16x16x32_bf16 v[144:147], a[176:179], a[224:227], v[144:147]
s_add_u32 s71, s61, 3
v_mfma_f32_16x16x32_bf16 v[148:151], a[180:183], a[224:227], v[148:151]
s_and_b32 s71, s71, 3
ds_read_b128 a[208:211], v7 offset:1792
ds_read_b64 a[144:145], v6 offset:2304
v_mfma_f32_16x16x32_bf16 v[148:151], a[176:179], a[228:231], v[148:151]
s_add_u32 s71, s71, s78
v_mfma_f32_16x16x32_bf16 v[148:151], a[172:175], a[232:235], v[148:151]
s_lshl_b32 s71, s71, 18
v_mfma_f32_16x16x32_bf16 v[148:151], a[168:171], a[236:239], v[148:151]
s_add_u32 s71, s71, s94
ds_read_b64 a[146:147], v6 offset:2312
ds_read_b128 a[212:215], v7 offset:1280
v_mfma_f32_16x16x32_bf16 v[148:151], a[164:167], a[240:243], v[148:151]
s_add_u32 m0, s77, 49152
v_mfma_f32_16x16x32_bf16 v[148:151], a[160:163], a[244:247], v[148:151]
s_add_u32 s72, s71, 0
ds_read_b64 a[148:149], v6 offset:2816
ds_read_b64 a[150:151], v6 offset:2824
v_mfma_f32_16x16x32_bf16 v[152:155], a[160:163], a[248:251], v[152:155]
s_waitcnt vmcnt(3) lgkmcnt(15)
buffer_load_dwordx4 v15, s[24:27], s72 offen lds
v_mfma_f32_16x16x32_bf16 v[152:155], a[164:167], a[244:247], v[152:155]
s_barrier
v_mov_b32 v244, 163328
v_mfma_f32_16x16x32_bf16 v[152:155], a[168:171], a[240:243], v[152:155]
ds_read_b128 a[216:219], v7 offset:768
ds_read_b64 a[152:153], v6 offset:3328
ds_read_b128 v[240:243], v244
v_mfma_f32_16x16x32_bf16 v[152:155], a[172:175], a[236:239], v[152:155]
s_add_u32 s72, s71, 15360
buffer_load_dwordx4 v15, s[24:27], s72 offen offset:1024 lds
v_mfma_f32_16x16x32_bf16 v[152:155], a[176:179], a[232:235], v[152:155]
ds_read_b64 a[154:155], v6 offset:3336
ds_read_b128 a[220:223], v7 offset:256
v_mfma_f32_16x16x32_bf16 v[152:155], a[180:183], a[228:231], v[152:155]
v_mfma_f32_16x16x32_bf16 v[152:155], a[184:187], a[224:227], v[152:155]
v_mfma_f32_16x16x32_bf16 v[156:159], a[188:191], a[224:227], v[156:159]
s_waitcnt lgkmcnt(2)
ds_read_b64 a[156:157], v6 offset:3840
ds_read_b64 a[158:159], v6 offset:3848
v_or3_b32 v240, v240, v241, v242
v_mfma_f32_16x16x32_bf16 v[156:159], a[184:187], a[228:231], v[156:159]
v_or_b32 v240, v240, v243
v_mfma_f32_16x16x32_bf16 v[156:159], a[180:183], a[232:235], v[156:159]
v_cmp_lt_u32 vcc, s86, v240
s_cbranch_vccnz Lslow
v_mfma_f32_16x16x32_bf16 v[156:159], a[176:179], a[236:239], v[156:159]
v_or_b32 v240, s58, v0
v_mov_b32 v241, 2
v_min_u32 v240, 1, v240
v_mfma_f32_16x16x32_bf16 v[156:159], a[172:175], a[240:243], v[156:159]
v_lshlrev_b32 v240, 30, v240
v_mfma_f32_16x16x32_bf16 v[156:159], a[168:171], a[244:247], v[156:159]
buffer_store_dword v241, v240, s[44:47], s91 offen sc1
v_mfma_f32_16x16x32_bf16 v[156:159], a[164:167], a[248:251], v[156:159]
s_add_u32 s72, s71, 30720
buffer_load_dwordx4 v15, s[24:27], s72 offen offset:2048 lds
v_mfma_f32_16x16x32_bf16 v[156:159], a[160:163], a[252:255], v[156:159]
s_waitcnt lgkmcnt(0)
v_mfma_f32_16x16x32_bf16 v[128:131], a[128:131], a[192:195], v[128:131]
s_add_u32 s80, s93, 0x3400000
ds_read_b128 a[224:227], v7 offset:3904
ds_read_b64 a[160:161], v6 offset:320
v_and_b32 v166, 7, v0
v_mfma_f32_16x16x32_bf16 v[132:135], a[132:135], a[192:195], v[132:135]
v_lshlrev_b32 v166, 4, v166
v_bfe_u32 v112, v0, 3, 1
v_lshl_add_u32 v166, v112, 8, v166
v_mfma_f32_16x16x32_bf16 v[132:135], a[128:131], a[196:199], v[132:135]
ds_read_b64 a[162:163], v6 offset:328
ds_read_b128 a[228:231], v7 offset:3392
v_bfe_u32 v112, v0, 4, 1
v_mfma_f32_16x16x32_bf16 v[136:139], a[128:131], a[200:203], v[136:139]
v_lshl_add_u32 v166, v112, 7, v166
v_lshrrev_b32 v112, 5, v0
v_lshl_add_u32 v166, v112, 9, v166
v_mfma_f32_16x16x32_bf16 v[136:139], a[132:135], a[196:199], v[136:139]
v_and_b32 v112, 15, v0
v_lshrrev_b32 v113, 2, v0
v_bfe_u32 v114, v0, 3, 2
v_mfma_f32_16x16x32_bf16 v[136:139], a[136:139], a[192:195], v[136:139]
ds_read_b64 a[164:165], v6 offset:832
ds_read_b64 a[166:167], v6 offset:840
v_and_b32 v115, 3, v0
v_mfma_f32_16x16x32_bf16 v[140:143], a[140:143], a[192:195], v[140:143]
v_lshlrev_b32 v8, 7, v113
v_lshl_add_u32 v8, v114, 5, v8
v_lshl_add_u32 v8, v115, 3, v8
v_mfma_f32_16x16x32_bf16 v[140:143], a[136:139], a[196:199], v[140:143]
ds_read_b128 a[232:235], v7 offset:2880
ds_read_b64 a[168:169], v6 offset:1344
v_add_u32 v8, s77, v8
v_mfma_f32_16x16x32_bf16 v[140:143], a[132:135], a[200:203], v[140:143]
s_add_u32 s72, s71, 46080
buffer_load_dwordx4 v15, s[24:27], s72 offen offset:3072 lds
s_waitcnt vmcnt(6)
v_cmp_gt_u32 vcc, 2, v3
s_or_b32 s81, vcc_lo, vcc_hi
s_cselect_b32 s81, 0x40000000, 0
v_or_b32 v4, s81, v1
v_mfma_f32_16x16x32_bf16 v[140:143], a[128:131], a[204:207], v[140:143]
s_add_u32 s69, s61, 0
s_and_b32 s69, s69, 3
s_add_u32 s69, s69, s78
s_lshl_b32 s69, s69, 12
s_add_u32 s69, s69, s95
buffer_load_dwordx4 a[0:3], v4, s[44:47], s69 offen sc1
v_mfma_f32_16x16x32_bf16 v[144:147], a[128:131], a[208:211], v[144:147]
ds_read_b64 a[170:171], v6 offset:1352
ds_read_b128 a[236:239], v7 offset:2368
v_subrev_u32 v8, s64, v8
v_xor_b32 v9, 32, v8
v_mfma_f32_16x16x32_bf16 v[144:147], a[132:135], a[204:207], v[144:147]
v_xor_b32 v10, 64, v8
v_xor_b32 v11, 0x60, v8
v_lshlrev_b32 v5, 8, v113
v_and_b32 v114, 1, v0
v_mfma_f32_16x16x32_bf16 v[144:147], a[136:139], a[200:203], v[144:147]
ds_read_b64 a[172:173], v6 offset:1856
ds_read_b64 a[174:175], v6 offset:1864
v_lshl_add_u32 v5, v114, 7, v5
v_bfe_u32 v114, v0, 1, 1
v_mfma_f32_16x16x32_bf16 v[144:147], a[140:143], a[196:199], v[144:147]
buffer_load_dwordx4 a[4:7], v4, s[44:47], s69 offen offset:1024 sc1
v_lshl_add_u32 v5, v114, 3, v5
v_mov_b32 v114, s58
v_mfma_f32_16x16x32_bf16 v[144:147], a[144:147], a[192:195], v[144:147]
v_lshl_add_u32 v5, v114, 5, v5
v_add_u32 v5, 147456, v5
v_bfe_u32 v114, v0, 1, 2
v_lshrrev_b32 v115, 4, v0
v_mfma_f32_16x16x32_bf16 v[148:151], a[148:151], a[192:195], v[148:151]
ds_read_b128 a[240:243], v7 offset:1856
ds_read_b64 a[176:177], v6 offset:2368
v_lshlrev_b32 v116, 7, v112
v_lshl_add_u32 v116, v114, 5, v116
v_mfma_f32_16x16x32_bf16 v[148:151], a[144:147], a[196:199], v[148:151]
v_lshl_add_u32 v116, v115, 3, v116
v_add_u32 v116, s64, v116
v_add_u32 v116, 131072, v116
v_xor_b32 v117, 32, v116
v_mfma_f32_16x16x32_bf16 v[148:151], a[140:143], a[200:203], v[148:151]
v_xor_b32 v118, 64, v116
v_xor_b32 v119, 0x60, v116
v_mfma_f32_16x16x32_bf16 v[148:151], a[136:139], a[204:207], v[148:151]
ds_read_b64 a[178:179], v6 offset:2376
ds_read_b128 a[244:247], v7 offset:1344
buffer_load_dwordx4 a[8:11], v4, s[44:47], s69 offen offset:2048 sc1
v_mfma_f32_16x16x32_bf16 v[148:151], a[132:135], a[208:211], v[148:151]
v_mfma_f32_16x16x32_bf16 v[148:151], a[128:131], a[212:215], v[148:151]
ds_read_b64 a[180:181], v6 offset:2880
ds_read_b64 a[182:183], v6 offset:2888
v_mfma_f32_16x16x32_bf16 v[152:155], a[128:131], a[216:219], v[152:155]
v_mfma_f32_16x16x32_bf16 v[152:155], a[132:135], a[212:215], v[152:155]
v_mfma_f32_16x16x32_bf16 v[152:155], a[136:139], a[208:211], v[152:155]
ds_read_b128 a[248:251], v7 offset:832
ds_read_b64 a[184:185], v6 offset:3392
buffer_load_dwordx4 a[12:15], v4, s[44:47], s69 offen offset:3072 sc1
v_mfma_f32_16x16x32_bf16 v[152:155], a[140:143], a[204:207], v[152:155]
v_mfma_f32_16x16x32_bf16 v[152:155], a[144:147], a[200:203], v[152:155]
ds_read_b64 a[186:187], v6 offset:3400
ds_read_b128 a[252:255], v7 offset:320
v_mfma_f32_16x16x32_bf16 v[152:155], a[148:151], a[196:199], v[152:155]
v_mfma_f32_16x16x32_bf16 v[152:155], a[152:155], a[192:195], v[152:155]
v_mfma_f32_16x16x32_bf16 v[156:159], a[156:159], a[192:195], v[156:159]
ds_read_b64 a[188:189], v6 offset:3904
ds_read_b64 a[190:191], v6 offset:3912
s_add_u32 s69, s69, 0x20000
buffer_load_dwordx4 a[16:19], v4, s[44:47], s69 offen sc1
v_mfma_f32_16x16x32_bf16 v[156:159], a[152:155], a[196:199], v[156:159]
v_mfma_f32_16x16x32_bf16 v[156:159], a[148:151], a[200:203], v[156:159]
v_mfma_f32_16x16x32_bf16 v[156:159], a[144:147], a[204:207], v[156:159]
v_mfma_f32_16x16x32_bf16 v[156:159], a[140:143], a[208:211], v[156:159]
buffer_load_dwordx4 a[20:23], v4, s[44:47], s69 offen offset:1024 sc1
v_mfma_f32_16x16x32_bf16 v[156:159], a[136:139], a[212:215], v[156:159]
v_mfma_f32_16x16x32_bf16 v[156:159], a[132:135], a[216:219], v[156:159]
v_mfma_f32_16x16x32_bf16 v[156:159], a[128:131], a[220:223], v[156:159]
s_waitcnt lgkmcnt(0)
v_mfma_f32_16x16x32_bf16 v[128:131], a[160:163], a[224:227], v[128:131]
ds_read_b128 a[192:195], v7 offset:3968
ds_read_b64 a[128:129], v6 offset:384
v_mfma_f32_16x16x32_bf16 v[132:135], a[164:167], a[224:227], v[132:135]
buffer_load_dwordx4 a[24:27], v4, s[44:47], s69 offen offset:2048 sc1
v_mfma_f32_16x16x32_bf16 v[132:135], a[160:163], a[228:231], v[132:135]
ds_read_b64 a[130:131], v6 offset:392
ds_read_b128 a[196:199], v7 offset:3456
v_mfma_f32_16x16x32_bf16 v[136:139], a[160:163], a[232:235], v[136:139]
v_mfma_f32_16x16x32_bf16 v[136:139], a[164:167], a[228:231], v[136:139]
v_mfma_f32_16x16x32_bf16 v[136:139], a[168:171], a[224:227], v[136:139]
ds_read_b64 a[132:133], v6 offset:896
ds_read_b64 a[134:135], v6 offset:904
v_mfma_f32_16x16x32_bf16 v[140:143], a[172:175], a[224:227], v[140:143]
buffer_load_dwordx4 a[28:31], v4, s[44:47], s69 offen offset:3072 sc1
v_mfma_f32_16x16x32_bf16 v[140:143], a[168:171], a[228:231], v[140:143]
ds_read_b128 a[200:203], v7 offset:2944
ds_read_b64 a[136:137], v6 offset:1408
v_mfma_f32_16x16x32_bf16 v[140:143], a[164:167], a[232:235], v[140:143]
v_mfma_f32_16x16x32_bf16 v[140:143], a[160:163], a[236:239], v[140:143]
v_mfma_f32_16x16x32_bf16 v[144:147], a[160:163], a[240:243], v[144:147]
ds_read_b64 a[138:139], v6 offset:1416
ds_read_b128 a[204:207], v7 offset:2432
v_mfma_f32_16x16x32_bf16 v[144:147], a[164:167], a[236:239], v[144:147]
s_add_u32 s69, s61, 1
s_and_b32 s69, s69, 3
s_add_u32 s69, s69, s78
s_lshl_b32 s69, s69, 12
s_add_u32 s69, s69, s95
buffer_load_dwordx4 a[32:35], v4, s[44:47], s69 offen sc1
v_mfma_f32_16x16x32_bf16 v[144:147], a[168:171], a[232:235], v[144:147]
ds_read_b64 a[140:141], v6 offset:1920
ds_read_b64 a[142:143], v6 offset:1928
v_mfma_f32_16x16x32_bf16 v[144:147], a[172:175], a[228:231], v[144:147]
v_mfma_f32_16x16x32_bf16 v[144:147], a[176:179], a[224:227], v[144:147]
v_mfma_f32_16x16x32_bf16 v[148:151], a[180:183], a[224:227], v[148:151]
ds_read_b128 a[208:211], v7 offset:1920
ds_read_b64 a[144:145], v6 offset:2432
v_mfma_f32_16x16x32_bf16 v[148:151], a[176:179], a[228:231], v[148:151]
buffer_load_dwordx4 a[36:39], v4, s[44:47], s69 offen offset:1024 sc1
v_mfma_f32_16x16x32_bf16 v[148:151], a[172:175], a[232:235], v[148:151]
v_mfma_f32_16x16x32_bf16 v[148:151], a[168:171], a[236:239], v[148:151]
ds_read_b64 a[146:147], v6 offset:2440
ds_read_b128 a[212:215], v7 offset:1408
v_mfma_f32_16x16x32_bf16 v[148:151], a[164:167], a[240:243], v[148:151]
v_mfma_f32_16x16x32_bf16 v[148:151], a[160:163], a[244:247], v[148:151]
ds_read_b64 a[148:149], v6 offset:2944
ds_read_b64 a[150:151], v6 offset:2952
buffer_load_dwordx4 a[40:43], v4, s[44:47], s69 offen offset:2048 sc1
v_mfma_f32_16x16x32_bf16 v[152:155], a[160:163], a[248:251], v[152:155]
v_mfma_f32_16x16x32_bf16 v[152:155], a[164:167], a[244:247], v[152:155]
v_mfma_f32_16x16x32_bf16 v[152:155], a[168:171], a[240:243], v[152:155]
ds_read_b128 a[216:219], v7 offset:896
ds_read_b64 a[152:153], v6 offset:3456
v_mfma_f32_16x16x32_bf16 v[152:155], a[172:175], a[236:239], v[152:155]
v_mfma_f32_16x16x32_bf16 v[152:155], a[176:179], a[232:235], v[152:155]
ds_read_b64 a[154:155], v6 offset:3464
ds_read_b128 a[220:223], v7 offset:384
buffer_load_dwordx4 a[44:47], v4, s[44:47], s69 offen offset:3072 sc1
v_mfma_f32_16x16x32_bf16 v[152:155], a[180:183], a[228:231], v[152:155]
v_mfma_f32_16x16x32_bf16 v[152:155], a[184:187], a[224:227], v[152:155]
v_mfma_f32_16x16x32_bf16 v[156:159], a[188:191], a[224:227], v[156:159]
ds_read_b64 a[156:157], v6 offset:3968
ds_read_b64 a[158:159], v6 offset:3976
v_mfma_f32_16x16x32_bf16 v[156:159], a[184:187], a[228:231], v[156:159]
v_mfma_f32_16x16x32_bf16 v[156:159], a[180:183], a[232:235], v[156:159]
s_add_u32 s69, s69, 0x20000
buffer_load_dwordx4 a[48:51], v4, s[44:47], s69 offen sc1
v_mfma_f32_16x16x32_bf16 v[156:159], a[176:179], a[236:239], v[156:159]
v_mfma_f32_16x16x32_bf16 v[156:159], a[172:175], a[240:243], v[156:159]
v_mfma_f32_16x16x32_bf16 v[156:159], a[168:171], a[244:247], v[156:159]
v_mfma_f32_16x16x32_bf16 v[156:159], a[164:167], a[248:251], v[156:159]
v_mfma_f32_16x16x32_bf16 v[156:159], a[160:163], a[252:255], v[156:159]
s_waitcnt lgkmcnt(0)
buffer_load_dwordx4 a[52:55], v4, s[44:47], s69 offen offset:1024 sc1
v_mfma_f32_16x16x32_bf16 v[128:131], a[128:131], a[192:195], v[128:131]
ds_read_b128 a[224:227], v7 offset:4032
ds_read_b64 a[160:161], v6 offset:448
v_mfma_f32_16x16x32_bf16 v[132:135], a[132:135], a[192:195], v[132:135]
v_mfma_f32_16x16x32_bf16 v[132:135], a[128:131], a[196:199], v[132:135]
ds_read_b64 a[162:163], v6 offset:456
ds_read_b128 a[228:231], v7 offset:3520
v_mfma_f32_16x16x32_bf16 v[136:139], a[128:131], a[200:203], v[136:139]
v_mfma_f32_16x16x32_bf16 v[136:139], a[132:135], a[196:199], v[136:139]
buffer_load_dwordx4 a[56:59], v4, s[44:47], s69 offen offset:2048 sc1
v_mfma_f32_16x16x32_bf16 v[136:139], a[136:139], a[192:195], v[136:139]
ds_read_b64 a[164:165], v6 offset:960
ds_read_b64 a[166:167], v6 offset:968
v_mfma_f32_16x16x32_bf16 v[140:143], a[140:143], a[192:195], v[140:143]
v_mfma_f32_16x16x32_bf16 v[140:143], a[136:139], a[196:199], v[140:143]
ds_read_b128 a[232:235], v7 offset:3008
ds_read_b64 a[168:169], v6 offset:1472
v_mfma_f32_16x16x32_bf16 v[140:143], a[132:135], a[200:203], v[140:143]
buffer_load_dwordx4 a[60:63], v4, s[44:47], s69 offen offset:3072 sc1
v_mfma_f32_16x16x32_bf16 v[140:143], a[128:131], a[204:207], v[140:143]
v_mfma_f32_16x16x32_bf16 v[144:147], a[128:131], a[208:211], v[144:147]
ds_read_b64 a[170:171], v6 offset:1480
ds_read_b128 a[236:239], v7 offset:2496
v_mfma_f32_16x16x32_bf16 v[144:147], a[132:135], a[204:207], v[144:147]
v_mfma_f32_16x16x32_bf16 v[144:147], a[136:139], a[200:203], v[144:147]
ds_read_b64 a[172:173], v6 offset:1984
ds_read_b64 a[174:175], v6 offset:1992
v_mfma_f32_16x16x32_bf16 v[144:147], a[140:143], a[196:199], v[144:147]
s_add_u32 s69, s61, 2
s_and_b32 s69, s69, 3
s_add_u32 s69, s69, s78
s_lshl_b32 s69, s69, 12
s_add_u32 s69, s69, s95
buffer_load_dwordx4 a[64:67], v4, s[44:47], s69 offen sc1
v_mfma_f32_16x16x32_bf16 v[144:147], a[144:147], a[192:195], v[144:147]
v_mfma_f32_16x16x32_bf16 v[148:151], a[148:151], a[192:195], v[148:151]
ds_read_b128 a[240:243], v7 offset:1984
ds_read_b64 a[176:177], v6 offset:2496
v_mfma_f32_16x16x32_bf16 v[148:151], a[144:147], a[196:199], v[148:151]
v_mfma_f32_16x16x32_bf16 v[148:151], a[140:143], a[200:203], v[148:151]
v_mfma_f32_16x16x32_bf16 v[148:151], a[136:139], a[204:207], v[148:151]
ds_read_b64 a[178:179], v6 offset:2504
ds_read_b128 a[244:247], v7 offset:1472
buffer_load_dwordx4 a[68:71], v4, s[44:47], s69 offen offset:1024 sc1
v_mfma_f32_16x16x32_bf16 v[148:151], a[132:135], a[208:211], v[148:151]
v_mfma_f32_16x16x32_bf16 v[148:151], a[128:131], a[212:215], v[148:151]
ds_read_b64 a[180:181], v6 offset:3008
ds_read_b64 a[182:183], v6 offset:3016
v_mfma_f32_16x16x32_bf16 v[152:155], a[128:131], a[216:219], v[152:155]
v_mfma_f32_16x16x32_bf16 v[152:155], a[132:135], a[212:215], v[152:155]
v_mfma_f32_16x16x32_bf16 v[152:155], a[136:139], a[208:211], v[152:155]
ds_read_b128 a[248:251], v7 offset:960
ds_read_b64 a[184:185], v6 offset:3520
buffer_load_dwordx4 a[72:75], v4, s[44:47], s69 offen offset:2048 sc1
v_mfma_f32_16x16x32_bf16 v[152:155], a[140:143], a[204:207], v[152:155]
v_mfma_f32_16x16x32_bf16 v[152:155], a[144:147], a[200:203], v[152:155]
ds_read_b64 a[186:187], v6 offset:3528
ds_read_b128 a[252:255], v7 offset:448
v_mfma_f32_16x16x32_bf16 v[152:155], a[148:151], a[196:199], v[152:155]
v_mfma_f32_16x16x32_bf16 v[152:155], a[152:155], a[192:195], v[152:155]
v_mfma_f32_16x16x32_bf16 v[156:159], a[156:159], a[192:195], v[156:159]
ds_read_b64 a[188:189], v6 offset:4032
ds_read_b64 a[190:191], v6 offset:4040
buffer_load_dwordx4 a[76:79], v4, s[44:47], s69 offen offset:3072 sc1
v_mfma_f32_16x16x32_bf16 v[156:159], a[152:155], a[196:199], v[156:159]
v_mfma_f32_16x16x32_bf16 v[156:159], a[148:151], a[200:203], v[156:159]
v_mfma_f32_16x16x32_bf16 v[156:159], a[144:147], a[204:207], v[156:159]
v_mfma_f32_16x16x32_bf16 v[156:159], a[140:143], a[208:211], v[156:159]
s_add_u32 s69, s69, 0x20000
buffer_load_dwordx4 a[80:83], v4, s[44:47], s69 offen sc1
v_mfma_f32_16x16x32_bf16 v[156:159], a[136:139], a[212:215], v[156:159]
v_mfma_f32_16x16x32_bf16 v[156:159], a[132:135], a[216:219], v[156:159]
v_mfma_f32_16x16x32_bf16 v[156:159], a[128:131], a[220:223], v[156:159]
s_waitcnt lgkmcnt(0)
v_mfma_f32_16x16x32_bf16 v[128:131], a[160:163], a[224:227], v[128:131]
ds_read_b64_tr_b16 v[192:193], v8 offset:0
v_mfma_f32_16x16x32_bf16 v[132:135], a[164:167], a[224:227], v[132:135]
ds_read_b64_tr_b16 v[194:195], v8 offset:2048
buffer_load_dwordx4 a[84:87], v4, s[44:47], s69 offen offset:1024 sc1
v_mfma_f32_16x16x32_bf16 v[132:135], a[160:163], a[228:231], v[132:135]
ds_read_b64_tr_b16 v[196:197], v9 offset:0
v_mfma_f32_16x16x32_bf16 v[136:139], a[160:163], a[232:235], v[136:139]
ds_read_b64_tr_b16 v[198:199], v9 offset:2048
v_mfma_f32_16x16x32_bf16 v[136:139], a[164:167], a[228:231], v[136:139]
ds_read_b64_tr_b16 v[200:201], v10 offset:0
v_mfma_f32_16x16x32_bf16 v[136:139], a[168:171], a[224:227], v[136:139]
ds_read_b64_tr_b16 v[202:203], v10 offset:2048
v_mfma_f32_16x16x32_bf16 v[140:143], a[172:175], a[224:227], v[140:143]
ds_read_b64_tr_b16 v[204:205], v11 offset:0
buffer_load_dwordx4 a[88:91], v4, s[44:47], s69 offen offset:2048 sc1
v_mfma_f32_16x16x32_bf16 v[140:143], a[168:171], a[228:231], v[140:143]
ds_read_b64_tr_b16 v[206:207], v11 offset:2048
v_cvt_pk_bf16_f32 v128, v128, v129
v_cvt_pk_bf16_f32 v129, v130, v131
v_cvt_pk_bf16_f32 v130, v132, v133
v_mfma_f32_16x16x32_bf16 v[140:143], a[164:167], a[232:235], v[140:143]
ds_read_b64_tr_b16 v[208:209], v8 offset:4096
v_cvt_pk_bf16_f32 v131, v134, v135
v_permlane32_swap_b32 v128, v130
s_nop 0
v_permlane32_swap_b32 v129, v131
v_mfma_f32_16x16x32_bf16 v[140:143], a[160:163], a[236:239], v[140:143]
ds_read_b64_tr_b16 v[210:211], v8 offset:6144
buffer_store_dwordx4 v[128:131], v166, s[44:47], s80 offen sc1
v_mfma_f32_16x16x32_bf16 v[144:147], a[160:163], a[240:243], v[144:147]
ds_read_b64_tr_b16 v[212:213], v9 offset:4096
v_mfma_f32_16x16x32_bf16 v[144:147], a[164:167], a[236:239], v[144:147]
ds_read_b64_tr_b16 v[214:215], v9 offset:6144
buffer_load_dwordx4 a[92:95], v4, s[44:47], s69 offen offset:3072 sc1
v_mfma_f32_16x16x32_bf16 v[144:147], a[168:171], a[232:235], v[144:147]
ds_read_b64_tr_b16 v[216:217], v10 offset:4096
v_mfma_f32_16x16x32_bf16 v[144:147], a[172:175], a[228:231], v[144:147]
ds_read_b64_tr_b16 v[218:219], v10 offset:6144
v_mfma_f32_16x16x32_bf16 v[144:147], a[176:179], a[224:227], v[144:147]
ds_read_b64_tr_b16 v[220:221], v11 offset:4096
v_cvt_pk_bf16_f32 v136, v136, v137
v_cvt_pk_bf16_f32 v137, v138, v139
v_cvt_pk_bf16_f32 v138, v140, v141
v_mfma_f32_16x16x32_bf16 v[148:151], a[180:183], a[224:227], v[148:151]
ds_read_b64_tr_b16 v[222:223], v11 offset:6144
v_cvt_pk_bf16_f32 v139, v142, v143
v_permlane32_swap_b32 v136, v138
s_nop 0
v_permlane32_swap_b32 v137, v139
v_mfma_f32_16x16x32_bf16 v[148:151], a[176:179], a[228:231], v[148:151]
ds_read_b64_tr_b16 v[224:225], v8 offset:8192
buffer_store_dwordx4 v[136:139], v166, s[44:47], s80 offen offset:1024 sc1
v_mfma_f32_16x16x32_bf16 v[148:151], a[172:175], a[232:235], v[148:151]
ds_read_b64_tr_b16 v[226:227], v8 offset:10240
v_mfma_f32_16x16x32_bf16 v[148:151], a[168:171], a[236:239], v[148:151]
ds_read_b64_tr_b16 v[228:229], v9 offset:8192
v_mfma_f32_16x16x32_bf16 v[148:151], a[164:167], a[240:243], v[148:151]
ds_read_b64_tr_b16 v[230:231], v9 offset:10240
v_mfma_f32_16x16x32_bf16 v[148:151], a[160:163], a[244:247], v[148:151]
ds_read_b64_tr_b16 v[232:233], v10 offset:8192
v_mfma_f32_16x16x32_bf16 v[152:155], a[160:163], a[248:251], v[152:155]
ds_read_b64_tr_b16 v[234:235], v10 offset:10240
v_mfma_f32_16x16x32_bf16 v[152:155], a[164:167], a[244:247], v[152:155]
ds_read_b64_tr_b16 v[236:237], v11 offset:8192
v_mfma_f32_16x16x32_bf16 v[152:155], a[168:171], a[240:243], v[152:155]
ds_read_b64_tr_b16 v[238:239], v11 offset:10240
v_mfma_f32_16x16x32_bf16 v[152:155], a[172:175], a[236:239], v[152:155]
ds_read_b64_tr_b16 v[240:241], v8 offset:12288
v_mfma_f32_16x16x32_bf16 v[152:155], a[176:179], a[232:235], v[152:155]
ds_read_b64_tr_b16 v[242:243], v8 offset:14336
v_cvt_pk_bf16_f32 v144, v144, v145
v_cvt_pk_bf16_f32 v145, v146, v147
v_cvt_pk_bf16_f32 v146, v148, v149
v_mfma_f32_16x16x32_bf16 v[152:155], a[180:183], a[228:231], v[152:155]
ds_read_b64_tr_b16 v[244:245], v9 offset:12288
v_cvt_pk_bf16_f32 v147, v150, v151
v_permlane32_swap_b32 v144, v146
s_nop 0
v_permlane32_swap_b32 v145, v147
v_mfma_f32_16x16x32_bf16 v[152:155], a[184:187], a[224:227], v[152:155]
ds_read_b64_tr_b16 v[246:247], v9 offset:14336
buffer_store_dwordx4 v[144:147], v166, s[44:47], s80 offen offset:2048 sc1
v_mfma_f32_16x16x32_bf16 v[156:159], a[188:191], a[224:227], v[156:159]
ds_read_b64_tr_b16 v[248:249], v10 offset:12288
v_mfma_f32_16x16x32_bf16 v[156:159], a[184:187], a[228:231], v[156:159]
ds_read_b64_tr_b16 v[250:251], v10 offset:14336
v_mfma_f32_16x16x32_bf16 v[156:159], a[180:183], a[232:235], v[156:159]
ds_read_b64_tr_b16 v[252:253], v11 offset:12288
v_mfma_f32_16x16x32_bf16 v[156:159], a[176:179], a[236:239], v[156:159]
ds_read_b64_tr_b16 v[254:255], v11 offset:14336
v_mfma_f32_16x16x32_bf16 v[156:159], a[172:175], a[240:243], v[156:159]
v_mfma_f32_16x16x32_bf16 v[156:159], a[168:171], a[244:247], v[156:159]
v_mfma_f32_16x16x32_bf16 v[156:159], a[164:167], a[248:251], v[156:159]
v_mfma_f32_16x16x32_bf16 v[156:159], a[160:163], a[252:255], v[156:159]
v_cvt_pk_bf16_f32 v152, v152, v153
v_cvt_pk_bf16_f32 v153, v154, v155
s_nop 5
v_cvt_pk_bf16_f32 v154, v156, v157
v_cvt_pk_bf16_f32 v155, v158, v159
s_nop 0
v_permlane32_swap_b32 v152, v154
v_permlane32_swap_b32 v153, v155
buffer_store_dwordx4 v[152:155], v166, s[44:47], s80 offen offset:3072 sc1
s_waitcnt vmcnt(20) lgkmcnt(0)
s_cmp_lg_u32 s81, 0
s_cbranch_scc1 Lredo0
Lredo0b:
s_barrier
v_mfma_f32_16x16x32_bf16 v[16:19], v[192:195], a[0:3], 0
s_add_u32 s82, s59, 8
s_and_b32 s82, s82, 28
s_lshl_b32 s82, s82, 10
s_add_u32 s82, s82, s74
buffer_load_dword v3, v2, s[44:47], s82 offen sc1
v_mfma_f32_16x16x32_bf16 v[16:19], v[208:211], a[4:7], v[16:19]
s_add_u32 s69, s61, 3
ds_read_b64_tr_b16 v[128:129], v8 offset:16384
ds_read_b64_tr_b16 v[130:131], v8 offset:18432
v_mfma_f32_16x16x32_bf16 v[16:19], v[224:227], a[8:11], v[16:19]
s_and_b32 s69, s69, 3
s_add_u32 s69, s69, s78
s_lshl_b32 s69, s69, 12
s_add_u32 s69, s69, s95
buffer_load_dwordx4 a[96:99], v1, s[44:47], s69 offen sc1
v_mfma_f32_16x16x32_bf16 v[16:19], v[240:243], a[12:15], v[16:19]
ds_read_b64_tr_b16 v[132:133], v9 offset:16384
ds_read_b64_tr_b16 v[134:135], v9 offset:18432
v_mfma_f32_16x16x32_bf16 v[32:35], v[240:243], a[28:31], 0
ds_read_b64_tr_b16 v[136:137], v10 offset:16384
ds_read_b64_tr_b16 v[138:139], v10 offset:18432
v_mfma_f32_16x16x32_bf16 v[32:35], v[224:227], a[24:27], v[32:35]
buffer_load_dwordx4 a[100:103], v1, s[44:47], s69 offen offset:1024 sc1
v_mfma_f32_16x16x32_bf16 v[32:35], v[208:211], a[20:23], v[32:35]
ds_read_b64_tr_b16 v[140:141], v11 offset:16384
ds_read_b64_tr_b16 v[142:143], v11 offset:18432
v_mfma_f32_16x16x32_bf16 v[32:35], v[192:195], a[16:19], v[32:35]
ds_read_b64_tr_b16 v[144:145], v8 offset:20480
ds_read_b64_tr_b16 v[146:147], v8 offset:22528
v_mfma_f32_16x16x32_bf16 v[36:39], v[196:199], a[16:19], 0
buffer_load_dwordx4 a[104:107], v1, s[44:47], s69 offen offset:2048 sc1
v_mfma_f32_16x16x32_bf16 v[36:39], v[212:215], a[20:23], v[36:39]
ds_read_b64_tr_b16 v[148:149], v9 offset:20480
ds_read_b64_tr_b16 v[150:151], v9 offset:22528
v_mfma_f32_16x16x32_bf16 v[36:39], v[228:231], a[24:27], v[36:39]
ds_read_b64_tr_b16 v[152:153], v10 offset:20480
ds_read_b64_tr_b16 v[154:155], v10 offset:22528
v_mfma_f32_16x16x32_bf16 v[36:39], v[244:247], a[28:31], v[36:39]
buffer_load_dwordx4 a[108:111], v1, s[44:47], s69 offen offset:3072 sc1
v_mfma_f32_16x16x32_bf16 v[20:23], v[244:247], a[12:15], 0
s_add_u32 s69, s69, 0x20000
ds_read_b64_tr_b16 v[156:157], v11 offset:20480
ds_read_b64_tr_b16 v[158:159], v11 offset:22528
v_mfma_f32_16x16x32_bf16 v[20:23], v[228:231], a[8:11], v[20:23]
buffer_load_dwordx4 a[112:115], v1, s[44:47], s69 offen sc1
v_mfma_f32_16x16x32_bf16 v[20:23], v[212:215], a[4:7], v[20:23]
ds_read_b64_tr_b16 v[160:161], v8 offset:24576
v_mfma_f32_16x16x32_bf16 v[20:23], v[196:199], a[0:3], v[20:23]
ds_read_b64_tr_b16 v[162:163], v8 offset:26624
ds_read_b64_tr_b16 v[164:165], v9 offset:24576
v_mfma_f32_16x16x32_bf16 v[24:27], v[200:203], a[0:3], 0
buffer_load_dwordx4 a[116:119], v1, s[44:47], s69 offen offset:1024 sc1
v_mfma_f32_16x16x32_bf16 v[24:27], v[216:219], a[4:7], v[24:27]
ds_read_b64_tr_b16 v[166:167], v9 offset:26624
ds_read_b64_tr_b16 v[168:169], v10 offset:24576
v_mfma_f32_16x16x32_bf16 v[24:27], v[232:235], a[8:11], v[24:27]
ds_read_b64_tr_b16 v[170:171], v10 offset:26624
ds_read_b64_tr_b16 v[172:173], v11 offset:24576
v_mfma_f32_16x16x32_bf16 v[24:27], v[248:251], a[12:15], v[24:27]
buffer_load_dwordx4 a[120:123], v1, s[44:47], s69 offen offset:2048 sc1
v_mfma_f32_16x16x32_bf16 v[40:43], v[248:251], a[28:31], 0
ds_read_b64_tr_b16 v[174:175], v11 offset:26624
ds_read_b64_tr_b16 v[176:177], v8 offset:28672
v_mfma_f32_16x16x32_bf16 v[40:43], v[232:235], a[24:27], v[40:43]
ds_read_b64_tr_b16 v[178:179], v8 offset:30720
ds_read_b64_tr_b16 v[180:181], v9 offset:28672
v_mfma_f32_16x16x32_bf16 v[40:43], v[216:219], a[20:23], v[40:43]
buffer_load_dwordx4 a[124:127], v1, s[44:47], s69 offen offset:3072 sc1
v_mfma_f32_16x16x32_bf16 v[40:43], v[200:203], a[16:19], v[40:43]
s_add_u32 s71, s61, 0
ds_read_b64_tr_b16 v[182:183], v9 offset:30720
ds_read_b64_tr_b16 v[184:185], v10 offset:28672
v_mfma_f32_16x16x32_bf16 v[44:47], v[204:207], a[16:19], 0
s_and_b32 s71, s71, 3
s_add_u32 s71, s71, s79
s_lshl_b32 s71, s71, 18
s_add_u32 s71, s71, s94
s_add_u32 m0, s77, 0
s_add_u32 s72, s71, 0
buffer_load_dwordx4 v15, s[24:27], s72 offen lds
v_mfma_f32_16x16x32_bf16 v[44:47], v[220:223], a[20:23], v[44:47]
s_add_u32 s72, s71, 15360
ds_read_b64_tr_b16 v[186:187], v10 offset:30720
ds_read_b64_tr_b16 v[188:189], v11 offset:28672
v_mfma_f32_16x16x32_bf16 v[44:47], v[236:239], a[24:27], v[44:47]
ds_read_b64_tr_b16 v[190:191], v11 offset:30720
v_mfma_f32_16x16x32_bf16 v[44:47], v[252:255], a[28:31], v[44:47]
buffer_load_dwordx4 v15, s[24:27], s72 offen offset:1024 lds
v_mfma_f32_16x16x32_bf16 v[28:31], v[252:255], a[12:15], 0
s_add_u32 s72, s71, 30720
v_mfma_f32_16x16x32_bf16 v[28:31], v[236:239], a[8:11], v[28:31]
v_mfma_f32_16x16x32_bf16 v[28:31], v[220:223], a[4:7], v[28:31]
s_waitcnt vmcnt(19) lgkmcnt(0)
buffer_load_dwordx4 v15, s[24:27], s72 offen offset:2048 lds
v_mfma_f32_16x16x32_bf16 v[28:31], v[204:207], a[0:3], v[28:31]
s_barrier
v_mfma_f32_16x16x32_bf16 v[16:19], v[128:131], a[32:35], v[16:19]
s_add_u32 s72, s71, 46080
ds_read_b64_tr_b16 v[192:193], v8 offset:32768
ds_read_b64_tr_b16 v[194:195], v8 offset:34816
v_mfma_f32_16x16x32_bf16 v[16:19], v[144:147], a[36:39], v[16:19]
buffer_load_dwordx4 v15, s[24:27], s72 offen offset:3072 lds
v_mfma_f32_16x16x32_bf16 v[16:19], v[160:163], a[40:43], v[16:19]
ds_read_b64_tr_b16 v[196:197], v9 offset:32768
ds_read_b64_tr_b16 v[198:199], v9 offset:34816
v_mfma_f32_16x16x32_bf16 v[16:19], v[176:179], a[44:47], v[16:19]
ds_read_b64_tr_b16 v[200:201], v10 offset:32768
ds_read_b64_tr_b16 v[202:203], v10 offset:34816
v_mfma_f32_16x16x32_bf16 v[32:35], v[176:179], a[60:63], v[32:35]
s_waitcnt vmcnt(12)
v_cmp_gt_u32 vcc, 2, v3
s_cbranch_vccnz Lspin63
Lback64:
s_add_u32 s69, s61, 0
s_and_b32 s69, s69, 3
s_add_u32 s69, s69, s79
s_lshl_b32 s69, s69, 12
s_add_u32 s69, s69, s95
buffer_load_dwordx4 a[0:3], v1, s[44:47], s69 offen sc1
v_mfma_f32_16x16x32_bf16 v[32:35], v[160:163], a[56:59], v[32:35]
ds_read_b64_tr_b16 v[204:205], v11 offset:32768
ds_read_b64_tr_b16 v[206:207], v11 offset:34816
v_mfma_f32_16x16x32_bf16 v[32:35], v[144:147], a[52:55], v[32:35]
buffer_load_dwordx4 a[4:7], v1, s[44:47], s69 offen offset:1024 sc1
v_mfma_f32_16x16x32_bf16 v[32:35], v[128:131], a[48:51], v[32:35]
ds_read_b64_tr_b16 v[208:209], v8 offset:36864
ds_read_b64_tr_b16 v[210:211], v8 offset:38912
v_mfma_f32_16x16x32_bf16 v[36:39], v[132:135], a[48:51], v[36:39]
ds_read_b64_tr_b16 v[212:213], v9 offset:36864
ds_read_b64_tr_b16 v[214:215], v9 offset:38912
v_mfma_f32_16x16x32_bf16 v[36:39], v[148:151], a[52:55], v[36:39]
buffer_load_dwordx4 a[8:11], v1, s[44:47], s69 offen offset:2048 sc1
v_mfma_f32_16x16x32_bf16 v[36:39], v[164:167], a[56:59], v[36:39]
ds_read_b64_tr_b16 v[216:217], v10 offset:36864
ds_read_b64_tr_b16 v[218:219], v10 offset:38912
v_mfma_f32_16x16x32_bf16 v[36:39], v[180:183], a[60:63], v[36:39]
ds_read_b64_tr_b16 v[220:221], v11 offset:36864
ds_read_b64_tr_b16 v[222:223], v11 offset:38912
v_mfma_f32_16x16x32_bf16 v[20:23], v[180:183], a[44:47], v[20:23]
buffer_load_dwordx4 a[12:15], v1, s[44:47], s69 offen offset:3072 sc1
v_mfma_f32_16x16x32_bf16 v[20:23], v[164:167], a[40:43], v[20:23]
s_add_u32 s69, s69, 0x20000
ds_read_b64_tr_b16 v[224:225], v8 offset:40960
v_mfma_f32_16x16x32_bf16 v[20:23], v[148:151], a[36:39], v[20:23]
ds_read_b64_tr_b16 v[226:227], v8 offset:43008
ds_read_b64_tr_b16 v[228:229], v9 offset:40960
v_mfma_f32_16x16x32_bf16 v[20:23], v[132:135], a[32:35], v[20:23]
buffer_load_dwordx4 a[16:19], v1, s[44:47], s69 offen sc1
v_mfma_f32_16x16x32_bf16 v[24:27], v[136:139], a[32:35], v[24:27]
ds_read_b64_tr_b16 v[230:231], v9 offset:43008
ds_read_b64_tr_b16 v[232:233], v10 offset:40960
v_mfma_f32_16x16x32_bf16 v[24:27], v[152:155], a[36:39], v[24:27]
buffer_load_dwordx4 a[20:23], v1, s[44:47], s69 offen offset:1024 sc1
v_mfma_f32_16x16x32_bf16 v[24:27], v[168:171], a[40:43], v[24:27]
ds_read_b64_tr_b16 v[234:235], v10 offset:43008
ds_read_b64_tr_b16 v[236:237], v11 offset:40960
v_mfma_f32_16x16x32_bf16 v[24:27], v[184:187], a[44:47], v[24:27]
ds_read_b64_tr_b16 v[238:239], v11 offset:43008
ds_read_b64_tr_b16 v[240:241], v8 offset:45056
v_mfma_f32_16x16x32_bf16 v[40:43], v[184:187], a[60:63], v[40:43]
buffer_load_dwordx4 a[24:27], v1, s[44:47], s69 offen offset:2048 sc1
v_mfma_f32_16x16x32_bf16 v[40:43], v[168:171], a[56:59], v[40:43]
ds_read_b64_tr_b16 v[242:243], v8 offset:47104
ds_read_b64_tr_b16 v[244:245], v9 offset:45056
v_mfma_f32_16x16x32_bf16 v[40:43], v[152:155], a[52:55], v[40:43]
ds_read_b64_tr_b16 v[246:247], v9 offset:47104
ds_read_b64_tr_b16 v[248:249], v10 offset:45056
v_mfma_f32_16x16x32_bf16 v[40:43], v[136:139], a[48:51], v[40:43]
buffer_load_dwordx4 a[28:31], v1, s[44:47], s69 offen offset:3072 sc1
v_mfma_f32_16x16x32_bf16 v[44:47], v[140:143], a[48:51], v[44:47]
s_add_u32 s71, s61, 1
ds_read_b64_tr_b16 v[250:251], v10 offset:47104
ds_read_b64_tr_b16 v[252:253], v11 offset:45056
v_mfma_f32_16x16x32_bf16 v[44:47], v[156:159], a[52:55], v[44:47]
s_and_b32 s71, s71, 3
ds_read_b64_tr_b16 v[254:255], v11 offset:47104
v_mfma_f32_16x16x32_bf16 v[44:47], v[172:175], a[56:59], v[44:47]
s_add_u32 s71, s71, s79
s_lshl_b32 s71, s71, 18
s_add_u32 s71, s71, s94
s_add_u32 m0, s77, 16384
s_add_u32 s72, s71, 0
buffer_load_dwordx4 v15, s[24:27], s72 offen lds
v_mfma_f32_16x16x32_bf16 v[44:47], v[188:191], a[60:63], v[44:47]
s_add_u32 s72, s71, 15360
v_mfma_f32_16x16x32_bf16 v[28:31], v[188:191], a[44:47], v[28:31]
v_mfma_f32_16x16x32_bf16 v[28:31], v[172:175], a[40:43], v[28:31]
buffer_load_dwordx4 v15, s[24:27], s72 offen offset:1024 lds
v_mfma_f32_16x16x32_bf16 v[28:31], v[156:159], a[36:39], v[28:31]
s_waitcnt vmcnt(23) lgkmcnt(0)
v_mfma_f32_16x16x32_bf16 v[28:31], v[140:143], a[32:35], v[28:31]
s_barrier
s_add_u32 s72, s71, 30720
buffer_load_dwordx4 v15, s[24:27], s72 offen offset:2048 lds
v_mfma_f32_16x16x32_bf16 v[16:19], v[192:195], a[64:67], v[16:19]
s_add_u32 s72, s71, 46080
ds_read_b64_tr_b16 v[128:129], v8 offset:49152
ds_read_b64_tr_b16 v[130:131], v8 offset:51200
v_mfma_f32_16x16x32_bf16 v[16:19], v[208:211], a[68:71], v[16:19]
ds_read_b64_tr_b16 v[132:133], v9 offset:49152
ds_read_b64_tr_b16 v[134:135], v9 offset:51200
v_mfma_f32_16x16x32_bf16 v[16:19], v[224:227], a[72:75], v[16:19]
buffer_load_dwordx4 v15, s[24:27], s72 offen offset:3072 lds
v_mfma_f32_16x16x32_bf16 v[16:19], v[240:243], a[76:79], v[16:19]
s_add_u32 s69, s61, 1
ds_read_b64_tr_b16 v[136:137], v10 offset:49152
ds_read_b64_tr_b16 v[138:139], v10 offset:51200
v_mfma_f32_16x16x32_bf16 v[32:35], v[240:243], a[92:95], v[32:35]
s_and_b32 s69, s69, 3
ds_read_b64_tr_b16 v[140:141], v11 offset:49152
ds_read_b64_tr_b16 v[142:143], v11 offset:51200
v_mfma_f32_16x16x32_bf16 v[32:35], v[224:227], a[88:91], v[32:35]
s_add_u32 s69, s69, s79
s_lshl_b32 s69, s69, 12
s_add_u32 s69, s69, s95
buffer_load_dwordx4 a[32:35], v1, s[44:47], s69 offen sc1
v_mfma_f32_16x16x32_bf16 v[32:35], v[208:211], a[84:87], v[32:35]
ds_read_b64_tr_b16 v[144:145], v8 offset:53248
v_mfma_f32_16x16x32_bf16 v[32:35], v[192:195], a[80:83], v[32:35]
ds_read_b64_tr_b16 v[146:147], v8 offset:55296
ds_read_b64_tr_b16 v[148:149], v9 offset:53248
v_mfma_f32_16x16x32_bf16 v[36:39], v[196:199], a[80:83], v[36:39]
buffer_load_dwordx4 a[36:39], v1, s[44:47], s69 offen offset:1024 sc1
v_mfma_f32_16x16x32_bf16 v[36:39], v[212:215], a[84:87], v[36:39]
ds_read_b64_tr_b16 v[150:151], v9 offset:55296
ds_read_b64_tr_b16 v[152:153], v10 offset:53248
v_mfma_f32_16x16x32_bf16 v[36:39], v[228:231], a[88:91], v[36:39]
buffer_load_dwordx4 a[40:43], v1, s[44:47], s69 offen offset:2048 sc1
v_mfma_f32_16x16x32_bf16 v[36:39], v[244:247], a[92:95], v[36:39]
ds_read_b64_tr_b16 v[154:155], v10 offset:55296
ds_read_b64_tr_b16 v[156:157], v11 offset:53248
v_mfma_f32_16x16x32_bf16 v[20:23], v[244:247], a[76:79], v[20:23]
ds_read_b64_tr_b16 v[158:159], v11 offset:55296
v_mfma_f32_16x16x32_bf16 v[20:23], v[228:231], a[72:75], v[20:23]
buffer_load_dwordx4 a[44:47], v1, s[44:47], s69 offen offset:3072 sc1
v_mfma_f32_16x16x32_bf16 v[20:23], v[212:215], a[68:71], v[20:23]
s_add_u32 s69, s69, 0x20000
ds_read_b64_tr_b16 v[160:161], v8 offset:57344
ds_read_b64_tr_b16 v[162:163], v8 offset:59392
v_mfma_f32_16x16x32_bf16 v[20:23], v[196:199], a[64:67], v[20:23]
ds_read_b64_tr_b16 v[164:165], v9 offset:57344
ds_read_b64_tr_b16 v[166:167], v9 offset:59392
v_mfma_f32_16x16x32_bf16 v[24:27], v[200:203], a[64:67], v[24:27]
buffer_load_dwordx4 a[48:51], v1, s[44:47], s69 offen sc1
v_mfma_f32_16x16x32_bf16 v[24:27], v[216:219], a[68:71], v[24:27]
ds_read_b64_tr_b16 v[168:169], v10 offset:57344
ds_read_b64_tr_b16 v[170:171], v10 offset:59392
v_mfma_f32_16x16x32_bf16 v[24:27], v[232:235], a[72:75], v[24:27]
ds_read_b64_tr_b16 v[172:173], v11 offset:57344
ds_read_b64_tr_b16 v[174:175], v11 offset:59392
v_mfma_f32_16x16x32_bf16 v[24:27], v[248:251], a[76:79], v[24:27]
buffer_load_dwordx4 a[52:55], v1, s[44:47], s69 offen offset:1024 sc1
v_mfma_f32_16x16x32_bf16 v[40:43], v[248:251], a[92:95], v[40:43]
ds_read_b64_tr_b16 v[176:177], v8 offset:61440
v_mfma_f32_16x16x32_bf16 v[40:43], v[232:235], a[88:91], v[40:43]
ds_read_b64_tr_b16 v[178:179], v8 offset:63488
ds_read_b64_tr_b16 v[180:181], v9 offset:61440
v_mfma_f32_16x16x32_bf16 v[40:43], v[216:219], a[84:87], v[40:43]
buffer_load_dwordx4 a[56:59], v1, s[44:47], s69 offen offset:2048 sc1
v_mfma_f32_16x16x32_bf16 v[40:43], v[200:203], a[80:83], v[40:43]
ds_read_b64_tr_b16 v[182:183], v9 offset:63488
ds_read_b64_tr_b16 v[184:185], v10 offset:61440
v_mfma_f32_16x16x32_bf16 v[44:47], v[204:207], a[80:83], v[44:47]
buffer_load_dwordx4 a[60:63], v1, s[44:47], s69 offen offset:3072 sc1
v_mfma_f32_16x16x32_bf16 v[44:47], v[220:223], a[84:87], v[44:47]
s_add_u32 s71, s61, 2
ds_read_b64_tr_b16 v[186:187], v10 offset:63488
ds_read_b64_tr_b16 v[188:189], v11 offset:61440
v_mfma_f32_16x16x32_bf16 v[44:47], v[236:239], a[88:91], v[44:47]
s_and_b32 s71, s71, 3
ds_read_b64_tr_b16 v[190:191], v11 offset:63488
v_mfma_f32_16x16x32_bf16 v[44:47], v[252:255], a[92:95], v[44:47]
s_add_u32 s71, s71, s79
s_lshl_b32 s71, s71, 18
s_add_u32 s71, s71, s94
s_add_u32 m0, s77, 32768
s_add_u32 s72, s71, 0
buffer_load_dwordx4 v15, s[24:27], s72 offen lds
v_mfma_f32_16x16x32_bf16 v[28:31], v[252:255], a[76:79], v[28:31]
s_add_u32 s72, s71, 15360
v_mfma_f32_16x16x32_bf16 v[28:31], v[236:239], a[72:75], v[28:31]
v_mfma_f32_16x16x32_bf16 v[28:31], v[220:223], a[68:71], v[28:31]
s_waitcnt vmcnt(21) lgkmcnt(0)
buffer_load_dwordx4 v15, s[24:27], s72 offen offset:1024 lds
v_mfma_f32_16x16x32_bf16 v[28:31], v[204:207], a[64:67], v[28:31]
s_barrier
v_mfma_f32_16x16x32_bf16 v[16:19], v[128:131], a[96:99], v[16:19]
s_add_u32 s72, s71, 30720
ds_read_b64_tr_b16 v[192:193], v8 offset:0
ds_read_b64_tr_b16 v[194:195], v8 offset:2048
v_or_b32 v112, s58, v0
v_mov_b32 v113, 3
v_min_u32 v112, 1, v112
v_lshlrev_b32 v112, 30, v112
buffer_store_dword v113, v112, s[44:47], s91 offen sc1
v_mfma_f32_16x16x32_bf16 v[16:19], v[144:147], a[100:103], v[16:19]
buffer_load_dwordx4 v15, s[24:27], s72 offen offset:2048 lds
v_mfma_f32_16x16x32_bf16 v[16:19], v[160:163], a[104:107], v[16:19]
s_add_u32 s72, s71, 46080
ds_read_b64_tr_b16 v[196:197], v9 offset:0
ds_read_b64_tr_b16 v[198:199], v9 offset:2048
v_mfma_f32_16x16x32_bf16 v[16:19], v[176:179], a[108:111], v[16:19]
buffer_load_dwordx4 v15, s[24:27], s72 offen offset:3072 lds
v_mfma_f32_16x16x32_bf16 v[32:35], v[176:179], a[124:127], v[32:35]
s_add_u32 s82, s59, 12
ds_read_b64_tr_b16 v[200:201], v10 offset:0
ds_read_b64_tr_b16 v[202:203], v10 offset:2048
v_mfma_f32_16x16x32_bf16 v[32:35], v[160:163], a[120:123], v[32:35]
s_and_b32 s82, s82, 28
ds_read_b64_tr_b16 v[204:205], v11 offset:0
ds_read_b64_tr_b16 v[206:207], v11 offset:2048
v_mfma_f32_16x16x32_bf16 v[32:35], v[144:147], a[116:119], v[32:35]
s_lshl_b32 s82, s82, 10
s_add_u32 s82, s82, s74
buffer_load_dword v3, v2, s[44:47], s82 offen sc1
v_mfma_f32_16x16x32_bf16 v[32:35], v[128:131], a[112:115], v[32:35]
s_add_u32 s69, s61, 2
ds_read_b64_tr_b16 v[208:209], v8 offset:4096
ds_read_b64_tr_b16 v[210:211], v8 offset:6144
v_mfma_f32_16x16x32_bf16 v[36:39], v[132:135], a[112:115], v[36:39]
s_and_b32 s69, s69, 3
ds_read_b64_tr_b16 v[212:213], v9 offset:4096
ds_read_b64_tr_b16 v[214:215], v9 offset:6144
v_mfma_f32_16x16x32_bf16 v[36:39], v[148:151], a[116:119], v[36:39]
s_add_u32 s69, s69, s79
s_lshl_b32 s69, s69, 12
s_add_u32 s69, s69, s95
buffer_load_dwordx4 a[64:67], v1, s[44:47], s69 offen sc1
v_mfma_f32_16x16x32_bf16 v[36:39], v[164:167], a[120:123], v[36:39]
ds_read_b64_tr_b16 v[216:217], v10 offset:4096
ds_read_b64_tr_b16 v[218:219], v10 offset:6144
v_mfma_f32_16x16x32_bf16 v[36:39], v[180:183], a[124:127], v[36:39]
ds_read_b64_tr_b16 v[220:221], v11 offset:4096
ds_read_b64_tr_b16 v[222:223], v11 offset:6144
v_mfma_f32_16x16x32_bf16 v[20:23], v[180:183], a[108:111], v[20:23]
buffer_load_dwordx4 a[68:71], v1, s[44:47], s69 offen offset:1024 sc1
v_mfma_f32_16x16x32_bf16 v[20:23], v[164:167], a[104:107], v[20:23]
ds_read_b64_tr_b16 v[224:225], v8 offset:8192
v_mfma_f32_16x16x32_bf16 v[20:23], v[148:151], a[100:103], v[20:23]
buffer_load_dwordx4 a[72:75], v1, s[44:47], s69 offen offset:2048 sc1
v_mfma_f32_16x16x32_bf16 v[20:23], v[132:135], a[96:99], v[20:23]
ds_read_b64_tr_b16 v[226:227], v8 offset:10240
ds_read_b64_tr_b16 v[228:229], v9 offset:8192
v_mfma_f32_16x16x32_bf16 v[24:27], v[136:139], a[96:99], v[24:27]
ds_read_b64_tr_b16 v[230:231], v9 offset:10240
ds_read_b64_tr_b16 v[232:233], v10 offset:8192
v_mfma_f32_16x16x32_bf16 v[24:27], v[152:155], a[100:103], v[24:27]
buffer_load_dwordx4 a[76:79], v1, s[44:47], s69 offen offset:3072 sc1
v_mfma_f32_16x16x32_bf16 v[24:27], v[168:171], a[104:107], v[24:27]
s_add_u32 s69, s69, 0x20000
ds_read_b64_tr_b16 v[234:235], v10 offset:10240
ds_read_b64_tr_b16 v[236:237], v11 offset:8192
v_mfma_f32_16x16x32_bf16 v[24:27], v[184:187], a[108:111], v[24:27]
ds_read_b64_tr_b16 v[238:239], v11 offset:10240
ds_read_b64_tr_b16 v[240:241], v8 offset:12288
v_mfma_f32_16x16x32_bf16 v[40:43], v[184:187], a[124:127], v[40:43]
buffer_load_dwordx4 a[80:83], v1, s[44:47], s69 offen sc1
v_mfma_f32_16x16x32_bf16 v[40:43], v[168:171], a[120:123], v[40:43]
ds_read_b64_tr_b16 v[242:243], v8 offset:14336
ds_read_b64_tr_b16 v[244:245], v9 offset:12288
v_mfma_f32_16x16x32_bf16 v[40:43], v[152:155], a[116:119], v[40:43]
ds_read_b64_tr_b16 v[246:247], v9 offset:14336
ds_read_b64_tr_b16 v[248:249], v10 offset:12288
v_mfma_f32_16x16x32_bf16 v[40:43], v[136:139], a[112:115], v[40:43]
buffer_load_dwordx4 a[84:87], v1, s[44:47], s69 offen offset:1024 sc1
v_mfma_f32_16x16x32_bf16 v[44:47], v[140:143], a[112:115], v[44:47]
ds_read_b64_tr_b16 v[250:251], v10 offset:14336
ds_read_b64_tr_b16 v[252:253], v11 offset:12288
v_mfma_f32_16x16x32_bf16 v[44:47], v[156:159], a[116:119], v[44:47]
ds_read_b64_tr_b16 v[254:255], v11 offset:14336
v_mfma_f32_16x16x32_bf16 v[44:47], v[172:175], a[120:123], v[44:47]
buffer_load_dwordx4 a[88:91], v1, s[44:47], s69 offen offset:2048 sc1
v_mfma_f32_16x16x32_bf16 v[44:47], v[188:191], a[124:127], v[44:47]
v_mfma_f32_16x16x32_bf16 v[28:31], v[188:191], a[108:111], v[28:31]
buffer_load_dwordx4 a[92:95], v1, s[44:47], s69 offen offset:3072 sc1
v_mfma_f32_16x16x32_bf16 v[28:31], v[172:175], a[104:107], v[28:31]
s_add_u32 s71, s61, 3
v_mfma_f32_16x16x32_bf16 v[28:31], v[156:159], a[100:103], v[28:31]
s_waitcnt vmcnt(22) lgkmcnt(0)
v_mfma_f32_16x16x32_bf16 v[28:31], v[140:143], a[96:99], v[28:31]
s_barrier
s_and_b32 s71, s71, 3
s_add_u32 s71, s71, s79
s_lshl_b32 s71, s71, 18
s_add_u32 s71, s71, s94
s_add_u32 m0, s77, 49152
s_add_u32 s72, s71, 0
buffer_load_dwordx4 v15, s[24:27], s72 offen lds
v_mfma_f32_16x16x32_bf16 v[16:19], v[192:195], a[0:3], v[16:19]
s_add_u32 s72, s71, 15360
ds_read_b64_tr_b16 v[128:129], v8 offset:16384
ds_read_b64_tr_b16 v[130:131], v8 offset:18432
v_mfma_f32_16x16x32_bf16 v[16:19], v[208:211], a[4:7], v[16:19]
ds_read_b64_tr_b16 v[132:133], v9 offset:16384
ds_read_b64_tr_b16 v[134:135], v9 offset:18432
v_mfma_f32_16x16x32_bf16 v[16:19], v[224:227], a[8:11], v[16:19]
buffer_load_dwordx4 v15, s[24:27], s72 offen offset:1024 lds
v_mfma_f32_16x16x32_bf16 v[16:19], v[240:243], a[12:15], v[16:19]
s_add_u32 s72, s71, 30720
ds_read_b64_tr_b16 v[136:137], v10 offset:16384
ds_read_b64_tr_b16 v[138:139], v10 offset:18432
v_mfma_f32_16x16x32_bf16 v[32:35], v[240:243], a[28:31], v[32:35]
ds_read_b64_tr_b16 v[140:141], v11 offset:16384
ds_read_b64_tr_b16 v[142:143], v11 offset:18432
v_mfma_f32_16x16x32_bf16 v[32:35], v[224:227], a[24:27], v[32:35]
buffer_load_dwordx4 v15, s[24:27], s72 offen offset:2048 lds
v_mfma_f32_16x16x32_bf16 v[32:35], v[208:211], a[20:23], v[32:35]
s_add_u32 s72, s71, 46080
ds_read_b64_tr_b16 v[144:145], v8 offset:20480
v_mfma_f32_16x16x32_bf16 v[32:35], v[192:195], a[16:19], v[32:35]
buffer_load_dwordx4 v15, s[24:27], s72 offen offset:3072 lds
v_mfma_f32_16x16x32_bf16 v[36:39], v[196:199], a[16:19], v[36:39]
s_add_u32 s69, s61, 3
ds_read_b64_tr_b16 v[146:147], v8 offset:22528
ds_read_b64_tr_b16 v[148:149], v9 offset:20480
v_mfma_f32_16x16x32_bf16 v[36:39], v[212:215], a[20:23], v[36:39]
s_and_b32 s69, s69, 3
ds_read_b64_tr_b16 v[150:151], v9 offset:22528
ds_read_b64_tr_b16 v[152:153], v10 offset:20480
v_mfma_f32_16x16x32_bf16 v[36:39], v[228:231], a[24:27], v[36:39]
s_add_u32 s69, s69, s79
s_lshl_b32 s69, s69, 12
s_add_u32 s69, s69, s95
buffer_load_dwordx4 a[96:99], v1, s[44:47], s69 offen sc1
v_mfma_f32_16x16x32_bf16 v[36:39], v[244:247], a[28:31], v[36:39]
ds_read_b64_tr_b16 v[154:155], v10 offset:22528
ds_read_b64_tr_b16 v[156:157], v11 offset:20480
v_mfma_f32_16x16x32_bf16 v[20:23], v[244:247], a[12:15], v[20:23]
ds_read_b64_tr_b16 v[158:159], v11 offset:22528
v_mfma_f32_16x16x32_bf16 v[20:23], v[228:231], a[8:11], v[20:23]
buffer_load_dwordx4 a[100:103], v1, s[44:47], s69 offen offset:1024 sc1
v_mfma_f32_16x16x32_bf16 v[20:23], v[212:215], a[4:7], v[20:23]
ds_read_b64_tr_b16 v[160:161], v8 offset:24576
ds_read_b64_tr_b16 v[162:163], v8 offset:26624
v_mfma_f32_16x16x32_bf16 v[20:23], v[196:199], a[0:3], v[20:23]
ds_read_b64_tr_b16 v[164:165], v9 offset:24576
ds_read_b64_tr_b16 v[166:167], v9 offset:26624
v_mfma_f32_16x16x32_bf16 v[24:27], v[200:203], a[0:3], v[24:27]
buffer_load_dwordx4 a[104:107], v1, s[44:47], s69 offen offset:2048 sc1
v_mfma_f32_16x16x32_bf16 v[24:27], v[216:219], a[4:7], v[24:27]
ds_read_b64_tr_b16 v[168:169], v10 offset:24576
ds_read_b64_tr_b16 v[170:171], v10 offset:26624
v_mfma_f32_16x16x32_bf16 v[24:27], v[232:235], a[8:11], v[24:27]
ds_read_b64_tr_b16 v[172:173], v11 offset:24576
ds_read_b64_tr_b16 v[174:175], v11 offset:26624
v_mfma_f32_16x16x32_bf16 v[24:27], v[248:251], a[12:15], v[24:27]
buffer_load_dwordx4 a[108:111], v1, s[44:47], s69 offen offset:3072 sc1
v_mfma_f32_16x16x32_bf16 v[40:43], v[248:251], a[28:31], v[40:43]
s_add_u32 s69, s69, 0x20000
ds_read_b64_tr_b16 v[176:177], v8 offset:28672
v_mfma_f32_16x16x32_bf16 v[40:43], v[232:235], a[24:27], v[40:43]
buffer_load_dwordx4 a[112:115], v1, s[44:47], s69 offen sc1
v_mfma_f32_16x16x32_bf16 v[40:43], v[216:219], a[20:23], v[40:43]
ds_read_b64_tr_b16 v[178:179], v8 offset:30720
ds_read_b64_tr_b16 v[180:181], v9 offset:28672
v_mfma_f32_16x16x32_bf16 v[40:43], v[200:203], a[16:19], v[40:43]
ds_read_b64_tr_b16 v[182:183], v9 offset:30720
ds_read_b64_tr_b16 v[184:185], v10 offset:28672
v_mfma_f32_16x16x32_bf16 v[44:47], v[204:207], a[16:19], v[44:47]
buffer_load_dwordx4 a[116:119], v1, s[44:47], s69 offen offset:1024 sc1
v_mfma_f32_16x16x32_bf16 v[44:47], v[220:223], a[20:23], v[44:47]
ds_read_b64_tr_b16 v[186:187], v10 offset:30720
ds_read_b64_tr_b16 v[188:189], v11 offset:28672
v_mfma_f32_16x16x32_bf16 v[44:47], v[236:239], a[24:27], v[44:47]
ds_read_b64_tr_b16 v[190:191], v11 offset:30720
v_mfma_f32_16x16x32_bf16 v[44:47], v[252:255], a[28:31], v[44:47]
buffer_load_dwordx4 a[120:123], v1, s[44:47], s69 offen offset:2048 sc1
v_mfma_f32_16x16x32_bf16 v[28:31], v[252:255], a[12:15], v[28:31]
v_mfma_f32_16x16x32_bf16 v[28:31], v[236:239], a[8:11], v[28:31]
v_mfma_f32_16x16x32_bf16 v[28:31], v[220:223], a[4:7], v[28:31]
s_waitcnt vmcnt(20) lgkmcnt(0)
buffer_load_dwordx4 a[124:127], v1, s[44:47], s69 offen offset:3072 sc1
v_mfma_f32_16x16x32_bf16 v[28:31], v[204:207], a[0:3], v[28:31]
s_barrier
v_mfma_f32_16x16x32_bf16 v[16:19], v[128:131], a[32:35], v[16:19]
s_add_u32 s78, s59, 12
s_and_b32 s78, s78, 28
s_add_u32 s71, s61, 0
s_and_b32 s71, s71, 3
s_add_u32 s71, s71, s78
s_lshl_b32 s71, s71, 18
s_add_u32 s71, s71, s94
s_add_u32 m0, s77, 0
s_add_u32 s72, s71, 0
buffer_load_dwordx4 v15, s[24:27], s72 offen lds
v_mfma_f32_16x16x32_bf16 v[16:19], v[144:147], a[36:39], v[16:19]
s_add_u32 s72, s71, 15360
ds_read_b64_tr_b16 v[192:193], v8 offset:32768
ds_read_b64_tr_b16 v[194:195], v8 offset:34816
v_mfma_f32_16x16x32_bf16 v[16:19], v[160:163], a[40:43], v[16:19]
ds_read_b64_tr_b16 v[196:197], v9 offset:32768
ds_read_b64_tr_b16 v[198:199], v9 offset:34816
v_mfma_f32_16x16x32_bf16 v[16:19], v[176:179], a[44:47], v[16:19]
buffer_load_dwordx4 v15, s[24:27], s72 offen offset:1024 lds
v_mfma_f32_16x16x32_bf16 v[32:35], v[176:179], a[60:63], v[32:35]
s_add_u32 s72, s71, 30720
ds_read_b64_tr_b16 v[200:201], v10 offset:32768
ds_read_b64_tr_b16 v[202:203], v10 offset:34816
v_mfma_f32_16x16x32_bf16 v[32:35], v[160:163], a[56:59], v[32:35]
ds_read_b64_tr_b16 v[204:205], v11 offset:32768
ds_read_b64_tr_b16 v[206:207], v11 offset:34816
v_mfma_f32_16x16x32_bf16 v[32:35], v[144:147], a[52:55], v[32:35]
buffer_load_dwordx4 v15, s[24:27], s72 offen offset:2048 lds
v_mfma_f32_16x16x32_bf16 v[32:35], v[128:131], a[48:51], v[32:35]
s_add_u32 s72, s71, 46080
ds_read_b64_tr_b16 v[208:209], v8 offset:36864
ds_read_b64_tr_b16 v[210:211], v8 offset:38912
v_mfma_f32_16x16x32_bf16 v[36:39], v[132:135], a[48:51], v[36:39]
ds_read_b64_tr_b16 v[212:213], v9 offset:36864
ds_read_b64_tr_b16 v[214:215], v9 offset:38912
v_mfma_f32_16x16x32_bf16 v[36:39], v[148:151], a[52:55], v[36:39]
buffer_load_dwordx4 v15, s[24:27], s72 offen offset:3072 lds
v_mfma_f32_16x16x32_bf16 v[36:39], v[164:167], a[56:59], v[36:39]
ds_read_b64_tr_b16 v[216:217], v10 offset:36864
ds_read_b64_tr_b16 v[218:219], v10 offset:38912
v_mfma_f32_16x16x32_bf16 v[36:39], v[180:183], a[60:63], v[36:39]
ds_read_b64_tr_b16 v[220:221], v11 offset:36864
ds_read_b64_tr_b16 v[222:223], v11 offset:38912
v_mfma_f32_16x16x32_bf16 v[20:23], v[180:183], a[44:47], v[20:23]
s_waitcnt vmcnt(24)
v_cmp_gt_u32 vcc, 2, v3
s_cbranch_vccnz Lspin66
Lback67:
s_add_u32 s82, s59, 16
s_and_b32 s82, s82, 28
s_lshl_b32 s82, s82, 10
s_add_u32 s82, s82, s74
buffer_load_dword v3, v2, s[44:47], s82 offen sc1
s_add_u32 s69, s61, 0
s_and_b32 s69, s69, 3
s_add_u32 s69, s69, s78
s_lshl_b32 s69, s69, 12
s_add_u32 s69, s69, s95
buffer_load_dwordx4 a[0:3], v1, s[44:47], s69 offen sc1
v_mfma_f32_16x16x32_bf16 v[20:23], v[164:167], a[40:43], v[20:23]
ds_read_b64_tr_b16 v[224:225], v8 offset:40960
v_mfma_f32_16x16x32_bf16 v[20:23], v[148:151], a[36:39], v[20:23]
buffer_load_dwordx4 a[4:7], v1, s[44:47], s69 offen offset:1024 sc1
v_mfma_f32_16x16x32_bf16 v[20:23], v[132:135], a[32:35], v[20:23]
ds_read_b64_tr_b16 v[226:227], v8 offset:43008
ds_read_b64_tr_b16 v[228:229], v9 offset:40960
v_mfma_f32_16x16x32_bf16 v[24:27], v[136:139], a[32:35], v[24:27]
ds_read_b64_tr_b16 v[230:231], v9 offset:43008
ds_read_b64_tr_b16 v[232:233], v10 offset:40960
v_mfma_f32_16x16x32_bf16 v[24:27], v[152:155], a[36:39], v[24:27]
buffer_load_dwordx4 a[8:11], v1, s[44:47], s69 offen offset:2048 sc1
v_mfma_f32_16x16x32_bf16 v[24:27], v[168:171], a[40:43], v[24:27]
ds_read_b64_tr_b16 v[234:235], v10 offset:43008
ds_read_b64_tr_b16 v[236:237], v11 offset:40960
v_mfma_f32_16x16x32_bf16 v[24:27], v[184:187], a[44:47], v[24:27]
ds_read_b64_tr_b16 v[238:239], v11 offset:43008
ds_read_b64_tr_b16 v[240:241], v8 offset:45056
v_mfma_f32_16x16x32_bf16 v[40:43], v[184:187], a[60:63], v[40:43]
buffer_load_dwordx4 a[12:15], v1, s[44:47], s69 offen offset:3072 sc1
v_mfma_f32_16x16x32_bf16 v[40:43], v[168:171], a[56:59], v[40:43]
s_add_u32 s69, s69, 0x20000
ds_read_b64_tr_b16 v[242:243], v8 offset:47104
ds_read_b64_tr_b16 v[244:245], v9 offset:45056
v_mfma_f32_16x16x32_bf16 v[40:43], v[152:155], a[52:55], v[40:43]
ds_read_b64_tr_b16 v[246:247], v9 offset:47104
ds_read_b64_tr_b16 v[248:249], v10 offset:45056
v_mfma_f32_16x16x32_bf16 v[40:43], v[136:139], a[48:51], v[40:43]
buffer_load_dwordx4 a[16:19], v1, s[44:47], s69 offen sc1
v_mfma_f32_16x16x32_bf16 v[44:47], v[140:143], a[48:51], v[44:47]
ds_read_b64_tr_b16 v[250:251], v10 offset:47104
ds_read_b64_tr_b16 v[252:253], v11 offset:45056
v_mfma_f32_16x16x32_bf16 v[44:47], v[156:159], a[52:55], v[44:47]
buffer_load_dwordx4 a[20:23], v1, s[44:47], s69 offen offset:1024 sc1
v_mfma_f32_16x16x32_bf16 v[44:47], v[172:175], a[56:59], v[44:47]
ds_read_b64_tr_b16 v[254:255], v11 offset:47104
v_mfma_f32_16x16x32_bf16 v[44:47], v[188:191], a[60:63], v[44:47]
v_mfma_f32_16x16x32_bf16 v[28:31], v[188:191], a[44:47], v[28:31]
buffer_load_dwordx4 a[24:27], v1, s[44:47], s69 offen offset:2048 sc1
v_mfma_f32_16x16x32_bf16 v[28:31], v[172:175], a[40:43], v[28:31]
v_mfma_f32_16x16x32_bf16 v[28:31], v[156:159], a[36:39], v[28:31]
s_waitcnt vmcnt(20) lgkmcnt(0)
v_mfma_f32_16x16x32_bf16 v[28:31], v[140:143], a[32:35], v[28:31]
s_barrier
buffer_load_dwordx4 a[28:31], v1, s[44:47], s69 offen offset:3072 sc1
v_mfma_f32_16x16x32_bf16 v[16:19], v[192:195], a[64:67], v[16:19]
s_add_u32 s71, s61, 1
ds_read_b64_tr_b16 v[128:129], v8 offset:49152
ds_read_b64_tr_b16 v[130:131], v8 offset:51200
v_mfma_f32_16x16x32_bf16 v[16:19], v[208:211], a[68:71], v[16:19]
s_and_b32 s71, s71, 3
ds_read_b64_tr_b16 v[132:133], v9 offset:49152
ds_read_b64_tr_b16 v[134:135], v9 offset:51200
v_mfma_f32_16x16x32_bf16 v[16:19], v[224:227], a[72:75], v[16:19]
s_add_u32 s71, s71, s78
s_lshl_b32 s71, s71, 18
s_add_u32 s71, s71, s94
s_add_u32 m0, s77, 16384
s_add_u32 s72, s71, 0
buffer_load_dwordx4 v15, s[24:27], s72 offen lds
v_mfma_f32_16x16x32_bf16 v[16:19], v[240:243], a[76:79], v[16:19]
s_add_u32 s72, s71, 15360
ds_read_b64_tr_b16 v[136:137], v10 offset:49152
ds_read_b64_tr_b16 v[138:139], v10 offset:51200
v_mfma_f32_16x16x32_bf16 v[32:35], v[240:243], a[92:95], v[32:35]
buffer_load_dwordx4 v15, s[24:27], s72 offen offset:1024 lds
v_mfma_f32_16x16x32_bf16 v[32:35], v[224:227], a[88:91], v[32:35]
s_add_u32 s72, s71, 30720
ds_read_b64_tr_b16 v[140:141], v11 offset:49152
ds_read_b64_tr_b16 v[142:143], v11 offset:51200
v_mfma_f32_16x16x32_bf16 v[32:35], v[208:211], a[84:87], v[32:35]
ds_read_b64_tr_b16 v[144:145], v8 offset:53248
v_mfma_f32_16x16x32_bf16 v[32:35], v[192:195], a[80:83], v[32:35]
buffer_load_dwordx4 v15, s[24:27], s72 offen offset:2048 lds
v_mfma_f32_16x16x32_bf16 v[36:39], v[196:199], a[80:83], v[36:39]
s_add_u32 s72, s71, 46080
ds_read_b64_tr_b16 v[146:147], v8 offset:55296
ds_read_b64_tr_b16 v[148:149], v9 offset:53248
v_mfma_f32_16x16x32_bf16 v[36:39], v[212:215], a[84:87], v[36:39]
ds_read_b64_tr_b16 v[150:151], v9 offset:55296
ds_read_b64_tr_b16 v[152:153], v10 offset:53248
v_mfma_f32_16x16x32_bf16 v[36:39], v[228:231], a[88:91], v[36:39]
buffer_load_dwordx4 v15, s[24:27], s72 offen offset:3072 lds
v_mfma_f32_16x16x32_bf16 v[36:39], v[244:247], a[92:95], v[36:39]
s_add_u32 s69, s61, 1
ds_read_b64_tr_b16 v[154:155], v10 offset:55296
ds_read_b64_tr_b16 v[156:157], v11 offset:53248
v_mfma_f32_16x16x32_bf16 v[20:23], v[244:247], a[76:79], v[20:23]
s_and_b32 s69, s69, 3
ds_read_b64_tr_b16 v[158:159], v11 offset:55296
v_mfma_f32_16x16x32_bf16 v[20:23], v[228:231], a[72:75], v[20:23]
s_add_u32 s69, s69, s78
s_lshl_b32 s69, s69, 12
s_add_u32 s69, s69, s95
buffer_load_dwordx4 a[32:35], v1, s[44:47], s69 offen sc1
v_mfma_f32_16x16x32_bf16 v[20:23], v[212:215], a[68:71], v[20:23]
ds_read_b64_tr_b16 v[160:161], v8 offset:57344
ds_read_b64_tr_b16 v[162:163], v8 offset:59392
v_mfma_f32_16x16x32_bf16 v[20:23], v[196:199], a[64:67], v[20:23]
ds_read_b64_tr_b16 v[164:165], v9 offset:57344
ds_read_b64_tr_b16 v[166:167], v9 offset:59392
v_mfma_f32_16x16x32_bf16 v[24:27], v[200:203], a[64:67], v[24:27]
buffer_load_dwordx4 a[36:39], v1, s[44:47], s69 offen offset:1024 sc1
v_mfma_f32_16x16x32_bf16 v[24:27], v[216:219], a[68:71], v[24:27]
ds_read_b64_tr_b16 v[168:169], v10 offset:57344
ds_read_b64_tr_b16 v[170:171], v10 offset:59392
v_mfma_f32_16x16x32_bf16 v[24:27], v[232:235], a[72:75], v[24:27]
buffer_load_dwordx4 a[40:43], v1, s[44:47], s69 offen offset:2048 sc1
v_mfma_f32_16x16x32_bf16 v[24:27], v[248:251], a[76:79], v[24:27]
ds_read_b64_tr_b16 v[172:173], v11 offset:57344
ds_read_b64_tr_b16 v[174:175], v11 offset:59392
v_mfma_f32_16x16x32_bf16 v[40:43], v[248:251], a[92:95], v[40:43]
ds_read_b64_tr_b16 v[176:177], v8 offset:61440
v_mfma_f32_16x16x32_bf16 v[40:43], v[232:235], a[88:91], v[40:43]
buffer_load_dwordx4 a[44:47], v1, s[44:47], s69 offen offset:3072 sc1
v_mfma_f32_16x16x32_bf16 v[40:43], v[216:219], a[84:87], v[40:43]
s_add_u32 s69, s69, 0x20000
ds_read_b64_tr_b16 v[178:179], v8 offset:63488
ds_read_b64_tr_b16 v[180:181], v9 offset:61440
v_mfma_f32_16x16x32_bf16 v[40:43], v[200:203], a[80:83], v[40:43]
ds_read_b64_tr_b16 v[182:183], v9 offset:63488
ds_read_b64_tr_b16 v[184:185], v10 offset:61440
v_mfma_f32_16x16x32_bf16 v[44:47], v[204:207], a[80:83], v[44:47]
buffer_load_dwordx4 a[48:51], v1, s[44:47], s69 offen sc1
v_mfma_f32_16x16x32_bf16 v[44:47], v[220:223], a[84:87], v[44:47]
ds_read_b64_tr_b16 v[186:187], v10 offset:63488
ds_read_b64_tr_b16 v[188:189], v11 offset:61440
v_mfma_f32_16x16x32_bf16 v[44:47], v[236:239], a[88:91], v[44:47]
ds_read_b64_tr_b16 v[190:191], v11 offset:63488
v_mfma_f32_16x16x32_bf16 v[44:47], v[252:255], a[92:95], v[44:47]
buffer_load_dwordx4 a[52:55], v1, s[44:47], s69 offen offset:1024 sc1
v_mfma_f32_16x16x32_bf16 v[28:31], v[252:255], a[76:79], v[28:31]
v_mfma_f32_16x16x32_bf16 v[28:31], v[236:239], a[72:75], v[28:31]
buffer_load_dwordx4 a[56:59], v1, s[44:47], s69 offen offset:2048 sc1
v_mfma_f32_16x16x32_bf16 v[28:31], v[220:223], a[68:71], v[28:31]
s_waitcnt vmcnt(20) lgkmcnt(0)
v_mfma_f32_16x16x32_bf16 v[28:31], v[204:207], a[64:67], v[28:31]
s_barrier
v_mfma_f32_16x16x32_bf16 v[16:19], v[128:131], a[96:99], v[16:19]
buffer_load_dwordx4 a[60:63], v1, s[44:47], s69 offen offset:3072 sc1
v_mfma_f32_16x16x32_bf16 v[16:19], v[144:147], a[100:103], v[16:19]
s_add_u32 s71, s61, 2
ds_read_b64_tr_b16 v[192:193], v8 offset:0
ds_read_b64_tr_b16 v[194:195], v8 offset:2048
v_mfma_f32_16x16x32_bf16 v[16:19], v[160:163], a[104:107], v[16:19]
s_and_b32 s71, s71, 3
ds_read_b64_tr_b16 v[196:197], v9 offset:0
ds_read_b64_tr_b16 v[198:199], v9 offset:2048
v_mfma_f32_16x16x32_bf16 v[16:19], v[176:179], a[108:111], v[16:19]
s_add_u32 s71, s71, s78
s_lshl_b32 s71, s71, 18
s_add_u32 s71, s71, s94
s_add_u32 m0, s77, 32768
s_add_u32 s72, s71, 0
buffer_load_dwordx4 v15, s[24:27], s72 offen lds
v_mfma_f32_16x16x32_bf16 v[32:35], v[176:179], a[124:127], v[32:35]
s_add_u32 s72, s71, 15360
ds_read_b64_tr_b16 v[200:201], v10 offset:0
ds_read_b64_tr_b16 v[202:203], v10 offset:2048
v_mfma_f32_16x16x32_bf16 v[32:35], v[160:163], a[120:123], v[32:35]
ds_read_b64_tr_b16 v[204:205], v11 offset:0
ds_read_b64_tr_b16 v[206:207], v11 offset:2048
v_mfma_f32_16x16x32_bf16 v[32:35], v[144:147], a[116:119], v[32:35]
buffer_load_dwordx4 v15, s[24:27], s72 offen offset:1024 lds
v_mfma_f32_16x16x32_bf16 v[32:35], v[128:131], a[112:115], v[32:35]
s_add_u32 s72, s71, 30720
ds_read_b64_tr_b16 v[208:209], v8 offset:4096
ds_read_b64_tr_b16 v[210:211], v8 offset:6144
v_mfma_f32_16x16x32_bf16 v[36:39], v[132:135], a[112:115], v[36:39]
ds_read_b64_tr_b16 v[212:213], v9 offset:4096
ds_read_b64_tr_b16 v[214:215], v9 offset:6144
v_mfma_f32_16x16x32_bf16 v[36:39], v[148:151], a[116:119], v[36:39]
buffer_load_dwordx4 v15, s[24:27], s72 offen offset:2048 lds
v_mfma_f32_16x16x32_bf16 v[36:39], v[164:167], a[120:123], v[36:39]
s_add_u32 s72, s71, 46080
ds_read_b64_tr_b16 v[216:217], v10 offset:4096
ds_read_b64_tr_b16 v[218:219], v10 offset:6144
v_mfma_f32_16x16x32_bf16 v[36:39], v[180:183], a[124:127], v[36:39]
buffer_load_dwordx4 v15, s[24:27], s72 offen offset:3072 lds
v_mfma_f32_16x16x32_bf16 v[20:23], v[180:183], a[108:111], v[20:23]
s_add_u32 s69, s61, 2
ds_read_b64_tr_b16 v[220:221], v11 offset:4096
ds_read_b64_tr_b16 v[222:223], v11 offset:6144
v_mfma_f32_16x16x32_bf16 v[20:23], v[164:167], a[104:107], v[20:23]
s_and_b32 s69, s69, 3
ds_read_b64_tr_b16 v[224:225], v8 offset:8192
v_mfma_f32_16x16x32_bf16 v[20:23], v[148:151], a[100:103], v[20:23]
s_add_u32 s69, s69, s78
s_lshl_b32 s69, s69, 12
s_add_u32 s69, s69, s95
buffer_load_dwordx4 a[64:67], v1, s[44:47], s69 offen sc1
v_mfma_f32_16x16x32_bf16 v[20:23], v[132:135], a[96:99], v[20:23]
ds_read_b64_tr_b16 v[226:227], v8 offset:10240
ds_read_b64_tr_b16 v[228:229], v9 offset:8192
v_mfma_f32_16x16x32_bf16 v[24:27], v[136:139], a[96:99], v[24:27]
ds_read_b64_tr_b16 v[230:231], v9 offset:10240
ds_read_b64_tr_b16 v[232:233], v10 offset:8192
v_mfma_f32_16x16x32_bf16 v[24:27], v[152:155], a[100:103], v[24:27]
buffer_load_dwordx4 a[68:71], v1, s[44:47], s69 offen offset:1024 sc1
v_mfma_f32_16x16x32_bf16 v[24:27], v[168:171], a[104:107], v[24:27]
ds_read_b64_tr_b16 v[234:235], v10 offset:10240
ds_read_b64_tr_b16 v[236:237], v11 offset:8192
v_mfma_f32_16x16x32_bf16 v[24:27], v[184:187], a[108:111], v[24:27]
ds_read_b64_tr_b16 v[238:239], v11 offset:10240
ds_read_b64_tr_b16 v[240:241], v8 offset:12288
v_mfma_f32_16x16x32_bf16 v[40:43], v[184:187], a[124:127], v[40:43]
buffer_load_dwordx4 a[72:75], v1, s[44:47], s69 offen offset:2048 sc1
v_mfma_f32_16x16x32_bf16 v[40:43], v[168:171], a[120:123], v[40:43]
ds_read_b64_tr_b16 v[242:243], v8 offset:14336
ds_read_b64_tr_b16 v[244:245], v9 offset:12288
v_mfma_f32_16x16x32_bf16 v[40:43], v[152:155], a[116:119], v[40:43]
buffer_load_dwordx4 a[76:79], v1, s[44:47], s69 offen offset:3072 sc1
v_mfma_f32_16x16x32_bf16 v[40:43], v[136:139], a[112:115], v[40:43]
s_add_u32 s69, s69, 0x20000
ds_read_b64_tr_b16 v[246:247], v9 offset:14336
ds_read_b64_tr_b16 v[248:249], v10 offset:12288
v_mfma_f32_16x16x32_bf16 v[44:47], v[140:143], a[112:115], v[44:47]
ds_read_b64_tr_b16 v[250:251], v10 offset:14336
ds_read_b64_tr_b16 v[252:253], v11 offset:12288
v_mfma_f32_16x16x32_bf16 v[44:47], v[156:159], a[116:119], v[44:47]
buffer_load_dwordx4 a[80:83], v1, s[44:47], s69 offen sc1
v_mfma_f32_16x16x32_bf16 v[44:47], v[172:175], a[120:123], v[44:47]
ds_read_b64_tr_b16 v[254:255], v11 offset:14336
v_mfma_f32_16x16x32_bf16 v[44:47], v[188:191], a[124:127], v[44:47]
v_mfma_f32_16x16x32_bf16 v[28:31], v[188:191], a[108:111], v[28:31]
buffer_load_dwordx4 a[84:87], v1, s[44:47], s69 offen offset:1024 sc1
v_mfma_f32_16x16x32_bf16 v[28:31], v[172:175], a[104:107], v[28:31]
v_mfma_f32_16x16x32_bf16 v[28:31], v[156:159], a[100:103], v[28:31]
s_waitcnt vmcnt(18) lgkmcnt(0)
v_mfma_f32_16x16x32_bf16 v[28:31], v[140:143], a[96:99], v[28:31]
s_barrier
buffer_load_dwordx4 a[88:91], v1, s[44:47], s69 offen offset:2048 sc1
v_mfma_f32_16x16x32_bf16 v[16:19], v[192:195], a[0:3], v[16:19]
ds_read_b64_tr_b16 v[128:129], v8 offset:16384
ds_read_b64_tr_b16 v[130:131], v8 offset:18432
v_mfma_f32_16x16x32_bf16 v[16:19], v[208:211], a[4:7], v[16:19]
ds_read_b64_tr_b16 v[132:133], v9 offset:16384
ds_read_b64_tr_b16 v[134:135], v9 offset:18432
v_mfma_f32_16x16x32_bf16 v[16:19], v[224:227], a[8:11], v[16:19]
buffer_load_dwordx4 a[92:95], v1, s[44:47], s69 offen offset:3072 sc1
v_mfma_f32_16x16x32_bf16 v[16:19], v[240:243], a[12:15], v[16:19]
s_add_u32 s71, s61, 3
ds_read_b64_tr_b16 v[136:137], v10 offset:16384
ds_read_b64_tr_b16 v[138:139], v10 offset:18432
v_mfma_f32_16x16x32_bf16 v[32:35], v[240:243], a[28:31], v[32:35]
s_and_b32 s71, s71, 3
s_add_u32 s71, s71, s78
s_lshl_b32 s71, s71, 18
s_add_u32 s71, s71, s94
s_add_u32 m0, s77, 49152
s_add_u32 s72, s71, 0
buffer_load_dwordx4 v15, s[24:27], s72 offen lds
v_mfma_f32_16x16x32_bf16 v[32:35], v[224:227], a[24:27], v[32:35]
s_add_u32 s72, s71, 15360
ds_read_b64_tr_b16 v[140:141], v11 offset:16384
ds_read_b64_tr_b16 v[142:143], v11 offset:18432
v_mfma_f32_16x16x32_bf16 v[32:35], v[208:211], a[20:23], v[32:35]
ds_read_b64_tr_b16 v[144:145], v8 offset:20480
v_mfma_f32_16x16x32_bf16 v[32:35], v[192:195], a[16:19], v[32:35]
buffer_load_dwordx4 v15, s[24:27], s72 offen offset:1024 lds
v_mfma_f32_16x16x32_bf16 v[36:39], v[196:199], a[16:19], v[36:39]
s_add_u32 s72, s71, 30720
ds_read_b64_tr_b16 v[146:147], v8 offset:22528
ds_read_b64_tr_b16 v[148:149], v9 offset:20480
v_mfma_f32_16x16x32_bf16 v[36:39], v[212:215], a[20:23], v[36:39]
ds_read_b64_tr_b16 v[150:151], v9 offset:22528
ds_read_b64_tr_b16 v[152:153], v10 offset:20480
v_mfma_f32_16x16x32_bf16 v[36:39], v[228:231], a[24:27], v[36:39]
buffer_load_dwordx4 v15, s[24:27], s72 offen offset:2048 lds
v_mfma_f32_16x16x32_bf16 v[36:39], v[244:247], a[28:31], v[36:39]
s_add_u32 s72, s71, 46080
ds_read_b64_tr_b16 v[154:155], v10 offset:22528
ds_read_b64_tr_b16 v[156:157], v11 offset:20480
v_mfma_f32_16x16x32_bf16 v[20:23], v[244:247], a[12:15], v[20:23]
ds_read_b64_tr_b16 v[158:159], v11 offset:22528
v_mfma_f32_16x16x32_bf16 v[20:23], v[228:231], a[8:11], v[20:23]
buffer_load_dwordx4 v15, s[24:27], s72 offen offset:3072 lds
v_mfma_f32_16x16x32_bf16 v[20:23], v[212:215], a[4:7], v[20:23]
s_add_u32 s69, s61, 3
ds_read_b64_tr_b16 v[160:161], v8 offset:24576
ds_read_b64_tr_b16 v[162:163], v8 offset:26624
v_mfma_f32_16x16x32_bf16 v[20:23], v[196:199], a[0:3], v[20:23]
s_and_b32 s69, s69, 3
s_add_u32 s69, s69, s78
s_lshl_b32 s69, s69, 12
s_add_u32 s69, s69, s95
buffer_load_dwordx4 a[96:99], v1, s[44:47], s69 offen sc1
v_mfma_f32_16x16x32_bf16 v[24:27], v[200:203], a[0:3], v[24:27]
ds_read_b64_tr_b16 v[164:165], v9 offset:24576
ds_read_b64_tr_b16 v[166:167], v9 offset:26624
v_mfma_f32_16x16x32_bf16 v[24:27], v[216:219], a[4:7], v[24:27]
ds_read_b64_tr_b16 v[168:169], v10 offset:24576
ds_read_b64_tr_b16 v[170:171], v10 offset:26624
v_mfma_f32_16x16x32_bf16 v[24:27], v[232:235], a[8:11], v[24:27]
buffer_load_dwordx4 a[100:103], v1, s[44:47], s69 offen offset:1024 sc1
v_mfma_f32_16x16x32_bf16 v[24:27], v[248:251], a[12:15], v[24:27]
ds_read_b64_tr_b16 v[172:173], v11 offset:24576
ds_read_b64_tr_b16 v[174:175], v11 offset:26624
v_mfma_f32_16x16x32_bf16 v[40:43], v[248:251], a[28:31], v[40:43]
ds_read_b64_tr_b16 v[176:177], v8 offset:28672
v_mfma_f32_16x16x32_bf16 v[40:43], v[232:235], a[24:27], v[40:43]
buffer_load_dwordx4 a[104:107], v1, s[44:47], s69 offen offset:2048 sc1
v_mfma_f32_16x16x32_bf16 v[40:43], v[216:219], a[20:23], v[40:43]
ds_read_b64_tr_b16 v[178:179], v8 offset:30720
ds_read_b64_tr_b16 v[180:181], v9 offset:28672
v_mfma_f32_16x16x32_bf16 v[40:43], v[200:203], a[16:19], v[40:43]
ds_read_b64_tr_b16 v[182:183], v9 offset:30720
ds_read_b64_tr_b16 v[184:185], v10 offset:28672
v_mfma_f32_16x16x32_bf16 v[44:47], v[204:207], a[16:19], v[44:47]
buffer_load_dwordx4 a[108:111], v1, s[44:47], s69 offen offset:3072 sc1
v_mfma_f32_16x16x32_bf16 v[44:47], v[220:223], a[20:23], v[44:47]
s_add_u32 s69, s69, 0x20000
ds_read_b64_tr_b16 v[186:187], v10 offset:30720
ds_read_b64_tr_b16 v[188:189], v11 offset:28672
v_mfma_f32_16x16x32_bf16 v[44:47], v[236:239], a[24:27], v[44:47]
ds_read_b64_tr_b16 v[190:191], v11 offset:30720
v_mfma_f32_16x16x32_bf16 v[44:47], v[252:255], a[28:31], v[44:47]
buffer_load_dwordx4 a[112:115], v1, s[44:47], s69 offen sc1
v_mfma_f32_16x16x32_bf16 v[28:31], v[252:255], a[12:15], v[28:31]
v_mfma_f32_16x16x32_bf16 v[28:31], v[236:239], a[8:11], v[28:31]
buffer_load_dwordx4 a[116:119], v1, s[44:47], s69 offen offset:1024 sc1
v_mfma_f32_16x16x32_bf16 v[28:31], v[220:223], a[4:7], v[28:31]
s_waitcnt vmcnt(18) lgkmcnt(0)
v_mfma_f32_16x16x32_bf16 v[28:31], v[204:207], a[0:3], v[28:31]
s_barrier
v_mfma_f32_16x16x32_bf16 v[16:19], v[128:131], a[32:35], v[16:19]
buffer_load_dwordx4 a[120:123], v1, s[44:47], s69 offen offset:2048 sc1
v_mfma_f32_16x16x32_bf16 v[16:19], v[144:147], a[36:39], v[16:19]
ds_read_b64_tr_b16 v[192:193], v8 offset:32768
ds_read_b64_tr_b16 v[194:195], v8 offset:34816
v_mfma_f32_16x16x32_bf16 v[16:19], v[160:163], a[40:43], v[16:19]
ds_read_b64_tr_b16 v[196:197], v9 offset:32768
ds_read_b64_tr_b16 v[198:199], v9 offset:34816
v_mfma_f32_16x16x32_bf16 v[16:19], v[176:179], a[44:47], v[16:19]
buffer_load_dwordx4 a[124:127], v1, s[44:47], s69 offen offset:3072 sc1
v_mfma_f32_16x16x32_bf16 v[32:35], v[176:179], a[60:63], v[32:35]
s_add_u32 s79, s59, 16
ds_read_b64_tr_b16 v[200:201], v10 offset:32768
ds_read_b64_tr_b16 v[202:203], v10 offset:34816
v_mfma_f32_16x16x32_bf16 v[32:35], v[160:163], a[56:59], v[32:35]
s_and_b32 s79, s79, 28
ds_read_b64_tr_b16 v[204:205], v11 offset:32768
ds_read_b64_tr_b16 v[206:207], v11 offset:34816
v_mfma_f32_16x16x32_bf16 v[32:35], v[144:147], a[52:55], v[32:35]
s_add_u32 s71, s61, 0
s_and_b32 s71, s71, 3
s_add_u32 s71, s71, s79
s_lshl_b32 s71, s71, 18
s_add_u32 s71, s71, s94
s_add_u32 m0, s77, 0
s_add_u32 s72, s71, 0
buffer_load_dwordx4 v15, s[24:27], s72 offen lds
v_mfma_f32_16x16x32_bf16 v[32:35], v[128:131], a[48:51], v[32:35]
s_add_u32 s72, s71, 15360
ds_read_b64_tr_b16 v[208:209], v8 offset:36864
ds_read_b64_tr_b16 v[210:211], v8 offset:38912
v_mfma_f32_16x16x32_bf16 v[36:39], v[132:135], a[48:51], v[36:39]
buffer_load_dwordx4 v15, s[24:27], s72 offen offset:1024 lds
v_mfma_f32_16x16x32_bf16 v[36:39], v[148:151], a[52:55], v[36:39]
s_add_u32 s72, s71, 30720
ds_read_b64_tr_b16 v[212:213], v9 offset:36864
ds_read_b64_tr_b16 v[214:215], v9 offset:38912
v_mfma_f32_16x16x32_bf16 v[36:39], v[164:167], a[56:59], v[36:39]
ds_read_b64_tr_b16 v[216:217], v10 offset:36864
ds_read_b64_tr_b16 v[218:219], v10 offset:38912
v_mfma_f32_16x16x32_bf16 v[36:39], v[180:183], a[60:63], v[36:39]
buffer_load_dwordx4 v15, s[24:27], s72 offen offset:2048 lds
v_mfma_f32_16x16x32_bf16 v[20:23], v[180:183], a[44:47], v[20:23]
s_add_u32 s72, s71, 46080
ds_read_b64_tr_b16 v[220:221], v11 offset:36864
ds_read_b64_tr_b16 v[222:223], v11 offset:38912
v_mfma_f32_16x16x32_bf16 v[20:23], v[164:167], a[40:43], v[20:23]
ds_read_b64_tr_b16 v[224:225], v8 offset:40960
v_mfma_f32_16x16x32_bf16 v[20:23], v[148:151], a[36:39], v[20:23]
buffer_load_dwordx4 v15, s[24:27], s72 offen offset:3072 lds
v_mfma_f32_16x16x32_bf16 v[20:23], v[132:135], a[32:35], v[20:23]
ds_read_b64_tr_b16 v[226:227], v8 offset:43008
ds_read_b64_tr_b16 v[228:229], v9 offset:40960
v_mfma_f32_16x16x32_bf16 v[24:27], v[136:139], a[32:35], v[24:27]
ds_read_b64_tr_b16 v[230:231], v9 offset:43008
ds_read_b64_tr_b16 v[232:233], v10 offset:40960
v_mfma_f32_16x16x32_bf16 v[24:27], v[152:155], a[36:39], v[24:27]
s_waitcnt vmcnt(48)
v_cmp_gt_u32 vcc, 2, v3
s_cbranch_vccnz Lspin69
Lback70:
s_add_u32 s82, s59, 20
s_and_b32 s82, s82, 28
s_lshl_b32 s82, s82, 10
s_add_u32 s82, s82, s74
buffer_load_dword v3, v2, s[44:47], s82 offen sc1
s_add_u32 s69, s61, 0
s_and_b32 s69, s69, 3
s_add_u32 s69, s69, s79
s_lshl_b32 s69, s69, 12
s_add_u32 s69, s69, s95
buffer_load_dwordx4 a[0:3], v1, s[44:47], s69 offen sc1
v_mfma_f32_16x16x32_bf16 v[24:27], v[168:171], a[40:43], v[24:27]
ds_read_b64_tr_b16 v[234:235], v10 offset:43008
ds_read_b64_tr_b16 v[236:237], v11 offset:40960
v_mfma_f32_16x16x32_bf16 v[24:27], v[184:187], a[44:47], v[24:27]
buffer_load_dwordx4 a[4:7], v1, s[44:47], s69 offen offset:1024 sc1
v_mfma_f32_16x16x32_bf16 v[40:43], v[184:187], a[60:63], v[40:43]
ds_read_b64_tr_b16 v[238:239], v11 offset:43008
ds_read_b64_tr_b16 v[240:241], v8 offset:45056
v_mfma_f32_16x16x32_bf16 v[40:43], v[168:171], a[56:59], v[40:43]
ds_read_b64_tr_b16 v[242:243], v8 offset:47104
ds_read_b64_tr_b16 v[244:245], v9 offset:45056
v_mfma_f32_16x16x32_bf16 v[40:43], v[152:155], a[52:55], v[40:43]
buffer_load_dwordx4 a[8:11], v1, s[44:47], s69 offen offset:2048 sc1
v_mfma_f32_16x16x32_bf16 v[40:43], v[136:139], a[48:51], v[40:43]
ds_read_b64_tr_b16 v[246:247], v9 offset:47104
ds_read_b64_tr_b16 v[248:249], v10 offset:45056
v_mfma_f32_16x16x32_bf16 v[44:47], v[140:143], a[48:51], v[44:47]
ds_read_b64_tr_b16 v[250:251], v10 offset:47104
ds_read_b64_tr_b16 v[252:253], v11 offset:45056
v_mfma_f32_16x16x32_bf16 v[44:47], v[156:159], a[52:55], v[44:47]
buffer_load_dwordx4 a[12:15], v1, s[44:47], s69 offen offset:3072 sc1
v_mfma_f32_16x16x32_bf16 v[44:47], v[172:175], a[56:59], v[44:47]
s_add_u32 s69, s69, 0x20000
ds_read_b64_tr_b16 v[254:255], v11 offset:47104
v_mfma_f32_16x16x32_bf16 v[44:47], v[188:191], a[60:63], v[44:47]
v_mfma_f32_16x16x32_bf16 v[28:31], v[188:191], a[44:47], v[28:31]
buffer_load_dwordx4 a[16:19], v1, s[44:47], s69 offen sc1
v_mfma_f32_16x16x32_bf16 v[28:31], v[172:175], a[40:43], v[28:31]
v_mfma_f32_16x16x32_bf16 v[28:31], v[156:159], a[36:39], v[28:31]
s_waitcnt vmcnt(18) lgkmcnt(0)
v_mfma_f32_16x16x32_bf16 v[28:31], v[140:143], a[32:35], v[28:31]
s_barrier
buffer_load_dwordx4 a[20:23], v1, s[44:47], s69 offen offset:1024 sc1
v_mfma_f32_16x16x32_bf16 v[16:19], v[192:195], a[64:67], v[16:19]
ds_read_b64_tr_b16 v[128:129], v8 offset:49152
ds_read_b64_tr_b16 v[130:131], v8 offset:51200
v_mfma_f32_16x16x32_bf16 v[16:19], v[208:211], a[68:71], v[16:19]
buffer_load_dwordx4 a[24:27], v1, s[44:47], s69 offen offset:2048 sc1
v_mfma_f32_16x16x32_bf16 v[16:19], v[224:227], a[72:75], v[16:19]
ds_read_b64_tr_b16 v[132:133], v9 offset:49152
ds_read_b64_tr_b16 v[134:135], v9 offset:51200
v_mfma_f32_16x16x32_bf16 v[16:19], v[240:243], a[76:79], v[16:19]
ds_read_b64_tr_b16 v[136:137], v10 offset:49152
ds_read_b64_tr_b16 v[138:139], v10 offset:51200
v_mfma_f32_16x16x32_bf16 v[32:35], v[240:243], a[92:95], v[32:35]
buffer_load_dwordx4 a[28:31], v1, s[44:47], s69 offen offset:3072 sc1
v_mfma_f32_16x16x32_bf16 v[32:35], v[224:227], a[88:91], v[32:35]
s_add_u32 s71, s61, 1
ds_read_b64_tr_b16 v[140:141], v11 offset:49152
ds_read_b64_tr_b16 v[142:143], v11 offset:51200
v_mfma_f32_16x16x32_bf16 v[32:35], v[208:211], a[84:87], v[32:35]
s_and_b32 s71, s71, 3
ds_read_b64_tr_b16 v[144:145], v8 offset:53248
ds_read_b64_tr_b16 v[146:147], v8 offset:55296
v_mfma_f32_16x16x32_bf16 v[32:35], v[192:195], a[80:83], v[32:35]
s_add_u32 s71, s71, s79
s_lshl_b32 s71, s71, 18
s_add_u32 s71, s71, s94
s_add_u32 m0, s77, 16384
s_add_u32 s72, s71, 0
buffer_load_dwordx4 v15, s[24:27], s72 offen lds
v_mfma_f32_16x16x32_bf16 v[36:39], v[196:199], a[80:83], v[36:39]
s_add_u32 s72, s71, 15360
ds_read_b64_tr_b16 v[148:149], v9 offset:53248
ds_read_b64_tr_b16 v[150:151], v9 offset:55296
v_mfma_f32_16x16x32_bf16 v[36:39], v[212:215], a[84:87], v[36:39]
ds_read_b64_tr_b16 v[152:153], v10 offset:53248
ds_read_b64_tr_b16 v[154:155], v10 offset:55296
v_mfma_f32_16x16x32_bf16 v[36:39], v[228:231], a[88:91], v[36:39]
buffer_load_dwordx4 v15, s[24:27], s72 offen offset:1024 lds
v_mfma_f32_16x16x32_bf16 v[36:39], v[244:247], a[92:95], v[36:39]
s_add_u32 s72, s71, 30720
ds_read_b64_tr_b16 v[156:157], v11 offset:53248
ds_read_b64_tr_b16 v[158:159], v11 offset:55296
v_mfma_f32_16x16x32_bf16 v[20:23], v[244:247], a[76:79], v[20:23]
buffer_load_dwordx4 v15, s[24:27], s72 offen offset:2048 lds
v_mfma_f32_16x16x32_bf16 v[20:23], v[228:231], a[72:75], v[20:23]
s_add_u32 s72, s71, 46080
ds_read_b64_tr_b16 v[160:161], v8 offset:57344
v_mfma_f32_16x16x32_bf16 v[20:23], v[212:215], a[68:71], v[20:23]
ds_read_b64_tr_b16 v[162:163], v8 offset:59392
ds_read_b64_tr_b16 v[164:165], v9 offset:57344
v_mfma_f32_16x16x32_bf16 v[20:23], v[196:199], a[64:67], v[20:23]
buffer_load_dwordx4 v15, s[24:27], s72 offen offset:3072 lds
v_mfma_f32_16x16x32_bf16 v[24:27], v[200:203], a[64:67], v[24:27]
s_add_u32 s69, s61, 1
ds_read_b64_tr_b16 v[166:167], v9 offset:59392
ds_read_b64_tr_b16 v[168:169], v10 offset:57344
v_mfma_f32_16x16x32_bf16 v[24:27], v[216:219], a[68:71], v[24:27]
s_and_b32 s69, s69, 3
ds_read_b64_tr_b16 v[170:171], v10 offset:59392
ds_read_b64_tr_b16 v[172:173], v11 offset:57344
v_mfma_f32_16x16x32_bf16 v[24:27], v[232:235], a[72:75], v[24:27]
s_add_u32 s69, s69, s79
s_lshl_b32 s69, s69, 12
s_add_u32 s69, s69, s95
buffer_load_dwordx4 a[32:35], v1, s[44:47], s69 offen sc1
v_mfma_f32_16x16x32_bf16 v[24:27], v[248:251], a[76:79], v[24:27]
ds_read_b64_tr_b16 v[174:175], v11 offset:59392
ds_read_b64_tr_b16 v[176:177], v8 offset:61440
v_mfma_f32_16x16x32_bf16 v[40:43], v[248:251], a[92:95], v[40:43]
ds_read_b64_tr_b16 v[178:179], v8 offset:63488
ds_read_b64_tr_b16 v[180:181], v9 offset:61440
v_mfma_f32_16x16x32_bf16 v[40:43], v[232:235], a[88:91], v[40:43]
buffer_load_dwordx4 a[36:39], v1, s[44:47], s69 offen offset:1024 sc1
v_mfma_f32_16x16x32_bf16 v[40:43], v[216:219], a[84:87], v[40:43]
ds_read_b64_tr_b16 v[182:183], v9 offset:63488
ds_read_b64_tr_b16 v[184:185], v10 offset:61440
v_mfma_f32_16x16x32_bf16 v[40:43], v[200:203], a[80:83], v[40:43]
ds_read_b64_tr_b16 v[186:187], v10 offset:63488
ds_read_b64_tr_b16 v[188:189], v11 offset:61440
v_mfma_f32_16x16x32_bf16 v[44:47], v[204:207], a[80:83], v[44:47]
buffer_load_dwordx4 a[40:43], v1, s[44:47], s69 offen offset:2048 sc1
v_mfma_f32_16x16x32_bf16 v[44:47], v[220:223], a[84:87], v[44:47]
ds_read_b64_tr_b16 v[190:191], v11 offset:63488
v_mfma_f32_16x16x32_bf16 v[44:47], v[236:239], a[88:91], v[44:47]
buffer_load_dwordx4 a[44:47], v1, s[44:47], s69 offen offset:3072 sc1
v_mfma_f32_16x16x32_bf16 v[44:47], v[252:255], a[92:95], v[44:47]
s_add_u32 s69, s69, 0x20000
v_mfma_f32_16x16x32_bf16 v[28:31], v[252:255], a[76:79], v[28:31]
v_mfma_f32_16x16x32_bf16 v[28:31], v[236:239], a[72:75], v[28:31]
buffer_load_dwordx4 a[48:51], v1, s[44:47], s69 offen sc1
v_mfma_f32_16x16x32_bf16 v[28:31], v[220:223], a[68:71], v[28:31]
s_waitcnt vmcnt(18) lgkmcnt(0)
v_mfma_f32_16x16x32_bf16 v[28:31], v[204:207], a[64:67], v[28:31]
s_barrier
v_mfma_f32_16x16x32_bf16 v[16:19], v[128:131], a[96:99], v[16:19]
buffer_load_dwordx4 a[52:55], v1, s[44:47], s69 offen offset:1024 sc1
v_mfma_f32_16x16x32_bf16 v[16:19], v[144:147], a[100:103], v[16:19]
ds_read_b64_tr_b16 v[192:193], v8 offset:0
ds_read_b64_tr_b16 v[194:195], v8 offset:2048
v_mfma_f32_16x16x32_bf16 v[16:19], v[160:163], a[104:107], v[16:19]
ds_read_b64_tr_b16 v[196:197], v9 offset:0
ds_read_b64_tr_b16 v[198:199], v9 offset:2048
v_mfma_f32_16x16x32_bf16 v[16:19], v[176:179], a[108:111], v[16:19]
buffer_load_dwordx4 a[56:59], v1, s[44:47], s69 offen offset:2048 sc1
v_mfma_f32_16x16x32_bf16 v[32:35], v[176:179], a[124:127], v[32:35]
ds_read_b64_tr_b16 v[200:201], v10 offset:0
ds_read_b64_tr_b16 v[202:203], v10 offset:2048
v_mfma_f32_16x16x32_bf16 v[32:35], v[160:163], a[120:123], v[32:35]
buffer_load_dwordx4 a[60:63], v1, s[44:47], s69 offen offset:3072 sc1
v_mfma_f32_16x16x32_bf16 v[32:35], v[144:147], a[116:119], v[32:35]
s_add_u32 s71, s61, 2
ds_read_b64_tr_b16 v[204:205], v11 offset:0
ds_read_b64_tr_b16 v[206:207], v11 offset:2048
v_mfma_f32_16x16x32_bf16 v[32:35], v[128:131], a[112:115], v[32:35]
s_and_b32 s71, s71, 3
ds_read_b64_tr_b16 v[208:209], v8 offset:4096
ds_read_b64_tr_b16 v[210:211], v8 offset:6144
v_mfma_f32_16x16x32_bf16 v[36:39], v[132:135], a[112:115], v[36:39]
s_add_u32 s71, s71, s79
s_lshl_b32 s71, s71, 18
s_add_u32 s71, s71, s94
s_add_u32 m0, s77, 32768
s_add_u32 s72, s71, 0
buffer_load_dwordx4 v15, s[24:27], s72 offen lds
v_mfma_f32_16x16x32_bf16 v[36:39], v[148:151], a[116:119], v[36:39]
s_add_u32 s72, s71, 15360
ds_read_b64_tr_b16 v[212:213], v9 offset:4096
ds_read_b64_tr_b16 v[214:215], v9 offset:6144
v_mfma_f32_16x16x32_bf16 v[36:39], v[164:167], a[120:123], v[36:39]
ds_read_b64_tr_b16 v[216:217], v10 offset:4096
ds_read_b64_tr_b16 v[218:219], v10 offset:6144
v_mfma_f32_16x16x32_bf16 v[36:39], v[180:183], a[124:127], v[36:39]
buffer_load_dwordx4 v15, s[24:27], s72 offen offset:1024 lds
v_mfma_f32_16x16x32_bf16 v[20:23], v[180:183], a[108:111], v[20:23]
s_add_u32 s72, s71, 30720
ds_read_b64_tr_b16 v[220:221], v11 offset:4096
ds_read_b64_tr_b16 v[222:223], v11 offset:6144
v_mfma_f32_16x16x32_bf16 v[20:23], v[164:167], a[104:107], v[20:23]
ds_read_b64_tr_b16 v[224:225], v8 offset:8192
v_mfma_f32_16x16x32_bf16 v[20:23], v[148:151], a[100:103], v[20:23]
buffer_load_dwordx4 v15, s[24:27], s72 offen offset:2048 lds
v_mfma_f32_16x16x32_bf16 v[20:23], v[132:135], a[96:99], v[20:23]
s_add_u32 s72, s71, 46080
ds_read_b64_tr_b16 v[226:227], v8 offset:10240
ds_read_b64_tr_b16 v[228:229], v9 offset:8192
v_mfma_f32_16x16x32_bf16 v[24:27], v[136:139], a[96:99], v[24:27]
ds_read_b64_tr_b16 v[230:231], v9 offset:10240
ds_read_b64_tr_b16 v[232:233], v10 offset:8192
v_mfma_f32_16x16x32_bf16 v[24:27], v[152:155], a[100:103], v[24:27]
buffer_load_dwordx4 v15, s[24:27], s72 offen offset:3072 lds
v_mfma_f32_16x16x32_bf16 v[24:27], v[168:171], a[104:107], v[24:27]
s_add_u32 s69, s61, 2
ds_read_b64_tr_b16 v[234:235], v10 offset:10240
ds_read_b64_tr_b16 v[236:237], v11 offset:8192
v_mfma_f32_16x16x32_bf16 v[24:27], v[184:187], a[108:111], v[24:27]
s_and_b32 s69, s69, 3
s_add_u32 s69, s69, s79
s_lshl_b32 s69, s69, 12
s_add_u32 s69, s69, s95
buffer_load_dwordx4 a[64:67], v1, s[44:47], s69 offen sc1
v_mfma_f32_16x16x32_bf16 v[40:43], v[184:187], a[124:127], v[40:43]
ds_read_b64_tr_b16 v[238:239], v11 offset:10240
ds_read_b64_tr_b16 v[240:241], v8 offset:12288
v_mfma_f32_16x16x32_bf16 v[40:43], v[168:171], a[120:123], v[40:43]
ds_read_b64_tr_b16 v[242:243], v8 offset:14336
ds_read_b64_tr_b16 v[244:245], v9 offset:12288
v_mfma_f32_16x16x32_bf16 v[40:43], v[152:155], a[116:119], v[40:43]
buffer_load_dwordx4 a[68:71], v1, s[44:47], s69 offen offset:1024 sc1
v_mfma_f32_16x16x32_bf16 v[40:43], v[136:139], a[112:115], v[40:43]
ds_read_b64_tr_b16 v[246:247], v9 offset:14336
ds_read_b64_tr_b16 v[248:249], v10 offset:12288
v_mfma_f32_16x16x32_bf16 v[44:47], v[140:143], a[112:115], v[44:47]
ds_read_b64_tr_b16 v[250:251], v10 offset:14336
ds_read_b64_tr_b16 v[252:253], v11 offset:12288
v_mfma_f32_16x16x32_bf16 v[44:47], v[156:159], a[116:119], v[44:47]
buffer_load_dwordx4 a[72:75], v1, s[44:47], s69 offen offset:2048 sc1
v_mfma_f32_16x16x32_bf16 v[44:47], v[172:175], a[120:123], v[44:47]
ds_read_b64_tr_b16 v[254:255], v11 offset:14336
v_mfma_f32_16x16x32_bf16 v[44:47], v[188:191], a[124:127], v[44:47]
v_mfma_f32_16x16x32_bf16 v[28:31], v[188:191], a[108:111], v[28:31]
buffer_load_dwordx4 a[76:79], v1, s[44:47], s69 offen offset:3072 sc1
v_mfma_f32_16x16x32_bf16 v[28:31], v[172:175], a[104:107], v[28:31]
s_add_u32 s69, s69, 0x20000
v_mfma_f32_16x16x32_bf16 v[28:31], v[156:159], a[100:103], v[28:31]
s_waitcnt vmcnt(16) lgkmcnt(0)
buffer_load_dwordx4 a[80:83], v1, s[44:47], s69 offen sc1
v_mfma_f32_16x16x32_bf16 v[28:31], v[140:143], a[96:99], v[28:31]
s_barrier
v_mfma_f32_16x16x32_bf16 v[16:19], v[192:195], a[0:3], v[16:19]
ds_read_b64_tr_b16 v[128:129], v8 offset:16384
ds_read_b64_tr_b16 v[130:131], v8 offset:18432
v_mfma_f32_16x16x32_bf16 v[16:19], v[208:211], a[4:7], v[16:19]
buffer_load_dwordx4 a[84:87], v1, s[44:47], s69 offen offset:1024 sc1
v_mfma_f32_16x16x32_bf16 v[16:19], v[224:227], a[8:11], v[16:19]
ds_read_b64_tr_b16 v[132:133], v9 offset:16384
ds_read_b64_tr_b16 v[134:135], v9 offset:18432
v_mfma_f32_16x16x32_bf16 v[16:19], v[240:243], a[12:15], v[16:19]
ds_read_b64_tr_b16 v[136:137], v10 offset:16384
ds_read_b64_tr_b16 v[138:139], v10 offset:18432
v_mfma_f32_16x16x32_bf16 v[32:35], v[240:243], a[28:31], v[32:35]
buffer_load_dwordx4 a[88:91], v1, s[44:47], s69 offen offset:2048 sc1
v_mfma_f32_16x16x32_bf16 v[32:35], v[224:227], a[24:27], v[32:35]
ds_read_b64_tr_b16 v[140:141], v11 offset:16384
ds_read_b64_tr_b16 v[142:143], v11 offset:18432
v_mfma_f32_16x16x32_bf16 v[32:35], v[208:211], a[20:23], v[32:35]
ds_read_b64_tr_b16 v[144:145], v8 offset:20480
ds_read_b64_tr_b16 v[146:147], v8 offset:22528
v_mfma_f32_16x16x32_bf16 v[32:35], v[192:195], a[16:19], v[32:35]
buffer_load_dwordx4 a[92:95], v1, s[44:47], s69 offen offset:3072 sc1
v_mfma_f32_16x16x32_bf16 v[36:39], v[196:199], a[16:19], v[36:39]
s_add_u32 s71, s61, 3
ds_read_b64_tr_b16 v[148:149], v9 offset:20480
ds_read_b64_tr_b16 v[150:151], v9 offset:22528
v_mfma_f32_16x16x32_bf16 v[36:39], v[212:215], a[20:23], v[36:39]
s_and_b32 s71, s71, 3
s_add_u32 s71, s71, s79
s_lshl_b32 s71, s71, 18
s_add_u32 s71, s71, s94
s_add_u32 m0, s77, 49152
s_add_u32 s72, s71, 0
buffer_load_dwordx4 v15, s[24:27], s72 offen lds
v_mfma_f32_16x16x32_bf16 v[36:39], v[228:231], a[24:27], v[36:39]
s_add_u32 s72, s71, 15360
ds_read_b64_tr_b16 v[152:153], v10 offset:20480
ds_read_b64_tr_b16 v[154:155], v10 offset:22528
v_mfma_f32_16x16x32_bf16 v[36:39], v[244:247], a[28:31], v[36:39]
ds_read_b64_tr_b16 v[156:157], v11 offset:20480
ds_read_b64_tr_b16 v[158:159], v11 offset:22528
v_mfma_f32_16x16x32_bf16 v[20:23], v[244:247], a[12:15], v[20:23]
buffer_load_dwordx4 v15, s[24:27], s72 offen offset:1024 lds
v_mfma_f32_16x16x32_bf16 v[20:23], v[228:231], a[8:11], v[20:23]
s_add_u32 s72, s71, 30720
ds_read_b64_tr_b16 v[160:161], v8 offset:24576
v_mfma_f32_16x16x32_bf16 v[20:23], v[212:215], a[4:7], v[20:23]
ds_read_b64_tr_b16 v[162:163], v8 offset:26624
ds_read_b64_tr_b16 v[164:165], v9 offset:24576
v_mfma_f32_16x16x32_bf16 v[20:23], v[196:199], a[0:3], v[20:23]
buffer_load_dwordx4 v15, s[24:27], s72 offen offset:2048 lds
v_mfma_f32_16x16x32_bf16 v[24:27], v[200:203], a[0:3], v[24:27]
s_add_u32 s72, s71, 46080
ds_read_b64_tr_b16 v[166:167], v9 offset:26624
ds_read_b64_tr_b16 v[168:169], v10 offset:24576
v_mfma_f32_16x16x32_bf16 v[24:27], v[216:219], a[4:7], v[24:27]
ds_read_b64_tr_b16 v[170:171], v10 offset:26624
ds_read_b64_tr_b16 v[172:173], v11 offset:24576
v_mfma_f32_16x16x32_bf16 v[24:27], v[232:235], a[8:11], v[24:27]
buffer_load_dwordx4 v15, s[24:27], s72 offen offset:3072 lds
v_mfma_f32_16x16x32_bf16 v[24:27], v[248:251], a[12:15], v[24:27]
s_add_u32 s69, s61, 3
ds_read_b64_tr_b16 v[174:175], v11 offset:26624
ds_read_b64_tr_b16 v[176:177], v8 offset:28672
v_mfma_f32_16x16x32_bf16 v[40:43], v[248:251], a[28:31], v[40:43]
s_and_b32 s69, s69, 3
ds_read_b64_tr_b16 v[178:179], v8 offset:30720
ds_read_b64_tr_b16 v[180:181], v9 offset:28672
v_mfma_f32_16x16x32_bf16 v[40:43], v[232:235], a[24:27], v[40:43]
s_add_u32 s69, s69, s79
s_lshl_b32 s69, s69, 12
s_add_u32 s69, s69, s95
buffer_load_dwordx4 a[96:99], v1, s[44:47], s69 offen sc1
v_mfma_f32_16x16x32_bf16 v[40:43], v[216:219], a[20:23], v[40:43]
ds_read_b64_tr_b16 v[182:183], v9 offset:30720
ds_read_b64_tr_b16 v[184:185], v10 offset:28672
v_mfma_f32_16x16x32_bf16 v[40:43], v[200:203], a[16:19], v[40:43]
buffer_load_dwordx4 a[100:103], v1, s[44:47], s69 offen offset:1024 sc1
v_mfma_f32_16x16x32_bf16 v[44:47], v[204:207], a[16:19], v[44:47]
ds_read_b64_tr_b16 v[186:187], v10 offset:30720
ds_read_b64_tr_b16 v[188:189], v11 offset:28672
v_mfma_f32_16x16x32_bf16 v[44:47], v[220:223], a[20:23], v[44:47]
ds_read_b64_tr_b16 v[190:191], v11 offset:30720
v_mfma_f32_16x16x32_bf16 v[44:47], v[236:239], a[24:27], v[44:47]
buffer_load_dwordx4 a[104:107], v1, s[44:47], s69 offen offset:2048 sc1
v_mfma_f32_16x16x32_bf16 v[44:47], v[252:255], a[28:31], v[44:47]
v_mfma_f32_16x16x32_bf16 v[28:31], v[252:255], a[12:15], v[28:31]
v_mfma_f32_16x16x32_bf16 v[28:31], v[236:239], a[8:11], v[28:31]
buffer_load_dwordx4 a[108:111], v1, s[44:47], s69 offen offset:3072 sc1
v_mfma_f32_16x16x32_bf16 v[28:31], v[220:223], a[4:7], v[28:31]
s_waitcnt vmcnt(16) lgkmcnt(0)
v_mfma_f32_16x16x32_bf16 v[28:31], v[204:207], a[0:3], v[28:31]
s_barrier
v_mfma_f32_16x16x32_bf16 v[16:19], v[128:131], a[32:35], v[16:19]
s_add_u32 s69, s69, 0x20000
buffer_load_dwordx4 a[112:115], v1, s[44:47], s69 offen sc1
v_mfma_f32_16x16x32_bf16 v[16:19], v[144:147], a[36:39], v[16:19]
ds_read_b64_tr_b16 v[192:193], v8 offset:32768
ds_read_b64_tr_b16 v[194:195], v8 offset:34816
v_mfma_f32_16x16x32_bf16 v[16:19], v[160:163], a[40:43], v[16:19]
buffer_load_dwordx4 a[116:119], v1, s[44:47], s69 offen offset:1024 sc1
v_mfma_f32_16x16x32_bf16 v[16:19], v[176:179], a[44:47], v[16:19]
ds_read_b64_tr_b16 v[196:197], v9 offset:32768
ds_read_b64_tr_b16 v[198:199], v9 offset:34816
v_mfma_f32_16x16x32_bf16 v[32:35], v[176:179], a[60:63], v[32:35]
ds_read_b64_tr_b16 v[200:201], v10 offset:32768
ds_read_b64_tr_b16 v[202:203], v10 offset:34816
v_mfma_f32_16x16x32_bf16 v[32:35], v[160:163], a[56:59], v[32:35]
buffer_load_dwordx4 a[120:123], v1, s[44:47], s69 offen offset:2048 sc1
v_mfma_f32_16x16x32_bf16 v[32:35], v[144:147], a[52:55], v[32:35]
ds_read_b64_tr_b16 v[204:205], v11 offset:32768
ds_read_b64_tr_b16 v[206:207], v11 offset:34816
v_mfma_f32_16x16x32_bf16 v[32:35], v[128:131], a[48:51], v[32:35]
ds_read_b64_tr_b16 v[208:209], v8 offset:36864
ds_read_b64_tr_b16 v[210:211], v8 offset:38912
v_mfma_f32_16x16x32_bf16 v[36:39], v[132:135], a[48:51], v[36:39]
buffer_load_dwordx4 a[124:127], v1, s[44:47], s69 offen offset:3072 sc1
v_mfma_f32_16x16x32_bf16 v[36:39], v[148:151], a[52:55], v[36:39]
s_add_u32 s78, s59, 20
ds_read_b64_tr_b16 v[212:213], v9 offset:36864
ds_read_b64_tr_b16 v[214:215], v9 offset:38912
v_mfma_f32_16x16x32_bf16 v[36:39], v[164:167], a[56:59], v[36:39]
s_and_b32 s78, s78, 28
ds_read_b64_tr_b16 v[216:217], v10 offset:36864
ds_read_b64_tr_b16 v[218:219], v10 offset:38912
v_mfma_f32_16x16x32_bf16 v[36:39], v[180:183], a[60:63], v[36:39]
s_add_u32 s71, s61, 0
s_and_b32 s71, s71, 3
s_add_u32 s71, s71, s78
s_lshl_b32 s71, s71, 18
s_add_u32 s71, s71, s94
s_add_u32 m0, s77, 0
s_add_u32 s72, s71, 0
buffer_load_dwordx4 v15, s[24:27], s72 offen lds
v_mfma_f32_16x16x32_bf16 v[20:23], v[180:183], a[44:47], v[20:23]
s_add_u32 s72, s71, 15360
ds_read_b64_tr_b16 v[220:221], v11 offset:36864
ds_read_b64_tr_b16 v[222:223], v11 offset:38912
v_mfma_f32_16x16x32_bf16 v[20:23], v[164:167], a[40:43], v[20:23]
ds_read_b64_tr_b16 v[224:225], v8 offset:40960
v_mfma_f32_16x16x32_bf16 v[20:23], v[148:151], a[36:39], v[20:23]
buffer_load_dwordx4 v15, s[24:27], s72 offen offset:1024 lds
v_mfma_f32_16x16x32_bf16 v[20:23], v[132:135], a[32:35], v[20:23]
s_add_u32 s72, s71, 30720
ds_read_b64_tr_b16 v[226:227], v8 offset:43008
ds_read_b64_tr_b16 v[228:229], v9 offset:40960
v_mfma_f32_16x16x32_bf16 v[24:27], v[136:139], a[32:35], v[24:27]
buffer_load_dwordx4 v15, s[24:27], s72 offen offset:2048 lds
v_mfma_f32_16x16x32_bf16 v[24:27], v[152:155], a[36:39], v[24:27]
s_add_u32 s72, s71, 46080
ds_read_b64_tr_b16 v[230:231], v9 offset:43008
ds_read_b64_tr_b16 v[232:233], v10 offset:40960
v_mfma_f32_16x16x32_bf16 v[24:27], v[168:171], a[40:43], v[24:27]
ds_read_b64_tr_b16 v[234:235], v10 offset:43008
ds_read_b64_tr_b16 v[236:237], v11 offset:40960
v_mfma_f32_16x16x32_bf16 v[24:27], v[184:187], a[44:47], v[24:27]
buffer_load_dwordx4 v15, s[24:27], s72 offen offset:3072 lds
v_mfma_f32_16x16x32_bf16 v[40:43], v[184:187], a[60:63], v[40:43]
ds_read_b64_tr_b16 v[238:239], v11 offset:43008
ds_read_b64_tr_b16 v[240:241], v8 offset:45056
v_mfma_f32_16x16x32_bf16 v[40:43], v[168:171], a[56:59], v[40:43]
ds_read_b64_tr_b16 v[242:243], v8 offset:47104
ds_read_b64_tr_b16 v[244:245], v9 offset:45056
v_mfma_f32_16x16x32_bf16 v[40:43], v[152:155], a[52:55], v[40:43]
s_waitcnt vmcnt(48)
v_cmp_gt_u32 vcc, 2, v3
s_cbranch_vccnz Lspin72
Lback73:
s_add_u32 s82, s59, 24
s_and_b32 s82, s82, 28
s_lshl_b32 s82, s82, 10
s_add_u32 s82, s82, s74
buffer_load_dword v3, v2, s[44:47], s82 offen sc1
s_add_u32 s69, s61, 0
s_and_b32 s69, s69, 3
s_add_u32 s69, s69, s78
s_lshl_b32 s69, s69, 12
s_add_u32 s69, s69, s95
buffer_load_dwordx4 a[0:3], v1, s[44:47], s69 offen sc1
v_mfma_f32_16x16x32_bf16 v[40:43], v[136:139], a[48:51], v[40:43]
ds_read_b64_tr_b16 v[246:247], v9 offset:47104
ds_read_b64_tr_b16 v[248:249], v10 offset:45056
v_mfma_f32_16x16x32_bf16 v[44:47], v[140:143], a[48:51], v[44:47]
ds_read_b64_tr_b16 v[250:251], v10 offset:47104
ds_read_b64_tr_b16 v[252:253], v11 offset:45056
v_mfma_f32_16x16x32_bf16 v[44:47], v[156:159], a[52:55], v[44:47]
buffer_load_dwordx4 a[4:7], v1, s[44:47], s69 offen offset:1024 sc1
v_mfma_f32_16x16x32_bf16 v[44:47], v[172:175], a[56:59], v[44:47]
ds_read_b64_tr_b16 v[254:255], v11 offset:47104
v_mfma_f32_16x16x32_bf16 v[44:47], v[188:191], a[60:63], v[44:47]
buffer_load_dwordx4 a[8:11], v1, s[44:47], s69 offen offset:2048 sc1
v_mfma_f32_16x16x32_bf16 v[28:31], v[188:191], a[44:47], v[28:31]
v_mfma_f32_16x16x32_bf16 v[28:31], v[172:175], a[40:43], v[28:31]
v_mfma_f32_16x16x32_bf16 v[28:31], v[156:159], a[36:39], v[28:31]
s_waitcnt vmcnt(16) lgkmcnt(0)
buffer_load_dwordx4 a[12:15], v1, s[44:47], s69 offen offset:3072 sc1
v_mfma_f32_16x16x32_bf16 v[28:31], v[140:143], a[32:35], v[28:31]
s_barrier
v_mfma_f32_16x16x32_bf16 v[16:19], v[192:195], a[64:67], v[16:19]
s_add_u32 s69, s69, 0x20000
ds_read_b64_tr_b16 v[128:129], v8 offset:49152
ds_read_b64_tr_b16 v[130:131], v8 offset:51200
v_mfma_f32_16x16x32_bf16 v[16:19], v[208:211], a[68:71], v[16:19]
buffer_load_dwordx4 a[16:19], v1, s[44:47], s69 offen sc1
v_mfma_f32_16x16x32_bf16 v[16:19], v[224:227], a[72:75], v[16:19]
ds_read_b64_tr_b16 v[132:133], v9 offset:49152
ds_read_b64_tr_b16 v[134:135], v9 offset:51200
v_mfma_f32_16x16x32_bf16 v[16:19], v[240:243], a[76:79], v[16:19]
ds_read_b64_tr_b16 v[136:137], v10 offset:49152
ds_read_b64_tr_b16 v[138:139], v10 offset:51200
v_mfma_f32_16x16x32_bf16 v[32:35], v[240:243], a[92:95], v[32:35]
buffer_load_dwordx4 a[20:23], v1, s[44:47], s69 offen offset:1024 sc1
v_mfma_f32_16x16x32_bf16 v[32:35], v[224:227], a[88:91], v[32:35]
ds_read_b64_tr_b16 v[140:141], v11 offset:49152
ds_read_b64_tr_b16 v[142:143], v11 offset:51200
v_mfma_f32_16x16x32_bf16 v[32:35], v[208:211], a[84:87], v[32:35]
ds_read_b64_tr_b16 v[144:145], v8 offset:53248
ds_read_b64_tr_b16 v[146:147], v8 offset:55296
v_mfma_f32_16x16x32_bf16 v[32:35], v[192:195], a[80:83], v[32:35]
buffer_load_dwordx4 a[24:27], v1, s[44:47], s69 offen offset:2048 sc1
v_mfma_f32_16x16x32_bf16 v[36:39], v[196:199], a[80:83], v[36:39]
ds_read_b64_tr_b16 v[148:149], v9 offset:53248
ds_read_b64_tr_b16 v[150:151], v9 offset:55296
v_mfma_f32_16x16x32_bf16 v[36:39], v[212:215], a[84:87], v[36:39]
buffer_load_dwordx4 a[28:31], v1, s[44:47], s69 offen offset:3072 sc1
v_mfma_f32_16x16x32_bf16 v[36:39], v[228:231], a[88:91], v[36:39]
s_add_u32 s71, s61, 1
ds_read_b64_tr_b16 v[152:153], v10 offset:53248
ds_read_b64_tr_b16 v[154:155], v10 offset:55296
v_mfma_f32_16x16x32_bf16 v[36:39], v[244:247], a[92:95], v[36:39]
s_and_b32 s71, s71, 3
ds_read_b64_tr_b16 v[156:157], v11 offset:53248
ds_read_b64_tr_b16 v[158:159], v11 offset:55296
v_mfma_f32_16x16x32_bf16 v[20:23], v[244:247], a[76:79], v[20:23]
s_add_u32 s71, s71, s78
s_lshl_b32 s71, s71, 18
s_add_u32 s71, s71, s94
s_add_u32 m0, s77, 16384
s_add_u32 s72, s71, 0
buffer_load_dwordx4 v15, s[24:27], s72 offen lds
v_mfma_f32_16x16x32_bf16 v[20:23], v[228:231], a[72:75], v[20:23]
s_add_u32 s72, s71, 15360
ds_read_b64_tr_b16 v[160:161], v8 offset:57344
v_mfma_f32_16x16x32_bf16 v[20:23], v[212:215], a[68:71], v[20:23]
ds_read_b64_tr_b16 v[162:163], v8 offset:59392
ds_read_b64_tr_b16 v[164:165], v9 offset:57344
v_mfma_f32_16x16x32_bf16 v[20:23], v[196:199], a[64:67], v[20:23]
buffer_load_dwordx4 v15, s[24:27], s72 offen offset:1024 lds
v_mfma_f32_16x16x32_bf16 v[24:27], v[200:203], a[64:67], v[24:27]
s_add_u32 s72, s71, 30720
ds_read_b64_tr_b16 v[166:167], v9 offset:59392
ds_read_b64_tr_b16 v[168:169], v10 offset:57344
v_mfma_f32_16x16x32_bf16 v[24:27], v[216:219], a[68:71], v[24:27]
ds_read_b64_tr_b16 v[170:171], v10 offset:59392
ds_read_b64_tr_b16 v[172:173], v11 offset:57344
v_mfma_f32_16x16x32_bf16 v[24:27], v[232:235], a[72:75], v[24:27]
buffer_load_dwordx4 v15, s[24:27], s72 offen offset:2048 lds
v_mfma_f32_16x16x32_bf16 v[24:27], v[248:251], a[76:79], v[24:27]
s_add_u32 s72, s71, 46080
ds_read_b64_tr_b16 v[174:175], v11 offset:59392
ds_read_b64_tr_b16 v[176:177], v8 offset:61440
v_mfma_f32_16x16x32_bf16 v[40:43], v[248:251], a[92:95], v[40:43]
buffer_load_dwordx4 v15, s[24:27], s72 offen offset:3072 lds
v_mfma_f32_16x16x32_bf16 v[40:43], v[232:235], a[88:91], v[40:43]
s_add_u32 s69, s61, 1
ds_read_b64_tr_b16 v[178:179], v8 offset:63488
ds_read_b64_tr_b16 v[180:181], v9 offset:61440
v_mfma_f32_16x16x32_bf16 v[40:43], v[216:219], a[84:87], v[40:43]
s_and_b32 s69, s69, 3
ds_read_b64_tr_b16 v[182:183], v9 offset:63488
ds_read_b64_tr_b16 v[184:185], v10 offset:61440
v_mfma_f32_16x16x32_bf16 v[40:43], v[200:203], a[80:83], v[40:43]
s_add_u32 s69, s69, s78
s_lshl_b32 s69, s69, 12
s_add_u32 s69, s69, s95
buffer_load_dwordx4 a[32:35], v1, s[44:47], s69 offen sc1
v_mfma_f32_16x16x32_bf16 v[44:47], v[204:207], a[80:83], v[44:47]
ds_read_b64_tr_b16 v[186:187], v10 offset:63488
ds_read_b64_tr_b16 v[188:189], v11 offset:61440
v_mfma_f32_16x16x32_bf16 v[44:47], v[220:223], a[84:87], v[44:47]
ds_read_b64_tr_b16 v[190:191], v11 offset:63488
v_mfma_f32_16x16x32_bf16 v[44:47], v[236:239], a[88:91], v[44:47]
buffer_load_dwordx4 a[36:39], v1, s[44:47], s69 offen offset:1024 sc1
v_mfma_f32_16x16x32_bf16 v[44:47], v[252:255], a[92:95], v[44:47]
v_mfma_f32_16x16x32_bf16 v[28:31], v[252:255], a[76:79], v[28:31]
v_mfma_f32_16x16x32_bf16 v[28:31], v[236:239], a[72:75], v[28:31]
buffer_load_dwordx4 a[40:43], v1, s[44:47], s69 offen offset:2048 sc1
v_mfma_f32_16x16x32_bf16 v[28:31], v[220:223], a[68:71], v[28:31]
s_waitcnt vmcnt(16) lgkmcnt(0)
v_mfma_f32_16x16x32_bf16 v[28:31], v[204:207], a[64:67], v[28:31]
s_barrier
v_mfma_f32_16x16x32_bf16 v[16:19], v[128:131], a[96:99], v[16:19]
buffer_load_dwordx4 a[44:47], v1, s[44:47], s69 offen offset:3072 sc1
v_mfma_f32_16x16x32_bf16 v[16:19], v[144:147], a[100:103], v[16:19]
s_add_u32 s69, s69, 0x20000
ds_read_b64_tr_b16 v[192:193], v8 offset:0
ds_read_b64_tr_b16 v[194:195], v8 offset:2048
v_mfma_f32_16x16x32_bf16 v[16:19], v[160:163], a[104:107], v[16:19]
buffer_load_dwordx4 a[48:51], v1, s[44:47], s69 offen sc1
v_mfma_f32_16x16x32_bf16 v[16:19], v[176:179], a[108:111], v[16:19]
ds_read_b64_tr_b16 v[196:197], v9 offset:0
ds_read_b64_tr_b16 v[198:199], v9 offset:2048
v_mfma_f32_16x16x32_bf16 v[32:35], v[176:179], a[124:127], v[32:35]
ds_read_b64_tr_b16 v[200:201], v10 offset:0
ds_read_b64_tr_b16 v[202:203], v10 offset:2048
v_mfma_f32_16x16x32_bf16 v[32:35], v[160:163], a[120:123], v[32:35]
buffer_load_dwordx4 a[52:55], v1, s[44:47], s69 offen offset:1024 sc1
v_mfma_f32_16x16x32_bf16 v[32:35], v[144:147], a[116:119], v[32:35]
ds_read_b64_tr_b16 v[204:205], v11 offset:0
ds_read_b64_tr_b16 v[206:207], v11 offset:2048
v_mfma_f32_16x16x32_bf16 v[32:35], v[128:131], a[112:115], v[32:35]
ds_read_b64_tr_b16 v[208:209], v8 offset:4096
ds_read_b64_tr_b16 v[210:211], v8 offset:6144
v_mfma_f32_16x16x32_bf16 v[36:39], v[132:135], a[112:115], v[36:39]
buffer_load_dwordx4 a[56:59], v1, s[44:47], s69 offen offset:2048 sc1
v_mfma_f32_16x16x32_bf16 v[36:39], v[148:151], a[116:119], v[36:39]
ds_read_b64_tr_b16 v[212:213], v9 offset:4096
ds_read_b64_tr_b16 v[214:215], v9 offset:6144
v_mfma_f32_16x16x32_bf16 v[36:39], v[164:167], a[120:123], v[36:39]
ds_read_b64_tr_b16 v[216:217], v10 offset:4096
ds_read_b64_tr_b16 v[218:219], v10 offset:6144
v_mfma_f32_16x16x32_bf16 v[36:39], v[180:183], a[124:127], v[36:39]
buffer_load_dwordx4 a[60:63], v1, s[44:47], s69 offen offset:3072 sc1
v_mfma_f32_16x16x32_bf16 v[20:23], v[180:183], a[108:111], v[20:23]
s_add_u32 s71, s61, 2
ds_read_b64_tr_b16 v[220:221], v11 offset:4096
ds_read_b64_tr_b16 v[222:223], v11 offset:6144
v_mfma_f32_16x16x32_bf16 v[20:23], v[164:167], a[104:107], v[20:23]
s_and_b32 s71, s71, 3
s_add_u32 s71, s71, s78
s_lshl_b32 s71, s71, 18
s_add_u32 s71, s71, s94
s_add_u32 m0, s77, 32768
s_add_u32 s72, s71, 0
buffer_load_dwordx4 v15, s[24:27], s72 offen lds
v_mfma_f32_16x16x32_bf16 v[20:23], v[148:151], a[100:103], v[20:23]
s_add_u32 s72, s71, 15360
ds_read_b64_tr_b16 v[224:225], v8 offset:8192
v_mfma_f32_16x16x32_bf16 v[20:23], v[132:135], a[96:99], v[20:23]
ds_read_b64_tr_b16 v[226:227], v8 offset:10240
ds_read_b64_tr_b16 v[228:229], v9 offset:8192
v_mfma_f32_16x16x32_bf16 v[24:27], v[136:139], a[96:99], v[24:27]
buffer_load_dwordx4 v15, s[24:27], s72 offen offset:1024 lds
v_mfma_f32_16x16x32_bf16 v[24:27], v[152:155], a[100:103], v[24:27]
s_add_u32 s72, s71, 30720
ds_read_b64_tr_b16 v[230:231], v9 offset:10240
ds_read_b64_tr_b16 v[232:233], v10 offset:8192
v_mfma_f32_16x16x32_bf16 v[24:27], v[168:171], a[104:107], v[24:27]
ds_read_b64_tr_b16 v[234:235], v10 offset:10240
ds_read_b64_tr_b16 v[236:237], v11 offset:8192
v_mfma_f32_16x16x32_bf16 v[24:27], v[184:187], a[108:111], v[24:27]
buffer_load_dwordx4 v15, s[24:27], s72 offen offset:2048 lds
v_mfma_f32_16x16x32_bf16 v[40:43], v[184:187], a[124:127], v[40:43]
s_add_u32 s72, s71, 46080
ds_read_b64_tr_b16 v[238:239], v11 offset:10240
ds_read_b64_tr_b16 v[240:241], v8 offset:12288
v_mfma_f32_16x16x32_bf16 v[40:43], v[168:171], a[120:123], v[40:43]
ds_read_b64_tr_b16 v[242:243], v8 offset:14336
ds_read_b64_tr_b16 v[244:245], v9 offset:12288
v_mfma_f32_16x16x32_bf16 v[40:43], v[152:155], a[116:119], v[40:43]
buffer_load_dwordx4 v15, s[24:27], s72 offen offset:3072 lds
v_mfma_f32_16x16x32_bf16 v[40:43], v[136:139], a[112:115], v[40:43]
s_add_u32 s69, s61, 2
ds_read_b64_tr_b16 v[246:247], v9 offset:14336
ds_read_b64_tr_b16 v[248:249], v10 offset:12288
v_mfma_f32_16x16x32_bf16 v[44:47], v[140:143], a[112:115], v[44:47]
s_and_b32 s69, s69, 3
s_add_u32 s69, s69, s78
s_lshl_b32 s69, s69, 12
s_add_u32 s69, s69, s95
buffer_load_dwordx4 a[64:67], v1, s[44:47], s69 offen sc1
v_mfma_f32_16x16x32_bf16 v[44:47], v[156:159], a[116:119], v[44:47]
ds_read_b64_tr_b16 v[250:251], v10 offset:14336
ds_read_b64_tr_b16 v[252:253], v11 offset:12288
v_mfma_f32_16x16x32_bf16 v[44:47], v[172:175], a[120:123], v[44:47]
ds_read_b64_tr_b16 v[254:255], v11 offset:14336
v_mfma_f32_16x16x32_bf16 v[44:47], v[188:191], a[124:127], v[44:47]
buffer_load_dwordx4 a[68:71], v1, s[44:47], s69 offen offset:1024 sc1
v_mfma_f32_16x16x32_bf16 v[28:31], v[188:191], a[108:111], v[28:31]
v_mfma_f32_16x16x32_bf16 v[28:31], v[172:175], a[104:107], v[28:31]
v_mfma_f32_16x16x32_bf16 v[28:31], v[156:159], a[100:103], v[28:31]
s_waitcnt vmcnt(14) lgkmcnt(0)
buffer_load_dwordx4 a[72:75], v1, s[44:47], s69 offen offset:2048 sc1
v_mfma_f32_16x16x32_bf16 v[28:31], v[140:143], a[96:99], v[28:31]
s_barrier
v_mfma_f32_16x16x32_bf16 v[16:19], v[192:195], a[0:3], v[16:19]
ds_read_b64_tr_b16 v[128:129], v8 offset:16384
ds_read_b64_tr_b16 v[130:131], v8 offset:18432
v_mfma_f32_16x16x32_bf16 v[16:19], v[208:211], a[4:7], v[16:19]
buffer_load_dwordx4 a[76:79], v1, s[44:47], s69 offen offset:3072 sc1
v_mfma_f32_16x16x32_bf16 v[16:19], v[224:227], a[8:11], v[16:19]
s_add_u32 s69, s69, 0x20000
ds_read_b64_tr_b16 v[132:133], v9 offset:16384
ds_read_b64_tr_b16 v[134:135], v9 offset:18432
v_mfma_f32_16x16x32_bf16 v[16:19], v[240:243], a[12:15], v[16:19]
ds_read_b64_tr_b16 v[136:137], v10 offset:16384
ds_read_b64_tr_b16 v[138:139], v10 offset:18432
v_mfma_f32_16x16x32_bf16 v[32:35], v[240:243], a[28:31], v[32:35]
buffer_load_dwordx4 a[80:83], v1, s[44:47], s69 offen sc1
v_mfma_f32_16x16x32_bf16 v[32:35], v[224:227], a[24:27], v[32:35]
ds_read_b64_tr_b16 v[140:141], v11 offset:16384
ds_read_b64_tr_b16 v[142:143], v11 offset:18432
v_mfma_f32_16x16x32_bf16 v[32:35], v[208:211], a[20:23], v[32:35]
buffer_load_dwordx4 a[84:87], v1, s[44:47], s69 offen offset:1024 sc1
v_mfma_f32_16x16x32_bf16 v[32:35], v[192:195], a[16:19], v[32:35]
ds_read_b64_tr_b16 v[144:145], v8 offset:20480
ds_read_b64_tr_b16 v[146:147], v8 offset:22528
v_mfma_f32_16x16x32_bf16 v[36:39], v[196:199], a[16:19], v[36:39]
ds_read_b64_tr_b16 v[148:149], v9 offset:20480
ds_read_b64_tr_b16 v[150:151], v9 offset:22528
v_mfma_f32_16x16x32_bf16 v[36:39], v[212:215], a[20:23], v[36:39]
buffer_load_dwordx4 a[88:91], v1, s[44:47], s69 offen offset:2048 sc1
v_mfma_f32_16x16x32_bf16 v[36:39], v[228:231], a[24:27], v[36:39]
ds_read_b64_tr_b16 v[152:153], v10 offset:20480
ds_read_b64_tr_b16 v[154:155], v10 offset:22528
v_mfma_f32_16x16x32_bf16 v[36:39], v[244:247], a[28:31], v[36:39]
ds_read_b64_tr_b16 v[156:157], v11 offset:20480
ds_read_b64_tr_b16 v[158:159], v11 offset:22528
v_mfma_f32_16x16x32_bf16 v[20:23], v[244:247], a[12:15], v[20:23]
buffer_load_dwordx4 a[92:95], v1, s[44:47], s69 offen offset:3072 sc1
v_mfma_f32_16x16x32_bf16 v[20:23], v[228:231], a[8:11], v[20:23]
s_add_u32 s71, s61, 3
ds_read_b64_tr_b16 v[160:161], v8 offset:24576
v_mfma_f32_16x16x32_bf16 v[20:23], v[212:215], a[4:7], v[20:23]
s_and_b32 s71, s71, 3
ds_read_b64_tr_b16 v[162:163], v8 offset:26624
ds_read_b64_tr_b16 v[164:165], v9 offset:24576
v_mfma_f32_16x16x32_bf16 v[20:23], v[196:199], a[0:3], v[20:23]
s_add_u32 s71, s71, s78
s_lshl_b32 s71, s71, 18
s_add_u32 s71, s71, s94
s_add_u32 m0, s77, 49152
s_add_u32 s72, s71, 0
buffer_load_dwordx4 v15, s[24:27], s72 offen lds
v_mfma_f32_16x16x32_bf16 v[24:27], v[200:203], a[0:3], v[24:27]
s_add_u32 s72, s71, 15360
ds_read_b64_tr_b16 v[166:167], v9 offset:26624
ds_read_b64_tr_b16 v[168:169], v10 offset:24576
v_mfma_f32_16x16x32_bf16 v[24:27], v[216:219], a[4:7], v[24:27]
buffer_load_dwordx4 v15, s[24:27], s72 offen offset:1024 lds
v_mfma_f32_16x16x32_bf16 v[24:27], v[232:235], a[8:11], v[24:27]
s_add_u32 s72, s71, 30720
ds_read_b64_tr_b16 v[170:171], v10 offset:26624
ds_read_b64_tr_b16 v[172:173], v11 offset:24576
v_mfma_f32_16x16x32_bf16 v[24:27], v[248:251], a[12:15], v[24:27]
ds_read_b64_tr_b16 v[174:175], v11 offset:26624
ds_read_b64_tr_b16 v[176:177], v8 offset:28672
v_mfma_f32_16x16x32_bf16 v[40:43], v[248:251], a[28:31], v[40:43]
buffer_load_dwordx4 v15, s[24:27], s72 offen offset:2048 lds
v_mfma_f32_16x16x32_bf16 v[40:43], v[232:235], a[24:27], v[40:43]
s_add_u32 s72, s71, 46080
ds_read_b64_tr_b16 v[178:179], v8 offset:30720
ds_read_b64_tr_b16 v[180:181], v9 offset:28672
v_mfma_f32_16x16x32_bf16 v[40:43], v[216:219], a[20:23], v[40:43]
ds_read_b64_tr_b16 v[182:183], v9 offset:30720
ds_read_b64_tr_b16 v[184:185], v10 offset:28672
v_mfma_f32_16x16x32_bf16 v[40:43], v[200:203], a[16:19], v[40:43]
buffer_load_dwordx4 v15, s[24:27], s72 offen offset:3072 lds
v_mfma_f32_16x16x32_bf16 v[44:47], v[204:207], a[16:19], v[44:47]
s_add_u32 s69, s61, 3
ds_read_b64_tr_b16 v[186:187], v10 offset:30720
ds_read_b64_tr_b16 v[188:189], v11 offset:28672
v_mfma_f32_16x16x32_bf16 v[44:47], v[220:223], a[20:23], v[44:47]
s_and_b32 s69, s69, 3
ds_read_b64_tr_b16 v[190:191], v11 offset:30720
v_mfma_f32_16x16x32_bf16 v[44:47], v[236:239], a[24:27], v[44:47]
s_add_u32 s69, s69, s78
s_lshl_b32 s69, s69, 12
s_add_u32 s69, s69, s95
buffer_load_dwordx4 a[96:99], v1, s[44:47], s69 offen sc1
v_mfma_f32_16x16x32_bf16 v[44:47], v[252:255], a[28:31], v[44:47]
v_mfma_f32_16x16x32_bf16 v[28:31], v[252:255], a[12:15], v[28:31]
v_mfma_f32_16x16x32_bf16 v[28:31], v[236:239], a[8:11], v[28:31]
buffer_load_dwordx4 a[100:103], v1, s[44:47], s69 offen offset:1024 sc1
s_lshl_b32 s84, s76, 11
s_add_u32 s84, s84, 0x3810000
v_lshrrev_b32 v115, 2, v0
v_lshlrev_b32 v115, 7, v115
buffer_load_dword v114, v115, s[44:47], s84 offen sc1
v_mfma_f32_16x16x32_bf16 v[28:31], v[220:223], a[4:7], v[28:31]
s_waitcnt vmcnt(15) lgkmcnt(0)
v_mfma_f32_16x16x32_bf16 v[28:31], v[204:207], a[0:3], v[28:31]
s_barrier
buffer_load_dwordx4 a[104:107], v1, s[44:47], s69 offen offset:2048 sc1
v_mfma_f32_16x16x32_bf16 v[16:19], v[128:131], a[32:35], v[16:19]
ds_read_b64_tr_b16 v[192:193], v8 offset:32768
ds_read_b64_tr_b16 v[194:195], v8 offset:34816
v_mfma_f32_16x16x32_bf16 v[16:19], v[144:147], a[36:39], v[16:19]
ds_read_b64_tr_b16 v[196:197], v9 offset:32768
ds_read_b64_tr_b16 v[198:199], v9 offset:34816
v_mfma_f32_16x16x32_bf16 v[16:19], v[160:163], a[40:43], v[16:19]
buffer_load_dwordx4 a[108:111], v1, s[44:47], s69 offen offset:3072 sc1
v_mfma_f32_16x16x32_bf16 v[16:19], v[176:179], a[44:47], v[16:19]
s_add_u32 s69, s69, 0x20000
ds_read_b64_tr_b16 v[200:201], v10 offset:32768
ds_read_b64_tr_b16 v[202:203], v10 offset:34816
v_mfma_f32_16x16x32_bf16 v[32:35], v[176:179], a[60:63], v[32:35]
ds_read_b64_tr_b16 v[204:205], v11 offset:32768
ds_read_b64_tr_b16 v[206:207], v11 offset:34816
v_mfma_f32_16x16x32_bf16 v[32:35], v[160:163], a[56:59], v[32:35]
buffer_load_dwordx4 a[112:115], v1, s[44:47], s69 offen sc1
v_mfma_f32_16x16x32_bf16 v[32:35], v[144:147], a[52:55], v[32:35]
ds_read_b64_tr_b16 v[208:209], v8 offset:36864
v_mfma_f32_16x16x32_bf16 v[32:35], v[128:131], a[48:51], v[32:35]
ds_read_b64_tr_b16 v[210:211], v8 offset:38912
ds_read_b64_tr_b16 v[212:213], v9 offset:36864
v_mfma_f32_16x16x32_bf16 v[36:39], v[132:135], a[48:51], v[36:39]
buffer_load_dwordx4 a[116:119], v1, s[44:47], s69 offen offset:1024 sc1
v_mfma_f32_16x16x32_bf16 v[36:39], v[148:151], a[52:55], v[36:39]
ds_read_b64_tr_b16 v[214:215], v9 offset:38912
ds_read_b64_tr_b16 v[216:217], v10 offset:36864
v_mfma_f32_16x16x32_bf16 v[36:39], v[164:167], a[56:59], v[36:39]
buffer_load_dwordx4 a[120:123], v1, s[44:47], s69 offen offset:2048 sc1
v_mfma_f32_16x16x32_bf16 v[36:39], v[180:183], a[60:63], v[36:39]
ds_read_b64_tr_b16 v[218:219], v10 offset:38912
ds_read_b64_tr_b16 v[220:221], v11 offset:36864
v_mfma_f32_16x16x32_bf16 v[20:23], v[180:183], a[44:47], v[20:23]
ds_read_b64_tr_b16 v[222:223], v11 offset:38912
v_mfma_f32_16x16x32_bf16 v[20:23], v[164:167], a[40:43], v[20:23]
buffer_load_dwordx4 a[124:127], v1, s[44:47], s69 offen offset:3072 sc1
v_mfma_f32_16x16x32_bf16 v[20:23], v[148:151], a[36:39], v[20:23]
s_add_u32 s79, s59, 24
ds_read_b64_tr_b16 v[224:225], v8 offset:40960
ds_read_b64_tr_b16 v[226:227], v8 offset:43008
v_mfma_f32_16x16x32_bf16 v[20:23], v[132:135], a[32:35], v[20:23]
s_and_b32 s79, s79, 28
ds_read_b64_tr_b16 v[228:229], v9 offset:40960
ds_read_b64_tr_b16 v[230:231], v9 offset:43008
v_mfma_f32_16x16x32_bf16 v[24:27], v[136:139], a[32:35], v[24:27]
s_add_u32 s71, s61, 0
s_and_b32 s71, s71, 3
s_add_u32 s71, s71, s79
s_lshl_b32 s71, s71, 18
s_add_u32 s71, s71, s94
s_add_u32 m0, s77, 0
s_add_u32 s72, s71, 0
buffer_load_dwordx4 v15, s[24:27], s72 offen lds
v_mfma_f32_16x16x32_bf16 v[24:27], v[152:155], a[36:39], v[24:27]
s_add_u32 s72, s71, 15360
ds_read_b64_tr_b16 v[232:233], v10 offset:40960
ds_read_b64_tr_b16 v[234:235], v10 offset:43008
v_mfma_f32_16x16x32_bf16 v[24:27], v[168:171], a[40:43], v[24:27]
ds_read_b64_tr_b16 v[236:237], v11 offset:40960
ds_read_b64_tr_b16 v[238:239], v11 offset:43008
v_mfma_f32_16x16x32_bf16 v[24:27], v[184:187], a[44:47], v[24:27]
buffer_load_dwordx4 v15, s[24:27], s72 offen offset:1024 lds
v_mfma_f32_16x16x32_bf16 v[40:43], v[184:187], a[60:63], v[40:43]
s_add_u32 s72, s71, 30720
ds_read_b64_tr_b16 v[240:241], v8 offset:45056
v_mfma_f32_16x16x32_bf16 v[40:43], v[168:171], a[56:59], v[40:43]
ds_read_b64_tr_b16 v[242:243], v8 offset:47104
ds_read_b64_tr_b16 v[244:245], v9 offset:45056
v_mfma_f32_16x16x32_bf16 v[40:43], v[152:155], a[52:55], v[40:43]
buffer_load_dwordx4 v15, s[24:27], s72 offen offset:2048 lds
v_mfma_f32_16x16x32_bf16 v[40:43], v[136:139], a[48:51], v[40:43]
s_add_u32 s72, s71, 46080
ds_read_b64_tr_b16 v[246:247], v9 offset:47104
ds_read_b64_tr_b16 v[248:249], v10 offset:45056
v_mfma_f32_16x16x32_bf16 v[44:47], v[140:143], a[48:51], v[44:47]
buffer_load_dwordx4 v15, s[24:27], s72 offen offset:3072 lds
v_mfma_f32_16x16x32_bf16 v[44:47], v[156:159], a[52:55], v[44:47]
ds_read_b64_tr_b16 v[250:251], v10 offset:47104
ds_read_b64_tr_b16 v[252:253], v11 offset:45056
v_mfma_f32_16x16x32_bf16 v[44:47], v[172:175], a[56:59], v[44:47]
ds_read_b64_tr_b16 v[254:255], v11 offset:47104
v_mfma_f32_16x16x32_bf16 v[44:47], v[188:191], a[60:63], v[44:47]
s_waitcnt vmcnt(49)
v_cmp_gt_u32 vcc, 2, v3
s_cbranch_vccnz Lspin75
Lback76:
s_add_u32 s82, s59, 28
s_and_b32 s82, s82, 28
s_lshl_b32 s82, s82, 10
s_add_u32 s82, s82, s74
buffer_load_dword v3, v2, s[44:47], s82 offen sc1
s_add_u32 s69, s61, 0
s_and_b32 s69, s69, 3
s_add_u32 s69, s69, s79
s_lshl_b32 s69, s69, 12
s_add_u32 s69, s69, s95
buffer_load_dwordx4 a[0:3], v1, s[44:47], s69 offen sc1
v_mfma_f32_16x16x32_bf16 v[28:31], v[188:191], a[44:47], v[28:31]
v_mfma_f32_16x16x32_bf16 v[28:31], v[172:175], a[40:43], v[28:31]
v_mfma_f32_16x16x32_bf16 v[28:31], v[156:159], a[36:39], v[28:31]
s_waitcnt vmcnt(15) lgkmcnt(0)
buffer_load_dwordx4 a[4:7], v1, s[44:47], s69 offen offset:1024 sc1
v_mfma_f32_16x16x32_bf16 v[28:31], v[140:143], a[32:35], v[28:31]
s_barrier
v_mfma_f32_16x16x32_bf16 v[16:19], v[192:195], a[64:67], v[16:19]
ds_read_b64_tr_b16 v[128:129], v8 offset:49152
ds_read_b64_tr_b16 v[130:131], v8 offset:51200
v_mfma_f32_16x16x32_bf16 v[16:19], v[208:211], a[68:71], v[16:19]
buffer_load_dwordx4 a[8:11], v1, s[44:47], s69 offen offset:2048 sc1
v_mfma_f32_16x16x32_bf16 v[16:19], v[224:227], a[72:75], v[16:19]
ds_read_b64_tr_b16 v[132:133], v9 offset:49152
ds_read_b64_tr_b16 v[134:135], v9 offset:51200
v_mfma_f32_16x16x32_bf16 v[16:19], v[240:243], a[76:79], v[16:19]
buffer_load_dwordx4 a[12:15], v1, s[44:47], s69 offen offset:3072 sc1
v_mfma_f32_16x16x32_bf16 v[32:35], v[240:243], a[92:95], v[32:35]
s_add_u32 s69, s69, 0x20000
ds_read_b64_tr_b16 v[136:137], v10 offset:49152
ds_read_b64_tr_b16 v[138:139], v10 offset:51200
v_mfma_f32_16x16x32_bf16 v[32:35], v[224:227], a[88:91], v[32:35]
ds_read_b64_tr_b16 v[140:141], v11 offset:49152
ds_read_b64_tr_b16 v[142:143], v11 offset:51200
v_mfma_f32_16x16x32_bf16 v[32:35], v[208:211], a[84:87], v[32:35]
buffer_load_dwordx4 a[16:19], v1, s[44:47], s69 offen sc1
v_mfma_f32_16x16x32_bf16 v[32:35], v[192:195], a[80:83], v[32:35]
ds_read_b64_tr_b16 v[144:145], v8 offset:53248
ds_read_b64_tr_b16 v[146:147], v8 offset:55296
v_mfma_f32_16x16x32_bf16 v[36:39], v[196:199], a[80:83], v[36:39]
ds_read_b64_tr_b16 v[148:149], v9 offset:53248
ds_read_b64_tr_b16 v[150:151], v9 offset:55296
v_mfma_f32_16x16x32_bf16 v[36:39], v[212:215], a[84:87], v[36:39]
buffer_load_dwordx4 a[20:23], v1, s[44:47], s69 offen offset:1024 sc1
v_mfma_f32_16x16x32_bf16 v[36:39], v[228:231], a[88:91], v[36:39]
ds_read_b64_tr_b16 v[152:153], v10 offset:53248
ds_read_b64_tr_b16 v[154:155], v10 offset:55296
v_mfma_f32_16x16x32_bf16 v[36:39], v[244:247], a[92:95], v[36:39]
ds_read_b64_tr_b16 v[156:157], v11 offset:53248
ds_read_b64_tr_b16 v[158:159], v11 offset:55296
v_mfma_f32_16x16x32_bf16 v[20:23], v[244:247], a[76:79], v[20:23]
buffer_load_dwordx4 a[24:27], v1, s[44:47], s69 offen offset:2048 sc1
v_mfma_f32_16x16x32_bf16 v[20:23], v[228:231], a[72:75], v[20:23]
ds_read_b64_tr_b16 v[160:161], v8 offset:57344
v_mfma_f32_16x16x32_bf16 v[20:23], v[212:215], a[68:71], v[20:23]
buffer_load_dwordx4 a[28:31], v1, s[44:47], s69 offen offset:3072 sc1
v_mfma_f32_16x16x32_bf16 v[20:23], v[196:199], a[64:67], v[20:23]
s_add_u32 s71, s61, 1
ds_read_b64_tr_b16 v[162:163], v8 offset:59392
ds_read_b64_tr_b16 v[164:165], v9 offset:57344
v_mfma_f32_16x16x32_bf16 v[24:27], v[200:203], a[64:67], v[24:27]
s_and_b32 s71, s71, 3
ds_read_b64_tr_b16 v[166:167], v9 offset:59392
ds_read_b64_tr_b16 v[168:169], v10 offset:57344
v_mfma_f32_16x16x32_bf16 v[24:27], v[216:219], a[68:71], v[24:27]
s_add_u32 s71, s71, s79
s_lshl_b32 s71, s71, 18
s_add_u32 s71, s71, s94
s_add_u32 m0, s77, 16384
s_add_u32 s72, s71, 0
buffer_load_dwordx4 v15, s[24:27], s72 offen lds
v_mfma_f32_16x16x32_bf16 v[24:27], v[232:235], a[72:75], v[24:27]
s_add_u32 s72, s71, 15360
ds_read_b64_tr_b16 v[170:171], v10 offset:59392
ds_read_b64_tr_b16 v[172:173], v11 offset:57344
v_mfma_f32_16x16x32_bf16 v[24:27], v[248:251], a[76:79], v[24:27]
ds_read_b64_tr_b16 v[174:175], v11 offset:59392
ds_read_b64_tr_b16 v[176:177], v8 offset:61440
v_mfma_f32_16x16x32_bf16 v[40:43], v[248:251], a[92:95], v[40:43]
buffer_load_dwordx4 v15, s[24:27], s72 offen offset:1024 lds
v_mfma_f32_16x16x32_bf16 v[40:43], v[232:235], a[88:91], v[40:43]
s_add_u32 s72, s71, 30720
ds_read_b64_tr_b16 v[178:179], v8 offset:63488
ds_read_b64_tr_b16 v[180:181], v9 offset:61440
v_mfma_f32_16x16x32_bf16 v[40:43], v[216:219], a[84:87], v[40:43]
ds_read_b64_tr_b16 v[182:183], v9 offset:63488
ds_read_b64_tr_b16 v[184:185], v10 offset:61440
v_mfma_f32_16x16x32_bf16 v[40:43], v[200:203], a[80:83], v[40:43]
buffer_load_dwordx4 v15, s[24:27], s72 offen offset:2048 lds
v_mfma_f32_16x16x32_bf16 v[44:47], v[204:207], a[80:83], v[44:47]
s_add_u32 s72, s71, 46080
ds_read_b64_tr_b16 v[186:187], v10 offset:63488
ds_read_b64_tr_b16 v[188:189], v11 offset:61440
v_mfma_f32_16x16x32_bf16 v[44:47], v[220:223], a[84:87], v[44:47]
ds_read_b64_tr_b16 v[190:191], v11 offset:63488
v_mfma_f32_16x16x32_bf16 v[44:47], v[236:239], a[88:91], v[44:47]
buffer_load_dwordx4 v15, s[24:27], s72 offen offset:3072 lds
v_mfma_f32_16x16x32_bf16 v[44:47], v[252:255], a[92:95], v[44:47]
s_add_u32 s69, s61, 1
v_mfma_f32_16x16x32_bf16 v[28:31], v[252:255], a[76:79], v[28:31]
s_and_b32 s69, s69, 3
s_add_u32 s69, s69, s79
s_lshl_b32 s69, s69, 12
s_add_u32 s69, s69, s95
buffer_load_dwordx4 a[32:35], v1, s[44:47], s69 offen sc1
v_mfma_f32_16x16x32_bf16 v[28:31], v[236:239], a[72:75], v[28:31]
v_mfma_f32_16x16x32_bf16 v[28:31], v[220:223], a[68:71], v[28:31]
s_waitcnt vmcnt(14) lgkmcnt(0)
v_mfma_f32_16x16x32_bf16 v[28:31], v[204:207], a[64:67], v[28:31]
s_barrier
buffer_load_dwordx4 a[36:39], v1, s[44:47], s69 offen offset:1024 sc1
v_mfma_f32_16x16x32_bf16 v[16:19], v[128:131], a[96:99], v[16:19]
ds_read_b64_tr_b16 v[192:193], v8 offset:0
ds_read_b64_tr_b16 v[194:195], v8 offset:2048
v_mfma_f32_16x16x32_bf16 v[16:19], v[144:147], a[100:103], v[16:19]
ds_read_b64_tr_b16 v[196:197], v9 offset:0
ds_read_b64_tr_b16 v[198:199], v9 offset:2048
v_mfma_f32_16x16x32_bf16 v[16:19], v[160:163], a[104:107], v[16:19]
buffer_load_dwordx4 a[40:43], v1, s[44:47], s69 offen offset:2048 sc1
v_mfma_f32_16x16x32_bf16 v[16:19], v[176:179], a[108:111], v[16:19]
ds_read_b64_tr_b16 v[200:201], v10 offset:0
ds_read_b64_tr_b16 v[202:203], v10 offset:2048
v_mfma_f32_16x16x32_bf16 v[32:35], v[176:179], a[124:127], v[32:35]
ds_read_b64_tr_b16 v[204:205], v11 offset:0
ds_read_b64_tr_b16 v[206:207], v11 offset:2048
v_mfma_f32_16x16x32_bf16 v[32:35], v[160:163], a[120:123], v[32:35]
buffer_load_dwordx4 a[44:47], v1, s[44:47], s69 offen offset:3072 sc1
v_mfma_f32_16x16x32_bf16 v[32:35], v[144:147], a[116:119], v[32:35]
s_add_u32 s69, s69, 0x20000
ds_read_b64_tr_b16 v[208:209], v8 offset:4096
v_mfma_f32_16x16x32_bf16 v[32:35], v[128:131], a[112:115], v[32:35]
buffer_load_dwordx4 a[48:51], v1, s[44:47], s69 offen sc1
v_mfma_f32_16x16x32_bf16 v[36:39], v[132:135], a[112:115], v[36:39]
ds_read_b64_tr_b16 v[210:211], v8 offset:6144
ds_read_b64_tr_b16 v[212:213], v9 offset:4096
v_mfma_f32_16x16x32_bf16 v[36:39], v[148:151], a[116:119], v[36:39]
ds_read_b64_tr_b16 v[214:215], v9 offset:6144
ds_read_b64_tr_b16 v[216:217], v10 offset:4096
v_mfma_f32_16x16x32_bf16 v[36:39], v[164:167], a[120:123], v[36:39]
buffer_load_dwordx4 a[52:55], v1, s[44:47], s69 offen offset:1024 sc1
v_mfma_f32_16x16x32_bf16 v[36:39], v[180:183], a[124:127], v[36:39]
ds_read_b64_tr_b16 v[218:219], v10 offset:6144
ds_read_b64_tr_b16 v[220:221], v11 offset:4096
v_mfma_f32_16x16x32_bf16 v[20:23], v[180:183], a[108:111], v[20:23]
ds_read_b64_tr_b16 v[222:223], v11 offset:6144
v_mfma_f32_16x16x32_bf16 v[20:23], v[164:167], a[104:107], v[20:23]
buffer_load_dwordx4 a[56:59], v1, s[44:47], s69 offen offset:2048 sc1
v_mfma_f32_16x16x32_bf16 v[20:23], v[148:151], a[100:103], v[20:23]
ds_read_b64_tr_b16 v[224:225], v8 offset:8192
ds_read_b64_tr_b16 v[226:227], v8 offset:10240
v_mfma_f32_16x16x32_bf16 v[20:23], v[132:135], a[96:99], v[20:23]
ds_read_b64_tr_b16 v[228:229], v9 offset:8192
ds_read_b64_tr_b16 v[230:231], v9 offset:10240
v_mfma_f32_16x16x32_bf16 v[24:27], v[136:139], a[96:99], v[24:27]
buffer_load_dwordx4 a[60:63], v1, s[44:47], s69 offen offset:3072 sc1
v_mfma_f32_16x16x32_bf16 v[24:27], v[152:155], a[100:103], v[24:27]
s_add_u32 s71, s61, 2
ds_read_b64_tr_b16 v[232:233], v10 offset:8192
ds_read_b64_tr_b16 v[234:235], v10 offset:10240
v_mfma_f32_16x16x32_bf16 v[24:27], v[168:171], a[104:107], v[24:27]
s_and_b32 s71, s71, 3
ds_read_b64_tr_b16 v[236:237], v11 offset:8192
ds_read_b64_tr_b16 v[238:239], v11 offset:10240
v_mfma_f32_16x16x32_bf16 v[24:27], v[184:187], a[108:111], v[24:27]
s_add_u32 s71, s71, s79
s_lshl_b32 s71, s71, 18
s_add_u32 s71, s71, s94
s_add_u32 m0, s77, 32768
s_add_u32 s72, s71, 0
buffer_load_dwordx4 v15, s[24:27], s72 offen lds
v_mfma_f32_16x16x32_bf16 v[40:43], v[184:187], a[124:127], v[40:43]
s_add_u32 s72, s71, 15360
ds_read_b64_tr_b16 v[240:241], v8 offset:12288
v_mfma_f32_16x16x32_bf16 v[40:43], v[168:171], a[120:123], v[40:43]
buffer_load_dwordx4 v15, s[24:27], s72 offen offset:1024 lds
v_mfma_f32_16x16x32_bf16 v[40:43], v[152:155], a[116:119], v[40:43]
s_add_u32 s72, s71, 30720
ds_read_b64_tr_b16 v[242:243], v8 offset:14336
ds_read_b64_tr_b16 v[244:245], v9 offset:12288
v_mfma_f32_16x16x32_bf16 v[40:43], v[136:139], a[112:115], v[40:43]
ds_read_b64_tr_b16 v[246:247], v9 offset:14336
ds_read_b64_tr_b16 v[248:249], v10 offset:12288
v_mfma_f32_16x16x32_bf16 v[44:47], v[140:143], a[112:115], v[44:47]
buffer_load_dwordx4 v15, s[24:27], s72 offen offset:2048 lds
v_mfma_f32_16x16x32_bf16 v[44:47], v[156:159], a[116:119], v[44:47]
s_add_u32 s72, s71, 46080
ds_read_b64_tr_b16 v[250:251], v10 offset:14336
ds_read_b64_tr_b16 v[252:253], v11 offset:12288
v_mfma_f32_16x16x32_bf16 v[44:47], v[172:175], a[120:123], v[44:47]
ds_read_b64_tr_b16 v[254:255], v11 offset:14336
v_mfma_f32_16x16x32_bf16 v[44:47], v[188:191], a[124:127], v[44:47]
buffer_load_dwordx4 v15, s[24:27], s72 offen offset:3072 lds
v_mfma_f32_16x16x32_bf16 v[28:31], v[188:191], a[108:111], v[28:31]
s_add_u32 s69, s61, 2
v_mfma_f32_16x16x32_bf16 v[28:31], v[172:175], a[104:107], v[28:31]
s_and_b32 s69, s69, 3
v_mfma_f32_16x16x32_bf16 v[28:31], v[156:159], a[100:103], v[28:31]
s_waitcnt vmcnt(12) lgkmcnt(0)
s_add_u32 s69, s69, s79
s_lshl_b32 s69, s69, 12
s_add_u32 s69, s69, s95
buffer_load_dwordx4 a[64:67], v1, s[44:47], s69 offen sc1
v_mfma_f32_16x16x32_bf16 v[28:31], v[140:143], a[96:99], v[28:31]
s_barrier
v_mfma_f32_16x16x32_bf16 v[16:19], v[192:195], a[0:3], v[16:19]
buffer_load_dwordx4 a[68:71], v1, s[44:47], s69 offen offset:1024 sc1
s_waitcnt vmcnt(37)
v_cmp_gt_u32 vcc, 3, v114
s_cbranch_vccnz Lspin84
Lback85:
s_lshl_b32 s73, s76, 18
s_lshl_b32 s84, s58, 16
s_add_u32 s73, s73, s84
s_lshl_b32 s84, s75, 8
s_add_u32 s73, s73, s84
s_add_u32 s73, s73, 0x3400000
v_lshrrev_b32 v112, 4, v0
v_and_b32 v113, 15, v0
v_lshlrev_b32 v114, 4, v113
v_lshl_add_u32 v112, v112, 12, v114
s_add_u32 m0, s64, 147456
s_add_u32 s72, s73, 0
buffer_load_dwordx4 v112, s[44:47], s72 offen sc1 lds
s_add_u32 s72, s73, 15360
buffer_load_dwordx4 v112, s[44:47], s72 offen offset:1024 sc1 lds
s_add_u32 s72, s73, 30720
buffer_load_dwordx4 v112, s[44:47], s72 offen offset:2048 sc1 lds
s_add_u32 s72, s73, 46080
buffer_load_dwordx4 v112, s[44:47], s72 offen offset:3072 sc1 lds
s_lshl_b32 s73, s75, 9
s_lshl_b32 s84, s58, 7
s_add_u32 s73, s73, s84
s_add_u32 s73, s73, 0x3800000
v_lshlrev_b32 v113, 2, v113
buffer_load_dword v6, v113, s[44:47], s73 offen sc1
buffer_load_dword v7, v113, s[44:47], s73 offen offset:64 sc1
v_mfma_f32_16x16x32_bf16 v[16:19], v[208:211], a[4:7], v[16:19]
ds_read_b64_tr_b16 v[128:129], v8 offset:16384
ds_read_b64_tr_b16 v[130:131], v8 offset:18432
v_mfma_f32_16x16x32_bf16 v[16:19], v[224:227], a[8:11], v[16:19]
ds_read_b64_tr_b16 v[132:133], v9 offset:16384
ds_read_b64_tr_b16 v[134:135], v9 offset:18432
v_mfma_f32_16x16x32_bf16 v[16:19], v[240:243], a[12:15], v[16:19]
buffer_load_dwordx4 a[72:75], v1, s[44:47], s69 offen offset:2048 sc1
v_mfma_f32_16x16x32_bf16 v[32:35], v[240:243], a[28:31], v[32:35]
ds_read_b64_tr_b16 v[136:137], v10 offset:16384
ds_read_b64_tr_b16 v[138:139], v10 offset:18432
v_mfma_f32_16x16x32_bf16 v[32:35], v[224:227], a[24:27], v[32:35]
ds_read_b64_tr_b16 v[140:141], v11 offset:16384
ds_read_b64_tr_b16 v[142:143], v11 offset:18432
v_mfma_f32_16x16x32_bf16 v[32:35], v[208:211], a[20:23], v[32:35]
buffer_load_dwordx4 a[76:79], v1, s[44:47], s69 offen offset:3072 sc1
v_mfma_f32_16x16x32_bf16 v[32:35], v[192:195], a[16:19], v[32:35]
s_add_u32 s69, s69, 0x20000
ds_read_b64_tr_b16 v[144:145], v8 offset:20480
ds_read_b64_tr_b16 v[146:147], v8 offset:22528
v_mfma_f32_16x16x32_bf16 v[36:39], v[196:199], a[16:19], v[36:39]
ds_read_b64_tr_b16 v[148:149], v9 offset:20480
ds_read_b64_tr_b16 v[150:151], v9 offset:22528
v_mfma_f32_16x16x32_bf16 v[36:39], v[212:215], a[20:23], v[36:39]
buffer_load_dwordx4 a[80:83], v1, s[44:47], s69 offen sc1
v_mfma_f32_16x16x32_bf16 v[36:39], v[228:231], a[24:27], v[36:39]
ds_read_b64_tr_b16 v[152:153], v10 offset:20480
ds_read_b64_tr_b16 v[154:155], v10 offset:22528
v_mfma_f32_16x16x32_bf16 v[36:39], v[244:247], a[28:31], v[36:39]
ds_read_b64_tr_b16 v[156:157], v11 offset:20480
ds_read_b64_tr_b16 v[158:159], v11 offset:22528
v_mfma_f32_16x16x32_bf16 v[20:23], v[244:247], a[12:15], v[20:23]
buffer_load_dwordx4 a[84:87], v1, s[44:47], s69 offen offset:1024 sc1
v_mfma_f32_16x16x32_bf16 v[20:23], v[228:231], a[8:11], v[20:23]
ds_read_b64_tr_b16 v[160:161], v8 offset:24576
v_mfma_f32_16x16x32_bf16 v[20:23], v[212:215], a[4:7], v[20:23]
buffer_load_dwordx4 a[88:91], v1, s[44:47], s69 offen offset:2048 sc1
v_mfma_f32_16x16x32_bf16 v[20:23], v[196:199], a[0:3], v[20:23]
ds_read_b64_tr_b16 v[162:163], v8 offset:26624
ds_read_b64_tr_b16 v[164:165], v9 offset:24576
v_mfma_f32_16x16x32_bf16 v[24:27], v[200:203], a[0:3], v[24:27]
ds_read_b64_tr_b16 v[166:167], v9 offset:26624
ds_read_b64_tr_b16 v[168:169], v10 offset:24576
v_mfma_f32_16x16x32_bf16 v[24:27], v[216:219], a[4:7], v[24:27]
buffer_load_dwordx4 a[92:95], v1, s[44:47], s69 offen offset:3072 sc1
v_mfma_f32_16x16x32_bf16 v[24:27], v[232:235], a[8:11], v[24:27]
s_add_u32 s71, s61, 3
ds_read_b64_tr_b16 v[170:171], v10 offset:26624
ds_read_b64_tr_b16 v[172:173], v11 offset:24576
v_mfma_f32_16x16x32_bf16 v[24:27], v[248:251], a[12:15], v[24:27]
s_and_b32 s71, s71, 3
ds_read_b64_tr_b16 v[174:175], v11 offset:26624
ds_read_b64_tr_b16 v[176:177], v8 offset:28672
v_mfma_f32_16x16x32_bf16 v[40:43], v[248:251], a[28:31], v[40:43]
s_add_u32 s71, s71, s79
s_lshl_b32 s71, s71, 18
s_add_u32 s71, s71, s94
s_add_u32 m0, s77, 49152
s_add_u32 s72, s71, 0
buffer_load_dwordx4 v15, s[24:27], s72 offen lds
v_mfma_f32_16x16x32_bf16 v[40:43], v[232:235], a[24:27], v[40:43]
s_add_u32 s72, s71, 15360
ds_read_b64_tr_b16 v[178:179], v8 offset:30720
ds_read_b64_tr_b16 v[180:181], v9 offset:28672
v_mfma_f32_16x16x32_bf16 v[40:43], v[216:219], a[20:23], v[40:43]
ds_read_b64_tr_b16 v[182:183], v9 offset:30720
ds_read_b64_tr_b16 v[184:185], v10 offset:28672
v_mfma_f32_16x16x32_bf16 v[40:43], v[200:203], a[16:19], v[40:43]
buffer_load_dwordx4 v15, s[24:27], s72 offen offset:1024 lds
v_mfma_f32_16x16x32_bf16 v[44:47], v[204:207], a[16:19], v[44:47]
s_add_u32 s72, s71, 30720
ds_read_b64_tr_b16 v[186:187], v10 offset:30720
ds_read_b64_tr_b16 v[188:189], v11 offset:28672
v_mfma_f32_16x16x32_bf16 v[44:47], v[220:223], a[20:23], v[44:47]
buffer_load_dwordx4 v15, s[24:27], s72 offen offset:2048 lds
v_mfma_f32_16x16x32_bf16 v[44:47], v[236:239], a[24:27], v[44:47]
s_add_u32 s72, s71, 46080
ds_read_b64_tr_b16 v[190:191], v11 offset:30720
v_mfma_f32_16x16x32_bf16 v[44:47], v[252:255], a[28:31], v[44:47]
v_mfma_f32_16x16x32_bf16 v[28:31], v[252:255], a[12:15], v[28:31]
buffer_load_dwordx4 v15, s[24:27], s72 offen offset:3072 lds
v_mfma_f32_16x16x32_bf16 v[28:31], v[236:239], a[8:11], v[28:31]
s_add_u32 s69, s61, 3
v_mfma_f32_16x16x32_bf16 v[28:31], v[220:223], a[4:7], v[28:31]
s_waitcnt vmcnt(18) lgkmcnt(0)
v_mfma_f32_16x16x32_bf16 v[28:31], v[204:207], a[0:3], v[28:31]
s_barrier
s_and_b32 s69, s69, 3
s_add_u32 s69, s69, s79
s_lshl_b32 s69, s69, 12
s_add_u32 s69, s69, s95
buffer_load_dwordx4 a[96:99], v1, s[44:47], s69 offen sc1
v_mfma_f32_16x16x32_bf16 v[16:19], v[128:131], a[32:35], v[16:19]
ds_read_b64_tr_b16 v[192:193], v8 offset:32768
ds_read_b64_tr_b16 v[194:195], v8 offset:34816
s_add_u32 s73, s64, 131072
v_add_u32 v120, s73, v1
s_lshl_b32 s70, s75, 18
s_add_u32 s70, s70, s94
v_mfma_f32_16x16x32_bf16 v[16:19], v[144:147], a[36:39], v[16:19]
ds_read_b64_tr_b16 v[196:197], v9 offset:32768
ds_read_b64_tr_b16 v[198:199], v9 offset:34816
v_mfma_f32_16x16x32_bf16 v[16:19], v[160:163], a[40:43], v[16:19]
buffer_load_dwordx4 a[100:103], v1, s[44:47], s69 offen offset:1024 sc1
v_mfma_f32_16x16x32_bf16 v[16:19], v[176:179], a[44:47], v[16:19]
ds_read_b64_tr_b16 v[200:201], v10 offset:32768
ds_read_b64_tr_b16 v[202:203], v10 offset:34816
v_mfma_f32_16x16x32_bf16 v[32:35], v[176:179], a[60:63], v[32:35]
ds_write_b128 v120, v[80:83] offset:0
buffer_load_dwordx4 a[104:107], v1, s[44:47], s69 offen offset:2048 sc1
v_mfma_f32_16x16x32_bf16 v[32:35], v[160:163], a[56:59], v[32:35]
ds_read_b64_tr_b16 v[204:205], v11 offset:32768
ds_read_b64_tr_b16 v[206:207], v11 offset:34816
v_mfma_f32_16x16x32_bf16 v[32:35], v[144:147], a[52:55], v[32:35]
ds_read_b64_tr_b16 v[208:209], v8 offset:36864
v_mfma_f32_16x16x32_bf16 v[32:35], v[128:131], a[48:51], v[32:35]
buffer_load_dwordx4 a[108:111], v1, s[44:47], s69 offen offset:3072 sc1
v_mfma_f32_16x16x32_bf16 v[36:39], v[132:135], a[48:51], v[36:39]
s_add_u32 s69, s69, 0x20000
ds_read_b64_tr_b16 v[210:211], v8 offset:38912
ds_read_b64_tr_b16 v[212:213], v9 offset:36864
v_mfma_f32_16x16x32_bf16 v[36:39], v[148:151], a[52:55], v[36:39]
ds_read_b64_tr_b16 v[214:215], v9 offset:38912
ds_read_b64_tr_b16 v[216:217], v10 offset:36864
ds_write_b128 v120, v[84:87] offset:1024
v_mfma_f32_16x16x32_bf16 v[36:39], v[164:167], a[56:59], v[36:39]
buffer_load_dwordx4 a[112:115], v1, s[44:47], s69 offen sc1
v_mfma_f32_16x16x32_bf16 v[36:39], v[180:183], a[60:63], v[36:39]
ds_read_b64_tr_b16 v[218:219], v10 offset:38912
ds_read_b64_tr_b16 v[220:221], v11 offset:36864
v_mfma_f32_16x16x32_bf16 v[20:23], v[180:183], a[44:47], v[20:23]
ds_read_b64_tr_b16 v[222:223], v11 offset:38912
v_mfma_f32_16x16x32_bf16 v[20:23], v[164:167], a[40:43], v[20:23]
buffer_load_dwordx4 a[116:119], v1, s[44:47], s69 offen offset:1024 sc1
v_mfma_f32_16x16x32_bf16 v[20:23], v[148:151], a[36:39], v[20:23]
ds_read_b64_tr_b16 v[224:225], v8 offset:40960
ds_read_b64_tr_b16 v[226:227], v8 offset:43008
ds_write_b128 v120, v[96:99] offset:2048
v_mfma_f32_16x16x32_bf16 v[20:23], v[132:135], a[32:35], v[20:23]
ds_read_b64_tr_b16 v[228:229], v9 offset:40960
ds_read_b64_tr_b16 v[230:231], v9 offset:43008
v_mfma_f32_16x16x32_bf16 v[24:27], v[136:139], a[32:35], v[24:27]
buffer_load_dwordx4 a[120:123], v1, s[44:47], s69 offen offset:2048 sc1
v_mfma_f32_16x16x32_bf16 v[24:27], v[152:155], a[36:39], v[24:27]
ds_read_b64_tr_b16 v[232:233], v10 offset:40960
ds_read_b64_tr_b16 v[234:235], v10 offset:43008
v_mfma_f32_16x16x32_bf16 v[24:27], v[168:171], a[40:43], v[24:27]
buffer_load_dwordx4 a[124:127], v1, s[44:47], s69 offen offset:3072 sc1
v_mfma_f32_16x16x32_bf16 v[24:27], v[184:187], a[44:47], v[24:27]
s_add_u32 s78, s59, 28
ds_read_b64_tr_b16 v[236:237], v11 offset:40960
ds_read_b64_tr_b16 v[238:239], v11 offset:43008
ds_write_b128 v120, v[100:103] offset:3072
v_mfma_f32_16x16x32_bf16 v[40:43], v[184:187], a[60:63], v[40:43]
s_and_b32 s78, s78, 28
ds_read_b64_tr_b16 v[240:241], v8 offset:45056
v_mfma_f32_16x16x32_bf16 v[40:43], v[168:171], a[56:59], v[40:43]
s_add_u32 s71, s61, 0
s_and_b32 s71, s71, 3
s_add_u32 s71, s71, s78
s_lshl_b32 s71, s71, 18
s_add_u32 s71, s71, s94
s_add_u32 m0, s77, 0
s_add_u32 s72, s71, 0
buffer_load_dwordx4 v15, s[24:27], s72 offen lds
v_mfma_f32_16x16x32_bf16 v[40:43], v[152:155], a[52:55], v[40:43]
s_add_u32 s72, s71, 15360
ds_read_b64_tr_b16 v[242:243], v8 offset:47104
ds_read_b64_tr_b16 v[244:245], v9 offset:45056
v_mfma_f32_16x16x32_bf16 v[40:43], v[136:139], a[48:51], v[40:43]
ds_read_b64_tr_b16 v[246:247], v9 offset:47104
ds_read_b64_tr_b16 v[248:249], v10 offset:45056
v_mfma_f32_16x16x32_bf16 v[44:47], v[140:143], a[48:51], v[44:47]
buffer_load_dwordx4 v15, s[24:27], s72 offen offset:1024 lds
v_mfma_f32_16x16x32_bf16 v[44:47], v[156:159], a[52:55], v[44:47]
s_add_u32 s72, s71, 30720
ds_read_b64_tr_b16 v[250:251], v10 offset:47104
ds_read_b64_tr_b16 v[252:253], v11 offset:45056
v_mfma_f32_16x16x32_bf16 v[44:47], v[172:175], a[56:59], v[44:47]
ds_read_b64_tr_b16 v[254:255], v11 offset:47104
v_mfma_f32_16x16x32_bf16 v[44:47], v[188:191], a[60:63], v[44:47]
buffer_load_dwordx4 v15, s[24:27], s72 offen offset:2048 lds
v_mfma_f32_16x16x32_bf16 v[28:31], v[188:191], a[44:47], v[28:31]
s_add_u32 s72, s71, 46080
v_mfma_f32_16x16x32_bf16 v[28:31], v[172:175], a[40:43], v[28:31]
buffer_load_dwordx4 v15, s[24:27], s72 offen offset:3072 lds
v_mfma_f32_16x16x32_bf16 v[28:31], v[156:159], a[36:39], v[28:31]
s_waitcnt vmcnt(12) lgkmcnt(0)
v_mfma_f32_16x16x32_bf16 v[28:31], v[140:143], a[32:35], v[28:31]
s_barrier
v_mfma_f32_16x16x32_bf16 v[16:19], v[192:195], a[64:67], v[16:19]
s_waitcnt vmcnt(54)
v_cmp_gt_u32 vcc, 2, v3
s_cbranch_vccnz Lspin78
Lback79:
s_add_u32 s82, s59, 32
s_and_b32 s82, s82, 28
s_lshl_b32 s82, s82, 10
s_add_u32 s82, s82, s74
buffer_load_dword v3, v2, s[44:47], s82 offen sc1
s_add_u32 s69, s61, 0
s_and_b32 s69, s69, 3
s_add_u32 s69, s69, s78
s_lshl_b32 s69, s69, 12
s_add_u32 s69, s69, s95
buffer_load_dwordx4 a[0:3], v1, s[44:47], s69 offen sc1
v_mfma_f32_16x16x32_bf16 v[16:19], v[208:211], a[68:71], v[16:19]
ds_read_b64_tr_b16 v[128:129], v8 offset:49152
ds_read_b64_tr_b16 v[130:131], v8 offset:51200
v_mfma_f32_16x16x32_bf16 v[16:19], v[224:227], a[72:75], v[16:19]
ds_read_b64_tr_b16 v[132:133], v9 offset:49152
ds_read_b64_tr_b16 v[134:135], v9 offset:51200
v_mfma_f32_16x16x32_bf16 v[16:19], v[240:243], a[76:79], v[16:19]
buffer_load_dwordx4 a[4:7], v1, s[44:47], s69 offen offset:1024 sc1
v_mfma_f32_16x16x32_bf16 v[32:35], v[240:243], a[92:95], v[32:35]
ds_read_b64_tr_b16 v[136:137], v10 offset:49152
ds_read_b64_tr_b16 v[138:139], v10 offset:51200
v_mfma_f32_16x16x32_bf16 v[32:35], v[224:227], a[88:91], v[32:35]
ds_read_b64_tr_b16 v[140:141], v11 offset:49152
ds_read_b64_tr_b16 v[142:143], v11 offset:51200
v_mfma_f32_16x16x32_bf16 v[32:35], v[208:211], a[84:87], v[32:35]
buffer_load_dwordx4 a[8:11], v1, s[44:47], s69 offen offset:2048 sc1
v_mfma_f32_16x16x32_bf16 v[32:35], v[192:195], a[80:83], v[32:35]
ds_read_b64_tr_b16 v[144:145], v8 offset:53248
ds_read_b64_tr_b16 v[146:147], v8 offset:55296
v_mfma_f32_16x16x32_bf16 v[36:39], v[196:199], a[80:83], v[36:39]
ds_read_b64_tr_b16 v[148:149], v9 offset:53248
ds_read_b64_tr_b16 v[150:151], v9 offset:55296
v_mfma_f32_16x16x32_bf16 v[36:39], v[212:215], a[84:87], v[36:39]
buffer_load_dwordx4 a[12:15], v1, s[44:47], s69 offen offset:3072 sc1
v_mfma_f32_16x16x32_bf16 v[36:39], v[228:231], a[88:91], v[36:39]
s_add_u32 s69, s69, 0x20000
ds_read_b64_tr_b16 v[152:153], v10 offset:53248
ds_read_b64_tr_b16 v[154:155], v10 offset:55296
v_mfma_f32_16x16x32_bf16 v[36:39], v[244:247], a[92:95], v[36:39]
buffer_load_dwordx4 a[16:19], v1, s[44:47], s69 offen sc1
v_mfma_f32_16x16x32_bf16 v[20:23], v[244:247], a[76:79], v[20:23]
ds_read_b64_tr_b16 v[156:157], v11 offset:53248
ds_read_b64_tr_b16 v[158:159], v11 offset:55296
v_mfma_f32_16x16x32_bf16 v[20:23], v[228:231], a[72:75], v[20:23]
ds_read_b64_tr_b16 v[160:161], v8 offset:57344
v_mfma_f32_16x16x32_bf16 v[20:23], v[212:215], a[68:71], v[20:23]
buffer_load_dwordx4 a[20:23], v1, s[44:47], s69 offen offset:1024 sc1
v_mfma_f32_16x16x32_bf16 v[20:23], v[196:199], a[64:67], v[20:23]
ds_read_b64_tr_b16 v[162:163], v8 offset:59392
ds_read_b64_tr_b16 v[164:165], v9 offset:57344
v_mfma_f32_16x16x32_bf16 v[24:27], v[200:203], a[64:67], v[24:27]
ds_read_b64_tr_b16 v[166:167], v9 offset:59392
ds_read_b64_tr_b16 v[168:169], v10 offset:57344
v_mfma_f32_16x16x32_bf16 v[24:27], v[216:219], a[68:71], v[24:27]
buffer_load_dwordx4 a[24:27], v1, s[44:47], s69 offen offset:2048 sc1
v_mfma_f32_16x16x32_bf16 v[24:27], v[232:235], a[72:75], v[24:27]
ds_read_b64_tr_b16 v[170:171], v10 offset:59392
ds_read_b64_tr_b16 v[172:173], v11 offset:57344
v_mfma_f32_16x16x32_bf16 v[24:27], v[248:251], a[76:79], v[24:27]
ds_read_b64_tr_b16 v[174:175], v11 offset:59392
ds_read_b64_tr_b16 v[176:177], v8 offset:61440
v_mfma_f32_16x16x32_bf16 v[40:43], v[248:251], a[92:95], v[40:43]
buffer_load_dwordx4 a[28:31], v1, s[44:47], s69 offen offset:3072 sc1
v_mfma_f32_16x16x32_bf16 v[40:43], v[232:235], a[88:91], v[40:43]
s_add_u32 s71, s61, 1
ds_read_b64_tr_b16 v[178:179], v8 offset:63488
ds_read_b64_tr_b16 v[180:181], v9 offset:61440
v_mfma_f32_16x16x32_bf16 v[40:43], v[216:219], a[84:87], v[40:43]
s_and_b32 s71, s71, 3
s_add_u32 s71, s71, s78
s_lshl_b32 s71, s71, 18
s_add_u32 s71, s71, s94
s_add_u32 m0, s77, 16384
s_add_u32 s72, s71, 0
buffer_load_dwordx4 v15, s[24:27], s72 offen lds
v_mfma_f32_16x16x32_bf16 v[40:43], v[200:203], a[80:83], v[40:43]
s_add_u32 s72, s71, 15360
ds_read_b64_tr_b16 v[182:183], v9 offset:63488
ds_read_b64_tr_b16 v[184:185], v10 offset:61440
v_mfma_f32_16x16x32_bf16 v[44:47], v[204:207], a[80:83], v[44:47]
ds_read_b64_tr_b16 v[186:187], v10 offset:63488
ds_read_b64_tr_b16 v[188:189], v11 offset:61440
v_mfma_f32_16x16x32_bf16 v[44:47], v[220:223], a[84:87], v[44:47]
buffer_load_dwordx4 v15, s[24:27], s72 offen offset:1024 lds
v_mfma_f32_16x16x32_bf16 v[44:47], v[236:239], a[88:91], v[44:47]
s_add_u32 s72, s71, 30720
ds_read_b64_tr_b16 v[190:191], v11 offset:63488
v_mfma_f32_16x16x32_bf16 v[44:47], v[252:255], a[92:95], v[44:47]
v_mfma_f32_16x16x32_bf16 v[28:31], v[252:255], a[76:79], v[28:31]
buffer_load_dwordx4 v15, s[24:27], s72 offen offset:2048 lds
v_mfma_f32_16x16x32_bf16 v[28:31], v[236:239], a[72:75], v[28:31]
s_add_u32 s72, s71, 46080
v_mfma_f32_16x16x32_bf16 v[28:31], v[220:223], a[68:71], v[28:31]
s_waitcnt vmcnt(12) lgkmcnt(0)
v_mfma_f32_16x16x32_bf16 v[28:31], v[204:207], a[64:67], v[28:31]
s_barrier
buffer_load_dwordx4 v15, s[24:27], s72 offen offset:3072 lds
v_mfma_f32_16x16x32_bf16 v[16:19], v[128:131], a[96:99], v[16:19]
s_add_u32 s69, s61, 1
ds_read_b64_tr_b16 v[192:193], v8 offset:0
ds_read_b64_tr_b16 v[194:195], v8 offset:2048
ds_read_b64 v[80:81], v116 offset:0
v_mfma_f32_16x16x32_bf16 v[16:19], v[144:147], a[100:103], v[16:19]
s_and_b32 s69, s69, 3
ds_read_b64_tr_b16 v[196:197], v9 offset:0
ds_read_b64_tr_b16 v[198:199], v9 offset:2048
ds_read_b64_tr_b16 v[88:89], v5 offset:0
v_mfma_f32_16x16x32_bf16 v[16:19], v[160:163], a[104:107], v[16:19]
s_add_u32 s69, s69, s78
ds_read_b64 v[82:83], v117 offset:0
s_lshl_b32 s69, s69, 12
s_add_u32 s69, s69, s95
buffer_load_dwordx4 a[32:35], v1, s[44:47], s69 offen sc1
v_mfma_f32_16x16x32_bf16 v[16:19], v[176:179], a[108:111], v[16:19]
ds_read_b64_tr_b16 v[200:201], v10 offset:0
ds_read_b64_tr_b16 v[202:203], v10 offset:2048
ds_read_b64_tr_b16 v[90:91], v5 offset:4096
v_mfma_f32_16x16x32_bf16 v[32:35], v[176:179], a[124:127], v[32:35]
ds_read_b64 v[84:85], v118 offset:0
buffer_load_dwordx4 a[36:39], v1, s[44:47], s69 offen offset:1024 sc1
v_mfma_f32_16x16x32_bf16 v[32:35], v[160:163], a[120:123], v[32:35]
ds_read_b64_tr_b16 v[204:205], v11 offset:0
ds_read_b64_tr_b16 v[206:207], v11 offset:2048
ds_read_b64_tr_b16 v[92:93], v5 offset:8192
v_mfma_f32_16x16x32_bf16 v[32:35], v[144:147], a[116:119], v[32:35]
ds_read_b64_tr_b16 v[208:209], v8 offset:4096
ds_read_b64 v[86:87], v119 offset:0
v_mfma_f32_16x16x32_bf16 v[32:35], v[128:131], a[112:115], v[32:35]
ds_read_b64_tr_b16 v[94:95], v5 offset:12288
buffer_load_dwordx4 a[40:43], v1, s[44:47], s69 offen offset:2048 sc1
v_mfma_f32_16x16x32_bf16 v[36:39], v[132:135], a[112:115], v[36:39]
ds_read_b64_tr_b16 v[210:211], v8 offset:6144
ds_read_b64_tr_b16 v[212:213], v9 offset:4096
ds_read_b64 v[96:97], v116 offset:2048
v_mfma_f32_16x16x32_bf16 v[36:39], v[148:151], a[116:119], v[36:39]
ds_read_b64_tr_b16 v[214:215], v9 offset:6144
ds_read_b64_tr_b16 v[216:217], v10 offset:4096
ds_read_b64_tr_b16 v[104:105], v5 offset:16
v_mfma_f32_16x16x32_bf16 v[36:39], v[164:167], a[120:123], v[36:39]
ds_read_b64 v[98:99], v117 offset:2048
buffer_load_dwordx4 a[44:47], v1, s[44:47], s69 offen offset:3072 sc1
v_mfma_f32_16x16x32_bf16 v[36:39], v[180:183], a[124:127], v[36:39]
s_add_u32 s69, s69, 0x20000
ds_read_b64_tr_b16 v[218:219], v10 offset:6144
ds_read_b64_tr_b16 v[220:221], v11 offset:4096
ds_read_b64_tr_b16 v[106:107], v5 offset:4112
v_mfma_f32_16x16x32_bf16 v[20:23], v[180:183], a[108:111], v[20:23]
ds_read_b64_tr_b16 v[222:223], v11 offset:6144
ds_read_b64 v[100:101], v118 offset:2048
v_mfma_f32_16x16x32_bf16 v[20:23], v[164:167], a[104:107], v[20:23]
ds_read_b64_tr_b16 v[108:109], v5 offset:8208
buffer_load_dwordx4 a[48:51], v1, s[44:47], s69 offen sc1
v_mfma_f32_16x16x32_bf16 v[20:23], v[148:151], a[100:103], v[20:23]
ds_read_b64_tr_b16 v[224:225], v8 offset:8192
ds_read_b64_tr_b16 v[226:227], v8 offset:10240
ds_read_b64 v[102:103], v119 offset:2048
v_mfma_f32_16x16x32_bf16 v[20:23], v[132:135], a[96:99], v[20:23]
ds_read_b64_tr_b16 v[110:111], v5 offset:12304
buffer_load_dwordx4 a[52:55], v1, s[44:47], s69 offen offset:1024 sc1
v_mfma_f32_16x16x32_bf16 v[24:27], v[136:139], a[96:99], v[24:27]
ds_read_b64_tr_b16 v[228:229], v9 offset:8192
ds_read_b64_tr_b16 v[230:231], v9 offset:10240
v_mfma_f32_16x16x32_bf16 v[24:27], v[152:155], a[100:103], v[24:27]
ds_read_b64_tr_b16 v[232:233], v10 offset:8192
ds_read_b64_tr_b16 v[234:235], v10 offset:10240
v_mfma_f32_16x16x32_bf16 v[24:27], v[168:171], a[104:107], v[24:27]
buffer_load_dwordx4 a[56:59], v1, s[44:47], s69 offen offset:2048 sc1
v_mfma_f32_16x16x32_bf16 v[24:27], v[184:187], a[108:111], v[24:27]
ds_read_b64_tr_b16 v[236:237], v11 offset:8192
ds_read_b64_tr_b16 v[238:239], v11 offset:10240
v_mfma_f32_16x16x32_bf16 v[40:43], v[184:187], a[124:127], v[40:43]
ds_read_b64_tr_b16 v[240:241], v8 offset:12288
v_mfma_f32_16x16x32_bf16 v[40:43], v[168:171], a[120:123], v[40:43]
buffer_load_dwordx4 a[60:63], v1, s[44:47], s69 offen offset:3072 sc1
v_mfma_f32_16x16x32_bf16 v[40:43], v[152:155], a[116:119], v[40:43]
s_add_u32 s71, s61, 2
ds_read_b64_tr_b16 v[242:243], v8 offset:14336
ds_read_b64_tr_b16 v[244:245], v9 offset:12288
v_mfma_f32_16x16x32_bf16 v[40:43], v[136:139], a[112:115], v[40:43]
s_and_b32 s71, s71, 3
ds_read_b64_tr_b16 v[246:247], v9 offset:14336
ds_read_b64_tr_b16 v[248:249], v10 offset:12288
v_mfma_f32_16x16x32_bf16 v[44:47], v[140:143], a[112:115], v[44:47]
s_add_u32 s71, s71, s78
s_lshl_b32 s71, s71, 18
s_add_u32 s71, s71, s94
s_add_u32 m0, s77, 32768
s_add_u32 s72, s71, 0
buffer_load_dwordx4 v15, s[24:27], s72 offen lds
v_mfma_f32_16x16x32_bf16 v[44:47], v[156:159], a[116:119], v[44:47]
s_add_u32 s72, s71, 15360
ds_read_b64_tr_b16 v[250:251], v10 offset:14336
ds_read_b64_tr_b16 v[252:253], v11 offset:12288
v_mfma_f32_16x16x32_bf16 v[44:47], v[172:175], a[120:123], v[44:47]
ds_read_b64_tr_b16 v[254:255], v11 offset:14336
v_mfma_f32_16x16x32_bf16 v[44:47], v[188:191], a[124:127], v[44:47]
buffer_load_dwordx4 v15, s[24:27], s72 offen offset:1024 lds
v_mfma_f32_16x16x32_bf16 v[28:31], v[188:191], a[108:111], v[28:31]
s_add_u32 s72, s71, 30720
v_mfma_f32_16x16x32_bf16 v[28:31], v[172:175], a[104:107], v[28:31]
buffer_load_dwordx4 v15, s[24:27], s72 offen offset:2048 lds
v_mfma_f32_16x16x32_bf16 v[28:31], v[156:159], a[100:103], v[28:31]
s_waitcnt vmcnt(11) lgkmcnt(0)
v_mfma_f32_16x16x32_bf16 v[28:31], v[140:143], a[96:99], v[28:31]
s_barrier
v_mfma_f32_16x16x32_bf16 v[16:19], v[192:195], a[0:3], v[16:19]
s_add_u32 s72, s71, 46080
buffer_load_dwordx4 v15, s[24:27], s72 offen offset:3072 lds
v_sub_f32 v112, 1.0, v6
v_mfma_f32_16x16x32_bf16 v[16:19], v[208:211], a[4:7], v[16:19]
s_add_u32 s69, s61, 2
ds_read_b64_tr_b16 v[128:129], v8 offset:16384
ds_read_b64_tr_b16 v[130:131], v8 offset:18432
v_sub_f32 v113, 1.0, v7
v_mfma_f32_16x16x32_bf16 v[16:19], v[224:227], a[8:11], v[16:19]
s_and_b32 s69, s69, 3
ds_read_b64_tr_b16 v[132:133], v9 offset:16384
ds_read_b64_tr_b16 v[134:135], v9 offset:18432
v_lshlrev_b32 v48, 16, v80
v_mfma_f32_16x16x32_bf16 v[16:19], v[240:243], a[12:15], v[16:19]
s_add_u32 s69, s69, s78
s_lshl_b32 s69, s69, 12
s_add_u32 s69, s69, s95
buffer_load_dwordx4 a[64:67], v1, s[44:47], s69 offen sc1
v_mfma_f32_16x16x32_bf16 v[32:35], v[240:243], a[28:31], v[32:35]
ds_read_b64_tr_b16 v[136:137], v10 offset:16384
ds_read_b64_tr_b16 v[138:139], v10 offset:18432
v_lshlrev_b32 v114, 16, v88
v_mfma_f32_16x16x32_bf16 v[32:35], v[224:227], a[24:27], v[32:35]
ds_read_b64_tr_b16 v[140:141], v11 offset:16384
ds_read_b64_tr_b16 v[142:143], v11 offset:18432
v_mul_f32 v48, v48, v112
v_mfma_f32_16x16x32_bf16 v[32:35], v[208:211], a[20:23], v[32:35]
buffer_load_dwordx4 a[68:71], v1, s[44:47], s69 offen offset:1024 sc1
v_mul_f32 v48, v48, v114
v_mfma_f32_16x16x32_bf16 v[32:35], v[192:195], a[16:19], v[32:35]
ds_read_b64_tr_b16 v[144:145], v8 offset:20480
ds_read_b64_tr_b16 v[146:147], v8 offset:22528
v_and_b32 v49, 0xffff0000, v80
v_mfma_f32_16x16x32_bf16 v[36:39], v[196:199], a[16:19], v[36:39]
buffer_load_dwordx4 a[72:75], v1, s[44:47], s69 offen offset:2048 sc1
v_and_b32 v115, 0xffff0000, v88
v_mfma_f32_16x16x32_bf16 v[36:39], v[212:215], a[20:23], v[36:39]
ds_read_b64_tr_b16 v[148:149], v9 offset:20480
ds_read_b64_tr_b16 v[150:151], v9 offset:22528
v_mul_f32 v49, v49, v112
v_mfma_f32_16x16x32_bf16 v[36:39], v[228:231], a[24:27], v[36:39]
ds_read_b64_tr_b16 v[152:153], v10 offset:20480
ds_read_b64_tr_b16 v[154:155], v10 offset:22528
v_mul_f32 v49, v49, v115
v_mfma_f32_16x16x32_bf16 v[36:39], v[244:247], a[28:31], v[36:39]
buffer_load_dwordx4 a[76:79], v1, s[44:47], s69 offen offset:3072 sc1
v_lshlrev_b32 v50, 16, v81
v_mfma_f32_16x16x32_bf16 v[20:23], v[244:247], a[12:15], v[20:23]
s_add_u32 s69, s69, 0x20000
ds_read_b64_tr_b16 v[156:157], v11 offset:20480
ds_read_b64_tr_b16 v[158:159], v11 offset:22528
v_lshlrev_b32 v114, 16, v89
v_mfma_f32_16x16x32_bf16 v[20:23], v[228:231], a[8:11], v[20:23]
ds_read_b64_tr_b16 v[160:161], v8 offset:24576
v_mul_f32 v50, v50, v112
v_mfma_f32_16x16x32_bf16 v[20:23], v[212:215], a[4:7], v[20:23]
buffer_load_dwordx4 a[80:83], v1, s[44:47], s69 offen sc1
v_mul_f32 v50, v50, v114
v_mfma_f32_16x16x32_bf16 v[20:23], v[196:199], a[0:3], v[20:23]
ds_read_b64_tr_b16 v[162:163], v8 offset:26624
ds_read_b64_tr_b16 v[164:165], v9 offset:24576
v_and_b32 v51, 0xffff0000, v81
v_mfma_f32_16x16x32_bf16 v[24:27], v[200:203], a[0:3], v[24:27]
ds_read_b64_tr_b16 v[166:167], v9 offset:26624
ds_read_b64_tr_b16 v[168:169], v10 offset:24576
v_and_b32 v115, 0xffff0000, v89
v_mfma_f32_16x16x32_bf16 v[24:27], v[216:219], a[4:7], v[24:27]
buffer_load_dwordx4 a[84:87], v1, s[44:47], s69 offen offset:1024 sc1
v_mul_f32 v51, v51, v112
v_mfma_f32_16x16x32_bf16 v[24:27], v[232:235], a[8:11], v[24:27]
ds_read_b64_tr_b16 v[170:171], v10 offset:26624
ds_read_b64_tr_b16 v[172:173], v11 offset:24576
v_mul_f32 v51, v51, v115
v_mfma_f32_16x16x32_bf16 v[24:27], v[248:251], a[12:15], v[24:27]
buffer_load_dwordx4 a[88:91], v1, s[44:47], s69 offen offset:2048 sc1
v_lshlrev_b32 v52, 16, v82
v_mfma_f32_16x16x32_bf16 v[40:43], v[248:251], a[28:31], v[40:43]
ds_read_b64_tr_b16 v[174:175], v11 offset:26624
ds_read_b64_tr_b16 v[176:177], v8 offset:28672
v_lshlrev_b32 v114, 16, v90
v_mfma_f32_16x16x32_bf16 v[40:43], v[232:235], a[24:27], v[40:43]
ds_read_b64_tr_b16 v[178:179], v8 offset:30720
ds_read_b64_tr_b16 v[180:181], v9 offset:28672
v_mul_f32 v52, v52, v112
v_mfma_f32_16x16x32_bf16 v[40:43], v[216:219], a[20:23], v[40:43]
buffer_load_dwordx4 a[92:95], v1, s[44:47], s69 offen offset:3072 sc1
v_mul_f32 v52, v52, v114
v_mfma_f32_16x16x32_bf16 v[40:43], v[200:203], a[16:19], v[40:43]
s_add_u32 s71, s61, 3
ds_read_b64_tr_b16 v[182:183], v9 offset:30720
ds_read_b64_tr_b16 v[184:185], v10 offset:28672
v_and_b32 v53, 0xffff0000, v82
v_mfma_f32_16x16x32_bf16 v[44:47], v[204:207], a[16:19], v[44:47]
s_and_b32 s71, s71, 3
ds_read_b64_tr_b16 v[186:187], v10 offset:30720
ds_read_b64_tr_b16 v[188:189], v11 offset:28672
v_and_b32 v115, 0xffff0000, v90
v_mfma_f32_16x16x32_bf16 v[44:47], v[220:223], a[20:23], v[44:47]
s_add_u32 s71, s71, s78
s_lshl_b32 s71, s71, 18
s_add_u32 s71, s71, s94
s_add_u32 m0, s77, 49152
s_add_u32 s72, s71, 0
buffer_load_dwordx4 v15, s[24:27], s72 offen lds
v_mfma_f32_16x16x32_bf16 v[44:47], v[236:239], a[24:27], v[44:47]
s_add_u32 s72, s71, 15360
ds_read_b64_tr_b16 v[190:191], v11 offset:30720
v_mul_f32 v53, v53, v112
v_mfma_f32_16x16x32_bf16 v[44:47], v[252:255], a[28:31], v[44:47]
v_mul_f32 v53, v53, v115
v_mfma_f32_16x16x32_bf16 v[28:31], v[252:255], a[12:15], v[28:31]
buffer_load_dwordx4 v15, s[24:27], s72 offen offset:1024 lds
v_lshlrev_b32 v54, 16, v83
v_mfma_f32_16x16x32_bf16 v[28:31], v[236:239], a[8:11], v[28:31]
s_add_u32 s72, s71, 30720
v_lshlrev_b32 v114, 16, v91
v_mfma_f32_16x16x32_bf16 v[28:31], v[220:223], a[4:7], v[28:31]
s_waitcnt vmcnt(10) lgkmcnt(0)
v_mul_f32 v54, v54, v112
v_mfma_f32_16x16x32_bf16 v[28:31], v[204:207], a[0:3], v[28:31]
s_barrier
buffer_load_dwordx4 v15, s[24:27], s72 offen offset:2048 lds
v_mul_f32 v54, v54, v114
v_mfma_f32_16x16x32_bf16 v[16:19], v[128:131], a[32:35], v[16:19]
s_add_u32 s72, s71, 46080
ds_read_b64_tr_b16 v[192:193], v8 offset:32768
ds_read_b64_tr_b16 v[194:195], v8 offset:34816
v_and_b32 v55, 0xffff0000, v83
v_mfma_f32_16x16x32_bf16 v[16:19], v[144:147], a[36:39], v[16:19]
buffer_load_dwordx4 v15, s[24:27], s72 offen offset:3072 lds
v_and_b32 v115, 0xffff0000, v91
v_mfma_f32_16x16x32_bf16 v[16:19], v[160:163], a[40:43], v[16:19]
s_add_u32 s69, s61, 3
ds_read_b64_tr_b16 v[196:197], v9 offset:32768
ds_read_b64_tr_b16 v[198:199], v9 offset:34816
v_mul_f32 v55, v55, v112
v_mfma_f32_16x16x32_bf16 v[16:19], v[176:179], a[44:47], v[16:19]
s_and_b32 s69, s69, 3
ds_read_b64_tr_b16 v[200:201], v10 offset:32768
ds_read_b64_tr_b16 v[202:203], v10 offset:34816
v_mul_f32 v55, v55, v115
v_mfma_f32_16x16x32_bf16 v[32:35], v[176:179], a[60:63], v[32:35]
s_add_u32 s69, s69, s78
s_lshl_b32 s69, s69, 12
s_add_u32 s69, s69, s95
buffer_load_dwordx4 a[96:99], v1, s[44:47], s69 offen sc1
v_mfma_f32_16x16x32_bf16 v[32:35], v[160:163], a[56:59], v[32:35]
ds_read_b64_tr_b16 v[204:205], v11 offset:32768
ds_read_b64_tr_b16 v[206:207], v11 offset:34816
v_lshlrev_b32 v56, 16, v84
v_mfma_f32_16x16x32_bf16 v[32:35], v[144:147], a[52:55], v[32:35]
ds_read_b64_tr_b16 v[208:209], v8 offset:36864
ds_read_b64_tr_b16 v[210:211], v8 offset:38912
v_lshlrev_b32 v114, 16, v92
v_mfma_f32_16x16x32_bf16 v[32:35], v[128:131], a[48:51], v[32:35]
buffer_load_dwordx4 a[100:103], v1, s[44:47], s69 offen offset:1024 sc1
v_mul_f32 v56, v56, v112
v_mfma_f32_16x16x32_bf16 v[36:39], v[132:135], a[48:51], v[36:39]
ds_read_b64_tr_b16 v[212:213], v9 offset:36864
ds_read_b64_tr_b16 v[214:215], v9 offset:38912
v_mul_f32 v56, v56, v114
v_mfma_f32_16x16x32_bf16 v[36:39], v[148:151], a[52:55], v[36:39]
ds_read_b64_tr_b16 v[216:217], v10 offset:36864
ds_read_b64_tr_b16 v[218:219], v10 offset:38912
v_and_b32 v57, 0xffff0000, v84
v_mfma_f32_16x16x32_bf16 v[36:39], v[164:167], a[56:59], v[36:39]
buffer_load_dwordx4 a[104:107], v1, s[44:47], s69 offen offset:2048 sc1
v_and_b32 v115, 0xffff0000, v92
v_mfma_f32_16x16x32_bf16 v[36:39], v[180:183], a[60:63], v[36:39]
ds_read_b64_tr_b16 v[220:221], v11 offset:36864
ds_read_b64_tr_b16 v[222:223], v11 offset:38912
v_mul_f32 v57, v57, v112
v_mfma_f32_16x16x32_bf16 v[20:23], v[180:183], a[44:47], v[20:23]
buffer_load_dwordx4 a[108:111], v1, s[44:47], s69 offen offset:3072 sc1
v_mul_f32 v57, v57, v115
v_mfma_f32_16x16x32_bf16 v[20:23], v[164:167], a[40:43], v[20:23]
s_add_u32 s69, s69, 0x20000
ds_read_b64_tr_b16 v[224:225], v8 offset:40960
v_lshlrev_b32 v58, 16, v85
v_mfma_f32_16x16x32_bf16 v[20:23], v[148:151], a[36:39], v[20:23]
ds_read_b64_tr_b16 v[226:227], v8 offset:43008
ds_read_b64_tr_b16 v[228:229], v9 offset:40960
v_lshlrev_b32 v114, 16, v93
v_mfma_f32_16x16x32_bf16 v[20:23], v[132:135], a[32:35], v[20:23]
buffer_load_dwordx4 a[112:115], v1, s[44:47], s69 offen sc1
v_mul_f32 v58, v58, v112
v_mfma_f32_16x16x32_bf16 v[24:27], v[136:139], a[32:35], v[24:27]
ds_read_b64_tr_b16 v[230:231], v9 offset:43008
ds_read_b64_tr_b16 v[232:233], v10 offset:40960
v_mul_f32 v58, v58, v114
v_mfma_f32_16x16x32_bf16 v[24:27], v[152:155], a[36:39], v[24:27]
ds_read_b64_tr_b16 v[234:235], v10 offset:43008
ds_read_b64_tr_b16 v[236:237], v11 offset:40960
v_and_b32 v59, 0xffff0000, v85
v_mfma_f32_16x16x32_bf16 v[24:27], v[168:171], a[40:43], v[24:27]
buffer_load_dwordx4 a[116:119], v1, s[44:47], s69 offen offset:1024 sc1
v_and_b32 v115, 0xffff0000, v93
v_mfma_f32_16x16x32_bf16 v[24:27], v[184:187], a[44:47], v[24:27]
ds_read_b64_tr_b16 v[238:239], v11 offset:43008
ds_read_b64_tr_b16 v[240:241], v8 offset:45056
v_mul_f32 v59, v59, v112
v_mfma_f32_16x16x32_bf16 v[40:43], v[184:187], a[60:63], v[40:43]
ds_read_b64_tr_b16 v[242:243], v8 offset:47104
ds_read_b64_tr_b16 v[244:245], v9 offset:45056
v_mul_f32 v59, v59, v115
v_mfma_f32_16x16x32_bf16 v[40:43], v[168:171], a[56:59], v[40:43]
buffer_load_dwordx4 a[120:123], v1, s[44:47], s69 offen offset:2048 sc1
v_lshlrev_b32 v60, 16, v86
v_mfma_f32_16x16x32_bf16 v[40:43], v[152:155], a[52:55], v[40:43]
ds_read_b64_tr_b16 v[246:247], v9 offset:47104
ds_read_b64_tr_b16 v[248:249], v10 offset:45056
v_lshlrev_b32 v114, 16, v94
v_mfma_f32_16x16x32_bf16 v[40:43], v[136:139], a[48:51], v[40:43]
ds_read_b64_tr_b16 v[250:251], v10 offset:47104
ds_read_b64_tr_b16 v[252:253], v11 offset:45056
v_mul_f32 v60, v60, v112
v_mfma_f32_16x16x32_bf16 v[44:47], v[140:143], a[48:51], v[44:47]
buffer_load_dwordx4 a[124:127], v1, s[44:47], s69 offen offset:3072 sc1
v_mul_f32 v60, v60, v114
v_mfma_f32_16x16x32_bf16 v[44:47], v[156:159], a[52:55], v[44:47]
s_add_u32 s79, s59, 32
ds_read_b64_tr_b16 v[254:255], v11 offset:47104
v_and_b32 v61, 0xffff0000, v86
v_mfma_f32_16x16x32_bf16 v[44:47], v[172:175], a[56:59], v[44:47]
s_and_b32 s79, s79, 28
s_add_u32 s71, s61, 0
s_and_b32 s71, s71, 3
s_add_u32 s71, s71, s79
s_lshl_b32 s71, s71, 18
s_add_u32 s71, s71, s94
s_add_u32 m0, s77, 0
s_add_u32 s72, s71, 0
buffer_load_dwordx4 v15, s[24:27], s72 offen lds
v_mfma_f32_16x16x32_bf16 v[44:47], v[188:191], a[60:63], v[44:47]
s_add_u32 s72, s71, 15360
v_and_b32 v115, 0xffff0000, v94
v_mfma_f32_16x16x32_bf16 v[28:31], v[188:191], a[44:47], v[28:31]
v_mul_f32 v61, v61, v112
v_mfma_f32_16x16x32_bf16 v[28:31], v[172:175], a[40:43], v[28:31]
buffer_load_dwordx4 v15, s[24:27], s72 offen offset:1024 lds
v_mul_f32 v61, v61, v115
v_mfma_f32_16x16x32_bf16 v[28:31], v[156:159], a[36:39], v[28:31]
s_waitcnt vmcnt(10) lgkmcnt(0)
v_lshlrev_b32 v62, 16, v87
v_mfma_f32_16x16x32_bf16 v[28:31], v[140:143], a[32:35], v[28:31]
s_barrier
v_lshlrev_b32 v114, 16, v95
v_mfma_f32_16x16x32_bf16 v[16:19], v[192:195], a[64:67], v[16:19]
s_add_u32 s72, s71, 30720
buffer_load_dwordx4 v15, s[24:27], s72 offen offset:2048 lds
v_mul_f32 v62, v62, v112
v_mfma_f32_16x16x32_bf16 v[16:19], v[208:211], a[68:71], v[16:19]
s_add_u32 s72, s71, 46080
ds_read_b64_tr_b16 v[128:129], v8 offset:49152
ds_read_b64_tr_b16 v[130:131], v8 offset:51200
v_mul_f32 v62, v62, v114
v_mfma_f32_16x16x32_bf16 v[16:19], v[224:227], a[72:75], v[16:19]
ds_read_b64_tr_b16 v[132:133], v9 offset:49152
ds_read_b64_tr_b16 v[134:135], v9 offset:51200
v_and_b32 v63, 0xffff0000, v87
v_mfma_f32_16x16x32_bf16 v[16:19], v[240:243], a[76:79], v[16:19]
buffer_load_dwordx4 v15, s[24:27], s72 offen offset:3072 lds
v_and_b32 v115, 0xffff0000, v95
v_mfma_f32_16x16x32_bf16 v[32:35], v[240:243], a[92:95], v[32:35]
ds_read_b64_tr_b16 v[136:137], v10 offset:49152
ds_read_b64_tr_b16 v[138:139], v10 offset:51200
v_mul_f32 v63, v63, v112
v_mfma_f32_16x16x32_bf16 v[32:35], v[224:227], a[88:91], v[32:35]
s_waitcnt vmcnt(48)
v_cmp_gt_u32 vcc, 2, v3
s_cbranch_vccnz Lspin81
Lback82:
s_add_u32 s69, s61, 0
s_and_b32 s69, s69, 3
s_add_u32 s69, s69, s79
s_lshl_b32 s69, s69, 12
s_add_u32 s69, s69, s95
buffer_load_dwordx4 a[0:3], v1, s[44:47], s69 offen sc1
v_mfma_f32_16x16x32_bf16 v[32:35], v[208:211], a[84:87], v[32:35]
ds_read_b64_tr_b16 v[140:141], v11 offset:49152
ds_read_b64_tr_b16 v[142:143], v11 offset:51200
v_mul_f32 v63, v63, v115
v_mfma_f32_16x16x32_bf16 v[32:35], v[192:195], a[80:83], v[32:35]
ds_read_b64_tr_b16 v[144:145], v8 offset:53248
ds_read_b64_tr_b16 v[146:147], v8 offset:55296
v_lshlrev_b32 v64, 16, v96
v_mfma_f32_16x16x32_bf16 v[36:39], v[196:199], a[80:83], v[36:39]
buffer_load_dwordx4 a[4:7], v1, s[44:47], s69 offen offset:1024 sc1
v_lshlrev_b32 v114, 16, v104
v_mfma_f32_16x16x32_bf16 v[36:39], v[212:215], a[84:87], v[36:39]
ds_read_b64_tr_b16 v[148:149], v9 offset:53248
ds_read_b64_tr_b16 v[150:151], v9 offset:55296
v_mul_f32 v64, v64, v113
v_mfma_f32_16x16x32_bf16 v[36:39], v[228:231], a[88:91], v[36:39]
ds_read_b64_tr_b16 v[152:153], v10 offset:53248
ds_read_b64_tr_b16 v[154:155], v10 offset:55296
v_mul_f32 v64, v64, v114
v_mfma_f32_16x16x32_bf16 v[36:39], v[244:247], a[92:95], v[36:39]
buffer_load_dwordx4 a[8:11], v1, s[44:47], s69 offen offset:2048 sc1
v_and_b32 v65, 0xffff0000, v96
v_mfma_f32_16x16x32_bf16 v[20:23], v[244:247], a[76:79], v[20:23]
ds_read_b64_tr_b16 v[156:157], v11 offset:53248
ds_read_b64_tr_b16 v[158:159], v11 offset:55296
v_and_b32 v115, 0xffff0000, v104
v_mfma_f32_16x16x32_bf16 v[20:23], v[228:231], a[72:75], v[20:23]
ds_read_b64_tr_b16 v[160:161], v8 offset:57344
v_mul_f32 v65, v65, v113
v_mfma_f32_16x16x32_bf16 v[20:23], v[212:215], a[68:71], v[20:23]
buffer_load_dwordx4 a[12:15], v1, s[44:47], s69 offen offset:3072 sc1
v_mul_f32 v65, v65, v115
v_mfma_f32_16x16x32_bf16 v[20:23], v[196:199], a[64:67], v[20:23]
s_add_u32 s69, s69, 0x20000
ds_read_b64_tr_b16 v[162:163], v8 offset:59392
ds_read_b64_tr_b16 v[164:165], v9 offset:57344
v_lshlrev_b32 v66, 16, v97
v_mfma_f32_16x16x32_bf16 v[24:27], v[200:203], a[64:67], v[24:27]
ds_read_b64_tr_b16 v[166:167], v9 offset:59392
ds_read_b64_tr_b16 v[168:169], v10 offset:57344
v_lshlrev_b32 v114, 16, v105
v_mfma_f32_16x16x32_bf16 v[24:27], v[216:219], a[68:71], v[24:27]
buffer_load_dwordx4 a[16:19], v1, s[44:47], s69 offen sc1
v_mul_f32 v66, v66, v113
v_mfma_f32_16x16x32_bf16 v[24:27], v[232:235], a[72:75], v[24:27]
ds_read_b64_tr_b16 v[170:171], v10 offset:59392
ds_read_b64_tr_b16 v[172:173], v11 offset:57344
v_mul_f32 v66, v66, v114
v_mfma_f32_16x16x32_bf16 v[24:27], v[248:251], a[76:79], v[24:27]
buffer_load_dwordx4 a[20:23], v1, s[44:47], s69 offen offset:1024 sc1
v_and_b32 v67, 0xffff0000, v97
v_mfma_f32_16x16x32_bf16 v[40:43], v[248:251], a[92:95], v[40:43]
ds_read_b64_tr_b16 v[174:175], v11 offset:59392
ds_read_b64_tr_b16 v[176:177], v8 offset:61440
v_and_b32 v115, 0xffff0000, v105
v_mfma_f32_16x16x32_bf16 v[40:43], v[232:235], a[88:91], v[40:43]
ds_read_b64_tr_b16 v[178:179], v8 offset:63488
ds_read_b64_tr_b16 v[180:181], v9 offset:61440
v_mul_f32 v67, v67, v113
v_mfma_f32_16x16x32_bf16 v[40:43], v[216:219], a[84:87], v[40:43]
buffer_load_dwordx4 a[24:27], v1, s[44:47], s69 offen offset:2048 sc1
v_mul_f32 v67, v67, v115
v_mfma_f32_16x16x32_bf16 v[40:43], v[200:203], a[80:83], v[40:43]
ds_read_b64_tr_b16 v[182:183], v9 offset:63488
ds_read_b64_tr_b16 v[184:185], v10 offset:61440
v_lshlrev_b32 v68, 16, v98
v_mfma_f32_16x16x32_bf16 v[44:47], v[204:207], a[80:83], v[44:47]
ds_read_b64_tr_b16 v[186:187], v10 offset:63488
ds_read_b64_tr_b16 v[188:189], v11 offset:61440
v_lshlrev_b32 v114, 16, v106
v_mfma_f32_16x16x32_bf16 v[44:47], v[220:223], a[84:87], v[44:47]
buffer_load_dwordx4 a[28:31], v1, s[44:47], s69 offen offset:3072 sc1
v_mul_f32 v68, v68, v113
v_mfma_f32_16x16x32_bf16 v[44:47], v[236:239], a[88:91], v[44:47]
s_add_u32 s71, s61, 1
ds_read_b64_tr_b16 v[190:191], v11 offset:63488
v_mul_f32 v68, v68, v114
v_mfma_f32_16x16x32_bf16 v[44:47], v[252:255], a[92:95], v[44:47]
s_and_b32 s71, s71, 3
v_and_b32 v69, 0xffff0000, v98
v_mfma_f32_16x16x32_bf16 v[28:31], v[252:255], a[76:79], v[28:31]
s_add_u32 s71, s71, s79
s_lshl_b32 s71, s71, 18
s_add_u32 s71, s71, s94
s_add_u32 m0, s77, 16384
s_add_u32 s72, s71, 0
buffer_load_dwordx4 v15, s[24:27], s72 offen lds
v_mfma_f32_16x16x32_bf16 v[28:31], v[236:239], a[72:75], v[28:31]
s_add_u32 s72, s71, 15360
v_and_b32 v115, 0xffff0000, v106
v_mfma_f32_16x16x32_bf16 v[28:31], v[220:223], a[68:71], v[28:31]
s_waitcnt vmcnt(9) lgkmcnt(0)
buffer_load_dwordx4 v15, s[24:27], s72 offen offset:1024 lds
v_mul_f32 v69, v69, v113
v_mfma_f32_16x16x32_bf16 v[28:31], v[204:207], a[64:67], v[28:31]
s_barrier
v_mul_f32 v69, v69, v115
v_mfma_f32_16x16x32_bf16 v[16:19], v[128:131], a[96:99], v[16:19]
s_add_u32 s72, s71, 30720
ds_read_b64_tr_b16 v[192:193], v8 offset:0
ds_read_b64_tr_b16 v[194:195], v8 offset:2048
v_lshlrev_b32 v70, 16, v99
v_mfma_f32_16x16x32_bf16 v[16:19], v[144:147], a[100:103], v[16:19]
buffer_load_dwordx4 v15, s[24:27], s72 offen offset:2048 lds
v_lshlrev_b32 v114, 16, v107
v_mfma_f32_16x16x32_bf16 v[16:19], v[160:163], a[104:107], v[16:19]
s_add_u32 s72, s71, 46080
ds_read_b64_tr_b16 v[196:197], v9 offset:0
ds_read_b64_tr_b16 v[198:199], v9 offset:2048
v_mul_f32 v70, v70, v113
v_mfma_f32_16x16x32_bf16 v[16:19], v[176:179], a[108:111], v[16:19]
ds_read_b64_tr_b16 v[200:201], v10 offset:0
ds_read_b64_tr_b16 v[202:203], v10 offset:2048
v_mul_f32 v70, v70, v114
v_mfma_f32_16x16x32_bf16 v[32:35], v[176:179], a[124:127], v[32:35]
buffer_load_dwordx4 v15, s[24:27], s72 offen offset:3072 lds
v_and_b32 v71, 0xffff0000, v99
v_mfma_f32_16x16x32_bf16 v[32:35], v[160:163], a[120:123], v[32:35]
s_add_u32 s69, s61, 1
ds_read_b64_tr_b16 v[204:205], v11 offset:0
ds_read_b64_tr_b16 v[206:207], v11 offset:2048
v_and_b32 v115, 0xffff0000, v107
v_mfma_f32_16x16x32_bf16 v[32:35], v[144:147], a[116:119], v[32:35]
s_and_b32 s69, s69, 3
ds_read_b64_tr_b16 v[208:209], v8 offset:4096
ds_read_b64_tr_b16 v[210:211], v8 offset:6144
v_mul_f32 v71, v71, v113
v_mfma_f32_16x16x32_bf16 v[32:35], v[128:131], a[112:115], v[32:35]
s_add_u32 s69, s69, s79
s_lshl_b32 s69, s69, 12
s_add_u32 s69, s69, s95
buffer_load_dwordx4 a[32:35], v1, s[44:47], s69 offen sc1
v_mfma_f32_16x16x32_bf16 v[36:39], v[132:135], a[112:115], v[36:39]
ds_read_b64_tr_b16 v[212:213], v9 offset:4096
ds_read_b64_tr_b16 v[214:215], v9 offset:6144
v_mul_f32 v71, v71, v115
v_mfma_f32_16x16x32_bf16 v[36:39], v[148:151], a[116:119], v[36:39]
buffer_load_dwordx4 a[36:39], v1, s[44:47], s69 offen offset:1024 sc1
v_lshlrev_b32 v72, 16, v100
v_mfma_f32_16x16x32_bf16 v[36:39], v[164:167], a[120:123], v[36:39]
ds_read_b64_tr_b16 v[216:217], v10 offset:4096
ds_read_b64_tr_b16 v[218:219], v10 offset:6144
v_lshlrev_b32 v114, 16, v108
v_mfma_f32_16x16x32_bf16 v[36:39], v[180:183], a[124:127], v[36:39]
ds_read_b64_tr_b16 v[220:221], v11 offset:4096
ds_read_b64_tr_b16 v[222:223], v11 offset:6144
v_mul_f32 v72, v72, v113
v_mfma_f32_16x16x32_bf16 v[20:23], v[180:183], a[108:111], v[20:23]
buffer_load_dwordx4 a[40:43], v1, s[44:47], s69 offen offset:2048 sc1
v_mul_f32 v72, v72, v114
v_mfma_f32_16x16x32_bf16 v[20:23], v[164:167], a[104:107], v[20:23]
ds_read_b64_tr_b16 v[224:225], v8 offset:8192
v_and_b32 v73, 0xffff0000, v100
v_mfma_f32_16x16x32_bf16 v[20:23], v[148:151], a[100:103], v[20:23]
ds_read_b64_tr_b16 v[226:227], v8 offset:10240
ds_read_b64_tr_b16 v[228:229], v9 offset:8192
v_and_b32 v115, 0xffff0000, v108
v_mfma_f32_16x16x32_bf16 v[20:23], v[132:135], a[96:99], v[20:23]
buffer_load_dwordx4 a[44:47], v1, s[44:47], s69 offen offset:3072 sc1
v_mul_f32 v73, v73, v113
v_mfma_f32_16x16x32_bf16 v[24:27], v[136:139], a[96:99], v[24:27]
s_add_u32 s69, s69, 0x20000
ds_read_b64_tr_b16 v[230:231], v9 offset:10240
ds_read_b64_tr_b16 v[232:233], v10 offset:8192
v_mul_f32 v73, v73, v115
v_mfma_f32_16x16x32_bf16 v[24:27], v[152:155], a[100:103], v[24:27]
ds_read_b64_tr_b16 v[234:235], v10 offset:10240
ds_read_b64_tr_b16 v[236:237], v11 offset:8192
v_lshlrev_b32 v74, 16, v101
v_mfma_f32_16x16x32_bf16 v[24:27], v[168:171], a[104:107], v[24:27]
buffer_load_dwordx4 a[48:51], v1, s[44:47], s69 offen sc1
v_lshlrev_b32 v114, 16, v109
v_mfma_f32_16x16x32_bf16 v[24:27], v[184:187], a[108:111], v[24:27]
ds_read_b64_tr_b16 v[238:239], v11 offset:10240
ds_read_b64_tr_b16 v[240:241], v8 offset:12288
v_mul_f32 v74, v74, v113
v_mfma_f32_16x16x32_bf16 v[40:43], v[184:187], a[124:127], v[40:43]
ds_read_b64_tr_b16 v[242:243], v8 offset:14336
ds_read_b64_tr_b16 v[244:245], v9 offset:12288
v_mul_f32 v74, v74, v114
v_mfma_f32_16x16x32_bf16 v[40:43], v[168:171], a[120:123], v[40:43]
buffer_load_dwordx4 a[52:55], v1, s[44:47], s69 offen offset:1024 sc1
v_and_b32 v75, 0xffff0000, v101
v_mfma_f32_16x16x32_bf16 v[40:43], v[152:155], a[116:119], v[40:43]
ds_read_b64_tr_b16 v[246:247], v9 offset:14336
ds_read_b64_tr_b16 v[248:249], v10 offset:12288
v_and_b32 v115, 0xffff0000, v109
v_mfma_f32_16x16x32_bf16 v[40:43], v[136:139], a[112:115], v[40:43]
buffer_load_dwordx4 a[56:59], v1, s[44:47], s69 offen offset:2048 sc1
v_mul_f32 v75, v75, v113
v_mfma_f32_16x16x32_bf16 v[44:47], v[140:143], a[112:115], v[44:47]
ds_read_b64_tr_b16 v[250:251], v10 offset:14336
ds_read_b64_tr_b16 v[252:253], v11 offset:12288
v_mul_f32 v75, v75, v115
v_mfma_f32_16x16x32_bf16 v[44:47], v[156:159], a[116:119], v[44:47]
ds_read_b64_tr_b16 v[254:255], v11 offset:14336
v_lshlrev_b32 v76, 16, v102
v_mfma_f32_16x16x32_bf16 v[44:47], v[172:175], a[120:123], v[44:47]
buffer_load_dwordx4 a[60:63], v1, s[44:47], s69 offen offset:3072 sc1
v_lshlrev_b32 v114, 16, v110
v_mfma_f32_16x16x32_bf16 v[44:47], v[188:191], a[124:127], v[44:47]
s_add_u32 s71, s61, 2
v_mul_f32 v76, v76, v113
v_mfma_f32_16x16x32_bf16 v[28:31], v[188:191], a[108:111], v[28:31]
s_and_b32 s71, s71, 3
v_mul_f32 v76, v76, v114
v_mfma_f32_16x16x32_bf16 v[28:31], v[172:175], a[104:107], v[28:31]
s_add_u32 s71, s71, s79
s_lshl_b32 s71, s71, 18
s_add_u32 s71, s71, s94
s_add_u32 m0, s77, 32768
s_add_u32 s72, s71, 0
buffer_load_dwordx4 v15, s[24:27], s72 offen lds
v_mfma_f32_16x16x32_bf16 v[28:31], v[156:159], a[100:103], v[28:31]
s_waitcnt vmcnt(9) lgkmcnt(0)
v_and_b32 v77, 0xffff0000, v102
v_mfma_f32_16x16x32_bf16 v[28:31], v[140:143], a[96:99], v[28:31]
s_barrier
v_and_b32 v115, 0xffff0000, v110
v_mfma_f32_16x16x32_bf16 v[16:19], v[192:195], a[0:3], v[16:19]
s_add_u32 s72, s71, 15360
buffer_load_dwordx4 v15, s[24:27], s72 offen offset:1024 lds
v_mul_f32 v77, v77, v113
v_mfma_f32_16x16x32_bf16 v[16:19], v[208:211], a[4:7], v[16:19]
s_add_u32 s72, s71, 30720
ds_read_b64_tr_b16 v[128:129], v8 offset:16384
ds_read_b64_tr_b16 v[130:131], v8 offset:18432
v_mul_f32 v77, v77, v115
v_mfma_f32_16x16x32_bf16 v[16:19], v[224:227], a[8:11], v[16:19]
buffer_load_dwordx4 v15, s[24:27], s72 offen offset:2048 lds
v_lshlrev_b32 v78, 16, v103
v_mfma_f32_16x16x32_bf16 v[16:19], v[240:243], a[12:15], v[16:19]
s_add_u32 s72, s71, 46080
ds_read_b64_tr_b16 v[132:133], v9 offset:16384
ds_read_b64_tr_b16 v[134:135], v9 offset:18432
v_lshlrev_b32 v114, 16, v111
v_mfma_f32_16x16x32_bf16 v[32:35], v[240:243], a[28:31], v[32:35]
ds_read_b64_tr_b16 v[136:137], v10 offset:16384
ds_read_b64_tr_b16 v[138:139], v10 offset:18432
v_mul_f32 v78, v78, v113
v_mfma_f32_16x16x32_bf16 v[32:35], v[224:227], a[24:27], v[32:35]
buffer_load_dwordx4 v15, s[24:27], s72 offen offset:3072 lds
v_mul_f32 v78, v78, v114
v_mfma_f32_16x16x32_bf16 v[32:35], v[208:211], a[20:23], v[32:35]
s_add_u32 s69, s61, 2
ds_read_b64_tr_b16 v[140:141], v11 offset:16384
ds_read_b64_tr_b16 v[142:143], v11 offset:18432
v_and_b32 v79, 0xffff0000, v103
v_mfma_f32_16x16x32_bf16 v[32:35], v[192:195], a[16:19], v[32:35]
s_and_b32 s69, s69, 3
ds_read_b64_tr_b16 v[144:145], v8 offset:20480
ds_read_b64_tr_b16 v[146:147], v8 offset:22528
v_and_b32 v115, 0xffff0000, v111
v_mfma_f32_16x16x32_bf16 v[36:39], v[196:199], a[16:19], v[36:39]
s_add_u32 s69, s69, s79
s_lshl_b32 s69, s69, 12
s_add_u32 s69, s69, s95
buffer_load_dwordx4 a[64:67], v1, s[44:47], s69 offen sc1
v_mfma_f32_16x16x32_bf16 v[36:39], v[212:215], a[20:23], v[36:39]
ds_read_b64_tr_b16 v[148:149], v9 offset:20480
ds_read_b64_tr_b16 v[150:151], v9 offset:22528
v_mul_f32 v79, v79, v113
v_mfma_f32_16x16x32_bf16 v[36:39], v[228:231], a[24:27], v[36:39]
ds_read_b64_tr_b16 v[152:153], v10 offset:20480
ds_read_b64_tr_b16 v[154:155], v10 offset:22528
v_mul_f32 v79, v79, v115
v_mfma_f32_16x16x32_bf16 v[36:39], v[244:247], a[28:31], v[36:39]
buffer_load_dwordx4 a[68:71], v1, s[44:47], s69 offen offset:1024 sc1
v_mfma_f32_16x16x32_bf16 v[20:23], v[244:247], a[12:15], v[20:23]
ds_read_b64_tr_b16 v[156:157], v11 offset:20480
ds_read_b64_tr_b16 v[158:159], v11 offset:22528
v_mfma_f32_16x16x32_bf16 v[20:23], v[228:231], a[8:11], v[20:23]
ds_read_b64_tr_b16 v[160:161], v8 offset:24576
v_mfma_f32_16x16x32_bf16 v[20:23], v[212:215], a[4:7], v[20:23]
buffer_load_dwordx4 a[72:75], v1, s[44:47], s69 offen offset:2048 sc1
v_mfma_f32_16x16x32_bf16 v[20:23], v[196:199], a[0:3], v[20:23]
ds_read_b64_tr_b16 v[162:163], v8 offset:26624
ds_read_b64_tr_b16 v[164:165], v9 offset:24576
v_mfma_f32_16x16x32_bf16 v[24:27], v[200:203], a[0:3], v[24:27]
buffer_load_dwordx4 a[76:79], v1, s[44:47], s69 offen offset:3072 sc1
v_mfma_f32_16x16x32_bf16 v[24:27], v[216:219], a[4:7], v[24:27]
s_add_u32 s69, s69, 0x20000
ds_read_b64_tr_b16 v[166:167], v9 offset:26624
ds_read_b64_tr_b16 v[168:169], v10 offset:24576
v_mfma_f32_16x16x32_bf16 v[24:27], v[232:235], a[8:11], v[24:27]
ds_read_b64_tr_b16 v[170:171], v10 offset:26624
ds_read_b64_tr_b16 v[172:173], v11 offset:24576
v_mfma_f32_16x16x32_bf16 v[24:27], v[248:251], a[12:15], v[24:27]
buffer_load_dwordx4 a[80:83], v1, s[44:47], s69 offen sc1
v_mfma_f32_16x16x32_bf16 v[40:43], v[248:251], a[28:31], v[40:43]
ds_read_b64_tr_b16 v[174:175], v11 offset:26624
ds_read_b64_tr_b16 v[176:177], v8 offset:28672
v_mfma_f32_16x16x32_bf16 v[40:43], v[232:235], a[24:27], v[40:43]
ds_read_b64_tr_b16 v[178:179], v8 offset:30720
ds_read_b64_tr_b16 v[180:181], v9 offset:28672
v_mfma_f32_16x16x32_bf16 v[40:43], v[216:219], a[20:23], v[40:43]
buffer_load_dwordx4 a[84:87], v1, s[44:47], s69 offen offset:1024 sc1
v_mfma_f32_16x16x32_bf16 v[40:43], v[200:203], a[16:19], v[40:43]
ds_read_b64_tr_b16 v[182:183], v9 offset:30720
ds_read_b64_tr_b16 v[184:185], v10 offset:28672
v_mfma_f32_16x16x32_bf16 v[44:47], v[204:207], a[16:19], v[44:47]
ds_read_b64_tr_b16 v[186:187], v10 offset:30720
ds_read_b64_tr_b16 v[188:189], v11 offset:28672
v_mfma_f32_16x16x32_bf16 v[44:47], v[220:223], a[20:23], v[44:47]
buffer_load_dwordx4 a[88:91], v1, s[44:47], s69 offen offset:2048 sc1
v_mfma_f32_16x16x32_bf16 v[44:47], v[236:239], a[24:27], v[44:47]
ds_read_b64_tr_b16 v[190:191], v11 offset:30720
v_mfma_f32_16x16x32_bf16 v[44:47], v[252:255], a[28:31], v[44:47]
buffer_load_dwordx4 a[92:95], v1, s[44:47], s69 offen offset:3072 sc1
v_mfma_f32_16x16x32_bf16 v[28:31], v[252:255], a[12:15], v[28:31]
s_add_u32 s71, s61, 3
v_mfma_f32_16x16x32_bf16 v[28:31], v[236:239], a[8:11], v[28:31]
s_and_b32 s71, s71, 3
v_mfma_f32_16x16x32_bf16 v[28:31], v[220:223], a[4:7], v[28:31]
s_waitcnt vmcnt(8) lgkmcnt(0)
s_add_u32 s71, s71, s79
s_lshl_b32 s71, s71, 18
s_add_u32 s71, s71, s94
s_add_u32 m0, s77, 49152
s_add_u32 s72, s71, 0
buffer_load_dwordx4 v15, s[24:27], s72 offen lds
v_mfma_f32_16x16x32_bf16 v[28:31], v[204:207], a[0:3], v[28:31]
s_barrier
v_mfma_f32_16x16x32_bf16 v[16:19], v[128:131], a[32:35], v[16:19]
s_add_u32 s72, s71, 15360
ds_read_b64_tr_b16 v[192:193], v8 offset:32768
ds_read_b64_tr_b16 v[194:195], v8 offset:34816
v_mfma_f32_16x16x32_bf16 v[16:19], v[144:147], a[36:39], v[16:19]
buffer_load_dwordx4 v15, s[24:27], s72 offen offset:1024 lds
v_mfma_f32_16x16x32_bf16 v[16:19], v[160:163], a[40:43], v[16:19]
s_add_u32 s72, s71, 30720
ds_read_b64_tr_b16 v[196:197], v9 offset:32768
ds_read_b64_tr_b16 v[198:199], v9 offset:34816
v_mfma_f32_16x16x32_bf16 v[16:19], v[176:179], a[44:47], v[16:19]
ds_read_b64_tr_b16 v[200:201], v10 offset:32768
ds_read_b64_tr_b16 v[202:203], v10 offset:34816
v_mfma_f32_16x16x32_bf16 v[32:35], v[176:179], a[60:63], v[32:35]
buffer_load_dwordx4 v15, s[24:27], s72 offen offset:2048 lds
v_mfma_f32_16x16x32_bf16 v[32:35], v[160:163], a[56:59], v[32:35]
s_add_u32 s72, s71, 46080
ds_read_b64_tr_b16 v[204:205], v11 offset:32768
ds_read_b64_tr_b16 v[206:207], v11 offset:34816
v_mfma_f32_16x16x32_bf16 v[32:35], v[144:147], a[52:55], v[32:35]
ds_read_b64_tr_b16 v[208:209], v8 offset:36864
ds_read_b64_tr_b16 v[210:211], v8 offset:38912
v_mfma_f32_16x16x32_bf16 v[32:35], v[128:131], a[48:51], v[32:35]
buffer_load_dwordx4 v15, s[24:27], s72 offen offset:3072 lds
v_mfma_f32_16x16x32_bf16 v[36:39], v[132:135], a[48:51], v[36:39]
s_add_u32 s69, s61, 3
ds_read_b64_tr_b16 v[212:213], v9 offset:36864
ds_read_b64_tr_b16 v[214:215], v9 offset:38912
v_mfma_f32_16x16x32_bf16 v[36:39], v[148:151], a[52:55], v[36:39]
s_and_b32 s69, s69, 3
s_add_u32 s69, s69, s79
s_lshl_b32 s69, s69, 12
s_add_u32 s69, s69, s95
buffer_load_dwordx4 a[96:99], v1, s[44:47], s69 offen sc1
v_mfma_f32_16x16x32_bf16 v[36:39], v[164:167], a[56:59], v[36:39]
ds_read_b64_tr_b16 v[216:217], v10 offset:36864
ds_read_b64_tr_b16 v[218:219], v10 offset:38912
v_mfma_f32_16x16x32_bf16 v[36:39], v[180:183], a[60:63], v[36:39]
ds_read_b64_tr_b16 v[220:221], v11 offset:36864
ds_read_b64_tr_b16 v[222:223], v11 offset:38912
v_mfma_f32_16x16x32_bf16 v[20:23], v[180:183], a[44:47], v[20:23]
buffer_load_dwordx4 a[100:103], v1, s[44:47], s69 offen offset:1024 sc1
v_mfma_f32_16x16x32_bf16 v[20:23], v[164:167], a[40:43], v[20:23]
ds_read_b64_tr_b16 v[224:225], v8 offset:40960
v_mfma_f32_16x16x32_bf16 v[20:23], v[148:151], a[36:39], v[20:23]
ds_read_b64_tr_b16 v[226:227], v8 offset:43008
ds_read_b64_tr_b16 v[228:229], v9 offset:40960
v_mfma_f32_16x16x32_bf16 v[20:23], v[132:135], a[32:35], v[20:23]
buffer_load_dwordx4 a[104:107], v1, s[44:47], s69 offen offset:2048 sc1
v_mfma_f32_16x16x32_bf16 v[24:27], v[136:139], a[32:35], v[24:27]
ds_read_b64_tr_b16 v[230:231], v9 offset:43008
ds_read_b64_tr_b16 v[232:233], v10 offset:40960
v_mfma_f32_16x16x32_bf16 v[24:27], v[152:155], a[36:39], v[24:27]
ds_read_b64_tr_b16 v[234:235], v10 offset:43008
ds_read_b64_tr_b16 v[236:237], v11 offset:40960
v_mfma_f32_16x16x32_bf16 v[24:27], v[168:171], a[40:43], v[24:27]
buffer_load_dwordx4 a[108:111], v1, s[44:47], s69 offen offset:3072 sc1
v_mfma_f32_16x16x32_bf16 v[24:27], v[184:187], a[44:47], v[24:27]
s_add_u32 s69, s69, 0x20000
ds_read_b64_tr_b16 v[238:239], v11 offset:43008
ds_read_b64_tr_b16 v[240:241], v8 offset:45056
v_mfma_f32_16x16x32_bf16 v[40:43], v[184:187], a[60:63], v[40:43]
buffer_load_dwordx4 a[112:115], v1, s[44:47], s69 offen sc1
v_mfma_f32_16x16x32_bf16 v[40:43], v[168:171], a[56:59], v[40:43]
ds_read_b64_tr_b16 v[242:243], v8 offset:47104
ds_read_b64_tr_b16 v[244:245], v9 offset:45056
v_mfma_f32_16x16x32_bf16 v[40:43], v[152:155], a[52:55], v[40:43]
ds_read_b64_tr_b16 v[246:247], v9 offset:47104
ds_read_b64_tr_b16 v[248:249], v10 offset:45056
v_mfma_f32_16x16x32_bf16 v[40:43], v[136:139], a[48:51], v[40:43]
buffer_load_dwordx4 a[116:119], v1, s[44:47], s69 offen offset:1024 sc1
v_mfma_f32_16x16x32_bf16 v[44:47], v[140:143], a[48:51], v[44:47]
ds_read_b64_tr_b16 v[250:251], v10 offset:47104
ds_read_b64_tr_b16 v[252:253], v11 offset:45056
v_mfma_f32_16x16x32_bf16 v[44:47], v[156:159], a[52:55], v[44:47]
ds_read_b64_tr_b16 v[254:255], v11 offset:47104
v_mfma_f32_16x16x32_bf16 v[44:47], v[172:175], a[56:59], v[44:47]
buffer_load_dwordx4 a[120:123], v1, s[44:47], s69 offen offset:2048 sc1
v_mfma_f32_16x16x32_bf16 v[44:47], v[188:191], a[60:63], v[44:47]
v_mfma_f32_16x16x32_bf16 v[28:31], v[188:191], a[44:47], v[28:31]
v_mfma_f32_16x16x32_bf16 v[28:31], v[172:175], a[40:43], v[28:31]
buffer_load_dwordx4 a[124:127], v1, s[44:47], s69 offen offset:3072 sc1
v_mfma_f32_16x16x32_bf16 v[28:31], v[156:159], a[36:39], v[28:31]
s_waitcnt vmcnt(8) lgkmcnt(0)
v_mfma_f32_16x16x32_bf16 v[28:31], v[140:143], a[32:35], v[28:31]
s_barrier
v_mfma_f32_16x16x32_bf16 v[16:19], v[192:195], a[64:67], v[16:19]
ds_read_b64_tr_b16 v[128:129], v8 offset:49152
ds_read_b64_tr_b16 v[130:131], v8 offset:51200
v_mfma_f32_16x16x32_bf16 v[16:19], v[208:211], a[68:71], v[16:19]
ds_read_b64_tr_b16 v[132:133], v9 offset:49152
v_mfma_f32_16x16x32_bf16 v[16:19], v[224:227], a[72:75], v[16:19]
ds_read_b64_tr_b16 v[134:135], v9 offset:51200
v_mfma_f32_16x16x32_bf16 v[16:19], v[240:243], a[76:79], v[16:19]
ds_read_b64_tr_b16 v[136:137], v10 offset:49152
v_mfma_f32_16x16x32_bf16 v[32:35], v[240:243], a[92:95], v[32:35]
ds_read_b64_tr_b16 v[138:139], v10 offset:51200
v_mfma_f32_16x16x32_bf16 v[32:35], v[224:227], a[88:91], v[32:35]
ds_read_b64_tr_b16 v[140:141], v11 offset:49152
ds_read_b64_tr_b16 v[142:143], v11 offset:51200
v_mfma_f32_16x16x32_bf16 v[32:35], v[208:211], a[84:87], v[32:35]
ds_read_b64_tr_b16 v[144:145], v8 offset:53248
v_mfma_f32_16x16x32_bf16 v[32:35], v[192:195], a[80:83], v[32:35]
ds_read_b64_tr_b16 v[146:147], v8 offset:55296
v_mfma_f32_16x16x32_bf16 v[36:39], v[196:199], a[80:83], v[36:39]
ds_read_b64_tr_b16 v[148:149], v9 offset:53248
v_mfma_f32_16x16x32_bf16 v[36:39], v[212:215], a[84:87], v[36:39]
ds_read_b64_tr_b16 v[150:151], v9 offset:55296
v_mfma_f32_16x16x32_bf16 v[36:39], v[228:231], a[88:91], v[36:39]
ds_read_b64_tr_b16 v[152:153], v10 offset:53248
ds_read_b64_tr_b16 v[154:155], v10 offset:55296
v_mfma_f32_16x16x32_bf16 v[36:39], v[244:247], a[92:95], v[36:39]
ds_read_b64_tr_b16 v[156:157], v11 offset:53248
v_mfma_f32_16x16x32_bf16 v[20:23], v[244:247], a[76:79], v[20:23]
ds_read_b64_tr_b16 v[158:159], v11 offset:55296
v_mfma_f32_16x16x32_bf16 v[20:23], v[228:231], a[72:75], v[20:23]
ds_read_b64_tr_b16 v[160:161], v8 offset:57344
v_mfma_f32_16x16x32_bf16 v[20:23], v[212:215], a[68:71], v[20:23]
ds_read_b64_tr_b16 v[162:163], v8 offset:59392
v_mfma_f32_16x16x32_bf16 v[20:23], v[196:199], a[64:67], v[20:23]
ds_read_b64_tr_b16 v[164:165], v9 offset:57344
v_mfma_f32_16x16x32_bf16 v[24:27], v[200:203], a[64:67], v[24:27]
ds_read_b64_tr_b16 v[166:167], v9 offset:59392
ds_read_b64_tr_b16 v[168:169], v10 offset:57344
v_mfma_f32_16x16x32_bf16 v[24:27], v[216:219], a[68:71], v[24:27]
ds_read_b64_tr_b16 v[170:171], v10 offset:59392
v_mfma_f32_16x16x32_bf16 v[24:27], v[232:235], a[72:75], v[24:27]
ds_read_b64_tr_b16 v[172:173], v11 offset:57344
v_mfma_f32_16x16x32_bf16 v[24:27], v[248:251], a[76:79], v[24:27]
ds_read_b64_tr_b16 v[174:175], v11 offset:59392
v_mfma_f32_16x16x32_bf16 v[40:43], v[248:251], a[92:95], v[40:43]
ds_read_b64_tr_b16 v[176:177], v8 offset:61440
v_mfma_f32_16x16x32_bf16 v[40:43], v[232:235], a[88:91], v[40:43]
ds_read_b64_tr_b16 v[178:179], v8 offset:63488
ds_read_b64_tr_b16 v[180:181], v9 offset:61440
v_mfma_f32_16x16x32_bf16 v[40:43], v[216:219], a[84:87], v[40:43]
ds_read_b64_tr_b16 v[182:183], v9 offset:63488
v_mfma_f32_16x16x32_bf16 v[40:43], v[200:203], a[80:83], v[40:43]
ds_read_b64_tr_b16 v[184:185], v10 offset:61440
v_mfma_f32_16x16x32_bf16 v[44:47], v[204:207], a[80:83], v[44:47]
ds_read_b64_tr_b16 v[186:187], v10 offset:63488
v_mfma_f32_16x16x32_bf16 v[44:47], v[220:223], a[84:87], v[44:47]
ds_read_b64_tr_b16 v[188:189], v11 offset:61440
v_mfma_f32_16x16x32_bf16 v[44:47], v[236:239], a[88:91], v[44:47]
ds_read_b64_tr_b16 v[190:191], v11 offset:63488
v_mfma_f32_16x16x32_bf16 v[44:47], v[252:255], a[92:95], v[44:47]
v_mfma_f32_16x16x32_bf16 v[28:31], v[252:255], a[76:79], v[28:31]
v_mfma_f32_16x16x32_bf16 v[28:31], v[236:239], a[72:75], v[28:31]
v_mfma_f32_16x16x32_bf16 v[28:31], v[220:223], a[68:71], v[28:31]
s_waitcnt vmcnt(0) lgkmcnt(0)
v_mfma_f32_16x16x32_bf16 v[28:31], v[204:207], a[64:67], v[28:31]
v_mfma_f32_16x16x32_bf16 v[16:19], v[128:131], a[96:99], v[16:19]
v_mfma_f32_16x16x32_bf16 v[16:19], v[144:147], a[100:103], v[16:19]
v_mfma_f32_16x16x32_bf16 v[16:19], v[160:163], a[104:107], v[16:19]
v_mfma_f32_16x16x32_bf16 v[16:19], v[176:179], a[108:111], v[16:19]
v_mfma_f32_16x16x32_bf16 v[32:35], v[176:179], a[124:127], v[32:35]
v_mfma_f32_16x16x32_bf16 v[32:35], v[160:163], a[120:123], v[32:35]
v_mfma_f32_16x16x32_bf16 v[32:35], v[144:147], a[116:119], v[32:35]
v_mfma_f32_16x16x32_bf16 v[32:35], v[128:131], a[112:115], v[32:35]
s_nop 3
v_fma_f32 v48, v16, v6, v48
v_fma_f32 v49, v17, v6, v49
v_mfma_f32_16x16x32_bf16 v[36:39], v[132:135], a[112:115], v[36:39]
v_fma_f32 v50, v18, v6, v50
v_fma_f32 v51, v19, v6, v51
v_mfma_f32_16x16x32_bf16 v[36:39], v[148:151], a[116:119], v[36:39]
v_cvt_pk_bf16_f32 v48, v48, v49
v_cvt_pk_bf16_f32 v49, v50, v51
v_mfma_f32_16x16x32_bf16 v[36:39], v[164:167], a[120:123], v[36:39]
ds_write_b64 v116, v[48:49] offset:0
v_mfma_f32_16x16x32_bf16 v[36:39], v[180:183], a[124:127], v[36:39]
v_fma_f32 v64, v32, v7, v64
v_fma_f32 v65, v33, v7, v65
v_mfma_f32_16x16x32_bf16 v[20:23], v[180:183], a[108:111], v[20:23]
v_fma_f32 v66, v34, v7, v66
v_fma_f32 v67, v35, v7, v67
v_mfma_f32_16x16x32_bf16 v[20:23], v[164:167], a[104:107], v[20:23]
v_cvt_pk_bf16_f32 v64, v64, v65
v_cvt_pk_bf16_f32 v65, v66, v67
v_mfma_f32_16x16x32_bf16 v[20:23], v[148:151], a[100:103], v[20:23]
ds_write_b64 v116, v[64:65] offset:2048
v_mfma_f32_16x16x32_bf16 v[20:23], v[132:135], a[96:99], v[20:23]
v_fma_f32 v68, v36, v7, v68
v_fma_f32 v69, v37, v7, v69
v_mfma_f32_16x16x32_bf16 v[24:27], v[136:139], a[96:99], v[24:27]
v_fma_f32 v70, v38, v7, v70
v_fma_f32 v71, v39, v7, v71
v_mfma_f32_16x16x32_bf16 v[24:27], v[152:155], a[100:103], v[24:27]
v_cvt_pk_bf16_f32 v68, v68, v69
v_cvt_pk_bf16_f32 v69, v70, v71
v_mfma_f32_16x16x32_bf16 v[24:27], v[168:171], a[104:107], v[24:27]
ds_write_b64 v117, v[68:69] offset:2048
v_mfma_f32_16x16x32_bf16 v[24:27], v[184:187], a[108:111], v[24:27]
v_fma_f32 v52, v20, v6, v52
v_fma_f32 v53, v21, v6, v53
v_mfma_f32_16x16x32_bf16 v[40:43], v[184:187], a[124:127], v[40:43]
v_fma_f32 v54, v22, v6, v54
v_fma_f32 v55, v23, v6, v55
v_mfma_f32_16x16x32_bf16 v[40:43], v[168:171], a[120:123], v[40:43]
v_cvt_pk_bf16_f32 v52, v52, v53
v_cvt_pk_bf16_f32 v53, v54, v55
v_mfma_f32_16x16x32_bf16 v[40:43], v[152:155], a[116:119], v[40:43]
ds_write_b64 v117, v[52:53] offset:0
v_mfma_f32_16x16x32_bf16 v[40:43], v[136:139], a[112:115], v[40:43]
v_fma_f32 v56, v24, v6, v56
v_fma_f32 v57, v25, v6, v57
v_mfma_f32_16x16x32_bf16 v[44:47], v[140:143], a[112:115], v[44:47]
v_fma_f32 v58, v26, v6, v58
v_fma_f32 v59, v27, v6, v59
v_mfma_f32_16x16x32_bf16 v[44:47], v[156:159], a[116:119], v[44:47]
v_cvt_pk_bf16_f32 v56, v56, v57
v_cvt_pk_bf16_f32 v57, v58, v59
v_mfma_f32_16x16x32_bf16 v[44:47], v[172:175], a[120:123], v[44:47]
ds_write_b64 v118, v[56:57] offset:0
v_mfma_f32_16x16x32_bf16 v[44:47], v[188:191], a[124:127], v[44:47]
v_fma_f32 v72, v40, v7, v72
v_fma_f32 v73, v41, v7, v73
v_mfma_f32_16x16x32_bf16 v[28:31], v[188:191], a[108:111], v[28:31]
v_fma_f32 v74, v42, v7, v74
v_fma_f32 v75, v43, v7, v75
v_mfma_f32_16x16x32_bf16 v[28:31], v[172:175], a[104:107], v[28:31]
v_cvt_pk_bf16_f32 v72, v72, v73
v_cvt_pk_bf16_f32 v73, v74, v75
v_mfma_f32_16x16x32_bf16 v[28:31], v[156:159], a[100:103], v[28:31]
ds_write_b64 v118, v[72:73] offset:2048
v_mfma_f32_16x16x32_bf16 v[28:31], v[140:143], a[96:99], v[28:31]
v_fma_f32 v76, v44, v7, v76
v_fma_f32 v77, v45, v7, v77
v_fma_f32 v78, v46, v7, v78
v_fma_f32 v79, v47, v7, v79
v_cvt_pk_bf16_f32 v76, v76, v77
v_cvt_pk_bf16_f32 v77, v78, v79
ds_write_b64 v119, v[76:77] offset:2048
s_nop 0
v_fma_f32 v60, v28, v6, v60
v_fma_f32 v61, v29, v6, v61
v_fma_f32 v62, v30, v6, v62
v_fma_f32 v63, v31, v6, v63
v_cvt_pk_bf16_f32 v60, v60, v61
v_cvt_pk_bf16_f32 v61, v62, v63
ds_write_b64 v119, v[60:61] offset:0
ds_read_b128 v[80:83], v120 offset:0
ds_read_b128 v[84:87], v120 offset:1024
ds_read_b128 v[96:99], v120 offset:2048
ds_read_b128 v[100:103], v120 offset:3072
s_waitcnt lgkmcnt(3)
buffer_store_dwordx4 v[80:83], v15, s[40:43], s70 offen sc1
s_add_u32 s70, s70, 0x4000
s_waitcnt lgkmcnt(2)
buffer_store_dwordx4 v[84:87], v15, s[40:43], s70 offen sc1
s_add_u32 s70, s70, 0x4000
s_waitcnt lgkmcnt(1)
buffer_store_dwordx4 v[96:99], v15, s[40:43], s70 offen sc1
s_add_u32 s70, s70, 0x4000
s_waitcnt lgkmcnt(0)
buffer_store_dwordx4 v[100:103], v15, s[40:43], s70 offen sc1
s_add_u32 s70, s70, 0x4000
Lend:
s_endpgm
Lspin1:
s_mov_b32 s83, 262144
Lsl3:
s_sleep 2
buffer_load_dword v3, v2, s[48:51], 0 offen sc1
s_sub_u32 s83, s83, 1
s_cmp_eq_u32 s83, 0
s_waitcnt vmcnt(0)
s_cbranch_scc1 Lback2
v_cmp_gt_u32 vcc, 8, v3
s_cbranch_vccnz Lsl3
s_branch Lback2
Lspin4:
s_mov_b32 s83, 262144
Lsl6:
s_sleep 2
buffer_load_dword v3, v2, s[44:47], s75 offen sc1
s_sub_u32 s83, s83, 1
s_cmp_eq_u32 s83, 0
s_waitcnt vmcnt(0)
s_cbranch_scc1 Lback5
v_cmp_gt_u32 vcc, 1, v3
s_cbranch_vccnz Lsl6
s_branch Lback5
LLT4x:
s_cmp_eq_u32 s85, 1
s_cbranch_scc1 Ltri40
s_cmp_gt_u32 s85, 1
s_cbranch_scc1 Lalt39
v_mfma_f32_16x16x32_bf16 v[168:171], a[160:163], v[48:51], v[112:115]
s_add_u32 m0, s66, 32
v_exp_f32 v136, v136
v_mfma_f32_16x16x32_bf16 v[172:175], a[160:163], v[64:67], v[112:115]
s_add_u32 s72, s93, 0x2
ds_read_b128 a[128:131], v2 offset:16384
v_mfma_f32_16x16x32_bf16 v[184:187], a[176:179], v[48:51], v[112:115]
v_exp_f32 v137, v137
v_mfma_f32_16x16x32_bf16 v[188:191], a[176:179], v[64:67], v[112:115]
ds_read_b128 a[132:135], v2 offset:17408
v_cvt_pk_bf16_f32 v200, v136, v137
s_branch Ljoin41
Lalt39:
v_mfma_f32_16x16x32_bf16 v[168:171], a[160:163], v[48:51], v[88:91]
s_add_u32 m0, s66, 32
v_exp_f32 v136, v136
v_mfma_f32_16x16x32_bf16 v[172:175], a[160:163], v[64:67], v[92:95]
s_add_u32 s72, s93, 0x2
ds_read_b128 a[128:131], v2 offset:16384
v_mfma_f32_16x16x32_bf16 v[184:187], a[176:179], v[48:51], v[88:91]
v_exp_f32 v137, v137
v_mfma_f32_16x16x32_bf16 v[188:191], a[176:179], v[64:67], v[92:95]
ds_read_b128 a[132:135], v2 offset:17408
v_cvt_pk_bf16_f32 v200, v136, v137
s_branch Ljoin41
Ltri40:
v_mfma_f32_16x16x32_bf16 v[168:171], a[160:163], v[48:51], v[104:107]
s_add_u32 m0, s66, 32
v_exp_f32 v136, v136
v_mfma_f32_16x16x32_bf16 v[172:175], a[160:163], v[64:67], v[92:95]
s_add_u32 s72, s93, 0x2
ds_read_b128 a[128:131], v2 offset:16384
v_mfma_f32_16x16x32_bf16 v[184:187], a[176:179], v[48:51], v[112:115]
v_exp_f32 v137, v137
v_mfma_f32_16x16x32_bf16 v[188:191], a[176:179], v[64:67], v[108:111]
ds_read_b128 a[132:135], v2 offset:17408
v_cvt_pk_bf16_f32 v200, v136, v137
Ljoin41:
v_mfma_f32_16x16x32_bf16 v[168:171], a[164:167], v[52:55], v[168:171]
buffer_load_dwordx4 v1, s[36:39], s72 offen lds
v_mfma_f32_16x16x32_bf16 v[168:171], a[168:171], v[56:59], v[168:171]
v_exp_f32 v138, v138
v_mfma_f32_16x16x32_bf16 v[168:171], a[172:175], v[60:63], v[168:171]
ds_read_b128 a[136:139], v2 offset:18432
v_lshrrev_b32 v15, 4, v0
v_mfma_f32_16x16x32_bf16 v[172:175], a[172:175], v[76:79], v[172:175]
buffer_load_dwordx4 v1, s[36:39], s72 offen offset:1024 lds
v_mfma_f32_16x16x32_bf16 v[172:175], a[168:171], v[72:75], v[172:175]
v_exp_f32 v139, v139
v_mfma_f32_16x16x32_bf16 v[172:175], a[164:167], v[68:71], v[172:175]
ds_read_b128 a[140:143], v2 offset:19456
v_cvt_pk_bf16_f32 v201, v138, v139
v_mfma_f32_16x16x32_bf16 v[188:191], a[180:183], v[68:71], v[188:191]
v_exp_f32 v152, v152
v_mfma_f32_16x16x32_bf16 v[188:191], a[184:187], v[72:75], v[188:191]
ds_read_b128 a[144:147], v2 offset:20480
v_lshlrev_b32 v15, 1, v15
v_mfma_f32_16x16x32_bf16 v[188:191], a[188:191], v[76:79], v[188:191]
buffer_load_dwordx4 v1, s[36:39], s72 offen offset:2048 lds
v_mfma_f32_16x16x32_bf16 v[184:187], a[188:191], v[60:63], v[184:187]
v_exp_f32 v153, v153
v_mfma_f32_16x16x32_bf16 v[184:187], a[184:187], v[56:59], v[184:187]
ds_read_b128 a[148:151], v2 offset:21504
v_cvt_pk_bf16_f32 v202, v152, v153
v_mfma_f32_16x16x32_bf16 v[184:187], a[180:183], v[52:55], v[184:187]
s_waitcnt lgkmcnt(6)
v_exp_f32 v154, v154
v_mfma_f32_16x16x32_bf16 a[0:3], a[224:227], v[208:211], a[0:3]
ds_read_b128 a[152:155], v2 offset:22528
v_and_b32 v240, 7, v0
v_mfma_f32_16x16x32_bf16 a[32:35], a[224:227], v[212:215], a[32:35]
buffer_load_dwordx4 v1, s[36:39], s72 offen offset:3072 lds
v_mfma_f32_16x16x32_bf16 a[64:67], a[224:227], v[216:219], a[64:67]
s_add_u32 m0, s92, 8352
v_exp_f32 v155, v155
v_mfma_f32_16x16x32_bf16 a[96:99], a[224:227], v[220:223], a[96:99]
s_add_u32 s72, s93, 0x6
ds_read_b128 a[156:159], v2 offset:23552
v_cvt_pk_bf16_f32 v203, v154, v155
v_mfma_f32_16x16x32_bf16 a[100:103], a[228:231], v[220:223], a[100:103]
v_exp_f32 v140, v140
v_mfma_f32_16x16x32_bf16 a[68:71], a[228:231], v[216:219], a[68:71]
ds_read_b128 a[192:195], v2 offset:0
v_xor_b32 v15, v15, v240
v_mfma_f32_16x16x32_bf16 a[36:39], a[228:231], v[212:215], a[36:39]
buffer_load_dwordx4 v1, s[36:39], s72 offen lds
v_mfma_f32_16x16x32_bf16 a[4:7], a[228:231], v[208:211], a[4:7]
v_exp_f32 v141, v141
v_mfma_f32_16x16x32_bf16 a[8:11], a[232:235], v[208:211], a[8:11]
ds_read_b128 a[196:199], v2 offset:1024
v_cvt_pk_bf16_f32 v204, v140, v141
v_mfma_f32_16x16x32_bf16 a[40:43], a[232:235], v[212:215], a[40:43]
buffer_load_dwordx4 v1, s[36:39], s72 offen offset:1024 lds
v_mfma_f32_16x16x32_bf16 a[72:75], a[232:235], v[216:219], a[72:75]
v_exp_f32 v142, v142
v_mfma_f32_16x16x32_bf16 a[104:107], a[232:235], v[220:223], a[104:107]
ds_read_b128 a[200:203], v2 offset:2048
v_lshlrev_b32 v15, 4, v15
v_mfma_f32_16x16x32_bf16 a[108:111], a[236:239], v[220:223], a[108:111]
v_exp_f32 v143, v143
v_mfma_f32_16x16x32_bf16 a[76:79], a[236:239], v[216:219], a[76:79]
ds_read_b128 a[204:207], v2 offset:3072
v_cvt_pk_bf16_f32 v205, v142, v143
v_mfma_f32_16x16x32_bf16 a[44:47], a[236:239], v[212:215], a[44:47]
buffer_load_dwordx4 v1, s[36:39], s72 offen offset:2048 lds
v_mfma_f32_16x16x32_bf16 a[12:15], a[236:239], v[208:211], a[12:15]
v_exp_f32 v156, v156
v_mfma_f32_16x16x32_bf16 a[16:19], a[240:243], v[208:211], a[16:19]
ds_read_b128 a[208:211], v2 offset:4096
v_lshrrev_b32 v240, 3, v0
v_mfma_f32_16x16x32_bf16 a[48:51], a[240:243], v[212:215], a[48:51]
v_exp_f32 v157, v157
v_mfma_f32_16x16x32_bf16 a[80:83], a[240:243], v[216:219], a[80:83]
ds_read_b128 a[212:215], v2 offset:5120
v_cvt_pk_bf16_f32 v206, v156, v157
v_mfma_f32_16x16x32_bf16 a[112:115], a[240:243], v[220:223], a[112:115]
buffer_load_dwordx4 v1, s[36:39], s72 offen offset:3072 lds
v_mfma_f32_16x16x32_bf16 a[116:119], a[244:247], v[220:223], a[116:119]
s_add_u32 m0, s62, 0
v_exp_f32 v158, v158
v_mfma_f32_16x16x32_bf16 a[84:87], a[244:247], v[216:219], a[84:87]
s_add_u32 s72, s93, 0x3000000
ds_read_b128 a[216:219], v2 offset:6144
v_lshl_add_u32 v15, v240, 11, v15
v_mfma_f32_16x16x32_bf16 a[52:55], a[244:247], v[212:215], a[52:55]
s_lshr_b32 s75, s59, 3
v_exp_f32 v159, v159
v_mfma_f32_16x16x32_bf16 a[20:23], a[244:247], v[208:211], a[20:23]
s_lshl_b32 s75, s75, 2
ds_read_b128 a[220:223], v2 offset:7168
v_cvt_pk_bf16_f32 v207, v158, v159
v_mfma_f32_16x16x32_bf16 a[24:27], a[248:251], v[208:211], a[24:27]
s_add_u32 s75, s75, s65
buffer_load_dwordx4 v1, s[44:47], s72 offen sc1 lds
v_mfma_f32_16x16x32_bf16 a[56:59], a[248:251], v[212:215], a[56:59]
s_lshl_b32 s76, s59, 1
v_mfma_f32_16x16x32_bf16 a[88:91], a[248:251], v[216:219], a[88:91]
s_and_b32 s76, s76, 8
v_mfma_f32_16x16x32_bf16 a[120:123], a[248:251], v[220:223], a[120:123]
s_add_u32 s76, s76, s60
v_mfma_f32_16x16x32_bf16 a[124:127], a[252:255], v[220:223], a[124:127]
s_lshl_b32 s94, s58, 16
v_mfma_f32_16x16x32_bf16 a[92:95], a[252:255], v[216:219], a[92:95]
s_lshl_b32 s80, s76, 7
v_mfma_f32_16x16x32_bf16 a[60:63], a[252:255], v[212:215], a[60:63]
s_add_u32 s94, s94, s80
v_mfma_f32_16x16x32_bf16 a[28:31], a[252:255], v[208:211], a[28:31]
s_lshl_b32 s80, s75, 18
v_mfma_f32_16x16x32_bf16 v[224:227], v[120:123], v[208:211], v[224:227]
s_add_u32 s80, s80, s94
v_mfma_f32_16x16x32_bf16 v[228:231], v[120:123], v[212:215], v[228:231]
v_mfma_f32_16x16x32_bf16 v[232:235], v[120:123], v[216:219], v[232:235]
v_mfma_f32_16x16x32_bf16 v[236:239], v[120:123], v[220:223], v[236:239]
s_waitcnt lgkmcnt(8)
buffer_load_dwordx4 v[80:83], v15, s[4:7], s80 offen
s_add_u32 s80, s80, 0x4000
buffer_load_dwordx4 v[84:87], v15, s[4:7], s80 offen
s_add_u32 s80, s80, 0x4000
buffer_load_dwordx4 v[96:99], v15, s[4:7], s80 offen
s_add_u32 s80, s80, 0x4000
buffer_load_dwordx4 v[100:103], v15, s[4:7], s80 offen
v_rcp_f32 v224, v224
v_rcp_f32 v228, v228
s_lshl_b32 s73, s59, 12
s_add_u32 s73, s73, 0x2000000
s_lshl_b32 s70, s67, 2
s_add_u32 s70, s70, s73
v_mov_b32 v225, v224
v_accvgpr_read_b32 v240, a0
v_accvgpr_read_b32 v241, a1
v_accvgpr_read_b32 v242, a2
v_accvgpr_read_b32 v243, a3
v_accvgpr_read_b32 v244, a4
v_accvgpr_read_b32 v245, a5
v_accvgpr_read_b32 v246, a6
v_accvgpr_read_b32 v247, a7
v_pk_mul_f32 v[240:241], v[240:241], v[224:225]
v_pk_mul_f32 v[242:243], v[242:243], v[224:225]
v_pk_mul_f32 v[244:245], v[244:245], v[224:225]
v_pk_mul_f32 v[246:247], v[246:247], v[224:225]
v_cvt_pk_bf16_f32 v240, v240, v241
v_cvt_pk_bf16_f32 v241, v242, v243
v_cvt_pk_bf16_f32 v242, v244, v245
v_cvt_pk_bf16_f32 v243, v246, v247
buffer_store_dwordx4 v[240:243], v1, s[44:47], s70 offen sc1
v_accvgpr_read_b32 v248, a8
v_accvgpr_read_b32 v249, a9
v_accvgpr_read_b32 v250, a10
v_accvgpr_read_b32 v251, a11
v_accvgpr_read_b32 v252, a12
v_accvgpr_read_b32 v253, a13
v_accvgpr_read_b32 v254, a14
v_accvgpr_read_b32 v255, a15
v_pk_mul_f32 v[248:249], v[248:249], v[224:225]
v_pk_mul_f32 v[250:251], v[250:251], v[224:225]
v_pk_mul_f32 v[252:253], v[252:253], v[224:225]
v_pk_mul_f32 v[254:255], v[254:255], v[224:225]
v_cvt_pk_bf16_f32 v248, v248, v249
v_cvt_pk_bf16_f32 v249, v250, v251
v_cvt_pk_bf16_f32 v250, v252, v253
v_cvt_pk_bf16_f32 v251, v254, v255
buffer_store_dwordx4 v[248:251], v1, s[44:47], s70 offen offset:1024 sc1
v_accvgpr_read_b32 v240, a16
v_accvgpr_read_b32 v241, a17
v_accvgpr_read_b32 v242, a18
v_accvgpr_read_b32 v243, a19
v_accvgpr_read_b32 v244, a20
v_accvgpr_read_b32 v245, a21
v_accvgpr_read_b32 v246, a22
v_accvgpr_read_b32 v247, a23
v_pk_mul_f32 v[240:241], v[240:241], v[224:225]
v_pk_mul_f32 v[242:243], v[242:243], v[224:225]
v_pk_mul_f32 v[244:245], v[244:245], v[224:225]
v_pk_mul_f32 v[246:247], v[246:247], v[224:225]
v_cvt_pk_bf16_f32 v240, v240, v241
v_cvt_pk_bf16_f32 v241, v242, v243
v_cvt_pk_bf16_f32 v242, v244, v245
v_cvt_pk_bf16_f32 v243, v246, v247
buffer_store_dwordx4 v[240:243], v1, s[44:47], s70 offen offset:2048 sc1
v_accvgpr_read_b32 v248, a24
v_accvgpr_read_b32 v249, a25
v_accvgpr_read_b32 v250, a26
v_accvgpr_read_b32 v251, a27
v_accvgpr_read_b32 v252, a28
v_accvgpr_read_b32 v253, a29
v_accvgpr_read_b32 v254, a30
v_accvgpr_read_b32 v255, a31
v_pk_mul_f32 v[248:249], v[248:249], v[224:225]
v_pk_mul_f32 v[250:251], v[250:251], v[224:225]
v_pk_mul_f32 v[252:253], v[252:253], v[224:225]
v_pk_mul_f32 v[254:255], v[254:255], v[224:225]
v_cvt_pk_bf16_f32 v248, v248, v249
v_cvt_pk_bf16_f32 v249, v250, v251
v_cvt_pk_bf16_f32 v250, v252, v253
v_cvt_pk_bf16_f32 v251, v254, v255
buffer_store_dwordx4 v[248:251], v1, s[44:47], s70 offen offset:3072 sc1
s_add_u32 s70, s70, 0x20000
v_mov_b32 v229, v228
v_accvgpr_read_b32 v240, a32
v_accvgpr_read_b32 v241, a33
v_accvgpr_read_b32 v242, a34
v_accvgpr_read_b32 v243, a35
v_accvgpr_read_b32 v244, a36
v_accvgpr_read_b32 v245, a37
v_accvgpr_read_b32 v246, a38
v_accvgpr_read_b32 v247, a39
v_pk_mul_f32 v[240:241], v[240:241], v[228:229]
v_pk_mul_f32 v[242:243], v[242:243], v[228:229]
v_pk_mul_f32 v[244:245], v[244:245], v[228:229]
v_pk_mul_f32 v[246:247], v[246:247], v[228:229]
v_cvt_pk_bf16_f32 v240, v240, v241
v_cvt_pk_bf16_f32 v241, v242, v243
v_cvt_pk_bf16_f32 v242, v244, v245
v_cvt_pk_bf16_f32 v243, v246, v247
buffer_store_dwordx4 v[240:243], v1, s[44:47], s70 offen sc1
v_accvgpr_read_b32 v248, a40
v_accvgpr_read_b32 v249, a41
v_accvgpr_read_b32 v250, a42
v_accvgpr_read_b32 v251, a43
v_accvgpr_read_b32 v252, a44
v_accvgpr_read_b32 v253, a45
v_accvgpr_read_b32 v254, a46
v_accvgpr_read_b32 v255, a47
v_pk_mul_f32 v[248:249], v[248:249], v[228:229]
v_pk_mul_f32 v[250:251], v[250:251], v[228:229]
v_pk_mul_f32 v[252:253], v[252:253], v[228:229]
v_pk_mul_f32 v[254:255], v[254:255], v[228:229]
v_cvt_pk_bf16_f32 v248, v248, v249
v_cvt_pk_bf16_f32 v249, v250, v251
v_cvt_pk_bf16_f32 v250, v252, v253
v_cvt_pk_bf16_f32 v251, v254, v255
buffer_store_dwordx4 v[248:251], v1, s[44:47], s70 offen offset:1024 sc1
v_accvgpr_read_b32 v240, a48
v_accvgpr_read_b32 v241, a49
v_accvgpr_read_b32 v242, a50
v_accvgpr_read_b32 v243, a51
v_accvgpr_read_b32 v244, a52
v_accvgpr_read_b32 v245, a53
v_accvgpr_read_b32 v246, a54
v_accvgpr_read_b32 v247, a55
v_pk_mul_f32 v[240:241], v[240:241], v[228:229]
v_pk_mul_f32 v[242:243], v[242:243], v[228:229]
v_pk_mul_f32 v[244:245], v[244:245], v[228:229]
v_pk_mul_f32 v[246:247], v[246:247], v[228:229]
v_cvt_pk_bf16_f32 v240, v240, v241
v_cvt_pk_bf16_f32 v241, v242, v243
v_cvt_pk_bf16_f32 v242, v244, v245
v_cvt_pk_bf16_f32 v243, v246, v247
buffer_store_dwordx4 v[240:243], v1, s[44:47], s70 offen offset:2048 sc1
v_accvgpr_read_b32 v248, a56
v_accvgpr_read_b32 v249, a57
v_accvgpr_read_b32 v250, a58
v_accvgpr_read_b32 v251, a59
v_accvgpr_read_b32 v252, a60
v_accvgpr_read_b32 v253, a61
v_accvgpr_read_b32 v254, a62
v_accvgpr_read_b32 v255, a63
v_pk_mul_f32 v[248:249], v[248:249], v[228:229]
v_pk_mul_f32 v[250:251], v[250:251], v[228:229]
v_pk_mul_f32 v[252:253], v[252:253], v[228:229]
v_pk_mul_f32 v[254:255], v[254:255], v[228:229]
v_cvt_pk_bf16_f32 v248, v248, v249
v_cvt_pk_bf16_f32 v249, v250, v251
v_cvt_pk_bf16_f32 v250, v252, v253
v_cvt_pk_bf16_f32 v251, v254, v255
buffer_store_dwordx4 v[248:251], v1, s[44:47], s70 offen offset:3072 sc1
s_cmp_eq_u32 s85, 2
s_cbranch_scc1 Ltri43
s_cmp_gt_u32 s85, 2
s_cbranch_scc1 Lalt42
v_mfma_f32_16x16x32_bf16 v[136:139], a[128:131], v[48:51], v[112:115]
s_add_u32 s82, s82, 0x8000
ds_read_b128 a[160:163], v2 offset:24576
ds_read_b128 a[164:167], v2 offset:25600
v_mfma_f32_16x16x32_bf16 v[140:143], a[128:131], v[64:67], v[112:115]
s_and_b32 s82, s82, 0x1ffff
v_exp_f32 v168, v168
v_mfma_f32_16x16x32_bf16 v[152:155], a[144:147], v[48:51], v[112:115]
v_exp_f32 v169, v169
v_mfma_f32_16x16x32_bf16 v[156:159], a[144:147], v[64:67], v[112:115]
buffer_load_dwordx4 v1, s[44:47], s72 offen offset:1024 sc1 lds
s_branch Ljoin44
Lalt42:
v_mfma_f32_16x16x32_bf16 v[136:139], a[128:131], v[48:51], v[88:91]
s_add_u32 s82, s82, 0x8000
ds_read_b128 a[160:163], v2 offset:24576
ds_read_b128 a[164:167], v2 offset:25600
v_mfma_f32_16x16x32_bf16 v[140:143], a[128:131], v[64:67], v[92:95]
s_and_b32 s82, s82, 0x1ffff
v_exp_f32 v168, v168
v_mfma_f32_16x16x32_bf16 v[152:155], a[144:147], v[48:51], v[88:91]
v_exp_f32 v169, v169
v_mfma_f32_16x16x32_bf16 v[156:159], a[144:147], v[64:67], v[92:95]
buffer_load_dwordx4 v1, s[44:47], s72 offen offset:1024 sc1 lds
s_branch Ljoin44
Ltri43:
v_mfma_f32_16x16x32_bf16 v[136:139], a[128:131], v[48:51], v[104:107]
s_add_u32 s82, s82, 0x8000
ds_read_b128 a[160:163], v2 offset:24576
ds_read_b128 a[164:167], v2 offset:25600
v_mfma_f32_16x16x32_bf16 v[140:143], a[128:131], v[64:67], v[92:95]
s_and_b32 s82, s82, 0x1ffff
v_exp_f32 v168, v168
v_mfma_f32_16x16x32_bf16 v[152:155], a[144:147], v[48:51], v[112:115]
v_exp_f32 v169, v169
v_mfma_f32_16x16x32_bf16 v[156:159], a[144:147], v[64:67], v[108:111]
buffer_load_dwordx4 v1, s[44:47], s72 offen offset:1024 sc1 lds
Ljoin44:
v_mfma_f32_16x16x32_bf16 v[136:139], a[132:135], v[52:55], v[136:139]
ds_read_b128 a[168:171], v2 offset:26624
v_cvt_pk_bf16_f32 v216, v168, v169
v_mfma_f32_16x16x32_bf16 v[136:139], a[136:139], v[56:59], v[136:139]
v_exp_f32 v170, v170
v_mfma_f32_16x16x32_bf16 v[136:139], a[140:143], v[60:63], v[136:139]
ds_read_b128 a[172:175], v2 offset:27648
ds_read_b128 a[176:179], v2 offset:28672
v_mfma_f32_16x16x32_bf16 v[140:143], a[140:143], v[76:79], v[140:143]
v_exp_f32 v171, v171
v_mfma_f32_16x16x32_bf16 v[140:143], a[136:139], v[72:75], v[140:143]
v_exp_f32 v184, v184
v_mfma_f32_16x16x32_bf16 v[140:143], a[132:135], v[68:71], v[140:143]
ds_read_b128 a[180:183], v2 offset:29696
v_cvt_pk_bf16_f32 v217, v170, v171
v_mfma_f32_16x16x32_bf16 v[156:159], a[148:151], v[68:71], v[156:159]
buffer_load_dwordx4 v1, s[44:47], s72 offen offset:2048 sc1 lds
v_mfma_f32_16x16x32_bf16 v[156:159], a[152:155], v[72:75], v[156:159]
v_exp_f32 v185, v185
v_mfma_f32_16x16x32_bf16 v[156:159], a[156:159], v[76:79], v[156:159]
ds_read_b128 a[184:187], v2 offset:30720
v_cvt_pk_bf16_f32 v218, v184, v185
v_mfma_f32_16x16x32_bf16 v[152:155], a[156:159], v[60:63], v[152:155]
v_exp_f32 v186, v186
v_mfma_f32_16x16x32_bf16 v[152:155], a[152:155], v[56:59], v[152:155]
ds_read_b128 a[188:191], v2 offset:31744
ds_read_b128 a[224:227], v2 offset:8192
v_mfma_f32_16x16x32_bf16 v[152:155], a[148:151], v[52:55], v[152:155]
s_waitcnt lgkmcnt(9)
v_exp_f32 v187, v187
v_mfma_f32_16x16x32_bf16 a[64:67], a[192:195], v[200:203], a[64:67]
v_exp_f32 v172, v172
v_mfma_f32_16x16x32_bf16 a[96:99], a[192:195], v[204:207], a[96:99]
buffer_load_dwordx4 v1, s[44:47], s72 offen offset:3072 sc1 lds
v_mfma_f32_16x16x32_bf16 a[100:103], a[196:199], v[204:207], a[100:103]
s_add_u32 m0, s92, 32
ds_read_b128 a[228:231], v2 offset:9216
v_cvt_pk_bf16_f32 v219, v186, v187
v_mfma_f32_16x16x32_bf16 a[68:71], a[196:199], v[200:203], a[68:71]
s_add_u32 s72, s93, 0x0
v_exp_f32 v173, v173
v_mfma_f32_16x16x32_bf16 a[72:75], a[200:203], v[200:203], a[72:75]
ds_read_b128 a[232:235], v2 offset:10240
v_cvt_pk_bf16_f32 v220, v172, v173
v_mfma_f32_16x16x32_bf16 a[104:107], a[200:203], v[204:207], a[104:107]
v_exp_f32 v174, v174
v_mfma_f32_16x16x32_bf16 a[108:111], a[204:207], v[204:207], a[108:111]
ds_read_b128 a[236:239], v2 offset:11264
ds_read_b128 a[240:243], v2 offset:12288
v_mfma_f32_16x16x32_bf16 a[76:79], a[204:207], v[200:203], a[76:79]
v_exp_f32 v175, v175
v_mfma_f32_16x16x32_bf16 a[80:83], a[208:211], v[200:203], a[80:83]
buffer_load_dwordx4 v1, s[36:39], s72 offen lds
v_mfma_f32_16x16x32_bf16 a[112:115], a[208:211], v[204:207], a[112:115]
v_exp_f32 v188, v188
v_mfma_f32_16x16x32_bf16 a[116:119], a[212:215], v[204:207], a[116:119]
ds_read_b128 a[244:247], v2 offset:13312
v_cvt_pk_bf16_f32 v221, v174, v175
v_mfma_f32_16x16x32_bf16 a[84:87], a[212:215], v[200:203], a[84:87]
v_exp_f32 v189, v189
v_mfma_f32_16x16x32_bf16 a[88:91], a[216:219], v[200:203], a[88:91]
ds_read_b128 a[248:251], v2 offset:14336
v_cvt_pk_bf16_f32 v222, v188, v189
v_mfma_f32_16x16x32_bf16 a[120:123], a[216:219], v[204:207], a[120:123]
v_exp_f32 v190, v190
v_mfma_f32_16x16x32_bf16 a[124:127], a[220:223], v[204:207], a[124:127]
buffer_load_dwordx4 v1, s[36:39], s72 offen offset:1024 lds
v_mfma_f32_16x16x32_bf16 a[92:95], a[220:223], v[200:203], a[92:95]
ds_read_b128 a[252:255], v2 offset:15360
v_add_u32 v2, s82, v1
v_mfma_f32_16x16x32_bf16 v[232:235], v[120:123], v[200:203], v[232:235]
s_waitcnt vmcnt(26) lgkmcnt(8)
v_exp_f32 v191, v191
v_mfma_f32_16x16x32_bf16 v[236:239], v[120:123], v[204:207], v[236:239]
s_barrier
v_cvt_pk_bf16_f32 v223, v190, v191
s_branch LHT3
Lslow:
s_waitcnt vmcnt(0) lgkmcnt(0)
s_barrier
s_mov_b32 s86, 1
s_lshl_b32 s81, s59, 20
s_add_u32 s81, s81, s64
s_sub_u32 s81, s81, 0x4000
s_mov_b32 s83, 0
s_lshl_b32 s75, s60, 2
s_sub_u32 s76, 64, s75
s_sub_u32 s75, s76, 4
s_add_u32 s75, s75, s58
v_mov_b32 v2, v1
v_lshrrev_b32 v240, 4, v0
v_and_b32 v241, 15, v0
v_lshlrev_b32 v240, 2, v240
v_sub_u32 v240, v241, v240
v_mov_b32 v112, 0xff800000
v_mov_b32 v113, 0xff800000
v_mov_b32 v114, 0xff800000
v_mov_b32 v115, 0xff800000
v_cmp_gt_i32 vcc, 0, v240
v_mov_b32 v120, 0x3f803f80
s_nop 0
v_cndmask_b32 v116, 0, v112, vcc
v_cmp_gt_i32 vcc, 1, v240
v_mov_b32 v121, 0x3f803f80
s_nop 0
v_cndmask_b32 v117, 0, v112, vcc
v_cmp_gt_i32 vcc, 2, v240
v_mov_b32 v122, 0x3f803f80
s_nop 0
v_cndmask_b32 v118, 0, v112, vcc
v_cmp_gt_i32 vcc, 3, v240
v_mov_b32 v123, 0x3f803f80
s_nop 0
v_cndmask_b32 v119, 0, v112, vcc
Lslow1:
s_add_u32 m0, s64, 16384
s_add_u32 s72, s81, 16384
buffer_load_dwordx4 v1, s[44:47], s72 offen sc1 lds
buffer_load_dwordx4 v1, s[44:47], s72 offen offset:1024 sc1 lds
buffer_load_dwordx4 v1, s[44:47], s72 offen offset:2048 sc1 lds
buffer_load_dwordx4 v1, s[44:47], s72 offen offset:3072 sc1 lds
s_add_u32 s81, s81, 0x8000
s_waitcnt vmcnt(0)
s_barrier
ds_read_b128 a[128:131], v2 offset:16384
ds_read_b128 a[132:135], v2 offset:17408
ds_read_b128 a[136:139], v2 offset:18432
ds_read_b128 a[140:143], v2 offset:19456
ds_read_b128 a[144:147], v2 offset:20480
ds_read_b128 a[148:151], v2 offset:21504
ds_read_b128 a[152:155], v2 offset:22528
ds_read_b128 a[156:159], v2 offset:23552
s_waitcnt lgkmcnt(0)
s_cmp_lt_u32 s84, s83
s_cbranch_scc1 Lsa48
s_cmp_eq_u32 s84, s83
s_cbranch_scc1 Lst49
v_mfma_f32_16x16x32_bf16 v[128:131], a[128:131], v[16:19], 0
v_mfma_f32_16x16x32_bf16 v[132:135], a[128:131], v[32:35], 0
v_mfma_f32_16x16x32_bf16 v[144:147], a[144:147], v[16:19], 0
v_mfma_f32_16x16x32_bf16 v[148:151], a[144:147], v[32:35], 0
s_branch Lsj50
Lst49:
v_mfma_f32_16x16x32_bf16 v[128:131], a[128:131], v[16:19], v[116:119]
v_mfma_f32_16x16x32_bf16 v[132:135], a[128:131], v[32:35], 0
v_mfma_f32_16x16x32_bf16 v[144:147], a[144:147], v[16:19], v[112:115]
v_mfma_f32_16x16x32_bf16 v[148:151], a[144:147], v[32:35], v[116:119]
Lsj50:
v_mfma_f32_16x16x32_bf16 v[128:131], a[132:135], v[20:23], v[128:131]
v_mfma_f32_16x16x32_bf16 v[128:131], a[136:139], v[24:27], v[128:131]
v_mfma_f32_16x16x32_bf16 v[128:131], a[140:143], v[28:31], v[128:131]
v_mfma_f32_16x16x32_bf16 v[132:135], a[140:143], v[44:47], v[132:135]
v_mfma_f32_16x16x32_bf16 v[132:135], a[136:139], v[40:43], v[132:135]
v_mfma_f32_16x16x32_bf16 v[132:135], a[132:135], v[36:39], v[132:135]
v_mfma_f32_16x16x32_bf16 v[148:151], a[148:151], v[36:39], v[148:151]
v_mfma_f32_16x16x32_bf16 v[148:151], a[152:155], v[40:43], v[148:151]
v_mfma_f32_16x16x32_bf16 v[148:151], a[156:159], v[44:47], v[148:151]
v_mfma_f32_16x16x32_bf16 v[144:147], a[156:159], v[28:31], v[144:147]
v_mfma_f32_16x16x32_bf16 v[144:147], a[152:155], v[24:27], v[144:147]
v_mfma_f32_16x16x32_bf16 v[144:147], a[148:151], v[20:23], v[144:147]
s_nop 7
v_max3_f32 v124, v124, v128, v129
v_max3_f32 v124, v124, v130, v131
v_max3_f32 v124, v124, v144, v145
v_max3_f32 v124, v124, v146, v147
v_max3_f32 v125, v125, v132, v133
v_max3_f32 v125, v125, v134, v135
v_max3_f32 v125, v125, v148, v149
v_max3_f32 v125, v125, v150, v151
Lsa48:
s_cmp_lt_u32 s75, s83
s_cbranch_scc1 Lsa51
s_cmp_eq_u32 s75, s83
s_cbranch_scc1 Lst52
v_mfma_f32_16x16x32_bf16 v[136:139], a[128:131], v[48:51], 0
v_mfma_f32_16x16x32_bf16 v[140:143], a[128:131], v[64:67], 0
v_mfma_f32_16x16x32_bf16 v[152:155], a[144:147], v[48:51], 0
v_mfma_f32_16x16x32_bf16 v[156:159], a[144:147], v[64:67], 0
s_branch Lsj53
Lst52:
v_mfma_f32_16x16x32_bf16 v[136:139], a[128:131], v[48:51], v[116:119]
v_mfma_f32_16x16x32_bf16 v[140:143], a[128:131], v[64:67], 0
v_mfma_f32_16x16x32_bf16 v[152:155], a[144:147], v[48:51], v[112:115]
v_mfma_f32_16x16x32_bf16 v[156:159], a[144:147], v[64:67], v[116:119]
Lsj53:
v_mfma_f32_16x16x32_bf16 v[136:139], a[132:135], v[52:55], v[136:139]
v_mfma_f32_16x16x32_bf16 v[136:139], a[136:139], v[56:59], v[136:139]
v_mfma_f32_16x16x32_bf16 v[136:139], a[140:143], v[60:63], v[136:139]
v_mfma_f32_16x16x32_bf16 v[140:143], a[140:143], v[76:79], v[140:143]
v_mfma_f32_16x16x32_bf16 v[140:143], a[136:139], v[72:75], v[140:143]
v_mfma_f32_16x16x32_bf16 v[140:143], a[132:135], v[68:71], v[140:143]
v_mfma_f32_16x16x32_bf16 v[156:159], a[148:151], v[68:71], v[156:159]
v_mfma_f32_16x16x32_bf16 v[156:159], a[152:155], v[72:75], v[156:159]
v_mfma_f32_16x16x32_bf16 v[156:159], a[156:159], v[76:79], v[156:159]
v_mfma_f32_16x16x32_bf16 v[152:155], a[156:159], v[60:63], v[152:155]
v_mfma_f32_16x16x32_bf16 v[152:155], a[152:155], v[56:59], v[152:155]
v_mfma_f32_16x16x32_bf16 v[152:155], a[148:151], v[52:55], v[152:155]
s_nop 7
v_max3_f32 v126, v126, v136, v137
v_max3_f32 v126, v126, v138, v139
v_max3_f32 v126, v126, v152, v153
v_max3_f32 v126, v126, v154, v155
v_max3_f32 v127, v127, v140, v141
v_max3_f32 v127, v127, v142, v143
v_max3_f32 v127, v127, v156, v157
v_max3_f32 v127, v127, v158, v159
Lsa51:
s_add_u32 s83, s83, 1
ds_read_b128 a[128:131], v2 offset:24576
ds_read_b128 a[132:135], v2 offset:25600
ds_read_b128 a[136:139], v2 offset:26624
ds_read_b128 a[140:143], v2 offset:27648
ds_read_b128 a[144:147], v2 offset:28672
ds_read_b128 a[148:151], v2 offset:29696
ds_read_b128 a[152:155], v2 offset:30720
ds_read_b128 a[156:159], v2 offset:31744
s_waitcnt lgkmcnt(0)
s_cmp_lt_u32 s84, s83
s_cbranch_scc1 Lsa54
s_cmp_eq_u32 s84, s83
s_cbranch_scc1 Lst55
v_mfma_f32_16x16x32_bf16 v[128:131], a[128:131], v[16:19], 0
v_mfma_f32_16x16x32_bf16 v[132:135], a[128:131], v[32:35], 0
v_mfma_f32_16x16x32_bf16 v[144:147], a[144:147], v[16:19], 0
v_mfma_f32_16x16x32_bf16 v[148:151], a[144:147], v[32:35], 0
s_branch Lsj56
Lst55:
v_mfma_f32_16x16x32_bf16 v[128:131], a[128:131], v[16:19], v[116:119]
v_mfma_f32_16x16x32_bf16 v[132:135], a[128:131], v[32:35], 0
v_mfma_f32_16x16x32_bf16 v[144:147], a[144:147], v[16:19], v[112:115]
v_mfma_f32_16x16x32_bf16 v[148:151], a[144:147], v[32:35], v[116:119]
Lsj56:
v_mfma_f32_16x16x32_bf16 v[128:131], a[132:135], v[20:23], v[128:131]
v_mfma_f32_16x16x32_bf16 v[128:131], a[136:139], v[24:27], v[128:131]
v_mfma_f32_16x16x32_bf16 v[128:131], a[140:143], v[28:31], v[128:131]
v_mfma_f32_16x16x32_bf16 v[132:135], a[140:143], v[44:47], v[132:135]
v_mfma_f32_16x16x32_bf16 v[132:135], a[136:139], v[40:43], v[132:135]
v_mfma_f32_16x16x32_bf16 v[132:135], a[132:135], v[36:39], v[132:135]
v_mfma_f32_16x16x32_bf16 v[148:151], a[148:151], v[36:39], v[148:151]
v_mfma_f32_16x16x32_bf16 v[148:151], a[152:155], v[40:43], v[148:151]
v_mfma_f32_16x16x32_bf16 v[148:151], a[156:159], v[44:47], v[148:151]
v_mfma_f32_16x16x32_bf16 v[144:147], a[156:159], v[28:31], v[144:147]
v_mfma_f32_16x16x32_bf16 v[144:147], a[152:155], v[24:27], v[144:147]
v_mfma_f32_16x16x32_bf16 v[144:147], a[148:151], v[20:23], v[144:147]
s_nop 7
v_max3_f32 v124, v124, v128, v129
v_max3_f32 v124, v124, v130, v131
v_max3_f32 v124, v124, v144, v145
v_max3_f32 v124, v124, v146, v147
v_max3_f32 v125, v125, v132, v133
v_max3_f32 v125, v125, v134, v135
v_max3_f32 v125, v125, v148, v149
v_max3_f32 v125, v125, v150, v151
Lsa54:
s_cmp_lt_u32 s75, s83
s_cbranch_scc1 Lsa57
s_cmp_eq_u32 s75, s83
s_cbranch_scc1 Lst58
v_mfma_f32_16x16x32_bf16 v[136:139], a[128:131], v[48:51], 0
v_mfma_f32_16x16x32_bf16 v[140:143], a[128:131], v[64:67], 0
v_mfma_f32_16x16x32_bf16 v[152:155], a[144:147], v[48:51], 0
v_mfma_f32_16x16x32_bf16 v[156:159], a[144:147], v[64:67], 0
s_branch Lsj59
Lst58:
v_mfma_f32_16x16x32_bf16 v[136:139], a[128:131], v[48:51], v[116:119]
v_mfma_f32_16x16x32_bf16 v[140:143], a[128:131], v[64:67], 0
v_mfma_f32_16x16x32_bf16 v[152:155], a[144:147], v[48:51], v[112:115]
v_mfma_f32_16x16x32_bf16 v[156:159], a[144:147], v[64:67], v[116:119]
Lsj59:
v_mfma_f32_16x16x32_bf16 v[136:139], a[132:135], v[52:55], v[136:139]
v_mfma_f32_16x16x32_bf16 v[136:139], a[136:139], v[56:59], v[136:139]
v_mfma_f32_16x16x32_bf16 v[136:139], a[140:143], v[60:63], v[136:139]
v_mfma_f32_16x16x32_bf16 v[140:143], a[140:143], v[76:79], v[140:143]
v_mfma_f32_16x16x32_bf16 v[140:143], a[136:139], v[72:75], v[140:143]
v_mfma_f32_16x16x32_bf16 v[140:143], a[132:135], v[68:71], v[140:143]
v_mfma_f32_16x16x32_bf16 v[156:159], a[148:151], v[68:71], v[156:159]
v_mfma_f32_16x16x32_bf16 v[156:159], a[152:155], v[72:75], v[156:159]
v_mfma_f32_16x16x32_bf16 v[156:159], a[156:159], v[76:79], v[156:159]
v_mfma_f32_16x16x32_bf16 v[152:155], a[156:159], v[60:63], v[152:155]
v_mfma_f32_16x16x32_bf16 v[152:155], a[152:155], v[56:59], v[152:155]
v_mfma_f32_16x16x32_bf16 v[152:155], a[148:151], v[52:55], v[152:155]
s_nop 7
v_max3_f32 v126, v126, v136, v137
v_max3_f32 v126, v126, v138, v139
v_max3_f32 v126, v126, v152, v153
v_max3_f32 v126, v126, v154, v155
v_max3_f32 v127, v127, v140, v141
v_max3_f32 v127, v127, v142, v143
v_max3_f32 v127, v127, v156, v157
v_max3_f32 v127, v127, v158, v159
Lsa57:
s_add_u32 s83, s83, 1
s_barrier
s_cmp_lt_u32 s83, s76
s_cbranch_scc1 Lslow1
s_lshl_b32 s81, s59, 20
s_add_u32 s81, s81, s64
s_sub_u32 s81, s81, 0x4000
s_add_u32 m0, s64, 49152
s_add_u32 s72, s81, 16384
buffer_load_dwordx4 v1, s[44:47], s72 offen sc1 lds
buffer_load_dwordx4 v1, s[44:47], s72 offen offset:1024 sc1 lds
buffer_load_dwordx4 v1, s[44:47], s72 offen offset:2048 sc1 lds
buffer_load_dwordx4 v1, s[44:47], s72 offen offset:3072 sc1 lds
s_add_u32 s81, s81, 0x8000
s_add_u32 m0, s64, 81920
s_add_u32 s72, s81, 16384
buffer_load_dwordx4 v1, s[44:47], s72 offen sc1 lds
buffer_load_dwordx4 v1, s[44:47], s72 offen offset:1024 sc1 lds
buffer_load_dwordx4 v1, s[44:47], s72 offen offset:2048 sc1 lds
buffer_load_dwordx4 v1, s[44:47], s72 offen offset:3072 sc1 lds
s_add_u32 m0, s64, 65536
s_add_u32 s72, s81, 0
buffer_load_dwordx4 v1, s[44:47], s72 offen sc1 lds
buffer_load_dwordx4 v1, s[44:47], s72 offen offset:1024 sc1 lds
buffer_load_dwordx4 v1, s[44:47], s72 offen offset:2048 sc1 lds
buffer_load_dwordx4 v1, s[44:47], s72 offen offset:3072 sc1 lds
s_add_u32 s81, s81, 0x8000
s_add_u32 m0, s64, 114688
s_add_u32 s72, s81, 16384
buffer_load_dwordx4 v1, s[44:47], s72 offen sc1 lds
buffer_load_dwordx4 v1, s[44:47], s72 offen offset:1024 sc1 lds
buffer_load_dwordx4 v1, s[44:47], s72 offen offset:2048 sc1 lds
buffer_load_dwordx4 v1, s[44:47], s72 offen offset:3072 sc1 lds
s_add_u32 m0, s64, 98304
s_add_u32 s72, s81, 0
buffer_load_dwordx4 v1, s[44:47], s72 offen sc1 lds
buffer_load_dwordx4 v1, s[44:47], s72 offen offset:1024 sc1 lds
buffer_load_dwordx4 v1, s[44:47], s72 offen offset:2048 sc1 lds
buffer_load_dwordx4 v1, s[44:47], s72 offen offset:3072 sc1 lds
v_add_u32 v2, 0x8000, v1
s_waitcnt vmcnt(16)
s_barrier
ds_read_b128 a[128:131], v2 offset:16384
ds_read_b128 a[132:135], v2 offset:17408
ds_read_b128 a[136:139], v2 offset:18432
ds_read_b128 a[140:143], v2 offset:19456
ds_read_b128 a[144:147], v2 offset:20480
ds_read_b128 a[148:151], v2 offset:21504
ds_read_b128 a[152:155], v2 offset:22528
ds_read_b128 a[156:159], v2 offset:23552
s_branch Lattn
Lspin60:
s_mov_b32 s83, 262144
Lsl62:
s_sleep 2
buffer_load_dword v3, v2, s[44:47], s82 offen sc1
s_sub_u32 s83, s83, 1
s_cmp_eq_u32 s83, 0
s_waitcnt vmcnt(0)
s_cbranch_scc1 Lback61
v_cmp_gt_u32 vcc, 2, v3
s_cbranch_vccnz Lsl62
s_branch Lback61
Lspin63:
s_mov_b32 s83, 262144
Lsl65:
s_sleep 2
buffer_load_dword v3, v2, s[44:47], s82 offen sc1
s_sub_u32 s83, s83, 1
s_cmp_eq_u32 s83, 0
s_waitcnt vmcnt(0)
s_cbranch_scc1 Lback64
v_cmp_gt_u32 vcc, 2, v3
s_cbranch_vccnz Lsl65
s_branch Lback64
Lspin66:
s_mov_b32 s83, 262144
Lsl68:
s_sleep 2
buffer_load_dword v3, v2, s[44:47], s82 offen sc1
s_sub_u32 s83, s83, 1
s_cmp_eq_u32 s83, 0
s_waitcnt vmcnt(0)
s_cbranch_scc1 Lback67
v_cmp_gt_u32 vcc, 2, v3
s_cbranch_vccnz Lsl68
s_branch Lback67
Lspin69:
s_mov_b32 s83, 262144
Lsl71:
s_sleep 2
buffer_load_dword v3, v2, s[44:47], s82 offen sc1
s_sub_u32 s83, s83, 1
s_cmp_eq_u32 s83, 0
s_waitcnt vmcnt(0)
s_cbranch_scc1 Lback70
v_cmp_gt_u32 vcc, 2, v3
s_cbranch_vccnz Lsl71
s_branch Lback70
Lspin72:
s_mov_b32 s83, 262144
Lsl74:
s_sleep 2
buffer_load_dword v3, v2, s[44:47], s82 offen sc1
s_sub_u32 s83, s83, 1
s_cmp_eq_u32 s83, 0
s_waitcnt vmcnt(0)
s_cbranch_scc1 Lback73
v_cmp_gt_u32 vcc, 2, v3
s_cbranch_vccnz Lsl74
s_branch Lback73
Lspin75:
s_mov_b32 s83, 262144
Lsl77:
s_sleep 2
buffer_load_dword v3, v2, s[44:47], s82 offen sc1
s_sub_u32 s83, s83, 1
s_cmp_eq_u32 s83, 0
s_waitcnt vmcnt(0)
s_cbranch_scc1 Lback76
v_cmp_gt_u32 vcc, 2, v3
s_cbranch_vccnz Lsl77
s_branch Lback76
Lspin78:
s_mov_b32 s83, 262144
Lsl80:
s_sleep 2
buffer_load_dword v3, v2, s[44:47], s82 offen sc1
s_sub_u32 s83, s83, 1
s_cmp_eq_u32 s83, 0
s_waitcnt vmcnt(0)
s_cbranch_scc1 Lback79
v_cmp_gt_u32 vcc, 2, v3
s_cbranch_vccnz Lsl80
s_branch Lback79
Lspin81:
s_mov_b32 s83, 262144
Lsl83:
s_sleep 2
buffer_load_dword v3, v2, s[44:47], s82 offen sc1
s_sub_u32 s83, s83, 1
s_cmp_eq_u32 s83, 0
s_waitcnt vmcnt(0)
s_cbranch_scc1 Lback82
v_cmp_gt_u32 vcc, 2, v3
s_cbranch_vccnz Lsl83
s_branch Lback82
Lredo0:
s_add_u32 s82, s59, 4
s_and_b32 s82, s82, 28
s_lshl_b32 s82, s82, 10
s_add_u32 s82, s82, s74
buffer_load_dword v3, v2, s[44:47], s82 offen sc1
s_waitcnt vmcnt(0)
v_cmp_gt_u32 vcc, 2, v3
s_cbranch_vccnz Lspin60
Lback61:
s_add_u32 s69, s61, 0
s_and_b32 s69, s69, 3
s_add_u32 s69, s69, s78
s_lshl_b32 s69, s69, 12
s_add_u32 s69, s69, s95
buffer_load_dwordx4 a[0:3], v1, s[44:47], s69 offen sc1
buffer_load_dwordx4 a[4:7], v1, s[44:47], s69 offen offset:1024 sc1
buffer_load_dwordx4 a[8:11], v1, s[44:47], s69 offen offset:2048 sc1
buffer_load_dwordx4 a[12:15], v1, s[44:47], s69 offen offset:3072 sc1
s_add_u32 s69, s69, 0x20000
buffer_load_dwordx4 a[16:19], v1, s[44:47], s69 offen sc1
buffer_load_dwordx4 a[20:23], v1, s[44:47], s69 offen offset:1024 sc1
buffer_load_dwordx4 a[24:27], v1, s[44:47], s69 offen offset:2048 sc1
buffer_load_dwordx4 a[28:31], v1, s[44:47], s69 offen offset:3072 sc1
s_add_u32 s69, s61, 1
s_and_b32 s69, s69, 3
s_add_u32 s69, s69, s78
s_lshl_b32 s69, s69, 12
s_add_u32 s69, s69, s95
buffer_load_dwordx4 a[32:35], v1, s[44:47], s69 offen sc1
buffer_load_dwordx4 a[36:39], v1, s[44:47], s69 offen offset:1024 sc1
buffer_load_dwordx4 a[40:43], v1, s[44:47], s69 offen offset:2048 sc1
buffer_load_dwordx4 a[44:47], v1, s[44:47], s69 offen offset:3072 sc1
s_add_u32 s69, s69, 0x20000
buffer_load_dwordx4 a[48:51], v1, s[44:47], s69 offen sc1
buffer_load_dwordx4 a[52:55], v1, s[44:47], s69 offen offset:1024 sc1
buffer_load_dwordx4 a[56:59], v1, s[44:47], s69 offen offset:2048 sc1
buffer_load_dwordx4 a[60:63], v1, s[44:47], s69 offen offset:3072 sc1
s_add_u32 s69, s61, 2
s_and_b32 s69, s69, 3
s_add_u32 s69, s69, s78
s_lshl_b32 s69, s69, 12
s_add_u32 s69, s69, s95
buffer_load_dwordx4 a[64:67], v1, s[44:47], s69 offen sc1
buffer_load_dwordx4 a[68:71], v1, s[44:47], s69 offen offset:1024 sc1
buffer_load_dwordx4 a[72:75], v1, s[44:47], s69 offen offset:2048 sc1
buffer_load_dwordx4 a[76:79], v1, s[44:47], s69 offen offset:3072 sc1
s_add_u32 s69, s69, 0x20000
buffer_load_dwordx4 a[80:83], v1, s[44:47], s69 offen sc1
buffer_load_dwordx4 a[84:87], v1, s[44:47], s69 offen offset:1024 sc1
buffer_load_dwordx4 a[88:91], v1, s[44:47], s69 offen offset:2048 sc1
buffer_load_dwordx4 a[92:95], v1, s[44:47], s69 offen offset:3072 sc1
s_waitcnt vmcnt(16)
s_branch Lredo0b
Lspin84:
s_mov_b32 s83, 262144
Lsl86:
s_sleep 2
buffer_load_dword v114, v115, s[44:47], s84 offen sc1
s_sub_u32 s83, s83, 1
s_cmp_eq_u32 s83, 0
s_waitcnt vmcnt(0)
s_cbranch_scc1 Lback85
v_cmp_gt_u32 vcc, 3, v114
s_cbranch_vccnz Lsl86
s_branch Lback85
Lcode_end:
s_endpgm
.section .rodata,"a"
.p2align 6
.amdhsa_kernel gated_mix__compressed_kv_cla__ssm_conv_h3__prompt_kernel
  .amdhsa_next_free_vgpr 512
  .amdhsa_next_free_sgpr 102
  .amdhsa_accum_offset 256
  .amdhsa_group_segment_fixed_size 0
  .amdhsa_kernarg_size 128
  .amdhsa_user_sgpr_count 2
  .amdhsa_user_sgpr_kernarg_segment_ptr 1
  .amdhsa_system_sgpr_workgroup_id_x 1
  .amdhsa_float_denorm_mode_32 3
.end_amdhsa_kernel
```

```asm
; @launch grid=(256,1,1) block=(256,1,1) lds=163840
.amdgcn_target "amdgcn-amd-amdhsa--gfx950"
.text
.globl gated_mix__compressed_kv_cla__ssm_conv_h3__prompt_kernel
.p2align 8
.type gated_mix__compressed_kv_cla__ssm_conv_h3__prompt_kernel,@function
gated_mix__compressed_kv_cla__ssm_conv_h3__prompt_kernel:
s_cmp_ge_u32 s2, 256
s_cbranch_scc1 Lend
s_load_dwordx2 s[8:9], s[0:1], 8
s_load_dwordx2 s[16:17], s[0:1], 24
s_load_dwordx2 s[20:21], s[0:1], 32
s_load_dwordx2 s[4:5], s[0:1], 0
s_load_dwordx2 s[12:13], s[0:1], 16
s_load_dwordx2 s[24:25], s[0:1], 40
s_load_dwordx2 s[28:29], s[0:1], 56
s_load_dwordx2 s[32:33], s[0:1], 64
s_load_dwordx2 s[52:53], s[0:1], 72
s_load_dwordx2 s[36:37], s[0:1], 80
s_load_dwordx2 s[54:55], s[0:1], 88
s_load_dwordx2 s[56:57], s[0:1], 96
s_load_dwordx2 s[40:41], s[0:1], 104
s_load_dwordx2 s[48:49], s[0:1], 112
s_load_dwordx2 s[44:45], s[0:1], 120
s_getpc_b64 s[98:99]
Lpc0:
s_lshr_b32 s75, s2, 3
v_lshrrev_b32 v26, 3, v0
s_lshl_b32 s73, s75, 12
v_lshlrev_b32 v26, 7, v26
v_add_u32 v26, s73, v26
v_min_u32 v26, Lcode_end-Lpc0, v26
global_load_dword v31, v26, s[98:99]
v_lshrrev_b32 v26, 6, v0
v_and_b32 v0, 63, v0
s_and_b32 s73, s2, 7
v_readfirstlane_b32 s58, v26
s_lshr_b32 s65, s75, 3
s_and_b32 s60, s75, 7
s_lshl_b32 s59, s73, 2
s_add_u32 s59, s59, s65
s_lshl_b32 s61, s65, 1
s_lshl_b32 s63, s58, 13
s_lshl_b32 s64, s58, 12
s_lshl_b32 s67, s60, 18
s_lshl_b32 s76, s58, 16
s_add_u32 s67, s67, s76
s_lshl_b32 s66, s58, 17
s_lshl_b32 s73, s59, 8
s_add_u32 s66, s66, s73
v_lshrrev_b32 v26, 4, v0
v_and_b32 v27, 7, v0
v_xor_b32 v27, v27, v26
v_lshlrev_b32 v27, 4, v27
v_lshrrev_b32 v28, 3, v0
v_lshl_add_u32 v2, v28, 10, v27
v_xor_b32 v3, 64, v2
v_and_b32 v29, 15, v0
v_lshlrev_b32 v30, 1, v26
v_xor_b32 v30, v30, v29
v_lshlrev_b32 v30, 4, v30
v_lshl_add_u32 v6, v26, 13, v30
v_xor_b32 v7, 0x80, v6
s_mov_b32 s10, 0x200000
s_mov_b32 s11, 0x20000
s_mov_b32 s18, 0x400000
s_mov_b32 s19, 0x20000
s_mov_b32 s22, 0x400000
s_mov_b32 s23, 0x20000
s_lshl_b32 s73, s2, 2
s_add_u32 s73, s73, s58
s_lshl_b32 s73, s73, 11
v_lshrrev_b32 v124, 2, v0
v_lshlrev_b32 v124, 7, v124
v_add_u32 v124, s73, v124
s_lshl_b32 s73, s60, 2
s_add_u32 s73, s73, s58
s_lshl_b32 s73, s73, 13
s_lshl_b32 s74, s59, 8
s_add_u32 s73, s73, s74
v_lshrrev_b32 v125, 4, v0
v_lshlrev_b32 v125, 18, v125
v_bfe_u32 v126, v0, 3, 1
v_lshl_add_u32 v125, v126, 7, v125
v_add_u32 v125, s73, v125
s_waitcnt lgkmcnt(0)
s_mov_b32 s80, 0x0
buffer_load_dword v126, v125, s[16:19], s80 offen
buffer_load_dword v126, v125, s[20:23], s80 offen
s_and_b32 s73, s65, 1
s_xor_b32 s73, s73, 0
s_lshl_b32 s69, s73, 7
s_add_u32 s69, s69, s67
s_lshl_b32 s71, s73, 19
s_add_u32 s71, s71, s66
s_add_u32 m0, s63, 65536
s_add_u32 s72, s69, 0
buffer_load_dwordx4 v2, s[8:11], s72 offen lds
s_add_u32 s72, s69, 7168
buffer_load_dwordx4 v3, s[8:11], s72 offen offset:1024 lds
s_add_u32 s72, s69, 14336
buffer_load_dwordx4 v2, s[8:11], s72 offen offset:2048 lds
s_add_u32 s72, s69, 21504
buffer_load_dwordx4 v3, s[8:11], s72 offen offset:3072 lds
s_add_u32 m0, s64, 0
s_add_u32 s72, s71, 0
buffer_load_dwordx4 v6, s[16:19], s72 offen lds
s_add_u32 s72, s71, 31744
buffer_load_dwordx4 v6, s[16:19], s72 offen offset:1024 lds
s_add_u32 s72, s71, 63488
buffer_load_dwordx4 v7, s[16:19], s72 offen offset:2048 lds
s_add_u32 s72, s71, 95232
buffer_load_dwordx4 v7, s[16:19], s72 offen offset:3072 lds
s_add_u32 m0, s63, 69632
s_add_u32 s72, s69, 32768
buffer_load_dwordx4 v2, s[8:11], s72 offen lds
s_add_u32 s72, s69, 39936
buffer_load_dwordx4 v3, s[8:11], s72 offen offset:1024 lds
s_add_u32 s72, s69, 47104
buffer_load_dwordx4 v2, s[8:11], s72 offen offset:2048 lds
s_add_u32 s72, s69, 54272
buffer_load_dwordx4 v3, s[8:11], s72 offen offset:3072 lds
s_add_u32 m0, s64, 16384
s_add_u32 s72, s71, 0
buffer_load_dwordx4 v6, s[20:23], s72 offen lds
s_add_u32 s72, s71, 31744
buffer_load_dwordx4 v6, s[20:23], s72 offen offset:1024 lds
s_add_u32 s72, s71, 63488
buffer_load_dwordx4 v7, s[20:23], s72 offen offset:2048 lds
s_add_u32 s72, s71, 95232
buffer_load_dwordx4 v7, s[20:23], s72 offen offset:3072 lds
buffer_load_dword v126, v124, s[8:11], 0 offen
s_and_b32 s73, s65, 1
s_xor_b32 s73, s73, 1
s_lshl_b32 s69, s73, 7
s_add_u32 s69, s69, s67
s_lshl_b32 s71, s73, 19
s_add_u32 s71, s71, s66
s_add_u32 m0, s63, 98304
s_add_u32 s72, s69, 0
buffer_load_dwordx4 v2, s[8:11], s72 offen lds
s_add_u32 s72, s69, 7168
buffer_load_dwordx4 v3, s[8:11], s72 offen offset:1024 lds
s_add_u32 s72, s69, 14336
buffer_load_dwordx4 v2, s[8:11], s72 offen offset:2048 lds
s_add_u32 s72, s69, 21504
buffer_load_dwordx4 v3, s[8:11], s72 offen offset:3072 lds
s_branch Lmain
.p2align 12
Lmain:
s_mov_b32 s6, 0x400000
s_mov_b32 s7, 0x20000
s_mov_b32 s14, 0x800000
s_mov_b32 s15, 0x20000
s_mov_b32 s26, 0x800000
s_mov_b32 s27, 0x20000
s_mov_b32 s30, 0x400000
s_mov_b32 s31, 0x20000
s_mov_b32 s34, 0x400000
s_mov_b32 s35, 0x20000
s_mov_b32 s38, 0x400000
s_mov_b32 s39, 0x20000
s_mov_b32 s42, 0x400000
s_mov_b32 s43, 0x20000
s_mov_b32 s46, 0x5000000
s_mov_b32 s47, 0x20000
s_mov_b32 s50, 0x100
s_mov_b32 s51, 0x20000
v_lshl_add_u32 v4, v28, 11, v27
v_xor_b32 v5, 64, v4
v_lshlrev_b32 v1, 4, v0
s_sub_u32 s74, 15, s60
s_lshl_b32 s68, s74, 18
s_add_u32 s68, s68, s76
s_and_b32 s62, s60, 3
s_sub_u32 s62, 16, s62
s_lshl_b32 s91, s59, 3
s_add_u32 s91, s91, s60
s_lshl_b32 s93, s91, 2
s_add_u32 s93, s93, s58
s_lshl_b32 s91, s91, 7
s_add_u32 s91, s91, 0x3810000
s_lshl_b32 s75, s93, 1
s_and_b32 s75, s75, 0xffc
s_lshl_b32 s93, s93, 12
s_mul_i32 s92, s58, 12480
s_load_dwordx2 s[88:89], s[36:37], s93
s_load_dword s90, s[54:55], s75
v_or_b32 v29, s58, v0
v_mov_b32 v30, 0
v_min_u32 v29, 1, v29
v_lshlrev_b32 v29, 30, v29
buffer_store_dword v30, v29, s[44:47], s91 offen sc1
s_and_b32 s73, s2, 15
s_lshr_b32 s74, s2, 4
s_lshl_b32 s74, s74, 7
s_lshl_b32 s75, s58, 5
s_add_u32 s74, s74, s75
s_mov_b32 s75, 131072
v_lshrrev_b32 v29, 5, v0
v_lshlrev_b32 v29, 4, v29
v_add_u32 v29, s74, v29
v_and_b32 v30, 31, v0
s_lshl_b32 s73, s73, 5
v_add_u32 v30, s73, v30
v_lshlrev_b32 v26, 11, v29
v_lshl_add_u32 v26, v30, 2, v26
v_subrev_u32 v27, 0x1800, v26
s_lshl_b32 s82, s74, 11
s_lshl_b32 s73, s73, 2
s_add_u32 s82, s82, s73
v_lshrrev_b32 v26, 3, v0
v_and_b32 v32, 7, v0
v_lshlrev_b32 v32, 4, v32
v_lshl_add_u32 v26, v26, 11, v32
v_lshrrev_b32 v98, 5, v0
v_lshlrev_b32 v98, 11, v98
v_and_b32 v32, 31, v0
v_lshl_add_u32 v98, v32, 2, v98
v_add_u32 v98, s63, v98
v_add_u32 v98, s75, v98
v_and_b32 v29, 0x7f, v29
v_sub_u32 v29, 0x70, v29
v_lshlrev_b32 v29, 1, v29
v_and_b32 v32, 31, v0
v_mul_u32_u24 v32, 544, v32
v_add3_u32 v28, v32, v29, s75
v_lshlrev_b32 v30, 4, v30
s_lshl_b32 s73, s2, 14
s_lshl_b32 s74, s58, 12
s_add_u32 s76, s73, s74
v_and_b32 v29, 15, v0
v_lshrrev_b32 v32, 4, v0
v_lshrrev_b32 v24, 1, v29
v_xor_b32 v24, v24, v32
v_lshlrev_b32 v24, 4, v24
v_lshl_add_u32 v24, v29, 7, v24
s_add_u32 s73, s63, 131072
v_add_u32 v16, s73, v24
v_xor_b32 v17, 64, v16
v_subrev_u32 v18, 0x10000, v16
v_subrev_u32 v19, 0x10000, v17
s_lshr_b32 s73, s58, 1
s_lshl_b32 s74, s73, 14
s_add_u32 s74, s74, 0x10000
v_add_u32 v24, s74, v24
v_xor_b32 v25, 64, v24
v_lshrrev_b32 v8, 2, v29
v_and_b32 v9, 1, v32
v_lshl_add_u32 v9, v9, 2, v8
v_lshl_add_u32 v8, v32, 3, v8
v_lshlrev_b32 v8, 8, v8
v_lshl_add_u32 v8, v9, 5, v8
v_and_b32 v29, 3, v0
v_lshl_add_u32 v8, v29, 3, v8
s_and_b32 s74, s58, 1
s_lshl_b32 s75, s74, 7
v_xor_b32 v20, s75, v8
v_xor_b32 v9, 32, v8
v_xor_b32 v10, 64, v8
v_xor_b32 v11, 96, v8
v_xor_b32 v12, 128, v8
v_xor_b32 v13, 160, v8
v_xor_b32 v14, 192, v8
v_xor_b32 v15, 224, v8
v_xor_b32 v21, 32, v20
v_xor_b32 v22, 64, v20
v_xor_b32 v23, 96, v20
s_lshl_b32 s77, s59, 20
s_add_u32 s81, s77, s64
s_sub_u32 s81, s81, 0x4000
s_lshl_b32 s75, s60, 17
s_add_u32 s77, s77, s75
s_lshl_b32 s73, s73, 16
s_add_u32 s77, s77, s73
s_lshl_b32 s75, s74, 12
s_add_u32 s78, s77, s75
s_add_u32 s78, s78, 0x4000
s_lshl_b32 s75, s74, 11
s_add_u32 s77, s77, s75
s_mov_b32 s79, 0x3e0293ee
s_waitcnt vmcnt(6)
s_barrier
ds_read_b64_tr_b16 v[160:161], v20 offset:0
ds_read_b64_tr_b16 v[162:163], v20 offset:1024
ds_read_b128 v[128:131], v24 offset:0
ds_read_b128 v[132:135], v24 offset:2048
ds_read_b128 v[136:139], v24 offset:4096
ds_read_b128 v[140:143], v24 offset:6144
ds_read_b128 v[144:147], v24 offset:8192
ds_read_b128 v[148:151], v24 offset:10240
ds_read_b128 v[152:155], v24 offset:12288
ds_read_b128 v[156:159], v24 offset:14336
ds_read_b64_tr_b16 v[164:165], v21 offset:0
ds_read_b64_tr_b16 v[166:167], v21 offset:1024
ds_read_b64_tr_b16 v[168:169], v22 offset:0
ds_read_b64_tr_b16 v[170:171], v22 offset:1024
ds_read_b64_tr_b16 v[172:173], v23 offset:0
ds_read_b64_tr_b16 v[174:175], v23 offset:1024
ds_read_b64_tr_b16 v[176:177], v20 offset:16384
ds_read_b64_tr_b16 v[178:179], v20 offset:17408
ds_read_b64_tr_b16 v[180:181], v21 offset:16384
ds_read_b64_tr_b16 v[182:183], v21 offset:17408
ds_read_b64_tr_b16 v[184:185], v22 offset:16384
ds_read_b64_tr_b16 v[186:187], v22 offset:17408
ds_read_b64_tr_b16 v[188:189], v23 offset:16384
ds_read_b64_tr_b16 v[190:191], v23 offset:17408
s_waitcnt lgkmcnt(0)
v_mfma_f32_16x16x32_bf16 a[0:3], v[160:163], v[128:131], 0
s_add_u32 m0, s64, 32768
ds_read_b64_tr_b16 v[224:225], v20 offset:8192
v_mfma_f32_16x16x32_bf16 a[4:7], v[160:163], v[132:135], 0
s_add_u32 s72, s71, 0
buffer_load_dwordx4 v6, s[16:19], s72 offen lds
v_mfma_f32_16x16x32_bf16 a[8:11], v[160:163], v[136:139], 0
s_add_u32 s72, s71, 31744
buffer_load_dwordx4 v6, s[16:19], s72 offen offset:1024 lds
v_mfma_f32_16x16x32_bf16 a[12:15], v[160:163], v[140:143], 0
ds_read_b64_tr_b16 v[226:227], v20 offset:9216
v_mfma_f32_16x16x32_bf16 a[16:19], v[160:163], v[144:147], 0
s_add_u32 s72, s71, 63488
buffer_load_dwordx4 v7, s[16:19], s72 offen offset:2048 lds
v_mfma_f32_16x16x32_bf16 a[20:23], v[160:163], v[148:151], 0
ds_read_b128 v[192:195], v25 offset:0
v_mfma_f32_16x16x32_bf16 a[24:27], v[160:163], v[152:155], 0
s_add_u32 s72, s71, 95232
buffer_load_dwordx4 v7, s[16:19], s72 offen offset:3072 lds
v_mfma_f32_16x16x32_bf16 a[28:31], v[160:163], v[156:159], 0
ds_read_b128 v[196:199], v25 offset:2048
v_mfma_f32_16x16x32_bf16 a[60:63], v[164:167], v[156:159], 0
s_add_u32 m0, s63, 102400
ds_read_b128 v[200:203], v25 offset:4096
v_mfma_f32_16x16x32_bf16 a[56:59], v[164:167], v[152:155], 0
s_add_u32 s72, s69, 32768
buffer_load_dwordx4 v2, s[8:11], s72 offen lds
v_mfma_f32_16x16x32_bf16 a[52:55], v[164:167], v[148:151], 0
s_add_u32 s72, s69, 39936
buffer_load_dwordx4 v3, s[8:11], s72 offen offset:1024 lds
v_mfma_f32_16x16x32_bf16 a[48:51], v[164:167], v[144:147], 0
ds_read_b128 v[204:207], v25 offset:6144
v_mfma_f32_16x16x32_bf16 a[44:47], v[164:167], v[140:143], 0
s_add_u32 s72, s69, 47104
buffer_load_dwordx4 v2, s[8:11], s72 offen offset:2048 lds
v_mfma_f32_16x16x32_bf16 a[40:43], v[164:167], v[136:139], 0
ds_read_b128 v[208:211], v25 offset:8192
v_mfma_f32_16x16x32_bf16 a[36:39], v[164:167], v[132:135], 0
s_add_u32 s72, s69, 54272
buffer_load_dwordx4 v3, s[8:11], s72 offen offset:3072 lds
v_mfma_f32_16x16x32_bf16 a[32:35], v[164:167], v[128:131], 0
ds_read_b128 v[212:215], v25 offset:10240
v_mfma_f32_16x16x32_bf16 a[64:67], v[168:171], v[128:131], 0
s_add_u32 m0, s64, 49152
ds_read_b128 v[216:219], v25 offset:12288
v_mfma_f32_16x16x32_bf16 a[68:71], v[168:171], v[132:135], 0
s_add_u32 s72, s71, 0
buffer_load_dwordx4 v6, s[20:23], s72 offen lds
v_mfma_f32_16x16x32_bf16 a[72:75], v[168:171], v[136:139], 0
s_add_u32 s72, s71, 31744
buffer_load_dwordx4 v6, s[20:23], s72 offen offset:1024 lds
v_mfma_f32_16x16x32_bf16 a[76:79], v[168:171], v[140:143], 0
ds_read_b128 v[220:223], v25 offset:14336
v_mfma_f32_16x16x32_bf16 a[80:83], v[168:171], v[144:147], 0
s_add_u32 s72, s71, 63488
buffer_load_dwordx4 v7, s[20:23], s72 offen offset:2048 lds
v_mfma_f32_16x16x32_bf16 a[84:87], v[168:171], v[148:151], 0
ds_read_b64_tr_b16 v[228:229], v21 offset:8192
v_mfma_f32_16x16x32_bf16 a[88:91], v[168:171], v[152:155], 0
s_add_u32 s72, s71, 95232
buffer_load_dwordx4 v7, s[20:23], s72 offen offset:3072 lds
v_mfma_f32_16x16x32_bf16 a[92:95], v[168:171], v[156:159], 0
s_mov_b32 s80, 0x100000
buffer_load_dword v126, v125, s[16:19], s80 offen
v_mfma_f32_16x16x32_bf16 a[124:127], v[172:175], v[156:159], 0
buffer_load_dword v126, v125, s[20:23], s80 offen
v_mfma_f32_16x16x32_bf16 a[120:123], v[172:175], v[152:155], 0
ds_read_b64_tr_b16 v[230:231], v21 offset:9216
v_mfma_f32_16x16x32_bf16 a[116:119], v[172:175], v[148:151], 0
ds_read_b64_tr_b16 v[232:233], v22 offset:8192
v_mfma_f32_16x16x32_bf16 a[112:115], v[172:175], v[144:147], 0
ds_read_b64_tr_b16 v[234:235], v22 offset:9216
v_mfma_f32_16x16x32_bf16 a[108:111], v[172:175], v[140:143], 0
ds_read_b64_tr_b16 v[236:237], v23 offset:8192
v_mfma_f32_16x16x32_bf16 a[104:107], v[172:175], v[136:139], 0
ds_read_b64_tr_b16 v[238:239], v23 offset:9216
v_mfma_f32_16x16x32_bf16 a[100:103], v[172:175], v[132:135], 0
ds_read_b64_tr_b16 v[240:241], v20 offset:24576
v_mfma_f32_16x16x32_bf16 a[96:99], v[172:175], v[128:131], 0
ds_read_b64_tr_b16 v[242:243], v20 offset:25600
v_mfma_f32_16x16x32_bf16 a[128:131], v[128:131], v[176:179], 0
ds_read_b64_tr_b16 v[244:245], v21 offset:24576
v_mfma_f32_16x16x32_bf16 a[132:135], v[132:135], v[176:179], 0
ds_read_b64_tr_b16 v[246:247], v21 offset:25600
v_mfma_f32_16x16x32_bf16 a[136:139], v[136:139], v[176:179], 0
ds_read_b64_tr_b16 v[248:249], v22 offset:24576
v_mfma_f32_16x16x32_bf16 a[140:143], v[140:143], v[176:179], 0
ds_read_b64_tr_b16 v[250:251], v22 offset:25600
v_mfma_f32_16x16x32_bf16 a[144:147], v[144:147], v[176:179], 0
ds_read_b64_tr_b16 v[252:253], v23 offset:24576
v_mfma_f32_16x16x32_bf16 a[148:151], v[148:151], v[176:179], 0
ds_read_b64_tr_b16 v[254:255], v23 offset:25600
v_mfma_f32_16x16x32_bf16 a[152:155], v[152:155], v[176:179], 0
v_mfma_f32_16x16x32_bf16 a[156:159], v[156:159], v[176:179], 0
v_mfma_f32_16x16x32_bf16 a[188:191], v[156:159], v[180:183], 0
v_mfma_f32_16x16x32_bf16 a[184:187], v[152:155], v[180:183], 0
v_mfma_f32_16x16x32_bf16 a[180:183], v[148:151], v[180:183], 0
v_mfma_f32_16x16x32_bf16 a[176:179], v[144:147], v[180:183], 0
v_mfma_f32_16x16x32_bf16 a[172:175], v[140:143], v[180:183], 0
v_mfma_f32_16x16x32_bf16 a[168:171], v[136:139], v[180:183], 0
v_mfma_f32_16x16x32_bf16 a[164:167], v[132:135], v[180:183], 0
v_mfma_f32_16x16x32_bf16 a[160:163], v[128:131], v[180:183], 0
v_mfma_f32_16x16x32_bf16 a[192:195], v[128:131], v[184:187], 0
v_mfma_f32_16x16x32_bf16 a[196:199], v[132:135], v[184:187], 0
v_mfma_f32_16x16x32_bf16 a[200:203], v[136:139], v[184:187], 0
v_mfma_f32_16x16x32_bf16 a[204:207], v[140:143], v[184:187], 0
v_mfma_f32_16x16x32_bf16 a[208:211], v[144:147], v[184:187], 0
v_mfma_f32_16x16x32_bf16 a[212:215], v[148:151], v[184:187], 0
v_mfma_f32_16x16x32_bf16 a[216:219], v[152:155], v[184:187], 0
v_mfma_f32_16x16x32_bf16 a[220:223], v[156:159], v[184:187], 0
v_mfma_f32_16x16x32_bf16 a[252:255], v[156:159], v[188:191], 0
v_mfma_f32_16x16x32_bf16 a[248:251], v[152:155], v[188:191], 0
v_mfma_f32_16x16x32_bf16 a[244:247], v[148:151], v[188:191], 0
v_mfma_f32_16x16x32_bf16 a[240:243], v[144:147], v[188:191], 0
v_mfma_f32_16x16x32_bf16 a[236:239], v[140:143], v[188:191], 0
v_mfma_f32_16x16x32_bf16 a[232:235], v[136:139], v[188:191], 0
s_nop 3
s_mov_b64 exec, 0
s_cmp_eq_u32 s58, 0
s_cbranch_scc1 Lstub0
s_cmp_eq_u32 s58, 1
s_cbranch_scc1 Lstub1
s_cmp_eq_u32 s58, 2
s_cbranch_scc1 Lstub2
s_branch Lstub3
Lret:
s_mov_b64 exec, -1
s_nop 3
v_mfma_f32_16x16x32_bf16 a[228:231], v[132:135], v[188:191], 0
s_waitcnt vmcnt(2) lgkmcnt(0)
v_mfma_f32_16x16x32_bf16 a[224:227], v[128:131], v[188:191], 0
s_barrier
v_mfma_f32_16x16x32_bf16 a[0:3], v[224:227], v[192:195], a[0:3]
s_and_b32 s73, s65, 1
ds_read_b64_tr_b16 v[160:161], v20 offset:32768
v_mfma_f32_16x16x32_bf16 a[4:7], v[224:227], v[196:199], a[4:7]
s_xor_b32 s73, s73, 2
ds_read_b64_tr_b16 v[162:163], v20 offset:33792
v_mfma_f32_16x16x32_bf16 a[8:11], v[224:227], v[200:203], a[8:11]
s_lshl_b32 s69, s73, 7
ds_read_b128 v[128:131], v24 offset:32768
v_mfma_f32_16x16x32_bf16 a[12:15], v[224:227], v[204:207], a[12:15]
s_add_u32 s69, s69, s67
ds_read_b128 v[132:135], v24 offset:34816
v_mfma_f32_16x16x32_bf16 a[16:19], v[224:227], v[208:211], a[16:19]
s_lshl_b32 s71, s73, 19
ds_read_b128 v[136:139], v24 offset:36864
v_mfma_f32_16x16x32_bf16 a[20:23], v[224:227], v[212:215], a[20:23]
s_add_u32 s71, s71, s66
ds_read_b128 v[140:143], v24 offset:38912
v_mfma_f32_16x16x32_bf16 a[24:27], v[224:227], v[216:219], a[24:27]
s_add_u32 m0, s63, 65536
ds_read_b128 v[144:147], v24 offset:40960
v_mfma_f32_16x16x32_bf16 a[28:31], v[224:227], v[220:223], a[28:31]
s_add_u32 s72, s69, 0
buffer_load_dwordx4 v2, s[8:11], s72 offen lds
v_mfma_f32_16x16x32_bf16 a[60:63], v[228:231], v[220:223], a[60:63]
s_add_u32 s72, s69, 7168
buffer_load_dwordx4 v3, s[8:11], s72 offen offset:1024 lds
v_mfma_f32_16x16x32_bf16 a[56:59], v[228:231], v[216:219], a[56:59]
s_add_u32 s72, s69, 14336
buffer_load_dwordx4 v2, s[8:11], s72 offen offset:2048 lds
v_mfma_f32_16x16x32_bf16 a[52:55], v[228:231], v[212:215], a[52:55]
ds_read_b128 v[148:151], v24 offset:43008
v_mfma_f32_16x16x32_bf16 a[48:51], v[228:231], v[208:211], a[48:51]
ds_read_b128 v[152:155], v24 offset:45056
v_mfma_f32_16x16x32_bf16 a[44:47], v[228:231], v[204:207], a[44:47]
s_add_u32 s72, s69, 21504
buffer_load_dwordx4 v3, s[8:11], s72 offen offset:3072 lds
v_mfma_f32_16x16x32_bf16 a[40:43], v[228:231], v[200:203], a[40:43]
ds_read_b128 v[156:159], v24 offset:47104
v_mfma_f32_16x16x32_bf16 a[36:39], v[228:231], v[196:199], a[36:39]
ds_read_b64_tr_b16 v[164:165], v21 offset:32768
v_mfma_f32_16x16x32_bf16 a[32:35], v[228:231], v[192:195], a[32:35]
ds_read_b64_tr_b16 v[166:167], v21 offset:33792
v_mfma_f32_16x16x32_bf16 a[64:67], v[232:235], v[192:195], a[64:67]
ds_read_b64_tr_b16 v[168:169], v22 offset:32768
v_mfma_f32_16x16x32_bf16 a[68:71], v[232:235], v[196:199], a[68:71]
s_add_u32 m0, s64, 0
ds_read_b64_tr_b16 v[170:171], v22 offset:33792
v_mfma_f32_16x16x32_bf16 a[72:75], v[232:235], v[200:203], a[72:75]
s_add_u32 s72, s71, 0
buffer_load_dwordx4 v6, s[16:19], s72 offen lds
v_mfma_f32_16x16x32_bf16 a[76:79], v[232:235], v[204:207], a[76:79]
ds_read_b64_tr_b16 v[172:173], v23 offset:32768
v_mfma_f32_16x16x32_bf16 a[80:83], v[232:235], v[208:211], a[80:83]
ds_read_b64_tr_b16 v[174:175], v23 offset:33792
v_mfma_f32_16x16x32_bf16 a[84:87], v[232:235], v[212:215], a[84:87]
s_add_u32 s72, s71, 31744
buffer_load_dwordx4 v6, s[16:19], s72 offen offset:1024 lds
v_mfma_f32_16x16x32_bf16 a[88:91], v[232:235], v[216:219], a[88:91]
ds_read_b64_tr_b16 v[176:177], v20 offset:49152
v_mfma_f32_16x16x32_bf16 a[92:95], v[232:235], v[220:223], a[92:95]
ds_read_b64_tr_b16 v[178:179], v20 offset:50176
v_mfma_f32_16x16x32_bf16 a[124:127], v[236:239], v[220:223], a[124:127]
ds_read_b64_tr_b16 v[180:181], v21 offset:49152
v_mfma_f32_16x16x32_bf16 a[120:123], v[236:239], v[216:219], a[120:123]
s_add_u32 s72, s71, 63488
buffer_load_dwordx4 v7, s[16:19], s72 offen offset:2048 lds
v_mfma_f32_16x16x32_bf16 a[116:119], v[236:239], v[212:215], a[116:119]
ds_read_b64_tr_b16 v[182:183], v21 offset:50176
v_mfma_f32_16x16x32_bf16 a[112:115], v[236:239], v[208:211], a[112:115]
ds_read_b64_tr_b16 v[184:185], v22 offset:49152
v_mfma_f32_16x16x32_bf16 a[108:111], v[236:239], v[204:207], a[108:111]
ds_read_b64_tr_b16 v[186:187], v22 offset:50176
v_mfma_f32_16x16x32_bf16 a[104:107], v[236:239], v[200:203], a[104:107]
ds_read_b64_tr_b16 v[188:189], v23 offset:49152
v_mfma_f32_16x16x32_bf16 a[100:103], v[236:239], v[196:199], a[100:103]
s_add_u32 s72, s71, 95232
buffer_load_dwordx4 v7, s[16:19], s72 offen offset:3072 lds
v_mfma_f32_16x16x32_bf16 a[96:99], v[236:239], v[192:195], a[96:99]
ds_read_b64_tr_b16 v[190:191], v23 offset:50176
v_mfma_f32_16x16x32_bf16 a[128:131], v[192:195], v[240:243], a[128:131]
v_mfma_f32_16x16x32_bf16 a[132:135], v[196:199], v[240:243], a[132:135]
v_mfma_f32_16x16x32_bf16 a[136:139], v[200:203], v[240:243], a[136:139]
s_add_u32 m0, s63, 69632
v_mfma_f32_16x16x32_bf16 a[140:143], v[204:207], v[240:243], a[140:143]
s_add_u32 s72, s69, 32768
buffer_load_dwordx4 v2, s[8:11], s72 offen lds
v_mfma_f32_16x16x32_bf16 a[144:147], v[208:211], v[240:243], a[144:147]
v_mfma_f32_16x16x32_bf16 a[148:151], v[212:215], v[240:243], a[148:151]
v_mfma_f32_16x16x32_bf16 a[152:155], v[216:219], v[240:243], a[152:155]
s_add_u32 s72, s69, 39936
buffer_load_dwordx4 v3, s[8:11], s72 offen offset:1024 lds
v_mfma_f32_16x16x32_bf16 a[156:159], v[220:223], v[240:243], a[156:159]
v_mfma_f32_16x16x32_bf16 a[188:191], v[220:223], v[244:247], a[188:191]
v_mfma_f32_16x16x32_bf16 a[184:187], v[216:219], v[244:247], a[184:187]
v_mfma_f32_16x16x32_bf16 a[180:183], v[212:215], v[244:247], a[180:183]
v_mfma_f32_16x16x32_bf16 a[176:179], v[208:211], v[244:247], a[176:179]
s_add_u32 s72, s69, 47104
buffer_load_dwordx4 v2, s[8:11], s72 offen offset:2048 lds
v_mfma_f32_16x16x32_bf16 a[172:175], v[204:207], v[244:247], a[172:175]
v_mfma_f32_16x16x32_bf16 a[168:171], v[200:203], v[244:247], a[168:171]
v_mfma_f32_16x16x32_bf16 a[164:167], v[196:199], v[244:247], a[164:167]
v_mfma_f32_16x16x32_bf16 a[160:163], v[192:195], v[244:247], a[160:163]
s_add_u32 s72, s69, 54272
buffer_load_dwordx4 v3, s[8:11], s72 offen offset:3072 lds
v_mfma_f32_16x16x32_bf16 a[192:195], v[192:195], v[248:251], a[192:195]
v_mfma_f32_16x16x32_bf16 a[196:199], v[196:199], v[248:251], a[196:199]
v_mfma_f32_16x16x32_bf16 a[200:203], v[200:203], v[248:251], a[200:203]
v_mfma_f32_16x16x32_bf16 a[204:207], v[204:207], v[248:251], a[204:207]
s_add_u32 m0, s64, 16384
v_mfma_f32_16x16x32_bf16 a[208:211], v[208:211], v[248:251], a[208:211]
s_add_u32 s72, s71, 0
buffer_load_dwordx4 v6, s[20:23], s72 offen lds
v_mfma_f32_16x16x32_bf16 a[212:215], v[212:215], v[248:251], a[212:215]
v_mfma_f32_16x16x32_bf16 a[216:219], v[216:219], v[248:251], a[216:219]
v_mfma_f32_16x16x32_bf16 a[220:223], v[220:223], v[248:251], a[220:223]
v_mfma_f32_16x16x32_bf16 a[252:255], v[220:223], v[252:255], a[252:255]
s_add_u32 s72, s71, 31744
buffer_load_dwordx4 v6, s[20:23], s72 offen offset:1024 lds
v_mfma_f32_16x16x32_bf16 a[248:251], v[216:219], v[252:255], a[248:251]
v_mfma_f32_16x16x32_bf16 a[244:247], v[212:215], v[252:255], a[244:247]
v_mfma_f32_16x16x32_bf16 a[240:243], v[208:211], v[252:255], a[240:243]
v_mfma_f32_16x16x32_bf16 a[236:239], v[204:207], v[252:255], a[236:239]
s_add_u32 s72, s71, 63488
buffer_load_dwordx4 v7, s[20:23], s72 offen offset:2048 lds
v_mfma_f32_16x16x32_bf16 a[232:235], v[200:203], v[252:255], a[232:235]
v_mfma_f32_16x16x32_bf16 a[228:231], v[196:199], v[252:255], a[228:231]
v_mfma_f32_16x16x32_bf16 a[224:227], v[192:195], v[252:255], a[224:227]
s_waitcnt lgkmcnt(0)
v_mfma_f32_16x16x32_bf16 a[0:3], v[160:163], v[128:131], a[0:3]
s_add_u32 s72, s71, 95232
buffer_load_dwordx4 v7, s[20:23], s72 offen offset:3072 lds
v_mfma_f32_16x16x32_bf16 a[4:7], v[160:163], v[132:135], a[4:7]
s_mov_b32 s80, 0x200000
buffer_load_dword v126, v125, s[16:19], s80 offen
v_mfma_f32_16x16x32_bf16 a[8:11], v[160:163], v[136:139], a[8:11]
buffer_load_dword v126, v125, s[20:23], s80 offen
v_mfma_f32_16x16x32_bf16 a[12:15], v[160:163], v[140:143], a[12:15]
global_load_dwordx4 v[68:71], v30, s[52:53]
v_mfma_f32_16x16x32_bf16 a[16:19], v[160:163], v[144:147], a[16:19]
buffer_load_dword v33, v27, s[28:31], 0 offen nt
v_mfma_f32_16x16x32_bf16 a[20:23], v[160:163], v[148:151], a[20:23]
buffer_load_dword v34, v27, s[28:31], 0 offen offset:2048 nt
v_mfma_f32_16x16x32_bf16 a[24:27], v[160:163], v[152:155], a[24:27]
ds_read_b64_tr_b16 v[224:225], v20 offset:40960
v_add_u32 v27, 0x1000, v27
v_mfma_f32_16x16x32_bf16 a[28:31], v[160:163], v[156:159], a[28:31]
buffer_load_dword v35, v27, s[28:31], 0 offen nt
v_mfma_f32_16x16x32_bf16 a[60:63], v[164:167], v[156:159], a[60:63]
s_add_u32 m0, s63, 131072
ds_read_b64_tr_b16 v[226:227], v20 offset:41984
v_mfma_f32_16x16x32_bf16 a[56:59], v[164:167], v[152:155], a[56:59]
s_add_u32 s80, s82, 0
buffer_load_dwordx4 v26, s[28:31], s80 offen nt lds
v_mfma_f32_16x16x32_bf16 a[52:55], v[164:167], v[148:151], a[52:55]
s_add_u32 s80, s82, 15360
buffer_load_dwordx4 v26, s[28:31], s80 offen offset:1024 nt lds
v_mfma_f32_16x16x32_bf16 a[48:51], v[164:167], v[144:147], a[48:51]
s_add_u32 s80, s82, 30720
buffer_load_dwordx4 v26, s[28:31], s80 offen offset:2048 nt lds
v_mfma_f32_16x16x32_bf16 a[44:47], v[164:167], v[140:143], a[44:47]
s_add_u32 s80, s82, 46080
buffer_load_dwordx4 v26, s[28:31], s80 offen offset:3072 nt lds
v_mfma_f32_16x16x32_bf16 a[40:43], v[164:167], v[136:139], a[40:43]
ds_read_b128 v[192:195], v25 offset:32768
v_mfma_f32_16x16x32_bf16 a[36:39], v[164:167], v[132:135], a[36:39]
ds_read_b128 v[196:199], v25 offset:34816
v_mfma_f32_16x16x32_bf16 a[32:35], v[164:167], v[128:131], a[32:35]
ds_read_b128 v[200:203], v25 offset:36864
v_mfma_f32_16x16x32_bf16 a[64:67], v[168:171], v[128:131], a[64:67]
ds_read_b128 v[204:207], v25 offset:38912
v_mfma_f32_16x16x32_bf16 a[68:71], v[168:171], v[132:135], a[68:71]
ds_read_b128 v[208:211], v25 offset:40960
v_mfma_f32_16x16x32_bf16 a[72:75], v[168:171], v[136:139], a[72:75]
ds_read_b128 v[212:215], v25 offset:43008
v_mfma_f32_16x16x32_bf16 a[76:79], v[168:171], v[140:143], a[76:79]
ds_read_b128 v[216:219], v25 offset:45056
v_mfma_f32_16x16x32_bf16 a[80:83], v[168:171], v[144:147], a[80:83]
ds_read_b128 v[220:223], v25 offset:47104
v_mfma_f32_16x16x32_bf16 a[84:87], v[168:171], v[148:151], a[84:87]
ds_read_b64_tr_b16 v[228:229], v21 offset:40960
v_mfma_f32_16x16x32_bf16 a[88:91], v[168:171], v[152:155], a[88:91]
ds_read_b64_tr_b16 v[230:231], v21 offset:41984
v_mfma_f32_16x16x32_bf16 a[92:95], v[168:171], v[156:159], a[92:95]
ds_read_b64_tr_b16 v[232:233], v22 offset:40960
v_mfma_f32_16x16x32_bf16 a[124:127], v[172:175], v[156:159], a[124:127]
ds_read_b64_tr_b16 v[234:235], v22 offset:41984
v_mfma_f32_16x16x32_bf16 a[120:123], v[172:175], v[152:155], a[120:123]
ds_read_b64_tr_b16 v[236:237], v23 offset:40960
v_mfma_f32_16x16x32_bf16 a[116:119], v[172:175], v[148:151], a[116:119]
ds_read_b64_tr_b16 v[238:239], v23 offset:41984
v_mfma_f32_16x16x32_bf16 a[112:115], v[172:175], v[144:147], a[112:115]
ds_read_b64_tr_b16 v[240:241], v20 offset:57344
v_mfma_f32_16x16x32_bf16 a[108:111], v[172:175], v[140:143], a[108:111]
ds_read_b64_tr_b16 v[242:243], v20 offset:58368
v_mfma_f32_16x16x32_bf16 a[104:107], v[172:175], v[136:139], a[104:107]
ds_read_b64_tr_b16 v[244:245], v21 offset:57344
v_mfma_f32_16x16x32_bf16 a[100:103], v[172:175], v[132:135], a[100:103]
ds_read_b64_tr_b16 v[246:247], v21 offset:58368
v_mfma_f32_16x16x32_bf16 a[96:99], v[172:175], v[128:131], a[96:99]
ds_read_b64_tr_b16 v[248:249], v22 offset:57344
v_mfma_f32_16x16x32_bf16 a[128:131], v[128:131], v[176:179], a[128:131]
ds_read_b64_tr_b16 v[250:251], v22 offset:58368
v_mfma_f32_16x16x32_bf16 a[132:135], v[132:135], v[176:179], a[132:135]
ds_read_b64_tr_b16 v[252:253], v23 offset:57344
v_mfma_f32_16x16x32_bf16 a[136:139], v[136:139], v[176:179], a[136:139]
ds_read_b64_tr_b16 v[254:255], v23 offset:58368
v_mfma_f32_16x16x32_bf16 a[140:143], v[140:143], v[176:179], a[140:143]
v_mfma_f32_16x16x32_bf16 a[144:147], v[144:147], v[176:179], a[144:147]
v_mfma_f32_16x16x32_bf16 a[148:151], v[148:151], v[176:179], a[148:151]
v_mfma_f32_16x16x32_bf16 a[152:155], v[152:155], v[176:179], a[152:155]
v_mfma_f32_16x16x32_bf16 a[156:159], v[156:159], v[176:179], a[156:159]
v_mfma_f32_16x16x32_bf16 a[188:191], v[156:159], v[180:183], a[188:191]
v_mfma_f32_16x16x32_bf16 a[184:187], v[152:155], v[180:183], a[184:187]
v_mfma_f32_16x16x32_bf16 a[180:183], v[148:151], v[180:183], a[180:183]
v_mfma_f32_16x16x32_bf16 a[176:179], v[144:147], v[180:183], a[176:179]
v_mfma_f32_16x16x32_bf16 a[172:175], v[140:143], v[180:183], a[172:175]
v_mfma_f32_16x16x32_bf16 a[168:171], v[136:139], v[180:183], a[168:171]
v_mfma_f32_16x16x32_bf16 a[164:167], v[132:135], v[180:183], a[164:167]
v_mfma_f32_16x16x32_bf16 a[160:163], v[128:131], v[180:183], a[160:163]
v_mfma_f32_16x16x32_bf16 a[192:195], v[128:131], v[184:187], a[192:195]
v_mfma_f32_16x16x32_bf16 a[196:199], v[132:135], v[184:187], a[196:199]
v_mfma_f32_16x16x32_bf16 a[200:203], v[136:139], v[184:187], a[200:203]
v_mfma_f32_16x16x32_bf16 a[204:207], v[140:143], v[184:187], a[204:207]
v_mfma_f32_16x16x32_bf16 a[208:211], v[144:147], v[184:187], a[208:211]
v_mfma_f32_16x16x32_bf16 a[212:215], v[148:151], v[184:187], a[212:215]
v_mfma_f32_16x16x32_bf16 a[216:219], v[152:155], v[184:187], a[216:219]
v_mfma_f32_16x16x32_bf16 a[220:223], v[156:159], v[184:187], a[220:223]
v_mfma_f32_16x16x32_bf16 a[252:255], v[156:159], v[188:191], a[252:255]
v_mfma_f32_16x16x32_bf16 a[248:251], v[152:155], v[188:191], a[248:251]
v_mfma_f32_16x16x32_bf16 a[244:247], v[148:151], v[188:191], a[244:247]
v_mfma_f32_16x16x32_bf16 a[240:243], v[144:147], v[188:191], a[240:243]
v_mfma_f32_16x16x32_bf16 a[236:239], v[140:143], v[188:191], a[236:239]
v_mfma_f32_16x16x32_bf16 a[232:235], v[136:139], v[188:191], a[232:235]
v_mfma_f32_16x16x32_bf16 a[228:231], v[132:135], v[188:191], a[228:231]
s_waitcnt vmcnt(10) lgkmcnt(0)
v_mfma_f32_16x16x32_bf16 a[224:227], v[128:131], v[188:191], a[224:227]
s_barrier
v_mfma_f32_16x16x32_bf16 a[0:3], v[224:227], v[192:195], a[0:3]
s_and_b32 s73, s65, 1
ds_read_b64_tr_b16 v[160:161], v20 offset:0
v_mfma_f32_16x16x32_bf16 a[4:7], v[224:227], v[196:199], a[4:7]
s_xor_b32 s73, s73, 3
ds_read_b64_tr_b16 v[162:163], v20 offset:1024
v_mfma_f32_16x16x32_bf16 a[8:11], v[224:227], v[200:203], a[8:11]
s_lshl_b32 s69, s73, 7
ds_read_b128 v[128:131], v24 offset:0
v_mfma_f32_16x16x32_bf16 a[12:15], v[224:227], v[204:207], a[12:15]
s_add_u32 s69, s69, s67
ds_read_b128 v[132:135], v24 offset:2048
v_mfma_f32_16x16x32_bf16 a[16:19], v[224:227], v[208:211], a[16:19]
s_lshl_b32 s71, s73, 19
ds_read_b128 v[136:139], v24 offset:4096
v_mfma_f32_16x16x32_bf16 a[20:23], v[224:227], v[212:215], a[20:23]
s_add_u32 s71, s71, s66
ds_read_b128 v[140:143], v24 offset:6144
v_mfma_f32_16x16x32_bf16 a[24:27], v[224:227], v[216:219], a[24:27]
s_add_u32 m0, s63, 98304
ds_read_b128 v[144:147], v24 offset:8192
v_mfma_f32_16x16x32_bf16 a[28:31], v[224:227], v[220:223], a[28:31]
s_add_u32 s72, s69, 0
buffer_load_dwordx4 v2, s[8:11], s72 offen lds
v_mfma_f32_16x16x32_bf16 a[60:63], v[228:231], v[220:223], a[60:63]
s_add_u32 s72, s69, 7168
buffer_load_dwordx4 v3, s[8:11], s72 offen offset:1024 lds
v_mfma_f32_16x16x32_bf16 a[56:59], v[228:231], v[216:219], a[56:59]
s_add_u32 s72, s69, 14336
buffer_load_dwordx4 v2, s[8:11], s72 offen offset:2048 lds
v_mfma_f32_16x16x32_bf16 a[52:55], v[228:231], v[212:215], a[52:55]
ds_read_b128 v[148:151], v24 offset:10240
v_mfma_f32_16x16x32_bf16 a[48:51], v[228:231], v[208:211], a[48:51]
ds_read_b128 v[152:155], v24 offset:12288
v_mfma_f32_16x16x32_bf16 a[44:47], v[228:231], v[204:207], a[44:47]
s_add_u32 s72, s69, 21504
buffer_load_dwordx4 v3, s[8:11], s72 offen offset:3072 lds
v_mfma_f32_16x16x32_bf16 a[40:43], v[228:231], v[200:203], a[40:43]
ds_read_b128 v[156:159], v24 offset:14336
v_mfma_f32_16x16x32_bf16 a[36:39], v[228:231], v[196:199], a[36:39]
ds_read_b64_tr_b16 v[164:165], v21 offset:0
v_mfma_f32_16x16x32_bf16 a[32:35], v[228:231], v[192:195], a[32:35]
ds_read_b64_tr_b16 v[166:167], v21 offset:1024
v_mfma_f32_16x16x32_bf16 a[64:67], v[232:235], v[192:195], a[64:67]
ds_read_b64_tr_b16 v[168:169], v22 offset:0
v_mfma_f32_16x16x32_bf16 a[68:71], v[232:235], v[196:199], a[68:71]
s_add_u32 m0, s64, 32768
ds_read_b64_tr_b16 v[170:171], v22 offset:1024
v_mfma_f32_16x16x32_bf16 a[72:75], v[232:235], v[200:203], a[72:75]
s_add_u32 s72, s71, 0
buffer_load_dwordx4 v6, s[16:19], s72 offen lds
v_mfma_f32_16x16x32_bf16 a[76:79], v[232:235], v[204:207], a[76:79]
ds_read_b64_tr_b16 v[172:173], v23 offset:0
v_mfma_f32_16x16x32_bf16 a[80:83], v[232:235], v[208:211], a[80:83]
ds_read_b64_tr_b16 v[174:175], v23 offset:1024
v_mfma_f32_16x16x32_bf16 a[84:87], v[232:235], v[212:215], a[84:87]
s_add_u32 s72, s71, 31744
buffer_load_dwordx4 v6, s[16:19], s72 offen offset:1024 lds
v_mfma_f32_16x16x32_bf16 a[88:91], v[232:235], v[216:219], a[88:91]
ds_read_b64_tr_b16 v[176:177], v20 offset:16384
v_mfma_f32_16x16x32_bf16 a[92:95], v[232:235], v[220:223], a[92:95]
ds_read_b64_tr_b16 v[178:179], v20 offset:17408
v_mfma_f32_16x16x32_bf16 a[124:127], v[236:239], v[220:223], a[124:127]
ds_read_b64_tr_b16 v[180:181], v21 offset:16384
v_mfma_f32_16x16x32_bf16 a[120:123], v[236:239], v[216:219], a[120:123]
s_add_u32 s72, s71, 63488
buffer_load_dwordx4 v7, s[16:19], s72 offen offset:2048 lds
v_mfma_f32_16x16x32_bf16 a[116:119], v[236:239], v[212:215], a[116:119]
ds_read_b64_tr_b16 v[182:183], v21 offset:17408
v_mfma_f32_16x16x32_bf16 a[112:115], v[236:239], v[208:211], a[112:115]
ds_read_b64_tr_b16 v[184:185], v22 offset:16384
v_mfma_f32_16x16x32_bf16 a[108:111], v[236:239], v[204:207], a[108:111]
ds_read_b64_tr_b16 v[186:187], v22 offset:17408
v_mfma_f32_16x16x32_bf16 a[104:107], v[236:239], v[200:203], a[104:107]
ds_read_b64_tr_b16 v[188:189], v23 offset:16384
v_mfma_f32_16x16x32_bf16 a[100:103], v[236:239], v[196:199], a[100:103]
s_add_u32 s72, s71, 95232
buffer_load_dwordx4 v7, s[16:19], s72 offen offset:3072 lds
v_mfma_f32_16x16x32_bf16 a[96:99], v[236:239], v[192:195], a[96:99]
ds_read_b64_tr_b16 v[190:191], v23 offset:17408
v_mfma_f32_16x16x32_bf16 a[128:131], v[192:195], v[240:243], a[128:131]
v_mfma_f32_16x16x32_bf16 a[132:135], v[196:199], v[240:243], a[132:135]
v_mfma_f32_16x16x32_bf16 a[136:139], v[200:203], v[240:243], a[136:139]
s_add_u32 m0, s63, 102400
v_mfma_f32_16x16x32_bf16 a[140:143], v[204:207], v[240:243], a[140:143]
s_add_u32 s72, s69, 32768
buffer_load_dwordx4 v2, s[8:11], s72 offen lds
v_mfma_f32_16x16x32_bf16 a[144:147], v[208:211], v[240:243], a[144:147]
v_mfma_f32_16x16x32_bf16 a[148:151], v[212:215], v[240:243], a[148:151]
v_mfma_f32_16x16x32_bf16 a[152:155], v[216:219], v[240:243], a[152:155]
s_add_u32 s72, s69, 39936
buffer_load_dwordx4 v3, s[8:11], s72 offen offset:1024 lds
v_mfma_f32_16x16x32_bf16 a[156:159], v[220:223], v[240:243], a[156:159]
v_mfma_f32_16x16x32_bf16 a[188:191], v[220:223], v[244:247], a[188:191]
v_mfma_f32_16x16x32_bf16 a[184:187], v[216:219], v[244:247], a[184:187]
v_mfma_f32_16x16x32_bf16 a[180:183], v[212:215], v[244:247], a[180:183]
v_mfma_f32_16x16x32_bf16 a[176:179], v[208:211], v[244:247], a[176:179]
s_add_u32 s72, s69, 47104
buffer_load_dwordx4 v2, s[8:11], s72 offen offset:2048 lds
v_mfma_f32_16x16x32_bf16 a[172:175], v[204:207], v[244:247], a[172:175]
v_mfma_f32_16x16x32_bf16 a[168:171], v[200:203], v[244:247], a[168:171]
v_mfma_f32_16x16x32_bf16 a[164:167], v[196:199], v[244:247], a[164:167]
v_mfma_f32_16x16x32_bf16 a[160:163], v[192:195], v[244:247], a[160:163]
s_add_u32 s72, s69, 54272
buffer_load_dwordx4 v3, s[8:11], s72 offen offset:3072 lds
v_mfma_f32_16x16x32_bf16 a[192:195], v[192:195], v[248:251], a[192:195]
v_mfma_f32_16x16x32_bf16 a[196:199], v[196:199], v[248:251], a[196:199]
v_mfma_f32_16x16x32_bf16 a[200:203], v[200:203], v[248:251], a[200:203]
v_mfma_f32_16x16x32_bf16 a[204:207], v[204:207], v[248:251], a[204:207]
s_add_u32 m0, s64, 49152
v_mfma_f32_16x16x32_bf16 a[208:211], v[208:211], v[248:251], a[208:211]
s_add_u32 s72, s71, 0
buffer_load_dwordx4 v6, s[20:23], s72 offen lds
v_mfma_f32_16x16x32_bf16 a[212:215], v[212:215], v[248:251], a[212:215]
v_mfma_f32_16x16x32_bf16 a[216:219], v[216:219], v[248:251], a[216:219]
v_mfma_f32_16x16x32_bf16 a[220:223], v[220:223], v[248:251], a[220:223]
v_mfma_f32_16x16x32_bf16 a[252:255], v[220:223], v[252:255], a[252:255]
s_add_u32 s72, s71, 31744
buffer_load_dwordx4 v6, s[20:23], s72 offen offset:1024 lds
v_mfma_f32_16x16x32_bf16 a[248:251], v[216:219], v[252:255], a[248:251]
v_mfma_f32_16x16x32_bf16 a[244:247], v[212:215], v[252:255], a[244:247]
v_mfma_f32_16x16x32_bf16 a[240:243], v[208:211], v[252:255], a[240:243]
v_mfma_f32_16x16x32_bf16 a[236:239], v[204:207], v[252:255], a[236:239]
s_add_u32 s72, s71, 63488
buffer_load_dwordx4 v7, s[20:23], s72 offen offset:2048 lds
v_mfma_f32_16x16x32_bf16 a[232:235], v[200:203], v[252:255], a[232:235]
v_mfma_f32_16x16x32_bf16 a[228:231], v[196:199], v[252:255], a[228:231]
v_mfma_f32_16x16x32_bf16 a[224:227], v[192:195], v[252:255], a[224:227]
s_waitcnt lgkmcnt(0)
v_mfma_f32_16x16x32_bf16 a[0:3], v[160:163], v[128:131], a[0:3]
s_add_u32 s72, s71, 95232
buffer_load_dwordx4 v7, s[20:23], s72 offen offset:3072 lds
v_mfma_f32_16x16x32_bf16 a[4:7], v[160:163], v[132:135], a[4:7]
s_mov_b32 s80, 0x300000
buffer_load_dword v126, v125, s[16:19], s80 offen
v_mfma_f32_16x16x32_bf16 a[8:11], v[160:163], v[136:139], a[8:11]
buffer_load_dword v126, v125, s[20:23], s80 offen
v_mfma_f32_16x16x32_bf16 a[12:15], v[160:163], v[140:143], a[12:15]
s_add_u32 m0, s63, 135168
ds_read_b64_tr_b16 v[224:225], v20 offset:8192
v_mfma_f32_16x16x32_bf16 a[16:19], v[160:163], v[144:147], a[16:19]
s_add_u32 s80, s82, 0
buffer_load_dwordx4 v26, s[32:35], s80 offen nt lds
v_mfma_f32_16x16x32_bf16 a[20:23], v[160:163], v[148:151], a[20:23]
s_add_u32 s80, s82, 15360
buffer_load_dwordx4 v26, s[32:35], s80 offen offset:1024 nt lds
v_mfma_f32_16x16x32_bf16 a[24:27], v[160:163], v[152:155], a[24:27]
s_add_u32 s80, s82, 30720
buffer_load_dwordx4 v26, s[32:35], s80 offen offset:2048 nt lds
v_mfma_f32_16x16x32_bf16 a[28:31], v[160:163], v[156:159], a[28:31]
s_add_u32 s80, s82, 46080
buffer_load_dwordx4 v26, s[32:35], s80 offen offset:3072 nt lds
v_mfma_f32_16x16x32_bf16 a[60:63], v[164:167], v[156:159], a[60:63]
ds_read_b64_tr_b16 v[226:227], v20 offset:9216
v_mfma_f32_16x16x32_bf16 a[56:59], v[164:167], v[152:155], a[56:59]
ds_read_b128 v[192:195], v25 offset:0
v_mfma_f32_16x16x32_bf16 a[52:55], v[164:167], v[148:151], a[52:55]
ds_read_b128 v[196:199], v25 offset:2048
v_mfma_f32_16x16x32_bf16 a[48:51], v[164:167], v[144:147], a[48:51]
ds_read_b128 v[200:203], v25 offset:4096
v_mfma_f32_16x16x32_bf16 a[44:47], v[164:167], v[140:143], a[44:47]
ds_read_b128 v[204:207], v25 offset:6144
v_mfma_f32_16x16x32_bf16 a[40:43], v[164:167], v[136:139], a[40:43]
ds_read_b128 v[208:211], v25 offset:8192
v_mfma_f32_16x16x32_bf16 a[36:39], v[164:167], v[132:135], a[36:39]
ds_read_b128 v[212:215], v25 offset:10240
v_mfma_f32_16x16x32_bf16 a[32:35], v[164:167], v[128:131], a[32:35]
ds_read_b128 v[216:219], v25 offset:12288
v_mfma_f32_16x16x32_bf16 a[64:67], v[168:171], v[128:131], a[64:67]
ds_read_b128 v[220:223], v25 offset:14336
v_mfma_f32_16x16x32_bf16 a[68:71], v[168:171], v[132:135], a[68:71]
ds_read_b64_tr_b16 v[228:229], v21 offset:8192
v_mfma_f32_16x16x32_bf16 a[72:75], v[168:171], v[136:139], a[72:75]
ds_read_b64_tr_b16 v[230:231], v21 offset:9216
v_mfma_f32_16x16x32_bf16 a[76:79], v[168:171], v[140:143], a[76:79]
ds_read_b64_tr_b16 v[232:233], v22 offset:8192
v_mfma_f32_16x16x32_bf16 a[80:83], v[168:171], v[144:147], a[80:83]
ds_read_b64_tr_b16 v[234:235], v22 offset:9216
v_mfma_f32_16x16x32_bf16 a[84:87], v[168:171], v[148:151], a[84:87]
ds_read_b64_tr_b16 v[236:237], v23 offset:8192
v_mfma_f32_16x16x32_bf16 a[88:91], v[168:171], v[152:155], a[88:91]
ds_read_b64_tr_b16 v[238:239], v23 offset:9216
v_mfma_f32_16x16x32_bf16 a[92:95], v[168:171], v[156:159], a[92:95]
ds_read_b64_tr_b16 v[240:241], v20 offset:24576
v_mfma_f32_16x16x32_bf16 a[124:127], v[172:175], v[156:159], a[124:127]
ds_read_b64_tr_b16 v[242:243], v20 offset:25600
v_mfma_f32_16x16x32_bf16 a[120:123], v[172:175], v[152:155], a[120:123]
ds_read_b64_tr_b16 v[244:245], v21 offset:24576
v_mfma_f32_16x16x32_bf16 a[116:119], v[172:175], v[148:151], a[116:119]
ds_read_b64_tr_b16 v[246:247], v21 offset:25600
v_mfma_f32_16x16x32_bf16 a[112:115], v[172:175], v[144:147], a[112:115]
ds_read_b64_tr_b16 v[248:249], v22 offset:24576
v_mfma_f32_16x16x32_bf16 a[108:111], v[172:175], v[140:143], a[108:111]
ds_read_b64_tr_b16 v[250:251], v22 offset:25600
v_mfma_f32_16x16x32_bf16 a[104:107], v[172:175], v[136:139], a[104:107]
ds_read_b64_tr_b16 v[252:253], v23 offset:24576
v_mfma_f32_16x16x32_bf16 a[100:103], v[172:175], v[132:135], a[100:103]
ds_read_b64_tr_b16 v[254:255], v23 offset:25600
v_mfma_f32_16x16x32_bf16 a[96:99], v[172:175], v[128:131], a[96:99]
v_mfma_f32_16x16x32_bf16 a[128:131], v[128:131], v[176:179], a[128:131]
v_mfma_f32_16x16x32_bf16 a[132:135], v[132:135], v[176:179], a[132:135]
v_mfma_f32_16x16x32_bf16 a[136:139], v[136:139], v[176:179], a[136:139]
v_mfma_f32_16x16x32_bf16 a[140:143], v[140:143], v[176:179], a[140:143]
v_mfma_f32_16x16x32_bf16 a[144:147], v[144:147], v[176:179], a[144:147]
v_mfma_f32_16x16x32_bf16 a[148:151], v[148:151], v[176:179], a[148:151]
v_mfma_f32_16x16x32_bf16 a[152:155], v[152:155], v[176:179], a[152:155]
v_mfma_f32_16x16x32_bf16 a[156:159], v[156:159], v[176:179], a[156:159]
v_mfma_f32_16x16x32_bf16 a[188:191], v[156:159], v[180:183], a[188:191]
v_mfma_f32_16x16x32_bf16 a[184:187], v[152:155], v[180:183], a[184:187]
v_mfma_f32_16x16x32_bf16 a[180:183], v[148:151], v[180:183], a[180:183]
v_mfma_f32_16x16x32_bf16 a[176:179], v[144:147], v[180:183], a[176:179]
v_mfma_f32_16x16x32_bf16 a[172:175], v[140:143], v[180:183], a[172:175]
v_mfma_f32_16x16x32_bf16 a[168:171], v[136:139], v[180:183], a[168:171]
v_mfma_f32_16x16x32_bf16 a[164:167], v[132:135], v[180:183], a[164:167]
v_mfma_f32_16x16x32_bf16 a[160:163], v[128:131], v[180:183], a[160:163]
v_mfma_f32_16x16x32_bf16 a[192:195], v[128:131], v[184:187], a[192:195]
v_mfma_f32_16x16x32_bf16 a[196:199], v[132:135], v[184:187], a[196:199]
v_mfma_f32_16x16x32_bf16 a[200:203], v[136:139], v[184:187], a[200:203]
v_mfma_f32_16x16x32_bf16 a[204:207], v[140:143], v[184:187], a[204:207]
v_mfma_f32_16x16x32_bf16 a[208:211], v[144:147], v[184:187], a[208:211]
v_mfma_f32_16x16x32_bf16 a[212:215], v[148:151], v[184:187], a[212:215]
v_mfma_f32_16x16x32_bf16 a[216:219], v[152:155], v[184:187], a[216:219]
v_mfma_f32_16x16x32_bf16 a[220:223], v[156:159], v[184:187], a[220:223]
v_mfma_f32_16x16x32_bf16 a[252:255], v[156:159], v[188:191], a[252:255]
v_mfma_f32_16x16x32_bf16 a[248:251], v[152:155], v[188:191], a[248:251]
v_mfma_f32_16x16x32_bf16 a[244:247], v[148:151], v[188:191], a[244:247]
v_mfma_f32_16x16x32_bf16 a[240:243], v[144:147], v[188:191], a[240:243]
v_mfma_f32_16x16x32_bf16 a[236:239], v[140:143], v[188:191], a[236:239]
v_mfma_f32_16x16x32_bf16 a[232:235], v[136:139], v[188:191], a[232:235]
v_mfma_f32_16x16x32_bf16 a[228:231], v[132:135], v[188:191], a[228:231]
s_waitcnt vmcnt(6) lgkmcnt(0)
v_mfma_f32_16x16x32_bf16 a[224:227], v[128:131], v[188:191], a[224:227]
s_barrier
v_mfma_f32_16x16x32_bf16 a[0:3], v[224:227], v[192:195], a[0:3]
s_and_b32 s73, s65, 1
ds_read_b64_tr_b16 v[160:161], v20 offset:32768
v_mfma_f32_16x16x32_bf16 a[4:7], v[224:227], v[196:199], a[4:7]
s_xor_b32 s73, s73, 4
ds_read_b64_tr_b16 v[162:163], v20 offset:33792
v_mfma_f32_16x16x32_bf16 a[8:11], v[224:227], v[200:203], a[8:11]
s_lshl_b32 s69, s73, 7
ds_read_b128 v[128:131], v24 offset:32768
v_mfma_f32_16x16x32_bf16 a[12:15], v[224:227], v[204:207], a[12:15]
s_add_u32 s69, s69, s67
ds_read_b128 v[132:135], v24 offset:34816
v_mfma_f32_16x16x32_bf16 a[16:19], v[224:227], v[208:211], a[16:19]
s_lshl_b32 s71, s73, 19
ds_read_b128 v[136:139], v24 offset:36864
v_mfma_f32_16x16x32_bf16 a[20:23], v[224:227], v[212:215], a[20:23]
s_add_u32 s71, s71, s66
ds_read_b128 v[140:143], v24 offset:38912
v_mfma_f32_16x16x32_bf16 a[24:27], v[224:227], v[216:219], a[24:27]
s_add_u32 m0, s63, 65536
ds_read_b128 v[144:147], v24 offset:40960
v_mfma_f32_16x16x32_bf16 a[28:31], v[224:227], v[220:223], a[28:31]
s_add_u32 s72, s69, 0
buffer_load_dwordx4 v2, s[8:11], s72 offen lds
v_mfma_f32_16x16x32_bf16 a[60:63], v[228:231], v[220:223], a[60:63]
s_add_u32 s72, s69, 7168
buffer_load_dwordx4 v3, s[8:11], s72 offen offset:1024 lds
v_mfma_f32_16x16x32_bf16 a[56:59], v[228:231], v[216:219], a[56:59]
s_add_u32 s72, s69, 14336
buffer_load_dwordx4 v2, s[8:11], s72 offen offset:2048 lds
v_mfma_f32_16x16x32_bf16 a[52:55], v[228:231], v[212:215], a[52:55]
ds_read_b128 v[148:151], v24 offset:43008
v_mfma_f32_16x16x32_bf16 a[48:51], v[228:231], v[208:211], a[48:51]
ds_read_b128 v[152:155], v24 offset:45056
v_mfma_f32_16x16x32_bf16 a[44:47], v[228:231], v[204:207], a[44:47]
s_add_u32 s72, s69, 21504
buffer_load_dwordx4 v3, s[8:11], s72 offen offset:3072 lds
v_mfma_f32_16x16x32_bf16 a[40:43], v[228:231], v[200:203], a[40:43]
ds_read_b128 v[156:159], v24 offset:47104
v_mfma_f32_16x16x32_bf16 a[36:39], v[228:231], v[196:199], a[36:39]
ds_read_b64_tr_b16 v[164:165], v21 offset:32768
v_mfma_f32_16x16x32_bf16 a[32:35], v[228:231], v[192:195], a[32:35]
ds_read_b64_tr_b16 v[166:167], v21 offset:33792
v_mfma_f32_16x16x32_bf16 a[64:67], v[232:235], v[192:195], a[64:67]
ds_read_b64_tr_b16 v[168:169], v22 offset:32768
v_mfma_f32_16x16x32_bf16 a[68:71], v[232:235], v[196:199], a[68:71]
s_add_u32 m0, s64, 0
ds_read_b64_tr_b16 v[170:171], v22 offset:33792
v_mfma_f32_16x16x32_bf16 a[72:75], v[232:235], v[200:203], a[72:75]
s_add_u32 s72, s71, 0
buffer_load_dwordx4 v6, s[16:19], s72 offen lds
v_mfma_f32_16x16x32_bf16 a[76:79], v[232:235], v[204:207], a[76:79]
ds_read_b64_tr_b16 v[172:173], v23 offset:32768
v_mfma_f32_16x16x32_bf16 a[80:83], v[232:235], v[208:211], a[80:83]
ds_read_b64_tr_b16 v[174:175], v23 offset:33792
v_mfma_f32_16x16x32_bf16 a[84:87], v[232:235], v[212:215], a[84:87]
s_add_u32 s72, s71, 31744
buffer_load_dwordx4 v6, s[16:19], s72 offen offset:1024 lds
v_mfma_f32_16x16x32_bf16 a[88:91], v[232:235], v[216:219], a[88:91]
ds_read_b64_tr_b16 v[176:177], v20 offset:49152
v_mfma_f32_16x16x32_bf16 a[92:95], v[232:235], v[220:223], a[92:95]
ds_read_b64_tr_b16 v[178:179], v20 offset:50176
v_mfma_f32_16x16x32_bf16 a[124:127], v[236:239], v[220:223], a[124:127]
ds_read_b64_tr_b16 v[180:181], v21 offset:49152
v_mfma_f32_16x16x32_bf16 a[120:123], v[236:239], v[216:219], a[120:123]
s_add_u32 s72, s71, 63488
buffer_load_dwordx4 v7, s[16:19], s72 offen offset:2048 lds
v_mfma_f32_16x16x32_bf16 a[116:119], v[236:239], v[212:215], a[116:119]
ds_read_b64_tr_b16 v[182:183], v21 offset:50176
v_mfma_f32_16x16x32_bf16 a[112:115], v[236:239], v[208:211], a[112:115]
ds_read_b64_tr_b16 v[184:185], v22 offset:49152
v_mfma_f32_16x16x32_bf16 a[108:111], v[236:239], v[204:207], a[108:111]
ds_read_b64_tr_b16 v[186:187], v22 offset:50176
v_mfma_f32_16x16x32_bf16 a[104:107], v[236:239], v[200:203], a[104:107]
ds_read_b64_tr_b16 v[188:189], v23 offset:49152
v_mfma_f32_16x16x32_bf16 a[100:103], v[236:239], v[196:199], a[100:103]
s_add_u32 s72, s71, 95232
buffer_load_dwordx4 v7, s[16:19], s72 offen offset:3072 lds
v_mfma_f32_16x16x32_bf16 a[96:99], v[236:239], v[192:195], a[96:99]
ds_read_b64_tr_b16 v[190:191], v23 offset:50176
v_mfma_f32_16x16x32_bf16 a[128:131], v[192:195], v[240:243], a[128:131]
v_mfma_f32_16x16x32_bf16 a[132:135], v[196:199], v[240:243], a[132:135]
v_mfma_f32_16x16x32_bf16 a[136:139], v[200:203], v[240:243], a[136:139]
s_add_u32 m0, s63, 69632
v_mfma_f32_16x16x32_bf16 a[140:143], v[204:207], v[240:243], a[140:143]
s_add_u32 s72, s69, 32768
buffer_load_dwordx4 v2, s[8:11], s72 offen lds
v_mfma_f32_16x16x32_bf16 a[144:147], v[208:211], v[240:243], a[144:147]
v_mfma_f32_16x16x32_bf16 a[148:151], v[212:215], v[240:243], a[148:151]
v_mfma_f32_16x16x32_bf16 a[152:155], v[216:219], v[240:243], a[152:155]
s_add_u32 s72, s69, 39936
buffer_load_dwordx4 v3, s[8:11], s72 offen offset:1024 lds
v_mfma_f32_16x16x32_bf16 a[156:159], v[220:223], v[240:243], a[156:159]
v_mfma_f32_16x16x32_bf16 a[188:191], v[220:223], v[244:247], a[188:191]
v_mfma_f32_16x16x32_bf16 a[184:187], v[216:219], v[244:247], a[184:187]
v_mfma_f32_16x16x32_bf16 a[180:183], v[212:215], v[244:247], a[180:183]
v_mfma_f32_16x16x32_bf16 a[176:179], v[208:211], v[244:247], a[176:179]
s_add_u32 s72, s69, 47104
buffer_load_dwordx4 v2, s[8:11], s72 offen offset:2048 lds
v_mfma_f32_16x16x32_bf16 a[172:175], v[204:207], v[244:247], a[172:175]
v_mfma_f32_16x16x32_bf16 a[168:171], v[200:203], v[244:247], a[168:171]
v_mfma_f32_16x16x32_bf16 a[164:167], v[196:199], v[244:247], a[164:167]
v_mfma_f32_16x16x32_bf16 a[160:163], v[192:195], v[244:247], a[160:163]
s_add_u32 s72, s69, 54272
buffer_load_dwordx4 v3, s[8:11], s72 offen offset:3072 lds
v_mfma_f32_16x16x32_bf16 a[192:195], v[192:195], v[248:251], a[192:195]
v_mfma_f32_16x16x32_bf16 a[196:199], v[196:199], v[248:251], a[196:199]
v_mfma_f32_16x16x32_bf16 a[200:203], v[200:203], v[248:251], a[200:203]
v_mfma_f32_16x16x32_bf16 a[204:207], v[204:207], v[248:251], a[204:207]
s_add_u32 m0, s64, 16384
v_mfma_f32_16x16x32_bf16 a[208:211], v[208:211], v[248:251], a[208:211]
s_add_u32 s72, s71, 0
buffer_load_dwordx4 v6, s[20:23], s72 offen lds
v_mfma_f32_16x16x32_bf16 a[212:215], v[212:215], v[248:251], a[212:215]
v_mfma_f32_16x16x32_bf16 a[216:219], v[216:219], v[248:251], a[216:219]
v_mfma_f32_16x16x32_bf16 a[220:223], v[220:223], v[248:251], a[220:223]
v_mfma_f32_16x16x32_bf16 a[252:255], v[220:223], v[252:255], a[252:255]
s_add_u32 s72, s71, 31744
buffer_load_dwordx4 v6, s[20:23], s72 offen offset:1024 lds
v_mfma_f32_16x16x32_bf16 a[248:251], v[216:219], v[252:255], a[248:251]
v_mfma_f32_16x16x32_bf16 a[244:247], v[212:215], v[252:255], a[244:247]
v_mfma_f32_16x16x32_bf16 a[240:243], v[208:211], v[252:255], a[240:243]
v_mfma_f32_16x16x32_bf16 a[236:239], v[204:207], v[252:255], a[236:239]
s_add_u32 s72, s71, 63488
buffer_load_dwordx4 v7, s[20:23], s72 offen offset:2048 lds
v_mfma_f32_16x16x32_bf16 a[232:235], v[200:203], v[252:255], a[232:235]
v_mfma_f32_16x16x32_bf16 a[228:231], v[196:199], v[252:255], a[228:231]
v_mfma_f32_16x16x32_bf16 a[224:227], v[192:195], v[252:255], a[224:227]
s_waitcnt lgkmcnt(0)
v_mfma_f32_16x16x32_bf16 a[0:3], v[160:163], v[128:131], a[0:3]
s_add_u32 s72, s71, 95232
buffer_load_dwordx4 v7, s[20:23], s72 offen offset:3072 lds
v_mfma_f32_16x16x32_bf16 a[4:7], v[160:163], v[132:135], a[4:7]
buffer_load_dwordx4 v[108:111], v1, s[4:7], s76 offen
v_mfma_f32_16x16x32_bf16 a[8:11], v[160:163], v[136:139], a[8:11]
buffer_load_dwordx4 v[112:115], v1, s[4:7], s76 offen offset:1024
v_mfma_f32_16x16x32_bf16 a[12:15], v[160:163], v[140:143], a[12:15]
buffer_load_dwordx4 v[116:119], v1, s[4:7], s76 offen offset:2048
v_mfma_f32_16x16x32_bf16 a[16:19], v[160:163], v[144:147], a[16:19]
buffer_load_dwordx4 v[120:123], v1, s[4:7], s76 offen offset:3072
v_mfma_f32_16x16x32_bf16 a[20:23], v[160:163], v[148:151], a[20:23]
ds_read_b64_tr_b16 v[224:225], v20 offset:40960
v_mfma_f32_16x16x32_bf16 a[24:27], v[160:163], v[152:155], a[24:27]
v_mfma_f32_16x16x32_bf16 a[28:31], v[160:163], v[156:159], a[28:31]
ds_read_b64_tr_b16 v[226:227], v20 offset:41984
v_mfma_f32_16x16x32_bf16 a[60:63], v[164:167], v[156:159], a[60:63]
v_mfma_f32_16x16x32_bf16 a[56:59], v[164:167], v[152:155], a[56:59]
ds_read_b128 v[192:195], v25 offset:32768
v_mfma_f32_16x16x32_bf16 a[52:55], v[164:167], v[148:151], a[52:55]
v_mfma_f32_16x16x32_bf16 a[48:51], v[164:167], v[144:147], a[48:51]
ds_read_b128 v[196:199], v25 offset:34816
v_mfma_f32_16x16x32_bf16 a[44:47], v[164:167], v[140:143], a[44:47]
v_mfma_f32_16x16x32_bf16 a[40:43], v[164:167], v[136:139], a[40:43]
ds_read_b128 v[200:203], v25 offset:36864
v_mfma_f32_16x16x32_bf16 a[36:39], v[164:167], v[132:135], a[36:39]
v_mfma_f32_16x16x32_bf16 a[32:35], v[164:167], v[128:131], a[32:35]
ds_read_b128 v[204:207], v25 offset:38912
v_mfma_f32_16x16x32_bf16 a[64:67], v[168:171], v[128:131], a[64:67]
v_mfma_f32_16x16x32_bf16 a[68:71], v[168:171], v[132:135], a[68:71]
ds_read_b128 v[208:211], v25 offset:40960
v_mfma_f32_16x16x32_bf16 a[72:75], v[168:171], v[136:139], a[72:75]
v_mfma_f32_16x16x32_bf16 a[76:79], v[168:171], v[140:143], a[76:79]
ds_read_b128 v[212:215], v25 offset:43008
v_mfma_f32_16x16x32_bf16 a[80:83], v[168:171], v[144:147], a[80:83]
s_waitcnt vmcnt(20)
ds_read2_b32 v[36:37], v98 offset0:0 offset1:32
ds_read2_b32 v[38:39], v98 offset0:64 offset1:96
v_mfma_f32_16x16x32_bf16 a[84:87], v[168:171], v[148:151], a[84:87]
ds_read_b128 v[216:219], v25 offset:45056
ds_read2_b32 v[40:41], v98 offset0:128 offset1:160
v_mfma_f32_16x16x32_bf16 a[88:91], v[168:171], v[152:155], a[88:91]
ds_read2_b32 v[42:43], v98 offset0:192 offset1:224
v_add_u32 v98, 1024, v98
v_mfma_f32_16x16x32_bf16 a[92:95], v[168:171], v[156:159], a[92:95]
ds_read_b128 v[220:223], v25 offset:47104
ds_read2_b32 v[44:45], v98 offset0:0 offset1:32
v_mfma_f32_16x16x32_bf16 a[124:127], v[172:175], v[156:159], a[124:127]
ds_read2_b32 v[46:47], v98 offset0:64 offset1:96
ds_read2_b32 v[48:49], v98 offset0:128 offset1:160
v_mfma_f32_16x16x32_bf16 a[120:123], v[172:175], v[152:155], a[120:123]
ds_read_b64_tr_b16 v[228:229], v21 offset:40960
ds_read2_b32 v[50:51], v98 offset0:192 offset1:224
v_mfma_f32_16x16x32_bf16 a[116:119], v[172:175], v[148:151], a[116:119]
v_add_u32 v98, 3072, v98
v_mfma_f32_16x16x32_bf16 a[112:115], v[172:175], v[144:147], a[112:115]
ds_read_b64_tr_b16 v[230:231], v21 offset:41984
ds_read2_b32 v[52:53], v98 offset0:0 offset1:32
v_mfma_f32_16x16x32_bf16 a[108:111], v[172:175], v[140:143], a[108:111]
ds_read2_b32 v[54:55], v98 offset0:64 offset1:96
ds_read2_b32 v[56:57], v98 offset0:128 offset1:160
v_mfma_f32_16x16x32_bf16 a[104:107], v[172:175], v[136:139], a[104:107]
ds_read_b64_tr_b16 v[232:233], v22 offset:40960
ds_read2_b32 v[58:59], v98 offset0:192 offset1:224
v_mfma_f32_16x16x32_bf16 a[100:103], v[172:175], v[132:135], a[100:103]
v_add_u32 v98, 1024, v98
v_mfma_f32_16x16x32_bf16 a[96:99], v[172:175], v[128:131], a[96:99]
ds_read_b64_tr_b16 v[234:235], v22 offset:41984
ds_read2_b32 v[60:61], v98 offset0:0 offset1:32
v_mfma_f32_16x16x32_bf16 a[128:131], v[128:131], v[176:179], a[128:131]
ds_read2_b32 v[62:63], v98 offset0:64 offset1:96
ds_read2_b32 v[64:65], v98 offset0:128 offset1:160
v_mfma_f32_16x16x32_bf16 a[132:135], v[132:135], v[176:179], a[132:135]
ds_read_b64_tr_b16 v[236:237], v23 offset:40960
ds_read2_b32 v[66:67], v98 offset0:192 offset1:224
v_mfma_f32_16x16x32_bf16 a[136:139], v[136:139], v[176:179], a[136:139]
v_mfma_f32_16x16x32_bf16 a[140:143], v[140:143], v[176:179], a[140:143]
ds_read_b64_tr_b16 v[238:239], v23 offset:41984
v_mfma_f32_16x16x32_bf16 a[144:147], v[144:147], v[176:179], a[144:147]
v_mfma_f32_16x16x32_bf16 a[148:151], v[148:151], v[176:179], a[148:151]
ds_read_b64_tr_b16 v[240:241], v20 offset:57344
v_mfma_f32_16x16x32_bf16 a[152:155], v[152:155], v[176:179], a[152:155]
v_mfma_f32_16x16x32_bf16 a[156:159], v[156:159], v[176:179], a[156:159]
ds_read_b64_tr_b16 v[242:243], v20 offset:58368
v_mfma_f32_16x16x32_bf16 a[188:191], v[156:159], v[180:183], a[188:191]
v_mfma_f32_16x16x32_bf16 a[184:187], v[152:155], v[180:183], a[184:187]
ds_read_b64_tr_b16 v[244:245], v21 offset:57344
v_mfma_f32_16x16x32_bf16 a[180:183], v[148:151], v[180:183], a[180:183]
v_mfma_f32_16x16x32_bf16 a[176:179], v[144:147], v[180:183], a[176:179]
ds_read_b64_tr_b16 v[246:247], v21 offset:58368
v_mfma_f32_16x16x32_bf16 a[172:175], v[140:143], v[180:183], a[172:175]
v_mfma_f32_16x16x32_bf16 a[168:171], v[136:139], v[180:183], a[168:171]
ds_read_b64_tr_b16 v[248:249], v22 offset:57344
v_mfma_f32_16x16x32_bf16 a[164:167], v[132:135], v[180:183], a[164:167]
v_mfma_f32_16x16x32_bf16 a[160:163], v[128:131], v[180:183], a[160:163]
ds_read_b64_tr_b16 v[250:251], v22 offset:58368
v_mfma_f32_16x16x32_bf16 a[192:195], v[128:131], v[184:187], a[192:195]
v_mfma_f32_16x16x32_bf16 a[196:199], v[132:135], v[184:187], a[196:199]
ds_read_b64_tr_b16 v[252:253], v23 offset:57344
v_mfma_f32_16x16x32_bf16 a[200:203], v[136:139], v[184:187], a[200:203]
v_mfma_f32_16x16x32_bf16 a[204:207], v[140:143], v[184:187], a[204:207]
ds_read_b64_tr_b16 v[254:255], v23 offset:58368
v_mfma_f32_16x16x32_bf16 a[208:211], v[144:147], v[184:187], a[208:211]
v_mfma_f32_16x16x32_bf16 a[212:215], v[148:151], v[184:187], a[212:215]
v_mfma_f32_16x16x32_bf16 a[216:219], v[152:155], v[184:187], a[216:219]
v_mfma_f32_16x16x32_bf16 a[220:223], v[156:159], v[184:187], a[220:223]
v_mfma_f32_16x16x32_bf16 a[252:255], v[156:159], v[188:191], a[252:255]
v_mfma_f32_16x16x32_bf16 a[248:251], v[152:155], v[188:191], a[248:251]
v_mfma_f32_16x16x32_bf16 a[244:247], v[148:151], v[188:191], a[244:247]
v_mfma_f32_16x16x32_bf16 a[240:243], v[144:147], v[188:191], a[240:243]
v_mfma_f32_16x16x32_bf16 a[236:239], v[140:143], v[188:191], a[236:239]
v_mfma_f32_16x16x32_bf16 a[232:235], v[136:139], v[188:191], a[232:235]
v_mfma_f32_16x16x32_bf16 a[228:231], v[132:135], v[188:191], a[228:231]
s_waitcnt vmcnt(4) lgkmcnt(0)
v_mfma_f32_16x16x32_bf16 a[224:227], v[128:131], v[188:191], a[224:227]
s_barrier
v_mfma_f32_16x16x32_bf16 a[0:3], v[224:227], v[192:195], a[0:3]
s_and_b32 s73, s65, 1
ds_read_b64_tr_b16 v[160:161], v20 offset:0
v_lshlrev_b32 v72, 16, v68
v_mfma_f32_16x16x32_bf16 a[4:7], v[224:227], v[196:199], a[4:7]
s_xor_b32 s73, s73, 5
ds_read_b64_tr_b16 v[162:163], v20 offset:1024
v_and_b32 v73, 0xffff0000, v68
v_mfma_f32_16x16x32_bf16 a[8:11], v[224:227], v[200:203], a[8:11]
s_lshl_b32 s69, s73, 7
ds_read_b128 v[128:131], v24 offset:0
v_lshlrev_b32 v74, 16, v69
v_mfma_f32_16x16x32_bf16 a[12:15], v[224:227], v[204:207], a[12:15]
s_add_u32 s69, s69, s67
ds_read_b128 v[132:135], v24 offset:2048
v_and_b32 v75, 0xffff0000, v69
v_mfma_f32_16x16x32_bf16 a[16:19], v[224:227], v[208:211], a[16:19]
s_lshl_b32 s71, s73, 19
ds_read_b128 v[136:139], v24 offset:4096
v_lshlrev_b32 v76, 16, v33
v_mfma_f32_16x16x32_bf16 a[20:23], v[224:227], v[212:215], a[20:23]
s_add_u32 s71, s71, s66
ds_read_b128 v[140:143], v24 offset:6144
v_lshlrev_b32 v77, 16, v34
v_mfma_f32_16x16x32_bf16 a[24:27], v[224:227], v[216:219], a[24:27]
s_add_u32 m0, s63, 98304
ds_read_b128 v[144:147], v24 offset:8192
v_lshlrev_b32 v78, 16, v35
v_mfma_f32_16x16x32_bf16 a[28:31], v[224:227], v[220:223], a[28:31]
s_add_u32 s72, s69, 0
buffer_load_dwordx4 v2, s[8:11], s72 offen lds
v_mfma_f32_16x16x32_bf16 a[60:63], v[228:231], v[220:223], a[60:63]
s_add_u32 s72, s69, 7168
buffer_load_dwordx4 v3, s[8:11], s72 offen offset:1024 lds
v_mfma_f32_16x16x32_bf16 a[56:59], v[228:231], v[216:219], a[56:59]
s_add_u32 s72, s69, 14336
buffer_load_dwordx4 v2, s[8:11], s72 offen offset:2048 lds
v_mfma_f32_16x16x32_bf16 a[52:55], v[228:231], v[212:215], a[52:55]
ds_read_b128 v[148:151], v24 offset:10240
v_lshlrev_b32 v79, 16, v36
v_mfma_f32_16x16x32_bf16 a[48:51], v[228:231], v[208:211], a[48:51]
ds_read_b128 v[152:155], v24 offset:12288
v_lshlrev_b32 v80, 16, v37
v_mfma_f32_16x16x32_bf16 a[44:47], v[228:231], v[204:207], a[44:47]
s_add_u32 s72, s69, 21504
buffer_load_dwordx4 v3, s[8:11], s72 offen offset:3072 lds
v_mfma_f32_16x16x32_bf16 a[40:43], v[228:231], v[200:203], a[40:43]
ds_read_b128 v[156:159], v24 offset:14336
v_lshlrev_b32 v81, 16, v38
v_mfma_f32_16x16x32_bf16 a[36:39], v[228:231], v[196:199], a[36:39]
ds_read_b64_tr_b16 v[164:165], v21 offset:0
v_lshlrev_b32 v82, 16, v39
v_mfma_f32_16x16x32_bf16 a[32:35], v[228:231], v[192:195], a[32:35]
ds_read_b64_tr_b16 v[166:167], v21 offset:1024
v_lshlrev_b32 v83, 16, v40
v_mfma_f32_16x16x32_bf16 a[64:67], v[232:235], v[192:195], a[64:67]
ds_read_b64_tr_b16 v[168:169], v22 offset:0
v_lshlrev_b32 v84, 16, v41
v_mfma_f32_16x16x32_bf16 a[68:71], v[232:235], v[196:199], a[68:71]
s_add_u32 m0, s64, 32768
ds_read_b64_tr_b16 v[170:171], v22 offset:1024
v_lshlrev_b32 v85, 16, v42
v_mfma_f32_16x16x32_bf16 a[72:75], v[232:235], v[200:203], a[72:75]
s_add_u32 s72, s71, 0
buffer_load_dwordx4 v6, s[16:19], s72 offen lds
v_mfma_f32_16x16x32_bf16 a[76:79], v[232:235], v[204:207], a[76:79]
ds_read_b64_tr_b16 v[172:173], v23 offset:0
v_lshlrev_b32 v86, 16, v43
v_mfma_f32_16x16x32_bf16 a[80:83], v[232:235], v[208:211], a[80:83]
ds_read_b64_tr_b16 v[174:175], v23 offset:1024
v_lshlrev_b32 v87, 16, v44
v_mfma_f32_16x16x32_bf16 a[84:87], v[232:235], v[212:215], a[84:87]
s_add_u32 s72, s71, 31744
buffer_load_dwordx4 v6, s[16:19], s72 offen offset:1024 lds
v_mfma_f32_16x16x32_bf16 a[88:91], v[232:235], v[216:219], a[88:91]
ds_read_b64_tr_b16 v[176:177], v20 offset:16384
v_lshlrev_b32 v88, 16, v45
v_mfma_f32_16x16x32_bf16 a[92:95], v[232:235], v[220:223], a[92:95]
ds_read_b64_tr_b16 v[178:179], v20 offset:17408
v_lshlrev_b32 v89, 16, v46
v_mfma_f32_16x16x32_bf16 a[124:127], v[236:239], v[220:223], a[124:127]
ds_read_b64_tr_b16 v[180:181], v21 offset:16384
v_lshlrev_b32 v90, 16, v47
v_mfma_f32_16x16x32_bf16 a[120:123], v[236:239], v[216:219], a[120:123]
s_add_u32 s72, s71, 63488
buffer_load_dwordx4 v7, s[16:19], s72 offen offset:2048 lds
v_mfma_f32_16x16x32_bf16 a[116:119], v[236:239], v[212:215], a[116:119]
ds_read_b64_tr_b16 v[182:183], v21 offset:17408
v_lshlrev_b32 v91, 16, v48
v_mfma_f32_16x16x32_bf16 a[112:115], v[236:239], v[208:211], a[112:115]
ds_read_b64_tr_b16 v[184:185], v22 offset:16384
v_lshlrev_b32 v92, 16, v49
v_mfma_f32_16x16x32_bf16 a[108:111], v[236:239], v[204:207], a[108:111]
ds_read_b64_tr_b16 v[186:187], v22 offset:17408
v_lshlrev_b32 v93, 16, v50
v_mfma_f32_16x16x32_bf16 a[104:107], v[236:239], v[200:203], a[104:107]
ds_read_b64_tr_b16 v[188:189], v23 offset:16384
v_lshlrev_b32 v94, 16, v51
v_mfma_f32_16x16x32_bf16 a[100:103], v[236:239], v[196:199], a[100:103]
s_add_u32 s72, s71, 95232
buffer_load_dwordx4 v7, s[16:19], s72 offen offset:3072 lds
v_mfma_f32_16x16x32_bf16 a[96:99], v[236:239], v[192:195], a[96:99]
ds_read_b64_tr_b16 v[190:191], v23 offset:17408
v_mul_f32 v95, v75, v91
v_mfma_f32_16x16x32_bf16 a[128:131], v[192:195], v[240:243], a[128:131]
v_lshlrev_b32 v97, 16, v67
v_fmac_f32 v95, v74, v92
v_mfma_f32_16x16x32_bf16 a[132:135], v[196:199], v[240:243], a[132:135]
v_fmac_f32 v95, v73, v93
v_fmac_f32 v95, v72, v94
v_mfma_f32_16x16x32_bf16 a[136:139], v[200:203], v[240:243], a[136:139]
s_add_u32 m0, s63, 102400
v_mul_f32 v95, v95, v97
v_mul_f32 v96, v75, v90
v_mfma_f32_16x16x32_bf16 a[140:143], v[204:207], v[240:243], a[140:143]
s_add_u32 s72, s69, 32768
buffer_load_dwordx4 v2, s[8:11], s72 offen lds
v_mfma_f32_16x16x32_bf16 a[144:147], v[208:211], v[240:243], a[144:147]
v_lshlrev_b32 v97, 16, v66
v_fmac_f32 v96, v74, v91
v_mfma_f32_16x16x32_bf16 a[148:151], v[212:215], v[240:243], a[148:151]
v_fmac_f32 v96, v73, v92
v_fmac_f32 v96, v72, v93
v_mfma_f32_16x16x32_bf16 a[152:155], v[216:219], v[240:243], a[152:155]
s_add_u32 s72, s69, 39936
buffer_load_dwordx4 v3, s[8:11], s72 offen offset:1024 lds
v_mfma_f32_16x16x32_bf16 a[156:159], v[220:223], v[240:243], a[156:159]
v_mul_f32 v96, v96, v97
v_cvt_pk_bf16_f32 v100, v95, v96
v_mfma_f32_16x16x32_bf16 a[188:191], v[220:223], v[244:247], a[188:191]
v_mul_f32 v95, v75, v89
v_lshlrev_b32 v97, 16, v65
v_mfma_f32_16x16x32_bf16 a[184:187], v[216:219], v[244:247], a[184:187]
v_fmac_f32 v95, v74, v90
v_fmac_f32 v95, v73, v91
v_mfma_f32_16x16x32_bf16 a[180:183], v[212:215], v[244:247], a[180:183]
v_fmac_f32 v95, v72, v92
v_mul_f32 v95, v95, v97
v_mfma_f32_16x16x32_bf16 a[176:179], v[208:211], v[244:247], a[176:179]
s_add_u32 s72, s69, 47104
buffer_load_dwordx4 v2, s[8:11], s72 offen offset:2048 lds
v_mfma_f32_16x16x32_bf16 a[172:175], v[204:207], v[244:247], a[172:175]
v_mul_f32 v96, v75, v88
v_lshlrev_b32 v97, 16, v64
v_mfma_f32_16x16x32_bf16 a[168:171], v[200:203], v[244:247], a[168:171]
v_fmac_f32 v96, v74, v89
v_fmac_f32 v96, v73, v90
v_mfma_f32_16x16x32_bf16 a[164:167], v[196:199], v[244:247], a[164:167]
v_fmac_f32 v96, v72, v91
v_mul_f32 v96, v96, v97
v_mfma_f32_16x16x32_bf16 a[160:163], v[192:195], v[244:247], a[160:163]
s_add_u32 s72, s69, 54272
buffer_load_dwordx4 v3, s[8:11], s72 offen offset:3072 lds
v_mfma_f32_16x16x32_bf16 a[192:195], v[192:195], v[248:251], a[192:195]
v_cvt_pk_bf16_f32 v101, v95, v96
v_mul_f32 v95, v75, v87
v_mfma_f32_16x16x32_bf16 a[196:199], v[196:199], v[248:251], a[196:199]
v_lshlrev_b32 v97, 16, v63
v_fmac_f32 v95, v74, v88
v_mfma_f32_16x16x32_bf16 a[200:203], v[200:203], v[248:251], a[200:203]
v_fmac_f32 v95, v73, v89
v_fmac_f32 v95, v72, v90
v_mfma_f32_16x16x32_bf16 a[204:207], v[204:207], v[248:251], a[204:207]
s_add_u32 m0, s64, 49152
v_mul_f32 v95, v95, v97
v_mul_f32 v96, v75, v86
v_mfma_f32_16x16x32_bf16 a[208:211], v[208:211], v[248:251], a[208:211]
s_add_u32 s72, s71, 0
buffer_load_dwordx4 v6, s[20:23], s72 offen lds
v_mfma_f32_16x16x32_bf16 a[212:215], v[212:215], v[248:251], a[212:215]
v_lshlrev_b32 v97, 16, v62
v_fmac_f32 v96, v74, v87
v_mfma_f32_16x16x32_bf16 a[216:219], v[216:219], v[248:251], a[216:219]
v_fmac_f32 v96, v73, v88
v_fmac_f32 v96, v72, v89
v_mfma_f32_16x16x32_bf16 a[220:223], v[220:223], v[248:251], a[220:223]
v_mul_f32 v96, v96, v97
v_cvt_pk_bf16_f32 v102, v95, v96
v_mfma_f32_16x16x32_bf16 a[252:255], v[220:223], v[252:255], a[252:255]
s_add_u32 s72, s71, 31744
buffer_load_dwordx4 v6, s[20:23], s72 offen offset:1024 lds
v_mfma_f32_16x16x32_bf16 a[248:251], v[216:219], v[252:255], a[248:251]
v_mul_f32 v95, v75, v85
v_lshlrev_b32 v97, 16, v61
v_mfma_f32_16x16x32_bf16 a[244:247], v[212:215], v[252:255], a[244:247]
v_fmac_f32 v95, v74, v86
v_fmac_f32 v95, v73, v87
v_mfma_f32_16x16x32_bf16 a[240:243], v[208:211], v[252:255], a[240:243]
v_fmac_f32 v95, v72, v88
v_mul_f32 v95, v95, v97
v_mfma_f32_16x16x32_bf16 a[236:239], v[204:207], v[252:255], a[236:239]
s_add_u32 s72, s71, 63488
buffer_load_dwordx4 v7, s[20:23], s72 offen offset:2048 lds
v_mfma_f32_16x16x32_bf16 a[232:235], v[200:203], v[252:255], a[232:235]
v_mul_f32 v96, v75, v84
v_lshlrev_b32 v97, 16, v60
v_mfma_f32_16x16x32_bf16 a[228:231], v[196:199], v[252:255], a[228:231]
v_fmac_f32 v96, v74, v85
v_fmac_f32 v96, v73, v86
v_mfma_f32_16x16x32_bf16 a[224:227], v[192:195], v[252:255], a[224:227]
s_waitcnt lgkmcnt(0)
v_fmac_f32 v96, v72, v87
v_mul_f32 v96, v96, v97
v_mfma_f32_16x16x32_bf16 a[0:3], v[160:163], v[128:131], a[0:3]
s_add_u32 s72, s71, 95232
buffer_load_dwordx4 v7, s[20:23], s72 offen offset:3072 lds
v_mfma_f32_16x16x32_bf16 a[4:7], v[160:163], v[132:135], a[4:7]
s_mov_b32 s80, 0x0
buffer_load_dword v126, v125, s[12:15], s80 offen
v_mfma_f32_16x16x32_bf16 a[8:11], v[160:163], v[136:139], a[8:11]
s_mov_b32 s80, 0x100000
buffer_load_dword v126, v125, s[12:15], s80 offen
v_mfma_f32_16x16x32_bf16 a[12:15], v[160:163], v[140:143], a[12:15]
s_mov_b32 s80, 0x200000
buffer_load_dword v126, v125, s[12:15], s80 offen
v_mfma_f32_16x16x32_bf16 a[16:19], v[160:163], v[144:147], a[16:19]
s_mov_b32 s80, 0x300000
buffer_load_dword v126, v125, s[12:15], s80 offen
v_mfma_f32_16x16x32_bf16 a[20:23], v[160:163], v[148:151], a[20:23]
ds_read_b64_tr_b16 v[224:225], v20 offset:8192
v_cvt_pk_bf16_f32 v103, v95, v96
v_mfma_f32_16x16x32_bf16 a[24:27], v[160:163], v[152:155], a[24:27]
ds_write_b128 v28, v[100:103] offset:0
v_mul_f32 v95, v75, v83
v_mfma_f32_16x16x32_bf16 a[28:31], v[160:163], v[156:159], a[28:31]
ds_read_b64_tr_b16 v[226:227], v20 offset:9216
v_lshlrev_b32 v97, 16, v59
v_mfma_f32_16x16x32_bf16 a[60:63], v[164:167], v[156:159], a[60:63]
v_fmac_f32 v95, v74, v84
v_fmac_f32 v95, v73, v85
v_mfma_f32_16x16x32_bf16 a[56:59], v[164:167], v[152:155], a[56:59]
ds_read_b128 v[192:195], v25 offset:0
v_fmac_f32 v95, v72, v86
v_mfma_f32_16x16x32_bf16 a[52:55], v[164:167], v[148:151], a[52:55]
v_mul_f32 v95, v95, v97
v_mul_f32 v96, v75, v82
v_mfma_f32_16x16x32_bf16 a[48:51], v[164:167], v[144:147], a[48:51]
ds_read_b128 v[196:199], v25 offset:2048
v_lshlrev_b32 v97, 16, v58
v_mfma_f32_16x16x32_bf16 a[44:47], v[164:167], v[140:143], a[44:47]
v_fmac_f32 v96, v74, v83
v_fmac_f32 v96, v73, v84
v_mfma_f32_16x16x32_bf16 a[40:43], v[164:167], v[136:139], a[40:43]
ds_read_b128 v[200:203], v25 offset:4096
v_fmac_f32 v96, v72, v85
v_mfma_f32_16x16x32_bf16 a[36:39], v[164:167], v[132:135], a[36:39]
v_mul_f32 v96, v96, v97
v_cvt_pk_bf16_f32 v104, v95, v96
v_mfma_f32_16x16x32_bf16 a[32:35], v[164:167], v[128:131], a[32:35]
ds_read_b128 v[204:207], v25 offset:6144
v_mul_f32 v95, v75, v81
v_mfma_f32_16x16x32_bf16 a[64:67], v[168:171], v[128:131], a[64:67]
v_lshlrev_b32 v97, 16, v57
v_fmac_f32 v95, v74, v82
v_mfma_f32_16x16x32_bf16 a[68:71], v[168:171], v[132:135], a[68:71]
ds_read_b128 v[208:211], v25 offset:8192
v_fmac_f32 v95, v73, v83
v_mfma_f32_16x16x32_bf16 a[72:75], v[168:171], v[136:139], a[72:75]
v_fmac_f32 v95, v72, v84
v_mul_f32 v95, v95, v97
v_mfma_f32_16x16x32_bf16 a[76:79], v[168:171], v[140:143], a[76:79]
ds_read_b128 v[212:215], v25 offset:10240
v_mul_f32 v96, v75, v80
v_mfma_f32_16x16x32_bf16 a[80:83], v[168:171], v[144:147], a[80:83]
v_lshlrev_b32 v97, 16, v56
v_fmac_f32 v96, v74, v81
v_mfma_f32_16x16x32_bf16 a[84:87], v[168:171], v[148:151], a[84:87]
ds_read_b128 v[216:219], v25 offset:12288
v_fmac_f32 v96, v73, v82
v_mfma_f32_16x16x32_bf16 a[88:91], v[168:171], v[152:155], a[88:91]
v_fmac_f32 v96, v72, v83
v_mul_f32 v96, v96, v97
v_mfma_f32_16x16x32_bf16 a[92:95], v[168:171], v[156:159], a[92:95]
ds_read_b128 v[220:223], v25 offset:14336
v_cvt_pk_bf16_f32 v105, v95, v96
v_mfma_f32_16x16x32_bf16 a[124:127], v[172:175], v[156:159], a[124:127]
v_mul_f32 v95, v75, v79
v_lshlrev_b32 v97, 16, v55
v_mfma_f32_16x16x32_bf16 a[120:123], v[172:175], v[152:155], a[120:123]
ds_read_b64_tr_b16 v[228:229], v21 offset:8192
v_fmac_f32 v95, v74, v80
v_mfma_f32_16x16x32_bf16 a[116:119], v[172:175], v[148:151], a[116:119]
v_fmac_f32 v95, v73, v81
v_fmac_f32 v95, v72, v82
v_mfma_f32_16x16x32_bf16 a[112:115], v[172:175], v[144:147], a[112:115]
ds_read_b64_tr_b16 v[230:231], v21 offset:9216
v_mul_f32 v95, v95, v97
v_mfma_f32_16x16x32_bf16 a[108:111], v[172:175], v[140:143], a[108:111]
v_mul_f32 v96, v75, v78
v_lshlrev_b32 v97, 16, v54
v_mfma_f32_16x16x32_bf16 a[104:107], v[172:175], v[136:139], a[104:107]
ds_read_b64_tr_b16 v[232:233], v22 offset:8192
v_fmac_f32 v96, v74, v79
v_mfma_f32_16x16x32_bf16 a[100:103], v[172:175], v[132:135], a[100:103]
v_fmac_f32 v96, v73, v80
v_fmac_f32 v96, v72, v81
v_mfma_f32_16x16x32_bf16 a[96:99], v[172:175], v[128:131], a[96:99]
ds_read_b64_tr_b16 v[234:235], v22 offset:9216
v_mul_f32 v96, v96, v97
v_mfma_f32_16x16x32_bf16 a[128:131], v[128:131], v[176:179], a[128:131]
v_cvt_pk_bf16_f32 v106, v95, v96
v_mul_f32 v95, v75, v77
v_mfma_f32_16x16x32_bf16 a[132:135], v[132:135], v[176:179], a[132:135]
ds_read_b64_tr_b16 v[236:237], v23 offset:8192
v_lshlrev_b32 v97, 16, v53
v_mfma_f32_16x16x32_bf16 a[136:139], v[136:139], v[176:179], a[136:139]
v_fmac_f32 v95, v74, v78
v_fmac_f32 v95, v73, v79
v_mfma_f32_16x16x32_bf16 a[140:143], v[140:143], v[176:179], a[140:143]
ds_read_b64_tr_b16 v[238:239], v23 offset:9216
v_fmac_f32 v95, v72, v80
v_mfma_f32_16x16x32_bf16 a[144:147], v[144:147], v[176:179], a[144:147]
v_mul_f32 v95, v95, v97
v_mul_f32 v96, v75, v76
v_mfma_f32_16x16x32_bf16 a[148:151], v[148:151], v[176:179], a[148:151]
ds_read_b64_tr_b16 v[240:241], v20 offset:24576
v_lshlrev_b32 v97, 16, v52
v_mfma_f32_16x16x32_bf16 a[152:155], v[152:155], v[176:179], a[152:155]
v_fmac_f32 v96, v74, v77
v_fmac_f32 v96, v73, v78
v_mfma_f32_16x16x32_bf16 a[156:159], v[156:159], v[176:179], a[156:159]
ds_read_b64_tr_b16 v[242:243], v20 offset:25600
v_fmac_f32 v96, v72, v79
v_mfma_f32_16x16x32_bf16 a[188:191], v[156:159], v[180:183], a[188:191]
v_mul_f32 v96, v96, v97
v_cvt_pk_bf16_f32 v107, v95, v96
v_mfma_f32_16x16x32_bf16 a[184:187], v[152:155], v[180:183], a[184:187]
ds_read_b64_tr_b16 v[244:245], v21 offset:24576
ds_write_b128 v28, v[104:107] offset:16
v_mfma_f32_16x16x32_bf16 a[180:183], v[148:151], v[180:183], a[180:183]
global_load_dwordx4 v[84:87], v1, s[56:57]
v_mfma_f32_16x16x32_bf16 a[176:179], v[144:147], v[180:183], a[176:179]
ds_read_b64_tr_b16 v[246:247], v21 offset:25600
v_mfma_f32_16x16x32_bf16 a[172:175], v[140:143], v[180:183], a[172:175]
global_load_dwordx4 v[88:91], v1, s[56:57] offset:1024
v_mfma_f32_16x16x32_bf16 a[168:171], v[136:139], v[180:183], a[168:171]
ds_read_b64_tr_b16 v[248:249], v22 offset:24576
v_lshlrev_b32 v72, 16, v70
v_mfma_f32_16x16x32_bf16 a[164:167], v[132:135], v[180:183], a[164:167]
v_and_b32 v73, 0xffff0000, v70
v_lshlrev_b32 v74, 16, v71
v_mfma_f32_16x16x32_bf16 a[160:163], v[128:131], v[180:183], a[160:163]
ds_read_b64_tr_b16 v[250:251], v22 offset:25600
v_and_b32 v75, 0xffff0000, v71
v_mfma_f32_16x16x32_bf16 a[192:195], v[128:131], v[184:187], a[192:195]
v_and_b32 v33, 0xffff0000, v33
v_and_b32 v34, 0xffff0000, v34
v_mfma_f32_16x16x32_bf16 a[196:199], v[132:135], v[184:187], a[196:199]
ds_read_b64_tr_b16 v[252:253], v23 offset:24576
v_and_b32 v35, 0xffff0000, v35
v_mfma_f32_16x16x32_bf16 a[200:203], v[136:139], v[184:187], a[200:203]
v_and_b32 v36, 0xffff0000, v36
v_and_b32 v37, 0xffff0000, v37
v_mfma_f32_16x16x32_bf16 a[204:207], v[140:143], v[184:187], a[204:207]
ds_read_b64_tr_b16 v[254:255], v23 offset:25600
v_and_b32 v38, 0xffff0000, v38
v_mfma_f32_16x16x32_bf16 a[208:211], v[144:147], v[184:187], a[208:211]
v_and_b32 v39, 0xffff0000, v39
v_and_b32 v40, 0xffff0000, v40
v_mfma_f32_16x16x32_bf16 a[212:215], v[148:151], v[184:187], a[212:215]
v_and_b32 v41, 0xffff0000, v41
v_and_b32 v42, 0xffff0000, v42
v_mfma_f32_16x16x32_bf16 a[216:219], v[152:155], v[184:187], a[216:219]
v_and_b32 v43, 0xffff0000, v43
v_and_b32 v44, 0xffff0000, v44
v_mfma_f32_16x16x32_bf16 a[220:223], v[156:159], v[184:187], a[220:223]
v_and_b32 v45, 0xffff0000, v45
v_and_b32 v46, 0xffff0000, v46
v_mfma_f32_16x16x32_bf16 a[252:255], v[156:159], v[188:191], a[252:255]
v_and_b32 v47, 0xffff0000, v47
v_and_b32 v48, 0xffff0000, v48
v_mfma_f32_16x16x32_bf16 a[248:251], v[152:155], v[188:191], a[248:251]
v_and_b32 v49, 0xffff0000, v49
v_and_b32 v50, 0xffff0000, v50
v_mfma_f32_16x16x32_bf16 a[244:247], v[148:151], v[188:191], a[244:247]
v_and_b32 v51, 0xffff0000, v51
v_mul_f32 v95, v75, v48
v_mfma_f32_16x16x32_bf16 a[240:243], v[144:147], v[188:191], a[240:243]
v_and_b32 v97, 0xffff0000, v67
v_fmac_f32 v95, v74, v49
v_mfma_f32_16x16x32_bf16 a[236:239], v[140:143], v[188:191], a[236:239]
v_fmac_f32 v95, v73, v50
v_fmac_f32 v95, v72, v51
v_mfma_f32_16x16x32_bf16 a[232:235], v[136:139], v[188:191], a[232:235]
v_mul_f32 v95, v95, v97
v_mul_f32 v96, v75, v47
v_mfma_f32_16x16x32_bf16 a[228:231], v[132:135], v[188:191], a[228:231]
s_waitcnt vmcnt(6) lgkmcnt(0)
v_and_b32 v97, 0xffff0000, v66
v_fmac_f32 v96, v74, v48
v_mfma_f32_16x16x32_bf16 a[224:227], v[128:131], v[188:191], a[224:227]
s_barrier
v_fmac_f32 v96, v73, v49
v_fmac_f32 v96, v72, v50
v_mfma_f32_16x16x32_bf16 a[0:3], v[224:227], v[192:195], a[0:3]
s_and_b32 s73, s65, 1
ds_read_b64_tr_b16 v[160:161], v20 offset:32768
v_mul_f32 v96, v96, v97
v_mfma_f32_16x16x32_bf16 a[4:7], v[224:227], v[196:199], a[4:7]
s_xor_b32 s73, s73, 6
ds_read_b64_tr_b16 v[162:163], v20 offset:33792
v_cvt_pk_bf16_f32 v100, v95, v96
v_mfma_f32_16x16x32_bf16 a[8:11], v[224:227], v[200:203], a[8:11]
s_lshl_b32 s69, s73, 7
ds_read_b128 v[128:131], v24 offset:32768
v_mul_f32 v95, v75, v46
v_mfma_f32_16x16x32_bf16 a[12:15], v[224:227], v[204:207], a[12:15]
s_add_u32 s69, s69, s67
ds_read_b128 v[132:135], v24 offset:34816
v_and_b32 v97, 0xffff0000, v65
v_mfma_f32_16x16x32_bf16 a[16:19], v[224:227], v[208:211], a[16:19]
s_lshl_b32 s71, s73, 19
ds_read_b128 v[136:139], v24 offset:36864
v_fmac_f32 v95, v74, v47
v_mfma_f32_16x16x32_bf16 a[20:23], v[224:227], v[212:215], a[20:23]
s_add_u32 s71, s71, s66
ds_read_b128 v[140:143], v24 offset:38912
v_fmac_f32 v95, v73, v48
v_mfma_f32_16x16x32_bf16 a[24:27], v[224:227], v[216:219], a[24:27]
s_add_u32 m0, s63, 65536
ds_read_b128 v[144:147], v24 offset:40960
v_fmac_f32 v95, v72, v49
v_mfma_f32_16x16x32_bf16 a[28:31], v[224:227], v[220:223], a[28:31]
s_add_u32 s72, s69, 0
buffer_load_dwordx4 v2, s[8:11], s72 offen lds
v_mfma_f32_16x16x32_bf16 a[60:63], v[228:231], v[220:223], a[60:63]
s_add_u32 s72, s69, 7168
buffer_load_dwordx4 v3, s[8:11], s72 offen offset:1024 lds
v_mfma_f32_16x16x32_bf16 a[56:59], v[228:231], v[216:219], a[56:59]
s_add_u32 s72, s69, 14336
buffer_load_dwordx4 v2, s[8:11], s72 offen offset:2048 lds
v_mfma_f32_16x16x32_bf16 a[52:55], v[228:231], v[212:215], a[52:55]
ds_read_b128 v[148:151], v24 offset:43008
v_mul_f32 v95, v95, v97
v_mfma_f32_16x16x32_bf16 a[48:51], v[228:231], v[208:211], a[48:51]
ds_read_b128 v[152:155], v24 offset:45056
v_mul_f32 v96, v75, v45
v_mfma_f32_16x16x32_bf16 a[44:47], v[228:231], v[204:207], a[44:47]
s_add_u32 s72, s69, 21504
buffer_load_dwordx4 v3, s[8:11], s72 offen offset:3072 lds
v_mfma_f32_16x16x32_bf16 a[40:43], v[228:231], v[200:203], a[40:43]
ds_read_b128 v[156:159], v24 offset:47104
v_and_b32 v97, 0xffff0000, v64
v_mfma_f32_16x16x32_bf16 a[36:39], v[228:231], v[196:199], a[36:39]
ds_read_b64_tr_b16 v[164:165], v21 offset:32768
v_fmac_f32 v96, v74, v46
v_mfma_f32_16x16x32_bf16 a[32:35], v[228:231], v[192:195], a[32:35]
ds_read_b64_tr_b16 v[166:167], v21 offset:33792
v_fmac_f32 v96, v73, v47
v_mfma_f32_16x16x32_bf16 a[64:67], v[232:235], v[192:195], a[64:67]
ds_read_b64_tr_b16 v[168:169], v22 offset:32768
v_fmac_f32 v96, v72, v48
v_mfma_f32_16x16x32_bf16 a[68:71], v[232:235], v[196:199], a[68:71]
s_add_u32 m0, s64, 0
ds_read_b64_tr_b16 v[170:171], v22 offset:33792
v_mul_f32 v96, v96, v97
v_mfma_f32_16x16x32_bf16 a[72:75], v[232:235], v[200:203], a[72:75]
s_add_u32 s72, s71, 0
buffer_load_dwordx4 v6, s[16:19], s72 offen lds
v_mfma_f32_16x16x32_bf16 a[76:79], v[232:235], v[204:207], a[76:79]
ds_read_b64_tr_b16 v[172:173], v23 offset:32768
v_cvt_pk_bf16_f32 v101, v95, v96
v_mfma_f32_16x16x32_bf16 a[80:83], v[232:235], v[208:211], a[80:83]
ds_read_b64_tr_b16 v[174:175], v23 offset:33792
v_mul_f32 v95, v75, v44
v_mfma_f32_16x16x32_bf16 a[84:87], v[232:235], v[212:215], a[84:87]
s_add_u32 s72, s71, 31744
buffer_load_dwordx4 v6, s[16:19], s72 offen offset:1024 lds
v_mfma_f32_16x16x32_bf16 a[88:91], v[232:235], v[216:219], a[88:91]
ds_read_b64_tr_b16 v[176:177], v20 offset:49152
v_and_b32 v97, 0xffff0000, v63
v_mfma_f32_16x16x32_bf16 a[92:95], v[232:235], v[220:223], a[92:95]
ds_read_b64_tr_b16 v[178:179], v20 offset:50176
v_fmac_f32 v95, v74, v45
v_mfma_f32_16x16x32_bf16 a[124:127], v[236:239], v[220:223], a[124:127]
ds_read_b64_tr_b16 v[180:181], v21 offset:49152
v_fmac_f32 v95, v73, v46
v_mfma_f32_16x16x32_bf16 a[120:123], v[236:239], v[216:219], a[120:123]
s_add_u32 s72, s71, 63488
buffer_load_dwordx4 v7, s[16:19], s72 offen offset:2048 lds
v_mfma_f32_16x16x32_bf16 a[116:119], v[236:239], v[212:215], a[116:119]
ds_read_b64_tr_b16 v[182:183], v21 offset:50176
v_fmac_f32 v95, v72, v47
v_mfma_f32_16x16x32_bf16 a[112:115], v[236:239], v[208:211], a[112:115]
ds_read_b64_tr_b16 v[184:185], v22 offset:49152
v_mul_f32 v95, v95, v97
v_mfma_f32_16x16x32_bf16 a[108:111], v[236:239], v[204:207], a[108:111]
ds_read_b64_tr_b16 v[186:187], v22 offset:50176
v_mul_f32 v96, v75, v43
v_mfma_f32_16x16x32_bf16 a[104:107], v[236:239], v[200:203], a[104:107]
ds_read_b64_tr_b16 v[188:189], v23 offset:49152
v_and_b32 v97, 0xffff0000, v62
v_mfma_f32_16x16x32_bf16 a[100:103], v[236:239], v[196:199], a[100:103]
s_add_u32 s72, s71, 95232
buffer_load_dwordx4 v7, s[16:19], s72 offen offset:3072 lds
v_mfma_f32_16x16x32_bf16 a[96:99], v[236:239], v[192:195], a[96:99]
ds_read_b64_tr_b16 v[190:191], v23 offset:50176
v_fmac_f32 v96, v74, v44
v_mfma_f32_16x16x32_bf16 a[128:131], v[192:195], v[240:243], a[128:131]
v_fmac_f32 v96, v73, v45
v_fmac_f32 v96, v72, v46
v_mfma_f32_16x16x32_bf16 a[132:135], v[196:199], v[240:243], a[132:135]
v_mul_f32 v96, v96, v97
v_cvt_pk_bf16_f32 v102, v95, v96
v_mfma_f32_16x16x32_bf16 a[136:139], v[200:203], v[240:243], a[136:139]
s_add_u32 m0, s63, 69632
v_mul_f32 v95, v75, v42
v_and_b32 v97, 0xffff0000, v61
v_mfma_f32_16x16x32_bf16 a[140:143], v[204:207], v[240:243], a[140:143]
s_add_u32 s72, s69, 32768
buffer_load_dwordx4 v2, s[8:11], s72 offen lds
v_mfma_f32_16x16x32_bf16 a[144:147], v[208:211], v[240:243], a[144:147]
v_fmac_f32 v95, v74, v43
v_fmac_f32 v95, v73, v44
v_mfma_f32_16x16x32_bf16 a[148:151], v[212:215], v[240:243], a[148:151]
v_fmac_f32 v95, v72, v45
v_mul_f32 v95, v95, v97
v_mfma_f32_16x16x32_bf16 a[152:155], v[216:219], v[240:243], a[152:155]
s_add_u32 s72, s69, 39936
buffer_load_dwordx4 v3, s[8:11], s72 offen offset:1024 lds
v_mfma_f32_16x16x32_bf16 a[156:159], v[220:223], v[240:243], a[156:159]
v_mul_f32 v96, v75, v41
v_and_b32 v97, 0xffff0000, v60
v_mfma_f32_16x16x32_bf16 a[188:191], v[220:223], v[244:247], a[188:191]
v_fmac_f32 v96, v74, v42
v_fmac_f32 v96, v73, v43
v_mfma_f32_16x16x32_bf16 a[184:187], v[216:219], v[244:247], a[184:187]
v_fmac_f32 v96, v72, v44
v_mul_f32 v96, v96, v97
v_mfma_f32_16x16x32_bf16 a[180:183], v[212:215], v[244:247], a[180:183]
v_cvt_pk_bf16_f32 v103, v95, v96
v_mfma_f32_16x16x32_bf16 a[176:179], v[208:211], v[244:247], a[176:179]
s_add_u32 s72, s69, 47104
buffer_load_dwordx4 v2, s[8:11], s72 offen offset:2048 lds
v_mfma_f32_16x16x32_bf16 a[172:175], v[204:207], v[244:247], a[172:175]
ds_write_b128 v28, v[100:103] offset:272
v_mul_f32 v95, v75, v40
v_mfma_f32_16x16x32_bf16 a[168:171], v[200:203], v[244:247], a[168:171]
v_and_b32 v97, 0xffff0000, v59
v_fmac_f32 v95, v74, v41
v_mfma_f32_16x16x32_bf16 a[164:167], v[196:199], v[244:247], a[164:167]
v_fmac_f32 v95, v73, v42
v_fmac_f32 v95, v72, v43
v_mfma_f32_16x16x32_bf16 a[160:163], v[192:195], v[244:247], a[160:163]
s_add_u32 s72, s69, 54272
buffer_load_dwordx4 v3, s[8:11], s72 offen offset:3072 lds
v_mfma_f32_16x16x32_bf16 a[192:195], v[192:195], v[248:251], a[192:195]
v_mul_f32 v95, v95, v97
v_mul_f32 v96, v75, v39
v_mfma_f32_16x16x32_bf16 a[196:199], v[196:199], v[248:251], a[196:199]
v_and_b32 v97, 0xffff0000, v58
v_fmac_f32 v96, v74, v40
v_mfma_f32_16x16x32_bf16 a[200:203], v[200:203], v[248:251], a[200:203]
v_fmac_f32 v96, v73, v41
v_fmac_f32 v96, v72, v42
v_mfma_f32_16x16x32_bf16 a[204:207], v[204:207], v[248:251], a[204:207]
s_add_u32 m0, s64, 16384
v_mul_f32 v96, v96, v97
v_cvt_pk_bf16_f32 v104, v95, v96
v_mfma_f32_16x16x32_bf16 a[208:211], v[208:211], v[248:251], a[208:211]
s_add_u32 s72, s71, 0
buffer_load_dwordx4 v6, s[20:23], s72 offen lds
v_mfma_f32_16x16x32_bf16 a[212:215], v[212:215], v[248:251], a[212:215]
v_mul_f32 v95, v75, v38
v_and_b32 v97, 0xffff0000, v57
v_mfma_f32_16x16x32_bf16 a[216:219], v[216:219], v[248:251], a[216:219]
v_fmac_f32 v95, v74, v39
v_fmac_f32 v95, v73, v40
v_mfma_f32_16x16x32_bf16 a[220:223], v[220:223], v[248:251], a[220:223]
v_fmac_f32 v95, v72, v41
v_mul_f32 v95, v95, v97
v_mfma_f32_16x16x32_bf16 a[252:255], v[220:223], v[252:255], a[252:255]
s_add_u32 s72, s71, 31744
buffer_load_dwordx4 v6, s[20:23], s72 offen offset:1024 lds
v_mfma_f32_16x16x32_bf16 a[248:251], v[216:219], v[252:255], a[248:251]
v_mul_f32 v96, v75, v37
v_and_b32 v97, 0xffff0000, v56
v_mfma_f32_16x16x32_bf16 a[244:247], v[212:215], v[252:255], a[244:247]
v_fmac_f32 v96, v74, v38
v_fmac_f32 v96, v73, v39
v_mfma_f32_16x16x32_bf16 a[240:243], v[208:211], v[252:255], a[240:243]
v_fmac_f32 v96, v72, v40
v_mul_f32 v96, v96, v97
v_mfma_f32_16x16x32_bf16 a[236:239], v[204:207], v[252:255], a[236:239]
s_add_u32 s72, s71, 63488
buffer_load_dwordx4 v7, s[20:23], s72 offen offset:2048 lds
v_mfma_f32_16x16x32_bf16 a[232:235], v[200:203], v[252:255], a[232:235]
v_cvt_pk_bf16_f32 v105, v95, v96
v_mul_f32 v95, v75, v36
v_mfma_f32_16x16x32_bf16 a[228:231], v[196:199], v[252:255], a[228:231]
v_and_b32 v97, 0xffff0000, v55
v_fmac_f32 v95, v74, v37
v_mfma_f32_16x16x32_bf16 a[224:227], v[192:195], v[252:255], a[224:227]
s_waitcnt lgkmcnt(0)
v_fmac_f32 v95, v73, v38
v_fmac_f32 v95, v72, v39
v_mfma_f32_16x16x32_bf16 a[0:3], v[160:163], v[128:131], a[0:3]
s_add_u32 s72, s71, 95232
buffer_load_dwordx4 v7, s[20:23], s72 offen offset:3072 lds
v_mfma_f32_16x16x32_bf16 a[4:7], v[160:163], v[132:135], a[4:7]
s_mov_b32 s80, 0x400000
buffer_load_dword v126, v125, s[12:15], s80 offen
v_mfma_f32_16x16x32_bf16 a[8:11], v[160:163], v[136:139], a[8:11]
s_mov_b32 s80, 0x500000
buffer_load_dword v126, v125, s[12:15], s80 offen
v_mfma_f32_16x16x32_bf16 a[12:15], v[160:163], v[140:143], a[12:15]
s_mov_b32 s80, 0x600000
buffer_load_dword v126, v125, s[12:15], s80 offen
v_mfma_f32_16x16x32_bf16 a[16:19], v[160:163], v[144:147], a[16:19]
s_mov_b32 s80, 0x700000
buffer_load_dword v126, v125, s[12:15], s80 offen
v_mfma_f32_16x16x32_bf16 a[20:23], v[160:163], v[148:151], a[20:23]
ds_read_b64_tr_b16 v[224:225], v20 offset:40960
v_mul_f32 v95, v95, v97
v_mfma_f32_16x16x32_bf16 a[24:27], v[160:163], v[152:155], a[24:27]
v_mul_f32 v96, v75, v35
v_and_b32 v97, 0xffff0000, v54
v_mfma_f32_16x16x32_bf16 a[28:31], v[160:163], v[156:159], a[28:31]
ds_read_b64_tr_b16 v[226:227], v20 offset:41984
v_fmac_f32 v96, v74, v36
v_mfma_f32_16x16x32_bf16 a[60:63], v[164:167], v[156:159], a[60:63]
v_fmac_f32 v96, v73, v37
v_fmac_f32 v96, v72, v38
v_mfma_f32_16x16x32_bf16 a[56:59], v[164:167], v[152:155], a[56:59]
ds_read_b128 v[192:195], v25 offset:32768
v_mul_f32 v96, v96, v97
v_mfma_f32_16x16x32_bf16 a[52:55], v[164:167], v[148:151], a[52:55]
v_cvt_pk_bf16_f32 v106, v95, v96
v_mul_f32 v95, v75, v34
v_mfma_f32_16x16x32_bf16 a[48:51], v[164:167], v[144:147], a[48:51]
ds_read_b128 v[196:199], v25 offset:34816
v_and_b32 v97, 0xffff0000, v53
v_mfma_f32_16x16x32_bf16 a[44:47], v[164:167], v[140:143], a[44:47]
v_fmac_f32 v95, v74, v35
v_fmac_f32 v95, v73, v36
v_mfma_f32_16x16x32_bf16 a[40:43], v[164:167], v[136:139], a[40:43]
ds_read_b128 v[200:203], v25 offset:36864
v_fmac_f32 v95, v72, v37
v_mfma_f32_16x16x32_bf16 a[36:39], v[164:167], v[132:135], a[36:39]
v_mul_f32 v95, v95, v97
v_mul_f32 v96, v75, v33
v_mfma_f32_16x16x32_bf16 a[32:35], v[164:167], v[128:131], a[32:35]
ds_read_b128 v[204:207], v25 offset:38912
v_and_b32 v97, 0xffff0000, v52
v_mfma_f32_16x16x32_bf16 a[64:67], v[168:171], v[128:131], a[64:67]
v_fmac_f32 v96, v74, v34
v_fmac_f32 v96, v73, v35
v_mfma_f32_16x16x32_bf16 a[68:71], v[168:171], v[132:135], a[68:71]
ds_read_b128 v[208:211], v25 offset:40960
v_fmac_f32 v96, v72, v36
v_mfma_f32_16x16x32_bf16 a[72:75], v[168:171], v[136:139], a[72:75]
v_mul_f32 v96, v96, v97
v_cvt_pk_bf16_f32 v107, v95, v96
v_mfma_f32_16x16x32_bf16 a[76:79], v[168:171], v[140:143], a[76:79]
ds_read_b128 v[212:215], v25 offset:43008
ds_write_b128 v28, v[104:107] offset:288
v_mfma_f32_16x16x32_bf16 a[80:83], v[168:171], v[144:147], a[80:83]
v_mfma_f32_16x16x32_bf16 a[84:87], v[168:171], v[148:151], a[84:87]
ds_read_b128 v[216:219], v25 offset:45056
v_mfma_f32_16x16x32_bf16 a[88:91], v[168:171], v[152:155], a[88:91]
v_mfma_f32_16x16x32_bf16 a[92:95], v[168:171], v[156:159], a[92:95]
ds_read_b128 v[220:223], v25 offset:47104
v_mfma_f32_16x16x32_bf16 a[124:127], v[172:175], v[156:159], a[124:127]
v_mfma_f32_16x16x32_bf16 a[120:123], v[172:175], v[152:155], a[120:123]
ds_read_b64_tr_b16 v[228:229], v21 offset:40960
v_mfma_f32_16x16x32_bf16 a[116:119], v[172:175], v[148:151], a[116:119]
v_mfma_f32_16x16x32_bf16 a[112:115], v[172:175], v[144:147], a[112:115]
ds_read_b64_tr_b16 v[230:231], v21 offset:41984
v_mfma_f32_16x16x32_bf16 a[108:111], v[172:175], v[140:143], a[108:111]
v_mfma_f32_16x16x32_bf16 a[104:107], v[172:175], v[136:139], a[104:107]
ds_read_b64_tr_b16 v[232:233], v22 offset:40960
v_mfma_f32_16x16x32_bf16 a[100:103], v[172:175], v[132:135], a[100:103]
v_mfma_f32_16x16x32_bf16 a[96:99], v[172:175], v[128:131], a[96:99]
ds_read_b64_tr_b16 v[234:235], v22 offset:41984
v_mfma_f32_16x16x32_bf16 a[128:131], v[128:131], v[176:179], a[128:131]
v_mfma_f32_16x16x32_bf16 a[132:135], v[132:135], v[176:179], a[132:135]
ds_read_b64_tr_b16 v[236:237], v23 offset:40960
v_mfma_f32_16x16x32_bf16 a[136:139], v[136:139], v[176:179], a[136:139]
v_mfma_f32_16x16x32_bf16 a[140:143], v[140:143], v[176:179], a[140:143]
ds_read_b64_tr_b16 v[238:239], v23 offset:41984
v_mfma_f32_16x16x32_bf16 a[144:147], v[144:147], v[176:179], a[144:147]
v_mfma_f32_16x16x32_bf16 a[148:151], v[148:151], v[176:179], a[148:151]
ds_read_b64_tr_b16 v[240:241], v20 offset:57344
v_mfma_f32_16x16x32_bf16 a[152:155], v[152:155], v[176:179], a[152:155]
v_mfma_f32_16x16x32_bf16 a[156:159], v[156:159], v[176:179], a[156:159]
ds_read_b64_tr_b16 v[242:243], v20 offset:58368
v_mfma_f32_16x16x32_bf16 a[188:191], v[156:159], v[180:183], a[188:191]
v_mfma_f32_16x16x32_bf16 a[184:187], v[152:155], v[180:183], a[184:187]
ds_read_b64_tr_b16 v[244:245], v21 offset:57344
v_mfma_f32_16x16x32_bf16 a[180:183], v[148:151], v[180:183], a[180:183]
v_mfma_f32_16x16x32_bf16 a[176:179], v[144:147], v[180:183], a[176:179]
ds_read_b64_tr_b16 v[246:247], v21 offset:58368
v_mfma_f32_16x16x32_bf16 a[172:175], v[140:143], v[180:183], a[172:175]
v_mfma_f32_16x16x32_bf16 a[168:171], v[136:139], v[180:183], a[168:171]
ds_read_b64_tr_b16 v[248:249], v22 offset:57344
v_mfma_f32_16x16x32_bf16 a[164:167], v[132:135], v[180:183], a[164:167]
v_mfma_f32_16x16x32_bf16 a[160:163], v[128:131], v[180:183], a[160:163]
ds_read_b64_tr_b16 v[250:251], v22 offset:58368
v_mfma_f32_16x16x32_bf16 a[192:195], v[128:131], v[184:187], a[192:195]
v_mfma_f32_16x16x32_bf16 a[196:199], v[132:135], v[184:187], a[196:199]
ds_read_b64_tr_b16 v[252:253], v23 offset:57344
v_mfma_f32_16x16x32_bf16 a[200:203], v[136:139], v[184:187], a[200:203]
v_mfma_f32_16x16x32_bf16 a[204:207], v[140:143], v[184:187], a[204:207]
ds_read_b64_tr_b16 v[254:255], v23 offset:58368
v_mfma_f32_16x16x32_bf16 a[208:211], v[144:147], v[184:187], a[208:211]
v_mfma_f32_16x16x32_bf16 a[212:215], v[148:151], v[184:187], a[212:215]
v_mfma_f32_16x16x32_bf16 a[216:219], v[152:155], v[184:187], a[216:219]
v_mfma_f32_16x16x32_bf16 a[220:223], v[156:159], v[184:187], a[220:223]
v_mfma_f32_16x16x32_bf16 a[252:255], v[156:159], v[188:191], a[252:255]
v_mfma_f32_16x16x32_bf16 a[248:251], v[152:155], v[188:191], a[248:251]
v_mfma_f32_16x16x32_bf16 a[244:247], v[148:151], v[188:191], a[244:247]
v_mfma_f32_16x16x32_bf16 a[240:243], v[144:147], v[188:191], a[240:243]
v_mfma_f32_16x16x32_bf16 a[236:239], v[140:143], v[188:191], a[236:239]
v_mfma_f32_16x16x32_bf16 a[232:235], v[136:139], v[188:191], a[232:235]
v_mfma_f32_16x16x32_bf16 a[228:231], v[132:135], v[188:191], a[228:231]
s_waitcnt vmcnt(4) lgkmcnt(0)
v_mfma_f32_16x16x32_bf16 a[224:227], v[128:131], v[188:191], a[224:227]
s_barrier
v_mfma_f32_16x16x32_bf16 a[0:3], v[224:227], v[192:195], a[0:3]
s_and_b32 s73, s65, 1
ds_read_b64_tr_b16 v[160:161], v20 offset:0
v_mfma_f32_16x16x32_bf16 a[4:7], v[224:227], v[196:199], a[4:7]
s_xor_b32 s73, s73, 7
ds_read_b64_tr_b16 v[162:163], v20 offset:1024
v_mfma_f32_16x16x32_bf16 a[8:11], v[224:227], v[200:203], a[8:11]
s_lshl_b32 s69, s73, 7
ds_read_b128 v[128:131], v24 offset:0
v_mfma_f32_16x16x32_bf16 a[12:15], v[224:227], v[204:207], a[12:15]
s_add_u32 s69, s69, s67
ds_read_b128 v[132:135], v24 offset:2048
v_mfma_f32_16x16x32_bf16 a[16:19], v[224:227], v[208:211], a[16:19]
s_lshl_b32 s71, s73, 19
ds_read_b128 v[136:139], v24 offset:4096
v_mfma_f32_16x16x32_bf16 a[20:23], v[224:227], v[212:215], a[20:23]
s_add_u32 s71, s71, s66
ds_read_b128 v[140:143], v24 offset:6144
v_mfma_f32_16x16x32_bf16 a[24:27], v[224:227], v[216:219], a[24:27]
s_add_u32 m0, s63, 98304
ds_read_b128 v[144:147], v24 offset:8192
v_mfma_f32_16x16x32_bf16 a[28:31], v[224:227], v[220:223], a[28:31]
s_add_u32 s72, s69, 0
buffer_load_dwordx4 v2, s[8:11], s72 offen lds
v_mfma_f32_16x16x32_bf16 a[60:63], v[228:231], v[220:223], a[60:63]
s_add_u32 s72, s69, 7168
buffer_load_dwordx4 v3, s[8:11], s72 offen offset:1024 lds
v_mfma_f32_16x16x32_bf16 a[56:59], v[228:231], v[216:219], a[56:59]
s_add_u32 s72, s69, 14336
buffer_load_dwordx4 v2, s[8:11], s72 offen offset:2048 lds
v_mfma_f32_16x16x32_bf16 a[52:55], v[228:231], v[212:215], a[52:55]
s_mul_i32 s74, s58, 4352
ds_read_b128 v[148:151], v24 offset:10240
v_mfma_f32_16x16x32_bf16 a[48:51], v[228:231], v[208:211], a[48:51]
s_add_u32 s74, s74, 131072
ds_read_b128 v[152:155], v24 offset:12288
v_lshrrev_b32 v26, 4, v0
v_mfma_f32_16x16x32_bf16 a[44:47], v[228:231], v[204:207], a[44:47]
s_add_u32 s72, s69, 21504
buffer_load_dwordx4 v3, s[8:11], s72 offen offset:3072 lds
v_mfma_f32_16x16x32_bf16 a[40:43], v[228:231], v[200:203], a[40:43]
ds_read_b128 v[156:159], v24 offset:14336
v_and_b32 v27, 15, v0
v_mfma_f32_16x16x32_bf16 a[36:39], v[228:231], v[196:199], a[36:39]
ds_read_b64_tr_b16 v[164:165], v21 offset:0
v_lshlrev_b32 v27, 4, v27
v_mfma_f32_16x16x32_bf16 a[32:35], v[228:231], v[192:195], a[32:35]
ds_read_b64_tr_b16 v[166:167], v21 offset:1024
v_mul_u32_u24 v28, 272, v26
v_mfma_f32_16x16x32_bf16 a[64:67], v[232:235], v[192:195], a[64:67]
ds_read_b64_tr_b16 v[168:169], v22 offset:0
v_add3_u32 v28, v28, v27, s74
v_mfma_f32_16x16x32_bf16 a[68:71], v[232:235], v[196:199], a[68:71]
s_add_u32 m0, s64, 32768
ds_read_b64_tr_b16 v[170:171], v22 offset:1024
v_lshl_add_u32 v26, v26, 12, v27
v_mfma_f32_16x16x32_bf16 a[72:75], v[232:235], v[200:203], a[72:75]
s_add_u32 s72, s71, 0
buffer_load_dwordx4 v6, s[16:19], s72 offen lds
v_mfma_f32_16x16x32_bf16 a[76:79], v[232:235], v[204:207], a[76:79]
ds_read_b64_tr_b16 v[172:173], v23 offset:0
ds_read_b128 v[36:39], v28 offset:0
v_mfma_f32_16x16x32_bf16 a[80:83], v[232:235], v[208:211], a[80:83]
ds_read_b64_tr_b16 v[174:175], v23 offset:1024
ds_read_b128 v[40:43], v28 offset:1088
v_mfma_f32_16x16x32_bf16 a[84:87], v[232:235], v[212:215], a[84:87]
s_add_u32 s72, s71, 31744
buffer_load_dwordx4 v6, s[16:19], s72 offen offset:1024 lds
v_mfma_f32_16x16x32_bf16 a[88:91], v[232:235], v[216:219], a[88:91]
ds_read_b64_tr_b16 v[176:177], v20 offset:16384
ds_read_b128 v[44:47], v28 offset:2176
v_mfma_f32_16x16x32_bf16 a[92:95], v[232:235], v[220:223], a[92:95]
ds_read_b64_tr_b16 v[178:179], v20 offset:17408
ds_read_b128 v[48:51], v28 offset:3264
v_mfma_f32_16x16x32_bf16 a[124:127], v[236:239], v[220:223], a[124:127]
s_and_b32 s74, s2, 15
ds_read_b64_tr_b16 v[180:181], v21 offset:16384
v_mfma_f32_16x16x32_bf16 a[120:123], v[236:239], v[216:219], a[120:123]
s_add_u32 s72, s71, 63488
buffer_load_dwordx4 v7, s[16:19], s72 offen offset:2048 lds
v_mfma_f32_16x16x32_bf16 a[116:119], v[236:239], v[212:215], a[116:119]
s_lshl_b32 s74, s74, 2
ds_read_b64_tr_b16 v[182:183], v21 offset:17408
v_mfma_f32_16x16x32_bf16 a[112:115], v[236:239], v[208:211], a[112:115]
s_add_u32 s74, s74, s58
ds_read_b64_tr_b16 v[184:185], v22 offset:16384
v_mfma_f32_16x16x32_bf16 a[108:111], v[236:239], v[204:207], a[108:111]
s_lshl_b32 s74, s74, 16
ds_read_b64_tr_b16 v[186:187], v22 offset:17408
v_mfma_f32_16x16x32_bf16 a[104:107], v[236:239], v[200:203], a[104:107]
s_lshr_b32 s75, s2, 4
ds_read_b64_tr_b16 v[188:189], v23 offset:16384
v_mfma_f32_16x16x32_bf16 a[100:103], v[236:239], v[196:199], a[100:103]
s_add_u32 s72, s71, 95232
buffer_load_dwordx4 v7, s[16:19], s72 offen offset:3072 lds
v_mfma_f32_16x16x32_bf16 a[96:99], v[236:239], v[192:195], a[96:99]
s_lshl_b32 s75, s75, 8
ds_read_b64_tr_b16 v[190:191], v23 offset:17408
v_mfma_f32_16x16x32_bf16 a[128:131], v[192:195], v[240:243], a[128:131]
s_sub_u32 s74, s74, s75
v_mfma_f32_16x16x32_bf16 a[132:135], v[196:199], v[240:243], a[132:135]
s_add_u32 s74, s74, 0x3000f00
v_mfma_f32_16x16x32_bf16 a[136:139], v[200:203], v[240:243], a[136:139]
s_add_u32 m0, s63, 102400
v_mfma_f32_16x16x32_bf16 a[140:143], v[204:207], v[240:243], a[140:143]
s_add_u32 s72, s69, 32768
buffer_load_dwordx4 v2, s[8:11], s72 offen lds
v_mfma_f32_16x16x32_bf16 a[144:147], v[208:211], v[240:243], a[144:147]
s_waitcnt vmcnt(29)
v_lshlrev_b32 v78, 16, v84
v_lshlrev_b32 v79, 16, v108
v_mfma_f32_16x16x32_bf16 a[148:151], v[212:215], v[240:243], a[148:151]
v_mul_f32 v76, v78, v79
v_lshlrev_b32 v80, 16, v116
v_mfma_f32_16x16x32_bf16 a[152:155], v[216:219], v[240:243], a[152:155]
s_add_u32 s72, s69, 39936
buffer_load_dwordx4 v3, s[8:11], s72 offen offset:1024 lds
v_mfma_f32_16x16x32_bf16 a[156:159], v[220:223], v[240:243], a[156:159]
v_mul_f32 v77, v78, v80
v_and_b32 v78, 0xffff0000, v84
v_mfma_f32_16x16x32_bf16 a[188:191], v[220:223], v[244:247], a[188:191]
v_and_b32 v79, 0xffff0000, v108
v_fmac_f32 v76, v78, v79
v_mfma_f32_16x16x32_bf16 a[184:187], v[216:219], v[244:247], a[184:187]
v_and_b32 v80, 0xffff0000, v116
v_fmac_f32 v77, v78, v80
v_mfma_f32_16x16x32_bf16 a[180:183], v[212:215], v[244:247], a[180:183]
v_lshlrev_b32 v78, 16, v85
v_lshlrev_b32 v79, 16, v109
v_mfma_f32_16x16x32_bf16 a[176:179], v[208:211], v[244:247], a[176:179]
s_add_u32 s72, s69, 47104
buffer_load_dwordx4 v2, s[8:11], s72 offen offset:2048 lds
v_mfma_f32_16x16x32_bf16 a[172:175], v[204:207], v[244:247], a[172:175]
v_fmac_f32 v76, v78, v79
v_lshlrev_b32 v80, 16, v117
v_mfma_f32_16x16x32_bf16 a[168:171], v[200:203], v[244:247], a[168:171]
v_fmac_f32 v77, v78, v80
v_and_b32 v78, 0xffff0000, v85
v_mfma_f32_16x16x32_bf16 a[164:167], v[196:199], v[244:247], a[164:167]
v_and_b32 v79, 0xffff0000, v109
v_fmac_f32 v76, v78, v79
v_mfma_f32_16x16x32_bf16 a[160:163], v[192:195], v[244:247], a[160:163]
s_add_u32 s72, s69, 54272
buffer_load_dwordx4 v3, s[8:11], s72 offen offset:3072 lds
v_mfma_f32_16x16x32_bf16 a[192:195], v[192:195], v[248:251], a[192:195]
v_and_b32 v80, 0xffff0000, v117
v_fmac_f32 v77, v78, v80
v_mfma_f32_16x16x32_bf16 a[196:199], v[196:199], v[248:251], a[196:199]
v_lshlrev_b32 v78, 16, v86
v_lshlrev_b32 v79, 16, v110
v_mfma_f32_16x16x32_bf16 a[200:203], v[200:203], v[248:251], a[200:203]
v_fmac_f32 v76, v78, v79
v_lshlrev_b32 v80, 16, v118
v_mfma_f32_16x16x32_bf16 a[204:207], v[204:207], v[248:251], a[204:207]
s_add_u32 m0, s64, 49152
v_fmac_f32 v77, v78, v80
v_and_b32 v78, 0xffff0000, v86
v_mfma_f32_16x16x32_bf16 a[208:211], v[208:211], v[248:251], a[208:211]
s_add_u32 s72, s71, 0
buffer_load_dwordx4 v6, s[20:23], s72 offen lds
v_mfma_f32_16x16x32_bf16 a[212:215], v[212:215], v[248:251], a[212:215]
v_and_b32 v79, 0xffff0000, v110
v_fmac_f32 v76, v78, v79
v_mfma_f32_16x16x32_bf16 a[216:219], v[216:219], v[248:251], a[216:219]
v_and_b32 v80, 0xffff0000, v118
v_fmac_f32 v77, v78, v80
v_mfma_f32_16x16x32_bf16 a[220:223], v[220:223], v[248:251], a[220:223]
v_lshlrev_b32 v78, 16, v87
v_lshlrev_b32 v79, 16, v111
v_mfma_f32_16x16x32_bf16 a[252:255], v[220:223], v[252:255], a[252:255]
s_add_u32 s72, s71, 31744
buffer_load_dwordx4 v6, s[20:23], s72 offen offset:1024 lds
v_mfma_f32_16x16x32_bf16 a[248:251], v[216:219], v[252:255], a[248:251]
v_fmac_f32 v76, v78, v79
v_lshlrev_b32 v80, 16, v119
v_mfma_f32_16x16x32_bf16 a[244:247], v[212:215], v[252:255], a[244:247]
v_fmac_f32 v77, v78, v80
v_and_b32 v78, 0xffff0000, v87
v_mfma_f32_16x16x32_bf16 a[240:243], v[208:211], v[252:255], a[240:243]
v_and_b32 v79, 0xffff0000, v111
v_fmac_f32 v76, v78, v79
v_mfma_f32_16x16x32_bf16 a[236:239], v[204:207], v[252:255], a[236:239]
s_add_u32 s72, s71, 63488
buffer_load_dwordx4 v7, s[20:23], s72 offen offset:2048 lds
v_mfma_f32_16x16x32_bf16 a[232:235], v[200:203], v[252:255], a[232:235]
v_and_b32 v80, 0xffff0000, v119
v_fmac_f32 v77, v78, v80
v_mfma_f32_16x16x32_bf16 a[228:231], v[196:199], v[252:255], a[228:231]
v_lshlrev_b32 v78, 16, v88
v_lshlrev_b32 v79, 16, v112
v_mfma_f32_16x16x32_bf16 a[224:227], v[192:195], v[252:255], a[224:227]
s_waitcnt lgkmcnt(0)
v_fmac_f32 v76, v78, v79
v_lshlrev_b32 v80, 16, v120
v_mfma_f32_16x16x32_bf16 a[0:3], v[160:163], v[128:131], a[0:3]
s_add_u32 s72, s71, 95232
buffer_load_dwordx4 v7, s[20:23], s72 offen offset:3072 lds
v_mfma_f32_16x16x32_bf16 a[4:7], v[160:163], v[132:135], a[4:7]
ds_read_b64_tr_b16 v[224:225], v20 offset:8192
v_fmac_f32 v77, v78, v80
v_mfma_f32_16x16x32_bf16 a[8:11], v[160:163], v[136:139], a[8:11]
ds_read_b64_tr_b16 v[226:227], v20 offset:9216
v_and_b32 v78, 0xffff0000, v88
v_mfma_f32_16x16x32_bf16 a[12:15], v[160:163], v[140:143], a[12:15]
ds_read_b128 v[192:195], v25 offset:0
v_and_b32 v79, 0xffff0000, v112
v_mfma_f32_16x16x32_bf16 a[16:19], v[160:163], v[144:147], a[16:19]
ds_read_b128 v[196:199], v25 offset:2048
v_fmac_f32 v76, v78, v79
v_mfma_f32_16x16x32_bf16 a[20:23], v[160:163], v[148:151], a[20:23]
ds_read_b128 v[200:203], v25 offset:4096
v_and_b32 v80, 0xffff0000, v120
v_mfma_f32_16x16x32_bf16 a[24:27], v[160:163], v[152:155], a[24:27]
ds_read_b128 v[204:207], v25 offset:6144
v_fmac_f32 v77, v78, v80
v_mfma_f32_16x16x32_bf16 a[28:31], v[160:163], v[156:159], a[28:31]
ds_read_b128 v[208:211], v25 offset:8192
v_lshlrev_b32 v78, 16, v89
v_mfma_f32_16x16x32_bf16 a[60:63], v[164:167], v[156:159], a[60:63]
buffer_store_dwordx4 v[36:39], v26, s[44:47], s74 offen sc1
v_mfma_f32_16x16x32_bf16 a[56:59], v[164:167], v[152:155], a[56:59]
ds_read_b128 v[212:215], v25 offset:10240
v_lshlrev_b32 v79, 16, v113
v_mfma_f32_16x16x32_bf16 a[52:55], v[164:167], v[148:151], a[52:55]
ds_read_b128 v[216:219], v25 offset:12288
v_fmac_f32 v76, v78, v79
v_mfma_f32_16x16x32_bf16 a[48:51], v[164:167], v[144:147], a[48:51]
ds_read_b128 v[220:223], v25 offset:14336
v_lshlrev_b32 v80, 16, v121
v_mfma_f32_16x16x32_bf16 a[44:47], v[164:167], v[140:143], a[44:47]
ds_read_b64_tr_b16 v[228:229], v21 offset:8192
v_fmac_f32 v77, v78, v80
v_mfma_f32_16x16x32_bf16 a[40:43], v[164:167], v[136:139], a[40:43]
ds_read_b64_tr_b16 v[230:231], v21 offset:9216
v_and_b32 v78, 0xffff0000, v89
v_mfma_f32_16x16x32_bf16 a[36:39], v[164:167], v[132:135], a[36:39]
ds_read_b64_tr_b16 v[232:233], v22 offset:8192
v_and_b32 v79, 0xffff0000, v113
v_mfma_f32_16x16x32_bf16 a[32:35], v[164:167], v[128:131], a[32:35]
ds_read_b64_tr_b16 v[234:235], v22 offset:9216
v_fmac_f32 v76, v78, v79
v_mfma_f32_16x16x32_bf16 a[64:67], v[168:171], v[128:131], a[64:67]
ds_read_b64_tr_b16 v[236:237], v23 offset:8192
v_and_b32 v80, 0xffff0000, v121
v_mfma_f32_16x16x32_bf16 a[68:71], v[168:171], v[132:135], a[68:71]
ds_read_b64_tr_b16 v[238:239], v23 offset:9216
v_fmac_f32 v77, v78, v80
v_mfma_f32_16x16x32_bf16 a[72:75], v[168:171], v[136:139], a[72:75]
ds_read_b64_tr_b16 v[240:241], v20 offset:24576
v_lshlrev_b32 v78, 16, v90
v_mfma_f32_16x16x32_bf16 a[76:79], v[168:171], v[140:143], a[76:79]
ds_read_b64_tr_b16 v[242:243], v20 offset:25600
v_lshlrev_b32 v79, 16, v114
v_mfma_f32_16x16x32_bf16 a[80:83], v[168:171], v[144:147], a[80:83]
s_lshr_b32 s75, s93, 5
ds_read_b64_tr_b16 v[244:245], v21 offset:24576
v_fmac_f32 v76, v78, v79
v_mfma_f32_16x16x32_bf16 a[84:87], v[168:171], v[148:151], a[84:87]
s_add_u32 s74, s74, 0x4000
buffer_store_dwordx4 v[40:43], v26, s[44:47], s74 offen sc1
v_mfma_f32_16x16x32_bf16 a[88:91], v[168:171], v[152:155], a[88:91]
s_and_b32 s75, s75, 0x3f80
ds_read_b64_tr_b16 v[246:247], v21 offset:25600
v_lshlrev_b32 v80, 16, v122
v_mfma_f32_16x16x32_bf16 a[92:95], v[168:171], v[156:159], a[92:95]
s_add_u32 s75, s75, LcB0-Lpc0
v_lshrrev_b32 v2, 6, v0
v_lshlrev_b32 v2, 7, v2
v_mfma_f32_16x16x32_bf16 a[124:127], v[172:175], v[156:159], a[124:127]
v_add_u32 v2, s75, v2
v_min_u32 v2, Lcode_end-Lpc0, v2
v_mfma_f32_16x16x32_bf16 a[120:123], v[172:175], v[152:155], a[120:123]
global_load_dword v3, v2, s[98:99]
v_mfma_f32_16x16x32_bf16 a[116:119], v[172:175], v[148:151], a[116:119]
ds_read_b64_tr_b16 v[248:249], v22 offset:24576
v_fmac_f32 v77, v78, v80
v_mfma_f32_16x16x32_bf16 a[112:115], v[172:175], v[144:147], a[112:115]
ds_read_b64_tr_b16 v[250:251], v22 offset:25600
v_and_b32 v78, 0xffff0000, v90
v_mfma_f32_16x16x32_bf16 a[108:111], v[172:175], v[140:143], a[108:111]
ds_read_b64_tr_b16 v[252:253], v23 offset:24576
v_and_b32 v79, 0xffff0000, v114
v_mfma_f32_16x16x32_bf16 a[104:107], v[172:175], v[136:139], a[104:107]
ds_read_b64_tr_b16 v[254:255], v23 offset:25600
v_fmac_f32 v76, v78, v79
v_mfma_f32_16x16x32_bf16 a[100:103], v[172:175], v[132:135], a[100:103]
v_and_b32 v80, 0xffff0000, v122
v_fmac_f32 v77, v78, v80
v_mfma_f32_16x16x32_bf16 a[96:99], v[172:175], v[128:131], a[96:99]
v_lshlrev_b32 v78, 16, v91
v_lshlrev_b32 v79, 16, v115
v_mfma_f32_16x16x32_bf16 a[128:131], v[128:131], v[176:179], a[128:131]
v_fmac_f32 v76, v78, v79
v_lshlrev_b32 v80, 16, v123
v_mfma_f32_16x16x32_bf16 a[132:135], v[132:135], v[176:179], a[132:135]
v_fmac_f32 v77, v78, v80
v_and_b32 v78, 0xffff0000, v91
v_mfma_f32_16x16x32_bf16 a[136:139], v[136:139], v[176:179], a[136:139]
v_and_b32 v79, 0xffff0000, v115
v_fmac_f32 v76, v78, v79
v_mfma_f32_16x16x32_bf16 a[140:143], v[140:143], v[176:179], a[140:143]
s_add_u32 s74, s74, 0x4000
buffer_store_dwordx4 v[44:47], v26, s[44:47], s74 offen sc1
v_mfma_f32_16x16x32_bf16 a[144:147], v[144:147], v[176:179], a[144:147]
v_and_b32 v80, 0xffff0000, v123
v_fmac_f32 v77, v78, v80
v_mfma_f32_16x16x32_bf16 a[148:151], v[148:151], v[176:179], a[148:151]
v_add_f32_dpp v76, v76, v76 row_ror:8 row_mask:0xf bank_mask:0xf
v_add_f32_dpp v77, v77, v77 row_ror:8 row_mask:0xf bank_mask:0xf
v_mfma_f32_16x16x32_bf16 a[152:155], v[152:155], v[176:179], a[152:155]
v_add_f32_dpp v76, v76, v76 row_ror:4 row_mask:0xf bank_mask:0xf
v_add_f32_dpp v77, v77, v77 row_ror:4 row_mask:0xf bank_mask:0xf
v_mfma_f32_16x16x32_bf16 a[156:159], v[156:159], v[176:179], a[156:159]
v_add_f32_dpp v76, v76, v76 row_ror:2 row_mask:0xf bank_mask:0xf
v_add_f32_dpp v77, v77, v77 row_ror:2 row_mask:0xf bank_mask:0xf
v_mfma_f32_16x16x32_bf16 a[188:191], v[156:159], v[180:183], a[188:191]
v_add_f32_dpp v76, v76, v76 row_ror:1 row_mask:0xf bank_mask:0xf
v_add_f32_dpp v77, v77, v77 row_ror:1 row_mask:0xf bank_mask:0xf
v_mfma_f32_16x16x32_bf16 a[184:187], v[152:155], v[180:183], a[184:187]
v_mov_b32 v78, v76
v_mov_b32 v79, v77
v_mfma_f32_16x16x32_bf16 a[180:183], v[148:151], v[180:183], a[180:183]
v_permlane16_swap_b32 v76, v78
v_permlane16_swap_b32 v77, v79
v_mfma_f32_16x16x32_bf16 a[176:179], v[144:147], v[180:183], a[176:179]
v_add_f32 v76, v76, v78
v_add_f32 v77, v77, v79
v_mfma_f32_16x16x32_bf16 a[172:175], v[140:143], v[180:183], a[172:175]
v_mov_b32 v78, v76
v_mov_b32 v79, v77
v_mfma_f32_16x16x32_bf16 a[168:171], v[136:139], v[180:183], a[168:171]
v_permlane32_swap_b32 v76, v78
v_permlane32_swap_b32 v77, v79
v_mfma_f32_16x16x32_bf16 a[164:167], v[132:135], v[180:183], a[164:167]
v_add_f32 v76, v76, v78
v_add_f32 v77, v77, v79
v_mfma_f32_16x16x32_bf16 a[160:163], v[128:131], v[180:183], a[160:163]
v_mul_f32 v76, 0xbfb8aa3b, v76
v_mul_f32 v77, 0xbfb8aa3b, v77
v_mfma_f32_16x16x32_bf16 a[192:195], v[128:131], v[184:187], a[192:195]
v_exp_f32 v76, v76
v_mfma_f32_16x16x32_bf16 a[196:199], v[132:135], v[184:187], a[196:199]
s_add_u32 s74, s74, 0x4000
buffer_store_dwordx4 v[48:51], v26, s[44:47], s74 offen sc1
v_mfma_f32_16x16x32_bf16 a[200:203], v[136:139], v[184:187], a[200:203]
v_exp_f32 v77, v77
v_mfma_f32_16x16x32_bf16 a[204:207], v[140:143], v[184:187], a[204:207]
v_add_f32 v76, 1.0, v76
v_add_f32 v77, 1.0, v77
v_mfma_f32_16x16x32_bf16 a[208:211], v[144:147], v[184:187], a[208:211]
v_rcp_f32 v76, v76
v_mfma_f32_16x16x32_bf16 a[212:215], v[148:151], v[184:187], a[212:215]
v_rcp_f32 v77, v77
v_mfma_f32_16x16x32_bf16 a[216:219], v[152:155], v[184:187], a[216:219]
s_lshr_b32 s80, s76, 9
v_mfma_f32_16x16x32_bf16 a[220:223], v[156:159], v[184:187], a[220:223]
s_add_u32 s80, s80, 0x3800000
v_min_u32 v78, 1, v0
v_lshlrev_b32 v78, 30, v78
v_mfma_f32_16x16x32_bf16 a[252:255], v[156:159], v[188:191], a[252:255]
buffer_store_dwordx2 v[76:77], v78, s[44:47], s80 offen sc1
v_mfma_f32_16x16x32_bf16 a[248:251], v[152:155], v[188:191], a[248:251]
v_mfma_f32_16x16x32_bf16 a[244:247], v[148:151], v[188:191], a[244:247]
v_mfma_f32_16x16x32_bf16 a[240:243], v[144:147], v[188:191], a[240:243]
v_mfma_f32_16x16x32_bf16 a[236:239], v[140:143], v[188:191], a[236:239]
v_mfma_f32_16x16x32_bf16 a[232:235], v[136:139], v[188:191], a[232:235]
v_mfma_f32_16x16x32_bf16 a[228:231], v[132:135], v[188:191], a[228:231]
s_waitcnt vmcnt(6) lgkmcnt(0)
v_mfma_f32_16x16x32_bf16 a[224:227], v[128:131], v[188:191], a[224:227]
s_barrier
v_mfma_f32_16x16x32_bf16 a[0:3], v[224:227], v[192:195], a[0:3]
s_add_u32 s73, s62, 0
ds_read_b64_tr_b16 v[160:161], v20 offset:32768
v_mfma_f32_16x16x32_bf16 a[4:7], v[224:227], v[196:199], a[4:7]
s_add_u32 s70, s73, s65
ds_read_b64_tr_b16 v[162:163], v20 offset:33792
v_mfma_f32_16x16x32_bf16 a[8:11], v[224:227], v[200:203], a[8:11]
s_and_b32 s70, s70, 3
ds_read_b128 v[128:131], v24 offset:32768
v_mfma_f32_16x16x32_bf16 a[12:15], v[224:227], v[204:207], a[12:15]
s_and_b32 s73, s73, 12
ds_read_b128 v[132:135], v24 offset:34816
v_mfma_f32_16x16x32_bf16 a[16:19], v[224:227], v[208:211], a[16:19]
s_or_b32 s73, s73, s70
ds_read_b128 v[136:139], v24 offset:36864
v_mfma_f32_16x16x32_bf16 a[20:23], v[224:227], v[212:215], a[20:23]
s_lshl_b32 s71, s73, 19
ds_read_b128 v[140:143], v24 offset:38912
v_mfma_f32_16x16x32_bf16 a[24:27], v[224:227], v[216:219], a[24:27]
s_add_u32 s71, s71, s66
ds_read_b128 v[144:147], v24 offset:40960
v_mfma_f32_16x16x32_bf16 a[28:31], v[224:227], v[220:223], a[28:31]
s_lshl_b32 s73, s73, 7
ds_read_b128 v[148:151], v24 offset:43008
v_mfma_f32_16x16x32_bf16 a[60:63], v[228:231], v[220:223], a[60:63]
s_add_u32 s69, s73, s67
ds_read_b128 v[152:155], v24 offset:45056
v_mfma_f32_16x16x32_bf16 a[56:59], v[228:231], v[216:219], a[56:59]
s_add_u32 s70, s73, s68
ds_read_b128 v[156:159], v24 offset:47104
v_mfma_f32_16x16x32_bf16 a[52:55], v[228:231], v[212:215], a[52:55]
s_add_u32 m0, s64, 0
ds_read_b64_tr_b16 v[164:165], v21 offset:32768
v_mfma_f32_16x16x32_bf16 a[48:51], v[228:231], v[208:211], a[48:51]
s_add_u32 s72, s71, 0
buffer_load_dwordx4 v6, s[12:15], s72 offen lds
v_mfma_f32_16x16x32_bf16 a[44:47], v[228:231], v[204:207], a[44:47]
s_add_u32 s72, s71, 31744
buffer_load_dwordx4 v6, s[12:15], s72 offen offset:1024 lds
v_mfma_f32_16x16x32_bf16 a[40:43], v[228:231], v[200:203], a[40:43]
s_add_u32 s72, s71, 63488
buffer_load_dwordx4 v7, s[12:15], s72 offen offset:2048 lds
v_mfma_f32_16x16x32_bf16 a[36:39], v[228:231], v[196:199], a[36:39]
ds_read_b64_tr_b16 v[166:167], v21 offset:33792
v_mfma_f32_16x16x32_bf16 a[32:35], v[228:231], v[192:195], a[32:35]
s_add_u32 s72, s71, 95232
buffer_load_dwordx4 v7, s[12:15], s72 offen offset:3072 lds
v_mfma_f32_16x16x32_bf16 a[64:67], v[232:235], v[192:195], a[64:67]
ds_read_b64_tr_b16 v[168:169], v22 offset:32768
v_mfma_f32_16x16x32_bf16 a[68:71], v[232:235], v[196:199], a[68:71]
ds_read_b64_tr_b16 v[170:171], v22 offset:33792
v_mfma_f32_16x16x32_bf16 a[72:75], v[232:235], v[200:203], a[72:75]
ds_read_b64_tr_b16 v[172:173], v23 offset:32768
v_mfma_f32_16x16x32_bf16 a[76:79], v[232:235], v[204:207], a[76:79]
ds_read_b64_tr_b16 v[174:175], v23 offset:33792
v_mfma_f32_16x16x32_bf16 a[80:83], v[232:235], v[208:211], a[80:83]
s_add_u32 m0, s63, 131072
ds_read_b64_tr_b16 v[176:177], v20 offset:49152
v_mfma_f32_16x16x32_bf16 a[84:87], v[232:235], v[212:215], a[84:87]
s_add_u32 s72, s69, 0
buffer_load_dwordx4 v4, s[4:7], s72 offen lds
v_mfma_f32_16x16x32_bf16 a[88:91], v[232:235], v[216:219], a[88:91]
ds_read_b64_tr_b16 v[178:179], v20 offset:50176
v_mfma_f32_16x16x32_bf16 a[92:95], v[232:235], v[220:223], a[92:95]
ds_read_b64_tr_b16 v[180:181], v21 offset:49152
v_mfma_f32_16x16x32_bf16 a[124:127], v[236:239], v[220:223], a[124:127]
ds_read_b64_tr_b16 v[182:183], v21 offset:50176
v_mfma_f32_16x16x32_bf16 a[120:123], v[236:239], v[216:219], a[120:123]
s_add_u32 s72, s69, 15360
buffer_load_dwordx4 v5, s[4:7], s72 offen offset:1024 lds
v_mfma_f32_16x16x32_bf16 a[116:119], v[236:239], v[212:215], a[116:119]
ds_read_b64_tr_b16 v[184:185], v22 offset:49152
v_mfma_f32_16x16x32_bf16 a[112:115], v[236:239], v[208:211], a[112:115]
ds_read_b64_tr_b16 v[186:187], v22 offset:50176
v_mfma_f32_16x16x32_bf16 a[108:111], v[236:239], v[204:207], a[108:111]
ds_read_b64_tr_b16 v[188:189], v23 offset:49152
v_mfma_f32_16x16x32_bf16 a[104:107], v[236:239], v[200:203], a[104:107]
ds_read_b64_tr_b16 v[190:191], v23 offset:50176
v_mfma_f32_16x16x32_bf16 a[100:103], v[236:239], v[196:199], a[100:103]
s_add_u32 s72, s69, 30720
buffer_load_dwordx4 v4, s[4:7], s72 offen offset:2048 lds
v_mfma_f32_16x16x32_bf16 a[96:99], v[236:239], v[192:195], a[96:99]
v_mfma_f32_16x16x32_bf16 a[128:131], v[192:195], v[240:243], a[128:131]
v_mfma_f32_16x16x32_bf16 a[132:135], v[196:199], v[240:243], a[132:135]
v_mfma_f32_16x16x32_bf16 a[136:139], v[200:203], v[240:243], a[136:139]
v_mfma_f32_16x16x32_bf16 a[140:143], v[204:207], v[240:243], a[140:143]
s_add_u32 s72, s69, 46080
buffer_load_dwordx4 v5, s[4:7], s72 offen offset:3072 lds
v_mfma_f32_16x16x32_bf16 a[144:147], v[208:211], v[240:243], a[144:147]
v_mfma_f32_16x16x32_bf16 a[148:151], v[212:215], v[240:243], a[148:151]
v_mfma_f32_16x16x32_bf16 a[152:155], v[216:219], v[240:243], a[152:155]
v_mfma_f32_16x16x32_bf16 a[156:159], v[220:223], v[240:243], a[156:159]
v_mfma_f32_16x16x32_bf16 a[188:191], v[220:223], v[244:247], a[188:191]
s_add_u32 m0, s63, 135168
v_mfma_f32_16x16x32_bf16 a[184:187], v[216:219], v[244:247], a[184:187]
s_add_u32 s72, s70, 0
buffer_load_dwordx4 v4, s[4:7], s72 offen lds
v_mfma_f32_16x16x32_bf16 a[180:183], v[212:215], v[244:247], a[180:183]
v_mfma_f32_16x16x32_bf16 a[176:179], v[208:211], v[244:247], a[176:179]
v_mfma_f32_16x16x32_bf16 a[172:175], v[204:207], v[244:247], a[172:175]
v_mfma_f32_16x16x32_bf16 a[168:171], v[200:203], v[244:247], a[168:171]
s_add_u32 s72, s70, 15360
buffer_load_dwordx4 v5, s[4:7], s72 offen offset:1024 lds
v_mfma_f32_16x16x32_bf16 a[164:167], v[196:199], v[244:247], a[164:167]
v_mfma_f32_16x16x32_bf16 a[160:163], v[192:195], v[244:247], a[160:163]
v_mfma_f32_16x16x32_bf16 a[192:195], v[192:195], v[248:251], a[192:195]
v_mfma_f32_16x16x32_bf16 a[196:199], v[196:199], v[248:251], a[196:199]
v_mfma_f32_16x16x32_bf16 a[200:203], v[200:203], v[248:251], a[200:203]
s_add_u32 s72, s70, 30720
buffer_load_dwordx4 v4, s[4:7], s72 offen offset:2048 lds
v_mfma_f32_16x16x32_bf16 a[204:207], v[204:207], v[248:251], a[204:207]
v_mfma_f32_16x16x32_bf16 a[208:211], v[208:211], v[248:251], a[208:211]
v_mfma_f32_16x16x32_bf16 a[212:215], v[212:215], v[248:251], a[212:215]
v_mfma_f32_16x16x32_bf16 a[216:219], v[216:219], v[248:251], a[216:219]
v_mfma_f32_16x16x32_bf16 a[220:223], v[220:223], v[248:251], a[220:223]
s_add_u32 s72, s70, 46080
buffer_load_dwordx4 v5, s[4:7], s72 offen offset:3072 lds
v_mfma_f32_16x16x32_bf16 a[252:255], v[220:223], v[252:255], a[252:255]
v_mfma_f32_16x16x32_bf16 a[248:251], v[216:219], v[252:255], a[248:251]
v_mfma_f32_16x16x32_bf16 a[244:247], v[212:215], v[252:255], a[244:247]
v_mfma_f32_16x16x32_bf16 a[240:243], v[208:211], v[252:255], a[240:243]
v_mfma_f32_16x16x32_bf16 a[236:239], v[204:207], v[252:255], a[236:239]
s_add_u32 s73, s62, 1
v_mfma_f32_16x16x32_bf16 a[232:235], v[200:203], v[252:255], a[232:235]
s_add_u32 s70, s73, s65
v_mfma_f32_16x16x32_bf16 a[228:231], v[196:199], v[252:255], a[228:231]
s_and_b32 s70, s70, 3
v_mfma_f32_16x16x32_bf16 a[224:227], v[192:195], v[252:255], a[224:227]
s_waitcnt lgkmcnt(0)
v_mfma_f32_16x16x32_bf16 a[0:3], v[160:163], v[128:131], a[0:3]
s_and_b32 s73, s73, 12
ds_read_b64_tr_b16 v[224:225], v20 offset:40960
v_mfma_f32_16x16x32_bf16 a[4:7], v[160:163], v[132:135], a[4:7]
s_or_b32 s73, s73, s70
ds_read_b64_tr_b16 v[226:227], v20 offset:41984
v_mfma_f32_16x16x32_bf16 a[8:11], v[160:163], v[136:139], a[8:11]
s_lshl_b32 s71, s73, 19
ds_read_b128 v[192:195], v25 offset:32768
v_mfma_f32_16x16x32_bf16 a[12:15], v[160:163], v[140:143], a[12:15]
s_add_u32 s71, s71, s66
ds_read_b128 v[196:199], v25 offset:34816
v_mfma_f32_16x16x32_bf16 a[16:19], v[160:163], v[144:147], a[16:19]
s_lshl_b32 s73, s73, 7
ds_read_b128 v[200:203], v25 offset:36864
v_mfma_f32_16x16x32_bf16 a[20:23], v[160:163], v[148:151], a[20:23]
s_add_u32 s69, s73, s67
ds_read_b128 v[204:207], v25 offset:38912
v_mfma_f32_16x16x32_bf16 a[24:27], v[160:163], v[152:155], a[24:27]
s_add_u32 s70, s73, s68
ds_read_b128 v[208:211], v25 offset:40960
v_mfma_f32_16x16x32_bf16 a[28:31], v[160:163], v[156:159], a[28:31]
s_add_u32 m0, s64, 16384
ds_read_b128 v[212:215], v25 offset:43008
v_mfma_f32_16x16x32_bf16 a[60:63], v[164:167], v[156:159], a[60:63]
s_add_u32 s72, s71, 0
buffer_load_dwordx4 v6, s[12:15], s72 offen lds
v_mfma_f32_16x16x32_bf16 a[56:59], v[164:167], v[152:155], a[56:59]
s_add_u32 s72, s71, 31744
buffer_load_dwordx4 v6, s[12:15], s72 offen offset:1024 lds
v_mfma_f32_16x16x32_bf16 a[52:55], v[164:167], v[148:151], a[52:55]
s_add_u32 s72, s71, 63488
buffer_load_dwordx4 v7, s[12:15], s72 offen offset:2048 lds
v_mfma_f32_16x16x32_bf16 a[48:51], v[164:167], v[144:147], a[48:51]
s_add_u32 s72, s71, 95232
buffer_load_dwordx4 v7, s[12:15], s72 offen offset:3072 lds
v_mfma_f32_16x16x32_bf16 a[44:47], v[164:167], v[140:143], a[44:47]
ds_read_b128 v[216:219], v25 offset:45056
v_mfma_f32_16x16x32_bf16 a[40:43], v[164:167], v[136:139], a[40:43]
ds_read_b128 v[220:223], v25 offset:47104
v_mfma_f32_16x16x32_bf16 a[36:39], v[164:167], v[132:135], a[36:39]
ds_read_b64_tr_b16 v[228:229], v21 offset:40960
v_mfma_f32_16x16x32_bf16 a[32:35], v[164:167], v[128:131], a[32:35]
ds_read_b64_tr_b16 v[230:231], v21 offset:41984
v_mfma_f32_16x16x32_bf16 a[64:67], v[168:171], v[128:131], a[64:67]
s_add_u32 m0, s63, 65536
ds_read_b64_tr_b16 v[232:233], v22 offset:40960
v_mfma_f32_16x16x32_bf16 a[68:71], v[168:171], v[132:135], a[68:71]
s_add_u32 s72, s69, 0
buffer_load_dwordx4 v4, s[4:7], s72 offen lds
v_mfma_f32_16x16x32_bf16 a[72:75], v[168:171], v[136:139], a[72:75]
ds_read_b64_tr_b16 v[234:235], v22 offset:41984
v_mfma_f32_16x16x32_bf16 a[76:79], v[168:171], v[140:143], a[76:79]
ds_read_b64_tr_b16 v[236:237], v23 offset:40960
v_mfma_f32_16x16x32_bf16 a[80:83], v[168:171], v[144:147], a[80:83]
ds_read_b64_tr_b16 v[238:239], v23 offset:41984
v_mfma_f32_16x16x32_bf16 a[84:87], v[168:171], v[148:151], a[84:87]
s_add_u32 s72, s69, 15360
buffer_load_dwordx4 v5, s[4:7], s72 offen offset:1024 lds
v_mfma_f32_16x16x32_bf16 a[88:91], v[168:171], v[152:155], a[88:91]
ds_read_b64_tr_b16 v[240:241], v20 offset:57344
v_mfma_f32_16x16x32_bf16 a[92:95], v[168:171], v[156:159], a[92:95]
ds_read_b64_tr_b16 v[242:243], v20 offset:58368
v_mfma_f32_16x16x32_bf16 a[124:127], v[172:175], v[156:159], a[124:127]
ds_read_b64_tr_b16 v[244:245], v21 offset:57344
v_mfma_f32_16x16x32_bf16 a[120:123], v[172:175], v[152:155], a[120:123]
ds_read_b64_tr_b16 v[246:247], v21 offset:58368
v_mfma_f32_16x16x32_bf16 a[116:119], v[172:175], v[148:151], a[116:119]
s_add_u32 s72, s69, 30720
buffer_load_dwordx4 v4, s[4:7], s72 offen offset:2048 lds
v_mfma_f32_16x16x32_bf16 a[112:115], v[172:175], v[144:147], a[112:115]
ds_read_b64_tr_b16 v[248:249], v22 offset:57344
v_mfma_f32_16x16x32_bf16 a[108:111], v[172:175], v[140:143], a[108:111]
ds_read_b64_tr_b16 v[250:251], v22 offset:58368
v_mfma_f32_16x16x32_bf16 a[104:107], v[172:175], v[136:139], a[104:107]
ds_read_b64_tr_b16 v[252:253], v23 offset:57344
v_mfma_f32_16x16x32_bf16 a[100:103], v[172:175], v[132:135], a[100:103]
ds_read_b64_tr_b16 v[254:255], v23 offset:58368
v_mfma_f32_16x16x32_bf16 a[96:99], v[172:175], v[128:131], a[96:99]
s_add_u32 s72, s69, 46080
buffer_load_dwordx4 v5, s[4:7], s72 offen offset:3072 lds
v_mfma_f32_16x16x32_bf16 a[128:131], v[128:131], v[176:179], a[128:131]
v_mfma_f32_16x16x32_bf16 a[132:135], v[132:135], v[176:179], a[132:135]
v_mfma_f32_16x16x32_bf16 a[136:139], v[136:139], v[176:179], a[136:139]
v_mfma_f32_16x16x32_bf16 a[140:143], v[140:143], v[176:179], a[140:143]
v_mfma_f32_16x16x32_bf16 a[144:147], v[144:147], v[176:179], a[144:147]
s_add_u32 m0, s63, 69632
v_mfma_f32_16x16x32_bf16 a[148:151], v[148:151], v[176:179], a[148:151]
s_add_u32 s72, s70, 0
buffer_load_dwordx4 v4, s[4:7], s72 offen lds
v_mfma_f32_16x16x32_bf16 a[152:155], v[152:155], v[176:179], a[152:155]
v_mfma_f32_16x16x32_bf16 a[156:159], v[156:159], v[176:179], a[156:159]
v_mfma_f32_16x16x32_bf16 a[188:191], v[156:159], v[180:183], a[188:191]
v_mfma_f32_16x16x32_bf16 a[184:187], v[152:155], v[180:183], a[184:187]
s_add_u32 s72, s70, 15360
buffer_load_dwordx4 v5, s[4:7], s72 offen offset:1024 lds
v_mfma_f32_16x16x32_bf16 a[180:183], v[148:151], v[180:183], a[180:183]
v_mfma_f32_16x16x32_bf16 a[176:179], v[144:147], v[180:183], a[176:179]
v_mfma_f32_16x16x32_bf16 a[172:175], v[140:143], v[180:183], a[172:175]
v_mfma_f32_16x16x32_bf16 a[168:171], v[136:139], v[180:183], a[168:171]
v_mfma_f32_16x16x32_bf16 a[164:167], v[132:135], v[180:183], a[164:167]
s_add_u32 s72, s70, 30720
buffer_load_dwordx4 v4, s[4:7], s72 offen offset:2048 lds
v_mfma_f32_16x16x32_bf16 a[160:163], v[128:131], v[180:183], a[160:163]
v_mfma_f32_16x16x32_bf16 a[192:195], v[128:131], v[184:187], a[192:195]
v_mfma_f32_16x16x32_bf16 a[196:199], v[132:135], v[184:187], a[196:199]
v_mfma_f32_16x16x32_bf16 a[200:203], v[136:139], v[184:187], a[200:203]
v_mfma_f32_16x16x32_bf16 a[204:207], v[140:143], v[184:187], a[204:207]
s_add_u32 s72, s70, 46080
buffer_load_dwordx4 v5, s[4:7], s72 offen offset:3072 lds
v_mfma_f32_16x16x32_bf16 a[208:211], v[144:147], v[184:187], a[208:211]
v_mfma_f32_16x16x32_bf16 a[212:215], v[148:151], v[184:187], a[212:215]
v_mfma_f32_16x16x32_bf16 a[216:219], v[152:155], v[184:187], a[216:219]
v_mfma_f32_16x16x32_bf16 a[220:223], v[156:159], v[184:187], a[220:223]
v_mfma_f32_16x16x32_bf16 a[252:255], v[156:159], v[188:191], a[252:255]
v_mfma_f32_16x16x32_bf16 a[248:251], v[152:155], v[188:191], a[248:251]
v_mfma_f32_16x16x32_bf16 a[244:247], v[148:151], v[188:191], a[244:247]
v_mfma_f32_16x16x32_bf16 a[240:243], v[144:147], v[188:191], a[240:243]
v_mfma_f32_16x16x32_bf16 a[236:239], v[140:143], v[188:191], a[236:239]
v_mfma_f32_16x16x32_bf16 a[232:235], v[136:139], v[188:191], a[232:235]
v_mfma_f32_16x16x32_bf16 a[228:231], v[132:135], v[188:191], a[228:231]
s_waitcnt vmcnt(12) lgkmcnt(0)
v_mfma_f32_16x16x32_bf16 a[224:227], v[128:131], v[188:191], a[224:227]
s_barrier
LcB0:
v_mfma_f32_16x16x32_bf16 a[0:3], v[224:227], v[192:195], a[0:3]
s_add_u32 s73, s62, 2
ds_read_b64_tr_b16 v[32:33], v8 offset:0
v_mfma_f32_16x16x32_bf16 a[4:7], v[224:227], v[196:199], a[4:7]
s_add_u32 s70, s73, s65
ds_read_b64_tr_b16 v[34:35], v8 offset:1024
v_mfma_f32_16x16x32_bf16 a[8:11], v[224:227], v[200:203], a[8:11]
s_and_b32 s70, s70, 3
ds_read_b128 v[64:67], v16 offset:0
v_mfma_f32_16x16x32_bf16 a[12:15], v[224:227], v[204:207], a[12:15]
s_and_b32 s73, s73, 12
ds_read_b128 v[68:71], v16 offset:2048
v_mfma_f32_16x16x32_bf16 a[16:19], v[224:227], v[208:211], a[16:19]
s_or_b32 s73, s73, s70
ds_read_b128 v[72:75], v16 offset:4096
v_mfma_f32_16x16x32_bf16 a[20:23], v[224:227], v[212:215], a[20:23]
s_lshl_b32 s71, s73, 19
ds_read_b128 v[76:79], v16 offset:6144
v_mfma_f32_16x16x32_bf16 a[24:27], v[224:227], v[216:219], a[24:27]
s_add_u32 s71, s71, s66
ds_read_b64_tr_b16 v[36:37], v9 offset:0
v_mfma_f32_16x16x32_bf16 a[28:31], v[224:227], v[220:223], a[28:31]
s_lshl_b32 s73, s73, 7
ds_read_b64_tr_b16 v[38:39], v9 offset:1024
v_mfma_f32_16x16x32_bf16 a[60:63], v[228:231], v[220:223], a[60:63]
s_add_u32 s69, s73, s67
ds_read_b64_tr_b16 v[40:41], v10 offset:0
v_mfma_f32_16x16x32_bf16 a[56:59], v[228:231], v[216:219], a[56:59]
s_add_u32 s70, s73, s68
ds_read_b64_tr_b16 v[42:43], v10 offset:1024
v_mfma_f32_16x16x32_bf16 a[52:55], v[228:231], v[212:215], a[52:55]
s_add_u32 m0, s64, 32768
ds_read_b64_tr_b16 v[44:45], v11 offset:0
v_mfma_f32_16x16x32_bf16 a[48:51], v[228:231], v[208:211], a[48:51]
s_add_u32 s72, s71, 0
buffer_load_dwordx4 v6, s[12:15], s72 offen lds
v_mfma_f32_16x16x32_bf16 a[44:47], v[228:231], v[204:207], a[44:47]
s_add_u32 s72, s71, 31744
buffer_load_dwordx4 v6, s[12:15], s72 offen offset:1024 lds
v_mfma_f32_16x16x32_bf16 a[40:43], v[228:231], v[200:203], a[40:43]
s_add_u32 s72, s71, 63488
buffer_load_dwordx4 v7, s[12:15], s72 offen offset:2048 lds
v_mfma_f32_16x16x32_bf16 a[36:39], v[228:231], v[196:199], a[36:39]
s_lshl_b32 s80, s59, 2
ds_read_b64_tr_b16 v[46:47], v11 offset:1024
v_or_b32 v26, s58, v0
v_mfma_f32_16x16x32_bf16 a[32:35], v[228:231], v[192:195], a[32:35]
s_add_u32 s72, s71, 95232
buffer_load_dwordx4 v7, s[12:15], s72 offen offset:3072 lds
v_mfma_f32_16x16x32_bf16 a[64:67], v[232:235], v[192:195], a[64:67]
ds_read_b64_tr_b16 v[48:49], v12 offset:0
v_mov_b32 v27, 1
v_mfma_f32_16x16x32_bf16 a[68:71], v[232:235], v[196:199], a[68:71]
ds_read_b64_tr_b16 v[50:51], v12 offset:1024
v_lshlrev_b32 v26, 8, v26
v_mfma_f32_16x16x32_bf16 a[72:75], v[232:235], v[200:203], a[72:75]
ds_read_b64_tr_b16 v[52:53], v13 offset:0
v_mfma_f32_16x16x32_bf16 a[76:79], v[232:235], v[204:207], a[76:79]
ds_read_b64_tr_b16 v[54:55], v13 offset:1024
v_mfma_f32_16x16x32_bf16 a[80:83], v[232:235], v[208:211], a[80:83]
s_add_u32 m0, s63, 98304
ds_read_b64_tr_b16 v[56:57], v14 offset:0
v_mfma_f32_16x16x32_bf16 a[84:87], v[232:235], v[212:215], a[84:87]
s_add_u32 s72, s69, 0
buffer_load_dwordx4 v4, s[4:7], s72 offen lds
v_mfma_f32_16x16x32_bf16 a[88:91], v[232:235], v[216:219], a[88:91]
ds_read_b64_tr_b16 v[58:59], v14 offset:1024
v_mfma_f32_16x16x32_bf16 a[92:95], v[232:235], v[220:223], a[92:95]
ds_read_b64_tr_b16 v[60:61], v15 offset:0
v_mfma_f32_16x16x32_bf16 a[124:127], v[236:239], v[220:223], a[124:127]
ds_read_b64_tr_b16 v[62:63], v15 offset:1024
v_mfma_f32_16x16x32_bf16 a[120:123], v[236:239], v[216:219], a[120:123]
s_add_u32 s72, s69, 15360
buffer_load_dwordx4 v5, s[4:7], s72 offen offset:1024 lds
v_mfma_f32_16x16x32_bf16 a[116:119], v[236:239], v[212:215], a[116:119]
buffer_atomic_add v27, v26, s[48:51], s80 offen sc1
v_mfma_f32_16x16x32_bf16 a[112:115], v[236:239], v[208:211], a[112:115]
v_accvgpr_read_b32 v20, a0
v_accvgpr_read_b32 v28, a1
v_mfma_f32_16x16x32_bf16 a[108:111], v[236:239], v[204:207], a[108:111]
v_accvgpr_read_b32 v21, a2
v_accvgpr_read_b32 v29, a3
v_mfma_f32_16x16x32_bf16 a[104:107], v[236:239], v[200:203], a[104:107]
v_accvgpr_read_b32 v22, a32
v_accvgpr_read_b32 v30, a33
v_mfma_f32_16x16x32_bf16 a[100:103], v[236:239], v[196:199], a[100:103]
s_add_u32 s72, s69, 30720
buffer_load_dwordx4 v4, s[4:7], s72 offen offset:2048 lds
v_mfma_f32_16x16x32_bf16 a[96:99], v[236:239], v[192:195], a[96:99]
v_accvgpr_read_b32 v23, a34
v_accvgpr_read_b32 v31, a35
v_mfma_f32_16x16x32_bf16 a[128:131], v[192:195], v[240:243], a[128:131]
v_mul_f32 v20, s79, v20
v_mul_f32 v28, s79, v28
v_mfma_f32_16x16x32_bf16 a[132:135], v[196:199], v[240:243], a[132:135]
v_mul_f32 v21, s79, v21
v_mul_f32 v29, s79, v29
v_mfma_f32_16x16x32_bf16 a[136:139], v[200:203], v[240:243], a[136:139]
v_mul_f32 v22, s79, v22
v_mul_f32 v30, s79, v30
v_mfma_f32_16x16x32_bf16 a[140:143], v[204:207], v[240:243], a[140:143]
s_add_u32 s72, s69, 46080
buffer_load_dwordx4 v5, s[4:7], s72 offen offset:3072 lds
v_mfma_f32_16x16x32_bf16 a[144:147], v[208:211], v[240:243], a[144:147]
v_mul_f32 v23, s79, v23
v_mul_f32 v31, s79, v31
v_mfma_f32_16x16x32_bf16 a[148:151], v[212:215], v[240:243], a[148:151]
v_cvt_pk_bf16_f32 v20, v20, v28
v_cvt_pk_bf16_f32 v21, v21, v29
v_mfma_f32_16x16x32_bf16 a[152:155], v[216:219], v[240:243], a[152:155]
v_cvt_pk_bf16_f32 v22, v22, v30
v_cvt_pk_bf16_f32 v23, v23, v31
v_mfma_f32_16x16x32_bf16 a[156:159], v[220:223], v[240:243], a[156:159]
s_add_u32 s80, s77, 0
buffer_store_dwordx4 v[20:23], v1, s[44:47], s80 offen sc1
v_mfma_f32_16x16x32_bf16 a[188:191], v[220:223], v[244:247], a[188:191]
s_add_u32 m0, s63, 102400
v_mfma_f32_16x16x32_bf16 a[184:187], v[216:219], v[244:247], a[184:187]
s_add_u32 s72, s70, 0
buffer_load_dwordx4 v4, s[4:7], s72 offen lds
v_mfma_f32_16x16x32_bf16 a[180:183], v[212:215], v[244:247], a[180:183]
v_mfma_f32_16x16x32_bf16 a[176:179], v[208:211], v[244:247], a[176:179]
v_mfma_f32_16x16x32_bf16 a[172:175], v[204:207], v[244:247], a[172:175]
v_mfma_f32_16x16x32_bf16 a[168:171], v[200:203], v[244:247], a[168:171]
s_add_u32 s72, s70, 15360
buffer_load_dwordx4 v5, s[4:7], s72 offen offset:1024 lds
v_mfma_f32_16x16x32_bf16 a[164:167], v[196:199], v[244:247], a[164:167]
v_accvgpr_read_b32 v24, a4
v_accvgpr_read_b32 v28, a5
v_mfma_f32_16x16x32_bf16 a[160:163], v[192:195], v[244:247], a[160:163]
v_accvgpr_read_b32 v25, a6
v_accvgpr_read_b32 v29, a7
v_mfma_f32_16x16x32_bf16 a[192:195], v[192:195], v[248:251], a[192:195]
v_accvgpr_read_b32 v26, a36
v_accvgpr_read_b32 v30, a37
v_mfma_f32_16x16x32_bf16 a[196:199], v[196:199], v[248:251], a[196:199]
v_accvgpr_read_b32 v27, a38
v_accvgpr_read_b32 v31, a39
v_mfma_f32_16x16x32_bf16 a[200:203], v[200:203], v[248:251], a[200:203]
s_add_u32 s72, s70, 30720
buffer_load_dwordx4 v4, s[4:7], s72 offen offset:2048 lds
v_mfma_f32_16x16x32_bf16 a[204:207], v[204:207], v[248:251], a[204:207]
v_mul_f32 v24, s79, v24
v_mul_f32 v28, s79, v28
v_mfma_f32_16x16x32_bf16 a[208:211], v[208:211], v[248:251], a[208:211]
v_mul_f32 v25, s79, v25
v_mul_f32 v29, s79, v29
v_mfma_f32_16x16x32_bf16 a[212:215], v[212:215], v[248:251], a[212:215]
v_mul_f32 v26, s79, v26
v_mul_f32 v30, s79, v30
v_mfma_f32_16x16x32_bf16 a[216:219], v[216:219], v[248:251], a[216:219]
v_mul_f32 v27, s79, v27
v_mul_f32 v31, s79, v31
v_mfma_f32_16x16x32_bf16 a[220:223], v[220:223], v[248:251], a[220:223]
s_add_u32 s72, s70, 46080
buffer_load_dwordx4 v5, s[4:7], s72 offen offset:3072 lds
v_mfma_f32_16x16x32_bf16 a[252:255], v[220:223], v[252:255], a[252:255]
v_cvt_pk_bf16_f32 v24, v24, v28
v_cvt_pk_bf16_f32 v25, v25, v29
v_mfma_f32_16x16x32_bf16 a[248:251], v[216:219], v[252:255], a[248:251]
v_cvt_pk_bf16_f32 v26, v26, v30
v_cvt_pk_bf16_f32 v27, v27, v31
v_mfma_f32_16x16x32_bf16 a[244:247], v[212:215], v[252:255], a[244:247]
s_add_u32 s80, s77, 4096
buffer_store_dwordx4 v[24:27], v1, s[44:47], s80 offen sc1
v_mfma_f32_16x16x32_bf16 a[240:243], v[208:211], v[252:255], a[240:243]
v_mfma_f32_16x16x32_bf16 a[236:239], v[204:207], v[252:255], a[236:239]
v_mfma_f32_16x16x32_bf16 a[232:235], v[200:203], v[252:255], a[232:235]
v_mfma_f32_16x16x32_bf16 a[228:231], v[196:199], v[252:255], a[228:231]
v_mfma_f32_16x16x32_bf16 a[224:227], v[192:195], v[252:255], a[224:227]
s_waitcnt lgkmcnt(0)
v_mfma_f32_16x16x32_bf16 v[128:131], v[32:35], v[64:67], 0
ds_read_b64_tr_b16 v[80:81], v8 offset:8192
ds_read_b64_tr_b16 v[82:83], v8 offset:9216
v_mfma_f32_16x16x32_bf16 v[132:135], v[32:35], v[68:71], 0
ds_read_b128 v[112:115], v17 offset:0
ds_read_b128 v[116:119], v17 offset:2048
v_mfma_f32_16x16x32_bf16 v[136:139], v[32:35], v[72:75], 0
ds_read_b128 v[120:123], v17 offset:4096
ds_read_b128 v[124:127], v17 offset:6144
v_mfma_f32_16x16x32_bf16 v[140:143], v[32:35], v[76:79], 0
ds_read_b64_tr_b16 v[84:85], v9 offset:8192
ds_read_b64_tr_b16 v[86:87], v9 offset:9216
v_mfma_f32_16x16x32_bf16 v[156:159], v[36:39], v[76:79], 0
ds_read_b64_tr_b16 v[88:89], v10 offset:8192
v_accvgpr_read_b32 v20, a8
v_mfma_f32_16x16x32_bf16 v[152:155], v[36:39], v[72:75], 0
ds_read_b64_tr_b16 v[90:91], v10 offset:9216
v_accvgpr_read_b32 v28, a9
v_mfma_f32_16x16x32_bf16 v[148:151], v[36:39], v[68:71], 0
ds_read_b64_tr_b16 v[92:93], v11 offset:8192
v_accvgpr_read_b32 v21, a10
v_mfma_f32_16x16x32_bf16 v[144:147], v[36:39], v[64:67], 0
ds_read_b64_tr_b16 v[94:95], v11 offset:9216
v_accvgpr_read_b32 v29, a11
v_mfma_f32_16x16x32_bf16 v[160:163], v[40:43], v[64:67], 0
ds_read_b64_tr_b16 v[96:97], v12 offset:8192
v_accvgpr_read_b32 v22, a40
v_mfma_f32_16x16x32_bf16 v[164:167], v[40:43], v[68:71], 0
ds_read_b64_tr_b16 v[98:99], v12 offset:9216
v_accvgpr_read_b32 v30, a41
v_mfma_f32_16x16x32_bf16 v[168:171], v[40:43], v[72:75], 0
ds_read_b64_tr_b16 v[100:101], v13 offset:8192
v_accvgpr_read_b32 v23, a42
v_mfma_f32_16x16x32_bf16 v[172:175], v[40:43], v[76:79], 0
ds_read_b64_tr_b16 v[102:103], v13 offset:9216
v_accvgpr_read_b32 v31, a43
v_mfma_f32_16x16x32_bf16 v[188:191], v[44:47], v[76:79], 0
ds_read_b64_tr_b16 v[104:105], v14 offset:8192
v_mul_f32 v20, s79, v20
v_mfma_f32_16x16x32_bf16 v[184:187], v[44:47], v[72:75], 0
ds_read_b64_tr_b16 v[106:107], v14 offset:9216
v_mul_f32 v28, s79, v28
v_mfma_f32_16x16x32_bf16 v[180:183], v[44:47], v[68:71], 0
ds_read_b64_tr_b16 v[108:109], v15 offset:8192
v_mul_f32 v21, s79, v21
v_mfma_f32_16x16x32_bf16 v[176:179], v[44:47], v[64:67], 0
ds_read_b64_tr_b16 v[110:111], v15 offset:9216
v_mul_f32 v29, s79, v29
v_mfma_f32_16x16x32_bf16 v[192:195], v[48:51], v[64:67], 0
v_mul_f32 v22, s79, v22
v_mul_f32 v30, s79, v30
v_mfma_f32_16x16x32_bf16 v[196:199], v[48:51], v[68:71], 0
v_mul_f32 v23, s79, v23
v_mul_f32 v31, s79, v31
v_mfma_f32_16x16x32_bf16 v[200:203], v[48:51], v[72:75], 0
v_cvt_pk_bf16_f32 v20, v20, v28
v_cvt_pk_bf16_f32 v21, v21, v29
v_mfma_f32_16x16x32_bf16 v[204:207], v[48:51], v[76:79], 0
v_cvt_pk_bf16_f32 v22, v22, v30
v_cvt_pk_bf16_f32 v23, v23, v31
v_mfma_f32_16x16x32_bf16 v[220:223], v[52:55], v[76:79], 0
s_add_u32 s80, s77, 8192
buffer_store_dwordx4 v[20:23], v1, s[44:47], s80 offen sc1
v_mfma_f32_16x16x32_bf16 v[216:219], v[52:55], v[72:75], 0
v_mfma_f32_16x16x32_bf16 v[212:215], v[52:55], v[68:71], 0
v_accvgpr_read_b32 v24, a128
v_accvgpr_read_b32 v28, a129
v_mfma_f32_16x16x32_bf16 v[208:211], v[52:55], v[64:67], 0
v_accvgpr_read_b32 v25, a130
v_accvgpr_read_b32 v29, a131
v_mfma_f32_16x16x32_bf16 v[224:227], v[56:59], v[64:67], 0
v_accvgpr_read_b32 v26, a132
v_accvgpr_read_b32 v30, a133
v_mfma_f32_16x16x32_bf16 v[228:231], v[56:59], v[68:71], 0
v_accvgpr_read_b32 v27, a134
v_accvgpr_read_b32 v31, a135
v_mfma_f32_16x16x32_bf16 v[232:235], v[56:59], v[72:75], 0
v_cvt_pk_bf16_f32 v24, v24, v28
v_cvt_pk_bf16_f32 v25, v25, v29
v_mfma_f32_16x16x32_bf16 v[236:239], v[56:59], v[76:79], 0
v_cvt_pk_bf16_f32 v26, v26, v30
v_cvt_pk_bf16_f32 v27, v27, v31
v_mfma_f32_16x16x32_bf16 v[252:255], v[60:63], v[76:79], 0
s_add_u32 s80, s78, 0
buffer_store_dwordx4 v[24:27], v1, s[44:47], s80 offen sc1
v_mfma_f32_16x16x32_bf16 v[248:251], v[60:63], v[72:75], 0
v_mfma_f32_16x16x32_bf16 v[244:247], v[60:63], v[68:71], 0
s_waitcnt vmcnt(17) lgkmcnt(0)
v_mfma_f32_16x16x32_bf16 v[240:243], v[60:63], v[64:67], 0
s_barrier
v_mfma_f32_16x16x32_bf16 v[128:131], v[80:83], v[112:115], v[128:131]
s_add_u32 s73, s62, 3
ds_read_b64_tr_b16 v[32:33], v8 offset:16384
ds_read_b64_tr_b16 v[34:35], v8 offset:17408
v_mfma_f32_16x16x32_bf16 v[132:135], v[80:83], v[116:119], v[132:135]
s_add_u32 s70, s73, s65
ds_read_b128 v[64:67], v18 offset:0
ds_read_b128 v[68:71], v18 offset:2048
v_mfma_f32_16x16x32_bf16 v[136:139], v[80:83], v[120:123], v[136:139]
s_and_b32 s70, s70, 3
ds_read_b128 v[72:75], v18 offset:4096
ds_read_b128 v[76:79], v18 offset:6144
v_mfma_f32_16x16x32_bf16 v[140:143], v[80:83], v[124:127], v[140:143]
s_and_b32 s73, s73, 12
ds_read_b64_tr_b16 v[36:37], v9 offset:16384
ds_read_b64_tr_b16 v[38:39], v9 offset:17408
v_mfma_f32_16x16x32_bf16 v[156:159], v[84:87], v[124:127], v[156:159]
s_or_b32 s73, s73, s70
ds_read_b64_tr_b16 v[40:41], v10 offset:16384
v_mfma_f32_16x16x32_bf16 v[152:155], v[84:87], v[120:123], v[152:155]
s_lshl_b32 s71, s73, 19
ds_read_b64_tr_b16 v[42:43], v10 offset:17408
v_mfma_f32_16x16x32_bf16 v[148:151], v[84:87], v[116:119], v[148:151]
s_add_u32 s71, s71, s66
ds_read_b64_tr_b16 v[44:45], v11 offset:16384
v_mfma_f32_16x16x32_bf16 v[144:147], v[84:87], v[112:115], v[144:147]
s_lshl_b32 s73, s73, 7
ds_read_b64_tr_b16 v[46:47], v11 offset:17408
v_mfma_f32_16x16x32_bf16 v[160:163], v[88:91], v[112:115], v[160:163]
s_add_u32 s69, s73, s67
ds_read_b64_tr_b16 v[48:49], v12 offset:16384
v_mfma_f32_16x16x32_bf16 v[164:167], v[88:91], v[116:119], v[164:167]
s_add_u32 s70, s73, s68
ds_read_b64_tr_b16 v[50:51], v12 offset:17408
v_mfma_f32_16x16x32_bf16 v[168:171], v[88:91], v[120:123], v[168:171]
s_add_u32 m0, s64, 0
ds_read_b64_tr_b16 v[52:53], v13 offset:16384
v_mfma_f32_16x16x32_bf16 v[172:175], v[88:91], v[124:127], v[172:175]
s_add_u32 s72, s71, 0
buffer_load_dwordx4 v6, s[12:15], s72 offen lds
v_mfma_f32_16x16x32_bf16 v[188:191], v[92:95], v[124:127], v[188:191]
s_add_u32 s72, s71, 31744
buffer_load_dwordx4 v6, s[12:15], s72 offen offset:1024 lds
v_mfma_f32_16x16x32_bf16 v[184:187], v[92:95], v[120:123], v[184:187]
s_add_u32 s72, s71, 63488
buffer_load_dwordx4 v7, s[12:15], s72 offen offset:2048 lds
v_mfma_f32_16x16x32_bf16 v[180:183], v[92:95], v[116:119], v[180:183]
s_add_u32 s72, s71, 95232
buffer_load_dwordx4 v7, s[12:15], s72 offen offset:3072 lds
v_mfma_f32_16x16x32_bf16 v[176:179], v[92:95], v[112:115], v[176:179]
ds_read_b64_tr_b16 v[54:55], v13 offset:17408
v_accvgpr_read_b32 v20, a12
v_mfma_f32_16x16x32_bf16 v[192:195], v[96:99], v[112:115], v[192:195]
ds_read_b64_tr_b16 v[56:57], v14 offset:16384
v_accvgpr_read_b32 v28, a13
v_mfma_f32_16x16x32_bf16 v[196:199], v[96:99], v[116:119], v[196:199]
ds_read_b64_tr_b16 v[58:59], v14 offset:17408
v_accvgpr_read_b32 v21, a14
v_mfma_f32_16x16x32_bf16 v[200:203], v[96:99], v[120:123], v[200:203]
ds_read_b64_tr_b16 v[60:61], v15 offset:16384
v_accvgpr_read_b32 v29, a15
v_mfma_f32_16x16x32_bf16 v[204:207], v[96:99], v[124:127], v[204:207]
s_add_u32 m0, s63, 131072
ds_read_b64_tr_b16 v[62:63], v15 offset:17408
v_accvgpr_read_b32 v22, a44
v_mfma_f32_16x16x32_bf16 v[220:223], v[100:103], v[124:127], v[220:223]
s_add_u32 s72, s69, 0
buffer_load_dwordx4 v4, s[4:7], s72 offen lds
v_mfma_f32_16x16x32_bf16 v[216:219], v[100:103], v[120:123], v[216:219]
v_accvgpr_read_b32 v30, a45
v_accvgpr_read_b32 v23, a46
v_mfma_f32_16x16x32_bf16 v[212:215], v[100:103], v[116:119], v[212:215]
v_accvgpr_read_b32 v31, a47
v_mul_f32 v20, s79, v20
v_mfma_f32_16x16x32_bf16 v[208:211], v[100:103], v[112:115], v[208:211]
v_mul_f32 v28, s79, v28
v_mul_f32 v21, s79, v21
v_mfma_f32_16x16x32_bf16 v[224:227], v[104:107], v[112:115], v[224:227]
s_add_u32 s72, s69, 15360
buffer_load_dwordx4 v5, s[4:7], s72 offen offset:1024 lds
v_mfma_f32_16x16x32_bf16 v[228:231], v[104:107], v[116:119], v[228:231]
v_mul_f32 v29, s79, v29
v_mul_f32 v22, s79, v22
v_mfma_f32_16x16x32_bf16 v[232:235], v[104:107], v[120:123], v[232:235]
v_mul_f32 v30, s79, v30
v_mul_f32 v23, s79, v23
v_mfma_f32_16x16x32_bf16 v[236:239], v[104:107], v[124:127], v[236:239]
v_mul_f32 v31, s79, v31
v_cvt_pk_bf16_f32 v20, v20, v28
v_mfma_f32_16x16x32_bf16 v[252:255], v[108:111], v[124:127], v[252:255]
v_cvt_pk_bf16_f32 v21, v21, v29
v_cvt_pk_bf16_f32 v22, v22, v30
v_mfma_f32_16x16x32_bf16 v[248:251], v[108:111], v[120:123], v[248:251]
s_add_u32 s72, s69, 30720
buffer_load_dwordx4 v4, s[4:7], s72 offen offset:2048 lds
v_mfma_f32_16x16x32_bf16 v[244:247], v[108:111], v[116:119], v[244:247]
v_cvt_pk_bf16_f32 v23, v23, v31
v_mfma_f32_16x16x32_bf16 v[240:243], v[108:111], v[112:115], v[240:243]
s_waitcnt lgkmcnt(0)
v_accvgpr_read_b32 v24, a136
v_accvgpr_read_b32 v28, a137
v_mfma_f32_16x16x32_bf16 v[128:131], v[32:35], v[64:67], v[128:131]
s_add_u32 s80, s77, 12288
ds_read_b64_tr_b16 v[80:81], v8 offset:24576
ds_read_b64_tr_b16 v[82:83], v8 offset:25600
v_mfma_f32_16x16x32_bf16 v[132:135], v[32:35], v[68:71], v[132:135]
ds_read_b128 v[112:115], v19 offset:0
ds_read_b128 v[116:119], v19 offset:2048
v_mfma_f32_16x16x32_bf16 v[136:139], v[32:35], v[72:75], v[136:139]
s_add_u32 s72, s69, 46080
buffer_load_dwordx4 v5, s[4:7], s72 offen offset:3072 lds
v_mfma_f32_16x16x32_bf16 v[140:143], v[32:35], v[76:79], v[140:143]
ds_read_b128 v[120:123], v19 offset:4096
ds_read_b128 v[124:127], v19 offset:6144
v_mfma_f32_16x16x32_bf16 v[156:159], v[36:39], v[76:79], v[156:159]
ds_read_b64_tr_b16 v[84:85], v9 offset:24576
ds_read_b64_tr_b16 v[86:87], v9 offset:25600
v_mfma_f32_16x16x32_bf16 v[152:155], v[36:39], v[72:75], v[152:155]
ds_read_b64_tr_b16 v[88:89], v10 offset:24576
v_accvgpr_read_b32 v25, a138
v_mfma_f32_16x16x32_bf16 v[148:151], v[36:39], v[68:71], v[148:151]
ds_read_b64_tr_b16 v[90:91], v10 offset:25600
v_accvgpr_read_b32 v29, a139
v_mfma_f32_16x16x32_bf16 v[144:147], v[36:39], v[64:67], v[144:147]
s_add_u32 m0, s63, 135168
ds_read_b64_tr_b16 v[92:93], v11 offset:24576
v_accvgpr_read_b32 v26, a140
v_mfma_f32_16x16x32_bf16 v[160:163], v[40:43], v[64:67], v[160:163]
s_add_u32 s72, s70, 0
buffer_load_dwordx4 v4, s[4:7], s72 offen lds
v_mfma_f32_16x16x32_bf16 v[164:167], v[40:43], v[68:71], v[164:167]
ds_read_b64_tr_b16 v[94:95], v11 offset:25600
v_accvgpr_read_b32 v30, a141
v_mfma_f32_16x16x32_bf16 v[168:171], v[40:43], v[72:75], v[168:171]
ds_read_b64_tr_b16 v[96:97], v12 offset:24576
v_accvgpr_read_b32 v27, a142
v_mfma_f32_16x16x32_bf16 v[172:175], v[40:43], v[76:79], v[172:175]
ds_read_b64_tr_b16 v[98:99], v12 offset:25600
v_accvgpr_read_b32 v31, a143
v_mfma_f32_16x16x32_bf16 v[188:191], v[44:47], v[76:79], v[188:191]
s_add_u32 s72, s70, 15360
buffer_load_dwordx4 v5, s[4:7], s72 offen offset:1024 lds
v_mfma_f32_16x16x32_bf16 v[184:187], v[44:47], v[72:75], v[184:187]
ds_read_b64_tr_b16 v[100:101], v13 offset:24576
v_cvt_pk_bf16_f32 v24, v24, v28
v_mfma_f32_16x16x32_bf16 v[180:183], v[44:47], v[68:71], v[180:183]
ds_read_b64_tr_b16 v[102:103], v13 offset:25600
v_cvt_pk_bf16_f32 v25, v25, v29
v_mfma_f32_16x16x32_bf16 v[176:179], v[44:47], v[64:67], v[176:179]
ds_read_b64_tr_b16 v[104:105], v14 offset:24576
v_cvt_pk_bf16_f32 v26, v26, v30
v_mfma_f32_16x16x32_bf16 v[192:195], v[48:51], v[64:67], v[192:195]
ds_read_b64_tr_b16 v[106:107], v14 offset:25600
v_cvt_pk_bf16_f32 v27, v27, v31
v_mfma_f32_16x16x32_bf16 v[196:199], v[48:51], v[68:71], v[196:199]
s_add_u32 s72, s70, 30720
buffer_load_dwordx4 v4, s[4:7], s72 offen offset:2048 lds
v_mfma_f32_16x16x32_bf16 v[200:203], v[48:51], v[72:75], v[200:203]
ds_read_b64_tr_b16 v[108:109], v15 offset:24576
v_mfma_f32_16x16x32_bf16 v[204:207], v[48:51], v[76:79], v[204:207]
ds_read_b64_tr_b16 v[110:111], v15 offset:25600
v_mfma_f32_16x16x32_bf16 v[220:223], v[52:55], v[76:79], v[220:223]
buffer_store_dwordx4 v[20:23], v1, s[44:47], s80 offen sc1
v_mfma_f32_16x16x32_bf16 v[216:219], v[52:55], v[72:75], v[216:219]
s_add_u32 s80, s78, 8192
buffer_store_dwordx4 v[24:27], v1, s[44:47], s80 offen sc1
v_mfma_f32_16x16x32_bf16 v[212:215], v[52:55], v[68:71], v[212:215]
s_add_u32 s72, s70, 46080
buffer_load_dwordx4 v5, s[4:7], s72 offen offset:3072 lds
v_mfma_f32_16x16x32_bf16 v[208:211], v[52:55], v[64:67], v[208:211]
v_accvgpr_read_b32 v20, a16
v_accvgpr_read_b32 v28, a17
v_mfma_f32_16x16x32_bf16 v[224:227], v[56:59], v[64:67], v[224:227]
v_accvgpr_read_b32 v21, a18
v_accvgpr_read_b32 v29, a19
v_mfma_f32_16x16x32_bf16 v[228:231], v[56:59], v[68:71], v[228:231]
v_accvgpr_read_b32 v22, a48
v_accvgpr_read_b32 v30, a49
v_mfma_f32_16x16x32_bf16 v[232:235], v[56:59], v[72:75], v[232:235]
v_accvgpr_read_b32 v23, a50
v_accvgpr_read_b32 v31, a51
v_mfma_f32_16x16x32_bf16 v[236:239], v[56:59], v[76:79], v[236:239]
v_mul_f32 v20, s79, v20
v_mul_f32 v28, s79, v28
v_mfma_f32_16x16x32_bf16 v[252:255], v[60:63], v[76:79], v[252:255]
v_mul_f32 v21, s79, v21
v_mul_f32 v29, s79, v29
v_mfma_f32_16x16x32_bf16 v[248:251], v[60:63], v[72:75], v[248:251]
v_mul_f32 v22, s79, v22
v_mul_f32 v30, s79, v30
v_mfma_f32_16x16x32_bf16 v[244:247], v[60:63], v[68:71], v[244:247]
s_waitcnt vmcnt(17) lgkmcnt(0)
v_mul_f32 v23, s79, v23
v_mul_f32 v31, s79, v31
v_mfma_f32_16x16x32_bf16 v[240:243], v[60:63], v[64:67], v[240:243]
s_barrier
v_cvt_pk_bf16_f32 v20, v20, v28
v_cvt_pk_bf16_f32 v21, v21, v29
v_mfma_f32_16x16x32_bf16 v[128:131], v[80:83], v[112:115], v[128:131]
s_add_u32 s73, s62, 4
ds_read_b64_tr_b16 v[32:33], v8 offset:32768
ds_read_b64_tr_b16 v[34:35], v8 offset:33792
v_mfma_f32_16x16x32_bf16 v[132:135], v[80:83], v[116:119], v[132:135]
s_add_u32 s70, s73, s65
ds_read_b128 v[64:67], v18 offset:32768
ds_read_b128 v[68:71], v18 offset:34816
v_mfma_f32_16x16x32_bf16 v[136:139], v[80:83], v[120:123], v[136:139]
s_and_b32 s70, s70, 3
ds_read_b128 v[72:75], v18 offset:36864
ds_read_b128 v[76:79], v18 offset:38912
v_mfma_f32_16x16x32_bf16 v[140:143], v[80:83], v[124:127], v[140:143]
s_and_b32 s73, s73, 12
ds_read_b64_tr_b16 v[36:37], v9 offset:32768
ds_read_b64_tr_b16 v[38:39], v9 offset:33792
v_mfma_f32_16x16x32_bf16 v[156:159], v[84:87], v[124:127], v[156:159]
s_or_b32 s73, s73, s70
ds_read_b64_tr_b16 v[40:41], v10 offset:32768
v_cvt_pk_bf16_f32 v22, v22, v30
v_mfma_f32_16x16x32_bf16 v[152:155], v[84:87], v[120:123], v[152:155]
s_lshl_b32 s71, s73, 19
ds_read_b64_tr_b16 v[42:43], v10 offset:33792
v_cvt_pk_bf16_f32 v23, v23, v31
v_mfma_f32_16x16x32_bf16 v[148:151], v[84:87], v[116:119], v[148:151]
s_add_u32 s71, s71, s66
ds_read_b64_tr_b16 v[44:45], v11 offset:32768
v_mfma_f32_16x16x32_bf16 v[144:147], v[84:87], v[112:115], v[144:147]
s_lshl_b32 s73, s73, 7
ds_read_b64_tr_b16 v[46:47], v11 offset:33792
v_accvgpr_read_b32 v24, a144
v_mfma_f32_16x16x32_bf16 v[160:163], v[88:91], v[112:115], v[160:163]
s_add_u32 s69, s73, s67
ds_read_b64_tr_b16 v[48:49], v12 offset:32768
v_accvgpr_read_b32 v28, a145
v_mfma_f32_16x16x32_bf16 v[164:167], v[88:91], v[116:119], v[164:167]
s_add_u32 s70, s73, s68
ds_read_b64_tr_b16 v[50:51], v12 offset:33792
v_accvgpr_read_b32 v25, a146
v_mfma_f32_16x16x32_bf16 v[168:171], v[88:91], v[120:123], v[168:171]
s_add_u32 m0, s64, 16384
ds_read_b64_tr_b16 v[52:53], v13 offset:32768
v_accvgpr_read_b32 v29, a147
v_mfma_f32_16x16x32_bf16 v[172:175], v[88:91], v[124:127], v[172:175]
s_add_u32 s72, s71, 0
buffer_load_dwordx4 v6, s[12:15], s72 offen lds
v_mfma_f32_16x16x32_bf16 v[188:191], v[92:95], v[124:127], v[188:191]
s_add_u32 s72, s71, 31744
buffer_load_dwordx4 v6, s[12:15], s72 offen offset:1024 lds
v_mfma_f32_16x16x32_bf16 v[184:187], v[92:95], v[120:123], v[184:187]
s_add_u32 s72, s71, 63488
buffer_load_dwordx4 v7, s[12:15], s72 offen offset:2048 lds
v_mfma_f32_16x16x32_bf16 v[180:183], v[92:95], v[116:119], v[180:183]
s_add_u32 s72, s71, 95232
buffer_load_dwordx4 v7, s[12:15], s72 offen offset:3072 lds
v_mfma_f32_16x16x32_bf16 v[176:179], v[92:95], v[112:115], v[176:179]
s_add_u32 s80, s77, 32768
ds_read_b64_tr_b16 v[54:55], v13 offset:33792
v_accvgpr_read_b32 v26, a148
v_mfma_f32_16x16x32_bf16 v[192:195], v[96:99], v[112:115], v[192:195]
ds_read_b64_tr_b16 v[56:57], v14 offset:32768
v_accvgpr_read_b32 v30, a149
v_mfma_f32_16x16x32_bf16 v[196:199], v[96:99], v[116:119], v[196:199]
ds_read_b64_tr_b16 v[58:59], v14 offset:33792
v_accvgpr_read_b32 v27, a150
v_mfma_f32_16x16x32_bf16 v[200:203], v[96:99], v[120:123], v[200:203]
ds_read_b64_tr_b16 v[60:61], v15 offset:32768
v_accvgpr_read_b32 v31, a151
v_mfma_f32_16x16x32_bf16 v[204:207], v[96:99], v[124:127], v[204:207]
s_add_u32 m0, s63, 65536
ds_read_b64_tr_b16 v[62:63], v15 offset:33792
v_cvt_pk_bf16_f32 v24, v24, v28
v_mfma_f32_16x16x32_bf16 v[220:223], v[100:103], v[124:127], v[220:223]
s_add_u32 s72, s69, 0
buffer_load_dwordx4 v4, s[4:7], s72 offen lds
v_mfma_f32_16x16x32_bf16 v[216:219], v[100:103], v[120:123], v[216:219]
buffer_store_dwordx4 v[20:23], v1, s[44:47], s80 offen sc1
v_mfma_f32_16x16x32_bf16 v[212:215], v[100:103], v[116:119], v[212:215]
v_cvt_pk_bf16_f32 v25, v25, v29
v_cvt_pk_bf16_f32 v26, v26, v30
v_mfma_f32_16x16x32_bf16 v[208:211], v[100:103], v[112:115], v[208:211]
v_cvt_pk_bf16_f32 v27, v27, v31
v_mfma_f32_16x16x32_bf16 v[224:227], v[104:107], v[112:115], v[224:227]
s_add_u32 s72, s69, 15360
buffer_load_dwordx4 v5, s[4:7], s72 offen offset:1024 lds
v_mfma_f32_16x16x32_bf16 v[228:231], v[104:107], v[116:119], v[228:231]
s_add_u32 s80, s78, 32768
buffer_store_dwordx4 v[24:27], v1, s[44:47], s80 offen sc1
v_mfma_f32_16x16x32_bf16 v[232:235], v[104:107], v[120:123], v[232:235]
v_mfma_f32_16x16x32_bf16 v[236:239], v[104:107], v[124:127], v[236:239]
v_mfma_f32_16x16x32_bf16 v[252:255], v[108:111], v[124:127], v[252:255]
v_accvgpr_read_b32 v20, a20
v_accvgpr_read_b32 v28, a21
v_mfma_f32_16x16x32_bf16 v[248:251], v[108:111], v[120:123], v[248:251]
s_add_u32 s72, s69, 30720
buffer_load_dwordx4 v4, s[4:7], s72 offen offset:2048 lds
v_mfma_f32_16x16x32_bf16 v[244:247], v[108:111], v[116:119], v[244:247]
v_accvgpr_read_b32 v21, a22
v_accvgpr_read_b32 v29, a23
v_mfma_f32_16x16x32_bf16 v[240:243], v[108:111], v[112:115], v[240:243]
s_waitcnt lgkmcnt(0)
v_accvgpr_read_b32 v22, a52
v_accvgpr_read_b32 v30, a53
v_mfma_f32_16x16x32_bf16 v[128:131], v[32:35], v[64:67], v[128:131]
ds_read_b64_tr_b16 v[80:81], v8 offset:40960
ds_read_b64_tr_b16 v[82:83], v8 offset:41984
v_mfma_f32_16x16x32_bf16 v[132:135], v[32:35], v[68:71], v[132:135]
ds_read_b128 v[112:115], v19 offset:32768
ds_read_b128 v[116:119], v19 offset:34816
v_mfma_f32_16x16x32_bf16 v[136:139], v[32:35], v[72:75], v[136:139]
s_add_u32 s72, s69, 46080
buffer_load_dwordx4 v5, s[4:7], s72 offen offset:3072 lds
v_mfma_f32_16x16x32_bf16 v[140:143], v[32:35], v[76:79], v[140:143]
ds_read_b128 v[120:123], v19 offset:36864
ds_read_b128 v[124:127], v19 offset:38912
v_mfma_f32_16x16x32_bf16 v[156:159], v[36:39], v[76:79], v[156:159]
ds_read_b64_tr_b16 v[84:85], v9 offset:40960
ds_read_b64_tr_b16 v[86:87], v9 offset:41984
v_mfma_f32_16x16x32_bf16 v[152:155], v[36:39], v[72:75], v[152:155]
ds_read_b64_tr_b16 v[88:89], v10 offset:40960
v_accvgpr_read_b32 v23, a54
v_mfma_f32_16x16x32_bf16 v[148:151], v[36:39], v[68:71], v[148:151]
ds_read_b64_tr_b16 v[90:91], v10 offset:41984
v_accvgpr_read_b32 v31, a55
v_mfma_f32_16x16x32_bf16 v[144:147], v[36:39], v[64:67], v[144:147]
s_add_u32 m0, s63, 69632
ds_read_b64_tr_b16 v[92:93], v11 offset:40960
v_mul_f32 v20, s79, v20
v_mfma_f32_16x16x32_bf16 v[160:163], v[40:43], v[64:67], v[160:163]
s_add_u32 s72, s70, 0
buffer_load_dwordx4 v4, s[4:7], s72 offen lds
v_mfma_f32_16x16x32_bf16 v[164:167], v[40:43], v[68:71], v[164:167]
ds_read_b64_tr_b16 v[94:95], v11 offset:41984
v_mul_f32 v28, s79, v28
v_mfma_f32_16x16x32_bf16 v[168:171], v[40:43], v[72:75], v[168:171]
ds_read_b64_tr_b16 v[96:97], v12 offset:40960
v_mul_f32 v21, s79, v21
v_mfma_f32_16x16x32_bf16 v[172:175], v[40:43], v[76:79], v[172:175]
ds_read_b64_tr_b16 v[98:99], v12 offset:41984
v_mul_f32 v29, s79, v29
v_mfma_f32_16x16x32_bf16 v[188:191], v[44:47], v[76:79], v[188:191]
s_add_u32 s72, s70, 15360
buffer_load_dwordx4 v5, s[4:7], s72 offen offset:1024 lds
v_mfma_f32_16x16x32_bf16 v[184:187], v[44:47], v[72:75], v[184:187]
ds_read_b64_tr_b16 v[100:101], v13 offset:40960
v_mul_f32 v22, s79, v22
v_mfma_f32_16x16x32_bf16 v[180:183], v[44:47], v[68:71], v[180:183]
ds_read_b64_tr_b16 v[102:103], v13 offset:41984
v_mul_f32 v30, s79, v30
v_mfma_f32_16x16x32_bf16 v[176:179], v[44:47], v[64:67], v[176:179]
ds_read_b64_tr_b16 v[104:105], v14 offset:40960
v_mul_f32 v23, s79, v23
v_mfma_f32_16x16x32_bf16 v[192:195], v[48:51], v[64:67], v[192:195]
ds_read_b64_tr_b16 v[106:107], v14 offset:41984
v_mul_f32 v31, s79, v31
v_mfma_f32_16x16x32_bf16 v[196:199], v[48:51], v[68:71], v[196:199]
s_add_u32 s72, s70, 30720
buffer_load_dwordx4 v4, s[4:7], s72 offen offset:2048 lds
v_mfma_f32_16x16x32_bf16 v[200:203], v[48:51], v[72:75], v[200:203]
ds_read_b64_tr_b16 v[108:109], v15 offset:40960
v_cvt_pk_bf16_f32 v20, v20, v28
v_mfma_f32_16x16x32_bf16 v[204:207], v[48:51], v[76:79], v[204:207]
ds_read_b64_tr_b16 v[110:111], v15 offset:41984
v_cvt_pk_bf16_f32 v21, v21, v29
v_mfma_f32_16x16x32_bf16 v[220:223], v[52:55], v[76:79], v[220:223]
v_cvt_pk_bf16_f32 v22, v22, v30
v_cvt_pk_bf16_f32 v23, v23, v31
v_mfma_f32_16x16x32_bf16 v[216:219], v[52:55], v[72:75], v[216:219]
s_add_u32 s80, s77, 36864
buffer_store_dwordx4 v[20:23], v1, s[44:47], s80 offen sc1
v_mfma_f32_16x16x32_bf16 v[212:215], v[52:55], v[68:71], v[212:215]
s_add_u32 s72, s70, 46080
buffer_load_dwordx4 v5, s[4:7], s72 offen offset:3072 lds
v_mfma_f32_16x16x32_bf16 v[208:211], v[52:55], v[64:67], v[208:211]
v_accvgpr_read_b32 v24, a152
v_accvgpr_read_b32 v28, a153
v_mfma_f32_16x16x32_bf16 v[224:227], v[56:59], v[64:67], v[224:227]
v_accvgpr_read_b32 v25, a154
v_accvgpr_read_b32 v29, a155
v_mfma_f32_16x16x32_bf16 v[228:231], v[56:59], v[68:71], v[228:231]
v_accvgpr_read_b32 v26, a156
v_accvgpr_read_b32 v30, a157
v_mfma_f32_16x16x32_bf16 v[232:235], v[56:59], v[72:75], v[232:235]
v_accvgpr_read_b32 v27, a158
v_accvgpr_read_b32 v31, a159
v_mfma_f32_16x16x32_bf16 v[236:239], v[56:59], v[76:79], v[236:239]
v_cvt_pk_bf16_f32 v24, v24, v28
v_cvt_pk_bf16_f32 v25, v25, v29
v_mfma_f32_16x16x32_bf16 v[252:255], v[60:63], v[76:79], v[252:255]
v_cvt_pk_bf16_f32 v26, v26, v30
v_cvt_pk_bf16_f32 v27, v27, v31
v_mfma_f32_16x16x32_bf16 v[248:251], v[60:63], v[72:75], v[248:251]
s_add_u32 s80, s78, 40960
buffer_store_dwordx4 v[24:27], v1, s[44:47], s80 offen sc1
v_mfma_f32_16x16x32_bf16 v[244:247], v[60:63], v[68:71], v[244:247]
s_waitcnt vmcnt(16) lgkmcnt(0)
v_mfma_f32_16x16x32_bf16 v[240:243], v[60:63], v[64:67], v[240:243]
s_barrier
v_mfma_f32_16x16x32_bf16 v[128:131], v[80:83], v[112:115], v[128:131]
s_add_u32 s73, s62, 5
ds_read_b64_tr_b16 v[32:33], v8 offset:0
ds_read_b64_tr_b16 v[34:35], v8 offset:1024
v_mfma_f32_16x16x32_bf16 v[132:135], v[80:83], v[116:119], v[132:135]
s_add_u32 s70, s73, s65
ds_read_b128 v[64:67], v16 offset:0
ds_read_b128 v[68:71], v16 offset:2048
v_mfma_f32_16x16x32_bf16 v[136:139], v[80:83], v[120:123], v[136:139]
s_and_b32 s70, s70, 3
ds_read_b128 v[72:75], v16 offset:4096
ds_read_b128 v[76:79], v16 offset:6144
v_mfma_f32_16x16x32_bf16 v[140:143], v[80:83], v[124:127], v[140:143]
s_and_b32 s73, s73, 12
ds_read_b64_tr_b16 v[36:37], v9 offset:0
ds_read_b64_tr_b16 v[38:39], v9 offset:1024
v_mfma_f32_16x16x32_bf16 v[156:159], v[84:87], v[124:127], v[156:159]
s_or_b32 s73, s73, s70
ds_read_b64_tr_b16 v[40:41], v10 offset:0
v_accvgpr_read_b32 v20, a24
v_mfma_f32_16x16x32_bf16 v[152:155], v[84:87], v[120:123], v[152:155]
s_lshl_b32 s71, s73, 19
ds_read_b64_tr_b16 v[42:43], v10 offset:1024
v_accvgpr_read_b32 v28, a25
v_mfma_f32_16x16x32_bf16 v[148:151], v[84:87], v[116:119], v[148:151]
s_add_u32 s71, s71, s66
ds_read_b64_tr_b16 v[44:45], v11 offset:0
v_accvgpr_read_b32 v21, a26
v_mfma_f32_16x16x32_bf16 v[144:147], v[84:87], v[112:115], v[144:147]
s_lshl_b32 s73, s73, 7
ds_read_b64_tr_b16 v[46:47], v11 offset:1024
v_accvgpr_read_b32 v29, a27
v_mfma_f32_16x16x32_bf16 v[160:163], v[88:91], v[112:115], v[160:163]
s_add_u32 s69, s73, s67
ds_read_b64_tr_b16 v[48:49], v12 offset:0
v_accvgpr_read_b32 v22, a56
v_mfma_f32_16x16x32_bf16 v[164:167], v[88:91], v[116:119], v[164:167]
s_add_u32 s70, s73, s68
ds_read_b64_tr_b16 v[50:51], v12 offset:1024
v_accvgpr_read_b32 v30, a57
v_mfma_f32_16x16x32_bf16 v[168:171], v[88:91], v[120:123], v[168:171]
s_add_u32 m0, s64, 32768
ds_read_b64_tr_b16 v[52:53], v13 offset:0
v_accvgpr_read_b32 v23, a58
v_mfma_f32_16x16x32_bf16 v[172:175], v[88:91], v[124:127], v[172:175]
s_add_u32 s72, s71, 0
buffer_load_dwordx4 v6, s[12:15], s72 offen lds
v_mfma_f32_16x16x32_bf16 v[188:191], v[92:95], v[124:127], v[188:191]
s_add_u32 s72, s71, 31744
buffer_load_dwordx4 v6, s[12:15], s72 offen offset:1024 lds
v_mfma_f32_16x16x32_bf16 v[184:187], v[92:95], v[120:123], v[184:187]
s_add_u32 s72, s71, 63488
buffer_load_dwordx4 v7, s[12:15], s72 offen offset:2048 lds
v_mfma_f32_16x16x32_bf16 v[180:183], v[92:95], v[116:119], v[180:183]
s_add_u32 s72, s71, 95232
buffer_load_dwordx4 v7, s[12:15], s72 offen offset:3072 lds
v_mfma_f32_16x16x32_bf16 v[176:179], v[92:95], v[112:115], v[176:179]
ds_read_b64_tr_b16 v[54:55], v13 offset:1024
v_accvgpr_read_b32 v31, a59
v_mfma_f32_16x16x32_bf16 v[192:195], v[96:99], v[112:115], v[192:195]
ds_read_b64_tr_b16 v[56:57], v14 offset:0
v_mul_f32 v20, s79, v20
v_mfma_f32_16x16x32_bf16 v[196:199], v[96:99], v[116:119], v[196:199]
ds_read_b64_tr_b16 v[58:59], v14 offset:1024
v_mul_f32 v28, s79, v28
v_mfma_f32_16x16x32_bf16 v[200:203], v[96:99], v[120:123], v[200:203]
ds_read_b64_tr_b16 v[60:61], v15 offset:0
v_mul_f32 v21, s79, v21
v_mfma_f32_16x16x32_bf16 v[204:207], v[96:99], v[124:127], v[204:207]
s_add_u32 m0, s63, 98304
ds_read_b64_tr_b16 v[62:63], v15 offset:1024
v_mul_f32 v29, s79, v29
v_mfma_f32_16x16x32_bf16 v[220:223], v[100:103], v[124:127], v[220:223]
s_add_u32 s72, s69, 0
buffer_load_dwordx4 v4, s[4:7], s72 offen lds
v_mfma_f32_16x16x32_bf16 v[216:219], v[100:103], v[120:123], v[216:219]
v_mul_f32 v22, s79, v22
v_mul_f32 v30, s79, v30
v_mfma_f32_16x16x32_bf16 v[212:215], v[100:103], v[116:119], v[212:215]
v_mul_f32 v23, s79, v23
v_mul_f32 v31, s79, v31
v_mfma_f32_16x16x32_bf16 v[208:211], v[100:103], v[112:115], v[208:211]
v_cvt_pk_bf16_f32 v20, v20, v28
v_cvt_pk_bf16_f32 v21, v21, v29
v_mfma_f32_16x16x32_bf16 v[224:227], v[104:107], v[112:115], v[224:227]
s_add_u32 s72, s69, 15360
buffer_load_dwordx4 v5, s[4:7], s72 offen offset:1024 lds
v_mfma_f32_16x16x32_bf16 v[228:231], v[104:107], v[116:119], v[228:231]
v_cvt_pk_bf16_f32 v22, v22, v30
v_cvt_pk_bf16_f32 v23, v23, v31
v_mfma_f32_16x16x32_bf16 v[232:235], v[104:107], v[120:123], v[232:235]
s_add_u32 s80, s77, 40960
buffer_store_dwordx4 v[20:23], v1, s[44:47], s80 offen sc1
v_mfma_f32_16x16x32_bf16 v[236:239], v[104:107], v[124:127], v[236:239]
v_accvgpr_read_b32 v24, a160
v_accvgpr_read_b32 v28, a161
v_mfma_f32_16x16x32_bf16 v[252:255], v[108:111], v[124:127], v[252:255]
v_accvgpr_read_b32 v25, a162
v_accvgpr_read_b32 v29, a163
v_mfma_f32_16x16x32_bf16 v[248:251], v[108:111], v[120:123], v[248:251]
s_add_u32 s72, s69, 30720
buffer_load_dwordx4 v4, s[4:7], s72 offen offset:2048 lds
v_mfma_f32_16x16x32_bf16 v[244:247], v[108:111], v[116:119], v[244:247]
v_accvgpr_read_b32 v26, a164
v_accvgpr_read_b32 v30, a165
v_mfma_f32_16x16x32_bf16 v[240:243], v[108:111], v[112:115], v[240:243]
s_waitcnt lgkmcnt(0)
v_accvgpr_read_b32 v27, a166
v_accvgpr_read_b32 v31, a167
v_mfma_f32_16x16x32_bf16 v[128:131], v[32:35], v[64:67], v[128:131]
ds_read_b64_tr_b16 v[80:81], v8 offset:8192
ds_read_b64_tr_b16 v[82:83], v8 offset:9216
v_mfma_f32_16x16x32_bf16 v[132:135], v[32:35], v[68:71], v[132:135]
ds_read_b128 v[112:115], v17 offset:0
ds_read_b128 v[116:119], v17 offset:2048
v_mfma_f32_16x16x32_bf16 v[136:139], v[32:35], v[72:75], v[136:139]
s_add_u32 s72, s69, 46080
buffer_load_dwordx4 v5, s[4:7], s72 offen offset:3072 lds
v_mfma_f32_16x16x32_bf16 v[140:143], v[32:35], v[76:79], v[140:143]
ds_read_b128 v[120:123], v17 offset:4096
ds_read_b128 v[124:127], v17 offset:6144
v_mfma_f32_16x16x32_bf16 v[156:159], v[36:39], v[76:79], v[156:159]
ds_read_b64_tr_b16 v[84:85], v9 offset:8192
ds_read_b64_tr_b16 v[86:87], v9 offset:9216
v_mfma_f32_16x16x32_bf16 v[152:155], v[36:39], v[72:75], v[152:155]
ds_read_b64_tr_b16 v[88:89], v10 offset:8192
v_cvt_pk_bf16_f32 v24, v24, v28
v_mfma_f32_16x16x32_bf16 v[148:151], v[36:39], v[68:71], v[148:151]
ds_read_b64_tr_b16 v[90:91], v10 offset:9216
v_cvt_pk_bf16_f32 v25, v25, v29
v_mfma_f32_16x16x32_bf16 v[144:147], v[36:39], v[64:67], v[144:147]
s_add_u32 m0, s63, 102400
ds_read_b64_tr_b16 v[92:93], v11 offset:8192
v_cvt_pk_bf16_f32 v26, v26, v30
v_mfma_f32_16x16x32_bf16 v[160:163], v[40:43], v[64:67], v[160:163]
s_add_u32 s72, s70, 0
buffer_load_dwordx4 v4, s[4:7], s72 offen lds
v_mfma_f32_16x16x32_bf16 v[164:167], v[40:43], v[68:71], v[164:167]
ds_read_b64_tr_b16 v[94:95], v11 offset:9216
v_cvt_pk_bf16_f32 v27, v27, v31
v_mfma_f32_16x16x32_bf16 v[168:171], v[40:43], v[72:75], v[168:171]
s_add_u32 s80, s78, 1024
ds_read_b64_tr_b16 v[96:97], v12 offset:8192
v_mfma_f32_16x16x32_bf16 v[172:175], v[40:43], v[76:79], v[172:175]
ds_read_b64_tr_b16 v[98:99], v12 offset:9216
v_mfma_f32_16x16x32_bf16 v[188:191], v[44:47], v[76:79], v[188:191]
s_add_u32 s72, s70, 15360
buffer_load_dwordx4 v5, s[4:7], s72 offen offset:1024 lds
v_mfma_f32_16x16x32_bf16 v[184:187], v[44:47], v[72:75], v[184:187]
ds_read_b64_tr_b16 v[100:101], v13 offset:8192
v_accvgpr_read_b32 v20, a28
v_mfma_f32_16x16x32_bf16 v[180:183], v[44:47], v[68:71], v[180:183]
ds_read_b64_tr_b16 v[102:103], v13 offset:9216
v_accvgpr_read_b32 v28, a29
v_mfma_f32_16x16x32_bf16 v[176:179], v[44:47], v[64:67], v[176:179]
ds_read_b64_tr_b16 v[104:105], v14 offset:8192
v_accvgpr_read_b32 v21, a30
v_mfma_f32_16x16x32_bf16 v[192:195], v[48:51], v[64:67], v[192:195]
ds_read_b64_tr_b16 v[106:107], v14 offset:9216
v_accvgpr_read_b32 v29, a31
v_mfma_f32_16x16x32_bf16 v[196:199], v[48:51], v[68:71], v[196:199]
s_add_u32 s72, s70, 30720
buffer_load_dwordx4 v4, s[4:7], s72 offen offset:2048 lds
v_mfma_f32_16x16x32_bf16 v[200:203], v[48:51], v[72:75], v[200:203]
ds_read_b64_tr_b16 v[108:109], v15 offset:8192
v_accvgpr_read_b32 v22, a60
v_mfma_f32_16x16x32_bf16 v[204:207], v[48:51], v[76:79], v[204:207]
ds_read_b64_tr_b16 v[110:111], v15 offset:9216
v_accvgpr_read_b32 v30, a61
v_mfma_f32_16x16x32_bf16 v[220:223], v[52:55], v[76:79], v[220:223]
buffer_store_dwordx4 v[24:27], v1, s[44:47], s80 offen sc1
v_mfma_f32_16x16x32_bf16 v[216:219], v[52:55], v[72:75], v[216:219]
v_accvgpr_read_b32 v23, a62
v_accvgpr_read_b32 v31, a63
v_mfma_f32_16x16x32_bf16 v[212:215], v[52:55], v[68:71], v[212:215]
s_add_u32 s72, s70, 46080
buffer_load_dwordx4 v5, s[4:7], s72 offen offset:3072 lds
v_mfma_f32_16x16x32_bf16 v[208:211], v[52:55], v[64:67], v[208:211]
v_mul_f32 v20, s79, v20
v_mul_f32 v28, s79, v28
v_mfma_f32_16x16x32_bf16 v[224:227], v[56:59], v[64:67], v[224:227]
v_mul_f32 v21, s79, v21
v_mul_f32 v29, s79, v29
v_mfma_f32_16x16x32_bf16 v[228:231], v[56:59], v[68:71], v[228:231]
v_mul_f32 v22, s79, v22
v_mul_f32 v30, s79, v30
v_mfma_f32_16x16x32_bf16 v[232:235], v[56:59], v[72:75], v[232:235]
v_mul_f32 v23, s79, v23
v_mul_f32 v31, s79, v31
v_mfma_f32_16x16x32_bf16 v[236:239], v[56:59], v[76:79], v[236:239]
v_cvt_pk_bf16_f32 v20, v20, v28
v_cvt_pk_bf16_f32 v21, v21, v29
v_mfma_f32_16x16x32_bf16 v[252:255], v[60:63], v[76:79], v[252:255]
v_cvt_pk_bf16_f32 v22, v22, v30
v_cvt_pk_bf16_f32 v23, v23, v31
v_mfma_f32_16x16x32_bf16 v[248:251], v[60:63], v[72:75], v[248:251]
s_add_u32 s80, s77, 45056
buffer_store_dwordx4 v[20:23], v1, s[44:47], s80 offen sc1
v_mfma_f32_16x16x32_bf16 v[244:247], v[60:63], v[68:71], v[244:247]
s_waitcnt vmcnt(16) lgkmcnt(0)
v_mfma_f32_16x16x32_bf16 v[240:243], v[60:63], v[64:67], v[240:243]
s_barrier
v_mfma_f32_16x16x32_bf16 v[128:131], v[80:83], v[112:115], v[128:131]
s_add_u32 s73, s62, 6
ds_read_b64_tr_b16 v[32:33], v8 offset:16384
ds_read_b64_tr_b16 v[34:35], v8 offset:17408
v_mfma_f32_16x16x32_bf16 v[132:135], v[80:83], v[116:119], v[132:135]
s_add_u32 s70, s73, s65
ds_read_b128 v[64:67], v18 offset:0
ds_read_b128 v[68:71], v18 offset:2048
v_mfma_f32_16x16x32_bf16 v[136:139], v[80:83], v[120:123], v[136:139]
s_and_b32 s70, s70, 3
ds_read_b128 v[72:75], v18 offset:4096
ds_read_b128 v[76:79], v18 offset:6144
v_mfma_f32_16x16x32_bf16 v[140:143], v[80:83], v[124:127], v[140:143]
s_and_b32 s73, s73, 12
ds_read_b64_tr_b16 v[36:37], v9 offset:16384
ds_read_b64_tr_b16 v[38:39], v9 offset:17408
v_mfma_f32_16x16x32_bf16 v[156:159], v[84:87], v[124:127], v[156:159]
s_or_b32 s73, s73, s70
ds_read_b64_tr_b16 v[40:41], v10 offset:16384
v_accvgpr_read_b32 v24, a168
v_mfma_f32_16x16x32_bf16 v[152:155], v[84:87], v[120:123], v[152:155]
s_lshl_b32 s71, s73, 19
ds_read_b64_tr_b16 v[42:43], v10 offset:17408
v_accvgpr_read_b32 v28, a169
v_mfma_f32_16x16x32_bf16 v[148:151], v[84:87], v[116:119], v[148:151]
s_add_u32 s71, s71, s66
ds_read_b64_tr_b16 v[44:45], v11 offset:16384
v_accvgpr_read_b32 v25, a170
v_mfma_f32_16x16x32_bf16 v[144:147], v[84:87], v[112:115], v[144:147]
s_lshl_b32 s73, s73, 7
ds_read_b64_tr_b16 v[46:47], v11 offset:17408
v_accvgpr_read_b32 v29, a171
v_mfma_f32_16x16x32_bf16 v[160:163], v[88:91], v[112:115], v[160:163]
s_add_u32 s69, s73, s67
ds_read_b64_tr_b16 v[48:49], v12 offset:16384
v_accvgpr_read_b32 v26, a172
v_mfma_f32_16x16x32_bf16 v[164:167], v[88:91], v[116:119], v[164:167]
s_add_u32 s70, s73, s68
ds_read_b64_tr_b16 v[50:51], v12 offset:17408
v_accvgpr_read_b32 v30, a173
v_mfma_f32_16x16x32_bf16 v[168:171], v[88:91], v[120:123], v[168:171]
s_add_u32 m0, s64, 0
ds_read_b64_tr_b16 v[52:53], v13 offset:16384
v_accvgpr_read_b32 v27, a174
v_mfma_f32_16x16x32_bf16 v[172:175], v[88:91], v[124:127], v[172:175]
s_add_u32 s72, s71, 0
buffer_load_dwordx4 v6, s[12:15], s72 offen lds
v_mfma_f32_16x16x32_bf16 v[188:191], v[92:95], v[124:127], v[188:191]
s_add_u32 s72, s71, 31744
buffer_load_dwordx4 v6, s[12:15], s72 offen offset:1024 lds
v_mfma_f32_16x16x32_bf16 v[184:187], v[92:95], v[120:123], v[184:187]
s_add_u32 s72, s71, 63488
buffer_load_dwordx4 v7, s[12:15], s72 offen offset:2048 lds
v_mfma_f32_16x16x32_bf16 v[180:183], v[92:95], v[116:119], v[180:183]
s_add_u32 s72, s71, 95232
buffer_load_dwordx4 v7, s[12:15], s72 offen offset:3072 lds
v_mfma_f32_16x16x32_bf16 v[176:179], v[92:95], v[112:115], v[176:179]
ds_read_b64_tr_b16 v[54:55], v13 offset:17408
v_accvgpr_read_b32 v31, a175
v_mfma_f32_16x16x32_bf16 v[192:195], v[96:99], v[112:115], v[192:195]
ds_read_b64_tr_b16 v[56:57], v14 offset:16384
v_cvt_pk_bf16_f32 v24, v24, v28
v_mfma_f32_16x16x32_bf16 v[196:199], v[96:99], v[116:119], v[196:199]
ds_read_b64_tr_b16 v[58:59], v14 offset:17408
v_cvt_pk_bf16_f32 v25, v25, v29
v_mfma_f32_16x16x32_bf16 v[200:203], v[96:99], v[120:123], v[200:203]
ds_read_b64_tr_b16 v[60:61], v15 offset:16384
v_cvt_pk_bf16_f32 v26, v26, v30
v_mfma_f32_16x16x32_bf16 v[204:207], v[96:99], v[124:127], v[204:207]
s_add_u32 m0, s63, 131072
ds_read_b64_tr_b16 v[62:63], v15 offset:17408
v_cvt_pk_bf16_f32 v27, v27, v31
v_mfma_f32_16x16x32_bf16 v[220:223], v[100:103], v[124:127], v[220:223]
s_add_u32 s72, s69, 0
buffer_load_dwordx4 v4, s[4:7], s72 offen lds
v_mfma_f32_16x16x32_bf16 v[216:219], v[100:103], v[120:123], v[216:219]
s_add_u32 s80, s78, 9216
buffer_store_dwordx4 v[24:27], v1, s[44:47], s80 offen sc1
v_mfma_f32_16x16x32_bf16 v[212:215], v[100:103], v[116:119], v[212:215]
v_accvgpr_read_b32 v20, a64
v_accvgpr_read_b32 v28, a65
v_mfma_f32_16x16x32_bf16 v[208:211], v[100:103], v[112:115], v[208:211]
v_accvgpr_read_b32 v21, a66
v_accvgpr_read_b32 v29, a67
v_mfma_f32_16x16x32_bf16 v[224:227], v[104:107], v[112:115], v[224:227]
s_add_u32 s72, s69, 15360
buffer_load_dwordx4 v5, s[4:7], s72 offen offset:1024 lds
v_mfma_f32_16x16x32_bf16 v[228:231], v[104:107], v[116:119], v[228:231]
v_accvgpr_read_b32 v22, a96
v_accvgpr_read_b32 v30, a97
v_mfma_f32_16x16x32_bf16 v[232:235], v[104:107], v[120:123], v[232:235]
v_accvgpr_read_b32 v23, a98
v_accvgpr_read_b32 v31, a99
v_mfma_f32_16x16x32_bf16 v[236:239], v[104:107], v[124:127], v[236:239]
v_mul_f32 v20, s79, v20
v_mul_f32 v28, s79, v28
v_mfma_f32_16x16x32_bf16 v[252:255], v[108:111], v[124:127], v[252:255]
v_mul_f32 v21, s79, v21
v_mul_f32 v29, s79, v29
v_mfma_f32_16x16x32_bf16 v[248:251], v[108:111], v[120:123], v[248:251]
s_add_u32 s72, s69, 30720
buffer_load_dwordx4 v4, s[4:7], s72 offen offset:2048 lds
v_mfma_f32_16x16x32_bf16 v[244:247], v[108:111], v[116:119], v[244:247]
v_mul_f32 v22, s79, v22
v_mul_f32 v30, s79, v30
v_mfma_f32_16x16x32_bf16 v[240:243], v[108:111], v[112:115], v[240:243]
s_waitcnt lgkmcnt(0)
v_mul_f32 v23, s79, v23
v_mul_f32 v31, s79, v31
v_mfma_f32_16x16x32_bf16 v[128:131], v[32:35], v[64:67], v[128:131]
ds_read_b64_tr_b16 v[80:81], v8 offset:24576
ds_read_b64_tr_b16 v[82:83], v8 offset:25600
v_mfma_f32_16x16x32_bf16 v[132:135], v[32:35], v[68:71], v[132:135]
ds_read_b128 v[112:115], v19 offset:0
ds_read_b128 v[116:119], v19 offset:2048
v_mfma_f32_16x16x32_bf16 v[136:139], v[32:35], v[72:75], v[136:139]
s_add_u32 s72, s69, 46080
buffer_load_dwordx4 v5, s[4:7], s72 offen offset:3072 lds
v_mfma_f32_16x16x32_bf16 v[140:143], v[32:35], v[76:79], v[140:143]
ds_read_b128 v[120:123], v19 offset:4096
ds_read_b128 v[124:127], v19 offset:6144
v_mfma_f32_16x16x32_bf16 v[156:159], v[36:39], v[76:79], v[156:159]
ds_read_b64_tr_b16 v[84:85], v9 offset:24576
ds_read_b64_tr_b16 v[86:87], v9 offset:25600
v_mfma_f32_16x16x32_bf16 v[152:155], v[36:39], v[72:75], v[152:155]
ds_read_b64_tr_b16 v[88:89], v10 offset:24576
v_cvt_pk_bf16_f32 v20, v20, v28
v_mfma_f32_16x16x32_bf16 v[148:151], v[36:39], v[68:71], v[148:151]
ds_read_b64_tr_b16 v[90:91], v10 offset:25600
v_cvt_pk_bf16_f32 v21, v21, v29
v_mfma_f32_16x16x32_bf16 v[144:147], v[36:39], v[64:67], v[144:147]
s_add_u32 m0, s63, 135168
ds_read_b64_tr_b16 v[92:93], v11 offset:24576
v_cvt_pk_bf16_f32 v22, v22, v30
v_mfma_f32_16x16x32_bf16 v[160:163], v[40:43], v[64:67], v[160:163]
s_add_u32 s72, s70, 0
buffer_load_dwordx4 v4, s[4:7], s72 offen lds
v_mfma_f32_16x16x32_bf16 v[164:167], v[40:43], v[68:71], v[164:167]
ds_read_b64_tr_b16 v[94:95], v11 offset:25600
v_cvt_pk_bf16_f32 v23, v23, v31
v_mfma_f32_16x16x32_bf16 v[168:171], v[40:43], v[72:75], v[168:171]
s_add_u32 s80, s77, 1024
ds_read_b64_tr_b16 v[96:97], v12 offset:24576
v_accvgpr_read_b32 v24, a176
v_mfma_f32_16x16x32_bf16 v[172:175], v[40:43], v[76:79], v[172:175]
ds_read_b64_tr_b16 v[98:99], v12 offset:25600
v_accvgpr_read_b32 v28, a177
v_mfma_f32_16x16x32_bf16 v[188:191], v[44:47], v[76:79], v[188:191]
s_add_u32 s72, s70, 15360
buffer_load_dwordx4 v5, s[4:7], s72 offen offset:1024 lds
v_mfma_f32_16x16x32_bf16 v[184:187], v[44:47], v[72:75], v[184:187]
ds_read_b64_tr_b16 v[100:101], v13 offset:24576
v_accvgpr_read_b32 v25, a178
v_mfma_f32_16x16x32_bf16 v[180:183], v[44:47], v[68:71], v[180:183]
ds_read_b64_tr_b16 v[102:103], v13 offset:25600
v_accvgpr_read_b32 v29, a179
v_mfma_f32_16x16x32_bf16 v[176:179], v[44:47], v[64:67], v[176:179]
ds_read_b64_tr_b16 v[104:105], v14 offset:24576
v_accvgpr_read_b32 v26, a180
v_mfma_f32_16x16x32_bf16 v[192:195], v[48:51], v[64:67], v[192:195]
ds_read_b64_tr_b16 v[106:107], v14 offset:25600
v_accvgpr_read_b32 v30, a181
v_mfma_f32_16x16x32_bf16 v[196:199], v[48:51], v[68:71], v[196:199]
s_add_u32 s72, s70, 30720
buffer_load_dwordx4 v4, s[4:7], s72 offen offset:2048 lds
v_mfma_f32_16x16x32_bf16 v[200:203], v[48:51], v[72:75], v[200:203]
ds_read_b64_tr_b16 v[108:109], v15 offset:24576
v_accvgpr_read_b32 v27, a182
v_mfma_f32_16x16x32_bf16 v[204:207], v[48:51], v[76:79], v[204:207]
ds_read_b64_tr_b16 v[110:111], v15 offset:25600
v_accvgpr_read_b32 v31, a183
v_mfma_f32_16x16x32_bf16 v[220:223], v[52:55], v[76:79], v[220:223]
buffer_store_dwordx4 v[20:23], v1, s[44:47], s80 offen sc1
v_mfma_f32_16x16x32_bf16 v[216:219], v[52:55], v[72:75], v[216:219]
v_cvt_pk_bf16_f32 v24, v24, v28
v_cvt_pk_bf16_f32 v25, v25, v29
v_mfma_f32_16x16x32_bf16 v[212:215], v[52:55], v[68:71], v[212:215]
s_add_u32 s72, s70, 46080
buffer_load_dwordx4 v5, s[4:7], s72 offen offset:3072 lds
v_mfma_f32_16x16x32_bf16 v[208:211], v[52:55], v[64:67], v[208:211]
v_cvt_pk_bf16_f32 v26, v26, v30
v_cvt_pk_bf16_f32 v27, v27, v31
v_mfma_f32_16x16x32_bf16 v[224:227], v[56:59], v[64:67], v[224:227]
s_add_u32 s80, s78, 33792
buffer_store_dwordx4 v[24:27], v1, s[44:47], s80 offen sc1
v_mfma_f32_16x16x32_bf16 v[228:231], v[56:59], v[68:71], v[228:231]
v_mfma_f32_16x16x32_bf16 v[232:235], v[56:59], v[72:75], v[232:235]
v_mfma_f32_16x16x32_bf16 v[236:239], v[56:59], v[76:79], v[236:239]
v_mfma_f32_16x16x32_bf16 v[252:255], v[60:63], v[76:79], v[252:255]
v_mfma_f32_16x16x32_bf16 v[248:251], v[60:63], v[72:75], v[248:251]
v_mfma_f32_16x16x32_bf16 v[244:247], v[60:63], v[68:71], v[244:247]
s_waitcnt vmcnt(16) lgkmcnt(0)
v_accvgpr_read_b32 v20, a68
v_accvgpr_read_b32 v28, a69
v_mfma_f32_16x16x32_bf16 v[240:243], v[60:63], v[64:67], v[240:243]
s_barrier
v_accvgpr_read_b32 v21, a70
v_accvgpr_read_b32 v29, a71
v_mfma_f32_16x16x32_bf16 v[128:131], v[80:83], v[112:115], v[128:131]
s_add_u32 s73, s62, 7
ds_read_b64_tr_b16 v[32:33], v8 offset:32768
ds_read_b64_tr_b16 v[34:35], v8 offset:33792
v_mfma_f32_16x16x32_bf16 v[132:135], v[80:83], v[116:119], v[132:135]
s_add_u32 s70, s73, s65
ds_read_b128 v[64:67], v18 offset:32768
ds_read_b128 v[68:71], v18 offset:34816
v_mfma_f32_16x16x32_bf16 v[136:139], v[80:83], v[120:123], v[136:139]
s_and_b32 s70, s70, 3
ds_read_b128 v[72:75], v18 offset:36864
ds_read_b128 v[76:79], v18 offset:38912
v_mfma_f32_16x16x32_bf16 v[140:143], v[80:83], v[124:127], v[140:143]
s_and_b32 s73, s73, 12
ds_read_b64_tr_b16 v[36:37], v9 offset:32768
ds_read_b64_tr_b16 v[38:39], v9 offset:33792
v_mfma_f32_16x16x32_bf16 v[156:159], v[84:87], v[124:127], v[156:159]
s_or_b32 s73, s73, s70
ds_read_b64_tr_b16 v[40:41], v10 offset:32768
v_accvgpr_read_b32 v22, a100
v_mfma_f32_16x16x32_bf16 v[152:155], v[84:87], v[120:123], v[152:155]
s_lshl_b32 s71, s73, 19
ds_read_b64_tr_b16 v[42:43], v10 offset:33792
v_accvgpr_read_b32 v30, a101
v_mfma_f32_16x16x32_bf16 v[148:151], v[84:87], v[116:119], v[148:151]
s_add_u32 s71, s71, s66
ds_read_b64_tr_b16 v[44:45], v11 offset:32768
v_accvgpr_read_b32 v23, a102
v_mfma_f32_16x16x32_bf16 v[144:147], v[84:87], v[112:115], v[144:147]
s_lshl_b32 s73, s73, 7
ds_read_b64_tr_b16 v[46:47], v11 offset:33792
v_accvgpr_read_b32 v31, a103
v_mfma_f32_16x16x32_bf16 v[160:163], v[88:91], v[112:115], v[160:163]
s_add_u32 s69, s73, s67
ds_read_b64_tr_b16 v[48:49], v12 offset:32768
v_mul_f32 v20, s79, v20
v_mfma_f32_16x16x32_bf16 v[164:167], v[88:91], v[116:119], v[164:167]
s_add_u32 s70, s73, s68
ds_read_b64_tr_b16 v[50:51], v12 offset:33792
v_mul_f32 v28, s79, v28
v_mfma_f32_16x16x32_bf16 v[168:171], v[88:91], v[120:123], v[168:171]
s_add_u32 m0, s64, 16384
ds_read_b64_tr_b16 v[52:53], v13 offset:32768
v_mul_f32 v21, s79, v21
v_mfma_f32_16x16x32_bf16 v[172:175], v[88:91], v[124:127], v[172:175]
s_add_u32 s72, s71, 0
buffer_load_dwordx4 v6, s[12:15], s72 offen lds
v_mfma_f32_16x16x32_bf16 v[188:191], v[92:95], v[124:127], v[188:191]
s_add_u32 s72, s71, 31744
buffer_load_dwordx4 v6, s[12:15], s72 offen offset:1024 lds
v_mfma_f32_16x16x32_bf16 v[184:187], v[92:95], v[120:123], v[184:187]
s_add_u32 s72, s71, 63488
buffer_load_dwordx4 v7, s[12:15], s72 offen offset:2048 lds
v_mfma_f32_16x16x32_bf16 v[180:183], v[92:95], v[116:119], v[180:183]
s_add_u32 s72, s71, 95232
buffer_load_dwordx4 v7, s[12:15], s72 offen offset:3072 lds
v_mfma_f32_16x16x32_bf16 v[176:179], v[92:95], v[112:115], v[176:179]
ds_read_b64_tr_b16 v[54:55], v13 offset:33792
v_mul_f32 v29, s79, v29
v_mfma_f32_16x16x32_bf16 v[192:195], v[96:99], v[112:115], v[192:195]
ds_read_b64_tr_b16 v[56:57], v14 offset:32768
v_mul_f32 v22, s79, v22
v_mfma_f32_16x16x32_bf16 v[196:199], v[96:99], v[116:119], v[196:199]
ds_read_b64_tr_b16 v[58:59], v14 offset:33792
v_mul_f32 v30, s79, v30
v_mfma_f32_16x16x32_bf16 v[200:203], v[96:99], v[120:123], v[200:203]
ds_read_b64_tr_b16 v[60:61], v15 offset:32768
v_mul_f32 v23, s79, v23
v_mfma_f32_16x16x32_bf16 v[204:207], v[96:99], v[124:127], v[204:207]
s_add_u32 m0, s63, 65536
ds_read_b64_tr_b16 v[62:63], v15 offset:33792
v_mul_f32 v31, s79, v31
v_mfma_f32_16x16x32_bf16 v[220:223], v[100:103], v[124:127], v[220:223]
s_add_u32 s72, s69, 0
buffer_load_dwordx4 v4, s[4:7], s72 offen lds
v_mfma_f32_16x16x32_bf16 v[216:219], v[100:103], v[120:123], v[216:219]
v_cvt_pk_bf16_f32 v20, v20, v28
v_cvt_pk_bf16_f32 v21, v21, v29
v_mfma_f32_16x16x32_bf16 v[212:215], v[100:103], v[116:119], v[212:215]
v_cvt_pk_bf16_f32 v22, v22, v30
v_cvt_pk_bf16_f32 v23, v23, v31
v_mfma_f32_16x16x32_bf16 v[208:211], v[100:103], v[112:115], v[208:211]
s_add_u32 s80, s77, 5120
buffer_store_dwordx4 v[20:23], v1, s[44:47], s80 offen sc1
v_mfma_f32_16x16x32_bf16 v[224:227], v[104:107], v[112:115], v[224:227]
s_add_u32 s72, s69, 15360
buffer_load_dwordx4 v5, s[4:7], s72 offen offset:1024 lds
v_mfma_f32_16x16x32_bf16 v[228:231], v[104:107], v[116:119], v[228:231]
v_accvgpr_read_b32 v24, a184
v_accvgpr_read_b32 v28, a185
v_mfma_f32_16x16x32_bf16 v[232:235], v[104:107], v[120:123], v[232:235]
v_accvgpr_read_b32 v25, a186
v_accvgpr_read_b32 v29, a187
v_mfma_f32_16x16x32_bf16 v[236:239], v[104:107], v[124:127], v[236:239]
v_accvgpr_read_b32 v26, a188
v_accvgpr_read_b32 v30, a189
v_mfma_f32_16x16x32_bf16 v[252:255], v[108:111], v[124:127], v[252:255]
v_accvgpr_read_b32 v27, a190
v_accvgpr_read_b32 v31, a191
v_mfma_f32_16x16x32_bf16 v[248:251], v[108:111], v[120:123], v[248:251]
s_add_u32 s72, s69, 30720
buffer_load_dwordx4 v4, s[4:7], s72 offen offset:2048 lds
v_mfma_f32_16x16x32_bf16 v[244:247], v[108:111], v[116:119], v[244:247]
v_cvt_pk_bf16_f32 v24, v24, v28
v_cvt_pk_bf16_f32 v25, v25, v29
v_mfma_f32_16x16x32_bf16 v[240:243], v[108:111], v[112:115], v[240:243]
s_waitcnt lgkmcnt(0)
v_cvt_pk_bf16_f32 v26, v26, v30
v_cvt_pk_bf16_f32 v27, v27, v31
v_mfma_f32_16x16x32_bf16 v[128:131], v[32:35], v[64:67], v[128:131]
s_lshr_b32 s75, s93, 4
ds_read_b64_tr_b16 v[80:81], v8 offset:40960
ds_read_b64_tr_b16 v[82:83], v8 offset:41984
v_mfma_f32_16x16x32_bf16 v[132:135], v[32:35], v[68:71], v[132:135]
s_and_b32 s75, s75, 0x7f00
ds_read_b128 v[112:115], v19 offset:32768
ds_read_b128 v[116:119], v19 offset:34816
v_mfma_f32_16x16x32_bf16 v[136:139], v[32:35], v[72:75], v[136:139]
s_add_u32 s72, s69, 46080
buffer_load_dwordx4 v5, s[4:7], s72 offen offset:3072 lds
v_mfma_f32_16x16x32_bf16 v[140:143], v[32:35], v[76:79], v[140:143]
s_add_u32 s75, s75, LcB1-Lpc0
v_lshrrev_b32 v2, 5, v0
v_lshlrev_b32 v2, 7, v2
v_mfma_f32_16x16x32_bf16 v[156:159], v[36:39], v[76:79], v[156:159]
s_add_u32 s80, s78, 41984
v_add_u32 v2, s75, v2
v_min_u32 v2, Lcode_end-Lpc0, v2
v_mfma_f32_16x16x32_bf16 v[152:155], v[36:39], v[72:75], v[152:155]
global_load_dword v3, v2, s[98:99]
v_mfma_f32_16x16x32_bf16 v[148:151], v[36:39], v[68:71], v[148:151]
ds_read_b128 v[120:123], v19 offset:36864
ds_read_b128 v[124:127], v19 offset:38912
v_mfma_f32_16x16x32_bf16 v[144:147], v[36:39], v[64:67], v[144:147]
s_add_u32 m0, s63, 69632
ds_read_b64_tr_b16 v[84:85], v9 offset:40960
ds_read_b64_tr_b16 v[86:87], v9 offset:41984
v_mfma_f32_16x16x32_bf16 v[160:163], v[40:43], v[64:67], v[160:163]
s_add_u32 s72, s70, 0
buffer_load_dwordx4 v4, s[4:7], s72 offen lds
v_mfma_f32_16x16x32_bf16 v[164:167], v[40:43], v[68:71], v[164:167]
ds_read_b64_tr_b16 v[88:89], v10 offset:40960
v_accvgpr_read_b32 v20, a72
v_mfma_f32_16x16x32_bf16 v[168:171], v[40:43], v[72:75], v[168:171]
ds_read_b64_tr_b16 v[90:91], v10 offset:41984
v_accvgpr_read_b32 v28, a73
v_mfma_f32_16x16x32_bf16 v[172:175], v[40:43], v[76:79], v[172:175]
ds_read_b64_tr_b16 v[92:93], v11 offset:40960
v_accvgpr_read_b32 v21, a74
v_mfma_f32_16x16x32_bf16 v[188:191], v[44:47], v[76:79], v[188:191]
s_add_u32 s72, s70, 15360
buffer_load_dwordx4 v5, s[4:7], s72 offen offset:1024 lds
v_mfma_f32_16x16x32_bf16 v[184:187], v[44:47], v[72:75], v[184:187]
ds_read_b64_tr_b16 v[94:95], v11 offset:41984
v_accvgpr_read_b32 v29, a75
v_mfma_f32_16x16x32_bf16 v[180:183], v[44:47], v[68:71], v[180:183]
ds_read_b64_tr_b16 v[96:97], v12 offset:40960
v_accvgpr_read_b32 v22, a104
v_mfma_f32_16x16x32_bf16 v[176:179], v[44:47], v[64:67], v[176:179]
ds_read_b64_tr_b16 v[98:99], v12 offset:41984
v_accvgpr_read_b32 v30, a105
v_mfma_f32_16x16x32_bf16 v[192:195], v[48:51], v[64:67], v[192:195]
ds_read_b64_tr_b16 v[100:101], v13 offset:40960
v_accvgpr_read_b32 v23, a106
v_mfma_f32_16x16x32_bf16 v[196:199], v[48:51], v[68:71], v[196:199]
s_add_u32 s72, s70, 30720
buffer_load_dwordx4 v4, s[4:7], s72 offen offset:2048 lds
v_mfma_f32_16x16x32_bf16 v[200:203], v[48:51], v[72:75], v[200:203]
ds_read_b64_tr_b16 v[102:103], v13 offset:41984
v_accvgpr_read_b32 v31, a107
v_mfma_f32_16x16x32_bf16 v[204:207], v[48:51], v[76:79], v[204:207]
ds_read_b64_tr_b16 v[104:105], v14 offset:40960
v_mul_f32 v20, s79, v20
v_mfma_f32_16x16x32_bf16 v[220:223], v[52:55], v[76:79], v[220:223]
ds_read_b64_tr_b16 v[106:107], v14 offset:41984
v_mul_f32 v28, s79, v28
v_mfma_f32_16x16x32_bf16 v[216:219], v[52:55], v[72:75], v[216:219]
ds_read_b64_tr_b16 v[108:109], v15 offset:40960
v_mul_f32 v21, s79, v21
v_mfma_f32_16x16x32_bf16 v[212:215], v[52:55], v[68:71], v[212:215]
s_add_u32 s72, s70, 46080
buffer_load_dwordx4 v5, s[4:7], s72 offen offset:3072 lds
v_mfma_f32_16x16x32_bf16 v[208:211], v[52:55], v[64:67], v[208:211]
ds_read_b64_tr_b16 v[110:111], v15 offset:41984
v_mul_f32 v29, s79, v29
v_mfma_f32_16x16x32_bf16 v[224:227], v[56:59], v[64:67], v[224:227]
buffer_store_dwordx4 v[24:27], v1, s[44:47], s80 offen sc1
v_mfma_f32_16x16x32_bf16 v[228:231], v[56:59], v[68:71], v[228:231]
v_mul_f32 v22, s79, v22
v_mul_f32 v30, s79, v30
v_mfma_f32_16x16x32_bf16 v[232:235], v[56:59], v[72:75], v[232:235]
v_mul_f32 v23, s79, v23
v_mul_f32 v31, s79, v31
v_mfma_f32_16x16x32_bf16 v[236:239], v[56:59], v[76:79], v[236:239]
v_cvt_pk_bf16_f32 v20, v20, v28
v_cvt_pk_bf16_f32 v21, v21, v29
v_mfma_f32_16x16x32_bf16 v[252:255], v[60:63], v[76:79], v[252:255]
v_cvt_pk_bf16_f32 v22, v22, v30
v_cvt_pk_bf16_f32 v23, v23, v31
v_mfma_f32_16x16x32_bf16 v[248:251], v[60:63], v[72:75], v[248:251]
s_add_u32 s80, s77, 9216
buffer_store_dwordx4 v[20:23], v1, s[44:47], s80 offen sc1
v_mfma_f32_16x16x32_bf16 v[244:247], v[60:63], v[68:71], v[244:247]
s_waitcnt vmcnt(17) lgkmcnt(0)
v_accvgpr_read_b32 v24, a192
v_accvgpr_read_b32 v28, a193
v_mfma_f32_16x16x32_bf16 v[240:243], v[60:63], v[64:67], v[240:243]
s_barrier
v_accvgpr_read_b32 v25, a194
v_accvgpr_read_b32 v29, a195
v_mfma_f32_16x16x32_bf16 v[128:131], v[80:83], v[112:115], v[128:131]
s_add_u32 s73, s62, 8
ds_read_b64_tr_b16 v[32:33], v8 offset:0
ds_read_b64_tr_b16 v[34:35], v8 offset:1024
v_mfma_f32_16x16x32_bf16 v[132:135], v[80:83], v[116:119], v[132:135]
s_add_u32 s70, s73, s65
ds_read_b128 v[64:67], v16 offset:0
ds_read_b128 v[68:71], v16 offset:2048
v_mfma_f32_16x16x32_bf16 v[136:139], v[80:83], v[120:123], v[136:139]
s_and_b32 s70, s70, 3
ds_read_b128 v[72:75], v16 offset:4096
ds_read_b128 v[76:79], v16 offset:6144
v_mfma_f32_16x16x32_bf16 v[140:143], v[80:83], v[124:127], v[140:143]
s_and_b32 s73, s73, 12
ds_read_b64_tr_b16 v[36:37], v9 offset:0
ds_read_b64_tr_b16 v[38:39], v9 offset:1024
v_mfma_f32_16x16x32_bf16 v[156:159], v[84:87], v[124:127], v[156:159]
s_or_b32 s73, s73, s70
ds_read_b64_tr_b16 v[40:41], v10 offset:0
v_accvgpr_read_b32 v26, a196
v_mfma_f32_16x16x32_bf16 v[152:155], v[84:87], v[120:123], v[152:155]
s_lshl_b32 s71, s73, 19
ds_read_b64_tr_b16 v[42:43], v10 offset:1024
v_accvgpr_read_b32 v30, a197
v_mfma_f32_16x16x32_bf16 v[148:151], v[84:87], v[116:119], v[148:151]
s_add_u32 s71, s71, s66
ds_read_b64_tr_b16 v[44:45], v11 offset:0
v_accvgpr_read_b32 v27, a198
v_mfma_f32_16x16x32_bf16 v[144:147], v[84:87], v[112:115], v[144:147]
s_lshl_b32 s73, s73, 7
ds_read_b64_tr_b16 v[46:47], v11 offset:1024
v_accvgpr_read_b32 v31, a199
v_mfma_f32_16x16x32_bf16 v[160:163], v[88:91], v[112:115], v[160:163]
s_add_u32 s69, s73, s67
ds_read_b64_tr_b16 v[48:49], v12 offset:0
v_cvt_pk_bf16_f32 v24, v24, v28
v_mfma_f32_16x16x32_bf16 v[164:167], v[88:91], v[116:119], v[164:167]
s_add_u32 s70, s73, s68
ds_read_b64_tr_b16 v[50:51], v12 offset:1024
v_cvt_pk_bf16_f32 v25, v25, v29
v_mfma_f32_16x16x32_bf16 v[168:171], v[88:91], v[120:123], v[168:171]
s_add_u32 m0, s64, 32768
ds_read_b64_tr_b16 v[52:53], v13 offset:0
v_cvt_pk_bf16_f32 v26, v26, v30
v_mfma_f32_16x16x32_bf16 v[172:175], v[88:91], v[124:127], v[172:175]
s_add_u32 s72, s71, 0
buffer_load_dwordx4 v6, s[12:15], s72 offen lds
v_mfma_f32_16x16x32_bf16 v[188:191], v[92:95], v[124:127], v[188:191]
s_add_u32 s72, s71, 31744
buffer_load_dwordx4 v6, s[12:15], s72 offen offset:1024 lds
v_mfma_f32_16x16x32_bf16 v[184:187], v[92:95], v[120:123], v[184:187]
s_add_u32 s72, s71, 63488
buffer_load_dwordx4 v7, s[12:15], s72 offen offset:2048 lds
v_mfma_f32_16x16x32_bf16 v[180:183], v[92:95], v[116:119], v[180:183]
s_add_u32 s72, s71, 95232
buffer_load_dwordx4 v7, s[12:15], s72 offen offset:3072 lds
v_mfma_f32_16x16x32_bf16 v[176:179], v[92:95], v[112:115], v[176:179]
ds_read_b64_tr_b16 v[54:55], v13 offset:1024
v_cvt_pk_bf16_f32 v27, v27, v31
v_mfma_f32_16x16x32_bf16 v[192:195], v[96:99], v[112:115], v[192:195]
s_add_u32 s80, s78, 2048
ds_read_b64_tr_b16 v[56:57], v14 offset:0
v_accvgpr_read_b32 v20, a76
v_mfma_f32_16x16x32_bf16 v[196:199], v[96:99], v[116:119], v[196:199]
ds_read_b64_tr_b16 v[58:59], v14 offset:1024
v_accvgpr_read_b32 v28, a77
v_mfma_f32_16x16x32_bf16 v[200:203], v[96:99], v[120:123], v[200:203]
ds_read_b64_tr_b16 v[60:61], v15 offset:0
v_accvgpr_read_b32 v21, a78
v_mfma_f32_16x16x32_bf16 v[204:207], v[96:99], v[124:127], v[204:207]
s_add_u32 m0, s63, 98304
ds_read_b64_tr_b16 v[62:63], v15 offset:1024
v_accvgpr_read_b32 v29, a79
v_mfma_f32_16x16x32_bf16 v[220:223], v[100:103], v[124:127], v[220:223]
s_add_u32 s72, s69, 0
buffer_load_dwordx4 v4, s[4:7], s72 offen lds
v_mfma_f32_16x16x32_bf16 v[216:219], v[100:103], v[120:123], v[216:219]
buffer_store_dwordx4 v[24:27], v1, s[44:47], s80 offen sc1
v_mfma_f32_16x16x32_bf16 v[212:215], v[100:103], v[116:119], v[212:215]
v_accvgpr_read_b32 v22, a108
v_accvgpr_read_b32 v30, a109
v_mfma_f32_16x16x32_bf16 v[208:211], v[100:103], v[112:115], v[208:211]
v_accvgpr_read_b32 v23, a110
v_accvgpr_read_b32 v31, a111
v_mfma_f32_16x16x32_bf16 v[224:227], v[104:107], v[112:115], v[224:227]
s_add_u32 s72, s69, 15360
buffer_load_dwordx4 v5, s[4:7], s72 offen offset:1024 lds
v_mfma_f32_16x16x32_bf16 v[228:231], v[104:107], v[116:119], v[228:231]
v_mul_f32 v20, s79, v20
v_mul_f32 v28, s79, v28
v_mfma_f32_16x16x32_bf16 v[232:235], v[104:107], v[120:123], v[232:235]
v_mul_f32 v21, s79, v21
v_mul_f32 v29, s79, v29
v_mfma_f32_16x16x32_bf16 v[236:239], v[104:107], v[124:127], v[236:239]
v_mul_f32 v22, s79, v22
v_mul_f32 v30, s79, v30
v_mfma_f32_16x16x32_bf16 v[252:255], v[108:111], v[124:127], v[252:255]
v_mul_f32 v23, s79, v23
v_mul_f32 v31, s79, v31
v_mfma_f32_16x16x32_bf16 v[248:251], v[108:111], v[120:123], v[248:251]
s_add_u32 s72, s69, 30720
buffer_load_dwordx4 v4, s[4:7], s72 offen offset:2048 lds
v_mfma_f32_16x16x32_bf16 v[244:247], v[108:111], v[116:119], v[244:247]
v_cvt_pk_bf16_f32 v20, v20, v28
v_cvt_pk_bf16_f32 v21, v21, v29
v_mfma_f32_16x16x32_bf16 v[240:243], v[108:111], v[112:115], v[240:243]
s_waitcnt lgkmcnt(0)
v_cvt_pk_bf16_f32 v22, v22, v30
v_cvt_pk_bf16_f32 v23, v23, v31
v_mfma_f32_16x16x32_bf16 v[128:131], v[32:35], v[64:67], v[128:131]
s_add_u32 s80, s77, 13312
ds_read_b64_tr_b16 v[80:81], v8 offset:8192
ds_read_b64_tr_b16 v[82:83], v8 offset:9216
v_mfma_f32_16x16x32_bf16 v[132:135], v[32:35], v[68:71], v[132:135]
ds_read_b128 v[112:115], v17 offset:0
ds_read_b128 v[116:119], v17 offset:2048
v_mfma_f32_16x16x32_bf16 v[136:139], v[32:35], v[72:75], v[136:139]
s_add_u32 s72, s69, 46080
buffer_load_dwordx4 v5, s[4:7], s72 offen offset:3072 lds
v_mfma_f32_16x16x32_bf16 v[140:143], v[32:35], v[76:79], v[140:143]
ds_read_b128 v[120:123], v17 offset:4096
ds_read_b128 v[124:127], v17 offset:6144
v_mfma_f32_16x16x32_bf16 v[156:159], v[36:39], v[76:79], v[156:159]
ds_read_b64_tr_b16 v[84:85], v9 offset:8192
ds_read_b64_tr_b16 v[86:87], v9 offset:9216
v_mfma_f32_16x16x32_bf16 v[152:155], v[36:39], v[72:75], v[152:155]
ds_read_b64_tr_b16 v[88:89], v10 offset:8192
v_accvgpr_read_b32 v24, a200
v_mfma_f32_16x16x32_bf16 v[148:151], v[36:39], v[68:71], v[148:151]
ds_read_b64_tr_b16 v[90:91], v10 offset:9216
v_accvgpr_read_b32 v28, a201
v_mfma_f32_16x16x32_bf16 v[144:147], v[36:39], v[64:67], v[144:147]
s_add_u32 m0, s63, 102400
ds_read_b64_tr_b16 v[92:93], v11 offset:8192
v_accvgpr_read_b32 v25, a202
v_mfma_f32_16x16x32_bf16 v[160:163], v[40:43], v[64:67], v[160:163]
s_add_u32 s72, s70, 0
buffer_load_dwordx4 v4, s[4:7], s72 offen lds
v_mfma_f32_16x16x32_bf16 v[164:167], v[40:43], v[68:71], v[164:167]
ds_read_b64_tr_b16 v[94:95], v11 offset:9216
v_accvgpr_read_b32 v29, a203
v_mfma_f32_16x16x32_bf16 v[168:171], v[40:43], v[72:75], v[168:171]
ds_read_b64_tr_b16 v[96:97], v12 offset:8192
v_accvgpr_read_b32 v26, a204
v_mfma_f32_16x16x32_bf16 v[172:175], v[40:43], v[76:79], v[172:175]
ds_read_b64_tr_b16 v[98:99], v12 offset:9216
v_accvgpr_read_b32 v30, a205
v_mfma_f32_16x16x32_bf16 v[188:191], v[44:47], v[76:79], v[188:191]
s_add_u32 s72, s70, 15360
buffer_load_dwordx4 v5, s[4:7], s72 offen offset:1024 lds
v_mfma_f32_16x16x32_bf16 v[184:187], v[44:47], v[72:75], v[184:187]
ds_read_b64_tr_b16 v[100:101], v13 offset:8192
v_accvgpr_read_b32 v27, a206
v_mfma_f32_16x16x32_bf16 v[180:183], v[44:47], v[68:71], v[180:183]
ds_read_b64_tr_b16 v[102:103], v13 offset:9216
v_accvgpr_read_b32 v31, a207
v_mfma_f32_16x16x32_bf16 v[176:179], v[44:47], v[64:67], v[176:179]
ds_read_b64_tr_b16 v[104:105], v14 offset:8192
v_cvt_pk_bf16_f32 v24, v24, v28
v_mfma_f32_16x16x32_bf16 v[192:195], v[48:51], v[64:67], v[192:195]
ds_read_b64_tr_b16 v[106:107], v14 offset:9216
v_cvt_pk_bf16_f32 v25, v25, v29
v_mfma_f32_16x16x32_bf16 v[196:199], v[48:51], v[68:71], v[196:199]
s_add_u32 s72, s70, 30720
buffer_load_dwordx4 v4, s[4:7], s72 offen offset:2048 lds
v_mfma_f32_16x16x32_bf16 v[200:203], v[48:51], v[72:75], v[200:203]
ds_read_b64_tr_b16 v[108:109], v15 offset:8192
v_cvt_pk_bf16_f32 v26, v26, v30
v_mfma_f32_16x16x32_bf16 v[204:207], v[48:51], v[76:79], v[204:207]
ds_read_b64_tr_b16 v[110:111], v15 offset:9216
v_cvt_pk_bf16_f32 v27, v27, v31
v_mfma_f32_16x16x32_bf16 v[220:223], v[52:55], v[76:79], v[220:223]
buffer_store_dwordx4 v[20:23], v1, s[44:47], s80 offen sc1
v_mfma_f32_16x16x32_bf16 v[216:219], v[52:55], v[72:75], v[216:219]
s_add_u32 s80, s78, 10240
buffer_store_dwordx4 v[24:27], v1, s[44:47], s80 offen sc1
v_mfma_f32_16x16x32_bf16 v[212:215], v[52:55], v[68:71], v[212:215]
s_add_u32 s72, s70, 46080
buffer_load_dwordx4 v5, s[4:7], s72 offen offset:3072 lds
v_mfma_f32_16x16x32_bf16 v[208:211], v[52:55], v[64:67], v[208:211]
v_accvgpr_read_b32 v20, a80
v_accvgpr_read_b32 v28, a81
v_mfma_f32_16x16x32_bf16 v[224:227], v[56:59], v[64:67], v[224:227]
v_accvgpr_read_b32 v21, a82
v_accvgpr_read_b32 v29, a83
v_mfma_f32_16x16x32_bf16 v[228:231], v[56:59], v[68:71], v[228:231]
v_accvgpr_read_b32 v22, a112
v_accvgpr_read_b32 v30, a113
v_mfma_f32_16x16x32_bf16 v[232:235], v[56:59], v[72:75], v[232:235]
v_accvgpr_read_b32 v23, a114
v_accvgpr_read_b32 v31, a115
v_mfma_f32_16x16x32_bf16 v[236:239], v[56:59], v[76:79], v[236:239]
v_mul_f32 v20, s79, v20
v_mul_f32 v28, s79, v28
v_mfma_f32_16x16x32_bf16 v[252:255], v[60:63], v[76:79], v[252:255]
v_mul_f32 v21, s79, v21
v_mul_f32 v29, s79, v29
v_mfma_f32_16x16x32_bf16 v[248:251], v[60:63], v[72:75], v[248:251]
v_mul_f32 v22, s79, v22
v_mul_f32 v30, s79, v30
v_mfma_f32_16x16x32_bf16 v[244:247], v[60:63], v[68:71], v[244:247]
s_waitcnt vmcnt(17) lgkmcnt(0)
v_mul_f32 v23, s79, v23
v_mul_f32 v31, s79, v31
v_mfma_f32_16x16x32_bf16 v[240:243], v[60:63], v[64:67], v[240:243]
s_barrier
v_cvt_pk_bf16_f32 v20, v20, v28
v_cvt_pk_bf16_f32 v21, v21, v29
v_mfma_f32_16x16x32_bf16 v[128:131], v[80:83], v[112:115], v[128:131]
s_add_u32 s73, s62, 9
ds_read_b64_tr_b16 v[32:33], v8 offset:16384
ds_read_b64_tr_b16 v[34:35], v8 offset:17408
v_mfma_f32_16x16x32_bf16 v[132:135], v[80:83], v[116:119], v[132:135]
s_add_u32 s70, s73, s65
ds_read_b128 v[64:67], v18 offset:0
ds_read_b128 v[68:71], v18 offset:2048
v_mfma_f32_16x16x32_bf16 v[136:139], v[80:83], v[120:123], v[136:139]
s_and_b32 s70, s70, 3
ds_read_b128 v[72:75], v18 offset:4096
ds_read_b128 v[76:79], v18 offset:6144
v_mfma_f32_16x16x32_bf16 v[140:143], v[80:83], v[124:127], v[140:143]
s_and_b32 s73, s73, 12
ds_read_b64_tr_b16 v[36:37], v9 offset:16384
ds_read_b64_tr_b16 v[38:39], v9 offset:17408
v_mfma_f32_16x16x32_bf16 v[156:159], v[84:87], v[124:127], v[156:159]
s_or_b32 s73, s73, s70
ds_read_b64_tr_b16 v[40:41], v10 offset:16384
v_cvt_pk_bf16_f32 v22, v22, v30
v_mfma_f32_16x16x32_bf16 v[152:155], v[84:87], v[120:123], v[152:155]
s_lshl_b32 s71, s73, 19
ds_read_b64_tr_b16 v[42:43], v10 offset:17408
v_cvt_pk_bf16_f32 v23, v23, v31
v_mfma_f32_16x16x32_bf16 v[148:151], v[84:87], v[116:119], v[148:151]
s_add_u32 s71, s71, s66
ds_read_b64_tr_b16 v[44:45], v11 offset:16384
v_mfma_f32_16x16x32_bf16 v[144:147], v[84:87], v[112:115], v[144:147]
s_lshl_b32 s73, s73, 7
ds_read_b64_tr_b16 v[46:47], v11 offset:17408
v_mfma_f32_16x16x32_bf16 v[160:163], v[88:91], v[112:115], v[160:163]
s_add_u32 s69, s73, s67
ds_read_b64_tr_b16 v[48:49], v12 offset:16384
v_mfma_f32_16x16x32_bf16 v[164:167], v[88:91], v[116:119], v[164:167]
s_add_u32 s70, s73, s68
ds_read_b64_tr_b16 v[50:51], v12 offset:17408
v_mfma_f32_16x16x32_bf16 v[168:171], v[88:91], v[120:123], v[168:171]
s_add_u32 m0, s64, 0
ds_read_b64_tr_b16 v[52:53], v13 offset:16384
v_mfma_f32_16x16x32_bf16 v[172:175], v[88:91], v[124:127], v[172:175]
s_add_u32 s72, s71, 0
buffer_load_dwordx4 v6, s[12:15], s72 offen lds
v_mfma_f32_16x16x32_bf16 v[188:191], v[92:95], v[124:127], v[188:191]
s_add_u32 s72, s71, 31744
buffer_load_dwordx4 v6, s[12:15], s72 offen offset:1024 lds
v_mfma_f32_16x16x32_bf16 v[184:187], v[92:95], v[120:123], v[184:187]
s_add_u32 s72, s71, 63488
buffer_load_dwordx4 v7, s[12:15], s72 offen offset:2048 lds
v_mfma_f32_16x16x32_bf16 v[180:183], v[92:95], v[116:119], v[180:183]
s_add_u32 s72, s71, 95232
buffer_load_dwordx4 v7, s[12:15], s72 offen offset:3072 lds
v_mfma_f32_16x16x32_bf16 v[176:179], v[92:95], v[112:115], v[176:179]
s_add_u32 s80, s77, 33792
ds_read_b64_tr_b16 v[54:55], v13 offset:17408
v_accvgpr_read_b32 v24, a208
v_mfma_f32_16x16x32_bf16 v[192:195], v[96:99], v[112:115], v[192:195]
ds_read_b64_tr_b16 v[56:57], v14 offset:16384
v_accvgpr_read_b32 v28, a209
v_mfma_f32_16x16x32_bf16 v[196:199], v[96:99], v[116:119], v[196:199]
ds_read_b64_tr_b16 v[58:59], v14 offset:17408
v_accvgpr_read_b32 v25, a210
v_mfma_f32_16x16x32_bf16 v[200:203], v[96:99], v[120:123], v[200:203]
ds_read_b64_tr_b16 v[60:61], v15 offset:16384
v_accvgpr_read_b32 v29, a211
v_mfma_f32_16x16x32_bf16 v[204:207], v[96:99], v[124:127], v[204:207]
s_add_u32 m0, s63, 131072
ds_read_b64_tr_b16 v[62:63], v15 offset:17408
v_accvgpr_read_b32 v26, a212
v_mfma_f32_16x16x32_bf16 v[220:223], v[100:103], v[124:127], v[220:223]
s_add_u32 s72, s69, 0
buffer_load_dwordx4 v4, s[4:7], s72 offen lds
v_mfma_f32_16x16x32_bf16 v[216:219], v[100:103], v[120:123], v[216:219]
buffer_store_dwordx4 v[20:23], v1, s[44:47], s80 offen sc1
v_mfma_f32_16x16x32_bf16 v[212:215], v[100:103], v[116:119], v[212:215]
v_accvgpr_read_b32 v30, a213
v_accvgpr_read_b32 v27, a214
v_mfma_f32_16x16x32_bf16 v[208:211], v[100:103], v[112:115], v[208:211]
v_accvgpr_read_b32 v31, a215
v_cvt_pk_bf16_f32 v24, v24, v28
v_mfma_f32_16x16x32_bf16 v[224:227], v[104:107], v[112:115], v[224:227]
s_add_u32 s72, s69, 15360
buffer_load_dwordx4 v5, s[4:7], s72 offen offset:1024 lds
v_mfma_f32_16x16x32_bf16 v[228:231], v[104:107], v[116:119], v[228:231]
v_cvt_pk_bf16_f32 v25, v25, v29
v_cvt_pk_bf16_f32 v26, v26, v30
v_mfma_f32_16x16x32_bf16 v[232:235], v[104:107], v[120:123], v[232:235]
v_cvt_pk_bf16_f32 v27, v27, v31
v_mfma_f32_16x16x32_bf16 v[236:239], v[104:107], v[124:127], v[236:239]
s_add_u32 s80, s78, 34816
buffer_store_dwordx4 v[24:27], v1, s[44:47], s80 offen sc1
v_mfma_f32_16x16x32_bf16 v[252:255], v[108:111], v[124:127], v[252:255]
v_mfma_f32_16x16x32_bf16 v[248:251], v[108:111], v[120:123], v[248:251]
s_add_u32 s72, s69, 30720
buffer_load_dwordx4 v4, s[4:7], s72 offen offset:2048 lds
v_mfma_f32_16x16x32_bf16 v[244:247], v[108:111], v[116:119], v[244:247]
v_mfma_f32_16x16x32_bf16 v[240:243], v[108:111], v[112:115], v[240:243]
s_waitcnt lgkmcnt(0)
v_mfma_f32_16x16x32_bf16 v[128:131], v[32:35], v[64:67], v[128:131]
ds_read_b64_tr_b16 v[80:81], v8 offset:24576
ds_read_b64_tr_b16 v[82:83], v8 offset:25600
v_mfma_f32_16x16x32_bf16 v[132:135], v[32:35], v[68:71], v[132:135]
ds_read_b128 v[112:115], v19 offset:0
ds_read_b128 v[116:119], v19 offset:2048
v_mfma_f32_16x16x32_bf16 v[136:139], v[32:35], v[72:75], v[136:139]
s_add_u32 s72, s69, 46080
buffer_load_dwordx4 v5, s[4:7], s72 offen offset:3072 lds
v_mfma_f32_16x16x32_bf16 v[140:143], v[32:35], v[76:79], v[140:143]
ds_read_b128 v[120:123], v19 offset:4096
ds_read_b128 v[124:127], v19 offset:6144
v_mfma_f32_16x16x32_bf16 v[156:159], v[36:39], v[76:79], v[156:159]
ds_read_b64_tr_b16 v[84:85], v9 offset:24576
ds_read_b64_tr_b16 v[86:87], v9 offset:25600
v_mfma_f32_16x16x32_bf16 v[152:155], v[36:39], v[72:75], v[152:155]
ds_read_b64_tr_b16 v[88:89], v10 offset:24576
v_accvgpr_read_b32 v20, a84
v_mfma_f32_16x16x32_bf16 v[148:151], v[36:39], v[68:71], v[148:151]
ds_read_b64_tr_b16 v[90:91], v10 offset:25600
v_accvgpr_read_b32 v28, a85
v_mfma_f32_16x16x32_bf16 v[144:147], v[36:39], v[64:67], v[144:147]
s_add_u32 m0, s63, 135168
ds_read_b64_tr_b16 v[92:93], v11 offset:24576
v_accvgpr_read_b32 v21, a86
v_mfma_f32_16x16x32_bf16 v[160:163], v[40:43], v[64:67], v[160:163]
s_add_u32 s72, s70, 0
buffer_load_dwordx4 v4, s[4:7], s72 offen lds
v_mfma_f32_16x16x32_bf16 v[164:167], v[40:43], v[68:71], v[164:167]
ds_read_b64_tr_b16 v[94:95], v11 offset:25600
v_accvgpr_read_b32 v29, a87
v_mfma_f32_16x16x32_bf16 v[168:171], v[40:43], v[72:75], v[168:171]
ds_read_b64_tr_b16 v[96:97], v12 offset:24576
v_accvgpr_read_b32 v22, a116
v_mfma_f32_16x16x32_bf16 v[172:175], v[40:43], v[76:79], v[172:175]
ds_read_b64_tr_b16 v[98:99], v12 offset:25600
v_accvgpr_read_b32 v30, a117
v_mfma_f32_16x16x32_bf16 v[188:191], v[44:47], v[76:79], v[188:191]
s_add_u32 s72, s70, 15360
buffer_load_dwordx4 v5, s[4:7], s72 offen offset:1024 lds
v_mfma_f32_16x16x32_bf16 v[184:187], v[44:47], v[72:75], v[184:187]
ds_read_b64_tr_b16 v[100:101], v13 offset:24576
v_accvgpr_read_b32 v23, a118
v_mfma_f32_16x16x32_bf16 v[180:183], v[44:47], v[68:71], v[180:183]
ds_read_b64_tr_b16 v[102:103], v13 offset:25600
v_accvgpr_read_b32 v31, a119
v_mfma_f32_16x16x32_bf16 v[176:179], v[44:47], v[64:67], v[176:179]
ds_read_b64_tr_b16 v[104:105], v14 offset:24576
v_mul_f32 v20, s79, v20
v_mfma_f32_16x16x32_bf16 v[192:195], v[48:51], v[64:67], v[192:195]
ds_read_b64_tr_b16 v[106:107], v14 offset:25600
v_mul_f32 v28, s79, v28
v_mfma_f32_16x16x32_bf16 v[196:199], v[48:51], v[68:71], v[196:199]
s_add_u32 s72, s70, 30720
buffer_load_dwordx4 v4, s[4:7], s72 offen offset:2048 lds
v_mfma_f32_16x16x32_bf16 v[200:203], v[48:51], v[72:75], v[200:203]
ds_read_b64_tr_b16 v[108:109], v15 offset:24576
v_mul_f32 v21, s79, v21
v_mfma_f32_16x16x32_bf16 v[204:207], v[48:51], v[76:79], v[204:207]
ds_read_b64_tr_b16 v[110:111], v15 offset:25600
v_mul_f32 v29, s79, v29
v_mfma_f32_16x16x32_bf16 v[220:223], v[52:55], v[76:79], v[220:223]
v_mul_f32 v22, s79, v22
v_mul_f32 v30, s79, v30
v_mfma_f32_16x16x32_bf16 v[216:219], v[52:55], v[72:75], v[216:219]
v_mul_f32 v23, s79, v23
v_mul_f32 v31, s79, v31
v_mfma_f32_16x16x32_bf16 v[212:215], v[52:55], v[68:71], v[212:215]
s_add_u32 s72, s70, 46080
buffer_load_dwordx4 v5, s[4:7], s72 offen offset:3072 lds
v_mfma_f32_16x16x32_bf16 v[208:211], v[52:55], v[64:67], v[208:211]
v_cvt_pk_bf16_f32 v20, v20, v28
v_cvt_pk_bf16_f32 v21, v21, v29
v_mfma_f32_16x16x32_bf16 v[224:227], v[56:59], v[64:67], v[224:227]
v_cvt_pk_bf16_f32 v22, v22, v30
v_cvt_pk_bf16_f32 v23, v23, v31
v_mfma_f32_16x16x32_bf16 v[228:231], v[56:59], v[68:71], v[228:231]
s_add_u32 s80, s77, 37888
buffer_store_dwordx4 v[20:23], v1, s[44:47], s80 offen sc1
v_mfma_f32_16x16x32_bf16 v[232:235], v[56:59], v[72:75], v[232:235]
v_accvgpr_read_b32 v24, a216
v_accvgpr_read_b32 v28, a217
v_mfma_f32_16x16x32_bf16 v[236:239], v[56:59], v[76:79], v[236:239]
v_accvgpr_read_b32 v25, a218
v_accvgpr_read_b32 v29, a219
v_mfma_f32_16x16x32_bf16 v[252:255], v[60:63], v[76:79], v[252:255]
v_accvgpr_read_b32 v26, a220
v_accvgpr_read_b32 v30, a221
v_mfma_f32_16x16x32_bf16 v[248:251], v[60:63], v[72:75], v[248:251]
v_accvgpr_read_b32 v27, a222
v_accvgpr_read_b32 v31, a223
v_mfma_f32_16x16x32_bf16 v[244:247], v[60:63], v[68:71], v[244:247]
s_waitcnt vmcnt(15) lgkmcnt(0)
v_cvt_pk_bf16_f32 v24, v24, v28
v_cvt_pk_bf16_f32 v25, v25, v29
v_mfma_f32_16x16x32_bf16 v[240:243], v[60:63], v[64:67], v[240:243]
s_barrier
v_cvt_pk_bf16_f32 v26, v26, v30
v_cvt_pk_bf16_f32 v27, v27, v31
v_mfma_f32_16x16x32_bf16 v[128:131], v[80:83], v[112:115], v[128:131]
s_add_u32 s73, s62, 10
ds_read_b64_tr_b16 v[32:33], v8 offset:32768
ds_read_b64_tr_b16 v[34:35], v8 offset:33792
v_mfma_f32_16x16x32_bf16 v[132:135], v[80:83], v[116:119], v[132:135]
s_add_u32 s70, s73, s65
ds_read_b128 v[64:67], v18 offset:32768
ds_read_b128 v[68:71], v18 offset:34816
v_mfma_f32_16x16x32_bf16 v[136:139], v[80:83], v[120:123], v[136:139]
s_and_b32 s70, s70, 3
ds_read_b128 v[72:75], v18 offset:36864
ds_read_b128 v[76:79], v18 offset:38912
v_mfma_f32_16x16x32_bf16 v[140:143], v[80:83], v[124:127], v[140:143]
s_and_b32 s73, s73, 12
ds_read_b64_tr_b16 v[36:37], v9 offset:32768
ds_read_b64_tr_b16 v[38:39], v9 offset:33792
v_mfma_f32_16x16x32_bf16 v[156:159], v[84:87], v[124:127], v[156:159]
s_or_b32 s73, s73, s70
ds_read_b64_tr_b16 v[40:41], v10 offset:32768
v_mfma_f32_16x16x32_bf16 v[152:155], v[84:87], v[120:123], v[152:155]
s_lshl_b32 s71, s73, 19
ds_read_b64_tr_b16 v[42:43], v10 offset:33792
v_mfma_f32_16x16x32_bf16 v[148:151], v[84:87], v[116:119], v[148:151]
s_add_u32 s71, s71, s66
ds_read_b64_tr_b16 v[44:45], v11 offset:32768
v_mfma_f32_16x16x32_bf16 v[144:147], v[84:87], v[112:115], v[144:147]
s_lshl_b32 s73, s73, 7
ds_read_b64_tr_b16 v[46:47], v11 offset:33792
v_mfma_f32_16x16x32_bf16 v[160:163], v[88:91], v[112:115], v[160:163]
s_add_u32 s69, s73, s67
ds_read_b64_tr_b16 v[48:49], v12 offset:32768
v_accvgpr_read_b32 v20, a88
v_mfma_f32_16x16x32_bf16 v[164:167], v[88:91], v[116:119], v[164:167]
s_add_u32 s70, s73, s68
ds_read_b64_tr_b16 v[50:51], v12 offset:33792
v_accvgpr_read_b32 v28, a89
v_mfma_f32_16x16x32_bf16 v[168:171], v[88:91], v[120:123], v[168:171]
s_add_u32 m0, s64, 16384
ds_read_b64_tr_b16 v[52:53], v13 offset:32768
v_accvgpr_read_b32 v21, a90
v_mfma_f32_16x16x32_bf16 v[172:175], v[88:91], v[124:127], v[172:175]
s_add_u32 s72, s71, 0
buffer_load_dwordx4 v6, s[12:15], s72 offen lds
v_mfma_f32_16x16x32_bf16 v[188:191], v[92:95], v[124:127], v[188:191]
s_add_u32 s72, s71, 31744
buffer_load_dwordx4 v6, s[12:15], s72 offen offset:1024 lds
v_mfma_f32_16x16x32_bf16 v[184:187], v[92:95], v[120:123], v[184:187]
s_add_u32 s72, s71, 63488
buffer_load_dwordx4 v7, s[12:15], s72 offen offset:2048 lds
v_mfma_f32_16x16x32_bf16 v[180:183], v[92:95], v[116:119], v[180:183]
s_add_u32 s72, s71, 95232
buffer_load_dwordx4 v7, s[12:15], s72 offen offset:3072 lds
v_mfma_f32_16x16x32_bf16 v[176:179], v[92:95], v[112:115], v[176:179]
s_add_u32 s80, s78, 43008
ds_read_b64_tr_b16 v[54:55], v13 offset:33792
v_accvgpr_read_b32 v29, a91
v_mfma_f32_16x16x32_bf16 v[192:195], v[96:99], v[112:115], v[192:195]
ds_read_b64_tr_b16 v[56:57], v14 offset:32768
v_accvgpr_read_b32 v22, a120
v_mfma_f32_16x16x32_bf16 v[196:199], v[96:99], v[116:119], v[196:199]
ds_read_b64_tr_b16 v[58:59], v14 offset:33792
v_accvgpr_read_b32 v30, a121
v_mfma_f32_16x16x32_bf16 v[200:203], v[96:99], v[120:123], v[200:203]
ds_read_b64_tr_b16 v[60:61], v15 offset:32768
v_accvgpr_read_b32 v23, a122
v_mfma_f32_16x16x32_bf16 v[204:207], v[96:99], v[124:127], v[204:207]
s_add_u32 m0, s63, 65536
ds_read_b64_tr_b16 v[62:63], v15 offset:33792
v_accvgpr_read_b32 v31, a123
v_mfma_f32_16x16x32_bf16 v[220:223], v[100:103], v[124:127], v[220:223]
s_add_u32 s72, s69, 0
buffer_load_dwordx4 v4, s[4:7], s72 offen lds
v_mfma_f32_16x16x32_bf16 v[216:219], v[100:103], v[120:123], v[216:219]
buffer_store_dwordx4 v[24:27], v1, s[44:47], s80 offen sc1
v_mfma_f32_16x16x32_bf16 v[212:215], v[100:103], v[116:119], v[212:215]
v_mul_f32 v20, s79, v20
v_mul_f32 v28, s79, v28
v_mfma_f32_16x16x32_bf16 v[208:211], v[100:103], v[112:115], v[208:211]
v_mul_f32 v21, s79, v21
v_mul_f32 v29, s79, v29
v_mfma_f32_16x16x32_bf16 v[224:227], v[104:107], v[112:115], v[224:227]
s_add_u32 s72, s69, 15360
buffer_load_dwordx4 v5, s[4:7], s72 offen offset:1024 lds
v_mfma_f32_16x16x32_bf16 v[228:231], v[104:107], v[116:119], v[228:231]
v_mul_f32 v22, s79, v22
v_mul_f32 v30, s79, v30
v_mfma_f32_16x16x32_bf16 v[232:235], v[104:107], v[120:123], v[232:235]
v_mul_f32 v23, s79, v23
v_mul_f32 v31, s79, v31
v_mfma_f32_16x16x32_bf16 v[236:239], v[104:107], v[124:127], v[236:239]
v_cvt_pk_bf16_f32 v20, v20, v28
v_cvt_pk_bf16_f32 v21, v21, v29
v_mfma_f32_16x16x32_bf16 v[252:255], v[108:111], v[124:127], v[252:255]
v_cvt_pk_bf16_f32 v22, v22, v30
v_cvt_pk_bf16_f32 v23, v23, v31
v_mfma_f32_16x16x32_bf16 v[248:251], v[108:111], v[120:123], v[248:251]
s_add_u32 s72, s69, 30720
buffer_load_dwordx4 v4, s[4:7], s72 offen offset:2048 lds
v_mfma_f32_16x16x32_bf16 v[244:247], v[108:111], v[116:119], v[244:247]
s_add_u32 s80, s77, 41984
buffer_store_dwordx4 v[20:23], v1, s[44:47], s80 offen sc1
v_mfma_f32_16x16x32_bf16 v[240:243], v[108:111], v[112:115], v[240:243]
s_waitcnt lgkmcnt(0)
v_accvgpr_read_b32 v24, a224
v_accvgpr_read_b32 v28, a225
LcB1:
v_mfma_f32_16x16x32_bf16 v[128:131], v[32:35], v[64:67], v[128:131]
ds_read_b64_tr_b16 v[80:81], v8 offset:40960
ds_read_b64_tr_b16 v[82:83], v8 offset:41984
v_mfma_f32_16x16x32_bf16 v[132:135], v[32:35], v[68:71], v[132:135]
ds_read_b128 v[112:115], v19 offset:32768
ds_read_b128 v[116:119], v19 offset:34816
v_mfma_f32_16x16x32_bf16 v[136:139], v[32:35], v[72:75], v[136:139]
s_add_u32 s72, s69, 46080
buffer_load_dwordx4 v5, s[4:7], s72 offen offset:3072 lds
v_mfma_f32_16x16x32_bf16 v[140:143], v[32:35], v[76:79], v[140:143]
ds_read_b128 v[120:123], v19 offset:36864
ds_read_b128 v[124:127], v19 offset:38912
v_mfma_f32_16x16x32_bf16 v[156:159], v[36:39], v[76:79], v[156:159]
ds_read_b64_tr_b16 v[84:85], v9 offset:40960
ds_read_b64_tr_b16 v[86:87], v9 offset:41984
v_mfma_f32_16x16x32_bf16 v[152:155], v[36:39], v[72:75], v[152:155]
ds_read_b64_tr_b16 v[88:89], v10 offset:40960
v_accvgpr_read_b32 v25, a226
v_mfma_f32_16x16x32_bf16 v[148:151], v[36:39], v[68:71], v[148:151]
ds_read_b64_tr_b16 v[90:91], v10 offset:41984
v_accvgpr_read_b32 v29, a227
v_mfma_f32_16x16x32_bf16 v[144:147], v[36:39], v[64:67], v[144:147]
s_add_u32 m0, s63, 69632
ds_read_b64_tr_b16 v[92:93], v11 offset:40960
v_accvgpr_read_b32 v26, a228
v_mfma_f32_16x16x32_bf16 v[160:163], v[40:43], v[64:67], v[160:163]
s_add_u32 s72, s70, 0
buffer_load_dwordx4 v4, s[4:7], s72 offen lds
v_mfma_f32_16x16x32_bf16 v[164:167], v[40:43], v[68:71], v[164:167]
ds_read_b64_tr_b16 v[94:95], v11 offset:41984
v_accvgpr_read_b32 v30, a229
v_mfma_f32_16x16x32_bf16 v[168:171], v[40:43], v[72:75], v[168:171]
ds_read_b64_tr_b16 v[96:97], v12 offset:40960
v_accvgpr_read_b32 v27, a230
v_mfma_f32_16x16x32_bf16 v[172:175], v[40:43], v[76:79], v[172:175]
ds_read_b64_tr_b16 v[98:99], v12 offset:41984
v_accvgpr_read_b32 v31, a231
v_mfma_f32_16x16x32_bf16 v[188:191], v[44:47], v[76:79], v[188:191]
s_add_u32 s72, s70, 15360
buffer_load_dwordx4 v5, s[4:7], s72 offen offset:1024 lds
v_mfma_f32_16x16x32_bf16 v[184:187], v[44:47], v[72:75], v[184:187]
ds_read_b64_tr_b16 v[100:101], v13 offset:40960
v_cvt_pk_bf16_f32 v24, v24, v28
v_mfma_f32_16x16x32_bf16 v[180:183], v[44:47], v[68:71], v[180:183]
ds_read_b64_tr_b16 v[102:103], v13 offset:41984
v_cvt_pk_bf16_f32 v25, v25, v29
v_mfma_f32_16x16x32_bf16 v[176:179], v[44:47], v[64:67], v[176:179]
ds_read_b64_tr_b16 v[104:105], v14 offset:40960
v_cvt_pk_bf16_f32 v26, v26, v30
v_mfma_f32_16x16x32_bf16 v[192:195], v[48:51], v[64:67], v[192:195]
ds_read_b64_tr_b16 v[106:107], v14 offset:41984
v_cvt_pk_bf16_f32 v27, v27, v31
v_mfma_f32_16x16x32_bf16 v[196:199], v[48:51], v[68:71], v[196:199]
s_add_u32 s72, s70, 30720
buffer_load_dwordx4 v4, s[4:7], s72 offen offset:2048 lds
v_mfma_f32_16x16x32_bf16 v[200:203], v[48:51], v[72:75], v[200:203]
s_add_u32 s80, s78, 3072
ds_read_b64_tr_b16 v[108:109], v15 offset:40960
v_accvgpr_read_b32 v20, a92
v_mfma_f32_16x16x32_bf16 v[204:207], v[48:51], v[76:79], v[204:207]
ds_read_b64_tr_b16 v[110:111], v15 offset:41984
v_accvgpr_read_b32 v28, a93
v_mfma_f32_16x16x32_bf16 v[220:223], v[52:55], v[76:79], v[220:223]
buffer_store_dwordx4 v[24:27], v1, s[44:47], s80 offen sc1
v_mfma_f32_16x16x32_bf16 v[216:219], v[52:55], v[72:75], v[216:219]
v_accvgpr_read_b32 v21, a94
v_accvgpr_read_b32 v29, a95
v_mfma_f32_16x16x32_bf16 v[212:215], v[52:55], v[68:71], v[212:215]
s_add_u32 s72, s70, 46080
buffer_load_dwordx4 v5, s[4:7], s72 offen offset:3072 lds
v_mfma_f32_16x16x32_bf16 v[208:211], v[52:55], v[64:67], v[208:211]
v_accvgpr_read_b32 v22, a124
v_accvgpr_read_b32 v30, a125
v_mfma_f32_16x16x32_bf16 v[224:227], v[56:59], v[64:67], v[224:227]
v_accvgpr_read_b32 v23, a126
v_accvgpr_read_b32 v31, a127
v_mfma_f32_16x16x32_bf16 v[228:231], v[56:59], v[68:71], v[228:231]
v_mul_f32 v20, s79, v20
v_mul_f32 v28, s79, v28
v_mfma_f32_16x16x32_bf16 v[232:235], v[56:59], v[72:75], v[232:235]
v_mul_f32 v21, s79, v21
v_mul_f32 v29, s79, v29
v_mfma_f32_16x16x32_bf16 v[236:239], v[56:59], v[76:79], v[236:239]
v_mul_f32 v22, s79, v22
v_mul_f32 v30, s79, v30
v_mfma_f32_16x16x32_bf16 v[252:255], v[60:63], v[76:79], v[252:255]
v_mul_f32 v23, s79, v23
v_mul_f32 v31, s79, v31
v_mfma_f32_16x16x32_bf16 v[248:251], v[60:63], v[72:75], v[248:251]
v_cvt_pk_bf16_f32 v20, v20, v28
v_cvt_pk_bf16_f32 v21, v21, v29
v_mfma_f32_16x16x32_bf16 v[244:247], v[60:63], v[68:71], v[244:247]
s_waitcnt vmcnt(16) lgkmcnt(0)
v_cvt_pk_bf16_f32 v22, v22, v30
v_cvt_pk_bf16_f32 v23, v23, v31
v_mfma_f32_16x16x32_bf16 v[240:243], v[60:63], v[64:67], v[240:243]
s_barrier
v_mfma_f32_16x16x32_bf16 v[128:131], v[80:83], v[112:115], v[128:131]
s_add_u32 s73, s62, 11
ds_read_b64_tr_b16 v[32:33], v8 offset:0
ds_read_b64_tr_b16 v[34:35], v8 offset:1024
v_mfma_f32_16x16x32_bf16 v[132:135], v[80:83], v[116:119], v[132:135]
s_add_u32 s70, s73, s65
ds_read_b128 v[64:67], v16 offset:0
ds_read_b128 v[68:71], v16 offset:2048
v_mfma_f32_16x16x32_bf16 v[136:139], v[80:83], v[120:123], v[136:139]
s_and_b32 s70, s70, 3
ds_read_b128 v[72:75], v16 offset:4096
ds_read_b128 v[76:79], v16 offset:6144
v_mfma_f32_16x16x32_bf16 v[140:143], v[80:83], v[124:127], v[140:143]
s_and_b32 s73, s73, 12
ds_read_b64_tr_b16 v[36:37], v9 offset:0
ds_read_b64_tr_b16 v[38:39], v9 offset:1024
v_mfma_f32_16x16x32_bf16 v[156:159], v[84:87], v[124:127], v[156:159]
s_or_b32 s73, s73, s70
ds_read_b64_tr_b16 v[40:41], v10 offset:0
v_mfma_f32_16x16x32_bf16 v[152:155], v[84:87], v[120:123], v[152:155]
s_lshl_b32 s71, s73, 19
ds_read_b64_tr_b16 v[42:43], v10 offset:1024
v_accvgpr_read_b32 v24, a232
v_mfma_f32_16x16x32_bf16 v[148:151], v[84:87], v[116:119], v[148:151]
s_add_u32 s71, s71, s66
ds_read_b64_tr_b16 v[44:45], v11 offset:0
v_accvgpr_read_b32 v28, a233
v_mfma_f32_16x16x32_bf16 v[144:147], v[84:87], v[112:115], v[144:147]
s_lshl_b32 s73, s73, 7
ds_read_b64_tr_b16 v[46:47], v11 offset:1024
v_accvgpr_read_b32 v25, a234
v_mfma_f32_16x16x32_bf16 v[160:163], v[88:91], v[112:115], v[160:163]
s_add_u32 s69, s73, s67
ds_read_b64_tr_b16 v[48:49], v12 offset:0
v_accvgpr_read_b32 v29, a235
v_mfma_f32_16x16x32_bf16 v[164:167], v[88:91], v[116:119], v[164:167]
s_add_u32 s70, s73, s68
ds_read_b64_tr_b16 v[50:51], v12 offset:1024
v_accvgpr_read_b32 v26, a236
v_mfma_f32_16x16x32_bf16 v[168:171], v[88:91], v[120:123], v[168:171]
s_add_u32 m0, s64, 32768
ds_read_b64_tr_b16 v[52:53], v13 offset:0
v_accvgpr_read_b32 v30, a237
v_mfma_f32_16x16x32_bf16 v[172:175], v[88:91], v[124:127], v[172:175]
s_add_u32 s72, s71, 0
buffer_load_dwordx4 v6, s[12:15], s72 offen lds
v_mfma_f32_16x16x32_bf16 v[188:191], v[92:95], v[124:127], v[188:191]
s_add_u32 s72, s71, 31744
buffer_load_dwordx4 v6, s[12:15], s72 offen offset:1024 lds
v_mfma_f32_16x16x32_bf16 v[184:187], v[92:95], v[120:123], v[184:187]
s_add_u32 s72, s71, 63488
buffer_load_dwordx4 v7, s[12:15], s72 offen offset:2048 lds
v_mfma_f32_16x16x32_bf16 v[180:183], v[92:95], v[116:119], v[180:183]
s_add_u32 s72, s71, 95232
buffer_load_dwordx4 v7, s[12:15], s72 offen offset:3072 lds
v_mfma_f32_16x16x32_bf16 v[176:179], v[92:95], v[112:115], v[176:179]
s_add_u32 s80, s77, 46080
ds_read_b64_tr_b16 v[54:55], v13 offset:1024
v_accvgpr_read_b32 v27, a238
v_mfma_f32_16x16x32_bf16 v[192:195], v[96:99], v[112:115], v[192:195]
ds_read_b64_tr_b16 v[56:57], v14 offset:0
v_accvgpr_read_b32 v31, a239
v_mfma_f32_16x16x32_bf16 v[196:199], v[96:99], v[116:119], v[196:199]
ds_read_b64_tr_b16 v[58:59], v14 offset:1024
v_cvt_pk_bf16_f32 v24, v24, v28
v_mfma_f32_16x16x32_bf16 v[200:203], v[96:99], v[120:123], v[200:203]
ds_read_b64_tr_b16 v[60:61], v15 offset:0
v_cvt_pk_bf16_f32 v25, v25, v29
v_mfma_f32_16x16x32_bf16 v[204:207], v[96:99], v[124:127], v[204:207]
s_add_u32 m0, s63, 98304
ds_read_b64_tr_b16 v[62:63], v15 offset:1024
v_cvt_pk_bf16_f32 v26, v26, v30
v_mfma_f32_16x16x32_bf16 v[220:223], v[100:103], v[124:127], v[220:223]
s_add_u32 s72, s69, 0
buffer_load_dwordx4 v4, s[4:7], s72 offen lds
v_mfma_f32_16x16x32_bf16 v[216:219], v[100:103], v[120:123], v[216:219]
buffer_store_dwordx4 v[20:23], v1, s[44:47], s80 offen sc1
v_mfma_f32_16x16x32_bf16 v[212:215], v[100:103], v[116:119], v[212:215]
v_cvt_pk_bf16_f32 v27, v27, v31
v_mfma_f32_16x16x32_bf16 v[208:211], v[100:103], v[112:115], v[208:211]
s_add_u32 s80, s78, 11264
buffer_store_dwordx4 v[24:27], v1, s[44:47], s80 offen sc1
v_mfma_f32_16x16x32_bf16 v[224:227], v[104:107], v[112:115], v[224:227]
s_add_u32 s72, s69, 15360
buffer_load_dwordx4 v5, s[4:7], s72 offen offset:1024 lds
v_mfma_f32_16x16x32_bf16 v[228:231], v[104:107], v[116:119], v[228:231]
v_accvgpr_read_b32 v20, a240
v_accvgpr_read_b32 v28, a241
v_mfma_f32_16x16x32_bf16 v[232:235], v[104:107], v[120:123], v[232:235]
v_accvgpr_read_b32 v21, a242
v_accvgpr_read_b32 v29, a243
v_mfma_f32_16x16x32_bf16 v[236:239], v[104:107], v[124:127], v[236:239]
v_accvgpr_read_b32 v22, a244
v_accvgpr_read_b32 v30, a245
v_mfma_f32_16x16x32_bf16 v[252:255], v[108:111], v[124:127], v[252:255]
v_accvgpr_read_b32 v23, a246
v_accvgpr_read_b32 v31, a247
v_mfma_f32_16x16x32_bf16 v[248:251], v[108:111], v[120:123], v[248:251]
s_add_u32 s72, s69, 30720
buffer_load_dwordx4 v4, s[4:7], s72 offen offset:2048 lds
v_mfma_f32_16x16x32_bf16 v[244:247], v[108:111], v[116:119], v[244:247]
v_cvt_pk_bf16_f32 v20, v20, v28
v_cvt_pk_bf16_f32 v21, v21, v29
v_mfma_f32_16x16x32_bf16 v[240:243], v[108:111], v[112:115], v[240:243]
s_waitcnt lgkmcnt(0)
v_cvt_pk_bf16_f32 v22, v22, v30
v_cvt_pk_bf16_f32 v23, v23, v31
v_mfma_f32_16x16x32_bf16 v[128:131], v[32:35], v[64:67], v[128:131]
s_add_u32 s80, s78, 35840
ds_read_b64_tr_b16 v[80:81], v8 offset:8192
ds_read_b64_tr_b16 v[82:83], v8 offset:9216
v_mfma_f32_16x16x32_bf16 v[132:135], v[32:35], v[68:71], v[132:135]
ds_read_b128 v[112:115], v17 offset:0
ds_read_b128 v[116:119], v17 offset:2048
v_mfma_f32_16x16x32_bf16 v[136:139], v[32:35], v[72:75], v[136:139]
s_add_u32 s72, s69, 46080
buffer_load_dwordx4 v5, s[4:7], s72 offen offset:3072 lds
v_mfma_f32_16x16x32_bf16 v[140:143], v[32:35], v[76:79], v[140:143]
ds_read_b128 v[120:123], v17 offset:4096
ds_read_b128 v[124:127], v17 offset:6144
v_mfma_f32_16x16x32_bf16 v[156:159], v[36:39], v[76:79], v[156:159]
ds_read_b64_tr_b16 v[84:85], v9 offset:8192
ds_read_b64_tr_b16 v[86:87], v9 offset:9216
v_mfma_f32_16x16x32_bf16 v[152:155], v[36:39], v[72:75], v[152:155]
ds_read_b64_tr_b16 v[88:89], v10 offset:8192
v_mfma_f32_16x16x32_bf16 v[148:151], v[36:39], v[68:71], v[148:151]
ds_read_b64_tr_b16 v[90:91], v10 offset:9216
v_mfma_f32_16x16x32_bf16 v[144:147], v[36:39], v[64:67], v[144:147]
s_add_u32 m0, s63, 102400
ds_read_b64_tr_b16 v[92:93], v11 offset:8192
v_mfma_f32_16x16x32_bf16 v[160:163], v[40:43], v[64:67], v[160:163]
s_add_u32 s72, s70, 0
buffer_load_dwordx4 v4, s[4:7], s72 offen lds
v_mfma_f32_16x16x32_bf16 v[164:167], v[40:43], v[68:71], v[164:167]
ds_read_b64_tr_b16 v[94:95], v11 offset:9216
v_mfma_f32_16x16x32_bf16 v[168:171], v[40:43], v[72:75], v[168:171]
ds_read_b64_tr_b16 v[96:97], v12 offset:8192
v_mfma_f32_16x16x32_bf16 v[172:175], v[40:43], v[76:79], v[172:175]
ds_read_b64_tr_b16 v[98:99], v12 offset:9216
v_mfma_f32_16x16x32_bf16 v[188:191], v[44:47], v[76:79], v[188:191]
s_add_u32 s72, s70, 15360
buffer_load_dwordx4 v5, s[4:7], s72 offen offset:1024 lds
v_mfma_f32_16x16x32_bf16 v[184:187], v[44:47], v[72:75], v[184:187]
ds_read_b64_tr_b16 v[100:101], v13 offset:8192
v_accvgpr_read_b32 v24, a248
v_mfma_f32_16x16x32_bf16 v[180:183], v[44:47], v[68:71], v[180:183]
ds_read_b64_tr_b16 v[102:103], v13 offset:9216
v_accvgpr_read_b32 v28, a249
v_mfma_f32_16x16x32_bf16 v[176:179], v[44:47], v[64:67], v[176:179]
ds_read_b64_tr_b16 v[104:105], v14 offset:8192
v_accvgpr_read_b32 v25, a250
v_mfma_f32_16x16x32_bf16 v[192:195], v[48:51], v[64:67], v[192:195]
ds_read_b64_tr_b16 v[106:107], v14 offset:9216
v_accvgpr_read_b32 v29, a251
v_mfma_f32_16x16x32_bf16 v[196:199], v[48:51], v[68:71], v[196:199]
s_add_u32 s72, s70, 30720
buffer_load_dwordx4 v4, s[4:7], s72 offen offset:2048 lds
v_mfma_f32_16x16x32_bf16 v[200:203], v[48:51], v[72:75], v[200:203]
ds_read_b64_tr_b16 v[108:109], v15 offset:8192
v_accvgpr_read_b32 v26, a252
v_mfma_f32_16x16x32_bf16 v[204:207], v[48:51], v[76:79], v[204:207]
ds_read_b64_tr_b16 v[110:111], v15 offset:9216
v_accvgpr_read_b32 v30, a253
v_mfma_f32_16x16x32_bf16 v[220:223], v[52:55], v[76:79], v[220:223]
buffer_store_dwordx4 v[20:23], v1, s[44:47], s80 offen sc1
v_mfma_f32_16x16x32_bf16 v[216:219], v[52:55], v[72:75], v[216:219]
v_accvgpr_read_b32 v27, a254
v_accvgpr_read_b32 v31, a255
v_mfma_f32_16x16x32_bf16 v[212:215], v[52:55], v[68:71], v[212:215]
s_add_u32 s72, s70, 46080
buffer_load_dwordx4 v5, s[4:7], s72 offen offset:3072 lds
v_mfma_f32_16x16x32_bf16 v[208:211], v[52:55], v[64:67], v[208:211]
v_cvt_pk_bf16_f32 v24, v24, v28
v_cvt_pk_bf16_f32 v25, v25, v29
v_mfma_f32_16x16x32_bf16 v[224:227], v[56:59], v[64:67], v[224:227]
v_cvt_pk_bf16_f32 v26, v26, v30
v_cvt_pk_bf16_f32 v27, v27, v31
v_mfma_f32_16x16x32_bf16 v[228:231], v[56:59], v[68:71], v[228:231]
s_add_u32 s80, s78, 44032
buffer_store_dwordx4 v[24:27], v1, s[44:47], s80 offen sc1
v_mfma_f32_16x16x32_bf16 v[232:235], v[56:59], v[72:75], v[232:235]
v_mfma_f32_16x16x32_bf16 v[236:239], v[56:59], v[76:79], v[236:239]
v_mfma_f32_16x16x32_bf16 v[252:255], v[60:63], v[76:79], v[252:255]
v_mfma_f32_16x16x32_bf16 v[248:251], v[60:63], v[72:75], v[248:251]
v_mfma_f32_16x16x32_bf16 v[244:247], v[60:63], v[68:71], v[244:247]
s_waitcnt vmcnt(16) lgkmcnt(0)
v_mfma_f32_16x16x32_bf16 v[240:243], v[60:63], v[64:67], v[240:243]
s_barrier
v_mfma_f32_16x16x32_bf16 v[128:131], v[80:83], v[112:115], v[128:131]
s_add_u32 s73, s62, 12
ds_read_b64_tr_b16 v[32:33], v8 offset:16384
ds_read_b64_tr_b16 v[34:35], v8 offset:17408
v_mfma_f32_16x16x32_bf16 v[132:135], v[80:83], v[116:119], v[132:135]
s_add_u32 s70, s73, s65
ds_read_b128 v[64:67], v18 offset:0
ds_read_b128 v[68:71], v18 offset:2048
v_mfma_f32_16x16x32_bf16 v[136:139], v[80:83], v[120:123], v[136:139]
s_and_b32 s70, s70, 3
v_and_b32 v2, 31, v0
v_lshlrev_b32 v2, 2, v2
v_mfma_f32_16x16x32_bf16 v[140:143], v[80:83], v[124:127], v[140:143]
s_and_b32 s73, s73, 12
buffer_load_dword v3, v2, s[48:51], 0 offen sc1
v_mfma_f32_16x16x32_bf16 v[156:159], v[84:87], v[124:127], v[156:159]
s_or_b32 s73, s73, s70
ds_read_b128 v[72:75], v18 offset:4096
ds_read_b128 v[76:79], v18 offset:6144
v_mfma_f32_16x16x32_bf16 v[152:155], v[84:87], v[120:123], v[152:155]
s_lshl_b32 s71, s73, 19
ds_read_b64_tr_b16 v[36:37], v9 offset:16384
ds_read_b64_tr_b16 v[38:39], v9 offset:17408
v_mfma_f32_16x16x32_bf16 v[148:151], v[84:87], v[116:119], v[148:151]
s_add_u32 s71, s71, s66
ds_read_b64_tr_b16 v[40:41], v10 offset:16384
v_mfma_f32_16x16x32_bf16 v[144:147], v[84:87], v[112:115], v[144:147]
s_lshl_b32 s73, s73, 7
ds_read_b64_tr_b16 v[42:43], v10 offset:17408
v_mfma_f32_16x16x32_bf16 v[160:163], v[88:91], v[112:115], v[160:163]
s_add_u32 s69, s73, s67
ds_read_b64_tr_b16 v[44:45], v11 offset:16384
v_mfma_f32_16x16x32_bf16 v[164:167], v[88:91], v[116:119], v[164:167]
s_add_u32 s70, s73, s68
ds_read_b64_tr_b16 v[46:47], v11 offset:17408
v_mfma_f32_16x16x32_bf16 v[168:171], v[88:91], v[120:123], v[168:171]
s_add_u32 m0, s64, 0
ds_read_b64_tr_b16 v[48:49], v12 offset:16384
v_mfma_f32_16x16x32_bf16 v[172:175], v[88:91], v[124:127], v[172:175]
s_add_u32 s72, s71, 0
buffer_load_dwordx4 v6, s[12:15], s72 offen lds
v_mfma_f32_16x16x32_bf16 v[188:191], v[92:95], v[124:127], v[188:191]
s_add_u32 s72, s71, 31744
buffer_load_dwordx4 v6, s[12:15], s72 offen offset:1024 lds
v_mfma_f32_16x16x32_bf16 v[184:187], v[92:95], v[120:123], v[184:187]
s_add_u32 s72, s71, 63488
buffer_load_dwordx4 v7, s[12:15], s72 offen offset:2048 lds
v_mfma_f32_16x16x32_bf16 v[180:183], v[92:95], v[116:119], v[180:183]
s_add_u32 s72, s71, 95232
buffer_load_dwordx4 v7, s[12:15], s72 offen offset:3072 lds
v_mfma_f32_16x16x32_bf16 v[176:179], v[92:95], v[112:115], v[176:179]
ds_read_b64_tr_b16 v[50:51], v12 offset:17408
v_mfma_f32_16x16x32_bf16 v[192:195], v[96:99], v[112:115], v[192:195]
ds_read_b64_tr_b16 v[52:53], v13 offset:16384
v_mfma_f32_16x16x32_bf16 v[196:199], v[96:99], v[116:119], v[196:199]
ds_read_b64_tr_b16 v[54:55], v13 offset:17408
v_mfma_f32_16x16x32_bf16 v[200:203], v[96:99], v[120:123], v[200:203]
ds_read_b64_tr_b16 v[56:57], v14 offset:16384
v_mfma_f32_16x16x32_bf16 v[204:207], v[96:99], v[124:127], v[204:207]
s_add_u32 m0, s63, 131072
ds_read_b64_tr_b16 v[58:59], v14 offset:17408
v_mfma_f32_16x16x32_bf16 v[220:223], v[100:103], v[124:127], v[220:223]
s_add_u32 s72, s69, 0
buffer_load_dwordx4 v4, s[4:7], s72 offen lds
v_mfma_f32_16x16x32_bf16 v[216:219], v[100:103], v[120:123], v[216:219]
ds_read_b64_tr_b16 v[60:61], v15 offset:16384
v_mfma_f32_16x16x32_bf16 v[212:215], v[100:103], v[116:119], v[212:215]
ds_read_b64_tr_b16 v[62:63], v15 offset:17408
v_mfma_f32_16x16x32_bf16 v[208:211], v[100:103], v[112:115], v[208:211]
v_mfma_f32_16x16x32_bf16 v[224:227], v[104:107], v[112:115], v[224:227]
s_add_u32 s72, s69, 15360
buffer_load_dwordx4 v5, s[4:7], s72 offen offset:1024 lds
v_mfma_f32_16x16x32_bf16 v[228:231], v[104:107], v[116:119], v[228:231]
v_mfma_f32_16x16x32_bf16 v[232:235], v[104:107], v[120:123], v[232:235]
v_mfma_f32_16x16x32_bf16 v[236:239], v[104:107], v[124:127], v[236:239]
v_mfma_f32_16x16x32_bf16 v[252:255], v[108:111], v[124:127], v[252:255]
v_mfma_f32_16x16x32_bf16 v[248:251], v[108:111], v[120:123], v[248:251]
s_add_u32 s72, s69, 30720
buffer_load_dwordx4 v4, s[4:7], s72 offen offset:2048 lds
v_mfma_f32_16x16x32_bf16 v[244:247], v[108:111], v[116:119], v[244:247]
v_mfma_f32_16x16x32_bf16 v[240:243], v[108:111], v[112:115], v[240:243]
s_waitcnt lgkmcnt(0)
v_mfma_f32_16x16x32_bf16 v[128:131], v[32:35], v[64:67], v[128:131]
ds_read_b64_tr_b16 v[80:81], v8 offset:24576
ds_read_b64_tr_b16 v[82:83], v8 offset:25600
v_mfma_f32_16x16x32_bf16 v[132:135], v[32:35], v[68:71], v[132:135]
ds_read_b128 v[112:115], v19 offset:0
ds_read_b128 v[116:119], v19 offset:2048
v_mfma_f32_16x16x32_bf16 v[136:139], v[32:35], v[72:75], v[136:139]
s_add_u32 s72, s69, 46080
buffer_load_dwordx4 v5, s[4:7], s72 offen offset:3072 lds
v_mfma_f32_16x16x32_bf16 v[140:143], v[32:35], v[76:79], v[140:143]
ds_read_b128 v[120:123], v19 offset:4096
ds_read_b128 v[124:127], v19 offset:6144
v_mfma_f32_16x16x32_bf16 v[156:159], v[36:39], v[76:79], v[156:159]
ds_read_b64_tr_b16 v[84:85], v9 offset:24576
ds_read_b64_tr_b16 v[86:87], v9 offset:25600
v_mfma_f32_16x16x32_bf16 v[152:155], v[36:39], v[72:75], v[152:155]
ds_read_b64_tr_b16 v[88:89], v10 offset:24576
v_mfma_f32_16x16x32_bf16 v[148:151], v[36:39], v[68:71], v[148:151]
ds_read_b64_tr_b16 v[90:91], v10 offset:25600
v_mfma_f32_16x16x32_bf16 v[144:147], v[36:39], v[64:67], v[144:147]
s_add_u32 m0, s63, 135168
ds_read_b64_tr_b16 v[92:93], v11 offset:24576
v_mfma_f32_16x16x32_bf16 v[160:163], v[40:43], v[64:67], v[160:163]
s_add_u32 s72, s70, 0
buffer_load_dwordx4 v4, s[4:7], s72 offen lds
v_mfma_f32_16x16x32_bf16 v[164:167], v[40:43], v[68:71], v[164:167]
ds_read_b64_tr_b16 v[94:95], v11 offset:25600
v_mfma_f32_16x16x32_bf16 v[168:171], v[40:43], v[72:75], v[168:171]
ds_read_b64_tr_b16 v[96:97], v12 offset:24576
v_mfma_f32_16x16x32_bf16 v[172:175], v[40:43], v[76:79], v[172:175]
ds_read_b64_tr_b16 v[98:99], v12 offset:25600
v_mfma_f32_16x16x32_bf16 v[188:191], v[44:47], v[76:79], v[188:191]
s_add_u32 s72, s70, 15360
buffer_load_dwordx4 v5, s[4:7], s72 offen offset:1024 lds
v_mfma_f32_16x16x32_bf16 v[184:187], v[44:47], v[72:75], v[184:187]
ds_read_b64_tr_b16 v[100:101], v13 offset:24576
v_mfma_f32_16x16x32_bf16 v[180:183], v[44:47], v[68:71], v[180:183]
ds_read_b64_tr_b16 v[102:103], v13 offset:25600
v_mfma_f32_16x16x32_bf16 v[176:179], v[44:47], v[64:67], v[176:179]
ds_read_b64_tr_b16 v[104:105], v14 offset:24576
v_mfma_f32_16x16x32_bf16 v[192:195], v[48:51], v[64:67], v[192:195]
ds_read_b64_tr_b16 v[106:107], v14 offset:25600
v_mfma_f32_16x16x32_bf16 v[196:199], v[48:51], v[68:71], v[196:199]
s_add_u32 s72, s70, 30720
buffer_load_dwordx4 v4, s[4:7], s72 offen offset:2048 lds
v_mfma_f32_16x16x32_bf16 v[200:203], v[48:51], v[72:75], v[200:203]
ds_read_b64_tr_b16 v[108:109], v15 offset:24576
v_mfma_f32_16x16x32_bf16 v[204:207], v[48:51], v[76:79], v[204:207]
ds_read_b64_tr_b16 v[110:111], v15 offset:25600
v_mfma_f32_16x16x32_bf16 v[220:223], v[52:55], v[76:79], v[220:223]
v_mfma_f32_16x16x32_bf16 v[216:219], v[52:55], v[72:75], v[216:219]
v_mfma_f32_16x16x32_bf16 v[212:215], v[52:55], v[68:71], v[212:215]
s_add_u32 s72, s70, 46080
buffer_load_dwordx4 v5, s[4:7], s72 offen offset:3072 lds
v_mfma_f32_16x16x32_bf16 v[208:211], v[52:55], v[64:67], v[208:211]
v_mfma_f32_16x16x32_bf16 v[224:227], v[56:59], v[64:67], v[224:227]
v_mfma_f32_16x16x32_bf16 v[228:231], v[56:59], v[68:71], v[228:231]
v_mfma_f32_16x16x32_bf16 v[232:235], v[56:59], v[72:75], v[232:235]
v_mfma_f32_16x16x32_bf16 v[236:239], v[56:59], v[76:79], v[236:239]
v_mfma_f32_16x16x32_bf16 v[252:255], v[60:63], v[76:79], v[252:255]
v_mfma_f32_16x16x32_bf16 v[248:251], v[60:63], v[72:75], v[248:251]
v_mfma_f32_16x16x32_bf16 v[244:247], v[60:63], v[68:71], v[244:247]
s_waitcnt vmcnt(13) lgkmcnt(0)
v_mfma_f32_16x16x32_bf16 v[240:243], v[60:63], v[64:67], v[240:243]
s_barrier
v_mfma_f32_16x16x32_bf16 v[128:131], v[80:83], v[112:115], v[128:131]
s_add_u32 s73, s62, 13
ds_read_b64_tr_b16 v[32:33], v8 offset:32768
ds_read_b64_tr_b16 v[34:35], v8 offset:33792
v_mfma_f32_16x16x32_bf16 v[132:135], v[80:83], v[116:119], v[132:135]
s_add_u32 s70, s73, s65
ds_read_b128 v[64:67], v18 offset:32768
ds_read_b128 v[68:71], v18 offset:34816
v_mfma_f32_16x16x32_bf16 v[136:139], v[80:83], v[120:123], v[136:139]
s_and_b32 s70, s70, 3
ds_read_b128 v[72:75], v18 offset:36864
ds_read_b128 v[76:79], v18 offset:38912
v_mfma_f32_16x16x32_bf16 v[140:143], v[80:83], v[124:127], v[140:143]
s_and_b32 s73, s73, 12
ds_read_b64_tr_b16 v[36:37], v9 offset:32768
ds_read_b64_tr_b16 v[38:39], v9 offset:33792
v_mfma_f32_16x16x32_bf16 v[156:159], v[84:87], v[124:127], v[156:159]
s_or_b32 s73, s73, s70
ds_read_b64_tr_b16 v[40:41], v10 offset:32768
v_or_b32 v20, s58, v0
v_mfma_f32_16x16x32_bf16 v[152:155], v[84:87], v[120:123], v[152:155]
s_lshl_b32 s71, s73, 19
ds_read_b64_tr_b16 v[42:43], v10 offset:33792
v_mov_b32 v21, 1
v_mfma_f32_16x16x32_bf16 v[148:151], v[84:87], v[116:119], v[148:151]
s_add_u32 s71, s71, s66
ds_read_b64_tr_b16 v[44:45], v11 offset:32768
v_min_u32 v20, 1, v20
v_mfma_f32_16x16x32_bf16 v[144:147], v[84:87], v[112:115], v[144:147]
s_lshl_b32 s73, s73, 7
ds_read_b64_tr_b16 v[46:47], v11 offset:33792
v_lshlrev_b32 v20, 30, v20
v_mfma_f32_16x16x32_bf16 v[160:163], v[88:91], v[112:115], v[160:163]
s_add_u32 s69, s73, s67
ds_read_b64_tr_b16 v[48:49], v12 offset:32768
v_mfma_f32_16x16x32_bf16 v[164:167], v[88:91], v[116:119], v[164:167]
s_add_u32 s70, s73, s68
ds_read_b64_tr_b16 v[50:51], v12 offset:33792
v_mfma_f32_16x16x32_bf16 v[168:171], v[88:91], v[120:123], v[168:171]
s_add_u32 m0, s64, 16384
ds_read_b64_tr_b16 v[52:53], v13 offset:32768
v_mfma_f32_16x16x32_bf16 v[172:175], v[88:91], v[124:127], v[172:175]
s_add_u32 s72, s71, 0
buffer_load_dwordx4 v6, s[12:15], s72 offen lds
v_mfma_f32_16x16x32_bf16 v[188:191], v[92:95], v[124:127], v[188:191]
s_add_u32 s72, s71, 31744
buffer_load_dwordx4 v6, s[12:15], s72 offen offset:1024 lds
v_mfma_f32_16x16x32_bf16 v[184:187], v[92:95], v[120:123], v[184:187]
s_add_u32 s72, s71, 63488
buffer_load_dwordx4 v7, s[12:15], s72 offen offset:2048 lds
v_mfma_f32_16x16x32_bf16 v[180:183], v[92:95], v[116:119], v[180:183]
s_add_u32 s72, s71, 95232
buffer_load_dwordx4 v7, s[12:15], s72 offen offset:3072 lds
v_mfma_f32_16x16x32_bf16 v[176:179], v[92:95], v[112:115], v[176:179]
ds_read_b64_tr_b16 v[54:55], v13 offset:33792
v_mfma_f32_16x16x32_bf16 v[192:195], v[96:99], v[112:115], v[192:195]
ds_read_b64_tr_b16 v[56:57], v14 offset:32768
v_mfma_f32_16x16x32_bf16 v[196:199], v[96:99], v[116:119], v[196:199]
ds_read_b64_tr_b16 v[58:59], v14 offset:33792
v_mfma_f32_16x16x32_bf16 v[200:203], v[96:99], v[120:123], v[200:203]
ds_read_b64_tr_b16 v[60:61], v15 offset:32768
v_mfma_f32_16x16x32_bf16 v[204:207], v[96:99], v[124:127], v[204:207]
s_add_u32 m0, s63, 65536
ds_read_b64_tr_b16 v[62:63], v15 offset:33792
v_mfma_f32_16x16x32_bf16 v[220:223], v[100:103], v[124:127], v[220:223]
s_add_u32 s72, s69, 0
buffer_load_dwordx4 v4, s[4:7], s72 offen lds
v_mfma_f32_16x16x32_bf16 v[216:219], v[100:103], v[120:123], v[216:219]
buffer_store_dword v21, v20, s[44:47], s91 offen sc1
v_mfma_f32_16x16x32_bf16 v[212:215], v[100:103], v[116:119], v[212:215]
v_mfma_f32_16x16x32_bf16 v[208:211], v[100:103], v[112:115], v[208:211]
v_mfma_f32_16x16x32_bf16 v[224:227], v[104:107], v[112:115], v[224:227]
s_add_u32 s72, s69, 15360
buffer_load_dwordx4 v5, s[4:7], s72 offen offset:1024 lds
v_mfma_f32_16x16x32_bf16 v[228:231], v[104:107], v[116:119], v[228:231]
v_mfma_f32_16x16x32_bf16 v[232:235], v[104:107], v[120:123], v[232:235]
v_mfma_f32_16x16x32_bf16 v[236:239], v[104:107], v[124:127], v[236:239]
v_mfma_f32_16x16x32_bf16 v[252:255], v[108:111], v[124:127], v[252:255]
v_mfma_f32_16x16x32_bf16 v[248:251], v[108:111], v[120:123], v[248:251]
s_add_u32 s72, s69, 30720
buffer_load_dwordx4 v4, s[4:7], s72 offen offset:2048 lds
v_mfma_f32_16x16x32_bf16 v[244:247], v[108:111], v[116:119], v[244:247]
v_mfma_f32_16x16x32_bf16 v[240:243], v[108:111], v[112:115], v[240:243]
s_waitcnt lgkmcnt(0)
v_mfma_f32_16x16x32_bf16 v[128:131], v[32:35], v[64:67], v[128:131]
ds_read_b64_tr_b16 v[80:81], v8 offset:40960
ds_read_b64_tr_b16 v[82:83], v8 offset:41984
v_mfma_f32_16x16x32_bf16 v[132:135], v[32:35], v[68:71], v[132:135]
ds_read_b128 v[112:115], v19 offset:32768
ds_read_b128 v[116:119], v19 offset:34816
v_mfma_f32_16x16x32_bf16 v[136:139], v[32:35], v[72:75], v[136:139]
s_add_u32 s72, s69, 46080
buffer_load_dwordx4 v5, s[4:7], s72 offen offset:3072 lds
v_mfma_f32_16x16x32_bf16 v[140:143], v[32:35], v[76:79], v[140:143]
ds_read_b128 v[120:123], v19 offset:36864
ds_read_b128 v[124:127], v19 offset:38912
v_mfma_f32_16x16x32_bf16 v[156:159], v[36:39], v[76:79], v[156:159]
ds_read_b64_tr_b16 v[84:85], v9 offset:40960
ds_read_b64_tr_b16 v[86:87], v9 offset:41984
v_mfma_f32_16x16x32_bf16 v[152:155], v[36:39], v[72:75], v[152:155]
ds_read_b64_tr_b16 v[88:89], v10 offset:40960
v_mfma_f32_16x16x32_bf16 v[148:151], v[36:39], v[68:71], v[148:151]
ds_read_b64_tr_b16 v[90:91], v10 offset:41984
v_mfma_f32_16x16x32_bf16 v[144:147], v[36:39], v[64:67], v[144:147]
s_add_u32 m0, s63, 69632
ds_read_b64_tr_b16 v[92:93], v11 offset:40960
v_mfma_f32_16x16x32_bf16 v[160:163], v[40:43], v[64:67], v[160:163]
s_add_u32 s72, s70, 0
buffer_load_dwordx4 v4, s[4:7], s72 offen lds
v_mfma_f32_16x16x32_bf16 v[164:167], v[40:43], v[68:71], v[164:167]
ds_read_b64_tr_b16 v[94:95], v11 offset:41984
v_mfma_f32_16x16x32_bf16 v[168:171], v[40:43], v[72:75], v[168:171]
ds_read_b64_tr_b16 v[96:97], v12 offset:40960
v_mfma_f32_16x16x32_bf16 v[172:175], v[40:43], v[76:79], v[172:175]
ds_read_b64_tr_b16 v[98:99], v12 offset:41984
v_mfma_f32_16x16x32_bf16 v[188:191], v[44:47], v[76:79], v[188:191]
s_add_u32 s72, s70, 15360
buffer_load_dwordx4 v5, s[4:7], s72 offen offset:1024 lds
v_mfma_f32_16x16x32_bf16 v[184:187], v[44:47], v[72:75], v[184:187]
ds_read_b64_tr_b16 v[100:101], v13 offset:40960
v_mfma_f32_16x16x32_bf16 v[180:183], v[44:47], v[68:71], v[180:183]
ds_read_b64_tr_b16 v[102:103], v13 offset:41984
v_mfma_f32_16x16x32_bf16 v[176:179], v[44:47], v[64:67], v[176:179]
ds_read_b64_tr_b16 v[104:105], v14 offset:40960
v_mfma_f32_16x16x32_bf16 v[192:195], v[48:51], v[64:67], v[192:195]
ds_read_b64_tr_b16 v[106:107], v14 offset:41984
v_mfma_f32_16x16x32_bf16 v[196:199], v[48:51], v[68:71], v[196:199]
s_add_u32 s72, s70, 30720
buffer_load_dwordx4 v4, s[4:7], s72 offen offset:2048 lds
v_mfma_f32_16x16x32_bf16 v[200:203], v[48:51], v[72:75], v[200:203]
ds_read_b64_tr_b16 v[108:109], v15 offset:40960
v_mfma_f32_16x16x32_bf16 v[204:207], v[48:51], v[76:79], v[204:207]
ds_read_b64_tr_b16 v[110:111], v15 offset:41984
v_mfma_f32_16x16x32_bf16 v[220:223], v[52:55], v[76:79], v[220:223]
v_mfma_f32_16x16x32_bf16 v[216:219], v[52:55], v[72:75], v[216:219]
v_mfma_f32_16x16x32_bf16 v[212:215], v[52:55], v[68:71], v[212:215]
s_add_u32 s72, s70, 46080
buffer_load_dwordx4 v5, s[4:7], s72 offen offset:3072 lds
v_mfma_f32_16x16x32_bf16 v[208:211], v[52:55], v[64:67], v[208:211]
v_mfma_f32_16x16x32_bf16 v[224:227], v[56:59], v[64:67], v[224:227]
v_mfma_f32_16x16x32_bf16 v[228:231], v[56:59], v[68:71], v[228:231]
v_mfma_f32_16x16x32_bf16 v[232:235], v[56:59], v[72:75], v[232:235]
v_mfma_f32_16x16x32_bf16 v[236:239], v[56:59], v[76:79], v[236:239]
v_mfma_f32_16x16x32_bf16 v[252:255], v[60:63], v[76:79], v[252:255]
v_mfma_f32_16x16x32_bf16 v[248:251], v[60:63], v[72:75], v[248:251]
v_mfma_f32_16x16x32_bf16 v[244:247], v[60:63], v[68:71], v[244:247]
s_waitcnt vmcnt(13) lgkmcnt(0)
v_mfma_f32_16x16x32_bf16 v[240:243], v[60:63], v[64:67], v[240:243]
s_barrier
v_mfma_f32_16x16x32_bf16 v[128:131], v[80:83], v[112:115], v[128:131]
s_add_u32 s73, s62, 14
s_waitcnt vmcnt(25)
v_cmp_gt_u32 vcc, 8, v3
s_cbranch_vccnz Lspin1
Lback2:
v_mfma_f32_16x16x32_bf16 v[132:135], v[80:83], v[116:119], v[132:135]
s_add_u32 s70, s73, s65
ds_read_b64_tr_b16 v[32:33], v8 offset:0
ds_read_b64_tr_b16 v[34:35], v8 offset:1024
v_mfma_f32_16x16x32_bf16 v[136:139], v[80:83], v[120:123], v[136:139]
s_and_b32 s70, s70, 3
ds_read_b128 v[64:67], v16 offset:0
ds_read_b128 v[68:71], v16 offset:2048
v_mfma_f32_16x16x32_bf16 v[140:143], v[80:83], v[124:127], v[140:143]
s_and_b32 s73, s73, 12
ds_read_b128 v[72:75], v16 offset:4096
ds_read_b128 v[76:79], v16 offset:6144
v_mfma_f32_16x16x32_bf16 v[156:159], v[84:87], v[124:127], v[156:159]
s_or_b32 s73, s73, s70
ds_read_b64_tr_b16 v[36:37], v9 offset:0
ds_read_b64_tr_b16 v[38:39], v9 offset:1024
v_mfma_f32_16x16x32_bf16 v[152:155], v[84:87], v[120:123], v[152:155]
s_lshl_b32 s71, s73, 19
ds_read_b64_tr_b16 v[40:41], v10 offset:0
v_mfma_f32_16x16x32_bf16 v[148:151], v[84:87], v[116:119], v[148:151]
s_add_u32 s71, s71, s66
ds_read_b64_tr_b16 v[42:43], v10 offset:1024
v_mfma_f32_16x16x32_bf16 v[144:147], v[84:87], v[112:115], v[144:147]
s_lshl_b32 s73, s73, 7
ds_read_b64_tr_b16 v[44:45], v11 offset:0
v_mfma_f32_16x16x32_bf16 v[160:163], v[88:91], v[112:115], v[160:163]
s_add_u32 s69, s73, s67
ds_read_b64_tr_b16 v[46:47], v11 offset:1024
v_mfma_f32_16x16x32_bf16 v[164:167], v[88:91], v[116:119], v[164:167]
s_add_u32 s70, s73, s68
ds_read_b64_tr_b16 v[48:49], v12 offset:0
v_mfma_f32_16x16x32_bf16 v[168:171], v[88:91], v[120:123], v[168:171]
s_add_u32 m0, s64, 32768
ds_read_b64_tr_b16 v[50:51], v12 offset:1024
v_mfma_f32_16x16x32_bf16 v[172:175], v[88:91], v[124:127], v[172:175]
s_add_u32 s72, s71, 0
buffer_load_dwordx4 v6, s[12:15], s72 offen lds
v_mfma_f32_16x16x32_bf16 v[188:191], v[92:95], v[124:127], v[188:191]
s_add_u32 s72, s71, 31744
buffer_load_dwordx4 v6, s[12:15], s72 offen offset:1024 lds
v_mfma_f32_16x16x32_bf16 v[184:187], v[92:95], v[120:123], v[184:187]
s_add_u32 s72, s71, 63488
buffer_load_dwordx4 v7, s[12:15], s72 offen offset:2048 lds
v_mfma_f32_16x16x32_bf16 v[180:183], v[92:95], v[116:119], v[180:183]
s_add_u32 s72, s71, 95232
buffer_load_dwordx4 v7, s[12:15], s72 offen offset:3072 lds
v_mfma_f32_16x16x32_bf16 v[176:179], v[92:95], v[112:115], v[176:179]
ds_read_b64_tr_b16 v[52:53], v13 offset:0
v_mfma_f32_16x16x32_bf16 v[192:195], v[96:99], v[112:115], v[192:195]
ds_read_b64_tr_b16 v[54:55], v13 offset:1024
v_mfma_f32_16x16x32_bf16 v[196:199], v[96:99], v[116:119], v[196:199]
ds_read_b64_tr_b16 v[56:57], v14 offset:0
v_mfma_f32_16x16x32_bf16 v[200:203], v[96:99], v[120:123], v[200:203]
ds_read_b64_tr_b16 v[58:59], v14 offset:1024
v_mfma_f32_16x16x32_bf16 v[204:207], v[96:99], v[124:127], v[204:207]
s_add_u32 m0, s63, 98304
ds_read_b64_tr_b16 v[60:61], v15 offset:0
v_mfma_f32_16x16x32_bf16 v[220:223], v[100:103], v[124:127], v[220:223]
s_add_u32 s72, s69, 0
buffer_load_dwordx4 v4, s[4:7], s72 offen lds
v_mfma_f32_16x16x32_bf16 v[216:219], v[100:103], v[120:123], v[216:219]
ds_read_b64_tr_b16 v[62:63], v15 offset:1024
v_mfma_f32_16x16x32_bf16 v[212:215], v[100:103], v[116:119], v[212:215]
v_mfma_f32_16x16x32_bf16 v[208:211], v[100:103], v[112:115], v[208:211]
v_mfma_f32_16x16x32_bf16 v[224:227], v[104:107], v[112:115], v[224:227]
s_add_u32 s72, s69, 15360
buffer_load_dwordx4 v5, s[4:7], s72 offen offset:1024 lds
v_mfma_f32_16x16x32_bf16 v[228:231], v[104:107], v[116:119], v[228:231]
v_mfma_f32_16x16x32_bf16 v[232:235], v[104:107], v[120:123], v[232:235]
v_mfma_f32_16x16x32_bf16 v[236:239], v[104:107], v[124:127], v[236:239]
v_mfma_f32_16x16x32_bf16 v[252:255], v[108:111], v[124:127], v[252:255]
v_mfma_f32_16x16x32_bf16 v[248:251], v[108:111], v[120:123], v[248:251]
s_add_u32 s72, s69, 30720
buffer_load_dwordx4 v4, s[4:7], s72 offen offset:2048 lds
v_mfma_f32_16x16x32_bf16 v[244:247], v[108:111], v[116:119], v[244:247]
v_mfma_f32_16x16x32_bf16 v[240:243], v[108:111], v[112:115], v[240:243]
s_waitcnt lgkmcnt(0)
v_mfma_f32_16x16x32_bf16 v[128:131], v[32:35], v[64:67], v[128:131]
ds_read_b64_tr_b16 v[80:81], v8 offset:8192
ds_read_b64_tr_b16 v[82:83], v8 offset:9216
v_mfma_f32_16x16x32_bf16 v[132:135], v[32:35], v[68:71], v[132:135]
ds_read_b128 v[112:115], v17 offset:0
ds_read_b128 v[116:119], v17 offset:2048
v_mfma_f32_16x16x32_bf16 v[136:139], v[32:35], v[72:75], v[136:139]
s_add_u32 s72, s69, 46080
buffer_load_dwordx4 v5, s[4:7], s72 offen offset:3072 lds
v_mfma_f32_16x16x32_bf16 v[140:143], v[32:35], v[76:79], v[140:143]
ds_read_b128 v[120:123], v17 offset:4096
ds_read_b128 v[124:127], v17 offset:6144
v_mfma_f32_16x16x32_bf16 v[156:159], v[36:39], v[76:79], v[156:159]
ds_read_b64_tr_b16 v[84:85], v9 offset:8192
ds_read_b64_tr_b16 v[86:87], v9 offset:9216
v_mfma_f32_16x16x32_bf16 v[152:155], v[36:39], v[72:75], v[152:155]
ds_read_b64_tr_b16 v[88:89], v10 offset:8192
v_mfma_f32_16x16x32_bf16 v[148:151], v[36:39], v[68:71], v[148:151]
ds_read_b64_tr_b16 v[90:91], v10 offset:9216
v_mfma_f32_16x16x32_bf16 v[144:147], v[36:39], v[64:67], v[144:147]
s_add_u32 m0, s63, 102400
ds_read_b64_tr_b16 v[92:93], v11 offset:8192
v_mfma_f32_16x16x32_bf16 v[160:163], v[40:43], v[64:67], v[160:163]
s_add_u32 s72, s70, 0
buffer_load_dwordx4 v4, s[4:7], s72 offen lds
v_mfma_f32_16x16x32_bf16 v[164:167], v[40:43], v[68:71], v[164:167]
ds_read_b64_tr_b16 v[94:95], v11 offset:9216
v_mfma_f32_16x16x32_bf16 v[168:171], v[40:43], v[72:75], v[168:171]
ds_read_b64_tr_b16 v[96:97], v12 offset:8192
v_mfma_f32_16x16x32_bf16 v[172:175], v[40:43], v[76:79], v[172:175]
ds_read_b64_tr_b16 v[98:99], v12 offset:9216
v_mfma_f32_16x16x32_bf16 v[188:191], v[44:47], v[76:79], v[188:191]
s_add_u32 s72, s70, 15360
buffer_load_dwordx4 v5, s[4:7], s72 offen offset:1024 lds
v_mfma_f32_16x16x32_bf16 v[184:187], v[44:47], v[72:75], v[184:187]
ds_read_b64_tr_b16 v[100:101], v13 offset:8192
v_mfma_f32_16x16x32_bf16 v[180:183], v[44:47], v[68:71], v[180:183]
ds_read_b64_tr_b16 v[102:103], v13 offset:9216
v_mfma_f32_16x16x32_bf16 v[176:179], v[44:47], v[64:67], v[176:179]
ds_read_b64_tr_b16 v[104:105], v14 offset:8192
v_mfma_f32_16x16x32_bf16 v[192:195], v[48:51], v[64:67], v[192:195]
ds_read_b64_tr_b16 v[106:107], v14 offset:9216
v_mfma_f32_16x16x32_bf16 v[196:199], v[48:51], v[68:71], v[196:199]
s_add_u32 s72, s70, 30720
buffer_load_dwordx4 v4, s[4:7], s72 offen offset:2048 lds
v_mfma_f32_16x16x32_bf16 v[200:203], v[48:51], v[72:75], v[200:203]
ds_read_b64_tr_b16 v[108:109], v15 offset:8192
v_mfma_f32_16x16x32_bf16 v[204:207], v[48:51], v[76:79], v[204:207]
ds_read_b64_tr_b16 v[110:111], v15 offset:9216
v_mfma_f32_16x16x32_bf16 v[220:223], v[52:55], v[76:79], v[220:223]
v_mfma_f32_16x16x32_bf16 v[216:219], v[52:55], v[72:75], v[216:219]
v_mfma_f32_16x16x32_bf16 v[212:215], v[52:55], v[68:71], v[212:215]
s_add_u32 s72, s70, 46080
buffer_load_dwordx4 v5, s[4:7], s72 offen offset:3072 lds
v_mfma_f32_16x16x32_bf16 v[208:211], v[52:55], v[64:67], v[208:211]
v_mfma_f32_16x16x32_bf16 v[224:227], v[56:59], v[64:67], v[224:227]
v_mfma_f32_16x16x32_bf16 v[228:231], v[56:59], v[68:71], v[228:231]
v_mfma_f32_16x16x32_bf16 v[232:235], v[56:59], v[72:75], v[232:235]
v_mfma_f32_16x16x32_bf16 v[236:239], v[56:59], v[76:79], v[236:239]
v_mfma_f32_16x16x32_bf16 v[252:255], v[60:63], v[76:79], v[252:255]
v_mfma_f32_16x16x32_bf16 v[248:251], v[60:63], v[72:75], v[248:251]
v_mfma_f32_16x16x32_bf16 v[244:247], v[60:63], v[68:71], v[244:247]
s_waitcnt vmcnt(12) lgkmcnt(0)
v_mfma_f32_16x16x32_bf16 v[240:243], v[60:63], v[64:67], v[240:243]
s_barrier
v_mfma_f32_16x16x32_bf16 v[128:131], v[80:83], v[112:115], v[128:131]
s_add_u32 s73, s62, 15
ds_read_b64_tr_b16 v[32:33], v8 offset:16384
ds_read_b64_tr_b16 v[34:35], v8 offset:17408
v_mfma_f32_16x16x32_bf16 v[132:135], v[80:83], v[116:119], v[132:135]
s_add_u32 s70, s73, s65
ds_read_b128 v[64:67], v18 offset:0
ds_read_b128 v[68:71], v18 offset:2048
v_mfma_f32_16x16x32_bf16 v[136:139], v[80:83], v[120:123], v[136:139]
s_and_b32 s70, s70, 3
ds_read_b128 v[72:75], v18 offset:4096
ds_read_b128 v[76:79], v18 offset:6144
v_mfma_f32_16x16x32_bf16 v[140:143], v[80:83], v[124:127], v[140:143]
s_and_b32 s73, s73, 12
ds_read_b64_tr_b16 v[36:37], v9 offset:16384
ds_read_b64_tr_b16 v[38:39], v9 offset:17408
v_mfma_f32_16x16x32_bf16 v[156:159], v[84:87], v[124:127], v[156:159]
s_or_b32 s73, s73, s70
ds_read_b64_tr_b16 v[40:41], v10 offset:16384
v_mfma_f32_16x16x32_bf16 v[152:155], v[84:87], v[120:123], v[152:155]
s_lshl_b32 s71, s73, 19
ds_read_b64_tr_b16 v[42:43], v10 offset:17408
v_mfma_f32_16x16x32_bf16 v[148:151], v[84:87], v[116:119], v[148:151]
s_add_u32 s71, s71, s66
ds_read_b64_tr_b16 v[44:45], v11 offset:16384
v_mfma_f32_16x16x32_bf16 v[144:147], v[84:87], v[112:115], v[144:147]
s_lshl_b32 s73, s73, 7
ds_read_b64_tr_b16 v[46:47], v11 offset:17408
v_mfma_f32_16x16x32_bf16 v[160:163], v[88:91], v[112:115], v[160:163]
s_add_u32 s69, s73, s67
ds_read_b64_tr_b16 v[48:49], v12 offset:16384
v_mfma_f32_16x16x32_bf16 v[164:167], v[88:91], v[116:119], v[164:167]
s_add_u32 s70, s73, s68
ds_read_b64_tr_b16 v[50:51], v12 offset:17408
v_mfma_f32_16x16x32_bf16 v[168:171], v[88:91], v[120:123], v[168:171]
s_add_u32 m0, s64, 0
ds_read_b64_tr_b16 v[52:53], v13 offset:16384
v_mfma_f32_16x16x32_bf16 v[172:175], v[88:91], v[124:127], v[172:175]
s_add_u32 s72, s71, 0
buffer_load_dwordx4 v6, s[12:15], s72 offen lds
v_mfma_f32_16x16x32_bf16 v[188:191], v[92:95], v[124:127], v[188:191]
s_add_u32 s72, s71, 31744
buffer_load_dwordx4 v6, s[12:15], s72 offen offset:1024 lds
v_mfma_f32_16x16x32_bf16 v[184:187], v[92:95], v[120:123], v[184:187]
s_add_u32 s72, s71, 63488
buffer_load_dwordx4 v7, s[12:15], s72 offen offset:2048 lds
v_mfma_f32_16x16x32_bf16 v[180:183], v[92:95], v[116:119], v[180:183]
s_add_u32 s72, s71, 95232
buffer_load_dwordx4 v7, s[12:15], s72 offen offset:3072 lds
v_mfma_f32_16x16x32_bf16 v[176:179], v[92:95], v[112:115], v[176:179]
s_and_b32 s75, s91, 0xfffffc7f
v_lshrrev_b32 v2, 3, v0
v_lshlrev_b32 v2, 7, v2
v_mfma_f32_16x16x32_bf16 v[192:195], v[96:99], v[112:115], v[192:195]
buffer_load_dword v3, v2, s[44:47], s75 offen sc1
v_mfma_f32_16x16x32_bf16 v[196:199], v[96:99], v[116:119], v[196:199]
ds_read_b64_tr_b16 v[54:55], v13 offset:17408
v_mfma_f32_16x16x32_bf16 v[200:203], v[96:99], v[120:123], v[200:203]
ds_read_b64_tr_b16 v[56:57], v14 offset:16384
v_mfma_f32_16x16x32_bf16 v[204:207], v[96:99], v[124:127], v[204:207]
s_add_u32 m0, s63, 131072
ds_read_b64_tr_b16 v[58:59], v14 offset:17408
v_mfma_f32_16x16x32_bf16 v[220:223], v[100:103], v[124:127], v[220:223]
s_add_u32 s72, s69, 0
buffer_load_dwordx4 v4, s[4:7], s72 offen lds
v_mfma_f32_16x16x32_bf16 v[216:219], v[100:103], v[120:123], v[216:219]
ds_read_b64_tr_b16 v[60:61], v15 offset:16384
v_mfma_f32_16x16x32_bf16 v[212:215], v[100:103], v[116:119], v[212:215]
ds_read_b64_tr_b16 v[62:63], v15 offset:17408
v_mfma_f32_16x16x32_bf16 v[208:211], v[100:103], v[112:115], v[208:211]
v_mfma_f32_16x16x32_bf16 v[224:227], v[104:107], v[112:115], v[224:227]
s_add_u32 s72, s69, 15360
buffer_load_dwordx4 v5, s[4:7], s72 offen offset:1024 lds
v_mfma_f32_16x16x32_bf16 v[228:231], v[104:107], v[116:119], v[228:231]
v_mfma_f32_16x16x32_bf16 v[232:235], v[104:107], v[120:123], v[232:235]
v_mfma_f32_16x16x32_bf16 v[236:239], v[104:107], v[124:127], v[236:239]
v_mfma_f32_16x16x32_bf16 v[252:255], v[108:111], v[124:127], v[252:255]
v_mfma_f32_16x16x32_bf16 v[248:251], v[108:111], v[120:123], v[248:251]
s_add_u32 s72, s69, 30720
buffer_load_dwordx4 v4, s[4:7], s72 offen offset:2048 lds
v_mfma_f32_16x16x32_bf16 v[244:247], v[108:111], v[116:119], v[244:247]
v_mfma_f32_16x16x32_bf16 v[240:243], v[108:111], v[112:115], v[240:243]
s_waitcnt lgkmcnt(0)
v_mfma_f32_16x16x32_bf16 v[128:131], v[32:35], v[64:67], v[128:131]
ds_read_b64_tr_b16 v[80:81], v8 offset:24576
ds_read_b64_tr_b16 v[82:83], v8 offset:25600
v_mfma_f32_16x16x32_bf16 v[132:135], v[32:35], v[68:71], v[132:135]
ds_read_b128 v[112:115], v19 offset:0
ds_read_b128 v[116:119], v19 offset:2048
v_mfma_f32_16x16x32_bf16 v[136:139], v[32:35], v[72:75], v[136:139]
s_add_u32 s72, s69, 46080
buffer_load_dwordx4 v5, s[4:7], s72 offen offset:3072 lds
v_mfma_f32_16x16x32_bf16 v[140:143], v[32:35], v[76:79], v[140:143]
ds_read_b128 v[120:123], v19 offset:4096
ds_read_b128 v[124:127], v19 offset:6144
v_mfma_f32_16x16x32_bf16 v[156:159], v[36:39], v[76:79], v[156:159]
ds_read_b64_tr_b16 v[84:85], v9 offset:24576
ds_read_b64_tr_b16 v[86:87], v9 offset:25600
v_mfma_f32_16x16x32_bf16 v[152:155], v[36:39], v[72:75], v[152:155]
ds_read_b64_tr_b16 v[88:89], v10 offset:24576
v_mfma_f32_16x16x32_bf16 v[148:151], v[36:39], v[68:71], v[148:151]
ds_read_b64_tr_b16 v[90:91], v10 offset:25600
v_mfma_f32_16x16x32_bf16 v[144:147], v[36:39], v[64:67], v[144:147]
s_add_u32 m0, s63, 135168
ds_read_b64_tr_b16 v[92:93], v11 offset:24576
v_mfma_f32_16x16x32_bf16 v[160:163], v[40:43], v[64:67], v[160:163]
s_add_u32 s72, s70, 0
buffer_load_dwordx4 v4, s[4:7], s72 offen lds
v_mfma_f32_16x16x32_bf16 v[164:167], v[40:43], v[68:71], v[164:167]
ds_read_b64_tr_b16 v[94:95], v11 offset:25600
v_mfma_f32_16x16x32_bf16 v[168:171], v[40:43], v[72:75], v[168:171]
ds_read_b64_tr_b16 v[96:97], v12 offset:24576
v_mfma_f32_16x16x32_bf16 v[172:175], v[40:43], v[76:79], v[172:175]
ds_read_b64_tr_b16 v[98:99], v12 offset:25600
v_mfma_f32_16x16x32_bf16 v[188:191], v[44:47], v[76:79], v[188:191]
s_add_u32 s72, s70, 15360
buffer_load_dwordx4 v5, s[4:7], s72 offen offset:1024 lds
v_mfma_f32_16x16x32_bf16 v[184:187], v[44:47], v[72:75], v[184:187]
ds_read_b64_tr_b16 v[100:101], v13 offset:24576
v_mfma_f32_16x16x32_bf16 v[180:183], v[44:47], v[68:71], v[180:183]
ds_read_b64_tr_b16 v[102:103], v13 offset:25600
v_mfma_f32_16x16x32_bf16 v[176:179], v[44:47], v[64:67], v[176:179]
ds_read_b64_tr_b16 v[104:105], v14 offset:24576
v_mfma_f32_16x16x32_bf16 v[192:195], v[48:51], v[64:67], v[192:195]
ds_read_b64_tr_b16 v[106:107], v14 offset:25600
v_mfma_f32_16x16x32_bf16 v[196:199], v[48:51], v[68:71], v[196:199]
s_add_u32 s72, s70, 30720
buffer_load_dwordx4 v4, s[4:7], s72 offen offset:2048 lds
v_mfma_f32_16x16x32_bf16 v[200:203], v[48:51], v[72:75], v[200:203]
ds_read_b64_tr_b16 v[108:109], v15 offset:24576
v_mfma_f32_16x16x32_bf16 v[204:207], v[48:51], v[76:79], v[204:207]
ds_read_b64_tr_b16 v[110:111], v15 offset:25600
v_mfma_f32_16x16x32_bf16 v[220:223], v[52:55], v[76:79], v[220:223]
v_mfma_f32_16x16x32_bf16 v[216:219], v[52:55], v[72:75], v[216:219]
v_mfma_f32_16x16x32_bf16 v[212:215], v[52:55], v[68:71], v[212:215]
s_add_u32 s72, s70, 46080
buffer_load_dwordx4 v5, s[4:7], s72 offen offset:3072 lds
v_mfma_f32_16x16x32_bf16 v[208:211], v[52:55], v[64:67], v[208:211]
v_mfma_f32_16x16x32_bf16 v[224:227], v[56:59], v[64:67], v[224:227]
v_mfma_f32_16x16x32_bf16 v[228:231], v[56:59], v[68:71], v[228:231]
v_mfma_f32_16x16x32_bf16 v[232:235], v[56:59], v[72:75], v[232:235]
v_mfma_f32_16x16x32_bf16 v[236:239], v[56:59], v[76:79], v[236:239]
v_mfma_f32_16x16x32_bf16 v[252:255], v[60:63], v[76:79], v[252:255]
v_mfma_f32_16x16x32_bf16 v[248:251], v[60:63], v[72:75], v[248:251]
v_mfma_f32_16x16x32_bf16 v[244:247], v[60:63], v[68:71], v[244:247]
s_waitcnt vmcnt(13) lgkmcnt(0)
v_mfma_f32_16x16x32_bf16 v[240:243], v[60:63], v[64:67], v[240:243]
s_barrier
v_mfma_f32_16x16x32_bf16 v[128:131], v[80:83], v[112:115], v[128:131]
s_waitcnt vmcnt(8)
v_cmp_gt_u32 vcc, 1, v3
s_cbranch_vccnz Lspin4
Lback5:
v_mfma_f32_16x16x32_bf16 v[132:135], v[80:83], v[116:119], v[132:135]
s_add_u32 m0, s64, 49152
ds_read_b64_tr_b16 v[32:33], v8 offset:32768
ds_read_b64_tr_b16 v[34:35], v8 offset:33792
v_mfma_f32_16x16x32_bf16 v[136:139], v[80:83], v[120:123], v[136:139]
s_add_u32 s72, s81, 16384
buffer_load_dwordx4 v1, s[44:47], s72 offen sc1 lds
v_mfma_f32_16x16x32_bf16 v[140:143], v[80:83], v[124:127], v[140:143]
ds_read_b128 v[64:67], v18 offset:32768
ds_read_b128 v[68:71], v18 offset:34816
v_mfma_f32_16x16x32_bf16 v[156:159], v[84:87], v[124:127], v[156:159]
ds_read_b128 v[72:75], v18 offset:36864
ds_read_b128 v[76:79], v18 offset:38912
v_mfma_f32_16x16x32_bf16 v[152:155], v[84:87], v[120:123], v[152:155]
buffer_load_dwordx4 v1, s[44:47], s72 offen offset:1024 sc1 lds
v_mfma_f32_16x16x32_bf16 v[148:151], v[84:87], v[116:119], v[148:151]
ds_read_b64_tr_b16 v[36:37], v9 offset:32768
ds_read_b64_tr_b16 v[38:39], v9 offset:33792
v_mfma_f32_16x16x32_bf16 v[144:147], v[84:87], v[112:115], v[144:147]
ds_read_b64_tr_b16 v[40:41], v10 offset:32768
v_mfma_f32_16x16x32_bf16 v[160:163], v[88:91], v[112:115], v[160:163]
ds_read_b64_tr_b16 v[42:43], v10 offset:33792
v_mfma_f32_16x16x32_bf16 v[164:167], v[88:91], v[116:119], v[164:167]
ds_read_b64_tr_b16 v[44:45], v11 offset:32768
v_mfma_f32_16x16x32_bf16 v[168:171], v[88:91], v[120:123], v[168:171]
buffer_load_dwordx4 v1, s[44:47], s72 offen offset:2048 sc1 lds
v_mfma_f32_16x16x32_bf16 v[172:175], v[88:91], v[124:127], v[172:175]
ds_read_b64_tr_b16 v[46:47], v11 offset:33792
v_mfma_f32_16x16x32_bf16 v[188:191], v[92:95], v[124:127], v[188:191]
ds_read_b64_tr_b16 v[48:49], v12 offset:32768
v_mfma_f32_16x16x32_bf16 v[184:187], v[92:95], v[120:123], v[184:187]
ds_read_b64_tr_b16 v[50:51], v12 offset:33792
v_mfma_f32_16x16x32_bf16 v[180:183], v[92:95], v[116:119], v[180:183]
ds_read_b64_tr_b16 v[52:53], v13 offset:32768
v_mfma_f32_16x16x32_bf16 v[176:179], v[92:95], v[112:115], v[176:179]
buffer_load_dwordx4 v1, s[44:47], s72 offen offset:3072 sc1 lds
v_mfma_f32_16x16x32_bf16 v[192:195], v[96:99], v[112:115], v[192:195]
ds_read_b64_tr_b16 v[54:55], v13 offset:33792
v_mfma_f32_16x16x32_bf16 v[196:199], v[96:99], v[116:119], v[196:199]
ds_read_b64_tr_b16 v[56:57], v14 offset:32768
v_mfma_f32_16x16x32_bf16 v[200:203], v[96:99], v[120:123], v[200:203]
ds_read_b64_tr_b16 v[58:59], v14 offset:33792
v_mfma_f32_16x16x32_bf16 v[204:207], v[96:99], v[124:127], v[204:207]
ds_read_b64_tr_b16 v[60:61], v15 offset:32768
v_mfma_f32_16x16x32_bf16 v[220:223], v[100:103], v[124:127], v[220:223]
s_add_u32 s81, s81, 0x8000
ds_read_b64_tr_b16 v[62:63], v15 offset:33792
v_mfma_f32_16x16x32_bf16 v[216:219], v[100:103], v[120:123], v[216:219]
s_add_u32 m0, s64, 81920
v_mfma_f32_16x16x32_bf16 v[212:215], v[100:103], v[116:119], v[212:215]
s_add_u32 s72, s81, 16384
buffer_load_dwordx4 v1, s[44:47], s72 offen sc1 lds
v_mfma_f32_16x16x32_bf16 v[208:211], v[100:103], v[112:115], v[208:211]
v_mfma_f32_16x16x32_bf16 v[224:227], v[104:107], v[112:115], v[224:227]
v_mfma_f32_16x16x32_bf16 v[228:231], v[104:107], v[116:119], v[228:231]
buffer_load_dwordx4 v1, s[44:47], s72 offen offset:1024 sc1 lds
v_mfma_f32_16x16x32_bf16 v[232:235], v[104:107], v[120:123], v[232:235]
v_mfma_f32_16x16x32_bf16 v[236:239], v[104:107], v[124:127], v[236:239]
v_mfma_f32_16x16x32_bf16 v[252:255], v[108:111], v[124:127], v[252:255]
v_mfma_f32_16x16x32_bf16 v[248:251], v[108:111], v[120:123], v[248:251]
v_mfma_f32_16x16x32_bf16 v[244:247], v[108:111], v[116:119], v[244:247]
buffer_load_dwordx4 v1, s[44:47], s72 offen offset:2048 sc1 lds
v_mfma_f32_16x16x32_bf16 v[240:243], v[108:111], v[112:115], v[240:243]
s_waitcnt lgkmcnt(0)
v_mfma_f32_16x16x32_bf16 v[128:131], v[32:35], v[64:67], v[128:131]
ds_read_b64_tr_b16 v[80:81], v8 offset:40960
ds_read_b64_tr_b16 v[82:83], v8 offset:41984
v_mfma_f32_16x16x32_bf16 v[132:135], v[32:35], v[68:71], v[132:135]
ds_read_b128 v[112:115], v19 offset:32768
ds_read_b128 v[116:119], v19 offset:34816
v_mfma_f32_16x16x32_bf16 v[136:139], v[32:35], v[72:75], v[136:139]
buffer_load_dwordx4 v1, s[44:47], s72 offen offset:3072 sc1 lds
v_mfma_f32_16x16x32_bf16 v[140:143], v[32:35], v[76:79], v[140:143]
ds_read_b128 v[120:123], v19 offset:36864
ds_read_b128 v[124:127], v19 offset:38912
v_mfma_f32_16x16x32_bf16 v[156:159], v[36:39], v[76:79], v[156:159]
ds_read_b64_tr_b16 v[84:85], v9 offset:40960
ds_read_b64_tr_b16 v[86:87], v9 offset:41984
v_mfma_f32_16x16x32_bf16 v[152:155], v[36:39], v[72:75], v[152:155]
ds_read_b64_tr_b16 v[88:89], v10 offset:40960
v_mfma_f32_16x16x32_bf16 v[148:151], v[36:39], v[68:71], v[148:151]
ds_read_b64_tr_b16 v[90:91], v10 offset:41984
v_mfma_f32_16x16x32_bf16 v[144:147], v[36:39], v[64:67], v[144:147]
s_add_u32 m0, s64, 65536
ds_read_b64_tr_b16 v[92:93], v11 offset:40960
v_mfma_f32_16x16x32_bf16 v[160:163], v[40:43], v[64:67], v[160:163]
s_add_u32 s72, s81, 0
buffer_load_dwordx4 v1, s[44:47], s72 offen sc1 lds
v_mfma_f32_16x16x32_bf16 v[164:167], v[40:43], v[68:71], v[164:167]
ds_read_b64_tr_b16 v[94:95], v11 offset:41984
v_mfma_f32_16x16x32_bf16 v[168:171], v[40:43], v[72:75], v[168:171]
ds_read_b64_tr_b16 v[96:97], v12 offset:40960
v_mfma_f32_16x16x32_bf16 v[172:175], v[40:43], v[76:79], v[172:175]
ds_read_b64_tr_b16 v[98:99], v12 offset:41984
v_mfma_f32_16x16x32_bf16 v[188:191], v[44:47], v[76:79], v[188:191]
buffer_load_dwordx4 v1, s[44:47], s72 offen offset:1024 sc1 lds
v_mfma_f32_16x16x32_bf16 v[184:187], v[44:47], v[72:75], v[184:187]
ds_read_b64_tr_b16 v[100:101], v13 offset:40960
v_mfma_f32_16x16x32_bf16 v[180:183], v[44:47], v[68:71], v[180:183]
ds_read_b64_tr_b16 v[102:103], v13 offset:41984
v_mfma_f32_16x16x32_bf16 v[176:179], v[44:47], v[64:67], v[176:179]
ds_read_b64_tr_b16 v[104:105], v14 offset:40960
v_mfma_f32_16x16x32_bf16 v[192:195], v[48:51], v[64:67], v[192:195]
ds_read_b64_tr_b16 v[106:107], v14 offset:41984
v_mfma_f32_16x16x32_bf16 v[196:199], v[48:51], v[68:71], v[196:199]
buffer_load_dwordx4 v1, s[44:47], s72 offen offset:2048 sc1 lds
v_mfma_f32_16x16x32_bf16 v[200:203], v[48:51], v[72:75], v[200:203]
ds_read_b64_tr_b16 v[108:109], v15 offset:40960
v_mfma_f32_16x16x32_bf16 v[204:207], v[48:51], v[76:79], v[204:207]
ds_read_b64_tr_b16 v[110:111], v15 offset:41984
v_mfma_f32_16x16x32_bf16 v[220:223], v[52:55], v[76:79], v[220:223]
v_mfma_f32_16x16x32_bf16 v[216:219], v[52:55], v[72:75], v[216:219]
v_mfma_f32_16x16x32_bf16 v[212:215], v[52:55], v[68:71], v[212:215]
buffer_load_dwordx4 v1, s[44:47], s72 offen offset:3072 sc1 lds
v_mfma_f32_16x16x32_bf16 v[208:211], v[52:55], v[64:67], v[208:211]
v_mfma_f32_16x16x32_bf16 v[224:227], v[56:59], v[64:67], v[224:227]
v_mfma_f32_16x16x32_bf16 v[228:231], v[56:59], v[68:71], v[228:231]
v_mfma_f32_16x16x32_bf16 v[232:235], v[56:59], v[72:75], v[232:235]
v_mfma_f32_16x16x32_bf16 v[236:239], v[56:59], v[76:79], v[236:239]
v_mfma_f32_16x16x32_bf16 v[252:255], v[60:63], v[76:79], v[252:255]
v_mfma_f32_16x16x32_bf16 v[248:251], v[60:63], v[72:75], v[248:251]
v_mfma_f32_16x16x32_bf16 v[244:247], v[60:63], v[68:71], v[244:247]
s_waitcnt vmcnt(12) lgkmcnt(0)
v_mfma_f32_16x16x32_bf16 v[240:243], v[60:63], v[64:67], v[240:243]
s_barrier
v_mfma_f32_16x16x32_bf16 v[128:131], v[80:83], v[112:115], v[128:131]
s_add_u32 s81, s81, 0x8000
ds_read_b64_tr_b16 v[32:33], v8 offset:0
ds_read_b64_tr_b16 v[34:35], v8 offset:1024
v_mfma_f32_16x16x32_bf16 v[132:135], v[80:83], v[116:119], v[132:135]
s_add_u32 m0, s64, 114688
ds_read_b128 v[64:67], v16 offset:0
ds_read_b128 v[68:71], v16 offset:2048
v_mfma_f32_16x16x32_bf16 v[136:139], v[80:83], v[120:123], v[136:139]
s_add_u32 s72, s81, 16384
buffer_load_dwordx4 v1, s[44:47], s72 offen sc1 lds
v_mfma_f32_16x16x32_bf16 v[140:143], v[80:83], v[124:127], v[140:143]
ds_read_b128 v[72:75], v16 offset:4096
ds_read_b128 v[76:79], v16 offset:6144
v_mfma_f32_16x16x32_bf16 v[156:159], v[84:87], v[124:127], v[156:159]
ds_read_b64_tr_b16 v[36:37], v9 offset:0
ds_read_b64_tr_b16 v[38:39], v9 offset:1024
v_mfma_f32_16x16x32_bf16 v[152:155], v[84:87], v[120:123], v[152:155]
ds_read_b64_tr_b16 v[40:41], v10 offset:0
v_mfma_f32_16x16x32_bf16 v[148:151], v[84:87], v[116:119], v[148:151]
ds_read_b64_tr_b16 v[42:43], v10 offset:1024
v_mfma_f32_16x16x32_bf16 v[144:147], v[84:87], v[112:115], v[144:147]
buffer_load_dwordx4 v1, s[44:47], s72 offen offset:1024 sc1 lds
v_mfma_f32_16x16x32_bf16 v[160:163], v[88:91], v[112:115], v[160:163]
ds_read_b64_tr_b16 v[44:45], v11 offset:0
v_mfma_f32_16x16x32_bf16 v[164:167], v[88:91], v[116:119], v[164:167]
ds_read_b64_tr_b16 v[46:47], v11 offset:1024
v_mfma_f32_16x16x32_bf16 v[168:171], v[88:91], v[120:123], v[168:171]
ds_read_b64_tr_b16 v[48:49], v12 offset:0
v_mfma_f32_16x16x32_bf16 v[172:175], v[88:91], v[124:127], v[172:175]
ds_read_b64_tr_b16 v[50:51], v12 offset:1024
v_mfma_f32_16x16x32_bf16 v[188:191], v[92:95], v[124:127], v[188:191]
ds_read_b64_tr_b16 v[52:53], v13 offset:0
v_mfma_f32_16x16x32_bf16 v[184:187], v[92:95], v[120:123], v[184:187]
ds_read_b64_tr_b16 v[54:55], v13 offset:1024
v_mfma_f32_16x16x32_bf16 v[180:183], v[92:95], v[116:119], v[180:183]
buffer_load_dwordx4 v1, s[44:47], s72 offen offset:2048 sc1 lds
v_mfma_f32_16x16x32_bf16 v[176:179], v[92:95], v[112:115], v[176:179]
ds_read_b64_tr_b16 v[56:57], v14 offset:0
v_mfma_f32_16x16x32_bf16 v[192:195], v[96:99], v[112:115], v[192:195]
ds_read_b64_tr_b16 v[58:59], v14 offset:1024
v_mfma_f32_16x16x32_bf16 v[196:199], v[96:99], v[116:119], v[196:199]
ds_read_b64_tr_b16 v[60:61], v15 offset:0
v_mfma_f32_16x16x32_bf16 v[200:203], v[96:99], v[120:123], v[200:203]
ds_read_b64_tr_b16 v[62:63], v15 offset:1024
v_mfma_f32_16x16x32_bf16 v[204:207], v[96:99], v[124:127], v[204:207]
v_mfma_f32_16x16x32_bf16 v[220:223], v[100:103], v[124:127], v[220:223]
v_mfma_f32_16x16x32_bf16 v[216:219], v[100:103], v[120:123], v[216:219]
v_mfma_f32_16x16x32_bf16 v[212:215], v[100:103], v[116:119], v[212:215]
buffer_load_dwordx4 v1, s[44:47], s72 offen offset:3072 sc1 lds
v_mfma_f32_16x16x32_bf16 v[208:211], v[100:103], v[112:115], v[208:211]
v_mfma_f32_16x16x32_bf16 v[224:227], v[104:107], v[112:115], v[224:227]
v_mfma_f32_16x16x32_bf16 v[228:231], v[104:107], v[116:119], v[228:231]
v_mfma_f32_16x16x32_bf16 v[232:235], v[104:107], v[120:123], v[232:235]
v_mfma_f32_16x16x32_bf16 v[236:239], v[104:107], v[124:127], v[236:239]
v_mfma_f32_16x16x32_bf16 v[252:255], v[108:111], v[124:127], v[252:255]
v_mfma_f32_16x16x32_bf16 v[248:251], v[108:111], v[120:123], v[248:251]
s_add_u32 m0, s64, 98304
v_mfma_f32_16x16x32_bf16 v[244:247], v[108:111], v[116:119], v[244:247]
s_add_u32 s72, s81, 0
buffer_load_dwordx4 v1, s[44:47], s72 offen sc1 lds
v_mfma_f32_16x16x32_bf16 v[240:243], v[108:111], v[112:115], v[240:243]
s_waitcnt lgkmcnt(0)
v_mfma_f32_16x16x32_bf16 v[128:131], v[32:35], v[64:67], v[128:131]
ds_read_b64_tr_b16 v[80:81], v8 offset:8192
v_add_u32 v2, 0x8000, v1
v_mfma_f32_16x16x32_bf16 v[132:135], v[32:35], v[68:71], v[132:135]
ds_read_b64_tr_b16 v[82:83], v8 offset:9216
ds_read_b128 v[112:115], v17 offset:0
v_mfma_f32_16x16x32_bf16 v[136:139], v[32:35], v[72:75], v[136:139]
ds_read_b128 v[116:119], v17 offset:2048
ds_read_b128 v[120:123], v17 offset:4096
v_mfma_f32_16x16x32_bf16 v[140:143], v[32:35], v[76:79], v[140:143]
ds_read_b128 v[124:127], v17 offset:6144
ds_read_b64_tr_b16 v[84:85], v9 offset:8192
v_mfma_f32_16x16x32_bf16 v[156:159], v[36:39], v[76:79], v[156:159]
buffer_load_dwordx4 v1, s[44:47], s72 offen offset:1024 sc1 lds
v_mfma_f32_16x16x32_bf16 v[152:155], v[36:39], v[72:75], v[152:155]
ds_read_b64_tr_b16 v[86:87], v9 offset:9216
v_mfma_f32_16x16x32_bf16 v[148:151], v[36:39], v[68:71], v[148:151]
ds_read_b64_tr_b16 v[88:89], v10 offset:8192
v_mfma_f32_16x16x32_bf16 v[144:147], v[36:39], v[64:67], v[144:147]
ds_read_b64_tr_b16 v[90:91], v10 offset:9216
v_mfma_f32_16x16x32_bf16 v[160:163], v[40:43], v[64:67], v[160:163]
ds_read_b64_tr_b16 v[92:93], v11 offset:8192
v_mfma_f32_16x16x32_bf16 v[164:167], v[40:43], v[68:71], v[164:167]
ds_read_b64_tr_b16 v[94:95], v11 offset:9216
v_mfma_f32_16x16x32_bf16 v[168:171], v[40:43], v[72:75], v[168:171]
ds_read_b64_tr_b16 v[96:97], v12 offset:8192
v_mfma_f32_16x16x32_bf16 v[172:175], v[40:43], v[76:79], v[172:175]
ds_read_b64_tr_b16 v[98:99], v12 offset:9216
v_mfma_f32_16x16x32_bf16 v[188:191], v[44:47], v[76:79], v[188:191]
buffer_load_dwordx4 v1, s[44:47], s72 offen offset:2048 sc1 lds
v_mfma_f32_16x16x32_bf16 v[184:187], v[44:47], v[72:75], v[184:187]
ds_read_b64_tr_b16 v[100:101], v13 offset:8192
v_mfma_f32_16x16x32_bf16 v[180:183], v[44:47], v[68:71], v[180:183]
ds_read_b64_tr_b16 v[102:103], v13 offset:9216
v_mfma_f32_16x16x32_bf16 v[176:179], v[44:47], v[64:67], v[176:179]
ds_read_b64_tr_b16 v[104:105], v14 offset:8192
v_mfma_f32_16x16x32_bf16 v[192:195], v[48:51], v[64:67], v[192:195]
ds_read_b64_tr_b16 v[106:107], v14 offset:9216
v_mfma_f32_16x16x32_bf16 v[196:199], v[48:51], v[68:71], v[196:199]
ds_read_b64_tr_b16 v[108:109], v15 offset:8192
v_mfma_f32_16x16x32_bf16 v[200:203], v[48:51], v[72:75], v[200:203]
ds_read_b64_tr_b16 v[110:111], v15 offset:9216
v_mfma_f32_16x16x32_bf16 v[204:207], v[48:51], v[76:79], v[204:207]
buffer_load_dwordx4 v1, s[44:47], s72 offen offset:3072 sc1 lds
v_mfma_f32_16x16x32_bf16 v[220:223], v[52:55], v[76:79], v[220:223]
v_mfma_f32_16x16x32_bf16 v[216:219], v[52:55], v[72:75], v[216:219]
v_mfma_f32_16x16x32_bf16 v[212:215], v[52:55], v[68:71], v[212:215]
v_mfma_f32_16x16x32_bf16 v[208:211], v[52:55], v[64:67], v[208:211]
v_mfma_f32_16x16x32_bf16 v[224:227], v[56:59], v[64:67], v[224:227]
v_mfma_f32_16x16x32_bf16 v[228:231], v[56:59], v[68:71], v[228:231]
v_mfma_f32_16x16x32_bf16 v[232:235], v[56:59], v[72:75], v[232:235]
v_mfma_f32_16x16x32_bf16 v[236:239], v[56:59], v[76:79], v[236:239]
v_mfma_f32_16x16x32_bf16 v[252:255], v[60:63], v[76:79], v[252:255]
v_mfma_f32_16x16x32_bf16 v[248:251], v[60:63], v[72:75], v[248:251]
v_mfma_f32_16x16x32_bf16 v[244:247], v[60:63], v[68:71], v[244:247]
s_waitcnt vmcnt(16) lgkmcnt(0)
v_mfma_f32_16x16x32_bf16 v[240:243], v[60:63], v[64:67], v[240:243]
s_barrier
v_mfma_f32_16x16x32_bf16 v[128:131], v[80:83], v[112:115], v[128:131]
ds_read_b128 a[128:131], v2 offset:16384
v_mfma_f32_16x16x32_bf16 v[132:135], v[80:83], v[116:119], v[132:135]
ds_read_b128 a[132:135], v2 offset:17408
v_mfma_f32_16x16x32_bf16 v[136:139], v[80:83], v[120:123], v[136:139]
ds_read_b128 a[136:139], v2 offset:18432
v_mfma_f32_16x16x32_bf16 v[140:143], v[80:83], v[124:127], v[140:143]
ds_read_b128 a[140:143], v2 offset:19456
v_mfma_f32_16x16x32_bf16 v[156:159], v[84:87], v[124:127], v[156:159]
ds_read_b128 a[144:147], v2 offset:20480
v_mfma_f32_16x16x32_bf16 v[152:155], v[84:87], v[120:123], v[152:155]
ds_read_b128 a[148:151], v2 offset:21504
v_mfma_f32_16x16x32_bf16 v[148:151], v[84:87], v[116:119], v[148:151]
ds_read_b128 a[152:155], v2 offset:22528
v_mfma_f32_16x16x32_bf16 v[144:147], v[84:87], v[112:115], v[144:147]
ds_read_b128 a[156:159], v2 offset:23552
v_mfma_f32_16x16x32_bf16 v[160:163], v[88:91], v[112:115], v[160:163]
v_mfma_f32_16x16x32_bf16 v[164:167], v[88:91], v[116:119], v[164:167]
v_mfma_f32_16x16x32_bf16 v[168:171], v[88:91], v[120:123], v[168:171]
v_mfma_f32_16x16x32_bf16 v[172:175], v[88:91], v[124:127], v[172:175]
v_mfma_f32_16x16x32_bf16 v[188:191], v[92:95], v[124:127], v[188:191]
v_cvt_pk_bf16_f32 v64, v140, v141
v_cvt_pk_bf16_f32 v65, v142, v143
v_mfma_f32_16x16x32_bf16 v[184:187], v[92:95], v[120:123], v[184:187]
v_cvt_pk_bf16_f32 v66, v156, v157
v_cvt_pk_bf16_f32 v67, v158, v159
v_mfma_f32_16x16x32_bf16 v[180:183], v[92:95], v[116:119], v[180:183]
v_cvt_pk_bf16_f32 v48, v136, v137
v_cvt_pk_bf16_f32 v49, v138, v139
v_mfma_f32_16x16x32_bf16 v[176:179], v[92:95], v[112:115], v[176:179]
v_cvt_pk_bf16_f32 v50, v152, v153
v_cvt_pk_bf16_f32 v51, v154, v155
v_mfma_f32_16x16x32_bf16 v[192:195], v[96:99], v[112:115], v[192:195]
v_cvt_pk_bf16_f32 v32, v132, v133
v_cvt_pk_bf16_f32 v33, v134, v135
v_mfma_f32_16x16x32_bf16 v[196:199], v[96:99], v[116:119], v[196:199]
v_cvt_pk_bf16_f32 v34, v148, v149
v_cvt_pk_bf16_f32 v35, v150, v151
v_mfma_f32_16x16x32_bf16 v[200:203], v[96:99], v[120:123], v[200:203]
v_cvt_pk_bf16_f32 v16, v128, v129
v_cvt_pk_bf16_f32 v17, v130, v131
v_mfma_f32_16x16x32_bf16 v[204:207], v[96:99], v[124:127], v[204:207]
v_cvt_pk_bf16_f32 v18, v144, v145
v_cvt_pk_bf16_f32 v19, v146, v147
v_mfma_f32_16x16x32_bf16 v[220:223], v[100:103], v[124:127], v[220:223]
v_cvt_pk_bf16_f32 v68, v172, v173
v_cvt_pk_bf16_f32 v69, v174, v175
v_mfma_f32_16x16x32_bf16 v[216:219], v[100:103], v[120:123], v[216:219]
v_cvt_pk_bf16_f32 v70, v188, v189
v_cvt_pk_bf16_f32 v71, v190, v191
v_mfma_f32_16x16x32_bf16 v[212:215], v[100:103], v[116:119], v[212:215]
v_cvt_pk_bf16_f32 v52, v168, v169
v_cvt_pk_bf16_f32 v53, v170, v171
v_mfma_f32_16x16x32_bf16 v[208:211], v[100:103], v[112:115], v[208:211]
v_cvt_pk_bf16_f32 v54, v184, v185
v_cvt_pk_bf16_f32 v55, v186, v187
v_mfma_f32_16x16x32_bf16 v[224:227], v[104:107], v[112:115], v[224:227]
v_cvt_pk_bf16_f32 v36, v164, v165
v_cvt_pk_bf16_f32 v37, v166, v167
v_mfma_f32_16x16x32_bf16 v[228:231], v[104:107], v[116:119], v[228:231]
v_cvt_pk_bf16_f32 v38, v180, v181
v_cvt_pk_bf16_f32 v39, v182, v183
v_mfma_f32_16x16x32_bf16 v[232:235], v[104:107], v[120:123], v[232:235]
v_cvt_pk_bf16_f32 v20, v160, v161
v_cvt_pk_bf16_f32 v21, v162, v163
v_mfma_f32_16x16x32_bf16 v[236:239], v[104:107], v[124:127], v[236:239]
v_cvt_pk_bf16_f32 v22, v176, v177
v_cvt_pk_bf16_f32 v23, v178, v179
v_mfma_f32_16x16x32_bf16 v[252:255], v[108:111], v[124:127], v[252:255]
v_cvt_pk_bf16_f32 v72, v204, v205
v_cvt_pk_bf16_f32 v73, v206, v207
v_mfma_f32_16x16x32_bf16 v[248:251], v[108:111], v[120:123], v[248:251]
v_cvt_pk_bf16_f32 v74, v220, v221
v_cvt_pk_bf16_f32 v75, v222, v223
v_mfma_f32_16x16x32_bf16 v[244:247], v[108:111], v[116:119], v[244:247]
v_cvt_pk_bf16_f32 v56, v200, v201
v_cvt_pk_bf16_f32 v57, v202, v203
v_mfma_f32_16x16x32_bf16 v[240:243], v[108:111], v[112:115], v[240:243]
v_cvt_pk_bf16_f32 v58, v216, v217
v_cvt_pk_bf16_f32 v59, v218, v219
v_cvt_pk_bf16_f32 v40, v196, v197
v_cvt_pk_bf16_f32 v41, v198, v199
v_cvt_pk_bf16_f32 v42, v212, v213
v_cvt_pk_bf16_f32 v43, v214, v215
v_cvt_pk_bf16_f32 v24, v192, v193
v_cvt_pk_bf16_f32 v25, v194, v195
v_cvt_pk_bf16_f32 v26, v208, v209
v_cvt_pk_bf16_f32 v27, v210, v211
v_cvt_pk_bf16_f32 v76, v236, v237
v_cvt_pk_bf16_f32 v77, v238, v239
v_cvt_pk_bf16_f32 v78, v252, v253
v_cvt_pk_bf16_f32 v79, v254, v255
v_cvt_pk_bf16_f32 v60, v232, v233
v_cvt_pk_bf16_f32 v61, v234, v235
v_cvt_pk_bf16_f32 v62, v248, v249
v_cvt_pk_bf16_f32 v63, v250, v251
v_cvt_pk_bf16_f32 v44, v228, v229
v_cvt_pk_bf16_f32 v45, v230, v231
v_cvt_pk_bf16_f32 v46, v244, v245
v_cvt_pk_bf16_f32 v47, v246, v247
v_cvt_pk_bf16_f32 v28, v224, v225
v_cvt_pk_bf16_f32 v29, v226, v227
v_cvt_pk_bf16_f32 v30, v240, v241
v_cvt_pk_bf16_f32 v31, v242, v243
v_mov_b32 v124, 0xff800000
v_mov_b32 v125, 0xff800000
v_mov_b32 v126, 0xff800000
v_mov_b32 v127, 0xff800000
s_lshl_b32 s84, s60, 2
s_add_u32 s84, s84, s58
s_mov_b32 s86, 0
s_add_u32 s61, s65, s60
s_and_b32 s73, s60, 1
s_lshl_b32 s73, s73, 16
s_add_u32 s77, s73, s64
s_xor_b32 s73, s73, 0x10000
s_add_u32 s92, s92, s73
s_mul_i32 s62, s58, 4608
s_add_u32 s62, s62, 143104
s_add_u32 s73, s73, 49920
s_cmp_eq_u32 s58, 0
s_cselect_b32 s62, s73, s62
s_mul_i32 s66, s58, 4160
s_sub_u32 s66, 143552, s66
Lattn:
s_mov_b32 s82, 0x10000
s_waitcnt lgkmcnt(0)
v_mfma_f32_16x16x32_bf16 v[136:139], a[128:131], v[48:51], 0
ds_read_b128 a[160:163], v2 offset:24576
v_lshrrev_b32 v240, 4, v0
v_mfma_f32_16x16x32_bf16 v[136:139], a[132:135], v[52:55], v[136:139]
ds_read_b128 a[164:167], v2 offset:25600
v_and_b32 v241, 15, v0
v_mfma_f32_16x16x32_bf16 v[136:139], a[136:139], v[56:59], v[136:139]
ds_read_b128 a[168:171], v2 offset:26624
v_lshlrev_b32 v240, 2, v240
v_mfma_f32_16x16x32_bf16 v[136:139], a[140:143], v[60:63], v[136:139]
ds_read_b128 a[172:175], v2 offset:27648
v_sub_u32 v240, v241, v240
v_mfma_f32_16x16x32_bf16 v[140:143], a[140:143], v[76:79], 0
ds_read_b128 a[176:179], v2 offset:28672
v_mov_b32 v112, 0xff800000
v_mfma_f32_16x16x32_bf16 v[140:143], a[136:139], v[72:75], v[140:143]
ds_read_b128 a[180:183], v2 offset:29696
v_mov_b32 v113, 0xff800000
v_mfma_f32_16x16x32_bf16 v[140:143], a[132:135], v[68:71], v[140:143]
ds_read_b128 a[184:187], v2 offset:30720
v_mov_b32 v114, 0xff800000
v_mfma_f32_16x16x32_bf16 v[140:143], a[128:131], v[64:67], v[140:143]
ds_read_b128 a[188:191], v2 offset:31744
v_mov_b32 v115, 0xff800000
v_mfma_f32_16x16x32_bf16 v[156:159], a[144:147], v[64:67], 0
v_cmp_gt_i32 vcc, 0, v240
v_mov_b32 v120, 0x3f803f80
v_mfma_f32_16x16x32_bf16 v[156:159], a[148:151], v[68:71], v[156:159]
v_cndmask_b32 v116, 0, v112, vcc
v_cmp_gt_i32 vcc, 1, v240
v_mfma_f32_16x16x32_bf16 v[156:159], a[152:155], v[72:75], v[156:159]
v_mov_b32 v121, 0x3f803f80
v_cndmask_b32 v117, 0, v112, vcc
v_mfma_f32_16x16x32_bf16 v[156:159], a[156:159], v[76:79], v[156:159]
v_cmp_gt_i32 vcc, 2, v240
v_mov_b32 v122, 0x3f803f80
v_mfma_f32_16x16x32_bf16 v[152:155], a[156:159], v[60:63], 0
v_cndmask_b32 v118, 0, v112, vcc
v_cmp_gt_i32 vcc, 3, v240
v_mfma_f32_16x16x32_bf16 v[152:155], a[152:155], v[56:59], v[152:155]
v_mov_b32 v123, 0x3f803f80
v_cndmask_b32 v119, 0, v112, vcc
v_mfma_f32_16x16x32_bf16 v[152:155], a[148:151], v[52:55], v[152:155]
v_mfma_f32_16x16x32_bf16 v[152:155], a[144:147], v[48:51], v[152:155]
s_cmp_eq_u32 s84, 0
s_cbranch_scc1 Lalt7
v_mfma_f32_16x16x32_bf16 v[128:131], a[128:131], v[16:19], 0
v_mfma_f32_16x16x32_bf16 v[132:135], a[128:131], v[32:35], 0
v_mfma_f32_16x16x32_bf16 v[144:147], a[144:147], v[16:19], 0
v_mfma_f32_16x16x32_bf16 v[148:151], a[144:147], v[32:35], 0
s_branch Ljoin8
Lalt7:
v_mfma_f32_16x16x32_bf16 v[128:131], a[128:131], v[16:19], v[116:119]
v_mfma_f32_16x16x32_bf16 v[132:135], a[128:131], v[32:35], 0
v_mfma_f32_16x16x32_bf16 v[144:147], a[144:147], v[16:19], v[112:115]
v_mfma_f32_16x16x32_bf16 v[148:151], a[144:147], v[32:35], v[116:119]
Ljoin8:
v_mfma_f32_16x16x32_bf16 v[128:131], a[132:135], v[20:23], v[128:131]
v_max3_f32 v240, v136, v137, v126
v_max3_f32 v242, v140, v141, v127
v_mfma_f32_16x16x32_bf16 v[128:131], a[136:139], v[24:27], v[128:131]
v_max3_f32 v240, v240, v138, v139
v_max3_f32 v242, v242, v142, v143
v_mfma_f32_16x16x32_bf16 v[128:131], a[140:143], v[28:31], v[128:131]
v_max3_f32 v240, v240, v152, v153
v_max3_f32 v242, v242, v156, v157
v_mfma_f32_16x16x32_bf16 v[132:135], a[140:143], v[44:47], v[132:135]
v_max3_f32 v240, v240, v154, v155
v_max3_f32 v242, v242, v158, v159
v_mfma_f32_16x16x32_bf16 v[132:135], a[136:139], v[40:43], v[132:135]
v_mov_b32 v241, v240
v_mov_b32 v243, v242
v_mfma_f32_16x16x32_bf16 v[132:135], a[132:135], v[36:39], v[132:135]
v_permlane16_swap_b32 v240, v241
v_permlane16_swap_b32 v242, v243
v_mfma_f32_16x16x32_bf16 v[148:151], a[148:151], v[36:39], v[148:151]
v_max_f32 v240, v240, v241
v_max_f32 v242, v242, v243
v_mfma_f32_16x16x32_bf16 v[148:151], a[152:155], v[40:43], v[148:151]
v_mov_b32 v241, v240
v_mov_b32 v243, v242
v_mfma_f32_16x16x32_bf16 v[148:151], a[156:159], v[44:47], v[148:151]
v_permlane32_swap_b32 v240, v241
v_permlane32_swap_b32 v242, v243
v_mfma_f32_16x16x32_bf16 v[144:147], a[156:159], v[28:31], v[144:147]
v_max_f32 v240, v240, v241
v_max_f32 v242, v242, v243
v_mfma_f32_16x16x32_bf16 v[144:147], a[152:155], v[24:27], v[144:147]
v_mfma_f32_16x16x32_bf16 v[144:147], a[148:151], v[20:23], v[144:147]
v_sub_f32 v88, 0, v240
v_sub_f32 v89, 0, v240
v_pk_add_f32 v[90:91], v[88:89], 0
v_pk_add_f32 v[104:105], v[116:117], v[88:89]
v_pk_add_f32 v[106:107], v[118:119], v[88:89]
v_pk_add_f32 v[136:137], v[136:137], v[88:89]
v_pk_add_f32 v[138:139], v[138:139], v[88:89]
v_pk_add_f32 v[152:153], v[152:153], v[88:89]
v_pk_add_f32 v[154:155], v[154:155], v[88:89]
v_sub_f32 v92, 0, v242
v_sub_f32 v93, 0, v242
v_pk_add_f32 v[94:95], v[92:93], 0
v_pk_add_f32 v[108:109], v[116:117], v[92:93]
v_pk_add_f32 v[110:111], v[118:119], v[92:93]
v_pk_add_f32 v[140:141], v[140:141], v[92:93]
v_pk_add_f32 v[142:143], v[142:143], v[92:93]
v_pk_add_f32 v[156:157], v[156:157], v[92:93]
v_pk_add_f32 v[158:159], v[158:159], v[92:93]
v_max3_f32 v240, v128, v129, v124
v_max3_f32 v242, v132, v133, v125
v_max3_f32 v240, v240, v130, v131
v_max3_f32 v242, v242, v134, v135
v_max3_f32 v240, v240, v144, v145
v_max3_f32 v242, v242, v148, v149
v_max3_f32 v240, v240, v146, v147
v_max3_f32 v242, v242, v150, v151
v_mov_b32 v241, v240
v_mov_b32 v243, v242
s_nop 0
v_permlane16_swap_b32 v240, v241
v_permlane16_swap_b32 v242, v243
v_max_f32 v240, v240, v241
v_max_f32 v242, v242, v243
v_mov_b32 v241, v240
v_mov_b32 v243, v242
s_nop 0
v_permlane32_swap_b32 v240, v241
v_permlane32_swap_b32 v242, v243
v_max_f32 v240, v240, v241
v_max_f32 v242, v242, v243
v_sub_f32 v80, 0, v240
v_sub_f32 v81, 0, v240
v_pk_add_f32 v[82:83], v[80:81], 0
v_pk_add_f32 v[96:97], v[116:117], v[80:81]
v_pk_add_f32 v[98:99], v[118:119], v[80:81]
v_pk_add_f32 v[128:129], v[128:129], v[80:81]
v_pk_add_f32 v[130:131], v[130:131], v[80:81]
v_pk_add_f32 v[144:145], v[144:145], v[80:81]
v_pk_add_f32 v[146:147], v[146:147], v[80:81]
v_sub_f32 v84, 0, v242
v_sub_f32 v85, 0, v242
v_pk_add_f32 v[86:87], v[84:85], 0
v_pk_add_f32 v[100:101], v[116:117], v[84:85]
v_pk_add_f32 v[102:103], v[118:119], v[84:85]
v_pk_add_f32 v[132:133], v[132:133], v[84:85]
v_pk_add_f32 v[134:135], v[134:135], v[84:85]
v_pk_add_f32 v[148:149], v[148:149], v[84:85]
v_pk_add_f32 v[150:151], v[150:151], v[84:85]
v_lshrrev_b32 v3, 1, v0
v_lshlrev_b32 v3, 7, v3
v_add_u32 v2, s82, v1
s_waitcnt vmcnt(8) lgkmcnt(0)
s_barrier
s_cmp_eq_u32 s84, 1
s_cbranch_scc1 Ltri10
s_cmp_gt_u32 s84, 1
s_cbranch_scc1 Lalt9
v_mfma_f32_16x16x32_bf16 v[160:163], a[160:163], v[16:19], v[112:115]
s_xor_b32 s74, s82, 0x10000
v_exp_f32 v128, v128
v_mfma_f32_16x16x32_bf16 v[164:167], a[160:163], v[32:35], v[112:115]
s_add_u32 s74, s74, s64
ds_read_b128 a[128:131], v2 offset:16384
ds_read_b128 a[132:135], v2 offset:17408
v_mfma_f32_16x16x32_bf16 v[176:179], a[176:179], v[16:19], v[112:115]
s_add_u32 s81, s81, 0x8000
v_exp_f32 v129, v129
v_mfma_f32_16x16x32_bf16 v[180:183], a[176:179], v[32:35], v[112:115]
s_add_u32 m0, s74, 16384
v_exp_f32 v130, v130
s_branch Ljoin11
Lalt9:
v_mfma_f32_16x16x32_bf16 v[160:163], a[160:163], v[16:19], v[80:83]
s_xor_b32 s74, s82, 0x10000
v_exp_f32 v128, v128
v_mfma_f32_16x16x32_bf16 v[164:167], a[160:163], v[32:35], v[84:87]
s_add_u32 s74, s74, s64
ds_read_b128 a[128:131], v2 offset:16384
ds_read_b128 a[132:135], v2 offset:17408
v_mfma_f32_16x16x32_bf16 v[176:179], a[176:179], v[16:19], v[80:83]
s_add_u32 s81, s81, 0x8000
v_exp_f32 v129, v129
v_mfma_f32_16x16x32_bf16 v[180:183], a[176:179], v[32:35], v[84:87]
s_add_u32 m0, s74, 16384
v_exp_f32 v130, v130
s_branch Ljoin11
Ltri10:
v_mfma_f32_16x16x32_bf16 v[160:163], a[160:163], v[16:19], v[96:99]
s_xor_b32 s74, s82, 0x10000
v_exp_f32 v128, v128
v_mfma_f32_16x16x32_bf16 v[164:167], a[160:163], v[32:35], v[84:87]
s_add_u32 s74, s74, s64
ds_read_b128 a[128:131], v2 offset:16384
ds_read_b128 a[132:135], v2 offset:17408
v_mfma_f32_16x16x32_bf16 v[176:179], a[176:179], v[16:19], v[112:115]
s_add_u32 s81, s81, 0x8000
v_exp_f32 v129, v129
v_mfma_f32_16x16x32_bf16 v[180:183], a[176:179], v[32:35], v[100:103]
s_add_u32 m0, s74, 16384
v_exp_f32 v130, v130
Ljoin11:
v_mfma_f32_16x16x32_bf16 v[160:163], a[164:167], v[20:23], v[160:163]
s_add_u32 s72, s81, 16384
v_exp_f32 v131, v131
v_mfma_f32_16x16x32_bf16 v[160:163], a[168:171], v[24:27], v[160:163]
v_exp_f32 v144, v144
v_mfma_f32_16x16x32_bf16 v[160:163], a[172:175], v[28:31], v[160:163]
ds_read_b128 a[136:139], v2 offset:18432
ds_read_b128 a[140:143], v2 offset:19456
v_mfma_f32_16x16x32_bf16 v[164:167], a[172:175], v[44:47], v[164:167]
ds_read_b128 a[144:147], v2 offset:20480
ds_read_b128 a[148:151], v2 offset:21504
v_mfma_f32_16x16x32_bf16 v[164:167], a[168:171], v[40:43], v[164:167]
ds_read_b128 a[152:155], v2 offset:22528
ds_read_b128 a[156:159], v2 offset:23552
v_mfma_f32_16x16x32_bf16 v[164:167], a[164:167], v[36:39], v[164:167]
ds_read_b128 a[192:195], v2 offset:0
ds_read_b128 a[196:199], v2 offset:1024
v_mfma_f32_16x16x32_bf16 v[168:171], a[160:163], v[48:51], v[88:91]
ds_read_b128 a[200:203], v2 offset:2048
ds_read_b128 a[204:207], v2 offset:3072
v_mfma_f32_16x16x32_bf16 v[168:171], a[164:167], v[52:55], v[168:171]
ds_read_b128 a[208:211], v2 offset:4096
ds_read_b128 a[212:215], v2 offset:5120
v_mfma_f32_16x16x32_bf16 v[168:171], a[168:171], v[56:59], v[168:171]
ds_read_b128 a[216:219], v2 offset:6144
ds_read_b128 a[220:223], v2 offset:7168
v_mfma_f32_16x16x32_bf16 v[168:171], a[172:175], v[60:63], v[168:171]
v_cvt_pk_bf16_f32 v192, v128, v129
v_cvt_pk_bf16_f32 v193, v130, v131
v_mfma_f32_16x16x32_bf16 v[172:175], a[172:175], v[76:79], v[92:95]
buffer_load_dwordx4 v1, s[44:47], s72 offen sc1 lds
v_mfma_f32_16x16x32_bf16 v[172:175], a[168:171], v[72:75], v[172:175]
v_exp_f32 v145, v145
v_mfma_f32_16x16x32_bf16 v[172:175], a[164:167], v[68:71], v[172:175]
v_exp_f32 v146, v146
v_mfma_f32_16x16x32_bf16 v[172:175], a[160:163], v[64:67], v[172:175]
v_exp_f32 v147, v147
v_mfma_f32_16x16x32_bf16 v[188:191], a[176:179], v[64:67], v[92:95]
Lstub0:
s_cbranch_execz Lstub4
v_exp_f32 v132, v132
v_mfma_f32_16x16x32_bf16 v[188:191], a[180:183], v[68:71], v[188:191]
v_cvt_pk_bf16_f32 v194, v144, v145
v_cvt_pk_bf16_f32 v195, v146, v147
v_mfma_f32_16x16x32_bf16 v[188:191], a[184:187], v[72:75], v[188:191]
v_exp_f32 v133, v133
v_mfma_f32_16x16x32_bf16 v[188:191], a[188:191], v[76:79], v[188:191]
v_exp_f32 v134, v134
v_mfma_f32_16x16x32_bf16 v[184:187], a[188:191], v[60:63], v[88:91]
v_exp_f32 v135, v135
v_mfma_f32_16x16x32_bf16 v[184:187], a[184:187], v[56:59], v[184:187]
v_exp_f32 v148, v148
v_mfma_f32_16x16x32_bf16 v[184:187], a[180:183], v[52:55], v[184:187]
v_cvt_pk_bf16_f32 v196, v132, v133
v_cvt_pk_bf16_f32 v197, v134, v135
v_mfma_f32_16x16x32_bf16 v[184:187], a[176:179], v[48:51], v[184:187]
buffer_load_dwordx4 v1, s[44:47], s72 offen offset:1024 sc1 lds
v_mfma_f32_16x16x32_bf16 v[180:183], a[180:183], v[36:39], v[180:183]
v_exp_f32 v149, v149
v_mfma_f32_16x16x32_bf16 v[180:183], a[184:187], v[40:43], v[180:183]
v_exp_f32 v150, v150
v_mfma_f32_16x16x32_bf16 v[180:183], a[188:191], v[44:47], v[180:183]
v_exp_f32 v151, v151
v_mfma_f32_16x16x32_bf16 v[176:179], a[188:191], v[28:31], v[176:179]
buffer_load_dwordx4 v1, s[44:47], s72 offen offset:2048 sc1 lds
v_mfma_f32_16x16x32_bf16 v[176:179], a[184:187], v[24:27], v[176:179]
buffer_load_dwordx4 v1, s[44:47], s72 offen offset:3072 sc1 lds
v_mfma_f32_16x16x32_bf16 v[176:179], a[180:183], v[20:23], v[176:179]
s_waitcnt lgkmcnt(8)
v_exp_f32 v136, v136
v_cvt_pk_bf16_f32 v198, v148, v149
v_cvt_pk_bf16_f32 v199, v150, v151
v_exp_f32 v137, v137
v_exp_f32 v138, v138
v_cvt_pk_bf16_f32 v200, v136, v137
v_exp_f32 v139, v139
v_exp_f32 v152, v152
v_cvt_pk_bf16_f32 v201, v138, v139
v_exp_f32 v153, v153
v_exp_f32 v154, v154
v_cvt_pk_bf16_f32 v202, v152, v153
v_exp_f32 v155, v155
v_exp_f32 v140, v140
v_cvt_pk_bf16_f32 v203, v154, v155
v_exp_f32 v141, v141
v_exp_f32 v142, v142
v_cvt_pk_bf16_f32 v204, v140, v141
v_exp_f32 v143, v143
v_exp_f32 v156, v156
v_cvt_pk_bf16_f32 v205, v142, v143
v_exp_f32 v157, v157
v_exp_f32 v158, v158
v_cvt_pk_bf16_f32 v206, v156, v157
v_exp_f32 v159, v159
s_nop 0
v_cvt_pk_bf16_f32 v207, v158, v159
s_cmp_eq_u32 s84, 2
s_cbranch_scc1 Ltri13
s_cmp_gt_u32 s84, 2
s_cbranch_scc1 Lalt12
v_mfma_f32_16x16x32_bf16 v[128:131], a[128:131], v[16:19], v[112:115]
s_add_u32 s82, s82, 0x8000
ds_read_b128 a[160:163], v2 offset:24576
v_mfma_f32_16x16x32_bf16 v[132:135], a[128:131], v[32:35], v[112:115]
s_and_b32 s82, s82, 0x1ffff
v_exp_f32 v160, v160
v_mfma_f32_16x16x32_bf16 v[144:147], a[144:147], v[16:19], v[112:115]
s_add_u32 m0, s74, 0
v_exp_f32 v161, v161
v_mfma_f32_16x16x32_bf16 v[148:151], a[144:147], v[32:35], v[112:115]
s_add_u32 s72, s81, 0
ds_read_b128 a[164:167], v2 offset:25600
v_cvt_pk_bf16_f32 v208, v160, v161
s_branch Ljoin14
Lalt12:
v_mfma_f32_16x16x32_bf16 v[128:131], a[128:131], v[16:19], v[80:83]
s_add_u32 s82, s82, 0x8000
ds_read_b128 a[160:163], v2 offset:24576
v_mfma_f32_16x16x32_bf16 v[132:135], a[128:131], v[32:35], v[84:87]
s_and_b32 s82, s82, 0x1ffff
v_exp_f32 v160, v160
v_mfma_f32_16x16x32_bf16 v[144:147], a[144:147], v[16:19], v[80:83]
s_add_u32 m0, s74, 0
v_exp_f32 v161, v161
v_mfma_f32_16x16x32_bf16 v[148:151], a[144:147], v[32:35], v[84:87]
s_add_u32 s72, s81, 0
ds_read_b128 a[164:167], v2 offset:25600
v_cvt_pk_bf16_f32 v208, v160, v161
s_branch Ljoin14
Ltri13:
v_mfma_f32_16x16x32_bf16 v[128:131], a[128:131], v[16:19], v[96:99]
s_add_u32 s82, s82, 0x8000
ds_read_b128 a[160:163], v2 offset:24576
v_mfma_f32_16x16x32_bf16 v[132:135], a[128:131], v[32:35], v[84:87]
s_and_b32 s82, s82, 0x1ffff
v_exp_f32 v160, v160
v_mfma_f32_16x16x32_bf16 v[144:147], a[144:147], v[16:19], v[112:115]
s_add_u32 m0, s74, 0
v_exp_f32 v161, v161
v_mfma_f32_16x16x32_bf16 v[148:151], a[144:147], v[32:35], v[100:103]
s_add_u32 s72, s81, 0
ds_read_b128 a[164:167], v2 offset:25600
v_cvt_pk_bf16_f32 v208, v160, v161
Ljoin14:
v_mfma_f32_16x16x32_bf16 v[128:131], a[132:135], v[20:23], v[128:131]
v_exp_f32 v162, v162
v_mfma_f32_16x16x32_bf16 v[128:131], a[136:139], v[24:27], v[128:131]
v_exp_f32 v163, v163
v_mfma_f32_16x16x32_bf16 v[128:131], a[140:143], v[28:31], v[128:131]
buffer_load_dwordx4 v1, s[44:47], s72 offen sc1 lds
v_mfma_f32_16x16x32_bf16 v[132:135], a[140:143], v[44:47], v[132:135]
ds_read_b128 a[168:171], v2 offset:26624
v_cvt_pk_bf16_f32 v209, v162, v163
v_mfma_f32_16x16x32_bf16 v[132:135], a[136:139], v[40:43], v[132:135]
v_exp_f32 v176, v176
v_mfma_f32_16x16x32_bf16 v[132:135], a[132:135], v[36:39], v[132:135]
v_exp_f32 v177, v177
v_mfma_f32_16x16x32_bf16 v[136:139], a[128:131], v[48:51], v[88:91]
ds_read_b128 a[172:175], v2 offset:27648
v_cvt_pk_bf16_f32 v210, v176, v177
v_mfma_f32_16x16x32_bf16 v[136:139], a[132:135], v[52:55], v[136:139]
v_exp_f32 v178, v178
v_mfma_f32_16x16x32_bf16 v[136:139], a[136:139], v[56:59], v[136:139]
v_exp_f32 v179, v179
v_mfma_f32_16x16x32_bf16 v[136:139], a[140:143], v[60:63], v[136:139]
ds_read_b128 a[176:179], v2 offset:28672
v_cvt_pk_bf16_f32 v211, v178, v179
v_mfma_f32_16x16x32_bf16 v[140:143], a[140:143], v[76:79], v[92:95]
v_exp_f32 v164, v164
v_mfma_f32_16x16x32_bf16 v[140:143], a[136:139], v[72:75], v[140:143]
v_exp_f32 v165, v165
v_mfma_f32_16x16x32_bf16 v[140:143], a[132:135], v[68:71], v[140:143]
ds_read_b128 a[180:183], v2 offset:29696
v_cvt_pk_bf16_f32 v212, v164, v165
v_mfma_f32_16x16x32_bf16 v[140:143], a[128:131], v[64:67], v[140:143]
v_exp_f32 v166, v166
v_mfma_f32_16x16x32_bf16 v[156:159], a[144:147], v[64:67], v[92:95]
buffer_load_dwordx4 v1, s[44:47], s72 offen offset:1024 sc1 lds
v_mfma_f32_16x16x32_bf16 v[156:159], a[148:151], v[68:71], v[156:159]
v_exp_f32 v167, v167
v_mfma_f32_16x16x32_bf16 v[156:159], a[152:155], v[72:75], v[156:159]
ds_read_b128 a[184:187], v2 offset:30720
v_cvt_pk_bf16_f32 v213, v166, v167
v_mfma_f32_16x16x32_bf16 v[156:159], a[156:159], v[76:79], v[156:159]
v_exp_f32 v180, v180
v_mfma_f32_16x16x32_bf16 v[152:155], a[156:159], v[60:63], v[88:91]
v_exp_f32 v181, v181
v_mfma_f32_16x16x32_bf16 v[152:155], a[152:155], v[56:59], v[152:155]
ds_read_b128 a[188:191], v2 offset:31744
v_cvt_pk_bf16_f32 v214, v180, v181
v_mfma_f32_16x16x32_bf16 v[152:155], a[148:151], v[52:55], v[152:155]
v_exp_f32 v182, v182
v_mfma_f32_16x16x32_bf16 v[152:155], a[144:147], v[48:51], v[152:155]
v_exp_f32 v183, v183
v_mfma_f32_16x16x32_bf16 v[148:151], a[148:151], v[36:39], v[148:151]
ds_read_b128 a[224:227], v2 offset:8192
v_cvt_pk_bf16_f32 v215, v182, v183
v_mfma_f32_16x16x32_bf16 v[148:151], a[152:155], v[40:43], v[148:151]
v_exp_f32 v168, v168
v_mfma_f32_16x16x32_bf16 v[148:151], a[156:159], v[44:47], v[148:151]
buffer_load_dwordx4 v1, s[44:47], s72 offen offset:2048 sc1 lds
v_mfma_f32_16x16x32_bf16 v[144:147], a[156:159], v[28:31], v[144:147]
v_exp_f32 v169, v169
v_mfma_f32_16x16x32_bf16 v[144:147], a[152:155], v[24:27], v[144:147]
ds_read_b128 a[228:231], v2 offset:9216
v_cvt_pk_bf16_f32 v216, v168, v169
v_mfma_f32_16x16x32_bf16 v[144:147], a[148:151], v[20:23], v[144:147]
s_waitcnt lgkmcnt(10)
v_exp_f32 v170, v170
v_mfma_f32_16x16x32_bf16 a[0:3], a[192:195], v[192:195], 0
v_exp_f32 v171, v171
v_mfma_f32_16x16x32_bf16 a[32:35], a[192:195], v[196:199], 0
ds_read_b128 a[232:235], v2 offset:10240
v_cvt_pk_bf16_f32 v217, v170, v171
v_mfma_f32_16x16x32_bf16 a[64:67], a[192:195], v[200:203], 0
v_exp_f32 v184, v184
v_mfma_f32_16x16x32_bf16 a[96:99], a[192:195], v[204:207], 0
v_exp_f32 v185, v185
v_mfma_f32_16x16x32_bf16 a[100:103], a[196:199], v[204:207], 0
ds_read_b128 a[236:239], v2 offset:11264
v_cvt_pk_bf16_f32 v218, v184, v185
v_mfma_f32_16x16x32_bf16 a[68:71], a[196:199], v[200:203], 0
v_exp_f32 v186, v186
v_mfma_f32_16x16x32_bf16 a[36:39], a[196:199], v[196:199], 0
buffer_load_dwordx4 v1, s[44:47], s72 offen offset:3072 sc1 lds
v_mfma_f32_16x16x32_bf16 a[4:7], a[196:199], v[192:195], 0
v_exp_f32 v187, v187
v_mfma_f32_16x16x32_bf16 a[8:11], a[200:203], v[192:195], 0
ds_read_b128 a[240:243], v2 offset:12288
v_cvt_pk_bf16_f32 v219, v186, v187
v_mfma_f32_16x16x32_bf16 a[40:43], a[200:203], v[196:199], 0
v_exp_f32 v172, v172
v_mfma_f32_16x16x32_bf16 a[72:75], a[200:203], v[200:203], 0
v_exp_f32 v173, v173
v_mfma_f32_16x16x32_bf16 a[104:107], a[200:203], v[204:207], 0
ds_read_b128 a[244:247], v2 offset:13312
v_cvt_pk_bf16_f32 v220, v172, v173
v_mfma_f32_16x16x32_bf16 a[108:111], a[204:207], v[204:207], 0
v_exp_f32 v174, v174
v_mfma_f32_16x16x32_bf16 a[76:79], a[204:207], v[200:203], 0
v_exp_f32 v175, v175
v_mfma_f32_16x16x32_bf16 a[44:47], a[204:207], v[196:199], 0
ds_read_b128 a[248:251], v2 offset:14336
v_cvt_pk_bf16_f32 v221, v174, v175
v_mfma_f32_16x16x32_bf16 a[12:15], a[204:207], v[192:195], 0
v_exp_f32 v188, v188
v_mfma_f32_16x16x32_bf16 a[16:19], a[208:211], v[192:195], 0
v_exp_f32 v189, v189
v_mfma_f32_16x16x32_bf16 a[48:51], a[208:211], v[196:199], 0
buffer_load_dword v4, v3, s[36:39], s93 offen
v_mfma_f32_16x16x32_bf16 a[80:83], a[208:211], v[200:203], 0
ds_read_b128 a[252:255], v2 offset:15360
v_cvt_pk_bf16_f32 v222, v188, v189
v_mfma_f32_16x16x32_bf16 a[112:115], a[208:211], v[204:207], 0
v_exp_f32 v190, v190
v_mfma_f32_16x16x32_bf16 a[116:119], a[212:215], v[204:207], 0
v_exp_f32 v191, v191
v_mfma_f32_16x16x32_bf16 a[84:87], a[212:215], v[200:203], 0
v_cvt_pk_bf16_f32 v223, v190, v191
v_add_u32 v2, s82, v1
v_mfma_f32_16x16x32_bf16 a[52:55], a[212:215], v[196:199], 0
v_and_b32 v240, 15, v0
v_lshrrev_b32 v241, 4, v0
v_mfma_f32_16x16x32_bf16 a[20:23], a[212:215], v[192:195], 0
v_add_u32 v248, 1, v240
v_and_b32 v249, 3, v248
v_mfma_f32_16x16x32_bf16 a[24:27], a[216:219], v[192:195], 0
v_lshrrev_b32 v248, 2, v248
v_mfma_f32_16x16x32_bf16 a[56:59], a[216:219], v[196:199], 0
s_sub_u32 s73, s92, 4160
v_mov_b32 v250, s66
v_max_u32 v6, 1, v249
v_mfma_f32_16x16x32_bf16 a[88:91], a[216:219], v[200:203], 0
v_cmp_ne_u32 vcc, 1, v249
v_mul_u32_u24 v6, 4160, v6
v_mfma_f32_16x16x32_bf16 a[120:123], a[216:219], v[204:207], 0
v_add_u32 v6, s73, v6
v_cndmask_b32 v6, v250, v6, vcc
v_mfma_f32_16x16x32_bf16 a[124:127], a[220:223], v[204:207], 0
v_bfe_u32 v251, v0, 2, 2
v_lshl_add_u32 v6, v248, 3, v6
v_mfma_f32_16x16x32_bf16 a[92:95], a[220:223], v[200:203], 0
v_lshl_add_u32 v6, v241, 4, v6
v_max_u32 v5, 1, v251
v_mfma_f32_16x16x32_bf16 a[60:63], a[220:223], v[196:199], 0
v_cmp_ne_u32 vcc, 1, v251
v_mul_u32_u24 v5, 4160, v5
v_mfma_f32_16x16x32_bf16 a[28:31], a[220:223], v[192:195], 0
v_add_u32 v5, s73, v5
v_cndmask_b32 v5, v250, v5, vcc
v_mfma_f32_16x16x32_bf16 v[224:227], v[120:123], v[192:195], 0
s_add_u32 s73, s62, 480
v_lshlrev_b32 v248, 5, v240
v_sub_u32 v248, s73, v248
v_mfma_f32_16x16x32_bf16 v[228:231], v[120:123], v[196:199], 0
v_lshl_add_u32 v7, v241, 4, v248
v_mfma_f32_16x16x32_bf16 v[232:235], v[120:123], v[200:203], 0
s_waitcnt vmcnt(9) lgkmcnt(8)
v_mfma_f32_16x16x32_bf16 v[236:239], v[120:123], v[204:207], 0
s_barrier
s_cmp_eq_u32 s60, 0
s_cbranch_scc1 LLT3
s_lshl_b32 s75, s59, 4
s_and_b32 s76, s84, 15
s_add_u32 s75, s75, s76
s_lshl_b32 s75, s75, 14
s_cmp_ge_u32 s60, 4
s_cselect_b32 s75, s75, 0x40001000
s_lshl_b32 s83, s60, 1
s_sub_u32 s83, 2, s83
s_cmp_eq_u32 s83, 0
s_cbranch_scc1 LLT1
.p2align 5
s_nop 0
s_nop 0
LloopI:
v_mfma_f32_16x16x32_bf16 v[160:163], a[160:163], v[16:19], v[80:83]
s_xor_b32 s74, s82, 0x10000
v_exp_f32 v128, v128
v_mfma_f32_16x16x32_bf16 v[160:163], a[164:167], v[20:23], v[160:163]
s_add_u32 s74, s74, s64
ds_read_b128 a[128:131], v2 offset:16384
v_mfma_f32_16x16x32_bf16 v[160:163], a[168:171], v[24:27], v[160:163]
s_add_u32 s81, s81, 0x8000
v_exp_f32 v129, v129
v_mfma_f32_16x16x32_bf16 v[160:163], a[172:175], v[28:31], v[160:163]
s_add_u32 m0, s74, 16384
v_exp_f32 v130, v130
v_mfma_f32_16x16x32_bf16 v[164:167], a[172:175], v[44:47], v[84:87]
s_add_u32 s72, s81, 16384
ds_read_b128 a[132:135], v2 offset:17408
v_cvt_pk_bf16_f32 v192, v128, v129
v_mfma_f32_16x16x32_bf16 v[164:167], a[168:171], v[40:43], v[164:167]
v_exp_f32 v131, v131
v_mfma_f32_16x16x32_bf16 v[164:167], a[164:167], v[36:39], v[164:167]
v_exp_f32 v144, v144
v_mfma_f32_16x16x32_bf16 v[164:167], a[160:163], v[32:35], v[164:167]
ds_read_b128 a[136:139], v2 offset:18432
v_cvt_pk_bf16_f32 v193, v130, v131
v_mfma_f32_16x16x32_bf16 v[168:171], a[160:163], v[48:51], v[88:91]
buffer_load_dwordx4 v1, s[44:47], s72 offen sc1 lds
v_mfma_f32_16x16x32_bf16 v[168:171], a[164:167], v[52:55], v[168:171]
v_exp_f32 v145, v145
v_mfma_f32_16x16x32_bf16 v[168:171], a[168:171], v[56:59], v[168:171]
v_exp_f32 v146, v146
v_mfma_f32_16x16x32_bf16 v[168:171], a[172:175], v[60:63], v[168:171]
ds_read_b128 a[140:143], v2 offset:19456
v_cvt_pk_bf16_f32 v194, v144, v145
v_mfma_f32_16x16x32_bf16 v[172:175], a[172:175], v[76:79], v[92:95]
v_exp_f32 v147, v147
v_mfma_f32_16x16x32_bf16 v[172:175], a[168:171], v[72:75], v[172:175]
v_exp_f32 v132, v132
v_mfma_f32_16x16x32_bf16 v[172:175], a[164:167], v[68:71], v[172:175]
ds_read_b128 a[144:147], v2 offset:20480
v_cvt_pk_bf16_f32 v195, v146, v147
v_mfma_f32_16x16x32_bf16 v[172:175], a[160:163], v[64:67], v[172:175]
v_exp_f32 v133, v133
v_mfma_f32_16x16x32_bf16 v[188:191], a[176:179], v[64:67], v[92:95]
v_exp_f32 v134, v134
v_mfma_f32_16x16x32_bf16 v[188:191], a[180:183], v[68:71], v[188:191]
ds_read_b128 a[148:151], v2 offset:21504
v_cvt_pk_bf16_f32 v196, v132, v133
v_mfma_f32_16x16x32_bf16 v[188:191], a[184:187], v[72:75], v[188:191]
v_exp_f32 v135, v135
v_mfma_f32_16x16x32_bf16 v[188:191], a[188:191], v[76:79], v[188:191]
v_exp_f32 v148, v148
v_mfma_f32_16x16x32_bf16 v[184:187], a[188:191], v[60:63], v[88:91]
ds_read_b128 a[152:155], v2 offset:22528
v_cvt_pk_bf16_f32 v197, v134, v135
v_mfma_f32_16x16x32_bf16 v[184:187], a[184:187], v[56:59], v[184:187]
buffer_load_dwordx4 v1, s[44:47], s72 offen offset:1024 sc1 lds
v_mfma_f32_16x16x32_bf16 v[184:187], a[180:183], v[52:55], v[184:187]
v_exp_f32 v149, v149
v_mfma_f32_16x16x32_bf16 v[184:187], a[176:179], v[48:51], v[184:187]
v_exp_f32 v150, v150
v_mfma_f32_16x16x32_bf16 v[180:183], a[176:179], v[32:35], v[84:87]
ds_read_b128 a[156:159], v2 offset:23552
v_cvt_pk_bf16_f32 v198, v148, v149
v_mfma_f32_16x16x32_bf16 v[180:183], a[180:183], v[36:39], v[180:183]
v_exp_f32 v151, v151
v_mfma_f32_16x16x32_bf16 v[180:183], a[184:187], v[40:43], v[180:183]
v_exp_f32 v136, v136
v_mfma_f32_16x16x32_bf16 v[180:183], a[188:191], v[44:47], v[180:183]
ds_read_b128 a[192:195], v2 offset:0
v_cvt_pk_bf16_f32 v199, v150, v151
v_mfma_f32_16x16x32_bf16 v[176:179], a[188:191], v[28:31], v[80:83]
v_exp_f32 v137, v137
v_mfma_f32_16x16x32_bf16 v[176:179], a[184:187], v[24:27], v[176:179]
v_exp_f32 v138, v138
v_mfma_f32_16x16x32_bf16 v[176:179], a[180:183], v[20:23], v[176:179]
ds_read_b128 a[196:199], v2 offset:1024
v_cvt_pk_bf16_f32 v200, v136, v137
v_mfma_f32_16x16x32_bf16 v[176:179], a[176:179], v[16:19], v[176:179]
s_waitcnt lgkmcnt(10)
v_exp_f32 v139, v139
v_mfma_f32_16x16x32_bf16 a[0:3], a[224:227], v[208:211], a[0:3]
v_exp_f32 v152, v152
v_mfma_f32_16x16x32_bf16 a[32:35], a[224:227], v[212:215], a[32:35]
ds_read_b128 a[200:203], v2 offset:2048
v_cvt_pk_bf16_f32 v201, v138, v139
v_mfma_f32_16x16x32_bf16 a[64:67], a[224:227], v[216:219], a[64:67]
buffer_load_dwordx4 v1, s[44:47], s72 offen offset:2048 sc1 lds
v_mfma_f32_16x16x32_bf16 a[96:99], a[224:227], v[220:223], a[96:99]
v_exp_f32 v153, v153
v_mfma_f32_16x16x32_bf16 a[100:103], a[228:231], v[220:223], a[100:103]
v_exp_f32 v154, v154
v_mfma_f32_16x16x32_bf16 a[68:71], a[228:231], v[216:219], a[68:71]
ds_read_b128 a[204:207], v2 offset:3072
v_cvt_pk_bf16_f32 v202, v152, v153
v_mfma_f32_16x16x32_bf16 a[36:39], a[228:231], v[212:215], a[36:39]
v_exp_f32 v155, v155
v_mfma_f32_16x16x32_bf16 a[4:7], a[228:231], v[208:211], a[4:7]
v_exp_f32 v140, v140
v_mfma_f32_16x16x32_bf16 a[8:11], a[232:235], v[208:211], a[8:11]
ds_read_b128 a[208:211], v2 offset:4096
v_cvt_pk_bf16_f32 v203, v154, v155
v_mfma_f32_16x16x32_bf16 a[40:43], a[232:235], v[212:215], a[40:43]
v_exp_f32 v141, v141
v_mfma_f32_16x16x32_bf16 a[72:75], a[232:235], v[216:219], a[72:75]
v_exp_f32 v142, v142
v_mfma_f32_16x16x32_bf16 a[104:107], a[232:235], v[220:223], a[104:107]
ds_read_b128 a[212:215], v2 offset:5120
v_cvt_pk_bf16_f32 v204, v140, v141
v_mfma_f32_16x16x32_bf16 a[108:111], a[236:239], v[220:223], a[108:111]
v_exp_f32 v143, v143
v_mfma_f32_16x16x32_bf16 a[76:79], a[236:239], v[216:219], a[76:79]
v_exp_f32 v156, v156
v_mfma_f32_16x16x32_bf16 a[44:47], a[236:239], v[212:215], a[44:47]
ds_read_b128 a[216:219], v2 offset:6144
v_cvt_pk_bf16_f32 v205, v142, v143
v_mfma_f32_16x16x32_bf16 a[12:15], a[236:239], v[208:211], a[12:15]
buffer_load_dwordx4 v1, s[44:47], s72 offen offset:3072 sc1 lds
v_mfma_f32_16x16x32_bf16 a[16:19], a[240:243], v[208:211], a[16:19]
v_exp_f32 v157, v157
v_mfma_f32_16x16x32_bf16 a[48:51], a[240:243], v[212:215], a[48:51]
v_exp_f32 v158, v158
v_mfma_f32_16x16x32_bf16 a[80:83], a[240:243], v[216:219], a[80:83]
ds_read_b128 a[220:223], v2 offset:7168
v_cvt_pk_bf16_f32 v206, v156, v157
v_mfma_f32_16x16x32_bf16 a[112:115], a[240:243], v[220:223], a[112:115]
v_exp_f32 v159, v159
v_mfma_f32_16x16x32_bf16 a[116:119], a[244:247], v[220:223], a[116:119]
v_cvt_pk_bf16_f32 v207, v158, v159
v_add_u32 v15, s75, v3
v_mfma_f32_16x16x32_bf16 a[84:87], a[244:247], v[216:219], a[84:87]
v_mfma_f32_16x16x32_bf16 a[52:55], a[244:247], v[212:215], a[52:55]
v_mfma_f32_16x16x32_bf16 a[20:23], a[244:247], v[208:211], a[20:23]
v_mfma_f32_16x16x32_bf16 a[24:27], a[248:251], v[208:211], a[24:27]
v_mfma_f32_16x16x32_bf16 a[56:59], a[248:251], v[212:215], a[56:59]
v_mfma_f32_16x16x32_bf16 a[88:91], a[248:251], v[216:219], a[88:91]
v_mfma_f32_16x16x32_bf16 a[120:123], a[248:251], v[220:223], a[120:123]
v_mfma_f32_16x16x32_bf16 a[124:127], a[252:255], v[220:223], a[124:127]
v_mfma_f32_16x16x32_bf16 a[92:95], a[252:255], v[216:219], a[92:95]
v_mfma_f32_16x16x32_bf16 a[60:63], a[252:255], v[212:215], a[60:63]
v_mfma_f32_16x16x32_bf16 a[28:31], a[252:255], v[208:211], a[28:31]
v_mfma_f32_16x16x32_bf16 v[224:227], v[120:123], v[208:211], v[224:227]
v_mfma_f32_16x16x32_bf16 v[228:231], v[120:123], v[212:215], v[228:231]
v_mfma_f32_16x16x32_bf16 v[232:235], v[120:123], v[216:219], v[232:235]
v_mfma_f32_16x16x32_bf16 v[236:239], v[120:123], v[220:223], v[236:239]
s_waitcnt lgkmcnt(8)
v_mfma_f32_16x16x32_bf16 v[128:131], a[128:131], v[16:19], v[80:83]
s_add_u32 s82, s82, 0x8000
ds_read_b128 a[160:163], v2 offset:24576
v_mfma_f32_16x16x32_bf16 v[128:131], a[132:135], v[20:23], v[128:131]
s_and_b32 s82, s82, 0x1ffff
v_exp_f32 v160, v160
v_mfma_f32_16x16x32_bf16 v[128:131], a[136:139], v[24:27], v[128:131]
s_add_u32 m0, s74, 0
v_exp_f32 v161, v161
v_mfma_f32_16x16x32_bf16 v[128:131], a[140:143], v[28:31], v[128:131]
s_add_u32 s72, s81, 0
ds_read_b128 a[164:167], v2 offset:25600
v_cvt_pk_bf16_f32 v208, v160, v161
v_mfma_f32_16x16x32_bf16 v[132:135], a[140:143], v[44:47], v[84:87]
v_exp_f32 v162, v162
v_mfma_f32_16x16x32_bf16 v[132:135], a[136:139], v[40:43], v[132:135]
v_exp_f32 v163, v163
v_mfma_f32_16x16x32_bf16 v[132:135], a[132:135], v[36:39], v[132:135]
buffer_load_dwordx4 v1, s[44:47], s72 offen sc1 lds
v_mfma_f32_16x16x32_bf16 v[132:135], a[128:131], v[32:35], v[132:135]
ds_read_b128 a[168:171], v2 offset:26624
v_cvt_pk_bf16_f32 v209, v162, v163
v_mfma_f32_16x16x32_bf16 v[136:139], a[128:131], v[48:51], v[88:91]
v_exp_f32 v176, v176
v_mfma_f32_16x16x32_bf16 v[136:139], a[132:135], v[52:55], v[136:139]
v_exp_f32 v177, v177
v_mfma_f32_16x16x32_bf16 v[136:139], a[136:139], v[56:59], v[136:139]
ds_read_b128 a[172:175], v2 offset:27648
v_cvt_pk_bf16_f32 v210, v176, v177
v_mfma_f32_16x16x32_bf16 v[136:139], a[140:143], v[60:63], v[136:139]
v_exp_f32 v178, v178
v_mfma_f32_16x16x32_bf16 v[140:143], a[140:143], v[76:79], v[92:95]
v_exp_f32 v179, v179
v_mfma_f32_16x16x32_bf16 v[140:143], a[136:139], v[72:75], v[140:143]
ds_read_b128 a[176:179], v2 offset:28672
v_cvt_pk_bf16_f32 v211, v178, v179
v_mfma_f32_16x16x32_bf16 v[140:143], a[132:135], v[68:71], v[140:143]
v_exp_f32 v164, v164
v_mfma_f32_16x16x32_bf16 v[140:143], a[128:131], v[64:67], v[140:143]
v_exp_f32 v165, v165
v_mfma_f32_16x16x32_bf16 v[156:159], a[144:147], v[64:67], v[92:95]
ds_read_b128 a[180:183], v2 offset:29696
v_cvt_pk_bf16_f32 v212, v164, v165
v_mfma_f32_16x16x32_bf16 v[156:159], a[148:151], v[68:71], v[156:159]
buffer_load_dwordx4 v1, s[44:47], s72 offen offset:1024 sc1 lds
v_mfma_f32_16x16x32_bf16 v[156:159], a[152:155], v[72:75], v[156:159]
v_exp_f32 v166, v166
v_mfma_f32_16x16x32_bf16 v[156:159], a[156:159], v[76:79], v[156:159]
v_exp_f32 v167, v167
v_mfma_f32_16x16x32_bf16 v[152:155], a[156:159], v[60:63], v[88:91]
ds_read_b128 a[184:187], v2 offset:30720
v_cvt_pk_bf16_f32 v213, v166, v167
v_mfma_f32_16x16x32_bf16 v[152:155], a[152:155], v[56:59], v[152:155]
v_exp_f32 v180, v180
v_mfma_f32_16x16x32_bf16 v[152:155], a[148:151], v[52:55], v[152:155]
v_exp_f32 v181, v181
v_mfma_f32_16x16x32_bf16 v[152:155], a[144:147], v[48:51], v[152:155]
ds_read_b128 a[188:191], v2 offset:31744
v_cvt_pk_bf16_f32 v214, v180, v181
v_mfma_f32_16x16x32_bf16 v[148:151], a[144:147], v[32:35], v[84:87]
v_exp_f32 v182, v182
v_mfma_f32_16x16x32_bf16 v[148:151], a[148:151], v[36:39], v[148:151]
v_exp_f32 v183, v183
v_mfma_f32_16x16x32_bf16 v[148:151], a[152:155], v[40:43], v[148:151]
ds_read_b128 a[224:227], v2 offset:8192
v_cvt_pk_bf16_f32 v215, v182, v183
v_mfma_f32_16x16x32_bf16 v[148:151], a[156:159], v[44:47], v[148:151]
v_exp_f32 v168, v168
v_mfma_f32_16x16x32_bf16 v[144:147], a[156:159], v[28:31], v[80:83]
buffer_load_dwordx4 v1, s[44:47], s72 offen offset:2048 sc1 lds
v_mfma_f32_16x16x32_bf16 v[144:147], a[152:155], v[24:27], v[144:147]
v_exp_f32 v169, v169
v_mfma_f32_16x16x32_bf16 v[144:147], a[148:151], v[20:23], v[144:147]
ds_read_b128 a[228:231], v2 offset:9216
v_cvt_pk_bf16_f32 v216, v168, v169
v_mfma_f32_16x16x32_bf16 v[144:147], a[144:147], v[16:19], v[144:147]
s_waitcnt lgkmcnt(10)
v_exp_f32 v170, v170
v_mfma_f32_16x16x32_bf16 a[0:3], a[192:195], v[192:195], a[0:3]
v_exp_f32 v171, v171
v_mfma_f32_16x16x32_bf16 a[32:35], a[192:195], v[196:199], a[32:35]
ds_read_b128 a[232:235], v2 offset:10240
v_cvt_pk_bf16_f32 v217, v170, v171
v_mfma_f32_16x16x32_bf16 a[64:67], a[192:195], v[200:203], a[64:67]
v_exp_f32 v184, v184
v_mfma_f32_16x16x32_bf16 a[96:99], a[192:195], v[204:207], a[96:99]
v_exp_f32 v185, v185
v_mfma_f32_16x16x32_bf16 a[100:103], a[196:199], v[204:207], a[100:103]
ds_read_b128 a[236:239], v2 offset:11264
v_cvt_pk_bf16_f32 v218, v184, v185
v_mfma_f32_16x16x32_bf16 a[68:71], a[196:199], v[200:203], a[68:71]
v_exp_f32 v186, v186
v_mfma_f32_16x16x32_bf16 a[36:39], a[196:199], v[196:199], a[36:39]
buffer_load_dwordx4 v1, s[44:47], s72 offen offset:3072 sc1 lds
v_mfma_f32_16x16x32_bf16 a[4:7], a[196:199], v[192:195], a[4:7]
s_add_u32 s75, s75, 0x1000
v_exp_f32 v187, v187
v_mfma_f32_16x16x32_bf16 a[8:11], a[200:203], v[192:195], a[8:11]
s_and_b32 s76, s75, 0x3000
ds_read_b128 a[240:243], v2 offset:12288
v_cvt_pk_bf16_f32 v219, v186, v187
v_mfma_f32_16x16x32_bf16 a[40:43], a[200:203], v[196:199], a[40:43]
s_cselect_b32 s75, s75, 0x40001000
v_exp_f32 v172, v172
v_mfma_f32_16x16x32_bf16 a[72:75], a[200:203], v[200:203], a[72:75]
v_exp_f32 v173, v173
v_mfma_f32_16x16x32_bf16 a[104:107], a[200:203], v[204:207], a[104:107]
ds_read_b128 a[244:247], v2 offset:13312
v_cvt_pk_bf16_f32 v220, v172, v173
v_mfma_f32_16x16x32_bf16 a[108:111], a[204:207], v[204:207], a[108:111]
v_exp_f32 v174, v174
v_mfma_f32_16x16x32_bf16 a[76:79], a[204:207], v[200:203], a[76:79]
v_exp_f32 v175, v175
v_mfma_f32_16x16x32_bf16 a[44:47], a[204:207], v[196:199], a[44:47]
ds_read_b128 a[248:251], v2 offset:14336
v_cvt_pk_bf16_f32 v221, v174, v175
v_mfma_f32_16x16x32_bf16 a[12:15], a[204:207], v[192:195], a[12:15]
v_exp_f32 v188, v188
v_mfma_f32_16x16x32_bf16 a[16:19], a[208:211], v[192:195], a[16:19]
buffer_load_dword v4, v15, s[24:27], 0 offen
v_mfma_f32_16x16x32_bf16 a[48:51], a[208:211], v[196:199], a[48:51]
v_exp_f32 v189, v189
v_mfma_f32_16x16x32_bf16 a[80:83], a[208:211], v[200:203], a[80:83]
ds_read_b128 a[252:255], v2 offset:15360
v_cvt_pk_bf16_f32 v222, v188, v189
v_mfma_f32_16x16x32_bf16 a[112:115], a[208:211], v[204:207], a[112:115]
v_exp_f32 v190, v190
v_mfma_f32_16x16x32_bf16 a[116:119], a[212:215], v[204:207], a[116:119]
v_exp_f32 v191, v191
v_mfma_f32_16x16x32_bf16 a[84:87], a[212:215], v[200:203], a[84:87]
v_cvt_pk_bf16_f32 v223, v190, v191
v_add_u32 v2, s82, v1
v_mfma_f32_16x16x32_bf16 a[52:55], a[212:215], v[196:199], a[52:55]
v_mfma_f32_16x16x32_bf16 a[20:23], a[212:215], v[192:195], a[20:23]
v_mfma_f32_16x16x32_bf16 a[24:27], a[216:219], v[192:195], a[24:27]
v_mfma_f32_16x16x32_bf16 a[56:59], a[216:219], v[196:199], a[56:59]
v_mfma_f32_16x16x32_bf16 a[88:91], a[216:219], v[200:203], a[88:91]
v_mfma_f32_16x16x32_bf16 a[120:123], a[216:219], v[204:207], a[120:123]
v_mfma_f32_16x16x32_bf16 a[124:127], a[220:223], v[204:207], a[124:127]
v_mfma_f32_16x16x32_bf16 a[92:95], a[220:223], v[200:203], a[92:95]
v_mfma_f32_16x16x32_bf16 a[60:63], a[220:223], v[196:199], a[60:63]
v_mfma_f32_16x16x32_bf16 a[28:31], a[220:223], v[192:195], a[28:31]
v_mfma_f32_16x16x32_bf16 v[224:227], v[120:123], v[192:195], v[224:227]
s_waitcnt vmcnt(9) lgkmcnt(8)
v_mfma_f32_16x16x32_bf16 v[228:231], v[120:123], v[196:199], v[228:231]
s_barrier
v_mfma_f32_16x16x32_bf16 v[232:235], v[120:123], v[200:203], v[232:235]
s_add_u32 s83, s83, 1
v_mfma_f32_16x16x32_bf16 v[236:239], v[120:123], v[204:207], v[236:239]
s_cbranch_scc0 LloopI
LLT1:
v_mfma_f32_16x16x32_bf16 v[160:163], a[160:163], v[16:19], v[80:83]
s_xor_b32 s74, s82, 0x10000
v_exp_f32 v128, v128
v_mfma_f32_16x16x32_bf16 v[160:163], a[164:167], v[20:23], v[160:163]
s_add_u32 s74, s74, s64
ds_read_b128 a[128:131], v2 offset:16384
v_mfma_f32_16x16x32_bf16 v[160:163], a[168:171], v[24:27], v[160:163]
s_add_u32 s81, s81, 0x8000
v_exp_f32 v129, v129
v_mfma_f32_16x16x32_bf16 v[160:163], a[172:175], v[28:31], v[160:163]
s_add_u32 m0, s74, 16384
v_exp_f32 v130, v130
v_mfma_f32_16x16x32_bf16 v[164:167], a[172:175], v[44:47], v[84:87]
s_add_u32 s72, s81, 16384
ds_read_b128 a[132:135], v2 offset:17408
v_cvt_pk_bf16_f32 v192, v128, v129
v_mfma_f32_16x16x32_bf16 v[164:167], a[168:171], v[40:43], v[164:167]
v_exp_f32 v131, v131
v_mfma_f32_16x16x32_bf16 v[164:167], a[164:167], v[36:39], v[164:167]
v_exp_f32 v144, v144
v_mfma_f32_16x16x32_bf16 v[164:167], a[160:163], v[32:35], v[164:167]
ds_read_b128 a[136:139], v2 offset:18432
v_cvt_pk_bf16_f32 v193, v130, v131
v_mfma_f32_16x16x32_bf16 v[168:171], a[160:163], v[48:51], v[88:91]
buffer_load_dwordx4 v1, s[44:47], s72 offen sc1 lds
v_mfma_f32_16x16x32_bf16 v[168:171], a[164:167], v[52:55], v[168:171]
v_exp_f32 v145, v145
v_mfma_f32_16x16x32_bf16 v[168:171], a[168:171], v[56:59], v[168:171]
v_exp_f32 v146, v146
v_mfma_f32_16x16x32_bf16 v[168:171], a[172:175], v[60:63], v[168:171]
ds_read_b128 a[140:143], v2 offset:19456
v_cvt_pk_bf16_f32 v194, v144, v145
v_mfma_f32_16x16x32_bf16 v[172:175], a[172:175], v[76:79], v[92:95]
v_exp_f32 v147, v147
v_mfma_f32_16x16x32_bf16 v[172:175], a[168:171], v[72:75], v[172:175]
v_exp_f32 v132, v132
v_mfma_f32_16x16x32_bf16 v[172:175], a[164:167], v[68:71], v[172:175]
ds_read_b128 a[144:147], v2 offset:20480
v_cvt_pk_bf16_f32 v195, v146, v147
v_mfma_f32_16x16x32_bf16 v[172:175], a[160:163], v[64:67], v[172:175]
Lstub1:
s_cbranch_execz Lstub5
v_exp_f32 v133, v133
v_mfma_f32_16x16x32_bf16 v[188:191], a[176:179], v[64:67], v[92:95]
v_exp_f32 v134, v134
v_mfma_f32_16x16x32_bf16 v[188:191], a[180:183], v[68:71], v[188:191]
ds_read_b128 a[148:151], v2 offset:21504
v_cvt_pk_bf16_f32 v196, v132, v133
v_mfma_f32_16x16x32_bf16 v[188:191], a[184:187], v[72:75], v[188:191]
v_exp_f32 v135, v135
v_mfma_f32_16x16x32_bf16 v[188:191], a[188:191], v[76:79], v[188:191]
v_exp_f32 v148, v148
v_mfma_f32_16x16x32_bf16 v[184:187], a[188:191], v[60:63], v[88:91]
ds_read_b128 a[152:155], v2 offset:22528
v_cvt_pk_bf16_f32 v197, v134, v135
v_mfma_f32_16x16x32_bf16 v[184:187], a[184:187], v[56:59], v[184:187]
buffer_load_dwordx4 v1, s[44:47], s72 offen offset:1024 sc1 lds
v_mfma_f32_16x16x32_bf16 v[184:187], a[180:183], v[52:55], v[184:187]
v_exp_f32 v149, v149
v_mfma_f32_16x16x32_bf16 v[184:187], a[176:179], v[48:51], v[184:187]
v_exp_f32 v150, v150
v_mfma_f32_16x16x32_bf16 v[180:183], a[176:179], v[32:35], v[84:87]
ds_read_b128 a[156:159], v2 offset:23552
v_cvt_pk_bf16_f32 v198, v148, v149
v_mfma_f32_16x16x32_bf16 v[180:183], a[180:183], v[36:39], v[180:183]
v_exp_f32 v151, v151
v_mfma_f32_16x16x32_bf16 v[180:183], a[184:187], v[40:43], v[180:183]
v_exp_f32 v136, v136
v_mfma_f32_16x16x32_bf16 v[180:183], a[188:191], v[44:47], v[180:183]
ds_read_b128 a[192:195], v2 offset:0
v_cvt_pk_bf16_f32 v199, v150, v151
v_mfma_f32_16x16x32_bf16 v[176:179], a[188:191], v[28:31], v[80:83]
v_exp_f32 v137, v137
v_mfma_f32_16x16x32_bf16 v[176:179], a[184:187], v[24:27], v[176:179]
v_exp_f32 v138, v138
v_mfma_f32_16x16x32_bf16 v[176:179], a[180:183], v[20:23], v[176:179]
ds_read_b128 a[196:199], v2 offset:1024
v_cvt_pk_bf16_f32 v200, v136, v137
v_mfma_f32_16x16x32_bf16 v[176:179], a[176:179], v[16:19], v[176:179]
s_waitcnt lgkmcnt(10)
v_exp_f32 v139, v139
v_mfma_f32_16x16x32_bf16 a[0:3], a[224:227], v[208:211], a[0:3]
v_exp_f32 v152, v152
v_mfma_f32_16x16x32_bf16 a[32:35], a[224:227], v[212:215], a[32:35]
ds_read_b128 a[200:203], v2 offset:2048
v_cvt_pk_bf16_f32 v201, v138, v139
v_mfma_f32_16x16x32_bf16 a[64:67], a[224:227], v[216:219], a[64:67]
buffer_load_dwordx4 v1, s[44:47], s72 offen offset:2048 sc1 lds
v_mfma_f32_16x16x32_bf16 a[96:99], a[224:227], v[220:223], a[96:99]
v_exp_f32 v153, v153
v_mfma_f32_16x16x32_bf16 a[100:103], a[228:231], v[220:223], a[100:103]
v_exp_f32 v154, v154
v_mfma_f32_16x16x32_bf16 a[68:71], a[228:231], v[216:219], a[68:71]
ds_read_b128 a[204:207], v2 offset:3072
v_cvt_pk_bf16_f32 v202, v152, v153
v_mfma_f32_16x16x32_bf16 a[36:39], a[228:231], v[212:215], a[36:39]
v_exp_f32 v155, v155
v_mfma_f32_16x16x32_bf16 a[4:7], a[228:231], v[208:211], a[4:7]
v_exp_f32 v140, v140
v_mfma_f32_16x16x32_bf16 a[8:11], a[232:235], v[208:211], a[8:11]
ds_read_b128 a[208:211], v2 offset:4096
v_cvt_pk_bf16_f32 v203, v154, v155
v_mfma_f32_16x16x32_bf16 a[40:43], a[232:235], v[212:215], a[40:43]
v_exp_f32 v141, v141
v_mfma_f32_16x16x32_bf16 a[72:75], a[232:235], v[216:219], a[72:75]
v_exp_f32 v142, v142
v_mfma_f32_16x16x32_bf16 a[104:107], a[232:235], v[220:223], a[104:107]
ds_read_b128 a[212:215], v2 offset:5120
v_cvt_pk_bf16_f32 v204, v140, v141
v_mfma_f32_16x16x32_bf16 a[108:111], a[236:239], v[220:223], a[108:111]
v_exp_f32 v143, v143
v_mfma_f32_16x16x32_bf16 a[76:79], a[236:239], v[216:219], a[76:79]
v_exp_f32 v156, v156
v_mfma_f32_16x16x32_bf16 a[44:47], a[236:239], v[212:215], a[44:47]
ds_read_b128 a[216:219], v2 offset:6144
v_cvt_pk_bf16_f32 v205, v142, v143
v_mfma_f32_16x16x32_bf16 a[12:15], a[236:239], v[208:211], a[12:15]
buffer_load_dwordx4 v1, s[44:47], s72 offen offset:3072 sc1 lds
v_mfma_f32_16x16x32_bf16 a[16:19], a[240:243], v[208:211], a[16:19]
v_exp_f32 v157, v157
v_mfma_f32_16x16x32_bf16 a[48:51], a[240:243], v[212:215], a[48:51]
v_exp_f32 v158, v158
v_mfma_f32_16x16x32_bf16 a[80:83], a[240:243], v[216:219], a[80:83]
ds_read_b128 a[220:223], v2 offset:7168
v_cvt_pk_bf16_f32 v206, v156, v157
v_mfma_f32_16x16x32_bf16 a[112:115], a[240:243], v[220:223], a[112:115]
v_exp_f32 v159, v159
v_mfma_f32_16x16x32_bf16 a[116:119], a[244:247], v[220:223], a[116:119]
v_cvt_pk_bf16_f32 v207, v158, v159
v_mfma_f32_16x16x32_bf16 a[84:87], a[244:247], v[216:219], a[84:87]
v_mfma_f32_16x16x32_bf16 a[52:55], a[244:247], v[212:215], a[52:55]
v_mfma_f32_16x16x32_bf16 a[20:23], a[244:247], v[208:211], a[20:23]
v_mfma_f32_16x16x32_bf16 a[24:27], a[248:251], v[208:211], a[24:27]
v_mfma_f32_16x16x32_bf16 a[56:59], a[248:251], v[212:215], a[56:59]
v_mfma_f32_16x16x32_bf16 a[88:91], a[248:251], v[216:219], a[88:91]
v_mfma_f32_16x16x32_bf16 a[120:123], a[248:251], v[220:223], a[120:123]
v_mfma_f32_16x16x32_bf16 a[124:127], a[252:255], v[220:223], a[124:127]
v_mfma_f32_16x16x32_bf16 a[92:95], a[252:255], v[216:219], a[92:95]
v_mfma_f32_16x16x32_bf16 a[60:63], a[252:255], v[212:215], a[60:63]
v_mfma_f32_16x16x32_bf16 a[28:31], a[252:255], v[208:211], a[28:31]
v_mfma_f32_16x16x32_bf16 v[224:227], v[120:123], v[208:211], v[224:227]
v_mfma_f32_16x16x32_bf16 v[228:231], v[120:123], v[212:215], v[228:231]
v_mfma_f32_16x16x32_bf16 v[232:235], v[120:123], v[216:219], v[232:235]
v_mfma_f32_16x16x32_bf16 v[236:239], v[120:123], v[220:223], v[236:239]
s_waitcnt lgkmcnt(8)
s_cmp_eq_u32 s58, 0
s_cbranch_scc1 Ltri16
v_mfma_f32_16x16x32_bf16 v[128:131], a[128:131], v[16:19], v[80:83]
s_add_u32 s82, s82, 0x8000
ds_read_b128 a[160:163], v2 offset:24576
v_mfma_f32_16x16x32_bf16 v[132:135], a[128:131], v[32:35], v[84:87]
s_and_b32 s82, s82, 0x1ffff
v_exp_f32 v160, v160
v_mfma_f32_16x16x32_bf16 v[144:147], a[144:147], v[16:19], v[80:83]
s_add_u32 m0, s74, 0
v_exp_f32 v161, v161
v_mfma_f32_16x16x32_bf16 v[148:151], a[144:147], v[32:35], v[84:87]
s_add_u32 s72, s81, 0
ds_read_b128 a[164:167], v2 offset:25600
v_cvt_pk_bf16_f32 v208, v160, v161
s_branch Ljoin17
Ltri16:
v_mfma_f32_16x16x32_bf16 v[128:131], a[128:131], v[16:19], v[96:99]
s_add_u32 s82, s82, 0x8000
ds_read_b128 a[160:163], v2 offset:24576
v_mfma_f32_16x16x32_bf16 v[132:135], a[128:131], v[32:35], v[84:87]
s_and_b32 s82, s82, 0x1ffff
v_exp_f32 v160, v160
v_mfma_f32_16x16x32_bf16 v[144:147], a[144:147], v[16:19], v[112:115]
s_add_u32 m0, s74, 0
v_exp_f32 v161, v161
v_mfma_f32_16x16x32_bf16 v[148:151], a[144:147], v[32:35], v[100:103]
s_add_u32 s72, s81, 0
ds_read_b128 a[164:167], v2 offset:25600
v_cvt_pk_bf16_f32 v208, v160, v161
Ljoin17:
v_mfma_f32_16x16x32_bf16 v[128:131], a[132:135], v[20:23], v[128:131]
v_exp_f32 v162, v162
v_mfma_f32_16x16x32_bf16 v[128:131], a[136:139], v[24:27], v[128:131]
v_exp_f32 v163, v163
v_mfma_f32_16x16x32_bf16 v[128:131], a[140:143], v[28:31], v[128:131]
ds_read_b128 a[168:171], v2 offset:26624
v_cvt_pk_bf16_f32 v209, v162, v163
v_mfma_f32_16x16x32_bf16 v[132:135], a[140:143], v[44:47], v[132:135]
v_exp_f32 v176, v176
v_mfma_f32_16x16x32_bf16 v[132:135], a[136:139], v[40:43], v[132:135]
buffer_load_dwordx4 v1, s[44:47], s72 offen sc1 lds
v_mfma_f32_16x16x32_bf16 v[132:135], a[132:135], v[36:39], v[132:135]
v_exp_f32 v177, v177
v_mfma_f32_16x16x32_bf16 v[136:139], a[128:131], v[48:51], v[88:91]
ds_read_b128 a[172:175], v2 offset:27648
v_cvt_pk_bf16_f32 v210, v176, v177
v_mfma_f32_16x16x32_bf16 v[136:139], a[132:135], v[52:55], v[136:139]
v_exp_f32 v178, v178
v_mfma_f32_16x16x32_bf16 v[136:139], a[136:139], v[56:59], v[136:139]
v_exp_f32 v179, v179
v_mfma_f32_16x16x32_bf16 v[136:139], a[140:143], v[60:63], v[136:139]
ds_read_b128 a[176:179], v2 offset:28672
v_cvt_pk_bf16_f32 v211, v178, v179
v_mfma_f32_16x16x32_bf16 v[140:143], a[140:143], v[76:79], v[92:95]
v_exp_f32 v164, v164
v_mfma_f32_16x16x32_bf16 v[140:143], a[136:139], v[72:75], v[140:143]
v_exp_f32 v165, v165
v_mfma_f32_16x16x32_bf16 v[140:143], a[132:135], v[68:71], v[140:143]
ds_read_b128 a[180:183], v2 offset:29696
v_cvt_pk_bf16_f32 v212, v164, v165
v_mfma_f32_16x16x32_bf16 v[140:143], a[128:131], v[64:67], v[140:143]
v_exp_f32 v166, v166
v_mfma_f32_16x16x32_bf16 v[156:159], a[144:147], v[64:67], v[92:95]
v_exp_f32 v167, v167
v_mfma_f32_16x16x32_bf16 v[156:159], a[148:151], v[68:71], v[156:159]
ds_read_b128 a[184:187], v2 offset:30720
v_cvt_pk_bf16_f32 v213, v166, v167
v_mfma_f32_16x16x32_bf16 v[156:159], a[152:155], v[72:75], v[156:159]
v_exp_f32 v180, v180
v_mfma_f32_16x16x32_bf16 v[156:159], a[156:159], v[76:79], v[156:159]
buffer_load_dwordx4 v1, s[44:47], s72 offen offset:1024 sc1 lds
v_mfma_f32_16x16x32_bf16 v[152:155], a[156:159], v[60:63], v[88:91]
v_exp_f32 v181, v181
v_mfma_f32_16x16x32_bf16 v[152:155], a[152:155], v[56:59], v[152:155]
ds_read_b128 a[188:191], v2 offset:31744
v_cvt_pk_bf16_f32 v214, v180, v181
v_mfma_f32_16x16x32_bf16 v[152:155], a[148:151], v[52:55], v[152:155]
v_exp_f32 v182, v182
v_mfma_f32_16x16x32_bf16 v[152:155], a[144:147], v[48:51], v[152:155]
v_exp_f32 v183, v183
v_mfma_f32_16x16x32_bf16 v[148:151], a[148:151], v[36:39], v[148:151]
ds_read_b128 a[224:227], v2 offset:8192
v_cvt_pk_bf16_f32 v215, v182, v183
v_mfma_f32_16x16x32_bf16 v[148:151], a[152:155], v[40:43], v[148:151]
v_exp_f32 v168, v168
v_mfma_f32_16x16x32_bf16 v[148:151], a[156:159], v[44:47], v[148:151]
v_exp_f32 v169, v169
v_mfma_f32_16x16x32_bf16 v[144:147], a[156:159], v[28:31], v[144:147]
ds_read_b128 a[228:231], v2 offset:9216
v_cvt_pk_bf16_f32 v216, v168, v169
v_mfma_f32_16x16x32_bf16 v[144:147], a[152:155], v[24:27], v[144:147]
v_exp_f32 v170, v170
v_mfma_f32_16x16x32_bf16 v[144:147], a[148:151], v[20:23], v[144:147]
s_waitcnt lgkmcnt(10)
v_exp_f32 v171, v171
v_mfma_f32_16x16x32_bf16 a[0:3], a[192:195], v[192:195], a[0:3]
ds_read_b128 a[232:235], v2 offset:10240
v_cvt_pk_bf16_f32 v217, v170, v171
v_mfma_f32_16x16x32_bf16 a[32:35], a[192:195], v[196:199], a[32:35]
v_exp_f32 v184, v184
v_mfma_f32_16x16x32_bf16 a[64:67], a[192:195], v[200:203], a[64:67]
buffer_load_dwordx4 v1, s[44:47], s72 offen offset:2048 sc1 lds
v_mfma_f32_16x16x32_bf16 a[96:99], a[192:195], v[204:207], a[96:99]
v_exp_f32 v185, v185
v_mfma_f32_16x16x32_bf16 a[100:103], a[196:199], v[204:207], a[100:103]
ds_read_b128 a[236:239], v2 offset:11264
v_cvt_pk_bf16_f32 v218, v184, v185
v_mfma_f32_16x16x32_bf16 a[68:71], a[196:199], v[200:203], a[68:71]
v_exp_f32 v186, v186
v_mfma_f32_16x16x32_bf16 a[36:39], a[196:199], v[196:199], a[36:39]
v_exp_f32 v187, v187
v_mfma_f32_16x16x32_bf16 a[4:7], a[196:199], v[192:195], a[4:7]
ds_read_b128 a[240:243], v2 offset:12288
v_cvt_pk_bf16_f32 v219, v186, v187
v_mfma_f32_16x16x32_bf16 a[8:11], a[200:203], v[192:195], a[8:11]
v_exp_f32 v172, v172
v_mfma_f32_16x16x32_bf16 a[40:43], a[200:203], v[196:199], a[40:43]
v_exp_f32 v173, v173
v_mfma_f32_16x16x32_bf16 a[72:75], a[200:203], v[200:203], a[72:75]
ds_read_b128 a[244:247], v2 offset:13312
v_cvt_pk_bf16_f32 v220, v172, v173
v_mfma_f32_16x16x32_bf16 a[104:107], a[200:203], v[204:207], a[104:107]
v_exp_f32 v174, v174
v_mfma_f32_16x16x32_bf16 a[108:111], a[204:207], v[204:207], a[108:111]
v_exp_f32 v175, v175
v_mfma_f32_16x16x32_bf16 a[76:79], a[204:207], v[200:203], a[76:79]
ds_read_b128 a[248:251], v2 offset:14336
v_cvt_pk_bf16_f32 v221, v174, v175
v_mfma_f32_16x16x32_bf16 a[44:47], a[204:207], v[196:199], a[44:47]
v_exp_f32 v188, v188
v_mfma_f32_16x16x32_bf16 a[12:15], a[204:207], v[192:195], a[12:15]
buffer_load_dwordx4 v1, s[44:47], s72 offen offset:3072 sc1 lds
v_mfma_f32_16x16x32_bf16 a[16:19], a[208:211], v[192:195], a[16:19]
v_exp_f32 v189, v189
v_mfma_f32_16x16x32_bf16 a[48:51], a[208:211], v[196:199], a[48:51]
ds_read_b128 a[252:255], v2 offset:15360
v_cvt_pk_bf16_f32 v222, v188, v189
v_mfma_f32_16x16x32_bf16 a[80:83], a[208:211], v[200:203], a[80:83]
v_exp_f32 v190, v190
v_mfma_f32_16x16x32_bf16 a[112:115], a[208:211], v[204:207], a[112:115]
v_exp_f32 v191, v191
v_mfma_f32_16x16x32_bf16 a[116:119], a[212:215], v[204:207], a[116:119]
v_cvt_pk_bf16_f32 v223, v190, v191
v_add_u32 v2, s82, v1
v_mfma_f32_16x16x32_bf16 a[84:87], a[212:215], v[200:203], a[84:87]
v_mfma_f32_16x16x32_bf16 a[52:55], a[212:215], v[196:199], a[52:55]
v_mfma_f32_16x16x32_bf16 a[20:23], a[212:215], v[192:195], a[20:23]
v_mfma_f32_16x16x32_bf16 a[24:27], a[216:219], v[192:195], a[24:27]
v_mfma_f32_16x16x32_bf16 a[56:59], a[216:219], v[196:199], a[56:59]
v_mfma_f32_16x16x32_bf16 a[88:91], a[216:219], v[200:203], a[88:91]
v_mfma_f32_16x16x32_bf16 a[120:123], a[216:219], v[204:207], a[120:123]
v_mfma_f32_16x16x32_bf16 a[124:127], a[220:223], v[204:207], a[124:127]
v_mfma_f32_16x16x32_bf16 a[92:95], a[220:223], v[200:203], a[92:95]
v_mfma_f32_16x16x32_bf16 a[60:63], a[220:223], v[196:199], a[60:63]
v_mfma_f32_16x16x32_bf16 a[28:31], a[220:223], v[192:195], a[28:31]
v_mfma_f32_16x16x32_bf16 v[224:227], v[120:123], v[192:195], v[224:227]
v_mfma_f32_16x16x32_bf16 v[228:231], v[120:123], v[196:199], v[228:231]
v_mfma_f32_16x16x32_bf16 v[232:235], v[120:123], v[200:203], v[232:235]
s_waitcnt vmcnt(8) lgkmcnt(8)
v_mfma_f32_16x16x32_bf16 v[236:239], v[120:123], v[204:207], v[236:239]
s_barrier
s_cmp_eq_u32 s58, 1
s_cbranch_scc1 Ltri19
s_cmp_gt_u32 s58, 1
s_cbranch_scc1 Lalt18
v_mfma_f32_16x16x32_bf16 v[160:163], a[160:163], v[16:19], v[112:115]
s_xor_b32 s74, s82, 0x10000
v_exp_f32 v128, v128
v_mfma_f32_16x16x32_bf16 v[164:167], a[160:163], v[32:35], v[112:115]
s_add_u32 s74, s74, s64
ds_read_b128 a[128:131], v2 offset:16384
v_mfma_f32_16x16x32_bf16 v[176:179], a[176:179], v[16:19], v[112:115]
s_add_u32 s81, s81, 0x8000
v_exp_f32 v129, v129
v_mfma_f32_16x16x32_bf16 v[180:183], a[176:179], v[32:35], v[112:115]
s_add_u32 m0, s74, 16384
v_exp_f32 v130, v130
s_branch Ljoin20
Lalt18:
v_mfma_f32_16x16x32_bf16 v[160:163], a[160:163], v[16:19], v[80:83]
s_xor_b32 s74, s82, 0x10000
v_exp_f32 v128, v128
v_mfma_f32_16x16x32_bf16 v[164:167], a[160:163], v[32:35], v[84:87]
s_add_u32 s74, s74, s64
ds_read_b128 a[128:131], v2 offset:16384
v_mfma_f32_16x16x32_bf16 v[176:179], a[176:179], v[16:19], v[80:83]
s_add_u32 s81, s81, 0x8000
v_exp_f32 v129, v129
v_mfma_f32_16x16x32_bf16 v[180:183], a[176:179], v[32:35], v[84:87]
s_add_u32 m0, s74, 16384
v_exp_f32 v130, v130
s_branch Ljoin20
Ltri19:
v_mfma_f32_16x16x32_bf16 v[160:163], a[160:163], v[16:19], v[96:99]
s_xor_b32 s74, s82, 0x10000
v_exp_f32 v128, v128
v_mfma_f32_16x16x32_bf16 v[164:167], a[160:163], v[32:35], v[84:87]
s_add_u32 s74, s74, s64
ds_read_b128 a[128:131], v2 offset:16384
v_mfma_f32_16x16x32_bf16 v[176:179], a[176:179], v[16:19], v[112:115]
s_add_u32 s81, s81, 0x8000
v_exp_f32 v129, v129
v_mfma_f32_16x16x32_bf16 v[180:183], a[176:179], v[32:35], v[100:103]
s_add_u32 m0, s74, 16384
v_exp_f32 v130, v130
Ljoin20:
v_mfma_f32_16x16x32_bf16 v[160:163], a[164:167], v[20:23], v[160:163]
s_add_u32 s72, s81, 16384
ds_read_b128 a[132:135], v2 offset:17408
v_cvt_pk_bf16_f32 v192, v128, v129
v_mfma_f32_16x16x32_bf16 v[160:163], a[168:171], v[24:27], v[160:163]
v_exp_f32 v131, v131
v_mfma_f32_16x16x32_bf16 v[160:163], a[172:175], v[28:31], v[160:163]
v_exp_f32 v144, v144
v_mfma_f32_16x16x32_bf16 v[164:167], a[172:175], v[44:47], v[164:167]
ds_read_b128 a[136:139], v2 offset:18432
v_cvt_pk_bf16_f32 v193, v130, v131
v_mfma_f32_16x16x32_bf16 v[164:167], a[168:171], v[40:43], v[164:167]
buffer_load_dwordx4 v1, s[44:47], s72 offen sc1 lds
v_mfma_f32_16x16x32_bf16 v[164:167], a[164:167], v[36:39], v[164:167]
v_exp_f32 v145, v145
v_mfma_f32_16x16x32_bf16 v[168:171], a[160:163], v[48:51], v[88:91]
v_exp_f32 v146, v146
v_mfma_f32_16x16x32_bf16 v[168:171], a[164:167], v[52:55], v[168:171]
ds_read_b128 a[140:143], v2 offset:19456
v_cvt_pk_bf16_f32 v194, v144, v145
v_mfma_f32_16x16x32_bf16 v[168:171], a[168:171], v[56:59], v[168:171]
v_exp_f32 v147, v147
v_mfma_f32_16x16x32_bf16 v[168:171], a[172:175], v[60:63], v[168:171]
v_exp_f32 v132, v132
v_mfma_f32_16x16x32_bf16 v[172:175], a[172:175], v[76:79], v[92:95]
ds_read_b128 a[144:147], v2 offset:20480
v_cvt_pk_bf16_f32 v195, v146, v147
v_mfma_f32_16x16x32_bf16 v[172:175], a[168:171], v[72:75], v[172:175]
v_exp_f32 v133, v133
v_mfma_f32_16x16x32_bf16 v[172:175], a[164:167], v[68:71], v[172:175]
v_exp_f32 v134, v134
v_mfma_f32_16x16x32_bf16 v[172:175], a[160:163], v[64:67], v[172:175]
ds_read_b128 a[148:151], v2 offset:21504
v_cvt_pk_bf16_f32 v196, v132, v133
v_mfma_f32_16x16x32_bf16 v[188:191], a[176:179], v[64:67], v[92:95]
v_exp_f32 v135, v135
v_mfma_f32_16x16x32_bf16 v[188:191], a[180:183], v[68:71], v[188:191]
v_exp_f32 v148, v148
v_mfma_f32_16x16x32_bf16 v[188:191], a[184:187], v[72:75], v[188:191]
ds_read_b128 a[152:155], v2 offset:22528
v_cvt_pk_bf16_f32 v197, v134, v135
v_mfma_f32_16x16x32_bf16 v[188:191], a[188:191], v[76:79], v[188:191]
buffer_load_dwordx4 v1, s[44:47], s72 offen offset:1024 sc1 lds
v_mfma_f32_16x16x32_bf16 v[184:187], a[188:191], v[60:63], v[88:91]
v_exp_f32 v149, v149
v_mfma_f32_16x16x32_bf16 v[184:187], a[184:187], v[56:59], v[184:187]
v_exp_f32 v150, v150
v_mfma_f32_16x16x32_bf16 v[184:187], a[180:183], v[52:55], v[184:187]
ds_read_b128 a[156:159], v2 offset:23552
v_cvt_pk_bf16_f32 v198, v148, v149
v_mfma_f32_16x16x32_bf16 v[184:187], a[176:179], v[48:51], v[184:187]
v_exp_f32 v151, v151
v_mfma_f32_16x16x32_bf16 v[180:183], a[180:183], v[36:39], v[180:183]
v_exp_f32 v136, v136
v_mfma_f32_16x16x32_bf16 v[180:183], a[184:187], v[40:43], v[180:183]
ds_read_b128 a[192:195], v2 offset:0
v_cvt_pk_bf16_f32 v199, v150, v151
v_mfma_f32_16x16x32_bf16 v[180:183], a[188:191], v[44:47], v[180:183]
v_exp_f32 v137, v137
v_mfma_f32_16x16x32_bf16 v[176:179], a[188:191], v[28:31], v[176:179]
v_exp_f32 v138, v138
v_mfma_f32_16x16x32_bf16 v[176:179], a[184:187], v[24:27], v[176:179]
ds_read_b128 a[196:199], v2 offset:1024
v_cvt_pk_bf16_f32 v200, v136, v137
v_mfma_f32_16x16x32_bf16 v[176:179], a[180:183], v[20:23], v[176:179]
s_waitcnt lgkmcnt(10)
v_exp_f32 v139, v139
v_mfma_f32_16x16x32_bf16 a[0:3], a[224:227], v[208:211], a[0:3]
v_exp_f32 v152, v152
v_mfma_f32_16x16x32_bf16 a[32:35], a[224:227], v[212:215], a[32:35]
ds_read_b128 a[200:203], v2 offset:2048
v_cvt_pk_bf16_f32 v201, v138, v139
v_mfma_f32_16x16x32_bf16 a[64:67], a[224:227], v[216:219], a[64:67]
buffer_load_dwordx4 v1, s[44:47], s72 offen offset:2048 sc1 lds
v_mfma_f32_16x16x32_bf16 a[96:99], a[224:227], v[220:223], a[96:99]
v_exp_f32 v153, v153
v_mfma_f32_16x16x32_bf16 a[100:103], a[228:231], v[220:223], a[100:103]
v_exp_f32 v154, v154
v_mfma_f32_16x16x32_bf16 a[68:71], a[228:231], v[216:219], a[68:71]
ds_read_b128 a[204:207], v2 offset:3072
v_cvt_pk_bf16_f32 v202, v152, v153
v_mfma_f32_16x16x32_bf16 a[36:39], a[228:231], v[212:215], a[36:39]
v_exp_f32 v155, v155
v_mfma_f32_16x16x32_bf16 a[4:7], a[228:231], v[208:211], a[4:7]
v_exp_f32 v140, v140
v_mfma_f32_16x16x32_bf16 a[8:11], a[232:235], v[208:211], a[8:11]
ds_read_b128 a[208:211], v2 offset:4096
v_cvt_pk_bf16_f32 v203, v154, v155
v_mfma_f32_16x16x32_bf16 a[40:43], a[232:235], v[212:215], a[40:43]
v_exp_f32 v141, v141
v_mfma_f32_16x16x32_bf16 a[72:75], a[232:235], v[216:219], a[72:75]
v_exp_f32 v142, v142
v_mfma_f32_16x16x32_bf16 a[104:107], a[232:235], v[220:223], a[104:107]
ds_read_b128 a[212:215], v2 offset:5120
v_cvt_pk_bf16_f32 v204, v140, v141
v_mfma_f32_16x16x32_bf16 a[108:111], a[236:239], v[220:223], a[108:111]
v_exp_f32 v143, v143
v_mfma_f32_16x16x32_bf16 a[76:79], a[236:239], v[216:219], a[76:79]
v_exp_f32 v156, v156
v_mfma_f32_16x16x32_bf16 a[44:47], a[236:239], v[212:215], a[44:47]
ds_read_b128 a[216:219], v2 offset:6144
v_cvt_pk_bf16_f32 v205, v142, v143
v_mfma_f32_16x16x32_bf16 a[12:15], a[236:239], v[208:211], a[12:15]
buffer_load_dwordx4 v1, s[44:47], s72 offen offset:3072 sc1 lds
v_mfma_f32_16x16x32_bf16 a[16:19], a[240:243], v[208:211], a[16:19]
v_exp_f32 v157, v157
v_mfma_f32_16x16x32_bf16 a[48:51], a[240:243], v[212:215], a[48:51]
v_exp_f32 v158, v158
v_mfma_f32_16x16x32_bf16 a[80:83], a[240:243], v[216:219], a[80:83]
ds_read_b128 a[220:223], v2 offset:7168
v_cvt_pk_bf16_f32 v206, v156, v157
v_mfma_f32_16x16x32_bf16 a[112:115], a[240:243], v[220:223], a[112:115]
v_exp_f32 v159, v159
v_mfma_f32_16x16x32_bf16 a[116:119], a[244:247], v[220:223], a[116:119]
v_cvt_pk_bf16_f32 v207, v158, v159
v_mfma_f32_16x16x32_bf16 a[84:87], a[244:247], v[216:219], a[84:87]
v_mfma_f32_16x16x32_bf16 a[52:55], a[244:247], v[212:215], a[52:55]
v_mfma_f32_16x16x32_bf16 a[20:23], a[244:247], v[208:211], a[20:23]
v_mfma_f32_16x16x32_bf16 a[24:27], a[248:251], v[208:211], a[24:27]
v_mfma_f32_16x16x32_bf16 a[56:59], a[248:251], v[212:215], a[56:59]
v_mfma_f32_16x16x32_bf16 a[88:91], a[248:251], v[216:219], a[88:91]
v_mfma_f32_16x16x32_bf16 a[120:123], a[248:251], v[220:223], a[120:123]
v_mfma_f32_16x16x32_bf16 a[124:127], a[252:255], v[220:223], a[124:127]
v_mfma_f32_16x16x32_bf16 a[92:95], a[252:255], v[216:219], a[92:95]
v_mfma_f32_16x16x32_bf16 a[60:63], a[252:255], v[212:215], a[60:63]
v_mfma_f32_16x16x32_bf16 a[28:31], a[252:255], v[208:211], a[28:31]
v_mfma_f32_16x16x32_bf16 v[224:227], v[120:123], v[208:211], v[224:227]
v_mfma_f32_16x16x32_bf16 v[228:231], v[120:123], v[212:215], v[228:231]
v_mfma_f32_16x16x32_bf16 v[232:235], v[120:123], v[216:219], v[232:235]
v_mfma_f32_16x16x32_bf16 v[236:239], v[120:123], v[220:223], v[236:239]
s_waitcnt lgkmcnt(8)
s_cmp_eq_u32 s58, 2
s_cbranch_scc1 Ltri22
s_cmp_gt_u32 s58, 2
s_cbranch_scc1 Lalt21
v_mfma_f32_16x16x32_bf16 v[128:131], a[128:131], v[16:19], v[112:115]
s_add_u32 s82, s82, 0x8000
ds_read_b128 a[160:163], v2 offset:24576
v_mfma_f32_16x16x32_bf16 v[132:135], a[128:131], v[32:35], v[112:115]
s_and_b32 s82, s82, 0x1ffff
v_exp_f32 v160, v160
v_mfma_f32_16x16x32_bf16 v[144:147], a[144:147], v[16:19], v[112:115]
s_add_u32 m0, s74, 0
v_exp_f32 v161, v161
v_mfma_f32_16x16x32_bf16 v[148:151], a[144:147], v[32:35], v[112:115]
s_add_u32 s72, s81, 0
ds_read_b128 a[164:167], v2 offset:25600
v_cvt_pk_bf16_f32 v208, v160, v161
s_branch Ljoin23
Lalt21:
v_mfma_f32_16x16x32_bf16 v[128:131], a[128:131], v[16:19], v[80:83]
s_add_u32 s82, s82, 0x8000
ds_read_b128 a[160:163], v2 offset:24576
v_mfma_f32_16x16x32_bf16 v[132:135], a[128:131], v[32:35], v[84:87]
s_and_b32 s82, s82, 0x1ffff
v_exp_f32 v160, v160
v_mfma_f32_16x16x32_bf16 v[144:147], a[144:147], v[16:19], v[80:83]
s_add_u32 m0, s74, 0
v_exp_f32 v161, v161
v_mfma_f32_16x16x32_bf16 v[148:151], a[144:147], v[32:35], v[84:87]
s_add_u32 s72, s81, 0
ds_read_b128 a[164:167], v2 offset:25600
v_cvt_pk_bf16_f32 v208, v160, v161
s_branch Ljoin23
Ltri22:
v_mfma_f32_16x16x32_bf16 v[128:131], a[128:131], v[16:19], v[96:99]
s_add_u32 s82, s82, 0x8000
ds_read_b128 a[160:163], v2 offset:24576
v_mfma_f32_16x16x32_bf16 v[132:135], a[128:131], v[32:35], v[84:87]
s_and_b32 s82, s82, 0x1ffff
v_exp_f32 v160, v160
v_mfma_f32_16x16x32_bf16 v[144:147], a[144:147], v[16:19], v[112:115]
s_add_u32 m0, s74, 0
v_exp_f32 v161, v161
v_mfma_f32_16x16x32_bf16 v[148:151], a[144:147], v[32:35], v[100:103]
s_add_u32 s72, s81, 0
ds_read_b128 a[164:167], v2 offset:25600
v_cvt_pk_bf16_f32 v208, v160, v161
Ljoin23:
v_mfma_f32_16x16x32_bf16 v[128:131], a[132:135], v[20:23], v[128:131]
v_exp_f32 v162, v162
v_mfma_f32_16x16x32_bf16 v[128:131], a[136:139], v[24:27], v[128:131]
v_exp_f32 v163, v163
v_mfma_f32_16x16x32_bf16 v[128:131], a[140:143], v[28:31], v[128:131]
ds_read_b128 a[168:171], v2 offset:26624
v_cvt_pk_bf16_f32 v209, v162, v163
v_mfma_f32_16x16x32_bf16 v[132:135], a[140:143], v[44:47], v[132:135]
v_exp_f32 v176, v176
v_mfma_f32_16x16x32_bf16 v[132:135], a[136:139], v[40:43], v[132:135]
buffer_load_dwordx4 v1, s[44:47], s72 offen sc1 lds
v_mfma_f32_16x16x32_bf16 v[132:135], a[132:135], v[36:39], v[132:135]
v_exp_f32 v177, v177
v_mfma_f32_16x16x32_bf16 v[136:139], a[128:131], v[48:51], v[88:91]
ds_read_b128 a[172:175], v2 offset:27648
v_cvt_pk_bf16_f32 v210, v176, v177
v_mfma_f32_16x16x32_bf16 v[136:139], a[132:135], v[52:55], v[136:139]
v_exp_f32 v178, v178
v_mfma_f32_16x16x32_bf16 v[136:139], a[136:139], v[56:59], v[136:139]
v_exp_f32 v179, v179
v_mfma_f32_16x16x32_bf16 v[136:139], a[140:143], v[60:63], v[136:139]
ds_read_b128 a[176:179], v2 offset:28672
v_cvt_pk_bf16_f32 v211, v178, v179
v_mfma_f32_16x16x32_bf16 v[140:143], a[140:143], v[76:79], v[92:95]
v_exp_f32 v164, v164
v_mfma_f32_16x16x32_bf16 v[140:143], a[136:139], v[72:75], v[140:143]
v_exp_f32 v165, v165
v_mfma_f32_16x16x32_bf16 v[140:143], a[132:135], v[68:71], v[140:143]
ds_read_b128 a[180:183], v2 offset:29696
v_cvt_pk_bf16_f32 v212, v164, v165
v_mfma_f32_16x16x32_bf16 v[140:143], a[128:131], v[64:67], v[140:143]
v_exp_f32 v166, v166
v_mfma_f32_16x16x32_bf16 v[156:159], a[144:147], v[64:67], v[92:95]
v_exp_f32 v167, v167
v_mfma_f32_16x16x32_bf16 v[156:159], a[148:151], v[68:71], v[156:159]
ds_read_b128 a[184:187], v2 offset:30720
v_cvt_pk_bf16_f32 v213, v166, v167
v_mfma_f32_16x16x32_bf16 v[156:159], a[152:155], v[72:75], v[156:159]
v_exp_f32 v180, v180
v_mfma_f32_16x16x32_bf16 v[156:159], a[156:159], v[76:79], v[156:159]
buffer_load_dwordx4 v1, s[44:47], s72 offen offset:1024 sc1 lds
v_mfma_f32_16x16x32_bf16 v[152:155], a[156:159], v[60:63], v[88:91]
v_exp_f32 v181, v181
v_mfma_f32_16x16x32_bf16 v[152:155], a[152:155], v[56:59], v[152:155]
ds_read_b128 a[188:191], v2 offset:31744
v_cvt_pk_bf16_f32 v214, v180, v181
v_mfma_f32_16x16x32_bf16 v[152:155], a[148:151], v[52:55], v[152:155]
v_exp_f32 v182, v182
v_mfma_f32_16x16x32_bf16 v[152:155], a[144:147], v[48:51], v[152:155]
v_exp_f32 v183, v183
v_mfma_f32_16x16x32_bf16 v[148:151], a[148:151], v[36:39], v[148:151]
ds_read_b128 a[224:227], v2 offset:8192
v_cvt_pk_bf16_f32 v215, v182, v183
v_mfma_f32_16x16x32_bf16 v[148:151], a[152:155], v[40:43], v[148:151]
v_exp_f32 v168, v168
v_mfma_f32_16x16x32_bf16 v[148:151], a[156:159], v[44:47], v[148:151]
v_exp_f32 v169, v169
v_mfma_f32_16x16x32_bf16 v[144:147], a[156:159], v[28:31], v[144:147]
ds_read_b128 a[228:231], v2 offset:9216
v_cvt_pk_bf16_f32 v216, v168, v169
v_mfma_f32_16x16x32_bf16 v[144:147], a[152:155], v[24:27], v[144:147]
v_exp_f32 v170, v170
v_mfma_f32_16x16x32_bf16 v[144:147], a[148:151], v[20:23], v[144:147]
s_waitcnt lgkmcnt(10)
v_exp_f32 v171, v171
v_mfma_f32_16x16x32_bf16 a[0:3], a[192:195], v[192:195], a[0:3]
ds_read_b128 a[232:235], v2 offset:10240
v_cvt_pk_bf16_f32 v217, v170, v171
v_mfma_f32_16x16x32_bf16 a[32:35], a[192:195], v[196:199], a[32:35]
v_exp_f32 v184, v184
v_mfma_f32_16x16x32_bf16 a[64:67], a[192:195], v[200:203], a[64:67]
buffer_load_dwordx4 v1, s[44:47], s72 offen offset:2048 sc1 lds
v_mfma_f32_16x16x32_bf16 a[96:99], a[192:195], v[204:207], a[96:99]
v_exp_f32 v185, v185
v_mfma_f32_16x16x32_bf16 a[100:103], a[196:199], v[204:207], a[100:103]
ds_read_b128 a[236:239], v2 offset:11264
v_cvt_pk_bf16_f32 v218, v184, v185
v_mfma_f32_16x16x32_bf16 a[68:71], a[196:199], v[200:203], a[68:71]
v_exp_f32 v186, v186
v_mfma_f32_16x16x32_bf16 a[36:39], a[196:199], v[196:199], a[36:39]
v_exp_f32 v187, v187
v_mfma_f32_16x16x32_bf16 a[4:7], a[196:199], v[192:195], a[4:7]
ds_read_b128 a[240:243], v2 offset:12288
v_cvt_pk_bf16_f32 v219, v186, v187
v_mfma_f32_16x16x32_bf16 a[8:11], a[200:203], v[192:195], a[8:11]
v_exp_f32 v172, v172
v_mfma_f32_16x16x32_bf16 a[40:43], a[200:203], v[196:199], a[40:43]
v_exp_f32 v173, v173
v_mfma_f32_16x16x32_bf16 a[72:75], a[200:203], v[200:203], a[72:75]
ds_read_b128 a[244:247], v2 offset:13312
v_cvt_pk_bf16_f32 v220, v172, v173
v_mfma_f32_16x16x32_bf16 a[104:107], a[200:203], v[204:207], a[104:107]
v_exp_f32 v174, v174
v_mfma_f32_16x16x32_bf16 a[108:111], a[204:207], v[204:207], a[108:111]
v_exp_f32 v175, v175
v_mfma_f32_16x16x32_bf16 a[76:79], a[204:207], v[200:203], a[76:79]
ds_read_b128 a[248:251], v2 offset:14336
v_cvt_pk_bf16_f32 v221, v174, v175
v_mfma_f32_16x16x32_bf16 a[44:47], a[204:207], v[196:199], a[44:47]
v_exp_f32 v188, v188
v_mfma_f32_16x16x32_bf16 a[12:15], a[204:207], v[192:195], a[12:15]
buffer_load_dwordx4 v1, s[44:47], s72 offen offset:3072 sc1 lds
v_mfma_f32_16x16x32_bf16 a[16:19], a[208:211], v[192:195], a[16:19]
v_exp_f32 v189, v189
v_mfma_f32_16x16x32_bf16 a[48:51], a[208:211], v[196:199], a[48:51]
ds_read_b128 a[252:255], v2 offset:15360
v_cvt_pk_bf16_f32 v222, v188, v189
v_mfma_f32_16x16x32_bf16 a[80:83], a[208:211], v[200:203], a[80:83]
v_exp_f32 v190, v190
v_mfma_f32_16x16x32_bf16 a[112:115], a[208:211], v[204:207], a[112:115]
v_exp_f32 v191, v191
v_mfma_f32_16x16x32_bf16 a[116:119], a[212:215], v[204:207], a[116:119]
v_cvt_pk_bf16_f32 v223, v190, v191
v_add_u32 v2, s82, v1
v_mfma_f32_16x16x32_bf16 a[84:87], a[212:215], v[200:203], a[84:87]
Lstub2:
s_cbranch_execz Lstub6
v_mfma_f32_16x16x32_bf16 a[52:55], a[212:215], v[196:199], a[52:55]
v_mfma_f32_16x16x32_bf16 a[20:23], a[212:215], v[192:195], a[20:23]
v_mfma_f32_16x16x32_bf16 a[24:27], a[216:219], v[192:195], a[24:27]
v_mfma_f32_16x16x32_bf16 a[56:59], a[216:219], v[196:199], a[56:59]
v_mfma_f32_16x16x32_bf16 a[88:91], a[216:219], v[200:203], a[88:91]
v_mfma_f32_16x16x32_bf16 a[120:123], a[216:219], v[204:207], a[120:123]
v_mfma_f32_16x16x32_bf16 a[124:127], a[220:223], v[204:207], a[124:127]
v_mfma_f32_16x16x32_bf16 a[92:95], a[220:223], v[200:203], a[92:95]
v_mfma_f32_16x16x32_bf16 a[60:63], a[220:223], v[196:199], a[60:63]
v_mfma_f32_16x16x32_bf16 a[28:31], a[220:223], v[192:195], a[28:31]
v_mfma_f32_16x16x32_bf16 v[224:227], v[120:123], v[192:195], v[224:227]
v_mfma_f32_16x16x32_bf16 v[228:231], v[120:123], v[196:199], v[228:231]
v_mfma_f32_16x16x32_bf16 v[232:235], v[120:123], v[200:203], v[232:235]
s_waitcnt vmcnt(8) lgkmcnt(8)
v_mfma_f32_16x16x32_bf16 v[236:239], v[120:123], v[204:207], v[236:239]
s_barrier
s_cmp_eq_u32 s60, 7
s_cbranch_scc1 LLT3x
LLT3:
s_cmp_eq_u32 s58, 3
s_cbranch_scc1 Ltri25
v_mfma_f32_16x16x32_bf16 v[160:163], a[160:163], v[16:19], v[112:115]
s_xor_b32 s74, s82, 0x10000
v_exp_f32 v128, v128
v_mfma_f32_16x16x32_bf16 v[164:167], a[160:163], v[32:35], v[112:115]
s_add_u32 s74, s74, s64
ds_read_b128 a[128:131], v2 offset:16384
v_mfma_f32_16x16x32_bf16 v[176:179], a[176:179], v[16:19], v[112:115]
s_add_u32 s81, s81, 0x8000
v_exp_f32 v129, v129
v_mfma_f32_16x16x32_bf16 v[180:183], a[176:179], v[32:35], v[112:115]
s_add_u32 m0, s74, 16384
v_exp_f32 v130, v130
s_branch Ljoin26
Lalt24:
Ltri25:
v_mfma_f32_16x16x32_bf16 v[160:163], a[160:163], v[16:19], v[96:99]
s_xor_b32 s74, s82, 0x10000
v_exp_f32 v128, v128
v_mfma_f32_16x16x32_bf16 v[164:167], a[160:163], v[32:35], v[84:87]
s_add_u32 s74, s74, s64
ds_read_b128 a[128:131], v2 offset:16384
v_mfma_f32_16x16x32_bf16 v[176:179], a[176:179], v[16:19], v[112:115]
s_add_u32 s81, s81, 0x8000
v_exp_f32 v129, v129
v_mfma_f32_16x16x32_bf16 v[180:183], a[176:179], v[32:35], v[100:103]
s_add_u32 m0, s74, 16384
v_exp_f32 v130, v130
Ljoin26:
v_mfma_f32_16x16x32_bf16 v[160:163], a[164:167], v[20:23], v[160:163]
s_add_u32 s72, s81, 16384
ds_read_b128 a[132:135], v2 offset:17408
v_cvt_pk_bf16_f32 v192, v128, v129
v_mfma_f32_16x16x32_bf16 v[160:163], a[168:171], v[24:27], v[160:163]
s_and_b32 s73, s58, 1
v_exp_f32 v131, v131
v_mfma_f32_16x16x32_bf16 v[160:163], a[172:175], v[28:31], v[160:163]
s_lshl_b32 s73, s73, 4
v_exp_f32 v144, v144
v_mfma_f32_16x16x32_bf16 v[164:167], a[172:175], v[44:47], v[164:167]
s_lshr_b32 s73, s90, s73
ds_read_b128 a[136:139], v2 offset:18432
v_cvt_pk_bf16_f32 v193, v130, v131
v_mfma_f32_16x16x32_bf16 v[164:167], a[168:171], v[40:43], v[164:167]
s_and_b32 s73, s73, 0xffff
buffer_load_dwordx4 v1, s[44:47], s72 offen sc1 lds
v_mfma_f32_16x16x32_bf16 v[164:167], a[164:167], v[36:39], v[164:167]
v_exp_f32 v145, v145
v_mfma_f32_16x16x32_bf16 v[168:171], a[160:163], v[48:51], v[88:91]
v_exp_f32 v146, v146
v_mfma_f32_16x16x32_bf16 v[168:171], a[164:167], v[52:55], v[168:171]
ds_read_b128 a[140:143], v2 offset:19456
v_cvt_pk_bf16_f32 v194, v144, v145
v_mfma_f32_16x16x32_bf16 v[168:171], a[168:171], v[56:59], v[168:171]
v_exp_f32 v147, v147
v_mfma_f32_16x16x32_bf16 v[168:171], a[172:175], v[60:63], v[168:171]
v_exp_f32 v132, v132
v_mfma_f32_16x16x32_bf16 v[172:175], a[172:175], v[76:79], v[92:95]
ds_read_b128 a[144:147], v2 offset:20480
v_cvt_pk_bf16_f32 v195, v146, v147
v_mfma_f32_16x16x32_bf16 v[172:175], a[168:171], v[72:75], v[172:175]
v_exp_f32 v133, v133
v_mfma_f32_16x16x32_bf16 v[172:175], a[164:167], v[68:71], v[172:175]
v_exp_f32 v134, v134
v_mfma_f32_16x16x32_bf16 v[172:175], a[160:163], v[64:67], v[172:175]
ds_read_b128 a[148:151], v2 offset:21504
v_cvt_pk_bf16_f32 v196, v132, v133
v_mfma_f32_16x16x32_bf16 v[188:191], a[176:179], v[64:67], v[92:95]
v_exp_f32 v135, v135
v_mfma_f32_16x16x32_bf16 v[188:191], a[180:183], v[68:71], v[188:191]
v_exp_f32 v148, v148
v_mfma_f32_16x16x32_bf16 v[188:191], a[184:187], v[72:75], v[188:191]
ds_read_b128 a[152:155], v2 offset:22528
v_cvt_pk_bf16_f32 v197, v134, v135
v_mfma_f32_16x16x32_bf16 v[188:191], a[188:191], v[76:79], v[188:191]
buffer_load_dwordx4 v1, s[44:47], s72 offen offset:1024 sc1 lds
v_mfma_f32_16x16x32_bf16 v[184:187], a[188:191], v[60:63], v[88:91]
v_exp_f32 v149, v149
v_mfma_f32_16x16x32_bf16 v[184:187], a[184:187], v[56:59], v[184:187]
v_exp_f32 v150, v150
v_mfma_f32_16x16x32_bf16 v[184:187], a[180:183], v[52:55], v[184:187]
ds_read_b128 a[156:159], v2 offset:23552
v_cvt_pk_bf16_f32 v198, v148, v149
v_mfma_f32_16x16x32_bf16 v[184:187], a[176:179], v[48:51], v[184:187]
v_exp_f32 v151, v151
v_mfma_f32_16x16x32_bf16 v[180:183], a[180:183], v[36:39], v[180:183]
v_exp_f32 v136, v136
v_mfma_f32_16x16x32_bf16 v[180:183], a[184:187], v[40:43], v[180:183]
ds_read_b128 a[192:195], v2 offset:0
v_cvt_pk_bf16_f32 v199, v150, v151
v_mfma_f32_16x16x32_bf16 v[180:183], a[188:191], v[44:47], v[180:183]
v_exp_f32 v137, v137
v_mfma_f32_16x16x32_bf16 v[176:179], a[188:191], v[28:31], v[176:179]
v_exp_f32 v138, v138
v_mfma_f32_16x16x32_bf16 v[176:179], a[184:187], v[24:27], v[176:179]
ds_read_b128 a[196:199], v2 offset:1024
v_cvt_pk_bf16_f32 v200, v136, v137
v_mfma_f32_16x16x32_bf16 v[176:179], a[180:183], v[20:23], v[176:179]
s_waitcnt lgkmcnt(10)
v_exp_f32 v139, v139
v_mfma_f32_16x16x32_bf16 a[0:3], a[224:227], v[208:211], a[0:3]
v_exp_f32 v152, v152
v_mfma_f32_16x16x32_bf16 a[32:35], a[224:227], v[212:215], a[32:35]
ds_read_b128 a[200:203], v2 offset:2048
v_cvt_pk_bf16_f32 v201, v138, v139
v_mfma_f32_16x16x32_bf16 a[64:67], a[224:227], v[216:219], a[64:67]
buffer_load_dwordx4 v1, s[44:47], s72 offen offset:2048 sc1 lds
v_mfma_f32_16x16x32_bf16 a[96:99], a[224:227], v[220:223], a[96:99]
v_exp_f32 v153, v153
v_mfma_f32_16x16x32_bf16 a[100:103], a[228:231], v[220:223], a[100:103]
v_exp_f32 v154, v154
v_mfma_f32_16x16x32_bf16 a[68:71], a[228:231], v[216:219], a[68:71]
ds_read_b128 a[204:207], v2 offset:3072
v_cvt_pk_bf16_f32 v202, v152, v153
v_mfma_f32_16x16x32_bf16 a[36:39], a[228:231], v[212:215], a[36:39]
v_exp_f32 v155, v155
v_mfma_f32_16x16x32_bf16 a[4:7], a[228:231], v[208:211], a[4:7]
v_exp_f32 v140, v140
v_mfma_f32_16x16x32_bf16 a[8:11], a[232:235], v[208:211], a[8:11]
ds_read_b128 a[208:211], v2 offset:4096
v_cvt_pk_bf16_f32 v203, v154, v155
v_mfma_f32_16x16x32_bf16 a[40:43], a[232:235], v[212:215], a[40:43]
v_exp_f32 v141, v141
v_mfma_f32_16x16x32_bf16 a[72:75], a[232:235], v[216:219], a[72:75]
v_exp_f32 v142, v142
v_mfma_f32_16x16x32_bf16 a[104:107], a[232:235], v[220:223], a[104:107]
ds_read_b128 a[212:215], v2 offset:5120
v_cvt_pk_bf16_f32 v204, v140, v141
v_mfma_f32_16x16x32_bf16 a[108:111], a[236:239], v[220:223], a[108:111]
v_exp_f32 v143, v143
v_mfma_f32_16x16x32_bf16 a[76:79], a[236:239], v[216:219], a[76:79]
v_exp_f32 v156, v156
v_mfma_f32_16x16x32_bf16 a[44:47], a[236:239], v[212:215], a[44:47]
ds_read_b128 a[216:219], v2 offset:6144
v_cvt_pk_bf16_f32 v205, v142, v143
v_mfma_f32_16x16x32_bf16 a[12:15], a[236:239], v[208:211], a[12:15]
buffer_load_dwordx4 v1, s[44:47], s72 offen offset:3072 sc1 lds
v_mfma_f32_16x16x32_bf16 a[16:19], a[240:243], v[208:211], a[16:19]
v_exp_f32 v157, v157
v_mfma_f32_16x16x32_bf16 a[48:51], a[240:243], v[212:215], a[48:51]
v_exp_f32 v158, v158
v_mfma_f32_16x16x32_bf16 a[80:83], a[240:243], v[216:219], a[80:83]
ds_read_b128 a[220:223], v2 offset:7168
v_cvt_pk_bf16_f32 v206, v156, v157
v_mfma_f32_16x16x32_bf16 a[112:115], a[240:243], v[220:223], a[112:115]
v_exp_f32 v159, v159
v_mfma_f32_16x16x32_bf16 a[116:119], a[244:247], v[220:223], a[116:119]
v_cvt_pk_bf16_f32 v207, v158, v159
v_lshl_add_u32 v248, v241, 3, v240
v_mfma_f32_16x16x32_bf16 a[84:87], a[244:247], v[216:219], a[84:87]
v_sub_u32 v248, 15, v248
v_and_b32 v249, 1, v248
v_mfma_f32_16x16x32_bf16 a[52:55], a[244:247], v[212:215], a[52:55]
v_lshlrev_b32 v249, 4, v249
v_lshlrev_b32 v249, v249, s73
v_mfma_f32_16x16x32_bf16 a[20:23], a[244:247], v[208:211], a[20:23]
v_lshrrev_b32 v248, 1, v248
v_and_b32 v241, 3, v0
v_mfma_f32_16x16x32_bf16 a[24:27], a[248:251], v[208:211], a[24:27]
v_cmp_eq_u32 vcc, 0, v248
v_lshl_add_u32 v5, v241, 3, v5
v_mfma_f32_16x16x32_bf16 a[56:59], a[248:251], v[212:215], a[56:59]
v_cndmask_b32 v8, 0, v249, vcc
v_cmp_eq_u32 vcc, 1, v248
v_mfma_f32_16x16x32_bf16 a[88:91], a[248:251], v[216:219], a[88:91]
v_lshlrev_b32 v240, 4, v251
v_cndmask_b32 v9, 0, v249, vcc
v_mfma_f32_16x16x32_bf16 a[120:123], a[248:251], v[220:223], a[120:123]
v_cmp_eq_u32 vcc, 2, v248
v_sub_u32 v240, 48, v240
v_mfma_f32_16x16x32_bf16 a[124:127], a[252:255], v[220:223], a[124:127]
v_lshlrev_b64 v[12:13], 16, s[88:89]
v_cndmask_b32 v10, 0, v249, vcc
v_mfma_f32_16x16x32_bf16 a[92:95], a[252:255], v[216:219], a[92:95]
v_cmp_eq_u32 vcc, 3, v248
v_lshlrev_b64 v[12:13], v240, v[12:13]
v_mfma_f32_16x16x32_bf16 a[60:63], a[252:255], v[212:215], a[60:63]
v_cndmask_b32 v11, 0, v249, vcc
v_cmp_eq_u32 vcc, 3, v241
v_mfma_f32_16x16x32_bf16 a[28:31], a[252:255], v[208:211], a[28:31]
s_add_u32 s73, s62, 4096
v_lshl_add_u32 v14, v0, 3, s73
v_cndmask_b32 v12, 0, v12, vcc
v_mfma_f32_16x16x32_bf16 v[224:227], v[120:123], v[208:211], v[224:227]
v_cndmask_b32 v13, 0, v13, vcc
v_lshrrev_b32 v15, 4, v0
v_mfma_f32_16x16x32_bf16 v[228:231], v[120:123], v[212:215], v[228:231]
v_lshlrev_b32 v15, 1, v15
v_and_b32 v240, 7, v0
v_mfma_f32_16x16x32_bf16 v[232:235], v[120:123], v[216:219], v[232:235]
v_xor_b32 v15, v15, v240
v_lshlrev_b32 v15, 4, v15
v_mfma_f32_16x16x32_bf16 v[236:239], v[120:123], v[220:223], v[236:239]
s_waitcnt lgkmcnt(8)
v_mfma_f32_16x16x32_bf16 v[136:139], a[128:131], v[48:51], v[88:91]
s_add_u32 s82, s82, 0x8000
ds_read_b128 a[160:163], v2 offset:24576
ds_read_b128 a[164:167], v2 offset:25600
v_mfma_f32_16x16x32_bf16 v[136:139], a[132:135], v[52:55], v[136:139]
s_and_b32 s82, s82, 0x1ffff
v_exp_f32 v160, v160
v_mfma_f32_16x16x32_bf16 v[136:139], a[136:139], v[56:59], v[136:139]
s_add_u32 m0, s74, 0
v_exp_f32 v161, v161
v_mfma_f32_16x16x32_bf16 v[136:139], a[140:143], v[60:63], v[136:139]
s_add_u32 s72, s81, 0
v_exp_f32 v162, v162
v_mfma_f32_16x16x32_bf16 v[140:143], a[140:143], v[76:79], v[92:95]
v_exp_f32 v163, v163
v_mfma_f32_16x16x32_bf16 v[140:143], a[136:139], v[72:75], v[140:143]
ds_read_b128 a[168:171], v2 offset:26624
v_cvt_pk_bf16_f32 v208, v160, v161
v_mfma_f32_16x16x32_bf16 v[140:143], a[132:135], v[68:71], v[140:143]
v_exp_f32 v176, v176
v_mfma_f32_16x16x32_bf16 v[140:143], a[128:131], v[64:67], v[140:143]
buffer_load_dwordx4 v1, s[44:47], s72 offen sc1 lds
v_mfma_f32_16x16x32_bf16 v[156:159], a[144:147], v[64:67], v[92:95]
v_exp_f32 v177, v177
v_mfma_f32_16x16x32_bf16 v[156:159], a[148:151], v[68:71], v[156:159]
ds_read_b128 a[172:175], v2 offset:27648
v_cvt_pk_bf16_f32 v209, v162, v163
v_mfma_f32_16x16x32_bf16 v[156:159], a[152:155], v[72:75], v[156:159]
v_exp_f32 v178, v178
v_mfma_f32_16x16x32_bf16 v[156:159], a[156:159], v[76:79], v[156:159]
v_exp_f32 v179, v179
v_mfma_f32_16x16x32_bf16 v[152:155], a[156:159], v[60:63], v[88:91]
ds_read_b128 a[176:179], v2 offset:28672
v_cvt_pk_bf16_f32 v210, v176, v177
v_mfma_f32_16x16x32_bf16 v[152:155], a[152:155], v[56:59], v[152:155]
v_exp_f32 v164, v164
v_mfma_f32_16x16x32_bf16 v[152:155], a[148:151], v[52:55], v[152:155]
v_exp_f32 v165, v165
v_mfma_f32_16x16x32_bf16 v[152:155], a[144:147], v[48:51], v[152:155]
s_waitcnt lgkmcnt(5)
ds_read_b128 a[180:183], v2 offset:29696
v_cvt_pk_bf16_f32 v211, v178, v179
v_mfma_f32_16x16x32_bf16 a[0:3], a[192:195], v[192:195], a[0:3]
v_exp_f32 v166, v166
v_mfma_f32_16x16x32_bf16 a[32:35], a[192:195], v[196:199], a[32:35]
v_exp_f32 v167, v167
v_mfma_f32_16x16x32_bf16 a[64:67], a[192:195], v[200:203], a[64:67]
ds_read_b128 a[184:187], v2 offset:30720
v_cvt_pk_bf16_f32 v212, v164, v165
v_mfma_f32_16x16x32_bf16 a[96:99], a[192:195], v[204:207], a[96:99]
v_exp_f32 v180, v180
v_mfma_f32_16x16x32_bf16 a[100:103], a[196:199], v[204:207], a[100:103]
buffer_load_dwordx4 v1, s[44:47], s72 offen offset:1024 sc1 lds
v_mfma_f32_16x16x32_bf16 a[68:71], a[196:199], v[200:203], a[68:71]
v_exp_f32 v181, v181
v_mfma_f32_16x16x32_bf16 a[36:39], a[196:199], v[196:199], a[36:39]
ds_read_b128 a[188:191], v2 offset:31744
v_cvt_pk_bf16_f32 v213, v166, v167
v_mfma_f32_16x16x32_bf16 a[4:7], a[196:199], v[192:195], a[4:7]
v_exp_f32 v182, v182
v_mfma_f32_16x16x32_bf16 a[8:11], a[200:203], v[192:195], a[8:11]
v_exp_f32 v183, v183
v_mfma_f32_16x16x32_bf16 a[40:43], a[200:203], v[196:199], a[40:43]
ds_read_b128 a[224:227], v2 offset:8192
v_cvt_pk_bf16_f32 v214, v180, v181
v_mfma_f32_16x16x32_bf16 a[72:75], a[200:203], v[200:203], a[72:75]
v_exp_f32 v168, v168
v_mfma_f32_16x16x32_bf16 a[104:107], a[200:203], v[204:207], a[104:107]
v_exp_f32 v169, v169
v_mfma_f32_16x16x32_bf16 a[108:111], a[204:207], v[204:207], a[108:111]
ds_read_b128 a[228:231], v2 offset:9216
v_cvt_pk_bf16_f32 v215, v182, v183
v_mfma_f32_16x16x32_bf16 a[76:79], a[204:207], v[200:203], a[76:79]
v_exp_f32 v170, v170
v_mfma_f32_16x16x32_bf16 a[44:47], a[204:207], v[196:199], a[44:47]
v_exp_f32 v171, v171
v_mfma_f32_16x16x32_bf16 a[12:15], a[204:207], v[192:195], a[12:15]
ds_read_b128 a[232:235], v2 offset:10240
v_cvt_pk_bf16_f32 v216, v168, v169
v_mfma_f32_16x16x32_bf16 a[16:19], a[208:211], v[192:195], a[16:19]
v_exp_f32 v184, v184
v_mfma_f32_16x16x32_bf16 a[48:51], a[208:211], v[196:199], a[48:51]
buffer_load_dwordx4 v1, s[44:47], s72 offen offset:2048 sc1 lds
v_mfma_f32_16x16x32_bf16 a[80:83], a[208:211], v[200:203], a[80:83]
v_exp_f32 v185, v185
v_mfma_f32_16x16x32_bf16 a[112:115], a[208:211], v[204:207], a[112:115]
ds_read_b128 a[236:239], v2 offset:11264
v_cvt_pk_bf16_f32 v217, v170, v171
v_mfma_f32_16x16x32_bf16 a[116:119], a[212:215], v[204:207], a[116:119]
v_exp_f32 v186, v186
v_mfma_f32_16x16x32_bf16 a[84:87], a[212:215], v[200:203], a[84:87]
v_exp_f32 v187, v187
v_mfma_f32_16x16x32_bf16 a[52:55], a[212:215], v[196:199], a[52:55]
ds_read_b128 a[240:243], v2 offset:12288
v_cvt_pk_bf16_f32 v218, v184, v185
v_mfma_f32_16x16x32_bf16 a[20:23], a[212:215], v[192:195], a[20:23]
v_exp_f32 v172, v172
v_mfma_f32_16x16x32_bf16 a[24:27], a[216:219], v[192:195], a[24:27]
v_exp_f32 v173, v173
v_mfma_f32_16x16x32_bf16 a[56:59], a[216:219], v[196:199], a[56:59]
ds_read_b128 a[244:247], v2 offset:13312
v_cvt_pk_bf16_f32 v219, v186, v187
v_mfma_f32_16x16x32_bf16 a[88:91], a[216:219], v[200:203], a[88:91]
v_exp_f32 v174, v174
v_mfma_f32_16x16x32_bf16 a[120:123], a[216:219], v[204:207], a[120:123]
v_exp_f32 v175, v175
v_mfma_f32_16x16x32_bf16 a[124:127], a[220:223], v[204:207], a[124:127]
ds_read_b128 a[248:251], v2 offset:14336
v_cvt_pk_bf16_f32 v220, v172, v173
v_mfma_f32_16x16x32_bf16 a[92:95], a[220:223], v[200:203], a[92:95]
v_exp_f32 v188, v188
v_mfma_f32_16x16x32_bf16 a[60:63], a[220:223], v[196:199], a[60:63]
buffer_load_dwordx4 v1, s[44:47], s72 offen offset:3072 sc1 lds
v_mfma_f32_16x16x32_bf16 a[28:31], a[220:223], v[192:195], a[28:31]
v_exp_f32 v189, v189
v_mfma_f32_16x16x32_bf16 v[224:227], v[120:123], v[192:195], v[224:227]
ds_read_b128 a[252:255], v2 offset:15360
v_cvt_pk_bf16_f32 v221, v174, v175
v_mfma_f32_16x16x32_bf16 v[228:231], v[120:123], v[196:199], v[228:231]
v_exp_f32 v190, v190
v_mfma_f32_16x16x32_bf16 v[232:235], v[120:123], v[200:203], v[232:235]
s_waitcnt vmcnt(8) lgkmcnt(8)
v_exp_f32 v191, v191
v_mfma_f32_16x16x32_bf16 v[236:239], v[120:123], v[204:207], v[236:239]
s_barrier
v_cvt_pk_bf16_f32 v222, v188, v189
v_cvt_pk_bf16_f32 v223, v190, v191
v_add_u32 v2, s82, v1
v_mfma_f32_16x16x32_bf16 v[168:171], a[160:163], v[48:51], v[88:91]
s_xor_b32 s74, s82, 0x10000
v_exp_f32 v136, v136
v_mfma_f32_16x16x32_bf16 v[168:171], a[164:167], v[52:55], v[168:171]
s_add_u32 s74, s74, s64
ds_read_b128 a[128:131], v2 offset:16384
v_mfma_f32_16x16x32_bf16 v[168:171], a[168:171], v[56:59], v[168:171]
s_add_u32 s81, s81, 0x8000
v_exp_f32 v137, v137
v_mfma_f32_16x16x32_bf16 v[168:171], a[172:175], v[60:63], v[168:171]
s_add_u32 m0, s74, 16384
ds_read_b128 a[132:135], v2 offset:17408
v_cvt_pk_bf16_f32 v200, v136, v137
v_mfma_f32_16x16x32_bf16 v[172:175], a[172:175], v[76:79], v[92:95]
s_add_u32 s72, s81, 16384
buffer_load_dwordx4 v1, s[44:47], s72 offen sc1 lds
v_mfma_f32_16x16x32_bf16 v[172:175], a[168:171], v[72:75], v[172:175]
v_exp_f32 v138, v138
v_mfma_f32_16x16x32_bf16 v[172:175], a[164:167], v[68:71], v[172:175]
ds_read_b128 a[136:139], v2 offset:18432
v_lshrrev_b32 v240, 3, v0
v_mfma_f32_16x16x32_bf16 v[172:175], a[160:163], v[64:67], v[172:175]
v_exp_f32 v139, v139
v_mfma_f32_16x16x32_bf16 v[188:191], a[176:179], v[64:67], v[92:95]
ds_read_b128 a[140:143], v2 offset:19456
v_cvt_pk_bf16_f32 v201, v138, v139
v_mfma_f32_16x16x32_bf16 v[188:191], a[180:183], v[68:71], v[188:191]
buffer_load_dwordx4 v1, s[44:47], s72 offen offset:1024 sc1 lds
v_mfma_f32_16x16x32_bf16 v[188:191], a[184:187], v[72:75], v[188:191]
v_exp_f32 v152, v152
v_mfma_f32_16x16x32_bf16 v[188:191], a[188:191], v[76:79], v[188:191]
ds_read_b128 a[144:147], v2 offset:20480
v_lshl_add_u32 v15, v240, 11, v15
v_mfma_f32_16x16x32_bf16 v[184:187], a[188:191], v[60:63], v[88:91]
s_lshr_b32 s75, s59, 3
v_exp_f32 v153, v153
v_mfma_f32_16x16x32_bf16 v[184:187], a[184:187], v[56:59], v[184:187]
s_lshl_b32 s75, s75, 2
ds_read_b128 a[148:151], v2 offset:21504
v_cvt_pk_bf16_f32 v202, v152, v153
v_mfma_f32_16x16x32_bf16 v[184:187], a[180:183], v[52:55], v[184:187]
s_add_u32 s75, s75, s65
buffer_load_dwordx4 v1, s[44:47], s72 offen offset:2048 sc1 lds
v_mfma_f32_16x16x32_bf16 v[184:187], a[176:179], v[48:51], v[184:187]
s_waitcnt lgkmcnt(6)
v_exp_f32 v154, v154
v_mfma_f32_16x16x32_bf16 a[0:3], a[224:227], v[208:211], a[0:3]
s_lshl_b32 s76, s59, 1
ds_read_b128 a[152:155], v2 offset:22528
v_mfma_f32_16x16x32_bf16 a[32:35], a[224:227], v[212:215], a[32:35]
s_and_b32 s76, s76, 8
v_exp_f32 v155, v155
v_mfma_f32_16x16x32_bf16 a[64:67], a[224:227], v[216:219], a[64:67]
s_add_u32 s76, s76, s60
ds_read_b128 a[156:159], v2 offset:23552
v_cvt_pk_bf16_f32 v203, v154, v155
v_mfma_f32_16x16x32_bf16 a[96:99], a[224:227], v[220:223], a[96:99]
s_lshl_b32 s94, s58, 16
buffer_load_dwordx4 v1, s[44:47], s72 offen offset:3072 sc1 lds
v_mfma_f32_16x16x32_bf16 a[100:103], a[228:231], v[220:223], a[100:103]
s_add_u32 m0, s66, 32
v_exp_f32 v140, v140
v_mfma_f32_16x16x32_bf16 a[68:71], a[228:231], v[216:219], a[68:71]
s_add_u32 s72, s93, 0x2
ds_read_b128 a[192:195], v2 offset:0
v_mfma_f32_16x16x32_bf16 a[36:39], a[228:231], v[212:215], a[36:39]
s_lshl_b32 s80, s76, 7
v_exp_f32 v141, v141
v_mfma_f32_16x16x32_bf16 a[4:7], a[228:231], v[208:211], a[4:7]
s_add_u32 s94, s94, s80
ds_read_b128 a[196:199], v2 offset:1024
v_cvt_pk_bf16_f32 v204, v140, v141
v_mfma_f32_16x16x32_bf16 a[8:11], a[232:235], v[208:211], a[8:11]
s_lshl_b32 s80, s75, 18
buffer_load_dwordx4 v1, s[36:39], s72 offen lds
v_mfma_f32_16x16x32_bf16 a[40:43], a[232:235], v[212:215], a[40:43]
s_add_u32 s80, s80, s94
v_exp_f32 v142, v142
v_mfma_f32_16x16x32_bf16 a[72:75], a[232:235], v[216:219], a[72:75]
ds_read_b128 a[200:203], v2 offset:2048
v_mfma_f32_16x16x32_bf16 a[104:107], a[232:235], v[220:223], a[104:107]
v_exp_f32 v143, v143
v_mfma_f32_16x16x32_bf16 a[108:111], a[236:239], v[220:223], a[108:111]
ds_read_b128 a[204:207], v2 offset:3072
v_cvt_pk_bf16_f32 v205, v142, v143
v_mfma_f32_16x16x32_bf16 a[76:79], a[236:239], v[216:219], a[76:79]
buffer_load_dwordx4 v1, s[36:39], s72 offen offset:1024 lds
v_mfma_f32_16x16x32_bf16 a[44:47], a[236:239], v[212:215], a[44:47]
v_exp_f32 v156, v156
v_mfma_f32_16x16x32_bf16 a[12:15], a[236:239], v[208:211], a[12:15]
ds_read_b128 a[208:211], v2 offset:4096
v_mfma_f32_16x16x32_bf16 a[16:19], a[240:243], v[208:211], a[16:19]
v_exp_f32 v157, v157
v_mfma_f32_16x16x32_bf16 a[48:51], a[240:243], v[212:215], a[48:51]
ds_read_b128 a[212:215], v2 offset:5120
v_cvt_pk_bf16_f32 v206, v156, v157
v_mfma_f32_16x16x32_bf16 a[80:83], a[240:243], v[216:219], a[80:83]
buffer_load_dwordx4 v1, s[36:39], s72 offen offset:2048 lds
v_mfma_f32_16x16x32_bf16 a[112:115], a[240:243], v[220:223], a[112:115]
v_exp_f32 v158, v158
v_mfma_f32_16x16x32_bf16 a[116:119], a[244:247], v[220:223], a[116:119]
ds_read_b128 a[216:219], v2 offset:6144
v_mfma_f32_16x16x32_bf16 a[84:87], a[244:247], v[216:219], a[84:87]
v_exp_f32 v159, v159
v_mfma_f32_16x16x32_bf16 a[52:55], a[244:247], v[212:215], a[52:55]
ds_read_b128 a[220:223], v2 offset:7168
v_cvt_pk_bf16_f32 v207, v158, v159
v_mfma_f32_16x16x32_bf16 a[20:23], a[244:247], v[208:211], a[20:23]
buffer_load_dwordx4 v1, s[36:39], s72 offen offset:3072 lds
v_mfma_f32_16x16x32_bf16 a[24:27], a[248:251], v[208:211], a[24:27]
v_mfma_f32_16x16x32_bf16 a[56:59], a[248:251], v[212:215], a[56:59]
v_mfma_f32_16x16x32_bf16 a[88:91], a[248:251], v[216:219], a[88:91]
v_mfma_f32_16x16x32_bf16 a[120:123], a[248:251], v[220:223], a[120:123]
v_mfma_f32_16x16x32_bf16 a[124:127], a[252:255], v[220:223], a[124:127]
v_mfma_f32_16x16x32_bf16 a[92:95], a[252:255], v[216:219], a[92:95]
v_mfma_f32_16x16x32_bf16 a[60:63], a[252:255], v[212:215], a[60:63]
v_mfma_f32_16x16x32_bf16 a[28:31], a[252:255], v[208:211], a[28:31]
v_mfma_f32_16x16x32_bf16 v[224:227], v[120:123], v[208:211], v[224:227]
v_mfma_f32_16x16x32_bf16 v[228:231], v[120:123], v[212:215], v[228:231]
v_mfma_f32_16x16x32_bf16 v[232:235], v[120:123], v[216:219], v[232:235]
v_mfma_f32_16x16x32_bf16 v[236:239], v[120:123], v[220:223], v[236:239]
s_waitcnt lgkmcnt(8)
s_nop 3
v_rcp_f32 v224, v224
v_rcp_f32 v228, v228
s_lshl_b32 s73, s59, 12
s_add_u32 s73, s73, 0x2000000
s_lshl_b32 s70, s67, 2
s_add_u32 s70, s70, s73
v_mov_b32 v225, v224
v_accvgpr_read_b32 v240, a0
v_accvgpr_read_b32 v241, a1
v_accvgpr_read_b32 v242, a2
v_accvgpr_read_b32 v243, a3
v_accvgpr_read_b32 v244, a4
v_accvgpr_read_b32 v245, a5
v_accvgpr_read_b32 v246, a6
v_accvgpr_read_b32 v247, a7
v_pk_mul_f32 v[240:241], v[240:241], v[224:225]
v_pk_mul_f32 v[242:243], v[242:243], v[224:225]
v_pk_mul_f32 v[244:245], v[244:245], v[224:225]
v_pk_mul_f32 v[246:247], v[246:247], v[224:225]
v_cvt_pk_bf16_f32 v128, v240, v241
v_cvt_pk_bf16_f32 v129, v242, v243
v_cvt_pk_bf16_f32 v130, v244, v245
v_cvt_pk_bf16_f32 v131, v246, v247
v_accvgpr_read_b32 v248, a8
v_accvgpr_read_b32 v249, a9
v_accvgpr_read_b32 v250, a10
v_accvgpr_read_b32 v251, a11
v_accvgpr_read_b32 v252, a12
v_accvgpr_read_b32 v253, a13
v_accvgpr_read_b32 v254, a14
v_accvgpr_read_b32 v255, a15
v_pk_mul_f32 v[248:249], v[248:249], v[224:225]
v_pk_mul_f32 v[250:251], v[250:251], v[224:225]
v_pk_mul_f32 v[252:253], v[252:253], v[224:225]
v_pk_mul_f32 v[254:255], v[254:255], v[224:225]
v_cvt_pk_bf16_f32 v144, v248, v249
v_cvt_pk_bf16_f32 v145, v250, v251
v_cvt_pk_bf16_f32 v146, v252, v253
v_cvt_pk_bf16_f32 v147, v254, v255
v_accvgpr_read_b32 v240, a16
v_accvgpr_read_b32 v241, a17
v_accvgpr_read_b32 v242, a18
v_accvgpr_read_b32 v243, a19
v_accvgpr_read_b32 v244, a20
v_accvgpr_read_b32 v245, a21
v_accvgpr_read_b32 v246, a22
v_accvgpr_read_b32 v247, a23
v_pk_mul_f32 v[240:241], v[240:241], v[224:225]
v_pk_mul_f32 v[242:243], v[242:243], v[224:225]
v_pk_mul_f32 v[244:245], v[244:245], v[224:225]
v_pk_mul_f32 v[246:247], v[246:247], v[224:225]
v_cvt_pk_bf16_f32 v160, v240, v241
v_cvt_pk_bf16_f32 v161, v242, v243
v_cvt_pk_bf16_f32 v162, v244, v245
v_cvt_pk_bf16_f32 v163, v246, v247
v_accvgpr_read_b32 v248, a24
v_accvgpr_read_b32 v249, a25
v_accvgpr_read_b32 v250, a26
v_accvgpr_read_b32 v251, a27
v_accvgpr_read_b32 v252, a28
v_accvgpr_read_b32 v253, a29
v_accvgpr_read_b32 v254, a30
v_accvgpr_read_b32 v255, a31
v_pk_mul_f32 v[248:249], v[248:249], v[224:225]
v_pk_mul_f32 v[250:251], v[250:251], v[224:225]
v_pk_mul_f32 v[252:253], v[252:253], v[224:225]
v_pk_mul_f32 v[254:255], v[254:255], v[224:225]
v_cvt_pk_bf16_f32 v176, v248, v249
v_cvt_pk_bf16_f32 v177, v250, v251
v_cvt_pk_bf16_f32 v178, v252, v253
v_cvt_pk_bf16_f32 v179, v254, v255
v_mov_b32 v229, v228
v_accvgpr_read_b32 v240, a32
v_accvgpr_read_b32 v241, a33
v_accvgpr_read_b32 v242, a34
v_accvgpr_read_b32 v243, a35
v_accvgpr_read_b32 v244, a36
v_accvgpr_read_b32 v245, a37
v_accvgpr_read_b32 v246, a38
v_accvgpr_read_b32 v247, a39
v_pk_mul_f32 v[240:241], v[240:241], v[228:229]
v_pk_mul_f32 v[242:243], v[242:243], v[228:229]
v_pk_mul_f32 v[244:245], v[244:245], v[228:229]
v_pk_mul_f32 v[246:247], v[246:247], v[228:229]
v_cvt_pk_bf16_f32 v132, v240, v241
v_cvt_pk_bf16_f32 v133, v242, v243
v_cvt_pk_bf16_f32 v134, v244, v245
v_cvt_pk_bf16_f32 v135, v246, v247
v_accvgpr_read_b32 v248, a40
v_accvgpr_read_b32 v249, a41
v_accvgpr_read_b32 v250, a42
v_accvgpr_read_b32 v251, a43
v_accvgpr_read_b32 v252, a44
v_accvgpr_read_b32 v253, a45
v_accvgpr_read_b32 v254, a46
v_accvgpr_read_b32 v255, a47
v_pk_mul_f32 v[248:249], v[248:249], v[228:229]
v_pk_mul_f32 v[250:251], v[250:251], v[228:229]
v_pk_mul_f32 v[252:253], v[252:253], v[228:229]
v_pk_mul_f32 v[254:255], v[254:255], v[228:229]
v_cvt_pk_bf16_f32 v148, v248, v249
v_cvt_pk_bf16_f32 v149, v250, v251
v_cvt_pk_bf16_f32 v150, v252, v253
v_cvt_pk_bf16_f32 v151, v254, v255
v_accvgpr_read_b32 v240, a48
v_accvgpr_read_b32 v241, a49
v_accvgpr_read_b32 v242, a50
v_accvgpr_read_b32 v243, a51
v_accvgpr_read_b32 v244, a52
v_accvgpr_read_b32 v245, a53
v_accvgpr_read_b32 v246, a54
v_accvgpr_read_b32 v247, a55
v_pk_mul_f32 v[240:241], v[240:241], v[228:229]
v_pk_mul_f32 v[242:243], v[242:243], v[228:229]
v_pk_mul_f32 v[244:245], v[244:245], v[228:229]
v_pk_mul_f32 v[246:247], v[246:247], v[228:229]
v_cvt_pk_bf16_f32 v164, v240, v241
v_cvt_pk_bf16_f32 v165, v242, v243
v_cvt_pk_bf16_f32 v166, v244, v245
v_cvt_pk_bf16_f32 v167, v246, v247
v_accvgpr_read_b32 v248, a56
v_accvgpr_read_b32 v249, a57
v_accvgpr_read_b32 v250, a58
v_accvgpr_read_b32 v251, a59
v_accvgpr_read_b32 v252, a60
v_accvgpr_read_b32 v253, a61
v_accvgpr_read_b32 v254, a62
v_accvgpr_read_b32 v255, a63
v_pk_mul_f32 v[248:249], v[248:249], v[228:229]
v_pk_mul_f32 v[250:251], v[250:251], v[228:229]
v_pk_mul_f32 v[252:253], v[252:253], v[228:229]
Lstub3:
s_cbranch_execz Lret
v_pk_mul_f32 v[254:255], v[254:255], v[228:229]
v_cvt_pk_bf16_f32 v180, v248, v249
v_cvt_pk_bf16_f32 v181, v250, v251
v_cvt_pk_bf16_f32 v182, v252, v253
v_cvt_pk_bf16_f32 v183, v254, v255
v_mfma_f32_16x16x32_bf16 v[136:139], a[128:131], v[48:51], v[88:91]
s_add_u32 s82, s82, 0x8000
ds_read_b128 a[160:163], v2 offset:24576
ds_read_b128 a[164:167], v2 offset:25600
v_mfma_f32_16x16x32_bf16 v[136:139], a[132:135], v[52:55], v[136:139]
s_and_b32 s82, s82, 0x1ffff
v_exp_f32 v168, v168
v_mfma_f32_16x16x32_bf16 v[136:139], a[136:139], v[56:59], v[136:139]
s_add_u32 m0, s74, 0
v_exp_f32 v169, v169
v_mfma_f32_16x16x32_bf16 v[136:139], a[140:143], v[60:63], v[136:139]
s_add_u32 s72, s81, 0
buffer_load_dwordx4 v1, s[44:47], s72 offen sc1 lds
v_mfma_f32_16x16x32_bf16 v[140:143], a[140:143], v[76:79], v[92:95]
ds_read_b128 a[168:171], v2 offset:26624
v_cvt_pk_bf16_f32 v216, v168, v169
v_mfma_f32_16x16x32_bf16 v[140:143], a[136:139], v[72:75], v[140:143]
v_exp_f32 v170, v170
v_mfma_f32_16x16x32_bf16 v[140:143], a[132:135], v[68:71], v[140:143]
ds_read_b128 a[172:175], v2 offset:27648
ds_read_b128 a[176:179], v2 offset:28672
v_mfma_f32_16x16x32_bf16 v[140:143], a[128:131], v[64:67], v[140:143]
v_exp_f32 v171, v171
v_mfma_f32_16x16x32_bf16 v[156:159], a[144:147], v[64:67], v[92:95]
v_exp_f32 v184, v184
v_mfma_f32_16x16x32_bf16 v[156:159], a[148:151], v[68:71], v[156:159]
buffer_store_dwordx4 v[128:131], v1, s[44:47], s70 offen sc1
v_mfma_f32_16x16x32_bf16 v[156:159], a[152:155], v[72:75], v[156:159]
ds_read_b128 a[180:183], v2 offset:29696
v_cvt_pk_bf16_f32 v217, v170, v171
v_mfma_f32_16x16x32_bf16 v[156:159], a[156:159], v[76:79], v[156:159]
v_exp_f32 v185, v185
v_mfma_f32_16x16x32_bf16 v[152:155], a[156:159], v[60:63], v[88:91]
ds_read_b128 a[184:187], v2 offset:30720
v_cvt_pk_bf16_f32 v218, v184, v185
v_mfma_f32_16x16x32_bf16 v[152:155], a[152:155], v[56:59], v[152:155]
v_exp_f32 v186, v186
v_mfma_f32_16x16x32_bf16 v[152:155], a[148:151], v[52:55], v[152:155]
buffer_load_dwordx4 v1, s[44:47], s72 offen offset:1024 sc1 lds
v_mfma_f32_16x16x32_bf16 v[152:155], a[144:147], v[48:51], v[152:155]
s_waitcnt lgkmcnt(7)
ds_read_b128 a[188:191], v2 offset:31744
ds_read_b128 a[224:227], v2 offset:8192
v_mfma_f32_16x16x32_bf16 a[64:67], a[192:195], v[200:203], a[64:67]
v_exp_f32 v187, v187
v_mfma_f32_16x16x32_bf16 a[96:99], a[192:195], v[204:207], a[96:99]
v_exp_f32 v172, v172
v_mfma_f32_16x16x32_bf16 a[100:103], a[196:199], v[204:207], a[100:103]
ds_read_b128 a[228:231], v2 offset:9216
v_cvt_pk_bf16_f32 v219, v186, v187
v_mfma_f32_16x16x32_bf16 a[68:71], a[196:199], v[200:203], a[68:71]
v_exp_f32 v173, v173
v_mfma_f32_16x16x32_bf16 a[72:75], a[200:203], v[200:203], a[72:75]
buffer_store_dwordx4 v[144:147], v1, s[44:47], s70 offen offset:1024 sc1
v_mfma_f32_16x16x32_bf16 a[104:107], a[200:203], v[204:207], a[104:107]
ds_read_b128 a[232:235], v2 offset:10240
v_cvt_pk_bf16_f32 v220, v172, v173
v_mfma_f32_16x16x32_bf16 a[108:111], a[204:207], v[204:207], a[108:111]
v_exp_f32 v174, v174
v_mfma_f32_16x16x32_bf16 a[76:79], a[204:207], v[200:203], a[76:79]
ds_read_b128 a[236:239], v2 offset:11264
ds_read_b128 a[240:243], v2 offset:12288
v_mfma_f32_16x16x32_bf16 a[80:83], a[208:211], v[200:203], a[80:83]
v_exp_f32 v175, v175
v_mfma_f32_16x16x32_bf16 a[112:115], a[208:211], v[204:207], a[112:115]
buffer_load_dwordx4 v1, s[44:47], s72 offen offset:2048 sc1 lds
v_mfma_f32_16x16x32_bf16 a[116:119], a[212:215], v[204:207], a[116:119]
v_exp_f32 v188, v188
v_mfma_f32_16x16x32_bf16 a[84:87], a[212:215], v[200:203], a[84:87]
ds_read_b128 a[244:247], v2 offset:13312
v_cvt_pk_bf16_f32 v221, v174, v175
v_mfma_f32_16x16x32_bf16 a[88:91], a[216:219], v[200:203], a[88:91]
v_exp_f32 v189, v189
v_mfma_f32_16x16x32_bf16 a[120:123], a[216:219], v[204:207], a[120:123]
ds_read_b128 a[248:251], v2 offset:14336
ds_read_b128 a[252:255], v2 offset:15360
v_mfma_f32_16x16x32_bf16 a[124:127], a[220:223], v[204:207], a[124:127]
v_exp_f32 v190, v190
v_mfma_f32_16x16x32_bf16 a[92:95], a[220:223], v[200:203], a[92:95]
buffer_load_dwordx4 v1, s[44:47], s72 offen offset:3072 sc1 lds
v_mfma_f32_16x16x32_bf16 v[232:235], v[120:123], v[200:203], v[232:235]
s_waitcnt vmcnt(14) lgkmcnt(8)
v_exp_f32 v191, v191
v_mfma_f32_16x16x32_bf16 v[236:239], v[120:123], v[204:207], v[236:239]
s_barrier
v_cvt_pk_bf16_f32 v222, v188, v189
v_cvt_pk_bf16_f32 v223, v190, v191
v_add_u32 v2, s82, v1
v_mfma_f32_16x16x32_bf16 v[168:171], a[160:163], v[48:51], v[88:91]
s_xor_b32 s74, s82, 0x10000
v_exp_f32 v136, v136
v_mfma_f32_16x16x32_bf16 v[168:171], a[164:167], v[52:55], v[168:171]
s_add_u32 s74, s74, s64
ds_read_b128 a[128:131], v2 offset:16384
ds_read_b128 a[132:135], v2 offset:17408
v_mfma_f32_16x16x32_bf16 v[168:171], a[168:171], v[56:59], v[168:171]
s_add_u32 s81, s81, 0x8000
v_exp_f32 v137, v137
v_mfma_f32_16x16x32_bf16 v[168:171], a[172:175], v[60:63], v[168:171]
s_add_u32 m0, s74, 16384
v_exp_f32 v138, v138
v_mfma_f32_16x16x32_bf16 v[172:175], a[172:175], v[76:79], v[92:95]
s_add_u32 s72, s81, 16384
buffer_load_dwordx4 v1, s[44:47], s72 offen sc1 lds
v_mfma_f32_16x16x32_bf16 v[172:175], a[168:171], v[72:75], v[172:175]
ds_read_b128 a[136:139], v2 offset:18432
v_cvt_pk_bf16_f32 v200, v136, v137
v_mfma_f32_16x16x32_bf16 v[172:175], a[164:167], v[68:71], v[172:175]
v_exp_f32 v139, v139
v_mfma_f32_16x16x32_bf16 v[172:175], a[160:163], v[64:67], v[172:175]
ds_read_b128 a[140:143], v2 offset:19456
v_cvt_pk_bf16_f32 v201, v138, v139
v_mfma_f32_16x16x32_bf16 v[188:191], a[176:179], v[64:67], v[92:95]
buffer_store_dwordx4 v[160:163], v1, s[44:47], s70 offen offset:2048 sc1
v_mfma_f32_16x16x32_bf16 v[188:191], a[180:183], v[68:71], v[188:191]
v_exp_f32 v152, v152
v_mfma_f32_16x16x32_bf16 v[188:191], a[184:187], v[72:75], v[188:191]
ds_read_b128 a[144:147], v2 offset:20480
ds_read_b128 a[148:151], v2 offset:21504
v_mfma_f32_16x16x32_bf16 v[188:191], a[188:191], v[76:79], v[188:191]
v_exp_f32 v153, v153
v_mfma_f32_16x16x32_bf16 v[184:187], a[188:191], v[60:63], v[88:91]
buffer_load_dwordx4 v1, s[44:47], s72 offen offset:1024 sc1 lds
v_mfma_f32_16x16x32_bf16 v[184:187], a[184:187], v[56:59], v[184:187]
v_exp_f32 v154, v154
v_mfma_f32_16x16x32_bf16 v[184:187], a[180:183], v[52:55], v[184:187]
ds_read_b128 a[152:155], v2 offset:22528
v_cvt_pk_bf16_f32 v202, v152, v153
v_mfma_f32_16x16x32_bf16 v[184:187], a[176:179], v[48:51], v[184:187]
s_waitcnt lgkmcnt(7)
v_exp_f32 v155, v155
v_mfma_f32_16x16x32_bf16 a[64:67], a[224:227], v[216:219], a[64:67]
ds_read_b128 a[156:159], v2 offset:23552
v_cvt_pk_bf16_f32 v203, v154, v155
v_mfma_f32_16x16x32_bf16 a[96:99], a[224:227], v[220:223], a[96:99]
v_exp_f32 v140, v140
v_mfma_f32_16x16x32_bf16 a[100:103], a[228:231], v[220:223], a[100:103]
ds_read_b128 a[192:195], v2 offset:0
ds_read_b128 a[196:199], v2 offset:1024
v_mfma_f32_16x16x32_bf16 a[68:71], a[228:231], v[216:219], a[68:71]
buffer_store_dwordx4 v[176:179], v1, s[44:47], s70 offen offset:3072 sc1
v_mfma_f32_16x16x32_bf16 a[72:75], a[232:235], v[216:219], a[72:75]
v_exp_f32 v141, v141
v_mfma_f32_16x16x32_bf16 a[104:107], a[232:235], v[220:223], a[104:107]
v_exp_f32 v142, v142
v_mfma_f32_16x16x32_bf16 a[108:111], a[236:239], v[220:223], a[108:111]
ds_read_b128 a[200:203], v2 offset:2048
ds_read_b128 a[204:207], v2 offset:3072
v_mfma_f32_16x16x32_bf16 a[76:79], a[236:239], v[216:219], a[76:79]
buffer_load_dwordx4 v1, s[44:47], s72 offen offset:2048 sc1 lds
v_mfma_f32_16x16x32_bf16 a[80:83], a[240:243], v[216:219], a[80:83]
s_add_u32 s70, s70, 0x20000
v_exp_f32 v143, v143
v_mfma_f32_16x16x32_bf16 a[112:115], a[240:243], v[220:223], a[112:115]
v_exp_f32 v156, v156
v_mfma_f32_16x16x32_bf16 a[116:119], a[244:247], v[220:223], a[116:119]
ds_read_b128 a[208:211], v2 offset:4096
ds_read_b128 a[212:215], v2 offset:5120
v_mfma_f32_16x16x32_bf16 a[84:87], a[244:247], v[216:219], a[84:87]
ds_read_b128 a[216:219], v2 offset:6144
ds_read_b128 a[220:223], v2 offset:7168
v_mfma_f32_16x16x32_bf16 a[88:91], a[248:251], v[216:219], a[88:91]
v_cvt_pk_bf16_f32 v204, v140, v141
v_cvt_pk_bf16_f32 v205, v142, v143
v_mfma_f32_16x16x32_bf16 a[120:123], a[248:251], v[220:223], a[120:123]
buffer_store_dwordx4 v[132:135], v1, s[44:47], s70 offen sc1
v_mfma_f32_16x16x32_bf16 a[124:127], a[252:255], v[220:223], a[124:127]
v_exp_f32 v157, v157
v_mfma_f32_16x16x32_bf16 a[92:95], a[252:255], v[216:219], a[92:95]
v_exp_f32 v158, v158
v_mfma_f32_16x16x32_bf16 v[232:235], v[120:123], v[216:219], v[232:235]
buffer_load_dwordx4 v1, s[44:47], s72 offen offset:3072 sc1 lds
v_mfma_f32_16x16x32_bf16 v[236:239], v[120:123], v[220:223], v[236:239]
s_waitcnt lgkmcnt(8)
v_exp_f32 v159, v159
v_cvt_pk_bf16_f32 v206, v156, v157
v_cvt_pk_bf16_f32 v207, v158, v159
v_mfma_f32_16x16x32_bf16 v[136:139], a[128:131], v[48:51], v[88:91]
s_add_u32 s82, s82, 0x8000
ds_read_b128 a[160:163], v2 offset:24576
ds_read_b128 a[164:167], v2 offset:25600
v_mfma_f32_16x16x32_bf16 v[136:139], a[132:135], v[52:55], v[136:139]
s_and_b32 s82, s82, 0x1ffff
v_exp_f32 v168, v168
v_mfma_f32_16x16x32_bf16 v[136:139], a[136:139], v[56:59], v[136:139]
s_add_u32 m0, s74, 0
v_exp_f32 v169, v169
v_mfma_f32_16x16x32_bf16 v[136:139], a[140:143], v[60:63], v[136:139]
s_add_u32 s72, s81, 0
buffer_load_dwordx4 v1, s[44:47], s72 offen sc1 lds
v_mfma_f32_16x16x32_bf16 v[140:143], a[140:143], v[76:79], v[92:95]
ds_read_b128 a[168:171], v2 offset:26624
v_cvt_pk_bf16_f32 v216, v168, v169
v_mfma_f32_16x16x32_bf16 v[140:143], a[136:139], v[72:75], v[140:143]
v_exp_f32 v170, v170
v_mfma_f32_16x16x32_bf16 v[140:143], a[132:135], v[68:71], v[140:143]
ds_read_b128 a[172:175], v2 offset:27648
ds_read_b128 a[176:179], v2 offset:28672
v_mfma_f32_16x16x32_bf16 v[140:143], a[128:131], v[64:67], v[140:143]
v_exp_f32 v171, v171
v_mfma_f32_16x16x32_bf16 v[156:159], a[144:147], v[64:67], v[92:95]
buffer_store_dwordx4 v[148:151], v1, s[44:47], s70 offen offset:1024 sc1
v_mfma_f32_16x16x32_bf16 v[156:159], a[148:151], v[68:71], v[156:159]
v_exp_f32 v184, v184
v_mfma_f32_16x16x32_bf16 v[156:159], a[152:155], v[72:75], v[156:159]
ds_read_b128 a[180:183], v2 offset:29696
v_cvt_pk_bf16_f32 v217, v170, v171
v_mfma_f32_16x16x32_bf16 v[156:159], a[156:159], v[76:79], v[156:159]
v_exp_f32 v185, v185
v_mfma_f32_16x16x32_bf16 v[152:155], a[156:159], v[60:63], v[88:91]
buffer_load_dwordx4 v1, s[44:47], s72 offen offset:1024 sc1 lds
v_mfma_f32_16x16x32_bf16 v[152:155], a[152:155], v[56:59], v[152:155]
ds_read_b128 a[184:187], v2 offset:30720
v_cvt_pk_bf16_f32 v218, v184, v185
v_mfma_f32_16x16x32_bf16 v[152:155], a[148:151], v[52:55], v[152:155]
v_exp_f32 v186, v186
v_mfma_f32_16x16x32_bf16 v[152:155], a[144:147], v[48:51], v[152:155]
s_waitcnt lgkmcnt(7)
ds_read_b128 a[188:191], v2 offset:31744
ds_read_b128 a[224:227], v2 offset:8192
v_mfma_f32_16x16x32_bf16 a[64:67], a[192:195], v[200:203], a[64:67]
v_exp_f32 v187, v187
v_mfma_f32_16x16x32_bf16 a[96:99], a[192:195], v[204:207], a[96:99]
buffer_store_dwordx4 v[164:167], v1, s[44:47], s70 offen offset:2048 sc1
v_mfma_f32_16x16x32_bf16 a[100:103], a[196:199], v[204:207], a[100:103]
v_exp_f32 v172, v172
v_mfma_f32_16x16x32_bf16 a[68:71], a[196:199], v[200:203], a[68:71]
ds_read_b128 a[228:231], v2 offset:9216
v_cvt_pk_bf16_f32 v219, v186, v187
v_mfma_f32_16x16x32_bf16 a[72:75], a[200:203], v[200:203], a[72:75]
v_exp_f32 v173, v173
v_mfma_f32_16x16x32_bf16 a[104:107], a[200:203], v[204:207], a[104:107]
ds_read_b128 a[232:235], v2 offset:10240
ds_read_b128 a[236:239], v2 offset:11264
v_mfma_f32_16x16x32_bf16 a[108:111], a[204:207], v[204:207], a[108:111]
v_exp_f32 v174, v174
v_mfma_f32_16x16x32_bf16 a[76:79], a[204:207], v[200:203], a[76:79]
buffer_load_dwordx4 v1, s[44:47], s72 offen offset:2048 sc1 lds
v_mfma_f32_16x16x32_bf16 a[80:83], a[208:211], v[200:203], a[80:83]
v_exp_f32 v175, v175
v_mfma_f32_16x16x32_bf16 a[112:115], a[208:211], v[204:207], a[112:115]
ds_read_b128 a[240:243], v2 offset:12288
ds_read_b128 a[244:247], v2 offset:13312
v_mfma_f32_16x16x32_bf16 a[116:119], a[212:215], v[204:207], a[116:119]
v_exp_f32 v188, v188
v_mfma_f32_16x16x32_bf16 a[84:87], a[212:215], v[200:203], a[84:87]
ds_read_b128 a[248:251], v2 offset:14336
ds_read_b128 a[252:255], v2 offset:15360
v_mfma_f32_16x16x32_bf16 a[88:91], a[216:219], v[200:203], a[88:91]
v_cvt_pk_bf16_f32 v220, v172, v173
v_cvt_pk_bf16_f32 v221, v174, v175
v_mfma_f32_16x16x32_bf16 a[120:123], a[216:219], v[204:207], a[120:123]
buffer_store_dwordx4 v[180:183], v1, s[44:47], s70 offen offset:3072 sc1
v_mfma_f32_16x16x32_bf16 a[124:127], a[220:223], v[204:207], a[124:127]
v_exp_f32 v189, v189
v_mfma_f32_16x16x32_bf16 a[92:95], a[220:223], v[200:203], a[92:95]
buffer_load_dwordx4 v1, s[44:47], s72 offen offset:3072 sc1 lds
v_mfma_f32_16x16x32_bf16 v[232:235], v[120:123], v[200:203], v[232:235]
s_waitcnt vmcnt(14) lgkmcnt(8)
v_exp_f32 v190, v190
v_mfma_f32_16x16x32_bf16 v[236:239], v[120:123], v[204:207], v[236:239]
s_barrier
v_exp_f32 v191, v191
v_add_u32 v2, s82, v1
v_cvt_pk_bf16_f32 v222, v188, v189
v_cvt_pk_bf16_f32 v223, v190, v191
s_lshl_b32 s83, s60, 2
s_sub_u32 s83, s83, 25
.p2align 5
s_nop 0
s_nop 0
LloopII:
v_mfma_f32_16x16x32_bf16 v[168:171], a[160:163], v[48:51], v[88:91]
s_xor_b32 s74, s82, 0x10000
v_exp_f32 v136, v136
v_mfma_f32_16x16x32_bf16 v[168:171], a[164:167], v[52:55], v[168:171]
s_add_u32 s74, s74, s64
ds_read_b128 a[128:131], v2 offset:16384
ds_read_b128 a[132:135], v2 offset:17408
v_mfma_f32_16x16x32_bf16 v[168:171], a[168:171], v[56:59], v[168:171]
s_add_u32 s81, s81, 0x8000
v_exp_f32 v137, v137
v_mfma_f32_16x16x32_bf16 v[168:171], a[172:175], v[60:63], v[168:171]
s_add_u32 m0, s74, 16384
v_exp_f32 v138, v138
v_mfma_f32_16x16x32_bf16 v[172:175], a[172:175], v[76:79], v[92:95]
s_add_u32 s72, s81, 16384
ds_read_b128 a[136:139], v2 offset:18432
v_cvt_pk_bf16_f32 v200, v136, v137
v_mfma_f32_16x16x32_bf16 v[172:175], a[168:171], v[72:75], v[172:175]
buffer_load_dwordx4 v1, s[44:47], s72 offen sc1 lds
v_mfma_f32_16x16x32_bf16 v[172:175], a[164:167], v[68:71], v[172:175]
v_exp_f32 v139, v139
v_mfma_f32_16x16x32_bf16 v[172:175], a[160:163], v[64:67], v[172:175]
ds_read_b128 a[140:143], v2 offset:19456
v_cvt_pk_bf16_f32 v201, v138, v139
v_mfma_f32_16x16x32_bf16 v[188:191], a[176:179], v[64:67], v[92:95]
v_exp_f32 v152, v152
v_mfma_f32_16x16x32_bf16 v[188:191], a[180:183], v[68:71], v[188:191]
ds_read_b128 a[144:147], v2 offset:20480
ds_read_b128 a[148:151], v2 offset:21504
v_mfma_f32_16x16x32_bf16 v[188:191], a[184:187], v[72:75], v[188:191]
v_exp_f32 v153, v153
v_mfma_f32_16x16x32_bf16 v[188:191], a[188:191], v[76:79], v[188:191]
v_exp_f32 v154, v154
v_mfma_f32_16x16x32_bf16 v[184:187], a[188:191], v[60:63], v[88:91]
ds_read_b128 a[152:155], v2 offset:22528
v_cvt_pk_bf16_f32 v202, v152, v153
v_mfma_f32_16x16x32_bf16 v[184:187], a[184:187], v[56:59], v[184:187]
buffer_load_dwordx4 v1, s[44:47], s72 offen offset:1024 sc1 lds
v_mfma_f32_16x16x32_bf16 v[184:187], a[180:183], v[52:55], v[184:187]
v_exp_f32 v155, v155
v_mfma_f32_16x16x32_bf16 v[184:187], a[176:179], v[48:51], v[184:187]
s_waitcnt lgkmcnt(7)
ds_read_b128 a[156:159], v2 offset:23552
v_cvt_pk_bf16_f32 v203, v154, v155
v_mfma_f32_16x16x32_bf16 a[64:67], a[224:227], v[216:219], a[64:67]
v_exp_f32 v140, v140
v_mfma_f32_16x16x32_bf16 a[96:99], a[224:227], v[220:223], a[96:99]
ds_read_b128 a[192:195], v2 offset:0
ds_read_b128 a[196:199], v2 offset:1024
v_mfma_f32_16x16x32_bf16 a[100:103], a[228:231], v[220:223], a[100:103]
v_exp_f32 v141, v141
v_mfma_f32_16x16x32_bf16 a[68:71], a[228:231], v[216:219], a[68:71]
v_exp_f32 v142, v142
v_mfma_f32_16x16x32_bf16 a[72:75], a[232:235], v[216:219], a[72:75]
ds_read_b128 a[200:203], v2 offset:2048
v_cvt_pk_bf16_f32 v204, v140, v141
v_mfma_f32_16x16x32_bf16 a[104:107], a[232:235], v[220:223], a[104:107]
buffer_load_dwordx4 v1, s[44:47], s72 offen offset:2048 sc1 lds
v_mfma_f32_16x16x32_bf16 a[108:111], a[236:239], v[220:223], a[108:111]
v_exp_f32 v143, v143
v_mfma_f32_16x16x32_bf16 a[76:79], a[236:239], v[216:219], a[76:79]
ds_read_b128 a[204:207], v2 offset:3072
v_cvt_pk_bf16_f32 v205, v142, v143
v_mfma_f32_16x16x32_bf16 a[80:83], a[240:243], v[216:219], a[80:83]
v_exp_f32 v156, v156
v_mfma_f32_16x16x32_bf16 a[112:115], a[240:243], v[220:223], a[112:115]
ds_read_b128 a[208:211], v2 offset:4096
v_mfma_f32_16x16x32_bf16 a[116:119], a[244:247], v[220:223], a[116:119]
v_exp_f32 v157, v157
v_mfma_f32_16x16x32_bf16 a[84:87], a[244:247], v[216:219], a[84:87]
ds_read_b128 a[212:215], v2 offset:5120
v_cvt_pk_bf16_f32 v206, v156, v157
v_mfma_f32_16x16x32_bf16 a[88:91], a[248:251], v[216:219], a[88:91]
v_exp_f32 v158, v158
v_mfma_f32_16x16x32_bf16 a[120:123], a[248:251], v[220:223], a[120:123]
ds_read_b128 a[216:219], v2 offset:6144
v_mfma_f32_16x16x32_bf16 a[124:127], a[252:255], v[220:223], a[124:127]
buffer_load_dwordx4 v1, s[44:47], s72 offen offset:3072 sc1 lds
v_mfma_f32_16x16x32_bf16 a[92:95], a[252:255], v[216:219], a[92:95]
v_exp_f32 v159, v159
v_mfma_f32_16x16x32_bf16 v[232:235], v[120:123], v[216:219], v[232:235]
ds_read_b128 a[220:223], v2 offset:7168
v_cvt_pk_bf16_f32 v207, v158, v159
v_mfma_f32_16x16x32_bf16 v[236:239], v[120:123], v[220:223], v[236:239]
s_waitcnt lgkmcnt(8)
v_mfma_f32_16x16x32_bf16 v[136:139], a[128:131], v[48:51], v[88:91]
s_add_u32 s82, s82, 0x8000
ds_read_b128 a[160:163], v2 offset:24576
ds_read_b128 a[164:167], v2 offset:25600
v_mfma_f32_16x16x32_bf16 v[136:139], a[132:135], v[52:55], v[136:139]
s_and_b32 s82, s82, 0x1ffff
v_exp_f32 v168, v168
v_mfma_f32_16x16x32_bf16 v[136:139], a[136:139], v[56:59], v[136:139]
s_add_u32 m0, s74, 0
v_exp_f32 v169, v169
v_mfma_f32_16x16x32_bf16 v[136:139], a[140:143], v[60:63], v[136:139]
s_add_u32 s72, s81, 0
ds_read_b128 a[168:171], v2 offset:26624
v_cvt_pk_bf16_f32 v216, v168, v169
v_mfma_f32_16x16x32_bf16 v[140:143], a[140:143], v[76:79], v[92:95]
v_exp_f32 v170, v170
v_mfma_f32_16x16x32_bf16 v[140:143], a[136:139], v[72:75], v[140:143]
buffer_load_dwordx4 v1, s[44:47], s72 offen sc1 lds
v_mfma_f32_16x16x32_bf16 v[140:143], a[132:135], v[68:71], v[140:143]
ds_read_b128 a[172:175], v2 offset:27648
ds_read_b128 a[176:179], v2 offset:28672
v_mfma_f32_16x16x32_bf16 v[140:143], a[128:131], v[64:67], v[140:143]
v_exp_f32 v171, v171
v_mfma_f32_16x16x32_bf16 v[156:159], a[144:147], v[64:67], v[92:95]
v_exp_f32 v184, v184
v_mfma_f32_16x16x32_bf16 v[156:159], a[148:151], v[68:71], v[156:159]
ds_read_b128 a[180:183], v2 offset:29696
v_cvt_pk_bf16_f32 v217, v170, v171
v_mfma_f32_16x16x32_bf16 v[156:159], a[152:155], v[72:75], v[156:159]
v_exp_f32 v185, v185
v_mfma_f32_16x16x32_bf16 v[156:159], a[156:159], v[76:79], v[156:159]
ds_read_b128 a[184:187], v2 offset:30720
v_cvt_pk_bf16_f32 v218, v184, v185
v_mfma_f32_16x16x32_bf16 v[152:155], a[156:159], v[60:63], v[88:91]
buffer_load_dwordx4 v1, s[44:47], s72 offen offset:1024 sc1 lds
v_mfma_f32_16x16x32_bf16 v[152:155], a[152:155], v[56:59], v[152:155]
v_exp_f32 v186, v186
v_mfma_f32_16x16x32_bf16 v[152:155], a[148:151], v[52:55], v[152:155]
ds_read_b128 a[188:191], v2 offset:31744
ds_read_b128 a[224:227], v2 offset:8192
v_mfma_f32_16x16x32_bf16 v[152:155], a[144:147], v[48:51], v[152:155]
s_waitcnt lgkmcnt(9)
v_exp_f32 v187, v187
v_mfma_f32_16x16x32_bf16 a[64:67], a[192:195], v[200:203], a[64:67]
v_exp_f32 v172, v172
v_mfma_f32_16x16x32_bf16 a[96:99], a[192:195], v[204:207], a[96:99]
ds_read_b128 a[228:231], v2 offset:9216
v_cvt_pk_bf16_f32 v219, v186, v187
v_mfma_f32_16x16x32_bf16 a[100:103], a[196:199], v[204:207], a[100:103]
v_exp_f32 v173, v173
v_mfma_f32_16x16x32_bf16 a[68:71], a[196:199], v[200:203], a[68:71]
ds_read_b128 a[232:235], v2 offset:10240
v_cvt_pk_bf16_f32 v220, v172, v173
v_mfma_f32_16x16x32_bf16 a[72:75], a[200:203], v[200:203], a[72:75]
buffer_load_dwordx4 v1, s[44:47], s72 offen offset:2048 sc1 lds
v_mfma_f32_16x16x32_bf16 a[104:107], a[200:203], v[204:207], a[104:107]
v_exp_f32 v174, v174
v_mfma_f32_16x16x32_bf16 a[108:111], a[204:207], v[204:207], a[108:111]
ds_read_b128 a[236:239], v2 offset:11264
ds_read_b128 a[240:243], v2 offset:12288
v_mfma_f32_16x16x32_bf16 a[76:79], a[204:207], v[200:203], a[76:79]
v_exp_f32 v175, v175
v_mfma_f32_16x16x32_bf16 a[80:83], a[208:211], v[200:203], a[80:83]
v_exp_f32 v188, v188
v_mfma_f32_16x16x32_bf16 a[112:115], a[208:211], v[204:207], a[112:115]
ds_read_b128 a[244:247], v2 offset:13312
v_cvt_pk_bf16_f32 v221, v174, v175
v_mfma_f32_16x16x32_bf16 a[116:119], a[212:215], v[204:207], a[116:119]
v_exp_f32 v189, v189
v_mfma_f32_16x16x32_bf16 a[84:87], a[212:215], v[200:203], a[84:87]
ds_read_b128 a[248:251], v2 offset:14336
v_cvt_pk_bf16_f32 v222, v188, v189
v_mfma_f32_16x16x32_bf16 a[88:91], a[216:219], v[200:203], a[88:91]
buffer_load_dwordx4 v1, s[44:47], s72 offen offset:3072 sc1 lds
v_mfma_f32_16x16x32_bf16 a[120:123], a[216:219], v[204:207], a[120:123]
ds_read_b128 a[252:255], v2 offset:15360
v_add_u32 v2, s82, v1
v_mfma_f32_16x16x32_bf16 a[124:127], a[220:223], v[204:207], a[124:127]
s_waitcnt vmcnt(8) lgkmcnt(8)
v_exp_f32 v190, v190
v_mfma_f32_16x16x32_bf16 a[92:95], a[220:223], v[200:203], a[92:95]
s_barrier
v_exp_f32 v191, v191
v_mfma_f32_16x16x32_bf16 v[232:235], v[120:123], v[200:203], v[232:235]
s_add_u32 s83, s83, 1
v_cvt_pk_bf16_f32 v223, v190, v191
v_mfma_f32_16x16x32_bf16 v[236:239], v[120:123], v[204:207], v[236:239]
s_cbranch_scc0 LloopII
v_mfma_f32_16x16x32_bf16 v[168:171], a[160:163], v[48:51], v[88:91]
s_xor_b32 s74, s82, 0x10000
v_exp_f32 v136, v136
v_mfma_f32_16x16x32_bf16 v[168:171], a[164:167], v[52:55], v[168:171]
s_add_u32 s74, s74, s64
ds_read_b128 a[128:131], v2 offset:16384
ds_read_b128 a[132:135], v2 offset:17408
v_mfma_f32_16x16x32_bf16 v[168:171], a[168:171], v[56:59], v[168:171]
s_add_u32 s81, s81, 0x8000
v_exp_f32 v137, v137
v_mfma_f32_16x16x32_bf16 v[168:171], a[172:175], v[60:63], v[168:171]
s_add_u32 m0, s74, 0
v_exp_f32 v138, v138
v_mfma_f32_16x16x32_bf16 v[172:175], a[172:175], v[76:79], v[92:95]
s_add_u32 s72, s81, 0
ds_read_b128 a[136:139], v2 offset:18432
v_cvt_pk_bf16_f32 v200, v136, v137
v_mfma_f32_16x16x32_bf16 v[172:175], a[168:171], v[72:75], v[172:175]
buffer_load_dwordx4 v1, s[44:47], s72 offen sc1 lds
v_mfma_f32_16x16x32_bf16 v[172:175], a[164:167], v[68:71], v[172:175]
v_exp_f32 v139, v139
v_mfma_f32_16x16x32_bf16 v[172:175], a[160:163], v[64:67], v[172:175]
ds_read_b128 a[140:143], v2 offset:19456
v_cvt_pk_bf16_f32 v201, v138, v139
v_mfma_f32_16x16x32_bf16 v[188:191], a[176:179], v[64:67], v[92:95]
v_exp_f32 v152, v152
v_mfma_f32_16x16x32_bf16 v[188:191], a[180:183], v[68:71], v[188:191]
ds_read_b128 a[144:147], v2 offset:20480
ds_read_b128 a[148:151], v2 offset:21504
v_mfma_f32_16x16x32_bf16 v[188:191], a[184:187], v[72:75], v[188:191]
v_exp_f32 v153, v153
v_mfma_f32_16x16x32_bf16 v[188:191], a[188:191], v[76:79], v[188:191]
v_exp_f32 v154, v154
v_mfma_f32_16x16x32_bf16 v[184:187], a[188:191], v[60:63], v[88:91]
ds_read_b128 a[152:155], v2 offset:22528
v_cvt_pk_bf16_f32 v202, v152, v153
v_mfma_f32_16x16x32_bf16 v[184:187], a[184:187], v[56:59], v[184:187]
buffer_load_dwordx4 v1, s[44:47], s72 offen offset:1024 sc1 lds
v_mfma_f32_16x16x32_bf16 v[184:187], a[180:183], v[52:55], v[184:187]
v_exp_f32 v155, v155
v_mfma_f32_16x16x32_bf16 v[184:187], a[176:179], v[48:51], v[184:187]
s_waitcnt lgkmcnt(7)
ds_read_b128 a[156:159], v2 offset:23552
v_cvt_pk_bf16_f32 v203, v154, v155
v_mfma_f32_16x16x32_bf16 a[64:67], a[224:227], v[216:219], a[64:67]
v_exp_f32 v140, v140
v_mfma_f32_16x16x32_bf16 a[96:99], a[224:227], v[220:223], a[96:99]
ds_read_b128 a[192:195], v2 offset:0
ds_read_b128 a[196:199], v2 offset:1024
v_mfma_f32_16x16x32_bf16 a[100:103], a[228:231], v[220:223], a[100:103]
v_exp_f32 v141, v141
v_mfma_f32_16x16x32_bf16 a[68:71], a[228:231], v[216:219], a[68:71]
v_exp_f32 v142, v142
v_mfma_f32_16x16x32_bf16 a[72:75], a[232:235], v[216:219], a[72:75]
ds_read_b128 a[200:203], v2 offset:2048
v_cvt_pk_bf16_f32 v204, v140, v141
v_mfma_f32_16x16x32_bf16 a[104:107], a[232:235], v[220:223], a[104:107]
buffer_load_dwordx4 v1, s[44:47], s72 offen offset:2048 sc1 lds
v_mfma_f32_16x16x32_bf16 a[108:111], a[236:239], v[220:223], a[108:111]
v_exp_f32 v143, v143
v_mfma_f32_16x16x32_bf16 a[76:79], a[236:239], v[216:219], a[76:79]
ds_read_b128 a[204:207], v2 offset:3072
v_cvt_pk_bf16_f32 v205, v142, v143
v_mfma_f32_16x16x32_bf16 a[80:83], a[240:243], v[216:219], a[80:83]
v_exp_f32 v156, v156
v_mfma_f32_16x16x32_bf16 a[112:115], a[240:243], v[220:223], a[112:115]
ds_read_b128 a[208:211], v2 offset:4096
v_mfma_f32_16x16x32_bf16 a[116:119], a[244:247], v[220:223], a[116:119]
v_exp_f32 v157, v157
v_mfma_f32_16x16x32_bf16 a[84:87], a[244:247], v[216:219], a[84:87]
ds_read_b128 a[212:215], v2 offset:5120
v_cvt_pk_bf16_f32 v206, v156, v157
v_mfma_f32_16x16x32_bf16 a[88:91], a[248:251], v[216:219], a[88:91]
v_exp_f32 v158, v158
v_mfma_f32_16x16x32_bf16 a[120:123], a[248:251], v[220:223], a[120:123]
ds_read_b128 a[216:219], v2 offset:6144
v_mfma_f32_16x16x32_bf16 a[124:127], a[252:255], v[220:223], a[124:127]
buffer_load_dwordx4 v1, s[44:47], s72 offen offset:3072 sc1 lds
v_mfma_f32_16x16x32_bf16 a[92:95], a[252:255], v[216:219], a[92:95]
v_exp_f32 v159, v159
v_mfma_f32_16x16x32_bf16 v[232:235], v[120:123], v[216:219], v[232:235]
ds_read_b128 a[220:223], v2 offset:7168
v_cvt_pk_bf16_f32 v207, v158, v159
v_mfma_f32_16x16x32_bf16 v[236:239], v[120:123], v[220:223], v[236:239]
s_waitcnt lgkmcnt(8)
s_cmp_eq_u32 s58, 0
s_cbranch_scc1 Ltri28
v_mfma_f32_16x16x32_bf16 v[136:139], a[128:131], v[48:51], v[88:91]
s_add_u32 s82, s82, 0x8000
ds_read_b128 a[160:163], v2 offset:24576
ds_read_b128 a[164:167], v2 offset:25600
v_mfma_f32_16x16x32_bf16 v[140:143], a[128:131], v[64:67], v[92:95]
s_and_b32 s82, s82, 0x1ffff
v_exp_f32 v168, v168
v_mfma_f32_16x16x32_bf16 v[152:155], a[144:147], v[48:51], v[88:91]
v_exp_f32 v169, v169
v_mfma_f32_16x16x32_bf16 v[156:159], a[144:147], v[64:67], v[92:95]
ds_read_b128 a[168:171], v2 offset:26624
v_cvt_pk_bf16_f32 v216, v168, v169
s_branch Ljoin29
Ltri28:
v_mfma_f32_16x16x32_bf16 v[136:139], a[128:131], v[48:51], v[104:107]
s_add_u32 s82, s82, 0x8000
ds_read_b128 a[160:163], v2 offset:24576
ds_read_b128 a[164:167], v2 offset:25600
v_mfma_f32_16x16x32_bf16 v[140:143], a[128:131], v[64:67], v[92:95]
s_and_b32 s82, s82, 0x1ffff
v_exp_f32 v168, v168
v_mfma_f32_16x16x32_bf16 v[152:155], a[144:147], v[48:51], v[112:115]
v_exp_f32 v169, v169
v_mfma_f32_16x16x32_bf16 v[156:159], a[144:147], v[64:67], v[108:111]
ds_read_b128 a[168:171], v2 offset:26624
v_cvt_pk_bf16_f32 v216, v168, v169
Ljoin29:
v_mfma_f32_16x16x32_bf16 v[136:139], a[132:135], v[52:55], v[136:139]
v_exp_f32 v170, v170
v_mfma_f32_16x16x32_bf16 v[136:139], a[136:139], v[56:59], v[136:139]
buffer_load_dwordx4 v[80:83], v15, s[4:7], s80 offen
v_mfma_f32_16x16x32_bf16 v[136:139], a[140:143], v[60:63], v[136:139]
s_add_u32 s80, s80, 0x4000
ds_read_b128 a[172:175], v2 offset:27648
ds_read_b128 a[176:179], v2 offset:28672
v_mfma_f32_16x16x32_bf16 v[140:143], a[140:143], v[76:79], v[140:143]
v_exp_f32 v171, v171
v_mfma_f32_16x16x32_bf16 v[140:143], a[136:139], v[72:75], v[140:143]
v_exp_f32 v184, v184
v_mfma_f32_16x16x32_bf16 v[140:143], a[132:135], v[68:71], v[140:143]
ds_read_b128 a[180:183], v2 offset:29696
v_cvt_pk_bf16_f32 v217, v170, v171
v_mfma_f32_16x16x32_bf16 v[156:159], a[148:151], v[68:71], v[156:159]
Lstub4:
s_cbranch_execz Lret
v_exp_f32 v185, v185
v_mfma_f32_16x16x32_bf16 v[156:159], a[152:155], v[72:75], v[156:159]
ds_read_b128 a[184:187], v2 offset:30720
v_cvt_pk_bf16_f32 v218, v184, v185
v_mfma_f32_16x16x32_bf16 v[156:159], a[156:159], v[76:79], v[156:159]
v_exp_f32 v186, v186
v_mfma_f32_16x16x32_bf16 v[152:155], a[156:159], v[60:63], v[152:155]
buffer_load_dwordx4 v[84:87], v15, s[4:7], s80 offen
v_mfma_f32_16x16x32_bf16 v[152:155], a[152:155], v[56:59], v[152:155]
s_add_u32 s80, s80, 0x4000
ds_read_b128 a[188:191], v2 offset:31744
ds_read_b128 a[224:227], v2 offset:8192
v_mfma_f32_16x16x32_bf16 v[152:155], a[148:151], v[52:55], v[152:155]
s_waitcnt lgkmcnt(9)
v_exp_f32 v187, v187
v_mfma_f32_16x16x32_bf16 a[64:67], a[192:195], v[200:203], a[64:67]
v_exp_f32 v172, v172
v_mfma_f32_16x16x32_bf16 a[96:99], a[192:195], v[204:207], a[96:99]
ds_read_b128 a[228:231], v2 offset:9216
v_cvt_pk_bf16_f32 v219, v186, v187
v_mfma_f32_16x16x32_bf16 a[100:103], a[196:199], v[204:207], a[100:103]
v_exp_f32 v173, v173
v_mfma_f32_16x16x32_bf16 a[68:71], a[196:199], v[200:203], a[68:71]
ds_read_b128 a[232:235], v2 offset:10240
v_cvt_pk_bf16_f32 v220, v172, v173
v_mfma_f32_16x16x32_bf16 a[72:75], a[200:203], v[200:203], a[72:75]
v_exp_f32 v174, v174
v_mfma_f32_16x16x32_bf16 a[104:107], a[200:203], v[204:207], a[104:107]
buffer_load_dwordx4 v[96:99], v15, s[4:7], s80 offen
v_mfma_f32_16x16x32_bf16 a[108:111], a[204:207], v[204:207], a[108:111]
s_add_u32 s80, s80, 0x4000
ds_read_b128 a[236:239], v2 offset:11264
v_mfma_f32_16x16x32_bf16 a[76:79], a[204:207], v[200:203], a[76:79]
v_exp_f32 v175, v175
v_mfma_f32_16x16x32_bf16 a[80:83], a[208:211], v[200:203], a[80:83]
ds_read_b128 a[240:243], v2 offset:12288
v_cvt_pk_bf16_f32 v221, v174, v175
v_mfma_f32_16x16x32_bf16 a[112:115], a[208:211], v[204:207], a[112:115]
v_exp_f32 v188, v188
v_mfma_f32_16x16x32_bf16 a[116:119], a[212:215], v[204:207], a[116:119]
ds_read_b128 a[244:247], v2 offset:13312
v_mfma_f32_16x16x32_bf16 a[84:87], a[212:215], v[200:203], a[84:87]
v_exp_f32 v189, v189
v_mfma_f32_16x16x32_bf16 a[88:91], a[216:219], v[200:203], a[88:91]
ds_read_b128 a[248:251], v2 offset:14336
v_cvt_pk_bf16_f32 v222, v188, v189
v_mfma_f32_16x16x32_bf16 a[120:123], a[216:219], v[204:207], a[120:123]
buffer_load_dwordx4 v[100:103], v15, s[4:7], s80 offen
v_mfma_f32_16x16x32_bf16 a[124:127], a[220:223], v[204:207], a[124:127]
v_exp_f32 v190, v190
v_mfma_f32_16x16x32_bf16 a[92:95], a[220:223], v[200:203], a[92:95]
ds_read_b128 a[252:255], v2 offset:15360
v_add_u32 v2, s82, v1
v_mfma_f32_16x16x32_bf16 v[232:235], v[120:123], v[200:203], v[232:235]
s_waitcnt vmcnt(8) lgkmcnt(0)
v_exp_f32 v191, v191
v_mfma_f32_16x16x32_bf16 v[236:239], v[120:123], v[204:207], v[236:239]
s_barrier
v_cvt_pk_bf16_f32 v223, v190, v191
s_cmp_eq_u32 s58, 1
s_cbranch_scc1 Ltri31
s_cmp_gt_u32 s58, 1
s_cbranch_scc1 Lalt30
v_mfma_f32_16x16x32_bf16 v[168:171], a[160:163], v[48:51], v[112:115]
s_add_u32 m0, s92, 8352
v_exp_f32 v136, v136
v_mfma_f32_16x16x32_bf16 v[172:175], a[160:163], v[64:67], v[112:115]
s_add_u32 s72, s93, 0x6
ds_read_b128 a[128:131], v2 offset:16384
ds_read_b128 a[132:135], v2 offset:17408
v_mfma_f32_16x16x32_bf16 v[184:187], a[176:179], v[48:51], v[112:115]
v_exp_f32 v137, v137
v_mfma_f32_16x16x32_bf16 v[188:191], a[176:179], v[64:67], v[112:115]
buffer_load_dwordx4 v1, s[36:39], s72 offen lds
s_branch Ljoin32
Lalt30:
v_mfma_f32_16x16x32_bf16 v[168:171], a[160:163], v[48:51], v[88:91]
s_add_u32 m0, s92, 8352
v_exp_f32 v136, v136
v_mfma_f32_16x16x32_bf16 v[172:175], a[160:163], v[64:67], v[92:95]
s_add_u32 s72, s93, 0x6
ds_read_b128 a[128:131], v2 offset:16384
ds_read_b128 a[132:135], v2 offset:17408
v_mfma_f32_16x16x32_bf16 v[184:187], a[176:179], v[48:51], v[88:91]
v_exp_f32 v137, v137
v_mfma_f32_16x16x32_bf16 v[188:191], a[176:179], v[64:67], v[92:95]
buffer_load_dwordx4 v1, s[36:39], s72 offen lds
s_branch Ljoin32
Ltri31:
v_mfma_f32_16x16x32_bf16 v[168:171], a[160:163], v[48:51], v[104:107]
s_add_u32 m0, s92, 8352
v_exp_f32 v136, v136
v_mfma_f32_16x16x32_bf16 v[172:175], a[160:163], v[64:67], v[92:95]
s_add_u32 s72, s93, 0x6
ds_read_b128 a[128:131], v2 offset:16384
ds_read_b128 a[132:135], v2 offset:17408
v_mfma_f32_16x16x32_bf16 v[184:187], a[176:179], v[48:51], v[112:115]
v_exp_f32 v137, v137
v_mfma_f32_16x16x32_bf16 v[188:191], a[176:179], v[64:67], v[108:111]
buffer_load_dwordx4 v1, s[36:39], s72 offen lds
Ljoin32:
v_mfma_f32_16x16x32_bf16 v[168:171], a[164:167], v[52:55], v[168:171]
v_exp_f32 v138, v138
v_mfma_f32_16x16x32_bf16 v[168:171], a[168:171], v[56:59], v[168:171]
ds_read_b128 a[136:139], v2 offset:18432
v_cvt_pk_bf16_f32 v200, v136, v137
v_mfma_f32_16x16x32_bf16 v[168:171], a[172:175], v[60:63], v[168:171]
v_exp_f32 v139, v139
v_mfma_f32_16x16x32_bf16 v[172:175], a[172:175], v[76:79], v[172:175]
ds_read_b128 a[140:143], v2 offset:19456
v_cvt_pk_bf16_f32 v201, v138, v139
v_mfma_f32_16x16x32_bf16 v[172:175], a[168:171], v[72:75], v[172:175]
v_exp_f32 v152, v152
v_mfma_f32_16x16x32_bf16 v[172:175], a[164:167], v[68:71], v[172:175]
ds_read_b128 a[144:147], v2 offset:20480
ds_read_b128 a[148:151], v2 offset:21504
v_mfma_f32_16x16x32_bf16 v[188:191], a[180:183], v[68:71], v[188:191]
v_exp_f32 v153, v153
v_mfma_f32_16x16x32_bf16 v[188:191], a[184:187], v[72:75], v[188:191]
buffer_load_dwordx4 v1, s[36:39], s72 offen offset:1024 lds
v_mfma_f32_16x16x32_bf16 v[188:191], a[188:191], v[76:79], v[188:191]
v_exp_f32 v154, v154
v_mfma_f32_16x16x32_bf16 v[184:187], a[188:191], v[60:63], v[184:187]
ds_read_b128 a[152:155], v2 offset:22528
v_cvt_pk_bf16_f32 v202, v152, v153
v_mfma_f32_16x16x32_bf16 v[184:187], a[184:187], v[56:59], v[184:187]
v_exp_f32 v155, v155
v_mfma_f32_16x16x32_bf16 v[184:187], a[180:183], v[52:55], v[184:187]
s_waitcnt lgkmcnt(7)
ds_read_b128 a[156:159], v2 offset:23552
v_cvt_pk_bf16_f32 v203, v154, v155
v_mfma_f32_16x16x32_bf16 a[64:67], a[224:227], v[216:219], a[64:67]
v_exp_f32 v140, v140
v_mfma_f32_16x16x32_bf16 a[96:99], a[224:227], v[220:223], a[96:99]
ds_read_b128 a[192:195], v2 offset:0
ds_read_b128 a[196:199], v2 offset:1024
v_mfma_f32_16x16x32_bf16 a[100:103], a[228:231], v[220:223], a[100:103]
buffer_load_dwordx4 v1, s[36:39], s72 offen offset:2048 lds
v_mfma_f32_16x16x32_bf16 a[68:71], a[228:231], v[216:219], a[68:71]
v_exp_f32 v141, v141
v_mfma_f32_16x16x32_bf16 a[72:75], a[232:235], v[216:219], a[72:75]
v_exp_f32 v142, v142
v_mfma_f32_16x16x32_bf16 a[104:107], a[232:235], v[220:223], a[104:107]
ds_read_b128 a[200:203], v2 offset:2048
v_cvt_pk_bf16_f32 v204, v140, v141
v_mfma_f32_16x16x32_bf16 a[108:111], a[236:239], v[220:223], a[108:111]
v_exp_f32 v143, v143
v_mfma_f32_16x16x32_bf16 a[76:79], a[236:239], v[216:219], a[76:79]
ds_read_b128 a[204:207], v2 offset:3072
v_cvt_pk_bf16_f32 v205, v142, v143
v_mfma_f32_16x16x32_bf16 a[80:83], a[240:243], v[216:219], a[80:83]
buffer_load_dwordx4 v1, s[36:39], s72 offen offset:3072 lds
v_mfma_f32_16x16x32_bf16 a[112:115], a[240:243], v[220:223], a[112:115]
s_add_u32 m0, s62, 0
v_exp_f32 v156, v156
v_mfma_f32_16x16x32_bf16 a[116:119], a[244:247], v[220:223], a[116:119]
s_add_u32 s72, s93, 0x3000000
ds_read_b128 a[208:211], v2 offset:4096
ds_read_b128 a[212:215], v2 offset:5120
v_mfma_f32_16x16x32_bf16 a[84:87], a[244:247], v[216:219], a[84:87]
v_exp_f32 v157, v157
v_mfma_f32_16x16x32_bf16 a[88:91], a[248:251], v[216:219], a[88:91]
v_exp_f32 v158, v158
v_mfma_f32_16x16x32_bf16 a[120:123], a[248:251], v[220:223], a[120:123]
ds_read_b128 a[216:219], v2 offset:6144
v_cvt_pk_bf16_f32 v206, v156, v157
v_mfma_f32_16x16x32_bf16 a[124:127], a[252:255], v[220:223], a[124:127]
buffer_load_dwordx4 v1, s[44:47], s72 offen sc1 lds
v_mfma_f32_16x16x32_bf16 a[92:95], a[252:255], v[216:219], a[92:95]
v_exp_f32 v159, v159
v_mfma_f32_16x16x32_bf16 v[232:235], v[120:123], v[216:219], v[232:235]
ds_read_b128 a[220:223], v2 offset:7168
v_cvt_pk_bf16_f32 v207, v158, v159
v_mfma_f32_16x16x32_bf16 v[236:239], v[120:123], v[220:223], v[236:239]
s_waitcnt lgkmcnt(8)
s_cmp_eq_u32 s58, 2
s_cbranch_scc1 Ltri34
s_cmp_gt_u32 s58, 2
s_cbranch_scc1 Lalt33
v_mfma_f32_16x16x32_bf16 v[136:139], a[128:131], v[48:51], v[112:115]
s_add_u32 s82, s82, 0x8000
ds_read_b128 a[160:163], v2 offset:24576
ds_read_b128 a[164:167], v2 offset:25600
v_mfma_f32_16x16x32_bf16 v[140:143], a[128:131], v[64:67], v[112:115]
s_and_b32 s82, s82, 0x1ffff
v_exp_f32 v168, v168
v_mfma_f32_16x16x32_bf16 v[152:155], a[144:147], v[48:51], v[112:115]
v_exp_f32 v169, v169
v_mfma_f32_16x16x32_bf16 v[156:159], a[144:147], v[64:67], v[112:115]
buffer_load_dwordx4 v1, s[44:47], s72 offen offset:1024 sc1 lds
s_branch Ljoin35
Lalt33:
v_mfma_f32_16x16x32_bf16 v[136:139], a[128:131], v[48:51], v[88:91]
s_add_u32 s82, s82, 0x8000
ds_read_b128 a[160:163], v2 offset:24576
ds_read_b128 a[164:167], v2 offset:25600
v_mfma_f32_16x16x32_bf16 v[140:143], a[128:131], v[64:67], v[92:95]
s_and_b32 s82, s82, 0x1ffff
v_exp_f32 v168, v168
v_mfma_f32_16x16x32_bf16 v[152:155], a[144:147], v[48:51], v[88:91]
v_exp_f32 v169, v169
v_mfma_f32_16x16x32_bf16 v[156:159], a[144:147], v[64:67], v[92:95]
buffer_load_dwordx4 v1, s[44:47], s72 offen offset:1024 sc1 lds
s_branch Ljoin35
Ltri34:
v_mfma_f32_16x16x32_bf16 v[136:139], a[128:131], v[48:51], v[104:107]
s_add_u32 s82, s82, 0x8000
ds_read_b128 a[160:163], v2 offset:24576
ds_read_b128 a[164:167], v2 offset:25600
v_mfma_f32_16x16x32_bf16 v[140:143], a[128:131], v[64:67], v[92:95]
s_and_b32 s82, s82, 0x1ffff
v_exp_f32 v168, v168
v_mfma_f32_16x16x32_bf16 v[152:155], a[144:147], v[48:51], v[112:115]
v_exp_f32 v169, v169
v_mfma_f32_16x16x32_bf16 v[156:159], a[144:147], v[64:67], v[108:111]
buffer_load_dwordx4 v1, s[44:47], s72 offen offset:1024 sc1 lds
Ljoin35:
v_mfma_f32_16x16x32_bf16 v[136:139], a[132:135], v[52:55], v[136:139]
ds_read_b128 a[168:171], v2 offset:26624
v_cvt_pk_bf16_f32 v216, v168, v169
v_mfma_f32_16x16x32_bf16 v[136:139], a[136:139], v[56:59], v[136:139]
v_exp_f32 v170, v170
v_mfma_f32_16x16x32_bf16 v[136:139], a[140:143], v[60:63], v[136:139]
ds_read_b128 a[172:175], v2 offset:27648
ds_read_b128 a[176:179], v2 offset:28672
v_mfma_f32_16x16x32_bf16 v[140:143], a[140:143], v[76:79], v[140:143]
v_exp_f32 v171, v171
v_mfma_f32_16x16x32_bf16 v[140:143], a[136:139], v[72:75], v[140:143]
v_exp_f32 v184, v184
v_mfma_f32_16x16x32_bf16 v[140:143], a[132:135], v[68:71], v[140:143]
ds_read_b128 a[180:183], v2 offset:29696
v_cvt_pk_bf16_f32 v217, v170, v171
v_mfma_f32_16x16x32_bf16 v[156:159], a[148:151], v[68:71], v[156:159]
buffer_load_dwordx4 v1, s[44:47], s72 offen offset:2048 sc1 lds
v_mfma_f32_16x16x32_bf16 v[156:159], a[152:155], v[72:75], v[156:159]
v_exp_f32 v185, v185
v_mfma_f32_16x16x32_bf16 v[156:159], a[156:159], v[76:79], v[156:159]
ds_read_b128 a[184:187], v2 offset:30720
v_cvt_pk_bf16_f32 v218, v184, v185
v_mfma_f32_16x16x32_bf16 v[152:155], a[156:159], v[60:63], v[152:155]
v_exp_f32 v186, v186
v_mfma_f32_16x16x32_bf16 v[152:155], a[152:155], v[56:59], v[152:155]
ds_read_b128 a[188:191], v2 offset:31744
ds_read_b128 a[224:227], v2 offset:8192
v_mfma_f32_16x16x32_bf16 v[152:155], a[148:151], v[52:55], v[152:155]
s_waitcnt lgkmcnt(9)
v_exp_f32 v187, v187
v_mfma_f32_16x16x32_bf16 a[64:67], a[192:195], v[200:203], a[64:67]
v_exp_f32 v172, v172
v_mfma_f32_16x16x32_bf16 a[96:99], a[192:195], v[204:207], a[96:99]
buffer_load_dwordx4 v1, s[44:47], s72 offen offset:3072 sc1 lds
v_mfma_f32_16x16x32_bf16 a[100:103], a[196:199], v[204:207], a[100:103]
s_add_u32 m0, s92, 32
ds_read_b128 a[228:231], v2 offset:9216
v_cvt_pk_bf16_f32 v219, v186, v187
v_mfma_f32_16x16x32_bf16 a[68:71], a[196:199], v[200:203], a[68:71]
s_add_u32 s72, s93, 0x0
v_exp_f32 v173, v173
v_mfma_f32_16x16x32_bf16 a[72:75], a[200:203], v[200:203], a[72:75]
ds_read_b128 a[232:235], v2 offset:10240
v_cvt_pk_bf16_f32 v220, v172, v173
v_mfma_f32_16x16x32_bf16 a[104:107], a[200:203], v[204:207], a[104:107]
v_exp_f32 v174, v174
v_mfma_f32_16x16x32_bf16 a[108:111], a[204:207], v[204:207], a[108:111]
ds_read_b128 a[236:239], v2 offset:11264
ds_read_b128 a[240:243], v2 offset:12288
v_mfma_f32_16x16x32_bf16 a[76:79], a[204:207], v[200:203], a[76:79]
v_exp_f32 v175, v175
v_mfma_f32_16x16x32_bf16 a[80:83], a[208:211], v[200:203], a[80:83]
buffer_load_dwordx4 v1, s[36:39], s72 offen lds
v_mfma_f32_16x16x32_bf16 a[112:115], a[208:211], v[204:207], a[112:115]
v_exp_f32 v188, v188
v_mfma_f32_16x16x32_bf16 a[116:119], a[212:215], v[204:207], a[116:119]
ds_read_b128 a[244:247], v2 offset:13312
v_cvt_pk_bf16_f32 v221, v174, v175
v_mfma_f32_16x16x32_bf16 a[84:87], a[212:215], v[200:203], a[84:87]
v_exp_f32 v189, v189
v_mfma_f32_16x16x32_bf16 a[88:91], a[216:219], v[200:203], a[88:91]
ds_read_b128 a[248:251], v2 offset:14336
v_cvt_pk_bf16_f32 v222, v188, v189
v_mfma_f32_16x16x32_bf16 a[120:123], a[216:219], v[204:207], a[120:123]
v_exp_f32 v190, v190
v_mfma_f32_16x16x32_bf16 a[124:127], a[220:223], v[204:207], a[124:127]
buffer_load_dwordx4 v1, s[36:39], s72 offen offset:1024 lds
v_mfma_f32_16x16x32_bf16 a[92:95], a[220:223], v[200:203], a[92:95]
ds_read_b128 a[252:255], v2 offset:15360
v_add_u32 v2, s82, v1
v_mfma_f32_16x16x32_bf16 v[232:235], v[120:123], v[200:203], v[232:235]
s_waitcnt vmcnt(14) lgkmcnt(8)
v_exp_f32 v191, v191
v_mfma_f32_16x16x32_bf16 v[236:239], v[120:123], v[204:207], v[236:239]
s_barrier
v_cvt_pk_bf16_f32 v223, v190, v191
s_cmp_eq_u32 s58, 3
s_cbranch_scc1 Ltri37
v_mfma_f32_16x16x32_bf16 v[168:171], a[160:163], v[48:51], v[112:115]
v_exp_f32 v136, v136
v_mfma_f32_16x16x32_bf16 v[172:175], a[160:163], v[64:67], v[112:115]
ds_read_b128 a[192:195], v2 offset:0
v_mfma_f32_16x16x32_bf16 v[184:187], a[176:179], v[48:51], v[112:115]
v_exp_f32 v137, v137
v_mfma_f32_16x16x32_bf16 v[188:191], a[176:179], v[64:67], v[112:115]
buffer_load_dwordx4 v1, s[36:39], s72 offen offset:2048 lds
s_branch Ljoin38
Lalt36:
Ltri37:
v_mfma_f32_16x16x32_bf16 v[168:171], a[160:163], v[48:51], v[104:107]
v_exp_f32 v136, v136
v_mfma_f32_16x16x32_bf16 v[172:175], a[160:163], v[64:67], v[92:95]
ds_read_b128 a[192:195], v2 offset:0
v_mfma_f32_16x16x32_bf16 v[184:187], a[176:179], v[48:51], v[112:115]
v_exp_f32 v137, v137
v_mfma_f32_16x16x32_bf16 v[188:191], a[176:179], v[64:67], v[108:111]
buffer_load_dwordx4 v1, s[36:39], s72 offen offset:2048 lds
Ljoin38:
v_mfma_f32_16x16x32_bf16 v[168:171], a[164:167], v[52:55], v[168:171]
v_exp_f32 v138, v138
v_mfma_f32_16x16x32_bf16 v[168:171], a[168:171], v[56:59], v[168:171]
ds_read_b128 a[196:199], v2 offset:1024
v_cvt_pk_bf16_f32 v200, v136, v137
v_mfma_f32_16x16x32_bf16 v[168:171], a[172:175], v[60:63], v[168:171]
v_exp_f32 v139, v139
v_mfma_f32_16x16x32_bf16 v[172:175], a[172:175], v[76:79], v[172:175]
v_exp_f32 v152, v152
v_mfma_f32_16x16x32_bf16 v[172:175], a[168:171], v[72:75], v[172:175]
ds_read_b128 a[200:203], v2 offset:2048
v_cvt_pk_bf16_f32 v201, v138, v139
v_mfma_f32_16x16x32_bf16 v[172:175], a[164:167], v[68:71], v[172:175]
buffer_load_dwordx4 v1, s[36:39], s72 offen offset:3072 lds
v_mfma_f32_16x16x32_bf16 v[188:191], a[180:183], v[68:71], v[188:191]
s_add_u32 m0, s92, 4192
v_exp_f32 v153, v153
v_mfma_f32_16x16x32_bf16 v[188:191], a[184:187], v[72:75], v[188:191]
s_add_u32 s72, s93, 0x4
v_exp_f32 v154, v154
v_mfma_f32_16x16x32_bf16 v[188:191], a[188:191], v[76:79], v[188:191]
ds_read_b128 a[204:207], v2 offset:3072
v_cvt_pk_bf16_f32 v202, v152, v153
v_mfma_f32_16x16x32_bf16 v[184:187], a[188:191], v[60:63], v[184:187]
buffer_load_dwordx4 v1, s[36:39], s72 offen lds
v_mfma_f32_16x16x32_bf16 v[184:187], a[184:187], v[56:59], v[184:187]
v_exp_f32 v155, v155
v_mfma_f32_16x16x32_bf16 v[184:187], a[180:183], v[52:55], v[184:187]
s_waitcnt lgkmcnt(4)
v_exp_f32 v140, v140
v_mfma_f32_16x16x32_bf16 a[64:67], a[224:227], v[216:219], a[64:67]
ds_read_b128 a[208:211], v2 offset:4096
v_cvt_pk_bf16_f32 v203, v154, v155
v_mfma_f32_16x16x32_bf16 a[96:99], a[224:227], v[220:223], a[96:99]
v_exp_f32 v141, v141
v_mfma_f32_16x16x32_bf16 a[100:103], a[228:231], v[220:223], a[100:103]
buffer_load_dwordx4 v1, s[36:39], s72 offen offset:1024 lds
v_mfma_f32_16x16x32_bf16 a[68:71], a[228:231], v[216:219], a[68:71]
v_exp_f32 v142, v142
v_mfma_f32_16x16x32_bf16 a[72:75], a[232:235], v[216:219], a[72:75]
ds_read_b128 a[212:215], v2 offset:5120
v_cvt_pk_bf16_f32 v204, v140, v141
v_mfma_f32_16x16x32_bf16 a[104:107], a[232:235], v[220:223], a[104:107]
v_exp_f32 v143, v143
v_mfma_f32_16x16x32_bf16 a[108:111], a[236:239], v[220:223], a[108:111]
v_exp_f32 v156, v156
v_mfma_f32_16x16x32_bf16 a[76:79], a[236:239], v[216:219], a[76:79]
ds_read_b128 a[216:219], v2 offset:6144
v_cvt_pk_bf16_f32 v205, v142, v143
v_mfma_f32_16x16x32_bf16 a[80:83], a[240:243], v[216:219], a[80:83]
buffer_load_dwordx4 v1, s[36:39], s72 offen offset:2048 lds
v_mfma_f32_16x16x32_bf16 a[112:115], a[240:243], v[220:223], a[112:115]
v_exp_f32 v157, v157
v_mfma_f32_16x16x32_bf16 a[116:119], a[244:247], v[220:223], a[116:119]
v_exp_f32 v158, v158
v_mfma_f32_16x16x32_bf16 a[84:87], a[244:247], v[216:219], a[84:87]
ds_read_b128 a[220:223], v2 offset:7168
v_cvt_pk_bf16_f32 v206, v156, v157
v_mfma_f32_16x16x32_bf16 a[88:91], a[248:251], v[216:219], a[88:91]
buffer_load_dwordx4 v1, s[36:39], s72 offen offset:3072 lds
v_mfma_f32_16x16x32_bf16 a[120:123], a[248:251], v[220:223], a[120:123]
v_exp_f32 v159, v159
v_mfma_f32_16x16x32_bf16 a[124:127], a[252:255], v[220:223], a[124:127]
v_cvt_pk_bf16_f32 v207, v158, v159
v_mfma_f32_16x16x32_bf16 a[92:95], a[252:255], v[216:219], a[92:95]
v_mfma_f32_16x16x32_bf16 v[232:235], v[120:123], v[216:219], v[232:235]
v_mfma_f32_16x16x32_bf16 v[236:239], v[120:123], v[220:223], v[236:239]
s_waitcnt lgkmcnt(0)
v_mfma_f32_16x16x32_bf16 a[64:67], a[192:195], v[200:203], a[64:67]
s_add_u32 s82, s82, 0x8000
ds_read_b128 a[224:227], v2 offset:8192
ds_read_b128 a[228:231], v2 offset:9216
v_mfma_f32_16x16x32_bf16 a[96:99], a[192:195], v[204:207], a[96:99]
s_and_b32 s82, s82, 0x1ffff
v_exp_f32 v168, v168
v_mfma_f32_16x16x32_bf16 a[100:103], a[196:199], v[204:207], a[100:103]
v_exp_f32 v169, v169
v_mfma_f32_16x16x32_bf16 a[68:71], a[196:199], v[200:203], a[68:71]
v_exp_f32 v170, v170
v_mfma_f32_16x16x32_bf16 a[72:75], a[200:203], v[200:203], a[72:75]
v_exp_f32 v171, v171
v_mfma_f32_16x16x32_bf16 a[104:107], a[200:203], v[204:207], a[104:107]
ds_read_b128 a[232:235], v2 offset:10240
ds_read_b128 a[236:239], v2 offset:11264
v_mfma_f32_16x16x32_bf16 a[108:111], a[204:207], v[204:207], a[108:111]
v_exp_f32 v184, v184
v_mfma_f32_16x16x32_bf16 a[76:79], a[204:207], v[200:203], a[76:79]
ds_read_b128 a[240:243], v2 offset:12288
ds_read_b128 a[244:247], v2 offset:13312
v_mfma_f32_16x16x32_bf16 a[80:83], a[208:211], v[200:203], a[80:83]
ds_read_b128 a[248:251], v2 offset:14336
ds_read_b128 a[252:255], v2 offset:15360
v_mfma_f32_16x16x32_bf16 a[112:115], a[208:211], v[204:207], a[112:115]
v_cvt_pk_bf16_f32 v216, v168, v169
v_cvt_pk_bf16_f32 v217, v170, v171
v_mfma_f32_16x16x32_bf16 a[116:119], a[212:215], v[204:207], a[116:119]
v_exp_f32 v185, v185
v_mfma_f32_16x16x32_bf16 a[84:87], a[212:215], v[200:203], a[84:87]
v_exp_f32 v186, v186
v_mfma_f32_16x16x32_bf16 a[88:91], a[216:219], v[200:203], a[88:91]
v_exp_f32 v187, v187
v_mfma_f32_16x16x32_bf16 a[120:123], a[216:219], v[204:207], a[120:123]
v_exp_f32 v172, v172
v_mfma_f32_16x16x32_bf16 a[124:127], a[220:223], v[204:207], a[124:127]
v_cvt_pk_bf16_f32 v218, v184, v185
v_cvt_pk_bf16_f32 v219, v186, v187
v_mfma_f32_16x16x32_bf16 a[92:95], a[220:223], v[200:203], a[92:95]
v_exp_f32 v173, v173
v_mfma_f32_16x16x32_bf16 v[232:235], v[120:123], v[200:203], v[232:235]
s_waitcnt vmcnt(0) lgkmcnt(0)
v_exp_f32 v174, v174
v_mfma_f32_16x16x32_bf16 v[236:239], v[120:123], v[204:207], v[236:239]
s_barrier
v_exp_f32 v175, v175
v_add_u32 v2, s82, v1
v_cvt_pk_bf16_f32 v220, v172, v173
v_exp_f32 v188, v188
v_cvt_pk_bf16_f32 v221, v174, v175
v_exp_f32 v189, v189
v_exp_f32 v190, v190
v_cvt_pk_bf16_f32 v222, v188, v189
v_exp_f32 v191, v191
s_nop 0
v_cvt_pk_bf16_f32 v223, v190, v191
LHT4:
v_mfma_f32_16x16x32_bf16 a[64:67], a[224:227], v[216:219], a[64:67]
s_add_u32 s78, s59, 4
ds_write_b64 v5, v[12:13]
v_mov_b32 v240, 0
v_mfma_f32_16x16x32_bf16 a[96:99], a[224:227], v[220:223], a[96:99]
s_and_b32 s78, s78, 28
v_mov_b32 v241, 0
v_mfma_f32_16x16x32_bf16 a[100:103], a[228:231], v[220:223], a[100:103]
s_lshl_b32 s95, s75, 20
ds_write_b64 v14, v[240:241]
ds_read_b128 a[192:195], v7 offset:3584
s_add_u32 s71, s61, 0
s_and_b32 s71, s71, 3
s_add_u32 s71, s71, s78
s_lshl_b32 s71, s71, 18
s_add_u32 s71, s71, s94
s_add_u32 m0, s77, 0
s_add_u32 s72, s71, 0
buffer_load_dwordx4 v15, s[24:27], s72 offen lds
v_mfma_f32_16x16x32_bf16 a[68:71], a[228:231], v[216:219], a[68:71]
s_lshl_b32 s74, s58, 18
ds_read_b64 a[128:129], v6 offset:0
ds_read_b64 a[130:131], v6 offset:8
v_mfma_f32_16x16x32_bf16 a[72:75], a[232:235], v[216:219], a[72:75]
s_add_u32 s95, s95, s74
ds_read_b128 a[196:199], v7 offset:3072
ds_read_b64 a[132:133], v6 offset:512
v_mfma_f32_16x16x32_bf16 a[104:107], a[232:235], v[220:223], a[104:107]
s_add_u32 s95, s95, 0x2000000
ds_read_b64 a[134:135], v6 offset:520
ds_read_b128 a[200:203], v7 offset:2560
v_mfma_f32_16x16x32_bf16 a[108:111], a[236:239], v[220:223], a[108:111]
s_sub_u32 s74, 15, s75
ds_read_b64 a[136:137], v6 offset:1024
ds_read_b64 a[138:139], v6 offset:1032
v_mfma_f32_16x16x32_bf16 a[76:79], a[236:239], v[216:219], a[76:79]
s_min_u32 s74, s74, s75
ds_read_b128 a[204:207], v7 offset:2048
ds_read_b64 a[140:141], v6 offset:1536
v_mfma_f32_16x16x32_bf16 a[80:83], a[240:243], v[216:219], a[80:83]
s_lshl_b32 s74, s74, 7
ds_read_b64 a[142:143], v6 offset:1544
ds_read_b128 a[208:211], v7 offset:1536
s_add_u32 s72, s71, 15360
buffer_load_dwordx4 v15, s[24:27], s72 offen offset:1024 lds
v_mfma_f32_16x16x32_bf16 a[112:115], a[240:243], v[220:223], a[112:115]
s_add_u32 s74, s74, 0x3810000
ds_read_b64 a[144:145], v6 offset:2048
ds_read_b64 a[146:147], v6 offset:2056
v_mfma_f32_16x16x32_bf16 a[116:119], a[244:247], v[220:223], a[116:119]
s_add_u32 s79, s59, 8
ds_read_b128 a[212:215], v7 offset:1024
ds_read_b64 a[148:149], v6 offset:2560
v_mfma_f32_16x16x32_bf16 a[84:87], a[244:247], v[216:219], a[84:87]
s_and_b32 s79, s79, 28
ds_read_b64 a[150:151], v6 offset:2568
ds_read_b128 a[216:219], v7 offset:512
v_mfma_f32_16x16x32_bf16 a[88:91], a[248:251], v[216:219], a[88:91]
ds_read_b64 a[152:153], v6 offset:3072
ds_read_b64 a[154:155], v6 offset:3080
v_mfma_f32_16x16x32_bf16 a[120:123], a[248:251], v[220:223], a[120:123]
ds_read_b128 a[220:223], v7 offset:0
ds_read_b64 a[156:157], v6 offset:3584
v_mfma_f32_16x16x32_bf16 a[124:127], a[252:255], v[220:223], a[124:127]
ds_read_b64 a[158:159], v6 offset:3592
s_add_u32 s72, s71, 30720
buffer_load_dwordx4 v15, s[24:27], s72 offen offset:2048 lds
v_mfma_f32_16x16x32_bf16 a[92:95], a[252:255], v[216:219], a[92:95]
v_mfma_f32_16x16x32_bf16 v[232:235], v[120:123], v[216:219], v[232:235]
v_mfma_f32_16x16x32_bf16 v[236:239], v[120:123], v[220:223], v[236:239]
s_waitcnt lgkmcnt(0)
v_mfma_f32_16x16x32_bf16 v[128:131], v[8:11], a[192:195], 0
v_mfma_f32_16x16x32_bf16 v[128:131], a[128:131], a[192:195], v[128:131]
v_mfma_f32_16x16x32_bf16 v[132:135], v[8:11], a[196:199], 0
ds_read_b128 a[224:227], v7 offset:3648
ds_read_b64 a[160:161], v6 offset:64
s_add_u32 s72, s71, 46080
buffer_load_dwordx4 v15, s[24:27], s72 offen offset:3072 lds
v_mfma_f32_16x16x32_bf16 v[132:135], a[128:131], a[196:199], v[132:135]
v_mfma_f32_16x16x32_bf16 v[132:135], a[132:135], a[192:195], v[132:135]
v_rcp_f32 v232, v232
v_mfma_f32_16x16x32_bf16 v[136:139], v[8:11], a[200:203], 0
ds_read_b64 a[162:163], v6 offset:72
ds_read_b128 a[228:231], v7 offset:3136
v_mfma_f32_16x16x32_bf16 v[136:139], a[128:131], a[200:203], v[136:139]
v_rcp_f32 v236, v236
v_mfma_f32_16x16x32_bf16 v[136:139], a[132:135], a[196:199], v[136:139]
s_lshl_b32 s73, s59, 12
v_mfma_f32_16x16x32_bf16 v[136:139], a[136:139], a[192:195], v[136:139]
s_add_u32 s73, s73, 0x2000000
ds_read_b64 a[164:165], v6 offset:576
ds_read_b64 a[166:167], v6 offset:584
v_mfma_f32_16x16x32_bf16 v[140:143], v[8:11], a[204:207], 0
s_lshl_b32 s70, s68, 2
v_mfma_f32_16x16x32_bf16 v[140:143], a[128:131], a[204:207], v[140:143]
s_add_u32 s70, s70, s73
v_accvgpr_read_b32 v240, a64
v_accvgpr_read_b32 v241, a65
v_accvgpr_read_b32 v242, a66
v_mfma_f32_16x16x32_bf16 v[140:143], a[132:135], a[200:203], v[140:143]
ds_read_b128 a[232:235], v7 offset:2624
ds_read_b64 a[168:169], v6 offset:1088
v_accvgpr_read_b32 v243, a67
v_mfma_f32_16x16x32_bf16 v[140:143], a[136:139], a[196:199], v[140:143]
v_accvgpr_read_b32 v244, a68
v_accvgpr_read_b32 v245, a69
v_accvgpr_read_b32 v246, a70
v_mfma_f32_16x16x32_bf16 v[140:143], a[140:143], a[192:195], v[140:143]
v_accvgpr_read_b32 v247, a71
v_mul_f32 v240, v240, v232
v_mul_f32 v241, v241, v232
v_mfma_f32_16x16x32_bf16 v[144:147], v[8:11], a[208:211], 0
ds_read_b64 a[170:171], v6 offset:1096
ds_read_b128 a[236:239], v7 offset:2112
v_mul_f32 v242, v242, v232
v_mfma_f32_16x16x32_bf16 v[144:147], a[128:131], a[208:211], v[144:147]
v_mul_f32 v243, v243, v232
v_mul_f32 v244, v244, v232
v_mul_f32 v245, v245, v232
v_mfma_f32_16x16x32_bf16 v[144:147], a[132:135], a[204:207], v[144:147]
v_mul_f32 v246, v246, v232
v_mul_f32 v247, v247, v232
v_cvt_pk_bf16_f32 v240, v240, v241
v_mfma_f32_16x16x32_bf16 v[144:147], a[136:139], a[200:203], v[144:147]
ds_read_b64 a[172:173], v6 offset:1600
ds_read_b64 a[174:175], v6 offset:1608
v_cvt_pk_bf16_f32 v241, v242, v243
v_mfma_f32_16x16x32_bf16 v[144:147], a[140:143], a[196:199], v[144:147]
v_cvt_pk_bf16_f32 v242, v244, v245
v_cvt_pk_bf16_f32 v243, v246, v247
v_mfma_f32_16x16x32_bf16 v[144:147], a[144:147], a[192:195], v[144:147]
buffer_store_dwordx4 v[240:243], v1, s[44:47], s70 offen sc1
v_mfma_f32_16x16x32_bf16 v[148:151], v[8:11], a[212:215], 0
ds_read_b128 a[240:243], v7 offset:1600
ds_read_b64 a[176:177], v6 offset:2112
v_accvgpr_read_b32 v248, a72
v_mfma_f32_16x16x32_bf16 v[148:151], a[128:131], a[212:215], v[148:151]
v_accvgpr_read_b32 v249, a73
v_accvgpr_read_b32 v250, a74
v_accvgpr_read_b32 v251, a75
v_mfma_f32_16x16x32_bf16 v[148:151], a[132:135], a[208:211], v[148:151]
v_accvgpr_read_b32 v252, a76
v_accvgpr_read_b32 v253, a77
v_accvgpr_read_b32 v254, a78
v_mfma_f32_16x16x32_bf16 v[148:151], a[136:139], a[204:207], v[148:151]
ds_read_b64 a[178:179], v6 offset:2120
ds_read_b128 a[244:247], v7 offset:1088
v_accvgpr_read_b32 v255, a79
v_mfma_f32_16x16x32_bf16 v[148:151], a[140:143], a[200:203], v[148:151]
v_mul_f32 v248, v248, v232
v_mul_f32 v249, v249, v232
v_mul_f32 v250, v250, v232
v_mfma_f32_16x16x32_bf16 v[148:151], a[144:147], a[196:199], v[148:151]
v_mul_f32 v251, v251, v232
v_mul_f32 v252, v252, v232
v_mul_f32 v253, v253, v232
v_mfma_f32_16x16x32_bf16 v[148:151], a[148:151], a[192:195], v[148:151]
ds_read_b64 a[180:181], v6 offset:2624
ds_read_b64 a[182:183], v6 offset:2632
v_mul_f32 v254, v254, v232
v_mfma_f32_16x16x32_bf16 v[152:155], v[8:11], a[216:219], 0
v_mul_f32 v255, v255, v232
v_cvt_pk_bf16_f32 v248, v248, v249
v_cvt_pk_bf16_f32 v249, v250, v251
v_mfma_f32_16x16x32_bf16 v[152:155], a[128:131], a[216:219], v[152:155]
Lstub5:
s_cbranch_execz Lret
v_cvt_pk_bf16_f32 v250, v252, v253
v_cvt_pk_bf16_f32 v251, v254, v255
v_mfma_f32_16x16x32_bf16 v[152:155], a[132:135], a[212:215], v[152:155]
ds_read_b128 a[248:251], v7 offset:576
ds_read_b64 a[184:185], v6 offset:3136
v_mfma_f32_16x16x32_bf16 v[152:155], a[136:139], a[208:211], v[152:155]
buffer_store_dwordx4 v[248:251], v1, s[44:47], s70 offen offset:1024 sc1
v_mfma_f32_16x16x32_bf16 v[152:155], a[140:143], a[204:207], v[152:155]
v_accvgpr_read_b32 v240, a80
v_accvgpr_read_b32 v241, a81
v_accvgpr_read_b32 v242, a82
v_mfma_f32_16x16x32_bf16 v[152:155], a[144:147], a[200:203], v[152:155]
ds_read_b64 a[186:187], v6 offset:3144
ds_read_b128 a[252:255], v7 offset:64
v_accvgpr_read_b32 v243, a83
v_mfma_f32_16x16x32_bf16 v[152:155], a[148:151], a[196:199], v[152:155]
v_accvgpr_read_b32 v244, a84
v_accvgpr_read_b32 v245, a85
v_accvgpr_read_b32 v246, a86
v_mfma_f32_16x16x32_bf16 v[152:155], a[152:155], a[192:195], v[152:155]
v_accvgpr_read_b32 v247, a87
v_mul_f32 v240, v240, v232
v_mul_f32 v241, v241, v232
v_mfma_f32_16x16x32_bf16 v[156:159], v[8:11], a[220:223], 0
ds_read_b64 a[188:189], v6 offset:3648
ds_read_b64 a[190:191], v6 offset:3656
v_mul_f32 v242, v242, v232
v_mfma_f32_16x16x32_bf16 v[156:159], a[128:131], a[220:223], v[156:159]
v_mul_f32 v243, v243, v232
v_mul_f32 v244, v244, v232
v_mul_f32 v245, v245, v232
v_mfma_f32_16x16x32_bf16 v[156:159], a[132:135], a[216:219], v[156:159]
v_mul_f32 v246, v246, v232
v_mul_f32 v247, v247, v232
v_cvt_pk_bf16_f32 v240, v240, v241
v_mfma_f32_16x16x32_bf16 v[156:159], a[136:139], a[212:215], v[156:159]
v_cvt_pk_bf16_f32 v241, v242, v243
v_cvt_pk_bf16_f32 v242, v244, v245
v_cvt_pk_bf16_f32 v243, v246, v247
v_mfma_f32_16x16x32_bf16 v[156:159], a[140:143], a[208:211], v[156:159]
buffer_store_dwordx4 v[240:243], v1, s[44:47], s70 offen offset:2048 sc1
v_mfma_f32_16x16x32_bf16 v[156:159], a[144:147], a[204:207], v[156:159]
v_accvgpr_read_b32 v248, a88
v_accvgpr_read_b32 v249, a89
v_accvgpr_read_b32 v250, a90
v_mfma_f32_16x16x32_bf16 v[156:159], a[148:151], a[200:203], v[156:159]
v_accvgpr_read_b32 v251, a91
v_accvgpr_read_b32 v252, a92
v_accvgpr_read_b32 v253, a93
v_mfma_f32_16x16x32_bf16 v[156:159], a[152:155], a[196:199], v[156:159]
v_accvgpr_read_b32 v254, a94
v_accvgpr_read_b32 v255, a95
v_mul_f32 v248, v248, v232
v_mfma_f32_16x16x32_bf16 v[156:159], a[156:159], a[192:195], v[156:159]
s_waitcnt lgkmcnt(0)
v_mul_f32 v249, v249, v232
v_mul_f32 v250, v250, v232
v_mul_f32 v251, v251, v232
v_mfma_f32_16x16x32_bf16 v[128:131], a[160:163], a[224:227], v[128:131]
ds_read_b128 a[192:195], v7 offset:3712
ds_read_b64 a[128:129], v6 offset:128
v_mul_f32 v252, v252, v232
v_mfma_f32_16x16x32_bf16 v[132:135], a[164:167], a[224:227], v[132:135]
v_mul_f32 v253, v253, v232
v_mul_f32 v254, v254, v232
v_mul_f32 v255, v255, v232
v_mfma_f32_16x16x32_bf16 v[132:135], a[160:163], a[228:231], v[132:135]
ds_read_b64 a[130:131], v6 offset:136
ds_read_b128 a[196:199], v7 offset:3200
v_cvt_pk_bf16_f32 v248, v248, v249
v_mfma_f32_16x16x32_bf16 v[136:139], a[160:163], a[232:235], v[136:139]
v_cvt_pk_bf16_f32 v249, v250, v251
v_cvt_pk_bf16_f32 v250, v252, v253
v_cvt_pk_bf16_f32 v251, v254, v255
v_mfma_f32_16x16x32_bf16 v[136:139], a[164:167], a[228:231], v[136:139]
buffer_store_dwordx4 v[248:251], v1, s[44:47], s70 offen offset:3072 sc1
v_mfma_f32_16x16x32_bf16 v[136:139], a[168:171], a[224:227], v[136:139]
s_add_u32 s70, s70, 0x20000
ds_read_b64 a[132:133], v6 offset:640
ds_read_b64 a[134:135], v6 offset:648
v_accvgpr_read_b32 v240, a96
v_mfma_f32_16x16x32_bf16 v[140:143], a[172:175], a[224:227], v[140:143]
v_accvgpr_read_b32 v241, a97
v_accvgpr_read_b32 v242, a98
v_accvgpr_read_b32 v243, a99
v_mfma_f32_16x16x32_bf16 v[140:143], a[168:171], a[228:231], v[140:143]
ds_read_b128 a[200:203], v7 offset:2688
ds_read_b64 a[136:137], v6 offset:1152
v_accvgpr_read_b32 v244, a100
v_mfma_f32_16x16x32_bf16 v[140:143], a[164:167], a[232:235], v[140:143]
v_accvgpr_read_b32 v245, a101
v_accvgpr_read_b32 v246, a102
v_accvgpr_read_b32 v247, a103
v_mfma_f32_16x16x32_bf16 v[140:143], a[160:163], a[236:239], v[140:143]
v_mul_f32 v240, v240, v236
v_mul_f32 v241, v241, v236
v_mul_f32 v242, v242, v236
v_mfma_f32_16x16x32_bf16 v[144:147], a[160:163], a[240:243], v[144:147]
ds_read_b64 a[138:139], v6 offset:1160
ds_read_b128 a[204:207], v7 offset:2176
v_mul_f32 v243, v243, v236
v_mfma_f32_16x16x32_bf16 v[144:147], a[164:167], a[236:239], v[144:147]
v_mul_f32 v244, v244, v236
v_mul_f32 v245, v245, v236
v_mul_f32 v246, v246, v236
v_mfma_f32_16x16x32_bf16 v[144:147], a[168:171], a[232:235], v[144:147]
ds_read_b64 a[140:141], v6 offset:1664
ds_read_b64 a[142:143], v6 offset:1672
v_mul_f32 v247, v247, v236
v_mfma_f32_16x16x32_bf16 v[144:147], a[172:175], a[228:231], v[144:147]
v_cvt_pk_bf16_f32 v240, v240, v241
v_cvt_pk_bf16_f32 v241, v242, v243
v_cvt_pk_bf16_f32 v242, v244, v245
v_mfma_f32_16x16x32_bf16 v[144:147], a[176:179], a[224:227], v[144:147]
v_cvt_pk_bf16_f32 v243, v246, v247
v_mfma_f32_16x16x32_bf16 v[148:151], a[180:183], a[224:227], v[148:151]
ds_read_b128 a[208:211], v7 offset:1664
ds_read_b64 a[144:145], v6 offset:2176
v_mfma_f32_16x16x32_bf16 v[148:151], a[176:179], a[228:231], v[148:151]
buffer_store_dwordx4 v[240:243], v1, s[44:47], s70 offen sc1
v_mfma_f32_16x16x32_bf16 v[148:151], a[172:175], a[232:235], v[148:151]
v_accvgpr_read_b32 v248, a104
v_accvgpr_read_b32 v249, a105
v_accvgpr_read_b32 v250, a106
v_mfma_f32_16x16x32_bf16 v[148:151], a[168:171], a[236:239], v[148:151]
ds_read_b64 a[146:147], v6 offset:2184
ds_read_b128 a[212:215], v7 offset:1152
v_accvgpr_read_b32 v251, a107
v_mfma_f32_16x16x32_bf16 v[148:151], a[164:167], a[240:243], v[148:151]
v_accvgpr_read_b32 v252, a108
v_accvgpr_read_b32 v253, a109
v_accvgpr_read_b32 v254, a110
v_mfma_f32_16x16x32_bf16 v[148:151], a[160:163], a[244:247], v[148:151]
ds_read_b64 a[148:149], v6 offset:2688
ds_read_b64 a[150:151], v6 offset:2696
v_accvgpr_read_b32 v255, a111
v_mfma_f32_16x16x32_bf16 v[152:155], a[160:163], a[248:251], v[152:155]
v_mul_f32 v248, v248, v236
v_mul_f32 v249, v249, v236
v_mul_f32 v250, v250, v236
v_mfma_f32_16x16x32_bf16 v[152:155], a[164:167], a[244:247], v[152:155]
v_mul_f32 v251, v251, v236
v_mul_f32 v252, v252, v236
v_mul_f32 v253, v253, v236
v_mfma_f32_16x16x32_bf16 v[152:155], a[168:171], a[240:243], v[152:155]
ds_read_b128 a[216:219], v7 offset:640
ds_read_b64 a[152:153], v6 offset:3200
v_mul_f32 v254, v254, v236
v_mfma_f32_16x16x32_bf16 v[152:155], a[172:175], a[236:239], v[152:155]
v_mul_f32 v255, v255, v236
v_cvt_pk_bf16_f32 v248, v248, v249
v_cvt_pk_bf16_f32 v249, v250, v251
v_mfma_f32_16x16x32_bf16 v[152:155], a[176:179], a[232:235], v[152:155]
ds_read_b64 a[154:155], v6 offset:3208
ds_read_b128 a[220:223], v7 offset:128
v_cvt_pk_bf16_f32 v250, v252, v253
v_mfma_f32_16x16x32_bf16 v[152:155], a[180:183], a[228:231], v[152:155]
v_cvt_pk_bf16_f32 v251, v254, v255
v_mfma_f32_16x16x32_bf16 v[152:155], a[184:187], a[224:227], v[152:155]
buffer_store_dwordx4 v[248:251], v1, s[44:47], s70 offen offset:1024 sc1
v_mfma_f32_16x16x32_bf16 v[156:159], a[188:191], a[224:227], v[156:159]
ds_read_b64 a[156:157], v6 offset:3712
ds_read_b64 a[158:159], v6 offset:3720
v_accvgpr_read_b32 v240, a112
v_mfma_f32_16x16x32_bf16 v[156:159], a[184:187], a[228:231], v[156:159]
v_accvgpr_read_b32 v241, a113
v_accvgpr_read_b32 v242, a114
v_accvgpr_read_b32 v243, a115
v_mfma_f32_16x16x32_bf16 v[156:159], a[180:183], a[232:235], v[156:159]
v_accvgpr_read_b32 v244, a116
v_accvgpr_read_b32 v245, a117
v_accvgpr_read_b32 v246, a118
v_mfma_f32_16x16x32_bf16 v[156:159], a[176:179], a[236:239], v[156:159]
v_accvgpr_read_b32 v247, a119
v_mul_f32 v240, v240, v236
v_mul_f32 v241, v241, v236
v_mfma_f32_16x16x32_bf16 v[156:159], a[172:175], a[240:243], v[156:159]
v_mul_f32 v242, v242, v236
v_mul_f32 v243, v243, v236
v_mul_f32 v244, v244, v236
v_mfma_f32_16x16x32_bf16 v[156:159], a[168:171], a[244:247], v[156:159]
v_mul_f32 v245, v245, v236
v_mul_f32 v246, v246, v236
v_mul_f32 v247, v247, v236
v_mfma_f32_16x16x32_bf16 v[156:159], a[164:167], a[248:251], v[156:159]
v_cvt_pk_bf16_f32 v240, v240, v241
v_cvt_pk_bf16_f32 v241, v242, v243
v_cvt_pk_bf16_f32 v242, v244, v245
v_mfma_f32_16x16x32_bf16 v[156:159], a[160:163], a[252:255], v[156:159]
s_waitcnt lgkmcnt(0)
v_cvt_pk_bf16_f32 v243, v246, v247
v_mfma_f32_16x16x32_bf16 v[128:131], a[128:131], a[192:195], v[128:131]
ds_read_b128 a[224:227], v7 offset:3776
ds_read_b64 a[160:161], v6 offset:192
v_mfma_f32_16x16x32_bf16 v[132:135], a[132:135], a[192:195], v[132:135]
buffer_store_dwordx4 v[240:243], v1, s[44:47], s70 offen offset:2048 sc1
v_mfma_f32_16x16x32_bf16 v[132:135], a[128:131], a[196:199], v[132:135]
ds_read_b64 a[162:163], v6 offset:200
ds_read_b128 a[228:231], v7 offset:3264
v_accvgpr_read_b32 v248, a120
v_mfma_f32_16x16x32_bf16 v[136:139], a[128:131], a[200:203], v[136:139]
v_accvgpr_read_b32 v249, a121
v_accvgpr_read_b32 v250, a122
v_accvgpr_read_b32 v251, a123
v_mfma_f32_16x16x32_bf16 v[136:139], a[132:135], a[196:199], v[136:139]
v_accvgpr_read_b32 v252, a124
v_accvgpr_read_b32 v253, a125
v_accvgpr_read_b32 v254, a126
v_mfma_f32_16x16x32_bf16 v[136:139], a[136:139], a[192:195], v[136:139]
ds_read_b64 a[164:165], v6 offset:704
ds_read_b64 a[166:167], v6 offset:712
v_accvgpr_read_b32 v255, a127
v_mfma_f32_16x16x32_bf16 v[140:143], a[140:143], a[192:195], v[140:143]
v_mul_f32 v248, v248, v236
v_mul_f32 v249, v249, v236
v_mul_f32 v250, v250, v236
v_mfma_f32_16x16x32_bf16 v[140:143], a[136:139], a[196:199], v[140:143]
ds_read_b128 a[232:235], v7 offset:2752
ds_read_b64 a[168:169], v6 offset:1216
v_mul_f32 v251, v251, v236
v_mfma_f32_16x16x32_bf16 v[140:143], a[132:135], a[200:203], v[140:143]
v_mul_f32 v252, v252, v236
v_mul_f32 v253, v253, v236
v_mul_f32 v254, v254, v236
v_mfma_f32_16x16x32_bf16 v[140:143], a[128:131], a[204:207], v[140:143]
v_mul_f32 v255, v255, v236
v_cvt_pk_bf16_f32 v248, v248, v249
v_cvt_pk_bf16_f32 v249, v250, v251
v_mfma_f32_16x16x32_bf16 v[144:147], a[128:131], a[208:211], v[144:147]
ds_read_b64 a[170:171], v6 offset:1224
ds_read_b128 a[236:239], v7 offset:2240
v_cvt_pk_bf16_f32 v250, v252, v253
v_mfma_f32_16x16x32_bf16 v[144:147], a[132:135], a[204:207], v[144:147]
v_cvt_pk_bf16_f32 v251, v254, v255
v_mfma_f32_16x16x32_bf16 v[144:147], a[136:139], a[200:203], v[144:147]
ds_read_b64 a[172:173], v6 offset:1728
ds_read_b64 a[174:175], v6 offset:1736
v_mfma_f32_16x16x32_bf16 v[144:147], a[140:143], a[196:199], v[144:147]
buffer_store_dwordx4 v[248:251], v1, s[44:47], s70 offen offset:3072 sc1
v_mfma_f32_16x16x32_bf16 v[144:147], a[144:147], a[192:195], v[144:147]
s_mov_b32 s73, 0x5d800000
v_add_f32 v227, v226, v230
v_add_f32 v231, v234, v238
v_add_f32 v227, v227, v231
v_mfma_f32_16x16x32_bf16 v[148:151], a[148:151], a[192:195], v[148:151]
ds_read_b128 a[240:243], v7 offset:1728
ds_read_b64 a[176:177], v6 offset:2240
v_cmp_nlt_f32 vcc, v227, s73
v_mfma_f32_16x16x32_bf16 v[148:151], a[144:147], a[196:199], v[148:151]
s_lshl_b32 s73, s58, 2
v_mfma_f32_16x16x32_bf16 v[148:151], a[140:143], a[200:203], v[148:151]
s_add_u32 s73, s73, 163328
v_mov_b32 v231, s73
v_mfma_f32_16x16x32_bf16 v[148:151], a[136:139], a[204:207], v[148:151]
s_or_b32 s73, vcc_lo, vcc_hi
ds_read_b64 a[178:179], v6 offset:2248
ds_read_b128 a[244:247], v7 offset:1216
v_mfma_f32_16x16x32_bf16 v[148:151], a[132:135], a[208:211], v[148:151]
s_min_u32 s73, s73, 1
v_mov_b32 v227, s73
v_mfma_f32_16x16x32_bf16 v[148:151], a[128:131], a[212:215], v[148:151]
ds_read_b64 a[180:181], v6 offset:2752
ds_read_b64 a[182:183], v6 offset:2760
ds_write_b32 v231, v227
v_mfma_f32_16x16x32_bf16 v[152:155], a[128:131], a[216:219], v[152:155]
v_lshrrev_b32 v2, 4, v0
v_lshlrev_b32 v2, 10, v2
v_mfma_f32_16x16x32_bf16 v[152:155], a[132:135], a[212:215], v[152:155]
s_add_u32 s82, s59, 4
v_mfma_f32_16x16x32_bf16 v[152:155], a[136:139], a[208:211], v[152:155]
s_and_b32 s82, s82, 28
ds_read_b128 a[248:251], v7 offset:704
ds_read_b64 a[184:185], v6 offset:3264
v_mfma_f32_16x16x32_bf16 v[152:155], a[140:143], a[204:207], v[152:155]
s_lshl_b32 s82, s82, 10
v_mfma_f32_16x16x32_bf16 v[152:155], a[144:147], a[200:203], v[152:155]
s_add_u32 s71, s61, 1
ds_read_b64 a[186:187], v6 offset:3272
ds_read_b128 a[252:255], v7 offset:192
v_mfma_f32_16x16x32_bf16 v[152:155], a[148:151], a[196:199], v[152:155]
s_and_b32 s71, s71, 3
v_mfma_f32_16x16x32_bf16 v[152:155], a[152:155], a[192:195], v[152:155]
s_add_u32 s71, s71, s78
v_mfma_f32_16x16x32_bf16 v[156:159], a[156:159], a[192:195], v[156:159]
s_lshl_b32 s71, s71, 18
ds_read_b64 a[188:189], v6 offset:3776
ds_read_b64 a[190:191], v6 offset:3784
v_mfma_f32_16x16x32_bf16 v[156:159], a[152:155], a[196:199], v[156:159]
s_add_u32 s71, s71, s94
v_mfma_f32_16x16x32_bf16 v[156:159], a[148:151], a[200:203], v[156:159]
s_add_u32 m0, s77, 16384
v_mfma_f32_16x16x32_bf16 v[156:159], a[144:147], a[204:207], v[156:159]
s_add_u32 s72, s71, 0
buffer_load_dwordx4 v15, s[24:27], s72 offen lds
v_mfma_f32_16x16x32_bf16 v[156:159], a[140:143], a[208:211], v[156:159]
s_add_u32 s72, s71, 15360
buffer_load_dwordx4 v15, s[24:27], s72 offen offset:1024 lds
v_mfma_f32_16x16x32_bf16 v[156:159], a[136:139], a[212:215], v[156:159]
s_add_u32 s82, s82, s74
buffer_load_dword v3, v2, s[44:47], s82 offen sc1
v_mfma_f32_16x16x32_bf16 v[156:159], a[132:135], a[216:219], v[156:159]
v_mfma_f32_16x16x32_bf16 v[156:159], a[128:131], a[220:223], v[156:159]
s_waitcnt lgkmcnt(0)
v_mfma_f32_16x16x32_bf16 v[128:131], a[160:163], a[224:227], v[128:131]
s_add_u32 s72, s71, 30720
ds_read_b128 a[192:195], v7 offset:3840
ds_read_b64 a[128:129], v6 offset:256
v_mfma_f32_16x16x32_bf16 v[132:135], a[164:167], a[224:227], v[132:135]
s_waitcnt vmcnt(3) lgkmcnt(8)
buffer_load_dwordx4 v15, s[24:27], s72 offen offset:2048 lds
v_mfma_f32_16x16x32_bf16 v[132:135], a[160:163], a[228:231], v[132:135]
s_barrier
ds_read_b64 a[130:131], v6 offset:264
ds_read_b128 a[196:199], v7 offset:3328
v_mov_b32 v244, 163328
v_mfma_f32_16x16x32_bf16 v[136:139], a[160:163], a[232:235], v[136:139]
ds_read_b128 v[240:243], v244
v_mfma_f32_16x16x32_bf16 v[136:139], a[164:167], a[228:231], v[136:139]
v_mfma_f32_16x16x32_bf16 v[136:139], a[168:171], a[224:227], v[136:139]
ds_read_b64 a[132:133], v6 offset:768
ds_read_b64 a[134:135], v6 offset:776
v_mfma_f32_16x16x32_bf16 v[140:143], a[172:175], a[224:227], v[140:143]
s_add_u32 s72, s71, 46080
buffer_load_dwordx4 v15, s[24:27], s72 offen offset:3072 lds
v_mfma_f32_16x16x32_bf16 v[140:143], a[168:171], a[228:231], v[140:143]
ds_read_b128 a[200:203], v7 offset:2816
ds_read_b64 a[136:137], v6 offset:1280
v_mfma_f32_16x16x32_bf16 v[140:143], a[164:167], a[232:235], v[140:143]
s_waitcnt lgkmcnt(4)
v_or3_b32 v240, v240, v241, v242
v_or_b32 v240, v240, v243
v_mfma_f32_16x16x32_bf16 v[140:143], a[160:163], a[236:239], v[140:143]
v_cmp_lt_u32 vcc, s86, v240
s_cbranch_vccnz Lslow
v_mfma_f32_16x16x32_bf16 v[144:147], a[160:163], a[240:243], v[144:147]
ds_read_b64 a[138:139], v6 offset:1288
ds_read_b128 a[204:207], v7 offset:2304
v_or_b32 v240, s58, v0
v_mfma_f32_16x16x32_bf16 v[144:147], a[164:167], a[236:239], v[144:147]
v_mov_b32 v241, 2
v_min_u32 v240, 1, v240
v_lshlrev_b32 v240, 30, v240
v_mfma_f32_16x16x32_bf16 v[144:147], a[168:171], a[232:235], v[144:147]
s_add_u32 s71, s61, 2
ds_read_b64 a[140:141], v6 offset:1792
ds_read_b64 a[142:143], v6 offset:1800
v_mfma_f32_16x16x32_bf16 v[144:147], a[172:175], a[228:231], v[144:147]
s_and_b32 s71, s71, 3
buffer_store_dword v241, v240, s[44:47], s91 offen sc1
v_mfma_f32_16x16x32_bf16 v[144:147], a[176:179], a[224:227], v[144:147]
s_add_u32 s71, s71, s78
v_mfma_f32_16x16x32_bf16 v[148:151], a[180:183], a[224:227], v[148:151]
s_lshl_b32 s71, s71, 18
ds_read_b128 a[208:211], v7 offset:1792
ds_read_b64 a[144:145], v6 offset:2304
v_mfma_f32_16x16x32_bf16 v[148:151], a[176:179], a[228:231], v[148:151]
s_add_u32 s71, s71, s94
v_mfma_f32_16x16x32_bf16 v[148:151], a[172:175], a[232:235], v[148:151]
s_add_u32 m0, s77, 32768
v_mfma_f32_16x16x32_bf16 v[148:151], a[168:171], a[236:239], v[148:151]
s_add_u32 s72, s71, 0
ds_read_b64 a[146:147], v6 offset:2312
ds_read_b128 a[212:215], v7 offset:1280
v_mfma_f32_16x16x32_bf16 v[148:151], a[164:167], a[240:243], v[148:151]
s_add_u32 s80, s93, 0x3400000
buffer_load_dwordx4 v15, s[24:27], s72 offen lds
v_and_b32 v166, 7, v0
v_mfma_f32_16x16x32_bf16 v[148:151], a[160:163], a[244:247], v[148:151]
s_add_u32 s72, s71, 15360
ds_read_b64 a[148:149], v6 offset:2816
ds_read_b64 a[150:151], v6 offset:2824
v_lshlrev_b32 v166, 4, v166
v_mfma_f32_16x16x32_bf16 v[152:155], a[160:163], a[248:251], v[152:155]
buffer_load_dwordx4 v15, s[24:27], s72 offen offset:1024 lds
v_bfe_u32 v112, v0, 3, 1
v_mfma_f32_16x16x32_bf16 v[152:155], a[164:167], a[244:247], v[152:155]
v_lshl_add_u32 v166, v112, 8, v166
v_bfe_u32 v112, v0, 4, 1
v_lshl_add_u32 v166, v112, 7, v166
v_mfma_f32_16x16x32_bf16 v[152:155], a[168:171], a[240:243], v[152:155]
ds_read_b128 a[216:219], v7 offset:768
ds_read_b64 a[152:153], v6 offset:3328
v_lshrrev_b32 v112, 5, v0
v_mfma_f32_16x16x32_bf16 v[152:155], a[172:175], a[236:239], v[152:155]
s_add_u32 s72, s71, 30720
buffer_load_dwordx4 v15, s[24:27], s72 offen offset:2048 lds
v_lshl_add_u32 v166, v112, 9, v166
v_mfma_f32_16x16x32_bf16 v[152:155], a[176:179], a[232:235], v[152:155]
ds_read_b64 a[154:155], v6 offset:3336
ds_read_b128 a[220:223], v7 offset:256
v_and_b32 v112, 15, v0
v_mfma_f32_16x16x32_bf16 v[152:155], a[180:183], a[228:231], v[152:155]
v_lshrrev_b32 v113, 2, v0
v_bfe_u32 v114, v0, 3, 2
v_and_b32 v115, 3, v0
v_mfma_f32_16x16x32_bf16 v[152:155], a[184:187], a[224:227], v[152:155]
v_lshlrev_b32 v8, 7, v113
v_lshl_add_u32 v8, v114, 5, v8
v_lshl_add_u32 v8, v115, 3, v8
v_mfma_f32_16x16x32_bf16 v[156:159], a[188:191], a[224:227], v[156:159]
ds_read_b64 a[156:157], v6 offset:3840
ds_read_b64 a[158:159], v6 offset:3848
v_add_u32 v8, s77, v8
v_mfma_f32_16x16x32_bf16 v[156:159], a[184:187], a[228:231], v[156:159]
v_subrev_u32 v8, s64, v8
v_xor_b32 v9, 32, v8
v_xor_b32 v10, 64, v8
v_mfma_f32_16x16x32_bf16 v[156:159], a[180:183], a[232:235], v[156:159]
s_add_u32 s72, s71, 46080
buffer_load_dwordx4 v15, s[24:27], s72 offen offset:3072 lds
v_xor_b32 v11, 0x60, v8
v_mfma_f32_16x16x32_bf16 v[156:159], a[176:179], a[236:239], v[156:159]
v_lshlrev_b32 v5, 8, v113
v_and_b32 v114, 1, v0
v_lshl_add_u32 v5, v114, 7, v5
v_mfma_f32_16x16x32_bf16 v[156:159], a[172:175], a[240:243], v[156:159]
v_bfe_u32 v114, v0, 1, 1
v_lshl_add_u32 v5, v114, 3, v5
v_mov_b32 v114, s58
v_mfma_f32_16x16x32_bf16 v[156:159], a[168:171], a[244:247], v[156:159]
v_lshl_add_u32 v5, v114, 5, v5
v_add_u32 v5, 147456, v5
v_bfe_u32 v114, v0, 1, 2
v_mfma_f32_16x16x32_bf16 v[156:159], a[164:167], a[248:251], v[156:159]
v_lshrrev_b32 v115, 4, v0
v_lshlrev_b32 v116, 7, v112
v_lshl_add_u32 v116, v114, 5, v116
v_mfma_f32_16x16x32_bf16 v[156:159], a[160:163], a[252:255], v[156:159]
s_waitcnt lgkmcnt(0)
v_lshl_add_u32 v116, v115, 3, v116
v_add_u32 v116, s64, v116
v_add_u32 v116, 131072, v116
v_mfma_f32_16x16x32_bf16 v[128:131], a[128:131], a[192:195], v[128:131]
s_add_u32 s71, s61, 3
ds_read_b128 a[224:227], v7 offset:3904
ds_read_b64 a[160:161], v6 offset:320
v_xor_b32 v117, 32, v116
v_mfma_f32_16x16x32_bf16 v[132:135], a[132:135], a[192:195], v[132:135]
s_and_b32 s71, s71, 3
v_xor_b32 v118, 64, v116
v_xor_b32 v119, 0x60, v116
v_mfma_f32_16x16x32_bf16 v[132:135], a[128:131], a[196:199], v[132:135]
s_add_u32 s71, s71, s78
ds_read_b64 a[162:163], v6 offset:328
ds_read_b128 a[228:231], v7 offset:3392
v_mfma_f32_16x16x32_bf16 v[136:139], a[128:131], a[200:203], v[136:139]
s_lshl_b32 s71, s71, 18
v_mfma_f32_16x16x32_bf16 v[136:139], a[132:135], a[196:199], v[136:139]
s_add_u32 s71, s71, s94
v_mfma_f32_16x16x32_bf16 v[136:139], a[136:139], a[192:195], v[136:139]
s_add_u32 m0, s77, 49152
ds_read_b64 a[164:165], v6 offset:832
ds_read_b64 a[166:167], v6 offset:840
v_mfma_f32_16x16x32_bf16 v[140:143], a[140:143], a[192:195], v[140:143]
s_add_u32 s72, s71, 0
buffer_load_dwordx4 v15, s[24:27], s72 offen lds
v_mfma_f32_16x16x32_bf16 v[140:143], a[136:139], a[196:199], v[140:143]
s_add_u32 s72, s71, 15360
ds_read_b128 a[232:235], v7 offset:2880
ds_read_b64 a[168:169], v6 offset:1344
v_mfma_f32_16x16x32_bf16 v[140:143], a[132:135], a[200:203], v[140:143]
buffer_load_dwordx4 v15, s[24:27], s72 offen offset:1024 lds
v_mfma_f32_16x16x32_bf16 v[140:143], a[128:131], a[204:207], v[140:143]
v_mfma_f32_16x16x32_bf16 v[144:147], a[128:131], a[208:211], v[144:147]
ds_read_b64 a[170:171], v6 offset:1352
ds_read_b128 a[236:239], v7 offset:2368
v_mfma_f32_16x16x32_bf16 v[144:147], a[132:135], a[204:207], v[144:147]
v_mfma_f32_16x16x32_bf16 v[144:147], a[136:139], a[200:203], v[144:147]
s_add_u32 s72, s71, 30720
ds_read_b64 a[172:173], v6 offset:1856
ds_read_b64 a[174:175], v6 offset:1864
v_mfma_f32_16x16x32_bf16 v[144:147], a[140:143], a[196:199], v[144:147]
buffer_load_dwordx4 v15, s[24:27], s72 offen offset:2048 lds
v_mfma_f32_16x16x32_bf16 v[144:147], a[144:147], a[192:195], v[144:147]
v_mfma_f32_16x16x32_bf16 v[148:151], a[148:151], a[192:195], v[148:151]
ds_read_b128 a[240:243], v7 offset:1856
ds_read_b64 a[176:177], v6 offset:2368
v_mfma_f32_16x16x32_bf16 v[148:151], a[144:147], a[196:199], v[148:151]
v_mfma_f32_16x16x32_bf16 v[148:151], a[140:143], a[200:203], v[148:151]
v_mfma_f32_16x16x32_bf16 v[148:151], a[136:139], a[204:207], v[148:151]
s_add_u32 s72, s71, 46080
ds_read_b64 a[178:179], v6 offset:2376
ds_read_b128 a[244:247], v7 offset:1344
v_mfma_f32_16x16x32_bf16 v[148:151], a[132:135], a[208:211], v[148:151]
buffer_load_dwordx4 v15, s[24:27], s72 offen offset:3072 lds
v_mfma_f32_16x16x32_bf16 v[148:151], a[128:131], a[212:215], v[148:151]
ds_read_b64 a[180:181], v6 offset:2880
ds_read_b64 a[182:183], v6 offset:2888
v_mfma_f32_16x16x32_bf16 v[152:155], a[128:131], a[216:219], v[152:155]
v_mfma_f32_16x16x32_bf16 v[152:155], a[132:135], a[212:215], v[152:155]
v_mfma_f32_16x16x32_bf16 v[152:155], a[136:139], a[208:211], v[152:155]
ds_read_b128 a[248:251], v7 offset:832
ds_read_b64 a[184:185], v6 offset:3392
v_mfma_f32_16x16x32_bf16 v[152:155], a[140:143], a[204:207], v[152:155]
s_waitcnt vmcnt(11)
v_cmp_gt_u32 vcc, 2, v3
s_or_b32 s81, vcc_lo, vcc_hi
s_cselect_b32 s81, 0x40000000, 0
v_or_b32 v4, s81, v1
v_mfma_f32_16x16x32_bf16 v[152:155], a[144:147], a[200:203], v[152:155]
ds_read_b64 a[186:187], v6 offset:3400
ds_read_b128 a[252:255], v7 offset:320
s_add_u32 s69, s61, 0
s_and_b32 s69, s69, 3
s_add_u32 s69, s69, s78
s_lshl_b32 s69, s69, 12
s_add_u32 s69, s69, s95
buffer_load_dwordx4 a[0:3], v4, s[44:47], s69 offen sc1
v_mfma_f32_16x16x32_bf16 v[152:155], a[148:151], a[196:199], v[152:155]
v_mfma_f32_16x16x32_bf16 v[152:155], a[152:155], a[192:195], v[152:155]
v_mfma_f32_16x16x32_bf16 v[156:159], a[156:159], a[192:195], v[156:159]
ds_read_b64 a[188:189], v6 offset:3904
ds_read_b64 a[190:191], v6 offset:3912
v_mfma_f32_16x16x32_bf16 v[156:159], a[152:155], a[196:199], v[156:159]
buffer_load_dwordx4 a[4:7], v4, s[44:47], s69 offen offset:1024 sc1
v_mfma_f32_16x16x32_bf16 v[156:159], a[148:151], a[200:203], v[156:159]
v_mfma_f32_16x16x32_bf16 v[156:159], a[144:147], a[204:207], v[156:159]
v_mfma_f32_16x16x32_bf16 v[156:159], a[140:143], a[208:211], v[156:159]
v_mfma_f32_16x16x32_bf16 v[156:159], a[136:139], a[212:215], v[156:159]
v_mfma_f32_16x16x32_bf16 v[156:159], a[132:135], a[216:219], v[156:159]
buffer_load_dwordx4 a[8:11], v4, s[44:47], s69 offen offset:2048 sc1
v_mfma_f32_16x16x32_bf16 v[156:159], a[128:131], a[220:223], v[156:159]
s_waitcnt lgkmcnt(0)
v_mfma_f32_16x16x32_bf16 v[128:131], a[160:163], a[224:227], v[128:131]
ds_read_b128 a[192:195], v7 offset:3968
ds_read_b64 a[128:129], v6 offset:384
v_mfma_f32_16x16x32_bf16 v[132:135], a[164:167], a[224:227], v[132:135]
v_mfma_f32_16x16x32_bf16 v[132:135], a[160:163], a[228:231], v[132:135]
ds_read_b64 a[130:131], v6 offset:392
ds_read_b128 a[196:199], v7 offset:3456
v_mfma_f32_16x16x32_bf16 v[136:139], a[160:163], a[232:235], v[136:139]
buffer_load_dwordx4 a[12:15], v4, s[44:47], s69 offen offset:3072 sc1
v_mfma_f32_16x16x32_bf16 v[136:139], a[164:167], a[228:231], v[136:139]
v_mfma_f32_16x16x32_bf16 v[136:139], a[168:171], a[224:227], v[136:139]
ds_read_b64 a[132:133], v6 offset:896
ds_read_b64 a[134:135], v6 offset:904
v_mfma_f32_16x16x32_bf16 v[140:143], a[172:175], a[224:227], v[140:143]
v_mfma_f32_16x16x32_bf16 v[140:143], a[168:171], a[228:231], v[140:143]
ds_read_b128 a[200:203], v7 offset:2944
ds_read_b64 a[136:137], v6 offset:1408
v_mfma_f32_16x16x32_bf16 v[140:143], a[164:167], a[232:235], v[140:143]
s_add_u32 s69, s69, 0x20000
buffer_load_dwordx4 a[16:19], v4, s[44:47], s69 offen sc1
v_mfma_f32_16x16x32_bf16 v[140:143], a[160:163], a[236:239], v[140:143]
v_mfma_f32_16x16x32_bf16 v[144:147], a[160:163], a[240:243], v[144:147]
ds_read_b64 a[138:139], v6 offset:1416
ds_read_b128 a[204:207], v7 offset:2432
v_mfma_f32_16x16x32_bf16 v[144:147], a[164:167], a[236:239], v[144:147]
v_mfma_f32_16x16x32_bf16 v[144:147], a[168:171], a[232:235], v[144:147]
ds_read_b64 a[140:141], v6 offset:1920
ds_read_b64 a[142:143], v6 offset:1928
v_mfma_f32_16x16x32_bf16 v[144:147], a[172:175], a[228:231], v[144:147]
buffer_load_dwordx4 a[20:23], v4, s[44:47], s69 offen offset:1024 sc1
v_mfma_f32_16x16x32_bf16 v[144:147], a[176:179], a[224:227], v[144:147]
v_mfma_f32_16x16x32_bf16 v[148:151], a[180:183], a[224:227], v[148:151]
ds_read_b128 a[208:211], v7 offset:1920
ds_read_b64 a[144:145], v6 offset:2432
v_mfma_f32_16x16x32_bf16 v[148:151], a[176:179], a[228:231], v[148:151]
v_mfma_f32_16x16x32_bf16 v[148:151], a[172:175], a[232:235], v[148:151]
v_mfma_f32_16x16x32_bf16 v[148:151], a[168:171], a[236:239], v[148:151]
ds_read_b64 a[146:147], v6 offset:2440
ds_read_b128 a[212:215], v7 offset:1408
buffer_load_dwordx4 a[24:27], v4, s[44:47], s69 offen offset:2048 sc1
v_mfma_f32_16x16x32_bf16 v[148:151], a[164:167], a[240:243], v[148:151]
v_mfma_f32_16x16x32_bf16 v[148:151], a[160:163], a[244:247], v[148:151]
ds_read_b64 a[148:149], v6 offset:2944
ds_read_b64 a[150:151], v6 offset:2952
v_mfma_f32_16x16x32_bf16 v[152:155], a[160:163], a[248:251], v[152:155]
v_mfma_f32_16x16x32_bf16 v[152:155], a[164:167], a[244:247], v[152:155]
v_mfma_f32_16x16x32_bf16 v[152:155], a[168:171], a[240:243], v[152:155]
ds_read_b128 a[216:219], v7 offset:896
ds_read_b64 a[152:153], v6 offset:3456
buffer_load_dwordx4 a[28:31], v4, s[44:47], s69 offen offset:3072 sc1
v_mfma_f32_16x16x32_bf16 v[152:155], a[172:175], a[236:239], v[152:155]
Lstub6:
s_cbranch_execz Lret
v_mfma_f32_16x16x32_bf16 v[152:155], a[176:179], a[232:235], v[152:155]
ds_read_b64 a[154:155], v6 offset:3464
ds_read_b128 a[220:223], v7 offset:384
v_mfma_f32_16x16x32_bf16 v[152:155], a[180:183], a[228:231], v[152:155]
v_mfma_f32_16x16x32_bf16 v[152:155], a[184:187], a[224:227], v[152:155]
v_mfma_f32_16x16x32_bf16 v[156:159], a[188:191], a[224:227], v[156:159]
ds_read_b64 a[156:157], v6 offset:3968
ds_read_b64 a[158:159], v6 offset:3976
s_add_u32 s69, s61, 1
s_and_b32 s69, s69, 3
s_add_u32 s69, s69, s78
s_lshl_b32 s69, s69, 12
s_add_u32 s69, s69, s95
buffer_load_dwordx4 a[32:35], v4, s[44:47], s69 offen sc1
v_mfma_f32_16x16x32_bf16 v[156:159], a[184:187], a[228:231], v[156:159]
v_mfma_f32_16x16x32_bf16 v[156:159], a[180:183], a[232:235], v[156:159]
v_mfma_f32_16x16x32_bf16 v[156:159], a[176:179], a[236:239], v[156:159]
v_mfma_f32_16x16x32_bf16 v[156:159], a[172:175], a[240:243], v[156:159]
buffer_load_dwordx4 a[36:39], v4, s[44:47], s69 offen offset:1024 sc1
v_mfma_f32_16x16x32_bf16 v[156:159], a[168:171], a[244:247], v[156:159]
v_mfma_f32_16x16x32_bf16 v[156:159], a[164:167], a[248:251], v[156:159]
v_mfma_f32_16x16x32_bf16 v[156:159], a[160:163], a[252:255], v[156:159]
s_waitcnt lgkmcnt(0)
v_mfma_f32_16x16x32_bf16 v[128:131], a[128:131], a[192:195], v[128:131]
ds_read_b128 a[224:227], v7 offset:4032
ds_read_b64 a[160:161], v6 offset:448
v_mfma_f32_16x16x32_bf16 v[132:135], a[132:135], a[192:195], v[132:135]
buffer_load_dwordx4 a[40:43], v4, s[44:47], s69 offen offset:2048 sc1
v_mfma_f32_16x16x32_bf16 v[132:135], a[128:131], a[196:199], v[132:135]
ds_read_b64 a[162:163], v6 offset:456
ds_read_b128 a[228:231], v7 offset:3520
v_mfma_f32_16x16x32_bf16 v[136:139], a[128:131], a[200:203], v[136:139]
v_mfma_f32_16x16x32_bf16 v[136:139], a[132:135], a[196:199], v[136:139]
v_mfma_f32_16x16x32_bf16 v[136:139], a[136:139], a[192:195], v[136:139]
ds_read_b64 a[164:165], v6 offset:960
ds_read_b64 a[166:167], v6 offset:968
v_mfma_f32_16x16x32_bf16 v[140:143], a[140:143], a[192:195], v[140:143]
buffer_load_dwordx4 a[44:47], v4, s[44:47], s69 offen offset:3072 sc1
v_mfma_f32_16x16x32_bf16 v[140:143], a[136:139], a[196:199], v[140:143]
ds_read_b128 a[232:235], v7 offset:3008
ds_read_b64 a[168:169], v6 offset:1472
v_mfma_f32_16x16x32_bf16 v[140:143], a[132:135], a[200:203], v[140:143]
v_mfma_f32_16x16x32_bf16 v[140:143], a[128:131], a[204:207], v[140:143]
v_mfma_f32_16x16x32_bf16 v[144:147], a[128:131], a[208:211], v[144:147]
ds_read_b64 a[170:171], v6 offset:1480
ds_read_b128 a[236:239], v7 offset:2496
v_mfma_f32_16x16x32_bf16 v[144:147], a[132:135], a[204:207], v[144:147]
s_add_u32 s69, s69, 0x20000
buffer_load_dwordx4 a[48:51], v4, s[44:47], s69 offen sc1
v_mfma_f32_16x16x32_bf16 v[144:147], a[136:139], a[200:203], v[144:147]
ds_read_b64 a[172:173], v6 offset:1984
ds_read_b64 a[174:175], v6 offset:1992
v_mfma_f32_16x16x32_bf16 v[144:147], a[140:143], a[196:199], v[144:147]
v_mfma_f32_16x16x32_bf16 v[144:147], a[144:147], a[192:195], v[144:147]
v_mfma_f32_16x16x32_bf16 v[148:151], a[148:151], a[192:195], v[148:151]
ds_read_b128 a[240:243], v7 offset:1984
ds_read_b64 a[176:177], v6 offset:2496
v_mfma_f32_16x16x32_bf16 v[148:151], a[144:147], a[196:199], v[148:151]
buffer_load_dwordx4 a[52:55], v4, s[44:47], s69 offen offset:1024 sc1
v_mfma_f32_16x16x32_bf16 v[148:151], a[140:143], a[200:203], v[148:151]
v_mfma_f32_16x16x32_bf16 v[148:151], a[136:139], a[204:207], v[148:151]
ds_read_b64 a[178:179], v6 offset:2504
ds_read_b128 a[244:247], v7 offset:1472
v_mfma_f32_16x16x32_bf16 v[148:151], a[132:135], a[208:211], v[148:151]
v_mfma_f32_16x16x32_bf16 v[148:151], a[128:131], a[212:215], v[148:151]
ds_read_b64 a[180:181], v6 offset:3008
ds_read_b64 a[182:183], v6 offset:3016
v_mfma_f32_16x16x32_bf16 v[152:155], a[128:131], a[216:219], v[152:155]
buffer_load_dwordx4 a[56:59], v4, s[44:47], s69 offen offset:2048 sc1
v_mfma_f32_16x16x32_bf16 v[152:155], a[132:135], a[212:215], v[152:155]
v_mfma_f32_16x16x32_bf16 v[152:155], a[136:139], a[208:211], v[152:155]
ds_read_b128 a[248:251], v7 offset:960
ds_read_b64 a[184:185], v6 offset:3520
v_mfma_f32_16x16x32_bf16 v[152:155], a[140:143], a[204:207], v[152:155]
v_mfma_f32_16x16x32_bf16 v[152:155], a[144:147], a[200:203], v[152:155]
ds_read_b64 a[186:187], v6 offset:3528
ds_read_b128 a[252:255], v7 offset:448
v_mfma_f32_16x16x32_bf16 v[152:155], a[148:151], a[196:199], v[152:155]
buffer_load_dwordx4 a[60:63], v4, s[44:47], s69 offen offset:3072 sc1
v_mfma_f32_16x16x32_bf16 v[152:155], a[152:155], a[192:195], v[152:155]
v_mfma_f32_16x16x32_bf16 v[156:159], a[156:159], a[192:195], v[156:159]
ds_read_b64 a[188:189], v6 offset:4032
ds_read_b64 a[190:191], v6 offset:4040
v_mfma_f32_16x16x32_bf16 v[156:159], a[152:155], a[196:199], v[156:159]
v_mfma_f32_16x16x32_bf16 v[156:159], a[148:151], a[200:203], v[156:159]
v_mfma_f32_16x16x32_bf16 v[156:159], a[144:147], a[204:207], v[156:159]
s_add_u32 s69, s61, 2
s_and_b32 s69, s69, 3
s_add_u32 s69, s69, s78
s_lshl_b32 s69, s69, 12
s_add_u32 s69, s69, s95
buffer_load_dwordx4 a[64:67], v4, s[44:47], s69 offen sc1
v_mfma_f32_16x16x32_bf16 v[156:159], a[140:143], a[208:211], v[156:159]
v_mfma_f32_16x16x32_bf16 v[156:159], a[136:139], a[212:215], v[156:159]
v_mfma_f32_16x16x32_bf16 v[156:159], a[132:135], a[216:219], v[156:159]
v_mfma_f32_16x16x32_bf16 v[156:159], a[128:131], a[220:223], v[156:159]
s_waitcnt lgkmcnt(0)
buffer_load_dwordx4 a[68:71], v4, s[44:47], s69 offen offset:1024 sc1
v_mfma_f32_16x16x32_bf16 v[128:131], a[160:163], a[224:227], v[128:131]
ds_read_b64_tr_b16 v[192:193], v8 offset:0
v_mfma_f32_16x16x32_bf16 v[132:135], a[164:167], a[224:227], v[132:135]
ds_read_b64_tr_b16 v[194:195], v8 offset:2048
v_mfma_f32_16x16x32_bf16 v[132:135], a[160:163], a[228:231], v[132:135]
ds_read_b64_tr_b16 v[196:197], v9 offset:0
v_mfma_f32_16x16x32_bf16 v[136:139], a[160:163], a[232:235], v[136:139]
ds_read_b64_tr_b16 v[198:199], v9 offset:2048
v_mfma_f32_16x16x32_bf16 v[136:139], a[164:167], a[228:231], v[136:139]
ds_read_b64_tr_b16 v[200:201], v10 offset:0
buffer_load_dwordx4 a[72:75], v4, s[44:47], s69 offen offset:2048 sc1
v_mfma_f32_16x16x32_bf16 v[136:139], a[168:171], a[224:227], v[136:139]
ds_read_b64_tr_b16 v[202:203], v10 offset:2048
v_mfma_f32_16x16x32_bf16 v[140:143], a[172:175], a[224:227], v[140:143]
ds_read_b64_tr_b16 v[204:205], v11 offset:0
v_mfma_f32_16x16x32_bf16 v[140:143], a[168:171], a[228:231], v[140:143]
ds_read_b64_tr_b16 v[206:207], v11 offset:2048
v_cvt_pk_bf16_f32 v128, v128, v129
v_cvt_pk_bf16_f32 v129, v130, v131
v_cvt_pk_bf16_f32 v130, v132, v133
v_mfma_f32_16x16x32_bf16 v[140:143], a[164:167], a[232:235], v[140:143]
ds_read_b64_tr_b16 v[208:209], v8 offset:4096
v_cvt_pk_bf16_f32 v131, v134, v135
v_permlane32_swap_b32 v128, v130
s_nop 0
v_permlane32_swap_b32 v129, v131
v_mfma_f32_16x16x32_bf16 v[140:143], a[160:163], a[236:239], v[140:143]
ds_read_b64_tr_b16 v[210:211], v8 offset:6144
buffer_load_dwordx4 a[76:79], v4, s[44:47], s69 offen offset:3072 sc1
v_mfma_f32_16x16x32_bf16 v[144:147], a[160:163], a[240:243], v[144:147]
ds_read_b64_tr_b16 v[212:213], v9 offset:4096
buffer_store_dwordx4 v[128:131], v166, s[44:47], s80 offen sc1
v_mfma_f32_16x16x32_bf16 v[144:147], a[164:167], a[236:239], v[144:147]
ds_read_b64_tr_b16 v[214:215], v9 offset:6144
v_mfma_f32_16x16x32_bf16 v[144:147], a[168:171], a[232:235], v[144:147]
ds_read_b64_tr_b16 v[216:217], v10 offset:4096
v_mfma_f32_16x16x32_bf16 v[144:147], a[172:175], a[228:231], v[144:147]
ds_read_b64_tr_b16 v[218:219], v10 offset:6144
v_mfma_f32_16x16x32_bf16 v[144:147], a[176:179], a[224:227], v[144:147]
ds_read_b64_tr_b16 v[220:221], v11 offset:4096
s_add_u32 s69, s69, 0x20000
buffer_load_dwordx4 a[80:83], v4, s[44:47], s69 offen sc1
v_mfma_f32_16x16x32_bf16 v[148:151], a[180:183], a[224:227], v[148:151]
ds_read_b64_tr_b16 v[222:223], v11 offset:6144
v_cvt_pk_bf16_f32 v136, v136, v137
v_cvt_pk_bf16_f32 v137, v138, v139
v_cvt_pk_bf16_f32 v138, v140, v141
v_mfma_f32_16x16x32_bf16 v[148:151], a[176:179], a[228:231], v[148:151]
ds_read_b64_tr_b16 v[224:225], v8 offset:8192
v_cvt_pk_bf16_f32 v139, v142, v143
v_permlane32_swap_b32 v136, v138
s_nop 0
v_permlane32_swap_b32 v137, v139
v_mfma_f32_16x16x32_bf16 v[148:151], a[172:175], a[232:235], v[148:151]
ds_read_b64_tr_b16 v[226:227], v8 offset:10240
buffer_store_dwordx4 v[136:139], v166, s[44:47], s80 offen offset:1024 sc1
v_mfma_f32_16x16x32_bf16 v[148:151], a[168:171], a[236:239], v[148:151]
ds_read_b64_tr_b16 v[228:229], v9 offset:8192
v_mfma_f32_16x16x32_bf16 v[148:151], a[164:167], a[240:243], v[148:151]
ds_read_b64_tr_b16 v[230:231], v9 offset:10240
buffer_load_dwordx4 a[84:87], v4, s[44:47], s69 offen offset:1024 sc1
v_mfma_f32_16x16x32_bf16 v[148:151], a[160:163], a[244:247], v[148:151]
ds_read_b64_tr_b16 v[232:233], v10 offset:8192
v_mfma_f32_16x16x32_bf16 v[152:155], a[160:163], a[248:251], v[152:155]
ds_read_b64_tr_b16 v[234:235], v10 offset:10240
v_mfma_f32_16x16x32_bf16 v[152:155], a[164:167], a[244:247], v[152:155]
ds_read_b64_tr_b16 v[236:237], v11 offset:8192
v_mfma_f32_16x16x32_bf16 v[152:155], a[168:171], a[240:243], v[152:155]
ds_read_b64_tr_b16 v[238:239], v11 offset:10240
v_mfma_f32_16x16x32_bf16 v[152:155], a[172:175], a[236:239], v[152:155]
ds_read_b64_tr_b16 v[240:241], v8 offset:12288
buffer_load_dwordx4 a[88:91], v4, s[44:47], s69 offen offset:2048 sc1
v_mfma_f32_16x16x32_bf16 v[152:155], a[176:179], a[232:235], v[152:155]
ds_read_b64_tr_b16 v[242:243], v8 offset:14336
v_cvt_pk_bf16_f32 v144, v144, v145
v_cvt_pk_bf16_f32 v145, v146, v147
v_cvt_pk_bf16_f32 v146, v148, v149
v_mfma_f32_16x16x32_bf16 v[152:155], a[180:183], a[228:231], v[152:155]
ds_read_b64_tr_b16 v[244:245], v9 offset:12288
v_cvt_pk_bf16_f32 v147, v150, v151
v_permlane32_swap_b32 v144, v146
s_nop 0
v_permlane32_swap_b32 v145, v147
v_mfma_f32_16x16x32_bf16 v[152:155], a[184:187], a[224:227], v[152:155]
ds_read_b64_tr_b16 v[246:247], v9 offset:14336
buffer_store_dwordx4 v[144:147], v166, s[44:47], s80 offen offset:2048 sc1
v_mfma_f32_16x16x32_bf16 v[156:159], a[188:191], a[224:227], v[156:159]
ds_read_b64_tr_b16 v[248:249], v10 offset:12288
v_mfma_f32_16x16x32_bf16 v[156:159], a[184:187], a[228:231], v[156:159]
ds_read_b64_tr_b16 v[250:251], v10 offset:14336
buffer_load_dwordx4 a[92:95], v4, s[44:47], s69 offen offset:3072 sc1
v_mfma_f32_16x16x32_bf16 v[156:159], a[180:183], a[232:235], v[156:159]
ds_read_b64_tr_b16 v[252:253], v11 offset:12288
v_mfma_f32_16x16x32_bf16 v[156:159], a[176:179], a[236:239], v[156:159]
ds_read_b64_tr_b16 v[254:255], v11 offset:14336
v_mfma_f32_16x16x32_bf16 v[156:159], a[172:175], a[240:243], v[156:159]
v_mfma_f32_16x16x32_bf16 v[156:159], a[168:171], a[244:247], v[156:159]
v_mfma_f32_16x16x32_bf16 v[156:159], a[164:167], a[248:251], v[156:159]
v_mfma_f32_16x16x32_bf16 v[156:159], a[160:163], a[252:255], v[156:159]
v_cvt_pk_bf16_f32 v152, v152, v153
v_cvt_pk_bf16_f32 v153, v154, v155
s_nop 5
v_cvt_pk_bf16_f32 v154, v156, v157
v_cvt_pk_bf16_f32 v155, v158, v159
s_nop 0
v_permlane32_swap_b32 v152, v154
v_permlane32_swap_b32 v153, v155
buffer_store_dwordx4 v[152:155], v166, s[44:47], s80 offen offset:3072 sc1
s_waitcnt vmcnt(20) lgkmcnt(0)
s_cmp_lg_u32 s81, 0
s_cbranch_scc1 Lredo0
Lredo0b:
s_barrier
v_mfma_f32_16x16x32_bf16 v[16:19], v[192:195], a[0:3], 0
s_add_u32 s82, s59, 8
s_and_b32 s82, s82, 28
s_lshl_b32 s82, s82, 10
s_add_u32 s82, s82, s74
buffer_load_dword v3, v2, s[44:47], s82 offen sc1
v_mfma_f32_16x16x32_bf16 v[16:19], v[208:211], a[4:7], v[16:19]
s_add_u32 s69, s61, 3
ds_read_b64_tr_b16 v[128:129], v8 offset:16384
ds_read_b64_tr_b16 v[130:131], v8 offset:18432
v_mfma_f32_16x16x32_bf16 v[16:19], v[224:227], a[8:11], v[16:19]
s_and_b32 s69, s69, 3
s_add_u32 s69, s69, s78
s_lshl_b32 s69, s69, 12
s_add_u32 s69, s69, s95
buffer_load_dwordx4 a[96:99], v1, s[44:47], s69 offen sc1
v_mfma_f32_16x16x32_bf16 v[16:19], v[240:243], a[12:15], v[16:19]
ds_read_b64_tr_b16 v[132:133], v9 offset:16384
ds_read_b64_tr_b16 v[134:135], v9 offset:18432
v_mfma_f32_16x16x32_bf16 v[32:35], v[240:243], a[28:31], 0
ds_read_b64_tr_b16 v[136:137], v10 offset:16384
ds_read_b64_tr_b16 v[138:139], v10 offset:18432
v_mfma_f32_16x16x32_bf16 v[32:35], v[224:227], a[24:27], v[32:35]
buffer_load_dwordx4 a[100:103], v1, s[44:47], s69 offen offset:1024 sc1
v_mfma_f32_16x16x32_bf16 v[32:35], v[208:211], a[20:23], v[32:35]
ds_read_b64_tr_b16 v[140:141], v11 offset:16384
ds_read_b64_tr_b16 v[142:143], v11 offset:18432
v_mfma_f32_16x16x32_bf16 v[32:35], v[192:195], a[16:19], v[32:35]
ds_read_b64_tr_b16 v[144:145], v8 offset:20480
ds_read_b64_tr_b16 v[146:147], v8 offset:22528
v_mfma_f32_16x16x32_bf16 v[36:39], v[196:199], a[16:19], 0
buffer_load_dwordx4 a[104:107], v1, s[44:47], s69 offen offset:2048 sc1
v_mfma_f32_16x16x32_bf16 v[36:39], v[212:215], a[20:23], v[36:39]
ds_read_b64_tr_b16 v[148:149], v9 offset:20480
ds_read_b64_tr_b16 v[150:151], v9 offset:22528
v_mfma_f32_16x16x32_bf16 v[36:39], v[228:231], a[24:27], v[36:39]
ds_read_b64_tr_b16 v[152:153], v10 offset:20480
ds_read_b64_tr_b16 v[154:155], v10 offset:22528
v_mfma_f32_16x16x32_bf16 v[36:39], v[244:247], a[28:31], v[36:39]
buffer_load_dwordx4 a[108:111], v1, s[44:47], s69 offen offset:3072 sc1
v_mfma_f32_16x16x32_bf16 v[20:23], v[244:247], a[12:15], 0
s_add_u32 s69, s69, 0x20000
ds_read_b64_tr_b16 v[156:157], v11 offset:20480
ds_read_b64_tr_b16 v[158:159], v11 offset:22528
v_mfma_f32_16x16x32_bf16 v[20:23], v[228:231], a[8:11], v[20:23]
buffer_load_dwordx4 a[112:115], v1, s[44:47], s69 offen sc1
v_mfma_f32_16x16x32_bf16 v[20:23], v[212:215], a[4:7], v[20:23]
ds_read_b64_tr_b16 v[160:161], v8 offset:24576
v_mfma_f32_16x16x32_bf16 v[20:23], v[196:199], a[0:3], v[20:23]
ds_read_b64_tr_b16 v[162:163], v8 offset:26624
ds_read_b64_tr_b16 v[164:165], v9 offset:24576
v_mfma_f32_16x16x32_bf16 v[24:27], v[200:203], a[0:3], 0
buffer_load_dwordx4 a[116:119], v1, s[44:47], s69 offen offset:1024 sc1
v_mfma_f32_16x16x32_bf16 v[24:27], v[216:219], a[4:7], v[24:27]
ds_read_b64_tr_b16 v[166:167], v9 offset:26624
ds_read_b64_tr_b16 v[168:169], v10 offset:24576
v_mfma_f32_16x16x32_bf16 v[24:27], v[232:235], a[8:11], v[24:27]
ds_read_b64_tr_b16 v[170:171], v10 offset:26624
ds_read_b64_tr_b16 v[172:173], v11 offset:24576
v_mfma_f32_16x16x32_bf16 v[24:27], v[248:251], a[12:15], v[24:27]
buffer_load_dwordx4 a[120:123], v1, s[44:47], s69 offen offset:2048 sc1
v_mfma_f32_16x16x32_bf16 v[40:43], v[248:251], a[28:31], 0
ds_read_b64_tr_b16 v[174:175], v11 offset:26624
ds_read_b64_tr_b16 v[176:177], v8 offset:28672
v_mfma_f32_16x16x32_bf16 v[40:43], v[232:235], a[24:27], v[40:43]
ds_read_b64_tr_b16 v[178:179], v8 offset:30720
ds_read_b64_tr_b16 v[180:181], v9 offset:28672
v_mfma_f32_16x16x32_bf16 v[40:43], v[216:219], a[20:23], v[40:43]
buffer_load_dwordx4 a[124:127], v1, s[44:47], s69 offen offset:3072 sc1
v_mfma_f32_16x16x32_bf16 v[40:43], v[200:203], a[16:19], v[40:43]
s_add_u32 s71, s61, 0
ds_read_b64_tr_b16 v[182:183], v9 offset:30720
ds_read_b64_tr_b16 v[184:185], v10 offset:28672
v_mfma_f32_16x16x32_bf16 v[44:47], v[204:207], a[16:19], 0
s_and_b32 s71, s71, 3
s_add_u32 s71, s71, s79
s_lshl_b32 s71, s71, 18
s_add_u32 s71, s71, s94
s_add_u32 m0, s77, 0
s_add_u32 s72, s71, 0
buffer_load_dwordx4 v15, s[24:27], s72 offen lds
v_mfma_f32_16x16x32_bf16 v[44:47], v[220:223], a[20:23], v[44:47]
s_add_u32 s72, s71, 15360
ds_read_b64_tr_b16 v[186:187], v10 offset:30720
ds_read_b64_tr_b16 v[188:189], v11 offset:28672
v_mfma_f32_16x16x32_bf16 v[44:47], v[236:239], a[24:27], v[44:47]
ds_read_b64_tr_b16 v[190:191], v11 offset:30720
v_mfma_f32_16x16x32_bf16 v[44:47], v[252:255], a[28:31], v[44:47]
buffer_load_dwordx4 v15, s[24:27], s72 offen offset:1024 lds
v_mfma_f32_16x16x32_bf16 v[28:31], v[252:255], a[12:15], 0
s_add_u32 s72, s71, 30720
v_mfma_f32_16x16x32_bf16 v[28:31], v[236:239], a[8:11], v[28:31]
v_mfma_f32_16x16x32_bf16 v[28:31], v[220:223], a[4:7], v[28:31]
s_waitcnt vmcnt(19) lgkmcnt(0)
buffer_load_dwordx4 v15, s[24:27], s72 offen offset:2048 lds
v_mfma_f32_16x16x32_bf16 v[28:31], v[204:207], a[0:3], v[28:31]
s_barrier
v_mfma_f32_16x16x32_bf16 v[16:19], v[128:131], a[32:35], v[16:19]
s_add_u32 s72, s71, 46080
ds_read_b64_tr_b16 v[192:193], v8 offset:32768
ds_read_b64_tr_b16 v[194:195], v8 offset:34816
v_mfma_f32_16x16x32_bf16 v[16:19], v[144:147], a[36:39], v[16:19]
buffer_load_dwordx4 v15, s[24:27], s72 offen offset:3072 lds
v_mfma_f32_16x16x32_bf16 v[16:19], v[160:163], a[40:43], v[16:19]
ds_read_b64_tr_b16 v[196:197], v9 offset:32768
ds_read_b64_tr_b16 v[198:199], v9 offset:34816
v_mfma_f32_16x16x32_bf16 v[16:19], v[176:179], a[44:47], v[16:19]
ds_read_b64_tr_b16 v[200:201], v10 offset:32768
ds_read_b64_tr_b16 v[202:203], v10 offset:34816
v_mfma_f32_16x16x32_bf16 v[32:35], v[176:179], a[60:63], v[32:35]
s_waitcnt vmcnt(12)
v_cmp_gt_u32 vcc, 2, v3
s_cbranch_vccnz Lspin69
Lback70:
s_add_u32 s69, s61, 0
s_and_b32 s69, s69, 3
s_add_u32 s69, s69, s79
s_lshl_b32 s69, s69, 12
s_add_u32 s69, s69, s95
buffer_load_dwordx4 a[0:3], v1, s[44:47], s69 offen sc1
v_mfma_f32_16x16x32_bf16 v[32:35], v[160:163], a[56:59], v[32:35]
ds_read_b64_tr_b16 v[204:205], v11 offset:32768
ds_read_b64_tr_b16 v[206:207], v11 offset:34816
v_mfma_f32_16x16x32_bf16 v[32:35], v[144:147], a[52:55], v[32:35]
buffer_load_dwordx4 a[4:7], v1, s[44:47], s69 offen offset:1024 sc1
v_mfma_f32_16x16x32_bf16 v[32:35], v[128:131], a[48:51], v[32:35]
ds_read_b64_tr_b16 v[208:209], v8 offset:36864
ds_read_b64_tr_b16 v[210:211], v8 offset:38912
v_mfma_f32_16x16x32_bf16 v[36:39], v[132:135], a[48:51], v[36:39]
ds_read_b64_tr_b16 v[212:213], v9 offset:36864
ds_read_b64_tr_b16 v[214:215], v9 offset:38912
v_mfma_f32_16x16x32_bf16 v[36:39], v[148:151], a[52:55], v[36:39]
buffer_load_dwordx4 a[8:11], v1, s[44:47], s69 offen offset:2048 sc1
v_mfma_f32_16x16x32_bf16 v[36:39], v[164:167], a[56:59], v[36:39]
ds_read_b64_tr_b16 v[216:217], v10 offset:36864
ds_read_b64_tr_b16 v[218:219], v10 offset:38912
v_mfma_f32_16x16x32_bf16 v[36:39], v[180:183], a[60:63], v[36:39]
ds_read_b64_tr_b16 v[220:221], v11 offset:36864
ds_read_b64_tr_b16 v[222:223], v11 offset:38912
v_mfma_f32_16x16x32_bf16 v[20:23], v[180:183], a[44:47], v[20:23]
buffer_load_dwordx4 a[12:15], v1, s[44:47], s69 offen offset:3072 sc1
v_mfma_f32_16x16x32_bf16 v[20:23], v[164:167], a[40:43], v[20:23]
s_add_u32 s69, s69, 0x20000
ds_read_b64_tr_b16 v[224:225], v8 offset:40960
v_mfma_f32_16x16x32_bf16 v[20:23], v[148:151], a[36:39], v[20:23]
ds_read_b64_tr_b16 v[226:227], v8 offset:43008
ds_read_b64_tr_b16 v[228:229], v9 offset:40960
v_mfma_f32_16x16x32_bf16 v[20:23], v[132:135], a[32:35], v[20:23]
buffer_load_dwordx4 a[16:19], v1, s[44:47], s69 offen sc1
v_mfma_f32_16x16x32_bf16 v[24:27], v[136:139], a[32:35], v[24:27]
ds_read_b64_tr_b16 v[230:231], v9 offset:43008
ds_read_b64_tr_b16 v[232:233], v10 offset:40960
v_mfma_f32_16x16x32_bf16 v[24:27], v[152:155], a[36:39], v[24:27]
buffer_load_dwordx4 a[20:23], v1, s[44:47], s69 offen offset:1024 sc1
v_mfma_f32_16x16x32_bf16 v[24:27], v[168:171], a[40:43], v[24:27]
ds_read_b64_tr_b16 v[234:235], v10 offset:43008
ds_read_b64_tr_b16 v[236:237], v11 offset:40960
v_mfma_f32_16x16x32_bf16 v[24:27], v[184:187], a[44:47], v[24:27]
ds_read_b64_tr_b16 v[238:239], v11 offset:43008
ds_read_b64_tr_b16 v[240:241], v8 offset:45056
v_mfma_f32_16x16x32_bf16 v[40:43], v[184:187], a[60:63], v[40:43]
buffer_load_dwordx4 a[24:27], v1, s[44:47], s69 offen offset:2048 sc1
v_mfma_f32_16x16x32_bf16 v[40:43], v[168:171], a[56:59], v[40:43]
ds_read_b64_tr_b16 v[242:243], v8 offset:47104
ds_read_b64_tr_b16 v[244:245], v9 offset:45056
v_mfma_f32_16x16x32_bf16 v[40:43], v[152:155], a[52:55], v[40:43]
ds_read_b64_tr_b16 v[246:247], v9 offset:47104
ds_read_b64_tr_b16 v[248:249], v10 offset:45056
v_mfma_f32_16x16x32_bf16 v[40:43], v[136:139], a[48:51], v[40:43]
buffer_load_dwordx4 a[28:31], v1, s[44:47], s69 offen offset:3072 sc1
v_mfma_f32_16x16x32_bf16 v[44:47], v[140:143], a[48:51], v[44:47]
s_add_u32 s71, s61, 1
ds_read_b64_tr_b16 v[250:251], v10 offset:47104
ds_read_b64_tr_b16 v[252:253], v11 offset:45056
v_mfma_f32_16x16x32_bf16 v[44:47], v[156:159], a[52:55], v[44:47]
s_and_b32 s71, s71, 3
ds_read_b64_tr_b16 v[254:255], v11 offset:47104
v_mfma_f32_16x16x32_bf16 v[44:47], v[172:175], a[56:59], v[44:47]
s_add_u32 s71, s71, s79
s_lshl_b32 s71, s71, 18
s_add_u32 s71, s71, s94
s_add_u32 m0, s77, 16384
s_add_u32 s72, s71, 0
buffer_load_dwordx4 v15, s[24:27], s72 offen lds
v_mfma_f32_16x16x32_bf16 v[44:47], v[188:191], a[60:63], v[44:47]
s_add_u32 s72, s71, 15360
v_mfma_f32_16x16x32_bf16 v[28:31], v[188:191], a[44:47], v[28:31]
v_mfma_f32_16x16x32_bf16 v[28:31], v[172:175], a[40:43], v[28:31]
buffer_load_dwordx4 v15, s[24:27], s72 offen offset:1024 lds
v_mfma_f32_16x16x32_bf16 v[28:31], v[156:159], a[36:39], v[28:31]
s_waitcnt vmcnt(23) lgkmcnt(0)
v_mfma_f32_16x16x32_bf16 v[28:31], v[140:143], a[32:35], v[28:31]
s_barrier
s_add_u32 s72, s71, 30720
buffer_load_dwordx4 v15, s[24:27], s72 offen offset:2048 lds
v_mfma_f32_16x16x32_bf16 v[16:19], v[192:195], a[64:67], v[16:19]
s_add_u32 s72, s71, 46080
ds_read_b64_tr_b16 v[128:129], v8 offset:49152
ds_read_b64_tr_b16 v[130:131], v8 offset:51200
v_mfma_f32_16x16x32_bf16 v[16:19], v[208:211], a[68:71], v[16:19]
ds_read_b64_tr_b16 v[132:133], v9 offset:49152
ds_read_b64_tr_b16 v[134:135], v9 offset:51200
v_mfma_f32_16x16x32_bf16 v[16:19], v[224:227], a[72:75], v[16:19]
buffer_load_dwordx4 v15, s[24:27], s72 offen offset:3072 lds
v_mfma_f32_16x16x32_bf16 v[16:19], v[240:243], a[76:79], v[16:19]
s_add_u32 s69, s61, 1
ds_read_b64_tr_b16 v[136:137], v10 offset:49152
ds_read_b64_tr_b16 v[138:139], v10 offset:51200
v_mfma_f32_16x16x32_bf16 v[32:35], v[240:243], a[92:95], v[32:35]
s_and_b32 s69, s69, 3
ds_read_b64_tr_b16 v[140:141], v11 offset:49152
ds_read_b64_tr_b16 v[142:143], v11 offset:51200
v_mfma_f32_16x16x32_bf16 v[32:35], v[224:227], a[88:91], v[32:35]
s_add_u32 s69, s69, s79
s_lshl_b32 s69, s69, 12
s_add_u32 s69, s69, s95
buffer_load_dwordx4 a[32:35], v1, s[44:47], s69 offen sc1
v_mfma_f32_16x16x32_bf16 v[32:35], v[208:211], a[84:87], v[32:35]
ds_read_b64_tr_b16 v[144:145], v8 offset:53248
v_mfma_f32_16x16x32_bf16 v[32:35], v[192:195], a[80:83], v[32:35]
ds_read_b64_tr_b16 v[146:147], v8 offset:55296
ds_read_b64_tr_b16 v[148:149], v9 offset:53248
v_mfma_f32_16x16x32_bf16 v[36:39], v[196:199], a[80:83], v[36:39]
buffer_load_dwordx4 a[36:39], v1, s[44:47], s69 offen offset:1024 sc1
v_mfma_f32_16x16x32_bf16 v[36:39], v[212:215], a[84:87], v[36:39]
ds_read_b64_tr_b16 v[150:151], v9 offset:55296
ds_read_b64_tr_b16 v[152:153], v10 offset:53248
v_mfma_f32_16x16x32_bf16 v[36:39], v[228:231], a[88:91], v[36:39]
buffer_load_dwordx4 a[40:43], v1, s[44:47], s69 offen offset:2048 sc1
v_mfma_f32_16x16x32_bf16 v[36:39], v[244:247], a[92:95], v[36:39]
ds_read_b64_tr_b16 v[154:155], v10 offset:55296
ds_read_b64_tr_b16 v[156:157], v11 offset:53248
v_mfma_f32_16x16x32_bf16 v[20:23], v[244:247], a[76:79], v[20:23]
ds_read_b64_tr_b16 v[158:159], v11 offset:55296
v_mfma_f32_16x16x32_bf16 v[20:23], v[228:231], a[72:75], v[20:23]
buffer_load_dwordx4 a[44:47], v1, s[44:47], s69 offen offset:3072 sc1
v_mfma_f32_16x16x32_bf16 v[20:23], v[212:215], a[68:71], v[20:23]
s_add_u32 s69, s69, 0x20000
ds_read_b64_tr_b16 v[160:161], v8 offset:57344
ds_read_b64_tr_b16 v[162:163], v8 offset:59392
v_mfma_f32_16x16x32_bf16 v[20:23], v[196:199], a[64:67], v[20:23]
ds_read_b64_tr_b16 v[164:165], v9 offset:57344
ds_read_b64_tr_b16 v[166:167], v9 offset:59392
v_mfma_f32_16x16x32_bf16 v[24:27], v[200:203], a[64:67], v[24:27]
buffer_load_dwordx4 a[48:51], v1, s[44:47], s69 offen sc1
v_mfma_f32_16x16x32_bf16 v[24:27], v[216:219], a[68:71], v[24:27]
ds_read_b64_tr_b16 v[168:169], v10 offset:57344
ds_read_b64_tr_b16 v[170:171], v10 offset:59392
v_mfma_f32_16x16x32_bf16 v[24:27], v[232:235], a[72:75], v[24:27]
ds_read_b64_tr_b16 v[172:173], v11 offset:57344
ds_read_b64_tr_b16 v[174:175], v11 offset:59392
v_mfma_f32_16x16x32_bf16 v[24:27], v[248:251], a[76:79], v[24:27]
buffer_load_dwordx4 a[52:55], v1, s[44:47], s69 offen offset:1024 sc1
v_mfma_f32_16x16x32_bf16 v[40:43], v[248:251], a[92:95], v[40:43]
ds_read_b64_tr_b16 v[176:177], v8 offset:61440
v_mfma_f32_16x16x32_bf16 v[40:43], v[232:235], a[88:91], v[40:43]
ds_read_b64_tr_b16 v[178:179], v8 offset:63488
ds_read_b64_tr_b16 v[180:181], v9 offset:61440
v_mfma_f32_16x16x32_bf16 v[40:43], v[216:219], a[84:87], v[40:43]
buffer_load_dwordx4 a[56:59], v1, s[44:47], s69 offen offset:2048 sc1
v_mfma_f32_16x16x32_bf16 v[40:43], v[200:203], a[80:83], v[40:43]
ds_read_b64_tr_b16 v[182:183], v9 offset:63488
ds_read_b64_tr_b16 v[184:185], v10 offset:61440
v_mfma_f32_16x16x32_bf16 v[44:47], v[204:207], a[80:83], v[44:47]
buffer_load_dwordx4 a[60:63], v1, s[44:47], s69 offen offset:3072 sc1
v_mfma_f32_16x16x32_bf16 v[44:47], v[220:223], a[84:87], v[44:47]
s_add_u32 s71, s61, 2
ds_read_b64_tr_b16 v[186:187], v10 offset:63488
ds_read_b64_tr_b16 v[188:189], v11 offset:61440
v_mfma_f32_16x16x32_bf16 v[44:47], v[236:239], a[88:91], v[44:47]
s_and_b32 s71, s71, 3
ds_read_b64_tr_b16 v[190:191], v11 offset:63488
v_mfma_f32_16x16x32_bf16 v[44:47], v[252:255], a[92:95], v[44:47]
s_add_u32 s71, s71, s79
s_lshl_b32 s71, s71, 18
s_add_u32 s71, s71, s94
s_add_u32 m0, s77, 32768
s_add_u32 s72, s71, 0
buffer_load_dwordx4 v15, s[24:27], s72 offen lds
v_mfma_f32_16x16x32_bf16 v[28:31], v[252:255], a[76:79], v[28:31]
s_add_u32 s72, s71, 15360
v_mfma_f32_16x16x32_bf16 v[28:31], v[236:239], a[72:75], v[28:31]
v_mfma_f32_16x16x32_bf16 v[28:31], v[220:223], a[68:71], v[28:31]
s_waitcnt vmcnt(21) lgkmcnt(0)
buffer_load_dwordx4 v15, s[24:27], s72 offen offset:1024 lds
v_mfma_f32_16x16x32_bf16 v[28:31], v[204:207], a[64:67], v[28:31]
s_barrier
v_mfma_f32_16x16x32_bf16 v[16:19], v[128:131], a[96:99], v[16:19]
s_add_u32 s72, s71, 30720
ds_read_b64_tr_b16 v[192:193], v8 offset:0
ds_read_b64_tr_b16 v[194:195], v8 offset:2048
v_or_b32 v112, s58, v0
v_mov_b32 v113, 3
v_min_u32 v112, 1, v112
v_lshlrev_b32 v112, 30, v112
buffer_store_dword v113, v112, s[44:47], s91 offen sc1
v_mfma_f32_16x16x32_bf16 v[16:19], v[144:147], a[100:103], v[16:19]
buffer_load_dwordx4 v15, s[24:27], s72 offen offset:2048 lds
v_mfma_f32_16x16x32_bf16 v[16:19], v[160:163], a[104:107], v[16:19]
s_add_u32 s72, s71, 46080
ds_read_b64_tr_b16 v[196:197], v9 offset:0
ds_read_b64_tr_b16 v[198:199], v9 offset:2048
v_mfma_f32_16x16x32_bf16 v[16:19], v[176:179], a[108:111], v[16:19]
buffer_load_dwordx4 v15, s[24:27], s72 offen offset:3072 lds
v_mfma_f32_16x16x32_bf16 v[32:35], v[176:179], a[124:127], v[32:35]
s_add_u32 s82, s59, 12
ds_read_b64_tr_b16 v[200:201], v10 offset:0
ds_read_b64_tr_b16 v[202:203], v10 offset:2048
v_mfma_f32_16x16x32_bf16 v[32:35], v[160:163], a[120:123], v[32:35]
s_and_b32 s82, s82, 28
ds_read_b64_tr_b16 v[204:205], v11 offset:0
ds_read_b64_tr_b16 v[206:207], v11 offset:2048
v_mfma_f32_16x16x32_bf16 v[32:35], v[144:147], a[116:119], v[32:35]
s_lshl_b32 s82, s82, 10
s_add_u32 s82, s82, s74
buffer_load_dword v3, v2, s[44:47], s82 offen sc1
v_mfma_f32_16x16x32_bf16 v[32:35], v[128:131], a[112:115], v[32:35]
s_add_u32 s69, s61, 2
ds_read_b64_tr_b16 v[208:209], v8 offset:4096
ds_read_b64_tr_b16 v[210:211], v8 offset:6144
v_mfma_f32_16x16x32_bf16 v[36:39], v[132:135], a[112:115], v[36:39]
s_and_b32 s69, s69, 3
ds_read_b64_tr_b16 v[212:213], v9 offset:4096
ds_read_b64_tr_b16 v[214:215], v9 offset:6144
v_mfma_f32_16x16x32_bf16 v[36:39], v[148:151], a[116:119], v[36:39]
s_add_u32 s69, s69, s79
s_lshl_b32 s69, s69, 12
s_add_u32 s69, s69, s95
buffer_load_dwordx4 a[64:67], v1, s[44:47], s69 offen sc1
v_mfma_f32_16x16x32_bf16 v[36:39], v[164:167], a[120:123], v[36:39]
ds_read_b64_tr_b16 v[216:217], v10 offset:4096
ds_read_b64_tr_b16 v[218:219], v10 offset:6144
v_mfma_f32_16x16x32_bf16 v[36:39], v[180:183], a[124:127], v[36:39]
ds_read_b64_tr_b16 v[220:221], v11 offset:4096
ds_read_b64_tr_b16 v[222:223], v11 offset:6144
v_mfma_f32_16x16x32_bf16 v[20:23], v[180:183], a[108:111], v[20:23]
buffer_load_dwordx4 a[68:71], v1, s[44:47], s69 offen offset:1024 sc1
v_mfma_f32_16x16x32_bf16 v[20:23], v[164:167], a[104:107], v[20:23]
ds_read_b64_tr_b16 v[224:225], v8 offset:8192
v_mfma_f32_16x16x32_bf16 v[20:23], v[148:151], a[100:103], v[20:23]
buffer_load_dwordx4 a[72:75], v1, s[44:47], s69 offen offset:2048 sc1
v_mfma_f32_16x16x32_bf16 v[20:23], v[132:135], a[96:99], v[20:23]
ds_read_b64_tr_b16 v[226:227], v8 offset:10240
ds_read_b64_tr_b16 v[228:229], v9 offset:8192
v_mfma_f32_16x16x32_bf16 v[24:27], v[136:139], a[96:99], v[24:27]
ds_read_b64_tr_b16 v[230:231], v9 offset:10240
ds_read_b64_tr_b16 v[232:233], v10 offset:8192
v_mfma_f32_16x16x32_bf16 v[24:27], v[152:155], a[100:103], v[24:27]
buffer_load_dwordx4 a[76:79], v1, s[44:47], s69 offen offset:3072 sc1
v_mfma_f32_16x16x32_bf16 v[24:27], v[168:171], a[104:107], v[24:27]
s_add_u32 s69, s69, 0x20000
ds_read_b64_tr_b16 v[234:235], v10 offset:10240
ds_read_b64_tr_b16 v[236:237], v11 offset:8192
v_mfma_f32_16x16x32_bf16 v[24:27], v[184:187], a[108:111], v[24:27]
ds_read_b64_tr_b16 v[238:239], v11 offset:10240
ds_read_b64_tr_b16 v[240:241], v8 offset:12288
v_mfma_f32_16x16x32_bf16 v[40:43], v[184:187], a[124:127], v[40:43]
buffer_load_dwordx4 a[80:83], v1, s[44:47], s69 offen sc1
v_mfma_f32_16x16x32_bf16 v[40:43], v[168:171], a[120:123], v[40:43]
ds_read_b64_tr_b16 v[242:243], v8 offset:14336
ds_read_b64_tr_b16 v[244:245], v9 offset:12288
v_mfma_f32_16x16x32_bf16 v[40:43], v[152:155], a[116:119], v[40:43]
ds_read_b64_tr_b16 v[246:247], v9 offset:14336
ds_read_b64_tr_b16 v[248:249], v10 offset:12288
v_mfma_f32_16x16x32_bf16 v[40:43], v[136:139], a[112:115], v[40:43]
buffer_load_dwordx4 a[84:87], v1, s[44:47], s69 offen offset:1024 sc1
v_mfma_f32_16x16x32_bf16 v[44:47], v[140:143], a[112:115], v[44:47]
ds_read_b64_tr_b16 v[250:251], v10 offset:14336
ds_read_b64_tr_b16 v[252:253], v11 offset:12288
v_mfma_f32_16x16x32_bf16 v[44:47], v[156:159], a[116:119], v[44:47]
ds_read_b64_tr_b16 v[254:255], v11 offset:14336
v_mfma_f32_16x16x32_bf16 v[44:47], v[172:175], a[120:123], v[44:47]
buffer_load_dwordx4 a[88:91], v1, s[44:47], s69 offen offset:2048 sc1
v_mfma_f32_16x16x32_bf16 v[44:47], v[188:191], a[124:127], v[44:47]
v_mfma_f32_16x16x32_bf16 v[28:31], v[188:191], a[108:111], v[28:31]
buffer_load_dwordx4 a[92:95], v1, s[44:47], s69 offen offset:3072 sc1
v_mfma_f32_16x16x32_bf16 v[28:31], v[172:175], a[104:107], v[28:31]
s_add_u32 s71, s61, 3
v_mfma_f32_16x16x32_bf16 v[28:31], v[156:159], a[100:103], v[28:31]
s_waitcnt vmcnt(22) lgkmcnt(0)
v_mfma_f32_16x16x32_bf16 v[28:31], v[140:143], a[96:99], v[28:31]
s_barrier
s_and_b32 s71, s71, 3
s_add_u32 s71, s71, s79
s_lshl_b32 s71, s71, 18
s_add_u32 s71, s71, s94
s_add_u32 m0, s77, 49152
s_add_u32 s72, s71, 0
buffer_load_dwordx4 v15, s[24:27], s72 offen lds
v_mfma_f32_16x16x32_bf16 v[16:19], v[192:195], a[0:3], v[16:19]
s_add_u32 s72, s71, 15360
ds_read_b64_tr_b16 v[128:129], v8 offset:16384
ds_read_b64_tr_b16 v[130:131], v8 offset:18432
v_mfma_f32_16x16x32_bf16 v[16:19], v[208:211], a[4:7], v[16:19]
ds_read_b64_tr_b16 v[132:133], v9 offset:16384
ds_read_b64_tr_b16 v[134:135], v9 offset:18432
v_mfma_f32_16x16x32_bf16 v[16:19], v[224:227], a[8:11], v[16:19]
buffer_load_dwordx4 v15, s[24:27], s72 offen offset:1024 lds
v_mfma_f32_16x16x32_bf16 v[16:19], v[240:243], a[12:15], v[16:19]
s_add_u32 s72, s71, 30720
ds_read_b64_tr_b16 v[136:137], v10 offset:16384
ds_read_b64_tr_b16 v[138:139], v10 offset:18432
v_mfma_f32_16x16x32_bf16 v[32:35], v[240:243], a[28:31], v[32:35]
ds_read_b64_tr_b16 v[140:141], v11 offset:16384
ds_read_b64_tr_b16 v[142:143], v11 offset:18432
v_mfma_f32_16x16x32_bf16 v[32:35], v[224:227], a[24:27], v[32:35]
buffer_load_dwordx4 v15, s[24:27], s72 offen offset:2048 lds
v_mfma_f32_16x16x32_bf16 v[32:35], v[208:211], a[20:23], v[32:35]
s_add_u32 s72, s71, 46080
ds_read_b64_tr_b16 v[144:145], v8 offset:20480
v_mfma_f32_16x16x32_bf16 v[32:35], v[192:195], a[16:19], v[32:35]
buffer_load_dwordx4 v15, s[24:27], s72 offen offset:3072 lds
v_mfma_f32_16x16x32_bf16 v[36:39], v[196:199], a[16:19], v[36:39]
s_add_u32 s69, s61, 3
ds_read_b64_tr_b16 v[146:147], v8 offset:22528
ds_read_b64_tr_b16 v[148:149], v9 offset:20480
v_mfma_f32_16x16x32_bf16 v[36:39], v[212:215], a[20:23], v[36:39]
s_and_b32 s69, s69, 3
ds_read_b64_tr_b16 v[150:151], v9 offset:22528
ds_read_b64_tr_b16 v[152:153], v10 offset:20480
v_mfma_f32_16x16x32_bf16 v[36:39], v[228:231], a[24:27], v[36:39]
s_add_u32 s69, s69, s79
s_lshl_b32 s69, s69, 12
s_add_u32 s69, s69, s95
buffer_load_dwordx4 a[96:99], v1, s[44:47], s69 offen sc1
v_mfma_f32_16x16x32_bf16 v[36:39], v[244:247], a[28:31], v[36:39]
ds_read_b64_tr_b16 v[154:155], v10 offset:22528
ds_read_b64_tr_b16 v[156:157], v11 offset:20480
v_mfma_f32_16x16x32_bf16 v[20:23], v[244:247], a[12:15], v[20:23]
ds_read_b64_tr_b16 v[158:159], v11 offset:22528
v_mfma_f32_16x16x32_bf16 v[20:23], v[228:231], a[8:11], v[20:23]
buffer_load_dwordx4 a[100:103], v1, s[44:47], s69 offen offset:1024 sc1
v_mfma_f32_16x16x32_bf16 v[20:23], v[212:215], a[4:7], v[20:23]
ds_read_b64_tr_b16 v[160:161], v8 offset:24576
ds_read_b64_tr_b16 v[162:163], v8 offset:26624
v_mfma_f32_16x16x32_bf16 v[20:23], v[196:199], a[0:3], v[20:23]
ds_read_b64_tr_b16 v[164:165], v9 offset:24576
ds_read_b64_tr_b16 v[166:167], v9 offset:26624
v_mfma_f32_16x16x32_bf16 v[24:27], v[200:203], a[0:3], v[24:27]
buffer_load_dwordx4 a[104:107], v1, s[44:47], s69 offen offset:2048 sc1
v_mfma_f32_16x16x32_bf16 v[24:27], v[216:219], a[4:7], v[24:27]
ds_read_b64_tr_b16 v[168:169], v10 offset:24576
ds_read_b64_tr_b16 v[170:171], v10 offset:26624
v_mfma_f32_16x16x32_bf16 v[24:27], v[232:235], a[8:11], v[24:27]
ds_read_b64_tr_b16 v[172:173], v11 offset:24576
ds_read_b64_tr_b16 v[174:175], v11 offset:26624
v_mfma_f32_16x16x32_bf16 v[24:27], v[248:251], a[12:15], v[24:27]
buffer_load_dwordx4 a[108:111], v1, s[44:47], s69 offen offset:3072 sc1
v_mfma_f32_16x16x32_bf16 v[40:43], v[248:251], a[28:31], v[40:43]
s_add_u32 s69, s69, 0x20000
ds_read_b64_tr_b16 v[176:177], v8 offset:28672
v_mfma_f32_16x16x32_bf16 v[40:43], v[232:235], a[24:27], v[40:43]
buffer_load_dwordx4 a[112:115], v1, s[44:47], s69 offen sc1
v_mfma_f32_16x16x32_bf16 v[40:43], v[216:219], a[20:23], v[40:43]
ds_read_b64_tr_b16 v[178:179], v8 offset:30720
ds_read_b64_tr_b16 v[180:181], v9 offset:28672
v_mfma_f32_16x16x32_bf16 v[40:43], v[200:203], a[16:19], v[40:43]
ds_read_b64_tr_b16 v[182:183], v9 offset:30720
ds_read_b64_tr_b16 v[184:185], v10 offset:28672
v_mfma_f32_16x16x32_bf16 v[44:47], v[204:207], a[16:19], v[44:47]
buffer_load_dwordx4 a[116:119], v1, s[44:47], s69 offen offset:1024 sc1
v_mfma_f32_16x16x32_bf16 v[44:47], v[220:223], a[20:23], v[44:47]
ds_read_b64_tr_b16 v[186:187], v10 offset:30720
ds_read_b64_tr_b16 v[188:189], v11 offset:28672
v_mfma_f32_16x16x32_bf16 v[44:47], v[236:239], a[24:27], v[44:47]
ds_read_b64_tr_b16 v[190:191], v11 offset:30720
v_mfma_f32_16x16x32_bf16 v[44:47], v[252:255], a[28:31], v[44:47]
buffer_load_dwordx4 a[120:123], v1, s[44:47], s69 offen offset:2048 sc1
v_mfma_f32_16x16x32_bf16 v[28:31], v[252:255], a[12:15], v[28:31]
v_mfma_f32_16x16x32_bf16 v[28:31], v[236:239], a[8:11], v[28:31]
v_mfma_f32_16x16x32_bf16 v[28:31], v[220:223], a[4:7], v[28:31]
s_waitcnt vmcnt(20) lgkmcnt(0)
buffer_load_dwordx4 a[124:127], v1, s[44:47], s69 offen offset:3072 sc1
v_mfma_f32_16x16x32_bf16 v[28:31], v[204:207], a[0:3], v[28:31]
s_barrier
v_mfma_f32_16x16x32_bf16 v[16:19], v[128:131], a[32:35], v[16:19]
s_add_u32 s78, s59, 12
s_and_b32 s78, s78, 28
s_add_u32 s71, s61, 0
s_and_b32 s71, s71, 3
s_add_u32 s71, s71, s78
s_lshl_b32 s71, s71, 18
s_add_u32 s71, s71, s94
s_add_u32 m0, s77, 0
s_add_u32 s72, s71, 0
buffer_load_dwordx4 v15, s[24:27], s72 offen lds
v_mfma_f32_16x16x32_bf16 v[16:19], v[144:147], a[36:39], v[16:19]
s_add_u32 s72, s71, 15360
ds_read_b64_tr_b16 v[192:193], v8 offset:32768
ds_read_b64_tr_b16 v[194:195], v8 offset:34816
v_mfma_f32_16x16x32_bf16 v[16:19], v[160:163], a[40:43], v[16:19]
ds_read_b64_tr_b16 v[196:197], v9 offset:32768
ds_read_b64_tr_b16 v[198:199], v9 offset:34816
v_mfma_f32_16x16x32_bf16 v[16:19], v[176:179], a[44:47], v[16:19]
buffer_load_dwordx4 v15, s[24:27], s72 offen offset:1024 lds
v_mfma_f32_16x16x32_bf16 v[32:35], v[176:179], a[60:63], v[32:35]
s_add_u32 s72, s71, 30720
ds_read_b64_tr_b16 v[200:201], v10 offset:32768
ds_read_b64_tr_b16 v[202:203], v10 offset:34816
v_mfma_f32_16x16x32_bf16 v[32:35], v[160:163], a[56:59], v[32:35]
ds_read_b64_tr_b16 v[204:205], v11 offset:32768
ds_read_b64_tr_b16 v[206:207], v11 offset:34816
v_mfma_f32_16x16x32_bf16 v[32:35], v[144:147], a[52:55], v[32:35]
buffer_load_dwordx4 v15, s[24:27], s72 offen offset:2048 lds
v_mfma_f32_16x16x32_bf16 v[32:35], v[128:131], a[48:51], v[32:35]
s_add_u32 s72, s71, 46080
ds_read_b64_tr_b16 v[208:209], v8 offset:36864
ds_read_b64_tr_b16 v[210:211], v8 offset:38912
v_mfma_f32_16x16x32_bf16 v[36:39], v[132:135], a[48:51], v[36:39]
ds_read_b64_tr_b16 v[212:213], v9 offset:36864
ds_read_b64_tr_b16 v[214:215], v9 offset:38912
v_mfma_f32_16x16x32_bf16 v[36:39], v[148:151], a[52:55], v[36:39]
buffer_load_dwordx4 v15, s[24:27], s72 offen offset:3072 lds
v_mfma_f32_16x16x32_bf16 v[36:39], v[164:167], a[56:59], v[36:39]
ds_read_b64_tr_b16 v[216:217], v10 offset:36864
ds_read_b64_tr_b16 v[218:219], v10 offset:38912
v_mfma_f32_16x16x32_bf16 v[36:39], v[180:183], a[60:63], v[36:39]
ds_read_b64_tr_b16 v[220:221], v11 offset:36864
ds_read_b64_tr_b16 v[222:223], v11 offset:38912
v_mfma_f32_16x16x32_bf16 v[20:23], v[180:183], a[44:47], v[20:23]
s_waitcnt vmcnt(24)
v_cmp_gt_u32 vcc, 2, v3
s_cbranch_vccnz Lspin72
Lback73:
s_add_u32 s82, s59, 16
s_and_b32 s82, s82, 28
s_lshl_b32 s82, s82, 10
s_add_u32 s82, s82, s74
buffer_load_dword v3, v2, s[44:47], s82 offen sc1
s_add_u32 s69, s61, 0
s_and_b32 s69, s69, 3
s_add_u32 s69, s69, s78
s_lshl_b32 s69, s69, 12
s_add_u32 s69, s69, s95
buffer_load_dwordx4 a[0:3], v1, s[44:47], s69 offen sc1
v_mfma_f32_16x16x32_bf16 v[20:23], v[164:167], a[40:43], v[20:23]
ds_read_b64_tr_b16 v[224:225], v8 offset:40960
v_mfma_f32_16x16x32_bf16 v[20:23], v[148:151], a[36:39], v[20:23]
buffer_load_dwordx4 a[4:7], v1, s[44:47], s69 offen offset:1024 sc1
v_mfma_f32_16x16x32_bf16 v[20:23], v[132:135], a[32:35], v[20:23]
ds_read_b64_tr_b16 v[226:227], v8 offset:43008
ds_read_b64_tr_b16 v[228:229], v9 offset:40960
v_mfma_f32_16x16x32_bf16 v[24:27], v[136:139], a[32:35], v[24:27]
ds_read_b64_tr_b16 v[230:231], v9 offset:43008
ds_read_b64_tr_b16 v[232:233], v10 offset:40960
v_mfma_f32_16x16x32_bf16 v[24:27], v[152:155], a[36:39], v[24:27]
buffer_load_dwordx4 a[8:11], v1, s[44:47], s69 offen offset:2048 sc1
v_mfma_f32_16x16x32_bf16 v[24:27], v[168:171], a[40:43], v[24:27]
ds_read_b64_tr_b16 v[234:235], v10 offset:43008
ds_read_b64_tr_b16 v[236:237], v11 offset:40960
v_mfma_f32_16x16x32_bf16 v[24:27], v[184:187], a[44:47], v[24:27]
ds_read_b64_tr_b16 v[238:239], v11 offset:43008
ds_read_b64_tr_b16 v[240:241], v8 offset:45056
v_mfma_f32_16x16x32_bf16 v[40:43], v[184:187], a[60:63], v[40:43]
buffer_load_dwordx4 a[12:15], v1, s[44:47], s69 offen offset:3072 sc1
v_mfma_f32_16x16x32_bf16 v[40:43], v[168:171], a[56:59], v[40:43]
s_add_u32 s69, s69, 0x20000
ds_read_b64_tr_b16 v[242:243], v8 offset:47104
ds_read_b64_tr_b16 v[244:245], v9 offset:45056
v_mfma_f32_16x16x32_bf16 v[40:43], v[152:155], a[52:55], v[40:43]
ds_read_b64_tr_b16 v[246:247], v9 offset:47104
ds_read_b64_tr_b16 v[248:249], v10 offset:45056
v_mfma_f32_16x16x32_bf16 v[40:43], v[136:139], a[48:51], v[40:43]
buffer_load_dwordx4 a[16:19], v1, s[44:47], s69 offen sc1
v_mfma_f32_16x16x32_bf16 v[44:47], v[140:143], a[48:51], v[44:47]
ds_read_b64_tr_b16 v[250:251], v10 offset:47104
ds_read_b64_tr_b16 v[252:253], v11 offset:45056
v_mfma_f32_16x16x32_bf16 v[44:47], v[156:159], a[52:55], v[44:47]
buffer_load_dwordx4 a[20:23], v1, s[44:47], s69 offen offset:1024 sc1
v_mfma_f32_16x16x32_bf16 v[44:47], v[172:175], a[56:59], v[44:47]
ds_read_b64_tr_b16 v[254:255], v11 offset:47104
v_mfma_f32_16x16x32_bf16 v[44:47], v[188:191], a[60:63], v[44:47]
v_mfma_f32_16x16x32_bf16 v[28:31], v[188:191], a[44:47], v[28:31]
buffer_load_dwordx4 a[24:27], v1, s[44:47], s69 offen offset:2048 sc1
v_mfma_f32_16x16x32_bf16 v[28:31], v[172:175], a[40:43], v[28:31]
v_mfma_f32_16x16x32_bf16 v[28:31], v[156:159], a[36:39], v[28:31]
s_waitcnt vmcnt(20) lgkmcnt(0)
v_mfma_f32_16x16x32_bf16 v[28:31], v[140:143], a[32:35], v[28:31]
s_barrier
buffer_load_dwordx4 a[28:31], v1, s[44:47], s69 offen offset:3072 sc1
v_mfma_f32_16x16x32_bf16 v[16:19], v[192:195], a[64:67], v[16:19]
s_add_u32 s71, s61, 1
ds_read_b64_tr_b16 v[128:129], v8 offset:49152
ds_read_b64_tr_b16 v[130:131], v8 offset:51200
v_mfma_f32_16x16x32_bf16 v[16:19], v[208:211], a[68:71], v[16:19]
s_and_b32 s71, s71, 3
ds_read_b64_tr_b16 v[132:133], v9 offset:49152
ds_read_b64_tr_b16 v[134:135], v9 offset:51200
v_mfma_f32_16x16x32_bf16 v[16:19], v[224:227], a[72:75], v[16:19]
s_add_u32 s71, s71, s78
s_lshl_b32 s71, s71, 18
s_add_u32 s71, s71, s94
s_add_u32 m0, s77, 16384
s_add_u32 s72, s71, 0
buffer_load_dwordx4 v15, s[24:27], s72 offen lds
v_mfma_f32_16x16x32_bf16 v[16:19], v[240:243], a[76:79], v[16:19]
s_add_u32 s72, s71, 15360
ds_read_b64_tr_b16 v[136:137], v10 offset:49152
ds_read_b64_tr_b16 v[138:139], v10 offset:51200
v_mfma_f32_16x16x32_bf16 v[32:35], v[240:243], a[92:95], v[32:35]
buffer_load_dwordx4 v15, s[24:27], s72 offen offset:1024 lds
v_mfma_f32_16x16x32_bf16 v[32:35], v[224:227], a[88:91], v[32:35]
s_add_u32 s72, s71, 30720
ds_read_b64_tr_b16 v[140:141], v11 offset:49152
ds_read_b64_tr_b16 v[142:143], v11 offset:51200
v_mfma_f32_16x16x32_bf16 v[32:35], v[208:211], a[84:87], v[32:35]
ds_read_b64_tr_b16 v[144:145], v8 offset:53248
v_mfma_f32_16x16x32_bf16 v[32:35], v[192:195], a[80:83], v[32:35]
buffer_load_dwordx4 v15, s[24:27], s72 offen offset:2048 lds
v_mfma_f32_16x16x32_bf16 v[36:39], v[196:199], a[80:83], v[36:39]
s_add_u32 s72, s71, 46080
ds_read_b64_tr_b16 v[146:147], v8 offset:55296
ds_read_b64_tr_b16 v[148:149], v9 offset:53248
v_mfma_f32_16x16x32_bf16 v[36:39], v[212:215], a[84:87], v[36:39]
ds_read_b64_tr_b16 v[150:151], v9 offset:55296
ds_read_b64_tr_b16 v[152:153], v10 offset:53248
v_mfma_f32_16x16x32_bf16 v[36:39], v[228:231], a[88:91], v[36:39]
buffer_load_dwordx4 v15, s[24:27], s72 offen offset:3072 lds
v_mfma_f32_16x16x32_bf16 v[36:39], v[244:247], a[92:95], v[36:39]
s_add_u32 s69, s61, 1
ds_read_b64_tr_b16 v[154:155], v10 offset:55296
ds_read_b64_tr_b16 v[156:157], v11 offset:53248
v_mfma_f32_16x16x32_bf16 v[20:23], v[244:247], a[76:79], v[20:23]
s_and_b32 s69, s69, 3
ds_read_b64_tr_b16 v[158:159], v11 offset:55296
v_mfma_f32_16x16x32_bf16 v[20:23], v[228:231], a[72:75], v[20:23]
s_add_u32 s69, s69, s78
s_lshl_b32 s69, s69, 12
s_add_u32 s69, s69, s95
buffer_load_dwordx4 a[32:35], v1, s[44:47], s69 offen sc1
v_mfma_f32_16x16x32_bf16 v[20:23], v[212:215], a[68:71], v[20:23]
ds_read_b64_tr_b16 v[160:161], v8 offset:57344
ds_read_b64_tr_b16 v[162:163], v8 offset:59392
v_mfma_f32_16x16x32_bf16 v[20:23], v[196:199], a[64:67], v[20:23]
ds_read_b64_tr_b16 v[164:165], v9 offset:57344
ds_read_b64_tr_b16 v[166:167], v9 offset:59392
v_mfma_f32_16x16x32_bf16 v[24:27], v[200:203], a[64:67], v[24:27]
buffer_load_dwordx4 a[36:39], v1, s[44:47], s69 offen offset:1024 sc1
v_mfma_f32_16x16x32_bf16 v[24:27], v[216:219], a[68:71], v[24:27]
ds_read_b64_tr_b16 v[168:169], v10 offset:57344
ds_read_b64_tr_b16 v[170:171], v10 offset:59392
v_mfma_f32_16x16x32_bf16 v[24:27], v[232:235], a[72:75], v[24:27]
buffer_load_dwordx4 a[40:43], v1, s[44:47], s69 offen offset:2048 sc1
v_mfma_f32_16x16x32_bf16 v[24:27], v[248:251], a[76:79], v[24:27]
ds_read_b64_tr_b16 v[172:173], v11 offset:57344
ds_read_b64_tr_b16 v[174:175], v11 offset:59392
v_mfma_f32_16x16x32_bf16 v[40:43], v[248:251], a[92:95], v[40:43]
ds_read_b64_tr_b16 v[176:177], v8 offset:61440
v_mfma_f32_16x16x32_bf16 v[40:43], v[232:235], a[88:91], v[40:43]
buffer_load_dwordx4 a[44:47], v1, s[44:47], s69 offen offset:3072 sc1
v_mfma_f32_16x16x32_bf16 v[40:43], v[216:219], a[84:87], v[40:43]
s_add_u32 s69, s69, 0x20000
ds_read_b64_tr_b16 v[178:179], v8 offset:63488
ds_read_b64_tr_b16 v[180:181], v9 offset:61440
v_mfma_f32_16x16x32_bf16 v[40:43], v[200:203], a[80:83], v[40:43]
ds_read_b64_tr_b16 v[182:183], v9 offset:63488
ds_read_b64_tr_b16 v[184:185], v10 offset:61440
v_mfma_f32_16x16x32_bf16 v[44:47], v[204:207], a[80:83], v[44:47]
buffer_load_dwordx4 a[48:51], v1, s[44:47], s69 offen sc1
v_mfma_f32_16x16x32_bf16 v[44:47], v[220:223], a[84:87], v[44:47]
ds_read_b64_tr_b16 v[186:187], v10 offset:63488
ds_read_b64_tr_b16 v[188:189], v11 offset:61440
v_mfma_f32_16x16x32_bf16 v[44:47], v[236:239], a[88:91], v[44:47]
ds_read_b64_tr_b16 v[190:191], v11 offset:63488
v_mfma_f32_16x16x32_bf16 v[44:47], v[252:255], a[92:95], v[44:47]
buffer_load_dwordx4 a[52:55], v1, s[44:47], s69 offen offset:1024 sc1
v_mfma_f32_16x16x32_bf16 v[28:31], v[252:255], a[76:79], v[28:31]
v_mfma_f32_16x16x32_bf16 v[28:31], v[236:239], a[72:75], v[28:31]
buffer_load_dwordx4 a[56:59], v1, s[44:47], s69 offen offset:2048 sc1
v_mfma_f32_16x16x32_bf16 v[28:31], v[220:223], a[68:71], v[28:31]
s_waitcnt vmcnt(20) lgkmcnt(0)
v_mfma_f32_16x16x32_bf16 v[28:31], v[204:207], a[64:67], v[28:31]
s_barrier
v_mfma_f32_16x16x32_bf16 v[16:19], v[128:131], a[96:99], v[16:19]
buffer_load_dwordx4 a[60:63], v1, s[44:47], s69 offen offset:3072 sc1
v_mfma_f32_16x16x32_bf16 v[16:19], v[144:147], a[100:103], v[16:19]
s_add_u32 s71, s61, 2
ds_read_b64_tr_b16 v[192:193], v8 offset:0
ds_read_b64_tr_b16 v[194:195], v8 offset:2048
v_mfma_f32_16x16x32_bf16 v[16:19], v[160:163], a[104:107], v[16:19]
s_and_b32 s71, s71, 3
ds_read_b64_tr_b16 v[196:197], v9 offset:0
ds_read_b64_tr_b16 v[198:199], v9 offset:2048
v_mfma_f32_16x16x32_bf16 v[16:19], v[176:179], a[108:111], v[16:19]
s_add_u32 s71, s71, s78
s_lshl_b32 s71, s71, 18
s_add_u32 s71, s71, s94
s_add_u32 m0, s77, 32768
s_add_u32 s72, s71, 0
buffer_load_dwordx4 v15, s[24:27], s72 offen lds
v_mfma_f32_16x16x32_bf16 v[32:35], v[176:179], a[124:127], v[32:35]
s_add_u32 s72, s71, 15360
ds_read_b64_tr_b16 v[200:201], v10 offset:0
ds_read_b64_tr_b16 v[202:203], v10 offset:2048
v_mfma_f32_16x16x32_bf16 v[32:35], v[160:163], a[120:123], v[32:35]
ds_read_b64_tr_b16 v[204:205], v11 offset:0
ds_read_b64_tr_b16 v[206:207], v11 offset:2048
v_mfma_f32_16x16x32_bf16 v[32:35], v[144:147], a[116:119], v[32:35]
buffer_load_dwordx4 v15, s[24:27], s72 offen offset:1024 lds
v_mfma_f32_16x16x32_bf16 v[32:35], v[128:131], a[112:115], v[32:35]
s_add_u32 s72, s71, 30720
ds_read_b64_tr_b16 v[208:209], v8 offset:4096
ds_read_b64_tr_b16 v[210:211], v8 offset:6144
v_mfma_f32_16x16x32_bf16 v[36:39], v[132:135], a[112:115], v[36:39]
ds_read_b64_tr_b16 v[212:213], v9 offset:4096
ds_read_b64_tr_b16 v[214:215], v9 offset:6144
v_mfma_f32_16x16x32_bf16 v[36:39], v[148:151], a[116:119], v[36:39]
buffer_load_dwordx4 v15, s[24:27], s72 offen offset:2048 lds
v_mfma_f32_16x16x32_bf16 v[36:39], v[164:167], a[120:123], v[36:39]
s_add_u32 s72, s71, 46080
ds_read_b64_tr_b16 v[216:217], v10 offset:4096
ds_read_b64_tr_b16 v[218:219], v10 offset:6144
v_mfma_f32_16x16x32_bf16 v[36:39], v[180:183], a[124:127], v[36:39]
buffer_load_dwordx4 v15, s[24:27], s72 offen offset:3072 lds
v_mfma_f32_16x16x32_bf16 v[20:23], v[180:183], a[108:111], v[20:23]
s_add_u32 s69, s61, 2
ds_read_b64_tr_b16 v[220:221], v11 offset:4096
ds_read_b64_tr_b16 v[222:223], v11 offset:6144
v_mfma_f32_16x16x32_bf16 v[20:23], v[164:167], a[104:107], v[20:23]
s_and_b32 s69, s69, 3
ds_read_b64_tr_b16 v[224:225], v8 offset:8192
v_mfma_f32_16x16x32_bf16 v[20:23], v[148:151], a[100:103], v[20:23]
s_add_u32 s69, s69, s78
s_lshl_b32 s69, s69, 12
s_add_u32 s69, s69, s95
buffer_load_dwordx4 a[64:67], v1, s[44:47], s69 offen sc1
v_mfma_f32_16x16x32_bf16 v[20:23], v[132:135], a[96:99], v[20:23]
ds_read_b64_tr_b16 v[226:227], v8 offset:10240
ds_read_b64_tr_b16 v[228:229], v9 offset:8192
v_mfma_f32_16x16x32_bf16 v[24:27], v[136:139], a[96:99], v[24:27]
ds_read_b64_tr_b16 v[230:231], v9 offset:10240
ds_read_b64_tr_b16 v[232:233], v10 offset:8192
v_mfma_f32_16x16x32_bf16 v[24:27], v[152:155], a[100:103], v[24:27]
buffer_load_dwordx4 a[68:71], v1, s[44:47], s69 offen offset:1024 sc1
v_mfma_f32_16x16x32_bf16 v[24:27], v[168:171], a[104:107], v[24:27]
ds_read_b64_tr_b16 v[234:235], v10 offset:10240
ds_read_b64_tr_b16 v[236:237], v11 offset:8192
v_mfma_f32_16x16x32_bf16 v[24:27], v[184:187], a[108:111], v[24:27]
ds_read_b64_tr_b16 v[238:239], v11 offset:10240
ds_read_b64_tr_b16 v[240:241], v8 offset:12288
v_mfma_f32_16x16x32_bf16 v[40:43], v[184:187], a[124:127], v[40:43]
buffer_load_dwordx4 a[72:75], v1, s[44:47], s69 offen offset:2048 sc1
v_mfma_f32_16x16x32_bf16 v[40:43], v[168:171], a[120:123], v[40:43]
ds_read_b64_tr_b16 v[242:243], v8 offset:14336
ds_read_b64_tr_b16 v[244:245], v9 offset:12288
v_mfma_f32_16x16x32_bf16 v[40:43], v[152:155], a[116:119], v[40:43]
buffer_load_dwordx4 a[76:79], v1, s[44:47], s69 offen offset:3072 sc1
v_mfma_f32_16x16x32_bf16 v[40:43], v[136:139], a[112:115], v[40:43]
s_add_u32 s69, s69, 0x20000
ds_read_b64_tr_b16 v[246:247], v9 offset:14336
ds_read_b64_tr_b16 v[248:249], v10 offset:12288
v_mfma_f32_16x16x32_bf16 v[44:47], v[140:143], a[112:115], v[44:47]
ds_read_b64_tr_b16 v[250:251], v10 offset:14336
ds_read_b64_tr_b16 v[252:253], v11 offset:12288
v_mfma_f32_16x16x32_bf16 v[44:47], v[156:159], a[116:119], v[44:47]
buffer_load_dwordx4 a[80:83], v1, s[44:47], s69 offen sc1
v_mfma_f32_16x16x32_bf16 v[44:47], v[172:175], a[120:123], v[44:47]
ds_read_b64_tr_b16 v[254:255], v11 offset:14336
v_mfma_f32_16x16x32_bf16 v[44:47], v[188:191], a[124:127], v[44:47]
v_mfma_f32_16x16x32_bf16 v[28:31], v[188:191], a[108:111], v[28:31]
buffer_load_dwordx4 a[84:87], v1, s[44:47], s69 offen offset:1024 sc1
v_mfma_f32_16x16x32_bf16 v[28:31], v[172:175], a[104:107], v[28:31]
v_mfma_f32_16x16x32_bf16 v[28:31], v[156:159], a[100:103], v[28:31]
s_waitcnt vmcnt(18) lgkmcnt(0)
v_mfma_f32_16x16x32_bf16 v[28:31], v[140:143], a[96:99], v[28:31]
s_barrier
buffer_load_dwordx4 a[88:91], v1, s[44:47], s69 offen offset:2048 sc1
v_mfma_f32_16x16x32_bf16 v[16:19], v[192:195], a[0:3], v[16:19]
ds_read_b64_tr_b16 v[128:129], v8 offset:16384
ds_read_b64_tr_b16 v[130:131], v8 offset:18432
v_mfma_f32_16x16x32_bf16 v[16:19], v[208:211], a[4:7], v[16:19]
ds_read_b64_tr_b16 v[132:133], v9 offset:16384
ds_read_b64_tr_b16 v[134:135], v9 offset:18432
v_mfma_f32_16x16x32_bf16 v[16:19], v[224:227], a[8:11], v[16:19]
buffer_load_dwordx4 a[92:95], v1, s[44:47], s69 offen offset:3072 sc1
v_mfma_f32_16x16x32_bf16 v[16:19], v[240:243], a[12:15], v[16:19]
s_add_u32 s71, s61, 3
ds_read_b64_tr_b16 v[136:137], v10 offset:16384
ds_read_b64_tr_b16 v[138:139], v10 offset:18432
v_mfma_f32_16x16x32_bf16 v[32:35], v[240:243], a[28:31], v[32:35]
s_and_b32 s71, s71, 3
s_add_u32 s71, s71, s78
s_lshl_b32 s71, s71, 18
s_add_u32 s71, s71, s94
s_add_u32 m0, s77, 49152
s_add_u32 s72, s71, 0
buffer_load_dwordx4 v15, s[24:27], s72 offen lds
v_mfma_f32_16x16x32_bf16 v[32:35], v[224:227], a[24:27], v[32:35]
s_add_u32 s72, s71, 15360
ds_read_b64_tr_b16 v[140:141], v11 offset:16384
ds_read_b64_tr_b16 v[142:143], v11 offset:18432
v_mfma_f32_16x16x32_bf16 v[32:35], v[208:211], a[20:23], v[32:35]
ds_read_b64_tr_b16 v[144:145], v8 offset:20480
v_mfma_f32_16x16x32_bf16 v[32:35], v[192:195], a[16:19], v[32:35]
buffer_load_dwordx4 v15, s[24:27], s72 offen offset:1024 lds
v_mfma_f32_16x16x32_bf16 v[36:39], v[196:199], a[16:19], v[36:39]
s_add_u32 s72, s71, 30720
ds_read_b64_tr_b16 v[146:147], v8 offset:22528
ds_read_b64_tr_b16 v[148:149], v9 offset:20480
v_mfma_f32_16x16x32_bf16 v[36:39], v[212:215], a[20:23], v[36:39]
ds_read_b64_tr_b16 v[150:151], v9 offset:22528
ds_read_b64_tr_b16 v[152:153], v10 offset:20480
v_mfma_f32_16x16x32_bf16 v[36:39], v[228:231], a[24:27], v[36:39]
buffer_load_dwordx4 v15, s[24:27], s72 offen offset:2048 lds
v_mfma_f32_16x16x32_bf16 v[36:39], v[244:247], a[28:31], v[36:39]
s_add_u32 s72, s71, 46080
ds_read_b64_tr_b16 v[154:155], v10 offset:22528
ds_read_b64_tr_b16 v[156:157], v11 offset:20480
v_mfma_f32_16x16x32_bf16 v[20:23], v[244:247], a[12:15], v[20:23]
ds_read_b64_tr_b16 v[158:159], v11 offset:22528
v_mfma_f32_16x16x32_bf16 v[20:23], v[228:231], a[8:11], v[20:23]
buffer_load_dwordx4 v15, s[24:27], s72 offen offset:3072 lds
v_mfma_f32_16x16x32_bf16 v[20:23], v[212:215], a[4:7], v[20:23]
s_add_u32 s69, s61, 3
ds_read_b64_tr_b16 v[160:161], v8 offset:24576
ds_read_b64_tr_b16 v[162:163], v8 offset:26624
v_mfma_f32_16x16x32_bf16 v[20:23], v[196:199], a[0:3], v[20:23]
s_and_b32 s69, s69, 3
s_add_u32 s69, s69, s78
s_lshl_b32 s69, s69, 12
s_add_u32 s69, s69, s95
buffer_load_dwordx4 a[96:99], v1, s[44:47], s69 offen sc1
v_mfma_f32_16x16x32_bf16 v[24:27], v[200:203], a[0:3], v[24:27]
ds_read_b64_tr_b16 v[164:165], v9 offset:24576
ds_read_b64_tr_b16 v[166:167], v9 offset:26624
v_mfma_f32_16x16x32_bf16 v[24:27], v[216:219], a[4:7], v[24:27]
ds_read_b64_tr_b16 v[168:169], v10 offset:24576
ds_read_b64_tr_b16 v[170:171], v10 offset:26624
v_mfma_f32_16x16x32_bf16 v[24:27], v[232:235], a[8:11], v[24:27]
buffer_load_dwordx4 a[100:103], v1, s[44:47], s69 offen offset:1024 sc1
v_mfma_f32_16x16x32_bf16 v[24:27], v[248:251], a[12:15], v[24:27]
ds_read_b64_tr_b16 v[172:173], v11 offset:24576
ds_read_b64_tr_b16 v[174:175], v11 offset:26624
v_mfma_f32_16x16x32_bf16 v[40:43], v[248:251], a[28:31], v[40:43]
ds_read_b64_tr_b16 v[176:177], v8 offset:28672
v_mfma_f32_16x16x32_bf16 v[40:43], v[232:235], a[24:27], v[40:43]
buffer_load_dwordx4 a[104:107], v1, s[44:47], s69 offen offset:2048 sc1
v_mfma_f32_16x16x32_bf16 v[40:43], v[216:219], a[20:23], v[40:43]
ds_read_b64_tr_b16 v[178:179], v8 offset:30720
ds_read_b64_tr_b16 v[180:181], v9 offset:28672
v_mfma_f32_16x16x32_bf16 v[40:43], v[200:203], a[16:19], v[40:43]
ds_read_b64_tr_b16 v[182:183], v9 offset:30720
ds_read_b64_tr_b16 v[184:185], v10 offset:28672
v_mfma_f32_16x16x32_bf16 v[44:47], v[204:207], a[16:19], v[44:47]
buffer_load_dwordx4 a[108:111], v1, s[44:47], s69 offen offset:3072 sc1
v_mfma_f32_16x16x32_bf16 v[44:47], v[220:223], a[20:23], v[44:47]
s_add_u32 s69, s69, 0x20000
ds_read_b64_tr_b16 v[186:187], v10 offset:30720
ds_read_b64_tr_b16 v[188:189], v11 offset:28672
v_mfma_f32_16x16x32_bf16 v[44:47], v[236:239], a[24:27], v[44:47]
ds_read_b64_tr_b16 v[190:191], v11 offset:30720
v_mfma_f32_16x16x32_bf16 v[44:47], v[252:255], a[28:31], v[44:47]
buffer_load_dwordx4 a[112:115], v1, s[44:47], s69 offen sc1
v_mfma_f32_16x16x32_bf16 v[28:31], v[252:255], a[12:15], v[28:31]
v_mfma_f32_16x16x32_bf16 v[28:31], v[236:239], a[8:11], v[28:31]
buffer_load_dwordx4 a[116:119], v1, s[44:47], s69 offen offset:1024 sc1
v_mfma_f32_16x16x32_bf16 v[28:31], v[220:223], a[4:7], v[28:31]
s_waitcnt vmcnt(18) lgkmcnt(0)
v_mfma_f32_16x16x32_bf16 v[28:31], v[204:207], a[0:3], v[28:31]
s_barrier
v_mfma_f32_16x16x32_bf16 v[16:19], v[128:131], a[32:35], v[16:19]
buffer_load_dwordx4 a[120:123], v1, s[44:47], s69 offen offset:2048 sc1
v_mfma_f32_16x16x32_bf16 v[16:19], v[144:147], a[36:39], v[16:19]
ds_read_b64_tr_b16 v[192:193], v8 offset:32768
ds_read_b64_tr_b16 v[194:195], v8 offset:34816
v_mfma_f32_16x16x32_bf16 v[16:19], v[160:163], a[40:43], v[16:19]
ds_read_b64_tr_b16 v[196:197], v9 offset:32768
ds_read_b64_tr_b16 v[198:199], v9 offset:34816
v_mfma_f32_16x16x32_bf16 v[16:19], v[176:179], a[44:47], v[16:19]
buffer_load_dwordx4 a[124:127], v1, s[44:47], s69 offen offset:3072 sc1
v_mfma_f32_16x16x32_bf16 v[32:35], v[176:179], a[60:63], v[32:35]
s_add_u32 s79, s59, 16
ds_read_b64_tr_b16 v[200:201], v10 offset:32768
ds_read_b64_tr_b16 v[202:203], v10 offset:34816
v_mfma_f32_16x16x32_bf16 v[32:35], v[160:163], a[56:59], v[32:35]
s_and_b32 s79, s79, 28
ds_read_b64_tr_b16 v[204:205], v11 offset:32768
ds_read_b64_tr_b16 v[206:207], v11 offset:34816
v_mfma_f32_16x16x32_bf16 v[32:35], v[144:147], a[52:55], v[32:35]
s_add_u32 s71, s61, 0
s_and_b32 s71, s71, 3
s_add_u32 s71, s71, s79
s_lshl_b32 s71, s71, 18
s_add_u32 s71, s71, s94
s_add_u32 m0, s77, 0
s_add_u32 s72, s71, 0
buffer_load_dwordx4 v15, s[24:27], s72 offen lds
v_mfma_f32_16x16x32_bf16 v[32:35], v[128:131], a[48:51], v[32:35]
s_add_u32 s72, s71, 15360
ds_read_b64_tr_b16 v[208:209], v8 offset:36864
ds_read_b64_tr_b16 v[210:211], v8 offset:38912
v_mfma_f32_16x16x32_bf16 v[36:39], v[132:135], a[48:51], v[36:39]
buffer_load_dwordx4 v15, s[24:27], s72 offen offset:1024 lds
v_mfma_f32_16x16x32_bf16 v[36:39], v[148:151], a[52:55], v[36:39]
s_add_u32 s72, s71, 30720
ds_read_b64_tr_b16 v[212:213], v9 offset:36864
ds_read_b64_tr_b16 v[214:215], v9 offset:38912
v_mfma_f32_16x16x32_bf16 v[36:39], v[164:167], a[56:59], v[36:39]
ds_read_b64_tr_b16 v[216:217], v10 offset:36864
ds_read_b64_tr_b16 v[218:219], v10 offset:38912
v_mfma_f32_16x16x32_bf16 v[36:39], v[180:183], a[60:63], v[36:39]
buffer_load_dwordx4 v15, s[24:27], s72 offen offset:2048 lds
v_mfma_f32_16x16x32_bf16 v[20:23], v[180:183], a[44:47], v[20:23]
s_add_u32 s72, s71, 46080
ds_read_b64_tr_b16 v[220:221], v11 offset:36864
ds_read_b64_tr_b16 v[222:223], v11 offset:38912
v_mfma_f32_16x16x32_bf16 v[20:23], v[164:167], a[40:43], v[20:23]
ds_read_b64_tr_b16 v[224:225], v8 offset:40960
v_mfma_f32_16x16x32_bf16 v[20:23], v[148:151], a[36:39], v[20:23]
buffer_load_dwordx4 v15, s[24:27], s72 offen offset:3072 lds
v_mfma_f32_16x16x32_bf16 v[20:23], v[132:135], a[32:35], v[20:23]
ds_read_b64_tr_b16 v[226:227], v8 offset:43008
ds_read_b64_tr_b16 v[228:229], v9 offset:40960
v_mfma_f32_16x16x32_bf16 v[24:27], v[136:139], a[32:35], v[24:27]
ds_read_b64_tr_b16 v[230:231], v9 offset:43008
ds_read_b64_tr_b16 v[232:233], v10 offset:40960
v_mfma_f32_16x16x32_bf16 v[24:27], v[152:155], a[36:39], v[24:27]
s_waitcnt vmcnt(48)
v_cmp_gt_u32 vcc, 2, v3
s_cbranch_vccnz Lspin75
Lback76:
s_add_u32 s82, s59, 20
s_and_b32 s82, s82, 28
s_lshl_b32 s82, s82, 10
s_add_u32 s82, s82, s74
buffer_load_dword v3, v2, s[44:47], s82 offen sc1
s_add_u32 s69, s61, 0
s_and_b32 s69, s69, 3
s_add_u32 s69, s69, s79
s_lshl_b32 s69, s69, 12
s_add_u32 s69, s69, s95
buffer_load_dwordx4 a[0:3], v1, s[44:47], s69 offen sc1
v_mfma_f32_16x16x32_bf16 v[24:27], v[168:171], a[40:43], v[24:27]
ds_read_b64_tr_b16 v[234:235], v10 offset:43008
ds_read_b64_tr_b16 v[236:237], v11 offset:40960
v_mfma_f32_16x16x32_bf16 v[24:27], v[184:187], a[44:47], v[24:27]
buffer_load_dwordx4 a[4:7], v1, s[44:47], s69 offen offset:1024 sc1
v_mfma_f32_16x16x32_bf16 v[40:43], v[184:187], a[60:63], v[40:43]
ds_read_b64_tr_b16 v[238:239], v11 offset:43008
ds_read_b64_tr_b16 v[240:241], v8 offset:45056
v_mfma_f32_16x16x32_bf16 v[40:43], v[168:171], a[56:59], v[40:43]
ds_read_b64_tr_b16 v[242:243], v8 offset:47104
ds_read_b64_tr_b16 v[244:245], v9 offset:45056
v_mfma_f32_16x16x32_bf16 v[40:43], v[152:155], a[52:55], v[40:43]
buffer_load_dwordx4 a[8:11], v1, s[44:47], s69 offen offset:2048 sc1
v_mfma_f32_16x16x32_bf16 v[40:43], v[136:139], a[48:51], v[40:43]
ds_read_b64_tr_b16 v[246:247], v9 offset:47104
ds_read_b64_tr_b16 v[248:249], v10 offset:45056
v_mfma_f32_16x16x32_bf16 v[44:47], v[140:143], a[48:51], v[44:47]
ds_read_b64_tr_b16 v[250:251], v10 offset:47104
ds_read_b64_tr_b16 v[252:253], v11 offset:45056
v_mfma_f32_16x16x32_bf16 v[44:47], v[156:159], a[52:55], v[44:47]
buffer_load_dwordx4 a[12:15], v1, s[44:47], s69 offen offset:3072 sc1
v_mfma_f32_16x16x32_bf16 v[44:47], v[172:175], a[56:59], v[44:47]
s_add_u32 s69, s69, 0x20000
ds_read_b64_tr_b16 v[254:255], v11 offset:47104
v_mfma_f32_16x16x32_bf16 v[44:47], v[188:191], a[60:63], v[44:47]
v_mfma_f32_16x16x32_bf16 v[28:31], v[188:191], a[44:47], v[28:31]
buffer_load_dwordx4 a[16:19], v1, s[44:47], s69 offen sc1
v_mfma_f32_16x16x32_bf16 v[28:31], v[172:175], a[40:43], v[28:31]
v_mfma_f32_16x16x32_bf16 v[28:31], v[156:159], a[36:39], v[28:31]
s_waitcnt vmcnt(18) lgkmcnt(0)
v_mfma_f32_16x16x32_bf16 v[28:31], v[140:143], a[32:35], v[28:31]
s_barrier
buffer_load_dwordx4 a[20:23], v1, s[44:47], s69 offen offset:1024 sc1
v_mfma_f32_16x16x32_bf16 v[16:19], v[192:195], a[64:67], v[16:19]
ds_read_b64_tr_b16 v[128:129], v8 offset:49152
ds_read_b64_tr_b16 v[130:131], v8 offset:51200
v_mfma_f32_16x16x32_bf16 v[16:19], v[208:211], a[68:71], v[16:19]
buffer_load_dwordx4 a[24:27], v1, s[44:47], s69 offen offset:2048 sc1
v_mfma_f32_16x16x32_bf16 v[16:19], v[224:227], a[72:75], v[16:19]
ds_read_b64_tr_b16 v[132:133], v9 offset:49152
ds_read_b64_tr_b16 v[134:135], v9 offset:51200
v_mfma_f32_16x16x32_bf16 v[16:19], v[240:243], a[76:79], v[16:19]
ds_read_b64_tr_b16 v[136:137], v10 offset:49152
ds_read_b64_tr_b16 v[138:139], v10 offset:51200
v_mfma_f32_16x16x32_bf16 v[32:35], v[240:243], a[92:95], v[32:35]
buffer_load_dwordx4 a[28:31], v1, s[44:47], s69 offen offset:3072 sc1
v_mfma_f32_16x16x32_bf16 v[32:35], v[224:227], a[88:91], v[32:35]
s_add_u32 s71, s61, 1
ds_read_b64_tr_b16 v[140:141], v11 offset:49152
ds_read_b64_tr_b16 v[142:143], v11 offset:51200
v_mfma_f32_16x16x32_bf16 v[32:35], v[208:211], a[84:87], v[32:35]
s_and_b32 s71, s71, 3
ds_read_b64_tr_b16 v[144:145], v8 offset:53248
ds_read_b64_tr_b16 v[146:147], v8 offset:55296
v_mfma_f32_16x16x32_bf16 v[32:35], v[192:195], a[80:83], v[32:35]
s_add_u32 s71, s71, s79
s_lshl_b32 s71, s71, 18
s_add_u32 s71, s71, s94
s_add_u32 m0, s77, 16384
s_add_u32 s72, s71, 0
buffer_load_dwordx4 v15, s[24:27], s72 offen lds
v_mfma_f32_16x16x32_bf16 v[36:39], v[196:199], a[80:83], v[36:39]
s_add_u32 s72, s71, 15360
ds_read_b64_tr_b16 v[148:149], v9 offset:53248
ds_read_b64_tr_b16 v[150:151], v9 offset:55296
v_mfma_f32_16x16x32_bf16 v[36:39], v[212:215], a[84:87], v[36:39]
ds_read_b64_tr_b16 v[152:153], v10 offset:53248
ds_read_b64_tr_b16 v[154:155], v10 offset:55296
v_mfma_f32_16x16x32_bf16 v[36:39], v[228:231], a[88:91], v[36:39]
buffer_load_dwordx4 v15, s[24:27], s72 offen offset:1024 lds
v_mfma_f32_16x16x32_bf16 v[36:39], v[244:247], a[92:95], v[36:39]
s_add_u32 s72, s71, 30720
ds_read_b64_tr_b16 v[156:157], v11 offset:53248
ds_read_b64_tr_b16 v[158:159], v11 offset:55296
v_mfma_f32_16x16x32_bf16 v[20:23], v[244:247], a[76:79], v[20:23]
buffer_load_dwordx4 v15, s[24:27], s72 offen offset:2048 lds
v_mfma_f32_16x16x32_bf16 v[20:23], v[228:231], a[72:75], v[20:23]
s_add_u32 s72, s71, 46080
ds_read_b64_tr_b16 v[160:161], v8 offset:57344
v_mfma_f32_16x16x32_bf16 v[20:23], v[212:215], a[68:71], v[20:23]
ds_read_b64_tr_b16 v[162:163], v8 offset:59392
ds_read_b64_tr_b16 v[164:165], v9 offset:57344
v_mfma_f32_16x16x32_bf16 v[20:23], v[196:199], a[64:67], v[20:23]
buffer_load_dwordx4 v15, s[24:27], s72 offen offset:3072 lds
v_mfma_f32_16x16x32_bf16 v[24:27], v[200:203], a[64:67], v[24:27]
s_add_u32 s69, s61, 1
ds_read_b64_tr_b16 v[166:167], v9 offset:59392
ds_read_b64_tr_b16 v[168:169], v10 offset:57344
v_mfma_f32_16x16x32_bf16 v[24:27], v[216:219], a[68:71], v[24:27]
s_and_b32 s69, s69, 3
ds_read_b64_tr_b16 v[170:171], v10 offset:59392
ds_read_b64_tr_b16 v[172:173], v11 offset:57344
v_mfma_f32_16x16x32_bf16 v[24:27], v[232:235], a[72:75], v[24:27]
s_add_u32 s69, s69, s79
s_lshl_b32 s69, s69, 12
s_add_u32 s69, s69, s95
buffer_load_dwordx4 a[32:35], v1, s[44:47], s69 offen sc1
v_mfma_f32_16x16x32_bf16 v[24:27], v[248:251], a[76:79], v[24:27]
ds_read_b64_tr_b16 v[174:175], v11 offset:59392
ds_read_b64_tr_b16 v[176:177], v8 offset:61440
v_mfma_f32_16x16x32_bf16 v[40:43], v[248:251], a[92:95], v[40:43]
ds_read_b64_tr_b16 v[178:179], v8 offset:63488
ds_read_b64_tr_b16 v[180:181], v9 offset:61440
v_mfma_f32_16x16x32_bf16 v[40:43], v[232:235], a[88:91], v[40:43]
buffer_load_dwordx4 a[36:39], v1, s[44:47], s69 offen offset:1024 sc1
v_mfma_f32_16x16x32_bf16 v[40:43], v[216:219], a[84:87], v[40:43]
ds_read_b64_tr_b16 v[182:183], v9 offset:63488
ds_read_b64_tr_b16 v[184:185], v10 offset:61440
v_mfma_f32_16x16x32_bf16 v[40:43], v[200:203], a[80:83], v[40:43]
ds_read_b64_tr_b16 v[186:187], v10 offset:63488
ds_read_b64_tr_b16 v[188:189], v11 offset:61440
v_mfma_f32_16x16x32_bf16 v[44:47], v[204:207], a[80:83], v[44:47]
buffer_load_dwordx4 a[40:43], v1, s[44:47], s69 offen offset:2048 sc1
v_mfma_f32_16x16x32_bf16 v[44:47], v[220:223], a[84:87], v[44:47]
ds_read_b64_tr_b16 v[190:191], v11 offset:63488
v_mfma_f32_16x16x32_bf16 v[44:47], v[236:239], a[88:91], v[44:47]
buffer_load_dwordx4 a[44:47], v1, s[44:47], s69 offen offset:3072 sc1
v_mfma_f32_16x16x32_bf16 v[44:47], v[252:255], a[92:95], v[44:47]
s_add_u32 s69, s69, 0x20000
v_mfma_f32_16x16x32_bf16 v[28:31], v[252:255], a[76:79], v[28:31]
v_mfma_f32_16x16x32_bf16 v[28:31], v[236:239], a[72:75], v[28:31]
buffer_load_dwordx4 a[48:51], v1, s[44:47], s69 offen sc1
v_mfma_f32_16x16x32_bf16 v[28:31], v[220:223], a[68:71], v[28:31]
s_waitcnt vmcnt(18) lgkmcnt(0)
v_mfma_f32_16x16x32_bf16 v[28:31], v[204:207], a[64:67], v[28:31]
s_barrier
v_mfma_f32_16x16x32_bf16 v[16:19], v[128:131], a[96:99], v[16:19]
buffer_load_dwordx4 a[52:55], v1, s[44:47], s69 offen offset:1024 sc1
v_mfma_f32_16x16x32_bf16 v[16:19], v[144:147], a[100:103], v[16:19]
ds_read_b64_tr_b16 v[192:193], v8 offset:0
ds_read_b64_tr_b16 v[194:195], v8 offset:2048
v_mfma_f32_16x16x32_bf16 v[16:19], v[160:163], a[104:107], v[16:19]
ds_read_b64_tr_b16 v[196:197], v9 offset:0
ds_read_b64_tr_b16 v[198:199], v9 offset:2048
v_mfma_f32_16x16x32_bf16 v[16:19], v[176:179], a[108:111], v[16:19]
buffer_load_dwordx4 a[56:59], v1, s[44:47], s69 offen offset:2048 sc1
v_mfma_f32_16x16x32_bf16 v[32:35], v[176:179], a[124:127], v[32:35]
ds_read_b64_tr_b16 v[200:201], v10 offset:0
ds_read_b64_tr_b16 v[202:203], v10 offset:2048
v_mfma_f32_16x16x32_bf16 v[32:35], v[160:163], a[120:123], v[32:35]
buffer_load_dwordx4 a[60:63], v1, s[44:47], s69 offen offset:3072 sc1
v_mfma_f32_16x16x32_bf16 v[32:35], v[144:147], a[116:119], v[32:35]
s_add_u32 s71, s61, 2
ds_read_b64_tr_b16 v[204:205], v11 offset:0
ds_read_b64_tr_b16 v[206:207], v11 offset:2048
v_mfma_f32_16x16x32_bf16 v[32:35], v[128:131], a[112:115], v[32:35]
s_and_b32 s71, s71, 3
ds_read_b64_tr_b16 v[208:209], v8 offset:4096
ds_read_b64_tr_b16 v[210:211], v8 offset:6144
v_mfma_f32_16x16x32_bf16 v[36:39], v[132:135], a[112:115], v[36:39]
s_add_u32 s71, s71, s79
s_lshl_b32 s71, s71, 18
s_add_u32 s71, s71, s94
s_add_u32 m0, s77, 32768
s_add_u32 s72, s71, 0
buffer_load_dwordx4 v15, s[24:27], s72 offen lds
v_mfma_f32_16x16x32_bf16 v[36:39], v[148:151], a[116:119], v[36:39]
s_add_u32 s72, s71, 15360
ds_read_b64_tr_b16 v[212:213], v9 offset:4096
ds_read_b64_tr_b16 v[214:215], v9 offset:6144
v_mfma_f32_16x16x32_bf16 v[36:39], v[164:167], a[120:123], v[36:39]
ds_read_b64_tr_b16 v[216:217], v10 offset:4096
ds_read_b64_tr_b16 v[218:219], v10 offset:6144
v_mfma_f32_16x16x32_bf16 v[36:39], v[180:183], a[124:127], v[36:39]
buffer_load_dwordx4 v15, s[24:27], s72 offen offset:1024 lds
v_mfma_f32_16x16x32_bf16 v[20:23], v[180:183], a[108:111], v[20:23]
s_add_u32 s72, s71, 30720
ds_read_b64_tr_b16 v[220:221], v11 offset:4096
ds_read_b64_tr_b16 v[222:223], v11 offset:6144
v_mfma_f32_16x16x32_bf16 v[20:23], v[164:167], a[104:107], v[20:23]
ds_read_b64_tr_b16 v[224:225], v8 offset:8192
v_mfma_f32_16x16x32_bf16 v[20:23], v[148:151], a[100:103], v[20:23]
buffer_load_dwordx4 v15, s[24:27], s72 offen offset:2048 lds
v_mfma_f32_16x16x32_bf16 v[20:23], v[132:135], a[96:99], v[20:23]
s_add_u32 s72, s71, 46080
ds_read_b64_tr_b16 v[226:227], v8 offset:10240
ds_read_b64_tr_b16 v[228:229], v9 offset:8192
v_mfma_f32_16x16x32_bf16 v[24:27], v[136:139], a[96:99], v[24:27]
ds_read_b64_tr_b16 v[230:231], v9 offset:10240
ds_read_b64_tr_b16 v[232:233], v10 offset:8192
v_mfma_f32_16x16x32_bf16 v[24:27], v[152:155], a[100:103], v[24:27]
buffer_load_dwordx4 v15, s[24:27], s72 offen offset:3072 lds
v_mfma_f32_16x16x32_bf16 v[24:27], v[168:171], a[104:107], v[24:27]
s_add_u32 s69, s61, 2
ds_read_b64_tr_b16 v[234:235], v10 offset:10240
ds_read_b64_tr_b16 v[236:237], v11 offset:8192
v_mfma_f32_16x16x32_bf16 v[24:27], v[184:187], a[108:111], v[24:27]
s_and_b32 s69, s69, 3
s_add_u32 s69, s69, s79
s_lshl_b32 s69, s69, 12
s_add_u32 s69, s69, s95
buffer_load_dwordx4 a[64:67], v1, s[44:47], s69 offen sc1
v_mfma_f32_16x16x32_bf16 v[40:43], v[184:187], a[124:127], v[40:43]
ds_read_b64_tr_b16 v[238:239], v11 offset:10240
ds_read_b64_tr_b16 v[240:241], v8 offset:12288
v_mfma_f32_16x16x32_bf16 v[40:43], v[168:171], a[120:123], v[40:43]
ds_read_b64_tr_b16 v[242:243], v8 offset:14336
ds_read_b64_tr_b16 v[244:245], v9 offset:12288
v_mfma_f32_16x16x32_bf16 v[40:43], v[152:155], a[116:119], v[40:43]
buffer_load_dwordx4 a[68:71], v1, s[44:47], s69 offen offset:1024 sc1
v_mfma_f32_16x16x32_bf16 v[40:43], v[136:139], a[112:115], v[40:43]
ds_read_b64_tr_b16 v[246:247], v9 offset:14336
ds_read_b64_tr_b16 v[248:249], v10 offset:12288
v_mfma_f32_16x16x32_bf16 v[44:47], v[140:143], a[112:115], v[44:47]
ds_read_b64_tr_b16 v[250:251], v10 offset:14336
ds_read_b64_tr_b16 v[252:253], v11 offset:12288
v_mfma_f32_16x16x32_bf16 v[44:47], v[156:159], a[116:119], v[44:47]
buffer_load_dwordx4 a[72:75], v1, s[44:47], s69 offen offset:2048 sc1
v_mfma_f32_16x16x32_bf16 v[44:47], v[172:175], a[120:123], v[44:47]
ds_read_b64_tr_b16 v[254:255], v11 offset:14336
v_mfma_f32_16x16x32_bf16 v[44:47], v[188:191], a[124:127], v[44:47]
v_mfma_f32_16x16x32_bf16 v[28:31], v[188:191], a[108:111], v[28:31]
buffer_load_dwordx4 a[76:79], v1, s[44:47], s69 offen offset:3072 sc1
v_mfma_f32_16x16x32_bf16 v[28:31], v[172:175], a[104:107], v[28:31]
s_add_u32 s69, s69, 0x20000
v_mfma_f32_16x16x32_bf16 v[28:31], v[156:159], a[100:103], v[28:31]
s_waitcnt vmcnt(16) lgkmcnt(0)
buffer_load_dwordx4 a[80:83], v1, s[44:47], s69 offen sc1
v_mfma_f32_16x16x32_bf16 v[28:31], v[140:143], a[96:99], v[28:31]
s_barrier
v_mfma_f32_16x16x32_bf16 v[16:19], v[192:195], a[0:3], v[16:19]
ds_read_b64_tr_b16 v[128:129], v8 offset:16384
ds_read_b64_tr_b16 v[130:131], v8 offset:18432
v_mfma_f32_16x16x32_bf16 v[16:19], v[208:211], a[4:7], v[16:19]
buffer_load_dwordx4 a[84:87], v1, s[44:47], s69 offen offset:1024 sc1
v_mfma_f32_16x16x32_bf16 v[16:19], v[224:227], a[8:11], v[16:19]
ds_read_b64_tr_b16 v[132:133], v9 offset:16384
ds_read_b64_tr_b16 v[134:135], v9 offset:18432
v_mfma_f32_16x16x32_bf16 v[16:19], v[240:243], a[12:15], v[16:19]
ds_read_b64_tr_b16 v[136:137], v10 offset:16384
ds_read_b64_tr_b16 v[138:139], v10 offset:18432
v_mfma_f32_16x16x32_bf16 v[32:35], v[240:243], a[28:31], v[32:35]
buffer_load_dwordx4 a[88:91], v1, s[44:47], s69 offen offset:2048 sc1
v_mfma_f32_16x16x32_bf16 v[32:35], v[224:227], a[24:27], v[32:35]
ds_read_b64_tr_b16 v[140:141], v11 offset:16384
ds_read_b64_tr_b16 v[142:143], v11 offset:18432
v_mfma_f32_16x16x32_bf16 v[32:35], v[208:211], a[20:23], v[32:35]
ds_read_b64_tr_b16 v[144:145], v8 offset:20480
ds_read_b64_tr_b16 v[146:147], v8 offset:22528
v_mfma_f32_16x16x32_bf16 v[32:35], v[192:195], a[16:19], v[32:35]
buffer_load_dwordx4 a[92:95], v1, s[44:47], s69 offen offset:3072 sc1
v_mfma_f32_16x16x32_bf16 v[36:39], v[196:199], a[16:19], v[36:39]
s_add_u32 s71, s61, 3
ds_read_b64_tr_b16 v[148:149], v9 offset:20480
ds_read_b64_tr_b16 v[150:151], v9 offset:22528
v_mfma_f32_16x16x32_bf16 v[36:39], v[212:215], a[20:23], v[36:39]
s_and_b32 s71, s71, 3
s_add_u32 s71, s71, s79
s_lshl_b32 s71, s71, 18
s_add_u32 s71, s71, s94
s_add_u32 m0, s77, 49152
s_add_u32 s72, s71, 0
buffer_load_dwordx4 v15, s[24:27], s72 offen lds
v_mfma_f32_16x16x32_bf16 v[36:39], v[228:231], a[24:27], v[36:39]
s_add_u32 s72, s71, 15360
ds_read_b64_tr_b16 v[152:153], v10 offset:20480
ds_read_b64_tr_b16 v[154:155], v10 offset:22528
v_mfma_f32_16x16x32_bf16 v[36:39], v[244:247], a[28:31], v[36:39]
ds_read_b64_tr_b16 v[156:157], v11 offset:20480
ds_read_b64_tr_b16 v[158:159], v11 offset:22528
v_mfma_f32_16x16x32_bf16 v[20:23], v[244:247], a[12:15], v[20:23]
buffer_load_dwordx4 v15, s[24:27], s72 offen offset:1024 lds
v_mfma_f32_16x16x32_bf16 v[20:23], v[228:231], a[8:11], v[20:23]
s_add_u32 s72, s71, 30720
ds_read_b64_tr_b16 v[160:161], v8 offset:24576
v_mfma_f32_16x16x32_bf16 v[20:23], v[212:215], a[4:7], v[20:23]
ds_read_b64_tr_b16 v[162:163], v8 offset:26624
ds_read_b64_tr_b16 v[164:165], v9 offset:24576
v_mfma_f32_16x16x32_bf16 v[20:23], v[196:199], a[0:3], v[20:23]
buffer_load_dwordx4 v15, s[24:27], s72 offen offset:2048 lds
v_mfma_f32_16x16x32_bf16 v[24:27], v[200:203], a[0:3], v[24:27]
s_add_u32 s72, s71, 46080
ds_read_b64_tr_b16 v[166:167], v9 offset:26624
ds_read_b64_tr_b16 v[168:169], v10 offset:24576
v_mfma_f32_16x16x32_bf16 v[24:27], v[216:219], a[4:7], v[24:27]
ds_read_b64_tr_b16 v[170:171], v10 offset:26624
ds_read_b64_tr_b16 v[172:173], v11 offset:24576
v_mfma_f32_16x16x32_bf16 v[24:27], v[232:235], a[8:11], v[24:27]
buffer_load_dwordx4 v15, s[24:27], s72 offen offset:3072 lds
v_mfma_f32_16x16x32_bf16 v[24:27], v[248:251], a[12:15], v[24:27]
s_add_u32 s69, s61, 3
ds_read_b64_tr_b16 v[174:175], v11 offset:26624
ds_read_b64_tr_b16 v[176:177], v8 offset:28672
v_mfma_f32_16x16x32_bf16 v[40:43], v[248:251], a[28:31], v[40:43]
s_and_b32 s69, s69, 3
ds_read_b64_tr_b16 v[178:179], v8 offset:30720
ds_read_b64_tr_b16 v[180:181], v9 offset:28672
v_mfma_f32_16x16x32_bf16 v[40:43], v[232:235], a[24:27], v[40:43]
s_add_u32 s69, s69, s79
s_lshl_b32 s69, s69, 12
s_add_u32 s69, s69, s95
buffer_load_dwordx4 a[96:99], v1, s[44:47], s69 offen sc1
v_mfma_f32_16x16x32_bf16 v[40:43], v[216:219], a[20:23], v[40:43]
ds_read_b64_tr_b16 v[182:183], v9 offset:30720
ds_read_b64_tr_b16 v[184:185], v10 offset:28672
v_mfma_f32_16x16x32_bf16 v[40:43], v[200:203], a[16:19], v[40:43]
buffer_load_dwordx4 a[100:103], v1, s[44:47], s69 offen offset:1024 sc1
v_mfma_f32_16x16x32_bf16 v[44:47], v[204:207], a[16:19], v[44:47]
ds_read_b64_tr_b16 v[186:187], v10 offset:30720
ds_read_b64_tr_b16 v[188:189], v11 offset:28672
v_mfma_f32_16x16x32_bf16 v[44:47], v[220:223], a[20:23], v[44:47]
ds_read_b64_tr_b16 v[190:191], v11 offset:30720
v_mfma_f32_16x16x32_bf16 v[44:47], v[236:239], a[24:27], v[44:47]
buffer_load_dwordx4 a[104:107], v1, s[44:47], s69 offen offset:2048 sc1
v_mfma_f32_16x16x32_bf16 v[44:47], v[252:255], a[28:31], v[44:47]
v_mfma_f32_16x16x32_bf16 v[28:31], v[252:255], a[12:15], v[28:31]
v_mfma_f32_16x16x32_bf16 v[28:31], v[236:239], a[8:11], v[28:31]
buffer_load_dwordx4 a[108:111], v1, s[44:47], s69 offen offset:3072 sc1
v_mfma_f32_16x16x32_bf16 v[28:31], v[220:223], a[4:7], v[28:31]
s_waitcnt vmcnt(16) lgkmcnt(0)
v_mfma_f32_16x16x32_bf16 v[28:31], v[204:207], a[0:3], v[28:31]
s_barrier
v_mfma_f32_16x16x32_bf16 v[16:19], v[128:131], a[32:35], v[16:19]
s_add_u32 s69, s69, 0x20000
buffer_load_dwordx4 a[112:115], v1, s[44:47], s69 offen sc1
v_mfma_f32_16x16x32_bf16 v[16:19], v[144:147], a[36:39], v[16:19]
ds_read_b64_tr_b16 v[192:193], v8 offset:32768
ds_read_b64_tr_b16 v[194:195], v8 offset:34816
v_mfma_f32_16x16x32_bf16 v[16:19], v[160:163], a[40:43], v[16:19]
buffer_load_dwordx4 a[116:119], v1, s[44:47], s69 offen offset:1024 sc1
v_mfma_f32_16x16x32_bf16 v[16:19], v[176:179], a[44:47], v[16:19]
ds_read_b64_tr_b16 v[196:197], v9 offset:32768
ds_read_b64_tr_b16 v[198:199], v9 offset:34816
v_mfma_f32_16x16x32_bf16 v[32:35], v[176:179], a[60:63], v[32:35]
ds_read_b64_tr_b16 v[200:201], v10 offset:32768
ds_read_b64_tr_b16 v[202:203], v10 offset:34816
v_mfma_f32_16x16x32_bf16 v[32:35], v[160:163], a[56:59], v[32:35]
buffer_load_dwordx4 a[120:123], v1, s[44:47], s69 offen offset:2048 sc1
v_mfma_f32_16x16x32_bf16 v[32:35], v[144:147], a[52:55], v[32:35]
ds_read_b64_tr_b16 v[204:205], v11 offset:32768
ds_read_b64_tr_b16 v[206:207], v11 offset:34816
v_mfma_f32_16x16x32_bf16 v[32:35], v[128:131], a[48:51], v[32:35]
ds_read_b64_tr_b16 v[208:209], v8 offset:36864
ds_read_b64_tr_b16 v[210:211], v8 offset:38912
v_mfma_f32_16x16x32_bf16 v[36:39], v[132:135], a[48:51], v[36:39]
buffer_load_dwordx4 a[124:127], v1, s[44:47], s69 offen offset:3072 sc1
v_mfma_f32_16x16x32_bf16 v[36:39], v[148:151], a[52:55], v[36:39]
s_add_u32 s78, s59, 20
ds_read_b64_tr_b16 v[212:213], v9 offset:36864
ds_read_b64_tr_b16 v[214:215], v9 offset:38912
v_mfma_f32_16x16x32_bf16 v[36:39], v[164:167], a[56:59], v[36:39]
s_and_b32 s78, s78, 28
ds_read_b64_tr_b16 v[216:217], v10 offset:36864
ds_read_b64_tr_b16 v[218:219], v10 offset:38912
v_mfma_f32_16x16x32_bf16 v[36:39], v[180:183], a[60:63], v[36:39]
s_add_u32 s71, s61, 0
s_and_b32 s71, s71, 3
s_add_u32 s71, s71, s78
s_lshl_b32 s71, s71, 18
s_add_u32 s71, s71, s94
s_add_u32 m0, s77, 0
s_add_u32 s72, s71, 0
buffer_load_dwordx4 v15, s[24:27], s72 offen lds
v_mfma_f32_16x16x32_bf16 v[20:23], v[180:183], a[44:47], v[20:23]
s_add_u32 s72, s71, 15360
ds_read_b64_tr_b16 v[220:221], v11 offset:36864
ds_read_b64_tr_b16 v[222:223], v11 offset:38912
v_mfma_f32_16x16x32_bf16 v[20:23], v[164:167], a[40:43], v[20:23]
ds_read_b64_tr_b16 v[224:225], v8 offset:40960
v_mfma_f32_16x16x32_bf16 v[20:23], v[148:151], a[36:39], v[20:23]
buffer_load_dwordx4 v15, s[24:27], s72 offen offset:1024 lds
v_mfma_f32_16x16x32_bf16 v[20:23], v[132:135], a[32:35], v[20:23]
s_add_u32 s72, s71, 30720
ds_read_b64_tr_b16 v[226:227], v8 offset:43008
ds_read_b64_tr_b16 v[228:229], v9 offset:40960
v_mfma_f32_16x16x32_bf16 v[24:27], v[136:139], a[32:35], v[24:27]
buffer_load_dwordx4 v15, s[24:27], s72 offen offset:2048 lds
v_mfma_f32_16x16x32_bf16 v[24:27], v[152:155], a[36:39], v[24:27]
s_add_u32 s72, s71, 46080
ds_read_b64_tr_b16 v[230:231], v9 offset:43008
ds_read_b64_tr_b16 v[232:233], v10 offset:40960
v_mfma_f32_16x16x32_bf16 v[24:27], v[168:171], a[40:43], v[24:27]
ds_read_b64_tr_b16 v[234:235], v10 offset:43008
ds_read_b64_tr_b16 v[236:237], v11 offset:40960
v_mfma_f32_16x16x32_bf16 v[24:27], v[184:187], a[44:47], v[24:27]
buffer_load_dwordx4 v15, s[24:27], s72 offen offset:3072 lds
v_mfma_f32_16x16x32_bf16 v[40:43], v[184:187], a[60:63], v[40:43]
ds_read_b64_tr_b16 v[238:239], v11 offset:43008
ds_read_b64_tr_b16 v[240:241], v8 offset:45056
v_mfma_f32_16x16x32_bf16 v[40:43], v[168:171], a[56:59], v[40:43]
ds_read_b64_tr_b16 v[242:243], v8 offset:47104
ds_read_b64_tr_b16 v[244:245], v9 offset:45056
v_mfma_f32_16x16x32_bf16 v[40:43], v[152:155], a[52:55], v[40:43]
s_waitcnt vmcnt(48)
v_cmp_gt_u32 vcc, 2, v3
s_cbranch_vccnz Lspin78
Lback79:
s_add_u32 s82, s59, 24
s_and_b32 s82, s82, 28
s_lshl_b32 s82, s82, 10
s_add_u32 s82, s82, s74
buffer_load_dword v3, v2, s[44:47], s82 offen sc1
s_add_u32 s69, s61, 0
s_and_b32 s69, s69, 3
s_add_u32 s69, s69, s78
s_lshl_b32 s69, s69, 12
s_add_u32 s69, s69, s95
buffer_load_dwordx4 a[0:3], v1, s[44:47], s69 offen sc1
v_mfma_f32_16x16x32_bf16 v[40:43], v[136:139], a[48:51], v[40:43]
ds_read_b64_tr_b16 v[246:247], v9 offset:47104
ds_read_b64_tr_b16 v[248:249], v10 offset:45056
v_mfma_f32_16x16x32_bf16 v[44:47], v[140:143], a[48:51], v[44:47]
ds_read_b64_tr_b16 v[250:251], v10 offset:47104
ds_read_b64_tr_b16 v[252:253], v11 offset:45056
v_mfma_f32_16x16x32_bf16 v[44:47], v[156:159], a[52:55], v[44:47]
buffer_load_dwordx4 a[4:7], v1, s[44:47], s69 offen offset:1024 sc1
v_mfma_f32_16x16x32_bf16 v[44:47], v[172:175], a[56:59], v[44:47]
ds_read_b64_tr_b16 v[254:255], v11 offset:47104
v_mfma_f32_16x16x32_bf16 v[44:47], v[188:191], a[60:63], v[44:47]
buffer_load_dwordx4 a[8:11], v1, s[44:47], s69 offen offset:2048 sc1
v_mfma_f32_16x16x32_bf16 v[28:31], v[188:191], a[44:47], v[28:31]
v_mfma_f32_16x16x32_bf16 v[28:31], v[172:175], a[40:43], v[28:31]
v_mfma_f32_16x16x32_bf16 v[28:31], v[156:159], a[36:39], v[28:31]
s_waitcnt vmcnt(16) lgkmcnt(0)
buffer_load_dwordx4 a[12:15], v1, s[44:47], s69 offen offset:3072 sc1
v_mfma_f32_16x16x32_bf16 v[28:31], v[140:143], a[32:35], v[28:31]
s_barrier
v_mfma_f32_16x16x32_bf16 v[16:19], v[192:195], a[64:67], v[16:19]
s_add_u32 s69, s69, 0x20000
ds_read_b64_tr_b16 v[128:129], v8 offset:49152
ds_read_b64_tr_b16 v[130:131], v8 offset:51200
v_mfma_f32_16x16x32_bf16 v[16:19], v[208:211], a[68:71], v[16:19]
buffer_load_dwordx4 a[16:19], v1, s[44:47], s69 offen sc1
v_mfma_f32_16x16x32_bf16 v[16:19], v[224:227], a[72:75], v[16:19]
ds_read_b64_tr_b16 v[132:133], v9 offset:49152
ds_read_b64_tr_b16 v[134:135], v9 offset:51200
v_mfma_f32_16x16x32_bf16 v[16:19], v[240:243], a[76:79], v[16:19]
ds_read_b64_tr_b16 v[136:137], v10 offset:49152
ds_read_b64_tr_b16 v[138:139], v10 offset:51200
v_mfma_f32_16x16x32_bf16 v[32:35], v[240:243], a[92:95], v[32:35]
buffer_load_dwordx4 a[20:23], v1, s[44:47], s69 offen offset:1024 sc1
v_mfma_f32_16x16x32_bf16 v[32:35], v[224:227], a[88:91], v[32:35]
ds_read_b64_tr_b16 v[140:141], v11 offset:49152
ds_read_b64_tr_b16 v[142:143], v11 offset:51200
v_mfma_f32_16x16x32_bf16 v[32:35], v[208:211], a[84:87], v[32:35]
ds_read_b64_tr_b16 v[144:145], v8 offset:53248
ds_read_b64_tr_b16 v[146:147], v8 offset:55296
v_mfma_f32_16x16x32_bf16 v[32:35], v[192:195], a[80:83], v[32:35]
buffer_load_dwordx4 a[24:27], v1, s[44:47], s69 offen offset:2048 sc1
v_mfma_f32_16x16x32_bf16 v[36:39], v[196:199], a[80:83], v[36:39]
ds_read_b64_tr_b16 v[148:149], v9 offset:53248
ds_read_b64_tr_b16 v[150:151], v9 offset:55296
v_mfma_f32_16x16x32_bf16 v[36:39], v[212:215], a[84:87], v[36:39]
buffer_load_dwordx4 a[28:31], v1, s[44:47], s69 offen offset:3072 sc1
v_mfma_f32_16x16x32_bf16 v[36:39], v[228:231], a[88:91], v[36:39]
s_add_u32 s71, s61, 1
ds_read_b64_tr_b16 v[152:153], v10 offset:53248
ds_read_b64_tr_b16 v[154:155], v10 offset:55296
v_mfma_f32_16x16x32_bf16 v[36:39], v[244:247], a[92:95], v[36:39]
s_and_b32 s71, s71, 3
ds_read_b64_tr_b16 v[156:157], v11 offset:53248
ds_read_b64_tr_b16 v[158:159], v11 offset:55296
v_mfma_f32_16x16x32_bf16 v[20:23], v[244:247], a[76:79], v[20:23]
s_add_u32 s71, s71, s78
s_lshl_b32 s71, s71, 18
s_add_u32 s71, s71, s94
s_add_u32 m0, s77, 16384
s_add_u32 s72, s71, 0
buffer_load_dwordx4 v15, s[24:27], s72 offen lds
v_mfma_f32_16x16x32_bf16 v[20:23], v[228:231], a[72:75], v[20:23]
s_add_u32 s72, s71, 15360
ds_read_b64_tr_b16 v[160:161], v8 offset:57344
v_mfma_f32_16x16x32_bf16 v[20:23], v[212:215], a[68:71], v[20:23]
ds_read_b64_tr_b16 v[162:163], v8 offset:59392
ds_read_b64_tr_b16 v[164:165], v9 offset:57344
v_mfma_f32_16x16x32_bf16 v[20:23], v[196:199], a[64:67], v[20:23]
buffer_load_dwordx4 v15, s[24:27], s72 offen offset:1024 lds
v_mfma_f32_16x16x32_bf16 v[24:27], v[200:203], a[64:67], v[24:27]
s_add_u32 s72, s71, 30720
ds_read_b64_tr_b16 v[166:167], v9 offset:59392
ds_read_b64_tr_b16 v[168:169], v10 offset:57344
v_mfma_f32_16x16x32_bf16 v[24:27], v[216:219], a[68:71], v[24:27]
ds_read_b64_tr_b16 v[170:171], v10 offset:59392
ds_read_b64_tr_b16 v[172:173], v11 offset:57344
v_mfma_f32_16x16x32_bf16 v[24:27], v[232:235], a[72:75], v[24:27]
buffer_load_dwordx4 v15, s[24:27], s72 offen offset:2048 lds
v_mfma_f32_16x16x32_bf16 v[24:27], v[248:251], a[76:79], v[24:27]
s_add_u32 s72, s71, 46080
ds_read_b64_tr_b16 v[174:175], v11 offset:59392
ds_read_b64_tr_b16 v[176:177], v8 offset:61440
v_mfma_f32_16x16x32_bf16 v[40:43], v[248:251], a[92:95], v[40:43]
buffer_load_dwordx4 v15, s[24:27], s72 offen offset:3072 lds
v_mfma_f32_16x16x32_bf16 v[40:43], v[232:235], a[88:91], v[40:43]
s_add_u32 s69, s61, 1
ds_read_b64_tr_b16 v[178:179], v8 offset:63488
ds_read_b64_tr_b16 v[180:181], v9 offset:61440
v_mfma_f32_16x16x32_bf16 v[40:43], v[216:219], a[84:87], v[40:43]
s_and_b32 s69, s69, 3
ds_read_b64_tr_b16 v[182:183], v9 offset:63488
ds_read_b64_tr_b16 v[184:185], v10 offset:61440
v_mfma_f32_16x16x32_bf16 v[40:43], v[200:203], a[80:83], v[40:43]
s_add_u32 s69, s69, s78
s_lshl_b32 s69, s69, 12
s_add_u32 s69, s69, s95
buffer_load_dwordx4 a[32:35], v1, s[44:47], s69 offen sc1
v_mfma_f32_16x16x32_bf16 v[44:47], v[204:207], a[80:83], v[44:47]
ds_read_b64_tr_b16 v[186:187], v10 offset:63488
ds_read_b64_tr_b16 v[188:189], v11 offset:61440
v_mfma_f32_16x16x32_bf16 v[44:47], v[220:223], a[84:87], v[44:47]
ds_read_b64_tr_b16 v[190:191], v11 offset:63488
v_mfma_f32_16x16x32_bf16 v[44:47], v[236:239], a[88:91], v[44:47]
buffer_load_dwordx4 a[36:39], v1, s[44:47], s69 offen offset:1024 sc1
v_mfma_f32_16x16x32_bf16 v[44:47], v[252:255], a[92:95], v[44:47]
v_mfma_f32_16x16x32_bf16 v[28:31], v[252:255], a[76:79], v[28:31]
v_mfma_f32_16x16x32_bf16 v[28:31], v[236:239], a[72:75], v[28:31]
buffer_load_dwordx4 a[40:43], v1, s[44:47], s69 offen offset:2048 sc1
v_mfma_f32_16x16x32_bf16 v[28:31], v[220:223], a[68:71], v[28:31]
s_waitcnt vmcnt(16) lgkmcnt(0)
v_mfma_f32_16x16x32_bf16 v[28:31], v[204:207], a[64:67], v[28:31]
s_barrier
v_mfma_f32_16x16x32_bf16 v[16:19], v[128:131], a[96:99], v[16:19]
buffer_load_dwordx4 a[44:47], v1, s[44:47], s69 offen offset:3072 sc1
v_mfma_f32_16x16x32_bf16 v[16:19], v[144:147], a[100:103], v[16:19]
s_add_u32 s69, s69, 0x20000
ds_read_b64_tr_b16 v[192:193], v8 offset:0
ds_read_b64_tr_b16 v[194:195], v8 offset:2048
v_mfma_f32_16x16x32_bf16 v[16:19], v[160:163], a[104:107], v[16:19]
buffer_load_dwordx4 a[48:51], v1, s[44:47], s69 offen sc1
v_mfma_f32_16x16x32_bf16 v[16:19], v[176:179], a[108:111], v[16:19]
ds_read_b64_tr_b16 v[196:197], v9 offset:0
ds_read_b64_tr_b16 v[198:199], v9 offset:2048
v_mfma_f32_16x16x32_bf16 v[32:35], v[176:179], a[124:127], v[32:35]
ds_read_b64_tr_b16 v[200:201], v10 offset:0
ds_read_b64_tr_b16 v[202:203], v10 offset:2048
v_mfma_f32_16x16x32_bf16 v[32:35], v[160:163], a[120:123], v[32:35]
buffer_load_dwordx4 a[52:55], v1, s[44:47], s69 offen offset:1024 sc1
v_mfma_f32_16x16x32_bf16 v[32:35], v[144:147], a[116:119], v[32:35]
ds_read_b64_tr_b16 v[204:205], v11 offset:0
ds_read_b64_tr_b16 v[206:207], v11 offset:2048
v_mfma_f32_16x16x32_bf16 v[32:35], v[128:131], a[112:115], v[32:35]
ds_read_b64_tr_b16 v[208:209], v8 offset:4096
ds_read_b64_tr_b16 v[210:211], v8 offset:6144
v_mfma_f32_16x16x32_bf16 v[36:39], v[132:135], a[112:115], v[36:39]
buffer_load_dwordx4 a[56:59], v1, s[44:47], s69 offen offset:2048 sc1
v_mfma_f32_16x16x32_bf16 v[36:39], v[148:151], a[116:119], v[36:39]
ds_read_b64_tr_b16 v[212:213], v9 offset:4096
ds_read_b64_tr_b16 v[214:215], v9 offset:6144
v_mfma_f32_16x16x32_bf16 v[36:39], v[164:167], a[120:123], v[36:39]
ds_read_b64_tr_b16 v[216:217], v10 offset:4096
ds_read_b64_tr_b16 v[218:219], v10 offset:6144
v_mfma_f32_16x16x32_bf16 v[36:39], v[180:183], a[124:127], v[36:39]
buffer_load_dwordx4 a[60:63], v1, s[44:47], s69 offen offset:3072 sc1
v_mfma_f32_16x16x32_bf16 v[20:23], v[180:183], a[108:111], v[20:23]
s_add_u32 s71, s61, 2
ds_read_b64_tr_b16 v[220:221], v11 offset:4096
ds_read_b64_tr_b16 v[222:223], v11 offset:6144
v_mfma_f32_16x16x32_bf16 v[20:23], v[164:167], a[104:107], v[20:23]
s_and_b32 s71, s71, 3
s_add_u32 s71, s71, s78
s_lshl_b32 s71, s71, 18
s_add_u32 s71, s71, s94
s_add_u32 m0, s77, 32768
s_add_u32 s72, s71, 0
buffer_load_dwordx4 v15, s[24:27], s72 offen lds
v_mfma_f32_16x16x32_bf16 v[20:23], v[148:151], a[100:103], v[20:23]
s_add_u32 s72, s71, 15360
ds_read_b64_tr_b16 v[224:225], v8 offset:8192
v_mfma_f32_16x16x32_bf16 v[20:23], v[132:135], a[96:99], v[20:23]
ds_read_b64_tr_b16 v[226:227], v8 offset:10240
ds_read_b64_tr_b16 v[228:229], v9 offset:8192
v_mfma_f32_16x16x32_bf16 v[24:27], v[136:139], a[96:99], v[24:27]
buffer_load_dwordx4 v15, s[24:27], s72 offen offset:1024 lds
v_mfma_f32_16x16x32_bf16 v[24:27], v[152:155], a[100:103], v[24:27]
s_add_u32 s72, s71, 30720
ds_read_b64_tr_b16 v[230:231], v9 offset:10240
ds_read_b64_tr_b16 v[232:233], v10 offset:8192
v_mfma_f32_16x16x32_bf16 v[24:27], v[168:171], a[104:107], v[24:27]
ds_read_b64_tr_b16 v[234:235], v10 offset:10240
ds_read_b64_tr_b16 v[236:237], v11 offset:8192
v_mfma_f32_16x16x32_bf16 v[24:27], v[184:187], a[108:111], v[24:27]
buffer_load_dwordx4 v15, s[24:27], s72 offen offset:2048 lds
v_mfma_f32_16x16x32_bf16 v[40:43], v[184:187], a[124:127], v[40:43]
s_add_u32 s72, s71, 46080
ds_read_b64_tr_b16 v[238:239], v11 offset:10240
ds_read_b64_tr_b16 v[240:241], v8 offset:12288
v_mfma_f32_16x16x32_bf16 v[40:43], v[168:171], a[120:123], v[40:43]
ds_read_b64_tr_b16 v[242:243], v8 offset:14336
ds_read_b64_tr_b16 v[244:245], v9 offset:12288
v_mfma_f32_16x16x32_bf16 v[40:43], v[152:155], a[116:119], v[40:43]
buffer_load_dwordx4 v15, s[24:27], s72 offen offset:3072 lds
v_mfma_f32_16x16x32_bf16 v[40:43], v[136:139], a[112:115], v[40:43]
s_add_u32 s69, s61, 2
ds_read_b64_tr_b16 v[246:247], v9 offset:14336
ds_read_b64_tr_b16 v[248:249], v10 offset:12288
v_mfma_f32_16x16x32_bf16 v[44:47], v[140:143], a[112:115], v[44:47]
s_and_b32 s69, s69, 3
s_add_u32 s69, s69, s78
s_lshl_b32 s69, s69, 12
s_add_u32 s69, s69, s95
buffer_load_dwordx4 a[64:67], v1, s[44:47], s69 offen sc1
v_mfma_f32_16x16x32_bf16 v[44:47], v[156:159], a[116:119], v[44:47]
ds_read_b64_tr_b16 v[250:251], v10 offset:14336
ds_read_b64_tr_b16 v[252:253], v11 offset:12288
v_mfma_f32_16x16x32_bf16 v[44:47], v[172:175], a[120:123], v[44:47]
ds_read_b64_tr_b16 v[254:255], v11 offset:14336
v_mfma_f32_16x16x32_bf16 v[44:47], v[188:191], a[124:127], v[44:47]
buffer_load_dwordx4 a[68:71], v1, s[44:47], s69 offen offset:1024 sc1
v_mfma_f32_16x16x32_bf16 v[28:31], v[188:191], a[108:111], v[28:31]
v_mfma_f32_16x16x32_bf16 v[28:31], v[172:175], a[104:107], v[28:31]
v_mfma_f32_16x16x32_bf16 v[28:31], v[156:159], a[100:103], v[28:31]
s_waitcnt vmcnt(14) lgkmcnt(0)
buffer_load_dwordx4 a[72:75], v1, s[44:47], s69 offen offset:2048 sc1
v_mfma_f32_16x16x32_bf16 v[28:31], v[140:143], a[96:99], v[28:31]
s_barrier
v_mfma_f32_16x16x32_bf16 v[16:19], v[192:195], a[0:3], v[16:19]
ds_read_b64_tr_b16 v[128:129], v8 offset:16384
ds_read_b64_tr_b16 v[130:131], v8 offset:18432
v_mfma_f32_16x16x32_bf16 v[16:19], v[208:211], a[4:7], v[16:19]
buffer_load_dwordx4 a[76:79], v1, s[44:47], s69 offen offset:3072 sc1
v_mfma_f32_16x16x32_bf16 v[16:19], v[224:227], a[8:11], v[16:19]
s_add_u32 s69, s69, 0x20000
ds_read_b64_tr_b16 v[132:133], v9 offset:16384
ds_read_b64_tr_b16 v[134:135], v9 offset:18432
v_mfma_f32_16x16x32_bf16 v[16:19], v[240:243], a[12:15], v[16:19]
ds_read_b64_tr_b16 v[136:137], v10 offset:16384
ds_read_b64_tr_b16 v[138:139], v10 offset:18432
v_mfma_f32_16x16x32_bf16 v[32:35], v[240:243], a[28:31], v[32:35]
buffer_load_dwordx4 a[80:83], v1, s[44:47], s69 offen sc1
v_mfma_f32_16x16x32_bf16 v[32:35], v[224:227], a[24:27], v[32:35]
ds_read_b64_tr_b16 v[140:141], v11 offset:16384
ds_read_b64_tr_b16 v[142:143], v11 offset:18432
v_mfma_f32_16x16x32_bf16 v[32:35], v[208:211], a[20:23], v[32:35]
buffer_load_dwordx4 a[84:87], v1, s[44:47], s69 offen offset:1024 sc1
v_mfma_f32_16x16x32_bf16 v[32:35], v[192:195], a[16:19], v[32:35]
ds_read_b64_tr_b16 v[144:145], v8 offset:20480
ds_read_b64_tr_b16 v[146:147], v8 offset:22528
v_mfma_f32_16x16x32_bf16 v[36:39], v[196:199], a[16:19], v[36:39]
ds_read_b64_tr_b16 v[148:149], v9 offset:20480
ds_read_b64_tr_b16 v[150:151], v9 offset:22528
v_mfma_f32_16x16x32_bf16 v[36:39], v[212:215], a[20:23], v[36:39]
buffer_load_dwordx4 a[88:91], v1, s[44:47], s69 offen offset:2048 sc1
v_mfma_f32_16x16x32_bf16 v[36:39], v[228:231], a[24:27], v[36:39]
ds_read_b64_tr_b16 v[152:153], v10 offset:20480
ds_read_b64_tr_b16 v[154:155], v10 offset:22528
v_mfma_f32_16x16x32_bf16 v[36:39], v[244:247], a[28:31], v[36:39]
ds_read_b64_tr_b16 v[156:157], v11 offset:20480
ds_read_b64_tr_b16 v[158:159], v11 offset:22528
v_mfma_f32_16x16x32_bf16 v[20:23], v[244:247], a[12:15], v[20:23]
buffer_load_dwordx4 a[92:95], v1, s[44:47], s69 offen offset:3072 sc1
v_mfma_f32_16x16x32_bf16 v[20:23], v[228:231], a[8:11], v[20:23]
s_add_u32 s71, s61, 3
ds_read_b64_tr_b16 v[160:161], v8 offset:24576
v_mfma_f32_16x16x32_bf16 v[20:23], v[212:215], a[4:7], v[20:23]
s_and_b32 s71, s71, 3
ds_read_b64_tr_b16 v[162:163], v8 offset:26624
ds_read_b64_tr_b16 v[164:165], v9 offset:24576
v_mfma_f32_16x16x32_bf16 v[20:23], v[196:199], a[0:3], v[20:23]
s_add_u32 s71, s71, s78
s_lshl_b32 s71, s71, 18
s_add_u32 s71, s71, s94
s_add_u32 m0, s77, 49152
s_add_u32 s72, s71, 0
buffer_load_dwordx4 v15, s[24:27], s72 offen lds
v_mfma_f32_16x16x32_bf16 v[24:27], v[200:203], a[0:3], v[24:27]
s_add_u32 s72, s71, 15360
ds_read_b64_tr_b16 v[166:167], v9 offset:26624
ds_read_b64_tr_b16 v[168:169], v10 offset:24576
v_mfma_f32_16x16x32_bf16 v[24:27], v[216:219], a[4:7], v[24:27]
buffer_load_dwordx4 v15, s[24:27], s72 offen offset:1024 lds
v_mfma_f32_16x16x32_bf16 v[24:27], v[232:235], a[8:11], v[24:27]
s_add_u32 s72, s71, 30720
ds_read_b64_tr_b16 v[170:171], v10 offset:26624
ds_read_b64_tr_b16 v[172:173], v11 offset:24576
v_mfma_f32_16x16x32_bf16 v[24:27], v[248:251], a[12:15], v[24:27]
ds_read_b64_tr_b16 v[174:175], v11 offset:26624
ds_read_b64_tr_b16 v[176:177], v8 offset:28672
v_mfma_f32_16x16x32_bf16 v[40:43], v[248:251], a[28:31], v[40:43]
buffer_load_dwordx4 v15, s[24:27], s72 offen offset:2048 lds
v_mfma_f32_16x16x32_bf16 v[40:43], v[232:235], a[24:27], v[40:43]
s_add_u32 s72, s71, 46080
ds_read_b64_tr_b16 v[178:179], v8 offset:30720
ds_read_b64_tr_b16 v[180:181], v9 offset:28672
v_mfma_f32_16x16x32_bf16 v[40:43], v[216:219], a[20:23], v[40:43]
ds_read_b64_tr_b16 v[182:183], v9 offset:30720
ds_read_b64_tr_b16 v[184:185], v10 offset:28672
v_mfma_f32_16x16x32_bf16 v[40:43], v[200:203], a[16:19], v[40:43]
buffer_load_dwordx4 v15, s[24:27], s72 offen offset:3072 lds
v_mfma_f32_16x16x32_bf16 v[44:47], v[204:207], a[16:19], v[44:47]
s_add_u32 s69, s61, 3
ds_read_b64_tr_b16 v[186:187], v10 offset:30720
ds_read_b64_tr_b16 v[188:189], v11 offset:28672
v_mfma_f32_16x16x32_bf16 v[44:47], v[220:223], a[20:23], v[44:47]
s_and_b32 s69, s69, 3
ds_read_b64_tr_b16 v[190:191], v11 offset:30720
v_mfma_f32_16x16x32_bf16 v[44:47], v[236:239], a[24:27], v[44:47]
s_add_u32 s69, s69, s78
s_lshl_b32 s69, s69, 12
s_add_u32 s69, s69, s95
buffer_load_dwordx4 a[96:99], v1, s[44:47], s69 offen sc1
v_mfma_f32_16x16x32_bf16 v[44:47], v[252:255], a[28:31], v[44:47]
v_mfma_f32_16x16x32_bf16 v[28:31], v[252:255], a[12:15], v[28:31]
v_mfma_f32_16x16x32_bf16 v[28:31], v[236:239], a[8:11], v[28:31]
buffer_load_dwordx4 a[100:103], v1, s[44:47], s69 offen offset:1024 sc1
s_lshl_b32 s84, s76, 11
s_add_u32 s84, s84, 0x3810000
v_lshrrev_b32 v115, 2, v0
v_lshlrev_b32 v115, 7, v115
buffer_load_dword v114, v115, s[44:47], s84 offen sc1
v_mfma_f32_16x16x32_bf16 v[28:31], v[220:223], a[4:7], v[28:31]
s_waitcnt vmcnt(15) lgkmcnt(0)
v_mfma_f32_16x16x32_bf16 v[28:31], v[204:207], a[0:3], v[28:31]
s_barrier
buffer_load_dwordx4 a[104:107], v1, s[44:47], s69 offen offset:2048 sc1
v_mfma_f32_16x16x32_bf16 v[16:19], v[128:131], a[32:35], v[16:19]
ds_read_b64_tr_b16 v[192:193], v8 offset:32768
ds_read_b64_tr_b16 v[194:195], v8 offset:34816
v_mfma_f32_16x16x32_bf16 v[16:19], v[144:147], a[36:39], v[16:19]
ds_read_b64_tr_b16 v[196:197], v9 offset:32768
ds_read_b64_tr_b16 v[198:199], v9 offset:34816
v_mfma_f32_16x16x32_bf16 v[16:19], v[160:163], a[40:43], v[16:19]
buffer_load_dwordx4 a[108:111], v1, s[44:47], s69 offen offset:3072 sc1
v_mfma_f32_16x16x32_bf16 v[16:19], v[176:179], a[44:47], v[16:19]
s_add_u32 s69, s69, 0x20000
ds_read_b64_tr_b16 v[200:201], v10 offset:32768
ds_read_b64_tr_b16 v[202:203], v10 offset:34816
v_mfma_f32_16x16x32_bf16 v[32:35], v[176:179], a[60:63], v[32:35]
ds_read_b64_tr_b16 v[204:205], v11 offset:32768
ds_read_b64_tr_b16 v[206:207], v11 offset:34816
v_mfma_f32_16x16x32_bf16 v[32:35], v[160:163], a[56:59], v[32:35]
buffer_load_dwordx4 a[112:115], v1, s[44:47], s69 offen sc1
v_mfma_f32_16x16x32_bf16 v[32:35], v[144:147], a[52:55], v[32:35]
ds_read_b64_tr_b16 v[208:209], v8 offset:36864
v_mfma_f32_16x16x32_bf16 v[32:35], v[128:131], a[48:51], v[32:35]
ds_read_b64_tr_b16 v[210:211], v8 offset:38912
ds_read_b64_tr_b16 v[212:213], v9 offset:36864
v_mfma_f32_16x16x32_bf16 v[36:39], v[132:135], a[48:51], v[36:39]
buffer_load_dwordx4 a[116:119], v1, s[44:47], s69 offen offset:1024 sc1
v_mfma_f32_16x16x32_bf16 v[36:39], v[148:151], a[52:55], v[36:39]
ds_read_b64_tr_b16 v[214:215], v9 offset:38912
ds_read_b64_tr_b16 v[216:217], v10 offset:36864
v_mfma_f32_16x16x32_bf16 v[36:39], v[164:167], a[56:59], v[36:39]
buffer_load_dwordx4 a[120:123], v1, s[44:47], s69 offen offset:2048 sc1
v_mfma_f32_16x16x32_bf16 v[36:39], v[180:183], a[60:63], v[36:39]
ds_read_b64_tr_b16 v[218:219], v10 offset:38912
ds_read_b64_tr_b16 v[220:221], v11 offset:36864
v_mfma_f32_16x16x32_bf16 v[20:23], v[180:183], a[44:47], v[20:23]
ds_read_b64_tr_b16 v[222:223], v11 offset:38912
v_mfma_f32_16x16x32_bf16 v[20:23], v[164:167], a[40:43], v[20:23]
buffer_load_dwordx4 a[124:127], v1, s[44:47], s69 offen offset:3072 sc1
v_mfma_f32_16x16x32_bf16 v[20:23], v[148:151], a[36:39], v[20:23]
s_add_u32 s79, s59, 24
ds_read_b64_tr_b16 v[224:225], v8 offset:40960
ds_read_b64_tr_b16 v[226:227], v8 offset:43008
v_mfma_f32_16x16x32_bf16 v[20:23], v[132:135], a[32:35], v[20:23]
s_and_b32 s79, s79, 28
ds_read_b64_tr_b16 v[228:229], v9 offset:40960
ds_read_b64_tr_b16 v[230:231], v9 offset:43008
v_mfma_f32_16x16x32_bf16 v[24:27], v[136:139], a[32:35], v[24:27]
s_add_u32 s71, s61, 0
s_and_b32 s71, s71, 3
s_add_u32 s71, s71, s79
s_lshl_b32 s71, s71, 18
s_add_u32 s71, s71, s94
s_add_u32 m0, s77, 0
s_add_u32 s72, s71, 0
buffer_load_dwordx4 v15, s[24:27], s72 offen lds
v_mfma_f32_16x16x32_bf16 v[24:27], v[152:155], a[36:39], v[24:27]
s_add_u32 s72, s71, 15360
ds_read_b64_tr_b16 v[232:233], v10 offset:40960
ds_read_b64_tr_b16 v[234:235], v10 offset:43008
v_mfma_f32_16x16x32_bf16 v[24:27], v[168:171], a[40:43], v[24:27]
ds_read_b64_tr_b16 v[236:237], v11 offset:40960
ds_read_b64_tr_b16 v[238:239], v11 offset:43008
v_mfma_f32_16x16x32_bf16 v[24:27], v[184:187], a[44:47], v[24:27]
buffer_load_dwordx4 v15, s[24:27], s72 offen offset:1024 lds
v_mfma_f32_16x16x32_bf16 v[40:43], v[184:187], a[60:63], v[40:43]
s_add_u32 s72, s71, 30720
ds_read_b64_tr_b16 v[240:241], v8 offset:45056
v_mfma_f32_16x16x32_bf16 v[40:43], v[168:171], a[56:59], v[40:43]
ds_read_b64_tr_b16 v[242:243], v8 offset:47104
ds_read_b64_tr_b16 v[244:245], v9 offset:45056
v_mfma_f32_16x16x32_bf16 v[40:43], v[152:155], a[52:55], v[40:43]
buffer_load_dwordx4 v15, s[24:27], s72 offen offset:2048 lds
v_mfma_f32_16x16x32_bf16 v[40:43], v[136:139], a[48:51], v[40:43]
s_add_u32 s72, s71, 46080
ds_read_b64_tr_b16 v[246:247], v9 offset:47104
ds_read_b64_tr_b16 v[248:249], v10 offset:45056
v_mfma_f32_16x16x32_bf16 v[44:47], v[140:143], a[48:51], v[44:47]
buffer_load_dwordx4 v15, s[24:27], s72 offen offset:3072 lds
v_mfma_f32_16x16x32_bf16 v[44:47], v[156:159], a[52:55], v[44:47]
ds_read_b64_tr_b16 v[250:251], v10 offset:47104
ds_read_b64_tr_b16 v[252:253], v11 offset:45056
v_mfma_f32_16x16x32_bf16 v[44:47], v[172:175], a[56:59], v[44:47]
ds_read_b64_tr_b16 v[254:255], v11 offset:47104
v_mfma_f32_16x16x32_bf16 v[44:47], v[188:191], a[60:63], v[44:47]
s_waitcnt vmcnt(49)
v_cmp_gt_u32 vcc, 2, v3
s_cbranch_vccnz Lspin81
Lback82:
s_add_u32 s82, s59, 28
s_and_b32 s82, s82, 28
s_lshl_b32 s82, s82, 10
s_add_u32 s82, s82, s74
buffer_load_dword v3, v2, s[44:47], s82 offen sc1
s_add_u32 s69, s61, 0
s_and_b32 s69, s69, 3
s_add_u32 s69, s69, s79
s_lshl_b32 s69, s69, 12
s_add_u32 s69, s69, s95
buffer_load_dwordx4 a[0:3], v1, s[44:47], s69 offen sc1
v_mfma_f32_16x16x32_bf16 v[28:31], v[188:191], a[44:47], v[28:31]
v_mfma_f32_16x16x32_bf16 v[28:31], v[172:175], a[40:43], v[28:31]
v_mfma_f32_16x16x32_bf16 v[28:31], v[156:159], a[36:39], v[28:31]
s_waitcnt vmcnt(15) lgkmcnt(0)
buffer_load_dwordx4 a[4:7], v1, s[44:47], s69 offen offset:1024 sc1
v_mfma_f32_16x16x32_bf16 v[28:31], v[140:143], a[32:35], v[28:31]
s_barrier
v_mfma_f32_16x16x32_bf16 v[16:19], v[192:195], a[64:67], v[16:19]
ds_read_b64_tr_b16 v[128:129], v8 offset:49152
ds_read_b64_tr_b16 v[130:131], v8 offset:51200
v_mfma_f32_16x16x32_bf16 v[16:19], v[208:211], a[68:71], v[16:19]
buffer_load_dwordx4 a[8:11], v1, s[44:47], s69 offen offset:2048 sc1
v_mfma_f32_16x16x32_bf16 v[16:19], v[224:227], a[72:75], v[16:19]
ds_read_b64_tr_b16 v[132:133], v9 offset:49152
ds_read_b64_tr_b16 v[134:135], v9 offset:51200
v_mfma_f32_16x16x32_bf16 v[16:19], v[240:243], a[76:79], v[16:19]
buffer_load_dwordx4 a[12:15], v1, s[44:47], s69 offen offset:3072 sc1
v_mfma_f32_16x16x32_bf16 v[32:35], v[240:243], a[92:95], v[32:35]
s_add_u32 s69, s69, 0x20000
ds_read_b64_tr_b16 v[136:137], v10 offset:49152
ds_read_b64_tr_b16 v[138:139], v10 offset:51200
v_mfma_f32_16x16x32_bf16 v[32:35], v[224:227], a[88:91], v[32:35]
ds_read_b64_tr_b16 v[140:141], v11 offset:49152
ds_read_b64_tr_b16 v[142:143], v11 offset:51200
v_mfma_f32_16x16x32_bf16 v[32:35], v[208:211], a[84:87], v[32:35]
buffer_load_dwordx4 a[16:19], v1, s[44:47], s69 offen sc1
v_mfma_f32_16x16x32_bf16 v[32:35], v[192:195], a[80:83], v[32:35]
ds_read_b64_tr_b16 v[144:145], v8 offset:53248
ds_read_b64_tr_b16 v[146:147], v8 offset:55296
v_mfma_f32_16x16x32_bf16 v[36:39], v[196:199], a[80:83], v[36:39]
ds_read_b64_tr_b16 v[148:149], v9 offset:53248
ds_read_b64_tr_b16 v[150:151], v9 offset:55296
v_mfma_f32_16x16x32_bf16 v[36:39], v[212:215], a[84:87], v[36:39]
buffer_load_dwordx4 a[20:23], v1, s[44:47], s69 offen offset:1024 sc1
v_mfma_f32_16x16x32_bf16 v[36:39], v[228:231], a[88:91], v[36:39]
ds_read_b64_tr_b16 v[152:153], v10 offset:53248
ds_read_b64_tr_b16 v[154:155], v10 offset:55296
v_mfma_f32_16x16x32_bf16 v[36:39], v[244:247], a[92:95], v[36:39]
ds_read_b64_tr_b16 v[156:157], v11 offset:53248
ds_read_b64_tr_b16 v[158:159], v11 offset:55296
v_mfma_f32_16x16x32_bf16 v[20:23], v[244:247], a[76:79], v[20:23]
buffer_load_dwordx4 a[24:27], v1, s[44:47], s69 offen offset:2048 sc1
v_mfma_f32_16x16x32_bf16 v[20:23], v[228:231], a[72:75], v[20:23]
ds_read_b64_tr_b16 v[160:161], v8 offset:57344
v_mfma_f32_16x16x32_bf16 v[20:23], v[212:215], a[68:71], v[20:23]
buffer_load_dwordx4 a[28:31], v1, s[44:47], s69 offen offset:3072 sc1
v_mfma_f32_16x16x32_bf16 v[20:23], v[196:199], a[64:67], v[20:23]
s_add_u32 s71, s61, 1
ds_read_b64_tr_b16 v[162:163], v8 offset:59392
ds_read_b64_tr_b16 v[164:165], v9 offset:57344
v_mfma_f32_16x16x32_bf16 v[24:27], v[200:203], a[64:67], v[24:27]
s_and_b32 s71, s71, 3
ds_read_b64_tr_b16 v[166:167], v9 offset:59392
ds_read_b64_tr_b16 v[168:169], v10 offset:57344
v_mfma_f32_16x16x32_bf16 v[24:27], v[216:219], a[68:71], v[24:27]
s_add_u32 s71, s71, s79
s_lshl_b32 s71, s71, 18
s_add_u32 s71, s71, s94
s_add_u32 m0, s77, 16384
s_add_u32 s72, s71, 0
buffer_load_dwordx4 v15, s[24:27], s72 offen lds
v_mfma_f32_16x16x32_bf16 v[24:27], v[232:235], a[72:75], v[24:27]
s_add_u32 s72, s71, 15360
ds_read_b64_tr_b16 v[170:171], v10 offset:59392
ds_read_b64_tr_b16 v[172:173], v11 offset:57344
v_mfma_f32_16x16x32_bf16 v[24:27], v[248:251], a[76:79], v[24:27]
ds_read_b64_tr_b16 v[174:175], v11 offset:59392
ds_read_b64_tr_b16 v[176:177], v8 offset:61440
v_mfma_f32_16x16x32_bf16 v[40:43], v[248:251], a[92:95], v[40:43]
buffer_load_dwordx4 v15, s[24:27], s72 offen offset:1024 lds
v_mfma_f32_16x16x32_bf16 v[40:43], v[232:235], a[88:91], v[40:43]
s_add_u32 s72, s71, 30720
ds_read_b64_tr_b16 v[178:179], v8 offset:63488
ds_read_b64_tr_b16 v[180:181], v9 offset:61440
v_mfma_f32_16x16x32_bf16 v[40:43], v[216:219], a[84:87], v[40:43]
ds_read_b64_tr_b16 v[182:183], v9 offset:63488
ds_read_b64_tr_b16 v[184:185], v10 offset:61440
v_mfma_f32_16x16x32_bf16 v[40:43], v[200:203], a[80:83], v[40:43]
buffer_load_dwordx4 v15, s[24:27], s72 offen offset:2048 lds
v_mfma_f32_16x16x32_bf16 v[44:47], v[204:207], a[80:83], v[44:47]
s_add_u32 s72, s71, 46080
ds_read_b64_tr_b16 v[186:187], v10 offset:63488
ds_read_b64_tr_b16 v[188:189], v11 offset:61440
v_mfma_f32_16x16x32_bf16 v[44:47], v[220:223], a[84:87], v[44:47]
ds_read_b64_tr_b16 v[190:191], v11 offset:63488
v_mfma_f32_16x16x32_bf16 v[44:47], v[236:239], a[88:91], v[44:47]
buffer_load_dwordx4 v15, s[24:27], s72 offen offset:3072 lds
v_mfma_f32_16x16x32_bf16 v[44:47], v[252:255], a[92:95], v[44:47]
s_add_u32 s69, s61, 1
v_mfma_f32_16x16x32_bf16 v[28:31], v[252:255], a[76:79], v[28:31]
s_and_b32 s69, s69, 3
s_add_u32 s69, s69, s79
s_lshl_b32 s69, s69, 12
s_add_u32 s69, s69, s95
buffer_load_dwordx4 a[32:35], v1, s[44:47], s69 offen sc1
v_mfma_f32_16x16x32_bf16 v[28:31], v[236:239], a[72:75], v[28:31]
v_mfma_f32_16x16x32_bf16 v[28:31], v[220:223], a[68:71], v[28:31]
s_waitcnt vmcnt(14) lgkmcnt(0)
v_mfma_f32_16x16x32_bf16 v[28:31], v[204:207], a[64:67], v[28:31]
s_barrier
buffer_load_dwordx4 a[36:39], v1, s[44:47], s69 offen offset:1024 sc1
v_mfma_f32_16x16x32_bf16 v[16:19], v[128:131], a[96:99], v[16:19]
ds_read_b64_tr_b16 v[192:193], v8 offset:0
ds_read_b64_tr_b16 v[194:195], v8 offset:2048
v_mfma_f32_16x16x32_bf16 v[16:19], v[144:147], a[100:103], v[16:19]
ds_read_b64_tr_b16 v[196:197], v9 offset:0
ds_read_b64_tr_b16 v[198:199], v9 offset:2048
v_mfma_f32_16x16x32_bf16 v[16:19], v[160:163], a[104:107], v[16:19]
buffer_load_dwordx4 a[40:43], v1, s[44:47], s69 offen offset:2048 sc1
v_mfma_f32_16x16x32_bf16 v[16:19], v[176:179], a[108:111], v[16:19]
ds_read_b64_tr_b16 v[200:201], v10 offset:0
ds_read_b64_tr_b16 v[202:203], v10 offset:2048
v_mfma_f32_16x16x32_bf16 v[32:35], v[176:179], a[124:127], v[32:35]
ds_read_b64_tr_b16 v[204:205], v11 offset:0
ds_read_b64_tr_b16 v[206:207], v11 offset:2048
v_mfma_f32_16x16x32_bf16 v[32:35], v[160:163], a[120:123], v[32:35]
buffer_load_dwordx4 a[44:47], v1, s[44:47], s69 offen offset:3072 sc1
v_mfma_f32_16x16x32_bf16 v[32:35], v[144:147], a[116:119], v[32:35]
s_add_u32 s69, s69, 0x20000
ds_read_b64_tr_b16 v[208:209], v8 offset:4096
v_mfma_f32_16x16x32_bf16 v[32:35], v[128:131], a[112:115], v[32:35]
buffer_load_dwordx4 a[48:51], v1, s[44:47], s69 offen sc1
v_mfma_f32_16x16x32_bf16 v[36:39], v[132:135], a[112:115], v[36:39]
ds_read_b64_tr_b16 v[210:211], v8 offset:6144
ds_read_b64_tr_b16 v[212:213], v9 offset:4096
v_mfma_f32_16x16x32_bf16 v[36:39], v[148:151], a[116:119], v[36:39]
ds_read_b64_tr_b16 v[214:215], v9 offset:6144
ds_read_b64_tr_b16 v[216:217], v10 offset:4096
v_mfma_f32_16x16x32_bf16 v[36:39], v[164:167], a[120:123], v[36:39]
buffer_load_dwordx4 a[52:55], v1, s[44:47], s69 offen offset:1024 sc1
v_mfma_f32_16x16x32_bf16 v[36:39], v[180:183], a[124:127], v[36:39]
ds_read_b64_tr_b16 v[218:219], v10 offset:6144
ds_read_b64_tr_b16 v[220:221], v11 offset:4096
v_mfma_f32_16x16x32_bf16 v[20:23], v[180:183], a[108:111], v[20:23]
ds_read_b64_tr_b16 v[222:223], v11 offset:6144
v_mfma_f32_16x16x32_bf16 v[20:23], v[164:167], a[104:107], v[20:23]
buffer_load_dwordx4 a[56:59], v1, s[44:47], s69 offen offset:2048 sc1
v_mfma_f32_16x16x32_bf16 v[20:23], v[148:151], a[100:103], v[20:23]
ds_read_b64_tr_b16 v[224:225], v8 offset:8192
ds_read_b64_tr_b16 v[226:227], v8 offset:10240
v_mfma_f32_16x16x32_bf16 v[20:23], v[132:135], a[96:99], v[20:23]
ds_read_b64_tr_b16 v[228:229], v9 offset:8192
ds_read_b64_tr_b16 v[230:231], v9 offset:10240
v_mfma_f32_16x16x32_bf16 v[24:27], v[136:139], a[96:99], v[24:27]
buffer_load_dwordx4 a[60:63], v1, s[44:47], s69 offen offset:3072 sc1
v_mfma_f32_16x16x32_bf16 v[24:27], v[152:155], a[100:103], v[24:27]
s_add_u32 s71, s61, 2
ds_read_b64_tr_b16 v[232:233], v10 offset:8192
ds_read_b64_tr_b16 v[234:235], v10 offset:10240
v_mfma_f32_16x16x32_bf16 v[24:27], v[168:171], a[104:107], v[24:27]
s_and_b32 s71, s71, 3
ds_read_b64_tr_b16 v[236:237], v11 offset:8192
ds_read_b64_tr_b16 v[238:239], v11 offset:10240
v_mfma_f32_16x16x32_bf16 v[24:27], v[184:187], a[108:111], v[24:27]
s_add_u32 s71, s71, s79
s_lshl_b32 s71, s71, 18
s_add_u32 s71, s71, s94
s_add_u32 m0, s77, 32768
s_add_u32 s72, s71, 0
buffer_load_dwordx4 v15, s[24:27], s72 offen lds
v_mfma_f32_16x16x32_bf16 v[40:43], v[184:187], a[124:127], v[40:43]
s_add_u32 s72, s71, 15360
ds_read_b64_tr_b16 v[240:241], v8 offset:12288
v_mfma_f32_16x16x32_bf16 v[40:43], v[168:171], a[120:123], v[40:43]
buffer_load_dwordx4 v15, s[24:27], s72 offen offset:1024 lds
v_mfma_f32_16x16x32_bf16 v[40:43], v[152:155], a[116:119], v[40:43]
s_add_u32 s72, s71, 30720
ds_read_b64_tr_b16 v[242:243], v8 offset:14336
ds_read_b64_tr_b16 v[244:245], v9 offset:12288
v_mfma_f32_16x16x32_bf16 v[40:43], v[136:139], a[112:115], v[40:43]
ds_read_b64_tr_b16 v[246:247], v9 offset:14336
ds_read_b64_tr_b16 v[248:249], v10 offset:12288
v_mfma_f32_16x16x32_bf16 v[44:47], v[140:143], a[112:115], v[44:47]
buffer_load_dwordx4 v15, s[24:27], s72 offen offset:2048 lds
v_mfma_f32_16x16x32_bf16 v[44:47], v[156:159], a[116:119], v[44:47]
s_add_u32 s72, s71, 46080
ds_read_b64_tr_b16 v[250:251], v10 offset:14336
ds_read_b64_tr_b16 v[252:253], v11 offset:12288
v_mfma_f32_16x16x32_bf16 v[44:47], v[172:175], a[120:123], v[44:47]
ds_read_b64_tr_b16 v[254:255], v11 offset:14336
v_mfma_f32_16x16x32_bf16 v[44:47], v[188:191], a[124:127], v[44:47]
buffer_load_dwordx4 v15, s[24:27], s72 offen offset:3072 lds
v_mfma_f32_16x16x32_bf16 v[28:31], v[188:191], a[108:111], v[28:31]
s_add_u32 s69, s61, 2
v_mfma_f32_16x16x32_bf16 v[28:31], v[172:175], a[104:107], v[28:31]
s_and_b32 s69, s69, 3
v_mfma_f32_16x16x32_bf16 v[28:31], v[156:159], a[100:103], v[28:31]
s_waitcnt vmcnt(12) lgkmcnt(0)
s_add_u32 s69, s69, s79
s_lshl_b32 s69, s69, 12
s_add_u32 s69, s69, s95
buffer_load_dwordx4 a[64:67], v1, s[44:47], s69 offen sc1
v_mfma_f32_16x16x32_bf16 v[28:31], v[140:143], a[96:99], v[28:31]
s_barrier
v_mfma_f32_16x16x32_bf16 v[16:19], v[192:195], a[0:3], v[16:19]
buffer_load_dwordx4 a[68:71], v1, s[44:47], s69 offen offset:1024 sc1
s_waitcnt vmcnt(37)
v_cmp_gt_u32 vcc, 3, v114
s_cbranch_vccnz Lspin90
Lback91:
s_lshl_b32 s73, s76, 18
s_lshl_b32 s84, s58, 16
s_add_u32 s73, s73, s84
s_lshl_b32 s84, s75, 8
s_add_u32 s73, s73, s84
s_add_u32 s73, s73, 0x3400000
v_lshrrev_b32 v112, 4, v0
v_and_b32 v113, 15, v0
v_lshlrev_b32 v114, 4, v113
v_lshl_add_u32 v112, v112, 12, v114
s_add_u32 m0, s64, 147456
s_add_u32 s72, s73, 0
buffer_load_dwordx4 v112, s[44:47], s72 offen sc1 lds
s_add_u32 s72, s73, 15360
buffer_load_dwordx4 v112, s[44:47], s72 offen offset:1024 sc1 lds
s_add_u32 s72, s73, 30720
buffer_load_dwordx4 v112, s[44:47], s72 offen offset:2048 sc1 lds
s_add_u32 s72, s73, 46080
buffer_load_dwordx4 v112, s[44:47], s72 offen offset:3072 sc1 lds
s_lshl_b32 s73, s75, 9
s_lshl_b32 s84, s58, 7
s_add_u32 s73, s73, s84
s_add_u32 s73, s73, 0x3800000
v_lshlrev_b32 v113, 2, v113
buffer_load_dword v6, v113, s[44:47], s73 offen sc1
buffer_load_dword v7, v113, s[44:47], s73 offen offset:64 sc1
v_mfma_f32_16x16x32_bf16 v[16:19], v[208:211], a[4:7], v[16:19]
ds_read_b64_tr_b16 v[128:129], v8 offset:16384
ds_read_b64_tr_b16 v[130:131], v8 offset:18432
v_mfma_f32_16x16x32_bf16 v[16:19], v[224:227], a[8:11], v[16:19]
ds_read_b64_tr_b16 v[132:133], v9 offset:16384
ds_read_b64_tr_b16 v[134:135], v9 offset:18432
v_mfma_f32_16x16x32_bf16 v[16:19], v[240:243], a[12:15], v[16:19]
buffer_load_dwordx4 a[72:75], v1, s[44:47], s69 offen offset:2048 sc1
v_mfma_f32_16x16x32_bf16 v[32:35], v[240:243], a[28:31], v[32:35]
ds_read_b64_tr_b16 v[136:137], v10 offset:16384
ds_read_b64_tr_b16 v[138:139], v10 offset:18432
v_mfma_f32_16x16x32_bf16 v[32:35], v[224:227], a[24:27], v[32:35]
ds_read_b64_tr_b16 v[140:141], v11 offset:16384
ds_read_b64_tr_b16 v[142:143], v11 offset:18432
v_mfma_f32_16x16x32_bf16 v[32:35], v[208:211], a[20:23], v[32:35]
buffer_load_dwordx4 a[76:79], v1, s[44:47], s69 offen offset:3072 sc1
v_mfma_f32_16x16x32_bf16 v[32:35], v[192:195], a[16:19], v[32:35]
s_add_u32 s69, s69, 0x20000
ds_read_b64_tr_b16 v[144:145], v8 offset:20480
ds_read_b64_tr_b16 v[146:147], v8 offset:22528
v_mfma_f32_16x16x32_bf16 v[36:39], v[196:199], a[16:19], v[36:39]
ds_read_b64_tr_b16 v[148:149], v9 offset:20480
ds_read_b64_tr_b16 v[150:151], v9 offset:22528
v_mfma_f32_16x16x32_bf16 v[36:39], v[212:215], a[20:23], v[36:39]
buffer_load_dwordx4 a[80:83], v1, s[44:47], s69 offen sc1
v_mfma_f32_16x16x32_bf16 v[36:39], v[228:231], a[24:27], v[36:39]
ds_read_b64_tr_b16 v[152:153], v10 offset:20480
ds_read_b64_tr_b16 v[154:155], v10 offset:22528
v_mfma_f32_16x16x32_bf16 v[36:39], v[244:247], a[28:31], v[36:39]
ds_read_b64_tr_b16 v[156:157], v11 offset:20480
ds_read_b64_tr_b16 v[158:159], v11 offset:22528
v_mfma_f32_16x16x32_bf16 v[20:23], v[244:247], a[12:15], v[20:23]
buffer_load_dwordx4 a[84:87], v1, s[44:47], s69 offen offset:1024 sc1
v_mfma_f32_16x16x32_bf16 v[20:23], v[228:231], a[8:11], v[20:23]
ds_read_b64_tr_b16 v[160:161], v8 offset:24576
v_mfma_f32_16x16x32_bf16 v[20:23], v[212:215], a[4:7], v[20:23]
buffer_load_dwordx4 a[88:91], v1, s[44:47], s69 offen offset:2048 sc1
v_mfma_f32_16x16x32_bf16 v[20:23], v[196:199], a[0:3], v[20:23]
ds_read_b64_tr_b16 v[162:163], v8 offset:26624
ds_read_b64_tr_b16 v[164:165], v9 offset:24576
v_mfma_f32_16x16x32_bf16 v[24:27], v[200:203], a[0:3], v[24:27]
ds_read_b64_tr_b16 v[166:167], v9 offset:26624
ds_read_b64_tr_b16 v[168:169], v10 offset:24576
v_mfma_f32_16x16x32_bf16 v[24:27], v[216:219], a[4:7], v[24:27]
buffer_load_dwordx4 a[92:95], v1, s[44:47], s69 offen offset:3072 sc1
v_mfma_f32_16x16x32_bf16 v[24:27], v[232:235], a[8:11], v[24:27]
s_add_u32 s71, s61, 3
ds_read_b64_tr_b16 v[170:171], v10 offset:26624
ds_read_b64_tr_b16 v[172:173], v11 offset:24576
v_mfma_f32_16x16x32_bf16 v[24:27], v[248:251], a[12:15], v[24:27]
s_and_b32 s71, s71, 3
ds_read_b64_tr_b16 v[174:175], v11 offset:26624
ds_read_b64_tr_b16 v[176:177], v8 offset:28672
v_mfma_f32_16x16x32_bf16 v[40:43], v[248:251], a[28:31], v[40:43]
s_add_u32 s71, s71, s79
s_lshl_b32 s71, s71, 18
s_add_u32 s71, s71, s94
s_add_u32 m0, s77, 49152
s_add_u32 s72, s71, 0
buffer_load_dwordx4 v15, s[24:27], s72 offen lds
v_mfma_f32_16x16x32_bf16 v[40:43], v[232:235], a[24:27], v[40:43]
s_add_u32 s72, s71, 15360
ds_read_b64_tr_b16 v[178:179], v8 offset:30720
ds_read_b64_tr_b16 v[180:181], v9 offset:28672
v_mfma_f32_16x16x32_bf16 v[40:43], v[216:219], a[20:23], v[40:43]
ds_read_b64_tr_b16 v[182:183], v9 offset:30720
ds_read_b64_tr_b16 v[184:185], v10 offset:28672
v_mfma_f32_16x16x32_bf16 v[40:43], v[200:203], a[16:19], v[40:43]
buffer_load_dwordx4 v15, s[24:27], s72 offen offset:1024 lds
v_mfma_f32_16x16x32_bf16 v[44:47], v[204:207], a[16:19], v[44:47]
s_add_u32 s72, s71, 30720
ds_read_b64_tr_b16 v[186:187], v10 offset:30720
ds_read_b64_tr_b16 v[188:189], v11 offset:28672
v_mfma_f32_16x16x32_bf16 v[44:47], v[220:223], a[20:23], v[44:47]
buffer_load_dwordx4 v15, s[24:27], s72 offen offset:2048 lds
v_mfma_f32_16x16x32_bf16 v[44:47], v[236:239], a[24:27], v[44:47]
s_add_u32 s72, s71, 46080
ds_read_b64_tr_b16 v[190:191], v11 offset:30720
v_mfma_f32_16x16x32_bf16 v[44:47], v[252:255], a[28:31], v[44:47]
v_mfma_f32_16x16x32_bf16 v[28:31], v[252:255], a[12:15], v[28:31]
buffer_load_dwordx4 v15, s[24:27], s72 offen offset:3072 lds
v_mfma_f32_16x16x32_bf16 v[28:31], v[236:239], a[8:11], v[28:31]
s_add_u32 s69, s61, 3
v_mfma_f32_16x16x32_bf16 v[28:31], v[220:223], a[4:7], v[28:31]
s_waitcnt vmcnt(18) lgkmcnt(0)
v_mfma_f32_16x16x32_bf16 v[28:31], v[204:207], a[0:3], v[28:31]
s_barrier
s_and_b32 s69, s69, 3
s_add_u32 s69, s69, s79
s_lshl_b32 s69, s69, 12
s_add_u32 s69, s69, s95
buffer_load_dwordx4 a[96:99], v1, s[44:47], s69 offen sc1
v_mfma_f32_16x16x32_bf16 v[16:19], v[128:131], a[32:35], v[16:19]
ds_read_b64_tr_b16 v[192:193], v8 offset:32768
ds_read_b64_tr_b16 v[194:195], v8 offset:34816
s_add_u32 s73, s64, 131072
v_add_u32 v120, s73, v1
s_lshl_b32 s70, s75, 18
s_add_u32 s70, s70, s94
v_mfma_f32_16x16x32_bf16 v[16:19], v[144:147], a[36:39], v[16:19]
ds_read_b64_tr_b16 v[196:197], v9 offset:32768
ds_read_b64_tr_b16 v[198:199], v9 offset:34816
v_mfma_f32_16x16x32_bf16 v[16:19], v[160:163], a[40:43], v[16:19]
buffer_load_dwordx4 a[100:103], v1, s[44:47], s69 offen offset:1024 sc1
v_mfma_f32_16x16x32_bf16 v[16:19], v[176:179], a[44:47], v[16:19]
ds_read_b64_tr_b16 v[200:201], v10 offset:32768
ds_read_b64_tr_b16 v[202:203], v10 offset:34816
v_mfma_f32_16x16x32_bf16 v[32:35], v[176:179], a[60:63], v[32:35]
ds_write_b128 v120, v[80:83] offset:0
buffer_load_dwordx4 a[104:107], v1, s[44:47], s69 offen offset:2048 sc1
v_mfma_f32_16x16x32_bf16 v[32:35], v[160:163], a[56:59], v[32:35]
ds_read_b64_tr_b16 v[204:205], v11 offset:32768
ds_read_b64_tr_b16 v[206:207], v11 offset:34816
v_mfma_f32_16x16x32_bf16 v[32:35], v[144:147], a[52:55], v[32:35]
ds_read_b64_tr_b16 v[208:209], v8 offset:36864
v_mfma_f32_16x16x32_bf16 v[32:35], v[128:131], a[48:51], v[32:35]
buffer_load_dwordx4 a[108:111], v1, s[44:47], s69 offen offset:3072 sc1
v_mfma_f32_16x16x32_bf16 v[36:39], v[132:135], a[48:51], v[36:39]
s_add_u32 s69, s69, 0x20000
ds_read_b64_tr_b16 v[210:211], v8 offset:38912
ds_read_b64_tr_b16 v[212:213], v9 offset:36864
v_mfma_f32_16x16x32_bf16 v[36:39], v[148:151], a[52:55], v[36:39]
ds_read_b64_tr_b16 v[214:215], v9 offset:38912
ds_read_b64_tr_b16 v[216:217], v10 offset:36864
ds_write_b128 v120, v[84:87] offset:1024
v_mfma_f32_16x16x32_bf16 v[36:39], v[164:167], a[56:59], v[36:39]
buffer_load_dwordx4 a[112:115], v1, s[44:47], s69 offen sc1
v_mfma_f32_16x16x32_bf16 v[36:39], v[180:183], a[60:63], v[36:39]
ds_read_b64_tr_b16 v[218:219], v10 offset:38912
ds_read_b64_tr_b16 v[220:221], v11 offset:36864
v_mfma_f32_16x16x32_bf16 v[20:23], v[180:183], a[44:47], v[20:23]
ds_read_b64_tr_b16 v[222:223], v11 offset:38912
v_mfma_f32_16x16x32_bf16 v[20:23], v[164:167], a[40:43], v[20:23]
buffer_load_dwordx4 a[116:119], v1, s[44:47], s69 offen offset:1024 sc1
v_mfma_f32_16x16x32_bf16 v[20:23], v[148:151], a[36:39], v[20:23]
ds_read_b64_tr_b16 v[224:225], v8 offset:40960
ds_read_b64_tr_b16 v[226:227], v8 offset:43008
ds_write_b128 v120, v[96:99] offset:2048
v_mfma_f32_16x16x32_bf16 v[20:23], v[132:135], a[32:35], v[20:23]
ds_read_b64_tr_b16 v[228:229], v9 offset:40960
ds_read_b64_tr_b16 v[230:231], v9 offset:43008
v_mfma_f32_16x16x32_bf16 v[24:27], v[136:139], a[32:35], v[24:27]
buffer_load_dwordx4 a[120:123], v1, s[44:47], s69 offen offset:2048 sc1
v_mfma_f32_16x16x32_bf16 v[24:27], v[152:155], a[36:39], v[24:27]
ds_read_b64_tr_b16 v[232:233], v10 offset:40960
ds_read_b64_tr_b16 v[234:235], v10 offset:43008
v_mfma_f32_16x16x32_bf16 v[24:27], v[168:171], a[40:43], v[24:27]
buffer_load_dwordx4 a[124:127], v1, s[44:47], s69 offen offset:3072 sc1
v_mfma_f32_16x16x32_bf16 v[24:27], v[184:187], a[44:47], v[24:27]
s_add_u32 s78, s59, 28
ds_read_b64_tr_b16 v[236:237], v11 offset:40960
ds_read_b64_tr_b16 v[238:239], v11 offset:43008
ds_write_b128 v120, v[100:103] offset:3072
v_mfma_f32_16x16x32_bf16 v[40:43], v[184:187], a[60:63], v[40:43]
s_and_b32 s78, s78, 28
ds_read_b64_tr_b16 v[240:241], v8 offset:45056
v_mfma_f32_16x16x32_bf16 v[40:43], v[168:171], a[56:59], v[40:43]
s_add_u32 s71, s61, 0
s_and_b32 s71, s71, 3
s_add_u32 s71, s71, s78
s_lshl_b32 s71, s71, 18
s_add_u32 s71, s71, s94
s_add_u32 m0, s77, 0
s_add_u32 s72, s71, 0
buffer_load_dwordx4 v15, s[24:27], s72 offen lds
v_mfma_f32_16x16x32_bf16 v[40:43], v[152:155], a[52:55], v[40:43]
s_add_u32 s72, s71, 15360
ds_read_b64_tr_b16 v[242:243], v8 offset:47104
ds_read_b64_tr_b16 v[244:245], v9 offset:45056
v_mfma_f32_16x16x32_bf16 v[40:43], v[136:139], a[48:51], v[40:43]
ds_read_b64_tr_b16 v[246:247], v9 offset:47104
ds_read_b64_tr_b16 v[248:249], v10 offset:45056
v_mfma_f32_16x16x32_bf16 v[44:47], v[140:143], a[48:51], v[44:47]
buffer_load_dwordx4 v15, s[24:27], s72 offen offset:1024 lds
v_mfma_f32_16x16x32_bf16 v[44:47], v[156:159], a[52:55], v[44:47]
s_add_u32 s72, s71, 30720
ds_read_b64_tr_b16 v[250:251], v10 offset:47104
ds_read_b64_tr_b16 v[252:253], v11 offset:45056
v_mfma_f32_16x16x32_bf16 v[44:47], v[172:175], a[56:59], v[44:47]
ds_read_b64_tr_b16 v[254:255], v11 offset:47104
v_mfma_f32_16x16x32_bf16 v[44:47], v[188:191], a[60:63], v[44:47]
buffer_load_dwordx4 v15, s[24:27], s72 offen offset:2048 lds
v_mfma_f32_16x16x32_bf16 v[28:31], v[188:191], a[44:47], v[28:31]
s_add_u32 s72, s71, 46080
v_mfma_f32_16x16x32_bf16 v[28:31], v[172:175], a[40:43], v[28:31]
buffer_load_dwordx4 v15, s[24:27], s72 offen offset:3072 lds
v_mfma_f32_16x16x32_bf16 v[28:31], v[156:159], a[36:39], v[28:31]
s_waitcnt vmcnt(12) lgkmcnt(0)
v_mfma_f32_16x16x32_bf16 v[28:31], v[140:143], a[32:35], v[28:31]
s_barrier
v_mfma_f32_16x16x32_bf16 v[16:19], v[192:195], a[64:67], v[16:19]
s_waitcnt vmcnt(54)
v_cmp_gt_u32 vcc, 2, v3
s_cbranch_vccnz Lspin84
Lback85:
s_add_u32 s82, s59, 32
s_and_b32 s82, s82, 28
s_lshl_b32 s82, s82, 10
s_add_u32 s82, s82, s74
buffer_load_dword v3, v2, s[44:47], s82 offen sc1
s_add_u32 s69, s61, 0
s_and_b32 s69, s69, 3
s_add_u32 s69, s69, s78
s_lshl_b32 s69, s69, 12
s_add_u32 s69, s69, s95
buffer_load_dwordx4 a[0:3], v1, s[44:47], s69 offen sc1
v_mfma_f32_16x16x32_bf16 v[16:19], v[208:211], a[68:71], v[16:19]
ds_read_b64_tr_b16 v[128:129], v8 offset:49152
ds_read_b64_tr_b16 v[130:131], v8 offset:51200
v_mfma_f32_16x16x32_bf16 v[16:19], v[224:227], a[72:75], v[16:19]
ds_read_b64_tr_b16 v[132:133], v9 offset:49152
ds_read_b64_tr_b16 v[134:135], v9 offset:51200
v_mfma_f32_16x16x32_bf16 v[16:19], v[240:243], a[76:79], v[16:19]
buffer_load_dwordx4 a[4:7], v1, s[44:47], s69 offen offset:1024 sc1
v_mfma_f32_16x16x32_bf16 v[32:35], v[240:243], a[92:95], v[32:35]
ds_read_b64_tr_b16 v[136:137], v10 offset:49152
ds_read_b64_tr_b16 v[138:139], v10 offset:51200
v_mfma_f32_16x16x32_bf16 v[32:35], v[224:227], a[88:91], v[32:35]
ds_read_b64_tr_b16 v[140:141], v11 offset:49152
ds_read_b64_tr_b16 v[142:143], v11 offset:51200
v_mfma_f32_16x16x32_bf16 v[32:35], v[208:211], a[84:87], v[32:35]
buffer_load_dwordx4 a[8:11], v1, s[44:47], s69 offen offset:2048 sc1
v_mfma_f32_16x16x32_bf16 v[32:35], v[192:195], a[80:83], v[32:35]
ds_read_b64_tr_b16 v[144:145], v8 offset:53248
ds_read_b64_tr_b16 v[146:147], v8 offset:55296
v_mfma_f32_16x16x32_bf16 v[36:39], v[196:199], a[80:83], v[36:39]
ds_read_b64_tr_b16 v[148:149], v9 offset:53248
ds_read_b64_tr_b16 v[150:151], v9 offset:55296
v_mfma_f32_16x16x32_bf16 v[36:39], v[212:215], a[84:87], v[36:39]
buffer_load_dwordx4 a[12:15], v1, s[44:47], s69 offen offset:3072 sc1
v_mfma_f32_16x16x32_bf16 v[36:39], v[228:231], a[88:91], v[36:39]
s_add_u32 s69, s69, 0x20000
ds_read_b64_tr_b16 v[152:153], v10 offset:53248
ds_read_b64_tr_b16 v[154:155], v10 offset:55296
v_mfma_f32_16x16x32_bf16 v[36:39], v[244:247], a[92:95], v[36:39]
buffer_load_dwordx4 a[16:19], v1, s[44:47], s69 offen sc1
v_mfma_f32_16x16x32_bf16 v[20:23], v[244:247], a[76:79], v[20:23]
ds_read_b64_tr_b16 v[156:157], v11 offset:53248
ds_read_b64_tr_b16 v[158:159], v11 offset:55296
v_mfma_f32_16x16x32_bf16 v[20:23], v[228:231], a[72:75], v[20:23]
ds_read_b64_tr_b16 v[160:161], v8 offset:57344
v_mfma_f32_16x16x32_bf16 v[20:23], v[212:215], a[68:71], v[20:23]
buffer_load_dwordx4 a[20:23], v1, s[44:47], s69 offen offset:1024 sc1
v_mfma_f32_16x16x32_bf16 v[20:23], v[196:199], a[64:67], v[20:23]
ds_read_b64_tr_b16 v[162:163], v8 offset:59392
ds_read_b64_tr_b16 v[164:165], v9 offset:57344
v_mfma_f32_16x16x32_bf16 v[24:27], v[200:203], a[64:67], v[24:27]
ds_read_b64_tr_b16 v[166:167], v9 offset:59392
ds_read_b64_tr_b16 v[168:169], v10 offset:57344
v_mfma_f32_16x16x32_bf16 v[24:27], v[216:219], a[68:71], v[24:27]
buffer_load_dwordx4 a[24:27], v1, s[44:47], s69 offen offset:2048 sc1
v_mfma_f32_16x16x32_bf16 v[24:27], v[232:235], a[72:75], v[24:27]
ds_read_b64_tr_b16 v[170:171], v10 offset:59392
ds_read_b64_tr_b16 v[172:173], v11 offset:57344
v_mfma_f32_16x16x32_bf16 v[24:27], v[248:251], a[76:79], v[24:27]
ds_read_b64_tr_b16 v[174:175], v11 offset:59392
ds_read_b64_tr_b16 v[176:177], v8 offset:61440
v_mfma_f32_16x16x32_bf16 v[40:43], v[248:251], a[92:95], v[40:43]
buffer_load_dwordx4 a[28:31], v1, s[44:47], s69 offen offset:3072 sc1
v_mfma_f32_16x16x32_bf16 v[40:43], v[232:235], a[88:91], v[40:43]
s_add_u32 s71, s61, 1
ds_read_b64_tr_b16 v[178:179], v8 offset:63488
ds_read_b64_tr_b16 v[180:181], v9 offset:61440
v_mfma_f32_16x16x32_bf16 v[40:43], v[216:219], a[84:87], v[40:43]
s_and_b32 s71, s71, 3
s_add_u32 s71, s71, s78
s_lshl_b32 s71, s71, 18
s_add_u32 s71, s71, s94
s_add_u32 m0, s77, 16384
s_add_u32 s72, s71, 0
buffer_load_dwordx4 v15, s[24:27], s72 offen lds
v_mfma_f32_16x16x32_bf16 v[40:43], v[200:203], a[80:83], v[40:43]
s_add_u32 s72, s71, 15360
ds_read_b64_tr_b16 v[182:183], v9 offset:63488
ds_read_b64_tr_b16 v[184:185], v10 offset:61440
v_mfma_f32_16x16x32_bf16 v[44:47], v[204:207], a[80:83], v[44:47]
ds_read_b64_tr_b16 v[186:187], v10 offset:63488
ds_read_b64_tr_b16 v[188:189], v11 offset:61440
v_mfma_f32_16x16x32_bf16 v[44:47], v[220:223], a[84:87], v[44:47]
buffer_load_dwordx4 v15, s[24:27], s72 offen offset:1024 lds
v_mfma_f32_16x16x32_bf16 v[44:47], v[236:239], a[88:91], v[44:47]
s_add_u32 s72, s71, 30720
ds_read_b64_tr_b16 v[190:191], v11 offset:63488
v_mfma_f32_16x16x32_bf16 v[44:47], v[252:255], a[92:95], v[44:47]
v_mfma_f32_16x16x32_bf16 v[28:31], v[252:255], a[76:79], v[28:31]
buffer_load_dwordx4 v15, s[24:27], s72 offen offset:2048 lds
v_mfma_f32_16x16x32_bf16 v[28:31], v[236:239], a[72:75], v[28:31]
s_add_u32 s72, s71, 46080
v_mfma_f32_16x16x32_bf16 v[28:31], v[220:223], a[68:71], v[28:31]
s_waitcnt vmcnt(12) lgkmcnt(0)
v_mfma_f32_16x16x32_bf16 v[28:31], v[204:207], a[64:67], v[28:31]
s_barrier
buffer_load_dwordx4 v15, s[24:27], s72 offen offset:3072 lds
v_mfma_f32_16x16x32_bf16 v[16:19], v[128:131], a[96:99], v[16:19]
s_add_u32 s69, s61, 1
ds_read_b64_tr_b16 v[192:193], v8 offset:0
ds_read_b64_tr_b16 v[194:195], v8 offset:2048
ds_read_b64 v[80:81], v116 offset:0
v_mfma_f32_16x16x32_bf16 v[16:19], v[144:147], a[100:103], v[16:19]
s_and_b32 s69, s69, 3
ds_read_b64_tr_b16 v[196:197], v9 offset:0
ds_read_b64_tr_b16 v[198:199], v9 offset:2048
ds_read_b64_tr_b16 v[88:89], v5 offset:0
v_mfma_f32_16x16x32_bf16 v[16:19], v[160:163], a[104:107], v[16:19]
s_add_u32 s69, s69, s78
ds_read_b64 v[82:83], v117 offset:0
s_lshl_b32 s69, s69, 12
s_add_u32 s69, s69, s95
buffer_load_dwordx4 a[32:35], v1, s[44:47], s69 offen sc1
v_mfma_f32_16x16x32_bf16 v[16:19], v[176:179], a[108:111], v[16:19]
ds_read_b64_tr_b16 v[200:201], v10 offset:0
ds_read_b64_tr_b16 v[202:203], v10 offset:2048
ds_read_b64_tr_b16 v[90:91], v5 offset:4096
v_mfma_f32_16x16x32_bf16 v[32:35], v[176:179], a[124:127], v[32:35]
ds_read_b64 v[84:85], v118 offset:0
buffer_load_dwordx4 a[36:39], v1, s[44:47], s69 offen offset:1024 sc1
v_mfma_f32_16x16x32_bf16 v[32:35], v[160:163], a[120:123], v[32:35]
ds_read_b64_tr_b16 v[204:205], v11 offset:0
ds_read_b64_tr_b16 v[206:207], v11 offset:2048
ds_read_b64_tr_b16 v[92:93], v5 offset:8192
v_mfma_f32_16x16x32_bf16 v[32:35], v[144:147], a[116:119], v[32:35]
ds_read_b64_tr_b16 v[208:209], v8 offset:4096
ds_read_b64 v[86:87], v119 offset:0
v_mfma_f32_16x16x32_bf16 v[32:35], v[128:131], a[112:115], v[32:35]
ds_read_b64_tr_b16 v[94:95], v5 offset:12288
buffer_load_dwordx4 a[40:43], v1, s[44:47], s69 offen offset:2048 sc1
v_mfma_f32_16x16x32_bf16 v[36:39], v[132:135], a[112:115], v[36:39]
ds_read_b64_tr_b16 v[210:211], v8 offset:6144
ds_read_b64_tr_b16 v[212:213], v9 offset:4096
ds_read_b64 v[96:97], v116 offset:2048
v_mfma_f32_16x16x32_bf16 v[36:39], v[148:151], a[116:119], v[36:39]
ds_read_b64_tr_b16 v[214:215], v9 offset:6144
ds_read_b64_tr_b16 v[216:217], v10 offset:4096
ds_read_b64_tr_b16 v[104:105], v5 offset:16
v_mfma_f32_16x16x32_bf16 v[36:39], v[164:167], a[120:123], v[36:39]
ds_read_b64 v[98:99], v117 offset:2048
buffer_load_dwordx4 a[44:47], v1, s[44:47], s69 offen offset:3072 sc1
v_mfma_f32_16x16x32_bf16 v[36:39], v[180:183], a[124:127], v[36:39]
s_add_u32 s69, s69, 0x20000
ds_read_b64_tr_b16 v[218:219], v10 offset:6144
ds_read_b64_tr_b16 v[220:221], v11 offset:4096
ds_read_b64_tr_b16 v[106:107], v5 offset:4112
v_mfma_f32_16x16x32_bf16 v[20:23], v[180:183], a[108:111], v[20:23]
ds_read_b64_tr_b16 v[222:223], v11 offset:6144
ds_read_b64 v[100:101], v118 offset:2048
v_mfma_f32_16x16x32_bf16 v[20:23], v[164:167], a[104:107], v[20:23]
ds_read_b64_tr_b16 v[108:109], v5 offset:8208
buffer_load_dwordx4 a[48:51], v1, s[44:47], s69 offen sc1
v_mfma_f32_16x16x32_bf16 v[20:23], v[148:151], a[100:103], v[20:23]
ds_read_b64_tr_b16 v[224:225], v8 offset:8192
ds_read_b64_tr_b16 v[226:227], v8 offset:10240
ds_read_b64 v[102:103], v119 offset:2048
v_mfma_f32_16x16x32_bf16 v[20:23], v[132:135], a[96:99], v[20:23]
ds_read_b64_tr_b16 v[110:111], v5 offset:12304
buffer_load_dwordx4 a[52:55], v1, s[44:47], s69 offen offset:1024 sc1
v_mfma_f32_16x16x32_bf16 v[24:27], v[136:139], a[96:99], v[24:27]
ds_read_b64_tr_b16 v[228:229], v9 offset:8192
ds_read_b64_tr_b16 v[230:231], v9 offset:10240
v_mfma_f32_16x16x32_bf16 v[24:27], v[152:155], a[100:103], v[24:27]
ds_read_b64_tr_b16 v[232:233], v10 offset:8192
ds_read_b64_tr_b16 v[234:235], v10 offset:10240
v_mfma_f32_16x16x32_bf16 v[24:27], v[168:171], a[104:107], v[24:27]
buffer_load_dwordx4 a[56:59], v1, s[44:47], s69 offen offset:2048 sc1
v_mfma_f32_16x16x32_bf16 v[24:27], v[184:187], a[108:111], v[24:27]
ds_read_b64_tr_b16 v[236:237], v11 offset:8192
ds_read_b64_tr_b16 v[238:239], v11 offset:10240
v_mfma_f32_16x16x32_bf16 v[40:43], v[184:187], a[124:127], v[40:43]
ds_read_b64_tr_b16 v[240:241], v8 offset:12288
v_mfma_f32_16x16x32_bf16 v[40:43], v[168:171], a[120:123], v[40:43]
buffer_load_dwordx4 a[60:63], v1, s[44:47], s69 offen offset:3072 sc1
v_mfma_f32_16x16x32_bf16 v[40:43], v[152:155], a[116:119], v[40:43]
s_add_u32 s71, s61, 2
ds_read_b64_tr_b16 v[242:243], v8 offset:14336
ds_read_b64_tr_b16 v[244:245], v9 offset:12288
v_mfma_f32_16x16x32_bf16 v[40:43], v[136:139], a[112:115], v[40:43]
s_and_b32 s71, s71, 3
ds_read_b64_tr_b16 v[246:247], v9 offset:14336
ds_read_b64_tr_b16 v[248:249], v10 offset:12288
v_mfma_f32_16x16x32_bf16 v[44:47], v[140:143], a[112:115], v[44:47]
s_add_u32 s71, s71, s78
s_lshl_b32 s71, s71, 18
s_add_u32 s71, s71, s94
s_add_u32 m0, s77, 32768
s_add_u32 s72, s71, 0
buffer_load_dwordx4 v15, s[24:27], s72 offen lds
v_mfma_f32_16x16x32_bf16 v[44:47], v[156:159], a[116:119], v[44:47]
s_add_u32 s72, s71, 15360
ds_read_b64_tr_b16 v[250:251], v10 offset:14336
ds_read_b64_tr_b16 v[252:253], v11 offset:12288
v_mfma_f32_16x16x32_bf16 v[44:47], v[172:175], a[120:123], v[44:47]
ds_read_b64_tr_b16 v[254:255], v11 offset:14336
v_mfma_f32_16x16x32_bf16 v[44:47], v[188:191], a[124:127], v[44:47]
buffer_load_dwordx4 v15, s[24:27], s72 offen offset:1024 lds
v_mfma_f32_16x16x32_bf16 v[28:31], v[188:191], a[108:111], v[28:31]
s_add_u32 s72, s71, 30720
v_mfma_f32_16x16x32_bf16 v[28:31], v[172:175], a[104:107], v[28:31]
buffer_load_dwordx4 v15, s[24:27], s72 offen offset:2048 lds
v_mfma_f32_16x16x32_bf16 v[28:31], v[156:159], a[100:103], v[28:31]
s_waitcnt vmcnt(11) lgkmcnt(0)
v_mfma_f32_16x16x32_bf16 v[28:31], v[140:143], a[96:99], v[28:31]
s_barrier
v_mfma_f32_16x16x32_bf16 v[16:19], v[192:195], a[0:3], v[16:19]
s_add_u32 s72, s71, 46080
buffer_load_dwordx4 v15, s[24:27], s72 offen offset:3072 lds
v_sub_f32 v112, 1.0, v6
v_mfma_f32_16x16x32_bf16 v[16:19], v[208:211], a[4:7], v[16:19]
s_add_u32 s69, s61, 2
ds_read_b64_tr_b16 v[128:129], v8 offset:16384
ds_read_b64_tr_b16 v[130:131], v8 offset:18432
v_sub_f32 v113, 1.0, v7
v_mfma_f32_16x16x32_bf16 v[16:19], v[224:227], a[8:11], v[16:19]
s_and_b32 s69, s69, 3
ds_read_b64_tr_b16 v[132:133], v9 offset:16384
ds_read_b64_tr_b16 v[134:135], v9 offset:18432
v_lshlrev_b32 v48, 16, v80
v_mfma_f32_16x16x32_bf16 v[16:19], v[240:243], a[12:15], v[16:19]
s_add_u32 s69, s69, s78
s_lshl_b32 s69, s69, 12
s_add_u32 s69, s69, s95
buffer_load_dwordx4 a[64:67], v1, s[44:47], s69 offen sc1
v_mfma_f32_16x16x32_bf16 v[32:35], v[240:243], a[28:31], v[32:35]
ds_read_b64_tr_b16 v[136:137], v10 offset:16384
ds_read_b64_tr_b16 v[138:139], v10 offset:18432
v_lshlrev_b32 v114, 16, v88
v_mfma_f32_16x16x32_bf16 v[32:35], v[224:227], a[24:27], v[32:35]
ds_read_b64_tr_b16 v[140:141], v11 offset:16384
ds_read_b64_tr_b16 v[142:143], v11 offset:18432
v_mul_f32 v48, v48, v112
v_mfma_f32_16x16x32_bf16 v[32:35], v[208:211], a[20:23], v[32:35]
buffer_load_dwordx4 a[68:71], v1, s[44:47], s69 offen offset:1024 sc1
v_mul_f32 v48, v48, v114
v_mfma_f32_16x16x32_bf16 v[32:35], v[192:195], a[16:19], v[32:35]
ds_read_b64_tr_b16 v[144:145], v8 offset:20480
ds_read_b64_tr_b16 v[146:147], v8 offset:22528
v_and_b32 v49, 0xffff0000, v80
v_mfma_f32_16x16x32_bf16 v[36:39], v[196:199], a[16:19], v[36:39]
buffer_load_dwordx4 a[72:75], v1, s[44:47], s69 offen offset:2048 sc1
v_and_b32 v115, 0xffff0000, v88
v_mfma_f32_16x16x32_bf16 v[36:39], v[212:215], a[20:23], v[36:39]
ds_read_b64_tr_b16 v[148:149], v9 offset:20480
ds_read_b64_tr_b16 v[150:151], v9 offset:22528
v_mul_f32 v49, v49, v112
v_mfma_f32_16x16x32_bf16 v[36:39], v[228:231], a[24:27], v[36:39]
ds_read_b64_tr_b16 v[152:153], v10 offset:20480
ds_read_b64_tr_b16 v[154:155], v10 offset:22528
v_mul_f32 v49, v49, v115
v_mfma_f32_16x16x32_bf16 v[36:39], v[244:247], a[28:31], v[36:39]
buffer_load_dwordx4 a[76:79], v1, s[44:47], s69 offen offset:3072 sc1
v_lshlrev_b32 v50, 16, v81
v_mfma_f32_16x16x32_bf16 v[20:23], v[244:247], a[12:15], v[20:23]
s_add_u32 s69, s69, 0x20000
ds_read_b64_tr_b16 v[156:157], v11 offset:20480
ds_read_b64_tr_b16 v[158:159], v11 offset:22528
v_lshlrev_b32 v114, 16, v89
v_mfma_f32_16x16x32_bf16 v[20:23], v[228:231], a[8:11], v[20:23]
ds_read_b64_tr_b16 v[160:161], v8 offset:24576
v_mul_f32 v50, v50, v112
v_mfma_f32_16x16x32_bf16 v[20:23], v[212:215], a[4:7], v[20:23]
buffer_load_dwordx4 a[80:83], v1, s[44:47], s69 offen sc1
v_mul_f32 v50, v50, v114
v_mfma_f32_16x16x32_bf16 v[20:23], v[196:199], a[0:3], v[20:23]
ds_read_b64_tr_b16 v[162:163], v8 offset:26624
ds_read_b64_tr_b16 v[164:165], v9 offset:24576
v_and_b32 v51, 0xffff0000, v81
v_mfma_f32_16x16x32_bf16 v[24:27], v[200:203], a[0:3], v[24:27]
ds_read_b64_tr_b16 v[166:167], v9 offset:26624
ds_read_b64_tr_b16 v[168:169], v10 offset:24576
v_and_b32 v115, 0xffff0000, v89
v_mfma_f32_16x16x32_bf16 v[24:27], v[216:219], a[4:7], v[24:27]
buffer_load_dwordx4 a[84:87], v1, s[44:47], s69 offen offset:1024 sc1
v_mul_f32 v51, v51, v112
v_mfma_f32_16x16x32_bf16 v[24:27], v[232:235], a[8:11], v[24:27]
ds_read_b64_tr_b16 v[170:171], v10 offset:26624
ds_read_b64_tr_b16 v[172:173], v11 offset:24576
v_mul_f32 v51, v51, v115
v_mfma_f32_16x16x32_bf16 v[24:27], v[248:251], a[12:15], v[24:27]
buffer_load_dwordx4 a[88:91], v1, s[44:47], s69 offen offset:2048 sc1
v_lshlrev_b32 v52, 16, v82
v_mfma_f32_16x16x32_bf16 v[40:43], v[248:251], a[28:31], v[40:43]
ds_read_b64_tr_b16 v[174:175], v11 offset:26624
ds_read_b64_tr_b16 v[176:177], v8 offset:28672
v_lshlrev_b32 v114, 16, v90
v_mfma_f32_16x16x32_bf16 v[40:43], v[232:235], a[24:27], v[40:43]
ds_read_b64_tr_b16 v[178:179], v8 offset:30720
ds_read_b64_tr_b16 v[180:181], v9 offset:28672
v_mul_f32 v52, v52, v112
v_mfma_f32_16x16x32_bf16 v[40:43], v[216:219], a[20:23], v[40:43]
buffer_load_dwordx4 a[92:95], v1, s[44:47], s69 offen offset:3072 sc1
v_mul_f32 v52, v52, v114
v_mfma_f32_16x16x32_bf16 v[40:43], v[200:203], a[16:19], v[40:43]
s_add_u32 s71, s61, 3
ds_read_b64_tr_b16 v[182:183], v9 offset:30720
ds_read_b64_tr_b16 v[184:185], v10 offset:28672
v_and_b32 v53, 0xffff0000, v82
v_mfma_f32_16x16x32_bf16 v[44:47], v[204:207], a[16:19], v[44:47]
s_and_b32 s71, s71, 3
ds_read_b64_tr_b16 v[186:187], v10 offset:30720
ds_read_b64_tr_b16 v[188:189], v11 offset:28672
v_and_b32 v115, 0xffff0000, v90
v_mfma_f32_16x16x32_bf16 v[44:47], v[220:223], a[20:23], v[44:47]
s_add_u32 s71, s71, s78
s_lshl_b32 s71, s71, 18
s_add_u32 s71, s71, s94
s_add_u32 m0, s77, 49152
s_add_u32 s72, s71, 0
buffer_load_dwordx4 v15, s[24:27], s72 offen lds
v_mfma_f32_16x16x32_bf16 v[44:47], v[236:239], a[24:27], v[44:47]
s_add_u32 s72, s71, 15360
ds_read_b64_tr_b16 v[190:191], v11 offset:30720
v_mul_f32 v53, v53, v112
v_mfma_f32_16x16x32_bf16 v[44:47], v[252:255], a[28:31], v[44:47]
v_mul_f32 v53, v53, v115
v_mfma_f32_16x16x32_bf16 v[28:31], v[252:255], a[12:15], v[28:31]
buffer_load_dwordx4 v15, s[24:27], s72 offen offset:1024 lds
v_lshlrev_b32 v54, 16, v83
v_mfma_f32_16x16x32_bf16 v[28:31], v[236:239], a[8:11], v[28:31]
s_add_u32 s72, s71, 30720
v_lshlrev_b32 v114, 16, v91
v_mfma_f32_16x16x32_bf16 v[28:31], v[220:223], a[4:7], v[28:31]
s_waitcnt vmcnt(10) lgkmcnt(0)
v_mul_f32 v54, v54, v112
v_mfma_f32_16x16x32_bf16 v[28:31], v[204:207], a[0:3], v[28:31]
s_barrier
buffer_load_dwordx4 v15, s[24:27], s72 offen offset:2048 lds
v_mul_f32 v54, v54, v114
v_mfma_f32_16x16x32_bf16 v[16:19], v[128:131], a[32:35], v[16:19]
s_add_u32 s72, s71, 46080
ds_read_b64_tr_b16 v[192:193], v8 offset:32768
ds_read_b64_tr_b16 v[194:195], v8 offset:34816
v_and_b32 v55, 0xffff0000, v83
v_mfma_f32_16x16x32_bf16 v[16:19], v[144:147], a[36:39], v[16:19]
buffer_load_dwordx4 v15, s[24:27], s72 offen offset:3072 lds
v_and_b32 v115, 0xffff0000, v91
v_mfma_f32_16x16x32_bf16 v[16:19], v[160:163], a[40:43], v[16:19]
s_add_u32 s69, s61, 3
ds_read_b64_tr_b16 v[196:197], v9 offset:32768
ds_read_b64_tr_b16 v[198:199], v9 offset:34816
v_mul_f32 v55, v55, v112
v_mfma_f32_16x16x32_bf16 v[16:19], v[176:179], a[44:47], v[16:19]
s_and_b32 s69, s69, 3
ds_read_b64_tr_b16 v[200:201], v10 offset:32768
ds_read_b64_tr_b16 v[202:203], v10 offset:34816
v_mul_f32 v55, v55, v115
v_mfma_f32_16x16x32_bf16 v[32:35], v[176:179], a[60:63], v[32:35]
s_add_u32 s69, s69, s78
s_lshl_b32 s69, s69, 12
s_add_u32 s69, s69, s95
buffer_load_dwordx4 a[96:99], v1, s[44:47], s69 offen sc1
v_mfma_f32_16x16x32_bf16 v[32:35], v[160:163], a[56:59], v[32:35]
ds_read_b64_tr_b16 v[204:205], v11 offset:32768
ds_read_b64_tr_b16 v[206:207], v11 offset:34816
v_lshlrev_b32 v56, 16, v84
v_mfma_f32_16x16x32_bf16 v[32:35], v[144:147], a[52:55], v[32:35]
ds_read_b64_tr_b16 v[208:209], v8 offset:36864
ds_read_b64_tr_b16 v[210:211], v8 offset:38912
v_lshlrev_b32 v114, 16, v92
v_mfma_f32_16x16x32_bf16 v[32:35], v[128:131], a[48:51], v[32:35]
buffer_load_dwordx4 a[100:103], v1, s[44:47], s69 offen offset:1024 sc1
v_mul_f32 v56, v56, v112
v_mfma_f32_16x16x32_bf16 v[36:39], v[132:135], a[48:51], v[36:39]
ds_read_b64_tr_b16 v[212:213], v9 offset:36864
ds_read_b64_tr_b16 v[214:215], v9 offset:38912
v_mul_f32 v56, v56, v114
v_mfma_f32_16x16x32_bf16 v[36:39], v[148:151], a[52:55], v[36:39]
ds_read_b64_tr_b16 v[216:217], v10 offset:36864
ds_read_b64_tr_b16 v[218:219], v10 offset:38912
v_and_b32 v57, 0xffff0000, v84
v_mfma_f32_16x16x32_bf16 v[36:39], v[164:167], a[56:59], v[36:39]
buffer_load_dwordx4 a[104:107], v1, s[44:47], s69 offen offset:2048 sc1
v_and_b32 v115, 0xffff0000, v92
v_mfma_f32_16x16x32_bf16 v[36:39], v[180:183], a[60:63], v[36:39]
ds_read_b64_tr_b16 v[220:221], v11 offset:36864
ds_read_b64_tr_b16 v[222:223], v11 offset:38912
v_mul_f32 v57, v57, v112
v_mfma_f32_16x16x32_bf16 v[20:23], v[180:183], a[44:47], v[20:23]
buffer_load_dwordx4 a[108:111], v1, s[44:47], s69 offen offset:3072 sc1
v_mul_f32 v57, v57, v115
v_mfma_f32_16x16x32_bf16 v[20:23], v[164:167], a[40:43], v[20:23]
s_add_u32 s69, s69, 0x20000
ds_read_b64_tr_b16 v[224:225], v8 offset:40960
v_lshlrev_b32 v58, 16, v85
v_mfma_f32_16x16x32_bf16 v[20:23], v[148:151], a[36:39], v[20:23]
ds_read_b64_tr_b16 v[226:227], v8 offset:43008
ds_read_b64_tr_b16 v[228:229], v9 offset:40960
v_lshlrev_b32 v114, 16, v93
v_mfma_f32_16x16x32_bf16 v[20:23], v[132:135], a[32:35], v[20:23]
buffer_load_dwordx4 a[112:115], v1, s[44:47], s69 offen sc1
v_mul_f32 v58, v58, v112
v_mfma_f32_16x16x32_bf16 v[24:27], v[136:139], a[32:35], v[24:27]
ds_read_b64_tr_b16 v[230:231], v9 offset:43008
ds_read_b64_tr_b16 v[232:233], v10 offset:40960
v_mul_f32 v58, v58, v114
v_mfma_f32_16x16x32_bf16 v[24:27], v[152:155], a[36:39], v[24:27]
ds_read_b64_tr_b16 v[234:235], v10 offset:43008
ds_read_b64_tr_b16 v[236:237], v11 offset:40960
v_and_b32 v59, 0xffff0000, v85
v_mfma_f32_16x16x32_bf16 v[24:27], v[168:171], a[40:43], v[24:27]
buffer_load_dwordx4 a[116:119], v1, s[44:47], s69 offen offset:1024 sc1
v_and_b32 v115, 0xffff0000, v93
v_mfma_f32_16x16x32_bf16 v[24:27], v[184:187], a[44:47], v[24:27]
ds_read_b64_tr_b16 v[238:239], v11 offset:43008
ds_read_b64_tr_b16 v[240:241], v8 offset:45056
v_mul_f32 v59, v59, v112
v_mfma_f32_16x16x32_bf16 v[40:43], v[184:187], a[60:63], v[40:43]
ds_read_b64_tr_b16 v[242:243], v8 offset:47104
ds_read_b64_tr_b16 v[244:245], v9 offset:45056
v_mul_f32 v59, v59, v115
v_mfma_f32_16x16x32_bf16 v[40:43], v[168:171], a[56:59], v[40:43]
buffer_load_dwordx4 a[120:123], v1, s[44:47], s69 offen offset:2048 sc1
v_lshlrev_b32 v60, 16, v86
v_mfma_f32_16x16x32_bf16 v[40:43], v[152:155], a[52:55], v[40:43]
ds_read_b64_tr_b16 v[246:247], v9 offset:47104
ds_read_b64_tr_b16 v[248:249], v10 offset:45056
v_lshlrev_b32 v114, 16, v94
v_mfma_f32_16x16x32_bf16 v[40:43], v[136:139], a[48:51], v[40:43]
ds_read_b64_tr_b16 v[250:251], v10 offset:47104
ds_read_b64_tr_b16 v[252:253], v11 offset:45056
v_mul_f32 v60, v60, v112
v_mfma_f32_16x16x32_bf16 v[44:47], v[140:143], a[48:51], v[44:47]
buffer_load_dwordx4 a[124:127], v1, s[44:47], s69 offen offset:3072 sc1
v_mul_f32 v60, v60, v114
v_mfma_f32_16x16x32_bf16 v[44:47], v[156:159], a[52:55], v[44:47]
s_add_u32 s79, s59, 32
ds_read_b64_tr_b16 v[254:255], v11 offset:47104
v_and_b32 v61, 0xffff0000, v86
v_mfma_f32_16x16x32_bf16 v[44:47], v[172:175], a[56:59], v[44:47]
s_and_b32 s79, s79, 28
s_add_u32 s71, s61, 0
s_and_b32 s71, s71, 3
s_add_u32 s71, s71, s79
s_lshl_b32 s71, s71, 18
s_add_u32 s71, s71, s94
s_add_u32 m0, s77, 0
s_add_u32 s72, s71, 0
buffer_load_dwordx4 v15, s[24:27], s72 offen lds
v_mfma_f32_16x16x32_bf16 v[44:47], v[188:191], a[60:63], v[44:47]
s_add_u32 s72, s71, 15360
v_and_b32 v115, 0xffff0000, v94
v_mfma_f32_16x16x32_bf16 v[28:31], v[188:191], a[44:47], v[28:31]
v_mul_f32 v61, v61, v112
v_mfma_f32_16x16x32_bf16 v[28:31], v[172:175], a[40:43], v[28:31]
buffer_load_dwordx4 v15, s[24:27], s72 offen offset:1024 lds
v_mul_f32 v61, v61, v115
v_mfma_f32_16x16x32_bf16 v[28:31], v[156:159], a[36:39], v[28:31]
s_waitcnt vmcnt(10) lgkmcnt(0)
v_lshlrev_b32 v62, 16, v87
v_mfma_f32_16x16x32_bf16 v[28:31], v[140:143], a[32:35], v[28:31]
s_barrier
v_lshlrev_b32 v114, 16, v95
v_mfma_f32_16x16x32_bf16 v[16:19], v[192:195], a[64:67], v[16:19]
s_add_u32 s72, s71, 30720
buffer_load_dwordx4 v15, s[24:27], s72 offen offset:2048 lds
v_mul_f32 v62, v62, v112
v_mfma_f32_16x16x32_bf16 v[16:19], v[208:211], a[68:71], v[16:19]
s_add_u32 s72, s71, 46080
ds_read_b64_tr_b16 v[128:129], v8 offset:49152
ds_read_b64_tr_b16 v[130:131], v8 offset:51200
v_mul_f32 v62, v62, v114
v_mfma_f32_16x16x32_bf16 v[16:19], v[224:227], a[72:75], v[16:19]
ds_read_b64_tr_b16 v[132:133], v9 offset:49152
ds_read_b64_tr_b16 v[134:135], v9 offset:51200
v_and_b32 v63, 0xffff0000, v87
v_mfma_f32_16x16x32_bf16 v[16:19], v[240:243], a[76:79], v[16:19]
buffer_load_dwordx4 v15, s[24:27], s72 offen offset:3072 lds
v_and_b32 v115, 0xffff0000, v95
v_mfma_f32_16x16x32_bf16 v[32:35], v[240:243], a[92:95], v[32:35]
ds_read_b64_tr_b16 v[136:137], v10 offset:49152
ds_read_b64_tr_b16 v[138:139], v10 offset:51200
v_mul_f32 v63, v63, v112
v_mfma_f32_16x16x32_bf16 v[32:35], v[224:227], a[88:91], v[32:35]
s_waitcnt vmcnt(48)
v_cmp_gt_u32 vcc, 2, v3
s_cbranch_vccnz Lspin87
Lback88:
s_add_u32 s69, s61, 0
s_and_b32 s69, s69, 3
s_add_u32 s69, s69, s79
s_lshl_b32 s69, s69, 12
s_add_u32 s69, s69, s95
buffer_load_dwordx4 a[0:3], v1, s[44:47], s69 offen sc1
v_mfma_f32_16x16x32_bf16 v[32:35], v[208:211], a[84:87], v[32:35]
ds_read_b64_tr_b16 v[140:141], v11 offset:49152
ds_read_b64_tr_b16 v[142:143], v11 offset:51200
v_mul_f32 v63, v63, v115
v_mfma_f32_16x16x32_bf16 v[32:35], v[192:195], a[80:83], v[32:35]
ds_read_b64_tr_b16 v[144:145], v8 offset:53248
ds_read_b64_tr_b16 v[146:147], v8 offset:55296
v_lshlrev_b32 v64, 16, v96
v_mfma_f32_16x16x32_bf16 v[36:39], v[196:199], a[80:83], v[36:39]
buffer_load_dwordx4 a[4:7], v1, s[44:47], s69 offen offset:1024 sc1
v_lshlrev_b32 v114, 16, v104
v_mfma_f32_16x16x32_bf16 v[36:39], v[212:215], a[84:87], v[36:39]
ds_read_b64_tr_b16 v[148:149], v9 offset:53248
ds_read_b64_tr_b16 v[150:151], v9 offset:55296
v_mul_f32 v64, v64, v113
v_mfma_f32_16x16x32_bf16 v[36:39], v[228:231], a[88:91], v[36:39]
ds_read_b64_tr_b16 v[152:153], v10 offset:53248
ds_read_b64_tr_b16 v[154:155], v10 offset:55296
v_mul_f32 v64, v64, v114
v_mfma_f32_16x16x32_bf16 v[36:39], v[244:247], a[92:95], v[36:39]
buffer_load_dwordx4 a[8:11], v1, s[44:47], s69 offen offset:2048 sc1
v_and_b32 v65, 0xffff0000, v96
v_mfma_f32_16x16x32_bf16 v[20:23], v[244:247], a[76:79], v[20:23]
ds_read_b64_tr_b16 v[156:157], v11 offset:53248
ds_read_b64_tr_b16 v[158:159], v11 offset:55296
v_and_b32 v115, 0xffff0000, v104
v_mfma_f32_16x16x32_bf16 v[20:23], v[228:231], a[72:75], v[20:23]
ds_read_b64_tr_b16 v[160:161], v8 offset:57344
v_mul_f32 v65, v65, v113
v_mfma_f32_16x16x32_bf16 v[20:23], v[212:215], a[68:71], v[20:23]
buffer_load_dwordx4 a[12:15], v1, s[44:47], s69 offen offset:3072 sc1
v_mul_f32 v65, v65, v115
v_mfma_f32_16x16x32_bf16 v[20:23], v[196:199], a[64:67], v[20:23]
s_add_u32 s69, s69, 0x20000
ds_read_b64_tr_b16 v[162:163], v8 offset:59392
ds_read_b64_tr_b16 v[164:165], v9 offset:57344
v_lshlrev_b32 v66, 16, v97
v_mfma_f32_16x16x32_bf16 v[24:27], v[200:203], a[64:67], v[24:27]
ds_read_b64_tr_b16 v[166:167], v9 offset:59392
ds_read_b64_tr_b16 v[168:169], v10 offset:57344
v_lshlrev_b32 v114, 16, v105
v_mfma_f32_16x16x32_bf16 v[24:27], v[216:219], a[68:71], v[24:27]
buffer_load_dwordx4 a[16:19], v1, s[44:47], s69 offen sc1
v_mul_f32 v66, v66, v113
v_mfma_f32_16x16x32_bf16 v[24:27], v[232:235], a[72:75], v[24:27]
ds_read_b64_tr_b16 v[170:171], v10 offset:59392
ds_read_b64_tr_b16 v[172:173], v11 offset:57344
v_mul_f32 v66, v66, v114
v_mfma_f32_16x16x32_bf16 v[24:27], v[248:251], a[76:79], v[24:27]
buffer_load_dwordx4 a[20:23], v1, s[44:47], s69 offen offset:1024 sc1
v_and_b32 v67, 0xffff0000, v97
v_mfma_f32_16x16x32_bf16 v[40:43], v[248:251], a[92:95], v[40:43]
ds_read_b64_tr_b16 v[174:175], v11 offset:59392
ds_read_b64_tr_b16 v[176:177], v8 offset:61440
v_and_b32 v115, 0xffff0000, v105
v_mfma_f32_16x16x32_bf16 v[40:43], v[232:235], a[88:91], v[40:43]
ds_read_b64_tr_b16 v[178:179], v8 offset:63488
ds_read_b64_tr_b16 v[180:181], v9 offset:61440
v_mul_f32 v67, v67, v113
v_mfma_f32_16x16x32_bf16 v[40:43], v[216:219], a[84:87], v[40:43]
buffer_load_dwordx4 a[24:27], v1, s[44:47], s69 offen offset:2048 sc1
v_mul_f32 v67, v67, v115
v_mfma_f32_16x16x32_bf16 v[40:43], v[200:203], a[80:83], v[40:43]
ds_read_b64_tr_b16 v[182:183], v9 offset:63488
ds_read_b64_tr_b16 v[184:185], v10 offset:61440
v_lshlrev_b32 v68, 16, v98
v_mfma_f32_16x16x32_bf16 v[44:47], v[204:207], a[80:83], v[44:47]
ds_read_b64_tr_b16 v[186:187], v10 offset:63488
ds_read_b64_tr_b16 v[188:189], v11 offset:61440
v_lshlrev_b32 v114, 16, v106
v_mfma_f32_16x16x32_bf16 v[44:47], v[220:223], a[84:87], v[44:47]
buffer_load_dwordx4 a[28:31], v1, s[44:47], s69 offen offset:3072 sc1
v_mul_f32 v68, v68, v113
v_mfma_f32_16x16x32_bf16 v[44:47], v[236:239], a[88:91], v[44:47]
s_add_u32 s71, s61, 1
ds_read_b64_tr_b16 v[190:191], v11 offset:63488
v_mul_f32 v68, v68, v114
v_mfma_f32_16x16x32_bf16 v[44:47], v[252:255], a[92:95], v[44:47]
s_and_b32 s71, s71, 3
v_and_b32 v69, 0xffff0000, v98
v_mfma_f32_16x16x32_bf16 v[28:31], v[252:255], a[76:79], v[28:31]
s_add_u32 s71, s71, s79
s_lshl_b32 s71, s71, 18
s_add_u32 s71, s71, s94
s_add_u32 m0, s77, 16384
s_add_u32 s72, s71, 0
buffer_load_dwordx4 v15, s[24:27], s72 offen lds
v_mfma_f32_16x16x32_bf16 v[28:31], v[236:239], a[72:75], v[28:31]
s_add_u32 s72, s71, 15360
v_and_b32 v115, 0xffff0000, v106
v_mfma_f32_16x16x32_bf16 v[28:31], v[220:223], a[68:71], v[28:31]
s_waitcnt vmcnt(9) lgkmcnt(0)
buffer_load_dwordx4 v15, s[24:27], s72 offen offset:1024 lds
v_mul_f32 v69, v69, v113
v_mfma_f32_16x16x32_bf16 v[28:31], v[204:207], a[64:67], v[28:31]
s_barrier
v_mul_f32 v69, v69, v115
v_mfma_f32_16x16x32_bf16 v[16:19], v[128:131], a[96:99], v[16:19]
s_add_u32 s72, s71, 30720
ds_read_b64_tr_b16 v[192:193], v8 offset:0
ds_read_b64_tr_b16 v[194:195], v8 offset:2048
v_lshlrev_b32 v70, 16, v99
v_mfma_f32_16x16x32_bf16 v[16:19], v[144:147], a[100:103], v[16:19]
buffer_load_dwordx4 v15, s[24:27], s72 offen offset:2048 lds
v_lshlrev_b32 v114, 16, v107
v_mfma_f32_16x16x32_bf16 v[16:19], v[160:163], a[104:107], v[16:19]
s_add_u32 s72, s71, 46080
ds_read_b64_tr_b16 v[196:197], v9 offset:0
ds_read_b64_tr_b16 v[198:199], v9 offset:2048
v_mul_f32 v70, v70, v113
v_mfma_f32_16x16x32_bf16 v[16:19], v[176:179], a[108:111], v[16:19]
ds_read_b64_tr_b16 v[200:201], v10 offset:0
ds_read_b64_tr_b16 v[202:203], v10 offset:2048
v_mul_f32 v70, v70, v114
v_mfma_f32_16x16x32_bf16 v[32:35], v[176:179], a[124:127], v[32:35]
buffer_load_dwordx4 v15, s[24:27], s72 offen offset:3072 lds
v_and_b32 v71, 0xffff0000, v99
v_mfma_f32_16x16x32_bf16 v[32:35], v[160:163], a[120:123], v[32:35]
s_add_u32 s69, s61, 1
ds_read_b64_tr_b16 v[204:205], v11 offset:0
ds_read_b64_tr_b16 v[206:207], v11 offset:2048
v_and_b32 v115, 0xffff0000, v107
v_mfma_f32_16x16x32_bf16 v[32:35], v[144:147], a[116:119], v[32:35]
s_and_b32 s69, s69, 3
ds_read_b64_tr_b16 v[208:209], v8 offset:4096
ds_read_b64_tr_b16 v[210:211], v8 offset:6144
v_mul_f32 v71, v71, v113
v_mfma_f32_16x16x32_bf16 v[32:35], v[128:131], a[112:115], v[32:35]
s_add_u32 s69, s69, s79
s_lshl_b32 s69, s69, 12
s_add_u32 s69, s69, s95
buffer_load_dwordx4 a[32:35], v1, s[44:47], s69 offen sc1
v_mfma_f32_16x16x32_bf16 v[36:39], v[132:135], a[112:115], v[36:39]
ds_read_b64_tr_b16 v[212:213], v9 offset:4096
ds_read_b64_tr_b16 v[214:215], v9 offset:6144
v_mul_f32 v71, v71, v115
v_mfma_f32_16x16x32_bf16 v[36:39], v[148:151], a[116:119], v[36:39]
buffer_load_dwordx4 a[36:39], v1, s[44:47], s69 offen offset:1024 sc1
v_lshlrev_b32 v72, 16, v100
v_mfma_f32_16x16x32_bf16 v[36:39], v[164:167], a[120:123], v[36:39]
ds_read_b64_tr_b16 v[216:217], v10 offset:4096
ds_read_b64_tr_b16 v[218:219], v10 offset:6144
v_lshlrev_b32 v114, 16, v108
v_mfma_f32_16x16x32_bf16 v[36:39], v[180:183], a[124:127], v[36:39]
ds_read_b64_tr_b16 v[220:221], v11 offset:4096
ds_read_b64_tr_b16 v[222:223], v11 offset:6144
v_mul_f32 v72, v72, v113
v_mfma_f32_16x16x32_bf16 v[20:23], v[180:183], a[108:111], v[20:23]
buffer_load_dwordx4 a[40:43], v1, s[44:47], s69 offen offset:2048 sc1
v_mul_f32 v72, v72, v114
v_mfma_f32_16x16x32_bf16 v[20:23], v[164:167], a[104:107], v[20:23]
ds_read_b64_tr_b16 v[224:225], v8 offset:8192
v_and_b32 v73, 0xffff0000, v100
v_mfma_f32_16x16x32_bf16 v[20:23], v[148:151], a[100:103], v[20:23]
ds_read_b64_tr_b16 v[226:227], v8 offset:10240
ds_read_b64_tr_b16 v[228:229], v9 offset:8192
v_and_b32 v115, 0xffff0000, v108
v_mfma_f32_16x16x32_bf16 v[20:23], v[132:135], a[96:99], v[20:23]
buffer_load_dwordx4 a[44:47], v1, s[44:47], s69 offen offset:3072 sc1
v_mul_f32 v73, v73, v113
v_mfma_f32_16x16x32_bf16 v[24:27], v[136:139], a[96:99], v[24:27]
s_add_u32 s69, s69, 0x20000
ds_read_b64_tr_b16 v[230:231], v9 offset:10240
ds_read_b64_tr_b16 v[232:233], v10 offset:8192
v_mul_f32 v73, v73, v115
v_mfma_f32_16x16x32_bf16 v[24:27], v[152:155], a[100:103], v[24:27]
ds_read_b64_tr_b16 v[234:235], v10 offset:10240
ds_read_b64_tr_b16 v[236:237], v11 offset:8192
v_lshlrev_b32 v74, 16, v101
v_mfma_f32_16x16x32_bf16 v[24:27], v[168:171], a[104:107], v[24:27]
buffer_load_dwordx4 a[48:51], v1, s[44:47], s69 offen sc1
v_lshlrev_b32 v114, 16, v109
v_mfma_f32_16x16x32_bf16 v[24:27], v[184:187], a[108:111], v[24:27]
ds_read_b64_tr_b16 v[238:239], v11 offset:10240
ds_read_b64_tr_b16 v[240:241], v8 offset:12288
v_mul_f32 v74, v74, v113
v_mfma_f32_16x16x32_bf16 v[40:43], v[184:187], a[124:127], v[40:43]
ds_read_b64_tr_b16 v[242:243], v8 offset:14336
ds_read_b64_tr_b16 v[244:245], v9 offset:12288
v_mul_f32 v74, v74, v114
v_mfma_f32_16x16x32_bf16 v[40:43], v[168:171], a[120:123], v[40:43]
buffer_load_dwordx4 a[52:55], v1, s[44:47], s69 offen offset:1024 sc1
v_and_b32 v75, 0xffff0000, v101
v_mfma_f32_16x16x32_bf16 v[40:43], v[152:155], a[116:119], v[40:43]
ds_read_b64_tr_b16 v[246:247], v9 offset:14336
ds_read_b64_tr_b16 v[248:249], v10 offset:12288
v_and_b32 v115, 0xffff0000, v109
v_mfma_f32_16x16x32_bf16 v[40:43], v[136:139], a[112:115], v[40:43]
buffer_load_dwordx4 a[56:59], v1, s[44:47], s69 offen offset:2048 sc1
v_mul_f32 v75, v75, v113
v_mfma_f32_16x16x32_bf16 v[44:47], v[140:143], a[112:115], v[44:47]
ds_read_b64_tr_b16 v[250:251], v10 offset:14336
ds_read_b64_tr_b16 v[252:253], v11 offset:12288
v_mul_f32 v75, v75, v115
v_mfma_f32_16x16x32_bf16 v[44:47], v[156:159], a[116:119], v[44:47]
ds_read_b64_tr_b16 v[254:255], v11 offset:14336
v_lshlrev_b32 v76, 16, v102
v_mfma_f32_16x16x32_bf16 v[44:47], v[172:175], a[120:123], v[44:47]
buffer_load_dwordx4 a[60:63], v1, s[44:47], s69 offen offset:3072 sc1
v_lshlrev_b32 v114, 16, v110
v_mfma_f32_16x16x32_bf16 v[44:47], v[188:191], a[124:127], v[44:47]
s_add_u32 s71, s61, 2
v_mul_f32 v76, v76, v113
v_mfma_f32_16x16x32_bf16 v[28:31], v[188:191], a[108:111], v[28:31]
s_and_b32 s71, s71, 3
v_mul_f32 v76, v76, v114
v_mfma_f32_16x16x32_bf16 v[28:31], v[172:175], a[104:107], v[28:31]
s_add_u32 s71, s71, s79
s_lshl_b32 s71, s71, 18
s_add_u32 s71, s71, s94
s_add_u32 m0, s77, 32768
s_add_u32 s72, s71, 0
buffer_load_dwordx4 v15, s[24:27], s72 offen lds
v_mfma_f32_16x16x32_bf16 v[28:31], v[156:159], a[100:103], v[28:31]
s_waitcnt vmcnt(9) lgkmcnt(0)
v_and_b32 v77, 0xffff0000, v102
v_mfma_f32_16x16x32_bf16 v[28:31], v[140:143], a[96:99], v[28:31]
s_barrier
v_and_b32 v115, 0xffff0000, v110
v_mfma_f32_16x16x32_bf16 v[16:19], v[192:195], a[0:3], v[16:19]
s_add_u32 s72, s71, 15360
buffer_load_dwordx4 v15, s[24:27], s72 offen offset:1024 lds
v_mul_f32 v77, v77, v113
v_mfma_f32_16x16x32_bf16 v[16:19], v[208:211], a[4:7], v[16:19]
s_add_u32 s72, s71, 30720
ds_read_b64_tr_b16 v[128:129], v8 offset:16384
ds_read_b64_tr_b16 v[130:131], v8 offset:18432
v_mul_f32 v77, v77, v115
v_mfma_f32_16x16x32_bf16 v[16:19], v[224:227], a[8:11], v[16:19]
buffer_load_dwordx4 v15, s[24:27], s72 offen offset:2048 lds
v_lshlrev_b32 v78, 16, v103
v_mfma_f32_16x16x32_bf16 v[16:19], v[240:243], a[12:15], v[16:19]
s_add_u32 s72, s71, 46080
ds_read_b64_tr_b16 v[132:133], v9 offset:16384
ds_read_b64_tr_b16 v[134:135], v9 offset:18432
v_lshlrev_b32 v114, 16, v111
v_mfma_f32_16x16x32_bf16 v[32:35], v[240:243], a[28:31], v[32:35]
ds_read_b64_tr_b16 v[136:137], v10 offset:16384
ds_read_b64_tr_b16 v[138:139], v10 offset:18432
v_mul_f32 v78, v78, v113
v_mfma_f32_16x16x32_bf16 v[32:35], v[224:227], a[24:27], v[32:35]
buffer_load_dwordx4 v15, s[24:27], s72 offen offset:3072 lds
v_mul_f32 v78, v78, v114
v_mfma_f32_16x16x32_bf16 v[32:35], v[208:211], a[20:23], v[32:35]
s_add_u32 s69, s61, 2
ds_read_b64_tr_b16 v[140:141], v11 offset:16384
ds_read_b64_tr_b16 v[142:143], v11 offset:18432
v_and_b32 v79, 0xffff0000, v103
v_mfma_f32_16x16x32_bf16 v[32:35], v[192:195], a[16:19], v[32:35]
s_and_b32 s69, s69, 3
ds_read_b64_tr_b16 v[144:145], v8 offset:20480
ds_read_b64_tr_b16 v[146:147], v8 offset:22528
v_and_b32 v115, 0xffff0000, v111
v_mfma_f32_16x16x32_bf16 v[36:39], v[196:199], a[16:19], v[36:39]
s_add_u32 s69, s69, s79
s_lshl_b32 s69, s69, 12
s_add_u32 s69, s69, s95
buffer_load_dwordx4 a[64:67], v1, s[44:47], s69 offen sc1
v_mfma_f32_16x16x32_bf16 v[36:39], v[212:215], a[20:23], v[36:39]
ds_read_b64_tr_b16 v[148:149], v9 offset:20480
ds_read_b64_tr_b16 v[150:151], v9 offset:22528
v_mul_f32 v79, v79, v113
v_mfma_f32_16x16x32_bf16 v[36:39], v[228:231], a[24:27], v[36:39]
ds_read_b64_tr_b16 v[152:153], v10 offset:20480
ds_read_b64_tr_b16 v[154:155], v10 offset:22528
v_mul_f32 v79, v79, v115
v_mfma_f32_16x16x32_bf16 v[36:39], v[244:247], a[28:31], v[36:39]
buffer_load_dwordx4 a[68:71], v1, s[44:47], s69 offen offset:1024 sc1
v_mfma_f32_16x16x32_bf16 v[20:23], v[244:247], a[12:15], v[20:23]
ds_read_b64_tr_b16 v[156:157], v11 offset:20480
ds_read_b64_tr_b16 v[158:159], v11 offset:22528
v_mfma_f32_16x16x32_bf16 v[20:23], v[228:231], a[8:11], v[20:23]
ds_read_b64_tr_b16 v[160:161], v8 offset:24576
v_mfma_f32_16x16x32_bf16 v[20:23], v[212:215], a[4:7], v[20:23]
buffer_load_dwordx4 a[72:75], v1, s[44:47], s69 offen offset:2048 sc1
v_mfma_f32_16x16x32_bf16 v[20:23], v[196:199], a[0:3], v[20:23]
ds_read_b64_tr_b16 v[162:163], v8 offset:26624
ds_read_b64_tr_b16 v[164:165], v9 offset:24576
v_mfma_f32_16x16x32_bf16 v[24:27], v[200:203], a[0:3], v[24:27]
buffer_load_dwordx4 a[76:79], v1, s[44:47], s69 offen offset:3072 sc1
v_mfma_f32_16x16x32_bf16 v[24:27], v[216:219], a[4:7], v[24:27]
s_add_u32 s69, s69, 0x20000
ds_read_b64_tr_b16 v[166:167], v9 offset:26624
ds_read_b64_tr_b16 v[168:169], v10 offset:24576
v_mfma_f32_16x16x32_bf16 v[24:27], v[232:235], a[8:11], v[24:27]
ds_read_b64_tr_b16 v[170:171], v10 offset:26624
ds_read_b64_tr_b16 v[172:173], v11 offset:24576
v_mfma_f32_16x16x32_bf16 v[24:27], v[248:251], a[12:15], v[24:27]
buffer_load_dwordx4 a[80:83], v1, s[44:47], s69 offen sc1
v_mfma_f32_16x16x32_bf16 v[40:43], v[248:251], a[28:31], v[40:43]
ds_read_b64_tr_b16 v[174:175], v11 offset:26624
ds_read_b64_tr_b16 v[176:177], v8 offset:28672
v_mfma_f32_16x16x32_bf16 v[40:43], v[232:235], a[24:27], v[40:43]
ds_read_b64_tr_b16 v[178:179], v8 offset:30720
ds_read_b64_tr_b16 v[180:181], v9 offset:28672
v_mfma_f32_16x16x32_bf16 v[40:43], v[216:219], a[20:23], v[40:43]
buffer_load_dwordx4 a[84:87], v1, s[44:47], s69 offen offset:1024 sc1
v_mfma_f32_16x16x32_bf16 v[40:43], v[200:203], a[16:19], v[40:43]
ds_read_b64_tr_b16 v[182:183], v9 offset:30720
ds_read_b64_tr_b16 v[184:185], v10 offset:28672
v_mfma_f32_16x16x32_bf16 v[44:47], v[204:207], a[16:19], v[44:47]
ds_read_b64_tr_b16 v[186:187], v10 offset:30720
ds_read_b64_tr_b16 v[188:189], v11 offset:28672
v_mfma_f32_16x16x32_bf16 v[44:47], v[220:223], a[20:23], v[44:47]
buffer_load_dwordx4 a[88:91], v1, s[44:47], s69 offen offset:2048 sc1
v_mfma_f32_16x16x32_bf16 v[44:47], v[236:239], a[24:27], v[44:47]
ds_read_b64_tr_b16 v[190:191], v11 offset:30720
v_mfma_f32_16x16x32_bf16 v[44:47], v[252:255], a[28:31], v[44:47]
buffer_load_dwordx4 a[92:95], v1, s[44:47], s69 offen offset:3072 sc1
v_mfma_f32_16x16x32_bf16 v[28:31], v[252:255], a[12:15], v[28:31]
s_add_u32 s71, s61, 3
v_mfma_f32_16x16x32_bf16 v[28:31], v[236:239], a[8:11], v[28:31]
s_and_b32 s71, s71, 3
v_mfma_f32_16x16x32_bf16 v[28:31], v[220:223], a[4:7], v[28:31]
s_waitcnt vmcnt(8) lgkmcnt(0)
s_add_u32 s71, s71, s79
s_lshl_b32 s71, s71, 18
s_add_u32 s71, s71, s94
s_add_u32 m0, s77, 49152
s_add_u32 s72, s71, 0
buffer_load_dwordx4 v15, s[24:27], s72 offen lds
v_mfma_f32_16x16x32_bf16 v[28:31], v[204:207], a[0:3], v[28:31]
s_barrier
v_mfma_f32_16x16x32_bf16 v[16:19], v[128:131], a[32:35], v[16:19]
s_add_u32 s72, s71, 15360
ds_read_b64_tr_b16 v[192:193], v8 offset:32768
ds_read_b64_tr_b16 v[194:195], v8 offset:34816
v_mfma_f32_16x16x32_bf16 v[16:19], v[144:147], a[36:39], v[16:19]
buffer_load_dwordx4 v15, s[24:27], s72 offen offset:1024 lds
v_mfma_f32_16x16x32_bf16 v[16:19], v[160:163], a[40:43], v[16:19]
s_add_u32 s72, s71, 30720
ds_read_b64_tr_b16 v[196:197], v9 offset:32768
ds_read_b64_tr_b16 v[198:199], v9 offset:34816
v_mfma_f32_16x16x32_bf16 v[16:19], v[176:179], a[44:47], v[16:19]
ds_read_b64_tr_b16 v[200:201], v10 offset:32768
ds_read_b64_tr_b16 v[202:203], v10 offset:34816
v_mfma_f32_16x16x32_bf16 v[32:35], v[176:179], a[60:63], v[32:35]
buffer_load_dwordx4 v15, s[24:27], s72 offen offset:2048 lds
v_mfma_f32_16x16x32_bf16 v[32:35], v[160:163], a[56:59], v[32:35]
s_add_u32 s72, s71, 46080
ds_read_b64_tr_b16 v[204:205], v11 offset:32768
ds_read_b64_tr_b16 v[206:207], v11 offset:34816
v_mfma_f32_16x16x32_bf16 v[32:35], v[144:147], a[52:55], v[32:35]
ds_read_b64_tr_b16 v[208:209], v8 offset:36864
ds_read_b64_tr_b16 v[210:211], v8 offset:38912
v_mfma_f32_16x16x32_bf16 v[32:35], v[128:131], a[48:51], v[32:35]
buffer_load_dwordx4 v15, s[24:27], s72 offen offset:3072 lds
v_mfma_f32_16x16x32_bf16 v[36:39], v[132:135], a[48:51], v[36:39]
s_add_u32 s69, s61, 3
ds_read_b64_tr_b16 v[212:213], v9 offset:36864
ds_read_b64_tr_b16 v[214:215], v9 offset:38912
v_mfma_f32_16x16x32_bf16 v[36:39], v[148:151], a[52:55], v[36:39]
s_and_b32 s69, s69, 3
s_add_u32 s69, s69, s79
s_lshl_b32 s69, s69, 12
s_add_u32 s69, s69, s95
buffer_load_dwordx4 a[96:99], v1, s[44:47], s69 offen sc1
v_mfma_f32_16x16x32_bf16 v[36:39], v[164:167], a[56:59], v[36:39]
ds_read_b64_tr_b16 v[216:217], v10 offset:36864
ds_read_b64_tr_b16 v[218:219], v10 offset:38912
v_mfma_f32_16x16x32_bf16 v[36:39], v[180:183], a[60:63], v[36:39]
ds_read_b64_tr_b16 v[220:221], v11 offset:36864
ds_read_b64_tr_b16 v[222:223], v11 offset:38912
v_mfma_f32_16x16x32_bf16 v[20:23], v[180:183], a[44:47], v[20:23]
buffer_load_dwordx4 a[100:103], v1, s[44:47], s69 offen offset:1024 sc1
v_mfma_f32_16x16x32_bf16 v[20:23], v[164:167], a[40:43], v[20:23]
ds_read_b64_tr_b16 v[224:225], v8 offset:40960
v_mfma_f32_16x16x32_bf16 v[20:23], v[148:151], a[36:39], v[20:23]
ds_read_b64_tr_b16 v[226:227], v8 offset:43008
ds_read_b64_tr_b16 v[228:229], v9 offset:40960
v_mfma_f32_16x16x32_bf16 v[20:23], v[132:135], a[32:35], v[20:23]
buffer_load_dwordx4 a[104:107], v1, s[44:47], s69 offen offset:2048 sc1
v_mfma_f32_16x16x32_bf16 v[24:27], v[136:139], a[32:35], v[24:27]
ds_read_b64_tr_b16 v[230:231], v9 offset:43008
ds_read_b64_tr_b16 v[232:233], v10 offset:40960
v_mfma_f32_16x16x32_bf16 v[24:27], v[152:155], a[36:39], v[24:27]
ds_read_b64_tr_b16 v[234:235], v10 offset:43008
ds_read_b64_tr_b16 v[236:237], v11 offset:40960
v_mfma_f32_16x16x32_bf16 v[24:27], v[168:171], a[40:43], v[24:27]
buffer_load_dwordx4 a[108:111], v1, s[44:47], s69 offen offset:3072 sc1
v_mfma_f32_16x16x32_bf16 v[24:27], v[184:187], a[44:47], v[24:27]
s_add_u32 s69, s69, 0x20000
ds_read_b64_tr_b16 v[238:239], v11 offset:43008
ds_read_b64_tr_b16 v[240:241], v8 offset:45056
v_mfma_f32_16x16x32_bf16 v[40:43], v[184:187], a[60:63], v[40:43]
buffer_load_dwordx4 a[112:115], v1, s[44:47], s69 offen sc1
v_mfma_f32_16x16x32_bf16 v[40:43], v[168:171], a[56:59], v[40:43]
ds_read_b64_tr_b16 v[242:243], v8 offset:47104
ds_read_b64_tr_b16 v[244:245], v9 offset:45056
v_mfma_f32_16x16x32_bf16 v[40:43], v[152:155], a[52:55], v[40:43]
ds_read_b64_tr_b16 v[246:247], v9 offset:47104
ds_read_b64_tr_b16 v[248:249], v10 offset:45056
v_mfma_f32_16x16x32_bf16 v[40:43], v[136:139], a[48:51], v[40:43]
buffer_load_dwordx4 a[116:119], v1, s[44:47], s69 offen offset:1024 sc1
v_mfma_f32_16x16x32_bf16 v[44:47], v[140:143], a[48:51], v[44:47]
ds_read_b64_tr_b16 v[250:251], v10 offset:47104
ds_read_b64_tr_b16 v[252:253], v11 offset:45056
v_mfma_f32_16x16x32_bf16 v[44:47], v[156:159], a[52:55], v[44:47]
ds_read_b64_tr_b16 v[254:255], v11 offset:47104
v_mfma_f32_16x16x32_bf16 v[44:47], v[172:175], a[56:59], v[44:47]
buffer_load_dwordx4 a[120:123], v1, s[44:47], s69 offen offset:2048 sc1
v_mfma_f32_16x16x32_bf16 v[44:47], v[188:191], a[60:63], v[44:47]
v_mfma_f32_16x16x32_bf16 v[28:31], v[188:191], a[44:47], v[28:31]
v_mfma_f32_16x16x32_bf16 v[28:31], v[172:175], a[40:43], v[28:31]
buffer_load_dwordx4 a[124:127], v1, s[44:47], s69 offen offset:3072 sc1
v_mfma_f32_16x16x32_bf16 v[28:31], v[156:159], a[36:39], v[28:31]
s_waitcnt vmcnt(8) lgkmcnt(0)
v_mfma_f32_16x16x32_bf16 v[28:31], v[140:143], a[32:35], v[28:31]
s_barrier
v_mfma_f32_16x16x32_bf16 v[16:19], v[192:195], a[64:67], v[16:19]
ds_read_b64_tr_b16 v[128:129], v8 offset:49152
ds_read_b64_tr_b16 v[130:131], v8 offset:51200
v_mfma_f32_16x16x32_bf16 v[16:19], v[208:211], a[68:71], v[16:19]
ds_read_b64_tr_b16 v[132:133], v9 offset:49152
v_mfma_f32_16x16x32_bf16 v[16:19], v[224:227], a[72:75], v[16:19]
ds_read_b64_tr_b16 v[134:135], v9 offset:51200
v_mfma_f32_16x16x32_bf16 v[16:19], v[240:243], a[76:79], v[16:19]
ds_read_b64_tr_b16 v[136:137], v10 offset:49152
v_mfma_f32_16x16x32_bf16 v[32:35], v[240:243], a[92:95], v[32:35]
ds_read_b64_tr_b16 v[138:139], v10 offset:51200
v_mfma_f32_16x16x32_bf16 v[32:35], v[224:227], a[88:91], v[32:35]
ds_read_b64_tr_b16 v[140:141], v11 offset:49152
ds_read_b64_tr_b16 v[142:143], v11 offset:51200
v_mfma_f32_16x16x32_bf16 v[32:35], v[208:211], a[84:87], v[32:35]
ds_read_b64_tr_b16 v[144:145], v8 offset:53248
v_mfma_f32_16x16x32_bf16 v[32:35], v[192:195], a[80:83], v[32:35]
ds_read_b64_tr_b16 v[146:147], v8 offset:55296
v_mfma_f32_16x16x32_bf16 v[36:39], v[196:199], a[80:83], v[36:39]
ds_read_b64_tr_b16 v[148:149], v9 offset:53248
v_mfma_f32_16x16x32_bf16 v[36:39], v[212:215], a[84:87], v[36:39]
ds_read_b64_tr_b16 v[150:151], v9 offset:55296
v_mfma_f32_16x16x32_bf16 v[36:39], v[228:231], a[88:91], v[36:39]
ds_read_b64_tr_b16 v[152:153], v10 offset:53248
ds_read_b64_tr_b16 v[154:155], v10 offset:55296
v_mfma_f32_16x16x32_bf16 v[36:39], v[244:247], a[92:95], v[36:39]
ds_read_b64_tr_b16 v[156:157], v11 offset:53248
v_mfma_f32_16x16x32_bf16 v[20:23], v[244:247], a[76:79], v[20:23]
ds_read_b64_tr_b16 v[158:159], v11 offset:55296
v_mfma_f32_16x16x32_bf16 v[20:23], v[228:231], a[72:75], v[20:23]
ds_read_b64_tr_b16 v[160:161], v8 offset:57344
v_mfma_f32_16x16x32_bf16 v[20:23], v[212:215], a[68:71], v[20:23]
ds_read_b64_tr_b16 v[162:163], v8 offset:59392
v_mfma_f32_16x16x32_bf16 v[20:23], v[196:199], a[64:67], v[20:23]
ds_read_b64_tr_b16 v[164:165], v9 offset:57344
v_mfma_f32_16x16x32_bf16 v[24:27], v[200:203], a[64:67], v[24:27]
ds_read_b64_tr_b16 v[166:167], v9 offset:59392
ds_read_b64_tr_b16 v[168:169], v10 offset:57344
v_mfma_f32_16x16x32_bf16 v[24:27], v[216:219], a[68:71], v[24:27]
ds_read_b64_tr_b16 v[170:171], v10 offset:59392
v_mfma_f32_16x16x32_bf16 v[24:27], v[232:235], a[72:75], v[24:27]
ds_read_b64_tr_b16 v[172:173], v11 offset:57344
v_mfma_f32_16x16x32_bf16 v[24:27], v[248:251], a[76:79], v[24:27]
ds_read_b64_tr_b16 v[174:175], v11 offset:59392
v_mfma_f32_16x16x32_bf16 v[40:43], v[248:251], a[92:95], v[40:43]
ds_read_b64_tr_b16 v[176:177], v8 offset:61440
v_mfma_f32_16x16x32_bf16 v[40:43], v[232:235], a[88:91], v[40:43]
ds_read_b64_tr_b16 v[178:179], v8 offset:63488
ds_read_b64_tr_b16 v[180:181], v9 offset:61440
v_mfma_f32_16x16x32_bf16 v[40:43], v[216:219], a[84:87], v[40:43]
ds_read_b64_tr_b16 v[182:183], v9 offset:63488
v_mfma_f32_16x16x32_bf16 v[40:43], v[200:203], a[80:83], v[40:43]
ds_read_b64_tr_b16 v[184:185], v10 offset:61440
v_mfma_f32_16x16x32_bf16 v[44:47], v[204:207], a[80:83], v[44:47]
ds_read_b64_tr_b16 v[186:187], v10 offset:63488
v_mfma_f32_16x16x32_bf16 v[44:47], v[220:223], a[84:87], v[44:47]
ds_read_b64_tr_b16 v[188:189], v11 offset:61440
v_mfma_f32_16x16x32_bf16 v[44:47], v[236:239], a[88:91], v[44:47]
ds_read_b64_tr_b16 v[190:191], v11 offset:63488
v_mfma_f32_16x16x32_bf16 v[44:47], v[252:255], a[92:95], v[44:47]
v_mfma_f32_16x16x32_bf16 v[28:31], v[252:255], a[76:79], v[28:31]
v_mfma_f32_16x16x32_bf16 v[28:31], v[236:239], a[72:75], v[28:31]
v_mfma_f32_16x16x32_bf16 v[28:31], v[220:223], a[68:71], v[28:31]
s_waitcnt vmcnt(0) lgkmcnt(0)
v_mfma_f32_16x16x32_bf16 v[28:31], v[204:207], a[64:67], v[28:31]
v_mfma_f32_16x16x32_bf16 v[16:19], v[128:131], a[96:99], v[16:19]
v_mfma_f32_16x16x32_bf16 v[16:19], v[144:147], a[100:103], v[16:19]
v_mfma_f32_16x16x32_bf16 v[16:19], v[160:163], a[104:107], v[16:19]
v_mfma_f32_16x16x32_bf16 v[16:19], v[176:179], a[108:111], v[16:19]
v_mfma_f32_16x16x32_bf16 v[32:35], v[176:179], a[124:127], v[32:35]
v_mfma_f32_16x16x32_bf16 v[32:35], v[160:163], a[120:123], v[32:35]
v_mfma_f32_16x16x32_bf16 v[32:35], v[144:147], a[116:119], v[32:35]
v_mfma_f32_16x16x32_bf16 v[32:35], v[128:131], a[112:115], v[32:35]
s_nop 3
v_fma_f32 v48, v16, v6, v48
v_fma_f32 v49, v17, v6, v49
v_mfma_f32_16x16x32_bf16 v[36:39], v[132:135], a[112:115], v[36:39]
v_fma_f32 v50, v18, v6, v50
v_fma_f32 v51, v19, v6, v51
v_mfma_f32_16x16x32_bf16 v[36:39], v[148:151], a[116:119], v[36:39]
v_cvt_pk_bf16_f32 v48, v48, v49
v_cvt_pk_bf16_f32 v49, v50, v51
v_mfma_f32_16x16x32_bf16 v[36:39], v[164:167], a[120:123], v[36:39]
ds_write_b64 v116, v[48:49] offset:0
v_mfma_f32_16x16x32_bf16 v[36:39], v[180:183], a[124:127], v[36:39]
v_fma_f32 v64, v32, v7, v64
v_fma_f32 v65, v33, v7, v65
v_mfma_f32_16x16x32_bf16 v[20:23], v[180:183], a[108:111], v[20:23]
v_fma_f32 v66, v34, v7, v66
v_fma_f32 v67, v35, v7, v67
v_mfma_f32_16x16x32_bf16 v[20:23], v[164:167], a[104:107], v[20:23]
v_cvt_pk_bf16_f32 v64, v64, v65
v_cvt_pk_bf16_f32 v65, v66, v67
v_mfma_f32_16x16x32_bf16 v[20:23], v[148:151], a[100:103], v[20:23]
ds_write_b64 v116, v[64:65] offset:2048
v_mfma_f32_16x16x32_bf16 v[20:23], v[132:135], a[96:99], v[20:23]
v_fma_f32 v68, v36, v7, v68
v_fma_f32 v69, v37, v7, v69
v_mfma_f32_16x16x32_bf16 v[24:27], v[136:139], a[96:99], v[24:27]
v_fma_f32 v70, v38, v7, v70
v_fma_f32 v71, v39, v7, v71
v_mfma_f32_16x16x32_bf16 v[24:27], v[152:155], a[100:103], v[24:27]
v_cvt_pk_bf16_f32 v68, v68, v69
v_cvt_pk_bf16_f32 v69, v70, v71
v_mfma_f32_16x16x32_bf16 v[24:27], v[168:171], a[104:107], v[24:27]
ds_write_b64 v117, v[68:69] offset:2048
v_mfma_f32_16x16x32_bf16 v[24:27], v[184:187], a[108:111], v[24:27]
v_fma_f32 v52, v20, v6, v52
v_fma_f32 v53, v21, v6, v53
v_mfma_f32_16x16x32_bf16 v[40:43], v[184:187], a[124:127], v[40:43]
v_fma_f32 v54, v22, v6, v54
v_fma_f32 v55, v23, v6, v55
v_mfma_f32_16x16x32_bf16 v[40:43], v[168:171], a[120:123], v[40:43]
v_cvt_pk_bf16_f32 v52, v52, v53
v_cvt_pk_bf16_f32 v53, v54, v55
v_mfma_f32_16x16x32_bf16 v[40:43], v[152:155], a[116:119], v[40:43]
ds_write_b64 v117, v[52:53] offset:0
v_mfma_f32_16x16x32_bf16 v[40:43], v[136:139], a[112:115], v[40:43]
v_fma_f32 v56, v24, v6, v56
v_fma_f32 v57, v25, v6, v57
v_mfma_f32_16x16x32_bf16 v[44:47], v[140:143], a[112:115], v[44:47]
v_fma_f32 v58, v26, v6, v58
v_fma_f32 v59, v27, v6, v59
v_mfma_f32_16x16x32_bf16 v[44:47], v[156:159], a[116:119], v[44:47]
v_cvt_pk_bf16_f32 v56, v56, v57
v_cvt_pk_bf16_f32 v57, v58, v59
v_mfma_f32_16x16x32_bf16 v[44:47], v[172:175], a[120:123], v[44:47]
ds_write_b64 v118, v[56:57] offset:0
v_mfma_f32_16x16x32_bf16 v[44:47], v[188:191], a[124:127], v[44:47]
v_fma_f32 v72, v40, v7, v72
v_fma_f32 v73, v41, v7, v73
v_mfma_f32_16x16x32_bf16 v[28:31], v[188:191], a[108:111], v[28:31]
v_fma_f32 v74, v42, v7, v74
v_fma_f32 v75, v43, v7, v75
v_mfma_f32_16x16x32_bf16 v[28:31], v[172:175], a[104:107], v[28:31]
v_cvt_pk_bf16_f32 v72, v72, v73
v_cvt_pk_bf16_f32 v73, v74, v75
v_mfma_f32_16x16x32_bf16 v[28:31], v[156:159], a[100:103], v[28:31]
ds_write_b64 v118, v[72:73] offset:2048
v_mfma_f32_16x16x32_bf16 v[28:31], v[140:143], a[96:99], v[28:31]
v_fma_f32 v76, v44, v7, v76
v_fma_f32 v77, v45, v7, v77
v_fma_f32 v78, v46, v7, v78
v_fma_f32 v79, v47, v7, v79
v_cvt_pk_bf16_f32 v76, v76, v77
v_cvt_pk_bf16_f32 v77, v78, v79
ds_write_b64 v119, v[76:77] offset:2048
s_nop 0
v_fma_f32 v60, v28, v6, v60
v_fma_f32 v61, v29, v6, v61
v_fma_f32 v62, v30, v6, v62
v_fma_f32 v63, v31, v6, v63
v_cvt_pk_bf16_f32 v60, v60, v61
v_cvt_pk_bf16_f32 v61, v62, v63
ds_write_b64 v119, v[60:61] offset:0
ds_read_b128 v[80:83], v120 offset:0
ds_read_b128 v[84:87], v120 offset:1024
ds_read_b128 v[96:99], v120 offset:2048
ds_read_b128 v[100:103], v120 offset:3072
s_waitcnt lgkmcnt(3)
buffer_store_dwordx4 v[80:83], v15, s[40:43], s70 offen sc1
s_add_u32 s70, s70, 0x4000
s_waitcnt lgkmcnt(2)
buffer_store_dwordx4 v[84:87], v15, s[40:43], s70 offen sc1
s_add_u32 s70, s70, 0x4000
s_waitcnt lgkmcnt(1)
buffer_store_dwordx4 v[96:99], v15, s[40:43], s70 offen sc1
s_add_u32 s70, s70, 0x4000
s_waitcnt lgkmcnt(0)
buffer_store_dwordx4 v[100:103], v15, s[40:43], s70 offen sc1
s_add_u32 s70, s70, 0x4000
Lend:
s_endpgm
Lspin1:
s_mov_b32 s83, 262144
Lsl3:
s_sleep 2
buffer_load_dword v3, v2, s[48:51], 0 offen sc1
s_sub_u32 s83, s83, 1
s_cmp_eq_u32 s83, 0
s_waitcnt vmcnt(0)
s_cbranch_scc1 Lback2
v_cmp_gt_u32 vcc, 8, v3
s_cbranch_vccnz Lsl3
s_branch Lback2
Lspin4:
s_mov_b32 s83, 262144
Lsl6:
s_sleep 2
buffer_load_dword v3, v2, s[44:47], s75 offen sc1
s_sub_u32 s83, s83, 1
s_cmp_eq_u32 s83, 0
s_waitcnt vmcnt(0)
s_cbranch_scc1 Lback5
v_cmp_gt_u32 vcc, 1, v3
s_cbranch_vccnz Lsl6
s_branch Lback5
LLT3x:
s_cmp_eq_u32 s58, 3
s_cbranch_scc1 Ltri40
v_mfma_f32_16x16x32_bf16 v[160:163], a[160:163], v[16:19], v[112:115]
s_xor_b32 s74, s82, 0x10000
v_exp_f32 v128, v128
v_mfma_f32_16x16x32_bf16 v[164:167], a[160:163], v[32:35], v[112:115]
s_add_u32 s74, s74, s64
ds_read_b128 a[128:131], v2 offset:16384
v_mfma_f32_16x16x32_bf16 v[176:179], a[176:179], v[16:19], v[112:115]
s_add_u32 s81, s81, 0x8000
v_exp_f32 v129, v129
v_mfma_f32_16x16x32_bf16 v[180:183], a[176:179], v[32:35], v[112:115]
s_add_u32 m0, s74, 0
v_exp_f32 v130, v130
s_branch Ljoin41
Lalt39:
Ltri40:
v_mfma_f32_16x16x32_bf16 v[160:163], a[160:163], v[16:19], v[96:99]
s_xor_b32 s74, s82, 0x10000
v_exp_f32 v128, v128
v_mfma_f32_16x16x32_bf16 v[164:167], a[160:163], v[32:35], v[84:87]
s_add_u32 s74, s74, s64
ds_read_b128 a[128:131], v2 offset:16384
v_mfma_f32_16x16x32_bf16 v[176:179], a[176:179], v[16:19], v[112:115]
s_add_u32 s81, s81, 0x8000
v_exp_f32 v129, v129
v_mfma_f32_16x16x32_bf16 v[180:183], a[176:179], v[32:35], v[100:103]
s_add_u32 m0, s74, 0
v_exp_f32 v130, v130
Ljoin41:
v_mfma_f32_16x16x32_bf16 v[160:163], a[164:167], v[20:23], v[160:163]
s_add_u32 s72, s81, 0
ds_read_b128 a[132:135], v2 offset:17408
v_cvt_pk_bf16_f32 v192, v128, v129
v_mfma_f32_16x16x32_bf16 v[160:163], a[168:171], v[24:27], v[160:163]
s_and_b32 s73, s58, 1
v_exp_f32 v131, v131
v_mfma_f32_16x16x32_bf16 v[160:163], a[172:175], v[28:31], v[160:163]
s_lshl_b32 s73, s73, 4
v_exp_f32 v144, v144
v_mfma_f32_16x16x32_bf16 v[164:167], a[172:175], v[44:47], v[164:167]
s_lshr_b32 s73, s90, s73
ds_read_b128 a[136:139], v2 offset:18432
v_cvt_pk_bf16_f32 v193, v130, v131
v_mfma_f32_16x16x32_bf16 v[164:167], a[168:171], v[40:43], v[164:167]
s_and_b32 s73, s73, 0xffff
buffer_load_dwordx4 v1, s[44:47], s72 offen sc1 lds
v_mfma_f32_16x16x32_bf16 v[164:167], a[164:167], v[36:39], v[164:167]
v_exp_f32 v145, v145
v_mfma_f32_16x16x32_bf16 v[168:171], a[160:163], v[48:51], v[88:91]
v_exp_f32 v146, v146
v_mfma_f32_16x16x32_bf16 v[168:171], a[164:167], v[52:55], v[168:171]
ds_read_b128 a[140:143], v2 offset:19456
v_cvt_pk_bf16_f32 v194, v144, v145
v_mfma_f32_16x16x32_bf16 v[168:171], a[168:171], v[56:59], v[168:171]
v_exp_f32 v147, v147
v_mfma_f32_16x16x32_bf16 v[168:171], a[172:175], v[60:63], v[168:171]
v_exp_f32 v132, v132
v_mfma_f32_16x16x32_bf16 v[172:175], a[172:175], v[76:79], v[92:95]
ds_read_b128 a[144:147], v2 offset:20480
v_cvt_pk_bf16_f32 v195, v146, v147
v_mfma_f32_16x16x32_bf16 v[172:175], a[168:171], v[72:75], v[172:175]
v_exp_f32 v133, v133
v_mfma_f32_16x16x32_bf16 v[172:175], a[164:167], v[68:71], v[172:175]
v_exp_f32 v134, v134
v_mfma_f32_16x16x32_bf16 v[172:175], a[160:163], v[64:67], v[172:175]
ds_read_b128 a[148:151], v2 offset:21504
v_cvt_pk_bf16_f32 v196, v132, v133
v_mfma_f32_16x16x32_bf16 v[188:191], a[176:179], v[64:67], v[92:95]
v_exp_f32 v135, v135
v_mfma_f32_16x16x32_bf16 v[188:191], a[180:183], v[68:71], v[188:191]
v_exp_f32 v148, v148
v_mfma_f32_16x16x32_bf16 v[188:191], a[184:187], v[72:75], v[188:191]
ds_read_b128 a[152:155], v2 offset:22528
v_cvt_pk_bf16_f32 v197, v134, v135
v_mfma_f32_16x16x32_bf16 v[188:191], a[188:191], v[76:79], v[188:191]
buffer_load_dwordx4 v1, s[44:47], s72 offen offset:1024 sc1 lds
v_mfma_f32_16x16x32_bf16 v[184:187], a[188:191], v[60:63], v[88:91]
v_exp_f32 v149, v149
v_mfma_f32_16x16x32_bf16 v[184:187], a[184:187], v[56:59], v[184:187]
v_exp_f32 v150, v150
v_mfma_f32_16x16x32_bf16 v[184:187], a[180:183], v[52:55], v[184:187]
ds_read_b128 a[156:159], v2 offset:23552
v_cvt_pk_bf16_f32 v198, v148, v149
v_mfma_f32_16x16x32_bf16 v[184:187], a[176:179], v[48:51], v[184:187]
v_exp_f32 v151, v151
v_mfma_f32_16x16x32_bf16 v[180:183], a[180:183], v[36:39], v[180:183]
v_exp_f32 v136, v136
v_mfma_f32_16x16x32_bf16 v[180:183], a[184:187], v[40:43], v[180:183]
ds_read_b128 a[192:195], v2 offset:0
v_cvt_pk_bf16_f32 v199, v150, v151
v_mfma_f32_16x16x32_bf16 v[180:183], a[188:191], v[44:47], v[180:183]
v_exp_f32 v137, v137
v_mfma_f32_16x16x32_bf16 v[176:179], a[188:191], v[28:31], v[176:179]
v_exp_f32 v138, v138
v_mfma_f32_16x16x32_bf16 v[176:179], a[184:187], v[24:27], v[176:179]
ds_read_b128 a[196:199], v2 offset:1024
v_cvt_pk_bf16_f32 v200, v136, v137
v_mfma_f32_16x16x32_bf16 v[176:179], a[180:183], v[20:23], v[176:179]
s_waitcnt lgkmcnt(10)
v_exp_f32 v139, v139
v_mfma_f32_16x16x32_bf16 a[0:3], a[224:227], v[208:211], a[0:3]
v_exp_f32 v152, v152
v_mfma_f32_16x16x32_bf16 a[32:35], a[224:227], v[212:215], a[32:35]
ds_read_b128 a[200:203], v2 offset:2048
v_cvt_pk_bf16_f32 v201, v138, v139
v_mfma_f32_16x16x32_bf16 a[64:67], a[224:227], v[216:219], a[64:67]
buffer_load_dwordx4 v1, s[44:47], s72 offen offset:2048 sc1 lds
v_mfma_f32_16x16x32_bf16 a[96:99], a[224:227], v[220:223], a[96:99]
v_exp_f32 v153, v153
v_mfma_f32_16x16x32_bf16 a[100:103], a[228:231], v[220:223], a[100:103]
v_exp_f32 v154, v154
v_mfma_f32_16x16x32_bf16 a[68:71], a[228:231], v[216:219], a[68:71]
ds_read_b128 a[204:207], v2 offset:3072
v_cvt_pk_bf16_f32 v202, v152, v153
v_mfma_f32_16x16x32_bf16 a[36:39], a[228:231], v[212:215], a[36:39]
v_exp_f32 v155, v155
v_mfma_f32_16x16x32_bf16 a[4:7], a[228:231], v[208:211], a[4:7]
v_exp_f32 v140, v140
v_mfma_f32_16x16x32_bf16 a[8:11], a[232:235], v[208:211], a[8:11]
ds_read_b128 a[208:211], v2 offset:4096
v_cvt_pk_bf16_f32 v203, v154, v155
v_mfma_f32_16x16x32_bf16 a[40:43], a[232:235], v[212:215], a[40:43]
v_exp_f32 v141, v141
v_mfma_f32_16x16x32_bf16 a[72:75], a[232:235], v[216:219], a[72:75]
v_exp_f32 v142, v142
v_mfma_f32_16x16x32_bf16 a[104:107], a[232:235], v[220:223], a[104:107]
ds_read_b128 a[212:215], v2 offset:5120
v_cvt_pk_bf16_f32 v204, v140, v141
v_mfma_f32_16x16x32_bf16 a[108:111], a[236:239], v[220:223], a[108:111]
v_exp_f32 v143, v143
v_mfma_f32_16x16x32_bf16 a[76:79], a[236:239], v[216:219], a[76:79]
v_exp_f32 v156, v156
v_mfma_f32_16x16x32_bf16 a[44:47], a[236:239], v[212:215], a[44:47]
ds_read_b128 a[216:219], v2 offset:6144
v_cvt_pk_bf16_f32 v205, v142, v143
v_mfma_f32_16x16x32_bf16 a[12:15], a[236:239], v[208:211], a[12:15]
buffer_load_dwordx4 v1, s[44:47], s72 offen offset:3072 sc1 lds
v_mfma_f32_16x16x32_bf16 a[16:19], a[240:243], v[208:211], a[16:19]
v_exp_f32 v157, v157
v_mfma_f32_16x16x32_bf16 a[48:51], a[240:243], v[212:215], a[48:51]
v_exp_f32 v158, v158
v_mfma_f32_16x16x32_bf16 a[80:83], a[240:243], v[216:219], a[80:83]
ds_read_b128 a[220:223], v2 offset:7168
v_cvt_pk_bf16_f32 v206, v156, v157
v_mfma_f32_16x16x32_bf16 a[112:115], a[240:243], v[220:223], a[112:115]
v_exp_f32 v159, v159
v_mfma_f32_16x16x32_bf16 a[116:119], a[244:247], v[220:223], a[116:119]
v_cvt_pk_bf16_f32 v207, v158, v159
v_lshl_add_u32 v248, v241, 3, v240
v_mfma_f32_16x16x32_bf16 a[84:87], a[244:247], v[216:219], a[84:87]
v_sub_u32 v248, 15, v248
v_and_b32 v249, 1, v248
v_mfma_f32_16x16x32_bf16 a[52:55], a[244:247], v[212:215], a[52:55]
v_lshlrev_b32 v249, 4, v249
v_lshlrev_b32 v249, v249, s73
v_mfma_f32_16x16x32_bf16 a[20:23], a[244:247], v[208:211], a[20:23]
v_lshrrev_b32 v248, 1, v248
v_and_b32 v241, 3, v0
v_mfma_f32_16x16x32_bf16 a[24:27], a[248:251], v[208:211], a[24:27]
v_cmp_eq_u32 vcc, 0, v248
v_lshl_add_u32 v5, v241, 3, v5
v_mfma_f32_16x16x32_bf16 a[56:59], a[248:251], v[212:215], a[56:59]
v_cndmask_b32 v8, 0, v249, vcc
v_cmp_eq_u32 vcc, 1, v248
v_mfma_f32_16x16x32_bf16 a[88:91], a[248:251], v[216:219], a[88:91]
v_lshlrev_b32 v240, 4, v251
v_cndmask_b32 v9, 0, v249, vcc
v_mfma_f32_16x16x32_bf16 a[120:123], a[248:251], v[220:223], a[120:123]
v_cmp_eq_u32 vcc, 2, v248
v_sub_u32 v240, 48, v240
v_mfma_f32_16x16x32_bf16 a[124:127], a[252:255], v[220:223], a[124:127]
v_lshlrev_b64 v[12:13], 16, s[88:89]
v_cndmask_b32 v10, 0, v249, vcc
v_mfma_f32_16x16x32_bf16 a[92:95], a[252:255], v[216:219], a[92:95]
v_cmp_eq_u32 vcc, 3, v248
v_lshlrev_b64 v[12:13], v240, v[12:13]
v_mfma_f32_16x16x32_bf16 a[60:63], a[252:255], v[212:215], a[60:63]
v_cndmask_b32 v11, 0, v249, vcc
v_cmp_eq_u32 vcc, 3, v241
v_mfma_f32_16x16x32_bf16 a[28:31], a[252:255], v[208:211], a[28:31]
s_add_u32 s73, s62, 4096
v_lshl_add_u32 v14, v0, 3, s73
v_cndmask_b32 v12, 0, v12, vcc
v_mfma_f32_16x16x32_bf16 v[224:227], v[120:123], v[208:211], v[224:227]
v_cndmask_b32 v13, 0, v13, vcc
v_lshrrev_b32 v15, 4, v0
v_mfma_f32_16x16x32_bf16 v[228:231], v[120:123], v[212:215], v[228:231]
v_lshlrev_b32 v15, 1, v15
v_and_b32 v240, 7, v0
v_mfma_f32_16x16x32_bf16 v[232:235], v[120:123], v[216:219], v[232:235]
v_xor_b32 v15, v15, v240
v_lshlrev_b32 v15, 4, v15
v_mfma_f32_16x16x32_bf16 v[236:239], v[120:123], v[220:223], v[236:239]
s_waitcnt lgkmcnt(8)
s_cmp_eq_u32 s58, 0
s_cbranch_scc1 Ltri43
v_mfma_f32_16x16x32_bf16 v[136:139], a[128:131], v[48:51], v[88:91]
s_add_u32 s82, s82, 0x8000
ds_read_b128 a[160:163], v2 offset:24576
ds_read_b128 a[164:167], v2 offset:25600
v_mfma_f32_16x16x32_bf16 v[140:143], a[128:131], v[64:67], v[92:95]
s_and_b32 s82, s82, 0x1ffff
v_exp_f32 v160, v160
v_mfma_f32_16x16x32_bf16 v[152:155], a[144:147], v[48:51], v[88:91]
s_add_u32 m0, s66, 32
v_exp_f32 v161, v161
v_mfma_f32_16x16x32_bf16 v[156:159], a[144:147], v[64:67], v[92:95]
s_add_u32 s72, s93, 0x2
v_exp_f32 v162, v162
s_branch Ljoin44
Ltri43:
v_mfma_f32_16x16x32_bf16 v[136:139], a[128:131], v[48:51], v[104:107]
s_add_u32 s82, s82, 0x8000
ds_read_b128 a[160:163], v2 offset:24576
ds_read_b128 a[164:167], v2 offset:25600
v_mfma_f32_16x16x32_bf16 v[140:143], a[128:131], v[64:67], v[92:95]
s_and_b32 s82, s82, 0x1ffff
v_exp_f32 v160, v160
v_mfma_f32_16x16x32_bf16 v[152:155], a[144:147], v[48:51], v[112:115]
s_add_u32 m0, s66, 32
v_exp_f32 v161, v161
v_mfma_f32_16x16x32_bf16 v[156:159], a[144:147], v[64:67], v[108:111]
s_add_u32 s72, s93, 0x2
v_exp_f32 v162, v162
Ljoin44:
v_mfma_f32_16x16x32_bf16 v[136:139], a[132:135], v[52:55], v[136:139]
v_exp_f32 v163, v163
v_mfma_f32_16x16x32_bf16 v[136:139], a[136:139], v[56:59], v[136:139]
ds_read_b128 a[168:171], v2 offset:26624
v_cvt_pk_bf16_f32 v208, v160, v161
v_mfma_f32_16x16x32_bf16 v[136:139], a[140:143], v[60:63], v[136:139]
v_exp_f32 v176, v176
v_mfma_f32_16x16x32_bf16 v[140:143], a[140:143], v[76:79], v[140:143]
buffer_load_dwordx4 v1, s[36:39], s72 offen lds
v_mfma_f32_16x16x32_bf16 v[140:143], a[136:139], v[72:75], v[140:143]
v_exp_f32 v177, v177
v_mfma_f32_16x16x32_bf16 v[140:143], a[132:135], v[68:71], v[140:143]
ds_read_b128 a[172:175], v2 offset:27648
v_cvt_pk_bf16_f32 v209, v162, v163
v_mfma_f32_16x16x32_bf16 v[156:159], a[148:151], v[68:71], v[156:159]
v_exp_f32 v178, v178
v_mfma_f32_16x16x32_bf16 v[156:159], a[152:155], v[72:75], v[156:159]
v_exp_f32 v179, v179
v_mfma_f32_16x16x32_bf16 v[156:159], a[156:159], v[76:79], v[156:159]
ds_read_b128 a[176:179], v2 offset:28672
v_cvt_pk_bf16_f32 v210, v176, v177
v_mfma_f32_16x16x32_bf16 v[152:155], a[156:159], v[60:63], v[152:155]
v_exp_f32 v164, v164
v_mfma_f32_16x16x32_bf16 v[152:155], a[152:155], v[56:59], v[152:155]
v_exp_f32 v165, v165
v_mfma_f32_16x16x32_bf16 v[152:155], a[148:151], v[52:55], v[152:155]
s_waitcnt lgkmcnt(5)
ds_read_b128 a[180:183], v2 offset:29696
v_cvt_pk_bf16_f32 v211, v178, v179
v_mfma_f32_16x16x32_bf16 a[0:3], a[192:195], v[192:195], a[0:3]
v_exp_f32 v166, v166
v_mfma_f32_16x16x32_bf16 a[32:35], a[192:195], v[196:199], a[32:35]
v_exp_f32 v167, v167
v_mfma_f32_16x16x32_bf16 a[64:67], a[192:195], v[200:203], a[64:67]
ds_read_b128 a[184:187], v2 offset:30720
v_cvt_pk_bf16_f32 v212, v164, v165
v_mfma_f32_16x16x32_bf16 a[96:99], a[192:195], v[204:207], a[96:99]
v_exp_f32 v180, v180
v_mfma_f32_16x16x32_bf16 a[100:103], a[196:199], v[204:207], a[100:103]
buffer_load_dwordx4 v1, s[36:39], s72 offen offset:1024 lds
v_mfma_f32_16x16x32_bf16 a[68:71], a[196:199], v[200:203], a[68:71]
v_exp_f32 v181, v181
v_mfma_f32_16x16x32_bf16 a[36:39], a[196:199], v[196:199], a[36:39]
ds_read_b128 a[188:191], v2 offset:31744
v_cvt_pk_bf16_f32 v213, v166, v167
v_mfma_f32_16x16x32_bf16 a[4:7], a[196:199], v[192:195], a[4:7]
v_exp_f32 v182, v182
v_mfma_f32_16x16x32_bf16 a[8:11], a[200:203], v[192:195], a[8:11]
v_exp_f32 v183, v183
v_mfma_f32_16x16x32_bf16 a[40:43], a[200:203], v[196:199], a[40:43]
ds_read_b128 a[224:227], v2 offset:8192
v_cvt_pk_bf16_f32 v214, v180, v181
v_mfma_f32_16x16x32_bf16 a[72:75], a[200:203], v[200:203], a[72:75]
v_exp_f32 v168, v168
v_mfma_f32_16x16x32_bf16 a[104:107], a[200:203], v[204:207], a[104:107]
v_exp_f32 v169, v169
v_mfma_f32_16x16x32_bf16 a[108:111], a[204:207], v[204:207], a[108:111]
ds_read_b128 a[228:231], v2 offset:9216
v_cvt_pk_bf16_f32 v215, v182, v183
v_mfma_f32_16x16x32_bf16 a[76:79], a[204:207], v[200:203], a[76:79]
v_exp_f32 v170, v170
v_mfma_f32_16x16x32_bf16 a[44:47], a[204:207], v[196:199], a[44:47]
v_exp_f32 v171, v171
v_mfma_f32_16x16x32_bf16 a[12:15], a[204:207], v[192:195], a[12:15]
ds_read_b128 a[232:235], v2 offset:10240
v_cvt_pk_bf16_f32 v216, v168, v169
v_mfma_f32_16x16x32_bf16 a[16:19], a[208:211], v[192:195], a[16:19]
v_exp_f32 v184, v184
v_mfma_f32_16x16x32_bf16 a[48:51], a[208:211], v[196:199], a[48:51]
buffer_load_dwordx4 v1, s[36:39], s72 offen offset:2048 lds
v_mfma_f32_16x16x32_bf16 a[80:83], a[208:211], v[200:203], a[80:83]
v_exp_f32 v185, v185
v_mfma_f32_16x16x32_bf16 a[112:115], a[208:211], v[204:207], a[112:115]
ds_read_b128 a[236:239], v2 offset:11264
v_cvt_pk_bf16_f32 v217, v170, v171
v_mfma_f32_16x16x32_bf16 a[116:119], a[212:215], v[204:207], a[116:119]
v_exp_f32 v186, v186
v_mfma_f32_16x16x32_bf16 a[84:87], a[212:215], v[200:203], a[84:87]
v_exp_f32 v187, v187
v_mfma_f32_16x16x32_bf16 a[52:55], a[212:215], v[196:199], a[52:55]
ds_read_b128 a[240:243], v2 offset:12288
v_cvt_pk_bf16_f32 v218, v184, v185
v_mfma_f32_16x16x32_bf16 a[20:23], a[212:215], v[192:195], a[20:23]
v_exp_f32 v172, v172
v_mfma_f32_16x16x32_bf16 a[24:27], a[216:219], v[192:195], a[24:27]
v_exp_f32 v173, v173
v_mfma_f32_16x16x32_bf16 a[56:59], a[216:219], v[196:199], a[56:59]
ds_read_b128 a[244:247], v2 offset:13312
v_cvt_pk_bf16_f32 v219, v186, v187
v_mfma_f32_16x16x32_bf16 a[88:91], a[216:219], v[200:203], a[88:91]
v_exp_f32 v174, v174
v_mfma_f32_16x16x32_bf16 a[120:123], a[216:219], v[204:207], a[120:123]
v_exp_f32 v175, v175
v_mfma_f32_16x16x32_bf16 a[124:127], a[220:223], v[204:207], a[124:127]
ds_read_b128 a[248:251], v2 offset:14336
v_cvt_pk_bf16_f32 v220, v172, v173
v_mfma_f32_16x16x32_bf16 a[92:95], a[220:223], v[200:203], a[92:95]
v_exp_f32 v188, v188
v_mfma_f32_16x16x32_bf16 a[60:63], a[220:223], v[196:199], a[60:63]
buffer_load_dwordx4 v1, s[36:39], s72 offen offset:3072 lds
v_mfma_f32_16x16x32_bf16 a[28:31], a[220:223], v[192:195], a[28:31]
v_exp_f32 v189, v189
v_mfma_f32_16x16x32_bf16 v[224:227], v[120:123], v[192:195], v[224:227]
ds_read_b128 a[252:255], v2 offset:15360
v_cvt_pk_bf16_f32 v221, v174, v175
v_mfma_f32_16x16x32_bf16 v[228:231], v[120:123], v[196:199], v[228:231]
v_exp_f32 v190, v190
v_mfma_f32_16x16x32_bf16 v[232:235], v[120:123], v[200:203], v[232:235]
s_waitcnt vmcnt(8) lgkmcnt(0)
v_exp_f32 v191, v191
v_mfma_f32_16x16x32_bf16 v[236:239], v[120:123], v[204:207], v[236:239]
s_barrier
v_cvt_pk_bf16_f32 v222, v188, v189
v_cvt_pk_bf16_f32 v223, v190, v191
v_add_u32 v2, s82, v1
s_cmp_eq_u32 s58, 1
s_cbranch_scc1 Ltri46
s_cmp_gt_u32 s58, 1
s_cbranch_scc1 Lalt45
v_mfma_f32_16x16x32_bf16 v[168:171], a[160:163], v[48:51], v[112:115]
s_add_u32 m0, s92, 8352
v_exp_f32 v136, v136
v_mfma_f32_16x16x32_bf16 v[172:175], a[160:163], v[64:67], v[112:115]
s_add_u32 s72, s93, 0x6
ds_read_b128 a[128:131], v2 offset:16384
v_mfma_f32_16x16x32_bf16 v[184:187], a[176:179], v[48:51], v[112:115]
buffer_load_dwordx4 v1, s[36:39], s72 offen lds
v_mfma_f32_16x16x32_bf16 v[188:191], a[176:179], v[64:67], v[112:115]
v_exp_f32 v137, v137
s_branch Ljoin47
Lalt45:
v_mfma_f32_16x16x32_bf16 v[168:171], a[160:163], v[48:51], v[88:91]
s_add_u32 m0, s92, 8352
v_exp_f32 v136, v136
v_mfma_f32_16x16x32_bf16 v[172:175], a[160:163], v[64:67], v[92:95]
s_add_u32 s72, s93, 0x6
ds_read_b128 a[128:131], v2 offset:16384
v_mfma_f32_16x16x32_bf16 v[184:187], a[176:179], v[48:51], v[88:91]
buffer_load_dwordx4 v1, s[36:39], s72 offen lds
v_mfma_f32_16x16x32_bf16 v[188:191], a[176:179], v[64:67], v[92:95]
v_exp_f32 v137, v137
s_branch Ljoin47
Ltri46:
v_mfma_f32_16x16x32_bf16 v[168:171], a[160:163], v[48:51], v[104:107]
s_add_u32 m0, s92, 8352
v_exp_f32 v136, v136
v_mfma_f32_16x16x32_bf16 v[172:175], a[160:163], v[64:67], v[92:95]
s_add_u32 s72, s93, 0x6
ds_read_b128 a[128:131], v2 offset:16384
v_mfma_f32_16x16x32_bf16 v[184:187], a[176:179], v[48:51], v[112:115]
buffer_load_dwordx4 v1, s[36:39], s72 offen lds
v_mfma_f32_16x16x32_bf16 v[188:191], a[176:179], v[64:67], v[108:111]
v_exp_f32 v137, v137
Ljoin47:
v_mfma_f32_16x16x32_bf16 v[168:171], a[164:167], v[52:55], v[168:171]
ds_read_b128 a[132:135], v2 offset:17408
v_cvt_pk_bf16_f32 v200, v136, v137
v_mfma_f32_16x16x32_bf16 v[168:171], a[168:171], v[56:59], v[168:171]
v_exp_f32 v138, v138
v_mfma_f32_16x16x32_bf16 v[168:171], a[172:175], v[60:63], v[168:171]
ds_read_b128 a[136:139], v2 offset:18432
v_lshrrev_b32 v240, 3, v0
v_mfma_f32_16x16x32_bf16 v[172:175], a[172:175], v[76:79], v[172:175]
buffer_load_dwordx4 v1, s[36:39], s72 offen offset:1024 lds
v_mfma_f32_16x16x32_bf16 v[172:175], a[168:171], v[72:75], v[172:175]
v_exp_f32 v139, v139
v_mfma_f32_16x16x32_bf16 v[172:175], a[164:167], v[68:71], v[172:175]
ds_read_b128 a[140:143], v2 offset:19456
v_cvt_pk_bf16_f32 v201, v138, v139
v_mfma_f32_16x16x32_bf16 v[188:191], a[180:183], v[68:71], v[188:191]
buffer_load_dwordx4 v1, s[36:39], s72 offen offset:2048 lds
v_mfma_f32_16x16x32_bf16 v[188:191], a[184:187], v[72:75], v[188:191]
v_exp_f32 v152, v152
v_mfma_f32_16x16x32_bf16 v[188:191], a[188:191], v[76:79], v[188:191]
ds_read_b128 a[144:147], v2 offset:20480
v_lshl_add_u32 v15, v240, 11, v15
v_mfma_f32_16x16x32_bf16 v[184:187], a[188:191], v[60:63], v[184:187]
s_lshr_b32 s75, s59, 3
buffer_load_dwordx4 v1, s[36:39], s72 offen offset:3072 lds
v_mfma_f32_16x16x32_bf16 v[184:187], a[184:187], v[56:59], v[184:187]
s_add_u32 m0, s62, 0
v_exp_f32 v153, v153
v_mfma_f32_16x16x32_bf16 v[184:187], a[180:183], v[52:55], v[184:187]
s_waitcnt lgkmcnt(5)
ds_read_b128 a[148:151], v2 offset:21504
v_cvt_pk_bf16_f32 v202, v152, v153
v_mfma_f32_16x16x32_bf16 a[0:3], a[224:227], v[208:211], a[0:3]
s_add_u32 s72, s93, 0x3000000
v_exp_f32 v154, v154
v_mfma_f32_16x16x32_bf16 a[32:35], a[224:227], v[212:215], a[32:35]
s_lshl_b32 s75, s75, 2
ds_read_b128 a[152:155], v2 offset:22528
v_mfma_f32_16x16x32_bf16 a[64:67], a[224:227], v[216:219], a[64:67]
s_add_u32 s75, s75, s65
buffer_load_dwordx4 v1, s[44:47], s72 offen sc1 lds
v_mfma_f32_16x16x32_bf16 a[96:99], a[224:227], v[220:223], a[96:99]
s_lshl_b32 s76, s59, 1
v_exp_f32 v155, v155
v_mfma_f32_16x16x32_bf16 a[100:103], a[228:231], v[220:223], a[100:103]
s_and_b32 s76, s76, 8
ds_read_b128 a[156:159], v2 offset:23552
v_cvt_pk_bf16_f32 v203, v154, v155
v_mfma_f32_16x16x32_bf16 a[68:71], a[228:231], v[216:219], a[68:71]
s_add_u32 s76, s76, s60
buffer_load_dwordx4 v1, s[44:47], s72 offen offset:1024 sc1 lds
v_mfma_f32_16x16x32_bf16 a[36:39], a[228:231], v[212:215], a[36:39]
s_lshl_b32 s94, s58, 16
v_exp_f32 v140, v140
v_mfma_f32_16x16x32_bf16 a[4:7], a[228:231], v[208:211], a[4:7]
s_lshl_b32 s80, s76, 7
ds_read_b128 a[192:195], v2 offset:0
v_mfma_f32_16x16x32_bf16 a[8:11], a[232:235], v[208:211], a[8:11]
s_add_u32 s94, s94, s80
buffer_load_dwordx4 v1, s[44:47], s72 offen offset:2048 sc1 lds
v_mfma_f32_16x16x32_bf16 a[40:43], a[232:235], v[212:215], a[40:43]
s_lshl_b32 s80, s75, 18
v_exp_f32 v141, v141
v_mfma_f32_16x16x32_bf16 a[72:75], a[232:235], v[216:219], a[72:75]
s_add_u32 s80, s80, s94
ds_read_b128 a[196:199], v2 offset:1024
v_cvt_pk_bf16_f32 v204, v140, v141
v_mfma_f32_16x16x32_bf16 a[104:107], a[232:235], v[220:223], a[104:107]
v_exp_f32 v142, v142
v_mfma_f32_16x16x32_bf16 a[108:111], a[236:239], v[220:223], a[108:111]
ds_read_b128 a[200:203], v2 offset:2048
v_mfma_f32_16x16x32_bf16 a[76:79], a[236:239], v[216:219], a[76:79]
buffer_load_dwordx4 v1, s[44:47], s72 offen offset:3072 sc1 lds
v_mfma_f32_16x16x32_bf16 a[44:47], a[236:239], v[212:215], a[44:47]
s_add_u32 m0, s92, 32
v_exp_f32 v143, v143
v_mfma_f32_16x16x32_bf16 a[12:15], a[236:239], v[208:211], a[12:15]
s_add_u32 s72, s93, 0x0
ds_read_b128 a[204:207], v2 offset:3072
v_cvt_pk_bf16_f32 v205, v142, v143
v_mfma_f32_16x16x32_bf16 a[16:19], a[240:243], v[208:211], a[16:19]
buffer_load_dwordx4 v1, s[36:39], s72 offen lds
v_mfma_f32_16x16x32_bf16 a[48:51], a[240:243], v[212:215], a[48:51]
v_exp_f32 v156, v156
v_mfma_f32_16x16x32_bf16 a[80:83], a[240:243], v[216:219], a[80:83]
ds_read_b128 a[208:211], v2 offset:4096
v_mfma_f32_16x16x32_bf16 a[112:115], a[240:243], v[220:223], a[112:115]
buffer_load_dwordx4 v1, s[36:39], s72 offen offset:1024 lds
v_mfma_f32_16x16x32_bf16 a[116:119], a[244:247], v[220:223], a[116:119]
v_exp_f32 v157, v157
v_mfma_f32_16x16x32_bf16 a[84:87], a[244:247], v[216:219], a[84:87]
ds_read_b128 a[212:215], v2 offset:5120
v_cvt_pk_bf16_f32 v206, v156, v157
v_mfma_f32_16x16x32_bf16 a[52:55], a[244:247], v[212:215], a[52:55]
v_exp_f32 v158, v158
v_mfma_f32_16x16x32_bf16 a[20:23], a[244:247], v[208:211], a[20:23]
ds_read_b128 a[216:219], v2 offset:6144
v_mfma_f32_16x16x32_bf16 a[24:27], a[248:251], v[208:211], a[24:27]
buffer_load_dwordx4 v1, s[36:39], s72 offen offset:2048 lds
v_mfma_f32_16x16x32_bf16 a[56:59], a[248:251], v[212:215], a[56:59]
v_exp_f32 v159, v159
v_mfma_f32_16x16x32_bf16 a[88:91], a[248:251], v[216:219], a[88:91]
ds_read_b128 a[220:223], v2 offset:7168
v_cvt_pk_bf16_f32 v207, v158, v159
v_mfma_f32_16x16x32_bf16 a[120:123], a[248:251], v[220:223], a[120:123]
buffer_load_dwordx4 v1, s[36:39], s72 offen offset:3072 lds
v_mfma_f32_16x16x32_bf16 a[124:127], a[252:255], v[220:223], a[124:127]
v_mfma_f32_16x16x32_bf16 a[92:95], a[252:255], v[216:219], a[92:95]
v_mfma_f32_16x16x32_bf16 a[60:63], a[252:255], v[212:215], a[60:63]
v_mfma_f32_16x16x32_bf16 a[28:31], a[252:255], v[208:211], a[28:31]
v_mfma_f32_16x16x32_bf16 v[224:227], v[120:123], v[208:211], v[224:227]
v_mfma_f32_16x16x32_bf16 v[228:231], v[120:123], v[212:215], v[228:231]
v_mfma_f32_16x16x32_bf16 v[232:235], v[120:123], v[216:219], v[232:235]
v_mfma_f32_16x16x32_bf16 v[236:239], v[120:123], v[220:223], v[236:239]
s_waitcnt lgkmcnt(8)
s_nop 3
v_rcp_f32 v224, v224
v_rcp_f32 v228, v228
s_lshl_b32 s73, s59, 12
s_add_u32 s73, s73, 0x2000000
s_lshl_b32 s70, s67, 2
s_add_u32 s70, s70, s73
v_mov_b32 v225, v224
v_accvgpr_read_b32 v240, a0
v_accvgpr_read_b32 v241, a1
v_accvgpr_read_b32 v242, a2
v_accvgpr_read_b32 v243, a3
v_accvgpr_read_b32 v244, a4
v_accvgpr_read_b32 v245, a5
v_accvgpr_read_b32 v246, a6
v_accvgpr_read_b32 v247, a7
s_add_u32 m0, s92, 4192
s_add_u32 s72, s93, 0x4
buffer_load_dwordx4 v1, s[36:39], s72 offen lds
v_pk_mul_f32 v[240:241], v[240:241], v[224:225]
v_pk_mul_f32 v[242:243], v[242:243], v[224:225]
v_pk_mul_f32 v[244:245], v[244:245], v[224:225]
v_pk_mul_f32 v[246:247], v[246:247], v[224:225]
v_cvt_pk_bf16_f32 v128, v240, v241
v_cvt_pk_bf16_f32 v129, v242, v243
v_cvt_pk_bf16_f32 v130, v244, v245
v_cvt_pk_bf16_f32 v131, v246, v247
v_accvgpr_read_b32 v248, a8
v_accvgpr_read_b32 v249, a9
v_accvgpr_read_b32 v250, a10
v_accvgpr_read_b32 v251, a11
buffer_load_dwordx4 v1, s[36:39], s72 offen offset:1024 lds
v_accvgpr_read_b32 v252, a12
v_accvgpr_read_b32 v253, a13
v_accvgpr_read_b32 v254, a14
v_accvgpr_read_b32 v255, a15
v_pk_mul_f32 v[248:249], v[248:249], v[224:225]
v_pk_mul_f32 v[250:251], v[250:251], v[224:225]
v_pk_mul_f32 v[252:253], v[252:253], v[224:225]
v_pk_mul_f32 v[254:255], v[254:255], v[224:225]
v_cvt_pk_bf16_f32 v144, v248, v249
v_cvt_pk_bf16_f32 v145, v250, v251
v_cvt_pk_bf16_f32 v146, v252, v253
v_cvt_pk_bf16_f32 v147, v254, v255
v_accvgpr_read_b32 v240, a16
v_accvgpr_read_b32 v241, a17
buffer_load_dwordx4 v1, s[36:39], s72 offen offset:2048 lds
v_accvgpr_read_b32 v242, a18
v_accvgpr_read_b32 v243, a19
v_accvgpr_read_b32 v244, a20
v_accvgpr_read_b32 v245, a21
v_accvgpr_read_b32 v246, a22
v_accvgpr_read_b32 v247, a23
v_pk_mul_f32 v[240:241], v[240:241], v[224:225]
v_pk_mul_f32 v[242:243], v[242:243], v[224:225]
v_pk_mul_f32 v[244:245], v[244:245], v[224:225]
v_pk_mul_f32 v[246:247], v[246:247], v[224:225]
v_cvt_pk_bf16_f32 v160, v240, v241
v_cvt_pk_bf16_f32 v161, v242, v243
v_cvt_pk_bf16_f32 v162, v244, v245
v_cvt_pk_bf16_f32 v163, v246, v247
buffer_load_dwordx4 v1, s[36:39], s72 offen offset:3072 lds
v_accvgpr_read_b32 v248, a24
v_accvgpr_read_b32 v249, a25
v_accvgpr_read_b32 v250, a26
v_accvgpr_read_b32 v251, a27
v_accvgpr_read_b32 v252, a28
v_accvgpr_read_b32 v253, a29
v_accvgpr_read_b32 v254, a30
v_accvgpr_read_b32 v255, a31
v_pk_mul_f32 v[248:249], v[248:249], v[224:225]
v_pk_mul_f32 v[250:251], v[250:251], v[224:225]
v_pk_mul_f32 v[252:253], v[252:253], v[224:225]
v_pk_mul_f32 v[254:255], v[254:255], v[224:225]
v_cvt_pk_bf16_f32 v176, v248, v249
v_cvt_pk_bf16_f32 v177, v250, v251
buffer_load_dwordx4 v[80:83], v15, s[4:7], s80 offen
v_cvt_pk_bf16_f32 v178, v252, v253
v_cvt_pk_bf16_f32 v179, v254, v255
v_mov_b32 v229, v228
v_accvgpr_read_b32 v240, a32
v_accvgpr_read_b32 v241, a33
v_accvgpr_read_b32 v242, a34
v_accvgpr_read_b32 v243, a35
v_accvgpr_read_b32 v244, a36
v_accvgpr_read_b32 v245, a37
v_accvgpr_read_b32 v246, a38
v_accvgpr_read_b32 v247, a39
v_pk_mul_f32 v[240:241], v[240:241], v[228:229]
v_pk_mul_f32 v[242:243], v[242:243], v[228:229]
v_pk_mul_f32 v[244:245], v[244:245], v[228:229]
s_add_u32 s80, s80, 0x4000
buffer_load_dwordx4 v[84:87], v15, s[4:7], s80 offen
v_pk_mul_f32 v[246:247], v[246:247], v[228:229]
v_cvt_pk_bf16_f32 v132, v240, v241
v_cvt_pk_bf16_f32 v133, v242, v243
v_cvt_pk_bf16_f32 v134, v244, v245
v_cvt_pk_bf16_f32 v135, v246, v247
v_accvgpr_read_b32 v248, a40
v_accvgpr_read_b32 v249, a41
v_accvgpr_read_b32 v250, a42
v_accvgpr_read_b32 v251, a43
v_accvgpr_read_b32 v252, a44
v_accvgpr_read_b32 v253, a45
v_accvgpr_read_b32 v254, a46
v_accvgpr_read_b32 v255, a47
v_pk_mul_f32 v[248:249], v[248:249], v[228:229]
s_add_u32 s80, s80, 0x4000
buffer_load_dwordx4 v[96:99], v15, s[4:7], s80 offen
v_pk_mul_f32 v[250:251], v[250:251], v[228:229]
v_pk_mul_f32 v[252:253], v[252:253], v[228:229]
v_pk_mul_f32 v[254:255], v[254:255], v[228:229]
v_cvt_pk_bf16_f32 v148, v248, v249
v_cvt_pk_bf16_f32 v149, v250, v251
v_cvt_pk_bf16_f32 v150, v252, v253
v_cvt_pk_bf16_f32 v151, v254, v255
v_accvgpr_read_b32 v240, a48
v_accvgpr_read_b32 v241, a49
v_accvgpr_read_b32 v242, a50
v_accvgpr_read_b32 v243, a51
v_accvgpr_read_b32 v244, a52
v_accvgpr_read_b32 v245, a53
v_accvgpr_read_b32 v246, a54
s_add_u32 s80, s80, 0x4000
buffer_load_dwordx4 v[100:103], v15, s[4:7], s80 offen
v_accvgpr_read_b32 v247, a55
v_pk_mul_f32 v[240:241], v[240:241], v[228:229]
v_pk_mul_f32 v[242:243], v[242:243], v[228:229]
v_pk_mul_f32 v[244:245], v[244:245], v[228:229]
v_pk_mul_f32 v[246:247], v[246:247], v[228:229]
v_cvt_pk_bf16_f32 v164, v240, v241
v_cvt_pk_bf16_f32 v165, v242, v243
v_cvt_pk_bf16_f32 v166, v244, v245
v_cvt_pk_bf16_f32 v167, v246, v247
v_accvgpr_read_b32 v248, a56
v_accvgpr_read_b32 v249, a57
v_accvgpr_read_b32 v250, a58
v_accvgpr_read_b32 v251, a59
v_accvgpr_read_b32 v252, a60
v_accvgpr_read_b32 v253, a61
v_accvgpr_read_b32 v254, a62
v_accvgpr_read_b32 v255, a63
v_pk_mul_f32 v[248:249], v[248:249], v[228:229]
v_pk_mul_f32 v[250:251], v[250:251], v[228:229]
v_pk_mul_f32 v[252:253], v[252:253], v[228:229]
v_pk_mul_f32 v[254:255], v[254:255], v[228:229]
v_cvt_pk_bf16_f32 v180, v248, v249
v_cvt_pk_bf16_f32 v181, v250, v251
v_cvt_pk_bf16_f32 v182, v252, v253
v_cvt_pk_bf16_f32 v183, v254, v255
s_cmp_eq_u32 s58, 2
s_cbranch_scc1 Ltri49
s_cmp_gt_u32 s58, 2
s_cbranch_scc1 Lalt48
v_mfma_f32_16x16x32_bf16 v[136:139], a[128:131], v[48:51], v[112:115]
s_add_u32 s82, s82, 0x8000
ds_read_b128 a[160:163], v2 offset:24576
ds_read_b128 a[164:167], v2 offset:25600
v_mfma_f32_16x16x32_bf16 v[140:143], a[128:131], v[64:67], v[112:115]
s_and_b32 s82, s82, 0x1ffff
v_exp_f32 v168, v168
v_mfma_f32_16x16x32_bf16 v[152:155], a[144:147], v[48:51], v[112:115]
v_exp_f32 v169, v169
v_mfma_f32_16x16x32_bf16 v[156:159], a[144:147], v[64:67], v[112:115]
ds_read_b128 a[168:171], v2 offset:26624
v_cvt_pk_bf16_f32 v216, v168, v169
s_branch Ljoin50
Lalt48:
v_mfma_f32_16x16x32_bf16 v[136:139], a[128:131], v[48:51], v[88:91]
s_add_u32 s82, s82, 0x8000
ds_read_b128 a[160:163], v2 offset:24576
ds_read_b128 a[164:167], v2 offset:25600
v_mfma_f32_16x16x32_bf16 v[140:143], a[128:131], v[64:67], v[92:95]
s_and_b32 s82, s82, 0x1ffff
v_exp_f32 v168, v168
v_mfma_f32_16x16x32_bf16 v[152:155], a[144:147], v[48:51], v[88:91]
v_exp_f32 v169, v169
v_mfma_f32_16x16x32_bf16 v[156:159], a[144:147], v[64:67], v[92:95]
ds_read_b128 a[168:171], v2 offset:26624
v_cvt_pk_bf16_f32 v216, v168, v169
s_branch Ljoin50
Ltri49:
v_mfma_f32_16x16x32_bf16 v[136:139], a[128:131], v[48:51], v[104:107]
s_add_u32 s82, s82, 0x8000
ds_read_b128 a[160:163], v2 offset:24576
ds_read_b128 a[164:167], v2 offset:25600
v_mfma_f32_16x16x32_bf16 v[140:143], a[128:131], v[64:67], v[92:95]
s_and_b32 s82, s82, 0x1ffff
v_exp_f32 v168, v168
v_mfma_f32_16x16x32_bf16 v[152:155], a[144:147], v[48:51], v[112:115]
v_exp_f32 v169, v169
v_mfma_f32_16x16x32_bf16 v[156:159], a[144:147], v[64:67], v[108:111]
ds_read_b128 a[168:171], v2 offset:26624
v_cvt_pk_bf16_f32 v216, v168, v169
Ljoin50:
v_mfma_f32_16x16x32_bf16 v[136:139], a[132:135], v[52:55], v[136:139]
v_exp_f32 v170, v170
v_mfma_f32_16x16x32_bf16 v[136:139], a[136:139], v[56:59], v[136:139]
ds_read_b128 a[172:175], v2 offset:27648
ds_read_b128 a[176:179], v2 offset:28672
v_mfma_f32_16x16x32_bf16 v[136:139], a[140:143], v[60:63], v[136:139]
v_exp_f32 v171, v171
v_mfma_f32_16x16x32_bf16 v[140:143], a[140:143], v[76:79], v[140:143]
buffer_store_dwordx4 v[128:131], v1, s[44:47], s70 offen sc1
v_mfma_f32_16x16x32_bf16 v[140:143], a[136:139], v[72:75], v[140:143]
v_exp_f32 v184, v184
v_mfma_f32_16x16x32_bf16 v[140:143], a[132:135], v[68:71], v[140:143]
ds_read_b128 a[180:183], v2 offset:29696
v_cvt_pk_bf16_f32 v217, v170, v171
v_mfma_f32_16x16x32_bf16 v[156:159], a[148:151], v[68:71], v[156:159]
v_exp_f32 v185, v185
v_mfma_f32_16x16x32_bf16 v[156:159], a[152:155], v[72:75], v[156:159]
ds_read_b128 a[184:187], v2 offset:30720
v_cvt_pk_bf16_f32 v218, v184, v185
v_mfma_f32_16x16x32_bf16 v[156:159], a[156:159], v[76:79], v[156:159]
v_exp_f32 v186, v186
v_mfma_f32_16x16x32_bf16 v[152:155], a[156:159], v[60:63], v[152:155]
ds_read_b128 a[188:191], v2 offset:31744
v_mfma_f32_16x16x32_bf16 v[152:155], a[152:155], v[56:59], v[152:155]
v_exp_f32 v187, v187
v_mfma_f32_16x16x32_bf16 v[152:155], a[148:151], v[52:55], v[152:155]
s_waitcnt lgkmcnt(8)
ds_read_b128 a[224:227], v2 offset:8192
v_cvt_pk_bf16_f32 v219, v186, v187
v_mfma_f32_16x16x32_bf16 a[64:67], a[192:195], v[200:203], a[64:67]
v_exp_f32 v172, v172
v_mfma_f32_16x16x32_bf16 a[96:99], a[192:195], v[204:207], a[96:99]
buffer_store_dwordx4 v[144:147], v1, s[44:47], s70 offen offset:1024 sc1
v_mfma_f32_16x16x32_bf16 a[100:103], a[196:199], v[204:207], a[100:103]
ds_read_b128 a[228:231], v2 offset:9216
v_mfma_f32_16x16x32_bf16 a[68:71], a[196:199], v[200:203], a[68:71]
v_exp_f32 v173, v173
v_mfma_f32_16x16x32_bf16 a[72:75], a[200:203], v[200:203], a[72:75]
ds_read_b128 a[232:235], v2 offset:10240
v_cvt_pk_bf16_f32 v220, v172, v173
v_mfma_f32_16x16x32_bf16 a[104:107], a[200:203], v[204:207], a[104:107]
v_exp_f32 v174, v174
v_mfma_f32_16x16x32_bf16 a[108:111], a[204:207], v[204:207], a[108:111]
ds_read_b128 a[236:239], v2 offset:11264
v_mfma_f32_16x16x32_bf16 a[76:79], a[204:207], v[200:203], a[76:79]
v_exp_f32 v175, v175
v_mfma_f32_16x16x32_bf16 a[80:83], a[208:211], v[200:203], a[80:83]
ds_read_b128 a[240:243], v2 offset:12288
v_cvt_pk_bf16_f32 v221, v174, v175
v_mfma_f32_16x16x32_bf16 a[112:115], a[208:211], v[204:207], a[112:115]
v_exp_f32 v188, v188
v_mfma_f32_16x16x32_bf16 a[116:119], a[212:215], v[204:207], a[116:119]
ds_read_b128 a[244:247], v2 offset:13312
v_mfma_f32_16x16x32_bf16 a[84:87], a[212:215], v[200:203], a[84:87]
v_exp_f32 v189, v189
v_mfma_f32_16x16x32_bf16 a[88:91], a[216:219], v[200:203], a[88:91]
buffer_store_dwordx4 v[160:163], v1, s[44:47], s70 offen offset:2048 sc1
v_mfma_f32_16x16x32_bf16 a[120:123], a[216:219], v[204:207], a[120:123]
ds_read_b128 a[248:251], v2 offset:14336
v_cvt_pk_bf16_f32 v222, v188, v189
v_mfma_f32_16x16x32_bf16 a[124:127], a[220:223], v[204:207], a[124:127]
v_exp_f32 v190, v190
v_mfma_f32_16x16x32_bf16 a[92:95], a[220:223], v[200:203], a[92:95]
ds_read_b128 a[252:255], v2 offset:15360
v_add_u32 v2, s82, v1
v_mfma_f32_16x16x32_bf16 v[232:235], v[120:123], v[200:203], v[232:235]
s_waitcnt vmcnt(27) lgkmcnt(8)
v_exp_f32 v191, v191
v_mfma_f32_16x16x32_bf16 v[236:239], v[120:123], v[204:207], v[236:239]
s_barrier
v_cvt_pk_bf16_f32 v223, v190, v191
s_cmp_eq_u32 s58, 3
s_cbranch_scc1 Ltri52
v_mfma_f32_16x16x32_bf16 v[168:171], a[160:163], v[48:51], v[112:115]
v_exp_f32 v136, v136
v_mfma_f32_16x16x32_bf16 v[172:175], a[160:163], v[64:67], v[112:115]
ds_read_b128 a[192:195], v2 offset:0
v_mfma_f32_16x16x32_bf16 v[184:187], a[176:179], v[48:51], v[112:115]
v_exp_f32 v137, v137
v_mfma_f32_16x16x32_bf16 v[188:191], a[176:179], v[64:67], v[112:115]
v_exp_f32 v138, v138
s_branch Ljoin53
Lalt51:
Ltri52:
v_mfma_f32_16x16x32_bf16 v[168:171], a[160:163], v[48:51], v[104:107]
v_exp_f32 v136, v136
v_mfma_f32_16x16x32_bf16 v[172:175], a[160:163], v[64:67], v[92:95]
ds_read_b128 a[192:195], v2 offset:0
v_mfma_f32_16x16x32_bf16 v[184:187], a[176:179], v[48:51], v[112:115]
v_exp_f32 v137, v137
v_mfma_f32_16x16x32_bf16 v[188:191], a[176:179], v[64:67], v[108:111]
v_exp_f32 v138, v138
Ljoin53:
v_mfma_f32_16x16x32_bf16 v[168:171], a[164:167], v[52:55], v[168:171]
ds_read_b128 a[196:199], v2 offset:1024
v_cvt_pk_bf16_f32 v200, v136, v137
v_mfma_f32_16x16x32_bf16 v[168:171], a[168:171], v[56:59], v[168:171]
v_exp_f32 v139, v139
v_mfma_f32_16x16x32_bf16 v[168:171], a[172:175], v[60:63], v[168:171]
buffer_store_dwordx4 v[176:179], v1, s[44:47], s70 offen offset:3072 sc1
v_mfma_f32_16x16x32_bf16 v[172:175], a[172:175], v[76:79], v[172:175]
s_add_u32 s70, s70, 0x20000
v_exp_f32 v152, v152
v_mfma_f32_16x16x32_bf16 v[172:175], a[168:171], v[72:75], v[172:175]
ds_read_b128 a[200:203], v2 offset:2048
v_cvt_pk_bf16_f32 v201, v138, v139
v_mfma_f32_16x16x32_bf16 v[172:175], a[164:167], v[68:71], v[172:175]
v_exp_f32 v153, v153
v_mfma_f32_16x16x32_bf16 v[188:191], a[180:183], v[68:71], v[188:191]
v_exp_f32 v154, v154
v_mfma_f32_16x16x32_bf16 v[188:191], a[184:187], v[72:75], v[188:191]
ds_read_b128 a[204:207], v2 offset:3072
v_cvt_pk_bf16_f32 v202, v152, v153
v_mfma_f32_16x16x32_bf16 v[188:191], a[188:191], v[76:79], v[188:191]
v_exp_f32 v155, v155
v_mfma_f32_16x16x32_bf16 v[184:187], a[188:191], v[60:63], v[184:187]
v_exp_f32 v140, v140
v_mfma_f32_16x16x32_bf16 v[184:187], a[184:187], v[56:59], v[184:187]
ds_read_b128 a[208:211], v2 offset:4096
v_cvt_pk_bf16_f32 v203, v154, v155
v_mfma_f32_16x16x32_bf16 v[184:187], a[180:183], v[52:55], v[184:187]
s_waitcnt lgkmcnt(5)
buffer_store_dwordx4 v[132:135], v1, s[44:47], s70 offen sc1
v_mfma_f32_16x16x32_bf16 a[64:67], a[224:227], v[216:219], a[64:67]
v_exp_f32 v141, v141
v_mfma_f32_16x16x32_bf16 a[96:99], a[224:227], v[220:223], a[96:99]
v_exp_f32 v142, v142
v_mfma_f32_16x16x32_bf16 a[100:103], a[228:231], v[220:223], a[100:103]
ds_read_b128 a[212:215], v2 offset:5120
v_cvt_pk_bf16_f32 v204, v140, v141
v_mfma_f32_16x16x32_bf16 a[68:71], a[228:231], v[216:219], a[68:71]
v_exp_f32 v143, v143
v_mfma_f32_16x16x32_bf16 a[72:75], a[232:235], v[216:219], a[72:75]
v_exp_f32 v156, v156
v_mfma_f32_16x16x32_bf16 a[104:107], a[232:235], v[220:223], a[104:107]
ds_read_b128 a[216:219], v2 offset:6144
v_cvt_pk_bf16_f32 v205, v142, v143
v_mfma_f32_16x16x32_bf16 a[108:111], a[236:239], v[220:223], a[108:111]
v_exp_f32 v157, v157
v_mfma_f32_16x16x32_bf16 a[76:79], a[236:239], v[216:219], a[76:79]
buffer_store_dwordx4 v[148:151], v1, s[44:47], s70 offen offset:1024 sc1
v_mfma_f32_16x16x32_bf16 a[80:83], a[240:243], v[216:219], a[80:83]
v_exp_f32 v158, v158
v_mfma_f32_16x16x32_bf16 a[112:115], a[240:243], v[220:223], a[112:115]
ds_read_b128 a[220:223], v2 offset:7168
v_cvt_pk_bf16_f32 v206, v156, v157
v_mfma_f32_16x16x32_bf16 a[116:119], a[244:247], v[220:223], a[116:119]
v_exp_f32 v159, v159
v_mfma_f32_16x16x32_bf16 a[84:87], a[244:247], v[216:219], a[84:87]
v_cvt_pk_bf16_f32 v207, v158, v159
v_mfma_f32_16x16x32_bf16 a[88:91], a[248:251], v[216:219], a[88:91]
v_mfma_f32_16x16x32_bf16 a[120:123], a[248:251], v[220:223], a[120:123]
v_mfma_f32_16x16x32_bf16 a[124:127], a[252:255], v[220:223], a[124:127]
v_mfma_f32_16x16x32_bf16 a[92:95], a[252:255], v[216:219], a[92:95]
v_mfma_f32_16x16x32_bf16 v[232:235], v[120:123], v[216:219], v[232:235]
v_mfma_f32_16x16x32_bf16 v[236:239], v[120:123], v[220:223], v[236:239]
s_waitcnt lgkmcnt(0)
v_mfma_f32_16x16x32_bf16 a[64:67], a[192:195], v[200:203], a[64:67]
s_add_u32 s82, s82, 0x8000
ds_read_b128 a[224:227], v2 offset:8192
ds_read_b128 a[228:231], v2 offset:9216
v_mfma_f32_16x16x32_bf16 a[96:99], a[192:195], v[204:207], a[96:99]
s_and_b32 s82, s82, 0x1ffff
v_exp_f32 v168, v168
v_mfma_f32_16x16x32_bf16 a[100:103], a[196:199], v[204:207], a[100:103]
v_exp_f32 v169, v169
v_mfma_f32_16x16x32_bf16 a[68:71], a[196:199], v[200:203], a[68:71]
v_exp_f32 v170, v170
v_mfma_f32_16x16x32_bf16 a[72:75], a[200:203], v[200:203], a[72:75]
v_exp_f32 v171, v171
v_mfma_f32_16x16x32_bf16 a[104:107], a[200:203], v[204:207], a[104:107]
ds_read_b128 a[232:235], v2 offset:10240
ds_read_b128 a[236:239], v2 offset:11264
v_mfma_f32_16x16x32_bf16 a[108:111], a[204:207], v[204:207], a[108:111]
v_exp_f32 v184, v184
v_mfma_f32_16x16x32_bf16 a[76:79], a[204:207], v[200:203], a[76:79]
ds_read_b128 a[240:243], v2 offset:12288
ds_read_b128 a[244:247], v2 offset:13312
v_mfma_f32_16x16x32_bf16 a[80:83], a[208:211], v[200:203], a[80:83]
ds_read_b128 a[248:251], v2 offset:14336
ds_read_b128 a[252:255], v2 offset:15360
v_mfma_f32_16x16x32_bf16 a[112:115], a[208:211], v[204:207], a[112:115]
v_cvt_pk_bf16_f32 v216, v168, v169
v_cvt_pk_bf16_f32 v217, v170, v171
v_mfma_f32_16x16x32_bf16 a[116:119], a[212:215], v[204:207], a[116:119]
buffer_store_dwordx4 v[164:167], v1, s[44:47], s70 offen offset:2048 sc1
v_mfma_f32_16x16x32_bf16 a[84:87], a[212:215], v[200:203], a[84:87]
v_exp_f32 v185, v185
v_mfma_f32_16x16x32_bf16 a[88:91], a[216:219], v[200:203], a[88:91]
v_exp_f32 v186, v186
v_mfma_f32_16x16x32_bf16 a[120:123], a[216:219], v[204:207], a[120:123]
v_exp_f32 v187, v187
v_mfma_f32_16x16x32_bf16 a[124:127], a[220:223], v[204:207], a[124:127]
v_exp_f32 v172, v172
v_mfma_f32_16x16x32_bf16 a[92:95], a[220:223], v[200:203], a[92:95]
buffer_store_dwordx4 v[180:183], v1, s[44:47], s70 offen offset:3072 sc1
v_mfma_f32_16x16x32_bf16 v[232:235], v[120:123], v[200:203], v[232:235]
s_waitcnt vmcnt(8) lgkmcnt(0)
v_cvt_pk_bf16_f32 v218, v184, v185
v_cvt_pk_bf16_f32 v219, v186, v187
v_mfma_f32_16x16x32_bf16 v[236:239], v[120:123], v[204:207], v[236:239]
s_barrier
v_exp_f32 v173, v173
v_add_u32 v2, s82, v1
v_exp_f32 v174, v174
v_cvt_pk_bf16_f32 v220, v172, v173
v_exp_f32 v175, v175
v_exp_f32 v188, v188
v_cvt_pk_bf16_f32 v221, v174, v175
v_exp_f32 v189, v189
v_exp_f32 v190, v190
v_cvt_pk_bf16_f32 v222, v188, v189
v_exp_f32 v191, v191
s_nop 0
v_cvt_pk_bf16_f32 v223, v190, v191
s_branch LHT4
Lslow:
s_waitcnt vmcnt(0) lgkmcnt(0)
s_barrier
s_mov_b32 s86, 1
s_lshl_b32 s81, s59, 20
s_add_u32 s81, s81, s64
s_sub_u32 s81, s81, 0x4000
s_mov_b32 s83, 0
s_lshl_b32 s75, s60, 2
s_sub_u32 s76, 64, s75
s_sub_u32 s75, s76, 4
s_add_u32 s75, s75, s58
v_mov_b32 v2, v1
v_lshrrev_b32 v240, 4, v0
v_and_b32 v241, 15, v0
v_lshlrev_b32 v240, 2, v240
v_sub_u32 v240, v241, v240
v_mov_b32 v112, 0xff800000
v_mov_b32 v113, 0xff800000
v_mov_b32 v114, 0xff800000
v_mov_b32 v115, 0xff800000
v_cmp_gt_i32 vcc, 0, v240
v_mov_b32 v120, 0x3f803f80
s_nop 0
v_cndmask_b32 v116, 0, v112, vcc
v_cmp_gt_i32 vcc, 1, v240
v_mov_b32 v121, 0x3f803f80
s_nop 0
v_cndmask_b32 v117, 0, v112, vcc
v_cmp_gt_i32 vcc, 2, v240
v_mov_b32 v122, 0x3f803f80
s_nop 0
v_cndmask_b32 v118, 0, v112, vcc
v_cmp_gt_i32 vcc, 3, v240
v_mov_b32 v123, 0x3f803f80
s_nop 0
v_cndmask_b32 v119, 0, v112, vcc
Lslow1:
s_add_u32 m0, s64, 16384
s_add_u32 s72, s81, 16384
buffer_load_dwordx4 v1, s[44:47], s72 offen sc1 lds
buffer_load_dwordx4 v1, s[44:47], s72 offen offset:1024 sc1 lds
buffer_load_dwordx4 v1, s[44:47], s72 offen offset:2048 sc1 lds
buffer_load_dwordx4 v1, s[44:47], s72 offen offset:3072 sc1 lds
s_add_u32 s81, s81, 0x8000
s_waitcnt vmcnt(0)
s_barrier
ds_read_b128 a[128:131], v2 offset:16384
ds_read_b128 a[132:135], v2 offset:17408
ds_read_b128 a[136:139], v2 offset:18432
ds_read_b128 a[140:143], v2 offset:19456
ds_read_b128 a[144:147], v2 offset:20480
ds_read_b128 a[148:151], v2 offset:21504
ds_read_b128 a[152:155], v2 offset:22528
ds_read_b128 a[156:159], v2 offset:23552
s_waitcnt lgkmcnt(0)
s_cmp_lt_u32 s84, s83
s_cbranch_scc1 Lsa54
s_cmp_eq_u32 s84, s83
s_cbranch_scc1 Lst55
v_mfma_f32_16x16x32_bf16 v[128:131], a[128:131], v[16:19], 0
v_mfma_f32_16x16x32_bf16 v[132:135], a[128:131], v[32:35], 0
v_mfma_f32_16x16x32_bf16 v[144:147], a[144:147], v[16:19], 0
v_mfma_f32_16x16x32_bf16 v[148:151], a[144:147], v[32:35], 0
s_branch Lsj56
Lst55:
v_mfma_f32_16x16x32_bf16 v[128:131], a[128:131], v[16:19], v[116:119]
v_mfma_f32_16x16x32_bf16 v[132:135], a[128:131], v[32:35], 0
v_mfma_f32_16x16x32_bf16 v[144:147], a[144:147], v[16:19], v[112:115]
v_mfma_f32_16x16x32_bf16 v[148:151], a[144:147], v[32:35], v[116:119]
Lsj56:
v_mfma_f32_16x16x32_bf16 v[128:131], a[132:135], v[20:23], v[128:131]
v_mfma_f32_16x16x32_bf16 v[128:131], a[136:139], v[24:27], v[128:131]
v_mfma_f32_16x16x32_bf16 v[128:131], a[140:143], v[28:31], v[128:131]
v_mfma_f32_16x16x32_bf16 v[132:135], a[140:143], v[44:47], v[132:135]
v_mfma_f32_16x16x32_bf16 v[132:135], a[136:139], v[40:43], v[132:135]
v_mfma_f32_16x16x32_bf16 v[132:135], a[132:135], v[36:39], v[132:135]
v_mfma_f32_16x16x32_bf16 v[148:151], a[148:151], v[36:39], v[148:151]
v_mfma_f32_16x16x32_bf16 v[148:151], a[152:155], v[40:43], v[148:151]
v_mfma_f32_16x16x32_bf16 v[148:151], a[156:159], v[44:47], v[148:151]
v_mfma_f32_16x16x32_bf16 v[144:147], a[156:159], v[28:31], v[144:147]
v_mfma_f32_16x16x32_bf16 v[144:147], a[152:155], v[24:27], v[144:147]
v_mfma_f32_16x16x32_bf16 v[144:147], a[148:151], v[20:23], v[144:147]
s_nop 7
v_max3_f32 v124, v124, v128, v129
v_max3_f32 v124, v124, v130, v131
v_max3_f32 v124, v124, v144, v145
v_max3_f32 v124, v124, v146, v147
v_max3_f32 v125, v125, v132, v133
v_max3_f32 v125, v125, v134, v135
v_max3_f32 v125, v125, v148, v149
v_max3_f32 v125, v125, v150, v151
Lsa54:
s_cmp_lt_u32 s75, s83
s_cbranch_scc1 Lsa57
s_cmp_eq_u32 s75, s83
s_cbranch_scc1 Lst58
v_mfma_f32_16x16x32_bf16 v[136:139], a[128:131], v[48:51], 0
v_mfma_f32_16x16x32_bf16 v[140:143], a[128:131], v[64:67], 0
v_mfma_f32_16x16x32_bf16 v[152:155], a[144:147], v[48:51], 0
v_mfma_f32_16x16x32_bf16 v[156:159], a[144:147], v[64:67], 0
s_branch Lsj59
Lst58:
v_mfma_f32_16x16x32_bf16 v[136:139], a[128:131], v[48:51], v[116:119]
v_mfma_f32_16x16x32_bf16 v[140:143], a[128:131], v[64:67], 0
v_mfma_f32_16x16x32_bf16 v[152:155], a[144:147], v[48:51], v[112:115]
v_mfma_f32_16x16x32_bf16 v[156:159], a[144:147], v[64:67], v[116:119]
Lsj59:
v_mfma_f32_16x16x32_bf16 v[136:139], a[132:135], v[52:55], v[136:139]
v_mfma_f32_16x16x32_bf16 v[136:139], a[136:139], v[56:59], v[136:139]
v_mfma_f32_16x16x32_bf16 v[136:139], a[140:143], v[60:63], v[136:139]
v_mfma_f32_16x16x32_bf16 v[140:143], a[140:143], v[76:79], v[140:143]
v_mfma_f32_16x16x32_bf16 v[140:143], a[136:139], v[72:75], v[140:143]
v_mfma_f32_16x16x32_bf16 v[140:143], a[132:135], v[68:71], v[140:143]
v_mfma_f32_16x16x32_bf16 v[156:159], a[148:151], v[68:71], v[156:159]
v_mfma_f32_16x16x32_bf16 v[156:159], a[152:155], v[72:75], v[156:159]
v_mfma_f32_16x16x32_bf16 v[156:159], a[156:159], v[76:79], v[156:159]
v_mfma_f32_16x16x32_bf16 v[152:155], a[156:159], v[60:63], v[152:155]
v_mfma_f32_16x16x32_bf16 v[152:155], a[152:155], v[56:59], v[152:155]
v_mfma_f32_16x16x32_bf16 v[152:155], a[148:151], v[52:55], v[152:155]
s_nop 7
v_max3_f32 v126, v126, v136, v137
v_max3_f32 v126, v126, v138, v139
v_max3_f32 v126, v126, v152, v153
v_max3_f32 v126, v126, v154, v155
v_max3_f32 v127, v127, v140, v141
v_max3_f32 v127, v127, v142, v143
v_max3_f32 v127, v127, v156, v157
v_max3_f32 v127, v127, v158, v159
Lsa57:
s_add_u32 s83, s83, 1
ds_read_b128 a[128:131], v2 offset:24576
ds_read_b128 a[132:135], v2 offset:25600
ds_read_b128 a[136:139], v2 offset:26624
ds_read_b128 a[140:143], v2 offset:27648
ds_read_b128 a[144:147], v2 offset:28672
ds_read_b128 a[148:151], v2 offset:29696
ds_read_b128 a[152:155], v2 offset:30720
ds_read_b128 a[156:159], v2 offset:31744
s_waitcnt lgkmcnt(0)
s_cmp_lt_u32 s84, s83
s_cbranch_scc1 Lsa60
s_cmp_eq_u32 s84, s83
s_cbranch_scc1 Lst61
v_mfma_f32_16x16x32_bf16 v[128:131], a[128:131], v[16:19], 0
v_mfma_f32_16x16x32_bf16 v[132:135], a[128:131], v[32:35], 0
v_mfma_f32_16x16x32_bf16 v[144:147], a[144:147], v[16:19], 0
v_mfma_f32_16x16x32_bf16 v[148:151], a[144:147], v[32:35], 0
s_branch Lsj62
Lst61:
v_mfma_f32_16x16x32_bf16 v[128:131], a[128:131], v[16:19], v[116:119]
v_mfma_f32_16x16x32_bf16 v[132:135], a[128:131], v[32:35], 0
v_mfma_f32_16x16x32_bf16 v[144:147], a[144:147], v[16:19], v[112:115]
v_mfma_f32_16x16x32_bf16 v[148:151], a[144:147], v[32:35], v[116:119]
Lsj62:
v_mfma_f32_16x16x32_bf16 v[128:131], a[132:135], v[20:23], v[128:131]
v_mfma_f32_16x16x32_bf16 v[128:131], a[136:139], v[24:27], v[128:131]
v_mfma_f32_16x16x32_bf16 v[128:131], a[140:143], v[28:31], v[128:131]
v_mfma_f32_16x16x32_bf16 v[132:135], a[140:143], v[44:47], v[132:135]
v_mfma_f32_16x16x32_bf16 v[132:135], a[136:139], v[40:43], v[132:135]
v_mfma_f32_16x16x32_bf16 v[132:135], a[132:135], v[36:39], v[132:135]
v_mfma_f32_16x16x32_bf16 v[148:151], a[148:151], v[36:39], v[148:151]
v_mfma_f32_16x16x32_bf16 v[148:151], a[152:155], v[40:43], v[148:151]
v_mfma_f32_16x16x32_bf16 v[148:151], a[156:159], v[44:47], v[148:151]
v_mfma_f32_16x16x32_bf16 v[144:147], a[156:159], v[28:31], v[144:147]
v_mfma_f32_16x16x32_bf16 v[144:147], a[152:155], v[24:27], v[144:147]
v_mfma_f32_16x16x32_bf16 v[144:147], a[148:151], v[20:23], v[144:147]
s_nop 7
v_max3_f32 v124, v124, v128, v129
v_max3_f32 v124, v124, v130, v131
v_max3_f32 v124, v124, v144, v145
v_max3_f32 v124, v124, v146, v147
v_max3_f32 v125, v125, v132, v133
v_max3_f32 v125, v125, v134, v135
v_max3_f32 v125, v125, v148, v149
v_max3_f32 v125, v125, v150, v151
Lsa60:
s_cmp_lt_u32 s75, s83
s_cbranch_scc1 Lsa63
s_cmp_eq_u32 s75, s83
s_cbranch_scc1 Lst64
v_mfma_f32_16x16x32_bf16 v[136:139], a[128:131], v[48:51], 0
v_mfma_f32_16x16x32_bf16 v[140:143], a[128:131], v[64:67], 0
v_mfma_f32_16x16x32_bf16 v[152:155], a[144:147], v[48:51], 0
v_mfma_f32_16x16x32_bf16 v[156:159], a[144:147], v[64:67], 0
s_branch Lsj65
Lst64:
v_mfma_f32_16x16x32_bf16 v[136:139], a[128:131], v[48:51], v[116:119]
v_mfma_f32_16x16x32_bf16 v[140:143], a[128:131], v[64:67], 0
v_mfma_f32_16x16x32_bf16 v[152:155], a[144:147], v[48:51], v[112:115]
v_mfma_f32_16x16x32_bf16 v[156:159], a[144:147], v[64:67], v[116:119]
Lsj65:
v_mfma_f32_16x16x32_bf16 v[136:139], a[132:135], v[52:55], v[136:139]
v_mfma_f32_16x16x32_bf16 v[136:139], a[136:139], v[56:59], v[136:139]
v_mfma_f32_16x16x32_bf16 v[136:139], a[140:143], v[60:63], v[136:139]
v_mfma_f32_16x16x32_bf16 v[140:143], a[140:143], v[76:79], v[140:143]
v_mfma_f32_16x16x32_bf16 v[140:143], a[136:139], v[72:75], v[140:143]
v_mfma_f32_16x16x32_bf16 v[140:143], a[132:135], v[68:71], v[140:143]
v_mfma_f32_16x16x32_bf16 v[156:159], a[148:151], v[68:71], v[156:159]
v_mfma_f32_16x16x32_bf16 v[156:159], a[152:155], v[72:75], v[156:159]
v_mfma_f32_16x16x32_bf16 v[156:159], a[156:159], v[76:79], v[156:159]
v_mfma_f32_16x16x32_bf16 v[152:155], a[156:159], v[60:63], v[152:155]
v_mfma_f32_16x16x32_bf16 v[152:155], a[152:155], v[56:59], v[152:155]
v_mfma_f32_16x16x32_bf16 v[152:155], a[148:151], v[52:55], v[152:155]
s_nop 7
v_max3_f32 v126, v126, v136, v137
v_max3_f32 v126, v126, v138, v139
v_max3_f32 v126, v126, v152, v153
v_max3_f32 v126, v126, v154, v155
v_max3_f32 v127, v127, v140, v141
v_max3_f32 v127, v127, v142, v143
v_max3_f32 v127, v127, v156, v157
v_max3_f32 v127, v127, v158, v159
Lsa63:
s_add_u32 s83, s83, 1
s_barrier
s_cmp_lt_u32 s83, s76
s_cbranch_scc1 Lslow1
s_lshl_b32 s81, s59, 20
s_add_u32 s81, s81, s64
s_sub_u32 s81, s81, 0x4000
s_add_u32 m0, s64, 49152
s_add_u32 s72, s81, 16384
buffer_load_dwordx4 v1, s[44:47], s72 offen sc1 lds
buffer_load_dwordx4 v1, s[44:47], s72 offen offset:1024 sc1 lds
buffer_load_dwordx4 v1, s[44:47], s72 offen offset:2048 sc1 lds
buffer_load_dwordx4 v1, s[44:47], s72 offen offset:3072 sc1 lds
s_add_u32 s81, s81, 0x8000
s_add_u32 m0, s64, 81920
s_add_u32 s72, s81, 16384
buffer_load_dwordx4 v1, s[44:47], s72 offen sc1 lds
buffer_load_dwordx4 v1, s[44:47], s72 offen offset:1024 sc1 lds
buffer_load_dwordx4 v1, s[44:47], s72 offen offset:2048 sc1 lds
buffer_load_dwordx4 v1, s[44:47], s72 offen offset:3072 sc1 lds
s_add_u32 m0, s64, 65536
s_add_u32 s72, s81, 0
buffer_load_dwordx4 v1, s[44:47], s72 offen sc1 lds
buffer_load_dwordx4 v1, s[44:47], s72 offen offset:1024 sc1 lds
buffer_load_dwordx4 v1, s[44:47], s72 offen offset:2048 sc1 lds
buffer_load_dwordx4 v1, s[44:47], s72 offen offset:3072 sc1 lds
s_add_u32 s81, s81, 0x8000
s_add_u32 m0, s64, 114688
s_add_u32 s72, s81, 16384
buffer_load_dwordx4 v1, s[44:47], s72 offen sc1 lds
buffer_load_dwordx4 v1, s[44:47], s72 offen offset:1024 sc1 lds
buffer_load_dwordx4 v1, s[44:47], s72 offen offset:2048 sc1 lds
buffer_load_dwordx4 v1, s[44:47], s72 offen offset:3072 sc1 lds
s_add_u32 m0, s64, 98304
s_add_u32 s72, s81, 0
buffer_load_dwordx4 v1, s[44:47], s72 offen sc1 lds
buffer_load_dwordx4 v1, s[44:47], s72 offen offset:1024 sc1 lds
buffer_load_dwordx4 v1, s[44:47], s72 offen offset:2048 sc1 lds
buffer_load_dwordx4 v1, s[44:47], s72 offen offset:3072 sc1 lds
v_add_u32 v2, 0x8000, v1
s_waitcnt vmcnt(16)
s_barrier
ds_read_b128 a[128:131], v2 offset:16384
ds_read_b128 a[132:135], v2 offset:17408
ds_read_b128 a[136:139], v2 offset:18432
ds_read_b128 a[140:143], v2 offset:19456
ds_read_b128 a[144:147], v2 offset:20480
ds_read_b128 a[148:151], v2 offset:21504
ds_read_b128 a[152:155], v2 offset:22528
ds_read_b128 a[156:159], v2 offset:23552
s_branch Lattn
Lspin66:
s_mov_b32 s83, 262144
Lsl68:
s_sleep 2
buffer_load_dword v3, v2, s[44:47], s82 offen sc1
s_sub_u32 s83, s83, 1
s_cmp_eq_u32 s83, 0
s_waitcnt vmcnt(0)
s_cbranch_scc1 Lback67
v_cmp_gt_u32 vcc, 2, v3
s_cbranch_vccnz Lsl68
s_branch Lback67
Lspin69:
s_mov_b32 s83, 262144
Lsl71:
s_sleep 2
buffer_load_dword v3, v2, s[44:47], s82 offen sc1
s_sub_u32 s83, s83, 1
s_cmp_eq_u32 s83, 0
s_waitcnt vmcnt(0)
s_cbranch_scc1 Lback70
v_cmp_gt_u32 vcc, 2, v3
s_cbranch_vccnz Lsl71
s_branch Lback70
Lspin72:
s_mov_b32 s83, 262144
Lsl74:
s_sleep 2
buffer_load_dword v3, v2, s[44:47], s82 offen sc1
s_sub_u32 s83, s83, 1
s_cmp_eq_u32 s83, 0
s_waitcnt vmcnt(0)
s_cbranch_scc1 Lback73
v_cmp_gt_u32 vcc, 2, v3
s_cbranch_vccnz Lsl74
s_branch Lback73
Lspin75:
s_mov_b32 s83, 262144
Lsl77:
s_sleep 2
buffer_load_dword v3, v2, s[44:47], s82 offen sc1
s_sub_u32 s83, s83, 1
s_cmp_eq_u32 s83, 0
s_waitcnt vmcnt(0)
s_cbranch_scc1 Lback76
v_cmp_gt_u32 vcc, 2, v3
s_cbranch_vccnz Lsl77
s_branch Lback76
Lspin78:
s_mov_b32 s83, 262144
Lsl80:
s_sleep 2
buffer_load_dword v3, v2, s[44:47], s82 offen sc1
s_sub_u32 s83, s83, 1
s_cmp_eq_u32 s83, 0
s_waitcnt vmcnt(0)
s_cbranch_scc1 Lback79
v_cmp_gt_u32 vcc, 2, v3
s_cbranch_vccnz Lsl80
s_branch Lback79
Lspin81:
s_mov_b32 s83, 262144
Lsl83:
s_sleep 2
buffer_load_dword v3, v2, s[44:47], s82 offen sc1
s_sub_u32 s83, s83, 1
s_cmp_eq_u32 s83, 0
s_waitcnt vmcnt(0)
s_cbranch_scc1 Lback82
v_cmp_gt_u32 vcc, 2, v3
s_cbranch_vccnz Lsl83
s_branch Lback82
Lspin84:
s_mov_b32 s83, 262144
Lsl86:
s_sleep 2
buffer_load_dword v3, v2, s[44:47], s82 offen sc1
s_sub_u32 s83, s83, 1
s_cmp_eq_u32 s83, 0
s_waitcnt vmcnt(0)
s_cbranch_scc1 Lback85
v_cmp_gt_u32 vcc, 2, v3
s_cbranch_vccnz Lsl86
s_branch Lback85
Lspin87:
s_mov_b32 s83, 262144
Lsl89:
s_sleep 2
buffer_load_dword v3, v2, s[44:47], s82 offen sc1
s_sub_u32 s83, s83, 1
s_cmp_eq_u32 s83, 0
s_waitcnt vmcnt(0)
s_cbranch_scc1 Lback88
v_cmp_gt_u32 vcc, 2, v3
s_cbranch_vccnz Lsl89
s_branch Lback88
Lredo0:
s_add_u32 s82, s59, 4
s_and_b32 s82, s82, 28
s_lshl_b32 s82, s82, 10
s_add_u32 s82, s82, s74
buffer_load_dword v3, v2, s[44:47], s82 offen sc1
s_waitcnt vmcnt(0)
v_cmp_gt_u32 vcc, 2, v3
s_cbranch_vccnz Lspin66
Lback67:
s_add_u32 s69, s61, 0
s_and_b32 s69, s69, 3
s_add_u32 s69, s69, s78
s_lshl_b32 s69, s69, 12
s_add_u32 s69, s69, s95
buffer_load_dwordx4 a[0:3], v1, s[44:47], s69 offen sc1
buffer_load_dwordx4 a[4:7], v1, s[44:47], s69 offen offset:1024 sc1
buffer_load_dwordx4 a[8:11], v1, s[44:47], s69 offen offset:2048 sc1
buffer_load_dwordx4 a[12:15], v1, s[44:47], s69 offen offset:3072 sc1
s_add_u32 s69, s69, 0x20000
buffer_load_dwordx4 a[16:19], v1, s[44:47], s69 offen sc1
buffer_load_dwordx4 a[20:23], v1, s[44:47], s69 offen offset:1024 sc1
buffer_load_dwordx4 a[24:27], v1, s[44:47], s69 offen offset:2048 sc1
buffer_load_dwordx4 a[28:31], v1, s[44:47], s69 offen offset:3072 sc1
s_add_u32 s69, s61, 1
s_and_b32 s69, s69, 3
s_add_u32 s69, s69, s78
s_lshl_b32 s69, s69, 12
s_add_u32 s69, s69, s95
buffer_load_dwordx4 a[32:35], v1, s[44:47], s69 offen sc1
buffer_load_dwordx4 a[36:39], v1, s[44:47], s69 offen offset:1024 sc1
buffer_load_dwordx4 a[40:43], v1, s[44:47], s69 offen offset:2048 sc1
buffer_load_dwordx4 a[44:47], v1, s[44:47], s69 offen offset:3072 sc1
s_add_u32 s69, s69, 0x20000
buffer_load_dwordx4 a[48:51], v1, s[44:47], s69 offen sc1
buffer_load_dwordx4 a[52:55], v1, s[44:47], s69 offen offset:1024 sc1
buffer_load_dwordx4 a[56:59], v1, s[44:47], s69 offen offset:2048 sc1
buffer_load_dwordx4 a[60:63], v1, s[44:47], s69 offen offset:3072 sc1
s_add_u32 s69, s61, 2
s_and_b32 s69, s69, 3
s_add_u32 s69, s69, s78
s_lshl_b32 s69, s69, 12
s_add_u32 s69, s69, s95
buffer_load_dwordx4 a[64:67], v1, s[44:47], s69 offen sc1
buffer_load_dwordx4 a[68:71], v1, s[44:47], s69 offen offset:1024 sc1
buffer_load_dwordx4 a[72:75], v1, s[44:47], s69 offen offset:2048 sc1
buffer_load_dwordx4 a[76:79], v1, s[44:47], s69 offen offset:3072 sc1
s_add_u32 s69, s69, 0x20000
buffer_load_dwordx4 a[80:83], v1, s[44:47], s69 offen sc1
buffer_load_dwordx4 a[84:87], v1, s[44:47], s69 offen offset:1024 sc1
buffer_load_dwordx4 a[88:91], v1, s[44:47], s69 offen offset:2048 sc1
buffer_load_dwordx4 a[92:95], v1, s[44:47], s69 offen offset:3072 sc1
s_waitcnt vmcnt(16)
s_branch Lredo0b
Lspin90:
s_mov_b32 s83, 262144
Lsl92:
s_sleep 2
buffer_load_dword v114, v115, s[44:47], s84 offen sc1
s_sub_u32 s83, s83, 1
s_cmp_eq_u32 s83, 0
s_waitcnt vmcnt(0)
s_cbranch_scc1 Lback91
v_cmp_gt_u32 vcc, 3, v114
s_cbranch_vccnz Lsl92
s_branch Lback91
Lcode_end:
s_endpgm
.section .rodata,"a"
.p2align 6
.amdhsa_kernel gated_mix__compressed_kv_cla__ssm_conv_h3__prompt_kernel
  .amdhsa_next_free_vgpr 512
  .amdhsa_next_free_sgpr 102
  .amdhsa_accum_offset 256
  .amdhsa_group_segment_fixed_size 0
  .amdhsa_kernarg_size 128
  .amdhsa_user_sgpr_count 2
  .amdhsa_user_sgpr_kernarg_segment_ptr 1
  .amdhsa_system_sgpr_workgroup_id_x 1
  .amdhsa_float_denorm_mode_32 3
.end_amdhsa_kernel
```

```asm
; @launch grid=(256,1,1) block=(256,1,1) lds=163840
.amdgcn_target "amdgcn-amd-amdhsa--gfx950"
.text
.globl gated_mix__compressed_kv_cla__ssm_conv_h3__prompt_kernel
.p2align 8
.type gated_mix__compressed_kv_cla__ssm_conv_h3__prompt_kernel,@function
gated_mix__compressed_kv_cla__ssm_conv_h3__prompt_kernel:
s_cmp_ge_u32 s2, 256
s_cbranch_scc1 Lend
s_load_dwordx2 s[8:9], s[0:1], 8
s_load_dwordx2 s[16:17], s[0:1], 24
s_load_dwordx2 s[20:21], s[0:1], 32
s_load_dwordx2 s[4:5], s[0:1], 0
s_load_dwordx2 s[12:13], s[0:1], 16
s_load_dwordx2 s[24:25], s[0:1], 40
s_load_dwordx2 s[28:29], s[0:1], 56
s_load_dwordx2 s[32:33], s[0:1], 64
s_load_dwordx2 s[52:53], s[0:1], 72
s_load_dwordx2 s[36:37], s[0:1], 80
s_load_dwordx2 s[54:55], s[0:1], 88
s_load_dwordx2 s[56:57], s[0:1], 96
s_load_dwordx2 s[40:41], s[0:1], 104
s_load_dwordx2 s[48:49], s[0:1], 112
s_load_dwordx2 s[44:45], s[0:1], 120
s_getpc_b64 s[98:99]
Lpc0:
s_lshr_b32 s75, s2, 3
v_lshrrev_b32 v26, 3, v0
s_lshl_b32 s73, s75, 12
v_lshlrev_b32 v26, 7, v26
v_add_u32 v26, s73, v26
v_min_u32 v26, Lcode_end-Lpc0, v26
global_load_dword v31, v26, s[98:99]
v_lshrrev_b32 v26, 6, v0
v_and_b32 v0, 63, v0
s_and_b32 s73, s2, 7
v_readfirstlane_b32 s58, v26
s_lshr_b32 s65, s75, 3
s_and_b32 s60, s75, 7
s_lshl_b32 s59, s73, 2
s_add_u32 s59, s59, s65
s_lshl_b32 s61, s65, 1
s_lshl_b32 s63, s58, 13
s_lshl_b32 s64, s58, 12
s_lshl_b32 s67, s60, 18
s_lshl_b32 s76, s58, 16
s_add_u32 s84, s67, s76
s_lshl_b32 s66, s58, 17
s_lshl_b32 s73, s59, 8
s_add_u32 s66, s66, s73
v_lshrrev_b32 v26, 4, v0
v_and_b32 v27, 7, v0
v_xor_b32 v27, v27, v26
v_lshlrev_b32 v27, 4, v27
v_lshrrev_b32 v28, 3, v0
v_lshl_add_u32 v2, v28, 10, v27
v_xor_b32 v3, 64, v2
v_and_b32 v29, 15, v0
v_lshlrev_b32 v30, 1, v26
v_xor_b32 v30, v30, v29
v_lshlrev_b32 v30, 4, v30
v_lshl_add_u32 v6, v26, 13, v30
v_xor_b32 v7, 0x80, v6
s_mov_b32 s10, 0x200000
s_mov_b32 s11, 0x20000
s_mov_b32 s18, 0x400000
s_mov_b32 s19, 0x20000
s_mov_b32 s22, 0x400000
s_mov_b32 s23, 0x20000
s_lshl_b32 s73, s2, 2
s_add_u32 s73, s73, s58
s_lshl_b32 s73, s73, 11
v_lshrrev_b32 v124, 2, v0
v_lshlrev_b32 v124, 7, v124
v_add_u32 v124, s73, v124
s_lshl_b32 s73, s60, 2
s_add_u32 s73, s73, s58
s_lshl_b32 s73, s73, 13
s_lshl_b32 s74, s59, 8
s_add_u32 s73, s73, s74
v_lshrrev_b32 v125, 4, v0
v_lshlrev_b32 v125, 18, v125
v_bfe_u32 v126, v0, 3, 1
v_lshl_add_u32 v125, v126, 7, v125
v_add_u32 v125, s73, v125
s_waitcnt lgkmcnt(0)
s_mov_b32 s80, 0x0
buffer_load_dword v126, v125, s[16:19], s80 offen
buffer_load_dword v126, v125, s[20:23], s80 offen
s_and_b32 s73, s65, 1
s_xor_b32 s73, s73, 0
s_lshl_b32 s69, s73, 7
s_add_u32 s69, s69, s84
s_lshl_b32 s71, s73, 19
s_add_u32 s71, s71, s66
s_add_u32 m0, s63, 65536
s_add_u32 s72, s69, 0
buffer_load_dwordx4 v2, s[8:11], s72 offen lds
s_add_u32 s72, s69, 7168
buffer_load_dwordx4 v3, s[8:11], s72 offen offset:1024 lds
s_add_u32 s72, s69, 14336
buffer_load_dwordx4 v2, s[8:11], s72 offen offset:2048 lds
s_add_u32 s72, s69, 21504
buffer_load_dwordx4 v3, s[8:11], s72 offen offset:3072 lds
s_add_u32 m0, s64, 0
s_add_u32 s72, s71, 0
buffer_load_dwordx4 v6, s[16:19], s72 offen lds
s_add_u32 s72, s71, 31744
buffer_load_dwordx4 v6, s[16:19], s72 offen offset:1024 lds
s_add_u32 s72, s71, 63488
buffer_load_dwordx4 v7, s[16:19], s72 offen offset:2048 lds
s_add_u32 s72, s71, 95232
buffer_load_dwordx4 v7, s[16:19], s72 offen offset:3072 lds
s_add_u32 m0, s63, 69632
s_add_u32 s72, s69, 32768
buffer_load_dwordx4 v2, s[8:11], s72 offen lds
s_add_u32 s72, s69, 39936
buffer_load_dwordx4 v3, s[8:11], s72 offen offset:1024 lds
s_add_u32 s72, s69, 47104
buffer_load_dwordx4 v2, s[8:11], s72 offen offset:2048 lds
s_add_u32 s72, s69, 54272
buffer_load_dwordx4 v3, s[8:11], s72 offen offset:3072 lds
s_add_u32 m0, s64, 16384
s_add_u32 s72, s71, 0
buffer_load_dwordx4 v6, s[20:23], s72 offen lds
s_add_u32 s72, s71, 31744
buffer_load_dwordx4 v6, s[20:23], s72 offen offset:1024 lds
s_add_u32 s72, s71, 63488
buffer_load_dwordx4 v7, s[20:23], s72 offen offset:2048 lds
s_add_u32 s72, s71, 95232
buffer_load_dwordx4 v7, s[20:23], s72 offen offset:3072 lds
buffer_load_dword v126, v124, s[8:11], 0 offen
s_and_b32 s73, s65, 1
s_xor_b32 s73, s73, 1
s_lshl_b32 s69, s73, 7
s_add_u32 s69, s69, s84
s_lshl_b32 s71, s73, 19
s_add_u32 s71, s71, s66
s_add_u32 m0, s63, 98304
s_add_u32 s72, s69, 0
buffer_load_dwordx4 v2, s[8:11], s72 offen lds
s_add_u32 s72, s69, 7168
buffer_load_dwordx4 v3, s[8:11], s72 offen offset:1024 lds
s_add_u32 s72, s69, 14336
buffer_load_dwordx4 v2, s[8:11], s72 offen offset:2048 lds
s_add_u32 s72, s69, 21504
buffer_load_dwordx4 v3, s[8:11], s72 offen offset:3072 lds
s_branch Lmain
.p2align 12
Lmain:
s_mov_b32 s6, 0x400000
s_mov_b32 s7, 0x20000
s_mov_b32 s14, 0x800000
s_mov_b32 s15, 0x20000
s_mov_b32 s26, 0x800000
s_mov_b32 s27, 0x20000
s_mov_b32 s30, 0x400000
s_mov_b32 s31, 0x20000
s_mov_b32 s34, 0x400000
s_mov_b32 s35, 0x20000
s_mov_b32 s38, 0x400000
s_mov_b32 s39, 0x20000
s_mov_b32 s42, 0x400000
s_mov_b32 s43, 0x20000
s_mov_b32 s46, 0x5000000
s_mov_b32 s47, 0x20000
s_mov_b32 s50, 0x100
s_mov_b32 s51, 0x20000
v_lshl_add_u32 v4, v28, 11, v27
v_xor_b32 v5, 64, v4
v_lshlrev_b32 v1, 4, v0
s_sub_u32 s74, 15, s60
s_lshl_b32 s68, s74, 18
s_lshl_b32 s76, s58, 15
s_add_u32 s68, s68, s76
s_add_u32 s67, s67, s76
s_and_b32 s62, s60, 3
s_sub_u32 s62, 16, s62
s_lshl_b32 s91, s59, 3
s_add_u32 s91, s91, s60
s_lshl_b32 s93, s91, 2
s_add_u32 s93, s93, s58
s_lshl_b32 s91, s91, 7
s_add_u32 s91, s91, 0x3810000
s_lshl_b32 s75, s93, 1
s_and_b32 s75, s75, 0xffc
s_lshl_b32 s93, s93, 12
s_load_dwordx2 s[88:89], s[36:37], s93
s_load_dword s90, s[54:55], s75
v_or_b32 v29, s58, v0
v_mov_b32 v30, 0
v_min_u32 v29, 1, v29
v_lshlrev_b32 v29, 30, v29
buffer_store_dword v30, v29, s[44:47], s91 offen sc1
s_and_b32 s73, s2, 15
s_lshr_b32 s74, s2, 4
s_lshl_b32 s74, s74, 7
s_lshl_b32 s75, s58, 5
s_add_u32 s74, s74, s75
s_mov_b32 s75, 131072
v_lshrrev_b32 v29, 5, v0
v_lshlrev_b32 v29, 4, v29
v_add_u32 v29, s74, v29
v_and_b32 v30, 31, v0
s_lshl_b32 s73, s73, 5
v_add_u32 v30, s73, v30
v_lshlrev_b32 v26, 11, v29
v_lshl_add_u32 v26, v30, 2, v26
v_subrev_u32 v27, 0x1800, v26
s_lshl_b32 s82, s74, 11
s_lshl_b32 s73, s73, 2
s_add_u32 s82, s82, s73
v_lshrrev_b32 v26, 3, v0
v_and_b32 v32, 7, v0
v_lshlrev_b32 v32, 4, v32
v_lshl_add_u32 v26, v26, 11, v32
v_lshrrev_b32 v98, 5, v0
v_lshlrev_b32 v98, 11, v98
v_and_b32 v32, 31, v0
v_lshl_add_u32 v98, v32, 2, v98
v_add_u32 v98, s63, v98
v_add_u32 v98, s75, v98
v_and_b32 v29, 0x7f, v29
v_sub_u32 v29, 0x70, v29
v_lshlrev_b32 v29, 1, v29
v_and_b32 v32, 31, v0
v_mul_u32_u24 v32, 544, v32
v_add3_u32 v28, v32, v29, s75
v_lshlrev_b32 v30, 4, v30
s_lshl_b32 s73, s2, 14
s_lshl_b32 s74, s58, 12
s_add_u32 s76, s73, s74
v_and_b32 v29, 15, v0
v_lshrrev_b32 v32, 4, v0
v_lshrrev_b32 v24, 1, v29
v_xor_b32 v24, v24, v32
v_lshlrev_b32 v24, 4, v24
v_lshl_add_u32 v24, v29, 7, v24
s_add_u32 s73, s63, 131072
v_add_u32 v16, s73, v24
v_xor_b32 v17, 64, v16
v_subrev_u32 v18, 0x10000, v16
v_subrev_u32 v19, 0x10000, v17
s_lshr_b32 s73, s58, 1
s_lshl_b32 s74, s73, 14
s_add_u32 s74, s74, 0x10000
v_add_u32 v24, s74, v24
v_xor_b32 v25, 64, v24
v_lshrrev_b32 v8, 2, v29
v_and_b32 v9, 1, v32
v_lshl_add_u32 v9, v9, 2, v8
v_lshl_add_u32 v8, v32, 3, v8
v_lshlrev_b32 v8, 8, v8
v_lshl_add_u32 v8, v9, 5, v8
v_and_b32 v29, 3, v0
v_lshl_add_u32 v8, v29, 3, v8
s_and_b32 s74, s58, 1
s_lshl_b32 s75, s74, 7
v_xor_b32 v20, s75, v8
v_xor_b32 v9, 32, v8
v_xor_b32 v10, 64, v8
v_xor_b32 v11, 96, v8
v_xor_b32 v12, 128, v8
v_xor_b32 v13, 160, v8
v_xor_b32 v14, 192, v8
v_xor_b32 v15, 224, v8
v_xor_b32 v21, 32, v20
v_xor_b32 v22, 64, v20
v_xor_b32 v23, 96, v20
s_lshl_b32 s77, s59, 20
s_add_u32 s81, s77, s64
s_sub_u32 s81, s81, 0x4000
s_lshl_b32 s75, s60, 17
s_add_u32 s77, s77, s75
s_lshl_b32 s73, s73, 16
s_add_u32 s77, s77, s73
s_lshl_b32 s75, s74, 12
s_add_u32 s78, s77, s75
s_add_u32 s78, s78, 0x4000
s_lshl_b32 s75, s74, 11
s_add_u32 s77, s77, s75
s_mov_b32 s79, 0x3e0293ee
s_waitcnt vmcnt(6)
s_barrier
ds_read_b64_tr_b16 v[160:161], v20 offset:0
ds_read_b64_tr_b16 v[162:163], v20 offset:1024
ds_read_b128 v[128:131], v24 offset:0
ds_read_b128 v[132:135], v24 offset:2048
ds_read_b128 v[136:139], v24 offset:4096
ds_read_b128 v[140:143], v24 offset:6144
ds_read_b128 v[144:147], v24 offset:8192
ds_read_b128 v[148:151], v24 offset:10240
ds_read_b128 v[152:155], v24 offset:12288
ds_read_b128 v[156:159], v24 offset:14336
ds_read_b64_tr_b16 v[164:165], v21 offset:0
ds_read_b64_tr_b16 v[166:167], v21 offset:1024
ds_read_b64_tr_b16 v[168:169], v22 offset:0
ds_read_b64_tr_b16 v[170:171], v22 offset:1024
ds_read_b64_tr_b16 v[172:173], v23 offset:0
ds_read_b64_tr_b16 v[174:175], v23 offset:1024
ds_read_b64_tr_b16 v[176:177], v20 offset:16384
ds_read_b64_tr_b16 v[178:179], v20 offset:17408
ds_read_b64_tr_b16 v[180:181], v21 offset:16384
ds_read_b64_tr_b16 v[182:183], v21 offset:17408
ds_read_b64_tr_b16 v[184:185], v22 offset:16384
ds_read_b64_tr_b16 v[186:187], v22 offset:17408
ds_read_b64_tr_b16 v[188:189], v23 offset:16384
ds_read_b64_tr_b16 v[190:191], v23 offset:17408
s_waitcnt lgkmcnt(0)
v_mfma_f32_16x16x32_bf16 a[0:3], v[160:163], v[128:131], 0
s_add_u32 m0, s64, 32768
ds_read_b64_tr_b16 v[224:225], v20 offset:8192
v_mfma_f32_16x16x32_bf16 a[4:7], v[160:163], v[132:135], 0
s_add_u32 s72, s71, 0
buffer_load_dwordx4 v6, s[16:19], s72 offen lds
v_mfma_f32_16x16x32_bf16 a[8:11], v[160:163], v[136:139], 0
s_add_u32 s72, s71, 31744
buffer_load_dwordx4 v6, s[16:19], s72 offen offset:1024 lds
v_mfma_f32_16x16x32_bf16 a[12:15], v[160:163], v[140:143], 0
ds_read_b64_tr_b16 v[226:227], v20 offset:9216
v_mfma_f32_16x16x32_bf16 a[16:19], v[160:163], v[144:147], 0
s_add_u32 s72, s71, 63488
buffer_load_dwordx4 v7, s[16:19], s72 offen offset:2048 lds
v_mfma_f32_16x16x32_bf16 a[20:23], v[160:163], v[148:151], 0
ds_read_b128 v[192:195], v25 offset:0
v_mfma_f32_16x16x32_bf16 a[24:27], v[160:163], v[152:155], 0
s_add_u32 s72, s71, 95232
buffer_load_dwordx4 v7, s[16:19], s72 offen offset:3072 lds
v_mfma_f32_16x16x32_bf16 a[28:31], v[160:163], v[156:159], 0
ds_read_b128 v[196:199], v25 offset:2048
v_mfma_f32_16x16x32_bf16 a[60:63], v[164:167], v[156:159], 0
s_add_u32 m0, s63, 102400
ds_read_b128 v[200:203], v25 offset:4096
v_mfma_f32_16x16x32_bf16 a[56:59], v[164:167], v[152:155], 0
s_add_u32 s72, s69, 32768
buffer_load_dwordx4 v2, s[8:11], s72 offen lds
v_mfma_f32_16x16x32_bf16 a[52:55], v[164:167], v[148:151], 0
s_add_u32 s72, s69, 39936
buffer_load_dwordx4 v3, s[8:11], s72 offen offset:1024 lds
v_mfma_f32_16x16x32_bf16 a[48:51], v[164:167], v[144:147], 0
ds_read_b128 v[204:207], v25 offset:6144
v_mfma_f32_16x16x32_bf16 a[44:47], v[164:167], v[140:143], 0
s_add_u32 s72, s69, 47104
buffer_load_dwordx4 v2, s[8:11], s72 offen offset:2048 lds
v_mfma_f32_16x16x32_bf16 a[40:43], v[164:167], v[136:139], 0
ds_read_b128 v[208:211], v25 offset:8192
v_mfma_f32_16x16x32_bf16 a[36:39], v[164:167], v[132:135], 0
s_add_u32 s72, s69, 54272
buffer_load_dwordx4 v3, s[8:11], s72 offen offset:3072 lds
v_mfma_f32_16x16x32_bf16 a[32:35], v[164:167], v[128:131], 0
ds_read_b128 v[212:215], v25 offset:10240
v_mfma_f32_16x16x32_bf16 a[64:67], v[168:171], v[128:131], 0
s_add_u32 m0, s64, 49152
ds_read_b128 v[216:219], v25 offset:12288
v_mfma_f32_16x16x32_bf16 a[68:71], v[168:171], v[132:135], 0
s_add_u32 s72, s71, 0
buffer_load_dwordx4 v6, s[20:23], s72 offen lds
v_mfma_f32_16x16x32_bf16 a[72:75], v[168:171], v[136:139], 0
s_add_u32 s72, s71, 31744
buffer_load_dwordx4 v6, s[20:23], s72 offen offset:1024 lds
v_mfma_f32_16x16x32_bf16 a[76:79], v[168:171], v[140:143], 0
ds_read_b128 v[220:223], v25 offset:14336
v_mfma_f32_16x16x32_bf16 a[80:83], v[168:171], v[144:147], 0
s_add_u32 s72, s71, 63488
buffer_load_dwordx4 v7, s[20:23], s72 offen offset:2048 lds
v_mfma_f32_16x16x32_bf16 a[84:87], v[168:171], v[148:151], 0
ds_read_b64_tr_b16 v[228:229], v21 offset:8192
v_mfma_f32_16x16x32_bf16 a[88:91], v[168:171], v[152:155], 0
s_add_u32 s72, s71, 95232
buffer_load_dwordx4 v7, s[20:23], s72 offen offset:3072 lds
v_mfma_f32_16x16x32_bf16 a[92:95], v[168:171], v[156:159], 0
s_mov_b32 s80, 0x100000
buffer_load_dword v126, v125, s[16:19], s80 offen
v_mfma_f32_16x16x32_bf16 a[124:127], v[172:175], v[156:159], 0
buffer_load_dword v126, v125, s[20:23], s80 offen
v_mfma_f32_16x16x32_bf16 a[120:123], v[172:175], v[152:155], 0
ds_read_b64_tr_b16 v[230:231], v21 offset:9216
v_mfma_f32_16x16x32_bf16 a[116:119], v[172:175], v[148:151], 0
ds_read_b64_tr_b16 v[232:233], v22 offset:8192
v_mfma_f32_16x16x32_bf16 a[112:115], v[172:175], v[144:147], 0
ds_read_b64_tr_b16 v[234:235], v22 offset:9216
v_mfma_f32_16x16x32_bf16 a[108:111], v[172:175], v[140:143], 0
ds_read_b64_tr_b16 v[236:237], v23 offset:8192
v_mfma_f32_16x16x32_bf16 a[104:107], v[172:175], v[136:139], 0
ds_read_b64_tr_b16 v[238:239], v23 offset:9216
v_mfma_f32_16x16x32_bf16 a[100:103], v[172:175], v[132:135], 0
ds_read_b64_tr_b16 v[240:241], v20 offset:24576
v_mfma_f32_16x16x32_bf16 a[96:99], v[172:175], v[128:131], 0
ds_read_b64_tr_b16 v[242:243], v20 offset:25600
v_mfma_f32_16x16x32_bf16 a[128:131], v[128:131], v[176:179], 0
ds_read_b64_tr_b16 v[244:245], v21 offset:24576
v_mfma_f32_16x16x32_bf16 a[132:135], v[132:135], v[176:179], 0
ds_read_b64_tr_b16 v[246:247], v21 offset:25600
v_mfma_f32_16x16x32_bf16 a[136:139], v[136:139], v[176:179], 0
ds_read_b64_tr_b16 v[248:249], v22 offset:24576
v_mfma_f32_16x16x32_bf16 a[140:143], v[140:143], v[176:179], 0
ds_read_b64_tr_b16 v[250:251], v22 offset:25600
v_mfma_f32_16x16x32_bf16 a[144:147], v[144:147], v[176:179], 0
ds_read_b64_tr_b16 v[252:253], v23 offset:24576
v_mfma_f32_16x16x32_bf16 a[148:151], v[148:151], v[176:179], 0
ds_read_b64_tr_b16 v[254:255], v23 offset:25600
v_mfma_f32_16x16x32_bf16 a[152:155], v[152:155], v[176:179], 0
v_mfma_f32_16x16x32_bf16 a[156:159], v[156:159], v[176:179], 0
v_mfma_f32_16x16x32_bf16 a[188:191], v[156:159], v[180:183], 0
v_mfma_f32_16x16x32_bf16 a[184:187], v[152:155], v[180:183], 0
v_mfma_f32_16x16x32_bf16 a[180:183], v[148:151], v[180:183], 0
v_mfma_f32_16x16x32_bf16 a[176:179], v[144:147], v[180:183], 0
v_mfma_f32_16x16x32_bf16 a[172:175], v[140:143], v[180:183], 0
v_mfma_f32_16x16x32_bf16 a[168:171], v[136:139], v[180:183], 0
v_mfma_f32_16x16x32_bf16 a[164:167], v[132:135], v[180:183], 0
v_mfma_f32_16x16x32_bf16 a[160:163], v[128:131], v[180:183], 0
v_mfma_f32_16x16x32_bf16 a[192:195], v[128:131], v[184:187], 0
v_mfma_f32_16x16x32_bf16 a[196:199], v[132:135], v[184:187], 0
v_mfma_f32_16x16x32_bf16 a[200:203], v[136:139], v[184:187], 0
v_mfma_f32_16x16x32_bf16 a[204:207], v[140:143], v[184:187], 0
v_mfma_f32_16x16x32_bf16 a[208:211], v[144:147], v[184:187], 0
v_mfma_f32_16x16x32_bf16 a[212:215], v[148:151], v[184:187], 0
v_mfma_f32_16x16x32_bf16 a[216:219], v[152:155], v[184:187], 0
v_mfma_f32_16x16x32_bf16 a[220:223], v[156:159], v[184:187], 0
v_mfma_f32_16x16x32_bf16 a[252:255], v[156:159], v[188:191], 0
v_mfma_f32_16x16x32_bf16 a[248:251], v[152:155], v[188:191], 0
v_mfma_f32_16x16x32_bf16 a[244:247], v[148:151], v[188:191], 0
v_mfma_f32_16x16x32_bf16 a[240:243], v[144:147], v[188:191], 0
v_mfma_f32_16x16x32_bf16 a[236:239], v[140:143], v[188:191], 0
v_mfma_f32_16x16x32_bf16 a[232:235], v[136:139], v[188:191], 0
s_nop 3
s_mov_b64 exec, 0
s_cmp_eq_u32 s58, 0
s_cbranch_scc1 Lstub0
s_cmp_eq_u32 s58, 1
s_cbranch_scc1 Lstub1
s_cmp_eq_u32 s58, 2
s_cbranch_scc1 Lstub2
s_branch Lstub3
Lret:
s_mov_b64 exec, -1
s_nop 3
v_mfma_f32_16x16x32_bf16 a[228:231], v[132:135], v[188:191], 0
s_waitcnt vmcnt(2) lgkmcnt(0)
v_mfma_f32_16x16x32_bf16 a[224:227], v[128:131], v[188:191], 0
s_barrier
v_mfma_f32_16x16x32_bf16 a[0:3], v[224:227], v[192:195], a[0:3]
s_and_b32 s73, s65, 1
ds_read_b64_tr_b16 v[160:161], v20 offset:32768
v_mfma_f32_16x16x32_bf16 a[4:7], v[224:227], v[196:199], a[4:7]
s_xor_b32 s73, s73, 2
ds_read_b64_tr_b16 v[162:163], v20 offset:33792
v_mfma_f32_16x16x32_bf16 a[8:11], v[224:227], v[200:203], a[8:11]
s_lshl_b32 s69, s73, 7
ds_read_b128 v[128:131], v24 offset:32768
v_mfma_f32_16x16x32_bf16 a[12:15], v[224:227], v[204:207], a[12:15]
s_add_u32 s69, s69, s84
ds_read_b128 v[132:135], v24 offset:34816
v_mfma_f32_16x16x32_bf16 a[16:19], v[224:227], v[208:211], a[16:19]
s_lshl_b32 s71, s73, 19
ds_read_b128 v[136:139], v24 offset:36864
v_mfma_f32_16x16x32_bf16 a[20:23], v[224:227], v[212:215], a[20:23]
s_add_u32 s71, s71, s66
ds_read_b128 v[140:143], v24 offset:38912
v_mfma_f32_16x16x32_bf16 a[24:27], v[224:227], v[216:219], a[24:27]
s_add_u32 m0, s63, 65536
ds_read_b128 v[144:147], v24 offset:40960
v_mfma_f32_16x16x32_bf16 a[28:31], v[224:227], v[220:223], a[28:31]
s_add_u32 s72, s69, 0
buffer_load_dwordx4 v2, s[8:11], s72 offen lds
v_mfma_f32_16x16x32_bf16 a[60:63], v[228:231], v[220:223], a[60:63]
s_add_u32 s72, s69, 7168
buffer_load_dwordx4 v3, s[8:11], s72 offen offset:1024 lds
v_mfma_f32_16x16x32_bf16 a[56:59], v[228:231], v[216:219], a[56:59]
s_add_u32 s72, s69, 14336
buffer_load_dwordx4 v2, s[8:11], s72 offen offset:2048 lds
v_mfma_f32_16x16x32_bf16 a[52:55], v[228:231], v[212:215], a[52:55]
ds_read_b128 v[148:151], v24 offset:43008
v_mfma_f32_16x16x32_bf16 a[48:51], v[228:231], v[208:211], a[48:51]
ds_read_b128 v[152:155], v24 offset:45056
v_mfma_f32_16x16x32_bf16 a[44:47], v[228:231], v[204:207], a[44:47]
s_add_u32 s72, s69, 21504
buffer_load_dwordx4 v3, s[8:11], s72 offen offset:3072 lds
v_mfma_f32_16x16x32_bf16 a[40:43], v[228:231], v[200:203], a[40:43]
ds_read_b128 v[156:159], v24 offset:47104
v_mfma_f32_16x16x32_bf16 a[36:39], v[228:231], v[196:199], a[36:39]
ds_read_b64_tr_b16 v[164:165], v21 offset:32768
v_mfma_f32_16x16x32_bf16 a[32:35], v[228:231], v[192:195], a[32:35]
ds_read_b64_tr_b16 v[166:167], v21 offset:33792
v_mfma_f32_16x16x32_bf16 a[64:67], v[232:235], v[192:195], a[64:67]
ds_read_b64_tr_b16 v[168:169], v22 offset:32768
v_mfma_f32_16x16x32_bf16 a[68:71], v[232:235], v[196:199], a[68:71]
s_add_u32 m0, s64, 0
ds_read_b64_tr_b16 v[170:171], v22 offset:33792
v_mfma_f32_16x16x32_bf16 a[72:75], v[232:235], v[200:203], a[72:75]
s_add_u32 s72, s71, 0
buffer_load_dwordx4 v6, s[16:19], s72 offen lds
v_mfma_f32_16x16x32_bf16 a[76:79], v[232:235], v[204:207], a[76:79]
ds_read_b64_tr_b16 v[172:173], v23 offset:32768
v_mfma_f32_16x16x32_bf16 a[80:83], v[232:235], v[208:211], a[80:83]
ds_read_b64_tr_b16 v[174:175], v23 offset:33792
v_mfma_f32_16x16x32_bf16 a[84:87], v[232:235], v[212:215], a[84:87]
s_add_u32 s72, s71, 31744
buffer_load_dwordx4 v6, s[16:19], s72 offen offset:1024 lds
v_mfma_f32_16x16x32_bf16 a[88:91], v[232:235], v[216:219], a[88:91]
ds_read_b64_tr_b16 v[176:177], v20 offset:49152
v_mfma_f32_16x16x32_bf16 a[92:95], v[232:235], v[220:223], a[92:95]
ds_read_b64_tr_b16 v[178:179], v20 offset:50176
v_mfma_f32_16x16x32_bf16 a[124:127], v[236:239], v[220:223], a[124:127]
ds_read_b64_tr_b16 v[180:181], v21 offset:49152
v_mfma_f32_16x16x32_bf16 a[120:123], v[236:239], v[216:219], a[120:123]
s_add_u32 s72, s71, 63488
buffer_load_dwordx4 v7, s[16:19], s72 offen offset:2048 lds
v_mfma_f32_16x16x32_bf16 a[116:119], v[236:239], v[212:215], a[116:119]
ds_read_b64_tr_b16 v[182:183], v21 offset:50176
v_mfma_f32_16x16x32_bf16 a[112:115], v[236:239], v[208:211], a[112:115]
ds_read_b64_tr_b16 v[184:185], v22 offset:49152
v_mfma_f32_16x16x32_bf16 a[108:111], v[236:239], v[204:207], a[108:111]
ds_read_b64_tr_b16 v[186:187], v22 offset:50176
v_mfma_f32_16x16x32_bf16 a[104:107], v[236:239], v[200:203], a[104:107]
ds_read_b64_tr_b16 v[188:189], v23 offset:49152
v_mfma_f32_16x16x32_bf16 a[100:103], v[236:239], v[196:199], a[100:103]
s_add_u32 s72, s71, 95232
buffer_load_dwordx4 v7, s[16:19], s72 offen offset:3072 lds
v_mfma_f32_16x16x32_bf16 a[96:99], v[236:239], v[192:195], a[96:99]
ds_read_b64_tr_b16 v[190:191], v23 offset:50176
v_mfma_f32_16x16x32_bf16 a[128:131], v[192:195], v[240:243], a[128:131]
v_mfma_f32_16x16x32_bf16 a[132:135], v[196:199], v[240:243], a[132:135]
v_mfma_f32_16x16x32_bf16 a[136:139], v[200:203], v[240:243], a[136:139]
s_add_u32 m0, s63, 69632
v_mfma_f32_16x16x32_bf16 a[140:143], v[204:207], v[240:243], a[140:143]
s_add_u32 s72, s69, 32768
buffer_load_dwordx4 v2, s[8:11], s72 offen lds
v_mfma_f32_16x16x32_bf16 a[144:147], v[208:211], v[240:243], a[144:147]
v_mfma_f32_16x16x32_bf16 a[148:151], v[212:215], v[240:243], a[148:151]
v_mfma_f32_16x16x32_bf16 a[152:155], v[216:219], v[240:243], a[152:155]
s_add_u32 s72, s69, 39936
buffer_load_dwordx4 v3, s[8:11], s72 offen offset:1024 lds
v_mfma_f32_16x16x32_bf16 a[156:159], v[220:223], v[240:243], a[156:159]
v_mfma_f32_16x16x32_bf16 a[188:191], v[220:223], v[244:247], a[188:191]
v_mfma_f32_16x16x32_bf16 a[184:187], v[216:219], v[244:247], a[184:187]
v_mfma_f32_16x16x32_bf16 a[180:183], v[212:215], v[244:247], a[180:183]
v_mfma_f32_16x16x32_bf16 a[176:179], v[208:211], v[244:247], a[176:179]
s_add_u32 s72, s69, 47104
buffer_load_dwordx4 v2, s[8:11], s72 offen offset:2048 lds
v_mfma_f32_16x16x32_bf16 a[172:175], v[204:207], v[244:247], a[172:175]
v_mfma_f32_16x16x32_bf16 a[168:171], v[200:203], v[244:247], a[168:171]
v_mfma_f32_16x16x32_bf16 a[164:167], v[196:199], v[244:247], a[164:167]
v_mfma_f32_16x16x32_bf16 a[160:163], v[192:195], v[244:247], a[160:163]
s_add_u32 s72, s69, 54272
buffer_load_dwordx4 v3, s[8:11], s72 offen offset:3072 lds
v_mfma_f32_16x16x32_bf16 a[192:195], v[192:195], v[248:251], a[192:195]
v_mfma_f32_16x16x32_bf16 a[196:199], v[196:199], v[248:251], a[196:199]
v_mfma_f32_16x16x32_bf16 a[200:203], v[200:203], v[248:251], a[200:203]
v_mfma_f32_16x16x32_bf16 a[204:207], v[204:207], v[248:251], a[204:207]
s_add_u32 m0, s64, 16384
v_mfma_f32_16x16x32_bf16 a[208:211], v[208:211], v[248:251], a[208:211]
s_add_u32 s72, s71, 0
buffer_load_dwordx4 v6, s[20:23], s72 offen lds
v_mfma_f32_16x16x32_bf16 a[212:215], v[212:215], v[248:251], a[212:215]
v_mfma_f32_16x16x32_bf16 a[216:219], v[216:219], v[248:251], a[216:219]
v_mfma_f32_16x16x32_bf16 a[220:223], v[220:223], v[248:251], a[220:223]
v_mfma_f32_16x16x32_bf16 a[252:255], v[220:223], v[252:255], a[252:255]
s_add_u32 s72, s71, 31744
buffer_load_dwordx4 v6, s[20:23], s72 offen offset:1024 lds
v_mfma_f32_16x16x32_bf16 a[248:251], v[216:219], v[252:255], a[248:251]
v_mfma_f32_16x16x32_bf16 a[244:247], v[212:215], v[252:255], a[244:247]
v_mfma_f32_16x16x32_bf16 a[240:243], v[208:211], v[252:255], a[240:243]
v_mfma_f32_16x16x32_bf16 a[236:239], v[204:207], v[252:255], a[236:239]
s_add_u32 s72, s71, 63488
buffer_load_dwordx4 v7, s[20:23], s72 offen offset:2048 lds
v_mfma_f32_16x16x32_bf16 a[232:235], v[200:203], v[252:255], a[232:235]
v_mfma_f32_16x16x32_bf16 a[228:231], v[196:199], v[252:255], a[228:231]
v_mfma_f32_16x16x32_bf16 a[224:227], v[192:195], v[252:255], a[224:227]
s_waitcnt lgkmcnt(0)
v_mfma_f32_16x16x32_bf16 a[0:3], v[160:163], v[128:131], a[0:3]
s_add_u32 s72, s71, 95232
buffer_load_dwordx4 v7, s[20:23], s72 offen offset:3072 lds
v_mfma_f32_16x16x32_bf16 a[4:7], v[160:163], v[132:135], a[4:7]
s_mov_b32 s80, 0x200000
buffer_load_dword v126, v125, s[16:19], s80 offen
v_mfma_f32_16x16x32_bf16 a[8:11], v[160:163], v[136:139], a[8:11]
buffer_load_dword v126, v125, s[20:23], s80 offen
v_mfma_f32_16x16x32_bf16 a[12:15], v[160:163], v[140:143], a[12:15]
global_load_dwordx4 v[68:71], v30, s[52:53]
v_mfma_f32_16x16x32_bf16 a[16:19], v[160:163], v[144:147], a[16:19]
buffer_load_dword v33, v27, s[28:31], 0 offen nt
v_mfma_f32_16x16x32_bf16 a[20:23], v[160:163], v[148:151], a[20:23]
buffer_load_dword v34, v27, s[28:31], 0 offen offset:2048 nt
v_mfma_f32_16x16x32_bf16 a[24:27], v[160:163], v[152:155], a[24:27]
ds_read_b64_tr_b16 v[224:225], v20 offset:40960
v_add_u32 v27, 0x1000, v27
v_mfma_f32_16x16x32_bf16 a[28:31], v[160:163], v[156:159], a[28:31]
buffer_load_dword v35, v27, s[28:31], 0 offen nt
v_mfma_f32_16x16x32_bf16 a[60:63], v[164:167], v[156:159], a[60:63]
s_add_u32 m0, s63, 131072
ds_read_b64_tr_b16 v[226:227], v20 offset:41984
v_mfma_f32_16x16x32_bf16 a[56:59], v[164:167], v[152:155], a[56:59]
s_add_u32 s80, s82, 0
buffer_load_dwordx4 v26, s[28:31], s80 offen nt lds
v_mfma_f32_16x16x32_bf16 a[52:55], v[164:167], v[148:151], a[52:55]
s_add_u32 s80, s82, 15360
buffer_load_dwordx4 v26, s[28:31], s80 offen offset:1024 nt lds
v_mfma_f32_16x16x32_bf16 a[48:51], v[164:167], v[144:147], a[48:51]
s_add_u32 s80, s82, 30720
buffer_load_dwordx4 v26, s[28:31], s80 offen offset:2048 nt lds
v_mfma_f32_16x16x32_bf16 a[44:47], v[164:167], v[140:143], a[44:47]
s_add_u32 s80, s82, 46080
buffer_load_dwordx4 v26, s[28:31], s80 offen offset:3072 nt lds
v_mfma_f32_16x16x32_bf16 a[40:43], v[164:167], v[136:139], a[40:43]
ds_read_b128 v[192:195], v25 offset:32768
v_mfma_f32_16x16x32_bf16 a[36:39], v[164:167], v[132:135], a[36:39]
ds_read_b128 v[196:199], v25 offset:34816
v_mfma_f32_16x16x32_bf16 a[32:35], v[164:167], v[128:131], a[32:35]
ds_read_b128 v[200:203], v25 offset:36864
v_mfma_f32_16x16x32_bf16 a[64:67], v[168:171], v[128:131], a[64:67]
ds_read_b128 v[204:207], v25 offset:38912
v_mfma_f32_16x16x32_bf16 a[68:71], v[168:171], v[132:135], a[68:71]
ds_read_b128 v[208:211], v25 offset:40960
v_mfma_f32_16x16x32_bf16 a[72:75], v[168:171], v[136:139], a[72:75]
ds_read_b128 v[212:215], v25 offset:43008
v_mfma_f32_16x16x32_bf16 a[76:79], v[168:171], v[140:143], a[76:79]
ds_read_b128 v[216:219], v25 offset:45056
v_mfma_f32_16x16x32_bf16 a[80:83], v[168:171], v[144:147], a[80:83]
ds_read_b128 v[220:223], v25 offset:47104
v_mfma_f32_16x16x32_bf16 a[84:87], v[168:171], v[148:151], a[84:87]
ds_read_b64_tr_b16 v[228:229], v21 offset:40960
v_mfma_f32_16x16x32_bf16 a[88:91], v[168:171], v[152:155], a[88:91]
ds_read_b64_tr_b16 v[230:231], v21 offset:41984
v_mfma_f32_16x16x32_bf16 a[92:95], v[168:171], v[156:159], a[92:95]
ds_read_b64_tr_b16 v[232:233], v22 offset:40960
v_mfma_f32_16x16x32_bf16 a[124:127], v[172:175], v[156:159], a[124:127]
ds_read_b64_tr_b16 v[234:235], v22 offset:41984
v_mfma_f32_16x16x32_bf16 a[120:123], v[172:175], v[152:155], a[120:123]
ds_read_b64_tr_b16 v[236:237], v23 offset:40960
v_mfma_f32_16x16x32_bf16 a[116:119], v[172:175], v[148:151], a[116:119]
ds_read_b64_tr_b16 v[238:239], v23 offset:41984
v_mfma_f32_16x16x32_bf16 a[112:115], v[172:175], v[144:147], a[112:115]
ds_read_b64_tr_b16 v[240:241], v20 offset:57344
v_mfma_f32_16x16x32_bf16 a[108:111], v[172:175], v[140:143], a[108:111]
ds_read_b64_tr_b16 v[242:243], v20 offset:58368
v_mfma_f32_16x16x32_bf16 a[104:107], v[172:175], v[136:139], a[104:107]
ds_read_b64_tr_b16 v[244:245], v21 offset:57344
v_mfma_f32_16x16x32_bf16 a[100:103], v[172:175], v[132:135], a[100:103]
ds_read_b64_tr_b16 v[246:247], v21 offset:58368
v_mfma_f32_16x16x32_bf16 a[96:99], v[172:175], v[128:131], a[96:99]
ds_read_b64_tr_b16 v[248:249], v22 offset:57344
v_mfma_f32_16x16x32_bf16 a[128:131], v[128:131], v[176:179], a[128:131]
ds_read_b64_tr_b16 v[250:251], v22 offset:58368
v_mfma_f32_16x16x32_bf16 a[132:135], v[132:135], v[176:179], a[132:135]
ds_read_b64_tr_b16 v[252:253], v23 offset:57344
v_mfma_f32_16x16x32_bf16 a[136:139], v[136:139], v[176:179], a[136:139]
ds_read_b64_tr_b16 v[254:255], v23 offset:58368
v_mfma_f32_16x16x32_bf16 a[140:143], v[140:143], v[176:179], a[140:143]
v_mfma_f32_16x16x32_bf16 a[144:147], v[144:147], v[176:179], a[144:147]
v_mfma_f32_16x16x32_bf16 a[148:151], v[148:151], v[176:179], a[148:151]
v_mfma_f32_16x16x32_bf16 a[152:155], v[152:155], v[176:179], a[152:155]
v_mfma_f32_16x16x32_bf16 a[156:159], v[156:159], v[176:179], a[156:159]
v_mfma_f32_16x16x32_bf16 a[188:191], v[156:159], v[180:183], a[188:191]
v_mfma_f32_16x16x32_bf16 a[184:187], v[152:155], v[180:183], a[184:187]
v_mfma_f32_16x16x32_bf16 a[180:183], v[148:151], v[180:183], a[180:183]
v_mfma_f32_16x16x32_bf16 a[176:179], v[144:147], v[180:183], a[176:179]
v_mfma_f32_16x16x32_bf16 a[172:175], v[140:143], v[180:183], a[172:175]
v_mfma_f32_16x16x32_bf16 a[168:171], v[136:139], v[180:183], a[168:171]
v_mfma_f32_16x16x32_bf16 a[164:167], v[132:135], v[180:183], a[164:167]
v_mfma_f32_16x16x32_bf16 a[160:163], v[128:131], v[180:183], a[160:163]
v_mfma_f32_16x16x32_bf16 a[192:195], v[128:131], v[184:187], a[192:195]
v_mfma_f32_16x16x32_bf16 a[196:199], v[132:135], v[184:187], a[196:199]
v_mfma_f32_16x16x32_bf16 a[200:203], v[136:139], v[184:187], a[200:203]
v_mfma_f32_16x16x32_bf16 a[204:207], v[140:143], v[184:187], a[204:207]
v_mfma_f32_16x16x32_bf16 a[208:211], v[144:147], v[184:187], a[208:211]
v_mfma_f32_16x16x32_bf16 a[212:215], v[148:151], v[184:187], a[212:215]
v_mfma_f32_16x16x32_bf16 a[216:219], v[152:155], v[184:187], a[216:219]
v_mfma_f32_16x16x32_bf16 a[220:223], v[156:159], v[184:187], a[220:223]
v_mfma_f32_16x16x32_bf16 a[252:255], v[156:159], v[188:191], a[252:255]
v_mfma_f32_16x16x32_bf16 a[248:251], v[152:155], v[188:191], a[248:251]
v_mfma_f32_16x16x32_bf16 a[244:247], v[148:151], v[188:191], a[244:247]
v_mfma_f32_16x16x32_bf16 a[240:243], v[144:147], v[188:191], a[240:243]
v_mfma_f32_16x16x32_bf16 a[236:239], v[140:143], v[188:191], a[236:239]
v_mfma_f32_16x16x32_bf16 a[232:235], v[136:139], v[188:191], a[232:235]
v_mfma_f32_16x16x32_bf16 a[228:231], v[132:135], v[188:191], a[228:231]
s_waitcnt vmcnt(10) lgkmcnt(0)
v_mfma_f32_16x16x32_bf16 a[224:227], v[128:131], v[188:191], a[224:227]
s_barrier
v_mfma_f32_16x16x32_bf16 a[0:3], v[224:227], v[192:195], a[0:3]
s_and_b32 s73, s65, 1
ds_read_b64_tr_b16 v[160:161], v20 offset:0
v_mfma_f32_16x16x32_bf16 a[4:7], v[224:227], v[196:199], a[4:7]
s_xor_b32 s73, s73, 3
ds_read_b64_tr_b16 v[162:163], v20 offset:1024
v_mfma_f32_16x16x32_bf16 a[8:11], v[224:227], v[200:203], a[8:11]
s_lshl_b32 s69, s73, 7
ds_read_b128 v[128:131], v24 offset:0
v_mfma_f32_16x16x32_bf16 a[12:15], v[224:227], v[204:207], a[12:15]
s_add_u32 s69, s69, s84
ds_read_b128 v[132:135], v24 offset:2048
v_mfma_f32_16x16x32_bf16 a[16:19], v[224:227], v[208:211], a[16:19]
s_lshl_b32 s71, s73, 19
ds_read_b128 v[136:139], v24 offset:4096
v_mfma_f32_16x16x32_bf16 a[20:23], v[224:227], v[212:215], a[20:23]
s_add_u32 s71, s71, s66
ds_read_b128 v[140:143], v24 offset:6144
v_mfma_f32_16x16x32_bf16 a[24:27], v[224:227], v[216:219], a[24:27]
s_add_u32 m0, s63, 98304
ds_read_b128 v[144:147], v24 offset:8192
v_mfma_f32_16x16x32_bf16 a[28:31], v[224:227], v[220:223], a[28:31]
s_add_u32 s72, s69, 0
buffer_load_dwordx4 v2, s[8:11], s72 offen lds
v_mfma_f32_16x16x32_bf16 a[60:63], v[228:231], v[220:223], a[60:63]
s_add_u32 s72, s69, 7168
buffer_load_dwordx4 v3, s[8:11], s72 offen offset:1024 lds
v_mfma_f32_16x16x32_bf16 a[56:59], v[228:231], v[216:219], a[56:59]
s_add_u32 s72, s69, 14336
buffer_load_dwordx4 v2, s[8:11], s72 offen offset:2048 lds
v_mfma_f32_16x16x32_bf16 a[52:55], v[228:231], v[212:215], a[52:55]
ds_read_b128 v[148:151], v24 offset:10240
v_mfma_f32_16x16x32_bf16 a[48:51], v[228:231], v[208:211], a[48:51]
ds_read_b128 v[152:155], v24 offset:12288
v_mfma_f32_16x16x32_bf16 a[44:47], v[228:231], v[204:207], a[44:47]
s_add_u32 s72, s69, 21504
buffer_load_dwordx4 v3, s[8:11], s72 offen offset:3072 lds
v_mfma_f32_16x16x32_bf16 a[40:43], v[228:231], v[200:203], a[40:43]
ds_read_b128 v[156:159], v24 offset:14336
v_mfma_f32_16x16x32_bf16 a[36:39], v[228:231], v[196:199], a[36:39]
ds_read_b64_tr_b16 v[164:165], v21 offset:0
v_mfma_f32_16x16x32_bf16 a[32:35], v[228:231], v[192:195], a[32:35]
ds_read_b64_tr_b16 v[166:167], v21 offset:1024
v_mfma_f32_16x16x32_bf16 a[64:67], v[232:235], v[192:195], a[64:67]
ds_read_b64_tr_b16 v[168:169], v22 offset:0
v_mfma_f32_16x16x32_bf16 a[68:71], v[232:235], v[196:199], a[68:71]
s_add_u32 m0, s64, 32768
ds_read_b64_tr_b16 v[170:171], v22 offset:1024
v_mfma_f32_16x16x32_bf16 a[72:75], v[232:235], v[200:203], a[72:75]
s_add_u32 s72, s71, 0
buffer_load_dwordx4 v6, s[16:19], s72 offen lds
v_mfma_f32_16x16x32_bf16 a[76:79], v[232:235], v[204:207], a[76:79]
ds_read_b64_tr_b16 v[172:173], v23 offset:0
v_mfma_f32_16x16x32_bf16 a[80:83], v[232:235], v[208:211], a[80:83]
ds_read_b64_tr_b16 v[174:175], v23 offset:1024
v_mfma_f32_16x16x32_bf16 a[84:87], v[232:235], v[212:215], a[84:87]
s_add_u32 s72, s71, 31744
buffer_load_dwordx4 v6, s[16:19], s72 offen offset:1024 lds
v_mfma_f32_16x16x32_bf16 a[88:91], v[232:235], v[216:219], a[88:91]
ds_read_b64_tr_b16 v[176:177], v20 offset:16384
v_mfma_f32_16x16x32_bf16 a[92:95], v[232:235], v[220:223], a[92:95]
ds_read_b64_tr_b16 v[178:179], v20 offset:17408
v_mfma_f32_16x16x32_bf16 a[124:127], v[236:239], v[220:223], a[124:127]
ds_read_b64_tr_b16 v[180:181], v21 offset:16384
v_mfma_f32_16x16x32_bf16 a[120:123], v[236:239], v[216:219], a[120:123]
s_add_u32 s72, s71, 63488
buffer_load_dwordx4 v7, s[16:19], s72 offen offset:2048 lds
v_mfma_f32_16x16x32_bf16 a[116:119], v[236:239], v[212:215], a[116:119]
ds_read_b64_tr_b16 v[182:183], v21 offset:17408
v_mfma_f32_16x16x32_bf16 a[112:115], v[236:239], v[208:211], a[112:115]
ds_read_b64_tr_b16 v[184:185], v22 offset:16384
v_mfma_f32_16x16x32_bf16 a[108:111], v[236:239], v[204:207], a[108:111]
ds_read_b64_tr_b16 v[186:187], v22 offset:17408
v_mfma_f32_16x16x32_bf16 a[104:107], v[236:239], v[200:203], a[104:107]
ds_read_b64_tr_b16 v[188:189], v23 offset:16384
v_mfma_f32_16x16x32_bf16 a[100:103], v[236:239], v[196:199], a[100:103]
s_add_u32 s72, s71, 95232
buffer_load_dwordx4 v7, s[16:19], s72 offen offset:3072 lds
v_mfma_f32_16x16x32_bf16 a[96:99], v[236:239], v[192:195], a[96:99]
ds_read_b64_tr_b16 v[190:191], v23 offset:17408
v_mfma_f32_16x16x32_bf16 a[128:131], v[192:195], v[240:243], a[128:131]
v_mfma_f32_16x16x32_bf16 a[132:135], v[196:199], v[240:243], a[132:135]
v_mfma_f32_16x16x32_bf16 a[136:139], v[200:203], v[240:243], a[136:139]
s_add_u32 m0, s63, 102400
v_mfma_f32_16x16x32_bf16 a[140:143], v[204:207], v[240:243], a[140:143]
s_add_u32 s72, s69, 32768
buffer_load_dwordx4 v2, s[8:11], s72 offen lds
v_mfma_f32_16x16x32_bf16 a[144:147], v[208:211], v[240:243], a[144:147]
v_mfma_f32_16x16x32_bf16 a[148:151], v[212:215], v[240:243], a[148:151]
v_mfma_f32_16x16x32_bf16 a[152:155], v[216:219], v[240:243], a[152:155]
s_add_u32 s72, s69, 39936
buffer_load_dwordx4 v3, s[8:11], s72 offen offset:1024 lds
v_mfma_f32_16x16x32_bf16 a[156:159], v[220:223], v[240:243], a[156:159]
v_mfma_f32_16x16x32_bf16 a[188:191], v[220:223], v[244:247], a[188:191]
v_mfma_f32_16x16x32_bf16 a[184:187], v[216:219], v[244:247], a[184:187]
v_mfma_f32_16x16x32_bf16 a[180:183], v[212:215], v[244:247], a[180:183]
v_mfma_f32_16x16x32_bf16 a[176:179], v[208:211], v[244:247], a[176:179]
s_add_u32 s72, s69, 47104
buffer_load_dwordx4 v2, s[8:11], s72 offen offset:2048 lds
v_mfma_f32_16x16x32_bf16 a[172:175], v[204:207], v[244:247], a[172:175]
v_mfma_f32_16x16x32_bf16 a[168:171], v[200:203], v[244:247], a[168:171]
v_mfma_f32_16x16x32_bf16 a[164:167], v[196:199], v[244:247], a[164:167]
v_mfma_f32_16x16x32_bf16 a[160:163], v[192:195], v[244:247], a[160:163]
s_add_u32 s72, s69, 54272
buffer_load_dwordx4 v3, s[8:11], s72 offen offset:3072 lds
v_mfma_f32_16x16x32_bf16 a[192:195], v[192:195], v[248:251], a[192:195]
v_mfma_f32_16x16x32_bf16 a[196:199], v[196:199], v[248:251], a[196:199]
v_mfma_f32_16x16x32_bf16 a[200:203], v[200:203], v[248:251], a[200:203]
v_mfma_f32_16x16x32_bf16 a[204:207], v[204:207], v[248:251], a[204:207]
s_add_u32 m0, s64, 49152
v_mfma_f32_16x16x32_bf16 a[208:211], v[208:211], v[248:251], a[208:211]
s_add_u32 s72, s71, 0
buffer_load_dwordx4 v6, s[20:23], s72 offen lds
v_mfma_f32_16x16x32_bf16 a[212:215], v[212:215], v[248:251], a[212:215]
v_mfma_f32_16x16x32_bf16 a[216:219], v[216:219], v[248:251], a[216:219]
v_mfma_f32_16x16x32_bf16 a[220:223], v[220:223], v[248:251], a[220:223]
v_mfma_f32_16x16x32_bf16 a[252:255], v[220:223], v[252:255], a[252:255]
s_add_u32 s72, s71, 31744
buffer_load_dwordx4 v6, s[20:23], s72 offen offset:1024 lds
v_mfma_f32_16x16x32_bf16 a[248:251], v[216:219], v[252:255], a[248:251]
v_mfma_f32_16x16x32_bf16 a[244:247], v[212:215], v[252:255], a[244:247]
v_mfma_f32_16x16x32_bf16 a[240:243], v[208:211], v[252:255], a[240:243]
v_mfma_f32_16x16x32_bf16 a[236:239], v[204:207], v[252:255], a[236:239]
s_add_u32 s72, s71, 63488
buffer_load_dwordx4 v7, s[20:23], s72 offen offset:2048 lds
v_mfma_f32_16x16x32_bf16 a[232:235], v[200:203], v[252:255], a[232:235]
v_mfma_f32_16x16x32_bf16 a[228:231], v[196:199], v[252:255], a[228:231]
v_mfma_f32_16x16x32_bf16 a[224:227], v[192:195], v[252:255], a[224:227]
s_waitcnt lgkmcnt(0)
v_mfma_f32_16x16x32_bf16 a[0:3], v[160:163], v[128:131], a[0:3]
s_add_u32 s72, s71, 95232
buffer_load_dwordx4 v7, s[20:23], s72 offen offset:3072 lds
v_mfma_f32_16x16x32_bf16 a[4:7], v[160:163], v[132:135], a[4:7]
s_mov_b32 s80, 0x300000
buffer_load_dword v126, v125, s[16:19], s80 offen
v_mfma_f32_16x16x32_bf16 a[8:11], v[160:163], v[136:139], a[8:11]
buffer_load_dword v126, v125, s[20:23], s80 offen
v_mfma_f32_16x16x32_bf16 a[12:15], v[160:163], v[140:143], a[12:15]
s_add_u32 m0, s63, 135168
ds_read_b64_tr_b16 v[224:225], v20 offset:8192
v_mfma_f32_16x16x32_bf16 a[16:19], v[160:163], v[144:147], a[16:19]
s_add_u32 s80, s82, 0
buffer_load_dwordx4 v26, s[32:35], s80 offen nt lds
v_mfma_f32_16x16x32_bf16 a[20:23], v[160:163], v[148:151], a[20:23]
s_add_u32 s80, s82, 15360
buffer_load_dwordx4 v26, s[32:35], s80 offen offset:1024 nt lds
v_mfma_f32_16x16x32_bf16 a[24:27], v[160:163], v[152:155], a[24:27]
s_add_u32 s80, s82, 30720
buffer_load_dwordx4 v26, s[32:35], s80 offen offset:2048 nt lds
v_mfma_f32_16x16x32_bf16 a[28:31], v[160:163], v[156:159], a[28:31]
s_add_u32 s80, s82, 46080
buffer_load_dwordx4 v26, s[32:35], s80 offen offset:3072 nt lds
v_mfma_f32_16x16x32_bf16 a[60:63], v[164:167], v[156:159], a[60:63]
ds_read_b64_tr_b16 v[226:227], v20 offset:9216
v_mfma_f32_16x16x32_bf16 a[56:59], v[164:167], v[152:155], a[56:59]
ds_read_b128 v[192:195], v25 offset:0
v_mfma_f32_16x16x32_bf16 a[52:55], v[164:167], v[148:151], a[52:55]
ds_read_b128 v[196:199], v25 offset:2048
v_mfma_f32_16x16x32_bf16 a[48:51], v[164:167], v[144:147], a[48:51]
ds_read_b128 v[200:203], v25 offset:4096
v_mfma_f32_16x16x32_bf16 a[44:47], v[164:167], v[140:143], a[44:47]
ds_read_b128 v[204:207], v25 offset:6144
v_mfma_f32_16x16x32_bf16 a[40:43], v[164:167], v[136:139], a[40:43]
ds_read_b128 v[208:211], v25 offset:8192
v_mfma_f32_16x16x32_bf16 a[36:39], v[164:167], v[132:135], a[36:39]
ds_read_b128 v[212:215], v25 offset:10240
v_mfma_f32_16x16x32_bf16 a[32:35], v[164:167], v[128:131], a[32:35]
ds_read_b128 v[216:219], v25 offset:12288
v_mfma_f32_16x16x32_bf16 a[64:67], v[168:171], v[128:131], a[64:67]
ds_read_b128 v[220:223], v25 offset:14336
v_mfma_f32_16x16x32_bf16 a[68:71], v[168:171], v[132:135], a[68:71]
ds_read_b64_tr_b16 v[228:229], v21 offset:8192
v_mfma_f32_16x16x32_bf16 a[72:75], v[168:171], v[136:139], a[72:75]
ds_read_b64_tr_b16 v[230:231], v21 offset:9216
v_mfma_f32_16x16x32_bf16 a[76:79], v[168:171], v[140:143], a[76:79]
ds_read_b64_tr_b16 v[232:233], v22 offset:8192
v_mfma_f32_16x16x32_bf16 a[80:83], v[168:171], v[144:147], a[80:83]
ds_read_b64_tr_b16 v[234:235], v22 offset:9216
v_mfma_f32_16x16x32_bf16 a[84:87], v[168:171], v[148:151], a[84:87]
ds_read_b64_tr_b16 v[236:237], v23 offset:8192
v_mfma_f32_16x16x32_bf16 a[88:91], v[168:171], v[152:155], a[88:91]
ds_read_b64_tr_b16 v[238:239], v23 offset:9216
v_mfma_f32_16x16x32_bf16 a[92:95], v[168:171], v[156:159], a[92:95]
ds_read_b64_tr_b16 v[240:241], v20 offset:24576
v_mfma_f32_16x16x32_bf16 a[124:127], v[172:175], v[156:159], a[124:127]
ds_read_b64_tr_b16 v[242:243], v20 offset:25600
v_mfma_f32_16x16x32_bf16 a[120:123], v[172:175], v[152:155], a[120:123]
ds_read_b64_tr_b16 v[244:245], v21 offset:24576
v_mfma_f32_16x16x32_bf16 a[116:119], v[172:175], v[148:151], a[116:119]
ds_read_b64_tr_b16 v[246:247], v21 offset:25600
v_mfma_f32_16x16x32_bf16 a[112:115], v[172:175], v[144:147], a[112:115]
ds_read_b64_tr_b16 v[248:249], v22 offset:24576
v_mfma_f32_16x16x32_bf16 a[108:111], v[172:175], v[140:143], a[108:111]
ds_read_b64_tr_b16 v[250:251], v22 offset:25600
v_mfma_f32_16x16x32_bf16 a[104:107], v[172:175], v[136:139], a[104:107]
ds_read_b64_tr_b16 v[252:253], v23 offset:24576
v_mfma_f32_16x16x32_bf16 a[100:103], v[172:175], v[132:135], a[100:103]
ds_read_b64_tr_b16 v[254:255], v23 offset:25600
v_mfma_f32_16x16x32_bf16 a[96:99], v[172:175], v[128:131], a[96:99]
v_mfma_f32_16x16x32_bf16 a[128:131], v[128:131], v[176:179], a[128:131]
v_mfma_f32_16x16x32_bf16 a[132:135], v[132:135], v[176:179], a[132:135]
v_mfma_f32_16x16x32_bf16 a[136:139], v[136:139], v[176:179], a[136:139]
v_mfma_f32_16x16x32_bf16 a[140:143], v[140:143], v[176:179], a[140:143]
v_mfma_f32_16x16x32_bf16 a[144:147], v[144:147], v[176:179], a[144:147]
v_mfma_f32_16x16x32_bf16 a[148:151], v[148:151], v[176:179], a[148:151]
v_mfma_f32_16x16x32_bf16 a[152:155], v[152:155], v[176:179], a[152:155]
v_mfma_f32_16x16x32_bf16 a[156:159], v[156:159], v[176:179], a[156:159]
v_mfma_f32_16x16x32_bf16 a[188:191], v[156:159], v[180:183], a[188:191]
v_mfma_f32_16x16x32_bf16 a[184:187], v[152:155], v[180:183], a[184:187]
v_mfma_f32_16x16x32_bf16 a[180:183], v[148:151], v[180:183], a[180:183]
v_mfma_f32_16x16x32_bf16 a[176:179], v[144:147], v[180:183], a[176:179]
v_mfma_f32_16x16x32_bf16 a[172:175], v[140:143], v[180:183], a[172:175]
v_mfma_f32_16x16x32_bf16 a[168:171], v[136:139], v[180:183], a[168:171]
v_mfma_f32_16x16x32_bf16 a[164:167], v[132:135], v[180:183], a[164:167]
v_mfma_f32_16x16x32_bf16 a[160:163], v[128:131], v[180:183], a[160:163]
v_mfma_f32_16x16x32_bf16 a[192:195], v[128:131], v[184:187], a[192:195]
v_mfma_f32_16x16x32_bf16 a[196:199], v[132:135], v[184:187], a[196:199]
v_mfma_f32_16x16x32_bf16 a[200:203], v[136:139], v[184:187], a[200:203]
v_mfma_f32_16x16x32_bf16 a[204:207], v[140:143], v[184:187], a[204:207]
v_mfma_f32_16x16x32_bf16 a[208:211], v[144:147], v[184:187], a[208:211]
v_mfma_f32_16x16x32_bf16 a[212:215], v[148:151], v[184:187], a[212:215]
v_mfma_f32_16x16x32_bf16 a[216:219], v[152:155], v[184:187], a[216:219]
v_mfma_f32_16x16x32_bf16 a[220:223], v[156:159], v[184:187], a[220:223]
v_mfma_f32_16x16x32_bf16 a[252:255], v[156:159], v[188:191], a[252:255]
v_mfma_f32_16x16x32_bf16 a[248:251], v[152:155], v[188:191], a[248:251]
v_mfma_f32_16x16x32_bf16 a[244:247], v[148:151], v[188:191], a[244:247]
v_mfma_f32_16x16x32_bf16 a[240:243], v[144:147], v[188:191], a[240:243]
v_mfma_f32_16x16x32_bf16 a[236:239], v[140:143], v[188:191], a[236:239]
v_mfma_f32_16x16x32_bf16 a[232:235], v[136:139], v[188:191], a[232:235]
v_mfma_f32_16x16x32_bf16 a[228:231], v[132:135], v[188:191], a[228:231]
s_waitcnt vmcnt(6) lgkmcnt(0)
v_mfma_f32_16x16x32_bf16 a[224:227], v[128:131], v[188:191], a[224:227]
s_barrier
v_mfma_f32_16x16x32_bf16 a[0:3], v[224:227], v[192:195], a[0:3]
s_and_b32 s73, s65, 1
ds_read_b64_tr_b16 v[160:161], v20 offset:32768
v_mfma_f32_16x16x32_bf16 a[4:7], v[224:227], v[196:199], a[4:7]
s_xor_b32 s73, s73, 4
ds_read_b64_tr_b16 v[162:163], v20 offset:33792
v_mfma_f32_16x16x32_bf16 a[8:11], v[224:227], v[200:203], a[8:11]
s_lshl_b32 s69, s73, 7
ds_read_b128 v[128:131], v24 offset:32768
v_mfma_f32_16x16x32_bf16 a[12:15], v[224:227], v[204:207], a[12:15]
s_add_u32 s69, s69, s84
ds_read_b128 v[132:135], v24 offset:34816
v_mfma_f32_16x16x32_bf16 a[16:19], v[224:227], v[208:211], a[16:19]
s_lshl_b32 s71, s73, 19
ds_read_b128 v[136:139], v24 offset:36864
v_mfma_f32_16x16x32_bf16 a[20:23], v[224:227], v[212:215], a[20:23]
s_add_u32 s71, s71, s66
ds_read_b128 v[140:143], v24 offset:38912
v_mfma_f32_16x16x32_bf16 a[24:27], v[224:227], v[216:219], a[24:27]
s_add_u32 m0, s63, 65536
ds_read_b128 v[144:147], v24 offset:40960
v_mfma_f32_16x16x32_bf16 a[28:31], v[224:227], v[220:223], a[28:31]
s_add_u32 s72, s69, 0
buffer_load_dwordx4 v2, s[8:11], s72 offen lds
v_mfma_f32_16x16x32_bf16 a[60:63], v[228:231], v[220:223], a[60:63]
s_add_u32 s72, s69, 7168
buffer_load_dwordx4 v3, s[8:11], s72 offen offset:1024 lds
v_mfma_f32_16x16x32_bf16 a[56:59], v[228:231], v[216:219], a[56:59]
s_add_u32 s72, s69, 14336
buffer_load_dwordx4 v2, s[8:11], s72 offen offset:2048 lds
v_mfma_f32_16x16x32_bf16 a[52:55], v[228:231], v[212:215], a[52:55]
ds_read_b128 v[148:151], v24 offset:43008
v_mfma_f32_16x16x32_bf16 a[48:51], v[228:231], v[208:211], a[48:51]
ds_read_b128 v[152:155], v24 offset:45056
v_mfma_f32_16x16x32_bf16 a[44:47], v[228:231], v[204:207], a[44:47]
s_add_u32 s72, s69, 21504
buffer_load_dwordx4 v3, s[8:11], s72 offen offset:3072 lds
v_mfma_f32_16x16x32_bf16 a[40:43], v[228:231], v[200:203], a[40:43]
ds_read_b128 v[156:159], v24 offset:47104
v_mfma_f32_16x16x32_bf16 a[36:39], v[228:231], v[196:199], a[36:39]
ds_read_b64_tr_b16 v[164:165], v21 offset:32768
v_mfma_f32_16x16x32_bf16 a[32:35], v[228:231], v[192:195], a[32:35]
ds_read_b64_tr_b16 v[166:167], v21 offset:33792
v_mfma_f32_16x16x32_bf16 a[64:67], v[232:235], v[192:195], a[64:67]
ds_read_b64_tr_b16 v[168:169], v22 offset:32768
v_mfma_f32_16x16x32_bf16 a[68:71], v[232:235], v[196:199], a[68:71]
s_add_u32 m0, s64, 0
ds_read_b64_tr_b16 v[170:171], v22 offset:33792
v_mfma_f32_16x16x32_bf16 a[72:75], v[232:235], v[200:203], a[72:75]
s_add_u32 s72, s71, 0
buffer_load_dwordx4 v6, s[16:19], s72 offen lds
v_mfma_f32_16x16x32_bf16 a[76:79], v[232:235], v[204:207], a[76:79]
ds_read_b64_tr_b16 v[172:173], v23 offset:32768
v_mfma_f32_16x16x32_bf16 a[80:83], v[232:235], v[208:211], a[80:83]
ds_read_b64_tr_b16 v[174:175], v23 offset:33792
v_mfma_f32_16x16x32_bf16 a[84:87], v[232:235], v[212:215], a[84:87]
s_add_u32 s72, s71, 31744
buffer_load_dwordx4 v6, s[16:19], s72 offen offset:1024 lds
v_mfma_f32_16x16x32_bf16 a[88:91], v[232:235], v[216:219], a[88:91]
ds_read_b64_tr_b16 v[176:177], v20 offset:49152
v_mfma_f32_16x16x32_bf16 a[92:95], v[232:235], v[220:223], a[92:95]
ds_read_b64_tr_b16 v[178:179], v20 offset:50176
v_mfma_f32_16x16x32_bf16 a[124:127], v[236:239], v[220:223], a[124:127]
ds_read_b64_tr_b16 v[180:181], v21 offset:49152
v_mfma_f32_16x16x32_bf16 a[120:123], v[236:239], v[216:219], a[120:123]
s_add_u32 s72, s71, 63488
buffer_load_dwordx4 v7, s[16:19], s72 offen offset:2048 lds
v_mfma_f32_16x16x32_bf16 a[116:119], v[236:239], v[212:215], a[116:119]
ds_read_b64_tr_b16 v[182:183], v21 offset:50176
v_mfma_f32_16x16x32_bf16 a[112:115], v[236:239], v[208:211], a[112:115]
ds_read_b64_tr_b16 v[184:185], v22 offset:49152
v_mfma_f32_16x16x32_bf16 a[108:111], v[236:239], v[204:207], a[108:111]
ds_read_b64_tr_b16 v[186:187], v22 offset:50176
v_mfma_f32_16x16x32_bf16 a[104:107], v[236:239], v[200:203], a[104:107]
ds_read_b64_tr_b16 v[188:189], v23 offset:49152
v_mfma_f32_16x16x32_bf16 a[100:103], v[236:239], v[196:199], a[100:103]
s_add_u32 s72, s71, 95232
buffer_load_dwordx4 v7, s[16:19], s72 offen offset:3072 lds
v_mfma_f32_16x16x32_bf16 a[96:99], v[236:239], v[192:195], a[96:99]
ds_read_b64_tr_b16 v[190:191], v23 offset:50176
v_mfma_f32_16x16x32_bf16 a[128:131], v[192:195], v[240:243], a[128:131]
v_mfma_f32_16x16x32_bf16 a[132:135], v[196:199], v[240:243], a[132:135]
v_mfma_f32_16x16x32_bf16 a[136:139], v[200:203], v[240:243], a[136:139]
s_add_u32 m0, s63, 69632
v_mfma_f32_16x16x32_bf16 a[140:143], v[204:207], v[240:243], a[140:143]
s_add_u32 s72, s69, 32768
buffer_load_dwordx4 v2, s[8:11], s72 offen lds
v_mfma_f32_16x16x32_bf16 a[144:147], v[208:211], v[240:243], a[144:147]
v_mfma_f32_16x16x32_bf16 a[148:151], v[212:215], v[240:243], a[148:151]
v_mfma_f32_16x16x32_bf16 a[152:155], v[216:219], v[240:243], a[152:155]
s_add_u32 s72, s69, 39936
buffer_load_dwordx4 v3, s[8:11], s72 offen offset:1024 lds
v_mfma_f32_16x16x32_bf16 a[156:159], v[220:223], v[240:243], a[156:159]
v_mfma_f32_16x16x32_bf16 a[188:191], v[220:223], v[244:247], a[188:191]
v_mfma_f32_16x16x32_bf16 a[184:187], v[216:219], v[244:247], a[184:187]
v_mfma_f32_16x16x32_bf16 a[180:183], v[212:215], v[244:247], a[180:183]
v_mfma_f32_16x16x32_bf16 a[176:179], v[208:211], v[244:247], a[176:179]
s_add_u32 s72, s69, 47104
buffer_load_dwordx4 v2, s[8:11], s72 offen offset:2048 lds
v_mfma_f32_16x16x32_bf16 a[172:175], v[204:207], v[244:247], a[172:175]
v_mfma_f32_16x16x32_bf16 a[168:171], v[200:203], v[244:247], a[168:171]
v_mfma_f32_16x16x32_bf16 a[164:167], v[196:199], v[244:247], a[164:167]
v_mfma_f32_16x16x32_bf16 a[160:163], v[192:195], v[244:247], a[160:163]
s_add_u32 s72, s69, 54272
buffer_load_dwordx4 v3, s[8:11], s72 offen offset:3072 lds
v_mfma_f32_16x16x32_bf16 a[192:195], v[192:195], v[248:251], a[192:195]
v_mfma_f32_16x16x32_bf16 a[196:199], v[196:199], v[248:251], a[196:199]
v_mfma_f32_16x16x32_bf16 a[200:203], v[200:203], v[248:251], a[200:203]
v_mfma_f32_16x16x32_bf16 a[204:207], v[204:207], v[248:251], a[204:207]
s_add_u32 m0, s64, 16384
v_mfma_f32_16x16x32_bf16 a[208:211], v[208:211], v[248:251], a[208:211]
s_add_u32 s72, s71, 0
buffer_load_dwordx4 v6, s[20:23], s72 offen lds
v_mfma_f32_16x16x32_bf16 a[212:215], v[212:215], v[248:251], a[212:215]
v_mfma_f32_16x16x32_bf16 a[216:219], v[216:219], v[248:251], a[216:219]
v_mfma_f32_16x16x32_bf16 a[220:223], v[220:223], v[248:251], a[220:223]
v_mfma_f32_16x16x32_bf16 a[252:255], v[220:223], v[252:255], a[252:255]
s_add_u32 s72, s71, 31744
buffer_load_dwordx4 v6, s[20:23], s72 offen offset:1024 lds
v_mfma_f32_16x16x32_bf16 a[248:251], v[216:219], v[252:255], a[248:251]
v_mfma_f32_16x16x32_bf16 a[244:247], v[212:215], v[252:255], a[244:247]
v_mfma_f32_16x16x32_bf16 a[240:243], v[208:211], v[252:255], a[240:243]
v_mfma_f32_16x16x32_bf16 a[236:239], v[204:207], v[252:255], a[236:239]
s_add_u32 s72, s71, 63488
buffer_load_dwordx4 v7, s[20:23], s72 offen offset:2048 lds
v_mfma_f32_16x16x32_bf16 a[232:235], v[200:203], v[252:255], a[232:235]
v_mfma_f32_16x16x32_bf16 a[228:231], v[196:199], v[252:255], a[228:231]
v_mfma_f32_16x16x32_bf16 a[224:227], v[192:195], v[252:255], a[224:227]
s_waitcnt lgkmcnt(0)
v_mfma_f32_16x16x32_bf16 a[0:3], v[160:163], v[128:131], a[0:3]
s_add_u32 s72, s71, 95232
buffer_load_dwordx4 v7, s[20:23], s72 offen offset:3072 lds
v_mfma_f32_16x16x32_bf16 a[4:7], v[160:163], v[132:135], a[4:7]
buffer_load_dwordx4 v[108:111], v1, s[4:7], s76 offen
v_mfma_f32_16x16x32_bf16 a[8:11], v[160:163], v[136:139], a[8:11]
buffer_load_dwordx4 v[112:115], v1, s[4:7], s76 offen offset:1024
v_mfma_f32_16x16x32_bf16 a[12:15], v[160:163], v[140:143], a[12:15]
buffer_load_dwordx4 v[116:119], v1, s[4:7], s76 offen offset:2048
v_mfma_f32_16x16x32_bf16 a[16:19], v[160:163], v[144:147], a[16:19]
buffer_load_dwordx4 v[120:123], v1, s[4:7], s76 offen offset:3072
v_mfma_f32_16x16x32_bf16 a[20:23], v[160:163], v[148:151], a[20:23]
ds_read_b64_tr_b16 v[224:225], v20 offset:40960
v_mfma_f32_16x16x32_bf16 a[24:27], v[160:163], v[152:155], a[24:27]
v_mfma_f32_16x16x32_bf16 a[28:31], v[160:163], v[156:159], a[28:31]
ds_read_b64_tr_b16 v[226:227], v20 offset:41984
v_mfma_f32_16x16x32_bf16 a[60:63], v[164:167], v[156:159], a[60:63]
v_mfma_f32_16x16x32_bf16 a[56:59], v[164:167], v[152:155], a[56:59]
ds_read_b128 v[192:195], v25 offset:32768
v_mfma_f32_16x16x32_bf16 a[52:55], v[164:167], v[148:151], a[52:55]
v_mfma_f32_16x16x32_bf16 a[48:51], v[164:167], v[144:147], a[48:51]
ds_read_b128 v[196:199], v25 offset:34816
v_mfma_f32_16x16x32_bf16 a[44:47], v[164:167], v[140:143], a[44:47]
v_mfma_f32_16x16x32_bf16 a[40:43], v[164:167], v[136:139], a[40:43]
ds_read_b128 v[200:203], v25 offset:36864
v_mfma_f32_16x16x32_bf16 a[36:39], v[164:167], v[132:135], a[36:39]
v_mfma_f32_16x16x32_bf16 a[32:35], v[164:167], v[128:131], a[32:35]
ds_read_b128 v[204:207], v25 offset:38912
v_mfma_f32_16x16x32_bf16 a[64:67], v[168:171], v[128:131], a[64:67]
v_mfma_f32_16x16x32_bf16 a[68:71], v[168:171], v[132:135], a[68:71]
ds_read_b128 v[208:211], v25 offset:40960
v_mfma_f32_16x16x32_bf16 a[72:75], v[168:171], v[136:139], a[72:75]
v_mfma_f32_16x16x32_bf16 a[76:79], v[168:171], v[140:143], a[76:79]
ds_read_b128 v[212:215], v25 offset:43008
v_mfma_f32_16x16x32_bf16 a[80:83], v[168:171], v[144:147], a[80:83]
s_waitcnt vmcnt(20)
ds_read2_b32 v[36:37], v98 offset0:0 offset1:32
ds_read2_b32 v[38:39], v98 offset0:64 offset1:96
v_mfma_f32_16x16x32_bf16 a[84:87], v[168:171], v[148:151], a[84:87]
ds_read_b128 v[216:219], v25 offset:45056
ds_read2_b32 v[40:41], v98 offset0:128 offset1:160
v_mfma_f32_16x16x32_bf16 a[88:91], v[168:171], v[152:155], a[88:91]
ds_read2_b32 v[42:43], v98 offset0:192 offset1:224
v_add_u32 v98, 1024, v98
v_mfma_f32_16x16x32_bf16 a[92:95], v[168:171], v[156:159], a[92:95]
ds_read_b128 v[220:223], v25 offset:47104
ds_read2_b32 v[44:45], v98 offset0:0 offset1:32
v_mfma_f32_16x16x32_bf16 a[124:127], v[172:175], v[156:159], a[124:127]
ds_read2_b32 v[46:47], v98 offset0:64 offset1:96
ds_read2_b32 v[48:49], v98 offset0:128 offset1:160
v_mfma_f32_16x16x32_bf16 a[120:123], v[172:175], v[152:155], a[120:123]
ds_read_b64_tr_b16 v[228:229], v21 offset:40960
ds_read2_b32 v[50:51], v98 offset0:192 offset1:224
v_mfma_f32_16x16x32_bf16 a[116:119], v[172:175], v[148:151], a[116:119]
v_add_u32 v98, 3072, v98
v_mfma_f32_16x16x32_bf16 a[112:115], v[172:175], v[144:147], a[112:115]
ds_read_b64_tr_b16 v[230:231], v21 offset:41984
ds_read2_b32 v[52:53], v98 offset0:0 offset1:32
v_mfma_f32_16x16x32_bf16 a[108:111], v[172:175], v[140:143], a[108:111]
ds_read2_b32 v[54:55], v98 offset0:64 offset1:96
ds_read2_b32 v[56:57], v98 offset0:128 offset1:160
v_mfma_f32_16x16x32_bf16 a[104:107], v[172:175], v[136:139], a[104:107]
ds_read_b64_tr_b16 v[232:233], v22 offset:40960
ds_read2_b32 v[58:59], v98 offset0:192 offset1:224
v_mfma_f32_16x16x32_bf16 a[100:103], v[172:175], v[132:135], a[100:103]
v_add_u32 v98, 1024, v98
v_mfma_f32_16x16x32_bf16 a[96:99], v[172:175], v[128:131], a[96:99]
ds_read_b64_tr_b16 v[234:235], v22 offset:41984
ds_read2_b32 v[60:61], v98 offset0:0 offset1:32
v_mfma_f32_16x16x32_bf16 a[128:131], v[128:131], v[176:179], a[128:131]
ds_read2_b32 v[62:63], v98 offset0:64 offset1:96
ds_read2_b32 v[64:65], v98 offset0:128 offset1:160
v_mfma_f32_16x16x32_bf16 a[132:135], v[132:135], v[176:179], a[132:135]
ds_read_b64_tr_b16 v[236:237], v23 offset:40960
ds_read2_b32 v[66:67], v98 offset0:192 offset1:224
v_mfma_f32_16x16x32_bf16 a[136:139], v[136:139], v[176:179], a[136:139]
v_mfma_f32_16x16x32_bf16 a[140:143], v[140:143], v[176:179], a[140:143]
ds_read_b64_tr_b16 v[238:239], v23 offset:41984
v_mfma_f32_16x16x32_bf16 a[144:147], v[144:147], v[176:179], a[144:147]
v_mfma_f32_16x16x32_bf16 a[148:151], v[148:151], v[176:179], a[148:151]
ds_read_b64_tr_b16 v[240:241], v20 offset:57344
v_mfma_f32_16x16x32_bf16 a[152:155], v[152:155], v[176:179], a[152:155]
v_mfma_f32_16x16x32_bf16 a[156:159], v[156:159], v[176:179], a[156:159]
ds_read_b64_tr_b16 v[242:243], v20 offset:58368
v_mfma_f32_16x16x32_bf16 a[188:191], v[156:159], v[180:183], a[188:191]
v_mfma_f32_16x16x32_bf16 a[184:187], v[152:155], v[180:183], a[184:187]
ds_read_b64_tr_b16 v[244:245], v21 offset:57344
v_mfma_f32_16x16x32_bf16 a[180:183], v[148:151], v[180:183], a[180:183]
v_mfma_f32_16x16x32_bf16 a[176:179], v[144:147], v[180:183], a[176:179]
ds_read_b64_tr_b16 v[246:247], v21 offset:58368
v_mfma_f32_16x16x32_bf16 a[172:175], v[140:143], v[180:183], a[172:175]
v_mfma_f32_16x16x32_bf16 a[168:171], v[136:139], v[180:183], a[168:171]
ds_read_b64_tr_b16 v[248:249], v22 offset:57344
v_mfma_f32_16x16x32_bf16 a[164:167], v[132:135], v[180:183], a[164:167]
v_mfma_f32_16x16x32_bf16 a[160:163], v[128:131], v[180:183], a[160:163]
ds_read_b64_tr_b16 v[250:251], v22 offset:58368
v_mfma_f32_16x16x32_bf16 a[192:195], v[128:131], v[184:187], a[192:195]
v_mfma_f32_16x16x32_bf16 a[196:199], v[132:135], v[184:187], a[196:199]
ds_read_b64_tr_b16 v[252:253], v23 offset:57344
v_mfma_f32_16x16x32_bf16 a[200:203], v[136:139], v[184:187], a[200:203]
v_mfma_f32_16x16x32_bf16 a[204:207], v[140:143], v[184:187], a[204:207]
ds_read_b64_tr_b16 v[254:255], v23 offset:58368
v_mfma_f32_16x16x32_bf16 a[208:211], v[144:147], v[184:187], a[208:211]
v_mfma_f32_16x16x32_bf16 a[212:215], v[148:151], v[184:187], a[212:215]
v_mfma_f32_16x16x32_bf16 a[216:219], v[152:155], v[184:187], a[216:219]
v_mfma_f32_16x16x32_bf16 a[220:223], v[156:159], v[184:187], a[220:223]
v_mfma_f32_16x16x32_bf16 a[252:255], v[156:159], v[188:191], a[252:255]
v_mfma_f32_16x16x32_bf16 a[248:251], v[152:155], v[188:191], a[248:251]
v_mfma_f32_16x16x32_bf16 a[244:247], v[148:151], v[188:191], a[244:247]
v_mfma_f32_16x16x32_bf16 a[240:243], v[144:147], v[188:191], a[240:243]
v_mfma_f32_16x16x32_bf16 a[236:239], v[140:143], v[188:191], a[236:239]
v_mfma_f32_16x16x32_bf16 a[232:235], v[136:139], v[188:191], a[232:235]
v_mfma_f32_16x16x32_bf16 a[228:231], v[132:135], v[188:191], a[228:231]
s_waitcnt vmcnt(4) lgkmcnt(0)
v_mfma_f32_16x16x32_bf16 a[224:227], v[128:131], v[188:191], a[224:227]
s_barrier
v_mfma_f32_16x16x32_bf16 a[0:3], v[224:227], v[192:195], a[0:3]
s_and_b32 s73, s65, 1
ds_read_b64_tr_b16 v[160:161], v20 offset:0
v_lshlrev_b32 v72, 16, v68
v_mfma_f32_16x16x32_bf16 a[4:7], v[224:227], v[196:199], a[4:7]
s_xor_b32 s73, s73, 5
ds_read_b64_tr_b16 v[162:163], v20 offset:1024
v_and_b32 v73, 0xffff0000, v68
v_mfma_f32_16x16x32_bf16 a[8:11], v[224:227], v[200:203], a[8:11]
s_lshl_b32 s69, s73, 7
ds_read_b128 v[128:131], v24 offset:0
v_lshlrev_b32 v74, 16, v69
v_mfma_f32_16x16x32_bf16 a[12:15], v[224:227], v[204:207], a[12:15]
s_add_u32 s69, s69, s84
ds_read_b128 v[132:135], v24 offset:2048
v_and_b32 v75, 0xffff0000, v69
v_mfma_f32_16x16x32_bf16 a[16:19], v[224:227], v[208:211], a[16:19]
s_lshl_b32 s71, s73, 19
ds_read_b128 v[136:139], v24 offset:4096
v_lshlrev_b32 v76, 16, v33
v_mfma_f32_16x16x32_bf16 a[20:23], v[224:227], v[212:215], a[20:23]
s_add_u32 s71, s71, s66
ds_read_b128 v[140:143], v24 offset:6144
v_lshlrev_b32 v77, 16, v34
v_mfma_f32_16x16x32_bf16 a[24:27], v[224:227], v[216:219], a[24:27]
s_add_u32 m0, s63, 98304
ds_read_b128 v[144:147], v24 offset:8192
v_lshlrev_b32 v78, 16, v35
v_mfma_f32_16x16x32_bf16 a[28:31], v[224:227], v[220:223], a[28:31]
s_add_u32 s72, s69, 0
buffer_load_dwordx4 v2, s[8:11], s72 offen lds
v_mfma_f32_16x16x32_bf16 a[60:63], v[228:231], v[220:223], a[60:63]
s_add_u32 s72, s69, 7168
buffer_load_dwordx4 v3, s[8:11], s72 offen offset:1024 lds
v_mfma_f32_16x16x32_bf16 a[56:59], v[228:231], v[216:219], a[56:59]
s_add_u32 s72, s69, 14336
buffer_load_dwordx4 v2, s[8:11], s72 offen offset:2048 lds
v_mfma_f32_16x16x32_bf16 a[52:55], v[228:231], v[212:215], a[52:55]
ds_read_b128 v[148:151], v24 offset:10240
v_lshlrev_b32 v79, 16, v36
v_mfma_f32_16x16x32_bf16 a[48:51], v[228:231], v[208:211], a[48:51]
ds_read_b128 v[152:155], v24 offset:12288
v_lshlrev_b32 v80, 16, v37
v_mfma_f32_16x16x32_bf16 a[44:47], v[228:231], v[204:207], a[44:47]
s_add_u32 s72, s69, 21504
buffer_load_dwordx4 v3, s[8:11], s72 offen offset:3072 lds
v_mfma_f32_16x16x32_bf16 a[40:43], v[228:231], v[200:203], a[40:43]
ds_read_b128 v[156:159], v24 offset:14336
v_lshlrev_b32 v81, 16, v38
v_mfma_f32_16x16x32_bf16 a[36:39], v[228:231], v[196:199], a[36:39]
ds_read_b64_tr_b16 v[164:165], v21 offset:0
v_lshlrev_b32 v82, 16, v39
v_mfma_f32_16x16x32_bf16 a[32:35], v[228:231], v[192:195], a[32:35]
ds_read_b64_tr_b16 v[166:167], v21 offset:1024
v_lshlrev_b32 v83, 16, v40
v_mfma_f32_16x16x32_bf16 a[64:67], v[232:235], v[192:195], a[64:67]
ds_read_b64_tr_b16 v[168:169], v22 offset:0
v_lshlrev_b32 v84, 16, v41
v_mfma_f32_16x16x32_bf16 a[68:71], v[232:235], v[196:199], a[68:71]
s_add_u32 m0, s64, 32768
ds_read_b64_tr_b16 v[170:171], v22 offset:1024
v_lshlrev_b32 v85, 16, v42
v_mfma_f32_16x16x32_bf16 a[72:75], v[232:235], v[200:203], a[72:75]
s_add_u32 s72, s71, 0
buffer_load_dwordx4 v6, s[16:19], s72 offen lds
v_mfma_f32_16x16x32_bf16 a[76:79], v[232:235], v[204:207], a[76:79]
ds_read_b64_tr_b16 v[172:173], v23 offset:0
v_lshlrev_b32 v86, 16, v43
v_mfma_f32_16x16x32_bf16 a[80:83], v[232:235], v[208:211], a[80:83]
ds_read_b64_tr_b16 v[174:175], v23 offset:1024
v_lshlrev_b32 v87, 16, v44
v_mfma_f32_16x16x32_bf16 a[84:87], v[232:235], v[212:215], a[84:87]
s_add_u32 s72, s71, 31744
buffer_load_dwordx4 v6, s[16:19], s72 offen offset:1024 lds
v_mfma_f32_16x16x32_bf16 a[88:91], v[232:235], v[216:219], a[88:91]
ds_read_b64_tr_b16 v[176:177], v20 offset:16384
v_lshlrev_b32 v88, 16, v45
v_mfma_f32_16x16x32_bf16 a[92:95], v[232:235], v[220:223], a[92:95]
ds_read_b64_tr_b16 v[178:179], v20 offset:17408
v_lshlrev_b32 v89, 16, v46
v_mfma_f32_16x16x32_bf16 a[124:127], v[236:239], v[220:223], a[124:127]
ds_read_b64_tr_b16 v[180:181], v21 offset:16384
v_lshlrev_b32 v90, 16, v47
v_mfma_f32_16x16x32_bf16 a[120:123], v[236:239], v[216:219], a[120:123]
s_add_u32 s72, s71, 63488
buffer_load_dwordx4 v7, s[16:19], s72 offen offset:2048 lds
v_mfma_f32_16x16x32_bf16 a[116:119], v[236:239], v[212:215], a[116:119]
ds_read_b64_tr_b16 v[182:183], v21 offset:17408
v_lshlrev_b32 v91, 16, v48
v_mfma_f32_16x16x32_bf16 a[112:115], v[236:239], v[208:211], a[112:115]
ds_read_b64_tr_b16 v[184:185], v22 offset:16384
v_lshlrev_b32 v92, 16, v49
v_mfma_f32_16x16x32_bf16 a[108:111], v[236:239], v[204:207], a[108:111]
ds_read_b64_tr_b16 v[186:187], v22 offset:17408
v_lshlrev_b32 v93, 16, v50
v_mfma_f32_16x16x32_bf16 a[104:107], v[236:239], v[200:203], a[104:107]
ds_read_b64_tr_b16 v[188:189], v23 offset:16384
v_lshlrev_b32 v94, 16, v51
v_mfma_f32_16x16x32_bf16 a[100:103], v[236:239], v[196:199], a[100:103]
s_add_u32 s72, s71, 95232
buffer_load_dwordx4 v7, s[16:19], s72 offen offset:3072 lds
v_mfma_f32_16x16x32_bf16 a[96:99], v[236:239], v[192:195], a[96:99]
ds_read_b64_tr_b16 v[190:191], v23 offset:17408
v_mul_f32 v95, v75, v91
v_mfma_f32_16x16x32_bf16 a[128:131], v[192:195], v[240:243], a[128:131]
v_lshlrev_b32 v97, 16, v67
v_fmac_f32 v95, v74, v92
v_mfma_f32_16x16x32_bf16 a[132:135], v[196:199], v[240:243], a[132:135]
v_fmac_f32 v95, v73, v93
v_fmac_f32 v95, v72, v94
v_mfma_f32_16x16x32_bf16 a[136:139], v[200:203], v[240:243], a[136:139]
s_add_u32 m0, s63, 102400
v_mul_f32 v95, v95, v97
v_mul_f32 v96, v75, v90
v_mfma_f32_16x16x32_bf16 a[140:143], v[204:207], v[240:243], a[140:143]
s_add_u32 s72, s69, 32768
buffer_load_dwordx4 v2, s[8:11], s72 offen lds
v_mfma_f32_16x16x32_bf16 a[144:147], v[208:211], v[240:243], a[144:147]
v_lshlrev_b32 v97, 16, v66
v_fmac_f32 v96, v74, v91
v_mfma_f32_16x16x32_bf16 a[148:151], v[212:215], v[240:243], a[148:151]
v_fmac_f32 v96, v73, v92
v_fmac_f32 v96, v72, v93
v_mfma_f32_16x16x32_bf16 a[152:155], v[216:219], v[240:243], a[152:155]
s_add_u32 s72, s69, 39936
buffer_load_dwordx4 v3, s[8:11], s72 offen offset:1024 lds
v_mfma_f32_16x16x32_bf16 a[156:159], v[220:223], v[240:243], a[156:159]
v_mul_f32 v96, v96, v97
v_cvt_pk_bf16_f32 v100, v95, v96
v_mfma_f32_16x16x32_bf16 a[188:191], v[220:223], v[244:247], a[188:191]
v_mul_f32 v95, v75, v89
v_lshlrev_b32 v97, 16, v65
v_mfma_f32_16x16x32_bf16 a[184:187], v[216:219], v[244:247], a[184:187]
v_fmac_f32 v95, v74, v90
v_fmac_f32 v95, v73, v91
v_mfma_f32_16x16x32_bf16 a[180:183], v[212:215], v[244:247], a[180:183]
v_fmac_f32 v95, v72, v92
v_mul_f32 v95, v95, v97
v_mfma_f32_16x16x32_bf16 a[176:179], v[208:211], v[244:247], a[176:179]
s_add_u32 s72, s69, 47104
buffer_load_dwordx4 v2, s[8:11], s72 offen offset:2048 lds
v_mfma_f32_16x16x32_bf16 a[172:175], v[204:207], v[244:247], a[172:175]
v_mul_f32 v96, v75, v88
v_lshlrev_b32 v97, 16, v64
v_mfma_f32_16x16x32_bf16 a[168:171], v[200:203], v[244:247], a[168:171]
v_fmac_f32 v96, v74, v89
v_fmac_f32 v96, v73, v90
v_mfma_f32_16x16x32_bf16 a[164:167], v[196:199], v[244:247], a[164:167]
v_fmac_f32 v96, v72, v91
v_mul_f32 v96, v96, v97
v_mfma_f32_16x16x32_bf16 a[160:163], v[192:195], v[244:247], a[160:163]
s_add_u32 s72, s69, 54272
buffer_load_dwordx4 v3, s[8:11], s72 offen offset:3072 lds
v_mfma_f32_16x16x32_bf16 a[192:195], v[192:195], v[248:251], a[192:195]
v_cvt_pk_bf16_f32 v101, v95, v96
v_mul_f32 v95, v75, v87
v_mfma_f32_16x16x32_bf16 a[196:199], v[196:199], v[248:251], a[196:199]
v_lshlrev_b32 v97, 16, v63
v_fmac_f32 v95, v74, v88
v_mfma_f32_16x16x32_bf16 a[200:203], v[200:203], v[248:251], a[200:203]
v_fmac_f32 v95, v73, v89
v_fmac_f32 v95, v72, v90
v_mfma_f32_16x16x32_bf16 a[204:207], v[204:207], v[248:251], a[204:207]
s_add_u32 m0, s64, 49152
v_mul_f32 v95, v95, v97
v_mul_f32 v96, v75, v86
v_mfma_f32_16x16x32_bf16 a[208:211], v[208:211], v[248:251], a[208:211]
s_add_u32 s72, s71, 0
buffer_load_dwordx4 v6, s[20:23], s72 offen lds
v_mfma_f32_16x16x32_bf16 a[212:215], v[212:215], v[248:251], a[212:215]
v_lshlrev_b32 v97, 16, v62
v_fmac_f32 v96, v74, v87
v_mfma_f32_16x16x32_bf16 a[216:219], v[216:219], v[248:251], a[216:219]
v_fmac_f32 v96, v73, v88
v_fmac_f32 v96, v72, v89
v_mfma_f32_16x16x32_bf16 a[220:223], v[220:223], v[248:251], a[220:223]
v_mul_f32 v96, v96, v97
v_cvt_pk_bf16_f32 v102, v95, v96
v_mfma_f32_16x16x32_bf16 a[252:255], v[220:223], v[252:255], a[252:255]
s_add_u32 s72, s71, 31744
buffer_load_dwordx4 v6, s[20:23], s72 offen offset:1024 lds
v_mfma_f32_16x16x32_bf16 a[248:251], v[216:219], v[252:255], a[248:251]
v_mul_f32 v95, v75, v85
v_lshlrev_b32 v97, 16, v61
v_mfma_f32_16x16x32_bf16 a[244:247], v[212:215], v[252:255], a[244:247]
v_fmac_f32 v95, v74, v86
v_fmac_f32 v95, v73, v87
v_mfma_f32_16x16x32_bf16 a[240:243], v[208:211], v[252:255], a[240:243]
v_fmac_f32 v95, v72, v88
v_mul_f32 v95, v95, v97
v_mfma_f32_16x16x32_bf16 a[236:239], v[204:207], v[252:255], a[236:239]
s_add_u32 s72, s71, 63488
buffer_load_dwordx4 v7, s[20:23], s72 offen offset:2048 lds
v_mfma_f32_16x16x32_bf16 a[232:235], v[200:203], v[252:255], a[232:235]
v_mul_f32 v96, v75, v84
v_lshlrev_b32 v97, 16, v60
v_mfma_f32_16x16x32_bf16 a[228:231], v[196:199], v[252:255], a[228:231]
v_fmac_f32 v96, v74, v85
v_fmac_f32 v96, v73, v86
v_mfma_f32_16x16x32_bf16 a[224:227], v[192:195], v[252:255], a[224:227]
s_waitcnt lgkmcnt(0)
v_fmac_f32 v96, v72, v87
v_mul_f32 v96, v96, v97
v_mfma_f32_16x16x32_bf16 a[0:3], v[160:163], v[128:131], a[0:3]
s_add_u32 s72, s71, 95232
buffer_load_dwordx4 v7, s[20:23], s72 offen offset:3072 lds
v_mfma_f32_16x16x32_bf16 a[4:7], v[160:163], v[132:135], a[4:7]
s_mov_b32 s80, 0x0
buffer_load_dword v126, v125, s[12:15], s80 offen
v_mfma_f32_16x16x32_bf16 a[8:11], v[160:163], v[136:139], a[8:11]
s_mov_b32 s80, 0x100000
buffer_load_dword v126, v125, s[12:15], s80 offen
v_mfma_f32_16x16x32_bf16 a[12:15], v[160:163], v[140:143], a[12:15]
s_mov_b32 s80, 0x200000
buffer_load_dword v126, v125, s[12:15], s80 offen
v_mfma_f32_16x16x32_bf16 a[16:19], v[160:163], v[144:147], a[16:19]
s_mov_b32 s80, 0x300000
buffer_load_dword v126, v125, s[12:15], s80 offen
v_mfma_f32_16x16x32_bf16 a[20:23], v[160:163], v[148:151], a[20:23]
ds_read_b64_tr_b16 v[224:225], v20 offset:8192
v_cvt_pk_bf16_f32 v103, v95, v96
v_mfma_f32_16x16x32_bf16 a[24:27], v[160:163], v[152:155], a[24:27]
ds_write_b128 v28, v[100:103] offset:0
v_mul_f32 v95, v75, v83
v_mfma_f32_16x16x32_bf16 a[28:31], v[160:163], v[156:159], a[28:31]
ds_read_b64_tr_b16 v[226:227], v20 offset:9216
v_lshlrev_b32 v97, 16, v59
v_mfma_f32_16x16x32_bf16 a[60:63], v[164:167], v[156:159], a[60:63]
v_fmac_f32 v95, v74, v84
v_fmac_f32 v95, v73, v85
v_mfma_f32_16x16x32_bf16 a[56:59], v[164:167], v[152:155], a[56:59]
ds_read_b128 v[192:195], v25 offset:0
v_fmac_f32 v95, v72, v86
v_mfma_f32_16x16x32_bf16 a[52:55], v[164:167], v[148:151], a[52:55]
v_mul_f32 v95, v95, v97
v_mul_f32 v96, v75, v82
v_mfma_f32_16x16x32_bf16 a[48:51], v[164:167], v[144:147], a[48:51]
ds_read_b128 v[196:199], v25 offset:2048
v_lshlrev_b32 v97, 16, v58
v_mfma_f32_16x16x32_bf16 a[44:47], v[164:167], v[140:143], a[44:47]
v_fmac_f32 v96, v74, v83
v_fmac_f32 v96, v73, v84
v_mfma_f32_16x16x32_bf16 a[40:43], v[164:167], v[136:139], a[40:43]
ds_read_b128 v[200:203], v25 offset:4096
v_fmac_f32 v96, v72, v85
v_mfma_f32_16x16x32_bf16 a[36:39], v[164:167], v[132:135], a[36:39]
v_mul_f32 v96, v96, v97
v_cvt_pk_bf16_f32 v104, v95, v96
v_mfma_f32_16x16x32_bf16 a[32:35], v[164:167], v[128:131], a[32:35]
ds_read_b128 v[204:207], v25 offset:6144
v_mul_f32 v95, v75, v81
v_mfma_f32_16x16x32_bf16 a[64:67], v[168:171], v[128:131], a[64:67]
v_lshlrev_b32 v97, 16, v57
v_fmac_f32 v95, v74, v82
v_mfma_f32_16x16x32_bf16 a[68:71], v[168:171], v[132:135], a[68:71]
ds_read_b128 v[208:211], v25 offset:8192
v_fmac_f32 v95, v73, v83
v_mfma_f32_16x16x32_bf16 a[72:75], v[168:171], v[136:139], a[72:75]
v_fmac_f32 v95, v72, v84
v_mul_f32 v95, v95, v97
v_mfma_f32_16x16x32_bf16 a[76:79], v[168:171], v[140:143], a[76:79]
ds_read_b128 v[212:215], v25 offset:10240
v_mul_f32 v96, v75, v80
v_mfma_f32_16x16x32_bf16 a[80:83], v[168:171], v[144:147], a[80:83]
v_lshlrev_b32 v97, 16, v56
v_fmac_f32 v96, v74, v81
v_mfma_f32_16x16x32_bf16 a[84:87], v[168:171], v[148:151], a[84:87]
ds_read_b128 v[216:219], v25 offset:12288
v_fmac_f32 v96, v73, v82
v_mfma_f32_16x16x32_bf16 a[88:91], v[168:171], v[152:155], a[88:91]
v_fmac_f32 v96, v72, v83
v_mul_f32 v96, v96, v97
v_mfma_f32_16x16x32_bf16 a[92:95], v[168:171], v[156:159], a[92:95]
ds_read_b128 v[220:223], v25 offset:14336
v_cvt_pk_bf16_f32 v105, v95, v96
v_mfma_f32_16x16x32_bf16 a[124:127], v[172:175], v[156:159], a[124:127]
v_mul_f32 v95, v75, v79
v_lshlrev_b32 v97, 16, v55
v_mfma_f32_16x16x32_bf16 a[120:123], v[172:175], v[152:155], a[120:123]
ds_read_b64_tr_b16 v[228:229], v21 offset:8192
v_fmac_f32 v95, v74, v80
v_mfma_f32_16x16x32_bf16 a[116:119], v[172:175], v[148:151], a[116:119]
v_fmac_f32 v95, v73, v81
v_fmac_f32 v95, v72, v82
v_mfma_f32_16x16x32_bf16 a[112:115], v[172:175], v[144:147], a[112:115]
ds_read_b64_tr_b16 v[230:231], v21 offset:9216
v_mul_f32 v95, v95, v97
v_mfma_f32_16x16x32_bf16 a[108:111], v[172:175], v[140:143], a[108:111]
v_mul_f32 v96, v75, v78
v_lshlrev_b32 v97, 16, v54
v_mfma_f32_16x16x32_bf16 a[104:107], v[172:175], v[136:139], a[104:107]
ds_read_b64_tr_b16 v[232:233], v22 offset:8192
v_fmac_f32 v96, v74, v79
v_mfma_f32_16x16x32_bf16 a[100:103], v[172:175], v[132:135], a[100:103]
v_fmac_f32 v96, v73, v80
v_fmac_f32 v96, v72, v81
v_mfma_f32_16x16x32_bf16 a[96:99], v[172:175], v[128:131], a[96:99]
ds_read_b64_tr_b16 v[234:235], v22 offset:9216
v_mul_f32 v96, v96, v97
v_mfma_f32_16x16x32_bf16 a[128:131], v[128:131], v[176:179], a[128:131]
v_cvt_pk_bf16_f32 v106, v95, v96
v_mul_f32 v95, v75, v77
v_mfma_f32_16x16x32_bf16 a[132:135], v[132:135], v[176:179], a[132:135]
ds_read_b64_tr_b16 v[236:237], v23 offset:8192
v_lshlrev_b32 v97, 16, v53
v_mfma_f32_16x16x32_bf16 a[136:139], v[136:139], v[176:179], a[136:139]
v_fmac_f32 v95, v74, v78
v_fmac_f32 v95, v73, v79
v_mfma_f32_16x16x32_bf16 a[140:143], v[140:143], v[176:179], a[140:143]
ds_read_b64_tr_b16 v[238:239], v23 offset:9216
v_fmac_f32 v95, v72, v80
v_mfma_f32_16x16x32_bf16 a[144:147], v[144:147], v[176:179], a[144:147]
v_mul_f32 v95, v95, v97
v_mul_f32 v96, v75, v76
v_mfma_f32_16x16x32_bf16 a[148:151], v[148:151], v[176:179], a[148:151]
ds_read_b64_tr_b16 v[240:241], v20 offset:24576
v_lshlrev_b32 v97, 16, v52
v_mfma_f32_16x16x32_bf16 a[152:155], v[152:155], v[176:179], a[152:155]
v_fmac_f32 v96, v74, v77
v_fmac_f32 v96, v73, v78
v_mfma_f32_16x16x32_bf16 a[156:159], v[156:159], v[176:179], a[156:159]
ds_read_b64_tr_b16 v[242:243], v20 offset:25600
v_fmac_f32 v96, v72, v79
v_mfma_f32_16x16x32_bf16 a[188:191], v[156:159], v[180:183], a[188:191]
v_mul_f32 v96, v96, v97
v_cvt_pk_bf16_f32 v107, v95, v96
v_mfma_f32_16x16x32_bf16 a[184:187], v[152:155], v[180:183], a[184:187]
ds_read_b64_tr_b16 v[244:245], v21 offset:24576
ds_write_b128 v28, v[104:107] offset:16
v_mfma_f32_16x16x32_bf16 a[180:183], v[148:151], v[180:183], a[180:183]
global_load_dwordx4 v[84:87], v1, s[56:57]
v_mfma_f32_16x16x32_bf16 a[176:179], v[144:147], v[180:183], a[176:179]
ds_read_b64_tr_b16 v[246:247], v21 offset:25600
v_mfma_f32_16x16x32_bf16 a[172:175], v[140:143], v[180:183], a[172:175]
global_load_dwordx4 v[88:91], v1, s[56:57] offset:1024
v_mfma_f32_16x16x32_bf16 a[168:171], v[136:139], v[180:183], a[168:171]
ds_read_b64_tr_b16 v[248:249], v22 offset:24576
v_lshlrev_b32 v72, 16, v70
v_mfma_f32_16x16x32_bf16 a[164:167], v[132:135], v[180:183], a[164:167]
v_and_b32 v73, 0xffff0000, v70
v_lshlrev_b32 v74, 16, v71
v_mfma_f32_16x16x32_bf16 a[160:163], v[128:131], v[180:183], a[160:163]
ds_read_b64_tr_b16 v[250:251], v22 offset:25600
v_and_b32 v75, 0xffff0000, v71
v_mfma_f32_16x16x32_bf16 a[192:195], v[128:131], v[184:187], a[192:195]
v_and_b32 v33, 0xffff0000, v33
v_and_b32 v34, 0xffff0000, v34
v_mfma_f32_16x16x32_bf16 a[196:199], v[132:135], v[184:187], a[196:199]
ds_read_b64_tr_b16 v[252:253], v23 offset:24576
v_and_b32 v35, 0xffff0000, v35
v_mfma_f32_16x16x32_bf16 a[200:203], v[136:139], v[184:187], a[200:203]
v_and_b32 v36, 0xffff0000, v36
v_and_b32 v37, 0xffff0000, v37
v_mfma_f32_16x16x32_bf16 a[204:207], v[140:143], v[184:187], a[204:207]
ds_read_b64_tr_b16 v[254:255], v23 offset:25600
v_and_b32 v38, 0xffff0000, v38
v_mfma_f32_16x16x32_bf16 a[208:211], v[144:147], v[184:187], a[208:211]
v_and_b32 v39, 0xffff0000, v39
v_and_b32 v40, 0xffff0000, v40
v_mfma_f32_16x16x32_bf16 a[212:215], v[148:151], v[184:187], a[212:215]
v_and_b32 v41, 0xffff0000, v41
v_and_b32 v42, 0xffff0000, v42
v_mfma_f32_16x16x32_bf16 a[216:219], v[152:155], v[184:187], a[216:219]
v_and_b32 v43, 0xffff0000, v43
v_and_b32 v44, 0xffff0000, v44
v_mfma_f32_16x16x32_bf16 a[220:223], v[156:159], v[184:187], a[220:223]
v_and_b32 v45, 0xffff0000, v45
v_and_b32 v46, 0xffff0000, v46
v_mfma_f32_16x16x32_bf16 a[252:255], v[156:159], v[188:191], a[252:255]
v_and_b32 v47, 0xffff0000, v47
v_and_b32 v48, 0xffff0000, v48
v_mfma_f32_16x16x32_bf16 a[248:251], v[152:155], v[188:191], a[248:251]
v_and_b32 v49, 0xffff0000, v49
v_and_b32 v50, 0xffff0000, v50
v_mfma_f32_16x16x32_bf16 a[244:247], v[148:151], v[188:191], a[244:247]
v_and_b32 v51, 0xffff0000, v51
v_mul_f32 v95, v75, v48
v_mfma_f32_16x16x32_bf16 a[240:243], v[144:147], v[188:191], a[240:243]
v_and_b32 v97, 0xffff0000, v67
v_fmac_f32 v95, v74, v49
v_mfma_f32_16x16x32_bf16 a[236:239], v[140:143], v[188:191], a[236:239]
v_fmac_f32 v95, v73, v50
v_fmac_f32 v95, v72, v51
v_mfma_f32_16x16x32_bf16 a[232:235], v[136:139], v[188:191], a[232:235]
v_mul_f32 v95, v95, v97
v_mul_f32 v96, v75, v47
v_mfma_f32_16x16x32_bf16 a[228:231], v[132:135], v[188:191], a[228:231]
s_waitcnt vmcnt(6) lgkmcnt(0)
v_and_b32 v97, 0xffff0000, v66
v_fmac_f32 v96, v74, v48
v_mfma_f32_16x16x32_bf16 a[224:227], v[128:131], v[188:191], a[224:227]
s_barrier
v_fmac_f32 v96, v73, v49
v_fmac_f32 v96, v72, v50
v_mfma_f32_16x16x32_bf16 a[0:3], v[224:227], v[192:195], a[0:3]
s_and_b32 s73, s65, 1
ds_read_b64_tr_b16 v[160:161], v20 offset:32768
v_mul_f32 v96, v96, v97
v_mfma_f32_16x16x32_bf16 a[4:7], v[224:227], v[196:199], a[4:7]
s_xor_b32 s73, s73, 6
ds_read_b64_tr_b16 v[162:163], v20 offset:33792
v_cvt_pk_bf16_f32 v100, v95, v96
v_mfma_f32_16x16x32_bf16 a[8:11], v[224:227], v[200:203], a[8:11]
s_lshl_b32 s69, s73, 7
ds_read_b128 v[128:131], v24 offset:32768
v_mul_f32 v95, v75, v46
v_mfma_f32_16x16x32_bf16 a[12:15], v[224:227], v[204:207], a[12:15]
s_add_u32 s69, s69, s84
ds_read_b128 v[132:135], v24 offset:34816
v_and_b32 v97, 0xffff0000, v65
v_mfma_f32_16x16x32_bf16 a[16:19], v[224:227], v[208:211], a[16:19]
s_lshl_b32 s71, s73, 19
ds_read_b128 v[136:139], v24 offset:36864
v_fmac_f32 v95, v74, v47
v_mfma_f32_16x16x32_bf16 a[20:23], v[224:227], v[212:215], a[20:23]
s_add_u32 s71, s71, s66
ds_read_b128 v[140:143], v24 offset:38912
v_fmac_f32 v95, v73, v48
v_mfma_f32_16x16x32_bf16 a[24:27], v[224:227], v[216:219], a[24:27]
s_add_u32 m0, s63, 65536
ds_read_b128 v[144:147], v24 offset:40960
v_fmac_f32 v95, v72, v49
v_mfma_f32_16x16x32_bf16 a[28:31], v[224:227], v[220:223], a[28:31]
s_add_u32 s72, s69, 0
buffer_load_dwordx4 v2, s[8:11], s72 offen lds
v_mfma_f32_16x16x32_bf16 a[60:63], v[228:231], v[220:223], a[60:63]
s_add_u32 s72, s69, 7168
buffer_load_dwordx4 v3, s[8:11], s72 offen offset:1024 lds
v_mfma_f32_16x16x32_bf16 a[56:59], v[228:231], v[216:219], a[56:59]
s_add_u32 s72, s69, 14336
buffer_load_dwordx4 v2, s[8:11], s72 offen offset:2048 lds
v_mfma_f32_16x16x32_bf16 a[52:55], v[228:231], v[212:215], a[52:55]
ds_read_b128 v[148:151], v24 offset:43008
v_mul_f32 v95, v95, v97
v_mfma_f32_16x16x32_bf16 a[48:51], v[228:231], v[208:211], a[48:51]
ds_read_b128 v[152:155], v24 offset:45056
v_mul_f32 v96, v75, v45
v_mfma_f32_16x16x32_bf16 a[44:47], v[228:231], v[204:207], a[44:47]
s_add_u32 s72, s69, 21504
buffer_load_dwordx4 v3, s[8:11], s72 offen offset:3072 lds
v_mfma_f32_16x16x32_bf16 a[40:43], v[228:231], v[200:203], a[40:43]
ds_read_b128 v[156:159], v24 offset:47104
v_and_b32 v97, 0xffff0000, v64
v_mfma_f32_16x16x32_bf16 a[36:39], v[228:231], v[196:199], a[36:39]
ds_read_b64_tr_b16 v[164:165], v21 offset:32768
v_fmac_f32 v96, v74, v46
v_mfma_f32_16x16x32_bf16 a[32:35], v[228:231], v[192:195], a[32:35]
ds_read_b64_tr_b16 v[166:167], v21 offset:33792
v_fmac_f32 v96, v73, v47
v_mfma_f32_16x16x32_bf16 a[64:67], v[232:235], v[192:195], a[64:67]
ds_read_b64_tr_b16 v[168:169], v22 offset:32768
v_fmac_f32 v96, v72, v48
v_mfma_f32_16x16x32_bf16 a[68:71], v[232:235], v[196:199], a[68:71]
s_add_u32 m0, s64, 0
ds_read_b64_tr_b16 v[170:171], v22 offset:33792
v_mul_f32 v96, v96, v97
v_mfma_f32_16x16x32_bf16 a[72:75], v[232:235], v[200:203], a[72:75]
s_add_u32 s72, s71, 0
buffer_load_dwordx4 v6, s[16:19], s72 offen lds
v_mfma_f32_16x16x32_bf16 a[76:79], v[232:235], v[204:207], a[76:79]
ds_read_b64_tr_b16 v[172:173], v23 offset:32768
v_cvt_pk_bf16_f32 v101, v95, v96
v_mfma_f32_16x16x32_bf16 a[80:83], v[232:235], v[208:211], a[80:83]
ds_read_b64_tr_b16 v[174:175], v23 offset:33792
v_mul_f32 v95, v75, v44
v_mfma_f32_16x16x32_bf16 a[84:87], v[232:235], v[212:215], a[84:87]
s_add_u32 s72, s71, 31744
buffer_load_dwordx4 v6, s[16:19], s72 offen offset:1024 lds
v_mfma_f32_16x16x32_bf16 a[88:91], v[232:235], v[216:219], a[88:91]
ds_read_b64_tr_b16 v[176:177], v20 offset:49152
v_and_b32 v97, 0xffff0000, v63
v_mfma_f32_16x16x32_bf16 a[92:95], v[232:235], v[220:223], a[92:95]
ds_read_b64_tr_b16 v[178:179], v20 offset:50176
v_fmac_f32 v95, v74, v45
v_mfma_f32_16x16x32_bf16 a[124:127], v[236:239], v[220:223], a[124:127]
ds_read_b64_tr_b16 v[180:181], v21 offset:49152
v_fmac_f32 v95, v73, v46
v_mfma_f32_16x16x32_bf16 a[120:123], v[236:239], v[216:219], a[120:123]
s_add_u32 s72, s71, 63488
buffer_load_dwordx4 v7, s[16:19], s72 offen offset:2048 lds
v_mfma_f32_16x16x32_bf16 a[116:119], v[236:239], v[212:215], a[116:119]
ds_read_b64_tr_b16 v[182:183], v21 offset:50176
v_fmac_f32 v95, v72, v47
v_mfma_f32_16x16x32_bf16 a[112:115], v[236:239], v[208:211], a[112:115]
ds_read_b64_tr_b16 v[184:185], v22 offset:49152
v_mul_f32 v95, v95, v97
v_mfma_f32_16x16x32_bf16 a[108:111], v[236:239], v[204:207], a[108:111]
ds_read_b64_tr_b16 v[186:187], v22 offset:50176
v_mul_f32 v96, v75, v43
v_mfma_f32_16x16x32_bf16 a[104:107], v[236:239], v[200:203], a[104:107]
ds_read_b64_tr_b16 v[188:189], v23 offset:49152
v_and_b32 v97, 0xffff0000, v62
v_mfma_f32_16x16x32_bf16 a[100:103], v[236:239], v[196:199], a[100:103]
s_add_u32 s72, s71, 95232
buffer_load_dwordx4 v7, s[16:19], s72 offen offset:3072 lds
v_mfma_f32_16x16x32_bf16 a[96:99], v[236:239], v[192:195], a[96:99]
ds_read_b64_tr_b16 v[190:191], v23 offset:50176
v_fmac_f32 v96, v74, v44
v_mfma_f32_16x16x32_bf16 a[128:131], v[192:195], v[240:243], a[128:131]
v_fmac_f32 v96, v73, v45
v_fmac_f32 v96, v72, v46
v_mfma_f32_16x16x32_bf16 a[132:135], v[196:199], v[240:243], a[132:135]
v_mul_f32 v96, v96, v97
v_cvt_pk_bf16_f32 v102, v95, v96
v_mfma_f32_16x16x32_bf16 a[136:139], v[200:203], v[240:243], a[136:139]
s_add_u32 m0, s63, 69632
v_mul_f32 v95, v75, v42
v_and_b32 v97, 0xffff0000, v61
v_mfma_f32_16x16x32_bf16 a[140:143], v[204:207], v[240:243], a[140:143]
s_add_u32 s72, s69, 32768
buffer_load_dwordx4 v2, s[8:11], s72 offen lds
v_mfma_f32_16x16x32_bf16 a[144:147], v[208:211], v[240:243], a[144:147]
v_fmac_f32 v95, v74, v43
v_fmac_f32 v95, v73, v44
v_mfma_f32_16x16x32_bf16 a[148:151], v[212:215], v[240:243], a[148:151]
v_fmac_f32 v95, v72, v45
v_mul_f32 v95, v95, v97
v_mfma_f32_16x16x32_bf16 a[152:155], v[216:219], v[240:243], a[152:155]
s_add_u32 s72, s69, 39936
buffer_load_dwordx4 v3, s[8:11], s72 offen offset:1024 lds
v_mfma_f32_16x16x32_bf16 a[156:159], v[220:223], v[240:243], a[156:159]
v_mul_f32 v96, v75, v41
v_and_b32 v97, 0xffff0000, v60
v_mfma_f32_16x16x32_bf16 a[188:191], v[220:223], v[244:247], a[188:191]
v_fmac_f32 v96, v74, v42
v_fmac_f32 v96, v73, v43
v_mfma_f32_16x16x32_bf16 a[184:187], v[216:219], v[244:247], a[184:187]
v_fmac_f32 v96, v72, v44
v_mul_f32 v96, v96, v97
v_mfma_f32_16x16x32_bf16 a[180:183], v[212:215], v[244:247], a[180:183]
v_cvt_pk_bf16_f32 v103, v95, v96
v_mfma_f32_16x16x32_bf16 a[176:179], v[208:211], v[244:247], a[176:179]
s_add_u32 s72, s69, 47104
buffer_load_dwordx4 v2, s[8:11], s72 offen offset:2048 lds
v_mfma_f32_16x16x32_bf16 a[172:175], v[204:207], v[244:247], a[172:175]
ds_write_b128 v28, v[100:103] offset:272
v_mul_f32 v95, v75, v40
v_mfma_f32_16x16x32_bf16 a[168:171], v[200:203], v[244:247], a[168:171]
v_and_b32 v97, 0xffff0000, v59
v_fmac_f32 v95, v74, v41
v_mfma_f32_16x16x32_bf16 a[164:167], v[196:199], v[244:247], a[164:167]
v_fmac_f32 v95, v73, v42
v_fmac_f32 v95, v72, v43
v_mfma_f32_16x16x32_bf16 a[160:163], v[192:195], v[244:247], a[160:163]
s_add_u32 s72, s69, 54272
buffer_load_dwordx4 v3, s[8:11], s72 offen offset:3072 lds
v_mfma_f32_16x16x32_bf16 a[192:195], v[192:195], v[248:251], a[192:195]
v_mul_f32 v95, v95, v97
v_mul_f32 v96, v75, v39
v_mfma_f32_16x16x32_bf16 a[196:199], v[196:199], v[248:251], a[196:199]
v_and_b32 v97, 0xffff0000, v58
v_fmac_f32 v96, v74, v40
v_mfma_f32_16x16x32_bf16 a[200:203], v[200:203], v[248:251], a[200:203]
v_fmac_f32 v96, v73, v41
v_fmac_f32 v96, v72, v42
v_mfma_f32_16x16x32_bf16 a[204:207], v[204:207], v[248:251], a[204:207]
s_add_u32 m0, s64, 16384
v_mul_f32 v96, v96, v97
v_cvt_pk_bf16_f32 v104, v95, v96
v_mfma_f32_16x16x32_bf16 a[208:211], v[208:211], v[248:251], a[208:211]
s_add_u32 s72, s71, 0
buffer_load_dwordx4 v6, s[20:23], s72 offen lds
v_mfma_f32_16x16x32_bf16 a[212:215], v[212:215], v[248:251], a[212:215]
v_mul_f32 v95, v75, v38
v_and_b32 v97, 0xffff0000, v57
v_mfma_f32_16x16x32_bf16 a[216:219], v[216:219], v[248:251], a[216:219]
v_fmac_f32 v95, v74, v39
v_fmac_f32 v95, v73, v40
v_mfma_f32_16x16x32_bf16 a[220:223], v[220:223], v[248:251], a[220:223]
v_fmac_f32 v95, v72, v41
v_mul_f32 v95, v95, v97
v_mfma_f32_16x16x32_bf16 a[252:255], v[220:223], v[252:255], a[252:255]
s_add_u32 s72, s71, 31744
buffer_load_dwordx4 v6, s[20:23], s72 offen offset:1024 lds
v_mfma_f32_16x16x32_bf16 a[248:251], v[216:219], v[252:255], a[248:251]
v_mul_f32 v96, v75, v37
v_and_b32 v97, 0xffff0000, v56
v_mfma_f32_16x16x32_bf16 a[244:247], v[212:215], v[252:255], a[244:247]
v_fmac_f32 v96, v74, v38
v_fmac_f32 v96, v73, v39
v_mfma_f32_16x16x32_bf16 a[240:243], v[208:211], v[252:255], a[240:243]
v_fmac_f32 v96, v72, v40
v_mul_f32 v96, v96, v97
v_mfma_f32_16x16x32_bf16 a[236:239], v[204:207], v[252:255], a[236:239]
s_add_u32 s72, s71, 63488
buffer_load_dwordx4 v7, s[20:23], s72 offen offset:2048 lds
v_mfma_f32_16x16x32_bf16 a[232:235], v[200:203], v[252:255], a[232:235]
v_cvt_pk_bf16_f32 v105, v95, v96
v_mul_f32 v95, v75, v36
v_mfma_f32_16x16x32_bf16 a[228:231], v[196:199], v[252:255], a[228:231]
v_and_b32 v97, 0xffff0000, v55
v_fmac_f32 v95, v74, v37
v_mfma_f32_16x16x32_bf16 a[224:227], v[192:195], v[252:255], a[224:227]
s_waitcnt lgkmcnt(0)
v_fmac_f32 v95, v73, v38
v_fmac_f32 v95, v72, v39
v_mfma_f32_16x16x32_bf16 a[0:3], v[160:163], v[128:131], a[0:3]
s_add_u32 s72, s71, 95232
buffer_load_dwordx4 v7, s[20:23], s72 offen offset:3072 lds
v_mfma_f32_16x16x32_bf16 a[4:7], v[160:163], v[132:135], a[4:7]
s_mov_b32 s80, 0x400000
buffer_load_dword v126, v125, s[12:15], s80 offen
v_mfma_f32_16x16x32_bf16 a[8:11], v[160:163], v[136:139], a[8:11]
s_mov_b32 s80, 0x500000
buffer_load_dword v126, v125, s[12:15], s80 offen
v_mfma_f32_16x16x32_bf16 a[12:15], v[160:163], v[140:143], a[12:15]
s_mov_b32 s80, 0x600000
buffer_load_dword v126, v125, s[12:15], s80 offen
v_mfma_f32_16x16x32_bf16 a[16:19], v[160:163], v[144:147], a[16:19]
s_mov_b32 s80, 0x700000
buffer_load_dword v126, v125, s[12:15], s80 offen
v_mfma_f32_16x16x32_bf16 a[20:23], v[160:163], v[148:151], a[20:23]
ds_read_b64_tr_b16 v[224:225], v20 offset:40960
v_mul_f32 v95, v95, v97
v_mfma_f32_16x16x32_bf16 a[24:27], v[160:163], v[152:155], a[24:27]
v_mul_f32 v96, v75, v35
v_and_b32 v97, 0xffff0000, v54
v_mfma_f32_16x16x32_bf16 a[28:31], v[160:163], v[156:159], a[28:31]
ds_read_b64_tr_b16 v[226:227], v20 offset:41984
v_fmac_f32 v96, v74, v36
v_mfma_f32_16x16x32_bf16 a[60:63], v[164:167], v[156:159], a[60:63]
v_fmac_f32 v96, v73, v37
v_fmac_f32 v96, v72, v38
v_mfma_f32_16x16x32_bf16 a[56:59], v[164:167], v[152:155], a[56:59]
ds_read_b128 v[192:195], v25 offset:32768
v_mul_f32 v96, v96, v97
v_mfma_f32_16x16x32_bf16 a[52:55], v[164:167], v[148:151], a[52:55]
v_cvt_pk_bf16_f32 v106, v95, v96
v_mul_f32 v95, v75, v34
v_mfma_f32_16x16x32_bf16 a[48:51], v[164:167], v[144:147], a[48:51]
ds_read_b128 v[196:199], v25 offset:34816
v_and_b32 v97, 0xffff0000, v53
v_mfma_f32_16x16x32_bf16 a[44:47], v[164:167], v[140:143], a[44:47]
v_fmac_f32 v95, v74, v35
v_fmac_f32 v95, v73, v36
v_mfma_f32_16x16x32_bf16 a[40:43], v[164:167], v[136:139], a[40:43]
ds_read_b128 v[200:203], v25 offset:36864
v_fmac_f32 v95, v72, v37
v_mfma_f32_16x16x32_bf16 a[36:39], v[164:167], v[132:135], a[36:39]
v_mul_f32 v95, v95, v97
v_mul_f32 v96, v75, v33
v_mfma_f32_16x16x32_bf16 a[32:35], v[164:167], v[128:131], a[32:35]
ds_read_b128 v[204:207], v25 offset:38912
v_and_b32 v97, 0xffff0000, v52
v_mfma_f32_16x16x32_bf16 a[64:67], v[168:171], v[128:131], a[64:67]
v_fmac_f32 v96, v74, v34
v_fmac_f32 v96, v73, v35
v_mfma_f32_16x16x32_bf16 a[68:71], v[168:171], v[132:135], a[68:71]
ds_read_b128 v[208:211], v25 offset:40960
v_fmac_f32 v96, v72, v36
v_mfma_f32_16x16x32_bf16 a[72:75], v[168:171], v[136:139], a[72:75]
v_mul_f32 v96, v96, v97
v_cvt_pk_bf16_f32 v107, v95, v96
v_mfma_f32_16x16x32_bf16 a[76:79], v[168:171], v[140:143], a[76:79]
ds_read_b128 v[212:215], v25 offset:43008
ds_write_b128 v28, v[104:107] offset:288
v_mfma_f32_16x16x32_bf16 a[80:83], v[168:171], v[144:147], a[80:83]
v_mfma_f32_16x16x32_bf16 a[84:87], v[168:171], v[148:151], a[84:87]
ds_read_b128 v[216:219], v25 offset:45056
v_mfma_f32_16x16x32_bf16 a[88:91], v[168:171], v[152:155], a[88:91]
v_mfma_f32_16x16x32_bf16 a[92:95], v[168:171], v[156:159], a[92:95]
ds_read_b128 v[220:223], v25 offset:47104
v_mfma_f32_16x16x32_bf16 a[124:127], v[172:175], v[156:159], a[124:127]
v_mfma_f32_16x16x32_bf16 a[120:123], v[172:175], v[152:155], a[120:123]
ds_read_b64_tr_b16 v[228:229], v21 offset:40960
v_mfma_f32_16x16x32_bf16 a[116:119], v[172:175], v[148:151], a[116:119]
v_mfma_f32_16x16x32_bf16 a[112:115], v[172:175], v[144:147], a[112:115]
ds_read_b64_tr_b16 v[230:231], v21 offset:41984
v_mfma_f32_16x16x32_bf16 a[108:111], v[172:175], v[140:143], a[108:111]
v_mfma_f32_16x16x32_bf16 a[104:107], v[172:175], v[136:139], a[104:107]
ds_read_b64_tr_b16 v[232:233], v22 offset:40960
v_mfma_f32_16x16x32_bf16 a[100:103], v[172:175], v[132:135], a[100:103]
v_mfma_f32_16x16x32_bf16 a[96:99], v[172:175], v[128:131], a[96:99]
ds_read_b64_tr_b16 v[234:235], v22 offset:41984
v_mfma_f32_16x16x32_bf16 a[128:131], v[128:131], v[176:179], a[128:131]
v_mfma_f32_16x16x32_bf16 a[132:135], v[132:135], v[176:179], a[132:135]
ds_read_b64_tr_b16 v[236:237], v23 offset:40960
v_mfma_f32_16x16x32_bf16 a[136:139], v[136:139], v[176:179], a[136:139]
v_mfma_f32_16x16x32_bf16 a[140:143], v[140:143], v[176:179], a[140:143]
ds_read_b64_tr_b16 v[238:239], v23 offset:41984
v_mfma_f32_16x16x32_bf16 a[144:147], v[144:147], v[176:179], a[144:147]
v_mfma_f32_16x16x32_bf16 a[148:151], v[148:151], v[176:179], a[148:151]
ds_read_b64_tr_b16 v[240:241], v20 offset:57344
v_mfma_f32_16x16x32_bf16 a[152:155], v[152:155], v[176:179], a[152:155]
v_mfma_f32_16x16x32_bf16 a[156:159], v[156:159], v[176:179], a[156:159]
ds_read_b64_tr_b16 v[242:243], v20 offset:58368
v_mfma_f32_16x16x32_bf16 a[188:191], v[156:159], v[180:183], a[188:191]
v_mfma_f32_16x16x32_bf16 a[184:187], v[152:155], v[180:183], a[184:187]
ds_read_b64_tr_b16 v[244:245], v21 offset:57344
v_mfma_f32_16x16x32_bf16 a[180:183], v[148:151], v[180:183], a[180:183]
v_mfma_f32_16x16x32_bf16 a[176:179], v[144:147], v[180:183], a[176:179]
ds_read_b64_tr_b16 v[246:247], v21 offset:58368
v_mfma_f32_16x16x32_bf16 a[172:175], v[140:143], v[180:183], a[172:175]
v_mfma_f32_16x16x32_bf16 a[168:171], v[136:139], v[180:183], a[168:171]
ds_read_b64_tr_b16 v[248:249], v22 offset:57344
v_mfma_f32_16x16x32_bf16 a[164:167], v[132:135], v[180:183], a[164:167]
v_mfma_f32_16x16x32_bf16 a[160:163], v[128:131], v[180:183], a[160:163]
ds_read_b64_tr_b16 v[250:251], v22 offset:58368
v_mfma_f32_16x16x32_bf16 a[192:195], v[128:131], v[184:187], a[192:195]
v_mfma_f32_16x16x32_bf16 a[196:199], v[132:135], v[184:187], a[196:199]
ds_read_b64_tr_b16 v[252:253], v23 offset:57344
v_mfma_f32_16x16x32_bf16 a[200:203], v[136:139], v[184:187], a[200:203]
v_mfma_f32_16x16x32_bf16 a[204:207], v[140:143], v[184:187], a[204:207]
ds_read_b64_tr_b16 v[254:255], v23 offset:58368
v_mfma_f32_16x16x32_bf16 a[208:211], v[144:147], v[184:187], a[208:211]
v_mfma_f32_16x16x32_bf16 a[212:215], v[148:151], v[184:187], a[212:215]
v_mfma_f32_16x16x32_bf16 a[216:219], v[152:155], v[184:187], a[216:219]
v_mfma_f32_16x16x32_bf16 a[220:223], v[156:159], v[184:187], a[220:223]
v_mfma_f32_16x16x32_bf16 a[252:255], v[156:159], v[188:191], a[252:255]
v_mfma_f32_16x16x32_bf16 a[248:251], v[152:155], v[188:191], a[248:251]
v_mfma_f32_16x16x32_bf16 a[244:247], v[148:151], v[188:191], a[244:247]
v_mfma_f32_16x16x32_bf16 a[240:243], v[144:147], v[188:191], a[240:243]
v_mfma_f32_16x16x32_bf16 a[236:239], v[140:143], v[188:191], a[236:239]
v_mfma_f32_16x16x32_bf16 a[232:235], v[136:139], v[188:191], a[232:235]
v_mfma_f32_16x16x32_bf16 a[228:231], v[132:135], v[188:191], a[228:231]
s_waitcnt vmcnt(4) lgkmcnt(0)
v_mfma_f32_16x16x32_bf16 a[224:227], v[128:131], v[188:191], a[224:227]
s_barrier
v_mfma_f32_16x16x32_bf16 a[0:3], v[224:227], v[192:195], a[0:3]
s_and_b32 s73, s65, 1
ds_read_b64_tr_b16 v[160:161], v20 offset:0
v_mfma_f32_16x16x32_bf16 a[4:7], v[224:227], v[196:199], a[4:7]
s_xor_b32 s73, s73, 7
ds_read_b64_tr_b16 v[162:163], v20 offset:1024
v_mfma_f32_16x16x32_bf16 a[8:11], v[224:227], v[200:203], a[8:11]
s_lshl_b32 s69, s73, 7
ds_read_b128 v[128:131], v24 offset:0
v_mfma_f32_16x16x32_bf16 a[12:15], v[224:227], v[204:207], a[12:15]
s_add_u32 s69, s69, s84
ds_read_b128 v[132:135], v24 offset:2048
v_mfma_f32_16x16x32_bf16 a[16:19], v[224:227], v[208:211], a[16:19]
s_lshl_b32 s71, s73, 19
ds_read_b128 v[136:139], v24 offset:4096
v_mfma_f32_16x16x32_bf16 a[20:23], v[224:227], v[212:215], a[20:23]
s_add_u32 s71, s71, s66
ds_read_b128 v[140:143], v24 offset:6144
v_mfma_f32_16x16x32_bf16 a[24:27], v[224:227], v[216:219], a[24:27]
s_add_u32 m0, s63, 98304
ds_read_b128 v[144:147], v24 offset:8192
v_mfma_f32_16x16x32_bf16 a[28:31], v[224:227], v[220:223], a[28:31]
s_add_u32 s72, s69, 0
buffer_load_dwordx4 v2, s[8:11], s72 offen lds
v_mfma_f32_16x16x32_bf16 a[60:63], v[228:231], v[220:223], a[60:63]
s_add_u32 s72, s69, 7168
buffer_load_dwordx4 v3, s[8:11], s72 offen offset:1024 lds
v_mfma_f32_16x16x32_bf16 a[56:59], v[228:231], v[216:219], a[56:59]
s_add_u32 s72, s69, 14336
buffer_load_dwordx4 v2, s[8:11], s72 offen offset:2048 lds
v_mfma_f32_16x16x32_bf16 a[52:55], v[228:231], v[212:215], a[52:55]
s_mul_i32 s74, s58, 4352
ds_read_b128 v[148:151], v24 offset:10240
v_mfma_f32_16x16x32_bf16 a[48:51], v[228:231], v[208:211], a[48:51]
s_add_u32 s74, s74, 131072
ds_read_b128 v[152:155], v24 offset:12288
v_lshrrev_b32 v26, 4, v0
v_mfma_f32_16x16x32_bf16 a[44:47], v[228:231], v[204:207], a[44:47]
s_add_u32 s72, s69, 21504
buffer_load_dwordx4 v3, s[8:11], s72 offen offset:3072 lds
v_mfma_f32_16x16x32_bf16 a[40:43], v[228:231], v[200:203], a[40:43]
ds_read_b128 v[156:159], v24 offset:14336
v_and_b32 v27, 15, v0
v_mfma_f32_16x16x32_bf16 a[36:39], v[228:231], v[196:199], a[36:39]
ds_read_b64_tr_b16 v[164:165], v21 offset:0
v_lshlrev_b32 v27, 4, v27
v_mfma_f32_16x16x32_bf16 a[32:35], v[228:231], v[192:195], a[32:35]
ds_read_b64_tr_b16 v[166:167], v21 offset:1024
v_mul_u32_u24 v28, 272, v26
v_mfma_f32_16x16x32_bf16 a[64:67], v[232:235], v[192:195], a[64:67]
ds_read_b64_tr_b16 v[168:169], v22 offset:0
v_add3_u32 v28, v28, v27, s74
v_mfma_f32_16x16x32_bf16 a[68:71], v[232:235], v[196:199], a[68:71]
s_add_u32 m0, s64, 32768
ds_read_b64_tr_b16 v[170:171], v22 offset:1024
v_lshl_add_u32 v26, v26, 12, v27
v_mfma_f32_16x16x32_bf16 a[72:75], v[232:235], v[200:203], a[72:75]
s_add_u32 s72, s71, 0
buffer_load_dwordx4 v6, s[16:19], s72 offen lds
v_mfma_f32_16x16x32_bf16 a[76:79], v[232:235], v[204:207], a[76:79]
ds_read_b64_tr_b16 v[172:173], v23 offset:0
ds_read_b128 v[36:39], v28 offset:0
v_mfma_f32_16x16x32_bf16 a[80:83], v[232:235], v[208:211], a[80:83]
ds_read_b64_tr_b16 v[174:175], v23 offset:1024
ds_read_b128 v[40:43], v28 offset:1088
v_mfma_f32_16x16x32_bf16 a[84:87], v[232:235], v[212:215], a[84:87]
s_add_u32 s72, s71, 31744
buffer_load_dwordx4 v6, s[16:19], s72 offen offset:1024 lds
v_mfma_f32_16x16x32_bf16 a[88:91], v[232:235], v[216:219], a[88:91]
ds_read_b64_tr_b16 v[176:177], v20 offset:16384
ds_read_b128 v[44:47], v28 offset:2176
v_mfma_f32_16x16x32_bf16 a[92:95], v[232:235], v[220:223], a[92:95]
ds_read_b64_tr_b16 v[178:179], v20 offset:17408
ds_read_b128 v[48:51], v28 offset:3264
v_mfma_f32_16x16x32_bf16 a[124:127], v[236:239], v[220:223], a[124:127]
s_and_b32 s74, s2, 15
ds_read_b64_tr_b16 v[180:181], v21 offset:16384
v_mfma_f32_16x16x32_bf16 a[120:123], v[236:239], v[216:219], a[120:123]
s_add_u32 s72, s71, 63488
buffer_load_dwordx4 v7, s[16:19], s72 offen offset:2048 lds
v_mfma_f32_16x16x32_bf16 a[116:119], v[236:239], v[212:215], a[116:119]
s_lshl_b32 s74, s74, 2
ds_read_b64_tr_b16 v[182:183], v21 offset:17408
v_mfma_f32_16x16x32_bf16 a[112:115], v[236:239], v[208:211], a[112:115]
s_add_u32 s74, s74, s58
ds_read_b64_tr_b16 v[184:185], v22 offset:16384
v_mfma_f32_16x16x32_bf16 a[108:111], v[236:239], v[204:207], a[108:111]
s_lshl_b32 s74, s74, 16
ds_read_b64_tr_b16 v[186:187], v22 offset:17408
v_mfma_f32_16x16x32_bf16 a[104:107], v[236:239], v[200:203], a[104:107]
s_lshr_b32 s75, s2, 4
ds_read_b64_tr_b16 v[188:189], v23 offset:16384
v_mfma_f32_16x16x32_bf16 a[100:103], v[236:239], v[196:199], a[100:103]
s_add_u32 s72, s71, 95232
buffer_load_dwordx4 v7, s[16:19], s72 offen offset:3072 lds
v_mfma_f32_16x16x32_bf16 a[96:99], v[236:239], v[192:195], a[96:99]
s_lshl_b32 s75, s75, 8
ds_read_b64_tr_b16 v[190:191], v23 offset:17408
v_mfma_f32_16x16x32_bf16 a[128:131], v[192:195], v[240:243], a[128:131]
s_sub_u32 s74, s74, s75
v_mfma_f32_16x16x32_bf16 a[132:135], v[196:199], v[240:243], a[132:135]
s_add_u32 s74, s74, 0x3000f00
v_mfma_f32_16x16x32_bf16 a[136:139], v[200:203], v[240:243], a[136:139]
s_add_u32 m0, s63, 102400
v_mfma_f32_16x16x32_bf16 a[140:143], v[204:207], v[240:243], a[140:143]
s_add_u32 s72, s69, 32768
buffer_load_dwordx4 v2, s[8:11], s72 offen lds
v_mfma_f32_16x16x32_bf16 a[144:147], v[208:211], v[240:243], a[144:147]
s_waitcnt vmcnt(29)
v_lshlrev_b32 v78, 16, v84
v_lshlrev_b32 v79, 16, v108
v_mfma_f32_16x16x32_bf16 a[148:151], v[212:215], v[240:243], a[148:151]
v_mul_f32 v76, v78, v79
v_lshlrev_b32 v80, 16, v116
v_mfma_f32_16x16x32_bf16 a[152:155], v[216:219], v[240:243], a[152:155]
s_add_u32 s72, s69, 39936
buffer_load_dwordx4 v3, s[8:11], s72 offen offset:1024 lds
v_mfma_f32_16x16x32_bf16 a[156:159], v[220:223], v[240:243], a[156:159]
v_mul_f32 v77, v78, v80
v_and_b32 v78, 0xffff0000, v84
v_mfma_f32_16x16x32_bf16 a[188:191], v[220:223], v[244:247], a[188:191]
v_and_b32 v79, 0xffff0000, v108
v_fmac_f32 v76, v78, v79
v_mfma_f32_16x16x32_bf16 a[184:187], v[216:219], v[244:247], a[184:187]
v_and_b32 v80, 0xffff0000, v116
v_fmac_f32 v77, v78, v80
v_mfma_f32_16x16x32_bf16 a[180:183], v[212:215], v[244:247], a[180:183]
v_lshlrev_b32 v78, 16, v85
v_lshlrev_b32 v79, 16, v109
v_mfma_f32_16x16x32_bf16 a[176:179], v[208:211], v[244:247], a[176:179]
s_add_u32 s72, s69, 47104
buffer_load_dwordx4 v2, s[8:11], s72 offen offset:2048 lds
v_mfma_f32_16x16x32_bf16 a[172:175], v[204:207], v[244:247], a[172:175]
v_fmac_f32 v76, v78, v79
v_lshlrev_b32 v80, 16, v117
v_mfma_f32_16x16x32_bf16 a[168:171], v[200:203], v[244:247], a[168:171]
v_fmac_f32 v77, v78, v80
v_and_b32 v78, 0xffff0000, v85
v_mfma_f32_16x16x32_bf16 a[164:167], v[196:199], v[244:247], a[164:167]
v_and_b32 v79, 0xffff0000, v109
v_fmac_f32 v76, v78, v79
v_mfma_f32_16x16x32_bf16 a[160:163], v[192:195], v[244:247], a[160:163]
s_add_u32 s72, s69, 54272
buffer_load_dwordx4 v3, s[8:11], s72 offen offset:3072 lds
v_mfma_f32_16x16x32_bf16 a[192:195], v[192:195], v[248:251], a[192:195]
v_and_b32 v80, 0xffff0000, v117
v_fmac_f32 v77, v78, v80
v_mfma_f32_16x16x32_bf16 a[196:199], v[196:199], v[248:251], a[196:199]
v_lshlrev_b32 v78, 16, v86
v_lshlrev_b32 v79, 16, v110
v_mfma_f32_16x16x32_bf16 a[200:203], v[200:203], v[248:251], a[200:203]
v_fmac_f32 v76, v78, v79
v_lshlrev_b32 v80, 16, v118
v_mfma_f32_16x16x32_bf16 a[204:207], v[204:207], v[248:251], a[204:207]
s_add_u32 m0, s64, 49152
v_fmac_f32 v77, v78, v80
v_and_b32 v78, 0xffff0000, v86
v_mfma_f32_16x16x32_bf16 a[208:211], v[208:211], v[248:251], a[208:211]
s_add_u32 s72, s71, 0
buffer_load_dwordx4 v6, s[20:23], s72 offen lds
v_mfma_f32_16x16x32_bf16 a[212:215], v[212:215], v[248:251], a[212:215]
v_and_b32 v79, 0xffff0000, v110
v_fmac_f32 v76, v78, v79
v_mfma_f32_16x16x32_bf16 a[216:219], v[216:219], v[248:251], a[216:219]
v_and_b32 v80, 0xffff0000, v118
v_fmac_f32 v77, v78, v80
v_mfma_f32_16x16x32_bf16 a[220:223], v[220:223], v[248:251], a[220:223]
v_lshlrev_b32 v78, 16, v87
v_lshlrev_b32 v79, 16, v111
v_mfma_f32_16x16x32_bf16 a[252:255], v[220:223], v[252:255], a[252:255]
s_add_u32 s72, s71, 31744
buffer_load_dwordx4 v6, s[20:23], s72 offen offset:1024 lds
v_mfma_f32_16x16x32_bf16 a[248:251], v[216:219], v[252:255], a[248:251]
v_fmac_f32 v76, v78, v79
v_lshlrev_b32 v80, 16, v119
v_mfma_f32_16x16x32_bf16 a[244:247], v[212:215], v[252:255], a[244:247]
v_fmac_f32 v77, v78, v80
v_and_b32 v78, 0xffff0000, v87
v_mfma_f32_16x16x32_bf16 a[240:243], v[208:211], v[252:255], a[240:243]
v_and_b32 v79, 0xffff0000, v111
v_fmac_f32 v76, v78, v79
v_mfma_f32_16x16x32_bf16 a[236:239], v[204:207], v[252:255], a[236:239]
s_add_u32 s72, s71, 63488
buffer_load_dwordx4 v7, s[20:23], s72 offen offset:2048 lds
v_mfma_f32_16x16x32_bf16 a[232:235], v[200:203], v[252:255], a[232:235]
v_and_b32 v80, 0xffff0000, v119
v_fmac_f32 v77, v78, v80
v_mfma_f32_16x16x32_bf16 a[228:231], v[196:199], v[252:255], a[228:231]
v_lshlrev_b32 v78, 16, v88
v_lshlrev_b32 v79, 16, v112
v_mfma_f32_16x16x32_bf16 a[224:227], v[192:195], v[252:255], a[224:227]
s_waitcnt lgkmcnt(0)
v_fmac_f32 v76, v78, v79
v_lshlrev_b32 v80, 16, v120
v_mfma_f32_16x16x32_bf16 a[0:3], v[160:163], v[128:131], a[0:3]
s_add_u32 s72, s71, 95232
buffer_load_dwordx4 v7, s[20:23], s72 offen offset:3072 lds
v_mfma_f32_16x16x32_bf16 a[4:7], v[160:163], v[132:135], a[4:7]
ds_read_b64_tr_b16 v[224:225], v20 offset:8192
v_fmac_f32 v77, v78, v80
v_mfma_f32_16x16x32_bf16 a[8:11], v[160:163], v[136:139], a[8:11]
ds_read_b64_tr_b16 v[226:227], v20 offset:9216
v_and_b32 v78, 0xffff0000, v88
v_mfma_f32_16x16x32_bf16 a[12:15], v[160:163], v[140:143], a[12:15]
ds_read_b128 v[192:195], v25 offset:0
v_and_b32 v79, 0xffff0000, v112
v_mfma_f32_16x16x32_bf16 a[16:19], v[160:163], v[144:147], a[16:19]
ds_read_b128 v[196:199], v25 offset:2048
v_fmac_f32 v76, v78, v79
v_mfma_f32_16x16x32_bf16 a[20:23], v[160:163], v[148:151], a[20:23]
ds_read_b128 v[200:203], v25 offset:4096
v_and_b32 v80, 0xffff0000, v120
v_mfma_f32_16x16x32_bf16 a[24:27], v[160:163], v[152:155], a[24:27]
ds_read_b128 v[204:207], v25 offset:6144
v_fmac_f32 v77, v78, v80
v_mfma_f32_16x16x32_bf16 a[28:31], v[160:163], v[156:159], a[28:31]
ds_read_b128 v[208:211], v25 offset:8192
v_lshlrev_b32 v78, 16, v89
v_mfma_f32_16x16x32_bf16 a[60:63], v[164:167], v[156:159], a[60:63]
buffer_store_dwordx4 v[36:39], v26, s[44:47], s74 offen sc1
v_mfma_f32_16x16x32_bf16 a[56:59], v[164:167], v[152:155], a[56:59]
ds_read_b128 v[212:215], v25 offset:10240
v_lshlrev_b32 v79, 16, v113
v_mfma_f32_16x16x32_bf16 a[52:55], v[164:167], v[148:151], a[52:55]
ds_read_b128 v[216:219], v25 offset:12288
v_fmac_f32 v76, v78, v79
v_mfma_f32_16x16x32_bf16 a[48:51], v[164:167], v[144:147], a[48:51]
ds_read_b128 v[220:223], v25 offset:14336
v_lshlrev_b32 v80, 16, v121
v_mfma_f32_16x16x32_bf16 a[44:47], v[164:167], v[140:143], a[44:47]
ds_read_b64_tr_b16 v[228:229], v21 offset:8192
v_fmac_f32 v77, v78, v80
v_mfma_f32_16x16x32_bf16 a[40:43], v[164:167], v[136:139], a[40:43]
ds_read_b64_tr_b16 v[230:231], v21 offset:9216
v_and_b32 v78, 0xffff0000, v89
v_mfma_f32_16x16x32_bf16 a[36:39], v[164:167], v[132:135], a[36:39]
ds_read_b64_tr_b16 v[232:233], v22 offset:8192
v_and_b32 v79, 0xffff0000, v113
v_mfma_f32_16x16x32_bf16 a[32:35], v[164:167], v[128:131], a[32:35]
ds_read_b64_tr_b16 v[234:235], v22 offset:9216
v_fmac_f32 v76, v78, v79
v_mfma_f32_16x16x32_bf16 a[64:67], v[168:171], v[128:131], a[64:67]
ds_read_b64_tr_b16 v[236:237], v23 offset:8192
v_and_b32 v80, 0xffff0000, v121
v_mfma_f32_16x16x32_bf16 a[68:71], v[168:171], v[132:135], a[68:71]
ds_read_b64_tr_b16 v[238:239], v23 offset:9216
v_fmac_f32 v77, v78, v80
v_mfma_f32_16x16x32_bf16 a[72:75], v[168:171], v[136:139], a[72:75]
ds_read_b64_tr_b16 v[240:241], v20 offset:24576
v_lshlrev_b32 v78, 16, v90
v_mfma_f32_16x16x32_bf16 a[76:79], v[168:171], v[140:143], a[76:79]
ds_read_b64_tr_b16 v[242:243], v20 offset:25600
v_lshlrev_b32 v79, 16, v114
v_mfma_f32_16x16x32_bf16 a[80:83], v[168:171], v[144:147], a[80:83]
s_lshr_b32 s75, s93, 5
ds_read_b64_tr_b16 v[244:245], v21 offset:24576
v_fmac_f32 v76, v78, v79
v_mfma_f32_16x16x32_bf16 a[84:87], v[168:171], v[148:151], a[84:87]
s_add_u32 s74, s74, 0x4000
buffer_store_dwordx4 v[40:43], v26, s[44:47], s74 offen sc1
v_mfma_f32_16x16x32_bf16 a[88:91], v[168:171], v[152:155], a[88:91]
s_and_b32 s75, s75, 0x3f80
ds_read_b64_tr_b16 v[246:247], v21 offset:25600
v_lshlrev_b32 v80, 16, v122
v_mfma_f32_16x16x32_bf16 a[92:95], v[168:171], v[156:159], a[92:95]
s_add_u32 s75, s75, LcB0-Lpc0
v_lshrrev_b32 v2, 6, v0
v_lshlrev_b32 v2, 7, v2
v_mfma_f32_16x16x32_bf16 a[124:127], v[172:175], v[156:159], a[124:127]
v_add_u32 v2, s75, v2
v_min_u32 v2, Lcode_end-Lpc0, v2
v_mfma_f32_16x16x32_bf16 a[120:123], v[172:175], v[152:155], a[120:123]
global_load_dword v3, v2, s[98:99]
v_mfma_f32_16x16x32_bf16 a[116:119], v[172:175], v[148:151], a[116:119]
ds_read_b64_tr_b16 v[248:249], v22 offset:24576
v_fmac_f32 v77, v78, v80
v_mfma_f32_16x16x32_bf16 a[112:115], v[172:175], v[144:147], a[112:115]
ds_read_b64_tr_b16 v[250:251], v22 offset:25600
v_and_b32 v78, 0xffff0000, v90
v_mfma_f32_16x16x32_bf16 a[108:111], v[172:175], v[140:143], a[108:111]
ds_read_b64_tr_b16 v[252:253], v23 offset:24576
v_and_b32 v79, 0xffff0000, v114
v_mfma_f32_16x16x32_bf16 a[104:107], v[172:175], v[136:139], a[104:107]
ds_read_b64_tr_b16 v[254:255], v23 offset:25600
v_fmac_f32 v76, v78, v79
v_mfma_f32_16x16x32_bf16 a[100:103], v[172:175], v[132:135], a[100:103]
v_and_b32 v80, 0xffff0000, v122
v_fmac_f32 v77, v78, v80
v_mfma_f32_16x16x32_bf16 a[96:99], v[172:175], v[128:131], a[96:99]
v_lshlrev_b32 v78, 16, v91
v_lshlrev_b32 v79, 16, v115
v_mfma_f32_16x16x32_bf16 a[128:131], v[128:131], v[176:179], a[128:131]
v_fmac_f32 v76, v78, v79
v_lshlrev_b32 v80, 16, v123
v_mfma_f32_16x16x32_bf16 a[132:135], v[132:135], v[176:179], a[132:135]
v_fmac_f32 v77, v78, v80
v_and_b32 v78, 0xffff0000, v91
v_mfma_f32_16x16x32_bf16 a[136:139], v[136:139], v[176:179], a[136:139]
v_and_b32 v79, 0xffff0000, v115
v_fmac_f32 v76, v78, v79
v_mfma_f32_16x16x32_bf16 a[140:143], v[140:143], v[176:179], a[140:143]
s_add_u32 s74, s74, 0x4000
buffer_store_dwordx4 v[44:47], v26, s[44:47], s74 offen sc1
v_mfma_f32_16x16x32_bf16 a[144:147], v[144:147], v[176:179], a[144:147]
v_and_b32 v80, 0xffff0000, v123
v_fmac_f32 v77, v78, v80
v_mfma_f32_16x16x32_bf16 a[148:151], v[148:151], v[176:179], a[148:151]
v_add_f32_dpp v76, v76, v76 row_ror:8 row_mask:0xf bank_mask:0xf
v_add_f32_dpp v77, v77, v77 row_ror:8 row_mask:0xf bank_mask:0xf
v_mfma_f32_16x16x32_bf16 a[152:155], v[152:155], v[176:179], a[152:155]
v_add_f32_dpp v76, v76, v76 row_ror:4 row_mask:0xf bank_mask:0xf
v_add_f32_dpp v77, v77, v77 row_ror:4 row_mask:0xf bank_mask:0xf
v_mfma_f32_16x16x32_bf16 a[156:159], v[156:159], v[176:179], a[156:159]
v_add_f32_dpp v76, v76, v76 row_ror:2 row_mask:0xf bank_mask:0xf
v_add_f32_dpp v77, v77, v77 row_ror:2 row_mask:0xf bank_mask:0xf
v_mfma_f32_16x16x32_bf16 a[188:191], v[156:159], v[180:183], a[188:191]
v_add_f32_dpp v76, v76, v76 row_ror:1 row_mask:0xf bank_mask:0xf
v_add_f32_dpp v77, v77, v77 row_ror:1 row_mask:0xf bank_mask:0xf
v_mfma_f32_16x16x32_bf16 a[184:187], v[152:155], v[180:183], a[184:187]
v_mov_b32 v78, v76
v_mov_b32 v79, v77
v_mfma_f32_16x16x32_bf16 a[180:183], v[148:151], v[180:183], a[180:183]
v_permlane16_swap_b32 v76, v78
v_permlane16_swap_b32 v77, v79
v_mfma_f32_16x16x32_bf16 a[176:179], v[144:147], v[180:183], a[176:179]
v_add_f32 v76, v76, v78
v_add_f32 v77, v77, v79
v_mfma_f32_16x16x32_bf16 a[172:175], v[140:143], v[180:183], a[172:175]
v_mov_b32 v78, v76
v_mov_b32 v79, v77
v_mfma_f32_16x16x32_bf16 a[168:171], v[136:139], v[180:183], a[168:171]
v_permlane32_swap_b32 v76, v78
v_permlane32_swap_b32 v77, v79
v_mfma_f32_16x16x32_bf16 a[164:167], v[132:135], v[180:183], a[164:167]
v_add_f32 v76, v76, v78
v_add_f32 v77, v77, v79
v_mfma_f32_16x16x32_bf16 a[160:163], v[128:131], v[180:183], a[160:163]
v_mul_f32 v76, 0xbfb8aa3b, v76
v_mul_f32 v77, 0xbfb8aa3b, v77
v_mfma_f32_16x16x32_bf16 a[192:195], v[128:131], v[184:187], a[192:195]
v_exp_f32 v76, v76
v_mfma_f32_16x16x32_bf16 a[196:199], v[132:135], v[184:187], a[196:199]
s_add_u32 s74, s74, 0x4000
buffer_store_dwordx4 v[48:51], v26, s[44:47], s74 offen sc1
v_mfma_f32_16x16x32_bf16 a[200:203], v[136:139], v[184:187], a[200:203]
v_exp_f32 v77, v77
v_mfma_f32_16x16x32_bf16 a[204:207], v[140:143], v[184:187], a[204:207]
v_add_f32 v76, 1.0, v76
v_add_f32 v77, 1.0, v77
v_mfma_f32_16x16x32_bf16 a[208:211], v[144:147], v[184:187], a[208:211]
v_rcp_f32 v76, v76
v_mfma_f32_16x16x32_bf16 a[212:215], v[148:151], v[184:187], a[212:215]
v_rcp_f32 v77, v77
v_mfma_f32_16x16x32_bf16 a[216:219], v[152:155], v[184:187], a[216:219]
s_lshr_b32 s80, s76, 9
v_mfma_f32_16x16x32_bf16 a[220:223], v[156:159], v[184:187], a[220:223]
s_add_u32 s80, s80, 0x3800000
v_min_u32 v78, 1, v0
v_lshlrev_b32 v78, 30, v78
v_mfma_f32_16x16x32_bf16 a[252:255], v[156:159], v[188:191], a[252:255]
buffer_store_dwordx2 v[76:77], v78, s[44:47], s80 offen sc1
v_mfma_f32_16x16x32_bf16 a[248:251], v[152:155], v[188:191], a[248:251]
v_mfma_f32_16x16x32_bf16 a[244:247], v[148:151], v[188:191], a[244:247]
v_mfma_f32_16x16x32_bf16 a[240:243], v[144:147], v[188:191], a[240:243]
v_mfma_f32_16x16x32_bf16 a[236:239], v[140:143], v[188:191], a[236:239]
v_mfma_f32_16x16x32_bf16 a[232:235], v[136:139], v[188:191], a[232:235]
v_mfma_f32_16x16x32_bf16 a[228:231], v[132:135], v[188:191], a[228:231]
s_waitcnt vmcnt(6) lgkmcnt(0)
v_mfma_f32_16x16x32_bf16 a[224:227], v[128:131], v[188:191], a[224:227]
s_barrier
v_mfma_f32_16x16x32_bf16 a[0:3], v[224:227], v[192:195], a[0:3]
s_add_u32 s73, s62, 0
ds_read_b64_tr_b16 v[160:161], v20 offset:32768
v_mfma_f32_16x16x32_bf16 a[4:7], v[224:227], v[196:199], a[4:7]
s_add_u32 s70, s73, s65
ds_read_b64_tr_b16 v[162:163], v20 offset:33792
v_mfma_f32_16x16x32_bf16 a[8:11], v[224:227], v[200:203], a[8:11]
s_and_b32 s70, s70, 3
ds_read_b128 v[128:131], v24 offset:32768
v_mfma_f32_16x16x32_bf16 a[12:15], v[224:227], v[204:207], a[12:15]
s_and_b32 s73, s73, 12
ds_read_b128 v[132:135], v24 offset:34816
v_mfma_f32_16x16x32_bf16 a[16:19], v[224:227], v[208:211], a[16:19]
s_or_b32 s73, s73, s70
ds_read_b128 v[136:139], v24 offset:36864
v_mfma_f32_16x16x32_bf16 a[20:23], v[224:227], v[212:215], a[20:23]
s_lshl_b32 s71, s73, 19
ds_read_b128 v[140:143], v24 offset:38912
v_mfma_f32_16x16x32_bf16 a[24:27], v[224:227], v[216:219], a[24:27]
s_add_u32 s71, s71, s66
ds_read_b128 v[144:147], v24 offset:40960
v_mfma_f32_16x16x32_bf16 a[28:31], v[224:227], v[220:223], a[28:31]
s_lshl_b32 s73, s73, 7
ds_read_b128 v[148:151], v24 offset:43008
v_mfma_f32_16x16x32_bf16 a[60:63], v[228:231], v[220:223], a[60:63]
s_add_u32 s69, s73, s67
ds_read_b128 v[152:155], v24 offset:45056
v_mfma_f32_16x16x32_bf16 a[56:59], v[228:231], v[216:219], a[56:59]
s_add_u32 s70, s73, s68
ds_read_b128 v[156:159], v24 offset:47104
v_mfma_f32_16x16x32_bf16 a[52:55], v[228:231], v[212:215], a[52:55]
s_add_u32 m0, s64, 0
ds_read_b64_tr_b16 v[164:165], v21 offset:32768
v_mfma_f32_16x16x32_bf16 a[48:51], v[228:231], v[208:211], a[48:51]
s_add_u32 s72, s71, 0
buffer_load_dwordx4 v6, s[12:15], s72 offen lds
v_mfma_f32_16x16x32_bf16 a[44:47], v[228:231], v[204:207], a[44:47]
s_add_u32 s72, s71, 31744
buffer_load_dwordx4 v6, s[12:15], s72 offen offset:1024 lds
v_mfma_f32_16x16x32_bf16 a[40:43], v[228:231], v[200:203], a[40:43]
s_add_u32 s72, s71, 63488
buffer_load_dwordx4 v7, s[12:15], s72 offen offset:2048 lds
v_mfma_f32_16x16x32_bf16 a[36:39], v[228:231], v[196:199], a[36:39]
ds_read_b64_tr_b16 v[166:167], v21 offset:33792
v_mfma_f32_16x16x32_bf16 a[32:35], v[228:231], v[192:195], a[32:35]
s_add_u32 s72, s71, 95232
buffer_load_dwordx4 v7, s[12:15], s72 offen offset:3072 lds
v_mfma_f32_16x16x32_bf16 a[64:67], v[232:235], v[192:195], a[64:67]
ds_read_b64_tr_b16 v[168:169], v22 offset:32768
v_mfma_f32_16x16x32_bf16 a[68:71], v[232:235], v[196:199], a[68:71]
ds_read_b64_tr_b16 v[170:171], v22 offset:33792
v_mfma_f32_16x16x32_bf16 a[72:75], v[232:235], v[200:203], a[72:75]
ds_read_b64_tr_b16 v[172:173], v23 offset:32768
v_mfma_f32_16x16x32_bf16 a[76:79], v[232:235], v[204:207], a[76:79]
ds_read_b64_tr_b16 v[174:175], v23 offset:33792
v_mfma_f32_16x16x32_bf16 a[80:83], v[232:235], v[208:211], a[80:83]
s_add_u32 m0, s63, 131072
ds_read_b64_tr_b16 v[176:177], v20 offset:49152
v_mfma_f32_16x16x32_bf16 a[84:87], v[232:235], v[212:215], a[84:87]
s_add_u32 s72, s69, 0
buffer_load_dwordx4 v4, s[4:7], s72 offen lds
v_mfma_f32_16x16x32_bf16 a[88:91], v[232:235], v[216:219], a[88:91]
ds_read_b64_tr_b16 v[178:179], v20 offset:50176
v_mfma_f32_16x16x32_bf16 a[92:95], v[232:235], v[220:223], a[92:95]
ds_read_b64_tr_b16 v[180:181], v21 offset:49152
v_mfma_f32_16x16x32_bf16 a[124:127], v[236:239], v[220:223], a[124:127]
ds_read_b64_tr_b16 v[182:183], v21 offset:50176
v_mfma_f32_16x16x32_bf16 a[120:123], v[236:239], v[216:219], a[120:123]
s_add_u32 s72, s69, 15360
buffer_load_dwordx4 v5, s[4:7], s72 offen offset:1024 lds
v_mfma_f32_16x16x32_bf16 a[116:119], v[236:239], v[212:215], a[116:119]
ds_read_b64_tr_b16 v[184:185], v22 offset:49152
v_mfma_f32_16x16x32_bf16 a[112:115], v[236:239], v[208:211], a[112:115]
ds_read_b64_tr_b16 v[186:187], v22 offset:50176
v_mfma_f32_16x16x32_bf16 a[108:111], v[236:239], v[204:207], a[108:111]
ds_read_b64_tr_b16 v[188:189], v23 offset:49152
v_mfma_f32_16x16x32_bf16 a[104:107], v[236:239], v[200:203], a[104:107]
ds_read_b64_tr_b16 v[190:191], v23 offset:50176
v_mfma_f32_16x16x32_bf16 a[100:103], v[236:239], v[196:199], a[100:103]
s_add_u32 s72, s69, 129024
buffer_load_dwordx4 v4, s[4:7], s72 offen offset:2048 lds
v_mfma_f32_16x16x32_bf16 a[96:99], v[236:239], v[192:195], a[96:99]
v_mfma_f32_16x16x32_bf16 a[128:131], v[192:195], v[240:243], a[128:131]
v_mfma_f32_16x16x32_bf16 a[132:135], v[196:199], v[240:243], a[132:135]
v_mfma_f32_16x16x32_bf16 a[136:139], v[200:203], v[240:243], a[136:139]
v_mfma_f32_16x16x32_bf16 a[140:143], v[204:207], v[240:243], a[140:143]
s_add_u32 s72, s69, 144384
buffer_load_dwordx4 v5, s[4:7], s72 offen offset:3072 lds
v_mfma_f32_16x16x32_bf16 a[144:147], v[208:211], v[240:243], a[144:147]
v_mfma_f32_16x16x32_bf16 a[148:151], v[212:215], v[240:243], a[148:151]
v_mfma_f32_16x16x32_bf16 a[152:155], v[216:219], v[240:243], a[152:155]
v_mfma_f32_16x16x32_bf16 a[156:159], v[220:223], v[240:243], a[156:159]
v_mfma_f32_16x16x32_bf16 a[188:191], v[220:223], v[244:247], a[188:191]
s_add_u32 m0, s63, 135168
v_mfma_f32_16x16x32_bf16 a[184:187], v[216:219], v[244:247], a[184:187]
s_add_u32 s72, s70, 0
buffer_load_dwordx4 v4, s[4:7], s72 offen lds
v_mfma_f32_16x16x32_bf16 a[180:183], v[212:215], v[244:247], a[180:183]
v_mfma_f32_16x16x32_bf16 a[176:179], v[208:211], v[244:247], a[176:179]
v_mfma_f32_16x16x32_bf16 a[172:175], v[204:207], v[244:247], a[172:175]
v_mfma_f32_16x16x32_bf16 a[168:171], v[200:203], v[244:247], a[168:171]
s_add_u32 s72, s70, 15360
buffer_load_dwordx4 v5, s[4:7], s72 offen offset:1024 lds
v_mfma_f32_16x16x32_bf16 a[164:167], v[196:199], v[244:247], a[164:167]
v_mfma_f32_16x16x32_bf16 a[160:163], v[192:195], v[244:247], a[160:163]
v_mfma_f32_16x16x32_bf16 a[192:195], v[192:195], v[248:251], a[192:195]
v_mfma_f32_16x16x32_bf16 a[196:199], v[196:199], v[248:251], a[196:199]
v_mfma_f32_16x16x32_bf16 a[200:203], v[200:203], v[248:251], a[200:203]
s_add_u32 s72, s70, 129024
buffer_load_dwordx4 v4, s[4:7], s72 offen offset:2048 lds
v_mfma_f32_16x16x32_bf16 a[204:207], v[204:207], v[248:251], a[204:207]
v_mfma_f32_16x16x32_bf16 a[208:211], v[208:211], v[248:251], a[208:211]
v_mfma_f32_16x16x32_bf16 a[212:215], v[212:215], v[248:251], a[212:215]
v_mfma_f32_16x16x32_bf16 a[216:219], v[216:219], v[248:251], a[216:219]
v_mfma_f32_16x16x32_bf16 a[220:223], v[220:223], v[248:251], a[220:223]
s_add_u32 s72, s70, 144384
buffer_load_dwordx4 v5, s[4:7], s72 offen offset:3072 lds
v_mfma_f32_16x16x32_bf16 a[252:255], v[220:223], v[252:255], a[252:255]
v_mfma_f32_16x16x32_bf16 a[248:251], v[216:219], v[252:255], a[248:251]
v_mfma_f32_16x16x32_bf16 a[244:247], v[212:215], v[252:255], a[244:247]
v_mfma_f32_16x16x32_bf16 a[240:243], v[208:211], v[252:255], a[240:243]
v_mfma_f32_16x16x32_bf16 a[236:239], v[204:207], v[252:255], a[236:239]
s_add_u32 s73, s62, 1
v_mfma_f32_16x16x32_bf16 a[232:235], v[200:203], v[252:255], a[232:235]
s_add_u32 s70, s73, s65
v_mfma_f32_16x16x32_bf16 a[228:231], v[196:199], v[252:255], a[228:231]
s_and_b32 s70, s70, 3
v_mfma_f32_16x16x32_bf16 a[224:227], v[192:195], v[252:255], a[224:227]
s_waitcnt lgkmcnt(0)
v_mfma_f32_16x16x32_bf16 a[0:3], v[160:163], v[128:131], a[0:3]
s_and_b32 s73, s73, 12
ds_read_b64_tr_b16 v[224:225], v20 offset:40960
v_mfma_f32_16x16x32_bf16 a[4:7], v[160:163], v[132:135], a[4:7]
s_or_b32 s73, s73, s70
ds_read_b64_tr_b16 v[226:227], v20 offset:41984
v_mfma_f32_16x16x32_bf16 a[8:11], v[160:163], v[136:139], a[8:11]
s_lshl_b32 s71, s73, 19
ds_read_b128 v[192:195], v25 offset:32768
v_mfma_f32_16x16x32_bf16 a[12:15], v[160:163], v[140:143], a[12:15]
s_add_u32 s71, s71, s66
ds_read_b128 v[196:199], v25 offset:34816
v_mfma_f32_16x16x32_bf16 a[16:19], v[160:163], v[144:147], a[16:19]
s_lshl_b32 s73, s73, 7
ds_read_b128 v[200:203], v25 offset:36864
v_mfma_f32_16x16x32_bf16 a[20:23], v[160:163], v[148:151], a[20:23]
s_add_u32 s69, s73, s67
ds_read_b128 v[204:207], v25 offset:38912
v_mfma_f32_16x16x32_bf16 a[24:27], v[160:163], v[152:155], a[24:27]
s_add_u32 s70, s73, s68
ds_read_b128 v[208:211], v25 offset:40960
v_mfma_f32_16x16x32_bf16 a[28:31], v[160:163], v[156:159], a[28:31]
s_add_u32 m0, s64, 16384
ds_read_b128 v[212:215], v25 offset:43008
v_mfma_f32_16x16x32_bf16 a[60:63], v[164:167], v[156:159], a[60:63]
s_add_u32 s72, s71, 0
buffer_load_dwordx4 v6, s[12:15], s72 offen lds
v_mfma_f32_16x16x32_bf16 a[56:59], v[164:167], v[152:155], a[56:59]
s_add_u32 s72, s71, 31744
buffer_load_dwordx4 v6, s[12:15], s72 offen offset:1024 lds
v_mfma_f32_16x16x32_bf16 a[52:55], v[164:167], v[148:151], a[52:55]
s_add_u32 s72, s71, 63488
buffer_load_dwordx4 v7, s[12:15], s72 offen offset:2048 lds
v_mfma_f32_16x16x32_bf16 a[48:51], v[164:167], v[144:147], a[48:51]
s_add_u32 s72, s71, 95232
buffer_load_dwordx4 v7, s[12:15], s72 offen offset:3072 lds
v_mfma_f32_16x16x32_bf16 a[44:47], v[164:167], v[140:143], a[44:47]
ds_read_b128 v[216:219], v25 offset:45056
v_mfma_f32_16x16x32_bf16 a[40:43], v[164:167], v[136:139], a[40:43]
ds_read_b128 v[220:223], v25 offset:47104
v_mfma_f32_16x16x32_bf16 a[36:39], v[164:167], v[132:135], a[36:39]
ds_read_b64_tr_b16 v[228:229], v21 offset:40960
v_mfma_f32_16x16x32_bf16 a[32:35], v[164:167], v[128:131], a[32:35]
ds_read_b64_tr_b16 v[230:231], v21 offset:41984
v_mfma_f32_16x16x32_bf16 a[64:67], v[168:171], v[128:131], a[64:67]
s_add_u32 m0, s63, 65536
ds_read_b64_tr_b16 v[232:233], v22 offset:40960
v_mfma_f32_16x16x32_bf16 a[68:71], v[168:171], v[132:135], a[68:71]
s_add_u32 s72, s69, 0
buffer_load_dwordx4 v4, s[4:7], s72 offen lds
v_mfma_f32_16x16x32_bf16 a[72:75], v[168:171], v[136:139], a[72:75]
ds_read_b64_tr_b16 v[234:235], v22 offset:41984
v_mfma_f32_16x16x32_bf16 a[76:79], v[168:171], v[140:143], a[76:79]
ds_read_b64_tr_b16 v[236:237], v23 offset:40960
v_mfma_f32_16x16x32_bf16 a[80:83], v[168:171], v[144:147], a[80:83]
ds_read_b64_tr_b16 v[238:239], v23 offset:41984
v_mfma_f32_16x16x32_bf16 a[84:87], v[168:171], v[148:151], a[84:87]
s_add_u32 s72, s69, 15360
buffer_load_dwordx4 v5, s[4:7], s72 offen offset:1024 lds
v_mfma_f32_16x16x32_bf16 a[88:91], v[168:171], v[152:155], a[88:91]
ds_read_b64_tr_b16 v[240:241], v20 offset:57344
v_mfma_f32_16x16x32_bf16 a[92:95], v[168:171], v[156:159], a[92:95]
ds_read_b64_tr_b16 v[242:243], v20 offset:58368
v_mfma_f32_16x16x32_bf16 a[124:127], v[172:175], v[156:159], a[124:127]
ds_read_b64_tr_b16 v[244:245], v21 offset:57344
v_mfma_f32_16x16x32_bf16 a[120:123], v[172:175], v[152:155], a[120:123]
ds_read_b64_tr_b16 v[246:247], v21 offset:58368
v_mfma_f32_16x16x32_bf16 a[116:119], v[172:175], v[148:151], a[116:119]
s_add_u32 s72, s69, 129024
buffer_load_dwordx4 v4, s[4:7], s72 offen offset:2048 lds
v_mfma_f32_16x16x32_bf16 a[112:115], v[172:175], v[144:147], a[112:115]
ds_read_b64_tr_b16 v[248:249], v22 offset:57344
v_mfma_f32_16x16x32_bf16 a[108:111], v[172:175], v[140:143], a[108:111]
ds_read_b64_tr_b16 v[250:251], v22 offset:58368
v_mfma_f32_16x16x32_bf16 a[104:107], v[172:175], v[136:139], a[104:107]
ds_read_b64_tr_b16 v[252:253], v23 offset:57344
v_mfma_f32_16x16x32_bf16 a[100:103], v[172:175], v[132:135], a[100:103]
ds_read_b64_tr_b16 v[254:255], v23 offset:58368
v_mfma_f32_16x16x32_bf16 a[96:99], v[172:175], v[128:131], a[96:99]
s_add_u32 s72, s69, 144384
buffer_load_dwordx4 v5, s[4:7], s72 offen offset:3072 lds
v_mfma_f32_16x16x32_bf16 a[128:131], v[128:131], v[176:179], a[128:131]
v_mfma_f32_16x16x32_bf16 a[132:135], v[132:135], v[176:179], a[132:135]
v_mfma_f32_16x16x32_bf16 a[136:139], v[136:139], v[176:179], a[136:139]
v_mfma_f32_16x16x32_bf16 a[140:143], v[140:143], v[176:179], a[140:143]
v_mfma_f32_16x16x32_bf16 a[144:147], v[144:147], v[176:179], a[144:147]
s_add_u32 m0, s63, 69632
v_mfma_f32_16x16x32_bf16 a[148:151], v[148:151], v[176:179], a[148:151]
s_add_u32 s72, s70, 0
buffer_load_dwordx4 v4, s[4:7], s72 offen lds
v_mfma_f32_16x16x32_bf16 a[152:155], v[152:155], v[176:179], a[152:155]
v_mfma_f32_16x16x32_bf16 a[156:159], v[156:159], v[176:179], a[156:159]
v_mfma_f32_16x16x32_bf16 a[188:191], v[156:159], v[180:183], a[188:191]
v_mfma_f32_16x16x32_bf16 a[184:187], v[152:155], v[180:183], a[184:187]
s_add_u32 s72, s70, 15360
buffer_load_dwordx4 v5, s[4:7], s72 offen offset:1024 lds
v_mfma_f32_16x16x32_bf16 a[180:183], v[148:151], v[180:183], a[180:183]
v_mfma_f32_16x16x32_bf16 a[176:179], v[144:147], v[180:183], a[176:179]
v_mfma_f32_16x16x32_bf16 a[172:175], v[140:143], v[180:183], a[172:175]
v_mfma_f32_16x16x32_bf16 a[168:171], v[136:139], v[180:183], a[168:171]
v_mfma_f32_16x16x32_bf16 a[164:167], v[132:135], v[180:183], a[164:167]
s_add_u32 s72, s70, 129024
buffer_load_dwordx4 v4, s[4:7], s72 offen offset:2048 lds
v_mfma_f32_16x16x32_bf16 a[160:163], v[128:131], v[180:183], a[160:163]
v_mfma_f32_16x16x32_bf16 a[192:195], v[128:131], v[184:187], a[192:195]
v_mfma_f32_16x16x32_bf16 a[196:199], v[132:135], v[184:187], a[196:199]
v_mfma_f32_16x16x32_bf16 a[200:203], v[136:139], v[184:187], a[200:203]
v_mfma_f32_16x16x32_bf16 a[204:207], v[140:143], v[184:187], a[204:207]
s_add_u32 s72, s70, 144384
buffer_load_dwordx4 v5, s[4:7], s72 offen offset:3072 lds
v_mfma_f32_16x16x32_bf16 a[208:211], v[144:147], v[184:187], a[208:211]
v_mfma_f32_16x16x32_bf16 a[212:215], v[148:151], v[184:187], a[212:215]
v_mfma_f32_16x16x32_bf16 a[216:219], v[152:155], v[184:187], a[216:219]
v_mfma_f32_16x16x32_bf16 a[220:223], v[156:159], v[184:187], a[220:223]
v_mfma_f32_16x16x32_bf16 a[252:255], v[156:159], v[188:191], a[252:255]
v_mfma_f32_16x16x32_bf16 a[248:251], v[152:155], v[188:191], a[248:251]
v_mfma_f32_16x16x32_bf16 a[244:247], v[148:151], v[188:191], a[244:247]
v_mfma_f32_16x16x32_bf16 a[240:243], v[144:147], v[188:191], a[240:243]
v_mfma_f32_16x16x32_bf16 a[236:239], v[140:143], v[188:191], a[236:239]
v_mfma_f32_16x16x32_bf16 a[232:235], v[136:139], v[188:191], a[232:235]
v_mfma_f32_16x16x32_bf16 a[228:231], v[132:135], v[188:191], a[228:231]
s_waitcnt vmcnt(12) lgkmcnt(0)
v_mfma_f32_16x16x32_bf16 a[224:227], v[128:131], v[188:191], a[224:227]
s_barrier
LcB0:
v_mfma_f32_16x16x32_bf16 a[0:3], v[224:227], v[192:195], a[0:3]
s_add_u32 s73, s62, 2
ds_read_b64_tr_b16 v[32:33], v8 offset:0
v_mfma_f32_16x16x32_bf16 a[4:7], v[224:227], v[196:199], a[4:7]
s_add_u32 s70, s73, s65
ds_read_b64_tr_b16 v[34:35], v8 offset:1024
v_mfma_f32_16x16x32_bf16 a[8:11], v[224:227], v[200:203], a[8:11]
s_and_b32 s70, s70, 3
ds_read_b128 v[64:67], v16 offset:0
v_mfma_f32_16x16x32_bf16 a[12:15], v[224:227], v[204:207], a[12:15]
s_and_b32 s73, s73, 12
ds_read_b128 v[68:71], v16 offset:2048
v_mfma_f32_16x16x32_bf16 a[16:19], v[224:227], v[208:211], a[16:19]
s_or_b32 s73, s73, s70
ds_read_b128 v[72:75], v16 offset:4096
v_mfma_f32_16x16x32_bf16 a[20:23], v[224:227], v[212:215], a[20:23]
s_lshl_b32 s71, s73, 19
ds_read_b128 v[76:79], v16 offset:6144
v_mfma_f32_16x16x32_bf16 a[24:27], v[224:227], v[216:219], a[24:27]
s_add_u32 s71, s71, s66
ds_read_b64_tr_b16 v[36:37], v9 offset:0
v_mfma_f32_16x16x32_bf16 a[28:31], v[224:227], v[220:223], a[28:31]
s_lshl_b32 s73, s73, 7
ds_read_b64_tr_b16 v[38:39], v9 offset:1024
v_mfma_f32_16x16x32_bf16 a[60:63], v[228:231], v[220:223], a[60:63]
s_add_u32 s69, s73, s67
ds_read_b64_tr_b16 v[40:41], v10 offset:0
v_mfma_f32_16x16x32_bf16 a[56:59], v[228:231], v[216:219], a[56:59]
s_add_u32 s70, s73, s68
ds_read_b64_tr_b16 v[42:43], v10 offset:1024
v_mfma_f32_16x16x32_bf16 a[52:55], v[228:231], v[212:215], a[52:55]
s_add_u32 m0, s64, 32768
ds_read_b64_tr_b16 v[44:45], v11 offset:0
v_mfma_f32_16x16x32_bf16 a[48:51], v[228:231], v[208:211], a[48:51]
s_add_u32 s72, s71, 0
buffer_load_dwordx4 v6, s[12:15], s72 offen lds
v_mfma_f32_16x16x32_bf16 a[44:47], v[228:231], v[204:207], a[44:47]
s_add_u32 s72, s71, 31744
buffer_load_dwordx4 v6, s[12:15], s72 offen offset:1024 lds
v_mfma_f32_16x16x32_bf16 a[40:43], v[228:231], v[200:203], a[40:43]
s_add_u32 s72, s71, 63488
buffer_load_dwordx4 v7, s[12:15], s72 offen offset:2048 lds
v_mfma_f32_16x16x32_bf16 a[36:39], v[228:231], v[196:199], a[36:39]
s_lshl_b32 s80, s59, 2
ds_read_b64_tr_b16 v[46:47], v11 offset:1024
v_or_b32 v26, s58, v0
v_mfma_f32_16x16x32_bf16 a[32:35], v[228:231], v[192:195], a[32:35]
s_add_u32 s72, s71, 95232
buffer_load_dwordx4 v7, s[12:15], s72 offen offset:3072 lds
v_mfma_f32_16x16x32_bf16 a[64:67], v[232:235], v[192:195], a[64:67]
ds_read_b64_tr_b16 v[48:49], v12 offset:0
v_mov_b32 v27, 1
v_mfma_f32_16x16x32_bf16 a[68:71], v[232:235], v[196:199], a[68:71]
ds_read_b64_tr_b16 v[50:51], v12 offset:1024
v_lshlrev_b32 v26, 8, v26
v_mfma_f32_16x16x32_bf16 a[72:75], v[232:235], v[200:203], a[72:75]
ds_read_b64_tr_b16 v[52:53], v13 offset:0
v_mfma_f32_16x16x32_bf16 a[76:79], v[232:235], v[204:207], a[76:79]
ds_read_b64_tr_b16 v[54:55], v13 offset:1024
v_mfma_f32_16x16x32_bf16 a[80:83], v[232:235], v[208:211], a[80:83]
s_add_u32 m0, s63, 98304
ds_read_b64_tr_b16 v[56:57], v14 offset:0
v_mfma_f32_16x16x32_bf16 a[84:87], v[232:235], v[212:215], a[84:87]
s_add_u32 s72, s69, 0
buffer_load_dwordx4 v4, s[4:7], s72 offen lds
v_mfma_f32_16x16x32_bf16 a[88:91], v[232:235], v[216:219], a[88:91]
ds_read_b64_tr_b16 v[58:59], v14 offset:1024
v_mfma_f32_16x16x32_bf16 a[92:95], v[232:235], v[220:223], a[92:95]
ds_read_b64_tr_b16 v[60:61], v15 offset:0
v_mfma_f32_16x16x32_bf16 a[124:127], v[236:239], v[220:223], a[124:127]
ds_read_b64_tr_b16 v[62:63], v15 offset:1024
v_mfma_f32_16x16x32_bf16 a[120:123], v[236:239], v[216:219], a[120:123]
s_add_u32 s72, s69, 15360
buffer_load_dwordx4 v5, s[4:7], s72 offen offset:1024 lds
v_mfma_f32_16x16x32_bf16 a[116:119], v[236:239], v[212:215], a[116:119]
buffer_atomic_add v27, v26, s[48:51], s80 offen sc1
v_mfma_f32_16x16x32_bf16 a[112:115], v[236:239], v[208:211], a[112:115]
v_accvgpr_read_b32 v20, a0
v_accvgpr_read_b32 v28, a1
v_mfma_f32_16x16x32_bf16 a[108:111], v[236:239], v[204:207], a[108:111]
v_accvgpr_read_b32 v21, a2
v_accvgpr_read_b32 v29, a3
v_mfma_f32_16x16x32_bf16 a[104:107], v[236:239], v[200:203], a[104:107]
v_accvgpr_read_b32 v22, a32
v_accvgpr_read_b32 v30, a33
v_mfma_f32_16x16x32_bf16 a[100:103], v[236:239], v[196:199], a[100:103]
s_add_u32 s72, s69, 129024
buffer_load_dwordx4 v4, s[4:7], s72 offen offset:2048 lds
v_mfma_f32_16x16x32_bf16 a[96:99], v[236:239], v[192:195], a[96:99]
v_accvgpr_read_b32 v23, a34
v_accvgpr_read_b32 v31, a35
v_mfma_f32_16x16x32_bf16 a[128:131], v[192:195], v[240:243], a[128:131]
v_mul_f32 v20, s79, v20
v_mul_f32 v28, s79, v28
v_mfma_f32_16x16x32_bf16 a[132:135], v[196:199], v[240:243], a[132:135]
v_mul_f32 v21, s79, v21
v_mul_f32 v29, s79, v29
v_mfma_f32_16x16x32_bf16 a[136:139], v[200:203], v[240:243], a[136:139]
v_mul_f32 v22, s79, v22
v_mul_f32 v30, s79, v30
v_mfma_f32_16x16x32_bf16 a[140:143], v[204:207], v[240:243], a[140:143]
s_add_u32 s72, s69, 144384
buffer_load_dwordx4 v5, s[4:7], s72 offen offset:3072 lds
v_mfma_f32_16x16x32_bf16 a[144:147], v[208:211], v[240:243], a[144:147]
v_mul_f32 v23, s79, v23
v_mul_f32 v31, s79, v31
v_mfma_f32_16x16x32_bf16 a[148:151], v[212:215], v[240:243], a[148:151]
v_cvt_pk_bf16_f32 v20, v20, v28
v_cvt_pk_bf16_f32 v21, v21, v29
v_mfma_f32_16x16x32_bf16 a[152:155], v[216:219], v[240:243], a[152:155]
v_cvt_pk_bf16_f32 v22, v22, v30
v_cvt_pk_bf16_f32 v23, v23, v31
v_mfma_f32_16x16x32_bf16 a[156:159], v[220:223], v[240:243], a[156:159]
s_add_u32 s80, s77, 0
buffer_store_dwordx4 v[20:23], v1, s[44:47], s80 offen sc1
v_mfma_f32_16x16x32_bf16 a[188:191], v[220:223], v[244:247], a[188:191]
s_add_u32 m0, s63, 102400
v_mfma_f32_16x16x32_bf16 a[184:187], v[216:219], v[244:247], a[184:187]
s_add_u32 s72, s70, 0
buffer_load_dwordx4 v4, s[4:7], s72 offen lds
v_mfma_f32_16x16x32_bf16 a[180:183], v[212:215], v[244:247], a[180:183]
v_mfma_f32_16x16x32_bf16 a[176:179], v[208:211], v[244:247], a[176:179]
v_mfma_f32_16x16x32_bf16 a[172:175], v[204:207], v[244:247], a[172:175]
v_mfma_f32_16x16x32_bf16 a[168:171], v[200:203], v[244:247], a[168:171]
s_add_u32 s72, s70, 15360
buffer_load_dwordx4 v5, s[4:7], s72 offen offset:1024 lds
v_mfma_f32_16x16x32_bf16 a[164:167], v[196:199], v[244:247], a[164:167]
v_accvgpr_read_b32 v24, a4
v_accvgpr_read_b32 v28, a5
v_mfma_f32_16x16x32_bf16 a[160:163], v[192:195], v[244:247], a[160:163]
v_accvgpr_read_b32 v25, a6
v_accvgpr_read_b32 v29, a7
v_mfma_f32_16x16x32_bf16 a[192:195], v[192:195], v[248:251], a[192:195]
v_accvgpr_read_b32 v26, a36
v_accvgpr_read_b32 v30, a37
v_mfma_f32_16x16x32_bf16 a[196:199], v[196:199], v[248:251], a[196:199]
v_accvgpr_read_b32 v27, a38
v_accvgpr_read_b32 v31, a39
v_mfma_f32_16x16x32_bf16 a[200:203], v[200:203], v[248:251], a[200:203]
s_add_u32 s72, s70, 129024
buffer_load_dwordx4 v4, s[4:7], s72 offen offset:2048 lds
v_mfma_f32_16x16x32_bf16 a[204:207], v[204:207], v[248:251], a[204:207]
v_mul_f32 v24, s79, v24
v_mul_f32 v28, s79, v28
v_mfma_f32_16x16x32_bf16 a[208:211], v[208:211], v[248:251], a[208:211]
v_mul_f32 v25, s79, v25
v_mul_f32 v29, s79, v29
v_mfma_f32_16x16x32_bf16 a[212:215], v[212:215], v[248:251], a[212:215]
v_mul_f32 v26, s79, v26
v_mul_f32 v30, s79, v30
v_mfma_f32_16x16x32_bf16 a[216:219], v[216:219], v[248:251], a[216:219]
v_mul_f32 v27, s79, v27
v_mul_f32 v31, s79, v31
v_mfma_f32_16x16x32_bf16 a[220:223], v[220:223], v[248:251], a[220:223]
s_add_u32 s72, s70, 144384
buffer_load_dwordx4 v5, s[4:7], s72 offen offset:3072 lds
v_mfma_f32_16x16x32_bf16 a[252:255], v[220:223], v[252:255], a[252:255]
v_cvt_pk_bf16_f32 v24, v24, v28
v_cvt_pk_bf16_f32 v25, v25, v29
v_mfma_f32_16x16x32_bf16 a[248:251], v[216:219], v[252:255], a[248:251]
v_cvt_pk_bf16_f32 v26, v26, v30
v_cvt_pk_bf16_f32 v27, v27, v31
v_mfma_f32_16x16x32_bf16 a[244:247], v[212:215], v[252:255], a[244:247]
s_add_u32 s80, s77, 4096
buffer_store_dwordx4 v[24:27], v1, s[44:47], s80 offen sc1
v_mfma_f32_16x16x32_bf16 a[240:243], v[208:211], v[252:255], a[240:243]
v_mfma_f32_16x16x32_bf16 a[236:239], v[204:207], v[252:255], a[236:239]
v_mfma_f32_16x16x32_bf16 a[232:235], v[200:203], v[252:255], a[232:235]
v_mfma_f32_16x16x32_bf16 a[228:231], v[196:199], v[252:255], a[228:231]
v_mfma_f32_16x16x32_bf16 a[224:227], v[192:195], v[252:255], a[224:227]
s_waitcnt lgkmcnt(0)
v_mfma_f32_16x16x32_bf16 v[128:131], v[32:35], v[64:67], 0
ds_read_b64_tr_b16 v[80:81], v8 offset:8192
ds_read_b64_tr_b16 v[82:83], v8 offset:9216
v_mfma_f32_16x16x32_bf16 v[132:135], v[32:35], v[68:71], 0
ds_read_b128 v[112:115], v17 offset:0
ds_read_b128 v[116:119], v17 offset:2048
v_mfma_f32_16x16x32_bf16 v[136:139], v[32:35], v[72:75], 0
ds_read_b128 v[120:123], v17 offset:4096
ds_read_b128 v[124:127], v17 offset:6144
v_mfma_f32_16x16x32_bf16 v[140:143], v[32:35], v[76:79], 0
ds_read_b64_tr_b16 v[84:85], v9 offset:8192
ds_read_b64_tr_b16 v[86:87], v9 offset:9216
v_mfma_f32_16x16x32_bf16 v[156:159], v[36:39], v[76:79], 0
ds_read_b64_tr_b16 v[88:89], v10 offset:8192
v_accvgpr_read_b32 v20, a8
v_mfma_f32_16x16x32_bf16 v[152:155], v[36:39], v[72:75], 0
ds_read_b64_tr_b16 v[90:91], v10 offset:9216
v_accvgpr_read_b32 v28, a9
v_mfma_f32_16x16x32_bf16 v[148:151], v[36:39], v[68:71], 0
ds_read_b64_tr_b16 v[92:93], v11 offset:8192
v_accvgpr_read_b32 v21, a10
v_mfma_f32_16x16x32_bf16 v[144:147], v[36:39], v[64:67], 0
ds_read_b64_tr_b16 v[94:95], v11 offset:9216
v_accvgpr_read_b32 v29, a11
v_mfma_f32_16x16x32_bf16 v[160:163], v[40:43], v[64:67], 0
ds_read_b64_tr_b16 v[96:97], v12 offset:8192
v_accvgpr_read_b32 v22, a40
v_mfma_f32_16x16x32_bf16 v[164:167], v[40:43], v[68:71], 0
ds_read_b64_tr_b16 v[98:99], v12 offset:9216
v_accvgpr_read_b32 v30, a41
v_mfma_f32_16x16x32_bf16 v[168:171], v[40:43], v[72:75], 0
ds_read_b64_tr_b16 v[100:101], v13 offset:8192
v_accvgpr_read_b32 v23, a42
v_mfma_f32_16x16x32_bf16 v[172:175], v[40:43], v[76:79], 0
ds_read_b64_tr_b16 v[102:103], v13 offset:9216
v_accvgpr_read_b32 v31, a43
v_mfma_f32_16x16x32_bf16 v[188:191], v[44:47], v[76:79], 0
ds_read_b64_tr_b16 v[104:105], v14 offset:8192
v_mul_f32 v20, s79, v20
v_mfma_f32_16x16x32_bf16 v[184:187], v[44:47], v[72:75], 0
ds_read_b64_tr_b16 v[106:107], v14 offset:9216
v_mul_f32 v28, s79, v28
v_mfma_f32_16x16x32_bf16 v[180:183], v[44:47], v[68:71], 0
ds_read_b64_tr_b16 v[108:109], v15 offset:8192
v_mul_f32 v21, s79, v21
v_mfma_f32_16x16x32_bf16 v[176:179], v[44:47], v[64:67], 0
ds_read_b64_tr_b16 v[110:111], v15 offset:9216
v_mul_f32 v29, s79, v29
v_mfma_f32_16x16x32_bf16 v[192:195], v[48:51], v[64:67], 0
v_mul_f32 v22, s79, v22
v_mul_f32 v30, s79, v30
v_mfma_f32_16x16x32_bf16 v[196:199], v[48:51], v[68:71], 0
v_mul_f32 v23, s79, v23
v_mul_f32 v31, s79, v31
v_mfma_f32_16x16x32_bf16 v[200:203], v[48:51], v[72:75], 0
v_cvt_pk_bf16_f32 v20, v20, v28
v_cvt_pk_bf16_f32 v21, v21, v29
v_mfma_f32_16x16x32_bf16 v[204:207], v[48:51], v[76:79], 0
v_cvt_pk_bf16_f32 v22, v22, v30
v_cvt_pk_bf16_f32 v23, v23, v31
v_mfma_f32_16x16x32_bf16 v[220:223], v[52:55], v[76:79], 0
s_add_u32 s80, s77, 8192
buffer_store_dwordx4 v[20:23], v1, s[44:47], s80 offen sc1
v_mfma_f32_16x16x32_bf16 v[216:219], v[52:55], v[72:75], 0
v_mfma_f32_16x16x32_bf16 v[212:215], v[52:55], v[68:71], 0
v_accvgpr_read_b32 v24, a128
v_accvgpr_read_b32 v28, a129
v_mfma_f32_16x16x32_bf16 v[208:211], v[52:55], v[64:67], 0
v_accvgpr_read_b32 v25, a130
v_accvgpr_read_b32 v29, a131
v_mfma_f32_16x16x32_bf16 v[224:227], v[56:59], v[64:67], 0
v_accvgpr_read_b32 v26, a132
v_accvgpr_read_b32 v30, a133
v_mfma_f32_16x16x32_bf16 v[228:231], v[56:59], v[68:71], 0
v_accvgpr_read_b32 v27, a134
v_accvgpr_read_b32 v31, a135
v_mfma_f32_16x16x32_bf16 v[232:235], v[56:59], v[72:75], 0
v_cvt_pk_bf16_f32 v24, v24, v28
v_cvt_pk_bf16_f32 v25, v25, v29
v_mfma_f32_16x16x32_bf16 v[236:239], v[56:59], v[76:79], 0
v_cvt_pk_bf16_f32 v26, v26, v30
v_cvt_pk_bf16_f32 v27, v27, v31
v_mfma_f32_16x16x32_bf16 v[252:255], v[60:63], v[76:79], 0
s_add_u32 s80, s78, 0
buffer_store_dwordx4 v[24:27], v1, s[44:47], s80 offen sc1
v_mfma_f32_16x16x32_bf16 v[248:251], v[60:63], v[72:75], 0
v_mfma_f32_16x16x32_bf16 v[244:247], v[60:63], v[68:71], 0
s_waitcnt vmcnt(17) lgkmcnt(0)
v_mfma_f32_16x16x32_bf16 v[240:243], v[60:63], v[64:67], 0
s_barrier
v_mfma_f32_16x16x32_bf16 v[128:131], v[80:83], v[112:115], v[128:131]
s_add_u32 s73, s62, 3
ds_read_b64_tr_b16 v[32:33], v8 offset:16384
ds_read_b64_tr_b16 v[34:35], v8 offset:17408
v_mfma_f32_16x16x32_bf16 v[132:135], v[80:83], v[116:119], v[132:135]
s_add_u32 s70, s73, s65
ds_read_b128 v[64:67], v18 offset:0
ds_read_b128 v[68:71], v18 offset:2048
v_mfma_f32_16x16x32_bf16 v[136:139], v[80:83], v[120:123], v[136:139]
s_and_b32 s70, s70, 3
ds_read_b128 v[72:75], v18 offset:4096
ds_read_b128 v[76:79], v18 offset:6144
v_mfma_f32_16x16x32_bf16 v[140:143], v[80:83], v[124:127], v[140:143]
s_and_b32 s73, s73, 12
ds_read_b64_tr_b16 v[36:37], v9 offset:16384
ds_read_b64_tr_b16 v[38:39], v9 offset:17408
v_mfma_f32_16x16x32_bf16 v[156:159], v[84:87], v[124:127], v[156:159]
s_or_b32 s73, s73, s70
ds_read_b64_tr_b16 v[40:41], v10 offset:16384
v_mfma_f32_16x16x32_bf16 v[152:155], v[84:87], v[120:123], v[152:155]
s_lshl_b32 s71, s73, 19
ds_read_b64_tr_b16 v[42:43], v10 offset:17408
v_mfma_f32_16x16x32_bf16 v[148:151], v[84:87], v[116:119], v[148:151]
s_add_u32 s71, s71, s66
ds_read_b64_tr_b16 v[44:45], v11 offset:16384
v_mfma_f32_16x16x32_bf16 v[144:147], v[84:87], v[112:115], v[144:147]
s_lshl_b32 s73, s73, 7
ds_read_b64_tr_b16 v[46:47], v11 offset:17408
v_mfma_f32_16x16x32_bf16 v[160:163], v[88:91], v[112:115], v[160:163]
s_add_u32 s69, s73, s67
ds_read_b64_tr_b16 v[48:49], v12 offset:16384
v_mfma_f32_16x16x32_bf16 v[164:167], v[88:91], v[116:119], v[164:167]
s_add_u32 s70, s73, s68
ds_read_b64_tr_b16 v[50:51], v12 offset:17408
v_mfma_f32_16x16x32_bf16 v[168:171], v[88:91], v[120:123], v[168:171]
s_add_u32 m0, s64, 0
ds_read_b64_tr_b16 v[52:53], v13 offset:16384
v_mfma_f32_16x16x32_bf16 v[172:175], v[88:91], v[124:127], v[172:175]
s_add_u32 s72, s71, 0
buffer_load_dwordx4 v6, s[12:15], s72 offen lds
v_mfma_f32_16x16x32_bf16 v[188:191], v[92:95], v[124:127], v[188:191]
s_add_u32 s72, s71, 31744
buffer_load_dwordx4 v6, s[12:15], s72 offen offset:1024 lds
v_mfma_f32_16x16x32_bf16 v[184:187], v[92:95], v[120:123], v[184:187]
s_add_u32 s72, s71, 63488
buffer_load_dwordx4 v7, s[12:15], s72 offen offset:2048 lds
v_mfma_f32_16x16x32_bf16 v[180:183], v[92:95], v[116:119], v[180:183]
s_add_u32 s72, s71, 95232
buffer_load_dwordx4 v7, s[12:15], s72 offen offset:3072 lds
v_mfma_f32_16x16x32_bf16 v[176:179], v[92:95], v[112:115], v[176:179]
ds_read_b64_tr_b16 v[54:55], v13 offset:17408
v_accvgpr_read_b32 v20, a12
v_mfma_f32_16x16x32_bf16 v[192:195], v[96:99], v[112:115], v[192:195]
ds_read_b64_tr_b16 v[56:57], v14 offset:16384
v_accvgpr_read_b32 v28, a13
v_mfma_f32_16x16x32_bf16 v[196:199], v[96:99], v[116:119], v[196:199]
ds_read_b64_tr_b16 v[58:59], v14 offset:17408
v_accvgpr_read_b32 v21, a14
v_mfma_f32_16x16x32_bf16 v[200:203], v[96:99], v[120:123], v[200:203]
ds_read_b64_tr_b16 v[60:61], v15 offset:16384
v_accvgpr_read_b32 v29, a15
v_mfma_f32_16x16x32_bf16 v[204:207], v[96:99], v[124:127], v[204:207]
s_add_u32 m0, s63, 131072
ds_read_b64_tr_b16 v[62:63], v15 offset:17408
v_accvgpr_read_b32 v22, a44
v_mfma_f32_16x16x32_bf16 v[220:223], v[100:103], v[124:127], v[220:223]
s_add_u32 s72, s69, 0
buffer_load_dwordx4 v4, s[4:7], s72 offen lds
v_mfma_f32_16x16x32_bf16 v[216:219], v[100:103], v[120:123], v[216:219]
v_accvgpr_read_b32 v30, a45
v_accvgpr_read_b32 v23, a46
v_mfma_f32_16x16x32_bf16 v[212:215], v[100:103], v[116:119], v[212:215]
v_accvgpr_read_b32 v31, a47
v_mul_f32 v20, s79, v20
v_mfma_f32_16x16x32_bf16 v[208:211], v[100:103], v[112:115], v[208:211]
v_mul_f32 v28, s79, v28
v_mul_f32 v21, s79, v21
v_mfma_f32_16x16x32_bf16 v[224:227], v[104:107], v[112:115], v[224:227]
s_add_u32 s72, s69, 15360
buffer_load_dwordx4 v5, s[4:7], s72 offen offset:1024 lds
v_mfma_f32_16x16x32_bf16 v[228:231], v[104:107], v[116:119], v[228:231]
v_mul_f32 v29, s79, v29
v_mul_f32 v22, s79, v22
v_mfma_f32_16x16x32_bf16 v[232:235], v[104:107], v[120:123], v[232:235]
v_mul_f32 v30, s79, v30
v_mul_f32 v23, s79, v23
v_mfma_f32_16x16x32_bf16 v[236:239], v[104:107], v[124:127], v[236:239]
v_mul_f32 v31, s79, v31
v_cvt_pk_bf16_f32 v20, v20, v28
v_mfma_f32_16x16x32_bf16 v[252:255], v[108:111], v[124:127], v[252:255]
v_cvt_pk_bf16_f32 v21, v21, v29
v_cvt_pk_bf16_f32 v22, v22, v30
v_mfma_f32_16x16x32_bf16 v[248:251], v[108:111], v[120:123], v[248:251]
s_add_u32 s72, s69, 129024
buffer_load_dwordx4 v4, s[4:7], s72 offen offset:2048 lds
v_mfma_f32_16x16x32_bf16 v[244:247], v[108:111], v[116:119], v[244:247]
v_cvt_pk_bf16_f32 v23, v23, v31
v_mfma_f32_16x16x32_bf16 v[240:243], v[108:111], v[112:115], v[240:243]
s_waitcnt lgkmcnt(0)
v_accvgpr_read_b32 v24, a136
v_accvgpr_read_b32 v28, a137
v_mfma_f32_16x16x32_bf16 v[128:131], v[32:35], v[64:67], v[128:131]
s_add_u32 s80, s77, 12288
ds_read_b64_tr_b16 v[80:81], v8 offset:24576
ds_read_b64_tr_b16 v[82:83], v8 offset:25600
v_mfma_f32_16x16x32_bf16 v[132:135], v[32:35], v[68:71], v[132:135]
ds_read_b128 v[112:115], v19 offset:0
ds_read_b128 v[116:119], v19 offset:2048
v_mfma_f32_16x16x32_bf16 v[136:139], v[32:35], v[72:75], v[136:139]
s_add_u32 s72, s69, 144384
buffer_load_dwordx4 v5, s[4:7], s72 offen offset:3072 lds
v_mfma_f32_16x16x32_bf16 v[140:143], v[32:35], v[76:79], v[140:143]
ds_read_b128 v[120:123], v19 offset:4096
ds_read_b128 v[124:127], v19 offset:6144
v_mfma_f32_16x16x32_bf16 v[156:159], v[36:39], v[76:79], v[156:159]
ds_read_b64_tr_b16 v[84:85], v9 offset:24576
ds_read_b64_tr_b16 v[86:87], v9 offset:25600
v_mfma_f32_16x16x32_bf16 v[152:155], v[36:39], v[72:75], v[152:155]
ds_read_b64_tr_b16 v[88:89], v10 offset:24576
v_accvgpr_read_b32 v25, a138
v_mfma_f32_16x16x32_bf16 v[148:151], v[36:39], v[68:71], v[148:151]
ds_read_b64_tr_b16 v[90:91], v10 offset:25600
v_accvgpr_read_b32 v29, a139
v_mfma_f32_16x16x32_bf16 v[144:147], v[36:39], v[64:67], v[144:147]
s_add_u32 m0, s63, 135168
ds_read_b64_tr_b16 v[92:93], v11 offset:24576
v_accvgpr_read_b32 v26, a140
v_mfma_f32_16x16x32_bf16 v[160:163], v[40:43], v[64:67], v[160:163]
s_add_u32 s72, s70, 0
buffer_load_dwordx4 v4, s[4:7], s72 offen lds
v_mfma_f32_16x16x32_bf16 v[164:167], v[40:43], v[68:71], v[164:167]
ds_read_b64_tr_b16 v[94:95], v11 offset:25600
v_accvgpr_read_b32 v30, a141
v_mfma_f32_16x16x32_bf16 v[168:171], v[40:43], v[72:75], v[168:171]
ds_read_b64_tr_b16 v[96:97], v12 offset:24576
v_accvgpr_read_b32 v27, a142
v_mfma_f32_16x16x32_bf16 v[172:175], v[40:43], v[76:79], v[172:175]
ds_read_b64_tr_b16 v[98:99], v12 offset:25600
v_accvgpr_read_b32 v31, a143
v_mfma_f32_16x16x32_bf16 v[188:191], v[44:47], v[76:79], v[188:191]
s_add_u32 s72, s70, 15360
buffer_load_dwordx4 v5, s[4:7], s72 offen offset:1024 lds
v_mfma_f32_16x16x32_bf16 v[184:187], v[44:47], v[72:75], v[184:187]
ds_read_b64_tr_b16 v[100:101], v13 offset:24576
v_cvt_pk_bf16_f32 v24, v24, v28
v_mfma_f32_16x16x32_bf16 v[180:183], v[44:47], v[68:71], v[180:183]
ds_read_b64_tr_b16 v[102:103], v13 offset:25600
v_cvt_pk_bf16_f32 v25, v25, v29
v_mfma_f32_16x16x32_bf16 v[176:179], v[44:47], v[64:67], v[176:179]
ds_read_b64_tr_b16 v[104:105], v14 offset:24576
v_cvt_pk_bf16_f32 v26, v26, v30
v_mfma_f32_16x16x32_bf16 v[192:195], v[48:51], v[64:67], v[192:195]
ds_read_b64_tr_b16 v[106:107], v14 offset:25600
v_cvt_pk_bf16_f32 v27, v27, v31
v_mfma_f32_16x16x32_bf16 v[196:199], v[48:51], v[68:71], v[196:199]
s_add_u32 s72, s70, 129024
buffer_load_dwordx4 v4, s[4:7], s72 offen offset:2048 lds
v_mfma_f32_16x16x32_bf16 v[200:203], v[48:51], v[72:75], v[200:203]
ds_read_b64_tr_b16 v[108:109], v15 offset:24576
v_mfma_f32_16x16x32_bf16 v[204:207], v[48:51], v[76:79], v[204:207]
ds_read_b64_tr_b16 v[110:111], v15 offset:25600
v_mfma_f32_16x16x32_bf16 v[220:223], v[52:55], v[76:79], v[220:223]
buffer_store_dwordx4 v[20:23], v1, s[44:47], s80 offen sc1
v_mfma_f32_16x16x32_bf16 v[216:219], v[52:55], v[72:75], v[216:219]
s_add_u32 s80, s78, 8192
buffer_store_dwordx4 v[24:27], v1, s[44:47], s80 offen sc1
v_mfma_f32_16x16x32_bf16 v[212:215], v[52:55], v[68:71], v[212:215]
s_add_u32 s72, s70, 144384
buffer_load_dwordx4 v5, s[4:7], s72 offen offset:3072 lds
v_mfma_f32_16x16x32_bf16 v[208:211], v[52:55], v[64:67], v[208:211]
v_accvgpr_read_b32 v20, a16
v_accvgpr_read_b32 v28, a17
v_mfma_f32_16x16x32_bf16 v[224:227], v[56:59], v[64:67], v[224:227]
v_accvgpr_read_b32 v21, a18
v_accvgpr_read_b32 v29, a19
v_mfma_f32_16x16x32_bf16 v[228:231], v[56:59], v[68:71], v[228:231]
v_accvgpr_read_b32 v22, a48
v_accvgpr_read_b32 v30, a49
v_mfma_f32_16x16x32_bf16 v[232:235], v[56:59], v[72:75], v[232:235]
v_accvgpr_read_b32 v23, a50
v_accvgpr_read_b32 v31, a51
v_mfma_f32_16x16x32_bf16 v[236:239], v[56:59], v[76:79], v[236:239]
v_mul_f32 v20, s79, v20
v_mul_f32 v28, s79, v28
v_mfma_f32_16x16x32_bf16 v[252:255], v[60:63], v[76:79], v[252:255]
v_mul_f32 v21, s79, v21
v_mul_f32 v29, s79, v29
v_mfma_f32_16x16x32_bf16 v[248:251], v[60:63], v[72:75], v[248:251]
v_mul_f32 v22, s79, v22
v_mul_f32 v30, s79, v30
v_mfma_f32_16x16x32_bf16 v[244:247], v[60:63], v[68:71], v[244:247]
s_waitcnt vmcnt(17) lgkmcnt(0)
v_mul_f32 v23, s79, v23
v_mul_f32 v31, s79, v31
v_mfma_f32_16x16x32_bf16 v[240:243], v[60:63], v[64:67], v[240:243]
s_barrier
v_cvt_pk_bf16_f32 v20, v20, v28
v_cvt_pk_bf16_f32 v21, v21, v29
v_mfma_f32_16x16x32_bf16 v[128:131], v[80:83], v[112:115], v[128:131]
s_add_u32 s73, s62, 4
ds_read_b64_tr_b16 v[32:33], v8 offset:32768
ds_read_b64_tr_b16 v[34:35], v8 offset:33792
v_mfma_f32_16x16x32_bf16 v[132:135], v[80:83], v[116:119], v[132:135]
s_add_u32 s70, s73, s65
ds_read_b128 v[64:67], v18 offset:32768
ds_read_b128 v[68:71], v18 offset:34816
v_mfma_f32_16x16x32_bf16 v[136:139], v[80:83], v[120:123], v[136:139]
s_and_b32 s70, s70, 3
ds_read_b128 v[72:75], v18 offset:36864
ds_read_b128 v[76:79], v18 offset:38912
v_mfma_f32_16x16x32_bf16 v[140:143], v[80:83], v[124:127], v[140:143]
s_and_b32 s73, s73, 12
ds_read_b64_tr_b16 v[36:37], v9 offset:32768
ds_read_b64_tr_b16 v[38:39], v9 offset:33792
v_mfma_f32_16x16x32_bf16 v[156:159], v[84:87], v[124:127], v[156:159]
s_or_b32 s73, s73, s70
ds_read_b64_tr_b16 v[40:41], v10 offset:32768
v_cvt_pk_bf16_f32 v22, v22, v30
v_mfma_f32_16x16x32_bf16 v[152:155], v[84:87], v[120:123], v[152:155]
s_lshl_b32 s71, s73, 19
ds_read_b64_tr_b16 v[42:43], v10 offset:33792
v_cvt_pk_bf16_f32 v23, v23, v31
v_mfma_f32_16x16x32_bf16 v[148:151], v[84:87], v[116:119], v[148:151]
s_add_u32 s71, s71, s66
ds_read_b64_tr_b16 v[44:45], v11 offset:32768
v_mfma_f32_16x16x32_bf16 v[144:147], v[84:87], v[112:115], v[144:147]
s_lshl_b32 s73, s73, 7
ds_read_b64_tr_b16 v[46:47], v11 offset:33792
v_accvgpr_read_b32 v24, a144
v_mfma_f32_16x16x32_bf16 v[160:163], v[88:91], v[112:115], v[160:163]
s_add_u32 s69, s73, s67
ds_read_b64_tr_b16 v[48:49], v12 offset:32768
v_accvgpr_read_b32 v28, a145
v_mfma_f32_16x16x32_bf16 v[164:167], v[88:91], v[116:119], v[164:167]
s_add_u32 s70, s73, s68
ds_read_b64_tr_b16 v[50:51], v12 offset:33792
v_accvgpr_read_b32 v25, a146
v_mfma_f32_16x16x32_bf16 v[168:171], v[88:91], v[120:123], v[168:171]
s_add_u32 m0, s64, 16384
ds_read_b64_tr_b16 v[52:53], v13 offset:32768
v_accvgpr_read_b32 v29, a147
v_mfma_f32_16x16x32_bf16 v[172:175], v[88:91], v[124:127], v[172:175]
s_add_u32 s72, s71, 0
buffer_load_dwordx4 v6, s[12:15], s72 offen lds
v_mfma_f32_16x16x32_bf16 v[188:191], v[92:95], v[124:127], v[188:191]
s_add_u32 s72, s71, 31744
buffer_load_dwordx4 v6, s[12:15], s72 offen offset:1024 lds
v_mfma_f32_16x16x32_bf16 v[184:187], v[92:95], v[120:123], v[184:187]
s_add_u32 s72, s71, 63488
buffer_load_dwordx4 v7, s[12:15], s72 offen offset:2048 lds
v_mfma_f32_16x16x32_bf16 v[180:183], v[92:95], v[116:119], v[180:183]
s_add_u32 s72, s71, 95232
buffer_load_dwordx4 v7, s[12:15], s72 offen offset:3072 lds
v_mfma_f32_16x16x32_bf16 v[176:179], v[92:95], v[112:115], v[176:179]
s_add_u32 s80, s77, 32768
ds_read_b64_tr_b16 v[54:55], v13 offset:33792
v_accvgpr_read_b32 v26, a148
v_mfma_f32_16x16x32_bf16 v[192:195], v[96:99], v[112:115], v[192:195]
ds_read_b64_tr_b16 v[56:57], v14 offset:32768
v_accvgpr_read_b32 v30, a149
v_mfma_f32_16x16x32_bf16 v[196:199], v[96:99], v[116:119], v[196:199]
ds_read_b64_tr_b16 v[58:59], v14 offset:33792
v_accvgpr_read_b32 v27, a150
v_mfma_f32_16x16x32_bf16 v[200:203], v[96:99], v[120:123], v[200:203]
ds_read_b64_tr_b16 v[60:61], v15 offset:32768
v_accvgpr_read_b32 v31, a151
v_mfma_f32_16x16x32_bf16 v[204:207], v[96:99], v[124:127], v[204:207]
s_add_u32 m0, s63, 65536
ds_read_b64_tr_b16 v[62:63], v15 offset:33792
v_cvt_pk_bf16_f32 v24, v24, v28
v_mfma_f32_16x16x32_bf16 v[220:223], v[100:103], v[124:127], v[220:223]
s_add_u32 s72, s69, 0
buffer_load_dwordx4 v4, s[4:7], s72 offen lds
v_mfma_f32_16x16x32_bf16 v[216:219], v[100:103], v[120:123], v[216:219]
buffer_store_dwordx4 v[20:23], v1, s[44:47], s80 offen sc1
v_mfma_f32_16x16x32_bf16 v[212:215], v[100:103], v[116:119], v[212:215]
v_cvt_pk_bf16_f32 v25, v25, v29
v_cvt_pk_bf16_f32 v26, v26, v30
v_mfma_f32_16x16x32_bf16 v[208:211], v[100:103], v[112:115], v[208:211]
v_cvt_pk_bf16_f32 v27, v27, v31
v_mfma_f32_16x16x32_bf16 v[224:227], v[104:107], v[112:115], v[224:227]
s_add_u32 s72, s69, 15360
buffer_load_dwordx4 v5, s[4:7], s72 offen offset:1024 lds
v_mfma_f32_16x16x32_bf16 v[228:231], v[104:107], v[116:119], v[228:231]
s_add_u32 s80, s78, 32768
buffer_store_dwordx4 v[24:27], v1, s[44:47], s80 offen sc1
v_mfma_f32_16x16x32_bf16 v[232:235], v[104:107], v[120:123], v[232:235]
v_mfma_f32_16x16x32_bf16 v[236:239], v[104:107], v[124:127], v[236:239]
v_mfma_f32_16x16x32_bf16 v[252:255], v[108:111], v[124:127], v[252:255]
v_accvgpr_read_b32 v20, a20
v_accvgpr_read_b32 v28, a21
v_mfma_f32_16x16x32_bf16 v[248:251], v[108:111], v[120:123], v[248:251]
s_add_u32 s72, s69, 129024
buffer_load_dwordx4 v4, s[4:7], s72 offen offset:2048 lds
v_mfma_f32_16x16x32_bf16 v[244:247], v[108:111], v[116:119], v[244:247]
v_accvgpr_read_b32 v21, a22
v_accvgpr_read_b32 v29, a23
v_mfma_f32_16x16x32_bf16 v[240:243], v[108:111], v[112:115], v[240:243]
s_waitcnt lgkmcnt(0)
v_accvgpr_read_b32 v22, a52
v_accvgpr_read_b32 v30, a53
v_mfma_f32_16x16x32_bf16 v[128:131], v[32:35], v[64:67], v[128:131]
ds_read_b64_tr_b16 v[80:81], v8 offset:40960
ds_read_b64_tr_b16 v[82:83], v8 offset:41984
v_mfma_f32_16x16x32_bf16 v[132:135], v[32:35], v[68:71], v[132:135]
ds_read_b128 v[112:115], v19 offset:32768
ds_read_b128 v[116:119], v19 offset:34816
v_mfma_f32_16x16x32_bf16 v[136:139], v[32:35], v[72:75], v[136:139]
s_add_u32 s72, s69, 144384
buffer_load_dwordx4 v5, s[4:7], s72 offen offset:3072 lds
v_mfma_f32_16x16x32_bf16 v[140:143], v[32:35], v[76:79], v[140:143]
ds_read_b128 v[120:123], v19 offset:36864
ds_read_b128 v[124:127], v19 offset:38912
v_mfma_f32_16x16x32_bf16 v[156:159], v[36:39], v[76:79], v[156:159]
ds_read_b64_tr_b16 v[84:85], v9 offset:40960
ds_read_b64_tr_b16 v[86:87], v9 offset:41984
v_mfma_f32_16x16x32_bf16 v[152:155], v[36:39], v[72:75], v[152:155]
ds_read_b64_tr_b16 v[88:89], v10 offset:40960
v_accvgpr_read_b32 v23, a54
v_mfma_f32_16x16x32_bf16 v[148:151], v[36:39], v[68:71], v[148:151]
ds_read_b64_tr_b16 v[90:91], v10 offset:41984
v_accvgpr_read_b32 v31, a55
v_mfma_f32_16x16x32_bf16 v[144:147], v[36:39], v[64:67], v[144:147]
s_add_u32 m0, s63, 69632
ds_read_b64_tr_b16 v[92:93], v11 offset:40960
v_mul_f32 v20, s79, v20
v_mfma_f32_16x16x32_bf16 v[160:163], v[40:43], v[64:67], v[160:163]
s_add_u32 s72, s70, 0
buffer_load_dwordx4 v4, s[4:7], s72 offen lds
v_mfma_f32_16x16x32_bf16 v[164:167], v[40:43], v[68:71], v[164:167]
ds_read_b64_tr_b16 v[94:95], v11 offset:41984
v_mul_f32 v28, s79, v28
v_mfma_f32_16x16x32_bf16 v[168:171], v[40:43], v[72:75], v[168:171]
ds_read_b64_tr_b16 v[96:97], v12 offset:40960
v_mul_f32 v21, s79, v21
v_mfma_f32_16x16x32_bf16 v[172:175], v[40:43], v[76:79], v[172:175]
ds_read_b64_tr_b16 v[98:99], v12 offset:41984
v_mul_f32 v29, s79, v29
v_mfma_f32_16x16x32_bf16 v[188:191], v[44:47], v[76:79], v[188:191]
s_add_u32 s72, s70, 15360
buffer_load_dwordx4 v5, s[4:7], s72 offen offset:1024 lds
v_mfma_f32_16x16x32_bf16 v[184:187], v[44:47], v[72:75], v[184:187]
ds_read_b64_tr_b16 v[100:101], v13 offset:40960
v_mul_f32 v22, s79, v22
v_mfma_f32_16x16x32_bf16 v[180:183], v[44:47], v[68:71], v[180:183]
ds_read_b64_tr_b16 v[102:103], v13 offset:41984
v_mul_f32 v30, s79, v30
v_mfma_f32_16x16x32_bf16 v[176:179], v[44:47], v[64:67], v[176:179]
ds_read_b64_tr_b16 v[104:105], v14 offset:40960
v_mul_f32 v23, s79, v23
v_mfma_f32_16x16x32_bf16 v[192:195], v[48:51], v[64:67], v[192:195]
ds_read_b64_tr_b16 v[106:107], v14 offset:41984
v_mul_f32 v31, s79, v31
v_mfma_f32_16x16x32_bf16 v[196:199], v[48:51], v[68:71], v[196:199]
s_add_u32 s72, s70, 129024
buffer_load_dwordx4 v4, s[4:7], s72 offen offset:2048 lds
v_mfma_f32_16x16x32_bf16 v[200:203], v[48:51], v[72:75], v[200:203]
ds_read_b64_tr_b16 v[108:109], v15 offset:40960
v_cvt_pk_bf16_f32 v20, v20, v28
v_mfma_f32_16x16x32_bf16 v[204:207], v[48:51], v[76:79], v[204:207]
ds_read_b64_tr_b16 v[110:111], v15 offset:41984
v_cvt_pk_bf16_f32 v21, v21, v29
v_mfma_f32_16x16x32_bf16 v[220:223], v[52:55], v[76:79], v[220:223]
v_cvt_pk_bf16_f32 v22, v22, v30
v_cvt_pk_bf16_f32 v23, v23, v31
v_mfma_f32_16x16x32_bf16 v[216:219], v[52:55], v[72:75], v[216:219]
s_add_u32 s80, s77, 36864
buffer_store_dwordx4 v[20:23], v1, s[44:47], s80 offen sc1
v_mfma_f32_16x16x32_bf16 v[212:215], v[52:55], v[68:71], v[212:215]
s_add_u32 s72, s70, 144384
buffer_load_dwordx4 v5, s[4:7], s72 offen offset:3072 lds
v_mfma_f32_16x16x32_bf16 v[208:211], v[52:55], v[64:67], v[208:211]
v_accvgpr_read_b32 v24, a152
v_accvgpr_read_b32 v28, a153
v_mfma_f32_16x16x32_bf16 v[224:227], v[56:59], v[64:67], v[224:227]
v_accvgpr_read_b32 v25, a154
v_accvgpr_read_b32 v29, a155
v_mfma_f32_16x16x32_bf16 v[228:231], v[56:59], v[68:71], v[228:231]
v_accvgpr_read_b32 v26, a156
v_accvgpr_read_b32 v30, a157
v_mfma_f32_16x16x32_bf16 v[232:235], v[56:59], v[72:75], v[232:235]
v_accvgpr_read_b32 v27, a158
v_accvgpr_read_b32 v31, a159
v_mfma_f32_16x16x32_bf16 v[236:239], v[56:59], v[76:79], v[236:239]
v_cvt_pk_bf16_f32 v24, v24, v28
v_cvt_pk_bf16_f32 v25, v25, v29
v_mfma_f32_16x16x32_bf16 v[252:255], v[60:63], v[76:79], v[252:255]
v_cvt_pk_bf16_f32 v26, v26, v30
v_cvt_pk_bf16_f32 v27, v27, v31
v_mfma_f32_16x16x32_bf16 v[248:251], v[60:63], v[72:75], v[248:251]
s_add_u32 s80, s78, 40960
buffer_store_dwordx4 v[24:27], v1, s[44:47], s80 offen sc1
v_mfma_f32_16x16x32_bf16 v[244:247], v[60:63], v[68:71], v[244:247]
s_waitcnt vmcnt(16) lgkmcnt(0)
v_mfma_f32_16x16x32_bf16 v[240:243], v[60:63], v[64:67], v[240:243]
s_barrier
v_mfma_f32_16x16x32_bf16 v[128:131], v[80:83], v[112:115], v[128:131]
s_add_u32 s73, s62, 5
ds_read_b64_tr_b16 v[32:33], v8 offset:0
ds_read_b64_tr_b16 v[34:35], v8 offset:1024
v_mfma_f32_16x16x32_bf16 v[132:135], v[80:83], v[116:119], v[132:135]
s_add_u32 s70, s73, s65
ds_read_b128 v[64:67], v16 offset:0
ds_read_b128 v[68:71], v16 offset:2048
v_mfma_f32_16x16x32_bf16 v[136:139], v[80:83], v[120:123], v[136:139]
s_and_b32 s70, s70, 3
ds_read_b128 v[72:75], v16 offset:4096
ds_read_b128 v[76:79], v16 offset:6144
v_mfma_f32_16x16x32_bf16 v[140:143], v[80:83], v[124:127], v[140:143]
s_and_b32 s73, s73, 12
ds_read_b64_tr_b16 v[36:37], v9 offset:0
ds_read_b64_tr_b16 v[38:39], v9 offset:1024
v_mfma_f32_16x16x32_bf16 v[156:159], v[84:87], v[124:127], v[156:159]
s_or_b32 s73, s73, s70
ds_read_b64_tr_b16 v[40:41], v10 offset:0
v_accvgpr_read_b32 v20, a24
v_mfma_f32_16x16x32_bf16 v[152:155], v[84:87], v[120:123], v[152:155]
s_lshl_b32 s71, s73, 19
ds_read_b64_tr_b16 v[42:43], v10 offset:1024
v_accvgpr_read_b32 v28, a25
v_mfma_f32_16x16x32_bf16 v[148:151], v[84:87], v[116:119], v[148:151]
s_add_u32 s71, s71, s66
ds_read_b64_tr_b16 v[44:45], v11 offset:0
v_accvgpr_read_b32 v21, a26
v_mfma_f32_16x16x32_bf16 v[144:147], v[84:87], v[112:115], v[144:147]
s_lshl_b32 s73, s73, 7
ds_read_b64_tr_b16 v[46:47], v11 offset:1024
v_accvgpr_read_b32 v29, a27
v_mfma_f32_16x16x32_bf16 v[160:163], v[88:91], v[112:115], v[160:163]
s_add_u32 s69, s73, s67
ds_read_b64_tr_b16 v[48:49], v12 offset:0
v_accvgpr_read_b32 v22, a56
v_mfma_f32_16x16x32_bf16 v[164:167], v[88:91], v[116:119], v[164:167]
s_add_u32 s70, s73, s68
ds_read_b64_tr_b16 v[50:51], v12 offset:1024
v_accvgpr_read_b32 v30, a57
v_mfma_f32_16x16x32_bf16 v[168:171], v[88:91], v[120:123], v[168:171]
s_add_u32 m0, s64, 32768
ds_read_b64_tr_b16 v[52:53], v13 offset:0
v_accvgpr_read_b32 v23, a58
v_mfma_f32_16x16x32_bf16 v[172:175], v[88:91], v[124:127], v[172:175]
s_add_u32 s72, s71, 0
buffer_load_dwordx4 v6, s[12:15], s72 offen lds
v_mfma_f32_16x16x32_bf16 v[188:191], v[92:95], v[124:127], v[188:191]
s_add_u32 s72, s71, 31744
buffer_load_dwordx4 v6, s[12:15], s72 offen offset:1024 lds
v_mfma_f32_16x16x32_bf16 v[184:187], v[92:95], v[120:123], v[184:187]
s_add_u32 s72, s71, 63488
buffer_load_dwordx4 v7, s[12:15], s72 offen offset:2048 lds
v_mfma_f32_16x16x32_bf16 v[180:183], v[92:95], v[116:119], v[180:183]
s_add_u32 s72, s71, 95232
buffer_load_dwordx4 v7, s[12:15], s72 offen offset:3072 lds
v_mfma_f32_16x16x32_bf16 v[176:179], v[92:95], v[112:115], v[176:179]
ds_read_b64_tr_b16 v[54:55], v13 offset:1024
v_accvgpr_read_b32 v31, a59
v_mfma_f32_16x16x32_bf16 v[192:195], v[96:99], v[112:115], v[192:195]
ds_read_b64_tr_b16 v[56:57], v14 offset:0
v_mul_f32 v20, s79, v20
v_mfma_f32_16x16x32_bf16 v[196:199], v[96:99], v[116:119], v[196:199]
ds_read_b64_tr_b16 v[58:59], v14 offset:1024
v_mul_f32 v28, s79, v28
v_mfma_f32_16x16x32_bf16 v[200:203], v[96:99], v[120:123], v[200:203]
ds_read_b64_tr_b16 v[60:61], v15 offset:0
v_mul_f32 v21, s79, v21
v_mfma_f32_16x16x32_bf16 v[204:207], v[96:99], v[124:127], v[204:207]
s_add_u32 m0, s63, 98304
ds_read_b64_tr_b16 v[62:63], v15 offset:1024
v_mul_f32 v29, s79, v29
v_mfma_f32_16x16x32_bf16 v[220:223], v[100:103], v[124:127], v[220:223]
s_add_u32 s72, s69, 0
buffer_load_dwordx4 v4, s[4:7], s72 offen lds
v_mfma_f32_16x16x32_bf16 v[216:219], v[100:103], v[120:123], v[216:219]
v_mul_f32 v22, s79, v22
v_mul_f32 v30, s79, v30
v_mfma_f32_16x16x32_bf16 v[212:215], v[100:103], v[116:119], v[212:215]
v_mul_f32 v23, s79, v23
v_mul_f32 v31, s79, v31
v_mfma_f32_16x16x32_bf16 v[208:211], v[100:103], v[112:115], v[208:211]
v_cvt_pk_bf16_f32 v20, v20, v28
v_cvt_pk_bf16_f32 v21, v21, v29
v_mfma_f32_16x16x32_bf16 v[224:227], v[104:107], v[112:115], v[224:227]
s_add_u32 s72, s69, 15360
buffer_load_dwordx4 v5, s[4:7], s72 offen offset:1024 lds
v_mfma_f32_16x16x32_bf16 v[228:231], v[104:107], v[116:119], v[228:231]
v_cvt_pk_bf16_f32 v22, v22, v30
v_cvt_pk_bf16_f32 v23, v23, v31
v_mfma_f32_16x16x32_bf16 v[232:235], v[104:107], v[120:123], v[232:235]
s_add_u32 s80, s77, 40960
buffer_store_dwordx4 v[20:23], v1, s[44:47], s80 offen sc1
v_mfma_f32_16x16x32_bf16 v[236:239], v[104:107], v[124:127], v[236:239]
v_accvgpr_read_b32 v24, a160
v_accvgpr_read_b32 v28, a161
v_mfma_f32_16x16x32_bf16 v[252:255], v[108:111], v[124:127], v[252:255]
v_accvgpr_read_b32 v25, a162
v_accvgpr_read_b32 v29, a163
v_mfma_f32_16x16x32_bf16 v[248:251], v[108:111], v[120:123], v[248:251]
s_add_u32 s72, s69, 129024
buffer_load_dwordx4 v4, s[4:7], s72 offen offset:2048 lds
v_mfma_f32_16x16x32_bf16 v[244:247], v[108:111], v[116:119], v[244:247]
v_accvgpr_read_b32 v26, a164
v_accvgpr_read_b32 v30, a165
v_mfma_f32_16x16x32_bf16 v[240:243], v[108:111], v[112:115], v[240:243]
s_waitcnt lgkmcnt(0)
v_accvgpr_read_b32 v27, a166
v_accvgpr_read_b32 v31, a167
v_mfma_f32_16x16x32_bf16 v[128:131], v[32:35], v[64:67], v[128:131]
ds_read_b64_tr_b16 v[80:81], v8 offset:8192
ds_read_b64_tr_b16 v[82:83], v8 offset:9216
v_mfma_f32_16x16x32_bf16 v[132:135], v[32:35], v[68:71], v[132:135]
ds_read_b128 v[112:115], v17 offset:0
ds_read_b128 v[116:119], v17 offset:2048
v_mfma_f32_16x16x32_bf16 v[136:139], v[32:35], v[72:75], v[136:139]
s_add_u32 s72, s69, 144384
buffer_load_dwordx4 v5, s[4:7], s72 offen offset:3072 lds
v_mfma_f32_16x16x32_bf16 v[140:143], v[32:35], v[76:79], v[140:143]
ds_read_b128 v[120:123], v17 offset:4096
ds_read_b128 v[124:127], v17 offset:6144
v_mfma_f32_16x16x32_bf16 v[156:159], v[36:39], v[76:79], v[156:159]
ds_read_b64_tr_b16 v[84:85], v9 offset:8192
ds_read_b64_tr_b16 v[86:87], v9 offset:9216
v_mfma_f32_16x16x32_bf16 v[152:155], v[36:39], v[72:75], v[152:155]
ds_read_b64_tr_b16 v[88:89], v10 offset:8192
v_cvt_pk_bf16_f32 v24, v24, v28
v_mfma_f32_16x16x32_bf16 v[148:151], v[36:39], v[68:71], v[148:151]
ds_read_b64_tr_b16 v[90:91], v10 offset:9216
v_cvt_pk_bf16_f32 v25, v25, v29
v_mfma_f32_16x16x32_bf16 v[144:147], v[36:39], v[64:67], v[144:147]
s_add_u32 m0, s63, 102400
ds_read_b64_tr_b16 v[92:93], v11 offset:8192
v_cvt_pk_bf16_f32 v26, v26, v30
v_mfma_f32_16x16x32_bf16 v[160:163], v[40:43], v[64:67], v[160:163]
s_add_u32 s72, s70, 0
buffer_load_dwordx4 v4, s[4:7], s72 offen lds
v_mfma_f32_16x16x32_bf16 v[164:167], v[40:43], v[68:71], v[164:167]
ds_read_b64_tr_b16 v[94:95], v11 offset:9216
v_cvt_pk_bf16_f32 v27, v27, v31
v_mfma_f32_16x16x32_bf16 v[168:171], v[40:43], v[72:75], v[168:171]
s_add_u32 s80, s78, 1024
ds_read_b64_tr_b16 v[96:97], v12 offset:8192
v_mfma_f32_16x16x32_bf16 v[172:175], v[40:43], v[76:79], v[172:175]
ds_read_b64_tr_b16 v[98:99], v12 offset:9216
v_mfma_f32_16x16x32_bf16 v[188:191], v[44:47], v[76:79], v[188:191]
s_add_u32 s72, s70, 15360
buffer_load_dwordx4 v5, s[4:7], s72 offen offset:1024 lds
v_mfma_f32_16x16x32_bf16 v[184:187], v[44:47], v[72:75], v[184:187]
ds_read_b64_tr_b16 v[100:101], v13 offset:8192
v_accvgpr_read_b32 v20, a28
v_mfma_f32_16x16x32_bf16 v[180:183], v[44:47], v[68:71], v[180:183]
ds_read_b64_tr_b16 v[102:103], v13 offset:9216
v_accvgpr_read_b32 v28, a29
v_mfma_f32_16x16x32_bf16 v[176:179], v[44:47], v[64:67], v[176:179]
ds_read_b64_tr_b16 v[104:105], v14 offset:8192
v_accvgpr_read_b32 v21, a30
v_mfma_f32_16x16x32_bf16 v[192:195], v[48:51], v[64:67], v[192:195]
ds_read_b64_tr_b16 v[106:107], v14 offset:9216
v_accvgpr_read_b32 v29, a31
v_mfma_f32_16x16x32_bf16 v[196:199], v[48:51], v[68:71], v[196:199]
s_add_u32 s72, s70, 129024
buffer_load_dwordx4 v4, s[4:7], s72 offen offset:2048 lds
v_mfma_f32_16x16x32_bf16 v[200:203], v[48:51], v[72:75], v[200:203]
ds_read_b64_tr_b16 v[108:109], v15 offset:8192
v_accvgpr_read_b32 v22, a60
v_mfma_f32_16x16x32_bf16 v[204:207], v[48:51], v[76:79], v[204:207]
ds_read_b64_tr_b16 v[110:111], v15 offset:9216
v_accvgpr_read_b32 v30, a61
v_mfma_f32_16x16x32_bf16 v[220:223], v[52:55], v[76:79], v[220:223]
buffer_store_dwordx4 v[24:27], v1, s[44:47], s80 offen sc1
v_mfma_f32_16x16x32_bf16 v[216:219], v[52:55], v[72:75], v[216:219]
v_accvgpr_read_b32 v23, a62
v_accvgpr_read_b32 v31, a63
v_mfma_f32_16x16x32_bf16 v[212:215], v[52:55], v[68:71], v[212:215]
s_add_u32 s72, s70, 144384
buffer_load_dwordx4 v5, s[4:7], s72 offen offset:3072 lds
v_mfma_f32_16x16x32_bf16 v[208:211], v[52:55], v[64:67], v[208:211]
v_mul_f32 v20, s79, v20
v_mul_f32 v28, s79, v28
v_mfma_f32_16x16x32_bf16 v[224:227], v[56:59], v[64:67], v[224:227]
v_mul_f32 v21, s79, v21
v_mul_f32 v29, s79, v29
v_mfma_f32_16x16x32_bf16 v[228:231], v[56:59], v[68:71], v[228:231]
v_mul_f32 v22, s79, v22
v_mul_f32 v30, s79, v30
v_mfma_f32_16x16x32_bf16 v[232:235], v[56:59], v[72:75], v[232:235]
v_mul_f32 v23, s79, v23
v_mul_f32 v31, s79, v31
v_mfma_f32_16x16x32_bf16 v[236:239], v[56:59], v[76:79], v[236:239]
v_cvt_pk_bf16_f32 v20, v20, v28
v_cvt_pk_bf16_f32 v21, v21, v29
v_mfma_f32_16x16x32_bf16 v[252:255], v[60:63], v[76:79], v[252:255]
v_cvt_pk_bf16_f32 v22, v22, v30
v_cvt_pk_bf16_f32 v23, v23, v31
v_mfma_f32_16x16x32_bf16 v[248:251], v[60:63], v[72:75], v[248:251]
s_add_u32 s80, s77, 45056
buffer_store_dwordx4 v[20:23], v1, s[44:47], s80 offen sc1
v_mfma_f32_16x16x32_bf16 v[244:247], v[60:63], v[68:71], v[244:247]
s_waitcnt vmcnt(16) lgkmcnt(0)
v_mfma_f32_16x16x32_bf16 v[240:243], v[60:63], v[64:67], v[240:243]
s_barrier
v_mfma_f32_16x16x32_bf16 v[128:131], v[80:83], v[112:115], v[128:131]
s_add_u32 s73, s62, 6
ds_read_b64_tr_b16 v[32:33], v8 offset:16384
ds_read_b64_tr_b16 v[34:35], v8 offset:17408
v_mfma_f32_16x16x32_bf16 v[132:135], v[80:83], v[116:119], v[132:135]
s_add_u32 s70, s73, s65
ds_read_b128 v[64:67], v18 offset:0
ds_read_b128 v[68:71], v18 offset:2048
v_mfma_f32_16x16x32_bf16 v[136:139], v[80:83], v[120:123], v[136:139]
s_and_b32 s70, s70, 3
ds_read_b128 v[72:75], v18 offset:4096
ds_read_b128 v[76:79], v18 offset:6144
v_mfma_f32_16x16x32_bf16 v[140:143], v[80:83], v[124:127], v[140:143]
s_and_b32 s73, s73, 12
ds_read_b64_tr_b16 v[36:37], v9 offset:16384
ds_read_b64_tr_b16 v[38:39], v9 offset:17408
v_mfma_f32_16x16x32_bf16 v[156:159], v[84:87], v[124:127], v[156:159]
s_or_b32 s73, s73, s70
ds_read_b64_tr_b16 v[40:41], v10 offset:16384
v_accvgpr_read_b32 v24, a168
v_mfma_f32_16x16x32_bf16 v[152:155], v[84:87], v[120:123], v[152:155]
s_lshl_b32 s71, s73, 19
ds_read_b64_tr_b16 v[42:43], v10 offset:17408
v_accvgpr_read_b32 v28, a169
v_mfma_f32_16x16x32_bf16 v[148:151], v[84:87], v[116:119], v[148:151]
s_add_u32 s71, s71, s66
ds_read_b64_tr_b16 v[44:45], v11 offset:16384
v_accvgpr_read_b32 v25, a170
v_mfma_f32_16x16x32_bf16 v[144:147], v[84:87], v[112:115], v[144:147]
s_lshl_b32 s73, s73, 7
ds_read_b64_tr_b16 v[46:47], v11 offset:17408
v_accvgpr_read_b32 v29, a171
v_mfma_f32_16x16x32_bf16 v[160:163], v[88:91], v[112:115], v[160:163]
s_add_u32 s69, s73, s67
ds_read_b64_tr_b16 v[48:49], v12 offset:16384
v_accvgpr_read_b32 v26, a172
v_mfma_f32_16x16x32_bf16 v[164:167], v[88:91], v[116:119], v[164:167]
s_add_u32 s70, s73, s68
ds_read_b64_tr_b16 v[50:51], v12 offset:17408
v_accvgpr_read_b32 v30, a173
v_mfma_f32_16x16x32_bf16 v[168:171], v[88:91], v[120:123], v[168:171]
s_add_u32 m0, s64, 0
ds_read_b64_tr_b16 v[52:53], v13 offset:16384
v_accvgpr_read_b32 v27, a174
v_mfma_f32_16x16x32_bf16 v[172:175], v[88:91], v[124:127], v[172:175]
s_add_u32 s72, s71, 0
buffer_load_dwordx4 v6, s[12:15], s72 offen lds
v_mfma_f32_16x16x32_bf16 v[188:191], v[92:95], v[124:127], v[188:191]
s_add_u32 s72, s71, 31744
buffer_load_dwordx4 v6, s[12:15], s72 offen offset:1024 lds
v_mfma_f32_16x16x32_bf16 v[184:187], v[92:95], v[120:123], v[184:187]
s_add_u32 s72, s71, 63488
buffer_load_dwordx4 v7, s[12:15], s72 offen offset:2048 lds
v_mfma_f32_16x16x32_bf16 v[180:183], v[92:95], v[116:119], v[180:183]
s_add_u32 s72, s71, 95232
buffer_load_dwordx4 v7, s[12:15], s72 offen offset:3072 lds
v_mfma_f32_16x16x32_bf16 v[176:179], v[92:95], v[112:115], v[176:179]
ds_read_b64_tr_b16 v[54:55], v13 offset:17408
v_accvgpr_read_b32 v31, a175
v_mfma_f32_16x16x32_bf16 v[192:195], v[96:99], v[112:115], v[192:195]
ds_read_b64_tr_b16 v[56:57], v14 offset:16384
v_cvt_pk_bf16_f32 v24, v24, v28
v_mfma_f32_16x16x32_bf16 v[196:199], v[96:99], v[116:119], v[196:199]
ds_read_b64_tr_b16 v[58:59], v14 offset:17408
v_cvt_pk_bf16_f32 v25, v25, v29
v_mfma_f32_16x16x32_bf16 v[200:203], v[96:99], v[120:123], v[200:203]
ds_read_b64_tr_b16 v[60:61], v15 offset:16384
v_cvt_pk_bf16_f32 v26, v26, v30
v_mfma_f32_16x16x32_bf16 v[204:207], v[96:99], v[124:127], v[204:207]
s_add_u32 m0, s63, 131072
ds_read_b64_tr_b16 v[62:63], v15 offset:17408
v_cvt_pk_bf16_f32 v27, v27, v31
v_mfma_f32_16x16x32_bf16 v[220:223], v[100:103], v[124:127], v[220:223]
s_add_u32 s72, s69, 0
buffer_load_dwordx4 v4, s[4:7], s72 offen lds
v_mfma_f32_16x16x32_bf16 v[216:219], v[100:103], v[120:123], v[216:219]
s_add_u32 s80, s78, 9216
buffer_store_dwordx4 v[24:27], v1, s[44:47], s80 offen sc1
v_mfma_f32_16x16x32_bf16 v[212:215], v[100:103], v[116:119], v[212:215]
v_accvgpr_read_b32 v20, a64
v_accvgpr_read_b32 v28, a65
v_mfma_f32_16x16x32_bf16 v[208:211], v[100:103], v[112:115], v[208:211]
v_accvgpr_read_b32 v21, a66
v_accvgpr_read_b32 v29, a67
v_mfma_f32_16x16x32_bf16 v[224:227], v[104:107], v[112:115], v[224:227]
s_add_u32 s72, s69, 15360
buffer_load_dwordx4 v5, s[4:7], s72 offen offset:1024 lds
v_mfma_f32_16x16x32_bf16 v[228:231], v[104:107], v[116:119], v[228:231]
v_accvgpr_read_b32 v22, a96
v_accvgpr_read_b32 v30, a97
v_mfma_f32_16x16x32_bf16 v[232:235], v[104:107], v[120:123], v[232:235]
v_accvgpr_read_b32 v23, a98
v_accvgpr_read_b32 v31, a99
v_mfma_f32_16x16x32_bf16 v[236:239], v[104:107], v[124:127], v[236:239]
v_mul_f32 v20, s79, v20
v_mul_f32 v28, s79, v28
v_mfma_f32_16x16x32_bf16 v[252:255], v[108:111], v[124:127], v[252:255]
v_mul_f32 v21, s79, v21
v_mul_f32 v29, s79, v29
v_mfma_f32_16x16x32_bf16 v[248:251], v[108:111], v[120:123], v[248:251]
s_add_u32 s72, s69, 129024
buffer_load_dwordx4 v4, s[4:7], s72 offen offset:2048 lds
v_mfma_f32_16x16x32_bf16 v[244:247], v[108:111], v[116:119], v[244:247]
v_mul_f32 v22, s79, v22
v_mul_f32 v30, s79, v30
v_mfma_f32_16x16x32_bf16 v[240:243], v[108:111], v[112:115], v[240:243]
s_waitcnt lgkmcnt(0)
v_mul_f32 v23, s79, v23
v_mul_f32 v31, s79, v31
v_mfma_f32_16x16x32_bf16 v[128:131], v[32:35], v[64:67], v[128:131]
ds_read_b64_tr_b16 v[80:81], v8 offset:24576
ds_read_b64_tr_b16 v[82:83], v8 offset:25600
v_mfma_f32_16x16x32_bf16 v[132:135], v[32:35], v[68:71], v[132:135]
ds_read_b128 v[112:115], v19 offset:0
ds_read_b128 v[116:119], v19 offset:2048
v_mfma_f32_16x16x32_bf16 v[136:139], v[32:35], v[72:75], v[136:139]
s_add_u32 s72, s69, 144384
buffer_load_dwordx4 v5, s[4:7], s72 offen offset:3072 lds
v_mfma_f32_16x16x32_bf16 v[140:143], v[32:35], v[76:79], v[140:143]
ds_read_b128 v[120:123], v19 offset:4096
ds_read_b128 v[124:127], v19 offset:6144
v_mfma_f32_16x16x32_bf16 v[156:159], v[36:39], v[76:79], v[156:159]
ds_read_b64_tr_b16 v[84:85], v9 offset:24576
ds_read_b64_tr_b16 v[86:87], v9 offset:25600
v_mfma_f32_16x16x32_bf16 v[152:155], v[36:39], v[72:75], v[152:155]
ds_read_b64_tr_b16 v[88:89], v10 offset:24576
v_cvt_pk_bf16_f32 v20, v20, v28
v_mfma_f32_16x16x32_bf16 v[148:151], v[36:39], v[68:71], v[148:151]
ds_read_b64_tr_b16 v[90:91], v10 offset:25600
v_cvt_pk_bf16_f32 v21, v21, v29
v_mfma_f32_16x16x32_bf16 v[144:147], v[36:39], v[64:67], v[144:147]
s_add_u32 m0, s63, 135168
ds_read_b64_tr_b16 v[92:93], v11 offset:24576
v_cvt_pk_bf16_f32 v22, v22, v30
v_mfma_f32_16x16x32_bf16 v[160:163], v[40:43], v[64:67], v[160:163]
s_add_u32 s72, s70, 0
buffer_load_dwordx4 v4, s[4:7], s72 offen lds
v_mfma_f32_16x16x32_bf16 v[164:167], v[40:43], v[68:71], v[164:167]
ds_read_b64_tr_b16 v[94:95], v11 offset:25600
v_cvt_pk_bf16_f32 v23, v23, v31
v_mfma_f32_16x16x32_bf16 v[168:171], v[40:43], v[72:75], v[168:171]
s_add_u32 s80, s77, 1024
ds_read_b64_tr_b16 v[96:97], v12 offset:24576
v_accvgpr_read_b32 v24, a176
v_mfma_f32_16x16x32_bf16 v[172:175], v[40:43], v[76:79], v[172:175]
ds_read_b64_tr_b16 v[98:99], v12 offset:25600
v_accvgpr_read_b32 v28, a177
v_mfma_f32_16x16x32_bf16 v[188:191], v[44:47], v[76:79], v[188:191]
s_add_u32 s72, s70, 15360
buffer_load_dwordx4 v5, s[4:7], s72 offen offset:1024 lds
v_mfma_f32_16x16x32_bf16 v[184:187], v[44:47], v[72:75], v[184:187]
ds_read_b64_tr_b16 v[100:101], v13 offset:24576
v_accvgpr_read_b32 v25, a178
v_mfma_f32_16x16x32_bf16 v[180:183], v[44:47], v[68:71], v[180:183]
ds_read_b64_tr_b16 v[102:103], v13 offset:25600
v_accvgpr_read_b32 v29, a179
v_mfma_f32_16x16x32_bf16 v[176:179], v[44:47], v[64:67], v[176:179]
ds_read_b64_tr_b16 v[104:105], v14 offset:24576
v_accvgpr_read_b32 v26, a180
v_mfma_f32_16x16x32_bf16 v[192:195], v[48:51], v[64:67], v[192:195]
ds_read_b64_tr_b16 v[106:107], v14 offset:25600
v_accvgpr_read_b32 v30, a181
v_mfma_f32_16x16x32_bf16 v[196:199], v[48:51], v[68:71], v[196:199]
s_add_u32 s72, s70, 129024
buffer_load_dwordx4 v4, s[4:7], s72 offen offset:2048 lds
v_mfma_f32_16x16x32_bf16 v[200:203], v[48:51], v[72:75], v[200:203]
ds_read_b64_tr_b16 v[108:109], v15 offset:24576
v_accvgpr_read_b32 v27, a182
v_mfma_f32_16x16x32_bf16 v[204:207], v[48:51], v[76:79], v[204:207]
ds_read_b64_tr_b16 v[110:111], v15 offset:25600
v_accvgpr_read_b32 v31, a183
v_mfma_f32_16x16x32_bf16 v[220:223], v[52:55], v[76:79], v[220:223]
buffer_store_dwordx4 v[20:23], v1, s[44:47], s80 offen sc1
v_mfma_f32_16x16x32_bf16 v[216:219], v[52:55], v[72:75], v[216:219]
v_cvt_pk_bf16_f32 v24, v24, v28
v_cvt_pk_bf16_f32 v25, v25, v29
v_mfma_f32_16x16x32_bf16 v[212:215], v[52:55], v[68:71], v[212:215]
s_add_u32 s72, s70, 144384
buffer_load_dwordx4 v5, s[4:7], s72 offen offset:3072 lds
v_mfma_f32_16x16x32_bf16 v[208:211], v[52:55], v[64:67], v[208:211]
v_cvt_pk_bf16_f32 v26, v26, v30
v_cvt_pk_bf16_f32 v27, v27, v31
v_mfma_f32_16x16x32_bf16 v[224:227], v[56:59], v[64:67], v[224:227]
s_add_u32 s80, s78, 33792
buffer_store_dwordx4 v[24:27], v1, s[44:47], s80 offen sc1
v_mfma_f32_16x16x32_bf16 v[228:231], v[56:59], v[68:71], v[228:231]
v_mfma_f32_16x16x32_bf16 v[232:235], v[56:59], v[72:75], v[232:235]
v_mfma_f32_16x16x32_bf16 v[236:239], v[56:59], v[76:79], v[236:239]
v_mfma_f32_16x16x32_bf16 v[252:255], v[60:63], v[76:79], v[252:255]
v_mfma_f32_16x16x32_bf16 v[248:251], v[60:63], v[72:75], v[248:251]
v_mfma_f32_16x16x32_bf16 v[244:247], v[60:63], v[68:71], v[244:247]
s_waitcnt vmcnt(16) lgkmcnt(0)
v_accvgpr_read_b32 v20, a68
v_accvgpr_read_b32 v28, a69
v_mfma_f32_16x16x32_bf16 v[240:243], v[60:63], v[64:67], v[240:243]
s_barrier
v_accvgpr_read_b32 v21, a70
v_accvgpr_read_b32 v29, a71
v_mfma_f32_16x16x32_bf16 v[128:131], v[80:83], v[112:115], v[128:131]
s_add_u32 s73, s62, 7
ds_read_b64_tr_b16 v[32:33], v8 offset:32768
ds_read_b64_tr_b16 v[34:35], v8 offset:33792
v_mfma_f32_16x16x32_bf16 v[132:135], v[80:83], v[116:119], v[132:135]
s_add_u32 s70, s73, s65
ds_read_b128 v[64:67], v18 offset:32768
ds_read_b128 v[68:71], v18 offset:34816
v_mfma_f32_16x16x32_bf16 v[136:139], v[80:83], v[120:123], v[136:139]
s_and_b32 s70, s70, 3
ds_read_b128 v[72:75], v18 offset:36864
ds_read_b128 v[76:79], v18 offset:38912
v_mfma_f32_16x16x32_bf16 v[140:143], v[80:83], v[124:127], v[140:143]
s_and_b32 s73, s73, 12
ds_read_b64_tr_b16 v[36:37], v9 offset:32768
ds_read_b64_tr_b16 v[38:39], v9 offset:33792
v_mfma_f32_16x16x32_bf16 v[156:159], v[84:87], v[124:127], v[156:159]
s_or_b32 s73, s73, s70
ds_read_b64_tr_b16 v[40:41], v10 offset:32768
v_accvgpr_read_b32 v22, a100
v_mfma_f32_16x16x32_bf16 v[152:155], v[84:87], v[120:123], v[152:155]
s_lshl_b32 s71, s73, 19
ds_read_b64_tr_b16 v[42:43], v10 offset:33792
v_accvgpr_read_b32 v30, a101
v_mfma_f32_16x16x32_bf16 v[148:151], v[84:87], v[116:119], v[148:151]
s_add_u32 s71, s71, s66
ds_read_b64_tr_b16 v[44:45], v11 offset:32768
v_accvgpr_read_b32 v23, a102
v_mfma_f32_16x16x32_bf16 v[144:147], v[84:87], v[112:115], v[144:147]
s_lshl_b32 s73, s73, 7
ds_read_b64_tr_b16 v[46:47], v11 offset:33792
v_accvgpr_read_b32 v31, a103
v_mfma_f32_16x16x32_bf16 v[160:163], v[88:91], v[112:115], v[160:163]
s_add_u32 s69, s73, s67
ds_read_b64_tr_b16 v[48:49], v12 offset:32768
v_mul_f32 v20, s79, v20
v_mfma_f32_16x16x32_bf16 v[164:167], v[88:91], v[116:119], v[164:167]
s_add_u32 s70, s73, s68
ds_read_b64_tr_b16 v[50:51], v12 offset:33792
v_mul_f32 v28, s79, v28
v_mfma_f32_16x16x32_bf16 v[168:171], v[88:91], v[120:123], v[168:171]
s_add_u32 m0, s64, 16384
ds_read_b64_tr_b16 v[52:53], v13 offset:32768
v_mul_f32 v21, s79, v21
v_mfma_f32_16x16x32_bf16 v[172:175], v[88:91], v[124:127], v[172:175]
s_add_u32 s72, s71, 0
buffer_load_dwordx4 v6, s[12:15], s72 offen lds
v_mfma_f32_16x16x32_bf16 v[188:191], v[92:95], v[124:127], v[188:191]
s_add_u32 s72, s71, 31744
buffer_load_dwordx4 v6, s[12:15], s72 offen offset:1024 lds
v_mfma_f32_16x16x32_bf16 v[184:187], v[92:95], v[120:123], v[184:187]
s_add_u32 s72, s71, 63488
buffer_load_dwordx4 v7, s[12:15], s72 offen offset:2048 lds
v_mfma_f32_16x16x32_bf16 v[180:183], v[92:95], v[116:119], v[180:183]
s_add_u32 s72, s71, 95232
buffer_load_dwordx4 v7, s[12:15], s72 offen offset:3072 lds
v_mfma_f32_16x16x32_bf16 v[176:179], v[92:95], v[112:115], v[176:179]
ds_read_b64_tr_b16 v[54:55], v13 offset:33792
v_mul_f32 v29, s79, v29
v_mfma_f32_16x16x32_bf16 v[192:195], v[96:99], v[112:115], v[192:195]
ds_read_b64_tr_b16 v[56:57], v14 offset:32768
v_mul_f32 v22, s79, v22
v_mfma_f32_16x16x32_bf16 v[196:199], v[96:99], v[116:119], v[196:199]
ds_read_b64_tr_b16 v[58:59], v14 offset:33792
v_mul_f32 v30, s79, v30
v_mfma_f32_16x16x32_bf16 v[200:203], v[96:99], v[120:123], v[200:203]
ds_read_b64_tr_b16 v[60:61], v15 offset:32768
v_mul_f32 v23, s79, v23
v_mfma_f32_16x16x32_bf16 v[204:207], v[96:99], v[124:127], v[204:207]
s_add_u32 m0, s63, 65536
ds_read_b64_tr_b16 v[62:63], v15 offset:33792
v_mul_f32 v31, s79, v31
v_mfma_f32_16x16x32_bf16 v[220:223], v[100:103], v[124:127], v[220:223]
s_add_u32 s72, s69, 0
buffer_load_dwordx4 v4, s[4:7], s72 offen lds
v_mfma_f32_16x16x32_bf16 v[216:219], v[100:103], v[120:123], v[216:219]
v_cvt_pk_bf16_f32 v20, v20, v28
v_cvt_pk_bf16_f32 v21, v21, v29
v_mfma_f32_16x16x32_bf16 v[212:215], v[100:103], v[116:119], v[212:215]
v_cvt_pk_bf16_f32 v22, v22, v30
v_cvt_pk_bf16_f32 v23, v23, v31
v_mfma_f32_16x16x32_bf16 v[208:211], v[100:103], v[112:115], v[208:211]
s_add_u32 s80, s77, 5120
buffer_store_dwordx4 v[20:23], v1, s[44:47], s80 offen sc1
v_mfma_f32_16x16x32_bf16 v[224:227], v[104:107], v[112:115], v[224:227]
s_add_u32 s72, s69, 15360
buffer_load_dwordx4 v5, s[4:7], s72 offen offset:1024 lds
v_mfma_f32_16x16x32_bf16 v[228:231], v[104:107], v[116:119], v[228:231]
v_accvgpr_read_b32 v24, a184
v_accvgpr_read_b32 v28, a185
v_mfma_f32_16x16x32_bf16 v[232:235], v[104:107], v[120:123], v[232:235]
v_accvgpr_read_b32 v25, a186
v_accvgpr_read_b32 v29, a187
v_mfma_f32_16x16x32_bf16 v[236:239], v[104:107], v[124:127], v[236:239]
v_accvgpr_read_b32 v26, a188
v_accvgpr_read_b32 v30, a189
v_mfma_f32_16x16x32_bf16 v[252:255], v[108:111], v[124:127], v[252:255]
v_accvgpr_read_b32 v27, a190
v_accvgpr_read_b32 v31, a191
v_mfma_f32_16x16x32_bf16 v[248:251], v[108:111], v[120:123], v[248:251]
s_add_u32 s72, s69, 129024
buffer_load_dwordx4 v4, s[4:7], s72 offen offset:2048 lds
v_mfma_f32_16x16x32_bf16 v[244:247], v[108:111], v[116:119], v[244:247]
v_cvt_pk_bf16_f32 v24, v24, v28
v_cvt_pk_bf16_f32 v25, v25, v29
v_mfma_f32_16x16x32_bf16 v[240:243], v[108:111], v[112:115], v[240:243]
s_waitcnt lgkmcnt(0)
v_cvt_pk_bf16_f32 v26, v26, v30
v_cvt_pk_bf16_f32 v27, v27, v31
v_mfma_f32_16x16x32_bf16 v[128:131], v[32:35], v[64:67], v[128:131]
s_lshr_b32 s75, s93, 4
ds_read_b64_tr_b16 v[80:81], v8 offset:40960
ds_read_b64_tr_b16 v[82:83], v8 offset:41984
v_mfma_f32_16x16x32_bf16 v[132:135], v[32:35], v[68:71], v[132:135]
s_and_b32 s75, s75, 0x7f00
ds_read_b128 v[112:115], v19 offset:32768
ds_read_b128 v[116:119], v19 offset:34816
v_mfma_f32_16x16x32_bf16 v[136:139], v[32:35], v[72:75], v[136:139]
s_add_u32 s72, s69, 144384
buffer_load_dwordx4 v5, s[4:7], s72 offen offset:3072 lds
v_mfma_f32_16x16x32_bf16 v[140:143], v[32:35], v[76:79], v[140:143]
s_add_u32 s75, s75, LcB1-Lpc0
v_lshrrev_b32 v2, 5, v0
v_lshlrev_b32 v2, 7, v2
v_mfma_f32_16x16x32_bf16 v[156:159], v[36:39], v[76:79], v[156:159]
s_add_u32 s80, s78, 41984
v_add_u32 v2, s75, v2
v_min_u32 v2, Lcode_end-Lpc0, v2
v_mfma_f32_16x16x32_bf16 v[152:155], v[36:39], v[72:75], v[152:155]
global_load_dword v3, v2, s[98:99]
v_mfma_f32_16x16x32_bf16 v[148:151], v[36:39], v[68:71], v[148:151]
ds_read_b128 v[120:123], v19 offset:36864
ds_read_b128 v[124:127], v19 offset:38912
v_mfma_f32_16x16x32_bf16 v[144:147], v[36:39], v[64:67], v[144:147]
s_add_u32 m0, s63, 69632
ds_read_b64_tr_b16 v[84:85], v9 offset:40960
ds_read_b64_tr_b16 v[86:87], v9 offset:41984
v_mfma_f32_16x16x32_bf16 v[160:163], v[40:43], v[64:67], v[160:163]
s_add_u32 s72, s70, 0
buffer_load_dwordx4 v4, s[4:7], s72 offen lds
v_mfma_f32_16x16x32_bf16 v[164:167], v[40:43], v[68:71], v[164:167]
ds_read_b64_tr_b16 v[88:89], v10 offset:40960
v_accvgpr_read_b32 v20, a72
v_mfma_f32_16x16x32_bf16 v[168:171], v[40:43], v[72:75], v[168:171]
ds_read_b64_tr_b16 v[90:91], v10 offset:41984
v_accvgpr_read_b32 v28, a73
v_mfma_f32_16x16x32_bf16 v[172:175], v[40:43], v[76:79], v[172:175]
ds_read_b64_tr_b16 v[92:93], v11 offset:40960
v_accvgpr_read_b32 v21, a74
v_mfma_f32_16x16x32_bf16 v[188:191], v[44:47], v[76:79], v[188:191]
s_add_u32 s72, s70, 15360
buffer_load_dwordx4 v5, s[4:7], s72 offen offset:1024 lds
v_mfma_f32_16x16x32_bf16 v[184:187], v[44:47], v[72:75], v[184:187]
ds_read_b64_tr_b16 v[94:95], v11 offset:41984
v_accvgpr_read_b32 v29, a75
v_mfma_f32_16x16x32_bf16 v[180:183], v[44:47], v[68:71], v[180:183]
ds_read_b64_tr_b16 v[96:97], v12 offset:40960
v_accvgpr_read_b32 v22, a104
v_mfma_f32_16x16x32_bf16 v[176:179], v[44:47], v[64:67], v[176:179]
ds_read_b64_tr_b16 v[98:99], v12 offset:41984
v_accvgpr_read_b32 v30, a105
v_mfma_f32_16x16x32_bf16 v[192:195], v[48:51], v[64:67], v[192:195]
ds_read_b64_tr_b16 v[100:101], v13 offset:40960
v_accvgpr_read_b32 v23, a106
v_mfma_f32_16x16x32_bf16 v[196:199], v[48:51], v[68:71], v[196:199]
s_add_u32 s72, s70, 129024
buffer_load_dwordx4 v4, s[4:7], s72 offen offset:2048 lds
v_mfma_f32_16x16x32_bf16 v[200:203], v[48:51], v[72:75], v[200:203]
ds_read_b64_tr_b16 v[102:103], v13 offset:41984
v_accvgpr_read_b32 v31, a107
v_mfma_f32_16x16x32_bf16 v[204:207], v[48:51], v[76:79], v[204:207]
ds_read_b64_tr_b16 v[104:105], v14 offset:40960
v_mul_f32 v20, s79, v20
v_mfma_f32_16x16x32_bf16 v[220:223], v[52:55], v[76:79], v[220:223]
ds_read_b64_tr_b16 v[106:107], v14 offset:41984
v_mul_f32 v28, s79, v28
v_mfma_f32_16x16x32_bf16 v[216:219], v[52:55], v[72:75], v[216:219]
ds_read_b64_tr_b16 v[108:109], v15 offset:40960
v_mul_f32 v21, s79, v21
v_mfma_f32_16x16x32_bf16 v[212:215], v[52:55], v[68:71], v[212:215]
s_add_u32 s72, s70, 144384
buffer_load_dwordx4 v5, s[4:7], s72 offen offset:3072 lds
v_mfma_f32_16x16x32_bf16 v[208:211], v[52:55], v[64:67], v[208:211]
ds_read_b64_tr_b16 v[110:111], v15 offset:41984
v_mul_f32 v29, s79, v29
v_mfma_f32_16x16x32_bf16 v[224:227], v[56:59], v[64:67], v[224:227]
buffer_store_dwordx4 v[24:27], v1, s[44:47], s80 offen sc1
v_mfma_f32_16x16x32_bf16 v[228:231], v[56:59], v[68:71], v[228:231]
v_mul_f32 v22, s79, v22
v_mul_f32 v30, s79, v30
v_mfma_f32_16x16x32_bf16 v[232:235], v[56:59], v[72:75], v[232:235]
v_mul_f32 v23, s79, v23
v_mul_f32 v31, s79, v31
v_mfma_f32_16x16x32_bf16 v[236:239], v[56:59], v[76:79], v[236:239]
v_cvt_pk_bf16_f32 v20, v20, v28
v_cvt_pk_bf16_f32 v21, v21, v29
v_mfma_f32_16x16x32_bf16 v[252:255], v[60:63], v[76:79], v[252:255]
v_cvt_pk_bf16_f32 v22, v22, v30
v_cvt_pk_bf16_f32 v23, v23, v31
v_mfma_f32_16x16x32_bf16 v[248:251], v[60:63], v[72:75], v[248:251]
s_add_u32 s80, s77, 9216
buffer_store_dwordx4 v[20:23], v1, s[44:47], s80 offen sc1
v_mfma_f32_16x16x32_bf16 v[244:247], v[60:63], v[68:71], v[244:247]
s_waitcnt vmcnt(17) lgkmcnt(0)
v_accvgpr_read_b32 v24, a192
v_accvgpr_read_b32 v28, a193
v_mfma_f32_16x16x32_bf16 v[240:243], v[60:63], v[64:67], v[240:243]
s_barrier
v_accvgpr_read_b32 v25, a194
v_accvgpr_read_b32 v29, a195
v_mfma_f32_16x16x32_bf16 v[128:131], v[80:83], v[112:115], v[128:131]
s_add_u32 s73, s62, 8
ds_read_b64_tr_b16 v[32:33], v8 offset:0
ds_read_b64_tr_b16 v[34:35], v8 offset:1024
v_mfma_f32_16x16x32_bf16 v[132:135], v[80:83], v[116:119], v[132:135]
s_add_u32 s70, s73, s65
ds_read_b128 v[64:67], v16 offset:0
ds_read_b128 v[68:71], v16 offset:2048
v_mfma_f32_16x16x32_bf16 v[136:139], v[80:83], v[120:123], v[136:139]
s_and_b32 s70, s70, 3
ds_read_b128 v[72:75], v16 offset:4096
ds_read_b128 v[76:79], v16 offset:6144
v_mfma_f32_16x16x32_bf16 v[140:143], v[80:83], v[124:127], v[140:143]
s_and_b32 s73, s73, 12
ds_read_b64_tr_b16 v[36:37], v9 offset:0
ds_read_b64_tr_b16 v[38:39], v9 offset:1024
v_mfma_f32_16x16x32_bf16 v[156:159], v[84:87], v[124:127], v[156:159]
s_or_b32 s73, s73, s70
ds_read_b64_tr_b16 v[40:41], v10 offset:0
v_accvgpr_read_b32 v26, a196
v_mfma_f32_16x16x32_bf16 v[152:155], v[84:87], v[120:123], v[152:155]
s_lshl_b32 s71, s73, 19
ds_read_b64_tr_b16 v[42:43], v10 offset:1024
v_accvgpr_read_b32 v30, a197
v_mfma_f32_16x16x32_bf16 v[148:151], v[84:87], v[116:119], v[148:151]
s_add_u32 s71, s71, s66
ds_read_b64_tr_b16 v[44:45], v11 offset:0
v_accvgpr_read_b32 v27, a198
v_mfma_f32_16x16x32_bf16 v[144:147], v[84:87], v[112:115], v[144:147]
s_lshl_b32 s73, s73, 7
ds_read_b64_tr_b16 v[46:47], v11 offset:1024
v_accvgpr_read_b32 v31, a199
v_mfma_f32_16x16x32_bf16 v[160:163], v[88:91], v[112:115], v[160:163]
s_add_u32 s69, s73, s67
ds_read_b64_tr_b16 v[48:49], v12 offset:0
v_cvt_pk_bf16_f32 v24, v24, v28
v_mfma_f32_16x16x32_bf16 v[164:167], v[88:91], v[116:119], v[164:167]
s_add_u32 s70, s73, s68
ds_read_b64_tr_b16 v[50:51], v12 offset:1024
v_cvt_pk_bf16_f32 v25, v25, v29
v_mfma_f32_16x16x32_bf16 v[168:171], v[88:91], v[120:123], v[168:171]
s_add_u32 m0, s64, 32768
ds_read_b64_tr_b16 v[52:53], v13 offset:0
v_cvt_pk_bf16_f32 v26, v26, v30
v_mfma_f32_16x16x32_bf16 v[172:175], v[88:91], v[124:127], v[172:175]
s_add_u32 s72, s71, 0
buffer_load_dwordx4 v6, s[12:15], s72 offen lds
v_mfma_f32_16x16x32_bf16 v[188:191], v[92:95], v[124:127], v[188:191]
s_add_u32 s72, s71, 31744
buffer_load_dwordx4 v6, s[12:15], s72 offen offset:1024 lds
v_mfma_f32_16x16x32_bf16 v[184:187], v[92:95], v[120:123], v[184:187]
s_add_u32 s72, s71, 63488
buffer_load_dwordx4 v7, s[12:15], s72 offen offset:2048 lds
v_mfma_f32_16x16x32_bf16 v[180:183], v[92:95], v[116:119], v[180:183]
s_add_u32 s72, s71, 95232
buffer_load_dwordx4 v7, s[12:15], s72 offen offset:3072 lds
v_mfma_f32_16x16x32_bf16 v[176:179], v[92:95], v[112:115], v[176:179]
ds_read_b64_tr_b16 v[54:55], v13 offset:1024
v_cvt_pk_bf16_f32 v27, v27, v31
v_mfma_f32_16x16x32_bf16 v[192:195], v[96:99], v[112:115], v[192:195]
s_add_u32 s80, s78, 2048
ds_read_b64_tr_b16 v[56:57], v14 offset:0
v_accvgpr_read_b32 v20, a76
v_mfma_f32_16x16x32_bf16 v[196:199], v[96:99], v[116:119], v[196:199]
ds_read_b64_tr_b16 v[58:59], v14 offset:1024
v_accvgpr_read_b32 v28, a77
v_mfma_f32_16x16x32_bf16 v[200:203], v[96:99], v[120:123], v[200:203]
ds_read_b64_tr_b16 v[60:61], v15 offset:0
v_accvgpr_read_b32 v21, a78
v_mfma_f32_16x16x32_bf16 v[204:207], v[96:99], v[124:127], v[204:207]
s_add_u32 m0, s63, 98304
ds_read_b64_tr_b16 v[62:63], v15 offset:1024
v_accvgpr_read_b32 v29, a79
v_mfma_f32_16x16x32_bf16 v[220:223], v[100:103], v[124:127], v[220:223]
s_add_u32 s72, s69, 0
buffer_load_dwordx4 v4, s[4:7], s72 offen lds
v_mfma_f32_16x16x32_bf16 v[216:219], v[100:103], v[120:123], v[216:219]
buffer_store_dwordx4 v[24:27], v1, s[44:47], s80 offen sc1
v_mfma_f32_16x16x32_bf16 v[212:215], v[100:103], v[116:119], v[212:215]
v_accvgpr_read_b32 v22, a108
v_accvgpr_read_b32 v30, a109
v_mfma_f32_16x16x32_bf16 v[208:211], v[100:103], v[112:115], v[208:211]
v_accvgpr_read_b32 v23, a110
v_accvgpr_read_b32 v31, a111
v_mfma_f32_16x16x32_bf16 v[224:227], v[104:107], v[112:115], v[224:227]
s_add_u32 s72, s69, 15360
buffer_load_dwordx4 v5, s[4:7], s72 offen offset:1024 lds
v_mfma_f32_16x16x32_bf16 v[228:231], v[104:107], v[116:119], v[228:231]
v_mul_f32 v20, s79, v20
v_mul_f32 v28, s79, v28
v_mfma_f32_16x16x32_bf16 v[232:235], v[104:107], v[120:123], v[232:235]
v_mul_f32 v21, s79, v21
v_mul_f32 v29, s79, v29
v_mfma_f32_16x16x32_bf16 v[236:239], v[104:107], v[124:127], v[236:239]
v_mul_f32 v22, s79, v22
v_mul_f32 v30, s79, v30
v_mfma_f32_16x16x32_bf16 v[252:255], v[108:111], v[124:127], v[252:255]
v_mul_f32 v23, s79, v23
v_mul_f32 v31, s79, v31
v_mfma_f32_16x16x32_bf16 v[248:251], v[108:111], v[120:123], v[248:251]
s_add_u32 s72, s69, 129024
buffer_load_dwordx4 v4, s[4:7], s72 offen offset:2048 lds
v_mfma_f32_16x16x32_bf16 v[244:247], v[108:111], v[116:119], v[244:247]
v_cvt_pk_bf16_f32 v20, v20, v28
v_cvt_pk_bf16_f32 v21, v21, v29
v_mfma_f32_16x16x32_bf16 v[240:243], v[108:111], v[112:115], v[240:243]
s_waitcnt lgkmcnt(0)
v_cvt_pk_bf16_f32 v22, v22, v30
v_cvt_pk_bf16_f32 v23, v23, v31
v_mfma_f32_16x16x32_bf16 v[128:131], v[32:35], v[64:67], v[128:131]
s_add_u32 s80, s77, 13312
ds_read_b64_tr_b16 v[80:81], v8 offset:8192
ds_read_b64_tr_b16 v[82:83], v8 offset:9216
v_mfma_f32_16x16x32_bf16 v[132:135], v[32:35], v[68:71], v[132:135]
ds_read_b128 v[112:115], v17 offset:0
ds_read_b128 v[116:119], v17 offset:2048
v_mfma_f32_16x16x32_bf16 v[136:139], v[32:35], v[72:75], v[136:139]
s_add_u32 s72, s69, 144384
buffer_load_dwordx4 v5, s[4:7], s72 offen offset:3072 lds
v_mfma_f32_16x16x32_bf16 v[140:143], v[32:35], v[76:79], v[140:143]
ds_read_b128 v[120:123], v17 offset:4096
ds_read_b128 v[124:127], v17 offset:6144
v_mfma_f32_16x16x32_bf16 v[156:159], v[36:39], v[76:79], v[156:159]
ds_read_b64_tr_b16 v[84:85], v9 offset:8192
ds_read_b64_tr_b16 v[86:87], v9 offset:9216
v_mfma_f32_16x16x32_bf16 v[152:155], v[36:39], v[72:75], v[152:155]
ds_read_b64_tr_b16 v[88:89], v10 offset:8192
v_accvgpr_read_b32 v24, a200
v_mfma_f32_16x16x32_bf16 v[148:151], v[36:39], v[68:71], v[148:151]
ds_read_b64_tr_b16 v[90:91], v10 offset:9216
v_accvgpr_read_b32 v28, a201
v_mfma_f32_16x16x32_bf16 v[144:147], v[36:39], v[64:67], v[144:147]
s_add_u32 m0, s63, 102400
ds_read_b64_tr_b16 v[92:93], v11 offset:8192
v_accvgpr_read_b32 v25, a202
v_mfma_f32_16x16x32_bf16 v[160:163], v[40:43], v[64:67], v[160:163]
s_add_u32 s72, s70, 0
buffer_load_dwordx4 v4, s[4:7], s72 offen lds
v_mfma_f32_16x16x32_bf16 v[164:167], v[40:43], v[68:71], v[164:167]
ds_read_b64_tr_b16 v[94:95], v11 offset:9216
v_accvgpr_read_b32 v29, a203
v_mfma_f32_16x16x32_bf16 v[168:171], v[40:43], v[72:75], v[168:171]
ds_read_b64_tr_b16 v[96:97], v12 offset:8192
v_accvgpr_read_b32 v26, a204
v_mfma_f32_16x16x32_bf16 v[172:175], v[40:43], v[76:79], v[172:175]
ds_read_b64_tr_b16 v[98:99], v12 offset:9216
v_accvgpr_read_b32 v30, a205
v_mfma_f32_16x16x32_bf16 v[188:191], v[44:47], v[76:79], v[188:191]
s_add_u32 s72, s70, 15360
buffer_load_dwordx4 v5, s[4:7], s72 offen offset:1024 lds
v_mfma_f32_16x16x32_bf16 v[184:187], v[44:47], v[72:75], v[184:187]
ds_read_b64_tr_b16 v[100:101], v13 offset:8192
v_accvgpr_read_b32 v27, a206
v_mfma_f32_16x16x32_bf16 v[180:183], v[44:47], v[68:71], v[180:183]
ds_read_b64_tr_b16 v[102:103], v13 offset:9216
v_accvgpr_read_b32 v31, a207
v_mfma_f32_16x16x32_bf16 v[176:179], v[44:47], v[64:67], v[176:179]
ds_read_b64_tr_b16 v[104:105], v14 offset:8192
v_cvt_pk_bf16_f32 v24, v24, v28
v_mfma_f32_16x16x32_bf16 v[192:195], v[48:51], v[64:67], v[192:195]
ds_read_b64_tr_b16 v[106:107], v14 offset:9216
v_cvt_pk_bf16_f32 v25, v25, v29
v_mfma_f32_16x16x32_bf16 v[196:199], v[48:51], v[68:71], v[196:199]
s_add_u32 s72, s70, 129024
buffer_load_dwordx4 v4, s[4:7], s72 offen offset:2048 lds
v_mfma_f32_16x16x32_bf16 v[200:203], v[48:51], v[72:75], v[200:203]
ds_read_b64_tr_b16 v[108:109], v15 offset:8192
v_cvt_pk_bf16_f32 v26, v26, v30
v_mfma_f32_16x16x32_bf16 v[204:207], v[48:51], v[76:79], v[204:207]
ds_read_b64_tr_b16 v[110:111], v15 offset:9216
v_cvt_pk_bf16_f32 v27, v27, v31
v_mfma_f32_16x16x32_bf16 v[220:223], v[52:55], v[76:79], v[220:223]
buffer_store_dwordx4 v[20:23], v1, s[44:47], s80 offen sc1
v_mfma_f32_16x16x32_bf16 v[216:219], v[52:55], v[72:75], v[216:219]
s_add_u32 s80, s78, 10240
buffer_store_dwordx4 v[24:27], v1, s[44:47], s80 offen sc1
v_mfma_f32_16x16x32_bf16 v[212:215], v[52:55], v[68:71], v[212:215]
s_add_u32 s72, s70, 144384
buffer_load_dwordx4 v5, s[4:7], s72 offen offset:3072 lds
v_mfma_f32_16x16x32_bf16 v[208:211], v[52:55], v[64:67], v[208:211]
v_accvgpr_read_b32 v20, a80
v_accvgpr_read_b32 v28, a81
v_mfma_f32_16x16x32_bf16 v[224:227], v[56:59], v[64:67], v[224:227]
v_accvgpr_read_b32 v21, a82
v_accvgpr_read_b32 v29, a83
v_mfma_f32_16x16x32_bf16 v[228:231], v[56:59], v[68:71], v[228:231]
v_accvgpr_read_b32 v22, a112
v_accvgpr_read_b32 v30, a113
v_mfma_f32_16x16x32_bf16 v[232:235], v[56:59], v[72:75], v[232:235]
v_accvgpr_read_b32 v23, a114
v_accvgpr_read_b32 v31, a115
v_mfma_f32_16x16x32_bf16 v[236:239], v[56:59], v[76:79], v[236:239]
v_mul_f32 v20, s79, v20
v_mul_f32 v28, s79, v28
v_mfma_f32_16x16x32_bf16 v[252:255], v[60:63], v[76:79], v[252:255]
v_mul_f32 v21, s79, v21
v_mul_f32 v29, s79, v29
v_mfma_f32_16x16x32_bf16 v[248:251], v[60:63], v[72:75], v[248:251]
v_mul_f32 v22, s79, v22
v_mul_f32 v30, s79, v30
v_mfma_f32_16x16x32_bf16 v[244:247], v[60:63], v[68:71], v[244:247]
s_waitcnt vmcnt(17) lgkmcnt(0)
v_mul_f32 v23, s79, v23
v_mul_f32 v31, s79, v31
v_mfma_f32_16x16x32_bf16 v[240:243], v[60:63], v[64:67], v[240:243]
s_barrier
v_cvt_pk_bf16_f32 v20, v20, v28
v_cvt_pk_bf16_f32 v21, v21, v29
v_mfma_f32_16x16x32_bf16 v[128:131], v[80:83], v[112:115], v[128:131]
s_add_u32 s73, s62, 9
ds_read_b64_tr_b16 v[32:33], v8 offset:16384
ds_read_b64_tr_b16 v[34:35], v8 offset:17408
v_mfma_f32_16x16x32_bf16 v[132:135], v[80:83], v[116:119], v[132:135]
s_add_u32 s70, s73, s65
ds_read_b128 v[64:67], v18 offset:0
ds_read_b128 v[68:71], v18 offset:2048
v_mfma_f32_16x16x32_bf16 v[136:139], v[80:83], v[120:123], v[136:139]
s_and_b32 s70, s70, 3
ds_read_b128 v[72:75], v18 offset:4096
ds_read_b128 v[76:79], v18 offset:6144
v_mfma_f32_16x16x32_bf16 v[140:143], v[80:83], v[124:127], v[140:143]
s_and_b32 s73, s73, 12
ds_read_b64_tr_b16 v[36:37], v9 offset:16384
ds_read_b64_tr_b16 v[38:39], v9 offset:17408
v_mfma_f32_16x16x32_bf16 v[156:159], v[84:87], v[124:127], v[156:159]
s_or_b32 s73, s73, s70
ds_read_b64_tr_b16 v[40:41], v10 offset:16384
v_cvt_pk_bf16_f32 v22, v22, v30
v_mfma_f32_16x16x32_bf16 v[152:155], v[84:87], v[120:123], v[152:155]
s_lshl_b32 s71, s73, 19
ds_read_b64_tr_b16 v[42:43], v10 offset:17408
v_cvt_pk_bf16_f32 v23, v23, v31
v_mfma_f32_16x16x32_bf16 v[148:151], v[84:87], v[116:119], v[148:151]
s_add_u32 s71, s71, s66
ds_read_b64_tr_b16 v[44:45], v11 offset:16384
v_mfma_f32_16x16x32_bf16 v[144:147], v[84:87], v[112:115], v[144:147]
s_lshl_b32 s73, s73, 7
ds_read_b64_tr_b16 v[46:47], v11 offset:17408
v_mfma_f32_16x16x32_bf16 v[160:163], v[88:91], v[112:115], v[160:163]
s_add_u32 s69, s73, s67
ds_read_b64_tr_b16 v[48:49], v12 offset:16384
v_mfma_f32_16x16x32_bf16 v[164:167], v[88:91], v[116:119], v[164:167]
s_add_u32 s70, s73, s68
ds_read_b64_tr_b16 v[50:51], v12 offset:17408
v_mfma_f32_16x16x32_bf16 v[168:171], v[88:91], v[120:123], v[168:171]
s_add_u32 m0, s64, 0
ds_read_b64_tr_b16 v[52:53], v13 offset:16384
v_mfma_f32_16x16x32_bf16 v[172:175], v[88:91], v[124:127], v[172:175]
s_add_u32 s72, s71, 0
buffer_load_dwordx4 v6, s[12:15], s72 offen lds
v_mfma_f32_16x16x32_bf16 v[188:191], v[92:95], v[124:127], v[188:191]
s_add_u32 s72, s71, 31744
buffer_load_dwordx4 v6, s[12:15], s72 offen offset:1024 lds
v_mfma_f32_16x16x32_bf16 v[184:187], v[92:95], v[120:123], v[184:187]
s_add_u32 s72, s71, 63488
buffer_load_dwordx4 v7, s[12:15], s72 offen offset:2048 lds
v_mfma_f32_16x16x32_bf16 v[180:183], v[92:95], v[116:119], v[180:183]
s_add_u32 s72, s71, 95232
buffer_load_dwordx4 v7, s[12:15], s72 offen offset:3072 lds
v_mfma_f32_16x16x32_bf16 v[176:179], v[92:95], v[112:115], v[176:179]
s_add_u32 s80, s77, 33792
ds_read_b64_tr_b16 v[54:55], v13 offset:17408
v_accvgpr_read_b32 v24, a208
v_mfma_f32_16x16x32_bf16 v[192:195], v[96:99], v[112:115], v[192:195]
ds_read_b64_tr_b16 v[56:57], v14 offset:16384
v_accvgpr_read_b32 v28, a209
v_mfma_f32_16x16x32_bf16 v[196:199], v[96:99], v[116:119], v[196:199]
ds_read_b64_tr_b16 v[58:59], v14 offset:17408
v_accvgpr_read_b32 v25, a210
v_mfma_f32_16x16x32_bf16 v[200:203], v[96:99], v[120:123], v[200:203]
ds_read_b64_tr_b16 v[60:61], v15 offset:16384
v_accvgpr_read_b32 v29, a211
v_mfma_f32_16x16x32_bf16 v[204:207], v[96:99], v[124:127], v[204:207]
s_add_u32 m0, s63, 131072
ds_read_b64_tr_b16 v[62:63], v15 offset:17408
v_accvgpr_read_b32 v26, a212
v_mfma_f32_16x16x32_bf16 v[220:223], v[100:103], v[124:127], v[220:223]
s_add_u32 s72, s69, 0
buffer_load_dwordx4 v4, s[4:7], s72 offen lds
v_mfma_f32_16x16x32_bf16 v[216:219], v[100:103], v[120:123], v[216:219]
buffer_store_dwordx4 v[20:23], v1, s[44:47], s80 offen sc1
v_mfma_f32_16x16x32_bf16 v[212:215], v[100:103], v[116:119], v[212:215]
v_accvgpr_read_b32 v30, a213
v_accvgpr_read_b32 v27, a214
v_mfma_f32_16x16x32_bf16 v[208:211], v[100:103], v[112:115], v[208:211]
v_accvgpr_read_b32 v31, a215
v_cvt_pk_bf16_f32 v24, v24, v28
v_mfma_f32_16x16x32_bf16 v[224:227], v[104:107], v[112:115], v[224:227]
s_add_u32 s72, s69, 15360
buffer_load_dwordx4 v5, s[4:7], s72 offen offset:1024 lds
v_mfma_f32_16x16x32_bf16 v[228:231], v[104:107], v[116:119], v[228:231]
v_cvt_pk_bf16_f32 v25, v25, v29
v_cvt_pk_bf16_f32 v26, v26, v30
v_mfma_f32_16x16x32_bf16 v[232:235], v[104:107], v[120:123], v[232:235]
v_cvt_pk_bf16_f32 v27, v27, v31
v_mfma_f32_16x16x32_bf16 v[236:239], v[104:107], v[124:127], v[236:239]
s_add_u32 s80, s78, 34816
buffer_store_dwordx4 v[24:27], v1, s[44:47], s80 offen sc1
v_mfma_f32_16x16x32_bf16 v[252:255], v[108:111], v[124:127], v[252:255]
v_mfma_f32_16x16x32_bf16 v[248:251], v[108:111], v[120:123], v[248:251]
s_add_u32 s72, s69, 129024
buffer_load_dwordx4 v4, s[4:7], s72 offen offset:2048 lds
v_mfma_f32_16x16x32_bf16 v[244:247], v[108:111], v[116:119], v[244:247]
v_mfma_f32_16x16x32_bf16 v[240:243], v[108:111], v[112:115], v[240:243]
s_waitcnt lgkmcnt(0)
v_mfma_f32_16x16x32_bf16 v[128:131], v[32:35], v[64:67], v[128:131]
ds_read_b64_tr_b16 v[80:81], v8 offset:24576
ds_read_b64_tr_b16 v[82:83], v8 offset:25600
v_mfma_f32_16x16x32_bf16 v[132:135], v[32:35], v[68:71], v[132:135]
ds_read_b128 v[112:115], v19 offset:0
ds_read_b128 v[116:119], v19 offset:2048
v_mfma_f32_16x16x32_bf16 v[136:139], v[32:35], v[72:75], v[136:139]
s_add_u32 s72, s69, 144384
buffer_load_dwordx4 v5, s[4:7], s72 offen offset:3072 lds
v_mfma_f32_16x16x32_bf16 v[140:143], v[32:35], v[76:79], v[140:143]
ds_read_b128 v[120:123], v19 offset:4096
ds_read_b128 v[124:127], v19 offset:6144
v_mfma_f32_16x16x32_bf16 v[156:159], v[36:39], v[76:79], v[156:159]
ds_read_b64_tr_b16 v[84:85], v9 offset:24576
ds_read_b64_tr_b16 v[86:87], v9 offset:25600
v_mfma_f32_16x16x32_bf16 v[152:155], v[36:39], v[72:75], v[152:155]
ds_read_b64_tr_b16 v[88:89], v10 offset:24576
v_accvgpr_read_b32 v20, a84
v_mfma_f32_16x16x32_bf16 v[148:151], v[36:39], v[68:71], v[148:151]
ds_read_b64_tr_b16 v[90:91], v10 offset:25600
v_accvgpr_read_b32 v28, a85
v_mfma_f32_16x16x32_bf16 v[144:147], v[36:39], v[64:67], v[144:147]
s_add_u32 m0, s63, 135168
ds_read_b64_tr_b16 v[92:93], v11 offset:24576
v_accvgpr_read_b32 v21, a86
v_mfma_f32_16x16x32_bf16 v[160:163], v[40:43], v[64:67], v[160:163]
s_add_u32 s72, s70, 0
buffer_load_dwordx4 v4, s[4:7], s72 offen lds
v_mfma_f32_16x16x32_bf16 v[164:167], v[40:43], v[68:71], v[164:167]
ds_read_b64_tr_b16 v[94:95], v11 offset:25600
v_accvgpr_read_b32 v29, a87
v_mfma_f32_16x16x32_bf16 v[168:171], v[40:43], v[72:75], v[168:171]
ds_read_b64_tr_b16 v[96:97], v12 offset:24576
v_accvgpr_read_b32 v22, a116
v_mfma_f32_16x16x32_bf16 v[172:175], v[40:43], v[76:79], v[172:175]
ds_read_b64_tr_b16 v[98:99], v12 offset:25600
v_accvgpr_read_b32 v30, a117
v_mfma_f32_16x16x32_bf16 v[188:191], v[44:47], v[76:79], v[188:191]
s_add_u32 s72, s70, 15360
buffer_load_dwordx4 v5, s[4:7], s72 offen offset:1024 lds
v_mfma_f32_16x16x32_bf16 v[184:187], v[44:47], v[72:75], v[184:187]
ds_read_b64_tr_b16 v[100:101], v13 offset:24576
v_accvgpr_read_b32 v23, a118
v_mfma_f32_16x16x32_bf16 v[180:183], v[44:47], v[68:71], v[180:183]
ds_read_b64_tr_b16 v[102:103], v13 offset:25600
v_accvgpr_read_b32 v31, a119
v_mfma_f32_16x16x32_bf16 v[176:179], v[44:47], v[64:67], v[176:179]
ds_read_b64_tr_b16 v[104:105], v14 offset:24576
v_mul_f32 v20, s79, v20
v_mfma_f32_16x16x32_bf16 v[192:195], v[48:51], v[64:67], v[192:195]
ds_read_b64_tr_b16 v[106:107], v14 offset:25600
v_mul_f32 v28, s79, v28
v_mfma_f32_16x16x32_bf16 v[196:199], v[48:51], v[68:71], v[196:199]
s_add_u32 s72, s70, 129024
buffer_load_dwordx4 v4, s[4:7], s72 offen offset:2048 lds
v_mfma_f32_16x16x32_bf16 v[200:203], v[48:51], v[72:75], v[200:203]
ds_read_b64_tr_b16 v[108:109], v15 offset:24576
v_mul_f32 v21, s79, v21
v_mfma_f32_16x16x32_bf16 v[204:207], v[48:51], v[76:79], v[204:207]
ds_read_b64_tr_b16 v[110:111], v15 offset:25600
v_mul_f32 v29, s79, v29
v_mfma_f32_16x16x32_bf16 v[220:223], v[52:55], v[76:79], v[220:223]
v_mul_f32 v22, s79, v22
v_mul_f32 v30, s79, v30
v_mfma_f32_16x16x32_bf16 v[216:219], v[52:55], v[72:75], v[216:219]
v_mul_f32 v23, s79, v23
v_mul_f32 v31, s79, v31
v_mfma_f32_16x16x32_bf16 v[212:215], v[52:55], v[68:71], v[212:215]
s_add_u32 s72, s70, 144384
buffer_load_dwordx4 v5, s[4:7], s72 offen offset:3072 lds
v_mfma_f32_16x16x32_bf16 v[208:211], v[52:55], v[64:67], v[208:211]
v_cvt_pk_bf16_f32 v20, v20, v28
v_cvt_pk_bf16_f32 v21, v21, v29
v_mfma_f32_16x16x32_bf16 v[224:227], v[56:59], v[64:67], v[224:227]
v_cvt_pk_bf16_f32 v22, v22, v30
v_cvt_pk_bf16_f32 v23, v23, v31
v_mfma_f32_16x16x32_bf16 v[228:231], v[56:59], v[68:71], v[228:231]
s_add_u32 s80, s77, 37888
buffer_store_dwordx4 v[20:23], v1, s[44:47], s80 offen sc1
v_mfma_f32_16x16x32_bf16 v[232:235], v[56:59], v[72:75], v[232:235]
v_accvgpr_read_b32 v24, a216
v_accvgpr_read_b32 v28, a217
v_mfma_f32_16x16x32_bf16 v[236:239], v[56:59], v[76:79], v[236:239]
v_accvgpr_read_b32 v25, a218
v_accvgpr_read_b32 v29, a219
v_mfma_f32_16x16x32_bf16 v[252:255], v[60:63], v[76:79], v[252:255]
v_accvgpr_read_b32 v26, a220
v_accvgpr_read_b32 v30, a221
v_mfma_f32_16x16x32_bf16 v[248:251], v[60:63], v[72:75], v[248:251]
v_accvgpr_read_b32 v27, a222
v_accvgpr_read_b32 v31, a223
v_mfma_f32_16x16x32_bf16 v[244:247], v[60:63], v[68:71], v[244:247]
s_waitcnt vmcnt(15) lgkmcnt(0)
v_cvt_pk_bf16_f32 v24, v24, v28
v_cvt_pk_bf16_f32 v25, v25, v29
v_mfma_f32_16x16x32_bf16 v[240:243], v[60:63], v[64:67], v[240:243]
s_barrier
v_cvt_pk_bf16_f32 v26, v26, v30
v_cvt_pk_bf16_f32 v27, v27, v31
v_mfma_f32_16x16x32_bf16 v[128:131], v[80:83], v[112:115], v[128:131]
s_add_u32 s73, s62, 10
ds_read_b64_tr_b16 v[32:33], v8 offset:32768
ds_read_b64_tr_b16 v[34:35], v8 offset:33792
v_mfma_f32_16x16x32_bf16 v[132:135], v[80:83], v[116:119], v[132:135]
s_add_u32 s70, s73, s65
ds_read_b128 v[64:67], v18 offset:32768
ds_read_b128 v[68:71], v18 offset:34816
v_mfma_f32_16x16x32_bf16 v[136:139], v[80:83], v[120:123], v[136:139]
s_and_b32 s70, s70, 3
ds_read_b128 v[72:75], v18 offset:36864
ds_read_b128 v[76:79], v18 offset:38912
v_mfma_f32_16x16x32_bf16 v[140:143], v[80:83], v[124:127], v[140:143]
s_and_b32 s73, s73, 12
ds_read_b64_tr_b16 v[36:37], v9 offset:32768
ds_read_b64_tr_b16 v[38:39], v9 offset:33792
v_mfma_f32_16x16x32_bf16 v[156:159], v[84:87], v[124:127], v[156:159]
s_or_b32 s73, s73, s70
ds_read_b64_tr_b16 v[40:41], v10 offset:32768
v_mfma_f32_16x16x32_bf16 v[152:155], v[84:87], v[120:123], v[152:155]
s_lshl_b32 s71, s73, 19
ds_read_b64_tr_b16 v[42:43], v10 offset:33792
v_mfma_f32_16x16x32_bf16 v[148:151], v[84:87], v[116:119], v[148:151]
s_add_u32 s71, s71, s66
ds_read_b64_tr_b16 v[44:45], v11 offset:32768
v_mfma_f32_16x16x32_bf16 v[144:147], v[84:87], v[112:115], v[144:147]
s_lshl_b32 s73, s73, 7
ds_read_b64_tr_b16 v[46:47], v11 offset:33792
v_mfma_f32_16x16x32_bf16 v[160:163], v[88:91], v[112:115], v[160:163]
s_add_u32 s69, s73, s67
ds_read_b64_tr_b16 v[48:49], v12 offset:32768
v_accvgpr_read_b32 v20, a88
v_mfma_f32_16x16x32_bf16 v[164:167], v[88:91], v[116:119], v[164:167]
s_add_u32 s70, s73, s68
ds_read_b64_tr_b16 v[50:51], v12 offset:33792
v_accvgpr_read_b32 v28, a89
v_mfma_f32_16x16x32_bf16 v[168:171], v[88:91], v[120:123], v[168:171]
s_add_u32 m0, s64, 16384
ds_read_b64_tr_b16 v[52:53], v13 offset:32768
v_accvgpr_read_b32 v21, a90
v_mfma_f32_16x16x32_bf16 v[172:175], v[88:91], v[124:127], v[172:175]
s_add_u32 s72, s71, 0
buffer_load_dwordx4 v6, s[12:15], s72 offen lds
v_mfma_f32_16x16x32_bf16 v[188:191], v[92:95], v[124:127], v[188:191]
s_add_u32 s72, s71, 31744
buffer_load_dwordx4 v6, s[12:15], s72 offen offset:1024 lds
v_mfma_f32_16x16x32_bf16 v[184:187], v[92:95], v[120:123], v[184:187]
s_add_u32 s72, s71, 63488
buffer_load_dwordx4 v7, s[12:15], s72 offen offset:2048 lds
v_mfma_f32_16x16x32_bf16 v[180:183], v[92:95], v[116:119], v[180:183]
s_add_u32 s72, s71, 95232
buffer_load_dwordx4 v7, s[12:15], s72 offen offset:3072 lds
v_mfma_f32_16x16x32_bf16 v[176:179], v[92:95], v[112:115], v[176:179]
s_add_u32 s80, s78, 43008
ds_read_b64_tr_b16 v[54:55], v13 offset:33792
v_accvgpr_read_b32 v29, a91
v_mfma_f32_16x16x32_bf16 v[192:195], v[96:99], v[112:115], v[192:195]
ds_read_b64_tr_b16 v[56:57], v14 offset:32768
v_accvgpr_read_b32 v22, a120
v_mfma_f32_16x16x32_bf16 v[196:199], v[96:99], v[116:119], v[196:199]
ds_read_b64_tr_b16 v[58:59], v14 offset:33792
v_accvgpr_read_b32 v30, a121
v_mfma_f32_16x16x32_bf16 v[200:203], v[96:99], v[120:123], v[200:203]
ds_read_b64_tr_b16 v[60:61], v15 offset:32768
v_accvgpr_read_b32 v23, a122
v_mfma_f32_16x16x32_bf16 v[204:207], v[96:99], v[124:127], v[204:207]
s_add_u32 m0, s63, 65536
ds_read_b64_tr_b16 v[62:63], v15 offset:33792
v_accvgpr_read_b32 v31, a123
v_mfma_f32_16x16x32_bf16 v[220:223], v[100:103], v[124:127], v[220:223]
s_add_u32 s72, s69, 0
buffer_load_dwordx4 v4, s[4:7], s72 offen lds
v_mfma_f32_16x16x32_bf16 v[216:219], v[100:103], v[120:123], v[216:219]
buffer_store_dwordx4 v[24:27], v1, s[44:47], s80 offen sc1
v_mfma_f32_16x16x32_bf16 v[212:215], v[100:103], v[116:119], v[212:215]
v_mul_f32 v20, s79, v20
v_mul_f32 v28, s79, v28
v_mfma_f32_16x16x32_bf16 v[208:211], v[100:103], v[112:115], v[208:211]
v_mul_f32 v21, s79, v21
v_mul_f32 v29, s79, v29
v_mfma_f32_16x16x32_bf16 v[224:227], v[104:107], v[112:115], v[224:227]
s_add_u32 s72, s69, 15360
buffer_load_dwordx4 v5, s[4:7], s72 offen offset:1024 lds
v_mfma_f32_16x16x32_bf16 v[228:231], v[104:107], v[116:119], v[228:231]
v_mul_f32 v22, s79, v22
v_mul_f32 v30, s79, v30
v_mfma_f32_16x16x32_bf16 v[232:235], v[104:107], v[120:123], v[232:235]
v_mul_f32 v23, s79, v23
v_mul_f32 v31, s79, v31
v_mfma_f32_16x16x32_bf16 v[236:239], v[104:107], v[124:127], v[236:239]
v_cvt_pk_bf16_f32 v20, v20, v28
v_cvt_pk_bf16_f32 v21, v21, v29
v_mfma_f32_16x16x32_bf16 v[252:255], v[108:111], v[124:127], v[252:255]
v_cvt_pk_bf16_f32 v22, v22, v30
v_cvt_pk_bf16_f32 v23, v23, v31
v_mfma_f32_16x16x32_bf16 v[248:251], v[108:111], v[120:123], v[248:251]
s_add_u32 s72, s69, 129024
buffer_load_dwordx4 v4, s[4:7], s72 offen offset:2048 lds
v_mfma_f32_16x16x32_bf16 v[244:247], v[108:111], v[116:119], v[244:247]
s_add_u32 s80, s77, 41984
buffer_store_dwordx4 v[20:23], v1, s[44:47], s80 offen sc1
v_mfma_f32_16x16x32_bf16 v[240:243], v[108:111], v[112:115], v[240:243]
s_waitcnt lgkmcnt(0)
v_accvgpr_read_b32 v24, a224
v_accvgpr_read_b32 v28, a225
LcB1:
v_mfma_f32_16x16x32_bf16 v[128:131], v[32:35], v[64:67], v[128:131]
ds_read_b64_tr_b16 v[80:81], v8 offset:40960
ds_read_b64_tr_b16 v[82:83], v8 offset:41984
v_mfma_f32_16x16x32_bf16 v[132:135], v[32:35], v[68:71], v[132:135]
ds_read_b128 v[112:115], v19 offset:32768
ds_read_b128 v[116:119], v19 offset:34816
v_mfma_f32_16x16x32_bf16 v[136:139], v[32:35], v[72:75], v[136:139]
s_add_u32 s72, s69, 144384
buffer_load_dwordx4 v5, s[4:7], s72 offen offset:3072 lds
v_mfma_f32_16x16x32_bf16 v[140:143], v[32:35], v[76:79], v[140:143]
ds_read_b128 v[120:123], v19 offset:36864
ds_read_b128 v[124:127], v19 offset:38912
v_mfma_f32_16x16x32_bf16 v[156:159], v[36:39], v[76:79], v[156:159]
ds_read_b64_tr_b16 v[84:85], v9 offset:40960
ds_read_b64_tr_b16 v[86:87], v9 offset:41984
v_mfma_f32_16x16x32_bf16 v[152:155], v[36:39], v[72:75], v[152:155]
ds_read_b64_tr_b16 v[88:89], v10 offset:40960
v_accvgpr_read_b32 v25, a226
v_mfma_f32_16x16x32_bf16 v[148:151], v[36:39], v[68:71], v[148:151]
ds_read_b64_tr_b16 v[90:91], v10 offset:41984
v_accvgpr_read_b32 v29, a227
v_mfma_f32_16x16x32_bf16 v[144:147], v[36:39], v[64:67], v[144:147]
s_add_u32 m0, s63, 69632
ds_read_b64_tr_b16 v[92:93], v11 offset:40960
v_accvgpr_read_b32 v26, a228
v_mfma_f32_16x16x32_bf16 v[160:163], v[40:43], v[64:67], v[160:163]
s_add_u32 s72, s70, 0
buffer_load_dwordx4 v4, s[4:7], s72 offen lds
v_mfma_f32_16x16x32_bf16 v[164:167], v[40:43], v[68:71], v[164:167]
ds_read_b64_tr_b16 v[94:95], v11 offset:41984
v_accvgpr_read_b32 v30, a229
v_mfma_f32_16x16x32_bf16 v[168:171], v[40:43], v[72:75], v[168:171]
ds_read_b64_tr_b16 v[96:97], v12 offset:40960
v_accvgpr_read_b32 v27, a230
v_mfma_f32_16x16x32_bf16 v[172:175], v[40:43], v[76:79], v[172:175]
ds_read_b64_tr_b16 v[98:99], v12 offset:41984
v_accvgpr_read_b32 v31, a231
v_mfma_f32_16x16x32_bf16 v[188:191], v[44:47], v[76:79], v[188:191]
s_add_u32 s72, s70, 15360
buffer_load_dwordx4 v5, s[4:7], s72 offen offset:1024 lds
v_mfma_f32_16x16x32_bf16 v[184:187], v[44:47], v[72:75], v[184:187]
ds_read_b64_tr_b16 v[100:101], v13 offset:40960
v_cvt_pk_bf16_f32 v24, v24, v28
v_mfma_f32_16x16x32_bf16 v[180:183], v[44:47], v[68:71], v[180:183]
ds_read_b64_tr_b16 v[102:103], v13 offset:41984
v_cvt_pk_bf16_f32 v25, v25, v29
v_mfma_f32_16x16x32_bf16 v[176:179], v[44:47], v[64:67], v[176:179]
ds_read_b64_tr_b16 v[104:105], v14 offset:40960
v_cvt_pk_bf16_f32 v26, v26, v30
v_mfma_f32_16x16x32_bf16 v[192:195], v[48:51], v[64:67], v[192:195]
ds_read_b64_tr_b16 v[106:107], v14 offset:41984
v_cvt_pk_bf16_f32 v27, v27, v31
v_mfma_f32_16x16x32_bf16 v[196:199], v[48:51], v[68:71], v[196:199]
s_add_u32 s72, s70, 129024
buffer_load_dwordx4 v4, s[4:7], s72 offen offset:2048 lds
v_mfma_f32_16x16x32_bf16 v[200:203], v[48:51], v[72:75], v[200:203]
s_add_u32 s80, s78, 3072
ds_read_b64_tr_b16 v[108:109], v15 offset:40960
v_accvgpr_read_b32 v20, a92
v_mfma_f32_16x16x32_bf16 v[204:207], v[48:51], v[76:79], v[204:207]
ds_read_b64_tr_b16 v[110:111], v15 offset:41984
v_accvgpr_read_b32 v28, a93
v_mfma_f32_16x16x32_bf16 v[220:223], v[52:55], v[76:79], v[220:223]
buffer_store_dwordx4 v[24:27], v1, s[44:47], s80 offen sc1
v_mfma_f32_16x16x32_bf16 v[216:219], v[52:55], v[72:75], v[216:219]
v_accvgpr_read_b32 v21, a94
v_accvgpr_read_b32 v29, a95
v_mfma_f32_16x16x32_bf16 v[212:215], v[52:55], v[68:71], v[212:215]
s_add_u32 s72, s70, 144384
buffer_load_dwordx4 v5, s[4:7], s72 offen offset:3072 lds
v_mfma_f32_16x16x32_bf16 v[208:211], v[52:55], v[64:67], v[208:211]
v_accvgpr_read_b32 v22, a124
v_accvgpr_read_b32 v30, a125
v_mfma_f32_16x16x32_bf16 v[224:227], v[56:59], v[64:67], v[224:227]
v_accvgpr_read_b32 v23, a126
v_accvgpr_read_b32 v31, a127
v_mfma_f32_16x16x32_bf16 v[228:231], v[56:59], v[68:71], v[228:231]
v_mul_f32 v20, s79, v20
v_mul_f32 v28, s79, v28
v_mfma_f32_16x16x32_bf16 v[232:235], v[56:59], v[72:75], v[232:235]
v_mul_f32 v21, s79, v21
v_mul_f32 v29, s79, v29
v_mfma_f32_16x16x32_bf16 v[236:239], v[56:59], v[76:79], v[236:239]
v_mul_f32 v22, s79, v22
v_mul_f32 v30, s79, v30
v_mfma_f32_16x16x32_bf16 v[252:255], v[60:63], v[76:79], v[252:255]
v_mul_f32 v23, s79, v23
v_mul_f32 v31, s79, v31
v_mfma_f32_16x16x32_bf16 v[248:251], v[60:63], v[72:75], v[248:251]
v_cvt_pk_bf16_f32 v20, v20, v28
v_cvt_pk_bf16_f32 v21, v21, v29
v_mfma_f32_16x16x32_bf16 v[244:247], v[60:63], v[68:71], v[244:247]
s_waitcnt vmcnt(16) lgkmcnt(0)
v_cvt_pk_bf16_f32 v22, v22, v30
v_cvt_pk_bf16_f32 v23, v23, v31
v_mfma_f32_16x16x32_bf16 v[240:243], v[60:63], v[64:67], v[240:243]
s_barrier
v_mfma_f32_16x16x32_bf16 v[128:131], v[80:83], v[112:115], v[128:131]
s_add_u32 s73, s62, 11
ds_read_b64_tr_b16 v[32:33], v8 offset:0
ds_read_b64_tr_b16 v[34:35], v8 offset:1024
v_mfma_f32_16x16x32_bf16 v[132:135], v[80:83], v[116:119], v[132:135]
s_add_u32 s70, s73, s65
ds_read_b128 v[64:67], v16 offset:0
ds_read_b128 v[68:71], v16 offset:2048
v_mfma_f32_16x16x32_bf16 v[136:139], v[80:83], v[120:123], v[136:139]
s_and_b32 s70, s70, 3
ds_read_b128 v[72:75], v16 offset:4096
ds_read_b128 v[76:79], v16 offset:6144
v_mfma_f32_16x16x32_bf16 v[140:143], v[80:83], v[124:127], v[140:143]
s_and_b32 s73, s73, 12
ds_read_b64_tr_b16 v[36:37], v9 offset:0
ds_read_b64_tr_b16 v[38:39], v9 offset:1024
v_mfma_f32_16x16x32_bf16 v[156:159], v[84:87], v[124:127], v[156:159]
s_or_b32 s73, s73, s70
ds_read_b64_tr_b16 v[40:41], v10 offset:0
v_mfma_f32_16x16x32_bf16 v[152:155], v[84:87], v[120:123], v[152:155]
s_lshl_b32 s71, s73, 19
ds_read_b64_tr_b16 v[42:43], v10 offset:1024
v_accvgpr_read_b32 v24, a232
v_mfma_f32_16x16x32_bf16 v[148:151], v[84:87], v[116:119], v[148:151]
s_add_u32 s71, s71, s66
ds_read_b64_tr_b16 v[44:45], v11 offset:0
v_accvgpr_read_b32 v28, a233
v_mfma_f32_16x16x32_bf16 v[144:147], v[84:87], v[112:115], v[144:147]
s_lshl_b32 s73, s73, 7
ds_read_b64_tr_b16 v[46:47], v11 offset:1024
v_accvgpr_read_b32 v25, a234
v_mfma_f32_16x16x32_bf16 v[160:163], v[88:91], v[112:115], v[160:163]
s_add_u32 s69, s73, s67
ds_read_b64_tr_b16 v[48:49], v12 offset:0
v_accvgpr_read_b32 v29, a235
v_mfma_f32_16x16x32_bf16 v[164:167], v[88:91], v[116:119], v[164:167]
s_add_u32 s70, s73, s68
ds_read_b64_tr_b16 v[50:51], v12 offset:1024
v_accvgpr_read_b32 v26, a236
v_mfma_f32_16x16x32_bf16 v[168:171], v[88:91], v[120:123], v[168:171]
s_add_u32 m0, s64, 32768
ds_read_b64_tr_b16 v[52:53], v13 offset:0
v_accvgpr_read_b32 v30, a237
v_mfma_f32_16x16x32_bf16 v[172:175], v[88:91], v[124:127], v[172:175]
s_add_u32 s72, s71, 0
buffer_load_dwordx4 v6, s[12:15], s72 offen lds
v_mfma_f32_16x16x32_bf16 v[188:191], v[92:95], v[124:127], v[188:191]
s_add_u32 s72, s71, 31744
buffer_load_dwordx4 v6, s[12:15], s72 offen offset:1024 lds
v_mfma_f32_16x16x32_bf16 v[184:187], v[92:95], v[120:123], v[184:187]
s_add_u32 s72, s71, 63488
buffer_load_dwordx4 v7, s[12:15], s72 offen offset:2048 lds
v_mfma_f32_16x16x32_bf16 v[180:183], v[92:95], v[116:119], v[180:183]
s_add_u32 s72, s71, 95232
buffer_load_dwordx4 v7, s[12:15], s72 offen offset:3072 lds
v_mfma_f32_16x16x32_bf16 v[176:179], v[92:95], v[112:115], v[176:179]
s_add_u32 s80, s77, 46080
ds_read_b64_tr_b16 v[54:55], v13 offset:1024
v_accvgpr_read_b32 v27, a238
v_mfma_f32_16x16x32_bf16 v[192:195], v[96:99], v[112:115], v[192:195]
ds_read_b64_tr_b16 v[56:57], v14 offset:0
v_accvgpr_read_b32 v31, a239
v_mfma_f32_16x16x32_bf16 v[196:199], v[96:99], v[116:119], v[196:199]
ds_read_b64_tr_b16 v[58:59], v14 offset:1024
v_cvt_pk_bf16_f32 v24, v24, v28
v_mfma_f32_16x16x32_bf16 v[200:203], v[96:99], v[120:123], v[200:203]
ds_read_b64_tr_b16 v[60:61], v15 offset:0
v_cvt_pk_bf16_f32 v25, v25, v29
v_mfma_f32_16x16x32_bf16 v[204:207], v[96:99], v[124:127], v[204:207]
s_add_u32 m0, s63, 98304
ds_read_b64_tr_b16 v[62:63], v15 offset:1024
v_cvt_pk_bf16_f32 v26, v26, v30
v_mfma_f32_16x16x32_bf16 v[220:223], v[100:103], v[124:127], v[220:223]
s_add_u32 s72, s69, 0
buffer_load_dwordx4 v4, s[4:7], s72 offen lds
v_mfma_f32_16x16x32_bf16 v[216:219], v[100:103], v[120:123], v[216:219]
buffer_store_dwordx4 v[20:23], v1, s[44:47], s80 offen sc1
v_mfma_f32_16x16x32_bf16 v[212:215], v[100:103], v[116:119], v[212:215]
v_cvt_pk_bf16_f32 v27, v27, v31
v_mfma_f32_16x16x32_bf16 v[208:211], v[100:103], v[112:115], v[208:211]
s_add_u32 s80, s78, 11264
buffer_store_dwordx4 v[24:27], v1, s[44:47], s80 offen sc1
v_mfma_f32_16x16x32_bf16 v[224:227], v[104:107], v[112:115], v[224:227]
s_add_u32 s72, s69, 15360
buffer_load_dwordx4 v5, s[4:7], s72 offen offset:1024 lds
v_mfma_f32_16x16x32_bf16 v[228:231], v[104:107], v[116:119], v[228:231]
v_accvgpr_read_b32 v20, a240
v_accvgpr_read_b32 v28, a241
v_mfma_f32_16x16x32_bf16 v[232:235], v[104:107], v[120:123], v[232:235]
v_accvgpr_read_b32 v21, a242
v_accvgpr_read_b32 v29, a243
v_mfma_f32_16x16x32_bf16 v[236:239], v[104:107], v[124:127], v[236:239]
v_accvgpr_read_b32 v22, a244
v_accvgpr_read_b32 v30, a245
v_mfma_f32_16x16x32_bf16 v[252:255], v[108:111], v[124:127], v[252:255]
v_accvgpr_read_b32 v23, a246
v_accvgpr_read_b32 v31, a247
v_mfma_f32_16x16x32_bf16 v[248:251], v[108:111], v[120:123], v[248:251]
s_add_u32 s72, s69, 129024
buffer_load_dwordx4 v4, s[4:7], s72 offen offset:2048 lds
v_mfma_f32_16x16x32_bf16 v[244:247], v[108:111], v[116:119], v[244:247]
v_cvt_pk_bf16_f32 v20, v20, v28
v_cvt_pk_bf16_f32 v21, v21, v29
v_mfma_f32_16x16x32_bf16 v[240:243], v[108:111], v[112:115], v[240:243]
s_waitcnt lgkmcnt(0)
v_cvt_pk_bf16_f32 v22, v22, v30
v_cvt_pk_bf16_f32 v23, v23, v31
v_mfma_f32_16x16x32_bf16 v[128:131], v[32:35], v[64:67], v[128:131]
s_add_u32 s80, s78, 35840
ds_read_b64_tr_b16 v[80:81], v8 offset:8192
ds_read_b64_tr_b16 v[82:83], v8 offset:9216
v_mfma_f32_16x16x32_bf16 v[132:135], v[32:35], v[68:71], v[132:135]
ds_read_b128 v[112:115], v17 offset:0
ds_read_b128 v[116:119], v17 offset:2048
v_mfma_f32_16x16x32_bf16 v[136:139], v[32:35], v[72:75], v[136:139]
s_add_u32 s72, s69, 144384
buffer_load_dwordx4 v5, s[4:7], s72 offen offset:3072 lds
v_mfma_f32_16x16x32_bf16 v[140:143], v[32:35], v[76:79], v[140:143]
ds_read_b128 v[120:123], v17 offset:4096
ds_read_b128 v[124:127], v17 offset:6144
v_mfma_f32_16x16x32_bf16 v[156:159], v[36:39], v[76:79], v[156:159]
ds_read_b64_tr_b16 v[84:85], v9 offset:8192
ds_read_b64_tr_b16 v[86:87], v9 offset:9216
v_mfma_f32_16x16x32_bf16 v[152:155], v[36:39], v[72:75], v[152:155]
ds_read_b64_tr_b16 v[88:89], v10 offset:8192
v_mfma_f32_16x16x32_bf16 v[148:151], v[36:39], v[68:71], v[148:151]
ds_read_b64_tr_b16 v[90:91], v10 offset:9216
v_mfma_f32_16x16x32_bf16 v[144:147], v[36:39], v[64:67], v[144:147]
s_add_u32 m0, s63, 102400
ds_read_b64_tr_b16 v[92:93], v11 offset:8192
v_mfma_f32_16x16x32_bf16 v[160:163], v[40:43], v[64:67], v[160:163]
s_add_u32 s72, s70, 0
buffer_load_dwordx4 v4, s[4:7], s72 offen lds
v_mfma_f32_16x16x32_bf16 v[164:167], v[40:43], v[68:71], v[164:167]
ds_read_b64_tr_b16 v[94:95], v11 offset:9216
v_mfma_f32_16x16x32_bf16 v[168:171], v[40:43], v[72:75], v[168:171]
ds_read_b64_tr_b16 v[96:97], v12 offset:8192
v_mfma_f32_16x16x32_bf16 v[172:175], v[40:43], v[76:79], v[172:175]
ds_read_b64_tr_b16 v[98:99], v12 offset:9216
v_mfma_f32_16x16x32_bf16 v[188:191], v[44:47], v[76:79], v[188:191]
s_add_u32 s72, s70, 15360
buffer_load_dwordx4 v5, s[4:7], s72 offen offset:1024 lds
v_mfma_f32_16x16x32_bf16 v[184:187], v[44:47], v[72:75], v[184:187]
ds_read_b64_tr_b16 v[100:101], v13 offset:8192
v_accvgpr_read_b32 v24, a248
v_mfma_f32_16x16x32_bf16 v[180:183], v[44:47], v[68:71], v[180:183]
ds_read_b64_tr_b16 v[102:103], v13 offset:9216
v_accvgpr_read_b32 v28, a249
v_mfma_f32_16x16x32_bf16 v[176:179], v[44:47], v[64:67], v[176:179]
ds_read_b64_tr_b16 v[104:105], v14 offset:8192
v_accvgpr_read_b32 v25, a250
v_mfma_f32_16x16x32_bf16 v[192:195], v[48:51], v[64:67], v[192:195]
ds_read_b64_tr_b16 v[106:107], v14 offset:9216
v_accvgpr_read_b32 v29, a251
v_mfma_f32_16x16x32_bf16 v[196:199], v[48:51], v[68:71], v[196:199]
s_add_u32 s72, s70, 129024
buffer_load_dwordx4 v4, s[4:7], s72 offen offset:2048 lds
v_mfma_f32_16x16x32_bf16 v[200:203], v[48:51], v[72:75], v[200:203]
ds_read_b64_tr_b16 v[108:109], v15 offset:8192
v_accvgpr_read_b32 v26, a252
v_mfma_f32_16x16x32_bf16 v[204:207], v[48:51], v[76:79], v[204:207]
ds_read_b64_tr_b16 v[110:111], v15 offset:9216
v_accvgpr_read_b32 v30, a253
v_mfma_f32_16x16x32_bf16 v[220:223], v[52:55], v[76:79], v[220:223]
buffer_store_dwordx4 v[20:23], v1, s[44:47], s80 offen sc1
v_mfma_f32_16x16x32_bf16 v[216:219], v[52:55], v[72:75], v[216:219]
v_accvgpr_read_b32 v27, a254
v_accvgpr_read_b32 v31, a255
v_mfma_f32_16x16x32_bf16 v[212:215], v[52:55], v[68:71], v[212:215]
s_add_u32 s72, s70, 144384
buffer_load_dwordx4 v5, s[4:7], s72 offen offset:3072 lds
v_mfma_f32_16x16x32_bf16 v[208:211], v[52:55], v[64:67], v[208:211]
v_cvt_pk_bf16_f32 v24, v24, v28
v_cvt_pk_bf16_f32 v25, v25, v29
v_mfma_f32_16x16x32_bf16 v[224:227], v[56:59], v[64:67], v[224:227]
v_cvt_pk_bf16_f32 v26, v26, v30
v_cvt_pk_bf16_f32 v27, v27, v31
v_mfma_f32_16x16x32_bf16 v[228:231], v[56:59], v[68:71], v[228:231]
s_add_u32 s80, s78, 44032
buffer_store_dwordx4 v[24:27], v1, s[44:47], s80 offen sc1
v_mfma_f32_16x16x32_bf16 v[232:235], v[56:59], v[72:75], v[232:235]
v_mfma_f32_16x16x32_bf16 v[236:239], v[56:59], v[76:79], v[236:239]
v_mfma_f32_16x16x32_bf16 v[252:255], v[60:63], v[76:79], v[252:255]
v_mfma_f32_16x16x32_bf16 v[248:251], v[60:63], v[72:75], v[248:251]
v_mfma_f32_16x16x32_bf16 v[244:247], v[60:63], v[68:71], v[244:247]
s_waitcnt vmcnt(16) lgkmcnt(0)
v_mfma_f32_16x16x32_bf16 v[240:243], v[60:63], v[64:67], v[240:243]
s_barrier
v_mfma_f32_16x16x32_bf16 v[128:131], v[80:83], v[112:115], v[128:131]
s_add_u32 s73, s62, 12
ds_read_b64_tr_b16 v[32:33], v8 offset:16384
ds_read_b64_tr_b16 v[34:35], v8 offset:17408
v_mfma_f32_16x16x32_bf16 v[132:135], v[80:83], v[116:119], v[132:135]
s_add_u32 s70, s73, s65
ds_read_b128 v[64:67], v18 offset:0
ds_read_b128 v[68:71], v18 offset:2048
v_mfma_f32_16x16x32_bf16 v[136:139], v[80:83], v[120:123], v[136:139]
s_and_b32 s70, s70, 3
v_and_b32 v2, 31, v0
v_lshlrev_b32 v2, 2, v2
v_mfma_f32_16x16x32_bf16 v[140:143], v[80:83], v[124:127], v[140:143]
s_and_b32 s73, s73, 12
buffer_load_dword v3, v2, s[48:51], 0 offen sc1
v_mfma_f32_16x16x32_bf16 v[156:159], v[84:87], v[124:127], v[156:159]
s_or_b32 s73, s73, s70
ds_read_b128 v[72:75], v18 offset:4096
ds_read_b128 v[76:79], v18 offset:6144
v_mfma_f32_16x16x32_bf16 v[152:155], v[84:87], v[120:123], v[152:155]
s_lshl_b32 s71, s73, 19
ds_read_b64_tr_b16 v[36:37], v9 offset:16384
ds_read_b64_tr_b16 v[38:39], v9 offset:17408
v_mfma_f32_16x16x32_bf16 v[148:151], v[84:87], v[116:119], v[148:151]
s_add_u32 s71, s71, s66
ds_read_b64_tr_b16 v[40:41], v10 offset:16384
v_mfma_f32_16x16x32_bf16 v[144:147], v[84:87], v[112:115], v[144:147]
s_lshl_b32 s73, s73, 7
ds_read_b64_tr_b16 v[42:43], v10 offset:17408
v_mfma_f32_16x16x32_bf16 v[160:163], v[88:91], v[112:115], v[160:163]
s_add_u32 s69, s73, s67
ds_read_b64_tr_b16 v[44:45], v11 offset:16384
v_mfma_f32_16x16x32_bf16 v[164:167], v[88:91], v[116:119], v[164:167]
s_add_u32 s70, s73, s68
ds_read_b64_tr_b16 v[46:47], v11 offset:17408
v_mfma_f32_16x16x32_bf16 v[168:171], v[88:91], v[120:123], v[168:171]
s_add_u32 m0, s64, 0
ds_read_b64_tr_b16 v[48:49], v12 offset:16384
v_mfma_f32_16x16x32_bf16 v[172:175], v[88:91], v[124:127], v[172:175]
s_add_u32 s72, s71, 0
buffer_load_dwordx4 v6, s[12:15], s72 offen lds
v_mfma_f32_16x16x32_bf16 v[188:191], v[92:95], v[124:127], v[188:191]
s_add_u32 s72, s71, 31744
buffer_load_dwordx4 v6, s[12:15], s72 offen offset:1024 lds
v_mfma_f32_16x16x32_bf16 v[184:187], v[92:95], v[120:123], v[184:187]
s_add_u32 s72, s71, 63488
buffer_load_dwordx4 v7, s[12:15], s72 offen offset:2048 lds
v_mfma_f32_16x16x32_bf16 v[180:183], v[92:95], v[116:119], v[180:183]
s_add_u32 s72, s71, 95232
buffer_load_dwordx4 v7, s[12:15], s72 offen offset:3072 lds
v_mfma_f32_16x16x32_bf16 v[176:179], v[92:95], v[112:115], v[176:179]
ds_read_b64_tr_b16 v[50:51], v12 offset:17408
v_mfma_f32_16x16x32_bf16 v[192:195], v[96:99], v[112:115], v[192:195]
ds_read_b64_tr_b16 v[52:53], v13 offset:16384
v_mfma_f32_16x16x32_bf16 v[196:199], v[96:99], v[116:119], v[196:199]
ds_read_b64_tr_b16 v[54:55], v13 offset:17408
v_mfma_f32_16x16x32_bf16 v[200:203], v[96:99], v[120:123], v[200:203]
ds_read_b64_tr_b16 v[56:57], v14 offset:16384
v_mfma_f32_16x16x32_bf16 v[204:207], v[96:99], v[124:127], v[204:207]
s_add_u32 m0, s63, 131072
ds_read_b64_tr_b16 v[58:59], v14 offset:17408
v_mfma_f32_16x16x32_bf16 v[220:223], v[100:103], v[124:127], v[220:223]
s_add_u32 s72, s69, 0
buffer_load_dwordx4 v4, s[4:7], s72 offen lds
v_mfma_f32_16x16x32_bf16 v[216:219], v[100:103], v[120:123], v[216:219]
ds_read_b64_tr_b16 v[60:61], v15 offset:16384
v_mfma_f32_16x16x32_bf16 v[212:215], v[100:103], v[116:119], v[212:215]
ds_read_b64_tr_b16 v[62:63], v15 offset:17408
v_mfma_f32_16x16x32_bf16 v[208:211], v[100:103], v[112:115], v[208:211]
v_mfma_f32_16x16x32_bf16 v[224:227], v[104:107], v[112:115], v[224:227]
s_add_u32 s72, s69, 15360
buffer_load_dwordx4 v5, s[4:7], s72 offen offset:1024 lds
v_mfma_f32_16x16x32_bf16 v[228:231], v[104:107], v[116:119], v[228:231]
v_mfma_f32_16x16x32_bf16 v[232:235], v[104:107], v[120:123], v[232:235]
v_mfma_f32_16x16x32_bf16 v[236:239], v[104:107], v[124:127], v[236:239]
v_mfma_f32_16x16x32_bf16 v[252:255], v[108:111], v[124:127], v[252:255]
v_mfma_f32_16x16x32_bf16 v[248:251], v[108:111], v[120:123], v[248:251]
s_add_u32 s72, s69, 129024
buffer_load_dwordx4 v4, s[4:7], s72 offen offset:2048 lds
v_mfma_f32_16x16x32_bf16 v[244:247], v[108:111], v[116:119], v[244:247]
v_mfma_f32_16x16x32_bf16 v[240:243], v[108:111], v[112:115], v[240:243]
s_waitcnt lgkmcnt(0)
v_mfma_f32_16x16x32_bf16 v[128:131], v[32:35], v[64:67], v[128:131]
ds_read_b64_tr_b16 v[80:81], v8 offset:24576
ds_read_b64_tr_b16 v[82:83], v8 offset:25600
v_mfma_f32_16x16x32_bf16 v[132:135], v[32:35], v[68:71], v[132:135]
ds_read_b128 v[112:115], v19 offset:0
ds_read_b128 v[116:119], v19 offset:2048
v_mfma_f32_16x16x32_bf16 v[136:139], v[32:35], v[72:75], v[136:139]
s_add_u32 s72, s69, 144384
buffer_load_dwordx4 v5, s[4:7], s72 offen offset:3072 lds
v_mfma_f32_16x16x32_bf16 v[140:143], v[32:35], v[76:79], v[140:143]
ds_read_b128 v[120:123], v19 offset:4096
ds_read_b128 v[124:127], v19 offset:6144
v_mfma_f32_16x16x32_bf16 v[156:159], v[36:39], v[76:79], v[156:159]
ds_read_b64_tr_b16 v[84:85], v9 offset:24576
ds_read_b64_tr_b16 v[86:87], v9 offset:25600
v_mfma_f32_16x16x32_bf16 v[152:155], v[36:39], v[72:75], v[152:155]
ds_read_b64_tr_b16 v[88:89], v10 offset:24576
v_mfma_f32_16x16x32_bf16 v[148:151], v[36:39], v[68:71], v[148:151]
ds_read_b64_tr_b16 v[90:91], v10 offset:25600
v_mfma_f32_16x16x32_bf16 v[144:147], v[36:39], v[64:67], v[144:147]
s_add_u32 m0, s63, 135168
ds_read_b64_tr_b16 v[92:93], v11 offset:24576
v_mfma_f32_16x16x32_bf16 v[160:163], v[40:43], v[64:67], v[160:163]
s_add_u32 s72, s70, 0
buffer_load_dwordx4 v4, s[4:7], s72 offen lds
v_mfma_f32_16x16x32_bf16 v[164:167], v[40:43], v[68:71], v[164:167]
ds_read_b64_tr_b16 v[94:95], v11 offset:25600
v_mfma_f32_16x16x32_bf16 v[168:171], v[40:43], v[72:75], v[168:171]
ds_read_b64_tr_b16 v[96:97], v12 offset:24576
v_mfma_f32_16x16x32_bf16 v[172:175], v[40:43], v[76:79], v[172:175]
ds_read_b64_tr_b16 v[98:99], v12 offset:25600
v_mfma_f32_16x16x32_bf16 v[188:191], v[44:47], v[76:79], v[188:191]
s_add_u32 s72, s70, 15360
buffer_load_dwordx4 v5, s[4:7], s72 offen offset:1024 lds
v_mfma_f32_16x16x32_bf16 v[184:187], v[44:47], v[72:75], v[184:187]
ds_read_b64_tr_b16 v[100:101], v13 offset:24576
v_mfma_f32_16x16x32_bf16 v[180:183], v[44:47], v[68:71], v[180:183]
ds_read_b64_tr_b16 v[102:103], v13 offset:25600
v_mfma_f32_16x16x32_bf16 v[176:179], v[44:47], v[64:67], v[176:179]
ds_read_b64_tr_b16 v[104:105], v14 offset:24576
v_mfma_f32_16x16x32_bf16 v[192:195], v[48:51], v[64:67], v[192:195]
ds_read_b64_tr_b16 v[106:107], v14 offset:25600
v_mfma_f32_16x16x32_bf16 v[196:199], v[48:51], v[68:71], v[196:199]
s_add_u32 s72, s70, 129024
buffer_load_dwordx4 v4, s[4:7], s72 offen offset:2048 lds
v_mfma_f32_16x16x32_bf16 v[200:203], v[48:51], v[72:75], v[200:203]
ds_read_b64_tr_b16 v[108:109], v15 offset:24576
v_mfma_f32_16x16x32_bf16 v[204:207], v[48:51], v[76:79], v[204:207]
ds_read_b64_tr_b16 v[110:111], v15 offset:25600
v_mfma_f32_16x16x32_bf16 v[220:223], v[52:55], v[76:79], v[220:223]
v_mfma_f32_16x16x32_bf16 v[216:219], v[52:55], v[72:75], v[216:219]
v_mfma_f32_16x16x32_bf16 v[212:215], v[52:55], v[68:71], v[212:215]
s_add_u32 s72, s70, 144384
buffer_load_dwordx4 v5, s[4:7], s72 offen offset:3072 lds
v_mfma_f32_16x16x32_bf16 v[208:211], v[52:55], v[64:67], v[208:211]
v_mfma_f32_16x16x32_bf16 v[224:227], v[56:59], v[64:67], v[224:227]
v_mfma_f32_16x16x32_bf16 v[228:231], v[56:59], v[68:71], v[228:231]
v_mfma_f32_16x16x32_bf16 v[232:235], v[56:59], v[72:75], v[232:235]
v_mfma_f32_16x16x32_bf16 v[236:239], v[56:59], v[76:79], v[236:239]
v_mfma_f32_16x16x32_bf16 v[252:255], v[60:63], v[76:79], v[252:255]
v_mfma_f32_16x16x32_bf16 v[248:251], v[60:63], v[72:75], v[248:251]
v_mfma_f32_16x16x32_bf16 v[244:247], v[60:63], v[68:71], v[244:247]
s_waitcnt vmcnt(13) lgkmcnt(0)
v_mfma_f32_16x16x32_bf16 v[240:243], v[60:63], v[64:67], v[240:243]
s_barrier
v_mfma_f32_16x16x32_bf16 v[128:131], v[80:83], v[112:115], v[128:131]
s_add_u32 s73, s62, 13
ds_read_b64_tr_b16 v[32:33], v8 offset:32768
ds_read_b64_tr_b16 v[34:35], v8 offset:33792
v_mfma_f32_16x16x32_bf16 v[132:135], v[80:83], v[116:119], v[132:135]
s_add_u32 s70, s73, s65
ds_read_b128 v[64:67], v18 offset:32768
ds_read_b128 v[68:71], v18 offset:34816
v_mfma_f32_16x16x32_bf16 v[136:139], v[80:83], v[120:123], v[136:139]
s_and_b32 s70, s70, 3
ds_read_b128 v[72:75], v18 offset:36864
ds_read_b128 v[76:79], v18 offset:38912
v_mfma_f32_16x16x32_bf16 v[140:143], v[80:83], v[124:127], v[140:143]
s_and_b32 s73, s73, 12
ds_read_b64_tr_b16 v[36:37], v9 offset:32768
ds_read_b64_tr_b16 v[38:39], v9 offset:33792
v_mfma_f32_16x16x32_bf16 v[156:159], v[84:87], v[124:127], v[156:159]
s_or_b32 s73, s73, s70
ds_read_b64_tr_b16 v[40:41], v10 offset:32768
v_or_b32 v20, s58, v0
v_mfma_f32_16x16x32_bf16 v[152:155], v[84:87], v[120:123], v[152:155]
s_lshl_b32 s71, s73, 19
ds_read_b64_tr_b16 v[42:43], v10 offset:33792
v_mov_b32 v21, 1
v_mfma_f32_16x16x32_bf16 v[148:151], v[84:87], v[116:119], v[148:151]
s_add_u32 s71, s71, s66
ds_read_b64_tr_b16 v[44:45], v11 offset:32768
v_min_u32 v20, 1, v20
v_mfma_f32_16x16x32_bf16 v[144:147], v[84:87], v[112:115], v[144:147]
s_lshl_b32 s73, s73, 7
ds_read_b64_tr_b16 v[46:47], v11 offset:33792
v_lshlrev_b32 v20, 30, v20
v_mfma_f32_16x16x32_bf16 v[160:163], v[88:91], v[112:115], v[160:163]
s_add_u32 s69, s73, s67
ds_read_b64_tr_b16 v[48:49], v12 offset:32768
v_mfma_f32_16x16x32_bf16 v[164:167], v[88:91], v[116:119], v[164:167]
s_add_u32 s70, s73, s68
ds_read_b64_tr_b16 v[50:51], v12 offset:33792
v_mfma_f32_16x16x32_bf16 v[168:171], v[88:91], v[120:123], v[168:171]
s_add_u32 m0, s64, 16384
ds_read_b64_tr_b16 v[52:53], v13 offset:32768
v_mfma_f32_16x16x32_bf16 v[172:175], v[88:91], v[124:127], v[172:175]
s_add_u32 s72, s71, 0
buffer_load_dwordx4 v6, s[12:15], s72 offen lds
v_mfma_f32_16x16x32_bf16 v[188:191], v[92:95], v[124:127], v[188:191]
s_add_u32 s72, s71, 31744
buffer_load_dwordx4 v6, s[12:15], s72 offen offset:1024 lds
v_mfma_f32_16x16x32_bf16 v[184:187], v[92:95], v[120:123], v[184:187]
s_add_u32 s72, s71, 63488
buffer_load_dwordx4 v7, s[12:15], s72 offen offset:2048 lds
v_mfma_f32_16x16x32_bf16 v[180:183], v[92:95], v[116:119], v[180:183]
s_add_u32 s72, s71, 95232
buffer_load_dwordx4 v7, s[12:15], s72 offen offset:3072 lds
v_mfma_f32_16x16x32_bf16 v[176:179], v[92:95], v[112:115], v[176:179]
ds_read_b64_tr_b16 v[54:55], v13 offset:33792
v_mfma_f32_16x16x32_bf16 v[192:195], v[96:99], v[112:115], v[192:195]
ds_read_b64_tr_b16 v[56:57], v14 offset:32768
v_mfma_f32_16x16x32_bf16 v[196:199], v[96:99], v[116:119], v[196:199]
ds_read_b64_tr_b16 v[58:59], v14 offset:33792
v_mfma_f32_16x16x32_bf16 v[200:203], v[96:99], v[120:123], v[200:203]
ds_read_b64_tr_b16 v[60:61], v15 offset:32768
v_mfma_f32_16x16x32_bf16 v[204:207], v[96:99], v[124:127], v[204:207]
s_add_u32 m0, s63, 65536
ds_read_b64_tr_b16 v[62:63], v15 offset:33792
v_mfma_f32_16x16x32_bf16 v[220:223], v[100:103], v[124:127], v[220:223]
s_add_u32 s72, s69, 0
buffer_load_dwordx4 v4, s[4:7], s72 offen lds
v_mfma_f32_16x16x32_bf16 v[216:219], v[100:103], v[120:123], v[216:219]
buffer_store_dword v21, v20, s[44:47], s91 offen sc1
v_mfma_f32_16x16x32_bf16 v[212:215], v[100:103], v[116:119], v[212:215]
v_mfma_f32_16x16x32_bf16 v[208:211], v[100:103], v[112:115], v[208:211]
v_mfma_f32_16x16x32_bf16 v[224:227], v[104:107], v[112:115], v[224:227]
s_add_u32 s72, s69, 15360
buffer_load_dwordx4 v5, s[4:7], s72 offen offset:1024 lds
v_mfma_f32_16x16x32_bf16 v[228:231], v[104:107], v[116:119], v[228:231]
v_mfma_f32_16x16x32_bf16 v[232:235], v[104:107], v[120:123], v[232:235]
v_mfma_f32_16x16x32_bf16 v[236:239], v[104:107], v[124:127], v[236:239]
v_mfma_f32_16x16x32_bf16 v[252:255], v[108:111], v[124:127], v[252:255]
v_mfma_f32_16x16x32_bf16 v[248:251], v[108:111], v[120:123], v[248:251]
s_add_u32 s72, s69, 129024
buffer_load_dwordx4 v4, s[4:7], s72 offen offset:2048 lds
v_mfma_f32_16x16x32_bf16 v[244:247], v[108:111], v[116:119], v[244:247]
v_mfma_f32_16x16x32_bf16 v[240:243], v[108:111], v[112:115], v[240:243]
s_waitcnt lgkmcnt(0)
v_mfma_f32_16x16x32_bf16 v[128:131], v[32:35], v[64:67], v[128:131]
ds_read_b64_tr_b16 v[80:81], v8 offset:40960
ds_read_b64_tr_b16 v[82:83], v8 offset:41984
v_mfma_f32_16x16x32_bf16 v[132:135], v[32:35], v[68:71], v[132:135]
ds_read_b128 v[112:115], v19 offset:32768
ds_read_b128 v[116:119], v19 offset:34816
v_mfma_f32_16x16x32_bf16 v[136:139], v[32:35], v[72:75], v[136:139]
s_add_u32 s72, s69, 144384
buffer_load_dwordx4 v5, s[4:7], s72 offen offset:3072 lds
v_mfma_f32_16x16x32_bf16 v[140:143], v[32:35], v[76:79], v[140:143]
ds_read_b128 v[120:123], v19 offset:36864
ds_read_b128 v[124:127], v19 offset:38912
v_mfma_f32_16x16x32_bf16 v[156:159], v[36:39], v[76:79], v[156:159]
ds_read_b64_tr_b16 v[84:85], v9 offset:40960
ds_read_b64_tr_b16 v[86:87], v9 offset:41984
v_mfma_f32_16x16x32_bf16 v[152:155], v[36:39], v[72:75], v[152:155]
ds_read_b64_tr_b16 v[88:89], v10 offset:40960
v_mfma_f32_16x16x32_bf16 v[148:151], v[36:39], v[68:71], v[148:151]
ds_read_b64_tr_b16 v[90:91], v10 offset:41984
v_mfma_f32_16x16x32_bf16 v[144:147], v[36:39], v[64:67], v[144:147]
s_add_u32 m0, s63, 69632
ds_read_b64_tr_b16 v[92:93], v11 offset:40960
v_mfma_f32_16x16x32_bf16 v[160:163], v[40:43], v[64:67], v[160:163]
s_add_u32 s72, s70, 0
buffer_load_dwordx4 v4, s[4:7], s72 offen lds
v_mfma_f32_16x16x32_bf16 v[164:167], v[40:43], v[68:71], v[164:167]
ds_read_b64_tr_b16 v[94:95], v11 offset:41984
v_mfma_f32_16x16x32_bf16 v[168:171], v[40:43], v[72:75], v[168:171]
ds_read_b64_tr_b16 v[96:97], v12 offset:40960
v_mfma_f32_16x16x32_bf16 v[172:175], v[40:43], v[76:79], v[172:175]
ds_read_b64_tr_b16 v[98:99], v12 offset:41984
v_mfma_f32_16x16x32_bf16 v[188:191], v[44:47], v[76:79], v[188:191]
s_add_u32 s72, s70, 15360
buffer_load_dwordx4 v5, s[4:7], s72 offen offset:1024 lds
v_mfma_f32_16x16x32_bf16 v[184:187], v[44:47], v[72:75], v[184:187]
ds_read_b64_tr_b16 v[100:101], v13 offset:40960
v_mfma_f32_16x16x32_bf16 v[180:183], v[44:47], v[68:71], v[180:183]
ds_read_b64_tr_b16 v[102:103], v13 offset:41984
v_mfma_f32_16x16x32_bf16 v[176:179], v[44:47], v[64:67], v[176:179]
ds_read_b64_tr_b16 v[104:105], v14 offset:40960
v_mfma_f32_16x16x32_bf16 v[192:195], v[48:51], v[64:67], v[192:195]
ds_read_b64_tr_b16 v[106:107], v14 offset:41984
v_mfma_f32_16x16x32_bf16 v[196:199], v[48:51], v[68:71], v[196:199]
s_add_u32 s72, s70, 129024
buffer_load_dwordx4 v4, s[4:7], s72 offen offset:2048 lds
v_mfma_f32_16x16x32_bf16 v[200:203], v[48:51], v[72:75], v[200:203]
ds_read_b64_tr_b16 v[108:109], v15 offset:40960
v_mfma_f32_16x16x32_bf16 v[204:207], v[48:51], v[76:79], v[204:207]
ds_read_b64_tr_b16 v[110:111], v15 offset:41984
v_mfma_f32_16x16x32_bf16 v[220:223], v[52:55], v[76:79], v[220:223]
v_mfma_f32_16x16x32_bf16 v[216:219], v[52:55], v[72:75], v[216:219]
v_mfma_f32_16x16x32_bf16 v[212:215], v[52:55], v[68:71], v[212:215]
s_add_u32 s72, s70, 144384
buffer_load_dwordx4 v5, s[4:7], s72 offen offset:3072 lds
v_mfma_f32_16x16x32_bf16 v[208:211], v[52:55], v[64:67], v[208:211]
v_mfma_f32_16x16x32_bf16 v[224:227], v[56:59], v[64:67], v[224:227]
v_mfma_f32_16x16x32_bf16 v[228:231], v[56:59], v[68:71], v[228:231]
v_mfma_f32_16x16x32_bf16 v[232:235], v[56:59], v[72:75], v[232:235]
v_mfma_f32_16x16x32_bf16 v[236:239], v[56:59], v[76:79], v[236:239]
v_mfma_f32_16x16x32_bf16 v[252:255], v[60:63], v[76:79], v[252:255]
v_mfma_f32_16x16x32_bf16 v[248:251], v[60:63], v[72:75], v[248:251]
v_mfma_f32_16x16x32_bf16 v[244:247], v[60:63], v[68:71], v[244:247]
s_waitcnt vmcnt(13) lgkmcnt(0)
v_mfma_f32_16x16x32_bf16 v[240:243], v[60:63], v[64:67], v[240:243]
s_barrier
v_mfma_f32_16x16x32_bf16 v[128:131], v[80:83], v[112:115], v[128:131]
s_add_u32 s73, s62, 14
s_waitcnt vmcnt(25)
v_cmp_gt_u32 vcc, 8, v3
s_cbranch_vccnz Lspin1
Lback2:
v_mfma_f32_16x16x32_bf16 v[132:135], v[80:83], v[116:119], v[132:135]
s_add_u32 s70, s73, s65
ds_read_b64_tr_b16 v[32:33], v8 offset:0
ds_read_b64_tr_b16 v[34:35], v8 offset:1024
v_mfma_f32_16x16x32_bf16 v[136:139], v[80:83], v[120:123], v[136:139]
s_and_b32 s70, s70, 3
ds_read_b128 v[64:67], v16 offset:0
ds_read_b128 v[68:71], v16 offset:2048
v_mfma_f32_16x16x32_bf16 v[140:143], v[80:83], v[124:127], v[140:143]
s_and_b32 s73, s73, 12
ds_read_b128 v[72:75], v16 offset:4096
ds_read_b128 v[76:79], v16 offset:6144
v_mfma_f32_16x16x32_bf16 v[156:159], v[84:87], v[124:127], v[156:159]
s_or_b32 s73, s73, s70
ds_read_b64_tr_b16 v[36:37], v9 offset:0
ds_read_b64_tr_b16 v[38:39], v9 offset:1024
v_mfma_f32_16x16x32_bf16 v[152:155], v[84:87], v[120:123], v[152:155]
s_lshl_b32 s71, s73, 19
ds_read_b64_tr_b16 v[40:41], v10 offset:0
v_mfma_f32_16x16x32_bf16 v[148:151], v[84:87], v[116:119], v[148:151]
s_add_u32 s71, s71, s66
ds_read_b64_tr_b16 v[42:43], v10 offset:1024
v_mfma_f32_16x16x32_bf16 v[144:147], v[84:87], v[112:115], v[144:147]
s_lshl_b32 s73, s73, 7
ds_read_b64_tr_b16 v[44:45], v11 offset:0
v_mfma_f32_16x16x32_bf16 v[160:163], v[88:91], v[112:115], v[160:163]
s_add_u32 s69, s73, s67
ds_read_b64_tr_b16 v[46:47], v11 offset:1024
v_mfma_f32_16x16x32_bf16 v[164:167], v[88:91], v[116:119], v[164:167]
s_add_u32 s70, s73, s68
ds_read_b64_tr_b16 v[48:49], v12 offset:0
v_mfma_f32_16x16x32_bf16 v[168:171], v[88:91], v[120:123], v[168:171]
s_add_u32 m0, s64, 32768
ds_read_b64_tr_b16 v[50:51], v12 offset:1024
v_mfma_f32_16x16x32_bf16 v[172:175], v[88:91], v[124:127], v[172:175]
s_add_u32 s72, s71, 0
buffer_load_dwordx4 v6, s[12:15], s72 offen lds
v_mfma_f32_16x16x32_bf16 v[188:191], v[92:95], v[124:127], v[188:191]
s_add_u32 s72, s71, 31744
buffer_load_dwordx4 v6, s[12:15], s72 offen offset:1024 lds
v_mfma_f32_16x16x32_bf16 v[184:187], v[92:95], v[120:123], v[184:187]
s_add_u32 s72, s71, 63488
buffer_load_dwordx4 v7, s[12:15], s72 offen offset:2048 lds
v_mfma_f32_16x16x32_bf16 v[180:183], v[92:95], v[116:119], v[180:183]
s_add_u32 s72, s71, 95232
buffer_load_dwordx4 v7, s[12:15], s72 offen offset:3072 lds
v_mfma_f32_16x16x32_bf16 v[176:179], v[92:95], v[112:115], v[176:179]
ds_read_b64_tr_b16 v[52:53], v13 offset:0
v_mfma_f32_16x16x32_bf16 v[192:195], v[96:99], v[112:115], v[192:195]
ds_read_b64_tr_b16 v[54:55], v13 offset:1024
v_mfma_f32_16x16x32_bf16 v[196:199], v[96:99], v[116:119], v[196:199]
ds_read_b64_tr_b16 v[56:57], v14 offset:0
v_mfma_f32_16x16x32_bf16 v[200:203], v[96:99], v[120:123], v[200:203]
ds_read_b64_tr_b16 v[58:59], v14 offset:1024
v_mfma_f32_16x16x32_bf16 v[204:207], v[96:99], v[124:127], v[204:207]
s_add_u32 m0, s63, 98304
ds_read_b64_tr_b16 v[60:61], v15 offset:0
v_mfma_f32_16x16x32_bf16 v[220:223], v[100:103], v[124:127], v[220:223]
s_add_u32 s72, s69, 0
buffer_load_dwordx4 v4, s[4:7], s72 offen lds
v_mfma_f32_16x16x32_bf16 v[216:219], v[100:103], v[120:123], v[216:219]
ds_read_b64_tr_b16 v[62:63], v15 offset:1024
v_mfma_f32_16x16x32_bf16 v[212:215], v[100:103], v[116:119], v[212:215]
v_mfma_f32_16x16x32_bf16 v[208:211], v[100:103], v[112:115], v[208:211]
v_mfma_f32_16x16x32_bf16 v[224:227], v[104:107], v[112:115], v[224:227]
s_add_u32 s72, s69, 15360
buffer_load_dwordx4 v5, s[4:7], s72 offen offset:1024 lds
v_mfma_f32_16x16x32_bf16 v[228:231], v[104:107], v[116:119], v[228:231]
v_mfma_f32_16x16x32_bf16 v[232:235], v[104:107], v[120:123], v[232:235]
v_mfma_f32_16x16x32_bf16 v[236:239], v[104:107], v[124:127], v[236:239]
v_mfma_f32_16x16x32_bf16 v[252:255], v[108:111], v[124:127], v[252:255]
v_mfma_f32_16x16x32_bf16 v[248:251], v[108:111], v[120:123], v[248:251]
s_add_u32 s72, s69, 129024
buffer_load_dwordx4 v4, s[4:7], s72 offen offset:2048 lds
v_mfma_f32_16x16x32_bf16 v[244:247], v[108:111], v[116:119], v[244:247]
v_mfma_f32_16x16x32_bf16 v[240:243], v[108:111], v[112:115], v[240:243]
s_waitcnt lgkmcnt(0)
v_mfma_f32_16x16x32_bf16 v[128:131], v[32:35], v[64:67], v[128:131]
ds_read_b64_tr_b16 v[80:81], v8 offset:8192
ds_read_b64_tr_b16 v[82:83], v8 offset:9216
v_mfma_f32_16x16x32_bf16 v[132:135], v[32:35], v[68:71], v[132:135]
ds_read_b128 v[112:115], v17 offset:0
ds_read_b128 v[116:119], v17 offset:2048
v_mfma_f32_16x16x32_bf16 v[136:139], v[32:35], v[72:75], v[136:139]
s_add_u32 s72, s69, 144384
buffer_load_dwordx4 v5, s[4:7], s72 offen offset:3072 lds
v_mfma_f32_16x16x32_bf16 v[140:143], v[32:35], v[76:79], v[140:143]
ds_read_b128 v[120:123], v17 offset:4096
ds_read_b128 v[124:127], v17 offset:6144
v_mfma_f32_16x16x32_bf16 v[156:159], v[36:39], v[76:79], v[156:159]
ds_read_b64_tr_b16 v[84:85], v9 offset:8192
ds_read_b64_tr_b16 v[86:87], v9 offset:9216
v_mfma_f32_16x16x32_bf16 v[152:155], v[36:39], v[72:75], v[152:155]
ds_read_b64_tr_b16 v[88:89], v10 offset:8192
v_mfma_f32_16x16x32_bf16 v[148:151], v[36:39], v[68:71], v[148:151]
ds_read_b64_tr_b16 v[90:91], v10 offset:9216
v_mfma_f32_16x16x32_bf16 v[144:147], v[36:39], v[64:67], v[144:147]
s_add_u32 m0, s63, 102400
ds_read_b64_tr_b16 v[92:93], v11 offset:8192
v_mfma_f32_16x16x32_bf16 v[160:163], v[40:43], v[64:67], v[160:163]
s_add_u32 s72, s70, 0
buffer_load_dwordx4 v4, s[4:7], s72 offen lds
v_mfma_f32_16x16x32_bf16 v[164:167], v[40:43], v[68:71], v[164:167]
ds_read_b64_tr_b16 v[94:95], v11 offset:9216
v_mfma_f32_16x16x32_bf16 v[168:171], v[40:43], v[72:75], v[168:171]
ds_read_b64_tr_b16 v[96:97], v12 offset:8192
v_mfma_f32_16x16x32_bf16 v[172:175], v[40:43], v[76:79], v[172:175]
ds_read_b64_tr_b16 v[98:99], v12 offset:9216
v_mfma_f32_16x16x32_bf16 v[188:191], v[44:47], v[76:79], v[188:191]
s_add_u32 s72, s70, 15360
buffer_load_dwordx4 v5, s[4:7], s72 offen offset:1024 lds
v_mfma_f32_16x16x32_bf16 v[184:187], v[44:47], v[72:75], v[184:187]
ds_read_b64_tr_b16 v[100:101], v13 offset:8192
v_mfma_f32_16x16x32_bf16 v[180:183], v[44:47], v[68:71], v[180:183]
ds_read_b64_tr_b16 v[102:103], v13 offset:9216
v_mfma_f32_16x16x32_bf16 v[176:179], v[44:47], v[64:67], v[176:179]
ds_read_b64_tr_b16 v[104:105], v14 offset:8192
v_mfma_f32_16x16x32_bf16 v[192:195], v[48:51], v[64:67], v[192:195]
ds_read_b64_tr_b16 v[106:107], v14 offset:9216
v_mfma_f32_16x16x32_bf16 v[196:199], v[48:51], v[68:71], v[196:199]
s_add_u32 s72, s70, 129024
buffer_load_dwordx4 v4, s[4:7], s72 offen offset:2048 lds
v_mfma_f32_16x16x32_bf16 v[200:203], v[48:51], v[72:75], v[200:203]
ds_read_b64_tr_b16 v[108:109], v15 offset:8192
v_mfma_f32_16x16x32_bf16 v[204:207], v[48:51], v[76:79], v[204:207]
ds_read_b64_tr_b16 v[110:111], v15 offset:9216
v_mfma_f32_16x16x32_bf16 v[220:223], v[52:55], v[76:79], v[220:223]
v_mfma_f32_16x16x32_bf16 v[216:219], v[52:55], v[72:75], v[216:219]
v_mfma_f32_16x16x32_bf16 v[212:215], v[52:55], v[68:71], v[212:215]
s_add_u32 s72, s70, 144384
buffer_load_dwordx4 v5, s[4:7], s72 offen offset:3072 lds
v_mfma_f32_16x16x32_bf16 v[208:211], v[52:55], v[64:67], v[208:211]
v_mfma_f32_16x16x32_bf16 v[224:227], v[56:59], v[64:67], v[224:227]
v_mfma_f32_16x16x32_bf16 v[228:231], v[56:59], v[68:71], v[228:231]
v_mfma_f32_16x16x32_bf16 v[232:235], v[56:59], v[72:75], v[232:235]
v_mfma_f32_16x16x32_bf16 v[236:239], v[56:59], v[76:79], v[236:239]
v_mfma_f32_16x16x32_bf16 v[252:255], v[60:63], v[76:79], v[252:255]
v_mfma_f32_16x16x32_bf16 v[248:251], v[60:63], v[72:75], v[248:251]
v_mfma_f32_16x16x32_bf16 v[244:247], v[60:63], v[68:71], v[244:247]
s_waitcnt vmcnt(12) lgkmcnt(0)
v_mfma_f32_16x16x32_bf16 v[240:243], v[60:63], v[64:67], v[240:243]
s_barrier
v_mfma_f32_16x16x32_bf16 v[128:131], v[80:83], v[112:115], v[128:131]
s_add_u32 s73, s62, 15
ds_read_b64_tr_b16 v[32:33], v8 offset:16384
ds_read_b64_tr_b16 v[34:35], v8 offset:17408
v_mfma_f32_16x16x32_bf16 v[132:135], v[80:83], v[116:119], v[132:135]
s_add_u32 s70, s73, s65
ds_read_b128 v[64:67], v18 offset:0
ds_read_b128 v[68:71], v18 offset:2048
v_mfma_f32_16x16x32_bf16 v[136:139], v[80:83], v[120:123], v[136:139]
s_and_b32 s70, s70, 3
ds_read_b128 v[72:75], v18 offset:4096
ds_read_b128 v[76:79], v18 offset:6144
v_mfma_f32_16x16x32_bf16 v[140:143], v[80:83], v[124:127], v[140:143]
s_and_b32 s73, s73, 12
ds_read_b64_tr_b16 v[36:37], v9 offset:16384
ds_read_b64_tr_b16 v[38:39], v9 offset:17408
v_mfma_f32_16x16x32_bf16 v[156:159], v[84:87], v[124:127], v[156:159]
s_or_b32 s73, s73, s70
ds_read_b64_tr_b16 v[40:41], v10 offset:16384
v_mfma_f32_16x16x32_bf16 v[152:155], v[84:87], v[120:123], v[152:155]
s_lshl_b32 s71, s73, 19
ds_read_b64_tr_b16 v[42:43], v10 offset:17408
v_mfma_f32_16x16x32_bf16 v[148:151], v[84:87], v[116:119], v[148:151]
s_add_u32 s71, s71, s66
ds_read_b64_tr_b16 v[44:45], v11 offset:16384
v_mfma_f32_16x16x32_bf16 v[144:147], v[84:87], v[112:115], v[144:147]
s_lshl_b32 s73, s73, 7
ds_read_b64_tr_b16 v[46:47], v11 offset:17408
v_mfma_f32_16x16x32_bf16 v[160:163], v[88:91], v[112:115], v[160:163]
s_add_u32 s69, s73, s67
ds_read_b64_tr_b16 v[48:49], v12 offset:16384
v_mfma_f32_16x16x32_bf16 v[164:167], v[88:91], v[116:119], v[164:167]
s_add_u32 s70, s73, s68
ds_read_b64_tr_b16 v[50:51], v12 offset:17408
v_mfma_f32_16x16x32_bf16 v[168:171], v[88:91], v[120:123], v[168:171]
s_add_u32 m0, s64, 0
ds_read_b64_tr_b16 v[52:53], v13 offset:16384
v_mfma_f32_16x16x32_bf16 v[172:175], v[88:91], v[124:127], v[172:175]
s_add_u32 s72, s71, 0
buffer_load_dwordx4 v6, s[12:15], s72 offen lds
v_mfma_f32_16x16x32_bf16 v[188:191], v[92:95], v[124:127], v[188:191]
s_add_u32 s72, s71, 31744
buffer_load_dwordx4 v6, s[12:15], s72 offen offset:1024 lds
v_mfma_f32_16x16x32_bf16 v[184:187], v[92:95], v[120:123], v[184:187]
s_add_u32 s72, s71, 63488
buffer_load_dwordx4 v7, s[12:15], s72 offen offset:2048 lds
v_mfma_f32_16x16x32_bf16 v[180:183], v[92:95], v[116:119], v[180:183]
s_add_u32 s72, s71, 95232
buffer_load_dwordx4 v7, s[12:15], s72 offen offset:3072 lds
v_mfma_f32_16x16x32_bf16 v[176:179], v[92:95], v[112:115], v[176:179]
s_and_b32 s75, s91, 0xfffffc7f
v_lshrrev_b32 v2, 3, v0
v_lshlrev_b32 v2, 7, v2
v_mfma_f32_16x16x32_bf16 v[192:195], v[96:99], v[112:115], v[192:195]
buffer_load_dword v3, v2, s[44:47], s75 offen sc1
v_mfma_f32_16x16x32_bf16 v[196:199], v[96:99], v[116:119], v[196:199]
ds_read_b64_tr_b16 v[54:55], v13 offset:17408
v_mfma_f32_16x16x32_bf16 v[200:203], v[96:99], v[120:123], v[200:203]
ds_read_b64_tr_b16 v[56:57], v14 offset:16384
v_mfma_f32_16x16x32_bf16 v[204:207], v[96:99], v[124:127], v[204:207]
s_add_u32 m0, s63, 131072
ds_read_b64_tr_b16 v[58:59], v14 offset:17408
v_mfma_f32_16x16x32_bf16 v[220:223], v[100:103], v[124:127], v[220:223]
s_add_u32 s72, s69, 0
buffer_load_dwordx4 v4, s[4:7], s72 offen lds
v_mfma_f32_16x16x32_bf16 v[216:219], v[100:103], v[120:123], v[216:219]
ds_read_b64_tr_b16 v[60:61], v15 offset:16384
v_mfma_f32_16x16x32_bf16 v[212:215], v[100:103], v[116:119], v[212:215]
ds_read_b64_tr_b16 v[62:63], v15 offset:17408
v_mfma_f32_16x16x32_bf16 v[208:211], v[100:103], v[112:115], v[208:211]
v_mfma_f32_16x16x32_bf16 v[224:227], v[104:107], v[112:115], v[224:227]
s_add_u32 s72, s69, 15360
buffer_load_dwordx4 v5, s[4:7], s72 offen offset:1024 lds
v_mfma_f32_16x16x32_bf16 v[228:231], v[104:107], v[116:119], v[228:231]
v_mfma_f32_16x16x32_bf16 v[232:235], v[104:107], v[120:123], v[232:235]
v_mfma_f32_16x16x32_bf16 v[236:239], v[104:107], v[124:127], v[236:239]
v_mfma_f32_16x16x32_bf16 v[252:255], v[108:111], v[124:127], v[252:255]
v_mfma_f32_16x16x32_bf16 v[248:251], v[108:111], v[120:123], v[248:251]
s_add_u32 s72, s69, 129024
buffer_load_dwordx4 v4, s[4:7], s72 offen offset:2048 lds
v_mfma_f32_16x16x32_bf16 v[244:247], v[108:111], v[116:119], v[244:247]
v_mfma_f32_16x16x32_bf16 v[240:243], v[108:111], v[112:115], v[240:243]
s_waitcnt lgkmcnt(0)
v_mfma_f32_16x16x32_bf16 v[128:131], v[32:35], v[64:67], v[128:131]
ds_read_b64_tr_b16 v[80:81], v8 offset:24576
ds_read_b64_tr_b16 v[82:83], v8 offset:25600
v_mfma_f32_16x16x32_bf16 v[132:135], v[32:35], v[68:71], v[132:135]
ds_read_b128 v[112:115], v19 offset:0
ds_read_b128 v[116:119], v19 offset:2048
v_mfma_f32_16x16x32_bf16 v[136:139], v[32:35], v[72:75], v[136:139]
s_add_u32 s72, s69, 144384
buffer_load_dwordx4 v5, s[4:7], s72 offen offset:3072 lds
v_mfma_f32_16x16x32_bf16 v[140:143], v[32:35], v[76:79], v[140:143]
ds_read_b128 v[120:123], v19 offset:4096
ds_read_b128 v[124:127], v19 offset:6144
v_mfma_f32_16x16x32_bf16 v[156:159], v[36:39], v[76:79], v[156:159]
ds_read_b64_tr_b16 v[84:85], v9 offset:24576
ds_read_b64_tr_b16 v[86:87], v9 offset:25600
v_mfma_f32_16x16x32_bf16 v[152:155], v[36:39], v[72:75], v[152:155]
ds_read_b64_tr_b16 v[88:89], v10 offset:24576
v_mfma_f32_16x16x32_bf16 v[148:151], v[36:39], v[68:71], v[148:151]
ds_read_b64_tr_b16 v[90:91], v10 offset:25600
v_mfma_f32_16x16x32_bf16 v[144:147], v[36:39], v[64:67], v[144:147]
s_add_u32 m0, s63, 135168
ds_read_b64_tr_b16 v[92:93], v11 offset:24576
v_mfma_f32_16x16x32_bf16 v[160:163], v[40:43], v[64:67], v[160:163]
s_add_u32 s72, s70, 0
buffer_load_dwordx4 v4, s[4:7], s72 offen lds
v_mfma_f32_16x16x32_bf16 v[164:167], v[40:43], v[68:71], v[164:167]
ds_read_b64_tr_b16 v[94:95], v11 offset:25600
v_mfma_f32_16x16x32_bf16 v[168:171], v[40:43], v[72:75], v[168:171]
ds_read_b64_tr_b16 v[96:97], v12 offset:24576
v_mfma_f32_16x16x32_bf16 v[172:175], v[40:43], v[76:79], v[172:175]
ds_read_b64_tr_b16 v[98:99], v12 offset:25600
v_mfma_f32_16x16x32_bf16 v[188:191], v[44:47], v[76:79], v[188:191]
s_add_u32 s72, s70, 15360
buffer_load_dwordx4 v5, s[4:7], s72 offen offset:1024 lds
v_mfma_f32_16x16x32_bf16 v[184:187], v[44:47], v[72:75], v[184:187]
ds_read_b64_tr_b16 v[100:101], v13 offset:24576
v_mfma_f32_16x16x32_bf16 v[180:183], v[44:47], v[68:71], v[180:183]
ds_read_b64_tr_b16 v[102:103], v13 offset:25600
v_mfma_f32_16x16x32_bf16 v[176:179], v[44:47], v[64:67], v[176:179]
ds_read_b64_tr_b16 v[104:105], v14 offset:24576
v_mfma_f32_16x16x32_bf16 v[192:195], v[48:51], v[64:67], v[192:195]
ds_read_b64_tr_b16 v[106:107], v14 offset:25600
v_mfma_f32_16x16x32_bf16 v[196:199], v[48:51], v[68:71], v[196:199]
s_add_u32 s72, s70, 129024
buffer_load_dwordx4 v4, s[4:7], s72 offen offset:2048 lds
v_mfma_f32_16x16x32_bf16 v[200:203], v[48:51], v[72:75], v[200:203]
ds_read_b64_tr_b16 v[108:109], v15 offset:24576
v_mfma_f32_16x16x32_bf16 v[204:207], v[48:51], v[76:79], v[204:207]
ds_read_b64_tr_b16 v[110:111], v15 offset:25600
v_mfma_f32_16x16x32_bf16 v[220:223], v[52:55], v[76:79], v[220:223]
v_mfma_f32_16x16x32_bf16 v[216:219], v[52:55], v[72:75], v[216:219]
v_mfma_f32_16x16x32_bf16 v[212:215], v[52:55], v[68:71], v[212:215]
s_add_u32 s72, s70, 144384
buffer_load_dwordx4 v5, s[4:7], s72 offen offset:3072 lds
v_mfma_f32_16x16x32_bf16 v[208:211], v[52:55], v[64:67], v[208:211]
v_mfma_f32_16x16x32_bf16 v[224:227], v[56:59], v[64:67], v[224:227]
v_mfma_f32_16x16x32_bf16 v[228:231], v[56:59], v[68:71], v[228:231]
v_mfma_f32_16x16x32_bf16 v[232:235], v[56:59], v[72:75], v[232:235]
v_mfma_f32_16x16x32_bf16 v[236:239], v[56:59], v[76:79], v[236:239]
v_mfma_f32_16x16x32_bf16 v[252:255], v[60:63], v[76:79], v[252:255]
v_mfma_f32_16x16x32_bf16 v[248:251], v[60:63], v[72:75], v[248:251]
v_mfma_f32_16x16x32_bf16 v[244:247], v[60:63], v[68:71], v[244:247]
s_waitcnt vmcnt(13) lgkmcnt(0)
v_mfma_f32_16x16x32_bf16 v[240:243], v[60:63], v[64:67], v[240:243]
s_barrier
v_mfma_f32_16x16x32_bf16 v[128:131], v[80:83], v[112:115], v[128:131]
s_waitcnt vmcnt(8)
v_cmp_gt_u32 vcc, 1, v3
s_cbranch_vccnz Lspin4
Lback5:
v_mfma_f32_16x16x32_bf16 v[132:135], v[80:83], v[116:119], v[132:135]
s_add_u32 m0, s64, 49152
ds_read_b64_tr_b16 v[32:33], v8 offset:32768
ds_read_b64_tr_b16 v[34:35], v8 offset:33792
v_mfma_f32_16x16x32_bf16 v[136:139], v[80:83], v[120:123], v[136:139]
s_add_u32 s72, s81, 16384
buffer_load_dwordx4 v1, s[44:47], s72 offen sc1 lds
v_mfma_f32_16x16x32_bf16 v[140:143], v[80:83], v[124:127], v[140:143]
ds_read_b128 v[64:67], v18 offset:32768
ds_read_b128 v[68:71], v18 offset:34816
v_mfma_f32_16x16x32_bf16 v[156:159], v[84:87], v[124:127], v[156:159]
ds_read_b128 v[72:75], v18 offset:36864
ds_read_b128 v[76:79], v18 offset:38912
v_mfma_f32_16x16x32_bf16 v[152:155], v[84:87], v[120:123], v[152:155]
buffer_load_dwordx4 v1, s[44:47], s72 offen offset:1024 sc1 lds
v_mfma_f32_16x16x32_bf16 v[148:151], v[84:87], v[116:119], v[148:151]
ds_read_b64_tr_b16 v[36:37], v9 offset:32768
ds_read_b64_tr_b16 v[38:39], v9 offset:33792
v_mfma_f32_16x16x32_bf16 v[144:147], v[84:87], v[112:115], v[144:147]
ds_read_b64_tr_b16 v[40:41], v10 offset:32768
v_mfma_f32_16x16x32_bf16 v[160:163], v[88:91], v[112:115], v[160:163]
ds_read_b64_tr_b16 v[42:43], v10 offset:33792
v_mfma_f32_16x16x32_bf16 v[164:167], v[88:91], v[116:119], v[164:167]
ds_read_b64_tr_b16 v[44:45], v11 offset:32768
v_mfma_f32_16x16x32_bf16 v[168:171], v[88:91], v[120:123], v[168:171]
buffer_load_dwordx4 v1, s[44:47], s72 offen offset:2048 sc1 lds
v_mfma_f32_16x16x32_bf16 v[172:175], v[88:91], v[124:127], v[172:175]
ds_read_b64_tr_b16 v[46:47], v11 offset:33792
v_mfma_f32_16x16x32_bf16 v[188:191], v[92:95], v[124:127], v[188:191]
ds_read_b64_tr_b16 v[48:49], v12 offset:32768
v_mfma_f32_16x16x32_bf16 v[184:187], v[92:95], v[120:123], v[184:187]
ds_read_b64_tr_b16 v[50:51], v12 offset:33792
v_mfma_f32_16x16x32_bf16 v[180:183], v[92:95], v[116:119], v[180:183]
ds_read_b64_tr_b16 v[52:53], v13 offset:32768
v_mfma_f32_16x16x32_bf16 v[176:179], v[92:95], v[112:115], v[176:179]
buffer_load_dwordx4 v1, s[44:47], s72 offen offset:3072 sc1 lds
v_mfma_f32_16x16x32_bf16 v[192:195], v[96:99], v[112:115], v[192:195]
ds_read_b64_tr_b16 v[54:55], v13 offset:33792
v_mfma_f32_16x16x32_bf16 v[196:199], v[96:99], v[116:119], v[196:199]
ds_read_b64_tr_b16 v[56:57], v14 offset:32768
v_mfma_f32_16x16x32_bf16 v[200:203], v[96:99], v[120:123], v[200:203]
ds_read_b64_tr_b16 v[58:59], v14 offset:33792
v_mfma_f32_16x16x32_bf16 v[204:207], v[96:99], v[124:127], v[204:207]
ds_read_b64_tr_b16 v[60:61], v15 offset:32768
v_mfma_f32_16x16x32_bf16 v[220:223], v[100:103], v[124:127], v[220:223]
s_add_u32 s81, s81, 0x8000
ds_read_b64_tr_b16 v[62:63], v15 offset:33792
v_mfma_f32_16x16x32_bf16 v[216:219], v[100:103], v[120:123], v[216:219]
s_add_u32 m0, s64, 81920
v_mfma_f32_16x16x32_bf16 v[212:215], v[100:103], v[116:119], v[212:215]
s_add_u32 s72, s81, 16384
buffer_load_dwordx4 v1, s[44:47], s72 offen sc1 lds
v_mfma_f32_16x16x32_bf16 v[208:211], v[100:103], v[112:115], v[208:211]
v_mfma_f32_16x16x32_bf16 v[224:227], v[104:107], v[112:115], v[224:227]
v_mfma_f32_16x16x32_bf16 v[228:231], v[104:107], v[116:119], v[228:231]
buffer_load_dwordx4 v1, s[44:47], s72 offen offset:1024 sc1 lds
v_mfma_f32_16x16x32_bf16 v[232:235], v[104:107], v[120:123], v[232:235]
v_mfma_f32_16x16x32_bf16 v[236:239], v[104:107], v[124:127], v[236:239]
v_mfma_f32_16x16x32_bf16 v[252:255], v[108:111], v[124:127], v[252:255]
v_mfma_f32_16x16x32_bf16 v[248:251], v[108:111], v[120:123], v[248:251]
v_mfma_f32_16x16x32_bf16 v[244:247], v[108:111], v[116:119], v[244:247]
buffer_load_dwordx4 v1, s[44:47], s72 offen offset:2048 sc1 lds
v_mfma_f32_16x16x32_bf16 v[240:243], v[108:111], v[112:115], v[240:243]
s_waitcnt lgkmcnt(0)
v_mfma_f32_16x16x32_bf16 v[128:131], v[32:35], v[64:67], v[128:131]
ds_read_b64_tr_b16 v[80:81], v8 offset:40960
ds_read_b64_tr_b16 v[82:83], v8 offset:41984
v_mfma_f32_16x16x32_bf16 v[132:135], v[32:35], v[68:71], v[132:135]
ds_read_b128 v[112:115], v19 offset:32768
ds_read_b128 v[116:119], v19 offset:34816
v_mfma_f32_16x16x32_bf16 v[136:139], v[32:35], v[72:75], v[136:139]
buffer_load_dwordx4 v1, s[44:47], s72 offen offset:3072 sc1 lds
v_mfma_f32_16x16x32_bf16 v[140:143], v[32:35], v[76:79], v[140:143]
ds_read_b128 v[120:123], v19 offset:36864
ds_read_b128 v[124:127], v19 offset:38912
v_mfma_f32_16x16x32_bf16 v[156:159], v[36:39], v[76:79], v[156:159]
ds_read_b64_tr_b16 v[84:85], v9 offset:40960
ds_read_b64_tr_b16 v[86:87], v9 offset:41984
v_mfma_f32_16x16x32_bf16 v[152:155], v[36:39], v[72:75], v[152:155]
ds_read_b64_tr_b16 v[88:89], v10 offset:40960
v_mfma_f32_16x16x32_bf16 v[148:151], v[36:39], v[68:71], v[148:151]
ds_read_b64_tr_b16 v[90:91], v10 offset:41984
v_mfma_f32_16x16x32_bf16 v[144:147], v[36:39], v[64:67], v[144:147]
s_add_u32 m0, s64, 65536
ds_read_b64_tr_b16 v[92:93], v11 offset:40960
v_mfma_f32_16x16x32_bf16 v[160:163], v[40:43], v[64:67], v[160:163]
s_add_u32 s72, s81, 0
buffer_load_dwordx4 v1, s[44:47], s72 offen sc1 lds
v_mfma_f32_16x16x32_bf16 v[164:167], v[40:43], v[68:71], v[164:167]
ds_read_b64_tr_b16 v[94:95], v11 offset:41984
v_mfma_f32_16x16x32_bf16 v[168:171], v[40:43], v[72:75], v[168:171]
ds_read_b64_tr_b16 v[96:97], v12 offset:40960
v_mfma_f32_16x16x32_bf16 v[172:175], v[40:43], v[76:79], v[172:175]
ds_read_b64_tr_b16 v[98:99], v12 offset:41984
v_mfma_f32_16x16x32_bf16 v[188:191], v[44:47], v[76:79], v[188:191]
buffer_load_dwordx4 v1, s[44:47], s72 offen offset:1024 sc1 lds
v_mfma_f32_16x16x32_bf16 v[184:187], v[44:47], v[72:75], v[184:187]
ds_read_b64_tr_b16 v[100:101], v13 offset:40960
v_mfma_f32_16x16x32_bf16 v[180:183], v[44:47], v[68:71], v[180:183]
ds_read_b64_tr_b16 v[102:103], v13 offset:41984
v_mfma_f32_16x16x32_bf16 v[176:179], v[44:47], v[64:67], v[176:179]
ds_read_b64_tr_b16 v[104:105], v14 offset:40960
v_mfma_f32_16x16x32_bf16 v[192:195], v[48:51], v[64:67], v[192:195]
ds_read_b64_tr_b16 v[106:107], v14 offset:41984
v_mfma_f32_16x16x32_bf16 v[196:199], v[48:51], v[68:71], v[196:199]
buffer_load_dwordx4 v1, s[44:47], s72 offen offset:2048 sc1 lds
v_mfma_f32_16x16x32_bf16 v[200:203], v[48:51], v[72:75], v[200:203]
ds_read_b64_tr_b16 v[108:109], v15 offset:40960
v_mfma_f32_16x16x32_bf16 v[204:207], v[48:51], v[76:79], v[204:207]
ds_read_b64_tr_b16 v[110:111], v15 offset:41984
v_mfma_f32_16x16x32_bf16 v[220:223], v[52:55], v[76:79], v[220:223]
v_mfma_f32_16x16x32_bf16 v[216:219], v[52:55], v[72:75], v[216:219]
v_mfma_f32_16x16x32_bf16 v[212:215], v[52:55], v[68:71], v[212:215]
buffer_load_dwordx4 v1, s[44:47], s72 offen offset:3072 sc1 lds
v_mfma_f32_16x16x32_bf16 v[208:211], v[52:55], v[64:67], v[208:211]
v_mfma_f32_16x16x32_bf16 v[224:227], v[56:59], v[64:67], v[224:227]
v_mfma_f32_16x16x32_bf16 v[228:231], v[56:59], v[68:71], v[228:231]
v_mfma_f32_16x16x32_bf16 v[232:235], v[56:59], v[72:75], v[232:235]
v_mfma_f32_16x16x32_bf16 v[236:239], v[56:59], v[76:79], v[236:239]
v_mfma_f32_16x16x32_bf16 v[252:255], v[60:63], v[76:79], v[252:255]
v_mfma_f32_16x16x32_bf16 v[248:251], v[60:63], v[72:75], v[248:251]
v_mfma_f32_16x16x32_bf16 v[244:247], v[60:63], v[68:71], v[244:247]
s_waitcnt vmcnt(12) lgkmcnt(0)
v_mfma_f32_16x16x32_bf16 v[240:243], v[60:63], v[64:67], v[240:243]
s_barrier
v_mfma_f32_16x16x32_bf16 v[128:131], v[80:83], v[112:115], v[128:131]
s_add_u32 s81, s81, 0x8000
ds_read_b64_tr_b16 v[32:33], v8 offset:0
ds_read_b64_tr_b16 v[34:35], v8 offset:1024
v_mfma_f32_16x16x32_bf16 v[132:135], v[80:83], v[116:119], v[132:135]
s_add_u32 m0, s64, 114688
ds_read_b128 v[64:67], v16 offset:0
ds_read_b128 v[68:71], v16 offset:2048
v_mfma_f32_16x16x32_bf16 v[136:139], v[80:83], v[120:123], v[136:139]
s_add_u32 s72, s81, 16384
buffer_load_dwordx4 v1, s[44:47], s72 offen sc1 lds
v_mfma_f32_16x16x32_bf16 v[140:143], v[80:83], v[124:127], v[140:143]
ds_read_b128 v[72:75], v16 offset:4096
ds_read_b128 v[76:79], v16 offset:6144
v_mfma_f32_16x16x32_bf16 v[156:159], v[84:87], v[124:127], v[156:159]
ds_read_b64_tr_b16 v[36:37], v9 offset:0
ds_read_b64_tr_b16 v[38:39], v9 offset:1024
v_mfma_f32_16x16x32_bf16 v[152:155], v[84:87], v[120:123], v[152:155]
ds_read_b64_tr_b16 v[40:41], v10 offset:0
v_mfma_f32_16x16x32_bf16 v[148:151], v[84:87], v[116:119], v[148:151]
buffer_load_dwordx4 v1, s[44:47], s72 offen offset:1024 sc1 lds
v_mfma_f32_16x16x32_bf16 v[144:147], v[84:87], v[112:115], v[144:147]
ds_read_b64_tr_b16 v[42:43], v10 offset:1024
v_mfma_f32_16x16x32_bf16 v[160:163], v[88:91], v[112:115], v[160:163]
ds_read_b64_tr_b16 v[44:45], v11 offset:0
v_mfma_f32_16x16x32_bf16 v[164:167], v[88:91], v[116:119], v[164:167]
ds_read_b64_tr_b16 v[46:47], v11 offset:1024
v_mfma_f32_16x16x32_bf16 v[168:171], v[88:91], v[120:123], v[168:171]
ds_read_b64_tr_b16 v[48:49], v12 offset:0
v_mfma_f32_16x16x32_bf16 v[172:175], v[88:91], v[124:127], v[172:175]
ds_read_b64_tr_b16 v[50:51], v12 offset:1024
v_mfma_f32_16x16x32_bf16 v[188:191], v[92:95], v[124:127], v[188:191]
ds_read_b64_tr_b16 v[52:53], v13 offset:0
v_mfma_f32_16x16x32_bf16 v[184:187], v[92:95], v[120:123], v[184:187]
buffer_load_dwordx4 v1, s[44:47], s72 offen offset:2048 sc1 lds
v_mfma_f32_16x16x32_bf16 v[180:183], v[92:95], v[116:119], v[180:183]
ds_read_b64_tr_b16 v[54:55], v13 offset:1024
v_mfma_f32_16x16x32_bf16 v[176:179], v[92:95], v[112:115], v[176:179]
ds_read_b64_tr_b16 v[56:57], v14 offset:0
v_mfma_f32_16x16x32_bf16 v[192:195], v[96:99], v[112:115], v[192:195]
ds_read_b64_tr_b16 v[58:59], v14 offset:1024
v_mfma_f32_16x16x32_bf16 v[196:199], v[96:99], v[116:119], v[196:199]
ds_read_b64_tr_b16 v[60:61], v15 offset:0
v_mfma_f32_16x16x32_bf16 v[200:203], v[96:99], v[120:123], v[200:203]
ds_read_b64_tr_b16 v[62:63], v15 offset:1024
v_mfma_f32_16x16x32_bf16 v[204:207], v[96:99], v[124:127], v[204:207]
buffer_load_dwordx4 v1, s[44:47], s72 offen offset:3072 sc1 lds
v_mfma_f32_16x16x32_bf16 v[220:223], v[100:103], v[124:127], v[220:223]
v_mfma_f32_16x16x32_bf16 v[216:219], v[100:103], v[120:123], v[216:219]
v_mfma_f32_16x16x32_bf16 v[212:215], v[100:103], v[116:119], v[212:215]
v_mfma_f32_16x16x32_bf16 v[208:211], v[100:103], v[112:115], v[208:211]
v_mfma_f32_16x16x32_bf16 v[224:227], v[104:107], v[112:115], v[224:227]
v_mfma_f32_16x16x32_bf16 v[228:231], v[104:107], v[116:119], v[228:231]
v_mfma_f32_16x16x32_bf16 v[232:235], v[104:107], v[120:123], v[232:235]
s_add_u32 m0, s64, 98304
v_mfma_f32_16x16x32_bf16 v[236:239], v[104:107], v[124:127], v[236:239]
s_add_u32 s72, s81, 0
buffer_load_dwordx4 v1, s[44:47], s72 offen sc1 lds
v_mfma_f32_16x16x32_bf16 v[252:255], v[108:111], v[124:127], v[252:255]
v_mfma_f32_16x16x32_bf16 v[248:251], v[108:111], v[120:123], v[248:251]
v_mfma_f32_16x16x32_bf16 v[244:247], v[108:111], v[116:119], v[244:247]
v_mfma_f32_16x16x32_bf16 v[240:243], v[108:111], v[112:115], v[240:243]
s_waitcnt lgkmcnt(0)
v_mfma_f32_16x16x32_bf16 v[128:131], v[32:35], v[64:67], v[128:131]
buffer_load_dwordx4 v1, s[44:47], s72 offen offset:1024 sc1 lds
v_mfma_f32_16x16x32_bf16 v[132:135], v[32:35], v[68:71], v[132:135]
ds_read_b64_tr_b16 v[80:81], v8 offset:8192
v_add_u32 v2, 0x8000, v1
v_mfma_f32_16x16x32_bf16 v[136:139], v[32:35], v[72:75], v[136:139]
ds_read_b64_tr_b16 v[82:83], v8 offset:9216
ds_read_b128 v[112:115], v17 offset:0
v_mfma_f32_16x16x32_bf16 v[140:143], v[32:35], v[76:79], v[140:143]
ds_read_b128 v[116:119], v17 offset:2048
ds_read_b128 v[120:123], v17 offset:4096
v_mfma_f32_16x16x32_bf16 v[156:159], v[36:39], v[76:79], v[156:159]
ds_read_b128 v[124:127], v17 offset:6144
ds_read_b64_tr_b16 v[84:85], v9 offset:8192
v_mfma_f32_16x16x32_bf16 v[152:155], v[36:39], v[72:75], v[152:155]
ds_read_b64_tr_b16 v[86:87], v9 offset:9216
v_mfma_f32_16x16x32_bf16 v[148:151], v[36:39], v[68:71], v[148:151]
ds_read_b64_tr_b16 v[88:89], v10 offset:8192
v_mfma_f32_16x16x32_bf16 v[144:147], v[36:39], v[64:67], v[144:147]
buffer_load_dwordx4 v1, s[44:47], s72 offen offset:2048 sc1 lds
v_mfma_f32_16x16x32_bf16 v[160:163], v[40:43], v[64:67], v[160:163]
ds_read_b64_tr_b16 v[90:91], v10 offset:9216
v_mfma_f32_16x16x32_bf16 v[164:167], v[40:43], v[68:71], v[164:167]
ds_read_b64_tr_b16 v[92:93], v11 offset:8192
v_mfma_f32_16x16x32_bf16 v[168:171], v[40:43], v[72:75], v[168:171]
ds_read_b64_tr_b16 v[94:95], v11 offset:9216
v_mfma_f32_16x16x32_bf16 v[172:175], v[40:43], v[76:79], v[172:175]
ds_read_b64_tr_b16 v[96:97], v12 offset:8192
v_mfma_f32_16x16x32_bf16 v[188:191], v[44:47], v[76:79], v[188:191]
ds_read_b64_tr_b16 v[98:99], v12 offset:9216
v_mfma_f32_16x16x32_bf16 v[184:187], v[44:47], v[72:75], v[184:187]
buffer_load_dwordx4 v1, s[44:47], s72 offen offset:3072 sc1 lds
v_mfma_f32_16x16x32_bf16 v[180:183], v[44:47], v[68:71], v[180:183]
ds_read_b64_tr_b16 v[100:101], v13 offset:8192
v_mfma_f32_16x16x32_bf16 v[176:179], v[44:47], v[64:67], v[176:179]
ds_read_b64_tr_b16 v[102:103], v13 offset:9216
v_mfma_f32_16x16x32_bf16 v[192:195], v[48:51], v[64:67], v[192:195]
ds_read_b64_tr_b16 v[104:105], v14 offset:8192
v_mfma_f32_16x16x32_bf16 v[196:199], v[48:51], v[68:71], v[196:199]
ds_read_b64_tr_b16 v[106:107], v14 offset:9216
v_mfma_f32_16x16x32_bf16 v[200:203], v[48:51], v[72:75], v[200:203]
ds_read_b64_tr_b16 v[108:109], v15 offset:8192
v_mfma_f32_16x16x32_bf16 v[204:207], v[48:51], v[76:79], v[204:207]
ds_read_b64_tr_b16 v[110:111], v15 offset:9216
v_mfma_f32_16x16x32_bf16 v[220:223], v[52:55], v[76:79], v[220:223]
v_lshrrev_b32 v3, 1, v0
v_lshlrev_b32 v3, 7, v3
v_mfma_f32_16x16x32_bf16 v[216:219], v[52:55], v[72:75], v[216:219]
buffer_load_dword v4, v3, s[36:39], s93 offen
v_mfma_f32_16x16x32_bf16 v[212:215], v[52:55], v[68:71], v[212:215]
v_mfma_f32_16x16x32_bf16 v[208:211], v[52:55], v[64:67], v[208:211]
v_mfma_f32_16x16x32_bf16 v[224:227], v[56:59], v[64:67], v[224:227]
v_mfma_f32_16x16x32_bf16 v[228:231], v[56:59], v[68:71], v[228:231]
v_mfma_f32_16x16x32_bf16 v[232:235], v[56:59], v[72:75], v[232:235]
v_mfma_f32_16x16x32_bf16 v[236:239], v[56:59], v[76:79], v[236:239]
v_mfma_f32_16x16x32_bf16 v[252:255], v[60:63], v[76:79], v[252:255]
v_mfma_f32_16x16x32_bf16 v[248:251], v[60:63], v[72:75], v[248:251]
v_mfma_f32_16x16x32_bf16 v[244:247], v[60:63], v[68:71], v[244:247]
s_waitcnt vmcnt(17) lgkmcnt(0)
v_mfma_f32_16x16x32_bf16 v[240:243], v[60:63], v[64:67], v[240:243]
s_barrier
v_mfma_f32_16x16x32_bf16 v[128:131], v[80:83], v[112:115], v[128:131]
ds_read_b128 a[128:131], v2 offset:16384
v_mfma_f32_16x16x32_bf16 v[132:135], v[80:83], v[116:119], v[132:135]
ds_read_b128 a[132:135], v2 offset:17408
v_mfma_f32_16x16x32_bf16 v[136:139], v[80:83], v[120:123], v[136:139]
ds_read_b128 a[136:139], v2 offset:18432
v_mfma_f32_16x16x32_bf16 v[140:143], v[80:83], v[124:127], v[140:143]
ds_read_b128 a[140:143], v2 offset:19456
v_mfma_f32_16x16x32_bf16 v[156:159], v[84:87], v[124:127], v[156:159]
ds_read_b128 a[144:147], v2 offset:20480
v_mfma_f32_16x16x32_bf16 v[152:155], v[84:87], v[120:123], v[152:155]
ds_read_b128 a[148:151], v2 offset:21504
v_mfma_f32_16x16x32_bf16 v[148:151], v[84:87], v[116:119], v[148:151]
ds_read_b128 a[152:155], v2 offset:22528
v_mfma_f32_16x16x32_bf16 v[144:147], v[84:87], v[112:115], v[144:147]
ds_read_b128 a[156:159], v2 offset:23552
v_mfma_f32_16x16x32_bf16 v[160:163], v[88:91], v[112:115], v[160:163]
v_mfma_f32_16x16x32_bf16 v[164:167], v[88:91], v[116:119], v[164:167]
v_mfma_f32_16x16x32_bf16 v[168:171], v[88:91], v[120:123], v[168:171]
v_mfma_f32_16x16x32_bf16 v[172:175], v[88:91], v[124:127], v[172:175]
v_mfma_f32_16x16x32_bf16 v[188:191], v[92:95], v[124:127], v[188:191]
v_cvt_pk_bf16_f32 v64, v140, v141
v_cvt_pk_bf16_f32 v65, v142, v143
v_mfma_f32_16x16x32_bf16 v[184:187], v[92:95], v[120:123], v[184:187]
v_cvt_pk_bf16_f32 v66, v156, v157
v_cvt_pk_bf16_f32 v67, v158, v159
v_mfma_f32_16x16x32_bf16 v[180:183], v[92:95], v[116:119], v[180:183]
v_cvt_pk_bf16_f32 v48, v136, v137
v_cvt_pk_bf16_f32 v49, v138, v139
v_mfma_f32_16x16x32_bf16 v[176:179], v[92:95], v[112:115], v[176:179]
v_cvt_pk_bf16_f32 v50, v152, v153
v_cvt_pk_bf16_f32 v51, v154, v155
v_mfma_f32_16x16x32_bf16 v[192:195], v[96:99], v[112:115], v[192:195]
v_cvt_pk_bf16_f32 v32, v132, v133
v_cvt_pk_bf16_f32 v33, v134, v135
v_mfma_f32_16x16x32_bf16 v[196:199], v[96:99], v[116:119], v[196:199]
v_cvt_pk_bf16_f32 v34, v148, v149
v_cvt_pk_bf16_f32 v35, v150, v151
v_mfma_f32_16x16x32_bf16 v[200:203], v[96:99], v[120:123], v[200:203]
v_cvt_pk_bf16_f32 v16, v128, v129
v_cvt_pk_bf16_f32 v17, v130, v131
v_mfma_f32_16x16x32_bf16 v[204:207], v[96:99], v[124:127], v[204:207]
v_cvt_pk_bf16_f32 v18, v144, v145
v_cvt_pk_bf16_f32 v19, v146, v147
v_mfma_f32_16x16x32_bf16 v[220:223], v[100:103], v[124:127], v[220:223]
v_cvt_pk_bf16_f32 v68, v172, v173
v_cvt_pk_bf16_f32 v69, v174, v175
v_mfma_f32_16x16x32_bf16 v[216:219], v[100:103], v[120:123], v[216:219]
v_cvt_pk_bf16_f32 v70, v188, v189
v_cvt_pk_bf16_f32 v71, v190, v191
v_mfma_f32_16x16x32_bf16 v[212:215], v[100:103], v[116:119], v[212:215]
v_cvt_pk_bf16_f32 v52, v168, v169
v_cvt_pk_bf16_f32 v53, v170, v171
v_mfma_f32_16x16x32_bf16 v[208:211], v[100:103], v[112:115], v[208:211]
v_cvt_pk_bf16_f32 v54, v184, v185
v_cvt_pk_bf16_f32 v55, v186, v187
v_mfma_f32_16x16x32_bf16 v[224:227], v[104:107], v[112:115], v[224:227]
v_cvt_pk_bf16_f32 v36, v164, v165
v_cvt_pk_bf16_f32 v37, v166, v167
v_mfma_f32_16x16x32_bf16 v[228:231], v[104:107], v[116:119], v[228:231]
v_cvt_pk_bf16_f32 v38, v180, v181
v_cvt_pk_bf16_f32 v39, v182, v183
v_mfma_f32_16x16x32_bf16 v[232:235], v[104:107], v[120:123], v[232:235]
v_cvt_pk_bf16_f32 v20, v160, v161
v_cvt_pk_bf16_f32 v21, v162, v163
v_mfma_f32_16x16x32_bf16 v[236:239], v[104:107], v[124:127], v[236:239]
v_cvt_pk_bf16_f32 v22, v176, v177
v_cvt_pk_bf16_f32 v23, v178, v179
v_mfma_f32_16x16x32_bf16 v[252:255], v[108:111], v[124:127], v[252:255]
v_cvt_pk_bf16_f32 v72, v204, v205
v_cvt_pk_bf16_f32 v73, v206, v207
v_mfma_f32_16x16x32_bf16 v[248:251], v[108:111], v[120:123], v[248:251]
v_cvt_pk_bf16_f32 v74, v220, v221
v_cvt_pk_bf16_f32 v75, v222, v223
v_mfma_f32_16x16x32_bf16 v[244:247], v[108:111], v[116:119], v[244:247]
v_cvt_pk_bf16_f32 v56, v200, v201
v_cvt_pk_bf16_f32 v57, v202, v203
v_mfma_f32_16x16x32_bf16 v[240:243], v[108:111], v[112:115], v[240:243]
v_cvt_pk_bf16_f32 v58, v216, v217
v_cvt_pk_bf16_f32 v59, v218, v219
v_cvt_pk_bf16_f32 v40, v196, v197
v_cvt_pk_bf16_f32 v41, v198, v199
v_cvt_pk_bf16_f32 v42, v212, v213
v_cvt_pk_bf16_f32 v43, v214, v215
v_cvt_pk_bf16_f32 v24, v192, v193
v_cvt_pk_bf16_f32 v25, v194, v195
v_cvt_pk_bf16_f32 v26, v208, v209
v_cvt_pk_bf16_f32 v27, v210, v211
v_cvt_pk_bf16_f32 v76, v236, v237
v_cvt_pk_bf16_f32 v77, v238, v239
v_cvt_pk_bf16_f32 v78, v252, v253
v_cvt_pk_bf16_f32 v79, v254, v255
v_cvt_pk_bf16_f32 v60, v232, v233
v_cvt_pk_bf16_f32 v61, v234, v235
v_cvt_pk_bf16_f32 v62, v248, v249
v_cvt_pk_bf16_f32 v63, v250, v251
v_cvt_pk_bf16_f32 v44, v228, v229
v_cvt_pk_bf16_f32 v45, v230, v231
v_cvt_pk_bf16_f32 v46, v244, v245
v_cvt_pk_bf16_f32 v47, v246, v247
v_cvt_pk_bf16_f32 v28, v224, v225
v_cvt_pk_bf16_f32 v29, v226, v227
v_cvt_pk_bf16_f32 v30, v240, v241
v_cvt_pk_bf16_f32 v31, v242, v243
v_mov_b32 v124, 0xff800000
v_mov_b32 v125, 0xff800000
v_mov_b32 v126, 0xff800000
v_mov_b32 v127, 0xff800000
s_lshl_b32 s84, s60, 2
s_add_u32 s84, s84, s58
s_mov_b32 s86, 0
s_add_u32 s61, s65, s60
s_and_b32 s73, s60, 1
s_lshl_b32 s73, s73, 16
s_add_u32 s77, s73, s64
s_xor_b32 s73, s73, 0x10000
s_mov_b32 s92, s73
s_mul_i32 s62, s58, 4608
s_add_u32 s62, s62, 143104
s_add_u32 s73, s73, 49920
s_cmp_eq_u32 s58, 0
s_cselect_b32 s62, s73, s62
Lattn:
s_mov_b32 s82, 0x10000
s_waitcnt lgkmcnt(0)
v_mfma_f32_16x16x32_bf16 v[136:139], a[128:131], v[48:51], 0
ds_read_b128 a[160:163], v2 offset:24576
v_lshrrev_b32 v240, 4, v0
v_mfma_f32_16x16x32_bf16 v[136:139], a[132:135], v[52:55], v[136:139]
ds_read_b128 a[164:167], v2 offset:25600
v_and_b32 v241, 15, v0
v_mfma_f32_16x16x32_bf16 v[136:139], a[136:139], v[56:59], v[136:139]
ds_read_b128 a[168:171], v2 offset:26624
v_lshlrev_b32 v240, 2, v240
v_mfma_f32_16x16x32_bf16 v[136:139], a[140:143], v[60:63], v[136:139]
ds_read_b128 a[172:175], v2 offset:27648
v_sub_u32 v240, v241, v240
v_mfma_f32_16x16x32_bf16 v[140:143], a[140:143], v[76:79], 0
ds_read_b128 a[176:179], v2 offset:28672
v_mov_b32 v112, 0xff800000
v_mfma_f32_16x16x32_bf16 v[140:143], a[136:139], v[72:75], v[140:143]
ds_read_b128 a[180:183], v2 offset:29696
v_mov_b32 v113, 0xff800000
v_mfma_f32_16x16x32_bf16 v[140:143], a[132:135], v[68:71], v[140:143]
ds_read_b128 a[184:187], v2 offset:30720
v_mov_b32 v114, 0xff800000
v_mfma_f32_16x16x32_bf16 v[140:143], a[128:131], v[64:67], v[140:143]
ds_read_b128 a[188:191], v2 offset:31744
v_mov_b32 v115, 0xff800000
v_mfma_f32_16x16x32_bf16 v[156:159], a[144:147], v[64:67], 0
v_cmp_gt_i32 vcc, 0, v240
v_mov_b32 v120, 0x3f803f80
v_mfma_f32_16x16x32_bf16 v[156:159], a[148:151], v[68:71], v[156:159]
v_cndmask_b32 v116, 0, v112, vcc
v_cmp_gt_i32 vcc, 1, v240
v_mfma_f32_16x16x32_bf16 v[156:159], a[152:155], v[72:75], v[156:159]
v_mov_b32 v121, 0x3f803f80
v_cndmask_b32 v117, 0, v112, vcc
v_mfma_f32_16x16x32_bf16 v[156:159], a[156:159], v[76:79], v[156:159]
v_cmp_gt_i32 vcc, 2, v240
v_mov_b32 v122, 0x3f803f80
v_mfma_f32_16x16x32_bf16 v[152:155], a[156:159], v[60:63], 0
v_cndmask_b32 v118, 0, v112, vcc
v_cmp_gt_i32 vcc, 3, v240
v_mfma_f32_16x16x32_bf16 v[152:155], a[152:155], v[56:59], v[152:155]
v_mov_b32 v123, 0x3f803f80
v_cndmask_b32 v119, 0, v112, vcc
v_mfma_f32_16x16x32_bf16 v[152:155], a[148:151], v[52:55], v[152:155]
v_mfma_f32_16x16x32_bf16 v[152:155], a[144:147], v[48:51], v[152:155]
s_cmp_eq_u32 s84, 0
s_cbranch_scc1 Lta7
s_cmp_eq_u32 s84, 1
s_cbranch_scc1 Lnt8
v_mfma_f32_16x16x32_bf16 v[128:131], a[128:131], v[16:19], 0
v_mfma_f32_16x16x32_bf16 v[144:147], a[144:147], v[16:19], 0
s_branch Ljoin9
Lta7:
v_mfma_f32_16x16x32_bf16 v[128:131], a[128:131], v[16:19], v[116:119]
v_mfma_f32_16x16x32_bf16 v[144:147], a[144:147], v[16:19], v[112:115]
s_branch Ljoin9
Lnt8:
v_mfma_f32_16x16x32_bf16 v[128:131], a[128:131], v[16:19], 0
v_mfma_f32_16x16x32_bf16 v[144:147], a[144:147], v[16:19], v[116:119]
Ljoin9:
v_mfma_f32_16x16x32_bf16 v[128:131], a[132:135], v[20:23], v[128:131]
v_mfma_f32_16x16x32_bf16 v[128:131], a[136:139], v[24:27], v[128:131]
v_mfma_f32_16x16x32_bf16 v[128:131], a[140:143], v[28:31], v[128:131]
v_max3_f32 v240, v136, v137, v126
v_max3_f32 v242, v140, v141, v127
v_mfma_f32_16x16x32_bf16 v[132:135], a[140:143], v[44:47], 0
v_max3_f32 v240, v240, v138, v139
v_max3_f32 v242, v242, v142, v143
v_mfma_f32_16x16x32_bf16 v[132:135], a[136:139], v[40:43], v[132:135]
v_max3_f32 v240, v240, v152, v153
v_max3_f32 v242, v242, v156, v157
v_mfma_f32_16x16x32_bf16 v[132:135], a[132:135], v[36:39], v[132:135]
v_max3_f32 v240, v240, v154, v155
v_max3_f32 v242, v242, v158, v159
v_mfma_f32_16x16x32_bf16 v[132:135], a[128:131], v[32:35], v[132:135]
v_mov_b32 v241, v240
v_mov_b32 v243, v242
v_mfma_f32_16x16x32_bf16 v[148:151], a[144:147], v[32:35], 0
v_permlane16_swap_b32 v240, v241
v_permlane16_swap_b32 v242, v243
v_mfma_f32_16x16x32_bf16 v[148:151], a[148:151], v[36:39], v[148:151]
v_max_f32 v240, v240, v241
v_max_f32 v242, v242, v243
v_mfma_f32_16x16x32_bf16 v[148:151], a[152:155], v[40:43], v[148:151]
v_mov_b32 v241, v240
v_mov_b32 v243, v242
v_mfma_f32_16x16x32_bf16 v[148:151], a[156:159], v[44:47], v[148:151]
v_permlane32_swap_b32 v240, v241
v_permlane32_swap_b32 v242, v243
v_mfma_f32_16x16x32_bf16 v[144:147], a[156:159], v[28:31], v[144:147]
v_max_f32 v240, v240, v241
v_max_f32 v242, v242, v243
v_mfma_f32_16x16x32_bf16 v[144:147], a[152:155], v[24:27], v[144:147]
v_mfma_f32_16x16x32_bf16 v[144:147], a[148:151], v[20:23], v[144:147]
v_sub_f32 v88, 0, v240
v_sub_f32 v89, 0, v240
v_pk_add_f32 v[90:91], v[88:89], 0
v_pk_add_f32 v[104:105], v[116:117], v[88:89]
v_pk_add_f32 v[106:107], v[118:119], v[88:89]
v_pk_add_f32 v[136:137], v[136:137], v[88:89]
v_pk_add_f32 v[138:139], v[138:139], v[88:89]
v_pk_add_f32 v[152:153], v[152:153], v[88:89]
v_pk_add_f32 v[154:155], v[154:155], v[88:89]
v_sub_f32 v92, 0, v242
v_sub_f32 v93, 0, v242
v_pk_add_f32 v[94:95], v[92:93], 0
v_pk_add_f32 v[108:109], v[116:117], v[92:93]
v_pk_add_f32 v[110:111], v[118:119], v[92:93]
v_pk_add_f32 v[140:141], v[140:141], v[92:93]
v_pk_add_f32 v[142:143], v[142:143], v[92:93]
v_pk_add_f32 v[156:157], v[156:157], v[92:93]
v_pk_add_f32 v[158:159], v[158:159], v[92:93]
v_max3_f32 v240, v128, v129, v124
v_max3_f32 v242, v132, v133, v125
v_max3_f32 v240, v240, v130, v131
v_max3_f32 v242, v242, v134, v135
v_max3_f32 v240, v240, v144, v145
v_max3_f32 v242, v242, v148, v149
v_max3_f32 v240, v240, v146, v147
v_max3_f32 v242, v242, v150, v151
v_mov_b32 v241, v240
v_mov_b32 v243, v242
s_nop 0
v_permlane16_swap_b32 v240, v241
v_permlane16_swap_b32 v242, v243
v_max_f32 v240, v240, v241
v_max_f32 v242, v242, v243
v_mov_b32 v241, v240
v_mov_b32 v243, v242
s_nop 0
v_permlane32_swap_b32 v240, v241
v_permlane32_swap_b32 v242, v243
v_max_f32 v240, v240, v241
v_max_f32 v242, v242, v243
v_sub_f32 v80, 0, v240
v_sub_f32 v81, 0, v240
v_pk_add_f32 v[82:83], v[80:81], 0
v_pk_add_f32 v[96:97], v[116:117], v[80:81]
v_pk_add_f32 v[98:99], v[118:119], v[80:81]
v_pk_add_f32 v[128:129], v[128:129], v[80:81]
v_pk_add_f32 v[130:131], v[130:131], v[80:81]
v_pk_add_f32 v[144:145], v[144:145], v[80:81]
v_pk_add_f32 v[146:147], v[146:147], v[80:81]
v_sub_f32 v84, 0, v242
v_sub_f32 v85, 0, v242
v_pk_add_f32 v[86:87], v[84:85], 0
v_pk_add_f32 v[100:101], v[116:117], v[84:85]
v_pk_add_f32 v[102:103], v[118:119], v[84:85]
v_pk_add_f32 v[132:133], v[132:133], v[84:85]
v_pk_add_f32 v[134:135], v[134:135], v[84:85]
v_pk_add_f32 v[148:149], v[148:149], v[84:85]
v_pk_add_f32 v[150:151], v[150:151], v[84:85]
v_add_u32 v2, s82, v1
s_waitcnt vmcnt(9) lgkmcnt(0)
s_barrier
s_cmp_eq_u32 s60, 0
s_cbranch_scc1 LP0x
v_mfma_f32_16x16x32_bf16 v[160:163], a[160:163], v[16:19], v[80:83]
s_xor_b32 s74, s82, 0x10000
v_exp_f32 v128, v128
v_mfma_f32_16x16x32_bf16 v[160:163], a[164:167], v[20:23], v[160:163]
s_add_u32 s74, s74, s64
ds_read_b128 a[128:131], v2 offset:16384
ds_read_b128 a[132:135], v2 offset:17408
v_mfma_f32_16x16x32_bf16 v[160:163], a[168:171], v[24:27], v[160:163]
s_add_u32 s81, s81, 0x8000
v_exp_f32 v129, v129
v_mfma_f32_16x16x32_bf16 v[160:163], a[172:175], v[28:31], v[160:163]
s_add_u32 m0, s74, 16384
v_exp_f32 v130, v130
v_mfma_f32_16x16x32_bf16 v[164:167], a[172:175], v[44:47], v[84:87]
s_add_u32 s72, s81, 16384
v_exp_f32 v131, v131
v_mfma_f32_16x16x32_bf16 v[164:167], a[168:171], v[40:43], v[164:167]
v_exp_f32 v144, v144
v_mfma_f32_16x16x32_bf16 v[164:167], a[164:167], v[36:39], v[164:167]
ds_read_b128 a[136:139], v2 offset:18432
ds_read_b128 a[140:143], v2 offset:19456
v_mfma_f32_16x16x32_bf16 v[164:167], a[160:163], v[32:35], v[164:167]
ds_read_b128 a[144:147], v2 offset:20480
ds_read_b128 a[148:151], v2 offset:21504
v_mfma_f32_16x16x32_bf16 v[168:171], a[160:163], v[48:51], v[88:91]
ds_read_b128 a[152:155], v2 offset:22528
ds_read_b128 a[156:159], v2 offset:23552
v_mfma_f32_16x16x32_bf16 v[168:171], a[164:167], v[52:55], v[168:171]
ds_read_b128 a[192:195], v2 offset:0
ds_read_b128 a[196:199], v2 offset:1024
v_mfma_f32_16x16x32_bf16 v[168:171], a[168:171], v[56:59], v[168:171]
ds_read_b128 a[200:203], v2 offset:2048
ds_read_b128 a[204:207], v2 offset:3072
v_mfma_f32_16x16x32_bf16 v[168:171], a[172:175], v[60:63], v[168:171]
ds_read_b128 a[208:211], v2 offset:4096
ds_read_b128 a[212:215], v2 offset:5120
v_mfma_f32_16x16x32_bf16 v[172:175], a[172:175], v[76:79], v[92:95]
ds_read_b128 a[216:219], v2 offset:6144
ds_read_b128 a[220:223], v2 offset:7168
v_mfma_f32_16x16x32_bf16 v[172:175], a[168:171], v[72:75], v[172:175]
v_cvt_pk_bf16_f32 v192, v128, v129
v_cvt_pk_bf16_f32 v193, v130, v131
v_mfma_f32_16x16x32_bf16 v[172:175], a[164:167], v[68:71], v[172:175]
buffer_load_dwordx4 v1, s[44:47], s72 offen sc1 lds
v_mfma_f32_16x16x32_bf16 v[172:175], a[160:163], v[64:67], v[172:175]
v_exp_f32 v145, v145
v_mfma_f32_16x16x32_bf16 v[188:191], a[176:179], v[64:67], v[92:95]
v_exp_f32 v146, v146
v_mfma_f32_16x16x32_bf16 v[188:191], a[180:183], v[68:71], v[188:191]
v_exp_f32 v147, v147
v_mfma_f32_16x16x32_bf16 v[188:191], a[184:187], v[72:75], v[188:191]
v_exp_f32 v132, v132
v_mfma_f32_16x16x32_bf16 v[188:191], a[188:191], v[76:79], v[188:191]
v_cvt_pk_bf16_f32 v194, v144, v145
v_cvt_pk_bf16_f32 v195, v146, v147
v_mfma_f32_16x16x32_bf16 v[184:187], a[188:191], v[60:63], v[88:91]
v_exp_f32 v133, v133
v_mfma_f32_16x16x32_bf16 v[184:187], a[184:187], v[56:59], v[184:187]
v_exp_f32 v134, v134
v_mfma_f32_16x16x32_bf16 v[184:187], a[180:183], v[52:55], v[184:187]
v_exp_f32 v135, v135
v_mfma_f32_16x16x32_bf16 v[184:187], a[176:179], v[48:51], v[184:187]
v_exp_f32 v148, v148
v_mfma_f32_16x16x32_bf16 v[180:183], a[176:179], v[32:35], v[84:87]
v_cvt_pk_bf16_f32 v196, v132, v133
v_cvt_pk_bf16_f32 v197, v134, v135
v_mfma_f32_16x16x32_bf16 v[180:183], a[180:183], v[36:39], v[180:183]
buffer_load_dwordx4 v1, s[44:47], s72 offen offset:1024 sc1 lds
v_mfma_f32_16x16x32_bf16 v[180:183], a[184:187], v[40:43], v[180:183]
v_exp_f32 v149, v149
v_mfma_f32_16x16x32_bf16 v[180:183], a[188:191], v[44:47], v[180:183]
v_exp_f32 v150, v150
v_mfma_f32_16x16x32_bf16 v[176:179], a[188:191], v[28:31], v[80:83]
v_exp_f32 v151, v151
v_mfma_f32_16x16x32_bf16 v[176:179], a[184:187], v[24:27], v[176:179]
buffer_load_dwordx4 v1, s[44:47], s72 offen offset:2048 sc1 lds
v_mfma_f32_16x16x32_bf16 v[176:179], a[180:183], v[20:23], v[176:179]
buffer_load_dwordx4 v1, s[44:47], s72 offen offset:3072 sc1 lds
v_mfma_f32_16x16x32_bf16 v[176:179], a[176:179], v[16:19], v[176:179]
s_waitcnt lgkmcnt(8)
v_exp_f32 v136, v136
v_cvt_pk_bf16_f32 v198, v148, v149
v_cvt_pk_bf16_f32 v199, v150, v151
v_exp_f32 v137, v137
v_exp_f32 v138, v138
v_cvt_pk_bf16_f32 v200, v136, v137
Lstub0:
s_cbranch_execz Lstub4
v_exp_f32 v139, v139
v_exp_f32 v152, v152
v_cvt_pk_bf16_f32 v201, v138, v139
v_exp_f32 v153, v153
v_exp_f32 v154, v154
v_cvt_pk_bf16_f32 v202, v152, v153
v_exp_f32 v155, v155
v_exp_f32 v140, v140
v_cvt_pk_bf16_f32 v203, v154, v155
v_exp_f32 v141, v141
v_exp_f32 v142, v142
v_cvt_pk_bf16_f32 v204, v140, v141
v_exp_f32 v143, v143
v_exp_f32 v156, v156
v_cvt_pk_bf16_f32 v205, v142, v143
v_exp_f32 v157, v157
v_exp_f32 v158, v158
v_cvt_pk_bf16_f32 v206, v156, v157
v_exp_f32 v159, v159
s_nop 0
v_cvt_pk_bf16_f32 v207, v158, v159
v_mfma_f32_16x16x32_bf16 v[128:131], a[128:131], v[16:19], v[80:83]
s_add_u32 s82, s82, 0x8000
ds_read_b128 a[160:163], v2 offset:24576
v_mfma_f32_16x16x32_bf16 v[128:131], a[132:135], v[20:23], v[128:131]
s_and_b32 s82, s82, 0x1ffff
v_exp_f32 v160, v160
v_mfma_f32_16x16x32_bf16 v[128:131], a[136:139], v[24:27], v[128:131]
s_add_u32 m0, s74, 0
v_exp_f32 v161, v161
v_mfma_f32_16x16x32_bf16 v[128:131], a[140:143], v[28:31], v[128:131]
s_add_u32 s72, s81, 0
ds_read_b128 a[164:167], v2 offset:25600
v_cvt_pk_bf16_f32 v208, v160, v161
v_mfma_f32_16x16x32_bf16 v[132:135], a[140:143], v[44:47], v[84:87]
v_exp_f32 v162, v162
v_mfma_f32_16x16x32_bf16 v[132:135], a[136:139], v[40:43], v[132:135]
buffer_load_dwordx4 v1, s[44:47], s72 offen sc1 lds
v_mfma_f32_16x16x32_bf16 v[132:135], a[132:135], v[36:39], v[132:135]
v_exp_f32 v163, v163
v_mfma_f32_16x16x32_bf16 v[132:135], a[128:131], v[32:35], v[132:135]
ds_read_b128 a[168:171], v2 offset:26624
v_cvt_pk_bf16_f32 v209, v162, v163
v_mfma_f32_16x16x32_bf16 v[136:139], a[128:131], v[48:51], v[88:91]
v_exp_f32 v176, v176
v_mfma_f32_16x16x32_bf16 v[136:139], a[132:135], v[52:55], v[136:139]
v_exp_f32 v177, v177
v_mfma_f32_16x16x32_bf16 v[136:139], a[136:139], v[56:59], v[136:139]
ds_read_b128 a[172:175], v2 offset:27648
v_cvt_pk_bf16_f32 v210, v176, v177
v_mfma_f32_16x16x32_bf16 v[136:139], a[140:143], v[60:63], v[136:139]
v_exp_f32 v178, v178
v_mfma_f32_16x16x32_bf16 v[140:143], a[140:143], v[76:79], v[92:95]
buffer_load_dwordx4 v1, s[44:47], s72 offen offset:1024 sc1 lds
v_mfma_f32_16x16x32_bf16 v[140:143], a[136:139], v[72:75], v[140:143]
v_exp_f32 v179, v179
v_mfma_f32_16x16x32_bf16 v[140:143], a[132:135], v[68:71], v[140:143]
ds_read_b128 a[176:179], v2 offset:28672
v_cvt_pk_bf16_f32 v211, v178, v179
v_mfma_f32_16x16x32_bf16 v[140:143], a[128:131], v[64:67], v[140:143]
v_exp_f32 v164, v164
v_mfma_f32_16x16x32_bf16 v[156:159], a[144:147], v[64:67], v[92:95]
v_exp_f32 v165, v165
v_mfma_f32_16x16x32_bf16 v[156:159], a[148:151], v[68:71], v[156:159]
ds_read_b128 a[180:183], v2 offset:29696
v_cvt_pk_bf16_f32 v212, v164, v165
v_mfma_f32_16x16x32_bf16 v[156:159], a[152:155], v[72:75], v[156:159]
v_exp_f32 v166, v166
v_mfma_f32_16x16x32_bf16 v[156:159], a[156:159], v[76:79], v[156:159]
buffer_load_dwordx4 v1, s[44:47], s72 offen offset:2048 sc1 lds
v_mfma_f32_16x16x32_bf16 v[152:155], a[156:159], v[60:63], v[88:91]
v_exp_f32 v167, v167
v_mfma_f32_16x16x32_bf16 v[152:155], a[152:155], v[56:59], v[152:155]
ds_read_b128 a[184:187], v2 offset:30720
v_cvt_pk_bf16_f32 v213, v166, v167
v_mfma_f32_16x16x32_bf16 v[152:155], a[148:151], v[52:55], v[152:155]
v_exp_f32 v180, v180
v_mfma_f32_16x16x32_bf16 v[152:155], a[144:147], v[48:51], v[152:155]
v_exp_f32 v181, v181
v_mfma_f32_16x16x32_bf16 v[148:151], a[144:147], v[32:35], v[84:87]
ds_read_b128 a[188:191], v2 offset:31744
v_cvt_pk_bf16_f32 v214, v180, v181
v_mfma_f32_16x16x32_bf16 v[148:151], a[148:151], v[36:39], v[148:151]
v_exp_f32 v182, v182
v_mfma_f32_16x16x32_bf16 v[148:151], a[152:155], v[40:43], v[148:151]
buffer_load_dwordx4 v1, s[44:47], s72 offen offset:3072 sc1 lds
v_mfma_f32_16x16x32_bf16 v[148:151], a[156:159], v[44:47], v[148:151]
s_add_u32 s66, s58, 1
v_exp_f32 v183, v183
v_mfma_f32_16x16x32_bf16 v[144:147], a[156:159], v[28:31], v[80:83]
s_and_b32 s66, s66, 3
ds_read_b128 a[224:227], v2 offset:8192
v_cvt_pk_bf16_f32 v215, v182, v183
v_mfma_f32_16x16x32_bf16 v[144:147], a[152:155], v[24:27], v[144:147]
s_mul_i32 s66, s66, 4160
v_exp_f32 v168, v168
v_mfma_f32_16x16x32_bf16 v[144:147], a[148:151], v[20:23], v[144:147]
s_add_u32 m0, s66, 131104
v_exp_f32 v169, v169
v_mfma_f32_16x16x32_bf16 v[144:147], a[144:147], v[16:19], v[144:147]
s_waitcnt lgkmcnt(9)
ds_read_b128 a[228:231], v2 offset:9216
v_cvt_pk_bf16_f32 v216, v168, v169
v_mfma_f32_16x16x32_bf16 a[0:3], a[192:195], v[192:195], 0
s_add_u32 s72, s93, 0x2
v_exp_f32 v170, v170
v_mfma_f32_16x16x32_bf16 a[32:35], a[192:195], v[196:199], 0
buffer_load_dwordx4 v1, s[36:39], s72 offen lds
v_mfma_f32_16x16x32_bf16 a[64:67], a[192:195], v[200:203], 0
v_exp_f32 v171, v171
v_mfma_f32_16x16x32_bf16 a[96:99], a[192:195], v[204:207], 0
ds_read_b128 a[232:235], v2 offset:10240
v_cvt_pk_bf16_f32 v217, v170, v171
v_mfma_f32_16x16x32_bf16 a[100:103], a[196:199], v[204:207], 0
v_exp_f32 v184, v184
v_mfma_f32_16x16x32_bf16 a[68:71], a[196:199], v[200:203], 0
v_exp_f32 v185, v185
v_mfma_f32_16x16x32_bf16 a[36:39], a[196:199], v[196:199], 0
ds_read_b128 a[236:239], v2 offset:11264
v_cvt_pk_bf16_f32 v218, v184, v185
v_mfma_f32_16x16x32_bf16 a[4:7], a[196:199], v[192:195], 0
v_exp_f32 v186, v186
v_mfma_f32_16x16x32_bf16 a[8:11], a[200:203], v[192:195], 0
buffer_load_dwordx4 v1, s[36:39], s72 offen offset:1024 lds
v_mfma_f32_16x16x32_bf16 a[40:43], a[200:203], v[196:199], 0
v_exp_f32 v187, v187
v_mfma_f32_16x16x32_bf16 a[72:75], a[200:203], v[200:203], 0
ds_read_b128 a[240:243], v2 offset:12288
v_cvt_pk_bf16_f32 v219, v186, v187
v_mfma_f32_16x16x32_bf16 a[104:107], a[200:203], v[204:207], 0
v_exp_f32 v172, v172
v_mfma_f32_16x16x32_bf16 a[108:111], a[204:207], v[204:207], 0
v_exp_f32 v173, v173
v_mfma_f32_16x16x32_bf16 a[76:79], a[204:207], v[200:203], 0
ds_read_b128 a[244:247], v2 offset:13312
v_cvt_pk_bf16_f32 v220, v172, v173
v_mfma_f32_16x16x32_bf16 a[44:47], a[204:207], v[196:199], 0
v_exp_f32 v174, v174
v_mfma_f32_16x16x32_bf16 a[12:15], a[204:207], v[192:195], 0
buffer_load_dwordx4 v1, s[36:39], s72 offen offset:2048 lds
v_mfma_f32_16x16x32_bf16 a[16:19], a[208:211], v[192:195], 0
v_exp_f32 v175, v175
v_mfma_f32_16x16x32_bf16 a[48:51], a[208:211], v[196:199], 0
ds_read_b128 a[248:251], v2 offset:14336
v_cvt_pk_bf16_f32 v221, v174, v175
v_mfma_f32_16x16x32_bf16 a[80:83], a[208:211], v[200:203], 0
v_exp_f32 v188, v188
v_mfma_f32_16x16x32_bf16 a[112:115], a[208:211], v[204:207], 0
v_exp_f32 v189, v189
v_mfma_f32_16x16x32_bf16 a[116:119], a[212:215], v[204:207], 0
ds_read_b128 a[252:255], v2 offset:15360
v_cvt_pk_bf16_f32 v222, v188, v189
v_mfma_f32_16x16x32_bf16 a[84:87], a[212:215], v[200:203], 0
v_exp_f32 v190, v190
v_mfma_f32_16x16x32_bf16 a[52:55], a[212:215], v[196:199], 0
buffer_load_dwordx4 v1, s[36:39], s72 offen offset:3072 lds
v_mfma_f32_16x16x32_bf16 a[20:23], a[212:215], v[192:195], 0
v_exp_f32 v191, v191
v_mfma_f32_16x16x32_bf16 a[24:27], a[216:219], v[192:195], 0
v_cvt_pk_bf16_f32 v223, v190, v191
v_add_u32 v2, s82, v1
v_mfma_f32_16x16x32_bf16 a[56:59], a[216:219], v[196:199], 0
v_and_b32 v240, 15, v0
v_lshrrev_b32 v241, 4, v0
v_mfma_f32_16x16x32_bf16 a[88:91], a[216:219], v[200:203], 0
v_add_u32 v248, 1, v240
v_and_b32 v249, 3, v248
v_mfma_f32_16x16x32_bf16 a[120:123], a[216:219], v[204:207], 0
v_lshrrev_b32 v248, 2, v248
v_mov_b32 v250, 0x20000
v_mfma_f32_16x16x32_bf16 a[124:127], a[220:223], v[204:207], 0
v_mov_b32 v252, 0x20001
v_lshlrev_b32 v6, 3, v249
v_mfma_f32_16x16x32_bf16 a[92:95], a[220:223], v[200:203], 0
v_lshrrev_b32 v6, v6, v252
v_and_b32 v6, 3, v6
v_mfma_f32_16x16x32_bf16 a[60:63], a[220:223], v[196:199], 0
v_cmp_ne_u32 vcc, 1, v249
v_mul_u32_u24 v6, 16640, v6
v_mfma_f32_16x16x32_bf16 a[28:31], a[220:223], v[192:195], 0
v_add_u32 v6, s92, v6
v_cndmask_b32 v6, v250, v6, vcc
v_mfma_f32_16x16x32_bf16 v[224:227], v[120:123], v[192:195], 0
v_add_u32 v253, s58, v249
v_and_b32 v253, 3, v253
v_mfma_f32_16x16x32_bf16 v[228:231], v[120:123], v[196:199], 0
v_mul_u32_u24 v253, 4160, v253
v_add_u32 v6, v6, v253
v_mfma_f32_16x16x32_bf16 v[232:235], v[120:123], v[200:203], 0
s_waitcnt vmcnt(12) lgkmcnt(8)
v_mfma_f32_16x16x32_bf16 v[236:239], v[120:123], v[204:207], 0
s_barrier
s_lshl_b32 s75, s59, 4
s_and_b32 s76, s84, 15
s_add_u32 s75, s75, s76
s_lshl_b32 s75, s75, 14
s_cmp_ge_u32 s60, 4
s_cselect_b32 s75, s75, 0x40001000
s_lshl_b32 s83, s60, 1
s_sub_u32 s83, 2, s83
s_cmp_eq_u32 s83, 0
s_cbranch_scc1 LLT1
.p2align 5
s_nop 0
s_nop 0
LloopI:
v_mfma_f32_16x16x32_bf16 v[160:163], a[160:163], v[16:19], v[80:83]
s_xor_b32 s74, s82, 0x10000
v_exp_f32 v128, v128
v_mfma_f32_16x16x32_bf16 v[160:163], a[164:167], v[20:23], v[160:163]
s_add_u32 s74, s74, s64
ds_read_b128 a[128:131], v2 offset:16384
v_mfma_f32_16x16x32_bf16 v[160:163], a[168:171], v[24:27], v[160:163]
s_add_u32 s81, s81, 0x8000
v_exp_f32 v129, v129
v_mfma_f32_16x16x32_bf16 v[160:163], a[172:175], v[28:31], v[160:163]
s_add_u32 m0, s74, 16384
v_exp_f32 v130, v130
v_mfma_f32_16x16x32_bf16 v[164:167], a[172:175], v[44:47], v[84:87]
s_add_u32 s72, s81, 16384
ds_read_b128 a[132:135], v2 offset:17408
v_cvt_pk_bf16_f32 v192, v128, v129
v_mfma_f32_16x16x32_bf16 v[164:167], a[168:171], v[40:43], v[164:167]
v_exp_f32 v131, v131
v_mfma_f32_16x16x32_bf16 v[164:167], a[164:167], v[36:39], v[164:167]
v_exp_f32 v144, v144
v_mfma_f32_16x16x32_bf16 v[164:167], a[160:163], v[32:35], v[164:167]
ds_read_b128 a[136:139], v2 offset:18432
v_cvt_pk_bf16_f32 v193, v130, v131
v_mfma_f32_16x16x32_bf16 v[168:171], a[160:163], v[48:51], v[88:91]
buffer_load_dwordx4 v1, s[44:47], s72 offen sc1 lds
v_mfma_f32_16x16x32_bf16 v[168:171], a[164:167], v[52:55], v[168:171]
v_exp_f32 v145, v145
v_mfma_f32_16x16x32_bf16 v[168:171], a[168:171], v[56:59], v[168:171]
v_exp_f32 v146, v146
v_mfma_f32_16x16x32_bf16 v[168:171], a[172:175], v[60:63], v[168:171]
ds_read_b128 a[140:143], v2 offset:19456
v_cvt_pk_bf16_f32 v194, v144, v145
v_mfma_f32_16x16x32_bf16 v[172:175], a[172:175], v[76:79], v[92:95]
v_exp_f32 v147, v147
v_mfma_f32_16x16x32_bf16 v[172:175], a[168:171], v[72:75], v[172:175]
v_exp_f32 v132, v132
v_mfma_f32_16x16x32_bf16 v[172:175], a[164:167], v[68:71], v[172:175]
ds_read_b128 a[144:147], v2 offset:20480
v_cvt_pk_bf16_f32 v195, v146, v147
v_mfma_f32_16x16x32_bf16 v[172:175], a[160:163], v[64:67], v[172:175]
v_exp_f32 v133, v133
v_mfma_f32_16x16x32_bf16 v[188:191], a[176:179], v[64:67], v[92:95]
v_exp_f32 v134, v134
v_mfma_f32_16x16x32_bf16 v[188:191], a[180:183], v[68:71], v[188:191]
ds_read_b128 a[148:151], v2 offset:21504
v_cvt_pk_bf16_f32 v196, v132, v133
v_mfma_f32_16x16x32_bf16 v[188:191], a[184:187], v[72:75], v[188:191]
v_exp_f32 v135, v135
v_mfma_f32_16x16x32_bf16 v[188:191], a[188:191], v[76:79], v[188:191]
v_exp_f32 v148, v148
v_mfma_f32_16x16x32_bf16 v[184:187], a[188:191], v[60:63], v[88:91]
ds_read_b128 a[152:155], v2 offset:22528
v_cvt_pk_bf16_f32 v197, v134, v135
v_mfma_f32_16x16x32_bf16 v[184:187], a[184:187], v[56:59], v[184:187]
buffer_load_dwordx4 v1, s[44:47], s72 offen offset:1024 sc1 lds
v_mfma_f32_16x16x32_bf16 v[184:187], a[180:183], v[52:55], v[184:187]
v_exp_f32 v149, v149
v_mfma_f32_16x16x32_bf16 v[184:187], a[176:179], v[48:51], v[184:187]
v_exp_f32 v150, v150
v_mfma_f32_16x16x32_bf16 v[180:183], a[176:179], v[32:35], v[84:87]
ds_read_b128 a[156:159], v2 offset:23552
v_cvt_pk_bf16_f32 v198, v148, v149
v_mfma_f32_16x16x32_bf16 v[180:183], a[180:183], v[36:39], v[180:183]
v_exp_f32 v151, v151
v_mfma_f32_16x16x32_bf16 v[180:183], a[184:187], v[40:43], v[180:183]
v_exp_f32 v136, v136
v_mfma_f32_16x16x32_bf16 v[180:183], a[188:191], v[44:47], v[180:183]
ds_read_b128 a[192:195], v2 offset:0
v_cvt_pk_bf16_f32 v199, v150, v151
v_mfma_f32_16x16x32_bf16 v[176:179], a[188:191], v[28:31], v[80:83]
v_exp_f32 v137, v137
v_mfma_f32_16x16x32_bf16 v[176:179], a[184:187], v[24:27], v[176:179]
v_exp_f32 v138, v138
v_mfma_f32_16x16x32_bf16 v[176:179], a[180:183], v[20:23], v[176:179]
ds_read_b128 a[196:199], v2 offset:1024
v_cvt_pk_bf16_f32 v200, v136, v137
v_mfma_f32_16x16x32_bf16 v[176:179], a[176:179], v[16:19], v[176:179]
s_waitcnt lgkmcnt(10)
v_exp_f32 v139, v139
v_mfma_f32_16x16x32_bf16 a[0:3], a[224:227], v[208:211], a[0:3]
v_exp_f32 v152, v152
v_mfma_f32_16x16x32_bf16 a[32:35], a[224:227], v[212:215], a[32:35]
ds_read_b128 a[200:203], v2 offset:2048
v_cvt_pk_bf16_f32 v201, v138, v139
v_mfma_f32_16x16x32_bf16 a[64:67], a[224:227], v[216:219], a[64:67]
buffer_load_dwordx4 v1, s[44:47], s72 offen offset:2048 sc1 lds
v_mfma_f32_16x16x32_bf16 a[96:99], a[224:227], v[220:223], a[96:99]
v_exp_f32 v153, v153
v_mfma_f32_16x16x32_bf16 a[100:103], a[228:231], v[220:223], a[100:103]
v_exp_f32 v154, v154
v_mfma_f32_16x16x32_bf16 a[68:71], a[228:231], v[216:219], a[68:71]
ds_read_b128 a[204:207], v2 offset:3072
v_cvt_pk_bf16_f32 v202, v152, v153
v_mfma_f32_16x16x32_bf16 a[36:39], a[228:231], v[212:215], a[36:39]
v_exp_f32 v155, v155
v_mfma_f32_16x16x32_bf16 a[4:7], a[228:231], v[208:211], a[4:7]
v_exp_f32 v140, v140
v_mfma_f32_16x16x32_bf16 a[8:11], a[232:235], v[208:211], a[8:11]
ds_read_b128 a[208:211], v2 offset:4096
v_cvt_pk_bf16_f32 v203, v154, v155
v_mfma_f32_16x16x32_bf16 a[40:43], a[232:235], v[212:215], a[40:43]
v_exp_f32 v141, v141
v_mfma_f32_16x16x32_bf16 a[72:75], a[232:235], v[216:219], a[72:75]
v_exp_f32 v142, v142
v_mfma_f32_16x16x32_bf16 a[104:107], a[232:235], v[220:223], a[104:107]
ds_read_b128 a[212:215], v2 offset:5120
v_cvt_pk_bf16_f32 v204, v140, v141
v_mfma_f32_16x16x32_bf16 a[108:111], a[236:239], v[220:223], a[108:111]
v_exp_f32 v143, v143
v_mfma_f32_16x16x32_bf16 a[76:79], a[236:239], v[216:219], a[76:79]
v_exp_f32 v156, v156
v_mfma_f32_16x16x32_bf16 a[44:47], a[236:239], v[212:215], a[44:47]
ds_read_b128 a[216:219], v2 offset:6144
v_cvt_pk_bf16_f32 v205, v142, v143
v_mfma_f32_16x16x32_bf16 a[12:15], a[236:239], v[208:211], a[12:15]
buffer_load_dwordx4 v1, s[44:47], s72 offen offset:3072 sc1 lds
v_mfma_f32_16x16x32_bf16 a[16:19], a[240:243], v[208:211], a[16:19]
v_exp_f32 v157, v157
v_mfma_f32_16x16x32_bf16 a[48:51], a[240:243], v[212:215], a[48:51]
v_exp_f32 v158, v158
v_mfma_f32_16x16x32_bf16 a[80:83], a[240:243], v[216:219], a[80:83]
ds_read_b128 a[220:223], v2 offset:7168
v_cvt_pk_bf16_f32 v206, v156, v157
v_mfma_f32_16x16x32_bf16 a[112:115], a[240:243], v[220:223], a[112:115]
v_exp_f32 v159, v159
v_mfma_f32_16x16x32_bf16 a[116:119], a[244:247], v[220:223], a[116:119]
v_cvt_pk_bf16_f32 v207, v158, v159
v_add_u32 v15, s75, v3
v_mfma_f32_16x16x32_bf16 a[84:87], a[244:247], v[216:219], a[84:87]
v_mfma_f32_16x16x32_bf16 a[52:55], a[244:247], v[212:215], a[52:55]
v_mfma_f32_16x16x32_bf16 a[20:23], a[244:247], v[208:211], a[20:23]
v_mfma_f32_16x16x32_bf16 a[24:27], a[248:251], v[208:211], a[24:27]
v_mfma_f32_16x16x32_bf16 a[56:59], a[248:251], v[212:215], a[56:59]
v_mfma_f32_16x16x32_bf16 a[88:91], a[248:251], v[216:219], a[88:91]
v_mfma_f32_16x16x32_bf16 a[120:123], a[248:251], v[220:223], a[120:123]
v_mfma_f32_16x16x32_bf16 a[124:127], a[252:255], v[220:223], a[124:127]
v_mfma_f32_16x16x32_bf16 a[92:95], a[252:255], v[216:219], a[92:95]
v_mfma_f32_16x16x32_bf16 a[60:63], a[252:255], v[212:215], a[60:63]
v_mfma_f32_16x16x32_bf16 a[28:31], a[252:255], v[208:211], a[28:31]
v_mfma_f32_16x16x32_bf16 v[224:227], v[120:123], v[208:211], v[224:227]
v_mfma_f32_16x16x32_bf16 v[228:231], v[120:123], v[212:215], v[228:231]
v_mfma_f32_16x16x32_bf16 v[232:235], v[120:123], v[216:219], v[232:235]
v_mfma_f32_16x16x32_bf16 v[236:239], v[120:123], v[220:223], v[236:239]
s_waitcnt lgkmcnt(8)
v_mfma_f32_16x16x32_bf16 v[128:131], a[128:131], v[16:19], v[80:83]
s_add_u32 s82, s82, 0x8000
ds_read_b128 a[160:163], v2 offset:24576
v_mfma_f32_16x16x32_bf16 v[128:131], a[132:135], v[20:23], v[128:131]
s_and_b32 s82, s82, 0x1ffff
v_exp_f32 v160, v160
v_mfma_f32_16x16x32_bf16 v[128:131], a[136:139], v[24:27], v[128:131]
s_add_u32 m0, s74, 0
v_exp_f32 v161, v161
v_mfma_f32_16x16x32_bf16 v[128:131], a[140:143], v[28:31], v[128:131]
s_add_u32 s72, s81, 0
ds_read_b128 a[164:167], v2 offset:25600
v_cvt_pk_bf16_f32 v208, v160, v161
v_mfma_f32_16x16x32_bf16 v[132:135], a[140:143], v[44:47], v[84:87]
v_exp_f32 v162, v162
v_mfma_f32_16x16x32_bf16 v[132:135], a[136:139], v[40:43], v[132:135]
v_exp_f32 v163, v163
v_mfma_f32_16x16x32_bf16 v[132:135], a[132:135], v[36:39], v[132:135]
buffer_load_dwordx4 v1, s[44:47], s72 offen sc1 lds
v_mfma_f32_16x16x32_bf16 v[132:135], a[128:131], v[32:35], v[132:135]
ds_read_b128 a[168:171], v2 offset:26624
v_cvt_pk_bf16_f32 v209, v162, v163
v_mfma_f32_16x16x32_bf16 v[136:139], a[128:131], v[48:51], v[88:91]
v_exp_f32 v176, v176
v_mfma_f32_16x16x32_bf16 v[136:139], a[132:135], v[52:55], v[136:139]
v_exp_f32 v177, v177
v_mfma_f32_16x16x32_bf16 v[136:139], a[136:139], v[56:59], v[136:139]
ds_read_b128 a[172:175], v2 offset:27648
v_cvt_pk_bf16_f32 v210, v176, v177
v_mfma_f32_16x16x32_bf16 v[136:139], a[140:143], v[60:63], v[136:139]
v_exp_f32 v178, v178
v_mfma_f32_16x16x32_bf16 v[140:143], a[140:143], v[76:79], v[92:95]
v_exp_f32 v179, v179
v_mfma_f32_16x16x32_bf16 v[140:143], a[136:139], v[72:75], v[140:143]
ds_read_b128 a[176:179], v2 offset:28672
v_cvt_pk_bf16_f32 v211, v178, v179
v_mfma_f32_16x16x32_bf16 v[140:143], a[132:135], v[68:71], v[140:143]
v_exp_f32 v164, v164
v_mfma_f32_16x16x32_bf16 v[140:143], a[128:131], v[64:67], v[140:143]
v_exp_f32 v165, v165
v_mfma_f32_16x16x32_bf16 v[156:159], a[144:147], v[64:67], v[92:95]
ds_read_b128 a[180:183], v2 offset:29696
v_cvt_pk_bf16_f32 v212, v164, v165
v_mfma_f32_16x16x32_bf16 v[156:159], a[148:151], v[68:71], v[156:159]
buffer_load_dwordx4 v1, s[44:47], s72 offen offset:1024 sc1 lds
v_mfma_f32_16x16x32_bf16 v[156:159], a[152:155], v[72:75], v[156:159]
v_exp_f32 v166, v166
v_mfma_f32_16x16x32_bf16 v[156:159], a[156:159], v[76:79], v[156:159]
v_exp_f32 v167, v167
v_mfma_f32_16x16x32_bf16 v[152:155], a[156:159], v[60:63], v[88:91]
ds_read_b128 a[184:187], v2 offset:30720
v_cvt_pk_bf16_f32 v213, v166, v167
v_mfma_f32_16x16x32_bf16 v[152:155], a[152:155], v[56:59], v[152:155]
v_exp_f32 v180, v180
v_mfma_f32_16x16x32_bf16 v[152:155], a[148:151], v[52:55], v[152:155]
v_exp_f32 v181, v181
v_mfma_f32_16x16x32_bf16 v[152:155], a[144:147], v[48:51], v[152:155]
ds_read_b128 a[188:191], v2 offset:31744
v_cvt_pk_bf16_f32 v214, v180, v181
v_mfma_f32_16x16x32_bf16 v[148:151], a[144:147], v[32:35], v[84:87]
v_exp_f32 v182, v182
v_mfma_f32_16x16x32_bf16 v[148:151], a[148:151], v[36:39], v[148:151]
v_exp_f32 v183, v183
v_mfma_f32_16x16x32_bf16 v[148:151], a[152:155], v[40:43], v[148:151]
ds_read_b128 a[224:227], v2 offset:8192
v_cvt_pk_bf16_f32 v215, v182, v183
v_mfma_f32_16x16x32_bf16 v[148:151], a[156:159], v[44:47], v[148:151]
v_exp_f32 v168, v168
v_mfma_f32_16x16x32_bf16 v[144:147], a[156:159], v[28:31], v[80:83]
buffer_load_dwordx4 v1, s[44:47], s72 offen offset:2048 sc1 lds
v_mfma_f32_16x16x32_bf16 v[144:147], a[152:155], v[24:27], v[144:147]
v_exp_f32 v169, v169
v_mfma_f32_16x16x32_bf16 v[144:147], a[148:151], v[20:23], v[144:147]
ds_read_b128 a[228:231], v2 offset:9216
v_cvt_pk_bf16_f32 v216, v168, v169
v_mfma_f32_16x16x32_bf16 v[144:147], a[144:147], v[16:19], v[144:147]
s_waitcnt lgkmcnt(10)
v_exp_f32 v170, v170
v_mfma_f32_16x16x32_bf16 a[0:3], a[192:195], v[192:195], a[0:3]
v_exp_f32 v171, v171
v_mfma_f32_16x16x32_bf16 a[32:35], a[192:195], v[196:199], a[32:35]
ds_read_b128 a[232:235], v2 offset:10240
v_cvt_pk_bf16_f32 v217, v170, v171
v_mfma_f32_16x16x32_bf16 a[64:67], a[192:195], v[200:203], a[64:67]
v_exp_f32 v184, v184
v_mfma_f32_16x16x32_bf16 a[96:99], a[192:195], v[204:207], a[96:99]
v_exp_f32 v185, v185
v_mfma_f32_16x16x32_bf16 a[100:103], a[196:199], v[204:207], a[100:103]
ds_read_b128 a[236:239], v2 offset:11264
v_cvt_pk_bf16_f32 v218, v184, v185
v_mfma_f32_16x16x32_bf16 a[68:71], a[196:199], v[200:203], a[68:71]
v_exp_f32 v186, v186
v_mfma_f32_16x16x32_bf16 a[36:39], a[196:199], v[196:199], a[36:39]
buffer_load_dwordx4 v1, s[44:47], s72 offen offset:3072 sc1 lds
v_mfma_f32_16x16x32_bf16 a[4:7], a[196:199], v[192:195], a[4:7]
s_add_u32 s75, s75, 0x1000
v_exp_f32 v187, v187
v_mfma_f32_16x16x32_bf16 a[8:11], a[200:203], v[192:195], a[8:11]
s_and_b32 s76, s75, 0x3000
ds_read_b128 a[240:243], v2 offset:12288
v_cvt_pk_bf16_f32 v219, v186, v187
v_mfma_f32_16x16x32_bf16 a[40:43], a[200:203], v[196:199], a[40:43]
s_cselect_b32 s75, s75, 0x40001000
v_exp_f32 v172, v172
v_mfma_f32_16x16x32_bf16 a[72:75], a[200:203], v[200:203], a[72:75]
v_exp_f32 v173, v173
v_mfma_f32_16x16x32_bf16 a[104:107], a[200:203], v[204:207], a[104:107]
ds_read_b128 a[244:247], v2 offset:13312
v_cvt_pk_bf16_f32 v220, v172, v173
v_mfma_f32_16x16x32_bf16 a[108:111], a[204:207], v[204:207], a[108:111]
v_exp_f32 v174, v174
v_mfma_f32_16x16x32_bf16 a[76:79], a[204:207], v[200:203], a[76:79]
v_exp_f32 v175, v175
v_mfma_f32_16x16x32_bf16 a[44:47], a[204:207], v[196:199], a[44:47]
ds_read_b128 a[248:251], v2 offset:14336
v_cvt_pk_bf16_f32 v221, v174, v175
v_mfma_f32_16x16x32_bf16 a[12:15], a[204:207], v[192:195], a[12:15]
v_exp_f32 v188, v188
v_mfma_f32_16x16x32_bf16 a[16:19], a[208:211], v[192:195], a[16:19]
buffer_load_dword v4, v15, s[24:27], 0 offen
v_mfma_f32_16x16x32_bf16 a[48:51], a[208:211], v[196:199], a[48:51]
v_exp_f32 v189, v189
v_mfma_f32_16x16x32_bf16 a[80:83], a[208:211], v[200:203], a[80:83]
ds_read_b128 a[252:255], v2 offset:15360
v_cvt_pk_bf16_f32 v222, v188, v189
v_mfma_f32_16x16x32_bf16 a[112:115], a[208:211], v[204:207], a[112:115]
v_exp_f32 v190, v190
v_mfma_f32_16x16x32_bf16 a[116:119], a[212:215], v[204:207], a[116:119]
v_exp_f32 v191, v191
v_mfma_f32_16x16x32_bf16 a[84:87], a[212:215], v[200:203], a[84:87]
v_cvt_pk_bf16_f32 v223, v190, v191
v_add_u32 v2, s82, v1
v_mfma_f32_16x16x32_bf16 a[52:55], a[212:215], v[196:199], a[52:55]
v_mfma_f32_16x16x32_bf16 a[20:23], a[212:215], v[192:195], a[20:23]
v_mfma_f32_16x16x32_bf16 a[24:27], a[216:219], v[192:195], a[24:27]
v_mfma_f32_16x16x32_bf16 a[56:59], a[216:219], v[196:199], a[56:59]
v_mfma_f32_16x16x32_bf16 a[88:91], a[216:219], v[200:203], a[88:91]
v_mfma_f32_16x16x32_bf16 a[120:123], a[216:219], v[204:207], a[120:123]
v_mfma_f32_16x16x32_bf16 a[124:127], a[220:223], v[204:207], a[124:127]
v_mfma_f32_16x16x32_bf16 a[92:95], a[220:223], v[200:203], a[92:95]
v_mfma_f32_16x16x32_bf16 a[60:63], a[220:223], v[196:199], a[60:63]
v_mfma_f32_16x16x32_bf16 a[28:31], a[220:223], v[192:195], a[28:31]
v_mfma_f32_16x16x32_bf16 v[224:227], v[120:123], v[192:195], v[224:227]
s_waitcnt vmcnt(9) lgkmcnt(8)
v_mfma_f32_16x16x32_bf16 v[228:231], v[120:123], v[196:199], v[228:231]
s_barrier
v_mfma_f32_16x16x32_bf16 v[232:235], v[120:123], v[200:203], v[232:235]
s_add_u32 s83, s83, 1
v_mfma_f32_16x16x32_bf16 v[236:239], v[120:123], v[204:207], v[236:239]
s_cbranch_scc0 LloopI
LLT1:
Lstub1:
s_cbranch_execz Lstub5
v_mfma_f32_16x16x32_bf16 v[160:163], a[160:163], v[16:19], v[80:83]
s_xor_b32 s74, s82, 0x10000
v_exp_f32 v128, v128
v_mfma_f32_16x16x32_bf16 v[160:163], a[164:167], v[20:23], v[160:163]
s_add_u32 s74, s74, s64
ds_read_b128 a[128:131], v2 offset:16384
v_mfma_f32_16x16x32_bf16 v[160:163], a[168:171], v[24:27], v[160:163]
s_add_u32 s81, s81, 0x8000
v_exp_f32 v129, v129
v_mfma_f32_16x16x32_bf16 v[160:163], a[172:175], v[28:31], v[160:163]
s_add_u32 m0, s74, 16384
v_exp_f32 v130, v130
v_mfma_f32_16x16x32_bf16 v[164:167], a[172:175], v[44:47], v[84:87]
s_add_u32 s72, s81, 16384
ds_read_b128 a[132:135], v2 offset:17408
v_cvt_pk_bf16_f32 v192, v128, v129
v_mfma_f32_16x16x32_bf16 v[164:167], a[168:171], v[40:43], v[164:167]
v_exp_f32 v131, v131
v_mfma_f32_16x16x32_bf16 v[164:167], a[164:167], v[36:39], v[164:167]
v_exp_f32 v144, v144
v_mfma_f32_16x16x32_bf16 v[164:167], a[160:163], v[32:35], v[164:167]
ds_read_b128 a[136:139], v2 offset:18432
v_cvt_pk_bf16_f32 v193, v130, v131
v_mfma_f32_16x16x32_bf16 v[168:171], a[160:163], v[48:51], v[88:91]
buffer_load_dwordx4 v1, s[44:47], s72 offen sc1 lds
v_mfma_f32_16x16x32_bf16 v[168:171], a[164:167], v[52:55], v[168:171]
v_exp_f32 v145, v145
v_mfma_f32_16x16x32_bf16 v[168:171], a[168:171], v[56:59], v[168:171]
v_exp_f32 v146, v146
v_mfma_f32_16x16x32_bf16 v[168:171], a[172:175], v[60:63], v[168:171]
ds_read_b128 a[140:143], v2 offset:19456
v_cvt_pk_bf16_f32 v194, v144, v145
v_mfma_f32_16x16x32_bf16 v[172:175], a[172:175], v[76:79], v[92:95]
v_exp_f32 v147, v147
v_mfma_f32_16x16x32_bf16 v[172:175], a[168:171], v[72:75], v[172:175]
v_exp_f32 v132, v132
v_mfma_f32_16x16x32_bf16 v[172:175], a[164:167], v[68:71], v[172:175]
ds_read_b128 a[144:147], v2 offset:20480
v_cvt_pk_bf16_f32 v195, v146, v147
v_mfma_f32_16x16x32_bf16 v[172:175], a[160:163], v[64:67], v[172:175]
v_exp_f32 v133, v133
v_mfma_f32_16x16x32_bf16 v[188:191], a[176:179], v[64:67], v[92:95]
v_exp_f32 v134, v134
v_mfma_f32_16x16x32_bf16 v[188:191], a[180:183], v[68:71], v[188:191]
ds_read_b128 a[148:151], v2 offset:21504
v_cvt_pk_bf16_f32 v196, v132, v133
v_mfma_f32_16x16x32_bf16 v[188:191], a[184:187], v[72:75], v[188:191]
v_exp_f32 v135, v135
v_mfma_f32_16x16x32_bf16 v[188:191], a[188:191], v[76:79], v[188:191]
v_exp_f32 v148, v148
v_mfma_f32_16x16x32_bf16 v[184:187], a[188:191], v[60:63], v[88:91]
ds_read_b128 a[152:155], v2 offset:22528
v_cvt_pk_bf16_f32 v197, v134, v135
v_mfma_f32_16x16x32_bf16 v[184:187], a[184:187], v[56:59], v[184:187]
buffer_load_dwordx4 v1, s[44:47], s72 offen offset:1024 sc1 lds
v_mfma_f32_16x16x32_bf16 v[184:187], a[180:183], v[52:55], v[184:187]
v_exp_f32 v149, v149
v_mfma_f32_16x16x32_bf16 v[184:187], a[176:179], v[48:51], v[184:187]
v_exp_f32 v150, v150
v_mfma_f32_16x16x32_bf16 v[180:183], a[176:179], v[32:35], v[84:87]
ds_read_b128 a[156:159], v2 offset:23552
v_cvt_pk_bf16_f32 v198, v148, v149
v_mfma_f32_16x16x32_bf16 v[180:183], a[180:183], v[36:39], v[180:183]
v_exp_f32 v151, v151
v_mfma_f32_16x16x32_bf16 v[180:183], a[184:187], v[40:43], v[180:183]
v_exp_f32 v136, v136
v_mfma_f32_16x16x32_bf16 v[180:183], a[188:191], v[44:47], v[180:183]
ds_read_b128 a[192:195], v2 offset:0
v_cvt_pk_bf16_f32 v199, v150, v151
v_mfma_f32_16x16x32_bf16 v[176:179], a[188:191], v[28:31], v[80:83]
v_exp_f32 v137, v137
v_mfma_f32_16x16x32_bf16 v[176:179], a[184:187], v[24:27], v[176:179]
v_exp_f32 v138, v138
v_mfma_f32_16x16x32_bf16 v[176:179], a[180:183], v[20:23], v[176:179]
ds_read_b128 a[196:199], v2 offset:1024
v_cvt_pk_bf16_f32 v200, v136, v137
v_mfma_f32_16x16x32_bf16 v[176:179], a[176:179], v[16:19], v[176:179]
s_waitcnt lgkmcnt(10)
v_exp_f32 v139, v139
v_mfma_f32_16x16x32_bf16 a[0:3], a[224:227], v[208:211], a[0:3]
v_exp_f32 v152, v152
v_mfma_f32_16x16x32_bf16 a[32:35], a[224:227], v[212:215], a[32:35]
ds_read_b128 a[200:203], v2 offset:2048
v_cvt_pk_bf16_f32 v201, v138, v139
v_mfma_f32_16x16x32_bf16 a[64:67], a[224:227], v[216:219], a[64:67]
buffer_load_dwordx4 v1, s[44:47], s72 offen offset:2048 sc1 lds
v_mfma_f32_16x16x32_bf16 a[96:99], a[224:227], v[220:223], a[96:99]
v_exp_f32 v153, v153
v_mfma_f32_16x16x32_bf16 a[100:103], a[228:231], v[220:223], a[100:103]
v_exp_f32 v154, v154
v_mfma_f32_16x16x32_bf16 a[68:71], a[228:231], v[216:219], a[68:71]
ds_read_b128 a[204:207], v2 offset:3072
v_cvt_pk_bf16_f32 v202, v152, v153
v_mfma_f32_16x16x32_bf16 a[36:39], a[228:231], v[212:215], a[36:39]
v_exp_f32 v155, v155
v_mfma_f32_16x16x32_bf16 a[4:7], a[228:231], v[208:211], a[4:7]
Lstub2:
s_cbranch_execz Lstub6
v_exp_f32 v140, v140
v_mfma_f32_16x16x32_bf16 a[8:11], a[232:235], v[208:211], a[8:11]
ds_read_b128 a[208:211], v2 offset:4096
v_cvt_pk_bf16_f32 v203, v154, v155
v_mfma_f32_16x16x32_bf16 a[40:43], a[232:235], v[212:215], a[40:43]
v_exp_f32 v141, v141
v_mfma_f32_16x16x32_bf16 a[72:75], a[232:235], v[216:219], a[72:75]
v_exp_f32 v142, v142
v_mfma_f32_16x16x32_bf16 a[104:107], a[232:235], v[220:223], a[104:107]
ds_read_b128 a[212:215], v2 offset:5120
v_cvt_pk_bf16_f32 v204, v140, v141
v_mfma_f32_16x16x32_bf16 a[108:111], a[236:239], v[220:223], a[108:111]
v_exp_f32 v143, v143
v_mfma_f32_16x16x32_bf16 a[76:79], a[236:239], v[216:219], a[76:79]
v_exp_f32 v156, v156
v_mfma_f32_16x16x32_bf16 a[44:47], a[236:239], v[212:215], a[44:47]
ds_read_b128 a[216:219], v2 offset:6144
v_cvt_pk_bf16_f32 v205, v142, v143
v_mfma_f32_16x16x32_bf16 a[12:15], a[236:239], v[208:211], a[12:15]
buffer_load_dwordx4 v1, s[44:47], s72 offen offset:3072 sc1 lds
v_mfma_f32_16x16x32_bf16 a[16:19], a[240:243], v[208:211], a[16:19]
v_exp_f32 v157, v157
v_mfma_f32_16x16x32_bf16 a[48:51], a[240:243], v[212:215], a[48:51]
v_exp_f32 v158, v158
v_mfma_f32_16x16x32_bf16 a[80:83], a[240:243], v[216:219], a[80:83]
ds_read_b128 a[220:223], v2 offset:7168
v_cvt_pk_bf16_f32 v206, v156, v157
v_mfma_f32_16x16x32_bf16 a[112:115], a[240:243], v[220:223], a[112:115]
v_exp_f32 v159, v159
v_mfma_f32_16x16x32_bf16 a[116:119], a[244:247], v[220:223], a[116:119]
v_cvt_pk_bf16_f32 v207, v158, v159
v_mfma_f32_16x16x32_bf16 a[84:87], a[244:247], v[216:219], a[84:87]
v_mfma_f32_16x16x32_bf16 a[52:55], a[244:247], v[212:215], a[52:55]
v_mfma_f32_16x16x32_bf16 a[20:23], a[244:247], v[208:211], a[20:23]
v_mfma_f32_16x16x32_bf16 a[24:27], a[248:251], v[208:211], a[24:27]
v_mfma_f32_16x16x32_bf16 a[56:59], a[248:251], v[212:215], a[56:59]
v_mfma_f32_16x16x32_bf16 a[88:91], a[248:251], v[216:219], a[88:91]
v_mfma_f32_16x16x32_bf16 a[120:123], a[248:251], v[220:223], a[120:123]
v_mfma_f32_16x16x32_bf16 a[124:127], a[252:255], v[220:223], a[124:127]
v_mfma_f32_16x16x32_bf16 a[92:95], a[252:255], v[216:219], a[92:95]
v_mfma_f32_16x16x32_bf16 a[60:63], a[252:255], v[212:215], a[60:63]
v_mfma_f32_16x16x32_bf16 a[28:31], a[252:255], v[208:211], a[28:31]
v_mfma_f32_16x16x32_bf16 v[224:227], v[120:123], v[208:211], v[224:227]
v_mfma_f32_16x16x32_bf16 v[228:231], v[120:123], v[212:215], v[228:231]
v_mfma_f32_16x16x32_bf16 v[232:235], v[120:123], v[216:219], v[232:235]
v_mfma_f32_16x16x32_bf16 v[236:239], v[120:123], v[220:223], v[236:239]
s_waitcnt lgkmcnt(8)
s_cmp_eq_u32 s58, 0
s_cbranch_scc1 Lta16
s_cmp_eq_u32 s58, 1
s_cbranch_scc1 Lnt17
v_mfma_f32_16x16x32_bf16 v[128:131], a[128:131], v[16:19], v[80:83]
s_add_u32 s82, s82, 0x8000
ds_read_b128 a[160:163], v2 offset:24576
v_mfma_f32_16x16x32_bf16 v[144:147], a[144:147], v[16:19], v[80:83]
s_and_b32 s82, s82, 0x1ffff
v_exp_f32 v160, v160
s_branch Ljoin18
Lta16:
v_mfma_f32_16x16x32_bf16 v[128:131], a[128:131], v[16:19], v[96:99]
s_add_u32 s82, s82, 0x8000
ds_read_b128 a[160:163], v2 offset:24576
v_mfma_f32_16x16x32_bf16 v[144:147], a[144:147], v[16:19], v[112:115]
s_and_b32 s82, s82, 0x1ffff
v_exp_f32 v160, v160
s_branch Ljoin18
Lnt17:
v_mfma_f32_16x16x32_bf16 v[128:131], a[128:131], v[16:19], v[80:83]
s_add_u32 s82, s82, 0x8000
ds_read_b128 a[160:163], v2 offset:24576
v_mfma_f32_16x16x32_bf16 v[144:147], a[144:147], v[16:19], v[96:99]
s_and_b32 s82, s82, 0x1ffff
v_exp_f32 v160, v160
Ljoin18:
v_mfma_f32_16x16x32_bf16 v[128:131], a[132:135], v[20:23], v[128:131]
s_add_u32 m0, s74, 0
v_exp_f32 v161, v161
v_mfma_f32_16x16x32_bf16 v[128:131], a[136:139], v[24:27], v[128:131]
s_add_u32 s72, s81, 0
ds_read_b128 a[164:167], v2 offset:25600
v_cvt_pk_bf16_f32 v208, v160, v161
v_mfma_f32_16x16x32_bf16 v[128:131], a[140:143], v[28:31], v[128:131]
v_exp_f32 v162, v162
v_mfma_f32_16x16x32_bf16 v[132:135], a[140:143], v[44:47], v[84:87]
v_exp_f32 v163, v163
v_mfma_f32_16x16x32_bf16 v[132:135], a[136:139], v[40:43], v[132:135]
ds_read_b128 a[168:171], v2 offset:26624
v_cvt_pk_bf16_f32 v209, v162, v163
v_mfma_f32_16x16x32_bf16 v[132:135], a[132:135], v[36:39], v[132:135]
v_exp_f32 v176, v176
v_mfma_f32_16x16x32_bf16 v[132:135], a[128:131], v[32:35], v[132:135]
buffer_load_dwordx4 v1, s[44:47], s72 offen sc1 lds
v_mfma_f32_16x16x32_bf16 v[136:139], a[128:131], v[48:51], v[88:91]
v_exp_f32 v177, v177
v_mfma_f32_16x16x32_bf16 v[136:139], a[132:135], v[52:55], v[136:139]
ds_read_b128 a[172:175], v2 offset:27648
v_cvt_pk_bf16_f32 v210, v176, v177
v_mfma_f32_16x16x32_bf16 v[136:139], a[136:139], v[56:59], v[136:139]
v_exp_f32 v178, v178
v_mfma_f32_16x16x32_bf16 v[136:139], a[140:143], v[60:63], v[136:139]
v_exp_f32 v179, v179
v_mfma_f32_16x16x32_bf16 v[140:143], a[140:143], v[76:79], v[92:95]
ds_read_b128 a[176:179], v2 offset:28672
v_cvt_pk_bf16_f32 v211, v178, v179
v_mfma_f32_16x16x32_bf16 v[140:143], a[136:139], v[72:75], v[140:143]
v_exp_f32 v164, v164
v_mfma_f32_16x16x32_bf16 v[140:143], a[132:135], v[68:71], v[140:143]
v_exp_f32 v165, v165
v_mfma_f32_16x16x32_bf16 v[140:143], a[128:131], v[64:67], v[140:143]
ds_read_b128 a[180:183], v2 offset:29696
v_cvt_pk_bf16_f32 v212, v164, v165
v_mfma_f32_16x16x32_bf16 v[156:159], a[144:147], v[64:67], v[92:95]
v_exp_f32 v166, v166
v_mfma_f32_16x16x32_bf16 v[156:159], a[148:151], v[68:71], v[156:159]
v_exp_f32 v167, v167
v_mfma_f32_16x16x32_bf16 v[156:159], a[152:155], v[72:75], v[156:159]
ds_read_b128 a[184:187], v2 offset:30720
v_cvt_pk_bf16_f32 v213, v166, v167
v_mfma_f32_16x16x32_bf16 v[156:159], a[156:159], v[76:79], v[156:159]
v_exp_f32 v180, v180
v_mfma_f32_16x16x32_bf16 v[152:155], a[156:159], v[60:63], v[88:91]
buffer_load_dwordx4 v1, s[44:47], s72 offen offset:1024 sc1 lds
v_mfma_f32_16x16x32_bf16 v[152:155], a[152:155], v[56:59], v[152:155]
v_exp_f32 v181, v181
v_mfma_f32_16x16x32_bf16 v[152:155], a[148:151], v[52:55], v[152:155]
ds_read_b128 a[188:191], v2 offset:31744
v_cvt_pk_bf16_f32 v214, v180, v181
v_mfma_f32_16x16x32_bf16 v[152:155], a[144:147], v[48:51], v[152:155]
v_exp_f32 v182, v182
v_mfma_f32_16x16x32_bf16 v[148:151], a[144:147], v[32:35], v[84:87]
v_exp_f32 v183, v183
v_mfma_f32_16x16x32_bf16 v[148:151], a[148:151], v[36:39], v[148:151]
ds_read_b128 a[224:227], v2 offset:8192
v_cvt_pk_bf16_f32 v215, v182, v183
v_mfma_f32_16x16x32_bf16 v[148:151], a[152:155], v[40:43], v[148:151]
v_exp_f32 v168, v168
v_mfma_f32_16x16x32_bf16 v[148:151], a[156:159], v[44:47], v[148:151]
v_exp_f32 v169, v169
v_mfma_f32_16x16x32_bf16 v[144:147], a[156:159], v[28:31], v[144:147]
ds_read_b128 a[228:231], v2 offset:9216
v_cvt_pk_bf16_f32 v216, v168, v169
v_mfma_f32_16x16x32_bf16 v[144:147], a[152:155], v[24:27], v[144:147]
v_exp_f32 v170, v170
v_mfma_f32_16x16x32_bf16 v[144:147], a[148:151], v[20:23], v[144:147]
s_waitcnt lgkmcnt(10)
v_exp_f32 v171, v171
v_mfma_f32_16x16x32_bf16 a[0:3], a[192:195], v[192:195], a[0:3]
ds_read_b128 a[232:235], v2 offset:10240
v_cvt_pk_bf16_f32 v217, v170, v171
v_mfma_f32_16x16x32_bf16 a[32:35], a[192:195], v[196:199], a[32:35]
v_exp_f32 v184, v184
v_mfma_f32_16x16x32_bf16 a[64:67], a[192:195], v[200:203], a[64:67]
buffer_load_dwordx4 v1, s[44:47], s72 offen offset:2048 sc1 lds
v_mfma_f32_16x16x32_bf16 a[96:99], a[192:195], v[204:207], a[96:99]
v_exp_f32 v185, v185
v_mfma_f32_16x16x32_bf16 a[100:103], a[196:199], v[204:207], a[100:103]
ds_read_b128 a[236:239], v2 offset:11264
v_cvt_pk_bf16_f32 v218, v184, v185
v_mfma_f32_16x16x32_bf16 a[68:71], a[196:199], v[200:203], a[68:71]
v_exp_f32 v186, v186
v_mfma_f32_16x16x32_bf16 a[36:39], a[196:199], v[196:199], a[36:39]
v_exp_f32 v187, v187
v_mfma_f32_16x16x32_bf16 a[4:7], a[196:199], v[192:195], a[4:7]
ds_read_b128 a[240:243], v2 offset:12288
v_cvt_pk_bf16_f32 v219, v186, v187
v_mfma_f32_16x16x32_bf16 a[8:11], a[200:203], v[192:195], a[8:11]
v_exp_f32 v172, v172
v_mfma_f32_16x16x32_bf16 a[40:43], a[200:203], v[196:199], a[40:43]
v_exp_f32 v173, v173
v_mfma_f32_16x16x32_bf16 a[72:75], a[200:203], v[200:203], a[72:75]
ds_read_b128 a[244:247], v2 offset:13312
v_cvt_pk_bf16_f32 v220, v172, v173
v_mfma_f32_16x16x32_bf16 a[104:107], a[200:203], v[204:207], a[104:107]
v_exp_f32 v174, v174
v_mfma_f32_16x16x32_bf16 a[108:111], a[204:207], v[204:207], a[108:111]
v_exp_f32 v175, v175
v_mfma_f32_16x16x32_bf16 a[76:79], a[204:207], v[200:203], a[76:79]
ds_read_b128 a[248:251], v2 offset:14336
v_cvt_pk_bf16_f32 v221, v174, v175
v_mfma_f32_16x16x32_bf16 a[44:47], a[204:207], v[196:199], a[44:47]
v_exp_f32 v188, v188
v_mfma_f32_16x16x32_bf16 a[12:15], a[204:207], v[192:195], a[12:15]
buffer_load_dwordx4 v1, s[44:47], s72 offen offset:3072 sc1 lds
v_mfma_f32_16x16x32_bf16 a[16:19], a[208:211], v[192:195], a[16:19]
v_exp_f32 v189, v189
v_mfma_f32_16x16x32_bf16 a[48:51], a[208:211], v[196:199], a[48:51]
ds_read_b128 a[252:255], v2 offset:15360
v_cvt_pk_bf16_f32 v222, v188, v189
v_mfma_f32_16x16x32_bf16 a[80:83], a[208:211], v[200:203], a[80:83]
v_exp_f32 v190, v190
v_mfma_f32_16x16x32_bf16 a[112:115], a[208:211], v[204:207], a[112:115]
v_exp_f32 v191, v191
v_mfma_f32_16x16x32_bf16 a[116:119], a[212:215], v[204:207], a[116:119]
v_cvt_pk_bf16_f32 v223, v190, v191
v_add_u32 v2, s82, v1
v_mfma_f32_16x16x32_bf16 a[84:87], a[212:215], v[200:203], a[84:87]
v_mfma_f32_16x16x32_bf16 a[52:55], a[212:215], v[196:199], a[52:55]
v_mfma_f32_16x16x32_bf16 a[20:23], a[212:215], v[192:195], a[20:23]
v_mfma_f32_16x16x32_bf16 a[24:27], a[216:219], v[192:195], a[24:27]
v_mfma_f32_16x16x32_bf16 a[56:59], a[216:219], v[196:199], a[56:59]
v_mfma_f32_16x16x32_bf16 a[88:91], a[216:219], v[200:203], a[88:91]
v_mfma_f32_16x16x32_bf16 a[120:123], a[216:219], v[204:207], a[120:123]
v_mfma_f32_16x16x32_bf16 a[124:127], a[220:223], v[204:207], a[124:127]
v_mfma_f32_16x16x32_bf16 a[92:95], a[220:223], v[200:203], a[92:95]
v_mfma_f32_16x16x32_bf16 a[60:63], a[220:223], v[196:199], a[60:63]
v_mfma_f32_16x16x32_bf16 a[28:31], a[220:223], v[192:195], a[28:31]
v_mfma_f32_16x16x32_bf16 v[224:227], v[120:123], v[192:195], v[224:227]
v_mfma_f32_16x16x32_bf16 v[228:231], v[120:123], v[196:199], v[228:231]
v_mfma_f32_16x16x32_bf16 v[232:235], v[120:123], v[200:203], v[232:235]
s_waitcnt vmcnt(8) lgkmcnt(8)
v_mfma_f32_16x16x32_bf16 v[236:239], v[120:123], v[204:207], v[236:239]
s_barrier
s_cmp_eq_u32 s58, 2
s_cbranch_scc1 Lta19
s_cmp_eq_u32 s58, 3
s_cbranch_scc1 Lnt20
v_mfma_f32_16x16x32_bf16 v[160:163], a[160:163], v[16:19], v[112:115]
s_xor_b32 s74, s82, 0x10000
v_exp_f32 v128, v128
v_mfma_f32_16x16x32_bf16 v[176:179], a[176:179], v[16:19], v[112:115]
s_add_u32 s74, s74, s64
ds_read_b128 a[128:131], v2 offset:16384
s_branch Ljoin21
Lta19:
v_mfma_f32_16x16x32_bf16 v[160:163], a[160:163], v[16:19], v[96:99]
s_xor_b32 s74, s82, 0x10000
v_exp_f32 v128, v128
v_mfma_f32_16x16x32_bf16 v[176:179], a[176:179], v[16:19], v[112:115]
s_add_u32 s74, s74, s64
ds_read_b128 a[128:131], v2 offset:16384
s_branch Ljoin21
Lnt20:
v_mfma_f32_16x16x32_bf16 v[160:163], a[160:163], v[16:19], v[80:83]
s_xor_b32 s74, s82, 0x10000
v_exp_f32 v128, v128
v_mfma_f32_16x16x32_bf16 v[176:179], a[176:179], v[16:19], v[96:99]
s_add_u32 s74, s74, s64
ds_read_b128 a[128:131], v2 offset:16384
Ljoin21:
v_mfma_f32_16x16x32_bf16 v[160:163], a[164:167], v[20:23], v[160:163]
s_add_u32 s81, s81, 0x8000
v_exp_f32 v129, v129
v_mfma_f32_16x16x32_bf16 v[160:163], a[168:171], v[24:27], v[160:163]
s_add_u32 m0, s74, 16384
v_exp_f32 v130, v130
v_mfma_f32_16x16x32_bf16 v[160:163], a[172:175], v[28:31], v[160:163]
s_add_u32 s72, s81, 16384
ds_read_b128 a[132:135], v2 offset:17408
v_cvt_pk_bf16_f32 v192, v128, v129
v_mfma_f32_16x16x32_bf16 v[164:167], a[172:175], v[44:47], v[84:87]
v_exp_f32 v131, v131
v_mfma_f32_16x16x32_bf16 v[164:167], a[168:171], v[40:43], v[164:167]
v_exp_f32 v144, v144
v_mfma_f32_16x16x32_bf16 v[164:167], a[164:167], v[36:39], v[164:167]
ds_read_b128 a[136:139], v2 offset:18432
v_cvt_pk_bf16_f32 v193, v130, v131
v_mfma_f32_16x16x32_bf16 v[164:167], a[160:163], v[32:35], v[164:167]
buffer_load_dwordx4 v1, s[44:47], s72 offen sc1 lds
v_mfma_f32_16x16x32_bf16 v[168:171], a[160:163], v[48:51], v[88:91]
v_exp_f32 v145, v145
v_mfma_f32_16x16x32_bf16 v[168:171], a[164:167], v[52:55], v[168:171]
v_exp_f32 v146, v146
v_mfma_f32_16x16x32_bf16 v[168:171], a[168:171], v[56:59], v[168:171]
ds_read_b128 a[140:143], v2 offset:19456
v_cvt_pk_bf16_f32 v194, v144, v145
v_mfma_f32_16x16x32_bf16 v[168:171], a[172:175], v[60:63], v[168:171]
v_exp_f32 v147, v147
v_mfma_f32_16x16x32_bf16 v[172:175], a[172:175], v[76:79], v[92:95]
v_exp_f32 v132, v132
v_mfma_f32_16x16x32_bf16 v[172:175], a[168:171], v[72:75], v[172:175]
ds_read_b128 a[144:147], v2 offset:20480
v_cvt_pk_bf16_f32 v195, v146, v147
v_mfma_f32_16x16x32_bf16 v[172:175], a[164:167], v[68:71], v[172:175]
v_exp_f32 v133, v133
v_mfma_f32_16x16x32_bf16 v[172:175], a[160:163], v[64:67], v[172:175]
v_exp_f32 v134, v134
v_mfma_f32_16x16x32_bf16 v[188:191], a[176:179], v[64:67], v[92:95]
ds_read_b128 a[148:151], v2 offset:21504
v_cvt_pk_bf16_f32 v196, v132, v133
v_mfma_f32_16x16x32_bf16 v[188:191], a[180:183], v[68:71], v[188:191]
v_exp_f32 v135, v135
v_mfma_f32_16x16x32_bf16 v[188:191], a[184:187], v[72:75], v[188:191]
v_exp_f32 v148, v148
v_mfma_f32_16x16x32_bf16 v[188:191], a[188:191], v[76:79], v[188:191]
ds_read_b128 a[152:155], v2 offset:22528
v_cvt_pk_bf16_f32 v197, v134, v135
v_mfma_f32_16x16x32_bf16 v[184:187], a[188:191], v[60:63], v[88:91]
buffer_load_dwordx4 v1, s[44:47], s72 offen offset:1024 sc1 lds
v_mfma_f32_16x16x32_bf16 v[184:187], a[184:187], v[56:59], v[184:187]
v_exp_f32 v149, v149
v_mfma_f32_16x16x32_bf16 v[184:187], a[180:183], v[52:55], v[184:187]
v_exp_f32 v150, v150
v_mfma_f32_16x16x32_bf16 v[184:187], a[176:179], v[48:51], v[184:187]
ds_read_b128 a[156:159], v2 offset:23552
v_cvt_pk_bf16_f32 v198, v148, v149
v_mfma_f32_16x16x32_bf16 v[180:183], a[176:179], v[32:35], v[84:87]
v_exp_f32 v151, v151
v_mfma_f32_16x16x32_bf16 v[180:183], a[180:183], v[36:39], v[180:183]
v_exp_f32 v136, v136
v_mfma_f32_16x16x32_bf16 v[180:183], a[184:187], v[40:43], v[180:183]
ds_read_b128 a[192:195], v2 offset:0
v_cvt_pk_bf16_f32 v199, v150, v151
v_mfma_f32_16x16x32_bf16 v[180:183], a[188:191], v[44:47], v[180:183]
v_exp_f32 v137, v137
v_mfma_f32_16x16x32_bf16 v[176:179], a[188:191], v[28:31], v[176:179]
v_exp_f32 v138, v138
v_mfma_f32_16x16x32_bf16 v[176:179], a[184:187], v[24:27], v[176:179]
ds_read_b128 a[196:199], v2 offset:1024
v_cvt_pk_bf16_f32 v200, v136, v137
v_mfma_f32_16x16x32_bf16 v[176:179], a[180:183], v[20:23], v[176:179]
s_waitcnt lgkmcnt(10)
v_exp_f32 v139, v139
v_mfma_f32_16x16x32_bf16 a[0:3], a[224:227], v[208:211], a[0:3]
v_exp_f32 v152, v152
v_mfma_f32_16x16x32_bf16 a[32:35], a[224:227], v[212:215], a[32:35]
ds_read_b128 a[200:203], v2 offset:2048
v_cvt_pk_bf16_f32 v201, v138, v139
v_mfma_f32_16x16x32_bf16 a[64:67], a[224:227], v[216:219], a[64:67]
buffer_load_dwordx4 v1, s[44:47], s72 offen offset:2048 sc1 lds
v_mfma_f32_16x16x32_bf16 a[96:99], a[224:227], v[220:223], a[96:99]
v_exp_f32 v153, v153
v_mfma_f32_16x16x32_bf16 a[100:103], a[228:231], v[220:223], a[100:103]
v_exp_f32 v154, v154
v_mfma_f32_16x16x32_bf16 a[68:71], a[228:231], v[216:219], a[68:71]
ds_read_b128 a[204:207], v2 offset:3072
v_cvt_pk_bf16_f32 v202, v152, v153
v_mfma_f32_16x16x32_bf16 a[36:39], a[228:231], v[212:215], a[36:39]
v_exp_f32 v155, v155
v_mfma_f32_16x16x32_bf16 a[4:7], a[228:231], v[208:211], a[4:7]
v_exp_f32 v140, v140
v_mfma_f32_16x16x32_bf16 a[8:11], a[232:235], v[208:211], a[8:11]
ds_read_b128 a[208:211], v2 offset:4096
v_cvt_pk_bf16_f32 v203, v154, v155
v_mfma_f32_16x16x32_bf16 a[40:43], a[232:235], v[212:215], a[40:43]
v_exp_f32 v141, v141
v_mfma_f32_16x16x32_bf16 a[72:75], a[232:235], v[216:219], a[72:75]
v_exp_f32 v142, v142
v_mfma_f32_16x16x32_bf16 a[104:107], a[232:235], v[220:223], a[104:107]
ds_read_b128 a[212:215], v2 offset:5120
v_cvt_pk_bf16_f32 v204, v140, v141
v_mfma_f32_16x16x32_bf16 a[108:111], a[236:239], v[220:223], a[108:111]
v_exp_f32 v143, v143
v_mfma_f32_16x16x32_bf16 a[76:79], a[236:239], v[216:219], a[76:79]
v_exp_f32 v156, v156
v_mfma_f32_16x16x32_bf16 a[44:47], a[236:239], v[212:215], a[44:47]
ds_read_b128 a[216:219], v2 offset:6144
v_cvt_pk_bf16_f32 v205, v142, v143
v_mfma_f32_16x16x32_bf16 a[12:15], a[236:239], v[208:211], a[12:15]
buffer_load_dwordx4 v1, s[44:47], s72 offen offset:3072 sc1 lds
v_mfma_f32_16x16x32_bf16 a[16:19], a[240:243], v[208:211], a[16:19]
v_exp_f32 v157, v157
v_mfma_f32_16x16x32_bf16 a[48:51], a[240:243], v[212:215], a[48:51]
v_exp_f32 v158, v158
v_mfma_f32_16x16x32_bf16 a[80:83], a[240:243], v[216:219], a[80:83]
ds_read_b128 a[220:223], v2 offset:7168
v_cvt_pk_bf16_f32 v206, v156, v157
v_mfma_f32_16x16x32_bf16 a[112:115], a[240:243], v[220:223], a[112:115]
v_exp_f32 v159, v159
v_mfma_f32_16x16x32_bf16 a[116:119], a[244:247], v[220:223], a[116:119]
v_cvt_pk_bf16_f32 v207, v158, v159
v_mfma_f32_16x16x32_bf16 a[84:87], a[244:247], v[216:219], a[84:87]
v_mfma_f32_16x16x32_bf16 a[52:55], a[244:247], v[212:215], a[52:55]
v_mfma_f32_16x16x32_bf16 a[20:23], a[244:247], v[208:211], a[20:23]
v_mfma_f32_16x16x32_bf16 a[24:27], a[248:251], v[208:211], a[24:27]
v_mfma_f32_16x16x32_bf16 a[56:59], a[248:251], v[212:215], a[56:59]
v_mfma_f32_16x16x32_bf16 a[88:91], a[248:251], v[216:219], a[88:91]
v_mfma_f32_16x16x32_bf16 a[120:123], a[248:251], v[220:223], a[120:123]
v_mfma_f32_16x16x32_bf16 a[124:127], a[252:255], v[220:223], a[124:127]
v_mfma_f32_16x16x32_bf16 a[92:95], a[252:255], v[216:219], a[92:95]
v_mfma_f32_16x16x32_bf16 a[60:63], a[252:255], v[212:215], a[60:63]
v_mfma_f32_16x16x32_bf16 a[28:31], a[252:255], v[208:211], a[28:31]
v_mfma_f32_16x16x32_bf16 v[224:227], v[120:123], v[208:211], v[224:227]
v_mfma_f32_16x16x32_bf16 v[228:231], v[120:123], v[212:215], v[228:231]
v_mfma_f32_16x16x32_bf16 v[232:235], v[120:123], v[216:219], v[232:235]
v_mfma_f32_16x16x32_bf16 v[236:239], v[120:123], v[220:223], v[236:239]
s_waitcnt lgkmcnt(8)
s_cmp_eq_u32 s58, 0
s_cbranch_scc1 Lta22
s_cmp_eq_u32 s58, 1
s_cbranch_scc1 Lnt23
v_mfma_f32_16x16x32_bf16 v[132:135], a[128:131], v[32:35], v[84:87]
s_add_u32 s82, s82, 0x8000
ds_read_b128 a[160:163], v2 offset:24576
v_mfma_f32_16x16x32_bf16 v[148:151], a[144:147], v[32:35], v[84:87]
s_and_b32 s82, s82, 0x1ffff
v_exp_f32 v160, v160
s_branch Ljoin24
Lta22:
v_mfma_f32_16x16x32_bf16 v[132:135], a[128:131], v[32:35], v[100:103]
s_add_u32 s82, s82, 0x8000
ds_read_b128 a[160:163], v2 offset:24576
v_mfma_f32_16x16x32_bf16 v[148:151], a[144:147], v[32:35], v[112:115]
s_and_b32 s82, s82, 0x1ffff
v_exp_f32 v160, v160
s_branch Ljoin24
Lnt23:
v_mfma_f32_16x16x32_bf16 v[132:135], a[128:131], v[32:35], v[84:87]
s_add_u32 s82, s82, 0x8000
ds_read_b128 a[160:163], v2 offset:24576
v_mfma_f32_16x16x32_bf16 v[148:151], a[144:147], v[32:35], v[100:103]
s_and_b32 s82, s82, 0x1ffff
v_exp_f32 v160, v160
Ljoin24:
v_mfma_f32_16x16x32_bf16 v[132:135], a[132:135], v[36:39], v[132:135]
s_add_u32 m0, s74, 0
v_exp_f32 v161, v161
v_mfma_f32_16x16x32_bf16 v[132:135], a[136:139], v[40:43], v[132:135]
s_add_u32 s72, s81, 0
ds_read_b128 a[164:167], v2 offset:25600
v_cvt_pk_bf16_f32 v208, v160, v161
v_mfma_f32_16x16x32_bf16 v[132:135], a[140:143], v[44:47], v[132:135]
v_exp_f32 v162, v162
v_mfma_f32_16x16x32_bf16 v[136:139], a[140:143], v[60:63], v[88:91]
v_exp_f32 v163, v163
v_mfma_f32_16x16x32_bf16 v[136:139], a[136:139], v[56:59], v[136:139]
ds_read_b128 a[168:171], v2 offset:26624
v_cvt_pk_bf16_f32 v209, v162, v163
v_mfma_f32_16x16x32_bf16 v[136:139], a[132:135], v[52:55], v[136:139]
v_exp_f32 v176, v176
v_mfma_f32_16x16x32_bf16 v[136:139], a[128:131], v[48:51], v[136:139]
buffer_load_dwordx4 v1, s[44:47], s72 offen sc1 lds
v_mfma_f32_16x16x32_bf16 v[140:143], a[128:131], v[64:67], v[92:95]
v_exp_f32 v177, v177
v_mfma_f32_16x16x32_bf16 v[140:143], a[132:135], v[68:71], v[140:143]
ds_read_b128 a[172:175], v2 offset:27648
v_cvt_pk_bf16_f32 v210, v176, v177
v_mfma_f32_16x16x32_bf16 v[140:143], a[136:139], v[72:75], v[140:143]
v_exp_f32 v178, v178
v_mfma_f32_16x16x32_bf16 v[140:143], a[140:143], v[76:79], v[140:143]
v_exp_f32 v179, v179
v_mfma_f32_16x16x32_bf16 v[156:159], a[156:159], v[76:79], v[92:95]
ds_read_b128 a[176:179], v2 offset:28672
v_cvt_pk_bf16_f32 v211, v178, v179
v_mfma_f32_16x16x32_bf16 v[156:159], a[152:155], v[72:75], v[156:159]
v_exp_f32 v164, v164
v_mfma_f32_16x16x32_bf16 v[156:159], a[148:151], v[68:71], v[156:159]
v_exp_f32 v165, v165
v_mfma_f32_16x16x32_bf16 v[156:159], a[144:147], v[64:67], v[156:159]
ds_read_b128 a[180:183], v2 offset:29696
v_cvt_pk_bf16_f32 v212, v164, v165
v_mfma_f32_16x16x32_bf16 v[152:155], a[144:147], v[48:51], v[88:91]
v_exp_f32 v166, v166
v_mfma_f32_16x16x32_bf16 v[152:155], a[148:151], v[52:55], v[152:155]
v_exp_f32 v167, v167
v_mfma_f32_16x16x32_bf16 v[152:155], a[152:155], v[56:59], v[152:155]
ds_read_b128 a[184:187], v2 offset:30720
v_cvt_pk_bf16_f32 v213, v166, v167
v_mfma_f32_16x16x32_bf16 v[152:155], a[156:159], v[60:63], v[152:155]
v_exp_f32 v180, v180
v_mfma_f32_16x16x32_bf16 v[148:151], a[156:159], v[44:47], v[148:151]
buffer_load_dwordx4 v1, s[44:47], s72 offen offset:1024 sc1 lds
v_mfma_f32_16x16x32_bf16 v[148:151], a[152:155], v[40:43], v[148:151]
v_exp_f32 v181, v181
v_mfma_f32_16x16x32_bf16 v[148:151], a[148:151], v[36:39], v[148:151]
s_waitcnt lgkmcnt(7)
ds_read_b128 a[188:191], v2 offset:31744
v_cvt_pk_bf16_f32 v214, v180, v181
v_mfma_f32_16x16x32_bf16 a[0:3], a[192:195], v[192:195], a[0:3]
v_exp_f32 v182, v182
v_mfma_f32_16x16x32_bf16 a[32:35], a[192:195], v[196:199], a[32:35]
v_exp_f32 v183, v183
v_mfma_f32_16x16x32_bf16 a[64:67], a[192:195], v[200:203], a[64:67]
ds_read_b128 a[224:227], v2 offset:8192
v_cvt_pk_bf16_f32 v215, v182, v183
v_mfma_f32_16x16x32_bf16 a[96:99], a[192:195], v[204:207], a[96:99]
v_exp_f32 v168, v168
v_mfma_f32_16x16x32_bf16 a[100:103], a[196:199], v[204:207], a[100:103]
v_exp_f32 v169, v169
v_mfma_f32_16x16x32_bf16 a[68:71], a[196:199], v[200:203], a[68:71]
ds_read_b128 a[228:231], v2 offset:9216
v_cvt_pk_bf16_f32 v216, v168, v169
v_mfma_f32_16x16x32_bf16 a[36:39], a[196:199], v[196:199], a[36:39]
v_exp_f32 v170, v170
v_mfma_f32_16x16x32_bf16 a[4:7], a[196:199], v[192:195], a[4:7]
v_exp_f32 v171, v171
v_mfma_f32_16x16x32_bf16 a[8:11], a[200:203], v[192:195], a[8:11]
ds_read_b128 a[232:235], v2 offset:10240
v_cvt_pk_bf16_f32 v217, v170, v171
v_mfma_f32_16x16x32_bf16 a[40:43], a[200:203], v[196:199], a[40:43]
v_exp_f32 v184, v184
v_mfma_f32_16x16x32_bf16 a[72:75], a[200:203], v[200:203], a[72:75]
buffer_load_dwordx4 v1, s[44:47], s72 offen offset:2048 sc1 lds
v_mfma_f32_16x16x32_bf16 a[104:107], a[200:203], v[204:207], a[104:107]
v_exp_f32 v185, v185
v_mfma_f32_16x16x32_bf16 a[108:111], a[204:207], v[204:207], a[108:111]
ds_read_b128 a[236:239], v2 offset:11264
v_cvt_pk_bf16_f32 v218, v184, v185
v_mfma_f32_16x16x32_bf16 a[76:79], a[204:207], v[200:203], a[76:79]
v_exp_f32 v186, v186
v_mfma_f32_16x16x32_bf16 a[44:47], a[204:207], v[196:199], a[44:47]
v_exp_f32 v187, v187
v_mfma_f32_16x16x32_bf16 a[12:15], a[204:207], v[192:195], a[12:15]
ds_read_b128 a[240:243], v2 offset:12288
v_cvt_pk_bf16_f32 v219, v186, v187
v_mfma_f32_16x16x32_bf16 a[16:19], a[208:211], v[192:195], a[16:19]
v_exp_f32 v172, v172
v_mfma_f32_16x16x32_bf16 a[48:51], a[208:211], v[196:199], a[48:51]
v_exp_f32 v173, v173
v_mfma_f32_16x16x32_bf16 a[80:83], a[208:211], v[200:203], a[80:83]
ds_read_b128 a[244:247], v2 offset:13312
v_cvt_pk_bf16_f32 v220, v172, v173
v_mfma_f32_16x16x32_bf16 a[112:115], a[208:211], v[204:207], a[112:115]
v_exp_f32 v174, v174
v_mfma_f32_16x16x32_bf16 a[116:119], a[212:215], v[204:207], a[116:119]
v_exp_f32 v175, v175
v_mfma_f32_16x16x32_bf16 a[84:87], a[212:215], v[200:203], a[84:87]
ds_read_b128 a[248:251], v2 offset:14336
v_cvt_pk_bf16_f32 v221, v174, v175
v_mfma_f32_16x16x32_bf16 a[52:55], a[212:215], v[196:199], a[52:55]
v_exp_f32 v188, v188
v_mfma_f32_16x16x32_bf16 a[20:23], a[212:215], v[192:195], a[20:23]
buffer_load_dwordx4 v1, s[44:47], s72 offen offset:3072 sc1 lds
v_mfma_f32_16x16x32_bf16 a[24:27], a[216:219], v[192:195], a[24:27]
v_exp_f32 v189, v189
v_mfma_f32_16x16x32_bf16 a[56:59], a[216:219], v[196:199], a[56:59]
ds_read_b128 a[252:255], v2 offset:15360
v_cvt_pk_bf16_f32 v222, v188, v189
v_mfma_f32_16x16x32_bf16 a[88:91], a[216:219], v[200:203], a[88:91]
v_exp_f32 v190, v190
v_mfma_f32_16x16x32_bf16 a[120:123], a[216:219], v[204:207], a[120:123]
v_exp_f32 v191, v191
v_mfma_f32_16x16x32_bf16 a[124:127], a[220:223], v[204:207], a[124:127]
v_cvt_pk_bf16_f32 v223, v190, v191
v_add_u32 v2, s82, v1
v_mfma_f32_16x16x32_bf16 a[92:95], a[220:223], v[200:203], a[92:95]
v_mfma_f32_16x16x32_bf16 a[60:63], a[220:223], v[196:199], a[60:63]
v_mfma_f32_16x16x32_bf16 a[28:31], a[220:223], v[192:195], a[28:31]
v_mfma_f32_16x16x32_bf16 v[224:227], v[120:123], v[192:195], v[224:227]
v_mfma_f32_16x16x32_bf16 v[228:231], v[120:123], v[196:199], v[228:231]
v_mfma_f32_16x16x32_bf16 v[232:235], v[120:123], v[200:203], v[232:235]
s_waitcnt vmcnt(8) lgkmcnt(8)
v_mfma_f32_16x16x32_bf16 v[236:239], v[120:123], v[204:207], v[236:239]
s_barrier
s_cmp_eq_u32 s60, 7
s_cbranch_scc1 LLT3x
LLT3:
Lstub3:
s_cbranch_execz Lstub7
s_cmp_eq_u32 s58, 2
s_cbranch_scc1 Lta25
s_cmp_eq_u32 s58, 3
s_cbranch_scc1 Lnt26
v_mfma_f32_16x16x32_bf16 v[164:167], a[160:163], v[32:35], v[112:115]
s_xor_b32 s74, s82, 0x10000
v_exp_f32 v132, v132
v_mfma_f32_16x16x32_bf16 v[180:183], a[176:179], v[32:35], v[112:115]
s_add_u32 s74, s74, s64
ds_read_b128 a[128:131], v2 offset:16384
s_branch Ljoin27
Lta25:
v_mfma_f32_16x16x32_bf16 v[164:167], a[160:163], v[32:35], v[100:103]
s_xor_b32 s74, s82, 0x10000
v_exp_f32 v132, v132
v_mfma_f32_16x16x32_bf16 v[180:183], a[176:179], v[32:35], v[112:115]
s_add_u32 s74, s74, s64
ds_read_b128 a[128:131], v2 offset:16384
s_branch Ljoin27
Lnt26:
v_mfma_f32_16x16x32_bf16 v[164:167], a[160:163], v[32:35], v[84:87]
s_xor_b32 s74, s82, 0x10000
v_exp_f32 v132, v132
v_mfma_f32_16x16x32_bf16 v[180:183], a[176:179], v[32:35], v[100:103]
s_add_u32 s74, s74, s64
ds_read_b128 a[128:131], v2 offset:16384
Ljoin27:
v_mfma_f32_16x16x32_bf16 v[164:167], a[164:167], v[36:39], v[164:167]
s_add_u32 s81, s81, 0x8000
v_exp_f32 v133, v133
v_mfma_f32_16x16x32_bf16 v[164:167], a[168:171], v[40:43], v[164:167]
s_add_u32 m0, s74, 16384
ds_read_b128 a[132:135], v2 offset:17408
v_cvt_pk_bf16_f32 v196, v132, v133
v_mfma_f32_16x16x32_bf16 v[164:167], a[172:175], v[44:47], v[164:167]
s_add_u32 s72, s81, 16384
v_exp_f32 v134, v134
v_mfma_f32_16x16x32_bf16 v[168:171], a[172:175], v[60:63], v[88:91]
v_exp_f32 v135, v135
v_mfma_f32_16x16x32_bf16 v[168:171], a[168:171], v[56:59], v[168:171]
ds_read_b128 a[136:139], v2 offset:18432
v_cvt_pk_bf16_f32 v197, v134, v135
v_mfma_f32_16x16x32_bf16 v[168:171], a[164:167], v[52:55], v[168:171]
buffer_load_dwordx4 v1, s[44:47], s72 offen sc1 lds
v_mfma_f32_16x16x32_bf16 v[168:171], a[160:163], v[48:51], v[168:171]
v_exp_f32 v148, v148
v_mfma_f32_16x16x32_bf16 v[172:175], a[160:163], v[64:67], v[92:95]
ds_read_b128 a[140:143], v2 offset:19456
v_bfe_u32 v251, v0, 2, 2
v_mfma_f32_16x16x32_bf16 v[172:175], a[164:167], v[68:71], v[172:175]
v_exp_f32 v149, v149
v_mfma_f32_16x16x32_bf16 v[172:175], a[168:171], v[72:75], v[172:175]
v_exp_f32 v150, v150
v_mfma_f32_16x16x32_bf16 v[172:175], a[172:175], v[76:79], v[172:175]
ds_read_b128 a[144:147], v2 offset:20480
v_cvt_pk_bf16_f32 v198, v148, v149
v_mfma_f32_16x16x32_bf16 v[188:191], a[188:191], v[76:79], v[92:95]
v_exp_f32 v151, v151
v_mfma_f32_16x16x32_bf16 v[188:191], a[184:187], v[72:75], v[188:191]
ds_read_b128 a[148:151], v2 offset:21504
v_cvt_pk_bf16_f32 v199, v150, v151
v_mfma_f32_16x16x32_bf16 v[188:191], a[180:183], v[68:71], v[188:191]
v_exp_f32 v136, v136
v_mfma_f32_16x16x32_bf16 v[188:191], a[176:179], v[64:67], v[188:191]
v_exp_f32 v137, v137
v_mfma_f32_16x16x32_bf16 v[184:187], a[176:179], v[48:51], v[88:91]
ds_read_b128 a[152:155], v2 offset:22528
v_cvt_pk_bf16_f32 v200, v136, v137
v_mfma_f32_16x16x32_bf16 v[184:187], a[180:183], v[52:55], v[184:187]
buffer_load_dwordx4 v1, s[44:47], s72 offen offset:1024 sc1 lds
v_mfma_f32_16x16x32_bf16 v[184:187], a[184:187], v[56:59], v[184:187]
v_exp_f32 v138, v138
v_mfma_f32_16x16x32_bf16 v[184:187], a[188:191], v[60:63], v[184:187]
Lstub4:
s_cbranch_execz Lstub8
ds_read_b128 a[156:159], v2 offset:23552
v_lshl_add_u32 v6, v248, 3, v6
v_mfma_f32_16x16x32_bf16 v[180:183], a[188:191], v[44:47], v[180:183]
v_exp_f32 v139, v139
v_mfma_f32_16x16x32_bf16 v[180:183], a[184:187], v[40:43], v[180:183]
v_exp_f32 v152, v152
v_mfma_f32_16x16x32_bf16 v[180:183], a[180:183], v[36:39], v[180:183]
s_waitcnt lgkmcnt(8)
ds_read_b128 a[192:195], v2 offset:0
v_cvt_pk_bf16_f32 v201, v138, v139
v_mfma_f32_16x16x32_bf16 a[0:3], a[224:227], v[208:211], a[0:3]
v_exp_f32 v153, v153
v_mfma_f32_16x16x32_bf16 a[32:35], a[224:227], v[212:215], a[32:35]
ds_read_b128 a[196:199], v2 offset:1024
v_cvt_pk_bf16_f32 v202, v152, v153
v_mfma_f32_16x16x32_bf16 a[64:67], a[224:227], v[216:219], a[64:67]
v_exp_f32 v154, v154
v_mfma_f32_16x16x32_bf16 a[96:99], a[224:227], v[220:223], a[96:99]
v_exp_f32 v155, v155
v_mfma_f32_16x16x32_bf16 a[100:103], a[228:231], v[220:223], a[100:103]
ds_read_b128 a[200:203], v2 offset:2048
v_cvt_pk_bf16_f32 v203, v154, v155
v_mfma_f32_16x16x32_bf16 a[68:71], a[228:231], v[216:219], a[68:71]
buffer_load_dwordx4 v1, s[44:47], s72 offen offset:2048 sc1 lds
v_mfma_f32_16x16x32_bf16 a[36:39], a[228:231], v[212:215], a[36:39]
v_exp_f32 v140, v140
v_mfma_f32_16x16x32_bf16 a[4:7], a[228:231], v[208:211], a[4:7]
ds_read_b128 a[204:207], v2 offset:3072
v_lshl_add_u32 v6, v241, 4, v6
v_mfma_f32_16x16x32_bf16 a[8:11], a[232:235], v[208:211], a[8:11]
v_exp_f32 v141, v141
v_mfma_f32_16x16x32_bf16 a[40:43], a[232:235], v[212:215], a[40:43]
v_exp_f32 v142, v142
v_mfma_f32_16x16x32_bf16 a[72:75], a[232:235], v[216:219], a[72:75]
ds_read_b128 a[208:211], v2 offset:4096
v_cvt_pk_bf16_f32 v204, v140, v141
v_mfma_f32_16x16x32_bf16 a[104:107], a[232:235], v[220:223], a[104:107]
v_exp_f32 v143, v143
v_mfma_f32_16x16x32_bf16 a[108:111], a[236:239], v[220:223], a[108:111]
ds_read_b128 a[212:215], v2 offset:5120
v_cvt_pk_bf16_f32 v205, v142, v143
v_mfma_f32_16x16x32_bf16 a[76:79], a[236:239], v[216:219], a[76:79]
v_exp_f32 v156, v156
v_mfma_f32_16x16x32_bf16 a[44:47], a[236:239], v[212:215], a[44:47]
v_exp_f32 v157, v157
v_mfma_f32_16x16x32_bf16 a[12:15], a[236:239], v[208:211], a[12:15]
ds_read_b128 a[216:219], v2 offset:6144
v_cvt_pk_bf16_f32 v206, v156, v157
v_mfma_f32_16x16x32_bf16 a[16:19], a[240:243], v[208:211], a[16:19]
buffer_load_dwordx4 v1, s[44:47], s72 offen offset:3072 sc1 lds
v_mfma_f32_16x16x32_bf16 a[48:51], a[240:243], v[212:215], a[48:51]
v_exp_f32 v158, v158
v_mfma_f32_16x16x32_bf16 a[80:83], a[240:243], v[216:219], a[80:83]
ds_read_b128 a[220:223], v2 offset:7168
v_lshlrev_b32 v5, 3, v251
v_mfma_f32_16x16x32_bf16 a[112:115], a[240:243], v[220:223], a[112:115]
v_exp_f32 v159, v159
v_mfma_f32_16x16x32_bf16 a[116:119], a[244:247], v[220:223], a[116:119]
v_cvt_pk_bf16_f32 v207, v158, v159
v_lshrrev_b32 v5, v5, v252
v_mfma_f32_16x16x32_bf16 a[84:87], a[244:247], v[216:219], a[84:87]
v_and_b32 v5, 3, v5
v_cmp_ne_u32 vcc, 1, v251
v_mfma_f32_16x16x32_bf16 a[52:55], a[244:247], v[212:215], a[52:55]
v_mul_u32_u24 v5, 16640, v5
v_add_u32 v5, s92, v5
v_mfma_f32_16x16x32_bf16 a[20:23], a[244:247], v[208:211], a[20:23]
v_cndmask_b32 v5, v250, v5, vcc
v_add_u32 v253, s58, v251
v_mfma_f32_16x16x32_bf16 a[24:27], a[248:251], v[208:211], a[24:27]
v_and_b32 v253, 3, v253
v_mul_u32_u24 v253, 4160, v253
v_mfma_f32_16x16x32_bf16 a[56:59], a[248:251], v[212:215], a[56:59]
v_add_u32 v5, v5, v253
v_mfma_f32_16x16x32_bf16 a[88:91], a[248:251], v[216:219], a[88:91]
s_add_u32 s73, s62, 480
v_lshlrev_b32 v248, 5, v240
v_sub_u32 v248, s73, v248
v_mfma_f32_16x16x32_bf16 a[120:123], a[248:251], v[220:223], a[120:123]
v_lshl_add_u32 v7, v241, 4, v248
v_mfma_f32_16x16x32_bf16 a[124:127], a[252:255], v[220:223], a[124:127]
s_and_b32 s73, s58, 1
v_mfma_f32_16x16x32_bf16 a[92:95], a[252:255], v[216:219], a[92:95]
s_lshl_b32 s73, s73, 4
v_mfma_f32_16x16x32_bf16 a[60:63], a[252:255], v[212:215], a[60:63]
s_lshr_b32 s73, s90, s73
v_mfma_f32_16x16x32_bf16 a[28:31], a[252:255], v[208:211], a[28:31]
s_and_b32 s73, s73, 0xffff
v_lshl_add_u32 v248, v241, 3, v240
v_sub_u32 v248, 15, v248
v_mfma_f32_16x16x32_bf16 v[224:227], v[120:123], v[208:211], v[224:227]
v_and_b32 v249, 1, v248
v_lshlrev_b32 v249, 4, v249
v_mfma_f32_16x16x32_bf16 v[228:231], v[120:123], v[212:215], v[228:231]
v_lshlrev_b32 v249, v249, s73
v_lshrrev_b32 v248, 1, v248
v_mfma_f32_16x16x32_bf16 v[232:235], v[120:123], v[216:219], v[232:235]
v_and_b32 v241, 3, v0
v_cmp_eq_u32 vcc, 0, v248
v_mfma_f32_16x16x32_bf16 v[236:239], v[120:123], v[220:223], v[236:239]
s_waitcnt lgkmcnt(8)
v_mfma_f32_16x16x32_bf16 v[136:139], a[128:131], v[48:51], v[88:91]
s_add_u32 s82, s82, 0x8000
ds_read_b128 a[160:163], v2 offset:24576
ds_read_b128 a[164:167], v2 offset:25600
v_mfma_f32_16x16x32_bf16 v[136:139], a[132:135], v[52:55], v[136:139]
s_and_b32 s82, s82, 0x1ffff
v_exp_f32 v164, v164
v_mfma_f32_16x16x32_bf16 v[136:139], a[136:139], v[56:59], v[136:139]
s_add_u32 m0, s74, 0
v_exp_f32 v165, v165
v_mfma_f32_16x16x32_bf16 v[136:139], a[140:143], v[60:63], v[136:139]
s_add_u32 s72, s81, 0
v_exp_f32 v166, v166
v_mfma_f32_16x16x32_bf16 v[140:143], a[140:143], v[76:79], v[92:95]
ds_read_b128 a[168:171], v2 offset:26624
v_cvt_pk_bf16_f32 v212, v164, v165
v_mfma_f32_16x16x32_bf16 v[140:143], a[136:139], v[72:75], v[140:143]
v_exp_f32 v167, v167
v_mfma_f32_16x16x32_bf16 v[140:143], a[132:135], v[68:71], v[140:143]
buffer_load_dwordx4 v1, s[44:47], s72 offen sc1 lds
v_mfma_f32_16x16x32_bf16 v[140:143], a[128:131], v[64:67], v[140:143]
v_exp_f32 v180, v180
v_mfma_f32_16x16x32_bf16 v[156:159], a[144:147], v[64:67], v[92:95]
ds_read_b128 a[172:175], v2 offset:27648
v_cvt_pk_bf16_f32 v213, v166, v167
v_mfma_f32_16x16x32_bf16 v[156:159], a[148:151], v[68:71], v[156:159]
v_exp_f32 v181, v181
v_mfma_f32_16x16x32_bf16 v[156:159], a[152:155], v[72:75], v[156:159]
ds_read_b128 a[176:179], v2 offset:28672
v_cvt_pk_bf16_f32 v214, v180, v181
v_mfma_f32_16x16x32_bf16 v[156:159], a[156:159], v[76:79], v[156:159]
v_exp_f32 v182, v182
v_mfma_f32_16x16x32_bf16 v[152:155], a[156:159], v[60:63], v[88:91]
v_exp_f32 v183, v183
v_mfma_f32_16x16x32_bf16 v[152:155], a[152:155], v[56:59], v[152:155]
ds_read_b128 a[180:183], v2 offset:29696
v_cvt_pk_bf16_f32 v215, v182, v183
v_mfma_f32_16x16x32_bf16 v[152:155], a[148:151], v[52:55], v[152:155]
v_exp_f32 v168, v168
v_mfma_f32_16x16x32_bf16 v[152:155], a[144:147], v[48:51], v[152:155]
s_waitcnt lgkmcnt(6)
ds_read_b128 a[184:187], v2 offset:30720
ds_read_b128 a[188:191], v2 offset:31744
v_mfma_f32_16x16x32_bf16 a[32:35], a[192:195], v[196:199], a[32:35]
v_exp_f32 v169, v169
v_mfma_f32_16x16x32_bf16 a[64:67], a[192:195], v[200:203], a[64:67]
buffer_load_dwordx4 v1, s[44:47], s72 offen offset:1024 sc1 lds
v_mfma_f32_16x16x32_bf16 a[96:99], a[192:195], v[204:207], a[96:99]
v_exp_f32 v170, v170
v_mfma_f32_16x16x32_bf16 a[100:103], a[196:199], v[204:207], a[100:103]
v_exp_f32 v171, v171
v_mfma_f32_16x16x32_bf16 a[68:71], a[196:199], v[200:203], a[68:71]
ds_read_b128 a[224:227], v2 offset:8192
v_cvt_pk_bf16_f32 v216, v168, v169
v_mfma_f32_16x16x32_bf16 a[36:39], a[196:199], v[196:199], a[36:39]
v_exp_f32 v184, v184
v_mfma_f32_16x16x32_bf16 a[40:43], a[200:203], v[196:199], a[40:43]
v_exp_f32 v185, v185
v_mfma_f32_16x16x32_bf16 a[72:75], a[200:203], v[200:203], a[72:75]
ds_read_b128 a[228:231], v2 offset:9216
v_cvt_pk_bf16_f32 v217, v170, v171
v_mfma_f32_16x16x32_bf16 a[104:107], a[200:203], v[204:207], a[104:107]
v_exp_f32 v186, v186
v_mfma_f32_16x16x32_bf16 a[108:111], a[204:207], v[204:207], a[108:111]
ds_read_b128 a[232:235], v2 offset:10240
v_cvt_pk_bf16_f32 v218, v184, v185
v_mfma_f32_16x16x32_bf16 a[76:79], a[204:207], v[200:203], a[76:79]
v_exp_f32 v187, v187
v_mfma_f32_16x16x32_bf16 a[44:47], a[204:207], v[196:199], a[44:47]
buffer_load_dwordx4 v1, s[44:47], s72 offen offset:2048 sc1 lds
v_mfma_f32_16x16x32_bf16 a[48:51], a[208:211], v[196:199], a[48:51]
v_exp_f32 v172, v172
v_mfma_f32_16x16x32_bf16 a[80:83], a[208:211], v[200:203], a[80:83]
ds_read_b128 a[236:239], v2 offset:11264
v_cvt_pk_bf16_f32 v219, v186, v187
v_mfma_f32_16x16x32_bf16 a[112:115], a[208:211], v[204:207], a[112:115]
v_exp_f32 v173, v173
v_mfma_f32_16x16x32_bf16 a[116:119], a[212:215], v[204:207], a[116:119]
ds_read_b128 a[240:243], v2 offset:12288
v_cvt_pk_bf16_f32 v220, v172, v173
v_mfma_f32_16x16x32_bf16 a[84:87], a[212:215], v[200:203], a[84:87]
v_exp_f32 v174, v174
v_mfma_f32_16x16x32_bf16 a[52:55], a[212:215], v[196:199], a[52:55]
v_exp_f32 v175, v175
v_mfma_f32_16x16x32_bf16 a[56:59], a[216:219], v[196:199], a[56:59]
ds_read_b128 a[244:247], v2 offset:13312
v_cvt_pk_bf16_f32 v221, v174, v175
v_mfma_f32_16x16x32_bf16 a[88:91], a[216:219], v[200:203], a[88:91]
v_exp_f32 v188, v188
v_mfma_f32_16x16x32_bf16 a[120:123], a[216:219], v[204:207], a[120:123]
ds_read_b128 a[248:251], v2 offset:14336
v_mfma_f32_16x16x32_bf16 a[124:127], a[220:223], v[204:207], a[124:127]
v_exp_f32 v189, v189
v_mfma_f32_16x16x32_bf16 a[92:95], a[220:223], v[200:203], a[92:95]
buffer_load_dwordx4 v1, s[44:47], s72 offen offset:3072 sc1 lds
v_mfma_f32_16x16x32_bf16 a[60:63], a[220:223], v[196:199], a[60:63]
ds_read_b128 a[252:255], v2 offset:15360
v_cvt_pk_bf16_f32 v222, v188, v189
v_mfma_f32_16x16x32_bf16 v[228:231], v[120:123], v[196:199], v[228:231]
v_exp_f32 v190, v190
v_mfma_f32_16x16x32_bf16 v[232:235], v[120:123], v[200:203], v[232:235]
s_waitcnt vmcnt(8) lgkmcnt(8)
v_exp_f32 v191, v191
v_mfma_f32_16x16x32_bf16 v[236:239], v[120:123], v[204:207], v[236:239]
s_barrier
v_cvt_pk_bf16_f32 v223, v190, v191
v_add_u32 v2, s82, v1
v_mfma_f32_16x16x32_bf16 v[168:171], a[160:163], v[48:51], v[88:91]
s_xor_b32 s74, s82, 0x10000
v_exp_f32 v136, v136
v_mfma_f32_16x16x32_bf16 v[168:171], a[164:167], v[52:55], v[168:171]
s_add_u32 s74, s74, s64
ds_read_b128 a[128:131], v2 offset:16384
v_mfma_f32_16x16x32_bf16 v[168:171], a[168:171], v[56:59], v[168:171]
s_add_u32 s81, s81, 0x8000
v_exp_f32 v137, v137
v_mfma_f32_16x16x32_bf16 v[168:171], a[172:175], v[60:63], v[168:171]
s_add_u32 m0, s74, 16384
ds_read_b128 a[132:135], v2 offset:17408
v_cvt_pk_bf16_f32 v200, v136, v137
v_mfma_f32_16x16x32_bf16 v[172:175], a[172:175], v[76:79], v[92:95]
s_add_u32 s72, s81, 16384
v_exp_f32 v138, v138
v_mfma_f32_16x16x32_bf16 v[172:175], a[168:171], v[72:75], v[172:175]
ds_read_b128 a[136:139], v2 offset:18432
v_lshl_add_u32 v5, v241, 3, v5
v_mfma_f32_16x16x32_bf16 v[172:175], a[164:167], v[68:71], v[172:175]
buffer_load_dwordx4 v1, s[44:47], s72 offen sc1 lds
v_mfma_f32_16x16x32_bf16 v[172:175], a[160:163], v[64:67], v[172:175]
v_exp_f32 v139, v139
v_mfma_f32_16x16x32_bf16 v[188:191], a[176:179], v[64:67], v[92:95]
ds_read_b128 a[140:143], v2 offset:19456
v_cvt_pk_bf16_f32 v201, v138, v139
v_mfma_f32_16x16x32_bf16 v[188:191], a[180:183], v[68:71], v[188:191]
v_exp_f32 v152, v152
v_mfma_f32_16x16x32_bf16 v[188:191], a[184:187], v[72:75], v[188:191]
ds_read_b128 a[144:147], v2 offset:20480
v_cndmask_b32 v8, 0, v249, vcc
v_mfma_f32_16x16x32_bf16 v[188:191], a[188:191], v[76:79], v[188:191]
v_exp_f32 v153, v153
v_mfma_f32_16x16x32_bf16 v[184:187], a[188:191], v[60:63], v[88:91]
ds_read_b128 a[148:151], v2 offset:21504
v_cvt_pk_bf16_f32 v202, v152, v153
v_mfma_f32_16x16x32_bf16 v[184:187], a[184:187], v[56:59], v[184:187]
v_exp_f32 v154, v154
v_mfma_f32_16x16x32_bf16 v[184:187], a[180:183], v[52:55], v[184:187]
ds_read_b128 a[152:155], v2 offset:22528
v_cmp_eq_u32 vcc, 1, v248
v_mfma_f32_16x16x32_bf16 v[184:187], a[176:179], v[48:51], v[184:187]
s_waitcnt lgkmcnt(7)
buffer_load_dwordx4 v1, s[44:47], s72 offen offset:1024 sc1 lds
v_mfma_f32_16x16x32_bf16 a[32:35], a[224:227], v[212:215], a[32:35]
v_exp_f32 v155, v155
v_mfma_f32_16x16x32_bf16 a[64:67], a[224:227], v[216:219], a[64:67]
ds_read_b128 a[156:159], v2 offset:23552
v_cvt_pk_bf16_f32 v203, v154, v155
v_mfma_f32_16x16x32_bf16 a[96:99], a[224:227], v[220:223], a[96:99]
v_exp_f32 v140, v140
v_mfma_f32_16x16x32_bf16 a[100:103], a[228:231], v[220:223], a[100:103]
ds_read_b128 a[192:195], v2 offset:0
v_lshlrev_b32 v240, 4, v251
v_mfma_f32_16x16x32_bf16 a[68:71], a[228:231], v[216:219], a[68:71]
v_exp_f32 v141, v141
v_mfma_f32_16x16x32_bf16 a[36:39], a[228:231], v[212:215], a[36:39]
ds_read_b128 a[196:199], v2 offset:1024
v_cvt_pk_bf16_f32 v204, v140, v141
v_mfma_f32_16x16x32_bf16 a[40:43], a[232:235], v[212:215], a[40:43]
v_exp_f32 v142, v142
v_mfma_f32_16x16x32_bf16 a[72:75], a[232:235], v[216:219], a[72:75]
ds_read_b128 a[200:203], v2 offset:2048
v_cndmask_b32 v9, 0, v249, vcc
v_mfma_f32_16x16x32_bf16 a[104:107], a[232:235], v[220:223], a[104:107]
buffer_load_dwordx4 v1, s[44:47], s72 offen offset:2048 sc1 lds
v_mfma_f32_16x16x32_bf16 a[108:111], a[236:239], v[220:223], a[108:111]
v_exp_f32 v143, v143
v_mfma_f32_16x16x32_bf16 a[76:79], a[236:239], v[216:219], a[76:79]
ds_read_b128 a[204:207], v2 offset:3072
v_cvt_pk_bf16_f32 v205, v142, v143
v_mfma_f32_16x16x32_bf16 a[44:47], a[236:239], v[212:215], a[44:47]
v_exp_f32 v156, v156
v_mfma_f32_16x16x32_bf16 a[48:51], a[240:243], v[212:215], a[48:51]
ds_read_b128 a[208:211], v2 offset:4096
v_cmp_eq_u32 vcc, 2, v248
v_mfma_f32_16x16x32_bf16 a[80:83], a[240:243], v[216:219], a[80:83]
v_exp_f32 v157, v157
v_mfma_f32_16x16x32_bf16 a[112:115], a[240:243], v[220:223], a[112:115]
ds_read_b128 a[212:215], v2 offset:5120
v_cvt_pk_bf16_f32 v206, v156, v157
v_mfma_f32_16x16x32_bf16 a[116:119], a[244:247], v[220:223], a[116:119]
v_exp_f32 v158, v158
v_mfma_f32_16x16x32_bf16 a[84:87], a[244:247], v[216:219], a[84:87]
ds_read_b128 a[216:219], v2 offset:6144
v_sub_u32 v240, 48, v240
v_mfma_f32_16x16x32_bf16 a[52:55], a[244:247], v[212:215], a[52:55]
buffer_load_dwordx4 v1, s[44:47], s72 offen offset:3072 sc1 lds
v_mfma_f32_16x16x32_bf16 a[56:59], a[248:251], v[212:215], a[56:59]
v_exp_f32 v159, v159
v_mfma_f32_16x16x32_bf16 a[88:91], a[248:251], v[216:219], a[88:91]
ds_read_b128 a[220:223], v2 offset:7168
v_cvt_pk_bf16_f32 v207, v158, v159
v_mfma_f32_16x16x32_bf16 a[120:123], a[248:251], v[220:223], a[120:123]
v_lshlrev_b64 v[12:13], 16, s[88:89]
v_cndmask_b32 v10, 0, v249, vcc
v_mfma_f32_16x16x32_bf16 a[124:127], a[252:255], v[220:223], a[124:127]
v_cmp_eq_u32 vcc, 3, v248
v_lshlrev_b64 v[12:13], v240, v[12:13]
v_mfma_f32_16x16x32_bf16 a[92:95], a[252:255], v[216:219], a[92:95]
v_cndmask_b32 v11, 0, v249, vcc
v_cmp_eq_u32 vcc, 3, v241
v_mfma_f32_16x16x32_bf16 a[60:63], a[252:255], v[212:215], a[60:63]
s_add_u32 s73, s62, 4096
v_lshl_add_u32 v14, v0, 3, s73
v_cndmask_b32 v12, 0, v12, vcc
v_mfma_f32_16x16x32_bf16 v[228:231], v[120:123], v[212:215], v[228:231]
v_cndmask_b32 v13, 0, v13, vcc
v_lshrrev_b32 v15, 4, v0
v_mfma_f32_16x16x32_bf16 v[232:235], v[120:123], v[216:219], v[232:235]
v_lshlrev_b32 v15, 1, v15
v_and_b32 v240, 7, v0
v_mfma_f32_16x16x32_bf16 v[236:239], v[120:123], v[220:223], v[236:239]
s_waitcnt lgkmcnt(8)
v_xor_b32 v15, v15, v240
v_lshlrev_b32 v15, 4, v15
v_lshrrev_b32 v240, 3, v0
v_lshl_add_u32 v15, v240, 11, v15
s_lshr_b32 s75, s59, 3
s_lshl_b32 s75, s75, 2
s_add_u32 s75, s75, s65
s_lshl_b32 s76, s59, 1
s_and_b32 s76, s76, 8
s_add_u32 s76, s76, s60
s_lshl_b32 s94, s58, 16
s_lshl_b32 s80, s76, 7
s_add_u32 s94, s94, s80
s_lshl_b32 s80, s75, 18
s_add_u32 s80, s80, s94
v_rcp_f32 v224, v224
v_rcp_f32 v228, v228
s_lshl_b32 s73, s59, 12
s_add_u32 s73, s73, 0x2000000
s_lshl_b32 s70, s67, 2
s_add_u32 s70, s70, s73
v_mov_b32 v225, v224
v_accvgpr_read_b32 v240, a0
v_accvgpr_read_b32 v241, a1
v_accvgpr_read_b32 v242, a2
v_accvgpr_read_b32 v243, a3
v_accvgpr_read_b32 v244, a4
v_accvgpr_read_b32 v245, a5
v_accvgpr_read_b32 v246, a6
v_accvgpr_read_b32 v247, a7
v_pk_mul_f32 v[240:241], v[240:241], v[224:225]
v_pk_mul_f32 v[242:243], v[242:243], v[224:225]
v_pk_mul_f32 v[244:245], v[244:245], v[224:225]
v_pk_mul_f32 v[246:247], v[246:247], v[224:225]
v_cvt_pk_bf16_f32 v128, v240, v241
v_cvt_pk_bf16_f32 v129, v242, v243
v_cvt_pk_bf16_f32 v130, v244, v245
v_cvt_pk_bf16_f32 v131, v246, v247
v_accvgpr_read_b32 v248, a8
v_accvgpr_read_b32 v249, a9
v_accvgpr_read_b32 v250, a10
v_accvgpr_read_b32 v251, a11
v_accvgpr_read_b32 v252, a12
v_accvgpr_read_b32 v253, a13
v_accvgpr_read_b32 v254, a14
v_accvgpr_read_b32 v255, a15
v_pk_mul_f32 v[248:249], v[248:249], v[224:225]
v_pk_mul_f32 v[250:251], v[250:251], v[224:225]
v_pk_mul_f32 v[252:253], v[252:253], v[224:225]
v_pk_mul_f32 v[254:255], v[254:255], v[224:225]
v_cvt_pk_bf16_f32 v144, v248, v249
v_cvt_pk_bf16_f32 v145, v250, v251
v_cvt_pk_bf16_f32 v146, v252, v253
v_cvt_pk_bf16_f32 v147, v254, v255
v_accvgpr_read_b32 v240, a16
v_accvgpr_read_b32 v241, a17
v_accvgpr_read_b32 v242, a18
v_accvgpr_read_b32 v243, a19
v_accvgpr_read_b32 v244, a20
v_accvgpr_read_b32 v245, a21
v_accvgpr_read_b32 v246, a22
v_accvgpr_read_b32 v247, a23
v_pk_mul_f32 v[240:241], v[240:241], v[224:225]
v_pk_mul_f32 v[242:243], v[242:243], v[224:225]
v_pk_mul_f32 v[244:245], v[244:245], v[224:225]
v_pk_mul_f32 v[246:247], v[246:247], v[224:225]
v_cvt_pk_bf16_f32 v160, v240, v241
v_cvt_pk_bf16_f32 v161, v242, v243
v_cvt_pk_bf16_f32 v162, v244, v245
v_cvt_pk_bf16_f32 v163, v246, v247
v_accvgpr_read_b32 v248, a24
v_accvgpr_read_b32 v249, a25
v_accvgpr_read_b32 v250, a26
v_accvgpr_read_b32 v251, a27
v_accvgpr_read_b32 v252, a28
v_accvgpr_read_b32 v253, a29
v_accvgpr_read_b32 v254, a30
v_accvgpr_read_b32 v255, a31
v_pk_mul_f32 v[248:249], v[248:249], v[224:225]
v_pk_mul_f32 v[250:251], v[250:251], v[224:225]
v_pk_mul_f32 v[252:253], v[252:253], v[224:225]
v_pk_mul_f32 v[254:255], v[254:255], v[224:225]
v_cvt_pk_bf16_f32 v176, v248, v249
v_cvt_pk_bf16_f32 v177, v250, v251
v_cvt_pk_bf16_f32 v178, v252, v253
v_cvt_pk_bf16_f32 v179, v254, v255
v_mov_b32 v229, v228
v_accvgpr_read_b32 v240, a32
v_accvgpr_read_b32 v241, a33
v_accvgpr_read_b32 v242, a34
v_accvgpr_read_b32 v243, a35
v_accvgpr_read_b32 v244, a36
v_accvgpr_read_b32 v245, a37
v_accvgpr_read_b32 v246, a38
v_accvgpr_read_b32 v247, a39
v_pk_mul_f32 v[240:241], v[240:241], v[228:229]
v_pk_mul_f32 v[242:243], v[242:243], v[228:229]
v_pk_mul_f32 v[244:245], v[244:245], v[228:229]
v_pk_mul_f32 v[246:247], v[246:247], v[228:229]
v_cvt_pk_bf16_f32 v132, v240, v241
v_cvt_pk_bf16_f32 v133, v242, v243
v_cvt_pk_bf16_f32 v134, v244, v245
v_cvt_pk_bf16_f32 v135, v246, v247
v_accvgpr_read_b32 v248, a40
v_accvgpr_read_b32 v249, a41
v_accvgpr_read_b32 v250, a42
v_accvgpr_read_b32 v251, a43
v_accvgpr_read_b32 v252, a44
v_accvgpr_read_b32 v253, a45
v_accvgpr_read_b32 v254, a46
v_accvgpr_read_b32 v255, a47
v_pk_mul_f32 v[248:249], v[248:249], v[228:229]
v_pk_mul_f32 v[250:251], v[250:251], v[228:229]
v_pk_mul_f32 v[252:253], v[252:253], v[228:229]
v_pk_mul_f32 v[254:255], v[254:255], v[228:229]
v_cvt_pk_bf16_f32 v148, v248, v249
v_cvt_pk_bf16_f32 v149, v250, v251
v_cvt_pk_bf16_f32 v150, v252, v253
v_cvt_pk_bf16_f32 v151, v254, v255
v_accvgpr_read_b32 v240, a48
v_accvgpr_read_b32 v241, a49
v_accvgpr_read_b32 v242, a50
v_accvgpr_read_b32 v243, a51
v_accvgpr_read_b32 v244, a52
v_accvgpr_read_b32 v245, a53
v_accvgpr_read_b32 v246, a54
v_accvgpr_read_b32 v247, a55
v_pk_mul_f32 v[240:241], v[240:241], v[228:229]
v_pk_mul_f32 v[242:243], v[242:243], v[228:229]
v_pk_mul_f32 v[244:245], v[244:245], v[228:229]
v_pk_mul_f32 v[246:247], v[246:247], v[228:229]
v_cvt_pk_bf16_f32 v164, v240, v241
v_cvt_pk_bf16_f32 v165, v242, v243
v_cvt_pk_bf16_f32 v166, v244, v245
v_cvt_pk_bf16_f32 v167, v246, v247
v_accvgpr_read_b32 v248, a56
v_accvgpr_read_b32 v249, a57
v_accvgpr_read_b32 v250, a58
v_accvgpr_read_b32 v251, a59
v_accvgpr_read_b32 v252, a60
v_accvgpr_read_b32 v253, a61
v_accvgpr_read_b32 v254, a62
v_accvgpr_read_b32 v255, a63
v_pk_mul_f32 v[248:249], v[248:249], v[228:229]
v_pk_mul_f32 v[250:251], v[250:251], v[228:229]
v_pk_mul_f32 v[252:253], v[252:253], v[228:229]
v_pk_mul_f32 v[254:255], v[254:255], v[228:229]
v_cvt_pk_bf16_f32 v180, v248, v249
v_cvt_pk_bf16_f32 v181, v250, v251
v_cvt_pk_bf16_f32 v182, v252, v253
v_cvt_pk_bf16_f32 v183, v254, v255
v_mfma_f32_16x16x32_bf16 v[136:139], a[128:131], v[48:51], v[88:91]
s_add_u32 s82, s82, 0x8000
ds_read_b128 a[160:163], v2 offset:24576
ds_read_b128 a[164:167], v2 offset:25600
v_mfma_f32_16x16x32_bf16 v[136:139], a[132:135], v[52:55], v[136:139]
s_and_b32 s82, s82, 0x1ffff
v_exp_f32 v168, v168
v_mfma_f32_16x16x32_bf16 v[136:139], a[136:139], v[56:59], v[136:139]
s_add_u32 m0, s74, 0
v_exp_f32 v169, v169
v_mfma_f32_16x16x32_bf16 v[136:139], a[140:143], v[60:63], v[136:139]
s_add_u32 s72, s81, 0
buffer_load_dwordx4 v1, s[44:47], s72 offen sc1 lds
v_mfma_f32_16x16x32_bf16 v[140:143], a[140:143], v[76:79], v[92:95]
ds_read_b128 a[168:171], v2 offset:26624
v_cvt_pk_bf16_f32 v216, v168, v169
v_mfma_f32_16x16x32_bf16 v[140:143], a[136:139], v[72:75], v[140:143]
v_exp_f32 v170, v170
v_mfma_f32_16x16x32_bf16 v[140:143], a[132:135], v[68:71], v[140:143]
ds_read_b128 a[172:175], v2 offset:27648
ds_read_b128 a[176:179], v2 offset:28672
v_mfma_f32_16x16x32_bf16 v[140:143], a[128:131], v[64:67], v[140:143]
v_exp_f32 v171, v171
v_mfma_f32_16x16x32_bf16 v[156:159], a[144:147], v[64:67], v[92:95]
v_exp_f32 v184, v184
v_mfma_f32_16x16x32_bf16 v[156:159], a[148:151], v[68:71], v[156:159]
buffer_store_dwordx4 v[128:131], v1, s[44:47], s70 offen sc1
v_mfma_f32_16x16x32_bf16 v[156:159], a[152:155], v[72:75], v[156:159]
ds_read_b128 a[180:183], v2 offset:29696
v_cvt_pk_bf16_f32 v217, v170, v171
v_mfma_f32_16x16x32_bf16 v[156:159], a[156:159], v[76:79], v[156:159]
v_exp_f32 v185, v185
v_mfma_f32_16x16x32_bf16 v[152:155], a[156:159], v[60:63], v[88:91]
ds_read_b128 a[184:187], v2 offset:30720
v_cvt_pk_bf16_f32 v218, v184, v185
v_mfma_f32_16x16x32_bf16 v[152:155], a[152:155], v[56:59], v[152:155]
v_exp_f32 v186, v186
v_mfma_f32_16x16x32_bf16 v[152:155], a[148:151], v[52:55], v[152:155]
buffer_load_dwordx4 v1, s[44:47], s72 offen offset:1024 sc1 lds
v_mfma_f32_16x16x32_bf16 v[152:155], a[144:147], v[48:51], v[152:155]
s_waitcnt lgkmcnt(7)
ds_read_b128 a[188:191], v2 offset:31744
ds_read_b128 a[224:227], v2 offset:8192
v_mfma_f32_16x16x32_bf16 a[64:67], a[192:195], v[200:203], a[64:67]
v_exp_f32 v187, v187
v_mfma_f32_16x16x32_bf16 a[96:99], a[192:195], v[204:207], a[96:99]
v_exp_f32 v172, v172
v_mfma_f32_16x16x32_bf16 a[100:103], a[196:199], v[204:207], a[100:103]
ds_read_b128 a[228:231], v2 offset:9216
v_cvt_pk_bf16_f32 v219, v186, v187
v_mfma_f32_16x16x32_bf16 a[68:71], a[196:199], v[200:203], a[68:71]
v_exp_f32 v173, v173
v_mfma_f32_16x16x32_bf16 a[72:75], a[200:203], v[200:203], a[72:75]
buffer_store_dwordx4 v[144:147], v1, s[44:47], s70 offen offset:1024 sc1
v_mfma_f32_16x16x32_bf16 a[104:107], a[200:203], v[204:207], a[104:107]
ds_read_b128 a[232:235], v2 offset:10240
v_cvt_pk_bf16_f32 v220, v172, v173
v_mfma_f32_16x16x32_bf16 a[108:111], a[204:207], v[204:207], a[108:111]
v_exp_f32 v174, v174
v_mfma_f32_16x16x32_bf16 a[76:79], a[204:207], v[200:203], a[76:79]
ds_read_b128 a[236:239], v2 offset:11264
ds_read_b128 a[240:243], v2 offset:12288
v_mfma_f32_16x16x32_bf16 a[80:83], a[208:211], v[200:203], a[80:83]
v_exp_f32 v175, v175
v_mfma_f32_16x16x32_bf16 a[112:115], a[208:211], v[204:207], a[112:115]
buffer_load_dwordx4 v1, s[44:47], s72 offen offset:2048 sc1 lds
v_mfma_f32_16x16x32_bf16 a[116:119], a[212:215], v[204:207], a[116:119]
v_exp_f32 v188, v188
v_mfma_f32_16x16x32_bf16 a[84:87], a[212:215], v[200:203], a[84:87]
ds_read_b128 a[244:247], v2 offset:13312
v_cvt_pk_bf16_f32 v221, v174, v175
v_mfma_f32_16x16x32_bf16 a[88:91], a[216:219], v[200:203], a[88:91]
v_exp_f32 v189, v189
v_mfma_f32_16x16x32_bf16 a[120:123], a[216:219], v[204:207], a[120:123]
ds_read_b128 a[248:251], v2 offset:14336
ds_read_b128 a[252:255], v2 offset:15360
v_mfma_f32_16x16x32_bf16 a[124:127], a[220:223], v[204:207], a[124:127]
v_exp_f32 v190, v190
v_mfma_f32_16x16x32_bf16 a[92:95], a[220:223], v[200:203], a[92:95]
buffer_load_dwordx4 v1, s[44:47], s72 offen offset:3072 sc1 lds
v_mfma_f32_16x16x32_bf16 v[232:235], v[120:123], v[200:203], v[232:235]
s_waitcnt vmcnt(10) lgkmcnt(8)
v_exp_f32 v191, v191
v_mfma_f32_16x16x32_bf16 v[236:239], v[120:123], v[204:207], v[236:239]
s_barrier
v_cvt_pk_bf16_f32 v222, v188, v189
v_cvt_pk_bf16_f32 v223, v190, v191
v_add_u32 v2, s82, v1
v_mfma_f32_16x16x32_bf16 v[168:171], a[160:163], v[48:51], v[88:91]
s_xor_b32 s74, s82, 0x10000
v_exp_f32 v136, v136
v_mfma_f32_16x16x32_bf16 v[168:171], a[164:167], v[52:55], v[168:171]
s_add_u32 s74, s74, s64
ds_read_b128 a[128:131], v2 offset:16384
ds_read_b128 a[132:135], v2 offset:17408
v_mfma_f32_16x16x32_bf16 v[168:171], a[168:171], v[56:59], v[168:171]
s_add_u32 s81, s81, 0x8000
v_exp_f32 v137, v137
v_mfma_f32_16x16x32_bf16 v[168:171], a[172:175], v[60:63], v[168:171]
s_add_u32 m0, s74, 16384
v_exp_f32 v138, v138
v_mfma_f32_16x16x32_bf16 v[172:175], a[172:175], v[76:79], v[92:95]
s_add_u32 s72, s81, 16384
buffer_load_dwordx4 v1, s[44:47], s72 offen sc1 lds
v_mfma_f32_16x16x32_bf16 v[172:175], a[168:171], v[72:75], v[172:175]
ds_read_b128 a[136:139], v2 offset:18432
v_cvt_pk_bf16_f32 v200, v136, v137
v_mfma_f32_16x16x32_bf16 v[172:175], a[164:167], v[68:71], v[172:175]
v_exp_f32 v139, v139
v_mfma_f32_16x16x32_bf16 v[172:175], a[160:163], v[64:67], v[172:175]
ds_read_b128 a[140:143], v2 offset:19456
v_cvt_pk_bf16_f32 v201, v138, v139
v_mfma_f32_16x16x32_bf16 v[188:191], a[176:179], v[64:67], v[92:95]
Lstub5:
s_cbranch_execz Lstub9
buffer_store_dwordx4 v[160:163], v1, s[44:47], s70 offen offset:2048 sc1
v_mfma_f32_16x16x32_bf16 v[188:191], a[180:183], v[68:71], v[188:191]
v_exp_f32 v152, v152
v_mfma_f32_16x16x32_bf16 v[188:191], a[184:187], v[72:75], v[188:191]
ds_read_b128 a[144:147], v2 offset:20480
ds_read_b128 a[148:151], v2 offset:21504
v_mfma_f32_16x16x32_bf16 v[188:191], a[188:191], v[76:79], v[188:191]
v_exp_f32 v153, v153
v_mfma_f32_16x16x32_bf16 v[184:187], a[188:191], v[60:63], v[88:91]
buffer_load_dwordx4 v1, s[44:47], s72 offen offset:1024 sc1 lds
v_mfma_f32_16x16x32_bf16 v[184:187], a[184:187], v[56:59], v[184:187]
v_exp_f32 v154, v154
v_mfma_f32_16x16x32_bf16 v[184:187], a[180:183], v[52:55], v[184:187]
ds_read_b128 a[152:155], v2 offset:22528
v_cvt_pk_bf16_f32 v202, v152, v153
v_mfma_f32_16x16x32_bf16 v[184:187], a[176:179], v[48:51], v[184:187]
s_waitcnt lgkmcnt(7)
v_exp_f32 v155, v155
v_mfma_f32_16x16x32_bf16 a[64:67], a[224:227], v[216:219], a[64:67]
ds_read_b128 a[156:159], v2 offset:23552
v_cvt_pk_bf16_f32 v203, v154, v155
v_mfma_f32_16x16x32_bf16 a[96:99], a[224:227], v[220:223], a[96:99]
v_exp_f32 v140, v140
v_mfma_f32_16x16x32_bf16 a[100:103], a[228:231], v[220:223], a[100:103]
ds_read_b128 a[192:195], v2 offset:0
ds_read_b128 a[196:199], v2 offset:1024
v_mfma_f32_16x16x32_bf16 a[68:71], a[228:231], v[216:219], a[68:71]
buffer_store_dwordx4 v[176:179], v1, s[44:47], s70 offen offset:3072 sc1
v_mfma_f32_16x16x32_bf16 a[72:75], a[232:235], v[216:219], a[72:75]
v_exp_f32 v141, v141
v_mfma_f32_16x16x32_bf16 a[104:107], a[232:235], v[220:223], a[104:107]
v_exp_f32 v142, v142
v_mfma_f32_16x16x32_bf16 a[108:111], a[236:239], v[220:223], a[108:111]
ds_read_b128 a[200:203], v2 offset:2048
ds_read_b128 a[204:207], v2 offset:3072
v_mfma_f32_16x16x32_bf16 a[76:79], a[236:239], v[216:219], a[76:79]
buffer_load_dwordx4 v1, s[44:47], s72 offen offset:2048 sc1 lds
v_mfma_f32_16x16x32_bf16 a[80:83], a[240:243], v[216:219], a[80:83]
s_add_u32 s70, s70, 0x80000
v_exp_f32 v143, v143
v_mfma_f32_16x16x32_bf16 a[112:115], a[240:243], v[220:223], a[112:115]
v_exp_f32 v156, v156
v_mfma_f32_16x16x32_bf16 a[116:119], a[244:247], v[220:223], a[116:119]
ds_read_b128 a[208:211], v2 offset:4096
ds_read_b128 a[212:215], v2 offset:5120
v_mfma_f32_16x16x32_bf16 a[84:87], a[244:247], v[216:219], a[84:87]
ds_read_b128 a[216:219], v2 offset:6144
ds_read_b128 a[220:223], v2 offset:7168
v_mfma_f32_16x16x32_bf16 a[88:91], a[248:251], v[216:219], a[88:91]
v_cvt_pk_bf16_f32 v204, v140, v141
v_cvt_pk_bf16_f32 v205, v142, v143
v_mfma_f32_16x16x32_bf16 a[120:123], a[248:251], v[220:223], a[120:123]
buffer_store_dwordx4 v[132:135], v1, s[44:47], s70 offen sc1
v_mfma_f32_16x16x32_bf16 a[124:127], a[252:255], v[220:223], a[124:127]
v_exp_f32 v157, v157
v_mfma_f32_16x16x32_bf16 a[92:95], a[252:255], v[216:219], a[92:95]
v_exp_f32 v158, v158
v_mfma_f32_16x16x32_bf16 v[232:235], v[120:123], v[216:219], v[232:235]
buffer_load_dwordx4 v1, s[44:47], s72 offen offset:3072 sc1 lds
v_mfma_f32_16x16x32_bf16 v[236:239], v[120:123], v[220:223], v[236:239]
s_waitcnt lgkmcnt(8)
v_exp_f32 v159, v159
v_cvt_pk_bf16_f32 v206, v156, v157
v_cvt_pk_bf16_f32 v207, v158, v159
v_mfma_f32_16x16x32_bf16 v[136:139], a[128:131], v[48:51], v[88:91]
s_add_u32 s82, s82, 0x8000
ds_read_b128 a[160:163], v2 offset:24576
ds_read_b128 a[164:167], v2 offset:25600
v_mfma_f32_16x16x32_bf16 v[136:139], a[132:135], v[52:55], v[136:139]
s_and_b32 s82, s82, 0x1ffff
v_exp_f32 v168, v168
v_mfma_f32_16x16x32_bf16 v[136:139], a[136:139], v[56:59], v[136:139]
s_add_u32 m0, s74, 0
v_exp_f32 v169, v169
v_mfma_f32_16x16x32_bf16 v[136:139], a[140:143], v[60:63], v[136:139]
s_add_u32 s72, s81, 0
buffer_load_dwordx4 v1, s[44:47], s72 offen sc1 lds
v_mfma_f32_16x16x32_bf16 v[140:143], a[140:143], v[76:79], v[92:95]
ds_read_b128 a[168:171], v2 offset:26624
v_cvt_pk_bf16_f32 v216, v168, v169
v_mfma_f32_16x16x32_bf16 v[140:143], a[136:139], v[72:75], v[140:143]
v_exp_f32 v170, v170
v_mfma_f32_16x16x32_bf16 v[140:143], a[132:135], v[68:71], v[140:143]
ds_read_b128 a[172:175], v2 offset:27648
ds_read_b128 a[176:179], v2 offset:28672
v_mfma_f32_16x16x32_bf16 v[140:143], a[128:131], v[64:67], v[140:143]
v_exp_f32 v171, v171
v_mfma_f32_16x16x32_bf16 v[156:159], a[144:147], v[64:67], v[92:95]
buffer_store_dwordx4 v[148:151], v1, s[44:47], s70 offen offset:1024 sc1
v_mfma_f32_16x16x32_bf16 v[156:159], a[148:151], v[68:71], v[156:159]
v_exp_f32 v184, v184
v_mfma_f32_16x16x32_bf16 v[156:159], a[152:155], v[72:75], v[156:159]
ds_read_b128 a[180:183], v2 offset:29696
v_cvt_pk_bf16_f32 v217, v170, v171
v_mfma_f32_16x16x32_bf16 v[156:159], a[156:159], v[76:79], v[156:159]
v_exp_f32 v185, v185
v_mfma_f32_16x16x32_bf16 v[152:155], a[156:159], v[60:63], v[88:91]
buffer_load_dwordx4 v1, s[44:47], s72 offen offset:1024 sc1 lds
v_mfma_f32_16x16x32_bf16 v[152:155], a[152:155], v[56:59], v[152:155]
ds_read_b128 a[184:187], v2 offset:30720
v_cvt_pk_bf16_f32 v218, v184, v185
v_mfma_f32_16x16x32_bf16 v[152:155], a[148:151], v[52:55], v[152:155]
v_exp_f32 v186, v186
v_mfma_f32_16x16x32_bf16 v[152:155], a[144:147], v[48:51], v[152:155]
s_waitcnt lgkmcnt(7)
ds_read_b128 a[188:191], v2 offset:31744
ds_read_b128 a[224:227], v2 offset:8192
v_mfma_f32_16x16x32_bf16 a[64:67], a[192:195], v[200:203], a[64:67]
v_exp_f32 v187, v187
v_mfma_f32_16x16x32_bf16 a[96:99], a[192:195], v[204:207], a[96:99]
buffer_store_dwordx4 v[164:167], v1, s[44:47], s70 offen offset:2048 sc1
v_mfma_f32_16x16x32_bf16 a[100:103], a[196:199], v[204:207], a[100:103]
v_exp_f32 v172, v172
v_mfma_f32_16x16x32_bf16 a[68:71], a[196:199], v[200:203], a[68:71]
ds_read_b128 a[228:231], v2 offset:9216
v_cvt_pk_bf16_f32 v219, v186, v187
v_mfma_f32_16x16x32_bf16 a[72:75], a[200:203], v[200:203], a[72:75]
v_exp_f32 v173, v173
v_mfma_f32_16x16x32_bf16 a[104:107], a[200:203], v[204:207], a[104:107]
ds_read_b128 a[232:235], v2 offset:10240
ds_read_b128 a[236:239], v2 offset:11264
v_mfma_f32_16x16x32_bf16 a[108:111], a[204:207], v[204:207], a[108:111]
v_exp_f32 v174, v174
v_mfma_f32_16x16x32_bf16 a[76:79], a[204:207], v[200:203], a[76:79]
buffer_load_dwordx4 v1, s[44:47], s72 offen offset:2048 sc1 lds
v_mfma_f32_16x16x32_bf16 a[80:83], a[208:211], v[200:203], a[80:83]
v_exp_f32 v175, v175
v_mfma_f32_16x16x32_bf16 a[112:115], a[208:211], v[204:207], a[112:115]
ds_read_b128 a[240:243], v2 offset:12288
ds_read_b128 a[244:247], v2 offset:13312
v_mfma_f32_16x16x32_bf16 a[116:119], a[212:215], v[204:207], a[116:119]
v_exp_f32 v188, v188
v_mfma_f32_16x16x32_bf16 a[84:87], a[212:215], v[200:203], a[84:87]
ds_read_b128 a[248:251], v2 offset:14336
ds_read_b128 a[252:255], v2 offset:15360
v_mfma_f32_16x16x32_bf16 a[88:91], a[216:219], v[200:203], a[88:91]
v_cvt_pk_bf16_f32 v220, v172, v173
v_cvt_pk_bf16_f32 v221, v174, v175
v_mfma_f32_16x16x32_bf16 a[120:123], a[216:219], v[204:207], a[120:123]
buffer_store_dwordx4 v[180:183], v1, s[44:47], s70 offen offset:3072 sc1
v_mfma_f32_16x16x32_bf16 a[124:127], a[220:223], v[204:207], a[124:127]
v_exp_f32 v189, v189
v_mfma_f32_16x16x32_bf16 a[92:95], a[220:223], v[200:203], a[92:95]
buffer_load_dwordx4 v1, s[44:47], s72 offen offset:3072 sc1 lds
v_mfma_f32_16x16x32_bf16 v[232:235], v[120:123], v[200:203], v[232:235]
s_waitcnt vmcnt(14) lgkmcnt(8)
v_exp_f32 v190, v190
v_mfma_f32_16x16x32_bf16 v[236:239], v[120:123], v[204:207], v[236:239]
s_barrier
v_exp_f32 v191, v191
v_add_u32 v2, s82, v1
v_cvt_pk_bf16_f32 v222, v188, v189
v_cvt_pk_bf16_f32 v223, v190, v191
s_lshl_b32 s83, s60, 2
s_sub_u32 s83, s83, 25
.p2align 5
s_nop 0
s_nop 0
LloopII:
v_mfma_f32_16x16x32_bf16 v[168:171], a[160:163], v[48:51], v[88:91]
s_xor_b32 s74, s82, 0x10000
v_exp_f32 v136, v136
v_mfma_f32_16x16x32_bf16 v[168:171], a[164:167], v[52:55], v[168:171]
s_add_u32 s74, s74, s64
ds_read_b128 a[128:131], v2 offset:16384
ds_read_b128 a[132:135], v2 offset:17408
v_mfma_f32_16x16x32_bf16 v[168:171], a[168:171], v[56:59], v[168:171]
s_add_u32 s81, s81, 0x8000
v_exp_f32 v137, v137
v_mfma_f32_16x16x32_bf16 v[168:171], a[172:175], v[60:63], v[168:171]
s_add_u32 m0, s74, 16384
v_exp_f32 v138, v138
v_mfma_f32_16x16x32_bf16 v[172:175], a[172:175], v[76:79], v[92:95]
s_add_u32 s72, s81, 16384
ds_read_b128 a[136:139], v2 offset:18432
v_cvt_pk_bf16_f32 v200, v136, v137
v_mfma_f32_16x16x32_bf16 v[172:175], a[168:171], v[72:75], v[172:175]
buffer_load_dwordx4 v1, s[44:47], s72 offen sc1 lds
v_mfma_f32_16x16x32_bf16 v[172:175], a[164:167], v[68:71], v[172:175]
v_exp_f32 v139, v139
v_mfma_f32_16x16x32_bf16 v[172:175], a[160:163], v[64:67], v[172:175]
ds_read_b128 a[140:143], v2 offset:19456
v_cvt_pk_bf16_f32 v201, v138, v139
v_mfma_f32_16x16x32_bf16 v[188:191], a[176:179], v[64:67], v[92:95]
v_exp_f32 v152, v152
v_mfma_f32_16x16x32_bf16 v[188:191], a[180:183], v[68:71], v[188:191]
ds_read_b128 a[144:147], v2 offset:20480
ds_read_b128 a[148:151], v2 offset:21504
v_mfma_f32_16x16x32_bf16 v[188:191], a[184:187], v[72:75], v[188:191]
v_exp_f32 v153, v153
v_mfma_f32_16x16x32_bf16 v[188:191], a[188:191], v[76:79], v[188:191]
v_exp_f32 v154, v154
v_mfma_f32_16x16x32_bf16 v[184:187], a[188:191], v[60:63], v[88:91]
ds_read_b128 a[152:155], v2 offset:22528
v_cvt_pk_bf16_f32 v202, v152, v153
v_mfma_f32_16x16x32_bf16 v[184:187], a[184:187], v[56:59], v[184:187]
buffer_load_dwordx4 v1, s[44:47], s72 offen offset:1024 sc1 lds
v_mfma_f32_16x16x32_bf16 v[184:187], a[180:183], v[52:55], v[184:187]
v_exp_f32 v155, v155
v_mfma_f32_16x16x32_bf16 v[184:187], a[176:179], v[48:51], v[184:187]
s_waitcnt lgkmcnt(7)
ds_read_b128 a[156:159], v2 offset:23552
v_cvt_pk_bf16_f32 v203, v154, v155
v_mfma_f32_16x16x32_bf16 a[64:67], a[224:227], v[216:219], a[64:67]
v_exp_f32 v140, v140
v_mfma_f32_16x16x32_bf16 a[96:99], a[224:227], v[220:223], a[96:99]
ds_read_b128 a[192:195], v2 offset:0
ds_read_b128 a[196:199], v2 offset:1024
v_mfma_f32_16x16x32_bf16 a[100:103], a[228:231], v[220:223], a[100:103]
v_exp_f32 v141, v141
v_mfma_f32_16x16x32_bf16 a[68:71], a[228:231], v[216:219], a[68:71]
v_exp_f32 v142, v142
v_mfma_f32_16x16x32_bf16 a[72:75], a[232:235], v[216:219], a[72:75]
ds_read_b128 a[200:203], v2 offset:2048
v_cvt_pk_bf16_f32 v204, v140, v141
v_mfma_f32_16x16x32_bf16 a[104:107], a[232:235], v[220:223], a[104:107]
buffer_load_dwordx4 v1, s[44:47], s72 offen offset:2048 sc1 lds
v_mfma_f32_16x16x32_bf16 a[108:111], a[236:239], v[220:223], a[108:111]
v_exp_f32 v143, v143
v_mfma_f32_16x16x32_bf16 a[76:79], a[236:239], v[216:219], a[76:79]
ds_read_b128 a[204:207], v2 offset:3072
v_cvt_pk_bf16_f32 v205, v142, v143
v_mfma_f32_16x16x32_bf16 a[80:83], a[240:243], v[216:219], a[80:83]
v_exp_f32 v156, v156
v_mfma_f32_16x16x32_bf16 a[112:115], a[240:243], v[220:223], a[112:115]
ds_read_b128 a[208:211], v2 offset:4096
v_mfma_f32_16x16x32_bf16 a[116:119], a[244:247], v[220:223], a[116:119]
v_exp_f32 v157, v157
v_mfma_f32_16x16x32_bf16 a[84:87], a[244:247], v[216:219], a[84:87]
ds_read_b128 a[212:215], v2 offset:5120
v_cvt_pk_bf16_f32 v206, v156, v157
v_mfma_f32_16x16x32_bf16 a[88:91], a[248:251], v[216:219], a[88:91]
v_exp_f32 v158, v158
v_mfma_f32_16x16x32_bf16 a[120:123], a[248:251], v[220:223], a[120:123]
ds_read_b128 a[216:219], v2 offset:6144
v_mfma_f32_16x16x32_bf16 a[124:127], a[252:255], v[220:223], a[124:127]
buffer_load_dwordx4 v1, s[44:47], s72 offen offset:3072 sc1 lds
v_mfma_f32_16x16x32_bf16 a[92:95], a[252:255], v[216:219], a[92:95]
v_exp_f32 v159, v159
v_mfma_f32_16x16x32_bf16 v[232:235], v[120:123], v[216:219], v[232:235]
ds_read_b128 a[220:223], v2 offset:7168
v_cvt_pk_bf16_f32 v207, v158, v159
v_mfma_f32_16x16x32_bf16 v[236:239], v[120:123], v[220:223], v[236:239]
s_waitcnt lgkmcnt(8)
v_mfma_f32_16x16x32_bf16 v[136:139], a[128:131], v[48:51], v[88:91]
s_add_u32 s82, s82, 0x8000
ds_read_b128 a[160:163], v2 offset:24576
ds_read_b128 a[164:167], v2 offset:25600
v_mfma_f32_16x16x32_bf16 v[136:139], a[132:135], v[52:55], v[136:139]
s_and_b32 s82, s82, 0x1ffff
v_exp_f32 v168, v168
v_mfma_f32_16x16x32_bf16 v[136:139], a[136:139], v[56:59], v[136:139]
s_add_u32 m0, s74, 0
v_exp_f32 v169, v169
v_mfma_f32_16x16x32_bf16 v[136:139], a[140:143], v[60:63], v[136:139]
s_add_u32 s72, s81, 0
ds_read_b128 a[168:171], v2 offset:26624
v_cvt_pk_bf16_f32 v216, v168, v169
v_mfma_f32_16x16x32_bf16 v[140:143], a[140:143], v[76:79], v[92:95]
v_exp_f32 v170, v170
v_mfma_f32_16x16x32_bf16 v[140:143], a[136:139], v[72:75], v[140:143]
buffer_load_dwordx4 v1, s[44:47], s72 offen sc1 lds
v_mfma_f32_16x16x32_bf16 v[140:143], a[132:135], v[68:71], v[140:143]
ds_read_b128 a[172:175], v2 offset:27648
ds_read_b128 a[176:179], v2 offset:28672
v_mfma_f32_16x16x32_bf16 v[140:143], a[128:131], v[64:67], v[140:143]
v_exp_f32 v171, v171
v_mfma_f32_16x16x32_bf16 v[156:159], a[144:147], v[64:67], v[92:95]
v_exp_f32 v184, v184
v_mfma_f32_16x16x32_bf16 v[156:159], a[148:151], v[68:71], v[156:159]
ds_read_b128 a[180:183], v2 offset:29696
v_cvt_pk_bf16_f32 v217, v170, v171
v_mfma_f32_16x16x32_bf16 v[156:159], a[152:155], v[72:75], v[156:159]
v_exp_f32 v185, v185
v_mfma_f32_16x16x32_bf16 v[156:159], a[156:159], v[76:79], v[156:159]
ds_read_b128 a[184:187], v2 offset:30720
v_cvt_pk_bf16_f32 v218, v184, v185
v_mfma_f32_16x16x32_bf16 v[152:155], a[156:159], v[60:63], v[88:91]
buffer_load_dwordx4 v1, s[44:47], s72 offen offset:1024 sc1 lds
v_mfma_f32_16x16x32_bf16 v[152:155], a[152:155], v[56:59], v[152:155]
v_exp_f32 v186, v186
v_mfma_f32_16x16x32_bf16 v[152:155], a[148:151], v[52:55], v[152:155]
ds_read_b128 a[188:191], v2 offset:31744
ds_read_b128 a[224:227], v2 offset:8192
v_mfma_f32_16x16x32_bf16 v[152:155], a[144:147], v[48:51], v[152:155]
s_waitcnt lgkmcnt(9)
v_exp_f32 v187, v187
v_mfma_f32_16x16x32_bf16 a[64:67], a[192:195], v[200:203], a[64:67]
v_exp_f32 v172, v172
v_mfma_f32_16x16x32_bf16 a[96:99], a[192:195], v[204:207], a[96:99]
ds_read_b128 a[228:231], v2 offset:9216
v_cvt_pk_bf16_f32 v219, v186, v187
v_mfma_f32_16x16x32_bf16 a[100:103], a[196:199], v[204:207], a[100:103]
v_exp_f32 v173, v173
v_mfma_f32_16x16x32_bf16 a[68:71], a[196:199], v[200:203], a[68:71]
ds_read_b128 a[232:235], v2 offset:10240
v_cvt_pk_bf16_f32 v220, v172, v173
v_mfma_f32_16x16x32_bf16 a[72:75], a[200:203], v[200:203], a[72:75]
buffer_load_dwordx4 v1, s[44:47], s72 offen offset:2048 sc1 lds
v_mfma_f32_16x16x32_bf16 a[104:107], a[200:203], v[204:207], a[104:107]
v_exp_f32 v174, v174
v_mfma_f32_16x16x32_bf16 a[108:111], a[204:207], v[204:207], a[108:111]
ds_read_b128 a[236:239], v2 offset:11264
ds_read_b128 a[240:243], v2 offset:12288
v_mfma_f32_16x16x32_bf16 a[76:79], a[204:207], v[200:203], a[76:79]
v_exp_f32 v175, v175
v_mfma_f32_16x16x32_bf16 a[80:83], a[208:211], v[200:203], a[80:83]
v_exp_f32 v188, v188
v_mfma_f32_16x16x32_bf16 a[112:115], a[208:211], v[204:207], a[112:115]
ds_read_b128 a[244:247], v2 offset:13312
v_cvt_pk_bf16_f32 v221, v174, v175
v_mfma_f32_16x16x32_bf16 a[116:119], a[212:215], v[204:207], a[116:119]
v_exp_f32 v189, v189
v_mfma_f32_16x16x32_bf16 a[84:87], a[212:215], v[200:203], a[84:87]
ds_read_b128 a[248:251], v2 offset:14336
v_cvt_pk_bf16_f32 v222, v188, v189
v_mfma_f32_16x16x32_bf16 a[88:91], a[216:219], v[200:203], a[88:91]
buffer_load_dwordx4 v1, s[44:47], s72 offen offset:3072 sc1 lds
v_mfma_f32_16x16x32_bf16 a[120:123], a[216:219], v[204:207], a[120:123]
ds_read_b128 a[252:255], v2 offset:15360
v_add_u32 v2, s82, v1
v_mfma_f32_16x16x32_bf16 a[124:127], a[220:223], v[204:207], a[124:127]
s_waitcnt vmcnt(8) lgkmcnt(8)
v_exp_f32 v190, v190
v_mfma_f32_16x16x32_bf16 a[92:95], a[220:223], v[200:203], a[92:95]
s_barrier
v_exp_f32 v191, v191
v_mfma_f32_16x16x32_bf16 v[232:235], v[120:123], v[200:203], v[232:235]
s_add_u32 s83, s83, 1
v_cvt_pk_bf16_f32 v223, v190, v191
v_mfma_f32_16x16x32_bf16 v[236:239], v[120:123], v[204:207], v[236:239]
s_cbranch_scc0 LloopII
v_mfma_f32_16x16x32_bf16 v[168:171], a[160:163], v[48:51], v[88:91]
s_xor_b32 s74, s82, 0x10000
ds_read_b128 a[128:131], v2 offset:16384
ds_read_b128 a[132:135], v2 offset:17408
v_mfma_f32_16x16x32_bf16 v[168:171], a[164:167], v[52:55], v[168:171]
s_add_u32 s74, s74, s64
v_exp_f32 v136, v136
v_mfma_f32_16x16x32_bf16 v[168:171], a[168:171], v[56:59], v[168:171]
s_add_u32 s81, s81, 0x8000
v_exp_f32 v137, v137
v_mfma_f32_16x16x32_bf16 v[168:171], a[172:175], v[60:63], v[168:171]
s_add_u32 m0, s74, 0
ds_read_b128 a[136:139], v2 offset:18432
v_cvt_pk_bf16_f32 v200, v136, v137
v_mfma_f32_16x16x32_bf16 v[172:175], a[172:175], v[76:79], v[92:95]
s_add_u32 s72, s81, 0
v_exp_f32 v138, v138
v_mfma_f32_16x16x32_bf16 v[172:175], a[168:171], v[72:75], v[172:175]
buffer_load_dwordx4 v1, s[44:47], s72 offen sc1 lds
v_mfma_f32_16x16x32_bf16 v[172:175], a[164:167], v[68:71], v[172:175]
ds_read_b128 a[140:143], v2 offset:19456
ds_read_b128 a[144:147], v2 offset:20480
v_mfma_f32_16x16x32_bf16 v[172:175], a[160:163], v[64:67], v[172:175]
v_exp_f32 v139, v139
v_mfma_f32_16x16x32_bf16 v[188:191], a[176:179], v[64:67], v[92:95]
v_exp_f32 v152, v152
v_mfma_f32_16x16x32_bf16 v[188:191], a[180:183], v[68:71], v[188:191]
ds_read_b128 a[148:151], v2 offset:21504
v_cvt_pk_bf16_f32 v201, v138, v139
v_mfma_f32_16x16x32_bf16 v[188:191], a[184:187], v[72:75], v[188:191]
v_exp_f32 v153, v153
v_mfma_f32_16x16x32_bf16 v[188:191], a[188:191], v[76:79], v[188:191]
ds_read_b128 a[152:155], v2 offset:22528
v_cvt_pk_bf16_f32 v202, v152, v153
v_mfma_f32_16x16x32_bf16 v[184:187], a[188:191], v[60:63], v[88:91]
v_exp_f32 v154, v154
v_mfma_f32_16x16x32_bf16 v[184:187], a[184:187], v[56:59], v[184:187]
buffer_load_dwordx4 v1, s[44:47], s72 offen offset:1024 sc1 lds
v_mfma_f32_16x16x32_bf16 v[184:187], a[180:183], v[52:55], v[184:187]
ds_read_b128 a[156:159], v2 offset:23552
ds_read_b128 a[192:195], v2 offset:0
v_mfma_f32_16x16x32_bf16 v[184:187], a[176:179], v[48:51], v[184:187]
s_waitcnt lgkmcnt(9)
v_exp_f32 v155, v155
v_mfma_f32_16x16x32_bf16 a[64:67], a[224:227], v[216:219], a[64:67]
v_exp_f32 v140, v140
v_mfma_f32_16x16x32_bf16 a[96:99], a[224:227], v[220:223], a[96:99]
ds_read_b128 a[196:199], v2 offset:1024
v_cvt_pk_bf16_f32 v203, v154, v155
v_mfma_f32_16x16x32_bf16 a[100:103], a[228:231], v[220:223], a[100:103]
v_exp_f32 v141, v141
v_mfma_f32_16x16x32_bf16 a[68:71], a[228:231], v[216:219], a[68:71]
ds_read_b128 a[200:203], v2 offset:2048
v_cvt_pk_bf16_f32 v204, v140, v141
v_mfma_f32_16x16x32_bf16 a[72:75], a[232:235], v[216:219], a[72:75]
v_exp_f32 v142, v142
v_mfma_f32_16x16x32_bf16 a[104:107], a[232:235], v[220:223], a[104:107]
buffer_load_dwordx4 v1, s[44:47], s72 offen offset:2048 sc1 lds
v_mfma_f32_16x16x32_bf16 a[108:111], a[236:239], v[220:223], a[108:111]
ds_read_b128 a[204:207], v2 offset:3072
v_mfma_f32_16x16x32_bf16 a[76:79], a[236:239], v[216:219], a[76:79]
v_exp_f32 v143, v143
v_mfma_f32_16x16x32_bf16 a[80:83], a[240:243], v[216:219], a[80:83]
ds_read_b128 a[208:211], v2 offset:4096
v_cvt_pk_bf16_f32 v205, v142, v143
v_mfma_f32_16x16x32_bf16 a[112:115], a[240:243], v[220:223], a[112:115]
v_exp_f32 v156, v156
v_mfma_f32_16x16x32_bf16 a[116:119], a[244:247], v[220:223], a[116:119]
ds_read_b128 a[212:215], v2 offset:5120
v_mfma_f32_16x16x32_bf16 a[84:87], a[244:247], v[216:219], a[84:87]
v_exp_f32 v157, v157
v_mfma_f32_16x16x32_bf16 a[88:91], a[248:251], v[216:219], a[88:91]
ds_read_b128 a[216:219], v2 offset:6144
v_cvt_pk_bf16_f32 v206, v156, v157
v_mfma_f32_16x16x32_bf16 a[120:123], a[248:251], v[220:223], a[120:123]
buffer_load_dwordx4 v1, s[44:47], s72 offen offset:3072 sc1 lds
v_mfma_f32_16x16x32_bf16 a[124:127], a[252:255], v[220:223], a[124:127]
v_exp_f32 v158, v158
v_mfma_f32_16x16x32_bf16 a[92:95], a[252:255], v[216:219], a[92:95]
ds_read_b128 a[220:223], v2 offset:7168
v_mfma_f32_16x16x32_bf16 v[232:235], v[120:123], v[216:219], v[232:235]
s_waitcnt lgkmcnt(8)
v_exp_f32 v159, v159
v_mfma_f32_16x16x32_bf16 v[236:239], v[120:123], v[220:223], v[236:239]
s_barrier
v_cvt_pk_bf16_f32 v207, v158, v159
s_cmp_eq_u32 s58, 0
s_cbranch_scc1 Lta28
s_cmp_eq_u32 s58, 1
s_cbranch_scc1 Lnt29
v_mfma_f32_16x16x32_bf16 v[136:139], a[128:131], v[48:51], v[88:91]
s_add_u32 s82, s82, 0x8000
ds_read_b128 a[160:163], v2 offset:24576
ds_read_b128 a[164:167], v2 offset:25600
v_mfma_f32_16x16x32_bf16 v[152:155], a[144:147], v[48:51], v[88:91]
s_and_b32 s82, s82, 0x1ffff
v_exp_f32 v168, v168
s_branch Ljoin30
Lta28:
v_mfma_f32_16x16x32_bf16 v[136:139], a[128:131], v[48:51], v[104:107]
s_add_u32 s82, s82, 0x8000
ds_read_b128 a[160:163], v2 offset:24576
ds_read_b128 a[164:167], v2 offset:25600
v_mfma_f32_16x16x32_bf16 v[152:155], a[144:147], v[48:51], v[112:115]
s_and_b32 s82, s82, 0x1ffff
v_exp_f32 v168, v168
s_branch Ljoin30
Lnt29:
v_mfma_f32_16x16x32_bf16 v[136:139], a[128:131], v[48:51], v[88:91]
s_add_u32 s82, s82, 0x8000
ds_read_b128 a[160:163], v2 offset:24576
ds_read_b128 a[164:167], v2 offset:25600
v_mfma_f32_16x16x32_bf16 v[152:155], a[144:147], v[48:51], v[104:107]
s_and_b32 s82, s82, 0x1ffff
v_exp_f32 v168, v168
Ljoin30:
v_mfma_f32_16x16x32_bf16 v[136:139], a[132:135], v[52:55], v[136:139]
s_add_u32 s66, s58, 3
v_exp_f32 v169, v169
v_mfma_f32_16x16x32_bf16 v[136:139], a[136:139], v[56:59], v[136:139]
s_and_b32 s66, s66, 3
ds_read_b128 a[168:171], v2 offset:26624
v_cvt_pk_bf16_f32 v216, v168, v169
v_mfma_f32_16x16x32_bf16 v[136:139], a[140:143], v[60:63], v[136:139]
s_mul_i32 s66, s66, 4160
v_exp_f32 v170, v170
v_mfma_f32_16x16x32_bf16 v[140:143], a[140:143], v[76:79], v[92:95]
s_add_u32 s66, s66, s92
ds_read_b128 a[172:175], v2 offset:27648
ds_read_b128 a[176:179], v2 offset:28672
v_mfma_f32_16x16x32_bf16 v[140:143], a[136:139], v[72:75], v[140:143]
s_add_u32 m0, s66, 32
v_exp_f32 v171, v171
v_mfma_f32_16x16x32_bf16 v[140:143], a[132:135], v[68:71], v[140:143]
s_add_u32 s72, s93, 0x6
buffer_load_dwordx4 v1, s[36:39], s72 offen lds
v_mfma_f32_16x16x32_bf16 v[140:143], a[128:131], v[64:67], v[140:143]
v_exp_f32 v184, v184
v_mfma_f32_16x16x32_bf16 v[156:159], a[144:147], v[64:67], v[92:95]
ds_read_b128 a[180:183], v2 offset:29696
v_cvt_pk_bf16_f32 v217, v170, v171
v_mfma_f32_16x16x32_bf16 v[156:159], a[148:151], v[68:71], v[156:159]
v_exp_f32 v185, v185
v_mfma_f32_16x16x32_bf16 v[156:159], a[152:155], v[72:75], v[156:159]
ds_read_b128 a[184:187], v2 offset:30720
v_cvt_pk_bf16_f32 v218, v184, v185
v_mfma_f32_16x16x32_bf16 v[156:159], a[156:159], v[76:79], v[156:159]
v_exp_f32 v186, v186
v_mfma_f32_16x16x32_bf16 v[152:155], a[156:159], v[60:63], v[152:155]
buffer_load_dwordx4 v1, s[36:39], s72 offen offset:1024 lds
v_mfma_f32_16x16x32_bf16 v[152:155], a[152:155], v[56:59], v[152:155]
ds_read_b128 a[188:191], v2 offset:31744
ds_read_b128 a[224:227], v2 offset:8192
v_mfma_f32_16x16x32_bf16 v[152:155], a[148:151], v[52:55], v[152:155]
s_waitcnt lgkmcnt(9)
v_exp_f32 v187, v187
v_mfma_f32_16x16x32_bf16 a[64:67], a[192:195], v[200:203], a[64:67]
v_exp_f32 v172, v172
v_mfma_f32_16x16x32_bf16 a[96:99], a[192:195], v[204:207], a[96:99]
ds_read_b128 a[228:231], v2 offset:9216
v_cvt_pk_bf16_f32 v219, v186, v187
v_mfma_f32_16x16x32_bf16 a[100:103], a[196:199], v[204:207], a[100:103]
v_exp_f32 v173, v173
v_mfma_f32_16x16x32_bf16 a[68:71], a[196:199], v[200:203], a[68:71]
ds_read_b128 a[232:235], v2 offset:10240
v_cvt_pk_bf16_f32 v220, v172, v173
v_mfma_f32_16x16x32_bf16 a[72:75], a[200:203], v[200:203], a[72:75]
v_exp_f32 v174, v174
v_mfma_f32_16x16x32_bf16 a[104:107], a[200:203], v[204:207], a[104:107]
buffer_load_dwordx4 v1, s[36:39], s72 offen offset:2048 lds
v_mfma_f32_16x16x32_bf16 a[108:111], a[204:207], v[204:207], a[108:111]
ds_read_b128 a[236:239], v2 offset:11264
v_mfma_f32_16x16x32_bf16 a[76:79], a[204:207], v[200:203], a[76:79]
v_exp_f32 v175, v175
v_mfma_f32_16x16x32_bf16 a[80:83], a[208:211], v[200:203], a[80:83]
ds_read_b128 a[240:243], v2 offset:12288
v_cvt_pk_bf16_f32 v221, v174, v175
v_mfma_f32_16x16x32_bf16 a[112:115], a[208:211], v[204:207], a[112:115]
v_exp_f32 v188, v188
v_mfma_f32_16x16x32_bf16 a[116:119], a[212:215], v[204:207], a[116:119]
ds_read_b128 a[244:247], v2 offset:13312
v_mfma_f32_16x16x32_bf16 a[84:87], a[212:215], v[200:203], a[84:87]
v_exp_f32 v189, v189
v_mfma_f32_16x16x32_bf16 a[88:91], a[216:219], v[200:203], a[88:91]
ds_read_b128 a[248:251], v2 offset:14336
v_cvt_pk_bf16_f32 v222, v188, v189
v_mfma_f32_16x16x32_bf16 a[120:123], a[216:219], v[204:207], a[120:123]
buffer_load_dwordx4 v1, s[36:39], s72 offen offset:3072 lds
v_mfma_f32_16x16x32_bf16 a[124:127], a[220:223], v[204:207], a[124:127]
v_exp_f32 v190, v190
v_mfma_f32_16x16x32_bf16 a[92:95], a[220:223], v[200:203], a[92:95]
ds_read_b128 a[252:255], v2 offset:15360
v_add_u32 v2, s82, v1
v_mfma_f32_16x16x32_bf16 v[232:235], v[120:123], v[200:203], v[232:235]
s_waitcnt vmcnt(8) lgkmcnt(0)
v_exp_f32 v191, v191
v_mfma_f32_16x16x32_bf16 v[236:239], v[120:123], v[204:207], v[236:239]
s_barrier
v_cvt_pk_bf16_f32 v223, v190, v191
s_cmp_eq_u32 s58, 2
s_cbranch_scc1 Lta31
s_cmp_eq_u32 s58, 3
s_cbranch_scc1 Lnt32
v_mfma_f32_16x16x32_bf16 v[168:171], a[160:163], v[48:51], v[112:115]
s_mov_b32 m0, s62
v_exp_f32 v136, v136
v_mfma_f32_16x16x32_bf16 v[184:187], a[176:179], v[48:51], v[112:115]
s_add_u32 s72, s93, 0x3000000
ds_read_b128 a[128:131], v2 offset:16384
ds_read_b128 a[132:135], v2 offset:17408
s_branch Ljoin33
Lta31:
v_mfma_f32_16x16x32_bf16 v[168:171], a[160:163], v[48:51], v[104:107]
s_mov_b32 m0, s62
v_exp_f32 v136, v136
v_mfma_f32_16x16x32_bf16 v[184:187], a[176:179], v[48:51], v[112:115]
s_add_u32 s72, s93, 0x3000000
ds_read_b128 a[128:131], v2 offset:16384
ds_read_b128 a[132:135], v2 offset:17408
s_branch Ljoin33
Lnt32:
v_mfma_f32_16x16x32_bf16 v[168:171], a[160:163], v[48:51], v[88:91]
s_mov_b32 m0, s62
v_exp_f32 v136, v136
v_mfma_f32_16x16x32_bf16 v[184:187], a[176:179], v[48:51], v[104:107]
s_add_u32 s72, s93, 0x3000000
ds_read_b128 a[128:131], v2 offset:16384
ds_read_b128 a[132:135], v2 offset:17408
Ljoin33:
v_mfma_f32_16x16x32_bf16 v[168:171], a[164:167], v[52:55], v[168:171]
v_exp_f32 v137, v137
v_mfma_f32_16x16x32_bf16 v[168:171], a[168:171], v[56:59], v[168:171]
buffer_load_dwordx4 v1, s[44:47], s72 offen sc1 lds
v_mfma_f32_16x16x32_bf16 v[168:171], a[172:175], v[60:63], v[168:171]
v_exp_f32 v138, v138
v_mfma_f32_16x16x32_bf16 v[172:175], a[172:175], v[76:79], v[92:95]
ds_read_b128 a[136:139], v2 offset:18432
v_cvt_pk_bf16_f32 v200, v136, v137
v_mfma_f32_16x16x32_bf16 v[172:175], a[168:171], v[72:75], v[172:175]
v_exp_f32 v139, v139
v_mfma_f32_16x16x32_bf16 v[172:175], a[164:167], v[68:71], v[172:175]
ds_read_b128 a[140:143], v2 offset:19456
v_cvt_pk_bf16_f32 v201, v138, v139
v_mfma_f32_16x16x32_bf16 v[172:175], a[160:163], v[64:67], v[172:175]
v_exp_f32 v152, v152
v_mfma_f32_16x16x32_bf16 v[188:191], a[176:179], v[64:67], v[92:95]
ds_read_b128 a[144:147], v2 offset:20480
ds_read_b128 a[148:151], v2 offset:21504
v_mfma_f32_16x16x32_bf16 v[188:191], a[180:183], v[68:71], v[188:191]
buffer_load_dwordx4 v1, s[44:47], s72 offen offset:1024 sc1 lds
v_mfma_f32_16x16x32_bf16 v[188:191], a[184:187], v[72:75], v[188:191]
v_exp_f32 v153, v153
v_mfma_f32_16x16x32_bf16 v[188:191], a[188:191], v[76:79], v[188:191]
v_exp_f32 v154, v154
v_mfma_f32_16x16x32_bf16 v[184:187], a[188:191], v[60:63], v[184:187]
ds_read_b128 a[152:155], v2 offset:22528
v_cvt_pk_bf16_f32 v202, v152, v153
v_mfma_f32_16x16x32_bf16 v[184:187], a[184:187], v[56:59], v[184:187]
buffer_load_dwordx4 v1, s[44:47], s72 offen offset:2048 sc1 lds
v_mfma_f32_16x16x32_bf16 v[184:187], a[180:183], v[52:55], v[184:187]
s_waitcnt lgkmcnt(7)
v_exp_f32 v155, v155
v_mfma_f32_16x16x32_bf16 a[64:67], a[224:227], v[216:219], a[64:67]
Lstub6:
s_cbranch_execz Lstub10
ds_read_b128 a[156:159], v2 offset:23552
v_cvt_pk_bf16_f32 v203, v154, v155
v_mfma_f32_16x16x32_bf16 a[96:99], a[224:227], v[220:223], a[96:99]
v_exp_f32 v140, v140
v_mfma_f32_16x16x32_bf16 a[100:103], a[228:231], v[220:223], a[100:103]
ds_read_b128 a[192:195], v2 offset:0
ds_read_b128 a[196:199], v2 offset:1024
v_mfma_f32_16x16x32_bf16 a[68:71], a[228:231], v[216:219], a[68:71]
v_exp_f32 v141, v141
v_mfma_f32_16x16x32_bf16 a[72:75], a[232:235], v[216:219], a[72:75]
buffer_load_dwordx4 v1, s[44:47], s72 offen offset:3072 sc1 lds
v_mfma_f32_16x16x32_bf16 a[104:107], a[232:235], v[220:223], a[104:107]
s_add_u32 s66, s58, 0
v_exp_f32 v142, v142
v_mfma_f32_16x16x32_bf16 a[108:111], a[236:239], v[220:223], a[108:111]
s_and_b32 s66, s66, 3
ds_read_b128 a[200:203], v2 offset:2048
v_cvt_pk_bf16_f32 v204, v140, v141
v_mfma_f32_16x16x32_bf16 a[76:79], a[236:239], v[216:219], a[76:79]
s_mul_i32 s66, s66, 4160
v_exp_f32 v143, v143
v_mfma_f32_16x16x32_bf16 a[80:83], a[240:243], v[216:219], a[80:83]
s_add_u32 s66, s66, s92
ds_read_b128 a[204:207], v2 offset:3072
v_cvt_pk_bf16_f32 v205, v142, v143
v_mfma_f32_16x16x32_bf16 a[112:115], a[240:243], v[220:223], a[112:115]
s_add_u32 m0, s66, 16672
v_exp_f32 v156, v156
v_mfma_f32_16x16x32_bf16 a[116:119], a[244:247], v[220:223], a[116:119]
s_add_u32 s72, s93, 0x0
ds_read_b128 a[208:211], v2 offset:4096
ds_read_b128 a[212:215], v2 offset:5120
v_mfma_f32_16x16x32_bf16 a[84:87], a[244:247], v[216:219], a[84:87]
buffer_load_dwordx4 v1, s[36:39], s72 offen lds
v_mfma_f32_16x16x32_bf16 a[88:91], a[248:251], v[216:219], a[88:91]
v_exp_f32 v157, v157
v_mfma_f32_16x16x32_bf16 a[120:123], a[248:251], v[220:223], a[120:123]
v_exp_f32 v158, v158
v_mfma_f32_16x16x32_bf16 a[124:127], a[252:255], v[220:223], a[124:127]
ds_read_b128 a[216:219], v2 offset:6144
ds_read_b128 a[220:223], v2 offset:7168
v_mfma_f32_16x16x32_bf16 a[92:95], a[252:255], v[216:219], a[92:95]
buffer_load_dwordx4 v1, s[36:39], s72 offen offset:1024 lds
v_mfma_f32_16x16x32_bf16 v[232:235], v[120:123], v[216:219], v[232:235]
v_exp_f32 v159, v159
v_mfma_f32_16x16x32_bf16 v[236:239], v[120:123], v[220:223], v[236:239]
s_waitcnt lgkmcnt(8)
v_cvt_pk_bf16_f32 v206, v156, v157
v_cvt_pk_bf16_f32 v207, v158, v159
s_cmp_eq_u32 s58, 0
s_cbranch_scc1 Lta34
s_cmp_eq_u32 s58, 1
s_cbranch_scc1 Lnt35
v_mfma_f32_16x16x32_bf16 v[140:143], a[128:131], v[64:67], v[92:95]
s_add_u32 s82, s82, 0x8000
ds_read_b128 a[160:163], v2 offset:24576
ds_read_b128 a[164:167], v2 offset:25600
v_mfma_f32_16x16x32_bf16 v[156:159], a[144:147], v[64:67], v[92:95]
s_and_b32 s82, s82, 0x1ffff
v_exp_f32 v168, v168
s_branch Ljoin36
Lta34:
v_mfma_f32_16x16x32_bf16 v[140:143], a[128:131], v[64:67], v[108:111]
s_add_u32 s82, s82, 0x8000
ds_read_b128 a[160:163], v2 offset:24576
ds_read_b128 a[164:167], v2 offset:25600
v_mfma_f32_16x16x32_bf16 v[156:159], a[144:147], v[64:67], v[112:115]
s_and_b32 s82, s82, 0x1ffff
v_exp_f32 v168, v168
s_branch Ljoin36
Lnt35:
v_mfma_f32_16x16x32_bf16 v[140:143], a[128:131], v[64:67], v[92:95]
s_add_u32 s82, s82, 0x8000
ds_read_b128 a[160:163], v2 offset:24576
ds_read_b128 a[164:167], v2 offset:25600
v_mfma_f32_16x16x32_bf16 v[156:159], a[144:147], v[64:67], v[108:111]
s_and_b32 s82, s82, 0x1ffff
v_exp_f32 v168, v168
Ljoin36:
v_mfma_f32_16x16x32_bf16 v[140:143], a[132:135], v[68:71], v[140:143]
v_exp_f32 v169, v169
v_mfma_f32_16x16x32_bf16 v[140:143], a[136:139], v[72:75], v[140:143]
ds_read_b128 a[168:171], v2 offset:26624
ds_read_b128 a[172:175], v2 offset:27648
v_mfma_f32_16x16x32_bf16 v[140:143], a[140:143], v[76:79], v[140:143]
v_exp_f32 v170, v170
v_mfma_f32_16x16x32_bf16 v[156:159], a[156:159], v[76:79], v[156:159]
v_exp_f32 v171, v171
v_mfma_f32_16x16x32_bf16 v[156:159], a[152:155], v[72:75], v[156:159]
ds_read_b128 a[176:179], v2 offset:28672
ds_read_b128 a[180:183], v2 offset:29696
v_mfma_f32_16x16x32_bf16 v[156:159], a[148:151], v[68:71], v[156:159]
s_waitcnt lgkmcnt(6)
v_exp_f32 v184, v184
v_mfma_f32_16x16x32_bf16 a[64:67], a[192:195], v[200:203], a[64:67]
ds_read_b128 a[184:187], v2 offset:30720
ds_read_b128 a[188:191], v2 offset:31744
v_mfma_f32_16x16x32_bf16 a[96:99], a[192:195], v[204:207], a[96:99]
ds_read_b128 a[224:227], v2 offset:8192
ds_read_b128 a[228:231], v2 offset:9216
v_mfma_f32_16x16x32_bf16 a[100:103], a[196:199], v[204:207], a[100:103]
ds_read_b128 a[232:235], v2 offset:10240
ds_read_b128 a[236:239], v2 offset:11264
v_mfma_f32_16x16x32_bf16 a[68:71], a[196:199], v[200:203], a[68:71]
ds_read_b128 a[240:243], v2 offset:12288
ds_read_b128 a[244:247], v2 offset:13312
v_mfma_f32_16x16x32_bf16 a[72:75], a[200:203], v[200:203], a[72:75]
ds_read_b128 a[248:251], v2 offset:14336
ds_read_b128 a[252:255], v2 offset:15360
v_mfma_f32_16x16x32_bf16 a[104:107], a[200:203], v[204:207], a[104:107]
v_cvt_pk_bf16_f32 v216, v168, v169
v_cvt_pk_bf16_f32 v217, v170, v171
v_mfma_f32_16x16x32_bf16 a[108:111], a[204:207], v[204:207], a[108:111]
buffer_load_dwordx4 v1, s[36:39], s72 offen offset:2048 lds
v_mfma_f32_16x16x32_bf16 a[76:79], a[204:207], v[200:203], a[76:79]
v_exp_f32 v185, v185
v_mfma_f32_16x16x32_bf16 a[80:83], a[208:211], v[200:203], a[80:83]
v_exp_f32 v186, v186
v_mfma_f32_16x16x32_bf16 a[112:115], a[208:211], v[204:207], a[112:115]
v_exp_f32 v187, v187
v_mfma_f32_16x16x32_bf16 a[116:119], a[212:215], v[204:207], a[116:119]
v_exp_f32 v172, v172
v_mfma_f32_16x16x32_bf16 a[84:87], a[212:215], v[200:203], a[84:87]
v_cvt_pk_bf16_f32 v218, v184, v185
v_cvt_pk_bf16_f32 v219, v186, v187
v_mfma_f32_16x16x32_bf16 a[88:91], a[216:219], v[200:203], a[88:91]
v_exp_f32 v173, v173
v_mfma_f32_16x16x32_bf16 a[120:123], a[216:219], v[204:207], a[120:123]
v_exp_f32 v174, v174
v_mfma_f32_16x16x32_bf16 a[124:127], a[220:223], v[204:207], a[124:127]
v_exp_f32 v175, v175
v_mfma_f32_16x16x32_bf16 a[92:95], a[220:223], v[200:203], a[92:95]
buffer_load_dwordx4 v1, s[36:39], s72 offen offset:3072 lds
v_mfma_f32_16x16x32_bf16 v[232:235], v[120:123], v[200:203], v[232:235]
s_waitcnt vmcnt(12) lgkmcnt(8)
v_exp_f32 v188, v188
v_mfma_f32_16x16x32_bf16 v[236:239], v[120:123], v[204:207], v[236:239]
s_barrier
v_cvt_pk_bf16_f32 v220, v172, v173
v_cvt_pk_bf16_f32 v221, v174, v175
v_add_u32 v2, s82, v1
v_exp_f32 v189, v189
v_exp_f32 v190, v190
v_cvt_pk_bf16_f32 v222, v188, v189
v_exp_f32 v191, v191
s_nop 0
v_cvt_pk_bf16_f32 v223, v190, v191
s_cmp_eq_u32 s58, 2
s_cbranch_scc1 Lta37
s_cmp_eq_u32 s58, 3
s_cbranch_scc1 Lnt38
v_mfma_f32_16x16x32_bf16 v[172:175], a[160:163], v[64:67], v[112:115]
s_add_u32 s66, s58, 2
v_exp_f32 v140, v140
v_mfma_f32_16x16x32_bf16 v[188:191], a[176:179], v[64:67], v[112:115]
s_and_b32 s66, s66, 3
ds_read_b128 a[192:195], v2 offset:0
s_branch Ljoin39
Lta37:
v_mfma_f32_16x16x32_bf16 v[172:175], a[160:163], v[64:67], v[108:111]
s_add_u32 s66, s58, 2
v_exp_f32 v140, v140
v_mfma_f32_16x16x32_bf16 v[188:191], a[176:179], v[64:67], v[112:115]
s_and_b32 s66, s66, 3
ds_read_b128 a[192:195], v2 offset:0
s_branch Ljoin39
Lnt38:
v_mfma_f32_16x16x32_bf16 v[172:175], a[160:163], v[64:67], v[92:95]
s_add_u32 s66, s58, 2
v_exp_f32 v140, v140
v_mfma_f32_16x16x32_bf16 v[188:191], a[176:179], v[64:67], v[108:111]
s_and_b32 s66, s66, 3
ds_read_b128 a[192:195], v2 offset:0
Ljoin39:
v_mfma_f32_16x16x32_bf16 v[172:175], a[164:167], v[68:71], v[172:175]
s_mul_i32 s66, s66, 4160
v_exp_f32 v141, v141
v_mfma_f32_16x16x32_bf16 v[172:175], a[168:171], v[72:75], v[172:175]
s_add_u32 s66, s66, s92
ds_read_b128 a[196:199], v2 offset:1024
v_cvt_pk_bf16_f32 v204, v140, v141
v_mfma_f32_16x16x32_bf16 v[172:175], a[172:175], v[76:79], v[172:175]
s_add_u32 m0, s66, 33312
v_exp_f32 v142, v142
v_mfma_f32_16x16x32_bf16 v[188:191], a[188:191], v[76:79], v[188:191]
s_add_u32 s72, s93, 0x4
buffer_load_dwordx4 v1, s[36:39], s72 offen lds
v_mfma_f32_16x16x32_bf16 v[188:191], a[184:187], v[72:75], v[188:191]
buffer_load_dwordx4 v1, s[36:39], s72 offen offset:1024 lds
v_mfma_f32_16x16x32_bf16 v[188:191], a[180:183], v[68:71], v[188:191]
s_waitcnt lgkmcnt(2)
ds_read_b128 a[200:203], v2 offset:2048
v_mfma_f32_16x16x32_bf16 a[64:67], a[224:227], v[216:219], a[64:67]
buffer_load_dwordx4 v1, s[36:39], s72 offen offset:2048 lds
v_mfma_f32_16x16x32_bf16 a[96:99], a[224:227], v[220:223], a[96:99]
v_exp_f32 v143, v143
v_mfma_f32_16x16x32_bf16 a[100:103], a[228:231], v[220:223], a[100:103]
ds_read_b128 a[204:207], v2 offset:3072
v_cvt_pk_bf16_f32 v205, v142, v143
v_mfma_f32_16x16x32_bf16 a[68:71], a[228:231], v[216:219], a[68:71]
buffer_load_dwordx4 v1, s[36:39], s72 offen offset:3072 lds
v_mfma_f32_16x16x32_bf16 a[72:75], a[232:235], v[216:219], a[72:75]
v_exp_f32 v156, v156
v_mfma_f32_16x16x32_bf16 a[104:107], a[232:235], v[220:223], a[104:107]
ds_read_b128 a[208:211], v2 offset:4096
v_mfma_f32_16x16x32_bf16 a[108:111], a[236:239], v[220:223], a[108:111]
buffer_load_dwordx4 v[80:83], v15, s[4:7], s80 offen
v_mfma_f32_16x16x32_bf16 a[76:79], a[236:239], v[216:219], a[76:79]
s_add_u32 s80, s80, 0x4000
v_exp_f32 v157, v157
v_mfma_f32_16x16x32_bf16 a[80:83], a[240:243], v[216:219], a[80:83]
ds_read_b128 a[212:215], v2 offset:5120
v_cvt_pk_bf16_f32 v206, v156, v157
v_mfma_f32_16x16x32_bf16 a[112:115], a[240:243], v[220:223], a[112:115]
buffer_load_dwordx4 v[84:87], v15, s[4:7], s80 offen
v_mfma_f32_16x16x32_bf16 a[116:119], a[244:247], v[220:223], a[116:119]
s_add_u32 s80, s80, 0x4000
v_exp_f32 v158, v158
v_mfma_f32_16x16x32_bf16 a[84:87], a[244:247], v[216:219], a[84:87]
ds_read_b128 a[216:219], v2 offset:6144
v_mfma_f32_16x16x32_bf16 a[88:91], a[248:251], v[216:219], a[88:91]
buffer_load_dwordx4 v[96:99], v15, s[4:7], s80 offen
v_mfma_f32_16x16x32_bf16 a[120:123], a[248:251], v[220:223], a[120:123]
s_add_u32 s80, s80, 0x4000
v_exp_f32 v159, v159
v_mfma_f32_16x16x32_bf16 a[124:127], a[252:255], v[220:223], a[124:127]
ds_read_b128 a[220:223], v2 offset:7168
v_cvt_pk_bf16_f32 v207, v158, v159
v_mfma_f32_16x16x32_bf16 a[92:95], a[252:255], v[216:219], a[92:95]
buffer_load_dwordx4 v[100:103], v15, s[4:7], s80 offen
v_mfma_f32_16x16x32_bf16 v[232:235], v[120:123], v[216:219], v[232:235]
v_mfma_f32_16x16x32_bf16 v[236:239], v[120:123], v[220:223], v[236:239]
s_waitcnt lgkmcnt(0)
v_mfma_f32_16x16x32_bf16 a[96:99], a[192:195], v[204:207], a[96:99]
s_add_u32 s82, s82, 0x8000
ds_read_b128 a[224:227], v2 offset:8192
ds_read_b128 a[228:231], v2 offset:9216
v_mfma_f32_16x16x32_bf16 a[100:103], a[196:199], v[204:207], a[100:103]
s_and_b32 s82, s82, 0x1ffff
v_exp_f32 v172, v172
v_mfma_f32_16x16x32_bf16 a[104:107], a[200:203], v[204:207], a[104:107]
v_exp_f32 v173, v173
v_mfma_f32_16x16x32_bf16 a[108:111], a[204:207], v[204:207], a[108:111]
ds_read_b128 a[232:235], v2 offset:10240
ds_read_b128 a[236:239], v2 offset:11264
v_mfma_f32_16x16x32_bf16 a[112:115], a[208:211], v[204:207], a[112:115]
v_exp_f32 v174, v174
v_mfma_f32_16x16x32_bf16 a[116:119], a[212:215], v[204:207], a[116:119]
ds_read_b128 a[240:243], v2 offset:12288
ds_read_b128 a[244:247], v2 offset:13312
v_mfma_f32_16x16x32_bf16 a[120:123], a[216:219], v[204:207], a[120:123]
ds_read_b128 a[248:251], v2 offset:14336
ds_read_b128 a[252:255], v2 offset:15360
v_mfma_f32_16x16x32_bf16 a[124:127], a[220:223], v[204:207], a[124:127]
s_waitcnt vmcnt(4) lgkmcnt(0)
v_exp_f32 v175, v175
v_mfma_f32_16x16x32_bf16 v[236:239], v[120:123], v[204:207], v[236:239]
s_barrier
v_exp_f32 v188, v188
v_add_u32 v2, s82, v1
v_cvt_pk_bf16_f32 v220, v172, v173
v_cvt_pk_bf16_f32 v221, v174, v175
v_exp_f32 v189, v189
v_exp_f32 v190, v190
v_cvt_pk_bf16_f32 v222, v188, v189
v_exp_f32 v191, v191
s_nop 0
v_cvt_pk_bf16_f32 v223, v190, v191
LHT4:
Lstub7:
s_cbranch_execz Lstub11
s_nop 1
v_mfma_f32_16x16x32_bf16 a[96:99], a[224:227], v[220:223], a[96:99]
s_add_u32 s78, s59, 4
ds_write_b64 v5, v[12:13]
v_mov_b32 v240, 0
v_mfma_f32_16x16x32_bf16 a[100:103], a[228:231], v[220:223], a[100:103]
s_and_b32 s78, s78, 28
v_mov_b32 v241, 0
v_mfma_f32_16x16x32_bf16 a[104:107], a[232:235], v[220:223], a[104:107]
s_lshl_b32 s73, s59, 12
ds_write_b64 v14, v[240:241]
ds_read_b128 a[192:195], v7 offset:3584
v_mfma_f32_16x16x32_bf16 a[108:111], a[236:239], v[220:223], a[108:111]
s_add_u32 s71, s61, 0
ds_read_b64 a[128:129], v6 offset:0
ds_read_b64 a[130:131], v6 offset:8
v_mfma_f32_16x16x32_bf16 a[112:115], a[240:243], v[220:223], a[112:115]
s_and_b32 s71, s71, 3
ds_read_b128 a[196:199], v7 offset:3072
ds_read_b64 a[132:133], v6 offset:512
v_mfma_f32_16x16x32_bf16 a[116:119], a[244:247], v[220:223], a[116:119]
s_add_u32 s71, s71, s78
ds_read_b64 a[134:135], v6 offset:520
ds_read_b128 a[200:203], v7 offset:2560
v_mfma_f32_16x16x32_bf16 a[120:123], a[248:251], v[220:223], a[120:123]
s_lshl_b32 s71, s71, 18
ds_read_b64 a[136:137], v6 offset:1024
ds_read_b64 a[138:139], v6 offset:1032
v_mfma_f32_16x16x32_bf16 a[124:127], a[252:255], v[220:223], a[124:127]
s_add_u32 s71, s71, s94
ds_read_b128 a[204:207], v7 offset:2048
ds_read_b64 a[140:141], v6 offset:1536
v_mfma_f32_16x16x32_bf16 v[236:239], v[120:123], v[220:223], v[236:239]
s_add_u32 m0, s77, 0
ds_read_b64 a[142:143], v6 offset:1544
ds_read_b128 a[208:211], v7 offset:1536
ds_read_b64 a[144:145], v6 offset:2048
ds_read_b64 a[146:147], v6 offset:2056
ds_read_b128 a[212:215], v7 offset:1024
ds_read_b64 a[148:149], v6 offset:2560
ds_read_b64 a[150:151], v6 offset:2568
ds_read_b128 a[216:219], v7 offset:512
ds_read_b64 a[152:153], v6 offset:3072
ds_read_b64 a[154:155], v6 offset:3080
ds_read_b128 a[220:223], v7 offset:0
ds_read_b64 a[156:157], v6 offset:3584
ds_read_b64 a[158:159], v6 offset:3592
s_waitcnt lgkmcnt(0)
v_mfma_f32_16x16x32_bf16 v[128:131], v[8:11], a[192:195], 0
s_add_u32 s72, s71, 0
buffer_load_dwordx4 v15, s[24:27], s72 offen lds
v_mfma_f32_16x16x32_bf16 v[128:131], a[128:131], a[192:195], v[128:131]
s_add_u32 s73, s73, 0x2000000
v_mfma_f32_16x16x32_bf16 v[132:135], v[8:11], a[196:199], 0
s_lshl_b32 s70, s68, 2
ds_read_b128 a[224:227], v7 offset:3648
ds_read_b64 a[160:161], v6 offset:64
v_mfma_f32_16x16x32_bf16 v[132:135], a[128:131], a[196:199], v[132:135]
s_add_u32 s70, s70, s73
v_accvgpr_read_b32 v240, a64
v_accvgpr_read_b32 v241, a65
v_accvgpr_read_b32 v242, a66
v_mfma_f32_16x16x32_bf16 v[132:135], a[132:135], a[192:195], v[132:135]
s_add_u32 s72, s71, 15360
buffer_load_dwordx4 v15, s[24:27], s72 offen offset:1024 lds
v_accvgpr_read_b32 v243, a67
v_mfma_f32_16x16x32_bf16 v[136:139], v[8:11], a[200:203], 0
ds_read_b64 a[162:163], v6 offset:72
ds_read_b128 a[228:231], v7 offset:3136
v_mfma_f32_16x16x32_bf16 v[136:139], a[128:131], a[200:203], v[136:139]
v_rcp_f32 v232, v232
v_mfma_f32_16x16x32_bf16 v[136:139], a[132:135], a[196:199], v[136:139]
v_rcp_f32 v236, v236
v_accvgpr_read_b32 v244, a68
v_mfma_f32_16x16x32_bf16 v[136:139], a[136:139], a[192:195], v[136:139]
ds_read_b64 a[164:165], v6 offset:576
ds_read_b64 a[166:167], v6 offset:584
v_accvgpr_read_b32 v245, a69
v_mfma_f32_16x16x32_bf16 v[140:143], v[8:11], a[204:207], 0
s_add_u32 s72, s71, 30720
buffer_load_dwordx4 v15, s[24:27], s72 offen offset:2048 lds
v_accvgpr_read_b32 v246, a70
v_mfma_f32_16x16x32_bf16 v[140:143], a[128:131], a[204:207], v[140:143]
v_accvgpr_read_b32 v247, a71
v_mul_f32 v240, v240, v232
v_mul_f32 v241, v241, v232
v_mfma_f32_16x16x32_bf16 v[140:143], a[132:135], a[200:203], v[140:143]
ds_read_b128 a[232:235], v7 offset:2624
ds_read_b64 a[168:169], v6 offset:1088
v_mul_f32 v242, v242, v232
v_mfma_f32_16x16x32_bf16 v[140:143], a[136:139], a[196:199], v[140:143]
s_add_u32 s72, s71, 46080
buffer_load_dwordx4 v15, s[24:27], s72 offen offset:3072 lds
v_mul_f32 v243, v243, v232
v_mfma_f32_16x16x32_bf16 v[140:143], a[140:143], a[192:195], v[140:143]
v_mul_f32 v244, v244, v232
v_mul_f32 v245, v245, v232
v_mul_f32 v246, v246, v232
v_mfma_f32_16x16x32_bf16 v[144:147], v[8:11], a[208:211], 0
ds_read_b64 a[170:171], v6 offset:1096
ds_read_b128 a[236:239], v7 offset:2112
v_mul_f32 v247, v247, v232
v_mfma_f32_16x16x32_bf16 v[144:147], a[128:131], a[208:211], v[144:147]
s_lshl_b32 s95, s75, 20
v_cvt_pk_bf16_f32 v240, v240, v241
v_cvt_pk_bf16_f32 v241, v242, v243
v_cvt_pk_bf16_f32 v242, v244, v245
v_mfma_f32_16x16x32_bf16 v[144:147], a[132:135], a[204:207], v[144:147]
s_lshl_b32 s74, s58, 18
v_cvt_pk_bf16_f32 v243, v246, v247
v_mfma_f32_16x16x32_bf16 v[144:147], a[136:139], a[200:203], v[144:147]
s_add_u32 s95, s95, s74
ds_read_b64 a[172:173], v6 offset:1600
ds_read_b64 a[174:175], v6 offset:1608
v_mfma_f32_16x16x32_bf16 v[144:147], a[140:143], a[196:199], v[144:147]
s_add_u32 s95, s95, 0x2000000
buffer_store_dwordx4 v[240:243], v1, s[44:47], s70 offen sc1
v_mfma_f32_16x16x32_bf16 v[144:147], a[144:147], a[192:195], v[144:147]
s_sub_u32 s74, 15, s75
v_accvgpr_read_b32 v248, a72
v_accvgpr_read_b32 v249, a73
v_accvgpr_read_b32 v250, a74
v_mfma_f32_16x16x32_bf16 v[148:151], v[8:11], a[212:215], 0
s_min_u32 s74, s74, s75
ds_read_b128 a[240:243], v7 offset:1600
ds_read_b64 a[176:177], v6 offset:2112
v_accvgpr_read_b32 v251, a75
v_mfma_f32_16x16x32_bf16 v[148:151], a[128:131], a[212:215], v[148:151]
s_lshl_b32 s74, s74, 7
v_accvgpr_read_b32 v252, a76
v_accvgpr_read_b32 v253, a77
v_accvgpr_read_b32 v254, a78
v_mfma_f32_16x16x32_bf16 v[148:151], a[132:135], a[208:211], v[148:151]
s_add_u32 s74, s74, 0x3810000
v_accvgpr_read_b32 v255, a79
v_mul_f32 v248, v248, v232
v_mul_f32 v249, v249, v232
v_mfma_f32_16x16x32_bf16 v[148:151], a[136:139], a[204:207], v[148:151]
s_add_u32 s79, s59, 8
ds_read_b64 a[178:179], v6 offset:2120
ds_read_b128 a[244:247], v7 offset:1088
v_mul_f32 v250, v250, v232
v_mfma_f32_16x16x32_bf16 v[148:151], a[140:143], a[200:203], v[148:151]
s_and_b32 s79, s79, 28
v_mul_f32 v251, v251, v232
v_mul_f32 v252, v252, v232
v_mul_f32 v253, v253, v232
v_mfma_f32_16x16x32_bf16 v[148:151], a[144:147], a[196:199], v[148:151]
v_mul_f32 v254, v254, v232
v_mul_f32 v255, v255, v232
v_cvt_pk_bf16_f32 v248, v248, v249
v_mfma_f32_16x16x32_bf16 v[148:151], a[148:151], a[192:195], v[148:151]
ds_read_b64 a[180:181], v6 offset:2624
ds_read_b64 a[182:183], v6 offset:2632
v_cvt_pk_bf16_f32 v249, v250, v251
v_mfma_f32_16x16x32_bf16 v[152:155], v[8:11], a[216:219], 0
v_cvt_pk_bf16_f32 v250, v252, v253
v_cvt_pk_bf16_f32 v251, v254, v255
v_mfma_f32_16x16x32_bf16 v[152:155], a[128:131], a[216:219], v[152:155]
buffer_store_dwordx4 v[248:251], v1, s[44:47], s70 offen offset:1024 sc1
v_mfma_f32_16x16x32_bf16 v[152:155], a[132:135], a[212:215], v[152:155]
ds_read_b128 a[248:251], v7 offset:576
ds_read_b64 a[184:185], v6 offset:3136
v_accvgpr_read_b32 v240, a80
v_mfma_f32_16x16x32_bf16 v[152:155], a[136:139], a[208:211], v[152:155]
v_accvgpr_read_b32 v241, a81
v_accvgpr_read_b32 v242, a82
v_accvgpr_read_b32 v243, a83
v_mfma_f32_16x16x32_bf16 v[152:155], a[140:143], a[204:207], v[152:155]
v_accvgpr_read_b32 v244, a84
v_accvgpr_read_b32 v245, a85
v_accvgpr_read_b32 v246, a86
v_mfma_f32_16x16x32_bf16 v[152:155], a[144:147], a[200:203], v[152:155]
ds_read_b64 a[186:187], v6 offset:3144
ds_read_b128 a[252:255], v7 offset:64
v_accvgpr_read_b32 v247, a87
v_mfma_f32_16x16x32_bf16 v[152:155], a[148:151], a[196:199], v[152:155]
v_mul_f32 v240, v240, v232
v_mul_f32 v241, v241, v232
v_mul_f32 v242, v242, v232
v_mfma_f32_16x16x32_bf16 v[152:155], a[152:155], a[192:195], v[152:155]
v_mul_f32 v243, v243, v232
v_mul_f32 v244, v244, v232
v_mul_f32 v245, v245, v232
v_mfma_f32_16x16x32_bf16 v[156:159], v[8:11], a[220:223], 0
ds_read_b64 a[188:189], v6 offset:3648
ds_read_b64 a[190:191], v6 offset:3656
v_mul_f32 v246, v246, v232
v_mfma_f32_16x16x32_bf16 v[156:159], a[128:131], a[220:223], v[156:159]
v_mul_f32 v247, v247, v232
v_cvt_pk_bf16_f32 v240, v240, v241
v_cvt_pk_bf16_f32 v241, v242, v243
v_mfma_f32_16x16x32_bf16 v[156:159], a[132:135], a[216:219], v[156:159]
v_cvt_pk_bf16_f32 v242, v244, v245
v_cvt_pk_bf16_f32 v243, v246, v247
v_mfma_f32_16x16x32_bf16 v[156:159], a[136:139], a[212:215], v[156:159]
buffer_store_dwordx4 v[240:243], v1, s[44:47], s70 offen offset:2048 sc1
v_mfma_f32_16x16x32_bf16 v[156:159], a[140:143], a[208:211], v[156:159]
v_accvgpr_read_b32 v248, a88
v_accvgpr_read_b32 v249, a89
v_accvgpr_read_b32 v250, a90
v_mfma_f32_16x16x32_bf16 v[156:159], a[144:147], a[204:207], v[156:159]
v_accvgpr_read_b32 v251, a91
v_accvgpr_read_b32 v252, a92
v_accvgpr_read_b32 v253, a93
v_mfma_f32_16x16x32_bf16 v[156:159], a[148:151], a[200:203], v[156:159]
v_accvgpr_read_b32 v254, a94
v_accvgpr_read_b32 v255, a95
v_mul_f32 v248, v248, v232
v_mfma_f32_16x16x32_bf16 v[156:159], a[152:155], a[196:199], v[156:159]
v_mul_f32 v249, v249, v232
v_mul_f32 v250, v250, v232
v_mul_f32 v251, v251, v232
v_mfma_f32_16x16x32_bf16 v[156:159], a[156:159], a[192:195], v[156:159]
s_waitcnt lgkmcnt(0)
v_mul_f32 v252, v252, v232
v_mul_f32 v253, v253, v232
v_mul_f32 v254, v254, v232
v_mfma_f32_16x16x32_bf16 v[128:131], a[160:163], a[224:227], v[128:131]
ds_read_b128 a[192:195], v7 offset:3712
ds_read_b64 a[128:129], v6 offset:128
v_mul_f32 v255, v255, v232
v_mfma_f32_16x16x32_bf16 v[132:135], a[164:167], a[224:227], v[132:135]
v_cvt_pk_bf16_f32 v248, v248, v249
v_cvt_pk_bf16_f32 v249, v250, v251
v_cvt_pk_bf16_f32 v250, v252, v253
v_mfma_f32_16x16x32_bf16 v[132:135], a[160:163], a[228:231], v[132:135]
ds_read_b64 a[130:131], v6 offset:136
ds_read_b128 a[196:199], v7 offset:3200
v_cvt_pk_bf16_f32 v251, v254, v255
v_mfma_f32_16x16x32_bf16 v[136:139], a[160:163], a[232:235], v[136:139]
buffer_store_dwordx4 v[248:251], v1, s[44:47], s70 offen offset:3072 sc1
v_mfma_f32_16x16x32_bf16 v[136:139], a[164:167], a[228:231], v[136:139]
s_add_u32 s70, s70, 0x80000
v_accvgpr_read_b32 v240, a96
v_accvgpr_read_b32 v241, a97
v_accvgpr_read_b32 v242, a98
v_mfma_f32_16x16x32_bf16 v[136:139], a[168:171], a[224:227], v[136:139]
ds_read_b64 a[132:133], v6 offset:640
ds_read_b64 a[134:135], v6 offset:648
v_accvgpr_read_b32 v243, a99
v_mfma_f32_16x16x32_bf16 v[140:143], a[172:175], a[224:227], v[140:143]
v_accvgpr_read_b32 v244, a100
v_accvgpr_read_b32 v245, a101
v_accvgpr_read_b32 v246, a102
v_mfma_f32_16x16x32_bf16 v[140:143], a[168:171], a[228:231], v[140:143]
ds_read_b128 a[200:203], v7 offset:2688
ds_read_b64 a[136:137], v6 offset:1152
v_accvgpr_read_b32 v247, a103
v_mfma_f32_16x16x32_bf16 v[140:143], a[164:167], a[232:235], v[140:143]
v_mul_f32 v240, v240, v236
v_mul_f32 v241, v241, v236
v_mul_f32 v242, v242, v236
v_mfma_f32_16x16x32_bf16 v[140:143], a[160:163], a[236:239], v[140:143]
v_mul_f32 v243, v243, v236
v_mul_f32 v244, v244, v236
v_mul_f32 v245, v245, v236
v_mfma_f32_16x16x32_bf16 v[144:147], a[160:163], a[240:243], v[144:147]
ds_read_b64 a[138:139], v6 offset:1160
ds_read_b128 a[204:207], v7 offset:2176
v_mul_f32 v246, v246, v236
v_mfma_f32_16x16x32_bf16 v[144:147], a[164:167], a[236:239], v[144:147]
v_mul_f32 v247, v247, v236
v_cvt_pk_bf16_f32 v240, v240, v241
v_cvt_pk_bf16_f32 v241, v242, v243
v_mfma_f32_16x16x32_bf16 v[144:147], a[168:171], a[232:235], v[144:147]
ds_read_b64 a[140:141], v6 offset:1664
ds_read_b64 a[142:143], v6 offset:1672
v_cvt_pk_bf16_f32 v242, v244, v245
v_mfma_f32_16x16x32_bf16 v[144:147], a[172:175], a[228:231], v[144:147]
v_cvt_pk_bf16_f32 v243, v246, v247
v_mfma_f32_16x16x32_bf16 v[144:147], a[176:179], a[224:227], v[144:147]
buffer_store_dwordx4 v[240:243], v1, s[44:47], s70 offen sc1
v_mfma_f32_16x16x32_bf16 v[148:151], a[180:183], a[224:227], v[148:151]
ds_read_b128 a[208:211], v7 offset:1664
ds_read_b64 a[144:145], v6 offset:2176
v_accvgpr_read_b32 v248, a104
v_mfma_f32_16x16x32_bf16 v[148:151], a[176:179], a[228:231], v[148:151]
v_accvgpr_read_b32 v249, a105
v_accvgpr_read_b32 v250, a106
v_accvgpr_read_b32 v251, a107
v_mfma_f32_16x16x32_bf16 v[148:151], a[172:175], a[232:235], v[148:151]
v_accvgpr_read_b32 v252, a108
v_accvgpr_read_b32 v253, a109
v_accvgpr_read_b32 v254, a110
v_mfma_f32_16x16x32_bf16 v[148:151], a[168:171], a[236:239], v[148:151]
ds_read_b64 a[146:147], v6 offset:2184
ds_read_b128 a[212:215], v7 offset:1152
v_accvgpr_read_b32 v255, a111
v_mfma_f32_16x16x32_bf16 v[148:151], a[164:167], a[240:243], v[148:151]
v_mul_f32 v248, v248, v236
v_mul_f32 v249, v249, v236
v_mul_f32 v250, v250, v236
v_mfma_f32_16x16x32_bf16 v[148:151], a[160:163], a[244:247], v[148:151]
ds_read_b64 a[148:149], v6 offset:2688
ds_read_b64 a[150:151], v6 offset:2696
v_mul_f32 v251, v251, v236
v_mfma_f32_16x16x32_bf16 v[152:155], a[160:163], a[248:251], v[152:155]
v_mul_f32 v252, v252, v236
v_mul_f32 v253, v253, v236
v_mul_f32 v254, v254, v236
v_mfma_f32_16x16x32_bf16 v[152:155], a[164:167], a[244:247], v[152:155]
v_mul_f32 v255, v255, v236
v_cvt_pk_bf16_f32 v248, v248, v249
v_cvt_pk_bf16_f32 v249, v250, v251
v_mfma_f32_16x16x32_bf16 v[152:155], a[168:171], a[240:243], v[152:155]
ds_read_b128 a[216:219], v7 offset:640
ds_read_b64 a[152:153], v6 offset:3200
v_cvt_pk_bf16_f32 v250, v252, v253
v_mfma_f32_16x16x32_bf16 v[152:155], a[172:175], a[236:239], v[152:155]
v_cvt_pk_bf16_f32 v251, v254, v255
v_mfma_f32_16x16x32_bf16 v[152:155], a[176:179], a[232:235], v[152:155]
ds_read_b64 a[154:155], v6 offset:3208
ds_read_b128 a[220:223], v7 offset:128
v_mfma_f32_16x16x32_bf16 v[152:155], a[180:183], a[228:231], v[152:155]
buffer_store_dwordx4 v[248:251], v1, s[44:47], s70 offen offset:1024 sc1
v_mfma_f32_16x16x32_bf16 v[152:155], a[184:187], a[224:227], v[152:155]
v_accvgpr_read_b32 v240, a112
v_accvgpr_read_b32 v241, a113
v_accvgpr_read_b32 v242, a114
v_mfma_f32_16x16x32_bf16 v[156:159], a[188:191], a[224:227], v[156:159]
ds_read_b64 a[156:157], v6 offset:3712
ds_read_b64 a[158:159], v6 offset:3720
v_accvgpr_read_b32 v243, a115
v_mfma_f32_16x16x32_bf16 v[156:159], a[184:187], a[228:231], v[156:159]
v_accvgpr_read_b32 v244, a116
v_accvgpr_read_b32 v245, a117
v_accvgpr_read_b32 v246, a118
v_mfma_f32_16x16x32_bf16 v[156:159], a[180:183], a[232:235], v[156:159]
Lstub8:
s_cbranch_execz Lret
v_accvgpr_read_b32 v247, a119
v_mul_f32 v240, v240, v236
v_mul_f32 v241, v241, v236
v_mfma_f32_16x16x32_bf16 v[156:159], a[176:179], a[236:239], v[156:159]
v_mul_f32 v242, v242, v236
v_mul_f32 v243, v243, v236
v_mul_f32 v244, v244, v236
v_mfma_f32_16x16x32_bf16 v[156:159], a[172:175], a[240:243], v[156:159]
v_mul_f32 v245, v245, v236
v_mul_f32 v246, v246, v236
v_mul_f32 v247, v247, v236
v_mfma_f32_16x16x32_bf16 v[156:159], a[168:171], a[244:247], v[156:159]
v_cvt_pk_bf16_f32 v240, v240, v241
v_cvt_pk_bf16_f32 v241, v242, v243
v_cvt_pk_bf16_f32 v242, v244, v245
v_mfma_f32_16x16x32_bf16 v[156:159], a[164:167], a[248:251], v[156:159]
v_cvt_pk_bf16_f32 v243, v246, v247
v_mfma_f32_16x16x32_bf16 v[156:159], a[160:163], a[252:255], v[156:159]
s_waitcnt lgkmcnt(0)
buffer_store_dwordx4 v[240:243], v1, s[44:47], s70 offen offset:2048 sc1
v_mfma_f32_16x16x32_bf16 v[128:131], a[128:131], a[192:195], v[128:131]
ds_read_b128 a[224:227], v7 offset:3776
ds_read_b64 a[160:161], v6 offset:192
v_accvgpr_read_b32 v248, a120
v_mfma_f32_16x16x32_bf16 v[132:135], a[132:135], a[192:195], v[132:135]
v_accvgpr_read_b32 v249, a121
v_accvgpr_read_b32 v250, a122
v_accvgpr_read_b32 v251, a123
v_mfma_f32_16x16x32_bf16 v[132:135], a[128:131], a[196:199], v[132:135]
ds_read_b64 a[162:163], v6 offset:200
ds_read_b128 a[228:231], v7 offset:3264
v_accvgpr_read_b32 v252, a124
v_mfma_f32_16x16x32_bf16 v[136:139], a[128:131], a[200:203], v[136:139]
v_accvgpr_read_b32 v253, a125
v_accvgpr_read_b32 v254, a126
v_accvgpr_read_b32 v255, a127
v_mfma_f32_16x16x32_bf16 v[136:139], a[132:135], a[196:199], v[136:139]
v_mul_f32 v248, v248, v236
v_mul_f32 v249, v249, v236
v_mul_f32 v250, v250, v236
v_mfma_f32_16x16x32_bf16 v[136:139], a[136:139], a[192:195], v[136:139]
ds_read_b64 a[164:165], v6 offset:704
ds_read_b64 a[166:167], v6 offset:712
v_mul_f32 v251, v251, v236
v_mfma_f32_16x16x32_bf16 v[140:143], a[140:143], a[192:195], v[140:143]
v_mul_f32 v252, v252, v236
v_mul_f32 v253, v253, v236
v_mul_f32 v254, v254, v236
v_mfma_f32_16x16x32_bf16 v[140:143], a[136:139], a[196:199], v[140:143]
ds_read_b128 a[232:235], v7 offset:2752
ds_read_b64 a[168:169], v6 offset:1216
v_mul_f32 v255, v255, v236
v_mfma_f32_16x16x32_bf16 v[140:143], a[132:135], a[200:203], v[140:143]
v_cvt_pk_bf16_f32 v248, v248, v249
v_cvt_pk_bf16_f32 v249, v250, v251
v_cvt_pk_bf16_f32 v250, v252, v253
v_mfma_f32_16x16x32_bf16 v[140:143], a[128:131], a[204:207], v[140:143]
v_cvt_pk_bf16_f32 v251, v254, v255
v_mfma_f32_16x16x32_bf16 v[144:147], a[128:131], a[208:211], v[144:147]
ds_read_b64 a[170:171], v6 offset:1224
ds_read_b128 a[236:239], v7 offset:2240
v_mfma_f32_16x16x32_bf16 v[144:147], a[132:135], a[204:207], v[144:147]
buffer_store_dwordx4 v[248:251], v1, s[44:47], s70 offen offset:3072 sc1
v_mfma_f32_16x16x32_bf16 v[144:147], a[136:139], a[200:203], v[144:147]
s_mov_b32 s73, 0x5d800000
ds_read_b64 a[172:173], v6 offset:1728
ds_read_b64 a[174:175], v6 offset:1736
v_add_f32 v227, v226, v230
v_mfma_f32_16x16x32_bf16 v[144:147], a[140:143], a[196:199], v[144:147]
v_add_f32 v231, v234, v238
v_add_f32 v227, v227, v231
v_cmp_nlt_f32 vcc, v227, s73
v_mfma_f32_16x16x32_bf16 v[144:147], a[144:147], a[192:195], v[144:147]
s_lshl_b32 s73, s58, 2
v_mfma_f32_16x16x32_bf16 v[148:151], a[148:151], a[192:195], v[148:151]
s_add_u32 s73, s73, 163328
ds_read_b128 a[240:243], v7 offset:1728
ds_read_b64 a[176:177], v6 offset:2240
v_mov_b32 v231, s73
v_mfma_f32_16x16x32_bf16 v[148:151], a[144:147], a[196:199], v[148:151]
s_or_b32 s73, vcc_lo, vcc_hi
v_mfma_f32_16x16x32_bf16 v[148:151], a[140:143], a[200:203], v[148:151]
s_min_u32 s73, s73, 1
v_mov_b32 v227, s73
v_mfma_f32_16x16x32_bf16 v[148:151], a[136:139], a[204:207], v[148:151]
ds_read_b64 a[178:179], v6 offset:2248
ds_read_b128 a[244:247], v7 offset:1216
ds_write_b32 v231, v227
v_mfma_f32_16x16x32_bf16 v[148:151], a[132:135], a[208:211], v[148:151]
v_mfma_f32_16x16x32_bf16 v[148:151], a[128:131], a[212:215], v[148:151]
ds_read_b64 a[180:181], v6 offset:2752
ds_read_b64 a[182:183], v6 offset:2760
v_lshrrev_b32 v2, 4, v0
v_mfma_f32_16x16x32_bf16 v[152:155], a[128:131], a[216:219], v[152:155]
v_lshlrev_b32 v2, 10, v2
v_mfma_f32_16x16x32_bf16 v[152:155], a[132:135], a[212:215], v[152:155]
s_add_u32 s82, s59, 4
v_mfma_f32_16x16x32_bf16 v[152:155], a[136:139], a[208:211], v[152:155]
s_and_b32 s82, s82, 28
ds_read_b128 a[248:251], v7 offset:704
ds_read_b64 a[184:185], v6 offset:3264
v_mfma_f32_16x16x32_bf16 v[152:155], a[140:143], a[204:207], v[152:155]
s_lshl_b32 s82, s82, 10
v_mfma_f32_16x16x32_bf16 v[152:155], a[144:147], a[200:203], v[152:155]
s_add_u32 s71, s61, 1
ds_read_b64 a[186:187], v6 offset:3272
ds_read_b128 a[252:255], v7 offset:192
v_mfma_f32_16x16x32_bf16 v[152:155], a[148:151], a[196:199], v[152:155]
s_and_b32 s71, s71, 3
v_mfma_f32_16x16x32_bf16 v[152:155], a[152:155], a[192:195], v[152:155]
s_add_u32 s71, s71, s78
v_mfma_f32_16x16x32_bf16 v[156:159], a[156:159], a[192:195], v[156:159]
s_lshl_b32 s71, s71, 18
ds_read_b64 a[188:189], v6 offset:3776
ds_read_b64 a[190:191], v6 offset:3784
v_mfma_f32_16x16x32_bf16 v[156:159], a[152:155], a[196:199], v[156:159]
s_add_u32 s71, s71, s94
v_mfma_f32_16x16x32_bf16 v[156:159], a[148:151], a[200:203], v[156:159]
s_add_u32 m0, s77, 16384
v_mfma_f32_16x16x32_bf16 v[156:159], a[144:147], a[204:207], v[156:159]
s_add_u32 s72, s71, 0
buffer_load_dwordx4 v15, s[24:27], s72 offen lds
v_mfma_f32_16x16x32_bf16 v[156:159], a[140:143], a[208:211], v[156:159]
s_add_u32 s72, s71, 15360
buffer_load_dwordx4 v15, s[24:27], s72 offen offset:1024 lds
v_mfma_f32_16x16x32_bf16 v[156:159], a[136:139], a[212:215], v[156:159]
s_add_u32 s82, s82, s74
buffer_load_dword v3, v2, s[44:47], s82 offen sc1
v_mfma_f32_16x16x32_bf16 v[156:159], a[132:135], a[216:219], v[156:159]
v_mfma_f32_16x16x32_bf16 v[156:159], a[128:131], a[220:223], v[156:159]
s_waitcnt lgkmcnt(0)
v_mfma_f32_16x16x32_bf16 v[128:131], a[160:163], a[224:227], v[128:131]
s_add_u32 s72, s71, 30720
ds_read_b128 a[192:195], v7 offset:3840
ds_read_b64 a[128:129], v6 offset:256
v_mfma_f32_16x16x32_bf16 v[132:135], a[164:167], a[224:227], v[132:135]
s_waitcnt vmcnt(3) lgkmcnt(10)
buffer_load_dwordx4 v15, s[24:27], s72 offen offset:2048 lds
v_mfma_f32_16x16x32_bf16 v[132:135], a[160:163], a[228:231], v[132:135]
s_barrier
ds_read_b64 a[130:131], v6 offset:264
ds_read_b128 a[196:199], v7 offset:3328
v_mfma_f32_16x16x32_bf16 v[136:139], a[160:163], a[232:235], v[136:139]
v_mov_b32 v244, 163328
v_mfma_f32_16x16x32_bf16 v[136:139], a[164:167], a[228:231], v[136:139]
ds_read_b128 v[240:243], v244
v_mfma_f32_16x16x32_bf16 v[136:139], a[168:171], a[224:227], v[136:139]
ds_read_b64 a[132:133], v6 offset:768
ds_read_b64 a[134:135], v6 offset:776
v_mfma_f32_16x16x32_bf16 v[140:143], a[172:175], a[224:227], v[140:143]
s_add_u32 s72, s71, 46080
buffer_load_dwordx4 v15, s[24:27], s72 offen offset:3072 lds
v_mfma_f32_16x16x32_bf16 v[140:143], a[168:171], a[228:231], v[140:143]
ds_read_b128 a[200:203], v7 offset:2816
ds_read_b64 a[136:137], v6 offset:1280
v_mfma_f32_16x16x32_bf16 v[140:143], a[164:167], a[232:235], v[140:143]
v_mfma_f32_16x16x32_bf16 v[140:143], a[160:163], a[236:239], v[140:143]
s_waitcnt lgkmcnt(4)
v_or3_b32 v240, v240, v241, v242
v_or_b32 v240, v240, v243
v_mfma_f32_16x16x32_bf16 v[144:147], a[160:163], a[240:243], v[144:147]
ds_read_b64 a[138:139], v6 offset:1288
ds_read_b128 a[204:207], v7 offset:2304
v_cmp_lt_u32 vcc, s86, v240
s_cbranch_vccnz Lslow
v_mfma_f32_16x16x32_bf16 v[144:147], a[164:167], a[236:239], v[144:147]
v_or_b32 v240, s58, v0
v_mov_b32 v241, 2
v_mfma_f32_16x16x32_bf16 v[144:147], a[168:171], a[232:235], v[144:147]
s_add_u32 s71, s61, 2
ds_read_b64 a[140:141], v6 offset:1792
ds_read_b64 a[142:143], v6 offset:1800
v_mfma_f32_16x16x32_bf16 v[144:147], a[172:175], a[228:231], v[144:147]
s_and_b32 s71, s71, 3
v_min_u32 v240, 1, v240
v_lshlrev_b32 v240, 30, v240
v_mfma_f32_16x16x32_bf16 v[144:147], a[176:179], a[224:227], v[144:147]
s_add_u32 s71, s71, s78
buffer_store_dword v241, v240, s[44:47], s91 offen sc1
v_mfma_f32_16x16x32_bf16 v[148:151], a[180:183], a[224:227], v[148:151]
s_lshl_b32 s71, s71, 18
ds_read_b128 a[208:211], v7 offset:1792
ds_read_b64 a[144:145], v6 offset:2304
v_mfma_f32_16x16x32_bf16 v[148:151], a[176:179], a[228:231], v[148:151]
s_add_u32 s71, s71, s94
v_mfma_f32_16x16x32_bf16 v[148:151], a[172:175], a[232:235], v[148:151]
s_add_u32 m0, s77, 32768
v_mfma_f32_16x16x32_bf16 v[148:151], a[168:171], a[236:239], v[148:151]
s_add_u32 s72, s71, 0
ds_read_b64 a[146:147], v6 offset:2312
ds_read_b128 a[212:215], v7 offset:1280
v_mfma_f32_16x16x32_bf16 v[148:151], a[164:167], a[240:243], v[148:151]
s_add_u32 s80, s93, 0x3400000
buffer_load_dwordx4 v15, s[24:27], s72 offen lds
v_mfma_f32_16x16x32_bf16 v[148:151], a[160:163], a[244:247], v[148:151]
s_add_u32 s72, s71, 15360
ds_read_b64 a[148:149], v6 offset:2816
ds_read_b64 a[150:151], v6 offset:2824
v_mfma_f32_16x16x32_bf16 v[152:155], a[160:163], a[248:251], v[152:155]
buffer_load_dwordx4 v15, s[24:27], s72 offen offset:1024 lds
v_mfma_f32_16x16x32_bf16 v[152:155], a[164:167], a[244:247], v[152:155]
v_and_b32 v166, 7, v0
v_lshlrev_b32 v166, 4, v166
v_mfma_f32_16x16x32_bf16 v[152:155], a[168:171], a[240:243], v[152:155]
ds_read_b128 a[216:219], v7 offset:768
ds_read_b64 a[152:153], v6 offset:3328
v_mfma_f32_16x16x32_bf16 v[152:155], a[172:175], a[236:239], v[152:155]
s_add_u32 s72, s71, 30720
buffer_load_dwordx4 v15, s[24:27], s72 offen offset:2048 lds
v_mfma_f32_16x16x32_bf16 v[152:155], a[176:179], a[232:235], v[152:155]
ds_read_b64 a[154:155], v6 offset:3336
ds_read_b128 a[220:223], v7 offset:256
v_mfma_f32_16x16x32_bf16 v[152:155], a[180:183], a[228:231], v[152:155]
v_bfe_u32 v112, v0, 3, 1
v_lshl_add_u32 v166, v112, 8, v166
v_mfma_f32_16x16x32_bf16 v[152:155], a[184:187], a[224:227], v[152:155]
v_bfe_u32 v112, v0, 4, 1
v_lshl_add_u32 v166, v112, 7, v166
v_mfma_f32_16x16x32_bf16 v[156:159], a[188:191], a[224:227], v[156:159]
ds_read_b64 a[156:157], v6 offset:3840
ds_read_b64 a[158:159], v6 offset:3848
v_mfma_f32_16x16x32_bf16 v[156:159], a[184:187], a[228:231], v[156:159]
v_lshrrev_b32 v112, 5, v0
v_lshl_add_u32 v166, v112, 9, v166
v_mfma_f32_16x16x32_bf16 v[156:159], a[180:183], a[232:235], v[156:159]
s_add_u32 s72, s71, 46080
buffer_load_dwordx4 v15, s[24:27], s72 offen offset:3072 lds
v_mfma_f32_16x16x32_bf16 v[156:159], a[176:179], a[236:239], v[156:159]
v_and_b32 v112, 15, v0
v_lshrrev_b32 v113, 2, v0
v_mfma_f32_16x16x32_bf16 v[156:159], a[172:175], a[240:243], v[156:159]
v_bfe_u32 v114, v0, 3, 2
v_and_b32 v115, 3, v0
v_mfma_f32_16x16x32_bf16 v[156:159], a[168:171], a[244:247], v[156:159]
v_lshlrev_b32 v8, 7, v113
v_lshl_add_u32 v8, v114, 5, v8
v_mfma_f32_16x16x32_bf16 v[156:159], a[164:167], a[248:251], v[156:159]
v_lshl_add_u32 v8, v115, 3, v8
v_add_u32 v8, s77, v8
v_mfma_f32_16x16x32_bf16 v[156:159], a[160:163], a[252:255], v[156:159]
s_waitcnt lgkmcnt(0)
v_subrev_u32 v8, s64, v8
v_xor_b32 v9, 32, v8
v_mfma_f32_16x16x32_bf16 v[128:131], a[128:131], a[192:195], v[128:131]
s_add_u32 s71, s61, 3
ds_read_b128 a[224:227], v7 offset:3904
ds_read_b64 a[160:161], v6 offset:320
v_mfma_f32_16x16x32_bf16 v[132:135], a[132:135], a[192:195], v[132:135]
s_and_b32 s71, s71, 3
v_xor_b32 v10, 64, v8
v_xor_b32 v11, 0x60, v8
v_mfma_f32_16x16x32_bf16 v[132:135], a[128:131], a[196:199], v[132:135]
s_add_u32 s71, s71, s78
ds_read_b64 a[162:163], v6 offset:328
ds_read_b128 a[228:231], v7 offset:3392
v_mfma_f32_16x16x32_bf16 v[136:139], a[128:131], a[200:203], v[136:139]
s_lshl_b32 s71, s71, 18
v_lshlrev_b32 v5, 8, v113
v_and_b32 v114, 1, v0
v_mfma_f32_16x16x32_bf16 v[136:139], a[132:135], a[196:199], v[136:139]
s_add_u32 s71, s71, s94
v_lshl_add_u32 v5, v114, 7, v5
v_bfe_u32 v114, v0, 1, 1
v_mfma_f32_16x16x32_bf16 v[136:139], a[136:139], a[192:195], v[136:139]
s_add_u32 m0, s77, 49152
ds_read_b64 a[164:165], v6 offset:832
ds_read_b64 a[166:167], v6 offset:840
v_mfma_f32_16x16x32_bf16 v[140:143], a[140:143], a[192:195], v[140:143]
s_add_u32 s72, s71, 0
buffer_load_dwordx4 v15, s[24:27], s72 offen lds
v_mfma_f32_16x16x32_bf16 v[140:143], a[136:139], a[196:199], v[140:143]
s_add_u32 s72, s71, 15360
ds_read_b128 a[232:235], v7 offset:2880
ds_read_b64 a[168:169], v6 offset:1344
v_mfma_f32_16x16x32_bf16 v[140:143], a[132:135], a[200:203], v[140:143]
buffer_load_dwordx4 v15, s[24:27], s72 offen offset:1024 lds
v_mfma_f32_16x16x32_bf16 v[140:143], a[128:131], a[204:207], v[140:143]
v_lshl_add_u32 v5, v114, 3, v5
v_mov_b32 v114, s58
v_mfma_f32_16x16x32_bf16 v[144:147], a[128:131], a[208:211], v[144:147]
ds_read_b64 a[170:171], v6 offset:1352
ds_read_b128 a[236:239], v7 offset:2368
v_mfma_f32_16x16x32_bf16 v[144:147], a[132:135], a[204:207], v[144:147]
v_lshl_add_u32 v5, v114, 5, v5
v_add_u32 v5, 147456, v5
v_mfma_f32_16x16x32_bf16 v[144:147], a[136:139], a[200:203], v[144:147]
s_add_u32 s72, s71, 30720
ds_read_b64 a[172:173], v6 offset:1856
ds_read_b64 a[174:175], v6 offset:1864
v_mfma_f32_16x16x32_bf16 v[144:147], a[140:143], a[196:199], v[144:147]
buffer_load_dwordx4 v15, s[24:27], s72 offen offset:2048 lds
v_mfma_f32_16x16x32_bf16 v[144:147], a[144:147], a[192:195], v[144:147]
v_bfe_u32 v114, v0, 1, 2
v_lshrrev_b32 v115, 4, v0
v_mfma_f32_16x16x32_bf16 v[148:151], a[148:151], a[192:195], v[148:151]
ds_read_b128 a[240:243], v7 offset:1856
ds_read_b64 a[176:177], v6 offset:2368
v_mfma_f32_16x16x32_bf16 v[148:151], a[144:147], a[196:199], v[148:151]
v_lshlrev_b32 v116, 7, v112
v_lshl_add_u32 v116, v114, 5, v116
v_mfma_f32_16x16x32_bf16 v[148:151], a[140:143], a[200:203], v[148:151]
v_lshl_add_u32 v116, v115, 3, v116
v_add_u32 v116, s64, v116
v_mfma_f32_16x16x32_bf16 v[148:151], a[136:139], a[204:207], v[148:151]
s_add_u32 s72, s71, 46080
ds_read_b64 a[178:179], v6 offset:2376
ds_read_b128 a[244:247], v7 offset:1344
v_mfma_f32_16x16x32_bf16 v[148:151], a[132:135], a[208:211], v[148:151]
buffer_load_dwordx4 v15, s[24:27], s72 offen offset:3072 lds
v_mfma_f32_16x16x32_bf16 v[148:151], a[128:131], a[212:215], v[148:151]
ds_read_b64 a[180:181], v6 offset:2880
ds_read_b64 a[182:183], v6 offset:2888
v_mfma_f32_16x16x32_bf16 v[152:155], a[128:131], a[216:219], v[152:155]
v_add_u32 v116, 131072, v116
v_xor_b32 v117, 32, v116
v_mfma_f32_16x16x32_bf16 v[152:155], a[132:135], a[212:215], v[152:155]
v_xor_b32 v118, 64, v116
v_xor_b32 v119, 0x60, v116
v_mfma_f32_16x16x32_bf16 v[152:155], a[136:139], a[208:211], v[152:155]
ds_read_b128 a[248:251], v7 offset:832
ds_read_b64 a[184:185], v6 offset:3392
v_mfma_f32_16x16x32_bf16 v[152:155], a[140:143], a[204:207], v[152:155]
s_waitcnt vmcnt(11)
v_cmp_gt_u32 vcc, 2, v3
s_or_b32 s81, vcc_lo, vcc_hi
s_cselect_b32 s81, 0x40000000, 0
v_or_b32 v4, s81, v1
v_mfma_f32_16x16x32_bf16 v[152:155], a[144:147], a[200:203], v[152:155]
ds_read_b64 a[186:187], v6 offset:3400
ds_read_b128 a[252:255], v7 offset:320
v_mfma_f32_16x16x32_bf16 v[152:155], a[148:151], a[196:199], v[152:155]
s_add_u32 s69, s61, 0
v_mfma_f32_16x16x32_bf16 v[152:155], a[152:155], a[192:195], v[152:155]
s_and_b32 s69, s69, 3
v_mfma_f32_16x16x32_bf16 v[156:159], a[156:159], a[192:195], v[156:159]
s_add_u32 s69, s69, s78
ds_read_b64 a[188:189], v6 offset:3904
ds_read_b64 a[190:191], v6 offset:3912
v_mfma_f32_16x16x32_bf16 v[156:159], a[152:155], a[196:199], v[156:159]
s_lshl_b32 s69, s69, 12
v_mfma_f32_16x16x32_bf16 v[156:159], a[148:151], a[200:203], v[156:159]
s_add_u32 s69, s69, s95
buffer_load_dwordx4 a[0:3], v4, s[44:47], s69 offen sc1
v_mfma_f32_16x16x32_bf16 v[156:159], a[144:147], a[204:207], v[156:159]
v_mfma_f32_16x16x32_bf16 v[156:159], a[140:143], a[208:211], v[156:159]
v_mfma_f32_16x16x32_bf16 v[156:159], a[136:139], a[212:215], v[156:159]
buffer_load_dwordx4 a[4:7], v4, s[44:47], s69 offen offset:1024 sc1
v_mfma_f32_16x16x32_bf16 v[156:159], a[132:135], a[216:219], v[156:159]
v_mfma_f32_16x16x32_bf16 v[156:159], a[128:131], a[220:223], v[156:159]
s_waitcnt lgkmcnt(0)
v_mfma_f32_16x16x32_bf16 v[128:131], a[160:163], a[224:227], v[128:131]
ds_read_b128 a[192:195], v7 offset:3968
ds_read_b64 a[128:129], v6 offset:384
v_mfma_f32_16x16x32_bf16 v[132:135], a[164:167], a[224:227], v[132:135]
buffer_load_dwordx4 a[8:11], v4, s[44:47], s69 offen offset:2048 sc1
v_mfma_f32_16x16x32_bf16 v[132:135], a[160:163], a[228:231], v[132:135]
ds_read_b64 a[130:131], v6 offset:392
ds_read_b128 a[196:199], v7 offset:3456
v_mfma_f32_16x16x32_bf16 v[136:139], a[160:163], a[232:235], v[136:139]
v_mfma_f32_16x16x32_bf16 v[136:139], a[164:167], a[228:231], v[136:139]
buffer_load_dwordx4 a[12:15], v4, s[44:47], s69 offen offset:3072 sc1
v_mfma_f32_16x16x32_bf16 v[136:139], a[168:171], a[224:227], v[136:139]
ds_read_b64 a[132:133], v6 offset:896
ds_read_b64 a[134:135], v6 offset:904
v_mfma_f32_16x16x32_bf16 v[140:143], a[172:175], a[224:227], v[140:143]
v_mfma_f32_16x16x32_bf16 v[140:143], a[168:171], a[228:231], v[140:143]
ds_read_b128 a[200:203], v7 offset:2944
ds_read_b64 a[136:137], v6 offset:1408
v_mfma_f32_16x16x32_bf16 v[140:143], a[164:167], a[232:235], v[140:143]
s_add_u32 s69, s69, 0x20000
buffer_load_dwordx4 a[16:19], v4, s[44:47], s69 offen sc1
v_mfma_f32_16x16x32_bf16 v[140:143], a[160:163], a[236:239], v[140:143]
v_mfma_f32_16x16x32_bf16 v[144:147], a[160:163], a[240:243], v[144:147]
ds_read_b64 a[138:139], v6 offset:1416
ds_read_b128 a[204:207], v7 offset:2432
v_mfma_f32_16x16x32_bf16 v[144:147], a[164:167], a[236:239], v[144:147]
buffer_load_dwordx4 a[20:23], v4, s[44:47], s69 offen offset:1024 sc1
v_mfma_f32_16x16x32_bf16 v[144:147], a[168:171], a[232:235], v[144:147]
ds_read_b64 a[140:141], v6 offset:1920
ds_read_b64 a[142:143], v6 offset:1928
v_mfma_f32_16x16x32_bf16 v[144:147], a[172:175], a[228:231], v[144:147]
v_mfma_f32_16x16x32_bf16 v[144:147], a[176:179], a[224:227], v[144:147]
v_mfma_f32_16x16x32_bf16 v[148:151], a[180:183], a[224:227], v[148:151]
ds_read_b128 a[208:211], v7 offset:1920
ds_read_b64 a[144:145], v6 offset:2432
v_mfma_f32_16x16x32_bf16 v[148:151], a[176:179], a[228:231], v[148:151]
buffer_load_dwordx4 a[24:27], v4, s[44:47], s69 offen offset:2048 sc1
v_mfma_f32_16x16x32_bf16 v[148:151], a[172:175], a[232:235], v[148:151]
v_mfma_f32_16x16x32_bf16 v[148:151], a[168:171], a[236:239], v[148:151]
ds_read_b64 a[146:147], v6 offset:2440
ds_read_b128 a[212:215], v7 offset:1408
v_mfma_f32_16x16x32_bf16 v[148:151], a[164:167], a[240:243], v[148:151]
buffer_load_dwordx4 a[28:31], v4, s[44:47], s69 offen offset:3072 sc1
v_mfma_f32_16x16x32_bf16 v[148:151], a[160:163], a[244:247], v[148:151]
s_add_u32 s69, s61, 1
ds_read_b64 a[148:149], v6 offset:2944
ds_read_b64 a[150:151], v6 offset:2952
v_mfma_f32_16x16x32_bf16 v[152:155], a[160:163], a[248:251], v[152:155]
s_and_b32 s69, s69, 3
v_mfma_f32_16x16x32_bf16 v[152:155], a[164:167], a[244:247], v[152:155]
s_add_u32 s69, s69, s78
s_lshl_b32 s69, s69, 12
s_add_u32 s69, s69, s95
buffer_load_dwordx4 a[32:35], v4, s[44:47], s69 offen sc1
v_mfma_f32_16x16x32_bf16 v[152:155], a[168:171], a[240:243], v[152:155]
ds_read_b128 a[216:219], v7 offset:896
ds_read_b64 a[152:153], v6 offset:3456
v_mfma_f32_16x16x32_bf16 v[152:155], a[172:175], a[236:239], v[152:155]
v_mfma_f32_16x16x32_bf16 v[152:155], a[176:179], a[232:235], v[152:155]
ds_read_b64 a[154:155], v6 offset:3464
ds_read_b128 a[220:223], v7 offset:384
v_mfma_f32_16x16x32_bf16 v[152:155], a[180:183], a[228:231], v[152:155]
buffer_load_dwordx4 a[36:39], v4, s[44:47], s69 offen offset:1024 sc1
v_mfma_f32_16x16x32_bf16 v[152:155], a[184:187], a[224:227], v[152:155]
v_mfma_f32_16x16x32_bf16 v[156:159], a[188:191], a[224:227], v[156:159]
ds_read_b64 a[156:157], v6 offset:3968
ds_read_b64 a[158:159], v6 offset:3976
v_mfma_f32_16x16x32_bf16 v[156:159], a[184:187], a[228:231], v[156:159]
buffer_load_dwordx4 a[40:43], v4, s[44:47], s69 offen offset:2048 sc1
v_mfma_f32_16x16x32_bf16 v[156:159], a[180:183], a[232:235], v[156:159]
v_mfma_f32_16x16x32_bf16 v[156:159], a[176:179], a[236:239], v[156:159]
v_mfma_f32_16x16x32_bf16 v[156:159], a[172:175], a[240:243], v[156:159]
buffer_load_dwordx4 a[44:47], v4, s[44:47], s69 offen offset:3072 sc1
v_mfma_f32_16x16x32_bf16 v[156:159], a[168:171], a[244:247], v[156:159]
v_mfma_f32_16x16x32_bf16 v[156:159], a[164:167], a[248:251], v[156:159]
v_mfma_f32_16x16x32_bf16 v[156:159], a[160:163], a[252:255], v[156:159]
s_waitcnt lgkmcnt(0)
v_mfma_f32_16x16x32_bf16 v[128:131], a[128:131], a[192:195], v[128:131]
ds_read_b128 a[224:227], v7 offset:4032
ds_read_b64 a[160:161], v6 offset:448
v_mfma_f32_16x16x32_bf16 v[132:135], a[132:135], a[192:195], v[132:135]
s_add_u32 s69, s69, 0x20000
buffer_load_dwordx4 a[48:51], v4, s[44:47], s69 offen sc1
v_mfma_f32_16x16x32_bf16 v[132:135], a[128:131], a[196:199], v[132:135]
ds_read_b64 a[162:163], v6 offset:456
ds_read_b128 a[228:231], v7 offset:3520
v_mfma_f32_16x16x32_bf16 v[136:139], a[128:131], a[200:203], v[136:139]
buffer_load_dwordx4 a[52:55], v4, s[44:47], s69 offen offset:1024 sc1
v_mfma_f32_16x16x32_bf16 v[136:139], a[132:135], a[196:199], v[136:139]
v_mfma_f32_16x16x32_bf16 v[136:139], a[136:139], a[192:195], v[136:139]
ds_read_b64 a[164:165], v6 offset:960
ds_read_b64 a[166:167], v6 offset:968
v_mfma_f32_16x16x32_bf16 v[140:143], a[140:143], a[192:195], v[140:143]
v_mfma_f32_16x16x32_bf16 v[140:143], a[136:139], a[196:199], v[140:143]
ds_read_b128 a[232:235], v7 offset:3008
ds_read_b64 a[168:169], v6 offset:1472
v_mfma_f32_16x16x32_bf16 v[140:143], a[132:135], a[200:203], v[140:143]
buffer_load_dwordx4 a[56:59], v4, s[44:47], s69 offen offset:2048 sc1
v_mfma_f32_16x16x32_bf16 v[140:143], a[128:131], a[204:207], v[140:143]
v_mfma_f32_16x16x32_bf16 v[144:147], a[128:131], a[208:211], v[144:147]
ds_read_b64 a[170:171], v6 offset:1480
ds_read_b128 a[236:239], v7 offset:2496
v_mfma_f32_16x16x32_bf16 v[144:147], a[132:135], a[204:207], v[144:147]
buffer_load_dwordx4 a[60:63], v4, s[44:47], s69 offen offset:3072 sc1
v_mfma_f32_16x16x32_bf16 v[144:147], a[136:139], a[200:203], v[144:147]
s_add_u32 s69, s61, 2
ds_read_b64 a[172:173], v6 offset:1984
ds_read_b64 a[174:175], v6 offset:1992
v_mfma_f32_16x16x32_bf16 v[144:147], a[140:143], a[196:199], v[144:147]
s_and_b32 s69, s69, 3
v_mfma_f32_16x16x32_bf16 v[144:147], a[144:147], a[192:195], v[144:147]
s_add_u32 s69, s69, s78
s_lshl_b32 s69, s69, 12
s_add_u32 s69, s69, s95
buffer_load_dwordx4 a[64:67], v4, s[44:47], s69 offen sc1
v_mfma_f32_16x16x32_bf16 v[148:151], a[148:151], a[192:195], v[148:151]
ds_read_b128 a[240:243], v7 offset:1984
ds_read_b64 a[176:177], v6 offset:2496
v_mfma_f32_16x16x32_bf16 v[148:151], a[144:147], a[196:199], v[148:151]
v_mfma_f32_16x16x32_bf16 v[148:151], a[140:143], a[200:203], v[148:151]
buffer_load_dwordx4 a[68:71], v4, s[44:47], s69 offen offset:1024 sc1
v_mfma_f32_16x16x32_bf16 v[148:151], a[136:139], a[204:207], v[148:151]
ds_read_b64 a[178:179], v6 offset:2504
ds_read_b128 a[244:247], v7 offset:1472
v_mfma_f32_16x16x32_bf16 v[148:151], a[132:135], a[208:211], v[148:151]
v_mfma_f32_16x16x32_bf16 v[148:151], a[128:131], a[212:215], v[148:151]
ds_read_b64 a[180:181], v6 offset:3008
ds_read_b64 a[182:183], v6 offset:3016
v_mfma_f32_16x16x32_bf16 v[152:155], a[128:131], a[216:219], v[152:155]
buffer_load_dwordx4 a[72:75], v4, s[44:47], s69 offen offset:2048 sc1
v_mfma_f32_16x16x32_bf16 v[152:155], a[132:135], a[212:215], v[152:155]
v_mfma_f32_16x16x32_bf16 v[152:155], a[136:139], a[208:211], v[152:155]
ds_read_b128 a[248:251], v7 offset:960
ds_read_b64 a[184:185], v6 offset:3520
v_mfma_f32_16x16x32_bf16 v[152:155], a[140:143], a[204:207], v[152:155]
buffer_load_dwordx4 a[76:79], v4, s[44:47], s69 offen offset:3072 sc1
v_mfma_f32_16x16x32_bf16 v[152:155], a[144:147], a[200:203], v[152:155]
ds_read_b64 a[186:187], v6 offset:3528
ds_read_b128 a[252:255], v7 offset:448
v_mfma_f32_16x16x32_bf16 v[152:155], a[148:151], a[196:199], v[152:155]
v_mfma_f32_16x16x32_bf16 v[152:155], a[152:155], a[192:195], v[152:155]
v_mfma_f32_16x16x32_bf16 v[156:159], a[156:159], a[192:195], v[156:159]
ds_read_b64 a[188:189], v6 offset:4032
ds_read_b64 a[190:191], v6 offset:4040
v_mfma_f32_16x16x32_bf16 v[156:159], a[152:155], a[196:199], v[156:159]
s_add_u32 s69, s69, 0x20000
buffer_load_dwordx4 a[80:83], v4, s[44:47], s69 offen sc1
v_mfma_f32_16x16x32_bf16 v[156:159], a[148:151], a[200:203], v[156:159]
v_mfma_f32_16x16x32_bf16 v[156:159], a[144:147], a[204:207], v[156:159]
buffer_load_dwordx4 a[84:87], v4, s[44:47], s69 offen offset:1024 sc1
v_mfma_f32_16x16x32_bf16 v[156:159], a[140:143], a[208:211], v[156:159]
v_mfma_f32_16x16x32_bf16 v[156:159], a[136:139], a[212:215], v[156:159]
v_mfma_f32_16x16x32_bf16 v[156:159], a[132:135], a[216:219], v[156:159]
v_mfma_f32_16x16x32_bf16 v[156:159], a[128:131], a[220:223], v[156:159]
s_waitcnt lgkmcnt(0)
buffer_load_dwordx4 a[88:91], v4, s[44:47], s69 offen offset:2048 sc1
v_mfma_f32_16x16x32_bf16 v[128:131], a[160:163], a[224:227], v[128:131]
ds_read_b64_tr_b16 v[192:193], v8 offset:0
ds_read_b64_tr_b16 v[194:195], v8 offset:2048
v_mfma_f32_16x16x32_bf16 v[132:135], a[164:167], a[224:227], v[132:135]
v_mfma_f32_16x16x32_bf16 v[132:135], a[160:163], a[228:231], v[132:135]
ds_read_b64_tr_b16 v[196:197], v9 offset:0
ds_read_b64_tr_b16 v[198:199], v9 offset:2048
v_mfma_f32_16x16x32_bf16 v[136:139], a[160:163], a[232:235], v[136:139]
buffer_load_dwordx4 a[92:95], v4, s[44:47], s69 offen offset:3072 sc1
v_mfma_f32_16x16x32_bf16 v[136:139], a[164:167], a[228:231], v[136:139]
s_add_u32 s69, s61, 3
ds_read_b64_tr_b16 v[200:201], v10 offset:0
ds_read_b64_tr_b16 v[202:203], v10 offset:2048
v_mfma_f32_16x16x32_bf16 v[136:139], a[168:171], a[224:227], v[136:139]
s_and_b32 s69, s69, 3
v_mfma_f32_16x16x32_bf16 v[140:143], a[172:175], a[224:227], v[140:143]
s_add_u32 s69, s69, s78
ds_read_b64_tr_b16 v[204:205], v11 offset:0
ds_read_b64_tr_b16 v[206:207], v11 offset:2048
v_mfma_f32_16x16x32_bf16 v[140:143], a[168:171], a[228:231], v[140:143]
s_lshl_b32 s69, s69, 12
s_add_u32 s69, s69, s95
buffer_load_dwordx4 a[96:99], v4, s[44:47], s69 offen sc1
v_mfma_f32_16x16x32_bf16 v[140:143], a[164:167], a[232:235], v[140:143]
ds_read_b64_tr_b16 v[208:209], v8 offset:4096
ds_read_b64_tr_b16 v[210:211], v8 offset:6144
v_cvt_pk_bf16_f32 v128, v128, v129
v_mfma_f32_16x16x32_bf16 v[140:143], a[160:163], a[236:239], v[140:143]
buffer_load_dwordx4 a[100:103], v4, s[44:47], s69 offen offset:1024 sc1
v_cvt_pk_bf16_f32 v129, v130, v131
v_mfma_f32_16x16x32_bf16 v[144:147], a[160:163], a[240:243], v[144:147]
ds_read_b64_tr_b16 v[212:213], v9 offset:4096
ds_read_b64_tr_b16 v[214:215], v9 offset:6144
v_cvt_pk_bf16_f32 v130, v132, v133
v_mfma_f32_16x16x32_bf16 v[144:147], a[164:167], a[236:239], v[144:147]
v_cvt_pk_bf16_f32 v131, v134, v135
v_permlane32_swap_b32 v128, v130
s_nop 0
v_permlane32_swap_b32 v129, v131
v_mfma_f32_16x16x32_bf16 v[144:147], a[168:171], a[232:235], v[144:147]
ds_read_b64_tr_b16 v[216:217], v10 offset:4096
ds_read_b64_tr_b16 v[218:219], v10 offset:6144
v_mfma_f32_16x16x32_bf16 v[144:147], a[172:175], a[228:231], v[144:147]
buffer_load_dwordx4 a[104:107], v4, s[44:47], s69 offen offset:2048 sc1
v_mfma_f32_16x16x32_bf16 v[144:147], a[176:179], a[224:227], v[144:147]
ds_read_b64_tr_b16 v[220:221], v11 offset:4096
ds_read_b64_tr_b16 v[222:223], v11 offset:6144
v_cvt_pk_bf16_f32 v136, v136, v137
v_mfma_f32_16x16x32_bf16 v[148:151], a[180:183], a[224:227], v[148:151]
buffer_store_dwordx4 v[128:131], v166, s[44:47], s80 offen sc1
v_cvt_pk_bf16_f32 v137, v138, v139
v_mfma_f32_16x16x32_bf16 v[148:151], a[176:179], a[228:231], v[148:151]
ds_read_b64_tr_b16 v[224:225], v8 offset:8192
ds_read_b64_tr_b16 v[226:227], v8 offset:10240
v_cvt_pk_bf16_f32 v138, v140, v141
v_mfma_f32_16x16x32_bf16 v[148:151], a[172:175], a[232:235], v[148:151]
buffer_load_dwordx4 a[108:111], v4, s[44:47], s69 offen offset:3072 sc1
v_cvt_pk_bf16_f32 v139, v142, v143
v_mfma_f32_16x16x32_bf16 v[148:151], a[168:171], a[236:239], v[148:151]
Lstub9:
s_cbranch_execz Lret
ds_read_b64_tr_b16 v[228:229], v9 offset:8192
ds_read_b64_tr_b16 v[230:231], v9 offset:10240
v_permlane32_swap_b32 v136, v138
v_mfma_f32_16x16x32_bf16 v[148:151], a[164:167], a[240:243], v[148:151]
v_permlane32_swap_b32 v137, v139
v_mfma_f32_16x16x32_bf16 v[148:151], a[160:163], a[244:247], v[148:151]
ds_read_b64_tr_b16 v[232:233], v10 offset:8192
ds_read_b64_tr_b16 v[234:235], v10 offset:10240
v_mfma_f32_16x16x32_bf16 v[152:155], a[160:163], a[248:251], v[152:155]
s_add_u32 s69, s69, 0x20000
buffer_load_dwordx4 a[112:115], v4, s[44:47], s69 offen sc1
v_mfma_f32_16x16x32_bf16 v[152:155], a[164:167], a[244:247], v[152:155]
ds_read_b64_tr_b16 v[236:237], v11 offset:8192
ds_read_b64_tr_b16 v[238:239], v11 offset:10240
v_mfma_f32_16x16x32_bf16 v[152:155], a[168:171], a[240:243], v[152:155]
buffer_load_dwordx4 a[116:119], v4, s[44:47], s69 offen offset:1024 sc1
v_mfma_f32_16x16x32_bf16 v[152:155], a[172:175], a[236:239], v[152:155]
ds_read_b64_tr_b16 v[240:241], v8 offset:12288
ds_read_b64_tr_b16 v[242:243], v8 offset:14336
v_mfma_f32_16x16x32_bf16 v[152:155], a[176:179], a[232:235], v[152:155]
buffer_store_dwordx4 v[136:139], v166, s[44:47], s80 offen offset:1024 sc1
v_cvt_pk_bf16_f32 v144, v144, v145
v_mfma_f32_16x16x32_bf16 v[152:155], a[180:183], a[228:231], v[152:155]
ds_read_b64_tr_b16 v[244:245], v9 offset:12288
ds_read_b64_tr_b16 v[246:247], v9 offset:14336
v_cvt_pk_bf16_f32 v145, v146, v147
v_mfma_f32_16x16x32_bf16 v[152:155], a[184:187], a[224:227], v[152:155]
buffer_load_dwordx4 a[120:123], v4, s[44:47], s69 offen offset:2048 sc1
v_cvt_pk_bf16_f32 v146, v148, v149
v_mfma_f32_16x16x32_bf16 v[156:159], a[188:191], a[224:227], v[156:159]
ds_read_b64_tr_b16 v[248:249], v10 offset:12288
ds_read_b64_tr_b16 v[250:251], v10 offset:14336
v_cvt_pk_bf16_f32 v147, v150, v151
v_mfma_f32_16x16x32_bf16 v[156:159], a[184:187], a[228:231], v[156:159]
v_permlane32_swap_b32 v144, v146
v_permlane32_swap_b32 v145, v147
v_mfma_f32_16x16x32_bf16 v[156:159], a[180:183], a[232:235], v[156:159]
ds_read_b64_tr_b16 v[252:253], v11 offset:12288
ds_read_b64_tr_b16 v[254:255], v11 offset:14336
v_mfma_f32_16x16x32_bf16 v[156:159], a[176:179], a[236:239], v[156:159]
buffer_load_dwordx4 a[124:127], v4, s[44:47], s69 offen offset:3072 sc1
v_mfma_f32_16x16x32_bf16 v[156:159], a[172:175], a[240:243], v[156:159]
buffer_store_dwordx4 v[144:147], v166, s[44:47], s80 offen offset:2048 sc1
v_mfma_f32_16x16x32_bf16 v[156:159], a[168:171], a[244:247], v[156:159]
v_mfma_f32_16x16x32_bf16 v[156:159], a[164:167], a[248:251], v[156:159]
v_mfma_f32_16x16x32_bf16 v[156:159], a[160:163], a[252:255], v[156:159]
v_cvt_pk_bf16_f32 v152, v152, v153
v_cvt_pk_bf16_f32 v153, v154, v155
s_nop 5
v_cvt_pk_bf16_f32 v154, v156, v157
v_cvt_pk_bf16_f32 v155, v158, v159
s_nop 0
v_permlane32_swap_b32 v152, v154
v_permlane32_swap_b32 v153, v155
buffer_store_dwordx4 v[152:155], v166, s[44:47], s80 offen offset:3072 sc1
s_waitcnt vmcnt(28) lgkmcnt(0)
s_cmp_lg_u32 s81, 0
s_cbranch_scc1 Lredo0
Lredo0b:
s_barrier
v_mfma_f32_16x16x32_bf16 v[16:19], v[192:195], a[0:3], 0
s_add_u32 s82, s59, 8
s_and_b32 s82, s82, 28
s_lshl_b32 s82, s82, 10
s_add_u32 s82, s82, s74
buffer_load_dword v3, v2, s[44:47], s82 offen sc1
v_mfma_f32_16x16x32_bf16 v[16:19], v[208:211], a[4:7], v[16:19]
s_add_u32 s71, s61, 0
ds_read_b64_tr_b16 v[128:129], v8 offset:16384
ds_read_b64_tr_b16 v[130:131], v8 offset:18432
v_mfma_f32_16x16x32_bf16 v[16:19], v[224:227], a[8:11], v[16:19]
s_and_b32 s71, s71, 3
s_add_u32 s71, s71, s79
s_lshl_b32 s71, s71, 18
s_add_u32 s71, s71, s94
s_add_u32 m0, s77, 0
s_add_u32 s72, s71, 0
buffer_load_dwordx4 v15, s[24:27], s72 offen lds
v_mfma_f32_16x16x32_bf16 v[16:19], v[240:243], a[12:15], v[16:19]
s_add_u32 s72, s71, 15360
ds_read_b64_tr_b16 v[132:133], v9 offset:16384
v_mfma_f32_16x16x32_bf16 v[32:35], v[240:243], a[28:31], 0
ds_read_b64_tr_b16 v[134:135], v9 offset:18432
ds_read_b64_tr_b16 v[136:137], v10 offset:16384
v_mfma_f32_16x16x32_bf16 v[32:35], v[224:227], a[24:27], v[32:35]
buffer_load_dwordx4 v15, s[24:27], s72 offen offset:1024 lds
v_mfma_f32_16x16x32_bf16 v[32:35], v[208:211], a[20:23], v[32:35]
s_add_u32 s72, s71, 30720
ds_read_b64_tr_b16 v[138:139], v10 offset:18432
v_mfma_f32_16x16x32_bf16 v[32:35], v[192:195], a[16:19], v[32:35]
ds_read_b64_tr_b16 v[140:141], v11 offset:16384
ds_read_b64_tr_b16 v[142:143], v11 offset:18432
v_mfma_f32_16x16x32_bf16 v[36:39], v[196:199], a[16:19], 0
buffer_load_dwordx4 v15, s[24:27], s72 offen offset:2048 lds
v_mfma_f32_16x16x32_bf16 v[36:39], v[212:215], a[20:23], v[36:39]
s_add_u32 s72, s71, 46080
ds_read_b64_tr_b16 v[144:145], v8 offset:20480
v_mfma_f32_16x16x32_bf16 v[36:39], v[228:231], a[24:27], v[36:39]
ds_read_b64_tr_b16 v[146:147], v8 offset:22528
ds_read_b64_tr_b16 v[148:149], v9 offset:20480
v_mfma_f32_16x16x32_bf16 v[36:39], v[244:247], a[28:31], v[36:39]
buffer_load_dwordx4 v15, s[24:27], s72 offen offset:3072 lds
v_mfma_f32_16x16x32_bf16 v[20:23], v[244:247], a[12:15], 0
ds_read_b64_tr_b16 v[150:151], v9 offset:22528
v_mfma_f32_16x16x32_bf16 v[20:23], v[228:231], a[8:11], v[20:23]
ds_read_b64_tr_b16 v[152:153], v10 offset:20480
ds_read_b64_tr_b16 v[154:155], v10 offset:22528
v_mfma_f32_16x16x32_bf16 v[20:23], v[212:215], a[4:7], v[20:23]
ds_read_b64_tr_b16 v[156:157], v11 offset:20480
v_mfma_f32_16x16x32_bf16 v[20:23], v[196:199], a[0:3], v[20:23]
ds_read_b64_tr_b16 v[158:159], v11 offset:22528
v_mfma_f32_16x16x32_bf16 v[24:27], v[200:203], a[0:3], 0
ds_read_b64_tr_b16 v[160:161], v8 offset:24576
ds_read_b64_tr_b16 v[162:163], v8 offset:26624
v_mfma_f32_16x16x32_bf16 v[24:27], v[216:219], a[4:7], v[24:27]
ds_read_b64_tr_b16 v[164:165], v9 offset:24576
v_mfma_f32_16x16x32_bf16 v[24:27], v[232:235], a[8:11], v[24:27]
ds_read_b64_tr_b16 v[166:167], v9 offset:26624
ds_read_b64_tr_b16 v[168:169], v10 offset:24576
v_mfma_f32_16x16x32_bf16 v[24:27], v[248:251], a[12:15], v[24:27]
ds_read_b64_tr_b16 v[170:171], v10 offset:26624
v_mfma_f32_16x16x32_bf16 v[40:43], v[248:251], a[28:31], 0
ds_read_b64_tr_b16 v[172:173], v11 offset:24576
ds_read_b64_tr_b16 v[174:175], v11 offset:26624
v_mfma_f32_16x16x32_bf16 v[40:43], v[232:235], a[24:27], v[40:43]
ds_read_b64_tr_b16 v[176:177], v8 offset:28672
v_mfma_f32_16x16x32_bf16 v[40:43], v[216:219], a[20:23], v[40:43]
ds_read_b64_tr_b16 v[178:179], v8 offset:30720
ds_read_b64_tr_b16 v[180:181], v9 offset:28672
v_mfma_f32_16x16x32_bf16 v[40:43], v[200:203], a[16:19], v[40:43]
ds_read_b64_tr_b16 v[182:183], v9 offset:30720
v_mfma_f32_16x16x32_bf16 v[44:47], v[204:207], a[16:19], 0
ds_read_b64_tr_b16 v[184:185], v10 offset:28672
ds_read_b64_tr_b16 v[186:187], v10 offset:30720
v_mfma_f32_16x16x32_bf16 v[44:47], v[220:223], a[20:23], v[44:47]
ds_read_b64_tr_b16 v[188:189], v11 offset:28672
v_mfma_f32_16x16x32_bf16 v[44:47], v[236:239], a[24:27], v[44:47]
ds_read_b64_tr_b16 v[190:191], v11 offset:30720
v_mfma_f32_16x16x32_bf16 v[44:47], v[252:255], a[28:31], v[44:47]
v_mfma_f32_16x16x32_bf16 v[28:31], v[252:255], a[12:15], 0
v_mfma_f32_16x16x32_bf16 v[28:31], v[236:239], a[8:11], v[28:31]
v_mfma_f32_16x16x32_bf16 v[28:31], v[220:223], a[4:7], v[28:31]
s_waitcnt vmcnt(21) lgkmcnt(0)
v_mfma_f32_16x16x32_bf16 v[28:31], v[204:207], a[0:3], v[28:31]
s_barrier
v_mfma_f32_16x16x32_bf16 v[16:19], v[128:131], a[32:35], v[16:19]
s_waitcnt vmcnt(4)
v_cmp_gt_u32 vcc, 2, v3
s_cbranch_vccnz Lspin106
Lback107:
s_add_u32 s69, s61, 0
s_and_b32 s69, s69, 3
s_add_u32 s69, s69, s79
s_lshl_b32 s69, s69, 12
s_add_u32 s69, s69, s95
buffer_load_dwordx4 a[0:3], v1, s[44:47], s69 offen sc1
buffer_load_dwordx4 a[4:7], v1, s[44:47], s69 offen offset:1024 sc1
buffer_load_dwordx4 a[8:11], v1, s[44:47], s69 offen offset:2048 sc1
buffer_load_dwordx4 a[12:15], v1, s[44:47], s69 offen offset:3072 sc1
s_add_u32 s69, s69, 0x20000
buffer_load_dwordx4 a[16:19], v1, s[44:47], s69 offen sc1
buffer_load_dwordx4 a[20:23], v1, s[44:47], s69 offen offset:1024 sc1
buffer_load_dwordx4 a[24:27], v1, s[44:47], s69 offen offset:2048 sc1
v_mfma_f32_16x16x32_bf16 v[16:19], v[144:147], a[36:39], v[16:19]
ds_read_b64_tr_b16 v[192:193], v8 offset:32768
ds_read_b64_tr_b16 v[194:195], v8 offset:34816
v_mfma_f32_16x16x32_bf16 v[16:19], v[160:163], a[40:43], v[16:19]
buffer_load_dwordx4 a[28:31], v1, s[44:47], s69 offen offset:3072 sc1
v_mfma_f32_16x16x32_bf16 v[16:19], v[176:179], a[44:47], v[16:19]
s_add_u32 s71, s61, 1
ds_read_b64_tr_b16 v[196:197], v9 offset:32768
ds_read_b64_tr_b16 v[198:199], v9 offset:34816
v_mfma_f32_16x16x32_bf16 v[32:35], v[176:179], a[60:63], v[32:35]
s_and_b32 s71, s71, 3
s_add_u32 s71, s71, s79
s_lshl_b32 s71, s71, 18
s_add_u32 s71, s71, s94
s_add_u32 m0, s77, 16384
s_add_u32 s72, s71, 0
buffer_load_dwordx4 v15, s[24:27], s72 offen lds
v_mfma_f32_16x16x32_bf16 v[32:35], v[160:163], a[56:59], v[32:35]
s_add_u32 s72, s71, 15360
ds_read_b64_tr_b16 v[200:201], v10 offset:32768
v_mfma_f32_16x16x32_bf16 v[32:35], v[144:147], a[52:55], v[32:35]
ds_read_b64_tr_b16 v[202:203], v10 offset:34816
ds_read_b64_tr_b16 v[204:205], v11 offset:32768
v_mfma_f32_16x16x32_bf16 v[32:35], v[128:131], a[48:51], v[32:35]
buffer_load_dwordx4 v15, s[24:27], s72 offen offset:1024 lds
v_mfma_f32_16x16x32_bf16 v[36:39], v[132:135], a[48:51], v[36:39]
s_add_u32 s72, s71, 30720
ds_read_b64_tr_b16 v[206:207], v11 offset:34816
v_mfma_f32_16x16x32_bf16 v[36:39], v[148:151], a[52:55], v[36:39]
ds_read_b64_tr_b16 v[208:209], v8 offset:36864
ds_read_b64_tr_b16 v[210:211], v8 offset:38912
v_mfma_f32_16x16x32_bf16 v[36:39], v[164:167], a[56:59], v[36:39]
buffer_load_dwordx4 v15, s[24:27], s72 offen offset:2048 lds
v_mfma_f32_16x16x32_bf16 v[36:39], v[180:183], a[60:63], v[36:39]
s_add_u32 s72, s71, 46080
ds_read_b64_tr_b16 v[212:213], v9 offset:36864
v_mfma_f32_16x16x32_bf16 v[20:23], v[180:183], a[44:47], v[20:23]
ds_read_b64_tr_b16 v[214:215], v9 offset:38912
ds_read_b64_tr_b16 v[216:217], v10 offset:36864
v_mfma_f32_16x16x32_bf16 v[20:23], v[164:167], a[40:43], v[20:23]
buffer_load_dwordx4 v15, s[24:27], s72 offen offset:3072 lds
v_mfma_f32_16x16x32_bf16 v[20:23], v[148:151], a[36:39], v[20:23]
s_add_u32 s69, s61, 1
ds_read_b64_tr_b16 v[218:219], v10 offset:38912
v_mfma_f32_16x16x32_bf16 v[20:23], v[132:135], a[32:35], v[20:23]
s_and_b32 s69, s69, 3
ds_read_b64_tr_b16 v[220:221], v11 offset:36864
ds_read_b64_tr_b16 v[222:223], v11 offset:38912
v_mfma_f32_16x16x32_bf16 v[24:27], v[136:139], a[32:35], v[24:27]
s_add_u32 s69, s69, s79
ds_read_b64_tr_b16 v[224:225], v8 offset:40960
v_mfma_f32_16x16x32_bf16 v[24:27], v[152:155], a[36:39], v[24:27]
s_lshl_b32 s69, s69, 12
ds_read_b64_tr_b16 v[226:227], v8 offset:43008
ds_read_b64_tr_b16 v[228:229], v9 offset:40960
v_mfma_f32_16x16x32_bf16 v[24:27], v[168:171], a[40:43], v[24:27]
s_add_u32 s69, s69, s95
ds_read_b64_tr_b16 v[230:231], v9 offset:43008
v_mfma_f32_16x16x32_bf16 v[24:27], v[184:187], a[44:47], v[24:27]
ds_read_b64_tr_b16 v[232:233], v10 offset:40960
ds_read_b64_tr_b16 v[234:235], v10 offset:43008
v_mfma_f32_16x16x32_bf16 v[40:43], v[184:187], a[60:63], v[40:43]
ds_read_b64_tr_b16 v[236:237], v11 offset:40960
v_mfma_f32_16x16x32_bf16 v[40:43], v[168:171], a[56:59], v[40:43]
ds_read_b64_tr_b16 v[238:239], v11 offset:43008
ds_read_b64_tr_b16 v[240:241], v8 offset:45056
v_mfma_f32_16x16x32_bf16 v[40:43], v[152:155], a[52:55], v[40:43]
ds_read_b64_tr_b16 v[242:243], v8 offset:47104
v_mfma_f32_16x16x32_bf16 v[40:43], v[136:139], a[48:51], v[40:43]
ds_read_b64_tr_b16 v[244:245], v9 offset:45056
ds_read_b64_tr_b16 v[246:247], v9 offset:47104
v_mfma_f32_16x16x32_bf16 v[44:47], v[140:143], a[48:51], v[44:47]
ds_read_b64_tr_b16 v[248:249], v10 offset:45056
v_mfma_f32_16x16x32_bf16 v[44:47], v[156:159], a[52:55], v[44:47]
ds_read_b64_tr_b16 v[250:251], v10 offset:47104
ds_read_b64_tr_b16 v[252:253], v11 offset:45056
v_mfma_f32_16x16x32_bf16 v[44:47], v[172:175], a[56:59], v[44:47]
ds_read_b64_tr_b16 v[254:255], v11 offset:47104
v_mfma_f32_16x16x32_bf16 v[44:47], v[188:191], a[60:63], v[44:47]
v_mfma_f32_16x16x32_bf16 v[28:31], v[188:191], a[44:47], v[28:31]
v_mfma_f32_16x16x32_bf16 v[28:31], v[172:175], a[40:43], v[28:31]
v_mfma_f32_16x16x32_bf16 v[28:31], v[156:159], a[36:39], v[28:31]
s_waitcnt vmcnt(25) lgkmcnt(0)
v_mfma_f32_16x16x32_bf16 v[28:31], v[140:143], a[32:35], v[28:31]
s_barrier
v_mfma_f32_16x16x32_bf16 v[16:19], v[192:195], a[64:67], v[16:19]
buffer_load_dwordx4 a[32:35], v1, s[44:47], s69 offen sc1
buffer_load_dwordx4 a[36:39], v1, s[44:47], s69 offen offset:1024 sc1
buffer_load_dwordx4 a[40:43], v1, s[44:47], s69 offen offset:2048 sc1
buffer_load_dwordx4 a[44:47], v1, s[44:47], s69 offen offset:3072 sc1
s_add_u32 s69, s69, 0x20000
buffer_load_dwordx4 a[48:51], v1, s[44:47], s69 offen sc1
buffer_load_dwordx4 a[52:55], v1, s[44:47], s69 offen offset:1024 sc1
v_mfma_f32_16x16x32_bf16 v[16:19], v[208:211], a[68:71], v[16:19]
buffer_load_dwordx4 a[56:59], v1, s[44:47], s69 offen offset:2048 sc1
v_mfma_f32_16x16x32_bf16 v[16:19], v[224:227], a[72:75], v[16:19]
ds_read_b64_tr_b16 v[128:129], v8 offset:49152
ds_read_b64_tr_b16 v[130:131], v8 offset:51200
v_mfma_f32_16x16x32_bf16 v[16:19], v[240:243], a[76:79], v[16:19]
ds_read_b64_tr_b16 v[132:133], v9 offset:49152
ds_read_b64_tr_b16 v[134:135], v9 offset:51200
v_mfma_f32_16x16x32_bf16 v[32:35], v[240:243], a[92:95], v[32:35]
buffer_load_dwordx4 a[60:63], v1, s[44:47], s69 offen offset:3072 sc1
v_mfma_f32_16x16x32_bf16 v[32:35], v[224:227], a[88:91], v[32:35]
s_add_u32 s71, s61, 2
ds_read_b64_tr_b16 v[136:137], v10 offset:49152
v_mfma_f32_16x16x32_bf16 v[32:35], v[208:211], a[84:87], v[32:35]
s_and_b32 s71, s71, 3
ds_read_b64_tr_b16 v[138:139], v10 offset:51200
ds_read_b64_tr_b16 v[140:141], v11 offset:49152
v_mfma_f32_16x16x32_bf16 v[32:35], v[192:195], a[80:83], v[32:35]
s_add_u32 s71, s71, s79
s_lshl_b32 s71, s71, 18
s_add_u32 s71, s71, s94
s_add_u32 m0, s77, 32768
s_add_u32 s72, s71, 0
buffer_load_dwordx4 v15, s[24:27], s72 offen lds
v_mfma_f32_16x16x32_bf16 v[36:39], v[196:199], a[80:83], v[36:39]
s_add_u32 s72, s71, 15360
ds_read_b64_tr_b16 v[142:143], v11 offset:51200
v_mfma_f32_16x16x32_bf16 v[36:39], v[212:215], a[84:87], v[36:39]
buffer_load_dwordx4 v15, s[24:27], s72 offen offset:1024 lds
v_mfma_f32_16x16x32_bf16 v[36:39], v[228:231], a[88:91], v[36:39]
s_add_u32 s72, s71, 30720
ds_read_b64_tr_b16 v[144:145], v8 offset:53248
ds_read_b64_tr_b16 v[146:147], v8 offset:55296
v_mfma_f32_16x16x32_bf16 v[36:39], v[244:247], a[92:95], v[36:39]
ds_read_b64_tr_b16 v[148:149], v9 offset:53248
ds_read_b64_tr_b16 v[150:151], v9 offset:55296
v_mfma_f32_16x16x32_bf16 v[20:23], v[244:247], a[76:79], v[20:23]
buffer_load_dwordx4 v15, s[24:27], s72 offen offset:2048 lds
v_mfma_f32_16x16x32_bf16 v[20:23], v[228:231], a[72:75], v[20:23]
s_add_u32 s72, s71, 46080
ds_read_b64_tr_b16 v[152:153], v10 offset:53248
v_mfma_f32_16x16x32_bf16 v[20:23], v[212:215], a[68:71], v[20:23]
ds_read_b64_tr_b16 v[154:155], v10 offset:55296
ds_read_b64_tr_b16 v[156:157], v11 offset:53248
v_mfma_f32_16x16x32_bf16 v[20:23], v[196:199], a[64:67], v[20:23]
buffer_load_dwordx4 v15, s[24:27], s72 offen offset:3072 lds
v_mfma_f32_16x16x32_bf16 v[24:27], v[200:203], a[64:67], v[24:27]
s_add_u32 s82, s59, 12
ds_read_b64_tr_b16 v[158:159], v11 offset:55296
v_mfma_f32_16x16x32_bf16 v[24:27], v[216:219], a[68:71], v[24:27]
s_and_b32 s82, s82, 28
ds_read_b64_tr_b16 v[160:161], v8 offset:57344
ds_read_b64_tr_b16 v[162:163], v8 offset:59392
v_mfma_f32_16x16x32_bf16 v[24:27], v[232:235], a[72:75], v[24:27]
s_lshl_b32 s82, s82, 10
ds_read_b64_tr_b16 v[164:165], v9 offset:57344
ds_read_b64_tr_b16 v[166:167], v9 offset:59392
v_mfma_f32_16x16x32_bf16 v[24:27], v[248:251], a[76:79], v[24:27]
s_add_u32 s82, s82, s74
ds_read_b64_tr_b16 v[168:169], v10 offset:57344
v_mfma_f32_16x16x32_bf16 v[40:43], v[248:251], a[92:95], v[40:43]
ds_read_b64_tr_b16 v[170:171], v10 offset:59392
ds_read_b64_tr_b16 v[172:173], v11 offset:57344
v_mfma_f32_16x16x32_bf16 v[40:43], v[232:235], a[88:91], v[40:43]
ds_read_b64_tr_b16 v[174:175], v11 offset:59392
v_mfma_f32_16x16x32_bf16 v[40:43], v[216:219], a[84:87], v[40:43]
ds_read_b64_tr_b16 v[176:177], v8 offset:61440
ds_read_b64_tr_b16 v[178:179], v8 offset:63488
v_mfma_f32_16x16x32_bf16 v[40:43], v[200:203], a[80:83], v[40:43]
ds_read_b64_tr_b16 v[180:181], v9 offset:61440
ds_read_b64_tr_b16 v[182:183], v9 offset:63488
v_mfma_f32_16x16x32_bf16 v[44:47], v[204:207], a[80:83], v[44:47]
ds_read_b64_tr_b16 v[184:185], v10 offset:61440
v_mfma_f32_16x16x32_bf16 v[44:47], v[220:223], a[84:87], v[44:47]
ds_read_b64_tr_b16 v[186:187], v10 offset:63488
ds_read_b64_tr_b16 v[188:189], v11 offset:61440
v_mfma_f32_16x16x32_bf16 v[44:47], v[236:239], a[88:91], v[44:47]
ds_read_b64_tr_b16 v[190:191], v11 offset:63488
v_mfma_f32_16x16x32_bf16 v[44:47], v[252:255], a[92:95], v[44:47]
v_mfma_f32_16x16x32_bf16 v[28:31], v[252:255], a[76:79], v[28:31]
v_mfma_f32_16x16x32_bf16 v[28:31], v[236:239], a[72:75], v[28:31]
v_mfma_f32_16x16x32_bf16 v[28:31], v[220:223], a[68:71], v[28:31]
s_waitcnt vmcnt(24) lgkmcnt(0)
v_mfma_f32_16x16x32_bf16 v[28:31], v[204:207], a[64:67], v[28:31]
s_barrier
v_mfma_f32_16x16x32_bf16 v[16:19], v[128:131], a[96:99], v[16:19]
buffer_load_dword v3, v2, s[44:47], s82 offen sc1
s_add_u32 s69, s61, 2
s_and_b32 s69, s69, 3
s_add_u32 s69, s69, s79
s_lshl_b32 s69, s69, 12
s_add_u32 s69, s69, s95
buffer_load_dwordx4 a[64:67], v1, s[44:47], s69 offen sc1
buffer_load_dwordx4 a[68:71], v1, s[44:47], s69 offen offset:1024 sc1
buffer_load_dwordx4 a[72:75], v1, s[44:47], s69 offen offset:2048 sc1
buffer_load_dwordx4 a[76:79], v1, s[44:47], s69 offen offset:3072 sc1
s_add_u32 s69, s69, 0x20000
buffer_load_dwordx4 a[80:83], v1, s[44:47], s69 offen sc1
v_or_b32 v112, s58, v0
v_mov_b32 v113, 3
v_min_u32 v112, 1, v112
v_lshlrev_b32 v112, 30, v112
buffer_store_dword v113, v112, s[44:47], s91 offen sc1
v_mfma_f32_16x16x32_bf16 v[16:19], v[144:147], a[100:103], v[16:19]
ds_read_b64_tr_b16 v[192:193], v8 offset:0
ds_read_b64_tr_b16 v[194:195], v8 offset:2048
v_mfma_f32_16x16x32_bf16 v[16:19], v[160:163], a[104:107], v[16:19]
ds_read_b64_tr_b16 v[196:197], v9 offset:0
ds_read_b64_tr_b16 v[198:199], v9 offset:2048
v_mfma_f32_16x16x32_bf16 v[16:19], v[176:179], a[108:111], v[16:19]
buffer_load_dwordx4 a[84:87], v1, s[44:47], s69 offen offset:1024 sc1
v_mfma_f32_16x16x32_bf16 v[32:35], v[176:179], a[124:127], v[32:35]
ds_read_b64_tr_b16 v[200:201], v10 offset:0
ds_read_b64_tr_b16 v[202:203], v10 offset:2048
v_mfma_f32_16x16x32_bf16 v[32:35], v[160:163], a[120:123], v[32:35]
ds_read_b64_tr_b16 v[204:205], v11 offset:0
v_mfma_f32_16x16x32_bf16 v[32:35], v[144:147], a[116:119], v[32:35]
buffer_load_dwordx4 a[88:91], v1, s[44:47], s69 offen offset:2048 sc1
v_mfma_f32_16x16x32_bf16 v[32:35], v[128:131], a[112:115], v[32:35]
ds_read_b64_tr_b16 v[206:207], v11 offset:2048
ds_read_b64_tr_b16 v[208:209], v8 offset:4096
v_mfma_f32_16x16x32_bf16 v[36:39], v[132:135], a[112:115], v[36:39]
ds_read_b64_tr_b16 v[210:211], v8 offset:6144
ds_read_b64_tr_b16 v[212:213], v9 offset:4096
v_mfma_f32_16x16x32_bf16 v[36:39], v[148:151], a[116:119], v[36:39]
buffer_load_dwordx4 a[92:95], v1, s[44:47], s69 offen offset:3072 sc1
v_mfma_f32_16x16x32_bf16 v[36:39], v[164:167], a[120:123], v[36:39]
s_add_u32 s71, s61, 3
ds_read_b64_tr_b16 v[214:215], v9 offset:6144
v_mfma_f32_16x16x32_bf16 v[36:39], v[180:183], a[124:127], v[36:39]
s_and_b32 s71, s71, 3
s_add_u32 s71, s71, s79
s_lshl_b32 s71, s71, 18
s_add_u32 s71, s71, s94
s_add_u32 m0, s77, 49152
s_add_u32 s72, s71, 0
buffer_load_dwordx4 v15, s[24:27], s72 offen lds
v_mfma_f32_16x16x32_bf16 v[20:23], v[180:183], a[108:111], v[20:23]
s_add_u32 s72, s71, 15360
ds_read_b64_tr_b16 v[216:217], v10 offset:4096
ds_read_b64_tr_b16 v[218:219], v10 offset:6144
v_mfma_f32_16x16x32_bf16 v[20:23], v[164:167], a[104:107], v[20:23]
ds_read_b64_tr_b16 v[220:221], v11 offset:4096
ds_read_b64_tr_b16 v[222:223], v11 offset:6144
v_mfma_f32_16x16x32_bf16 v[20:23], v[148:151], a[100:103], v[20:23]
buffer_load_dwordx4 v15, s[24:27], s72 offen offset:1024 lds
v_mfma_f32_16x16x32_bf16 v[20:23], v[132:135], a[96:99], v[20:23]
s_add_u32 s72, s71, 30720
ds_read_b64_tr_b16 v[224:225], v8 offset:8192
v_mfma_f32_16x16x32_bf16 v[24:27], v[136:139], a[96:99], v[24:27]
ds_read_b64_tr_b16 v[226:227], v8 offset:10240
ds_read_b64_tr_b16 v[228:229], v9 offset:8192
v_mfma_f32_16x16x32_bf16 v[24:27], v[152:155], a[100:103], v[24:27]
buffer_load_dwordx4 v15, s[24:27], s72 offen offset:2048 lds
v_mfma_f32_16x16x32_bf16 v[24:27], v[168:171], a[104:107], v[24:27]
s_add_u32 s72, s71, 46080
ds_read_b64_tr_b16 v[230:231], v9 offset:10240
ds_read_b64_tr_b16 v[232:233], v10 offset:8192
v_mfma_f32_16x16x32_bf16 v[24:27], v[184:187], a[108:111], v[24:27]
ds_read_b64_tr_b16 v[234:235], v10 offset:10240
v_mfma_f32_16x16x32_bf16 v[40:43], v[184:187], a[124:127], v[40:43]
buffer_load_dwordx4 v15, s[24:27], s72 offen offset:3072 lds
v_mfma_f32_16x16x32_bf16 v[40:43], v[168:171], a[120:123], v[40:43]
s_add_u32 s69, s61, 3
ds_read_b64_tr_b16 v[236:237], v11 offset:8192
ds_read_b64_tr_b16 v[238:239], v11 offset:10240
v_mfma_f32_16x16x32_bf16 v[40:43], v[152:155], a[116:119], v[40:43]
s_and_b32 s69, s69, 3
ds_read_b64_tr_b16 v[240:241], v8 offset:12288
ds_read_b64_tr_b16 v[242:243], v8 offset:14336
v_mfma_f32_16x16x32_bf16 v[40:43], v[136:139], a[112:115], v[40:43]
s_add_u32 s69, s69, s79
ds_read_b64_tr_b16 v[244:245], v9 offset:12288
v_mfma_f32_16x16x32_bf16 v[44:47], v[140:143], a[112:115], v[44:47]
s_lshl_b32 s69, s69, 12
ds_read_b64_tr_b16 v[246:247], v9 offset:14336
ds_read_b64_tr_b16 v[248:249], v10 offset:12288
v_mfma_f32_16x16x32_bf16 v[44:47], v[156:159], a[116:119], v[44:47]
s_add_u32 s69, s69, s95
ds_read_b64_tr_b16 v[250:251], v10 offset:14336
ds_read_b64_tr_b16 v[252:253], v11 offset:12288
v_mfma_f32_16x16x32_bf16 v[44:47], v[172:175], a[120:123], v[44:47]
ds_read_b64_tr_b16 v[254:255], v11 offset:14336
v_mfma_f32_16x16x32_bf16 v[44:47], v[188:191], a[124:127], v[44:47]
v_mfma_f32_16x16x32_bf16 v[28:31], v[188:191], a[108:111], v[28:31]
v_mfma_f32_16x16x32_bf16 v[28:31], v[172:175], a[104:107], v[28:31]
v_mfma_f32_16x16x32_bf16 v[28:31], v[156:159], a[100:103], v[28:31]
s_waitcnt vmcnt(26) lgkmcnt(0)
v_mfma_f32_16x16x32_bf16 v[28:31], v[140:143], a[96:99], v[28:31]
s_barrier
v_mfma_f32_16x16x32_bf16 v[16:19], v[192:195], a[0:3], v[16:19]
buffer_load_dwordx4 a[96:99], v1, s[44:47], s69 offen sc1
buffer_load_dwordx4 a[100:103], v1, s[44:47], s69 offen offset:1024 sc1
buffer_load_dwordx4 a[104:107], v1, s[44:47], s69 offen offset:2048 sc1
buffer_load_dwordx4 a[108:111], v1, s[44:47], s69 offen offset:3072 sc1
v_mfma_f32_16x16x32_bf16 v[16:19], v[208:211], a[4:7], v[16:19]
s_add_u32 s69, s69, 0x20000
ds_read_b64_tr_b16 v[128:129], v8 offset:16384
ds_read_b64_tr_b16 v[130:131], v8 offset:18432
v_mfma_f32_16x16x32_bf16 v[16:19], v[224:227], a[8:11], v[16:19]
buffer_load_dwordx4 a[112:115], v1, s[44:47], s69 offen sc1
v_mfma_f32_16x16x32_bf16 v[16:19], v[240:243], a[12:15], v[16:19]
ds_read_b64_tr_b16 v[132:133], v9 offset:16384
ds_read_b64_tr_b16 v[134:135], v9 offset:18432
v_mfma_f32_16x16x32_bf16 v[32:35], v[240:243], a[28:31], v[32:35]
ds_read_b64_tr_b16 v[136:137], v10 offset:16384
ds_read_b64_tr_b16 v[138:139], v10 offset:18432
v_mfma_f32_16x16x32_bf16 v[32:35], v[224:227], a[24:27], v[32:35]
buffer_load_dwordx4 a[116:119], v1, s[44:47], s69 offen offset:1024 sc1
v_mfma_f32_16x16x32_bf16 v[32:35], v[208:211], a[20:23], v[32:35]
ds_read_b64_tr_b16 v[140:141], v11 offset:16384
ds_read_b64_tr_b16 v[142:143], v11 offset:18432
v_mfma_f32_16x16x32_bf16 v[32:35], v[192:195], a[16:19], v[32:35]
ds_read_b64_tr_b16 v[144:145], v8 offset:20480
v_mfma_f32_16x16x32_bf16 v[36:39], v[196:199], a[16:19], v[36:39]
buffer_load_dwordx4 a[120:123], v1, s[44:47], s69 offen offset:2048 sc1
v_mfma_f32_16x16x32_bf16 v[36:39], v[212:215], a[20:23], v[36:39]
ds_read_b64_tr_b16 v[146:147], v8 offset:22528
ds_read_b64_tr_b16 v[148:149], v9 offset:20480
v_mfma_f32_16x16x32_bf16 v[36:39], v[228:231], a[24:27], v[36:39]
ds_read_b64_tr_b16 v[150:151], v9 offset:22528
ds_read_b64_tr_b16 v[152:153], v10 offset:20480
v_mfma_f32_16x16x32_bf16 v[36:39], v[244:247], a[28:31], v[36:39]
buffer_load_dwordx4 a[124:127], v1, s[44:47], s69 offen offset:3072 sc1
v_mfma_f32_16x16x32_bf16 v[20:23], v[244:247], a[12:15], v[20:23]
s_add_u32 s78, s59, 12
ds_read_b64_tr_b16 v[154:155], v10 offset:22528
ds_read_b64_tr_b16 v[156:157], v11 offset:20480
v_mfma_f32_16x16x32_bf16 v[20:23], v[228:231], a[8:11], v[20:23]
s_and_b32 s78, s78, 28
ds_read_b64_tr_b16 v[158:159], v11 offset:22528
v_mfma_f32_16x16x32_bf16 v[20:23], v[212:215], a[4:7], v[20:23]
s_add_u32 s71, s61, 0
s_and_b32 s71, s71, 3
s_add_u32 s71, s71, s78
s_lshl_b32 s71, s71, 18
s_add_u32 s71, s71, s94
s_add_u32 m0, s77, 0
s_add_u32 s72, s71, 0
buffer_load_dwordx4 v15, s[24:27], s72 offen lds
v_mfma_f32_16x16x32_bf16 v[20:23], v[196:199], a[0:3], v[20:23]
s_add_u32 s72, s71, 15360
ds_read_b64_tr_b16 v[160:161], v8 offset:24576
ds_read_b64_tr_b16 v[162:163], v8 offset:26624
v_mfma_f32_16x16x32_bf16 v[24:27], v[200:203], a[0:3], v[24:27]
buffer_load_dwordx4 v15, s[24:27], s72 offen offset:1024 lds
v_mfma_f32_16x16x32_bf16 v[24:27], v[216:219], a[4:7], v[24:27]
s_add_u32 s72, s71, 30720
ds_read_b64_tr_b16 v[164:165], v9 offset:24576
ds_read_b64_tr_b16 v[166:167], v9 offset:26624
v_mfma_f32_16x16x32_bf16 v[24:27], v[232:235], a[8:11], v[24:27]
ds_read_b64_tr_b16 v[168:169], v10 offset:24576
ds_read_b64_tr_b16 v[170:171], v10 offset:26624
v_mfma_f32_16x16x32_bf16 v[24:27], v[248:251], a[12:15], v[24:27]
buffer_load_dwordx4 v15, s[24:27], s72 offen offset:2048 lds
v_mfma_f32_16x16x32_bf16 v[40:43], v[248:251], a[28:31], v[40:43]
s_add_u32 s72, s71, 46080
ds_read_b64_tr_b16 v[172:173], v11 offset:24576
ds_read_b64_tr_b16 v[174:175], v11 offset:26624
v_mfma_f32_16x16x32_bf16 v[40:43], v[232:235], a[24:27], v[40:43]
ds_read_b64_tr_b16 v[176:177], v8 offset:28672
v_mfma_f32_16x16x32_bf16 v[40:43], v[216:219], a[20:23], v[40:43]
buffer_load_dwordx4 v15, s[24:27], s72 offen offset:3072 lds
v_mfma_f32_16x16x32_bf16 v[40:43], v[200:203], a[16:19], v[40:43]
ds_read_b64_tr_b16 v[178:179], v8 offset:30720
ds_read_b64_tr_b16 v[180:181], v9 offset:28672
v_mfma_f32_16x16x32_bf16 v[44:47], v[204:207], a[16:19], v[44:47]
ds_read_b64_tr_b16 v[182:183], v9 offset:30720
ds_read_b64_tr_b16 v[184:185], v10 offset:28672
v_mfma_f32_16x16x32_bf16 v[44:47], v[220:223], a[20:23], v[44:47]
ds_read_b64_tr_b16 v[186:187], v10 offset:30720
ds_read_b64_tr_b16 v[188:189], v11 offset:28672
v_mfma_f32_16x16x32_bf16 v[44:47], v[236:239], a[24:27], v[44:47]
ds_read_b64_tr_b16 v[190:191], v11 offset:30720
v_mfma_f32_16x16x32_bf16 v[44:47], v[252:255], a[28:31], v[44:47]
v_mfma_f32_16x16x32_bf16 v[28:31], v[252:255], a[12:15], v[28:31]
v_mfma_f32_16x16x32_bf16 v[28:31], v[236:239], a[8:11], v[28:31]
v_mfma_f32_16x16x32_bf16 v[28:31], v[220:223], a[4:7], v[28:31]
s_waitcnt vmcnt(26) lgkmcnt(0)
v_mfma_f32_16x16x32_bf16 v[28:31], v[204:207], a[0:3], v[28:31]
s_barrier
v_mfma_f32_16x16x32_bf16 v[16:19], v[128:131], a[32:35], v[16:19]
s_waitcnt vmcnt(25)
v_cmp_gt_u32 vcc, 2, v3
s_cbranch_vccnz Lspin109
Lback110:
s_add_u32 s82, s59, 16
s_and_b32 s82, s82, 28
s_lshl_b32 s82, s82, 10
s_add_u32 s82, s82, s74
buffer_load_dword v3, v2, s[44:47], s82 offen sc1
s_add_u32 s69, s61, 0
s_and_b32 s69, s69, 3
s_add_u32 s69, s69, s78
s_lshl_b32 s69, s69, 12
s_add_u32 s69, s69, s95
buffer_load_dwordx4 a[0:3], v1, s[44:47], s69 offen sc1
buffer_load_dwordx4 a[4:7], v1, s[44:47], s69 offen offset:1024 sc1
buffer_load_dwordx4 a[8:11], v1, s[44:47], s69 offen offset:2048 sc1
v_mfma_f32_16x16x32_bf16 v[16:19], v[144:147], a[36:39], v[16:19]
buffer_load_dwordx4 a[12:15], v1, s[44:47], s69 offen offset:3072 sc1
v_mfma_f32_16x16x32_bf16 v[16:19], v[160:163], a[40:43], v[16:19]
s_add_u32 s69, s69, 0x20000
ds_read_b64_tr_b16 v[192:193], v8 offset:32768
ds_read_b64_tr_b16 v[194:195], v8 offset:34816
v_mfma_f32_16x16x32_bf16 v[16:19], v[176:179], a[44:47], v[16:19]
ds_read_b64_tr_b16 v[196:197], v9 offset:32768
ds_read_b64_tr_b16 v[198:199], v9 offset:34816
v_mfma_f32_16x16x32_bf16 v[32:35], v[176:179], a[60:63], v[32:35]
buffer_load_dwordx4 a[16:19], v1, s[44:47], s69 offen sc1
v_mfma_f32_16x16x32_bf16 v[32:35], v[160:163], a[56:59], v[32:35]
ds_read_b64_tr_b16 v[200:201], v10 offset:32768
ds_read_b64_tr_b16 v[202:203], v10 offset:34816
v_mfma_f32_16x16x32_bf16 v[32:35], v[144:147], a[52:55], v[32:35]
ds_read_b64_tr_b16 v[204:205], v11 offset:32768
ds_read_b64_tr_b16 v[206:207], v11 offset:34816
v_mfma_f32_16x16x32_bf16 v[32:35], v[128:131], a[48:51], v[32:35]
buffer_load_dwordx4 a[20:23], v1, s[44:47], s69 offen offset:1024 sc1
v_mfma_f32_16x16x32_bf16 v[36:39], v[132:135], a[48:51], v[36:39]
ds_read_b64_tr_b16 v[208:209], v8 offset:36864
ds_read_b64_tr_b16 v[210:211], v8 offset:38912
v_mfma_f32_16x16x32_bf16 v[36:39], v[148:151], a[52:55], v[36:39]
ds_read_b64_tr_b16 v[212:213], v9 offset:36864
ds_read_b64_tr_b16 v[214:215], v9 offset:38912
v_mfma_f32_16x16x32_bf16 v[36:39], v[164:167], a[56:59], v[36:39]
buffer_load_dwordx4 a[24:27], v1, s[44:47], s69 offen offset:2048 sc1
v_mfma_f32_16x16x32_bf16 v[36:39], v[180:183], a[60:63], v[36:39]
ds_read_b64_tr_b16 v[216:217], v10 offset:36864
ds_read_b64_tr_b16 v[218:219], v10 offset:38912
v_mfma_f32_16x16x32_bf16 v[20:23], v[180:183], a[44:47], v[20:23]
ds_read_b64_tr_b16 v[220:221], v11 offset:36864
ds_read_b64_tr_b16 v[222:223], v11 offset:38912
v_mfma_f32_16x16x32_bf16 v[20:23], v[164:167], a[40:43], v[20:23]
buffer_load_dwordx4 a[28:31], v1, s[44:47], s69 offen offset:3072 sc1
v_mfma_f32_16x16x32_bf16 v[20:23], v[148:151], a[36:39], v[20:23]
s_add_u32 s71, s61, 1
ds_read_b64_tr_b16 v[224:225], v8 offset:40960
v_mfma_f32_16x16x32_bf16 v[20:23], v[132:135], a[32:35], v[20:23]
s_and_b32 s71, s71, 3
ds_read_b64_tr_b16 v[226:227], v8 offset:43008
ds_read_b64_tr_b16 v[228:229], v9 offset:40960
v_mfma_f32_16x16x32_bf16 v[24:27], v[136:139], a[32:35], v[24:27]
s_add_u32 s71, s71, s78
s_lshl_b32 s71, s71, 18
s_add_u32 s71, s71, s94
s_add_u32 m0, s77, 16384
s_add_u32 s72, s71, 0
buffer_load_dwordx4 v15, s[24:27], s72 offen lds
v_mfma_f32_16x16x32_bf16 v[24:27], v[152:155], a[36:39], v[24:27]
s_add_u32 s72, s71, 15360
ds_read_b64_tr_b16 v[230:231], v9 offset:43008
ds_read_b64_tr_b16 v[232:233], v10 offset:40960
v_mfma_f32_16x16x32_bf16 v[24:27], v[168:171], a[40:43], v[24:27]
buffer_load_dwordx4 v15, s[24:27], s72 offen offset:1024 lds
v_mfma_f32_16x16x32_bf16 v[24:27], v[184:187], a[44:47], v[24:27]
s_add_u32 s72, s71, 30720
ds_read_b64_tr_b16 v[234:235], v10 offset:43008
ds_read_b64_tr_b16 v[236:237], v11 offset:40960
v_mfma_f32_16x16x32_bf16 v[40:43], v[184:187], a[60:63], v[40:43]
ds_read_b64_tr_b16 v[238:239], v11 offset:43008
ds_read_b64_tr_b16 v[240:241], v8 offset:45056
v_mfma_f32_16x16x32_bf16 v[40:43], v[168:171], a[56:59], v[40:43]
buffer_load_dwordx4 v15, s[24:27], s72 offen offset:2048 lds
v_mfma_f32_16x16x32_bf16 v[40:43], v[152:155], a[52:55], v[40:43]
s_add_u32 s72, s71, 46080
ds_read_b64_tr_b16 v[242:243], v8 offset:47104
ds_read_b64_tr_b16 v[244:245], v9 offset:45056
v_mfma_f32_16x16x32_bf16 v[40:43], v[136:139], a[48:51], v[40:43]
ds_read_b64_tr_b16 v[246:247], v9 offset:47104
ds_read_b64_tr_b16 v[248:249], v10 offset:45056
v_mfma_f32_16x16x32_bf16 v[44:47], v[140:143], a[48:51], v[44:47]
buffer_load_dwordx4 v15, s[24:27], s72 offen offset:3072 lds
v_mfma_f32_16x16x32_bf16 v[44:47], v[156:159], a[52:55], v[44:47]
s_add_u32 s69, s61, 1
ds_read_b64_tr_b16 v[250:251], v10 offset:47104
ds_read_b64_tr_b16 v[252:253], v11 offset:45056
v_mfma_f32_16x16x32_bf16 v[44:47], v[172:175], a[56:59], v[44:47]
s_and_b32 s69, s69, 3
ds_read_b64_tr_b16 v[254:255], v11 offset:47104
v_mfma_f32_16x16x32_bf16 v[44:47], v[188:191], a[60:63], v[44:47]
s_add_u32 s69, s69, s78
v_mfma_f32_16x16x32_bf16 v[28:31], v[188:191], a[44:47], v[28:31]
s_lshl_b32 s69, s69, 12
v_mfma_f32_16x16x32_bf16 v[28:31], v[172:175], a[40:43], v[28:31]
s_add_u32 s69, s69, s95
v_mfma_f32_16x16x32_bf16 v[28:31], v[156:159], a[36:39], v[28:31]
s_waitcnt vmcnt(25) lgkmcnt(0)
v_mfma_f32_16x16x32_bf16 v[28:31], v[140:143], a[32:35], v[28:31]
s_barrier
v_mfma_f32_16x16x32_bf16 v[16:19], v[192:195], a[64:67], v[16:19]
buffer_load_dwordx4 a[32:35], v1, s[44:47], s69 offen sc1
buffer_load_dwordx4 a[36:39], v1, s[44:47], s69 offen offset:1024 sc1
v_mfma_f32_16x16x32_bf16 v[16:19], v[208:211], a[68:71], v[16:19]
buffer_load_dwordx4 a[40:43], v1, s[44:47], s69 offen offset:2048 sc1
v_mfma_f32_16x16x32_bf16 v[16:19], v[224:227], a[72:75], v[16:19]
ds_read_b64_tr_b16 v[128:129], v8 offset:49152
ds_read_b64_tr_b16 v[130:131], v8 offset:51200
v_mfma_f32_16x16x32_bf16 v[16:19], v[240:243], a[76:79], v[16:19]
buffer_load_dwordx4 a[44:47], v1, s[44:47], s69 offen offset:3072 sc1
v_mfma_f32_16x16x32_bf16 v[32:35], v[240:243], a[92:95], v[32:35]
s_add_u32 s69, s69, 0x20000
ds_read_b64_tr_b16 v[132:133], v9 offset:49152
ds_read_b64_tr_b16 v[134:135], v9 offset:51200
v_mfma_f32_16x16x32_bf16 v[32:35], v[224:227], a[88:91], v[32:35]
ds_read_b64_tr_b16 v[136:137], v10 offset:49152
ds_read_b64_tr_b16 v[138:139], v10 offset:51200
v_mfma_f32_16x16x32_bf16 v[32:35], v[208:211], a[84:87], v[32:35]
buffer_load_dwordx4 a[48:51], v1, s[44:47], s69 offen sc1
v_mfma_f32_16x16x32_bf16 v[32:35], v[192:195], a[80:83], v[32:35]
ds_read_b64_tr_b16 v[140:141], v11 offset:49152
ds_read_b64_tr_b16 v[142:143], v11 offset:51200
v_mfma_f32_16x16x32_bf16 v[36:39], v[196:199], a[80:83], v[36:39]
ds_read_b64_tr_b16 v[144:145], v8 offset:53248
ds_read_b64_tr_b16 v[146:147], v8 offset:55296
v_mfma_f32_16x16x32_bf16 v[36:39], v[212:215], a[84:87], v[36:39]
buffer_load_dwordx4 a[52:55], v1, s[44:47], s69 offen offset:1024 sc1
v_mfma_f32_16x16x32_bf16 v[36:39], v[228:231], a[88:91], v[36:39]
ds_read_b64_tr_b16 v[148:149], v9 offset:53248
ds_read_b64_tr_b16 v[150:151], v9 offset:55296
v_mfma_f32_16x16x32_bf16 v[36:39], v[244:247], a[92:95], v[36:39]
ds_read_b64_tr_b16 v[152:153], v10 offset:53248
ds_read_b64_tr_b16 v[154:155], v10 offset:55296
v_mfma_f32_16x16x32_bf16 v[20:23], v[244:247], a[76:79], v[20:23]
buffer_load_dwordx4 a[56:59], v1, s[44:47], s69 offen offset:2048 sc1
v_mfma_f32_16x16x32_bf16 v[20:23], v[228:231], a[72:75], v[20:23]
ds_read_b64_tr_b16 v[156:157], v11 offset:53248
ds_read_b64_tr_b16 v[158:159], v11 offset:55296
v_mfma_f32_16x16x32_bf16 v[20:23], v[212:215], a[68:71], v[20:23]
ds_read_b64_tr_b16 v[160:161], v8 offset:57344
ds_read_b64_tr_b16 v[162:163], v8 offset:59392
v_mfma_f32_16x16x32_bf16 v[20:23], v[196:199], a[64:67], v[20:23]
buffer_load_dwordx4 a[60:63], v1, s[44:47], s69 offen offset:3072 sc1
v_mfma_f32_16x16x32_bf16 v[24:27], v[200:203], a[64:67], v[24:27]
s_add_u32 s71, s61, 2
ds_read_b64_tr_b16 v[164:165], v9 offset:57344
ds_read_b64_tr_b16 v[166:167], v9 offset:59392
v_mfma_f32_16x16x32_bf16 v[24:27], v[216:219], a[68:71], v[24:27]
s_and_b32 s71, s71, 3
ds_read_b64_tr_b16 v[168:169], v10 offset:57344
ds_read_b64_tr_b16 v[170:171], v10 offset:59392
v_mfma_f32_16x16x32_bf16 v[24:27], v[232:235], a[72:75], v[24:27]
s_add_u32 s71, s71, s78
s_lshl_b32 s71, s71, 18
s_add_u32 s71, s71, s94
s_add_u32 m0, s77, 32768
s_add_u32 s72, s71, 0
buffer_load_dwordx4 v15, s[24:27], s72 offen lds
v_mfma_f32_16x16x32_bf16 v[24:27], v[248:251], a[76:79], v[24:27]
s_add_u32 s72, s71, 15360
ds_read_b64_tr_b16 v[172:173], v11 offset:57344
ds_read_b64_tr_b16 v[174:175], v11 offset:59392
v_mfma_f32_16x16x32_bf16 v[40:43], v[248:251], a[92:95], v[40:43]
ds_read_b64_tr_b16 v[176:177], v8 offset:61440
ds_read_b64_tr_b16 v[178:179], v8 offset:63488
v_mfma_f32_16x16x32_bf16 v[40:43], v[232:235], a[88:91], v[40:43]
buffer_load_dwordx4 v15, s[24:27], s72 offen offset:1024 lds
v_mfma_f32_16x16x32_bf16 v[40:43], v[216:219], a[84:87], v[40:43]
s_add_u32 s72, s71, 30720
ds_read_b64_tr_b16 v[180:181], v9 offset:61440
ds_read_b64_tr_b16 v[182:183], v9 offset:63488
v_mfma_f32_16x16x32_bf16 v[40:43], v[200:203], a[80:83], v[40:43]
buffer_load_dwordx4 v15, s[24:27], s72 offen offset:2048 lds
v_mfma_f32_16x16x32_bf16 v[44:47], v[204:207], a[80:83], v[44:47]
s_add_u32 s72, s71, 46080
ds_read_b64_tr_b16 v[184:185], v10 offset:61440
ds_read_b64_tr_b16 v[186:187], v10 offset:63488
v_mfma_f32_16x16x32_bf16 v[44:47], v[220:223], a[84:87], v[44:47]
ds_read_b64_tr_b16 v[188:189], v11 offset:61440
ds_read_b64_tr_b16 v[190:191], v11 offset:63488
v_mfma_f32_16x16x32_bf16 v[44:47], v[236:239], a[88:91], v[44:47]
buffer_load_dwordx4 v15, s[24:27], s72 offen offset:3072 lds
v_mfma_f32_16x16x32_bf16 v[44:47], v[252:255], a[92:95], v[44:47]
s_add_u32 s69, s61, 2
v_mfma_f32_16x16x32_bf16 v[28:31], v[252:255], a[76:79], v[28:31]
s_and_b32 s69, s69, 3
v_mfma_f32_16x16x32_bf16 v[28:31], v[236:239], a[72:75], v[28:31]
s_add_u32 s69, s69, s78
v_mfma_f32_16x16x32_bf16 v[28:31], v[220:223], a[68:71], v[28:31]
s_waitcnt vmcnt(25) lgkmcnt(0)
v_mfma_f32_16x16x32_bf16 v[28:31], v[204:207], a[64:67], v[28:31]
s_barrier
v_mfma_f32_16x16x32_bf16 v[16:19], v[128:131], a[96:99], v[16:19]
s_lshl_b32 s69, s69, 12
s_add_u32 s69, s69, s95
buffer_load_dwordx4 a[64:67], v1, s[44:47], s69 offen sc1
buffer_load_dwordx4 a[68:71], v1, s[44:47], s69 offen offset:1024 sc1
v_mfma_f32_16x16x32_bf16 v[16:19], v[144:147], a[100:103], v[16:19]
ds_read_b64_tr_b16 v[192:193], v8 offset:0
ds_read_b64_tr_b16 v[194:195], v8 offset:2048
v_mfma_f32_16x16x32_bf16 v[16:19], v[160:163], a[104:107], v[16:19]
ds_read_b64_tr_b16 v[196:197], v9 offset:0
ds_read_b64_tr_b16 v[198:199], v9 offset:2048
v_mfma_f32_16x16x32_bf16 v[16:19], v[176:179], a[108:111], v[16:19]
buffer_load_dwordx4 a[72:75], v1, s[44:47], s69 offen offset:2048 sc1
v_mfma_f32_16x16x32_bf16 v[32:35], v[176:179], a[124:127], v[32:35]
ds_read_b64_tr_b16 v[200:201], v10 offset:0
ds_read_b64_tr_b16 v[202:203], v10 offset:2048
v_mfma_f32_16x16x32_bf16 v[32:35], v[160:163], a[120:123], v[32:35]
ds_read_b64_tr_b16 v[204:205], v11 offset:0
ds_read_b64_tr_b16 v[206:207], v11 offset:2048
v_mfma_f32_16x16x32_bf16 v[32:35], v[144:147], a[116:119], v[32:35]
buffer_load_dwordx4 a[76:79], v1, s[44:47], s69 offen offset:3072 sc1
v_mfma_f32_16x16x32_bf16 v[32:35], v[128:131], a[112:115], v[32:35]
s_add_u32 s69, s69, 0x20000
ds_read_b64_tr_b16 v[208:209], v8 offset:4096
ds_read_b64_tr_b16 v[210:211], v8 offset:6144
v_mfma_f32_16x16x32_bf16 v[36:39], v[132:135], a[112:115], v[36:39]
buffer_load_dwordx4 a[80:83], v1, s[44:47], s69 offen sc1
v_mfma_f32_16x16x32_bf16 v[36:39], v[148:151], a[116:119], v[36:39]
ds_read_b64_tr_b16 v[212:213], v9 offset:4096
ds_read_b64_tr_b16 v[214:215], v9 offset:6144
v_mfma_f32_16x16x32_bf16 v[36:39], v[164:167], a[120:123], v[36:39]
ds_read_b64_tr_b16 v[216:217], v10 offset:4096
ds_read_b64_tr_b16 v[218:219], v10 offset:6144
v_mfma_f32_16x16x32_bf16 v[36:39], v[180:183], a[124:127], v[36:39]
buffer_load_dwordx4 a[84:87], v1, s[44:47], s69 offen offset:1024 sc1
v_mfma_f32_16x16x32_bf16 v[20:23], v[180:183], a[108:111], v[20:23]
ds_read_b64_tr_b16 v[220:221], v11 offset:4096
ds_read_b64_tr_b16 v[222:223], v11 offset:6144
v_mfma_f32_16x16x32_bf16 v[20:23], v[164:167], a[104:107], v[20:23]
ds_read_b64_tr_b16 v[224:225], v8 offset:8192
v_mfma_f32_16x16x32_bf16 v[20:23], v[148:151], a[100:103], v[20:23]
buffer_load_dwordx4 a[88:91], v1, s[44:47], s69 offen offset:2048 sc1
v_mfma_f32_16x16x32_bf16 v[20:23], v[132:135], a[96:99], v[20:23]
ds_read_b64_tr_b16 v[226:227], v8 offset:10240
ds_read_b64_tr_b16 v[228:229], v9 offset:8192
v_mfma_f32_16x16x32_bf16 v[24:27], v[136:139], a[96:99], v[24:27]
ds_read_b64_tr_b16 v[230:231], v9 offset:10240
ds_read_b64_tr_b16 v[232:233], v10 offset:8192
v_mfma_f32_16x16x32_bf16 v[24:27], v[152:155], a[100:103], v[24:27]
buffer_load_dwordx4 a[92:95], v1, s[44:47], s69 offen offset:3072 sc1
v_mfma_f32_16x16x32_bf16 v[24:27], v[168:171], a[104:107], v[24:27]
s_add_u32 s71, s61, 3
ds_read_b64_tr_b16 v[234:235], v10 offset:10240
ds_read_b64_tr_b16 v[236:237], v11 offset:8192
v_mfma_f32_16x16x32_bf16 v[24:27], v[184:187], a[108:111], v[24:27]
s_and_b32 s71, s71, 3
ds_read_b64_tr_b16 v[238:239], v11 offset:10240
ds_read_b64_tr_b16 v[240:241], v8 offset:12288
v_mfma_f32_16x16x32_bf16 v[40:43], v[184:187], a[124:127], v[40:43]
s_add_u32 s71, s71, s78
s_lshl_b32 s71, s71, 18
s_add_u32 s71, s71, s94
s_add_u32 m0, s77, 49152
s_add_u32 s72, s71, 0
buffer_load_dwordx4 v15, s[24:27], s72 offen lds
v_mfma_f32_16x16x32_bf16 v[40:43], v[168:171], a[120:123], v[40:43]
s_add_u32 s72, s71, 15360
ds_read_b64_tr_b16 v[242:243], v8 offset:14336
ds_read_b64_tr_b16 v[244:245], v9 offset:12288
v_mfma_f32_16x16x32_bf16 v[40:43], v[152:155], a[116:119], v[40:43]
ds_read_b64_tr_b16 v[246:247], v9 offset:14336
ds_read_b64_tr_b16 v[248:249], v10 offset:12288
v_mfma_f32_16x16x32_bf16 v[40:43], v[136:139], a[112:115], v[40:43]
buffer_load_dwordx4 v15, s[24:27], s72 offen offset:1024 lds
v_mfma_f32_16x16x32_bf16 v[44:47], v[140:143], a[112:115], v[44:47]
s_add_u32 s72, s71, 30720
ds_read_b64_tr_b16 v[250:251], v10 offset:14336
ds_read_b64_tr_b16 v[252:253], v11 offset:12288
v_mfma_f32_16x16x32_bf16 v[44:47], v[156:159], a[116:119], v[44:47]
buffer_load_dwordx4 v15, s[24:27], s72 offen offset:2048 lds
v_mfma_f32_16x16x32_bf16 v[44:47], v[172:175], a[120:123], v[44:47]
s_add_u32 s72, s71, 46080
ds_read_b64_tr_b16 v[254:255], v11 offset:14336
v_mfma_f32_16x16x32_bf16 v[44:47], v[188:191], a[124:127], v[44:47]
v_mfma_f32_16x16x32_bf16 v[28:31], v[188:191], a[108:111], v[28:31]
buffer_load_dwordx4 v15, s[24:27], s72 offen offset:3072 lds
v_mfma_f32_16x16x32_bf16 v[28:31], v[172:175], a[104:107], v[28:31]
s_add_u32 s69, s61, 3
v_mfma_f32_16x16x32_bf16 v[28:31], v[156:159], a[100:103], v[28:31]
s_waitcnt vmcnt(24) lgkmcnt(0)
v_mfma_f32_16x16x32_bf16 v[28:31], v[140:143], a[96:99], v[28:31]
s_barrier
v_mfma_f32_16x16x32_bf16 v[16:19], v[192:195], a[0:3], v[16:19]
s_and_b32 s69, s69, 3
s_add_u32 s69, s69, s78
s_lshl_b32 s69, s69, 12
s_add_u32 s69, s69, s95
buffer_load_dwordx4 a[96:99], v1, s[44:47], s69 offen sc1
v_mfma_f32_16x16x32_bf16 v[16:19], v[208:211], a[4:7], v[16:19]
ds_read_b64_tr_b16 v[128:129], v8 offset:16384
ds_read_b64_tr_b16 v[130:131], v8 offset:18432
v_mfma_f32_16x16x32_bf16 v[16:19], v[224:227], a[8:11], v[16:19]
buffer_load_dwordx4 a[100:103], v1, s[44:47], s69 offen offset:1024 sc1
v_mfma_f32_16x16x32_bf16 v[16:19], v[240:243], a[12:15], v[16:19]
ds_read_b64_tr_b16 v[132:133], v9 offset:16384
ds_read_b64_tr_b16 v[134:135], v9 offset:18432
v_mfma_f32_16x16x32_bf16 v[32:35], v[240:243], a[28:31], v[32:35]
ds_read_b64_tr_b16 v[136:137], v10 offset:16384
ds_read_b64_tr_b16 v[138:139], v10 offset:18432
v_mfma_f32_16x16x32_bf16 v[32:35], v[224:227], a[24:27], v[32:35]
buffer_load_dwordx4 a[104:107], v1, s[44:47], s69 offen offset:2048 sc1
v_mfma_f32_16x16x32_bf16 v[32:35], v[208:211], a[20:23], v[32:35]
ds_read_b64_tr_b16 v[140:141], v11 offset:16384
ds_read_b64_tr_b16 v[142:143], v11 offset:18432
v_mfma_f32_16x16x32_bf16 v[32:35], v[192:195], a[16:19], v[32:35]
ds_read_b64_tr_b16 v[144:145], v8 offset:20480
ds_read_b64_tr_b16 v[146:147], v8 offset:22528
v_mfma_f32_16x16x32_bf16 v[36:39], v[196:199], a[16:19], v[36:39]
buffer_load_dwordx4 a[108:111], v1, s[44:47], s69 offen offset:3072 sc1
v_mfma_f32_16x16x32_bf16 v[36:39], v[212:215], a[20:23], v[36:39]
s_add_u32 s69, s69, 0x20000
ds_read_b64_tr_b16 v[148:149], v9 offset:20480
ds_read_b64_tr_b16 v[150:151], v9 offset:22528
v_mfma_f32_16x16x32_bf16 v[36:39], v[228:231], a[24:27], v[36:39]
buffer_load_dwordx4 a[112:115], v1, s[44:47], s69 offen sc1
v_mfma_f32_16x16x32_bf16 v[36:39], v[244:247], a[28:31], v[36:39]
ds_read_b64_tr_b16 v[152:153], v10 offset:20480
ds_read_b64_tr_b16 v[154:155], v10 offset:22528
v_mfma_f32_16x16x32_bf16 v[20:23], v[244:247], a[12:15], v[20:23]
ds_read_b64_tr_b16 v[156:157], v11 offset:20480
ds_read_b64_tr_b16 v[158:159], v11 offset:22528
v_mfma_f32_16x16x32_bf16 v[20:23], v[228:231], a[8:11], v[20:23]
buffer_load_dwordx4 a[116:119], v1, s[44:47], s69 offen offset:1024 sc1
v_mfma_f32_16x16x32_bf16 v[20:23], v[212:215], a[4:7], v[20:23]
ds_read_b64_tr_b16 v[160:161], v8 offset:24576
v_mfma_f32_16x16x32_bf16 v[20:23], v[196:199], a[0:3], v[20:23]
ds_read_b64_tr_b16 v[162:163], v8 offset:26624
ds_read_b64_tr_b16 v[164:165], v9 offset:24576
v_mfma_f32_16x16x32_bf16 v[24:27], v[200:203], a[0:3], v[24:27]
buffer_load_dwordx4 a[120:123], v1, s[44:47], s69 offen offset:2048 sc1
v_mfma_f32_16x16x32_bf16 v[24:27], v[216:219], a[4:7], v[24:27]
ds_read_b64_tr_b16 v[166:167], v9 offset:26624
ds_read_b64_tr_b16 v[168:169], v10 offset:24576
v_mfma_f32_16x16x32_bf16 v[24:27], v[232:235], a[8:11], v[24:27]
ds_read_b64_tr_b16 v[170:171], v10 offset:26624
ds_read_b64_tr_b16 v[172:173], v11 offset:24576
v_mfma_f32_16x16x32_bf16 v[24:27], v[248:251], a[12:15], v[24:27]
buffer_load_dwordx4 a[124:127], v1, s[44:47], s69 offen offset:3072 sc1
v_mfma_f32_16x16x32_bf16 v[40:43], v[248:251], a[28:31], v[40:43]
s_add_u32 s79, s59, 16
ds_read_b64_tr_b16 v[174:175], v11 offset:26624
ds_read_b64_tr_b16 v[176:177], v8 offset:28672
v_mfma_f32_16x16x32_bf16 v[40:43], v[232:235], a[24:27], v[40:43]
s_and_b32 s79, s79, 28
ds_read_b64_tr_b16 v[178:179], v8 offset:30720
ds_read_b64_tr_b16 v[180:181], v9 offset:28672
v_mfma_f32_16x16x32_bf16 v[40:43], v[216:219], a[20:23], v[40:43]
s_add_u32 s71, s61, 0
s_and_b32 s71, s71, 3
s_add_u32 s71, s71, s79
s_lshl_b32 s71, s71, 18
s_add_u32 s71, s71, s94
s_add_u32 m0, s77, 0
s_add_u32 s72, s71, 0
buffer_load_dwordx4 v15, s[24:27], s72 offen lds
v_mfma_f32_16x16x32_bf16 v[40:43], v[200:203], a[16:19], v[40:43]
s_add_u32 s72, s71, 15360
ds_read_b64_tr_b16 v[182:183], v9 offset:30720
ds_read_b64_tr_b16 v[184:185], v10 offset:28672
v_mfma_f32_16x16x32_bf16 v[44:47], v[204:207], a[16:19], v[44:47]
ds_read_b64_tr_b16 v[186:187], v10 offset:30720
ds_read_b64_tr_b16 v[188:189], v11 offset:28672
v_mfma_f32_16x16x32_bf16 v[44:47], v[220:223], a[20:23], v[44:47]
buffer_load_dwordx4 v15, s[24:27], s72 offen offset:1024 lds
v_mfma_f32_16x16x32_bf16 v[44:47], v[236:239], a[24:27], v[44:47]
s_add_u32 s72, s71, 30720
ds_read_b64_tr_b16 v[190:191], v11 offset:30720
v_mfma_f32_16x16x32_bf16 v[44:47], v[252:255], a[28:31], v[44:47]
v_mfma_f32_16x16x32_bf16 v[28:31], v[252:255], a[12:15], v[28:31]
buffer_load_dwordx4 v15, s[24:27], s72 offen offset:2048 lds
v_mfma_f32_16x16x32_bf16 v[28:31], v[236:239], a[8:11], v[28:31]
s_add_u32 s72, s71, 46080
v_mfma_f32_16x16x32_bf16 v[28:31], v[220:223], a[4:7], v[28:31]
s_waitcnt vmcnt(23) lgkmcnt(0)
buffer_load_dwordx4 v15, s[24:27], s72 offen offset:3072 lds
v_mfma_f32_16x16x32_bf16 v[28:31], v[204:207], a[0:3], v[28:31]
s_barrier
v_mfma_f32_16x16x32_bf16 v[16:19], v[128:131], a[32:35], v[16:19]
ds_read_b64_tr_b16 v[192:193], v8 offset:32768
ds_read_b64_tr_b16 v[194:195], v8 offset:34816
v_mfma_f32_16x16x32_bf16 v[16:19], v[144:147], a[36:39], v[16:19]
s_waitcnt vmcnt(48)
v_cmp_gt_u32 vcc, 2, v3
s_cbranch_vccnz Lspin112
Lback113:
s_add_u32 s82, s59, 20
s_and_b32 s82, s82, 28
s_lshl_b32 s82, s82, 10
s_add_u32 s82, s82, s74
buffer_load_dword v3, v2, s[44:47], s82 offen sc1
s_add_u32 s69, s61, 0
s_and_b32 s69, s69, 3
s_add_u32 s69, s69, s79
s_lshl_b32 s69, s69, 12
s_add_u32 s69, s69, s95
buffer_load_dwordx4 a[0:3], v1, s[44:47], s69 offen sc1
v_mfma_f32_16x16x32_bf16 v[16:19], v[160:163], a[40:43], v[16:19]
ds_read_b64_tr_b16 v[196:197], v9 offset:32768
ds_read_b64_tr_b16 v[198:199], v9 offset:34816
v_mfma_f32_16x16x32_bf16 v[16:19], v[176:179], a[44:47], v[16:19]
ds_read_b64_tr_b16 v[200:201], v10 offset:32768
ds_read_b64_tr_b16 v[202:203], v10 offset:34816
v_mfma_f32_16x16x32_bf16 v[32:35], v[176:179], a[60:63], v[32:35]
buffer_load_dwordx4 a[4:7], v1, s[44:47], s69 offen offset:1024 sc1
v_mfma_f32_16x16x32_bf16 v[32:35], v[160:163], a[56:59], v[32:35]
ds_read_b64_tr_b16 v[204:205], v11 offset:32768
ds_read_b64_tr_b16 v[206:207], v11 offset:34816
v_mfma_f32_16x16x32_bf16 v[32:35], v[144:147], a[52:55], v[32:35]
ds_read_b64_tr_b16 v[208:209], v8 offset:36864
v_mfma_f32_16x16x32_bf16 v[32:35], v[128:131], a[48:51], v[32:35]
buffer_load_dwordx4 a[8:11], v1, s[44:47], s69 offen offset:2048 sc1
v_mfma_f32_16x16x32_bf16 v[36:39], v[132:135], a[48:51], v[36:39]
ds_read_b64_tr_b16 v[210:211], v8 offset:38912
ds_read_b64_tr_b16 v[212:213], v9 offset:36864
v_mfma_f32_16x16x32_bf16 v[36:39], v[148:151], a[52:55], v[36:39]
ds_read_b64_tr_b16 v[214:215], v9 offset:38912
ds_read_b64_tr_b16 v[216:217], v10 offset:36864
v_mfma_f32_16x16x32_bf16 v[36:39], v[164:167], a[56:59], v[36:39]
buffer_load_dwordx4 a[12:15], v1, s[44:47], s69 offen offset:3072 sc1
v_mfma_f32_16x16x32_bf16 v[36:39], v[180:183], a[60:63], v[36:39]
s_add_u32 s69, s69, 0x20000
ds_read_b64_tr_b16 v[218:219], v10 offset:38912
ds_read_b64_tr_b16 v[220:221], v11 offset:36864
v_mfma_f32_16x16x32_bf16 v[20:23], v[180:183], a[44:47], v[20:23]
ds_read_b64_tr_b16 v[222:223], v11 offset:38912
v_mfma_f32_16x16x32_bf16 v[20:23], v[164:167], a[40:43], v[20:23]
buffer_load_dwordx4 a[16:19], v1, s[44:47], s69 offen sc1
v_mfma_f32_16x16x32_bf16 v[20:23], v[148:151], a[36:39], v[20:23]
ds_read_b64_tr_b16 v[224:225], v8 offset:40960
ds_read_b64_tr_b16 v[226:227], v8 offset:43008
v_mfma_f32_16x16x32_bf16 v[20:23], v[132:135], a[32:35], v[20:23]
buffer_load_dwordx4 a[20:23], v1, s[44:47], s69 offen offset:1024 sc1
v_mfma_f32_16x16x32_bf16 v[24:27], v[136:139], a[32:35], v[24:27]
ds_read_b64_tr_b16 v[228:229], v9 offset:40960
ds_read_b64_tr_b16 v[230:231], v9 offset:43008
v_mfma_f32_16x16x32_bf16 v[24:27], v[152:155], a[36:39], v[24:27]
ds_read_b64_tr_b16 v[232:233], v10 offset:40960
ds_read_b64_tr_b16 v[234:235], v10 offset:43008
v_mfma_f32_16x16x32_bf16 v[24:27], v[168:171], a[40:43], v[24:27]
buffer_load_dwordx4 a[24:27], v1, s[44:47], s69 offen offset:2048 sc1
v_mfma_f32_16x16x32_bf16 v[24:27], v[184:187], a[44:47], v[24:27]
ds_read_b64_tr_b16 v[236:237], v11 offset:40960
ds_read_b64_tr_b16 v[238:239], v11 offset:43008
v_mfma_f32_16x16x32_bf16 v[40:43], v[184:187], a[60:63], v[40:43]
ds_read_b64_tr_b16 v[240:241], v8 offset:45056
v_mfma_f32_16x16x32_bf16 v[40:43], v[168:171], a[56:59], v[40:43]
buffer_load_dwordx4 a[28:31], v1, s[44:47], s69 offen offset:3072 sc1
v_mfma_f32_16x16x32_bf16 v[40:43], v[152:155], a[52:55], v[40:43]
s_add_u32 s71, s61, 1
ds_read_b64_tr_b16 v[242:243], v8 offset:47104
ds_read_b64_tr_b16 v[244:245], v9 offset:45056
v_mfma_f32_16x16x32_bf16 v[40:43], v[136:139], a[48:51], v[40:43]
s_and_b32 s71, s71, 3
ds_read_b64_tr_b16 v[246:247], v9 offset:47104
ds_read_b64_tr_b16 v[248:249], v10 offset:45056
v_mfma_f32_16x16x32_bf16 v[44:47], v[140:143], a[48:51], v[44:47]
s_add_u32 s71, s71, s79
s_lshl_b32 s71, s71, 18
s_add_u32 s71, s71, s94
s_add_u32 m0, s77, 16384
s_add_u32 s72, s71, 0
buffer_load_dwordx4 v15, s[24:27], s72 offen lds
v_mfma_f32_16x16x32_bf16 v[44:47], v[156:159], a[52:55], v[44:47]
s_add_u32 s72, s71, 15360
ds_read_b64_tr_b16 v[250:251], v10 offset:47104
ds_read_b64_tr_b16 v[252:253], v11 offset:45056
v_mfma_f32_16x16x32_bf16 v[44:47], v[172:175], a[56:59], v[44:47]
ds_read_b64_tr_b16 v[254:255], v11 offset:47104
v_mfma_f32_16x16x32_bf16 v[44:47], v[188:191], a[60:63], v[44:47]
buffer_load_dwordx4 v15, s[24:27], s72 offen offset:1024 lds
v_mfma_f32_16x16x32_bf16 v[28:31], v[188:191], a[44:47], v[28:31]
s_add_u32 s72, s71, 30720
v_mfma_f32_16x16x32_bf16 v[28:31], v[172:175], a[40:43], v[28:31]
v_mfma_f32_16x16x32_bf16 v[28:31], v[156:159], a[36:39], v[28:31]
s_waitcnt vmcnt(23) lgkmcnt(0)
buffer_load_dwordx4 v15, s[24:27], s72 offen offset:2048 lds
v_mfma_f32_16x16x32_bf16 v[28:31], v[140:143], a[32:35], v[28:31]
s_barrier
v_mfma_f32_16x16x32_bf16 v[16:19], v[192:195], a[64:67], v[16:19]
s_add_u32 s72, s71, 46080
buffer_load_dwordx4 v15, s[24:27], s72 offen offset:3072 lds
v_mfma_f32_16x16x32_bf16 v[16:19], v[208:211], a[68:71], v[16:19]
s_add_u32 s69, s61, 1
ds_read_b64_tr_b16 v[128:129], v8 offset:49152
ds_read_b64_tr_b16 v[130:131], v8 offset:51200
v_mfma_f32_16x16x32_bf16 v[16:19], v[224:227], a[72:75], v[16:19]
s_and_b32 s69, s69, 3
ds_read_b64_tr_b16 v[132:133], v9 offset:49152
ds_read_b64_tr_b16 v[134:135], v9 offset:51200
v_mfma_f32_16x16x32_bf16 v[16:19], v[240:243], a[76:79], v[16:19]
s_add_u32 s69, s69, s79
s_lshl_b32 s69, s69, 12
s_add_u32 s69, s69, s95
buffer_load_dwordx4 a[32:35], v1, s[44:47], s69 offen sc1
v_mfma_f32_16x16x32_bf16 v[32:35], v[240:243], a[92:95], v[32:35]
ds_read_b64_tr_b16 v[136:137], v10 offset:49152
ds_read_b64_tr_b16 v[138:139], v10 offset:51200
v_mfma_f32_16x16x32_bf16 v[32:35], v[224:227], a[88:91], v[32:35]
ds_read_b64_tr_b16 v[140:141], v11 offset:49152
ds_read_b64_tr_b16 v[142:143], v11 offset:51200
v_mfma_f32_16x16x32_bf16 v[32:35], v[208:211], a[84:87], v[32:35]
buffer_load_dwordx4 a[36:39], v1, s[44:47], s69 offen offset:1024 sc1
v_mfma_f32_16x16x32_bf16 v[32:35], v[192:195], a[80:83], v[32:35]
ds_read_b64_tr_b16 v[144:145], v8 offset:53248
ds_read_b64_tr_b16 v[146:147], v8 offset:55296
v_mfma_f32_16x16x32_bf16 v[36:39], v[196:199], a[80:83], v[36:39]
ds_read_b64_tr_b16 v[148:149], v9 offset:53248
ds_read_b64_tr_b16 v[150:151], v9 offset:55296
v_mfma_f32_16x16x32_bf16 v[36:39], v[212:215], a[84:87], v[36:39]
buffer_load_dwordx4 a[40:43], v1, s[44:47], s69 offen offset:2048 sc1
v_mfma_f32_16x16x32_bf16 v[36:39], v[228:231], a[88:91], v[36:39]
ds_read_b64_tr_b16 v[152:153], v10 offset:53248
ds_read_b64_tr_b16 v[154:155], v10 offset:55296
v_mfma_f32_16x16x32_bf16 v[36:39], v[244:247], a[92:95], v[36:39]
ds_read_b64_tr_b16 v[156:157], v11 offset:53248
ds_read_b64_tr_b16 v[158:159], v11 offset:55296
v_mfma_f32_16x16x32_bf16 v[20:23], v[244:247], a[76:79], v[20:23]
buffer_load_dwordx4 a[44:47], v1, s[44:47], s69 offen offset:3072 sc1
v_mfma_f32_16x16x32_bf16 v[20:23], v[228:231], a[72:75], v[20:23]
s_add_u32 s69, s69, 0x20000
ds_read_b64_tr_b16 v[160:161], v8 offset:57344
v_mfma_f32_16x16x32_bf16 v[20:23], v[212:215], a[68:71], v[20:23]
ds_read_b64_tr_b16 v[162:163], v8 offset:59392
ds_read_b64_tr_b16 v[164:165], v9 offset:57344
v_mfma_f32_16x16x32_bf16 v[20:23], v[196:199], a[64:67], v[20:23]
buffer_load_dwordx4 a[48:51], v1, s[44:47], s69 offen sc1
v_mfma_f32_16x16x32_bf16 v[24:27], v[200:203], a[64:67], v[24:27]
ds_read_b64_tr_b16 v[166:167], v9 offset:59392
ds_read_b64_tr_b16 v[168:169], v10 offset:57344
v_mfma_f32_16x16x32_bf16 v[24:27], v[216:219], a[68:71], v[24:27]
buffer_load_dwordx4 a[52:55], v1, s[44:47], s69 offen offset:1024 sc1
v_mfma_f32_16x16x32_bf16 v[24:27], v[232:235], a[72:75], v[24:27]
ds_read_b64_tr_b16 v[170:171], v10 offset:59392
ds_read_b64_tr_b16 v[172:173], v11 offset:57344
v_mfma_f32_16x16x32_bf16 v[24:27], v[248:251], a[76:79], v[24:27]
ds_read_b64_tr_b16 v[174:175], v11 offset:59392
ds_read_b64_tr_b16 v[176:177], v8 offset:61440
v_mfma_f32_16x16x32_bf16 v[40:43], v[248:251], a[92:95], v[40:43]
buffer_load_dwordx4 a[56:59], v1, s[44:47], s69 offen offset:2048 sc1
v_mfma_f32_16x16x32_bf16 v[40:43], v[232:235], a[88:91], v[40:43]
ds_read_b64_tr_b16 v[178:179], v8 offset:63488
ds_read_b64_tr_b16 v[180:181], v9 offset:61440
v_mfma_f32_16x16x32_bf16 v[40:43], v[216:219], a[84:87], v[40:43]
ds_read_b64_tr_b16 v[182:183], v9 offset:63488
ds_read_b64_tr_b16 v[184:185], v10 offset:61440
v_mfma_f32_16x16x32_bf16 v[40:43], v[200:203], a[80:83], v[40:43]
buffer_load_dwordx4 a[60:63], v1, s[44:47], s69 offen offset:3072 sc1
v_mfma_f32_16x16x32_bf16 v[44:47], v[204:207], a[80:83], v[44:47]
s_add_u32 s71, s61, 2
ds_read_b64_tr_b16 v[186:187], v10 offset:63488
ds_read_b64_tr_b16 v[188:189], v11 offset:61440
v_mfma_f32_16x16x32_bf16 v[44:47], v[220:223], a[84:87], v[44:47]
s_and_b32 s71, s71, 3
ds_read_b64_tr_b16 v[190:191], v11 offset:63488
v_mfma_f32_16x16x32_bf16 v[44:47], v[236:239], a[88:91], v[44:47]
s_add_u32 s71, s71, s79
s_lshl_b32 s71, s71, 18
s_add_u32 s71, s71, s94
s_add_u32 m0, s77, 32768
s_add_u32 s72, s71, 0
buffer_load_dwordx4 v15, s[24:27], s72 offen lds
v_mfma_f32_16x16x32_bf16 v[44:47], v[252:255], a[92:95], v[44:47]
s_add_u32 s72, s71, 15360
v_mfma_f32_16x16x32_bf16 v[28:31], v[252:255], a[76:79], v[28:31]
v_mfma_f32_16x16x32_bf16 v[28:31], v[236:239], a[72:75], v[28:31]
buffer_load_dwordx4 v15, s[24:27], s72 offen offset:1024 lds
v_mfma_f32_16x16x32_bf16 v[28:31], v[220:223], a[68:71], v[28:31]
s_waitcnt vmcnt(23) lgkmcnt(0)
v_mfma_f32_16x16x32_bf16 v[28:31], v[204:207], a[64:67], v[28:31]
s_barrier
v_mfma_f32_16x16x32_bf16 v[16:19], v[128:131], a[96:99], v[16:19]
s_add_u32 s72, s71, 30720
buffer_load_dwordx4 v15, s[24:27], s72 offen offset:2048 lds
v_mfma_f32_16x16x32_bf16 v[16:19], v[144:147], a[100:103], v[16:19]
s_add_u32 s72, s71, 46080
ds_read_b64_tr_b16 v[192:193], v8 offset:0
ds_read_b64_tr_b16 v[194:195], v8 offset:2048
v_mfma_f32_16x16x32_bf16 v[16:19], v[160:163], a[104:107], v[16:19]
ds_read_b64_tr_b16 v[196:197], v9 offset:0
ds_read_b64_tr_b16 v[198:199], v9 offset:2048
v_mfma_f32_16x16x32_bf16 v[16:19], v[176:179], a[108:111], v[16:19]
buffer_load_dwordx4 v15, s[24:27], s72 offen offset:3072 lds
v_mfma_f32_16x16x32_bf16 v[32:35], v[176:179], a[124:127], v[32:35]
s_add_u32 s69, s61, 2
ds_read_b64_tr_b16 v[200:201], v10 offset:0
ds_read_b64_tr_b16 v[202:203], v10 offset:2048
v_mfma_f32_16x16x32_bf16 v[32:35], v[160:163], a[120:123], v[32:35]
s_and_b32 s69, s69, 3
s_add_u32 s69, s69, s79
s_lshl_b32 s69, s69, 12
s_add_u32 s69, s69, s95
buffer_load_dwordx4 a[64:67], v1, s[44:47], s69 offen sc1
v_mfma_f32_16x16x32_bf16 v[32:35], v[144:147], a[116:119], v[32:35]
ds_read_b64_tr_b16 v[204:205], v11 offset:0
ds_read_b64_tr_b16 v[206:207], v11 offset:2048
v_mfma_f32_16x16x32_bf16 v[32:35], v[128:131], a[112:115], v[32:35]
ds_read_b64_tr_b16 v[208:209], v8 offset:4096
ds_read_b64_tr_b16 v[210:211], v8 offset:6144
v_mfma_f32_16x16x32_bf16 v[36:39], v[132:135], a[112:115], v[36:39]
buffer_load_dwordx4 a[68:71], v1, s[44:47], s69 offen offset:1024 sc1
v_mfma_f32_16x16x32_bf16 v[36:39], v[148:151], a[116:119], v[36:39]
ds_read_b64_tr_b16 v[212:213], v9 offset:4096
ds_read_b64_tr_b16 v[214:215], v9 offset:6144
v_mfma_f32_16x16x32_bf16 v[36:39], v[164:167], a[120:123], v[36:39]
ds_read_b64_tr_b16 v[216:217], v10 offset:4096
ds_read_b64_tr_b16 v[218:219], v10 offset:6144
v_mfma_f32_16x16x32_bf16 v[36:39], v[180:183], a[124:127], v[36:39]
buffer_load_dwordx4 a[72:75], v1, s[44:47], s69 offen offset:2048 sc1
v_mfma_f32_16x16x32_bf16 v[20:23], v[180:183], a[108:111], v[20:23]
ds_read_b64_tr_b16 v[220:221], v11 offset:4096
ds_read_b64_tr_b16 v[222:223], v11 offset:6144
v_mfma_f32_16x16x32_bf16 v[20:23], v[164:167], a[104:107], v[20:23]
ds_read_b64_tr_b16 v[224:225], v8 offset:8192
v_mfma_f32_16x16x32_bf16 v[20:23], v[148:151], a[100:103], v[20:23]
buffer_load_dwordx4 a[76:79], v1, s[44:47], s69 offen offset:3072 sc1
v_mfma_f32_16x16x32_bf16 v[20:23], v[132:135], a[96:99], v[20:23]
s_add_u32 s69, s69, 0x20000
ds_read_b64_tr_b16 v[226:227], v8 offset:10240
ds_read_b64_tr_b16 v[228:229], v9 offset:8192
v_mfma_f32_16x16x32_bf16 v[24:27], v[136:139], a[96:99], v[24:27]
ds_read_b64_tr_b16 v[230:231], v9 offset:10240
ds_read_b64_tr_b16 v[232:233], v10 offset:8192
v_mfma_f32_16x16x32_bf16 v[24:27], v[152:155], a[100:103], v[24:27]
buffer_load_dwordx4 a[80:83], v1, s[44:47], s69 offen sc1
v_mfma_f32_16x16x32_bf16 v[24:27], v[168:171], a[104:107], v[24:27]
ds_read_b64_tr_b16 v[234:235], v10 offset:10240
ds_read_b64_tr_b16 v[236:237], v11 offset:8192
v_mfma_f32_16x16x32_bf16 v[24:27], v[184:187], a[108:111], v[24:27]
ds_read_b64_tr_b16 v[238:239], v11 offset:10240
ds_read_b64_tr_b16 v[240:241], v8 offset:12288
v_mfma_f32_16x16x32_bf16 v[40:43], v[184:187], a[124:127], v[40:43]
buffer_load_dwordx4 a[84:87], v1, s[44:47], s69 offen offset:1024 sc1
v_mfma_f32_16x16x32_bf16 v[40:43], v[168:171], a[120:123], v[40:43]
ds_read_b64_tr_b16 v[242:243], v8 offset:14336
ds_read_b64_tr_b16 v[244:245], v9 offset:12288
v_mfma_f32_16x16x32_bf16 v[40:43], v[152:155], a[116:119], v[40:43]
buffer_load_dwordx4 a[88:91], v1, s[44:47], s69 offen offset:2048 sc1
v_mfma_f32_16x16x32_bf16 v[40:43], v[136:139], a[112:115], v[40:43]
ds_read_b64_tr_b16 v[246:247], v9 offset:14336
ds_read_b64_tr_b16 v[248:249], v10 offset:12288
v_mfma_f32_16x16x32_bf16 v[44:47], v[140:143], a[112:115], v[44:47]
ds_read_b64_tr_b16 v[250:251], v10 offset:14336
ds_read_b64_tr_b16 v[252:253], v11 offset:12288
v_mfma_f32_16x16x32_bf16 v[44:47], v[156:159], a[116:119], v[44:47]
buffer_load_dwordx4 a[92:95], v1, s[44:47], s69 offen offset:3072 sc1
v_mfma_f32_16x16x32_bf16 v[44:47], v[172:175], a[120:123], v[44:47]
s_add_u32 s71, s61, 3
ds_read_b64_tr_b16 v[254:255], v11 offset:14336
v_mfma_f32_16x16x32_bf16 v[44:47], v[188:191], a[124:127], v[44:47]
s_and_b32 s71, s71, 3
v_mfma_f32_16x16x32_bf16 v[28:31], v[188:191], a[108:111], v[28:31]
s_add_u32 s71, s71, s79
s_lshl_b32 s71, s71, 18
s_add_u32 s71, s71, s94
s_add_u32 m0, s77, 49152
s_add_u32 s72, s71, 0
buffer_load_dwordx4 v15, s[24:27], s72 offen lds
v_mfma_f32_16x16x32_bf16 v[28:31], v[172:175], a[104:107], v[28:31]
s_add_u32 s72, s71, 15360
v_mfma_f32_16x16x32_bf16 v[28:31], v[156:159], a[100:103], v[28:31]
s_waitcnt vmcnt(21) lgkmcnt(0)
v_mfma_f32_16x16x32_bf16 v[28:31], v[140:143], a[96:99], v[28:31]
s_barrier
buffer_load_dwordx4 v15, s[24:27], s72 offen offset:1024 lds
v_mfma_f32_16x16x32_bf16 v[16:19], v[192:195], a[0:3], v[16:19]
s_add_u32 s72, s71, 30720
ds_read_b64_tr_b16 v[128:129], v8 offset:16384
ds_read_b64_tr_b16 v[130:131], v8 offset:18432
v_mfma_f32_16x16x32_bf16 v[16:19], v[208:211], a[4:7], v[16:19]
ds_read_b64_tr_b16 v[132:133], v9 offset:16384
ds_read_b64_tr_b16 v[134:135], v9 offset:18432
v_mfma_f32_16x16x32_bf16 v[16:19], v[224:227], a[8:11], v[16:19]
buffer_load_dwordx4 v15, s[24:27], s72 offen offset:2048 lds
v_mfma_f32_16x16x32_bf16 v[16:19], v[240:243], a[12:15], v[16:19]
s_add_u32 s72, s71, 46080
ds_read_b64_tr_b16 v[136:137], v10 offset:16384
ds_read_b64_tr_b16 v[138:139], v10 offset:18432
v_mfma_f32_16x16x32_bf16 v[32:35], v[240:243], a[28:31], v[32:35]
ds_read_b64_tr_b16 v[140:141], v11 offset:16384
ds_read_b64_tr_b16 v[142:143], v11 offset:18432
v_mfma_f32_16x16x32_bf16 v[32:35], v[224:227], a[24:27], v[32:35]
buffer_load_dwordx4 v15, s[24:27], s72 offen offset:3072 lds
v_mfma_f32_16x16x32_bf16 v[32:35], v[208:211], a[20:23], v[32:35]
s_add_u32 s69, s61, 3
ds_read_b64_tr_b16 v[144:145], v8 offset:20480
v_mfma_f32_16x16x32_bf16 v[32:35], v[192:195], a[16:19], v[32:35]
s_and_b32 s69, s69, 3
s_add_u32 s69, s69, s79
s_lshl_b32 s69, s69, 12
s_add_u32 s69, s69, s95
buffer_load_dwordx4 a[96:99], v1, s[44:47], s69 offen sc1
v_mfma_f32_16x16x32_bf16 v[36:39], v[196:199], a[16:19], v[36:39]
ds_read_b64_tr_b16 v[146:147], v8 offset:22528
ds_read_b64_tr_b16 v[148:149], v9 offset:20480
v_mfma_f32_16x16x32_bf16 v[36:39], v[212:215], a[20:23], v[36:39]
ds_read_b64_tr_b16 v[150:151], v9 offset:22528
ds_read_b64_tr_b16 v[152:153], v10 offset:20480
v_mfma_f32_16x16x32_bf16 v[36:39], v[228:231], a[24:27], v[36:39]
buffer_load_dwordx4 a[100:103], v1, s[44:47], s69 offen offset:1024 sc1
v_mfma_f32_16x16x32_bf16 v[36:39], v[244:247], a[28:31], v[36:39]
ds_read_b64_tr_b16 v[154:155], v10 offset:22528
ds_read_b64_tr_b16 v[156:157], v11 offset:20480
v_mfma_f32_16x16x32_bf16 v[20:23], v[244:247], a[12:15], v[20:23]
ds_read_b64_tr_b16 v[158:159], v11 offset:22528
v_mfma_f32_16x16x32_bf16 v[20:23], v[228:231], a[8:11], v[20:23]
buffer_load_dwordx4 a[104:107], v1, s[44:47], s69 offen offset:2048 sc1
v_mfma_f32_16x16x32_bf16 v[20:23], v[212:215], a[4:7], v[20:23]
ds_read_b64_tr_b16 v[160:161], v8 offset:24576
ds_read_b64_tr_b16 v[162:163], v8 offset:26624
v_mfma_f32_16x16x32_bf16 v[20:23], v[196:199], a[0:3], v[20:23]
ds_read_b64_tr_b16 v[164:165], v9 offset:24576
ds_read_b64_tr_b16 v[166:167], v9 offset:26624
v_mfma_f32_16x16x32_bf16 v[24:27], v[200:203], a[0:3], v[24:27]
buffer_load_dwordx4 a[108:111], v1, s[44:47], s69 offen offset:3072 sc1
v_mfma_f32_16x16x32_bf16 v[24:27], v[216:219], a[4:7], v[24:27]
s_add_u32 s69, s69, 0x20000
ds_read_b64_tr_b16 v[168:169], v10 offset:24576
ds_read_b64_tr_b16 v[170:171], v10 offset:26624
v_mfma_f32_16x16x32_bf16 v[24:27], v[232:235], a[8:11], v[24:27]
ds_read_b64_tr_b16 v[172:173], v11 offset:24576
ds_read_b64_tr_b16 v[174:175], v11 offset:26624
v_mfma_f32_16x16x32_bf16 v[24:27], v[248:251], a[12:15], v[24:27]
buffer_load_dwordx4 a[112:115], v1, s[44:47], s69 offen sc1
v_mfma_f32_16x16x32_bf16 v[40:43], v[248:251], a[28:31], v[40:43]
ds_read_b64_tr_b16 v[176:177], v8 offset:28672
v_mfma_f32_16x16x32_bf16 v[40:43], v[232:235], a[24:27], v[40:43]
ds_read_b64_tr_b16 v[178:179], v8 offset:30720
ds_read_b64_tr_b16 v[180:181], v9 offset:28672
v_mfma_f32_16x16x32_bf16 v[40:43], v[216:219], a[20:23], v[40:43]
buffer_load_dwordx4 a[116:119], v1, s[44:47], s69 offen offset:1024 sc1
v_mfma_f32_16x16x32_bf16 v[40:43], v[200:203], a[16:19], v[40:43]
ds_read_b64_tr_b16 v[182:183], v9 offset:30720
ds_read_b64_tr_b16 v[184:185], v10 offset:28672
v_mfma_f32_16x16x32_bf16 v[44:47], v[204:207], a[16:19], v[44:47]
buffer_load_dwordx4 a[120:123], v1, s[44:47], s69 offen offset:2048 sc1
v_mfma_f32_16x16x32_bf16 v[44:47], v[220:223], a[20:23], v[44:47]
ds_read_b64_tr_b16 v[186:187], v10 offset:30720
ds_read_b64_tr_b16 v[188:189], v11 offset:28672
v_mfma_f32_16x16x32_bf16 v[44:47], v[236:239], a[24:27], v[44:47]
ds_read_b64_tr_b16 v[190:191], v11 offset:30720
v_mfma_f32_16x16x32_bf16 v[44:47], v[252:255], a[28:31], v[44:47]
buffer_load_dwordx4 a[124:127], v1, s[44:47], s69 offen offset:3072 sc1
v_mfma_f32_16x16x32_bf16 v[28:31], v[252:255], a[12:15], v[28:31]
s_add_u32 s78, s59, 20
v_mfma_f32_16x16x32_bf16 v[28:31], v[236:239], a[8:11], v[28:31]
s_and_b32 s78, s78, 28
v_mfma_f32_16x16x32_bf16 v[28:31], v[220:223], a[4:7], v[28:31]
s_waitcnt vmcnt(20) lgkmcnt(0)
s_add_u32 s71, s61, 0
s_and_b32 s71, s71, 3
s_add_u32 s71, s71, s78
s_lshl_b32 s71, s71, 18
s_add_u32 s71, s71, s94
s_add_u32 m0, s77, 0
s_add_u32 s72, s71, 0
buffer_load_dwordx4 v15, s[24:27], s72 offen lds
v_mfma_f32_16x16x32_bf16 v[28:31], v[204:207], a[0:3], v[28:31]
s_barrier
v_mfma_f32_16x16x32_bf16 v[16:19], v[128:131], a[32:35], v[16:19]
s_add_u32 s72, s71, 15360
ds_read_b64_tr_b16 v[192:193], v8 offset:32768
ds_read_b64_tr_b16 v[194:195], v8 offset:34816
v_mfma_f32_16x16x32_bf16 v[16:19], v[144:147], a[36:39], v[16:19]
buffer_load_dwordx4 v15, s[24:27], s72 offen offset:1024 lds
v_mfma_f32_16x16x32_bf16 v[16:19], v[160:163], a[40:43], v[16:19]
s_add_u32 s72, s71, 30720
ds_read_b64_tr_b16 v[196:197], v9 offset:32768
ds_read_b64_tr_b16 v[198:199], v9 offset:34816
v_mfma_f32_16x16x32_bf16 v[16:19], v[176:179], a[44:47], v[16:19]
ds_read_b64_tr_b16 v[200:201], v10 offset:32768
ds_read_b64_tr_b16 v[202:203], v10 offset:34816
v_mfma_f32_16x16x32_bf16 v[32:35], v[176:179], a[60:63], v[32:35]
buffer_load_dwordx4 v15, s[24:27], s72 offen offset:2048 lds
v_mfma_f32_16x16x32_bf16 v[32:35], v[160:163], a[56:59], v[32:35]
s_add_u32 s72, s71, 46080
ds_read_b64_tr_b16 v[204:205], v11 offset:32768
ds_read_b64_tr_b16 v[206:207], v11 offset:34816
v_mfma_f32_16x16x32_bf16 v[32:35], v[144:147], a[52:55], v[32:35]
ds_read_b64_tr_b16 v[208:209], v8 offset:36864
v_mfma_f32_16x16x32_bf16 v[32:35], v[128:131], a[48:51], v[32:35]
buffer_load_dwordx4 v15, s[24:27], s72 offen offset:3072 lds
v_mfma_f32_16x16x32_bf16 v[36:39], v[132:135], a[48:51], v[36:39]
ds_read_b64_tr_b16 v[210:211], v8 offset:38912
ds_read_b64_tr_b16 v[212:213], v9 offset:36864
v_mfma_f32_16x16x32_bf16 v[36:39], v[148:151], a[52:55], v[36:39]
ds_read_b64_tr_b16 v[214:215], v9 offset:38912
ds_read_b64_tr_b16 v[216:217], v10 offset:36864
v_mfma_f32_16x16x32_bf16 v[36:39], v[164:167], a[56:59], v[36:39]
s_waitcnt vmcnt(48)
v_cmp_gt_u32 vcc, 2, v3
s_cbranch_vccnz Lspin115
Lback116:
s_add_u32 s82, s59, 24
s_and_b32 s82, s82, 28
s_lshl_b32 s82, s82, 10
s_add_u32 s82, s82, s74
buffer_load_dword v3, v2, s[44:47], s82 offen sc1
s_add_u32 s69, s61, 0
s_and_b32 s69, s69, 3
s_add_u32 s69, s69, s78
s_lshl_b32 s69, s69, 12
s_add_u32 s69, s69, s95
buffer_load_dwordx4 a[0:3], v1, s[44:47], s69 offen sc1
v_mfma_f32_16x16x32_bf16 v[36:39], v[180:183], a[60:63], v[36:39]
ds_read_b64_tr_b16 v[218:219], v10 offset:38912
ds_read_b64_tr_b16 v[220:221], v11 offset:36864
v_mfma_f32_16x16x32_bf16 v[20:23], v[180:183], a[44:47], v[20:23]
buffer_load_dwordx4 a[4:7], v1, s[44:47], s69 offen offset:1024 sc1
v_mfma_f32_16x16x32_bf16 v[20:23], v[164:167], a[40:43], v[20:23]
ds_read_b64_tr_b16 v[222:223], v11 offset:38912
v_mfma_f32_16x16x32_bf16 v[20:23], v[148:151], a[36:39], v[20:23]
ds_read_b64_tr_b16 v[224:225], v8 offset:40960
ds_read_b64_tr_b16 v[226:227], v8 offset:43008
v_mfma_f32_16x16x32_bf16 v[20:23], v[132:135], a[32:35], v[20:23]
buffer_load_dwordx4 a[8:11], v1, s[44:47], s69 offen offset:2048 sc1
v_mfma_f32_16x16x32_bf16 v[24:27], v[136:139], a[32:35], v[24:27]
ds_read_b64_tr_b16 v[228:229], v9 offset:40960
ds_read_b64_tr_b16 v[230:231], v9 offset:43008
v_mfma_f32_16x16x32_bf16 v[24:27], v[152:155], a[36:39], v[24:27]
ds_read_b64_tr_b16 v[232:233], v10 offset:40960
ds_read_b64_tr_b16 v[234:235], v10 offset:43008
v_mfma_f32_16x16x32_bf16 v[24:27], v[168:171], a[40:43], v[24:27]
buffer_load_dwordx4 a[12:15], v1, s[44:47], s69 offen offset:3072 sc1
v_mfma_f32_16x16x32_bf16 v[24:27], v[184:187], a[44:47], v[24:27]
s_add_u32 s69, s69, 0x20000
ds_read_b64_tr_b16 v[236:237], v11 offset:40960
ds_read_b64_tr_b16 v[238:239], v11 offset:43008
v_mfma_f32_16x16x32_bf16 v[40:43], v[184:187], a[60:63], v[40:43]
ds_read_b64_tr_b16 v[240:241], v8 offset:45056
v_mfma_f32_16x16x32_bf16 v[40:43], v[168:171], a[56:59], v[40:43]
buffer_load_dwordx4 a[16:19], v1, s[44:47], s69 offen sc1
v_mfma_f32_16x16x32_bf16 v[40:43], v[152:155], a[52:55], v[40:43]
ds_read_b64_tr_b16 v[242:243], v8 offset:47104
ds_read_b64_tr_b16 v[244:245], v9 offset:45056
v_mfma_f32_16x16x32_bf16 v[40:43], v[136:139], a[48:51], v[40:43]
ds_read_b64_tr_b16 v[246:247], v9 offset:47104
ds_read_b64_tr_b16 v[248:249], v10 offset:45056
v_mfma_f32_16x16x32_bf16 v[44:47], v[140:143], a[48:51], v[44:47]
buffer_load_dwordx4 a[20:23], v1, s[44:47], s69 offen offset:1024 sc1
v_mfma_f32_16x16x32_bf16 v[44:47], v[156:159], a[52:55], v[44:47]
ds_read_b64_tr_b16 v[250:251], v10 offset:47104
ds_read_b64_tr_b16 v[252:253], v11 offset:45056
v_mfma_f32_16x16x32_bf16 v[44:47], v[172:175], a[56:59], v[44:47]
ds_read_b64_tr_b16 v[254:255], v11 offset:47104
v_mfma_f32_16x16x32_bf16 v[44:47], v[188:191], a[60:63], v[44:47]
buffer_load_dwordx4 a[24:27], v1, s[44:47], s69 offen offset:2048 sc1
v_mfma_f32_16x16x32_bf16 v[28:31], v[188:191], a[44:47], v[28:31]
v_mfma_f32_16x16x32_bf16 v[28:31], v[172:175], a[40:43], v[28:31]
buffer_load_dwordx4 a[28:31], v1, s[44:47], s69 offen offset:3072 sc1
v_mfma_f32_16x16x32_bf16 v[28:31], v[156:159], a[36:39], v[28:31]
s_waitcnt vmcnt(21) lgkmcnt(0)
v_mfma_f32_16x16x32_bf16 v[28:31], v[140:143], a[32:35], v[28:31]
s_barrier
v_mfma_f32_16x16x32_bf16 v[16:19], v[192:195], a[64:67], v[16:19]
s_add_u32 s71, s61, 1
s_and_b32 s71, s71, 3
s_add_u32 s71, s71, s78
s_lshl_b32 s71, s71, 18
s_add_u32 s71, s71, s94
s_add_u32 m0, s77, 16384
s_add_u32 s72, s71, 0
buffer_load_dwordx4 v15, s[24:27], s72 offen lds
v_mfma_f32_16x16x32_bf16 v[16:19], v[208:211], a[68:71], v[16:19]
s_add_u32 s72, s71, 15360
ds_read_b64_tr_b16 v[128:129], v8 offset:49152
ds_read_b64_tr_b16 v[130:131], v8 offset:51200
v_mfma_f32_16x16x32_bf16 v[16:19], v[224:227], a[72:75], v[16:19]
ds_read_b64_tr_b16 v[132:133], v9 offset:49152
ds_read_b64_tr_b16 v[134:135], v9 offset:51200
v_mfma_f32_16x16x32_bf16 v[16:19], v[240:243], a[76:79], v[16:19]
buffer_load_dwordx4 v15, s[24:27], s72 offen offset:1024 lds
v_mfma_f32_16x16x32_bf16 v[32:35], v[240:243], a[92:95], v[32:35]
s_add_u32 s72, s71, 30720
ds_read_b64_tr_b16 v[136:137], v10 offset:49152
ds_read_b64_tr_b16 v[138:139], v10 offset:51200
v_mfma_f32_16x16x32_bf16 v[32:35], v[224:227], a[88:91], v[32:35]
ds_read_b64_tr_b16 v[140:141], v11 offset:49152
ds_read_b64_tr_b16 v[142:143], v11 offset:51200
v_mfma_f32_16x16x32_bf16 v[32:35], v[208:211], a[84:87], v[32:35]
buffer_load_dwordx4 v15, s[24:27], s72 offen offset:2048 lds
v_mfma_f32_16x16x32_bf16 v[32:35], v[192:195], a[80:83], v[32:35]
s_add_u32 s72, s71, 46080
ds_read_b64_tr_b16 v[144:145], v8 offset:53248
ds_read_b64_tr_b16 v[146:147], v8 offset:55296
v_mfma_f32_16x16x32_bf16 v[36:39], v[196:199], a[80:83], v[36:39]
ds_read_b64_tr_b16 v[148:149], v9 offset:53248
ds_read_b64_tr_b16 v[150:151], v9 offset:55296
v_mfma_f32_16x16x32_bf16 v[36:39], v[212:215], a[84:87], v[36:39]
buffer_load_dwordx4 v15, s[24:27], s72 offen offset:3072 lds
v_mfma_f32_16x16x32_bf16 v[36:39], v[228:231], a[88:91], v[36:39]
s_add_u32 s69, s61, 1
ds_read_b64_tr_b16 v[152:153], v10 offset:53248
ds_read_b64_tr_b16 v[154:155], v10 offset:55296
v_mfma_f32_16x16x32_bf16 v[36:39], v[244:247], a[92:95], v[36:39]
s_and_b32 s69, s69, 3
ds_read_b64_tr_b16 v[156:157], v11 offset:53248
ds_read_b64_tr_b16 v[158:159], v11 offset:55296
v_mfma_f32_16x16x32_bf16 v[20:23], v[244:247], a[76:79], v[20:23]
s_add_u32 s69, s69, s78
s_lshl_b32 s69, s69, 12
s_add_u32 s69, s69, s95
buffer_load_dwordx4 a[32:35], v1, s[44:47], s69 offen sc1
v_mfma_f32_16x16x32_bf16 v[20:23], v[228:231], a[72:75], v[20:23]
ds_read_b64_tr_b16 v[160:161], v8 offset:57344
v_mfma_f32_16x16x32_bf16 v[20:23], v[212:215], a[68:71], v[20:23]
buffer_load_dwordx4 a[36:39], v1, s[44:47], s69 offen offset:1024 sc1
v_mfma_f32_16x16x32_bf16 v[20:23], v[196:199], a[64:67], v[20:23]
ds_read_b64_tr_b16 v[162:163], v8 offset:59392
ds_read_b64_tr_b16 v[164:165], v9 offset:57344
v_mfma_f32_16x16x32_bf16 v[24:27], v[200:203], a[64:67], v[24:27]
ds_read_b64_tr_b16 v[166:167], v9 offset:59392
ds_read_b64_tr_b16 v[168:169], v10 offset:57344
v_mfma_f32_16x16x32_bf16 v[24:27], v[216:219], a[68:71], v[24:27]
buffer_load_dwordx4 a[40:43], v1, s[44:47], s69 offen offset:2048 sc1
v_mfma_f32_16x16x32_bf16 v[24:27], v[232:235], a[72:75], v[24:27]
ds_read_b64_tr_b16 v[170:171], v10 offset:59392
ds_read_b64_tr_b16 v[172:173], v11 offset:57344
v_mfma_f32_16x16x32_bf16 v[24:27], v[248:251], a[76:79], v[24:27]
ds_read_b64_tr_b16 v[174:175], v11 offset:59392
ds_read_b64_tr_b16 v[176:177], v8 offset:61440
v_mfma_f32_16x16x32_bf16 v[40:43], v[248:251], a[92:95], v[40:43]
buffer_load_dwordx4 a[44:47], v1, s[44:47], s69 offen offset:3072 sc1
v_mfma_f32_16x16x32_bf16 v[40:43], v[232:235], a[88:91], v[40:43]
s_add_u32 s69, s69, 0x20000
ds_read_b64_tr_b16 v[178:179], v8 offset:63488
ds_read_b64_tr_b16 v[180:181], v9 offset:61440
v_mfma_f32_16x16x32_bf16 v[40:43], v[216:219], a[84:87], v[40:43]
ds_read_b64_tr_b16 v[182:183], v9 offset:63488
ds_read_b64_tr_b16 v[184:185], v10 offset:61440
v_mfma_f32_16x16x32_bf16 v[40:43], v[200:203], a[80:83], v[40:43]
buffer_load_dwordx4 a[48:51], v1, s[44:47], s69 offen sc1
v_mfma_f32_16x16x32_bf16 v[44:47], v[204:207], a[80:83], v[44:47]
ds_read_b64_tr_b16 v[186:187], v10 offset:63488
ds_read_b64_tr_b16 v[188:189], v11 offset:61440
v_mfma_f32_16x16x32_bf16 v[44:47], v[220:223], a[84:87], v[44:47]
ds_read_b64_tr_b16 v[190:191], v11 offset:63488
v_mfma_f32_16x16x32_bf16 v[44:47], v[236:239], a[88:91], v[44:47]
buffer_load_dwordx4 a[52:55], v1, s[44:47], s69 offen offset:1024 sc1
v_mfma_f32_16x16x32_bf16 v[44:47], v[252:255], a[92:95], v[44:47]
v_mfma_f32_16x16x32_bf16 v[28:31], v[252:255], a[76:79], v[28:31]
v_mfma_f32_16x16x32_bf16 v[28:31], v[236:239], a[72:75], v[28:31]
buffer_load_dwordx4 a[56:59], v1, s[44:47], s69 offen offset:2048 sc1
v_mfma_f32_16x16x32_bf16 v[28:31], v[220:223], a[68:71], v[28:31]
s_waitcnt vmcnt(20) lgkmcnt(0)
v_mfma_f32_16x16x32_bf16 v[28:31], v[204:207], a[64:67], v[28:31]
s_barrier
v_mfma_f32_16x16x32_bf16 v[16:19], v[128:131], a[96:99], v[16:19]
buffer_load_dwordx4 a[60:63], v1, s[44:47], s69 offen offset:3072 sc1
v_mfma_f32_16x16x32_bf16 v[16:19], v[144:147], a[100:103], v[16:19]
s_add_u32 s71, s61, 2
ds_read_b64_tr_b16 v[192:193], v8 offset:0
ds_read_b64_tr_b16 v[194:195], v8 offset:2048
v_mfma_f32_16x16x32_bf16 v[16:19], v[160:163], a[104:107], v[16:19]
s_and_b32 s71, s71, 3
s_add_u32 s71, s71, s78
s_lshl_b32 s71, s71, 18
s_add_u32 s71, s71, s94
s_add_u32 m0, s77, 32768
s_add_u32 s72, s71, 0
buffer_load_dwordx4 v15, s[24:27], s72 offen lds
v_mfma_f32_16x16x32_bf16 v[16:19], v[176:179], a[108:111], v[16:19]
s_add_u32 s72, s71, 15360
ds_read_b64_tr_b16 v[196:197], v9 offset:0
ds_read_b64_tr_b16 v[198:199], v9 offset:2048
v_mfma_f32_16x16x32_bf16 v[32:35], v[176:179], a[124:127], v[32:35]
ds_read_b64_tr_b16 v[200:201], v10 offset:0
ds_read_b64_tr_b16 v[202:203], v10 offset:2048
v_mfma_f32_16x16x32_bf16 v[32:35], v[160:163], a[120:123], v[32:35]
buffer_load_dwordx4 v15, s[24:27], s72 offen offset:1024 lds
v_mfma_f32_16x16x32_bf16 v[32:35], v[144:147], a[116:119], v[32:35]
s_add_u32 s72, s71, 30720
ds_read_b64_tr_b16 v[204:205], v11 offset:0
ds_read_b64_tr_b16 v[206:207], v11 offset:2048
v_mfma_f32_16x16x32_bf16 v[32:35], v[128:131], a[112:115], v[32:35]
ds_read_b64_tr_b16 v[208:209], v8 offset:4096
ds_read_b64_tr_b16 v[210:211], v8 offset:6144
v_mfma_f32_16x16x32_bf16 v[36:39], v[132:135], a[112:115], v[36:39]
buffer_load_dwordx4 v15, s[24:27], s72 offen offset:2048 lds
v_mfma_f32_16x16x32_bf16 v[36:39], v[148:151], a[116:119], v[36:39]
s_add_u32 s72, s71, 46080
ds_read_b64_tr_b16 v[212:213], v9 offset:4096
ds_read_b64_tr_b16 v[214:215], v9 offset:6144
v_mfma_f32_16x16x32_bf16 v[36:39], v[164:167], a[120:123], v[36:39]
ds_read_b64_tr_b16 v[216:217], v10 offset:4096
ds_read_b64_tr_b16 v[218:219], v10 offset:6144
v_mfma_f32_16x16x32_bf16 v[36:39], v[180:183], a[124:127], v[36:39]
buffer_load_dwordx4 v15, s[24:27], s72 offen offset:3072 lds
v_mfma_f32_16x16x32_bf16 v[20:23], v[180:183], a[108:111], v[20:23]
s_add_u32 s69, s61, 2
ds_read_b64_tr_b16 v[220:221], v11 offset:4096
ds_read_b64_tr_b16 v[222:223], v11 offset:6144
v_mfma_f32_16x16x32_bf16 v[20:23], v[164:167], a[104:107], v[20:23]
s_and_b32 s69, s69, 3
ds_read_b64_tr_b16 v[224:225], v8 offset:8192
v_mfma_f32_16x16x32_bf16 v[20:23], v[148:151], a[100:103], v[20:23]
s_add_u32 s69, s69, s78
s_lshl_b32 s69, s69, 12
s_add_u32 s69, s69, s95
buffer_load_dwordx4 a[64:67], v1, s[44:47], s69 offen sc1
v_mfma_f32_16x16x32_bf16 v[20:23], v[132:135], a[96:99], v[20:23]
ds_read_b64_tr_b16 v[226:227], v8 offset:10240
ds_read_b64_tr_b16 v[228:229], v9 offset:8192
v_mfma_f32_16x16x32_bf16 v[24:27], v[136:139], a[96:99], v[24:27]
ds_read_b64_tr_b16 v[230:231], v9 offset:10240
ds_read_b64_tr_b16 v[232:233], v10 offset:8192
v_mfma_f32_16x16x32_bf16 v[24:27], v[152:155], a[100:103], v[24:27]
buffer_load_dwordx4 a[68:71], v1, s[44:47], s69 offen offset:1024 sc1
v_mfma_f32_16x16x32_bf16 v[24:27], v[168:171], a[104:107], v[24:27]
ds_read_b64_tr_b16 v[234:235], v10 offset:10240
ds_read_b64_tr_b16 v[236:237], v11 offset:8192
v_mfma_f32_16x16x32_bf16 v[24:27], v[184:187], a[108:111], v[24:27]
buffer_load_dwordx4 a[72:75], v1, s[44:47], s69 offen offset:2048 sc1
v_mfma_f32_16x16x32_bf16 v[40:43], v[184:187], a[124:127], v[40:43]
ds_read_b64_tr_b16 v[238:239], v11 offset:10240
ds_read_b64_tr_b16 v[240:241], v8 offset:12288
v_mfma_f32_16x16x32_bf16 v[40:43], v[168:171], a[120:123], v[40:43]
ds_read_b64_tr_b16 v[242:243], v8 offset:14336
ds_read_b64_tr_b16 v[244:245], v9 offset:12288
v_mfma_f32_16x16x32_bf16 v[40:43], v[152:155], a[116:119], v[40:43]
buffer_load_dwordx4 a[76:79], v1, s[44:47], s69 offen offset:3072 sc1
v_mfma_f32_16x16x32_bf16 v[40:43], v[136:139], a[112:115], v[40:43]
s_add_u32 s69, s69, 0x20000
ds_read_b64_tr_b16 v[246:247], v9 offset:14336
ds_read_b64_tr_b16 v[248:249], v10 offset:12288
v_mfma_f32_16x16x32_bf16 v[44:47], v[140:143], a[112:115], v[44:47]
ds_read_b64_tr_b16 v[250:251], v10 offset:14336
ds_read_b64_tr_b16 v[252:253], v11 offset:12288
v_mfma_f32_16x16x32_bf16 v[44:47], v[156:159], a[116:119], v[44:47]
buffer_load_dwordx4 a[80:83], v1, s[44:47], s69 offen sc1
v_mfma_f32_16x16x32_bf16 v[44:47], v[172:175], a[120:123], v[44:47]
ds_read_b64_tr_b16 v[254:255], v11 offset:14336
v_mfma_f32_16x16x32_bf16 v[44:47], v[188:191], a[124:127], v[44:47]
v_mfma_f32_16x16x32_bf16 v[28:31], v[188:191], a[108:111], v[28:31]
buffer_load_dwordx4 a[84:87], v1, s[44:47], s69 offen offset:1024 sc1
v_mfma_f32_16x16x32_bf16 v[28:31], v[172:175], a[104:107], v[28:31]
v_mfma_f32_16x16x32_bf16 v[28:31], v[156:159], a[100:103], v[28:31]
s_waitcnt vmcnt(18) lgkmcnt(0)
v_mfma_f32_16x16x32_bf16 v[28:31], v[140:143], a[96:99], v[28:31]
s_barrier
buffer_load_dwordx4 a[88:91], v1, s[44:47], s69 offen offset:2048 sc1
v_mfma_f32_16x16x32_bf16 v[16:19], v[192:195], a[0:3], v[16:19]
ds_read_b64_tr_b16 v[128:129], v8 offset:16384
ds_read_b64_tr_b16 v[130:131], v8 offset:18432
v_mfma_f32_16x16x32_bf16 v[16:19], v[208:211], a[4:7], v[16:19]
ds_read_b64_tr_b16 v[132:133], v9 offset:16384
ds_read_b64_tr_b16 v[134:135], v9 offset:18432
v_mfma_f32_16x16x32_bf16 v[16:19], v[224:227], a[8:11], v[16:19]
buffer_load_dwordx4 a[92:95], v1, s[44:47], s69 offen offset:3072 sc1
v_mfma_f32_16x16x32_bf16 v[16:19], v[240:243], a[12:15], v[16:19]
s_add_u32 s71, s61, 3
ds_read_b64_tr_b16 v[136:137], v10 offset:16384
ds_read_b64_tr_b16 v[138:139], v10 offset:18432
v_mfma_f32_16x16x32_bf16 v[32:35], v[240:243], a[28:31], v[32:35]
s_and_b32 s71, s71, 3
s_add_u32 s71, s71, s78
s_lshl_b32 s71, s71, 18
s_add_u32 s71, s71, s94
s_add_u32 m0, s77, 49152
s_add_u32 s72, s71, 0
buffer_load_dwordx4 v15, s[24:27], s72 offen lds
v_mfma_f32_16x16x32_bf16 v[32:35], v[224:227], a[24:27], v[32:35]
s_add_u32 s72, s71, 15360
ds_read_b64_tr_b16 v[140:141], v11 offset:16384
ds_read_b64_tr_b16 v[142:143], v11 offset:18432
v_mfma_f32_16x16x32_bf16 v[32:35], v[208:211], a[20:23], v[32:35]
ds_read_b64_tr_b16 v[144:145], v8 offset:20480
v_mfma_f32_16x16x32_bf16 v[32:35], v[192:195], a[16:19], v[32:35]
buffer_load_dwordx4 v15, s[24:27], s72 offen offset:1024 lds
v_mfma_f32_16x16x32_bf16 v[36:39], v[196:199], a[16:19], v[36:39]
s_add_u32 s72, s71, 30720
ds_read_b64_tr_b16 v[146:147], v8 offset:22528
ds_read_b64_tr_b16 v[148:149], v9 offset:20480
v_mfma_f32_16x16x32_bf16 v[36:39], v[212:215], a[20:23], v[36:39]
ds_read_b64_tr_b16 v[150:151], v9 offset:22528
ds_read_b64_tr_b16 v[152:153], v10 offset:20480
v_mfma_f32_16x16x32_bf16 v[36:39], v[228:231], a[24:27], v[36:39]
buffer_load_dwordx4 v15, s[24:27], s72 offen offset:2048 lds
v_mfma_f32_16x16x32_bf16 v[36:39], v[244:247], a[28:31], v[36:39]
s_add_u32 s72, s71, 46080
ds_read_b64_tr_b16 v[154:155], v10 offset:22528
ds_read_b64_tr_b16 v[156:157], v11 offset:20480
v_mfma_f32_16x16x32_bf16 v[20:23], v[244:247], a[12:15], v[20:23]
ds_read_b64_tr_b16 v[158:159], v11 offset:22528
v_mfma_f32_16x16x32_bf16 v[20:23], v[228:231], a[8:11], v[20:23]
buffer_load_dwordx4 v15, s[24:27], s72 offen offset:3072 lds
v_mfma_f32_16x16x32_bf16 v[20:23], v[212:215], a[4:7], v[20:23]
s_add_u32 s69, s61, 3
ds_read_b64_tr_b16 v[160:161], v8 offset:24576
ds_read_b64_tr_b16 v[162:163], v8 offset:26624
v_mfma_f32_16x16x32_bf16 v[20:23], v[196:199], a[0:3], v[20:23]
s_and_b32 s69, s69, 3
ds_read_b64_tr_b16 v[164:165], v9 offset:24576
ds_read_b64_tr_b16 v[166:167], v9 offset:26624
v_mfma_f32_16x16x32_bf16 v[24:27], v[200:203], a[0:3], v[24:27]
s_add_u32 s69, s69, s78
s_lshl_b32 s69, s69, 12
s_add_u32 s69, s69, s95
buffer_load_dwordx4 a[96:99], v1, s[44:47], s69 offen sc1
v_mfma_f32_16x16x32_bf16 v[24:27], v[216:219], a[4:7], v[24:27]
ds_read_b64_tr_b16 v[168:169], v10 offset:24576
ds_read_b64_tr_b16 v[170:171], v10 offset:26624
v_mfma_f32_16x16x32_bf16 v[24:27], v[232:235], a[8:11], v[24:27]
ds_read_b64_tr_b16 v[172:173], v11 offset:24576
ds_read_b64_tr_b16 v[174:175], v11 offset:26624
v_mfma_f32_16x16x32_bf16 v[24:27], v[248:251], a[12:15], v[24:27]
buffer_load_dwordx4 a[100:103], v1, s[44:47], s69 offen offset:1024 sc1
v_mfma_f32_16x16x32_bf16 v[40:43], v[248:251], a[28:31], v[40:43]
ds_read_b64_tr_b16 v[176:177], v8 offset:28672
v_mfma_f32_16x16x32_bf16 v[40:43], v[232:235], a[24:27], v[40:43]
buffer_load_dwordx4 a[104:107], v1, s[44:47], s69 offen offset:2048 sc1
v_mfma_f32_16x16x32_bf16 v[40:43], v[216:219], a[20:23], v[40:43]
ds_read_b64_tr_b16 v[178:179], v8 offset:30720
ds_read_b64_tr_b16 v[180:181], v9 offset:28672
v_mfma_f32_16x16x32_bf16 v[40:43], v[200:203], a[16:19], v[40:43]
ds_read_b64_tr_b16 v[182:183], v9 offset:30720
ds_read_b64_tr_b16 v[184:185], v10 offset:28672
v_mfma_f32_16x16x32_bf16 v[44:47], v[204:207], a[16:19], v[44:47]
buffer_load_dwordx4 a[108:111], v1, s[44:47], s69 offen offset:3072 sc1
v_mfma_f32_16x16x32_bf16 v[44:47], v[220:223], a[20:23], v[44:47]
s_add_u32 s69, s69, 0x20000
ds_read_b64_tr_b16 v[186:187], v10 offset:30720
ds_read_b64_tr_b16 v[188:189], v11 offset:28672
v_mfma_f32_16x16x32_bf16 v[44:47], v[236:239], a[24:27], v[44:47]
ds_read_b64_tr_b16 v[190:191], v11 offset:30720
v_mfma_f32_16x16x32_bf16 v[44:47], v[252:255], a[28:31], v[44:47]
buffer_load_dwordx4 a[112:115], v1, s[44:47], s69 offen sc1
v_mfma_f32_16x16x32_bf16 v[28:31], v[252:255], a[12:15], v[28:31]
v_mfma_f32_16x16x32_bf16 v[28:31], v[236:239], a[8:11], v[28:31]
s_lshl_b32 s84, s76, 11
s_add_u32 s84, s84, 0x3810000
v_lshrrev_b32 v115, 2, v0
v_lshlrev_b32 v115, 7, v115
buffer_load_dword v114, v115, s[44:47], s84 offen sc1
v_mfma_f32_16x16x32_bf16 v[28:31], v[220:223], a[4:7], v[28:31]
s_waitcnt vmcnt(18) lgkmcnt(0)
buffer_load_dwordx4 a[116:119], v1, s[44:47], s69 offen offset:1024 sc1
v_mfma_f32_16x16x32_bf16 v[28:31], v[204:207], a[0:3], v[28:31]
s_barrier
v_mfma_f32_16x16x32_bf16 v[16:19], v[128:131], a[32:35], v[16:19]
ds_read_b64_tr_b16 v[192:193], v8 offset:32768
ds_read_b64_tr_b16 v[194:195], v8 offset:34816
v_mfma_f32_16x16x32_bf16 v[16:19], v[144:147], a[36:39], v[16:19]
buffer_load_dwordx4 a[120:123], v1, s[44:47], s69 offen offset:2048 sc1
v_mfma_f32_16x16x32_bf16 v[16:19], v[160:163], a[40:43], v[16:19]
ds_read_b64_tr_b16 v[196:197], v9 offset:32768
ds_read_b64_tr_b16 v[198:199], v9 offset:34816
v_mfma_f32_16x16x32_bf16 v[16:19], v[176:179], a[44:47], v[16:19]
ds_read_b64_tr_b16 v[200:201], v10 offset:32768
ds_read_b64_tr_b16 v[202:203], v10 offset:34816
v_mfma_f32_16x16x32_bf16 v[32:35], v[176:179], a[60:63], v[32:35]
buffer_load_dwordx4 a[124:127], v1, s[44:47], s69 offen offset:3072 sc1
v_mfma_f32_16x16x32_bf16 v[32:35], v[160:163], a[56:59], v[32:35]
s_add_u32 s79, s59, 24
ds_read_b64_tr_b16 v[204:205], v11 offset:32768
ds_read_b64_tr_b16 v[206:207], v11 offset:34816
v_mfma_f32_16x16x32_bf16 v[32:35], v[144:147], a[52:55], v[32:35]
s_and_b32 s79, s79, 28
ds_read_b64_tr_b16 v[208:209], v8 offset:36864
ds_read_b64_tr_b16 v[210:211], v8 offset:38912
v_mfma_f32_16x16x32_bf16 v[32:35], v[128:131], a[48:51], v[32:35]
s_add_u32 s71, s61, 0
s_and_b32 s71, s71, 3
s_add_u32 s71, s71, s79
s_lshl_b32 s71, s71, 18
s_add_u32 s71, s71, s94
s_add_u32 m0, s77, 0
s_add_u32 s72, s71, 0
buffer_load_dwordx4 v15, s[24:27], s72 offen lds
v_mfma_f32_16x16x32_bf16 v[36:39], v[132:135], a[48:51], v[36:39]
s_add_u32 s72, s71, 15360
ds_read_b64_tr_b16 v[212:213], v9 offset:36864
ds_read_b64_tr_b16 v[214:215], v9 offset:38912
v_mfma_f32_16x16x32_bf16 v[36:39], v[148:151], a[52:55], v[36:39]
buffer_load_dwordx4 v15, s[24:27], s72 offen offset:1024 lds
v_mfma_f32_16x16x32_bf16 v[36:39], v[164:167], a[56:59], v[36:39]
s_add_u32 s72, s71, 30720
ds_read_b64_tr_b16 v[216:217], v10 offset:36864
ds_read_b64_tr_b16 v[218:219], v10 offset:38912
v_mfma_f32_16x16x32_bf16 v[36:39], v[180:183], a[60:63], v[36:39]
ds_read_b64_tr_b16 v[220:221], v11 offset:36864
ds_read_b64_tr_b16 v[222:223], v11 offset:38912
v_mfma_f32_16x16x32_bf16 v[20:23], v[180:183], a[44:47], v[20:23]
buffer_load_dwordx4 v15, s[24:27], s72 offen offset:2048 lds
v_mfma_f32_16x16x32_bf16 v[20:23], v[164:167], a[40:43], v[20:23]
s_add_u32 s72, s71, 46080
ds_read_b64_tr_b16 v[224:225], v8 offset:40960
v_mfma_f32_16x16x32_bf16 v[20:23], v[148:151], a[36:39], v[20:23]
ds_read_b64_tr_b16 v[226:227], v8 offset:43008
ds_read_b64_tr_b16 v[228:229], v9 offset:40960
v_mfma_f32_16x16x32_bf16 v[20:23], v[132:135], a[32:35], v[20:23]
buffer_load_dwordx4 v15, s[24:27], s72 offen offset:3072 lds
v_mfma_f32_16x16x32_bf16 v[24:27], v[136:139], a[32:35], v[24:27]
ds_read_b64_tr_b16 v[230:231], v9 offset:43008
ds_read_b64_tr_b16 v[232:233], v10 offset:40960
v_mfma_f32_16x16x32_bf16 v[24:27], v[152:155], a[36:39], v[24:27]
ds_read_b64_tr_b16 v[234:235], v10 offset:43008
ds_read_b64_tr_b16 v[236:237], v11 offset:40960
v_mfma_f32_16x16x32_bf16 v[24:27], v[168:171], a[40:43], v[24:27]
s_waitcnt vmcnt(49)
v_cmp_gt_u32 vcc, 2, v3
s_cbranch_vccnz Lspin118
Lback119:
s_add_u32 s82, s59, 28
s_and_b32 s82, s82, 28
s_lshl_b32 s82, s82, 10
s_add_u32 s82, s82, s74
buffer_load_dword v3, v2, s[44:47], s82 offen sc1
s_add_u32 s69, s61, 0
s_and_b32 s69, s69, 3
s_add_u32 s69, s69, s79
s_lshl_b32 s69, s69, 12
s_add_u32 s69, s69, s95
buffer_load_dwordx4 a[0:3], v1, s[44:47], s69 offen sc1
v_mfma_f32_16x16x32_bf16 v[24:27], v[184:187], a[44:47], v[24:27]
ds_read_b64_tr_b16 v[238:239], v11 offset:43008
ds_read_b64_tr_b16 v[240:241], v8 offset:45056
v_mfma_f32_16x16x32_bf16 v[40:43], v[184:187], a[60:63], v[40:43]
ds_read_b64_tr_b16 v[242:243], v8 offset:47104
ds_read_b64_tr_b16 v[244:245], v9 offset:45056
v_mfma_f32_16x16x32_bf16 v[40:43], v[168:171], a[56:59], v[40:43]
buffer_load_dwordx4 a[4:7], v1, s[44:47], s69 offen offset:1024 sc1
v_mfma_f32_16x16x32_bf16 v[40:43], v[152:155], a[52:55], v[40:43]
ds_read_b64_tr_b16 v[246:247], v9 offset:47104
ds_read_b64_tr_b16 v[248:249], v10 offset:45056
v_mfma_f32_16x16x32_bf16 v[40:43], v[136:139], a[48:51], v[40:43]
ds_read_b64_tr_b16 v[250:251], v10 offset:47104
ds_read_b64_tr_b16 v[252:253], v11 offset:45056
v_mfma_f32_16x16x32_bf16 v[44:47], v[140:143], a[48:51], v[44:47]
buffer_load_dwordx4 a[8:11], v1, s[44:47], s69 offen offset:2048 sc1
v_mfma_f32_16x16x32_bf16 v[44:47], v[156:159], a[52:55], v[44:47]
ds_read_b64_tr_b16 v[254:255], v11 offset:47104
v_mfma_f32_16x16x32_bf16 v[44:47], v[172:175], a[56:59], v[44:47]
buffer_load_dwordx4 a[12:15], v1, s[44:47], s69 offen offset:3072 sc1
v_mfma_f32_16x16x32_bf16 v[44:47], v[188:191], a[60:63], v[44:47]
s_add_u32 s69, s69, 0x20000
v_mfma_f32_16x16x32_bf16 v[28:31], v[188:191], a[44:47], v[28:31]
v_mfma_f32_16x16x32_bf16 v[28:31], v[172:175], a[40:43], v[28:31]
buffer_load_dwordx4 a[16:19], v1, s[44:47], s69 offen sc1
v_mfma_f32_16x16x32_bf16 v[28:31], v[156:159], a[36:39], v[28:31]
s_waitcnt vmcnt(19) lgkmcnt(0)
v_mfma_f32_16x16x32_bf16 v[28:31], v[140:143], a[32:35], v[28:31]
s_barrier
v_mfma_f32_16x16x32_bf16 v[16:19], v[192:195], a[64:67], v[16:19]
buffer_load_dwordx4 a[20:23], v1, s[44:47], s69 offen offset:1024 sc1
v_mfma_f32_16x16x32_bf16 v[16:19], v[208:211], a[68:71], v[16:19]
ds_read_b64_tr_b16 v[128:129], v8 offset:49152
ds_read_b64_tr_b16 v[130:131], v8 offset:51200
v_mfma_f32_16x16x32_bf16 v[16:19], v[224:227], a[72:75], v[16:19]
ds_read_b64_tr_b16 v[132:133], v9 offset:49152
ds_read_b64_tr_b16 v[134:135], v9 offset:51200
v_mfma_f32_16x16x32_bf16 v[16:19], v[240:243], a[76:79], v[16:19]
buffer_load_dwordx4 a[24:27], v1, s[44:47], s69 offen offset:2048 sc1
v_mfma_f32_16x16x32_bf16 v[32:35], v[240:243], a[92:95], v[32:35]
ds_read_b64_tr_b16 v[136:137], v10 offset:49152
ds_read_b64_tr_b16 v[138:139], v10 offset:51200
v_mfma_f32_16x16x32_bf16 v[32:35], v[224:227], a[88:91], v[32:35]
ds_read_b64_tr_b16 v[140:141], v11 offset:49152
ds_read_b64_tr_b16 v[142:143], v11 offset:51200
v_mfma_f32_16x16x32_bf16 v[32:35], v[208:211], a[84:87], v[32:35]
buffer_load_dwordx4 a[28:31], v1, s[44:47], s69 offen offset:3072 sc1
v_mfma_f32_16x16x32_bf16 v[32:35], v[192:195], a[80:83], v[32:35]
s_add_u32 s71, s61, 1
ds_read_b64_tr_b16 v[144:145], v8 offset:53248
ds_read_b64_tr_b16 v[146:147], v8 offset:55296
v_mfma_f32_16x16x32_bf16 v[36:39], v[196:199], a[80:83], v[36:39]
s_and_b32 s71, s71, 3
ds_read_b64_tr_b16 v[148:149], v9 offset:53248
ds_read_b64_tr_b16 v[150:151], v9 offset:55296
v_mfma_f32_16x16x32_bf16 v[36:39], v[212:215], a[84:87], v[36:39]
s_add_u32 s71, s71, s79
s_lshl_b32 s71, s71, 18
s_add_u32 s71, s71, s94
s_add_u32 m0, s77, 16384
s_add_u32 s72, s71, 0
buffer_load_dwordx4 v15, s[24:27], s72 offen lds
v_mfma_f32_16x16x32_bf16 v[36:39], v[228:231], a[88:91], v[36:39]
s_add_u32 s72, s71, 15360
ds_read_b64_tr_b16 v[152:153], v10 offset:53248
ds_read_b64_tr_b16 v[154:155], v10 offset:55296
v_mfma_f32_16x16x32_bf16 v[36:39], v[244:247], a[92:95], v[36:39]
buffer_load_dwordx4 v15, s[24:27], s72 offen offset:1024 lds
v_mfma_f32_16x16x32_bf16 v[20:23], v[244:247], a[76:79], v[20:23]
s_add_u32 s72, s71, 30720
ds_read_b64_tr_b16 v[156:157], v11 offset:53248
ds_read_b64_tr_b16 v[158:159], v11 offset:55296
v_mfma_f32_16x16x32_bf16 v[20:23], v[228:231], a[72:75], v[20:23]
ds_read_b64_tr_b16 v[160:161], v8 offset:57344
v_mfma_f32_16x16x32_bf16 v[20:23], v[212:215], a[68:71], v[20:23]
buffer_load_dwordx4 v15, s[24:27], s72 offen offset:2048 lds
v_mfma_f32_16x16x32_bf16 v[20:23], v[196:199], a[64:67], v[20:23]
s_add_u32 s72, s71, 46080
ds_read_b64_tr_b16 v[162:163], v8 offset:59392
ds_read_b64_tr_b16 v[164:165], v9 offset:57344
v_mfma_f32_16x16x32_bf16 v[24:27], v[200:203], a[64:67], v[24:27]
ds_read_b64_tr_b16 v[166:167], v9 offset:59392
ds_read_b64_tr_b16 v[168:169], v10 offset:57344
v_mfma_f32_16x16x32_bf16 v[24:27], v[216:219], a[68:71], v[24:27]
buffer_load_dwordx4 v15, s[24:27], s72 offen offset:3072 lds
v_mfma_f32_16x16x32_bf16 v[24:27], v[232:235], a[72:75], v[24:27]
s_add_u32 s69, s61, 1
ds_read_b64_tr_b16 v[170:171], v10 offset:59392
ds_read_b64_tr_b16 v[172:173], v11 offset:57344
v_mfma_f32_16x16x32_bf16 v[24:27], v[248:251], a[76:79], v[24:27]
s_and_b32 s69, s69, 3
ds_read_b64_tr_b16 v[174:175], v11 offset:59392
ds_read_b64_tr_b16 v[176:177], v8 offset:61440
v_mfma_f32_16x16x32_bf16 v[40:43], v[248:251], a[92:95], v[40:43]
s_add_u32 s69, s69, s79
s_lshl_b32 s69, s69, 12
s_add_u32 s69, s69, s95
buffer_load_dwordx4 a[32:35], v1, s[44:47], s69 offen sc1
v_mfma_f32_16x16x32_bf16 v[40:43], v[232:235], a[88:91], v[40:43]
ds_read_b64_tr_b16 v[178:179], v8 offset:63488
ds_read_b64_tr_b16 v[180:181], v9 offset:61440
v_mfma_f32_16x16x32_bf16 v[40:43], v[216:219], a[84:87], v[40:43]
ds_read_b64_tr_b16 v[182:183], v9 offset:63488
ds_read_b64_tr_b16 v[184:185], v10 offset:61440
v_mfma_f32_16x16x32_bf16 v[40:43], v[200:203], a[80:83], v[40:43]
buffer_load_dwordx4 a[36:39], v1, s[44:47], s69 offen offset:1024 sc1
v_mfma_f32_16x16x32_bf16 v[44:47], v[204:207], a[80:83], v[44:47]
ds_read_b64_tr_b16 v[186:187], v10 offset:63488
ds_read_b64_tr_b16 v[188:189], v11 offset:61440
v_mfma_f32_16x16x32_bf16 v[44:47], v[220:223], a[84:87], v[44:47]
ds_read_b64_tr_b16 v[190:191], v11 offset:63488
v_mfma_f32_16x16x32_bf16 v[44:47], v[236:239], a[88:91], v[44:47]
buffer_load_dwordx4 a[40:43], v1, s[44:47], s69 offen offset:2048 sc1
v_mfma_f32_16x16x32_bf16 v[44:47], v[252:255], a[92:95], v[44:47]
v_mfma_f32_16x16x32_bf16 v[28:31], v[252:255], a[76:79], v[28:31]
buffer_load_dwordx4 a[44:47], v1, s[44:47], s69 offen offset:3072 sc1
v_mfma_f32_16x16x32_bf16 v[28:31], v[236:239], a[72:75], v[28:31]
s_add_u32 s69, s69, 0x20000
v_mfma_f32_16x16x32_bf16 v[28:31], v[220:223], a[68:71], v[28:31]
s_waitcnt vmcnt(17) lgkmcnt(0)
v_mfma_f32_16x16x32_bf16 v[28:31], v[204:207], a[64:67], v[28:31]
s_barrier
buffer_load_dwordx4 a[48:51], v1, s[44:47], s69 offen sc1
v_mfma_f32_16x16x32_bf16 v[16:19], v[128:131], a[96:99], v[16:19]
ds_read_b64_tr_b16 v[192:193], v8 offset:0
ds_read_b64_tr_b16 v[194:195], v8 offset:2048
v_mfma_f32_16x16x32_bf16 v[16:19], v[144:147], a[100:103], v[16:19]
ds_read_b64_tr_b16 v[196:197], v9 offset:0
ds_read_b64_tr_b16 v[198:199], v9 offset:2048
v_mfma_f32_16x16x32_bf16 v[16:19], v[160:163], a[104:107], v[16:19]
buffer_load_dwordx4 a[52:55], v1, s[44:47], s69 offen offset:1024 sc1
v_mfma_f32_16x16x32_bf16 v[16:19], v[176:179], a[108:111], v[16:19]
ds_read_b64_tr_b16 v[200:201], v10 offset:0
ds_read_b64_tr_b16 v[202:203], v10 offset:2048
v_mfma_f32_16x16x32_bf16 v[32:35], v[176:179], a[124:127], v[32:35]
ds_read_b64_tr_b16 v[204:205], v11 offset:0
ds_read_b64_tr_b16 v[206:207], v11 offset:2048
v_mfma_f32_16x16x32_bf16 v[32:35], v[160:163], a[120:123], v[32:35]
buffer_load_dwordx4 a[56:59], v1, s[44:47], s69 offen offset:2048 sc1
v_mfma_f32_16x16x32_bf16 v[32:35], v[144:147], a[116:119], v[32:35]
ds_read_b64_tr_b16 v[208:209], v8 offset:4096
v_mfma_f32_16x16x32_bf16 v[32:35], v[128:131], a[112:115], v[32:35]
ds_read_b64_tr_b16 v[210:211], v8 offset:6144
ds_read_b64_tr_b16 v[212:213], v9 offset:4096
v_mfma_f32_16x16x32_bf16 v[36:39], v[132:135], a[112:115], v[36:39]
buffer_load_dwordx4 a[60:63], v1, s[44:47], s69 offen offset:3072 sc1
v_mfma_f32_16x16x32_bf16 v[36:39], v[148:151], a[116:119], v[36:39]
s_add_u32 s71, s61, 2
ds_read_b64_tr_b16 v[214:215], v9 offset:6144
ds_read_b64_tr_b16 v[216:217], v10 offset:4096
v_mfma_f32_16x16x32_bf16 v[36:39], v[164:167], a[120:123], v[36:39]
s_and_b32 s71, s71, 3
ds_read_b64_tr_b16 v[218:219], v10 offset:6144
ds_read_b64_tr_b16 v[220:221], v11 offset:4096
v_mfma_f32_16x16x32_bf16 v[36:39], v[180:183], a[124:127], v[36:39]
s_add_u32 s71, s71, s79
s_lshl_b32 s71, s71, 18
s_add_u32 s71, s71, s94
s_add_u32 m0, s77, 32768
s_add_u32 s72, s71, 0
buffer_load_dwordx4 v15, s[24:27], s72 offen lds
v_mfma_f32_16x16x32_bf16 v[20:23], v[180:183], a[108:111], v[20:23]
s_add_u32 s72, s71, 15360
ds_read_b64_tr_b16 v[222:223], v11 offset:6144
v_mfma_f32_16x16x32_bf16 v[20:23], v[164:167], a[104:107], v[20:23]
ds_read_b64_tr_b16 v[224:225], v8 offset:8192
ds_read_b64_tr_b16 v[226:227], v8 offset:10240
v_mfma_f32_16x16x32_bf16 v[20:23], v[148:151], a[100:103], v[20:23]
buffer_load_dwordx4 v15, s[24:27], s72 offen offset:1024 lds
v_mfma_f32_16x16x32_bf16 v[20:23], v[132:135], a[96:99], v[20:23]
s_add_u32 s72, s71, 30720
ds_read_b64_tr_b16 v[228:229], v9 offset:8192
ds_read_b64_tr_b16 v[230:231], v9 offset:10240
v_mfma_f32_16x16x32_bf16 v[24:27], v[136:139], a[96:99], v[24:27]
buffer_load_dwordx4 v15, s[24:27], s72 offen offset:2048 lds
v_mfma_f32_16x16x32_bf16 v[24:27], v[152:155], a[100:103], v[24:27]
s_add_u32 s72, s71, 46080
ds_read_b64_tr_b16 v[232:233], v10 offset:8192
ds_read_b64_tr_b16 v[234:235], v10 offset:10240
v_mfma_f32_16x16x32_bf16 v[24:27], v[168:171], a[104:107], v[24:27]
ds_read_b64_tr_b16 v[236:237], v11 offset:8192
ds_read_b64_tr_b16 v[238:239], v11 offset:10240
v_mfma_f32_16x16x32_bf16 v[24:27], v[184:187], a[108:111], v[24:27]
buffer_load_dwordx4 v15, s[24:27], s72 offen offset:3072 lds
v_mfma_f32_16x16x32_bf16 v[40:43], v[184:187], a[124:127], v[40:43]
s_add_u32 s69, s61, 2
ds_read_b64_tr_b16 v[240:241], v8 offset:12288
v_mfma_f32_16x16x32_bf16 v[40:43], v[168:171], a[120:123], v[40:43]
s_and_b32 s69, s69, 3
ds_read_b64_tr_b16 v[242:243], v8 offset:14336
ds_read_b64_tr_b16 v[244:245], v9 offset:12288
v_mfma_f32_16x16x32_bf16 v[40:43], v[152:155], a[116:119], v[40:43]
s_add_u32 s69, s69, s79
s_lshl_b32 s69, s69, 12
s_add_u32 s69, s69, s95
buffer_load_dwordx4 a[64:67], v1, s[44:47], s69 offen sc1
v_mfma_f32_16x16x32_bf16 v[40:43], v[136:139], a[112:115], v[40:43]
ds_read_b64_tr_b16 v[246:247], v9 offset:14336
ds_read_b64_tr_b16 v[248:249], v10 offset:12288
v_mfma_f32_16x16x32_bf16 v[44:47], v[140:143], a[112:115], v[44:47]
ds_read_b64_tr_b16 v[250:251], v10 offset:14336
ds_read_b64_tr_b16 v[252:253], v11 offset:12288
v_mfma_f32_16x16x32_bf16 v[44:47], v[156:159], a[116:119], v[44:47]
buffer_load_dwordx4 a[68:71], v1, s[44:47], s69 offen offset:1024 sc1
v_mfma_f32_16x16x32_bf16 v[44:47], v[172:175], a[120:123], v[44:47]
ds_read_b64_tr_b16 v[254:255], v11 offset:14336
v_mfma_f32_16x16x32_bf16 v[44:47], v[188:191], a[124:127], v[44:47]
v_mfma_f32_16x16x32_bf16 v[28:31], v[188:191], a[108:111], v[28:31]
buffer_load_dwordx4 a[72:75], v1, s[44:47], s69 offen offset:2048 sc1
v_mfma_f32_16x16x32_bf16 v[28:31], v[172:175], a[104:107], v[28:31]
v_mfma_f32_16x16x32_bf16 v[28:31], v[156:159], a[100:103], v[28:31]
s_waitcnt vmcnt(15) lgkmcnt(0)
v_mfma_f32_16x16x32_bf16 v[28:31], v[140:143], a[96:99], v[28:31]
s_barrier
buffer_load_dwordx4 a[76:79], v1, s[44:47], s69 offen offset:3072 sc1
v_mfma_f32_16x16x32_bf16 v[16:19], v[192:195], a[0:3], v[16:19]
s_add_u32 s69, s69, 0x20000
ds_read_b64_tr_b16 v[128:129], v8 offset:16384
ds_read_b64_tr_b16 v[130:131], v8 offset:18432
v_mfma_f32_16x16x32_bf16 v[16:19], v[208:211], a[4:7], v[16:19]
buffer_load_dwordx4 a[80:83], v1, s[44:47], s69 offen sc1
s_waitcnt vmcnt(37)
v_cmp_gt_u32 vcc, 3, v114
s_cbranch_vccnz Lspin127
Lback128:
s_lshl_b32 s73, s76, 18
s_lshl_b32 s84, s58, 16
s_add_u32 s73, s73, s84
s_lshl_b32 s84, s75, 8
s_add_u32 s73, s73, s84
s_add_u32 s73, s73, 0x3400000
v_lshrrev_b32 v112, 4, v0
v_and_b32 v113, 15, v0
v_lshlrev_b32 v114, 4, v113
v_lshl_add_u32 v112, v112, 12, v114
s_add_u32 m0, s64, 147456
s_add_u32 s72, s73, 0
buffer_load_dwordx4 v112, s[44:47], s72 offen sc1 lds
s_add_u32 s72, s73, 15360
buffer_load_dwordx4 v112, s[44:47], s72 offen offset:1024 sc1 lds
s_add_u32 s72, s73, 30720
buffer_load_dwordx4 v112, s[44:47], s72 offen offset:2048 sc1 lds
s_add_u32 s72, s73, 46080
buffer_load_dwordx4 v112, s[44:47], s72 offen offset:3072 sc1 lds
s_lshl_b32 s73, s75, 9
s_lshl_b32 s84, s58, 7
s_add_u32 s73, s73, s84
s_add_u32 s73, s73, 0x3800000
v_lshlrev_b32 v113, 2, v113
buffer_load_dword v6, v113, s[44:47], s73 offen sc1
buffer_load_dword v7, v113, s[44:47], s73 offen offset:64 sc1
v_mfma_f32_16x16x32_bf16 v[16:19], v[224:227], a[8:11], v[16:19]
ds_read_b64_tr_b16 v[132:133], v9 offset:16384
ds_read_b64_tr_b16 v[134:135], v9 offset:18432
v_mfma_f32_16x16x32_bf16 v[16:19], v[240:243], a[12:15], v[16:19]
ds_read_b64_tr_b16 v[136:137], v10 offset:16384
ds_read_b64_tr_b16 v[138:139], v10 offset:18432
v_mfma_f32_16x16x32_bf16 v[32:35], v[240:243], a[28:31], v[32:35]
buffer_load_dwordx4 a[84:87], v1, s[44:47], s69 offen offset:1024 sc1
v_mfma_f32_16x16x32_bf16 v[32:35], v[224:227], a[24:27], v[32:35]
ds_read_b64_tr_b16 v[140:141], v11 offset:16384
ds_read_b64_tr_b16 v[142:143], v11 offset:18432
v_mfma_f32_16x16x32_bf16 v[32:35], v[208:211], a[20:23], v[32:35]
ds_read_b64_tr_b16 v[144:145], v8 offset:20480
v_mfma_f32_16x16x32_bf16 v[32:35], v[192:195], a[16:19], v[32:35]
buffer_load_dwordx4 a[88:91], v1, s[44:47], s69 offen offset:2048 sc1
v_mfma_f32_16x16x32_bf16 v[36:39], v[196:199], a[16:19], v[36:39]
ds_read_b64_tr_b16 v[146:147], v8 offset:22528
ds_read_b64_tr_b16 v[148:149], v9 offset:20480
v_mfma_f32_16x16x32_bf16 v[36:39], v[212:215], a[20:23], v[36:39]
ds_read_b64_tr_b16 v[150:151], v9 offset:22528
ds_read_b64_tr_b16 v[152:153], v10 offset:20480
v_mfma_f32_16x16x32_bf16 v[36:39], v[228:231], a[24:27], v[36:39]
buffer_load_dwordx4 a[92:95], v1, s[44:47], s69 offen offset:3072 sc1
v_mfma_f32_16x16x32_bf16 v[36:39], v[244:247], a[28:31], v[36:39]
s_add_u32 s71, s61, 3
ds_read_b64_tr_b16 v[154:155], v10 offset:22528
ds_read_b64_tr_b16 v[156:157], v11 offset:20480
v_mfma_f32_16x16x32_bf16 v[20:23], v[244:247], a[12:15], v[20:23]
s_and_b32 s71, s71, 3
ds_read_b64_tr_b16 v[158:159], v11 offset:22528
v_mfma_f32_16x16x32_bf16 v[20:23], v[228:231], a[8:11], v[20:23]
s_add_u32 s71, s71, s79
s_lshl_b32 s71, s71, 18
s_add_u32 s71, s71, s94
s_add_u32 m0, s77, 49152
s_add_u32 s72, s71, 0
buffer_load_dwordx4 v15, s[24:27], s72 offen lds
v_mfma_f32_16x16x32_bf16 v[20:23], v[212:215], a[4:7], v[20:23]
s_add_u32 s72, s71, 15360
ds_read_b64_tr_b16 v[160:161], v8 offset:24576
ds_read_b64_tr_b16 v[162:163], v8 offset:26624
v_mfma_f32_16x16x32_bf16 v[20:23], v[196:199], a[0:3], v[20:23]
ds_read_b64_tr_b16 v[164:165], v9 offset:24576
ds_read_b64_tr_b16 v[166:167], v9 offset:26624
v_mfma_f32_16x16x32_bf16 v[24:27], v[200:203], a[0:3], v[24:27]
buffer_load_dwordx4 v15, s[24:27], s72 offen offset:1024 lds
v_mfma_f32_16x16x32_bf16 v[24:27], v[216:219], a[4:7], v[24:27]
s_add_u32 s72, s71, 30720
ds_read_b64_tr_b16 v[168:169], v10 offset:24576
ds_read_b64_tr_b16 v[170:171], v10 offset:26624
v_mfma_f32_16x16x32_bf16 v[24:27], v[232:235], a[8:11], v[24:27]
buffer_load_dwordx4 v15, s[24:27], s72 offen offset:2048 lds
v_mfma_f32_16x16x32_bf16 v[24:27], v[248:251], a[12:15], v[24:27]
s_add_u32 s72, s71, 46080
ds_read_b64_tr_b16 v[172:173], v11 offset:24576
ds_read_b64_tr_b16 v[174:175], v11 offset:26624
v_mfma_f32_16x16x32_bf16 v[40:43], v[248:251], a[28:31], v[40:43]
ds_read_b64_tr_b16 v[176:177], v8 offset:28672
v_mfma_f32_16x16x32_bf16 v[40:43], v[232:235], a[24:27], v[40:43]
buffer_load_dwordx4 v15, s[24:27], s72 offen offset:3072 lds
v_mfma_f32_16x16x32_bf16 v[40:43], v[216:219], a[20:23], v[40:43]
s_add_u32 s69, s61, 3
ds_read_b64_tr_b16 v[178:179], v8 offset:30720
ds_read_b64_tr_b16 v[180:181], v9 offset:28672
v_mfma_f32_16x16x32_bf16 v[40:43], v[200:203], a[16:19], v[40:43]
s_and_b32 s69, s69, 3
ds_read_b64_tr_b16 v[182:183], v9 offset:30720
ds_read_b64_tr_b16 v[184:185], v10 offset:28672
v_mfma_f32_16x16x32_bf16 v[44:47], v[204:207], a[16:19], v[44:47]
s_add_u32 s69, s69, s79
s_lshl_b32 s69, s69, 12
s_add_u32 s69, s69, s95
buffer_load_dwordx4 a[96:99], v1, s[44:47], s69 offen sc1
v_mfma_f32_16x16x32_bf16 v[44:47], v[220:223], a[20:23], v[44:47]
ds_read_b64_tr_b16 v[186:187], v10 offset:30720
ds_read_b64_tr_b16 v[188:189], v11 offset:28672
v_mfma_f32_16x16x32_bf16 v[44:47], v[236:239], a[24:27], v[44:47]
ds_read_b64_tr_b16 v[190:191], v11 offset:30720
v_mfma_f32_16x16x32_bf16 v[44:47], v[252:255], a[28:31], v[44:47]
buffer_load_dwordx4 a[100:103], v1, s[44:47], s69 offen offset:1024 sc1
v_mfma_f32_16x16x32_bf16 v[28:31], v[252:255], a[12:15], v[28:31]
v_mfma_f32_16x16x32_bf16 v[28:31], v[236:239], a[8:11], v[28:31]
v_mfma_f32_16x16x32_bf16 v[28:31], v[220:223], a[4:7], v[28:31]
s_waitcnt vmcnt(20) lgkmcnt(0)
buffer_load_dwordx4 a[104:107], v1, s[44:47], s69 offen offset:2048 sc1
v_mfma_f32_16x16x32_bf16 v[28:31], v[204:207], a[0:3], v[28:31]
s_barrier
v_mfma_f32_16x16x32_bf16 v[16:19], v[128:131], a[32:35], v[16:19]
ds_read_b64_tr_b16 v[192:193], v8 offset:32768
ds_read_b64_tr_b16 v[194:195], v8 offset:34816
s_add_u32 s73, s64, 131072
v_add_u32 v120, s73, v1
s_lshl_b32 s70, s75, 18
s_add_u32 s70, s70, s94
v_mfma_f32_16x16x32_bf16 v[16:19], v[144:147], a[36:39], v[16:19]
buffer_load_dwordx4 a[108:111], v1, s[44:47], s69 offen offset:3072 sc1
v_mfma_f32_16x16x32_bf16 v[16:19], v[160:163], a[40:43], v[16:19]
s_add_u32 s69, s69, 0x20000
ds_read_b64_tr_b16 v[196:197], v9 offset:32768
ds_read_b64_tr_b16 v[198:199], v9 offset:34816
v_mfma_f32_16x16x32_bf16 v[16:19], v[176:179], a[44:47], v[16:19]
buffer_load_dwordx4 a[112:115], v1, s[44:47], s69 offen sc1
v_mfma_f32_16x16x32_bf16 v[32:35], v[176:179], a[60:63], v[32:35]
ds_read_b64_tr_b16 v[200:201], v10 offset:32768
ds_read_b64_tr_b16 v[202:203], v10 offset:34816
ds_write_b128 v120, v[80:83] offset:0
v_mfma_f32_16x16x32_bf16 v[32:35], v[160:163], a[56:59], v[32:35]
ds_read_b64_tr_b16 v[204:205], v11 offset:32768
ds_read_b64_tr_b16 v[206:207], v11 offset:34816
v_mfma_f32_16x16x32_bf16 v[32:35], v[144:147], a[52:55], v[32:35]
buffer_load_dwordx4 a[116:119], v1, s[44:47], s69 offen offset:1024 sc1
v_mfma_f32_16x16x32_bf16 v[32:35], v[128:131], a[48:51], v[32:35]
ds_read_b64_tr_b16 v[208:209], v8 offset:36864
ds_read_b64_tr_b16 v[210:211], v8 offset:38912
v_mfma_f32_16x16x32_bf16 v[36:39], v[132:135], a[48:51], v[36:39]
ds_read_b64_tr_b16 v[212:213], v9 offset:36864
ds_read_b64_tr_b16 v[214:215], v9 offset:38912
v_mfma_f32_16x16x32_bf16 v[36:39], v[148:151], a[52:55], v[36:39]
ds_write_b128 v120, v[84:87] offset:1024
buffer_load_dwordx4 a[120:123], v1, s[44:47], s69 offen offset:2048 sc1
v_mfma_f32_16x16x32_bf16 v[36:39], v[164:167], a[56:59], v[36:39]
ds_read_b64_tr_b16 v[216:217], v10 offset:36864
ds_read_b64_tr_b16 v[218:219], v10 offset:38912
v_mfma_f32_16x16x32_bf16 v[36:39], v[180:183], a[60:63], v[36:39]
ds_read_b64_tr_b16 v[220:221], v11 offset:36864
ds_read_b64_tr_b16 v[222:223], v11 offset:38912
v_mfma_f32_16x16x32_bf16 v[20:23], v[180:183], a[44:47], v[20:23]
buffer_load_dwordx4 a[124:127], v1, s[44:47], s69 offen offset:3072 sc1
v_mfma_f32_16x16x32_bf16 v[20:23], v[164:167], a[40:43], v[20:23]
s_add_u32 s78, s59, 28
ds_read_b64_tr_b16 v[224:225], v8 offset:40960
v_mfma_f32_16x16x32_bf16 v[20:23], v[148:151], a[36:39], v[20:23]
s_and_b32 s78, s78, 28
ds_read_b64_tr_b16 v[226:227], v8 offset:43008
ds_read_b64_tr_b16 v[228:229], v9 offset:40960
ds_write_b128 v120, v[96:99] offset:2048
v_mfma_f32_16x16x32_bf16 v[20:23], v[132:135], a[32:35], v[20:23]
s_add_u32 s71, s61, 0
s_and_b32 s71, s71, 3
s_add_u32 s71, s71, s78
s_lshl_b32 s71, s71, 18
s_add_u32 s71, s71, s94
s_add_u32 m0, s77, 0
s_add_u32 s72, s71, 0
buffer_load_dwordx4 v15, s[24:27], s72 offen lds
v_mfma_f32_16x16x32_bf16 v[24:27], v[136:139], a[32:35], v[24:27]
s_add_u32 s72, s71, 15360
ds_read_b64_tr_b16 v[230:231], v9 offset:43008
ds_read_b64_tr_b16 v[232:233], v10 offset:40960
v_mfma_f32_16x16x32_bf16 v[24:27], v[152:155], a[36:39], v[24:27]
ds_read_b64_tr_b16 v[234:235], v10 offset:43008
ds_read_b64_tr_b16 v[236:237], v11 offset:40960
v_mfma_f32_16x16x32_bf16 v[24:27], v[168:171], a[40:43], v[24:27]
buffer_load_dwordx4 v15, s[24:27], s72 offen offset:1024 lds
v_mfma_f32_16x16x32_bf16 v[24:27], v[184:187], a[44:47], v[24:27]
s_add_u32 s72, s71, 30720
ds_read_b64_tr_b16 v[238:239], v11 offset:43008
ds_read_b64_tr_b16 v[240:241], v8 offset:45056
ds_write_b128 v120, v[100:103] offset:3072
v_mfma_f32_16x16x32_bf16 v[40:43], v[184:187], a[60:63], v[40:43]
ds_read_b64_tr_b16 v[242:243], v8 offset:47104
ds_read_b64_tr_b16 v[244:245], v9 offset:45056
v_mfma_f32_16x16x32_bf16 v[40:43], v[168:171], a[56:59], v[40:43]
buffer_load_dwordx4 v15, s[24:27], s72 offen offset:2048 lds
v_mfma_f32_16x16x32_bf16 v[40:43], v[152:155], a[52:55], v[40:43]
s_add_u32 s72, s71, 46080
ds_read_b64_tr_b16 v[246:247], v9 offset:47104
ds_read_b64_tr_b16 v[248:249], v10 offset:45056
v_mfma_f32_16x16x32_bf16 v[40:43], v[136:139], a[48:51], v[40:43]
buffer_load_dwordx4 v15, s[24:27], s72 offen offset:3072 lds
v_mfma_f32_16x16x32_bf16 v[44:47], v[140:143], a[48:51], v[44:47]
ds_read_b64_tr_b16 v[250:251], v10 offset:47104
ds_read_b64_tr_b16 v[252:253], v11 offset:45056
v_mfma_f32_16x16x32_bf16 v[44:47], v[156:159], a[52:55], v[44:47]
ds_read_b64_tr_b16 v[254:255], v11 offset:47104
v_mfma_f32_16x16x32_bf16 v[44:47], v[172:175], a[56:59], v[44:47]
s_waitcnt vmcnt(54)
v_cmp_gt_u32 vcc, 2, v3
s_cbranch_vccnz Lspin121
Lback122:
s_add_u32 s82, s59, 32
s_and_b32 s82, s82, 28
s_lshl_b32 s82, s82, 10
s_add_u32 s82, s82, s74
buffer_load_dword v3, v2, s[44:47], s82 offen sc1
s_add_u32 s69, s61, 0
s_and_b32 s69, s69, 3
s_add_u32 s69, s69, s78
s_lshl_b32 s69, s69, 12
s_add_u32 s69, s69, s95
buffer_load_dwordx4 a[0:3], v1, s[44:47], s69 offen sc1
v_mfma_f32_16x16x32_bf16 v[44:47], v[188:191], a[60:63], v[44:47]
v_mfma_f32_16x16x32_bf16 v[28:31], v[188:191], a[44:47], v[28:31]
v_mfma_f32_16x16x32_bf16 v[28:31], v[172:175], a[40:43], v[28:31]
buffer_load_dwordx4 a[4:7], v1, s[44:47], s69 offen offset:1024 sc1
v_mfma_f32_16x16x32_bf16 v[28:31], v[156:159], a[36:39], v[28:31]
s_waitcnt vmcnt(15) lgkmcnt(0)
v_mfma_f32_16x16x32_bf16 v[28:31], v[140:143], a[32:35], v[28:31]
s_barrier
v_mfma_f32_16x16x32_bf16 v[16:19], v[192:195], a[64:67], v[16:19]
buffer_load_dwordx4 a[8:11], v1, s[44:47], s69 offen offset:2048 sc1
v_mfma_f32_16x16x32_bf16 v[16:19], v[208:211], a[68:71], v[16:19]
ds_read_b64_tr_b16 v[128:129], v8 offset:49152
ds_read_b64_tr_b16 v[130:131], v8 offset:51200
v_mfma_f32_16x16x32_bf16 v[16:19], v[224:227], a[72:75], v[16:19]
ds_read_b64_tr_b16 v[132:133], v9 offset:49152
ds_read_b64_tr_b16 v[134:135], v9 offset:51200
v_mfma_f32_16x16x32_bf16 v[16:19], v[240:243], a[76:79], v[16:19]
buffer_load_dwordx4 a[12:15], v1, s[44:47], s69 offen offset:3072 sc1
v_mfma_f32_16x16x32_bf16 v[32:35], v[240:243], a[92:95], v[32:35]
s_add_u32 s69, s69, 0x20000
ds_read_b64_tr_b16 v[136:137], v10 offset:49152
ds_read_b64_tr_b16 v[138:139], v10 offset:51200
v_mfma_f32_16x16x32_bf16 v[32:35], v[224:227], a[88:91], v[32:35]
ds_read_b64_tr_b16 v[140:141], v11 offset:49152
ds_read_b64_tr_b16 v[142:143], v11 offset:51200
v_mfma_f32_16x16x32_bf16 v[32:35], v[208:211], a[84:87], v[32:35]
buffer_load_dwordx4 a[16:19], v1, s[44:47], s69 offen sc1
v_mfma_f32_16x16x32_bf16 v[32:35], v[192:195], a[80:83], v[32:35]
ds_read_b64_tr_b16 v[144:145], v8 offset:53248
ds_read_b64_tr_b16 v[146:147], v8 offset:55296
v_mfma_f32_16x16x32_bf16 v[36:39], v[196:199], a[80:83], v[36:39]
buffer_load_dwordx4 a[20:23], v1, s[44:47], s69 offen offset:1024 sc1
v_mfma_f32_16x16x32_bf16 v[36:39], v[212:215], a[84:87], v[36:39]
ds_read_b64_tr_b16 v[148:149], v9 offset:53248
ds_read_b64_tr_b16 v[150:151], v9 offset:55296
v_mfma_f32_16x16x32_bf16 v[36:39], v[228:231], a[88:91], v[36:39]
ds_read_b64_tr_b16 v[152:153], v10 offset:53248
ds_read_b64_tr_b16 v[154:155], v10 offset:55296
v_mfma_f32_16x16x32_bf16 v[36:39], v[244:247], a[92:95], v[36:39]
buffer_load_dwordx4 a[24:27], v1, s[44:47], s69 offen offset:2048 sc1
v_mfma_f32_16x16x32_bf16 v[20:23], v[244:247], a[76:79], v[20:23]
ds_read_b64_tr_b16 v[156:157], v11 offset:53248
ds_read_b64_tr_b16 v[158:159], v11 offset:55296
v_mfma_f32_16x16x32_bf16 v[20:23], v[228:231], a[72:75], v[20:23]
ds_read_b64_tr_b16 v[160:161], v8 offset:57344
v_mfma_f32_16x16x32_bf16 v[20:23], v[212:215], a[68:71], v[20:23]
buffer_load_dwordx4 a[28:31], v1, s[44:47], s69 offen offset:3072 sc1
v_mfma_f32_16x16x32_bf16 v[20:23], v[196:199], a[64:67], v[20:23]
s_add_u32 s71, s61, 1
ds_read_b64_tr_b16 v[162:163], v8 offset:59392
ds_read_b64_tr_b16 v[164:165], v9 offset:57344
v_mfma_f32_16x16x32_bf16 v[24:27], v[200:203], a[64:67], v[24:27]
s_and_b32 s71, s71, 3
ds_read_b64_tr_b16 v[166:167], v9 offset:59392
ds_read_b64_tr_b16 v[168:169], v10 offset:57344
v_mfma_f32_16x16x32_bf16 v[24:27], v[216:219], a[68:71], v[24:27]
s_add_u32 s71, s71, s78
s_lshl_b32 s71, s71, 18
s_add_u32 s71, s71, s94
s_add_u32 m0, s77, 16384
s_add_u32 s72, s71, 0
buffer_load_dwordx4 v15, s[24:27], s72 offen lds
v_mfma_f32_16x16x32_bf16 v[24:27], v[232:235], a[72:75], v[24:27]
s_add_u32 s72, s71, 15360
ds_read_b64_tr_b16 v[170:171], v10 offset:59392
ds_read_b64_tr_b16 v[172:173], v11 offset:57344
v_mfma_f32_16x16x32_bf16 v[24:27], v[248:251], a[76:79], v[24:27]
ds_read_b64_tr_b16 v[174:175], v11 offset:59392
ds_read_b64_tr_b16 v[176:177], v8 offset:61440
v_mfma_f32_16x16x32_bf16 v[40:43], v[248:251], a[92:95], v[40:43]
buffer_load_dwordx4 v15, s[24:27], s72 offen offset:1024 lds
v_mfma_f32_16x16x32_bf16 v[40:43], v[232:235], a[88:91], v[40:43]
s_add_u32 s72, s71, 30720
ds_read_b64_tr_b16 v[178:179], v8 offset:63488
ds_read_b64_tr_b16 v[180:181], v9 offset:61440
v_mfma_f32_16x16x32_bf16 v[40:43], v[216:219], a[84:87], v[40:43]
ds_read_b64_tr_b16 v[182:183], v9 offset:63488
ds_read_b64_tr_b16 v[184:185], v10 offset:61440
v_mfma_f32_16x16x32_bf16 v[40:43], v[200:203], a[80:83], v[40:43]
buffer_load_dwordx4 v15, s[24:27], s72 offen offset:2048 lds
v_mfma_f32_16x16x32_bf16 v[44:47], v[204:207], a[80:83], v[44:47]
s_add_u32 s72, s71, 46080
ds_read_b64_tr_b16 v[186:187], v10 offset:63488
ds_read_b64_tr_b16 v[188:189], v11 offset:61440
v_mfma_f32_16x16x32_bf16 v[44:47], v[220:223], a[84:87], v[44:47]
buffer_load_dwordx4 v15, s[24:27], s72 offen offset:3072 lds
v_mfma_f32_16x16x32_bf16 v[44:47], v[236:239], a[88:91], v[44:47]
s_add_u32 s69, s61, 1
ds_read_b64_tr_b16 v[190:191], v11 offset:63488
v_mfma_f32_16x16x32_bf16 v[44:47], v[252:255], a[92:95], v[44:47]
s_and_b32 s69, s69, 3
v_mfma_f32_16x16x32_bf16 v[28:31], v[252:255], a[76:79], v[28:31]
s_add_u32 s69, s69, s78
s_lshl_b32 s69, s69, 12
s_add_u32 s69, s69, s95
buffer_load_dwordx4 a[32:35], v1, s[44:47], s69 offen sc1
v_mfma_f32_16x16x32_bf16 v[28:31], v[236:239], a[72:75], v[28:31]
v_mfma_f32_16x16x32_bf16 v[28:31], v[220:223], a[68:71], v[28:31]
s_waitcnt vmcnt(14) lgkmcnt(0)
v_mfma_f32_16x16x32_bf16 v[28:31], v[204:207], a[64:67], v[28:31]
s_barrier
buffer_load_dwordx4 a[36:39], v1, s[44:47], s69 offen offset:1024 sc1
v_mfma_f32_16x16x32_bf16 v[16:19], v[128:131], a[96:99], v[16:19]
ds_read_b64_tr_b16 v[192:193], v8 offset:0
ds_read_b64_tr_b16 v[194:195], v8 offset:2048
ds_read_b64 v[80:81], v116 offset:0
v_mfma_f32_16x16x32_bf16 v[16:19], v[144:147], a[100:103], v[16:19]
ds_read_b64_tr_b16 v[196:197], v9 offset:0
ds_read_b64_tr_b16 v[198:199], v9 offset:2048
ds_read_b64_tr_b16 v[88:89], v5 offset:0
v_mfma_f32_16x16x32_bf16 v[16:19], v[160:163], a[104:107], v[16:19]
ds_read_b64 v[82:83], v117 offset:0
buffer_load_dwordx4 a[40:43], v1, s[44:47], s69 offen offset:2048 sc1
v_mfma_f32_16x16x32_bf16 v[16:19], v[176:179], a[108:111], v[16:19]
ds_read_b64_tr_b16 v[200:201], v10 offset:0
ds_read_b64_tr_b16 v[202:203], v10 offset:2048
ds_read_b64_tr_b16 v[90:91], v5 offset:4096
v_mfma_f32_16x16x32_bf16 v[32:35], v[176:179], a[124:127], v[32:35]
ds_read_b64_tr_b16 v[204:205], v11 offset:0
ds_read_b64_tr_b16 v[206:207], v11 offset:2048
ds_read_b64 v[84:85], v118 offset:0
v_mfma_f32_16x16x32_bf16 v[32:35], v[160:163], a[120:123], v[32:35]
ds_read_b64_tr_b16 v[92:93], v5 offset:8192
buffer_load_dwordx4 a[44:47], v1, s[44:47], s69 offen offset:3072 sc1
v_mfma_f32_16x16x32_bf16 v[32:35], v[144:147], a[116:119], v[32:35]
s_add_u32 s69, s69, 0x20000
ds_read_b64_tr_b16 v[208:209], v8 offset:4096
ds_read_b64 v[86:87], v119 offset:0
v_mfma_f32_16x16x32_bf16 v[32:35], v[128:131], a[112:115], v[32:35]
ds_read_b64_tr_b16 v[210:211], v8 offset:6144
ds_read_b64_tr_b16 v[212:213], v9 offset:4096
ds_read_b64_tr_b16 v[94:95], v5 offset:12288
v_mfma_f32_16x16x32_bf16 v[36:39], v[132:135], a[112:115], v[36:39]
ds_read_b64 v[96:97], v116 offset:2048
buffer_load_dwordx4 a[48:51], v1, s[44:47], s69 offen sc1
v_mfma_f32_16x16x32_bf16 v[36:39], v[148:151], a[116:119], v[36:39]
ds_read_b64_tr_b16 v[214:215], v9 offset:6144
ds_read_b64_tr_b16 v[216:217], v10 offset:4096
ds_read_b64_tr_b16 v[104:105], v5 offset:16
v_mfma_f32_16x16x32_bf16 v[36:39], v[164:167], a[120:123], v[36:39]
ds_read_b64 v[98:99], v117 offset:2048
buffer_load_dwordx4 a[52:55], v1, s[44:47], s69 offen offset:1024 sc1
v_mfma_f32_16x16x32_bf16 v[36:39], v[180:183], a[124:127], v[36:39]
ds_read_b64_tr_b16 v[218:219], v10 offset:6144
ds_read_b64_tr_b16 v[220:221], v11 offset:4096
ds_read_b64_tr_b16 v[106:107], v5 offset:4112
v_mfma_f32_16x16x32_bf16 v[20:23], v[180:183], a[108:111], v[20:23]
ds_read_b64_tr_b16 v[222:223], v11 offset:6144
ds_read_b64 v[100:101], v118 offset:2048
v_mfma_f32_16x16x32_bf16 v[20:23], v[164:167], a[104:107], v[20:23]
ds_read_b64_tr_b16 v[108:109], v5 offset:8208
buffer_load_dwordx4 a[56:59], v1, s[44:47], s69 offen offset:2048 sc1
v_mfma_f32_16x16x32_bf16 v[20:23], v[148:151], a[100:103], v[20:23]
ds_read_b64_tr_b16 v[224:225], v8 offset:8192
ds_read_b64_tr_b16 v[226:227], v8 offset:10240
ds_read_b64 v[102:103], v119 offset:2048
v_mfma_f32_16x16x32_bf16 v[20:23], v[132:135], a[96:99], v[20:23]
ds_read_b64_tr_b16 v[228:229], v9 offset:8192
ds_read_b64_tr_b16 v[230:231], v9 offset:10240
ds_read_b64_tr_b16 v[110:111], v5 offset:12304
v_mfma_f32_16x16x32_bf16 v[24:27], v[136:139], a[96:99], v[24:27]
buffer_load_dwordx4 a[60:63], v1, s[44:47], s69 offen offset:3072 sc1
v_mfma_f32_16x16x32_bf16 v[24:27], v[152:155], a[100:103], v[24:27]
s_add_u32 s71, s61, 2
ds_read_b64_tr_b16 v[232:233], v10 offset:8192
ds_read_b64_tr_b16 v[234:235], v10 offset:10240
v_mfma_f32_16x16x32_bf16 v[24:27], v[168:171], a[104:107], v[24:27]
s_and_b32 s71, s71, 3
ds_read_b64_tr_b16 v[236:237], v11 offset:8192
ds_read_b64_tr_b16 v[238:239], v11 offset:10240
v_mfma_f32_16x16x32_bf16 v[24:27], v[184:187], a[108:111], v[24:27]
s_add_u32 s71, s71, s78
s_lshl_b32 s71, s71, 18
s_add_u32 s71, s71, s94
s_add_u32 m0, s77, 32768
s_add_u32 s72, s71, 0
buffer_load_dwordx4 v15, s[24:27], s72 offen lds
v_mfma_f32_16x16x32_bf16 v[40:43], v[184:187], a[124:127], v[40:43]
s_add_u32 s72, s71, 15360
ds_read_b64_tr_b16 v[240:241], v8 offset:12288
v_mfma_f32_16x16x32_bf16 v[40:43], v[168:171], a[120:123], v[40:43]
ds_read_b64_tr_b16 v[242:243], v8 offset:14336
ds_read_b64_tr_b16 v[244:245], v9 offset:12288
v_mfma_f32_16x16x32_bf16 v[40:43], v[152:155], a[116:119], v[40:43]
buffer_load_dwordx4 v15, s[24:27], s72 offen offset:1024 lds
v_mfma_f32_16x16x32_bf16 v[40:43], v[136:139], a[112:115], v[40:43]
s_add_u32 s72, s71, 30720
ds_read_b64_tr_b16 v[246:247], v9 offset:14336
ds_read_b64_tr_b16 v[248:249], v10 offset:12288
v_mfma_f32_16x16x32_bf16 v[44:47], v[140:143], a[112:115], v[44:47]
ds_read_b64_tr_b16 v[250:251], v10 offset:14336
ds_read_b64_tr_b16 v[252:253], v11 offset:12288
v_mfma_f32_16x16x32_bf16 v[44:47], v[156:159], a[116:119], v[44:47]
buffer_load_dwordx4 v15, s[24:27], s72 offen offset:2048 lds
v_mfma_f32_16x16x32_bf16 v[44:47], v[172:175], a[120:123], v[44:47]
s_add_u32 s72, s71, 46080
ds_read_b64_tr_b16 v[254:255], v11 offset:14336
v_mfma_f32_16x16x32_bf16 v[44:47], v[188:191], a[124:127], v[44:47]
v_mfma_f32_16x16x32_bf16 v[28:31], v[188:191], a[108:111], v[28:31]
buffer_load_dwordx4 v15, s[24:27], s72 offen offset:3072 lds
v_mfma_f32_16x16x32_bf16 v[28:31], v[172:175], a[104:107], v[28:31]
s_add_u32 s69, s61, 2
v_mfma_f32_16x16x32_bf16 v[28:31], v[156:159], a[100:103], v[28:31]
s_waitcnt vmcnt(12) lgkmcnt(0)
s_and_b32 s69, s69, 3
s_add_u32 s69, s69, s78
s_lshl_b32 s69, s69, 12
s_add_u32 s69, s69, s95
buffer_load_dwordx4 a[64:67], v1, s[44:47], s69 offen sc1
v_mfma_f32_16x16x32_bf16 v[28:31], v[140:143], a[96:99], v[28:31]
s_barrier
v_mfma_f32_16x16x32_bf16 v[16:19], v[192:195], a[0:3], v[16:19]
ds_read_b64_tr_b16 v[128:129], v8 offset:16384
ds_read_b64_tr_b16 v[130:131], v8 offset:18432
v_sub_f32 v112, 1.0, v6
v_mfma_f32_16x16x32_bf16 v[16:19], v[208:211], a[4:7], v[16:19]
buffer_load_dwordx4 a[68:71], v1, s[44:47], s69 offen offset:1024 sc1
v_sub_f32 v113, 1.0, v7
v_mfma_f32_16x16x32_bf16 v[16:19], v[224:227], a[8:11], v[16:19]
ds_read_b64_tr_b16 v[132:133], v9 offset:16384
ds_read_b64_tr_b16 v[134:135], v9 offset:18432
v_lshlrev_b32 v48, 16, v80
v_mfma_f32_16x16x32_bf16 v[16:19], v[240:243], a[12:15], v[16:19]
ds_read_b64_tr_b16 v[136:137], v10 offset:16384
ds_read_b64_tr_b16 v[138:139], v10 offset:18432
v_lshlrev_b32 v114, 16, v88
v_mfma_f32_16x16x32_bf16 v[32:35], v[240:243], a[28:31], v[32:35]
buffer_load_dwordx4 a[72:75], v1, s[44:47], s69 offen offset:2048 sc1
v_mul_f32 v48, v48, v112
v_mfma_f32_16x16x32_bf16 v[32:35], v[224:227], a[24:27], v[32:35]
ds_read_b64_tr_b16 v[140:141], v11 offset:16384
ds_read_b64_tr_b16 v[142:143], v11 offset:18432
v_mul_f32 v48, v48, v114
v_mfma_f32_16x16x32_bf16 v[32:35], v[208:211], a[20:23], v[32:35]
ds_read_b64_tr_b16 v[144:145], v8 offset:20480
v_and_b32 v49, 0xffff0000, v80
v_mfma_f32_16x16x32_bf16 v[32:35], v[192:195], a[16:19], v[32:35]
buffer_load_dwordx4 a[76:79], v1, s[44:47], s69 offen offset:3072 sc1
v_and_b32 v115, 0xffff0000, v88
v_mfma_f32_16x16x32_bf16 v[36:39], v[196:199], a[16:19], v[36:39]
s_add_u32 s69, s69, 0x20000
ds_read_b64_tr_b16 v[146:147], v8 offset:22528
ds_read_b64_tr_b16 v[148:149], v9 offset:20480
v_mul_f32 v49, v49, v112
v_mfma_f32_16x16x32_bf16 v[36:39], v[212:215], a[20:23], v[36:39]
ds_read_b64_tr_b16 v[150:151], v9 offset:22528
ds_read_b64_tr_b16 v[152:153], v10 offset:20480
v_mul_f32 v49, v49, v115
v_mfma_f32_16x16x32_bf16 v[36:39], v[228:231], a[24:27], v[36:39]
buffer_load_dwordx4 a[80:83], v1, s[44:47], s69 offen sc1
v_lshlrev_b32 v50, 16, v81
v_mfma_f32_16x16x32_bf16 v[36:39], v[244:247], a[28:31], v[36:39]
ds_read_b64_tr_b16 v[154:155], v10 offset:22528
ds_read_b64_tr_b16 v[156:157], v11 offset:20480
v_lshlrev_b32 v114, 16, v89
v_mfma_f32_16x16x32_bf16 v[20:23], v[244:247], a[12:15], v[20:23]
ds_read_b64_tr_b16 v[158:159], v11 offset:22528
v_mul_f32 v50, v50, v112
v_mfma_f32_16x16x32_bf16 v[20:23], v[228:231], a[8:11], v[20:23]
buffer_load_dwordx4 a[84:87], v1, s[44:47], s69 offen offset:1024 sc1
v_mul_f32 v50, v50, v114
v_mfma_f32_16x16x32_bf16 v[20:23], v[212:215], a[4:7], v[20:23]
ds_read_b64_tr_b16 v[160:161], v8 offset:24576
ds_read_b64_tr_b16 v[162:163], v8 offset:26624
v_and_b32 v51, 0xffff0000, v81
v_mfma_f32_16x16x32_bf16 v[20:23], v[196:199], a[0:3], v[20:23]
buffer_load_dwordx4 a[88:91], v1, s[44:47], s69 offen offset:2048 sc1
v_and_b32 v115, 0xffff0000, v89
v_mfma_f32_16x16x32_bf16 v[24:27], v[200:203], a[0:3], v[24:27]
ds_read_b64_tr_b16 v[164:165], v9 offset:24576
ds_read_b64_tr_b16 v[166:167], v9 offset:26624
v_mul_f32 v51, v51, v112
v_mfma_f32_16x16x32_bf16 v[24:27], v[216:219], a[4:7], v[24:27]
ds_read_b64_tr_b16 v[168:169], v10 offset:24576
ds_read_b64_tr_b16 v[170:171], v10 offset:26624
v_mul_f32 v51, v51, v115
v_mfma_f32_16x16x32_bf16 v[24:27], v[232:235], a[8:11], v[24:27]
buffer_load_dwordx4 a[92:95], v1, s[44:47], s69 offen offset:3072 sc1
v_lshlrev_b32 v52, 16, v82
v_mfma_f32_16x16x32_bf16 v[24:27], v[248:251], a[12:15], v[24:27]
s_add_u32 s71, s61, 3
ds_read_b64_tr_b16 v[172:173], v11 offset:24576
ds_read_b64_tr_b16 v[174:175], v11 offset:26624
v_lshlrev_b32 v114, 16, v90
v_mfma_f32_16x16x32_bf16 v[40:43], v[248:251], a[28:31], v[40:43]
s_and_b32 s71, s71, 3
ds_read_b64_tr_b16 v[176:177], v8 offset:28672
v_mul_f32 v52, v52, v112
v_mfma_f32_16x16x32_bf16 v[40:43], v[232:235], a[24:27], v[40:43]
s_add_u32 s71, s71, s78
s_lshl_b32 s71, s71, 18
s_add_u32 s71, s71, s94
s_add_u32 m0, s77, 49152
s_add_u32 s72, s71, 0
buffer_load_dwordx4 v15, s[24:27], s72 offen lds
v_mfma_f32_16x16x32_bf16 v[40:43], v[216:219], a[20:23], v[40:43]
s_add_u32 s72, s71, 15360
ds_read_b64_tr_b16 v[178:179], v8 offset:30720
ds_read_b64_tr_b16 v[180:181], v9 offset:28672
v_mul_f32 v52, v52, v114
v_mfma_f32_16x16x32_bf16 v[40:43], v[200:203], a[16:19], v[40:43]
ds_read_b64_tr_b16 v[182:183], v9 offset:30720
ds_read_b64_tr_b16 v[184:185], v10 offset:28672
v_and_b32 v53, 0xffff0000, v82
v_mfma_f32_16x16x32_bf16 v[44:47], v[204:207], a[16:19], v[44:47]
buffer_load_dwordx4 v15, s[24:27], s72 offen offset:1024 lds
v_and_b32 v115, 0xffff0000, v90
v_mfma_f32_16x16x32_bf16 v[44:47], v[220:223], a[20:23], v[44:47]
s_add_u32 s72, s71, 30720
ds_read_b64_tr_b16 v[186:187], v10 offset:30720
ds_read_b64_tr_b16 v[188:189], v11 offset:28672
v_mul_f32 v53, v53, v112
v_mfma_f32_16x16x32_bf16 v[44:47], v[236:239], a[24:27], v[44:47]
ds_read_b64_tr_b16 v[190:191], v11 offset:30720
v_mul_f32 v53, v53, v115
v_mfma_f32_16x16x32_bf16 v[44:47], v[252:255], a[28:31], v[44:47]
buffer_load_dwordx4 v15, s[24:27], s72 offen offset:2048 lds
v_lshlrev_b32 v54, 16, v83
v_mfma_f32_16x16x32_bf16 v[28:31], v[252:255], a[12:15], v[28:31]
s_add_u32 s72, s71, 46080
v_lshlrev_b32 v114, 16, v91
v_mfma_f32_16x16x32_bf16 v[28:31], v[236:239], a[8:11], v[28:31]
v_mul_f32 v54, v54, v112
v_mfma_f32_16x16x32_bf16 v[28:31], v[220:223], a[4:7], v[28:31]
s_waitcnt vmcnt(11) lgkmcnt(0)
buffer_load_dwordx4 v15, s[24:27], s72 offen offset:3072 lds
v_mul_f32 v54, v54, v114
v_mfma_f32_16x16x32_bf16 v[28:31], v[204:207], a[0:3], v[28:31]
s_barrier
v_and_b32 v55, 0xffff0000, v83
v_mfma_f32_16x16x32_bf16 v[16:19], v[128:131], a[32:35], v[16:19]
s_add_u32 s69, s61, 3
s_and_b32 s69, s69, 3
s_add_u32 s69, s69, s78
s_lshl_b32 s69, s69, 12
s_add_u32 s69, s69, s95
buffer_load_dwordx4 a[96:99], v1, s[44:47], s69 offen sc1
v_mfma_f32_16x16x32_bf16 v[16:19], v[144:147], a[36:39], v[16:19]
ds_read_b64_tr_b16 v[192:193], v8 offset:32768
ds_read_b64_tr_b16 v[194:195], v8 offset:34816
v_and_b32 v115, 0xffff0000, v91
v_mfma_f32_16x16x32_bf16 v[16:19], v[160:163], a[40:43], v[16:19]
ds_read_b64_tr_b16 v[196:197], v9 offset:32768
ds_read_b64_tr_b16 v[198:199], v9 offset:34816
v_mul_f32 v55, v55, v112
v_mfma_f32_16x16x32_bf16 v[16:19], v[176:179], a[44:47], v[16:19]
buffer_load_dwordx4 a[100:103], v1, s[44:47], s69 offen offset:1024 sc1
v_mul_f32 v55, v55, v115
v_mfma_f32_16x16x32_bf16 v[32:35], v[176:179], a[60:63], v[32:35]
ds_read_b64_tr_b16 v[200:201], v10 offset:32768
ds_read_b64_tr_b16 v[202:203], v10 offset:34816
v_lshlrev_b32 v56, 16, v84
v_mfma_f32_16x16x32_bf16 v[32:35], v[160:163], a[56:59], v[32:35]
ds_read_b64_tr_b16 v[204:205], v11 offset:32768
ds_read_b64_tr_b16 v[206:207], v11 offset:34816
v_lshlrev_b32 v114, 16, v92
v_mfma_f32_16x16x32_bf16 v[32:35], v[144:147], a[52:55], v[32:35]
buffer_load_dwordx4 a[104:107], v1, s[44:47], s69 offen offset:2048 sc1
v_mul_f32 v56, v56, v112
v_mfma_f32_16x16x32_bf16 v[32:35], v[128:131], a[48:51], v[32:35]
ds_read_b64_tr_b16 v[208:209], v8 offset:36864
ds_read_b64_tr_b16 v[210:211], v8 offset:38912
v_mul_f32 v56, v56, v114
v_mfma_f32_16x16x32_bf16 v[36:39], v[132:135], a[48:51], v[36:39]
ds_read_b64_tr_b16 v[212:213], v9 offset:36864
ds_read_b64_tr_b16 v[214:215], v9 offset:38912
v_and_b32 v57, 0xffff0000, v84
v_mfma_f32_16x16x32_bf16 v[36:39], v[148:151], a[52:55], v[36:39]
buffer_load_dwordx4 a[108:111], v1, s[44:47], s69 offen offset:3072 sc1
v_and_b32 v115, 0xffff0000, v92
v_mfma_f32_16x16x32_bf16 v[36:39], v[164:167], a[56:59], v[36:39]
s_add_u32 s69, s69, 0x20000
ds_read_b64_tr_b16 v[216:217], v10 offset:36864
ds_read_b64_tr_b16 v[218:219], v10 offset:38912
v_mul_f32 v57, v57, v112
v_mfma_f32_16x16x32_bf16 v[36:39], v[180:183], a[60:63], v[36:39]
ds_read_b64_tr_b16 v[220:221], v11 offset:36864
ds_read_b64_tr_b16 v[222:223], v11 offset:38912
v_mul_f32 v57, v57, v115
v_mfma_f32_16x16x32_bf16 v[20:23], v[180:183], a[44:47], v[20:23]
buffer_load_dwordx4 a[112:115], v1, s[44:47], s69 offen sc1
v_lshlrev_b32 v58, 16, v85
v_mfma_f32_16x16x32_bf16 v[20:23], v[164:167], a[40:43], v[20:23]
ds_read_b64_tr_b16 v[224:225], v8 offset:40960
v_lshlrev_b32 v114, 16, v93
v_mfma_f32_16x16x32_bf16 v[20:23], v[148:151], a[36:39], v[20:23]
ds_read_b64_tr_b16 v[226:227], v8 offset:43008
ds_read_b64_tr_b16 v[228:229], v9 offset:40960
v_mul_f32 v58, v58, v112
v_mfma_f32_16x16x32_bf16 v[20:23], v[132:135], a[32:35], v[20:23]
buffer_load_dwordx4 a[116:119], v1, s[44:47], s69 offen offset:1024 sc1
v_mul_f32 v58, v58, v114
v_mfma_f32_16x16x32_bf16 v[24:27], v[136:139], a[32:35], v[24:27]
ds_read_b64_tr_b16 v[230:231], v9 offset:43008
ds_read_b64_tr_b16 v[232:233], v10 offset:40960
v_and_b32 v59, 0xffff0000, v85
v_mfma_f32_16x16x32_bf16 v[24:27], v[152:155], a[36:39], v[24:27]
buffer_load_dwordx4 a[120:123], v1, s[44:47], s69 offen offset:2048 sc1
v_and_b32 v115, 0xffff0000, v93
v_mfma_f32_16x16x32_bf16 v[24:27], v[168:171], a[40:43], v[24:27]
ds_read_b64_tr_b16 v[234:235], v10 offset:43008
ds_read_b64_tr_b16 v[236:237], v11 offset:40960
v_mul_f32 v59, v59, v112
v_mfma_f32_16x16x32_bf16 v[24:27], v[184:187], a[44:47], v[24:27]
ds_read_b64_tr_b16 v[238:239], v11 offset:43008
ds_read_b64_tr_b16 v[240:241], v8 offset:45056
v_mul_f32 v59, v59, v115
v_mfma_f32_16x16x32_bf16 v[40:43], v[184:187], a[60:63], v[40:43]
buffer_load_dwordx4 a[124:127], v1, s[44:47], s69 offen offset:3072 sc1
v_lshlrev_b32 v60, 16, v86
v_mfma_f32_16x16x32_bf16 v[40:43], v[168:171], a[56:59], v[40:43]
s_add_u32 s79, s59, 32
ds_read_b64_tr_b16 v[242:243], v8 offset:47104
ds_read_b64_tr_b16 v[244:245], v9 offset:45056
v_lshlrev_b32 v114, 16, v94
v_mfma_f32_16x16x32_bf16 v[40:43], v[152:155], a[52:55], v[40:43]
s_and_b32 s79, s79, 28
ds_read_b64_tr_b16 v[246:247], v9 offset:47104
ds_read_b64_tr_b16 v[248:249], v10 offset:45056
v_mul_f32 v60, v60, v112
v_mfma_f32_16x16x32_bf16 v[40:43], v[136:139], a[48:51], v[40:43]
s_add_u32 s71, s61, 0
s_and_b32 s71, s71, 3
s_add_u32 s71, s71, s79
s_lshl_b32 s71, s71, 18
s_add_u32 s71, s71, s94
s_add_u32 m0, s77, 0
s_add_u32 s72, s71, 0
buffer_load_dwordx4 v15, s[24:27], s72 offen lds
v_mfma_f32_16x16x32_bf16 v[44:47], v[140:143], a[48:51], v[44:47]
s_add_u32 s72, s71, 15360
ds_read_b64_tr_b16 v[250:251], v10 offset:47104
ds_read_b64_tr_b16 v[252:253], v11 offset:45056
v_mul_f32 v60, v60, v114
v_mfma_f32_16x16x32_bf16 v[44:47], v[156:159], a[52:55], v[44:47]
ds_read_b64_tr_b16 v[254:255], v11 offset:47104
v_and_b32 v61, 0xffff0000, v86
v_mfma_f32_16x16x32_bf16 v[44:47], v[172:175], a[56:59], v[44:47]
buffer_load_dwordx4 v15, s[24:27], s72 offen offset:1024 lds
v_and_b32 v115, 0xffff0000, v94
v_mfma_f32_16x16x32_bf16 v[44:47], v[188:191], a[60:63], v[44:47]
s_add_u32 s72, s71, 30720
v_mul_f32 v61, v61, v112
v_mfma_f32_16x16x32_bf16 v[28:31], v[188:191], a[44:47], v[28:31]
v_mul_f32 v61, v61, v115
v_mfma_f32_16x16x32_bf16 v[28:31], v[172:175], a[40:43], v[28:31]
buffer_load_dwordx4 v15, s[24:27], s72 offen offset:2048 lds
v_lshlrev_b32 v62, 16, v87
v_mfma_f32_16x16x32_bf16 v[28:31], v[156:159], a[36:39], v[28:31]
s_waitcnt vmcnt(11) lgkmcnt(0)
v_lshlrev_b32 v114, 16, v95
v_mfma_f32_16x16x32_bf16 v[28:31], v[140:143], a[32:35], v[28:31]
s_barrier
v_mul_f32 v62, v62, v112
v_mfma_f32_16x16x32_bf16 v[16:19], v[192:195], a[64:67], v[16:19]
s_add_u32 s72, s71, 46080
buffer_load_dwordx4 v15, s[24:27], s72 offen offset:3072 lds
v_mul_f32 v62, v62, v114
v_mfma_f32_16x16x32_bf16 v[16:19], v[208:211], a[68:71], v[16:19]
ds_read_b64_tr_b16 v[128:129], v8 offset:49152
ds_read_b64_tr_b16 v[130:131], v8 offset:51200
v_and_b32 v63, 0xffff0000, v87
v_mfma_f32_16x16x32_bf16 v[16:19], v[224:227], a[72:75], v[16:19]
ds_read_b64_tr_b16 v[132:133], v9 offset:49152
ds_read_b64_tr_b16 v[134:135], v9 offset:51200
v_and_b32 v115, 0xffff0000, v95
v_mfma_f32_16x16x32_bf16 v[16:19], v[240:243], a[76:79], v[16:19]
s_waitcnt vmcnt(48)
v_cmp_gt_u32 vcc, 2, v3
s_cbranch_vccnz Lspin124
Lback125:
s_add_u32 s69, s61, 0
s_and_b32 s69, s69, 3
s_add_u32 s69, s69, s79
s_lshl_b32 s69, s69, 12
s_add_u32 s69, s69, s95
buffer_load_dwordx4 a[0:3], v1, s[44:47], s69 offen sc1
v_mfma_f32_16x16x32_bf16 v[32:35], v[240:243], a[92:95], v[32:35]
ds_read_b64_tr_b16 v[136:137], v10 offset:49152
ds_read_b64_tr_b16 v[138:139], v10 offset:51200
v_mul_f32 v63, v63, v112
v_mfma_f32_16x16x32_bf16 v[32:35], v[224:227], a[88:91], v[32:35]
buffer_load_dwordx4 a[4:7], v1, s[44:47], s69 offen offset:1024 sc1
v_mul_f32 v63, v63, v115
v_mfma_f32_16x16x32_bf16 v[32:35], v[208:211], a[84:87], v[32:35]
ds_read_b64_tr_b16 v[140:141], v11 offset:49152
ds_read_b64_tr_b16 v[142:143], v11 offset:51200
v_lshlrev_b32 v64, 16, v96
v_mfma_f32_16x16x32_bf16 v[32:35], v[192:195], a[80:83], v[32:35]
ds_read_b64_tr_b16 v[144:145], v8 offset:53248
ds_read_b64_tr_b16 v[146:147], v8 offset:55296
v_lshlrev_b32 v114, 16, v104
v_mfma_f32_16x16x32_bf16 v[36:39], v[196:199], a[80:83], v[36:39]
buffer_load_dwordx4 a[8:11], v1, s[44:47], s69 offen offset:2048 sc1
v_mul_f32 v64, v64, v113
v_mfma_f32_16x16x32_bf16 v[36:39], v[212:215], a[84:87], v[36:39]
ds_read_b64_tr_b16 v[148:149], v9 offset:53248
ds_read_b64_tr_b16 v[150:151], v9 offset:55296
v_mul_f32 v64, v64, v114
v_mfma_f32_16x16x32_bf16 v[36:39], v[228:231], a[88:91], v[36:39]
ds_read_b64_tr_b16 v[152:153], v10 offset:53248
ds_read_b64_tr_b16 v[154:155], v10 offset:55296
v_and_b32 v65, 0xffff0000, v96
v_mfma_f32_16x16x32_bf16 v[36:39], v[244:247], a[92:95], v[36:39]
buffer_load_dwordx4 a[12:15], v1, s[44:47], s69 offen offset:3072 sc1
v_and_b32 v115, 0xffff0000, v104
v_mfma_f32_16x16x32_bf16 v[20:23], v[244:247], a[76:79], v[20:23]
s_add_u32 s69, s69, 0x20000
ds_read_b64_tr_b16 v[156:157], v11 offset:53248
ds_read_b64_tr_b16 v[158:159], v11 offset:55296
v_mul_f32 v65, v65, v113
v_mfma_f32_16x16x32_bf16 v[20:23], v[228:231], a[72:75], v[20:23]
ds_read_b64_tr_b16 v[160:161], v8 offset:57344
v_mul_f32 v65, v65, v115
v_mfma_f32_16x16x32_bf16 v[20:23], v[212:215], a[68:71], v[20:23]
buffer_load_dwordx4 a[16:19], v1, s[44:47], s69 offen sc1
v_lshlrev_b32 v66, 16, v97
v_mfma_f32_16x16x32_bf16 v[20:23], v[196:199], a[64:67], v[20:23]
ds_read_b64_tr_b16 v[162:163], v8 offset:59392
ds_read_b64_tr_b16 v[164:165], v9 offset:57344
v_lshlrev_b32 v114, 16, v105
v_mfma_f32_16x16x32_bf16 v[24:27], v[200:203], a[64:67], v[24:27]
ds_read_b64_tr_b16 v[166:167], v9 offset:59392
ds_read_b64_tr_b16 v[168:169], v10 offset:57344
v_mul_f32 v66, v66, v113
v_mfma_f32_16x16x32_bf16 v[24:27], v[216:219], a[68:71], v[24:27]
buffer_load_dwordx4 a[20:23], v1, s[44:47], s69 offen offset:1024 sc1
v_mul_f32 v66, v66, v114
v_mfma_f32_16x16x32_bf16 v[24:27], v[232:235], a[72:75], v[24:27]
ds_read_b64_tr_b16 v[170:171], v10 offset:59392
ds_read_b64_tr_b16 v[172:173], v11 offset:57344
v_and_b32 v67, 0xffff0000, v97
v_mfma_f32_16x16x32_bf16 v[24:27], v[248:251], a[76:79], v[24:27]
ds_read_b64_tr_b16 v[174:175], v11 offset:59392
ds_read_b64_tr_b16 v[176:177], v8 offset:61440
v_and_b32 v115, 0xffff0000, v105
v_mfma_f32_16x16x32_bf16 v[40:43], v[248:251], a[92:95], v[40:43]
buffer_load_dwordx4 a[24:27], v1, s[44:47], s69 offen offset:2048 sc1
v_mul_f32 v67, v67, v113
v_mfma_f32_16x16x32_bf16 v[40:43], v[232:235], a[88:91], v[40:43]
ds_read_b64_tr_b16 v[178:179], v8 offset:63488
ds_read_b64_tr_b16 v[180:181], v9 offset:61440
v_mul_f32 v67, v67, v115
v_mfma_f32_16x16x32_bf16 v[40:43], v[216:219], a[84:87], v[40:43]
buffer_load_dwordx4 a[28:31], v1, s[44:47], s69 offen offset:3072 sc1
v_lshlrev_b32 v68, 16, v98
v_mfma_f32_16x16x32_bf16 v[40:43], v[200:203], a[80:83], v[40:43]
s_add_u32 s71, s61, 1
ds_read_b64_tr_b16 v[182:183], v9 offset:63488
ds_read_b64_tr_b16 v[184:185], v10 offset:61440
v_lshlrev_b32 v114, 16, v106
v_mfma_f32_16x16x32_bf16 v[44:47], v[204:207], a[80:83], v[44:47]
s_and_b32 s71, s71, 3
ds_read_b64_tr_b16 v[186:187], v10 offset:63488
ds_read_b64_tr_b16 v[188:189], v11 offset:61440
v_mul_f32 v68, v68, v113
v_mfma_f32_16x16x32_bf16 v[44:47], v[220:223], a[84:87], v[44:47]
s_add_u32 s71, s71, s79
s_lshl_b32 s71, s71, 18
s_add_u32 s71, s71, s94
s_add_u32 m0, s77, 16384
s_add_u32 s72, s71, 0
buffer_load_dwordx4 v15, s[24:27], s72 offen lds
v_mfma_f32_16x16x32_bf16 v[44:47], v[236:239], a[88:91], v[44:47]
s_add_u32 s72, s71, 15360
ds_read_b64_tr_b16 v[190:191], v11 offset:63488
v_mul_f32 v68, v68, v114
v_mfma_f32_16x16x32_bf16 v[44:47], v[252:255], a[92:95], v[44:47]
v_and_b32 v69, 0xffff0000, v98
v_mfma_f32_16x16x32_bf16 v[28:31], v[252:255], a[76:79], v[28:31]
buffer_load_dwordx4 v15, s[24:27], s72 offen offset:1024 lds
v_and_b32 v115, 0xffff0000, v106
v_mfma_f32_16x16x32_bf16 v[28:31], v[236:239], a[72:75], v[28:31]
s_add_u32 s72, s71, 30720
v_mul_f32 v69, v69, v113
v_mfma_f32_16x16x32_bf16 v[28:31], v[220:223], a[68:71], v[28:31]
s_waitcnt vmcnt(10) lgkmcnt(0)
v_mul_f32 v69, v69, v115
v_mfma_f32_16x16x32_bf16 v[28:31], v[204:207], a[64:67], v[28:31]
s_barrier
buffer_load_dwordx4 v15, s[24:27], s72 offen offset:2048 lds
v_lshlrev_b32 v70, 16, v99
v_mfma_f32_16x16x32_bf16 v[16:19], v[128:131], a[96:99], v[16:19]
s_add_u32 s72, s71, 46080
ds_read_b64_tr_b16 v[192:193], v8 offset:0
ds_read_b64_tr_b16 v[194:195], v8 offset:2048
v_lshlrev_b32 v114, 16, v107
v_mfma_f32_16x16x32_bf16 v[16:19], v[144:147], a[100:103], v[16:19]
ds_read_b64_tr_b16 v[196:197], v9 offset:0
ds_read_b64_tr_b16 v[198:199], v9 offset:2048
v_mul_f32 v70, v70, v113
v_mfma_f32_16x16x32_bf16 v[16:19], v[160:163], a[104:107], v[16:19]
buffer_load_dwordx4 v15, s[24:27], s72 offen offset:3072 lds
v_mul_f32 v70, v70, v114
v_mfma_f32_16x16x32_bf16 v[16:19], v[176:179], a[108:111], v[16:19]
s_add_u32 s69, s61, 1
ds_read_b64_tr_b16 v[200:201], v10 offset:0
ds_read_b64_tr_b16 v[202:203], v10 offset:2048
v_and_b32 v71, 0xffff0000, v99
v_mfma_f32_16x16x32_bf16 v[32:35], v[176:179], a[124:127], v[32:35]
s_and_b32 s69, s69, 3
ds_read_b64_tr_b16 v[204:205], v11 offset:0
ds_read_b64_tr_b16 v[206:207], v11 offset:2048
v_and_b32 v115, 0xffff0000, v107
v_mfma_f32_16x16x32_bf16 v[32:35], v[160:163], a[120:123], v[32:35]
s_add_u32 s69, s69, s79
s_lshl_b32 s69, s69, 12
s_add_u32 s69, s69, s95
buffer_load_dwordx4 a[32:35], v1, s[44:47], s69 offen sc1
v_mfma_f32_16x16x32_bf16 v[32:35], v[144:147], a[116:119], v[32:35]
ds_read_b64_tr_b16 v[208:209], v8 offset:4096
v_mul_f32 v71, v71, v113
v_mfma_f32_16x16x32_bf16 v[32:35], v[128:131], a[112:115], v[32:35]
buffer_load_dwordx4 a[36:39], v1, s[44:47], s69 offen offset:1024 sc1
v_mul_f32 v71, v71, v115
v_mfma_f32_16x16x32_bf16 v[36:39], v[132:135], a[112:115], v[36:39]
ds_read_b64_tr_b16 v[210:211], v8 offset:6144
ds_read_b64_tr_b16 v[212:213], v9 offset:4096
v_lshlrev_b32 v72, 16, v100
v_mfma_f32_16x16x32_bf16 v[36:39], v[148:151], a[116:119], v[36:39]
ds_read_b64_tr_b16 v[214:215], v9 offset:6144
ds_read_b64_tr_b16 v[216:217], v10 offset:4096
v_lshlrev_b32 v114, 16, v108
v_mfma_f32_16x16x32_bf16 v[36:39], v[164:167], a[120:123], v[36:39]
buffer_load_dwordx4 a[40:43], v1, s[44:47], s69 offen offset:2048 sc1
v_mul_f32 v72, v72, v113
v_mfma_f32_16x16x32_bf16 v[36:39], v[180:183], a[124:127], v[36:39]
ds_read_b64_tr_b16 v[218:219], v10 offset:6144
ds_read_b64_tr_b16 v[220:221], v11 offset:4096
v_mul_f32 v72, v72, v114
v_mfma_f32_16x16x32_bf16 v[20:23], v[180:183], a[108:111], v[20:23]
ds_read_b64_tr_b16 v[222:223], v11 offset:6144
v_and_b32 v73, 0xffff0000, v100
v_mfma_f32_16x16x32_bf16 v[20:23], v[164:167], a[104:107], v[20:23]
buffer_load_dwordx4 a[44:47], v1, s[44:47], s69 offen offset:3072 sc1
v_and_b32 v115, 0xffff0000, v108
v_mfma_f32_16x16x32_bf16 v[20:23], v[148:151], a[100:103], v[20:23]
s_add_u32 s69, s69, 0x20000
ds_read_b64_tr_b16 v[224:225], v8 offset:8192
ds_read_b64_tr_b16 v[226:227], v8 offset:10240
v_mul_f32 v73, v73, v113
v_mfma_f32_16x16x32_bf16 v[20:23], v[132:135], a[96:99], v[20:23]
ds_read_b64_tr_b16 v[228:229], v9 offset:8192
ds_read_b64_tr_b16 v[230:231], v9 offset:10240
v_mul_f32 v73, v73, v115
v_mfma_f32_16x16x32_bf16 v[24:27], v[136:139], a[96:99], v[24:27]
buffer_load_dwordx4 a[48:51], v1, s[44:47], s69 offen sc1
v_lshlrev_b32 v74, 16, v101
v_mfma_f32_16x16x32_bf16 v[24:27], v[152:155], a[100:103], v[24:27]
ds_read_b64_tr_b16 v[232:233], v10 offset:8192
ds_read_b64_tr_b16 v[234:235], v10 offset:10240
v_lshlrev_b32 v114, 16, v109
v_mfma_f32_16x16x32_bf16 v[24:27], v[168:171], a[104:107], v[24:27]
ds_read_b64_tr_b16 v[236:237], v11 offset:8192
ds_read_b64_tr_b16 v[238:239], v11 offset:10240
v_mul_f32 v74, v74, v113
v_mfma_f32_16x16x32_bf16 v[24:27], v[184:187], a[108:111], v[24:27]
buffer_load_dwordx4 a[52:55], v1, s[44:47], s69 offen offset:1024 sc1
v_mul_f32 v74, v74, v114
v_mfma_f32_16x16x32_bf16 v[40:43], v[184:187], a[124:127], v[40:43]
ds_read_b64_tr_b16 v[240:241], v8 offset:12288
v_and_b32 v75, 0xffff0000, v101
v_mfma_f32_16x16x32_bf16 v[40:43], v[168:171], a[120:123], v[40:43]
ds_read_b64_tr_b16 v[242:243], v8 offset:14336
ds_read_b64_tr_b16 v[244:245], v9 offset:12288
v_and_b32 v115, 0xffff0000, v109
v_mfma_f32_16x16x32_bf16 v[40:43], v[152:155], a[116:119], v[40:43]
buffer_load_dwordx4 a[56:59], v1, s[44:47], s69 offen offset:2048 sc1
v_mul_f32 v75, v75, v113
v_mfma_f32_16x16x32_bf16 v[40:43], v[136:139], a[112:115], v[40:43]
ds_read_b64_tr_b16 v[246:247], v9 offset:14336
ds_read_b64_tr_b16 v[248:249], v10 offset:12288
v_mul_f32 v75, v75, v115
v_mfma_f32_16x16x32_bf16 v[44:47], v[140:143], a[112:115], v[44:47]
buffer_load_dwordx4 a[60:63], v1, s[44:47], s69 offen offset:3072 sc1
v_lshlrev_b32 v76, 16, v102
v_mfma_f32_16x16x32_bf16 v[44:47], v[156:159], a[116:119], v[44:47]
s_add_u32 s71, s61, 2
ds_read_b64_tr_b16 v[250:251], v10 offset:14336
ds_read_b64_tr_b16 v[252:253], v11 offset:12288
v_lshlrev_b32 v114, 16, v110
v_mfma_f32_16x16x32_bf16 v[44:47], v[172:175], a[120:123], v[44:47]
s_and_b32 s71, s71, 3
ds_read_b64_tr_b16 v[254:255], v11 offset:14336
v_mul_f32 v76, v76, v113
v_mfma_f32_16x16x32_bf16 v[44:47], v[188:191], a[124:127], v[44:47]
s_add_u32 s71, s71, s79
s_lshl_b32 s71, s71, 18
s_add_u32 s71, s71, s94
s_add_u32 m0, s77, 32768
s_add_u32 s72, s71, 0
buffer_load_dwordx4 v15, s[24:27], s72 offen lds
v_mfma_f32_16x16x32_bf16 v[28:31], v[188:191], a[108:111], v[28:31]
s_add_u32 s72, s71, 15360
v_mul_f32 v76, v76, v114
v_mfma_f32_16x16x32_bf16 v[28:31], v[172:175], a[104:107], v[28:31]
v_and_b32 v77, 0xffff0000, v102
v_mfma_f32_16x16x32_bf16 v[28:31], v[156:159], a[100:103], v[28:31]
s_waitcnt vmcnt(9) lgkmcnt(0)
buffer_load_dwordx4 v15, s[24:27], s72 offen offset:1024 lds
v_and_b32 v115, 0xffff0000, v110
v_mfma_f32_16x16x32_bf16 v[28:31], v[140:143], a[96:99], v[28:31]
s_barrier
v_mul_f32 v77, v77, v113
v_mfma_f32_16x16x32_bf16 v[16:19], v[192:195], a[0:3], v[16:19]
s_add_u32 s72, s71, 30720
ds_read_b64_tr_b16 v[128:129], v8 offset:16384
ds_read_b64_tr_b16 v[130:131], v8 offset:18432
v_mul_f32 v77, v77, v115
v_mfma_f32_16x16x32_bf16 v[16:19], v[208:211], a[4:7], v[16:19]
buffer_load_dwordx4 v15, s[24:27], s72 offen offset:2048 lds
v_lshlrev_b32 v78, 16, v103
v_mfma_f32_16x16x32_bf16 v[16:19], v[224:227], a[8:11], v[16:19]
s_add_u32 s72, s71, 46080
ds_read_b64_tr_b16 v[132:133], v9 offset:16384
ds_read_b64_tr_b16 v[134:135], v9 offset:18432
v_lshlrev_b32 v114, 16, v111
v_mfma_f32_16x16x32_bf16 v[16:19], v[240:243], a[12:15], v[16:19]
ds_read_b64_tr_b16 v[136:137], v10 offset:16384
ds_read_b64_tr_b16 v[138:139], v10 offset:18432
v_mul_f32 v78, v78, v113
v_mfma_f32_16x16x32_bf16 v[32:35], v[240:243], a[28:31], v[32:35]
buffer_load_dwordx4 v15, s[24:27], s72 offen offset:3072 lds
v_mul_f32 v78, v78, v114
v_mfma_f32_16x16x32_bf16 v[32:35], v[224:227], a[24:27], v[32:35]
s_add_u32 s69, s61, 2
ds_read_b64_tr_b16 v[140:141], v11 offset:16384
ds_read_b64_tr_b16 v[142:143], v11 offset:18432
v_and_b32 v79, 0xffff0000, v103
v_mfma_f32_16x16x32_bf16 v[32:35], v[208:211], a[20:23], v[32:35]
s_and_b32 s69, s69, 3
ds_read_b64_tr_b16 v[144:145], v8 offset:20480
v_and_b32 v115, 0xffff0000, v111
v_mfma_f32_16x16x32_bf16 v[32:35], v[192:195], a[16:19], v[32:35]
s_add_u32 s69, s69, s79
s_lshl_b32 s69, s69, 12
s_add_u32 s69, s69, s95
buffer_load_dwordx4 a[64:67], v1, s[44:47], s69 offen sc1
v_mfma_f32_16x16x32_bf16 v[36:39], v[196:199], a[16:19], v[36:39]
ds_read_b64_tr_b16 v[146:147], v8 offset:22528
ds_read_b64_tr_b16 v[148:149], v9 offset:20480
v_mul_f32 v79, v79, v113
v_mfma_f32_16x16x32_bf16 v[36:39], v[212:215], a[20:23], v[36:39]
ds_read_b64_tr_b16 v[150:151], v9 offset:22528
ds_read_b64_tr_b16 v[152:153], v10 offset:20480
v_mul_f32 v79, v79, v115
v_mfma_f32_16x16x32_bf16 v[36:39], v[228:231], a[24:27], v[36:39]
buffer_load_dwordx4 a[68:71], v1, s[44:47], s69 offen offset:1024 sc1
v_mfma_f32_16x16x32_bf16 v[36:39], v[244:247], a[28:31], v[36:39]
ds_read_b64_tr_b16 v[154:155], v10 offset:22528
ds_read_b64_tr_b16 v[156:157], v11 offset:20480
v_mfma_f32_16x16x32_bf16 v[20:23], v[244:247], a[12:15], v[20:23]
buffer_load_dwordx4 a[72:75], v1, s[44:47], s69 offen offset:2048 sc1
v_mfma_f32_16x16x32_bf16 v[20:23], v[228:231], a[8:11], v[20:23]
ds_read_b64_tr_b16 v[158:159], v11 offset:22528
v_mfma_f32_16x16x32_bf16 v[20:23], v[212:215], a[4:7], v[20:23]
ds_read_b64_tr_b16 v[160:161], v8 offset:24576
ds_read_b64_tr_b16 v[162:163], v8 offset:26624
v_mfma_f32_16x16x32_bf16 v[20:23], v[196:199], a[0:3], v[20:23]
buffer_load_dwordx4 a[76:79], v1, s[44:47], s69 offen offset:3072 sc1
v_mfma_f32_16x16x32_bf16 v[24:27], v[200:203], a[0:3], v[24:27]
s_add_u32 s69, s69, 0x20000
ds_read_b64_tr_b16 v[164:165], v9 offset:24576
ds_read_b64_tr_b16 v[166:167], v9 offset:26624
v_mfma_f32_16x16x32_bf16 v[24:27], v[216:219], a[4:7], v[24:27]
ds_read_b64_tr_b16 v[168:169], v10 offset:24576
ds_read_b64_tr_b16 v[170:171], v10 offset:26624
v_mfma_f32_16x16x32_bf16 v[24:27], v[232:235], a[8:11], v[24:27]
buffer_load_dwordx4 a[80:83], v1, s[44:47], s69 offen sc1
v_mfma_f32_16x16x32_bf16 v[24:27], v[248:251], a[12:15], v[24:27]
ds_read_b64_tr_b16 v[172:173], v11 offset:24576
ds_read_b64_tr_b16 v[174:175], v11 offset:26624
v_mfma_f32_16x16x32_bf16 v[40:43], v[248:251], a[28:31], v[40:43]
ds_read_b64_tr_b16 v[176:177], v8 offset:28672
v_mfma_f32_16x16x32_bf16 v[40:43], v[232:235], a[24:27], v[40:43]
buffer_load_dwordx4 a[84:87], v1, s[44:47], s69 offen offset:1024 sc1
v_mfma_f32_16x16x32_bf16 v[40:43], v[216:219], a[20:23], v[40:43]
ds_read_b64_tr_b16 v[178:179], v8 offset:30720
ds_read_b64_tr_b16 v[180:181], v9 offset:28672
v_mfma_f32_16x16x32_bf16 v[40:43], v[200:203], a[16:19], v[40:43]
ds_read_b64_tr_b16 v[182:183], v9 offset:30720
ds_read_b64_tr_b16 v[184:185], v10 offset:28672
v_mfma_f32_16x16x32_bf16 v[44:47], v[204:207], a[16:19], v[44:47]
buffer_load_dwordx4 a[88:91], v1, s[44:47], s69 offen offset:2048 sc1
v_mfma_f32_16x16x32_bf16 v[44:47], v[220:223], a[20:23], v[44:47]
ds_read_b64_tr_b16 v[186:187], v10 offset:30720
ds_read_b64_tr_b16 v[188:189], v11 offset:28672
v_mfma_f32_16x16x32_bf16 v[44:47], v[236:239], a[24:27], v[44:47]
ds_read_b64_tr_b16 v[190:191], v11 offset:30720
v_mfma_f32_16x16x32_bf16 v[44:47], v[252:255], a[28:31], v[44:47]
buffer_load_dwordx4 a[92:95], v1, s[44:47], s69 offen offset:3072 sc1
v_mfma_f32_16x16x32_bf16 v[28:31], v[252:255], a[12:15], v[28:31]
s_add_u32 s71, s61, 3
v_mfma_f32_16x16x32_bf16 v[28:31], v[236:239], a[8:11], v[28:31]
s_and_b32 s71, s71, 3
s_add_u32 s71, s71, s79
s_lshl_b32 s71, s71, 18
s_add_u32 s71, s71, s94
s_add_u32 m0, s77, 49152
s_add_u32 s72, s71, 0
buffer_load_dwordx4 v15, s[24:27], s72 offen lds
v_mfma_f32_16x16x32_bf16 v[28:31], v[220:223], a[4:7], v[28:31]
s_waitcnt vmcnt(9) lgkmcnt(0)
v_mfma_f32_16x16x32_bf16 v[28:31], v[204:207], a[0:3], v[28:31]
s_barrier
v_mfma_f32_16x16x32_bf16 v[16:19], v[128:131], a[32:35], v[16:19]
s_add_u32 s72, s71, 15360
buffer_load_dwordx4 v15, s[24:27], s72 offen offset:1024 lds
v_mfma_f32_16x16x32_bf16 v[16:19], v[144:147], a[36:39], v[16:19]
s_add_u32 s72, s71, 30720
ds_read_b64_tr_b16 v[192:193], v8 offset:32768
ds_read_b64_tr_b16 v[194:195], v8 offset:34816
v_mfma_f32_16x16x32_bf16 v[16:19], v[160:163], a[40:43], v[16:19]
ds_read_b64_tr_b16 v[196:197], v9 offset:32768
ds_read_b64_tr_b16 v[198:199], v9 offset:34816
v_mfma_f32_16x16x32_bf16 v[16:19], v[176:179], a[44:47], v[16:19]
buffer_load_dwordx4 v15, s[24:27], s72 offen offset:2048 lds
v_mfma_f32_16x16x32_bf16 v[32:35], v[176:179], a[60:63], v[32:35]
s_add_u32 s72, s71, 46080
ds_read_b64_tr_b16 v[200:201], v10 offset:32768
ds_read_b64_tr_b16 v[202:203], v10 offset:34816
v_mfma_f32_16x16x32_bf16 v[32:35], v[160:163], a[56:59], v[32:35]
ds_read_b64_tr_b16 v[204:205], v11 offset:32768
ds_read_b64_tr_b16 v[206:207], v11 offset:34816
v_mfma_f32_16x16x32_bf16 v[32:35], v[144:147], a[52:55], v[32:35]
buffer_load_dwordx4 v15, s[24:27], s72 offen offset:3072 lds
v_mfma_f32_16x16x32_bf16 v[32:35], v[128:131], a[48:51], v[32:35]
s_add_u32 s69, s61, 3
ds_read_b64_tr_b16 v[208:209], v8 offset:36864
ds_read_b64_tr_b16 v[210:211], v8 offset:38912
v_mfma_f32_16x16x32_bf16 v[36:39], v[132:135], a[48:51], v[36:39]
s_and_b32 s69, s69, 3
ds_read_b64_tr_b16 v[212:213], v9 offset:36864
ds_read_b64_tr_b16 v[214:215], v9 offset:38912
v_mfma_f32_16x16x32_bf16 v[36:39], v[148:151], a[52:55], v[36:39]
s_add_u32 s69, s69, s79
s_lshl_b32 s69, s69, 12
s_add_u32 s69, s69, s95
buffer_load_dwordx4 a[96:99], v1, s[44:47], s69 offen sc1
v_mfma_f32_16x16x32_bf16 v[36:39], v[164:167], a[56:59], v[36:39]
ds_read_b64_tr_b16 v[216:217], v10 offset:36864
ds_read_b64_tr_b16 v[218:219], v10 offset:38912
v_mfma_f32_16x16x32_bf16 v[36:39], v[180:183], a[60:63], v[36:39]
ds_read_b64_tr_b16 v[220:221], v11 offset:36864
ds_read_b64_tr_b16 v[222:223], v11 offset:38912
v_mfma_f32_16x16x32_bf16 v[20:23], v[180:183], a[44:47], v[20:23]
buffer_load_dwordx4 a[100:103], v1, s[44:47], s69 offen offset:1024 sc1
v_mfma_f32_16x16x32_bf16 v[20:23], v[164:167], a[40:43], v[20:23]
ds_read_b64_tr_b16 v[224:225], v8 offset:40960
v_mfma_f32_16x16x32_bf16 v[20:23], v[148:151], a[36:39], v[20:23]
buffer_load_dwordx4 a[104:107], v1, s[44:47], s69 offen offset:2048 sc1
v_mfma_f32_16x16x32_bf16 v[20:23], v[132:135], a[32:35], v[20:23]
ds_read_b64_tr_b16 v[226:227], v8 offset:43008
ds_read_b64_tr_b16 v[228:229], v9 offset:40960
v_mfma_f32_16x16x32_bf16 v[24:27], v[136:139], a[32:35], v[24:27]
ds_read_b64_tr_b16 v[230:231], v9 offset:43008
ds_read_b64_tr_b16 v[232:233], v10 offset:40960
v_mfma_f32_16x16x32_bf16 v[24:27], v[152:155], a[36:39], v[24:27]
buffer_load_dwordx4 a[108:111], v1, s[44:47], s69 offen offset:3072 sc1
v_mfma_f32_16x16x32_bf16 v[24:27], v[168:171], a[40:43], v[24:27]
s_add_u32 s69, s69, 0x20000
ds_read_b64_tr_b16 v[234:235], v10 offset:43008
ds_read_b64_tr_b16 v[236:237], v11 offset:40960
v_mfma_f32_16x16x32_bf16 v[24:27], v[184:187], a[44:47], v[24:27]
ds_read_b64_tr_b16 v[238:239], v11 offset:43008
ds_read_b64_tr_b16 v[240:241], v8 offset:45056
v_mfma_f32_16x16x32_bf16 v[40:43], v[184:187], a[60:63], v[40:43]
buffer_load_dwordx4 a[112:115], v1, s[44:47], s69 offen sc1
v_mfma_f32_16x16x32_bf16 v[40:43], v[168:171], a[56:59], v[40:43]
ds_read_b64_tr_b16 v[242:243], v8 offset:47104
ds_read_b64_tr_b16 v[244:245], v9 offset:45056
v_mfma_f32_16x16x32_bf16 v[40:43], v[152:155], a[52:55], v[40:43]
ds_read_b64_tr_b16 v[246:247], v9 offset:47104
ds_read_b64_tr_b16 v[248:249], v10 offset:45056
v_mfma_f32_16x16x32_bf16 v[40:43], v[136:139], a[48:51], v[40:43]
buffer_load_dwordx4 a[116:119], v1, s[44:47], s69 offen offset:1024 sc1
v_mfma_f32_16x16x32_bf16 v[44:47], v[140:143], a[48:51], v[44:47]
ds_read_b64_tr_b16 v[250:251], v10 offset:47104
ds_read_b64_tr_b16 v[252:253], v11 offset:45056
v_mfma_f32_16x16x32_bf16 v[44:47], v[156:159], a[52:55], v[44:47]
ds_read_b64_tr_b16 v[254:255], v11 offset:47104
v_mfma_f32_16x16x32_bf16 v[44:47], v[172:175], a[56:59], v[44:47]
buffer_load_dwordx4 a[120:123], v1, s[44:47], s69 offen offset:2048 sc1
v_mfma_f32_16x16x32_bf16 v[44:47], v[188:191], a[60:63], v[44:47]
v_mfma_f32_16x16x32_bf16 v[28:31], v[188:191], a[44:47], v[28:31]
v_mfma_f32_16x16x32_bf16 v[28:31], v[172:175], a[40:43], v[28:31]
buffer_load_dwordx4 a[124:127], v1, s[44:47], s69 offen offset:3072 sc1
v_mfma_f32_16x16x32_bf16 v[28:31], v[156:159], a[36:39], v[28:31]
s_waitcnt vmcnt(8) lgkmcnt(0)
v_mfma_f32_16x16x32_bf16 v[28:31], v[140:143], a[32:35], v[28:31]
s_barrier
v_mfma_f32_16x16x32_bf16 v[16:19], v[192:195], a[64:67], v[16:19]
ds_read_b64_tr_b16 v[128:129], v8 offset:49152
ds_read_b64_tr_b16 v[130:131], v8 offset:51200
v_mfma_f32_16x16x32_bf16 v[16:19], v[208:211], a[68:71], v[16:19]
ds_read_b64_tr_b16 v[132:133], v9 offset:49152
v_mfma_f32_16x16x32_bf16 v[16:19], v[224:227], a[72:75], v[16:19]
ds_read_b64_tr_b16 v[134:135], v9 offset:51200
v_mfma_f32_16x16x32_bf16 v[16:19], v[240:243], a[76:79], v[16:19]
ds_read_b64_tr_b16 v[136:137], v10 offset:49152
v_mfma_f32_16x16x32_bf16 v[32:35], v[240:243], a[92:95], v[32:35]
ds_read_b64_tr_b16 v[138:139], v10 offset:51200
v_mfma_f32_16x16x32_bf16 v[32:35], v[224:227], a[88:91], v[32:35]
ds_read_b64_tr_b16 v[140:141], v11 offset:49152
ds_read_b64_tr_b16 v[142:143], v11 offset:51200
v_mfma_f32_16x16x32_bf16 v[32:35], v[208:211], a[84:87], v[32:35]
ds_read_b64_tr_b16 v[144:145], v8 offset:53248
v_mfma_f32_16x16x32_bf16 v[32:35], v[192:195], a[80:83], v[32:35]
ds_read_b64_tr_b16 v[146:147], v8 offset:55296
v_mfma_f32_16x16x32_bf16 v[36:39], v[196:199], a[80:83], v[36:39]
ds_read_b64_tr_b16 v[148:149], v9 offset:53248
v_mfma_f32_16x16x32_bf16 v[36:39], v[212:215], a[84:87], v[36:39]
ds_read_b64_tr_b16 v[150:151], v9 offset:55296
v_mfma_f32_16x16x32_bf16 v[36:39], v[228:231], a[88:91], v[36:39]
ds_read_b64_tr_b16 v[152:153], v10 offset:53248
ds_read_b64_tr_b16 v[154:155], v10 offset:55296
v_mfma_f32_16x16x32_bf16 v[36:39], v[244:247], a[92:95], v[36:39]
ds_read_b64_tr_b16 v[156:157], v11 offset:53248
v_mfma_f32_16x16x32_bf16 v[20:23], v[244:247], a[76:79], v[20:23]
ds_read_b64_tr_b16 v[158:159], v11 offset:55296
v_mfma_f32_16x16x32_bf16 v[20:23], v[228:231], a[72:75], v[20:23]
ds_read_b64_tr_b16 v[160:161], v8 offset:57344
v_mfma_f32_16x16x32_bf16 v[20:23], v[212:215], a[68:71], v[20:23]
ds_read_b64_tr_b16 v[162:163], v8 offset:59392
v_mfma_f32_16x16x32_bf16 v[20:23], v[196:199], a[64:67], v[20:23]
ds_read_b64_tr_b16 v[164:165], v9 offset:57344
v_mfma_f32_16x16x32_bf16 v[24:27], v[200:203], a[64:67], v[24:27]
ds_read_b64_tr_b16 v[166:167], v9 offset:59392
ds_read_b64_tr_b16 v[168:169], v10 offset:57344
v_mfma_f32_16x16x32_bf16 v[24:27], v[216:219], a[68:71], v[24:27]
ds_read_b64_tr_b16 v[170:171], v10 offset:59392
v_mfma_f32_16x16x32_bf16 v[24:27], v[232:235], a[72:75], v[24:27]
ds_read_b64_tr_b16 v[172:173], v11 offset:57344
v_mfma_f32_16x16x32_bf16 v[24:27], v[248:251], a[76:79], v[24:27]
ds_read_b64_tr_b16 v[174:175], v11 offset:59392
v_mfma_f32_16x16x32_bf16 v[40:43], v[248:251], a[92:95], v[40:43]
ds_read_b64_tr_b16 v[176:177], v8 offset:61440
v_mfma_f32_16x16x32_bf16 v[40:43], v[232:235], a[88:91], v[40:43]
ds_read_b64_tr_b16 v[178:179], v8 offset:63488
ds_read_b64_tr_b16 v[180:181], v9 offset:61440
v_mfma_f32_16x16x32_bf16 v[40:43], v[216:219], a[84:87], v[40:43]
ds_read_b64_tr_b16 v[182:183], v9 offset:63488
v_mfma_f32_16x16x32_bf16 v[40:43], v[200:203], a[80:83], v[40:43]
ds_read_b64_tr_b16 v[184:185], v10 offset:61440
v_mfma_f32_16x16x32_bf16 v[44:47], v[204:207], a[80:83], v[44:47]
ds_read_b64_tr_b16 v[186:187], v10 offset:63488
v_mfma_f32_16x16x32_bf16 v[44:47], v[220:223], a[84:87], v[44:47]
ds_read_b64_tr_b16 v[188:189], v11 offset:61440
v_mfma_f32_16x16x32_bf16 v[44:47], v[236:239], a[88:91], v[44:47]
ds_read_b64_tr_b16 v[190:191], v11 offset:63488
v_mfma_f32_16x16x32_bf16 v[44:47], v[252:255], a[92:95], v[44:47]
v_mfma_f32_16x16x32_bf16 v[28:31], v[252:255], a[76:79], v[28:31]
v_mfma_f32_16x16x32_bf16 v[28:31], v[236:239], a[72:75], v[28:31]
v_mfma_f32_16x16x32_bf16 v[28:31], v[220:223], a[68:71], v[28:31]
s_waitcnt vmcnt(0) lgkmcnt(0)
v_mfma_f32_16x16x32_bf16 v[28:31], v[204:207], a[64:67], v[28:31]
v_mfma_f32_16x16x32_bf16 v[16:19], v[128:131], a[96:99], v[16:19]
v_mfma_f32_16x16x32_bf16 v[16:19], v[144:147], a[100:103], v[16:19]
v_mfma_f32_16x16x32_bf16 v[16:19], v[160:163], a[104:107], v[16:19]
v_mfma_f32_16x16x32_bf16 v[16:19], v[176:179], a[108:111], v[16:19]
v_mfma_f32_16x16x32_bf16 v[32:35], v[176:179], a[124:127], v[32:35]
v_mfma_f32_16x16x32_bf16 v[32:35], v[160:163], a[120:123], v[32:35]
v_mfma_f32_16x16x32_bf16 v[32:35], v[144:147], a[116:119], v[32:35]
v_mfma_f32_16x16x32_bf16 v[32:35], v[128:131], a[112:115], v[32:35]
s_nop 3
v_fma_f32 v48, v16, v6, v48
v_fma_f32 v49, v17, v6, v49
v_mfma_f32_16x16x32_bf16 v[36:39], v[132:135], a[112:115], v[36:39]
v_fma_f32 v50, v18, v6, v50
v_fma_f32 v51, v19, v6, v51
v_mfma_f32_16x16x32_bf16 v[36:39], v[148:151], a[116:119], v[36:39]
v_cvt_pk_bf16_f32 v48, v48, v49
v_cvt_pk_bf16_f32 v49, v50, v51
v_mfma_f32_16x16x32_bf16 v[36:39], v[164:167], a[120:123], v[36:39]
ds_write_b64 v116, v[48:49] offset:0
v_mfma_f32_16x16x32_bf16 v[36:39], v[180:183], a[124:127], v[36:39]
v_fma_f32 v64, v32, v7, v64
v_fma_f32 v65, v33, v7, v65
v_mfma_f32_16x16x32_bf16 v[20:23], v[180:183], a[108:111], v[20:23]
v_fma_f32 v66, v34, v7, v66
v_fma_f32 v67, v35, v7, v67
v_mfma_f32_16x16x32_bf16 v[20:23], v[164:167], a[104:107], v[20:23]
v_cvt_pk_bf16_f32 v64, v64, v65
v_cvt_pk_bf16_f32 v65, v66, v67
v_mfma_f32_16x16x32_bf16 v[20:23], v[148:151], a[100:103], v[20:23]
ds_write_b64 v116, v[64:65] offset:2048
v_mfma_f32_16x16x32_bf16 v[20:23], v[132:135], a[96:99], v[20:23]
v_fma_f32 v68, v36, v7, v68
v_fma_f32 v69, v37, v7, v69
v_mfma_f32_16x16x32_bf16 v[24:27], v[136:139], a[96:99], v[24:27]
v_fma_f32 v70, v38, v7, v70
v_fma_f32 v71, v39, v7, v71
v_mfma_f32_16x16x32_bf16 v[24:27], v[152:155], a[100:103], v[24:27]
v_cvt_pk_bf16_f32 v68, v68, v69
v_cvt_pk_bf16_f32 v69, v70, v71
v_mfma_f32_16x16x32_bf16 v[24:27], v[168:171], a[104:107], v[24:27]
ds_write_b64 v117, v[68:69] offset:2048
v_mfma_f32_16x16x32_bf16 v[24:27], v[184:187], a[108:111], v[24:27]
v_fma_f32 v52, v20, v6, v52
v_fma_f32 v53, v21, v6, v53
v_mfma_f32_16x16x32_bf16 v[40:43], v[184:187], a[124:127], v[40:43]
v_fma_f32 v54, v22, v6, v54
v_fma_f32 v55, v23, v6, v55
v_mfma_f32_16x16x32_bf16 v[40:43], v[168:171], a[120:123], v[40:43]
v_cvt_pk_bf16_f32 v52, v52, v53
v_cvt_pk_bf16_f32 v53, v54, v55
v_mfma_f32_16x16x32_bf16 v[40:43], v[152:155], a[116:119], v[40:43]
ds_write_b64 v117, v[52:53] offset:0
v_mfma_f32_16x16x32_bf16 v[40:43], v[136:139], a[112:115], v[40:43]
v_fma_f32 v56, v24, v6, v56
v_fma_f32 v57, v25, v6, v57
v_mfma_f32_16x16x32_bf16 v[44:47], v[140:143], a[112:115], v[44:47]
v_fma_f32 v58, v26, v6, v58
v_fma_f32 v59, v27, v6, v59
v_mfma_f32_16x16x32_bf16 v[44:47], v[156:159], a[116:119], v[44:47]
v_cvt_pk_bf16_f32 v56, v56, v57
v_cvt_pk_bf16_f32 v57, v58, v59
v_mfma_f32_16x16x32_bf16 v[44:47], v[172:175], a[120:123], v[44:47]
ds_write_b64 v118, v[56:57] offset:0
v_mfma_f32_16x16x32_bf16 v[44:47], v[188:191], a[124:127], v[44:47]
v_fma_f32 v72, v40, v7, v72
v_fma_f32 v73, v41, v7, v73
v_mfma_f32_16x16x32_bf16 v[28:31], v[188:191], a[108:111], v[28:31]
v_fma_f32 v74, v42, v7, v74
v_fma_f32 v75, v43, v7, v75
v_mfma_f32_16x16x32_bf16 v[28:31], v[172:175], a[104:107], v[28:31]
v_cvt_pk_bf16_f32 v72, v72, v73
v_cvt_pk_bf16_f32 v73, v74, v75
v_mfma_f32_16x16x32_bf16 v[28:31], v[156:159], a[100:103], v[28:31]
ds_write_b64 v118, v[72:73] offset:2048
v_mfma_f32_16x16x32_bf16 v[28:31], v[140:143], a[96:99], v[28:31]
v_fma_f32 v76, v44, v7, v76
v_fma_f32 v77, v45, v7, v77
v_fma_f32 v78, v46, v7, v78
v_fma_f32 v79, v47, v7, v79
v_cvt_pk_bf16_f32 v76, v76, v77
v_cvt_pk_bf16_f32 v77, v78, v79
ds_write_b64 v119, v[76:77] offset:2048
s_nop 0
v_fma_f32 v60, v28, v6, v60
v_fma_f32 v61, v29, v6, v61
v_fma_f32 v62, v30, v6, v62
v_fma_f32 v63, v31, v6, v63
v_cvt_pk_bf16_f32 v60, v60, v61
v_cvt_pk_bf16_f32 v61, v62, v63
ds_write_b64 v119, v[60:61] offset:0
ds_read_b128 v[80:83], v120 offset:0
ds_read_b128 v[84:87], v120 offset:1024
ds_read_b128 v[96:99], v120 offset:2048
ds_read_b128 v[100:103], v120 offset:3072
s_waitcnt lgkmcnt(3)
buffer_store_dwordx4 v[80:83], v15, s[40:43], s70 offen sc1
s_add_u32 s70, s70, 0x4000
s_waitcnt lgkmcnt(2)
buffer_store_dwordx4 v[84:87], v15, s[40:43], s70 offen sc1
s_add_u32 s70, s70, 0x4000
s_waitcnt lgkmcnt(1)
buffer_store_dwordx4 v[96:99], v15, s[40:43], s70 offen sc1
s_add_u32 s70, s70, 0x4000
s_waitcnt lgkmcnt(0)
buffer_store_dwordx4 v[100:103], v15, s[40:43], s70 offen sc1
s_add_u32 s70, s70, 0x4000
Lend:
s_endpgm
Lspin1:
s_mov_b32 s83, 262144
Lsl3:
s_sleep 2
buffer_load_dword v3, v2, s[48:51], 0 offen sc1
s_sub_u32 s83, s83, 1
s_cmp_eq_u32 s83, 0
s_waitcnt vmcnt(0)
s_cbranch_scc1 Lback2
v_cmp_gt_u32 vcc, 8, v3
s_cbranch_vccnz Lsl3
s_branch Lback2
Lspin4:
s_mov_b32 s83, 262144
Lsl6:
s_sleep 2
buffer_load_dword v3, v2, s[44:47], s75 offen sc1
s_sub_u32 s83, s83, 1
s_cmp_eq_u32 s83, 0
s_waitcnt vmcnt(0)
s_cbranch_scc1 Lback5
v_cmp_gt_u32 vcc, 1, v3
s_cbranch_vccnz Lsl6
s_branch Lback5
.p2align 12
s_endpgm
.p2align 7
LP0x:
Lstub10:
s_cbranch_execz Lret
s_cmp_eq_u32 s58, 2
s_cbranch_scc1 Lta10
s_cmp_eq_u32 s58, 3
s_cbranch_scc1 Lnt11
v_mfma_f32_16x16x32_bf16 v[160:163], a[160:163], v[16:19], v[112:115]
s_xor_b32 s74, s82, 0x10000
v_exp_f32 v128, v128
v_mfma_f32_16x16x32_bf16 v[176:179], a[176:179], v[16:19], v[112:115]
s_add_u32 s74, s74, s64
ds_read_b128 a[128:131], v2 offset:16384
ds_read_b128 a[132:135], v2 offset:17408
s_branch Ljoin12
Lta10:
v_mfma_f32_16x16x32_bf16 v[160:163], a[160:163], v[16:19], v[96:99]
s_xor_b32 s74, s82, 0x10000
v_exp_f32 v128, v128
v_mfma_f32_16x16x32_bf16 v[176:179], a[176:179], v[16:19], v[112:115]
s_add_u32 s74, s74, s64
ds_read_b128 a[128:131], v2 offset:16384
ds_read_b128 a[132:135], v2 offset:17408
s_branch Ljoin12
Lnt11:
v_mfma_f32_16x16x32_bf16 v[160:163], a[160:163], v[16:19], v[80:83]
s_xor_b32 s74, s82, 0x10000
v_exp_f32 v128, v128
v_mfma_f32_16x16x32_bf16 v[176:179], a[176:179], v[16:19], v[96:99]
s_add_u32 s74, s74, s64
ds_read_b128 a[128:131], v2 offset:16384
ds_read_b128 a[132:135], v2 offset:17408
Ljoin12:
v_mfma_f32_16x16x32_bf16 v[160:163], a[164:167], v[20:23], v[160:163]
s_add_u32 s81, s81, 0x8000
v_exp_f32 v129, v129
v_mfma_f32_16x16x32_bf16 v[160:163], a[168:171], v[24:27], v[160:163]
s_add_u32 m0, s74, 16384
v_exp_f32 v130, v130
v_mfma_f32_16x16x32_bf16 v[160:163], a[172:175], v[28:31], v[160:163]
s_add_u32 s72, s81, 16384
v_exp_f32 v131, v131
v_mfma_f32_16x16x32_bf16 v[164:167], a[172:175], v[44:47], v[84:87]
v_exp_f32 v144, v144
v_mfma_f32_16x16x32_bf16 v[164:167], a[168:171], v[40:43], v[164:167]
ds_read_b128 a[136:139], v2 offset:18432
ds_read_b128 a[140:143], v2 offset:19456
v_mfma_f32_16x16x32_bf16 v[164:167], a[164:167], v[36:39], v[164:167]
ds_read_b128 a[144:147], v2 offset:20480
ds_read_b128 a[148:151], v2 offset:21504
v_mfma_f32_16x16x32_bf16 v[164:167], a[160:163], v[32:35], v[164:167]
ds_read_b128 a[152:155], v2 offset:22528
ds_read_b128 a[156:159], v2 offset:23552
v_mfma_f32_16x16x32_bf16 v[168:171], a[160:163], v[48:51], v[88:91]
ds_read_b128 a[192:195], v2 offset:0
ds_read_b128 a[196:199], v2 offset:1024
v_mfma_f32_16x16x32_bf16 v[168:171], a[164:167], v[52:55], v[168:171]
ds_read_b128 a[200:203], v2 offset:2048
ds_read_b128 a[204:207], v2 offset:3072
v_mfma_f32_16x16x32_bf16 v[168:171], a[168:171], v[56:59], v[168:171]
ds_read_b128 a[208:211], v2 offset:4096
ds_read_b128 a[212:215], v2 offset:5120
v_mfma_f32_16x16x32_bf16 v[168:171], a[172:175], v[60:63], v[168:171]
ds_read_b128 a[216:219], v2 offset:6144
ds_read_b128 a[220:223], v2 offset:7168
v_mfma_f32_16x16x32_bf16 v[172:175], a[172:175], v[76:79], v[92:95]
v_cvt_pk_bf16_f32 v192, v128, v129
v_cvt_pk_bf16_f32 v193, v130, v131
v_mfma_f32_16x16x32_bf16 v[172:175], a[168:171], v[72:75], v[172:175]
buffer_load_dwordx4 v1, s[44:47], s72 offen sc1 lds
v_mfma_f32_16x16x32_bf16 v[172:175], a[164:167], v[68:71], v[172:175]
v_exp_f32 v145, v145
v_mfma_f32_16x16x32_bf16 v[172:175], a[160:163], v[64:67], v[172:175]
v_exp_f32 v146, v146
v_mfma_f32_16x16x32_bf16 v[188:191], a[176:179], v[64:67], v[92:95]
v_exp_f32 v147, v147
v_mfma_f32_16x16x32_bf16 v[188:191], a[180:183], v[68:71], v[188:191]
v_exp_f32 v132, v132
v_mfma_f32_16x16x32_bf16 v[188:191], a[184:187], v[72:75], v[188:191]
v_cvt_pk_bf16_f32 v194, v144, v145
v_cvt_pk_bf16_f32 v195, v146, v147
v_mfma_f32_16x16x32_bf16 v[188:191], a[188:191], v[76:79], v[188:191]
v_exp_f32 v133, v133
v_mfma_f32_16x16x32_bf16 v[184:187], a[188:191], v[60:63], v[88:91]
v_exp_f32 v134, v134
v_mfma_f32_16x16x32_bf16 v[184:187], a[184:187], v[56:59], v[184:187]
v_exp_f32 v135, v135
v_mfma_f32_16x16x32_bf16 v[184:187], a[180:183], v[52:55], v[184:187]
v_exp_f32 v148, v148
v_mfma_f32_16x16x32_bf16 v[184:187], a[176:179], v[48:51], v[184:187]
v_cvt_pk_bf16_f32 v196, v132, v133
v_cvt_pk_bf16_f32 v197, v134, v135
v_mfma_f32_16x16x32_bf16 v[180:183], a[176:179], v[32:35], v[84:87]
buffer_load_dwordx4 v1, s[44:47], s72 offen offset:1024 sc1 lds
v_mfma_f32_16x16x32_bf16 v[180:183], a[180:183], v[36:39], v[180:183]
v_exp_f32 v149, v149
v_mfma_f32_16x16x32_bf16 v[180:183], a[184:187], v[40:43], v[180:183]
v_exp_f32 v150, v150
v_mfma_f32_16x16x32_bf16 v[180:183], a[188:191], v[44:47], v[180:183]
v_exp_f32 v151, v151
v_mfma_f32_16x16x32_bf16 v[176:179], a[188:191], v[28:31], v[176:179]
buffer_load_dwordx4 v1, s[44:47], s72 offen offset:2048 sc1 lds
v_mfma_f32_16x16x32_bf16 v[176:179], a[184:187], v[24:27], v[176:179]
buffer_load_dwordx4 v1, s[44:47], s72 offen offset:3072 sc1 lds
v_mfma_f32_16x16x32_bf16 v[176:179], a[180:183], v[20:23], v[176:179]
s_waitcnt lgkmcnt(8)
v_exp_f32 v136, v136
v_cvt_pk_bf16_f32 v198, v148, v149
v_cvt_pk_bf16_f32 v199, v150, v151
v_exp_f32 v137, v137
v_exp_f32 v138, v138
v_cvt_pk_bf16_f32 v200, v136, v137
v_exp_f32 v139, v139
v_exp_f32 v152, v152
v_cvt_pk_bf16_f32 v201, v138, v139
v_exp_f32 v153, v153
v_exp_f32 v154, v154
v_cvt_pk_bf16_f32 v202, v152, v153
v_exp_f32 v155, v155
v_exp_f32 v140, v140
v_cvt_pk_bf16_f32 v203, v154, v155
v_exp_f32 v141, v141
v_exp_f32 v142, v142
v_cvt_pk_bf16_f32 v204, v140, v141
v_exp_f32 v143, v143
v_exp_f32 v156, v156
v_cvt_pk_bf16_f32 v205, v142, v143
v_exp_f32 v157, v157
v_exp_f32 v158, v158
v_cvt_pk_bf16_f32 v206, v156, v157
v_exp_f32 v159, v159
s_nop 0
v_cvt_pk_bf16_f32 v207, v158, v159
s_cmp_eq_u32 s58, 0
s_cbranch_scc1 Lta13
s_cmp_eq_u32 s58, 1
s_cbranch_scc1 Lnt14
v_mfma_f32_16x16x32_bf16 v[132:135], a[128:131], v[32:35], v[84:87]
s_add_u32 s82, s82, 0x8000
ds_read_b128 a[160:163], v2 offset:24576
v_mfma_f32_16x16x32_bf16 v[148:151], a[144:147], v[32:35], v[84:87]
s_and_b32 s82, s82, 0x1ffff
v_exp_f32 v160, v160
s_branch Ljoin15
Lta13:
v_mfma_f32_16x16x32_bf16 v[132:135], a[128:131], v[32:35], v[100:103]
s_add_u32 s82, s82, 0x8000
ds_read_b128 a[160:163], v2 offset:24576
v_mfma_f32_16x16x32_bf16 v[148:151], a[144:147], v[32:35], v[112:115]
s_and_b32 s82, s82, 0x1ffff
v_exp_f32 v160, v160
s_branch Ljoin15
Lnt14:
v_mfma_f32_16x16x32_bf16 v[132:135], a[128:131], v[32:35], v[84:87]
s_add_u32 s82, s82, 0x8000
ds_read_b128 a[160:163], v2 offset:24576
v_mfma_f32_16x16x32_bf16 v[148:151], a[144:147], v[32:35], v[100:103]
s_and_b32 s82, s82, 0x1ffff
v_exp_f32 v160, v160
Ljoin15:
v_mfma_f32_16x16x32_bf16 v[132:135], a[132:135], v[36:39], v[132:135]
s_add_u32 m0, s74, 0
v_exp_f32 v161, v161
v_mfma_f32_16x16x32_bf16 v[132:135], a[136:139], v[40:43], v[132:135]
s_add_u32 s72, s81, 0
ds_read_b128 a[164:167], v2 offset:25600
v_cvt_pk_bf16_f32 v208, v160, v161
v_mfma_f32_16x16x32_bf16 v[132:135], a[140:143], v[44:47], v[132:135]
v_exp_f32 v162, v162
v_mfma_f32_16x16x32_bf16 v[136:139], a[140:143], v[60:63], v[88:91]
buffer_load_dwordx4 v1, s[44:47], s72 offen sc1 lds
v_mfma_f32_16x16x32_bf16 v[136:139], a[136:139], v[56:59], v[136:139]
v_exp_f32 v163, v163
v_mfma_f32_16x16x32_bf16 v[136:139], a[132:135], v[52:55], v[136:139]
ds_read_b128 a[168:171], v2 offset:26624
v_cvt_pk_bf16_f32 v209, v162, v163
v_mfma_f32_16x16x32_bf16 v[136:139], a[128:131], v[48:51], v[136:139]
v_exp_f32 v176, v176
v_mfma_f32_16x16x32_bf16 v[140:143], a[128:131], v[64:67], v[92:95]
v_exp_f32 v177, v177
v_mfma_f32_16x16x32_bf16 v[140:143], a[132:135], v[68:71], v[140:143]
ds_read_b128 a[172:175], v2 offset:27648
v_cvt_pk_bf16_f32 v210, v176, v177
v_mfma_f32_16x16x32_bf16 v[140:143], a[136:139], v[72:75], v[140:143]
v_exp_f32 v178, v178
v_mfma_f32_16x16x32_bf16 v[140:143], a[140:143], v[76:79], v[140:143]
buffer_load_dwordx4 v1, s[44:47], s72 offen offset:1024 sc1 lds
v_mfma_f32_16x16x32_bf16 v[156:159], a[156:159], v[76:79], v[92:95]
v_exp_f32 v179, v179
v_mfma_f32_16x16x32_bf16 v[156:159], a[152:155], v[72:75], v[156:159]
ds_read_b128 a[176:179], v2 offset:28672
v_cvt_pk_bf16_f32 v211, v178, v179
v_mfma_f32_16x16x32_bf16 v[156:159], a[148:151], v[68:71], v[156:159]
v_exp_f32 v164, v164
v_mfma_f32_16x16x32_bf16 v[156:159], a[144:147], v[64:67], v[156:159]
v_exp_f32 v165, v165
v_mfma_f32_16x16x32_bf16 v[152:155], a[144:147], v[48:51], v[88:91]
ds_read_b128 a[180:183], v2 offset:29696
v_cvt_pk_bf16_f32 v212, v164, v165
v_mfma_f32_16x16x32_bf16 v[152:155], a[148:151], v[52:55], v[152:155]
v_exp_f32 v166, v166
v_mfma_f32_16x16x32_bf16 v[152:155], a[152:155], v[56:59], v[152:155]
buffer_load_dwordx4 v1, s[44:47], s72 offen offset:2048 sc1 lds
v_mfma_f32_16x16x32_bf16 v[152:155], a[156:159], v[60:63], v[152:155]
v_exp_f32 v167, v167
v_mfma_f32_16x16x32_bf16 v[148:151], a[156:159], v[44:47], v[148:151]
ds_read_b128 a[184:187], v2 offset:30720
v_cvt_pk_bf16_f32 v213, v166, v167
v_mfma_f32_16x16x32_bf16 v[148:151], a[152:155], v[40:43], v[148:151]
v_exp_f32 v180, v180
v_mfma_f32_16x16x32_bf16 v[148:151], a[148:151], v[36:39], v[148:151]
s_waitcnt lgkmcnt(7)
v_exp_f32 v181, v181
v_mfma_f32_16x16x32_bf16 a[0:3], a[192:195], v[192:195], 0
ds_read_b128 a[188:191], v2 offset:31744
v_cvt_pk_bf16_f32 v214, v180, v181
v_mfma_f32_16x16x32_bf16 a[32:35], a[192:195], v[196:199], 0
v_exp_f32 v182, v182
v_mfma_f32_16x16x32_bf16 a[64:67], a[192:195], v[200:203], 0
buffer_load_dwordx4 v1, s[44:47], s72 offen offset:3072 sc1 lds
v_mfma_f32_16x16x32_bf16 a[96:99], a[192:195], v[204:207], 0
s_add_u32 s66, s58, 1
v_exp_f32 v183, v183
v_mfma_f32_16x16x32_bf16 a[100:103], a[196:199], v[204:207], 0
s_and_b32 s66, s66, 3
ds_read_b128 a[224:227], v2 offset:8192
v_cvt_pk_bf16_f32 v215, v182, v183
v_mfma_f32_16x16x32_bf16 a[68:71], a[196:199], v[200:203], 0
s_mul_i32 s66, s66, 4160
v_exp_f32 v168, v168
v_mfma_f32_16x16x32_bf16 a[36:39], a[196:199], v[196:199], 0
s_add_u32 m0, s66, 131104
v_exp_f32 v169, v169
v_mfma_f32_16x16x32_bf16 a[4:7], a[196:199], v[192:195], 0
s_add_u32 s72, s93, 0x2
ds_read_b128 a[228:231], v2 offset:9216
v_cvt_pk_bf16_f32 v216, v168, v169
v_mfma_f32_16x16x32_bf16 a[8:11], a[200:203], v[192:195], 0
v_exp_f32 v170, v170
v_mfma_f32_16x16x32_bf16 a[40:43], a[200:203], v[196:199], 0
buffer_load_dwordx4 v1, s[36:39], s72 offen lds
v_mfma_f32_16x16x32_bf16 a[72:75], a[200:203], v[200:203], 0
v_exp_f32 v171, v171
v_mfma_f32_16x16x32_bf16 a[104:107], a[200:203], v[204:207], 0
ds_read_b128 a[232:235], v2 offset:10240
v_cvt_pk_bf16_f32 v217, v170, v171
v_mfma_f32_16x16x32_bf16 a[108:111], a[204:207], v[204:207], 0
v_exp_f32 v184, v184
v_mfma_f32_16x16x32_bf16 a[76:79], a[204:207], v[200:203], 0
v_exp_f32 v185, v185
v_mfma_f32_16x16x32_bf16 a[44:47], a[204:207], v[196:199], 0
ds_read_b128 a[236:239], v2 offset:11264
v_cvt_pk_bf16_f32 v218, v184, v185
v_mfma_f32_16x16x32_bf16 a[12:15], a[204:207], v[192:195], 0
v_exp_f32 v186, v186
v_mfma_f32_16x16x32_bf16 a[16:19], a[208:211], v[192:195], 0
buffer_load_dwordx4 v1, s[36:39], s72 offen offset:1024 lds
v_mfma_f32_16x16x32_bf16 a[48:51], a[208:211], v[196:199], 0
v_exp_f32 v187, v187
v_mfma_f32_16x16x32_bf16 a[80:83], a[208:211], v[200:203], 0
ds_read_b128 a[240:243], v2 offset:12288
v_cvt_pk_bf16_f32 v219, v186, v187
v_mfma_f32_16x16x32_bf16 a[112:115], a[208:211], v[204:207], 0
v_exp_f32 v172, v172
v_mfma_f32_16x16x32_bf16 a[116:119], a[212:215], v[204:207], 0
v_exp_f32 v173, v173
v_mfma_f32_16x16x32_bf16 a[84:87], a[212:215], v[200:203], 0
ds_read_b128 a[244:247], v2 offset:13312
v_cvt_pk_bf16_f32 v220, v172, v173
v_mfma_f32_16x16x32_bf16 a[52:55], a[212:215], v[196:199], 0
buffer_load_dwordx4 v1, s[36:39], s72 offen offset:2048 lds
v_mfma_f32_16x16x32_bf16 a[20:23], a[212:215], v[192:195], 0
v_exp_f32 v174, v174
v_mfma_f32_16x16x32_bf16 a[24:27], a[216:219], v[192:195], 0
v_exp_f32 v175, v175
v_mfma_f32_16x16x32_bf16 a[56:59], a[216:219], v[196:199], 0
ds_read_b128 a[248:251], v2 offset:14336
v_cvt_pk_bf16_f32 v221, v174, v175
v_mfma_f32_16x16x32_bf16 a[88:91], a[216:219], v[200:203], 0
v_exp_f32 v188, v188
v_mfma_f32_16x16x32_bf16 a[120:123], a[216:219], v[204:207], 0
v_exp_f32 v189, v189
v_mfma_f32_16x16x32_bf16 a[124:127], a[220:223], v[204:207], 0
ds_read_b128 a[252:255], v2 offset:15360
v_cvt_pk_bf16_f32 v222, v188, v189
v_mfma_f32_16x16x32_bf16 a[92:95], a[220:223], v[200:203], 0
buffer_load_dwordx4 v1, s[36:39], s72 offen offset:3072 lds
v_mfma_f32_16x16x32_bf16 a[60:63], a[220:223], v[196:199], 0
v_exp_f32 v190, v190
v_mfma_f32_16x16x32_bf16 a[28:31], a[220:223], v[192:195], 0
v_exp_f32 v191, v191
v_mfma_f32_16x16x32_bf16 v[224:227], v[120:123], v[192:195], 0
v_cvt_pk_bf16_f32 v223, v190, v191
v_add_u32 v2, s82, v1
v_mfma_f32_16x16x32_bf16 v[228:231], v[120:123], v[196:199], 0
v_and_b32 v240, 15, v0
v_lshrrev_b32 v241, 4, v0
v_mfma_f32_16x16x32_bf16 v[232:235], v[120:123], v[200:203], 0
s_waitcnt vmcnt(12) lgkmcnt(8)
v_mfma_f32_16x16x32_bf16 v[236:239], v[120:123], v[204:207], 0
s_barrier
v_add_u32 v248, 1, v240
v_and_b32 v249, 3, v248
v_lshrrev_b32 v248, 2, v248
v_mov_b32 v250, 0x20000
v_mov_b32 v252, 0x20001
v_lshlrev_b32 v6, 3, v249
v_lshrrev_b32 v6, v6, v252
v_and_b32 v6, 3, v6
v_cmp_ne_u32 vcc, 1, v249
v_mul_u32_u24 v6, 16640, v6
v_add_u32 v6, s92, v6
v_cndmask_b32 v6, v250, v6, vcc
v_add_u32 v253, s58, v249
v_and_b32 v253, 3, v253
v_mul_u32_u24 v253, 4160, v253
v_add_u32 v6, v6, v253
s_branch LLT3
.p2align 12
s_endpgm
.p2align 7
LLT3x:
Lstub11:
s_cbranch_execz Lret
s_cmp_eq_u32 s58, 2
s_cbranch_scc1 Lta40
s_cmp_eq_u32 s58, 3
s_cbranch_scc1 Lnt41
v_mfma_f32_16x16x32_bf16 v[164:167], a[160:163], v[32:35], v[112:115]
s_xor_b32 s74, s82, 0x10000
ds_read_b128 a[128:131], v2 offset:16384
v_mfma_f32_16x16x32_bf16 v[180:183], a[176:179], v[32:35], v[112:115]
s_add_u32 s74, s74, s64
v_exp_f32 v132, v132
s_branch Ljoin42
Lta40:
v_mfma_f32_16x16x32_bf16 v[164:167], a[160:163], v[32:35], v[100:103]
s_xor_b32 s74, s82, 0x10000
ds_read_b128 a[128:131], v2 offset:16384
v_mfma_f32_16x16x32_bf16 v[180:183], a[176:179], v[32:35], v[112:115]
s_add_u32 s74, s74, s64
v_exp_f32 v132, v132
s_branch Ljoin42
Lnt41:
v_mfma_f32_16x16x32_bf16 v[164:167], a[160:163], v[32:35], v[84:87]
s_xor_b32 s74, s82, 0x10000
ds_read_b128 a[128:131], v2 offset:16384
v_mfma_f32_16x16x32_bf16 v[180:183], a[176:179], v[32:35], v[100:103]
s_add_u32 s74, s74, s64
v_exp_f32 v132, v132
Ljoin42:
v_mfma_f32_16x16x32_bf16 v[164:167], a[164:167], v[36:39], v[164:167]
s_add_u32 s81, s81, 0x8000
v_exp_f32 v133, v133
v_mfma_f32_16x16x32_bf16 v[164:167], a[168:171], v[40:43], v[164:167]
s_add_u32 m0, s74, 0
ds_read_b128 a[132:135], v2 offset:17408
v_cvt_pk_bf16_f32 v196, v132, v133
v_mfma_f32_16x16x32_bf16 v[164:167], a[172:175], v[44:47], v[164:167]
s_add_u32 s72, s81, 0
v_exp_f32 v134, v134
v_mfma_f32_16x16x32_bf16 v[168:171], a[172:175], v[60:63], v[88:91]
ds_read_b128 a[136:139], v2 offset:18432
v_bfe_u32 v251, v0, 2, 2
v_mfma_f32_16x16x32_bf16 v[168:171], a[168:171], v[56:59], v[168:171]
v_exp_f32 v135, v135
v_mfma_f32_16x16x32_bf16 v[168:171], a[164:167], v[52:55], v[168:171]
buffer_load_dwordx4 v1, s[44:47], s72 offen sc1 lds
v_mfma_f32_16x16x32_bf16 v[168:171], a[160:163], v[48:51], v[168:171]
v_exp_f32 v148, v148
v_mfma_f32_16x16x32_bf16 v[172:175], a[160:163], v[64:67], v[92:95]
ds_read_b128 a[140:143], v2 offset:19456
v_cvt_pk_bf16_f32 v197, v134, v135
v_mfma_f32_16x16x32_bf16 v[172:175], a[164:167], v[68:71], v[172:175]
v_exp_f32 v149, v149
v_mfma_f32_16x16x32_bf16 v[172:175], a[168:171], v[72:75], v[172:175]
ds_read_b128 a[144:147], v2 offset:20480
v_cvt_pk_bf16_f32 v198, v148, v149
v_mfma_f32_16x16x32_bf16 v[172:175], a[172:175], v[76:79], v[172:175]
v_exp_f32 v150, v150
v_mfma_f32_16x16x32_bf16 v[188:191], a[188:191], v[76:79], v[92:95]
v_exp_f32 v151, v151
v_mfma_f32_16x16x32_bf16 v[188:191], a[184:187], v[72:75], v[188:191]
ds_read_b128 a[148:151], v2 offset:21504
v_cvt_pk_bf16_f32 v199, v150, v151
v_mfma_f32_16x16x32_bf16 v[188:191], a[180:183], v[68:71], v[188:191]
v_exp_f32 v136, v136
v_mfma_f32_16x16x32_bf16 v[188:191], a[176:179], v[64:67], v[188:191]
ds_read_b128 a[152:155], v2 offset:22528
v_lshl_add_u32 v6, v248, 3, v6
v_mfma_f32_16x16x32_bf16 v[184:187], a[176:179], v[48:51], v[88:91]
v_exp_f32 v137, v137
v_mfma_f32_16x16x32_bf16 v[184:187], a[180:183], v[52:55], v[184:187]
buffer_load_dwordx4 v1, s[44:47], s72 offen offset:1024 sc1 lds
v_mfma_f32_16x16x32_bf16 v[184:187], a[184:187], v[56:59], v[184:187]
v_exp_f32 v138, v138
v_mfma_f32_16x16x32_bf16 v[184:187], a[188:191], v[60:63], v[184:187]
ds_read_b128 a[156:159], v2 offset:23552
v_cvt_pk_bf16_f32 v200, v136, v137
v_mfma_f32_16x16x32_bf16 v[180:183], a[188:191], v[44:47], v[180:183]
v_exp_f32 v139, v139
v_mfma_f32_16x16x32_bf16 v[180:183], a[184:187], v[40:43], v[180:183]
ds_read_b128 a[192:195], v2 offset:0
v_cvt_pk_bf16_f32 v201, v138, v139
v_mfma_f32_16x16x32_bf16 v[180:183], a[180:183], v[36:39], v[180:183]
s_waitcnt lgkmcnt(9)
v_exp_f32 v152, v152
v_mfma_f32_16x16x32_bf16 a[0:3], a[224:227], v[208:211], a[0:3]
v_exp_f32 v153, v153
v_mfma_f32_16x16x32_bf16 a[32:35], a[224:227], v[212:215], a[32:35]
ds_read_b128 a[196:199], v2 offset:1024
v_cvt_pk_bf16_f32 v202, v152, v153
v_mfma_f32_16x16x32_bf16 a[64:67], a[224:227], v[216:219], a[64:67]
v_exp_f32 v154, v154
v_mfma_f32_16x16x32_bf16 a[96:99], a[224:227], v[220:223], a[96:99]
ds_read_b128 a[200:203], v2 offset:2048
v_lshl_add_u32 v6, v241, 4, v6
v_mfma_f32_16x16x32_bf16 a[100:103], a[228:231], v[220:223], a[100:103]
v_exp_f32 v155, v155
v_mfma_f32_16x16x32_bf16 a[68:71], a[228:231], v[216:219], a[68:71]
buffer_load_dwordx4 v1, s[44:47], s72 offen offset:2048 sc1 lds
v_mfma_f32_16x16x32_bf16 a[36:39], a[228:231], v[212:215], a[36:39]
v_exp_f32 v140, v140
v_mfma_f32_16x16x32_bf16 a[4:7], a[228:231], v[208:211], a[4:7]
ds_read_b128 a[204:207], v2 offset:3072
v_cvt_pk_bf16_f32 v203, v154, v155
v_mfma_f32_16x16x32_bf16 a[8:11], a[232:235], v[208:211], a[8:11]
v_exp_f32 v141, v141
v_mfma_f32_16x16x32_bf16 a[40:43], a[232:235], v[212:215], a[40:43]
ds_read_b128 a[208:211], v2 offset:4096
v_cvt_pk_bf16_f32 v204, v140, v141
v_mfma_f32_16x16x32_bf16 a[72:75], a[232:235], v[216:219], a[72:75]
v_exp_f32 v142, v142
v_mfma_f32_16x16x32_bf16 a[104:107], a[232:235], v[220:223], a[104:107]
v_exp_f32 v143, v143
v_mfma_f32_16x16x32_bf16 a[108:111], a[236:239], v[220:223], a[108:111]
ds_read_b128 a[212:215], v2 offset:5120
v_cvt_pk_bf16_f32 v205, v142, v143
v_mfma_f32_16x16x32_bf16 a[76:79], a[236:239], v[216:219], a[76:79]
v_exp_f32 v156, v156
v_mfma_f32_16x16x32_bf16 a[44:47], a[236:239], v[212:215], a[44:47]
ds_read_b128 a[216:219], v2 offset:6144
v_lshlrev_b32 v5, 3, v251
v_mfma_f32_16x16x32_bf16 a[12:15], a[236:239], v[208:211], a[12:15]
v_exp_f32 v157, v157
v_mfma_f32_16x16x32_bf16 a[16:19], a[240:243], v[208:211], a[16:19]
buffer_load_dwordx4 v1, s[44:47], s72 offen offset:3072 sc1 lds
v_mfma_f32_16x16x32_bf16 a[48:51], a[240:243], v[212:215], a[48:51]
v_exp_f32 v158, v158
v_mfma_f32_16x16x32_bf16 a[80:83], a[240:243], v[216:219], a[80:83]
ds_read_b128 a[220:223], v2 offset:7168
v_cvt_pk_bf16_f32 v206, v156, v157
v_mfma_f32_16x16x32_bf16 a[112:115], a[240:243], v[220:223], a[112:115]
v_exp_f32 v159, v159
v_mfma_f32_16x16x32_bf16 a[116:119], a[244:247], v[220:223], a[116:119]
v_cvt_pk_bf16_f32 v207, v158, v159
v_lshrrev_b32 v5, v5, v252
v_mfma_f32_16x16x32_bf16 a[84:87], a[244:247], v[216:219], a[84:87]
v_and_b32 v5, 3, v5
v_cmp_ne_u32 vcc, 1, v251
v_mfma_f32_16x16x32_bf16 a[52:55], a[244:247], v[212:215], a[52:55]
v_mul_u32_u24 v5, 16640, v5
v_add_u32 v5, s92, v5
v_mfma_f32_16x16x32_bf16 a[20:23], a[244:247], v[208:211], a[20:23]
v_cndmask_b32 v5, v250, v5, vcc
v_add_u32 v253, s58, v251
v_mfma_f32_16x16x32_bf16 a[24:27], a[248:251], v[208:211], a[24:27]
v_and_b32 v253, 3, v253
v_mul_u32_u24 v253, 4160, v253
v_mfma_f32_16x16x32_bf16 a[56:59], a[248:251], v[212:215], a[56:59]
v_add_u32 v5, v5, v253
v_mfma_f32_16x16x32_bf16 a[88:91], a[248:251], v[216:219], a[88:91]
s_add_u32 s73, s62, 480
v_lshlrev_b32 v248, 5, v240
v_sub_u32 v248, s73, v248
v_mfma_f32_16x16x32_bf16 a[120:123], a[248:251], v[220:223], a[120:123]
v_lshl_add_u32 v7, v241, 4, v248
v_mfma_f32_16x16x32_bf16 a[124:127], a[252:255], v[220:223], a[124:127]
s_and_b32 s73, s58, 1
v_mfma_f32_16x16x32_bf16 a[92:95], a[252:255], v[216:219], a[92:95]
s_lshl_b32 s73, s73, 4
v_mfma_f32_16x16x32_bf16 a[60:63], a[252:255], v[212:215], a[60:63]
s_lshr_b32 s73, s90, s73
v_mfma_f32_16x16x32_bf16 a[28:31], a[252:255], v[208:211], a[28:31]
s_and_b32 s73, s73, 0xffff
v_lshl_add_u32 v248, v241, 3, v240
v_sub_u32 v248, 15, v248
v_mfma_f32_16x16x32_bf16 v[224:227], v[120:123], v[208:211], v[224:227]
v_and_b32 v249, 1, v248
v_lshlrev_b32 v249, 4, v249
v_mfma_f32_16x16x32_bf16 v[228:231], v[120:123], v[212:215], v[228:231]
v_lshlrev_b32 v249, v249, s73
v_lshrrev_b32 v248, 1, v248
v_mfma_f32_16x16x32_bf16 v[232:235], v[120:123], v[216:219], v[232:235]
s_waitcnt lgkmcnt(8)
v_mfma_f32_16x16x32_bf16 v[236:239], v[120:123], v[220:223], v[236:239]
s_barrier
s_cmp_eq_u32 s58, 0
s_cbranch_scc1 Lta43
s_cmp_eq_u32 s58, 1
s_cbranch_scc1 Lnt44
v_mfma_f32_16x16x32_bf16 v[136:139], a[128:131], v[48:51], v[88:91]
s_add_u32 s82, s82, 0x8000
ds_read_b128 a[160:163], v2 offset:24576
ds_read_b128 a[164:167], v2 offset:25600
v_mfma_f32_16x16x32_bf16 v[152:155], a[144:147], v[48:51], v[88:91]
s_and_b32 s82, s82, 0x1ffff
v_exp_f32 v164, v164
s_branch Ljoin45
Lta43:
v_mfma_f32_16x16x32_bf16 v[136:139], a[128:131], v[48:51], v[104:107]
s_add_u32 s82, s82, 0x8000
ds_read_b128 a[160:163], v2 offset:24576
ds_read_b128 a[164:167], v2 offset:25600
v_mfma_f32_16x16x32_bf16 v[152:155], a[144:147], v[48:51], v[112:115]
s_and_b32 s82, s82, 0x1ffff
v_exp_f32 v164, v164
s_branch Ljoin45
Lnt44:
v_mfma_f32_16x16x32_bf16 v[136:139], a[128:131], v[48:51], v[88:91]
s_add_u32 s82, s82, 0x8000
ds_read_b128 a[160:163], v2 offset:24576
ds_read_b128 a[164:167], v2 offset:25600
v_mfma_f32_16x16x32_bf16 v[152:155], a[144:147], v[48:51], v[104:107]
s_and_b32 s82, s82, 0x1ffff
v_exp_f32 v164, v164
Ljoin45:
v_mfma_f32_16x16x32_bf16 v[136:139], a[132:135], v[52:55], v[136:139]
s_add_u32 s66, s58, 3
v_exp_f32 v165, v165
v_mfma_f32_16x16x32_bf16 v[136:139], a[136:139], v[56:59], v[136:139]
s_and_b32 s66, s66, 3
v_exp_f32 v166, v166
v_mfma_f32_16x16x32_bf16 v[136:139], a[140:143], v[60:63], v[136:139]
s_mul_i32 s66, s66, 4160
ds_read_b128 a[168:171], v2 offset:26624
v_cvt_pk_bf16_f32 v212, v164, v165
v_mfma_f32_16x16x32_bf16 v[140:143], a[140:143], v[76:79], v[92:95]
s_add_u32 s66, s66, s92
v_exp_f32 v167, v167
v_mfma_f32_16x16x32_bf16 v[140:143], a[136:139], v[72:75], v[140:143]
s_add_u32 m0, s66, 32
v_exp_f32 v180, v180
v_mfma_f32_16x16x32_bf16 v[140:143], a[132:135], v[68:71], v[140:143]
s_add_u32 s72, s93, 0x6
buffer_load_dwordx4 v1, s[36:39], s72 offen lds
v_mfma_f32_16x16x32_bf16 v[140:143], a[128:131], v[64:67], v[140:143]
ds_read_b128 a[172:175], v2 offset:27648
v_cvt_pk_bf16_f32 v213, v166, v167
v_mfma_f32_16x16x32_bf16 v[156:159], a[144:147], v[64:67], v[92:95]
v_exp_f32 v181, v181
v_mfma_f32_16x16x32_bf16 v[156:159], a[148:151], v[68:71], v[156:159]
ds_read_b128 a[176:179], v2 offset:28672
v_cvt_pk_bf16_f32 v214, v180, v181
v_mfma_f32_16x16x32_bf16 v[156:159], a[152:155], v[72:75], v[156:159]
v_exp_f32 v182, v182
v_mfma_f32_16x16x32_bf16 v[156:159], a[156:159], v[76:79], v[156:159]
v_exp_f32 v183, v183
v_mfma_f32_16x16x32_bf16 v[152:155], a[156:159], v[60:63], v[152:155]
ds_read_b128 a[180:183], v2 offset:29696
v_cvt_pk_bf16_f32 v215, v182, v183
v_mfma_f32_16x16x32_bf16 v[152:155], a[152:155], v[56:59], v[152:155]
v_exp_f32 v168, v168
v_mfma_f32_16x16x32_bf16 v[152:155], a[148:151], v[52:55], v[152:155]
s_waitcnt lgkmcnt(6)
ds_read_b128 a[184:187], v2 offset:30720
ds_read_b128 a[188:191], v2 offset:31744
v_mfma_f32_16x16x32_bf16 a[32:35], a[192:195], v[196:199], a[32:35]
v_exp_f32 v169, v169
v_mfma_f32_16x16x32_bf16 a[64:67], a[192:195], v[200:203], a[64:67]
buffer_load_dwordx4 v1, s[36:39], s72 offen offset:1024 lds
v_mfma_f32_16x16x32_bf16 a[96:99], a[192:195], v[204:207], a[96:99]
v_exp_f32 v170, v170
v_mfma_f32_16x16x32_bf16 a[100:103], a[196:199], v[204:207], a[100:103]
v_exp_f32 v171, v171
v_mfma_f32_16x16x32_bf16 a[68:71], a[196:199], v[200:203], a[68:71]
ds_read_b128 a[224:227], v2 offset:8192
v_cvt_pk_bf16_f32 v216, v168, v169
v_mfma_f32_16x16x32_bf16 a[36:39], a[196:199], v[196:199], a[36:39]
v_exp_f32 v184, v184
v_mfma_f32_16x16x32_bf16 a[40:43], a[200:203], v[196:199], a[40:43]
v_exp_f32 v185, v185
v_mfma_f32_16x16x32_bf16 a[72:75], a[200:203], v[200:203], a[72:75]
ds_read_b128 a[228:231], v2 offset:9216
v_cvt_pk_bf16_f32 v217, v170, v171
v_mfma_f32_16x16x32_bf16 a[104:107], a[200:203], v[204:207], a[104:107]
v_exp_f32 v186, v186
v_mfma_f32_16x16x32_bf16 a[108:111], a[204:207], v[204:207], a[108:111]
ds_read_b128 a[232:235], v2 offset:10240
v_cvt_pk_bf16_f32 v218, v184, v185
v_mfma_f32_16x16x32_bf16 a[76:79], a[204:207], v[200:203], a[76:79]
v_exp_f32 v187, v187
v_mfma_f32_16x16x32_bf16 a[44:47], a[204:207], v[196:199], a[44:47]
buffer_load_dwordx4 v1, s[36:39], s72 offen offset:2048 lds
v_mfma_f32_16x16x32_bf16 a[48:51], a[208:211], v[196:199], a[48:51]
v_exp_f32 v172, v172
v_mfma_f32_16x16x32_bf16 a[80:83], a[208:211], v[200:203], a[80:83]
ds_read_b128 a[236:239], v2 offset:11264
v_cvt_pk_bf16_f32 v219, v186, v187
v_mfma_f32_16x16x32_bf16 a[112:115], a[208:211], v[204:207], a[112:115]
v_exp_f32 v173, v173
v_mfma_f32_16x16x32_bf16 a[116:119], a[212:215], v[204:207], a[116:119]
ds_read_b128 a[240:243], v2 offset:12288
v_cvt_pk_bf16_f32 v220, v172, v173
v_mfma_f32_16x16x32_bf16 a[84:87], a[212:215], v[200:203], a[84:87]
v_exp_f32 v174, v174
v_mfma_f32_16x16x32_bf16 a[52:55], a[212:215], v[196:199], a[52:55]
v_exp_f32 v175, v175
v_mfma_f32_16x16x32_bf16 a[56:59], a[216:219], v[196:199], a[56:59]
ds_read_b128 a[244:247], v2 offset:13312
v_cvt_pk_bf16_f32 v221, v174, v175
v_mfma_f32_16x16x32_bf16 a[88:91], a[216:219], v[200:203], a[88:91]
v_exp_f32 v188, v188
v_mfma_f32_16x16x32_bf16 a[120:123], a[216:219], v[204:207], a[120:123]
ds_read_b128 a[248:251], v2 offset:14336
v_mfma_f32_16x16x32_bf16 a[124:127], a[220:223], v[204:207], a[124:127]
v_exp_f32 v189, v189
v_mfma_f32_16x16x32_bf16 a[92:95], a[220:223], v[200:203], a[92:95]
buffer_load_dwordx4 v1, s[36:39], s72 offen offset:3072 lds
v_mfma_f32_16x16x32_bf16 a[60:63], a[220:223], v[196:199], a[60:63]
ds_read_b128 a[252:255], v2 offset:15360
v_cvt_pk_bf16_f32 v222, v188, v189
v_mfma_f32_16x16x32_bf16 v[228:231], v[120:123], v[196:199], v[228:231]
v_exp_f32 v190, v190
v_mfma_f32_16x16x32_bf16 v[232:235], v[120:123], v[200:203], v[232:235]
s_waitcnt vmcnt(8) lgkmcnt(0)
v_exp_f32 v191, v191
v_mfma_f32_16x16x32_bf16 v[236:239], v[120:123], v[204:207], v[236:239]
s_barrier
v_cvt_pk_bf16_f32 v223, v190, v191
v_add_u32 v2, s82, v1
s_cmp_eq_u32 s58, 2
s_cbranch_scc1 Lta46
s_cmp_eq_u32 s58, 3
s_cbranch_scc1 Lnt47
v_mfma_f32_16x16x32_bf16 v[168:171], a[160:163], v[48:51], v[112:115]
s_mov_b32 m0, s62
v_exp_f32 v136, v136
v_mfma_f32_16x16x32_bf16 v[184:187], a[176:179], v[48:51], v[112:115]
s_add_u32 s72, s93, 0x3000000
ds_read_b128 a[128:131], v2 offset:16384
s_branch Ljoin48
Lta46:
v_mfma_f32_16x16x32_bf16 v[168:171], a[160:163], v[48:51], v[104:107]
s_mov_b32 m0, s62
v_exp_f32 v136, v136
v_mfma_f32_16x16x32_bf16 v[184:187], a[176:179], v[48:51], v[112:115]
s_add_u32 s72, s93, 0x3000000
ds_read_b128 a[128:131], v2 offset:16384
s_branch Ljoin48
Lnt47:
v_mfma_f32_16x16x32_bf16 v[168:171], a[160:163], v[48:51], v[88:91]
s_mov_b32 m0, s62
v_exp_f32 v136, v136
v_mfma_f32_16x16x32_bf16 v[184:187], a[176:179], v[48:51], v[104:107]
s_add_u32 s72, s93, 0x3000000
ds_read_b128 a[128:131], v2 offset:16384
Ljoin48:
v_mfma_f32_16x16x32_bf16 v[168:171], a[164:167], v[52:55], v[168:171]
buffer_load_dwordx4 v1, s[44:47], s72 offen sc1 lds
v_mfma_f32_16x16x32_bf16 v[168:171], a[168:171], v[56:59], v[168:171]
v_exp_f32 v137, v137
v_mfma_f32_16x16x32_bf16 v[168:171], a[172:175], v[60:63], v[168:171]
ds_read_b128 a[132:135], v2 offset:17408
v_cvt_pk_bf16_f32 v200, v136, v137
v_mfma_f32_16x16x32_bf16 v[172:175], a[172:175], v[76:79], v[92:95]
v_exp_f32 v138, v138
v_mfma_f32_16x16x32_bf16 v[172:175], a[168:171], v[72:75], v[172:175]
ds_read_b128 a[136:139], v2 offset:18432
v_and_b32 v241, 3, v0
v_mfma_f32_16x16x32_bf16 v[172:175], a[164:167], v[68:71], v[172:175]
buffer_load_dwordx4 v1, s[44:47], s72 offen offset:1024 sc1 lds
v_mfma_f32_16x16x32_bf16 v[172:175], a[160:163], v[64:67], v[172:175]
v_exp_f32 v139, v139
v_mfma_f32_16x16x32_bf16 v[188:191], a[176:179], v[64:67], v[92:95]
ds_read_b128 a[140:143], v2 offset:19456
v_cvt_pk_bf16_f32 v201, v138, v139
v_mfma_f32_16x16x32_bf16 v[188:191], a[180:183], v[68:71], v[188:191]
v_exp_f32 v152, v152
v_mfma_f32_16x16x32_bf16 v[188:191], a[184:187], v[72:75], v[188:191]
ds_read_b128 a[144:147], v2 offset:20480
v_cmp_eq_u32 vcc, 0, v248
v_mfma_f32_16x16x32_bf16 v[188:191], a[188:191], v[76:79], v[188:191]
buffer_load_dwordx4 v1, s[44:47], s72 offen offset:2048 sc1 lds
v_mfma_f32_16x16x32_bf16 v[184:187], a[188:191], v[60:63], v[184:187]
v_exp_f32 v153, v153
v_mfma_f32_16x16x32_bf16 v[184:187], a[184:187], v[56:59], v[184:187]
ds_read_b128 a[148:151], v2 offset:21504
v_cvt_pk_bf16_f32 v202, v152, v153
v_mfma_f32_16x16x32_bf16 v[184:187], a[180:183], v[52:55], v[184:187]
s_waitcnt lgkmcnt(6)
buffer_load_dwordx4 v1, s[44:47], s72 offen offset:3072 sc1 lds
v_mfma_f32_16x16x32_bf16 a[32:35], a[224:227], v[212:215], a[32:35]
s_add_u32 s66, s58, 0
v_exp_f32 v154, v154
v_mfma_f32_16x16x32_bf16 a[64:67], a[224:227], v[216:219], a[64:67]
s_and_b32 s66, s66, 3
ds_read_b128 a[152:155], v2 offset:22528
v_lshl_add_u32 v5, v241, 3, v5
v_mfma_f32_16x16x32_bf16 a[96:99], a[224:227], v[220:223], a[96:99]
s_mul_i32 s66, s66, 4160
v_exp_f32 v155, v155
v_mfma_f32_16x16x32_bf16 a[100:103], a[228:231], v[220:223], a[100:103]
s_add_u32 s66, s66, s92
ds_read_b128 a[156:159], v2 offset:23552
v_cvt_pk_bf16_f32 v203, v154, v155
v_mfma_f32_16x16x32_bf16 a[68:71], a[228:231], v[216:219], a[68:71]
s_add_u32 m0, s66, 16672
v_exp_f32 v140, v140
v_mfma_f32_16x16x32_bf16 a[36:39], a[228:231], v[212:215], a[36:39]
s_add_u32 s72, s93, 0x0
buffer_load_dwordx4 v1, s[36:39], s72 offen lds
v_mfma_f32_16x16x32_bf16 a[40:43], a[232:235], v[212:215], a[40:43]
ds_read_b128 a[192:195], v2 offset:0
v_cndmask_b32 v8, 0, v249, vcc
v_mfma_f32_16x16x32_bf16 a[72:75], a[232:235], v[216:219], a[72:75]
buffer_load_dwordx4 v1, s[36:39], s72 offen offset:1024 lds
v_mfma_f32_16x16x32_bf16 a[104:107], a[232:235], v[220:223], a[104:107]
v_exp_f32 v141, v141
v_mfma_f32_16x16x32_bf16 a[108:111], a[236:239], v[220:223], a[108:111]
ds_read_b128 a[196:199], v2 offset:1024
v_cvt_pk_bf16_f32 v204, v140, v141
v_mfma_f32_16x16x32_bf16 a[76:79], a[236:239], v[216:219], a[76:79]
v_exp_f32 v142, v142
v_mfma_f32_16x16x32_bf16 a[44:47], a[236:239], v[212:215], a[44:47]
ds_read_b128 a[200:203], v2 offset:2048
v_cmp_eq_u32 vcc, 1, v248
v_mfma_f32_16x16x32_bf16 a[48:51], a[240:243], v[212:215], a[48:51]
buffer_load_dwordx4 v1, s[36:39], s72 offen offset:2048 lds
v_mfma_f32_16x16x32_bf16 a[80:83], a[240:243], v[216:219], a[80:83]
v_exp_f32 v143, v143
v_mfma_f32_16x16x32_bf16 a[112:115], a[240:243], v[220:223], a[112:115]
ds_read_b128 a[204:207], v2 offset:3072
v_cvt_pk_bf16_f32 v205, v142, v143
v_mfma_f32_16x16x32_bf16 a[116:119], a[244:247], v[220:223], a[116:119]
v_exp_f32 v156, v156
v_mfma_f32_16x16x32_bf16 a[84:87], a[244:247], v[216:219], a[84:87]
ds_read_b128 a[208:211], v2 offset:4096
v_lshlrev_b32 v240, 4, v251
v_mfma_f32_16x16x32_bf16 a[52:55], a[244:247], v[212:215], a[52:55]
buffer_load_dwordx4 v1, s[36:39], s72 offen offset:3072 lds
v_mfma_f32_16x16x32_bf16 a[56:59], a[248:251], v[212:215], a[56:59]
s_add_u32 s66, s58, 2
v_exp_f32 v157, v157
v_mfma_f32_16x16x32_bf16 a[88:91], a[248:251], v[216:219], a[88:91]
s_and_b32 s66, s66, 3
ds_read_b128 a[212:215], v2 offset:5120
v_cvt_pk_bf16_f32 v206, v156, v157
v_mfma_f32_16x16x32_bf16 a[120:123], a[248:251], v[220:223], a[120:123]
s_mul_i32 s66, s66, 4160
v_exp_f32 v158, v158
v_mfma_f32_16x16x32_bf16 a[124:127], a[252:255], v[220:223], a[124:127]
s_add_u32 s66, s66, s92
ds_read_b128 a[216:219], v2 offset:6144
v_cndmask_b32 v9, 0, v249, vcc
v_mfma_f32_16x16x32_bf16 a[92:95], a[252:255], v[216:219], a[92:95]
s_add_u32 m0, s66, 33312
v_exp_f32 v159, v159
v_mfma_f32_16x16x32_bf16 a[60:63], a[252:255], v[212:215], a[60:63]
s_add_u32 s72, s93, 0x4
buffer_load_dwordx4 v1, s[36:39], s72 offen lds
v_mfma_f32_16x16x32_bf16 v[228:231], v[120:123], v[212:215], v[228:231]
ds_read_b128 a[220:223], v2 offset:7168
v_cvt_pk_bf16_f32 v207, v158, v159
v_mfma_f32_16x16x32_bf16 v[232:235], v[120:123], v[216:219], v[232:235]
buffer_load_dwordx4 v1, s[36:39], s72 offen offset:1024 lds
v_mfma_f32_16x16x32_bf16 v[236:239], v[120:123], v[220:223], v[236:239]
s_waitcnt lgkmcnt(8)
v_cmp_eq_u32 vcc, 2, v248
v_sub_u32 v240, 48, v240
v_lshlrev_b64 v[12:13], 16, s[88:89]
v_cndmask_b32 v10, 0, v249, vcc
v_cmp_eq_u32 vcc, 3, v248
v_lshlrev_b64 v[12:13], v240, v[12:13]
s_nop 0
v_cndmask_b32 v11, 0, v249, vcc
v_cmp_eq_u32 vcc, 3, v241
s_add_u32 s73, s62, 4096
v_lshl_add_u32 v14, v0, 3, s73
v_cndmask_b32 v12, 0, v12, vcc
v_cndmask_b32 v13, 0, v13, vcc
v_lshrrev_b32 v15, 4, v0
v_lshlrev_b32 v15, 1, v15
v_and_b32 v240, 7, v0
v_xor_b32 v15, v15, v240
v_lshlrev_b32 v15, 4, v15
v_lshrrev_b32 v240, 3, v0
v_lshl_add_u32 v15, v240, 11, v15
s_lshr_b32 s75, s59, 3
s_lshl_b32 s75, s75, 2
s_add_u32 s75, s75, s65
s_lshl_b32 s76, s59, 1
s_and_b32 s76, s76, 8
s_add_u32 s76, s76, s60
s_lshl_b32 s94, s58, 16
s_lshl_b32 s80, s76, 7
s_add_u32 s94, s94, s80
s_lshl_b32 s80, s75, 18
s_add_u32 s80, s80, s94
v_rcp_f32 v224, v224
v_rcp_f32 v228, v228
s_lshl_b32 s73, s59, 12
s_add_u32 s73, s73, 0x2000000
s_lshl_b32 s70, s67, 2
s_add_u32 s70, s70, s73
v_mov_b32 v225, v224
v_accvgpr_read_b32 v240, a0
v_accvgpr_read_b32 v241, a1
v_accvgpr_read_b32 v242, a2
v_accvgpr_read_b32 v243, a3
v_accvgpr_read_b32 v244, a4
v_accvgpr_read_b32 v245, a5
v_accvgpr_read_b32 v246, a6
v_accvgpr_read_b32 v247, a7
v_pk_mul_f32 v[240:241], v[240:241], v[224:225]
v_pk_mul_f32 v[242:243], v[242:243], v[224:225]
v_pk_mul_f32 v[244:245], v[244:245], v[224:225]
v_pk_mul_f32 v[246:247], v[246:247], v[224:225]
buffer_load_dwordx4 v1, s[36:39], s72 offen offset:2048 lds
v_cvt_pk_bf16_f32 v128, v240, v241
v_cvt_pk_bf16_f32 v129, v242, v243
v_cvt_pk_bf16_f32 v130, v244, v245
v_cvt_pk_bf16_f32 v131, v246, v247
v_accvgpr_read_b32 v248, a8
v_accvgpr_read_b32 v249, a9
v_accvgpr_read_b32 v250, a10
v_accvgpr_read_b32 v251, a11
v_accvgpr_read_b32 v252, a12
v_accvgpr_read_b32 v253, a13
v_accvgpr_read_b32 v254, a14
v_accvgpr_read_b32 v255, a15
v_pk_mul_f32 v[248:249], v[248:249], v[224:225]
v_pk_mul_f32 v[250:251], v[250:251], v[224:225]
v_pk_mul_f32 v[252:253], v[252:253], v[224:225]
v_pk_mul_f32 v[254:255], v[254:255], v[224:225]
v_cvt_pk_bf16_f32 v144, v248, v249
v_cvt_pk_bf16_f32 v145, v250, v251
buffer_load_dwordx4 v1, s[36:39], s72 offen offset:3072 lds
v_cvt_pk_bf16_f32 v146, v252, v253
v_cvt_pk_bf16_f32 v147, v254, v255
v_accvgpr_read_b32 v240, a16
v_accvgpr_read_b32 v241, a17
v_accvgpr_read_b32 v242, a18
v_accvgpr_read_b32 v243, a19
v_accvgpr_read_b32 v244, a20
v_accvgpr_read_b32 v245, a21
v_accvgpr_read_b32 v246, a22
v_accvgpr_read_b32 v247, a23
v_pk_mul_f32 v[240:241], v[240:241], v[224:225]
v_pk_mul_f32 v[242:243], v[242:243], v[224:225]
v_pk_mul_f32 v[244:245], v[244:245], v[224:225]
v_pk_mul_f32 v[246:247], v[246:247], v[224:225]
v_cvt_pk_bf16_f32 v160, v240, v241
v_cvt_pk_bf16_f32 v161, v242, v243
v_cvt_pk_bf16_f32 v162, v244, v245
v_cvt_pk_bf16_f32 v163, v246, v247
buffer_load_dwordx4 v[80:83], v15, s[4:7], s80 offen
v_accvgpr_read_b32 v248, a24
v_accvgpr_read_b32 v249, a25
v_accvgpr_read_b32 v250, a26
v_accvgpr_read_b32 v251, a27
v_accvgpr_read_b32 v252, a28
v_accvgpr_read_b32 v253, a29
v_accvgpr_read_b32 v254, a30
v_accvgpr_read_b32 v255, a31
v_pk_mul_f32 v[248:249], v[248:249], v[224:225]
v_pk_mul_f32 v[250:251], v[250:251], v[224:225]
v_pk_mul_f32 v[252:253], v[252:253], v[224:225]
v_pk_mul_f32 v[254:255], v[254:255], v[224:225]
v_cvt_pk_bf16_f32 v176, v248, v249
v_cvt_pk_bf16_f32 v177, v250, v251
v_cvt_pk_bf16_f32 v178, v252, v253
v_cvt_pk_bf16_f32 v179, v254, v255
v_mov_b32 v229, v228
v_accvgpr_read_b32 v240, a32
s_add_u32 s80, s80, 0x4000
buffer_load_dwordx4 v[84:87], v15, s[4:7], s80 offen
v_accvgpr_read_b32 v241, a33
v_accvgpr_read_b32 v242, a34
v_accvgpr_read_b32 v243, a35
v_accvgpr_read_b32 v244, a36
v_accvgpr_read_b32 v245, a37
v_accvgpr_read_b32 v246, a38
v_accvgpr_read_b32 v247, a39
v_pk_mul_f32 v[240:241], v[240:241], v[228:229]
v_pk_mul_f32 v[242:243], v[242:243], v[228:229]
v_pk_mul_f32 v[244:245], v[244:245], v[228:229]
v_pk_mul_f32 v[246:247], v[246:247], v[228:229]
v_cvt_pk_bf16_f32 v132, v240, v241
v_cvt_pk_bf16_f32 v133, v242, v243
v_cvt_pk_bf16_f32 v134, v244, v245
v_cvt_pk_bf16_f32 v135, v246, v247
v_accvgpr_read_b32 v248, a40
v_accvgpr_read_b32 v249, a41
v_accvgpr_read_b32 v250, a42
s_add_u32 s80, s80, 0x4000
buffer_load_dwordx4 v[96:99], v15, s[4:7], s80 offen
v_accvgpr_read_b32 v251, a43
v_accvgpr_read_b32 v252, a44
v_accvgpr_read_b32 v253, a45
v_accvgpr_read_b32 v254, a46
v_accvgpr_read_b32 v255, a47
v_pk_mul_f32 v[248:249], v[248:249], v[228:229]
v_pk_mul_f32 v[250:251], v[250:251], v[228:229]
v_pk_mul_f32 v[252:253], v[252:253], v[228:229]
v_pk_mul_f32 v[254:255], v[254:255], v[228:229]
v_cvt_pk_bf16_f32 v148, v248, v249
v_cvt_pk_bf16_f32 v149, v250, v251
v_cvt_pk_bf16_f32 v150, v252, v253
v_cvt_pk_bf16_f32 v151, v254, v255
v_accvgpr_read_b32 v240, a48
v_accvgpr_read_b32 v241, a49
v_accvgpr_read_b32 v242, a50
v_accvgpr_read_b32 v243, a51
v_accvgpr_read_b32 v244, a52
s_add_u32 s80, s80, 0x4000
buffer_load_dwordx4 v[100:103], v15, s[4:7], s80 offen
v_accvgpr_read_b32 v245, a53
v_accvgpr_read_b32 v246, a54
v_accvgpr_read_b32 v247, a55
v_pk_mul_f32 v[240:241], v[240:241], v[228:229]
v_pk_mul_f32 v[242:243], v[242:243], v[228:229]
v_pk_mul_f32 v[244:245], v[244:245], v[228:229]
v_pk_mul_f32 v[246:247], v[246:247], v[228:229]
v_cvt_pk_bf16_f32 v164, v240, v241
v_cvt_pk_bf16_f32 v165, v242, v243
v_cvt_pk_bf16_f32 v166, v244, v245
v_cvt_pk_bf16_f32 v167, v246, v247
v_accvgpr_read_b32 v248, a56
v_accvgpr_read_b32 v249, a57
v_accvgpr_read_b32 v250, a58
v_accvgpr_read_b32 v251, a59
v_accvgpr_read_b32 v252, a60
v_accvgpr_read_b32 v253, a61
v_accvgpr_read_b32 v254, a62
v_accvgpr_read_b32 v255, a63
v_pk_mul_f32 v[248:249], v[248:249], v[228:229]
v_pk_mul_f32 v[250:251], v[250:251], v[228:229]
v_pk_mul_f32 v[252:253], v[252:253], v[228:229]
v_pk_mul_f32 v[254:255], v[254:255], v[228:229]
v_cvt_pk_bf16_f32 v180, v248, v249
v_cvt_pk_bf16_f32 v181, v250, v251
v_cvt_pk_bf16_f32 v182, v252, v253
v_cvt_pk_bf16_f32 v183, v254, v255
s_cmp_eq_u32 s58, 0
s_cbranch_scc1 Lta49
s_cmp_eq_u32 s58, 1
s_cbranch_scc1 Lnt50
v_mfma_f32_16x16x32_bf16 v[140:143], a[128:131], v[64:67], v[92:95]
s_add_u32 s82, s82, 0x8000
ds_read_b128 a[160:163], v2 offset:24576
ds_read_b128 a[164:167], v2 offset:25600
v_mfma_f32_16x16x32_bf16 v[156:159], a[144:147], v[64:67], v[92:95]
s_and_b32 s82, s82, 0x1ffff
v_exp_f32 v168, v168
s_branch Ljoin51
Lta49:
v_mfma_f32_16x16x32_bf16 v[140:143], a[128:131], v[64:67], v[108:111]
s_add_u32 s82, s82, 0x8000
ds_read_b128 a[160:163], v2 offset:24576
ds_read_b128 a[164:167], v2 offset:25600
v_mfma_f32_16x16x32_bf16 v[156:159], a[144:147], v[64:67], v[112:115]
s_and_b32 s82, s82, 0x1ffff
v_exp_f32 v168, v168
s_branch Ljoin51
Lnt50:
v_mfma_f32_16x16x32_bf16 v[140:143], a[128:131], v[64:67], v[92:95]
s_add_u32 s82, s82, 0x8000
ds_read_b128 a[160:163], v2 offset:24576
ds_read_b128 a[164:167], v2 offset:25600
v_mfma_f32_16x16x32_bf16 v[156:159], a[144:147], v[64:67], v[108:111]
s_and_b32 s82, s82, 0x1ffff
v_exp_f32 v168, v168
Ljoin51:
v_mfma_f32_16x16x32_bf16 v[140:143], a[132:135], v[68:71], v[140:143]
v_exp_f32 v169, v169
v_mfma_f32_16x16x32_bf16 v[140:143], a[136:139], v[72:75], v[140:143]
ds_read_b128 a[168:171], v2 offset:26624
ds_read_b128 a[172:175], v2 offset:27648
v_mfma_f32_16x16x32_bf16 v[140:143], a[140:143], v[76:79], v[140:143]
v_exp_f32 v170, v170
v_mfma_f32_16x16x32_bf16 v[156:159], a[156:159], v[76:79], v[156:159]
v_exp_f32 v171, v171
v_mfma_f32_16x16x32_bf16 v[156:159], a[152:155], v[72:75], v[156:159]
buffer_store_dwordx4 v[128:131], v1, s[44:47], s70 offen sc1
v_mfma_f32_16x16x32_bf16 v[156:159], a[148:151], v[68:71], v[156:159]
s_waitcnt lgkmcnt(4)
ds_read_b128 a[176:179], v2 offset:28672
ds_read_b128 a[180:183], v2 offset:29696
v_mfma_f32_16x16x32_bf16 a[64:67], a[192:195], v[200:203], a[64:67]
v_exp_f32 v184, v184
v_mfma_f32_16x16x32_bf16 a[96:99], a[192:195], v[204:207], a[96:99]
ds_read_b128 a[184:187], v2 offset:30720
ds_read_b128 a[188:191], v2 offset:31744
v_mfma_f32_16x16x32_bf16 a[100:103], a[196:199], v[204:207], a[100:103]
ds_read_b128 a[224:227], v2 offset:8192
ds_read_b128 a[228:231], v2 offset:9216
v_mfma_f32_16x16x32_bf16 a[68:71], a[196:199], v[200:203], a[68:71]
ds_read_b128 a[232:235], v2 offset:10240
ds_read_b128 a[236:239], v2 offset:11264
v_mfma_f32_16x16x32_bf16 a[72:75], a[200:203], v[200:203], a[72:75]
ds_read_b128 a[240:243], v2 offset:12288
ds_read_b128 a[244:247], v2 offset:13312
v_mfma_f32_16x16x32_bf16 a[104:107], a[200:203], v[204:207], a[104:107]
ds_read_b128 a[248:251], v2 offset:14336
ds_read_b128 a[252:255], v2 offset:15360
v_mfma_f32_16x16x32_bf16 a[108:111], a[204:207], v[204:207], a[108:111]
v_cvt_pk_bf16_f32 v216, v168, v169
v_cvt_pk_bf16_f32 v217, v170, v171
v_mfma_f32_16x16x32_bf16 a[76:79], a[204:207], v[200:203], a[76:79]
v_exp_f32 v185, v185
v_mfma_f32_16x16x32_bf16 a[80:83], a[208:211], v[200:203], a[80:83]
v_exp_f32 v186, v186
v_mfma_f32_16x16x32_bf16 a[112:115], a[208:211], v[204:207], a[112:115]
v_exp_f32 v187, v187
v_mfma_f32_16x16x32_bf16 a[116:119], a[212:215], v[204:207], a[116:119]
v_exp_f32 v172, v172
v_mfma_f32_16x16x32_bf16 a[84:87], a[212:215], v[200:203], a[84:87]
buffer_store_dwordx4 v[144:147], v1, s[44:47], s70 offen offset:1024 sc1
v_mfma_f32_16x16x32_bf16 a[88:91], a[216:219], v[200:203], a[88:91]
v_cvt_pk_bf16_f32 v218, v184, v185
v_cvt_pk_bf16_f32 v219, v186, v187
v_mfma_f32_16x16x32_bf16 a[120:123], a[216:219], v[204:207], a[120:123]
v_exp_f32 v173, v173
v_mfma_f32_16x16x32_bf16 a[124:127], a[220:223], v[204:207], a[124:127]
v_exp_f32 v174, v174
v_mfma_f32_16x16x32_bf16 a[92:95], a[220:223], v[200:203], a[92:95]
buffer_store_dwordx4 v[160:163], v1, s[44:47], s70 offen offset:2048 sc1
v_mfma_f32_16x16x32_bf16 v[232:235], v[120:123], v[200:203], v[232:235]
s_waitcnt vmcnt(23) lgkmcnt(8)
v_exp_f32 v175, v175
v_mfma_f32_16x16x32_bf16 v[236:239], v[120:123], v[204:207], v[236:239]
s_barrier
v_exp_f32 v188, v188
v_add_u32 v2, s82, v1
v_cvt_pk_bf16_f32 v220, v172, v173
v_cvt_pk_bf16_f32 v221, v174, v175
v_exp_f32 v189, v189
v_exp_f32 v190, v190
v_cvt_pk_bf16_f32 v222, v188, v189
v_exp_f32 v191, v191
s_nop 0
v_cvt_pk_bf16_f32 v223, v190, v191
s_cmp_eq_u32 s58, 2
s_cbranch_scc1 Lta52
s_cmp_eq_u32 s58, 3
s_cbranch_scc1 Lnt53
v_mfma_f32_16x16x32_bf16 v[172:175], a[160:163], v[64:67], v[112:115]
v_exp_f32 v140, v140
v_mfma_f32_16x16x32_bf16 v[188:191], a[176:179], v[64:67], v[112:115]
ds_read_b128 a[192:195], v2 offset:0
s_branch Ljoin54
Lta52:
v_mfma_f32_16x16x32_bf16 v[172:175], a[160:163], v[64:67], v[108:111]
v_exp_f32 v140, v140
v_mfma_f32_16x16x32_bf16 v[188:191], a[176:179], v[64:67], v[112:115]
ds_read_b128 a[192:195], v2 offset:0
s_branch Ljoin54
Lnt53:
v_mfma_f32_16x16x32_bf16 v[172:175], a[160:163], v[64:67], v[92:95]
v_exp_f32 v140, v140
v_mfma_f32_16x16x32_bf16 v[188:191], a[176:179], v[64:67], v[108:111]
ds_read_b128 a[192:195], v2 offset:0
Ljoin54:
v_mfma_f32_16x16x32_bf16 v[172:175], a[164:167], v[68:71], v[172:175]
v_exp_f32 v141, v141
v_mfma_f32_16x16x32_bf16 v[172:175], a[168:171], v[72:75], v[172:175]
ds_read_b128 a[196:199], v2 offset:1024
v_cvt_pk_bf16_f32 v204, v140, v141
v_mfma_f32_16x16x32_bf16 v[172:175], a[172:175], v[76:79], v[172:175]
buffer_store_dwordx4 v[176:179], v1, s[44:47], s70 offen offset:3072 sc1
v_mfma_f32_16x16x32_bf16 v[188:191], a[188:191], v[76:79], v[188:191]
s_add_u32 s70, s70, 0x80000
v_exp_f32 v142, v142
v_mfma_f32_16x16x32_bf16 v[188:191], a[184:187], v[72:75], v[188:191]
ds_read_b128 a[200:203], v2 offset:2048
v_mfma_f32_16x16x32_bf16 v[188:191], a[180:183], v[68:71], v[188:191]
s_waitcnt lgkmcnt(3)
v_exp_f32 v143, v143
v_mfma_f32_16x16x32_bf16 a[64:67], a[224:227], v[216:219], a[64:67]
ds_read_b128 a[204:207], v2 offset:3072
v_cvt_pk_bf16_f32 v205, v142, v143
v_mfma_f32_16x16x32_bf16 a[96:99], a[224:227], v[220:223], a[96:99]
v_exp_f32 v156, v156
v_mfma_f32_16x16x32_bf16 a[100:103], a[228:231], v[220:223], a[100:103]
ds_read_b128 a[208:211], v2 offset:4096
v_mfma_f32_16x16x32_bf16 a[68:71], a[228:231], v[216:219], a[68:71]
buffer_store_dwordx4 v[132:135], v1, s[44:47], s70 offen sc1
v_mfma_f32_16x16x32_bf16 a[72:75], a[232:235], v[216:219], a[72:75]
v_exp_f32 v157, v157
v_mfma_f32_16x16x32_bf16 a[104:107], a[232:235], v[220:223], a[104:107]
ds_read_b128 a[212:215], v2 offset:5120
v_cvt_pk_bf16_f32 v206, v156, v157
v_mfma_f32_16x16x32_bf16 a[108:111], a[236:239], v[220:223], a[108:111]
v_exp_f32 v158, v158
v_mfma_f32_16x16x32_bf16 a[76:79], a[236:239], v[216:219], a[76:79]
ds_read_b128 a[216:219], v2 offset:6144
v_mfma_f32_16x16x32_bf16 a[80:83], a[240:243], v[216:219], a[80:83]
buffer_store_dwordx4 v[148:151], v1, s[44:47], s70 offen offset:1024 sc1
v_mfma_f32_16x16x32_bf16 a[112:115], a[240:243], v[220:223], a[112:115]
v_exp_f32 v159, v159
v_mfma_f32_16x16x32_bf16 a[116:119], a[244:247], v[220:223], a[116:119]
ds_read_b128 a[220:223], v2 offset:7168
v_cvt_pk_bf16_f32 v207, v158, v159
v_mfma_f32_16x16x32_bf16 a[84:87], a[244:247], v[216:219], a[84:87]
v_mfma_f32_16x16x32_bf16 a[88:91], a[248:251], v[216:219], a[88:91]
v_mfma_f32_16x16x32_bf16 a[120:123], a[248:251], v[220:223], a[120:123]
v_mfma_f32_16x16x32_bf16 a[124:127], a[252:255], v[220:223], a[124:127]
v_mfma_f32_16x16x32_bf16 a[92:95], a[252:255], v[216:219], a[92:95]
v_mfma_f32_16x16x32_bf16 v[232:235], v[120:123], v[216:219], v[232:235]
v_mfma_f32_16x16x32_bf16 v[236:239], v[120:123], v[220:223], v[236:239]
s_waitcnt lgkmcnt(0)
v_mfma_f32_16x16x32_bf16 a[96:99], a[192:195], v[204:207], a[96:99]
s_add_u32 s82, s82, 0x8000
ds_read_b128 a[224:227], v2 offset:8192
ds_read_b128 a[228:231], v2 offset:9216
v_mfma_f32_16x16x32_bf16 a[100:103], a[196:199], v[204:207], a[100:103]
s_and_b32 s82, s82, 0x1ffff
v_exp_f32 v172, v172
v_mfma_f32_16x16x32_bf16 a[104:107], a[200:203], v[204:207], a[104:107]
ds_read_b128 a[232:235], v2 offset:10240
ds_read_b128 a[236:239], v2 offset:11264
v_mfma_f32_16x16x32_bf16 a[108:111], a[204:207], v[204:207], a[108:111]
buffer_store_dwordx4 v[164:167], v1, s[44:47], s70 offen offset:2048 sc1
v_mfma_f32_16x16x32_bf16 a[112:115], a[208:211], v[204:207], a[112:115]
ds_read_b128 a[240:243], v2 offset:12288
ds_read_b128 a[244:247], v2 offset:13312
v_mfma_f32_16x16x32_bf16 a[116:119], a[212:215], v[204:207], a[116:119]
ds_read_b128 a[248:251], v2 offset:14336
ds_read_b128 a[252:255], v2 offset:15360
v_mfma_f32_16x16x32_bf16 a[120:123], a[216:219], v[204:207], a[120:123]
buffer_store_dwordx4 v[180:183], v1, s[44:47], s70 offen offset:3072 sc1
v_mfma_f32_16x16x32_bf16 a[124:127], a[220:223], v[204:207], a[124:127]
s_waitcnt vmcnt(8) lgkmcnt(0)
v_exp_f32 v173, v173
v_mfma_f32_16x16x32_bf16 v[236:239], v[120:123], v[204:207], v[236:239]
s_barrier
v_exp_f32 v174, v174
v_add_u32 v2, s82, v1
v_cvt_pk_bf16_f32 v220, v172, v173
v_exp_f32 v175, v175
v_exp_f32 v188, v188
v_cvt_pk_bf16_f32 v221, v174, v175
v_exp_f32 v189, v189
v_exp_f32 v190, v190
v_cvt_pk_bf16_f32 v222, v188, v189
v_exp_f32 v191, v191
s_nop 0
v_cvt_pk_bf16_f32 v223, v190, v191
s_branch LHT4
Lslow:
s_waitcnt vmcnt(0) lgkmcnt(0)
s_barrier
s_mov_b32 s86, 1
s_lshl_b32 s81, s59, 20
s_add_u32 s81, s81, s64
s_sub_u32 s81, s81, 0x4000
s_mov_b32 s83, 0
s_lshl_b32 s75, s60, 3
s_sub_u32 s76, 128, s75
s_add_u32 s74, s75, s58
s_sub_u32 s75, s76, 8
s_add_u32 s75, s75, s58
v_mov_b32 v2, v1
v_lshrrev_b32 v240, 4, v0
v_and_b32 v241, 15, v0
v_lshlrev_b32 v240, 2, v240
v_sub_u32 v240, v241, v240
v_mov_b32 v112, 0xff800000
v_mov_b32 v113, 0xff800000
v_mov_b32 v114, 0xff800000
v_mov_b32 v115, 0xff800000
v_cmp_gt_i32 vcc, 0, v240
v_mov_b32 v120, 0x3f803f80
s_nop 0
v_cndmask_b32 v116, 0, v112, vcc
v_cmp_gt_i32 vcc, 1, v240
v_mov_b32 v121, 0x3f803f80
s_nop 0
v_cndmask_b32 v117, 0, v112, vcc
v_cmp_gt_i32 vcc, 2, v240
v_mov_b32 v122, 0x3f803f80
s_nop 0
v_cndmask_b32 v118, 0, v112, vcc
v_cmp_gt_i32 vcc, 3, v240
v_mov_b32 v123, 0x3f803f80
s_nop 0
v_cndmask_b32 v119, 0, v112, vcc
Lslow1:
s_add_u32 m0, s64, 16384
s_add_u32 s72, s81, 16384
buffer_load_dwordx4 v1, s[44:47], s72 offen sc1 lds
buffer_load_dwordx4 v1, s[44:47], s72 offen offset:1024 sc1 lds
buffer_load_dwordx4 v1, s[44:47], s72 offen offset:2048 sc1 lds
buffer_load_dwordx4 v1, s[44:47], s72 offen offset:3072 sc1 lds
s_add_u32 s81, s81, 0x8000
s_waitcnt vmcnt(0)
s_barrier
ds_read_b128 a[128:131], v2 offset:16384
ds_read_b128 a[132:135], v2 offset:17408
ds_read_b128 a[136:139], v2 offset:18432
ds_read_b128 a[140:143], v2 offset:19456
ds_read_b128 a[144:147], v2 offset:20480
ds_read_b128 a[148:151], v2 offset:21504
ds_read_b128 a[152:155], v2 offset:22528
ds_read_b128 a[156:159], v2 offset:23552
s_waitcnt lgkmcnt(0)
s_add_u32 s73, s74, 0
s_cmp_lt_u32 s73, s83
s_cbranch_scc1 Lsa55
s_cmp_eq_u32 s73, s83
s_cbranch_scc1 Lst56
v_mfma_f32_16x16x32_bf16 v[128:131], a[128:131], v[16:19], 0
s_branch Lsj57
Lst56:
v_mfma_f32_16x16x32_bf16 v[128:131], a[128:131], v[16:19], v[116:119]
Lsj57:
v_mfma_f32_16x16x32_bf16 v[128:131], a[132:135], v[20:23], v[128:131]
v_mfma_f32_16x16x32_bf16 v[128:131], a[136:139], v[24:27], v[128:131]
v_mfma_f32_16x16x32_bf16 v[128:131], a[140:143], v[28:31], v[128:131]
s_nop 7
v_max3_f32 v124, v124, v128, v129
v_max3_f32 v124, v124, v130, v131
Lsa55:
s_add_u32 s73, s74, 4
s_cmp_lt_u32 s73, s83
s_cbranch_scc1 Lsa58
s_cmp_eq_u32 s73, s83
s_cbranch_scc1 Lst59
v_mfma_f32_16x16x32_bf16 v[132:135], a[128:131], v[32:35], 0
s_branch Lsj60
Lst59:
v_mfma_f32_16x16x32_bf16 v[132:135], a[128:131], v[32:35], v[116:119]
Lsj60:
v_mfma_f32_16x16x32_bf16 v[132:135], a[132:135], v[36:39], v[132:135]
v_mfma_f32_16x16x32_bf16 v[132:135], a[136:139], v[40:43], v[132:135]
v_mfma_f32_16x16x32_bf16 v[132:135], a[140:143], v[44:47], v[132:135]
s_nop 7
v_max3_f32 v125, v125, v132, v133
v_max3_f32 v125, v125, v134, v135
Lsa58:
s_add_u32 s73, s75, 0
s_cmp_lt_u32 s73, s83
s_cbranch_scc1 Lsa61
s_cmp_eq_u32 s73, s83
s_cbranch_scc1 Lst62
v_mfma_f32_16x16x32_bf16 v[136:139], a[128:131], v[48:51], 0
s_branch Lsj63
Lst62:
v_mfma_f32_16x16x32_bf16 v[136:139], a[128:131], v[48:51], v[116:119]
Lsj63:
v_mfma_f32_16x16x32_bf16 v[136:139], a[132:135], v[52:55], v[136:139]
v_mfma_f32_16x16x32_bf16 v[136:139], a[136:139], v[56:59], v[136:139]
v_mfma_f32_16x16x32_bf16 v[136:139], a[140:143], v[60:63], v[136:139]
s_nop 7
v_max3_f32 v126, v126, v136, v137
v_max3_f32 v126, v126, v138, v139
Lsa61:
s_add_u32 s73, s75, 4
s_cmp_lt_u32 s73, s83
s_cbranch_scc1 Lsa64
s_cmp_eq_u32 s73, s83
s_cbranch_scc1 Lst65
v_mfma_f32_16x16x32_bf16 v[140:143], a[128:131], v[64:67], 0
s_branch Lsj66
Lst65:
v_mfma_f32_16x16x32_bf16 v[140:143], a[128:131], v[64:67], v[116:119]
Lsj66:
v_mfma_f32_16x16x32_bf16 v[140:143], a[132:135], v[68:71], v[140:143]
v_mfma_f32_16x16x32_bf16 v[140:143], a[136:139], v[72:75], v[140:143]
v_mfma_f32_16x16x32_bf16 v[140:143], a[140:143], v[76:79], v[140:143]
s_nop 7
v_max3_f32 v127, v127, v140, v141
v_max3_f32 v127, v127, v142, v143
Lsa64:
s_add_u32 s83, s83, 1
s_add_u32 s73, s74, 0
s_cmp_lt_u32 s73, s83
s_cbranch_scc1 Lsa67
s_cmp_eq_u32 s73, s83
s_cbranch_scc1 Lst68
v_mfma_f32_16x16x32_bf16 v[144:147], a[144:147], v[16:19], 0
s_branch Lsj69
Lst68:
v_mfma_f32_16x16x32_bf16 v[144:147], a[144:147], v[16:19], v[116:119]
Lsj69:
v_mfma_f32_16x16x32_bf16 v[144:147], a[148:151], v[20:23], v[144:147]
v_mfma_f32_16x16x32_bf16 v[144:147], a[152:155], v[24:27], v[144:147]
v_mfma_f32_16x16x32_bf16 v[144:147], a[156:159], v[28:31], v[144:147]
s_nop 7
v_max3_f32 v124, v124, v144, v145
v_max3_f32 v124, v124, v146, v147
Lsa67:
s_add_u32 s73, s74, 4
s_cmp_lt_u32 s73, s83
s_cbranch_scc1 Lsa70
s_cmp_eq_u32 s73, s83
s_cbranch_scc1 Lst71
v_mfma_f32_16x16x32_bf16 v[148:151], a[144:147], v[32:35], 0
s_branch Lsj72
Lst71:
v_mfma_f32_16x16x32_bf16 v[148:151], a[144:147], v[32:35], v[116:119]
Lsj72:
v_mfma_f32_16x16x32_bf16 v[148:151], a[148:151], v[36:39], v[148:151]
v_mfma_f32_16x16x32_bf16 v[148:151], a[152:155], v[40:43], v[148:151]
v_mfma_f32_16x16x32_bf16 v[148:151], a[156:159], v[44:47], v[148:151]
s_nop 7
v_max3_f32 v125, v125, v148, v149
v_max3_f32 v125, v125, v150, v151
Lsa70:
s_add_u32 s73, s75, 0
s_cmp_lt_u32 s73, s83
s_cbranch_scc1 Lsa73
s_cmp_eq_u32 s73, s83
s_cbranch_scc1 Lst74
v_mfma_f32_16x16x32_bf16 v[152:155], a[144:147], v[48:51], 0
s_branch Lsj75
Lst74:
v_mfma_f32_16x16x32_bf16 v[152:155], a[144:147], v[48:51], v[116:119]
Lsj75:
v_mfma_f32_16x16x32_bf16 v[152:155], a[148:151], v[52:55], v[152:155]
v_mfma_f32_16x16x32_bf16 v[152:155], a[152:155], v[56:59], v[152:155]
v_mfma_f32_16x16x32_bf16 v[152:155], a[156:159], v[60:63], v[152:155]
s_nop 7
v_max3_f32 v126, v126, v152, v153
v_max3_f32 v126, v126, v154, v155
Lsa73:
s_add_u32 s73, s75, 4
s_cmp_lt_u32 s73, s83
s_cbranch_scc1 Lsa76
s_cmp_eq_u32 s73, s83
s_cbranch_scc1 Lst77
v_mfma_f32_16x16x32_bf16 v[156:159], a[144:147], v[64:67], 0
s_branch Lsj78
Lst77:
v_mfma_f32_16x16x32_bf16 v[156:159], a[144:147], v[64:67], v[116:119]
Lsj78:
v_mfma_f32_16x16x32_bf16 v[156:159], a[148:151], v[68:71], v[156:159]
v_mfma_f32_16x16x32_bf16 v[156:159], a[152:155], v[72:75], v[156:159]
v_mfma_f32_16x16x32_bf16 v[156:159], a[156:159], v[76:79], v[156:159]
s_nop 7
v_max3_f32 v127, v127, v156, v157
v_max3_f32 v127, v127, v158, v159
Lsa76:
s_add_u32 s83, s83, 1
ds_read_b128 a[128:131], v2 offset:24576
ds_read_b128 a[132:135], v2 offset:25600
ds_read_b128 a[136:139], v2 offset:26624
ds_read_b128 a[140:143], v2 offset:27648
ds_read_b128 a[144:147], v2 offset:28672
ds_read_b128 a[148:151], v2 offset:29696
ds_read_b128 a[152:155], v2 offset:30720
ds_read_b128 a[156:159], v2 offset:31744
s_waitcnt lgkmcnt(0)
s_add_u32 s73, s74, 0
s_cmp_lt_u32 s73, s83
s_cbranch_scc1 Lsa79
s_cmp_eq_u32 s73, s83
s_cbranch_scc1 Lst80
v_mfma_f32_16x16x32_bf16 v[128:131], a[128:131], v[16:19], 0
s_branch Lsj81
Lst80:
v_mfma_f32_16x16x32_bf16 v[128:131], a[128:131], v[16:19], v[116:119]
Lsj81:
v_mfma_f32_16x16x32_bf16 v[128:131], a[132:135], v[20:23], v[128:131]
v_mfma_f32_16x16x32_bf16 v[128:131], a[136:139], v[24:27], v[128:131]
v_mfma_f32_16x16x32_bf16 v[128:131], a[140:143], v[28:31], v[128:131]
s_nop 7
v_max3_f32 v124, v124, v128, v129
v_max3_f32 v124, v124, v130, v131
Lsa79:
s_add_u32 s73, s74, 4
s_cmp_lt_u32 s73, s83
s_cbranch_scc1 Lsa82
s_cmp_eq_u32 s73, s83
s_cbranch_scc1 Lst83
v_mfma_f32_16x16x32_bf16 v[132:135], a[128:131], v[32:35], 0
s_branch Lsj84
Lst83:
v_mfma_f32_16x16x32_bf16 v[132:135], a[128:131], v[32:35], v[116:119]
Lsj84:
v_mfma_f32_16x16x32_bf16 v[132:135], a[132:135], v[36:39], v[132:135]
v_mfma_f32_16x16x32_bf16 v[132:135], a[136:139], v[40:43], v[132:135]
v_mfma_f32_16x16x32_bf16 v[132:135], a[140:143], v[44:47], v[132:135]
s_nop 7
v_max3_f32 v125, v125, v132, v133
v_max3_f32 v125, v125, v134, v135
Lsa82:
s_add_u32 s73, s75, 0
s_cmp_lt_u32 s73, s83
s_cbranch_scc1 Lsa85
s_cmp_eq_u32 s73, s83
s_cbranch_scc1 Lst86
v_mfma_f32_16x16x32_bf16 v[136:139], a[128:131], v[48:51], 0
s_branch Lsj87
Lst86:
v_mfma_f32_16x16x32_bf16 v[136:139], a[128:131], v[48:51], v[116:119]
Lsj87:
v_mfma_f32_16x16x32_bf16 v[136:139], a[132:135], v[52:55], v[136:139]
v_mfma_f32_16x16x32_bf16 v[136:139], a[136:139], v[56:59], v[136:139]
v_mfma_f32_16x16x32_bf16 v[136:139], a[140:143], v[60:63], v[136:139]
s_nop 7
v_max3_f32 v126, v126, v136, v137
v_max3_f32 v126, v126, v138, v139
Lsa85:
s_add_u32 s73, s75, 4
s_cmp_lt_u32 s73, s83
s_cbranch_scc1 Lsa88
s_cmp_eq_u32 s73, s83
s_cbranch_scc1 Lst89
v_mfma_f32_16x16x32_bf16 v[140:143], a[128:131], v[64:67], 0
s_branch Lsj90
Lst89:
v_mfma_f32_16x16x32_bf16 v[140:143], a[128:131], v[64:67], v[116:119]
Lsj90:
v_mfma_f32_16x16x32_bf16 v[140:143], a[132:135], v[68:71], v[140:143]
v_mfma_f32_16x16x32_bf16 v[140:143], a[136:139], v[72:75], v[140:143]
v_mfma_f32_16x16x32_bf16 v[140:143], a[140:143], v[76:79], v[140:143]
s_nop 7
v_max3_f32 v127, v127, v140, v141
v_max3_f32 v127, v127, v142, v143
Lsa88:
s_add_u32 s83, s83, 1
s_add_u32 s73, s74, 0
s_cmp_lt_u32 s73, s83
s_cbranch_scc1 Lsa91
s_cmp_eq_u32 s73, s83
s_cbranch_scc1 Lst92
v_mfma_f32_16x16x32_bf16 v[144:147], a[144:147], v[16:19], 0
s_branch Lsj93
Lst92:
v_mfma_f32_16x16x32_bf16 v[144:147], a[144:147], v[16:19], v[116:119]
Lsj93:
v_mfma_f32_16x16x32_bf16 v[144:147], a[148:151], v[20:23], v[144:147]
v_mfma_f32_16x16x32_bf16 v[144:147], a[152:155], v[24:27], v[144:147]
v_mfma_f32_16x16x32_bf16 v[144:147], a[156:159], v[28:31], v[144:147]
s_nop 7
v_max3_f32 v124, v124, v144, v145
v_max3_f32 v124, v124, v146, v147
Lsa91:
s_add_u32 s73, s74, 4
s_cmp_lt_u32 s73, s83
s_cbranch_scc1 Lsa94
s_cmp_eq_u32 s73, s83
s_cbranch_scc1 Lst95
v_mfma_f32_16x16x32_bf16 v[148:151], a[144:147], v[32:35], 0
s_branch Lsj96
Lst95:
v_mfma_f32_16x16x32_bf16 v[148:151], a[144:147], v[32:35], v[116:119]
Lsj96:
v_mfma_f32_16x16x32_bf16 v[148:151], a[148:151], v[36:39], v[148:151]
v_mfma_f32_16x16x32_bf16 v[148:151], a[152:155], v[40:43], v[148:151]
v_mfma_f32_16x16x32_bf16 v[148:151], a[156:159], v[44:47], v[148:151]
s_nop 7
v_max3_f32 v125, v125, v148, v149
v_max3_f32 v125, v125, v150, v151
Lsa94:
s_add_u32 s73, s75, 0
s_cmp_lt_u32 s73, s83
s_cbranch_scc1 Lsa97
s_cmp_eq_u32 s73, s83
s_cbranch_scc1 Lst98
v_mfma_f32_16x16x32_bf16 v[152:155], a[144:147], v[48:51], 0
s_branch Lsj99
Lst98:
v_mfma_f32_16x16x32_bf16 v[152:155], a[144:147], v[48:51], v[116:119]
Lsj99:
v_mfma_f32_16x16x32_bf16 v[152:155], a[148:151], v[52:55], v[152:155]
v_mfma_f32_16x16x32_bf16 v[152:155], a[152:155], v[56:59], v[152:155]
v_mfma_f32_16x16x32_bf16 v[152:155], a[156:159], v[60:63], v[152:155]
s_nop 7
v_max3_f32 v126, v126, v152, v153
v_max3_f32 v126, v126, v154, v155
Lsa97:
s_add_u32 s73, s75, 4
s_cmp_lt_u32 s73, s83
s_cbranch_scc1 Lsa100
s_cmp_eq_u32 s73, s83
s_cbranch_scc1 Lst101
v_mfma_f32_16x16x32_bf16 v[156:159], a[144:147], v[64:67], 0
s_branch Lsj102
Lst101:
v_mfma_f32_16x16x32_bf16 v[156:159], a[144:147], v[64:67], v[116:119]
Lsj102:
v_mfma_f32_16x16x32_bf16 v[156:159], a[148:151], v[68:71], v[156:159]
v_mfma_f32_16x16x32_bf16 v[156:159], a[152:155], v[72:75], v[156:159]
v_mfma_f32_16x16x32_bf16 v[156:159], a[156:159], v[76:79], v[156:159]
s_nop 7
v_max3_f32 v127, v127, v156, v157
v_max3_f32 v127, v127, v158, v159
Lsa100:
s_add_u32 s83, s83, 1
s_barrier
s_cmp_lt_u32 s83, s76
s_cbranch_scc1 Lslow1
s_lshl_b32 s81, s59, 20
s_add_u32 s81, s81, s64
s_sub_u32 s81, s81, 0x4000
s_add_u32 m0, s64, 49152
s_add_u32 s72, s81, 16384
buffer_load_dwordx4 v1, s[44:47], s72 offen sc1 lds
buffer_load_dwordx4 v1, s[44:47], s72 offen offset:1024 sc1 lds
buffer_load_dwordx4 v1, s[44:47], s72 offen offset:2048 sc1 lds
buffer_load_dwordx4 v1, s[44:47], s72 offen offset:3072 sc1 lds
s_add_u32 s81, s81, 0x8000
s_add_u32 m0, s64, 81920
s_add_u32 s72, s81, 16384
buffer_load_dwordx4 v1, s[44:47], s72 offen sc1 lds
buffer_load_dwordx4 v1, s[44:47], s72 offen offset:1024 sc1 lds
buffer_load_dwordx4 v1, s[44:47], s72 offen offset:2048 sc1 lds
buffer_load_dwordx4 v1, s[44:47], s72 offen offset:3072 sc1 lds
s_add_u32 m0, s64, 65536
s_add_u32 s72, s81, 0
buffer_load_dwordx4 v1, s[44:47], s72 offen sc1 lds
buffer_load_dwordx4 v1, s[44:47], s72 offen offset:1024 sc1 lds
buffer_load_dwordx4 v1, s[44:47], s72 offen offset:2048 sc1 lds
buffer_load_dwordx4 v1, s[44:47], s72 offen offset:3072 sc1 lds
s_add_u32 s81, s81, 0x8000
s_add_u32 m0, s64, 114688
s_add_u32 s72, s81, 16384
buffer_load_dwordx4 v1, s[44:47], s72 offen sc1 lds
buffer_load_dwordx4 v1, s[44:47], s72 offen offset:1024 sc1 lds
buffer_load_dwordx4 v1, s[44:47], s72 offen offset:2048 sc1 lds
buffer_load_dwordx4 v1, s[44:47], s72 offen offset:3072 sc1 lds
s_add_u32 m0, s64, 98304
s_add_u32 s72, s81, 0
buffer_load_dwordx4 v1, s[44:47], s72 offen sc1 lds
buffer_load_dwordx4 v1, s[44:47], s72 offen offset:1024 sc1 lds
buffer_load_dwordx4 v1, s[44:47], s72 offen offset:2048 sc1 lds
buffer_load_dwordx4 v1, s[44:47], s72 offen offset:3072 sc1 lds
v_add_u32 v2, 0x8000, v1
v_lshrrev_b32 v3, 1, v0
v_lshlrev_b32 v3, 7, v3
s_waitcnt vmcnt(0)
s_barrier
ds_read_b128 a[128:131], v2 offset:16384
ds_read_b128 a[132:135], v2 offset:17408
ds_read_b128 a[136:139], v2 offset:18432
ds_read_b128 a[140:143], v2 offset:19456
ds_read_b128 a[144:147], v2 offset:20480
ds_read_b128 a[148:151], v2 offset:21504
ds_read_b128 a[152:155], v2 offset:22528
ds_read_b128 a[156:159], v2 offset:23552
s_branch Lattn
Lspin103:
s_mov_b32 s83, 262144
Lsl105:
s_sleep 2
buffer_load_dword v3, v2, s[44:47], s82 offen sc1
s_sub_u32 s83, s83, 1
s_cmp_eq_u32 s83, 0
s_waitcnt vmcnt(0)
s_cbranch_scc1 Lback104
v_cmp_gt_u32 vcc, 2, v3
s_cbranch_vccnz Lsl105
s_branch Lback104
Lspin106:
s_mov_b32 s83, 262144
Lsl108:
s_sleep 2
buffer_load_dword v3, v2, s[44:47], s82 offen sc1
s_sub_u32 s83, s83, 1
s_cmp_eq_u32 s83, 0
s_waitcnt vmcnt(0)
s_cbranch_scc1 Lback107
v_cmp_gt_u32 vcc, 2, v3
s_cbranch_vccnz Lsl108
s_branch Lback107
Lspin109:
s_mov_b32 s83, 262144
Lsl111:
s_sleep 2
buffer_load_dword v3, v2, s[44:47], s82 offen sc1
s_sub_u32 s83, s83, 1
s_cmp_eq_u32 s83, 0
s_waitcnt vmcnt(0)
s_cbranch_scc1 Lback110
v_cmp_gt_u32 vcc, 2, v3
s_cbranch_vccnz Lsl111
s_branch Lback110
Lspin112:
s_mov_b32 s83, 262144
Lsl114:
s_sleep 2
buffer_load_dword v3, v2, s[44:47], s82 offen sc1
s_sub_u32 s83, s83, 1
s_cmp_eq_u32 s83, 0
s_waitcnt vmcnt(0)
s_cbranch_scc1 Lback113
v_cmp_gt_u32 vcc, 2, v3
s_cbranch_vccnz Lsl114
s_branch Lback113
Lspin115:
s_mov_b32 s83, 262144
Lsl117:
s_sleep 2
buffer_load_dword v3, v2, s[44:47], s82 offen sc1
s_sub_u32 s83, s83, 1
s_cmp_eq_u32 s83, 0
s_waitcnt vmcnt(0)
s_cbranch_scc1 Lback116
v_cmp_gt_u32 vcc, 2, v3
s_cbranch_vccnz Lsl117
s_branch Lback116
Lspin118:
s_mov_b32 s83, 262144
Lsl120:
s_sleep 2
buffer_load_dword v3, v2, s[44:47], s82 offen sc1
s_sub_u32 s83, s83, 1
s_cmp_eq_u32 s83, 0
s_waitcnt vmcnt(0)
s_cbranch_scc1 Lback119
v_cmp_gt_u32 vcc, 2, v3
s_cbranch_vccnz Lsl120
s_branch Lback119
Lspin121:
s_mov_b32 s83, 262144
Lsl123:
s_sleep 2
buffer_load_dword v3, v2, s[44:47], s82 offen sc1
s_sub_u32 s83, s83, 1
s_cmp_eq_u32 s83, 0
s_waitcnt vmcnt(0)
s_cbranch_scc1 Lback122
v_cmp_gt_u32 vcc, 2, v3
s_cbranch_vccnz Lsl123
s_branch Lback122
Lspin124:
s_mov_b32 s83, 262144
Lsl126:
s_sleep 2
buffer_load_dword v3, v2, s[44:47], s82 offen sc1
s_sub_u32 s83, s83, 1
s_cmp_eq_u32 s83, 0
s_waitcnt vmcnt(0)
s_cbranch_scc1 Lback125
v_cmp_gt_u32 vcc, 2, v3
s_cbranch_vccnz Lsl126
s_branch Lback125
Lredo0:
s_add_u32 s82, s59, 4
s_and_b32 s82, s82, 28
s_lshl_b32 s82, s82, 10
s_add_u32 s82, s82, s74
buffer_load_dword v3, v2, s[44:47], s82 offen sc1
s_waitcnt vmcnt(0)
v_cmp_gt_u32 vcc, 2, v3
s_cbranch_vccnz Lspin103
Lback104:
s_add_u32 s69, s61, 0
s_and_b32 s69, s69, 3
s_add_u32 s69, s69, s78
s_lshl_b32 s69, s69, 12
s_add_u32 s69, s69, s95
buffer_load_dwordx4 a[0:3], v1, s[44:47], s69 offen sc1
buffer_load_dwordx4 a[4:7], v1, s[44:47], s69 offen offset:1024 sc1
buffer_load_dwordx4 a[8:11], v1, s[44:47], s69 offen offset:2048 sc1
buffer_load_dwordx4 a[12:15], v1, s[44:47], s69 offen offset:3072 sc1
s_add_u32 s69, s69, 0x20000
buffer_load_dwordx4 a[16:19], v1, s[44:47], s69 offen sc1
buffer_load_dwordx4 a[20:23], v1, s[44:47], s69 offen offset:1024 sc1
buffer_load_dwordx4 a[24:27], v1, s[44:47], s69 offen offset:2048 sc1
buffer_load_dwordx4 a[28:31], v1, s[44:47], s69 offen offset:3072 sc1
s_add_u32 s69, s61, 1
s_and_b32 s69, s69, 3
s_add_u32 s69, s69, s78
s_lshl_b32 s69, s69, 12
s_add_u32 s69, s69, s95
buffer_load_dwordx4 a[32:35], v1, s[44:47], s69 offen sc1
buffer_load_dwordx4 a[36:39], v1, s[44:47], s69 offen offset:1024 sc1
buffer_load_dwordx4 a[40:43], v1, s[44:47], s69 offen offset:2048 sc1
buffer_load_dwordx4 a[44:47], v1, s[44:47], s69 offen offset:3072 sc1
s_add_u32 s69, s69, 0x20000
buffer_load_dwordx4 a[48:51], v1, s[44:47], s69 offen sc1
buffer_load_dwordx4 a[52:55], v1, s[44:47], s69 offen offset:1024 sc1
buffer_load_dwordx4 a[56:59], v1, s[44:47], s69 offen offset:2048 sc1
buffer_load_dwordx4 a[60:63], v1, s[44:47], s69 offen offset:3072 sc1
s_add_u32 s69, s61, 2
s_and_b32 s69, s69, 3
s_add_u32 s69, s69, s78
s_lshl_b32 s69, s69, 12
s_add_u32 s69, s69, s95
buffer_load_dwordx4 a[64:67], v1, s[44:47], s69 offen sc1
buffer_load_dwordx4 a[68:71], v1, s[44:47], s69 offen offset:1024 sc1
buffer_load_dwordx4 a[72:75], v1, s[44:47], s69 offen offset:2048 sc1
buffer_load_dwordx4 a[76:79], v1, s[44:47], s69 offen offset:3072 sc1
s_add_u32 s69, s69, 0x20000
buffer_load_dwordx4 a[80:83], v1, s[44:47], s69 offen sc1
buffer_load_dwordx4 a[84:87], v1, s[44:47], s69 offen offset:1024 sc1
buffer_load_dwordx4 a[88:91], v1, s[44:47], s69 offen offset:2048 sc1
buffer_load_dwordx4 a[92:95], v1, s[44:47], s69 offen offset:3072 sc1
s_add_u32 s69, s61, 3
s_and_b32 s69, s69, 3
s_add_u32 s69, s69, s78
s_lshl_b32 s69, s69, 12
s_add_u32 s69, s69, s95
buffer_load_dwordx4 a[96:99], v1, s[44:47], s69 offen sc1
buffer_load_dwordx4 a[100:103], v1, s[44:47], s69 offen offset:1024 sc1
buffer_load_dwordx4 a[104:107], v1, s[44:47], s69 offen offset:2048 sc1
buffer_load_dwordx4 a[108:111], v1, s[44:47], s69 offen offset:3072 sc1
s_add_u32 s69, s69, 0x20000
buffer_load_dwordx4 a[112:115], v1, s[44:47], s69 offen sc1
buffer_load_dwordx4 a[116:119], v1, s[44:47], s69 offen offset:1024 sc1
buffer_load_dwordx4 a[120:123], v1, s[44:47], s69 offen offset:2048 sc1
buffer_load_dwordx4 a[124:127], v1, s[44:47], s69 offen offset:3072 sc1
s_waitcnt vmcnt(24)
s_branch Lredo0b
Lspin127:
s_mov_b32 s83, 262144
Lsl129:
s_sleep 2
buffer_load_dword v114, v115, s[44:47], s84 offen sc1
s_sub_u32 s83, s83, 1
s_cmp_eq_u32 s83, 0
s_waitcnt vmcnt(0)
s_cbranch_scc1 Lback128
v_cmp_gt_u32 vcc, 3, v114
s_cbranch_vccnz Lsl129
s_branch Lback128
Lcode_end:
s_endpgm
.section .rodata,"a"
.p2align 6
.amdhsa_kernel gated_mix__compressed_kv_cla__ssm_conv_h3__prompt_kernel
  .amdhsa_next_free_vgpr 512
  .amdhsa_next_free_sgpr 102
  .amdhsa_accum_offset 256
  .amdhsa_group_segment_fixed_size 0
  .amdhsa_kernarg_size 128
  .amdhsa_user_sgpr_count 2
  .amdhsa_user_sgpr_kernarg_segment_ptr 1
  .amdhsa_system_sgpr_workgroup_id_x 1
  .amdhsa_float_denorm_mode_32 3
.end_amdhsa_kernel
```

```asm
; @launch grid=(256,1,1) block=(256,1,1) lds=163840
.amdgcn_target "amdgcn-amd-amdhsa--gfx950"
.text
.globl gated_mix__compressed_kv_cla__ssm_conv_h3__prompt_kernel
.p2align 8
.type gated_mix__compressed_kv_cla__ssm_conv_h3__prompt_kernel,@function
gated_mix__compressed_kv_cla__ssm_conv_h3__prompt_kernel:
s_cmp_ge_u32 s2, 256
s_cbranch_scc1 Lend
s_load_dwordx2 s[8:9], s[0:1], 8
s_load_dwordx2 s[16:17], s[0:1], 24
s_load_dwordx2 s[20:21], s[0:1], 32
s_load_dwordx2 s[4:5], s[0:1], 0
s_load_dwordx2 s[12:13], s[0:1], 16
s_load_dwordx2 s[24:25], s[0:1], 40
s_load_dwordx2 s[28:29], s[0:1], 56
s_load_dwordx2 s[32:33], s[0:1], 64
s_load_dwordx2 s[52:53], s[0:1], 72
s_load_dwordx2 s[36:37], s[0:1], 80
s_load_dwordx2 s[54:55], s[0:1], 88
s_load_dwordx2 s[56:57], s[0:1], 96
s_load_dwordx2 s[40:41], s[0:1], 104
s_load_dwordx2 s[48:49], s[0:1], 112
s_load_dwordx2 s[44:45], s[0:1], 120
s_getpc_b64 s[98:99]
Lpc0:
s_lshr_b32 s75, s2, 3
v_lshrrev_b32 v26, 3, v0
s_lshl_b32 s73, s75, 12
v_lshlrev_b32 v26, 7, v26
v_add_u32 v26, s73, v26
v_min_u32 v26, Lcode_end-Lpc0, v26
global_load_dword v31, v26, s[98:99]
v_lshrrev_b32 v26, 6, v0
v_and_b32 v0, 63, v0
s_and_b32 s73, s2, 7
v_readfirstlane_b32 s58, v26
s_lshr_b32 s65, s75, 3
s_and_b32 s60, s75, 7
s_lshl_b32 s59, s73, 2
s_add_u32 s59, s59, s65
s_lshl_b32 s61, s65, 1
s_lshl_b32 s63, s58, 13
s_lshl_b32 s64, s58, 12
s_lshl_b32 s67, s60, 18
s_lshl_b32 s76, s58, 16
s_add_u32 s84, s67, s76
s_lshl_b32 s66, s58, 17
s_lshl_b32 s73, s59, 8
s_add_u32 s66, s66, s73
v_lshrrev_b32 v26, 4, v0
v_and_b32 v27, 7, v0
v_xor_b32 v27, v27, v26
v_lshlrev_b32 v27, 4, v27
v_lshrrev_b32 v28, 3, v0
v_lshl_add_u32 v2, v28, 10, v27
v_xor_b32 v3, 64, v2
v_and_b32 v29, 15, v0
v_lshlrev_b32 v30, 1, v26
v_xor_b32 v30, v30, v29
v_lshlrev_b32 v30, 4, v30
v_lshl_add_u32 v6, v26, 13, v30
v_xor_b32 v7, 0x80, v6
s_mov_b32 s10, 0x200000
s_mov_b32 s11, 0x20000
s_mov_b32 s18, 0x400000
s_mov_b32 s19, 0x20000
s_mov_b32 s22, 0x400000
s_mov_b32 s23, 0x20000
s_lshl_b32 s73, s2, 2
s_add_u32 s73, s73, s58
s_lshl_b32 s73, s73, 11
v_lshrrev_b32 v124, 2, v0
v_lshlrev_b32 v124, 7, v124
v_add_u32 v124, s73, v124
s_lshl_b32 s73, s60, 2
s_add_u32 s73, s73, s58
s_lshl_b32 s73, s73, 13
s_lshl_b32 s74, s59, 8
s_add_u32 s73, s73, s74
v_lshrrev_b32 v125, 4, v0
v_lshlrev_b32 v125, 18, v125
v_bfe_u32 v126, v0, 3, 1
v_lshl_add_u32 v125, v126, 7, v125
v_add_u32 v125, s73, v125
s_waitcnt lgkmcnt(0)
s_mov_b32 s80, 0x0
buffer_load_dword v126, v125, s[16:19], s80 offen
buffer_load_dword v126, v125, s[20:23], s80 offen
s_and_b32 s73, s65, 1
s_xor_b32 s73, s73, 0
s_lshl_b32 s69, s73, 7
s_add_u32 s69, s69, s84
s_lshl_b32 s71, s73, 19
s_add_u32 s71, s71, s66
s_add_u32 m0, s63, 65536
s_add_u32 s72, s69, 0
buffer_load_dwordx4 v2, s[8:11], s72 offen lds
s_add_u32 s72, s69, 7168
buffer_load_dwordx4 v3, s[8:11], s72 offen offset:1024 lds
s_add_u32 s72, s69, 14336
buffer_load_dwordx4 v2, s[8:11], s72 offen offset:2048 lds
s_add_u32 s72, s69, 21504
buffer_load_dwordx4 v3, s[8:11], s72 offen offset:3072 lds
s_add_u32 m0, s64, 0
s_add_u32 s72, s71, 0
buffer_load_dwordx4 v6, s[16:19], s72 offen lds
s_add_u32 s72, s71, 31744
buffer_load_dwordx4 v6, s[16:19], s72 offen offset:1024 lds
s_add_u32 s72, s71, 63488
buffer_load_dwordx4 v7, s[16:19], s72 offen offset:2048 lds
s_add_u32 s72, s71, 95232
buffer_load_dwordx4 v7, s[16:19], s72 offen offset:3072 lds
s_add_u32 m0, s63, 69632
s_add_u32 s72, s69, 32768
buffer_load_dwordx4 v2, s[8:11], s72 offen lds
s_add_u32 s72, s69, 39936
buffer_load_dwordx4 v3, s[8:11], s72 offen offset:1024 lds
s_add_u32 s72, s69, 47104
buffer_load_dwordx4 v2, s[8:11], s72 offen offset:2048 lds
s_add_u32 s72, s69, 54272
buffer_load_dwordx4 v3, s[8:11], s72 offen offset:3072 lds
s_add_u32 m0, s64, 16384
s_add_u32 s72, s71, 0
buffer_load_dwordx4 v6, s[20:23], s72 offen lds
s_add_u32 s72, s71, 31744
buffer_load_dwordx4 v6, s[20:23], s72 offen offset:1024 lds
s_add_u32 s72, s71, 63488
buffer_load_dwordx4 v7, s[20:23], s72 offen offset:2048 lds
s_add_u32 s72, s71, 95232
buffer_load_dwordx4 v7, s[20:23], s72 offen offset:3072 lds
buffer_load_dword v126, v124, s[8:11], 0 offen
s_and_b32 s73, s65, 1
s_xor_b32 s73, s73, 1
s_lshl_b32 s69, s73, 7
s_add_u32 s69, s69, s84
s_lshl_b32 s71, s73, 19
s_add_u32 s71, s71, s66
s_add_u32 m0, s63, 98304
s_add_u32 s72, s69, 0
buffer_load_dwordx4 v2, s[8:11], s72 offen lds
s_add_u32 s72, s69, 7168
buffer_load_dwordx4 v3, s[8:11], s72 offen offset:1024 lds
s_add_u32 s72, s69, 14336
buffer_load_dwordx4 v2, s[8:11], s72 offen offset:2048 lds
s_add_u32 s72, s69, 21504
buffer_load_dwordx4 v3, s[8:11], s72 offen offset:3072 lds
s_branch Lmain
.p2align 12
Lmain:
s_mov_b32 s6, 0x400000
s_mov_b32 s7, 0x20000
s_mov_b32 s14, 0x800000
s_mov_b32 s15, 0x20000
s_mov_b32 s26, 0x800000
s_mov_b32 s27, 0x20000
s_mov_b32 s30, 0x400000
s_mov_b32 s31, 0x20000
s_mov_b32 s34, 0x400000
s_mov_b32 s35, 0x20000
s_mov_b32 s38, 0x400000
s_mov_b32 s39, 0x20000
s_mov_b32 s42, 0x400000
s_mov_b32 s43, 0x20000
s_mov_b32 s46, 0x5000000
s_mov_b32 s47, 0x20000
s_mov_b32 s50, 0x100
s_mov_b32 s51, 0x20000
v_lshl_add_u32 v4, v28, 11, v27
v_xor_b32 v5, 64, v4
v_lshlrev_b32 v1, 4, v0
s_sub_u32 s74, 15, s60
s_lshl_b32 s68, s74, 18
s_lshl_b32 s76, s58, 15
s_add_u32 s68, s68, s76
s_add_u32 s67, s67, s76
s_and_b32 s62, s60, 3
s_sub_u32 s62, 16, s62
s_lshl_b32 s91, s59, 3
s_add_u32 s91, s91, s60
s_lshl_b32 s93, s91, 2
s_add_u32 s93, s93, s58
s_lshl_b32 s91, s91, 7
s_add_u32 s91, s91, 0x3810000
s_lshl_b32 s75, s93, 1
s_and_b32 s75, s75, 0xffc
s_lshl_b32 s93, s93, 12
s_load_dwordx2 s[88:89], s[36:37], s93
s_load_dword s90, s[54:55], s75
v_or_b32 v29, s58, v0
v_mov_b32 v30, 0
v_min_u32 v29, 1, v29
v_lshlrev_b32 v29, 30, v29
buffer_store_dword v30, v29, s[44:47], s91 offen sc1
s_and_b32 s73, s2, 15
s_lshr_b32 s74, s2, 4
s_lshl_b32 s74, s74, 7
s_lshl_b32 s75, s58, 5
s_add_u32 s74, s74, s75
s_mov_b32 s75, 131072
v_lshrrev_b32 v29, 5, v0
v_lshlrev_b32 v29, 4, v29
v_add_u32 v29, s74, v29
v_and_b32 v30, 31, v0
s_lshl_b32 s73, s73, 5
v_add_u32 v30, s73, v30
v_lshlrev_b32 v26, 11, v29
v_lshl_add_u32 v26, v30, 2, v26
v_subrev_u32 v27, 0x1800, v26
s_lshl_b32 s82, s74, 11
s_lshl_b32 s73, s73, 2
s_add_u32 s82, s82, s73
v_lshrrev_b32 v26, 3, v0
v_and_b32 v32, 7, v0
v_lshlrev_b32 v32, 4, v32
v_lshl_add_u32 v26, v26, 11, v32
v_lshrrev_b32 v98, 5, v0
v_lshlrev_b32 v98, 11, v98
v_and_b32 v32, 31, v0
v_lshl_add_u32 v98, v32, 2, v98
v_add_u32 v98, s63, v98
v_add_u32 v98, s75, v98
v_and_b32 v29, 0x7f, v29
v_sub_u32 v29, 0x70, v29
v_lshlrev_b32 v29, 1, v29
v_and_b32 v32, 31, v0
v_mul_u32_u24 v32, 544, v32
v_add3_u32 v28, v32, v29, s75
v_lshlrev_b32 v30, 4, v30
s_lshl_b32 s73, s2, 14
s_lshl_b32 s74, s58, 12
s_add_u32 s76, s73, s74
v_and_b32 v29, 15, v0
v_lshrrev_b32 v32, 4, v0
v_lshrrev_b32 v24, 1, v29
v_xor_b32 v24, v24, v32
v_lshlrev_b32 v24, 4, v24
v_lshl_add_u32 v24, v29, 7, v24
s_add_u32 s73, s63, 131072
v_add_u32 v16, s73, v24
v_xor_b32 v17, 64, v16
v_subrev_u32 v18, 0x10000, v16
v_subrev_u32 v19, 0x10000, v17
s_lshr_b32 s73, s58, 1
s_lshl_b32 s74, s73, 14
s_add_u32 s74, s74, 0x10000
v_add_u32 v24, s74, v24
v_xor_b32 v25, 64, v24
v_lshrrev_b32 v8, 2, v29
v_and_b32 v9, 1, v32
v_lshl_add_u32 v9, v9, 2, v8
v_lshl_add_u32 v8, v32, 3, v8
v_lshlrev_b32 v8, 8, v8
v_lshl_add_u32 v8, v9, 5, v8
v_and_b32 v29, 3, v0
v_lshl_add_u32 v8, v29, 3, v8
s_and_b32 s74, s58, 1
s_lshl_b32 s75, s74, 7
v_xor_b32 v20, s75, v8
v_xor_b32 v9, 32, v8
v_xor_b32 v10, 64, v8
v_xor_b32 v11, 96, v8
v_xor_b32 v12, 128, v8
v_xor_b32 v13, 160, v8
v_xor_b32 v14, 192, v8
v_xor_b32 v15, 224, v8
v_xor_b32 v21, 32, v20
v_xor_b32 v22, 64, v20
v_xor_b32 v23, 96, v20
s_lshl_b32 s77, s59, 20
s_add_u32 s81, s77, s64
s_sub_u32 s81, s81, 0x4000
s_lshl_b32 s75, s60, 17
s_add_u32 s77, s77, s75
s_lshl_b32 s73, s73, 16
s_add_u32 s77, s77, s73
s_lshl_b32 s75, s74, 12
s_add_u32 s78, s77, s75
s_add_u32 s78, s78, 0x4000
s_lshl_b32 s75, s74, 11
s_add_u32 s77, s77, s75
s_mov_b32 s79, 0x3e0293ee
s_waitcnt vmcnt(6)
s_barrier
ds_read_b64_tr_b16 v[160:161], v20 offset:0
ds_read_b64_tr_b16 v[162:163], v20 offset:1024
ds_read_b128 v[128:131], v24 offset:0
ds_read_b128 v[132:135], v24 offset:2048
ds_read_b128 v[136:139], v24 offset:4096
ds_read_b128 v[140:143], v24 offset:6144
ds_read_b128 v[144:147], v24 offset:8192
ds_read_b128 v[148:151], v24 offset:10240
ds_read_b128 v[152:155], v24 offset:12288
ds_read_b128 v[156:159], v24 offset:14336
ds_read_b64_tr_b16 v[164:165], v21 offset:0
ds_read_b64_tr_b16 v[166:167], v21 offset:1024
ds_read_b64_tr_b16 v[168:169], v22 offset:0
ds_read_b64_tr_b16 v[170:171], v22 offset:1024
ds_read_b64_tr_b16 v[172:173], v23 offset:0
ds_read_b64_tr_b16 v[174:175], v23 offset:1024
ds_read_b64_tr_b16 v[176:177], v20 offset:16384
ds_read_b64_tr_b16 v[178:179], v20 offset:17408
ds_read_b64_tr_b16 v[180:181], v21 offset:16384
ds_read_b64_tr_b16 v[182:183], v21 offset:17408
ds_read_b64_tr_b16 v[184:185], v22 offset:16384
ds_read_b64_tr_b16 v[186:187], v22 offset:17408
ds_read_b64_tr_b16 v[188:189], v23 offset:16384
ds_read_b64_tr_b16 v[190:191], v23 offset:17408
s_waitcnt lgkmcnt(0)
v_mfma_f32_16x16x32_bf16 a[0:3], v[160:163], v[128:131], 0
s_add_u32 m0, s64, 32768
ds_read_b64_tr_b16 v[224:225], v20 offset:8192
v_mfma_f32_16x16x32_bf16 a[4:7], v[160:163], v[132:135], 0
s_add_u32 s72, s71, 0
buffer_load_dwordx4 v6, s[16:19], s72 offen lds
v_mfma_f32_16x16x32_bf16 a[8:11], v[160:163], v[136:139], 0
s_add_u32 s72, s71, 31744
buffer_load_dwordx4 v6, s[16:19], s72 offen offset:1024 lds
v_mfma_f32_16x16x32_bf16 a[12:15], v[160:163], v[140:143], 0
ds_read_b64_tr_b16 v[226:227], v20 offset:9216
v_mfma_f32_16x16x32_bf16 a[16:19], v[160:163], v[144:147], 0
s_add_u32 s72, s71, 63488
buffer_load_dwordx4 v7, s[16:19], s72 offen offset:2048 lds
v_mfma_f32_16x16x32_bf16 a[20:23], v[160:163], v[148:151], 0
ds_read_b128 v[192:195], v25 offset:0
v_mfma_f32_16x16x32_bf16 a[24:27], v[160:163], v[152:155], 0
s_add_u32 s72, s71, 95232
buffer_load_dwordx4 v7, s[16:19], s72 offen offset:3072 lds
v_mfma_f32_16x16x32_bf16 a[28:31], v[160:163], v[156:159], 0
ds_read_b128 v[196:199], v25 offset:2048
v_mfma_f32_16x16x32_bf16 a[60:63], v[164:167], v[156:159], 0
s_add_u32 m0, s63, 102400
ds_read_b128 v[200:203], v25 offset:4096
v_mfma_f32_16x16x32_bf16 a[56:59], v[164:167], v[152:155], 0
s_add_u32 s72, s69, 32768
buffer_load_dwordx4 v2, s[8:11], s72 offen lds
v_mfma_f32_16x16x32_bf16 a[52:55], v[164:167], v[148:151], 0
s_add_u32 s72, s69, 39936
buffer_load_dwordx4 v3, s[8:11], s72 offen offset:1024 lds
v_mfma_f32_16x16x32_bf16 a[48:51], v[164:167], v[144:147], 0
ds_read_b128 v[204:207], v25 offset:6144
v_mfma_f32_16x16x32_bf16 a[44:47], v[164:167], v[140:143], 0
s_add_u32 s72, s69, 47104
buffer_load_dwordx4 v2, s[8:11], s72 offen offset:2048 lds
v_mfma_f32_16x16x32_bf16 a[40:43], v[164:167], v[136:139], 0
ds_read_b128 v[208:211], v25 offset:8192
v_mfma_f32_16x16x32_bf16 a[36:39], v[164:167], v[132:135], 0
s_add_u32 s72, s69, 54272
buffer_load_dwordx4 v3, s[8:11], s72 offen offset:3072 lds
v_mfma_f32_16x16x32_bf16 a[32:35], v[164:167], v[128:131], 0
ds_read_b128 v[212:215], v25 offset:10240
v_mfma_f32_16x16x32_bf16 a[64:67], v[168:171], v[128:131], 0
s_add_u32 m0, s64, 49152
ds_read_b128 v[216:219], v25 offset:12288
v_mfma_f32_16x16x32_bf16 a[68:71], v[168:171], v[132:135], 0
s_add_u32 s72, s71, 0
buffer_load_dwordx4 v6, s[20:23], s72 offen lds
v_mfma_f32_16x16x32_bf16 a[72:75], v[168:171], v[136:139], 0
s_add_u32 s72, s71, 31744
buffer_load_dwordx4 v6, s[20:23], s72 offen offset:1024 lds
v_mfma_f32_16x16x32_bf16 a[76:79], v[168:171], v[140:143], 0
ds_read_b128 v[220:223], v25 offset:14336
v_mfma_f32_16x16x32_bf16 a[80:83], v[168:171], v[144:147], 0
s_add_u32 s72, s71, 63488
buffer_load_dwordx4 v7, s[20:23], s72 offen offset:2048 lds
v_mfma_f32_16x16x32_bf16 a[84:87], v[168:171], v[148:151], 0
ds_read_b64_tr_b16 v[228:229], v21 offset:8192
v_mfma_f32_16x16x32_bf16 a[88:91], v[168:171], v[152:155], 0
s_add_u32 s72, s71, 95232
buffer_load_dwordx4 v7, s[20:23], s72 offen offset:3072 lds
v_mfma_f32_16x16x32_bf16 a[92:95], v[168:171], v[156:159], 0
s_mov_b32 s80, 0x100000
buffer_load_dword v126, v125, s[16:19], s80 offen
v_mfma_f32_16x16x32_bf16 a[124:127], v[172:175], v[156:159], 0
buffer_load_dword v126, v125, s[20:23], s80 offen
v_mfma_f32_16x16x32_bf16 a[120:123], v[172:175], v[152:155], 0
ds_read_b64_tr_b16 v[230:231], v21 offset:9216
v_mfma_f32_16x16x32_bf16 a[116:119], v[172:175], v[148:151], 0
ds_read_b64_tr_b16 v[232:233], v22 offset:8192
v_mfma_f32_16x16x32_bf16 a[112:115], v[172:175], v[144:147], 0
ds_read_b64_tr_b16 v[234:235], v22 offset:9216
v_mfma_f32_16x16x32_bf16 a[108:111], v[172:175], v[140:143], 0
ds_read_b64_tr_b16 v[236:237], v23 offset:8192
v_mfma_f32_16x16x32_bf16 a[104:107], v[172:175], v[136:139], 0
ds_read_b64_tr_b16 v[238:239], v23 offset:9216
v_mfma_f32_16x16x32_bf16 a[100:103], v[172:175], v[132:135], 0
ds_read_b64_tr_b16 v[240:241], v20 offset:24576
v_mfma_f32_16x16x32_bf16 a[96:99], v[172:175], v[128:131], 0
ds_read_b64_tr_b16 v[242:243], v20 offset:25600
v_mfma_f32_16x16x32_bf16 a[128:131], v[128:131], v[176:179], 0
ds_read_b64_tr_b16 v[244:245], v21 offset:24576
v_mfma_f32_16x16x32_bf16 a[132:135], v[132:135], v[176:179], 0
ds_read_b64_tr_b16 v[246:247], v21 offset:25600
v_mfma_f32_16x16x32_bf16 a[136:139], v[136:139], v[176:179], 0
ds_read_b64_tr_b16 v[248:249], v22 offset:24576
v_mfma_f32_16x16x32_bf16 a[140:143], v[140:143], v[176:179], 0
ds_read_b64_tr_b16 v[250:251], v22 offset:25600
v_mfma_f32_16x16x32_bf16 a[144:147], v[144:147], v[176:179], 0
ds_read_b64_tr_b16 v[252:253], v23 offset:24576
v_mfma_f32_16x16x32_bf16 a[148:151], v[148:151], v[176:179], 0
ds_read_b64_tr_b16 v[254:255], v23 offset:25600
v_mfma_f32_16x16x32_bf16 a[152:155], v[152:155], v[176:179], 0
v_mfma_f32_16x16x32_bf16 a[156:159], v[156:159], v[176:179], 0
v_mfma_f32_16x16x32_bf16 a[188:191], v[156:159], v[180:183], 0
v_mfma_f32_16x16x32_bf16 a[184:187], v[152:155], v[180:183], 0
v_mfma_f32_16x16x32_bf16 a[180:183], v[148:151], v[180:183], 0
v_mfma_f32_16x16x32_bf16 a[176:179], v[144:147], v[180:183], 0
v_mfma_f32_16x16x32_bf16 a[172:175], v[140:143], v[180:183], 0
v_mfma_f32_16x16x32_bf16 a[168:171], v[136:139], v[180:183], 0
v_mfma_f32_16x16x32_bf16 a[164:167], v[132:135], v[180:183], 0
v_mfma_f32_16x16x32_bf16 a[160:163], v[128:131], v[180:183], 0
v_mfma_f32_16x16x32_bf16 a[192:195], v[128:131], v[184:187], 0
v_mfma_f32_16x16x32_bf16 a[196:199], v[132:135], v[184:187], 0
v_mfma_f32_16x16x32_bf16 a[200:203], v[136:139], v[184:187], 0
v_mfma_f32_16x16x32_bf16 a[204:207], v[140:143], v[184:187], 0
v_mfma_f32_16x16x32_bf16 a[208:211], v[144:147], v[184:187], 0
v_mfma_f32_16x16x32_bf16 a[212:215], v[148:151], v[184:187], 0
v_mfma_f32_16x16x32_bf16 a[216:219], v[152:155], v[184:187], 0
v_mfma_f32_16x16x32_bf16 a[220:223], v[156:159], v[184:187], 0
v_mfma_f32_16x16x32_bf16 a[252:255], v[156:159], v[188:191], 0
v_mfma_f32_16x16x32_bf16 a[248:251], v[152:155], v[188:191], 0
v_mfma_f32_16x16x32_bf16 a[244:247], v[148:151], v[188:191], 0
v_mfma_f32_16x16x32_bf16 a[240:243], v[144:147], v[188:191], 0
v_mfma_f32_16x16x32_bf16 a[236:239], v[140:143], v[188:191], 0
v_mfma_f32_16x16x32_bf16 a[232:235], v[136:139], v[188:191], 0
s_nop 3
s_mov_b64 exec, 0
s_cmp_eq_u32 s58, 0
s_cbranch_scc1 Lstub0
s_cmp_eq_u32 s58, 1
s_cbranch_scc1 Lstub1
s_cmp_eq_u32 s58, 2
s_cbranch_scc1 Lstub2
s_branch Lstub3
Lret:
s_mov_b64 exec, -1
s_nop 3
v_mfma_f32_16x16x32_bf16 a[228:231], v[132:135], v[188:191], 0
s_waitcnt vmcnt(2) lgkmcnt(0)
v_mfma_f32_16x16x32_bf16 a[224:227], v[128:131], v[188:191], 0
s_barrier
v_mfma_f32_16x16x32_bf16 a[0:3], v[224:227], v[192:195], a[0:3]
s_and_b32 s73, s65, 1
ds_read_b64_tr_b16 v[160:161], v20 offset:32768
v_mfma_f32_16x16x32_bf16 a[4:7], v[224:227], v[196:199], a[4:7]
s_xor_b32 s73, s73, 2
ds_read_b64_tr_b16 v[162:163], v20 offset:33792
v_mfma_f32_16x16x32_bf16 a[8:11], v[224:227], v[200:203], a[8:11]
s_lshl_b32 s69, s73, 7
ds_read_b128 v[128:131], v24 offset:32768
v_mfma_f32_16x16x32_bf16 a[12:15], v[224:227], v[204:207], a[12:15]
s_add_u32 s69, s69, s84
ds_read_b128 v[132:135], v24 offset:34816
v_mfma_f32_16x16x32_bf16 a[16:19], v[224:227], v[208:211], a[16:19]
s_lshl_b32 s71, s73, 19
ds_read_b128 v[136:139], v24 offset:36864
v_mfma_f32_16x16x32_bf16 a[20:23], v[224:227], v[212:215], a[20:23]
s_add_u32 s71, s71, s66
ds_read_b128 v[140:143], v24 offset:38912
v_mfma_f32_16x16x32_bf16 a[24:27], v[224:227], v[216:219], a[24:27]
s_add_u32 m0, s63, 65536
ds_read_b128 v[144:147], v24 offset:40960
v_mfma_f32_16x16x32_bf16 a[28:31], v[224:227], v[220:223], a[28:31]
s_add_u32 s72, s69, 0
buffer_load_dwordx4 v2, s[8:11], s72 offen lds
v_mfma_f32_16x16x32_bf16 a[60:63], v[228:231], v[220:223], a[60:63]
s_add_u32 s72, s69, 7168
buffer_load_dwordx4 v3, s[8:11], s72 offen offset:1024 lds
v_mfma_f32_16x16x32_bf16 a[56:59], v[228:231], v[216:219], a[56:59]
s_add_u32 s72, s69, 14336
buffer_load_dwordx4 v2, s[8:11], s72 offen offset:2048 lds
v_mfma_f32_16x16x32_bf16 a[52:55], v[228:231], v[212:215], a[52:55]
ds_read_b128 v[148:151], v24 offset:43008
v_mfma_f32_16x16x32_bf16 a[48:51], v[228:231], v[208:211], a[48:51]
ds_read_b128 v[152:155], v24 offset:45056
v_mfma_f32_16x16x32_bf16 a[44:47], v[228:231], v[204:207], a[44:47]
s_add_u32 s72, s69, 21504
buffer_load_dwordx4 v3, s[8:11], s72 offen offset:3072 lds
v_mfma_f32_16x16x32_bf16 a[40:43], v[228:231], v[200:203], a[40:43]
ds_read_b128 v[156:159], v24 offset:47104
v_mfma_f32_16x16x32_bf16 a[36:39], v[228:231], v[196:199], a[36:39]
ds_read_b64_tr_b16 v[164:165], v21 offset:32768
v_mfma_f32_16x16x32_bf16 a[32:35], v[228:231], v[192:195], a[32:35]
ds_read_b64_tr_b16 v[166:167], v21 offset:33792
v_mfma_f32_16x16x32_bf16 a[64:67], v[232:235], v[192:195], a[64:67]
ds_read_b64_tr_b16 v[168:169], v22 offset:32768
v_mfma_f32_16x16x32_bf16 a[68:71], v[232:235], v[196:199], a[68:71]
s_add_u32 m0, s64, 0
ds_read_b64_tr_b16 v[170:171], v22 offset:33792
v_mfma_f32_16x16x32_bf16 a[72:75], v[232:235], v[200:203], a[72:75]
s_add_u32 s72, s71, 0
buffer_load_dwordx4 v6, s[16:19], s72 offen lds
v_mfma_f32_16x16x32_bf16 a[76:79], v[232:235], v[204:207], a[76:79]
ds_read_b64_tr_b16 v[172:173], v23 offset:32768
v_mfma_f32_16x16x32_bf16 a[80:83], v[232:235], v[208:211], a[80:83]
ds_read_b64_tr_b16 v[174:175], v23 offset:33792
v_mfma_f32_16x16x32_bf16 a[84:87], v[232:235], v[212:215], a[84:87]
s_add_u32 s72, s71, 31744
buffer_load_dwordx4 v6, s[16:19], s72 offen offset:1024 lds
v_mfma_f32_16x16x32_bf16 a[88:91], v[232:235], v[216:219], a[88:91]
ds_read_b64_tr_b16 v[176:177], v20 offset:49152
v_mfma_f32_16x16x32_bf16 a[92:95], v[232:235], v[220:223], a[92:95]
ds_read_b64_tr_b16 v[178:179], v20 offset:50176
v_mfma_f32_16x16x32_bf16 a[124:127], v[236:239], v[220:223], a[124:127]
ds_read_b64_tr_b16 v[180:181], v21 offset:49152
v_mfma_f32_16x16x32_bf16 a[120:123], v[236:239], v[216:219], a[120:123]
s_add_u32 s72, s71, 63488
buffer_load_dwordx4 v7, s[16:19], s72 offen offset:2048 lds
v_mfma_f32_16x16x32_bf16 a[116:119], v[236:239], v[212:215], a[116:119]
ds_read_b64_tr_b16 v[182:183], v21 offset:50176
v_mfma_f32_16x16x32_bf16 a[112:115], v[236:239], v[208:211], a[112:115]
ds_read_b64_tr_b16 v[184:185], v22 offset:49152
v_mfma_f32_16x16x32_bf16 a[108:111], v[236:239], v[204:207], a[108:111]
ds_read_b64_tr_b16 v[186:187], v22 offset:50176
v_mfma_f32_16x16x32_bf16 a[104:107], v[236:239], v[200:203], a[104:107]
ds_read_b64_tr_b16 v[188:189], v23 offset:49152
v_mfma_f32_16x16x32_bf16 a[100:103], v[236:239], v[196:199], a[100:103]
s_add_u32 s72, s71, 95232
buffer_load_dwordx4 v7, s[16:19], s72 offen offset:3072 lds
v_mfma_f32_16x16x32_bf16 a[96:99], v[236:239], v[192:195], a[96:99]
ds_read_b64_tr_b16 v[190:191], v23 offset:50176
v_mfma_f32_16x16x32_bf16 a[128:131], v[192:195], v[240:243], a[128:131]
v_mfma_f32_16x16x32_bf16 a[132:135], v[196:199], v[240:243], a[132:135]
v_mfma_f32_16x16x32_bf16 a[136:139], v[200:203], v[240:243], a[136:139]
s_add_u32 m0, s63, 69632
v_mfma_f32_16x16x32_bf16 a[140:143], v[204:207], v[240:243], a[140:143]
s_add_u32 s72, s69, 32768
buffer_load_dwordx4 v2, s[8:11], s72 offen lds
v_mfma_f32_16x16x32_bf16 a[144:147], v[208:211], v[240:243], a[144:147]
v_mfma_f32_16x16x32_bf16 a[148:151], v[212:215], v[240:243], a[148:151]
v_mfma_f32_16x16x32_bf16 a[152:155], v[216:219], v[240:243], a[152:155]
s_add_u32 s72, s69, 39936
buffer_load_dwordx4 v3, s[8:11], s72 offen offset:1024 lds
v_mfma_f32_16x16x32_bf16 a[156:159], v[220:223], v[240:243], a[156:159]
v_mfma_f32_16x16x32_bf16 a[188:191], v[220:223], v[244:247], a[188:191]
v_mfma_f32_16x16x32_bf16 a[184:187], v[216:219], v[244:247], a[184:187]
v_mfma_f32_16x16x32_bf16 a[180:183], v[212:215], v[244:247], a[180:183]
v_mfma_f32_16x16x32_bf16 a[176:179], v[208:211], v[244:247], a[176:179]
s_add_u32 s72, s69, 47104
buffer_load_dwordx4 v2, s[8:11], s72 offen offset:2048 lds
v_mfma_f32_16x16x32_bf16 a[172:175], v[204:207], v[244:247], a[172:175]
v_mfma_f32_16x16x32_bf16 a[168:171], v[200:203], v[244:247], a[168:171]
v_mfma_f32_16x16x32_bf16 a[164:167], v[196:199], v[244:247], a[164:167]
v_mfma_f32_16x16x32_bf16 a[160:163], v[192:195], v[244:247], a[160:163]
s_add_u32 s72, s69, 54272
buffer_load_dwordx4 v3, s[8:11], s72 offen offset:3072 lds
v_mfma_f32_16x16x32_bf16 a[192:195], v[192:195], v[248:251], a[192:195]
v_mfma_f32_16x16x32_bf16 a[196:199], v[196:199], v[248:251], a[196:199]
v_mfma_f32_16x16x32_bf16 a[200:203], v[200:203], v[248:251], a[200:203]
v_mfma_f32_16x16x32_bf16 a[204:207], v[204:207], v[248:251], a[204:207]
s_add_u32 m0, s64, 16384
v_mfma_f32_16x16x32_bf16 a[208:211], v[208:211], v[248:251], a[208:211]
s_add_u32 s72, s71, 0
buffer_load_dwordx4 v6, s[20:23], s72 offen lds
v_mfma_f32_16x16x32_bf16 a[212:215], v[212:215], v[248:251], a[212:215]
v_mfma_f32_16x16x32_bf16 a[216:219], v[216:219], v[248:251], a[216:219]
v_mfma_f32_16x16x32_bf16 a[220:223], v[220:223], v[248:251], a[220:223]
v_mfma_f32_16x16x32_bf16 a[252:255], v[220:223], v[252:255], a[252:255]
s_add_u32 s72, s71, 31744
buffer_load_dwordx4 v6, s[20:23], s72 offen offset:1024 lds
v_mfma_f32_16x16x32_bf16 a[248:251], v[216:219], v[252:255], a[248:251]
v_mfma_f32_16x16x32_bf16 a[244:247], v[212:215], v[252:255], a[244:247]
v_mfma_f32_16x16x32_bf16 a[240:243], v[208:211], v[252:255], a[240:243]
v_mfma_f32_16x16x32_bf16 a[236:239], v[204:207], v[252:255], a[236:239]
s_add_u32 s72, s71, 63488
buffer_load_dwordx4 v7, s[20:23], s72 offen offset:2048 lds
v_mfma_f32_16x16x32_bf16 a[232:235], v[200:203], v[252:255], a[232:235]
v_mfma_f32_16x16x32_bf16 a[228:231], v[196:199], v[252:255], a[228:231]
v_mfma_f32_16x16x32_bf16 a[224:227], v[192:195], v[252:255], a[224:227]
s_waitcnt lgkmcnt(0)
v_mfma_f32_16x16x32_bf16 a[0:3], v[160:163], v[128:131], a[0:3]
s_add_u32 s72, s71, 95232
buffer_load_dwordx4 v7, s[20:23], s72 offen offset:3072 lds
v_mfma_f32_16x16x32_bf16 a[4:7], v[160:163], v[132:135], a[4:7]
s_mov_b32 s80, 0x200000
buffer_load_dword v126, v125, s[16:19], s80 offen
v_mfma_f32_16x16x32_bf16 a[8:11], v[160:163], v[136:139], a[8:11]
buffer_load_dword v126, v125, s[20:23], s80 offen
v_mfma_f32_16x16x32_bf16 a[12:15], v[160:163], v[140:143], a[12:15]
global_load_dwordx4 v[68:71], v30, s[52:53]
v_mfma_f32_16x16x32_bf16 a[16:19], v[160:163], v[144:147], a[16:19]
buffer_load_dword v33, v27, s[28:31], 0 offen nt
v_mfma_f32_16x16x32_bf16 a[20:23], v[160:163], v[148:151], a[20:23]
buffer_load_dword v34, v27, s[28:31], 0 offen offset:2048 nt
v_mfma_f32_16x16x32_bf16 a[24:27], v[160:163], v[152:155], a[24:27]
ds_read_b64_tr_b16 v[224:225], v20 offset:40960
v_add_u32 v27, 0x1000, v27
v_mfma_f32_16x16x32_bf16 a[28:31], v[160:163], v[156:159], a[28:31]
buffer_load_dword v35, v27, s[28:31], 0 offen nt
v_mfma_f32_16x16x32_bf16 a[60:63], v[164:167], v[156:159], a[60:63]
s_add_u32 m0, s63, 131072
ds_read_b64_tr_b16 v[226:227], v20 offset:41984
v_mfma_f32_16x16x32_bf16 a[56:59], v[164:167], v[152:155], a[56:59]
s_add_u32 s80, s82, 0
buffer_load_dwordx4 v26, s[28:31], s80 offen nt lds
v_mfma_f32_16x16x32_bf16 a[52:55], v[164:167], v[148:151], a[52:55]
s_add_u32 s80, s82, 15360
buffer_load_dwordx4 v26, s[28:31], s80 offen offset:1024 nt lds
v_mfma_f32_16x16x32_bf16 a[48:51], v[164:167], v[144:147], a[48:51]
s_add_u32 s80, s82, 30720
buffer_load_dwordx4 v26, s[28:31], s80 offen offset:2048 nt lds
v_mfma_f32_16x16x32_bf16 a[44:47], v[164:167], v[140:143], a[44:47]
s_add_u32 s80, s82, 46080
buffer_load_dwordx4 v26, s[28:31], s80 offen offset:3072 nt lds
v_mfma_f32_16x16x32_bf16 a[40:43], v[164:167], v[136:139], a[40:43]
ds_read_b128 v[192:195], v25 offset:32768
v_mfma_f32_16x16x32_bf16 a[36:39], v[164:167], v[132:135], a[36:39]
ds_read_b128 v[196:199], v25 offset:34816
v_mfma_f32_16x16x32_bf16 a[32:35], v[164:167], v[128:131], a[32:35]
ds_read_b128 v[200:203], v25 offset:36864
v_mfma_f32_16x16x32_bf16 a[64:67], v[168:171], v[128:131], a[64:67]
ds_read_b128 v[204:207], v25 offset:38912
v_mfma_f32_16x16x32_bf16 a[68:71], v[168:171], v[132:135], a[68:71]
ds_read_b128 v[208:211], v25 offset:40960
v_mfma_f32_16x16x32_bf16 a[72:75], v[168:171], v[136:139], a[72:75]
ds_read_b128 v[212:215], v25 offset:43008
v_mfma_f32_16x16x32_bf16 a[76:79], v[168:171], v[140:143], a[76:79]
ds_read_b128 v[216:219], v25 offset:45056
v_mfma_f32_16x16x32_bf16 a[80:83], v[168:171], v[144:147], a[80:83]
ds_read_b128 v[220:223], v25 offset:47104
v_mfma_f32_16x16x32_bf16 a[84:87], v[168:171], v[148:151], a[84:87]
ds_read_b64_tr_b16 v[228:229], v21 offset:40960
v_mfma_f32_16x16x32_bf16 a[88:91], v[168:171], v[152:155], a[88:91]
ds_read_b64_tr_b16 v[230:231], v21 offset:41984
v_mfma_f32_16x16x32_bf16 a[92:95], v[168:171], v[156:159], a[92:95]
ds_read_b64_tr_b16 v[232:233], v22 offset:40960
v_mfma_f32_16x16x32_bf16 a[124:127], v[172:175], v[156:159], a[124:127]
ds_read_b64_tr_b16 v[234:235], v22 offset:41984
v_mfma_f32_16x16x32_bf16 a[120:123], v[172:175], v[152:155], a[120:123]
ds_read_b64_tr_b16 v[236:237], v23 offset:40960
v_mfma_f32_16x16x32_bf16 a[116:119], v[172:175], v[148:151], a[116:119]
ds_read_b64_tr_b16 v[238:239], v23 offset:41984
v_mfma_f32_16x16x32_bf16 a[112:115], v[172:175], v[144:147], a[112:115]
ds_read_b64_tr_b16 v[240:241], v20 offset:57344
v_mfma_f32_16x16x32_bf16 a[108:111], v[172:175], v[140:143], a[108:111]
ds_read_b64_tr_b16 v[242:243], v20 offset:58368
v_mfma_f32_16x16x32_bf16 a[104:107], v[172:175], v[136:139], a[104:107]
ds_read_b64_tr_b16 v[244:245], v21 offset:57344
v_mfma_f32_16x16x32_bf16 a[100:103], v[172:175], v[132:135], a[100:103]
ds_read_b64_tr_b16 v[246:247], v21 offset:58368
v_mfma_f32_16x16x32_bf16 a[96:99], v[172:175], v[128:131], a[96:99]
ds_read_b64_tr_b16 v[248:249], v22 offset:57344
v_mfma_f32_16x16x32_bf16 a[128:131], v[128:131], v[176:179], a[128:131]
ds_read_b64_tr_b16 v[250:251], v22 offset:58368
v_mfma_f32_16x16x32_bf16 a[132:135], v[132:135], v[176:179], a[132:135]
ds_read_b64_tr_b16 v[252:253], v23 offset:57344
v_mfma_f32_16x16x32_bf16 a[136:139], v[136:139], v[176:179], a[136:139]
ds_read_b64_tr_b16 v[254:255], v23 offset:58368
v_mfma_f32_16x16x32_bf16 a[140:143], v[140:143], v[176:179], a[140:143]
v_mfma_f32_16x16x32_bf16 a[144:147], v[144:147], v[176:179], a[144:147]
v_mfma_f32_16x16x32_bf16 a[148:151], v[148:151], v[176:179], a[148:151]
v_mfma_f32_16x16x32_bf16 a[152:155], v[152:155], v[176:179], a[152:155]
v_mfma_f32_16x16x32_bf16 a[156:159], v[156:159], v[176:179], a[156:159]
v_mfma_f32_16x16x32_bf16 a[188:191], v[156:159], v[180:183], a[188:191]
v_mfma_f32_16x16x32_bf16 a[184:187], v[152:155], v[180:183], a[184:187]
v_mfma_f32_16x16x32_bf16 a[180:183], v[148:151], v[180:183], a[180:183]
v_mfma_f32_16x16x32_bf16 a[176:179], v[144:147], v[180:183], a[176:179]
v_mfma_f32_16x16x32_bf16 a[172:175], v[140:143], v[180:183], a[172:175]
v_mfma_f32_16x16x32_bf16 a[168:171], v[136:139], v[180:183], a[168:171]
v_mfma_f32_16x16x32_bf16 a[164:167], v[132:135], v[180:183], a[164:167]
v_mfma_f32_16x16x32_bf16 a[160:163], v[128:131], v[180:183], a[160:163]
v_mfma_f32_16x16x32_bf16 a[192:195], v[128:131], v[184:187], a[192:195]
v_mfma_f32_16x16x32_bf16 a[196:199], v[132:135], v[184:187], a[196:199]
v_mfma_f32_16x16x32_bf16 a[200:203], v[136:139], v[184:187], a[200:203]
v_mfma_f32_16x16x32_bf16 a[204:207], v[140:143], v[184:187], a[204:207]
v_mfma_f32_16x16x32_bf16 a[208:211], v[144:147], v[184:187], a[208:211]
v_mfma_f32_16x16x32_bf16 a[212:215], v[148:151], v[184:187], a[212:215]
v_mfma_f32_16x16x32_bf16 a[216:219], v[152:155], v[184:187], a[216:219]
v_mfma_f32_16x16x32_bf16 a[220:223], v[156:159], v[184:187], a[220:223]
v_mfma_f32_16x16x32_bf16 a[252:255], v[156:159], v[188:191], a[252:255]
v_mfma_f32_16x16x32_bf16 a[248:251], v[152:155], v[188:191], a[248:251]
v_mfma_f32_16x16x32_bf16 a[244:247], v[148:151], v[188:191], a[244:247]
v_mfma_f32_16x16x32_bf16 a[240:243], v[144:147], v[188:191], a[240:243]
v_mfma_f32_16x16x32_bf16 a[236:239], v[140:143], v[188:191], a[236:239]
v_mfma_f32_16x16x32_bf16 a[232:235], v[136:139], v[188:191], a[232:235]
v_mfma_f32_16x16x32_bf16 a[228:231], v[132:135], v[188:191], a[228:231]
s_waitcnt vmcnt(10) lgkmcnt(0)
v_mfma_f32_16x16x32_bf16 a[224:227], v[128:131], v[188:191], a[224:227]
s_barrier
v_mfma_f32_16x16x32_bf16 a[0:3], v[224:227], v[192:195], a[0:3]
s_and_b32 s73, s65, 1
ds_read_b64_tr_b16 v[160:161], v20 offset:0
v_mfma_f32_16x16x32_bf16 a[4:7], v[224:227], v[196:199], a[4:7]
s_xor_b32 s73, s73, 3
ds_read_b64_tr_b16 v[162:163], v20 offset:1024
v_mfma_f32_16x16x32_bf16 a[8:11], v[224:227], v[200:203], a[8:11]
s_lshl_b32 s69, s73, 7
ds_read_b128 v[128:131], v24 offset:0
v_mfma_f32_16x16x32_bf16 a[12:15], v[224:227], v[204:207], a[12:15]
s_add_u32 s69, s69, s84
ds_read_b128 v[132:135], v24 offset:2048
v_mfma_f32_16x16x32_bf16 a[16:19], v[224:227], v[208:211], a[16:19]
s_lshl_b32 s71, s73, 19
ds_read_b128 v[136:139], v24 offset:4096
v_mfma_f32_16x16x32_bf16 a[20:23], v[224:227], v[212:215], a[20:23]
s_add_u32 s71, s71, s66
ds_read_b128 v[140:143], v24 offset:6144
v_mfma_f32_16x16x32_bf16 a[24:27], v[224:227], v[216:219], a[24:27]
s_add_u32 m0, s63, 98304
ds_read_b128 v[144:147], v24 offset:8192
v_mfma_f32_16x16x32_bf16 a[28:31], v[224:227], v[220:223], a[28:31]
s_add_u32 s72, s69, 0
buffer_load_dwordx4 v2, s[8:11], s72 offen lds
v_mfma_f32_16x16x32_bf16 a[60:63], v[228:231], v[220:223], a[60:63]
s_add_u32 s72, s69, 7168
buffer_load_dwordx4 v3, s[8:11], s72 offen offset:1024 lds
v_mfma_f32_16x16x32_bf16 a[56:59], v[228:231], v[216:219], a[56:59]
s_add_u32 s72, s69, 14336
buffer_load_dwordx4 v2, s[8:11], s72 offen offset:2048 lds
v_mfma_f32_16x16x32_bf16 a[52:55], v[228:231], v[212:215], a[52:55]
ds_read_b128 v[148:151], v24 offset:10240
v_mfma_f32_16x16x32_bf16 a[48:51], v[228:231], v[208:211], a[48:51]
ds_read_b128 v[152:155], v24 offset:12288
v_mfma_f32_16x16x32_bf16 a[44:47], v[228:231], v[204:207], a[44:47]
s_add_u32 s72, s69, 21504
buffer_load_dwordx4 v3, s[8:11], s72 offen offset:3072 lds
v_mfma_f32_16x16x32_bf16 a[40:43], v[228:231], v[200:203], a[40:43]
ds_read_b128 v[156:159], v24 offset:14336
v_mfma_f32_16x16x32_bf16 a[36:39], v[228:231], v[196:199], a[36:39]
ds_read_b64_tr_b16 v[164:165], v21 offset:0
v_mfma_f32_16x16x32_bf16 a[32:35], v[228:231], v[192:195], a[32:35]
ds_read_b64_tr_b16 v[166:167], v21 offset:1024
v_mfma_f32_16x16x32_bf16 a[64:67], v[232:235], v[192:195], a[64:67]
ds_read_b64_tr_b16 v[168:169], v22 offset:0
v_mfma_f32_16x16x32_bf16 a[68:71], v[232:235], v[196:199], a[68:71]
s_add_u32 m0, s64, 32768
ds_read_b64_tr_b16 v[170:171], v22 offset:1024
v_mfma_f32_16x16x32_bf16 a[72:75], v[232:235], v[200:203], a[72:75]
s_add_u32 s72, s71, 0
buffer_load_dwordx4 v6, s[16:19], s72 offen lds
v_mfma_f32_16x16x32_bf16 a[76:79], v[232:235], v[204:207], a[76:79]
ds_read_b64_tr_b16 v[172:173], v23 offset:0
v_mfma_f32_16x16x32_bf16 a[80:83], v[232:235], v[208:211], a[80:83]
ds_read_b64_tr_b16 v[174:175], v23 offset:1024
v_mfma_f32_16x16x32_bf16 a[84:87], v[232:235], v[212:215], a[84:87]
s_add_u32 s72, s71, 31744
buffer_load_dwordx4 v6, s[16:19], s72 offen offset:1024 lds
v_mfma_f32_16x16x32_bf16 a[88:91], v[232:235], v[216:219], a[88:91]
ds_read_b64_tr_b16 v[176:177], v20 offset:16384
v_mfma_f32_16x16x32_bf16 a[92:95], v[232:235], v[220:223], a[92:95]
ds_read_b64_tr_b16 v[178:179], v20 offset:17408
v_mfma_f32_16x16x32_bf16 a[124:127], v[236:239], v[220:223], a[124:127]
ds_read_b64_tr_b16 v[180:181], v21 offset:16384
v_mfma_f32_16x16x32_bf16 a[120:123], v[236:239], v[216:219], a[120:123]
s_add_u32 s72, s71, 63488
buffer_load_dwordx4 v7, s[16:19], s72 offen offset:2048 lds
v_mfma_f32_16x16x32_bf16 a[116:119], v[236:239], v[212:215], a[116:119]
ds_read_b64_tr_b16 v[182:183], v21 offset:17408
v_mfma_f32_16x16x32_bf16 a[112:115], v[236:239], v[208:211], a[112:115]
ds_read_b64_tr_b16 v[184:185], v22 offset:16384
v_mfma_f32_16x16x32_bf16 a[108:111], v[236:239], v[204:207], a[108:111]
ds_read_b64_tr_b16 v[186:187], v22 offset:17408
v_mfma_f32_16x16x32_bf16 a[104:107], v[236:239], v[200:203], a[104:107]
ds_read_b64_tr_b16 v[188:189], v23 offset:16384
v_mfma_f32_16x16x32_bf16 a[100:103], v[236:239], v[196:199], a[100:103]
s_add_u32 s72, s71, 95232
buffer_load_dwordx4 v7, s[16:19], s72 offen offset:3072 lds
v_mfma_f32_16x16x32_bf16 a[96:99], v[236:239], v[192:195], a[96:99]
ds_read_b64_tr_b16 v[190:191], v23 offset:17408
v_mfma_f32_16x16x32_bf16 a[128:131], v[192:195], v[240:243], a[128:131]
v_mfma_f32_16x16x32_bf16 a[132:135], v[196:199], v[240:243], a[132:135]
v_mfma_f32_16x16x32_bf16 a[136:139], v[200:203], v[240:243], a[136:139]
s_add_u32 m0, s63, 102400
v_mfma_f32_16x16x32_bf16 a[140:143], v[204:207], v[240:243], a[140:143]
s_add_u32 s72, s69, 32768
buffer_load_dwordx4 v2, s[8:11], s72 offen lds
v_mfma_f32_16x16x32_bf16 a[144:147], v[208:211], v[240:243], a[144:147]
v_mfma_f32_16x16x32_bf16 a[148:151], v[212:215], v[240:243], a[148:151]
v_mfma_f32_16x16x32_bf16 a[152:155], v[216:219], v[240:243], a[152:155]
s_add_u32 s72, s69, 39936
buffer_load_dwordx4 v3, s[8:11], s72 offen offset:1024 lds
v_mfma_f32_16x16x32_bf16 a[156:159], v[220:223], v[240:243], a[156:159]
v_mfma_f32_16x16x32_bf16 a[188:191], v[220:223], v[244:247], a[188:191]
v_mfma_f32_16x16x32_bf16 a[184:187], v[216:219], v[244:247], a[184:187]
v_mfma_f32_16x16x32_bf16 a[180:183], v[212:215], v[244:247], a[180:183]
v_mfma_f32_16x16x32_bf16 a[176:179], v[208:211], v[244:247], a[176:179]
s_add_u32 s72, s69, 47104
buffer_load_dwordx4 v2, s[8:11], s72 offen offset:2048 lds
v_mfma_f32_16x16x32_bf16 a[172:175], v[204:207], v[244:247], a[172:175]
v_mfma_f32_16x16x32_bf16 a[168:171], v[200:203], v[244:247], a[168:171]
v_mfma_f32_16x16x32_bf16 a[164:167], v[196:199], v[244:247], a[164:167]
v_mfma_f32_16x16x32_bf16 a[160:163], v[192:195], v[244:247], a[160:163]
s_add_u32 s72, s69, 54272
buffer_load_dwordx4 v3, s[8:11], s72 offen offset:3072 lds
v_mfma_f32_16x16x32_bf16 a[192:195], v[192:195], v[248:251], a[192:195]
v_mfma_f32_16x16x32_bf16 a[196:199], v[196:199], v[248:251], a[196:199]
v_mfma_f32_16x16x32_bf16 a[200:203], v[200:203], v[248:251], a[200:203]
v_mfma_f32_16x16x32_bf16 a[204:207], v[204:207], v[248:251], a[204:207]
s_add_u32 m0, s64, 49152
v_mfma_f32_16x16x32_bf16 a[208:211], v[208:211], v[248:251], a[208:211]
s_add_u32 s72, s71, 0
buffer_load_dwordx4 v6, s[20:23], s72 offen lds
v_mfma_f32_16x16x32_bf16 a[212:215], v[212:215], v[248:251], a[212:215]
v_mfma_f32_16x16x32_bf16 a[216:219], v[216:219], v[248:251], a[216:219]
v_mfma_f32_16x16x32_bf16 a[220:223], v[220:223], v[248:251], a[220:223]
v_mfma_f32_16x16x32_bf16 a[252:255], v[220:223], v[252:255], a[252:255]
s_add_u32 s72, s71, 31744
buffer_load_dwordx4 v6, s[20:23], s72 offen offset:1024 lds
v_mfma_f32_16x16x32_bf16 a[248:251], v[216:219], v[252:255], a[248:251]
v_mfma_f32_16x16x32_bf16 a[244:247], v[212:215], v[252:255], a[244:247]
v_mfma_f32_16x16x32_bf16 a[240:243], v[208:211], v[252:255], a[240:243]
v_mfma_f32_16x16x32_bf16 a[236:239], v[204:207], v[252:255], a[236:239]
s_add_u32 s72, s71, 63488
buffer_load_dwordx4 v7, s[20:23], s72 offen offset:2048 lds
v_mfma_f32_16x16x32_bf16 a[232:235], v[200:203], v[252:255], a[232:235]
v_mfma_f32_16x16x32_bf16 a[228:231], v[196:199], v[252:255], a[228:231]
v_mfma_f32_16x16x32_bf16 a[224:227], v[192:195], v[252:255], a[224:227]
s_waitcnt lgkmcnt(0)
v_mfma_f32_16x16x32_bf16 a[0:3], v[160:163], v[128:131], a[0:3]
s_add_u32 s72, s71, 95232
buffer_load_dwordx4 v7, s[20:23], s72 offen offset:3072 lds
v_mfma_f32_16x16x32_bf16 a[4:7], v[160:163], v[132:135], a[4:7]
s_mov_b32 s80, 0x300000
buffer_load_dword v126, v125, s[16:19], s80 offen
v_mfma_f32_16x16x32_bf16 a[8:11], v[160:163], v[136:139], a[8:11]
buffer_load_dword v126, v125, s[20:23], s80 offen
v_mfma_f32_16x16x32_bf16 a[12:15], v[160:163], v[140:143], a[12:15]
s_add_u32 m0, s63, 135168
ds_read_b64_tr_b16 v[224:225], v20 offset:8192
v_mfma_f32_16x16x32_bf16 a[16:19], v[160:163], v[144:147], a[16:19]
s_add_u32 s80, s82, 0
buffer_load_dwordx4 v26, s[32:35], s80 offen nt lds
v_mfma_f32_16x16x32_bf16 a[20:23], v[160:163], v[148:151], a[20:23]
s_add_u32 s80, s82, 15360
buffer_load_dwordx4 v26, s[32:35], s80 offen offset:1024 nt lds
v_mfma_f32_16x16x32_bf16 a[24:27], v[160:163], v[152:155], a[24:27]
s_add_u32 s80, s82, 30720
buffer_load_dwordx4 v26, s[32:35], s80 offen offset:2048 nt lds
v_mfma_f32_16x16x32_bf16 a[28:31], v[160:163], v[156:159], a[28:31]
s_add_u32 s80, s82, 46080
buffer_load_dwordx4 v26, s[32:35], s80 offen offset:3072 nt lds
v_mfma_f32_16x16x32_bf16 a[60:63], v[164:167], v[156:159], a[60:63]
ds_read_b64_tr_b16 v[226:227], v20 offset:9216
v_mfma_f32_16x16x32_bf16 a[56:59], v[164:167], v[152:155], a[56:59]
ds_read_b128 v[192:195], v25 offset:0
v_mfma_f32_16x16x32_bf16 a[52:55], v[164:167], v[148:151], a[52:55]
ds_read_b128 v[196:199], v25 offset:2048
v_mfma_f32_16x16x32_bf16 a[48:51], v[164:167], v[144:147], a[48:51]
ds_read_b128 v[200:203], v25 offset:4096
v_mfma_f32_16x16x32_bf16 a[44:47], v[164:167], v[140:143], a[44:47]
ds_read_b128 v[204:207], v25 offset:6144
v_mfma_f32_16x16x32_bf16 a[40:43], v[164:167], v[136:139], a[40:43]
ds_read_b128 v[208:211], v25 offset:8192
v_mfma_f32_16x16x32_bf16 a[36:39], v[164:167], v[132:135], a[36:39]
ds_read_b128 v[212:215], v25 offset:10240
v_mfma_f32_16x16x32_bf16 a[32:35], v[164:167], v[128:131], a[32:35]
ds_read_b128 v[216:219], v25 offset:12288
v_mfma_f32_16x16x32_bf16 a[64:67], v[168:171], v[128:131], a[64:67]
ds_read_b128 v[220:223], v25 offset:14336
v_mfma_f32_16x16x32_bf16 a[68:71], v[168:171], v[132:135], a[68:71]
ds_read_b64_tr_b16 v[228:229], v21 offset:8192
v_mfma_f32_16x16x32_bf16 a[72:75], v[168:171], v[136:139], a[72:75]
ds_read_b64_tr_b16 v[230:231], v21 offset:9216
v_mfma_f32_16x16x32_bf16 a[76:79], v[168:171], v[140:143], a[76:79]
ds_read_b64_tr_b16 v[232:233], v22 offset:8192
v_mfma_f32_16x16x32_bf16 a[80:83], v[168:171], v[144:147], a[80:83]
ds_read_b64_tr_b16 v[234:235], v22 offset:9216
v_mfma_f32_16x16x32_bf16 a[84:87], v[168:171], v[148:151], a[84:87]
ds_read_b64_tr_b16 v[236:237], v23 offset:8192
v_mfma_f32_16x16x32_bf16 a[88:91], v[168:171], v[152:155], a[88:91]
ds_read_b64_tr_b16 v[238:239], v23 offset:9216
v_mfma_f32_16x16x32_bf16 a[92:95], v[168:171], v[156:159], a[92:95]
ds_read_b64_tr_b16 v[240:241], v20 offset:24576
v_mfma_f32_16x16x32_bf16 a[124:127], v[172:175], v[156:159], a[124:127]
ds_read_b64_tr_b16 v[242:243], v20 offset:25600
v_mfma_f32_16x16x32_bf16 a[120:123], v[172:175], v[152:155], a[120:123]
ds_read_b64_tr_b16 v[244:245], v21 offset:24576
v_mfma_f32_16x16x32_bf16 a[116:119], v[172:175], v[148:151], a[116:119]
ds_read_b64_tr_b16 v[246:247], v21 offset:25600
v_mfma_f32_16x16x32_bf16 a[112:115], v[172:175], v[144:147], a[112:115]
ds_read_b64_tr_b16 v[248:249], v22 offset:24576
v_mfma_f32_16x16x32_bf16 a[108:111], v[172:175], v[140:143], a[108:111]
ds_read_b64_tr_b16 v[250:251], v22 offset:25600
v_mfma_f32_16x16x32_bf16 a[104:107], v[172:175], v[136:139], a[104:107]
ds_read_b64_tr_b16 v[252:253], v23 offset:24576
v_mfma_f32_16x16x32_bf16 a[100:103], v[172:175], v[132:135], a[100:103]
ds_read_b64_tr_b16 v[254:255], v23 offset:25600
v_mfma_f32_16x16x32_bf16 a[96:99], v[172:175], v[128:131], a[96:99]
v_mfma_f32_16x16x32_bf16 a[128:131], v[128:131], v[176:179], a[128:131]
v_mfma_f32_16x16x32_bf16 a[132:135], v[132:135], v[176:179], a[132:135]
v_mfma_f32_16x16x32_bf16 a[136:139], v[136:139], v[176:179], a[136:139]
v_mfma_f32_16x16x32_bf16 a[140:143], v[140:143], v[176:179], a[140:143]
v_mfma_f32_16x16x32_bf16 a[144:147], v[144:147], v[176:179], a[144:147]
v_mfma_f32_16x16x32_bf16 a[148:151], v[148:151], v[176:179], a[148:151]
v_mfma_f32_16x16x32_bf16 a[152:155], v[152:155], v[176:179], a[152:155]
v_mfma_f32_16x16x32_bf16 a[156:159], v[156:159], v[176:179], a[156:159]
v_mfma_f32_16x16x32_bf16 a[188:191], v[156:159], v[180:183], a[188:191]
v_mfma_f32_16x16x32_bf16 a[184:187], v[152:155], v[180:183], a[184:187]
v_mfma_f32_16x16x32_bf16 a[180:183], v[148:151], v[180:183], a[180:183]
v_mfma_f32_16x16x32_bf16 a[176:179], v[144:147], v[180:183], a[176:179]
v_mfma_f32_16x16x32_bf16 a[172:175], v[140:143], v[180:183], a[172:175]
v_mfma_f32_16x16x32_bf16 a[168:171], v[136:139], v[180:183], a[168:171]
v_mfma_f32_16x16x32_bf16 a[164:167], v[132:135], v[180:183], a[164:167]
v_mfma_f32_16x16x32_bf16 a[160:163], v[128:131], v[180:183], a[160:163]
v_mfma_f32_16x16x32_bf16 a[192:195], v[128:131], v[184:187], a[192:195]
v_mfma_f32_16x16x32_bf16 a[196:199], v[132:135], v[184:187], a[196:199]
v_mfma_f32_16x16x32_bf16 a[200:203], v[136:139], v[184:187], a[200:203]
v_mfma_f32_16x16x32_bf16 a[204:207], v[140:143], v[184:187], a[204:207]
v_mfma_f32_16x16x32_bf16 a[208:211], v[144:147], v[184:187], a[208:211]
v_mfma_f32_16x16x32_bf16 a[212:215], v[148:151], v[184:187], a[212:215]
v_mfma_f32_16x16x32_bf16 a[216:219], v[152:155], v[184:187], a[216:219]
v_mfma_f32_16x16x32_bf16 a[220:223], v[156:159], v[184:187], a[220:223]
v_mfma_f32_16x16x32_bf16 a[252:255], v[156:159], v[188:191], a[252:255]
v_mfma_f32_16x16x32_bf16 a[248:251], v[152:155], v[188:191], a[248:251]
v_mfma_f32_16x16x32_bf16 a[244:247], v[148:151], v[188:191], a[244:247]
v_mfma_f32_16x16x32_bf16 a[240:243], v[144:147], v[188:191], a[240:243]
v_mfma_f32_16x16x32_bf16 a[236:239], v[140:143], v[188:191], a[236:239]
v_mfma_f32_16x16x32_bf16 a[232:235], v[136:139], v[188:191], a[232:235]
v_mfma_f32_16x16x32_bf16 a[228:231], v[132:135], v[188:191], a[228:231]
s_waitcnt vmcnt(6) lgkmcnt(0)
v_mfma_f32_16x16x32_bf16 a[224:227], v[128:131], v[188:191], a[224:227]
s_barrier
v_mfma_f32_16x16x32_bf16 a[0:3], v[224:227], v[192:195], a[0:3]
s_and_b32 s73, s65, 1
ds_read_b64_tr_b16 v[160:161], v20 offset:32768
v_mfma_f32_16x16x32_bf16 a[4:7], v[224:227], v[196:199], a[4:7]
s_xor_b32 s73, s73, 4
ds_read_b64_tr_b16 v[162:163], v20 offset:33792
v_mfma_f32_16x16x32_bf16 a[8:11], v[224:227], v[200:203], a[8:11]
s_lshl_b32 s69, s73, 7
ds_read_b128 v[128:131], v24 offset:32768
v_mfma_f32_16x16x32_bf16 a[12:15], v[224:227], v[204:207], a[12:15]
s_add_u32 s69, s69, s84
ds_read_b128 v[132:135], v24 offset:34816
v_mfma_f32_16x16x32_bf16 a[16:19], v[224:227], v[208:211], a[16:19]
s_lshl_b32 s71, s73, 19
ds_read_b128 v[136:139], v24 offset:36864
v_mfma_f32_16x16x32_bf16 a[20:23], v[224:227], v[212:215], a[20:23]
s_add_u32 s71, s71, s66
ds_read_b128 v[140:143], v24 offset:38912
v_mfma_f32_16x16x32_bf16 a[24:27], v[224:227], v[216:219], a[24:27]
s_add_u32 m0, s63, 65536
ds_read_b128 v[144:147], v24 offset:40960
v_mfma_f32_16x16x32_bf16 a[28:31], v[224:227], v[220:223], a[28:31]
s_add_u32 s72, s69, 0
buffer_load_dwordx4 v2, s[8:11], s72 offen lds
v_mfma_f32_16x16x32_bf16 a[60:63], v[228:231], v[220:223], a[60:63]
s_add_u32 s72, s69, 7168
buffer_load_dwordx4 v3, s[8:11], s72 offen offset:1024 lds
v_mfma_f32_16x16x32_bf16 a[56:59], v[228:231], v[216:219], a[56:59]
s_add_u32 s72, s69, 14336
buffer_load_dwordx4 v2, s[8:11], s72 offen offset:2048 lds
v_mfma_f32_16x16x32_bf16 a[52:55], v[228:231], v[212:215], a[52:55]
ds_read_b128 v[148:151], v24 offset:43008
v_mfma_f32_16x16x32_bf16 a[48:51], v[228:231], v[208:211], a[48:51]
ds_read_b128 v[152:155], v24 offset:45056
v_mfma_f32_16x16x32_bf16 a[44:47], v[228:231], v[204:207], a[44:47]
s_add_u32 s72, s69, 21504
buffer_load_dwordx4 v3, s[8:11], s72 offen offset:3072 lds
v_mfma_f32_16x16x32_bf16 a[40:43], v[228:231], v[200:203], a[40:43]
ds_read_b128 v[156:159], v24 offset:47104
v_mfma_f32_16x16x32_bf16 a[36:39], v[228:231], v[196:199], a[36:39]
ds_read_b64_tr_b16 v[164:165], v21 offset:32768
v_mfma_f32_16x16x32_bf16 a[32:35], v[228:231], v[192:195], a[32:35]
ds_read_b64_tr_b16 v[166:167], v21 offset:33792
v_mfma_f32_16x16x32_bf16 a[64:67], v[232:235], v[192:195], a[64:67]
ds_read_b64_tr_b16 v[168:169], v22 offset:32768
v_mfma_f32_16x16x32_bf16 a[68:71], v[232:235], v[196:199], a[68:71]
s_add_u32 m0, s64, 0
ds_read_b64_tr_b16 v[170:171], v22 offset:33792
v_mfma_f32_16x16x32_bf16 a[72:75], v[232:235], v[200:203], a[72:75]
s_add_u32 s72, s71, 0
buffer_load_dwordx4 v6, s[16:19], s72 offen lds
v_mfma_f32_16x16x32_bf16 a[76:79], v[232:235], v[204:207], a[76:79]
ds_read_b64_tr_b16 v[172:173], v23 offset:32768
v_mfma_f32_16x16x32_bf16 a[80:83], v[232:235], v[208:211], a[80:83]
ds_read_b64_tr_b16 v[174:175], v23 offset:33792
v_mfma_f32_16x16x32_bf16 a[84:87], v[232:235], v[212:215], a[84:87]
s_add_u32 s72, s71, 31744
buffer_load_dwordx4 v6, s[16:19], s72 offen offset:1024 lds
v_mfma_f32_16x16x32_bf16 a[88:91], v[232:235], v[216:219], a[88:91]
ds_read_b64_tr_b16 v[176:177], v20 offset:49152
v_mfma_f32_16x16x32_bf16 a[92:95], v[232:235], v[220:223], a[92:95]
ds_read_b64_tr_b16 v[178:179], v20 offset:50176
v_mfma_f32_16x16x32_bf16 a[124:127], v[236:239], v[220:223], a[124:127]
ds_read_b64_tr_b16 v[180:181], v21 offset:49152
v_mfma_f32_16x16x32_bf16 a[120:123], v[236:239], v[216:219], a[120:123]
s_add_u32 s72, s71, 63488
buffer_load_dwordx4 v7, s[16:19], s72 offen offset:2048 lds
v_mfma_f32_16x16x32_bf16 a[116:119], v[236:239], v[212:215], a[116:119]
ds_read_b64_tr_b16 v[182:183], v21 offset:50176
v_mfma_f32_16x16x32_bf16 a[112:115], v[236:239], v[208:211], a[112:115]
ds_read_b64_tr_b16 v[184:185], v22 offset:49152
v_mfma_f32_16x16x32_bf16 a[108:111], v[236:239], v[204:207], a[108:111]
ds_read_b64_tr_b16 v[186:187], v22 offset:50176
v_mfma_f32_16x16x32_bf16 a[104:107], v[236:239], v[200:203], a[104:107]
ds_read_b64_tr_b16 v[188:189], v23 offset:49152
v_mfma_f32_16x16x32_bf16 a[100:103], v[236:239], v[196:199], a[100:103]
s_add_u32 s72, s71, 95232
buffer_load_dwordx4 v7, s[16:19], s72 offen offset:3072 lds
v_mfma_f32_16x16x32_bf16 a[96:99], v[236:239], v[192:195], a[96:99]
ds_read_b64_tr_b16 v[190:191], v23 offset:50176
v_mfma_f32_16x16x32_bf16 a[128:131], v[192:195], v[240:243], a[128:131]
v_mfma_f32_16x16x32_bf16 a[132:135], v[196:199], v[240:243], a[132:135]
v_mfma_f32_16x16x32_bf16 a[136:139], v[200:203], v[240:243], a[136:139]
s_add_u32 m0, s63, 69632
v_mfma_f32_16x16x32_bf16 a[140:143], v[204:207], v[240:243], a[140:143]
s_add_u32 s72, s69, 32768
buffer_load_dwordx4 v2, s[8:11], s72 offen lds
v_mfma_f32_16x16x32_bf16 a[144:147], v[208:211], v[240:243], a[144:147]
v_mfma_f32_16x16x32_bf16 a[148:151], v[212:215], v[240:243], a[148:151]
v_mfma_f32_16x16x32_bf16 a[152:155], v[216:219], v[240:243], a[152:155]
s_add_u32 s72, s69, 39936
buffer_load_dwordx4 v3, s[8:11], s72 offen offset:1024 lds
v_mfma_f32_16x16x32_bf16 a[156:159], v[220:223], v[240:243], a[156:159]
v_mfma_f32_16x16x32_bf16 a[188:191], v[220:223], v[244:247], a[188:191]
v_mfma_f32_16x16x32_bf16 a[184:187], v[216:219], v[244:247], a[184:187]
v_mfma_f32_16x16x32_bf16 a[180:183], v[212:215], v[244:247], a[180:183]
v_mfma_f32_16x16x32_bf16 a[176:179], v[208:211], v[244:247], a[176:179]
s_add_u32 s72, s69, 47104
buffer_load_dwordx4 v2, s[8:11], s72 offen offset:2048 lds
v_mfma_f32_16x16x32_bf16 a[172:175], v[204:207], v[244:247], a[172:175]
v_mfma_f32_16x16x32_bf16 a[168:171], v[200:203], v[244:247], a[168:171]
v_mfma_f32_16x16x32_bf16 a[164:167], v[196:199], v[244:247], a[164:167]
v_mfma_f32_16x16x32_bf16 a[160:163], v[192:195], v[244:247], a[160:163]
s_add_u32 s72, s69, 54272
buffer_load_dwordx4 v3, s[8:11], s72 offen offset:3072 lds
v_mfma_f32_16x16x32_bf16 a[192:195], v[192:195], v[248:251], a[192:195]
v_mfma_f32_16x16x32_bf16 a[196:199], v[196:199], v[248:251], a[196:199]
v_mfma_f32_16x16x32_bf16 a[200:203], v[200:203], v[248:251], a[200:203]
v_mfma_f32_16x16x32_bf16 a[204:207], v[204:207], v[248:251], a[204:207]
s_add_u32 m0, s64, 16384
v_mfma_f32_16x16x32_bf16 a[208:211], v[208:211], v[248:251], a[208:211]
s_add_u32 s72, s71, 0
buffer_load_dwordx4 v6, s[20:23], s72 offen lds
v_mfma_f32_16x16x32_bf16 a[212:215], v[212:215], v[248:251], a[212:215]
v_mfma_f32_16x16x32_bf16 a[216:219], v[216:219], v[248:251], a[216:219]
v_mfma_f32_16x16x32_bf16 a[220:223], v[220:223], v[248:251], a[220:223]
v_mfma_f32_16x16x32_bf16 a[252:255], v[220:223], v[252:255], a[252:255]
s_add_u32 s72, s71, 31744
buffer_load_dwordx4 v6, s[20:23], s72 offen offset:1024 lds
v_mfma_f32_16x16x32_bf16 a[248:251], v[216:219], v[252:255], a[248:251]
v_mfma_f32_16x16x32_bf16 a[244:247], v[212:215], v[252:255], a[244:247]
v_mfma_f32_16x16x32_bf16 a[240:243], v[208:211], v[252:255], a[240:243]
v_mfma_f32_16x16x32_bf16 a[236:239], v[204:207], v[252:255], a[236:239]
s_add_u32 s72, s71, 63488
buffer_load_dwordx4 v7, s[20:23], s72 offen offset:2048 lds
v_mfma_f32_16x16x32_bf16 a[232:235], v[200:203], v[252:255], a[232:235]
v_mfma_f32_16x16x32_bf16 a[228:231], v[196:199], v[252:255], a[228:231]
v_mfma_f32_16x16x32_bf16 a[224:227], v[192:195], v[252:255], a[224:227]
s_waitcnt lgkmcnt(0)
v_mfma_f32_16x16x32_bf16 a[0:3], v[160:163], v[128:131], a[0:3]
s_add_u32 s72, s71, 95232
buffer_load_dwordx4 v7, s[20:23], s72 offen offset:3072 lds
v_mfma_f32_16x16x32_bf16 a[4:7], v[160:163], v[132:135], a[4:7]
buffer_load_dwordx4 v[108:111], v1, s[4:7], s76 offen
v_mfma_f32_16x16x32_bf16 a[8:11], v[160:163], v[136:139], a[8:11]
buffer_load_dwordx4 v[112:115], v1, s[4:7], s76 offen offset:1024
v_mfma_f32_16x16x32_bf16 a[12:15], v[160:163], v[140:143], a[12:15]
buffer_load_dwordx4 v[116:119], v1, s[4:7], s76 offen offset:2048
v_mfma_f32_16x16x32_bf16 a[16:19], v[160:163], v[144:147], a[16:19]
buffer_load_dwordx4 v[120:123], v1, s[4:7], s76 offen offset:3072
v_mfma_f32_16x16x32_bf16 a[20:23], v[160:163], v[148:151], a[20:23]
ds_read_b64_tr_b16 v[224:225], v20 offset:40960
v_mfma_f32_16x16x32_bf16 a[24:27], v[160:163], v[152:155], a[24:27]
v_mfma_f32_16x16x32_bf16 a[28:31], v[160:163], v[156:159], a[28:31]
ds_read_b64_tr_b16 v[226:227], v20 offset:41984
v_mfma_f32_16x16x32_bf16 a[60:63], v[164:167], v[156:159], a[60:63]
v_mfma_f32_16x16x32_bf16 a[56:59], v[164:167], v[152:155], a[56:59]
ds_read_b128 v[192:195], v25 offset:32768
v_mfma_f32_16x16x32_bf16 a[52:55], v[164:167], v[148:151], a[52:55]
v_mfma_f32_16x16x32_bf16 a[48:51], v[164:167], v[144:147], a[48:51]
ds_read_b128 v[196:199], v25 offset:34816
v_mfma_f32_16x16x32_bf16 a[44:47], v[164:167], v[140:143], a[44:47]
v_mfma_f32_16x16x32_bf16 a[40:43], v[164:167], v[136:139], a[40:43]
ds_read_b128 v[200:203], v25 offset:36864
v_mfma_f32_16x16x32_bf16 a[36:39], v[164:167], v[132:135], a[36:39]
v_mfma_f32_16x16x32_bf16 a[32:35], v[164:167], v[128:131], a[32:35]
ds_read_b128 v[204:207], v25 offset:38912
v_mfma_f32_16x16x32_bf16 a[64:67], v[168:171], v[128:131], a[64:67]
v_mfma_f32_16x16x32_bf16 a[68:71], v[168:171], v[132:135], a[68:71]
ds_read_b128 v[208:211], v25 offset:40960
v_mfma_f32_16x16x32_bf16 a[72:75], v[168:171], v[136:139], a[72:75]
v_mfma_f32_16x16x32_bf16 a[76:79], v[168:171], v[140:143], a[76:79]
ds_read_b128 v[212:215], v25 offset:43008
v_mfma_f32_16x16x32_bf16 a[80:83], v[168:171], v[144:147], a[80:83]
s_waitcnt vmcnt(20)
ds_read2_b32 v[36:37], v98 offset0:0 offset1:32
ds_read2_b32 v[38:39], v98 offset0:64 offset1:96
v_mfma_f32_16x16x32_bf16 a[84:87], v[168:171], v[148:151], a[84:87]
ds_read_b128 v[216:219], v25 offset:45056
ds_read2_b32 v[40:41], v98 offset0:128 offset1:160
v_mfma_f32_16x16x32_bf16 a[88:91], v[168:171], v[152:155], a[88:91]
ds_read2_b32 v[42:43], v98 offset0:192 offset1:224
v_add_u32 v98, 1024, v98
v_mfma_f32_16x16x32_bf16 a[92:95], v[168:171], v[156:159], a[92:95]
ds_read_b128 v[220:223], v25 offset:47104
ds_read2_b32 v[44:45], v98 offset0:0 offset1:32
v_mfma_f32_16x16x32_bf16 a[124:127], v[172:175], v[156:159], a[124:127]
ds_read2_b32 v[46:47], v98 offset0:64 offset1:96
ds_read2_b32 v[48:49], v98 offset0:128 offset1:160
v_mfma_f32_16x16x32_bf16 a[120:123], v[172:175], v[152:155], a[120:123]
ds_read_b64_tr_b16 v[228:229], v21 offset:40960
ds_read2_b32 v[50:51], v98 offset0:192 offset1:224
v_mfma_f32_16x16x32_bf16 a[116:119], v[172:175], v[148:151], a[116:119]
v_add_u32 v98, 3072, v98
v_mfma_f32_16x16x32_bf16 a[112:115], v[172:175], v[144:147], a[112:115]
ds_read_b64_tr_b16 v[230:231], v21 offset:41984
ds_read2_b32 v[52:53], v98 offset0:0 offset1:32
v_mfma_f32_16x16x32_bf16 a[108:111], v[172:175], v[140:143], a[108:111]
ds_read2_b32 v[54:55], v98 offset0:64 offset1:96
ds_read2_b32 v[56:57], v98 offset0:128 offset1:160
v_mfma_f32_16x16x32_bf16 a[104:107], v[172:175], v[136:139], a[104:107]
ds_read_b64_tr_b16 v[232:233], v22 offset:40960
ds_read2_b32 v[58:59], v98 offset0:192 offset1:224
v_mfma_f32_16x16x32_bf16 a[100:103], v[172:175], v[132:135], a[100:103]
v_add_u32 v98, 1024, v98
v_mfma_f32_16x16x32_bf16 a[96:99], v[172:175], v[128:131], a[96:99]
ds_read_b64_tr_b16 v[234:235], v22 offset:41984
ds_read2_b32 v[60:61], v98 offset0:0 offset1:32
v_mfma_f32_16x16x32_bf16 a[128:131], v[128:131], v[176:179], a[128:131]
ds_read2_b32 v[62:63], v98 offset0:64 offset1:96
ds_read2_b32 v[64:65], v98 offset0:128 offset1:160
v_mfma_f32_16x16x32_bf16 a[132:135], v[132:135], v[176:179], a[132:135]
ds_read_b64_tr_b16 v[236:237], v23 offset:40960
ds_read2_b32 v[66:67], v98 offset0:192 offset1:224
v_mfma_f32_16x16x32_bf16 a[136:139], v[136:139], v[176:179], a[136:139]
v_mfma_f32_16x16x32_bf16 a[140:143], v[140:143], v[176:179], a[140:143]
ds_read_b64_tr_b16 v[238:239], v23 offset:41984
v_mfma_f32_16x16x32_bf16 a[144:147], v[144:147], v[176:179], a[144:147]
v_mfma_f32_16x16x32_bf16 a[148:151], v[148:151], v[176:179], a[148:151]
ds_read_b64_tr_b16 v[240:241], v20 offset:57344
v_mfma_f32_16x16x32_bf16 a[152:155], v[152:155], v[176:179], a[152:155]
v_mfma_f32_16x16x32_bf16 a[156:159], v[156:159], v[176:179], a[156:159]
ds_read_b64_tr_b16 v[242:243], v20 offset:58368
v_mfma_f32_16x16x32_bf16 a[188:191], v[156:159], v[180:183], a[188:191]
v_mfma_f32_16x16x32_bf16 a[184:187], v[152:155], v[180:183], a[184:187]
ds_read_b64_tr_b16 v[244:245], v21 offset:57344
v_mfma_f32_16x16x32_bf16 a[180:183], v[148:151], v[180:183], a[180:183]
v_mfma_f32_16x16x32_bf16 a[176:179], v[144:147], v[180:183], a[176:179]
ds_read_b64_tr_b16 v[246:247], v21 offset:58368
v_mfma_f32_16x16x32_bf16 a[172:175], v[140:143], v[180:183], a[172:175]
v_mfma_f32_16x16x32_bf16 a[168:171], v[136:139], v[180:183], a[168:171]
ds_read_b64_tr_b16 v[248:249], v22 offset:57344
v_mfma_f32_16x16x32_bf16 a[164:167], v[132:135], v[180:183], a[164:167]
v_mfma_f32_16x16x32_bf16 a[160:163], v[128:131], v[180:183], a[160:163]
ds_read_b64_tr_b16 v[250:251], v22 offset:58368
v_mfma_f32_16x16x32_bf16 a[192:195], v[128:131], v[184:187], a[192:195]
v_mfma_f32_16x16x32_bf16 a[196:199], v[132:135], v[184:187], a[196:199]
ds_read_b64_tr_b16 v[252:253], v23 offset:57344
v_mfma_f32_16x16x32_bf16 a[200:203], v[136:139], v[184:187], a[200:203]
v_mfma_f32_16x16x32_bf16 a[204:207], v[140:143], v[184:187], a[204:207]
ds_read_b64_tr_b16 v[254:255], v23 offset:58368
v_mfma_f32_16x16x32_bf16 a[208:211], v[144:147], v[184:187], a[208:211]
v_mfma_f32_16x16x32_bf16 a[212:215], v[148:151], v[184:187], a[212:215]
v_mfma_f32_16x16x32_bf16 a[216:219], v[152:155], v[184:187], a[216:219]
v_mfma_f32_16x16x32_bf16 a[220:223], v[156:159], v[184:187], a[220:223]
v_mfma_f32_16x16x32_bf16 a[252:255], v[156:159], v[188:191], a[252:255]
v_mfma_f32_16x16x32_bf16 a[248:251], v[152:155], v[188:191], a[248:251]
v_mfma_f32_16x16x32_bf16 a[244:247], v[148:151], v[188:191], a[244:247]
v_mfma_f32_16x16x32_bf16 a[240:243], v[144:147], v[188:191], a[240:243]
v_mfma_f32_16x16x32_bf16 a[236:239], v[140:143], v[188:191], a[236:239]
v_mfma_f32_16x16x32_bf16 a[232:235], v[136:139], v[188:191], a[232:235]
v_mfma_f32_16x16x32_bf16 a[228:231], v[132:135], v[188:191], a[228:231]
s_waitcnt vmcnt(4) lgkmcnt(0)
v_mfma_f32_16x16x32_bf16 a[224:227], v[128:131], v[188:191], a[224:227]
s_barrier
v_mfma_f32_16x16x32_bf16 a[0:3], v[224:227], v[192:195], a[0:3]
s_and_b32 s73, s65, 1
ds_read_b64_tr_b16 v[160:161], v20 offset:0
v_lshlrev_b32 v72, 16, v68
v_mfma_f32_16x16x32_bf16 a[4:7], v[224:227], v[196:199], a[4:7]
s_xor_b32 s73, s73, 5
ds_read_b64_tr_b16 v[162:163], v20 offset:1024
v_and_b32 v73, 0xffff0000, v68
v_mfma_f32_16x16x32_bf16 a[8:11], v[224:227], v[200:203], a[8:11]
s_lshl_b32 s69, s73, 7
ds_read_b128 v[128:131], v24 offset:0
v_lshlrev_b32 v74, 16, v69
v_mfma_f32_16x16x32_bf16 a[12:15], v[224:227], v[204:207], a[12:15]
s_add_u32 s69, s69, s84
ds_read_b128 v[132:135], v24 offset:2048
v_and_b32 v75, 0xffff0000, v69
v_mfma_f32_16x16x32_bf16 a[16:19], v[224:227], v[208:211], a[16:19]
s_lshl_b32 s71, s73, 19
ds_read_b128 v[136:139], v24 offset:4096
v_lshlrev_b32 v76, 16, v33
v_mfma_f32_16x16x32_bf16 a[20:23], v[224:227], v[212:215], a[20:23]
s_add_u32 s71, s71, s66
ds_read_b128 v[140:143], v24 offset:6144
v_lshlrev_b32 v77, 16, v34
v_mfma_f32_16x16x32_bf16 a[24:27], v[224:227], v[216:219], a[24:27]
s_add_u32 m0, s63, 98304
ds_read_b128 v[144:147], v24 offset:8192
v_lshlrev_b32 v78, 16, v35
v_mfma_f32_16x16x32_bf16 a[28:31], v[224:227], v[220:223], a[28:31]
s_add_u32 s72, s69, 0
buffer_load_dwordx4 v2, s[8:11], s72 offen lds
v_mfma_f32_16x16x32_bf16 a[60:63], v[228:231], v[220:223], a[60:63]
s_add_u32 s72, s69, 7168
buffer_load_dwordx4 v3, s[8:11], s72 offen offset:1024 lds
v_mfma_f32_16x16x32_bf16 a[56:59], v[228:231], v[216:219], a[56:59]
s_add_u32 s72, s69, 14336
buffer_load_dwordx4 v2, s[8:11], s72 offen offset:2048 lds
v_mfma_f32_16x16x32_bf16 a[52:55], v[228:231], v[212:215], a[52:55]
ds_read_b128 v[148:151], v24 offset:10240
v_lshlrev_b32 v79, 16, v36
v_mfma_f32_16x16x32_bf16 a[48:51], v[228:231], v[208:211], a[48:51]
ds_read_b128 v[152:155], v24 offset:12288
v_lshlrev_b32 v80, 16, v37
v_mfma_f32_16x16x32_bf16 a[44:47], v[228:231], v[204:207], a[44:47]
s_add_u32 s72, s69, 21504
buffer_load_dwordx4 v3, s[8:11], s72 offen offset:3072 lds
v_mfma_f32_16x16x32_bf16 a[40:43], v[228:231], v[200:203], a[40:43]
ds_read_b128 v[156:159], v24 offset:14336
v_lshlrev_b32 v81, 16, v38
v_mfma_f32_16x16x32_bf16 a[36:39], v[228:231], v[196:199], a[36:39]
ds_read_b64_tr_b16 v[164:165], v21 offset:0
v_lshlrev_b32 v82, 16, v39
v_mfma_f32_16x16x32_bf16 a[32:35], v[228:231], v[192:195], a[32:35]
ds_read_b64_tr_b16 v[166:167], v21 offset:1024
v_lshlrev_b32 v83, 16, v40
v_mfma_f32_16x16x32_bf16 a[64:67], v[232:235], v[192:195], a[64:67]
ds_read_b64_tr_b16 v[168:169], v22 offset:0
v_lshlrev_b32 v84, 16, v41
v_mfma_f32_16x16x32_bf16 a[68:71], v[232:235], v[196:199], a[68:71]
s_add_u32 m0, s64, 32768
ds_read_b64_tr_b16 v[170:171], v22 offset:1024
v_lshlrev_b32 v85, 16, v42
v_mfma_f32_16x16x32_bf16 a[72:75], v[232:235], v[200:203], a[72:75]
s_add_u32 s72, s71, 0
buffer_load_dwordx4 v6, s[16:19], s72 offen lds
v_mfma_f32_16x16x32_bf16 a[76:79], v[232:235], v[204:207], a[76:79]
ds_read_b64_tr_b16 v[172:173], v23 offset:0
v_lshlrev_b32 v86, 16, v43
v_mfma_f32_16x16x32_bf16 a[80:83], v[232:235], v[208:211], a[80:83]
ds_read_b64_tr_b16 v[174:175], v23 offset:1024
v_lshlrev_b32 v87, 16, v44
v_mfma_f32_16x16x32_bf16 a[84:87], v[232:235], v[212:215], a[84:87]
s_add_u32 s72, s71, 31744
buffer_load_dwordx4 v6, s[16:19], s72 offen offset:1024 lds
v_mfma_f32_16x16x32_bf16 a[88:91], v[232:235], v[216:219], a[88:91]
ds_read_b64_tr_b16 v[176:177], v20 offset:16384
v_lshlrev_b32 v88, 16, v45
v_mfma_f32_16x16x32_bf16 a[92:95], v[232:235], v[220:223], a[92:95]
ds_read_b64_tr_b16 v[178:179], v20 offset:17408
v_lshlrev_b32 v89, 16, v46
v_mfma_f32_16x16x32_bf16 a[124:127], v[236:239], v[220:223], a[124:127]
ds_read_b64_tr_b16 v[180:181], v21 offset:16384
v_lshlrev_b32 v90, 16, v47
v_mfma_f32_16x16x32_bf16 a[120:123], v[236:239], v[216:219], a[120:123]
s_add_u32 s72, s71, 63488
buffer_load_dwordx4 v7, s[16:19], s72 offen offset:2048 lds
v_mfma_f32_16x16x32_bf16 a[116:119], v[236:239], v[212:215], a[116:119]
ds_read_b64_tr_b16 v[182:183], v21 offset:17408
v_lshlrev_b32 v91, 16, v48
v_mfma_f32_16x16x32_bf16 a[112:115], v[236:239], v[208:211], a[112:115]
ds_read_b64_tr_b16 v[184:185], v22 offset:16384
v_lshlrev_b32 v92, 16, v49
v_mfma_f32_16x16x32_bf16 a[108:111], v[236:239], v[204:207], a[108:111]
ds_read_b64_tr_b16 v[186:187], v22 offset:17408
v_lshlrev_b32 v93, 16, v50
v_mfma_f32_16x16x32_bf16 a[104:107], v[236:239], v[200:203], a[104:107]
ds_read_b64_tr_b16 v[188:189], v23 offset:16384
v_lshlrev_b32 v94, 16, v51
v_mfma_f32_16x16x32_bf16 a[100:103], v[236:239], v[196:199], a[100:103]
s_add_u32 s72, s71, 95232
buffer_load_dwordx4 v7, s[16:19], s72 offen offset:3072 lds
v_mfma_f32_16x16x32_bf16 a[96:99], v[236:239], v[192:195], a[96:99]
ds_read_b64_tr_b16 v[190:191], v23 offset:17408
v_mul_f32 v95, v75, v91
v_mfma_f32_16x16x32_bf16 a[128:131], v[192:195], v[240:243], a[128:131]
v_lshlrev_b32 v97, 16, v67
v_fmac_f32 v95, v74, v92
v_mfma_f32_16x16x32_bf16 a[132:135], v[196:199], v[240:243], a[132:135]
v_fmac_f32 v95, v73, v93
v_fmac_f32 v95, v72, v94
v_mfma_f32_16x16x32_bf16 a[136:139], v[200:203], v[240:243], a[136:139]
s_add_u32 m0, s63, 102400
v_mul_f32 v95, v95, v97
v_mul_f32 v96, v75, v90
v_mfma_f32_16x16x32_bf16 a[140:143], v[204:207], v[240:243], a[140:143]
s_add_u32 s72, s69, 32768
buffer_load_dwordx4 v2, s[8:11], s72 offen lds
v_mfma_f32_16x16x32_bf16 a[144:147], v[208:211], v[240:243], a[144:147]
v_lshlrev_b32 v97, 16, v66
v_fmac_f32 v96, v74, v91
v_mfma_f32_16x16x32_bf16 a[148:151], v[212:215], v[240:243], a[148:151]
v_fmac_f32 v96, v73, v92
v_fmac_f32 v96, v72, v93
v_mfma_f32_16x16x32_bf16 a[152:155], v[216:219], v[240:243], a[152:155]
s_add_u32 s72, s69, 39936
buffer_load_dwordx4 v3, s[8:11], s72 offen offset:1024 lds
v_mfma_f32_16x16x32_bf16 a[156:159], v[220:223], v[240:243], a[156:159]
v_mul_f32 v96, v96, v97
v_cvt_pk_bf16_f32 v100, v95, v96
v_mfma_f32_16x16x32_bf16 a[188:191], v[220:223], v[244:247], a[188:191]
v_mul_f32 v95, v75, v89
v_lshlrev_b32 v97, 16, v65
v_mfma_f32_16x16x32_bf16 a[184:187], v[216:219], v[244:247], a[184:187]
v_fmac_f32 v95, v74, v90
v_fmac_f32 v95, v73, v91
v_mfma_f32_16x16x32_bf16 a[180:183], v[212:215], v[244:247], a[180:183]
v_fmac_f32 v95, v72, v92
v_mul_f32 v95, v95, v97
v_mfma_f32_16x16x32_bf16 a[176:179], v[208:211], v[244:247], a[176:179]
s_add_u32 s72, s69, 47104
buffer_load_dwordx4 v2, s[8:11], s72 offen offset:2048 lds
v_mfma_f32_16x16x32_bf16 a[172:175], v[204:207], v[244:247], a[172:175]
v_mul_f32 v96, v75, v88
v_lshlrev_b32 v97, 16, v64
v_mfma_f32_16x16x32_bf16 a[168:171], v[200:203], v[244:247], a[168:171]
v_fmac_f32 v96, v74, v89
v_fmac_f32 v96, v73, v90
v_mfma_f32_16x16x32_bf16 a[164:167], v[196:199], v[244:247], a[164:167]
v_fmac_f32 v96, v72, v91
v_mul_f32 v96, v96, v97
v_mfma_f32_16x16x32_bf16 a[160:163], v[192:195], v[244:247], a[160:163]
s_add_u32 s72, s69, 54272
buffer_load_dwordx4 v3, s[8:11], s72 offen offset:3072 lds
v_mfma_f32_16x16x32_bf16 a[192:195], v[192:195], v[248:251], a[192:195]
v_cvt_pk_bf16_f32 v101, v95, v96
v_mul_f32 v95, v75, v87
v_mfma_f32_16x16x32_bf16 a[196:199], v[196:199], v[248:251], a[196:199]
v_lshlrev_b32 v97, 16, v63
v_fmac_f32 v95, v74, v88
v_mfma_f32_16x16x32_bf16 a[200:203], v[200:203], v[248:251], a[200:203]
v_fmac_f32 v95, v73, v89
v_fmac_f32 v95, v72, v90
v_mfma_f32_16x16x32_bf16 a[204:207], v[204:207], v[248:251], a[204:207]
s_add_u32 m0, s64, 49152
v_mul_f32 v95, v95, v97
v_mul_f32 v96, v75, v86
v_mfma_f32_16x16x32_bf16 a[208:211], v[208:211], v[248:251], a[208:211]
s_add_u32 s72, s71, 0
buffer_load_dwordx4 v6, s[20:23], s72 offen lds
v_mfma_f32_16x16x32_bf16 a[212:215], v[212:215], v[248:251], a[212:215]
v_lshlrev_b32 v97, 16, v62
v_fmac_f32 v96, v74, v87
v_mfma_f32_16x16x32_bf16 a[216:219], v[216:219], v[248:251], a[216:219]
v_fmac_f32 v96, v73, v88
v_fmac_f32 v96, v72, v89
v_mfma_f32_16x16x32_bf16 a[220:223], v[220:223], v[248:251], a[220:223]
v_mul_f32 v96, v96, v97
v_cvt_pk_bf16_f32 v102, v95, v96
v_mfma_f32_16x16x32_bf16 a[252:255], v[220:223], v[252:255], a[252:255]
s_add_u32 s72, s71, 31744
buffer_load_dwordx4 v6, s[20:23], s72 offen offset:1024 lds
v_mfma_f32_16x16x32_bf16 a[248:251], v[216:219], v[252:255], a[248:251]
v_mul_f32 v95, v75, v85
v_lshlrev_b32 v97, 16, v61
v_mfma_f32_16x16x32_bf16 a[244:247], v[212:215], v[252:255], a[244:247]
v_fmac_f32 v95, v74, v86
v_fmac_f32 v95, v73, v87
v_mfma_f32_16x16x32_bf16 a[240:243], v[208:211], v[252:255], a[240:243]
v_fmac_f32 v95, v72, v88
v_mul_f32 v95, v95, v97
v_mfma_f32_16x16x32_bf16 a[236:239], v[204:207], v[252:255], a[236:239]
s_add_u32 s72, s71, 63488
buffer_load_dwordx4 v7, s[20:23], s72 offen offset:2048 lds
v_mfma_f32_16x16x32_bf16 a[232:235], v[200:203], v[252:255], a[232:235]
v_mul_f32 v96, v75, v84
v_lshlrev_b32 v97, 16, v60
v_mfma_f32_16x16x32_bf16 a[228:231], v[196:199], v[252:255], a[228:231]
v_fmac_f32 v96, v74, v85
v_fmac_f32 v96, v73, v86
v_mfma_f32_16x16x32_bf16 a[224:227], v[192:195], v[252:255], a[224:227]
s_waitcnt lgkmcnt(0)
v_fmac_f32 v96, v72, v87
v_mul_f32 v96, v96, v97
v_mfma_f32_16x16x32_bf16 a[0:3], v[160:163], v[128:131], a[0:3]
s_add_u32 s72, s71, 95232
buffer_load_dwordx4 v7, s[20:23], s72 offen offset:3072 lds
v_mfma_f32_16x16x32_bf16 a[4:7], v[160:163], v[132:135], a[4:7]
s_mov_b32 s80, 0x0
buffer_load_dword v126, v125, s[12:15], s80 offen
v_mfma_f32_16x16x32_bf16 a[8:11], v[160:163], v[136:139], a[8:11]
s_mov_b32 s80, 0x100000
buffer_load_dword v126, v125, s[12:15], s80 offen
v_mfma_f32_16x16x32_bf16 a[12:15], v[160:163], v[140:143], a[12:15]
s_mov_b32 s80, 0x200000
buffer_load_dword v126, v125, s[12:15], s80 offen
v_mfma_f32_16x16x32_bf16 a[16:19], v[160:163], v[144:147], a[16:19]
s_mov_b32 s80, 0x300000
buffer_load_dword v126, v125, s[12:15], s80 offen
v_mfma_f32_16x16x32_bf16 a[20:23], v[160:163], v[148:151], a[20:23]
ds_read_b64_tr_b16 v[224:225], v20 offset:8192
v_cvt_pk_bf16_f32 v103, v95, v96
v_mfma_f32_16x16x32_bf16 a[24:27], v[160:163], v[152:155], a[24:27]
ds_write_b128 v28, v[100:103] offset:0
v_mul_f32 v95, v75, v83
v_mfma_f32_16x16x32_bf16 a[28:31], v[160:163], v[156:159], a[28:31]
ds_read_b64_tr_b16 v[226:227], v20 offset:9216
v_lshlrev_b32 v97, 16, v59
v_mfma_f32_16x16x32_bf16 a[60:63], v[164:167], v[156:159], a[60:63]
v_fmac_f32 v95, v74, v84
v_fmac_f32 v95, v73, v85
v_mfma_f32_16x16x32_bf16 a[56:59], v[164:167], v[152:155], a[56:59]
ds_read_b128 v[192:195], v25 offset:0
v_fmac_f32 v95, v72, v86
v_mfma_f32_16x16x32_bf16 a[52:55], v[164:167], v[148:151], a[52:55]
v_mul_f32 v95, v95, v97
v_mul_f32 v96, v75, v82
v_mfma_f32_16x16x32_bf16 a[48:51], v[164:167], v[144:147], a[48:51]
ds_read_b128 v[196:199], v25 offset:2048
v_lshlrev_b32 v97, 16, v58
v_mfma_f32_16x16x32_bf16 a[44:47], v[164:167], v[140:143], a[44:47]
v_fmac_f32 v96, v74, v83
v_fmac_f32 v96, v73, v84
v_mfma_f32_16x16x32_bf16 a[40:43], v[164:167], v[136:139], a[40:43]
ds_read_b128 v[200:203], v25 offset:4096
v_fmac_f32 v96, v72, v85
v_mfma_f32_16x16x32_bf16 a[36:39], v[164:167], v[132:135], a[36:39]
v_mul_f32 v96, v96, v97
v_cvt_pk_bf16_f32 v104, v95, v96
v_mfma_f32_16x16x32_bf16 a[32:35], v[164:167], v[128:131], a[32:35]
ds_read_b128 v[204:207], v25 offset:6144
v_mul_f32 v95, v75, v81
v_mfma_f32_16x16x32_bf16 a[64:67], v[168:171], v[128:131], a[64:67]
v_lshlrev_b32 v97, 16, v57
v_fmac_f32 v95, v74, v82
v_mfma_f32_16x16x32_bf16 a[68:71], v[168:171], v[132:135], a[68:71]
ds_read_b128 v[208:211], v25 offset:8192
v_fmac_f32 v95, v73, v83
v_mfma_f32_16x16x32_bf16 a[72:75], v[168:171], v[136:139], a[72:75]
v_fmac_f32 v95, v72, v84
v_mul_f32 v95, v95, v97
v_mfma_f32_16x16x32_bf16 a[76:79], v[168:171], v[140:143], a[76:79]
ds_read_b128 v[212:215], v25 offset:10240
v_mul_f32 v96, v75, v80
v_mfma_f32_16x16x32_bf16 a[80:83], v[168:171], v[144:147], a[80:83]
v_lshlrev_b32 v97, 16, v56
v_fmac_f32 v96, v74, v81
v_mfma_f32_16x16x32_bf16 a[84:87], v[168:171], v[148:151], a[84:87]
ds_read_b128 v[216:219], v25 offset:12288
v_fmac_f32 v96, v73, v82
v_mfma_f32_16x16x32_bf16 a[88:91], v[168:171], v[152:155], a[88:91]
v_fmac_f32 v96, v72, v83
v_mul_f32 v96, v96, v97
v_mfma_f32_16x16x32_bf16 a[92:95], v[168:171], v[156:159], a[92:95]
ds_read_b128 v[220:223], v25 offset:14336
v_cvt_pk_bf16_f32 v105, v95, v96
v_mfma_f32_16x16x32_bf16 a[124:127], v[172:175], v[156:159], a[124:127]
v_mul_f32 v95, v75, v79
v_lshlrev_b32 v97, 16, v55
v_mfma_f32_16x16x32_bf16 a[120:123], v[172:175], v[152:155], a[120:123]
ds_read_b64_tr_b16 v[228:229], v21 offset:8192
v_fmac_f32 v95, v74, v80
v_mfma_f32_16x16x32_bf16 a[116:119], v[172:175], v[148:151], a[116:119]
v_fmac_f32 v95, v73, v81
v_fmac_f32 v95, v72, v82
v_mfma_f32_16x16x32_bf16 a[112:115], v[172:175], v[144:147], a[112:115]
ds_read_b64_tr_b16 v[230:231], v21 offset:9216
v_mul_f32 v95, v95, v97
v_mfma_f32_16x16x32_bf16 a[108:111], v[172:175], v[140:143], a[108:111]
v_mul_f32 v96, v75, v78
v_lshlrev_b32 v97, 16, v54
v_mfma_f32_16x16x32_bf16 a[104:107], v[172:175], v[136:139], a[104:107]
ds_read_b64_tr_b16 v[232:233], v22 offset:8192
v_fmac_f32 v96, v74, v79
v_mfma_f32_16x16x32_bf16 a[100:103], v[172:175], v[132:135], a[100:103]
v_fmac_f32 v96, v73, v80
v_fmac_f32 v96, v72, v81
v_mfma_f32_16x16x32_bf16 a[96:99], v[172:175], v[128:131], a[96:99]
ds_read_b64_tr_b16 v[234:235], v22 offset:9216
v_mul_f32 v96, v96, v97
v_mfma_f32_16x16x32_bf16 a[128:131], v[128:131], v[176:179], a[128:131]
v_cvt_pk_bf16_f32 v106, v95, v96
v_mul_f32 v95, v75, v77
v_mfma_f32_16x16x32_bf16 a[132:135], v[132:135], v[176:179], a[132:135]
ds_read_b64_tr_b16 v[236:237], v23 offset:8192
v_lshlrev_b32 v97, 16, v53
v_mfma_f32_16x16x32_bf16 a[136:139], v[136:139], v[176:179], a[136:139]
v_fmac_f32 v95, v74, v78
v_fmac_f32 v95, v73, v79
v_mfma_f32_16x16x32_bf16 a[140:143], v[140:143], v[176:179], a[140:143]
ds_read_b64_tr_b16 v[238:239], v23 offset:9216
v_fmac_f32 v95, v72, v80
v_mfma_f32_16x16x32_bf16 a[144:147], v[144:147], v[176:179], a[144:147]
v_mul_f32 v95, v95, v97
v_mul_f32 v96, v75, v76
v_mfma_f32_16x16x32_bf16 a[148:151], v[148:151], v[176:179], a[148:151]
ds_read_b64_tr_b16 v[240:241], v20 offset:24576
v_lshlrev_b32 v97, 16, v52
v_mfma_f32_16x16x32_bf16 a[152:155], v[152:155], v[176:179], a[152:155]
v_fmac_f32 v96, v74, v77
v_fmac_f32 v96, v73, v78
v_mfma_f32_16x16x32_bf16 a[156:159], v[156:159], v[176:179], a[156:159]
ds_read_b64_tr_b16 v[242:243], v20 offset:25600
v_fmac_f32 v96, v72, v79
v_mfma_f32_16x16x32_bf16 a[188:191], v[156:159], v[180:183], a[188:191]
v_mul_f32 v96, v96, v97
v_cvt_pk_bf16_f32 v107, v95, v96
v_mfma_f32_16x16x32_bf16 a[184:187], v[152:155], v[180:183], a[184:187]
ds_read_b64_tr_b16 v[244:245], v21 offset:24576
ds_write_b128 v28, v[104:107] offset:16
v_mfma_f32_16x16x32_bf16 a[180:183], v[148:151], v[180:183], a[180:183]
global_load_dwordx4 v[84:87], v1, s[56:57]
v_mfma_f32_16x16x32_bf16 a[176:179], v[144:147], v[180:183], a[176:179]
ds_read_b64_tr_b16 v[246:247], v21 offset:25600
v_mfma_f32_16x16x32_bf16 a[172:175], v[140:143], v[180:183], a[172:175]
global_load_dwordx4 v[88:91], v1, s[56:57] offset:1024
v_mfma_f32_16x16x32_bf16 a[168:171], v[136:139], v[180:183], a[168:171]
ds_read_b64_tr_b16 v[248:249], v22 offset:24576
v_lshlrev_b32 v72, 16, v70
v_mfma_f32_16x16x32_bf16 a[164:167], v[132:135], v[180:183], a[164:167]
v_and_b32 v73, 0xffff0000, v70
v_lshlrev_b32 v74, 16, v71
v_mfma_f32_16x16x32_bf16 a[160:163], v[128:131], v[180:183], a[160:163]
ds_read_b64_tr_b16 v[250:251], v22 offset:25600
v_and_b32 v75, 0xffff0000, v71
v_mfma_f32_16x16x32_bf16 a[192:195], v[128:131], v[184:187], a[192:195]
v_and_b32 v33, 0xffff0000, v33
v_and_b32 v34, 0xffff0000, v34
v_mfma_f32_16x16x32_bf16 a[196:199], v[132:135], v[184:187], a[196:199]
ds_read_b64_tr_b16 v[252:253], v23 offset:24576
v_and_b32 v35, 0xffff0000, v35
v_mfma_f32_16x16x32_bf16 a[200:203], v[136:139], v[184:187], a[200:203]
v_and_b32 v36, 0xffff0000, v36
v_and_b32 v37, 0xffff0000, v37
v_mfma_f32_16x16x32_bf16 a[204:207], v[140:143], v[184:187], a[204:207]
ds_read_b64_tr_b16 v[254:255], v23 offset:25600
v_and_b32 v38, 0xffff0000, v38
v_mfma_f32_16x16x32_bf16 a[208:211], v[144:147], v[184:187], a[208:211]
v_and_b32 v39, 0xffff0000, v39
v_and_b32 v40, 0xffff0000, v40
v_mfma_f32_16x16x32_bf16 a[212:215], v[148:151], v[184:187], a[212:215]
v_and_b32 v41, 0xffff0000, v41
v_and_b32 v42, 0xffff0000, v42
v_mfma_f32_16x16x32_bf16 a[216:219], v[152:155], v[184:187], a[216:219]
v_and_b32 v43, 0xffff0000, v43
v_and_b32 v44, 0xffff0000, v44
v_mfma_f32_16x16x32_bf16 a[220:223], v[156:159], v[184:187], a[220:223]
v_and_b32 v45, 0xffff0000, v45
v_and_b32 v46, 0xffff0000, v46
v_mfma_f32_16x16x32_bf16 a[252:255], v[156:159], v[188:191], a[252:255]
v_and_b32 v47, 0xffff0000, v47
v_and_b32 v48, 0xffff0000, v48
v_mfma_f32_16x16x32_bf16 a[248:251], v[152:155], v[188:191], a[248:251]
v_and_b32 v49, 0xffff0000, v49
v_and_b32 v50, 0xffff0000, v50
v_mfma_f32_16x16x32_bf16 a[244:247], v[148:151], v[188:191], a[244:247]
v_and_b32 v51, 0xffff0000, v51
v_mul_f32 v95, v75, v48
v_mfma_f32_16x16x32_bf16 a[240:243], v[144:147], v[188:191], a[240:243]
v_and_b32 v97, 0xffff0000, v67
v_fmac_f32 v95, v74, v49
v_mfma_f32_16x16x32_bf16 a[236:239], v[140:143], v[188:191], a[236:239]
v_fmac_f32 v95, v73, v50
v_fmac_f32 v95, v72, v51
v_mfma_f32_16x16x32_bf16 a[232:235], v[136:139], v[188:191], a[232:235]
v_mul_f32 v95, v95, v97
v_mul_f32 v96, v75, v47
v_mfma_f32_16x16x32_bf16 a[228:231], v[132:135], v[188:191], a[228:231]
s_waitcnt vmcnt(6) lgkmcnt(0)
v_and_b32 v97, 0xffff0000, v66
v_fmac_f32 v96, v74, v48
v_mfma_f32_16x16x32_bf16 a[224:227], v[128:131], v[188:191], a[224:227]
s_barrier
v_fmac_f32 v96, v73, v49
v_fmac_f32 v96, v72, v50
v_mfma_f32_16x16x32_bf16 a[0:3], v[224:227], v[192:195], a[0:3]
s_and_b32 s73, s65, 1
ds_read_b64_tr_b16 v[160:161], v20 offset:32768
v_mul_f32 v96, v96, v97
v_mfma_f32_16x16x32_bf16 a[4:7], v[224:227], v[196:199], a[4:7]
s_xor_b32 s73, s73, 6
ds_read_b64_tr_b16 v[162:163], v20 offset:33792
v_cvt_pk_bf16_f32 v100, v95, v96
v_mfma_f32_16x16x32_bf16 a[8:11], v[224:227], v[200:203], a[8:11]
s_lshl_b32 s69, s73, 7
ds_read_b128 v[128:131], v24 offset:32768
v_mul_f32 v95, v75, v46
v_mfma_f32_16x16x32_bf16 a[12:15], v[224:227], v[204:207], a[12:15]
s_add_u32 s69, s69, s84
ds_read_b128 v[132:135], v24 offset:34816
v_and_b32 v97, 0xffff0000, v65
v_mfma_f32_16x16x32_bf16 a[16:19], v[224:227], v[208:211], a[16:19]
s_lshl_b32 s71, s73, 19
ds_read_b128 v[136:139], v24 offset:36864
v_fmac_f32 v95, v74, v47
v_mfma_f32_16x16x32_bf16 a[20:23], v[224:227], v[212:215], a[20:23]
s_add_u32 s71, s71, s66
ds_read_b128 v[140:143], v24 offset:38912
v_fmac_f32 v95, v73, v48
v_mfma_f32_16x16x32_bf16 a[24:27], v[224:227], v[216:219], a[24:27]
s_add_u32 m0, s63, 65536
ds_read_b128 v[144:147], v24 offset:40960
v_fmac_f32 v95, v72, v49
v_mfma_f32_16x16x32_bf16 a[28:31], v[224:227], v[220:223], a[28:31]
s_add_u32 s72, s69, 0
buffer_load_dwordx4 v2, s[8:11], s72 offen lds
v_mfma_f32_16x16x32_bf16 a[60:63], v[228:231], v[220:223], a[60:63]
s_add_u32 s72, s69, 7168
buffer_load_dwordx4 v3, s[8:11], s72 offen offset:1024 lds
v_mfma_f32_16x16x32_bf16 a[56:59], v[228:231], v[216:219], a[56:59]
s_add_u32 s72, s69, 14336
buffer_load_dwordx4 v2, s[8:11], s72 offen offset:2048 lds
v_mfma_f32_16x16x32_bf16 a[52:55], v[228:231], v[212:215], a[52:55]
ds_read_b128 v[148:151], v24 offset:43008
v_mul_f32 v95, v95, v97
v_mfma_f32_16x16x32_bf16 a[48:51], v[228:231], v[208:211], a[48:51]
ds_read_b128 v[152:155], v24 offset:45056
v_mul_f32 v96, v75, v45
v_mfma_f32_16x16x32_bf16 a[44:47], v[228:231], v[204:207], a[44:47]
s_add_u32 s72, s69, 21504
buffer_load_dwordx4 v3, s[8:11], s72 offen offset:3072 lds
v_mfma_f32_16x16x32_bf16 a[40:43], v[228:231], v[200:203], a[40:43]
ds_read_b128 v[156:159], v24 offset:47104
v_and_b32 v97, 0xffff0000, v64
v_mfma_f32_16x16x32_bf16 a[36:39], v[228:231], v[196:199], a[36:39]
ds_read_b64_tr_b16 v[164:165], v21 offset:32768
v_fmac_f32 v96, v74, v46
v_mfma_f32_16x16x32_bf16 a[32:35], v[228:231], v[192:195], a[32:35]
ds_read_b64_tr_b16 v[166:167], v21 offset:33792
v_fmac_f32 v96, v73, v47
v_mfma_f32_16x16x32_bf16 a[64:67], v[232:235], v[192:195], a[64:67]
ds_read_b64_tr_b16 v[168:169], v22 offset:32768
v_fmac_f32 v96, v72, v48
v_mfma_f32_16x16x32_bf16 a[68:71], v[232:235], v[196:199], a[68:71]
s_add_u32 m0, s64, 0
ds_read_b64_tr_b16 v[170:171], v22 offset:33792
v_mul_f32 v96, v96, v97
v_mfma_f32_16x16x32_bf16 a[72:75], v[232:235], v[200:203], a[72:75]
s_add_u32 s72, s71, 0
buffer_load_dwordx4 v6, s[16:19], s72 offen lds
v_mfma_f32_16x16x32_bf16 a[76:79], v[232:235], v[204:207], a[76:79]
ds_read_b64_tr_b16 v[172:173], v23 offset:32768
v_cvt_pk_bf16_f32 v101, v95, v96
v_mfma_f32_16x16x32_bf16 a[80:83], v[232:235], v[208:211], a[80:83]
ds_read_b64_tr_b16 v[174:175], v23 offset:33792
v_mul_f32 v95, v75, v44
v_mfma_f32_16x16x32_bf16 a[84:87], v[232:235], v[212:215], a[84:87]
s_add_u32 s72, s71, 31744
buffer_load_dwordx4 v6, s[16:19], s72 offen offset:1024 lds
v_mfma_f32_16x16x32_bf16 a[88:91], v[232:235], v[216:219], a[88:91]
ds_read_b64_tr_b16 v[176:177], v20 offset:49152
v_and_b32 v97, 0xffff0000, v63
v_mfma_f32_16x16x32_bf16 a[92:95], v[232:235], v[220:223], a[92:95]
ds_read_b64_tr_b16 v[178:179], v20 offset:50176
v_fmac_f32 v95, v74, v45
v_mfma_f32_16x16x32_bf16 a[124:127], v[236:239], v[220:223], a[124:127]
ds_read_b64_tr_b16 v[180:181], v21 offset:49152
v_fmac_f32 v95, v73, v46
v_mfma_f32_16x16x32_bf16 a[120:123], v[236:239], v[216:219], a[120:123]
s_add_u32 s72, s71, 63488
buffer_load_dwordx4 v7, s[16:19], s72 offen offset:2048 lds
v_mfma_f32_16x16x32_bf16 a[116:119], v[236:239], v[212:215], a[116:119]
ds_read_b64_tr_b16 v[182:183], v21 offset:50176
v_fmac_f32 v95, v72, v47
v_mfma_f32_16x16x32_bf16 a[112:115], v[236:239], v[208:211], a[112:115]
ds_read_b64_tr_b16 v[184:185], v22 offset:49152
v_mul_f32 v95, v95, v97
v_mfma_f32_16x16x32_bf16 a[108:111], v[236:239], v[204:207], a[108:111]
ds_read_b64_tr_b16 v[186:187], v22 offset:50176
v_mul_f32 v96, v75, v43
v_mfma_f32_16x16x32_bf16 a[104:107], v[236:239], v[200:203], a[104:107]
ds_read_b64_tr_b16 v[188:189], v23 offset:49152
v_and_b32 v97, 0xffff0000, v62
v_mfma_f32_16x16x32_bf16 a[100:103], v[236:239], v[196:199], a[100:103]
s_add_u32 s72, s71, 95232
buffer_load_dwordx4 v7, s[16:19], s72 offen offset:3072 lds
v_mfma_f32_16x16x32_bf16 a[96:99], v[236:239], v[192:195], a[96:99]
ds_read_b64_tr_b16 v[190:191], v23 offset:50176
v_fmac_f32 v96, v74, v44
v_mfma_f32_16x16x32_bf16 a[128:131], v[192:195], v[240:243], a[128:131]
v_fmac_f32 v96, v73, v45
v_fmac_f32 v96, v72, v46
v_mfma_f32_16x16x32_bf16 a[132:135], v[196:199], v[240:243], a[132:135]
v_mul_f32 v96, v96, v97
v_cvt_pk_bf16_f32 v102, v95, v96
v_mfma_f32_16x16x32_bf16 a[136:139], v[200:203], v[240:243], a[136:139]
s_add_u32 m0, s63, 69632
v_mul_f32 v95, v75, v42
v_and_b32 v97, 0xffff0000, v61
v_mfma_f32_16x16x32_bf16 a[140:143], v[204:207], v[240:243], a[140:143]
s_add_u32 s72, s69, 32768
buffer_load_dwordx4 v2, s[8:11], s72 offen lds
v_mfma_f32_16x16x32_bf16 a[144:147], v[208:211], v[240:243], a[144:147]
v_fmac_f32 v95, v74, v43
v_fmac_f32 v95, v73, v44
v_mfma_f32_16x16x32_bf16 a[148:151], v[212:215], v[240:243], a[148:151]
v_fmac_f32 v95, v72, v45
v_mul_f32 v95, v95, v97
v_mfma_f32_16x16x32_bf16 a[152:155], v[216:219], v[240:243], a[152:155]
s_add_u32 s72, s69, 39936
buffer_load_dwordx4 v3, s[8:11], s72 offen offset:1024 lds
v_mfma_f32_16x16x32_bf16 a[156:159], v[220:223], v[240:243], a[156:159]
v_mul_f32 v96, v75, v41
v_and_b32 v97, 0xffff0000, v60
v_mfma_f32_16x16x32_bf16 a[188:191], v[220:223], v[244:247], a[188:191]
v_fmac_f32 v96, v74, v42
v_fmac_f32 v96, v73, v43
v_mfma_f32_16x16x32_bf16 a[184:187], v[216:219], v[244:247], a[184:187]
v_fmac_f32 v96, v72, v44
v_mul_f32 v96, v96, v97
v_mfma_f32_16x16x32_bf16 a[180:183], v[212:215], v[244:247], a[180:183]
v_cvt_pk_bf16_f32 v103, v95, v96
v_mfma_f32_16x16x32_bf16 a[176:179], v[208:211], v[244:247], a[176:179]
s_add_u32 s72, s69, 47104
buffer_load_dwordx4 v2, s[8:11], s72 offen offset:2048 lds
v_mfma_f32_16x16x32_bf16 a[172:175], v[204:207], v[244:247], a[172:175]
ds_write_b128 v28, v[100:103] offset:272
v_mul_f32 v95, v75, v40
v_mfma_f32_16x16x32_bf16 a[168:171], v[200:203], v[244:247], a[168:171]
v_and_b32 v97, 0xffff0000, v59
v_fmac_f32 v95, v74, v41
v_mfma_f32_16x16x32_bf16 a[164:167], v[196:199], v[244:247], a[164:167]
v_fmac_f32 v95, v73, v42
v_fmac_f32 v95, v72, v43
v_mfma_f32_16x16x32_bf16 a[160:163], v[192:195], v[244:247], a[160:163]
s_add_u32 s72, s69, 54272
buffer_load_dwordx4 v3, s[8:11], s72 offen offset:3072 lds
v_mfma_f32_16x16x32_bf16 a[192:195], v[192:195], v[248:251], a[192:195]
v_mul_f32 v95, v95, v97
v_mul_f32 v96, v75, v39
v_mfma_f32_16x16x32_bf16 a[196:199], v[196:199], v[248:251], a[196:199]
v_and_b32 v97, 0xffff0000, v58
v_fmac_f32 v96, v74, v40
v_mfma_f32_16x16x32_bf16 a[200:203], v[200:203], v[248:251], a[200:203]
v_fmac_f32 v96, v73, v41
v_fmac_f32 v96, v72, v42
v_mfma_f32_16x16x32_bf16 a[204:207], v[204:207], v[248:251], a[204:207]
s_add_u32 m0, s64, 16384
v_mul_f32 v96, v96, v97
v_cvt_pk_bf16_f32 v104, v95, v96
v_mfma_f32_16x16x32_bf16 a[208:211], v[208:211], v[248:251], a[208:211]
s_add_u32 s72, s71, 0
buffer_load_dwordx4 v6, s[20:23], s72 offen lds
v_mfma_f32_16x16x32_bf16 a[212:215], v[212:215], v[248:251], a[212:215]
v_mul_f32 v95, v75, v38
v_and_b32 v97, 0xffff0000, v57
v_mfma_f32_16x16x32_bf16 a[216:219], v[216:219], v[248:251], a[216:219]
v_fmac_f32 v95, v74, v39
v_fmac_f32 v95, v73, v40
v_mfma_f32_16x16x32_bf16 a[220:223], v[220:223], v[248:251], a[220:223]
v_fmac_f32 v95, v72, v41
v_mul_f32 v95, v95, v97
v_mfma_f32_16x16x32_bf16 a[252:255], v[220:223], v[252:255], a[252:255]
s_add_u32 s72, s71, 31744
buffer_load_dwordx4 v6, s[20:23], s72 offen offset:1024 lds
v_mfma_f32_16x16x32_bf16 a[248:251], v[216:219], v[252:255], a[248:251]
v_mul_f32 v96, v75, v37
v_and_b32 v97, 0xffff0000, v56
v_mfma_f32_16x16x32_bf16 a[244:247], v[212:215], v[252:255], a[244:247]
v_fmac_f32 v96, v74, v38
v_fmac_f32 v96, v73, v39
v_mfma_f32_16x16x32_bf16 a[240:243], v[208:211], v[252:255], a[240:243]
v_fmac_f32 v96, v72, v40
v_mul_f32 v96, v96, v97
v_mfma_f32_16x16x32_bf16 a[236:239], v[204:207], v[252:255], a[236:239]
s_add_u32 s72, s71, 63488
buffer_load_dwordx4 v7, s[20:23], s72 offen offset:2048 lds
v_mfma_f32_16x16x32_bf16 a[232:235], v[200:203], v[252:255], a[232:235]
v_cvt_pk_bf16_f32 v105, v95, v96
v_mul_f32 v95, v75, v36
v_mfma_f32_16x16x32_bf16 a[228:231], v[196:199], v[252:255], a[228:231]
v_and_b32 v97, 0xffff0000, v55
v_fmac_f32 v95, v74, v37
v_mfma_f32_16x16x32_bf16 a[224:227], v[192:195], v[252:255], a[224:227]
s_waitcnt lgkmcnt(0)
v_fmac_f32 v95, v73, v38
v_fmac_f32 v95, v72, v39
v_mfma_f32_16x16x32_bf16 a[0:3], v[160:163], v[128:131], a[0:3]
s_add_u32 s72, s71, 95232
buffer_load_dwordx4 v7, s[20:23], s72 offen offset:3072 lds
v_mfma_f32_16x16x32_bf16 a[4:7], v[160:163], v[132:135], a[4:7]
s_mov_b32 s80, 0x400000
buffer_load_dword v126, v125, s[12:15], s80 offen
v_mfma_f32_16x16x32_bf16 a[8:11], v[160:163], v[136:139], a[8:11]
s_mov_b32 s80, 0x500000
buffer_load_dword v126, v125, s[12:15], s80 offen
v_mfma_f32_16x16x32_bf16 a[12:15], v[160:163], v[140:143], a[12:15]
s_mov_b32 s80, 0x600000
buffer_load_dword v126, v125, s[12:15], s80 offen
v_mfma_f32_16x16x32_bf16 a[16:19], v[160:163], v[144:147], a[16:19]
s_mov_b32 s80, 0x700000
buffer_load_dword v126, v125, s[12:15], s80 offen
v_mfma_f32_16x16x32_bf16 a[20:23], v[160:163], v[148:151], a[20:23]
ds_read_b64_tr_b16 v[224:225], v20 offset:40960
v_mul_f32 v95, v95, v97
v_mfma_f32_16x16x32_bf16 a[24:27], v[160:163], v[152:155], a[24:27]
v_mul_f32 v96, v75, v35
v_and_b32 v97, 0xffff0000, v54
v_mfma_f32_16x16x32_bf16 a[28:31], v[160:163], v[156:159], a[28:31]
ds_read_b64_tr_b16 v[226:227], v20 offset:41984
v_fmac_f32 v96, v74, v36
v_mfma_f32_16x16x32_bf16 a[60:63], v[164:167], v[156:159], a[60:63]
v_fmac_f32 v96, v73, v37
v_fmac_f32 v96, v72, v38
v_mfma_f32_16x16x32_bf16 a[56:59], v[164:167], v[152:155], a[56:59]
ds_read_b128 v[192:195], v25 offset:32768
v_mul_f32 v96, v96, v97
v_mfma_f32_16x16x32_bf16 a[52:55], v[164:167], v[148:151], a[52:55]
v_cvt_pk_bf16_f32 v106, v95, v96
v_mul_f32 v95, v75, v34
v_mfma_f32_16x16x32_bf16 a[48:51], v[164:167], v[144:147], a[48:51]
ds_read_b128 v[196:199], v25 offset:34816
v_and_b32 v97, 0xffff0000, v53
v_mfma_f32_16x16x32_bf16 a[44:47], v[164:167], v[140:143], a[44:47]
v_fmac_f32 v95, v74, v35
v_fmac_f32 v95, v73, v36
v_mfma_f32_16x16x32_bf16 a[40:43], v[164:167], v[136:139], a[40:43]
ds_read_b128 v[200:203], v25 offset:36864
v_fmac_f32 v95, v72, v37
v_mfma_f32_16x16x32_bf16 a[36:39], v[164:167], v[132:135], a[36:39]
v_mul_f32 v95, v95, v97
v_mul_f32 v96, v75, v33
v_mfma_f32_16x16x32_bf16 a[32:35], v[164:167], v[128:131], a[32:35]
ds_read_b128 v[204:207], v25 offset:38912
v_and_b32 v97, 0xffff0000, v52
v_mfma_f32_16x16x32_bf16 a[64:67], v[168:171], v[128:131], a[64:67]
v_fmac_f32 v96, v74, v34
v_fmac_f32 v96, v73, v35
v_mfma_f32_16x16x32_bf16 a[68:71], v[168:171], v[132:135], a[68:71]
ds_read_b128 v[208:211], v25 offset:40960
v_fmac_f32 v96, v72, v36
v_mfma_f32_16x16x32_bf16 a[72:75], v[168:171], v[136:139], a[72:75]
v_mul_f32 v96, v96, v97
v_cvt_pk_bf16_f32 v107, v95, v96
v_mfma_f32_16x16x32_bf16 a[76:79], v[168:171], v[140:143], a[76:79]
ds_read_b128 v[212:215], v25 offset:43008
ds_write_b128 v28, v[104:107] offset:288
v_mfma_f32_16x16x32_bf16 a[80:83], v[168:171], v[144:147], a[80:83]
v_mfma_f32_16x16x32_bf16 a[84:87], v[168:171], v[148:151], a[84:87]
ds_read_b128 v[216:219], v25 offset:45056
v_mfma_f32_16x16x32_bf16 a[88:91], v[168:171], v[152:155], a[88:91]
v_mfma_f32_16x16x32_bf16 a[92:95], v[168:171], v[156:159], a[92:95]
ds_read_b128 v[220:223], v25 offset:47104
v_mfma_f32_16x16x32_bf16 a[124:127], v[172:175], v[156:159], a[124:127]
v_mfma_f32_16x16x32_bf16 a[120:123], v[172:175], v[152:155], a[120:123]
ds_read_b64_tr_b16 v[228:229], v21 offset:40960
v_mfma_f32_16x16x32_bf16 a[116:119], v[172:175], v[148:151], a[116:119]
v_mfma_f32_16x16x32_bf16 a[112:115], v[172:175], v[144:147], a[112:115]
ds_read_b64_tr_b16 v[230:231], v21 offset:41984
v_mfma_f32_16x16x32_bf16 a[108:111], v[172:175], v[140:143], a[108:111]
v_mfma_f32_16x16x32_bf16 a[104:107], v[172:175], v[136:139], a[104:107]
ds_read_b64_tr_b16 v[232:233], v22 offset:40960
v_mfma_f32_16x16x32_bf16 a[100:103], v[172:175], v[132:135], a[100:103]
v_mfma_f32_16x16x32_bf16 a[96:99], v[172:175], v[128:131], a[96:99]
ds_read_b64_tr_b16 v[234:235], v22 offset:41984
v_mfma_f32_16x16x32_bf16 a[128:131], v[128:131], v[176:179], a[128:131]
v_mfma_f32_16x16x32_bf16 a[132:135], v[132:135], v[176:179], a[132:135]
ds_read_b64_tr_b16 v[236:237], v23 offset:40960
v_mfma_f32_16x16x32_bf16 a[136:139], v[136:139], v[176:179], a[136:139]
v_mfma_f32_16x16x32_bf16 a[140:143], v[140:143], v[176:179], a[140:143]
ds_read_b64_tr_b16 v[238:239], v23 offset:41984
v_mfma_f32_16x16x32_bf16 a[144:147], v[144:147], v[176:179], a[144:147]
v_mfma_f32_16x16x32_bf16 a[148:151], v[148:151], v[176:179], a[148:151]
ds_read_b64_tr_b16 v[240:241], v20 offset:57344
v_mfma_f32_16x16x32_bf16 a[152:155], v[152:155], v[176:179], a[152:155]
v_mfma_f32_16x16x32_bf16 a[156:159], v[156:159], v[176:179], a[156:159]
ds_read_b64_tr_b16 v[242:243], v20 offset:58368
v_mfma_f32_16x16x32_bf16 a[188:191], v[156:159], v[180:183], a[188:191]
v_mfma_f32_16x16x32_bf16 a[184:187], v[152:155], v[180:183], a[184:187]
ds_read_b64_tr_b16 v[244:245], v21 offset:57344
v_mfma_f32_16x16x32_bf16 a[180:183], v[148:151], v[180:183], a[180:183]
v_mfma_f32_16x16x32_bf16 a[176:179], v[144:147], v[180:183], a[176:179]
ds_read_b64_tr_b16 v[246:247], v21 offset:58368
v_mfma_f32_16x16x32_bf16 a[172:175], v[140:143], v[180:183], a[172:175]
v_mfma_f32_16x16x32_bf16 a[168:171], v[136:139], v[180:183], a[168:171]
ds_read_b64_tr_b16 v[248:249], v22 offset:57344
v_mfma_f32_16x16x32_bf16 a[164:167], v[132:135], v[180:183], a[164:167]
v_mfma_f32_16x16x32_bf16 a[160:163], v[128:131], v[180:183], a[160:163]
ds_read_b64_tr_b16 v[250:251], v22 offset:58368
v_mfma_f32_16x16x32_bf16 a[192:195], v[128:131], v[184:187], a[192:195]
v_mfma_f32_16x16x32_bf16 a[196:199], v[132:135], v[184:187], a[196:199]
ds_read_b64_tr_b16 v[252:253], v23 offset:57344
v_mfma_f32_16x16x32_bf16 a[200:203], v[136:139], v[184:187], a[200:203]
v_mfma_f32_16x16x32_bf16 a[204:207], v[140:143], v[184:187], a[204:207]
ds_read_b64_tr_b16 v[254:255], v23 offset:58368
v_mfma_f32_16x16x32_bf16 a[208:211], v[144:147], v[184:187], a[208:211]
v_mfma_f32_16x16x32_bf16 a[212:215], v[148:151], v[184:187], a[212:215]
v_mfma_f32_16x16x32_bf16 a[216:219], v[152:155], v[184:187], a[216:219]
v_mfma_f32_16x16x32_bf16 a[220:223], v[156:159], v[184:187], a[220:223]
v_mfma_f32_16x16x32_bf16 a[252:255], v[156:159], v[188:191], a[252:255]
v_mfma_f32_16x16x32_bf16 a[248:251], v[152:155], v[188:191], a[248:251]
v_mfma_f32_16x16x32_bf16 a[244:247], v[148:151], v[188:191], a[244:247]
v_mfma_f32_16x16x32_bf16 a[240:243], v[144:147], v[188:191], a[240:243]
v_mfma_f32_16x16x32_bf16 a[236:239], v[140:143], v[188:191], a[236:239]
v_mfma_f32_16x16x32_bf16 a[232:235], v[136:139], v[188:191], a[232:235]
v_mfma_f32_16x16x32_bf16 a[228:231], v[132:135], v[188:191], a[228:231]
s_waitcnt vmcnt(4) lgkmcnt(0)
v_mfma_f32_16x16x32_bf16 a[224:227], v[128:131], v[188:191], a[224:227]
s_barrier
v_mfma_f32_16x16x32_bf16 a[0:3], v[224:227], v[192:195], a[0:3]
s_and_b32 s73, s65, 1
ds_read_b64_tr_b16 v[160:161], v20 offset:0
v_mfma_f32_16x16x32_bf16 a[4:7], v[224:227], v[196:199], a[4:7]
s_xor_b32 s73, s73, 7
ds_read_b64_tr_b16 v[162:163], v20 offset:1024
v_mfma_f32_16x16x32_bf16 a[8:11], v[224:227], v[200:203], a[8:11]
s_lshl_b32 s69, s73, 7
ds_read_b128 v[128:131], v24 offset:0
v_mfma_f32_16x16x32_bf16 a[12:15], v[224:227], v[204:207], a[12:15]
s_add_u32 s69, s69, s84
ds_read_b128 v[132:135], v24 offset:2048
v_mfma_f32_16x16x32_bf16 a[16:19], v[224:227], v[208:211], a[16:19]
s_lshl_b32 s71, s73, 19
ds_read_b128 v[136:139], v24 offset:4096
v_mfma_f32_16x16x32_bf16 a[20:23], v[224:227], v[212:215], a[20:23]
s_add_u32 s71, s71, s66
ds_read_b128 v[140:143], v24 offset:6144
v_mfma_f32_16x16x32_bf16 a[24:27], v[224:227], v[216:219], a[24:27]
s_add_u32 m0, s63, 98304
ds_read_b128 v[144:147], v24 offset:8192
v_mfma_f32_16x16x32_bf16 a[28:31], v[224:227], v[220:223], a[28:31]
s_add_u32 s72, s69, 0
buffer_load_dwordx4 v2, s[8:11], s72 offen lds
v_mfma_f32_16x16x32_bf16 a[60:63], v[228:231], v[220:223], a[60:63]
s_add_u32 s72, s69, 7168
buffer_load_dwordx4 v3, s[8:11], s72 offen offset:1024 lds
v_mfma_f32_16x16x32_bf16 a[56:59], v[228:231], v[216:219], a[56:59]
s_add_u32 s72, s69, 14336
buffer_load_dwordx4 v2, s[8:11], s72 offen offset:2048 lds
v_mfma_f32_16x16x32_bf16 a[52:55], v[228:231], v[212:215], a[52:55]
s_mul_i32 s74, s58, 4352
ds_read_b128 v[148:151], v24 offset:10240
v_mfma_f32_16x16x32_bf16 a[48:51], v[228:231], v[208:211], a[48:51]
s_add_u32 s74, s74, 131072
ds_read_b128 v[152:155], v24 offset:12288
v_lshrrev_b32 v26, 4, v0
v_mfma_f32_16x16x32_bf16 a[44:47], v[228:231], v[204:207], a[44:47]
s_add_u32 s72, s69, 21504
buffer_load_dwordx4 v3, s[8:11], s72 offen offset:3072 lds
v_mfma_f32_16x16x32_bf16 a[40:43], v[228:231], v[200:203], a[40:43]
ds_read_b128 v[156:159], v24 offset:14336
v_and_b32 v27, 15, v0
v_mfma_f32_16x16x32_bf16 a[36:39], v[228:231], v[196:199], a[36:39]
ds_read_b64_tr_b16 v[164:165], v21 offset:0
v_lshlrev_b32 v27, 4, v27
v_mfma_f32_16x16x32_bf16 a[32:35], v[228:231], v[192:195], a[32:35]
ds_read_b64_tr_b16 v[166:167], v21 offset:1024
v_mul_u32_u24 v28, 272, v26
v_mfma_f32_16x16x32_bf16 a[64:67], v[232:235], v[192:195], a[64:67]
ds_read_b64_tr_b16 v[168:169], v22 offset:0
v_add3_u32 v28, v28, v27, s74
v_mfma_f32_16x16x32_bf16 a[68:71], v[232:235], v[196:199], a[68:71]
s_add_u32 m0, s64, 32768
ds_read_b64_tr_b16 v[170:171], v22 offset:1024
v_lshl_add_u32 v26, v26, 12, v27
v_mfma_f32_16x16x32_bf16 a[72:75], v[232:235], v[200:203], a[72:75]
s_add_u32 s72, s71, 0
buffer_load_dwordx4 v6, s[16:19], s72 offen lds
v_mfma_f32_16x16x32_bf16 a[76:79], v[232:235], v[204:207], a[76:79]
ds_read_b64_tr_b16 v[172:173], v23 offset:0
ds_read_b128 v[36:39], v28 offset:0
v_mfma_f32_16x16x32_bf16 a[80:83], v[232:235], v[208:211], a[80:83]
ds_read_b64_tr_b16 v[174:175], v23 offset:1024
ds_read_b128 v[40:43], v28 offset:1088
v_mfma_f32_16x16x32_bf16 a[84:87], v[232:235], v[212:215], a[84:87]
s_add_u32 s72, s71, 31744
buffer_load_dwordx4 v6, s[16:19], s72 offen offset:1024 lds
v_mfma_f32_16x16x32_bf16 a[88:91], v[232:235], v[216:219], a[88:91]
ds_read_b64_tr_b16 v[176:177], v20 offset:16384
ds_read_b128 v[44:47], v28 offset:2176
v_mfma_f32_16x16x32_bf16 a[92:95], v[232:235], v[220:223], a[92:95]
ds_read_b64_tr_b16 v[178:179], v20 offset:17408
ds_read_b128 v[48:51], v28 offset:3264
v_mfma_f32_16x16x32_bf16 a[124:127], v[236:239], v[220:223], a[124:127]
s_and_b32 s74, s2, 15
ds_read_b64_tr_b16 v[180:181], v21 offset:16384
v_mfma_f32_16x16x32_bf16 a[120:123], v[236:239], v[216:219], a[120:123]
s_add_u32 s72, s71, 63488
buffer_load_dwordx4 v7, s[16:19], s72 offen offset:2048 lds
v_mfma_f32_16x16x32_bf16 a[116:119], v[236:239], v[212:215], a[116:119]
s_lshl_b32 s74, s74, 2
ds_read_b64_tr_b16 v[182:183], v21 offset:17408
v_mfma_f32_16x16x32_bf16 a[112:115], v[236:239], v[208:211], a[112:115]
s_add_u32 s74, s74, s58
ds_read_b64_tr_b16 v[184:185], v22 offset:16384
v_mfma_f32_16x16x32_bf16 a[108:111], v[236:239], v[204:207], a[108:111]
s_lshl_b32 s74, s74, 16
ds_read_b64_tr_b16 v[186:187], v22 offset:17408
v_mfma_f32_16x16x32_bf16 a[104:107], v[236:239], v[200:203], a[104:107]
s_lshr_b32 s75, s2, 4
ds_read_b64_tr_b16 v[188:189], v23 offset:16384
v_mfma_f32_16x16x32_bf16 a[100:103], v[236:239], v[196:199], a[100:103]
s_add_u32 s72, s71, 95232
buffer_load_dwordx4 v7, s[16:19], s72 offen offset:3072 lds
v_mfma_f32_16x16x32_bf16 a[96:99], v[236:239], v[192:195], a[96:99]
s_lshl_b32 s75, s75, 8
ds_read_b64_tr_b16 v[190:191], v23 offset:17408
v_mfma_f32_16x16x32_bf16 a[128:131], v[192:195], v[240:243], a[128:131]
s_sub_u32 s74, s74, s75
v_mfma_f32_16x16x32_bf16 a[132:135], v[196:199], v[240:243], a[132:135]
s_add_u32 s74, s74, 0x3000f00
v_mfma_f32_16x16x32_bf16 a[136:139], v[200:203], v[240:243], a[136:139]
s_add_u32 m0, s63, 102400
v_mfma_f32_16x16x32_bf16 a[140:143], v[204:207], v[240:243], a[140:143]
s_add_u32 s72, s69, 32768
buffer_load_dwordx4 v2, s[8:11], s72 offen lds
v_mfma_f32_16x16x32_bf16 a[144:147], v[208:211], v[240:243], a[144:147]
s_waitcnt vmcnt(29)
v_lshlrev_b32 v78, 16, v84
v_lshlrev_b32 v79, 16, v108
v_mfma_f32_16x16x32_bf16 a[148:151], v[212:215], v[240:243], a[148:151]
v_mul_f32 v76, v78, v79
v_lshlrev_b32 v80, 16, v116
v_mfma_f32_16x16x32_bf16 a[152:155], v[216:219], v[240:243], a[152:155]
s_add_u32 s72, s69, 39936
buffer_load_dwordx4 v3, s[8:11], s72 offen offset:1024 lds
v_mfma_f32_16x16x32_bf16 a[156:159], v[220:223], v[240:243], a[156:159]
v_mul_f32 v77, v78, v80
v_and_b32 v78, 0xffff0000, v84
v_mfma_f32_16x16x32_bf16 a[188:191], v[220:223], v[244:247], a[188:191]
v_and_b32 v79, 0xffff0000, v108
v_fmac_f32 v76, v78, v79
v_mfma_f32_16x16x32_bf16 a[184:187], v[216:219], v[244:247], a[184:187]
v_and_b32 v80, 0xffff0000, v116
v_fmac_f32 v77, v78, v80
v_mfma_f32_16x16x32_bf16 a[180:183], v[212:215], v[244:247], a[180:183]
v_lshlrev_b32 v78, 16, v85
v_lshlrev_b32 v79, 16, v109
v_mfma_f32_16x16x32_bf16 a[176:179], v[208:211], v[244:247], a[176:179]
s_add_u32 s72, s69, 47104
buffer_load_dwordx4 v2, s[8:11], s72 offen offset:2048 lds
v_mfma_f32_16x16x32_bf16 a[172:175], v[204:207], v[244:247], a[172:175]
v_fmac_f32 v76, v78, v79
v_lshlrev_b32 v80, 16, v117
v_mfma_f32_16x16x32_bf16 a[168:171], v[200:203], v[244:247], a[168:171]
v_fmac_f32 v77, v78, v80
v_and_b32 v78, 0xffff0000, v85
v_mfma_f32_16x16x32_bf16 a[164:167], v[196:199], v[244:247], a[164:167]
v_and_b32 v79, 0xffff0000, v109
v_fmac_f32 v76, v78, v79
v_mfma_f32_16x16x32_bf16 a[160:163], v[192:195], v[244:247], a[160:163]
s_add_u32 s72, s69, 54272
buffer_load_dwordx4 v3, s[8:11], s72 offen offset:3072 lds
v_mfma_f32_16x16x32_bf16 a[192:195], v[192:195], v[248:251], a[192:195]
v_and_b32 v80, 0xffff0000, v117
v_fmac_f32 v77, v78, v80
v_mfma_f32_16x16x32_bf16 a[196:199], v[196:199], v[248:251], a[196:199]
v_lshlrev_b32 v78, 16, v86
v_lshlrev_b32 v79, 16, v110
v_mfma_f32_16x16x32_bf16 a[200:203], v[200:203], v[248:251], a[200:203]
v_fmac_f32 v76, v78, v79
v_lshlrev_b32 v80, 16, v118
v_mfma_f32_16x16x32_bf16 a[204:207], v[204:207], v[248:251], a[204:207]
s_add_u32 m0, s64, 49152
v_fmac_f32 v77, v78, v80
v_and_b32 v78, 0xffff0000, v86
v_mfma_f32_16x16x32_bf16 a[208:211], v[208:211], v[248:251], a[208:211]
s_add_u32 s72, s71, 0
buffer_load_dwordx4 v6, s[20:23], s72 offen lds
v_mfma_f32_16x16x32_bf16 a[212:215], v[212:215], v[248:251], a[212:215]
v_and_b32 v79, 0xffff0000, v110
v_fmac_f32 v76, v78, v79
v_mfma_f32_16x16x32_bf16 a[216:219], v[216:219], v[248:251], a[216:219]
v_and_b32 v80, 0xffff0000, v118
v_fmac_f32 v77, v78, v80
v_mfma_f32_16x16x32_bf16 a[220:223], v[220:223], v[248:251], a[220:223]
v_lshlrev_b32 v78, 16, v87
v_lshlrev_b32 v79, 16, v111
v_mfma_f32_16x16x32_bf16 a[252:255], v[220:223], v[252:255], a[252:255]
s_add_u32 s72, s71, 31744
buffer_load_dwordx4 v6, s[20:23], s72 offen offset:1024 lds
v_mfma_f32_16x16x32_bf16 a[248:251], v[216:219], v[252:255], a[248:251]
v_fmac_f32 v76, v78, v79
v_lshlrev_b32 v80, 16, v119
v_mfma_f32_16x16x32_bf16 a[244:247], v[212:215], v[252:255], a[244:247]
v_fmac_f32 v77, v78, v80
v_and_b32 v78, 0xffff0000, v87
v_mfma_f32_16x16x32_bf16 a[240:243], v[208:211], v[252:255], a[240:243]
v_and_b32 v79, 0xffff0000, v111
v_fmac_f32 v76, v78, v79
v_mfma_f32_16x16x32_bf16 a[236:239], v[204:207], v[252:255], a[236:239]
s_add_u32 s72, s71, 63488
buffer_load_dwordx4 v7, s[20:23], s72 offen offset:2048 lds
v_mfma_f32_16x16x32_bf16 a[232:235], v[200:203], v[252:255], a[232:235]
v_and_b32 v80, 0xffff0000, v119
v_fmac_f32 v77, v78, v80
v_mfma_f32_16x16x32_bf16 a[228:231], v[196:199], v[252:255], a[228:231]
v_lshlrev_b32 v78, 16, v88
v_lshlrev_b32 v79, 16, v112
v_mfma_f32_16x16x32_bf16 a[224:227], v[192:195], v[252:255], a[224:227]
s_waitcnt lgkmcnt(0)
v_fmac_f32 v76, v78, v79
v_lshlrev_b32 v80, 16, v120
v_mfma_f32_16x16x32_bf16 a[0:3], v[160:163], v[128:131], a[0:3]
s_add_u32 s72, s71, 95232
buffer_load_dwordx4 v7, s[20:23], s72 offen offset:3072 lds
v_mfma_f32_16x16x32_bf16 a[4:7], v[160:163], v[132:135], a[4:7]
ds_read_b64_tr_b16 v[224:225], v20 offset:8192
v_fmac_f32 v77, v78, v80
v_mfma_f32_16x16x32_bf16 a[8:11], v[160:163], v[136:139], a[8:11]
ds_read_b64_tr_b16 v[226:227], v20 offset:9216
v_and_b32 v78, 0xffff0000, v88
v_mfma_f32_16x16x32_bf16 a[12:15], v[160:163], v[140:143], a[12:15]
ds_read_b128 v[192:195], v25 offset:0
v_and_b32 v79, 0xffff0000, v112
v_mfma_f32_16x16x32_bf16 a[16:19], v[160:163], v[144:147], a[16:19]
ds_read_b128 v[196:199], v25 offset:2048
v_fmac_f32 v76, v78, v79
v_mfma_f32_16x16x32_bf16 a[20:23], v[160:163], v[148:151], a[20:23]
ds_read_b128 v[200:203], v25 offset:4096
v_and_b32 v80, 0xffff0000, v120
v_mfma_f32_16x16x32_bf16 a[24:27], v[160:163], v[152:155], a[24:27]
ds_read_b128 v[204:207], v25 offset:6144
v_fmac_f32 v77, v78, v80
v_mfma_f32_16x16x32_bf16 a[28:31], v[160:163], v[156:159], a[28:31]
ds_read_b128 v[208:211], v25 offset:8192
v_lshlrev_b32 v78, 16, v89
v_mfma_f32_16x16x32_bf16 a[60:63], v[164:167], v[156:159], a[60:63]
buffer_store_dwordx4 v[36:39], v26, s[44:47], s74 offen sc1
v_mfma_f32_16x16x32_bf16 a[56:59], v[164:167], v[152:155], a[56:59]
ds_read_b128 v[212:215], v25 offset:10240
v_lshlrev_b32 v79, 16, v113
v_mfma_f32_16x16x32_bf16 a[52:55], v[164:167], v[148:151], a[52:55]
ds_read_b128 v[216:219], v25 offset:12288
v_fmac_f32 v76, v78, v79
v_mfma_f32_16x16x32_bf16 a[48:51], v[164:167], v[144:147], a[48:51]
ds_read_b128 v[220:223], v25 offset:14336
v_lshlrev_b32 v80, 16, v121
v_mfma_f32_16x16x32_bf16 a[44:47], v[164:167], v[140:143], a[44:47]
ds_read_b64_tr_b16 v[228:229], v21 offset:8192
v_fmac_f32 v77, v78, v80
v_mfma_f32_16x16x32_bf16 a[40:43], v[164:167], v[136:139], a[40:43]
ds_read_b64_tr_b16 v[230:231], v21 offset:9216
v_and_b32 v78, 0xffff0000, v89
v_mfma_f32_16x16x32_bf16 a[36:39], v[164:167], v[132:135], a[36:39]
ds_read_b64_tr_b16 v[232:233], v22 offset:8192
v_and_b32 v79, 0xffff0000, v113
v_mfma_f32_16x16x32_bf16 a[32:35], v[164:167], v[128:131], a[32:35]
ds_read_b64_tr_b16 v[234:235], v22 offset:9216
v_fmac_f32 v76, v78, v79
v_mfma_f32_16x16x32_bf16 a[64:67], v[168:171], v[128:131], a[64:67]
ds_read_b64_tr_b16 v[236:237], v23 offset:8192
v_and_b32 v80, 0xffff0000, v121
v_mfma_f32_16x16x32_bf16 a[68:71], v[168:171], v[132:135], a[68:71]
ds_read_b64_tr_b16 v[238:239], v23 offset:9216
v_fmac_f32 v77, v78, v80
v_mfma_f32_16x16x32_bf16 a[72:75], v[168:171], v[136:139], a[72:75]
ds_read_b64_tr_b16 v[240:241], v20 offset:24576
v_lshlrev_b32 v78, 16, v90
v_mfma_f32_16x16x32_bf16 a[76:79], v[168:171], v[140:143], a[76:79]
ds_read_b64_tr_b16 v[242:243], v20 offset:25600
v_lshlrev_b32 v79, 16, v114
v_mfma_f32_16x16x32_bf16 a[80:83], v[168:171], v[144:147], a[80:83]
s_lshr_b32 s75, s93, 5
ds_read_b64_tr_b16 v[244:245], v21 offset:24576
v_fmac_f32 v76, v78, v79
v_mfma_f32_16x16x32_bf16 a[84:87], v[168:171], v[148:151], a[84:87]
s_add_u32 s74, s74, 0x4000
buffer_store_dwordx4 v[40:43], v26, s[44:47], s74 offen sc1
v_mfma_f32_16x16x32_bf16 a[88:91], v[168:171], v[152:155], a[88:91]
s_and_b32 s75, s75, 0x3f80
ds_read_b64_tr_b16 v[246:247], v21 offset:25600
v_lshlrev_b32 v80, 16, v122
v_mfma_f32_16x16x32_bf16 a[92:95], v[168:171], v[156:159], a[92:95]
s_add_u32 s75, s75, LcB0-Lpc0
v_lshrrev_b32 v2, 6, v0
v_lshlrev_b32 v2, 7, v2
v_mfma_f32_16x16x32_bf16 a[124:127], v[172:175], v[156:159], a[124:127]
v_add_u32 v2, s75, v2
v_min_u32 v2, Lcode_end-Lpc0, v2
v_mfma_f32_16x16x32_bf16 a[120:123], v[172:175], v[152:155], a[120:123]
global_load_dword v3, v2, s[98:99]
v_mfma_f32_16x16x32_bf16 a[116:119], v[172:175], v[148:151], a[116:119]
ds_read_b64_tr_b16 v[248:249], v22 offset:24576
v_fmac_f32 v77, v78, v80
v_mfma_f32_16x16x32_bf16 a[112:115], v[172:175], v[144:147], a[112:115]
ds_read_b64_tr_b16 v[250:251], v22 offset:25600
v_and_b32 v78, 0xffff0000, v90
v_mfma_f32_16x16x32_bf16 a[108:111], v[172:175], v[140:143], a[108:111]
ds_read_b64_tr_b16 v[252:253], v23 offset:24576
v_and_b32 v79, 0xffff0000, v114
v_mfma_f32_16x16x32_bf16 a[104:107], v[172:175], v[136:139], a[104:107]
ds_read_b64_tr_b16 v[254:255], v23 offset:25600
v_fmac_f32 v76, v78, v79
v_mfma_f32_16x16x32_bf16 a[100:103], v[172:175], v[132:135], a[100:103]
v_and_b32 v80, 0xffff0000, v122
v_fmac_f32 v77, v78, v80
v_mfma_f32_16x16x32_bf16 a[96:99], v[172:175], v[128:131], a[96:99]
v_lshlrev_b32 v78, 16, v91
v_lshlrev_b32 v79, 16, v115
v_mfma_f32_16x16x32_bf16 a[128:131], v[128:131], v[176:179], a[128:131]
v_fmac_f32 v76, v78, v79
v_lshlrev_b32 v80, 16, v123
v_mfma_f32_16x16x32_bf16 a[132:135], v[132:135], v[176:179], a[132:135]
v_fmac_f32 v77, v78, v80
v_and_b32 v78, 0xffff0000, v91
v_mfma_f32_16x16x32_bf16 a[136:139], v[136:139], v[176:179], a[136:139]
v_and_b32 v79, 0xffff0000, v115
v_fmac_f32 v76, v78, v79
v_mfma_f32_16x16x32_bf16 a[140:143], v[140:143], v[176:179], a[140:143]
s_add_u32 s74, s74, 0x4000
buffer_store_dwordx4 v[44:47], v26, s[44:47], s74 offen sc1
v_mfma_f32_16x16x32_bf16 a[144:147], v[144:147], v[176:179], a[144:147]
v_and_b32 v80, 0xffff0000, v123
v_fmac_f32 v77, v78, v80
v_mfma_f32_16x16x32_bf16 a[148:151], v[148:151], v[176:179], a[148:151]
v_add_f32_dpp v76, v76, v76 row_ror:8 row_mask:0xf bank_mask:0xf
v_add_f32_dpp v77, v77, v77 row_ror:8 row_mask:0xf bank_mask:0xf
v_mfma_f32_16x16x32_bf16 a[152:155], v[152:155], v[176:179], a[152:155]
v_add_f32_dpp v76, v76, v76 row_ror:4 row_mask:0xf bank_mask:0xf
v_add_f32_dpp v77, v77, v77 row_ror:4 row_mask:0xf bank_mask:0xf
v_mfma_f32_16x16x32_bf16 a[156:159], v[156:159], v[176:179], a[156:159]
v_add_f32_dpp v76, v76, v76 row_ror:2 row_mask:0xf bank_mask:0xf
v_add_f32_dpp v77, v77, v77 row_ror:2 row_mask:0xf bank_mask:0xf
v_mfma_f32_16x16x32_bf16 a[188:191], v[156:159], v[180:183], a[188:191]
v_add_f32_dpp v76, v76, v76 row_ror:1 row_mask:0xf bank_mask:0xf
v_add_f32_dpp v77, v77, v77 row_ror:1 row_mask:0xf bank_mask:0xf
v_mfma_f32_16x16x32_bf16 a[184:187], v[152:155], v[180:183], a[184:187]
v_mov_b32 v78, v76
v_mov_b32 v79, v77
v_mfma_f32_16x16x32_bf16 a[180:183], v[148:151], v[180:183], a[180:183]
v_permlane16_swap_b32 v76, v78
v_permlane16_swap_b32 v77, v79
v_mfma_f32_16x16x32_bf16 a[176:179], v[144:147], v[180:183], a[176:179]
v_add_f32 v76, v76, v78
v_add_f32 v77, v77, v79
v_mfma_f32_16x16x32_bf16 a[172:175], v[140:143], v[180:183], a[172:175]
v_mov_b32 v78, v76
v_mov_b32 v79, v77
v_mfma_f32_16x16x32_bf16 a[168:171], v[136:139], v[180:183], a[168:171]
v_permlane32_swap_b32 v76, v78
v_permlane32_swap_b32 v77, v79
v_mfma_f32_16x16x32_bf16 a[164:167], v[132:135], v[180:183], a[164:167]
v_add_f32 v76, v76, v78
v_add_f32 v77, v77, v79
v_mfma_f32_16x16x32_bf16 a[160:163], v[128:131], v[180:183], a[160:163]
v_mul_f32 v76, 0xbfb8aa3b, v76
v_mul_f32 v77, 0xbfb8aa3b, v77
v_mfma_f32_16x16x32_bf16 a[192:195], v[128:131], v[184:187], a[192:195]
v_exp_f32 v76, v76
v_mfma_f32_16x16x32_bf16 a[196:199], v[132:135], v[184:187], a[196:199]
s_add_u32 s74, s74, 0x4000
buffer_store_dwordx4 v[48:51], v26, s[44:47], s74 offen sc1
v_mfma_f32_16x16x32_bf16 a[200:203], v[136:139], v[184:187], a[200:203]
v_exp_f32 v77, v77
v_mfma_f32_16x16x32_bf16 a[204:207], v[140:143], v[184:187], a[204:207]
v_add_f32 v76, 1.0, v76
v_add_f32 v77, 1.0, v77
v_mfma_f32_16x16x32_bf16 a[208:211], v[144:147], v[184:187], a[208:211]
v_rcp_f32 v76, v76
v_mfma_f32_16x16x32_bf16 a[212:215], v[148:151], v[184:187], a[212:215]
v_rcp_f32 v77, v77
v_mfma_f32_16x16x32_bf16 a[216:219], v[152:155], v[184:187], a[216:219]
s_lshr_b32 s80, s76, 9
v_mfma_f32_16x16x32_bf16 a[220:223], v[156:159], v[184:187], a[220:223]
s_add_u32 s80, s80, 0x3800000
v_min_u32 v78, 1, v0
v_lshlrev_b32 v78, 30, v78
v_mfma_f32_16x16x32_bf16 a[252:255], v[156:159], v[188:191], a[252:255]
buffer_store_dwordx2 v[76:77], v78, s[44:47], s80 offen sc1
v_mfma_f32_16x16x32_bf16 a[248:251], v[152:155], v[188:191], a[248:251]
v_mfma_f32_16x16x32_bf16 a[244:247], v[148:151], v[188:191], a[244:247]
v_mfma_f32_16x16x32_bf16 a[240:243], v[144:147], v[188:191], a[240:243]
v_mfma_f32_16x16x32_bf16 a[236:239], v[140:143], v[188:191], a[236:239]
v_mfma_f32_16x16x32_bf16 a[232:235], v[136:139], v[188:191], a[232:235]
v_mfma_f32_16x16x32_bf16 a[228:231], v[132:135], v[188:191], a[228:231]
s_waitcnt vmcnt(6) lgkmcnt(0)
v_mfma_f32_16x16x32_bf16 a[224:227], v[128:131], v[188:191], a[224:227]
s_barrier
v_mfma_f32_16x16x32_bf16 a[0:3], v[224:227], v[192:195], a[0:3]
s_add_u32 s73, s62, 0
ds_read_b64_tr_b16 v[160:161], v20 offset:32768
v_mfma_f32_16x16x32_bf16 a[4:7], v[224:227], v[196:199], a[4:7]
s_add_u32 s70, s73, s65
ds_read_b64_tr_b16 v[162:163], v20 offset:33792
v_mfma_f32_16x16x32_bf16 a[8:11], v[224:227], v[200:203], a[8:11]
s_and_b32 s70, s70, 3
ds_read_b128 v[128:131], v24 offset:32768
v_mfma_f32_16x16x32_bf16 a[12:15], v[224:227], v[204:207], a[12:15]
s_and_b32 s73, s73, 12
ds_read_b128 v[132:135], v24 offset:34816
v_mfma_f32_16x16x32_bf16 a[16:19], v[224:227], v[208:211], a[16:19]
s_or_b32 s73, s73, s70
ds_read_b128 v[136:139], v24 offset:36864
v_mfma_f32_16x16x32_bf16 a[20:23], v[224:227], v[212:215], a[20:23]
s_lshl_b32 s71, s73, 19
ds_read_b128 v[140:143], v24 offset:38912
v_mfma_f32_16x16x32_bf16 a[24:27], v[224:227], v[216:219], a[24:27]
s_add_u32 s71, s71, s66
ds_read_b128 v[144:147], v24 offset:40960
v_mfma_f32_16x16x32_bf16 a[28:31], v[224:227], v[220:223], a[28:31]
s_lshl_b32 s73, s73, 7
ds_read_b128 v[148:151], v24 offset:43008
v_mfma_f32_16x16x32_bf16 a[60:63], v[228:231], v[220:223], a[60:63]
s_add_u32 s69, s73, s67
ds_read_b128 v[152:155], v24 offset:45056
v_mfma_f32_16x16x32_bf16 a[56:59], v[228:231], v[216:219], a[56:59]
s_add_u32 s70, s73, s68
ds_read_b128 v[156:159], v24 offset:47104
v_mfma_f32_16x16x32_bf16 a[52:55], v[228:231], v[212:215], a[52:55]
s_add_u32 m0, s64, 0
ds_read_b64_tr_b16 v[164:165], v21 offset:32768
v_mfma_f32_16x16x32_bf16 a[48:51], v[228:231], v[208:211], a[48:51]
s_add_u32 s72, s71, 0
buffer_load_dwordx4 v6, s[12:15], s72 offen lds
v_mfma_f32_16x16x32_bf16 a[44:47], v[228:231], v[204:207], a[44:47]
s_add_u32 s72, s71, 31744
buffer_load_dwordx4 v6, s[12:15], s72 offen offset:1024 lds
v_mfma_f32_16x16x32_bf16 a[40:43], v[228:231], v[200:203], a[40:43]
s_add_u32 s72, s71, 63488
buffer_load_dwordx4 v7, s[12:15], s72 offen offset:2048 lds
v_mfma_f32_16x16x32_bf16 a[36:39], v[228:231], v[196:199], a[36:39]
ds_read_b64_tr_b16 v[166:167], v21 offset:33792
v_mfma_f32_16x16x32_bf16 a[32:35], v[228:231], v[192:195], a[32:35]
s_add_u32 s72, s71, 95232
buffer_load_dwordx4 v7, s[12:15], s72 offen offset:3072 lds
v_mfma_f32_16x16x32_bf16 a[64:67], v[232:235], v[192:195], a[64:67]
ds_read_b64_tr_b16 v[168:169], v22 offset:32768
v_mfma_f32_16x16x32_bf16 a[68:71], v[232:235], v[196:199], a[68:71]
ds_read_b64_tr_b16 v[170:171], v22 offset:33792
v_mfma_f32_16x16x32_bf16 a[72:75], v[232:235], v[200:203], a[72:75]
ds_read_b64_tr_b16 v[172:173], v23 offset:32768
v_mfma_f32_16x16x32_bf16 a[76:79], v[232:235], v[204:207], a[76:79]
ds_read_b64_tr_b16 v[174:175], v23 offset:33792
v_mfma_f32_16x16x32_bf16 a[80:83], v[232:235], v[208:211], a[80:83]
s_add_u32 m0, s63, 131072
ds_read_b64_tr_b16 v[176:177], v20 offset:49152
v_mfma_f32_16x16x32_bf16 a[84:87], v[232:235], v[212:215], a[84:87]
s_add_u32 s72, s69, 0
buffer_load_dwordx4 v4, s[4:7], s72 offen lds
v_mfma_f32_16x16x32_bf16 a[88:91], v[232:235], v[216:219], a[88:91]
ds_read_b64_tr_b16 v[178:179], v20 offset:50176
v_mfma_f32_16x16x32_bf16 a[92:95], v[232:235], v[220:223], a[92:95]
ds_read_b64_tr_b16 v[180:181], v21 offset:49152
v_mfma_f32_16x16x32_bf16 a[124:127], v[236:239], v[220:223], a[124:127]
ds_read_b64_tr_b16 v[182:183], v21 offset:50176
v_mfma_f32_16x16x32_bf16 a[120:123], v[236:239], v[216:219], a[120:123]
s_add_u32 s72, s69, 15360
buffer_load_dwordx4 v5, s[4:7], s72 offen offset:1024 lds
v_mfma_f32_16x16x32_bf16 a[116:119], v[236:239], v[212:215], a[116:119]
ds_read_b64_tr_b16 v[184:185], v22 offset:49152
v_mfma_f32_16x16x32_bf16 a[112:115], v[236:239], v[208:211], a[112:115]
ds_read_b64_tr_b16 v[186:187], v22 offset:50176
v_mfma_f32_16x16x32_bf16 a[108:111], v[236:239], v[204:207], a[108:111]
ds_read_b64_tr_b16 v[188:189], v23 offset:49152
v_mfma_f32_16x16x32_bf16 a[104:107], v[236:239], v[200:203], a[104:107]
ds_read_b64_tr_b16 v[190:191], v23 offset:50176
v_mfma_f32_16x16x32_bf16 a[100:103], v[236:239], v[196:199], a[100:103]
s_add_u32 s72, s69, 129024
buffer_load_dwordx4 v4, s[4:7], s72 offen offset:2048 lds
v_mfma_f32_16x16x32_bf16 a[96:99], v[236:239], v[192:195], a[96:99]
v_mfma_f32_16x16x32_bf16 a[128:131], v[192:195], v[240:243], a[128:131]
v_mfma_f32_16x16x32_bf16 a[132:135], v[196:199], v[240:243], a[132:135]
v_mfma_f32_16x16x32_bf16 a[136:139], v[200:203], v[240:243], a[136:139]
v_mfma_f32_16x16x32_bf16 a[140:143], v[204:207], v[240:243], a[140:143]
s_add_u32 s72, s69, 144384
buffer_load_dwordx4 v5, s[4:7], s72 offen offset:3072 lds
v_mfma_f32_16x16x32_bf16 a[144:147], v[208:211], v[240:243], a[144:147]
v_mfma_f32_16x16x32_bf16 a[148:151], v[212:215], v[240:243], a[148:151]
v_mfma_f32_16x16x32_bf16 a[152:155], v[216:219], v[240:243], a[152:155]
v_mfma_f32_16x16x32_bf16 a[156:159], v[220:223], v[240:243], a[156:159]
v_mfma_f32_16x16x32_bf16 a[188:191], v[220:223], v[244:247], a[188:191]
s_add_u32 m0, s63, 135168
v_mfma_f32_16x16x32_bf16 a[184:187], v[216:219], v[244:247], a[184:187]
s_add_u32 s72, s70, 0
buffer_load_dwordx4 v4, s[4:7], s72 offen lds
v_mfma_f32_16x16x32_bf16 a[180:183], v[212:215], v[244:247], a[180:183]
v_mfma_f32_16x16x32_bf16 a[176:179], v[208:211], v[244:247], a[176:179]
v_mfma_f32_16x16x32_bf16 a[172:175], v[204:207], v[244:247], a[172:175]
v_mfma_f32_16x16x32_bf16 a[168:171], v[200:203], v[244:247], a[168:171]
s_add_u32 s72, s70, 15360
buffer_load_dwordx4 v5, s[4:7], s72 offen offset:1024 lds
v_mfma_f32_16x16x32_bf16 a[164:167], v[196:199], v[244:247], a[164:167]
v_mfma_f32_16x16x32_bf16 a[160:163], v[192:195], v[244:247], a[160:163]
v_mfma_f32_16x16x32_bf16 a[192:195], v[192:195], v[248:251], a[192:195]
v_mfma_f32_16x16x32_bf16 a[196:199], v[196:199], v[248:251], a[196:199]
v_mfma_f32_16x16x32_bf16 a[200:203], v[200:203], v[248:251], a[200:203]
s_add_u32 s72, s70, 129024
buffer_load_dwordx4 v4, s[4:7], s72 offen offset:2048 lds
v_mfma_f32_16x16x32_bf16 a[204:207], v[204:207], v[248:251], a[204:207]
v_mfma_f32_16x16x32_bf16 a[208:211], v[208:211], v[248:251], a[208:211]
v_mfma_f32_16x16x32_bf16 a[212:215], v[212:215], v[248:251], a[212:215]
v_mfma_f32_16x16x32_bf16 a[216:219], v[216:219], v[248:251], a[216:219]
v_mfma_f32_16x16x32_bf16 a[220:223], v[220:223], v[248:251], a[220:223]
s_add_u32 s72, s70, 144384
buffer_load_dwordx4 v5, s[4:7], s72 offen offset:3072 lds
v_mfma_f32_16x16x32_bf16 a[252:255], v[220:223], v[252:255], a[252:255]
v_mfma_f32_16x16x32_bf16 a[248:251], v[216:219], v[252:255], a[248:251]
v_mfma_f32_16x16x32_bf16 a[244:247], v[212:215], v[252:255], a[244:247]
v_mfma_f32_16x16x32_bf16 a[240:243], v[208:211], v[252:255], a[240:243]
v_mfma_f32_16x16x32_bf16 a[236:239], v[204:207], v[252:255], a[236:239]
s_add_u32 s73, s62, 1
v_mfma_f32_16x16x32_bf16 a[232:235], v[200:203], v[252:255], a[232:235]
s_add_u32 s70, s73, s65
v_mfma_f32_16x16x32_bf16 a[228:231], v[196:199], v[252:255], a[228:231]
s_and_b32 s70, s70, 3
v_mfma_f32_16x16x32_bf16 a[224:227], v[192:195], v[252:255], a[224:227]
s_waitcnt lgkmcnt(0)
v_mfma_f32_16x16x32_bf16 a[0:3], v[160:163], v[128:131], a[0:3]
s_and_b32 s73, s73, 12
ds_read_b64_tr_b16 v[224:225], v20 offset:40960
v_mfma_f32_16x16x32_bf16 a[4:7], v[160:163], v[132:135], a[4:7]
s_or_b32 s73, s73, s70
ds_read_b64_tr_b16 v[226:227], v20 offset:41984
v_mfma_f32_16x16x32_bf16 a[8:11], v[160:163], v[136:139], a[8:11]
s_lshl_b32 s71, s73, 19
ds_read_b128 v[192:195], v25 offset:32768
v_mfma_f32_16x16x32_bf16 a[12:15], v[160:163], v[140:143], a[12:15]
s_add_u32 s71, s71, s66
ds_read_b128 v[196:199], v25 offset:34816
v_mfma_f32_16x16x32_bf16 a[16:19], v[160:163], v[144:147], a[16:19]
s_lshl_b32 s73, s73, 7
ds_read_b128 v[200:203], v25 offset:36864
v_mfma_f32_16x16x32_bf16 a[20:23], v[160:163], v[148:151], a[20:23]
s_add_u32 s69, s73, s67
ds_read_b128 v[204:207], v25 offset:38912
v_mfma_f32_16x16x32_bf16 a[24:27], v[160:163], v[152:155], a[24:27]
s_add_u32 s70, s73, s68
ds_read_b128 v[208:211], v25 offset:40960
v_mfma_f32_16x16x32_bf16 a[28:31], v[160:163], v[156:159], a[28:31]
s_add_u32 m0, s64, 16384
ds_read_b128 v[212:215], v25 offset:43008
v_mfma_f32_16x16x32_bf16 a[60:63], v[164:167], v[156:159], a[60:63]
s_add_u32 s72, s71, 0
buffer_load_dwordx4 v6, s[12:15], s72 offen lds
v_mfma_f32_16x16x32_bf16 a[56:59], v[164:167], v[152:155], a[56:59]
s_add_u32 s72, s71, 31744
buffer_load_dwordx4 v6, s[12:15], s72 offen offset:1024 lds
v_mfma_f32_16x16x32_bf16 a[52:55], v[164:167], v[148:151], a[52:55]
s_add_u32 s72, s71, 63488
buffer_load_dwordx4 v7, s[12:15], s72 offen offset:2048 lds
v_mfma_f32_16x16x32_bf16 a[48:51], v[164:167], v[144:147], a[48:51]
s_add_u32 s72, s71, 95232
buffer_load_dwordx4 v7, s[12:15], s72 offen offset:3072 lds
v_mfma_f32_16x16x32_bf16 a[44:47], v[164:167], v[140:143], a[44:47]
ds_read_b128 v[216:219], v25 offset:45056
v_mfma_f32_16x16x32_bf16 a[40:43], v[164:167], v[136:139], a[40:43]
ds_read_b128 v[220:223], v25 offset:47104
v_mfma_f32_16x16x32_bf16 a[36:39], v[164:167], v[132:135], a[36:39]
ds_read_b64_tr_b16 v[228:229], v21 offset:40960
v_mfma_f32_16x16x32_bf16 a[32:35], v[164:167], v[128:131], a[32:35]
ds_read_b64_tr_b16 v[230:231], v21 offset:41984
v_mfma_f32_16x16x32_bf16 a[64:67], v[168:171], v[128:131], a[64:67]
s_add_u32 m0, s63, 65536
ds_read_b64_tr_b16 v[232:233], v22 offset:40960
v_mfma_f32_16x16x32_bf16 a[68:71], v[168:171], v[132:135], a[68:71]
s_add_u32 s72, s69, 0
buffer_load_dwordx4 v4, s[4:7], s72 offen lds
v_mfma_f32_16x16x32_bf16 a[72:75], v[168:171], v[136:139], a[72:75]
ds_read_b64_tr_b16 v[234:235], v22 offset:41984
v_mfma_f32_16x16x32_bf16 a[76:79], v[168:171], v[140:143], a[76:79]
ds_read_b64_tr_b16 v[236:237], v23 offset:40960
v_mfma_f32_16x16x32_bf16 a[80:83], v[168:171], v[144:147], a[80:83]
ds_read_b64_tr_b16 v[238:239], v23 offset:41984
v_mfma_f32_16x16x32_bf16 a[84:87], v[168:171], v[148:151], a[84:87]
s_add_u32 s72, s69, 15360
buffer_load_dwordx4 v5, s[4:7], s72 offen offset:1024 lds
v_mfma_f32_16x16x32_bf16 a[88:91], v[168:171], v[152:155], a[88:91]
ds_read_b64_tr_b16 v[240:241], v20 offset:57344
v_mfma_f32_16x16x32_bf16 a[92:95], v[168:171], v[156:159], a[92:95]
ds_read_b64_tr_b16 v[242:243], v20 offset:58368
v_mfma_f32_16x16x32_bf16 a[124:127], v[172:175], v[156:159], a[124:127]
ds_read_b64_tr_b16 v[244:245], v21 offset:57344
v_mfma_f32_16x16x32_bf16 a[120:123], v[172:175], v[152:155], a[120:123]
ds_read_b64_tr_b16 v[246:247], v21 offset:58368
v_mfma_f32_16x16x32_bf16 a[116:119], v[172:175], v[148:151], a[116:119]
s_add_u32 s72, s69, 129024
buffer_load_dwordx4 v4, s[4:7], s72 offen offset:2048 lds
v_mfma_f32_16x16x32_bf16 a[112:115], v[172:175], v[144:147], a[112:115]
ds_read_b64_tr_b16 v[248:249], v22 offset:57344
v_mfma_f32_16x16x32_bf16 a[108:111], v[172:175], v[140:143], a[108:111]
ds_read_b64_tr_b16 v[250:251], v22 offset:58368
v_mfma_f32_16x16x32_bf16 a[104:107], v[172:175], v[136:139], a[104:107]
ds_read_b64_tr_b16 v[252:253], v23 offset:57344
v_mfma_f32_16x16x32_bf16 a[100:103], v[172:175], v[132:135], a[100:103]
ds_read_b64_tr_b16 v[254:255], v23 offset:58368
v_mfma_f32_16x16x32_bf16 a[96:99], v[172:175], v[128:131], a[96:99]
s_add_u32 s72, s69, 144384
buffer_load_dwordx4 v5, s[4:7], s72 offen offset:3072 lds
v_mfma_f32_16x16x32_bf16 a[128:131], v[128:131], v[176:179], a[128:131]
v_mfma_f32_16x16x32_bf16 a[132:135], v[132:135], v[176:179], a[132:135]
v_mfma_f32_16x16x32_bf16 a[136:139], v[136:139], v[176:179], a[136:139]
v_mfma_f32_16x16x32_bf16 a[140:143], v[140:143], v[176:179], a[140:143]
v_mfma_f32_16x16x32_bf16 a[144:147], v[144:147], v[176:179], a[144:147]
s_add_u32 m0, s63, 69632
v_mfma_f32_16x16x32_bf16 a[148:151], v[148:151], v[176:179], a[148:151]
s_add_u32 s72, s70, 0
buffer_load_dwordx4 v4, s[4:7], s72 offen lds
v_mfma_f32_16x16x32_bf16 a[152:155], v[152:155], v[176:179], a[152:155]
v_mfma_f32_16x16x32_bf16 a[156:159], v[156:159], v[176:179], a[156:159]
v_mfma_f32_16x16x32_bf16 a[188:191], v[156:159], v[180:183], a[188:191]
v_mfma_f32_16x16x32_bf16 a[184:187], v[152:155], v[180:183], a[184:187]
s_add_u32 s72, s70, 15360
buffer_load_dwordx4 v5, s[4:7], s72 offen offset:1024 lds
v_mfma_f32_16x16x32_bf16 a[180:183], v[148:151], v[180:183], a[180:183]
v_mfma_f32_16x16x32_bf16 a[176:179], v[144:147], v[180:183], a[176:179]
v_mfma_f32_16x16x32_bf16 a[172:175], v[140:143], v[180:183], a[172:175]
v_mfma_f32_16x16x32_bf16 a[168:171], v[136:139], v[180:183], a[168:171]
v_mfma_f32_16x16x32_bf16 a[164:167], v[132:135], v[180:183], a[164:167]
s_add_u32 s72, s70, 129024
buffer_load_dwordx4 v4, s[4:7], s72 offen offset:2048 lds
v_mfma_f32_16x16x32_bf16 a[160:163], v[128:131], v[180:183], a[160:163]
v_mfma_f32_16x16x32_bf16 a[192:195], v[128:131], v[184:187], a[192:195]
v_mfma_f32_16x16x32_bf16 a[196:199], v[132:135], v[184:187], a[196:199]
v_mfma_f32_16x16x32_bf16 a[200:203], v[136:139], v[184:187], a[200:203]
v_mfma_f32_16x16x32_bf16 a[204:207], v[140:143], v[184:187], a[204:207]
s_add_u32 s72, s70, 144384
buffer_load_dwordx4 v5, s[4:7], s72 offen offset:3072 lds
v_mfma_f32_16x16x32_bf16 a[208:211], v[144:147], v[184:187], a[208:211]
v_mfma_f32_16x16x32_bf16 a[212:215], v[148:151], v[184:187], a[212:215]
v_mfma_f32_16x16x32_bf16 a[216:219], v[152:155], v[184:187], a[216:219]
v_mfma_f32_16x16x32_bf16 a[220:223], v[156:159], v[184:187], a[220:223]
v_mfma_f32_16x16x32_bf16 a[252:255], v[156:159], v[188:191], a[252:255]
v_mfma_f32_16x16x32_bf16 a[248:251], v[152:155], v[188:191], a[248:251]
v_mfma_f32_16x16x32_bf16 a[244:247], v[148:151], v[188:191], a[244:247]
v_mfma_f32_16x16x32_bf16 a[240:243], v[144:147], v[188:191], a[240:243]
v_mfma_f32_16x16x32_bf16 a[236:239], v[140:143], v[188:191], a[236:239]
v_mfma_f32_16x16x32_bf16 a[232:235], v[136:139], v[188:191], a[232:235]
v_mfma_f32_16x16x32_bf16 a[228:231], v[132:135], v[188:191], a[228:231]
s_waitcnt vmcnt(12) lgkmcnt(0)
v_mfma_f32_16x16x32_bf16 a[224:227], v[128:131], v[188:191], a[224:227]
s_barrier
LcB0:
v_mfma_f32_16x16x32_bf16 a[0:3], v[224:227], v[192:195], a[0:3]
s_add_u32 s73, s62, 2
ds_read_b64_tr_b16 v[32:33], v8 offset:0
v_mfma_f32_16x16x32_bf16 a[4:7], v[224:227], v[196:199], a[4:7]
s_add_u32 s70, s73, s65
ds_read_b64_tr_b16 v[34:35], v8 offset:1024
v_mfma_f32_16x16x32_bf16 a[8:11], v[224:227], v[200:203], a[8:11]
s_and_b32 s70, s70, 3
ds_read_b128 v[64:67], v16 offset:0
v_mfma_f32_16x16x32_bf16 a[12:15], v[224:227], v[204:207], a[12:15]
s_and_b32 s73, s73, 12
ds_read_b128 v[68:71], v16 offset:2048
v_mfma_f32_16x16x32_bf16 a[16:19], v[224:227], v[208:211], a[16:19]
s_or_b32 s73, s73, s70
ds_read_b128 v[72:75], v16 offset:4096
v_mfma_f32_16x16x32_bf16 a[20:23], v[224:227], v[212:215], a[20:23]
s_lshl_b32 s71, s73, 19
ds_read_b128 v[76:79], v16 offset:6144
v_mfma_f32_16x16x32_bf16 a[24:27], v[224:227], v[216:219], a[24:27]
s_add_u32 s71, s71, s66
ds_read_b64_tr_b16 v[36:37], v9 offset:0
v_mfma_f32_16x16x32_bf16 a[28:31], v[224:227], v[220:223], a[28:31]
s_lshl_b32 s73, s73, 7
ds_read_b64_tr_b16 v[38:39], v9 offset:1024
v_mfma_f32_16x16x32_bf16 a[60:63], v[228:231], v[220:223], a[60:63]
s_add_u32 s69, s73, s67
ds_read_b64_tr_b16 v[40:41], v10 offset:0
v_mfma_f32_16x16x32_bf16 a[56:59], v[228:231], v[216:219], a[56:59]
s_add_u32 s70, s73, s68
ds_read_b64_tr_b16 v[42:43], v10 offset:1024
v_mfma_f32_16x16x32_bf16 a[52:55], v[228:231], v[212:215], a[52:55]
s_add_u32 m0, s64, 32768
ds_read_b64_tr_b16 v[44:45], v11 offset:0
v_mfma_f32_16x16x32_bf16 a[48:51], v[228:231], v[208:211], a[48:51]
s_add_u32 s72, s71, 0
buffer_load_dwordx4 v6, s[12:15], s72 offen lds
v_mfma_f32_16x16x32_bf16 a[44:47], v[228:231], v[204:207], a[44:47]
s_add_u32 s72, s71, 31744
buffer_load_dwordx4 v6, s[12:15], s72 offen offset:1024 lds
v_mfma_f32_16x16x32_bf16 a[40:43], v[228:231], v[200:203], a[40:43]
s_add_u32 s72, s71, 63488
buffer_load_dwordx4 v7, s[12:15], s72 offen offset:2048 lds
v_mfma_f32_16x16x32_bf16 a[36:39], v[228:231], v[196:199], a[36:39]
s_lshl_b32 s80, s59, 2
ds_read_b64_tr_b16 v[46:47], v11 offset:1024
v_or_b32 v26, s58, v0
v_mfma_f32_16x16x32_bf16 a[32:35], v[228:231], v[192:195], a[32:35]
s_add_u32 s72, s71, 95232
buffer_load_dwordx4 v7, s[12:15], s72 offen offset:3072 lds
v_mfma_f32_16x16x32_bf16 a[64:67], v[232:235], v[192:195], a[64:67]
ds_read_b64_tr_b16 v[48:49], v12 offset:0
v_mov_b32 v27, 1
v_mfma_f32_16x16x32_bf16 a[68:71], v[232:235], v[196:199], a[68:71]
ds_read_b64_tr_b16 v[50:51], v12 offset:1024
v_lshlrev_b32 v26, 8, v26
v_mfma_f32_16x16x32_bf16 a[72:75], v[232:235], v[200:203], a[72:75]
ds_read_b64_tr_b16 v[52:53], v13 offset:0
v_mfma_f32_16x16x32_bf16 a[76:79], v[232:235], v[204:207], a[76:79]
ds_read_b64_tr_b16 v[54:55], v13 offset:1024
v_mfma_f32_16x16x32_bf16 a[80:83], v[232:235], v[208:211], a[80:83]
s_add_u32 m0, s63, 98304
ds_read_b64_tr_b16 v[56:57], v14 offset:0
v_mfma_f32_16x16x32_bf16 a[84:87], v[232:235], v[212:215], a[84:87]
s_add_u32 s72, s69, 0
buffer_load_dwordx4 v4, s[4:7], s72 offen lds
v_mfma_f32_16x16x32_bf16 a[88:91], v[232:235], v[216:219], a[88:91]
ds_read_b64_tr_b16 v[58:59], v14 offset:1024
v_mfma_f32_16x16x32_bf16 a[92:95], v[232:235], v[220:223], a[92:95]
ds_read_b64_tr_b16 v[60:61], v15 offset:0
v_mfma_f32_16x16x32_bf16 a[124:127], v[236:239], v[220:223], a[124:127]
ds_read_b64_tr_b16 v[62:63], v15 offset:1024
v_mfma_f32_16x16x32_bf16 a[120:123], v[236:239], v[216:219], a[120:123]
s_add_u32 s72, s69, 15360
buffer_load_dwordx4 v5, s[4:7], s72 offen offset:1024 lds
v_mfma_f32_16x16x32_bf16 a[116:119], v[236:239], v[212:215], a[116:119]
buffer_atomic_add v27, v26, s[48:51], s80 offen sc1
v_mfma_f32_16x16x32_bf16 a[112:115], v[236:239], v[208:211], a[112:115]
v_accvgpr_read_b32 v20, a0
v_accvgpr_read_b32 v28, a1
v_mfma_f32_16x16x32_bf16 a[108:111], v[236:239], v[204:207], a[108:111]
v_accvgpr_read_b32 v21, a2
v_accvgpr_read_b32 v29, a3
v_mfma_f32_16x16x32_bf16 a[104:107], v[236:239], v[200:203], a[104:107]
v_accvgpr_read_b32 v22, a32
v_accvgpr_read_b32 v30, a33
v_mfma_f32_16x16x32_bf16 a[100:103], v[236:239], v[196:199], a[100:103]
s_add_u32 s72, s69, 129024
buffer_load_dwordx4 v4, s[4:7], s72 offen offset:2048 lds
v_mfma_f32_16x16x32_bf16 a[96:99], v[236:239], v[192:195], a[96:99]
v_accvgpr_read_b32 v23, a34
v_accvgpr_read_b32 v31, a35
v_mfma_f32_16x16x32_bf16 a[128:131], v[192:195], v[240:243], a[128:131]
v_mul_f32 v20, s79, v20
v_mul_f32 v28, s79, v28
v_mfma_f32_16x16x32_bf16 a[132:135], v[196:199], v[240:243], a[132:135]
v_mul_f32 v21, s79, v21
v_mul_f32 v29, s79, v29
v_mfma_f32_16x16x32_bf16 a[136:139], v[200:203], v[240:243], a[136:139]
v_mul_f32 v22, s79, v22
v_mul_f32 v30, s79, v30
v_mfma_f32_16x16x32_bf16 a[140:143], v[204:207], v[240:243], a[140:143]
s_add_u32 s72, s69, 144384
buffer_load_dwordx4 v5, s[4:7], s72 offen offset:3072 lds
v_mfma_f32_16x16x32_bf16 a[144:147], v[208:211], v[240:243], a[144:147]
v_mul_f32 v23, s79, v23
v_mul_f32 v31, s79, v31
v_mfma_f32_16x16x32_bf16 a[148:151], v[212:215], v[240:243], a[148:151]
v_cvt_pk_bf16_f32 v20, v20, v28
v_cvt_pk_bf16_f32 v21, v21, v29
v_mfma_f32_16x16x32_bf16 a[152:155], v[216:219], v[240:243], a[152:155]
v_cvt_pk_bf16_f32 v22, v22, v30
v_cvt_pk_bf16_f32 v23, v23, v31
v_mfma_f32_16x16x32_bf16 a[156:159], v[220:223], v[240:243], a[156:159]
s_add_u32 s80, s77, 0
buffer_store_dwordx4 v[20:23], v1, s[44:47], s80 offen sc1
v_mfma_f32_16x16x32_bf16 a[188:191], v[220:223], v[244:247], a[188:191]
s_add_u32 m0, s63, 102400
v_mfma_f32_16x16x32_bf16 a[184:187], v[216:219], v[244:247], a[184:187]
s_add_u32 s72, s70, 0
buffer_load_dwordx4 v4, s[4:7], s72 offen lds
v_mfma_f32_16x16x32_bf16 a[180:183], v[212:215], v[244:247], a[180:183]
v_mfma_f32_16x16x32_bf16 a[176:179], v[208:211], v[244:247], a[176:179]
v_mfma_f32_16x16x32_bf16 a[172:175], v[204:207], v[244:247], a[172:175]
v_mfma_f32_16x16x32_bf16 a[168:171], v[200:203], v[244:247], a[168:171]
s_add_u32 s72, s70, 15360
buffer_load_dwordx4 v5, s[4:7], s72 offen offset:1024 lds
v_mfma_f32_16x16x32_bf16 a[164:167], v[196:199], v[244:247], a[164:167]
v_accvgpr_read_b32 v24, a4
v_accvgpr_read_b32 v28, a5
v_mfma_f32_16x16x32_bf16 a[160:163], v[192:195], v[244:247], a[160:163]
v_accvgpr_read_b32 v25, a6
v_accvgpr_read_b32 v29, a7
v_mfma_f32_16x16x32_bf16 a[192:195], v[192:195], v[248:251], a[192:195]
v_accvgpr_read_b32 v26, a36
v_accvgpr_read_b32 v30, a37
v_mfma_f32_16x16x32_bf16 a[196:199], v[196:199], v[248:251], a[196:199]
v_accvgpr_read_b32 v27, a38
v_accvgpr_read_b32 v31, a39
v_mfma_f32_16x16x32_bf16 a[200:203], v[200:203], v[248:251], a[200:203]
s_add_u32 s72, s70, 129024
buffer_load_dwordx4 v4, s[4:7], s72 offen offset:2048 lds
v_mfma_f32_16x16x32_bf16 a[204:207], v[204:207], v[248:251], a[204:207]
v_mul_f32 v24, s79, v24
v_mul_f32 v28, s79, v28
v_mfma_f32_16x16x32_bf16 a[208:211], v[208:211], v[248:251], a[208:211]
v_mul_f32 v25, s79, v25
v_mul_f32 v29, s79, v29
v_mfma_f32_16x16x32_bf16 a[212:215], v[212:215], v[248:251], a[212:215]
v_mul_f32 v26, s79, v26
v_mul_f32 v30, s79, v30
v_mfma_f32_16x16x32_bf16 a[216:219], v[216:219], v[248:251], a[216:219]
v_mul_f32 v27, s79, v27
v_mul_f32 v31, s79, v31
v_mfma_f32_16x16x32_bf16 a[220:223], v[220:223], v[248:251], a[220:223]
s_add_u32 s72, s70, 144384
buffer_load_dwordx4 v5, s[4:7], s72 offen offset:3072 lds
v_mfma_f32_16x16x32_bf16 a[252:255], v[220:223], v[252:255], a[252:255]
v_cvt_pk_bf16_f32 v24, v24, v28
v_cvt_pk_bf16_f32 v25, v25, v29
v_mfma_f32_16x16x32_bf16 a[248:251], v[216:219], v[252:255], a[248:251]
v_cvt_pk_bf16_f32 v26, v26, v30
v_cvt_pk_bf16_f32 v27, v27, v31
v_mfma_f32_16x16x32_bf16 a[244:247], v[212:215], v[252:255], a[244:247]
s_add_u32 s80, s77, 4096
buffer_store_dwordx4 v[24:27], v1, s[44:47], s80 offen sc1
v_mfma_f32_16x16x32_bf16 a[240:243], v[208:211], v[252:255], a[240:243]
v_mfma_f32_16x16x32_bf16 a[236:239], v[204:207], v[252:255], a[236:239]
v_mfma_f32_16x16x32_bf16 a[232:235], v[200:203], v[252:255], a[232:235]
v_mfma_f32_16x16x32_bf16 a[228:231], v[196:199], v[252:255], a[228:231]
v_mfma_f32_16x16x32_bf16 a[224:227], v[192:195], v[252:255], a[224:227]
s_waitcnt lgkmcnt(0)
v_mfma_f32_16x16x32_bf16 v[128:131], v[32:35], v[64:67], 0
ds_read_b64_tr_b16 v[80:81], v8 offset:8192
ds_read_b64_tr_b16 v[82:83], v8 offset:9216
v_mfma_f32_16x16x32_bf16 v[132:135], v[32:35], v[68:71], 0
ds_read_b128 v[112:115], v17 offset:0
ds_read_b128 v[116:119], v17 offset:2048
v_mfma_f32_16x16x32_bf16 v[136:139], v[32:35], v[72:75], 0
ds_read_b128 v[120:123], v17 offset:4096
ds_read_b128 v[124:127], v17 offset:6144
v_mfma_f32_16x16x32_bf16 v[140:143], v[32:35], v[76:79], 0
ds_read_b64_tr_b16 v[84:85], v9 offset:8192
ds_read_b64_tr_b16 v[86:87], v9 offset:9216
v_mfma_f32_16x16x32_bf16 v[156:159], v[36:39], v[76:79], 0
ds_read_b64_tr_b16 v[88:89], v10 offset:8192
v_accvgpr_read_b32 v20, a8
v_mfma_f32_16x16x32_bf16 v[152:155], v[36:39], v[72:75], 0
ds_read_b64_tr_b16 v[90:91], v10 offset:9216
v_accvgpr_read_b32 v28, a9
v_mfma_f32_16x16x32_bf16 v[148:151], v[36:39], v[68:71], 0
ds_read_b64_tr_b16 v[92:93], v11 offset:8192
v_accvgpr_read_b32 v21, a10
v_mfma_f32_16x16x32_bf16 v[144:147], v[36:39], v[64:67], 0
ds_read_b64_tr_b16 v[94:95], v11 offset:9216
v_accvgpr_read_b32 v29, a11
v_mfma_f32_16x16x32_bf16 v[160:163], v[40:43], v[64:67], 0
ds_read_b64_tr_b16 v[96:97], v12 offset:8192
v_accvgpr_read_b32 v22, a40
v_mfma_f32_16x16x32_bf16 v[164:167], v[40:43], v[68:71], 0
ds_read_b64_tr_b16 v[98:99], v12 offset:9216
v_accvgpr_read_b32 v30, a41
v_mfma_f32_16x16x32_bf16 v[168:171], v[40:43], v[72:75], 0
ds_read_b64_tr_b16 v[100:101], v13 offset:8192
v_accvgpr_read_b32 v23, a42
v_mfma_f32_16x16x32_bf16 v[172:175], v[40:43], v[76:79], 0
ds_read_b64_tr_b16 v[102:103], v13 offset:9216
v_accvgpr_read_b32 v31, a43
v_mfma_f32_16x16x32_bf16 v[188:191], v[44:47], v[76:79], 0
ds_read_b64_tr_b16 v[104:105], v14 offset:8192
v_mul_f32 v20, s79, v20
v_mfma_f32_16x16x32_bf16 v[184:187], v[44:47], v[72:75], 0
ds_read_b64_tr_b16 v[106:107], v14 offset:9216
v_mul_f32 v28, s79, v28
v_mfma_f32_16x16x32_bf16 v[180:183], v[44:47], v[68:71], 0
ds_read_b64_tr_b16 v[108:109], v15 offset:8192
v_mul_f32 v21, s79, v21
v_mfma_f32_16x16x32_bf16 v[176:179], v[44:47], v[64:67], 0
ds_read_b64_tr_b16 v[110:111], v15 offset:9216
v_mul_f32 v29, s79, v29
v_mfma_f32_16x16x32_bf16 v[192:195], v[48:51], v[64:67], 0
v_mul_f32 v22, s79, v22
v_mul_f32 v30, s79, v30
v_mfma_f32_16x16x32_bf16 v[196:199], v[48:51], v[68:71], 0
v_mul_f32 v23, s79, v23
v_mul_f32 v31, s79, v31
v_mfma_f32_16x16x32_bf16 v[200:203], v[48:51], v[72:75], 0
v_cvt_pk_bf16_f32 v20, v20, v28
v_cvt_pk_bf16_f32 v21, v21, v29
v_mfma_f32_16x16x32_bf16 v[204:207], v[48:51], v[76:79], 0
v_cvt_pk_bf16_f32 v22, v22, v30
v_cvt_pk_bf16_f32 v23, v23, v31
v_mfma_f32_16x16x32_bf16 v[220:223], v[52:55], v[76:79], 0
s_add_u32 s80, s77, 8192
buffer_store_dwordx4 v[20:23], v1, s[44:47], s80 offen sc1
v_mfma_f32_16x16x32_bf16 v[216:219], v[52:55], v[72:75], 0
v_mfma_f32_16x16x32_bf16 v[212:215], v[52:55], v[68:71], 0
v_accvgpr_read_b32 v24, a128
v_accvgpr_read_b32 v28, a129
v_mfma_f32_16x16x32_bf16 v[208:211], v[52:55], v[64:67], 0
v_accvgpr_read_b32 v25, a130
v_accvgpr_read_b32 v29, a131
v_mfma_f32_16x16x32_bf16 v[224:227], v[56:59], v[64:67], 0
v_accvgpr_read_b32 v26, a132
v_accvgpr_read_b32 v30, a133
v_mfma_f32_16x16x32_bf16 v[228:231], v[56:59], v[68:71], 0
v_accvgpr_read_b32 v27, a134
v_accvgpr_read_b32 v31, a135
v_mfma_f32_16x16x32_bf16 v[232:235], v[56:59], v[72:75], 0
v_cvt_pk_bf16_f32 v24, v24, v28
v_cvt_pk_bf16_f32 v25, v25, v29
v_mfma_f32_16x16x32_bf16 v[236:239], v[56:59], v[76:79], 0
v_cvt_pk_bf16_f32 v26, v26, v30
v_cvt_pk_bf16_f32 v27, v27, v31
v_mfma_f32_16x16x32_bf16 v[252:255], v[60:63], v[76:79], 0
s_add_u32 s80, s78, 0
buffer_store_dwordx4 v[24:27], v1, s[44:47], s80 offen sc1
v_mfma_f32_16x16x32_bf16 v[248:251], v[60:63], v[72:75], 0
v_mfma_f32_16x16x32_bf16 v[244:247], v[60:63], v[68:71], 0
s_waitcnt vmcnt(17) lgkmcnt(0)
v_mfma_f32_16x16x32_bf16 v[240:243], v[60:63], v[64:67], 0
s_barrier
v_mfma_f32_16x16x32_bf16 v[128:131], v[80:83], v[112:115], v[128:131]
s_add_u32 s73, s62, 3
ds_read_b64_tr_b16 v[32:33], v8 offset:16384
ds_read_b64_tr_b16 v[34:35], v8 offset:17408
v_mfma_f32_16x16x32_bf16 v[132:135], v[80:83], v[116:119], v[132:135]
s_add_u32 s70, s73, s65
ds_read_b128 v[64:67], v18 offset:0
ds_read_b128 v[68:71], v18 offset:2048
v_mfma_f32_16x16x32_bf16 v[136:139], v[80:83], v[120:123], v[136:139]
s_and_b32 s70, s70, 3
ds_read_b128 v[72:75], v18 offset:4096
ds_read_b128 v[76:79], v18 offset:6144
v_mfma_f32_16x16x32_bf16 v[140:143], v[80:83], v[124:127], v[140:143]
s_and_b32 s73, s73, 12
ds_read_b64_tr_b16 v[36:37], v9 offset:16384
ds_read_b64_tr_b16 v[38:39], v9 offset:17408
v_mfma_f32_16x16x32_bf16 v[156:159], v[84:87], v[124:127], v[156:159]
s_or_b32 s73, s73, s70
ds_read_b64_tr_b16 v[40:41], v10 offset:16384
v_mfma_f32_16x16x32_bf16 v[152:155], v[84:87], v[120:123], v[152:155]
s_lshl_b32 s71, s73, 19
ds_read_b64_tr_b16 v[42:43], v10 offset:17408
v_mfma_f32_16x16x32_bf16 v[148:151], v[84:87], v[116:119], v[148:151]
s_add_u32 s71, s71, s66
ds_read_b64_tr_b16 v[44:45], v11 offset:16384
v_mfma_f32_16x16x32_bf16 v[144:147], v[84:87], v[112:115], v[144:147]
s_lshl_b32 s73, s73, 7
ds_read_b64_tr_b16 v[46:47], v11 offset:17408
v_mfma_f32_16x16x32_bf16 v[160:163], v[88:91], v[112:115], v[160:163]
s_add_u32 s69, s73, s67
ds_read_b64_tr_b16 v[48:49], v12 offset:16384
v_mfma_f32_16x16x32_bf16 v[164:167], v[88:91], v[116:119], v[164:167]
s_add_u32 s70, s73, s68
ds_read_b64_tr_b16 v[50:51], v12 offset:17408
v_mfma_f32_16x16x32_bf16 v[168:171], v[88:91], v[120:123], v[168:171]
s_add_u32 m0, s64, 0
ds_read_b64_tr_b16 v[52:53], v13 offset:16384
v_mfma_f32_16x16x32_bf16 v[172:175], v[88:91], v[124:127], v[172:175]
s_add_u32 s72, s71, 0
buffer_load_dwordx4 v6, s[12:15], s72 offen lds
v_mfma_f32_16x16x32_bf16 v[188:191], v[92:95], v[124:127], v[188:191]
s_add_u32 s72, s71, 31744
buffer_load_dwordx4 v6, s[12:15], s72 offen offset:1024 lds
v_mfma_f32_16x16x32_bf16 v[184:187], v[92:95], v[120:123], v[184:187]
s_add_u32 s72, s71, 63488
buffer_load_dwordx4 v7, s[12:15], s72 offen offset:2048 lds
v_mfma_f32_16x16x32_bf16 v[180:183], v[92:95], v[116:119], v[180:183]
s_add_u32 s72, s71, 95232
buffer_load_dwordx4 v7, s[12:15], s72 offen offset:3072 lds
v_mfma_f32_16x16x32_bf16 v[176:179], v[92:95], v[112:115], v[176:179]
ds_read_b64_tr_b16 v[54:55], v13 offset:17408
v_accvgpr_read_b32 v20, a12
v_mfma_f32_16x16x32_bf16 v[192:195], v[96:99], v[112:115], v[192:195]
ds_read_b64_tr_b16 v[56:57], v14 offset:16384
v_accvgpr_read_b32 v28, a13
v_mfma_f32_16x16x32_bf16 v[196:199], v[96:99], v[116:119], v[196:199]
ds_read_b64_tr_b16 v[58:59], v14 offset:17408
v_accvgpr_read_b32 v21, a14
v_mfma_f32_16x16x32_bf16 v[200:203], v[96:99], v[120:123], v[200:203]
ds_read_b64_tr_b16 v[60:61], v15 offset:16384
v_accvgpr_read_b32 v29, a15
v_mfma_f32_16x16x32_bf16 v[204:207], v[96:99], v[124:127], v[204:207]
s_add_u32 m0, s63, 131072
ds_read_b64_tr_b16 v[62:63], v15 offset:17408
v_accvgpr_read_b32 v22, a44
v_mfma_f32_16x16x32_bf16 v[220:223], v[100:103], v[124:127], v[220:223]
s_add_u32 s72, s69, 0
buffer_load_dwordx4 v4, s[4:7], s72 offen lds
v_mfma_f32_16x16x32_bf16 v[216:219], v[100:103], v[120:123], v[216:219]
v_accvgpr_read_b32 v30, a45
v_accvgpr_read_b32 v23, a46
v_mfma_f32_16x16x32_bf16 v[212:215], v[100:103], v[116:119], v[212:215]
v_accvgpr_read_b32 v31, a47
v_mul_f32 v20, s79, v20
v_mfma_f32_16x16x32_bf16 v[208:211], v[100:103], v[112:115], v[208:211]
v_mul_f32 v28, s79, v28
v_mul_f32 v21, s79, v21
v_mfma_f32_16x16x32_bf16 v[224:227], v[104:107], v[112:115], v[224:227]
s_add_u32 s72, s69, 15360
buffer_load_dwordx4 v5, s[4:7], s72 offen offset:1024 lds
v_mfma_f32_16x16x32_bf16 v[228:231], v[104:107], v[116:119], v[228:231]
v_mul_f32 v29, s79, v29
v_mul_f32 v22, s79, v22
v_mfma_f32_16x16x32_bf16 v[232:235], v[104:107], v[120:123], v[232:235]
v_mul_f32 v30, s79, v30
v_mul_f32 v23, s79, v23
v_mfma_f32_16x16x32_bf16 v[236:239], v[104:107], v[124:127], v[236:239]
v_mul_f32 v31, s79, v31
v_cvt_pk_bf16_f32 v20, v20, v28
v_mfma_f32_16x16x32_bf16 v[252:255], v[108:111], v[124:127], v[252:255]
v_cvt_pk_bf16_f32 v21, v21, v29
v_cvt_pk_bf16_f32 v22, v22, v30
v_mfma_f32_16x16x32_bf16 v[248:251], v[108:111], v[120:123], v[248:251]
s_add_u32 s72, s69, 129024
buffer_load_dwordx4 v4, s[4:7], s72 offen offset:2048 lds
v_mfma_f32_16x16x32_bf16 v[244:247], v[108:111], v[116:119], v[244:247]
v_cvt_pk_bf16_f32 v23, v23, v31
v_mfma_f32_16x16x32_bf16 v[240:243], v[108:111], v[112:115], v[240:243]
s_waitcnt lgkmcnt(0)
v_accvgpr_read_b32 v24, a136
v_accvgpr_read_b32 v28, a137
v_mfma_f32_16x16x32_bf16 v[128:131], v[32:35], v[64:67], v[128:131]
s_add_u32 s80, s77, 12288
ds_read_b64_tr_b16 v[80:81], v8 offset:24576
ds_read_b64_tr_b16 v[82:83], v8 offset:25600
v_mfma_f32_16x16x32_bf16 v[132:135], v[32:35], v[68:71], v[132:135]
ds_read_b128 v[112:115], v19 offset:0
ds_read_b128 v[116:119], v19 offset:2048
v_mfma_f32_16x16x32_bf16 v[136:139], v[32:35], v[72:75], v[136:139]
s_add_u32 s72, s69, 144384
buffer_load_dwordx4 v5, s[4:7], s72 offen offset:3072 lds
v_mfma_f32_16x16x32_bf16 v[140:143], v[32:35], v[76:79], v[140:143]
ds_read_b128 v[120:123], v19 offset:4096
ds_read_b128 v[124:127], v19 offset:6144
v_mfma_f32_16x16x32_bf16 v[156:159], v[36:39], v[76:79], v[156:159]
ds_read_b64_tr_b16 v[84:85], v9 offset:24576
ds_read_b64_tr_b16 v[86:87], v9 offset:25600
v_mfma_f32_16x16x32_bf16 v[152:155], v[36:39], v[72:75], v[152:155]
ds_read_b64_tr_b16 v[88:89], v10 offset:24576
v_accvgpr_read_b32 v25, a138
v_mfma_f32_16x16x32_bf16 v[148:151], v[36:39], v[68:71], v[148:151]
ds_read_b64_tr_b16 v[90:91], v10 offset:25600
v_accvgpr_read_b32 v29, a139
v_mfma_f32_16x16x32_bf16 v[144:147], v[36:39], v[64:67], v[144:147]
s_add_u32 m0, s63, 135168
ds_read_b64_tr_b16 v[92:93], v11 offset:24576
v_accvgpr_read_b32 v26, a140
v_mfma_f32_16x16x32_bf16 v[160:163], v[40:43], v[64:67], v[160:163]
s_add_u32 s72, s70, 0
buffer_load_dwordx4 v4, s[4:7], s72 offen lds
v_mfma_f32_16x16x32_bf16 v[164:167], v[40:43], v[68:71], v[164:167]
ds_read_b64_tr_b16 v[94:95], v11 offset:25600
v_accvgpr_read_b32 v30, a141
v_mfma_f32_16x16x32_bf16 v[168:171], v[40:43], v[72:75], v[168:171]
ds_read_b64_tr_b16 v[96:97], v12 offset:24576
v_accvgpr_read_b32 v27, a142
v_mfma_f32_16x16x32_bf16 v[172:175], v[40:43], v[76:79], v[172:175]
ds_read_b64_tr_b16 v[98:99], v12 offset:25600
v_accvgpr_read_b32 v31, a143
v_mfma_f32_16x16x32_bf16 v[188:191], v[44:47], v[76:79], v[188:191]
s_add_u32 s72, s70, 15360
buffer_load_dwordx4 v5, s[4:7], s72 offen offset:1024 lds
v_mfma_f32_16x16x32_bf16 v[184:187], v[44:47], v[72:75], v[184:187]
ds_read_b64_tr_b16 v[100:101], v13 offset:24576
v_cvt_pk_bf16_f32 v24, v24, v28
v_mfma_f32_16x16x32_bf16 v[180:183], v[44:47], v[68:71], v[180:183]
ds_read_b64_tr_b16 v[102:103], v13 offset:25600
v_cvt_pk_bf16_f32 v25, v25, v29
v_mfma_f32_16x16x32_bf16 v[176:179], v[44:47], v[64:67], v[176:179]
ds_read_b64_tr_b16 v[104:105], v14 offset:24576
v_cvt_pk_bf16_f32 v26, v26, v30
v_mfma_f32_16x16x32_bf16 v[192:195], v[48:51], v[64:67], v[192:195]
ds_read_b64_tr_b16 v[106:107], v14 offset:25600
v_cvt_pk_bf16_f32 v27, v27, v31
v_mfma_f32_16x16x32_bf16 v[196:199], v[48:51], v[68:71], v[196:199]
s_add_u32 s72, s70, 129024
buffer_load_dwordx4 v4, s[4:7], s72 offen offset:2048 lds
v_mfma_f32_16x16x32_bf16 v[200:203], v[48:51], v[72:75], v[200:203]
ds_read_b64_tr_b16 v[108:109], v15 offset:24576
v_mfma_f32_16x16x32_bf16 v[204:207], v[48:51], v[76:79], v[204:207]
ds_read_b64_tr_b16 v[110:111], v15 offset:25600
v_mfma_f32_16x16x32_bf16 v[220:223], v[52:55], v[76:79], v[220:223]
buffer_store_dwordx4 v[20:23], v1, s[44:47], s80 offen sc1
v_mfma_f32_16x16x32_bf16 v[216:219], v[52:55], v[72:75], v[216:219]
s_add_u32 s80, s78, 8192
buffer_store_dwordx4 v[24:27], v1, s[44:47], s80 offen sc1
v_mfma_f32_16x16x32_bf16 v[212:215], v[52:55], v[68:71], v[212:215]
s_add_u32 s72, s70, 144384
buffer_load_dwordx4 v5, s[4:7], s72 offen offset:3072 lds
v_mfma_f32_16x16x32_bf16 v[208:211], v[52:55], v[64:67], v[208:211]
v_accvgpr_read_b32 v20, a16
v_accvgpr_read_b32 v28, a17
v_mfma_f32_16x16x32_bf16 v[224:227], v[56:59], v[64:67], v[224:227]
v_accvgpr_read_b32 v21, a18
v_accvgpr_read_b32 v29, a19
v_mfma_f32_16x16x32_bf16 v[228:231], v[56:59], v[68:71], v[228:231]
v_accvgpr_read_b32 v22, a48
v_accvgpr_read_b32 v30, a49
v_mfma_f32_16x16x32_bf16 v[232:235], v[56:59], v[72:75], v[232:235]
v_accvgpr_read_b32 v23, a50
v_accvgpr_read_b32 v31, a51
v_mfma_f32_16x16x32_bf16 v[236:239], v[56:59], v[76:79], v[236:239]
v_mul_f32 v20, s79, v20
v_mul_f32 v28, s79, v28
v_mfma_f32_16x16x32_bf16 v[252:255], v[60:63], v[76:79], v[252:255]
v_mul_f32 v21, s79, v21
v_mul_f32 v29, s79, v29
v_mfma_f32_16x16x32_bf16 v[248:251], v[60:63], v[72:75], v[248:251]
v_mul_f32 v22, s79, v22
v_mul_f32 v30, s79, v30
v_mfma_f32_16x16x32_bf16 v[244:247], v[60:63], v[68:71], v[244:247]
s_waitcnt vmcnt(17) lgkmcnt(0)
v_mul_f32 v23, s79, v23
v_mul_f32 v31, s79, v31
v_mfma_f32_16x16x32_bf16 v[240:243], v[60:63], v[64:67], v[240:243]
s_barrier
v_cvt_pk_bf16_f32 v20, v20, v28
v_cvt_pk_bf16_f32 v21, v21, v29
v_mfma_f32_16x16x32_bf16 v[128:131], v[80:83], v[112:115], v[128:131]
s_add_u32 s73, s62, 4
ds_read_b64_tr_b16 v[32:33], v8 offset:32768
ds_read_b64_tr_b16 v[34:35], v8 offset:33792
v_mfma_f32_16x16x32_bf16 v[132:135], v[80:83], v[116:119], v[132:135]
s_add_u32 s70, s73, s65
ds_read_b128 v[64:67], v18 offset:32768
ds_read_b128 v[68:71], v18 offset:34816
v_mfma_f32_16x16x32_bf16 v[136:139], v[80:83], v[120:123], v[136:139]
s_and_b32 s70, s70, 3
ds_read_b128 v[72:75], v18 offset:36864
ds_read_b128 v[76:79], v18 offset:38912
v_mfma_f32_16x16x32_bf16 v[140:143], v[80:83], v[124:127], v[140:143]
s_and_b32 s73, s73, 12
ds_read_b64_tr_b16 v[36:37], v9 offset:32768
ds_read_b64_tr_b16 v[38:39], v9 offset:33792
v_mfma_f32_16x16x32_bf16 v[156:159], v[84:87], v[124:127], v[156:159]
s_or_b32 s73, s73, s70
ds_read_b64_tr_b16 v[40:41], v10 offset:32768
v_cvt_pk_bf16_f32 v22, v22, v30
v_mfma_f32_16x16x32_bf16 v[152:155], v[84:87], v[120:123], v[152:155]
s_lshl_b32 s71, s73, 19
ds_read_b64_tr_b16 v[42:43], v10 offset:33792
v_cvt_pk_bf16_f32 v23, v23, v31
v_mfma_f32_16x16x32_bf16 v[148:151], v[84:87], v[116:119], v[148:151]
s_add_u32 s71, s71, s66
ds_read_b64_tr_b16 v[44:45], v11 offset:32768
v_mfma_f32_16x16x32_bf16 v[144:147], v[84:87], v[112:115], v[144:147]
s_lshl_b32 s73, s73, 7
ds_read_b64_tr_b16 v[46:47], v11 offset:33792
v_accvgpr_read_b32 v24, a144
v_mfma_f32_16x16x32_bf16 v[160:163], v[88:91], v[112:115], v[160:163]
s_add_u32 s69, s73, s67
ds_read_b64_tr_b16 v[48:49], v12 offset:32768
v_accvgpr_read_b32 v28, a145
v_mfma_f32_16x16x32_bf16 v[164:167], v[88:91], v[116:119], v[164:167]
s_add_u32 s70, s73, s68
ds_read_b64_tr_b16 v[50:51], v12 offset:33792
v_accvgpr_read_b32 v25, a146
v_mfma_f32_16x16x32_bf16 v[168:171], v[88:91], v[120:123], v[168:171]
s_add_u32 m0, s64, 16384
ds_read_b64_tr_b16 v[52:53], v13 offset:32768
v_accvgpr_read_b32 v29, a147
v_mfma_f32_16x16x32_bf16 v[172:175], v[88:91], v[124:127], v[172:175]
s_add_u32 s72, s71, 0
buffer_load_dwordx4 v6, s[12:15], s72 offen lds
v_mfma_f32_16x16x32_bf16 v[188:191], v[92:95], v[124:127], v[188:191]
s_add_u32 s72, s71, 31744
buffer_load_dwordx4 v6, s[12:15], s72 offen offset:1024 lds
v_mfma_f32_16x16x32_bf16 v[184:187], v[92:95], v[120:123], v[184:187]
s_add_u32 s72, s71, 63488
buffer_load_dwordx4 v7, s[12:15], s72 offen offset:2048 lds
v_mfma_f32_16x16x32_bf16 v[180:183], v[92:95], v[116:119], v[180:183]
s_add_u32 s72, s71, 95232
buffer_load_dwordx4 v7, s[12:15], s72 offen offset:3072 lds
v_mfma_f32_16x16x32_bf16 v[176:179], v[92:95], v[112:115], v[176:179]
s_add_u32 s80, s77, 32768
ds_read_b64_tr_b16 v[54:55], v13 offset:33792
v_accvgpr_read_b32 v26, a148
v_mfma_f32_16x16x32_bf16 v[192:195], v[96:99], v[112:115], v[192:195]
ds_read_b64_tr_b16 v[56:57], v14 offset:32768
v_accvgpr_read_b32 v30, a149
v_mfma_f32_16x16x32_bf16 v[196:199], v[96:99], v[116:119], v[196:199]
ds_read_b64_tr_b16 v[58:59], v14 offset:33792
v_accvgpr_read_b32 v27, a150
v_mfma_f32_16x16x32_bf16 v[200:203], v[96:99], v[120:123], v[200:203]
ds_read_b64_tr_b16 v[60:61], v15 offset:32768
v_accvgpr_read_b32 v31, a151
v_mfma_f32_16x16x32_bf16 v[204:207], v[96:99], v[124:127], v[204:207]
s_add_u32 m0, s63, 65536
ds_read_b64_tr_b16 v[62:63], v15 offset:33792
v_cvt_pk_bf16_f32 v24, v24, v28
v_mfma_f32_16x16x32_bf16 v[220:223], v[100:103], v[124:127], v[220:223]
s_add_u32 s72, s69, 0
buffer_load_dwordx4 v4, s[4:7], s72 offen lds
v_mfma_f32_16x16x32_bf16 v[216:219], v[100:103], v[120:123], v[216:219]
buffer_store_dwordx4 v[20:23], v1, s[44:47], s80 offen sc1
v_mfma_f32_16x16x32_bf16 v[212:215], v[100:103], v[116:119], v[212:215]
v_cvt_pk_bf16_f32 v25, v25, v29
v_cvt_pk_bf16_f32 v26, v26, v30
v_mfma_f32_16x16x32_bf16 v[208:211], v[100:103], v[112:115], v[208:211]
v_cvt_pk_bf16_f32 v27, v27, v31
v_mfma_f32_16x16x32_bf16 v[224:227], v[104:107], v[112:115], v[224:227]
s_add_u32 s72, s69, 15360
buffer_load_dwordx4 v5, s[4:7], s72 offen offset:1024 lds
v_mfma_f32_16x16x32_bf16 v[228:231], v[104:107], v[116:119], v[228:231]
s_add_u32 s80, s78, 32768
buffer_store_dwordx4 v[24:27], v1, s[44:47], s80 offen sc1
v_mfma_f32_16x16x32_bf16 v[232:235], v[104:107], v[120:123], v[232:235]
v_mfma_f32_16x16x32_bf16 v[236:239], v[104:107], v[124:127], v[236:239]
v_mfma_f32_16x16x32_bf16 v[252:255], v[108:111], v[124:127], v[252:255]
v_accvgpr_read_b32 v20, a20
v_accvgpr_read_b32 v28, a21
v_mfma_f32_16x16x32_bf16 v[248:251], v[108:111], v[120:123], v[248:251]
s_add_u32 s72, s69, 129024
buffer_load_dwordx4 v4, s[4:7], s72 offen offset:2048 lds
v_mfma_f32_16x16x32_bf16 v[244:247], v[108:111], v[116:119], v[244:247]
v_accvgpr_read_b32 v21, a22
v_accvgpr_read_b32 v29, a23
v_mfma_f32_16x16x32_bf16 v[240:243], v[108:111], v[112:115], v[240:243]
s_waitcnt lgkmcnt(0)
v_accvgpr_read_b32 v22, a52
v_accvgpr_read_b32 v30, a53
v_mfma_f32_16x16x32_bf16 v[128:131], v[32:35], v[64:67], v[128:131]
ds_read_b64_tr_b16 v[80:81], v8 offset:40960
ds_read_b64_tr_b16 v[82:83], v8 offset:41984
v_mfma_f32_16x16x32_bf16 v[132:135], v[32:35], v[68:71], v[132:135]
ds_read_b128 v[112:115], v19 offset:32768
ds_read_b128 v[116:119], v19 offset:34816
v_mfma_f32_16x16x32_bf16 v[136:139], v[32:35], v[72:75], v[136:139]
s_add_u32 s72, s69, 144384
buffer_load_dwordx4 v5, s[4:7], s72 offen offset:3072 lds
v_mfma_f32_16x16x32_bf16 v[140:143], v[32:35], v[76:79], v[140:143]
ds_read_b128 v[120:123], v19 offset:36864
ds_read_b128 v[124:127], v19 offset:38912
v_mfma_f32_16x16x32_bf16 v[156:159], v[36:39], v[76:79], v[156:159]
ds_read_b64_tr_b16 v[84:85], v9 offset:40960
ds_read_b64_tr_b16 v[86:87], v9 offset:41984
v_mfma_f32_16x16x32_bf16 v[152:155], v[36:39], v[72:75], v[152:155]
ds_read_b64_tr_b16 v[88:89], v10 offset:40960
v_accvgpr_read_b32 v23, a54
v_mfma_f32_16x16x32_bf16 v[148:151], v[36:39], v[68:71], v[148:151]
ds_read_b64_tr_b16 v[90:91], v10 offset:41984
v_accvgpr_read_b32 v31, a55
v_mfma_f32_16x16x32_bf16 v[144:147], v[36:39], v[64:67], v[144:147]
s_add_u32 m0, s63, 69632
ds_read_b64_tr_b16 v[92:93], v11 offset:40960
v_mul_f32 v20, s79, v20
v_mfma_f32_16x16x32_bf16 v[160:163], v[40:43], v[64:67], v[160:163]
s_add_u32 s72, s70, 0
buffer_load_dwordx4 v4, s[4:7], s72 offen lds
v_mfma_f32_16x16x32_bf16 v[164:167], v[40:43], v[68:71], v[164:167]
ds_read_b64_tr_b16 v[94:95], v11 offset:41984
v_mul_f32 v28, s79, v28
v_mfma_f32_16x16x32_bf16 v[168:171], v[40:43], v[72:75], v[168:171]
ds_read_b64_tr_b16 v[96:97], v12 offset:40960
v_mul_f32 v21, s79, v21
v_mfma_f32_16x16x32_bf16 v[172:175], v[40:43], v[76:79], v[172:175]
ds_read_b64_tr_b16 v[98:99], v12 offset:41984
v_mul_f32 v29, s79, v29
v_mfma_f32_16x16x32_bf16 v[188:191], v[44:47], v[76:79], v[188:191]
s_add_u32 s72, s70, 15360
buffer_load_dwordx4 v5, s[4:7], s72 offen offset:1024 lds
v_mfma_f32_16x16x32_bf16 v[184:187], v[44:47], v[72:75], v[184:187]
ds_read_b64_tr_b16 v[100:101], v13 offset:40960
v_mul_f32 v22, s79, v22
v_mfma_f32_16x16x32_bf16 v[180:183], v[44:47], v[68:71], v[180:183]
ds_read_b64_tr_b16 v[102:103], v13 offset:41984
v_mul_f32 v30, s79, v30
v_mfma_f32_16x16x32_bf16 v[176:179], v[44:47], v[64:67], v[176:179]
ds_read_b64_tr_b16 v[104:105], v14 offset:40960
v_mul_f32 v23, s79, v23
v_mfma_f32_16x16x32_bf16 v[192:195], v[48:51], v[64:67], v[192:195]
ds_read_b64_tr_b16 v[106:107], v14 offset:41984
v_mul_f32 v31, s79, v31
v_mfma_f32_16x16x32_bf16 v[196:199], v[48:51], v[68:71], v[196:199]
s_add_u32 s72, s70, 129024
buffer_load_dwordx4 v4, s[4:7], s72 offen offset:2048 lds
v_mfma_f32_16x16x32_bf16 v[200:203], v[48:51], v[72:75], v[200:203]
ds_read_b64_tr_b16 v[108:109], v15 offset:40960
v_cvt_pk_bf16_f32 v20, v20, v28
v_mfma_f32_16x16x32_bf16 v[204:207], v[48:51], v[76:79], v[204:207]
ds_read_b64_tr_b16 v[110:111], v15 offset:41984
v_cvt_pk_bf16_f32 v21, v21, v29
v_mfma_f32_16x16x32_bf16 v[220:223], v[52:55], v[76:79], v[220:223]
v_cvt_pk_bf16_f32 v22, v22, v30
v_cvt_pk_bf16_f32 v23, v23, v31
v_mfma_f32_16x16x32_bf16 v[216:219], v[52:55], v[72:75], v[216:219]
s_add_u32 s80, s77, 36864
buffer_store_dwordx4 v[20:23], v1, s[44:47], s80 offen sc1
v_mfma_f32_16x16x32_bf16 v[212:215], v[52:55], v[68:71], v[212:215]
s_add_u32 s72, s70, 144384
buffer_load_dwordx4 v5, s[4:7], s72 offen offset:3072 lds
v_mfma_f32_16x16x32_bf16 v[208:211], v[52:55], v[64:67], v[208:211]
v_accvgpr_read_b32 v24, a152
v_accvgpr_read_b32 v28, a153
v_mfma_f32_16x16x32_bf16 v[224:227], v[56:59], v[64:67], v[224:227]
v_accvgpr_read_b32 v25, a154
v_accvgpr_read_b32 v29, a155
v_mfma_f32_16x16x32_bf16 v[228:231], v[56:59], v[68:71], v[228:231]
v_accvgpr_read_b32 v26, a156
v_accvgpr_read_b32 v30, a157
v_mfma_f32_16x16x32_bf16 v[232:235], v[56:59], v[72:75], v[232:235]
v_accvgpr_read_b32 v27, a158
v_accvgpr_read_b32 v31, a159
v_mfma_f32_16x16x32_bf16 v[236:239], v[56:59], v[76:79], v[236:239]
v_cvt_pk_bf16_f32 v24, v24, v28
v_cvt_pk_bf16_f32 v25, v25, v29
v_mfma_f32_16x16x32_bf16 v[252:255], v[60:63], v[76:79], v[252:255]
v_cvt_pk_bf16_f32 v26, v26, v30
v_cvt_pk_bf16_f32 v27, v27, v31
v_mfma_f32_16x16x32_bf16 v[248:251], v[60:63], v[72:75], v[248:251]
s_add_u32 s80, s78, 40960
buffer_store_dwordx4 v[24:27], v1, s[44:47], s80 offen sc1
v_mfma_f32_16x16x32_bf16 v[244:247], v[60:63], v[68:71], v[244:247]
s_waitcnt vmcnt(16) lgkmcnt(0)
v_mfma_f32_16x16x32_bf16 v[240:243], v[60:63], v[64:67], v[240:243]
s_barrier
v_mfma_f32_16x16x32_bf16 v[128:131], v[80:83], v[112:115], v[128:131]
s_add_u32 s73, s62, 5
ds_read_b64_tr_b16 v[32:33], v8 offset:0
ds_read_b64_tr_b16 v[34:35], v8 offset:1024
v_mfma_f32_16x16x32_bf16 v[132:135], v[80:83], v[116:119], v[132:135]
s_add_u32 s70, s73, s65
ds_read_b128 v[64:67], v16 offset:0
ds_read_b128 v[68:71], v16 offset:2048
v_mfma_f32_16x16x32_bf16 v[136:139], v[80:83], v[120:123], v[136:139]
s_and_b32 s70, s70, 3
ds_read_b128 v[72:75], v16 offset:4096
ds_read_b128 v[76:79], v16 offset:6144
v_mfma_f32_16x16x32_bf16 v[140:143], v[80:83], v[124:127], v[140:143]
s_and_b32 s73, s73, 12
ds_read_b64_tr_b16 v[36:37], v9 offset:0
ds_read_b64_tr_b16 v[38:39], v9 offset:1024
v_mfma_f32_16x16x32_bf16 v[156:159], v[84:87], v[124:127], v[156:159]
s_or_b32 s73, s73, s70
ds_read_b64_tr_b16 v[40:41], v10 offset:0
v_accvgpr_read_b32 v20, a24
v_mfma_f32_16x16x32_bf16 v[152:155], v[84:87], v[120:123], v[152:155]
s_lshl_b32 s71, s73, 19
ds_read_b64_tr_b16 v[42:43], v10 offset:1024
v_accvgpr_read_b32 v28, a25
v_mfma_f32_16x16x32_bf16 v[148:151], v[84:87], v[116:119], v[148:151]
s_add_u32 s71, s71, s66
ds_read_b64_tr_b16 v[44:45], v11 offset:0
v_accvgpr_read_b32 v21, a26
v_mfma_f32_16x16x32_bf16 v[144:147], v[84:87], v[112:115], v[144:147]
s_lshl_b32 s73, s73, 7
ds_read_b64_tr_b16 v[46:47], v11 offset:1024
v_accvgpr_read_b32 v29, a27
v_mfma_f32_16x16x32_bf16 v[160:163], v[88:91], v[112:115], v[160:163]
s_add_u32 s69, s73, s67
ds_read_b64_tr_b16 v[48:49], v12 offset:0
v_accvgpr_read_b32 v22, a56
v_mfma_f32_16x16x32_bf16 v[164:167], v[88:91], v[116:119], v[164:167]
s_add_u32 s70, s73, s68
ds_read_b64_tr_b16 v[50:51], v12 offset:1024
v_accvgpr_read_b32 v30, a57
v_mfma_f32_16x16x32_bf16 v[168:171], v[88:91], v[120:123], v[168:171]
s_add_u32 m0, s64, 32768
ds_read_b64_tr_b16 v[52:53], v13 offset:0
v_accvgpr_read_b32 v23, a58
v_mfma_f32_16x16x32_bf16 v[172:175], v[88:91], v[124:127], v[172:175]
s_add_u32 s72, s71, 0
buffer_load_dwordx4 v6, s[12:15], s72 offen lds
v_mfma_f32_16x16x32_bf16 v[188:191], v[92:95], v[124:127], v[188:191]
s_add_u32 s72, s71, 31744
buffer_load_dwordx4 v6, s[12:15], s72 offen offset:1024 lds
v_mfma_f32_16x16x32_bf16 v[184:187], v[92:95], v[120:123], v[184:187]
s_add_u32 s72, s71, 63488
buffer_load_dwordx4 v7, s[12:15], s72 offen offset:2048 lds
v_mfma_f32_16x16x32_bf16 v[180:183], v[92:95], v[116:119], v[180:183]
s_add_u32 s72, s71, 95232
buffer_load_dwordx4 v7, s[12:15], s72 offen offset:3072 lds
v_mfma_f32_16x16x32_bf16 v[176:179], v[92:95], v[112:115], v[176:179]
ds_read_b64_tr_b16 v[54:55], v13 offset:1024
v_accvgpr_read_b32 v31, a59
v_mfma_f32_16x16x32_bf16 v[192:195], v[96:99], v[112:115], v[192:195]
ds_read_b64_tr_b16 v[56:57], v14 offset:0
v_mul_f32 v20, s79, v20
v_mfma_f32_16x16x32_bf16 v[196:199], v[96:99], v[116:119], v[196:199]
ds_read_b64_tr_b16 v[58:59], v14 offset:1024
v_mul_f32 v28, s79, v28
v_mfma_f32_16x16x32_bf16 v[200:203], v[96:99], v[120:123], v[200:203]
ds_read_b64_tr_b16 v[60:61], v15 offset:0
v_mul_f32 v21, s79, v21
v_mfma_f32_16x16x32_bf16 v[204:207], v[96:99], v[124:127], v[204:207]
s_add_u32 m0, s63, 98304
ds_read_b64_tr_b16 v[62:63], v15 offset:1024
v_mul_f32 v29, s79, v29
v_mfma_f32_16x16x32_bf16 v[220:223], v[100:103], v[124:127], v[220:223]
s_add_u32 s72, s69, 0
buffer_load_dwordx4 v4, s[4:7], s72 offen lds
v_mfma_f32_16x16x32_bf16 v[216:219], v[100:103], v[120:123], v[216:219]
v_mul_f32 v22, s79, v22
v_mul_f32 v30, s79, v30
v_mfma_f32_16x16x32_bf16 v[212:215], v[100:103], v[116:119], v[212:215]
v_mul_f32 v23, s79, v23
v_mul_f32 v31, s79, v31
v_mfma_f32_16x16x32_bf16 v[208:211], v[100:103], v[112:115], v[208:211]
v_cvt_pk_bf16_f32 v20, v20, v28
v_cvt_pk_bf16_f32 v21, v21, v29
v_mfma_f32_16x16x32_bf16 v[224:227], v[104:107], v[112:115], v[224:227]
s_add_u32 s72, s69, 15360
buffer_load_dwordx4 v5, s[4:7], s72 offen offset:1024 lds
v_mfma_f32_16x16x32_bf16 v[228:231], v[104:107], v[116:119], v[228:231]
v_cvt_pk_bf16_f32 v22, v22, v30
v_cvt_pk_bf16_f32 v23, v23, v31
v_mfma_f32_16x16x32_bf16 v[232:235], v[104:107], v[120:123], v[232:235]
s_add_u32 s80, s77, 40960
buffer_store_dwordx4 v[20:23], v1, s[44:47], s80 offen sc1
v_mfma_f32_16x16x32_bf16 v[236:239], v[104:107], v[124:127], v[236:239]
v_accvgpr_read_b32 v24, a160
v_accvgpr_read_b32 v28, a161
v_mfma_f32_16x16x32_bf16 v[252:255], v[108:111], v[124:127], v[252:255]
v_accvgpr_read_b32 v25, a162
v_accvgpr_read_b32 v29, a163
v_mfma_f32_16x16x32_bf16 v[248:251], v[108:111], v[120:123], v[248:251]
s_add_u32 s72, s69, 129024
buffer_load_dwordx4 v4, s[4:7], s72 offen offset:2048 lds
v_mfma_f32_16x16x32_bf16 v[244:247], v[108:111], v[116:119], v[244:247]
v_accvgpr_read_b32 v26, a164
v_accvgpr_read_b32 v30, a165
v_mfma_f32_16x16x32_bf16 v[240:243], v[108:111], v[112:115], v[240:243]
s_waitcnt lgkmcnt(0)
v_accvgpr_read_b32 v27, a166
v_accvgpr_read_b32 v31, a167
v_mfma_f32_16x16x32_bf16 v[128:131], v[32:35], v[64:67], v[128:131]
ds_read_b64_tr_b16 v[80:81], v8 offset:8192
ds_read_b64_tr_b16 v[82:83], v8 offset:9216
v_mfma_f32_16x16x32_bf16 v[132:135], v[32:35], v[68:71], v[132:135]
ds_read_b128 v[112:115], v17 offset:0
ds_read_b128 v[116:119], v17 offset:2048
v_mfma_f32_16x16x32_bf16 v[136:139], v[32:35], v[72:75], v[136:139]
s_add_u32 s72, s69, 144384
buffer_load_dwordx4 v5, s[4:7], s72 offen offset:3072 lds
v_mfma_f32_16x16x32_bf16 v[140:143], v[32:35], v[76:79], v[140:143]
ds_read_b128 v[120:123], v17 offset:4096
ds_read_b128 v[124:127], v17 offset:6144
v_mfma_f32_16x16x32_bf16 v[156:159], v[36:39], v[76:79], v[156:159]
ds_read_b64_tr_b16 v[84:85], v9 offset:8192
ds_read_b64_tr_b16 v[86:87], v9 offset:9216
v_mfma_f32_16x16x32_bf16 v[152:155], v[36:39], v[72:75], v[152:155]
ds_read_b64_tr_b16 v[88:89], v10 offset:8192
v_cvt_pk_bf16_f32 v24, v24, v28
v_mfma_f32_16x16x32_bf16 v[148:151], v[36:39], v[68:71], v[148:151]
ds_read_b64_tr_b16 v[90:91], v10 offset:9216
v_cvt_pk_bf16_f32 v25, v25, v29
v_mfma_f32_16x16x32_bf16 v[144:147], v[36:39], v[64:67], v[144:147]
s_add_u32 m0, s63, 102400
ds_read_b64_tr_b16 v[92:93], v11 offset:8192
v_cvt_pk_bf16_f32 v26, v26, v30
v_mfma_f32_16x16x32_bf16 v[160:163], v[40:43], v[64:67], v[160:163]
s_add_u32 s72, s70, 0
buffer_load_dwordx4 v4, s[4:7], s72 offen lds
v_mfma_f32_16x16x32_bf16 v[164:167], v[40:43], v[68:71], v[164:167]
ds_read_b64_tr_b16 v[94:95], v11 offset:9216
v_cvt_pk_bf16_f32 v27, v27, v31
v_mfma_f32_16x16x32_bf16 v[168:171], v[40:43], v[72:75], v[168:171]
s_add_u32 s80, s78, 1024
ds_read_b64_tr_b16 v[96:97], v12 offset:8192
v_mfma_f32_16x16x32_bf16 v[172:175], v[40:43], v[76:79], v[172:175]
ds_read_b64_tr_b16 v[98:99], v12 offset:9216
v_mfma_f32_16x16x32_bf16 v[188:191], v[44:47], v[76:79], v[188:191]
s_add_u32 s72, s70, 15360
buffer_load_dwordx4 v5, s[4:7], s72 offen offset:1024 lds
v_mfma_f32_16x16x32_bf16 v[184:187], v[44:47], v[72:75], v[184:187]
ds_read_b64_tr_b16 v[100:101], v13 offset:8192
v_accvgpr_read_b32 v20, a28
v_mfma_f32_16x16x32_bf16 v[180:183], v[44:47], v[68:71], v[180:183]
ds_read_b64_tr_b16 v[102:103], v13 offset:9216
v_accvgpr_read_b32 v28, a29
v_mfma_f32_16x16x32_bf16 v[176:179], v[44:47], v[64:67], v[176:179]
ds_read_b64_tr_b16 v[104:105], v14 offset:8192
v_accvgpr_read_b32 v21, a30
v_mfma_f32_16x16x32_bf16 v[192:195], v[48:51], v[64:67], v[192:195]
ds_read_b64_tr_b16 v[106:107], v14 offset:9216
v_accvgpr_read_b32 v29, a31
v_mfma_f32_16x16x32_bf16 v[196:199], v[48:51], v[68:71], v[196:199]
s_add_u32 s72, s70, 129024
buffer_load_dwordx4 v4, s[4:7], s72 offen offset:2048 lds
v_mfma_f32_16x16x32_bf16 v[200:203], v[48:51], v[72:75], v[200:203]
ds_read_b64_tr_b16 v[108:109], v15 offset:8192
v_accvgpr_read_b32 v22, a60
v_mfma_f32_16x16x32_bf16 v[204:207], v[48:51], v[76:79], v[204:207]
ds_read_b64_tr_b16 v[110:111], v15 offset:9216
v_accvgpr_read_b32 v30, a61
v_mfma_f32_16x16x32_bf16 v[220:223], v[52:55], v[76:79], v[220:223]
buffer_store_dwordx4 v[24:27], v1, s[44:47], s80 offen sc1
v_mfma_f32_16x16x32_bf16 v[216:219], v[52:55], v[72:75], v[216:219]
v_accvgpr_read_b32 v23, a62
v_accvgpr_read_b32 v31, a63
v_mfma_f32_16x16x32_bf16 v[212:215], v[52:55], v[68:71], v[212:215]
s_add_u32 s72, s70, 144384
buffer_load_dwordx4 v5, s[4:7], s72 offen offset:3072 lds
v_mfma_f32_16x16x32_bf16 v[208:211], v[52:55], v[64:67], v[208:211]
v_mul_f32 v20, s79, v20
v_mul_f32 v28, s79, v28
v_mfma_f32_16x16x32_bf16 v[224:227], v[56:59], v[64:67], v[224:227]
v_mul_f32 v21, s79, v21
v_mul_f32 v29, s79, v29
v_mfma_f32_16x16x32_bf16 v[228:231], v[56:59], v[68:71], v[228:231]
v_mul_f32 v22, s79, v22
v_mul_f32 v30, s79, v30
v_mfma_f32_16x16x32_bf16 v[232:235], v[56:59], v[72:75], v[232:235]
v_mul_f32 v23, s79, v23
v_mul_f32 v31, s79, v31
v_mfma_f32_16x16x32_bf16 v[236:239], v[56:59], v[76:79], v[236:239]
v_cvt_pk_bf16_f32 v20, v20, v28
v_cvt_pk_bf16_f32 v21, v21, v29
v_mfma_f32_16x16x32_bf16 v[252:255], v[60:63], v[76:79], v[252:255]
v_cvt_pk_bf16_f32 v22, v22, v30
v_cvt_pk_bf16_f32 v23, v23, v31
v_mfma_f32_16x16x32_bf16 v[248:251], v[60:63], v[72:75], v[248:251]
s_add_u32 s80, s77, 45056
buffer_store_dwordx4 v[20:23], v1, s[44:47], s80 offen sc1
v_mfma_f32_16x16x32_bf16 v[244:247], v[60:63], v[68:71], v[244:247]
s_waitcnt vmcnt(16) lgkmcnt(0)
v_mfma_f32_16x16x32_bf16 v[240:243], v[60:63], v[64:67], v[240:243]
s_barrier
v_mfma_f32_16x16x32_bf16 v[128:131], v[80:83], v[112:115], v[128:131]
s_add_u32 s73, s62, 6
ds_read_b64_tr_b16 v[32:33], v8 offset:16384
ds_read_b64_tr_b16 v[34:35], v8 offset:17408
v_mfma_f32_16x16x32_bf16 v[132:135], v[80:83], v[116:119], v[132:135]
s_add_u32 s70, s73, s65
ds_read_b128 v[64:67], v18 offset:0
ds_read_b128 v[68:71], v18 offset:2048
v_mfma_f32_16x16x32_bf16 v[136:139], v[80:83], v[120:123], v[136:139]
s_and_b32 s70, s70, 3
ds_read_b128 v[72:75], v18 offset:4096
ds_read_b128 v[76:79], v18 offset:6144
v_mfma_f32_16x16x32_bf16 v[140:143], v[80:83], v[124:127], v[140:143]
s_and_b32 s73, s73, 12
ds_read_b64_tr_b16 v[36:37], v9 offset:16384
ds_read_b64_tr_b16 v[38:39], v9 offset:17408
v_mfma_f32_16x16x32_bf16 v[156:159], v[84:87], v[124:127], v[156:159]
s_or_b32 s73, s73, s70
ds_read_b64_tr_b16 v[40:41], v10 offset:16384
v_accvgpr_read_b32 v24, a168
v_mfma_f32_16x16x32_bf16 v[152:155], v[84:87], v[120:123], v[152:155]
s_lshl_b32 s71, s73, 19
ds_read_b64_tr_b16 v[42:43], v10 offset:17408
v_accvgpr_read_b32 v28, a169
v_mfma_f32_16x16x32_bf16 v[148:151], v[84:87], v[116:119], v[148:151]
s_add_u32 s71, s71, s66
ds_read_b64_tr_b16 v[44:45], v11 offset:16384
v_accvgpr_read_b32 v25, a170
v_mfma_f32_16x16x32_bf16 v[144:147], v[84:87], v[112:115], v[144:147]
s_lshl_b32 s73, s73, 7
ds_read_b64_tr_b16 v[46:47], v11 offset:17408
v_accvgpr_read_b32 v29, a171
v_mfma_f32_16x16x32_bf16 v[160:163], v[88:91], v[112:115], v[160:163]
s_add_u32 s69, s73, s67
ds_read_b64_tr_b16 v[48:49], v12 offset:16384
v_accvgpr_read_b32 v26, a172
v_mfma_f32_16x16x32_bf16 v[164:167], v[88:91], v[116:119], v[164:167]
s_add_u32 s70, s73, s68
ds_read_b64_tr_b16 v[50:51], v12 offset:17408
v_accvgpr_read_b32 v30, a173
v_mfma_f32_16x16x32_bf16 v[168:171], v[88:91], v[120:123], v[168:171]
s_add_u32 m0, s64, 0
ds_read_b64_tr_b16 v[52:53], v13 offset:16384
v_accvgpr_read_b32 v27, a174
v_mfma_f32_16x16x32_bf16 v[172:175], v[88:91], v[124:127], v[172:175]
s_add_u32 s72, s71, 0
buffer_load_dwordx4 v6, s[12:15], s72 offen lds
v_mfma_f32_16x16x32_bf16 v[188:191], v[92:95], v[124:127], v[188:191]
s_add_u32 s72, s71, 31744
buffer_load_dwordx4 v6, s[12:15], s72 offen offset:1024 lds
v_mfma_f32_16x16x32_bf16 v[184:187], v[92:95], v[120:123], v[184:187]
s_add_u32 s72, s71, 63488
buffer_load_dwordx4 v7, s[12:15], s72 offen offset:2048 lds
v_mfma_f32_16x16x32_bf16 v[180:183], v[92:95], v[116:119], v[180:183]
s_add_u32 s72, s71, 95232
buffer_load_dwordx4 v7, s[12:15], s72 offen offset:3072 lds
v_mfma_f32_16x16x32_bf16 v[176:179], v[92:95], v[112:115], v[176:179]
ds_read_b64_tr_b16 v[54:55], v13 offset:17408
v_accvgpr_read_b32 v31, a175
v_mfma_f32_16x16x32_bf16 v[192:195], v[96:99], v[112:115], v[192:195]
ds_read_b64_tr_b16 v[56:57], v14 offset:16384
v_cvt_pk_bf16_f32 v24, v24, v28
v_mfma_f32_16x16x32_bf16 v[196:199], v[96:99], v[116:119], v[196:199]
ds_read_b64_tr_b16 v[58:59], v14 offset:17408
v_cvt_pk_bf16_f32 v25, v25, v29
v_mfma_f32_16x16x32_bf16 v[200:203], v[96:99], v[120:123], v[200:203]
ds_read_b64_tr_b16 v[60:61], v15 offset:16384
v_cvt_pk_bf16_f32 v26, v26, v30
v_mfma_f32_16x16x32_bf16 v[204:207], v[96:99], v[124:127], v[204:207]
s_add_u32 m0, s63, 131072
ds_read_b64_tr_b16 v[62:63], v15 offset:17408
v_cvt_pk_bf16_f32 v27, v27, v31
v_mfma_f32_16x16x32_bf16 v[220:223], v[100:103], v[124:127], v[220:223]
s_add_u32 s72, s69, 0
buffer_load_dwordx4 v4, s[4:7], s72 offen lds
v_mfma_f32_16x16x32_bf16 v[216:219], v[100:103], v[120:123], v[216:219]
s_add_u32 s80, s78, 9216
buffer_store_dwordx4 v[24:27], v1, s[44:47], s80 offen sc1
v_mfma_f32_16x16x32_bf16 v[212:215], v[100:103], v[116:119], v[212:215]
v_accvgpr_read_b32 v20, a64
v_accvgpr_read_b32 v28, a65
v_mfma_f32_16x16x32_bf16 v[208:211], v[100:103], v[112:115], v[208:211]
v_accvgpr_read_b32 v21, a66
v_accvgpr_read_b32 v29, a67
v_mfma_f32_16x16x32_bf16 v[224:227], v[104:107], v[112:115], v[224:227]
s_add_u32 s72, s69, 15360
buffer_load_dwordx4 v5, s[4:7], s72 offen offset:1024 lds
v_mfma_f32_16x16x32_bf16 v[228:231], v[104:107], v[116:119], v[228:231]
v_accvgpr_read_b32 v22, a96
v_accvgpr_read_b32 v30, a97
v_mfma_f32_16x16x32_bf16 v[232:235], v[104:107], v[120:123], v[232:235]
v_accvgpr_read_b32 v23, a98
v_accvgpr_read_b32 v31, a99
v_mfma_f32_16x16x32_bf16 v[236:239], v[104:107], v[124:127], v[236:239]
v_mul_f32 v20, s79, v20
v_mul_f32 v28, s79, v28
v_mfma_f32_16x16x32_bf16 v[252:255], v[108:111], v[124:127], v[252:255]
v_mul_f32 v21, s79, v21
v_mul_f32 v29, s79, v29
v_mfma_f32_16x16x32_bf16 v[248:251], v[108:111], v[120:123], v[248:251]
s_add_u32 s72, s69, 129024
buffer_load_dwordx4 v4, s[4:7], s72 offen offset:2048 lds
v_mfma_f32_16x16x32_bf16 v[244:247], v[108:111], v[116:119], v[244:247]
v_mul_f32 v22, s79, v22
v_mul_f32 v30, s79, v30
v_mfma_f32_16x16x32_bf16 v[240:243], v[108:111], v[112:115], v[240:243]
s_waitcnt lgkmcnt(0)
v_mul_f32 v23, s79, v23
v_mul_f32 v31, s79, v31
v_mfma_f32_16x16x32_bf16 v[128:131], v[32:35], v[64:67], v[128:131]
ds_read_b64_tr_b16 v[80:81], v8 offset:24576
ds_read_b64_tr_b16 v[82:83], v8 offset:25600
v_mfma_f32_16x16x32_bf16 v[132:135], v[32:35], v[68:71], v[132:135]
ds_read_b128 v[112:115], v19 offset:0
ds_read_b128 v[116:119], v19 offset:2048
v_mfma_f32_16x16x32_bf16 v[136:139], v[32:35], v[72:75], v[136:139]
s_add_u32 s72, s69, 144384
buffer_load_dwordx4 v5, s[4:7], s72 offen offset:3072 lds
v_mfma_f32_16x16x32_bf16 v[140:143], v[32:35], v[76:79], v[140:143]
ds_read_b128 v[120:123], v19 offset:4096
ds_read_b128 v[124:127], v19 offset:6144
v_mfma_f32_16x16x32_bf16 v[156:159], v[36:39], v[76:79], v[156:159]
ds_read_b64_tr_b16 v[84:85], v9 offset:24576
ds_read_b64_tr_b16 v[86:87], v9 offset:25600
v_mfma_f32_16x16x32_bf16 v[152:155], v[36:39], v[72:75], v[152:155]
ds_read_b64_tr_b16 v[88:89], v10 offset:24576
v_cvt_pk_bf16_f32 v20, v20, v28
v_mfma_f32_16x16x32_bf16 v[148:151], v[36:39], v[68:71], v[148:151]
ds_read_b64_tr_b16 v[90:91], v10 offset:25600
v_cvt_pk_bf16_f32 v21, v21, v29
v_mfma_f32_16x16x32_bf16 v[144:147], v[36:39], v[64:67], v[144:147]
s_add_u32 m0, s63, 135168
ds_read_b64_tr_b16 v[92:93], v11 offset:24576
v_cvt_pk_bf16_f32 v22, v22, v30
v_mfma_f32_16x16x32_bf16 v[160:163], v[40:43], v[64:67], v[160:163]
s_add_u32 s72, s70, 0
buffer_load_dwordx4 v4, s[4:7], s72 offen lds
v_mfma_f32_16x16x32_bf16 v[164:167], v[40:43], v[68:71], v[164:167]
ds_read_b64_tr_b16 v[94:95], v11 offset:25600
v_cvt_pk_bf16_f32 v23, v23, v31
v_mfma_f32_16x16x32_bf16 v[168:171], v[40:43], v[72:75], v[168:171]
s_add_u32 s80, s77, 1024
ds_read_b64_tr_b16 v[96:97], v12 offset:24576
v_accvgpr_read_b32 v24, a176
v_mfma_f32_16x16x32_bf16 v[172:175], v[40:43], v[76:79], v[172:175]
ds_read_b64_tr_b16 v[98:99], v12 offset:25600
v_accvgpr_read_b32 v28, a177
v_mfma_f32_16x16x32_bf16 v[188:191], v[44:47], v[76:79], v[188:191]
s_add_u32 s72, s70, 15360
buffer_load_dwordx4 v5, s[4:7], s72 offen offset:1024 lds
v_mfma_f32_16x16x32_bf16 v[184:187], v[44:47], v[72:75], v[184:187]
ds_read_b64_tr_b16 v[100:101], v13 offset:24576
v_accvgpr_read_b32 v25, a178
v_mfma_f32_16x16x32_bf16 v[180:183], v[44:47], v[68:71], v[180:183]
ds_read_b64_tr_b16 v[102:103], v13 offset:25600
v_accvgpr_read_b32 v29, a179
v_mfma_f32_16x16x32_bf16 v[176:179], v[44:47], v[64:67], v[176:179]
ds_read_b64_tr_b16 v[104:105], v14 offset:24576
v_accvgpr_read_b32 v26, a180
v_mfma_f32_16x16x32_bf16 v[192:195], v[48:51], v[64:67], v[192:195]
ds_read_b64_tr_b16 v[106:107], v14 offset:25600
v_accvgpr_read_b32 v30, a181
v_mfma_f32_16x16x32_bf16 v[196:199], v[48:51], v[68:71], v[196:199]
s_add_u32 s72, s70, 129024
buffer_load_dwordx4 v4, s[4:7], s72 offen offset:2048 lds
v_mfma_f32_16x16x32_bf16 v[200:203], v[48:51], v[72:75], v[200:203]
ds_read_b64_tr_b16 v[108:109], v15 offset:24576
v_accvgpr_read_b32 v27, a182
v_mfma_f32_16x16x32_bf16 v[204:207], v[48:51], v[76:79], v[204:207]
ds_read_b64_tr_b16 v[110:111], v15 offset:25600
v_accvgpr_read_b32 v31, a183
v_mfma_f32_16x16x32_bf16 v[220:223], v[52:55], v[76:79], v[220:223]
buffer_store_dwordx4 v[20:23], v1, s[44:47], s80 offen sc1
v_mfma_f32_16x16x32_bf16 v[216:219], v[52:55], v[72:75], v[216:219]
v_cvt_pk_bf16_f32 v24, v24, v28
v_cvt_pk_bf16_f32 v25, v25, v29
v_mfma_f32_16x16x32_bf16 v[212:215], v[52:55], v[68:71], v[212:215]
s_add_u32 s72, s70, 144384
buffer_load_dwordx4 v5, s[4:7], s72 offen offset:3072 lds
v_mfma_f32_16x16x32_bf16 v[208:211], v[52:55], v[64:67], v[208:211]
v_cvt_pk_bf16_f32 v26, v26, v30
v_cvt_pk_bf16_f32 v27, v27, v31
v_mfma_f32_16x16x32_bf16 v[224:227], v[56:59], v[64:67], v[224:227]
s_add_u32 s80, s78, 33792
buffer_store_dwordx4 v[24:27], v1, s[44:47], s80 offen sc1
v_mfma_f32_16x16x32_bf16 v[228:231], v[56:59], v[68:71], v[228:231]
v_mfma_f32_16x16x32_bf16 v[232:235], v[56:59], v[72:75], v[232:235]
v_mfma_f32_16x16x32_bf16 v[236:239], v[56:59], v[76:79], v[236:239]
v_mfma_f32_16x16x32_bf16 v[252:255], v[60:63], v[76:79], v[252:255]
v_mfma_f32_16x16x32_bf16 v[248:251], v[60:63], v[72:75], v[248:251]
v_mfma_f32_16x16x32_bf16 v[244:247], v[60:63], v[68:71], v[244:247]
s_waitcnt vmcnt(16) lgkmcnt(0)
v_accvgpr_read_b32 v20, a68
v_accvgpr_read_b32 v28, a69
v_mfma_f32_16x16x32_bf16 v[240:243], v[60:63], v[64:67], v[240:243]
s_barrier
v_accvgpr_read_b32 v21, a70
v_accvgpr_read_b32 v29, a71
v_mfma_f32_16x16x32_bf16 v[128:131], v[80:83], v[112:115], v[128:131]
s_add_u32 s73, s62, 7
ds_read_b64_tr_b16 v[32:33], v8 offset:32768
ds_read_b64_tr_b16 v[34:35], v8 offset:33792
v_mfma_f32_16x16x32_bf16 v[132:135], v[80:83], v[116:119], v[132:135]
s_add_u32 s70, s73, s65
ds_read_b128 v[64:67], v18 offset:32768
ds_read_b128 v[68:71], v18 offset:34816
v_mfma_f32_16x16x32_bf16 v[136:139], v[80:83], v[120:123], v[136:139]
s_and_b32 s70, s70, 3
ds_read_b128 v[72:75], v18 offset:36864
ds_read_b128 v[76:79], v18 offset:38912
v_mfma_f32_16x16x32_bf16 v[140:143], v[80:83], v[124:127], v[140:143]
s_and_b32 s73, s73, 12
ds_read_b64_tr_b16 v[36:37], v9 offset:32768
ds_read_b64_tr_b16 v[38:39], v9 offset:33792
v_mfma_f32_16x16x32_bf16 v[156:159], v[84:87], v[124:127], v[156:159]
s_or_b32 s73, s73, s70
ds_read_b64_tr_b16 v[40:41], v10 offset:32768
v_accvgpr_read_b32 v22, a100
v_mfma_f32_16x16x32_bf16 v[152:155], v[84:87], v[120:123], v[152:155]
s_lshl_b32 s71, s73, 19
ds_read_b64_tr_b16 v[42:43], v10 offset:33792
v_accvgpr_read_b32 v30, a101
v_mfma_f32_16x16x32_bf16 v[148:151], v[84:87], v[116:119], v[148:151]
s_add_u32 s71, s71, s66
ds_read_b64_tr_b16 v[44:45], v11 offset:32768
v_accvgpr_read_b32 v23, a102
v_mfma_f32_16x16x32_bf16 v[144:147], v[84:87], v[112:115], v[144:147]
s_lshl_b32 s73, s73, 7
ds_read_b64_tr_b16 v[46:47], v11 offset:33792
v_accvgpr_read_b32 v31, a103
v_mfma_f32_16x16x32_bf16 v[160:163], v[88:91], v[112:115], v[160:163]
s_add_u32 s69, s73, s67
ds_read_b64_tr_b16 v[48:49], v12 offset:32768
v_mul_f32 v20, s79, v20
v_mfma_f32_16x16x32_bf16 v[164:167], v[88:91], v[116:119], v[164:167]
s_add_u32 s70, s73, s68
ds_read_b64_tr_b16 v[50:51], v12 offset:33792
v_mul_f32 v28, s79, v28
v_mfma_f32_16x16x32_bf16 v[168:171], v[88:91], v[120:123], v[168:171]
s_add_u32 m0, s64, 16384
ds_read_b64_tr_b16 v[52:53], v13 offset:32768
v_mul_f32 v21, s79, v21
v_mfma_f32_16x16x32_bf16 v[172:175], v[88:91], v[124:127], v[172:175]
s_add_u32 s72, s71, 0
buffer_load_dwordx4 v6, s[12:15], s72 offen lds
v_mfma_f32_16x16x32_bf16 v[188:191], v[92:95], v[124:127], v[188:191]
s_add_u32 s72, s71, 31744
buffer_load_dwordx4 v6, s[12:15], s72 offen offset:1024 lds
v_mfma_f32_16x16x32_bf16 v[184:187], v[92:95], v[120:123], v[184:187]
s_add_u32 s72, s71, 63488
buffer_load_dwordx4 v7, s[12:15], s72 offen offset:2048 lds
v_mfma_f32_16x16x32_bf16 v[180:183], v[92:95], v[116:119], v[180:183]
s_add_u32 s72, s71, 95232
buffer_load_dwordx4 v7, s[12:15], s72 offen offset:3072 lds
v_mfma_f32_16x16x32_bf16 v[176:179], v[92:95], v[112:115], v[176:179]
ds_read_b64_tr_b16 v[54:55], v13 offset:33792
v_mul_f32 v29, s79, v29
v_mfma_f32_16x16x32_bf16 v[192:195], v[96:99], v[112:115], v[192:195]
ds_read_b64_tr_b16 v[56:57], v14 offset:32768
v_mul_f32 v22, s79, v22
v_mfma_f32_16x16x32_bf16 v[196:199], v[96:99], v[116:119], v[196:199]
ds_read_b64_tr_b16 v[58:59], v14 offset:33792
v_mul_f32 v30, s79, v30
v_mfma_f32_16x16x32_bf16 v[200:203], v[96:99], v[120:123], v[200:203]
ds_read_b64_tr_b16 v[60:61], v15 offset:32768
v_mul_f32 v23, s79, v23
v_mfma_f32_16x16x32_bf16 v[204:207], v[96:99], v[124:127], v[204:207]
s_add_u32 m0, s63, 65536
ds_read_b64_tr_b16 v[62:63], v15 offset:33792
v_mul_f32 v31, s79, v31
v_mfma_f32_16x16x32_bf16 v[220:223], v[100:103], v[124:127], v[220:223]
s_add_u32 s72, s69, 0
buffer_load_dwordx4 v4, s[4:7], s72 offen lds
v_mfma_f32_16x16x32_bf16 v[216:219], v[100:103], v[120:123], v[216:219]
v_cvt_pk_bf16_f32 v20, v20, v28
v_cvt_pk_bf16_f32 v21, v21, v29
v_mfma_f32_16x16x32_bf16 v[212:215], v[100:103], v[116:119], v[212:215]
v_cvt_pk_bf16_f32 v22, v22, v30
v_cvt_pk_bf16_f32 v23, v23, v31
v_mfma_f32_16x16x32_bf16 v[208:211], v[100:103], v[112:115], v[208:211]
s_add_u32 s80, s77, 5120
buffer_store_dwordx4 v[20:23], v1, s[44:47], s80 offen sc1
v_mfma_f32_16x16x32_bf16 v[224:227], v[104:107], v[112:115], v[224:227]
s_add_u32 s72, s69, 15360
buffer_load_dwordx4 v5, s[4:7], s72 offen offset:1024 lds
v_mfma_f32_16x16x32_bf16 v[228:231], v[104:107], v[116:119], v[228:231]
v_accvgpr_read_b32 v24, a184
v_accvgpr_read_b32 v28, a185
v_mfma_f32_16x16x32_bf16 v[232:235], v[104:107], v[120:123], v[232:235]
v_accvgpr_read_b32 v25, a186
v_accvgpr_read_b32 v29, a187
v_mfma_f32_16x16x32_bf16 v[236:239], v[104:107], v[124:127], v[236:239]
v_accvgpr_read_b32 v26, a188
v_accvgpr_read_b32 v30, a189
v_mfma_f32_16x16x32_bf16 v[252:255], v[108:111], v[124:127], v[252:255]
v_accvgpr_read_b32 v27, a190
v_accvgpr_read_b32 v31, a191
v_mfma_f32_16x16x32_bf16 v[248:251], v[108:111], v[120:123], v[248:251]
s_add_u32 s72, s69, 129024
buffer_load_dwordx4 v4, s[4:7], s72 offen offset:2048 lds
v_mfma_f32_16x16x32_bf16 v[244:247], v[108:111], v[116:119], v[244:247]
v_cvt_pk_bf16_f32 v24, v24, v28
v_cvt_pk_bf16_f32 v25, v25, v29
v_mfma_f32_16x16x32_bf16 v[240:243], v[108:111], v[112:115], v[240:243]
s_waitcnt lgkmcnt(0)
v_cvt_pk_bf16_f32 v26, v26, v30
v_cvt_pk_bf16_f32 v27, v27, v31
v_mfma_f32_16x16x32_bf16 v[128:131], v[32:35], v[64:67], v[128:131]
s_lshr_b32 s75, s93, 4
ds_read_b64_tr_b16 v[80:81], v8 offset:40960
ds_read_b64_tr_b16 v[82:83], v8 offset:41984
v_mfma_f32_16x16x32_bf16 v[132:135], v[32:35], v[68:71], v[132:135]
s_and_b32 s75, s75, 0x7f00
ds_read_b128 v[112:115], v19 offset:32768
ds_read_b128 v[116:119], v19 offset:34816
v_mfma_f32_16x16x32_bf16 v[136:139], v[32:35], v[72:75], v[136:139]
s_add_u32 s72, s69, 144384
buffer_load_dwordx4 v5, s[4:7], s72 offen offset:3072 lds
v_mfma_f32_16x16x32_bf16 v[140:143], v[32:35], v[76:79], v[140:143]
s_add_u32 s75, s75, LcB1-Lpc0
v_lshrrev_b32 v2, 5, v0
v_lshlrev_b32 v2, 7, v2
v_mfma_f32_16x16x32_bf16 v[156:159], v[36:39], v[76:79], v[156:159]
s_add_u32 s80, s78, 41984
v_add_u32 v2, s75, v2
v_min_u32 v2, Lcode_end-Lpc0, v2
v_mfma_f32_16x16x32_bf16 v[152:155], v[36:39], v[72:75], v[152:155]
global_load_dword v3, v2, s[98:99]
v_mfma_f32_16x16x32_bf16 v[148:151], v[36:39], v[68:71], v[148:151]
ds_read_b128 v[120:123], v19 offset:36864
ds_read_b128 v[124:127], v19 offset:38912
v_mfma_f32_16x16x32_bf16 v[144:147], v[36:39], v[64:67], v[144:147]
s_add_u32 m0, s63, 69632
ds_read_b64_tr_b16 v[84:85], v9 offset:40960
ds_read_b64_tr_b16 v[86:87], v9 offset:41984
v_mfma_f32_16x16x32_bf16 v[160:163], v[40:43], v[64:67], v[160:163]
s_add_u32 s72, s70, 0
buffer_load_dwordx4 v4, s[4:7], s72 offen lds
v_mfma_f32_16x16x32_bf16 v[164:167], v[40:43], v[68:71], v[164:167]
ds_read_b64_tr_b16 v[88:89], v10 offset:40960
v_accvgpr_read_b32 v20, a72
v_mfma_f32_16x16x32_bf16 v[168:171], v[40:43], v[72:75], v[168:171]
ds_read_b64_tr_b16 v[90:91], v10 offset:41984
v_accvgpr_read_b32 v28, a73
v_mfma_f32_16x16x32_bf16 v[172:175], v[40:43], v[76:79], v[172:175]
ds_read_b64_tr_b16 v[92:93], v11 offset:40960
v_accvgpr_read_b32 v21, a74
v_mfma_f32_16x16x32_bf16 v[188:191], v[44:47], v[76:79], v[188:191]
s_add_u32 s72, s70, 15360
buffer_load_dwordx4 v5, s[4:7], s72 offen offset:1024 lds
v_mfma_f32_16x16x32_bf16 v[184:187], v[44:47], v[72:75], v[184:187]
ds_read_b64_tr_b16 v[94:95], v11 offset:41984
v_accvgpr_read_b32 v29, a75
v_mfma_f32_16x16x32_bf16 v[180:183], v[44:47], v[68:71], v[180:183]
ds_read_b64_tr_b16 v[96:97], v12 offset:40960
v_accvgpr_read_b32 v22, a104
v_mfma_f32_16x16x32_bf16 v[176:179], v[44:47], v[64:67], v[176:179]
ds_read_b64_tr_b16 v[98:99], v12 offset:41984
v_accvgpr_read_b32 v30, a105
v_mfma_f32_16x16x32_bf16 v[192:195], v[48:51], v[64:67], v[192:195]
ds_read_b64_tr_b16 v[100:101], v13 offset:40960
v_accvgpr_read_b32 v23, a106
v_mfma_f32_16x16x32_bf16 v[196:199], v[48:51], v[68:71], v[196:199]
s_add_u32 s72, s70, 129024
buffer_load_dwordx4 v4, s[4:7], s72 offen offset:2048 lds
v_mfma_f32_16x16x32_bf16 v[200:203], v[48:51], v[72:75], v[200:203]
ds_read_b64_tr_b16 v[102:103], v13 offset:41984
v_accvgpr_read_b32 v31, a107
v_mfma_f32_16x16x32_bf16 v[204:207], v[48:51], v[76:79], v[204:207]
ds_read_b64_tr_b16 v[104:105], v14 offset:40960
v_mul_f32 v20, s79, v20
v_mfma_f32_16x16x32_bf16 v[220:223], v[52:55], v[76:79], v[220:223]
ds_read_b64_tr_b16 v[106:107], v14 offset:41984
v_mul_f32 v28, s79, v28
v_mfma_f32_16x16x32_bf16 v[216:219], v[52:55], v[72:75], v[216:219]
ds_read_b64_tr_b16 v[108:109], v15 offset:40960
v_mul_f32 v21, s79, v21
v_mfma_f32_16x16x32_bf16 v[212:215], v[52:55], v[68:71], v[212:215]
s_add_u32 s72, s70, 144384
buffer_load_dwordx4 v5, s[4:7], s72 offen offset:3072 lds
v_mfma_f32_16x16x32_bf16 v[208:211], v[52:55], v[64:67], v[208:211]
ds_read_b64_tr_b16 v[110:111], v15 offset:41984
v_mul_f32 v29, s79, v29
v_mfma_f32_16x16x32_bf16 v[224:227], v[56:59], v[64:67], v[224:227]
buffer_store_dwordx4 v[24:27], v1, s[44:47], s80 offen sc1
v_mfma_f32_16x16x32_bf16 v[228:231], v[56:59], v[68:71], v[228:231]
v_mul_f32 v22, s79, v22
v_mul_f32 v30, s79, v30
v_mfma_f32_16x16x32_bf16 v[232:235], v[56:59], v[72:75], v[232:235]
v_mul_f32 v23, s79, v23
v_mul_f32 v31, s79, v31
v_mfma_f32_16x16x32_bf16 v[236:239], v[56:59], v[76:79], v[236:239]
v_cvt_pk_bf16_f32 v20, v20, v28
v_cvt_pk_bf16_f32 v21, v21, v29
v_mfma_f32_16x16x32_bf16 v[252:255], v[60:63], v[76:79], v[252:255]
v_cvt_pk_bf16_f32 v22, v22, v30
v_cvt_pk_bf16_f32 v23, v23, v31
v_mfma_f32_16x16x32_bf16 v[248:251], v[60:63], v[72:75], v[248:251]
s_add_u32 s80, s77, 9216
buffer_store_dwordx4 v[20:23], v1, s[44:47], s80 offen sc1
v_mfma_f32_16x16x32_bf16 v[244:247], v[60:63], v[68:71], v[244:247]
s_waitcnt vmcnt(17) lgkmcnt(0)
v_accvgpr_read_b32 v24, a192
v_accvgpr_read_b32 v28, a193
v_mfma_f32_16x16x32_bf16 v[240:243], v[60:63], v[64:67], v[240:243]
s_barrier
v_accvgpr_read_b32 v25, a194
v_accvgpr_read_b32 v29, a195
v_mfma_f32_16x16x32_bf16 v[128:131], v[80:83], v[112:115], v[128:131]
s_add_u32 s73, s62, 8
ds_read_b64_tr_b16 v[32:33], v8 offset:0
ds_read_b64_tr_b16 v[34:35], v8 offset:1024
v_mfma_f32_16x16x32_bf16 v[132:135], v[80:83], v[116:119], v[132:135]
s_add_u32 s70, s73, s65
ds_read_b128 v[64:67], v16 offset:0
ds_read_b128 v[68:71], v16 offset:2048
v_mfma_f32_16x16x32_bf16 v[136:139], v[80:83], v[120:123], v[136:139]
s_and_b32 s70, s70, 3
ds_read_b128 v[72:75], v16 offset:4096
ds_read_b128 v[76:79], v16 offset:6144
v_mfma_f32_16x16x32_bf16 v[140:143], v[80:83], v[124:127], v[140:143]
s_and_b32 s73, s73, 12
ds_read_b64_tr_b16 v[36:37], v9 offset:0
ds_read_b64_tr_b16 v[38:39], v9 offset:1024
v_mfma_f32_16x16x32_bf16 v[156:159], v[84:87], v[124:127], v[156:159]
s_or_b32 s73, s73, s70
ds_read_b64_tr_b16 v[40:41], v10 offset:0
v_accvgpr_read_b32 v26, a196
v_mfma_f32_16x16x32_bf16 v[152:155], v[84:87], v[120:123], v[152:155]
s_lshl_b32 s71, s73, 19
ds_read_b64_tr_b16 v[42:43], v10 offset:1024
v_accvgpr_read_b32 v30, a197
v_mfma_f32_16x16x32_bf16 v[148:151], v[84:87], v[116:119], v[148:151]
s_add_u32 s71, s71, s66
ds_read_b64_tr_b16 v[44:45], v11 offset:0
v_accvgpr_read_b32 v27, a198
v_mfma_f32_16x16x32_bf16 v[144:147], v[84:87], v[112:115], v[144:147]
s_lshl_b32 s73, s73, 7
ds_read_b64_tr_b16 v[46:47], v11 offset:1024
v_accvgpr_read_b32 v31, a199
v_mfma_f32_16x16x32_bf16 v[160:163], v[88:91], v[112:115], v[160:163]
s_add_u32 s69, s73, s67
ds_read_b64_tr_b16 v[48:49], v12 offset:0
v_cvt_pk_bf16_f32 v24, v24, v28
v_mfma_f32_16x16x32_bf16 v[164:167], v[88:91], v[116:119], v[164:167]
s_add_u32 s70, s73, s68
ds_read_b64_tr_b16 v[50:51], v12 offset:1024
v_cvt_pk_bf16_f32 v25, v25, v29
v_mfma_f32_16x16x32_bf16 v[168:171], v[88:91], v[120:123], v[168:171]
s_add_u32 m0, s64, 32768
ds_read_b64_tr_b16 v[52:53], v13 offset:0
v_cvt_pk_bf16_f32 v26, v26, v30
v_mfma_f32_16x16x32_bf16 v[172:175], v[88:91], v[124:127], v[172:175]
s_add_u32 s72, s71, 0
buffer_load_dwordx4 v6, s[12:15], s72 offen lds
v_mfma_f32_16x16x32_bf16 v[188:191], v[92:95], v[124:127], v[188:191]
s_add_u32 s72, s71, 31744
buffer_load_dwordx4 v6, s[12:15], s72 offen offset:1024 lds
v_mfma_f32_16x16x32_bf16 v[184:187], v[92:95], v[120:123], v[184:187]
s_add_u32 s72, s71, 63488
buffer_load_dwordx4 v7, s[12:15], s72 offen offset:2048 lds
v_mfma_f32_16x16x32_bf16 v[180:183], v[92:95], v[116:119], v[180:183]
s_add_u32 s72, s71, 95232
buffer_load_dwordx4 v7, s[12:15], s72 offen offset:3072 lds
v_mfma_f32_16x16x32_bf16 v[176:179], v[92:95], v[112:115], v[176:179]
ds_read_b64_tr_b16 v[54:55], v13 offset:1024
v_cvt_pk_bf16_f32 v27, v27, v31
v_mfma_f32_16x16x32_bf16 v[192:195], v[96:99], v[112:115], v[192:195]
s_add_u32 s80, s78, 2048
ds_read_b64_tr_b16 v[56:57], v14 offset:0
v_accvgpr_read_b32 v20, a76
v_mfma_f32_16x16x32_bf16 v[196:199], v[96:99], v[116:119], v[196:199]
ds_read_b64_tr_b16 v[58:59], v14 offset:1024
v_accvgpr_read_b32 v28, a77
v_mfma_f32_16x16x32_bf16 v[200:203], v[96:99], v[120:123], v[200:203]
ds_read_b64_tr_b16 v[60:61], v15 offset:0
v_accvgpr_read_b32 v21, a78
v_mfma_f32_16x16x32_bf16 v[204:207], v[96:99], v[124:127], v[204:207]
s_add_u32 m0, s63, 98304
ds_read_b64_tr_b16 v[62:63], v15 offset:1024
v_accvgpr_read_b32 v29, a79
v_mfma_f32_16x16x32_bf16 v[220:223], v[100:103], v[124:127], v[220:223]
s_add_u32 s72, s69, 0
buffer_load_dwordx4 v4, s[4:7], s72 offen lds
v_mfma_f32_16x16x32_bf16 v[216:219], v[100:103], v[120:123], v[216:219]
buffer_store_dwordx4 v[24:27], v1, s[44:47], s80 offen sc1
v_mfma_f32_16x16x32_bf16 v[212:215], v[100:103], v[116:119], v[212:215]
v_accvgpr_read_b32 v22, a108
v_accvgpr_read_b32 v30, a109
v_mfma_f32_16x16x32_bf16 v[208:211], v[100:103], v[112:115], v[208:211]
v_accvgpr_read_b32 v23, a110
v_accvgpr_read_b32 v31, a111
v_mfma_f32_16x16x32_bf16 v[224:227], v[104:107], v[112:115], v[224:227]
s_add_u32 s72, s69, 15360
buffer_load_dwordx4 v5, s[4:7], s72 offen offset:1024 lds
v_mfma_f32_16x16x32_bf16 v[228:231], v[104:107], v[116:119], v[228:231]
v_mul_f32 v20, s79, v20
v_mul_f32 v28, s79, v28
v_mfma_f32_16x16x32_bf16 v[232:235], v[104:107], v[120:123], v[232:235]
v_mul_f32 v21, s79, v21
v_mul_f32 v29, s79, v29
v_mfma_f32_16x16x32_bf16 v[236:239], v[104:107], v[124:127], v[236:239]
v_mul_f32 v22, s79, v22
v_mul_f32 v30, s79, v30
v_mfma_f32_16x16x32_bf16 v[252:255], v[108:111], v[124:127], v[252:255]
v_mul_f32 v23, s79, v23
v_mul_f32 v31, s79, v31
v_mfma_f32_16x16x32_bf16 v[248:251], v[108:111], v[120:123], v[248:251]
s_add_u32 s72, s69, 129024
buffer_load_dwordx4 v4, s[4:7], s72 offen offset:2048 lds
v_mfma_f32_16x16x32_bf16 v[244:247], v[108:111], v[116:119], v[244:247]
v_cvt_pk_bf16_f32 v20, v20, v28
v_cvt_pk_bf16_f32 v21, v21, v29
v_mfma_f32_16x16x32_bf16 v[240:243], v[108:111], v[112:115], v[240:243]
s_waitcnt lgkmcnt(0)
v_cvt_pk_bf16_f32 v22, v22, v30
v_cvt_pk_bf16_f32 v23, v23, v31
v_mfma_f32_16x16x32_bf16 v[128:131], v[32:35], v[64:67], v[128:131]
s_add_u32 s80, s77, 13312
ds_read_b64_tr_b16 v[80:81], v8 offset:8192
ds_read_b64_tr_b16 v[82:83], v8 offset:9216
v_mfma_f32_16x16x32_bf16 v[132:135], v[32:35], v[68:71], v[132:135]
ds_read_b128 v[112:115], v17 offset:0
ds_read_b128 v[116:119], v17 offset:2048
v_mfma_f32_16x16x32_bf16 v[136:139], v[32:35], v[72:75], v[136:139]
s_add_u32 s72, s69, 144384
buffer_load_dwordx4 v5, s[4:7], s72 offen offset:3072 lds
v_mfma_f32_16x16x32_bf16 v[140:143], v[32:35], v[76:79], v[140:143]
ds_read_b128 v[120:123], v17 offset:4096
ds_read_b128 v[124:127], v17 offset:6144
v_mfma_f32_16x16x32_bf16 v[156:159], v[36:39], v[76:79], v[156:159]
ds_read_b64_tr_b16 v[84:85], v9 offset:8192
ds_read_b64_tr_b16 v[86:87], v9 offset:9216
v_mfma_f32_16x16x32_bf16 v[152:155], v[36:39], v[72:75], v[152:155]
ds_read_b64_tr_b16 v[88:89], v10 offset:8192
v_accvgpr_read_b32 v24, a200
v_mfma_f32_16x16x32_bf16 v[148:151], v[36:39], v[68:71], v[148:151]
ds_read_b64_tr_b16 v[90:91], v10 offset:9216
v_accvgpr_read_b32 v28, a201
v_mfma_f32_16x16x32_bf16 v[144:147], v[36:39], v[64:67], v[144:147]
s_add_u32 m0, s63, 102400
ds_read_b64_tr_b16 v[92:93], v11 offset:8192
v_accvgpr_read_b32 v25, a202
v_mfma_f32_16x16x32_bf16 v[160:163], v[40:43], v[64:67], v[160:163]
s_add_u32 s72, s70, 0
buffer_load_dwordx4 v4, s[4:7], s72 offen lds
v_mfma_f32_16x16x32_bf16 v[164:167], v[40:43], v[68:71], v[164:167]
ds_read_b64_tr_b16 v[94:95], v11 offset:9216
v_accvgpr_read_b32 v29, a203
v_mfma_f32_16x16x32_bf16 v[168:171], v[40:43], v[72:75], v[168:171]
ds_read_b64_tr_b16 v[96:97], v12 offset:8192
v_accvgpr_read_b32 v26, a204
v_mfma_f32_16x16x32_bf16 v[172:175], v[40:43], v[76:79], v[172:175]
ds_read_b64_tr_b16 v[98:99], v12 offset:9216
v_accvgpr_read_b32 v30, a205
v_mfma_f32_16x16x32_bf16 v[188:191], v[44:47], v[76:79], v[188:191]
s_add_u32 s72, s70, 15360
buffer_load_dwordx4 v5, s[4:7], s72 offen offset:1024 lds
v_mfma_f32_16x16x32_bf16 v[184:187], v[44:47], v[72:75], v[184:187]
ds_read_b64_tr_b16 v[100:101], v13 offset:8192
v_accvgpr_read_b32 v27, a206
v_mfma_f32_16x16x32_bf16 v[180:183], v[44:47], v[68:71], v[180:183]
ds_read_b64_tr_b16 v[102:103], v13 offset:9216
v_accvgpr_read_b32 v31, a207
v_mfma_f32_16x16x32_bf16 v[176:179], v[44:47], v[64:67], v[176:179]
ds_read_b64_tr_b16 v[104:105], v14 offset:8192
v_cvt_pk_bf16_f32 v24, v24, v28
v_mfma_f32_16x16x32_bf16 v[192:195], v[48:51], v[64:67], v[192:195]
ds_read_b64_tr_b16 v[106:107], v14 offset:9216
v_cvt_pk_bf16_f32 v25, v25, v29
v_mfma_f32_16x16x32_bf16 v[196:199], v[48:51], v[68:71], v[196:199]
s_add_u32 s72, s70, 129024
buffer_load_dwordx4 v4, s[4:7], s72 offen offset:2048 lds
v_mfma_f32_16x16x32_bf16 v[200:203], v[48:51], v[72:75], v[200:203]
ds_read_b64_tr_b16 v[108:109], v15 offset:8192
v_cvt_pk_bf16_f32 v26, v26, v30
v_mfma_f32_16x16x32_bf16 v[204:207], v[48:51], v[76:79], v[204:207]
ds_read_b64_tr_b16 v[110:111], v15 offset:9216
v_cvt_pk_bf16_f32 v27, v27, v31
v_mfma_f32_16x16x32_bf16 v[220:223], v[52:55], v[76:79], v[220:223]
buffer_store_dwordx4 v[20:23], v1, s[44:47], s80 offen sc1
v_mfma_f32_16x16x32_bf16 v[216:219], v[52:55], v[72:75], v[216:219]
s_add_u32 s80, s78, 10240
buffer_store_dwordx4 v[24:27], v1, s[44:47], s80 offen sc1
v_mfma_f32_16x16x32_bf16 v[212:215], v[52:55], v[68:71], v[212:215]
s_add_u32 s72, s70, 144384
buffer_load_dwordx4 v5, s[4:7], s72 offen offset:3072 lds
v_mfma_f32_16x16x32_bf16 v[208:211], v[52:55], v[64:67], v[208:211]
v_accvgpr_read_b32 v20, a80
v_accvgpr_read_b32 v28, a81
v_mfma_f32_16x16x32_bf16 v[224:227], v[56:59], v[64:67], v[224:227]
v_accvgpr_read_b32 v21, a82
v_accvgpr_read_b32 v29, a83
v_mfma_f32_16x16x32_bf16 v[228:231], v[56:59], v[68:71], v[228:231]
v_accvgpr_read_b32 v22, a112
v_accvgpr_read_b32 v30, a113
v_mfma_f32_16x16x32_bf16 v[232:235], v[56:59], v[72:75], v[232:235]
v_accvgpr_read_b32 v23, a114
v_accvgpr_read_b32 v31, a115
v_mfma_f32_16x16x32_bf16 v[236:239], v[56:59], v[76:79], v[236:239]
v_mul_f32 v20, s79, v20
v_mul_f32 v28, s79, v28
v_mfma_f32_16x16x32_bf16 v[252:255], v[60:63], v[76:79], v[252:255]
v_mul_f32 v21, s79, v21
v_mul_f32 v29, s79, v29
v_mfma_f32_16x16x32_bf16 v[248:251], v[60:63], v[72:75], v[248:251]
v_mul_f32 v22, s79, v22
v_mul_f32 v30, s79, v30
v_mfma_f32_16x16x32_bf16 v[244:247], v[60:63], v[68:71], v[244:247]
s_waitcnt vmcnt(17) lgkmcnt(0)
v_mul_f32 v23, s79, v23
v_mul_f32 v31, s79, v31
v_mfma_f32_16x16x32_bf16 v[240:243], v[60:63], v[64:67], v[240:243]
s_barrier
v_cvt_pk_bf16_f32 v20, v20, v28
v_cvt_pk_bf16_f32 v21, v21, v29
v_mfma_f32_16x16x32_bf16 v[128:131], v[80:83], v[112:115], v[128:131]
s_add_u32 s73, s62, 9
ds_read_b64_tr_b16 v[32:33], v8 offset:16384
ds_read_b64_tr_b16 v[34:35], v8 offset:17408
v_mfma_f32_16x16x32_bf16 v[132:135], v[80:83], v[116:119], v[132:135]
s_add_u32 s70, s73, s65
ds_read_b128 v[64:67], v18 offset:0
ds_read_b128 v[68:71], v18 offset:2048
v_mfma_f32_16x16x32_bf16 v[136:139], v[80:83], v[120:123], v[136:139]
s_and_b32 s70, s70, 3
ds_read_b128 v[72:75], v18 offset:4096
ds_read_b128 v[76:79], v18 offset:6144
v_mfma_f32_16x16x32_bf16 v[140:143], v[80:83], v[124:127], v[140:143]
s_and_b32 s73, s73, 12
ds_read_b64_tr_b16 v[36:37], v9 offset:16384
ds_read_b64_tr_b16 v[38:39], v9 offset:17408
v_mfma_f32_16x16x32_bf16 v[156:159], v[84:87], v[124:127], v[156:159]
s_or_b32 s73, s73, s70
ds_read_b64_tr_b16 v[40:41], v10 offset:16384
v_cvt_pk_bf16_f32 v22, v22, v30
v_mfma_f32_16x16x32_bf16 v[152:155], v[84:87], v[120:123], v[152:155]
s_lshl_b32 s71, s73, 19
ds_read_b64_tr_b16 v[42:43], v10 offset:17408
v_cvt_pk_bf16_f32 v23, v23, v31
v_mfma_f32_16x16x32_bf16 v[148:151], v[84:87], v[116:119], v[148:151]
s_add_u32 s71, s71, s66
ds_read_b64_tr_b16 v[44:45], v11 offset:16384
v_mfma_f32_16x16x32_bf16 v[144:147], v[84:87], v[112:115], v[144:147]
s_lshl_b32 s73, s73, 7
ds_read_b64_tr_b16 v[46:47], v11 offset:17408
v_mfma_f32_16x16x32_bf16 v[160:163], v[88:91], v[112:115], v[160:163]
s_add_u32 s69, s73, s67
ds_read_b64_tr_b16 v[48:49], v12 offset:16384
v_mfma_f32_16x16x32_bf16 v[164:167], v[88:91], v[116:119], v[164:167]
s_add_u32 s70, s73, s68
ds_read_b64_tr_b16 v[50:51], v12 offset:17408
v_mfma_f32_16x16x32_bf16 v[168:171], v[88:91], v[120:123], v[168:171]
s_add_u32 m0, s64, 0
ds_read_b64_tr_b16 v[52:53], v13 offset:16384
v_mfma_f32_16x16x32_bf16 v[172:175], v[88:91], v[124:127], v[172:175]
s_add_u32 s72, s71, 0
buffer_load_dwordx4 v6, s[12:15], s72 offen lds
v_mfma_f32_16x16x32_bf16 v[188:191], v[92:95], v[124:127], v[188:191]
s_add_u32 s72, s71, 31744
buffer_load_dwordx4 v6, s[12:15], s72 offen offset:1024 lds
v_mfma_f32_16x16x32_bf16 v[184:187], v[92:95], v[120:123], v[184:187]
s_add_u32 s72, s71, 63488
buffer_load_dwordx4 v7, s[12:15], s72 offen offset:2048 lds
v_mfma_f32_16x16x32_bf16 v[180:183], v[92:95], v[116:119], v[180:183]
s_add_u32 s72, s71, 95232
buffer_load_dwordx4 v7, s[12:15], s72 offen offset:3072 lds
v_mfma_f32_16x16x32_bf16 v[176:179], v[92:95], v[112:115], v[176:179]
s_add_u32 s80, s77, 33792
ds_read_b64_tr_b16 v[54:55], v13 offset:17408
v_accvgpr_read_b32 v24, a208
v_mfma_f32_16x16x32_bf16 v[192:195], v[96:99], v[112:115], v[192:195]
ds_read_b64_tr_b16 v[56:57], v14 offset:16384
v_accvgpr_read_b32 v28, a209
v_mfma_f32_16x16x32_bf16 v[196:199], v[96:99], v[116:119], v[196:199]
ds_read_b64_tr_b16 v[58:59], v14 offset:17408
v_accvgpr_read_b32 v25, a210
v_mfma_f32_16x16x32_bf16 v[200:203], v[96:99], v[120:123], v[200:203]
ds_read_b64_tr_b16 v[60:61], v15 offset:16384
v_accvgpr_read_b32 v29, a211
v_mfma_f32_16x16x32_bf16 v[204:207], v[96:99], v[124:127], v[204:207]
s_add_u32 m0, s63, 131072
ds_read_b64_tr_b16 v[62:63], v15 offset:17408
v_accvgpr_read_b32 v26, a212
v_mfma_f32_16x16x32_bf16 v[220:223], v[100:103], v[124:127], v[220:223]
s_add_u32 s72, s69, 0
buffer_load_dwordx4 v4, s[4:7], s72 offen lds
v_mfma_f32_16x16x32_bf16 v[216:219], v[100:103], v[120:123], v[216:219]
buffer_store_dwordx4 v[20:23], v1, s[44:47], s80 offen sc1
v_mfma_f32_16x16x32_bf16 v[212:215], v[100:103], v[116:119], v[212:215]
v_accvgpr_read_b32 v30, a213
v_accvgpr_read_b32 v27, a214
v_mfma_f32_16x16x32_bf16 v[208:211], v[100:103], v[112:115], v[208:211]
v_accvgpr_read_b32 v31, a215
v_cvt_pk_bf16_f32 v24, v24, v28
v_mfma_f32_16x16x32_bf16 v[224:227], v[104:107], v[112:115], v[224:227]
s_add_u32 s72, s69, 15360
buffer_load_dwordx4 v5, s[4:7], s72 offen offset:1024 lds
v_mfma_f32_16x16x32_bf16 v[228:231], v[104:107], v[116:119], v[228:231]
v_cvt_pk_bf16_f32 v25, v25, v29
v_cvt_pk_bf16_f32 v26, v26, v30
v_mfma_f32_16x16x32_bf16 v[232:235], v[104:107], v[120:123], v[232:235]
v_cvt_pk_bf16_f32 v27, v27, v31
v_mfma_f32_16x16x32_bf16 v[236:239], v[104:107], v[124:127], v[236:239]
s_add_u32 s80, s78, 34816
buffer_store_dwordx4 v[24:27], v1, s[44:47], s80 offen sc1
v_mfma_f32_16x16x32_bf16 v[252:255], v[108:111], v[124:127], v[252:255]
v_mfma_f32_16x16x32_bf16 v[248:251], v[108:111], v[120:123], v[248:251]
s_add_u32 s72, s69, 129024
buffer_load_dwordx4 v4, s[4:7], s72 offen offset:2048 lds
v_mfma_f32_16x16x32_bf16 v[244:247], v[108:111], v[116:119], v[244:247]
v_mfma_f32_16x16x32_bf16 v[240:243], v[108:111], v[112:115], v[240:243]
s_waitcnt lgkmcnt(0)
v_mfma_f32_16x16x32_bf16 v[128:131], v[32:35], v[64:67], v[128:131]
ds_read_b64_tr_b16 v[80:81], v8 offset:24576
ds_read_b64_tr_b16 v[82:83], v8 offset:25600
v_mfma_f32_16x16x32_bf16 v[132:135], v[32:35], v[68:71], v[132:135]
ds_read_b128 v[112:115], v19 offset:0
ds_read_b128 v[116:119], v19 offset:2048
v_mfma_f32_16x16x32_bf16 v[136:139], v[32:35], v[72:75], v[136:139]
s_add_u32 s72, s69, 144384
buffer_load_dwordx4 v5, s[4:7], s72 offen offset:3072 lds
v_mfma_f32_16x16x32_bf16 v[140:143], v[32:35], v[76:79], v[140:143]
ds_read_b128 v[120:123], v19 offset:4096
ds_read_b128 v[124:127], v19 offset:6144
v_mfma_f32_16x16x32_bf16 v[156:159], v[36:39], v[76:79], v[156:159]
ds_read_b64_tr_b16 v[84:85], v9 offset:24576
ds_read_b64_tr_b16 v[86:87], v9 offset:25600
v_mfma_f32_16x16x32_bf16 v[152:155], v[36:39], v[72:75], v[152:155]
ds_read_b64_tr_b16 v[88:89], v10 offset:24576
v_accvgpr_read_b32 v20, a84
v_mfma_f32_16x16x32_bf16 v[148:151], v[36:39], v[68:71], v[148:151]
ds_read_b64_tr_b16 v[90:91], v10 offset:25600
v_accvgpr_read_b32 v28, a85
v_mfma_f32_16x16x32_bf16 v[144:147], v[36:39], v[64:67], v[144:147]
s_add_u32 m0, s63, 135168
ds_read_b64_tr_b16 v[92:93], v11 offset:24576
v_accvgpr_read_b32 v21, a86
v_mfma_f32_16x16x32_bf16 v[160:163], v[40:43], v[64:67], v[160:163]
s_add_u32 s72, s70, 0
buffer_load_dwordx4 v4, s[4:7], s72 offen lds
v_mfma_f32_16x16x32_bf16 v[164:167], v[40:43], v[68:71], v[164:167]
ds_read_b64_tr_b16 v[94:95], v11 offset:25600
v_accvgpr_read_b32 v29, a87
v_mfma_f32_16x16x32_bf16 v[168:171], v[40:43], v[72:75], v[168:171]
ds_read_b64_tr_b16 v[96:97], v12 offset:24576
v_accvgpr_read_b32 v22, a116
v_mfma_f32_16x16x32_bf16 v[172:175], v[40:43], v[76:79], v[172:175]
ds_read_b64_tr_b16 v[98:99], v12 offset:25600
v_accvgpr_read_b32 v30, a117
v_mfma_f32_16x16x32_bf16 v[188:191], v[44:47], v[76:79], v[188:191]
s_add_u32 s72, s70, 15360
buffer_load_dwordx4 v5, s[4:7], s72 offen offset:1024 lds
v_mfma_f32_16x16x32_bf16 v[184:187], v[44:47], v[72:75], v[184:187]
ds_read_b64_tr_b16 v[100:101], v13 offset:24576
v_accvgpr_read_b32 v23, a118
v_mfma_f32_16x16x32_bf16 v[180:183], v[44:47], v[68:71], v[180:183]
ds_read_b64_tr_b16 v[102:103], v13 offset:25600
v_accvgpr_read_b32 v31, a119
v_mfma_f32_16x16x32_bf16 v[176:179], v[44:47], v[64:67], v[176:179]
ds_read_b64_tr_b16 v[104:105], v14 offset:24576
v_mul_f32 v20, s79, v20
v_mfma_f32_16x16x32_bf16 v[192:195], v[48:51], v[64:67], v[192:195]
ds_read_b64_tr_b16 v[106:107], v14 offset:25600
v_mul_f32 v28, s79, v28
v_mfma_f32_16x16x32_bf16 v[196:199], v[48:51], v[68:71], v[196:199]
s_add_u32 s72, s70, 129024
buffer_load_dwordx4 v4, s[4:7], s72 offen offset:2048 lds
v_mfma_f32_16x16x32_bf16 v[200:203], v[48:51], v[72:75], v[200:203]
ds_read_b64_tr_b16 v[108:109], v15 offset:24576
v_mul_f32 v21, s79, v21
v_mfma_f32_16x16x32_bf16 v[204:207], v[48:51], v[76:79], v[204:207]
ds_read_b64_tr_b16 v[110:111], v15 offset:25600
v_mul_f32 v29, s79, v29
v_mfma_f32_16x16x32_bf16 v[220:223], v[52:55], v[76:79], v[220:223]
v_mul_f32 v22, s79, v22
v_mul_f32 v30, s79, v30
v_mfma_f32_16x16x32_bf16 v[216:219], v[52:55], v[72:75], v[216:219]
v_mul_f32 v23, s79, v23
v_mul_f32 v31, s79, v31
v_mfma_f32_16x16x32_bf16 v[212:215], v[52:55], v[68:71], v[212:215]
s_add_u32 s72, s70, 144384
buffer_load_dwordx4 v5, s[4:7], s72 offen offset:3072 lds
v_mfma_f32_16x16x32_bf16 v[208:211], v[52:55], v[64:67], v[208:211]
v_cvt_pk_bf16_f32 v20, v20, v28
v_cvt_pk_bf16_f32 v21, v21, v29
v_mfma_f32_16x16x32_bf16 v[224:227], v[56:59], v[64:67], v[224:227]
v_cvt_pk_bf16_f32 v22, v22, v30
v_cvt_pk_bf16_f32 v23, v23, v31
v_mfma_f32_16x16x32_bf16 v[228:231], v[56:59], v[68:71], v[228:231]
s_add_u32 s80, s77, 37888
buffer_store_dwordx4 v[20:23], v1, s[44:47], s80 offen sc1
v_mfma_f32_16x16x32_bf16 v[232:235], v[56:59], v[72:75], v[232:235]
v_accvgpr_read_b32 v24, a216
v_accvgpr_read_b32 v28, a217
v_mfma_f32_16x16x32_bf16 v[236:239], v[56:59], v[76:79], v[236:239]
v_accvgpr_read_b32 v25, a218
v_accvgpr_read_b32 v29, a219
v_mfma_f32_16x16x32_bf16 v[252:255], v[60:63], v[76:79], v[252:255]
v_accvgpr_read_b32 v26, a220
v_accvgpr_read_b32 v30, a221
v_mfma_f32_16x16x32_bf16 v[248:251], v[60:63], v[72:75], v[248:251]
v_accvgpr_read_b32 v27, a222
v_accvgpr_read_b32 v31, a223
v_mfma_f32_16x16x32_bf16 v[244:247], v[60:63], v[68:71], v[244:247]
s_waitcnt vmcnt(15) lgkmcnt(0)
v_cvt_pk_bf16_f32 v24, v24, v28
v_cvt_pk_bf16_f32 v25, v25, v29
v_mfma_f32_16x16x32_bf16 v[240:243], v[60:63], v[64:67], v[240:243]
s_barrier
v_cvt_pk_bf16_f32 v26, v26, v30
v_cvt_pk_bf16_f32 v27, v27, v31
v_mfma_f32_16x16x32_bf16 v[128:131], v[80:83], v[112:115], v[128:131]
s_add_u32 s73, s62, 10
ds_read_b64_tr_b16 v[32:33], v8 offset:32768
ds_read_b64_tr_b16 v[34:35], v8 offset:33792
v_mfma_f32_16x16x32_bf16 v[132:135], v[80:83], v[116:119], v[132:135]
s_add_u32 s70, s73, s65
ds_read_b128 v[64:67], v18 offset:32768
ds_read_b128 v[68:71], v18 offset:34816
v_mfma_f32_16x16x32_bf16 v[136:139], v[80:83], v[120:123], v[136:139]
s_and_b32 s70, s70, 3
ds_read_b128 v[72:75], v18 offset:36864
ds_read_b128 v[76:79], v18 offset:38912
v_mfma_f32_16x16x32_bf16 v[140:143], v[80:83], v[124:127], v[140:143]
s_and_b32 s73, s73, 12
ds_read_b64_tr_b16 v[36:37], v9 offset:32768
ds_read_b64_tr_b16 v[38:39], v9 offset:33792
v_mfma_f32_16x16x32_bf16 v[156:159], v[84:87], v[124:127], v[156:159]
s_or_b32 s73, s73, s70
ds_read_b64_tr_b16 v[40:41], v10 offset:32768
v_mfma_f32_16x16x32_bf16 v[152:155], v[84:87], v[120:123], v[152:155]
s_lshl_b32 s71, s73, 19
ds_read_b64_tr_b16 v[42:43], v10 offset:33792
v_mfma_f32_16x16x32_bf16 v[148:151], v[84:87], v[116:119], v[148:151]
s_add_u32 s71, s71, s66
ds_read_b64_tr_b16 v[44:45], v11 offset:32768
v_mfma_f32_16x16x32_bf16 v[144:147], v[84:87], v[112:115], v[144:147]
s_lshl_b32 s73, s73, 7
ds_read_b64_tr_b16 v[46:47], v11 offset:33792
v_mfma_f32_16x16x32_bf16 v[160:163], v[88:91], v[112:115], v[160:163]
s_add_u32 s69, s73, s67
ds_read_b64_tr_b16 v[48:49], v12 offset:32768
v_accvgpr_read_b32 v20, a88
v_mfma_f32_16x16x32_bf16 v[164:167], v[88:91], v[116:119], v[164:167]
s_add_u32 s70, s73, s68
ds_read_b64_tr_b16 v[50:51], v12 offset:33792
v_accvgpr_read_b32 v28, a89
v_mfma_f32_16x16x32_bf16 v[168:171], v[88:91], v[120:123], v[168:171]
s_add_u32 m0, s64, 16384
ds_read_b64_tr_b16 v[52:53], v13 offset:32768
v_accvgpr_read_b32 v21, a90
v_mfma_f32_16x16x32_bf16 v[172:175], v[88:91], v[124:127], v[172:175]
s_add_u32 s72, s71, 0
buffer_load_dwordx4 v6, s[12:15], s72 offen lds
v_mfma_f32_16x16x32_bf16 v[188:191], v[92:95], v[124:127], v[188:191]
s_add_u32 s72, s71, 31744
buffer_load_dwordx4 v6, s[12:15], s72 offen offset:1024 lds
v_mfma_f32_16x16x32_bf16 v[184:187], v[92:95], v[120:123], v[184:187]
s_add_u32 s72, s71, 63488
buffer_load_dwordx4 v7, s[12:15], s72 offen offset:2048 lds
v_mfma_f32_16x16x32_bf16 v[180:183], v[92:95], v[116:119], v[180:183]
s_add_u32 s72, s71, 95232
buffer_load_dwordx4 v7, s[12:15], s72 offen offset:3072 lds
v_mfma_f32_16x16x32_bf16 v[176:179], v[92:95], v[112:115], v[176:179]
s_add_u32 s80, s78, 43008
ds_read_b64_tr_b16 v[54:55], v13 offset:33792
v_accvgpr_read_b32 v29, a91
v_mfma_f32_16x16x32_bf16 v[192:195], v[96:99], v[112:115], v[192:195]
ds_read_b64_tr_b16 v[56:57], v14 offset:32768
v_accvgpr_read_b32 v22, a120
v_mfma_f32_16x16x32_bf16 v[196:199], v[96:99], v[116:119], v[196:199]
ds_read_b64_tr_b16 v[58:59], v14 offset:33792
v_accvgpr_read_b32 v30, a121
v_mfma_f32_16x16x32_bf16 v[200:203], v[96:99], v[120:123], v[200:203]
ds_read_b64_tr_b16 v[60:61], v15 offset:32768
v_accvgpr_read_b32 v23, a122
v_mfma_f32_16x16x32_bf16 v[204:207], v[96:99], v[124:127], v[204:207]
s_add_u32 m0, s63, 65536
ds_read_b64_tr_b16 v[62:63], v15 offset:33792
v_accvgpr_read_b32 v31, a123
v_mfma_f32_16x16x32_bf16 v[220:223], v[100:103], v[124:127], v[220:223]
s_add_u32 s72, s69, 0
buffer_load_dwordx4 v4, s[4:7], s72 offen lds
v_mfma_f32_16x16x32_bf16 v[216:219], v[100:103], v[120:123], v[216:219]
buffer_store_dwordx4 v[24:27], v1, s[44:47], s80 offen sc1
v_mfma_f32_16x16x32_bf16 v[212:215], v[100:103], v[116:119], v[212:215]
v_mul_f32 v20, s79, v20
v_mul_f32 v28, s79, v28
v_mfma_f32_16x16x32_bf16 v[208:211], v[100:103], v[112:115], v[208:211]
v_mul_f32 v21, s79, v21
v_mul_f32 v29, s79, v29
v_mfma_f32_16x16x32_bf16 v[224:227], v[104:107], v[112:115], v[224:227]
s_add_u32 s72, s69, 15360
buffer_load_dwordx4 v5, s[4:7], s72 offen offset:1024 lds
v_mfma_f32_16x16x32_bf16 v[228:231], v[104:107], v[116:119], v[228:231]
v_mul_f32 v22, s79, v22
v_mul_f32 v30, s79, v30
v_mfma_f32_16x16x32_bf16 v[232:235], v[104:107], v[120:123], v[232:235]
v_mul_f32 v23, s79, v23
v_mul_f32 v31, s79, v31
v_mfma_f32_16x16x32_bf16 v[236:239], v[104:107], v[124:127], v[236:239]
v_cvt_pk_bf16_f32 v20, v20, v28
v_cvt_pk_bf16_f32 v21, v21, v29
v_mfma_f32_16x16x32_bf16 v[252:255], v[108:111], v[124:127], v[252:255]
v_cvt_pk_bf16_f32 v22, v22, v30
v_cvt_pk_bf16_f32 v23, v23, v31
v_mfma_f32_16x16x32_bf16 v[248:251], v[108:111], v[120:123], v[248:251]
s_add_u32 s72, s69, 129024
buffer_load_dwordx4 v4, s[4:7], s72 offen offset:2048 lds
v_mfma_f32_16x16x32_bf16 v[244:247], v[108:111], v[116:119], v[244:247]
s_add_u32 s80, s77, 41984
buffer_store_dwordx4 v[20:23], v1, s[44:47], s80 offen sc1
v_mfma_f32_16x16x32_bf16 v[240:243], v[108:111], v[112:115], v[240:243]
s_waitcnt lgkmcnt(0)
v_accvgpr_read_b32 v24, a224
v_accvgpr_read_b32 v28, a225
LcB1:
v_mfma_f32_16x16x32_bf16 v[128:131], v[32:35], v[64:67], v[128:131]
ds_read_b64_tr_b16 v[80:81], v8 offset:40960
ds_read_b64_tr_b16 v[82:83], v8 offset:41984
v_mfma_f32_16x16x32_bf16 v[132:135], v[32:35], v[68:71], v[132:135]
ds_read_b128 v[112:115], v19 offset:32768
ds_read_b128 v[116:119], v19 offset:34816
v_mfma_f32_16x16x32_bf16 v[136:139], v[32:35], v[72:75], v[136:139]
s_add_u32 s72, s69, 144384
buffer_load_dwordx4 v5, s[4:7], s72 offen offset:3072 lds
v_mfma_f32_16x16x32_bf16 v[140:143], v[32:35], v[76:79], v[140:143]
ds_read_b128 v[120:123], v19 offset:36864
ds_read_b128 v[124:127], v19 offset:38912
v_mfma_f32_16x16x32_bf16 v[156:159], v[36:39], v[76:79], v[156:159]
ds_read_b64_tr_b16 v[84:85], v9 offset:40960
ds_read_b64_tr_b16 v[86:87], v9 offset:41984
v_mfma_f32_16x16x32_bf16 v[152:155], v[36:39], v[72:75], v[152:155]
ds_read_b64_tr_b16 v[88:89], v10 offset:40960
v_accvgpr_read_b32 v25, a226
v_mfma_f32_16x16x32_bf16 v[148:151], v[36:39], v[68:71], v[148:151]
ds_read_b64_tr_b16 v[90:91], v10 offset:41984
v_accvgpr_read_b32 v29, a227
v_mfma_f32_16x16x32_bf16 v[144:147], v[36:39], v[64:67], v[144:147]
s_add_u32 m0, s63, 69632
ds_read_b64_tr_b16 v[92:93], v11 offset:40960
v_accvgpr_read_b32 v26, a228
v_mfma_f32_16x16x32_bf16 v[160:163], v[40:43], v[64:67], v[160:163]
s_add_u32 s72, s70, 0
buffer_load_dwordx4 v4, s[4:7], s72 offen lds
v_mfma_f32_16x16x32_bf16 v[164:167], v[40:43], v[68:71], v[164:167]
ds_read_b64_tr_b16 v[94:95], v11 offset:41984
v_accvgpr_read_b32 v30, a229
v_mfma_f32_16x16x32_bf16 v[168:171], v[40:43], v[72:75], v[168:171]
ds_read_b64_tr_b16 v[96:97], v12 offset:40960
v_accvgpr_read_b32 v27, a230
v_mfma_f32_16x16x32_bf16 v[172:175], v[40:43], v[76:79], v[172:175]
ds_read_b64_tr_b16 v[98:99], v12 offset:41984
v_accvgpr_read_b32 v31, a231
v_mfma_f32_16x16x32_bf16 v[188:191], v[44:47], v[76:79], v[188:191]
s_add_u32 s72, s70, 15360
buffer_load_dwordx4 v5, s[4:7], s72 offen offset:1024 lds
v_mfma_f32_16x16x32_bf16 v[184:187], v[44:47], v[72:75], v[184:187]
ds_read_b64_tr_b16 v[100:101], v13 offset:40960
v_cvt_pk_bf16_f32 v24, v24, v28
v_mfma_f32_16x16x32_bf16 v[180:183], v[44:47], v[68:71], v[180:183]
ds_read_b64_tr_b16 v[102:103], v13 offset:41984
v_cvt_pk_bf16_f32 v25, v25, v29
v_mfma_f32_16x16x32_bf16 v[176:179], v[44:47], v[64:67], v[176:179]
ds_read_b64_tr_b16 v[104:105], v14 offset:40960
v_cvt_pk_bf16_f32 v26, v26, v30
v_mfma_f32_16x16x32_bf16 v[192:195], v[48:51], v[64:67], v[192:195]
ds_read_b64_tr_b16 v[106:107], v14 offset:41984
v_cvt_pk_bf16_f32 v27, v27, v31
v_mfma_f32_16x16x32_bf16 v[196:199], v[48:51], v[68:71], v[196:199]
s_add_u32 s72, s70, 129024
buffer_load_dwordx4 v4, s[4:7], s72 offen offset:2048 lds
v_mfma_f32_16x16x32_bf16 v[200:203], v[48:51], v[72:75], v[200:203]
s_add_u32 s80, s78, 3072
ds_read_b64_tr_b16 v[108:109], v15 offset:40960
v_accvgpr_read_b32 v20, a92
v_mfma_f32_16x16x32_bf16 v[204:207], v[48:51], v[76:79], v[204:207]
ds_read_b64_tr_b16 v[110:111], v15 offset:41984
v_accvgpr_read_b32 v28, a93
v_mfma_f32_16x16x32_bf16 v[220:223], v[52:55], v[76:79], v[220:223]
buffer_store_dwordx4 v[24:27], v1, s[44:47], s80 offen sc1
v_mfma_f32_16x16x32_bf16 v[216:219], v[52:55], v[72:75], v[216:219]
v_accvgpr_read_b32 v21, a94
v_accvgpr_read_b32 v29, a95
v_mfma_f32_16x16x32_bf16 v[212:215], v[52:55], v[68:71], v[212:215]
s_add_u32 s72, s70, 144384
buffer_load_dwordx4 v5, s[4:7], s72 offen offset:3072 lds
v_mfma_f32_16x16x32_bf16 v[208:211], v[52:55], v[64:67], v[208:211]
v_accvgpr_read_b32 v22, a124
v_accvgpr_read_b32 v30, a125
v_mfma_f32_16x16x32_bf16 v[224:227], v[56:59], v[64:67], v[224:227]
v_accvgpr_read_b32 v23, a126
v_accvgpr_read_b32 v31, a127
v_mfma_f32_16x16x32_bf16 v[228:231], v[56:59], v[68:71], v[228:231]
v_mul_f32 v20, s79, v20
v_mul_f32 v28, s79, v28
v_mfma_f32_16x16x32_bf16 v[232:235], v[56:59], v[72:75], v[232:235]
v_mul_f32 v21, s79, v21
v_mul_f32 v29, s79, v29
v_mfma_f32_16x16x32_bf16 v[236:239], v[56:59], v[76:79], v[236:239]
v_mul_f32 v22, s79, v22
v_mul_f32 v30, s79, v30
v_mfma_f32_16x16x32_bf16 v[252:255], v[60:63], v[76:79], v[252:255]
v_mul_f32 v23, s79, v23
v_mul_f32 v31, s79, v31
v_mfma_f32_16x16x32_bf16 v[248:251], v[60:63], v[72:75], v[248:251]
v_cvt_pk_bf16_f32 v20, v20, v28
v_cvt_pk_bf16_f32 v21, v21, v29
v_mfma_f32_16x16x32_bf16 v[244:247], v[60:63], v[68:71], v[244:247]
s_waitcnt vmcnt(16) lgkmcnt(0)
v_cvt_pk_bf16_f32 v22, v22, v30
v_cvt_pk_bf16_f32 v23, v23, v31
v_mfma_f32_16x16x32_bf16 v[240:243], v[60:63], v[64:67], v[240:243]
s_barrier
v_mfma_f32_16x16x32_bf16 v[128:131], v[80:83], v[112:115], v[128:131]
s_add_u32 s73, s62, 11
ds_read_b64_tr_b16 v[32:33], v8 offset:0
ds_read_b64_tr_b16 v[34:35], v8 offset:1024
v_mfma_f32_16x16x32_bf16 v[132:135], v[80:83], v[116:119], v[132:135]
s_add_u32 s70, s73, s65
ds_read_b128 v[64:67], v16 offset:0
ds_read_b128 v[68:71], v16 offset:2048
v_mfma_f32_16x16x32_bf16 v[136:139], v[80:83], v[120:123], v[136:139]
s_and_b32 s70, s70, 3
ds_read_b128 v[72:75], v16 offset:4096
ds_read_b128 v[76:79], v16 offset:6144
v_mfma_f32_16x16x32_bf16 v[140:143], v[80:83], v[124:127], v[140:143]
s_and_b32 s73, s73, 12
ds_read_b64_tr_b16 v[36:37], v9 offset:0
ds_read_b64_tr_b16 v[38:39], v9 offset:1024
v_mfma_f32_16x16x32_bf16 v[156:159], v[84:87], v[124:127], v[156:159]
s_or_b32 s73, s73, s70
ds_read_b64_tr_b16 v[40:41], v10 offset:0
v_mfma_f32_16x16x32_bf16 v[152:155], v[84:87], v[120:123], v[152:155]
s_lshl_b32 s71, s73, 19
ds_read_b64_tr_b16 v[42:43], v10 offset:1024
v_accvgpr_read_b32 v24, a232
v_mfma_f32_16x16x32_bf16 v[148:151], v[84:87], v[116:119], v[148:151]
s_add_u32 s71, s71, s66
ds_read_b64_tr_b16 v[44:45], v11 offset:0
v_accvgpr_read_b32 v28, a233
v_mfma_f32_16x16x32_bf16 v[144:147], v[84:87], v[112:115], v[144:147]
s_lshl_b32 s73, s73, 7
ds_read_b64_tr_b16 v[46:47], v11 offset:1024
v_accvgpr_read_b32 v25, a234
v_mfma_f32_16x16x32_bf16 v[160:163], v[88:91], v[112:115], v[160:163]
s_add_u32 s69, s73, s67
ds_read_b64_tr_b16 v[48:49], v12 offset:0
v_accvgpr_read_b32 v29, a235
v_mfma_f32_16x16x32_bf16 v[164:167], v[88:91], v[116:119], v[164:167]
s_add_u32 s70, s73, s68
ds_read_b64_tr_b16 v[50:51], v12 offset:1024
v_accvgpr_read_b32 v26, a236
v_mfma_f32_16x16x32_bf16 v[168:171], v[88:91], v[120:123], v[168:171]
s_add_u32 m0, s64, 32768
ds_read_b64_tr_b16 v[52:53], v13 offset:0
v_accvgpr_read_b32 v30, a237
v_mfma_f32_16x16x32_bf16 v[172:175], v[88:91], v[124:127], v[172:175]
s_add_u32 s72, s71, 0
buffer_load_dwordx4 v6, s[12:15], s72 offen lds
v_mfma_f32_16x16x32_bf16 v[188:191], v[92:95], v[124:127], v[188:191]
s_add_u32 s72, s71, 31744
buffer_load_dwordx4 v6, s[12:15], s72 offen offset:1024 lds
v_mfma_f32_16x16x32_bf16 v[184:187], v[92:95], v[120:123], v[184:187]
s_add_u32 s72, s71, 63488
buffer_load_dwordx4 v7, s[12:15], s72 offen offset:2048 lds
v_mfma_f32_16x16x32_bf16 v[180:183], v[92:95], v[116:119], v[180:183]
s_add_u32 s72, s71, 95232
buffer_load_dwordx4 v7, s[12:15], s72 offen offset:3072 lds
v_mfma_f32_16x16x32_bf16 v[176:179], v[92:95], v[112:115], v[176:179]
s_add_u32 s80, s77, 46080
ds_read_b64_tr_b16 v[54:55], v13 offset:1024
v_accvgpr_read_b32 v27, a238
v_mfma_f32_16x16x32_bf16 v[192:195], v[96:99], v[112:115], v[192:195]
ds_read_b64_tr_b16 v[56:57], v14 offset:0
v_accvgpr_read_b32 v31, a239
v_mfma_f32_16x16x32_bf16 v[196:199], v[96:99], v[116:119], v[196:199]
ds_read_b64_tr_b16 v[58:59], v14 offset:1024
v_cvt_pk_bf16_f32 v24, v24, v28
v_mfma_f32_16x16x32_bf16 v[200:203], v[96:99], v[120:123], v[200:203]
ds_read_b64_tr_b16 v[60:61], v15 offset:0
v_cvt_pk_bf16_f32 v25, v25, v29
v_mfma_f32_16x16x32_bf16 v[204:207], v[96:99], v[124:127], v[204:207]
s_add_u32 m0, s63, 98304
ds_read_b64_tr_b16 v[62:63], v15 offset:1024
v_cvt_pk_bf16_f32 v26, v26, v30
v_mfma_f32_16x16x32_bf16 v[220:223], v[100:103], v[124:127], v[220:223]
s_add_u32 s72, s69, 0
buffer_load_dwordx4 v4, s[4:7], s72 offen lds
v_mfma_f32_16x16x32_bf16 v[216:219], v[100:103], v[120:123], v[216:219]
buffer_store_dwordx4 v[20:23], v1, s[44:47], s80 offen sc1
v_mfma_f32_16x16x32_bf16 v[212:215], v[100:103], v[116:119], v[212:215]
v_cvt_pk_bf16_f32 v27, v27, v31
v_mfma_f32_16x16x32_bf16 v[208:211], v[100:103], v[112:115], v[208:211]
s_add_u32 s80, s78, 11264
buffer_store_dwordx4 v[24:27], v1, s[44:47], s80 offen sc1
v_mfma_f32_16x16x32_bf16 v[224:227], v[104:107], v[112:115], v[224:227]
s_add_u32 s72, s69, 15360
buffer_load_dwordx4 v5, s[4:7], s72 offen offset:1024 lds
v_mfma_f32_16x16x32_bf16 v[228:231], v[104:107], v[116:119], v[228:231]
v_accvgpr_read_b32 v20, a240
v_accvgpr_read_b32 v28, a241
v_mfma_f32_16x16x32_bf16 v[232:235], v[104:107], v[120:123], v[232:235]
v_accvgpr_read_b32 v21, a242
v_accvgpr_read_b32 v29, a243
v_mfma_f32_16x16x32_bf16 v[236:239], v[104:107], v[124:127], v[236:239]
v_accvgpr_read_b32 v22, a244
v_accvgpr_read_b32 v30, a245
v_mfma_f32_16x16x32_bf16 v[252:255], v[108:111], v[124:127], v[252:255]
v_accvgpr_read_b32 v23, a246
v_accvgpr_read_b32 v31, a247
v_mfma_f32_16x16x32_bf16 v[248:251], v[108:111], v[120:123], v[248:251]
s_add_u32 s72, s69, 129024
buffer_load_dwordx4 v4, s[4:7], s72 offen offset:2048 lds
v_mfma_f32_16x16x32_bf16 v[244:247], v[108:111], v[116:119], v[244:247]
v_cvt_pk_bf16_f32 v20, v20, v28
v_cvt_pk_bf16_f32 v21, v21, v29
v_mfma_f32_16x16x32_bf16 v[240:243], v[108:111], v[112:115], v[240:243]
s_waitcnt lgkmcnt(0)
v_cvt_pk_bf16_f32 v22, v22, v30
v_cvt_pk_bf16_f32 v23, v23, v31
v_mfma_f32_16x16x32_bf16 v[128:131], v[32:35], v[64:67], v[128:131]
s_add_u32 s80, s78, 35840
ds_read_b64_tr_b16 v[80:81], v8 offset:8192
ds_read_b64_tr_b16 v[82:83], v8 offset:9216
v_mfma_f32_16x16x32_bf16 v[132:135], v[32:35], v[68:71], v[132:135]
ds_read_b128 v[112:115], v17 offset:0
ds_read_b128 v[116:119], v17 offset:2048
v_mfma_f32_16x16x32_bf16 v[136:139], v[32:35], v[72:75], v[136:139]
s_add_u32 s72, s69, 144384
buffer_load_dwordx4 v5, s[4:7], s72 offen offset:3072 lds
v_mfma_f32_16x16x32_bf16 v[140:143], v[32:35], v[76:79], v[140:143]
ds_read_b128 v[120:123], v17 offset:4096
ds_read_b128 v[124:127], v17 offset:6144
v_mfma_f32_16x16x32_bf16 v[156:159], v[36:39], v[76:79], v[156:159]
ds_read_b64_tr_b16 v[84:85], v9 offset:8192
ds_read_b64_tr_b16 v[86:87], v9 offset:9216
v_mfma_f32_16x16x32_bf16 v[152:155], v[36:39], v[72:75], v[152:155]
ds_read_b64_tr_b16 v[88:89], v10 offset:8192
v_mfma_f32_16x16x32_bf16 v[148:151], v[36:39], v[68:71], v[148:151]
ds_read_b64_tr_b16 v[90:91], v10 offset:9216
v_mfma_f32_16x16x32_bf16 v[144:147], v[36:39], v[64:67], v[144:147]
s_add_u32 m0, s63, 102400
ds_read_b64_tr_b16 v[92:93], v11 offset:8192
v_mfma_f32_16x16x32_bf16 v[160:163], v[40:43], v[64:67], v[160:163]
s_add_u32 s72, s70, 0
buffer_load_dwordx4 v4, s[4:7], s72 offen lds
v_mfma_f32_16x16x32_bf16 v[164:167], v[40:43], v[68:71], v[164:167]
ds_read_b64_tr_b16 v[94:95], v11 offset:9216
v_mfma_f32_16x16x32_bf16 v[168:171], v[40:43], v[72:75], v[168:171]
ds_read_b64_tr_b16 v[96:97], v12 offset:8192
v_mfma_f32_16x16x32_bf16 v[172:175], v[40:43], v[76:79], v[172:175]
ds_read_b64_tr_b16 v[98:99], v12 offset:9216
v_mfma_f32_16x16x32_bf16 v[188:191], v[44:47], v[76:79], v[188:191]
s_add_u32 s72, s70, 15360
buffer_load_dwordx4 v5, s[4:7], s72 offen offset:1024 lds
v_mfma_f32_16x16x32_bf16 v[184:187], v[44:47], v[72:75], v[184:187]
ds_read_b64_tr_b16 v[100:101], v13 offset:8192
v_accvgpr_read_b32 v24, a248
v_mfma_f32_16x16x32_bf16 v[180:183], v[44:47], v[68:71], v[180:183]
ds_read_b64_tr_b16 v[102:103], v13 offset:9216
v_accvgpr_read_b32 v28, a249
v_mfma_f32_16x16x32_bf16 v[176:179], v[44:47], v[64:67], v[176:179]
ds_read_b64_tr_b16 v[104:105], v14 offset:8192
v_accvgpr_read_b32 v25, a250
v_mfma_f32_16x16x32_bf16 v[192:195], v[48:51], v[64:67], v[192:195]
ds_read_b64_tr_b16 v[106:107], v14 offset:9216
v_accvgpr_read_b32 v29, a251
v_mfma_f32_16x16x32_bf16 v[196:199], v[48:51], v[68:71], v[196:199]
s_add_u32 s72, s70, 129024
buffer_load_dwordx4 v4, s[4:7], s72 offen offset:2048 lds
v_mfma_f32_16x16x32_bf16 v[200:203], v[48:51], v[72:75], v[200:203]
ds_read_b64_tr_b16 v[108:109], v15 offset:8192
v_accvgpr_read_b32 v26, a252
v_mfma_f32_16x16x32_bf16 v[204:207], v[48:51], v[76:79], v[204:207]
ds_read_b64_tr_b16 v[110:111], v15 offset:9216
v_accvgpr_read_b32 v30, a253
v_mfma_f32_16x16x32_bf16 v[220:223], v[52:55], v[76:79], v[220:223]
buffer_store_dwordx4 v[20:23], v1, s[44:47], s80 offen sc1
v_mfma_f32_16x16x32_bf16 v[216:219], v[52:55], v[72:75], v[216:219]
v_accvgpr_read_b32 v27, a254
v_accvgpr_read_b32 v31, a255
v_mfma_f32_16x16x32_bf16 v[212:215], v[52:55], v[68:71], v[212:215]
s_add_u32 s72, s70, 144384
buffer_load_dwordx4 v5, s[4:7], s72 offen offset:3072 lds
v_mfma_f32_16x16x32_bf16 v[208:211], v[52:55], v[64:67], v[208:211]
v_cvt_pk_bf16_f32 v24, v24, v28
v_cvt_pk_bf16_f32 v25, v25, v29
v_mfma_f32_16x16x32_bf16 v[224:227], v[56:59], v[64:67], v[224:227]
v_cvt_pk_bf16_f32 v26, v26, v30
v_cvt_pk_bf16_f32 v27, v27, v31
v_mfma_f32_16x16x32_bf16 v[228:231], v[56:59], v[68:71], v[228:231]
s_add_u32 s80, s78, 44032
buffer_store_dwordx4 v[24:27], v1, s[44:47], s80 offen sc1
v_mfma_f32_16x16x32_bf16 v[232:235], v[56:59], v[72:75], v[232:235]
v_mfma_f32_16x16x32_bf16 v[236:239], v[56:59], v[76:79], v[236:239]
v_mfma_f32_16x16x32_bf16 v[252:255], v[60:63], v[76:79], v[252:255]
v_mfma_f32_16x16x32_bf16 v[248:251], v[60:63], v[72:75], v[248:251]
v_mfma_f32_16x16x32_bf16 v[244:247], v[60:63], v[68:71], v[244:247]
s_waitcnt vmcnt(16) lgkmcnt(0)
v_mfma_f32_16x16x32_bf16 v[240:243], v[60:63], v[64:67], v[240:243]
s_barrier
v_mfma_f32_16x16x32_bf16 v[128:131], v[80:83], v[112:115], v[128:131]
s_add_u32 s73, s62, 12
ds_read_b64_tr_b16 v[32:33], v8 offset:16384
ds_read_b64_tr_b16 v[34:35], v8 offset:17408
v_mfma_f32_16x16x32_bf16 v[132:135], v[80:83], v[116:119], v[132:135]
s_add_u32 s70, s73, s65
ds_read_b128 v[64:67], v18 offset:0
ds_read_b128 v[68:71], v18 offset:2048
v_mfma_f32_16x16x32_bf16 v[136:139], v[80:83], v[120:123], v[136:139]
s_and_b32 s70, s70, 3
v_and_b32 v2, 31, v0
v_lshlrev_b32 v2, 2, v2
v_mfma_f32_16x16x32_bf16 v[140:143], v[80:83], v[124:127], v[140:143]
s_and_b32 s73, s73, 12
buffer_load_dword v3, v2, s[48:51], 0 offen sc1
v_mfma_f32_16x16x32_bf16 v[156:159], v[84:87], v[124:127], v[156:159]
s_or_b32 s73, s73, s70
ds_read_b128 v[72:75], v18 offset:4096
ds_read_b128 v[76:79], v18 offset:6144
v_mfma_f32_16x16x32_bf16 v[152:155], v[84:87], v[120:123], v[152:155]
s_lshl_b32 s71, s73, 19
ds_read_b64_tr_b16 v[36:37], v9 offset:16384
ds_read_b64_tr_b16 v[38:39], v9 offset:17408
v_mfma_f32_16x16x32_bf16 v[148:151], v[84:87], v[116:119], v[148:151]
s_add_u32 s71, s71, s66
ds_read_b64_tr_b16 v[40:41], v10 offset:16384
v_mfma_f32_16x16x32_bf16 v[144:147], v[84:87], v[112:115], v[144:147]
s_lshl_b32 s73, s73, 7
ds_read_b64_tr_b16 v[42:43], v10 offset:17408
v_mfma_f32_16x16x32_bf16 v[160:163], v[88:91], v[112:115], v[160:163]
s_add_u32 s69, s73, s67
ds_read_b64_tr_b16 v[44:45], v11 offset:16384
v_mfma_f32_16x16x32_bf16 v[164:167], v[88:91], v[116:119], v[164:167]
s_add_u32 s70, s73, s68
ds_read_b64_tr_b16 v[46:47], v11 offset:17408
v_mfma_f32_16x16x32_bf16 v[168:171], v[88:91], v[120:123], v[168:171]
s_add_u32 m0, s64, 0
ds_read_b64_tr_b16 v[48:49], v12 offset:16384
v_mfma_f32_16x16x32_bf16 v[172:175], v[88:91], v[124:127], v[172:175]
s_add_u32 s72, s71, 0
buffer_load_dwordx4 v6, s[12:15], s72 offen lds
v_mfma_f32_16x16x32_bf16 v[188:191], v[92:95], v[124:127], v[188:191]
s_add_u32 s72, s71, 31744
buffer_load_dwordx4 v6, s[12:15], s72 offen offset:1024 lds
v_mfma_f32_16x16x32_bf16 v[184:187], v[92:95], v[120:123], v[184:187]
s_add_u32 s72, s71, 63488
buffer_load_dwordx4 v7, s[12:15], s72 offen offset:2048 lds
v_mfma_f32_16x16x32_bf16 v[180:183], v[92:95], v[116:119], v[180:183]
s_add_u32 s72, s71, 95232
buffer_load_dwordx4 v7, s[12:15], s72 offen offset:3072 lds
v_mfma_f32_16x16x32_bf16 v[176:179], v[92:95], v[112:115], v[176:179]
ds_read_b64_tr_b16 v[50:51], v12 offset:17408
v_mfma_f32_16x16x32_bf16 v[192:195], v[96:99], v[112:115], v[192:195]
ds_read_b64_tr_b16 v[52:53], v13 offset:16384
v_mfma_f32_16x16x32_bf16 v[196:199], v[96:99], v[116:119], v[196:199]
ds_read_b64_tr_b16 v[54:55], v13 offset:17408
v_mfma_f32_16x16x32_bf16 v[200:203], v[96:99], v[120:123], v[200:203]
ds_read_b64_tr_b16 v[56:57], v14 offset:16384
v_mfma_f32_16x16x32_bf16 v[204:207], v[96:99], v[124:127], v[204:207]
s_add_u32 m0, s63, 131072
ds_read_b64_tr_b16 v[58:59], v14 offset:17408
v_mfma_f32_16x16x32_bf16 v[220:223], v[100:103], v[124:127], v[220:223]
s_add_u32 s72, s69, 0
buffer_load_dwordx4 v4, s[4:7], s72 offen lds
v_mfma_f32_16x16x32_bf16 v[216:219], v[100:103], v[120:123], v[216:219]
ds_read_b64_tr_b16 v[60:61], v15 offset:16384
v_mfma_f32_16x16x32_bf16 v[212:215], v[100:103], v[116:119], v[212:215]
ds_read_b64_tr_b16 v[62:63], v15 offset:17408
v_mfma_f32_16x16x32_bf16 v[208:211], v[100:103], v[112:115], v[208:211]
v_mfma_f32_16x16x32_bf16 v[224:227], v[104:107], v[112:115], v[224:227]
s_add_u32 s72, s69, 15360
buffer_load_dwordx4 v5, s[4:7], s72 offen offset:1024 lds
v_mfma_f32_16x16x32_bf16 v[228:231], v[104:107], v[116:119], v[228:231]
v_mfma_f32_16x16x32_bf16 v[232:235], v[104:107], v[120:123], v[232:235]
v_mfma_f32_16x16x32_bf16 v[236:239], v[104:107], v[124:127], v[236:239]
v_mfma_f32_16x16x32_bf16 v[252:255], v[108:111], v[124:127], v[252:255]
v_mfma_f32_16x16x32_bf16 v[248:251], v[108:111], v[120:123], v[248:251]
s_add_u32 s72, s69, 129024
buffer_load_dwordx4 v4, s[4:7], s72 offen offset:2048 lds
v_mfma_f32_16x16x32_bf16 v[244:247], v[108:111], v[116:119], v[244:247]
v_mfma_f32_16x16x32_bf16 v[240:243], v[108:111], v[112:115], v[240:243]
s_waitcnt lgkmcnt(0)
v_mfma_f32_16x16x32_bf16 v[128:131], v[32:35], v[64:67], v[128:131]
ds_read_b64_tr_b16 v[80:81], v8 offset:24576
ds_read_b64_tr_b16 v[82:83], v8 offset:25600
v_mfma_f32_16x16x32_bf16 v[132:135], v[32:35], v[68:71], v[132:135]
ds_read_b128 v[112:115], v19 offset:0
ds_read_b128 v[116:119], v19 offset:2048
v_mfma_f32_16x16x32_bf16 v[136:139], v[32:35], v[72:75], v[136:139]
s_add_u32 s72, s69, 144384
buffer_load_dwordx4 v5, s[4:7], s72 offen offset:3072 lds
v_mfma_f32_16x16x32_bf16 v[140:143], v[32:35], v[76:79], v[140:143]
ds_read_b128 v[120:123], v19 offset:4096
ds_read_b128 v[124:127], v19 offset:6144
v_mfma_f32_16x16x32_bf16 v[156:159], v[36:39], v[76:79], v[156:159]
ds_read_b64_tr_b16 v[84:85], v9 offset:24576
ds_read_b64_tr_b16 v[86:87], v9 offset:25600
v_mfma_f32_16x16x32_bf16 v[152:155], v[36:39], v[72:75], v[152:155]
ds_read_b64_tr_b16 v[88:89], v10 offset:24576
v_mfma_f32_16x16x32_bf16 v[148:151], v[36:39], v[68:71], v[148:151]
ds_read_b64_tr_b16 v[90:91], v10 offset:25600
v_mfma_f32_16x16x32_bf16 v[144:147], v[36:39], v[64:67], v[144:147]
s_add_u32 m0, s63, 135168
ds_read_b64_tr_b16 v[92:93], v11 offset:24576
v_mfma_f32_16x16x32_bf16 v[160:163], v[40:43], v[64:67], v[160:163]
s_add_u32 s72, s70, 0
buffer_load_dwordx4 v4, s[4:7], s72 offen lds
v_mfma_f32_16x16x32_bf16 v[164:167], v[40:43], v[68:71], v[164:167]
ds_read_b64_tr_b16 v[94:95], v11 offset:25600
v_mfma_f32_16x16x32_bf16 v[168:171], v[40:43], v[72:75], v[168:171]
ds_read_b64_tr_b16 v[96:97], v12 offset:24576
v_mfma_f32_16x16x32_bf16 v[172:175], v[40:43], v[76:79], v[172:175]
ds_read_b64_tr_b16 v[98:99], v12 offset:25600
v_mfma_f32_16x16x32_bf16 v[188:191], v[44:47], v[76:79], v[188:191]
s_add_u32 s72, s70, 15360
buffer_load_dwordx4 v5, s[4:7], s72 offen offset:1024 lds
v_mfma_f32_16x16x32_bf16 v[184:187], v[44:47], v[72:75], v[184:187]
ds_read_b64_tr_b16 v[100:101], v13 offset:24576
v_mfma_f32_16x16x32_bf16 v[180:183], v[44:47], v[68:71], v[180:183]
ds_read_b64_tr_b16 v[102:103], v13 offset:25600
v_mfma_f32_16x16x32_bf16 v[176:179], v[44:47], v[64:67], v[176:179]
ds_read_b64_tr_b16 v[104:105], v14 offset:24576
v_mfma_f32_16x16x32_bf16 v[192:195], v[48:51], v[64:67], v[192:195]
ds_read_b64_tr_b16 v[106:107], v14 offset:25600
v_mfma_f32_16x16x32_bf16 v[196:199], v[48:51], v[68:71], v[196:199]
s_add_u32 s72, s70, 129024
buffer_load_dwordx4 v4, s[4:7], s72 offen offset:2048 lds
v_mfma_f32_16x16x32_bf16 v[200:203], v[48:51], v[72:75], v[200:203]
ds_read_b64_tr_b16 v[108:109], v15 offset:24576
v_mfma_f32_16x16x32_bf16 v[204:207], v[48:51], v[76:79], v[204:207]
ds_read_b64_tr_b16 v[110:111], v15 offset:25600
v_mfma_f32_16x16x32_bf16 v[220:223], v[52:55], v[76:79], v[220:223]
v_mfma_f32_16x16x32_bf16 v[216:219], v[52:55], v[72:75], v[216:219]
v_mfma_f32_16x16x32_bf16 v[212:215], v[52:55], v[68:71], v[212:215]
s_add_u32 s72, s70, 144384
buffer_load_dwordx4 v5, s[4:7], s72 offen offset:3072 lds
v_mfma_f32_16x16x32_bf16 v[208:211], v[52:55], v[64:67], v[208:211]
v_mfma_f32_16x16x32_bf16 v[224:227], v[56:59], v[64:67], v[224:227]
v_mfma_f32_16x16x32_bf16 v[228:231], v[56:59], v[68:71], v[228:231]
v_mfma_f32_16x16x32_bf16 v[232:235], v[56:59], v[72:75], v[232:235]
v_mfma_f32_16x16x32_bf16 v[236:239], v[56:59], v[76:79], v[236:239]
v_mfma_f32_16x16x32_bf16 v[252:255], v[60:63], v[76:79], v[252:255]
v_mfma_f32_16x16x32_bf16 v[248:251], v[60:63], v[72:75], v[248:251]
v_mfma_f32_16x16x32_bf16 v[244:247], v[60:63], v[68:71], v[244:247]
s_waitcnt vmcnt(13) lgkmcnt(0)
v_mfma_f32_16x16x32_bf16 v[240:243], v[60:63], v[64:67], v[240:243]
s_barrier
v_mfma_f32_16x16x32_bf16 v[128:131], v[80:83], v[112:115], v[128:131]
s_add_u32 s73, s62, 13
ds_read_b64_tr_b16 v[32:33], v8 offset:32768
ds_read_b64_tr_b16 v[34:35], v8 offset:33792
v_mfma_f32_16x16x32_bf16 v[132:135], v[80:83], v[116:119], v[132:135]
s_add_u32 s70, s73, s65
ds_read_b128 v[64:67], v18 offset:32768
ds_read_b128 v[68:71], v18 offset:34816
v_mfma_f32_16x16x32_bf16 v[136:139], v[80:83], v[120:123], v[136:139]
s_and_b32 s70, s70, 3
ds_read_b128 v[72:75], v18 offset:36864
ds_read_b128 v[76:79], v18 offset:38912
v_mfma_f32_16x16x32_bf16 v[140:143], v[80:83], v[124:127], v[140:143]
s_and_b32 s73, s73, 12
ds_read_b64_tr_b16 v[36:37], v9 offset:32768
ds_read_b64_tr_b16 v[38:39], v9 offset:33792
v_mfma_f32_16x16x32_bf16 v[156:159], v[84:87], v[124:127], v[156:159]
s_or_b32 s73, s73, s70
ds_read_b64_tr_b16 v[40:41], v10 offset:32768
v_or_b32 v20, s58, v0
v_mfma_f32_16x16x32_bf16 v[152:155], v[84:87], v[120:123], v[152:155]
s_lshl_b32 s71, s73, 19
ds_read_b64_tr_b16 v[42:43], v10 offset:33792
v_mov_b32 v21, 1
v_mfma_f32_16x16x32_bf16 v[148:151], v[84:87], v[116:119], v[148:151]
s_add_u32 s71, s71, s66
ds_read_b64_tr_b16 v[44:45], v11 offset:32768
v_min_u32 v20, 1, v20
v_mfma_f32_16x16x32_bf16 v[144:147], v[84:87], v[112:115], v[144:147]
s_lshl_b32 s73, s73, 7
ds_read_b64_tr_b16 v[46:47], v11 offset:33792
v_lshlrev_b32 v20, 30, v20
v_mfma_f32_16x16x32_bf16 v[160:163], v[88:91], v[112:115], v[160:163]
s_add_u32 s69, s73, s67
ds_read_b64_tr_b16 v[48:49], v12 offset:32768
v_mfma_f32_16x16x32_bf16 v[164:167], v[88:91], v[116:119], v[164:167]
s_add_u32 s70, s73, s68
ds_read_b64_tr_b16 v[50:51], v12 offset:33792
v_mfma_f32_16x16x32_bf16 v[168:171], v[88:91], v[120:123], v[168:171]
s_add_u32 m0, s64, 16384
ds_read_b64_tr_b16 v[52:53], v13 offset:32768
v_mfma_f32_16x16x32_bf16 v[172:175], v[88:91], v[124:127], v[172:175]
s_add_u32 s72, s71, 0
buffer_load_dwordx4 v6, s[12:15], s72 offen lds
v_mfma_f32_16x16x32_bf16 v[188:191], v[92:95], v[124:127], v[188:191]
s_add_u32 s72, s71, 31744
buffer_load_dwordx4 v6, s[12:15], s72 offen offset:1024 lds
v_mfma_f32_16x16x32_bf16 v[184:187], v[92:95], v[120:123], v[184:187]
s_add_u32 s72, s71, 63488
buffer_load_dwordx4 v7, s[12:15], s72 offen offset:2048 lds
v_mfma_f32_16x16x32_bf16 v[180:183], v[92:95], v[116:119], v[180:183]
s_add_u32 s72, s71, 95232
buffer_load_dwordx4 v7, s[12:15], s72 offen offset:3072 lds
v_mfma_f32_16x16x32_bf16 v[176:179], v[92:95], v[112:115], v[176:179]
ds_read_b64_tr_b16 v[54:55], v13 offset:33792
v_mfma_f32_16x16x32_bf16 v[192:195], v[96:99], v[112:115], v[192:195]
ds_read_b64_tr_b16 v[56:57], v14 offset:32768
v_mfma_f32_16x16x32_bf16 v[196:199], v[96:99], v[116:119], v[196:199]
ds_read_b64_tr_b16 v[58:59], v14 offset:33792
v_mfma_f32_16x16x32_bf16 v[200:203], v[96:99], v[120:123], v[200:203]
ds_read_b64_tr_b16 v[60:61], v15 offset:32768
v_mfma_f32_16x16x32_bf16 v[204:207], v[96:99], v[124:127], v[204:207]
s_add_u32 m0, s63, 65536
ds_read_b64_tr_b16 v[62:63], v15 offset:33792
v_mfma_f32_16x16x32_bf16 v[220:223], v[100:103], v[124:127], v[220:223]
s_add_u32 s72, s69, 0
buffer_load_dwordx4 v4, s[4:7], s72 offen lds
v_mfma_f32_16x16x32_bf16 v[216:219], v[100:103], v[120:123], v[216:219]
buffer_store_dword v21, v20, s[44:47], s91 offen sc1
v_mfma_f32_16x16x32_bf16 v[212:215], v[100:103], v[116:119], v[212:215]
v_mfma_f32_16x16x32_bf16 v[208:211], v[100:103], v[112:115], v[208:211]
v_mfma_f32_16x16x32_bf16 v[224:227], v[104:107], v[112:115], v[224:227]
s_add_u32 s72, s69, 15360
buffer_load_dwordx4 v5, s[4:7], s72 offen offset:1024 lds
v_mfma_f32_16x16x32_bf16 v[228:231], v[104:107], v[116:119], v[228:231]
v_mfma_f32_16x16x32_bf16 v[232:235], v[104:107], v[120:123], v[232:235]
v_mfma_f32_16x16x32_bf16 v[236:239], v[104:107], v[124:127], v[236:239]
v_mfma_f32_16x16x32_bf16 v[252:255], v[108:111], v[124:127], v[252:255]
v_mfma_f32_16x16x32_bf16 v[248:251], v[108:111], v[120:123], v[248:251]
s_add_u32 s72, s69, 129024
buffer_load_dwordx4 v4, s[4:7], s72 offen offset:2048 lds
v_mfma_f32_16x16x32_bf16 v[244:247], v[108:111], v[116:119], v[244:247]
v_mfma_f32_16x16x32_bf16 v[240:243], v[108:111], v[112:115], v[240:243]
s_waitcnt lgkmcnt(0)
v_mfma_f32_16x16x32_bf16 v[128:131], v[32:35], v[64:67], v[128:131]
ds_read_b64_tr_b16 v[80:81], v8 offset:40960
ds_read_b64_tr_b16 v[82:83], v8 offset:41984
v_mfma_f32_16x16x32_bf16 v[132:135], v[32:35], v[68:71], v[132:135]
ds_read_b128 v[112:115], v19 offset:32768
ds_read_b128 v[116:119], v19 offset:34816
v_mfma_f32_16x16x32_bf16 v[136:139], v[32:35], v[72:75], v[136:139]
s_add_u32 s72, s69, 144384
buffer_load_dwordx4 v5, s[4:7], s72 offen offset:3072 lds
v_mfma_f32_16x16x32_bf16 v[140:143], v[32:35], v[76:79], v[140:143]
ds_read_b128 v[120:123], v19 offset:36864
ds_read_b128 v[124:127], v19 offset:38912
v_mfma_f32_16x16x32_bf16 v[156:159], v[36:39], v[76:79], v[156:159]
ds_read_b64_tr_b16 v[84:85], v9 offset:40960
ds_read_b64_tr_b16 v[86:87], v9 offset:41984
v_mfma_f32_16x16x32_bf16 v[152:155], v[36:39], v[72:75], v[152:155]
ds_read_b64_tr_b16 v[88:89], v10 offset:40960
v_mfma_f32_16x16x32_bf16 v[148:151], v[36:39], v[68:71], v[148:151]
ds_read_b64_tr_b16 v[90:91], v10 offset:41984
v_mfma_f32_16x16x32_bf16 v[144:147], v[36:39], v[64:67], v[144:147]
s_add_u32 m0, s63, 69632
ds_read_b64_tr_b16 v[92:93], v11 offset:40960
v_mfma_f32_16x16x32_bf16 v[160:163], v[40:43], v[64:67], v[160:163]
s_add_u32 s72, s70, 0
buffer_load_dwordx4 v4, s[4:7], s72 offen lds
v_mfma_f32_16x16x32_bf16 v[164:167], v[40:43], v[68:71], v[164:167]
ds_read_b64_tr_b16 v[94:95], v11 offset:41984
v_mfma_f32_16x16x32_bf16 v[168:171], v[40:43], v[72:75], v[168:171]
ds_read_b64_tr_b16 v[96:97], v12 offset:40960
v_mfma_f32_16x16x32_bf16 v[172:175], v[40:43], v[76:79], v[172:175]
ds_read_b64_tr_b16 v[98:99], v12 offset:41984
v_mfma_f32_16x16x32_bf16 v[188:191], v[44:47], v[76:79], v[188:191]
s_add_u32 s72, s70, 15360
buffer_load_dwordx4 v5, s[4:7], s72 offen offset:1024 lds
v_mfma_f32_16x16x32_bf16 v[184:187], v[44:47], v[72:75], v[184:187]
ds_read_b64_tr_b16 v[100:101], v13 offset:40960
v_mfma_f32_16x16x32_bf16 v[180:183], v[44:47], v[68:71], v[180:183]
ds_read_b64_tr_b16 v[102:103], v13 offset:41984
v_mfma_f32_16x16x32_bf16 v[176:179], v[44:47], v[64:67], v[176:179]
ds_read_b64_tr_b16 v[104:105], v14 offset:40960
v_mfma_f32_16x16x32_bf16 v[192:195], v[48:51], v[64:67], v[192:195]
ds_read_b64_tr_b16 v[106:107], v14 offset:41984
v_mfma_f32_16x16x32_bf16 v[196:199], v[48:51], v[68:71], v[196:199]
s_add_u32 s72, s70, 129024
buffer_load_dwordx4 v4, s[4:7], s72 offen offset:2048 lds
v_mfma_f32_16x16x32_bf16 v[200:203], v[48:51], v[72:75], v[200:203]
ds_read_b64_tr_b16 v[108:109], v15 offset:40960
v_mfma_f32_16x16x32_bf16 v[204:207], v[48:51], v[76:79], v[204:207]
ds_read_b64_tr_b16 v[110:111], v15 offset:41984
v_mfma_f32_16x16x32_bf16 v[220:223], v[52:55], v[76:79], v[220:223]
v_mfma_f32_16x16x32_bf16 v[216:219], v[52:55], v[72:75], v[216:219]
v_mfma_f32_16x16x32_bf16 v[212:215], v[52:55], v[68:71], v[212:215]
s_add_u32 s72, s70, 144384
buffer_load_dwordx4 v5, s[4:7], s72 offen offset:3072 lds
v_mfma_f32_16x16x32_bf16 v[208:211], v[52:55], v[64:67], v[208:211]
v_mfma_f32_16x16x32_bf16 v[224:227], v[56:59], v[64:67], v[224:227]
v_mfma_f32_16x16x32_bf16 v[228:231], v[56:59], v[68:71], v[228:231]
v_mfma_f32_16x16x32_bf16 v[232:235], v[56:59], v[72:75], v[232:235]
v_mfma_f32_16x16x32_bf16 v[236:239], v[56:59], v[76:79], v[236:239]
v_mfma_f32_16x16x32_bf16 v[252:255], v[60:63], v[76:79], v[252:255]
v_mfma_f32_16x16x32_bf16 v[248:251], v[60:63], v[72:75], v[248:251]
v_mfma_f32_16x16x32_bf16 v[244:247], v[60:63], v[68:71], v[244:247]
s_waitcnt vmcnt(13) lgkmcnt(0)
v_mfma_f32_16x16x32_bf16 v[240:243], v[60:63], v[64:67], v[240:243]
s_barrier
v_mfma_f32_16x16x32_bf16 v[128:131], v[80:83], v[112:115], v[128:131]
s_add_u32 s73, s62, 14
s_waitcnt vmcnt(25)
v_cmp_gt_u32 vcc, 8, v3
s_cbranch_vccnz Lspin1
Lback2:
v_mfma_f32_16x16x32_bf16 v[132:135], v[80:83], v[116:119], v[132:135]
s_add_u32 s70, s73, s65
ds_read_b64_tr_b16 v[32:33], v8 offset:0
ds_read_b64_tr_b16 v[34:35], v8 offset:1024
v_mfma_f32_16x16x32_bf16 v[136:139], v[80:83], v[120:123], v[136:139]
s_and_b32 s70, s70, 3
ds_read_b128 v[64:67], v16 offset:0
ds_read_b128 v[68:71], v16 offset:2048
v_mfma_f32_16x16x32_bf16 v[140:143], v[80:83], v[124:127], v[140:143]
s_and_b32 s73, s73, 12
ds_read_b128 v[72:75], v16 offset:4096
ds_read_b128 v[76:79], v16 offset:6144
v_mfma_f32_16x16x32_bf16 v[156:159], v[84:87], v[124:127], v[156:159]
s_or_b32 s73, s73, s70
ds_read_b64_tr_b16 v[36:37], v9 offset:0
ds_read_b64_tr_b16 v[38:39], v9 offset:1024
v_mfma_f32_16x16x32_bf16 v[152:155], v[84:87], v[120:123], v[152:155]
s_lshl_b32 s71, s73, 19
ds_read_b64_tr_b16 v[40:41], v10 offset:0
v_mfma_f32_16x16x32_bf16 v[148:151], v[84:87], v[116:119], v[148:151]
s_add_u32 s71, s71, s66
ds_read_b64_tr_b16 v[42:43], v10 offset:1024
v_mfma_f32_16x16x32_bf16 v[144:147], v[84:87], v[112:115], v[144:147]
s_lshl_b32 s73, s73, 7
ds_read_b64_tr_b16 v[44:45], v11 offset:0
v_mfma_f32_16x16x32_bf16 v[160:163], v[88:91], v[112:115], v[160:163]
s_add_u32 s69, s73, s67
ds_read_b64_tr_b16 v[46:47], v11 offset:1024
v_mfma_f32_16x16x32_bf16 v[164:167], v[88:91], v[116:119], v[164:167]
s_add_u32 s70, s73, s68
ds_read_b64_tr_b16 v[48:49], v12 offset:0
v_mfma_f32_16x16x32_bf16 v[168:171], v[88:91], v[120:123], v[168:171]
s_add_u32 m0, s64, 32768
ds_read_b64_tr_b16 v[50:51], v12 offset:1024
v_mfma_f32_16x16x32_bf16 v[172:175], v[88:91], v[124:127], v[172:175]
s_add_u32 s72, s71, 0
buffer_load_dwordx4 v6, s[12:15], s72 offen lds
v_mfma_f32_16x16x32_bf16 v[188:191], v[92:95], v[124:127], v[188:191]
s_add_u32 s72, s71, 31744
buffer_load_dwordx4 v6, s[12:15], s72 offen offset:1024 lds
v_mfma_f32_16x16x32_bf16 v[184:187], v[92:95], v[120:123], v[184:187]
s_add_u32 s72, s71, 63488
buffer_load_dwordx4 v7, s[12:15], s72 offen offset:2048 lds
v_mfma_f32_16x16x32_bf16 v[180:183], v[92:95], v[116:119], v[180:183]
s_add_u32 s72, s71, 95232
buffer_load_dwordx4 v7, s[12:15], s72 offen offset:3072 lds
v_mfma_f32_16x16x32_bf16 v[176:179], v[92:95], v[112:115], v[176:179]
ds_read_b64_tr_b16 v[52:53], v13 offset:0
v_mfma_f32_16x16x32_bf16 v[192:195], v[96:99], v[112:115], v[192:195]
ds_read_b64_tr_b16 v[54:55], v13 offset:1024
v_mfma_f32_16x16x32_bf16 v[196:199], v[96:99], v[116:119], v[196:199]
ds_read_b64_tr_b16 v[56:57], v14 offset:0
v_mfma_f32_16x16x32_bf16 v[200:203], v[96:99], v[120:123], v[200:203]
ds_read_b64_tr_b16 v[58:59], v14 offset:1024
v_mfma_f32_16x16x32_bf16 v[204:207], v[96:99], v[124:127], v[204:207]
s_add_u32 m0, s63, 98304
ds_read_b64_tr_b16 v[60:61], v15 offset:0
v_mfma_f32_16x16x32_bf16 v[220:223], v[100:103], v[124:127], v[220:223]
s_add_u32 s72, s69, 0
buffer_load_dwordx4 v4, s[4:7], s72 offen lds
v_mfma_f32_16x16x32_bf16 v[216:219], v[100:103], v[120:123], v[216:219]
ds_read_b64_tr_b16 v[62:63], v15 offset:1024
v_mfma_f32_16x16x32_bf16 v[212:215], v[100:103], v[116:119], v[212:215]
v_mfma_f32_16x16x32_bf16 v[208:211], v[100:103], v[112:115], v[208:211]
v_mfma_f32_16x16x32_bf16 v[224:227], v[104:107], v[112:115], v[224:227]
s_add_u32 s72, s69, 15360
buffer_load_dwordx4 v5, s[4:7], s72 offen offset:1024 lds
v_mfma_f32_16x16x32_bf16 v[228:231], v[104:107], v[116:119], v[228:231]
v_mfma_f32_16x16x32_bf16 v[232:235], v[104:107], v[120:123], v[232:235]
v_mfma_f32_16x16x32_bf16 v[236:239], v[104:107], v[124:127], v[236:239]
v_mfma_f32_16x16x32_bf16 v[252:255], v[108:111], v[124:127], v[252:255]
v_mfma_f32_16x16x32_bf16 v[248:251], v[108:111], v[120:123], v[248:251]
s_add_u32 s72, s69, 129024
buffer_load_dwordx4 v4, s[4:7], s72 offen offset:2048 lds
v_mfma_f32_16x16x32_bf16 v[244:247], v[108:111], v[116:119], v[244:247]
v_mfma_f32_16x16x32_bf16 v[240:243], v[108:111], v[112:115], v[240:243]
s_waitcnt lgkmcnt(0)
v_mfma_f32_16x16x32_bf16 v[128:131], v[32:35], v[64:67], v[128:131]
ds_read_b64_tr_b16 v[80:81], v8 offset:8192
ds_read_b64_tr_b16 v[82:83], v8 offset:9216
v_mfma_f32_16x16x32_bf16 v[132:135], v[32:35], v[68:71], v[132:135]
ds_read_b128 v[112:115], v17 offset:0
ds_read_b128 v[116:119], v17 offset:2048
v_mfma_f32_16x16x32_bf16 v[136:139], v[32:35], v[72:75], v[136:139]
s_add_u32 s72, s69, 144384
buffer_load_dwordx4 v5, s[4:7], s72 offen offset:3072 lds
v_mfma_f32_16x16x32_bf16 v[140:143], v[32:35], v[76:79], v[140:143]
ds_read_b128 v[120:123], v17 offset:4096
ds_read_b128 v[124:127], v17 offset:6144
v_mfma_f32_16x16x32_bf16 v[156:159], v[36:39], v[76:79], v[156:159]
ds_read_b64_tr_b16 v[84:85], v9 offset:8192
ds_read_b64_tr_b16 v[86:87], v9 offset:9216
v_mfma_f32_16x16x32_bf16 v[152:155], v[36:39], v[72:75], v[152:155]
ds_read_b64_tr_b16 v[88:89], v10 offset:8192
v_mfma_f32_16x16x32_bf16 v[148:151], v[36:39], v[68:71], v[148:151]
ds_read_b64_tr_b16 v[90:91], v10 offset:9216
v_mfma_f32_16x16x32_bf16 v[144:147], v[36:39], v[64:67], v[144:147]
s_add_u32 m0, s63, 102400
ds_read_b64_tr_b16 v[92:93], v11 offset:8192
v_mfma_f32_16x16x32_bf16 v[160:163], v[40:43], v[64:67], v[160:163]
s_add_u32 s72, s70, 0
buffer_load_dwordx4 v4, s[4:7], s72 offen lds
v_mfma_f32_16x16x32_bf16 v[164:167], v[40:43], v[68:71], v[164:167]
ds_read_b64_tr_b16 v[94:95], v11 offset:9216
v_mfma_f32_16x16x32_bf16 v[168:171], v[40:43], v[72:75], v[168:171]
ds_read_b64_tr_b16 v[96:97], v12 offset:8192
v_mfma_f32_16x16x32_bf16 v[172:175], v[40:43], v[76:79], v[172:175]
ds_read_b64_tr_b16 v[98:99], v12 offset:9216
v_mfma_f32_16x16x32_bf16 v[188:191], v[44:47], v[76:79], v[188:191]
s_add_u32 s72, s70, 15360
buffer_load_dwordx4 v5, s[4:7], s72 offen offset:1024 lds
v_mfma_f32_16x16x32_bf16 v[184:187], v[44:47], v[72:75], v[184:187]
ds_read_b64_tr_b16 v[100:101], v13 offset:8192
v_mfma_f32_16x16x32_bf16 v[180:183], v[44:47], v[68:71], v[180:183]
ds_read_b64_tr_b16 v[102:103], v13 offset:9216
v_mfma_f32_16x16x32_bf16 v[176:179], v[44:47], v[64:67], v[176:179]
ds_read_b64_tr_b16 v[104:105], v14 offset:8192
v_mfma_f32_16x16x32_bf16 v[192:195], v[48:51], v[64:67], v[192:195]
ds_read_b64_tr_b16 v[106:107], v14 offset:9216
v_mfma_f32_16x16x32_bf16 v[196:199], v[48:51], v[68:71], v[196:199]
s_add_u32 s72, s70, 129024
buffer_load_dwordx4 v4, s[4:7], s72 offen offset:2048 lds
v_mfma_f32_16x16x32_bf16 v[200:203], v[48:51], v[72:75], v[200:203]
ds_read_b64_tr_b16 v[108:109], v15 offset:8192
v_mfma_f32_16x16x32_bf16 v[204:207], v[48:51], v[76:79], v[204:207]
ds_read_b64_tr_b16 v[110:111], v15 offset:9216
v_mfma_f32_16x16x32_bf16 v[220:223], v[52:55], v[76:79], v[220:223]
v_mfma_f32_16x16x32_bf16 v[216:219], v[52:55], v[72:75], v[216:219]
v_mfma_f32_16x16x32_bf16 v[212:215], v[52:55], v[68:71], v[212:215]
s_add_u32 s72, s70, 144384
buffer_load_dwordx4 v5, s[4:7], s72 offen offset:3072 lds
v_mfma_f32_16x16x32_bf16 v[208:211], v[52:55], v[64:67], v[208:211]
v_mfma_f32_16x16x32_bf16 v[224:227], v[56:59], v[64:67], v[224:227]
v_mfma_f32_16x16x32_bf16 v[228:231], v[56:59], v[68:71], v[228:231]
v_mfma_f32_16x16x32_bf16 v[232:235], v[56:59], v[72:75], v[232:235]
v_mfma_f32_16x16x32_bf16 v[236:239], v[56:59], v[76:79], v[236:239]
v_mfma_f32_16x16x32_bf16 v[252:255], v[60:63], v[76:79], v[252:255]
v_mfma_f32_16x16x32_bf16 v[248:251], v[60:63], v[72:75], v[248:251]
v_mfma_f32_16x16x32_bf16 v[244:247], v[60:63], v[68:71], v[244:247]
s_waitcnt vmcnt(12) lgkmcnt(0)
v_mfma_f32_16x16x32_bf16 v[240:243], v[60:63], v[64:67], v[240:243]
s_barrier
v_mfma_f32_16x16x32_bf16 v[128:131], v[80:83], v[112:115], v[128:131]
s_add_u32 s73, s62, 15
ds_read_b64_tr_b16 v[32:33], v8 offset:16384
ds_read_b64_tr_b16 v[34:35], v8 offset:17408
v_mfma_f32_16x16x32_bf16 v[132:135], v[80:83], v[116:119], v[132:135]
s_add_u32 s70, s73, s65
ds_read_b128 v[64:67], v18 offset:0
ds_read_b128 v[68:71], v18 offset:2048
v_mfma_f32_16x16x32_bf16 v[136:139], v[80:83], v[120:123], v[136:139]
s_and_b32 s70, s70, 3
ds_read_b128 v[72:75], v18 offset:4096
ds_read_b128 v[76:79], v18 offset:6144
v_mfma_f32_16x16x32_bf16 v[140:143], v[80:83], v[124:127], v[140:143]
s_and_b32 s73, s73, 12
ds_read_b64_tr_b16 v[36:37], v9 offset:16384
ds_read_b64_tr_b16 v[38:39], v9 offset:17408
v_mfma_f32_16x16x32_bf16 v[156:159], v[84:87], v[124:127], v[156:159]
s_or_b32 s73, s73, s70
ds_read_b64_tr_b16 v[40:41], v10 offset:16384
v_mfma_f32_16x16x32_bf16 v[152:155], v[84:87], v[120:123], v[152:155]
s_lshl_b32 s71, s73, 19
ds_read_b64_tr_b16 v[42:43], v10 offset:17408
v_mfma_f32_16x16x32_bf16 v[148:151], v[84:87], v[116:119], v[148:151]
s_add_u32 s71, s71, s66
ds_read_b64_tr_b16 v[44:45], v11 offset:16384
v_mfma_f32_16x16x32_bf16 v[144:147], v[84:87], v[112:115], v[144:147]
s_lshl_b32 s73, s73, 7
ds_read_b64_tr_b16 v[46:47], v11 offset:17408
v_mfma_f32_16x16x32_bf16 v[160:163], v[88:91], v[112:115], v[160:163]
s_add_u32 s69, s73, s67
ds_read_b64_tr_b16 v[48:49], v12 offset:16384
v_mfma_f32_16x16x32_bf16 v[164:167], v[88:91], v[116:119], v[164:167]
s_add_u32 s70, s73, s68
ds_read_b64_tr_b16 v[50:51], v12 offset:17408
v_mfma_f32_16x16x32_bf16 v[168:171], v[88:91], v[120:123], v[168:171]
s_add_u32 m0, s64, 0
ds_read_b64_tr_b16 v[52:53], v13 offset:16384
v_mfma_f32_16x16x32_bf16 v[172:175], v[88:91], v[124:127], v[172:175]
s_add_u32 s72, s71, 0
buffer_load_dwordx4 v6, s[12:15], s72 offen lds
v_mfma_f32_16x16x32_bf16 v[188:191], v[92:95], v[124:127], v[188:191]
s_add_u32 s72, s71, 31744
buffer_load_dwordx4 v6, s[12:15], s72 offen offset:1024 lds
v_mfma_f32_16x16x32_bf16 v[184:187], v[92:95], v[120:123], v[184:187]
s_add_u32 s72, s71, 63488
buffer_load_dwordx4 v7, s[12:15], s72 offen offset:2048 lds
v_mfma_f32_16x16x32_bf16 v[180:183], v[92:95], v[116:119], v[180:183]
s_add_u32 s72, s71, 95232
buffer_load_dwordx4 v7, s[12:15], s72 offen offset:3072 lds
v_mfma_f32_16x16x32_bf16 v[176:179], v[92:95], v[112:115], v[176:179]
s_and_b32 s75, s91, 0xfffffc7f
v_lshrrev_b32 v2, 3, v0
v_lshlrev_b32 v2, 7, v2
v_mfma_f32_16x16x32_bf16 v[192:195], v[96:99], v[112:115], v[192:195]
buffer_load_dword v3, v2, s[44:47], s75 offen sc1
v_mfma_f32_16x16x32_bf16 v[196:199], v[96:99], v[116:119], v[196:199]
ds_read_b64_tr_b16 v[54:55], v13 offset:17408
v_mfma_f32_16x16x32_bf16 v[200:203], v[96:99], v[120:123], v[200:203]
ds_read_b64_tr_b16 v[56:57], v14 offset:16384
v_mfma_f32_16x16x32_bf16 v[204:207], v[96:99], v[124:127], v[204:207]
s_add_u32 m0, s63, 131072
ds_read_b64_tr_b16 v[58:59], v14 offset:17408
v_mfma_f32_16x16x32_bf16 v[220:223], v[100:103], v[124:127], v[220:223]
s_add_u32 s72, s69, 0
buffer_load_dwordx4 v4, s[4:7], s72 offen lds
v_mfma_f32_16x16x32_bf16 v[216:219], v[100:103], v[120:123], v[216:219]
ds_read_b64_tr_b16 v[60:61], v15 offset:16384
v_mfma_f32_16x16x32_bf16 v[212:215], v[100:103], v[116:119], v[212:215]
ds_read_b64_tr_b16 v[62:63], v15 offset:17408
v_mfma_f32_16x16x32_bf16 v[208:211], v[100:103], v[112:115], v[208:211]
v_mfma_f32_16x16x32_bf16 v[224:227], v[104:107], v[112:115], v[224:227]
s_add_u32 s72, s69, 15360
buffer_load_dwordx4 v5, s[4:7], s72 offen offset:1024 lds
v_mfma_f32_16x16x32_bf16 v[228:231], v[104:107], v[116:119], v[228:231]
v_mfma_f32_16x16x32_bf16 v[232:235], v[104:107], v[120:123], v[232:235]
v_mfma_f32_16x16x32_bf16 v[236:239], v[104:107], v[124:127], v[236:239]
v_mfma_f32_16x16x32_bf16 v[252:255], v[108:111], v[124:127], v[252:255]
v_mfma_f32_16x16x32_bf16 v[248:251], v[108:111], v[120:123], v[248:251]
s_add_u32 s72, s69, 129024
buffer_load_dwordx4 v4, s[4:7], s72 offen offset:2048 lds
v_mfma_f32_16x16x32_bf16 v[244:247], v[108:111], v[116:119], v[244:247]
v_mfma_f32_16x16x32_bf16 v[240:243], v[108:111], v[112:115], v[240:243]
s_waitcnt lgkmcnt(0)
v_mfma_f32_16x16x32_bf16 v[128:131], v[32:35], v[64:67], v[128:131]
v_accvgpr_write_b32 a0, -1
v_accvgpr_write_b32 a1, -1
v_mfma_f32_16x16x32_bf16 v[132:135], v[32:35], v[68:71], v[132:135]
v_accvgpr_write_b32 a2, -1
v_accvgpr_write_b32 a3, -1
v_mfma_f32_16x16x32_bf16 v[136:139], v[32:35], v[72:75], v[136:139]
s_add_u32 s72, s69, 144384
buffer_load_dwordx4 v5, s[4:7], s72 offen offset:3072 lds
v_mfma_f32_16x16x32_bf16 v[140:143], v[32:35], v[76:79], v[140:143]
s_add_u32 s80, s93, 0x3a00000
ds_read_b64_tr_b16 v[80:81], v8 offset:24576
ds_read_b64_tr_b16 v[82:83], v8 offset:25600
v_mfma_f32_16x16x32_bf16 v[156:159], v[36:39], v[76:79], v[156:159]
ds_read_b128 v[112:115], v19 offset:0
ds_read_b128 v[116:119], v19 offset:2048
v_mfma_f32_16x16x32_bf16 v[152:155], v[36:39], v[72:75], v[152:155]
ds_read_b128 v[120:123], v19 offset:4096
ds_read_b128 v[124:127], v19 offset:6144
v_mfma_f32_16x16x32_bf16 v[148:151], v[36:39], v[68:71], v[148:151]
ds_read_b64_tr_b16 v[84:85], v9 offset:24576
ds_read_b64_tr_b16 v[86:87], v9 offset:25600
v_mfma_f32_16x16x32_bf16 v[144:147], v[36:39], v[64:67], v[144:147]
s_add_u32 m0, s63, 135168
ds_read_b64_tr_b16 v[88:89], v10 offset:24576
v_mfma_f32_16x16x32_bf16 v[160:163], v[40:43], v[64:67], v[160:163]
s_add_u32 s72, s70, 0
buffer_load_dwordx4 v4, s[4:7], s72 offen lds
v_mfma_f32_16x16x32_bf16 v[164:167], v[40:43], v[68:71], v[164:167]
ds_read_b64_tr_b16 v[90:91], v10 offset:25600
v_mfma_f32_16x16x32_bf16 v[168:171], v[40:43], v[72:75], v[168:171]
ds_read_b64_tr_b16 v[92:93], v11 offset:24576
v_mfma_f32_16x16x32_bf16 v[172:175], v[40:43], v[76:79], v[172:175]
ds_read_b64_tr_b16 v[94:95], v11 offset:25600
v_mfma_f32_16x16x32_bf16 v[188:191], v[44:47], v[76:79], v[188:191]
s_add_u32 s72, s70, 15360
buffer_load_dwordx4 v5, s[4:7], s72 offen offset:1024 lds
v_mfma_f32_16x16x32_bf16 v[184:187], v[44:47], v[72:75], v[184:187]
ds_read_b64_tr_b16 v[96:97], v12 offset:24576
v_mfma_f32_16x16x32_bf16 v[180:183], v[44:47], v[68:71], v[180:183]
ds_read_b64_tr_b16 v[98:99], v12 offset:25600
v_mfma_f32_16x16x32_bf16 v[176:179], v[44:47], v[64:67], v[176:179]
ds_read_b64_tr_b16 v[100:101], v13 offset:24576
v_mfma_f32_16x16x32_bf16 v[192:195], v[48:51], v[64:67], v[192:195]
ds_read_b64_tr_b16 v[102:103], v13 offset:25600
v_mfma_f32_16x16x32_bf16 v[196:199], v[48:51], v[68:71], v[196:199]
s_add_u32 s72, s70, 129024
buffer_load_dwordx4 v4, s[4:7], s72 offen offset:2048 lds
v_mfma_f32_16x16x32_bf16 v[200:203], v[48:51], v[72:75], v[200:203]
ds_read_b64_tr_b16 v[104:105], v14 offset:24576
v_mfma_f32_16x16x32_bf16 v[204:207], v[48:51], v[76:79], v[204:207]
ds_read_b64_tr_b16 v[106:107], v14 offset:25600
v_mfma_f32_16x16x32_bf16 v[220:223], v[52:55], v[76:79], v[220:223]
ds_read_b64_tr_b16 v[108:109], v15 offset:24576
v_mfma_f32_16x16x32_bf16 v[216:219], v[52:55], v[72:75], v[216:219]
ds_read_b64_tr_b16 v[110:111], v15 offset:25600
v_mfma_f32_16x16x32_bf16 v[212:215], v[52:55], v[68:71], v[212:215]
s_add_u32 s72, s70, 144384
buffer_load_dwordx4 v5, s[4:7], s72 offen offset:3072 lds
v_mfma_f32_16x16x32_bf16 v[208:211], v[52:55], v[64:67], v[208:211]
v_mfma_f32_16x16x32_bf16 v[224:227], v[56:59], v[64:67], v[224:227]
v_mfma_f32_16x16x32_bf16 v[228:231], v[56:59], v[68:71], v[228:231]
v_mfma_f32_16x16x32_bf16 v[232:235], v[56:59], v[72:75], v[232:235]
v_mfma_f32_16x16x32_bf16 v[236:239], v[56:59], v[76:79], v[236:239]
v_mfma_f32_16x16x32_bf16 v[252:255], v[60:63], v[76:79], v[252:255]
v_mfma_f32_16x16x32_bf16 v[248:251], v[60:63], v[72:75], v[248:251]
v_mfma_f32_16x16x32_bf16 v[244:247], v[60:63], v[68:71], v[244:247]
s_waitcnt vmcnt(13) lgkmcnt(0)
v_mfma_f32_16x16x32_bf16 v[240:243], v[60:63], v[64:67], v[240:243]
s_barrier
v_mfma_f32_16x16x32_bf16 v[128:131], v[80:83], v[112:115], v[128:131]
s_waitcnt vmcnt(8)
v_cmp_gt_u32 vcc, 1, v3
s_cbranch_vccnz Lspin4
Lback5:
v_mfma_f32_16x16x32_bf16 v[132:135], v[80:83], v[116:119], v[132:135]
s_add_u32 m0, s64, 49152
ds_read_b64_tr_b16 v[32:33], v8 offset:32768
ds_read_b64_tr_b16 v[34:35], v8 offset:33792
v_mfma_f32_16x16x32_bf16 v[136:139], v[80:83], v[120:123], v[136:139]
s_add_u32 s72, s81, 16384
buffer_load_dwordx4 v1, s[44:47], s72 offen sc1 lds
v_mfma_f32_16x16x32_bf16 v[140:143], v[80:83], v[124:127], v[140:143]
ds_read_b128 v[64:67], v18 offset:32768
ds_read_b128 v[68:71], v18 offset:34816
v_mfma_f32_16x16x32_bf16 v[156:159], v[84:87], v[124:127], v[156:159]
ds_read_b128 v[72:75], v18 offset:36864
ds_read_b128 v[76:79], v18 offset:38912
v_mfma_f32_16x16x32_bf16 v[152:155], v[84:87], v[120:123], v[152:155]
buffer_load_dwordx4 v1, s[44:47], s72 offen offset:1024 sc1 lds
v_mfma_f32_16x16x32_bf16 v[148:151], v[84:87], v[116:119], v[148:151]
ds_read_b64_tr_b16 v[36:37], v9 offset:32768
ds_read_b64_tr_b16 v[38:39], v9 offset:33792
v_mfma_f32_16x16x32_bf16 v[144:147], v[84:87], v[112:115], v[144:147]
ds_read_b64_tr_b16 v[40:41], v10 offset:32768
v_mfma_f32_16x16x32_bf16 v[160:163], v[88:91], v[112:115], v[160:163]
ds_read_b64_tr_b16 v[42:43], v10 offset:33792
v_mfma_f32_16x16x32_bf16 v[164:167], v[88:91], v[116:119], v[164:167]
ds_read_b64_tr_b16 v[44:45], v11 offset:32768
v_mfma_f32_16x16x32_bf16 v[168:171], v[88:91], v[120:123], v[168:171]
buffer_load_dwordx4 v1, s[44:47], s72 offen offset:2048 sc1 lds
v_mfma_f32_16x16x32_bf16 v[172:175], v[88:91], v[124:127], v[172:175]
ds_read_b64_tr_b16 v[46:47], v11 offset:33792
v_mfma_f32_16x16x32_bf16 v[188:191], v[92:95], v[124:127], v[188:191]
ds_read_b64_tr_b16 v[48:49], v12 offset:32768
v_mfma_f32_16x16x32_bf16 v[184:187], v[92:95], v[120:123], v[184:187]
ds_read_b64_tr_b16 v[50:51], v12 offset:33792
v_mfma_f32_16x16x32_bf16 v[180:183], v[92:95], v[116:119], v[180:183]
ds_read_b64_tr_b16 v[52:53], v13 offset:32768
v_mfma_f32_16x16x32_bf16 v[176:179], v[92:95], v[112:115], v[176:179]
buffer_load_dwordx4 v1, s[44:47], s72 offen offset:3072 sc1 lds
v_mfma_f32_16x16x32_bf16 v[192:195], v[96:99], v[112:115], v[192:195]
ds_read_b64_tr_b16 v[54:55], v13 offset:33792
v_mfma_f32_16x16x32_bf16 v[196:199], v[96:99], v[116:119], v[196:199]
ds_read_b64_tr_b16 v[56:57], v14 offset:32768
v_mfma_f32_16x16x32_bf16 v[200:203], v[96:99], v[120:123], v[200:203]
ds_read_b64_tr_b16 v[58:59], v14 offset:33792
v_mfma_f32_16x16x32_bf16 v[204:207], v[96:99], v[124:127], v[204:207]
ds_read_b64_tr_b16 v[60:61], v15 offset:32768
v_mfma_f32_16x16x32_bf16 v[220:223], v[100:103], v[124:127], v[220:223]
s_add_u32 s81, s81, 0x8000
ds_read_b64_tr_b16 v[62:63], v15 offset:33792
v_mfma_f32_16x16x32_bf16 v[216:219], v[100:103], v[120:123], v[216:219]
s_add_u32 m0, s64, 81920
v_mfma_f32_16x16x32_bf16 v[212:215], v[100:103], v[116:119], v[212:215]
s_add_u32 s72, s81, 16384
buffer_load_dwordx4 v1, s[44:47], s72 offen sc1 lds
v_mfma_f32_16x16x32_bf16 v[208:211], v[100:103], v[112:115], v[208:211]
v_mfma_f32_16x16x32_bf16 v[224:227], v[104:107], v[112:115], v[224:227]
v_mfma_f32_16x16x32_bf16 v[228:231], v[104:107], v[116:119], v[228:231]
buffer_load_dwordx4 v1, s[44:47], s72 offen offset:1024 sc1 lds
v_mfma_f32_16x16x32_bf16 v[232:235], v[104:107], v[120:123], v[232:235]
v_mfma_f32_16x16x32_bf16 v[236:239], v[104:107], v[124:127], v[236:239]
v_mfma_f32_16x16x32_bf16 v[252:255], v[108:111], v[124:127], v[252:255]
v_mfma_f32_16x16x32_bf16 v[248:251], v[108:111], v[120:123], v[248:251]
v_mfma_f32_16x16x32_bf16 v[244:247], v[108:111], v[116:119], v[244:247]
buffer_load_dwordx4 v1, s[44:47], s72 offen offset:2048 sc1 lds
v_mfma_f32_16x16x32_bf16 v[240:243], v[108:111], v[112:115], v[240:243]
s_waitcnt lgkmcnt(0)
v_mfma_f32_16x16x32_bf16 v[128:131], v[32:35], v[64:67], v[128:131]
ds_read_b64_tr_b16 v[80:81], v8 offset:40960
ds_read_b64_tr_b16 v[82:83], v8 offset:41984
v_mfma_f32_16x16x32_bf16 v[132:135], v[32:35], v[68:71], v[132:135]
ds_read_b128 v[112:115], v19 offset:32768
ds_read_b128 v[116:119], v19 offset:34816
v_mfma_f32_16x16x32_bf16 v[136:139], v[32:35], v[72:75], v[136:139]
buffer_load_dwordx4 v1, s[44:47], s72 offen offset:3072 sc1 lds
v_mfma_f32_16x16x32_bf16 v[140:143], v[32:35], v[76:79], v[140:143]
ds_read_b128 v[120:123], v19 offset:36864
ds_read_b128 v[124:127], v19 offset:38912
v_mfma_f32_16x16x32_bf16 v[156:159], v[36:39], v[76:79], v[156:159]
ds_read_b64_tr_b16 v[84:85], v9 offset:40960
ds_read_b64_tr_b16 v[86:87], v9 offset:41984
v_mfma_f32_16x16x32_bf16 v[152:155], v[36:39], v[72:75], v[152:155]
ds_read_b64_tr_b16 v[88:89], v10 offset:40960
v_mfma_f32_16x16x32_bf16 v[148:151], v[36:39], v[68:71], v[148:151]
ds_read_b64_tr_b16 v[90:91], v10 offset:41984
v_mfma_f32_16x16x32_bf16 v[144:147], v[36:39], v[64:67], v[144:147]
s_add_u32 m0, s64, 65536
ds_read_b64_tr_b16 v[92:93], v11 offset:40960
v_mfma_f32_16x16x32_bf16 v[160:163], v[40:43], v[64:67], v[160:163]
s_add_u32 s72, s81, 0
buffer_load_dwordx4 v1, s[44:47], s72 offen sc1 lds
v_mfma_f32_16x16x32_bf16 v[164:167], v[40:43], v[68:71], v[164:167]
ds_read_b64_tr_b16 v[94:95], v11 offset:41984
v_mfma_f32_16x16x32_bf16 v[168:171], v[40:43], v[72:75], v[168:171]
ds_read_b64_tr_b16 v[96:97], v12 offset:40960
v_mfma_f32_16x16x32_bf16 v[172:175], v[40:43], v[76:79], v[172:175]
ds_read_b64_tr_b16 v[98:99], v12 offset:41984
v_mfma_f32_16x16x32_bf16 v[188:191], v[44:47], v[76:79], v[188:191]
buffer_load_dwordx4 v1, s[44:47], s72 offen offset:1024 sc1 lds
v_mfma_f32_16x16x32_bf16 v[184:187], v[44:47], v[72:75], v[184:187]
ds_read_b64_tr_b16 v[100:101], v13 offset:40960
v_mfma_f32_16x16x32_bf16 v[180:183], v[44:47], v[68:71], v[180:183]
ds_read_b64_tr_b16 v[102:103], v13 offset:41984
v_mfma_f32_16x16x32_bf16 v[176:179], v[44:47], v[64:67], v[176:179]
ds_read_b64_tr_b16 v[104:105], v14 offset:40960
v_mfma_f32_16x16x32_bf16 v[192:195], v[48:51], v[64:67], v[192:195]
ds_read_b64_tr_b16 v[106:107], v14 offset:41984
v_mfma_f32_16x16x32_bf16 v[196:199], v[48:51], v[68:71], v[196:199]
buffer_load_dwordx4 v1, s[44:47], s72 offen offset:2048 sc1 lds
v_mfma_f32_16x16x32_bf16 v[200:203], v[48:51], v[72:75], v[200:203]
ds_read_b64_tr_b16 v[108:109], v15 offset:40960
v_mfma_f32_16x16x32_bf16 v[204:207], v[48:51], v[76:79], v[204:207]
ds_read_b64_tr_b16 v[110:111], v15 offset:41984
v_mfma_f32_16x16x32_bf16 v[220:223], v[52:55], v[76:79], v[220:223]
v_mfma_f32_16x16x32_bf16 v[216:219], v[52:55], v[72:75], v[216:219]
v_mfma_f32_16x16x32_bf16 v[212:215], v[52:55], v[68:71], v[212:215]
buffer_load_dwordx4 v1, s[44:47], s72 offen offset:3072 sc1 lds
v_mfma_f32_16x16x32_bf16 v[208:211], v[52:55], v[64:67], v[208:211]
v_mfma_f32_16x16x32_bf16 v[224:227], v[56:59], v[64:67], v[224:227]
v_mfma_f32_16x16x32_bf16 v[228:231], v[56:59], v[68:71], v[228:231]
v_mfma_f32_16x16x32_bf16 v[232:235], v[56:59], v[72:75], v[232:235]
v_mfma_f32_16x16x32_bf16 v[236:239], v[56:59], v[76:79], v[236:239]
v_mfma_f32_16x16x32_bf16 v[252:255], v[60:63], v[76:79], v[252:255]
v_mfma_f32_16x16x32_bf16 v[248:251], v[60:63], v[72:75], v[248:251]
v_mfma_f32_16x16x32_bf16 v[244:247], v[60:63], v[68:71], v[244:247]
s_waitcnt vmcnt(12) lgkmcnt(0)
v_mfma_f32_16x16x32_bf16 v[240:243], v[60:63], v[64:67], v[240:243]
s_barrier
v_mfma_f32_16x16x32_bf16 v[128:131], v[80:83], v[112:115], v[128:131]
s_add_u32 s81, s81, 0x8000
ds_read_b64_tr_b16 v[32:33], v8 offset:0
ds_read_b64_tr_b16 v[34:35], v8 offset:1024
v_mfma_f32_16x16x32_bf16 v[132:135], v[80:83], v[116:119], v[132:135]
s_add_u32 m0, s64, 114688
ds_read_b128 v[64:67], v16 offset:0
ds_read_b128 v[68:71], v16 offset:2048
v_mfma_f32_16x16x32_bf16 v[136:139], v[80:83], v[120:123], v[136:139]
s_add_u32 s72, s81, 16384
buffer_load_dwordx4 v1, s[44:47], s72 offen sc1 lds
v_mfma_f32_16x16x32_bf16 v[140:143], v[80:83], v[124:127], v[140:143]
ds_read_b128 v[72:75], v16 offset:4096
ds_read_b128 v[76:79], v16 offset:6144
v_mfma_f32_16x16x32_bf16 v[156:159], v[84:87], v[124:127], v[156:159]
ds_read_b64_tr_b16 v[36:37], v9 offset:0
ds_read_b64_tr_b16 v[38:39], v9 offset:1024
v_mfma_f32_16x16x32_bf16 v[152:155], v[84:87], v[120:123], v[152:155]
buffer_load_dwordx4 v1, s[44:47], s72 offen offset:1024 sc1 lds
v_mfma_f32_16x16x32_bf16 v[148:151], v[84:87], v[116:119], v[148:151]
ds_read_b64_tr_b16 v[40:41], v10 offset:0
v_mfma_f32_16x16x32_bf16 v[144:147], v[84:87], v[112:115], v[144:147]
ds_read_b64_tr_b16 v[42:43], v10 offset:1024
v_mfma_f32_16x16x32_bf16 v[160:163], v[88:91], v[112:115], v[160:163]
ds_read_b64_tr_b16 v[44:45], v11 offset:0
v_mfma_f32_16x16x32_bf16 v[164:167], v[88:91], v[116:119], v[164:167]
ds_read_b64_tr_b16 v[46:47], v11 offset:1024
v_mfma_f32_16x16x32_bf16 v[168:171], v[88:91], v[120:123], v[168:171]
buffer_store_dwordx4 a[0:3], v1, s[44:47], s80 offen sc1
v_mfma_f32_16x16x32_bf16 v[172:175], v[88:91], v[124:127], v[172:175]
ds_read_b64_tr_b16 v[48:49], v12 offset:0
v_mfma_f32_16x16x32_bf16 v[188:191], v[92:95], v[124:127], v[188:191]
ds_read_b64_tr_b16 v[50:51], v12 offset:1024
v_mfma_f32_16x16x32_bf16 v[184:187], v[92:95], v[120:123], v[184:187]
ds_read_b64_tr_b16 v[52:53], v13 offset:0
v_mfma_f32_16x16x32_bf16 v[180:183], v[92:95], v[116:119], v[180:183]
ds_read_b64_tr_b16 v[54:55], v13 offset:1024
v_mfma_f32_16x16x32_bf16 v[176:179], v[92:95], v[112:115], v[176:179]
buffer_load_dwordx4 v1, s[44:47], s72 offen offset:2048 sc1 lds
v_mfma_f32_16x16x32_bf16 v[192:195], v[96:99], v[112:115], v[192:195]
ds_read_b64_tr_b16 v[56:57], v14 offset:0
v_mfma_f32_16x16x32_bf16 v[196:199], v[96:99], v[116:119], v[196:199]
ds_read_b64_tr_b16 v[58:59], v14 offset:1024
v_mfma_f32_16x16x32_bf16 v[200:203], v[96:99], v[120:123], v[200:203]
ds_read_b64_tr_b16 v[60:61], v15 offset:0
v_mfma_f32_16x16x32_bf16 v[204:207], v[96:99], v[124:127], v[204:207]
ds_read_b64_tr_b16 v[62:63], v15 offset:1024
v_mfma_f32_16x16x32_bf16 v[220:223], v[100:103], v[124:127], v[220:223]
buffer_load_dwordx4 v1, s[44:47], s72 offen offset:3072 sc1 lds
v_mfma_f32_16x16x32_bf16 v[216:219], v[100:103], v[120:123], v[216:219]
v_mfma_f32_16x16x32_bf16 v[212:215], v[100:103], v[116:119], v[212:215]
v_mfma_f32_16x16x32_bf16 v[208:211], v[100:103], v[112:115], v[208:211]
v_mfma_f32_16x16x32_bf16 v[224:227], v[104:107], v[112:115], v[224:227]
v_mfma_f32_16x16x32_bf16 v[228:231], v[104:107], v[116:119], v[228:231]
buffer_store_dwordx4 a[0:3], v1, s[44:47], s80 offen offset:1024 sc1
v_mfma_f32_16x16x32_bf16 v[232:235], v[104:107], v[120:123], v[232:235]
v_mfma_f32_16x16x32_bf16 v[236:239], v[104:107], v[124:127], v[236:239]
v_mfma_f32_16x16x32_bf16 v[252:255], v[108:111], v[124:127], v[252:255]
v_mfma_f32_16x16x32_bf16 v[248:251], v[108:111], v[120:123], v[248:251]
v_mfma_f32_16x16x32_bf16 v[244:247], v[108:111], v[116:119], v[244:247]
s_add_u32 m0, s64, 98304
v_mfma_f32_16x16x32_bf16 v[240:243], v[108:111], v[112:115], v[240:243]
s_waitcnt lgkmcnt(0)
v_mfma_f32_16x16x32_bf16 v[128:131], v[32:35], v[64:67], v[128:131]
s_add_u32 s72, s81, 0
buffer_load_dwordx4 v1, s[44:47], s72 offen sc1 lds
v_mfma_f32_16x16x32_bf16 v[132:135], v[32:35], v[68:71], v[132:135]
ds_read_b64_tr_b16 v[80:81], v8 offset:8192
v_add_u32 v2, 0x8000, v1
v_mfma_f32_16x16x32_bf16 v[136:139], v[32:35], v[72:75], v[136:139]
ds_read_b64_tr_b16 v[82:83], v8 offset:9216
ds_read_b128 v[112:115], v17 offset:0
v_mfma_f32_16x16x32_bf16 v[140:143], v[32:35], v[76:79], v[140:143]
ds_read_b128 v[116:119], v17 offset:2048
ds_read_b128 v[120:123], v17 offset:4096
v_mfma_f32_16x16x32_bf16 v[156:159], v[36:39], v[76:79], v[156:159]
buffer_load_dwordx4 v1, s[44:47], s72 offen offset:1024 sc1 lds
v_mfma_f32_16x16x32_bf16 v[152:155], v[36:39], v[72:75], v[152:155]
ds_read_b128 v[124:127], v17 offset:6144
ds_read_b64_tr_b16 v[84:85], v9 offset:8192
v_mfma_f32_16x16x32_bf16 v[148:151], v[36:39], v[68:71], v[148:151]
ds_read_b64_tr_b16 v[86:87], v9 offset:9216
v_mfma_f32_16x16x32_bf16 v[144:147], v[36:39], v[64:67], v[144:147]
ds_read_b64_tr_b16 v[88:89], v10 offset:8192
v_mfma_f32_16x16x32_bf16 v[160:163], v[40:43], v[64:67], v[160:163]
ds_read_b64_tr_b16 v[90:91], v10 offset:9216
v_mfma_f32_16x16x32_bf16 v[164:167], v[40:43], v[68:71], v[164:167]
buffer_store_dwordx4 a[0:3], v1, s[44:47], s80 offen offset:2048 sc1
v_mfma_f32_16x16x32_bf16 v[168:171], v[40:43], v[72:75], v[168:171]
ds_read_b64_tr_b16 v[92:93], v11 offset:8192
v_mfma_f32_16x16x32_bf16 v[172:175], v[40:43], v[76:79], v[172:175]
ds_read_b64_tr_b16 v[94:95], v11 offset:9216
v_mfma_f32_16x16x32_bf16 v[188:191], v[44:47], v[76:79], v[188:191]
ds_read_b64_tr_b16 v[96:97], v12 offset:8192
v_mfma_f32_16x16x32_bf16 v[184:187], v[44:47], v[72:75], v[184:187]
ds_read_b64_tr_b16 v[98:99], v12 offset:9216
v_mfma_f32_16x16x32_bf16 v[180:183], v[44:47], v[68:71], v[180:183]
buffer_load_dwordx4 v1, s[44:47], s72 offen offset:2048 sc1 lds
v_mfma_f32_16x16x32_bf16 v[176:179], v[44:47], v[64:67], v[176:179]
ds_read_b64_tr_b16 v[100:101], v13 offset:8192
v_mfma_f32_16x16x32_bf16 v[192:195], v[48:51], v[64:67], v[192:195]
ds_read_b64_tr_b16 v[102:103], v13 offset:9216
v_mfma_f32_16x16x32_bf16 v[196:199], v[48:51], v[68:71], v[196:199]
ds_read_b64_tr_b16 v[104:105], v14 offset:8192
v_mfma_f32_16x16x32_bf16 v[200:203], v[48:51], v[72:75], v[200:203]
ds_read_b64_tr_b16 v[106:107], v14 offset:9216
v_mfma_f32_16x16x32_bf16 v[204:207], v[48:51], v[76:79], v[204:207]
buffer_load_dwordx4 v1, s[44:47], s72 offen offset:3072 sc1 lds
v_mfma_f32_16x16x32_bf16 v[220:223], v[52:55], v[76:79], v[220:223]
ds_read_b64_tr_b16 v[108:109], v15 offset:8192
v_mfma_f32_16x16x32_bf16 v[216:219], v[52:55], v[72:75], v[216:219]
ds_read_b64_tr_b16 v[110:111], v15 offset:9216
v_mfma_f32_16x16x32_bf16 v[212:215], v[52:55], v[68:71], v[212:215]
v_mfma_f32_16x16x32_bf16 v[208:211], v[52:55], v[64:67], v[208:211]
v_mfma_f32_16x16x32_bf16 v[224:227], v[56:59], v[64:67], v[224:227]
buffer_store_dwordx4 a[0:3], v1, s[44:47], s80 offen offset:3072 sc1
v_mfma_f32_16x16x32_bf16 v[228:231], v[56:59], v[68:71], v[228:231]
v_mfma_f32_16x16x32_bf16 v[232:235], v[56:59], v[72:75], v[232:235]
v_mfma_f32_16x16x32_bf16 v[236:239], v[56:59], v[76:79], v[236:239]
v_mfma_f32_16x16x32_bf16 v[252:255], v[60:63], v[76:79], v[252:255]
v_mfma_f32_16x16x32_bf16 v[248:251], v[60:63], v[72:75], v[248:251]
v_lshrrev_b32 v3, 1, v0
v_lshlrev_b32 v3, 7, v3
v_mfma_f32_16x16x32_bf16 v[244:247], v[60:63], v[68:71], v[244:247]
s_waitcnt vmcnt(20) lgkmcnt(0)
buffer_load_dword v4, v3, s[36:39], s93 offen
v_mfma_f32_16x16x32_bf16 v[240:243], v[60:63], v[64:67], v[240:243]
s_barrier
v_mfma_f32_16x16x32_bf16 v[128:131], v[80:83], v[112:115], v[128:131]
ds_read_b128 a[128:131], v2 offset:16384
v_mfma_f32_16x16x32_bf16 v[132:135], v[80:83], v[116:119], v[132:135]
ds_read_b128 a[132:135], v2 offset:17408
v_mfma_f32_16x16x32_bf16 v[136:139], v[80:83], v[120:123], v[136:139]
ds_read_b128 a[136:139], v2 offset:18432
v_mfma_f32_16x16x32_bf16 v[140:143], v[80:83], v[124:127], v[140:143]
ds_read_b128 a[140:143], v2 offset:19456
v_mfma_f32_16x16x32_bf16 v[156:159], v[84:87], v[124:127], v[156:159]
ds_read_b128 a[144:147], v2 offset:20480
v_mfma_f32_16x16x32_bf16 v[152:155], v[84:87], v[120:123], v[152:155]
ds_read_b128 a[148:151], v2 offset:21504
v_mfma_f32_16x16x32_bf16 v[148:151], v[84:87], v[116:119], v[148:151]
ds_read_b128 a[152:155], v2 offset:22528
v_mfma_f32_16x16x32_bf16 v[144:147], v[84:87], v[112:115], v[144:147]
ds_read_b128 a[156:159], v2 offset:23552
v_mfma_f32_16x16x32_bf16 v[160:163], v[88:91], v[112:115], v[160:163]
v_mfma_f32_16x16x32_bf16 v[164:167], v[88:91], v[116:119], v[164:167]
v_mfma_f32_16x16x32_bf16 v[168:171], v[88:91], v[120:123], v[168:171]
v_mfma_f32_16x16x32_bf16 v[172:175], v[88:91], v[124:127], v[172:175]
v_mfma_f32_16x16x32_bf16 v[188:191], v[92:95], v[124:127], v[188:191]
v_cvt_pk_bf16_f32 v64, v140, v141
v_cvt_pk_bf16_f32 v65, v142, v143
v_mfma_f32_16x16x32_bf16 v[184:187], v[92:95], v[120:123], v[184:187]
v_cvt_pk_bf16_f32 v66, v156, v157
v_cvt_pk_bf16_f32 v67, v158, v159
v_mfma_f32_16x16x32_bf16 v[180:183], v[92:95], v[116:119], v[180:183]
v_cvt_pk_bf16_f32 v48, v136, v137
v_cvt_pk_bf16_f32 v49, v138, v139
v_mfma_f32_16x16x32_bf16 v[176:179], v[92:95], v[112:115], v[176:179]
v_cvt_pk_bf16_f32 v50, v152, v153
v_cvt_pk_bf16_f32 v51, v154, v155
v_mfma_f32_16x16x32_bf16 v[192:195], v[96:99], v[112:115], v[192:195]
v_cvt_pk_bf16_f32 v32, v132, v133
v_cvt_pk_bf16_f32 v33, v134, v135
v_mfma_f32_16x16x32_bf16 v[196:199], v[96:99], v[116:119], v[196:199]
v_cvt_pk_bf16_f32 v34, v148, v149
v_cvt_pk_bf16_f32 v35, v150, v151
v_mfma_f32_16x16x32_bf16 v[200:203], v[96:99], v[120:123], v[200:203]
v_cvt_pk_bf16_f32 v16, v128, v129
v_cvt_pk_bf16_f32 v17, v130, v131
v_mfma_f32_16x16x32_bf16 v[204:207], v[96:99], v[124:127], v[204:207]
v_cvt_pk_bf16_f32 v18, v144, v145
v_cvt_pk_bf16_f32 v19, v146, v147
v_mfma_f32_16x16x32_bf16 v[220:223], v[100:103], v[124:127], v[220:223]
v_cvt_pk_bf16_f32 v68, v172, v173
v_cvt_pk_bf16_f32 v69, v174, v175
v_mfma_f32_16x16x32_bf16 v[216:219], v[100:103], v[120:123], v[216:219]
v_cvt_pk_bf16_f32 v70, v188, v189
v_cvt_pk_bf16_f32 v71, v190, v191
v_mfma_f32_16x16x32_bf16 v[212:215], v[100:103], v[116:119], v[212:215]
v_cvt_pk_bf16_f32 v52, v168, v169
v_cvt_pk_bf16_f32 v53, v170, v171
v_mfma_f32_16x16x32_bf16 v[208:211], v[100:103], v[112:115], v[208:211]
v_cvt_pk_bf16_f32 v54, v184, v185
v_cvt_pk_bf16_f32 v55, v186, v187
v_mfma_f32_16x16x32_bf16 v[224:227], v[104:107], v[112:115], v[224:227]
v_cvt_pk_bf16_f32 v36, v164, v165
v_cvt_pk_bf16_f32 v37, v166, v167
v_mfma_f32_16x16x32_bf16 v[228:231], v[104:107], v[116:119], v[228:231]
v_cvt_pk_bf16_f32 v38, v180, v181
v_cvt_pk_bf16_f32 v39, v182, v183
v_mfma_f32_16x16x32_bf16 v[232:235], v[104:107], v[120:123], v[232:235]
v_cvt_pk_bf16_f32 v20, v160, v161
v_cvt_pk_bf16_f32 v21, v162, v163
v_mfma_f32_16x16x32_bf16 v[236:239], v[104:107], v[124:127], v[236:239]
v_cvt_pk_bf16_f32 v22, v176, v177
v_cvt_pk_bf16_f32 v23, v178, v179
v_mfma_f32_16x16x32_bf16 v[252:255], v[108:111], v[124:127], v[252:255]
v_cvt_pk_bf16_f32 v72, v204, v205
v_cvt_pk_bf16_f32 v73, v206, v207
v_mfma_f32_16x16x32_bf16 v[248:251], v[108:111], v[120:123], v[248:251]
v_cvt_pk_bf16_f32 v74, v220, v221
v_cvt_pk_bf16_f32 v75, v222, v223
v_mfma_f32_16x16x32_bf16 v[244:247], v[108:111], v[116:119], v[244:247]
v_cvt_pk_bf16_f32 v56, v200, v201
v_cvt_pk_bf16_f32 v57, v202, v203
v_mfma_f32_16x16x32_bf16 v[240:243], v[108:111], v[112:115], v[240:243]
v_cvt_pk_bf16_f32 v58, v216, v217
v_cvt_pk_bf16_f32 v59, v218, v219
v_cvt_pk_bf16_f32 v40, v196, v197
v_cvt_pk_bf16_f32 v41, v198, v199
v_cvt_pk_bf16_f32 v42, v212, v213
v_cvt_pk_bf16_f32 v43, v214, v215
v_cvt_pk_bf16_f32 v24, v192, v193
v_cvt_pk_bf16_f32 v25, v194, v195
v_cvt_pk_bf16_f32 v26, v208, v209
v_cvt_pk_bf16_f32 v27, v210, v211
v_cvt_pk_bf16_f32 v76, v236, v237
v_cvt_pk_bf16_f32 v77, v238, v239
v_cvt_pk_bf16_f32 v78, v252, v253
v_cvt_pk_bf16_f32 v79, v254, v255
v_cvt_pk_bf16_f32 v60, v232, v233
v_cvt_pk_bf16_f32 v61, v234, v235
v_cvt_pk_bf16_f32 v62, v248, v249
v_cvt_pk_bf16_f32 v63, v250, v251
v_cvt_pk_bf16_f32 v44, v228, v229
v_cvt_pk_bf16_f32 v45, v230, v231
v_cvt_pk_bf16_f32 v46, v244, v245
v_cvt_pk_bf16_f32 v47, v246, v247
v_cvt_pk_bf16_f32 v28, v224, v225
v_cvt_pk_bf16_f32 v29, v226, v227
v_cvt_pk_bf16_f32 v30, v240, v241
v_cvt_pk_bf16_f32 v31, v242, v243
v_mov_b32 v124, 0xff800000
v_mov_b32 v125, 0xff800000
v_mov_b32 v126, 0xff800000
v_mov_b32 v127, 0xff800000
s_lshl_b32 s84, s60, 2
s_add_u32 s84, s84, s58
s_mov_b32 s86, 0
s_add_u32 s61, s65, s60
s_and_b32 s73, s60, 1
s_lshl_b32 s73, s73, 16
s_add_u32 s77, s73, s64
s_xor_b32 s73, s73, 0x10000
s_mov_b32 s92, s73
s_mul_i32 s62, s58, 4608
s_add_u32 s62, s62, 143104
s_add_u32 s73, s73, 49920
s_cmp_eq_u32 s58, 0
s_cselect_b32 s62, s73, s62
Lattn:
s_mov_b32 s82, 0x10000
s_waitcnt lgkmcnt(0)
v_mfma_f32_16x16x32_bf16 v[136:139], a[128:131], v[48:51], 0
ds_read_b128 a[160:163], v2 offset:24576
v_lshrrev_b32 v240, 4, v0
v_mfma_f32_16x16x32_bf16 v[136:139], a[132:135], v[52:55], v[136:139]
ds_read_b128 a[164:167], v2 offset:25600
v_and_b32 v241, 15, v0
v_mfma_f32_16x16x32_bf16 v[136:139], a[136:139], v[56:59], v[136:139]
ds_read_b128 a[168:171], v2 offset:26624
v_lshlrev_b32 v240, 2, v240
v_mfma_f32_16x16x32_bf16 v[136:139], a[140:143], v[60:63], v[136:139]
ds_read_b128 a[172:175], v2 offset:27648
v_sub_u32 v240, v241, v240
v_mfma_f32_16x16x32_bf16 v[140:143], a[140:143], v[76:79], 0
ds_read_b128 a[176:179], v2 offset:28672
v_mov_b32 v112, 0xff800000
v_mfma_f32_16x16x32_bf16 v[140:143], a[136:139], v[72:75], v[140:143]
ds_read_b128 a[180:183], v2 offset:29696
v_mov_b32 v113, 0xff800000
v_mfma_f32_16x16x32_bf16 v[140:143], a[132:135], v[68:71], v[140:143]
ds_read_b128 a[184:187], v2 offset:30720
v_mov_b32 v114, 0xff800000
v_mfma_f32_16x16x32_bf16 v[140:143], a[128:131], v[64:67], v[140:143]
ds_read_b128 a[188:191], v2 offset:31744
v_mov_b32 v115, 0xff800000
v_mfma_f32_16x16x32_bf16 v[156:159], a[144:147], v[64:67], 0
v_cmp_gt_i32 vcc, 0, v240
v_mov_b32 v120, 0x3f803f80
v_mfma_f32_16x16x32_bf16 v[156:159], a[148:151], v[68:71], v[156:159]
v_cndmask_b32 v116, 0, v112, vcc
v_cmp_gt_i32 vcc, 1, v240
v_mfma_f32_16x16x32_bf16 v[156:159], a[152:155], v[72:75], v[156:159]
v_mov_b32 v121, 0x3f803f80
v_cndmask_b32 v117, 0, v112, vcc
v_mfma_f32_16x16x32_bf16 v[156:159], a[156:159], v[76:79], v[156:159]
v_cmp_gt_i32 vcc, 2, v240
v_mov_b32 v122, 0x3f803f80
v_mfma_f32_16x16x32_bf16 v[152:155], a[156:159], v[60:63], 0
v_cndmask_b32 v118, 0, v112, vcc
v_cmp_gt_i32 vcc, 3, v240
v_mfma_f32_16x16x32_bf16 v[152:155], a[152:155], v[56:59], v[152:155]
v_mov_b32 v123, 0x3f803f80
v_cndmask_b32 v119, 0, v112, vcc
v_mfma_f32_16x16x32_bf16 v[152:155], a[148:151], v[52:55], v[152:155]
v_mfma_f32_16x16x32_bf16 v[152:155], a[144:147], v[48:51], v[152:155]
s_cmp_eq_u32 s84, 0
s_cbranch_scc1 Lta7
s_cmp_eq_u32 s84, 1
s_cbranch_scc1 Lnt8
v_mfma_f32_16x16x32_bf16 v[128:131], a[128:131], v[16:19], 0
v_mfma_f32_16x16x32_bf16 v[144:147], a[144:147], v[16:19], 0
s_branch Ljoin9
Lta7:
v_mfma_f32_16x16x32_bf16 v[128:131], a[128:131], v[16:19], v[116:119]
v_mfma_f32_16x16x32_bf16 v[144:147], a[144:147], v[16:19], v[112:115]
s_branch Ljoin9
Lnt8:
v_mfma_f32_16x16x32_bf16 v[128:131], a[128:131], v[16:19], 0
v_mfma_f32_16x16x32_bf16 v[144:147], a[144:147], v[16:19], v[116:119]
Ljoin9:
v_mfma_f32_16x16x32_bf16 v[128:131], a[132:135], v[20:23], v[128:131]
v_mfma_f32_16x16x32_bf16 v[128:131], a[136:139], v[24:27], v[128:131]
v_mfma_f32_16x16x32_bf16 v[128:131], a[140:143], v[28:31], v[128:131]
v_max3_f32 v240, v136, v137, v126
v_max3_f32 v242, v140, v141, v127
v_mfma_f32_16x16x32_bf16 v[132:135], a[140:143], v[44:47], 0
v_max3_f32 v240, v240, v138, v139
v_max3_f32 v242, v242, v142, v143
v_mfma_f32_16x16x32_bf16 v[132:135], a[136:139], v[40:43], v[132:135]
v_max3_f32 v240, v240, v152, v153
v_max3_f32 v242, v242, v156, v157
v_mfma_f32_16x16x32_bf16 v[132:135], a[132:135], v[36:39], v[132:135]
v_max3_f32 v240, v240, v154, v155
v_max3_f32 v242, v242, v158, v159
v_mfma_f32_16x16x32_bf16 v[132:135], a[128:131], v[32:35], v[132:135]
v_mov_b32 v241, v240
v_mov_b32 v243, v242
v_mfma_f32_16x16x32_bf16 v[148:151], a[144:147], v[32:35], 0
v_permlane16_swap_b32 v240, v241
v_permlane16_swap_b32 v242, v243
v_mfma_f32_16x16x32_bf16 v[148:151], a[148:151], v[36:39], v[148:151]
v_max_f32 v240, v240, v241
v_max_f32 v242, v242, v243
v_mfma_f32_16x16x32_bf16 v[148:151], a[152:155], v[40:43], v[148:151]
v_mov_b32 v241, v240
v_mov_b32 v243, v242
v_mfma_f32_16x16x32_bf16 v[148:151], a[156:159], v[44:47], v[148:151]
v_permlane32_swap_b32 v240, v241
v_permlane32_swap_b32 v242, v243
v_mfma_f32_16x16x32_bf16 v[144:147], a[156:159], v[28:31], v[144:147]
v_max_f32 v240, v240, v241
v_max_f32 v242, v242, v243
v_mfma_f32_16x16x32_bf16 v[144:147], a[152:155], v[24:27], v[144:147]
v_mfma_f32_16x16x32_bf16 v[144:147], a[148:151], v[20:23], v[144:147]
v_sub_f32 v88, 0, v240
v_sub_f32 v89, 0, v240
v_pk_add_f32 v[90:91], v[88:89], 0
v_pk_add_f32 v[104:105], v[116:117], v[88:89]
v_pk_add_f32 v[106:107], v[118:119], v[88:89]
v_pk_add_f32 v[136:137], v[136:137], v[88:89]
v_pk_add_f32 v[138:139], v[138:139], v[88:89]
v_pk_add_f32 v[152:153], v[152:153], v[88:89]
v_pk_add_f32 v[154:155], v[154:155], v[88:89]
v_sub_f32 v92, 0, v242
v_sub_f32 v93, 0, v242
v_pk_add_f32 v[94:95], v[92:93], 0
v_pk_add_f32 v[108:109], v[116:117], v[92:93]
v_pk_add_f32 v[110:111], v[118:119], v[92:93]
v_pk_add_f32 v[140:141], v[140:141], v[92:93]
v_pk_add_f32 v[142:143], v[142:143], v[92:93]
v_pk_add_f32 v[156:157], v[156:157], v[92:93]
v_pk_add_f32 v[158:159], v[158:159], v[92:93]
v_max3_f32 v240, v128, v129, v124
v_max3_f32 v242, v132, v133, v125
v_max3_f32 v240, v240, v130, v131
v_max3_f32 v242, v242, v134, v135
v_max3_f32 v240, v240, v144, v145
v_max3_f32 v242, v242, v148, v149
v_max3_f32 v240, v240, v146, v147
v_max3_f32 v242, v242, v150, v151
v_mov_b32 v241, v240
v_mov_b32 v243, v242
s_nop 0
v_permlane16_swap_b32 v240, v241
v_permlane16_swap_b32 v242, v243
v_max_f32 v240, v240, v241
v_max_f32 v242, v242, v243
v_mov_b32 v241, v240
v_mov_b32 v243, v242
s_nop 0
v_permlane32_swap_b32 v240, v241
v_permlane32_swap_b32 v242, v243
v_max_f32 v240, v240, v241
v_max_f32 v242, v242, v243
v_sub_f32 v80, 0, v240
v_sub_f32 v81, 0, v240
v_pk_add_f32 v[82:83], v[80:81], 0
v_pk_add_f32 v[96:97], v[116:117], v[80:81]
v_pk_add_f32 v[98:99], v[118:119], v[80:81]
v_pk_add_f32 v[128:129], v[128:129], v[80:81]
v_pk_add_f32 v[130:131], v[130:131], v[80:81]
v_pk_add_f32 v[144:145], v[144:145], v[80:81]
v_pk_add_f32 v[146:147], v[146:147], v[80:81]
v_sub_f32 v84, 0, v242
v_sub_f32 v85, 0, v242
v_pk_add_f32 v[86:87], v[84:85], 0
v_pk_add_f32 v[100:101], v[116:117], v[84:85]
v_pk_add_f32 v[102:103], v[118:119], v[84:85]
v_pk_add_f32 v[132:133], v[132:133], v[84:85]
v_pk_add_f32 v[134:135], v[134:135], v[84:85]
v_pk_add_f32 v[148:149], v[148:149], v[84:85]
v_pk_add_f32 v[150:151], v[150:151], v[84:85]
v_add_u32 v2, s82, v1
s_waitcnt vmcnt(13) lgkmcnt(0)
s_barrier
s_cmp_eq_u32 s60, 0
s_cbranch_scc1 LP0x
v_mfma_f32_16x16x32_bf16 v[160:163], a[160:163], v[16:19], v[80:83]
s_xor_b32 s74, s82, 0x10000
v_exp_f32 v128, v128
v_mfma_f32_16x16x32_bf16 v[160:163], a[164:167], v[20:23], v[160:163]
s_add_u32 s74, s74, s64
ds_read_b128 a[128:131], v2 offset:16384
ds_read_b128 a[132:135], v2 offset:17408
v_mfma_f32_16x16x32_bf16 v[160:163], a[168:171], v[24:27], v[160:163]
s_add_u32 s81, s81, 0x8000
v_exp_f32 v129, v129
v_mfma_f32_16x16x32_bf16 v[160:163], a[172:175], v[28:31], v[160:163]
s_add_u32 m0, s74, 16384
v_exp_f32 v130, v130
v_mfma_f32_16x16x32_bf16 v[164:167], a[172:175], v[44:47], v[84:87]
s_add_u32 s72, s81, 16384
v_exp_f32 v131, v131
v_mfma_f32_16x16x32_bf16 v[164:167], a[168:171], v[40:43], v[164:167]
v_exp_f32 v144, v144
v_mfma_f32_16x16x32_bf16 v[164:167], a[164:167], v[36:39], v[164:167]
ds_read_b128 a[136:139], v2 offset:18432
ds_read_b128 a[140:143], v2 offset:19456
v_mfma_f32_16x16x32_bf16 v[164:167], a[160:163], v[32:35], v[164:167]
ds_read_b128 a[144:147], v2 offset:20480
ds_read_b128 a[148:151], v2 offset:21504
v_mfma_f32_16x16x32_bf16 v[168:171], a[160:163], v[48:51], v[88:91]
ds_read_b128 a[152:155], v2 offset:22528
ds_read_b128 a[156:159], v2 offset:23552
v_mfma_f32_16x16x32_bf16 v[168:171], a[164:167], v[52:55], v[168:171]
ds_read_b128 a[192:195], v2 offset:0
ds_read_b128 a[196:199], v2 offset:1024
v_mfma_f32_16x16x32_bf16 v[168:171], a[168:171], v[56:59], v[168:171]
ds_read_b128 a[200:203], v2 offset:2048
ds_read_b128 a[204:207], v2 offset:3072
v_mfma_f32_16x16x32_bf16 v[168:171], a[172:175], v[60:63], v[168:171]
ds_read_b128 a[208:211], v2 offset:4096
ds_read_b128 a[212:215], v2 offset:5120
v_mfma_f32_16x16x32_bf16 v[172:175], a[172:175], v[76:79], v[92:95]
ds_read_b128 a[216:219], v2 offset:6144
ds_read_b128 a[220:223], v2 offset:7168
v_mfma_f32_16x16x32_bf16 v[172:175], a[168:171], v[72:75], v[172:175]
v_cvt_pk_bf16_f32 v192, v128, v129
v_cvt_pk_bf16_f32 v193, v130, v131
v_mfma_f32_16x16x32_bf16 v[172:175], a[164:167], v[68:71], v[172:175]
buffer_load_dwordx4 v1, s[44:47], s72 offen sc1 lds
v_mfma_f32_16x16x32_bf16 v[172:175], a[160:163], v[64:67], v[172:175]
v_exp_f32 v145, v145
v_mfma_f32_16x16x32_bf16 v[188:191], a[176:179], v[64:67], v[92:95]
v_exp_f32 v146, v146
v_mfma_f32_16x16x32_bf16 v[188:191], a[180:183], v[68:71], v[188:191]
v_exp_f32 v147, v147
v_mfma_f32_16x16x32_bf16 v[188:191], a[184:187], v[72:75], v[188:191]
v_exp_f32 v132, v132
v_mfma_f32_16x16x32_bf16 v[188:191], a[188:191], v[76:79], v[188:191]
v_cvt_pk_bf16_f32 v194, v144, v145
v_cvt_pk_bf16_f32 v195, v146, v147
v_mfma_f32_16x16x32_bf16 v[184:187], a[188:191], v[60:63], v[88:91]
v_exp_f32 v133, v133
v_mfma_f32_16x16x32_bf16 v[184:187], a[184:187], v[56:59], v[184:187]
v_exp_f32 v134, v134
v_mfma_f32_16x16x32_bf16 v[184:187], a[180:183], v[52:55], v[184:187]
v_exp_f32 v135, v135
v_mfma_f32_16x16x32_bf16 v[184:187], a[176:179], v[48:51], v[184:187]
v_exp_f32 v148, v148
v_mfma_f32_16x16x32_bf16 v[180:183], a[176:179], v[32:35], v[84:87]
v_cvt_pk_bf16_f32 v196, v132, v133
v_cvt_pk_bf16_f32 v197, v134, v135
v_mfma_f32_16x16x32_bf16 v[180:183], a[180:183], v[36:39], v[180:183]
buffer_load_dwordx4 v1, s[44:47], s72 offen offset:1024 sc1 lds
v_mfma_f32_16x16x32_bf16 v[180:183], a[184:187], v[40:43], v[180:183]
Lstub0:
s_cbranch_execz Lstub4
v_exp_f32 v149, v149
v_mfma_f32_16x16x32_bf16 v[180:183], a[188:191], v[44:47], v[180:183]
v_exp_f32 v150, v150
v_mfma_f32_16x16x32_bf16 v[176:179], a[188:191], v[28:31], v[80:83]
v_exp_f32 v151, v151
v_mfma_f32_16x16x32_bf16 v[176:179], a[184:187], v[24:27], v[176:179]
buffer_load_dwordx4 v1, s[44:47], s72 offen offset:2048 sc1 lds
v_mfma_f32_16x16x32_bf16 v[176:179], a[180:183], v[20:23], v[176:179]
buffer_load_dwordx4 v1, s[44:47], s72 offen offset:3072 sc1 lds
v_mfma_f32_16x16x32_bf16 v[176:179], a[176:179], v[16:19], v[176:179]
s_waitcnt lgkmcnt(8)
v_exp_f32 v136, v136
v_cvt_pk_bf16_f32 v198, v148, v149
v_cvt_pk_bf16_f32 v199, v150, v151
v_exp_f32 v137, v137
v_exp_f32 v138, v138
v_cvt_pk_bf16_f32 v200, v136, v137
v_exp_f32 v139, v139
v_exp_f32 v152, v152
v_cvt_pk_bf16_f32 v201, v138, v139
v_exp_f32 v153, v153
v_exp_f32 v154, v154
v_cvt_pk_bf16_f32 v202, v152, v153
v_exp_f32 v155, v155
v_exp_f32 v140, v140
v_cvt_pk_bf16_f32 v203, v154, v155
v_exp_f32 v141, v141
v_exp_f32 v142, v142
v_cvt_pk_bf16_f32 v204, v140, v141
v_exp_f32 v143, v143
v_exp_f32 v156, v156
v_cvt_pk_bf16_f32 v205, v142, v143
v_exp_f32 v157, v157
v_exp_f32 v158, v158
v_cvt_pk_bf16_f32 v206, v156, v157
v_exp_f32 v159, v159
s_nop 0
v_cvt_pk_bf16_f32 v207, v158, v159
v_mfma_f32_16x16x32_bf16 v[128:131], a[128:131], v[16:19], v[80:83]
s_add_u32 s82, s82, 0x8000
ds_read_b128 a[160:163], v2 offset:24576
v_mfma_f32_16x16x32_bf16 v[128:131], a[132:135], v[20:23], v[128:131]
s_and_b32 s82, s82, 0x1ffff
v_exp_f32 v160, v160
v_mfma_f32_16x16x32_bf16 v[128:131], a[136:139], v[24:27], v[128:131]
s_add_u32 m0, s74, 0
v_exp_f32 v161, v161
v_mfma_f32_16x16x32_bf16 v[128:131], a[140:143], v[28:31], v[128:131]
s_add_u32 s72, s81, 0
ds_read_b128 a[164:167], v2 offset:25600
v_cvt_pk_bf16_f32 v208, v160, v161
v_mfma_f32_16x16x32_bf16 v[132:135], a[140:143], v[44:47], v[84:87]
v_exp_f32 v162, v162
v_mfma_f32_16x16x32_bf16 v[132:135], a[136:139], v[40:43], v[132:135]
buffer_load_dwordx4 v1, s[44:47], s72 offen sc1 lds
v_mfma_f32_16x16x32_bf16 v[132:135], a[132:135], v[36:39], v[132:135]
v_exp_f32 v163, v163
v_mfma_f32_16x16x32_bf16 v[132:135], a[128:131], v[32:35], v[132:135]
ds_read_b128 a[168:171], v2 offset:26624
v_cvt_pk_bf16_f32 v209, v162, v163
v_mfma_f32_16x16x32_bf16 v[136:139], a[128:131], v[48:51], v[88:91]
v_exp_f32 v176, v176
v_mfma_f32_16x16x32_bf16 v[136:139], a[132:135], v[52:55], v[136:139]
v_exp_f32 v177, v177
v_mfma_f32_16x16x32_bf16 v[136:139], a[136:139], v[56:59], v[136:139]
ds_read_b128 a[172:175], v2 offset:27648
v_cvt_pk_bf16_f32 v210, v176, v177
v_mfma_f32_16x16x32_bf16 v[136:139], a[140:143], v[60:63], v[136:139]
v_exp_f32 v178, v178
v_mfma_f32_16x16x32_bf16 v[140:143], a[140:143], v[76:79], v[92:95]
buffer_load_dwordx4 v1, s[44:47], s72 offen offset:1024 sc1 lds
v_mfma_f32_16x16x32_bf16 v[140:143], a[136:139], v[72:75], v[140:143]
v_exp_f32 v179, v179
v_mfma_f32_16x16x32_bf16 v[140:143], a[132:135], v[68:71], v[140:143]
ds_read_b128 a[176:179], v2 offset:28672
v_cvt_pk_bf16_f32 v211, v178, v179
v_mfma_f32_16x16x32_bf16 v[140:143], a[128:131], v[64:67], v[140:143]
v_exp_f32 v164, v164
v_mfma_f32_16x16x32_bf16 v[156:159], a[144:147], v[64:67], v[92:95]
v_exp_f32 v165, v165
v_mfma_f32_16x16x32_bf16 v[156:159], a[148:151], v[68:71], v[156:159]
ds_read_b128 a[180:183], v2 offset:29696
v_cvt_pk_bf16_f32 v212, v164, v165
v_mfma_f32_16x16x32_bf16 v[156:159], a[152:155], v[72:75], v[156:159]
v_exp_f32 v166, v166
v_mfma_f32_16x16x32_bf16 v[156:159], a[156:159], v[76:79], v[156:159]
buffer_load_dwordx4 v1, s[44:47], s72 offen offset:2048 sc1 lds
v_mfma_f32_16x16x32_bf16 v[152:155], a[156:159], v[60:63], v[88:91]
v_exp_f32 v167, v167
v_mfma_f32_16x16x32_bf16 v[152:155], a[152:155], v[56:59], v[152:155]
ds_read_b128 a[184:187], v2 offset:30720
v_cvt_pk_bf16_f32 v213, v166, v167
v_mfma_f32_16x16x32_bf16 v[152:155], a[148:151], v[52:55], v[152:155]
v_exp_f32 v180, v180
v_mfma_f32_16x16x32_bf16 v[152:155], a[144:147], v[48:51], v[152:155]
v_exp_f32 v181, v181
v_mfma_f32_16x16x32_bf16 v[148:151], a[144:147], v[32:35], v[84:87]
ds_read_b128 a[188:191], v2 offset:31744
v_cvt_pk_bf16_f32 v214, v180, v181
v_mfma_f32_16x16x32_bf16 v[148:151], a[148:151], v[36:39], v[148:151]
v_exp_f32 v182, v182
v_mfma_f32_16x16x32_bf16 v[148:151], a[152:155], v[40:43], v[148:151]
buffer_load_dwordx4 v1, s[44:47], s72 offen offset:3072 sc1 lds
v_mfma_f32_16x16x32_bf16 v[148:151], a[156:159], v[44:47], v[148:151]
s_add_u32 s66, s58, 1
v_exp_f32 v183, v183
v_mfma_f32_16x16x32_bf16 v[144:147], a[156:159], v[28:31], v[80:83]
s_and_b32 s66, s66, 3
ds_read_b128 a[224:227], v2 offset:8192
v_cvt_pk_bf16_f32 v215, v182, v183
v_mfma_f32_16x16x32_bf16 v[144:147], a[152:155], v[24:27], v[144:147]
s_mul_i32 s66, s66, 4160
v_exp_f32 v168, v168
v_mfma_f32_16x16x32_bf16 v[144:147], a[148:151], v[20:23], v[144:147]
s_add_u32 m0, s66, 131104
v_exp_f32 v169, v169
v_mfma_f32_16x16x32_bf16 v[144:147], a[144:147], v[16:19], v[144:147]
s_waitcnt lgkmcnt(9)
ds_read_b128 a[228:231], v2 offset:9216
v_cvt_pk_bf16_f32 v216, v168, v169
v_mfma_f32_16x16x32_bf16 a[0:3], a[192:195], v[192:195], 0
s_add_u32 s72, s93, 0x2
v_exp_f32 v170, v170
v_mfma_f32_16x16x32_bf16 a[32:35], a[192:195], v[196:199], 0
buffer_load_dwordx4 v1, s[36:39], s72 offen lds
v_mfma_f32_16x16x32_bf16 a[64:67], a[192:195], v[200:203], 0
v_exp_f32 v171, v171
v_mfma_f32_16x16x32_bf16 a[96:99], a[192:195], v[204:207], 0
ds_read_b128 a[232:235], v2 offset:10240
v_cvt_pk_bf16_f32 v217, v170, v171
v_mfma_f32_16x16x32_bf16 a[100:103], a[196:199], v[204:207], 0
v_exp_f32 v184, v184
v_mfma_f32_16x16x32_bf16 a[68:71], a[196:199], v[200:203], 0
v_exp_f32 v185, v185
v_mfma_f32_16x16x32_bf16 a[36:39], a[196:199], v[196:199], 0
ds_read_b128 a[236:239], v2 offset:11264
v_cvt_pk_bf16_f32 v218, v184, v185
v_mfma_f32_16x16x32_bf16 a[4:7], a[196:199], v[192:195], 0
v_exp_f32 v186, v186
v_mfma_f32_16x16x32_bf16 a[8:11], a[200:203], v[192:195], 0
buffer_load_dwordx4 v1, s[36:39], s72 offen offset:1024 lds
v_mfma_f32_16x16x32_bf16 a[40:43], a[200:203], v[196:199], 0
v_exp_f32 v187, v187
v_mfma_f32_16x16x32_bf16 a[72:75], a[200:203], v[200:203], 0
ds_read_b128 a[240:243], v2 offset:12288
v_cvt_pk_bf16_f32 v219, v186, v187
v_mfma_f32_16x16x32_bf16 a[104:107], a[200:203], v[204:207], 0
v_exp_f32 v172, v172
v_mfma_f32_16x16x32_bf16 a[108:111], a[204:207], v[204:207], 0
v_exp_f32 v173, v173
v_mfma_f32_16x16x32_bf16 a[76:79], a[204:207], v[200:203], 0
ds_read_b128 a[244:247], v2 offset:13312
v_cvt_pk_bf16_f32 v220, v172, v173
v_mfma_f32_16x16x32_bf16 a[44:47], a[204:207], v[196:199], 0
v_exp_f32 v174, v174
v_mfma_f32_16x16x32_bf16 a[12:15], a[204:207], v[192:195], 0
buffer_load_dwordx4 v1, s[36:39], s72 offen offset:2048 lds
v_mfma_f32_16x16x32_bf16 a[16:19], a[208:211], v[192:195], 0
v_exp_f32 v175, v175
v_mfma_f32_16x16x32_bf16 a[48:51], a[208:211], v[196:199], 0
ds_read_b128 a[248:251], v2 offset:14336
v_cvt_pk_bf16_f32 v221, v174, v175
v_mfma_f32_16x16x32_bf16 a[80:83], a[208:211], v[200:203], 0
v_exp_f32 v188, v188
v_mfma_f32_16x16x32_bf16 a[112:115], a[208:211], v[204:207], 0
v_exp_f32 v189, v189
v_mfma_f32_16x16x32_bf16 a[116:119], a[212:215], v[204:207], 0
ds_read_b128 a[252:255], v2 offset:15360
v_cvt_pk_bf16_f32 v222, v188, v189
v_mfma_f32_16x16x32_bf16 a[84:87], a[212:215], v[200:203], 0
v_exp_f32 v190, v190
v_mfma_f32_16x16x32_bf16 a[52:55], a[212:215], v[196:199], 0
buffer_load_dwordx4 v1, s[36:39], s72 offen offset:3072 lds
v_mfma_f32_16x16x32_bf16 a[20:23], a[212:215], v[192:195], 0
v_exp_f32 v191, v191
v_mfma_f32_16x16x32_bf16 a[24:27], a[216:219], v[192:195], 0
v_cvt_pk_bf16_f32 v223, v190, v191
v_add_u32 v2, s82, v1
v_mfma_f32_16x16x32_bf16 a[56:59], a[216:219], v[196:199], 0
v_and_b32 v240, 15, v0
v_lshrrev_b32 v241, 4, v0
v_mfma_f32_16x16x32_bf16 a[88:91], a[216:219], v[200:203], 0
v_add_u32 v248, 1, v240
v_and_b32 v249, 3, v248
v_mfma_f32_16x16x32_bf16 a[120:123], a[216:219], v[204:207], 0
v_lshrrev_b32 v248, 2, v248
v_mov_b32 v250, 0x20000
v_mfma_f32_16x16x32_bf16 a[124:127], a[220:223], v[204:207], 0
v_mov_b32 v252, 0x20001
v_lshlrev_b32 v6, 3, v249
v_mfma_f32_16x16x32_bf16 a[92:95], a[220:223], v[200:203], 0
v_lshrrev_b32 v6, v6, v252
v_and_b32 v6, 3, v6
v_mfma_f32_16x16x32_bf16 a[60:63], a[220:223], v[196:199], 0
v_cmp_ne_u32 vcc, 1, v249
v_mul_u32_u24 v6, 16640, v6
v_mfma_f32_16x16x32_bf16 a[28:31], a[220:223], v[192:195], 0
v_add_u32 v6, s92, v6
v_cndmask_b32 v6, v250, v6, vcc
v_mfma_f32_16x16x32_bf16 v[224:227], v[120:123], v[192:195], 0
v_add_u32 v253, s58, v249
v_and_b32 v253, 3, v253
v_mfma_f32_16x16x32_bf16 v[228:231], v[120:123], v[196:199], 0
v_mul_u32_u24 v253, 4160, v253
v_add_u32 v6, v6, v253
v_mfma_f32_16x16x32_bf16 v[232:235], v[120:123], v[200:203], 0
s_waitcnt vmcnt(12) lgkmcnt(8)
v_mfma_f32_16x16x32_bf16 v[236:239], v[120:123], v[204:207], 0
s_barrier
s_lshl_b32 s75, s59, 4
s_and_b32 s76, s84, 15
s_add_u32 s75, s75, s76
s_lshl_b32 s75, s75, 14
s_cmp_ge_u32 s60, 4
s_cselect_b32 s75, s75, 0x40001000
s_lshl_b32 s83, s60, 1
s_sub_u32 s83, 2, s83
s_cmp_eq_u32 s83, 0
s_cbranch_scc1 LLT1
.p2align 5
s_nop 0
s_nop 0
LloopI:
v_mfma_f32_16x16x32_bf16 v[160:163], a[160:163], v[16:19], v[80:83]
s_xor_b32 s74, s82, 0x10000
v_exp_f32 v128, v128
v_mfma_f32_16x16x32_bf16 v[160:163], a[164:167], v[20:23], v[160:163]
s_add_u32 s74, s74, s64
ds_read_b128 a[128:131], v2 offset:16384
v_mfma_f32_16x16x32_bf16 v[160:163], a[168:171], v[24:27], v[160:163]
s_add_u32 s81, s81, 0x8000
v_exp_f32 v129, v129
v_mfma_f32_16x16x32_bf16 v[160:163], a[172:175], v[28:31], v[160:163]
s_add_u32 m0, s74, 16384
v_exp_f32 v130, v130
v_mfma_f32_16x16x32_bf16 v[164:167], a[172:175], v[44:47], v[84:87]
s_add_u32 s72, s81, 16384
ds_read_b128 a[132:135], v2 offset:17408
v_cvt_pk_bf16_f32 v192, v128, v129
v_mfma_f32_16x16x32_bf16 v[164:167], a[168:171], v[40:43], v[164:167]
v_exp_f32 v131, v131
v_mfma_f32_16x16x32_bf16 v[164:167], a[164:167], v[36:39], v[164:167]
v_exp_f32 v144, v144
v_mfma_f32_16x16x32_bf16 v[164:167], a[160:163], v[32:35], v[164:167]
ds_read_b128 a[136:139], v2 offset:18432
v_cvt_pk_bf16_f32 v193, v130, v131
v_mfma_f32_16x16x32_bf16 v[168:171], a[160:163], v[48:51], v[88:91]
buffer_load_dwordx4 v1, s[44:47], s72 offen sc1 lds
v_mfma_f32_16x16x32_bf16 v[168:171], a[164:167], v[52:55], v[168:171]
v_exp_f32 v145, v145
v_mfma_f32_16x16x32_bf16 v[168:171], a[168:171], v[56:59], v[168:171]
v_exp_f32 v146, v146
v_mfma_f32_16x16x32_bf16 v[168:171], a[172:175], v[60:63], v[168:171]
ds_read_b128 a[140:143], v2 offset:19456
v_cvt_pk_bf16_f32 v194, v144, v145
v_mfma_f32_16x16x32_bf16 v[172:175], a[172:175], v[76:79], v[92:95]
v_exp_f32 v147, v147
v_mfma_f32_16x16x32_bf16 v[172:175], a[168:171], v[72:75], v[172:175]
v_exp_f32 v132, v132
v_mfma_f32_16x16x32_bf16 v[172:175], a[164:167], v[68:71], v[172:175]
ds_read_b128 a[144:147], v2 offset:20480
v_cvt_pk_bf16_f32 v195, v146, v147
v_mfma_f32_16x16x32_bf16 v[172:175], a[160:163], v[64:67], v[172:175]
v_exp_f32 v133, v133
v_mfma_f32_16x16x32_bf16 v[188:191], a[176:179], v[64:67], v[92:95]
v_exp_f32 v134, v134
v_mfma_f32_16x16x32_bf16 v[188:191], a[180:183], v[68:71], v[188:191]
ds_read_b128 a[148:151], v2 offset:21504
v_cvt_pk_bf16_f32 v196, v132, v133
v_mfma_f32_16x16x32_bf16 v[188:191], a[184:187], v[72:75], v[188:191]
v_exp_f32 v135, v135
v_mfma_f32_16x16x32_bf16 v[188:191], a[188:191], v[76:79], v[188:191]
v_exp_f32 v148, v148
v_mfma_f32_16x16x32_bf16 v[184:187], a[188:191], v[60:63], v[88:91]
ds_read_b128 a[152:155], v2 offset:22528
v_cvt_pk_bf16_f32 v197, v134, v135
v_mfma_f32_16x16x32_bf16 v[184:187], a[184:187], v[56:59], v[184:187]
buffer_load_dwordx4 v1, s[44:47], s72 offen offset:1024 sc1 lds
v_mfma_f32_16x16x32_bf16 v[184:187], a[180:183], v[52:55], v[184:187]
v_exp_f32 v149, v149
v_mfma_f32_16x16x32_bf16 v[184:187], a[176:179], v[48:51], v[184:187]
v_exp_f32 v150, v150
v_mfma_f32_16x16x32_bf16 v[180:183], a[176:179], v[32:35], v[84:87]
ds_read_b128 a[156:159], v2 offset:23552
v_cvt_pk_bf16_f32 v198, v148, v149
v_mfma_f32_16x16x32_bf16 v[180:183], a[180:183], v[36:39], v[180:183]
v_exp_f32 v151, v151
v_mfma_f32_16x16x32_bf16 v[180:183], a[184:187], v[40:43], v[180:183]
v_exp_f32 v136, v136
v_mfma_f32_16x16x32_bf16 v[180:183], a[188:191], v[44:47], v[180:183]
ds_read_b128 a[192:195], v2 offset:0
v_cvt_pk_bf16_f32 v199, v150, v151
v_mfma_f32_16x16x32_bf16 v[176:179], a[188:191], v[28:31], v[80:83]
v_exp_f32 v137, v137
v_mfma_f32_16x16x32_bf16 v[176:179], a[184:187], v[24:27], v[176:179]
v_exp_f32 v138, v138
v_mfma_f32_16x16x32_bf16 v[176:179], a[180:183], v[20:23], v[176:179]
ds_read_b128 a[196:199], v2 offset:1024
v_cvt_pk_bf16_f32 v200, v136, v137
v_mfma_f32_16x16x32_bf16 v[176:179], a[176:179], v[16:19], v[176:179]
s_waitcnt lgkmcnt(10)
v_exp_f32 v139, v139
v_mfma_f32_16x16x32_bf16 a[0:3], a[224:227], v[208:211], a[0:3]
v_exp_f32 v152, v152
v_mfma_f32_16x16x32_bf16 a[32:35], a[224:227], v[212:215], a[32:35]
ds_read_b128 a[200:203], v2 offset:2048
v_cvt_pk_bf16_f32 v201, v138, v139
v_mfma_f32_16x16x32_bf16 a[64:67], a[224:227], v[216:219], a[64:67]
buffer_load_dwordx4 v1, s[44:47], s72 offen offset:2048 sc1 lds
v_mfma_f32_16x16x32_bf16 a[96:99], a[224:227], v[220:223], a[96:99]
v_exp_f32 v153, v153
v_mfma_f32_16x16x32_bf16 a[100:103], a[228:231], v[220:223], a[100:103]
v_exp_f32 v154, v154
v_mfma_f32_16x16x32_bf16 a[68:71], a[228:231], v[216:219], a[68:71]
ds_read_b128 a[204:207], v2 offset:3072
v_cvt_pk_bf16_f32 v202, v152, v153
v_mfma_f32_16x16x32_bf16 a[36:39], a[228:231], v[212:215], a[36:39]
v_exp_f32 v155, v155
v_mfma_f32_16x16x32_bf16 a[4:7], a[228:231], v[208:211], a[4:7]
v_exp_f32 v140, v140
v_mfma_f32_16x16x32_bf16 a[8:11], a[232:235], v[208:211], a[8:11]
ds_read_b128 a[208:211], v2 offset:4096
v_cvt_pk_bf16_f32 v203, v154, v155
v_mfma_f32_16x16x32_bf16 a[40:43], a[232:235], v[212:215], a[40:43]
v_exp_f32 v141, v141
v_mfma_f32_16x16x32_bf16 a[72:75], a[232:235], v[216:219], a[72:75]
v_exp_f32 v142, v142
v_mfma_f32_16x16x32_bf16 a[104:107], a[232:235], v[220:223], a[104:107]
ds_read_b128 a[212:215], v2 offset:5120
v_cvt_pk_bf16_f32 v204, v140, v141
v_mfma_f32_16x16x32_bf16 a[108:111], a[236:239], v[220:223], a[108:111]
v_exp_f32 v143, v143
v_mfma_f32_16x16x32_bf16 a[76:79], a[236:239], v[216:219], a[76:79]
v_exp_f32 v156, v156
v_mfma_f32_16x16x32_bf16 a[44:47], a[236:239], v[212:215], a[44:47]
ds_read_b128 a[216:219], v2 offset:6144
v_cvt_pk_bf16_f32 v205, v142, v143
v_mfma_f32_16x16x32_bf16 a[12:15], a[236:239], v[208:211], a[12:15]
buffer_load_dwordx4 v1, s[44:47], s72 offen offset:3072 sc1 lds
v_mfma_f32_16x16x32_bf16 a[16:19], a[240:243], v[208:211], a[16:19]
v_exp_f32 v157, v157
v_mfma_f32_16x16x32_bf16 a[48:51], a[240:243], v[212:215], a[48:51]
v_exp_f32 v158, v158
v_mfma_f32_16x16x32_bf16 a[80:83], a[240:243], v[216:219], a[80:83]
ds_read_b128 a[220:223], v2 offset:7168
v_cvt_pk_bf16_f32 v206, v156, v157
v_mfma_f32_16x16x32_bf16 a[112:115], a[240:243], v[220:223], a[112:115]
v_exp_f32 v159, v159
v_mfma_f32_16x16x32_bf16 a[116:119], a[244:247], v[220:223], a[116:119]
v_cvt_pk_bf16_f32 v207, v158, v159
v_add_u32 v15, s75, v3
v_mfma_f32_16x16x32_bf16 a[84:87], a[244:247], v[216:219], a[84:87]
v_mfma_f32_16x16x32_bf16 a[52:55], a[244:247], v[212:215], a[52:55]
v_mfma_f32_16x16x32_bf16 a[20:23], a[244:247], v[208:211], a[20:23]
v_mfma_f32_16x16x32_bf16 a[24:27], a[248:251], v[208:211], a[24:27]
v_mfma_f32_16x16x32_bf16 a[56:59], a[248:251], v[212:215], a[56:59]
v_mfma_f32_16x16x32_bf16 a[88:91], a[248:251], v[216:219], a[88:91]
v_mfma_f32_16x16x32_bf16 a[120:123], a[248:251], v[220:223], a[120:123]
v_mfma_f32_16x16x32_bf16 a[124:127], a[252:255], v[220:223], a[124:127]
v_mfma_f32_16x16x32_bf16 a[92:95], a[252:255], v[216:219], a[92:95]
v_mfma_f32_16x16x32_bf16 a[60:63], a[252:255], v[212:215], a[60:63]
v_mfma_f32_16x16x32_bf16 a[28:31], a[252:255], v[208:211], a[28:31]
v_mfma_f32_16x16x32_bf16 v[224:227], v[120:123], v[208:211], v[224:227]
v_mfma_f32_16x16x32_bf16 v[228:231], v[120:123], v[212:215], v[228:231]
v_mfma_f32_16x16x32_bf16 v[232:235], v[120:123], v[216:219], v[232:235]
v_mfma_f32_16x16x32_bf16 v[236:239], v[120:123], v[220:223], v[236:239]
s_waitcnt lgkmcnt(8)
v_mfma_f32_16x16x32_bf16 v[128:131], a[128:131], v[16:19], v[80:83]
s_add_u32 s82, s82, 0x8000
ds_read_b128 a[160:163], v2 offset:24576
v_mfma_f32_16x16x32_bf16 v[128:131], a[132:135], v[20:23], v[128:131]
s_and_b32 s82, s82, 0x1ffff
v_exp_f32 v160, v160
v_mfma_f32_16x16x32_bf16 v[128:131], a[136:139], v[24:27], v[128:131]
s_add_u32 m0, s74, 0
v_exp_f32 v161, v161
v_mfma_f32_16x16x32_bf16 v[128:131], a[140:143], v[28:31], v[128:131]
s_add_u32 s72, s81, 0
ds_read_b128 a[164:167], v2 offset:25600
v_cvt_pk_bf16_f32 v208, v160, v161
v_mfma_f32_16x16x32_bf16 v[132:135], a[140:143], v[44:47], v[84:87]
v_exp_f32 v162, v162
v_mfma_f32_16x16x32_bf16 v[132:135], a[136:139], v[40:43], v[132:135]
v_exp_f32 v163, v163
v_mfma_f32_16x16x32_bf16 v[132:135], a[132:135], v[36:39], v[132:135]
buffer_load_dwordx4 v1, s[44:47], s72 offen sc1 lds
v_mfma_f32_16x16x32_bf16 v[132:135], a[128:131], v[32:35], v[132:135]
ds_read_b128 a[168:171], v2 offset:26624
v_cvt_pk_bf16_f32 v209, v162, v163
v_mfma_f32_16x16x32_bf16 v[136:139], a[128:131], v[48:51], v[88:91]
v_exp_f32 v176, v176
v_mfma_f32_16x16x32_bf16 v[136:139], a[132:135], v[52:55], v[136:139]
v_exp_f32 v177, v177
v_mfma_f32_16x16x32_bf16 v[136:139], a[136:139], v[56:59], v[136:139]
ds_read_b128 a[172:175], v2 offset:27648
v_cvt_pk_bf16_f32 v210, v176, v177
v_mfma_f32_16x16x32_bf16 v[136:139], a[140:143], v[60:63], v[136:139]
v_exp_f32 v178, v178
v_mfma_f32_16x16x32_bf16 v[140:143], a[140:143], v[76:79], v[92:95]
v_exp_f32 v179, v179
v_mfma_f32_16x16x32_bf16 v[140:143], a[136:139], v[72:75], v[140:143]
ds_read_b128 a[176:179], v2 offset:28672
v_cvt_pk_bf16_f32 v211, v178, v179
v_mfma_f32_16x16x32_bf16 v[140:143], a[132:135], v[68:71], v[140:143]
v_exp_f32 v164, v164
v_mfma_f32_16x16x32_bf16 v[140:143], a[128:131], v[64:67], v[140:143]
v_exp_f32 v165, v165
v_mfma_f32_16x16x32_bf16 v[156:159], a[144:147], v[64:67], v[92:95]
ds_read_b128 a[180:183], v2 offset:29696
v_cvt_pk_bf16_f32 v212, v164, v165
v_mfma_f32_16x16x32_bf16 v[156:159], a[148:151], v[68:71], v[156:159]
buffer_load_dwordx4 v1, s[44:47], s72 offen offset:1024 sc1 lds
v_mfma_f32_16x16x32_bf16 v[156:159], a[152:155], v[72:75], v[156:159]
v_exp_f32 v166, v166
v_mfma_f32_16x16x32_bf16 v[156:159], a[156:159], v[76:79], v[156:159]
v_exp_f32 v167, v167
v_mfma_f32_16x16x32_bf16 v[152:155], a[156:159], v[60:63], v[88:91]
ds_read_b128 a[184:187], v2 offset:30720
v_cvt_pk_bf16_f32 v213, v166, v167
v_mfma_f32_16x16x32_bf16 v[152:155], a[152:155], v[56:59], v[152:155]
v_exp_f32 v180, v180
v_mfma_f32_16x16x32_bf16 v[152:155], a[148:151], v[52:55], v[152:155]
v_exp_f32 v181, v181
v_mfma_f32_16x16x32_bf16 v[152:155], a[144:147], v[48:51], v[152:155]
ds_read_b128 a[188:191], v2 offset:31744
v_cvt_pk_bf16_f32 v214, v180, v181
v_mfma_f32_16x16x32_bf16 v[148:151], a[144:147], v[32:35], v[84:87]
v_exp_f32 v182, v182
v_mfma_f32_16x16x32_bf16 v[148:151], a[148:151], v[36:39], v[148:151]
v_exp_f32 v183, v183
v_mfma_f32_16x16x32_bf16 v[148:151], a[152:155], v[40:43], v[148:151]
ds_read_b128 a[224:227], v2 offset:8192
v_cvt_pk_bf16_f32 v215, v182, v183
v_mfma_f32_16x16x32_bf16 v[148:151], a[156:159], v[44:47], v[148:151]
v_exp_f32 v168, v168
v_mfma_f32_16x16x32_bf16 v[144:147], a[156:159], v[28:31], v[80:83]
buffer_load_dwordx4 v1, s[44:47], s72 offen offset:2048 sc1 lds
v_mfma_f32_16x16x32_bf16 v[144:147], a[152:155], v[24:27], v[144:147]
v_exp_f32 v169, v169
v_mfma_f32_16x16x32_bf16 v[144:147], a[148:151], v[20:23], v[144:147]
ds_read_b128 a[228:231], v2 offset:9216
v_cvt_pk_bf16_f32 v216, v168, v169
v_mfma_f32_16x16x32_bf16 v[144:147], a[144:147], v[16:19], v[144:147]
s_waitcnt lgkmcnt(10)
v_exp_f32 v170, v170
v_mfma_f32_16x16x32_bf16 a[0:3], a[192:195], v[192:195], a[0:3]
v_exp_f32 v171, v171
v_mfma_f32_16x16x32_bf16 a[32:35], a[192:195], v[196:199], a[32:35]
ds_read_b128 a[232:235], v2 offset:10240
v_cvt_pk_bf16_f32 v217, v170, v171
v_mfma_f32_16x16x32_bf16 a[64:67], a[192:195], v[200:203], a[64:67]
v_exp_f32 v184, v184
v_mfma_f32_16x16x32_bf16 a[96:99], a[192:195], v[204:207], a[96:99]
v_exp_f32 v185, v185
v_mfma_f32_16x16x32_bf16 a[100:103], a[196:199], v[204:207], a[100:103]
ds_read_b128 a[236:239], v2 offset:11264
v_cvt_pk_bf16_f32 v218, v184, v185
v_mfma_f32_16x16x32_bf16 a[68:71], a[196:199], v[200:203], a[68:71]
v_exp_f32 v186, v186
v_mfma_f32_16x16x32_bf16 a[36:39], a[196:199], v[196:199], a[36:39]
buffer_load_dwordx4 v1, s[44:47], s72 offen offset:3072 sc1 lds
v_mfma_f32_16x16x32_bf16 a[4:7], a[196:199], v[192:195], a[4:7]
s_add_u32 s75, s75, 0x1000
v_exp_f32 v187, v187
v_mfma_f32_16x16x32_bf16 a[8:11], a[200:203], v[192:195], a[8:11]
s_and_b32 s76, s75, 0x3000
ds_read_b128 a[240:243], v2 offset:12288
v_cvt_pk_bf16_f32 v219, v186, v187
v_mfma_f32_16x16x32_bf16 a[40:43], a[200:203], v[196:199], a[40:43]
s_cselect_b32 s75, s75, 0x40001000
v_exp_f32 v172, v172
v_mfma_f32_16x16x32_bf16 a[72:75], a[200:203], v[200:203], a[72:75]
v_exp_f32 v173, v173
v_mfma_f32_16x16x32_bf16 a[104:107], a[200:203], v[204:207], a[104:107]
ds_read_b128 a[244:247], v2 offset:13312
v_cvt_pk_bf16_f32 v220, v172, v173
v_mfma_f32_16x16x32_bf16 a[108:111], a[204:207], v[204:207], a[108:111]
v_exp_f32 v174, v174
v_mfma_f32_16x16x32_bf16 a[76:79], a[204:207], v[200:203], a[76:79]
v_exp_f32 v175, v175
v_mfma_f32_16x16x32_bf16 a[44:47], a[204:207], v[196:199], a[44:47]
ds_read_b128 a[248:251], v2 offset:14336
v_cvt_pk_bf16_f32 v221, v174, v175
v_mfma_f32_16x16x32_bf16 a[12:15], a[204:207], v[192:195], a[12:15]
v_exp_f32 v188, v188
v_mfma_f32_16x16x32_bf16 a[16:19], a[208:211], v[192:195], a[16:19]
buffer_load_dword v4, v15, s[24:27], 0 offen
v_mfma_f32_16x16x32_bf16 a[48:51], a[208:211], v[196:199], a[48:51]
v_exp_f32 v189, v189
v_mfma_f32_16x16x32_bf16 a[80:83], a[208:211], v[200:203], a[80:83]
ds_read_b128 a[252:255], v2 offset:15360
v_cvt_pk_bf16_f32 v222, v188, v189
v_mfma_f32_16x16x32_bf16 a[112:115], a[208:211], v[204:207], a[112:115]
v_exp_f32 v190, v190
v_mfma_f32_16x16x32_bf16 a[116:119], a[212:215], v[204:207], a[116:119]
v_exp_f32 v191, v191
v_mfma_f32_16x16x32_bf16 a[84:87], a[212:215], v[200:203], a[84:87]
v_cvt_pk_bf16_f32 v223, v190, v191
v_add_u32 v2, s82, v1
v_mfma_f32_16x16x32_bf16 a[52:55], a[212:215], v[196:199], a[52:55]
v_mfma_f32_16x16x32_bf16 a[20:23], a[212:215], v[192:195], a[20:23]
v_mfma_f32_16x16x32_bf16 a[24:27], a[216:219], v[192:195], a[24:27]
v_mfma_f32_16x16x32_bf16 a[56:59], a[216:219], v[196:199], a[56:59]
v_mfma_f32_16x16x32_bf16 a[88:91], a[216:219], v[200:203], a[88:91]
v_mfma_f32_16x16x32_bf16 a[120:123], a[216:219], v[204:207], a[120:123]
v_mfma_f32_16x16x32_bf16 a[124:127], a[220:223], v[204:207], a[124:127]
v_mfma_f32_16x16x32_bf16 a[92:95], a[220:223], v[200:203], a[92:95]
v_mfma_f32_16x16x32_bf16 a[60:63], a[220:223], v[196:199], a[60:63]
v_mfma_f32_16x16x32_bf16 a[28:31], a[220:223], v[192:195], a[28:31]
v_mfma_f32_16x16x32_bf16 v[224:227], v[120:123], v[192:195], v[224:227]
s_waitcnt vmcnt(9) lgkmcnt(8)
v_mfma_f32_16x16x32_bf16 v[228:231], v[120:123], v[196:199], v[228:231]
s_barrier
v_mfma_f32_16x16x32_bf16 v[232:235], v[120:123], v[200:203], v[232:235]
s_add_u32 s83, s83, 1
v_mfma_f32_16x16x32_bf16 v[236:239], v[120:123], v[204:207], v[236:239]
s_cbranch_scc0 LloopI
LLT1:
Lstub1:
s_cbranch_execz Lstub5
v_mfma_f32_16x16x32_bf16 v[160:163], a[160:163], v[16:19], v[80:83]
s_xor_b32 s74, s82, 0x10000
v_exp_f32 v128, v128
v_mfma_f32_16x16x32_bf16 v[160:163], a[164:167], v[20:23], v[160:163]
s_add_u32 s74, s74, s64
ds_read_b128 a[128:131], v2 offset:16384
v_mfma_f32_16x16x32_bf16 v[160:163], a[168:171], v[24:27], v[160:163]
s_add_u32 s81, s81, 0x8000
v_exp_f32 v129, v129
v_mfma_f32_16x16x32_bf16 v[160:163], a[172:175], v[28:31], v[160:163]
s_add_u32 m0, s74, 16384
v_exp_f32 v130, v130
v_mfma_f32_16x16x32_bf16 v[164:167], a[172:175], v[44:47], v[84:87]
s_add_u32 s72, s81, 16384
ds_read_b128 a[132:135], v2 offset:17408
v_cvt_pk_bf16_f32 v192, v128, v129
v_mfma_f32_16x16x32_bf16 v[164:167], a[168:171], v[40:43], v[164:167]
v_exp_f32 v131, v131
v_mfma_f32_16x16x32_bf16 v[164:167], a[164:167], v[36:39], v[164:167]
v_exp_f32 v144, v144
v_mfma_f32_16x16x32_bf16 v[164:167], a[160:163], v[32:35], v[164:167]
ds_read_b128 a[136:139], v2 offset:18432
v_cvt_pk_bf16_f32 v193, v130, v131
v_mfma_f32_16x16x32_bf16 v[168:171], a[160:163], v[48:51], v[88:91]
buffer_load_dwordx4 v1, s[44:47], s72 offen sc1 lds
v_mfma_f32_16x16x32_bf16 v[168:171], a[164:167], v[52:55], v[168:171]
v_exp_f32 v145, v145
v_mfma_f32_16x16x32_bf16 v[168:171], a[168:171], v[56:59], v[168:171]
v_exp_f32 v146, v146
v_mfma_f32_16x16x32_bf16 v[168:171], a[172:175], v[60:63], v[168:171]
ds_read_b128 a[140:143], v2 offset:19456
v_cvt_pk_bf16_f32 v194, v144, v145
v_mfma_f32_16x16x32_bf16 v[172:175], a[172:175], v[76:79], v[92:95]
v_exp_f32 v147, v147
v_mfma_f32_16x16x32_bf16 v[172:175], a[168:171], v[72:75], v[172:175]
v_exp_f32 v132, v132
v_mfma_f32_16x16x32_bf16 v[172:175], a[164:167], v[68:71], v[172:175]
ds_read_b128 a[144:147], v2 offset:20480
v_cvt_pk_bf16_f32 v195, v146, v147
v_mfma_f32_16x16x32_bf16 v[172:175], a[160:163], v[64:67], v[172:175]
v_exp_f32 v133, v133
v_mfma_f32_16x16x32_bf16 v[188:191], a[176:179], v[64:67], v[92:95]
v_exp_f32 v134, v134
v_mfma_f32_16x16x32_bf16 v[188:191], a[180:183], v[68:71], v[188:191]
ds_read_b128 a[148:151], v2 offset:21504
v_cvt_pk_bf16_f32 v196, v132, v133
v_mfma_f32_16x16x32_bf16 v[188:191], a[184:187], v[72:75], v[188:191]
v_exp_f32 v135, v135
v_mfma_f32_16x16x32_bf16 v[188:191], a[188:191], v[76:79], v[188:191]
v_exp_f32 v148, v148
v_mfma_f32_16x16x32_bf16 v[184:187], a[188:191], v[60:63], v[88:91]
ds_read_b128 a[152:155], v2 offset:22528
v_cvt_pk_bf16_f32 v197, v134, v135
v_mfma_f32_16x16x32_bf16 v[184:187], a[184:187], v[56:59], v[184:187]
buffer_load_dwordx4 v1, s[44:47], s72 offen offset:1024 sc1 lds
v_mfma_f32_16x16x32_bf16 v[184:187], a[180:183], v[52:55], v[184:187]
v_exp_f32 v149, v149
v_mfma_f32_16x16x32_bf16 v[184:187], a[176:179], v[48:51], v[184:187]
v_exp_f32 v150, v150
v_mfma_f32_16x16x32_bf16 v[180:183], a[176:179], v[32:35], v[84:87]
ds_read_b128 a[156:159], v2 offset:23552
v_cvt_pk_bf16_f32 v198, v148, v149
v_mfma_f32_16x16x32_bf16 v[180:183], a[180:183], v[36:39], v[180:183]
v_exp_f32 v151, v151
v_mfma_f32_16x16x32_bf16 v[180:183], a[184:187], v[40:43], v[180:183]
v_exp_f32 v136, v136
v_mfma_f32_16x16x32_bf16 v[180:183], a[188:191], v[44:47], v[180:183]
ds_read_b128 a[192:195], v2 offset:0
v_cvt_pk_bf16_f32 v199, v150, v151
v_mfma_f32_16x16x32_bf16 v[176:179], a[188:191], v[28:31], v[80:83]
v_exp_f32 v137, v137
v_mfma_f32_16x16x32_bf16 v[176:179], a[184:187], v[24:27], v[176:179]
v_exp_f32 v138, v138
v_mfma_f32_16x16x32_bf16 v[176:179], a[180:183], v[20:23], v[176:179]
ds_read_b128 a[196:199], v2 offset:1024
v_cvt_pk_bf16_f32 v200, v136, v137
v_mfma_f32_16x16x32_bf16 v[176:179], a[176:179], v[16:19], v[176:179]
s_waitcnt lgkmcnt(10)
v_exp_f32 v139, v139
v_mfma_f32_16x16x32_bf16 a[0:3], a[224:227], v[208:211], a[0:3]
v_exp_f32 v152, v152
v_mfma_f32_16x16x32_bf16 a[32:35], a[224:227], v[212:215], a[32:35]
ds_read_b128 a[200:203], v2 offset:2048
v_cvt_pk_bf16_f32 v201, v138, v139
v_mfma_f32_16x16x32_bf16 a[64:67], a[224:227], v[216:219], a[64:67]
buffer_load_dwordx4 v1, s[44:47], s72 offen offset:2048 sc1 lds
v_mfma_f32_16x16x32_bf16 a[96:99], a[224:227], v[220:223], a[96:99]
Lstub2:
s_cbranch_execz Lstub6
v_exp_f32 v153, v153
v_mfma_f32_16x16x32_bf16 a[100:103], a[228:231], v[220:223], a[100:103]
v_exp_f32 v154, v154
v_mfma_f32_16x16x32_bf16 a[68:71], a[228:231], v[216:219], a[68:71]
ds_read_b128 a[204:207], v2 offset:3072
v_cvt_pk_bf16_f32 v202, v152, v153
v_mfma_f32_16x16x32_bf16 a[36:39], a[228:231], v[212:215], a[36:39]
v_exp_f32 v155, v155
v_mfma_f32_16x16x32_bf16 a[4:7], a[228:231], v[208:211], a[4:7]
v_exp_f32 v140, v140
v_mfma_f32_16x16x32_bf16 a[8:11], a[232:235], v[208:211], a[8:11]
ds_read_b128 a[208:211], v2 offset:4096
v_cvt_pk_bf16_f32 v203, v154, v155
v_mfma_f32_16x16x32_bf16 a[40:43], a[232:235], v[212:215], a[40:43]
v_exp_f32 v141, v141
v_mfma_f32_16x16x32_bf16 a[72:75], a[232:235], v[216:219], a[72:75]
v_exp_f32 v142, v142
v_mfma_f32_16x16x32_bf16 a[104:107], a[232:235], v[220:223], a[104:107]
ds_read_b128 a[212:215], v2 offset:5120
v_cvt_pk_bf16_f32 v204, v140, v141
v_mfma_f32_16x16x32_bf16 a[108:111], a[236:239], v[220:223], a[108:111]
v_exp_f32 v143, v143
v_mfma_f32_16x16x32_bf16 a[76:79], a[236:239], v[216:219], a[76:79]
v_exp_f32 v156, v156
v_mfma_f32_16x16x32_bf16 a[44:47], a[236:239], v[212:215], a[44:47]
ds_read_b128 a[216:219], v2 offset:6144
v_cvt_pk_bf16_f32 v205, v142, v143
v_mfma_f32_16x16x32_bf16 a[12:15], a[236:239], v[208:211], a[12:15]
buffer_load_dwordx4 v1, s[44:47], s72 offen offset:3072 sc1 lds
v_mfma_f32_16x16x32_bf16 a[16:19], a[240:243], v[208:211], a[16:19]
v_exp_f32 v157, v157
v_mfma_f32_16x16x32_bf16 a[48:51], a[240:243], v[212:215], a[48:51]
v_exp_f32 v158, v158
v_mfma_f32_16x16x32_bf16 a[80:83], a[240:243], v[216:219], a[80:83]
ds_read_b128 a[220:223], v2 offset:7168
v_cvt_pk_bf16_f32 v206, v156, v157
v_mfma_f32_16x16x32_bf16 a[112:115], a[240:243], v[220:223], a[112:115]
v_exp_f32 v159, v159
v_mfma_f32_16x16x32_bf16 a[116:119], a[244:247], v[220:223], a[116:119]
v_cvt_pk_bf16_f32 v207, v158, v159
v_mfma_f32_16x16x32_bf16 a[84:87], a[244:247], v[216:219], a[84:87]
v_mfma_f32_16x16x32_bf16 a[52:55], a[244:247], v[212:215], a[52:55]
v_mfma_f32_16x16x32_bf16 a[20:23], a[244:247], v[208:211], a[20:23]
v_mfma_f32_16x16x32_bf16 a[24:27], a[248:251], v[208:211], a[24:27]
v_mfma_f32_16x16x32_bf16 a[56:59], a[248:251], v[212:215], a[56:59]
v_mfma_f32_16x16x32_bf16 a[88:91], a[248:251], v[216:219], a[88:91]
v_mfma_f32_16x16x32_bf16 a[120:123], a[248:251], v[220:223], a[120:123]
v_mfma_f32_16x16x32_bf16 a[124:127], a[252:255], v[220:223], a[124:127]
v_mfma_f32_16x16x32_bf16 a[92:95], a[252:255], v[216:219], a[92:95]
v_mfma_f32_16x16x32_bf16 a[60:63], a[252:255], v[212:215], a[60:63]
v_mfma_f32_16x16x32_bf16 a[28:31], a[252:255], v[208:211], a[28:31]
v_mfma_f32_16x16x32_bf16 v[224:227], v[120:123], v[208:211], v[224:227]
v_mfma_f32_16x16x32_bf16 v[228:231], v[120:123], v[212:215], v[228:231]
v_mfma_f32_16x16x32_bf16 v[232:235], v[120:123], v[216:219], v[232:235]
v_mfma_f32_16x16x32_bf16 v[236:239], v[120:123], v[220:223], v[236:239]
s_waitcnt lgkmcnt(8)
s_cmp_eq_u32 s58, 0
s_cbranch_scc1 Lta16
s_cmp_eq_u32 s58, 1
s_cbranch_scc1 Lnt17
v_mfma_f32_16x16x32_bf16 v[128:131], a[128:131], v[16:19], v[80:83]
s_add_u32 s82, s82, 0x8000
ds_read_b128 a[160:163], v2 offset:24576
v_mfma_f32_16x16x32_bf16 v[144:147], a[144:147], v[16:19], v[80:83]
s_and_b32 s82, s82, 0x1ffff
v_exp_f32 v160, v160
s_branch Ljoin18
Lta16:
v_mfma_f32_16x16x32_bf16 v[128:131], a[128:131], v[16:19], v[96:99]
s_add_u32 s82, s82, 0x8000
ds_read_b128 a[160:163], v2 offset:24576
v_mfma_f32_16x16x32_bf16 v[144:147], a[144:147], v[16:19], v[112:115]
s_and_b32 s82, s82, 0x1ffff
v_exp_f32 v160, v160
s_branch Ljoin18
Lnt17:
v_mfma_f32_16x16x32_bf16 v[128:131], a[128:131], v[16:19], v[80:83]
s_add_u32 s82, s82, 0x8000
ds_read_b128 a[160:163], v2 offset:24576
v_mfma_f32_16x16x32_bf16 v[144:147], a[144:147], v[16:19], v[96:99]
s_and_b32 s82, s82, 0x1ffff
v_exp_f32 v160, v160
Ljoin18:
v_mfma_f32_16x16x32_bf16 v[128:131], a[132:135], v[20:23], v[128:131]
s_add_u32 m0, s74, 0
v_exp_f32 v161, v161
v_mfma_f32_16x16x32_bf16 v[128:131], a[136:139], v[24:27], v[128:131]
s_add_u32 s72, s81, 0
ds_read_b128 a[164:167], v2 offset:25600
v_cvt_pk_bf16_f32 v208, v160, v161
v_mfma_f32_16x16x32_bf16 v[128:131], a[140:143], v[28:31], v[128:131]
v_exp_f32 v162, v162
v_mfma_f32_16x16x32_bf16 v[132:135], a[140:143], v[44:47], v[84:87]
v_exp_f32 v163, v163
v_mfma_f32_16x16x32_bf16 v[132:135], a[136:139], v[40:43], v[132:135]
ds_read_b128 a[168:171], v2 offset:26624
v_cvt_pk_bf16_f32 v209, v162, v163
v_mfma_f32_16x16x32_bf16 v[132:135], a[132:135], v[36:39], v[132:135]
v_exp_f32 v176, v176
v_mfma_f32_16x16x32_bf16 v[132:135], a[128:131], v[32:35], v[132:135]
buffer_load_dwordx4 v1, s[44:47], s72 offen sc1 lds
v_mfma_f32_16x16x32_bf16 v[136:139], a[128:131], v[48:51], v[88:91]
v_exp_f32 v177, v177
v_mfma_f32_16x16x32_bf16 v[136:139], a[132:135], v[52:55], v[136:139]
ds_read_b128 a[172:175], v2 offset:27648
v_cvt_pk_bf16_f32 v210, v176, v177
v_mfma_f32_16x16x32_bf16 v[136:139], a[136:139], v[56:59], v[136:139]
v_exp_f32 v178, v178
v_mfma_f32_16x16x32_bf16 v[136:139], a[140:143], v[60:63], v[136:139]
v_exp_f32 v179, v179
v_mfma_f32_16x16x32_bf16 v[140:143], a[140:143], v[76:79], v[92:95]
ds_read_b128 a[176:179], v2 offset:28672
v_cvt_pk_bf16_f32 v211, v178, v179
v_mfma_f32_16x16x32_bf16 v[140:143], a[136:139], v[72:75], v[140:143]
v_exp_f32 v164, v164
v_mfma_f32_16x16x32_bf16 v[140:143], a[132:135], v[68:71], v[140:143]
v_exp_f32 v165, v165
v_mfma_f32_16x16x32_bf16 v[140:143], a[128:131], v[64:67], v[140:143]
ds_read_b128 a[180:183], v2 offset:29696
v_cvt_pk_bf16_f32 v212, v164, v165
v_mfma_f32_16x16x32_bf16 v[156:159], a[144:147], v[64:67], v[92:95]
v_exp_f32 v166, v166
v_mfma_f32_16x16x32_bf16 v[156:159], a[148:151], v[68:71], v[156:159]
v_exp_f32 v167, v167
v_mfma_f32_16x16x32_bf16 v[156:159], a[152:155], v[72:75], v[156:159]
ds_read_b128 a[184:187], v2 offset:30720
v_cvt_pk_bf16_f32 v213, v166, v167
v_mfma_f32_16x16x32_bf16 v[156:159], a[156:159], v[76:79], v[156:159]
v_exp_f32 v180, v180
v_mfma_f32_16x16x32_bf16 v[152:155], a[156:159], v[60:63], v[88:91]
buffer_load_dwordx4 v1, s[44:47], s72 offen offset:1024 sc1 lds
v_mfma_f32_16x16x32_bf16 v[152:155], a[152:155], v[56:59], v[152:155]
v_exp_f32 v181, v181
v_mfma_f32_16x16x32_bf16 v[152:155], a[148:151], v[52:55], v[152:155]
ds_read_b128 a[188:191], v2 offset:31744
v_cvt_pk_bf16_f32 v214, v180, v181
v_mfma_f32_16x16x32_bf16 v[152:155], a[144:147], v[48:51], v[152:155]
v_exp_f32 v182, v182
v_mfma_f32_16x16x32_bf16 v[148:151], a[144:147], v[32:35], v[84:87]
v_exp_f32 v183, v183
v_mfma_f32_16x16x32_bf16 v[148:151], a[148:151], v[36:39], v[148:151]
ds_read_b128 a[224:227], v2 offset:8192
v_cvt_pk_bf16_f32 v215, v182, v183
v_mfma_f32_16x16x32_bf16 v[148:151], a[152:155], v[40:43], v[148:151]
v_exp_f32 v168, v168
v_mfma_f32_16x16x32_bf16 v[148:151], a[156:159], v[44:47], v[148:151]
v_exp_f32 v169, v169
v_mfma_f32_16x16x32_bf16 v[144:147], a[156:159], v[28:31], v[144:147]
ds_read_b128 a[228:231], v2 offset:9216
v_cvt_pk_bf16_f32 v216, v168, v169
v_mfma_f32_16x16x32_bf16 v[144:147], a[152:155], v[24:27], v[144:147]
v_exp_f32 v170, v170
v_mfma_f32_16x16x32_bf16 v[144:147], a[148:151], v[20:23], v[144:147]
s_waitcnt lgkmcnt(10)
v_exp_f32 v171, v171
v_mfma_f32_16x16x32_bf16 a[0:3], a[192:195], v[192:195], a[0:3]
ds_read_b128 a[232:235], v2 offset:10240
v_cvt_pk_bf16_f32 v217, v170, v171
v_mfma_f32_16x16x32_bf16 a[32:35], a[192:195], v[196:199], a[32:35]
v_exp_f32 v184, v184
v_mfma_f32_16x16x32_bf16 a[64:67], a[192:195], v[200:203], a[64:67]
buffer_load_dwordx4 v1, s[44:47], s72 offen offset:2048 sc1 lds
v_mfma_f32_16x16x32_bf16 a[96:99], a[192:195], v[204:207], a[96:99]
v_exp_f32 v185, v185
v_mfma_f32_16x16x32_bf16 a[100:103], a[196:199], v[204:207], a[100:103]
ds_read_b128 a[236:239], v2 offset:11264
v_cvt_pk_bf16_f32 v218, v184, v185
v_mfma_f32_16x16x32_bf16 a[68:71], a[196:199], v[200:203], a[68:71]
v_exp_f32 v186, v186
v_mfma_f32_16x16x32_bf16 a[36:39], a[196:199], v[196:199], a[36:39]
v_exp_f32 v187, v187
v_mfma_f32_16x16x32_bf16 a[4:7], a[196:199], v[192:195], a[4:7]
ds_read_b128 a[240:243], v2 offset:12288
v_cvt_pk_bf16_f32 v219, v186, v187
v_mfma_f32_16x16x32_bf16 a[8:11], a[200:203], v[192:195], a[8:11]
v_exp_f32 v172, v172
v_mfma_f32_16x16x32_bf16 a[40:43], a[200:203], v[196:199], a[40:43]
v_exp_f32 v173, v173
v_mfma_f32_16x16x32_bf16 a[72:75], a[200:203], v[200:203], a[72:75]
ds_read_b128 a[244:247], v2 offset:13312
v_cvt_pk_bf16_f32 v220, v172, v173
v_mfma_f32_16x16x32_bf16 a[104:107], a[200:203], v[204:207], a[104:107]
v_exp_f32 v174, v174
v_mfma_f32_16x16x32_bf16 a[108:111], a[204:207], v[204:207], a[108:111]
v_exp_f32 v175, v175
v_mfma_f32_16x16x32_bf16 a[76:79], a[204:207], v[200:203], a[76:79]
ds_read_b128 a[248:251], v2 offset:14336
v_cvt_pk_bf16_f32 v221, v174, v175
v_mfma_f32_16x16x32_bf16 a[44:47], a[204:207], v[196:199], a[44:47]
v_exp_f32 v188, v188
v_mfma_f32_16x16x32_bf16 a[12:15], a[204:207], v[192:195], a[12:15]
buffer_load_dwordx4 v1, s[44:47], s72 offen offset:3072 sc1 lds
v_mfma_f32_16x16x32_bf16 a[16:19], a[208:211], v[192:195], a[16:19]
v_exp_f32 v189, v189
v_mfma_f32_16x16x32_bf16 a[48:51], a[208:211], v[196:199], a[48:51]
ds_read_b128 a[252:255], v2 offset:15360
v_cvt_pk_bf16_f32 v222, v188, v189
v_mfma_f32_16x16x32_bf16 a[80:83], a[208:211], v[200:203], a[80:83]
v_exp_f32 v190, v190
v_mfma_f32_16x16x32_bf16 a[112:115], a[208:211], v[204:207], a[112:115]
v_exp_f32 v191, v191
v_mfma_f32_16x16x32_bf16 a[116:119], a[212:215], v[204:207], a[116:119]
v_cvt_pk_bf16_f32 v223, v190, v191
v_add_u32 v2, s82, v1
v_mfma_f32_16x16x32_bf16 a[84:87], a[212:215], v[200:203], a[84:87]
v_mfma_f32_16x16x32_bf16 a[52:55], a[212:215], v[196:199], a[52:55]
v_mfma_f32_16x16x32_bf16 a[20:23], a[212:215], v[192:195], a[20:23]
v_mfma_f32_16x16x32_bf16 a[24:27], a[216:219], v[192:195], a[24:27]
v_mfma_f32_16x16x32_bf16 a[56:59], a[216:219], v[196:199], a[56:59]
v_mfma_f32_16x16x32_bf16 a[88:91], a[216:219], v[200:203], a[88:91]
v_mfma_f32_16x16x32_bf16 a[120:123], a[216:219], v[204:207], a[120:123]
v_mfma_f32_16x16x32_bf16 a[124:127], a[220:223], v[204:207], a[124:127]
v_mfma_f32_16x16x32_bf16 a[92:95], a[220:223], v[200:203], a[92:95]
v_mfma_f32_16x16x32_bf16 a[60:63], a[220:223], v[196:199], a[60:63]
v_mfma_f32_16x16x32_bf16 a[28:31], a[220:223], v[192:195], a[28:31]
v_mfma_f32_16x16x32_bf16 v[224:227], v[120:123], v[192:195], v[224:227]
v_mfma_f32_16x16x32_bf16 v[228:231], v[120:123], v[196:199], v[228:231]
v_mfma_f32_16x16x32_bf16 v[232:235], v[120:123], v[200:203], v[232:235]
s_waitcnt vmcnt(8) lgkmcnt(8)
v_mfma_f32_16x16x32_bf16 v[236:239], v[120:123], v[204:207], v[236:239]
s_barrier
s_cmp_eq_u32 s58, 2
s_cbranch_scc1 Lta19
s_cmp_eq_u32 s58, 3
s_cbranch_scc1 Lnt20
v_mfma_f32_16x16x32_bf16 v[160:163], a[160:163], v[16:19], v[112:115]
s_xor_b32 s74, s82, 0x10000
v_exp_f32 v128, v128
v_mfma_f32_16x16x32_bf16 v[176:179], a[176:179], v[16:19], v[112:115]
s_add_u32 s74, s74, s64
ds_read_b128 a[128:131], v2 offset:16384
s_branch Ljoin21
Lta19:
v_mfma_f32_16x16x32_bf16 v[160:163], a[160:163], v[16:19], v[96:99]
s_xor_b32 s74, s82, 0x10000
v_exp_f32 v128, v128
v_mfma_f32_16x16x32_bf16 v[176:179], a[176:179], v[16:19], v[112:115]
s_add_u32 s74, s74, s64
ds_read_b128 a[128:131], v2 offset:16384
s_branch Ljoin21
Lnt20:
v_mfma_f32_16x16x32_bf16 v[160:163], a[160:163], v[16:19], v[80:83]
s_xor_b32 s74, s82, 0x10000
v_exp_f32 v128, v128
v_mfma_f32_16x16x32_bf16 v[176:179], a[176:179], v[16:19], v[96:99]
s_add_u32 s74, s74, s64
ds_read_b128 a[128:131], v2 offset:16384
Ljoin21:
v_mfma_f32_16x16x32_bf16 v[160:163], a[164:167], v[20:23], v[160:163]
s_add_u32 s81, s81, 0x8000
v_exp_f32 v129, v129
v_mfma_f32_16x16x32_bf16 v[160:163], a[168:171], v[24:27], v[160:163]
s_add_u32 m0, s74, 16384
v_exp_f32 v130, v130
v_mfma_f32_16x16x32_bf16 v[160:163], a[172:175], v[28:31], v[160:163]
s_add_u32 s72, s81, 16384
ds_read_b128 a[132:135], v2 offset:17408
v_cvt_pk_bf16_f32 v192, v128, v129
v_mfma_f32_16x16x32_bf16 v[164:167], a[172:175], v[44:47], v[84:87]
v_exp_f32 v131, v131
v_mfma_f32_16x16x32_bf16 v[164:167], a[168:171], v[40:43], v[164:167]
v_exp_f32 v144, v144
v_mfma_f32_16x16x32_bf16 v[164:167], a[164:167], v[36:39], v[164:167]
ds_read_b128 a[136:139], v2 offset:18432
v_cvt_pk_bf16_f32 v193, v130, v131
v_mfma_f32_16x16x32_bf16 v[164:167], a[160:163], v[32:35], v[164:167]
buffer_load_dwordx4 v1, s[44:47], s72 offen sc1 lds
v_mfma_f32_16x16x32_bf16 v[168:171], a[160:163], v[48:51], v[88:91]
v_exp_f32 v145, v145
v_mfma_f32_16x16x32_bf16 v[168:171], a[164:167], v[52:55], v[168:171]
v_exp_f32 v146, v146
v_mfma_f32_16x16x32_bf16 v[168:171], a[168:171], v[56:59], v[168:171]
ds_read_b128 a[140:143], v2 offset:19456
v_cvt_pk_bf16_f32 v194, v144, v145
v_mfma_f32_16x16x32_bf16 v[168:171], a[172:175], v[60:63], v[168:171]
v_exp_f32 v147, v147
v_mfma_f32_16x16x32_bf16 v[172:175], a[172:175], v[76:79], v[92:95]
v_exp_f32 v132, v132
v_mfma_f32_16x16x32_bf16 v[172:175], a[168:171], v[72:75], v[172:175]
ds_read_b128 a[144:147], v2 offset:20480
v_cvt_pk_bf16_f32 v195, v146, v147
v_mfma_f32_16x16x32_bf16 v[172:175], a[164:167], v[68:71], v[172:175]
v_exp_f32 v133, v133
v_mfma_f32_16x16x32_bf16 v[172:175], a[160:163], v[64:67], v[172:175]
v_exp_f32 v134, v134
v_mfma_f32_16x16x32_bf16 v[188:191], a[176:179], v[64:67], v[92:95]
ds_read_b128 a[148:151], v2 offset:21504
v_cvt_pk_bf16_f32 v196, v132, v133
v_mfma_f32_16x16x32_bf16 v[188:191], a[180:183], v[68:71], v[188:191]
v_exp_f32 v135, v135
v_mfma_f32_16x16x32_bf16 v[188:191], a[184:187], v[72:75], v[188:191]
v_exp_f32 v148, v148
v_mfma_f32_16x16x32_bf16 v[188:191], a[188:191], v[76:79], v[188:191]
ds_read_b128 a[152:155], v2 offset:22528
v_cvt_pk_bf16_f32 v197, v134, v135
v_mfma_f32_16x16x32_bf16 v[184:187], a[188:191], v[60:63], v[88:91]
buffer_load_dwordx4 v1, s[44:47], s72 offen offset:1024 sc1 lds
v_mfma_f32_16x16x32_bf16 v[184:187], a[184:187], v[56:59], v[184:187]
v_exp_f32 v149, v149
v_mfma_f32_16x16x32_bf16 v[184:187], a[180:183], v[52:55], v[184:187]
v_exp_f32 v150, v150
v_mfma_f32_16x16x32_bf16 v[184:187], a[176:179], v[48:51], v[184:187]
ds_read_b128 a[156:159], v2 offset:23552
v_cvt_pk_bf16_f32 v198, v148, v149
v_mfma_f32_16x16x32_bf16 v[180:183], a[176:179], v[32:35], v[84:87]
v_exp_f32 v151, v151
v_mfma_f32_16x16x32_bf16 v[180:183], a[180:183], v[36:39], v[180:183]
v_exp_f32 v136, v136
v_mfma_f32_16x16x32_bf16 v[180:183], a[184:187], v[40:43], v[180:183]
ds_read_b128 a[192:195], v2 offset:0
v_cvt_pk_bf16_f32 v199, v150, v151
v_mfma_f32_16x16x32_bf16 v[180:183], a[188:191], v[44:47], v[180:183]
v_exp_f32 v137, v137
v_mfma_f32_16x16x32_bf16 v[176:179], a[188:191], v[28:31], v[176:179]
v_exp_f32 v138, v138
v_mfma_f32_16x16x32_bf16 v[176:179], a[184:187], v[24:27], v[176:179]
ds_read_b128 a[196:199], v2 offset:1024
v_cvt_pk_bf16_f32 v200, v136, v137
v_mfma_f32_16x16x32_bf16 v[176:179], a[180:183], v[20:23], v[176:179]
s_waitcnt lgkmcnt(10)
v_exp_f32 v139, v139
v_mfma_f32_16x16x32_bf16 a[0:3], a[224:227], v[208:211], a[0:3]
v_exp_f32 v152, v152
v_mfma_f32_16x16x32_bf16 a[32:35], a[224:227], v[212:215], a[32:35]
ds_read_b128 a[200:203], v2 offset:2048
v_cvt_pk_bf16_f32 v201, v138, v139
v_mfma_f32_16x16x32_bf16 a[64:67], a[224:227], v[216:219], a[64:67]
buffer_load_dwordx4 v1, s[44:47], s72 offen offset:2048 sc1 lds
v_mfma_f32_16x16x32_bf16 a[96:99], a[224:227], v[220:223], a[96:99]
v_exp_f32 v153, v153
v_mfma_f32_16x16x32_bf16 a[100:103], a[228:231], v[220:223], a[100:103]
v_exp_f32 v154, v154
v_mfma_f32_16x16x32_bf16 a[68:71], a[228:231], v[216:219], a[68:71]
ds_read_b128 a[204:207], v2 offset:3072
v_cvt_pk_bf16_f32 v202, v152, v153
v_mfma_f32_16x16x32_bf16 a[36:39], a[228:231], v[212:215], a[36:39]
v_exp_f32 v155, v155
v_mfma_f32_16x16x32_bf16 a[4:7], a[228:231], v[208:211], a[4:7]
v_exp_f32 v140, v140
v_mfma_f32_16x16x32_bf16 a[8:11], a[232:235], v[208:211], a[8:11]
ds_read_b128 a[208:211], v2 offset:4096
v_cvt_pk_bf16_f32 v203, v154, v155
v_mfma_f32_16x16x32_bf16 a[40:43], a[232:235], v[212:215], a[40:43]
v_exp_f32 v141, v141
v_mfma_f32_16x16x32_bf16 a[72:75], a[232:235], v[216:219], a[72:75]
v_exp_f32 v142, v142
v_mfma_f32_16x16x32_bf16 a[104:107], a[232:235], v[220:223], a[104:107]
ds_read_b128 a[212:215], v2 offset:5120
v_cvt_pk_bf16_f32 v204, v140, v141
v_mfma_f32_16x16x32_bf16 a[108:111], a[236:239], v[220:223], a[108:111]
v_exp_f32 v143, v143
v_mfma_f32_16x16x32_bf16 a[76:79], a[236:239], v[216:219], a[76:79]
v_exp_f32 v156, v156
v_mfma_f32_16x16x32_bf16 a[44:47], a[236:239], v[212:215], a[44:47]
ds_read_b128 a[216:219], v2 offset:6144
v_cvt_pk_bf16_f32 v205, v142, v143
v_mfma_f32_16x16x32_bf16 a[12:15], a[236:239], v[208:211], a[12:15]
buffer_load_dwordx4 v1, s[44:47], s72 offen offset:3072 sc1 lds
v_mfma_f32_16x16x32_bf16 a[16:19], a[240:243], v[208:211], a[16:19]
v_exp_f32 v157, v157
v_mfma_f32_16x16x32_bf16 a[48:51], a[240:243], v[212:215], a[48:51]
v_exp_f32 v158, v158
v_mfma_f32_16x16x32_bf16 a[80:83], a[240:243], v[216:219], a[80:83]
ds_read_b128 a[220:223], v2 offset:7168
v_cvt_pk_bf16_f32 v206, v156, v157
v_mfma_f32_16x16x32_bf16 a[112:115], a[240:243], v[220:223], a[112:115]
v_exp_f32 v159, v159
v_mfma_f32_16x16x32_bf16 a[116:119], a[244:247], v[220:223], a[116:119]
v_cvt_pk_bf16_f32 v207, v158, v159
v_mfma_f32_16x16x32_bf16 a[84:87], a[244:247], v[216:219], a[84:87]
v_mfma_f32_16x16x32_bf16 a[52:55], a[244:247], v[212:215], a[52:55]
v_mfma_f32_16x16x32_bf16 a[20:23], a[244:247], v[208:211], a[20:23]
v_mfma_f32_16x16x32_bf16 a[24:27], a[248:251], v[208:211], a[24:27]
v_mfma_f32_16x16x32_bf16 a[56:59], a[248:251], v[212:215], a[56:59]
v_mfma_f32_16x16x32_bf16 a[88:91], a[248:251], v[216:219], a[88:91]
v_mfma_f32_16x16x32_bf16 a[120:123], a[248:251], v[220:223], a[120:123]
v_mfma_f32_16x16x32_bf16 a[124:127], a[252:255], v[220:223], a[124:127]
v_mfma_f32_16x16x32_bf16 a[92:95], a[252:255], v[216:219], a[92:95]
v_mfma_f32_16x16x32_bf16 a[60:63], a[252:255], v[212:215], a[60:63]
v_mfma_f32_16x16x32_bf16 a[28:31], a[252:255], v[208:211], a[28:31]
v_mfma_f32_16x16x32_bf16 v[224:227], v[120:123], v[208:211], v[224:227]
v_mfma_f32_16x16x32_bf16 v[228:231], v[120:123], v[212:215], v[228:231]
v_mfma_f32_16x16x32_bf16 v[232:235], v[120:123], v[216:219], v[232:235]
v_mfma_f32_16x16x32_bf16 v[236:239], v[120:123], v[220:223], v[236:239]
s_waitcnt lgkmcnt(8)
s_cmp_eq_u32 s58, 0
s_cbranch_scc1 Lta22
s_cmp_eq_u32 s58, 1
s_cbranch_scc1 Lnt23
v_mfma_f32_16x16x32_bf16 v[132:135], a[128:131], v[32:35], v[84:87]
s_add_u32 s82, s82, 0x8000
ds_read_b128 a[160:163], v2 offset:24576
v_mfma_f32_16x16x32_bf16 v[148:151], a[144:147], v[32:35], v[84:87]
s_and_b32 s82, s82, 0x1ffff
v_exp_f32 v160, v160
s_branch Ljoin24
Lta22:
v_mfma_f32_16x16x32_bf16 v[132:135], a[128:131], v[32:35], v[100:103]
s_add_u32 s82, s82, 0x8000
ds_read_b128 a[160:163], v2 offset:24576
v_mfma_f32_16x16x32_bf16 v[148:151], a[144:147], v[32:35], v[112:115]
s_and_b32 s82, s82, 0x1ffff
v_exp_f32 v160, v160
s_branch Ljoin24
Lnt23:
v_mfma_f32_16x16x32_bf16 v[132:135], a[128:131], v[32:35], v[84:87]
s_add_u32 s82, s82, 0x8000
ds_read_b128 a[160:163], v2 offset:24576
v_mfma_f32_16x16x32_bf16 v[148:151], a[144:147], v[32:35], v[100:103]
s_and_b32 s82, s82, 0x1ffff
v_exp_f32 v160, v160
Ljoin24:
v_mfma_f32_16x16x32_bf16 v[132:135], a[132:135], v[36:39], v[132:135]
s_add_u32 m0, s74, 0
v_exp_f32 v161, v161
v_mfma_f32_16x16x32_bf16 v[132:135], a[136:139], v[40:43], v[132:135]
s_add_u32 s72, s81, 0
ds_read_b128 a[164:167], v2 offset:25600
v_cvt_pk_bf16_f32 v208, v160, v161
v_mfma_f32_16x16x32_bf16 v[132:135], a[140:143], v[44:47], v[132:135]
v_exp_f32 v162, v162
v_mfma_f32_16x16x32_bf16 v[136:139], a[140:143], v[60:63], v[88:91]
v_exp_f32 v163, v163
v_mfma_f32_16x16x32_bf16 v[136:139], a[136:139], v[56:59], v[136:139]
ds_read_b128 a[168:171], v2 offset:26624
v_cvt_pk_bf16_f32 v209, v162, v163
v_mfma_f32_16x16x32_bf16 v[136:139], a[132:135], v[52:55], v[136:139]
v_exp_f32 v176, v176
v_mfma_f32_16x16x32_bf16 v[136:139], a[128:131], v[48:51], v[136:139]
buffer_load_dwordx4 v1, s[44:47], s72 offen sc1 lds
v_mfma_f32_16x16x32_bf16 v[140:143], a[128:131], v[64:67], v[92:95]
v_exp_f32 v177, v177
v_mfma_f32_16x16x32_bf16 v[140:143], a[132:135], v[68:71], v[140:143]
ds_read_b128 a[172:175], v2 offset:27648
v_cvt_pk_bf16_f32 v210, v176, v177
v_mfma_f32_16x16x32_bf16 v[140:143], a[136:139], v[72:75], v[140:143]
v_exp_f32 v178, v178
v_mfma_f32_16x16x32_bf16 v[140:143], a[140:143], v[76:79], v[140:143]
v_exp_f32 v179, v179
v_mfma_f32_16x16x32_bf16 v[156:159], a[156:159], v[76:79], v[92:95]
ds_read_b128 a[176:179], v2 offset:28672
v_cvt_pk_bf16_f32 v211, v178, v179
v_mfma_f32_16x16x32_bf16 v[156:159], a[152:155], v[72:75], v[156:159]
v_exp_f32 v164, v164
v_mfma_f32_16x16x32_bf16 v[156:159], a[148:151], v[68:71], v[156:159]
v_exp_f32 v165, v165
v_mfma_f32_16x16x32_bf16 v[156:159], a[144:147], v[64:67], v[156:159]
ds_read_b128 a[180:183], v2 offset:29696
v_cvt_pk_bf16_f32 v212, v164, v165
v_mfma_f32_16x16x32_bf16 v[152:155], a[144:147], v[48:51], v[88:91]
v_exp_f32 v166, v166
v_mfma_f32_16x16x32_bf16 v[152:155], a[148:151], v[52:55], v[152:155]
v_exp_f32 v167, v167
v_mfma_f32_16x16x32_bf16 v[152:155], a[152:155], v[56:59], v[152:155]
ds_read_b128 a[184:187], v2 offset:30720
v_cvt_pk_bf16_f32 v213, v166, v167
v_mfma_f32_16x16x32_bf16 v[152:155], a[156:159], v[60:63], v[152:155]
v_exp_f32 v180, v180
v_mfma_f32_16x16x32_bf16 v[148:151], a[156:159], v[44:47], v[148:151]
buffer_load_dwordx4 v1, s[44:47], s72 offen offset:1024 sc1 lds
v_mfma_f32_16x16x32_bf16 v[148:151], a[152:155], v[40:43], v[148:151]
v_exp_f32 v181, v181
v_mfma_f32_16x16x32_bf16 v[148:151], a[148:151], v[36:39], v[148:151]
s_waitcnt lgkmcnt(7)
ds_read_b128 a[188:191], v2 offset:31744
v_cvt_pk_bf16_f32 v214, v180, v181
v_mfma_f32_16x16x32_bf16 a[0:3], a[192:195], v[192:195], a[0:3]
v_exp_f32 v182, v182
v_mfma_f32_16x16x32_bf16 a[32:35], a[192:195], v[196:199], a[32:35]
v_exp_f32 v183, v183
v_mfma_f32_16x16x32_bf16 a[64:67], a[192:195], v[200:203], a[64:67]
ds_read_b128 a[224:227], v2 offset:8192
v_cvt_pk_bf16_f32 v215, v182, v183
v_mfma_f32_16x16x32_bf16 a[96:99], a[192:195], v[204:207], a[96:99]
v_exp_f32 v168, v168
v_mfma_f32_16x16x32_bf16 a[100:103], a[196:199], v[204:207], a[100:103]
v_exp_f32 v169, v169
v_mfma_f32_16x16x32_bf16 a[68:71], a[196:199], v[200:203], a[68:71]
ds_read_b128 a[228:231], v2 offset:9216
v_cvt_pk_bf16_f32 v216, v168, v169
v_mfma_f32_16x16x32_bf16 a[36:39], a[196:199], v[196:199], a[36:39]
v_exp_f32 v170, v170
v_mfma_f32_16x16x32_bf16 a[4:7], a[196:199], v[192:195], a[4:7]
v_exp_f32 v171, v171
v_mfma_f32_16x16x32_bf16 a[8:11], a[200:203], v[192:195], a[8:11]
ds_read_b128 a[232:235], v2 offset:10240
v_cvt_pk_bf16_f32 v217, v170, v171
v_mfma_f32_16x16x32_bf16 a[40:43], a[200:203], v[196:199], a[40:43]
v_exp_f32 v184, v184
v_mfma_f32_16x16x32_bf16 a[72:75], a[200:203], v[200:203], a[72:75]
buffer_load_dwordx4 v1, s[44:47], s72 offen offset:2048 sc1 lds
v_mfma_f32_16x16x32_bf16 a[104:107], a[200:203], v[204:207], a[104:107]
v_exp_f32 v185, v185
v_mfma_f32_16x16x32_bf16 a[108:111], a[204:207], v[204:207], a[108:111]
ds_read_b128 a[236:239], v2 offset:11264
v_cvt_pk_bf16_f32 v218, v184, v185
v_mfma_f32_16x16x32_bf16 a[76:79], a[204:207], v[200:203], a[76:79]
v_exp_f32 v186, v186
v_mfma_f32_16x16x32_bf16 a[44:47], a[204:207], v[196:199], a[44:47]
v_exp_f32 v187, v187
v_mfma_f32_16x16x32_bf16 a[12:15], a[204:207], v[192:195], a[12:15]
ds_read_b128 a[240:243], v2 offset:12288
v_cvt_pk_bf16_f32 v219, v186, v187
v_mfma_f32_16x16x32_bf16 a[16:19], a[208:211], v[192:195], a[16:19]
v_exp_f32 v172, v172
v_mfma_f32_16x16x32_bf16 a[48:51], a[208:211], v[196:199], a[48:51]
v_exp_f32 v173, v173
v_mfma_f32_16x16x32_bf16 a[80:83], a[208:211], v[200:203], a[80:83]
ds_read_b128 a[244:247], v2 offset:13312
v_cvt_pk_bf16_f32 v220, v172, v173
v_mfma_f32_16x16x32_bf16 a[112:115], a[208:211], v[204:207], a[112:115]
v_exp_f32 v174, v174
v_mfma_f32_16x16x32_bf16 a[116:119], a[212:215], v[204:207], a[116:119]
v_exp_f32 v175, v175
v_mfma_f32_16x16x32_bf16 a[84:87], a[212:215], v[200:203], a[84:87]
ds_read_b128 a[248:251], v2 offset:14336
v_cvt_pk_bf16_f32 v221, v174, v175
v_mfma_f32_16x16x32_bf16 a[52:55], a[212:215], v[196:199], a[52:55]
v_exp_f32 v188, v188
v_mfma_f32_16x16x32_bf16 a[20:23], a[212:215], v[192:195], a[20:23]
buffer_load_dwordx4 v1, s[44:47], s72 offen offset:3072 sc1 lds
v_mfma_f32_16x16x32_bf16 a[24:27], a[216:219], v[192:195], a[24:27]
v_exp_f32 v189, v189
v_mfma_f32_16x16x32_bf16 a[56:59], a[216:219], v[196:199], a[56:59]
ds_read_b128 a[252:255], v2 offset:15360
v_cvt_pk_bf16_f32 v222, v188, v189
v_mfma_f32_16x16x32_bf16 a[88:91], a[216:219], v[200:203], a[88:91]
v_exp_f32 v190, v190
v_mfma_f32_16x16x32_bf16 a[120:123], a[216:219], v[204:207], a[120:123]
v_exp_f32 v191, v191
v_mfma_f32_16x16x32_bf16 a[124:127], a[220:223], v[204:207], a[124:127]
v_cvt_pk_bf16_f32 v223, v190, v191
v_add_u32 v2, s82, v1
v_mfma_f32_16x16x32_bf16 a[92:95], a[220:223], v[200:203], a[92:95]
v_mfma_f32_16x16x32_bf16 a[60:63], a[220:223], v[196:199], a[60:63]
v_mfma_f32_16x16x32_bf16 a[28:31], a[220:223], v[192:195], a[28:31]
v_mfma_f32_16x16x32_bf16 v[224:227], v[120:123], v[192:195], v[224:227]
v_mfma_f32_16x16x32_bf16 v[228:231], v[120:123], v[196:199], v[228:231]
v_mfma_f32_16x16x32_bf16 v[232:235], v[120:123], v[200:203], v[232:235]
s_waitcnt vmcnt(8) lgkmcnt(8)
v_mfma_f32_16x16x32_bf16 v[236:239], v[120:123], v[204:207], v[236:239]
s_barrier
s_cmp_eq_u32 s60, 7
s_cbranch_scc1 LLT3x
LLT3:
Lstub3:
s_cbranch_execz Lstub7
s_cmp_eq_u32 s58, 2
s_cbranch_scc1 Lta25
s_cmp_eq_u32 s58, 3
s_cbranch_scc1 Lnt26
v_mfma_f32_16x16x32_bf16 v[164:167], a[160:163], v[32:35], v[112:115]
s_xor_b32 s74, s82, 0x10000
v_exp_f32 v132, v132
v_mfma_f32_16x16x32_bf16 v[180:183], a[176:179], v[32:35], v[112:115]
s_add_u32 s74, s74, s64
ds_read_b128 a[128:131], v2 offset:16384
s_branch Ljoin27
Lta25:
v_mfma_f32_16x16x32_bf16 v[164:167], a[160:163], v[32:35], v[100:103]
s_xor_b32 s74, s82, 0x10000
v_exp_f32 v132, v132
v_mfma_f32_16x16x32_bf16 v[180:183], a[176:179], v[32:35], v[112:115]
s_add_u32 s74, s74, s64
ds_read_b128 a[128:131], v2 offset:16384
s_branch Ljoin27
Lnt26:
v_mfma_f32_16x16x32_bf16 v[164:167], a[160:163], v[32:35], v[84:87]
s_xor_b32 s74, s82, 0x10000
v_exp_f32 v132, v132
v_mfma_f32_16x16x32_bf16 v[180:183], a[176:179], v[32:35], v[100:103]
s_add_u32 s74, s74, s64
ds_read_b128 a[128:131], v2 offset:16384
Ljoin27:
v_mfma_f32_16x16x32_bf16 v[164:167], a[164:167], v[36:39], v[164:167]
s_add_u32 s81, s81, 0x8000
v_exp_f32 v133, v133
v_mfma_f32_16x16x32_bf16 v[164:167], a[168:171], v[40:43], v[164:167]
s_add_u32 m0, s74, 16384
ds_read_b128 a[132:135], v2 offset:17408
v_cvt_pk_bf16_f32 v196, v132, v133
v_mfma_f32_16x16x32_bf16 v[164:167], a[172:175], v[44:47], v[164:167]
s_add_u32 s72, s81, 16384
v_exp_f32 v134, v134
v_mfma_f32_16x16x32_bf16 v[168:171], a[172:175], v[60:63], v[88:91]
v_exp_f32 v135, v135
v_mfma_f32_16x16x32_bf16 v[168:171], a[168:171], v[56:59], v[168:171]
ds_read_b128 a[136:139], v2 offset:18432
v_cvt_pk_bf16_f32 v197, v134, v135
v_mfma_f32_16x16x32_bf16 v[168:171], a[164:167], v[52:55], v[168:171]
buffer_load_dwordx4 v1, s[44:47], s72 offen sc1 lds
v_mfma_f32_16x16x32_bf16 v[168:171], a[160:163], v[48:51], v[168:171]
v_exp_f32 v148, v148
v_mfma_f32_16x16x32_bf16 v[172:175], a[160:163], v[64:67], v[92:95]
ds_read_b128 a[140:143], v2 offset:19456
v_bfe_u32 v251, v0, 2, 2
v_mfma_f32_16x16x32_bf16 v[172:175], a[164:167], v[68:71], v[172:175]
v_exp_f32 v149, v149
v_mfma_f32_16x16x32_bf16 v[172:175], a[168:171], v[72:75], v[172:175]
v_exp_f32 v150, v150
v_mfma_f32_16x16x32_bf16 v[172:175], a[172:175], v[76:79], v[172:175]
ds_read_b128 a[144:147], v2 offset:20480
v_cvt_pk_bf16_f32 v198, v148, v149
v_mfma_f32_16x16x32_bf16 v[188:191], a[188:191], v[76:79], v[92:95]
v_exp_f32 v151, v151
v_mfma_f32_16x16x32_bf16 v[188:191], a[184:187], v[72:75], v[188:191]
ds_read_b128 a[148:151], v2 offset:21504
v_cvt_pk_bf16_f32 v199, v150, v151
v_mfma_f32_16x16x32_bf16 v[188:191], a[180:183], v[68:71], v[188:191]
v_exp_f32 v136, v136
v_mfma_f32_16x16x32_bf16 v[188:191], a[176:179], v[64:67], v[188:191]
Lstub4:
s_cbranch_execz Lstub8
v_exp_f32 v137, v137
v_mfma_f32_16x16x32_bf16 v[184:187], a[176:179], v[48:51], v[88:91]
ds_read_b128 a[152:155], v2 offset:22528
v_cvt_pk_bf16_f32 v200, v136, v137
v_mfma_f32_16x16x32_bf16 v[184:187], a[180:183], v[52:55], v[184:187]
buffer_load_dwordx4 v1, s[44:47], s72 offen offset:1024 sc1 lds
v_mfma_f32_16x16x32_bf16 v[184:187], a[184:187], v[56:59], v[184:187]
v_exp_f32 v138, v138
v_mfma_f32_16x16x32_bf16 v[184:187], a[188:191], v[60:63], v[184:187]
ds_read_b128 a[156:159], v2 offset:23552
v_lshl_add_u32 v6, v248, 3, v6
v_mfma_f32_16x16x32_bf16 v[180:183], a[188:191], v[44:47], v[180:183]
v_exp_f32 v139, v139
v_mfma_f32_16x16x32_bf16 v[180:183], a[184:187], v[40:43], v[180:183]
v_exp_f32 v152, v152
v_mfma_f32_16x16x32_bf16 v[180:183], a[180:183], v[36:39], v[180:183]
s_waitcnt lgkmcnt(8)
ds_read_b128 a[192:195], v2 offset:0
v_cvt_pk_bf16_f32 v201, v138, v139
v_mfma_f32_16x16x32_bf16 a[0:3], a[224:227], v[208:211], a[0:3]
v_exp_f32 v153, v153
v_mfma_f32_16x16x32_bf16 a[32:35], a[224:227], v[212:215], a[32:35]
ds_read_b128 a[196:199], v2 offset:1024
v_cvt_pk_bf16_f32 v202, v152, v153
v_mfma_f32_16x16x32_bf16 a[64:67], a[224:227], v[216:219], a[64:67]
v_exp_f32 v154, v154
v_mfma_f32_16x16x32_bf16 a[96:99], a[224:227], v[220:223], a[96:99]
v_exp_f32 v155, v155
v_mfma_f32_16x16x32_bf16 a[100:103], a[228:231], v[220:223], a[100:103]
ds_read_b128 a[200:203], v2 offset:2048
v_cvt_pk_bf16_f32 v203, v154, v155
v_mfma_f32_16x16x32_bf16 a[68:71], a[228:231], v[216:219], a[68:71]
buffer_load_dwordx4 v1, s[44:47], s72 offen offset:2048 sc1 lds
v_mfma_f32_16x16x32_bf16 a[36:39], a[228:231], v[212:215], a[36:39]
v_exp_f32 v140, v140
v_mfma_f32_16x16x32_bf16 a[4:7], a[228:231], v[208:211], a[4:7]
ds_read_b128 a[204:207], v2 offset:3072
v_lshl_add_u32 v6, v241, 4, v6
v_mfma_f32_16x16x32_bf16 a[8:11], a[232:235], v[208:211], a[8:11]
v_exp_f32 v141, v141
v_mfma_f32_16x16x32_bf16 a[40:43], a[232:235], v[212:215], a[40:43]
v_exp_f32 v142, v142
v_mfma_f32_16x16x32_bf16 a[72:75], a[232:235], v[216:219], a[72:75]
ds_read_b128 a[208:211], v2 offset:4096
v_cvt_pk_bf16_f32 v204, v140, v141
v_mfma_f32_16x16x32_bf16 a[104:107], a[232:235], v[220:223], a[104:107]
v_exp_f32 v143, v143
v_mfma_f32_16x16x32_bf16 a[108:111], a[236:239], v[220:223], a[108:111]
ds_read_b128 a[212:215], v2 offset:5120
v_cvt_pk_bf16_f32 v205, v142, v143
v_mfma_f32_16x16x32_bf16 a[76:79], a[236:239], v[216:219], a[76:79]
v_exp_f32 v156, v156
v_mfma_f32_16x16x32_bf16 a[44:47], a[236:239], v[212:215], a[44:47]
v_exp_f32 v157, v157
v_mfma_f32_16x16x32_bf16 a[12:15], a[236:239], v[208:211], a[12:15]
ds_read_b128 a[216:219], v2 offset:6144
v_cvt_pk_bf16_f32 v206, v156, v157
v_mfma_f32_16x16x32_bf16 a[16:19], a[240:243], v[208:211], a[16:19]
buffer_load_dwordx4 v1, s[44:47], s72 offen offset:3072 sc1 lds
v_mfma_f32_16x16x32_bf16 a[48:51], a[240:243], v[212:215], a[48:51]
v_exp_f32 v158, v158
v_mfma_f32_16x16x32_bf16 a[80:83], a[240:243], v[216:219], a[80:83]
ds_read_b128 a[220:223], v2 offset:7168
v_lshlrev_b32 v5, 3, v251
v_mfma_f32_16x16x32_bf16 a[112:115], a[240:243], v[220:223], a[112:115]
v_exp_f32 v159, v159
v_mfma_f32_16x16x32_bf16 a[116:119], a[244:247], v[220:223], a[116:119]
v_cvt_pk_bf16_f32 v207, v158, v159
v_lshrrev_b32 v5, v5, v252
v_mfma_f32_16x16x32_bf16 a[84:87], a[244:247], v[216:219], a[84:87]
v_and_b32 v5, 3, v5
v_cmp_ne_u32 vcc, 1, v251
v_mfma_f32_16x16x32_bf16 a[52:55], a[244:247], v[212:215], a[52:55]
v_mul_u32_u24 v5, 16640, v5
v_add_u32 v5, s92, v5
v_mfma_f32_16x16x32_bf16 a[20:23], a[244:247], v[208:211], a[20:23]
v_cndmask_b32 v5, v250, v5, vcc
v_add_u32 v253, s58, v251
v_mfma_f32_16x16x32_bf16 a[24:27], a[248:251], v[208:211], a[24:27]
v_and_b32 v253, 3, v253
v_mul_u32_u24 v253, 4160, v253
v_mfma_f32_16x16x32_bf16 a[56:59], a[248:251], v[212:215], a[56:59]
v_add_u32 v5, v5, v253
v_mfma_f32_16x16x32_bf16 a[88:91], a[248:251], v[216:219], a[88:91]
s_add_u32 s73, s62, 480
v_lshlrev_b32 v248, 5, v240
v_sub_u32 v248, s73, v248
v_mfma_f32_16x16x32_bf16 a[120:123], a[248:251], v[220:223], a[120:123]
v_lshl_add_u32 v7, v241, 4, v248
v_mfma_f32_16x16x32_bf16 a[124:127], a[252:255], v[220:223], a[124:127]
s_and_b32 s73, s58, 1
v_mfma_f32_16x16x32_bf16 a[92:95], a[252:255], v[216:219], a[92:95]
s_lshl_b32 s73, s73, 4
v_mfma_f32_16x16x32_bf16 a[60:63], a[252:255], v[212:215], a[60:63]
s_lshr_b32 s73, s90, s73
v_mfma_f32_16x16x32_bf16 a[28:31], a[252:255], v[208:211], a[28:31]
s_and_b32 s73, s73, 0xffff
v_lshl_add_u32 v248, v241, 3, v240
v_sub_u32 v248, 15, v248
v_mfma_f32_16x16x32_bf16 v[224:227], v[120:123], v[208:211], v[224:227]
v_and_b32 v249, 1, v248
v_lshlrev_b32 v249, 4, v249
v_mfma_f32_16x16x32_bf16 v[228:231], v[120:123], v[212:215], v[228:231]
v_lshlrev_b32 v249, v249, s73
v_lshrrev_b32 v248, 1, v248
v_mfma_f32_16x16x32_bf16 v[232:235], v[120:123], v[216:219], v[232:235]
v_and_b32 v241, 3, v0
v_cmp_eq_u32 vcc, 0, v248
v_mfma_f32_16x16x32_bf16 v[236:239], v[120:123], v[220:223], v[236:239]
s_waitcnt lgkmcnt(8)
v_mfma_f32_16x16x32_bf16 v[136:139], a[128:131], v[48:51], v[88:91]
s_add_u32 s82, s82, 0x8000
ds_read_b128 a[160:163], v2 offset:24576
ds_read_b128 a[164:167], v2 offset:25600
v_mfma_f32_16x16x32_bf16 v[136:139], a[132:135], v[52:55], v[136:139]
s_and_b32 s82, s82, 0x1ffff
v_exp_f32 v164, v164
v_mfma_f32_16x16x32_bf16 v[136:139], a[136:139], v[56:59], v[136:139]
s_add_u32 m0, s74, 0
v_exp_f32 v165, v165
v_mfma_f32_16x16x32_bf16 v[136:139], a[140:143], v[60:63], v[136:139]
s_add_u32 s72, s81, 0
v_exp_f32 v166, v166
v_mfma_f32_16x16x32_bf16 v[140:143], a[140:143], v[76:79], v[92:95]
ds_read_b128 a[168:171], v2 offset:26624
v_cvt_pk_bf16_f32 v212, v164, v165
v_mfma_f32_16x16x32_bf16 v[140:143], a[136:139], v[72:75], v[140:143]
v_exp_f32 v167, v167
v_mfma_f32_16x16x32_bf16 v[140:143], a[132:135], v[68:71], v[140:143]
buffer_load_dwordx4 v1, s[44:47], s72 offen sc1 lds
v_mfma_f32_16x16x32_bf16 v[140:143], a[128:131], v[64:67], v[140:143]
v_exp_f32 v180, v180
v_mfma_f32_16x16x32_bf16 v[156:159], a[144:147], v[64:67], v[92:95]
ds_read_b128 a[172:175], v2 offset:27648
v_cvt_pk_bf16_f32 v213, v166, v167
v_mfma_f32_16x16x32_bf16 v[156:159], a[148:151], v[68:71], v[156:159]
v_exp_f32 v181, v181
v_mfma_f32_16x16x32_bf16 v[156:159], a[152:155], v[72:75], v[156:159]
ds_read_b128 a[176:179], v2 offset:28672
v_cvt_pk_bf16_f32 v214, v180, v181
v_mfma_f32_16x16x32_bf16 v[156:159], a[156:159], v[76:79], v[156:159]
v_exp_f32 v182, v182
v_mfma_f32_16x16x32_bf16 v[152:155], a[156:159], v[60:63], v[88:91]
v_exp_f32 v183, v183
v_mfma_f32_16x16x32_bf16 v[152:155], a[152:155], v[56:59], v[152:155]
ds_read_b128 a[180:183], v2 offset:29696
v_cvt_pk_bf16_f32 v215, v182, v183
v_mfma_f32_16x16x32_bf16 v[152:155], a[148:151], v[52:55], v[152:155]
v_exp_f32 v168, v168
v_mfma_f32_16x16x32_bf16 v[152:155], a[144:147], v[48:51], v[152:155]
s_waitcnt lgkmcnt(6)
ds_read_b128 a[184:187], v2 offset:30720
ds_read_b128 a[188:191], v2 offset:31744
v_mfma_f32_16x16x32_bf16 a[32:35], a[192:195], v[196:199], a[32:35]
v_exp_f32 v169, v169
v_mfma_f32_16x16x32_bf16 a[64:67], a[192:195], v[200:203], a[64:67]
buffer_load_dwordx4 v1, s[44:47], s72 offen offset:1024 sc1 lds
v_mfma_f32_16x16x32_bf16 a[96:99], a[192:195], v[204:207], a[96:99]
v_exp_f32 v170, v170
v_mfma_f32_16x16x32_bf16 a[100:103], a[196:199], v[204:207], a[100:103]
v_exp_f32 v171, v171
v_mfma_f32_16x16x32_bf16 a[68:71], a[196:199], v[200:203], a[68:71]
ds_read_b128 a[224:227], v2 offset:8192
v_cvt_pk_bf16_f32 v216, v168, v169
v_mfma_f32_16x16x32_bf16 a[36:39], a[196:199], v[196:199], a[36:39]
v_exp_f32 v184, v184
v_mfma_f32_16x16x32_bf16 a[40:43], a[200:203], v[196:199], a[40:43]
v_exp_f32 v185, v185
v_mfma_f32_16x16x32_bf16 a[72:75], a[200:203], v[200:203], a[72:75]
ds_read_b128 a[228:231], v2 offset:9216
v_cvt_pk_bf16_f32 v217, v170, v171
v_mfma_f32_16x16x32_bf16 a[104:107], a[200:203], v[204:207], a[104:107]
v_exp_f32 v186, v186
v_mfma_f32_16x16x32_bf16 a[108:111], a[204:207], v[204:207], a[108:111]
ds_read_b128 a[232:235], v2 offset:10240
v_cvt_pk_bf16_f32 v218, v184, v185
v_mfma_f32_16x16x32_bf16 a[76:79], a[204:207], v[200:203], a[76:79]
v_exp_f32 v187, v187
v_mfma_f32_16x16x32_bf16 a[44:47], a[204:207], v[196:199], a[44:47]
buffer_load_dwordx4 v1, s[44:47], s72 offen offset:2048 sc1 lds
v_mfma_f32_16x16x32_bf16 a[48:51], a[208:211], v[196:199], a[48:51]
v_exp_f32 v172, v172
v_mfma_f32_16x16x32_bf16 a[80:83], a[208:211], v[200:203], a[80:83]
ds_read_b128 a[236:239], v2 offset:11264
v_cvt_pk_bf16_f32 v219, v186, v187
v_mfma_f32_16x16x32_bf16 a[112:115], a[208:211], v[204:207], a[112:115]
v_exp_f32 v173, v173
v_mfma_f32_16x16x32_bf16 a[116:119], a[212:215], v[204:207], a[116:119]
ds_read_b128 a[240:243], v2 offset:12288
v_cvt_pk_bf16_f32 v220, v172, v173
v_mfma_f32_16x16x32_bf16 a[84:87], a[212:215], v[200:203], a[84:87]
v_exp_f32 v174, v174
v_mfma_f32_16x16x32_bf16 a[52:55], a[212:215], v[196:199], a[52:55]
v_exp_f32 v175, v175
v_mfma_f32_16x16x32_bf16 a[56:59], a[216:219], v[196:199], a[56:59]
ds_read_b128 a[244:247], v2 offset:13312
v_cvt_pk_bf16_f32 v221, v174, v175
v_mfma_f32_16x16x32_bf16 a[88:91], a[216:219], v[200:203], a[88:91]
v_exp_f32 v188, v188
v_mfma_f32_16x16x32_bf16 a[120:123], a[216:219], v[204:207], a[120:123]
ds_read_b128 a[248:251], v2 offset:14336
v_mfma_f32_16x16x32_bf16 a[124:127], a[220:223], v[204:207], a[124:127]
v_exp_f32 v189, v189
v_mfma_f32_16x16x32_bf16 a[92:95], a[220:223], v[200:203], a[92:95]
buffer_load_dwordx4 v1, s[44:47], s72 offen offset:3072 sc1 lds
v_mfma_f32_16x16x32_bf16 a[60:63], a[220:223], v[196:199], a[60:63]
ds_read_b128 a[252:255], v2 offset:15360
v_cvt_pk_bf16_f32 v222, v188, v189
v_mfma_f32_16x16x32_bf16 v[228:231], v[120:123], v[196:199], v[228:231]
v_exp_f32 v190, v190
v_mfma_f32_16x16x32_bf16 v[232:235], v[120:123], v[200:203], v[232:235]
s_waitcnt vmcnt(8) lgkmcnt(8)
v_exp_f32 v191, v191
v_mfma_f32_16x16x32_bf16 v[236:239], v[120:123], v[204:207], v[236:239]
s_barrier
v_cvt_pk_bf16_f32 v223, v190, v191
v_add_u32 v2, s82, v1
v_mfma_f32_16x16x32_bf16 v[168:171], a[160:163], v[48:51], v[88:91]
s_xor_b32 s74, s82, 0x10000
v_exp_f32 v136, v136
v_mfma_f32_16x16x32_bf16 v[168:171], a[164:167], v[52:55], v[168:171]
s_add_u32 s74, s74, s64
ds_read_b128 a[128:131], v2 offset:16384
v_mfma_f32_16x16x32_bf16 v[168:171], a[168:171], v[56:59], v[168:171]
s_add_u32 s81, s81, 0x8000
v_exp_f32 v137, v137
v_mfma_f32_16x16x32_bf16 v[168:171], a[172:175], v[60:63], v[168:171]
s_add_u32 m0, s74, 16384
ds_read_b128 a[132:135], v2 offset:17408
v_cvt_pk_bf16_f32 v200, v136, v137
v_mfma_f32_16x16x32_bf16 v[172:175], a[172:175], v[76:79], v[92:95]
s_add_u32 s72, s81, 16384
v_exp_f32 v138, v138
v_mfma_f32_16x16x32_bf16 v[172:175], a[168:171], v[72:75], v[172:175]
ds_read_b128 a[136:139], v2 offset:18432
v_lshl_add_u32 v5, v241, 3, v5
v_mfma_f32_16x16x32_bf16 v[172:175], a[164:167], v[68:71], v[172:175]
buffer_load_dwordx4 v1, s[44:47], s72 offen sc1 lds
v_mfma_f32_16x16x32_bf16 v[172:175], a[160:163], v[64:67], v[172:175]
v_exp_f32 v139, v139
v_mfma_f32_16x16x32_bf16 v[188:191], a[176:179], v[64:67], v[92:95]
ds_read_b128 a[140:143], v2 offset:19456
v_cvt_pk_bf16_f32 v201, v138, v139
v_mfma_f32_16x16x32_bf16 v[188:191], a[180:183], v[68:71], v[188:191]
v_exp_f32 v152, v152
v_mfma_f32_16x16x32_bf16 v[188:191], a[184:187], v[72:75], v[188:191]
ds_read_b128 a[144:147], v2 offset:20480
v_cndmask_b32 v8, 0, v249, vcc
v_mfma_f32_16x16x32_bf16 v[188:191], a[188:191], v[76:79], v[188:191]
v_exp_f32 v153, v153
v_mfma_f32_16x16x32_bf16 v[184:187], a[188:191], v[60:63], v[88:91]
ds_read_b128 a[148:151], v2 offset:21504
v_cvt_pk_bf16_f32 v202, v152, v153
v_mfma_f32_16x16x32_bf16 v[184:187], a[184:187], v[56:59], v[184:187]
v_exp_f32 v154, v154
v_mfma_f32_16x16x32_bf16 v[184:187], a[180:183], v[52:55], v[184:187]
ds_read_b128 a[152:155], v2 offset:22528
v_cmp_eq_u32 vcc, 1, v248
v_mfma_f32_16x16x32_bf16 v[184:187], a[176:179], v[48:51], v[184:187]
s_waitcnt lgkmcnt(7)
buffer_load_dwordx4 v1, s[44:47], s72 offen offset:1024 sc1 lds
v_mfma_f32_16x16x32_bf16 a[32:35], a[224:227], v[212:215], a[32:35]
v_exp_f32 v155, v155
v_mfma_f32_16x16x32_bf16 a[64:67], a[224:227], v[216:219], a[64:67]
ds_read_b128 a[156:159], v2 offset:23552
v_cvt_pk_bf16_f32 v203, v154, v155
v_mfma_f32_16x16x32_bf16 a[96:99], a[224:227], v[220:223], a[96:99]
v_exp_f32 v140, v140
v_mfma_f32_16x16x32_bf16 a[100:103], a[228:231], v[220:223], a[100:103]
ds_read_b128 a[192:195], v2 offset:0
v_lshlrev_b32 v240, 4, v251
v_mfma_f32_16x16x32_bf16 a[68:71], a[228:231], v[216:219], a[68:71]
v_exp_f32 v141, v141
v_mfma_f32_16x16x32_bf16 a[36:39], a[228:231], v[212:215], a[36:39]
ds_read_b128 a[196:199], v2 offset:1024
v_cvt_pk_bf16_f32 v204, v140, v141
v_mfma_f32_16x16x32_bf16 a[40:43], a[232:235], v[212:215], a[40:43]
v_exp_f32 v142, v142
v_mfma_f32_16x16x32_bf16 a[72:75], a[232:235], v[216:219], a[72:75]
ds_read_b128 a[200:203], v2 offset:2048
v_cndmask_b32 v9, 0, v249, vcc
v_mfma_f32_16x16x32_bf16 a[104:107], a[232:235], v[220:223], a[104:107]
buffer_load_dwordx4 v1, s[44:47], s72 offen offset:2048 sc1 lds
v_mfma_f32_16x16x32_bf16 a[108:111], a[236:239], v[220:223], a[108:111]
v_exp_f32 v143, v143
v_mfma_f32_16x16x32_bf16 a[76:79], a[236:239], v[216:219], a[76:79]
ds_read_b128 a[204:207], v2 offset:3072
v_cvt_pk_bf16_f32 v205, v142, v143
v_mfma_f32_16x16x32_bf16 a[44:47], a[236:239], v[212:215], a[44:47]
v_exp_f32 v156, v156
v_mfma_f32_16x16x32_bf16 a[48:51], a[240:243], v[212:215], a[48:51]
ds_read_b128 a[208:211], v2 offset:4096
v_cmp_eq_u32 vcc, 2, v248
v_mfma_f32_16x16x32_bf16 a[80:83], a[240:243], v[216:219], a[80:83]
v_exp_f32 v157, v157
v_mfma_f32_16x16x32_bf16 a[112:115], a[240:243], v[220:223], a[112:115]
ds_read_b128 a[212:215], v2 offset:5120
v_cvt_pk_bf16_f32 v206, v156, v157
v_mfma_f32_16x16x32_bf16 a[116:119], a[244:247], v[220:223], a[116:119]
v_exp_f32 v158, v158
v_mfma_f32_16x16x32_bf16 a[84:87], a[244:247], v[216:219], a[84:87]
ds_read_b128 a[216:219], v2 offset:6144
v_sub_u32 v240, 48, v240
v_mfma_f32_16x16x32_bf16 a[52:55], a[244:247], v[212:215], a[52:55]
buffer_load_dwordx4 v1, s[44:47], s72 offen offset:3072 sc1 lds
v_mfma_f32_16x16x32_bf16 a[56:59], a[248:251], v[212:215], a[56:59]
v_exp_f32 v159, v159
v_mfma_f32_16x16x32_bf16 a[88:91], a[248:251], v[216:219], a[88:91]
ds_read_b128 a[220:223], v2 offset:7168
v_cvt_pk_bf16_f32 v207, v158, v159
v_mfma_f32_16x16x32_bf16 a[120:123], a[248:251], v[220:223], a[120:123]
v_lshlrev_b64 v[12:13], 16, s[88:89]
v_cndmask_b32 v10, 0, v249, vcc
v_mfma_f32_16x16x32_bf16 a[124:127], a[252:255], v[220:223], a[124:127]
v_cmp_eq_u32 vcc, 3, v248
v_lshlrev_b64 v[12:13], v240, v[12:13]
v_mfma_f32_16x16x32_bf16 a[92:95], a[252:255], v[216:219], a[92:95]
v_cndmask_b32 v11, 0, v249, vcc
v_cmp_eq_u32 vcc, 3, v241
v_mfma_f32_16x16x32_bf16 a[60:63], a[252:255], v[212:215], a[60:63]
s_add_u32 s73, s62, 4096
v_lshl_add_u32 v14, v0, 3, s73
v_cndmask_b32 v12, 0, v12, vcc
v_mfma_f32_16x16x32_bf16 v[228:231], v[120:123], v[212:215], v[228:231]
v_cndmask_b32 v13, 0, v13, vcc
v_lshrrev_b32 v15, 4, v0
v_mfma_f32_16x16x32_bf16 v[232:235], v[120:123], v[216:219], v[232:235]
v_lshlrev_b32 v15, 1, v15
v_and_b32 v240, 7, v0
v_mfma_f32_16x16x32_bf16 v[236:239], v[120:123], v[220:223], v[236:239]
s_waitcnt lgkmcnt(8)
v_xor_b32 v15, v15, v240
v_lshlrev_b32 v15, 4, v15
v_lshrrev_b32 v240, 3, v0
v_lshl_add_u32 v15, v240, 11, v15
s_and_b32 s75, s59, 8
s_add_u32 s75, s75, s60
s_lshr_b32 s76, s59, 4
s_lshl_b32 s76, s76, 2
s_add_u32 s76, s76, s65
s_lshl_b32 s76, s76, 1
s_lshr_b32 s80, s59, 2
s_and_b32 s80, s80, 1
s_add_u32 s76, s76, s80
s_lshl_b32 s94, s58, 16
s_lshl_b32 s80, s76, 7
s_add_u32 s94, s94, s80
s_lshl_b32 s80, s75, 18
s_add_u32 s80, s80, s94
v_rcp_f32 v224, v224
v_rcp_f32 v228, v228
s_lshl_b32 s73, s59, 12
s_add_u32 s73, s73, 0x2000000
s_lshl_b32 s70, s67, 2
s_add_u32 s70, s70, s73
v_mov_b32 v225, v224
v_accvgpr_read_b32 v240, a0
v_accvgpr_read_b32 v241, a1
v_accvgpr_read_b32 v242, a2
v_accvgpr_read_b32 v243, a3
v_accvgpr_read_b32 v244, a4
v_accvgpr_read_b32 v245, a5
v_accvgpr_read_b32 v246, a6
v_accvgpr_read_b32 v247, a7
v_pk_mul_f32 v[240:241], v[240:241], v[224:225]
v_pk_mul_f32 v[242:243], v[242:243], v[224:225]
v_pk_mul_f32 v[244:245], v[244:245], v[224:225]
v_pk_mul_f32 v[246:247], v[246:247], v[224:225]
v_cvt_pk_bf16_f32 v128, v240, v241
v_cvt_pk_bf16_f32 v129, v242, v243
v_cvt_pk_bf16_f32 v130, v244, v245
v_cvt_pk_bf16_f32 v131, v246, v247
v_accvgpr_read_b32 v248, a8
v_accvgpr_read_b32 v249, a9
v_accvgpr_read_b32 v250, a10
v_accvgpr_read_b32 v251, a11
v_accvgpr_read_b32 v252, a12
v_accvgpr_read_b32 v253, a13
v_accvgpr_read_b32 v254, a14
v_accvgpr_read_b32 v255, a15
v_pk_mul_f32 v[248:249], v[248:249], v[224:225]
v_pk_mul_f32 v[250:251], v[250:251], v[224:225]
v_pk_mul_f32 v[252:253], v[252:253], v[224:225]
v_pk_mul_f32 v[254:255], v[254:255], v[224:225]
v_cvt_pk_bf16_f32 v144, v248, v249
v_cvt_pk_bf16_f32 v145, v250, v251
v_cvt_pk_bf16_f32 v146, v252, v253
v_cvt_pk_bf16_f32 v147, v254, v255
v_accvgpr_read_b32 v240, a16
v_accvgpr_read_b32 v241, a17
v_accvgpr_read_b32 v242, a18
v_accvgpr_read_b32 v243, a19
v_accvgpr_read_b32 v244, a20
v_accvgpr_read_b32 v245, a21
v_accvgpr_read_b32 v246, a22
v_accvgpr_read_b32 v247, a23
v_pk_mul_f32 v[240:241], v[240:241], v[224:225]
v_pk_mul_f32 v[242:243], v[242:243], v[224:225]
v_pk_mul_f32 v[244:245], v[244:245], v[224:225]
v_pk_mul_f32 v[246:247], v[246:247], v[224:225]
v_cvt_pk_bf16_f32 v160, v240, v241
v_cvt_pk_bf16_f32 v161, v242, v243
v_cvt_pk_bf16_f32 v162, v244, v245
v_cvt_pk_bf16_f32 v163, v246, v247
v_accvgpr_read_b32 v248, a24
v_accvgpr_read_b32 v249, a25
v_accvgpr_read_b32 v250, a26
v_accvgpr_read_b32 v251, a27
v_accvgpr_read_b32 v252, a28
v_accvgpr_read_b32 v253, a29
v_accvgpr_read_b32 v254, a30
v_accvgpr_read_b32 v255, a31
v_pk_mul_f32 v[248:249], v[248:249], v[224:225]
v_pk_mul_f32 v[250:251], v[250:251], v[224:225]
v_pk_mul_f32 v[252:253], v[252:253], v[224:225]
v_pk_mul_f32 v[254:255], v[254:255], v[224:225]
v_cvt_pk_bf16_f32 v176, v248, v249
v_cvt_pk_bf16_f32 v177, v250, v251
v_cvt_pk_bf16_f32 v178, v252, v253
v_cvt_pk_bf16_f32 v179, v254, v255
v_mov_b32 v229, v228
v_accvgpr_read_b32 v240, a32
v_accvgpr_read_b32 v241, a33
v_accvgpr_read_b32 v242, a34
v_accvgpr_read_b32 v243, a35
v_accvgpr_read_b32 v244, a36
v_accvgpr_read_b32 v245, a37
v_accvgpr_read_b32 v246, a38
v_accvgpr_read_b32 v247, a39
v_pk_mul_f32 v[240:241], v[240:241], v[228:229]
v_pk_mul_f32 v[242:243], v[242:243], v[228:229]
v_pk_mul_f32 v[244:245], v[244:245], v[228:229]
v_pk_mul_f32 v[246:247], v[246:247], v[228:229]
v_cvt_pk_bf16_f32 v132, v240, v241
v_cvt_pk_bf16_f32 v133, v242, v243
v_cvt_pk_bf16_f32 v134, v244, v245
v_cvt_pk_bf16_f32 v135, v246, v247
v_accvgpr_read_b32 v248, a40
v_accvgpr_read_b32 v249, a41
v_accvgpr_read_b32 v250, a42
v_accvgpr_read_b32 v251, a43
v_accvgpr_read_b32 v252, a44
v_accvgpr_read_b32 v253, a45
v_accvgpr_read_b32 v254, a46
v_accvgpr_read_b32 v255, a47
v_pk_mul_f32 v[248:249], v[248:249], v[228:229]
v_pk_mul_f32 v[250:251], v[250:251], v[228:229]
v_pk_mul_f32 v[252:253], v[252:253], v[228:229]
v_pk_mul_f32 v[254:255], v[254:255], v[228:229]
v_cvt_pk_bf16_f32 v148, v248, v249
v_cvt_pk_bf16_f32 v149, v250, v251
v_cvt_pk_bf16_f32 v150, v252, v253
v_cvt_pk_bf16_f32 v151, v254, v255
v_accvgpr_read_b32 v240, a48
v_accvgpr_read_b32 v241, a49
v_accvgpr_read_b32 v242, a50
v_accvgpr_read_b32 v243, a51
v_accvgpr_read_b32 v244, a52
v_accvgpr_read_b32 v245, a53
v_accvgpr_read_b32 v246, a54
v_accvgpr_read_b32 v247, a55
v_pk_mul_f32 v[240:241], v[240:241], v[228:229]
v_pk_mul_f32 v[242:243], v[242:243], v[228:229]
v_pk_mul_f32 v[244:245], v[244:245], v[228:229]
v_pk_mul_f32 v[246:247], v[246:247], v[228:229]
v_cvt_pk_bf16_f32 v164, v240, v241
v_cvt_pk_bf16_f32 v165, v242, v243
v_cvt_pk_bf16_f32 v166, v244, v245
v_cvt_pk_bf16_f32 v167, v246, v247
v_accvgpr_read_b32 v248, a56
v_accvgpr_read_b32 v249, a57
v_accvgpr_read_b32 v250, a58
v_accvgpr_read_b32 v251, a59
v_accvgpr_read_b32 v252, a60
v_accvgpr_read_b32 v253, a61
v_accvgpr_read_b32 v254, a62
v_accvgpr_read_b32 v255, a63
v_pk_mul_f32 v[248:249], v[248:249], v[228:229]
v_pk_mul_f32 v[250:251], v[250:251], v[228:229]
v_pk_mul_f32 v[252:253], v[252:253], v[228:229]
v_pk_mul_f32 v[254:255], v[254:255], v[228:229]
v_cvt_pk_bf16_f32 v180, v248, v249
v_cvt_pk_bf16_f32 v181, v250, v251
v_cvt_pk_bf16_f32 v182, v252, v253
v_cvt_pk_bf16_f32 v183, v254, v255
v_mfma_f32_16x16x32_bf16 v[136:139], a[128:131], v[48:51], v[88:91]
s_add_u32 s82, s82, 0x8000
ds_read_b128 a[160:163], v2 offset:24576
ds_read_b128 a[164:167], v2 offset:25600
v_mfma_f32_16x16x32_bf16 v[136:139], a[132:135], v[52:55], v[136:139]
s_and_b32 s82, s82, 0x1ffff
v_exp_f32 v168, v168
v_mfma_f32_16x16x32_bf16 v[136:139], a[136:139], v[56:59], v[136:139]
s_add_u32 m0, s74, 0
v_exp_f32 v169, v169
v_mfma_f32_16x16x32_bf16 v[136:139], a[140:143], v[60:63], v[136:139]
s_add_u32 s72, s81, 0
buffer_load_dwordx4 v1, s[44:47], s72 offen sc1 lds
v_mfma_f32_16x16x32_bf16 v[140:143], a[140:143], v[76:79], v[92:95]
ds_read_b128 a[168:171], v2 offset:26624
v_cvt_pk_bf16_f32 v216, v168, v169
v_mfma_f32_16x16x32_bf16 v[140:143], a[136:139], v[72:75], v[140:143]
v_exp_f32 v170, v170
v_mfma_f32_16x16x32_bf16 v[140:143], a[132:135], v[68:71], v[140:143]
ds_read_b128 a[172:175], v2 offset:27648
ds_read_b128 a[176:179], v2 offset:28672
v_mfma_f32_16x16x32_bf16 v[140:143], a[128:131], v[64:67], v[140:143]
v_exp_f32 v171, v171
v_mfma_f32_16x16x32_bf16 v[156:159], a[144:147], v[64:67], v[92:95]
v_exp_f32 v184, v184
v_mfma_f32_16x16x32_bf16 v[156:159], a[148:151], v[68:71], v[156:159]
buffer_store_dwordx4 v[128:131], v1, s[44:47], s70 offen sc1
v_mfma_f32_16x16x32_bf16 v[156:159], a[152:155], v[72:75], v[156:159]
ds_read_b128 a[180:183], v2 offset:29696
v_cvt_pk_bf16_f32 v217, v170, v171
v_mfma_f32_16x16x32_bf16 v[156:159], a[156:159], v[76:79], v[156:159]
v_exp_f32 v185, v185
v_mfma_f32_16x16x32_bf16 v[152:155], a[156:159], v[60:63], v[88:91]
ds_read_b128 a[184:187], v2 offset:30720
v_cvt_pk_bf16_f32 v218, v184, v185
v_mfma_f32_16x16x32_bf16 v[152:155], a[152:155], v[56:59], v[152:155]
v_exp_f32 v186, v186
v_mfma_f32_16x16x32_bf16 v[152:155], a[148:151], v[52:55], v[152:155]
buffer_load_dwordx4 v1, s[44:47], s72 offen offset:1024 sc1 lds
v_mfma_f32_16x16x32_bf16 v[152:155], a[144:147], v[48:51], v[152:155]
s_waitcnt lgkmcnt(7)
ds_read_b128 a[188:191], v2 offset:31744
ds_read_b128 a[224:227], v2 offset:8192
v_mfma_f32_16x16x32_bf16 a[64:67], a[192:195], v[200:203], a[64:67]
v_exp_f32 v187, v187
v_mfma_f32_16x16x32_bf16 a[96:99], a[192:195], v[204:207], a[96:99]
v_exp_f32 v172, v172
v_mfma_f32_16x16x32_bf16 a[100:103], a[196:199], v[204:207], a[100:103]
ds_read_b128 a[228:231], v2 offset:9216
v_cvt_pk_bf16_f32 v219, v186, v187
v_mfma_f32_16x16x32_bf16 a[68:71], a[196:199], v[200:203], a[68:71]
v_exp_f32 v173, v173
v_mfma_f32_16x16x32_bf16 a[72:75], a[200:203], v[200:203], a[72:75]
buffer_store_dwordx4 v[144:147], v1, s[44:47], s70 offen offset:1024 sc1
v_mfma_f32_16x16x32_bf16 a[104:107], a[200:203], v[204:207], a[104:107]
ds_read_b128 a[232:235], v2 offset:10240
v_cvt_pk_bf16_f32 v220, v172, v173
v_mfma_f32_16x16x32_bf16 a[108:111], a[204:207], v[204:207], a[108:111]
v_exp_f32 v174, v174
v_mfma_f32_16x16x32_bf16 a[76:79], a[204:207], v[200:203], a[76:79]
ds_read_b128 a[236:239], v2 offset:11264
ds_read_b128 a[240:243], v2 offset:12288
v_mfma_f32_16x16x32_bf16 a[80:83], a[208:211], v[200:203], a[80:83]
v_exp_f32 v175, v175
v_mfma_f32_16x16x32_bf16 a[112:115], a[208:211], v[204:207], a[112:115]
buffer_load_dwordx4 v1, s[44:47], s72 offen offset:2048 sc1 lds
v_mfma_f32_16x16x32_bf16 a[116:119], a[212:215], v[204:207], a[116:119]
v_exp_f32 v188, v188
v_mfma_f32_16x16x32_bf16 a[84:87], a[212:215], v[200:203], a[84:87]
ds_read_b128 a[244:247], v2 offset:13312
v_cvt_pk_bf16_f32 v221, v174, v175
v_mfma_f32_16x16x32_bf16 a[88:91], a[216:219], v[200:203], a[88:91]
v_exp_f32 v189, v189
v_mfma_f32_16x16x32_bf16 a[120:123], a[216:219], v[204:207], a[120:123]
ds_read_b128 a[248:251], v2 offset:14336
ds_read_b128 a[252:255], v2 offset:15360
v_mfma_f32_16x16x32_bf16 a[124:127], a[220:223], v[204:207], a[124:127]
v_exp_f32 v190, v190
v_mfma_f32_16x16x32_bf16 a[92:95], a[220:223], v[200:203], a[92:95]
buffer_load_dwordx4 v1, s[44:47], s72 offen offset:3072 sc1 lds
v_mfma_f32_16x16x32_bf16 v[232:235], v[120:123], v[200:203], v[232:235]
s_waitcnt vmcnt(10) lgkmcnt(8)
v_exp_f32 v191, v191
v_mfma_f32_16x16x32_bf16 v[236:239], v[120:123], v[204:207], v[236:239]
s_barrier
v_cvt_pk_bf16_f32 v222, v188, v189
v_cvt_pk_bf16_f32 v223, v190, v191
v_add_u32 v2, s82, v1
v_mfma_f32_16x16x32_bf16 v[168:171], a[160:163], v[48:51], v[88:91]
s_xor_b32 s74, s82, 0x10000
v_exp_f32 v136, v136
v_mfma_f32_16x16x32_bf16 v[168:171], a[164:167], v[52:55], v[168:171]
s_add_u32 s74, s74, s64
ds_read_b128 a[128:131], v2 offset:16384
ds_read_b128 a[132:135], v2 offset:17408
v_mfma_f32_16x16x32_bf16 v[168:171], a[168:171], v[56:59], v[168:171]
s_add_u32 s81, s81, 0x8000
v_exp_f32 v137, v137
v_mfma_f32_16x16x32_bf16 v[168:171], a[172:175], v[60:63], v[168:171]
s_add_u32 m0, s74, 16384
v_exp_f32 v138, v138
v_mfma_f32_16x16x32_bf16 v[172:175], a[172:175], v[76:79], v[92:95]
s_add_u32 s72, s81, 16384
buffer_load_dwordx4 v1, s[44:47], s72 offen sc1 lds
v_mfma_f32_16x16x32_bf16 v[172:175], a[168:171], v[72:75], v[172:175]
Lstub5:
s_cbranch_execz Lstub9
ds_read_b128 a[136:139], v2 offset:18432
v_cvt_pk_bf16_f32 v200, v136, v137
v_mfma_f32_16x16x32_bf16 v[172:175], a[164:167], v[68:71], v[172:175]
v_exp_f32 v139, v139
v_mfma_f32_16x16x32_bf16 v[172:175], a[160:163], v[64:67], v[172:175]
ds_read_b128 a[140:143], v2 offset:19456
v_cvt_pk_bf16_f32 v201, v138, v139
v_mfma_f32_16x16x32_bf16 v[188:191], a[176:179], v[64:67], v[92:95]
buffer_store_dwordx4 v[160:163], v1, s[44:47], s70 offen offset:2048 sc1
v_mfma_f32_16x16x32_bf16 v[188:191], a[180:183], v[68:71], v[188:191]
v_exp_f32 v152, v152
v_mfma_f32_16x16x32_bf16 v[188:191], a[184:187], v[72:75], v[188:191]
ds_read_b128 a[144:147], v2 offset:20480
ds_read_b128 a[148:151], v2 offset:21504
v_mfma_f32_16x16x32_bf16 v[188:191], a[188:191], v[76:79], v[188:191]
v_exp_f32 v153, v153
v_mfma_f32_16x16x32_bf16 v[184:187], a[188:191], v[60:63], v[88:91]
buffer_load_dwordx4 v1, s[44:47], s72 offen offset:1024 sc1 lds
v_mfma_f32_16x16x32_bf16 v[184:187], a[184:187], v[56:59], v[184:187]
v_exp_f32 v154, v154
v_mfma_f32_16x16x32_bf16 v[184:187], a[180:183], v[52:55], v[184:187]
ds_read_b128 a[152:155], v2 offset:22528
v_cvt_pk_bf16_f32 v202, v152, v153
v_mfma_f32_16x16x32_bf16 v[184:187], a[176:179], v[48:51], v[184:187]
s_waitcnt lgkmcnt(7)
v_exp_f32 v155, v155
v_mfma_f32_16x16x32_bf16 a[64:67], a[224:227], v[216:219], a[64:67]
ds_read_b128 a[156:159], v2 offset:23552
v_cvt_pk_bf16_f32 v203, v154, v155
v_mfma_f32_16x16x32_bf16 a[96:99], a[224:227], v[220:223], a[96:99]
v_exp_f32 v140, v140
v_mfma_f32_16x16x32_bf16 a[100:103], a[228:231], v[220:223], a[100:103]
ds_read_b128 a[192:195], v2 offset:0
ds_read_b128 a[196:199], v2 offset:1024
v_mfma_f32_16x16x32_bf16 a[68:71], a[228:231], v[216:219], a[68:71]
buffer_store_dwordx4 v[176:179], v1, s[44:47], s70 offen offset:3072 sc1
v_mfma_f32_16x16x32_bf16 a[72:75], a[232:235], v[216:219], a[72:75]
v_exp_f32 v141, v141
v_mfma_f32_16x16x32_bf16 a[104:107], a[232:235], v[220:223], a[104:107]
v_exp_f32 v142, v142
v_mfma_f32_16x16x32_bf16 a[108:111], a[236:239], v[220:223], a[108:111]
ds_read_b128 a[200:203], v2 offset:2048
ds_read_b128 a[204:207], v2 offset:3072
v_mfma_f32_16x16x32_bf16 a[76:79], a[236:239], v[216:219], a[76:79]
buffer_load_dwordx4 v1, s[44:47], s72 offen offset:2048 sc1 lds
v_mfma_f32_16x16x32_bf16 a[80:83], a[240:243], v[216:219], a[80:83]
s_add_u32 s70, s70, 0x80000
v_exp_f32 v143, v143
v_mfma_f32_16x16x32_bf16 a[112:115], a[240:243], v[220:223], a[112:115]
v_exp_f32 v156, v156
v_mfma_f32_16x16x32_bf16 a[116:119], a[244:247], v[220:223], a[116:119]
ds_read_b128 a[208:211], v2 offset:4096
ds_read_b128 a[212:215], v2 offset:5120
v_mfma_f32_16x16x32_bf16 a[84:87], a[244:247], v[216:219], a[84:87]
ds_read_b128 a[216:219], v2 offset:6144
ds_read_b128 a[220:223], v2 offset:7168
v_mfma_f32_16x16x32_bf16 a[88:91], a[248:251], v[216:219], a[88:91]
v_cvt_pk_bf16_f32 v204, v140, v141
v_cvt_pk_bf16_f32 v205, v142, v143
v_mfma_f32_16x16x32_bf16 a[120:123], a[248:251], v[220:223], a[120:123]
buffer_store_dwordx4 v[132:135], v1, s[44:47], s70 offen sc1
v_mfma_f32_16x16x32_bf16 a[124:127], a[252:255], v[220:223], a[124:127]
v_exp_f32 v157, v157
v_mfma_f32_16x16x32_bf16 a[92:95], a[252:255], v[216:219], a[92:95]
v_exp_f32 v158, v158
v_mfma_f32_16x16x32_bf16 v[232:235], v[120:123], v[216:219], v[232:235]
buffer_load_dwordx4 v1, s[44:47], s72 offen offset:3072 sc1 lds
v_mfma_f32_16x16x32_bf16 v[236:239], v[120:123], v[220:223], v[236:239]
s_waitcnt lgkmcnt(8)
v_exp_f32 v159, v159
v_cvt_pk_bf16_f32 v206, v156, v157
v_cvt_pk_bf16_f32 v207, v158, v159
v_mfma_f32_16x16x32_bf16 v[136:139], a[128:131], v[48:51], v[88:91]
s_add_u32 s82, s82, 0x8000
ds_read_b128 a[160:163], v2 offset:24576
ds_read_b128 a[164:167], v2 offset:25600
v_mfma_f32_16x16x32_bf16 v[136:139], a[132:135], v[52:55], v[136:139]
s_and_b32 s82, s82, 0x1ffff
v_exp_f32 v168, v168
v_mfma_f32_16x16x32_bf16 v[136:139], a[136:139], v[56:59], v[136:139]
s_add_u32 m0, s74, 0
v_exp_f32 v169, v169
v_mfma_f32_16x16x32_bf16 v[136:139], a[140:143], v[60:63], v[136:139]
s_add_u32 s72, s81, 0
buffer_load_dwordx4 v1, s[44:47], s72 offen sc1 lds
v_mfma_f32_16x16x32_bf16 v[140:143], a[140:143], v[76:79], v[92:95]
ds_read_b128 a[168:171], v2 offset:26624
v_cvt_pk_bf16_f32 v216, v168, v169
v_mfma_f32_16x16x32_bf16 v[140:143], a[136:139], v[72:75], v[140:143]
v_exp_f32 v170, v170
v_mfma_f32_16x16x32_bf16 v[140:143], a[132:135], v[68:71], v[140:143]
ds_read_b128 a[172:175], v2 offset:27648
ds_read_b128 a[176:179], v2 offset:28672
v_mfma_f32_16x16x32_bf16 v[140:143], a[128:131], v[64:67], v[140:143]
v_exp_f32 v171, v171
v_mfma_f32_16x16x32_bf16 v[156:159], a[144:147], v[64:67], v[92:95]
buffer_store_dwordx4 v[148:151], v1, s[44:47], s70 offen offset:1024 sc1
v_mfma_f32_16x16x32_bf16 v[156:159], a[148:151], v[68:71], v[156:159]
v_exp_f32 v184, v184
v_mfma_f32_16x16x32_bf16 v[156:159], a[152:155], v[72:75], v[156:159]
ds_read_b128 a[180:183], v2 offset:29696
v_cvt_pk_bf16_f32 v217, v170, v171
v_mfma_f32_16x16x32_bf16 v[156:159], a[156:159], v[76:79], v[156:159]
v_exp_f32 v185, v185
v_mfma_f32_16x16x32_bf16 v[152:155], a[156:159], v[60:63], v[88:91]
buffer_load_dwordx4 v1, s[44:47], s72 offen offset:1024 sc1 lds
v_mfma_f32_16x16x32_bf16 v[152:155], a[152:155], v[56:59], v[152:155]
ds_read_b128 a[184:187], v2 offset:30720
v_cvt_pk_bf16_f32 v218, v184, v185
v_mfma_f32_16x16x32_bf16 v[152:155], a[148:151], v[52:55], v[152:155]
v_exp_f32 v186, v186
v_mfma_f32_16x16x32_bf16 v[152:155], a[144:147], v[48:51], v[152:155]
s_waitcnt lgkmcnt(7)
ds_read_b128 a[188:191], v2 offset:31744
ds_read_b128 a[224:227], v2 offset:8192
v_mfma_f32_16x16x32_bf16 a[64:67], a[192:195], v[200:203], a[64:67]
v_exp_f32 v187, v187
v_mfma_f32_16x16x32_bf16 a[96:99], a[192:195], v[204:207], a[96:99]
buffer_store_dwordx4 v[164:167], v1, s[44:47], s70 offen offset:2048 sc1
v_mfma_f32_16x16x32_bf16 a[100:103], a[196:199], v[204:207], a[100:103]
v_exp_f32 v172, v172
v_mfma_f32_16x16x32_bf16 a[68:71], a[196:199], v[200:203], a[68:71]
ds_read_b128 a[228:231], v2 offset:9216
v_cvt_pk_bf16_f32 v219, v186, v187
v_mfma_f32_16x16x32_bf16 a[72:75], a[200:203], v[200:203], a[72:75]
v_exp_f32 v173, v173
v_mfma_f32_16x16x32_bf16 a[104:107], a[200:203], v[204:207], a[104:107]
ds_read_b128 a[232:235], v2 offset:10240
ds_read_b128 a[236:239], v2 offset:11264
v_mfma_f32_16x16x32_bf16 a[108:111], a[204:207], v[204:207], a[108:111]
v_exp_f32 v174, v174
v_mfma_f32_16x16x32_bf16 a[76:79], a[204:207], v[200:203], a[76:79]
buffer_load_dwordx4 v1, s[44:47], s72 offen offset:2048 sc1 lds
v_mfma_f32_16x16x32_bf16 a[80:83], a[208:211], v[200:203], a[80:83]
v_exp_f32 v175, v175
v_mfma_f32_16x16x32_bf16 a[112:115], a[208:211], v[204:207], a[112:115]
ds_read_b128 a[240:243], v2 offset:12288
ds_read_b128 a[244:247], v2 offset:13312
v_mfma_f32_16x16x32_bf16 a[116:119], a[212:215], v[204:207], a[116:119]
v_exp_f32 v188, v188
v_mfma_f32_16x16x32_bf16 a[84:87], a[212:215], v[200:203], a[84:87]
ds_read_b128 a[248:251], v2 offset:14336
ds_read_b128 a[252:255], v2 offset:15360
v_mfma_f32_16x16x32_bf16 a[88:91], a[216:219], v[200:203], a[88:91]
v_cvt_pk_bf16_f32 v220, v172, v173
v_cvt_pk_bf16_f32 v221, v174, v175
v_mfma_f32_16x16x32_bf16 a[120:123], a[216:219], v[204:207], a[120:123]
buffer_store_dwordx4 v[180:183], v1, s[44:47], s70 offen offset:3072 sc1
v_mfma_f32_16x16x32_bf16 a[124:127], a[220:223], v[204:207], a[124:127]
v_exp_f32 v189, v189
v_mfma_f32_16x16x32_bf16 a[92:95], a[220:223], v[200:203], a[92:95]
buffer_load_dwordx4 v1, s[44:47], s72 offen offset:3072 sc1 lds
v_mfma_f32_16x16x32_bf16 v[232:235], v[120:123], v[200:203], v[232:235]
s_waitcnt vmcnt(14) lgkmcnt(8)
v_exp_f32 v190, v190
v_mfma_f32_16x16x32_bf16 v[236:239], v[120:123], v[204:207], v[236:239]
s_barrier
v_exp_f32 v191, v191
v_add_u32 v2, s82, v1
v_cvt_pk_bf16_f32 v222, v188, v189
v_cvt_pk_bf16_f32 v223, v190, v191
s_lshl_b32 s83, s60, 2
s_sub_u32 s83, s83, 25
.p2align 5
s_nop 0
s_nop 0
LloopII:
v_mfma_f32_16x16x32_bf16 v[168:171], a[160:163], v[48:51], v[88:91]
s_xor_b32 s74, s82, 0x10000
v_exp_f32 v136, v136
v_mfma_f32_16x16x32_bf16 v[168:171], a[164:167], v[52:55], v[168:171]
s_add_u32 s74, s74, s64
ds_read_b128 a[128:131], v2 offset:16384
ds_read_b128 a[132:135], v2 offset:17408
v_mfma_f32_16x16x32_bf16 v[168:171], a[168:171], v[56:59], v[168:171]
s_add_u32 s81, s81, 0x8000
v_exp_f32 v137, v137
v_mfma_f32_16x16x32_bf16 v[168:171], a[172:175], v[60:63], v[168:171]
s_add_u32 m0, s74, 16384
v_exp_f32 v138, v138
v_mfma_f32_16x16x32_bf16 v[172:175], a[172:175], v[76:79], v[92:95]
s_add_u32 s72, s81, 16384
ds_read_b128 a[136:139], v2 offset:18432
v_cvt_pk_bf16_f32 v200, v136, v137
v_mfma_f32_16x16x32_bf16 v[172:175], a[168:171], v[72:75], v[172:175]
buffer_load_dwordx4 v1, s[44:47], s72 offen sc1 lds
v_mfma_f32_16x16x32_bf16 v[172:175], a[164:167], v[68:71], v[172:175]
v_exp_f32 v139, v139
v_mfma_f32_16x16x32_bf16 v[172:175], a[160:163], v[64:67], v[172:175]
ds_read_b128 a[140:143], v2 offset:19456
v_cvt_pk_bf16_f32 v201, v138, v139
v_mfma_f32_16x16x32_bf16 v[188:191], a[176:179], v[64:67], v[92:95]
v_exp_f32 v152, v152
v_mfma_f32_16x16x32_bf16 v[188:191], a[180:183], v[68:71], v[188:191]
ds_read_b128 a[144:147], v2 offset:20480
ds_read_b128 a[148:151], v2 offset:21504
v_mfma_f32_16x16x32_bf16 v[188:191], a[184:187], v[72:75], v[188:191]
v_exp_f32 v153, v153
v_mfma_f32_16x16x32_bf16 v[188:191], a[188:191], v[76:79], v[188:191]
v_exp_f32 v154, v154
v_mfma_f32_16x16x32_bf16 v[184:187], a[188:191], v[60:63], v[88:91]
ds_read_b128 a[152:155], v2 offset:22528
v_cvt_pk_bf16_f32 v202, v152, v153
v_mfma_f32_16x16x32_bf16 v[184:187], a[184:187], v[56:59], v[184:187]
buffer_load_dwordx4 v1, s[44:47], s72 offen offset:1024 sc1 lds
v_mfma_f32_16x16x32_bf16 v[184:187], a[180:183], v[52:55], v[184:187]
v_exp_f32 v155, v155
v_mfma_f32_16x16x32_bf16 v[184:187], a[176:179], v[48:51], v[184:187]
s_waitcnt lgkmcnt(7)
ds_read_b128 a[156:159], v2 offset:23552
v_cvt_pk_bf16_f32 v203, v154, v155
v_mfma_f32_16x16x32_bf16 a[64:67], a[224:227], v[216:219], a[64:67]
v_exp_f32 v140, v140
v_mfma_f32_16x16x32_bf16 a[96:99], a[224:227], v[220:223], a[96:99]
ds_read_b128 a[192:195], v2 offset:0
ds_read_b128 a[196:199], v2 offset:1024
v_mfma_f32_16x16x32_bf16 a[100:103], a[228:231], v[220:223], a[100:103]
v_exp_f32 v141, v141
v_mfma_f32_16x16x32_bf16 a[68:71], a[228:231], v[216:219], a[68:71]
v_exp_f32 v142, v142
v_mfma_f32_16x16x32_bf16 a[72:75], a[232:235], v[216:219], a[72:75]
ds_read_b128 a[200:203], v2 offset:2048
v_cvt_pk_bf16_f32 v204, v140, v141
v_mfma_f32_16x16x32_bf16 a[104:107], a[232:235], v[220:223], a[104:107]
buffer_load_dwordx4 v1, s[44:47], s72 offen offset:2048 sc1 lds
v_mfma_f32_16x16x32_bf16 a[108:111], a[236:239], v[220:223], a[108:111]
v_exp_f32 v143, v143
v_mfma_f32_16x16x32_bf16 a[76:79], a[236:239], v[216:219], a[76:79]
ds_read_b128 a[204:207], v2 offset:3072
v_cvt_pk_bf16_f32 v205, v142, v143
v_mfma_f32_16x16x32_bf16 a[80:83], a[240:243], v[216:219], a[80:83]
v_exp_f32 v156, v156
v_mfma_f32_16x16x32_bf16 a[112:115], a[240:243], v[220:223], a[112:115]
ds_read_b128 a[208:211], v2 offset:4096
v_mfma_f32_16x16x32_bf16 a[116:119], a[244:247], v[220:223], a[116:119]
v_exp_f32 v157, v157
v_mfma_f32_16x16x32_bf16 a[84:87], a[244:247], v[216:219], a[84:87]
ds_read_b128 a[212:215], v2 offset:5120
v_cvt_pk_bf16_f32 v206, v156, v157
v_mfma_f32_16x16x32_bf16 a[88:91], a[248:251], v[216:219], a[88:91]
v_exp_f32 v158, v158
v_mfma_f32_16x16x32_bf16 a[120:123], a[248:251], v[220:223], a[120:123]
ds_read_b128 a[216:219], v2 offset:6144
v_mfma_f32_16x16x32_bf16 a[124:127], a[252:255], v[220:223], a[124:127]
buffer_load_dwordx4 v1, s[44:47], s72 offen offset:3072 sc1 lds
v_mfma_f32_16x16x32_bf16 a[92:95], a[252:255], v[216:219], a[92:95]
v_exp_f32 v159, v159
v_mfma_f32_16x16x32_bf16 v[232:235], v[120:123], v[216:219], v[232:235]
ds_read_b128 a[220:223], v2 offset:7168
v_cvt_pk_bf16_f32 v207, v158, v159
v_mfma_f32_16x16x32_bf16 v[236:239], v[120:123], v[220:223], v[236:239]
s_waitcnt lgkmcnt(8)
v_mfma_f32_16x16x32_bf16 v[136:139], a[128:131], v[48:51], v[88:91]
s_add_u32 s82, s82, 0x8000
ds_read_b128 a[160:163], v2 offset:24576
ds_read_b128 a[164:167], v2 offset:25600
v_mfma_f32_16x16x32_bf16 v[136:139], a[132:135], v[52:55], v[136:139]
s_and_b32 s82, s82, 0x1ffff
v_exp_f32 v168, v168
v_mfma_f32_16x16x32_bf16 v[136:139], a[136:139], v[56:59], v[136:139]
s_add_u32 m0, s74, 0
v_exp_f32 v169, v169
v_mfma_f32_16x16x32_bf16 v[136:139], a[140:143], v[60:63], v[136:139]
s_add_u32 s72, s81, 0
ds_read_b128 a[168:171], v2 offset:26624
v_cvt_pk_bf16_f32 v216, v168, v169
v_mfma_f32_16x16x32_bf16 v[140:143], a[140:143], v[76:79], v[92:95]
v_exp_f32 v170, v170
v_mfma_f32_16x16x32_bf16 v[140:143], a[136:139], v[72:75], v[140:143]
buffer_load_dwordx4 v1, s[44:47], s72 offen sc1 lds
v_mfma_f32_16x16x32_bf16 v[140:143], a[132:135], v[68:71], v[140:143]
ds_read_b128 a[172:175], v2 offset:27648
ds_read_b128 a[176:179], v2 offset:28672
v_mfma_f32_16x16x32_bf16 v[140:143], a[128:131], v[64:67], v[140:143]
v_exp_f32 v171, v171
v_mfma_f32_16x16x32_bf16 v[156:159], a[144:147], v[64:67], v[92:95]
v_exp_f32 v184, v184
v_mfma_f32_16x16x32_bf16 v[156:159], a[148:151], v[68:71], v[156:159]
ds_read_b128 a[180:183], v2 offset:29696
v_cvt_pk_bf16_f32 v217, v170, v171
v_mfma_f32_16x16x32_bf16 v[156:159], a[152:155], v[72:75], v[156:159]
v_exp_f32 v185, v185
v_mfma_f32_16x16x32_bf16 v[156:159], a[156:159], v[76:79], v[156:159]
ds_read_b128 a[184:187], v2 offset:30720
v_cvt_pk_bf16_f32 v218, v184, v185
v_mfma_f32_16x16x32_bf16 v[152:155], a[156:159], v[60:63], v[88:91]
buffer_load_dwordx4 v1, s[44:47], s72 offen offset:1024 sc1 lds
v_mfma_f32_16x16x32_bf16 v[152:155], a[152:155], v[56:59], v[152:155]
v_exp_f32 v186, v186
v_mfma_f32_16x16x32_bf16 v[152:155], a[148:151], v[52:55], v[152:155]
ds_read_b128 a[188:191], v2 offset:31744
ds_read_b128 a[224:227], v2 offset:8192
v_mfma_f32_16x16x32_bf16 v[152:155], a[144:147], v[48:51], v[152:155]
s_waitcnt lgkmcnt(9)
v_exp_f32 v187, v187
v_mfma_f32_16x16x32_bf16 a[64:67], a[192:195], v[200:203], a[64:67]
v_exp_f32 v172, v172
v_mfma_f32_16x16x32_bf16 a[96:99], a[192:195], v[204:207], a[96:99]
ds_read_b128 a[228:231], v2 offset:9216
v_cvt_pk_bf16_f32 v219, v186, v187
v_mfma_f32_16x16x32_bf16 a[100:103], a[196:199], v[204:207], a[100:103]
v_exp_f32 v173, v173
v_mfma_f32_16x16x32_bf16 a[68:71], a[196:199], v[200:203], a[68:71]
ds_read_b128 a[232:235], v2 offset:10240
v_cvt_pk_bf16_f32 v220, v172, v173
v_mfma_f32_16x16x32_bf16 a[72:75], a[200:203], v[200:203], a[72:75]
buffer_load_dwordx4 v1, s[44:47], s72 offen offset:2048 sc1 lds
v_mfma_f32_16x16x32_bf16 a[104:107], a[200:203], v[204:207], a[104:107]
v_exp_f32 v174, v174
v_mfma_f32_16x16x32_bf16 a[108:111], a[204:207], v[204:207], a[108:111]
ds_read_b128 a[236:239], v2 offset:11264
ds_read_b128 a[240:243], v2 offset:12288
v_mfma_f32_16x16x32_bf16 a[76:79], a[204:207], v[200:203], a[76:79]
v_exp_f32 v175, v175
v_mfma_f32_16x16x32_bf16 a[80:83], a[208:211], v[200:203], a[80:83]
v_exp_f32 v188, v188
v_mfma_f32_16x16x32_bf16 a[112:115], a[208:211], v[204:207], a[112:115]
ds_read_b128 a[244:247], v2 offset:13312
v_cvt_pk_bf16_f32 v221, v174, v175
v_mfma_f32_16x16x32_bf16 a[116:119], a[212:215], v[204:207], a[116:119]
v_exp_f32 v189, v189
v_mfma_f32_16x16x32_bf16 a[84:87], a[212:215], v[200:203], a[84:87]
ds_read_b128 a[248:251], v2 offset:14336
v_cvt_pk_bf16_f32 v222, v188, v189
v_mfma_f32_16x16x32_bf16 a[88:91], a[216:219], v[200:203], a[88:91]
buffer_load_dwordx4 v1, s[44:47], s72 offen offset:3072 sc1 lds
v_mfma_f32_16x16x32_bf16 a[120:123], a[216:219], v[204:207], a[120:123]
ds_read_b128 a[252:255], v2 offset:15360
v_add_u32 v2, s82, v1
v_mfma_f32_16x16x32_bf16 a[124:127], a[220:223], v[204:207], a[124:127]
s_waitcnt vmcnt(8) lgkmcnt(8)
v_exp_f32 v190, v190
v_mfma_f32_16x16x32_bf16 a[92:95], a[220:223], v[200:203], a[92:95]
s_barrier
v_exp_f32 v191, v191
v_mfma_f32_16x16x32_bf16 v[232:235], v[120:123], v[200:203], v[232:235]
s_add_u32 s83, s83, 1
v_cvt_pk_bf16_f32 v223, v190, v191
v_mfma_f32_16x16x32_bf16 v[236:239], v[120:123], v[204:207], v[236:239]
s_cbranch_scc0 LloopII
v_mfma_f32_16x16x32_bf16 v[168:171], a[160:163], v[48:51], v[88:91]
s_xor_b32 s74, s82, 0x10000
ds_read_b128 a[128:131], v2 offset:16384
ds_read_b128 a[132:135], v2 offset:17408
v_mfma_f32_16x16x32_bf16 v[168:171], a[164:167], v[52:55], v[168:171]
s_add_u32 s74, s74, s64
v_exp_f32 v136, v136
v_mfma_f32_16x16x32_bf16 v[168:171], a[168:171], v[56:59], v[168:171]
s_add_u32 s81, s81, 0x8000
v_exp_f32 v137, v137
v_mfma_f32_16x16x32_bf16 v[168:171], a[172:175], v[60:63], v[168:171]
s_add_u32 m0, s74, 0
ds_read_b128 a[136:139], v2 offset:18432
v_cvt_pk_bf16_f32 v200, v136, v137
v_mfma_f32_16x16x32_bf16 v[172:175], a[172:175], v[76:79], v[92:95]
s_add_u32 s72, s81, 0
v_exp_f32 v138, v138
v_mfma_f32_16x16x32_bf16 v[172:175], a[168:171], v[72:75], v[172:175]
buffer_load_dwordx4 v1, s[44:47], s72 offen sc1 lds
v_mfma_f32_16x16x32_bf16 v[172:175], a[164:167], v[68:71], v[172:175]
ds_read_b128 a[140:143], v2 offset:19456
ds_read_b128 a[144:147], v2 offset:20480
v_mfma_f32_16x16x32_bf16 v[172:175], a[160:163], v[64:67], v[172:175]
v_exp_f32 v139, v139
v_mfma_f32_16x16x32_bf16 v[188:191], a[176:179], v[64:67], v[92:95]
v_exp_f32 v152, v152
v_mfma_f32_16x16x32_bf16 v[188:191], a[180:183], v[68:71], v[188:191]
ds_read_b128 a[148:151], v2 offset:21504
v_cvt_pk_bf16_f32 v201, v138, v139
v_mfma_f32_16x16x32_bf16 v[188:191], a[184:187], v[72:75], v[188:191]
v_exp_f32 v153, v153
v_mfma_f32_16x16x32_bf16 v[188:191], a[188:191], v[76:79], v[188:191]
ds_read_b128 a[152:155], v2 offset:22528
v_cvt_pk_bf16_f32 v202, v152, v153
v_mfma_f32_16x16x32_bf16 v[184:187], a[188:191], v[60:63], v[88:91]
v_exp_f32 v154, v154
v_mfma_f32_16x16x32_bf16 v[184:187], a[184:187], v[56:59], v[184:187]
buffer_load_dwordx4 v1, s[44:47], s72 offen offset:1024 sc1 lds
v_mfma_f32_16x16x32_bf16 v[184:187], a[180:183], v[52:55], v[184:187]
ds_read_b128 a[156:159], v2 offset:23552
ds_read_b128 a[192:195], v2 offset:0
v_mfma_f32_16x16x32_bf16 v[184:187], a[176:179], v[48:51], v[184:187]
s_waitcnt lgkmcnt(9)
v_exp_f32 v155, v155
v_mfma_f32_16x16x32_bf16 a[64:67], a[224:227], v[216:219], a[64:67]
v_exp_f32 v140, v140
v_mfma_f32_16x16x32_bf16 a[96:99], a[224:227], v[220:223], a[96:99]
ds_read_b128 a[196:199], v2 offset:1024
v_cvt_pk_bf16_f32 v203, v154, v155
v_mfma_f32_16x16x32_bf16 a[100:103], a[228:231], v[220:223], a[100:103]
v_exp_f32 v141, v141
v_mfma_f32_16x16x32_bf16 a[68:71], a[228:231], v[216:219], a[68:71]
ds_read_b128 a[200:203], v2 offset:2048
v_cvt_pk_bf16_f32 v204, v140, v141
v_mfma_f32_16x16x32_bf16 a[72:75], a[232:235], v[216:219], a[72:75]
v_exp_f32 v142, v142
v_mfma_f32_16x16x32_bf16 a[104:107], a[232:235], v[220:223], a[104:107]
buffer_load_dwordx4 v1, s[44:47], s72 offen offset:2048 sc1 lds
v_mfma_f32_16x16x32_bf16 a[108:111], a[236:239], v[220:223], a[108:111]
ds_read_b128 a[204:207], v2 offset:3072
v_mfma_f32_16x16x32_bf16 a[76:79], a[236:239], v[216:219], a[76:79]
v_exp_f32 v143, v143
v_mfma_f32_16x16x32_bf16 a[80:83], a[240:243], v[216:219], a[80:83]
ds_read_b128 a[208:211], v2 offset:4096
v_cvt_pk_bf16_f32 v205, v142, v143
v_mfma_f32_16x16x32_bf16 a[112:115], a[240:243], v[220:223], a[112:115]
v_exp_f32 v156, v156
v_mfma_f32_16x16x32_bf16 a[116:119], a[244:247], v[220:223], a[116:119]
ds_read_b128 a[212:215], v2 offset:5120
v_mfma_f32_16x16x32_bf16 a[84:87], a[244:247], v[216:219], a[84:87]
v_exp_f32 v157, v157
v_mfma_f32_16x16x32_bf16 a[88:91], a[248:251], v[216:219], a[88:91]
ds_read_b128 a[216:219], v2 offset:6144
v_cvt_pk_bf16_f32 v206, v156, v157
v_mfma_f32_16x16x32_bf16 a[120:123], a[248:251], v[220:223], a[120:123]
buffer_load_dwordx4 v1, s[44:47], s72 offen offset:3072 sc1 lds
v_mfma_f32_16x16x32_bf16 a[124:127], a[252:255], v[220:223], a[124:127]
v_exp_f32 v158, v158
v_mfma_f32_16x16x32_bf16 a[92:95], a[252:255], v[216:219], a[92:95]
ds_read_b128 a[220:223], v2 offset:7168
v_mfma_f32_16x16x32_bf16 v[232:235], v[120:123], v[216:219], v[232:235]
s_waitcnt lgkmcnt(8)
v_exp_f32 v159, v159
v_mfma_f32_16x16x32_bf16 v[236:239], v[120:123], v[220:223], v[236:239]
s_barrier
v_cvt_pk_bf16_f32 v207, v158, v159
s_lshr_b32 s69, s93, 4
s_and_b32 s69, s69, 0x7f00
s_add_u32 s69, s69, LHT4-Lpc0
v_lshrrev_b32 v3, 5, v0
v_lshlrev_b32 v3, 7, v3
v_add_u32 v3, s69, v3
v_min_u32 v3, Lcode_end-Lpc0, v3
global_load_dword v4, v3, s[98:99]
s_cmp_eq_u32 s58, 0
s_cbranch_scc1 Lta28
s_cmp_eq_u32 s58, 1
s_cbranch_scc1 Lnt29
v_mfma_f32_16x16x32_bf16 v[136:139], a[128:131], v[48:51], v[88:91]
s_add_u32 s82, s82, 0x8000
ds_read_b128 a[160:163], v2 offset:24576
ds_read_b128 a[164:167], v2 offset:25600
v_mfma_f32_16x16x32_bf16 v[152:155], a[144:147], v[48:51], v[88:91]
s_and_b32 s82, s82, 0x1ffff
v_exp_f32 v168, v168
s_branch Ljoin30
Lta28:
v_mfma_f32_16x16x32_bf16 v[136:139], a[128:131], v[48:51], v[104:107]
s_add_u32 s82, s82, 0x8000
ds_read_b128 a[160:163], v2 offset:24576
ds_read_b128 a[164:167], v2 offset:25600
v_mfma_f32_16x16x32_bf16 v[152:155], a[144:147], v[48:51], v[112:115]
s_and_b32 s82, s82, 0x1ffff
v_exp_f32 v168, v168
s_branch Ljoin30
Lnt29:
v_mfma_f32_16x16x32_bf16 v[136:139], a[128:131], v[48:51], v[88:91]
s_add_u32 s82, s82, 0x8000
ds_read_b128 a[160:163], v2 offset:24576
ds_read_b128 a[164:167], v2 offset:25600
v_mfma_f32_16x16x32_bf16 v[152:155], a[144:147], v[48:51], v[104:107]
s_and_b32 s82, s82, 0x1ffff
v_exp_f32 v168, v168
Ljoin30:
v_mfma_f32_16x16x32_bf16 v[136:139], a[132:135], v[52:55], v[136:139]
s_add_u32 s66, s58, 3
v_exp_f32 v169, v169
v_mfma_f32_16x16x32_bf16 v[136:139], a[136:139], v[56:59], v[136:139]
s_and_b32 s66, s66, 3
ds_read_b128 a[168:171], v2 offset:26624
v_cvt_pk_bf16_f32 v216, v168, v169
v_mfma_f32_16x16x32_bf16 v[136:139], a[140:143], v[60:63], v[136:139]
s_mul_i32 s66, s66, 4160
v_exp_f32 v170, v170
v_mfma_f32_16x16x32_bf16 v[140:143], a[140:143], v[76:79], v[92:95]
s_add_u32 s66, s66, s92
ds_read_b128 a[172:175], v2 offset:27648
ds_read_b128 a[176:179], v2 offset:28672
v_mfma_f32_16x16x32_bf16 v[140:143], a[136:139], v[72:75], v[140:143]
s_add_u32 m0, s66, 32
v_exp_f32 v171, v171
v_mfma_f32_16x16x32_bf16 v[140:143], a[132:135], v[68:71], v[140:143]
s_add_u32 s72, s93, 0x6
buffer_load_dwordx4 v1, s[36:39], s72 offen lds
v_mfma_f32_16x16x32_bf16 v[140:143], a[128:131], v[64:67], v[140:143]
v_exp_f32 v184, v184
v_mfma_f32_16x16x32_bf16 v[156:159], a[144:147], v[64:67], v[92:95]
ds_read_b128 a[180:183], v2 offset:29696
v_cvt_pk_bf16_f32 v217, v170, v171
v_mfma_f32_16x16x32_bf16 v[156:159], a[148:151], v[68:71], v[156:159]
v_exp_f32 v185, v185
v_mfma_f32_16x16x32_bf16 v[156:159], a[152:155], v[72:75], v[156:159]
ds_read_b128 a[184:187], v2 offset:30720
v_cvt_pk_bf16_f32 v218, v184, v185
v_mfma_f32_16x16x32_bf16 v[156:159], a[156:159], v[76:79], v[156:159]
v_exp_f32 v186, v186
v_mfma_f32_16x16x32_bf16 v[152:155], a[156:159], v[60:63], v[152:155]
buffer_load_dwordx4 v1, s[36:39], s72 offen offset:1024 lds
v_mfma_f32_16x16x32_bf16 v[152:155], a[152:155], v[56:59], v[152:155]
ds_read_b128 a[188:191], v2 offset:31744
ds_read_b128 a[224:227], v2 offset:8192
v_mfma_f32_16x16x32_bf16 v[152:155], a[148:151], v[52:55], v[152:155]
s_waitcnt lgkmcnt(9)
v_exp_f32 v187, v187
v_mfma_f32_16x16x32_bf16 a[64:67], a[192:195], v[200:203], a[64:67]
v_exp_f32 v172, v172
v_mfma_f32_16x16x32_bf16 a[96:99], a[192:195], v[204:207], a[96:99]
ds_read_b128 a[228:231], v2 offset:9216
v_cvt_pk_bf16_f32 v219, v186, v187
v_mfma_f32_16x16x32_bf16 a[100:103], a[196:199], v[204:207], a[100:103]
v_exp_f32 v173, v173
v_mfma_f32_16x16x32_bf16 a[68:71], a[196:199], v[200:203], a[68:71]
ds_read_b128 a[232:235], v2 offset:10240
v_cvt_pk_bf16_f32 v220, v172, v173
v_mfma_f32_16x16x32_bf16 a[72:75], a[200:203], v[200:203], a[72:75]
v_exp_f32 v174, v174
v_mfma_f32_16x16x32_bf16 a[104:107], a[200:203], v[204:207], a[104:107]
buffer_load_dwordx4 v1, s[36:39], s72 offen offset:2048 lds
v_mfma_f32_16x16x32_bf16 a[108:111], a[204:207], v[204:207], a[108:111]
ds_read_b128 a[236:239], v2 offset:11264
v_mfma_f32_16x16x32_bf16 a[76:79], a[204:207], v[200:203], a[76:79]
v_exp_f32 v175, v175
v_mfma_f32_16x16x32_bf16 a[80:83], a[208:211], v[200:203], a[80:83]
ds_read_b128 a[240:243], v2 offset:12288
v_cvt_pk_bf16_f32 v221, v174, v175
v_mfma_f32_16x16x32_bf16 a[112:115], a[208:211], v[204:207], a[112:115]
v_exp_f32 v188, v188
v_mfma_f32_16x16x32_bf16 a[116:119], a[212:215], v[204:207], a[116:119]
ds_read_b128 a[244:247], v2 offset:13312
v_mfma_f32_16x16x32_bf16 a[84:87], a[212:215], v[200:203], a[84:87]
v_exp_f32 v189, v189
v_mfma_f32_16x16x32_bf16 a[88:91], a[216:219], v[200:203], a[88:91]
ds_read_b128 a[248:251], v2 offset:14336
v_cvt_pk_bf16_f32 v222, v188, v189
v_mfma_f32_16x16x32_bf16 a[120:123], a[216:219], v[204:207], a[120:123]
buffer_load_dwordx4 v1, s[36:39], s72 offen offset:3072 lds
v_mfma_f32_16x16x32_bf16 a[124:127], a[220:223], v[204:207], a[124:127]
v_exp_f32 v190, v190
v_mfma_f32_16x16x32_bf16 a[92:95], a[220:223], v[200:203], a[92:95]
ds_read_b128 a[252:255], v2 offset:15360
v_add_u32 v2, s82, v1
v_mfma_f32_16x16x32_bf16 v[232:235], v[120:123], v[200:203], v[232:235]
s_waitcnt vmcnt(9) lgkmcnt(0)
v_exp_f32 v191, v191
v_mfma_f32_16x16x32_bf16 v[236:239], v[120:123], v[204:207], v[236:239]
s_barrier
v_cvt_pk_bf16_f32 v223, v190, v191
s_cmp_eq_u32 s58, 2
s_cbranch_scc1 Lta31
s_cmp_eq_u32 s58, 3
s_cbranch_scc1 Lnt32
v_mfma_f32_16x16x32_bf16 v[168:171], a[160:163], v[48:51], v[112:115]
s_mov_b32 m0, s62
v_exp_f32 v136, v136
v_mfma_f32_16x16x32_bf16 v[184:187], a[176:179], v[48:51], v[112:115]
s_add_u32 s72, s93, 0x3000000
ds_read_b128 a[128:131], v2 offset:16384
ds_read_b128 a[132:135], v2 offset:17408
s_branch Ljoin33
Lta31:
v_mfma_f32_16x16x32_bf16 v[168:171], a[160:163], v[48:51], v[104:107]
s_mov_b32 m0, s62
v_exp_f32 v136, v136
v_mfma_f32_16x16x32_bf16 v[184:187], a[176:179], v[48:51], v[112:115]
s_add_u32 s72, s93, 0x3000000
ds_read_b128 a[128:131], v2 offset:16384
ds_read_b128 a[132:135], v2 offset:17408
s_branch Ljoin33
Lnt32:
v_mfma_f32_16x16x32_bf16 v[168:171], a[160:163], v[48:51], v[88:91]
s_mov_b32 m0, s62
v_exp_f32 v136, v136
v_mfma_f32_16x16x32_bf16 v[184:187], a[176:179], v[48:51], v[104:107]
s_add_u32 s72, s93, 0x3000000
ds_read_b128 a[128:131], v2 offset:16384
ds_read_b128 a[132:135], v2 offset:17408
Ljoin33:
v_mfma_f32_16x16x32_bf16 v[168:171], a[164:167], v[52:55], v[168:171]
v_exp_f32 v137, v137
v_mfma_f32_16x16x32_bf16 v[168:171], a[168:171], v[56:59], v[168:171]
buffer_load_dwordx4 v1, s[44:47], s72 offen sc1 lds
v_mfma_f32_16x16x32_bf16 v[168:171], a[172:175], v[60:63], v[168:171]
s_add_u32 s78, s59, 4
v_exp_f32 v138, v138
v_mfma_f32_16x16x32_bf16 v[172:175], a[172:175], v[76:79], v[92:95]
s_and_b32 s78, s78, 28
ds_read_b128 a[136:139], v2 offset:18432
v_cvt_pk_bf16_f32 v200, v136, v137
v_mfma_f32_16x16x32_bf16 v[172:175], a[168:171], v[72:75], v[172:175]
s_add_u32 s12, s61, 0
v_exp_f32 v139, v139
v_mfma_f32_16x16x32_bf16 v[172:175], a[164:167], v[68:71], v[172:175]
s_and_b32 s12, s12, 3
ds_read_b128 a[140:143], v2 offset:19456
v_cvt_pk_bf16_f32 v201, v138, v139
v_mfma_f32_16x16x32_bf16 v[172:175], a[160:163], v[64:67], v[172:175]
s_add_u32 s12, s12, s78
v_exp_f32 v152, v152
v_mfma_f32_16x16x32_bf16 v[188:191], a[176:179], v[64:67], v[92:95]
s_lshl_b32 s12, s12, 18
ds_read_b128 a[144:147], v2 offset:20480
ds_read_b128 a[148:151], v2 offset:21504
v_mfma_f32_16x16x32_bf16 v[188:191], a[180:183], v[68:71], v[188:191]
Lstub6:
s_cbranch_execz Lstub10
s_add_u32 s13, s61, 1
buffer_load_dwordx4 v1, s[44:47], s72 offen offset:1024 sc1 lds
v_mfma_f32_16x16x32_bf16 v[188:191], a[184:187], v[72:75], v[188:191]
s_and_b32 s13, s13, 3
v_exp_f32 v153, v153
v_mfma_f32_16x16x32_bf16 v[188:191], a[188:191], v[76:79], v[188:191]
s_add_u32 s13, s13, s78
v_exp_f32 v154, v154
v_mfma_f32_16x16x32_bf16 v[184:187], a[188:191], v[60:63], v[184:187]
s_lshl_b32 s13, s13, 18
ds_read_b128 a[152:155], v2 offset:22528
v_cvt_pk_bf16_f32 v202, v152, v153
v_mfma_f32_16x16x32_bf16 v[184:187], a[184:187], v[56:59], v[184:187]
s_add_u32 s14, s61, 2
buffer_load_dwordx4 v1, s[44:47], s72 offen offset:2048 sc1 lds
v_mfma_f32_16x16x32_bf16 v[184:187], a[180:183], v[52:55], v[184:187]
s_waitcnt lgkmcnt(7)
v_exp_f32 v155, v155
v_mfma_f32_16x16x32_bf16 a[64:67], a[224:227], v[216:219], a[64:67]
s_and_b32 s14, s14, 3
ds_read_b128 a[156:159], v2 offset:23552
v_cvt_pk_bf16_f32 v203, v154, v155
v_mfma_f32_16x16x32_bf16 a[96:99], a[224:227], v[220:223], a[96:99]
s_add_u32 s14, s14, s78
v_exp_f32 v140, v140
v_mfma_f32_16x16x32_bf16 a[100:103], a[228:231], v[220:223], a[100:103]
s_lshl_b32 s14, s14, 18
ds_read_b128 a[192:195], v2 offset:0
ds_read_b128 a[196:199], v2 offset:1024
v_mfma_f32_16x16x32_bf16 a[68:71], a[228:231], v[216:219], a[68:71]
s_add_u32 s15, s61, 3
v_exp_f32 v141, v141
v_mfma_f32_16x16x32_bf16 a[72:75], a[232:235], v[216:219], a[72:75]
s_and_b32 s15, s15, 3
buffer_load_dwordx4 v1, s[44:47], s72 offen offset:3072 sc1 lds
v_mfma_f32_16x16x32_bf16 a[104:107], a[232:235], v[220:223], a[104:107]
s_add_u32 s66, s58, 0
v_exp_f32 v142, v142
v_mfma_f32_16x16x32_bf16 a[108:111], a[236:239], v[220:223], a[108:111]
s_and_b32 s66, s66, 3
ds_read_b128 a[200:203], v2 offset:2048
v_cvt_pk_bf16_f32 v204, v140, v141
v_mfma_f32_16x16x32_bf16 a[76:79], a[236:239], v[216:219], a[76:79]
s_mul_i32 s66, s66, 4160
v_exp_f32 v143, v143
v_mfma_f32_16x16x32_bf16 a[80:83], a[240:243], v[216:219], a[80:83]
s_add_u32 s66, s66, s92
ds_read_b128 a[204:207], v2 offset:3072
v_cvt_pk_bf16_f32 v205, v142, v143
v_mfma_f32_16x16x32_bf16 a[112:115], a[240:243], v[220:223], a[112:115]
s_add_u32 m0, s66, 16672
v_exp_f32 v156, v156
v_mfma_f32_16x16x32_bf16 a[116:119], a[244:247], v[220:223], a[116:119]
s_add_u32 s72, s93, 0x0
ds_read_b128 a[208:211], v2 offset:4096
ds_read_b128 a[212:215], v2 offset:5120
v_mfma_f32_16x16x32_bf16 a[84:87], a[244:247], v[216:219], a[84:87]
s_add_u32 s15, s15, s78
buffer_load_dwordx4 v1, s[36:39], s72 offen lds
v_mfma_f32_16x16x32_bf16 a[88:91], a[248:251], v[216:219], a[88:91]
s_lshl_b32 s15, s15, 18
v_exp_f32 v157, v157
v_mfma_f32_16x16x32_bf16 a[120:123], a[248:251], v[220:223], a[120:123]
s_xor_b32 s78, s94, 0x80
v_exp_f32 v158, v158
v_mfma_f32_16x16x32_bf16 a[124:127], a[252:255], v[220:223], a[124:127]
ds_read_b128 a[216:219], v2 offset:6144
ds_read_b128 a[220:223], v2 offset:7168
v_mfma_f32_16x16x32_bf16 a[92:95], a[252:255], v[216:219], a[92:95]
buffer_load_dwordx4 v1, s[36:39], s72 offen offset:1024 lds
v_mfma_f32_16x16x32_bf16 v[232:235], v[120:123], v[216:219], v[232:235]
v_exp_f32 v159, v159
v_mfma_f32_16x16x32_bf16 v[236:239], v[120:123], v[220:223], v[236:239]
s_waitcnt lgkmcnt(8)
v_cvt_pk_bf16_f32 v206, v156, v157
v_cvt_pk_bf16_f32 v207, v158, v159
s_cmp_eq_u32 s58, 0
s_cbranch_scc1 Lta34
s_cmp_eq_u32 s58, 1
s_cbranch_scc1 Lnt35
v_mfma_f32_16x16x32_bf16 v[140:143], a[128:131], v[64:67], v[92:95]
s_add_u32 s82, s82, 0x8000
ds_read_b128 a[160:163], v2 offset:24576
ds_read_b128 a[164:167], v2 offset:25600
v_mfma_f32_16x16x32_bf16 v[156:159], a[144:147], v[64:67], v[92:95]
s_and_b32 s82, s82, 0x1ffff
v_exp_f32 v168, v168
s_branch Ljoin36
Lta34:
v_mfma_f32_16x16x32_bf16 v[140:143], a[128:131], v[64:67], v[108:111]
s_add_u32 s82, s82, 0x8000
ds_read_b128 a[160:163], v2 offset:24576
ds_read_b128 a[164:167], v2 offset:25600
v_mfma_f32_16x16x32_bf16 v[156:159], a[144:147], v[64:67], v[112:115]
s_and_b32 s82, s82, 0x1ffff
v_exp_f32 v168, v168
s_branch Ljoin36
Lnt35:
v_mfma_f32_16x16x32_bf16 v[140:143], a[128:131], v[64:67], v[92:95]
s_add_u32 s82, s82, 0x8000
ds_read_b128 a[160:163], v2 offset:24576
ds_read_b128 a[164:167], v2 offset:25600
v_mfma_f32_16x16x32_bf16 v[156:159], a[144:147], v[64:67], v[108:111]
s_and_b32 s82, s82, 0x1ffff
v_exp_f32 v168, v168
Ljoin36:
v_mfma_f32_16x16x32_bf16 v[140:143], a[132:135], v[68:71], v[140:143]
v_exp_f32 v169, v169
v_mfma_f32_16x16x32_bf16 v[140:143], a[136:139], v[72:75], v[140:143]
ds_read_b128 a[168:171], v2 offset:26624
ds_read_b128 a[172:175], v2 offset:27648
v_mfma_f32_16x16x32_bf16 v[140:143], a[140:143], v[76:79], v[140:143]
v_exp_f32 v170, v170
v_mfma_f32_16x16x32_bf16 v[156:159], a[156:159], v[76:79], v[156:159]
v_exp_f32 v171, v171
v_mfma_f32_16x16x32_bf16 v[156:159], a[152:155], v[72:75], v[156:159]
ds_read_b128 a[176:179], v2 offset:28672
ds_read_b128 a[180:183], v2 offset:29696
v_mfma_f32_16x16x32_bf16 v[156:159], a[148:151], v[68:71], v[156:159]
s_waitcnt lgkmcnt(6)
v_exp_f32 v184, v184
v_mfma_f32_16x16x32_bf16 a[64:67], a[192:195], v[200:203], a[64:67]
ds_read_b128 a[184:187], v2 offset:30720
ds_read_b128 a[188:191], v2 offset:31744
v_mfma_f32_16x16x32_bf16 a[96:99], a[192:195], v[204:207], a[96:99]
ds_read_b128 a[224:227], v2 offset:8192
ds_read_b128 a[228:231], v2 offset:9216
v_mfma_f32_16x16x32_bf16 a[100:103], a[196:199], v[204:207], a[100:103]
ds_read_b128 a[232:235], v2 offset:10240
ds_read_b128 a[236:239], v2 offset:11264
v_mfma_f32_16x16x32_bf16 a[68:71], a[196:199], v[200:203], a[68:71]
ds_read_b128 a[240:243], v2 offset:12288
ds_read_b128 a[244:247], v2 offset:13312
v_mfma_f32_16x16x32_bf16 a[72:75], a[200:203], v[200:203], a[72:75]
ds_read_b128 a[248:251], v2 offset:14336
ds_read_b128 a[252:255], v2 offset:15360
v_mfma_f32_16x16x32_bf16 a[104:107], a[200:203], v[204:207], a[104:107]
v_cvt_pk_bf16_f32 v216, v168, v169
v_cvt_pk_bf16_f32 v217, v170, v171
v_mfma_f32_16x16x32_bf16 a[108:111], a[204:207], v[204:207], a[108:111]
buffer_load_dwordx4 v1, s[36:39], s72 offen offset:2048 lds
v_mfma_f32_16x16x32_bf16 a[76:79], a[204:207], v[200:203], a[76:79]
v_exp_f32 v185, v185
v_mfma_f32_16x16x32_bf16 a[80:83], a[208:211], v[200:203], a[80:83]
v_exp_f32 v186, v186
v_mfma_f32_16x16x32_bf16 a[112:115], a[208:211], v[204:207], a[112:115]
v_exp_f32 v187, v187
v_mfma_f32_16x16x32_bf16 a[116:119], a[212:215], v[204:207], a[116:119]
v_exp_f32 v172, v172
v_mfma_f32_16x16x32_bf16 a[84:87], a[212:215], v[200:203], a[84:87]
v_cvt_pk_bf16_f32 v218, v184, v185
v_cvt_pk_bf16_f32 v219, v186, v187
v_mfma_f32_16x16x32_bf16 a[88:91], a[216:219], v[200:203], a[88:91]
v_exp_f32 v173, v173
v_mfma_f32_16x16x32_bf16 a[120:123], a[216:219], v[204:207], a[120:123]
v_exp_f32 v174, v174
v_mfma_f32_16x16x32_bf16 a[124:127], a[220:223], v[204:207], a[124:127]
v_exp_f32 v175, v175
v_mfma_f32_16x16x32_bf16 a[92:95], a[220:223], v[200:203], a[92:95]
buffer_load_dwordx4 v1, s[36:39], s72 offen offset:3072 lds
v_mfma_f32_16x16x32_bf16 v[232:235], v[120:123], v[200:203], v[232:235]
s_waitcnt vmcnt(13) lgkmcnt(8)
v_exp_f32 v188, v188
v_mfma_f32_16x16x32_bf16 v[236:239], v[120:123], v[204:207], v[236:239]
s_barrier
v_cvt_pk_bf16_f32 v220, v172, v173
v_cvt_pk_bf16_f32 v221, v174, v175
v_add_u32 v2, s82, v1
v_exp_f32 v189, v189
v_exp_f32 v190, v190
v_cvt_pk_bf16_f32 v222, v188, v189
v_exp_f32 v191, v191
s_nop 0
v_cvt_pk_bf16_f32 v223, v190, v191
s_cmp_eq_u32 s58, 2
s_cbranch_scc1 Lta37
s_cmp_eq_u32 s58, 3
s_cbranch_scc1 Lnt38
v_mfma_f32_16x16x32_bf16 v[172:175], a[160:163], v[64:67], v[112:115]
s_add_u32 s66, s58, 2
v_exp_f32 v140, v140
v_mfma_f32_16x16x32_bf16 v[188:191], a[176:179], v[64:67], v[112:115]
s_and_b32 s66, s66, 3
ds_read_b128 a[192:195], v2 offset:0
s_branch Ljoin39
Lta37:
v_mfma_f32_16x16x32_bf16 v[172:175], a[160:163], v[64:67], v[108:111]
s_add_u32 s66, s58, 2
v_exp_f32 v140, v140
v_mfma_f32_16x16x32_bf16 v[188:191], a[176:179], v[64:67], v[112:115]
s_and_b32 s66, s66, 3
ds_read_b128 a[192:195], v2 offset:0
s_branch Ljoin39
Lnt38:
v_mfma_f32_16x16x32_bf16 v[172:175], a[160:163], v[64:67], v[92:95]
s_add_u32 s66, s58, 2
v_exp_f32 v140, v140
v_mfma_f32_16x16x32_bf16 v[188:191], a[176:179], v[64:67], v[108:111]
s_and_b32 s66, s66, 3
ds_read_b128 a[192:195], v2 offset:0
Ljoin39:
v_mfma_f32_16x16x32_bf16 v[172:175], a[164:167], v[68:71], v[172:175]
s_mul_i32 s66, s66, 4160
v_exp_f32 v141, v141
v_mfma_f32_16x16x32_bf16 v[172:175], a[168:171], v[72:75], v[172:175]
s_add_u32 s66, s66, s92
ds_read_b128 a[196:199], v2 offset:1024
v_cvt_pk_bf16_f32 v204, v140, v141
v_mfma_f32_16x16x32_bf16 v[172:175], a[172:175], v[76:79], v[172:175]
s_add_u32 m0, s66, 33312
v_exp_f32 v142, v142
v_mfma_f32_16x16x32_bf16 v[188:191], a[188:191], v[76:79], v[188:191]
s_add_u32 s72, s93, 0x4
buffer_load_dwordx4 v1, s[36:39], s72 offen lds
v_mfma_f32_16x16x32_bf16 v[188:191], a[184:187], v[72:75], v[188:191]
buffer_load_dwordx4 v1, s[36:39], s72 offen offset:1024 lds
v_mfma_f32_16x16x32_bf16 v[188:191], a[180:183], v[68:71], v[188:191]
s_waitcnt lgkmcnt(2)
ds_read_b128 a[200:203], v2 offset:2048
v_mfma_f32_16x16x32_bf16 a[64:67], a[224:227], v[216:219], a[64:67]
buffer_load_dwordx4 v1, s[36:39], s72 offen offset:2048 lds
v_mfma_f32_16x16x32_bf16 a[96:99], a[224:227], v[220:223], a[96:99]
v_exp_f32 v143, v143
v_mfma_f32_16x16x32_bf16 a[100:103], a[228:231], v[220:223], a[100:103]
ds_read_b128 a[204:207], v2 offset:3072
v_cvt_pk_bf16_f32 v205, v142, v143
v_mfma_f32_16x16x32_bf16 a[68:71], a[228:231], v[216:219], a[68:71]
buffer_load_dwordx4 v1, s[36:39], s72 offen offset:3072 lds
v_mfma_f32_16x16x32_bf16 a[72:75], a[232:235], v[216:219], a[72:75]
v_exp_f32 v156, v156
v_mfma_f32_16x16x32_bf16 a[104:107], a[232:235], v[220:223], a[104:107]
ds_read_b128 a[208:211], v2 offset:4096
v_mfma_f32_16x16x32_bf16 a[108:111], a[236:239], v[220:223], a[108:111]
buffer_load_dwordx4 v[80:83], v15, s[4:7], s80 offen
v_mfma_f32_16x16x32_bf16 a[76:79], a[236:239], v[216:219], a[76:79]
s_add_u32 s80, s80, 0x4000
v_exp_f32 v157, v157
v_mfma_f32_16x16x32_bf16 a[80:83], a[240:243], v[216:219], a[80:83]
ds_read_b128 a[212:215], v2 offset:5120
v_cvt_pk_bf16_f32 v206, v156, v157
v_mfma_f32_16x16x32_bf16 a[112:115], a[240:243], v[220:223], a[112:115]
buffer_load_dwordx4 v[84:87], v15, s[4:7], s80 offen
v_mfma_f32_16x16x32_bf16 a[116:119], a[244:247], v[220:223], a[116:119]
s_add_u32 s80, s80, 0x4000
v_exp_f32 v158, v158
v_mfma_f32_16x16x32_bf16 a[84:87], a[244:247], v[216:219], a[84:87]
ds_read_b128 a[216:219], v2 offset:6144
v_mfma_f32_16x16x32_bf16 a[88:91], a[248:251], v[216:219], a[88:91]
buffer_load_dwordx4 v[96:99], v15, s[4:7], s80 offen
v_mfma_f32_16x16x32_bf16 a[120:123], a[248:251], v[220:223], a[120:123]
s_add_u32 s80, s80, 0x4000
v_exp_f32 v159, v159
v_mfma_f32_16x16x32_bf16 a[124:127], a[252:255], v[220:223], a[124:127]
ds_read_b128 a[220:223], v2 offset:7168
v_cvt_pk_bf16_f32 v207, v158, v159
v_mfma_f32_16x16x32_bf16 a[92:95], a[252:255], v[216:219], a[92:95]
buffer_load_dwordx4 v[100:103], v15, s[4:7], s80 offen
v_mfma_f32_16x16x32_bf16 v[232:235], v[120:123], v[216:219], v[232:235]
v_mfma_f32_16x16x32_bf16 v[236:239], v[120:123], v[220:223], v[236:239]
s_waitcnt lgkmcnt(0)
v_mfma_f32_16x16x32_bf16 a[96:99], a[192:195], v[204:207], a[96:99]
s_add_u32 s82, s82, 0x8000
ds_read_b128 a[224:227], v2 offset:8192
ds_read_b128 a[228:231], v2 offset:9216
v_mfma_f32_16x16x32_bf16 a[100:103], a[196:199], v[204:207], a[100:103]
s_and_b32 s82, s82, 0x1ffff
v_exp_f32 v172, v172
v_mfma_f32_16x16x32_bf16 a[104:107], a[200:203], v[204:207], a[104:107]
v_exp_f32 v173, v173
v_mfma_f32_16x16x32_bf16 a[108:111], a[204:207], v[204:207], a[108:111]
ds_read_b128 a[232:235], v2 offset:10240
ds_read_b128 a[236:239], v2 offset:11264
v_mfma_f32_16x16x32_bf16 a[112:115], a[208:211], v[204:207], a[112:115]
v_exp_f32 v174, v174
v_mfma_f32_16x16x32_bf16 a[116:119], a[212:215], v[204:207], a[116:119]
ds_read_b128 a[240:243], v2 offset:12288
ds_read_b128 a[244:247], v2 offset:13312
v_mfma_f32_16x16x32_bf16 a[120:123], a[216:219], v[204:207], a[120:123]
ds_read_b128 a[248:251], v2 offset:14336
ds_read_b128 a[252:255], v2 offset:15360
v_mfma_f32_16x16x32_bf16 a[124:127], a[220:223], v[204:207], a[124:127]
s_waitcnt vmcnt(4) lgkmcnt(0)
v_exp_f32 v175, v175
v_mfma_f32_16x16x32_bf16 v[236:239], v[120:123], v[204:207], v[236:239]
s_barrier
v_exp_f32 v188, v188
v_add_u32 v2, s82, v1
v_cvt_pk_bf16_f32 v220, v172, v173
v_cvt_pk_bf16_f32 v221, v174, v175
v_exp_f32 v189, v189
v_exp_f32 v190, v190
v_cvt_pk_bf16_f32 v222, v188, v189
v_exp_f32 v191, v191
s_nop 0
v_cvt_pk_bf16_f32 v223, v190, v191
LHT4:
Lstub7:
s_cbranch_execz Lstub11
s_nop 1
v_mfma_f32_16x16x32_bf16 a[96:99], a[224:227], v[220:223], a[96:99]
ds_write_b64 v5, v[12:13]
v_mov_b32 v240, 0
v_mfma_f32_16x16x32_bf16 a[100:103], a[228:231], v[220:223], a[100:103]
s_lshl_b32 s73, s59, 12
v_mov_b32 v241, 0
v_mfma_f32_16x16x32_bf16 a[104:107], a[232:235], v[220:223], a[104:107]
s_add_u32 s73, s73, 0x2000000
ds_write_b64 v14, v[240:241]
ds_read_b128 a[192:195], v7 offset:3584
v_mfma_f32_16x16x32_bf16 a[108:111], a[236:239], v[220:223], a[108:111]
s_lshl_b32 s70, s68, 2
ds_read_b64 a[128:129], v6 offset:0
ds_read_b64 a[130:131], v6 offset:8
v_mfma_f32_16x16x32_bf16 a[112:115], a[240:243], v[220:223], a[112:115]
s_add_u32 s70, s70, s73
ds_read_b128 a[196:199], v7 offset:3072
ds_read_b64 a[132:133], v6 offset:512
v_mfma_f32_16x16x32_bf16 a[116:119], a[244:247], v[220:223], a[116:119]
ds_read_b64 a[134:135], v6 offset:520
ds_read_b128 a[200:203], v7 offset:2560
v_mfma_f32_16x16x32_bf16 a[120:123], a[248:251], v[220:223], a[120:123]
ds_read_b64 a[136:137], v6 offset:1024
ds_read_b64 a[138:139], v6 offset:1032
v_mfma_f32_16x16x32_bf16 a[124:127], a[252:255], v[220:223], a[124:127]
s_add_u32 s71, s12, s78
ds_read_b128 a[204:207], v7 offset:2048
ds_read_b64 a[140:141], v6 offset:1536
v_mfma_f32_16x16x32_bf16 v[236:239], v[120:123], v[220:223], v[236:239]
s_add_u32 m0, s77, 0
ds_read_b64 a[142:143], v6 offset:1544
ds_read_b128 a[208:211], v7 offset:1536
ds_read_b64 a[144:145], v6 offset:2048
ds_read_b64 a[146:147], v6 offset:2056
ds_read_b128 a[212:215], v7 offset:1024
ds_read_b64 a[148:149], v6 offset:2560
ds_read_b64 a[150:151], v6 offset:2568
ds_read_b128 a[216:219], v7 offset:512
ds_read_b64 a[152:153], v6 offset:3072
ds_read_b64 a[154:155], v6 offset:3080
ds_read_b128 a[220:223], v7 offset:0
ds_read_b64 a[156:157], v6 offset:3584
ds_read_b64 a[158:159], v6 offset:3592
s_waitcnt lgkmcnt(0)
v_mfma_f32_16x16x32_bf16 v[128:131], v[8:11], a[192:195], 0
s_add_u32 s72, s71, 0
buffer_load_dwordx4 v15, s[24:27], s72 offen lds
v_mfma_f32_16x16x32_bf16 v[128:131], a[128:131], a[192:195], v[128:131]
v_mfma_f32_16x16x32_bf16 v[132:135], v[8:11], a[196:199], 0
ds_read_b128 a[224:227], v7 offset:3648
ds_read_b64 a[160:161], v6 offset:64
v_mfma_f32_16x16x32_bf16 v[132:135], a[128:131], a[196:199], v[132:135]
v_accvgpr_read_b32 v240, a64
v_accvgpr_read_b32 v241, a65
v_accvgpr_read_b32 v242, a66
v_mfma_f32_16x16x32_bf16 v[132:135], a[132:135], a[192:195], v[132:135]
s_add_u32 s72, s71, 15360
buffer_load_dwordx4 v15, s[24:27], s72 offen offset:1024 lds
v_accvgpr_read_b32 v243, a67
v_mfma_f32_16x16x32_bf16 v[136:139], v[8:11], a[200:203], 0
ds_read_b64 a[162:163], v6 offset:72
ds_read_b128 a[228:231], v7 offset:3136
v_mfma_f32_16x16x32_bf16 v[136:139], a[128:131], a[200:203], v[136:139]
v_rcp_f32 v232, v232
v_mfma_f32_16x16x32_bf16 v[136:139], a[132:135], a[196:199], v[136:139]
v_rcp_f32 v236, v236
v_accvgpr_read_b32 v244, a68
v_mfma_f32_16x16x32_bf16 v[136:139], a[136:139], a[192:195], v[136:139]
ds_read_b64 a[164:165], v6 offset:576
ds_read_b64 a[166:167], v6 offset:584
v_accvgpr_read_b32 v245, a69
v_mfma_f32_16x16x32_bf16 v[140:143], v[8:11], a[204:207], 0
s_add_u32 s72, s71, 30720
buffer_load_dwordx4 v15, s[24:27], s72 offen offset:2048 lds
v_accvgpr_read_b32 v246, a70
v_mfma_f32_16x16x32_bf16 v[140:143], a[128:131], a[204:207], v[140:143]
v_accvgpr_read_b32 v247, a71
v_mul_f32 v240, v240, v232
v_mul_f32 v241, v241, v232
v_mfma_f32_16x16x32_bf16 v[140:143], a[132:135], a[200:203], v[140:143]
ds_read_b128 a[232:235], v7 offset:2624
ds_read_b64 a[168:169], v6 offset:1088
v_mul_f32 v242, v242, v232
v_mfma_f32_16x16x32_bf16 v[140:143], a[136:139], a[196:199], v[140:143]
s_add_u32 s72, s71, 46080
buffer_load_dwordx4 v15, s[24:27], s72 offen offset:3072 lds
v_mul_f32 v243, v243, v232
v_mfma_f32_16x16x32_bf16 v[140:143], a[140:143], a[192:195], v[140:143]
v_mul_f32 v244, v244, v232
v_mul_f32 v245, v245, v232
v_mul_f32 v246, v246, v232
v_mfma_f32_16x16x32_bf16 v[144:147], v[8:11], a[208:211], 0
ds_read_b64 a[170:171], v6 offset:1096
ds_read_b128 a[236:239], v7 offset:2112
v_mul_f32 v247, v247, v232
v_mfma_f32_16x16x32_bf16 v[144:147], a[128:131], a[208:211], v[144:147]
s_lshl_b32 s95, s75, 20
v_cvt_pk_bf16_f32 v240, v240, v241
v_cvt_pk_bf16_f32 v241, v242, v243
v_cvt_pk_bf16_f32 v242, v244, v245
v_mfma_f32_16x16x32_bf16 v[144:147], a[132:135], a[204:207], v[144:147]
s_lshl_b32 s74, s58, 18
v_cvt_pk_bf16_f32 v243, v246, v247
v_mfma_f32_16x16x32_bf16 v[144:147], a[136:139], a[200:203], v[144:147]
s_add_u32 s95, s95, s74
ds_read_b64 a[172:173], v6 offset:1600
ds_read_b64 a[174:175], v6 offset:1608
v_mfma_f32_16x16x32_bf16 v[144:147], a[140:143], a[196:199], v[144:147]
s_add_u32 s95, s95, 0x2000000
buffer_store_dwordx4 v[240:243], v1, s[44:47], s70 offen sc1
v_mfma_f32_16x16x32_bf16 v[144:147], a[144:147], a[192:195], v[144:147]
s_sub_u32 s74, 15, s75
v_accvgpr_read_b32 v248, a72
v_accvgpr_read_b32 v249, a73
v_accvgpr_read_b32 v250, a74
v_mfma_f32_16x16x32_bf16 v[148:151], v[8:11], a[212:215], 0
s_min_u32 s74, s74, s75
ds_read_b128 a[240:243], v7 offset:1600
ds_read_b64 a[176:177], v6 offset:2112
v_accvgpr_read_b32 v251, a75
v_mfma_f32_16x16x32_bf16 v[148:151], a[128:131], a[212:215], v[148:151]
s_lshl_b32 s74, s74, 7
v_accvgpr_read_b32 v252, a76
v_accvgpr_read_b32 v253, a77
v_accvgpr_read_b32 v254, a78
v_mfma_f32_16x16x32_bf16 v[148:151], a[132:135], a[208:211], v[148:151]
s_add_u32 s74, s74, 0x3810000
v_accvgpr_read_b32 v255, a79
v_mul_f32 v248, v248, v232
v_mul_f32 v249, v249, v232
v_mfma_f32_16x16x32_bf16 v[148:151], a[136:139], a[204:207], v[148:151]
ds_read_b64 a[178:179], v6 offset:2120
ds_read_b128 a[244:247], v7 offset:1088
v_mul_f32 v250, v250, v232
v_mfma_f32_16x16x32_bf16 v[148:151], a[140:143], a[200:203], v[148:151]
v_mul_f32 v251, v251, v232
v_mul_f32 v252, v252, v232
v_mul_f32 v253, v253, v232
v_mfma_f32_16x16x32_bf16 v[148:151], a[144:147], a[196:199], v[148:151]
v_mul_f32 v254, v254, v232
v_mul_f32 v255, v255, v232
v_cvt_pk_bf16_f32 v248, v248, v249
v_mfma_f32_16x16x32_bf16 v[148:151], a[148:151], a[192:195], v[148:151]
ds_read_b64 a[180:181], v6 offset:2624
ds_read_b64 a[182:183], v6 offset:2632
v_cvt_pk_bf16_f32 v249, v250, v251
v_mfma_f32_16x16x32_bf16 v[152:155], v[8:11], a[216:219], 0
v_cvt_pk_bf16_f32 v250, v252, v253
v_cvt_pk_bf16_f32 v251, v254, v255
v_mfma_f32_16x16x32_bf16 v[152:155], a[128:131], a[216:219], v[152:155]
buffer_store_dwordx4 v[248:251], v1, s[44:47], s70 offen offset:1024 sc1
v_mfma_f32_16x16x32_bf16 v[152:155], a[132:135], a[212:215], v[152:155]
ds_read_b128 a[248:251], v7 offset:576
ds_read_b64 a[184:185], v6 offset:3136
v_accvgpr_read_b32 v240, a80
v_mfma_f32_16x16x32_bf16 v[152:155], a[136:139], a[208:211], v[152:155]
v_accvgpr_read_b32 v241, a81
v_accvgpr_read_b32 v242, a82
v_accvgpr_read_b32 v243, a83
v_mfma_f32_16x16x32_bf16 v[152:155], a[140:143], a[204:207], v[152:155]
v_accvgpr_read_b32 v244, a84
v_accvgpr_read_b32 v245, a85
v_accvgpr_read_b32 v246, a86
v_mfma_f32_16x16x32_bf16 v[152:155], a[144:147], a[200:203], v[152:155]
ds_read_b64 a[186:187], v6 offset:3144
ds_read_b128 a[252:255], v7 offset:64
v_accvgpr_read_b32 v247, a87
v_mfma_f32_16x16x32_bf16 v[152:155], a[148:151], a[196:199], v[152:155]
v_mul_f32 v240, v240, v232
v_mul_f32 v241, v241, v232
v_mul_f32 v242, v242, v232
v_mfma_f32_16x16x32_bf16 v[152:155], a[152:155], a[192:195], v[152:155]
v_mul_f32 v243, v243, v232
v_mul_f32 v244, v244, v232
v_mul_f32 v245, v245, v232
v_mfma_f32_16x16x32_bf16 v[156:159], v[8:11], a[220:223], 0
ds_read_b64 a[188:189], v6 offset:3648
ds_read_b64 a[190:191], v6 offset:3656
v_mul_f32 v246, v246, v232
v_mfma_f32_16x16x32_bf16 v[156:159], a[128:131], a[220:223], v[156:159]
v_mul_f32 v247, v247, v232
v_cvt_pk_bf16_f32 v240, v240, v241
v_cvt_pk_bf16_f32 v241, v242, v243
v_mfma_f32_16x16x32_bf16 v[156:159], a[132:135], a[216:219], v[156:159]
v_cvt_pk_bf16_f32 v242, v244, v245
v_cvt_pk_bf16_f32 v243, v246, v247
v_mfma_f32_16x16x32_bf16 v[156:159], a[136:139], a[212:215], v[156:159]
buffer_store_dwordx4 v[240:243], v1, s[44:47], s70 offen offset:2048 sc1
v_mfma_f32_16x16x32_bf16 v[156:159], a[140:143], a[208:211], v[156:159]
v_accvgpr_read_b32 v248, a88
v_accvgpr_read_b32 v249, a89
v_accvgpr_read_b32 v250, a90
v_mfma_f32_16x16x32_bf16 v[156:159], a[144:147], a[204:207], v[156:159]
v_accvgpr_read_b32 v251, a91
v_accvgpr_read_b32 v252, a92
v_accvgpr_read_b32 v253, a93
v_mfma_f32_16x16x32_bf16 v[156:159], a[148:151], a[200:203], v[156:159]
v_accvgpr_read_b32 v254, a94
v_accvgpr_read_b32 v255, a95
v_mul_f32 v248, v248, v232
v_mfma_f32_16x16x32_bf16 v[156:159], a[152:155], a[196:199], v[156:159]
v_mul_f32 v249, v249, v232
v_mul_f32 v250, v250, v232
v_mul_f32 v251, v251, v232
v_mfma_f32_16x16x32_bf16 v[156:159], a[156:159], a[192:195], v[156:159]
s_waitcnt lgkmcnt(0)
v_mul_f32 v252, v252, v232
v_mul_f32 v253, v253, v232
v_mul_f32 v254, v254, v232
v_mfma_f32_16x16x32_bf16 v[128:131], a[160:163], a[224:227], v[128:131]
ds_read_b128 a[192:195], v7 offset:3712
ds_read_b64 a[128:129], v6 offset:128
v_mul_f32 v255, v255, v232
v_mfma_f32_16x16x32_bf16 v[132:135], a[164:167], a[224:227], v[132:135]
v_cvt_pk_bf16_f32 v248, v248, v249
v_cvt_pk_bf16_f32 v249, v250, v251
v_cvt_pk_bf16_f32 v250, v252, v253
v_mfma_f32_16x16x32_bf16 v[132:135], a[160:163], a[228:231], v[132:135]
ds_read_b64 a[130:131], v6 offset:136
ds_read_b128 a[196:199], v7 offset:3200
v_cvt_pk_bf16_f32 v251, v254, v255
v_mfma_f32_16x16x32_bf16 v[136:139], a[160:163], a[232:235], v[136:139]
buffer_store_dwordx4 v[248:251], v1, s[44:47], s70 offen offset:3072 sc1
v_mfma_f32_16x16x32_bf16 v[136:139], a[164:167], a[228:231], v[136:139]
s_add_u32 s70, s70, 0x80000
v_accvgpr_read_b32 v240, a96
v_accvgpr_read_b32 v241, a97
v_accvgpr_read_b32 v242, a98
v_mfma_f32_16x16x32_bf16 v[136:139], a[168:171], a[224:227], v[136:139]
ds_read_b64 a[132:133], v6 offset:640
ds_read_b64 a[134:135], v6 offset:648
v_accvgpr_read_b32 v243, a99
v_mfma_f32_16x16x32_bf16 v[140:143], a[172:175], a[224:227], v[140:143]
v_accvgpr_read_b32 v244, a100
v_accvgpr_read_b32 v245, a101
v_accvgpr_read_b32 v246, a102
v_mfma_f32_16x16x32_bf16 v[140:143], a[168:171], a[228:231], v[140:143]
ds_read_b128 a[200:203], v7 offset:2688
ds_read_b64 a[136:137], v6 offset:1152
v_accvgpr_read_b32 v247, a103
v_mfma_f32_16x16x32_bf16 v[140:143], a[164:167], a[232:235], v[140:143]
v_mul_f32 v240, v240, v236
v_mul_f32 v241, v241, v236
v_mul_f32 v242, v242, v236
v_mfma_f32_16x16x32_bf16 v[140:143], a[160:163], a[236:239], v[140:143]
v_mul_f32 v243, v243, v236
v_mul_f32 v244, v244, v236
v_mul_f32 v245, v245, v236
v_mfma_f32_16x16x32_bf16 v[144:147], a[160:163], a[240:243], v[144:147]
ds_read_b64 a[138:139], v6 offset:1160
ds_read_b128 a[204:207], v7 offset:2176
v_mul_f32 v246, v246, v236
v_mfma_f32_16x16x32_bf16 v[144:147], a[164:167], a[236:239], v[144:147]
v_mul_f32 v247, v247, v236
v_cvt_pk_bf16_f32 v240, v240, v241
v_cvt_pk_bf16_f32 v241, v242, v243
v_mfma_f32_16x16x32_bf16 v[144:147], a[168:171], a[232:235], v[144:147]
ds_read_b64 a[140:141], v6 offset:1664
ds_read_b64 a[142:143], v6 offset:1672
v_cvt_pk_bf16_f32 v242, v244, v245
v_mfma_f32_16x16x32_bf16 v[144:147], a[172:175], a[228:231], v[144:147]
v_cvt_pk_bf16_f32 v243, v246, v247
v_mfma_f32_16x16x32_bf16 v[144:147], a[176:179], a[224:227], v[144:147]
buffer_store_dwordx4 v[240:243], v1, s[44:47], s70 offen sc1
v_mfma_f32_16x16x32_bf16 v[148:151], a[180:183], a[224:227], v[148:151]
ds_read_b128 a[208:211], v7 offset:1664
ds_read_b64 a[144:145], v6 offset:2176
v_accvgpr_read_b32 v248, a104
v_mfma_f32_16x16x32_bf16 v[148:151], a[176:179], a[228:231], v[148:151]
v_accvgpr_read_b32 v249, a105
v_accvgpr_read_b32 v250, a106
v_accvgpr_read_b32 v251, a107
v_mfma_f32_16x16x32_bf16 v[148:151], a[172:175], a[232:235], v[148:151]
v_accvgpr_read_b32 v252, a108
v_accvgpr_read_b32 v253, a109
v_accvgpr_read_b32 v254, a110
v_mfma_f32_16x16x32_bf16 v[148:151], a[168:171], a[236:239], v[148:151]
ds_read_b64 a[146:147], v6 offset:2184
ds_read_b128 a[212:215], v7 offset:1152
v_accvgpr_read_b32 v255, a111
v_mfma_f32_16x16x32_bf16 v[148:151], a[164:167], a[240:243], v[148:151]
v_mul_f32 v248, v248, v236
v_mul_f32 v249, v249, v236
v_mul_f32 v250, v250, v236
v_mfma_f32_16x16x32_bf16 v[148:151], a[160:163], a[244:247], v[148:151]
ds_read_b64 a[148:149], v6 offset:2688
ds_read_b64 a[150:151], v6 offset:2696
v_mul_f32 v251, v251, v236
v_mfma_f32_16x16x32_bf16 v[152:155], a[160:163], a[248:251], v[152:155]
v_mul_f32 v252, v252, v236
v_mul_f32 v253, v253, v236
v_mul_f32 v254, v254, v236
v_mfma_f32_16x16x32_bf16 v[152:155], a[164:167], a[244:247], v[152:155]
v_mul_f32 v255, v255, v236
v_cvt_pk_bf16_f32 v248, v248, v249
v_cvt_pk_bf16_f32 v249, v250, v251
v_mfma_f32_16x16x32_bf16 v[152:155], a[168:171], a[240:243], v[152:155]
ds_read_b128 a[216:219], v7 offset:640
ds_read_b64 a[152:153], v6 offset:3200
v_cvt_pk_bf16_f32 v250, v252, v253
v_mfma_f32_16x16x32_bf16 v[152:155], a[172:175], a[236:239], v[152:155]
Lstub8:
s_cbranch_execz Lret
v_cvt_pk_bf16_f32 v251, v254, v255
v_mfma_f32_16x16x32_bf16 v[152:155], a[176:179], a[232:235], v[152:155]
ds_read_b64 a[154:155], v6 offset:3208
ds_read_b128 a[220:223], v7 offset:128
v_mfma_f32_16x16x32_bf16 v[152:155], a[180:183], a[228:231], v[152:155]
buffer_store_dwordx4 v[248:251], v1, s[44:47], s70 offen offset:1024 sc1
v_mfma_f32_16x16x32_bf16 v[152:155], a[184:187], a[224:227], v[152:155]
v_accvgpr_read_b32 v240, a112
v_accvgpr_read_b32 v241, a113
v_accvgpr_read_b32 v242, a114
v_mfma_f32_16x16x32_bf16 v[156:159], a[188:191], a[224:227], v[156:159]
ds_read_b64 a[156:157], v6 offset:3712
ds_read_b64 a[158:159], v6 offset:3720
v_accvgpr_read_b32 v243, a115
v_mfma_f32_16x16x32_bf16 v[156:159], a[184:187], a[228:231], v[156:159]
v_accvgpr_read_b32 v244, a116
v_accvgpr_read_b32 v245, a117
v_accvgpr_read_b32 v246, a118
v_mfma_f32_16x16x32_bf16 v[156:159], a[180:183], a[232:235], v[156:159]
v_accvgpr_read_b32 v247, a119
v_mul_f32 v240, v240, v236
v_mul_f32 v241, v241, v236
v_mfma_f32_16x16x32_bf16 v[156:159], a[176:179], a[236:239], v[156:159]
v_mul_f32 v242, v242, v236
v_mul_f32 v243, v243, v236
v_mul_f32 v244, v244, v236
v_mfma_f32_16x16x32_bf16 v[156:159], a[172:175], a[240:243], v[156:159]
v_mul_f32 v245, v245, v236
v_mul_f32 v246, v246, v236
v_mul_f32 v247, v247, v236
v_mfma_f32_16x16x32_bf16 v[156:159], a[168:171], a[244:247], v[156:159]
v_cvt_pk_bf16_f32 v240, v240, v241
v_cvt_pk_bf16_f32 v241, v242, v243
v_cvt_pk_bf16_f32 v242, v244, v245
v_mfma_f32_16x16x32_bf16 v[156:159], a[164:167], a[248:251], v[156:159]
v_cvt_pk_bf16_f32 v243, v246, v247
v_mfma_f32_16x16x32_bf16 v[156:159], a[160:163], a[252:255], v[156:159]
s_waitcnt lgkmcnt(0)
buffer_store_dwordx4 v[240:243], v1, s[44:47], s70 offen offset:2048 sc1
v_mfma_f32_16x16x32_bf16 v[128:131], a[128:131], a[192:195], v[128:131]
ds_read_b128 a[224:227], v7 offset:3776
ds_read_b64 a[160:161], v6 offset:192
v_accvgpr_read_b32 v248, a120
v_mfma_f32_16x16x32_bf16 v[132:135], a[132:135], a[192:195], v[132:135]
v_accvgpr_read_b32 v249, a121
v_accvgpr_read_b32 v250, a122
v_accvgpr_read_b32 v251, a123
v_mfma_f32_16x16x32_bf16 v[132:135], a[128:131], a[196:199], v[132:135]
ds_read_b64 a[162:163], v6 offset:200
ds_read_b128 a[228:231], v7 offset:3264
v_accvgpr_read_b32 v252, a124
v_mfma_f32_16x16x32_bf16 v[136:139], a[128:131], a[200:203], v[136:139]
v_accvgpr_read_b32 v253, a125
v_accvgpr_read_b32 v254, a126
v_accvgpr_read_b32 v255, a127
v_mfma_f32_16x16x32_bf16 v[136:139], a[132:135], a[196:199], v[136:139]
v_mul_f32 v248, v248, v236
v_mul_f32 v249, v249, v236
v_mul_f32 v250, v250, v236
v_mfma_f32_16x16x32_bf16 v[136:139], a[136:139], a[192:195], v[136:139]
ds_read_b64 a[164:165], v6 offset:704
ds_read_b64 a[166:167], v6 offset:712
v_mul_f32 v251, v251, v236
v_mfma_f32_16x16x32_bf16 v[140:143], a[140:143], a[192:195], v[140:143]
v_mul_f32 v252, v252, v236
v_mul_f32 v253, v253, v236
v_mul_f32 v254, v254, v236
v_mfma_f32_16x16x32_bf16 v[140:143], a[136:139], a[196:199], v[140:143]
ds_read_b128 a[232:235], v7 offset:2752
ds_read_b64 a[168:169], v6 offset:1216
v_mul_f32 v255, v255, v236
v_mfma_f32_16x16x32_bf16 v[140:143], a[132:135], a[200:203], v[140:143]
v_cvt_pk_bf16_f32 v248, v248, v249
v_cvt_pk_bf16_f32 v249, v250, v251
v_cvt_pk_bf16_f32 v250, v252, v253
v_mfma_f32_16x16x32_bf16 v[140:143], a[128:131], a[204:207], v[140:143]
v_cvt_pk_bf16_f32 v251, v254, v255
v_mfma_f32_16x16x32_bf16 v[144:147], a[128:131], a[208:211], v[144:147]
ds_read_b64 a[170:171], v6 offset:1224
ds_read_b128 a[236:239], v7 offset:2240
v_mfma_f32_16x16x32_bf16 v[144:147], a[132:135], a[204:207], v[144:147]
buffer_store_dwordx4 v[248:251], v1, s[44:47], s70 offen offset:3072 sc1
v_mfma_f32_16x16x32_bf16 v[144:147], a[136:139], a[200:203], v[144:147]
s_mov_b32 s73, 0x5d800000
ds_read_b64 a[172:173], v6 offset:1728
ds_read_b64 a[174:175], v6 offset:1736
v_add_f32 v227, v226, v230
v_mfma_f32_16x16x32_bf16 v[144:147], a[140:143], a[196:199], v[144:147]
v_add_f32 v231, v234, v238
v_add_f32 v227, v227, v231
v_cmp_nlt_f32 vcc, v227, s73
v_mfma_f32_16x16x32_bf16 v[144:147], a[144:147], a[192:195], v[144:147]
s_lshl_b32 s73, s58, 2
v_mfma_f32_16x16x32_bf16 v[148:151], a[148:151], a[192:195], v[148:151]
s_add_u32 s73, s73, 163328
ds_read_b128 a[240:243], v7 offset:1728
ds_read_b64 a[176:177], v6 offset:2240
v_mov_b32 v231, s73
v_mfma_f32_16x16x32_bf16 v[148:151], a[144:147], a[196:199], v[148:151]
s_or_b32 s73, vcc_lo, vcc_hi
v_mfma_f32_16x16x32_bf16 v[148:151], a[140:143], a[200:203], v[148:151]
s_min_u32 s73, s73, 1
v_mov_b32 v227, s73
v_mfma_f32_16x16x32_bf16 v[148:151], a[136:139], a[204:207], v[148:151]
ds_read_b64 a[178:179], v6 offset:2248
ds_read_b128 a[244:247], v7 offset:1216
ds_write_b32 v231, v227
v_mfma_f32_16x16x32_bf16 v[148:151], a[132:135], a[208:211], v[148:151]
v_mfma_f32_16x16x32_bf16 v[148:151], a[128:131], a[212:215], v[148:151]
ds_read_b64 a[180:181], v6 offset:2752
ds_read_b64 a[182:183], v6 offset:2760
v_mfma_f32_16x16x32_bf16 v[152:155], a[128:131], a[216:219], v[152:155]
v_mfma_f32_16x16x32_bf16 v[152:155], a[132:135], a[212:215], v[152:155]
v_mfma_f32_16x16x32_bf16 v[152:155], a[136:139], a[208:211], v[152:155]
ds_read_b128 a[248:251], v7 offset:704
ds_read_b64 a[184:185], v6 offset:3264
v_mfma_f32_16x16x32_bf16 v[152:155], a[140:143], a[204:207], v[152:155]
v_mfma_f32_16x16x32_bf16 v[152:155], a[144:147], a[200:203], v[152:155]
s_add_u32 s71, s12, s94
ds_read_b64 a[186:187], v6 offset:3272
ds_read_b128 a[252:255], v7 offset:192
v_mfma_f32_16x16x32_bf16 v[152:155], a[148:151], a[196:199], v[152:155]
s_add_u32 m0, s77, 16384
v_mfma_f32_16x16x32_bf16 v[152:155], a[152:155], a[192:195], v[152:155]
s_add_u32 s72, s71, 0
buffer_load_dwordx4 v15, s[24:27], s72 offen lds
v_mfma_f32_16x16x32_bf16 v[156:159], a[156:159], a[192:195], v[156:159]
ds_read_b64 a[188:189], v6 offset:3776
ds_read_b64 a[190:191], v6 offset:3784
v_mfma_f32_16x16x32_bf16 v[156:159], a[152:155], a[196:199], v[156:159]
v_mfma_f32_16x16x32_bf16 v[156:159], a[148:151], a[200:203], v[156:159]
s_add_u32 s72, s71, 15360
buffer_load_dwordx4 v15, s[24:27], s72 offen offset:1024 lds
v_mfma_f32_16x16x32_bf16 v[156:159], a[144:147], a[204:207], v[156:159]
v_mfma_f32_16x16x32_bf16 v[156:159], a[140:143], a[208:211], v[156:159]
v_mfma_f32_16x16x32_bf16 v[156:159], a[136:139], a[212:215], v[156:159]
v_mfma_f32_16x16x32_bf16 v[156:159], a[132:135], a[216:219], v[156:159]
v_mfma_f32_16x16x32_bf16 v[156:159], a[128:131], a[220:223], v[156:159]
s_waitcnt lgkmcnt(0)
v_mfma_f32_16x16x32_bf16 v[128:131], a[160:163], a[224:227], v[128:131]
s_add_u32 s72, s71, 30720
ds_read_b128 a[192:195], v7 offset:3840
ds_read_b64 a[128:129], v6 offset:256
v_mfma_f32_16x16x32_bf16 v[132:135], a[164:167], a[224:227], v[132:135]
s_waitcnt vmcnt(2) lgkmcnt(10)
buffer_load_dwordx4 v15, s[24:27], s72 offen offset:2048 lds
v_mfma_f32_16x16x32_bf16 v[132:135], a[160:163], a[228:231], v[132:135]
s_barrier
ds_read_b64 a[130:131], v6 offset:264
ds_read_b128 a[196:199], v7 offset:3328
v_mfma_f32_16x16x32_bf16 v[136:139], a[160:163], a[232:235], v[136:139]
v_mov_b32 v244, 163328
v_mfma_f32_16x16x32_bf16 v[136:139], a[164:167], a[228:231], v[136:139]
ds_read_b128 v[240:243], v244
v_mfma_f32_16x16x32_bf16 v[136:139], a[168:171], a[224:227], v[136:139]
ds_read_b64 a[132:133], v6 offset:768
ds_read_b64 a[134:135], v6 offset:776
v_mfma_f32_16x16x32_bf16 v[140:143], a[172:175], a[224:227], v[140:143]
s_add_u32 s72, s71, 46080
buffer_load_dwordx4 v15, s[24:27], s72 offen offset:3072 lds
v_mfma_f32_16x16x32_bf16 v[140:143], a[168:171], a[228:231], v[140:143]
ds_read_b128 a[200:203], v7 offset:2816
ds_read_b64 a[136:137], v6 offset:1280
v_mfma_f32_16x16x32_bf16 v[140:143], a[164:167], a[232:235], v[140:143]
v_mfma_f32_16x16x32_bf16 v[140:143], a[160:163], a[236:239], v[140:143]
s_waitcnt lgkmcnt(4)
v_or3_b32 v240, v240, v241, v242
v_or_b32 v240, v240, v243
v_mfma_f32_16x16x32_bf16 v[144:147], a[160:163], a[240:243], v[144:147]
ds_read_b64 a[138:139], v6 offset:1288
ds_read_b128 a[204:207], v7 offset:2304
v_cmp_lt_u32 vcc, s86, v240
s_cbranch_vccnz Lslow
v_mfma_f32_16x16x32_bf16 v[144:147], a[164:167], a[236:239], v[144:147]
v_or_b32 v240, s58, v0
v_mov_b32 v241, 2
v_mfma_f32_16x16x32_bf16 v[144:147], a[168:171], a[232:235], v[144:147]
s_add_u32 s71, s13, s78
ds_read_b64 a[140:141], v6 offset:1792
ds_read_b64 a[142:143], v6 offset:1800
v_mfma_f32_16x16x32_bf16 v[144:147], a[172:175], a[228:231], v[144:147]
s_add_u32 m0, s77, 32768
v_min_u32 v240, 1, v240
v_lshlrev_b32 v240, 30, v240
v_mfma_f32_16x16x32_bf16 v[144:147], a[176:179], a[224:227], v[144:147]
s_add_u32 s72, s71, 0
buffer_load_dwordx4 v15, s[24:27], s72 offen lds
v_mfma_f32_16x16x32_bf16 v[148:151], a[180:183], a[224:227], v[148:151]
ds_read_b128 a[208:211], v7 offset:1792
ds_read_b64 a[144:145], v6 offset:2304
v_mfma_f32_16x16x32_bf16 v[148:151], a[176:179], a[228:231], v[148:151]
buffer_store_dword v241, v240, s[44:47], s91 offen sc1
v_mfma_f32_16x16x32_bf16 v[148:151], a[172:175], a[232:235], v[148:151]
s_add_u32 s80, s93, 0x3400000
v_and_b32 v166, 7, v0
v_lshlrev_b32 v166, 4, v166
v_mfma_f32_16x16x32_bf16 v[148:151], a[168:171], a[236:239], v[148:151]
s_add_u32 s72, s71, 15360
ds_read_b64 a[146:147], v6 offset:2312
ds_read_b128 a[212:215], v7 offset:1280
v_mfma_f32_16x16x32_bf16 v[148:151], a[164:167], a[240:243], v[148:151]
buffer_load_dwordx4 v15, s[24:27], s72 offen offset:1024 lds
v_mfma_f32_16x16x32_bf16 v[148:151], a[160:163], a[244:247], v[148:151]
ds_read_b64 a[148:149], v6 offset:2816
ds_read_b64 a[150:151], v6 offset:2824
v_mfma_f32_16x16x32_bf16 v[152:155], a[160:163], a[248:251], v[152:155]
v_bfe_u32 v112, v0, 3, 1
v_lshl_add_u32 v166, v112, 8, v166
v_mfma_f32_16x16x32_bf16 v[152:155], a[164:167], a[244:247], v[152:155]
v_bfe_u32 v112, v0, 4, 1
v_lshl_add_u32 v166, v112, 7, v166
v_mfma_f32_16x16x32_bf16 v[152:155], a[168:171], a[240:243], v[152:155]
ds_read_b128 a[216:219], v7 offset:768
ds_read_b64 a[152:153], v6 offset:3328
v_mfma_f32_16x16x32_bf16 v[152:155], a[172:175], a[236:239], v[152:155]
s_add_u32 s72, s71, 30720
buffer_load_dwordx4 v15, s[24:27], s72 offen offset:2048 lds
v_mfma_f32_16x16x32_bf16 v[152:155], a[176:179], a[232:235], v[152:155]
ds_read_b64 a[154:155], v6 offset:3336
ds_read_b128 a[220:223], v7 offset:256
v_mfma_f32_16x16x32_bf16 v[152:155], a[180:183], a[228:231], v[152:155]
v_lshrrev_b32 v112, 5, v0
v_lshl_add_u32 v166, v112, 9, v166
v_mfma_f32_16x16x32_bf16 v[152:155], a[184:187], a[224:227], v[152:155]
v_and_b32 v112, 15, v0
v_lshrrev_b32 v113, 2, v0
v_mfma_f32_16x16x32_bf16 v[156:159], a[188:191], a[224:227], v[156:159]
ds_read_b64 a[156:157], v6 offset:3840
ds_read_b64 a[158:159], v6 offset:3848
v_mfma_f32_16x16x32_bf16 v[156:159], a[184:187], a[228:231], v[156:159]
v_bfe_u32 v114, v0, 3, 2
v_and_b32 v115, 3, v0
v_mfma_f32_16x16x32_bf16 v[156:159], a[180:183], a[232:235], v[156:159]
s_add_u32 s72, s71, 46080
buffer_load_dwordx4 v15, s[24:27], s72 offen offset:3072 lds
v_mfma_f32_16x16x32_bf16 v[156:159], a[176:179], a[236:239], v[156:159]
v_lshlrev_b32 v8, 7, v113
v_lshl_add_u32 v8, v114, 5, v8
v_mfma_f32_16x16x32_bf16 v[156:159], a[172:175], a[240:243], v[156:159]
v_lshl_add_u32 v8, v115, 3, v8
v_add_u32 v8, s77, v8
v_mfma_f32_16x16x32_bf16 v[156:159], a[168:171], a[244:247], v[156:159]
v_subrev_u32 v8, s64, v8
v_xor_b32 v9, 32, v8
v_mfma_f32_16x16x32_bf16 v[156:159], a[164:167], a[248:251], v[156:159]
v_lshrrev_b32 v2, 4, v0
v_lshlrev_b32 v2, 10, v2
v_mfma_f32_16x16x32_bf16 v[156:159], a[160:163], a[252:255], v[156:159]
s_waitcnt lgkmcnt(0)
v_xor_b32 v10, 64, v8
v_xor_b32 v11, 0x60, v8
v_mfma_f32_16x16x32_bf16 v[128:131], a[128:131], a[192:195], v[128:131]
s_add_u32 s71, s13, s94
ds_read_b128 a[224:227], v7 offset:3904
ds_read_b64 a[160:161], v6 offset:320
v_mfma_f32_16x16x32_bf16 v[132:135], a[132:135], a[192:195], v[132:135]
s_add_u32 m0, s77, 49152
v_lshlrev_b32 v5, 8, v113
v_and_b32 v114, 1, v0
v_mfma_f32_16x16x32_bf16 v[132:135], a[128:131], a[196:199], v[132:135]
s_add_u32 s72, s71, 0
ds_read_b64 a[162:163], v6 offset:328
ds_read_b128 a[228:231], v7 offset:3392
v_mfma_f32_16x16x32_bf16 v[136:139], a[128:131], a[200:203], v[136:139]
s_add_u32 s82, s59, 4
buffer_load_dwordx4 v15, s[24:27], s72 offen lds
v_mfma_f32_16x16x32_bf16 v[136:139], a[132:135], a[196:199], v[136:139]
s_and_b32 s82, s82, 28
v_lshl_add_u32 v5, v114, 7, v5
v_bfe_u32 v114, v0, 1, 1
v_mfma_f32_16x16x32_bf16 v[136:139], a[136:139], a[192:195], v[136:139]
s_lshl_b32 s82, s82, 10
ds_read_b64 a[164:165], v6 offset:832
ds_read_b64 a[166:167], v6 offset:840
v_mfma_f32_16x16x32_bf16 v[140:143], a[140:143], a[192:195], v[140:143]
s_add_u32 s72, s71, 15360
buffer_load_dwordx4 v15, s[24:27], s72 offen offset:1024 lds
v_mfma_f32_16x16x32_bf16 v[140:143], a[136:139], a[196:199], v[140:143]
s_add_u32 s82, s82, s74
ds_read_b128 a[232:235], v7 offset:2880
ds_read_b64 a[168:169], v6 offset:1344
v_mfma_f32_16x16x32_bf16 v[140:143], a[132:135], a[200:203], v[140:143]
buffer_load_dword v3, v2, s[44:47], s82 offen sc1
v_mfma_f32_16x16x32_bf16 v[140:143], a[128:131], a[204:207], v[140:143]
v_lshl_add_u32 v5, v114, 3, v5
v_mov_b32 v114, s58
v_mfma_f32_16x16x32_bf16 v[144:147], a[128:131], a[208:211], v[144:147]
ds_read_b64 a[170:171], v6 offset:1352
ds_read_b128 a[236:239], v7 offset:2368
v_mfma_f32_16x16x32_bf16 v[144:147], a[132:135], a[204:207], v[144:147]
v_lshl_add_u32 v5, v114, 5, v5
v_add_u32 v5, 147456, v5
v_mfma_f32_16x16x32_bf16 v[144:147], a[136:139], a[200:203], v[144:147]
s_add_u32 s72, s71, 30720
ds_read_b64 a[172:173], v6 offset:1856
ds_read_b64 a[174:175], v6 offset:1864
v_mfma_f32_16x16x32_bf16 v[144:147], a[140:143], a[196:199], v[144:147]
buffer_load_dwordx4 v15, s[24:27], s72 offen offset:2048 lds
v_mfma_f32_16x16x32_bf16 v[144:147], a[144:147], a[192:195], v[144:147]
v_bfe_u32 v114, v0, 1, 2
v_lshrrev_b32 v115, 4, v0
v_mfma_f32_16x16x32_bf16 v[148:151], a[148:151], a[192:195], v[148:151]
ds_read_b128 a[240:243], v7 offset:1856
ds_read_b64 a[176:177], v6 offset:2368
v_mfma_f32_16x16x32_bf16 v[148:151], a[144:147], a[196:199], v[148:151]
v_lshlrev_b32 v116, 7, v112
v_lshl_add_u32 v116, v114, 5, v116
v_mfma_f32_16x16x32_bf16 v[148:151], a[140:143], a[200:203], v[148:151]
v_lshl_add_u32 v116, v115, 3, v116
v_add_u32 v116, s64, v116
v_mfma_f32_16x16x32_bf16 v[148:151], a[136:139], a[204:207], v[148:151]
s_add_u32 s72, s71, 46080
ds_read_b64 a[178:179], v6 offset:2376
ds_read_b128 a[244:247], v7 offset:1344
v_mfma_f32_16x16x32_bf16 v[148:151], a[132:135], a[208:211], v[148:151]
buffer_load_dwordx4 v15, s[24:27], s72 offen offset:3072 lds
v_mfma_f32_16x16x32_bf16 v[148:151], a[128:131], a[212:215], v[148:151]
ds_read_b64 a[180:181], v6 offset:2880
ds_read_b64 a[182:183], v6 offset:2888
v_mfma_f32_16x16x32_bf16 v[152:155], a[128:131], a[216:219], v[152:155]
v_add_u32 v116, 131072, v116
v_xor_b32 v117, 32, v116
v_mfma_f32_16x16x32_bf16 v[152:155], a[132:135], a[212:215], v[152:155]
v_xor_b32 v118, 64, v116
v_xor_b32 v119, 0x60, v116
v_mfma_f32_16x16x32_bf16 v[152:155], a[136:139], a[208:211], v[152:155]
ds_read_b128 a[248:251], v7 offset:832
ds_read_b64 a[184:185], v6 offset:3392
v_mfma_f32_16x16x32_bf16 v[152:155], a[140:143], a[204:207], v[152:155]
v_mfma_f32_16x16x32_bf16 v[152:155], a[144:147], a[200:203], v[152:155]
ds_read_b64 a[186:187], v6 offset:3400
ds_read_b128 a[252:255], v7 offset:320
v_mfma_f32_16x16x32_bf16 v[152:155], a[148:151], a[196:199], v[152:155]
v_mfma_f32_16x16x32_bf16 v[152:155], a[152:155], a[192:195], v[152:155]
v_mfma_f32_16x16x32_bf16 v[156:159], a[156:159], a[192:195], v[156:159]
ds_read_b64 a[188:189], v6 offset:3904
ds_read_b64 a[190:191], v6 offset:3912
v_mfma_f32_16x16x32_bf16 v[156:159], a[152:155], a[196:199], v[156:159]
v_mfma_f32_16x16x32_bf16 v[156:159], a[148:151], a[200:203], v[156:159]
v_mfma_f32_16x16x32_bf16 v[156:159], a[144:147], a[204:207], v[156:159]
v_mfma_f32_16x16x32_bf16 v[156:159], a[140:143], a[208:211], v[156:159]
v_mfma_f32_16x16x32_bf16 v[156:159], a[136:139], a[212:215], v[156:159]
v_mfma_f32_16x16x32_bf16 v[156:159], a[132:135], a[216:219], v[156:159]
v_mfma_f32_16x16x32_bf16 v[156:159], a[128:131], a[220:223], v[156:159]
s_waitcnt lgkmcnt(0)
v_mfma_f32_16x16x32_bf16 v[128:131], a[160:163], a[224:227], v[128:131]
ds_read_b128 a[192:195], v7 offset:3968
ds_read_b64 a[128:129], v6 offset:384
v_mfma_f32_16x16x32_bf16 v[132:135], a[164:167], a[224:227], v[132:135]
v_mfma_f32_16x16x32_bf16 v[132:135], a[160:163], a[228:231], v[132:135]
ds_read_b64 a[130:131], v6 offset:392
ds_read_b128 a[196:199], v7 offset:3456
v_mfma_f32_16x16x32_bf16 v[136:139], a[160:163], a[232:235], v[136:139]
v_mfma_f32_16x16x32_bf16 v[136:139], a[164:167], a[228:231], v[136:139]
v_mfma_f32_16x16x32_bf16 v[136:139], a[168:171], a[224:227], v[136:139]
ds_read_b64 a[132:133], v6 offset:896
ds_read_b64 a[134:135], v6 offset:904
v_mfma_f32_16x16x32_bf16 v[140:143], a[172:175], a[224:227], v[140:143]
v_mfma_f32_16x16x32_bf16 v[140:143], a[168:171], a[228:231], v[140:143]
ds_read_b128 a[200:203], v7 offset:2944
ds_read_b64 a[136:137], v6 offset:1408
v_mfma_f32_16x16x32_bf16 v[140:143], a[164:167], a[232:235], v[140:143]
v_mfma_f32_16x16x32_bf16 v[140:143], a[160:163], a[236:239], v[140:143]
v_mfma_f32_16x16x32_bf16 v[144:147], a[160:163], a[240:243], v[144:147]
ds_read_b64 a[138:139], v6 offset:1416
ds_read_b128 a[204:207], v7 offset:2432
v_mfma_f32_16x16x32_bf16 v[144:147], a[164:167], a[236:239], v[144:147]
v_mfma_f32_16x16x32_bf16 v[144:147], a[168:171], a[232:235], v[144:147]
ds_read_b64 a[140:141], v6 offset:1920
ds_read_b64 a[142:143], v6 offset:1928
v_mfma_f32_16x16x32_bf16 v[144:147], a[172:175], a[228:231], v[144:147]
v_mfma_f32_16x16x32_bf16 v[144:147], a[176:179], a[224:227], v[144:147]
v_mfma_f32_16x16x32_bf16 v[148:151], a[180:183], a[224:227], v[148:151]
ds_read_b128 a[208:211], v7 offset:1920
ds_read_b64 a[144:145], v6 offset:2432
v_mfma_f32_16x16x32_bf16 v[148:151], a[176:179], a[228:231], v[148:151]
v_mfma_f32_16x16x32_bf16 v[148:151], a[172:175], a[232:235], v[148:151]
s_waitcnt vmcnt(2)
v_cmp_gt_u32 vcc, 2, v3
s_or_b32 s81, vcc_lo, vcc_hi
s_cselect_b32 s81, 0x40000000, 0
v_or_b32 v4, s81, v1
v_mfma_f32_16x16x32_bf16 v[148:151], a[168:171], a[236:239], v[148:151]
ds_read_b64 a[146:147], v6 offset:2440
ds_read_b128 a[212:215], v7 offset:1408
v_mfma_f32_16x16x32_bf16 v[148:151], a[164:167], a[240:243], v[148:151]
v_mfma_f32_16x16x32_bf16 v[148:151], a[160:163], a[244:247], v[148:151]
ds_read_b64 a[148:149], v6 offset:2944
ds_read_b64 a[150:151], v6 offset:2952
v_mfma_f32_16x16x32_bf16 v[152:155], a[160:163], a[248:251], v[152:155]
v_mfma_f32_16x16x32_bf16 v[152:155], a[164:167], a[244:247], v[152:155]
v_mfma_f32_16x16x32_bf16 v[152:155], a[168:171], a[240:243], v[152:155]
s_lshr_b32 s69, s12, 6
ds_read_b128 a[216:219], v7 offset:896
ds_read_b64 a[152:153], v6 offset:3456
v_mfma_f32_16x16x32_bf16 v[152:155], a[172:175], a[236:239], v[152:155]
s_add_u32 s69, s69, s95
buffer_load_dwordx4 a[0:3], v4, s[44:47], s69 offen sc1
v_mfma_f32_16x16x32_bf16 v[152:155], a[176:179], a[232:235], v[152:155]
ds_read_b64 a[154:155], v6 offset:3464
ds_read_b128 a[220:223], v7 offset:384
v_mfma_f32_16x16x32_bf16 v[152:155], a[180:183], a[228:231], v[152:155]
v_mfma_f32_16x16x32_bf16 v[152:155], a[184:187], a[224:227], v[152:155]
buffer_load_dwordx4 a[4:7], v4, s[44:47], s69 offen offset:1024 sc1
v_mfma_f32_16x16x32_bf16 v[156:159], a[188:191], a[224:227], v[156:159]
ds_read_b64 a[156:157], v6 offset:3968
ds_read_b64 a[158:159], v6 offset:3976
v_mfma_f32_16x16x32_bf16 v[156:159], a[184:187], a[228:231], v[156:159]
v_mfma_f32_16x16x32_bf16 v[156:159], a[180:183], a[232:235], v[156:159]
v_mfma_f32_16x16x32_bf16 v[156:159], a[176:179], a[236:239], v[156:159]
v_mfma_f32_16x16x32_bf16 v[156:159], a[172:175], a[240:243], v[156:159]
buffer_load_dwordx4 a[8:11], v4, s[44:47], s69 offen offset:2048 sc1
v_mfma_f32_16x16x32_bf16 v[156:159], a[168:171], a[244:247], v[156:159]
v_mfma_f32_16x16x32_bf16 v[156:159], a[164:167], a[248:251], v[156:159]
v_mfma_f32_16x16x32_bf16 v[156:159], a[160:163], a[252:255], v[156:159]
s_waitcnt lgkmcnt(0)
v_mfma_f32_16x16x32_bf16 v[128:131], a[128:131], a[192:195], v[128:131]
ds_read_b128 a[224:227], v7 offset:4032
ds_read_b64 a[160:161], v6 offset:448
v_mfma_f32_16x16x32_bf16 v[132:135], a[132:135], a[192:195], v[132:135]
buffer_load_dwordx4 a[12:15], v4, s[44:47], s69 offen offset:3072 sc1
v_mfma_f32_16x16x32_bf16 v[132:135], a[128:131], a[196:199], v[132:135]
ds_read_b64 a[162:163], v6 offset:456
ds_read_b128 a[228:231], v7 offset:3520
v_mfma_f32_16x16x32_bf16 v[136:139], a[128:131], a[200:203], v[136:139]
v_mfma_f32_16x16x32_bf16 v[136:139], a[132:135], a[196:199], v[136:139]
v_mfma_f32_16x16x32_bf16 v[136:139], a[136:139], a[192:195], v[136:139]
ds_read_b64 a[164:165], v6 offset:960
ds_read_b64 a[166:167], v6 offset:968
v_mfma_f32_16x16x32_bf16 v[140:143], a[140:143], a[192:195], v[140:143]
s_add_u32 s69, s69, 0x20000
buffer_load_dwordx4 a[16:19], v4, s[44:47], s69 offen sc1
v_mfma_f32_16x16x32_bf16 v[140:143], a[136:139], a[196:199], v[140:143]
ds_read_b128 a[232:235], v7 offset:3008
ds_read_b64 a[168:169], v6 offset:1472
v_mfma_f32_16x16x32_bf16 v[140:143], a[132:135], a[200:203], v[140:143]
v_mfma_f32_16x16x32_bf16 v[140:143], a[128:131], a[204:207], v[140:143]
v_mfma_f32_16x16x32_bf16 v[144:147], a[128:131], a[208:211], v[144:147]
ds_read_b64 a[170:171], v6 offset:1480
ds_read_b128 a[236:239], v7 offset:2496
v_mfma_f32_16x16x32_bf16 v[144:147], a[132:135], a[204:207], v[144:147]
buffer_load_dwordx4 a[20:23], v4, s[44:47], s69 offen offset:1024 sc1
v_mfma_f32_16x16x32_bf16 v[144:147], a[136:139], a[200:203], v[144:147]
ds_read_b64 a[172:173], v6 offset:1984
ds_read_b64 a[174:175], v6 offset:1992
v_mfma_f32_16x16x32_bf16 v[144:147], a[140:143], a[196:199], v[144:147]
v_mfma_f32_16x16x32_bf16 v[144:147], a[144:147], a[192:195], v[144:147]
v_mfma_f32_16x16x32_bf16 v[148:151], a[148:151], a[192:195], v[148:151]
ds_read_b128 a[240:243], v7 offset:1984
ds_read_b64 a[176:177], v6 offset:2496
v_mfma_f32_16x16x32_bf16 v[148:151], a[144:147], a[196:199], v[148:151]
buffer_load_dwordx4 a[24:27], v4, s[44:47], s69 offen offset:2048 sc1
v_mfma_f32_16x16x32_bf16 v[148:151], a[140:143], a[200:203], v[148:151]
v_mfma_f32_16x16x32_bf16 v[148:151], a[136:139], a[204:207], v[148:151]
ds_read_b64 a[178:179], v6 offset:2504
ds_read_b128 a[244:247], v7 offset:1472
v_mfma_f32_16x16x32_bf16 v[148:151], a[132:135], a[208:211], v[148:151]
v_mfma_f32_16x16x32_bf16 v[148:151], a[128:131], a[212:215], v[148:151]
ds_read_b64 a[180:181], v6 offset:3008
ds_read_b64 a[182:183], v6 offset:3016
v_mfma_f32_16x16x32_bf16 v[152:155], a[128:131], a[216:219], v[152:155]
buffer_load_dwordx4 a[28:31], v4, s[44:47], s69 offen offset:3072 sc1
v_mfma_f32_16x16x32_bf16 v[152:155], a[132:135], a[212:215], v[152:155]
v_mfma_f32_16x16x32_bf16 v[152:155], a[136:139], a[208:211], v[152:155]
s_add_u32 s79, s59, 12
ds_read_b128 a[248:251], v7 offset:960
ds_read_b64 a[184:185], v6 offset:3520
v_mfma_f32_16x16x32_bf16 v[152:155], a[140:143], a[204:207], v[152:155]
s_and_b32 s79, s79, 28
v_mfma_f32_16x16x32_bf16 v[152:155], a[144:147], a[200:203], v[152:155]
s_lshl_b32 s79, s79, 10
ds_read_b64 a[186:187], v6 offset:3528
ds_read_b128 a[252:255], v7 offset:448
v_mfma_f32_16x16x32_bf16 v[152:155], a[148:151], a[196:199], v[152:155]
s_add_u32 s79, s79, s74
buffer_load_dword v14, v2, s[44:47], s79 offen sc1
v_mfma_f32_16x16x32_bf16 v[152:155], a[152:155], a[192:195], v[152:155]
v_mfma_f32_16x16x32_bf16 v[156:159], a[156:159], a[192:195], v[156:159]
ds_read_b64 a[188:189], v6 offset:4032
ds_read_b64 a[190:191], v6 offset:4040
v_mfma_f32_16x16x32_bf16 v[156:159], a[152:155], a[196:199], v[156:159]
s_lshr_b32 s69, s13, 6
v_mfma_f32_16x16x32_bf16 v[156:159], a[148:151], a[200:203], v[156:159]
s_add_u32 s69, s69, s95
buffer_load_dwordx4 a[32:35], v4, s[44:47], s69 offen sc1
v_mfma_f32_16x16x32_bf16 v[156:159], a[144:147], a[204:207], v[156:159]
v_mfma_f32_16x16x32_bf16 v[156:159], a[140:143], a[208:211], v[156:159]
v_mfma_f32_16x16x32_bf16 v[156:159], a[136:139], a[212:215], v[156:159]
v_mfma_f32_16x16x32_bf16 v[156:159], a[132:135], a[216:219], v[156:159]
v_mfma_f32_16x16x32_bf16 v[156:159], a[128:131], a[220:223], v[156:159]
s_waitcnt lgkmcnt(0)
buffer_load_dwordx4 a[36:39], v4, s[44:47], s69 offen offset:1024 sc1
v_mfma_f32_16x16x32_bf16 v[128:131], a[160:163], a[224:227], v[128:131]
ds_read_b64_tr_b16 v[192:193], v8 offset:0
ds_read_b64_tr_b16 v[194:195], v8 offset:2048
v_mfma_f32_16x16x32_bf16 v[132:135], a[164:167], a[224:227], v[132:135]
v_mfma_f32_16x16x32_bf16 v[132:135], a[160:163], a[228:231], v[132:135]
ds_read_b64_tr_b16 v[196:197], v9 offset:0
ds_read_b64_tr_b16 v[198:199], v9 offset:2048
v_mfma_f32_16x16x32_bf16 v[136:139], a[160:163], a[232:235], v[136:139]
v_mfma_f32_16x16x32_bf16 v[136:139], a[164:167], a[228:231], v[136:139]
ds_read_b64_tr_b16 v[200:201], v10 offset:0
ds_read_b64_tr_b16 v[202:203], v10 offset:2048
v_mfma_f32_16x16x32_bf16 v[136:139], a[168:171], a[224:227], v[136:139]
buffer_load_dwordx4 a[40:43], v4, s[44:47], s69 offen offset:2048 sc1
v_mfma_f32_16x16x32_bf16 v[140:143], a[172:175], a[224:227], v[140:143]
ds_read_b64_tr_b16 v[204:205], v11 offset:0
ds_read_b64_tr_b16 v[206:207], v11 offset:2048
v_mfma_f32_16x16x32_bf16 v[140:143], a[168:171], a[228:231], v[140:143]
v_cvt_pk_bf16_f32 v128, v128, v129
v_cvt_pk_bf16_f32 v129, v130, v131
v_cvt_pk_bf16_f32 v130, v132, v133
v_mfma_f32_16x16x32_bf16 v[140:143], a[164:167], a[232:235], v[140:143]
ds_read_b64_tr_b16 v[208:209], v8 offset:4096
ds_read_b64_tr_b16 v[210:211], v8 offset:6144
v_cvt_pk_bf16_f32 v131, v134, v135
v_mfma_f32_16x16x32_bf16 v[140:143], a[160:163], a[236:239], v[140:143]
buffer_load_dwordx4 a[44:47], v4, s[44:47], s69 offen offset:3072 sc1
v_permlane32_swap_b32 v128, v130
v_mfma_f32_16x16x32_bf16 v[144:147], a[160:163], a[240:243], v[144:147]
ds_read_b64_tr_b16 v[212:213], v9 offset:4096
ds_read_b64_tr_b16 v[214:215], v9 offset:6144
v_permlane32_swap_b32 v129, v131
v_mfma_f32_16x16x32_bf16 v[144:147], a[164:167], a[236:239], v[144:147]
buffer_store_dwordx4 v[128:131], v166, s[44:47], s80 offen sc1
v_mfma_f32_16x16x32_bf16 v[144:147], a[168:171], a[232:235], v[144:147]
ds_read_b64_tr_b16 v[216:217], v10 offset:4096
ds_read_b64_tr_b16 v[218:219], v10 offset:6144
v_mfma_f32_16x16x32_bf16 v[144:147], a[172:175], a[228:231], v[144:147]
v_mfma_f32_16x16x32_bf16 v[144:147], a[176:179], a[224:227], v[144:147]
ds_read_b64_tr_b16 v[220:221], v11 offset:4096
ds_read_b64_tr_b16 v[222:223], v11 offset:6144
v_cvt_pk_bf16_f32 v136, v136, v137
v_mfma_f32_16x16x32_bf16 v[148:151], a[180:183], a[224:227], v[148:151]
s_add_u32 s69, s69, 0x20000
buffer_load_dwordx4 a[48:51], v4, s[44:47], s69 offen sc1
v_cvt_pk_bf16_f32 v137, v138, v139
v_mfma_f32_16x16x32_bf16 v[148:151], a[176:179], a[228:231], v[148:151]
ds_read_b64_tr_b16 v[224:225], v8 offset:8192
ds_read_b64_tr_b16 v[226:227], v8 offset:10240
v_cvt_pk_bf16_f32 v138, v140, v141
v_mfma_f32_16x16x32_bf16 v[148:151], a[172:175], a[232:235], v[148:151]
v_cvt_pk_bf16_f32 v139, v142, v143
v_permlane32_swap_b32 v136, v138
s_nop 0
v_permlane32_swap_b32 v137, v139
v_mfma_f32_16x16x32_bf16 v[148:151], a[168:171], a[236:239], v[148:151]
ds_read_b64_tr_b16 v[228:229], v9 offset:8192
ds_read_b64_tr_b16 v[230:231], v9 offset:10240
v_mfma_f32_16x16x32_bf16 v[148:151], a[164:167], a[240:243], v[148:151]
buffer_load_dwordx4 a[52:55], v4, s[44:47], s69 offen offset:1024 sc1
v_mfma_f32_16x16x32_bf16 v[148:151], a[160:163], a[244:247], v[148:151]
ds_read_b64_tr_b16 v[232:233], v10 offset:8192
ds_read_b64_tr_b16 v[234:235], v10 offset:10240
v_mfma_f32_16x16x32_bf16 v[152:155], a[160:163], a[248:251], v[152:155]
Lstub9:
s_cbranch_execz Lret
buffer_store_dwordx4 v[136:139], v166, s[44:47], s80 offen offset:1024 sc1
v_mfma_f32_16x16x32_bf16 v[152:155], a[164:167], a[244:247], v[152:155]
ds_read_b64_tr_b16 v[236:237], v11 offset:8192
ds_read_b64_tr_b16 v[238:239], v11 offset:10240
v_mfma_f32_16x16x32_bf16 v[152:155], a[168:171], a[240:243], v[152:155]
v_mfma_f32_16x16x32_bf16 v[152:155], a[172:175], a[236:239], v[152:155]
ds_read_b64_tr_b16 v[240:241], v8 offset:12288
ds_read_b64_tr_b16 v[242:243], v8 offset:14336
v_mfma_f32_16x16x32_bf16 v[152:155], a[176:179], a[232:235], v[152:155]
buffer_load_dwordx4 a[56:59], v4, s[44:47], s69 offen offset:2048 sc1
v_cvt_pk_bf16_f32 v144, v144, v145
v_mfma_f32_16x16x32_bf16 v[152:155], a[180:183], a[228:231], v[152:155]
ds_read_b64_tr_b16 v[244:245], v9 offset:12288
ds_read_b64_tr_b16 v[246:247], v9 offset:14336
v_cvt_pk_bf16_f32 v145, v146, v147
v_mfma_f32_16x16x32_bf16 v[152:155], a[184:187], a[224:227], v[152:155]
v_cvt_pk_bf16_f32 v146, v148, v149
v_cvt_pk_bf16_f32 v147, v150, v151
s_nop 0
v_permlane32_swap_b32 v144, v146
v_mfma_f32_16x16x32_bf16 v[156:159], a[188:191], a[224:227], v[156:159]
ds_read_b64_tr_b16 v[248:249], v10 offset:12288
ds_read_b64_tr_b16 v[250:251], v10 offset:14336
v_permlane32_swap_b32 v145, v147
v_mfma_f32_16x16x32_bf16 v[156:159], a[184:187], a[228:231], v[156:159]
buffer_load_dwordx4 a[60:63], v4, s[44:47], s69 offen offset:3072 sc1
v_mfma_f32_16x16x32_bf16 v[156:159], a[180:183], a[232:235], v[156:159]
ds_read_b64_tr_b16 v[252:253], v11 offset:12288
ds_read_b64_tr_b16 v[254:255], v11 offset:14336
v_mfma_f32_16x16x32_bf16 v[156:159], a[176:179], a[236:239], v[156:159]
buffer_store_dwordx4 v[144:147], v166, s[44:47], s80 offen offset:2048 sc1
v_mfma_f32_16x16x32_bf16 v[156:159], a[172:175], a[240:243], v[156:159]
v_mfma_f32_16x16x32_bf16 v[156:159], a[168:171], a[244:247], v[156:159]
v_mfma_f32_16x16x32_bf16 v[156:159], a[164:167], a[248:251], v[156:159]
v_mfma_f32_16x16x32_bf16 v[156:159], a[160:163], a[252:255], v[156:159]
v_cvt_pk_bf16_f32 v152, v152, v153
v_cvt_pk_bf16_f32 v153, v154, v155
s_nop 5
v_cvt_pk_bf16_f32 v154, v156, v157
v_cvt_pk_bf16_f32 v155, v158, v159
s_nop 0
v_permlane32_swap_b32 v152, v154
v_permlane32_swap_b32 v153, v155
buffer_store_dwordx4 v[152:155], v166, s[44:47], s80 offen offset:3072 sc1
s_waitcnt vmcnt(13) lgkmcnt(0)
s_cmp_lg_u32 s81, 0
s_cbranch_scc1 Lredo0
Lredo0b:
s_barrier
v_mfma_f32_16x16x32_bf16 v[48:51], v[192:195], a[0:3], 0
ds_read_b64_tr_b16 v[128:129], v8 offset:16384
ds_read_b64_tr_b16 v[130:131], v8 offset:18432
v_mfma_f32_16x16x32_bf16 v[48:51], v[208:211], a[4:7], v[48:51]
s_add_u32 s71, s14, s78
ds_read_b64_tr_b16 v[132:133], v9 offset:16384
ds_read_b64_tr_b16 v[134:135], v9 offset:18432
v_mfma_f32_16x16x32_bf16 v[48:51], v[224:227], a[8:11], v[48:51]
s_add_u32 m0, s77, 0
ds_read_b64_tr_b16 v[136:137], v10 offset:16384
ds_read_b64_tr_b16 v[138:139], v10 offset:18432
v_mfma_f32_16x16x32_bf16 v[48:51], v[240:243], a[12:15], v[48:51]
s_add_u32 s72, s71, 0
buffer_load_dwordx4 v15, s[24:27], s72 offen lds
v_mfma_f32_16x16x32_bf16 v[64:67], v[240:243], a[28:31], 0
ds_read_b64_tr_b16 v[140:141], v11 offset:16384
v_mfma_f32_16x16x32_bf16 v[64:67], v[224:227], a[24:27], v[64:67]
s_lshr_b32 s69, s14, 6
ds_read_b64_tr_b16 v[142:143], v11 offset:18432
ds_read_b64_tr_b16 v[144:145], v8 offset:20480
v_mfma_f32_16x16x32_bf16 v[64:67], v[208:211], a[20:23], v[64:67]
s_add_u32 s69, s69, s95
buffer_load_dwordx4 a[64:67], v1, s[44:47], s69 offen sc1
v_mfma_f32_16x16x32_bf16 v[64:67], v[192:195], a[16:19], v[64:67]
ds_read_b64_tr_b16 v[146:147], v8 offset:22528
ds_read_b64_tr_b16 v[148:149], v9 offset:20480
v_mfma_f32_16x16x32_bf16 v[68:71], v[196:199], a[16:19], 0
ds_read_b64_tr_b16 v[150:151], v9 offset:22528
v_mfma_f32_16x16x32_bf16 v[68:71], v[212:215], a[20:23], v[68:71]
ds_read_b64_tr_b16 v[152:153], v10 offset:20480
ds_read_b64_tr_b16 v[154:155], v10 offset:22528
v_mfma_f32_16x16x32_bf16 v[68:71], v[228:231], a[24:27], v[68:71]
s_add_u32 s72, s71, 15360
buffer_load_dwordx4 v15, s[24:27], s72 offen offset:1024 lds
v_mfma_f32_16x16x32_bf16 v[68:71], v[244:247], a[28:31], v[68:71]
ds_read_b64_tr_b16 v[156:157], v11 offset:20480
ds_read_b64_tr_b16 v[158:159], v11 offset:22528
v_mfma_f32_16x16x32_bf16 v[52:55], v[244:247], a[12:15], 0
buffer_load_dwordx4 a[68:71], v1, s[44:47], s69 offen offset:1024 sc1
v_mfma_f32_16x16x32_bf16 v[52:55], v[228:231], a[8:11], v[52:55]
ds_read_b64_tr_b16 v[160:161], v8 offset:24576
v_mfma_f32_16x16x32_bf16 v[52:55], v[212:215], a[4:7], v[52:55]
ds_read_b64_tr_b16 v[162:163], v8 offset:26624
ds_read_b64_tr_b16 v[164:165], v9 offset:24576
v_mfma_f32_16x16x32_bf16 v[52:55], v[196:199], a[0:3], v[52:55]
ds_read_b64_tr_b16 v[166:167], v9 offset:26624
ds_read_b64_tr_b16 v[168:169], v10 offset:24576
v_mfma_f32_16x16x32_bf16 v[56:59], v[200:203], a[0:3], 0
ds_read_b64_tr_b16 v[170:171], v10 offset:26624
v_mfma_f32_16x16x32_bf16 v[56:59], v[216:219], a[4:7], v[56:59]
s_add_u32 s72, s71, 30720
buffer_load_dwordx4 v15, s[24:27], s72 offen offset:2048 lds
v_mfma_f32_16x16x32_bf16 v[56:59], v[232:235], a[8:11], v[56:59]
ds_read_b64_tr_b16 v[172:173], v11 offset:24576
ds_read_b64_tr_b16 v[174:175], v11 offset:26624
v_mfma_f32_16x16x32_bf16 v[56:59], v[248:251], a[12:15], v[56:59]
buffer_load_dwordx4 a[72:75], v1, s[44:47], s69 offen offset:2048 sc1
v_mfma_f32_16x16x32_bf16 v[72:75], v[248:251], a[28:31], 0
ds_read_b64_tr_b16 v[176:177], v8 offset:28672
ds_read_b64_tr_b16 v[178:179], v8 offset:30720
v_mfma_f32_16x16x32_bf16 v[72:75], v[232:235], a[24:27], v[72:75]
ds_read_b64_tr_b16 v[180:181], v9 offset:28672
v_mfma_f32_16x16x32_bf16 v[72:75], v[216:219], a[20:23], v[72:75]
ds_read_b64_tr_b16 v[182:183], v9 offset:30720
ds_read_b64_tr_b16 v[184:185], v10 offset:28672
v_mfma_f32_16x16x32_bf16 v[72:75], v[200:203], a[16:19], v[72:75]
ds_read_b64_tr_b16 v[186:187], v10 offset:30720
ds_read_b64_tr_b16 v[188:189], v11 offset:28672
v_mfma_f32_16x16x32_bf16 v[76:79], v[204:207], a[16:19], 0
s_add_u32 s72, s71, 46080
buffer_load_dwordx4 v15, s[24:27], s72 offen offset:3072 lds
v_mfma_f32_16x16x32_bf16 v[76:79], v[220:223], a[20:23], v[76:79]
ds_read_b64_tr_b16 v[190:191], v11 offset:30720
v_mfma_f32_16x16x32_bf16 v[76:79], v[236:239], a[24:27], v[76:79]
buffer_load_dwordx4 a[76:79], v1, s[44:47], s69 offen offset:3072 sc1
v_mfma_f32_16x16x32_bf16 v[76:79], v[252:255], a[28:31], v[76:79]
v_mfma_f32_16x16x32_bf16 v[60:63], v[252:255], a[12:15], 0
v_mfma_f32_16x16x32_bf16 v[60:63], v[236:239], a[8:11], v[60:63]
v_mfma_f32_16x16x32_bf16 v[60:63], v[220:223], a[4:7], v[60:63]
s_waitcnt vmcnt(16) lgkmcnt(0)
v_mfma_f32_16x16x32_bf16 v[60:63], v[204:207], a[0:3], v[60:63]
s_barrier
v_mfma_f32_16x16x32_bf16 v[16:19], v[128:131], a[0:3], 0
s_add_u32 s69, s69, 0x20000
ds_read_b64_tr_b16 v[192:193], v8 offset:32768
ds_read_b64_tr_b16 v[194:195], v8 offset:34816
v_mfma_f32_16x16x32_bf16 v[16:19], v[144:147], a[4:7], v[16:19]
s_add_u32 s71, s14, s94
buffer_load_dwordx4 a[80:83], v1, s[44:47], s69 offen sc1
v_mfma_f32_16x16x32_bf16 v[16:19], v[160:163], a[8:11], v[16:19]
s_add_u32 m0, s77, 16384
ds_read_b64_tr_b16 v[196:197], v9 offset:32768
ds_read_b64_tr_b16 v[198:199], v9 offset:34816
v_mfma_f32_16x16x32_bf16 v[16:19], v[176:179], a[12:15], v[16:19]
s_add_u32 s72, s71, 0
buffer_load_dwordx4 v15, s[24:27], s72 offen lds
v_mfma_f32_16x16x32_bf16 v[32:35], v[176:179], a[28:31], 0
ds_read_b64_tr_b16 v[200:201], v10 offset:32768
ds_read_b64_tr_b16 v[202:203], v10 offset:34816
v_mfma_f32_16x16x32_bf16 v[32:35], v[160:163], a[24:27], v[32:35]
ds_read_b64_tr_b16 v[204:205], v11 offset:32768
v_mfma_f32_16x16x32_bf16 v[32:35], v[144:147], a[20:23], v[32:35]
ds_read_b64_tr_b16 v[206:207], v11 offset:34816
ds_read_b64_tr_b16 v[208:209], v8 offset:36864
v_mfma_f32_16x16x32_bf16 v[32:35], v[128:131], a[16:19], v[32:35]
ds_read_b64_tr_b16 v[210:211], v8 offset:38912
ds_read_b64_tr_b16 v[212:213], v9 offset:36864
v_mfma_f32_16x16x32_bf16 v[36:39], v[132:135], a[16:19], 0
buffer_load_dwordx4 a[84:87], v1, s[44:47], s69 offen offset:1024 sc1
v_mfma_f32_16x16x32_bf16 v[36:39], v[148:151], a[20:23], v[36:39]
ds_read_b64_tr_b16 v[214:215], v9 offset:38912
v_mfma_f32_16x16x32_bf16 v[36:39], v[164:167], a[24:27], v[36:39]
s_add_u32 s72, s71, 15360
buffer_load_dwordx4 v15, s[24:27], s72 offen offset:1024 lds
v_mfma_f32_16x16x32_bf16 v[36:39], v[180:183], a[28:31], v[36:39]
ds_read_b64_tr_b16 v[216:217], v10 offset:36864
ds_read_b64_tr_b16 v[218:219], v10 offset:38912
v_mfma_f32_16x16x32_bf16 v[20:23], v[180:183], a[12:15], 0
ds_read_b64_tr_b16 v[220:221], v11 offset:36864
ds_read_b64_tr_b16 v[222:223], v11 offset:38912
v_mfma_f32_16x16x32_bf16 v[20:23], v[164:167], a[8:11], v[20:23]
ds_read_b64_tr_b16 v[224:225], v8 offset:40960
v_mfma_f32_16x16x32_bf16 v[20:23], v[148:151], a[4:7], v[20:23]
ds_read_b64_tr_b16 v[226:227], v8 offset:43008
ds_read_b64_tr_b16 v[228:229], v9 offset:40960
v_mfma_f32_16x16x32_bf16 v[20:23], v[132:135], a[0:3], v[20:23]
buffer_load_dwordx4 a[88:91], v1, s[44:47], s69 offen offset:2048 sc1
v_mfma_f32_16x16x32_bf16 v[24:27], v[136:139], a[0:3], 0
ds_read_b64_tr_b16 v[230:231], v9 offset:43008
ds_read_b64_tr_b16 v[232:233], v10 offset:40960
v_mfma_f32_16x16x32_bf16 v[24:27], v[152:155], a[4:7], v[24:27]
s_add_u32 s72, s71, 30720
buffer_load_dwordx4 v15, s[24:27], s72 offen offset:2048 lds
v_mfma_f32_16x16x32_bf16 v[24:27], v[168:171], a[8:11], v[24:27]
ds_read_b64_tr_b16 v[234:235], v10 offset:43008
v_mfma_f32_16x16x32_bf16 v[24:27], v[184:187], a[12:15], v[24:27]
ds_read_b64_tr_b16 v[236:237], v11 offset:40960
ds_read_b64_tr_b16 v[238:239], v11 offset:43008
v_mfma_f32_16x16x32_bf16 v[40:43], v[184:187], a[28:31], 0
ds_read_b64_tr_b16 v[240:241], v8 offset:45056
ds_read_b64_tr_b16 v[242:243], v8 offset:47104
v_mfma_f32_16x16x32_bf16 v[40:43], v[168:171], a[24:27], v[40:43]
ds_read_b64_tr_b16 v[244:245], v9 offset:45056
v_mfma_f32_16x16x32_bf16 v[40:43], v[152:155], a[20:23], v[40:43]
buffer_load_dwordx4 a[92:95], v1, s[44:47], s69 offen offset:3072 sc1
v_mfma_f32_16x16x32_bf16 v[40:43], v[136:139], a[16:19], v[40:43]
ds_read_b64_tr_b16 v[246:247], v9 offset:47104
ds_read_b64_tr_b16 v[248:249], v10 offset:45056
v_mfma_f32_16x16x32_bf16 v[44:47], v[140:143], a[16:19], 0
s_add_u32 s72, s71, 46080
buffer_load_dwordx4 v15, s[24:27], s72 offen offset:3072 lds
v_mfma_f32_16x16x32_bf16 v[44:47], v[156:159], a[20:23], v[44:47]
ds_read_b64_tr_b16 v[250:251], v10 offset:47104
ds_read_b64_tr_b16 v[252:253], v11 offset:45056
v_mfma_f32_16x16x32_bf16 v[44:47], v[172:175], a[24:27], v[44:47]
ds_read_b64_tr_b16 v[254:255], v11 offset:47104
v_mfma_f32_16x16x32_bf16 v[44:47], v[188:191], a[28:31], v[44:47]
v_mfma_f32_16x16x32_bf16 v[28:31], v[188:191], a[12:15], 0
s_lshr_b32 s69, s15, 6
v_mfma_f32_16x16x32_bf16 v[28:31], v[172:175], a[8:11], v[28:31]
s_add_u32 s69, s69, s95
buffer_load_dwordx4 a[96:99], v1, s[44:47], s69 offen sc1
v_mfma_f32_16x16x32_bf16 v[28:31], v[156:159], a[4:7], v[28:31]
s_waitcnt vmcnt(17) lgkmcnt(0)
v_mfma_f32_16x16x32_bf16 v[28:31], v[140:143], a[0:3], v[28:31]
s_barrier
v_mfma_f32_16x16x32_bf16 v[48:51], v[192:195], a[32:35], v[48:51]
ds_read_b64_tr_b16 v[128:129], v8 offset:49152
ds_read_b64_tr_b16 v[130:131], v8 offset:51200
v_mfma_f32_16x16x32_bf16 v[48:51], v[208:211], a[36:39], v[48:51]
s_add_u32 s71, s15, s78
ds_read_b64_tr_b16 v[132:133], v9 offset:49152
ds_read_b64_tr_b16 v[134:135], v9 offset:51200
v_mfma_f32_16x16x32_bf16 v[48:51], v[224:227], a[40:43], v[48:51]
s_add_u32 m0, s77, 32768
ds_read_b64_tr_b16 v[136:137], v10 offset:49152
ds_read_b64_tr_b16 v[138:139], v10 offset:51200
v_mfma_f32_16x16x32_bf16 v[48:51], v[240:243], a[44:47], v[48:51]
s_add_u32 s72, s71, 0
buffer_load_dwordx4 v15, s[24:27], s72 offen lds
v_mfma_f32_16x16x32_bf16 v[64:67], v[240:243], a[60:63], v[64:67]
buffer_load_dwordx4 a[100:103], v1, s[44:47], s69 offen offset:1024 sc1
v_mfma_f32_16x16x32_bf16 v[64:67], v[224:227], a[56:59], v[64:67]
ds_read_b64_tr_b16 v[140:141], v11 offset:49152
v_mfma_f32_16x16x32_bf16 v[64:67], v[208:211], a[52:55], v[64:67]
ds_read_b64_tr_b16 v[142:143], v11 offset:51200
ds_read_b64_tr_b16 v[144:145], v8 offset:53248
v_mfma_f32_16x16x32_bf16 v[64:67], v[192:195], a[48:51], v[64:67]
ds_read_b64_tr_b16 v[146:147], v8 offset:55296
ds_read_b64_tr_b16 v[148:149], v9 offset:53248
v_mfma_f32_16x16x32_bf16 v[68:71], v[196:199], a[48:51], v[68:71]
ds_read_b64_tr_b16 v[150:151], v9 offset:55296
v_mfma_f32_16x16x32_bf16 v[68:71], v[212:215], a[52:55], v[68:71]
ds_read_b64_tr_b16 v[152:153], v10 offset:53248
ds_read_b64_tr_b16 v[154:155], v10 offset:55296
v_mfma_f32_16x16x32_bf16 v[68:71], v[228:231], a[56:59], v[68:71]
s_add_u32 s72, s71, 15360
buffer_load_dwordx4 v15, s[24:27], s72 offen offset:1024 lds
v_mfma_f32_16x16x32_bf16 v[68:71], v[244:247], a[60:63], v[68:71]
buffer_load_dwordx4 a[104:107], v1, s[44:47], s69 offen offset:2048 sc1
v_mfma_f32_16x16x32_bf16 v[52:55], v[244:247], a[44:47], v[52:55]
ds_read_b64_tr_b16 v[156:157], v11 offset:53248
ds_read_b64_tr_b16 v[158:159], v11 offset:55296
v_mfma_f32_16x16x32_bf16 v[52:55], v[228:231], a[40:43], v[52:55]
ds_read_b64_tr_b16 v[160:161], v8 offset:57344
v_mfma_f32_16x16x32_bf16 v[52:55], v[212:215], a[36:39], v[52:55]
ds_read_b64_tr_b16 v[162:163], v8 offset:59392
ds_read_b64_tr_b16 v[164:165], v9 offset:57344
v_mfma_f32_16x16x32_bf16 v[52:55], v[196:199], a[32:35], v[52:55]
ds_read_b64_tr_b16 v[166:167], v9 offset:59392
ds_read_b64_tr_b16 v[168:169], v10 offset:57344
v_mfma_f32_16x16x32_bf16 v[56:59], v[200:203], a[32:35], v[56:59]
ds_read_b64_tr_b16 v[170:171], v10 offset:59392
v_mfma_f32_16x16x32_bf16 v[56:59], v[216:219], a[36:39], v[56:59]
s_add_u32 s72, s71, 30720
buffer_load_dwordx4 v15, s[24:27], s72 offen offset:2048 lds
v_mfma_f32_16x16x32_bf16 v[56:59], v[232:235], a[40:43], v[56:59]
buffer_load_dwordx4 a[108:111], v1, s[44:47], s69 offen offset:3072 sc1
v_mfma_f32_16x16x32_bf16 v[56:59], v[248:251], a[44:47], v[56:59]
ds_read_b64_tr_b16 v[172:173], v11 offset:57344
ds_read_b64_tr_b16 v[174:175], v11 offset:59392
v_mfma_f32_16x16x32_bf16 v[72:75], v[248:251], a[60:63], v[72:75]
ds_read_b64_tr_b16 v[176:177], v8 offset:61440
ds_read_b64_tr_b16 v[178:179], v8 offset:63488
v_mfma_f32_16x16x32_bf16 v[72:75], v[232:235], a[56:59], v[72:75]
ds_read_b64_tr_b16 v[180:181], v9 offset:61440
v_mfma_f32_16x16x32_bf16 v[72:75], v[216:219], a[52:55], v[72:75]
ds_read_b64_tr_b16 v[182:183], v9 offset:63488
ds_read_b64_tr_b16 v[184:185], v10 offset:61440
v_mfma_f32_16x16x32_bf16 v[72:75], v[200:203], a[48:51], v[72:75]
ds_read_b64_tr_b16 v[186:187], v10 offset:63488
ds_read_b64_tr_b16 v[188:189], v11 offset:61440
v_mfma_f32_16x16x32_bf16 v[76:79], v[204:207], a[48:51], v[76:79]
s_add_u32 s72, s71, 46080
buffer_load_dwordx4 v15, s[24:27], s72 offen offset:3072 lds
v_mfma_f32_16x16x32_bf16 v[76:79], v[220:223], a[52:55], v[76:79]
s_add_u32 s69, s69, 0x20000
buffer_load_dwordx4 a[112:115], v1, s[44:47], s69 offen sc1
v_mfma_f32_16x16x32_bf16 v[76:79], v[236:239], a[56:59], v[76:79]
ds_read_b64_tr_b16 v[190:191], v11 offset:63488
v_mfma_f32_16x16x32_bf16 v[76:79], v[252:255], a[60:63], v[76:79]
v_mfma_f32_16x16x32_bf16 v[60:63], v[252:255], a[44:47], v[60:63]
v_mfma_f32_16x16x32_bf16 v[60:63], v[236:239], a[40:43], v[60:63]
s_add_u32 s71, s12, 0x200000
v_mfma_f32_16x16x32_bf16 v[60:63], v[220:223], a[36:39], v[60:63]
s_waitcnt vmcnt(18) lgkmcnt(0)
v_mfma_f32_16x16x32_bf16 v[60:63], v[204:207], a[32:35], v[60:63]
s_barrier
buffer_load_dwordx4 a[116:119], v1, s[44:47], s69 offen offset:1024 sc1
v_mfma_f32_16x16x32_bf16 v[16:19], v[128:131], a[32:35], v[16:19]
s_and_b32 s71, s71, 0x7c0000
ds_read_b64_tr_b16 v[192:193], v8 offset:0
ds_read_b64_tr_b16 v[194:195], v8 offset:2048
v_or_b32 v112, s58, v0
v_mov_b32 v113, 3
v_min_u32 v112, 1, v112
v_lshlrev_b32 v112, 30, v112
buffer_store_dword v113, v112, s[44:47], s91 offen sc1
v_mfma_f32_16x16x32_bf16 v[16:19], v[144:147], a[36:39], v[16:19]
s_add_u32 s71, s71, s78
ds_read_b64_tr_b16 v[196:197], v9 offset:0
ds_read_b64_tr_b16 v[198:199], v9 offset:2048
v_mfma_f32_16x16x32_bf16 v[16:19], v[160:163], a[40:43], v[16:19]
s_add_u32 m0, s77, 49152
ds_read_b64_tr_b16 v[200:201], v10 offset:0
ds_read_b64_tr_b16 v[202:203], v10 offset:2048
v_mfma_f32_16x16x32_bf16 v[16:19], v[176:179], a[44:47], v[16:19]
s_add_u32 s72, s71, 0
buffer_load_dwordx4 v15, s[24:27], s72 offen lds
v_mfma_f32_16x16x32_bf16 v[32:35], v[176:179], a[60:63], v[32:35]
ds_read_b64_tr_b16 v[204:205], v11 offset:0
v_mfma_f32_16x16x32_bf16 v[32:35], v[160:163], a[56:59], v[32:35]
ds_read_b64_tr_b16 v[206:207], v11 offset:2048
ds_read_b64_tr_b16 v[208:209], v8 offset:4096
v_mfma_f32_16x16x32_bf16 v[32:35], v[144:147], a[52:55], v[32:35]
buffer_load_dwordx4 a[120:123], v1, s[44:47], s69 offen offset:2048 sc1
v_mfma_f32_16x16x32_bf16 v[32:35], v[128:131], a[48:51], v[32:35]
ds_read_b64_tr_b16 v[210:211], v8 offset:6144
ds_read_b64_tr_b16 v[212:213], v9 offset:4096
v_mfma_f32_16x16x32_bf16 v[36:39], v[132:135], a[48:51], v[36:39]
ds_read_b64_tr_b16 v[214:215], v9 offset:6144
v_mfma_f32_16x16x32_bf16 v[36:39], v[148:151], a[52:55], v[36:39]
ds_read_b64_tr_b16 v[216:217], v10 offset:4096
ds_read_b64_tr_b16 v[218:219], v10 offset:6144
v_mfma_f32_16x16x32_bf16 v[36:39], v[164:167], a[56:59], v[36:39]
s_add_u32 s72, s71, 15360
buffer_load_dwordx4 v15, s[24:27], s72 offen offset:1024 lds
v_mfma_f32_16x16x32_bf16 v[36:39], v[180:183], a[60:63], v[36:39]
ds_read_b64_tr_b16 v[220:221], v11 offset:4096
ds_read_b64_tr_b16 v[222:223], v11 offset:6144
v_mfma_f32_16x16x32_bf16 v[20:23], v[180:183], a[44:47], v[20:23]
ds_read_b64_tr_b16 v[224:225], v8 offset:8192
v_mfma_f32_16x16x32_bf16 v[20:23], v[164:167], a[40:43], v[20:23]
buffer_load_dwordx4 a[124:127], v1, s[44:47], s69 offen offset:3072 sc1
v_mfma_f32_16x16x32_bf16 v[20:23], v[148:151], a[36:39], v[20:23]
ds_read_b64_tr_b16 v[226:227], v8 offset:10240
ds_read_b64_tr_b16 v[228:229], v9 offset:8192
v_mfma_f32_16x16x32_bf16 v[20:23], v[132:135], a[32:35], v[20:23]
ds_read_b64_tr_b16 v[230:231], v9 offset:10240
ds_read_b64_tr_b16 v[232:233], v10 offset:8192
v_mfma_f32_16x16x32_bf16 v[24:27], v[136:139], a[32:35], v[24:27]
ds_read_b64_tr_b16 v[234:235], v10 offset:10240
v_mfma_f32_16x16x32_bf16 v[24:27], v[152:155], a[36:39], v[24:27]
s_add_u32 s72, s71, 30720
buffer_load_dwordx4 v15, s[24:27], s72 offen offset:2048 lds
v_mfma_f32_16x16x32_bf16 v[24:27], v[168:171], a[40:43], v[24:27]
ds_read_b64_tr_b16 v[236:237], v11 offset:8192
ds_read_b64_tr_b16 v[238:239], v11 offset:10240
v_mfma_f32_16x16x32_bf16 v[24:27], v[184:187], a[44:47], v[24:27]
ds_read_b64_tr_b16 v[240:241], v8 offset:12288
ds_read_b64_tr_b16 v[242:243], v8 offset:14336
v_mfma_f32_16x16x32_bf16 v[40:43], v[184:187], a[60:63], v[40:43]
s_waitcnt vmcnt(44)
v_cmp_gt_u32 vcc, 2, v14
s_cbranch_vccnz Lspin106
Lback107:
s_add_u32 s82, s59, 20
s_and_b32 s82, s82, 28
s_lshl_b32 s82, s82, 10
s_add_u32 s82, s82, s74
buffer_load_dword v3, v2, s[44:47], s82 offen sc1
s_add_u32 s69, s12, 0x200000
s_and_b32 s69, s69, 0x7c0000
s_lshr_b32 s69, s69, 6
s_add_u32 s69, s69, s95
buffer_load_dwordx4 a[128:131], v1, s[44:47], s69 offen sc1
v_mfma_f32_16x16x32_bf16 v[40:43], v[168:171], a[56:59], v[40:43]
ds_read_b64_tr_b16 v[244:245], v9 offset:12288
v_mfma_f32_16x16x32_bf16 v[40:43], v[152:155], a[52:55], v[40:43]
ds_read_b64_tr_b16 v[246:247], v9 offset:14336
ds_read_b64_tr_b16 v[248:249], v10 offset:12288
v_mfma_f32_16x16x32_bf16 v[40:43], v[136:139], a[48:51], v[40:43]
ds_read_b64_tr_b16 v[250:251], v10 offset:14336
ds_read_b64_tr_b16 v[252:253], v11 offset:12288
v_mfma_f32_16x16x32_bf16 v[44:47], v[140:143], a[48:51], v[44:47]
s_add_u32 s72, s71, 46080
buffer_load_dwordx4 v15, s[24:27], s72 offen offset:3072 lds
v_mfma_f32_16x16x32_bf16 v[44:47], v[156:159], a[52:55], v[44:47]
ds_read_b64_tr_b16 v[254:255], v11 offset:14336
v_mfma_f32_16x16x32_bf16 v[44:47], v[172:175], a[56:59], v[44:47]
buffer_load_dwordx4 a[132:135], v1, s[44:47], s69 offen offset:1024 sc1
v_mfma_f32_16x16x32_bf16 v[44:47], v[188:191], a[60:63], v[44:47]
v_mfma_f32_16x16x32_bf16 v[28:31], v[188:191], a[44:47], v[28:31]
v_mfma_f32_16x16x32_bf16 v[28:31], v[172:175], a[40:43], v[28:31]
v_mfma_f32_16x16x32_bf16 v[28:31], v[156:159], a[36:39], v[28:31]
s_waitcnt vmcnt(20) lgkmcnt(0)
v_mfma_f32_16x16x32_bf16 v[28:31], v[140:143], a[32:35], v[28:31]
s_barrier
v_mfma_f32_16x16x32_bf16 v[48:51], v[192:195], a[64:67], v[48:51]
ds_read_b64_tr_b16 v[128:129], v8 offset:16384
ds_read_b64_tr_b16 v[130:131], v8 offset:18432
v_mfma_f32_16x16x32_bf16 v[48:51], v[208:211], a[68:71], v[48:51]
s_add_u32 s71, s15, s94
buffer_load_dwordx4 a[136:139], v1, s[44:47], s69 offen offset:2048 sc1
v_mfma_f32_16x16x32_bf16 v[48:51], v[224:227], a[72:75], v[48:51]
s_add_u32 m0, s77, 0
ds_read_b64_tr_b16 v[132:133], v9 offset:16384
ds_read_b64_tr_b16 v[134:135], v9 offset:18432
v_mfma_f32_16x16x32_bf16 v[48:51], v[240:243], a[76:79], v[48:51]
s_add_u32 s72, s71, 0
buffer_load_dwordx4 v15, s[24:27], s72 offen lds
v_mfma_f32_16x16x32_bf16 v[64:67], v[240:243], a[92:95], v[64:67]
ds_read_b64_tr_b16 v[136:137], v10 offset:16384
ds_read_b64_tr_b16 v[138:139], v10 offset:18432
v_mfma_f32_16x16x32_bf16 v[64:67], v[224:227], a[88:91], v[64:67]
ds_read_b64_tr_b16 v[140:141], v11 offset:16384
v_and_b32 v122, 15, v0
v_mfma_f32_16x16x32_bf16 v[64:67], v[208:211], a[84:87], v[64:67]
ds_read_b64_tr_b16 v[142:143], v11 offset:18432
ds_read_b64_tr_b16 v[144:145], v8 offset:20480
v_mfma_f32_16x16x32_bf16 v[64:67], v[192:195], a[80:83], v[64:67]
ds_read_b64_tr_b16 v[146:147], v8 offset:22528
ds_read_b64_tr_b16 v[148:149], v9 offset:20480
v_mfma_f32_16x16x32_bf16 v[68:71], v[196:199], a[80:83], v[68:71]
buffer_load_dwordx4 a[140:143], v1, s[44:47], s69 offen offset:3072 sc1
v_mfma_f32_16x16x32_bf16 v[68:71], v[212:215], a[84:87], v[68:71]
ds_read_b64_tr_b16 v[150:151], v9 offset:22528
v_lshrrev_b32 v123, 4, v0
v_mfma_f32_16x16x32_bf16 v[68:71], v[228:231], a[88:91], v[68:71]
s_add_u32 s72, s71, 15360
buffer_load_dwordx4 v15, s[24:27], s72 offen offset:1024 lds
v_mfma_f32_16x16x32_bf16 v[68:71], v[244:247], a[92:95], v[68:71]
ds_read_b64_tr_b16 v[152:153], v10 offset:20480
ds_read_b64_tr_b16 v[154:155], v10 offset:22528
v_mfma_f32_16x16x32_bf16 v[52:55], v[244:247], a[76:79], v[52:55]
ds_read_b64_tr_b16 v[156:157], v11 offset:20480
ds_read_b64_tr_b16 v[158:159], v11 offset:22528
v_mfma_f32_16x16x32_bf16 v[52:55], v[228:231], a[72:75], v[52:55]
ds_read_b64_tr_b16 v[160:161], v8 offset:24576
v_lshlrev_b32 v123, 2, v123
v_mfma_f32_16x16x32_bf16 v[52:55], v[212:215], a[68:71], v[52:55]
ds_read_b64_tr_b16 v[162:163], v8 offset:26624
ds_read_b64_tr_b16 v[164:165], v9 offset:24576
v_mfma_f32_16x16x32_bf16 v[52:55], v[196:199], a[64:67], v[52:55]
s_add_u32 s69, s69, 0x20000
buffer_load_dwordx4 a[144:147], v1, s[44:47], s69 offen sc1
v_mfma_f32_16x16x32_bf16 v[56:59], v[200:203], a[64:67], v[56:59]
ds_read_b64_tr_b16 v[166:167], v9 offset:26624
ds_read_b64_tr_b16 v[168:169], v10 offset:24576
v_mfma_f32_16x16x32_bf16 v[56:59], v[216:219], a[68:71], v[56:59]
s_add_u32 s72, s71, 30720
buffer_load_dwordx4 v15, s[24:27], s72 offen offset:2048 lds
v_mfma_f32_16x16x32_bf16 v[56:59], v[232:235], a[72:75], v[56:59]
ds_read_b64_tr_b16 v[170:171], v10 offset:26624
v_sub_u32 v122, v122, v123
v_mfma_f32_16x16x32_bf16 v[56:59], v[248:251], a[76:79], v[56:59]
ds_read_b64_tr_b16 v[172:173], v11 offset:24576
ds_read_b64_tr_b16 v[174:175], v11 offset:26624
v_mfma_f32_16x16x32_bf16 v[72:75], v[248:251], a[92:95], v[72:75]
ds_read_b64_tr_b16 v[176:177], v8 offset:28672
ds_read_b64_tr_b16 v[178:179], v8 offset:30720
v_mfma_f32_16x16x32_bf16 v[72:75], v[232:235], a[88:91], v[72:75]
ds_read_b64_tr_b16 v[180:181], v9 offset:28672
v_min_u32 v122, 4, v122
v_mfma_f32_16x16x32_bf16 v[72:75], v[216:219], a[84:87], v[72:75]
buffer_load_dwordx4 a[148:151], v1, s[44:47], s69 offen offset:1024 sc1
v_mfma_f32_16x16x32_bf16 v[72:75], v[200:203], a[80:83], v[72:75]
ds_read_b64_tr_b16 v[182:183], v9 offset:30720
ds_read_b64_tr_b16 v[184:185], v10 offset:28672
v_mfma_f32_16x16x32_bf16 v[76:79], v[204:207], a[80:83], v[76:79]
s_add_u32 s72, s71, 46080
buffer_load_dwordx4 v15, s[24:27], s72 offen offset:3072 lds
v_mfma_f32_16x16x32_bf16 v[76:79], v[220:223], a[84:87], v[76:79]
ds_read_b64_tr_b16 v[186:187], v10 offset:30720
ds_read_b64_tr_b16 v[188:189], v11 offset:28672
v_mfma_f32_16x16x32_bf16 v[76:79], v[236:239], a[88:91], v[76:79]
ds_read_b64_tr_b16 v[190:191], v11 offset:30720
v_lshlrev_b32 v122, 3, v122
v_mfma_f32_16x16x32_bf16 v[76:79], v[252:255], a[92:95], v[76:79]
v_mov_b32 v124, 0x3f80
v_mov_b32 v125, 0
v_mfma_f32_16x16x32_bf16 v[60:63], v[252:255], a[76:79], v[60:63]
v_lshlrev_b64 v[124:125], v122, v[124:125]
v_mov_b32 v126, 0
v_mfma_f32_16x16x32_bf16 v[60:63], v[236:239], a[72:75], v[60:63]
s_add_u32 s71, s13, 0x200000
buffer_load_dwordx4 a[152:155], v1, s[44:47], s69 offen offset:2048 sc1
v_mfma_f32_16x16x32_bf16 v[60:63], v[220:223], a[68:71], v[60:63]
s_waitcnt vmcnt(21) lgkmcnt(0)
v_lshlrev_b64 v[124:125], v122, v[124:125]
v_mov_b32 v127, 0
v_mfma_f32_16x16x32_bf16 v[60:63], v[204:207], a[64:67], v[60:63]
s_barrier
v_mov_b32 v122, 0
v_mov_b32 v123, 0
v_mfma_f32_16x16x32_bf16 v[16:19], v[128:131], a[64:67], v[16:19]
s_and_b32 s71, s71, 0x7c0000
ds_read_b64_tr_b16 v[192:193], v8 offset:32768
ds_read_b64_tr_b16 v[194:195], v8 offset:34816
v_mfma_f32_16x16x32_bf16 v[16:19], v[144:147], a[68:71], v[16:19]
s_add_u32 s71, s71, s78
ds_read_b64_tr_b16 v[196:197], v9 offset:32768
ds_read_b64_tr_b16 v[198:199], v9 offset:34816
v_mfma_f32_16x16x32_bf16 v[16:19], v[160:163], a[72:75], v[16:19]
s_add_u32 m0, s77, 16384
ds_read_b64_tr_b16 v[200:201], v10 offset:32768
ds_read_b64_tr_b16 v[202:203], v10 offset:34816
v_mfma_f32_16x16x32_bf16 v[16:19], v[176:179], a[76:79], v[16:19]
s_add_u32 s72, s71, 0
buffer_load_dwordx4 v15, s[24:27], s72 offen lds
v_mfma_f32_16x16x32_bf16 v[32:35], v[176:179], a[92:95], v[32:35]
buffer_load_dwordx4 a[156:159], v1, s[44:47], s69 offen offset:3072 sc1
v_mfma_f32_16x16x32_bf16 v[32:35], v[160:163], a[88:91], v[32:35]
ds_read_b64_tr_b16 v[204:205], v11 offset:32768
v_mfma_f32_16x16x32_bf16 v[32:35], v[144:147], a[84:87], v[32:35]
ds_read_b64_tr_b16 v[206:207], v11 offset:34816
ds_read_b64_tr_b16 v[208:209], v8 offset:36864
v_mfma_f32_16x16x32_bf16 v[32:35], v[128:131], a[80:83], v[32:35]
s_add_u32 s69, s13, 0x200000
ds_read_b64_tr_b16 v[210:211], v8 offset:38912
ds_read_b64_tr_b16 v[212:213], v9 offset:36864
v_mfma_f32_16x16x32_bf16 v[36:39], v[132:135], a[80:83], v[36:39]
s_and_b32 s69, s69, 0x7c0000
ds_read_b64_tr_b16 v[214:215], v9 offset:38912
v_mfma_f32_16x16x32_bf16 v[36:39], v[148:151], a[84:87], v[36:39]
s_lshr_b32 s69, s69, 6
ds_read_b64_tr_b16 v[216:217], v10 offset:36864
ds_read_b64_tr_b16 v[218:219], v10 offset:38912
v_mfma_f32_16x16x32_bf16 v[36:39], v[164:167], a[88:91], v[36:39]
s_add_u32 s72, s71, 15360
buffer_load_dwordx4 v15, s[24:27], s72 offen offset:1024 lds
v_mfma_f32_16x16x32_bf16 v[36:39], v[180:183], a[92:95], v[36:39]
s_add_u32 s69, s69, s95
buffer_load_dwordx4 a[160:163], v1, s[44:47], s69 offen sc1
v_mfma_f32_16x16x32_bf16 v[20:23], v[180:183], a[76:79], v[20:23]
ds_read_b64_tr_b16 v[220:221], v11 offset:36864
ds_read_b64_tr_b16 v[222:223], v11 offset:38912
v_mfma_f32_16x16x32_bf16 v[20:23], v[164:167], a[72:75], v[20:23]
ds_read_b64_tr_b16 v[224:225], v8 offset:40960
v_mfma_f32_16x16x32_bf16 v[20:23], v[148:151], a[68:71], v[20:23]
ds_read_b64_tr_b16 v[226:227], v8 offset:43008
ds_read_b64_tr_b16 v[228:229], v9 offset:40960
v_mfma_f32_16x16x32_bf16 v[20:23], v[132:135], a[64:67], v[20:23]
ds_read_b64_tr_b16 v[230:231], v9 offset:43008
ds_read_b64_tr_b16 v[232:233], v10 offset:40960
v_mfma_f32_16x16x32_bf16 v[24:27], v[136:139], a[64:67], v[24:27]
ds_read_b64_tr_b16 v[234:235], v10 offset:43008
v_mfma_f32_16x16x32_bf16 v[24:27], v[152:155], a[68:71], v[24:27]
s_add_u32 s72, s71, 30720
buffer_load_dwordx4 v15, s[24:27], s72 offen offset:2048 lds
v_mfma_f32_16x16x32_bf16 v[24:27], v[168:171], a[72:75], v[24:27]
buffer_load_dwordx4 a[164:167], v1, s[44:47], s69 offen offset:1024 sc1
v_mfma_f32_16x16x32_bf16 v[24:27], v[184:187], a[76:79], v[24:27]
ds_read_b64_tr_b16 v[236:237], v11 offset:40960
ds_read_b64_tr_b16 v[238:239], v11 offset:43008
v_mfma_f32_16x16x32_bf16 v[40:43], v[184:187], a[92:95], v[40:43]
ds_read_b64_tr_b16 v[240:241], v8 offset:45056
ds_read_b64_tr_b16 v[242:243], v8 offset:47104
v_mfma_f32_16x16x32_bf16 v[40:43], v[168:171], a[88:91], v[40:43]
ds_read_b64_tr_b16 v[244:245], v9 offset:45056
v_mfma_f32_16x16x32_bf16 v[40:43], v[152:155], a[84:87], v[40:43]
ds_read_b64_tr_b16 v[246:247], v9 offset:47104
ds_read_b64_tr_b16 v[248:249], v10 offset:45056
v_mfma_f32_16x16x32_bf16 v[40:43], v[136:139], a[80:83], v[40:43]
ds_read_b64_tr_b16 v[250:251], v10 offset:47104
ds_read_b64_tr_b16 v[252:253], v11 offset:45056
v_mfma_f32_16x16x32_bf16 v[44:47], v[140:143], a[80:83], v[44:47]
s_add_u32 s72, s71, 46080
buffer_load_dwordx4 v15, s[24:27], s72 offen offset:3072 lds
v_mfma_f32_16x16x32_bf16 v[44:47], v[156:159], a[84:87], v[44:47]
buffer_load_dwordx4 a[168:171], v1, s[44:47], s69 offen offset:2048 sc1
v_mfma_f32_16x16x32_bf16 v[44:47], v[172:175], a[88:91], v[44:47]
ds_read_b64_tr_b16 v[254:255], v11 offset:47104
v_mfma_f32_16x16x32_bf16 v[44:47], v[188:191], a[92:95], v[44:47]
v_mfma_f32_16x16x32_bf16 v[28:31], v[188:191], a[76:79], v[28:31]
v_mfma_f32_16x16x32_bf16 v[28:31], v[172:175], a[72:75], v[28:31]
s_add_u32 s71, s12, 0x200000
v_mfma_f32_16x16x32_bf16 v[28:31], v[156:159], a[68:71], v[28:31]
s_waitcnt vmcnt(18) lgkmcnt(0)
v_mfma_f32_16x16x32_bf16 v[28:31], v[140:143], a[64:67], v[28:31]
s_barrier
buffer_load_dwordx4 a[172:175], v1, s[44:47], s69 offen offset:3072 sc1
v_mfma_f32_16x16x32_bf16 v[48:51], v[192:195], a[96:99], v[48:51]
s_and_b32 s71, s71, 0x7c0000
ds_read_b64_tr_b16 v[128:129], v8 offset:49152
ds_read_b64_tr_b16 v[130:131], v8 offset:51200
v_mfma_f32_16x16x32_bf16 v[48:51], v[208:211], a[100:103], v[48:51]
s_add_u32 s71, s71, s94
ds_read_b64_tr_b16 v[132:133], v9 offset:49152
ds_read_b64_tr_b16 v[134:135], v9 offset:51200
v_mfma_f32_16x16x32_bf16 v[48:51], v[224:227], a[104:107], v[48:51]
s_add_u32 m0, s77, 32768
ds_read_b64_tr_b16 v[136:137], v10 offset:49152
v_mfma_f32_16x16x32_bf16 v[48:51], v[240:243], a[108:111], v[48:51]
s_add_u32 s72, s71, 0
buffer_load_dwordx4 v15, s[24:27], s72 offen lds
v_mfma_f32_16x16x32_bf16 v[64:67], v[240:243], a[124:127], v[64:67]
ds_read_b64_tr_b16 v[138:139], v10 offset:51200
ds_read_b64_tr_b16 v[140:141], v11 offset:49152
v_mfma_f32_16x16x32_bf16 v[64:67], v[224:227], a[120:123], v[64:67]
ds_read_b64_tr_b16 v[142:143], v11 offset:51200
v_mfma_f32_16x16x32_bf16 v[64:67], v[208:211], a[116:119], v[64:67]
s_add_u32 s69, s69, 0x20000
buffer_load_dwordx4 a[176:179], v1, s[44:47], s69 offen sc1
v_mfma_f32_16x16x32_bf16 v[64:67], v[192:195], a[112:115], v[64:67]
ds_read_b64_tr_b16 v[144:145], v8 offset:53248
ds_read_b64_tr_b16 v[146:147], v8 offset:55296
v_mfma_f32_16x16x32_bf16 v[68:71], v[196:199], a[112:115], v[68:71]
ds_read_b64_tr_b16 v[148:149], v9 offset:53248
ds_read_b64_tr_b16 v[150:151], v9 offset:55296
v_mfma_f32_16x16x32_bf16 v[68:71], v[212:215], a[116:119], v[68:71]
ds_read_b64_tr_b16 v[152:153], v10 offset:53248
v_mfma_f32_16x16x32_bf16 v[68:71], v[228:231], a[120:123], v[68:71]
s_add_u32 s72, s71, 15360
buffer_load_dwordx4 v15, s[24:27], s72 offen offset:1024 lds
v_mfma_f32_16x16x32_bf16 v[68:71], v[244:247], a[124:127], v[68:71]
ds_read_b64_tr_b16 v[154:155], v10 offset:55296
ds_read_b64_tr_b16 v[156:157], v11 offset:53248
v_mfma_f32_16x16x32_bf16 v[52:55], v[244:247], a[108:111], v[52:55]
ds_read_b64_tr_b16 v[158:159], v11 offset:55296
v_mfma_f32_16x16x32_bf16 v[52:55], v[228:231], a[104:107], v[52:55]
buffer_load_dwordx4 a[180:183], v1, s[44:47], s69 offen offset:1024 sc1
v_mfma_f32_16x16x32_bf16 v[52:55], v[212:215], a[100:103], v[52:55]
ds_read_b64_tr_b16 v[160:161], v8 offset:57344
ds_read_b64_tr_b16 v[162:163], v8 offset:59392
v_mfma_f32_16x16x32_bf16 v[52:55], v[196:199], a[96:99], v[52:55]
ds_read_b64_tr_b16 v[164:165], v9 offset:57344
ds_read_b64_tr_b16 v[166:167], v9 offset:59392
v_mfma_f32_16x16x32_bf16 v[56:59], v[200:203], a[96:99], v[56:59]
ds_read_b64_tr_b16 v[168:169], v10 offset:57344
v_mfma_f32_16x16x32_bf16 v[56:59], v[216:219], a[100:103], v[56:59]
s_add_u32 s72, s71, 30720
buffer_load_dwordx4 v15, s[24:27], s72 offen offset:2048 lds
v_mfma_f32_16x16x32_bf16 v[56:59], v[232:235], a[104:107], v[56:59]
ds_read_b64_tr_b16 v[170:171], v10 offset:59392
ds_read_b64_tr_b16 v[172:173], v11 offset:57344
v_mfma_f32_16x16x32_bf16 v[56:59], v[248:251], a[108:111], v[56:59]
ds_read_b64_tr_b16 v[174:175], v11 offset:59392
v_mfma_f32_16x16x32_bf16 v[72:75], v[248:251], a[124:127], v[72:75]
buffer_load_dwordx4 a[184:187], v1, s[44:47], s69 offen offset:2048 sc1
v_mfma_f32_16x16x32_bf16 v[72:75], v[232:235], a[120:123], v[72:75]
ds_read_b64_tr_b16 v[176:177], v8 offset:61440
ds_read_b64_tr_b16 v[178:179], v8 offset:63488
v_mfma_f32_16x16x32_bf16 v[72:75], v[216:219], a[116:119], v[72:75]
ds_read_b64_tr_b16 v[180:181], v9 offset:61440
ds_read_b64_tr_b16 v[182:183], v9 offset:63488
v_mfma_f32_16x16x32_bf16 v[72:75], v[200:203], a[112:115], v[72:75]
ds_read_b64_tr_b16 v[184:185], v10 offset:61440
v_mfma_f32_16x16x32_bf16 v[76:79], v[204:207], a[112:115], v[76:79]
s_add_u32 s72, s71, 46080
buffer_load_dwordx4 v15, s[24:27], s72 offen offset:3072 lds
v_mfma_f32_16x16x32_bf16 v[76:79], v[220:223], a[116:119], v[76:79]
ds_read_b64_tr_b16 v[186:187], v10 offset:63488
ds_read_b64_tr_b16 v[188:189], v11 offset:61440
v_mfma_f32_16x16x32_bf16 v[76:79], v[236:239], a[120:123], v[76:79]
ds_read_b64_tr_b16 v[190:191], v11 offset:63488
v_mfma_f32_16x16x32_bf16 v[76:79], v[252:255], a[124:127], v[76:79]
buffer_load_dwordx4 a[188:191], v1, s[44:47], s69 offen offset:3072 sc1
v_mfma_f32_16x16x32_bf16 v[60:63], v[252:255], a[108:111], v[60:63]
s_add_u32 s69, s14, 0x200000
v_mfma_f32_16x16x32_bf16 v[60:63], v[236:239], a[104:107], v[60:63]
s_add_u32 s71, s14, 0x200000
v_mfma_f32_16x16x32_bf16 v[60:63], v[220:223], a[100:103], v[60:63]
s_waitcnt vmcnt(15) lgkmcnt(0)
v_mfma_f32_16x16x32_bf16 v[60:63], v[204:207], a[96:99], v[60:63]
s_barrier
v_mfma_f32_16x16x32_bf16 v[48:51], v[128:131], a[128:131], v[48:51]
s_and_b32 s71, s71, 0x7c0000
ds_read_b64_tr_b16 v[192:193], v8 offset:0
ds_read_b64_tr_b16 v[194:195], v8 offset:2048
v_mfma_f32_16x16x32_bf16 v[48:51], v[144:147], a[132:135], v[48:51]
s_add_u32 s71, s71, s78
ds_read_b64_tr_b16 v[196:197], v9 offset:0
ds_read_b64_tr_b16 v[198:199], v9 offset:2048
v_mfma_f32_16x16x32_bf16 v[48:51], v[160:163], a[136:139], v[48:51]
s_add_u32 m0, s77, 49152
s_and_b32 s69, s69, 0x7c0000
s_lshr_b32 s69, s69, 6
s_add_u32 s69, s69, s95
buffer_load_dwordx4 a[192:195], v1, s[44:47], s69 offen sc1
v_mfma_f32_16x16x32_bf16 v[48:51], v[176:179], a[140:143], v[48:51]
s_add_u32 s72, s71, 0
buffer_load_dwordx4 v15, s[24:27], s72 offen lds
v_mfma_f32_16x16x32_bf16 v[64:67], v[176:179], a[156:159], v[64:67]
ds_read_b64_tr_b16 v[200:201], v10 offset:0
ds_read_b64_tr_b16 v[202:203], v10 offset:2048
v_mfma_f32_16x16x32_bf16 v[64:67], v[160:163], a[152:155], v[64:67]
ds_read_b64_tr_b16 v[204:205], v11 offset:0
v_add_u32 v120, s64, v1
v_mfma_f32_16x16x32_bf16 v[64:67], v[144:147], a[148:151], v[64:67]
ds_read_b64_tr_b16 v[206:207], v11 offset:2048
ds_read_b64_tr_b16 v[208:209], v8 offset:4096
v_mfma_f32_16x16x32_bf16 v[64:67], v[128:131], a[144:147], v[64:67]
ds_read_b64_tr_b16 v[210:211], v8 offset:6144
ds_read_b64_tr_b16 v[212:213], v9 offset:4096
v_mfma_f32_16x16x32_bf16 v[68:71], v[132:135], a[144:147], v[68:71]
buffer_load_dwordx4 a[196:199], v1, s[44:47], s69 offen offset:1024 sc1
v_mfma_f32_16x16x32_bf16 v[68:71], v[148:151], a[148:151], v[68:71]
ds_read_b64_tr_b16 v[214:215], v9 offset:6144
v_add_u32 v120, 131072, v120
v_mfma_f32_16x16x32_bf16 v[68:71], v[164:167], a[152:155], v[68:71]
s_add_u32 s72, s71, 15360
buffer_load_dwordx4 v15, s[24:27], s72 offen offset:1024 lds
v_mfma_f32_16x16x32_bf16 v[68:71], v[180:183], a[156:159], v[68:71]
s_lshl_b32 s70, s75, 18
ds_read_b64_tr_b16 v[216:217], v10 offset:4096
ds_read_b64_tr_b16 v[218:219], v10 offset:6144
v_mfma_f32_16x16x32_bf16 v[52:55], v[180:183], a[140:143], v[52:55]
s_add_u32 s70, s70, s94
ds_read_b64_tr_b16 v[220:221], v11 offset:4096
ds_read_b64_tr_b16 v[222:223], v11 offset:6144
v_mfma_f32_16x16x32_bf16 v[52:55], v[164:167], a[136:139], v[52:55]
ds_read_b64_tr_b16 v[224:225], v8 offset:8192
ds_write_b128 v120, v[80:83] offset:0
v_mfma_f32_16x16x32_bf16 v[52:55], v[148:151], a[132:135], v[52:55]
ds_read_b64_tr_b16 v[226:227], v8 offset:10240
ds_read_b64_tr_b16 v[228:229], v9 offset:8192
v_mfma_f32_16x16x32_bf16 v[52:55], v[132:135], a[128:131], v[52:55]
buffer_load_dwordx4 a[200:203], v1, s[44:47], s69 offen offset:2048 sc1
v_mfma_f32_16x16x32_bf16 v[56:59], v[136:139], a[128:131], v[56:59]
ds_read_b64_tr_b16 v[230:231], v9 offset:10240
ds_read_b64_tr_b16 v[232:233], v10 offset:8192
v_mfma_f32_16x16x32_bf16 v[56:59], v[152:155], a[132:135], v[56:59]
s_add_u32 s72, s71, 30720
buffer_load_dwordx4 v15, s[24:27], s72 offen offset:2048 lds
v_mfma_f32_16x16x32_bf16 v[56:59], v[168:171], a[136:139], v[56:59]
ds_read_b64_tr_b16 v[234:235], v10 offset:10240
ds_write_b128 v120, v[84:87] offset:1024
v_mfma_f32_16x16x32_bf16 v[56:59], v[184:187], a[140:143], v[56:59]
ds_read_b64_tr_b16 v[236:237], v11 offset:8192
ds_read_b64_tr_b16 v[238:239], v11 offset:10240
v_mfma_f32_16x16x32_bf16 v[72:75], v[184:187], a[156:159], v[72:75]
ds_read_b64_tr_b16 v[240:241], v8 offset:12288
ds_read_b64_tr_b16 v[242:243], v8 offset:14336
v_mfma_f32_16x16x32_bf16 v[72:75], v[168:171], a[152:155], v[72:75]
ds_read_b64_tr_b16 v[244:245], v9 offset:12288
ds_write_b128 v120, v[96:99] offset:2048
v_mfma_f32_16x16x32_bf16 v[72:75], v[152:155], a[148:151], v[72:75]
buffer_load_dwordx4 a[204:207], v1, s[44:47], s69 offen offset:3072 sc1
v_mfma_f32_16x16x32_bf16 v[72:75], v[136:139], a[144:147], v[72:75]
ds_read_b64_tr_b16 v[246:247], v9 offset:14336
ds_read_b64_tr_b16 v[248:249], v10 offset:12288
v_mfma_f32_16x16x32_bf16 v[76:79], v[140:143], a[144:147], v[76:79]
s_add_u32 s72, s71, 46080
buffer_load_dwordx4 v15, s[24:27], s72 offen offset:3072 lds
v_mfma_f32_16x16x32_bf16 v[76:79], v[156:159], a[148:151], v[76:79]
ds_read_b64_tr_b16 v[250:251], v10 offset:14336
ds_read_b64_tr_b16 v[252:253], v11 offset:12288
v_mfma_f32_16x16x32_bf16 v[76:79], v[172:175], a[152:155], v[76:79]
ds_read_b64_tr_b16 v[254:255], v11 offset:14336
ds_write_b128 v120, v[100:103] offset:3072
v_mfma_f32_16x16x32_bf16 v[76:79], v[188:191], a[156:159], v[76:79]
v_mfma_f32_16x16x32_bf16 v[60:63], v[188:191], a[140:143], v[60:63]
s_add_u32 s69, s69, 0x20000
v_mfma_f32_16x16x32_bf16 v[60:63], v[172:175], a[136:139], v[60:63]
s_add_u32 s71, s13, 0x200000
buffer_load_dwordx4 a[208:211], v1, s[44:47], s69 offen sc1
v_mfma_f32_16x16x32_bf16 v[60:63], v[156:159], a[132:135], v[60:63]
s_waitcnt vmcnt(19) lgkmcnt(0)
v_mfma_f32_16x16x32_bf16 v[60:63], v[140:143], a[128:131], v[60:63]
s_barrier
v_mfma_f32_16x16x32_bf16 v[16:19], v[192:195], a[96:99], v[16:19]
s_and_b32 s71, s71, 0x7c0000
ds_read_b64_tr_b16 v[128:129], v8 offset:16384
ds_read_b64_tr_b16 v[130:131], v8 offset:18432
v_mfma_f32_16x16x32_bf16 v[16:19], v[208:211], a[100:103], v[16:19]
s_add_u32 s71, s71, s94
ds_read_b64_tr_b16 v[132:133], v9 offset:16384
ds_read_b64_tr_b16 v[134:135], v9 offset:18432
v_mfma_f32_16x16x32_bf16 v[16:19], v[224:227], a[104:107], v[16:19]
s_add_u32 m0, s77, 0
ds_read_b64_tr_b16 v[136:137], v10 offset:16384
ds_read_b64_tr_b16 v[138:139], v10 offset:18432
v_mfma_f32_16x16x32_bf16 v[16:19], v[240:243], a[108:111], v[16:19]
s_add_u32 s72, s71, 0
buffer_load_dwordx4 v15, s[24:27], s72 offen lds
v_mfma_f32_16x16x32_bf16 v[32:35], v[240:243], a[124:127], v[32:35]
buffer_load_dwordx4 a[212:215], v1, s[44:47], s69 offen offset:1024 sc1
v_mfma_f32_16x16x32_bf16 v[32:35], v[224:227], a[120:123], v[32:35]
ds_read_b64_tr_b16 v[140:141], v11 offset:16384
v_mfma_f32_16x16x32_bf16 v[32:35], v[208:211], a[116:119], v[32:35]
ds_read_b64_tr_b16 v[142:143], v11 offset:18432
ds_read_b64_tr_b16 v[144:145], v8 offset:20480
v_mfma_f32_16x16x32_bf16 v[32:35], v[192:195], a[112:115], v[32:35]
ds_read_b64_tr_b16 v[146:147], v8 offset:22528
ds_read_b64_tr_b16 v[148:149], v9 offset:20480
v_mfma_f32_16x16x32_bf16 v[36:39], v[196:199], a[112:115], v[36:39]
ds_read_b64_tr_b16 v[150:151], v9 offset:22528
v_mfma_f32_16x16x32_bf16 v[36:39], v[212:215], a[116:119], v[36:39]
ds_read_b64_tr_b16 v[152:153], v10 offset:20480
ds_read_b64_tr_b16 v[154:155], v10 offset:22528
v_mfma_f32_16x16x32_bf16 v[36:39], v[228:231], a[120:123], v[36:39]
s_add_u32 s72, s71, 15360
buffer_load_dwordx4 v15, s[24:27], s72 offen offset:1024 lds
v_mfma_f32_16x16x32_bf16 v[36:39], v[244:247], a[124:127], v[36:39]
buffer_load_dwordx4 a[216:219], v1, s[44:47], s69 offen offset:2048 sc1
v_mfma_f32_16x16x32_bf16 v[20:23], v[244:247], a[108:111], v[20:23]
ds_read_b64_tr_b16 v[156:157], v11 offset:20480
ds_read_b64_tr_b16 v[158:159], v11 offset:22528
v_mfma_f32_16x16x32_bf16 v[20:23], v[228:231], a[104:107], v[20:23]
ds_read_b64_tr_b16 v[160:161], v8 offset:24576
v_mfma_f32_16x16x32_bf16 v[20:23], v[212:215], a[100:103], v[20:23]
ds_read_b64_tr_b16 v[162:163], v8 offset:26624
ds_read_b64_tr_b16 v[164:165], v9 offset:24576
v_mfma_f32_16x16x32_bf16 v[20:23], v[196:199], a[96:99], v[20:23]
ds_read_b64_tr_b16 v[166:167], v9 offset:26624
ds_read_b64_tr_b16 v[168:169], v10 offset:24576
v_mfma_f32_16x16x32_bf16 v[24:27], v[200:203], a[96:99], v[24:27]
ds_read_b64_tr_b16 v[170:171], v10 offset:26624
v_mfma_f32_16x16x32_bf16 v[24:27], v[216:219], a[100:103], v[24:27]
s_add_u32 s72, s71, 30720
buffer_load_dwordx4 v15, s[24:27], s72 offen offset:2048 lds
v_mfma_f32_16x16x32_bf16 v[24:27], v[232:235], a[104:107], v[24:27]
buffer_load_dwordx4 a[220:223], v1, s[44:47], s69 offen offset:3072 sc1
v_mfma_f32_16x16x32_bf16 v[24:27], v[248:251], a[108:111], v[24:27]
ds_read_b64_tr_b16 v[172:173], v11 offset:24576
ds_read_b64_tr_b16 v[174:175], v11 offset:26624
v_mfma_f32_16x16x32_bf16 v[40:43], v[248:251], a[124:127], v[40:43]
ds_read_b64_tr_b16 v[176:177], v8 offset:28672
ds_read_b64_tr_b16 v[178:179], v8 offset:30720
v_mfma_f32_16x16x32_bf16 v[40:43], v[232:235], a[120:123], v[40:43]
s_add_u32 s69, s15, 0x200000
ds_read_b64_tr_b16 v[180:181], v9 offset:28672
v_mfma_f32_16x16x32_bf16 v[40:43], v[216:219], a[116:119], v[40:43]
s_and_b32 s69, s69, 0x7c0000
ds_read_b64_tr_b16 v[182:183], v9 offset:30720
ds_read_b64_tr_b16 v[184:185], v10 offset:28672
v_mfma_f32_16x16x32_bf16 v[40:43], v[200:203], a[112:115], v[40:43]
s_lshr_b32 s69, s69, 6
ds_read_b64_tr_b16 v[186:187], v10 offset:30720
ds_read_b64_tr_b16 v[188:189], v11 offset:28672
v_mfma_f32_16x16x32_bf16 v[44:47], v[204:207], a[112:115], v[44:47]
s_add_u32 s72, s71, 46080
buffer_load_dwordx4 v15, s[24:27], s72 offen offset:3072 lds
v_mfma_f32_16x16x32_bf16 v[44:47], v[220:223], a[116:119], v[44:47]
s_add_u32 s69, s69, s95
buffer_load_dwordx4 a[224:227], v1, s[44:47], s69 offen sc1
v_mfma_f32_16x16x32_bf16 v[44:47], v[236:239], a[120:123], v[44:47]
ds_read_b64_tr_b16 v[190:191], v11 offset:30720
v_mfma_f32_16x16x32_bf16 v[44:47], v[252:255], a[124:127], v[44:47]
v_mfma_f32_16x16x32_bf16 v[28:31], v[252:255], a[108:111], v[28:31]
v_mfma_f32_16x16x32_bf16 v[28:31], v[236:239], a[104:107], v[28:31]
s_add_u32 s71, s15, 0x200000
v_mfma_f32_16x16x32_bf16 v[28:31], v[220:223], a[100:103], v[28:31]
s_waitcnt vmcnt(17) lgkmcnt(0)
v_mfma_f32_16x16x32_bf16 v[28:31], v[204:207], a[96:99], v[28:31]
s_barrier
buffer_load_dwordx4 a[228:231], v1, s[44:47], s69 offen offset:1024 sc1
v_mfma_f32_16x16x32_bf16 v[48:51], v[128:131], a[160:163], v[48:51]
s_and_b32 s71, s71, 0x7c0000
ds_read_b64_tr_b16 v[192:193], v8 offset:32768
ds_read_b64_tr_b16 v[194:195], v8 offset:34816
v_mfma_f32_16x16x32_bf16 v[48:51], v[144:147], a[164:167], v[48:51]
s_add_u32 s71, s71, s78
ds_read_b64_tr_b16 v[196:197], v9 offset:32768
ds_read_b64_tr_b16 v[198:199], v9 offset:34816
v_mfma_f32_16x16x32_bf16 v[48:51], v[160:163], a[168:171], v[48:51]
s_add_u32 m0, s77, 16384
ds_read_b64_tr_b16 v[200:201], v10 offset:32768
v_mfma_f32_16x16x32_bf16 v[48:51], v[176:179], a[172:175], v[48:51]
s_add_u32 s72, s71, 0
buffer_load_dwordx4 v15, s[24:27], s72 offen lds
v_mfma_f32_16x16x32_bf16 v[64:67], v[176:179], a[188:191], v[64:67]
ds_read_b64_tr_b16 v[202:203], v10 offset:34816
ds_read_b64_tr_b16 v[204:205], v11 offset:32768
v_mfma_f32_16x16x32_bf16 v[64:67], v[160:163], a[184:187], v[64:67]
ds_read_b64_tr_b16 v[206:207], v11 offset:34816
v_mfma_f32_16x16x32_bf16 v[64:67], v[144:147], a[180:183], v[64:67]
buffer_load_dwordx4 a[232:235], v1, s[44:47], s69 offen offset:2048 sc1
v_mfma_f32_16x16x32_bf16 v[64:67], v[128:131], a[176:179], v[64:67]
ds_read_b64_tr_b16 v[208:209], v8 offset:36864
ds_read_b64_tr_b16 v[210:211], v8 offset:38912
v_mfma_f32_16x16x32_bf16 v[68:71], v[132:135], a[176:179], v[68:71]
ds_read_b64_tr_b16 v[212:213], v9 offset:36864
ds_read_b64_tr_b16 v[214:215], v9 offset:38912
v_mfma_f32_16x16x32_bf16 v[68:71], v[148:151], a[180:183], v[68:71]
ds_read_b64_tr_b16 v[216:217], v10 offset:36864
v_mfma_f32_16x16x32_bf16 v[68:71], v[164:167], a[184:187], v[68:71]
s_add_u32 s72, s71, 15360
buffer_load_dwordx4 v15, s[24:27], s72 offen offset:1024 lds
v_mfma_f32_16x16x32_bf16 v[68:71], v[180:183], a[188:191], v[68:71]
ds_read_b64_tr_b16 v[218:219], v10 offset:38912
ds_read_b64_tr_b16 v[220:221], v11 offset:36864
v_mfma_f32_16x16x32_bf16 v[52:55], v[180:183], a[172:175], v[52:55]
ds_read_b64_tr_b16 v[222:223], v11 offset:38912
v_mfma_f32_16x16x32_bf16 v[52:55], v[164:167], a[168:171], v[52:55]
buffer_load_dwordx4 a[236:239], v1, s[44:47], s69 offen offset:3072 sc1
v_mfma_f32_16x16x32_bf16 v[52:55], v[148:151], a[164:167], v[52:55]
ds_read_b64_tr_b16 v[224:225], v8 offset:40960
ds_read_b64_tr_b16 v[226:227], v8 offset:43008
v_mfma_f32_16x16x32_bf16 v[52:55], v[132:135], a[160:163], v[52:55]
ds_read_b64_tr_b16 v[228:229], v9 offset:40960
ds_read_b64_tr_b16 v[230:231], v9 offset:43008
v_mfma_f32_16x16x32_bf16 v[56:59], v[136:139], a[160:163], v[56:59]
ds_read_b64_tr_b16 v[232:233], v10 offset:40960
v_mfma_f32_16x16x32_bf16 v[56:59], v[152:155], a[164:167], v[56:59]
s_add_u32 s72, s71, 30720
buffer_load_dwordx4 v15, s[24:27], s72 offen offset:2048 lds
v_mfma_f32_16x16x32_bf16 v[56:59], v[168:171], a[168:171], v[56:59]
ds_read_b64_tr_b16 v[234:235], v10 offset:43008
ds_read_b64_tr_b16 v[236:237], v11 offset:40960
v_mfma_f32_16x16x32_bf16 v[56:59], v[184:187], a[172:175], v[56:59]
ds_read_b64_tr_b16 v[238:239], v11 offset:43008
v_mfma_f32_16x16x32_bf16 v[72:75], v[184:187], a[188:191], v[72:75]
s_add_u32 s69, s69, 0x20000
buffer_load_dwordx4 a[240:243], v1, s[44:47], s69 offen sc1
v_mfma_f32_16x16x32_bf16 v[72:75], v[168:171], a[184:187], v[72:75]
ds_read_b64_tr_b16 v[240:241], v8 offset:45056
ds_read_b64_tr_b16 v[242:243], v8 offset:47104
v_mfma_f32_16x16x32_bf16 v[72:75], v[152:155], a[180:183], v[72:75]
ds_read_b64_tr_b16 v[244:245], v9 offset:45056
ds_read_b64_tr_b16 v[246:247], v9 offset:47104
v_mfma_f32_16x16x32_bf16 v[72:75], v[136:139], a[176:179], v[72:75]
ds_read_b64_tr_b16 v[248:249], v10 offset:45056
v_mfma_f32_16x16x32_bf16 v[76:79], v[140:143], a[176:179], v[76:79]
s_add_u32 s72, s71, 46080
buffer_load_dwordx4 v15, s[24:27], s72 offen offset:3072 lds
v_mfma_f32_16x16x32_bf16 v[76:79], v[156:159], a[180:183], v[76:79]
ds_read_b64_tr_b16 v[250:251], v10 offset:47104
ds_read_b64_tr_b16 v[252:253], v11 offset:45056
v_mfma_f32_16x16x32_bf16 v[76:79], v[172:175], a[184:187], v[76:79]
ds_read_b64_tr_b16 v[254:255], v11 offset:47104
v_mfma_f32_16x16x32_bf16 v[76:79], v[188:191], a[188:191], v[76:79]
buffer_load_dwordx4 a[244:247], v1, s[44:47], s69 offen offset:1024 sc1
v_mfma_f32_16x16x32_bf16 v[60:63], v[188:191], a[172:175], v[60:63]
v_mfma_f32_16x16x32_bf16 v[60:63], v[172:175], a[168:171], v[60:63]
s_add_u32 s71, s12, 0x400000
v_mfma_f32_16x16x32_bf16 v[60:63], v[156:159], a[164:167], v[60:63]
s_waitcnt vmcnt(18) lgkmcnt(0)
v_mfma_f32_16x16x32_bf16 v[60:63], v[140:143], a[160:163], v[60:63]
s_barrier
v_mfma_f32_16x16x32_bf16 v[16:19], v[192:195], a[128:131], v[16:19]
s_and_b32 s71, s71, 0x7c0000
ds_read_b64_tr_b16 v[128:129], v8 offset:49152
ds_read_b64_tr_b16 v[130:131], v8 offset:51200
v_mfma_f32_16x16x32_bf16 v[16:19], v[208:211], a[132:135], v[16:19]
s_add_u32 s71, s71, s78
ds_read_b64_tr_b16 v[132:133], v9 offset:49152
ds_read_b64_tr_b16 v[134:135], v9 offset:51200
v_mfma_f32_16x16x32_bf16 v[16:19], v[224:227], a[136:139], v[16:19]
s_add_u32 m0, s77, 32768
buffer_load_dwordx4 a[248:251], v1, s[44:47], s69 offen offset:2048 sc1
v_mfma_f32_16x16x32_bf16 v[16:19], v[240:243], a[140:143], v[16:19]
s_add_u32 s72, s71, 0
buffer_load_dwordx4 v15, s[24:27], s72 offen lds
v_mfma_f32_16x16x32_bf16 v[32:35], v[240:243], a[156:159], v[32:35]
ds_read_b64_tr_b16 v[136:137], v10 offset:49152
ds_read_b64_tr_b16 v[138:139], v10 offset:51200
v_mfma_f32_16x16x32_bf16 v[32:35], v[224:227], a[152:155], v[32:35]
ds_read_b64_tr_b16 v[140:141], v11 offset:49152
v_mfma_f32_16x16x32_bf16 v[32:35], v[208:211], a[148:151], v[32:35]
ds_read_b64_tr_b16 v[142:143], v11 offset:51200
ds_read_b64_tr_b16 v[144:145], v8 offset:53248
v_mfma_f32_16x16x32_bf16 v[32:35], v[192:195], a[144:147], v[32:35]
ds_read_b64_tr_b16 v[146:147], v8 offset:55296
ds_read_b64_tr_b16 v[148:149], v9 offset:53248
v_mfma_f32_16x16x32_bf16 v[36:39], v[196:199], a[144:147], v[36:39]
ds_read_b64_tr_b16 v[150:151], v9 offset:55296
v_mfma_f32_16x16x32_bf16 v[36:39], v[212:215], a[148:151], v[36:39]
buffer_load_dwordx4 a[252:255], v1, s[44:47], s69 offen offset:3072 sc1
v_mfma_f32_16x16x32_bf16 v[36:39], v[228:231], a[152:155], v[36:39]
s_add_u32 s72, s71, 15360
buffer_load_dwordx4 v15, s[24:27], s72 offen offset:1024 lds
v_mfma_f32_16x16x32_bf16 v[36:39], v[244:247], a[156:159], v[36:39]
ds_read_b64_tr_b16 v[152:153], v10 offset:53248
ds_read_b64_tr_b16 v[154:155], v10 offset:55296
v_mfma_f32_16x16x32_bf16 v[20:23], v[244:247], a[140:143], v[20:23]
ds_read_b64_tr_b16 v[156:157], v11 offset:53248
ds_read_b64_tr_b16 v[158:159], v11 offset:55296
v_mfma_f32_16x16x32_bf16 v[20:23], v[228:231], a[136:139], v[20:23]
ds_read_b64_tr_b16 v[160:161], v8 offset:57344
v_mfma_f32_16x16x32_bf16 v[20:23], v[212:215], a[132:135], v[20:23]
ds_read_b64_tr_b16 v[162:163], v8 offset:59392
ds_read_b64_tr_b16 v[164:165], v9 offset:57344
v_mfma_f32_16x16x32_bf16 v[20:23], v[196:199], a[128:131], v[20:23]
ds_read_b64_tr_b16 v[166:167], v9 offset:59392
ds_read_b64_tr_b16 v[168:169], v10 offset:57344
v_mfma_f32_16x16x32_bf16 v[24:27], v[200:203], a[128:131], v[24:27]
s_waitcnt vmcnt(59)
v_cmp_gt_u32 vcc, 2, v3
s_cbranch_vccnz Lspin109
Lback110:
s_add_u32 s82, s59, 28
s_and_b32 s82, s82, 28
s_lshl_b32 s82, s82, 10
s_add_u32 s82, s82, s74
buffer_load_dword v3, v2, s[44:47], s82 offen sc1
s_add_u32 s69, s12, 0x400000
s_and_b32 s69, s69, 0x7c0000
s_lshr_b32 s69, s69, 6
s_add_u32 s69, s69, s95
buffer_load_dwordx4 a[0:3], v1, s[44:47], s69 offen sc1
v_mfma_f32_16x16x32_bf16 v[24:27], v[216:219], a[132:135], v[24:27]
s_add_u32 s72, s71, 30720
buffer_load_dwordx4 v15, s[24:27], s72 offen offset:2048 lds
v_mfma_f32_16x16x32_bf16 v[24:27], v[232:235], a[136:139], v[24:27]
ds_read_b64_tr_b16 v[170:171], v10 offset:59392
v_mfma_f32_16x16x32_bf16 v[24:27], v[248:251], a[140:143], v[24:27]
ds_read_b64_tr_b16 v[172:173], v11 offset:57344
ds_read_b64_tr_b16 v[174:175], v11 offset:59392
v_mfma_f32_16x16x32_bf16 v[40:43], v[248:251], a[156:159], v[40:43]
ds_read_b64_tr_b16 v[176:177], v8 offset:61440
ds_read_b64_tr_b16 v[178:179], v8 offset:63488
v_mfma_f32_16x16x32_bf16 v[40:43], v[232:235], a[152:155], v[40:43]
ds_read_b64_tr_b16 v[180:181], v9 offset:61440
v_mfma_f32_16x16x32_bf16 v[40:43], v[216:219], a[148:151], v[40:43]
buffer_load_dwordx4 a[4:7], v1, s[44:47], s69 offen offset:1024 sc1
v_mfma_f32_16x16x32_bf16 v[40:43], v[200:203], a[144:147], v[40:43]
ds_read_b64_tr_b16 v[182:183], v9 offset:63488
ds_read_b64_tr_b16 v[184:185], v10 offset:61440
v_mfma_f32_16x16x32_bf16 v[44:47], v[204:207], a[144:147], v[44:47]
s_add_u32 s72, s71, 46080
buffer_load_dwordx4 v15, s[24:27], s72 offen offset:3072 lds
v_mfma_f32_16x16x32_bf16 v[44:47], v[220:223], a[148:151], v[44:47]
ds_read_b64_tr_b16 v[186:187], v10 offset:63488
ds_read_b64_tr_b16 v[188:189], v11 offset:61440
v_mfma_f32_16x16x32_bf16 v[44:47], v[236:239], a[152:155], v[44:47]
ds_read_b64_tr_b16 v[190:191], v11 offset:63488
v_mfma_f32_16x16x32_bf16 v[44:47], v[252:255], a[156:159], v[44:47]
v_mfma_f32_16x16x32_bf16 v[28:31], v[252:255], a[140:143], v[28:31]
v_mfma_f32_16x16x32_bf16 v[28:31], v[236:239], a[136:139], v[28:31]
s_add_u32 s71, s14, 0x200000
buffer_load_dwordx4 a[8:11], v1, s[44:47], s69 offen offset:2048 sc1
v_mfma_f32_16x16x32_bf16 v[28:31], v[220:223], a[132:135], v[28:31]
s_waitcnt vmcnt(20) lgkmcnt(0)
v_mfma_f32_16x16x32_bf16 v[28:31], v[204:207], a[128:131], v[28:31]
s_barrier
v_mfma_f32_16x16x32_bf16 v[48:51], v[128:131], a[192:195], v[48:51]
s_and_b32 s71, s71, 0x7c0000
ds_read_b64_tr_b16 v[192:193], v8 offset:0
ds_read_b64_tr_b16 v[194:195], v8 offset:2048
s_lshl_b32 s84, s76, 11
s_add_u32 s84, s84, 0x3810000
v_lshrrev_b32 v115, 2, v0
v_lshlrev_b32 v115, 7, v115
buffer_load_dword v114, v115, s[44:47], s84 offen sc1
v_mfma_f32_16x16x32_bf16 v[48:51], v[144:147], a[196:199], v[48:51]
s_add_u32 s71, s71, s94
ds_read_b64_tr_b16 v[196:197], v9 offset:0
ds_read_b64_tr_b16 v[198:199], v9 offset:2048
v_mfma_f32_16x16x32_bf16 v[48:51], v[160:163], a[200:203], v[48:51]
s_add_u32 m0, s77, 49152
ds_read_b64_tr_b16 v[200:201], v10 offset:0
ds_read_b64_tr_b16 v[202:203], v10 offset:2048
v_mfma_f32_16x16x32_bf16 v[48:51], v[176:179], a[204:207], v[48:51]
s_add_u32 s72, s71, 0
buffer_load_dwordx4 v15, s[24:27], s72 offen lds
v_mfma_f32_16x16x32_bf16 v[64:67], v[176:179], a[220:223], v[64:67]
buffer_load_dwordx4 a[12:15], v1, s[44:47], s69 offen offset:3072 sc1
v_mfma_f32_16x16x32_bf16 v[64:67], v[160:163], a[216:219], v[64:67]
ds_read_b64_tr_b16 v[204:205], v11 offset:0
ds_read_b64 v[80:81], v116 offset:0
v_mfma_f32_16x16x32_bf16 v[64:67], v[144:147], a[212:215], v[64:67]
ds_read_b64_tr_b16 v[206:207], v11 offset:2048
ds_read_b64_tr_b16 v[208:209], v8 offset:4096
v_mfma_f32_16x16x32_bf16 v[64:67], v[128:131], a[208:211], v[64:67]
ds_read_b64_tr_b16 v[210:211], v8 offset:6144
ds_read_b64_tr_b16 v[212:213], v9 offset:4096
v_mfma_f32_16x16x32_bf16 v[68:71], v[132:135], a[208:211], v[68:71]
ds_read_b64_tr_b16 v[214:215], v9 offset:6144
ds_read_b64 v[82:83], v117 offset:0
v_mfma_f32_16x16x32_bf16 v[68:71], v[148:151], a[212:215], v[68:71]
ds_read_b64_tr_b16 v[216:217], v10 offset:4096
ds_read_b64_tr_b16 v[218:219], v10 offset:6144
v_mfma_f32_16x16x32_bf16 v[68:71], v[164:167], a[216:219], v[68:71]
s_add_u32 s72, s71, 15360
buffer_load_dwordx4 v15, s[24:27], s72 offen offset:1024 lds
v_mfma_f32_16x16x32_bf16 v[68:71], v[180:183], a[220:223], v[68:71]
s_add_u32 s69, s69, 0x20000
buffer_load_dwordx4 a[16:19], v1, s[44:47], s69 offen sc1
v_mfma_f32_16x16x32_bf16 v[52:55], v[180:183], a[204:207], v[52:55]
ds_read_b64_tr_b16 v[220:221], v11 offset:4096
ds_read_b64_tr_b16 v[222:223], v11 offset:6144
v_mfma_f32_16x16x32_bf16 v[52:55], v[164:167], a[200:203], v[52:55]
ds_read_b64_tr_b16 v[224:225], v8 offset:8192
ds_read_b64 v[84:85], v118 offset:0
v_mfma_f32_16x16x32_bf16 v[52:55], v[148:151], a[196:199], v[52:55]
ds_read_b64_tr_b16 v[226:227], v8 offset:10240
ds_read_b64_tr_b16 v[228:229], v9 offset:8192
v_mfma_f32_16x16x32_bf16 v[52:55], v[132:135], a[192:195], v[52:55]
ds_read_b64_tr_b16 v[230:231], v9 offset:10240
ds_read_b64_tr_b16 v[232:233], v10 offset:8192
v_mfma_f32_16x16x32_bf16 v[56:59], v[136:139], a[192:195], v[56:59]
ds_read_b64_tr_b16 v[234:235], v10 offset:10240
ds_read_b64 v[86:87], v119 offset:0
v_mfma_f32_16x16x32_bf16 v[56:59], v[152:155], a[196:199], v[56:59]
s_add_u32 s72, s71, 30720
buffer_load_dwordx4 v15, s[24:27], s72 offen offset:2048 lds
v_mfma_f32_16x16x32_bf16 v[56:59], v[168:171], a[200:203], v[56:59]
buffer_load_dwordx4 a[20:23], v1, s[44:47], s69 offen offset:1024 sc1
v_mfma_f32_16x16x32_bf16 v[56:59], v[184:187], a[204:207], v[56:59]
ds_read_b64_tr_b16 v[236:237], v11 offset:8192
ds_read_b64_tr_b16 v[238:239], v11 offset:10240
v_mfma_f32_16x16x32_bf16 v[72:75], v[184:187], a[220:223], v[72:75]
ds_read_b64_tr_b16 v[240:241], v8 offset:12288
ds_read_b64_tr_b16 v[242:243], v8 offset:14336
v_mfma_f32_16x16x32_bf16 v[72:75], v[168:171], a[216:219], v[72:75]
ds_read_b64_tr_b16 v[244:245], v9 offset:12288
ds_read_b64 v[96:97], v116 offset:2048
v_mfma_f32_16x16x32_bf16 v[72:75], v[152:155], a[212:215], v[72:75]
ds_read_b64_tr_b16 v[246:247], v9 offset:14336
ds_read_b64_tr_b16 v[248:249], v10 offset:12288
v_mfma_f32_16x16x32_bf16 v[72:75], v[136:139], a[208:211], v[72:75]
ds_read_b64_tr_b16 v[250:251], v10 offset:14336
ds_read_b64_tr_b16 v[252:253], v11 offset:12288
v_mfma_f32_16x16x32_bf16 v[76:79], v[140:143], a[208:211], v[76:79]
s_add_u32 s72, s71, 46080
buffer_load_dwordx4 v15, s[24:27], s72 offen offset:3072 lds
v_mfma_f32_16x16x32_bf16 v[76:79], v[156:159], a[212:215], v[76:79]
buffer_load_dwordx4 a[24:27], v1, s[44:47], s69 offen offset:2048 sc1
v_mfma_f32_16x16x32_bf16 v[76:79], v[172:175], a[216:219], v[76:79]
ds_read_b64_tr_b16 v[254:255], v11 offset:14336
ds_read_b64 v[98:99], v117 offset:2048
v_mfma_f32_16x16x32_bf16 v[76:79], v[188:191], a[220:223], v[76:79]
ds_read_b64 v[100:101], v118 offset:2048
ds_read_b64 v[102:103], v119 offset:2048
v_mfma_f32_16x16x32_bf16 v[60:63], v[188:191], a[204:207], v[60:63]
v_mfma_f32_16x16x32_bf16 v[60:63], v[172:175], a[200:203], v[60:63]
s_add_u32 s71, s13, 0x400000
v_mfma_f32_16x16x32_bf16 v[60:63], v[156:159], a[196:199], v[60:63]
s_waitcnt vmcnt(20) lgkmcnt(0)
v_mfma_f32_16x16x32_bf16 v[60:63], v[140:143], a[192:195], v[60:63]
s_barrier
v_mfma_f32_16x16x32_bf16 v[16:19], v[192:195], a[160:163], v[16:19]
s_and_b32 s71, s71, 0x7c0000
buffer_load_dwordx4 a[28:31], v1, s[44:47], s69 offen offset:3072 sc1
v_mfma_f32_16x16x32_bf16 v[16:19], v[208:211], a[164:167], v[16:19]
s_add_u32 s71, s71, s78
ds_read_b64_tr_b16 v[128:129], v8 offset:16384
ds_read_b64_tr_b16 v[130:131], v8 offset:18432
v_mfma_f32_16x16x32_bf16 v[16:19], v[224:227], a[168:171], v[16:19]
s_add_u32 m0, s77, 0
ds_read_b64_tr_b16 v[132:133], v9 offset:16384
ds_read_b64_tr_b16 v[134:135], v9 offset:18432
v_mfma_f32_16x16x32_bf16 v[16:19], v[240:243], a[172:175], v[16:19]
s_add_u32 s72, s71, 0
buffer_load_dwordx4 v15, s[24:27], s72 offen lds
v_mfma_f32_16x16x32_bf16 v[32:35], v[240:243], a[188:191], v[32:35]
s_add_u32 s69, s13, 0x400000
ds_read_b64_tr_b16 v[136:137], v10 offset:16384
ds_read_b64_tr_b16 v[138:139], v10 offset:18432
v_mfma_f32_16x16x32_bf16 v[32:35], v[224:227], a[184:187], v[32:35]
s_and_b32 s69, s69, 0x7c0000
ds_read_b64_tr_b16 v[140:141], v11 offset:16384
v_mfma_f32_16x16x32_bf16 v[32:35], v[208:211], a[180:183], v[32:35]
s_lshr_b32 s69, s69, 6
ds_read_b64_tr_b16 v[142:143], v11 offset:18432
ds_read_b64_tr_b16 v[144:145], v8 offset:20480
v_mfma_f32_16x16x32_bf16 v[32:35], v[192:195], a[176:179], v[32:35]
s_add_u32 s69, s69, s95
buffer_load_dwordx4 a[32:35], v1, s[44:47], s69 offen sc1
v_mfma_f32_16x16x32_bf16 v[36:39], v[196:199], a[176:179], v[36:39]
ds_read_b64_tr_b16 v[146:147], v8 offset:22528
ds_read_b64_tr_b16 v[148:149], v9 offset:20480
v_mfma_f32_16x16x32_bf16 v[36:39], v[212:215], a[180:183], v[36:39]
ds_read_b64_tr_b16 v[150:151], v9 offset:22528
v_mfma_f32_16x16x32_bf16 v[36:39], v[228:231], a[184:187], v[36:39]
s_add_u32 s72, s71, 15360
buffer_load_dwordx4 v15, s[24:27], s72 offen offset:1024 lds
v_mfma_f32_16x16x32_bf16 v[36:39], v[244:247], a[188:191], v[36:39]
ds_read_b64_tr_b16 v[152:153], v10 offset:20480
ds_read_b64_tr_b16 v[154:155], v10 offset:22528
v_mfma_f32_16x16x32_bf16 v[20:23], v[244:247], a[172:175], v[20:23]
ds_read_b64_tr_b16 v[156:157], v11 offset:20480
ds_read_b64_tr_b16 v[158:159], v11 offset:22528
v_mfma_f32_16x16x32_bf16 v[20:23], v[228:231], a[168:171], v[20:23]
buffer_load_dwordx4 a[36:39], v1, s[44:47], s69 offen offset:1024 sc1
v_mfma_f32_16x16x32_bf16 v[20:23], v[212:215], a[164:167], v[20:23]
ds_read_b64_tr_b16 v[160:161], v8 offset:24576
v_mfma_f32_16x16x32_bf16 v[20:23], v[196:199], a[160:163], v[20:23]
ds_read_b64_tr_b16 v[162:163], v8 offset:26624
ds_read_b64_tr_b16 v[164:165], v9 offset:24576
v_mfma_f32_16x16x32_bf16 v[24:27], v[200:203], a[160:163], v[24:27]
ds_read_b64_tr_b16 v[166:167], v9 offset:26624
ds_read_b64_tr_b16 v[168:169], v10 offset:24576
v_mfma_f32_16x16x32_bf16 v[24:27], v[216:219], a[164:167], v[24:27]
s_add_u32 s72, s71, 30720
buffer_load_dwordx4 v15, s[24:27], s72 offen offset:2048 lds
v_mfma_f32_16x16x32_bf16 v[24:27], v[232:235], a[168:171], v[24:27]
ds_read_b64_tr_b16 v[170:171], v10 offset:26624
v_mfma_f32_16x16x32_bf16 v[24:27], v[248:251], a[172:175], v[24:27]
ds_read_b64_tr_b16 v[172:173], v11 offset:24576
ds_read_b64_tr_b16 v[174:175], v11 offset:26624
v_mfma_f32_16x16x32_bf16 v[40:43], v[248:251], a[188:191], v[40:43]
buffer_load_dwordx4 a[40:43], v1, s[44:47], s69 offen offset:2048 sc1
v_mfma_f32_16x16x32_bf16 v[40:43], v[232:235], a[184:187], v[40:43]
ds_read_b64_tr_b16 v[176:177], v8 offset:28672
ds_read_b64_tr_b16 v[178:179], v8 offset:30720
v_mfma_f32_16x16x32_bf16 v[40:43], v[216:219], a[180:183], v[40:43]
ds_read_b64_tr_b16 v[180:181], v9 offset:28672
v_mfma_f32_16x16x32_bf16 v[40:43], v[200:203], a[176:179], v[40:43]
ds_read_b64_tr_b16 v[182:183], v9 offset:30720
ds_read_b64_tr_b16 v[184:185], v10 offset:28672
v_mfma_f32_16x16x32_bf16 v[44:47], v[204:207], a[176:179], v[44:47]
s_add_u32 s72, s71, 46080
buffer_load_dwordx4 v15, s[24:27], s72 offen offset:3072 lds
v_mfma_f32_16x16x32_bf16 v[44:47], v[220:223], a[180:183], v[44:47]
ds_read_b64_tr_b16 v[186:187], v10 offset:30720
ds_read_b64_tr_b16 v[188:189], v11 offset:28672
v_mfma_f32_16x16x32_bf16 v[44:47], v[236:239], a[184:187], v[44:47]
ds_read_b64_tr_b16 v[190:191], v11 offset:30720
v_mfma_f32_16x16x32_bf16 v[44:47], v[252:255], a[188:191], v[44:47]
buffer_load_dwordx4 a[44:47], v1, s[44:47], s69 offen offset:3072 sc1
v_mfma_f32_16x16x32_bf16 v[28:31], v[252:255], a[172:175], v[28:31]
s_add_u32 s69, s69, 0x20000
v_mfma_f32_16x16x32_bf16 v[28:31], v[236:239], a[168:171], v[28:31]
s_add_u32 s71, s15, 0x200000
v_mfma_f32_16x16x32_bf16 v[28:31], v[220:223], a[164:167], v[28:31]
s_waitcnt vmcnt(19) lgkmcnt(0)
v_mfma_f32_16x16x32_bf16 v[28:31], v[204:207], a[160:163], v[28:31]
s_barrier
v_mfma_f32_16x16x32_bf16 v[48:51], v[128:131], a[224:227], v[48:51]
s_and_b32 s71, s71, 0x7c0000
ds_read_b64_tr_b16 v[192:193], v8 offset:32768
ds_read_b64_tr_b16 v[194:195], v8 offset:34816
v_mfma_f32_16x16x32_bf16 v[48:51], v[144:147], a[228:231], v[48:51]
s_add_u32 s71, s71, s94
ds_read_b64_tr_b16 v[196:197], v9 offset:32768
ds_read_b64_tr_b16 v[198:199], v9 offset:34816
v_mfma_f32_16x16x32_bf16 v[48:51], v[160:163], a[232:235], v[48:51]
s_add_u32 m0, s77, 16384
buffer_load_dwordx4 a[48:51], v1, s[44:47], s69 offen sc1
v_mfma_f32_16x16x32_bf16 v[48:51], v[176:179], a[236:239], v[48:51]
s_add_u32 s72, s71, 0
buffer_load_dwordx4 v15, s[24:27], s72 offen lds
v_mfma_f32_16x16x32_bf16 v[64:67], v[176:179], a[252:255], v[64:67]
ds_read_b64_tr_b16 v[200:201], v10 offset:32768
ds_read_b64_tr_b16 v[202:203], v10 offset:34816
v_mfma_f32_16x16x32_bf16 v[64:67], v[160:163], a[248:251], v[64:67]
ds_read_b64_tr_b16 v[204:205], v11 offset:32768
v_mfma_f32_16x16x32_bf16 v[64:67], v[144:147], a[244:247], v[64:67]
ds_read_b64_tr_b16 v[206:207], v11 offset:34816
ds_read_b64_tr_b16 v[208:209], v8 offset:36864
v_mfma_f32_16x16x32_bf16 v[64:67], v[128:131], a[240:243], v[64:67]
ds_read_b64_tr_b16 v[210:211], v8 offset:38912
ds_read_b64_tr_b16 v[212:213], v9 offset:36864
v_mfma_f32_16x16x32_bf16 v[68:71], v[132:135], a[240:243], v[68:71]
ds_read_b64_tr_b16 v[214:215], v9 offset:38912
s_waitcnt vmcnt(19)
v_cmp_gt_u32 vcc, 3, v114
s_cbranch_vccnz Lspin115
Lback116:
s_lshl_b32 s73, s76, 18
s_lshl_b32 s84, s58, 16
s_add_u32 s73, s73, s84
s_lshl_b32 s84, s75, 8
s_add_u32 s73, s73, s84
s_add_u32 s73, s73, 0x3400000
v_lshrrev_b32 v112, 4, v0
v_and_b32 v113, 15, v0
v_lshlrev_b32 v114, 4, v113
v_lshl_add_u32 v112, v112, 12, v114
v_lshlrev_b32 v113, 2, v113
v_mfma_f32_16x16x32_bf16 v[68:71], v[148:151], a[244:247], v[68:71]
buffer_load_dwordx4 a[52:55], v1, s[44:47], s69 offen offset:1024 sc1
v_mfma_f32_16x16x32_bf16 v[68:71], v[164:167], a[248:251], v[68:71]
s_add_u32 s72, s71, 15360
buffer_load_dwordx4 v15, s[24:27], s72 offen offset:1024 lds
v_mfma_f32_16x16x32_bf16 v[68:71], v[180:183], a[252:255], v[68:71]
ds_read_b64_tr_b16 v[216:217], v10 offset:36864
ds_read_b64_tr_b16 v[218:219], v10 offset:38912
v_mfma_f32_16x16x32_bf16 v[52:55], v[180:183], a[236:239], v[52:55]
ds_read_b64_tr_b16 v[220:221], v11 offset:36864
ds_read_b64_tr_b16 v[222:223], v11 offset:38912
v_mfma_f32_16x16x32_bf16 v[52:55], v[164:167], a[232:235], v[52:55]
ds_read_b64_tr_b16 v[224:225], v8 offset:40960
v_mfma_f32_16x16x32_bf16 v[52:55], v[148:151], a[228:231], v[52:55]
ds_read_b64_tr_b16 v[226:227], v8 offset:43008
ds_read_b64_tr_b16 v[228:229], v9 offset:40960
v_mfma_f32_16x16x32_bf16 v[52:55], v[132:135], a[224:227], v[52:55]
ds_read_b64_tr_b16 v[230:231], v9 offset:43008
ds_read_b64_tr_b16 v[232:233], v10 offset:40960
v_mfma_f32_16x16x32_bf16 v[56:59], v[136:139], a[224:227], v[56:59]
buffer_load_dwordx4 a[56:59], v1, s[44:47], s69 offen offset:2048 sc1
v_mfma_f32_16x16x32_bf16 v[56:59], v[152:155], a[228:231], v[56:59]
s_add_u32 s72, s71, 30720
buffer_load_dwordx4 v15, s[24:27], s72 offen offset:2048 lds
v_mfma_f32_16x16x32_bf16 v[56:59], v[168:171], a[232:235], v[56:59]
ds_read_b64_tr_b16 v[234:235], v10 offset:43008
v_mfma_f32_16x16x32_bf16 v[56:59], v[184:187], a[236:239], v[56:59]
ds_read_b64_tr_b16 v[236:237], v11 offset:40960
ds_read_b64_tr_b16 v[238:239], v11 offset:43008
v_mfma_f32_16x16x32_bf16 v[72:75], v[184:187], a[252:255], v[72:75]
ds_read_b64_tr_b16 v[240:241], v8 offset:45056
ds_read_b64_tr_b16 v[242:243], v8 offset:47104
v_mfma_f32_16x16x32_bf16 v[72:75], v[168:171], a[248:251], v[72:75]
ds_read_b64_tr_b16 v[244:245], v9 offset:45056
v_mfma_f32_16x16x32_bf16 v[72:75], v[152:155], a[244:247], v[72:75]
ds_read_b64_tr_b16 v[246:247], v9 offset:47104
ds_read_b64_tr_b16 v[248:249], v10 offset:45056
v_mfma_f32_16x16x32_bf16 v[72:75], v[136:139], a[240:243], v[72:75]
buffer_load_dwordx4 a[60:63], v1, s[44:47], s69 offen offset:3072 sc1
v_mfma_f32_16x16x32_bf16 v[76:79], v[140:143], a[240:243], v[76:79]
s_add_u32 s72, s71, 46080
buffer_load_dwordx4 v15, s[24:27], s72 offen offset:3072 lds
v_mfma_f32_16x16x32_bf16 v[76:79], v[156:159], a[244:247], v[76:79]
s_add_u32 s69, s14, 0x400000
ds_read_b64_tr_b16 v[250:251], v10 offset:47104
ds_read_b64_tr_b16 v[252:253], v11 offset:45056
v_mfma_f32_16x16x32_bf16 v[76:79], v[172:175], a[248:251], v[76:79]
s_and_b32 s69, s69, 0x7c0000
ds_read_b64_tr_b16 v[254:255], v11 offset:47104
v_mfma_f32_16x16x32_bf16 v[76:79], v[188:191], a[252:255], v[76:79]
s_lshr_b32 s69, s69, 6
v_mfma_f32_16x16x32_bf16 v[60:63], v[188:191], a[236:239], v[60:63]
s_add_u32 s69, s69, s95
v_mfma_f32_16x16x32_bf16 v[60:63], v[172:175], a[232:235], v[60:63]
s_add_u32 s71, s14, 0x400000
v_mfma_f32_16x16x32_bf16 v[60:63], v[156:159], a[228:231], v[60:63]
s_waitcnt vmcnt(16) lgkmcnt(0)
buffer_load_dwordx4 a[64:67], v1, s[44:47], s69 offen sc1
v_mfma_f32_16x16x32_bf16 v[60:63], v[140:143], a[224:227], v[60:63]
s_barrier
v_mfma_f32_16x16x32_bf16 v[48:51], v[192:195], a[0:3], v[48:51]
s_and_b32 s71, s71, 0x7c0000
ds_read_b64_tr_b16 v[128:129], v8 offset:49152
ds_read_b64_tr_b16 v[130:131], v8 offset:51200
v_mfma_f32_16x16x32_bf16 v[48:51], v[208:211], a[4:7], v[48:51]
s_add_u32 s71, s71, s78
ds_read_b64_tr_b16 v[132:133], v9 offset:49152
ds_read_b64_tr_b16 v[134:135], v9 offset:51200
v_mfma_f32_16x16x32_bf16 v[48:51], v[224:227], a[8:11], v[48:51]
s_add_u32 m0, s77, 32768
ds_read_b64_tr_b16 v[136:137], v10 offset:49152
ds_read_b64_tr_b16 v[138:139], v10 offset:51200
v_mfma_f32_16x16x32_bf16 v[48:51], v[240:243], a[12:15], v[48:51]
s_add_u32 s72, s71, 0
buffer_load_dwordx4 v15, s[24:27], s72 offen lds
v_mfma_f32_16x16x32_bf16 v[64:67], v[240:243], a[28:31], v[64:67]
buffer_load_dwordx4 a[68:71], v1, s[44:47], s69 offen offset:1024 sc1
v_mfma_f32_16x16x32_bf16 v[64:67], v[224:227], a[24:27], v[64:67]
ds_read_b64_tr_b16 v[140:141], v11 offset:49152
ds_read_b64_tr_b16 v[142:143], v11 offset:51200
v_mfma_f32_16x16x32_bf16 v[64:67], v[208:211], a[20:23], v[64:67]
s_add_u32 s72, s71, 15360
buffer_load_dwordx4 v15, s[24:27], s72 offen offset:1024 lds
v_mfma_f32_16x16x32_bf16 v[64:67], v[192:195], a[16:19], v[64:67]
ds_read_b64_tr_b16 v[144:145], v8 offset:53248
ds_read_b64_tr_b16 v[146:147], v8 offset:55296
v_mfma_f32_16x16x32_bf16 v[68:71], v[196:199], a[16:19], v[68:71]
ds_read_b64_tr_b16 v[148:149], v9 offset:53248
ds_read_b64_tr_b16 v[150:151], v9 offset:55296
v_mfma_f32_16x16x32_bf16 v[68:71], v[212:215], a[20:23], v[68:71]
ds_read_b64_tr_b16 v[152:153], v10 offset:53248
ds_read_b64_tr_b16 v[154:155], v10 offset:55296
v_mfma_f32_16x16x32_bf16 v[68:71], v[228:231], a[24:27], v[68:71]
s_add_u32 s72, s71, 30720
buffer_load_dwordx4 v15, s[24:27], s72 offen offset:2048 lds
v_mfma_f32_16x16x32_bf16 v[68:71], v[244:247], a[28:31], v[68:71]
buffer_load_dwordx4 a[72:75], v1, s[44:47], s69 offen offset:2048 sc1
v_mfma_f32_16x16x32_bf16 v[52:55], v[244:247], a[12:15], v[52:55]
ds_read_b64_tr_b16 v[156:157], v11 offset:53248
ds_read_b64_tr_b16 v[158:159], v11 offset:55296
v_mfma_f32_16x16x32_bf16 v[52:55], v[228:231], a[8:11], v[52:55]
s_add_u32 s72, s71, 46080
buffer_load_dwordx4 v15, s[24:27], s72 offen offset:3072 lds
v_mfma_f32_16x16x32_bf16 v[52:55], v[212:215], a[4:7], v[52:55]
ds_read_b64_tr_b16 v[160:161], v8 offset:57344
ds_read_b64_tr_b16 v[162:163], v8 offset:59392
v_mfma_f32_16x16x32_bf16 v[52:55], v[196:199], a[0:3], v[52:55]
ds_read_b64_tr_b16 v[164:165], v9 offset:57344
ds_read_b64_tr_b16 v[166:167], v9 offset:59392
v_mfma_f32_16x16x32_bf16 v[56:59], v[200:203], a[0:3], v[56:59]
s_add_u32 m0, s64, 147456
ds_read_b64_tr_b16 v[168:169], v10 offset:57344
ds_read_b64_tr_b16 v[170:171], v10 offset:59392
v_mfma_f32_16x16x32_bf16 v[56:59], v[216:219], a[4:7], v[56:59]
s_add_u32 s72, s73, 0
buffer_load_dwordx4 v112, s[44:47], s72 offen sc1 lds
v_mfma_f32_16x16x32_bf16 v[56:59], v[232:235], a[8:11], v[56:59]
buffer_load_dwordx4 a[76:79], v1, s[44:47], s69 offen offset:3072 sc1
v_mfma_f32_16x16x32_bf16 v[56:59], v[248:251], a[12:15], v[56:59]
ds_read_b64_tr_b16 v[172:173], v11 offset:57344
ds_read_b64_tr_b16 v[174:175], v11 offset:59392
v_mfma_f32_16x16x32_bf16 v[72:75], v[248:251], a[28:31], v[72:75]
s_add_u32 s72, s73, 15360
buffer_load_dwordx4 v112, s[44:47], s72 offen offset:1024 sc1 lds
v_mfma_f32_16x16x32_bf16 v[72:75], v[232:235], a[24:27], v[72:75]
ds_read_b64_tr_b16 v[176:177], v8 offset:61440
ds_read_b64_tr_b16 v[178:179], v8 offset:63488
v_mfma_f32_16x16x32_bf16 v[72:75], v[216:219], a[20:23], v[72:75]
ds_read_b64_tr_b16 v[180:181], v9 offset:61440
ds_read_b64_tr_b16 v[182:183], v9 offset:63488
v_mfma_f32_16x16x32_bf16 v[72:75], v[200:203], a[16:19], v[72:75]
ds_read_b64_tr_b16 v[184:185], v10 offset:61440
ds_read_b64_tr_b16 v[186:187], v10 offset:63488
v_mfma_f32_16x16x32_bf16 v[76:79], v[204:207], a[16:19], v[76:79]
s_add_u32 s72, s73, 30720
buffer_load_dwordx4 v112, s[44:47], s72 offen offset:2048 sc1 lds
v_mfma_f32_16x16x32_bf16 v[76:79], v[220:223], a[20:23], v[76:79]
s_add_u32 s69, s69, 0x20000
buffer_load_dwordx4 a[80:83], v1, s[44:47], s69 offen sc1
v_mfma_f32_16x16x32_bf16 v[76:79], v[236:239], a[24:27], v[76:79]
ds_read_b64_tr_b16 v[188:189], v11 offset:61440
ds_read_b64_tr_b16 v[190:191], v11 offset:63488
v_mfma_f32_16x16x32_bf16 v[76:79], v[252:255], a[28:31], v[76:79]
s_add_u32 s72, s73, 46080
buffer_load_dwordx4 v112, s[44:47], s72 offen offset:3072 sc1 lds
v_mfma_f32_16x16x32_bf16 v[60:63], v[252:255], a[12:15], v[60:63]
v_mfma_f32_16x16x32_bf16 v[60:63], v[236:239], a[8:11], v[60:63]
s_add_u32 s71, s12, 0x400000
v_mfma_f32_16x16x32_bf16 v[60:63], v[220:223], a[4:7], v[60:63]
s_waitcnt vmcnt(22) lgkmcnt(0)
v_mfma_f32_16x16x32_bf16 v[60:63], v[204:207], a[0:3], v[60:63]
s_barrier
v_mfma_f32_16x16x32_bf16 v[16:19], v[128:131], a[192:195], v[16:19]
s_and_b32 s71, s71, 0x7c0000
buffer_load_dwordx4 a[84:87], v1, s[44:47], s69 offen offset:1024 sc1
v_mfma_f32_16x16x32_bf16 v[16:19], v[144:147], a[196:199], v[16:19]
s_add_u32 s71, s71, s94
ds_read_b64_tr_b16 v[192:193], v8 offset:0
ds_read_b64_tr_b16 v[194:195], v8 offset:2048
v_mfma_f32_16x16x32_bf16 v[16:19], v[160:163], a[200:203], v[16:19]
s_add_u32 m0, s77, 49152
ds_read_b64_tr_b16 v[196:197], v9 offset:0
ds_read_b64_tr_b16 v[198:199], v9 offset:2048
s_lshl_b32 s73, s75, 9
s_lshl_b32 s84, s58, 7
s_add_u32 s73, s73, s84
s_add_u32 s73, s73, 0x3800000
buffer_load_dword v6, v113, s[44:47], s73 offen sc1
buffer_load_dword v7, v113, s[44:47], s73 offen offset:64 sc1
v_mfma_f32_16x16x32_bf16 v[16:19], v[176:179], a[204:207], v[16:19]
s_add_u32 s72, s71, 0
buffer_load_dwordx4 v15, s[24:27], s72 offen lds
v_mfma_f32_16x16x32_bf16 v[32:35], v[176:179], a[220:223], v[32:35]
ds_read_b64_tr_b16 v[200:201], v10 offset:0
ds_read_b64_tr_b16 v[202:203], v10 offset:2048
v_mfma_f32_16x16x32_bf16 v[32:35], v[160:163], a[216:219], v[32:35]
ds_read_b64_tr_b16 v[204:205], v11 offset:0
v_mfma_f32_16x16x32_bf16 v[32:35], v[144:147], a[212:215], v[32:35]
ds_read_b64_tr_b16 v[206:207], v11 offset:2048
ds_read_b64_tr_b16 v[208:209], v8 offset:4096
v_mfma_f32_16x16x32_bf16 v[32:35], v[128:131], a[208:211], v[32:35]
buffer_load_dwordx4 a[88:91], v1, s[44:47], s69 offen offset:2048 sc1
v_mfma_f32_16x16x32_bf16 v[36:39], v[132:135], a[208:211], v[36:39]
ds_read_b64_tr_b16 v[210:211], v8 offset:6144
ds_read_b64_tr_b16 v[212:213], v9 offset:4096
v_mfma_f32_16x16x32_bf16 v[36:39], v[148:151], a[212:215], v[36:39]
ds_read_b64_tr_b16 v[214:215], v9 offset:6144
v_mfma_f32_16x16x32_bf16 v[36:39], v[164:167], a[216:219], v[36:39]
s_add_u32 s72, s71, 15360
buffer_load_dwordx4 v15, s[24:27], s72 offen offset:1024 lds
v_mfma_f32_16x16x32_bf16 v[36:39], v[180:183], a[220:223], v[36:39]
ds_read_b64_tr_b16 v[216:217], v10 offset:4096
ds_read_b64_tr_b16 v[218:219], v10 offset:6144
v_mfma_f32_16x16x32_bf16 v[20:23], v[180:183], a[204:207], v[20:23]
ds_read_b64_tr_b16 v[220:221], v11 offset:4096
ds_read_b64_tr_b16 v[222:223], v11 offset:6144
v_mfma_f32_16x16x32_bf16 v[20:23], v[164:167], a[200:203], v[20:23]
ds_read_b64_tr_b16 v[224:225], v8 offset:8192
v_mfma_f32_16x16x32_bf16 v[20:23], v[148:151], a[196:199], v[20:23]
buffer_load_dwordx4 a[92:95], v1, s[44:47], s69 offen offset:3072 sc1
v_mfma_f32_16x16x32_bf16 v[20:23], v[132:135], a[192:195], v[20:23]
ds_read_b64_tr_b16 v[226:227], v8 offset:10240
ds_read_b64_tr_b16 v[228:229], v9 offset:8192
v_mfma_f32_16x16x32_bf16 v[24:27], v[136:139], a[192:195], v[24:27]
ds_read_b64_tr_b16 v[230:231], v9 offset:10240
ds_read_b64_tr_b16 v[232:233], v10 offset:8192
v_mfma_f32_16x16x32_bf16 v[24:27], v[152:155], a[196:199], v[24:27]
s_add_u32 s72, s71, 30720
buffer_load_dwordx4 v15, s[24:27], s72 offen offset:2048 lds
v_mfma_f32_16x16x32_bf16 v[24:27], v[168:171], a[200:203], v[24:27]
s_add_u32 s69, s15, 0x400000
ds_read_b64_tr_b16 v[234:235], v10 offset:10240
v_mfma_f32_16x16x32_bf16 v[24:27], v[184:187], a[204:207], v[24:27]
s_and_b32 s69, s69, 0x7c0000
ds_read_b64_tr_b16 v[236:237], v11 offset:8192
ds_read_b64_tr_b16 v[238:239], v11 offset:10240
v_mfma_f32_16x16x32_bf16 v[40:43], v[184:187], a[220:223], v[40:43]
s_lshr_b32 s69, s69, 6
ds_read_b64_tr_b16 v[240:241], v8 offset:12288
ds_read_b64_tr_b16 v[242:243], v8 offset:14336
v_mfma_f32_16x16x32_bf16 v[40:43], v[168:171], a[216:219], v[40:43]
s_add_u32 s69, s69, s95
buffer_load_dwordx4 a[96:99], v1, s[44:47], s69 offen sc1
v_mfma_f32_16x16x32_bf16 v[40:43], v[152:155], a[212:215], v[40:43]
ds_read_b64_tr_b16 v[244:245], v9 offset:12288
v_mfma_f32_16x16x32_bf16 v[40:43], v[136:139], a[208:211], v[40:43]
ds_read_b64_tr_b16 v[246:247], v9 offset:14336
ds_read_b64_tr_b16 v[248:249], v10 offset:12288
v_mfma_f32_16x16x32_bf16 v[44:47], v[140:143], a[208:211], v[44:47]
s_add_u32 s72, s71, 46080
buffer_load_dwordx4 v15, s[24:27], s72 offen offset:3072 lds
v_mfma_f32_16x16x32_bf16 v[44:47], v[156:159], a[212:215], v[44:47]
ds_read_b64_tr_b16 v[250:251], v10 offset:14336
ds_read_b64_tr_b16 v[252:253], v11 offset:12288
v_mfma_f32_16x16x32_bf16 v[44:47], v[172:175], a[216:219], v[44:47]
ds_read_b64_tr_b16 v[254:255], v11 offset:14336
v_mfma_f32_16x16x32_bf16 v[44:47], v[188:191], a[220:223], v[44:47]
buffer_load_dwordx4 a[100:103], v1, s[44:47], s69 offen offset:1024 sc1
v_mfma_f32_16x16x32_bf16 v[28:31], v[188:191], a[204:207], v[28:31]
v_mfma_f32_16x16x32_bf16 v[28:31], v[172:175], a[200:203], v[28:31]
s_add_u32 s71, s15, 0x400000
v_mfma_f32_16x16x32_bf16 v[28:31], v[156:159], a[196:199], v[28:31]
s_waitcnt vmcnt(24) lgkmcnt(0)
v_mfma_f32_16x16x32_bf16 v[28:31], v[140:143], a[192:195], v[28:31]
s_barrier
v_mfma_f32_16x16x32_bf16 v[48:51], v[192:195], a[32:35], v[48:51]
s_and_b32 s71, s71, 0x7c0000
ds_read_b64_tr_b16 v[128:129], v8 offset:16384
ds_read_b64_tr_b16 v[130:131], v8 offset:18432
v_mfma_f32_16x16x32_bf16 v[48:51], v[208:211], a[36:39], v[48:51]
s_add_u32 s71, s71, s78
ds_read_b64_tr_b16 v[132:133], v9 offset:16384
ds_read_b64_tr_b16 v[134:135], v9 offset:18432
v_mfma_f32_16x16x32_bf16 v[48:51], v[224:227], a[40:43], v[48:51]
s_add_u32 m0, s77, 0
buffer_load_dwordx4 a[104:107], v1, s[44:47], s69 offen offset:2048 sc1
v_mfma_f32_16x16x32_bf16 v[48:51], v[240:243], a[44:47], v[48:51]
s_add_u32 s72, s71, 0
buffer_load_dwordx4 v15, s[24:27], s72 offen lds
v_mfma_f32_16x16x32_bf16 v[64:67], v[240:243], a[60:63], v[64:67]
ds_read_b64_tr_b16 v[136:137], v10 offset:16384
ds_read_b64_tr_b16 v[138:139], v10 offset:18432
v_mfma_f32_16x16x32_bf16 v[64:67], v[224:227], a[56:59], v[64:67]
ds_read_b64_tr_b16 v[140:141], v11 offset:16384
v_mfma_f32_16x16x32_bf16 v[64:67], v[208:211], a[52:55], v[64:67]
ds_read_b64_tr_b16 v[142:143], v11 offset:18432
ds_read_b64_tr_b16 v[144:145], v8 offset:20480
v_mfma_f32_16x16x32_bf16 v[64:67], v[192:195], a[48:51], v[64:67]
ds_read_b64_tr_b16 v[146:147], v8 offset:22528
ds_read_b64_tr_b16 v[148:149], v9 offset:20480
v_mfma_f32_16x16x32_bf16 v[68:71], v[196:199], a[48:51], v[68:71]
ds_read_b64_tr_b16 v[150:151], v9 offset:22528
v_mfma_f32_16x16x32_bf16 v[68:71], v[212:215], a[52:55], v[68:71]
buffer_load_dwordx4 a[108:111], v1, s[44:47], s69 offen offset:3072 sc1
v_mfma_f32_16x16x32_bf16 v[68:71], v[228:231], a[56:59], v[68:71]
s_add_u32 s72, s71, 15360
buffer_load_dwordx4 v15, s[24:27], s72 offen offset:1024 lds
v_mfma_f32_16x16x32_bf16 v[68:71], v[244:247], a[60:63], v[68:71]
ds_read_b64_tr_b16 v[152:153], v10 offset:20480
ds_read_b64_tr_b16 v[154:155], v10 offset:22528
v_mfma_f32_16x16x32_bf16 v[52:55], v[244:247], a[44:47], v[52:55]
ds_read_b64_tr_b16 v[156:157], v11 offset:20480
ds_read_b64_tr_b16 v[158:159], v11 offset:22528
v_mfma_f32_16x16x32_bf16 v[52:55], v[228:231], a[40:43], v[52:55]
ds_read_b64_tr_b16 v[160:161], v8 offset:24576
v_mfma_f32_16x16x32_bf16 v[52:55], v[212:215], a[36:39], v[52:55]
ds_read_b64_tr_b16 v[162:163], v8 offset:26624
ds_read_b64_tr_b16 v[164:165], v9 offset:24576
v_mfma_f32_16x16x32_bf16 v[52:55], v[196:199], a[32:35], v[52:55]
ds_read_b64_tr_b16 v[166:167], v9 offset:26624
ds_read_b64_tr_b16 v[168:169], v10 offset:24576
v_mfma_f32_16x16x32_bf16 v[56:59], v[200:203], a[32:35], v[56:59]
s_add_u32 s69, s69, 0x20000
buffer_load_dwordx4 a[112:115], v1, s[44:47], s69 offen sc1
v_mfma_f32_16x16x32_bf16 v[56:59], v[216:219], a[36:39], v[56:59]
s_add_u32 s72, s71, 30720
buffer_load_dwordx4 v15, s[24:27], s72 offen offset:2048 lds
v_mfma_f32_16x16x32_bf16 v[56:59], v[232:235], a[40:43], v[56:59]
ds_read_b64_tr_b16 v[170:171], v10 offset:26624
v_mfma_f32_16x16x32_bf16 v[56:59], v[248:251], a[44:47], v[56:59]
ds_read_b64_tr_b16 v[172:173], v11 offset:24576
ds_read_b64_tr_b16 v[174:175], v11 offset:26624
v_mfma_f32_16x16x32_bf16 v[72:75], v[248:251], a[60:63], v[72:75]
ds_read_b64_tr_b16 v[176:177], v8 offset:28672
ds_read_b64_tr_b16 v[178:179], v8 offset:30720
v_mfma_f32_16x16x32_bf16 v[72:75], v[232:235], a[56:59], v[72:75]
ds_read_b64_tr_b16 v[180:181], v9 offset:28672
v_mfma_f32_16x16x32_bf16 v[72:75], v[216:219], a[52:55], v[72:75]
ds_read_b64_tr_b16 v[182:183], v9 offset:30720
ds_read_b64_tr_b16 v[184:185], v10 offset:28672
v_mfma_f32_16x16x32_bf16 v[72:75], v[200:203], a[48:51], v[72:75]
buffer_load_dwordx4 a[116:119], v1, s[44:47], s69 offen offset:1024 sc1
v_mfma_f32_16x16x32_bf16 v[76:79], v[204:207], a[48:51], v[76:79]
s_add_u32 s72, s71, 46080
buffer_load_dwordx4 v15, s[24:27], s72 offen offset:3072 lds
v_mfma_f32_16x16x32_bf16 v[76:79], v[220:223], a[52:55], v[76:79]
ds_read_b64_tr_b16 v[186:187], v10 offset:30720
ds_read_b64_tr_b16 v[188:189], v11 offset:28672
v_mfma_f32_16x16x32_bf16 v[76:79], v[236:239], a[56:59], v[76:79]
ds_read_b64_tr_b16 v[190:191], v11 offset:30720
v_mfma_f32_16x16x32_bf16 v[76:79], v[252:255], a[60:63], v[76:79]
v_mfma_f32_16x16x32_bf16 v[60:63], v[252:255], a[44:47], v[60:63]
v_mfma_f32_16x16x32_bf16 v[60:63], v[236:239], a[40:43], v[60:63]
s_add_u32 s71, s12, 0x600000
v_mfma_f32_16x16x32_bf16 v[60:63], v[220:223], a[36:39], v[60:63]
s_waitcnt vmcnt(19) lgkmcnt(0)
buffer_load_dwordx4 a[120:123], v1, s[44:47], s69 offen offset:2048 sc1
v_mfma_f32_16x16x32_bf16 v[60:63], v[204:207], a[32:35], v[60:63]
s_barrier
v_mfma_f32_16x16x32_bf16 v[16:19], v[128:131], a[224:227], v[16:19]
s_and_b32 s71, s71, 0x7c0000
ds_read_b64_tr_b16 v[192:193], v8 offset:32768
ds_read_b64_tr_b16 v[194:195], v8 offset:34816
v_mfma_f32_16x16x32_bf16 v[16:19], v[144:147], a[228:231], v[16:19]
s_add_u32 s71, s71, s78
ds_read_b64_tr_b16 v[196:197], v9 offset:32768
ds_read_b64_tr_b16 v[198:199], v9 offset:34816
v_mfma_f32_16x16x32_bf16 v[16:19], v[160:163], a[232:235], v[16:19]
s_add_u32 m0, s77, 16384
ds_read_b64_tr_b16 v[200:201], v10 offset:32768
ds_read_b64_tr_b16 v[202:203], v10 offset:34816
v_mfma_f32_16x16x32_bf16 v[16:19], v[176:179], a[236:239], v[16:19]
s_add_u32 s72, s71, 0
buffer_load_dwordx4 v15, s[24:27], s72 offen lds
v_mfma_f32_16x16x32_bf16 v[32:35], v[176:179], a[252:255], v[32:35]
ds_read_b64_tr_b16 v[204:205], v11 offset:32768
ds_read_b64_tr_b16 v[88:89], v5 offset:0
v_mfma_f32_16x16x32_bf16 v[32:35], v[160:163], a[248:251], v[32:35]
buffer_load_dwordx4 a[124:127], v1, s[44:47], s69 offen offset:3072 sc1
v_mfma_f32_16x16x32_bf16 v[32:35], v[144:147], a[244:247], v[32:35]
ds_read_b64_tr_b16 v[206:207], v11 offset:34816
ds_read_b64_tr_b16 v[208:209], v8 offset:36864
v_mfma_f32_16x16x32_bf16 v[32:35], v[128:131], a[240:243], v[32:35]
ds_read_b64_tr_b16 v[210:211], v8 offset:38912
ds_read_b64_tr_b16 v[212:213], v9 offset:36864
v_mfma_f32_16x16x32_bf16 v[36:39], v[132:135], a[240:243], v[36:39]
ds_read_b64_tr_b16 v[214:215], v9 offset:38912
ds_read_b64_tr_b16 v[90:91], v5 offset:4096
v_mfma_f32_16x16x32_bf16 v[36:39], v[148:151], a[244:247], v[36:39]
ds_read_b64_tr_b16 v[216:217], v10 offset:36864
ds_read_b64_tr_b16 v[218:219], v10 offset:38912
v_mfma_f32_16x16x32_bf16 v[36:39], v[164:167], a[248:251], v[36:39]
s_add_u32 s72, s71, 15360
buffer_load_dwordx4 v15, s[24:27], s72 offen offset:1024 lds
v_mfma_f32_16x16x32_bf16 v[36:39], v[180:183], a[252:255], v[36:39]
ds_read_b64_tr_b16 v[220:221], v11 offset:36864
ds_read_b64_tr_b16 v[222:223], v11 offset:38912
v_mfma_f32_16x16x32_bf16 v[20:23], v[180:183], a[236:239], v[20:23]
s_waitcnt vmcnt(63)
v_cmp_gt_u32 vcc, 2, v3
s_cbranch_vccnz Lspin112
Lback113:
s_add_u32 s69, s12, 0x600000
s_and_b32 s69, s69, 0x7c0000
s_lshr_b32 s69, s69, 6
s_add_u32 s69, s69, s95
buffer_load_dwordx4 a[128:131], v1, s[44:47], s69 offen sc1
v_mfma_f32_16x16x32_bf16 v[20:23], v[164:167], a[232:235], v[20:23]
ds_read_b64_tr_b16 v[224:225], v8 offset:40960
ds_read_b64_tr_b16 v[92:93], v5 offset:8192
v_mfma_f32_16x16x32_bf16 v[20:23], v[148:151], a[228:231], v[20:23]
ds_read_b64_tr_b16 v[226:227], v8 offset:43008
ds_read_b64_tr_b16 v[228:229], v9 offset:40960
v_mfma_f32_16x16x32_bf16 v[20:23], v[132:135], a[224:227], v[20:23]
ds_read_b64_tr_b16 v[230:231], v9 offset:43008
ds_read_b64_tr_b16 v[232:233], v10 offset:40960
v_mfma_f32_16x16x32_bf16 v[24:27], v[136:139], a[224:227], v[24:27]
ds_read_b64_tr_b16 v[234:235], v10 offset:43008
ds_read_b64_tr_b16 v[94:95], v5 offset:12288
v_mfma_f32_16x16x32_bf16 v[24:27], v[152:155], a[228:231], v[24:27]
s_add_u32 s72, s71, 30720
buffer_load_dwordx4 v15, s[24:27], s72 offen offset:2048 lds
v_mfma_f32_16x16x32_bf16 v[24:27], v[168:171], a[232:235], v[24:27]
buffer_load_dwordx4 a[132:135], v1, s[44:47], s69 offen offset:1024 sc1
v_mfma_f32_16x16x32_bf16 v[24:27], v[184:187], a[236:239], v[24:27]
ds_read_b64_tr_b16 v[236:237], v11 offset:40960
ds_read_b64_tr_b16 v[238:239], v11 offset:43008
v_mfma_f32_16x16x32_bf16 v[40:43], v[184:187], a[252:255], v[40:43]
ds_read_b64_tr_b16 v[240:241], v8 offset:45056
ds_read_b64_tr_b16 v[242:243], v8 offset:47104
v_mfma_f32_16x16x32_bf16 v[40:43], v[168:171], a[248:251], v[40:43]
ds_read_b64_tr_b16 v[244:245], v9 offset:45056
ds_read_b64_tr_b16 v[104:105], v5 offset:16
v_mfma_f32_16x16x32_bf16 v[40:43], v[152:155], a[244:247], v[40:43]
ds_read_b64_tr_b16 v[246:247], v9 offset:47104
ds_read_b64_tr_b16 v[248:249], v10 offset:45056
v_mfma_f32_16x16x32_bf16 v[40:43], v[136:139], a[240:243], v[40:43]
ds_read_b64_tr_b16 v[250:251], v10 offset:47104
ds_read_b64_tr_b16 v[252:253], v11 offset:45056
v_mfma_f32_16x16x32_bf16 v[44:47], v[140:143], a[240:243], v[44:47]
s_add_u32 s72, s71, 46080
buffer_load_dwordx4 v15, s[24:27], s72 offen offset:3072 lds
v_mfma_f32_16x16x32_bf16 v[44:47], v[156:159], a[244:247], v[44:47]
buffer_load_dwordx4 a[136:139], v1, s[44:47], s69 offen offset:2048 sc1
v_mfma_f32_16x16x32_bf16 v[44:47], v[172:175], a[248:251], v[44:47]
ds_read_b64_tr_b16 v[254:255], v11 offset:47104
ds_read_b64_tr_b16 v[106:107], v5 offset:4112
v_mfma_f32_16x16x32_bf16 v[44:47], v[188:191], a[252:255], v[44:47]
ds_read_b64_tr_b16 v[108:109], v5 offset:8208
ds_read_b64_tr_b16 v[110:111], v5 offset:12304
v_mfma_f32_16x16x32_bf16 v[28:31], v[188:191], a[236:239], v[28:31]
v_mfma_f32_16x16x32_bf16 v[28:31], v[172:175], a[232:235], v[28:31]
s_add_u32 s71, s13, 0x400000
v_mfma_f32_16x16x32_bf16 v[28:31], v[156:159], a[228:231], v[28:31]
s_waitcnt vmcnt(18) lgkmcnt(0)
v_mfma_f32_16x16x32_bf16 v[28:31], v[140:143], a[224:227], v[28:31]
s_barrier
v_mfma_f32_16x16x32_bf16 v[48:51], v[192:195], a[64:67], v[48:51]
s_and_b32 s71, s71, 0x7c0000
buffer_load_dwordx4 a[140:143], v1, s[44:47], s69 offen offset:3072 sc1
v_mfma_f32_16x16x32_bf16 v[48:51], v[208:211], a[68:71], v[48:51]
s_add_u32 s71, s71, s94
ds_read_b64_tr_b16 v[128:129], v8 offset:49152
ds_read_b64_tr_b16 v[130:131], v8 offset:51200
v_mfma_f32_16x16x32_bf16 v[48:51], v[224:227], a[72:75], v[48:51]
s_add_u32 m0, s77, 32768
ds_read_b64_tr_b16 v[132:133], v9 offset:49152
ds_read_b64_tr_b16 v[134:135], v9 offset:51200
v_mfma_f32_16x16x32_bf16 v[48:51], v[240:243], a[76:79], v[48:51]
s_add_u32 s72, s71, 0
buffer_load_dwordx4 v15, s[24:27], s72 offen lds
v_mfma_f32_16x16x32_bf16 v[64:67], v[240:243], a[92:95], v[64:67]
s_waitcnt vmcnt(27) lgkmcnt(4)
ds_read_b64_tr_b16 v[136:137], v10 offset:49152
ds_read_b64_tr_b16 v[138:139], v10 offset:51200
v_mfma_f32_16x16x32_bf16 v[64:67], v[224:227], a[88:91], v[64:67]
ds_read_b64_tr_b16 v[140:141], v11 offset:49152
v_sub_f32 v112, 1.0, v6
v_mfma_f32_16x16x32_bf16 v[64:67], v[208:211], a[84:87], v[64:67]
ds_read_b64_tr_b16 v[142:143], v11 offset:51200
ds_read_b64_tr_b16 v[144:145], v8 offset:53248
v_mfma_f32_16x16x32_bf16 v[64:67], v[192:195], a[80:83], v[64:67]
s_add_u32 s69, s69, 0x20000
buffer_load_dwordx4 a[144:147], v1, s[44:47], s69 offen sc1
v_mfma_f32_16x16x32_bf16 v[68:71], v[196:199], a[80:83], v[68:71]
ds_read_b64_tr_b16 v[146:147], v8 offset:55296
ds_read_b64_tr_b16 v[148:149], v9 offset:53248
v_mfma_f32_16x16x32_bf16 v[68:71], v[212:215], a[84:87], v[68:71]
ds_read_b64_tr_b16 v[150:151], v9 offset:55296
v_sub_f32 v113, 1.0, v7
v_mfma_f32_16x16x32_bf16 v[68:71], v[228:231], a[88:91], v[68:71]
s_add_u32 s72, s71, 15360
buffer_load_dwordx4 v15, s[24:27], s72 offen offset:1024 lds
v_mfma_f32_16x16x32_bf16 v[68:71], v[244:247], a[92:95], v[68:71]
ds_read_b64_tr_b16 v[152:153], v10 offset:53248
ds_read_b64_tr_b16 v[154:155], v10 offset:55296
v_mfma_f32_16x16x32_bf16 v[52:55], v[244:247], a[76:79], v[52:55]
ds_read_b64_tr_b16 v[156:157], v11 offset:53248
ds_read_b64_tr_b16 v[158:159], v11 offset:55296
v_mfma_f32_16x16x32_bf16 v[52:55], v[228:231], a[72:75], v[52:55]
ds_read_b64_tr_b16 v[160:161], v8 offset:57344
v_and_b32 v114, 0xffff0000, v80
v_mfma_f32_16x16x32_bf16 v[52:55], v[212:215], a[68:71], v[52:55]
buffer_load_dwordx4 a[148:151], v1, s[44:47], s69 offen offset:1024 sc1
v_mfma_f32_16x16x32_bf16 v[52:55], v[196:199], a[64:67], v[52:55]
ds_read_b64_tr_b16 v[162:163], v8 offset:59392
ds_read_b64_tr_b16 v[164:165], v9 offset:57344
v_mfma_f32_16x16x32_bf16 v[56:59], v[200:203], a[64:67], v[56:59]
ds_read_b64_tr_b16 v[166:167], v9 offset:59392
ds_read_b64_tr_b16 v[168:169], v10 offset:57344
v_mfma_f32_16x16x32_bf16 v[56:59], v[216:219], a[68:71], v[56:59]
s_add_u32 s72, s71, 30720
buffer_load_dwordx4 v15, s[24:27], s72 offen offset:2048 lds
v_mfma_f32_16x16x32_bf16 v[56:59], v[232:235], a[72:75], v[56:59]
ds_read_b64_tr_b16 v[170:171], v10 offset:59392
v_lshlrev_b32 v115, 16, v88
v_mfma_f32_16x16x32_bf16 v[56:59], v[248:251], a[76:79], v[56:59]
ds_read_b64_tr_b16 v[172:173], v11 offset:57344
ds_read_b64_tr_b16 v[174:175], v11 offset:59392
v_mfma_f32_16x16x32_bf16 v[72:75], v[248:251], a[92:95], v[72:75]
ds_read_b64_tr_b16 v[176:177], v8 offset:61440
ds_read_b64_tr_b16 v[178:179], v8 offset:63488
v_mfma_f32_16x16x32_bf16 v[72:75], v[232:235], a[88:91], v[72:75]
buffer_load_dwordx4 a[152:155], v1, s[44:47], s69 offen offset:2048 sc1
v_mfma_f32_16x16x32_bf16 v[72:75], v[216:219], a[84:87], v[72:75]
ds_read_b64_tr_b16 v[180:181], v9 offset:61440
v_lshlrev_b32 v80, 16, v80
v_mfma_f32_16x16x32_bf16 v[72:75], v[200:203], a[80:83], v[72:75]
ds_read_b64_tr_b16 v[182:183], v9 offset:63488
ds_read_b64_tr_b16 v[184:185], v10 offset:61440
v_mfma_f32_16x16x32_bf16 v[76:79], v[204:207], a[80:83], v[76:79]
s_add_u32 s72, s71, 46080
buffer_load_dwordx4 v15, s[24:27], s72 offen offset:3072 lds
v_mfma_f32_16x16x32_bf16 v[76:79], v[220:223], a[84:87], v[76:79]
ds_read_b64_tr_b16 v[186:187], v10 offset:63488
ds_read_b64_tr_b16 v[188:189], v11 offset:61440
v_mfma_f32_16x16x32_bf16 v[76:79], v[236:239], a[88:91], v[76:79]
ds_read_b64_tr_b16 v[190:191], v11 offset:63488
v_and_b32 v88, 0xffff0000, v88
v_mfma_f32_16x16x32_bf16 v[76:79], v[252:255], a[92:95], v[76:79]
v_mul_f32 v80, v80, v112
v_mul_f32 v114, v114, v112
v_mfma_f32_16x16x32_bf16 v[60:63], v[252:255], a[76:79], v[60:63]
buffer_load_dwordx4 a[156:159], v1, s[44:47], s69 offen offset:3072 sc1
v_mfma_f32_16x16x32_bf16 v[60:63], v[236:239], a[72:75], v[60:63]
s_add_u32 s71, s13, 0x600000
v_mul_f32 v80, v80, v115
v_mul_f32 v88, v88, v114
v_mfma_f32_16x16x32_bf16 v[60:63], v[220:223], a[68:71], v[60:63]
s_waitcnt vmcnt(18) lgkmcnt(0)
v_and_b32 v114, 0xffff0000, v81
v_lshlrev_b32 v115, 16, v89
v_mfma_f32_16x16x32_bf16 v[60:63], v[204:207], a[64:67], v[60:63]
s_barrier
v_lshlrev_b32 v81, 16, v81
v_and_b32 v89, 0xffff0000, v89
v_mfma_f32_16x16x32_bf16 v[16:19], v[128:131], a[0:3], v[16:19]
s_and_b32 s71, s71, 0x7c0000
ds_read_b64_tr_b16 v[192:193], v8 offset:0
ds_read_b64_tr_b16 v[194:195], v8 offset:2048
v_mfma_f32_16x16x32_bf16 v[16:19], v[144:147], a[4:7], v[16:19]
s_add_u32 s71, s71, s78
ds_read_b64_tr_b16 v[196:197], v9 offset:0
ds_read_b64_tr_b16 v[198:199], v9 offset:2048
v_mfma_f32_16x16x32_bf16 v[16:19], v[160:163], a[8:11], v[16:19]
s_add_u32 m0, s77, 49152
ds_read_b64_tr_b16 v[200:201], v10 offset:0
ds_read_b64_tr_b16 v[202:203], v10 offset:2048
v_mfma_f32_16x16x32_bf16 v[16:19], v[176:179], a[12:15], v[16:19]
s_add_u32 s72, s71, 0
buffer_load_dwordx4 v15, s[24:27], s72 offen lds
v_mfma_f32_16x16x32_bf16 v[32:35], v[176:179], a[28:31], v[32:35]
s_add_u32 s69, s13, 0x600000
s_and_b32 s69, s69, 0x7c0000
s_lshr_b32 s69, s69, 6
s_add_u32 s69, s69, s95
buffer_load_dwordx4 a[160:163], v1, s[44:47], s69 offen sc1
v_mfma_f32_16x16x32_bf16 v[32:35], v[160:163], a[24:27], v[32:35]
ds_read_b64_tr_b16 v[204:205], v11 offset:0
v_mul_f32 v81, v81, v112
v_mfma_f32_16x16x32_bf16 v[32:35], v[144:147], a[20:23], v[32:35]
ds_read_b64_tr_b16 v[206:207], v11 offset:2048
ds_read_b64_tr_b16 v[208:209], v8 offset:4096
v_mfma_f32_16x16x32_bf16 v[32:35], v[128:131], a[16:19], v[32:35]
ds_read_b64_tr_b16 v[210:211], v8 offset:6144
ds_read_b64_tr_b16 v[212:213], v9 offset:4096
v_mfma_f32_16x16x32_bf16 v[36:39], v[132:135], a[16:19], v[36:39]
ds_read_b64_tr_b16 v[214:215], v9 offset:6144
v_mul_f32 v114, v114, v112
v_mfma_f32_16x16x32_bf16 v[36:39], v[148:151], a[20:23], v[36:39]
buffer_load_dwordx4 a[164:167], v1, s[44:47], s69 offen offset:1024 sc1
v_mfma_f32_16x16x32_bf16 v[36:39], v[164:167], a[24:27], v[36:39]
s_add_u32 s72, s71, 15360
buffer_load_dwordx4 v15, s[24:27], s72 offen offset:1024 lds
v_mfma_f32_16x16x32_bf16 v[36:39], v[180:183], a[28:31], v[36:39]
ds_read_b64_tr_b16 v[216:217], v10 offset:4096
ds_read_b64_tr_b16 v[218:219], v10 offset:6144
v_mfma_f32_16x16x32_bf16 v[20:23], v[180:183], a[12:15], v[20:23]
ds_read_b64_tr_b16 v[220:221], v11 offset:4096
ds_read_b64_tr_b16 v[222:223], v11 offset:6144
v_mfma_f32_16x16x32_bf16 v[20:23], v[164:167], a[8:11], v[20:23]
ds_read_b64_tr_b16 v[224:225], v8 offset:8192
v_mul_f32 v81, v81, v115
v_mfma_f32_16x16x32_bf16 v[20:23], v[148:151], a[4:7], v[20:23]
ds_read_b64_tr_b16 v[226:227], v8 offset:10240
ds_read_b64_tr_b16 v[228:229], v9 offset:8192
v_mfma_f32_16x16x32_bf16 v[20:23], v[132:135], a[0:3], v[20:23]
ds_read_b64_tr_b16 v[230:231], v9 offset:10240
ds_read_b64_tr_b16 v[232:233], v10 offset:8192
v_mfma_f32_16x16x32_bf16 v[24:27], v[136:139], a[0:3], v[24:27]
buffer_load_dwordx4 a[168:171], v1, s[44:47], s69 offen offset:2048 sc1
v_mfma_f32_16x16x32_bf16 v[24:27], v[152:155], a[4:7], v[24:27]
s_add_u32 s72, s71, 30720
buffer_load_dwordx4 v15, s[24:27], s72 offen offset:2048 lds
v_mfma_f32_16x16x32_bf16 v[24:27], v[168:171], a[8:11], v[24:27]
ds_read_b64_tr_b16 v[234:235], v10 offset:10240
v_mul_f32 v89, v89, v114
v_mfma_f32_16x16x32_bf16 v[24:27], v[184:187], a[12:15], v[24:27]
ds_read_b64_tr_b16 v[236:237], v11 offset:8192
ds_read_b64_tr_b16 v[238:239], v11 offset:10240
v_mfma_f32_16x16x32_bf16 v[40:43], v[184:187], a[28:31], v[40:43]
ds_read_b64_tr_b16 v[240:241], v8 offset:12288
ds_read_b64_tr_b16 v[242:243], v8 offset:14336
v_mfma_f32_16x16x32_bf16 v[40:43], v[168:171], a[24:27], v[40:43]
ds_read_b64_tr_b16 v[244:245], v9 offset:12288
v_and_b32 v114, 0xffff0000, v82
v_mfma_f32_16x16x32_bf16 v[40:43], v[152:155], a[20:23], v[40:43]
ds_read_b64_tr_b16 v[246:247], v9 offset:14336
ds_read_b64_tr_b16 v[248:249], v10 offset:12288
v_mfma_f32_16x16x32_bf16 v[40:43], v[136:139], a[16:19], v[40:43]
buffer_load_dwordx4 a[172:175], v1, s[44:47], s69 offen offset:3072 sc1
v_mfma_f32_16x16x32_bf16 v[44:47], v[140:143], a[16:19], v[44:47]
s_add_u32 s72, s71, 46080
buffer_load_dwordx4 v15, s[24:27], s72 offen offset:3072 lds
v_mfma_f32_16x16x32_bf16 v[44:47], v[156:159], a[20:23], v[44:47]
ds_read_b64_tr_b16 v[250:251], v10 offset:14336
ds_read_b64_tr_b16 v[252:253], v11 offset:12288
v_mfma_f32_16x16x32_bf16 v[44:47], v[172:175], a[24:27], v[44:47]
ds_read_b64_tr_b16 v[254:255], v11 offset:14336
v_lshlrev_b32 v115, 16, v90
v_mfma_f32_16x16x32_bf16 v[44:47], v[188:191], a[28:31], v[44:47]
v_lshlrev_b32 v82, 16, v82
v_and_b32 v90, 0xffff0000, v90
v_mfma_f32_16x16x32_bf16 v[28:31], v[188:191], a[12:15], v[28:31]
s_add_u32 s69, s69, 0x20000
v_mul_f32 v82, v82, v112
v_mul_f32 v114, v114, v112
v_mfma_f32_16x16x32_bf16 v[28:31], v[172:175], a[8:11], v[28:31]
s_add_u32 s71, s14, 0x400000
v_mul_f32 v82, v82, v115
v_mul_f32 v90, v90, v114
v_mfma_f32_16x16x32_bf16 v[28:31], v[156:159], a[4:7], v[28:31]
s_waitcnt vmcnt(18) lgkmcnt(0)
buffer_load_dwordx4 a[176:179], v1, s[44:47], s69 offen sc1
v_mfma_f32_16x16x32_bf16 v[28:31], v[140:143], a[0:3], v[28:31]
s_barrier
v_and_b32 v114, 0xffff0000, v83
v_lshlrev_b32 v115, 16, v91
v_mfma_f32_16x16x32_bf16 v[48:51], v[192:195], a[96:99], v[48:51]
s_and_b32 s71, s71, 0x7c0000
s_xor_b32 s79, s91, 0x1000
v_mov_b32 v13, 0
buffer_load_dword v14, v13, s[44:47], s79 offen sc1
v_mfma_f32_16x16x32_bf16 v[48:51], v[208:211], a[100:103], v[48:51]
s_add_u32 s71, s71, s94
ds_read_b64_tr_b16 v[128:129], v8 offset:16384
ds_read_b64_tr_b16 v[130:131], v8 offset:18432
v_mfma_f32_16x16x32_bf16 v[48:51], v[224:227], a[104:107], v[48:51]
s_add_u32 m0, s77, 0
ds_read_b64_tr_b16 v[132:133], v9 offset:16384
ds_read_b64_tr_b16 v[134:135], v9 offset:18432
v_mfma_f32_16x16x32_bf16 v[48:51], v[240:243], a[108:111], v[48:51]
s_add_u32 s72, s71, 0
buffer_load_dwordx4 v15, s[24:27], s72 offen lds
v_mfma_f32_16x16x32_bf16 v[64:67], v[240:243], a[124:127], v[64:67]
ds_read_b64_tr_b16 v[136:137], v10 offset:16384
ds_read_b64_tr_b16 v[138:139], v10 offset:18432
v_mfma_f32_16x16x32_bf16 v[64:67], v[224:227], a[120:123], v[64:67]
buffer_load_dwordx4 a[180:183], v1, s[44:47], s69 offen offset:1024 sc1
v_mfma_f32_16x16x32_bf16 v[64:67], v[208:211], a[116:119], v[64:67]
ds_read_b64_tr_b16 v[140:141], v11 offset:16384
ds_read_b64_tr_b16 v[142:143], v11 offset:18432
v_mfma_f32_16x16x32_bf16 v[64:67], v[192:195], a[112:115], v[64:67]
ds_read_b64_tr_b16 v[144:145], v8 offset:20480
v_lshlrev_b32 v83, 16, v83
v_mfma_f32_16x16x32_bf16 v[68:71], v[196:199], a[112:115], v[68:71]
ds_read_b64_tr_b16 v[146:147], v8 offset:22528
ds_read_b64_tr_b16 v[148:149], v9 offset:20480
v_mfma_f32_16x16x32_bf16 v[68:71], v[212:215], a[116:119], v[68:71]
ds_read_b64_tr_b16 v[150:151], v9 offset:22528
ds_read_b64_tr_b16 v[152:153], v10 offset:20480
v_mfma_f32_16x16x32_bf16 v[68:71], v[228:231], a[120:123], v[68:71]
s_add_u32 s72, s71, 15360
buffer_load_dwordx4 v15, s[24:27], s72 offen offset:1024 lds
v_mfma_f32_16x16x32_bf16 v[68:71], v[244:247], a[124:127], v[68:71]
ds_read_b64_tr_b16 v[154:155], v10 offset:22528
ds_read_b64_tr_b16 v[156:157], v11 offset:20480
v_mfma_f32_16x16x32_bf16 v[52:55], v[244:247], a[108:111], v[52:55]
buffer_load_dwordx4 a[184:187], v1, s[44:47], s69 offen offset:2048 sc1
v_mfma_f32_16x16x32_bf16 v[52:55], v[228:231], a[104:107], v[52:55]
ds_read_b64_tr_b16 v[158:159], v11 offset:22528
v_and_b32 v91, 0xffff0000, v91
v_mfma_f32_16x16x32_bf16 v[52:55], v[212:215], a[100:103], v[52:55]
ds_read_b64_tr_b16 v[160:161], v8 offset:24576
ds_read_b64_tr_b16 v[162:163], v8 offset:26624
v_mfma_f32_16x16x32_bf16 v[52:55], v[196:199], a[96:99], v[52:55]
ds_read_b64_tr_b16 v[164:165], v9 offset:24576
ds_read_b64_tr_b16 v[166:167], v9 offset:26624
v_mfma_f32_16x16x32_bf16 v[56:59], v[200:203], a[96:99], v[56:59]
ds_read_b64_tr_b16 v[168:169], v10 offset:24576
ds_read_b64_tr_b16 v[170:171], v10 offset:26624
v_mfma_f32_16x16x32_bf16 v[56:59], v[216:219], a[100:103], v[56:59]
s_add_u32 s72, s71, 30720
buffer_load_dwordx4 v15, s[24:27], s72 offen offset:2048 lds
v_mfma_f32_16x16x32_bf16 v[56:59], v[232:235], a[104:107], v[56:59]
ds_read_b64_tr_b16 v[172:173], v11 offset:24576
ds_read_b64_tr_b16 v[174:175], v11 offset:26624
v_mfma_f32_16x16x32_bf16 v[56:59], v[248:251], a[108:111], v[56:59]
buffer_load_dwordx4 a[188:191], v1, s[44:47], s69 offen offset:3072 sc1
v_mfma_f32_16x16x32_bf16 v[72:75], v[248:251], a[124:127], v[72:75]
ds_read_b64_tr_b16 v[176:177], v8 offset:28672
v_mul_f32 v83, v83, v112
v_mfma_f32_16x16x32_bf16 v[72:75], v[232:235], a[120:123], v[72:75]
ds_read_b64_tr_b16 v[178:179], v8 offset:30720
ds_read_b64_tr_b16 v[180:181], v9 offset:28672
v_mfma_f32_16x16x32_bf16 v[72:75], v[216:219], a[116:119], v[72:75]
s_add_u32 s69, s14, 0x600000
ds_read_b64_tr_b16 v[182:183], v9 offset:30720
ds_read_b64_tr_b16 v[184:185], v10 offset:28672
v_mfma_f32_16x16x32_bf16 v[72:75], v[200:203], a[112:115], v[72:75]
s_and_b32 s69, s69, 0x7c0000
ds_read_b64_tr_b16 v[186:187], v10 offset:30720
ds_read_b64_tr_b16 v[188:189], v11 offset:28672
v_mfma_f32_16x16x32_bf16 v[76:79], v[204:207], a[112:115], v[76:79]
s_add_u32 s72, s71, 46080
buffer_load_dwordx4 v15, s[24:27], s72 offen offset:3072 lds
v_mfma_f32_16x16x32_bf16 v[76:79], v[220:223], a[116:119], v[76:79]
s_lshr_b32 s69, s69, 6
ds_read_b64_tr_b16 v[190:191], v11 offset:30720
v_mul_f32 v114, v114, v112
v_mfma_f32_16x16x32_bf16 v[76:79], v[236:239], a[120:123], v[76:79]
s_add_u32 s69, s69, s95
buffer_load_dwordx4 a[192:195], v1, s[44:47], s69 offen sc1
v_mfma_f32_16x16x32_bf16 v[76:79], v[252:255], a[124:127], v[76:79]
v_mul_f32 v83, v83, v115
v_mul_f32 v91, v91, v114
v_mfma_f32_16x16x32_bf16 v[60:63], v[252:255], a[108:111], v[60:63]
v_and_b32 v114, 0xffff0000, v84
v_lshlrev_b32 v115, 16, v92
v_mfma_f32_16x16x32_bf16 v[60:63], v[236:239], a[104:107], v[60:63]
s_add_u32 s71, s14, 0x600000
v_lshlrev_b32 v84, 16, v84
v_and_b32 v92, 0xffff0000, v92
v_mfma_f32_16x16x32_bf16 v[60:63], v[220:223], a[100:103], v[60:63]
s_waitcnt vmcnt(18) lgkmcnt(0)
v_mul_f32 v84, v84, v112
v_mul_f32 v114, v114, v112
v_mfma_f32_16x16x32_bf16 v[60:63], v[204:207], a[96:99], v[60:63]
s_barrier
v_mul_f32 v84, v84, v115
v_mul_f32 v92, v92, v114
v_mfma_f32_16x16x32_bf16 v[48:51], v[128:131], a[128:131], v[48:51]
s_and_b32 s71, s71, 0x7c0000
buffer_load_dwordx4 a[196:199], v1, s[44:47], s69 offen offset:1024 sc1
v_mfma_f32_16x16x32_bf16 v[48:51], v[144:147], a[132:135], v[48:51]
s_add_u32 s71, s71, s78
ds_read_b64_tr_b16 v[192:193], v8 offset:32768
ds_read_b64_tr_b16 v[194:195], v8 offset:34816
v_mfma_f32_16x16x32_bf16 v[48:51], v[160:163], a[136:139], v[48:51]
s_add_u32 m0, s77, 16384
ds_read_b64_tr_b16 v[196:197], v9 offset:32768
ds_read_b64_tr_b16 v[198:199], v9 offset:34816
v_mfma_f32_16x16x32_bf16 v[48:51], v[176:179], a[140:143], v[48:51]
s_add_u32 s72, s71, 0
buffer_load_dwordx4 v15, s[24:27], s72 offen lds
v_mfma_f32_16x16x32_bf16 v[64:67], v[176:179], a[156:159], v[64:67]
ds_read_b64_tr_b16 v[200:201], v10 offset:32768
ds_read_b64_tr_b16 v[202:203], v10 offset:34816
v_mfma_f32_16x16x32_bf16 v[64:67], v[160:163], a[152:155], v[64:67]
ds_read_b64_tr_b16 v[204:205], v11 offset:32768
v_and_b32 v114, 0xffff0000, v85
v_mfma_f32_16x16x32_bf16 v[64:67], v[144:147], a[148:151], v[64:67]
ds_read_b64_tr_b16 v[206:207], v11 offset:34816
ds_read_b64_tr_b16 v[208:209], v8 offset:36864
v_mfma_f32_16x16x32_bf16 v[64:67], v[128:131], a[144:147], v[64:67]
buffer_load_dwordx4 a[200:203], v1, s[44:47], s69 offen offset:2048 sc1
v_mfma_f32_16x16x32_bf16 v[68:71], v[132:135], a[144:147], v[68:71]
ds_read_b64_tr_b16 v[210:211], v8 offset:38912
ds_read_b64_tr_b16 v[212:213], v9 offset:36864
v_mfma_f32_16x16x32_bf16 v[68:71], v[148:151], a[148:151], v[68:71]
ds_read_b64_tr_b16 v[214:215], v9 offset:38912
v_lshlrev_b32 v115, 16, v93
v_mfma_f32_16x16x32_bf16 v[68:71], v[164:167], a[152:155], v[68:71]
s_add_u32 s72, s71, 15360
buffer_load_dwordx4 v15, s[24:27], s72 offen offset:1024 lds
v_mfma_f32_16x16x32_bf16 v[68:71], v[180:183], a[156:159], v[68:71]
ds_read_b64_tr_b16 v[216:217], v10 offset:36864
ds_read_b64_tr_b16 v[218:219], v10 offset:38912
v_mfma_f32_16x16x32_bf16 v[52:55], v[180:183], a[140:143], v[52:55]
ds_read_b64_tr_b16 v[220:221], v11 offset:36864
ds_read_b64_tr_b16 v[222:223], v11 offset:38912
v_mfma_f32_16x16x32_bf16 v[52:55], v[164:167], a[136:139], v[52:55]
ds_read_b64_tr_b16 v[224:225], v8 offset:40960
v_lshlrev_b32 v85, 16, v85
v_mfma_f32_16x16x32_bf16 v[52:55], v[148:151], a[132:135], v[52:55]
buffer_load_dwordx4 a[204:207], v1, s[44:47], s69 offen offset:3072 sc1
v_mfma_f32_16x16x32_bf16 v[52:55], v[132:135], a[128:131], v[52:55]
ds_read_b64_tr_b16 v[226:227], v8 offset:43008
ds_read_b64_tr_b16 v[228:229], v9 offset:40960
v_mfma_f32_16x16x32_bf16 v[56:59], v[136:139], a[128:131], v[56:59]
ds_read_b64_tr_b16 v[230:231], v9 offset:43008
ds_read_b64_tr_b16 v[232:233], v10 offset:40960
v_mfma_f32_16x16x32_bf16 v[56:59], v[152:155], a[132:135], v[56:59]
s_add_u32 s72, s71, 30720
buffer_load_dwordx4 v15, s[24:27], s72 offen offset:2048 lds
v_mfma_f32_16x16x32_bf16 v[56:59], v[168:171], a[136:139], v[56:59]
ds_read_b64_tr_b16 v[234:235], v10 offset:43008
v_and_b32 v93, 0xffff0000, v93
v_mfma_f32_16x16x32_bf16 v[56:59], v[184:187], a[140:143], v[56:59]
ds_read_b64_tr_b16 v[236:237], v11 offset:40960
ds_read_b64_tr_b16 v[238:239], v11 offset:43008
v_mfma_f32_16x16x32_bf16 v[72:75], v[184:187], a[156:159], v[72:75]
ds_read_b64_tr_b16 v[240:241], v8 offset:45056
ds_read_b64_tr_b16 v[242:243], v8 offset:47104
v_mfma_f32_16x16x32_bf16 v[72:75], v[168:171], a[152:155], v[72:75]
s_add_u32 s69, s69, 0x20000
buffer_load_dwordx4 a[208:211], v1, s[44:47], s69 offen sc1
v_mfma_f32_16x16x32_bf16 v[72:75], v[152:155], a[148:151], v[72:75]
ds_read_b64_tr_b16 v[244:245], v9 offset:45056
v_mul_f32 v85, v85, v112
v_mfma_f32_16x16x32_bf16 v[72:75], v[136:139], a[144:147], v[72:75]
ds_read_b64_tr_b16 v[246:247], v9 offset:47104
ds_read_b64_tr_b16 v[248:249], v10 offset:45056
v_mfma_f32_16x16x32_bf16 v[76:79], v[140:143], a[144:147], v[76:79]
s_add_u32 s72, s71, 46080
buffer_load_dwordx4 v15, s[24:27], s72 offen offset:3072 lds
v_mfma_f32_16x16x32_bf16 v[76:79], v[156:159], a[148:151], v[76:79]
ds_read_b64_tr_b16 v[250:251], v10 offset:47104
ds_read_b64_tr_b16 v[252:253], v11 offset:45056
v_mfma_f32_16x16x32_bf16 v[76:79], v[172:175], a[152:155], v[76:79]
ds_read_b64_tr_b16 v[254:255], v11 offset:47104
v_mul_f32 v114, v114, v112
v_mfma_f32_16x16x32_bf16 v[76:79], v[188:191], a[156:159], v[76:79]
v_mul_f32 v85, v85, v115
v_mul_f32 v93, v93, v114
v_mfma_f32_16x16x32_bf16 v[60:63], v[188:191], a[140:143], v[60:63]
buffer_load_dwordx4 a[212:215], v1, s[44:47], s69 offen offset:1024 sc1
v_mfma_f32_16x16x32_bf16 v[60:63], v[172:175], a[136:139], v[60:63]
s_add_u32 s71, s15, 0x600000
v_and_b32 v114, 0xffff0000, v86
v_lshlrev_b32 v115, 16, v94
v_mfma_f32_16x16x32_bf16 v[60:63], v[156:159], a[132:135], v[60:63]
s_waitcnt vmcnt(19) lgkmcnt(0)
v_lshlrev_b32 v86, 16, v86
v_and_b32 v94, 0xffff0000, v94
v_mfma_f32_16x16x32_bf16 v[60:63], v[140:143], a[128:131], v[60:63]
s_barrier
v_mul_f32 v86, v86, v112
v_mul_f32 v114, v114, v112
v_mfma_f32_16x16x32_bf16 v[16:19], v[192:195], a[32:35], v[16:19]
s_and_b32 s71, s71, 0x7c0000
ds_read_b64_tr_b16 v[128:129], v8 offset:49152
ds_read_b64_tr_b16 v[130:131], v8 offset:51200
v_mfma_f32_16x16x32_bf16 v[16:19], v[208:211], a[36:39], v[16:19]
s_add_u32 s71, s71, s78
ds_read_b64_tr_b16 v[132:133], v9 offset:49152
ds_read_b64_tr_b16 v[134:135], v9 offset:51200
v_mfma_f32_16x16x32_bf16 v[16:19], v[224:227], a[40:43], v[16:19]
s_add_u32 m0, s77, 32768
ds_read_b64_tr_b16 v[136:137], v10 offset:49152
ds_read_b64_tr_b16 v[138:139], v10 offset:51200
v_mfma_f32_16x16x32_bf16 v[16:19], v[240:243], a[44:47], v[16:19]
s_add_u32 s72, s71, 0
buffer_load_dwordx4 v15, s[24:27], s72 offen lds
v_mfma_f32_16x16x32_bf16 v[32:35], v[240:243], a[60:63], v[32:35]
buffer_load_dwordx4 a[216:219], v1, s[44:47], s69 offen offset:2048 sc1
v_mfma_f32_16x16x32_bf16 v[32:35], v[224:227], a[56:59], v[32:35]
ds_read_b64_tr_b16 v[140:141], v11 offset:49152
v_mul_f32 v86, v86, v115
v_mfma_f32_16x16x32_bf16 v[32:35], v[208:211], a[52:55], v[32:35]
ds_read_b64_tr_b16 v[142:143], v11 offset:51200
ds_read_b64_tr_b16 v[144:145], v8 offset:53248
v_mfma_f32_16x16x32_bf16 v[32:35], v[192:195], a[48:51], v[32:35]
ds_read_b64_tr_b16 v[146:147], v8 offset:55296
ds_read_b64_tr_b16 v[148:149], v9 offset:53248
v_mfma_f32_16x16x32_bf16 v[36:39], v[196:199], a[48:51], v[36:39]
ds_read_b64_tr_b16 v[150:151], v9 offset:55296
v_mul_f32 v94, v94, v114
v_mfma_f32_16x16x32_bf16 v[36:39], v[212:215], a[52:55], v[36:39]
ds_read_b64_tr_b16 v[152:153], v10 offset:53248
ds_read_b64_tr_b16 v[154:155], v10 offset:55296
v_mfma_f32_16x16x32_bf16 v[36:39], v[228:231], a[56:59], v[36:39]
s_add_u32 s72, s71, 15360
buffer_load_dwordx4 v15, s[24:27], s72 offen offset:1024 lds
v_mfma_f32_16x16x32_bf16 v[36:39], v[244:247], a[60:63], v[36:39]
buffer_load_dwordx4 a[220:223], v1, s[44:47], s69 offen offset:3072 sc1
v_mfma_f32_16x16x32_bf16 v[20:23], v[244:247], a[44:47], v[20:23]
ds_read_b64_tr_b16 v[156:157], v11 offset:53248
ds_read_b64_tr_b16 v[158:159], v11 offset:55296
v_mfma_f32_16x16x32_bf16 v[20:23], v[228:231], a[40:43], v[20:23]
ds_read_b64_tr_b16 v[160:161], v8 offset:57344
v_and_b32 v114, 0xffff0000, v87
v_mfma_f32_16x16x32_bf16 v[20:23], v[212:215], a[36:39], v[20:23]
s_add_u32 s69, s15, 0x600000
ds_read_b64_tr_b16 v[162:163], v8 offset:59392
ds_read_b64_tr_b16 v[164:165], v9 offset:57344
v_mfma_f32_16x16x32_bf16 v[20:23], v[196:199], a[32:35], v[20:23]
s_and_b32 s69, s69, 0x7c0000
ds_read_b64_tr_b16 v[166:167], v9 offset:59392
ds_read_b64_tr_b16 v[168:169], v10 offset:57344
v_mfma_f32_16x16x32_bf16 v[24:27], v[200:203], a[32:35], v[24:27]
s_lshr_b32 s69, s69, 6
ds_read_b64_tr_b16 v[170:171], v10 offset:59392
v_lshlrev_b32 v115, 16, v95
v_mfma_f32_16x16x32_bf16 v[24:27], v[216:219], a[36:39], v[24:27]
s_add_u32 s72, s71, 30720
buffer_load_dwordx4 v15, s[24:27], s72 offen offset:2048 lds
v_mfma_f32_16x16x32_bf16 v[24:27], v[232:235], a[40:43], v[24:27]
s_add_u32 s69, s69, s95
buffer_load_dwordx4 a[224:227], v1, s[44:47], s69 offen sc1
v_mfma_f32_16x16x32_bf16 v[24:27], v[248:251], a[44:47], v[24:27]
ds_read_b64_tr_b16 v[172:173], v11 offset:57344
ds_read_b64_tr_b16 v[174:175], v11 offset:59392
v_mfma_f32_16x16x32_bf16 v[40:43], v[248:251], a[60:63], v[40:43]
ds_read_b64_tr_b16 v[176:177], v8 offset:61440
ds_read_b64_tr_b16 v[178:179], v8 offset:63488
v_mfma_f32_16x16x32_bf16 v[40:43], v[232:235], a[56:59], v[40:43]
ds_read_b64_tr_b16 v[180:181], v9 offset:61440
v_lshlrev_b32 v87, 16, v87
v_mfma_f32_16x16x32_bf16 v[40:43], v[216:219], a[52:55], v[40:43]
ds_read_b64_tr_b16 v[182:183], v9 offset:63488
ds_read_b64_tr_b16 v[184:185], v10 offset:61440
v_mfma_f32_16x16x32_bf16 v[40:43], v[200:203], a[48:51], v[40:43]
buffer_load_dwordx4 a[228:231], v1, s[44:47], s69 offen offset:1024 sc1
v_mfma_f32_16x16x32_bf16 v[44:47], v[204:207], a[48:51], v[44:47]
s_add_u32 s72, s71, 46080
buffer_load_dwordx4 v15, s[24:27], s72 offen offset:3072 lds
v_mfma_f32_16x16x32_bf16 v[44:47], v[220:223], a[52:55], v[44:47]
ds_read_b64_tr_b16 v[186:187], v10 offset:63488
ds_read_b64_tr_b16 v[188:189], v11 offset:61440
v_mfma_f32_16x16x32_bf16 v[44:47], v[236:239], a[56:59], v[44:47]
ds_read_b64_tr_b16 v[190:191], v11 offset:63488
v_and_b32 v95, 0xffff0000, v95
v_mfma_f32_16x16x32_bf16 v[44:47], v[252:255], a[60:63], v[44:47]
v_mul_f32 v87, v87, v112
v_mul_f32 v114, v114, v112
v_mfma_f32_16x16x32_bf16 v[28:31], v[252:255], a[44:47], v[28:31]
v_mul_f32 v87, v87, v115
v_mul_f32 v95, v95, v114
v_mfma_f32_16x16x32_bf16 v[28:31], v[236:239], a[40:43], v[28:31]
s_add_u32 s71, s15, 0x400000
v_and_b32 v114, 0xffff0000, v96
v_lshlrev_b32 v115, 16, v104
v_mfma_f32_16x16x32_bf16 v[28:31], v[220:223], a[36:39], v[28:31]
s_waitcnt vmcnt(18) lgkmcnt(0)
buffer_load_dwordx4 a[232:235], v1, s[44:47], s69 offen offset:2048 sc1
v_mfma_f32_16x16x32_bf16 v[28:31], v[204:207], a[32:35], v[28:31]
s_barrier
v_lshlrev_b32 v96, 16, v96
v_and_b32 v104, 0xffff0000, v104
v_mfma_f32_16x16x32_bf16 v[48:51], v[128:131], a[160:163], v[48:51]
s_and_b32 s71, s71, 0x7c0000
s_waitcnt vmcnt(26)
v_cmp_gt_u32 vcc, 2, v14
s_cbranch_vccnz Lspin118
Lback119:
v_mfma_f32_16x16x32_bf16 v[48:51], v[144:147], a[164:167], v[48:51]
s_add_u32 s71, s71, s94
ds_read_b64_tr_b16 v[192:193], v8 offset:0
ds_read_b64_tr_b16 v[194:195], v8 offset:2048
v_mfma_f32_16x16x32_bf16 v[48:51], v[160:163], a[168:171], v[48:51]
s_add_u32 m0, s77, 49152
ds_read_b64_tr_b16 v[196:197], v9 offset:0
ds_read_b64_tr_b16 v[198:199], v9 offset:2048
v_mfma_f32_16x16x32_bf16 v[48:51], v[176:179], a[172:175], v[48:51]
s_add_u32 s72, s71, 0
buffer_load_dwordx4 v15, s[24:27], s72 offen lds
v_mfma_f32_16x16x32_bf16 v[64:67], v[176:179], a[188:191], v[64:67]
s_xor_b32 s80, s93, 0x80000
ds_read_b64_tr_b16 v[200:201], v10 offset:0
ds_read_b64_tr_b16 v[202:203], v10 offset:2048
v_mfma_f32_16x16x32_bf16 v[64:67], v[160:163], a[184:187], v[64:67]
s_add_u32 s80, s80, 0x3a00000
buffer_load_dwordx4 a[236:239], v1, s[44:47], s69 offen offset:3072 sc1
v_mfma_f32_16x16x32_bf16 v[64:67], v[144:147], a[180:183], v[64:67]
s_add_u32 s79, s93, 0x3a00000
ds_read_b64_tr_b16 v[204:205], v11 offset:0
ds_read_b64_tr_b16 v[206:207], v11 offset:2048
v_mfma_f32_16x16x32_bf16 v[64:67], v[128:131], a[176:179], v[64:67]
ds_read_b64_tr_b16 v[208:209], v8 offset:4096
v_mul_f32 v96, v96, v113
v_mfma_f32_16x16x32_bf16 v[68:71], v[132:135], a[176:179], v[68:71]
ds_read_b64_tr_b16 v[210:211], v8 offset:6144
ds_read_b64_tr_b16 v[212:213], v9 offset:4096
v_mfma_f32_16x16x32_bf16 v[68:71], v[148:151], a[180:183], v[68:71]
ds_read_b64_tr_b16 v[214:215], v9 offset:6144
ds_read_b64_tr_b16 v[216:217], v10 offset:4096
v_mfma_f32_16x16x32_bf16 v[68:71], v[164:167], a[184:187], v[68:71]
s_add_u32 s72, s71, 15360
buffer_load_dwordx4 v15, s[24:27], s72 offen offset:1024 lds
v_mfma_f32_16x16x32_bf16 v[68:71], v[180:183], a[188:191], v[68:71]
ds_read_b64_tr_b16 v[218:219], v10 offset:6144
ds_read_b64_tr_b16 v[220:221], v11 offset:4096
v_mfma_f32_16x16x32_bf16 v[52:55], v[180:183], a[172:175], v[52:55]
s_add_u32 s69, s69, 0x20000
buffer_load_dwordx4 a[240:243], v1, s[44:47], s69 offen sc1
v_mfma_f32_16x16x32_bf16 v[52:55], v[164:167], a[168:171], v[52:55]
ds_read_b64_tr_b16 v[222:223], v11 offset:6144
v_mul_f32 v114, v114, v113
v_mfma_f32_16x16x32_bf16 v[52:55], v[148:151], a[164:167], v[52:55]
ds_read_b64_tr_b16 v[224:225], v8 offset:8192
ds_read_b64_tr_b16 v[226:227], v8 offset:10240
v_mfma_f32_16x16x32_bf16 v[52:55], v[132:135], a[160:163], v[52:55]
ds_read_b64_tr_b16 v[228:229], v9 offset:8192
ds_read_b64_tr_b16 v[230:231], v9 offset:10240
v_mfma_f32_16x16x32_bf16 v[56:59], v[136:139], a[160:163], v[56:59]
ds_read_b64_tr_b16 v[232:233], v10 offset:8192
ds_read_b64_tr_b16 v[234:235], v10 offset:10240
v_mfma_f32_16x16x32_bf16 v[56:59], v[152:155], a[164:167], v[56:59]
s_add_u32 s72, s71, 30720
buffer_load_dwordx4 v15, s[24:27], s72 offen offset:2048 lds
v_mfma_f32_16x16x32_bf16 v[56:59], v[168:171], a[168:171], v[56:59]
ds_read_b64_tr_b16 v[236:237], v11 offset:8192
ds_read_b64_tr_b16 v[238:239], v11 offset:10240
v_mfma_f32_16x16x32_bf16 v[56:59], v[184:187], a[172:175], v[56:59]
buffer_load_dwordx4 a[244:247], v1, s[44:47], s69 offen offset:1024 sc1
v_mfma_f32_16x16x32_bf16 v[72:75], v[184:187], a[188:191], v[72:75]
ds_read_b64_tr_b16 v[240:241], v8 offset:12288
v_mul_f32 v96, v96, v115
v_mfma_f32_16x16x32_bf16 v[72:75], v[168:171], a[184:187], v[72:75]
ds_read_b64_tr_b16 v[242:243], v8 offset:14336
ds_read_b64_tr_b16 v[244:245], v9 offset:12288
v_mfma_f32_16x16x32_bf16 v[72:75], v[152:155], a[180:183], v[72:75]
ds_read_b64_tr_b16 v[246:247], v9 offset:14336
ds_read_b64_tr_b16 v[248:249], v10 offset:12288
v_mfma_f32_16x16x32_bf16 v[72:75], v[136:139], a[176:179], v[72:75]
ds_read_b64_tr_b16 v[250:251], v10 offset:14336
ds_read_b64_tr_b16 v[252:253], v11 offset:12288
v_mfma_f32_16x16x32_bf16 v[76:79], v[140:143], a[176:179], v[76:79]
s_add_u32 s72, s71, 46080
buffer_load_dwordx4 v15, s[24:27], s72 offen offset:3072 lds
v_mfma_f32_16x16x32_bf16 v[76:79], v[156:159], a[180:183], v[76:79]
ds_read_b64_tr_b16 v[254:255], v11 offset:14336
v_mul_f32 v104, v104, v114
v_mfma_f32_16x16x32_bf16 v[76:79], v[172:175], a[184:187], v[76:79]
buffer_load_dwordx4 a[248:251], v1, s[44:47], s69 offen offset:2048 sc1
v_mfma_f32_16x16x32_bf16 v[76:79], v[188:191], a[188:191], v[76:79]
v_and_b32 v114, 0xffff0000, v97
v_lshlrev_b32 v115, 16, v105
v_mfma_f32_16x16x32_bf16 v[60:63], v[188:191], a[172:175], v[60:63]
v_lshlrev_b32 v97, 16, v97
v_and_b32 v105, 0xffff0000, v105
v_mfma_f32_16x16x32_bf16 v[60:63], v[172:175], a[168:171], v[60:63]
s_add_u32 s71, s12, 0x600000
v_mul_f32 v97, v97, v113
v_mul_f32 v114, v114, v113
v_mfma_f32_16x16x32_bf16 v[60:63], v[156:159], a[164:167], v[60:63]
s_waitcnt vmcnt(18) lgkmcnt(0)
v_mul_f32 v97, v97, v115
v_mul_f32 v105, v105, v114
v_mfma_f32_16x16x32_bf16 v[60:63], v[140:143], a[160:163], v[60:63]
s_barrier
v_and_b32 v114, 0xffff0000, v98
v_lshlrev_b32 v115, 16, v106
v_mfma_f32_16x16x32_bf16 v[16:19], v[192:195], a[64:67], v[16:19]
s_and_b32 s71, s71, 0x7c0000
ds_read_b64_tr_b16 v[128:129], v8 offset:16384
ds_read_b64_tr_b16 v[130:131], v8 offset:18432
v_mfma_f32_16x16x32_bf16 v[16:19], v[208:211], a[68:71], v[16:19]
s_add_u32 s71, s71, s94
buffer_load_dwordx4 a[252:255], v1, s[44:47], s69 offen offset:3072 sc1
v_mfma_f32_16x16x32_bf16 v[16:19], v[224:227], a[72:75], v[16:19]
s_add_u32 m0, s77, 0
ds_read_b64_tr_b16 v[132:133], v9 offset:16384
v_lshlrev_b32 v98, 16, v98
v_mfma_f32_16x16x32_bf16 v[16:19], v[240:243], a[76:79], v[16:19]
s_add_u32 s72, s71, 0
buffer_load_dwordx4 v15, s[24:27], s72 offen lds
v_mfma_f32_16x16x32_bf16 v[32:35], v[240:243], a[92:95], v[32:35]
ds_read_b64_tr_b16 v[134:135], v9 offset:18432
ds_read_b64_tr_b16 v[136:137], v10 offset:16384
v_mfma_f32_16x16x32_bf16 v[32:35], v[224:227], a[88:91], v[32:35]
ds_read_b64_tr_b16 v[138:139], v10 offset:18432
v_and_b32 v106, 0xffff0000, v106
v_mfma_f32_16x16x32_bf16 v[32:35], v[208:211], a[84:87], v[32:35]
ds_read_b64_tr_b16 v[140:141], v11 offset:16384
ds_read_b64_tr_b16 v[142:143], v11 offset:18432
v_mfma_f32_16x16x32_bf16 v[32:35], v[192:195], a[80:83], v[32:35]
ds_read_b64_tr_b16 v[144:145], v8 offset:20480
v_mul_f32 v98, v98, v113
v_mfma_f32_16x16x32_bf16 v[36:39], v[196:199], a[80:83], v[36:39]
ds_read_b64_tr_b16 v[146:147], v8 offset:22528
ds_read_b64_tr_b16 v[148:149], v9 offset:20480
v_mfma_f32_16x16x32_bf16 v[36:39], v[212:215], a[84:87], v[36:39]
ds_read_b64_tr_b16 v[150:151], v9 offset:22528
v_mul_f32 v114, v114, v113
v_mfma_f32_16x16x32_bf16 v[36:39], v[228:231], a[88:91], v[36:39]
s_add_u32 s72, s71, 15360
buffer_load_dwordx4 v15, s[24:27], s72 offen offset:1024 lds
v_mfma_f32_16x16x32_bf16 v[36:39], v[244:247], a[92:95], v[36:39]
ds_read_b64_tr_b16 v[152:153], v10 offset:20480
ds_read_b64_tr_b16 v[154:155], v10 offset:22528
v_mfma_f32_16x16x32_bf16 v[20:23], v[244:247], a[76:79], v[20:23]
ds_read_b64_tr_b16 v[156:157], v11 offset:20480
v_mul_f32 v98, v98, v115
v_mfma_f32_16x16x32_bf16 v[20:23], v[228:231], a[72:75], v[20:23]
ds_read_b64_tr_b16 v[158:159], v11 offset:22528
v_mul_f32 v106, v106, v114
v_mfma_f32_16x16x32_bf16 v[20:23], v[212:215], a[68:71], v[20:23]
ds_read_b64_tr_b16 v[160:161], v8 offset:24576
ds_read_b64_tr_b16 v[162:163], v8 offset:26624
v_mfma_f32_16x16x32_bf16 v[20:23], v[196:199], a[64:67], v[20:23]
ds_read_b64_tr_b16 v[164:165], v9 offset:24576
v_and_b32 v114, 0xffff0000, v99
v_mfma_f32_16x16x32_bf16 v[24:27], v[200:203], a[64:67], v[24:27]
ds_read_b64_tr_b16 v[166:167], v9 offset:26624
ds_read_b64_tr_b16 v[168:169], v10 offset:24576
v_mfma_f32_16x16x32_bf16 v[24:27], v[216:219], a[68:71], v[24:27]
s_add_u32 s72, s71, 30720
buffer_load_dwordx4 v15, s[24:27], s72 offen offset:2048 lds
v_mfma_f32_16x16x32_bf16 v[24:27], v[232:235], a[72:75], v[24:27]
ds_read_b64_tr_b16 v[170:171], v10 offset:26624
v_lshlrev_b32 v115, 16, v107
v_mfma_f32_16x16x32_bf16 v[24:27], v[248:251], a[76:79], v[24:27]
ds_read_b64_tr_b16 v[172:173], v11 offset:24576
ds_read_b64_tr_b16 v[174:175], v11 offset:26624
v_mfma_f32_16x16x32_bf16 v[40:43], v[248:251], a[92:95], v[40:43]
ds_read_b64_tr_b16 v[176:177], v8 offset:28672
v_lshlrev_b32 v99, 16, v99
v_mfma_f32_16x16x32_bf16 v[40:43], v[232:235], a[88:91], v[40:43]
ds_read_b64_tr_b16 v[178:179], v8 offset:30720
ds_read_b64_tr_b16 v[180:181], v9 offset:28672
v_mfma_f32_16x16x32_bf16 v[40:43], v[216:219], a[84:87], v[40:43]
ds_read_b64_tr_b16 v[182:183], v9 offset:30720
v_and_b32 v107, 0xffff0000, v107
v_mfma_f32_16x16x32_bf16 v[40:43], v[200:203], a[80:83], v[40:43]
ds_read_b64_tr_b16 v[184:185], v10 offset:28672
ds_read_b64_tr_b16 v[186:187], v10 offset:30720
v_mfma_f32_16x16x32_bf16 v[44:47], v[204:207], a[80:83], v[44:47]
s_add_u32 s72, s71, 46080
buffer_load_dwordx4 v15, s[24:27], s72 offen offset:3072 lds
v_mfma_f32_16x16x32_bf16 v[44:47], v[220:223], a[84:87], v[44:47]
ds_read_b64_tr_b16 v[188:189], v11 offset:28672
v_mul_f32 v99, v99, v113
v_mfma_f32_16x16x32_bf16 v[44:47], v[236:239], a[88:91], v[44:47]
ds_read_b64_tr_b16 v[190:191], v11 offset:30720
v_mul_f32 v114, v114, v113
v_mfma_f32_16x16x32_bf16 v[44:47], v[252:255], a[92:95], v[44:47]
v_mul_f32 v99, v99, v115
v_mul_f32 v107, v107, v114
v_mfma_f32_16x16x32_bf16 v[28:31], v[252:255], a[76:79], v[28:31]
v_and_b32 v114, 0xffff0000, v100
v_lshlrev_b32 v115, 16, v108
v_mfma_f32_16x16x32_bf16 v[28:31], v[236:239], a[72:75], v[28:31]
s_add_u32 s71, s13, 0x600000
v_lshlrev_b32 v100, 16, v100
v_and_b32 v108, 0xffff0000, v108
v_mfma_f32_16x16x32_bf16 v[28:31], v[220:223], a[68:71], v[28:31]
s_waitcnt vmcnt(14) lgkmcnt(0)
v_mul_f32 v100, v100, v113
v_mul_f32 v114, v114, v113
v_mfma_f32_16x16x32_bf16 v[28:31], v[204:207], a[64:67], v[28:31]
s_barrier
v_mul_f32 v100, v100, v115
v_mul_f32 v108, v108, v114
v_mfma_f32_16x16x32_bf16 v[48:51], v[128:131], a[192:195], v[48:51]
s_and_b32 s71, s71, 0x7c0000
ds_read_b64_tr_b16 v[192:193], v8 offset:32768
ds_read_b64_tr_b16 v[194:195], v8 offset:34816
v_mfma_f32_16x16x32_bf16 v[48:51], v[144:147], a[196:199], v[48:51]
s_add_u32 s71, s71, s94
ds_read_b64_tr_b16 v[196:197], v9 offset:32768
v_and_b32 v114, 0xffff0000, v101
v_mfma_f32_16x16x32_bf16 v[48:51], v[160:163], a[200:203], v[48:51]
s_add_u32 m0, s77, 16384
ds_read_b64_tr_b16 v[198:199], v9 offset:34816
ds_read_b64_tr_b16 v[200:201], v10 offset:32768
v_mfma_f32_16x16x32_bf16 v[48:51], v[176:179], a[204:207], v[48:51]
s_add_u32 s72, s71, 0
buffer_load_dwordx4 v15, s[24:27], s72 offen lds
v_mfma_f32_16x16x32_bf16 v[64:67], v[176:179], a[220:223], v[64:67]
ds_read_b64_tr_b16 v[202:203], v10 offset:34816
v_lshlrev_b32 v115, 16, v109
v_mfma_f32_16x16x32_bf16 v[64:67], v[160:163], a[216:219], v[64:67]
ds_read_b64_tr_b16 v[204:205], v11 offset:32768
v_lshlrev_b32 v101, 16, v101
v_mfma_f32_16x16x32_bf16 v[64:67], v[144:147], a[212:215], v[64:67]
ds_read_b64_tr_b16 v[206:207], v11 offset:34816
ds_read_b64_tr_b16 v[208:209], v8 offset:36864
v_mfma_f32_16x16x32_bf16 v[64:67], v[128:131], a[208:211], v[64:67]
ds_read_b64_tr_b16 v[210:211], v8 offset:38912
v_and_b32 v109, 0xffff0000, v109
v_mfma_f32_16x16x32_bf16 v[68:71], v[132:135], a[208:211], v[68:71]
ds_read_b64_tr_b16 v[212:213], v9 offset:36864
ds_read_b64_tr_b16 v[214:215], v9 offset:38912
v_mfma_f32_16x16x32_bf16 v[68:71], v[148:151], a[212:215], v[68:71]
ds_read_b64_tr_b16 v[216:217], v10 offset:36864
v_mul_f32 v101, v101, v113
v_mfma_f32_16x16x32_bf16 v[68:71], v[164:167], a[216:219], v[68:71]
s_add_u32 s72, s71, 15360
buffer_load_dwordx4 v15, s[24:27], s72 offen offset:1024 lds
v_mfma_f32_16x16x32_bf16 v[68:71], v[180:183], a[220:223], v[68:71]
ds_read_b64_tr_b16 v[218:219], v10 offset:38912
v_mul_f32 v114, v114, v113
v_mfma_f32_16x16x32_bf16 v[52:55], v[180:183], a[204:207], v[52:55]
ds_read_b64_tr_b16 v[220:221], v11 offset:36864
ds_read_b64_tr_b16 v[222:223], v11 offset:38912
v_mfma_f32_16x16x32_bf16 v[52:55], v[164:167], a[200:203], v[52:55]
ds_read_b64_tr_b16 v[224:225], v8 offset:40960
v_mul_f32 v101, v101, v115
v_mfma_f32_16x16x32_bf16 v[52:55], v[148:151], a[196:199], v[52:55]
ds_read_b64_tr_b16 v[226:227], v8 offset:43008
ds_read_b64_tr_b16 v[228:229], v9 offset:40960
v_mfma_f32_16x16x32_bf16 v[52:55], v[132:135], a[192:195], v[52:55]
ds_read_b64_tr_b16 v[230:231], v9 offset:43008
v_mul_f32 v109, v109, v114
v_mfma_f32_16x16x32_bf16 v[56:59], v[136:139], a[192:195], v[56:59]
ds_read_b64_tr_b16 v[232:233], v10 offset:40960
v_and_b32 v114, 0xffff0000, v102
v_mfma_f32_16x16x32_bf16 v[56:59], v[152:155], a[196:199], v[56:59]
s_add_u32 s72, s71, 30720
buffer_load_dwordx4 v15, s[24:27], s72 offen offset:2048 lds
v_mfma_f32_16x16x32_bf16 v[56:59], v[168:171], a[200:203], v[56:59]
ds_read_b64_tr_b16 v[234:235], v10 offset:43008
ds_read_b64_tr_b16 v[236:237], v11 offset:40960
v_mfma_f32_16x16x32_bf16 v[56:59], v[184:187], a[204:207], v[56:59]
ds_read_b64_tr_b16 v[238:239], v11 offset:43008
v_lshlrev_b32 v115, 16, v110
v_mfma_f32_16x16x32_bf16 v[72:75], v[184:187], a[220:223], v[72:75]
ds_read_b64_tr_b16 v[240:241], v8 offset:45056
ds_read_b64_tr_b16 v[242:243], v8 offset:47104
v_mfma_f32_16x16x32_bf16 v[72:75], v[168:171], a[216:219], v[72:75]
ds_read_b64_tr_b16 v[244:245], v9 offset:45056
v_lshlrev_b32 v102, 16, v102
v_mfma_f32_16x16x32_bf16 v[72:75], v[152:155], a[212:215], v[72:75]
ds_read_b64_tr_b16 v[246:247], v9 offset:47104
v_and_b32 v110, 0xffff0000, v110
v_mfma_f32_16x16x32_bf16 v[72:75], v[136:139], a[208:211], v[72:75]
ds_read_b64_tr_b16 v[248:249], v10 offset:45056
ds_read_b64_tr_b16 v[250:251], v10 offset:47104
v_mfma_f32_16x16x32_bf16 v[76:79], v[140:143], a[208:211], v[76:79]
s_add_u32 s72, s71, 46080
buffer_load_dwordx4 v15, s[24:27], s72 offen offset:3072 lds
v_mfma_f32_16x16x32_bf16 v[76:79], v[156:159], a[212:215], v[76:79]
ds_read_b64_tr_b16 v[252:253], v11 offset:45056
v_mul_f32 v102, v102, v113
v_mfma_f32_16x16x32_bf16 v[76:79], v[172:175], a[216:219], v[76:79]
ds_read_b64_tr_b16 v[254:255], v11 offset:47104
v_mul_f32 v114, v114, v113
v_mfma_f32_16x16x32_bf16 v[76:79], v[188:191], a[220:223], v[76:79]
v_mul_f32 v102, v102, v115
v_mul_f32 v110, v110, v114
v_mfma_f32_16x16x32_bf16 v[60:63], v[188:191], a[204:207], v[60:63]
v_and_b32 v114, 0xffff0000, v103
v_lshlrev_b32 v115, 16, v111
v_mfma_f32_16x16x32_bf16 v[60:63], v[172:175], a[200:203], v[60:63]
s_add_u32 s71, s14, 0x600000
v_lshlrev_b32 v103, 16, v103
v_and_b32 v111, 0xffff0000, v111
v_mfma_f32_16x16x32_bf16 v[60:63], v[156:159], a[196:199], v[60:63]
s_waitcnt vmcnt(8) lgkmcnt(0)
v_mul_f32 v103, v103, v113
v_mul_f32 v114, v114, v113
v_mfma_f32_16x16x32_bf16 v[60:63], v[140:143], a[192:195], v[60:63]
s_barrier
v_mul_f32 v103, v103, v115
v_mul_f32 v111, v111, v114
v_mfma_f32_16x16x32_bf16 v[48:51], v[192:195], a[224:227], v[48:51]
s_and_b32 s71, s71, 0x7c0000
ds_read_b64_tr_b16 v[128:129], v8 offset:49152
ds_read_b64_tr_b16 v[130:131], v8 offset:51200
v_mfma_f32_16x16x32_bf16 v[48:51], v[208:211], a[228:231], v[48:51]
s_add_u32 s71, s71, s94
ds_read_b64_tr_b16 v[132:133], v9 offset:49152
v_mfma_f32_16x16x32_bf16 v[48:51], v[224:227], a[232:235], v[48:51]
s_add_u32 m0, s77, 32768
ds_read_b64_tr_b16 v[134:135], v9 offset:51200
ds_read_b64_tr_b16 v[136:137], v10 offset:49152
v_mfma_f32_16x16x32_bf16 v[48:51], v[240:243], a[236:239], v[48:51]
s_add_u32 s72, s71, 0
buffer_load_dwordx4 v15, s[24:27], s72 offen lds
v_mfma_f32_16x16x32_bf16 v[52:55], v[244:247], a[236:239], v[52:55]
ds_read_b64_tr_b16 v[138:139], v10 offset:51200
v_mfma_f32_16x16x32_bf16 v[52:55], v[228:231], a[232:235], v[52:55]
ds_read_b64_tr_b16 v[140:141], v11 offset:49152
ds_read_b64_tr_b16 v[142:143], v11 offset:51200
v_mfma_f32_16x16x32_bf16 v[52:55], v[212:215], a[228:231], v[52:55]
ds_read_b64_tr_b16 v[144:145], v8 offset:53248
v_mfma_f32_16x16x32_bf16 v[52:55], v[196:199], a[224:227], v[52:55]
ds_read_b64_tr_b16 v[146:147], v8 offset:55296
ds_read_b64_tr_b16 v[148:149], v9 offset:53248
v_mfma_f32_16x16x32_bf16 v[56:59], v[200:203], a[224:227], v[56:59]
ds_read_b64_tr_b16 v[150:151], v9 offset:55296
v_mfma_f32_16x16x32_bf16 v[56:59], v[216:219], a[228:231], v[56:59]
ds_read_b64_tr_b16 v[152:153], v10 offset:53248
ds_read_b64_tr_b16 v[154:155], v10 offset:55296
v_mfma_f32_16x16x32_bf16 v[56:59], v[232:235], a[232:235], v[56:59]
s_add_u32 s72, s71, 15360
buffer_load_dwordx4 v15, s[24:27], s72 offen offset:1024 lds
v_mfma_f32_16x16x32_bf16 v[56:59], v[248:251], a[236:239], v[56:59]
ds_read_b64_tr_b16 v[156:157], v11 offset:53248
v_cvt_pk_bf16_f32 v48, v48, v49
v_cvt_pk_bf16_f32 v49, v50, v51
v_mfma_f32_16x16x32_bf16 v[60:63], v[252:255], a[236:239], v[60:63]
ds_read_b64_tr_b16 v[158:159], v11 offset:55296
v_cvt_pk_bf16_f32 v50, v52, v53
v_cvt_pk_bf16_f32 v51, v54, v55
v_mfma_f32_16x16x32_bf16 v[60:63], v[236:239], a[232:235], v[60:63]
ds_read_b64_tr_b16 v[160:161], v8 offset:57344
ds_read_b64_tr_b16 v[162:163], v8 offset:59392
v_mfma_f32_16x16x32_bf16 v[60:63], v[220:223], a[228:231], v[60:63]
ds_read_b64_tr_b16 v[164:165], v9 offset:57344
v_mfma_f32_16x16x32_bf16 v[60:63], v[204:207], a[224:227], v[60:63]
ds_read_b64_tr_b16 v[166:167], v9 offset:59392
ds_read_b64_tr_b16 v[168:169], v10 offset:57344
v_mfma_f32_16x16x32_bf16 v[64:67], v[192:195], a[240:243], v[64:67]
ds_read_b64_tr_b16 v[170:171], v10 offset:59392
v_mfma_f32_16x16x32_bf16 v[64:67], v[208:211], a[244:247], v[64:67]
s_add_u32 s72, s71, 30720
buffer_load_dwordx4 v15, s[24:27], s72 offen offset:2048 lds
v_mfma_f32_16x16x32_bf16 v[64:67], v[224:227], a[248:251], v[64:67]
buffer_store_dwordx4 v[48:51], v1, s[44:47], s80 offen sc1
v_mfma_f32_16x16x32_bf16 v[64:67], v[240:243], a[252:255], v[64:67]
ds_read_b64_tr_b16 v[172:173], v11 offset:57344
ds_read_b64_tr_b16 v[174:175], v11 offset:59392
v_cvt_pk_bf16_f32 v52, v56, v57
v_mfma_f32_16x16x32_bf16 v[68:71], v[244:247], a[252:255], v[68:71]
ds_read_b64_tr_b16 v[176:177], v8 offset:61440
v_cvt_pk_bf16_f32 v53, v58, v59
v_cvt_pk_bf16_f32 v54, v60, v61
v_mfma_f32_16x16x32_bf16 v[68:71], v[228:231], a[248:251], v[68:71]
ds_read_b64_tr_b16 v[178:179], v8 offset:63488
ds_read_b64_tr_b16 v[180:181], v9 offset:61440
v_cvt_pk_bf16_f32 v55, v62, v63
v_mfma_f32_16x16x32_bf16 v[68:71], v[212:215], a[244:247], v[68:71]
ds_read_b64_tr_b16 v[182:183], v9 offset:63488
v_mfma_f32_16x16x32_bf16 v[68:71], v[196:199], a[240:243], v[68:71]
ds_read_b64_tr_b16 v[184:185], v10 offset:61440
ds_read_b64_tr_b16 v[186:187], v10 offset:63488
v_mfma_f32_16x16x32_bf16 v[72:75], v[200:203], a[240:243], v[72:75]
s_add_u32 s72, s71, 46080
buffer_load_dwordx4 v15, s[24:27], s72 offen offset:3072 lds
v_mfma_f32_16x16x32_bf16 v[72:75], v[216:219], a[244:247], v[72:75]
ds_read_b64_tr_b16 v[188:189], v11 offset:61440
v_mfma_f32_16x16x32_bf16 v[72:75], v[232:235], a[248:251], v[72:75]
ds_read_b64_tr_b16 v[190:191], v11 offset:63488
v_mfma_f32_16x16x32_bf16 v[72:75], v[248:251], a[252:255], v[72:75]
v_cvt_pk_bf16_f32 v56, v64, v65
v_cvt_pk_bf16_f32 v57, v66, v67
v_cvt_pk_bf16_f32 v58, v68, v69
v_mfma_f32_16x16x32_bf16 v[76:79], v[252:255], a[252:255], v[76:79]
v_cvt_pk_bf16_f32 v59, v70, v71
v_mfma_f32_16x16x32_bf16 v[76:79], v[236:239], a[248:251], v[76:79]
s_add_u32 s71, s15, 0x600000
v_mfma_f32_16x16x32_bf16 v[76:79], v[220:223], a[244:247], v[76:79]
s_waitcnt vmcnt(9) lgkmcnt(0)
v_mfma_f32_16x16x32_bf16 v[76:79], v[204:207], a[240:243], v[76:79]
s_barrier
buffer_store_dwordx4 v[52:55], v1, s[44:47], s80 offen offset:1024 sc1
v_mfma_f32_16x16x32_bf16 v[16:19], v[128:131], a[96:99], v[16:19]
s_and_b32 s71, s71, 0x7c0000
ds_read_b64_tr_b16 v[192:193], v8 offset:0
ds_read_b64_tr_b16 v[194:195], v8 offset:2048
v_mfma_f32_16x16x32_bf16 v[16:19], v[144:147], a[100:103], v[16:19]
s_add_u32 s71, s71, s94
ds_read_b64_tr_b16 v[196:197], v9 offset:0
ds_read_b64_tr_b16 v[198:199], v9 offset:2048
v_mfma_f32_16x16x32_bf16 v[16:19], v[160:163], a[104:107], v[16:19]
s_add_u32 m0, s77, 49152
ds_read_b64_tr_b16 v[200:201], v10 offset:0
v_mfma_f32_16x16x32_bf16 v[16:19], v[176:179], a[108:111], v[16:19]
s_add_u32 s72, s71, 0
buffer_load_dwordx4 v15, s[24:27], s72 offen lds
v_cvt_pk_bf16_f32 v60, v72, v73
v_mfma_f32_16x16x32_bf16 v[32:35], v[176:179], a[124:127], v[32:35]
ds_read_b64_tr_b16 v[202:203], v10 offset:2048
ds_read_b64_tr_b16 v[204:205], v11 offset:0
v_cvt_pk_bf16_f32 v61, v74, v75
v_mfma_f32_16x16x32_bf16 v[32:35], v[160:163], a[120:123], v[32:35]
ds_read_b64_tr_b16 v[206:207], v11 offset:2048
v_cvt_pk_bf16_f32 v62, v76, v77
v_cvt_pk_bf16_f32 v63, v78, v79
v_mfma_f32_16x16x32_bf16 v[32:35], v[144:147], a[116:119], v[32:35]
ds_read_b64_tr_b16 v[208:209], v8 offset:4096
ds_read_b64_tr_b16 v[210:211], v8 offset:6144
v_mfma_f32_16x16x32_bf16 v[32:35], v[128:131], a[112:115], v[32:35]
ds_read_b64_tr_b16 v[212:213], v9 offset:4096
v_mfma_f32_16x16x32_bf16 v[36:39], v[132:135], a[112:115], v[36:39]
ds_read_b64_tr_b16 v[214:215], v9 offset:6144
ds_read_b64_tr_b16 v[216:217], v10 offset:4096
v_mfma_f32_16x16x32_bf16 v[36:39], v[148:151], a[116:119], v[36:39]
ds_read_b64_tr_b16 v[218:219], v10 offset:6144
v_mfma_f32_16x16x32_bf16 v[36:39], v[164:167], a[120:123], v[36:39]
s_add_u32 s72, s71, 15360
buffer_load_dwordx4 v15, s[24:27], s72 offen offset:1024 lds
v_mfma_f32_16x16x32_bf16 v[36:39], v[180:183], a[124:127], v[36:39]
ds_read_b64_tr_b16 v[220:221], v11 offset:4096
ds_read_b64_tr_b16 v[222:223], v11 offset:6144
v_mfma_f32_16x16x32_bf16 v[20:23], v[180:183], a[108:111], v[20:23]
buffer_store_dwordx4 v[56:59], v1, s[44:47], s80 offen offset:2048 sc1
v_mfma_f32_16x16x32_bf16 v[20:23], v[164:167], a[104:107], v[20:23]
ds_read_b64_tr_b16 v[224:225], v8 offset:8192
v_mfma_f32_16x16x32_bf16 v[20:23], v[148:151], a[100:103], v[20:23]
ds_read_b64_tr_b16 v[226:227], v8 offset:10240
ds_read_b64_tr_b16 v[228:229], v9 offset:8192
v_mfma_f32_16x16x32_bf16 v[20:23], v[132:135], a[96:99], v[20:23]
ds_read_b64_tr_b16 v[230:231], v9 offset:10240
v_mfma_f32_16x16x32_bf16 v[24:27], v[136:139], a[96:99], v[24:27]
ds_read_b64_tr_b16 v[232:233], v10 offset:8192
ds_read_b64_tr_b16 v[234:235], v10 offset:10240
v_mfma_f32_16x16x32_bf16 v[24:27], v[152:155], a[100:103], v[24:27]
s_add_u32 s72, s71, 30720
buffer_load_dwordx4 v15, s[24:27], s72 offen offset:2048 lds
v_mfma_f32_16x16x32_bf16 v[24:27], v[168:171], a[104:107], v[24:27]
ds_read_b64_tr_b16 v[236:237], v11 offset:8192
v_mfma_f32_16x16x32_bf16 v[24:27], v[184:187], a[108:111], v[24:27]
ds_read_b64_tr_b16 v[238:239], v11 offset:10240
ds_read_b64_tr_b16 v[240:241], v8 offset:12288
v_mfma_f32_16x16x32_bf16 v[40:43], v[184:187], a[124:127], v[40:43]
ds_read_b64_tr_b16 v[242:243], v8 offset:14336
v_mfma_f32_16x16x32_bf16 v[40:43], v[168:171], a[120:123], v[40:43]
ds_read_b64_tr_b16 v[244:245], v9 offset:12288
ds_read_b64_tr_b16 v[246:247], v9 offset:14336
v_mfma_f32_16x16x32_bf16 v[40:43], v[152:155], a[116:119], v[40:43]
ds_read_b64_tr_b16 v[248:249], v10 offset:12288
v_mfma_f32_16x16x32_bf16 v[40:43], v[136:139], a[112:115], v[40:43]
ds_read_b64_tr_b16 v[250:251], v10 offset:14336
ds_read_b64_tr_b16 v[252:253], v11 offset:12288
v_mfma_f32_16x16x32_bf16 v[44:47], v[140:143], a[112:115], v[44:47]
s_add_u32 s72, s71, 46080
buffer_load_dwordx4 v15, s[24:27], s72 offen offset:3072 lds
v_mfma_f32_16x16x32_bf16 v[44:47], v[156:159], a[116:119], v[44:47]
buffer_store_dwordx4 v[60:63], v1, s[44:47], s80 offen offset:3072 sc1
v_mfma_f32_16x16x32_bf16 v[44:47], v[172:175], a[120:123], v[44:47]
ds_read_b64_tr_b16 v[254:255], v11 offset:14336
v_mfma_f32_16x16x32_bf16 v[44:47], v[188:191], a[124:127], v[44:47]
v_mfma_f32_16x16x32_bf16 v[28:31], v[188:191], a[108:111], v[28:31]
v_mfma_f32_16x16x32_bf16 v[28:31], v[172:175], a[104:107], v[28:31]
v_mfma_f32_16x16x32_bf16 v[28:31], v[156:159], a[100:103], v[28:31]
s_waitcnt vmcnt(12) lgkmcnt(0)
v_mfma_f32_16x16x32_bf16 v[28:31], v[140:143], a[96:99], v[28:31]
s_barrier
v_mfma_f32_16x16x32_bf16 v[16:19], v[192:195], a[128:131], v[16:19]
ds_read_b64_tr_b16 v[128:129], v8 offset:16384
ds_read_b64_tr_b16 v[130:131], v8 offset:18432
v_mfma_f32_16x16x32_bf16 v[16:19], v[208:211], a[132:135], v[16:19]
ds_read_b64_tr_b16 v[132:133], v9 offset:16384
v_mfma_f32_16x16x32_bf16 v[16:19], v[224:227], a[136:139], v[16:19]
ds_read_b64_tr_b16 v[134:135], v9 offset:18432
v_mfma_f32_16x16x32_bf16 v[16:19], v[240:243], a[140:143], v[16:19]
ds_read_b64_tr_b16 v[136:137], v10 offset:16384
v_mfma_f32_16x16x32_bf16 v[32:35], v[240:243], a[156:159], v[32:35]
ds_read_b64_tr_b16 v[138:139], v10 offset:18432
v_mfma_f32_16x16x32_bf16 v[32:35], v[224:227], a[152:155], v[32:35]
ds_read_b64_tr_b16 v[140:141], v11 offset:16384
ds_read_b64_tr_b16 v[142:143], v11 offset:18432
v_mfma_f32_16x16x32_bf16 v[32:35], v[208:211], a[148:151], v[32:35]
ds_read_b64_tr_b16 v[144:145], v8 offset:20480
v_mfma_f32_16x16x32_bf16 v[32:35], v[192:195], a[144:147], v[32:35]
ds_read_b64_tr_b16 v[146:147], v8 offset:22528
v_mfma_f32_16x16x32_bf16 v[36:39], v[196:199], a[144:147], v[36:39]
ds_read_b64_tr_b16 v[148:149], v9 offset:20480
v_mfma_f32_16x16x32_bf16 v[36:39], v[212:215], a[148:151], v[36:39]
ds_read_b64_tr_b16 v[150:151], v9 offset:22528
v_mfma_f32_16x16x32_bf16 v[36:39], v[228:231], a[152:155], v[36:39]
ds_read_b64_tr_b16 v[152:153], v10 offset:20480
ds_read_b64_tr_b16 v[154:155], v10 offset:22528
v_mfma_f32_16x16x32_bf16 v[36:39], v[244:247], a[156:159], v[36:39]
ds_read_b64_tr_b16 v[156:157], v11 offset:20480
v_mfma_f32_16x16x32_bf16 v[20:23], v[244:247], a[140:143], v[20:23]
ds_read_b64_tr_b16 v[158:159], v11 offset:22528
v_mfma_f32_16x16x32_bf16 v[20:23], v[228:231], a[136:139], v[20:23]
ds_read_b64_tr_b16 v[160:161], v8 offset:24576
v_mfma_f32_16x16x32_bf16 v[20:23], v[212:215], a[132:135], v[20:23]
ds_read_b64_tr_b16 v[162:163], v8 offset:26624
v_mfma_f32_16x16x32_bf16 v[20:23], v[196:199], a[128:131], v[20:23]
ds_read_b64_tr_b16 v[164:165], v9 offset:24576
v_mfma_f32_16x16x32_bf16 v[24:27], v[200:203], a[128:131], v[24:27]
ds_read_b64_tr_b16 v[166:167], v9 offset:26624
ds_read_b64_tr_b16 v[168:169], v10 offset:24576
v_mfma_f32_16x16x32_bf16 v[24:27], v[216:219], a[132:135], v[24:27]
ds_read_b64_tr_b16 v[170:171], v10 offset:26624
v_mfma_f32_16x16x32_bf16 v[24:27], v[232:235], a[136:139], v[24:27]
ds_read_b64_tr_b16 v[172:173], v11 offset:24576
v_mfma_f32_16x16x32_bf16 v[24:27], v[248:251], a[140:143], v[24:27]
ds_read_b64_tr_b16 v[174:175], v11 offset:26624
v_mfma_f32_16x16x32_bf16 v[40:43], v[248:251], a[156:159], v[40:43]
ds_read_b64_tr_b16 v[176:177], v8 offset:28672
v_mfma_f32_16x16x32_bf16 v[40:43], v[232:235], a[152:155], v[40:43]
ds_read_b64_tr_b16 v[178:179], v8 offset:30720
ds_read_b64_tr_b16 v[180:181], v9 offset:28672
v_mfma_f32_16x16x32_bf16 v[40:43], v[216:219], a[148:151], v[40:43]
ds_read_b64_tr_b16 v[182:183], v9 offset:30720
v_mfma_f32_16x16x32_bf16 v[40:43], v[200:203], a[144:147], v[40:43]
ds_read_b64_tr_b16 v[184:185], v10 offset:28672
v_mfma_f32_16x16x32_bf16 v[44:47], v[204:207], a[144:147], v[44:47]
ds_read_b64_tr_b16 v[186:187], v10 offset:30720
v_mfma_f32_16x16x32_bf16 v[44:47], v[220:223], a[148:151], v[44:47]
ds_read_b64_tr_b16 v[188:189], v11 offset:28672
v_mfma_f32_16x16x32_bf16 v[44:47], v[236:239], a[152:155], v[44:47]
ds_read_b64_tr_b16 v[190:191], v11 offset:30720
v_mfma_f32_16x16x32_bf16 v[44:47], v[252:255], a[156:159], v[44:47]
v_mfma_f32_16x16x32_bf16 v[28:31], v[252:255], a[140:143], v[28:31]
v_mfma_f32_16x16x32_bf16 v[28:31], v[236:239], a[136:139], v[28:31]
v_mfma_f32_16x16x32_bf16 v[28:31], v[220:223], a[132:135], v[28:31]
s_waitcnt vmcnt(7) lgkmcnt(0)
v_mfma_f32_16x16x32_bf16 v[28:31], v[204:207], a[128:131], v[28:31]
s_barrier
v_mfma_f32_16x16x32_bf16 v[16:19], v[128:131], a[160:163], v[16:19]
ds_read_b64_tr_b16 v[192:193], v8 offset:32768
ds_read_b64_tr_b16 v[194:195], v8 offset:34816
v_mfma_f32_16x16x32_bf16 v[16:19], v[144:147], a[164:167], v[16:19]
ds_read_b64_tr_b16 v[196:197], v9 offset:32768
v_mfma_f32_16x16x32_bf16 v[16:19], v[160:163], a[168:171], v[16:19]
ds_read_b64_tr_b16 v[198:199], v9 offset:34816
ds_read_b64_tr_b16 v[200:201], v10 offset:32768
v_mfma_f32_16x16x32_bf16 v[16:19], v[176:179], a[172:175], v[16:19]
ds_read_b64_tr_b16 v[202:203], v10 offset:34816
v_mfma_f32_16x16x32_bf16 v[32:35], v[176:179], a[188:191], v[32:35]
ds_read_b64_tr_b16 v[204:205], v11 offset:32768
v_mfma_f32_16x16x32_bf16 v[32:35], v[160:163], a[184:187], v[32:35]
ds_read_b64_tr_b16 v[206:207], v11 offset:34816
ds_read_b64_tr_b16 v[208:209], v8 offset:36864
v_mfma_f32_16x16x32_bf16 v[32:35], v[144:147], a[180:183], v[32:35]
ds_read_b64_tr_b16 v[210:211], v8 offset:38912
v_mfma_f32_16x16x32_bf16 v[32:35], v[128:131], a[176:179], v[32:35]
ds_read_b64_tr_b16 v[212:213], v9 offset:36864
ds_read_b64_tr_b16 v[214:215], v9 offset:38912
v_mfma_f32_16x16x32_bf16 v[36:39], v[132:135], a[176:179], v[36:39]
ds_read_b64_tr_b16 v[216:217], v10 offset:36864
v_mfma_f32_16x16x32_bf16 v[36:39], v[148:151], a[180:183], v[36:39]
ds_read_b64_tr_b16 v[218:219], v10 offset:38912
v_mfma_f32_16x16x32_bf16 v[36:39], v[164:167], a[184:187], v[36:39]
ds_read_b64_tr_b16 v[220:221], v11 offset:36864
ds_read_b64_tr_b16 v[222:223], v11 offset:38912
v_mfma_f32_16x16x32_bf16 v[36:39], v[180:183], a[188:191], v[36:39]
ds_read_b64_tr_b16 v[224:225], v8 offset:40960
v_mfma_f32_16x16x32_bf16 v[20:23], v[180:183], a[172:175], v[20:23]
ds_read_b64_tr_b16 v[226:227], v8 offset:43008
ds_read_b64_tr_b16 v[228:229], v9 offset:40960
v_mfma_f32_16x16x32_bf16 v[20:23], v[164:167], a[168:171], v[20:23]
ds_read_b64_tr_b16 v[230:231], v9 offset:43008
v_mfma_f32_16x16x32_bf16 v[20:23], v[148:151], a[164:167], v[20:23]
buffer_load_dwordx4 v[64:67], v1, s[44:47], s79 offen sc1
v_mfma_f32_16x16x32_bf16 v[20:23], v[132:135], a[160:163], v[20:23]
ds_read_b64_tr_b16 v[232:233], v10 offset:40960
v_mfma_f32_16x16x32_bf16 v[24:27], v[136:139], a[160:163], v[24:27]
buffer_load_dwordx4 v[68:71], v1, s[44:47], s79 offen offset:1024 sc1
v_mfma_f32_16x16x32_bf16 v[24:27], v[152:155], a[164:167], v[24:27]
ds_read_b64_tr_b16 v[234:235], v10 offset:43008
ds_read_b64_tr_b16 v[236:237], v11 offset:40960
v_mfma_f32_16x16x32_bf16 v[24:27], v[168:171], a[168:171], v[24:27]
buffer_load_dwordx4 v[72:75], v1, s[44:47], s79 offen offset:2048 sc1
v_mfma_f32_16x16x32_bf16 v[24:27], v[184:187], a[172:175], v[24:27]
ds_read_b64_tr_b16 v[238:239], v11 offset:43008
v_mfma_f32_16x16x32_bf16 v[40:43], v[184:187], a[188:191], v[40:43]
buffer_load_dwordx4 v[76:79], v1, s[44:47], s79 offen offset:3072 sc1
v_mfma_f32_16x16x32_bf16 v[40:43], v[168:171], a[184:187], v[40:43]
ds_read_b64_tr_b16 v[240:241], v8 offset:45056
ds_read_b64_tr_b16 v[242:243], v8 offset:47104
v_mfma_f32_16x16x32_bf16 v[40:43], v[152:155], a[180:183], v[40:43]
ds_read_b64_tr_b16 v[244:245], v9 offset:45056
v_mfma_f32_16x16x32_bf16 v[40:43], v[136:139], a[176:179], v[40:43]
ds_read_b64_tr_b16 v[246:247], v9 offset:47104
v_mfma_f32_16x16x32_bf16 v[44:47], v[140:143], a[176:179], v[44:47]
ds_read_b64_tr_b16 v[248:249], v10 offset:45056
ds_read_b64_tr_b16 v[250:251], v10 offset:47104
v_mfma_f32_16x16x32_bf16 v[44:47], v[156:159], a[180:183], v[44:47]
ds_read_b64_tr_b16 v[252:253], v11 offset:45056
v_mfma_f32_16x16x32_bf16 v[44:47], v[172:175], a[184:187], v[44:47]
ds_read_b64_tr_b16 v[254:255], v11 offset:47104
v_mfma_f32_16x16x32_bf16 v[44:47], v[188:191], a[188:191], v[44:47]
v_mfma_f32_16x16x32_bf16 v[28:31], v[188:191], a[172:175], v[28:31]
v_mfma_f32_16x16x32_bf16 v[28:31], v[172:175], a[168:171], v[28:31]
v_mfma_f32_16x16x32_bf16 v[28:31], v[156:159], a[164:167], v[28:31]
s_waitcnt vmcnt(5) lgkmcnt(0)
v_mfma_f32_16x16x32_bf16 v[28:31], v[140:143], a[160:163], v[28:31]
s_barrier
v_mfma_f32_16x16x32_bf16 v[16:19], v[192:195], a[192:195], v[16:19]
ds_read_b64_tr_b16 v[128:129], v8 offset:49152
ds_read_b64_tr_b16 v[130:131], v8 offset:51200
v_mfma_f32_16x16x32_bf16 v[16:19], v[208:211], a[196:199], v[16:19]
ds_read_b64_tr_b16 v[132:133], v9 offset:49152
v_mfma_f32_16x16x32_bf16 v[16:19], v[224:227], a[200:203], v[16:19]
ds_read_b64_tr_b16 v[134:135], v9 offset:51200
v_mfma_f32_16x16x32_bf16 v[16:19], v[240:243], a[204:207], v[16:19]
ds_read_b64_tr_b16 v[136:137], v10 offset:49152
v_mfma_f32_16x16x32_bf16 v[32:35], v[240:243], a[220:223], v[32:35]
ds_read_b64_tr_b16 v[138:139], v10 offset:51200
v_mfma_f32_16x16x32_bf16 v[32:35], v[224:227], a[216:219], v[32:35]
ds_read_b64_tr_b16 v[140:141], v11 offset:49152
ds_read_b64_tr_b16 v[142:143], v11 offset:51200
v_mfma_f32_16x16x32_bf16 v[32:35], v[208:211], a[212:215], v[32:35]
ds_read_b64_tr_b16 v[144:145], v8 offset:53248
v_mfma_f32_16x16x32_bf16 v[32:35], v[192:195], a[208:211], v[32:35]
ds_read_b64_tr_b16 v[146:147], v8 offset:55296
v_mfma_f32_16x16x32_bf16 v[36:39], v[196:199], a[208:211], v[36:39]
ds_read_b64_tr_b16 v[148:149], v9 offset:53248
v_mfma_f32_16x16x32_bf16 v[36:39], v[212:215], a[212:215], v[36:39]
ds_read_b64_tr_b16 v[150:151], v9 offset:55296
v_mfma_f32_16x16x32_bf16 v[36:39], v[228:231], a[216:219], v[36:39]
ds_read_b64_tr_b16 v[152:153], v10 offset:53248
ds_read_b64_tr_b16 v[154:155], v10 offset:55296
v_mfma_f32_16x16x32_bf16 v[36:39], v[244:247], a[220:223], v[36:39]
ds_read_b64_tr_b16 v[156:157], v11 offset:53248
v_mfma_f32_16x16x32_bf16 v[20:23], v[244:247], a[204:207], v[20:23]
ds_read_b64_tr_b16 v[158:159], v11 offset:55296
v_mfma_f32_16x16x32_bf16 v[20:23], v[228:231], a[200:203], v[20:23]
ds_read_b64_tr_b16 v[160:161], v8 offset:57344
v_mfma_f32_16x16x32_bf16 v[20:23], v[212:215], a[196:199], v[20:23]
ds_read_b64_tr_b16 v[162:163], v8 offset:59392
v_mfma_f32_16x16x32_bf16 v[20:23], v[196:199], a[192:195], v[20:23]
ds_read_b64_tr_b16 v[164:165], v9 offset:57344
v_mfma_f32_16x16x32_bf16 v[24:27], v[200:203], a[192:195], v[24:27]
ds_read_b64_tr_b16 v[166:167], v9 offset:59392
ds_read_b64_tr_b16 v[168:169], v10 offset:57344
v_mfma_f32_16x16x32_bf16 v[24:27], v[216:219], a[196:199], v[24:27]
ds_read_b64_tr_b16 v[170:171], v10 offset:59392
v_mfma_f32_16x16x32_bf16 v[24:27], v[232:235], a[200:203], v[24:27]
ds_read_b64_tr_b16 v[172:173], v11 offset:57344
v_mfma_f32_16x16x32_bf16 v[24:27], v[248:251], a[204:207], v[24:27]
ds_read_b64_tr_b16 v[174:175], v11 offset:59392
v_mfma_f32_16x16x32_bf16 v[40:43], v[248:251], a[220:223], v[40:43]
ds_read_b64_tr_b16 v[176:177], v8 offset:61440
v_mfma_f32_16x16x32_bf16 v[40:43], v[232:235], a[216:219], v[40:43]
ds_read_b64_tr_b16 v[178:179], v8 offset:63488
ds_read_b64_tr_b16 v[180:181], v9 offset:61440
v_mfma_f32_16x16x32_bf16 v[40:43], v[216:219], a[212:215], v[40:43]
ds_read_b64_tr_b16 v[182:183], v9 offset:63488
v_mfma_f32_16x16x32_bf16 v[40:43], v[200:203], a[208:211], v[40:43]
ds_read_b64_tr_b16 v[184:185], v10 offset:61440
v_mfma_f32_16x16x32_bf16 v[44:47], v[204:207], a[208:211], v[44:47]
ds_read_b64_tr_b16 v[186:187], v10 offset:63488
v_mfma_f32_16x16x32_bf16 v[44:47], v[220:223], a[212:215], v[44:47]
ds_read_b64_tr_b16 v[188:189], v11 offset:61440
v_mfma_f32_16x16x32_bf16 v[44:47], v[236:239], a[216:219], v[44:47]
ds_read_b64_tr_b16 v[190:191], v11 offset:63488
v_mfma_f32_16x16x32_bf16 v[44:47], v[252:255], a[220:223], v[44:47]
v_mfma_f32_16x16x32_bf16 v[28:31], v[252:255], a[204:207], v[28:31]
v_mfma_f32_16x16x32_bf16 v[28:31], v[236:239], a[200:203], v[28:31]
v_mfma_f32_16x16x32_bf16 v[28:31], v[220:223], a[196:199], v[28:31]
s_waitcnt lgkmcnt(0)
v_mfma_f32_16x16x32_bf16 v[28:31], v[204:207], a[192:195], v[28:31]
v_mfma_f32_16x16x32_bf16 v[16:19], v[128:131], a[224:227], v[16:19]
v_mfma_f32_16x16x32_bf16 v[16:19], v[144:147], a[228:231], v[16:19]
s_waitcnt vmcnt(0)
v_max3_u32 v112, v64, v65, v66
v_max3_u32 v112, v112, v67, v68
v_max3_u32 v112, v112, v69, v70
v_max3_u32 v112, v112, v71, v72
v_max3_u32 v112, v112, v73, v74
v_max3_u32 v112, v112, v75, v76
v_max3_u32 v112, v112, v77, v78
v_max3_u32 v112, v112, v79, v79
v_cmp_eq_u32 vcc, -1, v112
s_cbranch_vccnz Lxspin
Lxback:
v_mfma_f32_16x16x32_bf16 v[16:19], v[160:163], a[232:235], v[16:19]
v_mfma_f32_16x16x32_bf16 v[16:19], v[176:179], a[236:239], v[16:19]
v_mfma_f32_16x16x32_bf16 v[16:19], v[124:127], v[64:67], v[16:19]
v_mfma_f32_16x16x32_bf16 v[20:23], v[180:183], a[236:239], v[20:23]
v_mfma_f32_16x16x32_bf16 v[20:23], v[164:167], a[232:235], v[20:23]
v_mfma_f32_16x16x32_bf16 v[20:23], v[148:151], a[228:231], v[20:23]
v_mfma_f32_16x16x32_bf16 v[20:23], v[132:135], a[224:227], v[20:23]
s_nop 3
v_fma_f32 v16, v16, v6, v80
v_fma_f32 v17, v17, v6, v88
v_mfma_f32_16x16x32_bf16 v[20:23], v[122:125], v[64:67], v[20:23]
v_fma_f32 v18, v18, v6, v81
v_fma_f32 v19, v19, v6, v89
v_mfma_f32_16x16x32_bf16 v[24:27], v[136:139], a[224:227], v[24:27]
v_cvt_pk_bf16_f32 v16, v16, v17
v_cvt_pk_bf16_f32 v17, v18, v19
v_mfma_f32_16x16x32_bf16 v[24:27], v[152:155], a[228:231], v[24:27]
ds_write_b64 v116, v[16:17] offset:0
v_mfma_f32_16x16x32_bf16 v[24:27], v[168:171], a[232:235], v[24:27]
v_mfma_f32_16x16x32_bf16 v[24:27], v[184:187], a[236:239], v[24:27]
v_fma_f32 v20, v20, v6, v82
v_fma_f32 v21, v21, v6, v90
v_mfma_f32_16x16x32_bf16 v[24:27], v[124:127], v[68:71], v[24:27]
v_fma_f32 v22, v22, v6, v83
v_fma_f32 v23, v23, v6, v91
v_mfma_f32_16x16x32_bf16 v[28:31], v[188:191], a[236:239], v[28:31]
v_cvt_pk_bf16_f32 v20, v20, v21
v_cvt_pk_bf16_f32 v21, v22, v23
v_mfma_f32_16x16x32_bf16 v[28:31], v[172:175], a[232:235], v[28:31]
ds_write_b64 v117, v[20:21] offset:0
v_mfma_f32_16x16x32_bf16 v[28:31], v[156:159], a[228:231], v[28:31]
v_mfma_f32_16x16x32_bf16 v[28:31], v[140:143], a[224:227], v[28:31]
v_fma_f32 v24, v24, v6, v84
v_fma_f32 v25, v25, v6, v92
v_mfma_f32_16x16x32_bf16 v[28:31], v[122:125], v[68:71], v[28:31]
v_fma_f32 v26, v26, v6, v85
v_fma_f32 v27, v27, v6, v93
v_mfma_f32_16x16x32_bf16 v[32:35], v[128:131], a[240:243], v[32:35]
v_cvt_pk_bf16_f32 v24, v24, v25
v_cvt_pk_bf16_f32 v25, v26, v27
v_mfma_f32_16x16x32_bf16 v[32:35], v[144:147], a[244:247], v[32:35]
ds_write_b64 v118, v[24:25] offset:0
v_mfma_f32_16x16x32_bf16 v[32:35], v[160:163], a[248:251], v[32:35]
v_mfma_f32_16x16x32_bf16 v[32:35], v[176:179], a[252:255], v[32:35]
v_fma_f32 v28, v28, v6, v86
v_fma_f32 v29, v29, v6, v94
v_mfma_f32_16x16x32_bf16 v[32:35], v[124:127], v[72:75], v[32:35]
v_fma_f32 v30, v30, v6, v87
v_fma_f32 v31, v31, v6, v95
v_mfma_f32_16x16x32_bf16 v[36:39], v[180:183], a[252:255], v[36:39]
v_cvt_pk_bf16_f32 v28, v28, v29
v_cvt_pk_bf16_f32 v29, v30, v31
v_mfma_f32_16x16x32_bf16 v[36:39], v[164:167], a[248:251], v[36:39]
ds_write_b64 v119, v[28:29] offset:0
ds_read_b128 v[48:51], v120 offset:0
v_mfma_f32_16x16x32_bf16 v[36:39], v[148:151], a[244:247], v[36:39]
ds_read_b128 v[52:55], v120 offset:1024
v_mfma_f32_16x16x32_bf16 v[36:39], v[132:135], a[240:243], v[36:39]
v_fma_f32 v32, v32, v7, v96
v_fma_f32 v33, v33, v7, v104
v_mfma_f32_16x16x32_bf16 v[36:39], v[122:125], v[72:75], v[36:39]
v_fma_f32 v34, v34, v7, v97
v_fma_f32 v35, v35, v7, v105
v_mfma_f32_16x16x32_bf16 v[40:43], v[136:139], a[240:243], v[40:43]
v_cvt_pk_bf16_f32 v32, v32, v33
v_cvt_pk_bf16_f32 v33, v34, v35
v_mfma_f32_16x16x32_bf16 v[40:43], v[152:155], a[244:247], v[40:43]
ds_write_b64 v116, v[32:33] offset:2048
v_mfma_f32_16x16x32_bf16 v[40:43], v[168:171], a[248:251], v[40:43]
s_waitcnt lgkmcnt(2)
buffer_store_dwordx4 v[48:51], v15, s[40:43], s70 offen sc1
v_mfma_f32_16x16x32_bf16 v[40:43], v[184:187], a[252:255], v[40:43]
s_add_u32 s70, s70, 0x4000
v_mfma_f32_16x16x32_bf16 v[40:43], v[124:127], v[76:79], v[40:43]
v_fma_f32 v36, v36, v7, v98
v_fma_f32 v37, v37, v7, v106
v_mfma_f32_16x16x32_bf16 v[44:47], v[188:191], a[252:255], v[44:47]
v_fma_f32 v38, v38, v7, v99
v_fma_f32 v39, v39, v7, v107
v_mfma_f32_16x16x32_bf16 v[44:47], v[172:175], a[248:251], v[44:47]
v_cvt_pk_bf16_f32 v36, v36, v37
v_cvt_pk_bf16_f32 v37, v38, v39
v_mfma_f32_16x16x32_bf16 v[44:47], v[156:159], a[244:247], v[44:47]
ds_write_b64 v117, v[36:37] offset:2048
v_mfma_f32_16x16x32_bf16 v[44:47], v[140:143], a[240:243], v[44:47]
v_fma_f32 v40, v40, v7, v100
v_fma_f32 v41, v41, v7, v108
v_mfma_f32_16x16x32_bf16 v[44:47], v[122:125], v[76:79], v[44:47]
v_fma_f32 v42, v42, v7, v101
v_fma_f32 v43, v43, v7, v109
v_cvt_pk_bf16_f32 v40, v40, v41
v_cvt_pk_bf16_f32 v41, v42, v43
ds_write_b64 v118, v[40:41] offset:2048
s_waitcnt lgkmcnt(3)
buffer_store_dwordx4 v[52:55], v15, s[40:43], s70 offen sc1
s_add_u32 s70, s70, 0x4000
v_fma_f32 v44, v44, v7, v102
v_fma_f32 v45, v45, v7, v110
v_fma_f32 v46, v46, v7, v103
v_fma_f32 v47, v47, v7, v111
v_cvt_pk_bf16_f32 v44, v44, v45
v_cvt_pk_bf16_f32 v45, v46, v47
ds_write_b64 v119, v[44:45] offset:2048
ds_read_b128 v[56:59], v120 offset:2048
ds_read_b128 v[60:63], v120 offset:3072
s_waitcnt lgkmcnt(1)
buffer_store_dwordx4 v[56:59], v15, s[40:43], s70 offen sc1
s_add_u32 s70, s70, 0x4000
s_waitcnt lgkmcnt(0)
buffer_store_dwordx4 v[60:63], v15, s[40:43], s70 offen sc1
s_add_u32 s70, s70, 0x4000
Lend:
s_endpgm
Lspin1:
s_mov_b32 s83, 262144
Lsl3:
s_sleep 2
buffer_load_dword v3, v2, s[48:51], 0 offen sc1
s_sub_u32 s83, s83, 1
s_cmp_eq_u32 s83, 0
s_waitcnt vmcnt(0)
s_cbranch_scc1 Lback2
v_cmp_gt_u32 vcc, 8, v3
s_cbranch_vccnz Lsl3
s_branch Lback2
Lspin4:
s_mov_b32 s83, 262144
Lsl6:
s_sleep 2
buffer_load_dword v3, v2, s[44:47], s75 offen sc1
s_sub_u32 s83, s83, 1
s_cmp_eq_u32 s83, 0
s_waitcnt vmcnt(0)
s_cbranch_scc1 Lback5
v_cmp_gt_u32 vcc, 1, v3
s_cbranch_vccnz Lsl6
s_branch Lback5
.p2align 12
s_endpgm
.p2align 7
LP0x:
Lstub10:
s_cbranch_execz Lret
s_cmp_eq_u32 s58, 2
s_cbranch_scc1 Lta10
s_cmp_eq_u32 s58, 3
s_cbranch_scc1 Lnt11
v_mfma_f32_16x16x32_bf16 v[160:163], a[160:163], v[16:19], v[112:115]
s_xor_b32 s74, s82, 0x10000
v_exp_f32 v128, v128
v_mfma_f32_16x16x32_bf16 v[176:179], a[176:179], v[16:19], v[112:115]
s_add_u32 s74, s74, s64
ds_read_b128 a[128:131], v2 offset:16384
ds_read_b128 a[132:135], v2 offset:17408
s_branch Ljoin12
Lta10:
v_mfma_f32_16x16x32_bf16 v[160:163], a[160:163], v[16:19], v[96:99]
s_xor_b32 s74, s82, 0x10000
v_exp_f32 v128, v128
v_mfma_f32_16x16x32_bf16 v[176:179], a[176:179], v[16:19], v[112:115]
s_add_u32 s74, s74, s64
ds_read_b128 a[128:131], v2 offset:16384
ds_read_b128 a[132:135], v2 offset:17408
s_branch Ljoin12
Lnt11:
v_mfma_f32_16x16x32_bf16 v[160:163], a[160:163], v[16:19], v[80:83]
s_xor_b32 s74, s82, 0x10000
v_exp_f32 v128, v128
v_mfma_f32_16x16x32_bf16 v[176:179], a[176:179], v[16:19], v[96:99]
s_add_u32 s74, s74, s64
ds_read_b128 a[128:131], v2 offset:16384
ds_read_b128 a[132:135], v2 offset:17408
Ljoin12:
v_mfma_f32_16x16x32_bf16 v[160:163], a[164:167], v[20:23], v[160:163]
s_add_u32 s81, s81, 0x8000
v_exp_f32 v129, v129
v_mfma_f32_16x16x32_bf16 v[160:163], a[168:171], v[24:27], v[160:163]
s_add_u32 m0, s74, 16384
v_exp_f32 v130, v130
v_mfma_f32_16x16x32_bf16 v[160:163], a[172:175], v[28:31], v[160:163]
s_add_u32 s72, s81, 16384
v_exp_f32 v131, v131
v_mfma_f32_16x16x32_bf16 v[164:167], a[172:175], v[44:47], v[84:87]
v_exp_f32 v144, v144
v_mfma_f32_16x16x32_bf16 v[164:167], a[168:171], v[40:43], v[164:167]
ds_read_b128 a[136:139], v2 offset:18432
ds_read_b128 a[140:143], v2 offset:19456
v_mfma_f32_16x16x32_bf16 v[164:167], a[164:167], v[36:39], v[164:167]
ds_read_b128 a[144:147], v2 offset:20480
ds_read_b128 a[148:151], v2 offset:21504
v_mfma_f32_16x16x32_bf16 v[164:167], a[160:163], v[32:35], v[164:167]
ds_read_b128 a[152:155], v2 offset:22528
ds_read_b128 a[156:159], v2 offset:23552
v_mfma_f32_16x16x32_bf16 v[168:171], a[160:163], v[48:51], v[88:91]
ds_read_b128 a[192:195], v2 offset:0
ds_read_b128 a[196:199], v2 offset:1024
v_mfma_f32_16x16x32_bf16 v[168:171], a[164:167], v[52:55], v[168:171]
ds_read_b128 a[200:203], v2 offset:2048
ds_read_b128 a[204:207], v2 offset:3072
v_mfma_f32_16x16x32_bf16 v[168:171], a[168:171], v[56:59], v[168:171]
ds_read_b128 a[208:211], v2 offset:4096
ds_read_b128 a[212:215], v2 offset:5120
v_mfma_f32_16x16x32_bf16 v[168:171], a[172:175], v[60:63], v[168:171]
ds_read_b128 a[216:219], v2 offset:6144
ds_read_b128 a[220:223], v2 offset:7168
v_mfma_f32_16x16x32_bf16 v[172:175], a[172:175], v[76:79], v[92:95]
v_cvt_pk_bf16_f32 v192, v128, v129
v_cvt_pk_bf16_f32 v193, v130, v131
v_mfma_f32_16x16x32_bf16 v[172:175], a[168:171], v[72:75], v[172:175]
buffer_load_dwordx4 v1, s[44:47], s72 offen sc1 lds
v_mfma_f32_16x16x32_bf16 v[172:175], a[164:167], v[68:71], v[172:175]
v_exp_f32 v145, v145
v_mfma_f32_16x16x32_bf16 v[172:175], a[160:163], v[64:67], v[172:175]
v_exp_f32 v146, v146
v_mfma_f32_16x16x32_bf16 v[188:191], a[176:179], v[64:67], v[92:95]
v_exp_f32 v147, v147
v_mfma_f32_16x16x32_bf16 v[188:191], a[180:183], v[68:71], v[188:191]
v_exp_f32 v132, v132
v_mfma_f32_16x16x32_bf16 v[188:191], a[184:187], v[72:75], v[188:191]
v_cvt_pk_bf16_f32 v194, v144, v145
v_cvt_pk_bf16_f32 v195, v146, v147
v_mfma_f32_16x16x32_bf16 v[188:191], a[188:191], v[76:79], v[188:191]
v_exp_f32 v133, v133
v_mfma_f32_16x16x32_bf16 v[184:187], a[188:191], v[60:63], v[88:91]
v_exp_f32 v134, v134
v_mfma_f32_16x16x32_bf16 v[184:187], a[184:187], v[56:59], v[184:187]
v_exp_f32 v135, v135
v_mfma_f32_16x16x32_bf16 v[184:187], a[180:183], v[52:55], v[184:187]
v_exp_f32 v148, v148
v_mfma_f32_16x16x32_bf16 v[184:187], a[176:179], v[48:51], v[184:187]
v_cvt_pk_bf16_f32 v196, v132, v133
v_cvt_pk_bf16_f32 v197, v134, v135
v_mfma_f32_16x16x32_bf16 v[180:183], a[176:179], v[32:35], v[84:87]
buffer_load_dwordx4 v1, s[44:47], s72 offen offset:1024 sc1 lds
v_mfma_f32_16x16x32_bf16 v[180:183], a[180:183], v[36:39], v[180:183]
v_exp_f32 v149, v149
v_mfma_f32_16x16x32_bf16 v[180:183], a[184:187], v[40:43], v[180:183]
v_exp_f32 v150, v150
v_mfma_f32_16x16x32_bf16 v[180:183], a[188:191], v[44:47], v[180:183]
v_exp_f32 v151, v151
v_mfma_f32_16x16x32_bf16 v[176:179], a[188:191], v[28:31], v[176:179]
buffer_load_dwordx4 v1, s[44:47], s72 offen offset:2048 sc1 lds
v_mfma_f32_16x16x32_bf16 v[176:179], a[184:187], v[24:27], v[176:179]
buffer_load_dwordx4 v1, s[44:47], s72 offen offset:3072 sc1 lds
v_mfma_f32_16x16x32_bf16 v[176:179], a[180:183], v[20:23], v[176:179]
s_waitcnt lgkmcnt(8)
v_exp_f32 v136, v136
v_cvt_pk_bf16_f32 v198, v148, v149
v_cvt_pk_bf16_f32 v199, v150, v151
v_exp_f32 v137, v137
v_exp_f32 v138, v138
v_cvt_pk_bf16_f32 v200, v136, v137
v_exp_f32 v139, v139
v_exp_f32 v152, v152
v_cvt_pk_bf16_f32 v201, v138, v139
v_exp_f32 v153, v153
v_exp_f32 v154, v154
v_cvt_pk_bf16_f32 v202, v152, v153
v_exp_f32 v155, v155
v_exp_f32 v140, v140
v_cvt_pk_bf16_f32 v203, v154, v155
v_exp_f32 v141, v141
v_exp_f32 v142, v142
v_cvt_pk_bf16_f32 v204, v140, v141
v_exp_f32 v143, v143
v_exp_f32 v156, v156
v_cvt_pk_bf16_f32 v205, v142, v143
v_exp_f32 v157, v157
v_exp_f32 v158, v158
v_cvt_pk_bf16_f32 v206, v156, v157
v_exp_f32 v159, v159
s_nop 0
v_cvt_pk_bf16_f32 v207, v158, v159
s_cmp_eq_u32 s58, 0
s_cbranch_scc1 Lta13
s_cmp_eq_u32 s58, 1
s_cbranch_scc1 Lnt14
v_mfma_f32_16x16x32_bf16 v[132:135], a[128:131], v[32:35], v[84:87]
s_add_u32 s82, s82, 0x8000
ds_read_b128 a[160:163], v2 offset:24576
v_mfma_f32_16x16x32_bf16 v[148:151], a[144:147], v[32:35], v[84:87]
s_and_b32 s82, s82, 0x1ffff
v_exp_f32 v160, v160
s_branch Ljoin15
Lta13:
v_mfma_f32_16x16x32_bf16 v[132:135], a[128:131], v[32:35], v[100:103]
s_add_u32 s82, s82, 0x8000
ds_read_b128 a[160:163], v2 offset:24576
v_mfma_f32_16x16x32_bf16 v[148:151], a[144:147], v[32:35], v[112:115]
s_and_b32 s82, s82, 0x1ffff
v_exp_f32 v160, v160
s_branch Ljoin15
Lnt14:
v_mfma_f32_16x16x32_bf16 v[132:135], a[128:131], v[32:35], v[84:87]
s_add_u32 s82, s82, 0x8000
ds_read_b128 a[160:163], v2 offset:24576
v_mfma_f32_16x16x32_bf16 v[148:151], a[144:147], v[32:35], v[100:103]
s_and_b32 s82, s82, 0x1ffff
v_exp_f32 v160, v160
Ljoin15:
v_mfma_f32_16x16x32_bf16 v[132:135], a[132:135], v[36:39], v[132:135]
s_add_u32 m0, s74, 0
v_exp_f32 v161, v161
v_mfma_f32_16x16x32_bf16 v[132:135], a[136:139], v[40:43], v[132:135]
s_add_u32 s72, s81, 0
ds_read_b128 a[164:167], v2 offset:25600
v_cvt_pk_bf16_f32 v208, v160, v161
v_mfma_f32_16x16x32_bf16 v[132:135], a[140:143], v[44:47], v[132:135]
v_exp_f32 v162, v162
v_mfma_f32_16x16x32_bf16 v[136:139], a[140:143], v[60:63], v[88:91]
buffer_load_dwordx4 v1, s[44:47], s72 offen sc1 lds
v_mfma_f32_16x16x32_bf16 v[136:139], a[136:139], v[56:59], v[136:139]
v_exp_f32 v163, v163
v_mfma_f32_16x16x32_bf16 v[136:139], a[132:135], v[52:55], v[136:139]
ds_read_b128 a[168:171], v2 offset:26624
v_cvt_pk_bf16_f32 v209, v162, v163
v_mfma_f32_16x16x32_bf16 v[136:139], a[128:131], v[48:51], v[136:139]
v_exp_f32 v176, v176
v_mfma_f32_16x16x32_bf16 v[140:143], a[128:131], v[64:67], v[92:95]
v_exp_f32 v177, v177
v_mfma_f32_16x16x32_bf16 v[140:143], a[132:135], v[68:71], v[140:143]
ds_read_b128 a[172:175], v2 offset:27648
v_cvt_pk_bf16_f32 v210, v176, v177
v_mfma_f32_16x16x32_bf16 v[140:143], a[136:139], v[72:75], v[140:143]
v_exp_f32 v178, v178
v_mfma_f32_16x16x32_bf16 v[140:143], a[140:143], v[76:79], v[140:143]
buffer_load_dwordx4 v1, s[44:47], s72 offen offset:1024 sc1 lds
v_mfma_f32_16x16x32_bf16 v[156:159], a[156:159], v[76:79], v[92:95]
v_exp_f32 v179, v179
v_mfma_f32_16x16x32_bf16 v[156:159], a[152:155], v[72:75], v[156:159]
ds_read_b128 a[176:179], v2 offset:28672
v_cvt_pk_bf16_f32 v211, v178, v179
v_mfma_f32_16x16x32_bf16 v[156:159], a[148:151], v[68:71], v[156:159]
v_exp_f32 v164, v164
v_mfma_f32_16x16x32_bf16 v[156:159], a[144:147], v[64:67], v[156:159]
v_exp_f32 v165, v165
v_mfma_f32_16x16x32_bf16 v[152:155], a[144:147], v[48:51], v[88:91]
ds_read_b128 a[180:183], v2 offset:29696
v_cvt_pk_bf16_f32 v212, v164, v165
v_mfma_f32_16x16x32_bf16 v[152:155], a[148:151], v[52:55], v[152:155]
v_exp_f32 v166, v166
v_mfma_f32_16x16x32_bf16 v[152:155], a[152:155], v[56:59], v[152:155]
buffer_load_dwordx4 v1, s[44:47], s72 offen offset:2048 sc1 lds
v_mfma_f32_16x16x32_bf16 v[152:155], a[156:159], v[60:63], v[152:155]
v_exp_f32 v167, v167
v_mfma_f32_16x16x32_bf16 v[148:151], a[156:159], v[44:47], v[148:151]
ds_read_b128 a[184:187], v2 offset:30720
v_cvt_pk_bf16_f32 v213, v166, v167
v_mfma_f32_16x16x32_bf16 v[148:151], a[152:155], v[40:43], v[148:151]
v_exp_f32 v180, v180
v_mfma_f32_16x16x32_bf16 v[148:151], a[148:151], v[36:39], v[148:151]
s_waitcnt lgkmcnt(7)
v_exp_f32 v181, v181
v_mfma_f32_16x16x32_bf16 a[0:3], a[192:195], v[192:195], 0
ds_read_b128 a[188:191], v2 offset:31744
v_cvt_pk_bf16_f32 v214, v180, v181
v_mfma_f32_16x16x32_bf16 a[32:35], a[192:195], v[196:199], 0
v_exp_f32 v182, v182
v_mfma_f32_16x16x32_bf16 a[64:67], a[192:195], v[200:203], 0
buffer_load_dwordx4 v1, s[44:47], s72 offen offset:3072 sc1 lds
v_mfma_f32_16x16x32_bf16 a[96:99], a[192:195], v[204:207], 0
s_add_u32 s66, s58, 1
v_exp_f32 v183, v183
v_mfma_f32_16x16x32_bf16 a[100:103], a[196:199], v[204:207], 0
s_and_b32 s66, s66, 3
ds_read_b128 a[224:227], v2 offset:8192
v_cvt_pk_bf16_f32 v215, v182, v183
v_mfma_f32_16x16x32_bf16 a[68:71], a[196:199], v[200:203], 0
s_mul_i32 s66, s66, 4160
v_exp_f32 v168, v168
v_mfma_f32_16x16x32_bf16 a[36:39], a[196:199], v[196:199], 0
s_add_u32 m0, s66, 131104
v_exp_f32 v169, v169
v_mfma_f32_16x16x32_bf16 a[4:7], a[196:199], v[192:195], 0
s_add_u32 s72, s93, 0x2
ds_read_b128 a[228:231], v2 offset:9216
v_cvt_pk_bf16_f32 v216, v168, v169
v_mfma_f32_16x16x32_bf16 a[8:11], a[200:203], v[192:195], 0
v_exp_f32 v170, v170
v_mfma_f32_16x16x32_bf16 a[40:43], a[200:203], v[196:199], 0
buffer_load_dwordx4 v1, s[36:39], s72 offen lds
v_mfma_f32_16x16x32_bf16 a[72:75], a[200:203], v[200:203], 0
v_exp_f32 v171, v171
v_mfma_f32_16x16x32_bf16 a[104:107], a[200:203], v[204:207], 0
ds_read_b128 a[232:235], v2 offset:10240
v_cvt_pk_bf16_f32 v217, v170, v171
v_mfma_f32_16x16x32_bf16 a[108:111], a[204:207], v[204:207], 0
v_exp_f32 v184, v184
v_mfma_f32_16x16x32_bf16 a[76:79], a[204:207], v[200:203], 0
v_exp_f32 v185, v185
v_mfma_f32_16x16x32_bf16 a[44:47], a[204:207], v[196:199], 0
ds_read_b128 a[236:239], v2 offset:11264
v_cvt_pk_bf16_f32 v218, v184, v185
v_mfma_f32_16x16x32_bf16 a[12:15], a[204:207], v[192:195], 0
v_exp_f32 v186, v186
v_mfma_f32_16x16x32_bf16 a[16:19], a[208:211], v[192:195], 0
buffer_load_dwordx4 v1, s[36:39], s72 offen offset:1024 lds
v_mfma_f32_16x16x32_bf16 a[48:51], a[208:211], v[196:199], 0
v_exp_f32 v187, v187
v_mfma_f32_16x16x32_bf16 a[80:83], a[208:211], v[200:203], 0
ds_read_b128 a[240:243], v2 offset:12288
v_cvt_pk_bf16_f32 v219, v186, v187
v_mfma_f32_16x16x32_bf16 a[112:115], a[208:211], v[204:207], 0
v_exp_f32 v172, v172
v_mfma_f32_16x16x32_bf16 a[116:119], a[212:215], v[204:207], 0
v_exp_f32 v173, v173
v_mfma_f32_16x16x32_bf16 a[84:87], a[212:215], v[200:203], 0
ds_read_b128 a[244:247], v2 offset:13312
v_cvt_pk_bf16_f32 v220, v172, v173
v_mfma_f32_16x16x32_bf16 a[52:55], a[212:215], v[196:199], 0
buffer_load_dwordx4 v1, s[36:39], s72 offen offset:2048 lds
v_mfma_f32_16x16x32_bf16 a[20:23], a[212:215], v[192:195], 0
v_exp_f32 v174, v174
v_mfma_f32_16x16x32_bf16 a[24:27], a[216:219], v[192:195], 0
v_exp_f32 v175, v175
v_mfma_f32_16x16x32_bf16 a[56:59], a[216:219], v[196:199], 0
ds_read_b128 a[248:251], v2 offset:14336
v_cvt_pk_bf16_f32 v221, v174, v175
v_mfma_f32_16x16x32_bf16 a[88:91], a[216:219], v[200:203], 0
v_exp_f32 v188, v188
v_mfma_f32_16x16x32_bf16 a[120:123], a[216:219], v[204:207], 0
v_exp_f32 v189, v189
v_mfma_f32_16x16x32_bf16 a[124:127], a[220:223], v[204:207], 0
ds_read_b128 a[252:255], v2 offset:15360
v_cvt_pk_bf16_f32 v222, v188, v189
v_mfma_f32_16x16x32_bf16 a[92:95], a[220:223], v[200:203], 0
buffer_load_dwordx4 v1, s[36:39], s72 offen offset:3072 lds
v_mfma_f32_16x16x32_bf16 a[60:63], a[220:223], v[196:199], 0
v_exp_f32 v190, v190
v_mfma_f32_16x16x32_bf16 a[28:31], a[220:223], v[192:195], 0
v_exp_f32 v191, v191
v_mfma_f32_16x16x32_bf16 v[224:227], v[120:123], v[192:195], 0
v_cvt_pk_bf16_f32 v223, v190, v191
v_add_u32 v2, s82, v1
v_mfma_f32_16x16x32_bf16 v[228:231], v[120:123], v[196:199], 0
v_and_b32 v240, 15, v0
v_lshrrev_b32 v241, 4, v0
v_mfma_f32_16x16x32_bf16 v[232:235], v[120:123], v[200:203], 0
s_waitcnt vmcnt(12) lgkmcnt(8)
v_mfma_f32_16x16x32_bf16 v[236:239], v[120:123], v[204:207], 0
s_barrier
v_add_u32 v248, 1, v240
v_and_b32 v249, 3, v248
v_lshrrev_b32 v248, 2, v248
v_mov_b32 v250, 0x20000
v_mov_b32 v252, 0x20001
v_lshlrev_b32 v6, 3, v249
v_lshrrev_b32 v6, v6, v252
v_and_b32 v6, 3, v6
v_cmp_ne_u32 vcc, 1, v249
v_mul_u32_u24 v6, 16640, v6
v_add_u32 v6, s92, v6
v_cndmask_b32 v6, v250, v6, vcc
v_add_u32 v253, s58, v249
v_and_b32 v253, 3, v253
v_mul_u32_u24 v253, 4160, v253
v_add_u32 v6, v6, v253
s_branch LLT3
.p2align 12
s_endpgm
.p2align 7
LLT3x:
Lstub11:
s_cbranch_execz Lret
s_cmp_eq_u32 s58, 2
s_cbranch_scc1 Lta40
s_cmp_eq_u32 s58, 3
s_cbranch_scc1 Lnt41
v_mfma_f32_16x16x32_bf16 v[164:167], a[160:163], v[32:35], v[112:115]
s_xor_b32 s74, s82, 0x10000
ds_read_b128 a[128:131], v2 offset:16384
v_mfma_f32_16x16x32_bf16 v[180:183], a[176:179], v[32:35], v[112:115]
s_add_u32 s74, s74, s64
v_exp_f32 v132, v132
s_branch Ljoin42
Lta40:
v_mfma_f32_16x16x32_bf16 v[164:167], a[160:163], v[32:35], v[100:103]
s_xor_b32 s74, s82, 0x10000
ds_read_b128 a[128:131], v2 offset:16384
v_mfma_f32_16x16x32_bf16 v[180:183], a[176:179], v[32:35], v[112:115]
s_add_u32 s74, s74, s64
v_exp_f32 v132, v132
s_branch Ljoin42
Lnt41:
v_mfma_f32_16x16x32_bf16 v[164:167], a[160:163], v[32:35], v[84:87]
s_xor_b32 s74, s82, 0x10000
ds_read_b128 a[128:131], v2 offset:16384
v_mfma_f32_16x16x32_bf16 v[180:183], a[176:179], v[32:35], v[100:103]
s_add_u32 s74, s74, s64
v_exp_f32 v132, v132
Ljoin42:
v_mfma_f32_16x16x32_bf16 v[164:167], a[164:167], v[36:39], v[164:167]
s_add_u32 s81, s81, 0x8000
v_exp_f32 v133, v133
v_mfma_f32_16x16x32_bf16 v[164:167], a[168:171], v[40:43], v[164:167]
s_add_u32 m0, s74, 0
ds_read_b128 a[132:135], v2 offset:17408
v_cvt_pk_bf16_f32 v196, v132, v133
v_mfma_f32_16x16x32_bf16 v[164:167], a[172:175], v[44:47], v[164:167]
s_add_u32 s72, s81, 0
v_exp_f32 v134, v134
v_mfma_f32_16x16x32_bf16 v[168:171], a[172:175], v[60:63], v[88:91]
ds_read_b128 a[136:139], v2 offset:18432
v_bfe_u32 v251, v0, 2, 2
v_mfma_f32_16x16x32_bf16 v[168:171], a[168:171], v[56:59], v[168:171]
v_exp_f32 v135, v135
v_mfma_f32_16x16x32_bf16 v[168:171], a[164:167], v[52:55], v[168:171]
buffer_load_dwordx4 v1, s[44:47], s72 offen sc1 lds
v_mfma_f32_16x16x32_bf16 v[168:171], a[160:163], v[48:51], v[168:171]
v_exp_f32 v148, v148
v_mfma_f32_16x16x32_bf16 v[172:175], a[160:163], v[64:67], v[92:95]
ds_read_b128 a[140:143], v2 offset:19456
v_cvt_pk_bf16_f32 v197, v134, v135
v_mfma_f32_16x16x32_bf16 v[172:175], a[164:167], v[68:71], v[172:175]
v_exp_f32 v149, v149
v_mfma_f32_16x16x32_bf16 v[172:175], a[168:171], v[72:75], v[172:175]
ds_read_b128 a[144:147], v2 offset:20480
v_cvt_pk_bf16_f32 v198, v148, v149
v_mfma_f32_16x16x32_bf16 v[172:175], a[172:175], v[76:79], v[172:175]
v_exp_f32 v150, v150
v_mfma_f32_16x16x32_bf16 v[188:191], a[188:191], v[76:79], v[92:95]
v_exp_f32 v151, v151
v_mfma_f32_16x16x32_bf16 v[188:191], a[184:187], v[72:75], v[188:191]
ds_read_b128 a[148:151], v2 offset:21504
v_cvt_pk_bf16_f32 v199, v150, v151
v_mfma_f32_16x16x32_bf16 v[188:191], a[180:183], v[68:71], v[188:191]
v_exp_f32 v136, v136
v_mfma_f32_16x16x32_bf16 v[188:191], a[176:179], v[64:67], v[188:191]
ds_read_b128 a[152:155], v2 offset:22528
v_lshl_add_u32 v6, v248, 3, v6
v_mfma_f32_16x16x32_bf16 v[184:187], a[176:179], v[48:51], v[88:91]
v_exp_f32 v137, v137
v_mfma_f32_16x16x32_bf16 v[184:187], a[180:183], v[52:55], v[184:187]
buffer_load_dwordx4 v1, s[44:47], s72 offen offset:1024 sc1 lds
v_mfma_f32_16x16x32_bf16 v[184:187], a[184:187], v[56:59], v[184:187]
v_exp_f32 v138, v138
v_mfma_f32_16x16x32_bf16 v[184:187], a[188:191], v[60:63], v[184:187]
ds_read_b128 a[156:159], v2 offset:23552
v_cvt_pk_bf16_f32 v200, v136, v137
v_mfma_f32_16x16x32_bf16 v[180:183], a[188:191], v[44:47], v[180:183]
v_exp_f32 v139, v139
v_mfma_f32_16x16x32_bf16 v[180:183], a[184:187], v[40:43], v[180:183]
ds_read_b128 a[192:195], v2 offset:0
v_cvt_pk_bf16_f32 v201, v138, v139
v_mfma_f32_16x16x32_bf16 v[180:183], a[180:183], v[36:39], v[180:183]
s_waitcnt lgkmcnt(9)
v_exp_f32 v152, v152
v_mfma_f32_16x16x32_bf16 a[0:3], a[224:227], v[208:211], a[0:3]
v_exp_f32 v153, v153
v_mfma_f32_16x16x32_bf16 a[32:35], a[224:227], v[212:215], a[32:35]
ds_read_b128 a[196:199], v2 offset:1024
v_cvt_pk_bf16_f32 v202, v152, v153
v_mfma_f32_16x16x32_bf16 a[64:67], a[224:227], v[216:219], a[64:67]
v_exp_f32 v154, v154
v_mfma_f32_16x16x32_bf16 a[96:99], a[224:227], v[220:223], a[96:99]
ds_read_b128 a[200:203], v2 offset:2048
v_lshl_add_u32 v6, v241, 4, v6
v_mfma_f32_16x16x32_bf16 a[100:103], a[228:231], v[220:223], a[100:103]
v_exp_f32 v155, v155
v_mfma_f32_16x16x32_bf16 a[68:71], a[228:231], v[216:219], a[68:71]
buffer_load_dwordx4 v1, s[44:47], s72 offen offset:2048 sc1 lds
v_mfma_f32_16x16x32_bf16 a[36:39], a[228:231], v[212:215], a[36:39]
v_exp_f32 v140, v140
v_mfma_f32_16x16x32_bf16 a[4:7], a[228:231], v[208:211], a[4:7]
ds_read_b128 a[204:207], v2 offset:3072
v_cvt_pk_bf16_f32 v203, v154, v155
v_mfma_f32_16x16x32_bf16 a[8:11], a[232:235], v[208:211], a[8:11]
v_exp_f32 v141, v141
v_mfma_f32_16x16x32_bf16 a[40:43], a[232:235], v[212:215], a[40:43]
ds_read_b128 a[208:211], v2 offset:4096
v_cvt_pk_bf16_f32 v204, v140, v141
v_mfma_f32_16x16x32_bf16 a[72:75], a[232:235], v[216:219], a[72:75]
v_exp_f32 v142, v142
v_mfma_f32_16x16x32_bf16 a[104:107], a[232:235], v[220:223], a[104:107]
v_exp_f32 v143, v143
v_mfma_f32_16x16x32_bf16 a[108:111], a[236:239], v[220:223], a[108:111]
ds_read_b128 a[212:215], v2 offset:5120
v_cvt_pk_bf16_f32 v205, v142, v143
v_mfma_f32_16x16x32_bf16 a[76:79], a[236:239], v[216:219], a[76:79]
v_exp_f32 v156, v156
v_mfma_f32_16x16x32_bf16 a[44:47], a[236:239], v[212:215], a[44:47]
ds_read_b128 a[216:219], v2 offset:6144
v_lshlrev_b32 v5, 3, v251
v_mfma_f32_16x16x32_bf16 a[12:15], a[236:239], v[208:211], a[12:15]
v_exp_f32 v157, v157
v_mfma_f32_16x16x32_bf16 a[16:19], a[240:243], v[208:211], a[16:19]
buffer_load_dwordx4 v1, s[44:47], s72 offen offset:3072 sc1 lds
v_mfma_f32_16x16x32_bf16 a[48:51], a[240:243], v[212:215], a[48:51]
v_exp_f32 v158, v158
v_mfma_f32_16x16x32_bf16 a[80:83], a[240:243], v[216:219], a[80:83]
ds_read_b128 a[220:223], v2 offset:7168
v_cvt_pk_bf16_f32 v206, v156, v157
v_mfma_f32_16x16x32_bf16 a[112:115], a[240:243], v[220:223], a[112:115]
v_exp_f32 v159, v159
v_mfma_f32_16x16x32_bf16 a[116:119], a[244:247], v[220:223], a[116:119]
v_cvt_pk_bf16_f32 v207, v158, v159
v_lshrrev_b32 v5, v5, v252
v_mfma_f32_16x16x32_bf16 a[84:87], a[244:247], v[216:219], a[84:87]
v_and_b32 v5, 3, v5
v_cmp_ne_u32 vcc, 1, v251
v_mfma_f32_16x16x32_bf16 a[52:55], a[244:247], v[212:215], a[52:55]
v_mul_u32_u24 v5, 16640, v5
v_add_u32 v5, s92, v5
v_mfma_f32_16x16x32_bf16 a[20:23], a[244:247], v[208:211], a[20:23]
v_cndmask_b32 v5, v250, v5, vcc
v_add_u32 v253, s58, v251
v_mfma_f32_16x16x32_bf16 a[24:27], a[248:251], v[208:211], a[24:27]
v_and_b32 v253, 3, v253
v_mul_u32_u24 v253, 4160, v253
v_mfma_f32_16x16x32_bf16 a[56:59], a[248:251], v[212:215], a[56:59]
v_add_u32 v5, v5, v253
v_mfma_f32_16x16x32_bf16 a[88:91], a[248:251], v[216:219], a[88:91]
s_add_u32 s73, s62, 480
v_lshlrev_b32 v248, 5, v240
v_sub_u32 v248, s73, v248
v_mfma_f32_16x16x32_bf16 a[120:123], a[248:251], v[220:223], a[120:123]
v_lshl_add_u32 v7, v241, 4, v248
v_mfma_f32_16x16x32_bf16 a[124:127], a[252:255], v[220:223], a[124:127]
s_and_b32 s73, s58, 1
v_mfma_f32_16x16x32_bf16 a[92:95], a[252:255], v[216:219], a[92:95]
s_lshl_b32 s73, s73, 4
v_mfma_f32_16x16x32_bf16 a[60:63], a[252:255], v[212:215], a[60:63]
s_lshr_b32 s73, s90, s73
v_mfma_f32_16x16x32_bf16 a[28:31], a[252:255], v[208:211], a[28:31]
s_and_b32 s73, s73, 0xffff
v_lshl_add_u32 v248, v241, 3, v240
v_sub_u32 v248, 15, v248
v_mfma_f32_16x16x32_bf16 v[224:227], v[120:123], v[208:211], v[224:227]
v_and_b32 v249, 1, v248
v_lshlrev_b32 v249, 4, v249
v_mfma_f32_16x16x32_bf16 v[228:231], v[120:123], v[212:215], v[228:231]
v_lshlrev_b32 v249, v249, s73
v_lshrrev_b32 v248, 1, v248
v_mfma_f32_16x16x32_bf16 v[232:235], v[120:123], v[216:219], v[232:235]
s_waitcnt lgkmcnt(8)
v_mfma_f32_16x16x32_bf16 v[236:239], v[120:123], v[220:223], v[236:239]
s_barrier
s_lshr_b32 s69, s93, 4
s_and_b32 s69, s69, 0x7f00
s_add_u32 s69, s69, LHT4-Lpc0
v_lshrrev_b32 v3, 5, v0
v_lshlrev_b32 v3, 7, v3
v_add_u32 v3, s69, v3
v_min_u32 v3, Lcode_end-Lpc0, v3
global_load_dword v4, v3, s[98:99]
s_cmp_eq_u32 s58, 0
s_cbranch_scc1 Lta43
s_cmp_eq_u32 s58, 1
s_cbranch_scc1 Lnt44
v_mfma_f32_16x16x32_bf16 v[136:139], a[128:131], v[48:51], v[88:91]
s_add_u32 s82, s82, 0x8000
ds_read_b128 a[160:163], v2 offset:24576
ds_read_b128 a[164:167], v2 offset:25600
v_mfma_f32_16x16x32_bf16 v[152:155], a[144:147], v[48:51], v[88:91]
s_and_b32 s82, s82, 0x1ffff
v_exp_f32 v164, v164
s_branch Ljoin45
Lta43:
v_mfma_f32_16x16x32_bf16 v[136:139], a[128:131], v[48:51], v[104:107]
s_add_u32 s82, s82, 0x8000
ds_read_b128 a[160:163], v2 offset:24576
ds_read_b128 a[164:167], v2 offset:25600
v_mfma_f32_16x16x32_bf16 v[152:155], a[144:147], v[48:51], v[112:115]
s_and_b32 s82, s82, 0x1ffff
v_exp_f32 v164, v164
s_branch Ljoin45
Lnt44:
v_mfma_f32_16x16x32_bf16 v[136:139], a[128:131], v[48:51], v[88:91]
s_add_u32 s82, s82, 0x8000
ds_read_b128 a[160:163], v2 offset:24576
ds_read_b128 a[164:167], v2 offset:25600
v_mfma_f32_16x16x32_bf16 v[152:155], a[144:147], v[48:51], v[104:107]
s_and_b32 s82, s82, 0x1ffff
v_exp_f32 v164, v164
Ljoin45:
v_mfma_f32_16x16x32_bf16 v[136:139], a[132:135], v[52:55], v[136:139]
s_add_u32 s66, s58, 3
v_exp_f32 v165, v165
v_mfma_f32_16x16x32_bf16 v[136:139], a[136:139], v[56:59], v[136:139]
s_and_b32 s66, s66, 3
v_exp_f32 v166, v166
v_mfma_f32_16x16x32_bf16 v[136:139], a[140:143], v[60:63], v[136:139]
s_mul_i32 s66, s66, 4160
ds_read_b128 a[168:171], v2 offset:26624
v_cvt_pk_bf16_f32 v212, v164, v165
v_mfma_f32_16x16x32_bf16 v[140:143], a[140:143], v[76:79], v[92:95]
s_add_u32 s66, s66, s92
v_exp_f32 v167, v167
v_mfma_f32_16x16x32_bf16 v[140:143], a[136:139], v[72:75], v[140:143]
s_add_u32 m0, s66, 32
v_exp_f32 v180, v180
v_mfma_f32_16x16x32_bf16 v[140:143], a[132:135], v[68:71], v[140:143]
s_add_u32 s72, s93, 0x6
buffer_load_dwordx4 v1, s[36:39], s72 offen lds
v_mfma_f32_16x16x32_bf16 v[140:143], a[128:131], v[64:67], v[140:143]
ds_read_b128 a[172:175], v2 offset:27648
v_cvt_pk_bf16_f32 v213, v166, v167
v_mfma_f32_16x16x32_bf16 v[156:159], a[144:147], v[64:67], v[92:95]
v_exp_f32 v181, v181
v_mfma_f32_16x16x32_bf16 v[156:159], a[148:151], v[68:71], v[156:159]
ds_read_b128 a[176:179], v2 offset:28672
v_cvt_pk_bf16_f32 v214, v180, v181
v_mfma_f32_16x16x32_bf16 v[156:159], a[152:155], v[72:75], v[156:159]
v_exp_f32 v182, v182
v_mfma_f32_16x16x32_bf16 v[156:159], a[156:159], v[76:79], v[156:159]
v_exp_f32 v183, v183
v_mfma_f32_16x16x32_bf16 v[152:155], a[156:159], v[60:63], v[152:155]
ds_read_b128 a[180:183], v2 offset:29696
v_cvt_pk_bf16_f32 v215, v182, v183
v_mfma_f32_16x16x32_bf16 v[152:155], a[152:155], v[56:59], v[152:155]
v_exp_f32 v168, v168
v_mfma_f32_16x16x32_bf16 v[152:155], a[148:151], v[52:55], v[152:155]
s_waitcnt lgkmcnt(6)
ds_read_b128 a[184:187], v2 offset:30720
ds_read_b128 a[188:191], v2 offset:31744
v_mfma_f32_16x16x32_bf16 a[32:35], a[192:195], v[196:199], a[32:35]
v_exp_f32 v169, v169
v_mfma_f32_16x16x32_bf16 a[64:67], a[192:195], v[200:203], a[64:67]
buffer_load_dwordx4 v1, s[36:39], s72 offen offset:1024 lds
v_mfma_f32_16x16x32_bf16 a[96:99], a[192:195], v[204:207], a[96:99]
v_exp_f32 v170, v170
v_mfma_f32_16x16x32_bf16 a[100:103], a[196:199], v[204:207], a[100:103]
v_exp_f32 v171, v171
v_mfma_f32_16x16x32_bf16 a[68:71], a[196:199], v[200:203], a[68:71]
ds_read_b128 a[224:227], v2 offset:8192
v_cvt_pk_bf16_f32 v216, v168, v169
v_mfma_f32_16x16x32_bf16 a[36:39], a[196:199], v[196:199], a[36:39]
v_exp_f32 v184, v184
v_mfma_f32_16x16x32_bf16 a[40:43], a[200:203], v[196:199], a[40:43]
v_exp_f32 v185, v185
v_mfma_f32_16x16x32_bf16 a[72:75], a[200:203], v[200:203], a[72:75]
ds_read_b128 a[228:231], v2 offset:9216
v_cvt_pk_bf16_f32 v217, v170, v171
v_mfma_f32_16x16x32_bf16 a[104:107], a[200:203], v[204:207], a[104:107]
v_exp_f32 v186, v186
v_mfma_f32_16x16x32_bf16 a[108:111], a[204:207], v[204:207], a[108:111]
ds_read_b128 a[232:235], v2 offset:10240
v_cvt_pk_bf16_f32 v218, v184, v185
v_mfma_f32_16x16x32_bf16 a[76:79], a[204:207], v[200:203], a[76:79]
v_exp_f32 v187, v187
v_mfma_f32_16x16x32_bf16 a[44:47], a[204:207], v[196:199], a[44:47]
buffer_load_dwordx4 v1, s[36:39], s72 offen offset:2048 lds
v_mfma_f32_16x16x32_bf16 a[48:51], a[208:211], v[196:199], a[48:51]
v_exp_f32 v172, v172
v_mfma_f32_16x16x32_bf16 a[80:83], a[208:211], v[200:203], a[80:83]
ds_read_b128 a[236:239], v2 offset:11264
v_cvt_pk_bf16_f32 v219, v186, v187
v_mfma_f32_16x16x32_bf16 a[112:115], a[208:211], v[204:207], a[112:115]
v_exp_f32 v173, v173
v_mfma_f32_16x16x32_bf16 a[116:119], a[212:215], v[204:207], a[116:119]
ds_read_b128 a[240:243], v2 offset:12288
v_cvt_pk_bf16_f32 v220, v172, v173
v_mfma_f32_16x16x32_bf16 a[84:87], a[212:215], v[200:203], a[84:87]
v_exp_f32 v174, v174
v_mfma_f32_16x16x32_bf16 a[52:55], a[212:215], v[196:199], a[52:55]
v_exp_f32 v175, v175
v_mfma_f32_16x16x32_bf16 a[56:59], a[216:219], v[196:199], a[56:59]
ds_read_b128 a[244:247], v2 offset:13312
v_cvt_pk_bf16_f32 v221, v174, v175
v_mfma_f32_16x16x32_bf16 a[88:91], a[216:219], v[200:203], a[88:91]
v_exp_f32 v188, v188
v_mfma_f32_16x16x32_bf16 a[120:123], a[216:219], v[204:207], a[120:123]
ds_read_b128 a[248:251], v2 offset:14336
v_mfma_f32_16x16x32_bf16 a[124:127], a[220:223], v[204:207], a[124:127]
v_exp_f32 v189, v189
v_mfma_f32_16x16x32_bf16 a[92:95], a[220:223], v[200:203], a[92:95]
buffer_load_dwordx4 v1, s[36:39], s72 offen offset:3072 lds
v_mfma_f32_16x16x32_bf16 a[60:63], a[220:223], v[196:199], a[60:63]
ds_read_b128 a[252:255], v2 offset:15360
v_cvt_pk_bf16_f32 v222, v188, v189
v_mfma_f32_16x16x32_bf16 v[228:231], v[120:123], v[196:199], v[228:231]
v_exp_f32 v190, v190
v_mfma_f32_16x16x32_bf16 v[232:235], v[120:123], v[200:203], v[232:235]
s_waitcnt vmcnt(9) lgkmcnt(0)
v_exp_f32 v191, v191
v_mfma_f32_16x16x32_bf16 v[236:239], v[120:123], v[204:207], v[236:239]
s_barrier
v_cvt_pk_bf16_f32 v223, v190, v191
v_add_u32 v2, s82, v1
s_cmp_eq_u32 s58, 2
s_cbranch_scc1 Lta46
s_cmp_eq_u32 s58, 3
s_cbranch_scc1 Lnt47
v_mfma_f32_16x16x32_bf16 v[168:171], a[160:163], v[48:51], v[112:115]
s_mov_b32 m0, s62
v_exp_f32 v136, v136
v_mfma_f32_16x16x32_bf16 v[184:187], a[176:179], v[48:51], v[112:115]
s_add_u32 s72, s93, 0x3000000
ds_read_b128 a[128:131], v2 offset:16384
s_branch Ljoin48
Lta46:
v_mfma_f32_16x16x32_bf16 v[168:171], a[160:163], v[48:51], v[104:107]
s_mov_b32 m0, s62
v_exp_f32 v136, v136
v_mfma_f32_16x16x32_bf16 v[184:187], a[176:179], v[48:51], v[112:115]
s_add_u32 s72, s93, 0x3000000
ds_read_b128 a[128:131], v2 offset:16384
s_branch Ljoin48
Lnt47:
v_mfma_f32_16x16x32_bf16 v[168:171], a[160:163], v[48:51], v[88:91]
s_mov_b32 m0, s62
v_exp_f32 v136, v136
v_mfma_f32_16x16x32_bf16 v[184:187], a[176:179], v[48:51], v[104:107]
s_add_u32 s72, s93, 0x3000000
ds_read_b128 a[128:131], v2 offset:16384
Ljoin48:
v_mfma_f32_16x16x32_bf16 v[168:171], a[164:167], v[52:55], v[168:171]
buffer_load_dwordx4 v1, s[44:47], s72 offen sc1 lds
v_mfma_f32_16x16x32_bf16 v[168:171], a[168:171], v[56:59], v[168:171]
v_exp_f32 v137, v137
v_mfma_f32_16x16x32_bf16 v[168:171], a[172:175], v[60:63], v[168:171]
ds_read_b128 a[132:135], v2 offset:17408
v_cvt_pk_bf16_f32 v200, v136, v137
v_mfma_f32_16x16x32_bf16 v[172:175], a[172:175], v[76:79], v[92:95]
v_exp_f32 v138, v138
v_mfma_f32_16x16x32_bf16 v[172:175], a[168:171], v[72:75], v[172:175]
ds_read_b128 a[136:139], v2 offset:18432
v_and_b32 v241, 3, v0
v_mfma_f32_16x16x32_bf16 v[172:175], a[164:167], v[68:71], v[172:175]
buffer_load_dwordx4 v1, s[44:47], s72 offen offset:1024 sc1 lds
v_mfma_f32_16x16x32_bf16 v[172:175], a[160:163], v[64:67], v[172:175]
v_exp_f32 v139, v139
v_mfma_f32_16x16x32_bf16 v[188:191], a[176:179], v[64:67], v[92:95]
ds_read_b128 a[140:143], v2 offset:19456
v_cvt_pk_bf16_f32 v201, v138, v139
v_mfma_f32_16x16x32_bf16 v[188:191], a[180:183], v[68:71], v[188:191]
v_exp_f32 v152, v152
v_mfma_f32_16x16x32_bf16 v[188:191], a[184:187], v[72:75], v[188:191]
ds_read_b128 a[144:147], v2 offset:20480
v_cmp_eq_u32 vcc, 0, v248
v_mfma_f32_16x16x32_bf16 v[188:191], a[188:191], v[76:79], v[188:191]
buffer_load_dwordx4 v1, s[44:47], s72 offen offset:2048 sc1 lds
v_mfma_f32_16x16x32_bf16 v[184:187], a[188:191], v[60:63], v[184:187]
v_exp_f32 v153, v153
v_mfma_f32_16x16x32_bf16 v[184:187], a[184:187], v[56:59], v[184:187]
ds_read_b128 a[148:151], v2 offset:21504
v_cvt_pk_bf16_f32 v202, v152, v153
v_mfma_f32_16x16x32_bf16 v[184:187], a[180:183], v[52:55], v[184:187]
s_waitcnt lgkmcnt(6)
buffer_load_dwordx4 v1, s[44:47], s72 offen offset:3072 sc1 lds
v_mfma_f32_16x16x32_bf16 a[32:35], a[224:227], v[212:215], a[32:35]
s_add_u32 s66, s58, 0
v_exp_f32 v154, v154
v_mfma_f32_16x16x32_bf16 a[64:67], a[224:227], v[216:219], a[64:67]
s_and_b32 s66, s66, 3
ds_read_b128 a[152:155], v2 offset:22528
v_lshl_add_u32 v5, v241, 3, v5
v_mfma_f32_16x16x32_bf16 a[96:99], a[224:227], v[220:223], a[96:99]
s_mul_i32 s66, s66, 4160
v_exp_f32 v155, v155
v_mfma_f32_16x16x32_bf16 a[100:103], a[228:231], v[220:223], a[100:103]
s_add_u32 s66, s66, s92
ds_read_b128 a[156:159], v2 offset:23552
v_cvt_pk_bf16_f32 v203, v154, v155
v_mfma_f32_16x16x32_bf16 a[68:71], a[228:231], v[216:219], a[68:71]
s_add_u32 m0, s66, 16672
v_exp_f32 v140, v140
v_mfma_f32_16x16x32_bf16 a[36:39], a[228:231], v[212:215], a[36:39]
s_add_u32 s72, s93, 0x0
buffer_load_dwordx4 v1, s[36:39], s72 offen lds
v_mfma_f32_16x16x32_bf16 a[40:43], a[232:235], v[212:215], a[40:43]
ds_read_b128 a[192:195], v2 offset:0
v_cndmask_b32 v8, 0, v249, vcc
v_mfma_f32_16x16x32_bf16 a[72:75], a[232:235], v[216:219], a[72:75]
buffer_load_dwordx4 v1, s[36:39], s72 offen offset:1024 lds
v_mfma_f32_16x16x32_bf16 a[104:107], a[232:235], v[220:223], a[104:107]
v_exp_f32 v141, v141
v_mfma_f32_16x16x32_bf16 a[108:111], a[236:239], v[220:223], a[108:111]
ds_read_b128 a[196:199], v2 offset:1024
v_cvt_pk_bf16_f32 v204, v140, v141
v_mfma_f32_16x16x32_bf16 a[76:79], a[236:239], v[216:219], a[76:79]
v_exp_f32 v142, v142
v_mfma_f32_16x16x32_bf16 a[44:47], a[236:239], v[212:215], a[44:47]
ds_read_b128 a[200:203], v2 offset:2048
v_cmp_eq_u32 vcc, 1, v248
v_mfma_f32_16x16x32_bf16 a[48:51], a[240:243], v[212:215], a[48:51]
buffer_load_dwordx4 v1, s[36:39], s72 offen offset:2048 lds
v_mfma_f32_16x16x32_bf16 a[80:83], a[240:243], v[216:219], a[80:83]
v_exp_f32 v143, v143
v_mfma_f32_16x16x32_bf16 a[112:115], a[240:243], v[220:223], a[112:115]
ds_read_b128 a[204:207], v2 offset:3072
v_cvt_pk_bf16_f32 v205, v142, v143
v_mfma_f32_16x16x32_bf16 a[116:119], a[244:247], v[220:223], a[116:119]
v_exp_f32 v156, v156
v_mfma_f32_16x16x32_bf16 a[84:87], a[244:247], v[216:219], a[84:87]
ds_read_b128 a[208:211], v2 offset:4096
v_lshlrev_b32 v240, 4, v251
v_mfma_f32_16x16x32_bf16 a[52:55], a[244:247], v[212:215], a[52:55]
buffer_load_dwordx4 v1, s[36:39], s72 offen offset:3072 lds
v_mfma_f32_16x16x32_bf16 a[56:59], a[248:251], v[212:215], a[56:59]
s_add_u32 s66, s58, 2
v_exp_f32 v157, v157
v_mfma_f32_16x16x32_bf16 a[88:91], a[248:251], v[216:219], a[88:91]
s_and_b32 s66, s66, 3
ds_read_b128 a[212:215], v2 offset:5120
v_cvt_pk_bf16_f32 v206, v156, v157
v_mfma_f32_16x16x32_bf16 a[120:123], a[248:251], v[220:223], a[120:123]
s_mul_i32 s66, s66, 4160
v_exp_f32 v158, v158
v_mfma_f32_16x16x32_bf16 a[124:127], a[252:255], v[220:223], a[124:127]
s_add_u32 s66, s66, s92
ds_read_b128 a[216:219], v2 offset:6144
v_cndmask_b32 v9, 0, v249, vcc
v_mfma_f32_16x16x32_bf16 a[92:95], a[252:255], v[216:219], a[92:95]
s_add_u32 m0, s66, 33312
v_exp_f32 v159, v159
v_mfma_f32_16x16x32_bf16 a[60:63], a[252:255], v[212:215], a[60:63]
s_add_u32 s72, s93, 0x4
buffer_load_dwordx4 v1, s[36:39], s72 offen lds
v_mfma_f32_16x16x32_bf16 v[228:231], v[120:123], v[212:215], v[228:231]
ds_read_b128 a[220:223], v2 offset:7168
v_cvt_pk_bf16_f32 v207, v158, v159
v_mfma_f32_16x16x32_bf16 v[232:235], v[120:123], v[216:219], v[232:235]
buffer_load_dwordx4 v1, s[36:39], s72 offen offset:1024 lds
v_mfma_f32_16x16x32_bf16 v[236:239], v[120:123], v[220:223], v[236:239]
s_waitcnt lgkmcnt(8)
v_cmp_eq_u32 vcc, 2, v248
v_sub_u32 v240, 48, v240
v_lshlrev_b64 v[12:13], 16, s[88:89]
v_cndmask_b32 v10, 0, v249, vcc
v_cmp_eq_u32 vcc, 3, v248
v_lshlrev_b64 v[12:13], v240, v[12:13]
s_nop 0
v_cndmask_b32 v11, 0, v249, vcc
v_cmp_eq_u32 vcc, 3, v241
s_add_u32 s73, s62, 4096
v_lshl_add_u32 v14, v0, 3, s73
v_cndmask_b32 v12, 0, v12, vcc
v_cndmask_b32 v13, 0, v13, vcc
v_lshrrev_b32 v15, 4, v0
v_lshlrev_b32 v15, 1, v15
v_and_b32 v240, 7, v0
v_xor_b32 v15, v15, v240
v_lshlrev_b32 v15, 4, v15
v_lshrrev_b32 v240, 3, v0
v_lshl_add_u32 v15, v240, 11, v15
s_and_b32 s75, s59, 8
s_add_u32 s75, s75, s60
s_lshr_b32 s76, s59, 4
s_lshl_b32 s76, s76, 2
s_add_u32 s76, s76, s65
s_lshl_b32 s76, s76, 1
s_lshr_b32 s80, s59, 2
s_and_b32 s80, s80, 1
s_add_u32 s76, s76, s80
s_lshl_b32 s94, s58, 16
s_lshl_b32 s80, s76, 7
s_add_u32 s94, s94, s80
s_lshl_b32 s80, s75, 18
s_add_u32 s80, s80, s94
v_rcp_f32 v224, v224
v_rcp_f32 v228, v228
s_lshl_b32 s73, s59, 12
s_add_u32 s73, s73, 0x2000000
s_lshl_b32 s70, s67, 2
s_add_u32 s70, s70, s73
v_mov_b32 v225, v224
v_accvgpr_read_b32 v240, a0
v_accvgpr_read_b32 v241, a1
v_accvgpr_read_b32 v242, a2
v_accvgpr_read_b32 v243, a3
v_accvgpr_read_b32 v244, a4
v_accvgpr_read_b32 v245, a5
v_accvgpr_read_b32 v246, a6
v_accvgpr_read_b32 v247, a7
v_pk_mul_f32 v[240:241], v[240:241], v[224:225]
v_pk_mul_f32 v[242:243], v[242:243], v[224:225]
v_pk_mul_f32 v[244:245], v[244:245], v[224:225]
v_pk_mul_f32 v[246:247], v[246:247], v[224:225]
buffer_load_dwordx4 v1, s[36:39], s72 offen offset:2048 lds
v_cvt_pk_bf16_f32 v128, v240, v241
v_cvt_pk_bf16_f32 v129, v242, v243
v_cvt_pk_bf16_f32 v130, v244, v245
v_cvt_pk_bf16_f32 v131, v246, v247
v_accvgpr_read_b32 v248, a8
v_accvgpr_read_b32 v249, a9
v_accvgpr_read_b32 v250, a10
v_accvgpr_read_b32 v251, a11
v_accvgpr_read_b32 v252, a12
v_accvgpr_read_b32 v253, a13
v_accvgpr_read_b32 v254, a14
v_accvgpr_read_b32 v255, a15
v_pk_mul_f32 v[248:249], v[248:249], v[224:225]
v_pk_mul_f32 v[250:251], v[250:251], v[224:225]
v_pk_mul_f32 v[252:253], v[252:253], v[224:225]
v_pk_mul_f32 v[254:255], v[254:255], v[224:225]
v_cvt_pk_bf16_f32 v144, v248, v249
v_cvt_pk_bf16_f32 v145, v250, v251
buffer_load_dwordx4 v1, s[36:39], s72 offen offset:3072 lds
v_cvt_pk_bf16_f32 v146, v252, v253
v_cvt_pk_bf16_f32 v147, v254, v255
v_accvgpr_read_b32 v240, a16
v_accvgpr_read_b32 v241, a17
v_accvgpr_read_b32 v242, a18
v_accvgpr_read_b32 v243, a19
v_accvgpr_read_b32 v244, a20
v_accvgpr_read_b32 v245, a21
v_accvgpr_read_b32 v246, a22
v_accvgpr_read_b32 v247, a23
v_pk_mul_f32 v[240:241], v[240:241], v[224:225]
v_pk_mul_f32 v[242:243], v[242:243], v[224:225]
v_pk_mul_f32 v[244:245], v[244:245], v[224:225]
v_pk_mul_f32 v[246:247], v[246:247], v[224:225]
v_cvt_pk_bf16_f32 v160, v240, v241
v_cvt_pk_bf16_f32 v161, v242, v243
v_cvt_pk_bf16_f32 v162, v244, v245
v_cvt_pk_bf16_f32 v163, v246, v247
buffer_load_dwordx4 v[80:83], v15, s[4:7], s80 offen
v_accvgpr_read_b32 v248, a24
v_accvgpr_read_b32 v249, a25
v_accvgpr_read_b32 v250, a26
v_accvgpr_read_b32 v251, a27
v_accvgpr_read_b32 v252, a28
v_accvgpr_read_b32 v253, a29
v_accvgpr_read_b32 v254, a30
v_accvgpr_read_b32 v255, a31
v_pk_mul_f32 v[248:249], v[248:249], v[224:225]
v_pk_mul_f32 v[250:251], v[250:251], v[224:225]
v_pk_mul_f32 v[252:253], v[252:253], v[224:225]
v_pk_mul_f32 v[254:255], v[254:255], v[224:225]
v_cvt_pk_bf16_f32 v176, v248, v249
v_cvt_pk_bf16_f32 v177, v250, v251
v_cvt_pk_bf16_f32 v178, v252, v253
v_cvt_pk_bf16_f32 v179, v254, v255
v_mov_b32 v229, v228
v_accvgpr_read_b32 v240, a32
s_add_u32 s80, s80, 0x4000
buffer_load_dwordx4 v[84:87], v15, s[4:7], s80 offen
v_accvgpr_read_b32 v241, a33
v_accvgpr_read_b32 v242, a34
v_accvgpr_read_b32 v243, a35
v_accvgpr_read_b32 v244, a36
v_accvgpr_read_b32 v245, a37
v_accvgpr_read_b32 v246, a38
v_accvgpr_read_b32 v247, a39
v_pk_mul_f32 v[240:241], v[240:241], v[228:229]
v_pk_mul_f32 v[242:243], v[242:243], v[228:229]
v_pk_mul_f32 v[244:245], v[244:245], v[228:229]
v_pk_mul_f32 v[246:247], v[246:247], v[228:229]
v_cvt_pk_bf16_f32 v132, v240, v241
v_cvt_pk_bf16_f32 v133, v242, v243
v_cvt_pk_bf16_f32 v134, v244, v245
v_cvt_pk_bf16_f32 v135, v246, v247
v_accvgpr_read_b32 v248, a40
v_accvgpr_read_b32 v249, a41
v_accvgpr_read_b32 v250, a42
s_add_u32 s80, s80, 0x4000
buffer_load_dwordx4 v[96:99], v15, s[4:7], s80 offen
v_accvgpr_read_b32 v251, a43
v_accvgpr_read_b32 v252, a44
v_accvgpr_read_b32 v253, a45
v_accvgpr_read_b32 v254, a46
v_accvgpr_read_b32 v255, a47
v_pk_mul_f32 v[248:249], v[248:249], v[228:229]
v_pk_mul_f32 v[250:251], v[250:251], v[228:229]
v_pk_mul_f32 v[252:253], v[252:253], v[228:229]
v_pk_mul_f32 v[254:255], v[254:255], v[228:229]
v_cvt_pk_bf16_f32 v148, v248, v249
v_cvt_pk_bf16_f32 v149, v250, v251
v_cvt_pk_bf16_f32 v150, v252, v253
v_cvt_pk_bf16_f32 v151, v254, v255
v_accvgpr_read_b32 v240, a48
v_accvgpr_read_b32 v241, a49
v_accvgpr_read_b32 v242, a50
v_accvgpr_read_b32 v243, a51
v_accvgpr_read_b32 v244, a52
s_add_u32 s80, s80, 0x4000
buffer_load_dwordx4 v[100:103], v15, s[4:7], s80 offen
v_accvgpr_read_b32 v245, a53
v_accvgpr_read_b32 v246, a54
v_accvgpr_read_b32 v247, a55
v_pk_mul_f32 v[240:241], v[240:241], v[228:229]
v_pk_mul_f32 v[242:243], v[242:243], v[228:229]
v_pk_mul_f32 v[244:245], v[244:245], v[228:229]
v_pk_mul_f32 v[246:247], v[246:247], v[228:229]
v_cvt_pk_bf16_f32 v164, v240, v241
v_cvt_pk_bf16_f32 v165, v242, v243
v_cvt_pk_bf16_f32 v166, v244, v245
v_cvt_pk_bf16_f32 v167, v246, v247
v_accvgpr_read_b32 v248, a56
v_accvgpr_read_b32 v249, a57
v_accvgpr_read_b32 v250, a58
v_accvgpr_read_b32 v251, a59
v_accvgpr_read_b32 v252, a60
v_accvgpr_read_b32 v253, a61
v_accvgpr_read_b32 v254, a62
v_accvgpr_read_b32 v255, a63
v_pk_mul_f32 v[248:249], v[248:249], v[228:229]
v_pk_mul_f32 v[250:251], v[250:251], v[228:229]
v_pk_mul_f32 v[252:253], v[252:253], v[228:229]
v_pk_mul_f32 v[254:255], v[254:255], v[228:229]
v_cvt_pk_bf16_f32 v180, v248, v249
v_cvt_pk_bf16_f32 v181, v250, v251
v_cvt_pk_bf16_f32 v182, v252, v253
v_cvt_pk_bf16_f32 v183, v254, v255
s_cmp_eq_u32 s58, 0
s_cbranch_scc1 Lta49
s_cmp_eq_u32 s58, 1
s_cbranch_scc1 Lnt50
v_mfma_f32_16x16x32_bf16 v[140:143], a[128:131], v[64:67], v[92:95]
s_add_u32 s82, s82, 0x8000
ds_read_b128 a[160:163], v2 offset:24576
ds_read_b128 a[164:167], v2 offset:25600
v_mfma_f32_16x16x32_bf16 v[156:159], a[144:147], v[64:67], v[92:95]
s_and_b32 s82, s82, 0x1ffff
v_exp_f32 v168, v168
s_branch Ljoin51
Lta49:
v_mfma_f32_16x16x32_bf16 v[140:143], a[128:131], v[64:67], v[108:111]
s_add_u32 s82, s82, 0x8000
ds_read_b128 a[160:163], v2 offset:24576
ds_read_b128 a[164:167], v2 offset:25600
v_mfma_f32_16x16x32_bf16 v[156:159], a[144:147], v[64:67], v[112:115]
s_and_b32 s82, s82, 0x1ffff
v_exp_f32 v168, v168
s_branch Ljoin51
Lnt50:
v_mfma_f32_16x16x32_bf16 v[140:143], a[128:131], v[64:67], v[92:95]
s_add_u32 s82, s82, 0x8000
ds_read_b128 a[160:163], v2 offset:24576
ds_read_b128 a[164:167], v2 offset:25600
v_mfma_f32_16x16x32_bf16 v[156:159], a[144:147], v[64:67], v[108:111]
s_and_b32 s82, s82, 0x1ffff
v_exp_f32 v168, v168
Ljoin51:
v_mfma_f32_16x16x32_bf16 v[140:143], a[132:135], v[68:71], v[140:143]
v_exp_f32 v169, v169
v_mfma_f32_16x16x32_bf16 v[140:143], a[136:139], v[72:75], v[140:143]
ds_read_b128 a[168:171], v2 offset:26624
ds_read_b128 a[172:175], v2 offset:27648
v_mfma_f32_16x16x32_bf16 v[140:143], a[140:143], v[76:79], v[140:143]
v_exp_f32 v170, v170
v_mfma_f32_16x16x32_bf16 v[156:159], a[156:159], v[76:79], v[156:159]
v_exp_f32 v171, v171
v_mfma_f32_16x16x32_bf16 v[156:159], a[152:155], v[72:75], v[156:159]
buffer_store_dwordx4 v[128:131], v1, s[44:47], s70 offen sc1
v_mfma_f32_16x16x32_bf16 v[156:159], a[148:151], v[68:71], v[156:159]
s_waitcnt lgkmcnt(4)
ds_read_b128 a[176:179], v2 offset:28672
ds_read_b128 a[180:183], v2 offset:29696
v_mfma_f32_16x16x32_bf16 a[64:67], a[192:195], v[200:203], a[64:67]
v_exp_f32 v184, v184
v_mfma_f32_16x16x32_bf16 a[96:99], a[192:195], v[204:207], a[96:99]
ds_read_b128 a[184:187], v2 offset:30720
ds_read_b128 a[188:191], v2 offset:31744
v_mfma_f32_16x16x32_bf16 a[100:103], a[196:199], v[204:207], a[100:103]
ds_read_b128 a[224:227], v2 offset:8192
ds_read_b128 a[228:231], v2 offset:9216
v_mfma_f32_16x16x32_bf16 a[68:71], a[196:199], v[200:203], a[68:71]
ds_read_b128 a[232:235], v2 offset:10240
ds_read_b128 a[236:239], v2 offset:11264
v_mfma_f32_16x16x32_bf16 a[72:75], a[200:203], v[200:203], a[72:75]
ds_read_b128 a[240:243], v2 offset:12288
ds_read_b128 a[244:247], v2 offset:13312
v_mfma_f32_16x16x32_bf16 a[104:107], a[200:203], v[204:207], a[104:107]
ds_read_b128 a[248:251], v2 offset:14336
ds_read_b128 a[252:255], v2 offset:15360
v_mfma_f32_16x16x32_bf16 a[108:111], a[204:207], v[204:207], a[108:111]
v_cvt_pk_bf16_f32 v216, v168, v169
v_cvt_pk_bf16_f32 v217, v170, v171
v_mfma_f32_16x16x32_bf16 a[76:79], a[204:207], v[200:203], a[76:79]
v_exp_f32 v185, v185
v_mfma_f32_16x16x32_bf16 a[80:83], a[208:211], v[200:203], a[80:83]
v_exp_f32 v186, v186
v_mfma_f32_16x16x32_bf16 a[112:115], a[208:211], v[204:207], a[112:115]
v_exp_f32 v187, v187
v_mfma_f32_16x16x32_bf16 a[116:119], a[212:215], v[204:207], a[116:119]
v_exp_f32 v172, v172
v_mfma_f32_16x16x32_bf16 a[84:87], a[212:215], v[200:203], a[84:87]
buffer_store_dwordx4 v[144:147], v1, s[44:47], s70 offen offset:1024 sc1
v_mfma_f32_16x16x32_bf16 a[88:91], a[216:219], v[200:203], a[88:91]
v_cvt_pk_bf16_f32 v218, v184, v185
v_cvt_pk_bf16_f32 v219, v186, v187
v_mfma_f32_16x16x32_bf16 a[120:123], a[216:219], v[204:207], a[120:123]
v_exp_f32 v173, v173
v_mfma_f32_16x16x32_bf16 a[124:127], a[220:223], v[204:207], a[124:127]
v_exp_f32 v174, v174
v_mfma_f32_16x16x32_bf16 a[92:95], a[220:223], v[200:203], a[92:95]
buffer_store_dwordx4 v[160:163], v1, s[44:47], s70 offen offset:2048 sc1
v_mfma_f32_16x16x32_bf16 v[232:235], v[120:123], v[200:203], v[232:235]
s_waitcnt vmcnt(24) lgkmcnt(8)
v_exp_f32 v175, v175
v_mfma_f32_16x16x32_bf16 v[236:239], v[120:123], v[204:207], v[236:239]
s_barrier
v_exp_f32 v188, v188
v_add_u32 v2, s82, v1
v_cvt_pk_bf16_f32 v220, v172, v173
v_cvt_pk_bf16_f32 v221, v174, v175
v_exp_f32 v189, v189
v_exp_f32 v190, v190
v_cvt_pk_bf16_f32 v222, v188, v189
v_exp_f32 v191, v191
s_nop 0
v_cvt_pk_bf16_f32 v223, v190, v191
s_cmp_eq_u32 s58, 2
s_cbranch_scc1 Lta52
s_cmp_eq_u32 s58, 3
s_cbranch_scc1 Lnt53
v_mfma_f32_16x16x32_bf16 v[172:175], a[160:163], v[64:67], v[112:115]
v_exp_f32 v140, v140
v_mfma_f32_16x16x32_bf16 v[188:191], a[176:179], v[64:67], v[112:115]
ds_read_b128 a[192:195], v2 offset:0
s_branch Ljoin54
Lta52:
v_mfma_f32_16x16x32_bf16 v[172:175], a[160:163], v[64:67], v[108:111]
v_exp_f32 v140, v140
v_mfma_f32_16x16x32_bf16 v[188:191], a[176:179], v[64:67], v[112:115]
ds_read_b128 a[192:195], v2 offset:0
s_branch Ljoin54
Lnt53:
v_mfma_f32_16x16x32_bf16 v[172:175], a[160:163], v[64:67], v[92:95]
v_exp_f32 v140, v140
v_mfma_f32_16x16x32_bf16 v[188:191], a[176:179], v[64:67], v[108:111]
ds_read_b128 a[192:195], v2 offset:0
Ljoin54:
v_mfma_f32_16x16x32_bf16 v[172:175], a[164:167], v[68:71], v[172:175]
v_exp_f32 v141, v141
v_mfma_f32_16x16x32_bf16 v[172:175], a[168:171], v[72:75], v[172:175]
ds_read_b128 a[196:199], v2 offset:1024
v_cvt_pk_bf16_f32 v204, v140, v141
v_mfma_f32_16x16x32_bf16 v[172:175], a[172:175], v[76:79], v[172:175]
s_add_u32 s78, s59, 4
buffer_store_dwordx4 v[176:179], v1, s[44:47], s70 offen offset:3072 sc1
v_mfma_f32_16x16x32_bf16 v[188:191], a[188:191], v[76:79], v[188:191]
s_add_u32 s70, s70, 0x80000
v_exp_f32 v142, v142
v_mfma_f32_16x16x32_bf16 v[188:191], a[184:187], v[72:75], v[188:191]
s_and_b32 s78, s78, 28
ds_read_b128 a[200:203], v2 offset:2048
v_mfma_f32_16x16x32_bf16 v[188:191], a[180:183], v[68:71], v[188:191]
s_waitcnt lgkmcnt(3)
v_exp_f32 v143, v143
v_mfma_f32_16x16x32_bf16 a[64:67], a[224:227], v[216:219], a[64:67]
s_add_u32 s12, s61, 0
ds_read_b128 a[204:207], v2 offset:3072
v_cvt_pk_bf16_f32 v205, v142, v143
v_mfma_f32_16x16x32_bf16 a[96:99], a[224:227], v[220:223], a[96:99]
s_and_b32 s12, s12, 3
v_exp_f32 v156, v156
v_mfma_f32_16x16x32_bf16 a[100:103], a[228:231], v[220:223], a[100:103]
s_add_u32 s12, s12, s78
ds_read_b128 a[208:211], v2 offset:4096
v_mfma_f32_16x16x32_bf16 a[68:71], a[228:231], v[216:219], a[68:71]
s_lshl_b32 s12, s12, 18
buffer_store_dwordx4 v[132:135], v1, s[44:47], s70 offen sc1
v_mfma_f32_16x16x32_bf16 a[72:75], a[232:235], v[216:219], a[72:75]
s_add_u32 s13, s61, 1
v_exp_f32 v157, v157
v_mfma_f32_16x16x32_bf16 a[104:107], a[232:235], v[220:223], a[104:107]
s_and_b32 s13, s13, 3
ds_read_b128 a[212:215], v2 offset:5120
v_cvt_pk_bf16_f32 v206, v156, v157
v_mfma_f32_16x16x32_bf16 a[108:111], a[236:239], v[220:223], a[108:111]
s_add_u32 s13, s13, s78
v_exp_f32 v158, v158
v_mfma_f32_16x16x32_bf16 a[76:79], a[236:239], v[216:219], a[76:79]
s_lshl_b32 s13, s13, 18
ds_read_b128 a[216:219], v2 offset:6144
v_mfma_f32_16x16x32_bf16 a[80:83], a[240:243], v[216:219], a[80:83]
s_add_u32 s14, s61, 2
buffer_store_dwordx4 v[148:151], v1, s[44:47], s70 offen offset:1024 sc1
v_mfma_f32_16x16x32_bf16 a[112:115], a[240:243], v[220:223], a[112:115]
s_and_b32 s14, s14, 3
v_exp_f32 v159, v159
v_mfma_f32_16x16x32_bf16 a[116:119], a[244:247], v[220:223], a[116:119]
s_add_u32 s14, s14, s78
ds_read_b128 a[220:223], v2 offset:7168
v_cvt_pk_bf16_f32 v207, v158, v159
v_mfma_f32_16x16x32_bf16 a[84:87], a[244:247], v[216:219], a[84:87]
s_lshl_b32 s14, s14, 18
v_mfma_f32_16x16x32_bf16 a[88:91], a[248:251], v[216:219], a[88:91]
s_add_u32 s15, s61, 3
v_mfma_f32_16x16x32_bf16 a[120:123], a[248:251], v[220:223], a[120:123]
s_and_b32 s15, s15, 3
v_mfma_f32_16x16x32_bf16 a[124:127], a[252:255], v[220:223], a[124:127]
s_add_u32 s15, s15, s78
v_mfma_f32_16x16x32_bf16 a[92:95], a[252:255], v[216:219], a[92:95]
s_lshl_b32 s15, s15, 18
v_mfma_f32_16x16x32_bf16 v[232:235], v[120:123], v[216:219], v[232:235]
s_xor_b32 s78, s94, 0x80
v_mfma_f32_16x16x32_bf16 v[236:239], v[120:123], v[220:223], v[236:239]
s_waitcnt lgkmcnt(0)
v_mfma_f32_16x16x32_bf16 a[96:99], a[192:195], v[204:207], a[96:99]
s_add_u32 s82, s82, 0x8000
ds_read_b128 a[224:227], v2 offset:8192
ds_read_b128 a[228:231], v2 offset:9216
v_mfma_f32_16x16x32_bf16 a[100:103], a[196:199], v[204:207], a[100:103]
s_and_b32 s82, s82, 0x1ffff
v_exp_f32 v172, v172
v_mfma_f32_16x16x32_bf16 a[104:107], a[200:203], v[204:207], a[104:107]
ds_read_b128 a[232:235], v2 offset:10240
ds_read_b128 a[236:239], v2 offset:11264
v_mfma_f32_16x16x32_bf16 a[108:111], a[204:207], v[204:207], a[108:111]
buffer_store_dwordx4 v[164:167], v1, s[44:47], s70 offen offset:2048 sc1
v_mfma_f32_16x16x32_bf16 a[112:115], a[208:211], v[204:207], a[112:115]
ds_read_b128 a[240:243], v2 offset:12288
ds_read_b128 a[244:247], v2 offset:13312
v_mfma_f32_16x16x32_bf16 a[116:119], a[212:215], v[204:207], a[116:119]
ds_read_b128 a[248:251], v2 offset:14336
ds_read_b128 a[252:255], v2 offset:15360
v_mfma_f32_16x16x32_bf16 a[120:123], a[216:219], v[204:207], a[120:123]
buffer_store_dwordx4 v[180:183], v1, s[44:47], s70 offen offset:3072 sc1
v_mfma_f32_16x16x32_bf16 a[124:127], a[220:223], v[204:207], a[124:127]
s_waitcnt vmcnt(8) lgkmcnt(0)
v_exp_f32 v173, v173
v_mfma_f32_16x16x32_bf16 v[236:239], v[120:123], v[204:207], v[236:239]
s_barrier
v_exp_f32 v174, v174
v_add_u32 v2, s82, v1
v_cvt_pk_bf16_f32 v220, v172, v173
v_exp_f32 v175, v175
v_exp_f32 v188, v188
v_cvt_pk_bf16_f32 v221, v174, v175
v_exp_f32 v189, v189
v_exp_f32 v190, v190
v_cvt_pk_bf16_f32 v222, v188, v189
v_exp_f32 v191, v191
s_nop 0
v_cvt_pk_bf16_f32 v223, v190, v191
s_branch LHT4
Lslow:
s_waitcnt vmcnt(0) lgkmcnt(0)
s_barrier
s_mov_b32 s86, 1
s_lshl_b32 s81, s59, 20
s_add_u32 s81, s81, s64
s_sub_u32 s81, s81, 0x4000
s_mov_b32 s83, 0
s_lshl_b32 s75, s60, 3
s_sub_u32 s76, 128, s75
s_add_u32 s74, s75, s58
s_sub_u32 s75, s76, 8
s_add_u32 s75, s75, s58
v_mov_b32 v2, v1
v_lshrrev_b32 v240, 4, v0
v_and_b32 v241, 15, v0
v_lshlrev_b32 v240, 2, v240
v_sub_u32 v240, v241, v240
v_mov_b32 v112, 0xff800000
v_mov_b32 v113, 0xff800000
v_mov_b32 v114, 0xff800000
v_mov_b32 v115, 0xff800000
v_cmp_gt_i32 vcc, 0, v240
v_mov_b32 v120, 0x3f803f80
s_nop 0
v_cndmask_b32 v116, 0, v112, vcc
v_cmp_gt_i32 vcc, 1, v240
v_mov_b32 v121, 0x3f803f80
s_nop 0
v_cndmask_b32 v117, 0, v112, vcc
v_cmp_gt_i32 vcc, 2, v240
v_mov_b32 v122, 0x3f803f80
s_nop 0
v_cndmask_b32 v118, 0, v112, vcc
v_cmp_gt_i32 vcc, 3, v240
v_mov_b32 v123, 0x3f803f80
s_nop 0
v_cndmask_b32 v119, 0, v112, vcc
Lslow1:
s_add_u32 m0, s64, 16384
s_add_u32 s72, s81, 16384
buffer_load_dwordx4 v1, s[44:47], s72 offen sc1 lds
buffer_load_dwordx4 v1, s[44:47], s72 offen offset:1024 sc1 lds
buffer_load_dwordx4 v1, s[44:47], s72 offen offset:2048 sc1 lds
buffer_load_dwordx4 v1, s[44:47], s72 offen offset:3072 sc1 lds
s_add_u32 s81, s81, 0x8000
s_waitcnt vmcnt(0)
s_barrier
ds_read_b128 a[128:131], v2 offset:16384
ds_read_b128 a[132:135], v2 offset:17408
ds_read_b128 a[136:139], v2 offset:18432
ds_read_b128 a[140:143], v2 offset:19456
ds_read_b128 a[144:147], v2 offset:20480
ds_read_b128 a[148:151], v2 offset:21504
ds_read_b128 a[152:155], v2 offset:22528
ds_read_b128 a[156:159], v2 offset:23552
s_waitcnt lgkmcnt(0)
s_add_u32 s73, s74, 0
s_cmp_lt_u32 s73, s83
s_cbranch_scc1 Lsa55
s_cmp_eq_u32 s73, s83
s_cbranch_scc1 Lst56
v_mfma_f32_16x16x32_bf16 v[128:131], a[128:131], v[16:19], 0
s_branch Lsj57
Lst56:
v_mfma_f32_16x16x32_bf16 v[128:131], a[128:131], v[16:19], v[116:119]
Lsj57:
v_mfma_f32_16x16x32_bf16 v[128:131], a[132:135], v[20:23], v[128:131]
v_mfma_f32_16x16x32_bf16 v[128:131], a[136:139], v[24:27], v[128:131]
v_mfma_f32_16x16x32_bf16 v[128:131], a[140:143], v[28:31], v[128:131]
s_nop 7
v_max3_f32 v124, v124, v128, v129
v_max3_f32 v124, v124, v130, v131
Lsa55:
s_add_u32 s73, s74, 4
s_cmp_lt_u32 s73, s83
s_cbranch_scc1 Lsa58
s_cmp_eq_u32 s73, s83
s_cbranch_scc1 Lst59
v_mfma_f32_16x16x32_bf16 v[132:135], a[128:131], v[32:35], 0
s_branch Lsj60
Lst59:
v_mfma_f32_16x16x32_bf16 v[132:135], a[128:131], v[32:35], v[116:119]
Lsj60:
v_mfma_f32_16x16x32_bf16 v[132:135], a[132:135], v[36:39], v[132:135]
v_mfma_f32_16x16x32_bf16 v[132:135], a[136:139], v[40:43], v[132:135]
v_mfma_f32_16x16x32_bf16 v[132:135], a[140:143], v[44:47], v[132:135]
s_nop 7
v_max3_f32 v125, v125, v132, v133
v_max3_f32 v125, v125, v134, v135
Lsa58:
s_add_u32 s73, s75, 0
s_cmp_lt_u32 s73, s83
s_cbranch_scc1 Lsa61
s_cmp_eq_u32 s73, s83
s_cbranch_scc1 Lst62
v_mfma_f32_16x16x32_bf16 v[136:139], a[128:131], v[48:51], 0
s_branch Lsj63
Lst62:
v_mfma_f32_16x16x32_bf16 v[136:139], a[128:131], v[48:51], v[116:119]
Lsj63:
v_mfma_f32_16x16x32_bf16 v[136:139], a[132:135], v[52:55], v[136:139]
v_mfma_f32_16x16x32_bf16 v[136:139], a[136:139], v[56:59], v[136:139]
v_mfma_f32_16x16x32_bf16 v[136:139], a[140:143], v[60:63], v[136:139]
s_nop 7
v_max3_f32 v126, v126, v136, v137
v_max3_f32 v126, v126, v138, v139
Lsa61:
s_add_u32 s73, s75, 4
s_cmp_lt_u32 s73, s83
s_cbranch_scc1 Lsa64
s_cmp_eq_u32 s73, s83
s_cbranch_scc1 Lst65
v_mfma_f32_16x16x32_bf16 v[140:143], a[128:131], v[64:67], 0
s_branch Lsj66
Lst65:
v_mfma_f32_16x16x32_bf16 v[140:143], a[128:131], v[64:67], v[116:119]
Lsj66:
v_mfma_f32_16x16x32_bf16 v[140:143], a[132:135], v[68:71], v[140:143]
v_mfma_f32_16x16x32_bf16 v[140:143], a[136:139], v[72:75], v[140:143]
v_mfma_f32_16x16x32_bf16 v[140:143], a[140:143], v[76:79], v[140:143]
s_nop 7
v_max3_f32 v127, v127, v140, v141
v_max3_f32 v127, v127, v142, v143
Lsa64:
s_add_u32 s83, s83, 1
s_add_u32 s73, s74, 0
s_cmp_lt_u32 s73, s83
s_cbranch_scc1 Lsa67
s_cmp_eq_u32 s73, s83
s_cbranch_scc1 Lst68
v_mfma_f32_16x16x32_bf16 v[144:147], a[144:147], v[16:19], 0
s_branch Lsj69
Lst68:
v_mfma_f32_16x16x32_bf16 v[144:147], a[144:147], v[16:19], v[116:119]
Lsj69:
v_mfma_f32_16x16x32_bf16 v[144:147], a[148:151], v[20:23], v[144:147]
v_mfma_f32_16x16x32_bf16 v[144:147], a[152:155], v[24:27], v[144:147]
v_mfma_f32_16x16x32_bf16 v[144:147], a[156:159], v[28:31], v[144:147]
s_nop 7
v_max3_f32 v124, v124, v144, v145
v_max3_f32 v124, v124, v146, v147
Lsa67:
s_add_u32 s73, s74, 4
s_cmp_lt_u32 s73, s83
s_cbranch_scc1 Lsa70
s_cmp_eq_u32 s73, s83
s_cbranch_scc1 Lst71
v_mfma_f32_16x16x32_bf16 v[148:151], a[144:147], v[32:35], 0
s_branch Lsj72
Lst71:
v_mfma_f32_16x16x32_bf16 v[148:151], a[144:147], v[32:35], v[116:119]
Lsj72:
v_mfma_f32_16x16x32_bf16 v[148:151], a[148:151], v[36:39], v[148:151]
v_mfma_f32_16x16x32_bf16 v[148:151], a[152:155], v[40:43], v[148:151]
v_mfma_f32_16x16x32_bf16 v[148:151], a[156:159], v[44:47], v[148:151]
s_nop 7
v_max3_f32 v125, v125, v148, v149
v_max3_f32 v125, v125, v150, v151
Lsa70:
s_add_u32 s73, s75, 0
s_cmp_lt_u32 s73, s83
s_cbranch_scc1 Lsa73
s_cmp_eq_u32 s73, s83
s_cbranch_scc1 Lst74
v_mfma_f32_16x16x32_bf16 v[152:155], a[144:147], v[48:51], 0
s_branch Lsj75
Lst74:
v_mfma_f32_16x16x32_bf16 v[152:155], a[144:147], v[48:51], v[116:119]
Lsj75:
v_mfma_f32_16x16x32_bf16 v[152:155], a[148:151], v[52:55], v[152:155]
v_mfma_f32_16x16x32_bf16 v[152:155], a[152:155], v[56:59], v[152:155]
v_mfma_f32_16x16x32_bf16 v[152:155], a[156:159], v[60:63], v[152:155]
s_nop 7
v_max3_f32 v126, v126, v152, v153
v_max3_f32 v126, v126, v154, v155
Lsa73:
s_add_u32 s73, s75, 4
s_cmp_lt_u32 s73, s83
s_cbranch_scc1 Lsa76
s_cmp_eq_u32 s73, s83
s_cbranch_scc1 Lst77
v_mfma_f32_16x16x32_bf16 v[156:159], a[144:147], v[64:67], 0
s_branch Lsj78
Lst77:
v_mfma_f32_16x16x32_bf16 v[156:159], a[144:147], v[64:67], v[116:119]
Lsj78:
v_mfma_f32_16x16x32_bf16 v[156:159], a[148:151], v[68:71], v[156:159]
v_mfma_f32_16x16x32_bf16 v[156:159], a[152:155], v[72:75], v[156:159]
v_mfma_f32_16x16x32_bf16 v[156:159], a[156:159], v[76:79], v[156:159]
s_nop 7
v_max3_f32 v127, v127, v156, v157
v_max3_f32 v127, v127, v158, v159
Lsa76:
s_add_u32 s83, s83, 1
ds_read_b128 a[128:131], v2 offset:24576
ds_read_b128 a[132:135], v2 offset:25600
ds_read_b128 a[136:139], v2 offset:26624
ds_read_b128 a[140:143], v2 offset:27648
ds_read_b128 a[144:147], v2 offset:28672
ds_read_b128 a[148:151], v2 offset:29696
ds_read_b128 a[152:155], v2 offset:30720
ds_read_b128 a[156:159], v2 offset:31744
s_waitcnt lgkmcnt(0)
s_add_u32 s73, s74, 0
s_cmp_lt_u32 s73, s83
s_cbranch_scc1 Lsa79
s_cmp_eq_u32 s73, s83
s_cbranch_scc1 Lst80
v_mfma_f32_16x16x32_bf16 v[128:131], a[128:131], v[16:19], 0
s_branch Lsj81
Lst80:
v_mfma_f32_16x16x32_bf16 v[128:131], a[128:131], v[16:19], v[116:119]
Lsj81:
v_mfma_f32_16x16x32_bf16 v[128:131], a[132:135], v[20:23], v[128:131]
v_mfma_f32_16x16x32_bf16 v[128:131], a[136:139], v[24:27], v[128:131]
v_mfma_f32_16x16x32_bf16 v[128:131], a[140:143], v[28:31], v[128:131]
s_nop 7
v_max3_f32 v124, v124, v128, v129
v_max3_f32 v124, v124, v130, v131
Lsa79:
s_add_u32 s73, s74, 4
s_cmp_lt_u32 s73, s83
s_cbranch_scc1 Lsa82
s_cmp_eq_u32 s73, s83
s_cbranch_scc1 Lst83
v_mfma_f32_16x16x32_bf16 v[132:135], a[128:131], v[32:35], 0
s_branch Lsj84
Lst83:
v_mfma_f32_16x16x32_bf16 v[132:135], a[128:131], v[32:35], v[116:119]
Lsj84:
v_mfma_f32_16x16x32_bf16 v[132:135], a[132:135], v[36:39], v[132:135]
v_mfma_f32_16x16x32_bf16 v[132:135], a[136:139], v[40:43], v[132:135]
v_mfma_f32_16x16x32_bf16 v[132:135], a[140:143], v[44:47], v[132:135]
s_nop 7
v_max3_f32 v125, v125, v132, v133
v_max3_f32 v125, v125, v134, v135
Lsa82:
s_add_u32 s73, s75, 0
s_cmp_lt_u32 s73, s83
s_cbranch_scc1 Lsa85
s_cmp_eq_u32 s73, s83
s_cbranch_scc1 Lst86
v_mfma_f32_16x16x32_bf16 v[136:139], a[128:131], v[48:51], 0
s_branch Lsj87
Lst86:
v_mfma_f32_16x16x32_bf16 v[136:139], a[128:131], v[48:51], v[116:119]
Lsj87:
v_mfma_f32_16x16x32_bf16 v[136:139], a[132:135], v[52:55], v[136:139]
v_mfma_f32_16x16x32_bf16 v[136:139], a[136:139], v[56:59], v[136:139]
v_mfma_f32_16x16x32_bf16 v[136:139], a[140:143], v[60:63], v[136:139]
s_nop 7
v_max3_f32 v126, v126, v136, v137
v_max3_f32 v126, v126, v138, v139
Lsa85:
s_add_u32 s73, s75, 4
s_cmp_lt_u32 s73, s83
s_cbranch_scc1 Lsa88
s_cmp_eq_u32 s73, s83
s_cbranch_scc1 Lst89
v_mfma_f32_16x16x32_bf16 v[140:143], a[128:131], v[64:67], 0
s_branch Lsj90
Lst89:
v_mfma_f32_16x16x32_bf16 v[140:143], a[128:131], v[64:67], v[116:119]
Lsj90:
v_mfma_f32_16x16x32_bf16 v[140:143], a[132:135], v[68:71], v[140:143]
v_mfma_f32_16x16x32_bf16 v[140:143], a[136:139], v[72:75], v[140:143]
v_mfma_f32_16x16x32_bf16 v[140:143], a[140:143], v[76:79], v[140:143]
s_nop 7
v_max3_f32 v127, v127, v140, v141
v_max3_f32 v127, v127, v142, v143
Lsa88:
s_add_u32 s83, s83, 1
s_add_u32 s73, s74, 0
s_cmp_lt_u32 s73, s83
s_cbranch_scc1 Lsa91
s_cmp_eq_u32 s73, s83
s_cbranch_scc1 Lst92
v_mfma_f32_16x16x32_bf16 v[144:147], a[144:147], v[16:19], 0
s_branch Lsj93
Lst92:
v_mfma_f32_16x16x32_bf16 v[144:147], a[144:147], v[16:19], v[116:119]
Lsj93:
v_mfma_f32_16x16x32_bf16 v[144:147], a[148:151], v[20:23], v[144:147]
v_mfma_f32_16x16x32_bf16 v[144:147], a[152:155], v[24:27], v[144:147]
v_mfma_f32_16x16x32_bf16 v[144:147], a[156:159], v[28:31], v[144:147]
s_nop 7
v_max3_f32 v124, v124, v144, v145
v_max3_f32 v124, v124, v146, v147
Lsa91:
s_add_u32 s73, s74, 4
s_cmp_lt_u32 s73, s83
s_cbranch_scc1 Lsa94
s_cmp_eq_u32 s73, s83
s_cbranch_scc1 Lst95
v_mfma_f32_16x16x32_bf16 v[148:151], a[144:147], v[32:35], 0
s_branch Lsj96
Lst95:
v_mfma_f32_16x16x32_bf16 v[148:151], a[144:147], v[32:35], v[116:119]
Lsj96:
v_mfma_f32_16x16x32_bf16 v[148:151], a[148:151], v[36:39], v[148:151]
v_mfma_f32_16x16x32_bf16 v[148:151], a[152:155], v[40:43], v[148:151]
v_mfma_f32_16x16x32_bf16 v[148:151], a[156:159], v[44:47], v[148:151]
s_nop 7
v_max3_f32 v125, v125, v148, v149
v_max3_f32 v125, v125, v150, v151
Lsa94:
s_add_u32 s73, s75, 0
s_cmp_lt_u32 s73, s83
s_cbranch_scc1 Lsa97
s_cmp_eq_u32 s73, s83
s_cbranch_scc1 Lst98
v_mfma_f32_16x16x32_bf16 v[152:155], a[144:147], v[48:51], 0
s_branch Lsj99
Lst98:
v_mfma_f32_16x16x32_bf16 v[152:155], a[144:147], v[48:51], v[116:119]
Lsj99:
v_mfma_f32_16x16x32_bf16 v[152:155], a[148:151], v[52:55], v[152:155]
v_mfma_f32_16x16x32_bf16 v[152:155], a[152:155], v[56:59], v[152:155]
v_mfma_f32_16x16x32_bf16 v[152:155], a[156:159], v[60:63], v[152:155]
s_nop 7
v_max3_f32 v126, v126, v152, v153
v_max3_f32 v126, v126, v154, v155
Lsa97:
s_add_u32 s73, s75, 4
s_cmp_lt_u32 s73, s83
s_cbranch_scc1 Lsa100
s_cmp_eq_u32 s73, s83
s_cbranch_scc1 Lst101
v_mfma_f32_16x16x32_bf16 v[156:159], a[144:147], v[64:67], 0
s_branch Lsj102
Lst101:
v_mfma_f32_16x16x32_bf16 v[156:159], a[144:147], v[64:67], v[116:119]
Lsj102:
v_mfma_f32_16x16x32_bf16 v[156:159], a[148:151], v[68:71], v[156:159]
v_mfma_f32_16x16x32_bf16 v[156:159], a[152:155], v[72:75], v[156:159]
v_mfma_f32_16x16x32_bf16 v[156:159], a[156:159], v[76:79], v[156:159]
s_nop 7
v_max3_f32 v127, v127, v156, v157
v_max3_f32 v127, v127, v158, v159
Lsa100:
s_add_u32 s83, s83, 1
s_barrier
s_cmp_lt_u32 s83, s76
s_cbranch_scc1 Lslow1
s_lshl_b32 s81, s59, 20
s_add_u32 s81, s81, s64
s_sub_u32 s81, s81, 0x4000
s_add_u32 m0, s64, 49152
s_add_u32 s72, s81, 16384
buffer_load_dwordx4 v1, s[44:47], s72 offen sc1 lds
buffer_load_dwordx4 v1, s[44:47], s72 offen offset:1024 sc1 lds
buffer_load_dwordx4 v1, s[44:47], s72 offen offset:2048 sc1 lds
buffer_load_dwordx4 v1, s[44:47], s72 offen offset:3072 sc1 lds
s_add_u32 s81, s81, 0x8000
s_add_u32 m0, s64, 81920
s_add_u32 s72, s81, 16384
buffer_load_dwordx4 v1, s[44:47], s72 offen sc1 lds
buffer_load_dwordx4 v1, s[44:47], s72 offen offset:1024 sc1 lds
buffer_load_dwordx4 v1, s[44:47], s72 offen offset:2048 sc1 lds
buffer_load_dwordx4 v1, s[44:47], s72 offen offset:3072 sc1 lds
s_add_u32 m0, s64, 65536
s_add_u32 s72, s81, 0
buffer_load_dwordx4 v1, s[44:47], s72 offen sc1 lds
buffer_load_dwordx4 v1, s[44:47], s72 offen offset:1024 sc1 lds
buffer_load_dwordx4 v1, s[44:47], s72 offen offset:2048 sc1 lds
buffer_load_dwordx4 v1, s[44:47], s72 offen offset:3072 sc1 lds
s_add_u32 s81, s81, 0x8000
s_add_u32 m0, s64, 114688
s_add_u32 s72, s81, 16384
buffer_load_dwordx4 v1, s[44:47], s72 offen sc1 lds
buffer_load_dwordx4 v1, s[44:47], s72 offen offset:1024 sc1 lds
buffer_load_dwordx4 v1, s[44:47], s72 offen offset:2048 sc1 lds
buffer_load_dwordx4 v1, s[44:47], s72 offen offset:3072 sc1 lds
s_add_u32 m0, s64, 98304
s_add_u32 s72, s81, 0
buffer_load_dwordx4 v1, s[44:47], s72 offen sc1 lds
buffer_load_dwordx4 v1, s[44:47], s72 offen offset:1024 sc1 lds
buffer_load_dwordx4 v1, s[44:47], s72 offen offset:2048 sc1 lds
buffer_load_dwordx4 v1, s[44:47], s72 offen offset:3072 sc1 lds
v_add_u32 v2, 0x8000, v1
v_lshrrev_b32 v3, 1, v0
v_lshlrev_b32 v3, 7, v3
s_waitcnt vmcnt(0)
s_barrier
ds_read_b128 a[128:131], v2 offset:16384
ds_read_b128 a[132:135], v2 offset:17408
ds_read_b128 a[136:139], v2 offset:18432
ds_read_b128 a[140:143], v2 offset:19456
ds_read_b128 a[144:147], v2 offset:20480
ds_read_b128 a[148:151], v2 offset:21504
ds_read_b128 a[152:155], v2 offset:22528
ds_read_b128 a[156:159], v2 offset:23552
s_branch Lattn
Lspin103:
s_mov_b32 s83, 262144
Lsl105:
s_sleep 2
buffer_load_dword v3, v2, s[44:47], s82 offen sc1
s_sub_u32 s83, s83, 1
s_cmp_eq_u32 s83, 0
s_waitcnt vmcnt(0)
s_cbranch_scc1 Lback104
v_cmp_gt_u32 vcc, 2, v3
s_cbranch_vccnz Lsl105
s_branch Lback104
Lspin106:
s_mov_b32 s83, 262144
Lsl108:
s_sleep 2
buffer_load_dword v14, v2, s[44:47], s79 offen sc1
s_sub_u32 s83, s83, 1
s_cmp_eq_u32 s83, 0
s_waitcnt vmcnt(0)
s_cbranch_scc1 Lback107
v_cmp_gt_u32 vcc, 2, v14
s_cbranch_vccnz Lsl108
s_branch Lback107
Lspin109:
s_mov_b32 s83, 262144
Lsl111:
s_sleep 2
buffer_load_dword v3, v2, s[44:47], s82 offen sc1
s_sub_u32 s83, s83, 1
s_cmp_eq_u32 s83, 0
s_waitcnt vmcnt(0)
s_cbranch_scc1 Lback110
v_cmp_gt_u32 vcc, 2, v3
s_cbranch_vccnz Lsl111
s_branch Lback110
Lspin112:
s_mov_b32 s83, 262144
Lsl114:
s_sleep 2
buffer_load_dword v3, v2, s[44:47], s82 offen sc1
s_sub_u32 s83, s83, 1
s_cmp_eq_u32 s83, 0
s_waitcnt vmcnt(0)
s_cbranch_scc1 Lback113
v_cmp_gt_u32 vcc, 2, v3
s_cbranch_vccnz Lsl114
s_branch Lback113
Lredo0:
s_add_u32 s82, s59, 4
s_and_b32 s82, s82, 28
s_lshl_b32 s82, s82, 10
s_add_u32 s82, s82, s74
buffer_load_dword v3, v2, s[44:47], s82 offen sc1
s_waitcnt vmcnt(0)
v_cmp_gt_u32 vcc, 2, v3
s_cbranch_vccnz Lspin103
Lback104:
s_lshr_b32 s69, s12, 6
s_add_u32 s69, s69, s95
buffer_load_dwordx4 a[0:3], v1, s[44:47], s69 offen sc1
buffer_load_dwordx4 a[4:7], v1, s[44:47], s69 offen offset:1024 sc1
buffer_load_dwordx4 a[8:11], v1, s[44:47], s69 offen offset:2048 sc1
buffer_load_dwordx4 a[12:15], v1, s[44:47], s69 offen offset:3072 sc1
s_add_u32 s69, s69, 0x20000
buffer_load_dwordx4 a[16:19], v1, s[44:47], s69 offen sc1
buffer_load_dwordx4 a[20:23], v1, s[44:47], s69 offen offset:1024 sc1
buffer_load_dwordx4 a[24:27], v1, s[44:47], s69 offen offset:2048 sc1
buffer_load_dwordx4 a[28:31], v1, s[44:47], s69 offen offset:3072 sc1
s_lshr_b32 s69, s13, 6
s_add_u32 s69, s69, s95
buffer_load_dwordx4 a[32:35], v1, s[44:47], s69 offen sc1
buffer_load_dwordx4 a[36:39], v1, s[44:47], s69 offen offset:1024 sc1
buffer_load_dwordx4 a[40:43], v1, s[44:47], s69 offen offset:2048 sc1
buffer_load_dwordx4 a[44:47], v1, s[44:47], s69 offen offset:3072 sc1
s_add_u32 s69, s69, 0x20000
buffer_load_dwordx4 a[48:51], v1, s[44:47], s69 offen sc1
buffer_load_dwordx4 a[52:55], v1, s[44:47], s69 offen offset:1024 sc1
buffer_load_dwordx4 a[56:59], v1, s[44:47], s69 offen offset:2048 sc1
buffer_load_dwordx4 a[60:63], v1, s[44:47], s69 offen offset:3072 sc1
s_waitcnt vmcnt(8)
s_branch Lredo0b
Lspin115:
s_mov_b32 s83, 262144
Lsl117:
s_sleep 2
buffer_load_dword v114, v115, s[44:47], s84 offen sc1
s_sub_u32 s83, s83, 1
s_cmp_eq_u32 s83, 0
s_waitcnt vmcnt(0)
s_cbranch_scc1 Lback116
v_cmp_gt_u32 vcc, 3, v114
s_cbranch_vccnz Lsl117
s_branch Lback116
Lspin118:
s_mov_b32 s83, 262144
Lsl120:
s_sleep 2
buffer_load_dword v14, v13, s[44:47], s79 offen sc1
s_sub_u32 s83, s83, 1
s_cmp_eq_u32 s83, 0
s_waitcnt vmcnt(0)
s_cbranch_scc1 Lback119
v_cmp_gt_u32 vcc, 2, v14
s_cbranch_vccnz Lsl120
s_branch Lback119
Lxspin:
s_mov_b32 s83, 262144
Lxsl:
buffer_load_dwordx4 v[64:67], v1, s[44:47], s79 offen sc1
buffer_load_dwordx4 v[68:71], v1, s[44:47], s79 offen offset:1024 sc1
buffer_load_dwordx4 v[72:75], v1, s[44:47], s79 offen offset:2048 sc1
buffer_load_dwordx4 v[76:79], v1, s[44:47], s79 offen offset:3072 sc1
s_sub_u32 s83, s83, 1
s_cmp_eq_u32 s83, 0
s_waitcnt vmcnt(0)
s_cbranch_scc1 Lxback
v_max3_u32 v112, v64, v65, v66
v_max3_u32 v112, v112, v67, v68
v_max3_u32 v112, v112, v69, v70
v_max3_u32 v112, v112, v71, v72
v_max3_u32 v112, v112, v73, v74
v_max3_u32 v112, v112, v75, v76
v_max3_u32 v112, v112, v77, v78
v_max3_u32 v112, v112, v79, v79
v_cmp_eq_u32 vcc, -1, v112
s_cbranch_vccnz Lxsl
s_branch Lxback
Lcode_end:
s_endpgm
.section .rodata,"a"
.p2align 6
.amdhsa_kernel gated_mix__compressed_kv_cla__ssm_conv_h3__prompt_kernel
  .amdhsa_next_free_vgpr 512
  .amdhsa_next_free_sgpr 102
  .amdhsa_accum_offset 256
  .amdhsa_group_segment_fixed_size 0
  .amdhsa_kernarg_size 128
  .amdhsa_user_sgpr_count 2
  .amdhsa_user_sgpr_kernarg_segment_ptr 1
  .amdhsa_system_sgpr_workgroup_id_x 1
  .amdhsa_float_denorm_mode_32 3
.end_amdhsa_kernel
```

```asm
; @launch grid=(256,1,1) block=(256,1,1) lds=163840
.amdgcn_target "amdgcn-amd-amdhsa--gfx950"
.text
.globl gated_mix__compressed_kv_cla__ssm_conv_h3__prompt_kernel
.p2align 8
.type gated_mix__compressed_kv_cla__ssm_conv_h3__prompt_kernel,@function
gated_mix__compressed_kv_cla__ssm_conv_h3__prompt_kernel:
s_cmp_ge_u32 s2, 256
s_cbranch_scc1 Lend
s_load_dwordx2 s[8:9], s[0:1], 8
s_load_dwordx2 s[16:17], s[0:1], 24
s_load_dwordx2 s[20:21], s[0:1], 32
s_load_dwordx2 s[4:5], s[0:1], 0
s_load_dwordx2 s[12:13], s[0:1], 16
s_load_dwordx2 s[24:25], s[0:1], 40
s_load_dwordx2 s[28:29], s[0:1], 56
s_load_dwordx2 s[32:33], s[0:1], 64
s_load_dwordx2 s[52:53], s[0:1], 72
s_load_dwordx2 s[36:37], s[0:1], 80
s_load_dwordx2 s[54:55], s[0:1], 88
s_load_dwordx2 s[56:57], s[0:1], 96
s_load_dwordx2 s[40:41], s[0:1], 104
s_load_dwordx2 s[48:49], s[0:1], 112
s_load_dwordx2 s[44:45], s[0:1], 120
s_getpc_b64 s[98:99]
Lpc0:
s_lshr_b32 s75, s2, 3
v_lshrrev_b32 v26, 3, v0
s_lshl_b32 s73, s75, 12
v_lshlrev_b32 v26, 7, v26
v_add_u32 v26, s73, v26
v_min_u32 v26, Lcode_end-Lpc0, v26
global_load_dword v31, v26, s[98:99]
v_lshrrev_b32 v26, 6, v0
v_and_b32 v0, 63, v0
s_and_b32 s73, s2, 7
v_readfirstlane_b32 s58, v26
s_lshr_b32 s65, s75, 3
s_and_b32 s60, s75, 7
s_lshl_b32 s59, s73, 2
s_add_u32 s59, s59, s65
s_lshl_b32 s61, s65, 1
s_lshl_b32 s63, s58, 13
s_lshl_b32 s64, s58, 12
s_lshl_b32 s67, s60, 18
s_lshl_b32 s76, s58, 16
s_add_u32 s84, s67, s76
s_lshl_b32 s66, s58, 17
s_lshl_b32 s73, s59, 8
s_add_u32 s66, s66, s73
v_lshrrev_b32 v26, 4, v0
v_and_b32 v27, 7, v0
v_xor_b32 v27, v27, v26
v_lshlrev_b32 v27, 4, v27
v_lshrrev_b32 v28, 3, v0
v_lshl_add_u32 v2, v28, 10, v27
v_xor_b32 v3, 64, v2
v_and_b32 v29, 15, v0
v_lshlrev_b32 v30, 1, v26
v_xor_b32 v30, v30, v29
v_lshlrev_b32 v30, 4, v30
v_lshl_add_u32 v6, v26, 13, v30
v_xor_b32 v7, 0x80, v6
s_mov_b32 s10, 0x200000
s_mov_b32 s11, 0x20000
s_mov_b32 s18, 0x400000
s_mov_b32 s19, 0x20000
s_mov_b32 s22, 0x400000
s_mov_b32 s23, 0x20000
s_lshl_b32 s73, s2, 2
s_add_u32 s73, s73, s58
s_lshl_b32 s73, s73, 11
v_lshrrev_b32 v124, 2, v0
v_lshlrev_b32 v124, 7, v124
v_add_u32 v124, s73, v124
s_lshl_b32 s73, s60, 2
s_add_u32 s73, s73, s58
s_lshl_b32 s73, s73, 13
s_lshl_b32 s74, s59, 8
s_add_u32 s73, s73, s74
v_lshrrev_b32 v125, 4, v0
v_lshlrev_b32 v125, 18, v125
v_bfe_u32 v126, v0, 3, 1
v_lshl_add_u32 v125, v126, 7, v125
v_add_u32 v125, s73, v125
s_waitcnt lgkmcnt(0)
s_mov_b32 s80, 0x0
buffer_load_dword v126, v125, s[16:19], s80 offen
buffer_load_dword v126, v125, s[20:23], s80 offen
s_and_b32 s73, s65, 1
s_xor_b32 s73, s73, 0
s_lshl_b32 s69, s73, 7
s_add_u32 s69, s69, s84
s_lshl_b32 s71, s73, 19
s_add_u32 s71, s71, s66
s_add_u32 m0, s63, 65536
s_add_u32 s72, s69, 0
buffer_load_dwordx4 v2, s[8:11], s72 offen lds
s_add_u32 s72, s69, 7168
buffer_load_dwordx4 v3, s[8:11], s72 offen offset:1024 lds
s_add_u32 s72, s69, 14336
buffer_load_dwordx4 v2, s[8:11], s72 offen offset:2048 lds
s_add_u32 s72, s69, 21504
buffer_load_dwordx4 v3, s[8:11], s72 offen offset:3072 lds
s_add_u32 m0, s64, 0
s_add_u32 s72, s71, 0
buffer_load_dwordx4 v6, s[16:19], s72 offen lds
s_add_u32 s72, s71, 31744
buffer_load_dwordx4 v6, s[16:19], s72 offen offset:1024 lds
s_add_u32 s72, s71, 63488
buffer_load_dwordx4 v7, s[16:19], s72 offen offset:2048 lds
s_add_u32 s72, s71, 95232
buffer_load_dwordx4 v7, s[16:19], s72 offen offset:3072 lds
s_add_u32 m0, s63, 69632
s_add_u32 s72, s69, 32768
buffer_load_dwordx4 v2, s[8:11], s72 offen lds
s_add_u32 s72, s69, 39936
buffer_load_dwordx4 v3, s[8:11], s72 offen offset:1024 lds
s_add_u32 s72, s69, 47104
buffer_load_dwordx4 v2, s[8:11], s72 offen offset:2048 lds
s_add_u32 s72, s69, 54272
buffer_load_dwordx4 v3, s[8:11], s72 offen offset:3072 lds
s_add_u32 m0, s64, 16384
s_add_u32 s72, s71, 0
buffer_load_dwordx4 v6, s[20:23], s72 offen lds
s_add_u32 s72, s71, 31744
buffer_load_dwordx4 v6, s[20:23], s72 offen offset:1024 lds
s_add_u32 s72, s71, 63488
buffer_load_dwordx4 v7, s[20:23], s72 offen offset:2048 lds
s_add_u32 s72, s71, 95232
buffer_load_dwordx4 v7, s[20:23], s72 offen offset:3072 lds
buffer_load_dword v126, v124, s[8:11], 0 offen
s_and_b32 s73, s65, 1
s_xor_b32 s73, s73, 1
s_lshl_b32 s69, s73, 7
s_add_u32 s69, s69, s84
s_lshl_b32 s71, s73, 19
s_add_u32 s71, s71, s66
s_add_u32 m0, s63, 98304
s_add_u32 s72, s69, 0
buffer_load_dwordx4 v2, s[8:11], s72 offen lds
s_add_u32 s72, s69, 7168
buffer_load_dwordx4 v3, s[8:11], s72 offen offset:1024 lds
s_add_u32 s72, s69, 14336
buffer_load_dwordx4 v2, s[8:11], s72 offen offset:2048 lds
s_add_u32 s72, s69, 21504
buffer_load_dwordx4 v3, s[8:11], s72 offen offset:3072 lds
s_branch Lmain
.p2align 12
Lmain:
s_mov_b32 s6, 0x400000
s_mov_b32 s7, 0x20000
s_mov_b32 s14, 0x800000
s_mov_b32 s15, 0x20000
s_mov_b32 s26, 0x800000
s_mov_b32 s27, 0x20000
s_mov_b32 s30, 0x400000
s_mov_b32 s31, 0x20000
s_mov_b32 s34, 0x400000
s_mov_b32 s35, 0x20000
s_mov_b32 s38, 0x400000
s_mov_b32 s39, 0x20000
s_mov_b32 s42, 0x400000
s_mov_b32 s43, 0x20000
s_mov_b32 s46, 0x5000000
s_mov_b32 s47, 0x20000
s_mov_b32 s50, 0x100
s_mov_b32 s51, 0x20000
v_lshl_add_u32 v4, v28, 11, v27
v_xor_b32 v5, 64, v4
v_lshlrev_b32 v1, 4, v0
s_sub_u32 s74, 15, s60
s_lshl_b32 s68, s74, 18
s_lshl_b32 s76, s58, 15
s_add_u32 s68, s68, s76
s_add_u32 s67, s67, s76
s_and_b32 s62, s60, 3
s_sub_u32 s62, 16, s62
s_lshl_b32 s91, s59, 3
s_add_u32 s91, s91, s60
s_lshl_b32 s93, s91, 2
s_add_u32 s93, s93, s58
s_lshl_b32 s91, s91, 7
s_add_u32 s91, s91, 0x3810000
s_lshl_b32 s75, s93, 1
s_and_b32 s75, s75, 0xffc
s_lshl_b32 s93, s93, 12
s_load_dwordx2 s[88:89], s[36:37], s93
s_load_dword s90, s[54:55], s75
v_or_b32 v29, s58, v0
v_mov_b32 v30, 0
v_min_u32 v29, 1, v29
v_lshlrev_b32 v29, 30, v29
buffer_store_dword v30, v29, s[44:47], s91 offen sc1
s_and_b32 s73, s2, 15
s_lshr_b32 s74, s2, 4
s_lshl_b32 s74, s74, 7
s_lshl_b32 s75, s58, 5
s_add_u32 s74, s74, s75
s_mov_b32 s75, 131072
v_lshrrev_b32 v29, 5, v0
v_lshlrev_b32 v29, 4, v29
v_add_u32 v29, s74, v29
v_and_b32 v30, 31, v0
s_lshl_b32 s73, s73, 5
v_add_u32 v30, s73, v30
v_lshlrev_b32 v26, 11, v29
v_lshl_add_u32 v26, v30, 2, v26
v_subrev_u32 v27, 0x1800, v26
s_lshl_b32 s82, s74, 11
s_lshl_b32 s73, s73, 2
s_add_u32 s82, s82, s73
v_lshrrev_b32 v26, 3, v0
v_and_b32 v32, 7, v0
v_lshlrev_b32 v32, 4, v32
v_lshl_add_u32 v26, v26, 11, v32
v_lshrrev_b32 v98, 5, v0
v_lshlrev_b32 v98, 11, v98
v_and_b32 v32, 31, v0
v_lshl_add_u32 v98, v32, 2, v98
v_add_u32 v98, s63, v98
v_add_u32 v98, s75, v98
v_and_b32 v29, 0x7f, v29
v_sub_u32 v29, 0x70, v29
v_lshlrev_b32 v29, 1, v29
v_and_b32 v32, 31, v0
v_mul_u32_u24 v32, 544, v32
v_add3_u32 v28, v32, v29, s75
v_lshlrev_b32 v30, 4, v30
s_lshl_b32 s73, s2, 14
s_lshl_b32 s74, s58, 12
s_add_u32 s76, s73, s74
v_and_b32 v29, 15, v0
v_lshrrev_b32 v32, 4, v0
v_lshrrev_b32 v24, 1, v29
v_xor_b32 v24, v24, v32
v_lshlrev_b32 v24, 4, v24
v_lshl_add_u32 v24, v29, 7, v24
s_add_u32 s73, s63, 131072
v_add_u32 v16, s73, v24
v_xor_b32 v17, 64, v16
v_subrev_u32 v18, 0x10000, v16
v_subrev_u32 v19, 0x10000, v17
s_lshr_b32 s73, s58, 1
s_lshl_b32 s74, s73, 14
s_add_u32 s74, s74, 0x10000
v_add_u32 v24, s74, v24
v_xor_b32 v25, 64, v24
v_lshrrev_b32 v8, 2, v29
v_and_b32 v9, 1, v32
v_lshl_add_u32 v9, v9, 2, v8
v_lshl_add_u32 v8, v32, 3, v8
v_lshlrev_b32 v8, 8, v8
v_lshl_add_u32 v8, v9, 5, v8
v_and_b32 v29, 3, v0
v_lshl_add_u32 v8, v29, 3, v8
s_and_b32 s74, s58, 1
s_lshl_b32 s75, s74, 7
v_xor_b32 v20, s75, v8
v_xor_b32 v9, 32, v8
v_xor_b32 v10, 64, v8
v_xor_b32 v11, 96, v8
v_xor_b32 v12, 128, v8
v_xor_b32 v13, 160, v8
v_xor_b32 v14, 192, v8
v_xor_b32 v15, 224, v8
v_xor_b32 v21, 32, v20
v_xor_b32 v22, 64, v20
v_xor_b32 v23, 96, v20
s_lshl_b32 s77, s59, 20
s_add_u32 s81, s77, s64
s_sub_u32 s81, s81, 0x4000
s_lshl_b32 s75, s60, 17
s_add_u32 s77, s77, s75
s_lshl_b32 s73, s73, 16
s_add_u32 s77, s77, s73
s_lshl_b32 s75, s74, 12
s_add_u32 s78, s77, s75
s_add_u32 s78, s78, 0x4000
s_lshl_b32 s75, s74, 11
s_add_u32 s77, s77, s75
s_mov_b32 s79, 0x3e0293ee
s_waitcnt vmcnt(6)
s_barrier
ds_read_b64_tr_b16 v[160:161], v20 offset:0
ds_read_b64_tr_b16 v[162:163], v20 offset:1024
ds_read_b128 v[128:131], v24 offset:0
ds_read_b128 v[132:135], v24 offset:2048
ds_read_b128 v[136:139], v24 offset:4096
ds_read_b128 v[140:143], v24 offset:6144
ds_read_b128 v[144:147], v24 offset:8192
ds_read_b128 v[148:151], v24 offset:10240
ds_read_b128 v[152:155], v24 offset:12288
ds_read_b128 v[156:159], v24 offset:14336
ds_read_b64_tr_b16 v[164:165], v21 offset:0
ds_read_b64_tr_b16 v[166:167], v21 offset:1024
ds_read_b64_tr_b16 v[168:169], v22 offset:0
ds_read_b64_tr_b16 v[170:171], v22 offset:1024
ds_read_b64_tr_b16 v[172:173], v23 offset:0
ds_read_b64_tr_b16 v[174:175], v23 offset:1024
ds_read_b64_tr_b16 v[176:177], v20 offset:16384
ds_read_b64_tr_b16 v[178:179], v20 offset:17408
ds_read_b64_tr_b16 v[180:181], v21 offset:16384
ds_read_b64_tr_b16 v[182:183], v21 offset:17408
ds_read_b64_tr_b16 v[184:185], v22 offset:16384
ds_read_b64_tr_b16 v[186:187], v22 offset:17408
ds_read_b64_tr_b16 v[188:189], v23 offset:16384
ds_read_b64_tr_b16 v[190:191], v23 offset:17408
s_waitcnt lgkmcnt(0)
v_mfma_f32_16x16x32_bf16 a[0:3], v[160:163], v[128:131], 0
s_add_u32 m0, s64, 32768
ds_read_b64_tr_b16 v[224:225], v20 offset:8192
v_mfma_f32_16x16x32_bf16 a[4:7], v[160:163], v[132:135], 0
s_add_u32 s72, s71, 0
buffer_load_dwordx4 v6, s[16:19], s72 offen lds
v_mfma_f32_16x16x32_bf16 a[8:11], v[160:163], v[136:139], 0
s_add_u32 s72, s71, 31744
buffer_load_dwordx4 v6, s[16:19], s72 offen offset:1024 lds
v_mfma_f32_16x16x32_bf16 a[12:15], v[160:163], v[140:143], 0
ds_read_b64_tr_b16 v[226:227], v20 offset:9216
v_mfma_f32_16x16x32_bf16 a[16:19], v[160:163], v[144:147], 0
s_add_u32 s72, s71, 63488
buffer_load_dwordx4 v7, s[16:19], s72 offen offset:2048 lds
v_mfma_f32_16x16x32_bf16 a[20:23], v[160:163], v[148:151], 0
ds_read_b128 v[192:195], v25 offset:0
v_mfma_f32_16x16x32_bf16 a[24:27], v[160:163], v[152:155], 0
s_add_u32 s72, s71, 95232
buffer_load_dwordx4 v7, s[16:19], s72 offen offset:3072 lds
v_mfma_f32_16x16x32_bf16 a[28:31], v[160:163], v[156:159], 0
ds_read_b128 v[196:199], v25 offset:2048
v_mfma_f32_16x16x32_bf16 a[60:63], v[164:167], v[156:159], 0
s_add_u32 m0, s63, 102400
ds_read_b128 v[200:203], v25 offset:4096
v_mfma_f32_16x16x32_bf16 a[56:59], v[164:167], v[152:155], 0
s_add_u32 s72, s69, 32768
buffer_load_dwordx4 v2, s[8:11], s72 offen lds
v_mfma_f32_16x16x32_bf16 a[52:55], v[164:167], v[148:151], 0
s_add_u32 s72, s69, 39936
buffer_load_dwordx4 v3, s[8:11], s72 offen offset:1024 lds
v_mfma_f32_16x16x32_bf16 a[48:51], v[164:167], v[144:147], 0
ds_read_b128 v[204:207], v25 offset:6144
v_mfma_f32_16x16x32_bf16 a[44:47], v[164:167], v[140:143], 0
s_add_u32 s72, s69, 47104
buffer_load_dwordx4 v2, s[8:11], s72 offen offset:2048 lds
v_mfma_f32_16x16x32_bf16 a[40:43], v[164:167], v[136:139], 0
ds_read_b128 v[208:211], v25 offset:8192
v_mfma_f32_16x16x32_bf16 a[36:39], v[164:167], v[132:135], 0
s_add_u32 s72, s69, 54272
buffer_load_dwordx4 v3, s[8:11], s72 offen offset:3072 lds
v_mfma_f32_16x16x32_bf16 a[32:35], v[164:167], v[128:131], 0
ds_read_b128 v[212:215], v25 offset:10240
v_mfma_f32_16x16x32_bf16 a[64:67], v[168:171], v[128:131], 0
s_add_u32 m0, s64, 49152
ds_read_b128 v[216:219], v25 offset:12288
v_mfma_f32_16x16x32_bf16 a[68:71], v[168:171], v[132:135], 0
s_add_u32 s72, s71, 0
buffer_load_dwordx4 v6, s[20:23], s72 offen lds
v_mfma_f32_16x16x32_bf16 a[72:75], v[168:171], v[136:139], 0
s_add_u32 s72, s71, 31744
buffer_load_dwordx4 v6, s[20:23], s72 offen offset:1024 lds
v_mfma_f32_16x16x32_bf16 a[76:79], v[168:171], v[140:143], 0
ds_read_b128 v[220:223], v25 offset:14336
v_mfma_f32_16x16x32_bf16 a[80:83], v[168:171], v[144:147], 0
s_add_u32 s72, s71, 63488
buffer_load_dwordx4 v7, s[20:23], s72 offen offset:2048 lds
v_mfma_f32_16x16x32_bf16 a[84:87], v[168:171], v[148:151], 0
ds_read_b64_tr_b16 v[228:229], v21 offset:8192
v_mfma_f32_16x16x32_bf16 a[88:91], v[168:171], v[152:155], 0
s_add_u32 s72, s71, 95232
buffer_load_dwordx4 v7, s[20:23], s72 offen offset:3072 lds
v_mfma_f32_16x16x32_bf16 a[92:95], v[168:171], v[156:159], 0
s_mov_b32 s80, 0x100000
buffer_load_dword v126, v125, s[16:19], s80 offen
v_mfma_f32_16x16x32_bf16 a[124:127], v[172:175], v[156:159], 0
buffer_load_dword v126, v125, s[20:23], s80 offen
v_mfma_f32_16x16x32_bf16 a[120:123], v[172:175], v[152:155], 0
ds_read_b64_tr_b16 v[230:231], v21 offset:9216
v_mfma_f32_16x16x32_bf16 a[116:119], v[172:175], v[148:151], 0
ds_read_b64_tr_b16 v[232:233], v22 offset:8192
v_mfma_f32_16x16x32_bf16 a[112:115], v[172:175], v[144:147], 0
ds_read_b64_tr_b16 v[234:235], v22 offset:9216
v_mfma_f32_16x16x32_bf16 a[108:111], v[172:175], v[140:143], 0
ds_read_b64_tr_b16 v[236:237], v23 offset:8192
v_mfma_f32_16x16x32_bf16 a[104:107], v[172:175], v[136:139], 0
ds_read_b64_tr_b16 v[238:239], v23 offset:9216
v_mfma_f32_16x16x32_bf16 a[100:103], v[172:175], v[132:135], 0
ds_read_b64_tr_b16 v[240:241], v20 offset:24576
v_mfma_f32_16x16x32_bf16 a[96:99], v[172:175], v[128:131], 0
ds_read_b64_tr_b16 v[242:243], v20 offset:25600
v_mfma_f32_16x16x32_bf16 a[128:131], v[128:131], v[176:179], 0
ds_read_b64_tr_b16 v[244:245], v21 offset:24576
v_mfma_f32_16x16x32_bf16 a[132:135], v[132:135], v[176:179], 0
ds_read_b64_tr_b16 v[246:247], v21 offset:25600
v_mfma_f32_16x16x32_bf16 a[136:139], v[136:139], v[176:179], 0
ds_read_b64_tr_b16 v[248:249], v22 offset:24576
v_mfma_f32_16x16x32_bf16 a[140:143], v[140:143], v[176:179], 0
ds_read_b64_tr_b16 v[250:251], v22 offset:25600
v_mfma_f32_16x16x32_bf16 a[144:147], v[144:147], v[176:179], 0
ds_read_b64_tr_b16 v[252:253], v23 offset:24576
v_mfma_f32_16x16x32_bf16 a[148:151], v[148:151], v[176:179], 0
ds_read_b64_tr_b16 v[254:255], v23 offset:25600
v_mfma_f32_16x16x32_bf16 a[152:155], v[152:155], v[176:179], 0
v_mfma_f32_16x16x32_bf16 a[156:159], v[156:159], v[176:179], 0
v_mfma_f32_16x16x32_bf16 a[188:191], v[156:159], v[180:183], 0
v_mfma_f32_16x16x32_bf16 a[184:187], v[152:155], v[180:183], 0
v_mfma_f32_16x16x32_bf16 a[180:183], v[148:151], v[180:183], 0
v_mfma_f32_16x16x32_bf16 a[176:179], v[144:147], v[180:183], 0
v_mfma_f32_16x16x32_bf16 a[172:175], v[140:143], v[180:183], 0
v_mfma_f32_16x16x32_bf16 a[168:171], v[136:139], v[180:183], 0
v_mfma_f32_16x16x32_bf16 a[164:167], v[132:135], v[180:183], 0
v_mfma_f32_16x16x32_bf16 a[160:163], v[128:131], v[180:183], 0
v_mfma_f32_16x16x32_bf16 a[192:195], v[128:131], v[184:187], 0
v_mfma_f32_16x16x32_bf16 a[196:199], v[132:135], v[184:187], 0
v_mfma_f32_16x16x32_bf16 a[200:203], v[136:139], v[184:187], 0
v_mfma_f32_16x16x32_bf16 a[204:207], v[140:143], v[184:187], 0
v_mfma_f32_16x16x32_bf16 a[208:211], v[144:147], v[184:187], 0
v_mfma_f32_16x16x32_bf16 a[212:215], v[148:151], v[184:187], 0
v_mfma_f32_16x16x32_bf16 a[216:219], v[152:155], v[184:187], 0
v_mfma_f32_16x16x32_bf16 a[220:223], v[156:159], v[184:187], 0
v_mfma_f32_16x16x32_bf16 a[252:255], v[156:159], v[188:191], 0
v_mfma_f32_16x16x32_bf16 a[248:251], v[152:155], v[188:191], 0
v_mfma_f32_16x16x32_bf16 a[244:247], v[148:151], v[188:191], 0
v_mfma_f32_16x16x32_bf16 a[240:243], v[144:147], v[188:191], 0
v_mfma_f32_16x16x32_bf16 a[236:239], v[140:143], v[188:191], 0
v_mfma_f32_16x16x32_bf16 a[232:235], v[136:139], v[188:191], 0
s_nop 3
s_mov_b64 exec, 0
s_cmp_eq_u32 s58, 0
s_cbranch_scc1 Lstub0
s_cmp_eq_u32 s58, 1
s_cbranch_scc1 Lstub1
s_cmp_eq_u32 s58, 2
s_cbranch_scc1 Lstub2
s_branch Lstub3
Lret:
s_mov_b64 exec, -1
s_nop 3
v_mfma_f32_16x16x32_bf16 a[228:231], v[132:135], v[188:191], 0
s_waitcnt vmcnt(2) lgkmcnt(0)
v_mfma_f32_16x16x32_bf16 a[224:227], v[128:131], v[188:191], 0
s_barrier
v_mfma_f32_16x16x32_bf16 a[0:3], v[224:227], v[192:195], a[0:3]
s_and_b32 s73, s65, 1
ds_read_b64_tr_b16 v[160:161], v20 offset:32768
v_mfma_f32_16x16x32_bf16 a[4:7], v[224:227], v[196:199], a[4:7]
s_xor_b32 s73, s73, 2
ds_read_b64_tr_b16 v[162:163], v20 offset:33792
v_mfma_f32_16x16x32_bf16 a[8:11], v[224:227], v[200:203], a[8:11]
s_lshl_b32 s69, s73, 7
ds_read_b128 v[128:131], v24 offset:32768
v_mfma_f32_16x16x32_bf16 a[12:15], v[224:227], v[204:207], a[12:15]
s_add_u32 s69, s69, s84
ds_read_b128 v[132:135], v24 offset:34816
v_mfma_f32_16x16x32_bf16 a[16:19], v[224:227], v[208:211], a[16:19]
s_lshl_b32 s71, s73, 19
ds_read_b128 v[136:139], v24 offset:36864
v_mfma_f32_16x16x32_bf16 a[20:23], v[224:227], v[212:215], a[20:23]
s_add_u32 s71, s71, s66
ds_read_b128 v[140:143], v24 offset:38912
v_mfma_f32_16x16x32_bf16 a[24:27], v[224:227], v[216:219], a[24:27]
s_add_u32 m0, s63, 65536
ds_read_b128 v[144:147], v24 offset:40960
v_mfma_f32_16x16x32_bf16 a[28:31], v[224:227], v[220:223], a[28:31]
s_add_u32 s72, s69, 0
buffer_load_dwordx4 v2, s[8:11], s72 offen lds
v_mfma_f32_16x16x32_bf16 a[60:63], v[228:231], v[220:223], a[60:63]
s_add_u32 s72, s69, 7168
buffer_load_dwordx4 v3, s[8:11], s72 offen offset:1024 lds
v_mfma_f32_16x16x32_bf16 a[56:59], v[228:231], v[216:219], a[56:59]
s_add_u32 s72, s69, 14336
buffer_load_dwordx4 v2, s[8:11], s72 offen offset:2048 lds
v_mfma_f32_16x16x32_bf16 a[52:55], v[228:231], v[212:215], a[52:55]
ds_read_b128 v[148:151], v24 offset:43008
v_mfma_f32_16x16x32_bf16 a[48:51], v[228:231], v[208:211], a[48:51]
ds_read_b128 v[152:155], v24 offset:45056
v_mfma_f32_16x16x32_bf16 a[44:47], v[228:231], v[204:207], a[44:47]
s_add_u32 s72, s69, 21504
buffer_load_dwordx4 v3, s[8:11], s72 offen offset:3072 lds
v_mfma_f32_16x16x32_bf16 a[40:43], v[228:231], v[200:203], a[40:43]
ds_read_b128 v[156:159], v24 offset:47104
v_mfma_f32_16x16x32_bf16 a[36:39], v[228:231], v[196:199], a[36:39]
ds_read_b64_tr_b16 v[164:165], v21 offset:32768
v_mfma_f32_16x16x32_bf16 a[32:35], v[228:231], v[192:195], a[32:35]
ds_read_b64_tr_b16 v[166:167], v21 offset:33792
v_mfma_f32_16x16x32_bf16 a[64:67], v[232:235], v[192:195], a[64:67]
ds_read_b64_tr_b16 v[168:169], v22 offset:32768
v_mfma_f32_16x16x32_bf16 a[68:71], v[232:235], v[196:199], a[68:71]
s_add_u32 m0, s64, 0
ds_read_b64_tr_b16 v[170:171], v22 offset:33792
v_mfma_f32_16x16x32_bf16 a[72:75], v[232:235], v[200:203], a[72:75]
s_add_u32 s72, s71, 0
buffer_load_dwordx4 v6, s[16:19], s72 offen lds
v_mfma_f32_16x16x32_bf16 a[76:79], v[232:235], v[204:207], a[76:79]
ds_read_b64_tr_b16 v[172:173], v23 offset:32768
v_mfma_f32_16x16x32_bf16 a[80:83], v[232:235], v[208:211], a[80:83]
ds_read_b64_tr_b16 v[174:175], v23 offset:33792
v_mfma_f32_16x16x32_bf16 a[84:87], v[232:235], v[212:215], a[84:87]
s_add_u32 s72, s71, 31744
buffer_load_dwordx4 v6, s[16:19], s72 offen offset:1024 lds
v_mfma_f32_16x16x32_bf16 a[88:91], v[232:235], v[216:219], a[88:91]
ds_read_b64_tr_b16 v[176:177], v20 offset:49152
v_mfma_f32_16x16x32_bf16 a[92:95], v[232:235], v[220:223], a[92:95]
ds_read_b64_tr_b16 v[178:179], v20 offset:50176
v_mfma_f32_16x16x32_bf16 a[124:127], v[236:239], v[220:223], a[124:127]
ds_read_b64_tr_b16 v[180:181], v21 offset:49152
v_mfma_f32_16x16x32_bf16 a[120:123], v[236:239], v[216:219], a[120:123]
s_add_u32 s72, s71, 63488
buffer_load_dwordx4 v7, s[16:19], s72 offen offset:2048 lds
v_mfma_f32_16x16x32_bf16 a[116:119], v[236:239], v[212:215], a[116:119]
ds_read_b64_tr_b16 v[182:183], v21 offset:50176
v_mfma_f32_16x16x32_bf16 a[112:115], v[236:239], v[208:211], a[112:115]
ds_read_b64_tr_b16 v[184:185], v22 offset:49152
v_mfma_f32_16x16x32_bf16 a[108:111], v[236:239], v[204:207], a[108:111]
ds_read_b64_tr_b16 v[186:187], v22 offset:50176
v_mfma_f32_16x16x32_bf16 a[104:107], v[236:239], v[200:203], a[104:107]
ds_read_b64_tr_b16 v[188:189], v23 offset:49152
v_mfma_f32_16x16x32_bf16 a[100:103], v[236:239], v[196:199], a[100:103]
s_add_u32 s72, s71, 95232
buffer_load_dwordx4 v7, s[16:19], s72 offen offset:3072 lds
v_mfma_f32_16x16x32_bf16 a[96:99], v[236:239], v[192:195], a[96:99]
ds_read_b64_tr_b16 v[190:191], v23 offset:50176
v_mfma_f32_16x16x32_bf16 a[128:131], v[192:195], v[240:243], a[128:131]
v_mfma_f32_16x16x32_bf16 a[132:135], v[196:199], v[240:243], a[132:135]
v_mfma_f32_16x16x32_bf16 a[136:139], v[200:203], v[240:243], a[136:139]
s_add_u32 m0, s63, 69632
v_mfma_f32_16x16x32_bf16 a[140:143], v[204:207], v[240:243], a[140:143]
s_add_u32 s72, s69, 32768
buffer_load_dwordx4 v2, s[8:11], s72 offen lds
v_mfma_f32_16x16x32_bf16 a[144:147], v[208:211], v[240:243], a[144:147]
v_mfma_f32_16x16x32_bf16 a[148:151], v[212:215], v[240:243], a[148:151]
v_mfma_f32_16x16x32_bf16 a[152:155], v[216:219], v[240:243], a[152:155]
s_add_u32 s72, s69, 39936
buffer_load_dwordx4 v3, s[8:11], s72 offen offset:1024 lds
v_mfma_f32_16x16x32_bf16 a[156:159], v[220:223], v[240:243], a[156:159]
v_mfma_f32_16x16x32_bf16 a[188:191], v[220:223], v[244:247], a[188:191]
v_mfma_f32_16x16x32_bf16 a[184:187], v[216:219], v[244:247], a[184:187]
v_mfma_f32_16x16x32_bf16 a[180:183], v[212:215], v[244:247], a[180:183]
v_mfma_f32_16x16x32_bf16 a[176:179], v[208:211], v[244:247], a[176:179]
s_add_u32 s72, s69, 47104
buffer_load_dwordx4 v2, s[8:11], s72 offen offset:2048 lds
v_mfma_f32_16x16x32_bf16 a[172:175], v[204:207], v[244:247], a[172:175]
v_mfma_f32_16x16x32_bf16 a[168:171], v[200:203], v[244:247], a[168:171]
v_mfma_f32_16x16x32_bf16 a[164:167], v[196:199], v[244:247], a[164:167]
v_mfma_f32_16x16x32_bf16 a[160:163], v[192:195], v[244:247], a[160:163]
s_add_u32 s72, s69, 54272
buffer_load_dwordx4 v3, s[8:11], s72 offen offset:3072 lds
v_mfma_f32_16x16x32_bf16 a[192:195], v[192:195], v[248:251], a[192:195]
v_mfma_f32_16x16x32_bf16 a[196:199], v[196:199], v[248:251], a[196:199]
v_mfma_f32_16x16x32_bf16 a[200:203], v[200:203], v[248:251], a[200:203]
v_mfma_f32_16x16x32_bf16 a[204:207], v[204:207], v[248:251], a[204:207]
s_add_u32 m0, s64, 16384
v_mfma_f32_16x16x32_bf16 a[208:211], v[208:211], v[248:251], a[208:211]
s_add_u32 s72, s71, 0
buffer_load_dwordx4 v6, s[20:23], s72 offen lds
v_mfma_f32_16x16x32_bf16 a[212:215], v[212:215], v[248:251], a[212:215]
v_mfma_f32_16x16x32_bf16 a[216:219], v[216:219], v[248:251], a[216:219]
v_mfma_f32_16x16x32_bf16 a[220:223], v[220:223], v[248:251], a[220:223]
v_mfma_f32_16x16x32_bf16 a[252:255], v[220:223], v[252:255], a[252:255]
s_add_u32 s72, s71, 31744
buffer_load_dwordx4 v6, s[20:23], s72 offen offset:1024 lds
v_mfma_f32_16x16x32_bf16 a[248:251], v[216:219], v[252:255], a[248:251]
v_mfma_f32_16x16x32_bf16 a[244:247], v[212:215], v[252:255], a[244:247]
v_mfma_f32_16x16x32_bf16 a[240:243], v[208:211], v[252:255], a[240:243]
v_mfma_f32_16x16x32_bf16 a[236:239], v[204:207], v[252:255], a[236:239]
s_add_u32 s72, s71, 63488
buffer_load_dwordx4 v7, s[20:23], s72 offen offset:2048 lds
v_mfma_f32_16x16x32_bf16 a[232:235], v[200:203], v[252:255], a[232:235]
v_mfma_f32_16x16x32_bf16 a[228:231], v[196:199], v[252:255], a[228:231]
v_mfma_f32_16x16x32_bf16 a[224:227], v[192:195], v[252:255], a[224:227]
s_waitcnt lgkmcnt(0)
v_mfma_f32_16x16x32_bf16 a[0:3], v[160:163], v[128:131], a[0:3]
s_add_u32 s72, s71, 95232
buffer_load_dwordx4 v7, s[20:23], s72 offen offset:3072 lds
v_mfma_f32_16x16x32_bf16 a[4:7], v[160:163], v[132:135], a[4:7]
s_mov_b32 s80, 0x200000
buffer_load_dword v126, v125, s[16:19], s80 offen
v_mfma_f32_16x16x32_bf16 a[8:11], v[160:163], v[136:139], a[8:11]
buffer_load_dword v126, v125, s[20:23], s80 offen
v_mfma_f32_16x16x32_bf16 a[12:15], v[160:163], v[140:143], a[12:15]
global_load_dwordx4 v[68:71], v30, s[52:53]
v_mfma_f32_16x16x32_bf16 a[16:19], v[160:163], v[144:147], a[16:19]
buffer_load_dword v33, v27, s[28:31], 0 offen nt
v_mfma_f32_16x16x32_bf16 a[20:23], v[160:163], v[148:151], a[20:23]
buffer_load_dword v34, v27, s[28:31], 0 offen offset:2048 nt
v_mfma_f32_16x16x32_bf16 a[24:27], v[160:163], v[152:155], a[24:27]
ds_read_b64_tr_b16 v[224:225], v20 offset:40960
v_add_u32 v27, 0x1000, v27
v_mfma_f32_16x16x32_bf16 a[28:31], v[160:163], v[156:159], a[28:31]
buffer_load_dword v35, v27, s[28:31], 0 offen nt
v_mfma_f32_16x16x32_bf16 a[60:63], v[164:167], v[156:159], a[60:63]
s_add_u32 m0, s63, 131072
ds_read_b64_tr_b16 v[226:227], v20 offset:41984
v_mfma_f32_16x16x32_bf16 a[56:59], v[164:167], v[152:155], a[56:59]
s_add_u32 s80, s82, 0
buffer_load_dwordx4 v26, s[28:31], s80 offen nt lds
v_mfma_f32_16x16x32_bf16 a[52:55], v[164:167], v[148:151], a[52:55]
s_add_u32 s80, s82, 15360
buffer_load_dwordx4 v26, s[28:31], s80 offen offset:1024 nt lds
v_mfma_f32_16x16x32_bf16 a[48:51], v[164:167], v[144:147], a[48:51]
s_add_u32 s80, s82, 30720
buffer_load_dwordx4 v26, s[28:31], s80 offen offset:2048 nt lds
v_mfma_f32_16x16x32_bf16 a[44:47], v[164:167], v[140:143], a[44:47]
s_add_u32 s80, s82, 46080
buffer_load_dwordx4 v26, s[28:31], s80 offen offset:3072 nt lds
v_mfma_f32_16x16x32_bf16 a[40:43], v[164:167], v[136:139], a[40:43]
ds_read_b128 v[192:195], v25 offset:32768
v_mfma_f32_16x16x32_bf16 a[36:39], v[164:167], v[132:135], a[36:39]
ds_read_b128 v[196:199], v25 offset:34816
v_mfma_f32_16x16x32_bf16 a[32:35], v[164:167], v[128:131], a[32:35]
ds_read_b128 v[200:203], v25 offset:36864
v_mfma_f32_16x16x32_bf16 a[64:67], v[168:171], v[128:131], a[64:67]
ds_read_b128 v[204:207], v25 offset:38912
v_mfma_f32_16x16x32_bf16 a[68:71], v[168:171], v[132:135], a[68:71]
ds_read_b128 v[208:211], v25 offset:40960
v_mfma_f32_16x16x32_bf16 a[72:75], v[168:171], v[136:139], a[72:75]
ds_read_b128 v[212:215], v25 offset:43008
v_mfma_f32_16x16x32_bf16 a[76:79], v[168:171], v[140:143], a[76:79]
ds_read_b128 v[216:219], v25 offset:45056
v_mfma_f32_16x16x32_bf16 a[80:83], v[168:171], v[144:147], a[80:83]
ds_read_b128 v[220:223], v25 offset:47104
v_mfma_f32_16x16x32_bf16 a[84:87], v[168:171], v[148:151], a[84:87]
ds_read_b64_tr_b16 v[228:229], v21 offset:40960
v_mfma_f32_16x16x32_bf16 a[88:91], v[168:171], v[152:155], a[88:91]
ds_read_b64_tr_b16 v[230:231], v21 offset:41984
v_mfma_f32_16x16x32_bf16 a[92:95], v[168:171], v[156:159], a[92:95]
ds_read_b64_tr_b16 v[232:233], v22 offset:40960
v_mfma_f32_16x16x32_bf16 a[124:127], v[172:175], v[156:159], a[124:127]
ds_read_b64_tr_b16 v[234:235], v22 offset:41984
v_mfma_f32_16x16x32_bf16 a[120:123], v[172:175], v[152:155], a[120:123]
ds_read_b64_tr_b16 v[236:237], v23 offset:40960
v_mfma_f32_16x16x32_bf16 a[116:119], v[172:175], v[148:151], a[116:119]
ds_read_b64_tr_b16 v[238:239], v23 offset:41984
v_mfma_f32_16x16x32_bf16 a[112:115], v[172:175], v[144:147], a[112:115]
ds_read_b64_tr_b16 v[240:241], v20 offset:57344
v_mfma_f32_16x16x32_bf16 a[108:111], v[172:175], v[140:143], a[108:111]
ds_read_b64_tr_b16 v[242:243], v20 offset:58368
v_mfma_f32_16x16x32_bf16 a[104:107], v[172:175], v[136:139], a[104:107]
ds_read_b64_tr_b16 v[244:245], v21 offset:57344
v_mfma_f32_16x16x32_bf16 a[100:103], v[172:175], v[132:135], a[100:103]
ds_read_b64_tr_b16 v[246:247], v21 offset:58368
v_mfma_f32_16x16x32_bf16 a[96:99], v[172:175], v[128:131], a[96:99]
ds_read_b64_tr_b16 v[248:249], v22 offset:57344
v_mfma_f32_16x16x32_bf16 a[128:131], v[128:131], v[176:179], a[128:131]
ds_read_b64_tr_b16 v[250:251], v22 offset:58368
v_mfma_f32_16x16x32_bf16 a[132:135], v[132:135], v[176:179], a[132:135]
ds_read_b64_tr_b16 v[252:253], v23 offset:57344
v_mfma_f32_16x16x32_bf16 a[136:139], v[136:139], v[176:179], a[136:139]
ds_read_b64_tr_b16 v[254:255], v23 offset:58368
v_mfma_f32_16x16x32_bf16 a[140:143], v[140:143], v[176:179], a[140:143]
v_mfma_f32_16x16x32_bf16 a[144:147], v[144:147], v[176:179], a[144:147]
v_mfma_f32_16x16x32_bf16 a[148:151], v[148:151], v[176:179], a[148:151]
v_mfma_f32_16x16x32_bf16 a[152:155], v[152:155], v[176:179], a[152:155]
v_mfma_f32_16x16x32_bf16 a[156:159], v[156:159], v[176:179], a[156:159]
v_mfma_f32_16x16x32_bf16 a[188:191], v[156:159], v[180:183], a[188:191]
v_mfma_f32_16x16x32_bf16 a[184:187], v[152:155], v[180:183], a[184:187]
v_mfma_f32_16x16x32_bf16 a[180:183], v[148:151], v[180:183], a[180:183]
v_mfma_f32_16x16x32_bf16 a[176:179], v[144:147], v[180:183], a[176:179]
v_mfma_f32_16x16x32_bf16 a[172:175], v[140:143], v[180:183], a[172:175]
v_mfma_f32_16x16x32_bf16 a[168:171], v[136:139], v[180:183], a[168:171]
v_mfma_f32_16x16x32_bf16 a[164:167], v[132:135], v[180:183], a[164:167]
v_mfma_f32_16x16x32_bf16 a[160:163], v[128:131], v[180:183], a[160:163]
v_mfma_f32_16x16x32_bf16 a[192:195], v[128:131], v[184:187], a[192:195]
v_mfma_f32_16x16x32_bf16 a[196:199], v[132:135], v[184:187], a[196:199]
v_mfma_f32_16x16x32_bf16 a[200:203], v[136:139], v[184:187], a[200:203]
v_mfma_f32_16x16x32_bf16 a[204:207], v[140:143], v[184:187], a[204:207]
v_mfma_f32_16x16x32_bf16 a[208:211], v[144:147], v[184:187], a[208:211]
v_mfma_f32_16x16x32_bf16 a[212:215], v[148:151], v[184:187], a[212:215]
v_mfma_f32_16x16x32_bf16 a[216:219], v[152:155], v[184:187], a[216:219]
v_mfma_f32_16x16x32_bf16 a[220:223], v[156:159], v[184:187], a[220:223]
v_mfma_f32_16x16x32_bf16 a[252:255], v[156:159], v[188:191], a[252:255]
v_mfma_f32_16x16x32_bf16 a[248:251], v[152:155], v[188:191], a[248:251]
v_mfma_f32_16x16x32_bf16 a[244:247], v[148:151], v[188:191], a[244:247]
v_mfma_f32_16x16x32_bf16 a[240:243], v[144:147], v[188:191], a[240:243]
v_mfma_f32_16x16x32_bf16 a[236:239], v[140:143], v[188:191], a[236:239]
v_mfma_f32_16x16x32_bf16 a[232:235], v[136:139], v[188:191], a[232:235]
v_mfma_f32_16x16x32_bf16 a[228:231], v[132:135], v[188:191], a[228:231]
s_waitcnt vmcnt(10) lgkmcnt(0)
v_mfma_f32_16x16x32_bf16 a[224:227], v[128:131], v[188:191], a[224:227]
s_barrier
v_mfma_f32_16x16x32_bf16 a[0:3], v[224:227], v[192:195], a[0:3]
s_and_b32 s73, s65, 1
ds_read_b64_tr_b16 v[160:161], v20 offset:0
v_mfma_f32_16x16x32_bf16 a[4:7], v[224:227], v[196:199], a[4:7]
s_xor_b32 s73, s73, 3
ds_read_b64_tr_b16 v[162:163], v20 offset:1024
v_mfma_f32_16x16x32_bf16 a[8:11], v[224:227], v[200:203], a[8:11]
s_lshl_b32 s69, s73, 7
ds_read_b128 v[128:131], v24 offset:0
v_mfma_f32_16x16x32_bf16 a[12:15], v[224:227], v[204:207], a[12:15]
s_add_u32 s69, s69, s84
ds_read_b128 v[132:135], v24 offset:2048
v_mfma_f32_16x16x32_bf16 a[16:19], v[224:227], v[208:211], a[16:19]
s_lshl_b32 s71, s73, 19
ds_read_b128 v[136:139], v24 offset:4096
v_mfma_f32_16x16x32_bf16 a[20:23], v[224:227], v[212:215], a[20:23]
s_add_u32 s71, s71, s66
ds_read_b128 v[140:143], v24 offset:6144
v_mfma_f32_16x16x32_bf16 a[24:27], v[224:227], v[216:219], a[24:27]
s_add_u32 m0, s63, 98304
ds_read_b128 v[144:147], v24 offset:8192
v_mfma_f32_16x16x32_bf16 a[28:31], v[224:227], v[220:223], a[28:31]
s_add_u32 s72, s69, 0
buffer_load_dwordx4 v2, s[8:11], s72 offen lds
v_mfma_f32_16x16x32_bf16 a[60:63], v[228:231], v[220:223], a[60:63]
s_add_u32 s72, s69, 7168
buffer_load_dwordx4 v3, s[8:11], s72 offen offset:1024 lds
v_mfma_f32_16x16x32_bf16 a[56:59], v[228:231], v[216:219], a[56:59]
s_add_u32 s72, s69, 14336
buffer_load_dwordx4 v2, s[8:11], s72 offen offset:2048 lds
v_mfma_f32_16x16x32_bf16 a[52:55], v[228:231], v[212:215], a[52:55]
ds_read_b128 v[148:151], v24 offset:10240
v_mfma_f32_16x16x32_bf16 a[48:51], v[228:231], v[208:211], a[48:51]
ds_read_b128 v[152:155], v24 offset:12288
v_mfma_f32_16x16x32_bf16 a[44:47], v[228:231], v[204:207], a[44:47]
s_add_u32 s72, s69, 21504
buffer_load_dwordx4 v3, s[8:11], s72 offen offset:3072 lds
v_mfma_f32_16x16x32_bf16 a[40:43], v[228:231], v[200:203], a[40:43]
ds_read_b128 v[156:159], v24 offset:14336
v_mfma_f32_16x16x32_bf16 a[36:39], v[228:231], v[196:199], a[36:39]
ds_read_b64_tr_b16 v[164:165], v21 offset:0
v_mfma_f32_16x16x32_bf16 a[32:35], v[228:231], v[192:195], a[32:35]
ds_read_b64_tr_b16 v[166:167], v21 offset:1024
v_mfma_f32_16x16x32_bf16 a[64:67], v[232:235], v[192:195], a[64:67]
ds_read_b64_tr_b16 v[168:169], v22 offset:0
v_mfma_f32_16x16x32_bf16 a[68:71], v[232:235], v[196:199], a[68:71]
s_add_u32 m0, s64, 32768
ds_read_b64_tr_b16 v[170:171], v22 offset:1024
v_mfma_f32_16x16x32_bf16 a[72:75], v[232:235], v[200:203], a[72:75]
s_add_u32 s72, s71, 0
buffer_load_dwordx4 v6, s[16:19], s72 offen lds
v_mfma_f32_16x16x32_bf16 a[76:79], v[232:235], v[204:207], a[76:79]
ds_read_b64_tr_b16 v[172:173], v23 offset:0
v_mfma_f32_16x16x32_bf16 a[80:83], v[232:235], v[208:211], a[80:83]
ds_read_b64_tr_b16 v[174:175], v23 offset:1024
v_mfma_f32_16x16x32_bf16 a[84:87], v[232:235], v[212:215], a[84:87]
s_add_u32 s72, s71, 31744
buffer_load_dwordx4 v6, s[16:19], s72 offen offset:1024 lds
v_mfma_f32_16x16x32_bf16 a[88:91], v[232:235], v[216:219], a[88:91]
ds_read_b64_tr_b16 v[176:177], v20 offset:16384
v_mfma_f32_16x16x32_bf16 a[92:95], v[232:235], v[220:223], a[92:95]
ds_read_b64_tr_b16 v[178:179], v20 offset:17408
v_mfma_f32_16x16x32_bf16 a[124:127], v[236:239], v[220:223], a[124:127]
ds_read_b64_tr_b16 v[180:181], v21 offset:16384
v_mfma_f32_16x16x32_bf16 a[120:123], v[236:239], v[216:219], a[120:123]
s_add_u32 s72, s71, 63488
buffer_load_dwordx4 v7, s[16:19], s72 offen offset:2048 lds
v_mfma_f32_16x16x32_bf16 a[116:119], v[236:239], v[212:215], a[116:119]
ds_read_b64_tr_b16 v[182:183], v21 offset:17408
v_mfma_f32_16x16x32_bf16 a[112:115], v[236:239], v[208:211], a[112:115]
ds_read_b64_tr_b16 v[184:185], v22 offset:16384
v_mfma_f32_16x16x32_bf16 a[108:111], v[236:239], v[204:207], a[108:111]
ds_read_b64_tr_b16 v[186:187], v22 offset:17408
v_mfma_f32_16x16x32_bf16 a[104:107], v[236:239], v[200:203], a[104:107]
ds_read_b64_tr_b16 v[188:189], v23 offset:16384
v_mfma_f32_16x16x32_bf16 a[100:103], v[236:239], v[196:199], a[100:103]
s_add_u32 s72, s71, 95232
buffer_load_dwordx4 v7, s[16:19], s72 offen offset:3072 lds
v_mfma_f32_16x16x32_bf16 a[96:99], v[236:239], v[192:195], a[96:99]
ds_read_b64_tr_b16 v[190:191], v23 offset:17408
v_mfma_f32_16x16x32_bf16 a[128:131], v[192:195], v[240:243], a[128:131]
v_mfma_f32_16x16x32_bf16 a[132:135], v[196:199], v[240:243], a[132:135]
v_mfma_f32_16x16x32_bf16 a[136:139], v[200:203], v[240:243], a[136:139]
s_add_u32 m0, s63, 102400
v_mfma_f32_16x16x32_bf16 a[140:143], v[204:207], v[240:243], a[140:143]
s_add_u32 s72, s69, 32768
buffer_load_dwordx4 v2, s[8:11], s72 offen lds
v_mfma_f32_16x16x32_bf16 a[144:147], v[208:211], v[240:243], a[144:147]
v_mfma_f32_16x16x32_bf16 a[148:151], v[212:215], v[240:243], a[148:151]
v_mfma_f32_16x16x32_bf16 a[152:155], v[216:219], v[240:243], a[152:155]
s_add_u32 s72, s69, 39936
buffer_load_dwordx4 v3, s[8:11], s72 offen offset:1024 lds
v_mfma_f32_16x16x32_bf16 a[156:159], v[220:223], v[240:243], a[156:159]
v_mfma_f32_16x16x32_bf16 a[188:191], v[220:223], v[244:247], a[188:191]
v_mfma_f32_16x16x32_bf16 a[184:187], v[216:219], v[244:247], a[184:187]
v_mfma_f32_16x16x32_bf16 a[180:183], v[212:215], v[244:247], a[180:183]
v_mfma_f32_16x16x32_bf16 a[176:179], v[208:211], v[244:247], a[176:179]
s_add_u32 s72, s69, 47104
buffer_load_dwordx4 v2, s[8:11], s72 offen offset:2048 lds
v_mfma_f32_16x16x32_bf16 a[172:175], v[204:207], v[244:247], a[172:175]
v_mfma_f32_16x16x32_bf16 a[168:171], v[200:203], v[244:247], a[168:171]
v_mfma_f32_16x16x32_bf16 a[164:167], v[196:199], v[244:247], a[164:167]
v_mfma_f32_16x16x32_bf16 a[160:163], v[192:195], v[244:247], a[160:163]
s_add_u32 s72, s69, 54272
buffer_load_dwordx4 v3, s[8:11], s72 offen offset:3072 lds
v_mfma_f32_16x16x32_bf16 a[192:195], v[192:195], v[248:251], a[192:195]
v_mfma_f32_16x16x32_bf16 a[196:199], v[196:199], v[248:251], a[196:199]
v_mfma_f32_16x16x32_bf16 a[200:203], v[200:203], v[248:251], a[200:203]
v_mfma_f32_16x16x32_bf16 a[204:207], v[204:207], v[248:251], a[204:207]
s_add_u32 m0, s64, 49152
v_mfma_f32_16x16x32_bf16 a[208:211], v[208:211], v[248:251], a[208:211]
s_add_u32 s72, s71, 0
buffer_load_dwordx4 v6, s[20:23], s72 offen lds
v_mfma_f32_16x16x32_bf16 a[212:215], v[212:215], v[248:251], a[212:215]
v_mfma_f32_16x16x32_bf16 a[216:219], v[216:219], v[248:251], a[216:219]
v_mfma_f32_16x16x32_bf16 a[220:223], v[220:223], v[248:251], a[220:223]
v_mfma_f32_16x16x32_bf16 a[252:255], v[220:223], v[252:255], a[252:255]
s_add_u32 s72, s71, 31744
buffer_load_dwordx4 v6, s[20:23], s72 offen offset:1024 lds
v_mfma_f32_16x16x32_bf16 a[248:251], v[216:219], v[252:255], a[248:251]
v_mfma_f32_16x16x32_bf16 a[244:247], v[212:215], v[252:255], a[244:247]
v_mfma_f32_16x16x32_bf16 a[240:243], v[208:211], v[252:255], a[240:243]
v_mfma_f32_16x16x32_bf16 a[236:239], v[204:207], v[252:255], a[236:239]
s_add_u32 s72, s71, 63488
buffer_load_dwordx4 v7, s[20:23], s72 offen offset:2048 lds
v_mfma_f32_16x16x32_bf16 a[232:235], v[200:203], v[252:255], a[232:235]
v_mfma_f32_16x16x32_bf16 a[228:231], v[196:199], v[252:255], a[228:231]
v_mfma_f32_16x16x32_bf16 a[224:227], v[192:195], v[252:255], a[224:227]
s_waitcnt lgkmcnt(0)
v_mfma_f32_16x16x32_bf16 a[0:3], v[160:163], v[128:131], a[0:3]
s_add_u32 s72, s71, 95232
buffer_load_dwordx4 v7, s[20:23], s72 offen offset:3072 lds
v_mfma_f32_16x16x32_bf16 a[4:7], v[160:163], v[132:135], a[4:7]
s_mov_b32 s80, 0x300000
buffer_load_dword v126, v125, s[16:19], s80 offen
v_mfma_f32_16x16x32_bf16 a[8:11], v[160:163], v[136:139], a[8:11]
buffer_load_dword v126, v125, s[20:23], s80 offen
v_mfma_f32_16x16x32_bf16 a[12:15], v[160:163], v[140:143], a[12:15]
s_add_u32 m0, s63, 135168
ds_read_b64_tr_b16 v[224:225], v20 offset:8192
v_mfma_f32_16x16x32_bf16 a[16:19], v[160:163], v[144:147], a[16:19]
s_add_u32 s80, s82, 0
buffer_load_dwordx4 v26, s[32:35], s80 offen nt lds
v_mfma_f32_16x16x32_bf16 a[20:23], v[160:163], v[148:151], a[20:23]
s_add_u32 s80, s82, 15360
buffer_load_dwordx4 v26, s[32:35], s80 offen offset:1024 nt lds
v_mfma_f32_16x16x32_bf16 a[24:27], v[160:163], v[152:155], a[24:27]
s_add_u32 s80, s82, 30720
buffer_load_dwordx4 v26, s[32:35], s80 offen offset:2048 nt lds
v_mfma_f32_16x16x32_bf16 a[28:31], v[160:163], v[156:159], a[28:31]
s_add_u32 s80, s82, 46080
buffer_load_dwordx4 v26, s[32:35], s80 offen offset:3072 nt lds
v_mfma_f32_16x16x32_bf16 a[60:63], v[164:167], v[156:159], a[60:63]
ds_read_b64_tr_b16 v[226:227], v20 offset:9216
v_mfma_f32_16x16x32_bf16 a[56:59], v[164:167], v[152:155], a[56:59]
ds_read_b128 v[192:195], v25 offset:0
v_mfma_f32_16x16x32_bf16 a[52:55], v[164:167], v[148:151], a[52:55]
ds_read_b128 v[196:199], v25 offset:2048
v_mfma_f32_16x16x32_bf16 a[48:51], v[164:167], v[144:147], a[48:51]
ds_read_b128 v[200:203], v25 offset:4096
v_mfma_f32_16x16x32_bf16 a[44:47], v[164:167], v[140:143], a[44:47]
ds_read_b128 v[204:207], v25 offset:6144
v_mfma_f32_16x16x32_bf16 a[40:43], v[164:167], v[136:139], a[40:43]
ds_read_b128 v[208:211], v25 offset:8192
v_mfma_f32_16x16x32_bf16 a[36:39], v[164:167], v[132:135], a[36:39]
ds_read_b128 v[212:215], v25 offset:10240
v_mfma_f32_16x16x32_bf16 a[32:35], v[164:167], v[128:131], a[32:35]
ds_read_b128 v[216:219], v25 offset:12288
v_mfma_f32_16x16x32_bf16 a[64:67], v[168:171], v[128:131], a[64:67]
ds_read_b128 v[220:223], v25 offset:14336
v_mfma_f32_16x16x32_bf16 a[68:71], v[168:171], v[132:135], a[68:71]
ds_read_b64_tr_b16 v[228:229], v21 offset:8192
v_mfma_f32_16x16x32_bf16 a[72:75], v[168:171], v[136:139], a[72:75]
ds_read_b64_tr_b16 v[230:231], v21 offset:9216
v_mfma_f32_16x16x32_bf16 a[76:79], v[168:171], v[140:143], a[76:79]
ds_read_b64_tr_b16 v[232:233], v22 offset:8192
v_mfma_f32_16x16x32_bf16 a[80:83], v[168:171], v[144:147], a[80:83]
ds_read_b64_tr_b16 v[234:235], v22 offset:9216
v_mfma_f32_16x16x32_bf16 a[84:87], v[168:171], v[148:151], a[84:87]
ds_read_b64_tr_b16 v[236:237], v23 offset:8192
v_mfma_f32_16x16x32_bf16 a[88:91], v[168:171], v[152:155], a[88:91]
ds_read_b64_tr_b16 v[238:239], v23 offset:9216
v_mfma_f32_16x16x32_bf16 a[92:95], v[168:171], v[156:159], a[92:95]
ds_read_b64_tr_b16 v[240:241], v20 offset:24576
v_mfma_f32_16x16x32_bf16 a[124:127], v[172:175], v[156:159], a[124:127]
ds_read_b64_tr_b16 v[242:243], v20 offset:25600
v_mfma_f32_16x16x32_bf16 a[120:123], v[172:175], v[152:155], a[120:123]
ds_read_b64_tr_b16 v[244:245], v21 offset:24576
v_mfma_f32_16x16x32_bf16 a[116:119], v[172:175], v[148:151], a[116:119]
ds_read_b64_tr_b16 v[246:247], v21 offset:25600
v_mfma_f32_16x16x32_bf16 a[112:115], v[172:175], v[144:147], a[112:115]
ds_read_b64_tr_b16 v[248:249], v22 offset:24576
v_mfma_f32_16x16x32_bf16 a[108:111], v[172:175], v[140:143], a[108:111]
ds_read_b64_tr_b16 v[250:251], v22 offset:25600
v_mfma_f32_16x16x32_bf16 a[104:107], v[172:175], v[136:139], a[104:107]
ds_read_b64_tr_b16 v[252:253], v23 offset:24576
v_mfma_f32_16x16x32_bf16 a[100:103], v[172:175], v[132:135], a[100:103]
ds_read_b64_tr_b16 v[254:255], v23 offset:25600
v_mfma_f32_16x16x32_bf16 a[96:99], v[172:175], v[128:131], a[96:99]
v_mfma_f32_16x16x32_bf16 a[128:131], v[128:131], v[176:179], a[128:131]
v_mfma_f32_16x16x32_bf16 a[132:135], v[132:135], v[176:179], a[132:135]
v_mfma_f32_16x16x32_bf16 a[136:139], v[136:139], v[176:179], a[136:139]
v_mfma_f32_16x16x32_bf16 a[140:143], v[140:143], v[176:179], a[140:143]
v_mfma_f32_16x16x32_bf16 a[144:147], v[144:147], v[176:179], a[144:147]
v_mfma_f32_16x16x32_bf16 a[148:151], v[148:151], v[176:179], a[148:151]
v_mfma_f32_16x16x32_bf16 a[152:155], v[152:155], v[176:179], a[152:155]
v_mfma_f32_16x16x32_bf16 a[156:159], v[156:159], v[176:179], a[156:159]
v_mfma_f32_16x16x32_bf16 a[188:191], v[156:159], v[180:183], a[188:191]
v_mfma_f32_16x16x32_bf16 a[184:187], v[152:155], v[180:183], a[184:187]
v_mfma_f32_16x16x32_bf16 a[180:183], v[148:151], v[180:183], a[180:183]
v_mfma_f32_16x16x32_bf16 a[176:179], v[144:147], v[180:183], a[176:179]
v_mfma_f32_16x16x32_bf16 a[172:175], v[140:143], v[180:183], a[172:175]
v_mfma_f32_16x16x32_bf16 a[168:171], v[136:139], v[180:183], a[168:171]
v_mfma_f32_16x16x32_bf16 a[164:167], v[132:135], v[180:183], a[164:167]
v_mfma_f32_16x16x32_bf16 a[160:163], v[128:131], v[180:183], a[160:163]
v_mfma_f32_16x16x32_bf16 a[192:195], v[128:131], v[184:187], a[192:195]
v_mfma_f32_16x16x32_bf16 a[196:199], v[132:135], v[184:187], a[196:199]
v_mfma_f32_16x16x32_bf16 a[200:203], v[136:139], v[184:187], a[200:203]
v_mfma_f32_16x16x32_bf16 a[204:207], v[140:143], v[184:187], a[204:207]
v_mfma_f32_16x16x32_bf16 a[208:211], v[144:147], v[184:187], a[208:211]
v_mfma_f32_16x16x32_bf16 a[212:215], v[148:151], v[184:187], a[212:215]
v_mfma_f32_16x16x32_bf16 a[216:219], v[152:155], v[184:187], a[216:219]
v_mfma_f32_16x16x32_bf16 a[220:223], v[156:159], v[184:187], a[220:223]
v_mfma_f32_16x16x32_bf16 a[252:255], v[156:159], v[188:191], a[252:255]
v_mfma_f32_16x16x32_bf16 a[248:251], v[152:155], v[188:191], a[248:251]
v_mfma_f32_16x16x32_bf16 a[244:247], v[148:151], v[188:191], a[244:247]
v_mfma_f32_16x16x32_bf16 a[240:243], v[144:147], v[188:191], a[240:243]
v_mfma_f32_16x16x32_bf16 a[236:239], v[140:143], v[188:191], a[236:239]
v_mfma_f32_16x16x32_bf16 a[232:235], v[136:139], v[188:191], a[232:235]
v_mfma_f32_16x16x32_bf16 a[228:231], v[132:135], v[188:191], a[228:231]
s_waitcnt vmcnt(6) lgkmcnt(0)
v_mfma_f32_16x16x32_bf16 a[224:227], v[128:131], v[188:191], a[224:227]
s_barrier
v_mfma_f32_16x16x32_bf16 a[0:3], v[224:227], v[192:195], a[0:3]
s_and_b32 s73, s65, 1
ds_read_b64_tr_b16 v[160:161], v20 offset:32768
v_mfma_f32_16x16x32_bf16 a[4:7], v[224:227], v[196:199], a[4:7]
s_xor_b32 s73, s73, 4
ds_read_b64_tr_b16 v[162:163], v20 offset:33792
v_mfma_f32_16x16x32_bf16 a[8:11], v[224:227], v[200:203], a[8:11]
s_lshl_b32 s69, s73, 7
ds_read_b128 v[128:131], v24 offset:32768
v_mfma_f32_16x16x32_bf16 a[12:15], v[224:227], v[204:207], a[12:15]
s_add_u32 s69, s69, s84
ds_read_b128 v[132:135], v24 offset:34816
v_mfma_f32_16x16x32_bf16 a[16:19], v[224:227], v[208:211], a[16:19]
s_lshl_b32 s71, s73, 19
ds_read_b128 v[136:139], v24 offset:36864
v_mfma_f32_16x16x32_bf16 a[20:23], v[224:227], v[212:215], a[20:23]
s_add_u32 s71, s71, s66
ds_read_b128 v[140:143], v24 offset:38912
v_mfma_f32_16x16x32_bf16 a[24:27], v[224:227], v[216:219], a[24:27]
s_add_u32 m0, s63, 65536
ds_read_b128 v[144:147], v24 offset:40960
v_mfma_f32_16x16x32_bf16 a[28:31], v[224:227], v[220:223], a[28:31]
s_add_u32 s72, s69, 0
buffer_load_dwordx4 v2, s[8:11], s72 offen lds
v_mfma_f32_16x16x32_bf16 a[60:63], v[228:231], v[220:223], a[60:63]
s_add_u32 s72, s69, 7168
buffer_load_dwordx4 v3, s[8:11], s72 offen offset:1024 lds
v_mfma_f32_16x16x32_bf16 a[56:59], v[228:231], v[216:219], a[56:59]
s_add_u32 s72, s69, 14336
buffer_load_dwordx4 v2, s[8:11], s72 offen offset:2048 lds
v_mfma_f32_16x16x32_bf16 a[52:55], v[228:231], v[212:215], a[52:55]
ds_read_b128 v[148:151], v24 offset:43008
v_mfma_f32_16x16x32_bf16 a[48:51], v[228:231], v[208:211], a[48:51]
ds_read_b128 v[152:155], v24 offset:45056
v_mfma_f32_16x16x32_bf16 a[44:47], v[228:231], v[204:207], a[44:47]
s_add_u32 s72, s69, 21504
buffer_load_dwordx4 v3, s[8:11], s72 offen offset:3072 lds
v_mfma_f32_16x16x32_bf16 a[40:43], v[228:231], v[200:203], a[40:43]
ds_read_b128 v[156:159], v24 offset:47104
v_mfma_f32_16x16x32_bf16 a[36:39], v[228:231], v[196:199], a[36:39]
ds_read_b64_tr_b16 v[164:165], v21 offset:32768
v_mfma_f32_16x16x32_bf16 a[32:35], v[228:231], v[192:195], a[32:35]
ds_read_b64_tr_b16 v[166:167], v21 offset:33792
v_mfma_f32_16x16x32_bf16 a[64:67], v[232:235], v[192:195], a[64:67]
ds_read_b64_tr_b16 v[168:169], v22 offset:32768
v_mfma_f32_16x16x32_bf16 a[68:71], v[232:235], v[196:199], a[68:71]
s_add_u32 m0, s64, 0
ds_read_b64_tr_b16 v[170:171], v22 offset:33792
v_mfma_f32_16x16x32_bf16 a[72:75], v[232:235], v[200:203], a[72:75]
s_add_u32 s72, s71, 0
buffer_load_dwordx4 v6, s[16:19], s72 offen lds
v_mfma_f32_16x16x32_bf16 a[76:79], v[232:235], v[204:207], a[76:79]
ds_read_b64_tr_b16 v[172:173], v23 offset:32768
v_mfma_f32_16x16x32_bf16 a[80:83], v[232:235], v[208:211], a[80:83]
ds_read_b64_tr_b16 v[174:175], v23 offset:33792
v_mfma_f32_16x16x32_bf16 a[84:87], v[232:235], v[212:215], a[84:87]
s_add_u32 s72, s71, 31744
buffer_load_dwordx4 v6, s[16:19], s72 offen offset:1024 lds
v_mfma_f32_16x16x32_bf16 a[88:91], v[232:235], v[216:219], a[88:91]
ds_read_b64_tr_b16 v[176:177], v20 offset:49152
v_mfma_f32_16x16x32_bf16 a[92:95], v[232:235], v[220:223], a[92:95]
ds_read_b64_tr_b16 v[178:179], v20 offset:50176
v_mfma_f32_16x16x32_bf16 a[124:127], v[236:239], v[220:223], a[124:127]
ds_read_b64_tr_b16 v[180:181], v21 offset:49152
v_mfma_f32_16x16x32_bf16 a[120:123], v[236:239], v[216:219], a[120:123]
s_add_u32 s72, s71, 63488
buffer_load_dwordx4 v7, s[16:19], s72 offen offset:2048 lds
v_mfma_f32_16x16x32_bf16 a[116:119], v[236:239], v[212:215], a[116:119]
ds_read_b64_tr_b16 v[182:183], v21 offset:50176
v_mfma_f32_16x16x32_bf16 a[112:115], v[236:239], v[208:211], a[112:115]
ds_read_b64_tr_b16 v[184:185], v22 offset:49152
v_mfma_f32_16x16x32_bf16 a[108:111], v[236:239], v[204:207], a[108:111]
ds_read_b64_tr_b16 v[186:187], v22 offset:50176
v_mfma_f32_16x16x32_bf16 a[104:107], v[236:239], v[200:203], a[104:107]
ds_read_b64_tr_b16 v[188:189], v23 offset:49152
v_mfma_f32_16x16x32_bf16 a[100:103], v[236:239], v[196:199], a[100:103]
s_add_u32 s72, s71, 95232
buffer_load_dwordx4 v7, s[16:19], s72 offen offset:3072 lds
v_mfma_f32_16x16x32_bf16 a[96:99], v[236:239], v[192:195], a[96:99]
ds_read_b64_tr_b16 v[190:191], v23 offset:50176
v_mfma_f32_16x16x32_bf16 a[128:131], v[192:195], v[240:243], a[128:131]
v_mfma_f32_16x16x32_bf16 a[132:135], v[196:199], v[240:243], a[132:135]
v_mfma_f32_16x16x32_bf16 a[136:139], v[200:203], v[240:243], a[136:139]
s_add_u32 m0, s63, 69632
v_mfma_f32_16x16x32_bf16 a[140:143], v[204:207], v[240:243], a[140:143]
s_add_u32 s72, s69, 32768
buffer_load_dwordx4 v2, s[8:11], s72 offen lds
v_mfma_f32_16x16x32_bf16 a[144:147], v[208:211], v[240:243], a[144:147]
v_mfma_f32_16x16x32_bf16 a[148:151], v[212:215], v[240:243], a[148:151]
v_mfma_f32_16x16x32_bf16 a[152:155], v[216:219], v[240:243], a[152:155]
s_add_u32 s72, s69, 39936
buffer_load_dwordx4 v3, s[8:11], s72 offen offset:1024 lds
v_mfma_f32_16x16x32_bf16 a[156:159], v[220:223], v[240:243], a[156:159]
v_mfma_f32_16x16x32_bf16 a[188:191], v[220:223], v[244:247], a[188:191]
v_mfma_f32_16x16x32_bf16 a[184:187], v[216:219], v[244:247], a[184:187]
v_mfma_f32_16x16x32_bf16 a[180:183], v[212:215], v[244:247], a[180:183]
v_mfma_f32_16x16x32_bf16 a[176:179], v[208:211], v[244:247], a[176:179]
s_add_u32 s72, s69, 47104
buffer_load_dwordx4 v2, s[8:11], s72 offen offset:2048 lds
v_mfma_f32_16x16x32_bf16 a[172:175], v[204:207], v[244:247], a[172:175]
v_mfma_f32_16x16x32_bf16 a[168:171], v[200:203], v[244:247], a[168:171]
v_mfma_f32_16x16x32_bf16 a[164:167], v[196:199], v[244:247], a[164:167]
v_mfma_f32_16x16x32_bf16 a[160:163], v[192:195], v[244:247], a[160:163]
s_add_u32 s72, s69, 54272
buffer_load_dwordx4 v3, s[8:11], s72 offen offset:3072 lds
v_mfma_f32_16x16x32_bf16 a[192:195], v[192:195], v[248:251], a[192:195]
v_mfma_f32_16x16x32_bf16 a[196:199], v[196:199], v[248:251], a[196:199]
v_mfma_f32_16x16x32_bf16 a[200:203], v[200:203], v[248:251], a[200:203]
v_mfma_f32_16x16x32_bf16 a[204:207], v[204:207], v[248:251], a[204:207]
s_add_u32 m0, s64, 16384
v_mfma_f32_16x16x32_bf16 a[208:211], v[208:211], v[248:251], a[208:211]
s_add_u32 s72, s71, 0
buffer_load_dwordx4 v6, s[20:23], s72 offen lds
v_mfma_f32_16x16x32_bf16 a[212:215], v[212:215], v[248:251], a[212:215]
v_mfma_f32_16x16x32_bf16 a[216:219], v[216:219], v[248:251], a[216:219]
v_mfma_f32_16x16x32_bf16 a[220:223], v[220:223], v[248:251], a[220:223]
v_mfma_f32_16x16x32_bf16 a[252:255], v[220:223], v[252:255], a[252:255]
s_add_u32 s72, s71, 31744
buffer_load_dwordx4 v6, s[20:23], s72 offen offset:1024 lds
v_mfma_f32_16x16x32_bf16 a[248:251], v[216:219], v[252:255], a[248:251]
v_mfma_f32_16x16x32_bf16 a[244:247], v[212:215], v[252:255], a[244:247]
v_mfma_f32_16x16x32_bf16 a[240:243], v[208:211], v[252:255], a[240:243]
v_mfma_f32_16x16x32_bf16 a[236:239], v[204:207], v[252:255], a[236:239]
s_add_u32 s72, s71, 63488
buffer_load_dwordx4 v7, s[20:23], s72 offen offset:2048 lds
v_mfma_f32_16x16x32_bf16 a[232:235], v[200:203], v[252:255], a[232:235]
v_mfma_f32_16x16x32_bf16 a[228:231], v[196:199], v[252:255], a[228:231]
v_mfma_f32_16x16x32_bf16 a[224:227], v[192:195], v[252:255], a[224:227]
s_waitcnt lgkmcnt(0)
v_mfma_f32_16x16x32_bf16 a[0:3], v[160:163], v[128:131], a[0:3]
s_add_u32 s72, s71, 95232
buffer_load_dwordx4 v7, s[20:23], s72 offen offset:3072 lds
v_mfma_f32_16x16x32_bf16 a[4:7], v[160:163], v[132:135], a[4:7]
buffer_load_dwordx4 v[108:111], v1, s[4:7], s76 offen
v_mfma_f32_16x16x32_bf16 a[8:11], v[160:163], v[136:139], a[8:11]
buffer_load_dwordx4 v[112:115], v1, s[4:7], s76 offen offset:1024
v_mfma_f32_16x16x32_bf16 a[12:15], v[160:163], v[140:143], a[12:15]
buffer_load_dwordx4 v[116:119], v1, s[4:7], s76 offen offset:2048
v_mfma_f32_16x16x32_bf16 a[16:19], v[160:163], v[144:147], a[16:19]
buffer_load_dwordx4 v[120:123], v1, s[4:7], s76 offen offset:3072
v_mfma_f32_16x16x32_bf16 a[20:23], v[160:163], v[148:151], a[20:23]
ds_read_b64_tr_b16 v[224:225], v20 offset:40960
v_mfma_f32_16x16x32_bf16 a[24:27], v[160:163], v[152:155], a[24:27]
v_mfma_f32_16x16x32_bf16 a[28:31], v[160:163], v[156:159], a[28:31]
ds_read_b64_tr_b16 v[226:227], v20 offset:41984
v_mfma_f32_16x16x32_bf16 a[60:63], v[164:167], v[156:159], a[60:63]
v_mfma_f32_16x16x32_bf16 a[56:59], v[164:167], v[152:155], a[56:59]
ds_read_b128 v[192:195], v25 offset:32768
v_mfma_f32_16x16x32_bf16 a[52:55], v[164:167], v[148:151], a[52:55]
v_mfma_f32_16x16x32_bf16 a[48:51], v[164:167], v[144:147], a[48:51]
ds_read_b128 v[196:199], v25 offset:34816
v_mfma_f32_16x16x32_bf16 a[44:47], v[164:167], v[140:143], a[44:47]
v_mfma_f32_16x16x32_bf16 a[40:43], v[164:167], v[136:139], a[40:43]
ds_read_b128 v[200:203], v25 offset:36864
v_mfma_f32_16x16x32_bf16 a[36:39], v[164:167], v[132:135], a[36:39]
v_mfma_f32_16x16x32_bf16 a[32:35], v[164:167], v[128:131], a[32:35]
ds_read_b128 v[204:207], v25 offset:38912
v_mfma_f32_16x16x32_bf16 a[64:67], v[168:171], v[128:131], a[64:67]
v_mfma_f32_16x16x32_bf16 a[68:71], v[168:171], v[132:135], a[68:71]
ds_read_b128 v[208:211], v25 offset:40960
v_mfma_f32_16x16x32_bf16 a[72:75], v[168:171], v[136:139], a[72:75]
v_mfma_f32_16x16x32_bf16 a[76:79], v[168:171], v[140:143], a[76:79]
ds_read_b128 v[212:215], v25 offset:43008
v_mfma_f32_16x16x32_bf16 a[80:83], v[168:171], v[144:147], a[80:83]
s_waitcnt vmcnt(20)
ds_read2_b32 v[36:37], v98 offset0:0 offset1:32
ds_read2_b32 v[38:39], v98 offset0:64 offset1:96
v_mfma_f32_16x16x32_bf16 a[84:87], v[168:171], v[148:151], a[84:87]
ds_read_b128 v[216:219], v25 offset:45056
ds_read2_b32 v[40:41], v98 offset0:128 offset1:160
v_mfma_f32_16x16x32_bf16 a[88:91], v[168:171], v[152:155], a[88:91]
ds_read2_b32 v[42:43], v98 offset0:192 offset1:224
v_add_u32 v98, 1024, v98
v_mfma_f32_16x16x32_bf16 a[92:95], v[168:171], v[156:159], a[92:95]
ds_read_b128 v[220:223], v25 offset:47104
ds_read2_b32 v[44:45], v98 offset0:0 offset1:32
v_mfma_f32_16x16x32_bf16 a[124:127], v[172:175], v[156:159], a[124:127]
ds_read2_b32 v[46:47], v98 offset0:64 offset1:96
ds_read2_b32 v[48:49], v98 offset0:128 offset1:160
v_mfma_f32_16x16x32_bf16 a[120:123], v[172:175], v[152:155], a[120:123]
ds_read_b64_tr_b16 v[228:229], v21 offset:40960
ds_read2_b32 v[50:51], v98 offset0:192 offset1:224
v_mfma_f32_16x16x32_bf16 a[116:119], v[172:175], v[148:151], a[116:119]
v_add_u32 v98, 3072, v98
v_mfma_f32_16x16x32_bf16 a[112:115], v[172:175], v[144:147], a[112:115]
ds_read_b64_tr_b16 v[230:231], v21 offset:41984
ds_read2_b32 v[52:53], v98 offset0:0 offset1:32
v_mfma_f32_16x16x32_bf16 a[108:111], v[172:175], v[140:143], a[108:111]
ds_read2_b32 v[54:55], v98 offset0:64 offset1:96
ds_read2_b32 v[56:57], v98 offset0:128 offset1:160
v_mfma_f32_16x16x32_bf16 a[104:107], v[172:175], v[136:139], a[104:107]
ds_read_b64_tr_b16 v[232:233], v22 offset:40960
ds_read2_b32 v[58:59], v98 offset0:192 offset1:224
v_mfma_f32_16x16x32_bf16 a[100:103], v[172:175], v[132:135], a[100:103]
v_add_u32 v98, 1024, v98
v_mfma_f32_16x16x32_bf16 a[96:99], v[172:175], v[128:131], a[96:99]
ds_read_b64_tr_b16 v[234:235], v22 offset:41984
ds_read2_b32 v[60:61], v98 offset0:0 offset1:32
v_mfma_f32_16x16x32_bf16 a[128:131], v[128:131], v[176:179], a[128:131]
ds_read2_b32 v[62:63], v98 offset0:64 offset1:96
ds_read2_b32 v[64:65], v98 offset0:128 offset1:160
v_mfma_f32_16x16x32_bf16 a[132:135], v[132:135], v[176:179], a[132:135]
ds_read_b64_tr_b16 v[236:237], v23 offset:40960
ds_read2_b32 v[66:67], v98 offset0:192 offset1:224
v_mfma_f32_16x16x32_bf16 a[136:139], v[136:139], v[176:179], a[136:139]
v_mfma_f32_16x16x32_bf16 a[140:143], v[140:143], v[176:179], a[140:143]
ds_read_b64_tr_b16 v[238:239], v23 offset:41984
v_mfma_f32_16x16x32_bf16 a[144:147], v[144:147], v[176:179], a[144:147]
v_mfma_f32_16x16x32_bf16 a[148:151], v[148:151], v[176:179], a[148:151]
ds_read_b64_tr_b16 v[240:241], v20 offset:57344
v_mfma_f32_16x16x32_bf16 a[152:155], v[152:155], v[176:179], a[152:155]
v_mfma_f32_16x16x32_bf16 a[156:159], v[156:159], v[176:179], a[156:159]
ds_read_b64_tr_b16 v[242:243], v20 offset:58368
v_mfma_f32_16x16x32_bf16 a[188:191], v[156:159], v[180:183], a[188:191]
v_mfma_f32_16x16x32_bf16 a[184:187], v[152:155], v[180:183], a[184:187]
ds_read_b64_tr_b16 v[244:245], v21 offset:57344
v_mfma_f32_16x16x32_bf16 a[180:183], v[148:151], v[180:183], a[180:183]
v_mfma_f32_16x16x32_bf16 a[176:179], v[144:147], v[180:183], a[176:179]
ds_read_b64_tr_b16 v[246:247], v21 offset:58368
v_mfma_f32_16x16x32_bf16 a[172:175], v[140:143], v[180:183], a[172:175]
v_mfma_f32_16x16x32_bf16 a[168:171], v[136:139], v[180:183], a[168:171]
ds_read_b64_tr_b16 v[248:249], v22 offset:57344
v_mfma_f32_16x16x32_bf16 a[164:167], v[132:135], v[180:183], a[164:167]
v_mfma_f32_16x16x32_bf16 a[160:163], v[128:131], v[180:183], a[160:163]
ds_read_b64_tr_b16 v[250:251], v22 offset:58368
v_mfma_f32_16x16x32_bf16 a[192:195], v[128:131], v[184:187], a[192:195]
v_mfma_f32_16x16x32_bf16 a[196:199], v[132:135], v[184:187], a[196:199]
ds_read_b64_tr_b16 v[252:253], v23 offset:57344
v_mfma_f32_16x16x32_bf16 a[200:203], v[136:139], v[184:187], a[200:203]
v_mfma_f32_16x16x32_bf16 a[204:207], v[140:143], v[184:187], a[204:207]
ds_read_b64_tr_b16 v[254:255], v23 offset:58368
v_mfma_f32_16x16x32_bf16 a[208:211], v[144:147], v[184:187], a[208:211]
v_mfma_f32_16x16x32_bf16 a[212:215], v[148:151], v[184:187], a[212:215]
v_mfma_f32_16x16x32_bf16 a[216:219], v[152:155], v[184:187], a[216:219]
v_mfma_f32_16x16x32_bf16 a[220:223], v[156:159], v[184:187], a[220:223]
v_mfma_f32_16x16x32_bf16 a[252:255], v[156:159], v[188:191], a[252:255]
v_mfma_f32_16x16x32_bf16 a[248:251], v[152:155], v[188:191], a[248:251]
v_mfma_f32_16x16x32_bf16 a[244:247], v[148:151], v[188:191], a[244:247]
v_mfma_f32_16x16x32_bf16 a[240:243], v[144:147], v[188:191], a[240:243]
v_mfma_f32_16x16x32_bf16 a[236:239], v[140:143], v[188:191], a[236:239]
v_mfma_f32_16x16x32_bf16 a[232:235], v[136:139], v[188:191], a[232:235]
v_mfma_f32_16x16x32_bf16 a[228:231], v[132:135], v[188:191], a[228:231]
s_waitcnt vmcnt(4) lgkmcnt(0)
v_mfma_f32_16x16x32_bf16 a[224:227], v[128:131], v[188:191], a[224:227]
s_barrier
v_mfma_f32_16x16x32_bf16 a[0:3], v[224:227], v[192:195], a[0:3]
s_and_b32 s73, s65, 1
ds_read_b64_tr_b16 v[160:161], v20 offset:0
v_lshlrev_b32 v72, 16, v68
v_mfma_f32_16x16x32_bf16 a[4:7], v[224:227], v[196:199], a[4:7]
s_xor_b32 s73, s73, 5
ds_read_b64_tr_b16 v[162:163], v20 offset:1024
v_and_b32 v73, 0xffff0000, v68
v_mfma_f32_16x16x32_bf16 a[8:11], v[224:227], v[200:203], a[8:11]
s_lshl_b32 s69, s73, 7
ds_read_b128 v[128:131], v24 offset:0
v_lshlrev_b32 v74, 16, v69
v_mfma_f32_16x16x32_bf16 a[12:15], v[224:227], v[204:207], a[12:15]
s_add_u32 s69, s69, s84
ds_read_b128 v[132:135], v24 offset:2048
v_and_b32 v75, 0xffff0000, v69
v_mfma_f32_16x16x32_bf16 a[16:19], v[224:227], v[208:211], a[16:19]
s_lshl_b32 s71, s73, 19
ds_read_b128 v[136:139], v24 offset:4096
v_lshlrev_b32 v76, 16, v33
v_mfma_f32_16x16x32_bf16 a[20:23], v[224:227], v[212:215], a[20:23]
s_add_u32 s71, s71, s66
ds_read_b128 v[140:143], v24 offset:6144
v_lshlrev_b32 v77, 16, v34
v_mfma_f32_16x16x32_bf16 a[24:27], v[224:227], v[216:219], a[24:27]
s_add_u32 m0, s63, 98304
ds_read_b128 v[144:147], v24 offset:8192
v_lshlrev_b32 v78, 16, v35
v_mfma_f32_16x16x32_bf16 a[28:31], v[224:227], v[220:223], a[28:31]
s_add_u32 s72, s69, 0
buffer_load_dwordx4 v2, s[8:11], s72 offen lds
v_mfma_f32_16x16x32_bf16 a[60:63], v[228:231], v[220:223], a[60:63]
s_add_u32 s72, s69, 7168
buffer_load_dwordx4 v3, s[8:11], s72 offen offset:1024 lds
v_mfma_f32_16x16x32_bf16 a[56:59], v[228:231], v[216:219], a[56:59]
s_add_u32 s72, s69, 14336
buffer_load_dwordx4 v2, s[8:11], s72 offen offset:2048 lds
v_mfma_f32_16x16x32_bf16 a[52:55], v[228:231], v[212:215], a[52:55]
ds_read_b128 v[148:151], v24 offset:10240
v_lshlrev_b32 v79, 16, v36
v_mfma_f32_16x16x32_bf16 a[48:51], v[228:231], v[208:211], a[48:51]
ds_read_b128 v[152:155], v24 offset:12288
v_lshlrev_b32 v80, 16, v37
v_mfma_f32_16x16x32_bf16 a[44:47], v[228:231], v[204:207], a[44:47]
s_add_u32 s72, s69, 21504
buffer_load_dwordx4 v3, s[8:11], s72 offen offset:3072 lds
v_mfma_f32_16x16x32_bf16 a[40:43], v[228:231], v[200:203], a[40:43]
ds_read_b128 v[156:159], v24 offset:14336
v_lshlrev_b32 v81, 16, v38
v_mfma_f32_16x16x32_bf16 a[36:39], v[228:231], v[196:199], a[36:39]
ds_read_b64_tr_b16 v[164:165], v21 offset:0
v_lshlrev_b32 v82, 16, v39
v_mfma_f32_16x16x32_bf16 a[32:35], v[228:231], v[192:195], a[32:35]
ds_read_b64_tr_b16 v[166:167], v21 offset:1024
v_lshlrev_b32 v83, 16, v40
v_mfma_f32_16x16x32_bf16 a[64:67], v[232:235], v[192:195], a[64:67]
ds_read_b64_tr_b16 v[168:169], v22 offset:0
v_lshlrev_b32 v84, 16, v41
v_mfma_f32_16x16x32_bf16 a[68:71], v[232:235], v[196:199], a[68:71]
s_add_u32 m0, s64, 32768
ds_read_b64_tr_b16 v[170:171], v22 offset:1024
v_lshlrev_b32 v85, 16, v42
v_mfma_f32_16x16x32_bf16 a[72:75], v[232:235], v[200:203], a[72:75]
s_add_u32 s72, s71, 0
buffer_load_dwordx4 v6, s[16:19], s72 offen lds
v_mfma_f32_16x16x32_bf16 a[76:79], v[232:235], v[204:207], a[76:79]
ds_read_b64_tr_b16 v[172:173], v23 offset:0
v_lshlrev_b32 v86, 16, v43
v_mfma_f32_16x16x32_bf16 a[80:83], v[232:235], v[208:211], a[80:83]
ds_read_b64_tr_b16 v[174:175], v23 offset:1024
v_lshlrev_b32 v87, 16, v44
v_mfma_f32_16x16x32_bf16 a[84:87], v[232:235], v[212:215], a[84:87]
s_add_u32 s72, s71, 31744
buffer_load_dwordx4 v6, s[16:19], s72 offen offset:1024 lds
v_mfma_f32_16x16x32_bf16 a[88:91], v[232:235], v[216:219], a[88:91]
ds_read_b64_tr_b16 v[176:177], v20 offset:16384
v_lshlrev_b32 v88, 16, v45
v_mfma_f32_16x16x32_bf16 a[92:95], v[232:235], v[220:223], a[92:95]
ds_read_b64_tr_b16 v[178:179], v20 offset:17408
v_lshlrev_b32 v89, 16, v46
v_mfma_f32_16x16x32_bf16 a[124:127], v[236:239], v[220:223], a[124:127]
ds_read_b64_tr_b16 v[180:181], v21 offset:16384
v_lshlrev_b32 v90, 16, v47
v_mfma_f32_16x16x32_bf16 a[120:123], v[236:239], v[216:219], a[120:123]
s_add_u32 s72, s71, 63488
buffer_load_dwordx4 v7, s[16:19], s72 offen offset:2048 lds
v_mfma_f32_16x16x32_bf16 a[116:119], v[236:239], v[212:215], a[116:119]
ds_read_b64_tr_b16 v[182:183], v21 offset:17408
v_lshlrev_b32 v91, 16, v48
v_mfma_f32_16x16x32_bf16 a[112:115], v[236:239], v[208:211], a[112:115]
ds_read_b64_tr_b16 v[184:185], v22 offset:16384
v_lshlrev_b32 v92, 16, v49
v_mfma_f32_16x16x32_bf16 a[108:111], v[236:239], v[204:207], a[108:111]
ds_read_b64_tr_b16 v[186:187], v22 offset:17408
v_lshlrev_b32 v93, 16, v50
v_mfma_f32_16x16x32_bf16 a[104:107], v[236:239], v[200:203], a[104:107]
ds_read_b64_tr_b16 v[188:189], v23 offset:16384
v_lshlrev_b32 v94, 16, v51
v_mfma_f32_16x16x32_bf16 a[100:103], v[236:239], v[196:199], a[100:103]
s_add_u32 s72, s71, 95232
buffer_load_dwordx4 v7, s[16:19], s72 offen offset:3072 lds
v_mfma_f32_16x16x32_bf16 a[96:99], v[236:239], v[192:195], a[96:99]
ds_read_b64_tr_b16 v[190:191], v23 offset:17408
v_mul_f32 v95, v75, v91
v_mfma_f32_16x16x32_bf16 a[128:131], v[192:195], v[240:243], a[128:131]
v_lshlrev_b32 v97, 16, v67
v_fmac_f32 v95, v74, v92
v_mfma_f32_16x16x32_bf16 a[132:135], v[196:199], v[240:243], a[132:135]
v_fmac_f32 v95, v73, v93
v_fmac_f32 v95, v72, v94
v_mfma_f32_16x16x32_bf16 a[136:139], v[200:203], v[240:243], a[136:139]
s_add_u32 m0, s63, 102400
v_mul_f32 v95, v95, v97
v_mul_f32 v96, v75, v90
v_mfma_f32_16x16x32_bf16 a[140:143], v[204:207], v[240:243], a[140:143]
s_add_u32 s72, s69, 32768
buffer_load_dwordx4 v2, s[8:11], s72 offen lds
v_mfma_f32_16x16x32_bf16 a[144:147], v[208:211], v[240:243], a[144:147]
v_lshlrev_b32 v97, 16, v66
v_fmac_f32 v96, v74, v91
v_mfma_f32_16x16x32_bf16 a[148:151], v[212:215], v[240:243], a[148:151]
v_fmac_f32 v96, v73, v92
v_fmac_f32 v96, v72, v93
v_mfma_f32_16x16x32_bf16 a[152:155], v[216:219], v[240:243], a[152:155]
s_add_u32 s72, s69, 39936
buffer_load_dwordx4 v3, s[8:11], s72 offen offset:1024 lds
v_mfma_f32_16x16x32_bf16 a[156:159], v[220:223], v[240:243], a[156:159]
v_mul_f32 v96, v96, v97
v_cvt_pk_bf16_f32 v100, v95, v96
v_mfma_f32_16x16x32_bf16 a[188:191], v[220:223], v[244:247], a[188:191]
v_mul_f32 v95, v75, v89
v_lshlrev_b32 v97, 16, v65
v_mfma_f32_16x16x32_bf16 a[184:187], v[216:219], v[244:247], a[184:187]
v_fmac_f32 v95, v74, v90
v_fmac_f32 v95, v73, v91
v_mfma_f32_16x16x32_bf16 a[180:183], v[212:215], v[244:247], a[180:183]
v_fmac_f32 v95, v72, v92
v_mul_f32 v95, v95, v97
v_mfma_f32_16x16x32_bf16 a[176:179], v[208:211], v[244:247], a[176:179]
s_add_u32 s72, s69, 47104
buffer_load_dwordx4 v2, s[8:11], s72 offen offset:2048 lds
v_mfma_f32_16x16x32_bf16 a[172:175], v[204:207], v[244:247], a[172:175]
v_mul_f32 v96, v75, v88
v_lshlrev_b32 v97, 16, v64
v_mfma_f32_16x16x32_bf16 a[168:171], v[200:203], v[244:247], a[168:171]
v_fmac_f32 v96, v74, v89
v_fmac_f32 v96, v73, v90
v_mfma_f32_16x16x32_bf16 a[164:167], v[196:199], v[244:247], a[164:167]
v_fmac_f32 v96, v72, v91
v_mul_f32 v96, v96, v97
v_mfma_f32_16x16x32_bf16 a[160:163], v[192:195], v[244:247], a[160:163]
s_add_u32 s72, s69, 54272
buffer_load_dwordx4 v3, s[8:11], s72 offen offset:3072 lds
v_mfma_f32_16x16x32_bf16 a[192:195], v[192:195], v[248:251], a[192:195]
v_cvt_pk_bf16_f32 v101, v95, v96
v_mul_f32 v95, v75, v87
v_mfma_f32_16x16x32_bf16 a[196:199], v[196:199], v[248:251], a[196:199]
v_lshlrev_b32 v97, 16, v63
v_fmac_f32 v95, v74, v88
v_mfma_f32_16x16x32_bf16 a[200:203], v[200:203], v[248:251], a[200:203]
v_fmac_f32 v95, v73, v89
v_fmac_f32 v95, v72, v90
v_mfma_f32_16x16x32_bf16 a[204:207], v[204:207], v[248:251], a[204:207]
s_add_u32 m0, s64, 49152
v_mul_f32 v95, v95, v97
v_mul_f32 v96, v75, v86
v_mfma_f32_16x16x32_bf16 a[208:211], v[208:211], v[248:251], a[208:211]
s_add_u32 s72, s71, 0
buffer_load_dwordx4 v6, s[20:23], s72 offen lds
v_mfma_f32_16x16x32_bf16 a[212:215], v[212:215], v[248:251], a[212:215]
v_lshlrev_b32 v97, 16, v62
v_fmac_f32 v96, v74, v87
v_mfma_f32_16x16x32_bf16 a[216:219], v[216:219], v[248:251], a[216:219]
v_fmac_f32 v96, v73, v88
v_fmac_f32 v96, v72, v89
v_mfma_f32_16x16x32_bf16 a[220:223], v[220:223], v[248:251], a[220:223]
v_mul_f32 v96, v96, v97
v_cvt_pk_bf16_f32 v102, v95, v96
v_mfma_f32_16x16x32_bf16 a[252:255], v[220:223], v[252:255], a[252:255]
s_add_u32 s72, s71, 31744
buffer_load_dwordx4 v6, s[20:23], s72 offen offset:1024 lds
v_mfma_f32_16x16x32_bf16 a[248:251], v[216:219], v[252:255], a[248:251]
v_mul_f32 v95, v75, v85
v_lshlrev_b32 v97, 16, v61
v_mfma_f32_16x16x32_bf16 a[244:247], v[212:215], v[252:255], a[244:247]
v_fmac_f32 v95, v74, v86
v_fmac_f32 v95, v73, v87
v_mfma_f32_16x16x32_bf16 a[240:243], v[208:211], v[252:255], a[240:243]
v_fmac_f32 v95, v72, v88
v_mul_f32 v95, v95, v97
v_mfma_f32_16x16x32_bf16 a[236:239], v[204:207], v[252:255], a[236:239]
s_add_u32 s72, s71, 63488
buffer_load_dwordx4 v7, s[20:23], s72 offen offset:2048 lds
v_mfma_f32_16x16x32_bf16 a[232:235], v[200:203], v[252:255], a[232:235]
v_mul_f32 v96, v75, v84
v_lshlrev_b32 v97, 16, v60
v_mfma_f32_16x16x32_bf16 a[228:231], v[196:199], v[252:255], a[228:231]
v_fmac_f32 v96, v74, v85
v_fmac_f32 v96, v73, v86
v_mfma_f32_16x16x32_bf16 a[224:227], v[192:195], v[252:255], a[224:227]
s_waitcnt lgkmcnt(0)
v_fmac_f32 v96, v72, v87
v_mul_f32 v96, v96, v97
v_mfma_f32_16x16x32_bf16 a[0:3], v[160:163], v[128:131], a[0:3]
s_add_u32 s72, s71, 95232
buffer_load_dwordx4 v7, s[20:23], s72 offen offset:3072 lds
v_mfma_f32_16x16x32_bf16 a[4:7], v[160:163], v[132:135], a[4:7]
s_mov_b32 s80, 0x0
buffer_load_dword v126, v125, s[12:15], s80 offen
v_mfma_f32_16x16x32_bf16 a[8:11], v[160:163], v[136:139], a[8:11]
s_mov_b32 s80, 0x100000
buffer_load_dword v126, v125, s[12:15], s80 offen
v_mfma_f32_16x16x32_bf16 a[12:15], v[160:163], v[140:143], a[12:15]
s_mov_b32 s80, 0x200000
buffer_load_dword v126, v125, s[12:15], s80 offen
v_mfma_f32_16x16x32_bf16 a[16:19], v[160:163], v[144:147], a[16:19]
s_mov_b32 s80, 0x300000
buffer_load_dword v126, v125, s[12:15], s80 offen
v_mfma_f32_16x16x32_bf16 a[20:23], v[160:163], v[148:151], a[20:23]
ds_read_b64_tr_b16 v[224:225], v20 offset:8192
v_cvt_pk_bf16_f32 v103, v95, v96
v_mfma_f32_16x16x32_bf16 a[24:27], v[160:163], v[152:155], a[24:27]
ds_write_b128 v28, v[100:103] offset:0
v_mul_f32 v95, v75, v83
v_mfma_f32_16x16x32_bf16 a[28:31], v[160:163], v[156:159], a[28:31]
ds_read_b64_tr_b16 v[226:227], v20 offset:9216
v_lshlrev_b32 v97, 16, v59
v_mfma_f32_16x16x32_bf16 a[60:63], v[164:167], v[156:159], a[60:63]
v_fmac_f32 v95, v74, v84
v_fmac_f32 v95, v73, v85
v_mfma_f32_16x16x32_bf16 a[56:59], v[164:167], v[152:155], a[56:59]
ds_read_b128 v[192:195], v25 offset:0
v_fmac_f32 v95, v72, v86
v_mfma_f32_16x16x32_bf16 a[52:55], v[164:167], v[148:151], a[52:55]
v_mul_f32 v95, v95, v97
v_mul_f32 v96, v75, v82
v_mfma_f32_16x16x32_bf16 a[48:51], v[164:167], v[144:147], a[48:51]
ds_read_b128 v[196:199], v25 offset:2048
v_lshlrev_b32 v97, 16, v58
v_mfma_f32_16x16x32_bf16 a[44:47], v[164:167], v[140:143], a[44:47]
v_fmac_f32 v96, v74, v83
v_fmac_f32 v96, v73, v84
v_mfma_f32_16x16x32_bf16 a[40:43], v[164:167], v[136:139], a[40:43]
ds_read_b128 v[200:203], v25 offset:4096
v_fmac_f32 v96, v72, v85
v_mfma_f32_16x16x32_bf16 a[36:39], v[164:167], v[132:135], a[36:39]
v_mul_f32 v96, v96, v97
v_cvt_pk_bf16_f32 v104, v95, v96
v_mfma_f32_16x16x32_bf16 a[32:35], v[164:167], v[128:131], a[32:35]
ds_read_b128 v[204:207], v25 offset:6144
v_mul_f32 v95, v75, v81
v_mfma_f32_16x16x32_bf16 a[64:67], v[168:171], v[128:131], a[64:67]
v_lshlrev_b32 v97, 16, v57
v_fmac_f32 v95, v74, v82
v_mfma_f32_16x16x32_bf16 a[68:71], v[168:171], v[132:135], a[68:71]
ds_read_b128 v[208:211], v25 offset:8192
v_fmac_f32 v95, v73, v83
v_mfma_f32_16x16x32_bf16 a[72:75], v[168:171], v[136:139], a[72:75]
v_fmac_f32 v95, v72, v84
v_mul_f32 v95, v95, v97
v_mfma_f32_16x16x32_bf16 a[76:79], v[168:171], v[140:143], a[76:79]
ds_read_b128 v[212:215], v25 offset:10240
v_mul_f32 v96, v75, v80
v_mfma_f32_16x16x32_bf16 a[80:83], v[168:171], v[144:147], a[80:83]
v_lshlrev_b32 v97, 16, v56
v_fmac_f32 v96, v74, v81
v_mfma_f32_16x16x32_bf16 a[84:87], v[168:171], v[148:151], a[84:87]
ds_read_b128 v[216:219], v25 offset:12288
v_fmac_f32 v96, v73, v82
v_mfma_f32_16x16x32_bf16 a[88:91], v[168:171], v[152:155], a[88:91]
v_fmac_f32 v96, v72, v83
v_mul_f32 v96, v96, v97
v_mfma_f32_16x16x32_bf16 a[92:95], v[168:171], v[156:159], a[92:95]
ds_read_b128 v[220:223], v25 offset:14336
v_cvt_pk_bf16_f32 v105, v95, v96
v_mfma_f32_16x16x32_bf16 a[124:127], v[172:175], v[156:159], a[124:127]
v_mul_f32 v95, v75, v79
v_lshlrev_b32 v97, 16, v55
v_mfma_f32_16x16x32_bf16 a[120:123], v[172:175], v[152:155], a[120:123]
ds_read_b64_tr_b16 v[228:229], v21 offset:8192
v_fmac_f32 v95, v74, v80
v_mfma_f32_16x16x32_bf16 a[116:119], v[172:175], v[148:151], a[116:119]
v_fmac_f32 v95, v73, v81
v_fmac_f32 v95, v72, v82
v_mfma_f32_16x16x32_bf16 a[112:115], v[172:175], v[144:147], a[112:115]
ds_read_b64_tr_b16 v[230:231], v21 offset:9216
v_mul_f32 v95, v95, v97
v_mfma_f32_16x16x32_bf16 a[108:111], v[172:175], v[140:143], a[108:111]
v_mul_f32 v96, v75, v78
v_lshlrev_b32 v97, 16, v54
v_mfma_f32_16x16x32_bf16 a[104:107], v[172:175], v[136:139], a[104:107]
ds_read_b64_tr_b16 v[232:233], v22 offset:8192
v_fmac_f32 v96, v74, v79
v_mfma_f32_16x16x32_bf16 a[100:103], v[172:175], v[132:135], a[100:103]
v_fmac_f32 v96, v73, v80
v_fmac_f32 v96, v72, v81
v_mfma_f32_16x16x32_bf16 a[96:99], v[172:175], v[128:131], a[96:99]
ds_read_b64_tr_b16 v[234:235], v22 offset:9216
v_mul_f32 v96, v96, v97
v_mfma_f32_16x16x32_bf16 a[128:131], v[128:131], v[176:179], a[128:131]
v_cvt_pk_bf16_f32 v106, v95, v96
v_mul_f32 v95, v75, v77
v_mfma_f32_16x16x32_bf16 a[132:135], v[132:135], v[176:179], a[132:135]
ds_read_b64_tr_b16 v[236:237], v23 offset:8192
v_lshlrev_b32 v97, 16, v53
v_mfma_f32_16x16x32_bf16 a[136:139], v[136:139], v[176:179], a[136:139]
v_fmac_f32 v95, v74, v78
v_fmac_f32 v95, v73, v79
v_mfma_f32_16x16x32_bf16 a[140:143], v[140:143], v[176:179], a[140:143]
ds_read_b64_tr_b16 v[238:239], v23 offset:9216
v_fmac_f32 v95, v72, v80
v_mfma_f32_16x16x32_bf16 a[144:147], v[144:147], v[176:179], a[144:147]
v_mul_f32 v95, v95, v97
v_mul_f32 v96, v75, v76
v_mfma_f32_16x16x32_bf16 a[148:151], v[148:151], v[176:179], a[148:151]
ds_read_b64_tr_b16 v[240:241], v20 offset:24576
v_lshlrev_b32 v97, 16, v52
v_mfma_f32_16x16x32_bf16 a[152:155], v[152:155], v[176:179], a[152:155]
v_fmac_f32 v96, v74, v77
v_fmac_f32 v96, v73, v78
v_mfma_f32_16x16x32_bf16 a[156:159], v[156:159], v[176:179], a[156:159]
ds_read_b64_tr_b16 v[242:243], v20 offset:25600
v_fmac_f32 v96, v72, v79
v_mfma_f32_16x16x32_bf16 a[188:191], v[156:159], v[180:183], a[188:191]
v_mul_f32 v96, v96, v97
v_cvt_pk_bf16_f32 v107, v95, v96
v_mfma_f32_16x16x32_bf16 a[184:187], v[152:155], v[180:183], a[184:187]
ds_read_b64_tr_b16 v[244:245], v21 offset:24576
ds_write_b128 v28, v[104:107] offset:16
v_mfma_f32_16x16x32_bf16 a[180:183], v[148:151], v[180:183], a[180:183]
global_load_dwordx4 v[84:87], v1, s[56:57]
v_mfma_f32_16x16x32_bf16 a[176:179], v[144:147], v[180:183], a[176:179]
ds_read_b64_tr_b16 v[246:247], v21 offset:25600
v_mfma_f32_16x16x32_bf16 a[172:175], v[140:143], v[180:183], a[172:175]
global_load_dwordx4 v[88:91], v1, s[56:57] offset:1024
v_mfma_f32_16x16x32_bf16 a[168:171], v[136:139], v[180:183], a[168:171]
ds_read_b64_tr_b16 v[248:249], v22 offset:24576
v_lshlrev_b32 v72, 16, v70
v_mfma_f32_16x16x32_bf16 a[164:167], v[132:135], v[180:183], a[164:167]
v_and_b32 v73, 0xffff0000, v70
v_lshlrev_b32 v74, 16, v71
v_mfma_f32_16x16x32_bf16 a[160:163], v[128:131], v[180:183], a[160:163]
ds_read_b64_tr_b16 v[250:251], v22 offset:25600
v_and_b32 v75, 0xffff0000, v71
v_mfma_f32_16x16x32_bf16 a[192:195], v[128:131], v[184:187], a[192:195]
v_and_b32 v33, 0xffff0000, v33
v_and_b32 v34, 0xffff0000, v34
v_mfma_f32_16x16x32_bf16 a[196:199], v[132:135], v[184:187], a[196:199]
ds_read_b64_tr_b16 v[252:253], v23 offset:24576
v_and_b32 v35, 0xffff0000, v35
v_mfma_f32_16x16x32_bf16 a[200:203], v[136:139], v[184:187], a[200:203]
v_and_b32 v36, 0xffff0000, v36
v_and_b32 v37, 0xffff0000, v37
v_mfma_f32_16x16x32_bf16 a[204:207], v[140:143], v[184:187], a[204:207]
ds_read_b64_tr_b16 v[254:255], v23 offset:25600
v_and_b32 v38, 0xffff0000, v38
v_mfma_f32_16x16x32_bf16 a[208:211], v[144:147], v[184:187], a[208:211]
v_and_b32 v39, 0xffff0000, v39
v_and_b32 v40, 0xffff0000, v40
v_mfma_f32_16x16x32_bf16 a[212:215], v[148:151], v[184:187], a[212:215]
v_and_b32 v41, 0xffff0000, v41
v_and_b32 v42, 0xffff0000, v42
v_mfma_f32_16x16x32_bf16 a[216:219], v[152:155], v[184:187], a[216:219]
v_and_b32 v43, 0xffff0000, v43
v_and_b32 v44, 0xffff0000, v44
v_mfma_f32_16x16x32_bf16 a[220:223], v[156:159], v[184:187], a[220:223]
v_and_b32 v45, 0xffff0000, v45
v_and_b32 v46, 0xffff0000, v46
v_mfma_f32_16x16x32_bf16 a[252:255], v[156:159], v[188:191], a[252:255]
v_and_b32 v47, 0xffff0000, v47
v_and_b32 v48, 0xffff0000, v48
v_mfma_f32_16x16x32_bf16 a[248:251], v[152:155], v[188:191], a[248:251]
v_and_b32 v49, 0xffff0000, v49
v_and_b32 v50, 0xffff0000, v50
v_mfma_f32_16x16x32_bf16 a[244:247], v[148:151], v[188:191], a[244:247]
v_and_b32 v51, 0xffff0000, v51
v_mul_f32 v95, v75, v48
v_mfma_f32_16x16x32_bf16 a[240:243], v[144:147], v[188:191], a[240:243]
v_and_b32 v97, 0xffff0000, v67
v_fmac_f32 v95, v74, v49
v_mfma_f32_16x16x32_bf16 a[236:239], v[140:143], v[188:191], a[236:239]
v_fmac_f32 v95, v73, v50
v_fmac_f32 v95, v72, v51
v_mfma_f32_16x16x32_bf16 a[232:235], v[136:139], v[188:191], a[232:235]
v_mul_f32 v95, v95, v97
v_mul_f32 v96, v75, v47
v_mfma_f32_16x16x32_bf16 a[228:231], v[132:135], v[188:191], a[228:231]
s_waitcnt vmcnt(6) lgkmcnt(0)
v_and_b32 v97, 0xffff0000, v66
v_fmac_f32 v96, v74, v48
v_mfma_f32_16x16x32_bf16 a[224:227], v[128:131], v[188:191], a[224:227]
s_barrier
v_fmac_f32 v96, v73, v49
v_fmac_f32 v96, v72, v50
v_mfma_f32_16x16x32_bf16 a[0:3], v[224:227], v[192:195], a[0:3]
s_and_b32 s73, s65, 1
ds_read_b64_tr_b16 v[160:161], v20 offset:32768
v_mul_f32 v96, v96, v97
v_mfma_f32_16x16x32_bf16 a[4:7], v[224:227], v[196:199], a[4:7]
s_xor_b32 s73, s73, 6
ds_read_b64_tr_b16 v[162:163], v20 offset:33792
v_cvt_pk_bf16_f32 v100, v95, v96
v_mfma_f32_16x16x32_bf16 a[8:11], v[224:227], v[200:203], a[8:11]
s_lshl_b32 s69, s73, 7
ds_read_b128 v[128:131], v24 offset:32768
v_mul_f32 v95, v75, v46
v_mfma_f32_16x16x32_bf16 a[12:15], v[224:227], v[204:207], a[12:15]
s_add_u32 s69, s69, s84
ds_read_b128 v[132:135], v24 offset:34816
v_and_b32 v97, 0xffff0000, v65
v_mfma_f32_16x16x32_bf16 a[16:19], v[224:227], v[208:211], a[16:19]
s_lshl_b32 s71, s73, 19
ds_read_b128 v[136:139], v24 offset:36864
v_fmac_f32 v95, v74, v47
v_mfma_f32_16x16x32_bf16 a[20:23], v[224:227], v[212:215], a[20:23]
s_add_u32 s71, s71, s66
ds_read_b128 v[140:143], v24 offset:38912
v_fmac_f32 v95, v73, v48
v_mfma_f32_16x16x32_bf16 a[24:27], v[224:227], v[216:219], a[24:27]
s_add_u32 m0, s63, 65536
ds_read_b128 v[144:147], v24 offset:40960
v_fmac_f32 v95, v72, v49
v_mfma_f32_16x16x32_bf16 a[28:31], v[224:227], v[220:223], a[28:31]
s_add_u32 s72, s69, 0
buffer_load_dwordx4 v2, s[8:11], s72 offen lds
v_mfma_f32_16x16x32_bf16 a[60:63], v[228:231], v[220:223], a[60:63]
s_add_u32 s72, s69, 7168
buffer_load_dwordx4 v3, s[8:11], s72 offen offset:1024 lds
v_mfma_f32_16x16x32_bf16 a[56:59], v[228:231], v[216:219], a[56:59]
s_add_u32 s72, s69, 14336
buffer_load_dwordx4 v2, s[8:11], s72 offen offset:2048 lds
v_mfma_f32_16x16x32_bf16 a[52:55], v[228:231], v[212:215], a[52:55]
ds_read_b128 v[148:151], v24 offset:43008
v_mul_f32 v95, v95, v97
v_mfma_f32_16x16x32_bf16 a[48:51], v[228:231], v[208:211], a[48:51]
ds_read_b128 v[152:155], v24 offset:45056
v_mul_f32 v96, v75, v45
v_mfma_f32_16x16x32_bf16 a[44:47], v[228:231], v[204:207], a[44:47]
s_add_u32 s72, s69, 21504
buffer_load_dwordx4 v3, s[8:11], s72 offen offset:3072 lds
v_mfma_f32_16x16x32_bf16 a[40:43], v[228:231], v[200:203], a[40:43]
ds_read_b128 v[156:159], v24 offset:47104
v_and_b32 v97, 0xffff0000, v64
v_mfma_f32_16x16x32_bf16 a[36:39], v[228:231], v[196:199], a[36:39]
ds_read_b64_tr_b16 v[164:165], v21 offset:32768
v_fmac_f32 v96, v74, v46
v_mfma_f32_16x16x32_bf16 a[32:35], v[228:231], v[192:195], a[32:35]
ds_read_b64_tr_b16 v[166:167], v21 offset:33792
v_fmac_f32 v96, v73, v47
v_mfma_f32_16x16x32_bf16 a[64:67], v[232:235], v[192:195], a[64:67]
ds_read_b64_tr_b16 v[168:169], v22 offset:32768
v_fmac_f32 v96, v72, v48
v_mfma_f32_16x16x32_bf16 a[68:71], v[232:235], v[196:199], a[68:71]
s_add_u32 m0, s64, 0
ds_read_b64_tr_b16 v[170:171], v22 offset:33792
v_mul_f32 v96, v96, v97
v_mfma_f32_16x16x32_bf16 a[72:75], v[232:235], v[200:203], a[72:75]
s_add_u32 s72, s71, 0
buffer_load_dwordx4 v6, s[16:19], s72 offen lds
v_mfma_f32_16x16x32_bf16 a[76:79], v[232:235], v[204:207], a[76:79]
ds_read_b64_tr_b16 v[172:173], v23 offset:32768
v_cvt_pk_bf16_f32 v101, v95, v96
v_mfma_f32_16x16x32_bf16 a[80:83], v[232:235], v[208:211], a[80:83]
ds_read_b64_tr_b16 v[174:175], v23 offset:33792
v_mul_f32 v95, v75, v44
v_mfma_f32_16x16x32_bf16 a[84:87], v[232:235], v[212:215], a[84:87]
s_add_u32 s72, s71, 31744
buffer_load_dwordx4 v6, s[16:19], s72 offen offset:1024 lds
v_mfma_f32_16x16x32_bf16 a[88:91], v[232:235], v[216:219], a[88:91]
ds_read_b64_tr_b16 v[176:177], v20 offset:49152
v_and_b32 v97, 0xffff0000, v63
v_mfma_f32_16x16x32_bf16 a[92:95], v[232:235], v[220:223], a[92:95]
ds_read_b64_tr_b16 v[178:179], v20 offset:50176
v_fmac_f32 v95, v74, v45
v_mfma_f32_16x16x32_bf16 a[124:127], v[236:239], v[220:223], a[124:127]
ds_read_b64_tr_b16 v[180:181], v21 offset:49152
v_fmac_f32 v95, v73, v46
v_mfma_f32_16x16x32_bf16 a[120:123], v[236:239], v[216:219], a[120:123]
s_add_u32 s72, s71, 63488
buffer_load_dwordx4 v7, s[16:19], s72 offen offset:2048 lds
v_mfma_f32_16x16x32_bf16 a[116:119], v[236:239], v[212:215], a[116:119]
ds_read_b64_tr_b16 v[182:183], v21 offset:50176
v_fmac_f32 v95, v72, v47
v_mfma_f32_16x16x32_bf16 a[112:115], v[236:239], v[208:211], a[112:115]
ds_read_b64_tr_b16 v[184:185], v22 offset:49152
v_mul_f32 v95, v95, v97
v_mfma_f32_16x16x32_bf16 a[108:111], v[236:239], v[204:207], a[108:111]
ds_read_b64_tr_b16 v[186:187], v22 offset:50176
v_mul_f32 v96, v75, v43
v_mfma_f32_16x16x32_bf16 a[104:107], v[236:239], v[200:203], a[104:107]
ds_read_b64_tr_b16 v[188:189], v23 offset:49152
v_and_b32 v97, 0xffff0000, v62
v_mfma_f32_16x16x32_bf16 a[100:103], v[236:239], v[196:199], a[100:103]
s_add_u32 s72, s71, 95232
buffer_load_dwordx4 v7, s[16:19], s72 offen offset:3072 lds
v_mfma_f32_16x16x32_bf16 a[96:99], v[236:239], v[192:195], a[96:99]
ds_read_b64_tr_b16 v[190:191], v23 offset:50176
v_fmac_f32 v96, v74, v44
v_mfma_f32_16x16x32_bf16 a[128:131], v[192:195], v[240:243], a[128:131]
v_fmac_f32 v96, v73, v45
v_fmac_f32 v96, v72, v46
v_mfma_f32_16x16x32_bf16 a[132:135], v[196:199], v[240:243], a[132:135]
v_mul_f32 v96, v96, v97
v_cvt_pk_bf16_f32 v102, v95, v96
v_mfma_f32_16x16x32_bf16 a[136:139], v[200:203], v[240:243], a[136:139]
s_add_u32 m0, s63, 69632
v_mul_f32 v95, v75, v42
v_and_b32 v97, 0xffff0000, v61
v_mfma_f32_16x16x32_bf16 a[140:143], v[204:207], v[240:243], a[140:143]
s_add_u32 s72, s69, 32768
buffer_load_dwordx4 v2, s[8:11], s72 offen lds
v_mfma_f32_16x16x32_bf16 a[144:147], v[208:211], v[240:243], a[144:147]
v_fmac_f32 v95, v74, v43
v_fmac_f32 v95, v73, v44
v_mfma_f32_16x16x32_bf16 a[148:151], v[212:215], v[240:243], a[148:151]
v_fmac_f32 v95, v72, v45
v_mul_f32 v95, v95, v97
v_mfma_f32_16x16x32_bf16 a[152:155], v[216:219], v[240:243], a[152:155]
s_add_u32 s72, s69, 39936
buffer_load_dwordx4 v3, s[8:11], s72 offen offset:1024 lds
v_mfma_f32_16x16x32_bf16 a[156:159], v[220:223], v[240:243], a[156:159]
v_mul_f32 v96, v75, v41
v_and_b32 v97, 0xffff0000, v60
v_mfma_f32_16x16x32_bf16 a[188:191], v[220:223], v[244:247], a[188:191]
v_fmac_f32 v96, v74, v42
v_fmac_f32 v96, v73, v43
v_mfma_f32_16x16x32_bf16 a[184:187], v[216:219], v[244:247], a[184:187]
v_fmac_f32 v96, v72, v44
v_mul_f32 v96, v96, v97
v_mfma_f32_16x16x32_bf16 a[180:183], v[212:215], v[244:247], a[180:183]
v_cvt_pk_bf16_f32 v103, v95, v96
v_mfma_f32_16x16x32_bf16 a[176:179], v[208:211], v[244:247], a[176:179]
s_add_u32 s72, s69, 47104
buffer_load_dwordx4 v2, s[8:11], s72 offen offset:2048 lds
v_mfma_f32_16x16x32_bf16 a[172:175], v[204:207], v[244:247], a[172:175]
ds_write_b128 v28, v[100:103] offset:272
v_mul_f32 v95, v75, v40
v_mfma_f32_16x16x32_bf16 a[168:171], v[200:203], v[244:247], a[168:171]
v_and_b32 v97, 0xffff0000, v59
v_fmac_f32 v95, v74, v41
v_mfma_f32_16x16x32_bf16 a[164:167], v[196:199], v[244:247], a[164:167]
v_fmac_f32 v95, v73, v42
v_fmac_f32 v95, v72, v43
v_mfma_f32_16x16x32_bf16 a[160:163], v[192:195], v[244:247], a[160:163]
s_add_u32 s72, s69, 54272
buffer_load_dwordx4 v3, s[8:11], s72 offen offset:3072 lds
v_mfma_f32_16x16x32_bf16 a[192:195], v[192:195], v[248:251], a[192:195]
v_mul_f32 v95, v95, v97
v_mul_f32 v96, v75, v39
v_mfma_f32_16x16x32_bf16 a[196:199], v[196:199], v[248:251], a[196:199]
v_and_b32 v97, 0xffff0000, v58
v_fmac_f32 v96, v74, v40
v_mfma_f32_16x16x32_bf16 a[200:203], v[200:203], v[248:251], a[200:203]
v_fmac_f32 v96, v73, v41
v_fmac_f32 v96, v72, v42
v_mfma_f32_16x16x32_bf16 a[204:207], v[204:207], v[248:251], a[204:207]
s_add_u32 m0, s64, 16384
v_mul_f32 v96, v96, v97
v_cvt_pk_bf16_f32 v104, v95, v96
v_mfma_f32_16x16x32_bf16 a[208:211], v[208:211], v[248:251], a[208:211]
s_add_u32 s72, s71, 0
buffer_load_dwordx4 v6, s[20:23], s72 offen lds
v_mfma_f32_16x16x32_bf16 a[212:215], v[212:215], v[248:251], a[212:215]
v_mul_f32 v95, v75, v38
v_and_b32 v97, 0xffff0000, v57
v_mfma_f32_16x16x32_bf16 a[216:219], v[216:219], v[248:251], a[216:219]
v_fmac_f32 v95, v74, v39
v_fmac_f32 v95, v73, v40
v_mfma_f32_16x16x32_bf16 a[220:223], v[220:223], v[248:251], a[220:223]
v_fmac_f32 v95, v72, v41
v_mul_f32 v95, v95, v97
v_mfma_f32_16x16x32_bf16 a[252:255], v[220:223], v[252:255], a[252:255]
s_add_u32 s72, s71, 31744
buffer_load_dwordx4 v6, s[20:23], s72 offen offset:1024 lds
v_mfma_f32_16x16x32_bf16 a[248:251], v[216:219], v[252:255], a[248:251]
v_mul_f32 v96, v75, v37
v_and_b32 v97, 0xffff0000, v56
v_mfma_f32_16x16x32_bf16 a[244:247], v[212:215], v[252:255], a[244:247]
v_fmac_f32 v96, v74, v38
v_fmac_f32 v96, v73, v39
v_mfma_f32_16x16x32_bf16 a[240:243], v[208:211], v[252:255], a[240:243]
v_fmac_f32 v96, v72, v40
v_mul_f32 v96, v96, v97
v_mfma_f32_16x16x32_bf16 a[236:239], v[204:207], v[252:255], a[236:239]
s_add_u32 s72, s71, 63488
buffer_load_dwordx4 v7, s[20:23], s72 offen offset:2048 lds
v_mfma_f32_16x16x32_bf16 a[232:235], v[200:203], v[252:255], a[232:235]
v_cvt_pk_bf16_f32 v105, v95, v96
v_mul_f32 v95, v75, v36
v_mfma_f32_16x16x32_bf16 a[228:231], v[196:199], v[252:255], a[228:231]
v_and_b32 v97, 0xffff0000, v55
v_fmac_f32 v95, v74, v37
v_mfma_f32_16x16x32_bf16 a[224:227], v[192:195], v[252:255], a[224:227]
s_waitcnt lgkmcnt(0)
v_fmac_f32 v95, v73, v38
v_fmac_f32 v95, v72, v39
v_mfma_f32_16x16x32_bf16 a[0:3], v[160:163], v[128:131], a[0:3]
s_add_u32 s72, s71, 95232
buffer_load_dwordx4 v7, s[20:23], s72 offen offset:3072 lds
v_mfma_f32_16x16x32_bf16 a[4:7], v[160:163], v[132:135], a[4:7]
s_mov_b32 s80, 0x400000
buffer_load_dword v126, v125, s[12:15], s80 offen
v_mfma_f32_16x16x32_bf16 a[8:11], v[160:163], v[136:139], a[8:11]
s_mov_b32 s80, 0x500000
buffer_load_dword v126, v125, s[12:15], s80 offen
v_mfma_f32_16x16x32_bf16 a[12:15], v[160:163], v[140:143], a[12:15]
s_mov_b32 s80, 0x600000
buffer_load_dword v126, v125, s[12:15], s80 offen
v_mfma_f32_16x16x32_bf16 a[16:19], v[160:163], v[144:147], a[16:19]
s_mov_b32 s80, 0x700000
buffer_load_dword v126, v125, s[12:15], s80 offen
v_mfma_f32_16x16x32_bf16 a[20:23], v[160:163], v[148:151], a[20:23]
ds_read_b64_tr_b16 v[224:225], v20 offset:40960
v_mul_f32 v95, v95, v97
v_mfma_f32_16x16x32_bf16 a[24:27], v[160:163], v[152:155], a[24:27]
v_mul_f32 v96, v75, v35
v_and_b32 v97, 0xffff0000, v54
v_mfma_f32_16x16x32_bf16 a[28:31], v[160:163], v[156:159], a[28:31]
ds_read_b64_tr_b16 v[226:227], v20 offset:41984
v_fmac_f32 v96, v74, v36
v_mfma_f32_16x16x32_bf16 a[60:63], v[164:167], v[156:159], a[60:63]
v_fmac_f32 v96, v73, v37
v_fmac_f32 v96, v72, v38
v_mfma_f32_16x16x32_bf16 a[56:59], v[164:167], v[152:155], a[56:59]
ds_read_b128 v[192:195], v25 offset:32768
v_mul_f32 v96, v96, v97
v_mfma_f32_16x16x32_bf16 a[52:55], v[164:167], v[148:151], a[52:55]
v_cvt_pk_bf16_f32 v106, v95, v96
v_mul_f32 v95, v75, v34
v_mfma_f32_16x16x32_bf16 a[48:51], v[164:167], v[144:147], a[48:51]
ds_read_b128 v[196:199], v25 offset:34816
v_and_b32 v97, 0xffff0000, v53
v_mfma_f32_16x16x32_bf16 a[44:47], v[164:167], v[140:143], a[44:47]
v_fmac_f32 v95, v74, v35
v_fmac_f32 v95, v73, v36
v_mfma_f32_16x16x32_bf16 a[40:43], v[164:167], v[136:139], a[40:43]
ds_read_b128 v[200:203], v25 offset:36864
v_fmac_f32 v95, v72, v37
v_mfma_f32_16x16x32_bf16 a[36:39], v[164:167], v[132:135], a[36:39]
v_mul_f32 v95, v95, v97
v_mul_f32 v96, v75, v33
v_mfma_f32_16x16x32_bf16 a[32:35], v[164:167], v[128:131], a[32:35]
ds_read_b128 v[204:207], v25 offset:38912
v_and_b32 v97, 0xffff0000, v52
v_mfma_f32_16x16x32_bf16 a[64:67], v[168:171], v[128:131], a[64:67]
v_fmac_f32 v96, v74, v34
v_fmac_f32 v96, v73, v35
v_mfma_f32_16x16x32_bf16 a[68:71], v[168:171], v[132:135], a[68:71]
ds_read_b128 v[208:211], v25 offset:40960
v_fmac_f32 v96, v72, v36
v_mfma_f32_16x16x32_bf16 a[72:75], v[168:171], v[136:139], a[72:75]
v_mul_f32 v96, v96, v97
v_cvt_pk_bf16_f32 v107, v95, v96
v_mfma_f32_16x16x32_bf16 a[76:79], v[168:171], v[140:143], a[76:79]
ds_read_b128 v[212:215], v25 offset:43008
ds_write_b128 v28, v[104:107] offset:288
v_mfma_f32_16x16x32_bf16 a[80:83], v[168:171], v[144:147], a[80:83]
v_mfma_f32_16x16x32_bf16 a[84:87], v[168:171], v[148:151], a[84:87]
ds_read_b128 v[216:219], v25 offset:45056
v_mfma_f32_16x16x32_bf16 a[88:91], v[168:171], v[152:155], a[88:91]
v_mfma_f32_16x16x32_bf16 a[92:95], v[168:171], v[156:159], a[92:95]
ds_read_b128 v[220:223], v25 offset:47104
v_mfma_f32_16x16x32_bf16 a[124:127], v[172:175], v[156:159], a[124:127]
v_mfma_f32_16x16x32_bf16 a[120:123], v[172:175], v[152:155], a[120:123]
ds_read_b64_tr_b16 v[228:229], v21 offset:40960
v_mfma_f32_16x16x32_bf16 a[116:119], v[172:175], v[148:151], a[116:119]
v_mfma_f32_16x16x32_bf16 a[112:115], v[172:175], v[144:147], a[112:115]
ds_read_b64_tr_b16 v[230:231], v21 offset:41984
v_mfma_f32_16x16x32_bf16 a[108:111], v[172:175], v[140:143], a[108:111]
v_mfma_f32_16x16x32_bf16 a[104:107], v[172:175], v[136:139], a[104:107]
ds_read_b64_tr_b16 v[232:233], v22 offset:40960
v_mfma_f32_16x16x32_bf16 a[100:103], v[172:175], v[132:135], a[100:103]
v_mfma_f32_16x16x32_bf16 a[96:99], v[172:175], v[128:131], a[96:99]
ds_read_b64_tr_b16 v[234:235], v22 offset:41984
v_mfma_f32_16x16x32_bf16 a[128:131], v[128:131], v[176:179], a[128:131]
v_mfma_f32_16x16x32_bf16 a[132:135], v[132:135], v[176:179], a[132:135]
ds_read_b64_tr_b16 v[236:237], v23 offset:40960
v_mfma_f32_16x16x32_bf16 a[136:139], v[136:139], v[176:179], a[136:139]
v_mfma_f32_16x16x32_bf16 a[140:143], v[140:143], v[176:179], a[140:143]
ds_read_b64_tr_b16 v[238:239], v23 offset:41984
v_mfma_f32_16x16x32_bf16 a[144:147], v[144:147], v[176:179], a[144:147]
v_mfma_f32_16x16x32_bf16 a[148:151], v[148:151], v[176:179], a[148:151]
ds_read_b64_tr_b16 v[240:241], v20 offset:57344
v_mfma_f32_16x16x32_bf16 a[152:155], v[152:155], v[176:179], a[152:155]
v_mfma_f32_16x16x32_bf16 a[156:159], v[156:159], v[176:179], a[156:159]
ds_read_b64_tr_b16 v[242:243], v20 offset:58368
v_mfma_f32_16x16x32_bf16 a[188:191], v[156:159], v[180:183], a[188:191]
v_mfma_f32_16x16x32_bf16 a[184:187], v[152:155], v[180:183], a[184:187]
ds_read_b64_tr_b16 v[244:245], v21 offset:57344
v_mfma_f32_16x16x32_bf16 a[180:183], v[148:151], v[180:183], a[180:183]
v_mfma_f32_16x16x32_bf16 a[176:179], v[144:147], v[180:183], a[176:179]
ds_read_b64_tr_b16 v[246:247], v21 offset:58368
v_mfma_f32_16x16x32_bf16 a[172:175], v[140:143], v[180:183], a[172:175]
v_mfma_f32_16x16x32_bf16 a[168:171], v[136:139], v[180:183], a[168:171]
ds_read_b64_tr_b16 v[248:249], v22 offset:57344
v_mfma_f32_16x16x32_bf16 a[164:167], v[132:135], v[180:183], a[164:167]
v_mfma_f32_16x16x32_bf16 a[160:163], v[128:131], v[180:183], a[160:163]
ds_read_b64_tr_b16 v[250:251], v22 offset:58368
v_mfma_f32_16x16x32_bf16 a[192:195], v[128:131], v[184:187], a[192:195]
v_mfma_f32_16x16x32_bf16 a[196:199], v[132:135], v[184:187], a[196:199]
ds_read_b64_tr_b16 v[252:253], v23 offset:57344
v_mfma_f32_16x16x32_bf16 a[200:203], v[136:139], v[184:187], a[200:203]
v_mfma_f32_16x16x32_bf16 a[204:207], v[140:143], v[184:187], a[204:207]
ds_read_b64_tr_b16 v[254:255], v23 offset:58368
v_mfma_f32_16x16x32_bf16 a[208:211], v[144:147], v[184:187], a[208:211]
v_mfma_f32_16x16x32_bf16 a[212:215], v[148:151], v[184:187], a[212:215]
v_mfma_f32_16x16x32_bf16 a[216:219], v[152:155], v[184:187], a[216:219]
v_mfma_f32_16x16x32_bf16 a[220:223], v[156:159], v[184:187], a[220:223]
v_mfma_f32_16x16x32_bf16 a[252:255], v[156:159], v[188:191], a[252:255]
v_mfma_f32_16x16x32_bf16 a[248:251], v[152:155], v[188:191], a[248:251]
v_mfma_f32_16x16x32_bf16 a[244:247], v[148:151], v[188:191], a[244:247]
v_mfma_f32_16x16x32_bf16 a[240:243], v[144:147], v[188:191], a[240:243]
v_mfma_f32_16x16x32_bf16 a[236:239], v[140:143], v[188:191], a[236:239]
v_mfma_f32_16x16x32_bf16 a[232:235], v[136:139], v[188:191], a[232:235]
v_mfma_f32_16x16x32_bf16 a[228:231], v[132:135], v[188:191], a[228:231]
s_waitcnt vmcnt(4) lgkmcnt(0)
v_mfma_f32_16x16x32_bf16 a[224:227], v[128:131], v[188:191], a[224:227]
s_barrier
v_mfma_f32_16x16x32_bf16 a[0:3], v[224:227], v[192:195], a[0:3]
s_and_b32 s73, s65, 1
ds_read_b64_tr_b16 v[160:161], v20 offset:0
v_mfma_f32_16x16x32_bf16 a[4:7], v[224:227], v[196:199], a[4:7]
s_xor_b32 s73, s73, 7
ds_read_b64_tr_b16 v[162:163], v20 offset:1024
v_mfma_f32_16x16x32_bf16 a[8:11], v[224:227], v[200:203], a[8:11]
s_lshl_b32 s69, s73, 7
ds_read_b128 v[128:131], v24 offset:0
v_mfma_f32_16x16x32_bf16 a[12:15], v[224:227], v[204:207], a[12:15]
s_add_u32 s69, s69, s84
ds_read_b128 v[132:135], v24 offset:2048
v_mfma_f32_16x16x32_bf16 a[16:19], v[224:227], v[208:211], a[16:19]
s_lshl_b32 s71, s73, 19
ds_read_b128 v[136:139], v24 offset:4096
v_mfma_f32_16x16x32_bf16 a[20:23], v[224:227], v[212:215], a[20:23]
s_add_u32 s71, s71, s66
ds_read_b128 v[140:143], v24 offset:6144
v_mfma_f32_16x16x32_bf16 a[24:27], v[224:227], v[216:219], a[24:27]
s_add_u32 m0, s63, 98304
ds_read_b128 v[144:147], v24 offset:8192
v_mfma_f32_16x16x32_bf16 a[28:31], v[224:227], v[220:223], a[28:31]
s_add_u32 s72, s69, 0
buffer_load_dwordx4 v2, s[8:11], s72 offen lds
v_mfma_f32_16x16x32_bf16 a[60:63], v[228:231], v[220:223], a[60:63]
s_add_u32 s72, s69, 7168
buffer_load_dwordx4 v3, s[8:11], s72 offen offset:1024 lds
v_mfma_f32_16x16x32_bf16 a[56:59], v[228:231], v[216:219], a[56:59]
s_add_u32 s72, s69, 14336
buffer_load_dwordx4 v2, s[8:11], s72 offen offset:2048 lds
v_mfma_f32_16x16x32_bf16 a[52:55], v[228:231], v[212:215], a[52:55]
s_mul_i32 s74, s58, 4352
ds_read_b128 v[148:151], v24 offset:10240
v_mfma_f32_16x16x32_bf16 a[48:51], v[228:231], v[208:211], a[48:51]
s_add_u32 s74, s74, 131072
ds_read_b128 v[152:155], v24 offset:12288
v_lshrrev_b32 v26, 4, v0
v_mfma_f32_16x16x32_bf16 a[44:47], v[228:231], v[204:207], a[44:47]
s_add_u32 s72, s69, 21504
buffer_load_dwordx4 v3, s[8:11], s72 offen offset:3072 lds
v_mfma_f32_16x16x32_bf16 a[40:43], v[228:231], v[200:203], a[40:43]
ds_read_b128 v[156:159], v24 offset:14336
v_and_b32 v27, 15, v0
v_mfma_f32_16x16x32_bf16 a[36:39], v[228:231], v[196:199], a[36:39]
ds_read_b64_tr_b16 v[164:165], v21 offset:0
v_lshlrev_b32 v27, 4, v27
v_mfma_f32_16x16x32_bf16 a[32:35], v[228:231], v[192:195], a[32:35]
ds_read_b64_tr_b16 v[166:167], v21 offset:1024
v_mul_u32_u24 v28, 272, v26
v_mfma_f32_16x16x32_bf16 a[64:67], v[232:235], v[192:195], a[64:67]
ds_read_b64_tr_b16 v[168:169], v22 offset:0
v_add3_u32 v28, v28, v27, s74
v_mfma_f32_16x16x32_bf16 a[68:71], v[232:235], v[196:199], a[68:71]
s_add_u32 m0, s64, 32768
ds_read_b64_tr_b16 v[170:171], v22 offset:1024
v_lshl_add_u32 v26, v26, 12, v27
v_mfma_f32_16x16x32_bf16 a[72:75], v[232:235], v[200:203], a[72:75]
s_add_u32 s72, s71, 0
buffer_load_dwordx4 v6, s[16:19], s72 offen lds
v_mfma_f32_16x16x32_bf16 a[76:79], v[232:235], v[204:207], a[76:79]
ds_read_b64_tr_b16 v[172:173], v23 offset:0
ds_read_b128 v[36:39], v28 offset:0
v_mfma_f32_16x16x32_bf16 a[80:83], v[232:235], v[208:211], a[80:83]
ds_read_b64_tr_b16 v[174:175], v23 offset:1024
ds_read_b128 v[40:43], v28 offset:1088
v_mfma_f32_16x16x32_bf16 a[84:87], v[232:235], v[212:215], a[84:87]
s_add_u32 s72, s71, 31744
buffer_load_dwordx4 v6, s[16:19], s72 offen offset:1024 lds
v_mfma_f32_16x16x32_bf16 a[88:91], v[232:235], v[216:219], a[88:91]
ds_read_b64_tr_b16 v[176:177], v20 offset:16384
ds_read_b128 v[44:47], v28 offset:2176
v_mfma_f32_16x16x32_bf16 a[92:95], v[232:235], v[220:223], a[92:95]
ds_read_b64_tr_b16 v[178:179], v20 offset:17408
ds_read_b128 v[48:51], v28 offset:3264
v_mfma_f32_16x16x32_bf16 a[124:127], v[236:239], v[220:223], a[124:127]
s_and_b32 s74, s2, 15
ds_read_b64_tr_b16 v[180:181], v21 offset:16384
v_mfma_f32_16x16x32_bf16 a[120:123], v[236:239], v[216:219], a[120:123]
s_add_u32 s72, s71, 63488
buffer_load_dwordx4 v7, s[16:19], s72 offen offset:2048 lds
v_mfma_f32_16x16x32_bf16 a[116:119], v[236:239], v[212:215], a[116:119]
s_lshl_b32 s74, s74, 2
ds_read_b64_tr_b16 v[182:183], v21 offset:17408
v_mfma_f32_16x16x32_bf16 a[112:115], v[236:239], v[208:211], a[112:115]
s_add_u32 s74, s74, s58
ds_read_b64_tr_b16 v[184:185], v22 offset:16384
v_mfma_f32_16x16x32_bf16 a[108:111], v[236:239], v[204:207], a[108:111]
s_lshl_b32 s74, s74, 16
ds_read_b64_tr_b16 v[186:187], v22 offset:17408
v_mfma_f32_16x16x32_bf16 a[104:107], v[236:239], v[200:203], a[104:107]
s_lshr_b32 s75, s2, 4
ds_read_b64_tr_b16 v[188:189], v23 offset:16384
v_mfma_f32_16x16x32_bf16 a[100:103], v[236:239], v[196:199], a[100:103]
s_add_u32 s72, s71, 95232
buffer_load_dwordx4 v7, s[16:19], s72 offen offset:3072 lds
v_mfma_f32_16x16x32_bf16 a[96:99], v[236:239], v[192:195], a[96:99]
s_lshl_b32 s75, s75, 8
ds_read_b64_tr_b16 v[190:191], v23 offset:17408
v_mfma_f32_16x16x32_bf16 a[128:131], v[192:195], v[240:243], a[128:131]
s_sub_u32 s74, s74, s75
v_mfma_f32_16x16x32_bf16 a[132:135], v[196:199], v[240:243], a[132:135]
s_add_u32 s74, s74, 0x3000f00
v_mfma_f32_16x16x32_bf16 a[136:139], v[200:203], v[240:243], a[136:139]
s_add_u32 m0, s63, 102400
v_mfma_f32_16x16x32_bf16 a[140:143], v[204:207], v[240:243], a[140:143]
s_add_u32 s72, s69, 32768
buffer_load_dwordx4 v2, s[8:11], s72 offen lds
v_mfma_f32_16x16x32_bf16 a[144:147], v[208:211], v[240:243], a[144:147]
s_waitcnt vmcnt(29)
v_lshlrev_b32 v78, 16, v84
v_lshlrev_b32 v79, 16, v108
v_mfma_f32_16x16x32_bf16 a[148:151], v[212:215], v[240:243], a[148:151]
v_mul_f32 v76, v78, v79
v_lshlrev_b32 v80, 16, v116
v_mfma_f32_16x16x32_bf16 a[152:155], v[216:219], v[240:243], a[152:155]
s_add_u32 s72, s69, 39936
buffer_load_dwordx4 v3, s[8:11], s72 offen offset:1024 lds
v_mfma_f32_16x16x32_bf16 a[156:159], v[220:223], v[240:243], a[156:159]
v_mul_f32 v77, v78, v80
v_and_b32 v78, 0xffff0000, v84
v_mfma_f32_16x16x32_bf16 a[188:191], v[220:223], v[244:247], a[188:191]
v_and_b32 v79, 0xffff0000, v108
v_fmac_f32 v76, v78, v79
v_mfma_f32_16x16x32_bf16 a[184:187], v[216:219], v[244:247], a[184:187]
v_and_b32 v80, 0xffff0000, v116
v_fmac_f32 v77, v78, v80
v_mfma_f32_16x16x32_bf16 a[180:183], v[212:215], v[244:247], a[180:183]
v_lshlrev_b32 v78, 16, v85
v_lshlrev_b32 v79, 16, v109
v_mfma_f32_16x16x32_bf16 a[176:179], v[208:211], v[244:247], a[176:179]
s_add_u32 s72, s69, 47104
buffer_load_dwordx4 v2, s[8:11], s72 offen offset:2048 lds
v_mfma_f32_16x16x32_bf16 a[172:175], v[204:207], v[244:247], a[172:175]
v_fmac_f32 v76, v78, v79
v_lshlrev_b32 v80, 16, v117
v_mfma_f32_16x16x32_bf16 a[168:171], v[200:203], v[244:247], a[168:171]
v_fmac_f32 v77, v78, v80
v_and_b32 v78, 0xffff0000, v85
v_mfma_f32_16x16x32_bf16 a[164:167], v[196:199], v[244:247], a[164:167]
v_and_b32 v79, 0xffff0000, v109
v_fmac_f32 v76, v78, v79
v_mfma_f32_16x16x32_bf16 a[160:163], v[192:195], v[244:247], a[160:163]
s_add_u32 s72, s69, 54272
buffer_load_dwordx4 v3, s[8:11], s72 offen offset:3072 lds
v_mfma_f32_16x16x32_bf16 a[192:195], v[192:195], v[248:251], a[192:195]
v_and_b32 v80, 0xffff0000, v117
v_fmac_f32 v77, v78, v80
v_mfma_f32_16x16x32_bf16 a[196:199], v[196:199], v[248:251], a[196:199]
v_lshlrev_b32 v78, 16, v86
v_lshlrev_b32 v79, 16, v110
v_mfma_f32_16x16x32_bf16 a[200:203], v[200:203], v[248:251], a[200:203]
v_fmac_f32 v76, v78, v79
v_lshlrev_b32 v80, 16, v118
v_mfma_f32_16x16x32_bf16 a[204:207], v[204:207], v[248:251], a[204:207]
s_add_u32 m0, s64, 49152
v_fmac_f32 v77, v78, v80
v_and_b32 v78, 0xffff0000, v86
v_mfma_f32_16x16x32_bf16 a[208:211], v[208:211], v[248:251], a[208:211]
s_add_u32 s72, s71, 0
buffer_load_dwordx4 v6, s[20:23], s72 offen lds
v_mfma_f32_16x16x32_bf16 a[212:215], v[212:215], v[248:251], a[212:215]
v_and_b32 v79, 0xffff0000, v110
v_fmac_f32 v76, v78, v79
v_mfma_f32_16x16x32_bf16 a[216:219], v[216:219], v[248:251], a[216:219]
v_and_b32 v80, 0xffff0000, v118
v_fmac_f32 v77, v78, v80
v_mfma_f32_16x16x32_bf16 a[220:223], v[220:223], v[248:251], a[220:223]
v_lshlrev_b32 v78, 16, v87
v_lshlrev_b32 v79, 16, v111
v_mfma_f32_16x16x32_bf16 a[252:255], v[220:223], v[252:255], a[252:255]
s_add_u32 s72, s71, 31744
buffer_load_dwordx4 v6, s[20:23], s72 offen offset:1024 lds
v_mfma_f32_16x16x32_bf16 a[248:251], v[216:219], v[252:255], a[248:251]
v_fmac_f32 v76, v78, v79
v_lshlrev_b32 v80, 16, v119
v_mfma_f32_16x16x32_bf16 a[244:247], v[212:215], v[252:255], a[244:247]
v_fmac_f32 v77, v78, v80
v_and_b32 v78, 0xffff0000, v87
v_mfma_f32_16x16x32_bf16 a[240:243], v[208:211], v[252:255], a[240:243]
v_and_b32 v79, 0xffff0000, v111
v_fmac_f32 v76, v78, v79
v_mfma_f32_16x16x32_bf16 a[236:239], v[204:207], v[252:255], a[236:239]
s_add_u32 s72, s71, 63488
buffer_load_dwordx4 v7, s[20:23], s72 offen offset:2048 lds
v_mfma_f32_16x16x32_bf16 a[232:235], v[200:203], v[252:255], a[232:235]
v_and_b32 v80, 0xffff0000, v119
v_fmac_f32 v77, v78, v80
v_mfma_f32_16x16x32_bf16 a[228:231], v[196:199], v[252:255], a[228:231]
v_lshlrev_b32 v78, 16, v88
v_lshlrev_b32 v79, 16, v112
v_mfma_f32_16x16x32_bf16 a[224:227], v[192:195], v[252:255], a[224:227]
s_waitcnt lgkmcnt(0)
v_fmac_f32 v76, v78, v79
v_lshlrev_b32 v80, 16, v120
v_mfma_f32_16x16x32_bf16 a[0:3], v[160:163], v[128:131], a[0:3]
s_add_u32 s72, s71, 95232
buffer_load_dwordx4 v7, s[20:23], s72 offen offset:3072 lds
v_mfma_f32_16x16x32_bf16 a[4:7], v[160:163], v[132:135], a[4:7]
ds_read_b64_tr_b16 v[224:225], v20 offset:8192
v_fmac_f32 v77, v78, v80
v_mfma_f32_16x16x32_bf16 a[8:11], v[160:163], v[136:139], a[8:11]
ds_read_b64_tr_b16 v[226:227], v20 offset:9216
v_and_b32 v78, 0xffff0000, v88
v_mfma_f32_16x16x32_bf16 a[12:15], v[160:163], v[140:143], a[12:15]
ds_read_b128 v[192:195], v25 offset:0
v_and_b32 v79, 0xffff0000, v112
v_mfma_f32_16x16x32_bf16 a[16:19], v[160:163], v[144:147], a[16:19]
ds_read_b128 v[196:199], v25 offset:2048
v_fmac_f32 v76, v78, v79
v_mfma_f32_16x16x32_bf16 a[20:23], v[160:163], v[148:151], a[20:23]
ds_read_b128 v[200:203], v25 offset:4096
v_and_b32 v80, 0xffff0000, v120
v_mfma_f32_16x16x32_bf16 a[24:27], v[160:163], v[152:155], a[24:27]
ds_read_b128 v[204:207], v25 offset:6144
v_fmac_f32 v77, v78, v80
v_mfma_f32_16x16x32_bf16 a[28:31], v[160:163], v[156:159], a[28:31]
ds_read_b128 v[208:211], v25 offset:8192
v_lshlrev_b32 v78, 16, v89
v_mfma_f32_16x16x32_bf16 a[60:63], v[164:167], v[156:159], a[60:63]
buffer_store_dwordx4 v[36:39], v26, s[44:47], s74 offen sc1
v_mfma_f32_16x16x32_bf16 a[56:59], v[164:167], v[152:155], a[56:59]
ds_read_b128 v[212:215], v25 offset:10240
v_lshlrev_b32 v79, 16, v113
v_mfma_f32_16x16x32_bf16 a[52:55], v[164:167], v[148:151], a[52:55]
ds_read_b128 v[216:219], v25 offset:12288
v_fmac_f32 v76, v78, v79
v_mfma_f32_16x16x32_bf16 a[48:51], v[164:167], v[144:147], a[48:51]
ds_read_b128 v[220:223], v25 offset:14336
v_lshlrev_b32 v80, 16, v121
v_mfma_f32_16x16x32_bf16 a[44:47], v[164:167], v[140:143], a[44:47]
ds_read_b64_tr_b16 v[228:229], v21 offset:8192
v_fmac_f32 v77, v78, v80
v_mfma_f32_16x16x32_bf16 a[40:43], v[164:167], v[136:139], a[40:43]
ds_read_b64_tr_b16 v[230:231], v21 offset:9216
v_and_b32 v78, 0xffff0000, v89
v_mfma_f32_16x16x32_bf16 a[36:39], v[164:167], v[132:135], a[36:39]
ds_read_b64_tr_b16 v[232:233], v22 offset:8192
v_and_b32 v79, 0xffff0000, v113
v_mfma_f32_16x16x32_bf16 a[32:35], v[164:167], v[128:131], a[32:35]
ds_read_b64_tr_b16 v[234:235], v22 offset:9216
v_fmac_f32 v76, v78, v79
v_mfma_f32_16x16x32_bf16 a[64:67], v[168:171], v[128:131], a[64:67]
ds_read_b64_tr_b16 v[236:237], v23 offset:8192
v_and_b32 v80, 0xffff0000, v121
v_mfma_f32_16x16x32_bf16 a[68:71], v[168:171], v[132:135], a[68:71]
ds_read_b64_tr_b16 v[238:239], v23 offset:9216
v_fmac_f32 v77, v78, v80
v_mfma_f32_16x16x32_bf16 a[72:75], v[168:171], v[136:139], a[72:75]
ds_read_b64_tr_b16 v[240:241], v20 offset:24576
v_lshlrev_b32 v78, 16, v90
v_mfma_f32_16x16x32_bf16 a[76:79], v[168:171], v[140:143], a[76:79]
ds_read_b64_tr_b16 v[242:243], v20 offset:25600
v_lshlrev_b32 v79, 16, v114
v_mfma_f32_16x16x32_bf16 a[80:83], v[168:171], v[144:147], a[80:83]
s_lshr_b32 s75, s93, 5
ds_read_b64_tr_b16 v[244:245], v21 offset:24576
v_fmac_f32 v76, v78, v79
v_mfma_f32_16x16x32_bf16 a[84:87], v[168:171], v[148:151], a[84:87]
s_add_u32 s74, s74, 0x4000
buffer_store_dwordx4 v[40:43], v26, s[44:47], s74 offen sc1
v_mfma_f32_16x16x32_bf16 a[88:91], v[168:171], v[152:155], a[88:91]
s_and_b32 s75, s75, 0x3f80
ds_read_b64_tr_b16 v[246:247], v21 offset:25600
v_lshlrev_b32 v80, 16, v122
v_mfma_f32_16x16x32_bf16 a[92:95], v[168:171], v[156:159], a[92:95]
s_add_u32 s75, s75, LcB0-Lpc0
v_lshrrev_b32 v2, 6, v0
v_lshlrev_b32 v2, 7, v2
v_mfma_f32_16x16x32_bf16 a[124:127], v[172:175], v[156:159], a[124:127]
v_add_u32 v2, s75, v2
v_min_u32 v2, Lcode_end-Lpc0, v2
v_mfma_f32_16x16x32_bf16 a[120:123], v[172:175], v[152:155], a[120:123]
global_load_dword v3, v2, s[98:99]
v_mfma_f32_16x16x32_bf16 a[116:119], v[172:175], v[148:151], a[116:119]
ds_read_b64_tr_b16 v[248:249], v22 offset:24576
v_fmac_f32 v77, v78, v80
v_mfma_f32_16x16x32_bf16 a[112:115], v[172:175], v[144:147], a[112:115]
ds_read_b64_tr_b16 v[250:251], v22 offset:25600
v_and_b32 v78, 0xffff0000, v90
v_mfma_f32_16x16x32_bf16 a[108:111], v[172:175], v[140:143], a[108:111]
ds_read_b64_tr_b16 v[252:253], v23 offset:24576
v_and_b32 v79, 0xffff0000, v114
v_mfma_f32_16x16x32_bf16 a[104:107], v[172:175], v[136:139], a[104:107]
ds_read_b64_tr_b16 v[254:255], v23 offset:25600
v_fmac_f32 v76, v78, v79
v_mfma_f32_16x16x32_bf16 a[100:103], v[172:175], v[132:135], a[100:103]
v_and_b32 v80, 0xffff0000, v122
v_fmac_f32 v77, v78, v80
v_mfma_f32_16x16x32_bf16 a[96:99], v[172:175], v[128:131], a[96:99]
v_lshlrev_b32 v78, 16, v91
v_lshlrev_b32 v79, 16, v115
v_mfma_f32_16x16x32_bf16 a[128:131], v[128:131], v[176:179], a[128:131]
v_fmac_f32 v76, v78, v79
v_lshlrev_b32 v80, 16, v123
v_mfma_f32_16x16x32_bf16 a[132:135], v[132:135], v[176:179], a[132:135]
v_fmac_f32 v77, v78, v80
v_and_b32 v78, 0xffff0000, v91
v_mfma_f32_16x16x32_bf16 a[136:139], v[136:139], v[176:179], a[136:139]
v_and_b32 v79, 0xffff0000, v115
v_fmac_f32 v76, v78, v79
v_mfma_f32_16x16x32_bf16 a[140:143], v[140:143], v[176:179], a[140:143]
s_add_u32 s74, s74, 0x4000
buffer_store_dwordx4 v[44:47], v26, s[44:47], s74 offen sc1
v_mfma_f32_16x16x32_bf16 a[144:147], v[144:147], v[176:179], a[144:147]
v_and_b32 v80, 0xffff0000, v123
v_fmac_f32 v77, v78, v80
v_mfma_f32_16x16x32_bf16 a[148:151], v[148:151], v[176:179], a[148:151]
v_add_f32_dpp v76, v76, v76 row_ror:8 row_mask:0xf bank_mask:0xf
v_add_f32_dpp v77, v77, v77 row_ror:8 row_mask:0xf bank_mask:0xf
v_mfma_f32_16x16x32_bf16 a[152:155], v[152:155], v[176:179], a[152:155]
v_add_f32_dpp v76, v76, v76 row_ror:4 row_mask:0xf bank_mask:0xf
v_add_f32_dpp v77, v77, v77 row_ror:4 row_mask:0xf bank_mask:0xf
v_mfma_f32_16x16x32_bf16 a[156:159], v[156:159], v[176:179], a[156:159]
v_add_f32_dpp v76, v76, v76 row_ror:2 row_mask:0xf bank_mask:0xf
v_add_f32_dpp v77, v77, v77 row_ror:2 row_mask:0xf bank_mask:0xf
v_mfma_f32_16x16x32_bf16 a[188:191], v[156:159], v[180:183], a[188:191]
v_add_f32_dpp v76, v76, v76 row_ror:1 row_mask:0xf bank_mask:0xf
v_add_f32_dpp v77, v77, v77 row_ror:1 row_mask:0xf bank_mask:0xf
v_mfma_f32_16x16x32_bf16 a[184:187], v[152:155], v[180:183], a[184:187]
v_mov_b32 v78, v76
v_mov_b32 v79, v77
v_mfma_f32_16x16x32_bf16 a[180:183], v[148:151], v[180:183], a[180:183]
v_permlane16_swap_b32 v76, v78
v_permlane16_swap_b32 v77, v79
v_mfma_f32_16x16x32_bf16 a[176:179], v[144:147], v[180:183], a[176:179]
v_add_f32 v76, v76, v78
v_add_f32 v77, v77, v79
v_mfma_f32_16x16x32_bf16 a[172:175], v[140:143], v[180:183], a[172:175]
v_mov_b32 v78, v76
v_mov_b32 v79, v77
v_mfma_f32_16x16x32_bf16 a[168:171], v[136:139], v[180:183], a[168:171]
v_permlane32_swap_b32 v76, v78
v_permlane32_swap_b32 v77, v79
v_mfma_f32_16x16x32_bf16 a[164:167], v[132:135], v[180:183], a[164:167]
v_add_f32 v76, v76, v78
v_add_f32 v77, v77, v79
v_mfma_f32_16x16x32_bf16 a[160:163], v[128:131], v[180:183], a[160:163]
v_mul_f32 v76, 0xbfb8aa3b, v76
v_mul_f32 v77, 0xbfb8aa3b, v77
v_mfma_f32_16x16x32_bf16 a[192:195], v[128:131], v[184:187], a[192:195]
v_exp_f32 v76, v76
v_mfma_f32_16x16x32_bf16 a[196:199], v[132:135], v[184:187], a[196:199]
s_add_u32 s74, s74, 0x4000
buffer_store_dwordx4 v[48:51], v26, s[44:47], s74 offen sc1
v_mfma_f32_16x16x32_bf16 a[200:203], v[136:139], v[184:187], a[200:203]
v_exp_f32 v77, v77
v_mfma_f32_16x16x32_bf16 a[204:207], v[140:143], v[184:187], a[204:207]
v_add_f32 v76, 1.0, v76
v_add_f32 v77, 1.0, v77
v_mfma_f32_16x16x32_bf16 a[208:211], v[144:147], v[184:187], a[208:211]
v_rcp_f32 v76, v76
v_mfma_f32_16x16x32_bf16 a[212:215], v[148:151], v[184:187], a[212:215]
v_rcp_f32 v77, v77
v_mfma_f32_16x16x32_bf16 a[216:219], v[152:155], v[184:187], a[216:219]
s_lshr_b32 s80, s76, 9
v_mfma_f32_16x16x32_bf16 a[220:223], v[156:159], v[184:187], a[220:223]
s_add_u32 s80, s80, 0x3800000
v_min_u32 v78, 1, v0
v_lshlrev_b32 v78, 30, v78
v_mfma_f32_16x16x32_bf16 a[252:255], v[156:159], v[188:191], a[252:255]
buffer_store_dwordx2 v[76:77], v78, s[44:47], s80 offen sc1
v_mfma_f32_16x16x32_bf16 a[248:251], v[152:155], v[188:191], a[248:251]
v_mfma_f32_16x16x32_bf16 a[244:247], v[148:151], v[188:191], a[244:247]
v_mfma_f32_16x16x32_bf16 a[240:243], v[144:147], v[188:191], a[240:243]
v_mfma_f32_16x16x32_bf16 a[236:239], v[140:143], v[188:191], a[236:239]
v_mfma_f32_16x16x32_bf16 a[232:235], v[136:139], v[188:191], a[232:235]
v_mfma_f32_16x16x32_bf16 a[228:231], v[132:135], v[188:191], a[228:231]
s_waitcnt vmcnt(6) lgkmcnt(0)
v_mfma_f32_16x16x32_bf16 a[224:227], v[128:131], v[188:191], a[224:227]
s_barrier
v_mfma_f32_16x16x32_bf16 a[0:3], v[224:227], v[192:195], a[0:3]
s_add_u32 s73, s62, 0
ds_read_b64_tr_b16 v[160:161], v20 offset:32768
v_mfma_f32_16x16x32_bf16 a[4:7], v[224:227], v[196:199], a[4:7]
s_add_u32 s70, s73, s65
ds_read_b64_tr_b16 v[162:163], v20 offset:33792
v_mfma_f32_16x16x32_bf16 a[8:11], v[224:227], v[200:203], a[8:11]
s_and_b32 s70, s70, 3
ds_read_b128 v[128:131], v24 offset:32768
v_mfma_f32_16x16x32_bf16 a[12:15], v[224:227], v[204:207], a[12:15]
s_and_b32 s73, s73, 12
ds_read_b128 v[132:135], v24 offset:34816
v_mfma_f32_16x16x32_bf16 a[16:19], v[224:227], v[208:211], a[16:19]
s_or_b32 s73, s73, s70
ds_read_b128 v[136:139], v24 offset:36864
v_mfma_f32_16x16x32_bf16 a[20:23], v[224:227], v[212:215], a[20:23]
s_lshl_b32 s71, s73, 19
ds_read_b128 v[140:143], v24 offset:38912
v_mfma_f32_16x16x32_bf16 a[24:27], v[224:227], v[216:219], a[24:27]
s_add_u32 s71, s71, s66
ds_read_b128 v[144:147], v24 offset:40960
v_mfma_f32_16x16x32_bf16 a[28:31], v[224:227], v[220:223], a[28:31]
s_lshl_b32 s73, s73, 7
ds_read_b128 v[148:151], v24 offset:43008
v_mfma_f32_16x16x32_bf16 a[60:63], v[228:231], v[220:223], a[60:63]
s_add_u32 s69, s73, s67
ds_read_b128 v[152:155], v24 offset:45056
v_mfma_f32_16x16x32_bf16 a[56:59], v[228:231], v[216:219], a[56:59]
s_add_u32 s70, s73, s68
ds_read_b128 v[156:159], v24 offset:47104
v_mfma_f32_16x16x32_bf16 a[52:55], v[228:231], v[212:215], a[52:55]
s_add_u32 m0, s64, 0
ds_read_b64_tr_b16 v[164:165], v21 offset:32768
v_mfma_f32_16x16x32_bf16 a[48:51], v[228:231], v[208:211], a[48:51]
s_add_u32 s72, s71, 0
buffer_load_dwordx4 v6, s[12:15], s72 offen lds
v_mfma_f32_16x16x32_bf16 a[44:47], v[228:231], v[204:207], a[44:47]
s_add_u32 s72, s71, 31744
buffer_load_dwordx4 v6, s[12:15], s72 offen offset:1024 lds
v_mfma_f32_16x16x32_bf16 a[40:43], v[228:231], v[200:203], a[40:43]
s_add_u32 s72, s71, 63488
buffer_load_dwordx4 v7, s[12:15], s72 offen offset:2048 lds
v_mfma_f32_16x16x32_bf16 a[36:39], v[228:231], v[196:199], a[36:39]
ds_read_b64_tr_b16 v[166:167], v21 offset:33792
v_mfma_f32_16x16x32_bf16 a[32:35], v[228:231], v[192:195], a[32:35]
s_add_u32 s72, s71, 95232
buffer_load_dwordx4 v7, s[12:15], s72 offen offset:3072 lds
v_mfma_f32_16x16x32_bf16 a[64:67], v[232:235], v[192:195], a[64:67]
ds_read_b64_tr_b16 v[168:169], v22 offset:32768
v_mfma_f32_16x16x32_bf16 a[68:71], v[232:235], v[196:199], a[68:71]
ds_read_b64_tr_b16 v[170:171], v22 offset:33792
v_mfma_f32_16x16x32_bf16 a[72:75], v[232:235], v[200:203], a[72:75]
ds_read_b64_tr_b16 v[172:173], v23 offset:32768
v_mfma_f32_16x16x32_bf16 a[76:79], v[232:235], v[204:207], a[76:79]
ds_read_b64_tr_b16 v[174:175], v23 offset:33792
v_mfma_f32_16x16x32_bf16 a[80:83], v[232:235], v[208:211], a[80:83]
s_add_u32 m0, s63, 131072
ds_read_b64_tr_b16 v[176:177], v20 offset:49152
v_mfma_f32_16x16x32_bf16 a[84:87], v[232:235], v[212:215], a[84:87]
s_add_u32 s72, s69, 0
buffer_load_dwordx4 v4, s[4:7], s72 offen lds
v_mfma_f32_16x16x32_bf16 a[88:91], v[232:235], v[216:219], a[88:91]
ds_read_b64_tr_b16 v[178:179], v20 offset:50176
v_mfma_f32_16x16x32_bf16 a[92:95], v[232:235], v[220:223], a[92:95]
ds_read_b64_tr_b16 v[180:181], v21 offset:49152
v_mfma_f32_16x16x32_bf16 a[124:127], v[236:239], v[220:223], a[124:127]
ds_read_b64_tr_b16 v[182:183], v21 offset:50176
v_mfma_f32_16x16x32_bf16 a[120:123], v[236:239], v[216:219], a[120:123]
s_add_u32 s72, s69, 15360
buffer_load_dwordx4 v5, s[4:7], s72 offen offset:1024 lds
v_mfma_f32_16x16x32_bf16 a[116:119], v[236:239], v[212:215], a[116:119]
ds_read_b64_tr_b16 v[184:185], v22 offset:49152
v_mfma_f32_16x16x32_bf16 a[112:115], v[236:239], v[208:211], a[112:115]
ds_read_b64_tr_b16 v[186:187], v22 offset:50176
v_mfma_f32_16x16x32_bf16 a[108:111], v[236:239], v[204:207], a[108:111]
ds_read_b64_tr_b16 v[188:189], v23 offset:49152
v_mfma_f32_16x16x32_bf16 a[104:107], v[236:239], v[200:203], a[104:107]
ds_read_b64_tr_b16 v[190:191], v23 offset:50176
v_mfma_f32_16x16x32_bf16 a[100:103], v[236:239], v[196:199], a[100:103]
s_add_u32 s72, s69, 129024
buffer_load_dwordx4 v4, s[4:7], s72 offen offset:2048 lds
v_mfma_f32_16x16x32_bf16 a[96:99], v[236:239], v[192:195], a[96:99]
v_mfma_f32_16x16x32_bf16 a[128:131], v[192:195], v[240:243], a[128:131]
v_mfma_f32_16x16x32_bf16 a[132:135], v[196:199], v[240:243], a[132:135]
v_mfma_f32_16x16x32_bf16 a[136:139], v[200:203], v[240:243], a[136:139]
v_mfma_f32_16x16x32_bf16 a[140:143], v[204:207], v[240:243], a[140:143]
s_add_u32 s72, s69, 144384
buffer_load_dwordx4 v5, s[4:7], s72 offen offset:3072 lds
v_mfma_f32_16x16x32_bf16 a[144:147], v[208:211], v[240:243], a[144:147]
v_mfma_f32_16x16x32_bf16 a[148:151], v[212:215], v[240:243], a[148:151]
v_mfma_f32_16x16x32_bf16 a[152:155], v[216:219], v[240:243], a[152:155]
v_mfma_f32_16x16x32_bf16 a[156:159], v[220:223], v[240:243], a[156:159]
v_mfma_f32_16x16x32_bf16 a[188:191], v[220:223], v[244:247], a[188:191]
s_add_u32 m0, s63, 135168
v_mfma_f32_16x16x32_bf16 a[184:187], v[216:219], v[244:247], a[184:187]
s_add_u32 s72, s70, 0
buffer_load_dwordx4 v4, s[4:7], s72 offen lds
v_mfma_f32_16x16x32_bf16 a[180:183], v[212:215], v[244:247], a[180:183]
v_mfma_f32_16x16x32_bf16 a[176:179], v[208:211], v[244:247], a[176:179]
v_mfma_f32_16x16x32_bf16 a[172:175], v[204:207], v[244:247], a[172:175]
v_mfma_f32_16x16x32_bf16 a[168:171], v[200:203], v[244:247], a[168:171]
s_add_u32 s72, s70, 15360
buffer_load_dwordx4 v5, s[4:7], s72 offen offset:1024 lds
v_mfma_f32_16x16x32_bf16 a[164:167], v[196:199], v[244:247], a[164:167]
v_mfma_f32_16x16x32_bf16 a[160:163], v[192:195], v[244:247], a[160:163]
v_mfma_f32_16x16x32_bf16 a[192:195], v[192:195], v[248:251], a[192:195]
v_mfma_f32_16x16x32_bf16 a[196:199], v[196:199], v[248:251], a[196:199]
v_mfma_f32_16x16x32_bf16 a[200:203], v[200:203], v[248:251], a[200:203]
s_add_u32 s72, s70, 129024
buffer_load_dwordx4 v4, s[4:7], s72 offen offset:2048 lds
v_mfma_f32_16x16x32_bf16 a[204:207], v[204:207], v[248:251], a[204:207]
v_mfma_f32_16x16x32_bf16 a[208:211], v[208:211], v[248:251], a[208:211]
v_mfma_f32_16x16x32_bf16 a[212:215], v[212:215], v[248:251], a[212:215]
v_mfma_f32_16x16x32_bf16 a[216:219], v[216:219], v[248:251], a[216:219]
v_mfma_f32_16x16x32_bf16 a[220:223], v[220:223], v[248:251], a[220:223]
s_add_u32 s72, s70, 144384
buffer_load_dwordx4 v5, s[4:7], s72 offen offset:3072 lds
v_mfma_f32_16x16x32_bf16 a[252:255], v[220:223], v[252:255], a[252:255]
v_mfma_f32_16x16x32_bf16 a[248:251], v[216:219], v[252:255], a[248:251]
v_mfma_f32_16x16x32_bf16 a[244:247], v[212:215], v[252:255], a[244:247]
v_mfma_f32_16x16x32_bf16 a[240:243], v[208:211], v[252:255], a[240:243]
v_mfma_f32_16x16x32_bf16 a[236:239], v[204:207], v[252:255], a[236:239]
s_add_u32 s73, s62, 1
v_mfma_f32_16x16x32_bf16 a[232:235], v[200:203], v[252:255], a[232:235]
s_add_u32 s70, s73, s65
v_mfma_f32_16x16x32_bf16 a[228:231], v[196:199], v[252:255], a[228:231]
s_and_b32 s70, s70, 3
v_mfma_f32_16x16x32_bf16 a[224:227], v[192:195], v[252:255], a[224:227]
s_waitcnt lgkmcnt(0)
v_mfma_f32_16x16x32_bf16 a[0:3], v[160:163], v[128:131], a[0:3]
s_and_b32 s73, s73, 12
ds_read_b64_tr_b16 v[224:225], v20 offset:40960
v_mfma_f32_16x16x32_bf16 a[4:7], v[160:163], v[132:135], a[4:7]
s_or_b32 s73, s73, s70
ds_read_b64_tr_b16 v[226:227], v20 offset:41984
v_mfma_f32_16x16x32_bf16 a[8:11], v[160:163], v[136:139], a[8:11]
s_lshl_b32 s71, s73, 19
ds_read_b128 v[192:195], v25 offset:32768
v_mfma_f32_16x16x32_bf16 a[12:15], v[160:163], v[140:143], a[12:15]
s_add_u32 s71, s71, s66
ds_read_b128 v[196:199], v25 offset:34816
v_mfma_f32_16x16x32_bf16 a[16:19], v[160:163], v[144:147], a[16:19]
s_lshl_b32 s73, s73, 7
ds_read_b128 v[200:203], v25 offset:36864
v_mfma_f32_16x16x32_bf16 a[20:23], v[160:163], v[148:151], a[20:23]
s_add_u32 s69, s73, s67
ds_read_b128 v[204:207], v25 offset:38912
v_mfma_f32_16x16x32_bf16 a[24:27], v[160:163], v[152:155], a[24:27]
s_add_u32 s70, s73, s68
ds_read_b128 v[208:211], v25 offset:40960
v_mfma_f32_16x16x32_bf16 a[28:31], v[160:163], v[156:159], a[28:31]
s_add_u32 m0, s64, 16384
ds_read_b128 v[212:215], v25 offset:43008
v_mfma_f32_16x16x32_bf16 a[60:63], v[164:167], v[156:159], a[60:63]
s_add_u32 s72, s71, 0
buffer_load_dwordx4 v6, s[12:15], s72 offen lds
v_mfma_f32_16x16x32_bf16 a[56:59], v[164:167], v[152:155], a[56:59]
s_add_u32 s72, s71, 31744
buffer_load_dwordx4 v6, s[12:15], s72 offen offset:1024 lds
v_mfma_f32_16x16x32_bf16 a[52:55], v[164:167], v[148:151], a[52:55]
s_add_u32 s72, s71, 63488
buffer_load_dwordx4 v7, s[12:15], s72 offen offset:2048 lds
v_mfma_f32_16x16x32_bf16 a[48:51], v[164:167], v[144:147], a[48:51]
s_add_u32 s72, s71, 95232
buffer_load_dwordx4 v7, s[12:15], s72 offen offset:3072 lds
v_mfma_f32_16x16x32_bf16 a[44:47], v[164:167], v[140:143], a[44:47]
ds_read_b128 v[216:219], v25 offset:45056
v_mfma_f32_16x16x32_bf16 a[40:43], v[164:167], v[136:139], a[40:43]
ds_read_b128 v[220:223], v25 offset:47104
v_mfma_f32_16x16x32_bf16 a[36:39], v[164:167], v[132:135], a[36:39]
ds_read_b64_tr_b16 v[228:229], v21 offset:40960
v_mfma_f32_16x16x32_bf16 a[32:35], v[164:167], v[128:131], a[32:35]
ds_read_b64_tr_b16 v[230:231], v21 offset:41984
v_mfma_f32_16x16x32_bf16 a[64:67], v[168:171], v[128:131], a[64:67]
s_add_u32 m0, s63, 65536
ds_read_b64_tr_b16 v[232:233], v22 offset:40960
v_mfma_f32_16x16x32_bf16 a[68:71], v[168:171], v[132:135], a[68:71]
s_add_u32 s72, s69, 0
buffer_load_dwordx4 v4, s[4:7], s72 offen lds
v_mfma_f32_16x16x32_bf16 a[72:75], v[168:171], v[136:139], a[72:75]
ds_read_b64_tr_b16 v[234:235], v22 offset:41984
v_mfma_f32_16x16x32_bf16 a[76:79], v[168:171], v[140:143], a[76:79]
ds_read_b64_tr_b16 v[236:237], v23 offset:40960
v_mfma_f32_16x16x32_bf16 a[80:83], v[168:171], v[144:147], a[80:83]
ds_read_b64_tr_b16 v[238:239], v23 offset:41984
v_mfma_f32_16x16x32_bf16 a[84:87], v[168:171], v[148:151], a[84:87]
s_add_u32 s72, s69, 15360
buffer_load_dwordx4 v5, s[4:7], s72 offen offset:1024 lds
v_mfma_f32_16x16x32_bf16 a[88:91], v[168:171], v[152:155], a[88:91]
ds_read_b64_tr_b16 v[240:241], v20 offset:57344
v_mfma_f32_16x16x32_bf16 a[92:95], v[168:171], v[156:159], a[92:95]
ds_read_b64_tr_b16 v[242:243], v20 offset:58368
v_mfma_f32_16x16x32_bf16 a[124:127], v[172:175], v[156:159], a[124:127]
ds_read_b64_tr_b16 v[244:245], v21 offset:57344
v_mfma_f32_16x16x32_bf16 a[120:123], v[172:175], v[152:155], a[120:123]
ds_read_b64_tr_b16 v[246:247], v21 offset:58368
v_mfma_f32_16x16x32_bf16 a[116:119], v[172:175], v[148:151], a[116:119]
s_add_u32 s72, s69, 129024
buffer_load_dwordx4 v4, s[4:7], s72 offen offset:2048 lds
v_mfma_f32_16x16x32_bf16 a[112:115], v[172:175], v[144:147], a[112:115]
ds_read_b64_tr_b16 v[248:249], v22 offset:57344
v_mfma_f32_16x16x32_bf16 a[108:111], v[172:175], v[140:143], a[108:111]
ds_read_b64_tr_b16 v[250:251], v22 offset:58368
v_mfma_f32_16x16x32_bf16 a[104:107], v[172:175], v[136:139], a[104:107]
ds_read_b64_tr_b16 v[252:253], v23 offset:57344
v_mfma_f32_16x16x32_bf16 a[100:103], v[172:175], v[132:135], a[100:103]
ds_read_b64_tr_b16 v[254:255], v23 offset:58368
v_mfma_f32_16x16x32_bf16 a[96:99], v[172:175], v[128:131], a[96:99]
s_add_u32 s72, s69, 144384
buffer_load_dwordx4 v5, s[4:7], s72 offen offset:3072 lds
v_mfma_f32_16x16x32_bf16 a[128:131], v[128:131], v[176:179], a[128:131]
v_mfma_f32_16x16x32_bf16 a[132:135], v[132:135], v[176:179], a[132:135]
v_mfma_f32_16x16x32_bf16 a[136:139], v[136:139], v[176:179], a[136:139]
v_mfma_f32_16x16x32_bf16 a[140:143], v[140:143], v[176:179], a[140:143]
v_mfma_f32_16x16x32_bf16 a[144:147], v[144:147], v[176:179], a[144:147]
s_add_u32 m0, s63, 69632
v_mfma_f32_16x16x32_bf16 a[148:151], v[148:151], v[176:179], a[148:151]
s_add_u32 s72, s70, 0
buffer_load_dwordx4 v4, s[4:7], s72 offen lds
v_mfma_f32_16x16x32_bf16 a[152:155], v[152:155], v[176:179], a[152:155]
v_mfma_f32_16x16x32_bf16 a[156:159], v[156:159], v[176:179], a[156:159]
v_mfma_f32_16x16x32_bf16 a[188:191], v[156:159], v[180:183], a[188:191]
v_mfma_f32_16x16x32_bf16 a[184:187], v[152:155], v[180:183], a[184:187]
s_add_u32 s72, s70, 15360
buffer_load_dwordx4 v5, s[4:7], s72 offen offset:1024 lds
v_mfma_f32_16x16x32_bf16 a[180:183], v[148:151], v[180:183], a[180:183]
v_mfma_f32_16x16x32_bf16 a[176:179], v[144:147], v[180:183], a[176:179]
v_mfma_f32_16x16x32_bf16 a[172:175], v[140:143], v[180:183], a[172:175]
v_mfma_f32_16x16x32_bf16 a[168:171], v[136:139], v[180:183], a[168:171]
v_mfma_f32_16x16x32_bf16 a[164:167], v[132:135], v[180:183], a[164:167]
s_add_u32 s72, s70, 129024
buffer_load_dwordx4 v4, s[4:7], s72 offen offset:2048 lds
v_mfma_f32_16x16x32_bf16 a[160:163], v[128:131], v[180:183], a[160:163]
v_mfma_f32_16x16x32_bf16 a[192:195], v[128:131], v[184:187], a[192:195]
v_mfma_f32_16x16x32_bf16 a[196:199], v[132:135], v[184:187], a[196:199]
v_mfma_f32_16x16x32_bf16 a[200:203], v[136:139], v[184:187], a[200:203]
v_mfma_f32_16x16x32_bf16 a[204:207], v[140:143], v[184:187], a[204:207]
s_add_u32 s72, s70, 144384
buffer_load_dwordx4 v5, s[4:7], s72 offen offset:3072 lds
v_mfma_f32_16x16x32_bf16 a[208:211], v[144:147], v[184:187], a[208:211]
v_mfma_f32_16x16x32_bf16 a[212:215], v[148:151], v[184:187], a[212:215]
v_mfma_f32_16x16x32_bf16 a[216:219], v[152:155], v[184:187], a[216:219]
v_mfma_f32_16x16x32_bf16 a[220:223], v[156:159], v[184:187], a[220:223]
v_mfma_f32_16x16x32_bf16 a[252:255], v[156:159], v[188:191], a[252:255]
v_mfma_f32_16x16x32_bf16 a[248:251], v[152:155], v[188:191], a[248:251]
v_mfma_f32_16x16x32_bf16 a[244:247], v[148:151], v[188:191], a[244:247]
v_mfma_f32_16x16x32_bf16 a[240:243], v[144:147], v[188:191], a[240:243]
v_mfma_f32_16x16x32_bf16 a[236:239], v[140:143], v[188:191], a[236:239]
v_mfma_f32_16x16x32_bf16 a[232:235], v[136:139], v[188:191], a[232:235]
v_mfma_f32_16x16x32_bf16 a[228:231], v[132:135], v[188:191], a[228:231]
s_waitcnt vmcnt(12) lgkmcnt(0)
v_mfma_f32_16x16x32_bf16 a[224:227], v[128:131], v[188:191], a[224:227]
s_barrier
LcB0:
v_mfma_f32_16x16x32_bf16 a[0:3], v[224:227], v[192:195], a[0:3]
s_add_u32 s73, s62, 2
ds_read_b64_tr_b16 v[32:33], v8 offset:0
v_mfma_f32_16x16x32_bf16 a[4:7], v[224:227], v[196:199], a[4:7]
s_add_u32 s70, s73, s65
ds_read_b64_tr_b16 v[34:35], v8 offset:1024
v_mfma_f32_16x16x32_bf16 a[8:11], v[224:227], v[200:203], a[8:11]
s_and_b32 s70, s70, 3
ds_read_b128 v[64:67], v16 offset:0
v_mfma_f32_16x16x32_bf16 a[12:15], v[224:227], v[204:207], a[12:15]
s_and_b32 s73, s73, 12
ds_read_b128 v[68:71], v16 offset:2048
v_mfma_f32_16x16x32_bf16 a[16:19], v[224:227], v[208:211], a[16:19]
s_or_b32 s73, s73, s70
ds_read_b128 v[72:75], v16 offset:4096
v_mfma_f32_16x16x32_bf16 a[20:23], v[224:227], v[212:215], a[20:23]
s_lshl_b32 s71, s73, 19
ds_read_b128 v[76:79], v16 offset:6144
v_mfma_f32_16x16x32_bf16 a[24:27], v[224:227], v[216:219], a[24:27]
s_add_u32 s71, s71, s66
ds_read_b64_tr_b16 v[36:37], v9 offset:0
v_mfma_f32_16x16x32_bf16 a[28:31], v[224:227], v[220:223], a[28:31]
s_lshl_b32 s73, s73, 7
ds_read_b64_tr_b16 v[38:39], v9 offset:1024
v_mfma_f32_16x16x32_bf16 a[60:63], v[228:231], v[220:223], a[60:63]
s_add_u32 s69, s73, s67
ds_read_b64_tr_b16 v[40:41], v10 offset:0
v_mfma_f32_16x16x32_bf16 a[56:59], v[228:231], v[216:219], a[56:59]
s_add_u32 s70, s73, s68
ds_read_b64_tr_b16 v[42:43], v10 offset:1024
v_mfma_f32_16x16x32_bf16 a[52:55], v[228:231], v[212:215], a[52:55]
s_add_u32 m0, s64, 32768
ds_read_b64_tr_b16 v[44:45], v11 offset:0
v_mfma_f32_16x16x32_bf16 a[48:51], v[228:231], v[208:211], a[48:51]
s_add_u32 s72, s71, 0
buffer_load_dwordx4 v6, s[12:15], s72 offen lds
v_mfma_f32_16x16x32_bf16 a[44:47], v[228:231], v[204:207], a[44:47]
s_add_u32 s72, s71, 31744
buffer_load_dwordx4 v6, s[12:15], s72 offen offset:1024 lds
v_mfma_f32_16x16x32_bf16 a[40:43], v[228:231], v[200:203], a[40:43]
s_add_u32 s72, s71, 63488
buffer_load_dwordx4 v7, s[12:15], s72 offen offset:2048 lds
v_mfma_f32_16x16x32_bf16 a[36:39], v[228:231], v[196:199], a[36:39]
s_lshl_b32 s80, s59, 2
ds_read_b64_tr_b16 v[46:47], v11 offset:1024
v_or_b32 v26, s58, v0
v_mfma_f32_16x16x32_bf16 a[32:35], v[228:231], v[192:195], a[32:35]
s_add_u32 s72, s71, 95232
buffer_load_dwordx4 v7, s[12:15], s72 offen offset:3072 lds
v_mfma_f32_16x16x32_bf16 a[64:67], v[232:235], v[192:195], a[64:67]
ds_read_b64_tr_b16 v[48:49], v12 offset:0
v_mov_b32 v27, 1
v_mfma_f32_16x16x32_bf16 a[68:71], v[232:235], v[196:199], a[68:71]
ds_read_b64_tr_b16 v[50:51], v12 offset:1024
v_lshlrev_b32 v26, 8, v26
v_mfma_f32_16x16x32_bf16 a[72:75], v[232:235], v[200:203], a[72:75]
ds_read_b64_tr_b16 v[52:53], v13 offset:0
v_mfma_f32_16x16x32_bf16 a[76:79], v[232:235], v[204:207], a[76:79]
ds_read_b64_tr_b16 v[54:55], v13 offset:1024
v_mfma_f32_16x16x32_bf16 a[80:83], v[232:235], v[208:211], a[80:83]
s_add_u32 m0, s63, 98304
ds_read_b64_tr_b16 v[56:57], v14 offset:0
v_mfma_f32_16x16x32_bf16 a[84:87], v[232:235], v[212:215], a[84:87]
s_add_u32 s72, s69, 0
buffer_load_dwordx4 v4, s[4:7], s72 offen lds
v_mfma_f32_16x16x32_bf16 a[88:91], v[232:235], v[216:219], a[88:91]
ds_read_b64_tr_b16 v[58:59], v14 offset:1024
v_mfma_f32_16x16x32_bf16 a[92:95], v[232:235], v[220:223], a[92:95]
ds_read_b64_tr_b16 v[60:61], v15 offset:0
v_mfma_f32_16x16x32_bf16 a[124:127], v[236:239], v[220:223], a[124:127]
ds_read_b64_tr_b16 v[62:63], v15 offset:1024
v_mfma_f32_16x16x32_bf16 a[120:123], v[236:239], v[216:219], a[120:123]
s_add_u32 s72, s69, 15360
buffer_load_dwordx4 v5, s[4:7], s72 offen offset:1024 lds
v_mfma_f32_16x16x32_bf16 a[116:119], v[236:239], v[212:215], a[116:119]
buffer_atomic_add v27, v26, s[48:51], s80 offen sc1
v_mfma_f32_16x16x32_bf16 a[112:115], v[236:239], v[208:211], a[112:115]
v_accvgpr_read_b32 v20, a0
v_accvgpr_read_b32 v28, a1
v_mfma_f32_16x16x32_bf16 a[108:111], v[236:239], v[204:207], a[108:111]
v_accvgpr_read_b32 v21, a2
v_accvgpr_read_b32 v29, a3
v_mfma_f32_16x16x32_bf16 a[104:107], v[236:239], v[200:203], a[104:107]
v_accvgpr_read_b32 v22, a32
v_accvgpr_read_b32 v30, a33
v_mfma_f32_16x16x32_bf16 a[100:103], v[236:239], v[196:199], a[100:103]
s_add_u32 s72, s69, 129024
buffer_load_dwordx4 v4, s[4:7], s72 offen offset:2048 lds
v_mfma_f32_16x16x32_bf16 a[96:99], v[236:239], v[192:195], a[96:99]
v_accvgpr_read_b32 v23, a34
v_accvgpr_read_b32 v31, a35
v_mfma_f32_16x16x32_bf16 a[128:131], v[192:195], v[240:243], a[128:131]
v_mul_f32 v20, s79, v20
v_mul_f32 v28, s79, v28
v_mfma_f32_16x16x32_bf16 a[132:135], v[196:199], v[240:243], a[132:135]
v_mul_f32 v21, s79, v21
v_mul_f32 v29, s79, v29
v_mfma_f32_16x16x32_bf16 a[136:139], v[200:203], v[240:243], a[136:139]
v_mul_f32 v22, s79, v22
v_mul_f32 v30, s79, v30
v_mfma_f32_16x16x32_bf16 a[140:143], v[204:207], v[240:243], a[140:143]
s_add_u32 s72, s69, 144384
buffer_load_dwordx4 v5, s[4:7], s72 offen offset:3072 lds
v_mfma_f32_16x16x32_bf16 a[144:147], v[208:211], v[240:243], a[144:147]
v_mul_f32 v23, s79, v23
v_mul_f32 v31, s79, v31
v_mfma_f32_16x16x32_bf16 a[148:151], v[212:215], v[240:243], a[148:151]
v_cvt_pk_bf16_f32 v20, v20, v28
v_cvt_pk_bf16_f32 v21, v21, v29
v_mfma_f32_16x16x32_bf16 a[152:155], v[216:219], v[240:243], a[152:155]
v_cvt_pk_bf16_f32 v22, v22, v30
v_cvt_pk_bf16_f32 v23, v23, v31
v_mfma_f32_16x16x32_bf16 a[156:159], v[220:223], v[240:243], a[156:159]
s_add_u32 s80, s77, 0
buffer_store_dwordx4 v[20:23], v1, s[44:47], s80 offen sc1
v_mfma_f32_16x16x32_bf16 a[188:191], v[220:223], v[244:247], a[188:191]
s_add_u32 m0, s63, 102400
v_mfma_f32_16x16x32_bf16 a[184:187], v[216:219], v[244:247], a[184:187]
s_add_u32 s72, s70, 0
buffer_load_dwordx4 v4, s[4:7], s72 offen lds
v_mfma_f32_16x16x32_bf16 a[180:183], v[212:215], v[244:247], a[180:183]
v_mfma_f32_16x16x32_bf16 a[176:179], v[208:211], v[244:247], a[176:179]
v_mfma_f32_16x16x32_bf16 a[172:175], v[204:207], v[244:247], a[172:175]
v_mfma_f32_16x16x32_bf16 a[168:171], v[200:203], v[244:247], a[168:171]
s_add_u32 s72, s70, 15360
buffer_load_dwordx4 v5, s[4:7], s72 offen offset:1024 lds
v_mfma_f32_16x16x32_bf16 a[164:167], v[196:199], v[244:247], a[164:167]
v_accvgpr_read_b32 v24, a4
v_accvgpr_read_b32 v28, a5
v_mfma_f32_16x16x32_bf16 a[160:163], v[192:195], v[244:247], a[160:163]
v_accvgpr_read_b32 v25, a6
v_accvgpr_read_b32 v29, a7
v_mfma_f32_16x16x32_bf16 a[192:195], v[192:195], v[248:251], a[192:195]
v_accvgpr_read_b32 v26, a36
v_accvgpr_read_b32 v30, a37
v_mfma_f32_16x16x32_bf16 a[196:199], v[196:199], v[248:251], a[196:199]
v_accvgpr_read_b32 v27, a38
v_accvgpr_read_b32 v31, a39
v_mfma_f32_16x16x32_bf16 a[200:203], v[200:203], v[248:251], a[200:203]
s_add_u32 s72, s70, 129024
buffer_load_dwordx4 v4, s[4:7], s72 offen offset:2048 lds
v_mfma_f32_16x16x32_bf16 a[204:207], v[204:207], v[248:251], a[204:207]
v_mul_f32 v24, s79, v24
v_mul_f32 v28, s79, v28
v_mfma_f32_16x16x32_bf16 a[208:211], v[208:211], v[248:251], a[208:211]
v_mul_f32 v25, s79, v25
v_mul_f32 v29, s79, v29
v_mfma_f32_16x16x32_bf16 a[212:215], v[212:215], v[248:251], a[212:215]
v_mul_f32 v26, s79, v26
v_mul_f32 v30, s79, v30
v_mfma_f32_16x16x32_bf16 a[216:219], v[216:219], v[248:251], a[216:219]
v_mul_f32 v27, s79, v27
v_mul_f32 v31, s79, v31
v_mfma_f32_16x16x32_bf16 a[220:223], v[220:223], v[248:251], a[220:223]
s_add_u32 s72, s70, 144384
buffer_load_dwordx4 v5, s[4:7], s72 offen offset:3072 lds
v_mfma_f32_16x16x32_bf16 a[252:255], v[220:223], v[252:255], a[252:255]
v_cvt_pk_bf16_f32 v24, v24, v28
v_cvt_pk_bf16_f32 v25, v25, v29
v_mfma_f32_16x16x32_bf16 a[248:251], v[216:219], v[252:255], a[248:251]
v_cvt_pk_bf16_f32 v26, v26, v30
v_cvt_pk_bf16_f32 v27, v27, v31
v_mfma_f32_16x16x32_bf16 a[244:247], v[212:215], v[252:255], a[244:247]
s_add_u32 s80, s77, 4096
buffer_store_dwordx4 v[24:27], v1, s[44:47], s80 offen sc1
v_mfma_f32_16x16x32_bf16 a[240:243], v[208:211], v[252:255], a[240:243]
v_mfma_f32_16x16x32_bf16 a[236:239], v[204:207], v[252:255], a[236:239]
v_mfma_f32_16x16x32_bf16 a[232:235], v[200:203], v[252:255], a[232:235]
v_mfma_f32_16x16x32_bf16 a[228:231], v[196:199], v[252:255], a[228:231]
v_mfma_f32_16x16x32_bf16 a[224:227], v[192:195], v[252:255], a[224:227]
s_waitcnt lgkmcnt(0)
v_mfma_f32_16x16x32_bf16 v[128:131], v[32:35], v[64:67], 0
ds_read_b64_tr_b16 v[80:81], v8 offset:8192
ds_read_b64_tr_b16 v[82:83], v8 offset:9216
v_mfma_f32_16x16x32_bf16 v[132:135], v[32:35], v[68:71], 0
ds_read_b128 v[112:115], v17 offset:0
ds_read_b128 v[116:119], v17 offset:2048
v_mfma_f32_16x16x32_bf16 v[136:139], v[32:35], v[72:75], 0
ds_read_b128 v[120:123], v17 offset:4096
ds_read_b128 v[124:127], v17 offset:6144
v_mfma_f32_16x16x32_bf16 v[140:143], v[32:35], v[76:79], 0
ds_read_b64_tr_b16 v[84:85], v9 offset:8192
ds_read_b64_tr_b16 v[86:87], v9 offset:9216
v_mfma_f32_16x16x32_bf16 v[156:159], v[36:39], v[76:79], 0
ds_read_b64_tr_b16 v[88:89], v10 offset:8192
v_accvgpr_read_b32 v20, a8
v_mfma_f32_16x16x32_bf16 v[152:155], v[36:39], v[72:75], 0
ds_read_b64_tr_b16 v[90:91], v10 offset:9216
v_accvgpr_read_b32 v28, a9
v_mfma_f32_16x16x32_bf16 v[148:151], v[36:39], v[68:71], 0
ds_read_b64_tr_b16 v[92:93], v11 offset:8192
v_accvgpr_read_b32 v21, a10
v_mfma_f32_16x16x32_bf16 v[144:147], v[36:39], v[64:67], 0
ds_read_b64_tr_b16 v[94:95], v11 offset:9216
v_accvgpr_read_b32 v29, a11
v_mfma_f32_16x16x32_bf16 v[160:163], v[40:43], v[64:67], 0
ds_read_b64_tr_b16 v[96:97], v12 offset:8192
v_accvgpr_read_b32 v22, a40
v_mfma_f32_16x16x32_bf16 v[164:167], v[40:43], v[68:71], 0
ds_read_b64_tr_b16 v[98:99], v12 offset:9216
v_accvgpr_read_b32 v30, a41
v_mfma_f32_16x16x32_bf16 v[168:171], v[40:43], v[72:75], 0
ds_read_b64_tr_b16 v[100:101], v13 offset:8192
v_accvgpr_read_b32 v23, a42
v_mfma_f32_16x16x32_bf16 v[172:175], v[40:43], v[76:79], 0
ds_read_b64_tr_b16 v[102:103], v13 offset:9216
v_accvgpr_read_b32 v31, a43
v_mfma_f32_16x16x32_bf16 v[188:191], v[44:47], v[76:79], 0
ds_read_b64_tr_b16 v[104:105], v14 offset:8192
v_mul_f32 v20, s79, v20
v_mfma_f32_16x16x32_bf16 v[184:187], v[44:47], v[72:75], 0
ds_read_b64_tr_b16 v[106:107], v14 offset:9216
v_mul_f32 v28, s79, v28
v_mfma_f32_16x16x32_bf16 v[180:183], v[44:47], v[68:71], 0
ds_read_b64_tr_b16 v[108:109], v15 offset:8192
v_mul_f32 v21, s79, v21
v_mfma_f32_16x16x32_bf16 v[176:179], v[44:47], v[64:67], 0
ds_read_b64_tr_b16 v[110:111], v15 offset:9216
v_mul_f32 v29, s79, v29
v_mfma_f32_16x16x32_bf16 v[192:195], v[48:51], v[64:67], 0
v_mul_f32 v22, s79, v22
v_mul_f32 v30, s79, v30
v_mfma_f32_16x16x32_bf16 v[196:199], v[48:51], v[68:71], 0
v_mul_f32 v23, s79, v23
v_mul_f32 v31, s79, v31
v_mfma_f32_16x16x32_bf16 v[200:203], v[48:51], v[72:75], 0
v_cvt_pk_bf16_f32 v20, v20, v28
v_cvt_pk_bf16_f32 v21, v21, v29
v_mfma_f32_16x16x32_bf16 v[204:207], v[48:51], v[76:79], 0
v_cvt_pk_bf16_f32 v22, v22, v30
v_cvt_pk_bf16_f32 v23, v23, v31
v_mfma_f32_16x16x32_bf16 v[220:223], v[52:55], v[76:79], 0
s_add_u32 s80, s77, 8192
buffer_store_dwordx4 v[20:23], v1, s[44:47], s80 offen sc1
v_mfma_f32_16x16x32_bf16 v[216:219], v[52:55], v[72:75], 0
v_mfma_f32_16x16x32_bf16 v[212:215], v[52:55], v[68:71], 0
v_accvgpr_read_b32 v24, a128
v_accvgpr_read_b32 v28, a129
v_mfma_f32_16x16x32_bf16 v[208:211], v[52:55], v[64:67], 0
v_accvgpr_read_b32 v25, a130
v_accvgpr_read_b32 v29, a131
v_mfma_f32_16x16x32_bf16 v[224:227], v[56:59], v[64:67], 0
v_accvgpr_read_b32 v26, a132
v_accvgpr_read_b32 v30, a133
v_mfma_f32_16x16x32_bf16 v[228:231], v[56:59], v[68:71], 0
v_accvgpr_read_b32 v27, a134
v_accvgpr_read_b32 v31, a135
v_mfma_f32_16x16x32_bf16 v[232:235], v[56:59], v[72:75], 0
v_cvt_pk_bf16_f32 v24, v24, v28
v_cvt_pk_bf16_f32 v25, v25, v29
v_mfma_f32_16x16x32_bf16 v[236:239], v[56:59], v[76:79], 0
v_cvt_pk_bf16_f32 v26, v26, v30
v_cvt_pk_bf16_f32 v27, v27, v31
v_mfma_f32_16x16x32_bf16 v[252:255], v[60:63], v[76:79], 0
s_add_u32 s80, s78, 0
buffer_store_dwordx4 v[24:27], v1, s[44:47], s80 offen sc1
v_mfma_f32_16x16x32_bf16 v[248:251], v[60:63], v[72:75], 0
v_mfma_f32_16x16x32_bf16 v[244:247], v[60:63], v[68:71], 0
s_waitcnt vmcnt(17) lgkmcnt(0)
v_mfma_f32_16x16x32_bf16 v[240:243], v[60:63], v[64:67], 0
s_barrier
v_mfma_f32_16x16x32_bf16 v[128:131], v[80:83], v[112:115], v[128:131]
s_add_u32 s73, s62, 3
ds_read_b64_tr_b16 v[32:33], v8 offset:16384
ds_read_b64_tr_b16 v[34:35], v8 offset:17408
v_mfma_f32_16x16x32_bf16 v[132:135], v[80:83], v[116:119], v[132:135]
s_add_u32 s70, s73, s65
ds_read_b128 v[64:67], v18 offset:0
ds_read_b128 v[68:71], v18 offset:2048
v_mfma_f32_16x16x32_bf16 v[136:139], v[80:83], v[120:123], v[136:139]
s_and_b32 s70, s70, 3
ds_read_b128 v[72:75], v18 offset:4096
ds_read_b128 v[76:79], v18 offset:6144
v_mfma_f32_16x16x32_bf16 v[140:143], v[80:83], v[124:127], v[140:143]
s_and_b32 s73, s73, 12
ds_read_b64_tr_b16 v[36:37], v9 offset:16384
ds_read_b64_tr_b16 v[38:39], v9 offset:17408
v_mfma_f32_16x16x32_bf16 v[156:159], v[84:87], v[124:127], v[156:159]
s_or_b32 s73, s73, s70
ds_read_b64_tr_b16 v[40:41], v10 offset:16384
v_mfma_f32_16x16x32_bf16 v[152:155], v[84:87], v[120:123], v[152:155]
s_lshl_b32 s71, s73, 19
ds_read_b64_tr_b16 v[42:43], v10 offset:17408
v_mfma_f32_16x16x32_bf16 v[148:151], v[84:87], v[116:119], v[148:151]
s_add_u32 s71, s71, s66
ds_read_b64_tr_b16 v[44:45], v11 offset:16384
v_mfma_f32_16x16x32_bf16 v[144:147], v[84:87], v[112:115], v[144:147]
s_lshl_b32 s73, s73, 7
ds_read_b64_tr_b16 v[46:47], v11 offset:17408
v_mfma_f32_16x16x32_bf16 v[160:163], v[88:91], v[112:115], v[160:163]
s_add_u32 s69, s73, s67
ds_read_b64_tr_b16 v[48:49], v12 offset:16384
v_mfma_f32_16x16x32_bf16 v[164:167], v[88:91], v[116:119], v[164:167]
s_add_u32 s70, s73, s68
ds_read_b64_tr_b16 v[50:51], v12 offset:17408
v_mfma_f32_16x16x32_bf16 v[168:171], v[88:91], v[120:123], v[168:171]
s_add_u32 m0, s64, 0
ds_read_b64_tr_b16 v[52:53], v13 offset:16384
v_mfma_f32_16x16x32_bf16 v[172:175], v[88:91], v[124:127], v[172:175]
s_add_u32 s72, s71, 0
buffer_load_dwordx4 v6, s[12:15], s72 offen lds
v_mfma_f32_16x16x32_bf16 v[188:191], v[92:95], v[124:127], v[188:191]
s_add_u32 s72, s71, 31744
buffer_load_dwordx4 v6, s[12:15], s72 offen offset:1024 lds
v_mfma_f32_16x16x32_bf16 v[184:187], v[92:95], v[120:123], v[184:187]
s_add_u32 s72, s71, 63488
buffer_load_dwordx4 v7, s[12:15], s72 offen offset:2048 lds
v_mfma_f32_16x16x32_bf16 v[180:183], v[92:95], v[116:119], v[180:183]
s_add_u32 s72, s71, 95232
buffer_load_dwordx4 v7, s[12:15], s72 offen offset:3072 lds
v_mfma_f32_16x16x32_bf16 v[176:179], v[92:95], v[112:115], v[176:179]
ds_read_b64_tr_b16 v[54:55], v13 offset:17408
v_accvgpr_read_b32 v20, a12
v_mfma_f32_16x16x32_bf16 v[192:195], v[96:99], v[112:115], v[192:195]
ds_read_b64_tr_b16 v[56:57], v14 offset:16384
v_accvgpr_read_b32 v28, a13
v_mfma_f32_16x16x32_bf16 v[196:199], v[96:99], v[116:119], v[196:199]
ds_read_b64_tr_b16 v[58:59], v14 offset:17408
v_accvgpr_read_b32 v21, a14
v_mfma_f32_16x16x32_bf16 v[200:203], v[96:99], v[120:123], v[200:203]
ds_read_b64_tr_b16 v[60:61], v15 offset:16384
v_accvgpr_read_b32 v29, a15
v_mfma_f32_16x16x32_bf16 v[204:207], v[96:99], v[124:127], v[204:207]
s_add_u32 m0, s63, 131072
ds_read_b64_tr_b16 v[62:63], v15 offset:17408
v_accvgpr_read_b32 v22, a44
v_mfma_f32_16x16x32_bf16 v[220:223], v[100:103], v[124:127], v[220:223]
s_add_u32 s72, s69, 0
buffer_load_dwordx4 v4, s[4:7], s72 offen lds
v_mfma_f32_16x16x32_bf16 v[216:219], v[100:103], v[120:123], v[216:219]
v_accvgpr_read_b32 v30, a45
v_accvgpr_read_b32 v23, a46
v_mfma_f32_16x16x32_bf16 v[212:215], v[100:103], v[116:119], v[212:215]
v_accvgpr_read_b32 v31, a47
v_mul_f32 v20, s79, v20
v_mfma_f32_16x16x32_bf16 v[208:211], v[100:103], v[112:115], v[208:211]
v_mul_f32 v28, s79, v28
v_mul_f32 v21, s79, v21
v_mfma_f32_16x16x32_bf16 v[224:227], v[104:107], v[112:115], v[224:227]
s_add_u32 s72, s69, 15360
buffer_load_dwordx4 v5, s[4:7], s72 offen offset:1024 lds
v_mfma_f32_16x16x32_bf16 v[228:231], v[104:107], v[116:119], v[228:231]
v_mul_f32 v29, s79, v29
v_mul_f32 v22, s79, v22
v_mfma_f32_16x16x32_bf16 v[232:235], v[104:107], v[120:123], v[232:235]
v_mul_f32 v30, s79, v30
v_mul_f32 v23, s79, v23
v_mfma_f32_16x16x32_bf16 v[236:239], v[104:107], v[124:127], v[236:239]
v_mul_f32 v31, s79, v31
v_cvt_pk_bf16_f32 v20, v20, v28
v_mfma_f32_16x16x32_bf16 v[252:255], v[108:111], v[124:127], v[252:255]
v_cvt_pk_bf16_f32 v21, v21, v29
v_cvt_pk_bf16_f32 v22, v22, v30
v_mfma_f32_16x16x32_bf16 v[248:251], v[108:111], v[120:123], v[248:251]
s_add_u32 s72, s69, 129024
buffer_load_dwordx4 v4, s[4:7], s72 offen offset:2048 lds
v_mfma_f32_16x16x32_bf16 v[244:247], v[108:111], v[116:119], v[244:247]
v_cvt_pk_bf16_f32 v23, v23, v31
v_mfma_f32_16x16x32_bf16 v[240:243], v[108:111], v[112:115], v[240:243]
s_waitcnt lgkmcnt(0)
v_accvgpr_read_b32 v24, a136
v_accvgpr_read_b32 v28, a137
v_mfma_f32_16x16x32_bf16 v[128:131], v[32:35], v[64:67], v[128:131]
s_add_u32 s80, s77, 12288
ds_read_b64_tr_b16 v[80:81], v8 offset:24576
ds_read_b64_tr_b16 v[82:83], v8 offset:25600
v_mfma_f32_16x16x32_bf16 v[132:135], v[32:35], v[68:71], v[132:135]
ds_read_b128 v[112:115], v19 offset:0
ds_read_b128 v[116:119], v19 offset:2048
v_mfma_f32_16x16x32_bf16 v[136:139], v[32:35], v[72:75], v[136:139]
s_add_u32 s72, s69, 144384
buffer_load_dwordx4 v5, s[4:7], s72 offen offset:3072 lds
v_mfma_f32_16x16x32_bf16 v[140:143], v[32:35], v[76:79], v[140:143]
ds_read_b128 v[120:123], v19 offset:4096
ds_read_b128 v[124:127], v19 offset:6144
v_mfma_f32_16x16x32_bf16 v[156:159], v[36:39], v[76:79], v[156:159]
ds_read_b64_tr_b16 v[84:85], v9 offset:24576
ds_read_b64_tr_b16 v[86:87], v9 offset:25600
v_mfma_f32_16x16x32_bf16 v[152:155], v[36:39], v[72:75], v[152:155]
ds_read_b64_tr_b16 v[88:89], v10 offset:24576
v_accvgpr_read_b32 v25, a138
v_mfma_f32_16x16x32_bf16 v[148:151], v[36:39], v[68:71], v[148:151]
ds_read_b64_tr_b16 v[90:91], v10 offset:25600
v_accvgpr_read_b32 v29, a139
v_mfma_f32_16x16x32_bf16 v[144:147], v[36:39], v[64:67], v[144:147]
s_add_u32 m0, s63, 135168
ds_read_b64_tr_b16 v[92:93], v11 offset:24576
v_accvgpr_read_b32 v26, a140
v_mfma_f32_16x16x32_bf16 v[160:163], v[40:43], v[64:67], v[160:163]
s_add_u32 s72, s70, 0
buffer_load_dwordx4 v4, s[4:7], s72 offen lds
v_mfma_f32_16x16x32_bf16 v[164:167], v[40:43], v[68:71], v[164:167]
ds_read_b64_tr_b16 v[94:95], v11 offset:25600
v_accvgpr_read_b32 v30, a141
v_mfma_f32_16x16x32_bf16 v[168:171], v[40:43], v[72:75], v[168:171]
ds_read_b64_tr_b16 v[96:97], v12 offset:24576
v_accvgpr_read_b32 v27, a142
v_mfma_f32_16x16x32_bf16 v[172:175], v[40:43], v[76:79], v[172:175]
ds_read_b64_tr_b16 v[98:99], v12 offset:25600
v_accvgpr_read_b32 v31, a143
v_mfma_f32_16x16x32_bf16 v[188:191], v[44:47], v[76:79], v[188:191]
s_add_u32 s72, s70, 15360
buffer_load_dwordx4 v5, s[4:7], s72 offen offset:1024 lds
v_mfma_f32_16x16x32_bf16 v[184:187], v[44:47], v[72:75], v[184:187]
ds_read_b64_tr_b16 v[100:101], v13 offset:24576
v_cvt_pk_bf16_f32 v24, v24, v28
v_mfma_f32_16x16x32_bf16 v[180:183], v[44:47], v[68:71], v[180:183]
ds_read_b64_tr_b16 v[102:103], v13 offset:25600
v_cvt_pk_bf16_f32 v25, v25, v29
v_mfma_f32_16x16x32_bf16 v[176:179], v[44:47], v[64:67], v[176:179]
ds_read_b64_tr_b16 v[104:105], v14 offset:24576
v_cvt_pk_bf16_f32 v26, v26, v30
v_mfma_f32_16x16x32_bf16 v[192:195], v[48:51], v[64:67], v[192:195]
ds_read_b64_tr_b16 v[106:107], v14 offset:25600
v_cvt_pk_bf16_f32 v27, v27, v31
v_mfma_f32_16x16x32_bf16 v[196:199], v[48:51], v[68:71], v[196:199]
s_add_u32 s72, s70, 129024
buffer_load_dwordx4 v4, s[4:7], s72 offen offset:2048 lds
v_mfma_f32_16x16x32_bf16 v[200:203], v[48:51], v[72:75], v[200:203]
ds_read_b64_tr_b16 v[108:109], v15 offset:24576
v_mfma_f32_16x16x32_bf16 v[204:207], v[48:51], v[76:79], v[204:207]
ds_read_b64_tr_b16 v[110:111], v15 offset:25600
v_mfma_f32_16x16x32_bf16 v[220:223], v[52:55], v[76:79], v[220:223]
buffer_store_dwordx4 v[20:23], v1, s[44:47], s80 offen sc1
v_mfma_f32_16x16x32_bf16 v[216:219], v[52:55], v[72:75], v[216:219]
s_add_u32 s80, s78, 8192
buffer_store_dwordx4 v[24:27], v1, s[44:47], s80 offen sc1
v_mfma_f32_16x16x32_bf16 v[212:215], v[52:55], v[68:71], v[212:215]
s_add_u32 s72, s70, 144384
buffer_load_dwordx4 v5, s[4:7], s72 offen offset:3072 lds
v_mfma_f32_16x16x32_bf16 v[208:211], v[52:55], v[64:67], v[208:211]
v_accvgpr_read_b32 v20, a16
v_accvgpr_read_b32 v28, a17
v_mfma_f32_16x16x32_bf16 v[224:227], v[56:59], v[64:67], v[224:227]
v_accvgpr_read_b32 v21, a18
v_accvgpr_read_b32 v29, a19
v_mfma_f32_16x16x32_bf16 v[228:231], v[56:59], v[68:71], v[228:231]
v_accvgpr_read_b32 v22, a48
v_accvgpr_read_b32 v30, a49
v_mfma_f32_16x16x32_bf16 v[232:235], v[56:59], v[72:75], v[232:235]
v_accvgpr_read_b32 v23, a50
v_accvgpr_read_b32 v31, a51
v_mfma_f32_16x16x32_bf16 v[236:239], v[56:59], v[76:79], v[236:239]
v_mul_f32 v20, s79, v20
v_mul_f32 v28, s79, v28
v_mfma_f32_16x16x32_bf16 v[252:255], v[60:63], v[76:79], v[252:255]
v_mul_f32 v21, s79, v21
v_mul_f32 v29, s79, v29
v_mfma_f32_16x16x32_bf16 v[248:251], v[60:63], v[72:75], v[248:251]
v_mul_f32 v22, s79, v22
v_mul_f32 v30, s79, v30
v_mfma_f32_16x16x32_bf16 v[244:247], v[60:63], v[68:71], v[244:247]
s_waitcnt vmcnt(17) lgkmcnt(0)
v_mul_f32 v23, s79, v23
v_mul_f32 v31, s79, v31
v_mfma_f32_16x16x32_bf16 v[240:243], v[60:63], v[64:67], v[240:243]
s_barrier
v_cvt_pk_bf16_f32 v20, v20, v28
v_cvt_pk_bf16_f32 v21, v21, v29
v_mfma_f32_16x16x32_bf16 v[128:131], v[80:83], v[112:115], v[128:131]
s_add_u32 s73, s62, 4
ds_read_b64_tr_b16 v[32:33], v8 offset:32768
ds_read_b64_tr_b16 v[34:35], v8 offset:33792
v_mfma_f32_16x16x32_bf16 v[132:135], v[80:83], v[116:119], v[132:135]
s_add_u32 s70, s73, s65
ds_read_b128 v[64:67], v18 offset:32768
ds_read_b128 v[68:71], v18 offset:34816
v_mfma_f32_16x16x32_bf16 v[136:139], v[80:83], v[120:123], v[136:139]
s_and_b32 s70, s70, 3
ds_read_b128 v[72:75], v18 offset:36864
ds_read_b128 v[76:79], v18 offset:38912
v_mfma_f32_16x16x32_bf16 v[140:143], v[80:83], v[124:127], v[140:143]
s_and_b32 s73, s73, 12
ds_read_b64_tr_b16 v[36:37], v9 offset:32768
ds_read_b64_tr_b16 v[38:39], v9 offset:33792
v_mfma_f32_16x16x32_bf16 v[156:159], v[84:87], v[124:127], v[156:159]
s_or_b32 s73, s73, s70
ds_read_b64_tr_b16 v[40:41], v10 offset:32768
v_cvt_pk_bf16_f32 v22, v22, v30
v_mfma_f32_16x16x32_bf16 v[152:155], v[84:87], v[120:123], v[152:155]
s_lshl_b32 s71, s73, 19
ds_read_b64_tr_b16 v[42:43], v10 offset:33792
v_cvt_pk_bf16_f32 v23, v23, v31
v_mfma_f32_16x16x32_bf16 v[148:151], v[84:87], v[116:119], v[148:151]
s_add_u32 s71, s71, s66
ds_read_b64_tr_b16 v[44:45], v11 offset:32768
v_mfma_f32_16x16x32_bf16 v[144:147], v[84:87], v[112:115], v[144:147]
s_lshl_b32 s73, s73, 7
ds_read_b64_tr_b16 v[46:47], v11 offset:33792
v_accvgpr_read_b32 v24, a144
v_mfma_f32_16x16x32_bf16 v[160:163], v[88:91], v[112:115], v[160:163]
s_add_u32 s69, s73, s67
ds_read_b64_tr_b16 v[48:49], v12 offset:32768
v_accvgpr_read_b32 v28, a145
v_mfma_f32_16x16x32_bf16 v[164:167], v[88:91], v[116:119], v[164:167]
s_add_u32 s70, s73, s68
ds_read_b64_tr_b16 v[50:51], v12 offset:33792
v_accvgpr_read_b32 v25, a146
v_mfma_f32_16x16x32_bf16 v[168:171], v[88:91], v[120:123], v[168:171]
s_add_u32 m0, s64, 16384
ds_read_b64_tr_b16 v[52:53], v13 offset:32768
v_accvgpr_read_b32 v29, a147
v_mfma_f32_16x16x32_bf16 v[172:175], v[88:91], v[124:127], v[172:175]
s_add_u32 s72, s71, 0
buffer_load_dwordx4 v6, s[12:15], s72 offen lds
v_mfma_f32_16x16x32_bf16 v[188:191], v[92:95], v[124:127], v[188:191]
s_add_u32 s72, s71, 31744
buffer_load_dwordx4 v6, s[12:15], s72 offen offset:1024 lds
v_mfma_f32_16x16x32_bf16 v[184:187], v[92:95], v[120:123], v[184:187]
s_add_u32 s72, s71, 63488
buffer_load_dwordx4 v7, s[12:15], s72 offen offset:2048 lds
v_mfma_f32_16x16x32_bf16 v[180:183], v[92:95], v[116:119], v[180:183]
s_add_u32 s72, s71, 95232
buffer_load_dwordx4 v7, s[12:15], s72 offen offset:3072 lds
v_mfma_f32_16x16x32_bf16 v[176:179], v[92:95], v[112:115], v[176:179]
s_add_u32 s80, s77, 32768
ds_read_b64_tr_b16 v[54:55], v13 offset:33792
v_accvgpr_read_b32 v26, a148
v_mfma_f32_16x16x32_bf16 v[192:195], v[96:99], v[112:115], v[192:195]
ds_read_b64_tr_b16 v[56:57], v14 offset:32768
v_accvgpr_read_b32 v30, a149
v_mfma_f32_16x16x32_bf16 v[196:199], v[96:99], v[116:119], v[196:199]
ds_read_b64_tr_b16 v[58:59], v14 offset:33792
v_accvgpr_read_b32 v27, a150
v_mfma_f32_16x16x32_bf16 v[200:203], v[96:99], v[120:123], v[200:203]
ds_read_b64_tr_b16 v[60:61], v15 offset:32768
v_accvgpr_read_b32 v31, a151
v_mfma_f32_16x16x32_bf16 v[204:207], v[96:99], v[124:127], v[204:207]
s_add_u32 m0, s63, 65536
ds_read_b64_tr_b16 v[62:63], v15 offset:33792
v_cvt_pk_bf16_f32 v24, v24, v28
v_mfma_f32_16x16x32_bf16 v[220:223], v[100:103], v[124:127], v[220:223]
s_add_u32 s72, s69, 0
buffer_load_dwordx4 v4, s[4:7], s72 offen lds
v_mfma_f32_16x16x32_bf16 v[216:219], v[100:103], v[120:123], v[216:219]
buffer_store_dwordx4 v[20:23], v1, s[44:47], s80 offen sc1
v_mfma_f32_16x16x32_bf16 v[212:215], v[100:103], v[116:119], v[212:215]
v_cvt_pk_bf16_f32 v25, v25, v29
v_cvt_pk_bf16_f32 v26, v26, v30
v_mfma_f32_16x16x32_bf16 v[208:211], v[100:103], v[112:115], v[208:211]
v_cvt_pk_bf16_f32 v27, v27, v31
v_mfma_f32_16x16x32_bf16 v[224:227], v[104:107], v[112:115], v[224:227]
s_add_u32 s72, s69, 15360
buffer_load_dwordx4 v5, s[4:7], s72 offen offset:1024 lds
v_mfma_f32_16x16x32_bf16 v[228:231], v[104:107], v[116:119], v[228:231]
s_add_u32 s80, s78, 32768
buffer_store_dwordx4 v[24:27], v1, s[44:47], s80 offen sc1
v_mfma_f32_16x16x32_bf16 v[232:235], v[104:107], v[120:123], v[232:235]
v_mfma_f32_16x16x32_bf16 v[236:239], v[104:107], v[124:127], v[236:239]
v_mfma_f32_16x16x32_bf16 v[252:255], v[108:111], v[124:127], v[252:255]
v_accvgpr_read_b32 v20, a20
v_accvgpr_read_b32 v28, a21
v_mfma_f32_16x16x32_bf16 v[248:251], v[108:111], v[120:123], v[248:251]
s_add_u32 s72, s69, 129024
buffer_load_dwordx4 v4, s[4:7], s72 offen offset:2048 lds
v_mfma_f32_16x16x32_bf16 v[244:247], v[108:111], v[116:119], v[244:247]
v_accvgpr_read_b32 v21, a22
v_accvgpr_read_b32 v29, a23
v_mfma_f32_16x16x32_bf16 v[240:243], v[108:111], v[112:115], v[240:243]
s_waitcnt lgkmcnt(0)
v_accvgpr_read_b32 v22, a52
v_accvgpr_read_b32 v30, a53
v_mfma_f32_16x16x32_bf16 v[128:131], v[32:35], v[64:67], v[128:131]
ds_read_b64_tr_b16 v[80:81], v8 offset:40960
ds_read_b64_tr_b16 v[82:83], v8 offset:41984
v_mfma_f32_16x16x32_bf16 v[132:135], v[32:35], v[68:71], v[132:135]
ds_read_b128 v[112:115], v19 offset:32768
ds_read_b128 v[116:119], v19 offset:34816
v_mfma_f32_16x16x32_bf16 v[136:139], v[32:35], v[72:75], v[136:139]
s_add_u32 s72, s69, 144384
buffer_load_dwordx4 v5, s[4:7], s72 offen offset:3072 lds
v_mfma_f32_16x16x32_bf16 v[140:143], v[32:35], v[76:79], v[140:143]
ds_read_b128 v[120:123], v19 offset:36864
ds_read_b128 v[124:127], v19 offset:38912
v_mfma_f32_16x16x32_bf16 v[156:159], v[36:39], v[76:79], v[156:159]
ds_read_b64_tr_b16 v[84:85], v9 offset:40960
ds_read_b64_tr_b16 v[86:87], v9 offset:41984
v_mfma_f32_16x16x32_bf16 v[152:155], v[36:39], v[72:75], v[152:155]
ds_read_b64_tr_b16 v[88:89], v10 offset:40960
v_accvgpr_read_b32 v23, a54
v_mfma_f32_16x16x32_bf16 v[148:151], v[36:39], v[68:71], v[148:151]
ds_read_b64_tr_b16 v[90:91], v10 offset:41984
v_accvgpr_read_b32 v31, a55
v_mfma_f32_16x16x32_bf16 v[144:147], v[36:39], v[64:67], v[144:147]
s_add_u32 m0, s63, 69632
ds_read_b64_tr_b16 v[92:93], v11 offset:40960
v_mul_f32 v20, s79, v20
v_mfma_f32_16x16x32_bf16 v[160:163], v[40:43], v[64:67], v[160:163]
s_add_u32 s72, s70, 0
buffer_load_dwordx4 v4, s[4:7], s72 offen lds
v_mfma_f32_16x16x32_bf16 v[164:167], v[40:43], v[68:71], v[164:167]
ds_read_b64_tr_b16 v[94:95], v11 offset:41984
v_mul_f32 v28, s79, v28
v_mfma_f32_16x16x32_bf16 v[168:171], v[40:43], v[72:75], v[168:171]
ds_read_b64_tr_b16 v[96:97], v12 offset:40960
v_mul_f32 v21, s79, v21
v_mfma_f32_16x16x32_bf16 v[172:175], v[40:43], v[76:79], v[172:175]
ds_read_b64_tr_b16 v[98:99], v12 offset:41984
v_mul_f32 v29, s79, v29
v_mfma_f32_16x16x32_bf16 v[188:191], v[44:47], v[76:79], v[188:191]
s_add_u32 s72, s70, 15360
buffer_load_dwordx4 v5, s[4:7], s72 offen offset:1024 lds
v_mfma_f32_16x16x32_bf16 v[184:187], v[44:47], v[72:75], v[184:187]
ds_read_b64_tr_b16 v[100:101], v13 offset:40960
v_mul_f32 v22, s79, v22
v_mfma_f32_16x16x32_bf16 v[180:183], v[44:47], v[68:71], v[180:183]
ds_read_b64_tr_b16 v[102:103], v13 offset:41984
v_mul_f32 v30, s79, v30
v_mfma_f32_16x16x32_bf16 v[176:179], v[44:47], v[64:67], v[176:179]
ds_read_b64_tr_b16 v[104:105], v14 offset:40960
v_mul_f32 v23, s79, v23
v_mfma_f32_16x16x32_bf16 v[192:195], v[48:51], v[64:67], v[192:195]
ds_read_b64_tr_b16 v[106:107], v14 offset:41984
v_mul_f32 v31, s79, v31
v_mfma_f32_16x16x32_bf16 v[196:199], v[48:51], v[68:71], v[196:199]
s_add_u32 s72, s70, 129024
buffer_load_dwordx4 v4, s[4:7], s72 offen offset:2048 lds
v_mfma_f32_16x16x32_bf16 v[200:203], v[48:51], v[72:75], v[200:203]
ds_read_b64_tr_b16 v[108:109], v15 offset:40960
v_cvt_pk_bf16_f32 v20, v20, v28
v_mfma_f32_16x16x32_bf16 v[204:207], v[48:51], v[76:79], v[204:207]
ds_read_b64_tr_b16 v[110:111], v15 offset:41984
v_cvt_pk_bf16_f32 v21, v21, v29
v_mfma_f32_16x16x32_bf16 v[220:223], v[52:55], v[76:79], v[220:223]
v_cvt_pk_bf16_f32 v22, v22, v30
v_cvt_pk_bf16_f32 v23, v23, v31
v_mfma_f32_16x16x32_bf16 v[216:219], v[52:55], v[72:75], v[216:219]
s_add_u32 s80, s77, 36864
buffer_store_dwordx4 v[20:23], v1, s[44:47], s80 offen sc1
v_mfma_f32_16x16x32_bf16 v[212:215], v[52:55], v[68:71], v[212:215]
s_add_u32 s72, s70, 144384
buffer_load_dwordx4 v5, s[4:7], s72 offen offset:3072 lds
v_mfma_f32_16x16x32_bf16 v[208:211], v[52:55], v[64:67], v[208:211]
v_accvgpr_read_b32 v24, a152
v_accvgpr_read_b32 v28, a153
v_mfma_f32_16x16x32_bf16 v[224:227], v[56:59], v[64:67], v[224:227]
v_accvgpr_read_b32 v25, a154
v_accvgpr_read_b32 v29, a155
v_mfma_f32_16x16x32_bf16 v[228:231], v[56:59], v[68:71], v[228:231]
v_accvgpr_read_b32 v26, a156
v_accvgpr_read_b32 v30, a157
v_mfma_f32_16x16x32_bf16 v[232:235], v[56:59], v[72:75], v[232:235]
v_accvgpr_read_b32 v27, a158
v_accvgpr_read_b32 v31, a159
v_mfma_f32_16x16x32_bf16 v[236:239], v[56:59], v[76:79], v[236:239]
v_cvt_pk_bf16_f32 v24, v24, v28
v_cvt_pk_bf16_f32 v25, v25, v29
v_mfma_f32_16x16x32_bf16 v[252:255], v[60:63], v[76:79], v[252:255]
v_cvt_pk_bf16_f32 v26, v26, v30
v_cvt_pk_bf16_f32 v27, v27, v31
v_mfma_f32_16x16x32_bf16 v[248:251], v[60:63], v[72:75], v[248:251]
s_add_u32 s80, s78, 40960
buffer_store_dwordx4 v[24:27], v1, s[44:47], s80 offen sc1
v_mfma_f32_16x16x32_bf16 v[244:247], v[60:63], v[68:71], v[244:247]
s_waitcnt vmcnt(16) lgkmcnt(0)
v_mfma_f32_16x16x32_bf16 v[240:243], v[60:63], v[64:67], v[240:243]
s_barrier
v_mfma_f32_16x16x32_bf16 v[128:131], v[80:83], v[112:115], v[128:131]
s_add_u32 s73, s62, 5
ds_read_b64_tr_b16 v[32:33], v8 offset:0
ds_read_b64_tr_b16 v[34:35], v8 offset:1024
v_mfma_f32_16x16x32_bf16 v[132:135], v[80:83], v[116:119], v[132:135]
s_add_u32 s70, s73, s65
ds_read_b128 v[64:67], v16 offset:0
ds_read_b128 v[68:71], v16 offset:2048
v_mfma_f32_16x16x32_bf16 v[136:139], v[80:83], v[120:123], v[136:139]
s_and_b32 s70, s70, 3
ds_read_b128 v[72:75], v16 offset:4096
ds_read_b128 v[76:79], v16 offset:6144
v_mfma_f32_16x16x32_bf16 v[140:143], v[80:83], v[124:127], v[140:143]
s_and_b32 s73, s73, 12
ds_read_b64_tr_b16 v[36:37], v9 offset:0
ds_read_b64_tr_b16 v[38:39], v9 offset:1024
v_mfma_f32_16x16x32_bf16 v[156:159], v[84:87], v[124:127], v[156:159]
s_or_b32 s73, s73, s70
ds_read_b64_tr_b16 v[40:41], v10 offset:0
v_accvgpr_read_b32 v20, a24
v_mfma_f32_16x16x32_bf16 v[152:155], v[84:87], v[120:123], v[152:155]
s_lshl_b32 s71, s73, 19
ds_read_b64_tr_b16 v[42:43], v10 offset:1024
v_accvgpr_read_b32 v28, a25
v_mfma_f32_16x16x32_bf16 v[148:151], v[84:87], v[116:119], v[148:151]
s_add_u32 s71, s71, s66
ds_read_b64_tr_b16 v[44:45], v11 offset:0
v_accvgpr_read_b32 v21, a26
v_mfma_f32_16x16x32_bf16 v[144:147], v[84:87], v[112:115], v[144:147]
s_lshl_b32 s73, s73, 7
ds_read_b64_tr_b16 v[46:47], v11 offset:1024
v_accvgpr_read_b32 v29, a27
v_mfma_f32_16x16x32_bf16 v[160:163], v[88:91], v[112:115], v[160:163]
s_add_u32 s69, s73, s67
ds_read_b64_tr_b16 v[48:49], v12 offset:0
v_accvgpr_read_b32 v22, a56
v_mfma_f32_16x16x32_bf16 v[164:167], v[88:91], v[116:119], v[164:167]
s_add_u32 s70, s73, s68
ds_read_b64_tr_b16 v[50:51], v12 offset:1024
v_accvgpr_read_b32 v30, a57
v_mfma_f32_16x16x32_bf16 v[168:171], v[88:91], v[120:123], v[168:171]
s_add_u32 m0, s64, 32768
ds_read_b64_tr_b16 v[52:53], v13 offset:0
v_accvgpr_read_b32 v23, a58
v_mfma_f32_16x16x32_bf16 v[172:175], v[88:91], v[124:127], v[172:175]
s_add_u32 s72, s71, 0
buffer_load_dwordx4 v6, s[12:15], s72 offen lds
v_mfma_f32_16x16x32_bf16 v[188:191], v[92:95], v[124:127], v[188:191]
s_add_u32 s72, s71, 31744
buffer_load_dwordx4 v6, s[12:15], s72 offen offset:1024 lds
v_mfma_f32_16x16x32_bf16 v[184:187], v[92:95], v[120:123], v[184:187]
s_add_u32 s72, s71, 63488
buffer_load_dwordx4 v7, s[12:15], s72 offen offset:2048 lds
v_mfma_f32_16x16x32_bf16 v[180:183], v[92:95], v[116:119], v[180:183]
s_add_u32 s72, s71, 95232
buffer_load_dwordx4 v7, s[12:15], s72 offen offset:3072 lds
v_mfma_f32_16x16x32_bf16 v[176:179], v[92:95], v[112:115], v[176:179]
ds_read_b64_tr_b16 v[54:55], v13 offset:1024
v_accvgpr_read_b32 v31, a59
v_mfma_f32_16x16x32_bf16 v[192:195], v[96:99], v[112:115], v[192:195]
ds_read_b64_tr_b16 v[56:57], v14 offset:0
v_mul_f32 v20, s79, v20
v_mfma_f32_16x16x32_bf16 v[196:199], v[96:99], v[116:119], v[196:199]
ds_read_b64_tr_b16 v[58:59], v14 offset:1024
v_mul_f32 v28, s79, v28
v_mfma_f32_16x16x32_bf16 v[200:203], v[96:99], v[120:123], v[200:203]
ds_read_b64_tr_b16 v[60:61], v15 offset:0
v_mul_f32 v21, s79, v21
v_mfma_f32_16x16x32_bf16 v[204:207], v[96:99], v[124:127], v[204:207]
s_add_u32 m0, s63, 98304
ds_read_b64_tr_b16 v[62:63], v15 offset:1024
v_mul_f32 v29, s79, v29
v_mfma_f32_16x16x32_bf16 v[220:223], v[100:103], v[124:127], v[220:223]
s_add_u32 s72, s69, 0
buffer_load_dwordx4 v4, s[4:7], s72 offen lds
v_mfma_f32_16x16x32_bf16 v[216:219], v[100:103], v[120:123], v[216:219]
v_mul_f32 v22, s79, v22
v_mul_f32 v30, s79, v30
v_mfma_f32_16x16x32_bf16 v[212:215], v[100:103], v[116:119], v[212:215]
v_mul_f32 v23, s79, v23
v_mul_f32 v31, s79, v31
v_mfma_f32_16x16x32_bf16 v[208:211], v[100:103], v[112:115], v[208:211]
v_cvt_pk_bf16_f32 v20, v20, v28
v_cvt_pk_bf16_f32 v21, v21, v29
v_mfma_f32_16x16x32_bf16 v[224:227], v[104:107], v[112:115], v[224:227]
s_add_u32 s72, s69, 15360
buffer_load_dwordx4 v5, s[4:7], s72 offen offset:1024 lds
v_mfma_f32_16x16x32_bf16 v[228:231], v[104:107], v[116:119], v[228:231]
v_cvt_pk_bf16_f32 v22, v22, v30
v_cvt_pk_bf16_f32 v23, v23, v31
v_mfma_f32_16x16x32_bf16 v[232:235], v[104:107], v[120:123], v[232:235]
s_add_u32 s80, s77, 40960
buffer_store_dwordx4 v[20:23], v1, s[44:47], s80 offen sc1
v_mfma_f32_16x16x32_bf16 v[236:239], v[104:107], v[124:127], v[236:239]
v_accvgpr_read_b32 v24, a160
v_accvgpr_read_b32 v28, a161
v_mfma_f32_16x16x32_bf16 v[252:255], v[108:111], v[124:127], v[252:255]
v_accvgpr_read_b32 v25, a162
v_accvgpr_read_b32 v29, a163
v_mfma_f32_16x16x32_bf16 v[248:251], v[108:111], v[120:123], v[248:251]
s_add_u32 s72, s69, 129024
buffer_load_dwordx4 v4, s[4:7], s72 offen offset:2048 lds
v_mfma_f32_16x16x32_bf16 v[244:247], v[108:111], v[116:119], v[244:247]
v_accvgpr_read_b32 v26, a164
v_accvgpr_read_b32 v30, a165
v_mfma_f32_16x16x32_bf16 v[240:243], v[108:111], v[112:115], v[240:243]
s_waitcnt lgkmcnt(0)
v_accvgpr_read_b32 v27, a166
v_accvgpr_read_b32 v31, a167
v_mfma_f32_16x16x32_bf16 v[128:131], v[32:35], v[64:67], v[128:131]
ds_read_b64_tr_b16 v[80:81], v8 offset:8192
ds_read_b64_tr_b16 v[82:83], v8 offset:9216
v_mfma_f32_16x16x32_bf16 v[132:135], v[32:35], v[68:71], v[132:135]
ds_read_b128 v[112:115], v17 offset:0
ds_read_b128 v[116:119], v17 offset:2048
v_mfma_f32_16x16x32_bf16 v[136:139], v[32:35], v[72:75], v[136:139]
s_add_u32 s72, s69, 144384
buffer_load_dwordx4 v5, s[4:7], s72 offen offset:3072 lds
v_mfma_f32_16x16x32_bf16 v[140:143], v[32:35], v[76:79], v[140:143]
ds_read_b128 v[120:123], v17 offset:4096
ds_read_b128 v[124:127], v17 offset:6144
v_mfma_f32_16x16x32_bf16 v[156:159], v[36:39], v[76:79], v[156:159]
ds_read_b64_tr_b16 v[84:85], v9 offset:8192
ds_read_b64_tr_b16 v[86:87], v9 offset:9216
v_mfma_f32_16x16x32_bf16 v[152:155], v[36:39], v[72:75], v[152:155]
ds_read_b64_tr_b16 v[88:89], v10 offset:8192
v_cvt_pk_bf16_f32 v24, v24, v28
v_mfma_f32_16x16x32_bf16 v[148:151], v[36:39], v[68:71], v[148:151]
ds_read_b64_tr_b16 v[90:91], v10 offset:9216
v_cvt_pk_bf16_f32 v25, v25, v29
v_mfma_f32_16x16x32_bf16 v[144:147], v[36:39], v[64:67], v[144:147]
s_add_u32 m0, s63, 102400
ds_read_b64_tr_b16 v[92:93], v11 offset:8192
v_cvt_pk_bf16_f32 v26, v26, v30
v_mfma_f32_16x16x32_bf16 v[160:163], v[40:43], v[64:67], v[160:163]
s_add_u32 s72, s70, 0
buffer_load_dwordx4 v4, s[4:7], s72 offen lds
v_mfma_f32_16x16x32_bf16 v[164:167], v[40:43], v[68:71], v[164:167]
ds_read_b64_tr_b16 v[94:95], v11 offset:9216
v_cvt_pk_bf16_f32 v27, v27, v31
v_mfma_f32_16x16x32_bf16 v[168:171], v[40:43], v[72:75], v[168:171]
s_add_u32 s80, s78, 1024
ds_read_b64_tr_b16 v[96:97], v12 offset:8192
v_mfma_f32_16x16x32_bf16 v[172:175], v[40:43], v[76:79], v[172:175]
ds_read_b64_tr_b16 v[98:99], v12 offset:9216
v_mfma_f32_16x16x32_bf16 v[188:191], v[44:47], v[76:79], v[188:191]
s_add_u32 s72, s70, 15360
buffer_load_dwordx4 v5, s[4:7], s72 offen offset:1024 lds
v_mfma_f32_16x16x32_bf16 v[184:187], v[44:47], v[72:75], v[184:187]
ds_read_b64_tr_b16 v[100:101], v13 offset:8192
v_accvgpr_read_b32 v20, a28
v_mfma_f32_16x16x32_bf16 v[180:183], v[44:47], v[68:71], v[180:183]
ds_read_b64_tr_b16 v[102:103], v13 offset:9216
v_accvgpr_read_b32 v28, a29
v_mfma_f32_16x16x32_bf16 v[176:179], v[44:47], v[64:67], v[176:179]
ds_read_b64_tr_b16 v[104:105], v14 offset:8192
v_accvgpr_read_b32 v21, a30
v_mfma_f32_16x16x32_bf16 v[192:195], v[48:51], v[64:67], v[192:195]
ds_read_b64_tr_b16 v[106:107], v14 offset:9216
v_accvgpr_read_b32 v29, a31
v_mfma_f32_16x16x32_bf16 v[196:199], v[48:51], v[68:71], v[196:199]
s_add_u32 s72, s70, 129024
buffer_load_dwordx4 v4, s[4:7], s72 offen offset:2048 lds
v_mfma_f32_16x16x32_bf16 v[200:203], v[48:51], v[72:75], v[200:203]
ds_read_b64_tr_b16 v[108:109], v15 offset:8192
v_accvgpr_read_b32 v22, a60
v_mfma_f32_16x16x32_bf16 v[204:207], v[48:51], v[76:79], v[204:207]
ds_read_b64_tr_b16 v[110:111], v15 offset:9216
v_accvgpr_read_b32 v30, a61
v_mfma_f32_16x16x32_bf16 v[220:223], v[52:55], v[76:79], v[220:223]
buffer_store_dwordx4 v[24:27], v1, s[44:47], s80 offen sc1
v_mfma_f32_16x16x32_bf16 v[216:219], v[52:55], v[72:75], v[216:219]
v_accvgpr_read_b32 v23, a62
v_accvgpr_read_b32 v31, a63
v_mfma_f32_16x16x32_bf16 v[212:215], v[52:55], v[68:71], v[212:215]
s_add_u32 s72, s70, 144384
buffer_load_dwordx4 v5, s[4:7], s72 offen offset:3072 lds
v_mfma_f32_16x16x32_bf16 v[208:211], v[52:55], v[64:67], v[208:211]
v_mul_f32 v20, s79, v20
v_mul_f32 v28, s79, v28
v_mfma_f32_16x16x32_bf16 v[224:227], v[56:59], v[64:67], v[224:227]
v_mul_f32 v21, s79, v21
v_mul_f32 v29, s79, v29
v_mfma_f32_16x16x32_bf16 v[228:231], v[56:59], v[68:71], v[228:231]
v_mul_f32 v22, s79, v22
v_mul_f32 v30, s79, v30
v_mfma_f32_16x16x32_bf16 v[232:235], v[56:59], v[72:75], v[232:235]
v_mul_f32 v23, s79, v23
v_mul_f32 v31, s79, v31
v_mfma_f32_16x16x32_bf16 v[236:239], v[56:59], v[76:79], v[236:239]
v_cvt_pk_bf16_f32 v20, v20, v28
v_cvt_pk_bf16_f32 v21, v21, v29
v_mfma_f32_16x16x32_bf16 v[252:255], v[60:63], v[76:79], v[252:255]
v_cvt_pk_bf16_f32 v22, v22, v30
v_cvt_pk_bf16_f32 v23, v23, v31
v_mfma_f32_16x16x32_bf16 v[248:251], v[60:63], v[72:75], v[248:251]
s_add_u32 s80, s77, 45056
buffer_store_dwordx4 v[20:23], v1, s[44:47], s80 offen sc1
v_mfma_f32_16x16x32_bf16 v[244:247], v[60:63], v[68:71], v[244:247]
s_waitcnt vmcnt(16) lgkmcnt(0)
v_mfma_f32_16x16x32_bf16 v[240:243], v[60:63], v[64:67], v[240:243]
s_barrier
v_mfma_f32_16x16x32_bf16 v[128:131], v[80:83], v[112:115], v[128:131]
s_add_u32 s73, s62, 6
ds_read_b64_tr_b16 v[32:33], v8 offset:16384
ds_read_b64_tr_b16 v[34:35], v8 offset:17408
v_mfma_f32_16x16x32_bf16 v[132:135], v[80:83], v[116:119], v[132:135]
s_add_u32 s70, s73, s65
ds_read_b128 v[64:67], v18 offset:0
ds_read_b128 v[68:71], v18 offset:2048
v_mfma_f32_16x16x32_bf16 v[136:139], v[80:83], v[120:123], v[136:139]
s_and_b32 s70, s70, 3
ds_read_b128 v[72:75], v18 offset:4096
ds_read_b128 v[76:79], v18 offset:6144
v_mfma_f32_16x16x32_bf16 v[140:143], v[80:83], v[124:127], v[140:143]
s_and_b32 s73, s73, 12
ds_read_b64_tr_b16 v[36:37], v9 offset:16384
ds_read_b64_tr_b16 v[38:39], v9 offset:17408
v_mfma_f32_16x16x32_bf16 v[156:159], v[84:87], v[124:127], v[156:159]
s_or_b32 s73, s73, s70
ds_read_b64_tr_b16 v[40:41], v10 offset:16384
v_accvgpr_read_b32 v24, a168
v_mfma_f32_16x16x32_bf16 v[152:155], v[84:87], v[120:123], v[152:155]
s_lshl_b32 s71, s73, 19
ds_read_b64_tr_b16 v[42:43], v10 offset:17408
v_accvgpr_read_b32 v28, a169
v_mfma_f32_16x16x32_bf16 v[148:151], v[84:87], v[116:119], v[148:151]
s_add_u32 s71, s71, s66
ds_read_b64_tr_b16 v[44:45], v11 offset:16384
v_accvgpr_read_b32 v25, a170
v_mfma_f32_16x16x32_bf16 v[144:147], v[84:87], v[112:115], v[144:147]
s_lshl_b32 s73, s73, 7
ds_read_b64_tr_b16 v[46:47], v11 offset:17408
v_accvgpr_read_b32 v29, a171
v_mfma_f32_16x16x32_bf16 v[160:163], v[88:91], v[112:115], v[160:163]
s_add_u32 s69, s73, s67
ds_read_b64_tr_b16 v[48:49], v12 offset:16384
v_accvgpr_read_b32 v26, a172
v_mfma_f32_16x16x32_bf16 v[164:167], v[88:91], v[116:119], v[164:167]
s_add_u32 s70, s73, s68
ds_read_b64_tr_b16 v[50:51], v12 offset:17408
v_accvgpr_read_b32 v30, a173
v_mfma_f32_16x16x32_bf16 v[168:171], v[88:91], v[120:123], v[168:171]
s_add_u32 m0, s64, 0
ds_read_b64_tr_b16 v[52:53], v13 offset:16384
v_accvgpr_read_b32 v27, a174
v_mfma_f32_16x16x32_bf16 v[172:175], v[88:91], v[124:127], v[172:175]
s_add_u32 s72, s71, 0
buffer_load_dwordx4 v6, s[12:15], s72 offen lds
v_mfma_f32_16x16x32_bf16 v[188:191], v[92:95], v[124:127], v[188:191]
s_add_u32 s72, s71, 31744
buffer_load_dwordx4 v6, s[12:15], s72 offen offset:1024 lds
v_mfma_f32_16x16x32_bf16 v[184:187], v[92:95], v[120:123], v[184:187]
s_add_u32 s72, s71, 63488
buffer_load_dwordx4 v7, s[12:15], s72 offen offset:2048 lds
v_mfma_f32_16x16x32_bf16 v[180:183], v[92:95], v[116:119], v[180:183]
s_add_u32 s72, s71, 95232
buffer_load_dwordx4 v7, s[12:15], s72 offen offset:3072 lds
v_mfma_f32_16x16x32_bf16 v[176:179], v[92:95], v[112:115], v[176:179]
ds_read_b64_tr_b16 v[54:55], v13 offset:17408
v_accvgpr_read_b32 v31, a175
v_mfma_f32_16x16x32_bf16 v[192:195], v[96:99], v[112:115], v[192:195]
ds_read_b64_tr_b16 v[56:57], v14 offset:16384
v_cvt_pk_bf16_f32 v24, v24, v28
v_mfma_f32_16x16x32_bf16 v[196:199], v[96:99], v[116:119], v[196:199]
ds_read_b64_tr_b16 v[58:59], v14 offset:17408
v_cvt_pk_bf16_f32 v25, v25, v29
v_mfma_f32_16x16x32_bf16 v[200:203], v[96:99], v[120:123], v[200:203]
ds_read_b64_tr_b16 v[60:61], v15 offset:16384
v_cvt_pk_bf16_f32 v26, v26, v30
v_mfma_f32_16x16x32_bf16 v[204:207], v[96:99], v[124:127], v[204:207]
s_add_u32 m0, s63, 131072
ds_read_b64_tr_b16 v[62:63], v15 offset:17408
v_cvt_pk_bf16_f32 v27, v27, v31
v_mfma_f32_16x16x32_bf16 v[220:223], v[100:103], v[124:127], v[220:223]
s_add_u32 s72, s69, 0
buffer_load_dwordx4 v4, s[4:7], s72 offen lds
v_mfma_f32_16x16x32_bf16 v[216:219], v[100:103], v[120:123], v[216:219]
s_add_u32 s80, s78, 9216
buffer_store_dwordx4 v[24:27], v1, s[44:47], s80 offen sc1
v_mfma_f32_16x16x32_bf16 v[212:215], v[100:103], v[116:119], v[212:215]
v_accvgpr_read_b32 v20, a64
v_accvgpr_read_b32 v28, a65
v_mfma_f32_16x16x32_bf16 v[208:211], v[100:103], v[112:115], v[208:211]
v_accvgpr_read_b32 v21, a66
v_accvgpr_read_b32 v29, a67
v_mfma_f32_16x16x32_bf16 v[224:227], v[104:107], v[112:115], v[224:227]
s_add_u32 s72, s69, 15360
buffer_load_dwordx4 v5, s[4:7], s72 offen offset:1024 lds
v_mfma_f32_16x16x32_bf16 v[228:231], v[104:107], v[116:119], v[228:231]
v_accvgpr_read_b32 v22, a96
v_accvgpr_read_b32 v30, a97
v_mfma_f32_16x16x32_bf16 v[232:235], v[104:107], v[120:123], v[232:235]
v_accvgpr_read_b32 v23, a98
v_accvgpr_read_b32 v31, a99
v_mfma_f32_16x16x32_bf16 v[236:239], v[104:107], v[124:127], v[236:239]
v_mul_f32 v20, s79, v20
v_mul_f32 v28, s79, v28
v_mfma_f32_16x16x32_bf16 v[252:255], v[108:111], v[124:127], v[252:255]
v_mul_f32 v21, s79, v21
v_mul_f32 v29, s79, v29
v_mfma_f32_16x16x32_bf16 v[248:251], v[108:111], v[120:123], v[248:251]
s_add_u32 s72, s69, 129024
buffer_load_dwordx4 v4, s[4:7], s72 offen offset:2048 lds
v_mfma_f32_16x16x32_bf16 v[244:247], v[108:111], v[116:119], v[244:247]
v_mul_f32 v22, s79, v22
v_mul_f32 v30, s79, v30
v_mfma_f32_16x16x32_bf16 v[240:243], v[108:111], v[112:115], v[240:243]
s_waitcnt lgkmcnt(0)
v_mul_f32 v23, s79, v23
v_mul_f32 v31, s79, v31
v_mfma_f32_16x16x32_bf16 v[128:131], v[32:35], v[64:67], v[128:131]
ds_read_b64_tr_b16 v[80:81], v8 offset:24576
ds_read_b64_tr_b16 v[82:83], v8 offset:25600
v_mfma_f32_16x16x32_bf16 v[132:135], v[32:35], v[68:71], v[132:135]
ds_read_b128 v[112:115], v19 offset:0
ds_read_b128 v[116:119], v19 offset:2048
v_mfma_f32_16x16x32_bf16 v[136:139], v[32:35], v[72:75], v[136:139]
s_add_u32 s72, s69, 144384
buffer_load_dwordx4 v5, s[4:7], s72 offen offset:3072 lds
v_mfma_f32_16x16x32_bf16 v[140:143], v[32:35], v[76:79], v[140:143]
ds_read_b128 v[120:123], v19 offset:4096
ds_read_b128 v[124:127], v19 offset:6144
v_mfma_f32_16x16x32_bf16 v[156:159], v[36:39], v[76:79], v[156:159]
ds_read_b64_tr_b16 v[84:85], v9 offset:24576
ds_read_b64_tr_b16 v[86:87], v9 offset:25600
v_mfma_f32_16x16x32_bf16 v[152:155], v[36:39], v[72:75], v[152:155]
ds_read_b64_tr_b16 v[88:89], v10 offset:24576
v_cvt_pk_bf16_f32 v20, v20, v28
v_mfma_f32_16x16x32_bf16 v[148:151], v[36:39], v[68:71], v[148:151]
ds_read_b64_tr_b16 v[90:91], v10 offset:25600
v_cvt_pk_bf16_f32 v21, v21, v29
v_mfma_f32_16x16x32_bf16 v[144:147], v[36:39], v[64:67], v[144:147]
s_add_u32 m0, s63, 135168
ds_read_b64_tr_b16 v[92:93], v11 offset:24576
v_cvt_pk_bf16_f32 v22, v22, v30
v_mfma_f32_16x16x32_bf16 v[160:163], v[40:43], v[64:67], v[160:163]
s_add_u32 s72, s70, 0
buffer_load_dwordx4 v4, s[4:7], s72 offen lds
v_mfma_f32_16x16x32_bf16 v[164:167], v[40:43], v[68:71], v[164:167]
ds_read_b64_tr_b16 v[94:95], v11 offset:25600
v_cvt_pk_bf16_f32 v23, v23, v31
v_mfma_f32_16x16x32_bf16 v[168:171], v[40:43], v[72:75], v[168:171]
s_add_u32 s80, s77, 1024
ds_read_b64_tr_b16 v[96:97], v12 offset:24576
v_accvgpr_read_b32 v24, a176
v_mfma_f32_16x16x32_bf16 v[172:175], v[40:43], v[76:79], v[172:175]
ds_read_b64_tr_b16 v[98:99], v12 offset:25600
v_accvgpr_read_b32 v28, a177
v_mfma_f32_16x16x32_bf16 v[188:191], v[44:47], v[76:79], v[188:191]
s_add_u32 s72, s70, 15360
buffer_load_dwordx4 v5, s[4:7], s72 offen offset:1024 lds
v_mfma_f32_16x16x32_bf16 v[184:187], v[44:47], v[72:75], v[184:187]
ds_read_b64_tr_b16 v[100:101], v13 offset:24576
v_accvgpr_read_b32 v25, a178
v_mfma_f32_16x16x32_bf16 v[180:183], v[44:47], v[68:71], v[180:183]
ds_read_b64_tr_b16 v[102:103], v13 offset:25600
v_accvgpr_read_b32 v29, a179
v_mfma_f32_16x16x32_bf16 v[176:179], v[44:47], v[64:67], v[176:179]
ds_read_b64_tr_b16 v[104:105], v14 offset:24576
v_accvgpr_read_b32 v26, a180
v_mfma_f32_16x16x32_bf16 v[192:195], v[48:51], v[64:67], v[192:195]
ds_read_b64_tr_b16 v[106:107], v14 offset:25600
v_accvgpr_read_b32 v30, a181
v_mfma_f32_16x16x32_bf16 v[196:199], v[48:51], v[68:71], v[196:199]
s_add_u32 s72, s70, 129024
buffer_load_dwordx4 v4, s[4:7], s72 offen offset:2048 lds
v_mfma_f32_16x16x32_bf16 v[200:203], v[48:51], v[72:75], v[200:203]
ds_read_b64_tr_b16 v[108:109], v15 offset:24576
v_accvgpr_read_b32 v27, a182
v_mfma_f32_16x16x32_bf16 v[204:207], v[48:51], v[76:79], v[204:207]
ds_read_b64_tr_b16 v[110:111], v15 offset:25600
v_accvgpr_read_b32 v31, a183
v_mfma_f32_16x16x32_bf16 v[220:223], v[52:55], v[76:79], v[220:223]
buffer_store_dwordx4 v[20:23], v1, s[44:47], s80 offen sc1
v_mfma_f32_16x16x32_bf16 v[216:219], v[52:55], v[72:75], v[216:219]
v_cvt_pk_bf16_f32 v24, v24, v28
v_cvt_pk_bf16_f32 v25, v25, v29
v_mfma_f32_16x16x32_bf16 v[212:215], v[52:55], v[68:71], v[212:215]
s_add_u32 s72, s70, 144384
buffer_load_dwordx4 v5, s[4:7], s72 offen offset:3072 lds
v_mfma_f32_16x16x32_bf16 v[208:211], v[52:55], v[64:67], v[208:211]
v_cvt_pk_bf16_f32 v26, v26, v30
v_cvt_pk_bf16_f32 v27, v27, v31
v_mfma_f32_16x16x32_bf16 v[224:227], v[56:59], v[64:67], v[224:227]
s_add_u32 s80, s78, 33792
buffer_store_dwordx4 v[24:27], v1, s[44:47], s80 offen sc1
v_mfma_f32_16x16x32_bf16 v[228:231], v[56:59], v[68:71], v[228:231]
v_mfma_f32_16x16x32_bf16 v[232:235], v[56:59], v[72:75], v[232:235]
v_mfma_f32_16x16x32_bf16 v[236:239], v[56:59], v[76:79], v[236:239]
v_mfma_f32_16x16x32_bf16 v[252:255], v[60:63], v[76:79], v[252:255]
v_mfma_f32_16x16x32_bf16 v[248:251], v[60:63], v[72:75], v[248:251]
v_mfma_f32_16x16x32_bf16 v[244:247], v[60:63], v[68:71], v[244:247]
s_waitcnt vmcnt(16) lgkmcnt(0)
v_accvgpr_read_b32 v20, a68
v_accvgpr_read_b32 v28, a69
v_mfma_f32_16x16x32_bf16 v[240:243], v[60:63], v[64:67], v[240:243]
s_barrier
v_accvgpr_read_b32 v21, a70
v_accvgpr_read_b32 v29, a71
v_mfma_f32_16x16x32_bf16 v[128:131], v[80:83], v[112:115], v[128:131]
s_add_u32 s73, s62, 7
ds_read_b64_tr_b16 v[32:33], v8 offset:32768
ds_read_b64_tr_b16 v[34:35], v8 offset:33792
v_mfma_f32_16x16x32_bf16 v[132:135], v[80:83], v[116:119], v[132:135]
s_add_u32 s70, s73, s65
ds_read_b128 v[64:67], v18 offset:32768
ds_read_b128 v[68:71], v18 offset:34816
v_mfma_f32_16x16x32_bf16 v[136:139], v[80:83], v[120:123], v[136:139]
s_and_b32 s70, s70, 3
ds_read_b128 v[72:75], v18 offset:36864
ds_read_b128 v[76:79], v18 offset:38912
v_mfma_f32_16x16x32_bf16 v[140:143], v[80:83], v[124:127], v[140:143]
s_and_b32 s73, s73, 12
ds_read_b64_tr_b16 v[36:37], v9 offset:32768
ds_read_b64_tr_b16 v[38:39], v9 offset:33792
v_mfma_f32_16x16x32_bf16 v[156:159], v[84:87], v[124:127], v[156:159]
s_or_b32 s73, s73, s70
ds_read_b64_tr_b16 v[40:41], v10 offset:32768
v_accvgpr_read_b32 v22, a100
v_mfma_f32_16x16x32_bf16 v[152:155], v[84:87], v[120:123], v[152:155]
s_lshl_b32 s71, s73, 19
ds_read_b64_tr_b16 v[42:43], v10 offset:33792
v_accvgpr_read_b32 v30, a101
v_mfma_f32_16x16x32_bf16 v[148:151], v[84:87], v[116:119], v[148:151]
s_add_u32 s71, s71, s66
ds_read_b64_tr_b16 v[44:45], v11 offset:32768
v_accvgpr_read_b32 v23, a102
v_mfma_f32_16x16x32_bf16 v[144:147], v[84:87], v[112:115], v[144:147]
s_lshl_b32 s73, s73, 7
ds_read_b64_tr_b16 v[46:47], v11 offset:33792
v_accvgpr_read_b32 v31, a103
v_mfma_f32_16x16x32_bf16 v[160:163], v[88:91], v[112:115], v[160:163]
s_add_u32 s69, s73, s67
ds_read_b64_tr_b16 v[48:49], v12 offset:32768
v_mul_f32 v20, s79, v20
v_mfma_f32_16x16x32_bf16 v[164:167], v[88:91], v[116:119], v[164:167]
s_add_u32 s70, s73, s68
ds_read_b64_tr_b16 v[50:51], v12 offset:33792
v_mul_f32 v28, s79, v28
v_mfma_f32_16x16x32_bf16 v[168:171], v[88:91], v[120:123], v[168:171]
s_add_u32 m0, s64, 16384
ds_read_b64_tr_b16 v[52:53], v13 offset:32768
v_mul_f32 v21, s79, v21
v_mfma_f32_16x16x32_bf16 v[172:175], v[88:91], v[124:127], v[172:175]
s_add_u32 s72, s71, 0
buffer_load_dwordx4 v6, s[12:15], s72 offen lds
v_mfma_f32_16x16x32_bf16 v[188:191], v[92:95], v[124:127], v[188:191]
s_add_u32 s72, s71, 31744
buffer_load_dwordx4 v6, s[12:15], s72 offen offset:1024 lds
v_mfma_f32_16x16x32_bf16 v[184:187], v[92:95], v[120:123], v[184:187]
s_add_u32 s72, s71, 63488
buffer_load_dwordx4 v7, s[12:15], s72 offen offset:2048 lds
v_mfma_f32_16x16x32_bf16 v[180:183], v[92:95], v[116:119], v[180:183]
s_add_u32 s72, s71, 95232
buffer_load_dwordx4 v7, s[12:15], s72 offen offset:3072 lds
v_mfma_f32_16x16x32_bf16 v[176:179], v[92:95], v[112:115], v[176:179]
ds_read_b64_tr_b16 v[54:55], v13 offset:33792
v_mul_f32 v29, s79, v29
v_mfma_f32_16x16x32_bf16 v[192:195], v[96:99], v[112:115], v[192:195]
ds_read_b64_tr_b16 v[56:57], v14 offset:32768
v_mul_f32 v22, s79, v22
v_mfma_f32_16x16x32_bf16 v[196:199], v[96:99], v[116:119], v[196:199]
ds_read_b64_tr_b16 v[58:59], v14 offset:33792
v_mul_f32 v30, s79, v30
v_mfma_f32_16x16x32_bf16 v[200:203], v[96:99], v[120:123], v[200:203]
ds_read_b64_tr_b16 v[60:61], v15 offset:32768
v_mul_f32 v23, s79, v23
v_mfma_f32_16x16x32_bf16 v[204:207], v[96:99], v[124:127], v[204:207]
s_add_u32 m0, s63, 65536
ds_read_b64_tr_b16 v[62:63], v15 offset:33792
v_mul_f32 v31, s79, v31
v_mfma_f32_16x16x32_bf16 v[220:223], v[100:103], v[124:127], v[220:223]
s_add_u32 s72, s69, 0
buffer_load_dwordx4 v4, s[4:7], s72 offen lds
v_mfma_f32_16x16x32_bf16 v[216:219], v[100:103], v[120:123], v[216:219]
v_cvt_pk_bf16_f32 v20, v20, v28
v_cvt_pk_bf16_f32 v21, v21, v29
v_mfma_f32_16x16x32_bf16 v[212:215], v[100:103], v[116:119], v[212:215]
v_cvt_pk_bf16_f32 v22, v22, v30
v_cvt_pk_bf16_f32 v23, v23, v31
v_mfma_f32_16x16x32_bf16 v[208:211], v[100:103], v[112:115], v[208:211]
s_add_u32 s80, s77, 5120
buffer_store_dwordx4 v[20:23], v1, s[44:47], s80 offen sc1
v_mfma_f32_16x16x32_bf16 v[224:227], v[104:107], v[112:115], v[224:227]
s_add_u32 s72, s69, 15360
buffer_load_dwordx4 v5, s[4:7], s72 offen offset:1024 lds
v_mfma_f32_16x16x32_bf16 v[228:231], v[104:107], v[116:119], v[228:231]
v_accvgpr_read_b32 v24, a184
v_accvgpr_read_b32 v28, a185
v_mfma_f32_16x16x32_bf16 v[232:235], v[104:107], v[120:123], v[232:235]
v_accvgpr_read_b32 v25, a186
v_accvgpr_read_b32 v29, a187
v_mfma_f32_16x16x32_bf16 v[236:239], v[104:107], v[124:127], v[236:239]
v_accvgpr_read_b32 v26, a188
v_accvgpr_read_b32 v30, a189
v_mfma_f32_16x16x32_bf16 v[252:255], v[108:111], v[124:127], v[252:255]
v_accvgpr_read_b32 v27, a190
v_accvgpr_read_b32 v31, a191
v_mfma_f32_16x16x32_bf16 v[248:251], v[108:111], v[120:123], v[248:251]
s_add_u32 s72, s69, 129024
buffer_load_dwordx4 v4, s[4:7], s72 offen offset:2048 lds
v_mfma_f32_16x16x32_bf16 v[244:247], v[108:111], v[116:119], v[244:247]
v_cvt_pk_bf16_f32 v24, v24, v28
v_cvt_pk_bf16_f32 v25, v25, v29
v_mfma_f32_16x16x32_bf16 v[240:243], v[108:111], v[112:115], v[240:243]
s_waitcnt lgkmcnt(0)
v_cvt_pk_bf16_f32 v26, v26, v30
v_cvt_pk_bf16_f32 v27, v27, v31
v_mfma_f32_16x16x32_bf16 v[128:131], v[32:35], v[64:67], v[128:131]
s_lshr_b32 s75, s93, 4
ds_read_b64_tr_b16 v[80:81], v8 offset:40960
ds_read_b64_tr_b16 v[82:83], v8 offset:41984
v_mfma_f32_16x16x32_bf16 v[132:135], v[32:35], v[68:71], v[132:135]
s_and_b32 s75, s75, 0x7f00
ds_read_b128 v[112:115], v19 offset:32768
ds_read_b128 v[116:119], v19 offset:34816
v_mfma_f32_16x16x32_bf16 v[136:139], v[32:35], v[72:75], v[136:139]
s_add_u32 s72, s69, 144384
buffer_load_dwordx4 v5, s[4:7], s72 offen offset:3072 lds
v_mfma_f32_16x16x32_bf16 v[140:143], v[32:35], v[76:79], v[140:143]
s_add_u32 s75, s75, LcB1-Lpc0
v_lshrrev_b32 v2, 5, v0
v_lshlrev_b32 v2, 7, v2
v_mfma_f32_16x16x32_bf16 v[156:159], v[36:39], v[76:79], v[156:159]
s_add_u32 s80, s78, 41984
v_add_u32 v2, s75, v2
v_min_u32 v2, Lcode_end-Lpc0, v2
v_mfma_f32_16x16x32_bf16 v[152:155], v[36:39], v[72:75], v[152:155]
global_load_dword v3, v2, s[98:99]
v_mfma_f32_16x16x32_bf16 v[148:151], v[36:39], v[68:71], v[148:151]
ds_read_b128 v[120:123], v19 offset:36864
ds_read_b128 v[124:127], v19 offset:38912
v_mfma_f32_16x16x32_bf16 v[144:147], v[36:39], v[64:67], v[144:147]
s_add_u32 m0, s63, 69632
ds_read_b64_tr_b16 v[84:85], v9 offset:40960
ds_read_b64_tr_b16 v[86:87], v9 offset:41984
v_mfma_f32_16x16x32_bf16 v[160:163], v[40:43], v[64:67], v[160:163]
s_add_u32 s72, s70, 0
buffer_load_dwordx4 v4, s[4:7], s72 offen lds
v_mfma_f32_16x16x32_bf16 v[164:167], v[40:43], v[68:71], v[164:167]
ds_read_b64_tr_b16 v[88:89], v10 offset:40960
v_accvgpr_read_b32 v20, a72
v_mfma_f32_16x16x32_bf16 v[168:171], v[40:43], v[72:75], v[168:171]
ds_read_b64_tr_b16 v[90:91], v10 offset:41984
v_accvgpr_read_b32 v28, a73
v_mfma_f32_16x16x32_bf16 v[172:175], v[40:43], v[76:79], v[172:175]
ds_read_b64_tr_b16 v[92:93], v11 offset:40960
v_accvgpr_read_b32 v21, a74
v_mfma_f32_16x16x32_bf16 v[188:191], v[44:47], v[76:79], v[188:191]
s_add_u32 s72, s70, 15360
buffer_load_dwordx4 v5, s[4:7], s72 offen offset:1024 lds
v_mfma_f32_16x16x32_bf16 v[184:187], v[44:47], v[72:75], v[184:187]
ds_read_b64_tr_b16 v[94:95], v11 offset:41984
v_accvgpr_read_b32 v29, a75
v_mfma_f32_16x16x32_bf16 v[180:183], v[44:47], v[68:71], v[180:183]
ds_read_b64_tr_b16 v[96:97], v12 offset:40960
v_accvgpr_read_b32 v22, a104
v_mfma_f32_16x16x32_bf16 v[176:179], v[44:47], v[64:67], v[176:179]
ds_read_b64_tr_b16 v[98:99], v12 offset:41984
v_accvgpr_read_b32 v30, a105
v_mfma_f32_16x16x32_bf16 v[192:195], v[48:51], v[64:67], v[192:195]
ds_read_b64_tr_b16 v[100:101], v13 offset:40960
v_accvgpr_read_b32 v23, a106
v_mfma_f32_16x16x32_bf16 v[196:199], v[48:51], v[68:71], v[196:199]
s_add_u32 s72, s70, 129024
buffer_load_dwordx4 v4, s[4:7], s72 offen offset:2048 lds
v_mfma_f32_16x16x32_bf16 v[200:203], v[48:51], v[72:75], v[200:203]
ds_read_b64_tr_b16 v[102:103], v13 offset:41984
v_accvgpr_read_b32 v31, a107
v_mfma_f32_16x16x32_bf16 v[204:207], v[48:51], v[76:79], v[204:207]
ds_read_b64_tr_b16 v[104:105], v14 offset:40960
v_mul_f32 v20, s79, v20
v_mfma_f32_16x16x32_bf16 v[220:223], v[52:55], v[76:79], v[220:223]
ds_read_b64_tr_b16 v[106:107], v14 offset:41984
v_mul_f32 v28, s79, v28
v_mfma_f32_16x16x32_bf16 v[216:219], v[52:55], v[72:75], v[216:219]
ds_read_b64_tr_b16 v[108:109], v15 offset:40960
v_mul_f32 v21, s79, v21
v_mfma_f32_16x16x32_bf16 v[212:215], v[52:55], v[68:71], v[212:215]
s_add_u32 s72, s70, 144384
buffer_load_dwordx4 v5, s[4:7], s72 offen offset:3072 lds
v_mfma_f32_16x16x32_bf16 v[208:211], v[52:55], v[64:67], v[208:211]
ds_read_b64_tr_b16 v[110:111], v15 offset:41984
v_mul_f32 v29, s79, v29
v_mfma_f32_16x16x32_bf16 v[224:227], v[56:59], v[64:67], v[224:227]
buffer_store_dwordx4 v[24:27], v1, s[44:47], s80 offen sc1
v_mfma_f32_16x16x32_bf16 v[228:231], v[56:59], v[68:71], v[228:231]
v_mul_f32 v22, s79, v22
v_mul_f32 v30, s79, v30
v_mfma_f32_16x16x32_bf16 v[232:235], v[56:59], v[72:75], v[232:235]
v_mul_f32 v23, s79, v23
v_mul_f32 v31, s79, v31
v_mfma_f32_16x16x32_bf16 v[236:239], v[56:59], v[76:79], v[236:239]
v_cvt_pk_bf16_f32 v20, v20, v28
v_cvt_pk_bf16_f32 v21, v21, v29
v_mfma_f32_16x16x32_bf16 v[252:255], v[60:63], v[76:79], v[252:255]
v_cvt_pk_bf16_f32 v22, v22, v30
v_cvt_pk_bf16_f32 v23, v23, v31
v_mfma_f32_16x16x32_bf16 v[248:251], v[60:63], v[72:75], v[248:251]
s_add_u32 s80, s77, 9216
buffer_store_dwordx4 v[20:23], v1, s[44:47], s80 offen sc1
v_mfma_f32_16x16x32_bf16 v[244:247], v[60:63], v[68:71], v[244:247]
s_waitcnt vmcnt(17) lgkmcnt(0)
v_accvgpr_read_b32 v24, a192
v_accvgpr_read_b32 v28, a193
v_mfma_f32_16x16x32_bf16 v[240:243], v[60:63], v[64:67], v[240:243]
s_barrier
v_accvgpr_read_b32 v25, a194
v_accvgpr_read_b32 v29, a195
v_mfma_f32_16x16x32_bf16 v[128:131], v[80:83], v[112:115], v[128:131]
s_add_u32 s73, s62, 8
ds_read_b64_tr_b16 v[32:33], v8 offset:0
ds_read_b64_tr_b16 v[34:35], v8 offset:1024
v_mfma_f32_16x16x32_bf16 v[132:135], v[80:83], v[116:119], v[132:135]
s_add_u32 s70, s73, s65
ds_read_b128 v[64:67], v16 offset:0
ds_read_b128 v[68:71], v16 offset:2048
v_mfma_f32_16x16x32_bf16 v[136:139], v[80:83], v[120:123], v[136:139]
s_and_b32 s70, s70, 3
ds_read_b128 v[72:75], v16 offset:4096
ds_read_b128 v[76:79], v16 offset:6144
v_mfma_f32_16x16x32_bf16 v[140:143], v[80:83], v[124:127], v[140:143]
s_and_b32 s73, s73, 12
ds_read_b64_tr_b16 v[36:37], v9 offset:0
ds_read_b64_tr_b16 v[38:39], v9 offset:1024
v_mfma_f32_16x16x32_bf16 v[156:159], v[84:87], v[124:127], v[156:159]
s_or_b32 s73, s73, s70
ds_read_b64_tr_b16 v[40:41], v10 offset:0
v_accvgpr_read_b32 v26, a196
v_mfma_f32_16x16x32_bf16 v[152:155], v[84:87], v[120:123], v[152:155]
s_lshl_b32 s71, s73, 19
ds_read_b64_tr_b16 v[42:43], v10 offset:1024
v_accvgpr_read_b32 v30, a197
v_mfma_f32_16x16x32_bf16 v[148:151], v[84:87], v[116:119], v[148:151]
s_add_u32 s71, s71, s66
ds_read_b64_tr_b16 v[44:45], v11 offset:0
v_accvgpr_read_b32 v27, a198
v_mfma_f32_16x16x32_bf16 v[144:147], v[84:87], v[112:115], v[144:147]
s_lshl_b32 s73, s73, 7
ds_read_b64_tr_b16 v[46:47], v11 offset:1024
v_accvgpr_read_b32 v31, a199
v_mfma_f32_16x16x32_bf16 v[160:163], v[88:91], v[112:115], v[160:163]
s_add_u32 s69, s73, s67
ds_read_b64_tr_b16 v[48:49], v12 offset:0
v_cvt_pk_bf16_f32 v24, v24, v28
v_mfma_f32_16x16x32_bf16 v[164:167], v[88:91], v[116:119], v[164:167]
s_add_u32 s70, s73, s68
ds_read_b64_tr_b16 v[50:51], v12 offset:1024
v_cvt_pk_bf16_f32 v25, v25, v29
v_mfma_f32_16x16x32_bf16 v[168:171], v[88:91], v[120:123], v[168:171]
s_add_u32 m0, s64, 32768
ds_read_b64_tr_b16 v[52:53], v13 offset:0
v_cvt_pk_bf16_f32 v26, v26, v30
v_mfma_f32_16x16x32_bf16 v[172:175], v[88:91], v[124:127], v[172:175]
s_add_u32 s72, s71, 0
buffer_load_dwordx4 v6, s[12:15], s72 offen lds
v_mfma_f32_16x16x32_bf16 v[188:191], v[92:95], v[124:127], v[188:191]
s_add_u32 s72, s71, 31744
buffer_load_dwordx4 v6, s[12:15], s72 offen offset:1024 lds
v_mfma_f32_16x16x32_bf16 v[184:187], v[92:95], v[120:123], v[184:187]
s_add_u32 s72, s71, 63488
buffer_load_dwordx4 v7, s[12:15], s72 offen offset:2048 lds
v_mfma_f32_16x16x32_bf16 v[180:183], v[92:95], v[116:119], v[180:183]
s_add_u32 s72, s71, 95232
buffer_load_dwordx4 v7, s[12:15], s72 offen offset:3072 lds
v_mfma_f32_16x16x32_bf16 v[176:179], v[92:95], v[112:115], v[176:179]
ds_read_b64_tr_b16 v[54:55], v13 offset:1024
v_cvt_pk_bf16_f32 v27, v27, v31
v_mfma_f32_16x16x32_bf16 v[192:195], v[96:99], v[112:115], v[192:195]
s_add_u32 s80, s78, 2048
ds_read_b64_tr_b16 v[56:57], v14 offset:0
v_accvgpr_read_b32 v20, a76
v_mfma_f32_16x16x32_bf16 v[196:199], v[96:99], v[116:119], v[196:199]
ds_read_b64_tr_b16 v[58:59], v14 offset:1024
v_accvgpr_read_b32 v28, a77
v_mfma_f32_16x16x32_bf16 v[200:203], v[96:99], v[120:123], v[200:203]
ds_read_b64_tr_b16 v[60:61], v15 offset:0
v_accvgpr_read_b32 v21, a78
v_mfma_f32_16x16x32_bf16 v[204:207], v[96:99], v[124:127], v[204:207]
s_add_u32 m0, s63, 98304
ds_read_b64_tr_b16 v[62:63], v15 offset:1024
v_accvgpr_read_b32 v29, a79
v_mfma_f32_16x16x32_bf16 v[220:223], v[100:103], v[124:127], v[220:223]
s_add_u32 s72, s69, 0
buffer_load_dwordx4 v4, s[4:7], s72 offen lds
v_mfma_f32_16x16x32_bf16 v[216:219], v[100:103], v[120:123], v[216:219]
buffer_store_dwordx4 v[24:27], v1, s[44:47], s80 offen sc1
v_mfma_f32_16x16x32_bf16 v[212:215], v[100:103], v[116:119], v[212:215]
v_accvgpr_read_b32 v22, a108
v_accvgpr_read_b32 v30, a109
v_mfma_f32_16x16x32_bf16 v[208:211], v[100:103], v[112:115], v[208:211]
v_accvgpr_read_b32 v23, a110
v_accvgpr_read_b32 v31, a111
v_mfma_f32_16x16x32_bf16 v[224:227], v[104:107], v[112:115], v[224:227]
s_add_u32 s72, s69, 15360
buffer_load_dwordx4 v5, s[4:7], s72 offen offset:1024 lds
v_mfma_f32_16x16x32_bf16 v[228:231], v[104:107], v[116:119], v[228:231]
v_mul_f32 v20, s79, v20
v_mul_f32 v28, s79, v28
v_mfma_f32_16x16x32_bf16 v[232:235], v[104:107], v[120:123], v[232:235]
v_mul_f32 v21, s79, v21
v_mul_f32 v29, s79, v29
v_mfma_f32_16x16x32_bf16 v[236:239], v[104:107], v[124:127], v[236:239]
v_mul_f32 v22, s79, v22
v_mul_f32 v30, s79, v30
v_mfma_f32_16x16x32_bf16 v[252:255], v[108:111], v[124:127], v[252:255]
v_mul_f32 v23, s79, v23
v_mul_f32 v31, s79, v31
v_mfma_f32_16x16x32_bf16 v[248:251], v[108:111], v[120:123], v[248:251]
s_add_u32 s72, s69, 129024
buffer_load_dwordx4 v4, s[4:7], s72 offen offset:2048 lds
v_mfma_f32_16x16x32_bf16 v[244:247], v[108:111], v[116:119], v[244:247]
v_cvt_pk_bf16_f32 v20, v20, v28
v_cvt_pk_bf16_f32 v21, v21, v29
v_mfma_f32_16x16x32_bf16 v[240:243], v[108:111], v[112:115], v[240:243]
s_waitcnt lgkmcnt(0)
v_cvt_pk_bf16_f32 v22, v22, v30
v_cvt_pk_bf16_f32 v23, v23, v31
v_mfma_f32_16x16x32_bf16 v[128:131], v[32:35], v[64:67], v[128:131]
s_add_u32 s80, s77, 13312
ds_read_b64_tr_b16 v[80:81], v8 offset:8192
ds_read_b64_tr_b16 v[82:83], v8 offset:9216
v_mfma_f32_16x16x32_bf16 v[132:135], v[32:35], v[68:71], v[132:135]
ds_read_b128 v[112:115], v17 offset:0
ds_read_b128 v[116:119], v17 offset:2048
v_mfma_f32_16x16x32_bf16 v[136:139], v[32:35], v[72:75], v[136:139]
s_add_u32 s72, s69, 144384
buffer_load_dwordx4 v5, s[4:7], s72 offen offset:3072 lds
v_mfma_f32_16x16x32_bf16 v[140:143], v[32:35], v[76:79], v[140:143]
ds_read_b128 v[120:123], v17 offset:4096
ds_read_b128 v[124:127], v17 offset:6144
v_mfma_f32_16x16x32_bf16 v[156:159], v[36:39], v[76:79], v[156:159]
ds_read_b64_tr_b16 v[84:85], v9 offset:8192
ds_read_b64_tr_b16 v[86:87], v9 offset:9216
v_mfma_f32_16x16x32_bf16 v[152:155], v[36:39], v[72:75], v[152:155]
ds_read_b64_tr_b16 v[88:89], v10 offset:8192
v_accvgpr_read_b32 v24, a200
v_mfma_f32_16x16x32_bf16 v[148:151], v[36:39], v[68:71], v[148:151]
ds_read_b64_tr_b16 v[90:91], v10 offset:9216
v_accvgpr_read_b32 v28, a201
v_mfma_f32_16x16x32_bf16 v[144:147], v[36:39], v[64:67], v[144:147]
s_add_u32 m0, s63, 102400
ds_read_b64_tr_b16 v[92:93], v11 offset:8192
v_accvgpr_read_b32 v25, a202
v_mfma_f32_16x16x32_bf16 v[160:163], v[40:43], v[64:67], v[160:163]
s_add_u32 s72, s70, 0
buffer_load_dwordx4 v4, s[4:7], s72 offen lds
v_mfma_f32_16x16x32_bf16 v[164:167], v[40:43], v[68:71], v[164:167]
ds_read_b64_tr_b16 v[94:95], v11 offset:9216
v_accvgpr_read_b32 v29, a203
v_mfma_f32_16x16x32_bf16 v[168:171], v[40:43], v[72:75], v[168:171]
ds_read_b64_tr_b16 v[96:97], v12 offset:8192
v_accvgpr_read_b32 v26, a204
v_mfma_f32_16x16x32_bf16 v[172:175], v[40:43], v[76:79], v[172:175]
ds_read_b64_tr_b16 v[98:99], v12 offset:9216
v_accvgpr_read_b32 v30, a205
v_mfma_f32_16x16x32_bf16 v[188:191], v[44:47], v[76:79], v[188:191]
s_add_u32 s72, s70, 15360
buffer_load_dwordx4 v5, s[4:7], s72 offen offset:1024 lds
v_mfma_f32_16x16x32_bf16 v[184:187], v[44:47], v[72:75], v[184:187]
ds_read_b64_tr_b16 v[100:101], v13 offset:8192
v_accvgpr_read_b32 v27, a206
v_mfma_f32_16x16x32_bf16 v[180:183], v[44:47], v[68:71], v[180:183]
ds_read_b64_tr_b16 v[102:103], v13 offset:9216
v_accvgpr_read_b32 v31, a207
v_mfma_f32_16x16x32_bf16 v[176:179], v[44:47], v[64:67], v[176:179]
ds_read_b64_tr_b16 v[104:105], v14 offset:8192
v_cvt_pk_bf16_f32 v24, v24, v28
v_mfma_f32_16x16x32_bf16 v[192:195], v[48:51], v[64:67], v[192:195]
ds_read_b64_tr_b16 v[106:107], v14 offset:9216
v_cvt_pk_bf16_f32 v25, v25, v29
v_mfma_f32_16x16x32_bf16 v[196:199], v[48:51], v[68:71], v[196:199]
s_add_u32 s72, s70, 129024
buffer_load_dwordx4 v4, s[4:7], s72 offen offset:2048 lds
v_mfma_f32_16x16x32_bf16 v[200:203], v[48:51], v[72:75], v[200:203]
ds_read_b64_tr_b16 v[108:109], v15 offset:8192
v_cvt_pk_bf16_f32 v26, v26, v30
v_mfma_f32_16x16x32_bf16 v[204:207], v[48:51], v[76:79], v[204:207]
ds_read_b64_tr_b16 v[110:111], v15 offset:9216
v_cvt_pk_bf16_f32 v27, v27, v31
v_mfma_f32_16x16x32_bf16 v[220:223], v[52:55], v[76:79], v[220:223]
buffer_store_dwordx4 v[20:23], v1, s[44:47], s80 offen sc1
v_mfma_f32_16x16x32_bf16 v[216:219], v[52:55], v[72:75], v[216:219]
s_add_u32 s80, s78, 10240
buffer_store_dwordx4 v[24:27], v1, s[44:47], s80 offen sc1
v_mfma_f32_16x16x32_bf16 v[212:215], v[52:55], v[68:71], v[212:215]
s_add_u32 s72, s70, 144384
buffer_load_dwordx4 v5, s[4:7], s72 offen offset:3072 lds
v_mfma_f32_16x16x32_bf16 v[208:211], v[52:55], v[64:67], v[208:211]
v_accvgpr_read_b32 v20, a80
v_accvgpr_read_b32 v28, a81
v_mfma_f32_16x16x32_bf16 v[224:227], v[56:59], v[64:67], v[224:227]
v_accvgpr_read_b32 v21, a82
v_accvgpr_read_b32 v29, a83
v_mfma_f32_16x16x32_bf16 v[228:231], v[56:59], v[68:71], v[228:231]
v_accvgpr_read_b32 v22, a112
v_accvgpr_read_b32 v30, a113
v_mfma_f32_16x16x32_bf16 v[232:235], v[56:59], v[72:75], v[232:235]
v_accvgpr_read_b32 v23, a114
v_accvgpr_read_b32 v31, a115
v_mfma_f32_16x16x32_bf16 v[236:239], v[56:59], v[76:79], v[236:239]
v_mul_f32 v20, s79, v20
v_mul_f32 v28, s79, v28
v_mfma_f32_16x16x32_bf16 v[252:255], v[60:63], v[76:79], v[252:255]
v_mul_f32 v21, s79, v21
v_mul_f32 v29, s79, v29
v_mfma_f32_16x16x32_bf16 v[248:251], v[60:63], v[72:75], v[248:251]
v_mul_f32 v22, s79, v22
v_mul_f32 v30, s79, v30
v_mfma_f32_16x16x32_bf16 v[244:247], v[60:63], v[68:71], v[244:247]
s_waitcnt vmcnt(17) lgkmcnt(0)
v_mul_f32 v23, s79, v23
v_mul_f32 v31, s79, v31
v_mfma_f32_16x16x32_bf16 v[240:243], v[60:63], v[64:67], v[240:243]
s_barrier
v_cvt_pk_bf16_f32 v20, v20, v28
v_cvt_pk_bf16_f32 v21, v21, v29
v_mfma_f32_16x16x32_bf16 v[128:131], v[80:83], v[112:115], v[128:131]
s_add_u32 s73, s62, 9
ds_read_b64_tr_b16 v[32:33], v8 offset:16384
ds_read_b64_tr_b16 v[34:35], v8 offset:17408
v_mfma_f32_16x16x32_bf16 v[132:135], v[80:83], v[116:119], v[132:135]
s_add_u32 s70, s73, s65
ds_read_b128 v[64:67], v18 offset:0
ds_read_b128 v[68:71], v18 offset:2048
v_mfma_f32_16x16x32_bf16 v[136:139], v[80:83], v[120:123], v[136:139]
s_and_b32 s70, s70, 3
ds_read_b128 v[72:75], v18 offset:4096
ds_read_b128 v[76:79], v18 offset:6144
v_mfma_f32_16x16x32_bf16 v[140:143], v[80:83], v[124:127], v[140:143]
s_and_b32 s73, s73, 12
ds_read_b64_tr_b16 v[36:37], v9 offset:16384
ds_read_b64_tr_b16 v[38:39], v9 offset:17408
v_mfma_f32_16x16x32_bf16 v[156:159], v[84:87], v[124:127], v[156:159]
s_or_b32 s73, s73, s70
ds_read_b64_tr_b16 v[40:41], v10 offset:16384
v_cvt_pk_bf16_f32 v22, v22, v30
v_mfma_f32_16x16x32_bf16 v[152:155], v[84:87], v[120:123], v[152:155]
s_lshl_b32 s71, s73, 19
ds_read_b64_tr_b16 v[42:43], v10 offset:17408
v_cvt_pk_bf16_f32 v23, v23, v31
v_mfma_f32_16x16x32_bf16 v[148:151], v[84:87], v[116:119], v[148:151]
s_add_u32 s71, s71, s66
ds_read_b64_tr_b16 v[44:45], v11 offset:16384
v_mfma_f32_16x16x32_bf16 v[144:147], v[84:87], v[112:115], v[144:147]
s_lshl_b32 s73, s73, 7
ds_read_b64_tr_b16 v[46:47], v11 offset:17408
v_mfma_f32_16x16x32_bf16 v[160:163], v[88:91], v[112:115], v[160:163]
s_add_u32 s69, s73, s67
ds_read_b64_tr_b16 v[48:49], v12 offset:16384
v_mfma_f32_16x16x32_bf16 v[164:167], v[88:91], v[116:119], v[164:167]
s_add_u32 s70, s73, s68
ds_read_b64_tr_b16 v[50:51], v12 offset:17408
v_mfma_f32_16x16x32_bf16 v[168:171], v[88:91], v[120:123], v[168:171]
s_add_u32 m0, s64, 0
ds_read_b64_tr_b16 v[52:53], v13 offset:16384
v_mfma_f32_16x16x32_bf16 v[172:175], v[88:91], v[124:127], v[172:175]
s_add_u32 s72, s71, 0
buffer_load_dwordx4 v6, s[12:15], s72 offen lds
v_mfma_f32_16x16x32_bf16 v[188:191], v[92:95], v[124:127], v[188:191]
s_add_u32 s72, s71, 31744
buffer_load_dwordx4 v6, s[12:15], s72 offen offset:1024 lds
v_mfma_f32_16x16x32_bf16 v[184:187], v[92:95], v[120:123], v[184:187]
s_add_u32 s72, s71, 63488
buffer_load_dwordx4 v7, s[12:15], s72 offen offset:2048 lds
v_mfma_f32_16x16x32_bf16 v[180:183], v[92:95], v[116:119], v[180:183]
s_add_u32 s72, s71, 95232
buffer_load_dwordx4 v7, s[12:15], s72 offen offset:3072 lds
v_mfma_f32_16x16x32_bf16 v[176:179], v[92:95], v[112:115], v[176:179]
s_add_u32 s80, s77, 33792
ds_read_b64_tr_b16 v[54:55], v13 offset:17408
v_accvgpr_read_b32 v24, a208
v_mfma_f32_16x16x32_bf16 v[192:195], v[96:99], v[112:115], v[192:195]
ds_read_b64_tr_b16 v[56:57], v14 offset:16384
v_accvgpr_read_b32 v28, a209
v_mfma_f32_16x16x32_bf16 v[196:199], v[96:99], v[116:119], v[196:199]
ds_read_b64_tr_b16 v[58:59], v14 offset:17408
v_accvgpr_read_b32 v25, a210
v_mfma_f32_16x16x32_bf16 v[200:203], v[96:99], v[120:123], v[200:203]
ds_read_b64_tr_b16 v[60:61], v15 offset:16384
v_accvgpr_read_b32 v29, a211
v_mfma_f32_16x16x32_bf16 v[204:207], v[96:99], v[124:127], v[204:207]
s_add_u32 m0, s63, 131072
ds_read_b64_tr_b16 v[62:63], v15 offset:17408
v_accvgpr_read_b32 v26, a212
v_mfma_f32_16x16x32_bf16 v[220:223], v[100:103], v[124:127], v[220:223]
s_add_u32 s72, s69, 0
buffer_load_dwordx4 v4, s[4:7], s72 offen lds
v_mfma_f32_16x16x32_bf16 v[216:219], v[100:103], v[120:123], v[216:219]
buffer_store_dwordx4 v[20:23], v1, s[44:47], s80 offen sc1
v_mfma_f32_16x16x32_bf16 v[212:215], v[100:103], v[116:119], v[212:215]
v_accvgpr_read_b32 v30, a213
v_accvgpr_read_b32 v27, a214
v_mfma_f32_16x16x32_bf16 v[208:211], v[100:103], v[112:115], v[208:211]
v_accvgpr_read_b32 v31, a215
v_cvt_pk_bf16_f32 v24, v24, v28
v_mfma_f32_16x16x32_bf16 v[224:227], v[104:107], v[112:115], v[224:227]
s_add_u32 s72, s69, 15360
buffer_load_dwordx4 v5, s[4:7], s72 offen offset:1024 lds
v_mfma_f32_16x16x32_bf16 v[228:231], v[104:107], v[116:119], v[228:231]
v_cvt_pk_bf16_f32 v25, v25, v29
v_cvt_pk_bf16_f32 v26, v26, v30
v_mfma_f32_16x16x32_bf16 v[232:235], v[104:107], v[120:123], v[232:235]
v_cvt_pk_bf16_f32 v27, v27, v31
v_mfma_f32_16x16x32_bf16 v[236:239], v[104:107], v[124:127], v[236:239]
s_add_u32 s80, s78, 34816
buffer_store_dwordx4 v[24:27], v1, s[44:47], s80 offen sc1
v_mfma_f32_16x16x32_bf16 v[252:255], v[108:111], v[124:127], v[252:255]
v_mfma_f32_16x16x32_bf16 v[248:251], v[108:111], v[120:123], v[248:251]
s_add_u32 s72, s69, 129024
buffer_load_dwordx4 v4, s[4:7], s72 offen offset:2048 lds
v_mfma_f32_16x16x32_bf16 v[244:247], v[108:111], v[116:119], v[244:247]
v_mfma_f32_16x16x32_bf16 v[240:243], v[108:111], v[112:115], v[240:243]
s_waitcnt lgkmcnt(0)
v_mfma_f32_16x16x32_bf16 v[128:131], v[32:35], v[64:67], v[128:131]
ds_read_b64_tr_b16 v[80:81], v8 offset:24576
ds_read_b64_tr_b16 v[82:83], v8 offset:25600
v_mfma_f32_16x16x32_bf16 v[132:135], v[32:35], v[68:71], v[132:135]
ds_read_b128 v[112:115], v19 offset:0
ds_read_b128 v[116:119], v19 offset:2048
v_mfma_f32_16x16x32_bf16 v[136:139], v[32:35], v[72:75], v[136:139]
s_add_u32 s72, s69, 144384
buffer_load_dwordx4 v5, s[4:7], s72 offen offset:3072 lds
v_mfma_f32_16x16x32_bf16 v[140:143], v[32:35], v[76:79], v[140:143]
ds_read_b128 v[120:123], v19 offset:4096
ds_read_b128 v[124:127], v19 offset:6144
v_mfma_f32_16x16x32_bf16 v[156:159], v[36:39], v[76:79], v[156:159]
ds_read_b64_tr_b16 v[84:85], v9 offset:24576
ds_read_b64_tr_b16 v[86:87], v9 offset:25600
v_mfma_f32_16x16x32_bf16 v[152:155], v[36:39], v[72:75], v[152:155]
ds_read_b64_tr_b16 v[88:89], v10 offset:24576
v_accvgpr_read_b32 v20, a84
v_mfma_f32_16x16x32_bf16 v[148:151], v[36:39], v[68:71], v[148:151]
ds_read_b64_tr_b16 v[90:91], v10 offset:25600
v_accvgpr_read_b32 v28, a85
v_mfma_f32_16x16x32_bf16 v[144:147], v[36:39], v[64:67], v[144:147]
s_add_u32 m0, s63, 135168
ds_read_b64_tr_b16 v[92:93], v11 offset:24576
v_accvgpr_read_b32 v21, a86
v_mfma_f32_16x16x32_bf16 v[160:163], v[40:43], v[64:67], v[160:163]
s_add_u32 s72, s70, 0
buffer_load_dwordx4 v4, s[4:7], s72 offen lds
v_mfma_f32_16x16x32_bf16 v[164:167], v[40:43], v[68:71], v[164:167]
ds_read_b64_tr_b16 v[94:95], v11 offset:25600
v_accvgpr_read_b32 v29, a87
v_mfma_f32_16x16x32_bf16 v[168:171], v[40:43], v[72:75], v[168:171]
ds_read_b64_tr_b16 v[96:97], v12 offset:24576
v_accvgpr_read_b32 v22, a116
v_mfma_f32_16x16x32_bf16 v[172:175], v[40:43], v[76:79], v[172:175]
ds_read_b64_tr_b16 v[98:99], v12 offset:25600
v_accvgpr_read_b32 v30, a117
v_mfma_f32_16x16x32_bf16 v[188:191], v[44:47], v[76:79], v[188:191]
s_add_u32 s72, s70, 15360
buffer_load_dwordx4 v5, s[4:7], s72 offen offset:1024 lds
v_mfma_f32_16x16x32_bf16 v[184:187], v[44:47], v[72:75], v[184:187]
ds_read_b64_tr_b16 v[100:101], v13 offset:24576
v_accvgpr_read_b32 v23, a118
v_mfma_f32_16x16x32_bf16 v[180:183], v[44:47], v[68:71], v[180:183]
ds_read_b64_tr_b16 v[102:103], v13 offset:25600
v_accvgpr_read_b32 v31, a119
v_mfma_f32_16x16x32_bf16 v[176:179], v[44:47], v[64:67], v[176:179]
ds_read_b64_tr_b16 v[104:105], v14 offset:24576
v_mul_f32 v20, s79, v20
v_mfma_f32_16x16x32_bf16 v[192:195], v[48:51], v[64:67], v[192:195]
ds_read_b64_tr_b16 v[106:107], v14 offset:25600
v_mul_f32 v28, s79, v28
v_mfma_f32_16x16x32_bf16 v[196:199], v[48:51], v[68:71], v[196:199]
s_add_u32 s72, s70, 129024
buffer_load_dwordx4 v4, s[4:7], s72 offen offset:2048 lds
v_mfma_f32_16x16x32_bf16 v[200:203], v[48:51], v[72:75], v[200:203]
ds_read_b64_tr_b16 v[108:109], v15 offset:24576
v_mul_f32 v21, s79, v21
v_mfma_f32_16x16x32_bf16 v[204:207], v[48:51], v[76:79], v[204:207]
ds_read_b64_tr_b16 v[110:111], v15 offset:25600
v_mul_f32 v29, s79, v29
v_mfma_f32_16x16x32_bf16 v[220:223], v[52:55], v[76:79], v[220:223]
v_mul_f32 v22, s79, v22
v_mul_f32 v30, s79, v30
v_mfma_f32_16x16x32_bf16 v[216:219], v[52:55], v[72:75], v[216:219]
v_mul_f32 v23, s79, v23
v_mul_f32 v31, s79, v31
v_mfma_f32_16x16x32_bf16 v[212:215], v[52:55], v[68:71], v[212:215]
s_add_u32 s72, s70, 144384
buffer_load_dwordx4 v5, s[4:7], s72 offen offset:3072 lds
v_mfma_f32_16x16x32_bf16 v[208:211], v[52:55], v[64:67], v[208:211]
v_cvt_pk_bf16_f32 v20, v20, v28
v_cvt_pk_bf16_f32 v21, v21, v29
v_mfma_f32_16x16x32_bf16 v[224:227], v[56:59], v[64:67], v[224:227]
v_cvt_pk_bf16_f32 v22, v22, v30
v_cvt_pk_bf16_f32 v23, v23, v31
v_mfma_f32_16x16x32_bf16 v[228:231], v[56:59], v[68:71], v[228:231]
s_add_u32 s80, s77, 37888
buffer_store_dwordx4 v[20:23], v1, s[44:47], s80 offen sc1
v_mfma_f32_16x16x32_bf16 v[232:235], v[56:59], v[72:75], v[232:235]
v_accvgpr_read_b32 v24, a216
v_accvgpr_read_b32 v28, a217
v_mfma_f32_16x16x32_bf16 v[236:239], v[56:59], v[76:79], v[236:239]
v_accvgpr_read_b32 v25, a218
v_accvgpr_read_b32 v29, a219
v_mfma_f32_16x16x32_bf16 v[252:255], v[60:63], v[76:79], v[252:255]
v_accvgpr_read_b32 v26, a220
v_accvgpr_read_b32 v30, a221
v_mfma_f32_16x16x32_bf16 v[248:251], v[60:63], v[72:75], v[248:251]
v_accvgpr_read_b32 v27, a222
v_accvgpr_read_b32 v31, a223
v_mfma_f32_16x16x32_bf16 v[244:247], v[60:63], v[68:71], v[244:247]
s_waitcnt vmcnt(15) lgkmcnt(0)
v_cvt_pk_bf16_f32 v24, v24, v28
v_cvt_pk_bf16_f32 v25, v25, v29
v_mfma_f32_16x16x32_bf16 v[240:243], v[60:63], v[64:67], v[240:243]
s_barrier
v_cvt_pk_bf16_f32 v26, v26, v30
v_cvt_pk_bf16_f32 v27, v27, v31
v_mfma_f32_16x16x32_bf16 v[128:131], v[80:83], v[112:115], v[128:131]
s_add_u32 s73, s62, 10
ds_read_b64_tr_b16 v[32:33], v8 offset:32768
ds_read_b64_tr_b16 v[34:35], v8 offset:33792
v_mfma_f32_16x16x32_bf16 v[132:135], v[80:83], v[116:119], v[132:135]
s_add_u32 s70, s73, s65
ds_read_b128 v[64:67], v18 offset:32768
ds_read_b128 v[68:71], v18 offset:34816
v_mfma_f32_16x16x32_bf16 v[136:139], v[80:83], v[120:123], v[136:139]
s_and_b32 s70, s70, 3
ds_read_b128 v[72:75], v18 offset:36864
ds_read_b128 v[76:79], v18 offset:38912
v_mfma_f32_16x16x32_bf16 v[140:143], v[80:83], v[124:127], v[140:143]
s_and_b32 s73, s73, 12
ds_read_b64_tr_b16 v[36:37], v9 offset:32768
ds_read_b64_tr_b16 v[38:39], v9 offset:33792
v_mfma_f32_16x16x32_bf16 v[156:159], v[84:87], v[124:127], v[156:159]
s_or_b32 s73, s73, s70
ds_read_b64_tr_b16 v[40:41], v10 offset:32768
v_mfma_f32_16x16x32_bf16 v[152:155], v[84:87], v[120:123], v[152:155]
s_lshl_b32 s71, s73, 19
ds_read_b64_tr_b16 v[42:43], v10 offset:33792
v_mfma_f32_16x16x32_bf16 v[148:151], v[84:87], v[116:119], v[148:151]
s_add_u32 s71, s71, s66
ds_read_b64_tr_b16 v[44:45], v11 offset:32768
v_mfma_f32_16x16x32_bf16 v[144:147], v[84:87], v[112:115], v[144:147]
s_lshl_b32 s73, s73, 7
ds_read_b64_tr_b16 v[46:47], v11 offset:33792
v_mfma_f32_16x16x32_bf16 v[160:163], v[88:91], v[112:115], v[160:163]
s_add_u32 s69, s73, s67
ds_read_b64_tr_b16 v[48:49], v12 offset:32768
v_accvgpr_read_b32 v20, a88
v_mfma_f32_16x16x32_bf16 v[164:167], v[88:91], v[116:119], v[164:167]
s_add_u32 s70, s73, s68
ds_read_b64_tr_b16 v[50:51], v12 offset:33792
v_accvgpr_read_b32 v28, a89
v_mfma_f32_16x16x32_bf16 v[168:171], v[88:91], v[120:123], v[168:171]
s_add_u32 m0, s64, 16384
ds_read_b64_tr_b16 v[52:53], v13 offset:32768
v_accvgpr_read_b32 v21, a90
v_mfma_f32_16x16x32_bf16 v[172:175], v[88:91], v[124:127], v[172:175]
s_add_u32 s72, s71, 0
buffer_load_dwordx4 v6, s[12:15], s72 offen lds
v_mfma_f32_16x16x32_bf16 v[188:191], v[92:95], v[124:127], v[188:191]
s_add_u32 s72, s71, 31744
buffer_load_dwordx4 v6, s[12:15], s72 offen offset:1024 lds
v_mfma_f32_16x16x32_bf16 v[184:187], v[92:95], v[120:123], v[184:187]
s_add_u32 s72, s71, 63488
buffer_load_dwordx4 v7, s[12:15], s72 offen offset:2048 lds
v_mfma_f32_16x16x32_bf16 v[180:183], v[92:95], v[116:119], v[180:183]
s_add_u32 s72, s71, 95232
buffer_load_dwordx4 v7, s[12:15], s72 offen offset:3072 lds
v_mfma_f32_16x16x32_bf16 v[176:179], v[92:95], v[112:115], v[176:179]
s_add_u32 s80, s78, 43008
ds_read_b64_tr_b16 v[54:55], v13 offset:33792
v_accvgpr_read_b32 v29, a91
v_mfma_f32_16x16x32_bf16 v[192:195], v[96:99], v[112:115], v[192:195]
ds_read_b64_tr_b16 v[56:57], v14 offset:32768
v_accvgpr_read_b32 v22, a120
v_mfma_f32_16x16x32_bf16 v[196:199], v[96:99], v[116:119], v[196:199]
ds_read_b64_tr_b16 v[58:59], v14 offset:33792
v_accvgpr_read_b32 v30, a121
v_mfma_f32_16x16x32_bf16 v[200:203], v[96:99], v[120:123], v[200:203]
ds_read_b64_tr_b16 v[60:61], v15 offset:32768
v_accvgpr_read_b32 v23, a122
v_mfma_f32_16x16x32_bf16 v[204:207], v[96:99], v[124:127], v[204:207]
s_add_u32 m0, s63, 65536
ds_read_b64_tr_b16 v[62:63], v15 offset:33792
v_accvgpr_read_b32 v31, a123
v_mfma_f32_16x16x32_bf16 v[220:223], v[100:103], v[124:127], v[220:223]
s_add_u32 s72, s69, 0
buffer_load_dwordx4 v4, s[4:7], s72 offen lds
v_mfma_f32_16x16x32_bf16 v[216:219], v[100:103], v[120:123], v[216:219]
buffer_store_dwordx4 v[24:27], v1, s[44:47], s80 offen sc1
v_mfma_f32_16x16x32_bf16 v[212:215], v[100:103], v[116:119], v[212:215]
v_mul_f32 v20, s79, v20
v_mul_f32 v28, s79, v28
v_mfma_f32_16x16x32_bf16 v[208:211], v[100:103], v[112:115], v[208:211]
v_mul_f32 v21, s79, v21
v_mul_f32 v29, s79, v29
v_mfma_f32_16x16x32_bf16 v[224:227], v[104:107], v[112:115], v[224:227]
s_add_u32 s72, s69, 15360
buffer_load_dwordx4 v5, s[4:7], s72 offen offset:1024 lds
v_mfma_f32_16x16x32_bf16 v[228:231], v[104:107], v[116:119], v[228:231]
v_mul_f32 v22, s79, v22
v_mul_f32 v30, s79, v30
v_mfma_f32_16x16x32_bf16 v[232:235], v[104:107], v[120:123], v[232:235]
v_mul_f32 v23, s79, v23
v_mul_f32 v31, s79, v31
v_mfma_f32_16x16x32_bf16 v[236:239], v[104:107], v[124:127], v[236:239]
v_cvt_pk_bf16_f32 v20, v20, v28
v_cvt_pk_bf16_f32 v21, v21, v29
v_mfma_f32_16x16x32_bf16 v[252:255], v[108:111], v[124:127], v[252:255]
v_cvt_pk_bf16_f32 v22, v22, v30
v_cvt_pk_bf16_f32 v23, v23, v31
v_mfma_f32_16x16x32_bf16 v[248:251], v[108:111], v[120:123], v[248:251]
s_add_u32 s72, s69, 129024
buffer_load_dwordx4 v4, s[4:7], s72 offen offset:2048 lds
v_mfma_f32_16x16x32_bf16 v[244:247], v[108:111], v[116:119], v[244:247]
s_add_u32 s80, s77, 41984
buffer_store_dwordx4 v[20:23], v1, s[44:47], s80 offen sc1
v_mfma_f32_16x16x32_bf16 v[240:243], v[108:111], v[112:115], v[240:243]
s_waitcnt lgkmcnt(0)
v_accvgpr_read_b32 v24, a224
v_accvgpr_read_b32 v28, a225
LcB1:
v_mfma_f32_16x16x32_bf16 v[128:131], v[32:35], v[64:67], v[128:131]
ds_read_b64_tr_b16 v[80:81], v8 offset:40960
ds_read_b64_tr_b16 v[82:83], v8 offset:41984
v_mfma_f32_16x16x32_bf16 v[132:135], v[32:35], v[68:71], v[132:135]
ds_read_b128 v[112:115], v19 offset:32768
ds_read_b128 v[116:119], v19 offset:34816
v_mfma_f32_16x16x32_bf16 v[136:139], v[32:35], v[72:75], v[136:139]
s_add_u32 s72, s69, 144384
buffer_load_dwordx4 v5, s[4:7], s72 offen offset:3072 lds
v_mfma_f32_16x16x32_bf16 v[140:143], v[32:35], v[76:79], v[140:143]
ds_read_b128 v[120:123], v19 offset:36864
ds_read_b128 v[124:127], v19 offset:38912
v_mfma_f32_16x16x32_bf16 v[156:159], v[36:39], v[76:79], v[156:159]
ds_read_b64_tr_b16 v[84:85], v9 offset:40960
ds_read_b64_tr_b16 v[86:87], v9 offset:41984
v_mfma_f32_16x16x32_bf16 v[152:155], v[36:39], v[72:75], v[152:155]
ds_read_b64_tr_b16 v[88:89], v10 offset:40960
v_accvgpr_read_b32 v25, a226
v_mfma_f32_16x16x32_bf16 v[148:151], v[36:39], v[68:71], v[148:151]
ds_read_b64_tr_b16 v[90:91], v10 offset:41984
v_accvgpr_read_b32 v29, a227
v_mfma_f32_16x16x32_bf16 v[144:147], v[36:39], v[64:67], v[144:147]
s_add_u32 m0, s63, 69632
ds_read_b64_tr_b16 v[92:93], v11 offset:40960
v_accvgpr_read_b32 v26, a228
v_mfma_f32_16x16x32_bf16 v[160:163], v[40:43], v[64:67], v[160:163]
s_add_u32 s72, s70, 0
buffer_load_dwordx4 v4, s[4:7], s72 offen lds
v_mfma_f32_16x16x32_bf16 v[164:167], v[40:43], v[68:71], v[164:167]
ds_read_b64_tr_b16 v[94:95], v11 offset:41984
v_accvgpr_read_b32 v30, a229
v_mfma_f32_16x16x32_bf16 v[168:171], v[40:43], v[72:75], v[168:171]
ds_read_b64_tr_b16 v[96:97], v12 offset:40960
v_accvgpr_read_b32 v27, a230
v_mfma_f32_16x16x32_bf16 v[172:175], v[40:43], v[76:79], v[172:175]
ds_read_b64_tr_b16 v[98:99], v12 offset:41984
v_accvgpr_read_b32 v31, a231
v_mfma_f32_16x16x32_bf16 v[188:191], v[44:47], v[76:79], v[188:191]
s_add_u32 s72, s70, 15360
buffer_load_dwordx4 v5, s[4:7], s72 offen offset:1024 lds
v_mfma_f32_16x16x32_bf16 v[184:187], v[44:47], v[72:75], v[184:187]
ds_read_b64_tr_b16 v[100:101], v13 offset:40960
v_cvt_pk_bf16_f32 v24, v24, v28
v_mfma_f32_16x16x32_bf16 v[180:183], v[44:47], v[68:71], v[180:183]
ds_read_b64_tr_b16 v[102:103], v13 offset:41984
v_cvt_pk_bf16_f32 v25, v25, v29
v_mfma_f32_16x16x32_bf16 v[176:179], v[44:47], v[64:67], v[176:179]
ds_read_b64_tr_b16 v[104:105], v14 offset:40960
v_cvt_pk_bf16_f32 v26, v26, v30
v_mfma_f32_16x16x32_bf16 v[192:195], v[48:51], v[64:67], v[192:195]
ds_read_b64_tr_b16 v[106:107], v14 offset:41984
v_cvt_pk_bf16_f32 v27, v27, v31
v_mfma_f32_16x16x32_bf16 v[196:199], v[48:51], v[68:71], v[196:199]
s_add_u32 s72, s70, 129024
buffer_load_dwordx4 v4, s[4:7], s72 offen offset:2048 lds
v_mfma_f32_16x16x32_bf16 v[200:203], v[48:51], v[72:75], v[200:203]
s_add_u32 s80, s78, 3072
ds_read_b64_tr_b16 v[108:109], v15 offset:40960
v_accvgpr_read_b32 v20, a92
v_mfma_f32_16x16x32_bf16 v[204:207], v[48:51], v[76:79], v[204:207]
ds_read_b64_tr_b16 v[110:111], v15 offset:41984
v_accvgpr_read_b32 v28, a93
v_mfma_f32_16x16x32_bf16 v[220:223], v[52:55], v[76:79], v[220:223]
buffer_store_dwordx4 v[24:27], v1, s[44:47], s80 offen sc1
v_mfma_f32_16x16x32_bf16 v[216:219], v[52:55], v[72:75], v[216:219]
v_accvgpr_read_b32 v21, a94
v_accvgpr_read_b32 v29, a95
v_mfma_f32_16x16x32_bf16 v[212:215], v[52:55], v[68:71], v[212:215]
s_add_u32 s72, s70, 144384
buffer_load_dwordx4 v5, s[4:7], s72 offen offset:3072 lds
v_mfma_f32_16x16x32_bf16 v[208:211], v[52:55], v[64:67], v[208:211]
v_accvgpr_read_b32 v22, a124
v_accvgpr_read_b32 v30, a125
v_mfma_f32_16x16x32_bf16 v[224:227], v[56:59], v[64:67], v[224:227]
v_accvgpr_read_b32 v23, a126
v_accvgpr_read_b32 v31, a127
v_mfma_f32_16x16x32_bf16 v[228:231], v[56:59], v[68:71], v[228:231]
v_mul_f32 v20, s79, v20
v_mul_f32 v28, s79, v28
v_mfma_f32_16x16x32_bf16 v[232:235], v[56:59], v[72:75], v[232:235]
v_mul_f32 v21, s79, v21
v_mul_f32 v29, s79, v29
v_mfma_f32_16x16x32_bf16 v[236:239], v[56:59], v[76:79], v[236:239]
v_mul_f32 v22, s79, v22
v_mul_f32 v30, s79, v30
v_mfma_f32_16x16x32_bf16 v[252:255], v[60:63], v[76:79], v[252:255]
v_mul_f32 v23, s79, v23
v_mul_f32 v31, s79, v31
v_mfma_f32_16x16x32_bf16 v[248:251], v[60:63], v[72:75], v[248:251]
v_cvt_pk_bf16_f32 v20, v20, v28
v_cvt_pk_bf16_f32 v21, v21, v29
v_mfma_f32_16x16x32_bf16 v[244:247], v[60:63], v[68:71], v[244:247]
s_waitcnt vmcnt(16) lgkmcnt(0)
v_cvt_pk_bf16_f32 v22, v22, v30
v_cvt_pk_bf16_f32 v23, v23, v31
v_mfma_f32_16x16x32_bf16 v[240:243], v[60:63], v[64:67], v[240:243]
s_barrier
v_mfma_f32_16x16x32_bf16 v[128:131], v[80:83], v[112:115], v[128:131]
s_add_u32 s73, s62, 11
ds_read_b64_tr_b16 v[32:33], v8 offset:0
ds_read_b64_tr_b16 v[34:35], v8 offset:1024
v_mfma_f32_16x16x32_bf16 v[132:135], v[80:83], v[116:119], v[132:135]
s_add_u32 s70, s73, s65
ds_read_b128 v[64:67], v16 offset:0
ds_read_b128 v[68:71], v16 offset:2048
v_mfma_f32_16x16x32_bf16 v[136:139], v[80:83], v[120:123], v[136:139]
s_and_b32 s70, s70, 3
ds_read_b128 v[72:75], v16 offset:4096
ds_read_b128 v[76:79], v16 offset:6144
v_mfma_f32_16x16x32_bf16 v[140:143], v[80:83], v[124:127], v[140:143]
s_and_b32 s73, s73, 12
ds_read_b64_tr_b16 v[36:37], v9 offset:0
ds_read_b64_tr_b16 v[38:39], v9 offset:1024
v_mfma_f32_16x16x32_bf16 v[156:159], v[84:87], v[124:127], v[156:159]
s_or_b32 s73, s73, s70
ds_read_b64_tr_b16 v[40:41], v10 offset:0
v_mfma_f32_16x16x32_bf16 v[152:155], v[84:87], v[120:123], v[152:155]
s_lshl_b32 s71, s73, 19
ds_read_b64_tr_b16 v[42:43], v10 offset:1024
v_accvgpr_read_b32 v24, a232
v_mfma_f32_16x16x32_bf16 v[148:151], v[84:87], v[116:119], v[148:151]
s_add_u32 s71, s71, s66
ds_read_b64_tr_b16 v[44:45], v11 offset:0
v_accvgpr_read_b32 v28, a233
v_mfma_f32_16x16x32_bf16 v[144:147], v[84:87], v[112:115], v[144:147]
s_lshl_b32 s73, s73, 7
ds_read_b64_tr_b16 v[46:47], v11 offset:1024
v_accvgpr_read_b32 v25, a234
v_mfma_f32_16x16x32_bf16 v[160:163], v[88:91], v[112:115], v[160:163]
s_add_u32 s69, s73, s67
ds_read_b64_tr_b16 v[48:49], v12 offset:0
v_accvgpr_read_b32 v29, a235
v_mfma_f32_16x16x32_bf16 v[164:167], v[88:91], v[116:119], v[164:167]
s_add_u32 s70, s73, s68
ds_read_b64_tr_b16 v[50:51], v12 offset:1024
v_accvgpr_read_b32 v26, a236
v_mfma_f32_16x16x32_bf16 v[168:171], v[88:91], v[120:123], v[168:171]
s_add_u32 m0, s64, 32768
ds_read_b64_tr_b16 v[52:53], v13 offset:0
v_accvgpr_read_b32 v30, a237
v_mfma_f32_16x16x32_bf16 v[172:175], v[88:91], v[124:127], v[172:175]
s_add_u32 s72, s71, 0
buffer_load_dwordx4 v6, s[12:15], s72 offen lds
v_mfma_f32_16x16x32_bf16 v[188:191], v[92:95], v[124:127], v[188:191]
s_add_u32 s72, s71, 31744
buffer_load_dwordx4 v6, s[12:15], s72 offen offset:1024 lds
v_mfma_f32_16x16x32_bf16 v[184:187], v[92:95], v[120:123], v[184:187]
s_add_u32 s72, s71, 63488
buffer_load_dwordx4 v7, s[12:15], s72 offen offset:2048 lds
v_mfma_f32_16x16x32_bf16 v[180:183], v[92:95], v[116:119], v[180:183]
s_add_u32 s72, s71, 95232
buffer_load_dwordx4 v7, s[12:15], s72 offen offset:3072 lds
v_mfma_f32_16x16x32_bf16 v[176:179], v[92:95], v[112:115], v[176:179]
s_add_u32 s80, s77, 46080
ds_read_b64_tr_b16 v[54:55], v13 offset:1024
v_accvgpr_read_b32 v27, a238
v_mfma_f32_16x16x32_bf16 v[192:195], v[96:99], v[112:115], v[192:195]
ds_read_b64_tr_b16 v[56:57], v14 offset:0
v_accvgpr_read_b32 v31, a239
v_mfma_f32_16x16x32_bf16 v[196:199], v[96:99], v[116:119], v[196:199]
ds_read_b64_tr_b16 v[58:59], v14 offset:1024
v_cvt_pk_bf16_f32 v24, v24, v28
v_mfma_f32_16x16x32_bf16 v[200:203], v[96:99], v[120:123], v[200:203]
ds_read_b64_tr_b16 v[60:61], v15 offset:0
v_cvt_pk_bf16_f32 v25, v25, v29
v_mfma_f32_16x16x32_bf16 v[204:207], v[96:99], v[124:127], v[204:207]
s_add_u32 m0, s63, 98304
ds_read_b64_tr_b16 v[62:63], v15 offset:1024
v_cvt_pk_bf16_f32 v26, v26, v30
v_mfma_f32_16x16x32_bf16 v[220:223], v[100:103], v[124:127], v[220:223]
s_add_u32 s72, s69, 0
buffer_load_dwordx4 v4, s[4:7], s72 offen lds
v_mfma_f32_16x16x32_bf16 v[216:219], v[100:103], v[120:123], v[216:219]
buffer_store_dwordx4 v[20:23], v1, s[44:47], s80 offen sc1
v_mfma_f32_16x16x32_bf16 v[212:215], v[100:103], v[116:119], v[212:215]
v_cvt_pk_bf16_f32 v27, v27, v31
v_mfma_f32_16x16x32_bf16 v[208:211], v[100:103], v[112:115], v[208:211]
s_add_u32 s80, s78, 11264
buffer_store_dwordx4 v[24:27], v1, s[44:47], s80 offen sc1
v_mfma_f32_16x16x32_bf16 v[224:227], v[104:107], v[112:115], v[224:227]
s_add_u32 s72, s69, 15360
buffer_load_dwordx4 v5, s[4:7], s72 offen offset:1024 lds
v_mfma_f32_16x16x32_bf16 v[228:231], v[104:107], v[116:119], v[228:231]
v_accvgpr_read_b32 v20, a240
v_accvgpr_read_b32 v28, a241
v_mfma_f32_16x16x32_bf16 v[232:235], v[104:107], v[120:123], v[232:235]
v_accvgpr_read_b32 v21, a242
v_accvgpr_read_b32 v29, a243
v_mfma_f32_16x16x32_bf16 v[236:239], v[104:107], v[124:127], v[236:239]
v_accvgpr_read_b32 v22, a244
v_accvgpr_read_b32 v30, a245
v_mfma_f32_16x16x32_bf16 v[252:255], v[108:111], v[124:127], v[252:255]
v_accvgpr_read_b32 v23, a246
v_accvgpr_read_b32 v31, a247
v_mfma_f32_16x16x32_bf16 v[248:251], v[108:111], v[120:123], v[248:251]
s_add_u32 s72, s69, 129024
buffer_load_dwordx4 v4, s[4:7], s72 offen offset:2048 lds
v_mfma_f32_16x16x32_bf16 v[244:247], v[108:111], v[116:119], v[244:247]
v_cvt_pk_bf16_f32 v20, v20, v28
v_cvt_pk_bf16_f32 v21, v21, v29
v_mfma_f32_16x16x32_bf16 v[240:243], v[108:111], v[112:115], v[240:243]
s_waitcnt lgkmcnt(0)
v_cvt_pk_bf16_f32 v22, v22, v30
v_cvt_pk_bf16_f32 v23, v23, v31
v_mfma_f32_16x16x32_bf16 v[128:131], v[32:35], v[64:67], v[128:131]
s_add_u32 s80, s78, 35840
ds_read_b64_tr_b16 v[80:81], v8 offset:8192
ds_read_b64_tr_b16 v[82:83], v8 offset:9216
v_mfma_f32_16x16x32_bf16 v[132:135], v[32:35], v[68:71], v[132:135]
ds_read_b128 v[112:115], v17 offset:0
ds_read_b128 v[116:119], v17 offset:2048
v_mfma_f32_16x16x32_bf16 v[136:139], v[32:35], v[72:75], v[136:139]
s_add_u32 s72, s69, 144384
buffer_load_dwordx4 v5, s[4:7], s72 offen offset:3072 lds
v_mfma_f32_16x16x32_bf16 v[140:143], v[32:35], v[76:79], v[140:143]
ds_read_b128 v[120:123], v17 offset:4096
ds_read_b128 v[124:127], v17 offset:6144
v_mfma_f32_16x16x32_bf16 v[156:159], v[36:39], v[76:79], v[156:159]
ds_read_b64_tr_b16 v[84:85], v9 offset:8192
ds_read_b64_tr_b16 v[86:87], v9 offset:9216
v_mfma_f32_16x16x32_bf16 v[152:155], v[36:39], v[72:75], v[152:155]
ds_read_b64_tr_b16 v[88:89], v10 offset:8192
v_mfma_f32_16x16x32_bf16 v[148:151], v[36:39], v[68:71], v[148:151]
ds_read_b64_tr_b16 v[90:91], v10 offset:9216
v_mfma_f32_16x16x32_bf16 v[144:147], v[36:39], v[64:67], v[144:147]
s_add_u32 m0, s63, 102400
ds_read_b64_tr_b16 v[92:93], v11 offset:8192
v_mfma_f32_16x16x32_bf16 v[160:163], v[40:43], v[64:67], v[160:163]
s_add_u32 s72, s70, 0
buffer_load_dwordx4 v4, s[4:7], s72 offen lds
v_mfma_f32_16x16x32_bf16 v[164:167], v[40:43], v[68:71], v[164:167]
ds_read_b64_tr_b16 v[94:95], v11 offset:9216
v_mfma_f32_16x16x32_bf16 v[168:171], v[40:43], v[72:75], v[168:171]
ds_read_b64_tr_b16 v[96:97], v12 offset:8192
v_mfma_f32_16x16x32_bf16 v[172:175], v[40:43], v[76:79], v[172:175]
ds_read_b64_tr_b16 v[98:99], v12 offset:9216
v_mfma_f32_16x16x32_bf16 v[188:191], v[44:47], v[76:79], v[188:191]
s_add_u32 s72, s70, 15360
buffer_load_dwordx4 v5, s[4:7], s72 offen offset:1024 lds
v_mfma_f32_16x16x32_bf16 v[184:187], v[44:47], v[72:75], v[184:187]
ds_read_b64_tr_b16 v[100:101], v13 offset:8192
v_accvgpr_read_b32 v24, a248
v_mfma_f32_16x16x32_bf16 v[180:183], v[44:47], v[68:71], v[180:183]
ds_read_b64_tr_b16 v[102:103], v13 offset:9216
v_accvgpr_read_b32 v28, a249
v_mfma_f32_16x16x32_bf16 v[176:179], v[44:47], v[64:67], v[176:179]
ds_read_b64_tr_b16 v[104:105], v14 offset:8192
v_accvgpr_read_b32 v25, a250
v_mfma_f32_16x16x32_bf16 v[192:195], v[48:51], v[64:67], v[192:195]
ds_read_b64_tr_b16 v[106:107], v14 offset:9216
v_accvgpr_read_b32 v29, a251
v_mfma_f32_16x16x32_bf16 v[196:199], v[48:51], v[68:71], v[196:199]
s_add_u32 s72, s70, 129024
buffer_load_dwordx4 v4, s[4:7], s72 offen offset:2048 lds
v_mfma_f32_16x16x32_bf16 v[200:203], v[48:51], v[72:75], v[200:203]
ds_read_b64_tr_b16 v[108:109], v15 offset:8192
v_accvgpr_read_b32 v26, a252
v_mfma_f32_16x16x32_bf16 v[204:207], v[48:51], v[76:79], v[204:207]
ds_read_b64_tr_b16 v[110:111], v15 offset:9216
v_accvgpr_read_b32 v30, a253
v_mfma_f32_16x16x32_bf16 v[220:223], v[52:55], v[76:79], v[220:223]
buffer_store_dwordx4 v[20:23], v1, s[44:47], s80 offen sc1
v_mfma_f32_16x16x32_bf16 v[216:219], v[52:55], v[72:75], v[216:219]
v_accvgpr_read_b32 v27, a254
v_accvgpr_read_b32 v31, a255
v_mfma_f32_16x16x32_bf16 v[212:215], v[52:55], v[68:71], v[212:215]
s_add_u32 s72, s70, 144384
buffer_load_dwordx4 v5, s[4:7], s72 offen offset:3072 lds
v_mfma_f32_16x16x32_bf16 v[208:211], v[52:55], v[64:67], v[208:211]
v_cvt_pk_bf16_f32 v24, v24, v28
v_cvt_pk_bf16_f32 v25, v25, v29
v_mfma_f32_16x16x32_bf16 v[224:227], v[56:59], v[64:67], v[224:227]
v_cvt_pk_bf16_f32 v26, v26, v30
v_cvt_pk_bf16_f32 v27, v27, v31
v_mfma_f32_16x16x32_bf16 v[228:231], v[56:59], v[68:71], v[228:231]
s_add_u32 s80, s78, 44032
buffer_store_dwordx4 v[24:27], v1, s[44:47], s80 offen sc1
v_mfma_f32_16x16x32_bf16 v[232:235], v[56:59], v[72:75], v[232:235]
v_mfma_f32_16x16x32_bf16 v[236:239], v[56:59], v[76:79], v[236:239]
v_mfma_f32_16x16x32_bf16 v[252:255], v[60:63], v[76:79], v[252:255]
v_mfma_f32_16x16x32_bf16 v[248:251], v[60:63], v[72:75], v[248:251]
v_mfma_f32_16x16x32_bf16 v[244:247], v[60:63], v[68:71], v[244:247]
s_waitcnt vmcnt(16) lgkmcnt(0)
v_mfma_f32_16x16x32_bf16 v[240:243], v[60:63], v[64:67], v[240:243]
s_barrier
v_mfma_f32_16x16x32_bf16 v[128:131], v[80:83], v[112:115], v[128:131]
s_add_u32 s73, s62, 12
ds_read_b64_tr_b16 v[32:33], v8 offset:16384
ds_read_b64_tr_b16 v[34:35], v8 offset:17408
v_mfma_f32_16x16x32_bf16 v[132:135], v[80:83], v[116:119], v[132:135]
s_add_u32 s70, s73, s65
ds_read_b128 v[64:67], v18 offset:0
ds_read_b128 v[68:71], v18 offset:2048
v_mfma_f32_16x16x32_bf16 v[136:139], v[80:83], v[120:123], v[136:139]
s_and_b32 s70, s70, 3
v_and_b32 v2, 31, v0
v_lshlrev_b32 v2, 2, v2
v_mfma_f32_16x16x32_bf16 v[140:143], v[80:83], v[124:127], v[140:143]
s_and_b32 s73, s73, 12
buffer_load_dword v3, v2, s[48:51], 0 offen sc1
v_mfma_f32_16x16x32_bf16 v[156:159], v[84:87], v[124:127], v[156:159]
s_or_b32 s73, s73, s70
ds_read_b128 v[72:75], v18 offset:4096
ds_read_b128 v[76:79], v18 offset:6144
v_mfma_f32_16x16x32_bf16 v[152:155], v[84:87], v[120:123], v[152:155]
s_lshl_b32 s71, s73, 19
ds_read_b64_tr_b16 v[36:37], v9 offset:16384
ds_read_b64_tr_b16 v[38:39], v9 offset:17408
v_mfma_f32_16x16x32_bf16 v[148:151], v[84:87], v[116:119], v[148:151]
s_add_u32 s71, s71, s66
ds_read_b64_tr_b16 v[40:41], v10 offset:16384
v_mfma_f32_16x16x32_bf16 v[144:147], v[84:87], v[112:115], v[144:147]
s_lshl_b32 s73, s73, 7
ds_read_b64_tr_b16 v[42:43], v10 offset:17408
v_mfma_f32_16x16x32_bf16 v[160:163], v[88:91], v[112:115], v[160:163]
s_add_u32 s69, s73, s67
ds_read_b64_tr_b16 v[44:45], v11 offset:16384
v_mfma_f32_16x16x32_bf16 v[164:167], v[88:91], v[116:119], v[164:167]
s_add_u32 s70, s73, s68
ds_read_b64_tr_b16 v[46:47], v11 offset:17408
v_mfma_f32_16x16x32_bf16 v[168:171], v[88:91], v[120:123], v[168:171]
s_add_u32 m0, s64, 0
ds_read_b64_tr_b16 v[48:49], v12 offset:16384
v_mfma_f32_16x16x32_bf16 v[172:175], v[88:91], v[124:127], v[172:175]
s_add_u32 s72, s71, 0
buffer_load_dwordx4 v6, s[12:15], s72 offen lds
v_mfma_f32_16x16x32_bf16 v[188:191], v[92:95], v[124:127], v[188:191]
s_add_u32 s72, s71, 31744
buffer_load_dwordx4 v6, s[12:15], s72 offen offset:1024 lds
v_mfma_f32_16x16x32_bf16 v[184:187], v[92:95], v[120:123], v[184:187]
s_add_u32 s72, s71, 63488
buffer_load_dwordx4 v7, s[12:15], s72 offen offset:2048 lds
v_mfma_f32_16x16x32_bf16 v[180:183], v[92:95], v[116:119], v[180:183]
s_add_u32 s72, s71, 95232
buffer_load_dwordx4 v7, s[12:15], s72 offen offset:3072 lds
v_mfma_f32_16x16x32_bf16 v[176:179], v[92:95], v[112:115], v[176:179]
ds_read_b64_tr_b16 v[50:51], v12 offset:17408
v_mfma_f32_16x16x32_bf16 v[192:195], v[96:99], v[112:115], v[192:195]
ds_read_b64_tr_b16 v[52:53], v13 offset:16384
v_mfma_f32_16x16x32_bf16 v[196:199], v[96:99], v[116:119], v[196:199]
ds_read_b64_tr_b16 v[54:55], v13 offset:17408
v_mfma_f32_16x16x32_bf16 v[200:203], v[96:99], v[120:123], v[200:203]
ds_read_b64_tr_b16 v[56:57], v14 offset:16384
v_mfma_f32_16x16x32_bf16 v[204:207], v[96:99], v[124:127], v[204:207]
s_add_u32 m0, s63, 131072
ds_read_b64_tr_b16 v[58:59], v14 offset:17408
v_mfma_f32_16x16x32_bf16 v[220:223], v[100:103], v[124:127], v[220:223]
s_add_u32 s72, s69, 0
buffer_load_dwordx4 v4, s[4:7], s72 offen lds
v_mfma_f32_16x16x32_bf16 v[216:219], v[100:103], v[120:123], v[216:219]
ds_read_b64_tr_b16 v[60:61], v15 offset:16384
v_mfma_f32_16x16x32_bf16 v[212:215], v[100:103], v[116:119], v[212:215]
ds_read_b64_tr_b16 v[62:63], v15 offset:17408
v_mfma_f32_16x16x32_bf16 v[208:211], v[100:103], v[112:115], v[208:211]
v_mfma_f32_16x16x32_bf16 v[224:227], v[104:107], v[112:115], v[224:227]
s_add_u32 s72, s69, 15360
buffer_load_dwordx4 v5, s[4:7], s72 offen offset:1024 lds
v_mfma_f32_16x16x32_bf16 v[228:231], v[104:107], v[116:119], v[228:231]
v_mfma_f32_16x16x32_bf16 v[232:235], v[104:107], v[120:123], v[232:235]
v_mfma_f32_16x16x32_bf16 v[236:239], v[104:107], v[124:127], v[236:239]
v_mfma_f32_16x16x32_bf16 v[252:255], v[108:111], v[124:127], v[252:255]
v_mfma_f32_16x16x32_bf16 v[248:251], v[108:111], v[120:123], v[248:251]
s_add_u32 s72, s69, 129024
buffer_load_dwordx4 v4, s[4:7], s72 offen offset:2048 lds
v_mfma_f32_16x16x32_bf16 v[244:247], v[108:111], v[116:119], v[244:247]
v_mfma_f32_16x16x32_bf16 v[240:243], v[108:111], v[112:115], v[240:243]
s_waitcnt lgkmcnt(0)
v_mfma_f32_16x16x32_bf16 v[128:131], v[32:35], v[64:67], v[128:131]
ds_read_b64_tr_b16 v[80:81], v8 offset:24576
ds_read_b64_tr_b16 v[82:83], v8 offset:25600
v_mfma_f32_16x16x32_bf16 v[132:135], v[32:35], v[68:71], v[132:135]
ds_read_b128 v[112:115], v19 offset:0
ds_read_b128 v[116:119], v19 offset:2048
v_mfma_f32_16x16x32_bf16 v[136:139], v[32:35], v[72:75], v[136:139]
s_add_u32 s72, s69, 144384
buffer_load_dwordx4 v5, s[4:7], s72 offen offset:3072 lds
v_mfma_f32_16x16x32_bf16 v[140:143], v[32:35], v[76:79], v[140:143]
ds_read_b128 v[120:123], v19 offset:4096
ds_read_b128 v[124:127], v19 offset:6144
v_mfma_f32_16x16x32_bf16 v[156:159], v[36:39], v[76:79], v[156:159]
ds_read_b64_tr_b16 v[84:85], v9 offset:24576
ds_read_b64_tr_b16 v[86:87], v9 offset:25600
v_mfma_f32_16x16x32_bf16 v[152:155], v[36:39], v[72:75], v[152:155]
ds_read_b64_tr_b16 v[88:89], v10 offset:24576
v_mfma_f32_16x16x32_bf16 v[148:151], v[36:39], v[68:71], v[148:151]
ds_read_b64_tr_b16 v[90:91], v10 offset:25600
v_mfma_f32_16x16x32_bf16 v[144:147], v[36:39], v[64:67], v[144:147]
s_add_u32 m0, s63, 135168
ds_read_b64_tr_b16 v[92:93], v11 offset:24576
v_mfma_f32_16x16x32_bf16 v[160:163], v[40:43], v[64:67], v[160:163]
s_add_u32 s72, s70, 0
buffer_load_dwordx4 v4, s[4:7], s72 offen lds
v_mfma_f32_16x16x32_bf16 v[164:167], v[40:43], v[68:71], v[164:167]
ds_read_b64_tr_b16 v[94:95], v11 offset:25600
v_mfma_f32_16x16x32_bf16 v[168:171], v[40:43], v[72:75], v[168:171]
ds_read_b64_tr_b16 v[96:97], v12 offset:24576
v_mfma_f32_16x16x32_bf16 v[172:175], v[40:43], v[76:79], v[172:175]
ds_read_b64_tr_b16 v[98:99], v12 offset:25600
v_mfma_f32_16x16x32_bf16 v[188:191], v[44:47], v[76:79], v[188:191]
s_add_u32 s72, s70, 15360
buffer_load_dwordx4 v5, s[4:7], s72 offen offset:1024 lds
v_mfma_f32_16x16x32_bf16 v[184:187], v[44:47], v[72:75], v[184:187]
ds_read_b64_tr_b16 v[100:101], v13 offset:24576
v_mfma_f32_16x16x32_bf16 v[180:183], v[44:47], v[68:71], v[180:183]
ds_read_b64_tr_b16 v[102:103], v13 offset:25600
v_mfma_f32_16x16x32_bf16 v[176:179], v[44:47], v[64:67], v[176:179]
ds_read_b64_tr_b16 v[104:105], v14 offset:24576
v_mfma_f32_16x16x32_bf16 v[192:195], v[48:51], v[64:67], v[192:195]
ds_read_b64_tr_b16 v[106:107], v14 offset:25600
v_mfma_f32_16x16x32_bf16 v[196:199], v[48:51], v[68:71], v[196:199]
s_add_u32 s72, s70, 129024
buffer_load_dwordx4 v4, s[4:7], s72 offen offset:2048 lds
v_mfma_f32_16x16x32_bf16 v[200:203], v[48:51], v[72:75], v[200:203]
ds_read_b64_tr_b16 v[108:109], v15 offset:24576
v_mfma_f32_16x16x32_bf16 v[204:207], v[48:51], v[76:79], v[204:207]
ds_read_b64_tr_b16 v[110:111], v15 offset:25600
v_mfma_f32_16x16x32_bf16 v[220:223], v[52:55], v[76:79], v[220:223]
v_mfma_f32_16x16x32_bf16 v[216:219], v[52:55], v[72:75], v[216:219]
v_mfma_f32_16x16x32_bf16 v[212:215], v[52:55], v[68:71], v[212:215]
s_add_u32 s72, s70, 144384
buffer_load_dwordx4 v5, s[4:7], s72 offen offset:3072 lds
v_mfma_f32_16x16x32_bf16 v[208:211], v[52:55], v[64:67], v[208:211]
v_mfma_f32_16x16x32_bf16 v[224:227], v[56:59], v[64:67], v[224:227]
v_mfma_f32_16x16x32_bf16 v[228:231], v[56:59], v[68:71], v[228:231]
v_mfma_f32_16x16x32_bf16 v[232:235], v[56:59], v[72:75], v[232:235]
v_mfma_f32_16x16x32_bf16 v[236:239], v[56:59], v[76:79], v[236:239]
v_mfma_f32_16x16x32_bf16 v[252:255], v[60:63], v[76:79], v[252:255]
v_mfma_f32_16x16x32_bf16 v[248:251], v[60:63], v[72:75], v[248:251]
v_mfma_f32_16x16x32_bf16 v[244:247], v[60:63], v[68:71], v[244:247]
s_waitcnt vmcnt(13) lgkmcnt(0)
v_mfma_f32_16x16x32_bf16 v[240:243], v[60:63], v[64:67], v[240:243]
s_barrier
v_mfma_f32_16x16x32_bf16 v[128:131], v[80:83], v[112:115], v[128:131]
s_add_u32 s73, s62, 13
ds_read_b64_tr_b16 v[32:33], v8 offset:32768
ds_read_b64_tr_b16 v[34:35], v8 offset:33792
v_mfma_f32_16x16x32_bf16 v[132:135], v[80:83], v[116:119], v[132:135]
s_add_u32 s70, s73, s65
ds_read_b128 v[64:67], v18 offset:32768
ds_read_b128 v[68:71], v18 offset:34816
v_mfma_f32_16x16x32_bf16 v[136:139], v[80:83], v[120:123], v[136:139]
s_and_b32 s70, s70, 3
ds_read_b128 v[72:75], v18 offset:36864
ds_read_b128 v[76:79], v18 offset:38912
v_mfma_f32_16x16x32_bf16 v[140:143], v[80:83], v[124:127], v[140:143]
s_and_b32 s73, s73, 12
ds_read_b64_tr_b16 v[36:37], v9 offset:32768
ds_read_b64_tr_b16 v[38:39], v9 offset:33792
v_mfma_f32_16x16x32_bf16 v[156:159], v[84:87], v[124:127], v[156:159]
s_or_b32 s73, s73, s70
ds_read_b64_tr_b16 v[40:41], v10 offset:32768
v_or_b32 v20, s58, v0
v_mfma_f32_16x16x32_bf16 v[152:155], v[84:87], v[120:123], v[152:155]
s_lshl_b32 s71, s73, 19
ds_read_b64_tr_b16 v[42:43], v10 offset:33792
v_mov_b32 v21, 1
v_mfma_f32_16x16x32_bf16 v[148:151], v[84:87], v[116:119], v[148:151]
s_add_u32 s71, s71, s66
ds_read_b64_tr_b16 v[44:45], v11 offset:32768
v_min_u32 v20, 1, v20
v_mfma_f32_16x16x32_bf16 v[144:147], v[84:87], v[112:115], v[144:147]
s_lshl_b32 s73, s73, 7
ds_read_b64_tr_b16 v[46:47], v11 offset:33792
v_lshlrev_b32 v20, 30, v20
v_mfma_f32_16x16x32_bf16 v[160:163], v[88:91], v[112:115], v[160:163]
s_add_u32 s69, s73, s67
ds_read_b64_tr_b16 v[48:49], v12 offset:32768
v_mfma_f32_16x16x32_bf16 v[164:167], v[88:91], v[116:119], v[164:167]
s_add_u32 s70, s73, s68
ds_read_b64_tr_b16 v[50:51], v12 offset:33792
v_mfma_f32_16x16x32_bf16 v[168:171], v[88:91], v[120:123], v[168:171]
s_add_u32 m0, s64, 16384
ds_read_b64_tr_b16 v[52:53], v13 offset:32768
v_mfma_f32_16x16x32_bf16 v[172:175], v[88:91], v[124:127], v[172:175]
s_add_u32 s72, s71, 0
buffer_load_dwordx4 v6, s[12:15], s72 offen lds
v_mfma_f32_16x16x32_bf16 v[188:191], v[92:95], v[124:127], v[188:191]
s_add_u32 s72, s71, 31744
buffer_load_dwordx4 v6, s[12:15], s72 offen offset:1024 lds
v_mfma_f32_16x16x32_bf16 v[184:187], v[92:95], v[120:123], v[184:187]
s_add_u32 s72, s71, 63488
buffer_load_dwordx4 v7, s[12:15], s72 offen offset:2048 lds
v_mfma_f32_16x16x32_bf16 v[180:183], v[92:95], v[116:119], v[180:183]
s_add_u32 s72, s71, 95232
buffer_load_dwordx4 v7, s[12:15], s72 offen offset:3072 lds
v_mfma_f32_16x16x32_bf16 v[176:179], v[92:95], v[112:115], v[176:179]
ds_read_b64_tr_b16 v[54:55], v13 offset:33792
v_mfma_f32_16x16x32_bf16 v[192:195], v[96:99], v[112:115], v[192:195]
ds_read_b64_tr_b16 v[56:57], v14 offset:32768
v_mfma_f32_16x16x32_bf16 v[196:199], v[96:99], v[116:119], v[196:199]
ds_read_b64_tr_b16 v[58:59], v14 offset:33792
v_mfma_f32_16x16x32_bf16 v[200:203], v[96:99], v[120:123], v[200:203]
ds_read_b64_tr_b16 v[60:61], v15 offset:32768
v_mfma_f32_16x16x32_bf16 v[204:207], v[96:99], v[124:127], v[204:207]
s_add_u32 m0, s63, 65536
ds_read_b64_tr_b16 v[62:63], v15 offset:33792
v_mfma_f32_16x16x32_bf16 v[220:223], v[100:103], v[124:127], v[220:223]
s_add_u32 s72, s69, 0
buffer_load_dwordx4 v4, s[4:7], s72 offen lds
v_mfma_f32_16x16x32_bf16 v[216:219], v[100:103], v[120:123], v[216:219]
buffer_store_dword v21, v20, s[44:47], s91 offen sc1
v_mfma_f32_16x16x32_bf16 v[212:215], v[100:103], v[116:119], v[212:215]
v_mfma_f32_16x16x32_bf16 v[208:211], v[100:103], v[112:115], v[208:211]
v_mfma_f32_16x16x32_bf16 v[224:227], v[104:107], v[112:115], v[224:227]
s_add_u32 s72, s69, 15360
buffer_load_dwordx4 v5, s[4:7], s72 offen offset:1024 lds
v_mfma_f32_16x16x32_bf16 v[228:231], v[104:107], v[116:119], v[228:231]
v_mfma_f32_16x16x32_bf16 v[232:235], v[104:107], v[120:123], v[232:235]
v_mfma_f32_16x16x32_bf16 v[236:239], v[104:107], v[124:127], v[236:239]
v_mfma_f32_16x16x32_bf16 v[252:255], v[108:111], v[124:127], v[252:255]
v_mfma_f32_16x16x32_bf16 v[248:251], v[108:111], v[120:123], v[248:251]
s_add_u32 s72, s69, 129024
buffer_load_dwordx4 v4, s[4:7], s72 offen offset:2048 lds
v_mfma_f32_16x16x32_bf16 v[244:247], v[108:111], v[116:119], v[244:247]
v_mfma_f32_16x16x32_bf16 v[240:243], v[108:111], v[112:115], v[240:243]
s_waitcnt lgkmcnt(0)
v_mfma_f32_16x16x32_bf16 v[128:131], v[32:35], v[64:67], v[128:131]
ds_read_b64_tr_b16 v[80:81], v8 offset:40960
ds_read_b64_tr_b16 v[82:83], v8 offset:41984
v_mfma_f32_16x16x32_bf16 v[132:135], v[32:35], v[68:71], v[132:135]
ds_read_b128 v[112:115], v19 offset:32768
ds_read_b128 v[116:119], v19 offset:34816
v_mfma_f32_16x16x32_bf16 v[136:139], v[32:35], v[72:75], v[136:139]
s_add_u32 s72, s69, 144384
buffer_load_dwordx4 v5, s[4:7], s72 offen offset:3072 lds
v_mfma_f32_16x16x32_bf16 v[140:143], v[32:35], v[76:79], v[140:143]
ds_read_b128 v[120:123], v19 offset:36864
ds_read_b128 v[124:127], v19 offset:38912
v_mfma_f32_16x16x32_bf16 v[156:159], v[36:39], v[76:79], v[156:159]
ds_read_b64_tr_b16 v[84:85], v9 offset:40960
ds_read_b64_tr_b16 v[86:87], v9 offset:41984
v_mfma_f32_16x16x32_bf16 v[152:155], v[36:39], v[72:75], v[152:155]
ds_read_b64_tr_b16 v[88:89], v10 offset:40960
v_mfma_f32_16x16x32_bf16 v[148:151], v[36:39], v[68:71], v[148:151]
ds_read_b64_tr_b16 v[90:91], v10 offset:41984
v_mfma_f32_16x16x32_bf16 v[144:147], v[36:39], v[64:67], v[144:147]
s_add_u32 m0, s63, 69632
ds_read_b64_tr_b16 v[92:93], v11 offset:40960
v_mfma_f32_16x16x32_bf16 v[160:163], v[40:43], v[64:67], v[160:163]
s_add_u32 s72, s70, 0
buffer_load_dwordx4 v4, s[4:7], s72 offen lds
v_mfma_f32_16x16x32_bf16 v[164:167], v[40:43], v[68:71], v[164:167]
ds_read_b64_tr_b16 v[94:95], v11 offset:41984
v_mfma_f32_16x16x32_bf16 v[168:171], v[40:43], v[72:75], v[168:171]
ds_read_b64_tr_b16 v[96:97], v12 offset:40960
v_mfma_f32_16x16x32_bf16 v[172:175], v[40:43], v[76:79], v[172:175]
ds_read_b64_tr_b16 v[98:99], v12 offset:41984
v_mfma_f32_16x16x32_bf16 v[188:191], v[44:47], v[76:79], v[188:191]
s_add_u32 s72, s70, 15360
buffer_load_dwordx4 v5, s[4:7], s72 offen offset:1024 lds
v_mfma_f32_16x16x32_bf16 v[184:187], v[44:47], v[72:75], v[184:187]
ds_read_b64_tr_b16 v[100:101], v13 offset:40960
v_mfma_f32_16x16x32_bf16 v[180:183], v[44:47], v[68:71], v[180:183]
ds_read_b64_tr_b16 v[102:103], v13 offset:41984
v_mfma_f32_16x16x32_bf16 v[176:179], v[44:47], v[64:67], v[176:179]
ds_read_b64_tr_b16 v[104:105], v14 offset:40960
v_mfma_f32_16x16x32_bf16 v[192:195], v[48:51], v[64:67], v[192:195]
ds_read_b64_tr_b16 v[106:107], v14 offset:41984
v_mfma_f32_16x16x32_bf16 v[196:199], v[48:51], v[68:71], v[196:199]
s_add_u32 s72, s70, 129024
buffer_load_dwordx4 v4, s[4:7], s72 offen offset:2048 lds
v_mfma_f32_16x16x32_bf16 v[200:203], v[48:51], v[72:75], v[200:203]
ds_read_b64_tr_b16 v[108:109], v15 offset:40960
v_mfma_f32_16x16x32_bf16 v[204:207], v[48:51], v[76:79], v[204:207]
ds_read_b64_tr_b16 v[110:111], v15 offset:41984
v_mfma_f32_16x16x32_bf16 v[220:223], v[52:55], v[76:79], v[220:223]
v_mfma_f32_16x16x32_bf16 v[216:219], v[52:55], v[72:75], v[216:219]
v_mfma_f32_16x16x32_bf16 v[212:215], v[52:55], v[68:71], v[212:215]
s_add_u32 s72, s70, 144384
buffer_load_dwordx4 v5, s[4:7], s72 offen offset:3072 lds
v_mfma_f32_16x16x32_bf16 v[208:211], v[52:55], v[64:67], v[208:211]
v_mfma_f32_16x16x32_bf16 v[224:227], v[56:59], v[64:67], v[224:227]
v_mfma_f32_16x16x32_bf16 v[228:231], v[56:59], v[68:71], v[228:231]
v_mfma_f32_16x16x32_bf16 v[232:235], v[56:59], v[72:75], v[232:235]
v_mfma_f32_16x16x32_bf16 v[236:239], v[56:59], v[76:79], v[236:239]
v_mfma_f32_16x16x32_bf16 v[252:255], v[60:63], v[76:79], v[252:255]
v_mfma_f32_16x16x32_bf16 v[248:251], v[60:63], v[72:75], v[248:251]
v_mfma_f32_16x16x32_bf16 v[244:247], v[60:63], v[68:71], v[244:247]
s_waitcnt vmcnt(13) lgkmcnt(0)
v_mfma_f32_16x16x32_bf16 v[240:243], v[60:63], v[64:67], v[240:243]
s_barrier
v_mfma_f32_16x16x32_bf16 v[128:131], v[80:83], v[112:115], v[128:131]
s_add_u32 s73, s62, 14
s_waitcnt vmcnt(25)
v_cmp_gt_u32 vcc, 8, v3
s_cbranch_vccnz Lspin1
Lback2:
v_mfma_f32_16x16x32_bf16 v[132:135], v[80:83], v[116:119], v[132:135]
s_add_u32 s70, s73, s65
ds_read_b64_tr_b16 v[32:33], v8 offset:0
ds_read_b64_tr_b16 v[34:35], v8 offset:1024
v_mfma_f32_16x16x32_bf16 v[136:139], v[80:83], v[120:123], v[136:139]
s_and_b32 s70, s70, 3
ds_read_b128 v[64:67], v16 offset:0
ds_read_b128 v[68:71], v16 offset:2048
v_mfma_f32_16x16x32_bf16 v[140:143], v[80:83], v[124:127], v[140:143]
s_and_b32 s73, s73, 12
ds_read_b128 v[72:75], v16 offset:4096
ds_read_b128 v[76:79], v16 offset:6144
v_mfma_f32_16x16x32_bf16 v[156:159], v[84:87], v[124:127], v[156:159]
s_or_b32 s73, s73, s70
ds_read_b64_tr_b16 v[36:37], v9 offset:0
ds_read_b64_tr_b16 v[38:39], v9 offset:1024
v_mfma_f32_16x16x32_bf16 v[152:155], v[84:87], v[120:123], v[152:155]
s_lshl_b32 s71, s73, 19
ds_read_b64_tr_b16 v[40:41], v10 offset:0
v_mfma_f32_16x16x32_bf16 v[148:151], v[84:87], v[116:119], v[148:151]
s_add_u32 s71, s71, s66
ds_read_b64_tr_b16 v[42:43], v10 offset:1024
v_mfma_f32_16x16x32_bf16 v[144:147], v[84:87], v[112:115], v[144:147]
s_lshl_b32 s73, s73, 7
ds_read_b64_tr_b16 v[44:45], v11 offset:0
v_mfma_f32_16x16x32_bf16 v[160:163], v[88:91], v[112:115], v[160:163]
s_add_u32 s69, s73, s67
ds_read_b64_tr_b16 v[46:47], v11 offset:1024
v_mfma_f32_16x16x32_bf16 v[164:167], v[88:91], v[116:119], v[164:167]
s_add_u32 s70, s73, s68
ds_read_b64_tr_b16 v[48:49], v12 offset:0
v_mfma_f32_16x16x32_bf16 v[168:171], v[88:91], v[120:123], v[168:171]
s_add_u32 m0, s64, 32768
ds_read_b64_tr_b16 v[50:51], v12 offset:1024
v_mfma_f32_16x16x32_bf16 v[172:175], v[88:91], v[124:127], v[172:175]
s_add_u32 s72, s71, 0
buffer_load_dwordx4 v6, s[12:15], s72 offen lds
v_mfma_f32_16x16x32_bf16 v[188:191], v[92:95], v[124:127], v[188:191]
s_add_u32 s72, s71, 31744
buffer_load_dwordx4 v6, s[12:15], s72 offen offset:1024 lds
v_mfma_f32_16x16x32_bf16 v[184:187], v[92:95], v[120:123], v[184:187]
s_add_u32 s72, s71, 63488
buffer_load_dwordx4 v7, s[12:15], s72 offen offset:2048 lds
v_mfma_f32_16x16x32_bf16 v[180:183], v[92:95], v[116:119], v[180:183]
s_add_u32 s72, s71, 95232
buffer_load_dwordx4 v7, s[12:15], s72 offen offset:3072 lds
v_mfma_f32_16x16x32_bf16 v[176:179], v[92:95], v[112:115], v[176:179]
ds_read_b64_tr_b16 v[52:53], v13 offset:0
v_mfma_f32_16x16x32_bf16 v[192:195], v[96:99], v[112:115], v[192:195]
ds_read_b64_tr_b16 v[54:55], v13 offset:1024
v_mfma_f32_16x16x32_bf16 v[196:199], v[96:99], v[116:119], v[196:199]
ds_read_b64_tr_b16 v[56:57], v14 offset:0
v_mfma_f32_16x16x32_bf16 v[200:203], v[96:99], v[120:123], v[200:203]
ds_read_b64_tr_b16 v[58:59], v14 offset:1024
v_mfma_f32_16x16x32_bf16 v[204:207], v[96:99], v[124:127], v[204:207]
s_add_u32 m0, s63, 98304
ds_read_b64_tr_b16 v[60:61], v15 offset:0
v_mfma_f32_16x16x32_bf16 v[220:223], v[100:103], v[124:127], v[220:223]
s_add_u32 s72, s69, 0
buffer_load_dwordx4 v4, s[4:7], s72 offen lds
v_mfma_f32_16x16x32_bf16 v[216:219], v[100:103], v[120:123], v[216:219]
ds_read_b64_tr_b16 v[62:63], v15 offset:1024
v_mfma_f32_16x16x32_bf16 v[212:215], v[100:103], v[116:119], v[212:215]
v_mfma_f32_16x16x32_bf16 v[208:211], v[100:103], v[112:115], v[208:211]
v_mfma_f32_16x16x32_bf16 v[224:227], v[104:107], v[112:115], v[224:227]
s_add_u32 s72, s69, 15360
buffer_load_dwordx4 v5, s[4:7], s72 offen offset:1024 lds
v_mfma_f32_16x16x32_bf16 v[228:231], v[104:107], v[116:119], v[228:231]
v_mfma_f32_16x16x32_bf16 v[232:235], v[104:107], v[120:123], v[232:235]
v_mfma_f32_16x16x32_bf16 v[236:239], v[104:107], v[124:127], v[236:239]
v_mfma_f32_16x16x32_bf16 v[252:255], v[108:111], v[124:127], v[252:255]
v_mfma_f32_16x16x32_bf16 v[248:251], v[108:111], v[120:123], v[248:251]
s_add_u32 s72, s69, 129024
buffer_load_dwordx4 v4, s[4:7], s72 offen offset:2048 lds
v_mfma_f32_16x16x32_bf16 v[244:247], v[108:111], v[116:119], v[244:247]
v_mfma_f32_16x16x32_bf16 v[240:243], v[108:111], v[112:115], v[240:243]
s_waitcnt lgkmcnt(0)
v_mfma_f32_16x16x32_bf16 v[128:131], v[32:35], v[64:67], v[128:131]
ds_read_b64_tr_b16 v[80:81], v8 offset:8192
ds_read_b64_tr_b16 v[82:83], v8 offset:9216
v_mfma_f32_16x16x32_bf16 v[132:135], v[32:35], v[68:71], v[132:135]
ds_read_b128 v[112:115], v17 offset:0
ds_read_b128 v[116:119], v17 offset:2048
v_mfma_f32_16x16x32_bf16 v[136:139], v[32:35], v[72:75], v[136:139]
s_add_u32 s72, s69, 144384
buffer_load_dwordx4 v5, s[4:7], s72 offen offset:3072 lds
v_mfma_f32_16x16x32_bf16 v[140:143], v[32:35], v[76:79], v[140:143]
ds_read_b128 v[120:123], v17 offset:4096
ds_read_b128 v[124:127], v17 offset:6144
v_mfma_f32_16x16x32_bf16 v[156:159], v[36:39], v[76:79], v[156:159]
ds_read_b64_tr_b16 v[84:85], v9 offset:8192
ds_read_b64_tr_b16 v[86:87], v9 offset:9216
v_mfma_f32_16x16x32_bf16 v[152:155], v[36:39], v[72:75], v[152:155]
ds_read_b64_tr_b16 v[88:89], v10 offset:8192
v_mfma_f32_16x16x32_bf16 v[148:151], v[36:39], v[68:71], v[148:151]
ds_read_b64_tr_b16 v[90:91], v10 offset:9216
v_mfma_f32_16x16x32_bf16 v[144:147], v[36:39], v[64:67], v[144:147]
s_add_u32 m0, s63, 102400
ds_read_b64_tr_b16 v[92:93], v11 offset:8192
v_mfma_f32_16x16x32_bf16 v[160:163], v[40:43], v[64:67], v[160:163]
s_add_u32 s72, s70, 0
buffer_load_dwordx4 v4, s[4:7], s72 offen lds
v_mfma_f32_16x16x32_bf16 v[164:167], v[40:43], v[68:71], v[164:167]
ds_read_b64_tr_b16 v[94:95], v11 offset:9216
v_mfma_f32_16x16x32_bf16 v[168:171], v[40:43], v[72:75], v[168:171]
ds_read_b64_tr_b16 v[96:97], v12 offset:8192
v_mfma_f32_16x16x32_bf16 v[172:175], v[40:43], v[76:79], v[172:175]
ds_read_b64_tr_b16 v[98:99], v12 offset:9216
v_mfma_f32_16x16x32_bf16 v[188:191], v[44:47], v[76:79], v[188:191]
s_add_u32 s72, s70, 15360
buffer_load_dwordx4 v5, s[4:7], s72 offen offset:1024 lds
v_mfma_f32_16x16x32_bf16 v[184:187], v[44:47], v[72:75], v[184:187]
ds_read_b64_tr_b16 v[100:101], v13 offset:8192
v_mfma_f32_16x16x32_bf16 v[180:183], v[44:47], v[68:71], v[180:183]
ds_read_b64_tr_b16 v[102:103], v13 offset:9216
v_mfma_f32_16x16x32_bf16 v[176:179], v[44:47], v[64:67], v[176:179]
ds_read_b64_tr_b16 v[104:105], v14 offset:8192
v_mfma_f32_16x16x32_bf16 v[192:195], v[48:51], v[64:67], v[192:195]
ds_read_b64_tr_b16 v[106:107], v14 offset:9216
v_mfma_f32_16x16x32_bf16 v[196:199], v[48:51], v[68:71], v[196:199]
s_add_u32 s72, s70, 129024
buffer_load_dwordx4 v4, s[4:7], s72 offen offset:2048 lds
v_mfma_f32_16x16x32_bf16 v[200:203], v[48:51], v[72:75], v[200:203]
ds_read_b64_tr_b16 v[108:109], v15 offset:8192
v_mfma_f32_16x16x32_bf16 v[204:207], v[48:51], v[76:79], v[204:207]
ds_read_b64_tr_b16 v[110:111], v15 offset:9216
v_mfma_f32_16x16x32_bf16 v[220:223], v[52:55], v[76:79], v[220:223]
v_mfma_f32_16x16x32_bf16 v[216:219], v[52:55], v[72:75], v[216:219]
v_mfma_f32_16x16x32_bf16 v[212:215], v[52:55], v[68:71], v[212:215]
s_add_u32 s72, s70, 144384
buffer_load_dwordx4 v5, s[4:7], s72 offen offset:3072 lds
v_mfma_f32_16x16x32_bf16 v[208:211], v[52:55], v[64:67], v[208:211]
v_mfma_f32_16x16x32_bf16 v[224:227], v[56:59], v[64:67], v[224:227]
v_mfma_f32_16x16x32_bf16 v[228:231], v[56:59], v[68:71], v[228:231]
v_mfma_f32_16x16x32_bf16 v[232:235], v[56:59], v[72:75], v[232:235]
v_mfma_f32_16x16x32_bf16 v[236:239], v[56:59], v[76:79], v[236:239]
v_mfma_f32_16x16x32_bf16 v[252:255], v[60:63], v[76:79], v[252:255]
v_mfma_f32_16x16x32_bf16 v[248:251], v[60:63], v[72:75], v[248:251]
v_mfma_f32_16x16x32_bf16 v[244:247], v[60:63], v[68:71], v[244:247]
s_waitcnt vmcnt(12) lgkmcnt(0)
v_mfma_f32_16x16x32_bf16 v[240:243], v[60:63], v[64:67], v[240:243]
s_barrier
v_mfma_f32_16x16x32_bf16 v[128:131], v[80:83], v[112:115], v[128:131]
s_add_u32 s73, s62, 15
ds_read_b64_tr_b16 v[32:33], v8 offset:16384
ds_read_b64_tr_b16 v[34:35], v8 offset:17408
v_mfma_f32_16x16x32_bf16 v[132:135], v[80:83], v[116:119], v[132:135]
s_add_u32 s70, s73, s65
ds_read_b128 v[64:67], v18 offset:0
ds_read_b128 v[68:71], v18 offset:2048
v_mfma_f32_16x16x32_bf16 v[136:139], v[80:83], v[120:123], v[136:139]
s_and_b32 s70, s70, 3
ds_read_b128 v[72:75], v18 offset:4096
ds_read_b128 v[76:79], v18 offset:6144
v_mfma_f32_16x16x32_bf16 v[140:143], v[80:83], v[124:127], v[140:143]
s_and_b32 s73, s73, 12
ds_read_b64_tr_b16 v[36:37], v9 offset:16384
ds_read_b64_tr_b16 v[38:39], v9 offset:17408
v_mfma_f32_16x16x32_bf16 v[156:159], v[84:87], v[124:127], v[156:159]
s_or_b32 s73, s73, s70
ds_read_b64_tr_b16 v[40:41], v10 offset:16384
v_mfma_f32_16x16x32_bf16 v[152:155], v[84:87], v[120:123], v[152:155]
s_lshl_b32 s71, s73, 19
ds_read_b64_tr_b16 v[42:43], v10 offset:17408
v_mfma_f32_16x16x32_bf16 v[148:151], v[84:87], v[116:119], v[148:151]
s_add_u32 s71, s71, s66
ds_read_b64_tr_b16 v[44:45], v11 offset:16384
v_mfma_f32_16x16x32_bf16 v[144:147], v[84:87], v[112:115], v[144:147]
s_lshl_b32 s73, s73, 7
ds_read_b64_tr_b16 v[46:47], v11 offset:17408
v_mfma_f32_16x16x32_bf16 v[160:163], v[88:91], v[112:115], v[160:163]
s_add_u32 s69, s73, s67
ds_read_b64_tr_b16 v[48:49], v12 offset:16384
v_mfma_f32_16x16x32_bf16 v[164:167], v[88:91], v[116:119], v[164:167]
s_add_u32 s70, s73, s68
ds_read_b64_tr_b16 v[50:51], v12 offset:17408
v_mfma_f32_16x16x32_bf16 v[168:171], v[88:91], v[120:123], v[168:171]
s_add_u32 m0, s64, 0
ds_read_b64_tr_b16 v[52:53], v13 offset:16384
v_mfma_f32_16x16x32_bf16 v[172:175], v[88:91], v[124:127], v[172:175]
s_add_u32 s72, s71, 0
buffer_load_dwordx4 v6, s[12:15], s72 offen lds
v_mfma_f32_16x16x32_bf16 v[188:191], v[92:95], v[124:127], v[188:191]
s_add_u32 s72, s71, 31744
buffer_load_dwordx4 v6, s[12:15], s72 offen offset:1024 lds
v_mfma_f32_16x16x32_bf16 v[184:187], v[92:95], v[120:123], v[184:187]
s_add_u32 s72, s71, 63488
buffer_load_dwordx4 v7, s[12:15], s72 offen offset:2048 lds
v_mfma_f32_16x16x32_bf16 v[180:183], v[92:95], v[116:119], v[180:183]
s_add_u32 s72, s71, 95232
buffer_load_dwordx4 v7, s[12:15], s72 offen offset:3072 lds
v_mfma_f32_16x16x32_bf16 v[176:179], v[92:95], v[112:115], v[176:179]
s_and_b32 s75, s91, 0xfffffc7f
v_lshrrev_b32 v2, 3, v0
v_lshlrev_b32 v2, 7, v2
v_mfma_f32_16x16x32_bf16 v[192:195], v[96:99], v[112:115], v[192:195]
buffer_load_dword v3, v2, s[44:47], s75 offen sc1
v_mfma_f32_16x16x32_bf16 v[196:199], v[96:99], v[116:119], v[196:199]
ds_read_b64_tr_b16 v[54:55], v13 offset:17408
v_mfma_f32_16x16x32_bf16 v[200:203], v[96:99], v[120:123], v[200:203]
ds_read_b64_tr_b16 v[56:57], v14 offset:16384
v_mfma_f32_16x16x32_bf16 v[204:207], v[96:99], v[124:127], v[204:207]
s_add_u32 m0, s63, 131072
ds_read_b64_tr_b16 v[58:59], v14 offset:17408
v_mfma_f32_16x16x32_bf16 v[220:223], v[100:103], v[124:127], v[220:223]
s_add_u32 s72, s69, 0
buffer_load_dwordx4 v4, s[4:7], s72 offen lds
v_mfma_f32_16x16x32_bf16 v[216:219], v[100:103], v[120:123], v[216:219]
ds_read_b64_tr_b16 v[60:61], v15 offset:16384
v_mfma_f32_16x16x32_bf16 v[212:215], v[100:103], v[116:119], v[212:215]
ds_read_b64_tr_b16 v[62:63], v15 offset:17408
v_mfma_f32_16x16x32_bf16 v[208:211], v[100:103], v[112:115], v[208:211]
v_mfma_f32_16x16x32_bf16 v[224:227], v[104:107], v[112:115], v[224:227]
s_add_u32 s72, s69, 15360
buffer_load_dwordx4 v5, s[4:7], s72 offen offset:1024 lds
v_mfma_f32_16x16x32_bf16 v[228:231], v[104:107], v[116:119], v[228:231]
v_mfma_f32_16x16x32_bf16 v[232:235], v[104:107], v[120:123], v[232:235]
v_mfma_f32_16x16x32_bf16 v[236:239], v[104:107], v[124:127], v[236:239]
v_mfma_f32_16x16x32_bf16 v[252:255], v[108:111], v[124:127], v[252:255]
v_mfma_f32_16x16x32_bf16 v[248:251], v[108:111], v[120:123], v[248:251]
s_add_u32 s72, s69, 129024
buffer_load_dwordx4 v4, s[4:7], s72 offen offset:2048 lds
v_mfma_f32_16x16x32_bf16 v[244:247], v[108:111], v[116:119], v[244:247]
v_mfma_f32_16x16x32_bf16 v[240:243], v[108:111], v[112:115], v[240:243]
s_waitcnt lgkmcnt(0)
v_mfma_f32_16x16x32_bf16 v[128:131], v[32:35], v[64:67], v[128:131]
v_accvgpr_write_b32 a0, -1
v_accvgpr_write_b32 a1, -1
v_mfma_f32_16x16x32_bf16 v[132:135], v[32:35], v[68:71], v[132:135]
v_accvgpr_write_b32 a2, -1
v_accvgpr_write_b32 a3, -1
v_mfma_f32_16x16x32_bf16 v[136:139], v[32:35], v[72:75], v[136:139]
s_add_u32 s72, s69, 144384
buffer_load_dwordx4 v5, s[4:7], s72 offen offset:3072 lds
v_mfma_f32_16x16x32_bf16 v[140:143], v[32:35], v[76:79], v[140:143]
s_add_u32 s80, s93, 0x3a00000
ds_read_b64_tr_b16 v[80:81], v8 offset:24576
ds_read_b64_tr_b16 v[82:83], v8 offset:25600
v_mfma_f32_16x16x32_bf16 v[156:159], v[36:39], v[76:79], v[156:159]
ds_read_b128 v[112:115], v19 offset:0
ds_read_b128 v[116:119], v19 offset:2048
v_mfma_f32_16x16x32_bf16 v[152:155], v[36:39], v[72:75], v[152:155]
ds_read_b128 v[120:123], v19 offset:4096
ds_read_b128 v[124:127], v19 offset:6144
v_mfma_f32_16x16x32_bf16 v[148:151], v[36:39], v[68:71], v[148:151]
ds_read_b64_tr_b16 v[84:85], v9 offset:24576
ds_read_b64_tr_b16 v[86:87], v9 offset:25600
v_mfma_f32_16x16x32_bf16 v[144:147], v[36:39], v[64:67], v[144:147]
s_add_u32 m0, s63, 135168
ds_read_b64_tr_b16 v[88:89], v10 offset:24576
v_mfma_f32_16x16x32_bf16 v[160:163], v[40:43], v[64:67], v[160:163]
s_add_u32 s72, s70, 0
buffer_load_dwordx4 v4, s[4:7], s72 offen lds
v_mfma_f32_16x16x32_bf16 v[164:167], v[40:43], v[68:71], v[164:167]
ds_read_b64_tr_b16 v[90:91], v10 offset:25600
v_mfma_f32_16x16x32_bf16 v[168:171], v[40:43], v[72:75], v[168:171]
ds_read_b64_tr_b16 v[92:93], v11 offset:24576
v_mfma_f32_16x16x32_bf16 v[172:175], v[40:43], v[76:79], v[172:175]
ds_read_b64_tr_b16 v[94:95], v11 offset:25600
v_mfma_f32_16x16x32_bf16 v[188:191], v[44:47], v[76:79], v[188:191]
s_add_u32 s72, s70, 15360
buffer_load_dwordx4 v5, s[4:7], s72 offen offset:1024 lds
v_mfma_f32_16x16x32_bf16 v[184:187], v[44:47], v[72:75], v[184:187]
ds_read_b64_tr_b16 v[96:97], v12 offset:24576
v_mfma_f32_16x16x32_bf16 v[180:183], v[44:47], v[68:71], v[180:183]
ds_read_b64_tr_b16 v[98:99], v12 offset:25600
v_mfma_f32_16x16x32_bf16 v[176:179], v[44:47], v[64:67], v[176:179]
ds_read_b64_tr_b16 v[100:101], v13 offset:24576
v_mfma_f32_16x16x32_bf16 v[192:195], v[48:51], v[64:67], v[192:195]
ds_read_b64_tr_b16 v[102:103], v13 offset:25600
v_mfma_f32_16x16x32_bf16 v[196:199], v[48:51], v[68:71], v[196:199]
s_add_u32 s72, s70, 129024
buffer_load_dwordx4 v4, s[4:7], s72 offen offset:2048 lds
v_mfma_f32_16x16x32_bf16 v[200:203], v[48:51], v[72:75], v[200:203]
ds_read_b64_tr_b16 v[104:105], v14 offset:24576
v_mfma_f32_16x16x32_bf16 v[204:207], v[48:51], v[76:79], v[204:207]
ds_read_b64_tr_b16 v[106:107], v14 offset:25600
v_mfma_f32_16x16x32_bf16 v[220:223], v[52:55], v[76:79], v[220:223]
ds_read_b64_tr_b16 v[108:109], v15 offset:24576
v_mfma_f32_16x16x32_bf16 v[216:219], v[52:55], v[72:75], v[216:219]
ds_read_b64_tr_b16 v[110:111], v15 offset:25600
v_mfma_f32_16x16x32_bf16 v[212:215], v[52:55], v[68:71], v[212:215]
s_add_u32 s72, s70, 144384
buffer_load_dwordx4 v5, s[4:7], s72 offen offset:3072 lds
v_mfma_f32_16x16x32_bf16 v[208:211], v[52:55], v[64:67], v[208:211]
v_mfma_f32_16x16x32_bf16 v[224:227], v[56:59], v[64:67], v[224:227]
v_mfma_f32_16x16x32_bf16 v[228:231], v[56:59], v[68:71], v[228:231]
v_mfma_f32_16x16x32_bf16 v[232:235], v[56:59], v[72:75], v[232:235]
v_mfma_f32_16x16x32_bf16 v[236:239], v[56:59], v[76:79], v[236:239]
v_mfma_f32_16x16x32_bf16 v[252:255], v[60:63], v[76:79], v[252:255]
v_mfma_f32_16x16x32_bf16 v[248:251], v[60:63], v[72:75], v[248:251]
v_mfma_f32_16x16x32_bf16 v[244:247], v[60:63], v[68:71], v[244:247]
s_waitcnt vmcnt(13) lgkmcnt(0)
v_mfma_f32_16x16x32_bf16 v[240:243], v[60:63], v[64:67], v[240:243]
s_barrier
v_mfma_f32_16x16x32_bf16 v[128:131], v[80:83], v[112:115], v[128:131]
s_waitcnt vmcnt(8)
v_cmp_gt_u32 vcc, 1, v3
s_cbranch_vccnz Lspin4
Lback5:
v_mfma_f32_16x16x32_bf16 v[132:135], v[80:83], v[116:119], v[132:135]
s_add_u32 m0, s64, 49152
ds_read_b64_tr_b16 v[32:33], v8 offset:32768
ds_read_b64_tr_b16 v[34:35], v8 offset:33792
v_mfma_f32_16x16x32_bf16 v[136:139], v[80:83], v[120:123], v[136:139]
s_add_u32 s72, s81, 16384
buffer_load_dwordx4 v1, s[44:47], s72 offen sc1 lds
v_mfma_f32_16x16x32_bf16 v[140:143], v[80:83], v[124:127], v[140:143]
ds_read_b128 v[64:67], v18 offset:32768
ds_read_b128 v[68:71], v18 offset:34816
v_mfma_f32_16x16x32_bf16 v[156:159], v[84:87], v[124:127], v[156:159]
ds_read_b128 v[72:75], v18 offset:36864
ds_read_b128 v[76:79], v18 offset:38912
v_mfma_f32_16x16x32_bf16 v[152:155], v[84:87], v[120:123], v[152:155]
buffer_load_dwordx4 v1, s[44:47], s72 offen offset:1024 sc1 lds
v_mfma_f32_16x16x32_bf16 v[148:151], v[84:87], v[116:119], v[148:151]
ds_read_b64_tr_b16 v[36:37], v9 offset:32768
ds_read_b64_tr_b16 v[38:39], v9 offset:33792
v_mfma_f32_16x16x32_bf16 v[144:147], v[84:87], v[112:115], v[144:147]
ds_read_b64_tr_b16 v[40:41], v10 offset:32768
v_mfma_f32_16x16x32_bf16 v[160:163], v[88:91], v[112:115], v[160:163]
ds_read_b64_tr_b16 v[42:43], v10 offset:33792
v_mfma_f32_16x16x32_bf16 v[164:167], v[88:91], v[116:119], v[164:167]
ds_read_b64_tr_b16 v[44:45], v11 offset:32768
v_mfma_f32_16x16x32_bf16 v[168:171], v[88:91], v[120:123], v[168:171]
buffer_load_dwordx4 v1, s[44:47], s72 offen offset:2048 sc1 lds
v_mfma_f32_16x16x32_bf16 v[172:175], v[88:91], v[124:127], v[172:175]
ds_read_b64_tr_b16 v[46:47], v11 offset:33792
v_mfma_f32_16x16x32_bf16 v[188:191], v[92:95], v[124:127], v[188:191]
ds_read_b64_tr_b16 v[48:49], v12 offset:32768
v_mfma_f32_16x16x32_bf16 v[184:187], v[92:95], v[120:123], v[184:187]
ds_read_b64_tr_b16 v[50:51], v12 offset:33792
v_mfma_f32_16x16x32_bf16 v[180:183], v[92:95], v[116:119], v[180:183]
ds_read_b64_tr_b16 v[52:53], v13 offset:32768
v_mfma_f32_16x16x32_bf16 v[176:179], v[92:95], v[112:115], v[176:179]
buffer_load_dwordx4 v1, s[44:47], s72 offen offset:3072 sc1 lds
v_mfma_f32_16x16x32_bf16 v[192:195], v[96:99], v[112:115], v[192:195]
ds_read_b64_tr_b16 v[54:55], v13 offset:33792
v_mfma_f32_16x16x32_bf16 v[196:199], v[96:99], v[116:119], v[196:199]
ds_read_b64_tr_b16 v[56:57], v14 offset:32768
v_mfma_f32_16x16x32_bf16 v[200:203], v[96:99], v[120:123], v[200:203]
ds_read_b64_tr_b16 v[58:59], v14 offset:33792
v_mfma_f32_16x16x32_bf16 v[204:207], v[96:99], v[124:127], v[204:207]
ds_read_b64_tr_b16 v[60:61], v15 offset:32768
v_mfma_f32_16x16x32_bf16 v[220:223], v[100:103], v[124:127], v[220:223]
s_add_u32 s81, s81, 0x8000
ds_read_b64_tr_b16 v[62:63], v15 offset:33792
v_mfma_f32_16x16x32_bf16 v[216:219], v[100:103], v[120:123], v[216:219]
s_add_u32 m0, s64, 81920
v_mfma_f32_16x16x32_bf16 v[212:215], v[100:103], v[116:119], v[212:215]
s_add_u32 s72, s81, 16384
buffer_load_dwordx4 v1, s[44:47], s72 offen sc1 lds
v_mfma_f32_16x16x32_bf16 v[208:211], v[100:103], v[112:115], v[208:211]
v_mfma_f32_16x16x32_bf16 v[224:227], v[104:107], v[112:115], v[224:227]
v_mfma_f32_16x16x32_bf16 v[228:231], v[104:107], v[116:119], v[228:231]
buffer_load_dwordx4 v1, s[44:47], s72 offen offset:1024 sc1 lds
v_mfma_f32_16x16x32_bf16 v[232:235], v[104:107], v[120:123], v[232:235]
v_mfma_f32_16x16x32_bf16 v[236:239], v[104:107], v[124:127], v[236:239]
v_mfma_f32_16x16x32_bf16 v[252:255], v[108:111], v[124:127], v[252:255]
v_mfma_f32_16x16x32_bf16 v[248:251], v[108:111], v[120:123], v[248:251]
v_mfma_f32_16x16x32_bf16 v[244:247], v[108:111], v[116:119], v[244:247]
buffer_load_dwordx4 v1, s[44:47], s72 offen offset:2048 sc1 lds
v_mfma_f32_16x16x32_bf16 v[240:243], v[108:111], v[112:115], v[240:243]
s_waitcnt lgkmcnt(0)
v_mfma_f32_16x16x32_bf16 v[128:131], v[32:35], v[64:67], v[128:131]
ds_read_b64_tr_b16 v[80:81], v8 offset:40960
ds_read_b64_tr_b16 v[82:83], v8 offset:41984
v_mfma_f32_16x16x32_bf16 v[132:135], v[32:35], v[68:71], v[132:135]
ds_read_b128 v[112:115], v19 offset:32768
ds_read_b128 v[116:119], v19 offset:34816
v_mfma_f32_16x16x32_bf16 v[136:139], v[32:35], v[72:75], v[136:139]
buffer_load_dwordx4 v1, s[44:47], s72 offen offset:3072 sc1 lds
v_mfma_f32_16x16x32_bf16 v[140:143], v[32:35], v[76:79], v[140:143]
ds_read_b128 v[120:123], v19 offset:36864
ds_read_b128 v[124:127], v19 offset:38912
v_mfma_f32_16x16x32_bf16 v[156:159], v[36:39], v[76:79], v[156:159]
ds_read_b64_tr_b16 v[84:85], v9 offset:40960
ds_read_b64_tr_b16 v[86:87], v9 offset:41984
v_mfma_f32_16x16x32_bf16 v[152:155], v[36:39], v[72:75], v[152:155]
ds_read_b64_tr_b16 v[88:89], v10 offset:40960
v_mfma_f32_16x16x32_bf16 v[148:151], v[36:39], v[68:71], v[148:151]
ds_read_b64_tr_b16 v[90:91], v10 offset:41984
v_mfma_f32_16x16x32_bf16 v[144:147], v[36:39], v[64:67], v[144:147]
s_add_u32 m0, s64, 65536
ds_read_b64_tr_b16 v[92:93], v11 offset:40960
v_mfma_f32_16x16x32_bf16 v[160:163], v[40:43], v[64:67], v[160:163]
s_add_u32 s72, s81, 0
buffer_load_dwordx4 v1, s[44:47], s72 offen sc1 lds
v_mfma_f32_16x16x32_bf16 v[164:167], v[40:43], v[68:71], v[164:167]
ds_read_b64_tr_b16 v[94:95], v11 offset:41984
v_mfma_f32_16x16x32_bf16 v[168:171], v[40:43], v[72:75], v[168:171]
ds_read_b64_tr_b16 v[96:97], v12 offset:40960
v_mfma_f32_16x16x32_bf16 v[172:175], v[40:43], v[76:79], v[172:175]
ds_read_b64_tr_b16 v[98:99], v12 offset:41984
v_mfma_f32_16x16x32_bf16 v[188:191], v[44:47], v[76:79], v[188:191]
buffer_load_dwordx4 v1, s[44:47], s72 offen offset:1024 sc1 lds
v_mfma_f32_16x16x32_bf16 v[184:187], v[44:47], v[72:75], v[184:187]
ds_read_b64_tr_b16 v[100:101], v13 offset:40960
v_mfma_f32_16x16x32_bf16 v[180:183], v[44:47], v[68:71], v[180:183]
ds_read_b64_tr_b16 v[102:103], v13 offset:41984
v_mfma_f32_16x16x32_bf16 v[176:179], v[44:47], v[64:67], v[176:179]
ds_read_b64_tr_b16 v[104:105], v14 offset:40960
v_mfma_f32_16x16x32_bf16 v[192:195], v[48:51], v[64:67], v[192:195]
ds_read_b64_tr_b16 v[106:107], v14 offset:41984
v_mfma_f32_16x16x32_bf16 v[196:199], v[48:51], v[68:71], v[196:199]
buffer_load_dwordx4 v1, s[44:47], s72 offen offset:2048 sc1 lds
v_mfma_f32_16x16x32_bf16 v[200:203], v[48:51], v[72:75], v[200:203]
ds_read_b64_tr_b16 v[108:109], v15 offset:40960
v_mfma_f32_16x16x32_bf16 v[204:207], v[48:51], v[76:79], v[204:207]
ds_read_b64_tr_b16 v[110:111], v15 offset:41984
v_mfma_f32_16x16x32_bf16 v[220:223], v[52:55], v[76:79], v[220:223]
v_mfma_f32_16x16x32_bf16 v[216:219], v[52:55], v[72:75], v[216:219]
v_mfma_f32_16x16x32_bf16 v[212:215], v[52:55], v[68:71], v[212:215]
buffer_load_dwordx4 v1, s[44:47], s72 offen offset:3072 sc1 lds
v_mfma_f32_16x16x32_bf16 v[208:211], v[52:55], v[64:67], v[208:211]
v_mfma_f32_16x16x32_bf16 v[224:227], v[56:59], v[64:67], v[224:227]
v_mfma_f32_16x16x32_bf16 v[228:231], v[56:59], v[68:71], v[228:231]
v_mfma_f32_16x16x32_bf16 v[232:235], v[56:59], v[72:75], v[232:235]
v_mfma_f32_16x16x32_bf16 v[236:239], v[56:59], v[76:79], v[236:239]
v_mfma_f32_16x16x32_bf16 v[252:255], v[60:63], v[76:79], v[252:255]
v_mfma_f32_16x16x32_bf16 v[248:251], v[60:63], v[72:75], v[248:251]
v_mfma_f32_16x16x32_bf16 v[244:247], v[60:63], v[68:71], v[244:247]
s_waitcnt vmcnt(12) lgkmcnt(0)
v_mfma_f32_16x16x32_bf16 v[240:243], v[60:63], v[64:67], v[240:243]
s_barrier
v_mfma_f32_16x16x32_bf16 v[128:131], v[80:83], v[112:115], v[128:131]
s_add_u32 s81, s81, 0x8000
ds_read_b64_tr_b16 v[32:33], v8 offset:0
ds_read_b64_tr_b16 v[34:35], v8 offset:1024
v_mfma_f32_16x16x32_bf16 v[132:135], v[80:83], v[116:119], v[132:135]
s_add_u32 m0, s64, 114688
ds_read_b128 v[64:67], v16 offset:0
ds_read_b128 v[68:71], v16 offset:2048
v_mfma_f32_16x16x32_bf16 v[136:139], v[80:83], v[120:123], v[136:139]
s_add_u32 s72, s81, 16384
buffer_load_dwordx4 v1, s[44:47], s72 offen sc1 lds
v_mfma_f32_16x16x32_bf16 v[140:143], v[80:83], v[124:127], v[140:143]
ds_read_b128 v[72:75], v16 offset:4096
ds_read_b128 v[76:79], v16 offset:6144
v_mfma_f32_16x16x32_bf16 v[156:159], v[84:87], v[124:127], v[156:159]
ds_read_b64_tr_b16 v[36:37], v9 offset:0
ds_read_b64_tr_b16 v[38:39], v9 offset:1024
v_mfma_f32_16x16x32_bf16 v[152:155], v[84:87], v[120:123], v[152:155]
buffer_load_dwordx4 v1, s[44:47], s72 offen offset:1024 sc1 lds
v_mfma_f32_16x16x32_bf16 v[148:151], v[84:87], v[116:119], v[148:151]
ds_read_b64_tr_b16 v[40:41], v10 offset:0
v_mfma_f32_16x16x32_bf16 v[144:147], v[84:87], v[112:115], v[144:147]
ds_read_b64_tr_b16 v[42:43], v10 offset:1024
v_mfma_f32_16x16x32_bf16 v[160:163], v[88:91], v[112:115], v[160:163]
ds_read_b64_tr_b16 v[44:45], v11 offset:0
v_mfma_f32_16x16x32_bf16 v[164:167], v[88:91], v[116:119], v[164:167]
ds_read_b64_tr_b16 v[46:47], v11 offset:1024
v_mfma_f32_16x16x32_bf16 v[168:171], v[88:91], v[120:123], v[168:171]
buffer_store_dwordx4 a[0:3], v1, s[44:47], s80 offen sc1
v_mfma_f32_16x16x32_bf16 v[172:175], v[88:91], v[124:127], v[172:175]
ds_read_b64_tr_b16 v[48:49], v12 offset:0
v_mfma_f32_16x16x32_bf16 v[188:191], v[92:95], v[124:127], v[188:191]
ds_read_b64_tr_b16 v[50:51], v12 offset:1024
v_mfma_f32_16x16x32_bf16 v[184:187], v[92:95], v[120:123], v[184:187]
ds_read_b64_tr_b16 v[52:53], v13 offset:0
v_mfma_f32_16x16x32_bf16 v[180:183], v[92:95], v[116:119], v[180:183]
ds_read_b64_tr_b16 v[54:55], v13 offset:1024
v_mfma_f32_16x16x32_bf16 v[176:179], v[92:95], v[112:115], v[176:179]
buffer_load_dwordx4 v1, s[44:47], s72 offen offset:2048 sc1 lds
v_mfma_f32_16x16x32_bf16 v[192:195], v[96:99], v[112:115], v[192:195]
ds_read_b64_tr_b16 v[56:57], v14 offset:0
v_mfma_f32_16x16x32_bf16 v[196:199], v[96:99], v[116:119], v[196:199]
ds_read_b64_tr_b16 v[58:59], v14 offset:1024
v_mfma_f32_16x16x32_bf16 v[200:203], v[96:99], v[120:123], v[200:203]
ds_read_b64_tr_b16 v[60:61], v15 offset:0
v_mfma_f32_16x16x32_bf16 v[204:207], v[96:99], v[124:127], v[204:207]
ds_read_b64_tr_b16 v[62:63], v15 offset:1024
v_mfma_f32_16x16x32_bf16 v[220:223], v[100:103], v[124:127], v[220:223]
buffer_load_dwordx4 v1, s[44:47], s72 offen offset:3072 sc1 lds
v_mfma_f32_16x16x32_bf16 v[216:219], v[100:103], v[120:123], v[216:219]
v_mfma_f32_16x16x32_bf16 v[212:215], v[100:103], v[116:119], v[212:215]
v_mfma_f32_16x16x32_bf16 v[208:211], v[100:103], v[112:115], v[208:211]
v_mfma_f32_16x16x32_bf16 v[224:227], v[104:107], v[112:115], v[224:227]
v_mfma_f32_16x16x32_bf16 v[228:231], v[104:107], v[116:119], v[228:231]
buffer_store_dwordx4 a[0:3], v1, s[44:47], s80 offen offset:1024 sc1
v_mfma_f32_16x16x32_bf16 v[232:235], v[104:107], v[120:123], v[232:235]
v_mfma_f32_16x16x32_bf16 v[236:239], v[104:107], v[124:127], v[236:239]
v_mfma_f32_16x16x32_bf16 v[252:255], v[108:111], v[124:127], v[252:255]
v_mfma_f32_16x16x32_bf16 v[248:251], v[108:111], v[120:123], v[248:251]
v_mfma_f32_16x16x32_bf16 v[244:247], v[108:111], v[116:119], v[244:247]
s_add_u32 m0, s64, 98304
v_mfma_f32_16x16x32_bf16 v[240:243], v[108:111], v[112:115], v[240:243]
s_waitcnt lgkmcnt(0)
v_mfma_f32_16x16x32_bf16 v[128:131], v[32:35], v[64:67], v[128:131]
s_add_u32 s72, s81, 0
buffer_load_dwordx4 v1, s[44:47], s72 offen sc1 lds
v_mfma_f32_16x16x32_bf16 v[132:135], v[32:35], v[68:71], v[132:135]
ds_read_b64_tr_b16 v[80:81], v8 offset:8192
v_add_u32 v2, 0x8000, v1
v_mfma_f32_16x16x32_bf16 v[136:139], v[32:35], v[72:75], v[136:139]
ds_read_b64_tr_b16 v[82:83], v8 offset:9216
ds_read_b128 v[112:115], v17 offset:0
v_mfma_f32_16x16x32_bf16 v[140:143], v[32:35], v[76:79], v[140:143]
ds_read_b128 v[116:119], v17 offset:2048
ds_read_b128 v[120:123], v17 offset:4096
v_mfma_f32_16x16x32_bf16 v[156:159], v[36:39], v[76:79], v[156:159]
buffer_load_dwordx4 v1, s[44:47], s72 offen offset:1024 sc1 lds
v_mfma_f32_16x16x32_bf16 v[152:155], v[36:39], v[72:75], v[152:155]
ds_read_b128 v[124:127], v17 offset:6144
ds_read_b64_tr_b16 v[84:85], v9 offset:8192
v_mfma_f32_16x16x32_bf16 v[148:151], v[36:39], v[68:71], v[148:151]
ds_read_b64_tr_b16 v[86:87], v9 offset:9216
v_mfma_f32_16x16x32_bf16 v[144:147], v[36:39], v[64:67], v[144:147]
ds_read_b64_tr_b16 v[88:89], v10 offset:8192
v_mfma_f32_16x16x32_bf16 v[160:163], v[40:43], v[64:67], v[160:163]
ds_read_b64_tr_b16 v[90:91], v10 offset:9216
v_mfma_f32_16x16x32_bf16 v[164:167], v[40:43], v[68:71], v[164:167]
buffer_store_dwordx4 a[0:3], v1, s[44:47], s80 offen offset:2048 sc1
v_mfma_f32_16x16x32_bf16 v[168:171], v[40:43], v[72:75], v[168:171]
ds_read_b64_tr_b16 v[92:93], v11 offset:8192
v_mfma_f32_16x16x32_bf16 v[172:175], v[40:43], v[76:79], v[172:175]
ds_read_b64_tr_b16 v[94:95], v11 offset:9216
v_mfma_f32_16x16x32_bf16 v[188:191], v[44:47], v[76:79], v[188:191]
ds_read_b64_tr_b16 v[96:97], v12 offset:8192
v_mfma_f32_16x16x32_bf16 v[184:187], v[44:47], v[72:75], v[184:187]
ds_read_b64_tr_b16 v[98:99], v12 offset:9216
v_mfma_f32_16x16x32_bf16 v[180:183], v[44:47], v[68:71], v[180:183]
buffer_load_dwordx4 v1, s[44:47], s72 offen offset:2048 sc1 lds
v_mfma_f32_16x16x32_bf16 v[176:179], v[44:47], v[64:67], v[176:179]
ds_read_b64_tr_b16 v[100:101], v13 offset:8192
v_mfma_f32_16x16x32_bf16 v[192:195], v[48:51], v[64:67], v[192:195]
ds_read_b64_tr_b16 v[102:103], v13 offset:9216
v_mfma_f32_16x16x32_bf16 v[196:199], v[48:51], v[68:71], v[196:199]
ds_read_b64_tr_b16 v[104:105], v14 offset:8192
v_mfma_f32_16x16x32_bf16 v[200:203], v[48:51], v[72:75], v[200:203]
ds_read_b64_tr_b16 v[106:107], v14 offset:9216
v_mfma_f32_16x16x32_bf16 v[204:207], v[48:51], v[76:79], v[204:207]
buffer_load_dwordx4 v1, s[44:47], s72 offen offset:3072 sc1 lds
v_mfma_f32_16x16x32_bf16 v[220:223], v[52:55], v[76:79], v[220:223]
ds_read_b64_tr_b16 v[108:109], v15 offset:8192
v_mfma_f32_16x16x32_bf16 v[216:219], v[52:55], v[72:75], v[216:219]
ds_read_b64_tr_b16 v[110:111], v15 offset:9216
v_mfma_f32_16x16x32_bf16 v[212:215], v[52:55], v[68:71], v[212:215]
v_mfma_f32_16x16x32_bf16 v[208:211], v[52:55], v[64:67], v[208:211]
v_mfma_f32_16x16x32_bf16 v[224:227], v[56:59], v[64:67], v[224:227]
buffer_store_dwordx4 a[0:3], v1, s[44:47], s80 offen offset:3072 sc1
v_mfma_f32_16x16x32_bf16 v[228:231], v[56:59], v[68:71], v[228:231]
v_mfma_f32_16x16x32_bf16 v[232:235], v[56:59], v[72:75], v[232:235]
v_mfma_f32_16x16x32_bf16 v[236:239], v[56:59], v[76:79], v[236:239]
v_mfma_f32_16x16x32_bf16 v[252:255], v[60:63], v[76:79], v[252:255]
v_mfma_f32_16x16x32_bf16 v[248:251], v[60:63], v[72:75], v[248:251]
v_lshrrev_b32 v3, 1, v0
v_lshlrev_b32 v3, 7, v3
v_mfma_f32_16x16x32_bf16 v[244:247], v[60:63], v[68:71], v[244:247]
s_waitcnt vmcnt(20) lgkmcnt(0)
buffer_load_dword v4, v3, s[36:39], s93 offen
v_mfma_f32_16x16x32_bf16 v[240:243], v[60:63], v[64:67], v[240:243]
s_barrier
v_mfma_f32_16x16x32_bf16 v[128:131], v[80:83], v[112:115], v[128:131]
ds_read_b128 a[128:131], v2 offset:16384
v_mfma_f32_16x16x32_bf16 v[132:135], v[80:83], v[116:119], v[132:135]
ds_read_b128 a[132:135], v2 offset:17408
v_mfma_f32_16x16x32_bf16 v[136:139], v[80:83], v[120:123], v[136:139]
ds_read_b128 a[136:139], v2 offset:18432
v_mfma_f32_16x16x32_bf16 v[140:143], v[80:83], v[124:127], v[140:143]
ds_read_b128 a[140:143], v2 offset:19456
v_mfma_f32_16x16x32_bf16 v[156:159], v[84:87], v[124:127], v[156:159]
ds_read_b128 a[144:147], v2 offset:20480
v_mfma_f32_16x16x32_bf16 v[152:155], v[84:87], v[120:123], v[152:155]
ds_read_b128 a[148:151], v2 offset:21504
v_mfma_f32_16x16x32_bf16 v[148:151], v[84:87], v[116:119], v[148:151]
ds_read_b128 a[152:155], v2 offset:22528
v_mfma_f32_16x16x32_bf16 v[144:147], v[84:87], v[112:115], v[144:147]
ds_read_b128 a[156:159], v2 offset:23552
v_mfma_f32_16x16x32_bf16 v[160:163], v[88:91], v[112:115], v[160:163]
v_mfma_f32_16x16x32_bf16 v[164:167], v[88:91], v[116:119], v[164:167]
v_mfma_f32_16x16x32_bf16 v[168:171], v[88:91], v[120:123], v[168:171]
v_mfma_f32_16x16x32_bf16 v[172:175], v[88:91], v[124:127], v[172:175]
v_mfma_f32_16x16x32_bf16 v[188:191], v[92:95], v[124:127], v[188:191]
v_cvt_pk_bf16_f32 v64, v140, v141
v_cvt_pk_bf16_f32 v65, v142, v143
v_mfma_f32_16x16x32_bf16 v[184:187], v[92:95], v[120:123], v[184:187]
v_cvt_pk_bf16_f32 v66, v156, v157
v_cvt_pk_bf16_f32 v67, v158, v159
v_mfma_f32_16x16x32_bf16 v[180:183], v[92:95], v[116:119], v[180:183]
v_cvt_pk_bf16_f32 v48, v136, v137
v_cvt_pk_bf16_f32 v49, v138, v139
v_mfma_f32_16x16x32_bf16 v[176:179], v[92:95], v[112:115], v[176:179]
v_cvt_pk_bf16_f32 v50, v152, v153
v_cvt_pk_bf16_f32 v51, v154, v155
v_mfma_f32_16x16x32_bf16 v[192:195], v[96:99], v[112:115], v[192:195]
v_cvt_pk_bf16_f32 v32, v132, v133
v_cvt_pk_bf16_f32 v33, v134, v135
v_mfma_f32_16x16x32_bf16 v[196:199], v[96:99], v[116:119], v[196:199]
v_cvt_pk_bf16_f32 v34, v148, v149
v_cvt_pk_bf16_f32 v35, v150, v151
v_mfma_f32_16x16x32_bf16 v[200:203], v[96:99], v[120:123], v[200:203]
v_cvt_pk_bf16_f32 v16, v128, v129
v_cvt_pk_bf16_f32 v17, v130, v131
v_mfma_f32_16x16x32_bf16 v[204:207], v[96:99], v[124:127], v[204:207]
v_cvt_pk_bf16_f32 v18, v144, v145
v_cvt_pk_bf16_f32 v19, v146, v147
v_mfma_f32_16x16x32_bf16 v[220:223], v[100:103], v[124:127], v[220:223]
v_cvt_pk_bf16_f32 v68, v172, v173
v_cvt_pk_bf16_f32 v69, v174, v175
v_mfma_f32_16x16x32_bf16 v[216:219], v[100:103], v[120:123], v[216:219]
v_cvt_pk_bf16_f32 v70, v188, v189
v_cvt_pk_bf16_f32 v71, v190, v191
v_mfma_f32_16x16x32_bf16 v[212:215], v[100:103], v[116:119], v[212:215]
v_cvt_pk_bf16_f32 v52, v168, v169
v_cvt_pk_bf16_f32 v53, v170, v171
v_mfma_f32_16x16x32_bf16 v[208:211], v[100:103], v[112:115], v[208:211]
v_cvt_pk_bf16_f32 v54, v184, v185
v_cvt_pk_bf16_f32 v55, v186, v187
v_mfma_f32_16x16x32_bf16 v[224:227], v[104:107], v[112:115], v[224:227]
v_cvt_pk_bf16_f32 v36, v164, v165
v_cvt_pk_bf16_f32 v37, v166, v167
v_mfma_f32_16x16x32_bf16 v[228:231], v[104:107], v[116:119], v[228:231]
v_cvt_pk_bf16_f32 v38, v180, v181
v_cvt_pk_bf16_f32 v39, v182, v183
v_mfma_f32_16x16x32_bf16 v[232:235], v[104:107], v[120:123], v[232:235]
v_cvt_pk_bf16_f32 v20, v160, v161
v_cvt_pk_bf16_f32 v21, v162, v163
v_mfma_f32_16x16x32_bf16 v[236:239], v[104:107], v[124:127], v[236:239]
v_cvt_pk_bf16_f32 v22, v176, v177
v_cvt_pk_bf16_f32 v23, v178, v179
v_mfma_f32_16x16x32_bf16 v[252:255], v[108:111], v[124:127], v[252:255]
v_cvt_pk_bf16_f32 v72, v204, v205
v_cvt_pk_bf16_f32 v73, v206, v207
v_mfma_f32_16x16x32_bf16 v[248:251], v[108:111], v[120:123], v[248:251]
v_cvt_pk_bf16_f32 v74, v220, v221
v_cvt_pk_bf16_f32 v75, v222, v223
v_mfma_f32_16x16x32_bf16 v[244:247], v[108:111], v[116:119], v[244:247]
v_cvt_pk_bf16_f32 v56, v200, v201
v_cvt_pk_bf16_f32 v57, v202, v203
v_mfma_f32_16x16x32_bf16 v[240:243], v[108:111], v[112:115], v[240:243]
v_cvt_pk_bf16_f32 v58, v216, v217
v_cvt_pk_bf16_f32 v59, v218, v219
v_cvt_pk_bf16_f32 v40, v196, v197
v_cvt_pk_bf16_f32 v41, v198, v199
v_cvt_pk_bf16_f32 v42, v212, v213
v_cvt_pk_bf16_f32 v43, v214, v215
v_cvt_pk_bf16_f32 v24, v192, v193
v_cvt_pk_bf16_f32 v25, v194, v195
v_cvt_pk_bf16_f32 v26, v208, v209
v_cvt_pk_bf16_f32 v27, v210, v211
v_cvt_pk_bf16_f32 v76, v236, v237
v_cvt_pk_bf16_f32 v77, v238, v239
v_cvt_pk_bf16_f32 v78, v252, v253
v_cvt_pk_bf16_f32 v79, v254, v255
v_cvt_pk_bf16_f32 v60, v232, v233
v_cvt_pk_bf16_f32 v61, v234, v235
v_cvt_pk_bf16_f32 v62, v248, v249
v_cvt_pk_bf16_f32 v63, v250, v251
v_cvt_pk_bf16_f32 v44, v228, v229
v_cvt_pk_bf16_f32 v45, v230, v231
v_cvt_pk_bf16_f32 v46, v244, v245
v_cvt_pk_bf16_f32 v47, v246, v247
v_cvt_pk_bf16_f32 v28, v224, v225
v_cvt_pk_bf16_f32 v29, v226, v227
v_cvt_pk_bf16_f32 v30, v240, v241
v_cvt_pk_bf16_f32 v31, v242, v243
v_mov_b32 v124, 0xff800000
v_mov_b32 v125, 0xff800000
v_mov_b32 v126, 0xff800000
v_mov_b32 v127, 0xff800000
s_lshl_b32 s84, s60, 2
s_add_u32 s84, s84, s58
s_mov_b32 s86, 0
s_add_u32 s61, s65, s60
s_and_b32 s73, s60, 1
s_lshl_b32 s73, s73, 16
s_add_u32 s77, s73, s64
s_xor_b32 s73, s73, 0x10000
s_mov_b32 s92, s73
s_mul_i32 s62, s58, 4608
s_add_u32 s62, s62, 143104
s_add_u32 s73, s73, 49920
s_cmp_eq_u32 s58, 0
s_cselect_b32 s62, s73, s62
Lattn:
s_mov_b32 s82, 0x10000
s_waitcnt lgkmcnt(0)
v_mfma_f32_16x16x32_bf16 v[136:139], a[128:131], v[48:51], 0
ds_read_b128 a[160:163], v2 offset:24576
v_lshrrev_b32 v240, 4, v0
v_mfma_f32_16x16x32_bf16 v[136:139], a[132:135], v[52:55], v[136:139]
ds_read_b128 a[164:167], v2 offset:25600
v_and_b32 v241, 15, v0
v_mfma_f32_16x16x32_bf16 v[136:139], a[136:139], v[56:59], v[136:139]
ds_read_b128 a[168:171], v2 offset:26624
v_lshlrev_b32 v240, 2, v240
v_mfma_f32_16x16x32_bf16 v[136:139], a[140:143], v[60:63], v[136:139]
ds_read_b128 a[172:175], v2 offset:27648
v_sub_u32 v240, v241, v240
v_mfma_f32_16x16x32_bf16 v[140:143], a[140:143], v[76:79], 0
ds_read_b128 a[176:179], v2 offset:28672
v_mov_b32 v112, 0xff800000
v_mfma_f32_16x16x32_bf16 v[140:143], a[136:139], v[72:75], v[140:143]
ds_read_b128 a[180:183], v2 offset:29696
v_mov_b32 v113, 0xff800000
v_mfma_f32_16x16x32_bf16 v[140:143], a[132:135], v[68:71], v[140:143]
ds_read_b128 a[184:187], v2 offset:30720
v_mov_b32 v114, 0xff800000
v_mfma_f32_16x16x32_bf16 v[140:143], a[128:131], v[64:67], v[140:143]
ds_read_b128 a[188:191], v2 offset:31744
v_mov_b32 v115, 0xff800000
v_mfma_f32_16x16x32_bf16 v[156:159], a[144:147], v[64:67], 0
v_cmp_gt_i32 vcc, 0, v240
v_mov_b32 v120, 0x3f803f80
v_mfma_f32_16x16x32_bf16 v[156:159], a[148:151], v[68:71], v[156:159]
v_cndmask_b32 v116, 0, v112, vcc
v_cmp_gt_i32 vcc, 1, v240
v_mfma_f32_16x16x32_bf16 v[156:159], a[152:155], v[72:75], v[156:159]
v_mov_b32 v121, 0x3f803f80
v_cndmask_b32 v117, 0, v112, vcc
v_mfma_f32_16x16x32_bf16 v[156:159], a[156:159], v[76:79], v[156:159]
v_cmp_gt_i32 vcc, 2, v240
v_mov_b32 v122, 0x3f803f80
v_mfma_f32_16x16x32_bf16 v[152:155], a[156:159], v[60:63], 0
v_cndmask_b32 v118, 0, v112, vcc
v_cmp_gt_i32 vcc, 3, v240
v_mfma_f32_16x16x32_bf16 v[152:155], a[152:155], v[56:59], v[152:155]
v_mov_b32 v123, 0x3f803f80
v_cndmask_b32 v119, 0, v112, vcc
v_mfma_f32_16x16x32_bf16 v[152:155], a[148:151], v[52:55], v[152:155]
v_mfma_f32_16x16x32_bf16 v[152:155], a[144:147], v[48:51], v[152:155]
s_cmp_eq_u32 s84, 0
s_cbranch_scc1 Lta7
s_cmp_eq_u32 s84, 1
s_cbranch_scc1 Lnt8
v_mfma_f32_16x16x32_bf16 v[128:131], a[128:131], v[16:19], 0
v_mfma_f32_16x16x32_bf16 v[144:147], a[144:147], v[16:19], 0
s_branch Ljoin9
Lta7:
v_mfma_f32_16x16x32_bf16 v[128:131], a[128:131], v[16:19], v[116:119]
v_mfma_f32_16x16x32_bf16 v[144:147], a[144:147], v[16:19], v[112:115]
s_branch Ljoin9
Lnt8:
v_mfma_f32_16x16x32_bf16 v[128:131], a[128:131], v[16:19], 0
v_mfma_f32_16x16x32_bf16 v[144:147], a[144:147], v[16:19], v[116:119]
Ljoin9:
v_mfma_f32_16x16x32_bf16 v[128:131], a[132:135], v[20:23], v[128:131]
v_mfma_f32_16x16x32_bf16 v[128:131], a[136:139], v[24:27], v[128:131]
v_mfma_f32_16x16x32_bf16 v[128:131], a[140:143], v[28:31], v[128:131]
v_max3_f32 v240, v136, v137, v126
v_max3_f32 v242, v140, v141, v127
v_mfma_f32_16x16x32_bf16 v[132:135], a[140:143], v[44:47], 0
v_max3_f32 v240, v240, v138, v139
v_max3_f32 v242, v242, v142, v143
v_mfma_f32_16x16x32_bf16 v[132:135], a[136:139], v[40:43], v[132:135]
v_max3_f32 v240, v240, v152, v153
v_max3_f32 v242, v242, v156, v157
v_mfma_f32_16x16x32_bf16 v[132:135], a[132:135], v[36:39], v[132:135]
v_max3_f32 v240, v240, v154, v155
v_max3_f32 v242, v242, v158, v159
v_mfma_f32_16x16x32_bf16 v[132:135], a[128:131], v[32:35], v[132:135]
v_mov_b32 v241, v240
v_mov_b32 v243, v242
v_mfma_f32_16x16x32_bf16 v[148:151], a[144:147], v[32:35], 0
v_permlane16_swap_b32 v240, v241
v_permlane16_swap_b32 v242, v243
v_mfma_f32_16x16x32_bf16 v[148:151], a[148:151], v[36:39], v[148:151]
v_max_f32 v240, v240, v241
v_max_f32 v242, v242, v243
v_mfma_f32_16x16x32_bf16 v[148:151], a[152:155], v[40:43], v[148:151]
v_mov_b32 v241, v240
v_mov_b32 v243, v242
v_mfma_f32_16x16x32_bf16 v[148:151], a[156:159], v[44:47], v[148:151]
v_permlane32_swap_b32 v240, v241
v_permlane32_swap_b32 v242, v243
v_mfma_f32_16x16x32_bf16 v[144:147], a[156:159], v[28:31], v[144:147]
v_max_f32 v240, v240, v241
v_max_f32 v242, v242, v243
v_mfma_f32_16x16x32_bf16 v[144:147], a[152:155], v[24:27], v[144:147]
v_mfma_f32_16x16x32_bf16 v[144:147], a[148:151], v[20:23], v[144:147]
v_sub_f32 v88, 0, v240
v_sub_f32 v89, 0, v240
v_pk_add_f32 v[90:91], v[88:89], 0
v_pk_add_f32 v[104:105], v[116:117], v[88:89]
v_pk_add_f32 v[106:107], v[118:119], v[88:89]
v_pk_add_f32 v[136:137], v[136:137], v[88:89]
v_pk_add_f32 v[138:139], v[138:139], v[88:89]
v_pk_add_f32 v[152:153], v[152:153], v[88:89]
v_pk_add_f32 v[154:155], v[154:155], v[88:89]
v_sub_f32 v92, 0, v242
v_sub_f32 v93, 0, v242
v_pk_add_f32 v[94:95], v[92:93], 0
v_pk_add_f32 v[108:109], v[116:117], v[92:93]
v_pk_add_f32 v[110:111], v[118:119], v[92:93]
v_pk_add_f32 v[140:141], v[140:141], v[92:93]
v_pk_add_f32 v[142:143], v[142:143], v[92:93]
v_pk_add_f32 v[156:157], v[156:157], v[92:93]
v_pk_add_f32 v[158:159], v[158:159], v[92:93]
v_max3_f32 v240, v128, v129, v124
v_max3_f32 v242, v132, v133, v125
v_max3_f32 v240, v240, v130, v131
v_max3_f32 v242, v242, v134, v135
v_max3_f32 v240, v240, v144, v145
v_max3_f32 v242, v242, v148, v149
v_max3_f32 v240, v240, v146, v147
v_max3_f32 v242, v242, v150, v151
v_mov_b32 v241, v240
v_mov_b32 v243, v242
s_nop 0
v_permlane16_swap_b32 v240, v241
v_permlane16_swap_b32 v242, v243
v_max_f32 v240, v240, v241
v_max_f32 v242, v242, v243
v_mov_b32 v241, v240
v_mov_b32 v243, v242
s_nop 0
v_permlane32_swap_b32 v240, v241
v_permlane32_swap_b32 v242, v243
v_max_f32 v240, v240, v241
v_max_f32 v242, v242, v243
v_sub_f32 v80, 0, v240
v_sub_f32 v81, 0, v240
v_pk_add_f32 v[82:83], v[80:81], 0
v_pk_add_f32 v[96:97], v[116:117], v[80:81]
v_pk_add_f32 v[98:99], v[118:119], v[80:81]
v_pk_add_f32 v[128:129], v[128:129], v[80:81]
v_pk_add_f32 v[130:131], v[130:131], v[80:81]
v_pk_add_f32 v[144:145], v[144:145], v[80:81]
v_pk_add_f32 v[146:147], v[146:147], v[80:81]
v_sub_f32 v84, 0, v242
v_sub_f32 v85, 0, v242
v_pk_add_f32 v[86:87], v[84:85], 0
v_pk_add_f32 v[100:101], v[116:117], v[84:85]
v_pk_add_f32 v[102:103], v[118:119], v[84:85]
v_pk_add_f32 v[132:133], v[132:133], v[84:85]
v_pk_add_f32 v[134:135], v[134:135], v[84:85]
v_pk_add_f32 v[148:149], v[148:149], v[84:85]
v_pk_add_f32 v[150:151], v[150:151], v[84:85]
v_add_u32 v2, s82, v1
s_waitcnt vmcnt(13) lgkmcnt(0)
s_barrier
s_cmp_eq_u32 s60, 0
s_cbranch_scc1 LP0x
v_mfma_f32_16x16x32_bf16 v[160:163], a[160:163], v[16:19], v[80:83]
s_xor_b32 s74, s82, 0x10000
v_exp_f32 v128, v128
v_mfma_f32_16x16x32_bf16 v[160:163], a[164:167], v[20:23], v[160:163]
s_add_u32 s74, s74, s64
ds_read_b128 a[128:131], v2 offset:16384
ds_read_b128 a[132:135], v2 offset:17408
v_mfma_f32_16x16x32_bf16 v[160:163], a[168:171], v[24:27], v[160:163]
s_add_u32 s81, s81, 0x8000
v_exp_f32 v129, v129
v_mfma_f32_16x16x32_bf16 v[160:163], a[172:175], v[28:31], v[160:163]
s_add_u32 m0, s74, 16384
v_exp_f32 v130, v130
v_mfma_f32_16x16x32_bf16 v[164:167], a[172:175], v[44:47], v[84:87]
s_add_u32 s72, s81, 16384
v_exp_f32 v131, v131
v_mfma_f32_16x16x32_bf16 v[164:167], a[168:171], v[40:43], v[164:167]
v_exp_f32 v144, v144
v_mfma_f32_16x16x32_bf16 v[164:167], a[164:167], v[36:39], v[164:167]
ds_read_b128 a[136:139], v2 offset:18432
ds_read_b128 a[140:143], v2 offset:19456
v_mfma_f32_16x16x32_bf16 v[164:167], a[160:163], v[32:35], v[164:167]
ds_read_b128 a[144:147], v2 offset:20480
ds_read_b128 a[148:151], v2 offset:21504
v_mfma_f32_16x16x32_bf16 v[168:171], a[160:163], v[48:51], v[88:91]
ds_read_b128 a[152:155], v2 offset:22528
ds_read_b128 a[156:159], v2 offset:23552
v_mfma_f32_16x16x32_bf16 v[168:171], a[164:167], v[52:55], v[168:171]
ds_read_b128 a[192:195], v2 offset:0
ds_read_b128 a[196:199], v2 offset:1024
v_mfma_f32_16x16x32_bf16 v[168:171], a[168:171], v[56:59], v[168:171]
ds_read_b128 a[200:203], v2 offset:2048
ds_read_b128 a[204:207], v2 offset:3072
v_mfma_f32_16x16x32_bf16 v[168:171], a[172:175], v[60:63], v[168:171]
ds_read_b128 a[208:211], v2 offset:4096
ds_read_b128 a[212:215], v2 offset:5120
v_mfma_f32_16x16x32_bf16 v[172:175], a[172:175], v[76:79], v[92:95]
ds_read_b128 a[216:219], v2 offset:6144
ds_read_b128 a[220:223], v2 offset:7168
v_mfma_f32_16x16x32_bf16 v[172:175], a[168:171], v[72:75], v[172:175]
v_cvt_pk_bf16_f32 v192, v128, v129
v_cvt_pk_bf16_f32 v193, v130, v131
v_mfma_f32_16x16x32_bf16 v[172:175], a[164:167], v[68:71], v[172:175]
buffer_load_dwordx4 v1, s[44:47], s72 offen sc1 lds
v_mfma_f32_16x16x32_bf16 v[172:175], a[160:163], v[64:67], v[172:175]
v_exp_f32 v145, v145
v_mfma_f32_16x16x32_bf16 v[188:191], a[176:179], v[64:67], v[92:95]
v_exp_f32 v146, v146
v_mfma_f32_16x16x32_bf16 v[188:191], a[180:183], v[68:71], v[188:191]
v_exp_f32 v147, v147
v_mfma_f32_16x16x32_bf16 v[188:191], a[184:187], v[72:75], v[188:191]
v_exp_f32 v132, v132
v_mfma_f32_16x16x32_bf16 v[188:191], a[188:191], v[76:79], v[188:191]
v_cvt_pk_bf16_f32 v194, v144, v145
v_cvt_pk_bf16_f32 v195, v146, v147
v_mfma_f32_16x16x32_bf16 v[184:187], a[188:191], v[60:63], v[88:91]
v_exp_f32 v133, v133
v_mfma_f32_16x16x32_bf16 v[184:187], a[184:187], v[56:59], v[184:187]
v_exp_f32 v134, v134
v_mfma_f32_16x16x32_bf16 v[184:187], a[180:183], v[52:55], v[184:187]
v_exp_f32 v135, v135
v_mfma_f32_16x16x32_bf16 v[184:187], a[176:179], v[48:51], v[184:187]
v_exp_f32 v148, v148
v_mfma_f32_16x16x32_bf16 v[180:183], a[176:179], v[32:35], v[84:87]
v_cvt_pk_bf16_f32 v196, v132, v133
v_cvt_pk_bf16_f32 v197, v134, v135
v_mfma_f32_16x16x32_bf16 v[180:183], a[180:183], v[36:39], v[180:183]
buffer_load_dwordx4 v1, s[44:47], s72 offen offset:1024 sc1 lds
v_mfma_f32_16x16x32_bf16 v[180:183], a[184:187], v[40:43], v[180:183]
Lstub0:
s_cbranch_execz Lstub4
v_exp_f32 v149, v149
v_mfma_f32_16x16x32_bf16 v[180:183], a[188:191], v[44:47], v[180:183]
v_exp_f32 v150, v150
v_mfma_f32_16x16x32_bf16 v[176:179], a[188:191], v[28:31], v[80:83]
v_exp_f32 v151, v151
v_mfma_f32_16x16x32_bf16 v[176:179], a[184:187], v[24:27], v[176:179]
buffer_load_dwordx4 v1, s[44:47], s72 offen offset:2048 sc1 lds
v_mfma_f32_16x16x32_bf16 v[176:179], a[180:183], v[20:23], v[176:179]
buffer_load_dwordx4 v1, s[44:47], s72 offen offset:3072 sc1 lds
v_mfma_f32_16x16x32_bf16 v[176:179], a[176:179], v[16:19], v[176:179]
s_waitcnt lgkmcnt(8)
v_exp_f32 v136, v136
v_cvt_pk_bf16_f32 v198, v148, v149
v_cvt_pk_bf16_f32 v199, v150, v151
v_exp_f32 v137, v137
v_exp_f32 v138, v138
v_cvt_pk_bf16_f32 v200, v136, v137
v_exp_f32 v139, v139
v_exp_f32 v152, v152
v_cvt_pk_bf16_f32 v201, v138, v139
v_exp_f32 v153, v153
v_exp_f32 v154, v154
v_cvt_pk_bf16_f32 v202, v152, v153
v_exp_f32 v155, v155
v_exp_f32 v140, v140
v_cvt_pk_bf16_f32 v203, v154, v155
v_exp_f32 v141, v141
v_exp_f32 v142, v142
v_cvt_pk_bf16_f32 v204, v140, v141
v_exp_f32 v143, v143
v_exp_f32 v156, v156
v_cvt_pk_bf16_f32 v205, v142, v143
v_exp_f32 v157, v157
v_exp_f32 v158, v158
v_cvt_pk_bf16_f32 v206, v156, v157
v_exp_f32 v159, v159
s_nop 0
v_cvt_pk_bf16_f32 v207, v158, v159
v_mfma_f32_16x16x32_bf16 v[128:131], a[128:131], v[16:19], v[80:83]
s_add_u32 s82, s82, 0x8000
ds_read_b128 a[160:163], v2 offset:24576
v_mfma_f32_16x16x32_bf16 v[128:131], a[132:135], v[20:23], v[128:131]
s_and_b32 s82, s82, 0x1ffff
v_exp_f32 v160, v160
v_mfma_f32_16x16x32_bf16 v[128:131], a[136:139], v[24:27], v[128:131]
s_add_u32 m0, s74, 0
v_exp_f32 v161, v161
v_mfma_f32_16x16x32_bf16 v[128:131], a[140:143], v[28:31], v[128:131]
s_add_u32 s72, s81, 0
ds_read_b128 a[164:167], v2 offset:25600
v_cvt_pk_bf16_f32 v208, v160, v161
v_mfma_f32_16x16x32_bf16 v[132:135], a[140:143], v[44:47], v[84:87]
v_exp_f32 v162, v162
v_mfma_f32_16x16x32_bf16 v[132:135], a[136:139], v[40:43], v[132:135]
buffer_load_dwordx4 v1, s[44:47], s72 offen sc1 lds
v_mfma_f32_16x16x32_bf16 v[132:135], a[132:135], v[36:39], v[132:135]
v_exp_f32 v163, v163
v_mfma_f32_16x16x32_bf16 v[132:135], a[128:131], v[32:35], v[132:135]
ds_read_b128 a[168:171], v2 offset:26624
v_cvt_pk_bf16_f32 v209, v162, v163
v_mfma_f32_16x16x32_bf16 v[136:139], a[128:131], v[48:51], v[88:91]
v_exp_f32 v176, v176
v_mfma_f32_16x16x32_bf16 v[136:139], a[132:135], v[52:55], v[136:139]
v_exp_f32 v177, v177
v_mfma_f32_16x16x32_bf16 v[136:139], a[136:139], v[56:59], v[136:139]
ds_read_b128 a[172:175], v2 offset:27648
v_cvt_pk_bf16_f32 v210, v176, v177
v_mfma_f32_16x16x32_bf16 v[136:139], a[140:143], v[60:63], v[136:139]
v_exp_f32 v178, v178
v_mfma_f32_16x16x32_bf16 v[140:143], a[140:143], v[76:79], v[92:95]
buffer_load_dwordx4 v1, s[44:47], s72 offen offset:1024 sc1 lds
v_mfma_f32_16x16x32_bf16 v[140:143], a[136:139], v[72:75], v[140:143]
v_exp_f32 v179, v179
v_mfma_f32_16x16x32_bf16 v[140:143], a[132:135], v[68:71], v[140:143]
ds_read_b128 a[176:179], v2 offset:28672
v_cvt_pk_bf16_f32 v211, v178, v179
v_mfma_f32_16x16x32_bf16 v[140:143], a[128:131], v[64:67], v[140:143]
v_exp_f32 v164, v164
v_mfma_f32_16x16x32_bf16 v[156:159], a[144:147], v[64:67], v[92:95]
v_exp_f32 v165, v165
v_mfma_f32_16x16x32_bf16 v[156:159], a[148:151], v[68:71], v[156:159]
ds_read_b128 a[180:183], v2 offset:29696
v_cvt_pk_bf16_f32 v212, v164, v165
v_mfma_f32_16x16x32_bf16 v[156:159], a[152:155], v[72:75], v[156:159]
v_exp_f32 v166, v166
v_mfma_f32_16x16x32_bf16 v[156:159], a[156:159], v[76:79], v[156:159]
buffer_load_dwordx4 v1, s[44:47], s72 offen offset:2048 sc1 lds
v_mfma_f32_16x16x32_bf16 v[152:155], a[156:159], v[60:63], v[88:91]
v_exp_f32 v167, v167
v_mfma_f32_16x16x32_bf16 v[152:155], a[152:155], v[56:59], v[152:155]
ds_read_b128 a[184:187], v2 offset:30720
v_cvt_pk_bf16_f32 v213, v166, v167
v_mfma_f32_16x16x32_bf16 v[152:155], a[148:151], v[52:55], v[152:155]
v_exp_f32 v180, v180
v_mfma_f32_16x16x32_bf16 v[152:155], a[144:147], v[48:51], v[152:155]
v_exp_f32 v181, v181
v_mfma_f32_16x16x32_bf16 v[148:151], a[144:147], v[32:35], v[84:87]
ds_read_b128 a[188:191], v2 offset:31744
v_cvt_pk_bf16_f32 v214, v180, v181
v_mfma_f32_16x16x32_bf16 v[148:151], a[148:151], v[36:39], v[148:151]
v_exp_f32 v182, v182
v_mfma_f32_16x16x32_bf16 v[148:151], a[152:155], v[40:43], v[148:151]
buffer_load_dwordx4 v1, s[44:47], s72 offen offset:3072 sc1 lds
v_mfma_f32_16x16x32_bf16 v[148:151], a[156:159], v[44:47], v[148:151]
s_add_u32 s66, s58, 1
v_exp_f32 v183, v183
v_mfma_f32_16x16x32_bf16 v[144:147], a[156:159], v[28:31], v[80:83]
s_and_b32 s66, s66, 3
ds_read_b128 a[224:227], v2 offset:8192
v_cvt_pk_bf16_f32 v215, v182, v183
v_mfma_f32_16x16x32_bf16 v[144:147], a[152:155], v[24:27], v[144:147]
s_mul_i32 s66, s66, 4160
v_exp_f32 v168, v168
v_mfma_f32_16x16x32_bf16 v[144:147], a[148:151], v[20:23], v[144:147]
s_add_u32 m0, s66, 131104
v_exp_f32 v169, v169
v_mfma_f32_16x16x32_bf16 v[144:147], a[144:147], v[16:19], v[144:147]
s_waitcnt lgkmcnt(9)
ds_read_b128 a[228:231], v2 offset:9216
v_cvt_pk_bf16_f32 v216, v168, v169
v_mfma_f32_16x16x32_bf16 a[0:3], a[192:195], v[192:195], 0
s_add_u32 s72, s93, 0x2
v_exp_f32 v170, v170
v_mfma_f32_16x16x32_bf16 a[32:35], a[192:195], v[196:199], 0
buffer_load_dwordx4 v1, s[36:39], s72 offen lds
v_mfma_f32_16x16x32_bf16 a[64:67], a[192:195], v[200:203], 0
v_exp_f32 v171, v171
v_mfma_f32_16x16x32_bf16 a[96:99], a[192:195], v[204:207], 0
ds_read_b128 a[232:235], v2 offset:10240
v_cvt_pk_bf16_f32 v217, v170, v171
v_mfma_f32_16x16x32_bf16 a[100:103], a[196:199], v[204:207], 0
v_exp_f32 v184, v184
v_mfma_f32_16x16x32_bf16 a[68:71], a[196:199], v[200:203], 0
v_exp_f32 v185, v185
v_mfma_f32_16x16x32_bf16 a[36:39], a[196:199], v[196:199], 0
ds_read_b128 a[236:239], v2 offset:11264
v_cvt_pk_bf16_f32 v218, v184, v185
v_mfma_f32_16x16x32_bf16 a[4:7], a[196:199], v[192:195], 0
v_exp_f32 v186, v186
v_mfma_f32_16x16x32_bf16 a[8:11], a[200:203], v[192:195], 0
buffer_load_dwordx4 v1, s[36:39], s72 offen offset:1024 lds
v_mfma_f32_16x16x32_bf16 a[40:43], a[200:203], v[196:199], 0
v_exp_f32 v187, v187
v_mfma_f32_16x16x32_bf16 a[72:75], a[200:203], v[200:203], 0
ds_read_b128 a[240:243], v2 offset:12288
v_cvt_pk_bf16_f32 v219, v186, v187
v_mfma_f32_16x16x32_bf16 a[104:107], a[200:203], v[204:207], 0
v_exp_f32 v172, v172
v_mfma_f32_16x16x32_bf16 a[108:111], a[204:207], v[204:207], 0
v_exp_f32 v173, v173
v_mfma_f32_16x16x32_bf16 a[76:79], a[204:207], v[200:203], 0
ds_read_b128 a[244:247], v2 offset:13312
v_cvt_pk_bf16_f32 v220, v172, v173
v_mfma_f32_16x16x32_bf16 a[44:47], a[204:207], v[196:199], 0
v_exp_f32 v174, v174
v_mfma_f32_16x16x32_bf16 a[12:15], a[204:207], v[192:195], 0
buffer_load_dwordx4 v1, s[36:39], s72 offen offset:2048 lds
v_mfma_f32_16x16x32_bf16 a[16:19], a[208:211], v[192:195], 0
v_exp_f32 v175, v175
v_mfma_f32_16x16x32_bf16 a[48:51], a[208:211], v[196:199], 0
ds_read_b128 a[248:251], v2 offset:14336
v_cvt_pk_bf16_f32 v221, v174, v175
v_mfma_f32_16x16x32_bf16 a[80:83], a[208:211], v[200:203], 0
v_exp_f32 v188, v188
v_mfma_f32_16x16x32_bf16 a[112:115], a[208:211], v[204:207], 0
v_exp_f32 v189, v189
v_mfma_f32_16x16x32_bf16 a[116:119], a[212:215], v[204:207], 0
ds_read_b128 a[252:255], v2 offset:15360
v_cvt_pk_bf16_f32 v222, v188, v189
v_mfma_f32_16x16x32_bf16 a[84:87], a[212:215], v[200:203], 0
v_exp_f32 v190, v190
v_mfma_f32_16x16x32_bf16 a[52:55], a[212:215], v[196:199], 0
buffer_load_dwordx4 v1, s[36:39], s72 offen offset:3072 lds
v_mfma_f32_16x16x32_bf16 a[20:23], a[212:215], v[192:195], 0
v_exp_f32 v191, v191
v_mfma_f32_16x16x32_bf16 a[24:27], a[216:219], v[192:195], 0
v_cvt_pk_bf16_f32 v223, v190, v191
v_add_u32 v2, s82, v1
v_mfma_f32_16x16x32_bf16 a[56:59], a[216:219], v[196:199], 0
v_and_b32 v240, 15, v0
v_lshrrev_b32 v241, 4, v0
v_mfma_f32_16x16x32_bf16 a[88:91], a[216:219], v[200:203], 0
v_add_u32 v248, 1, v240
v_and_b32 v249, 3, v248
v_mfma_f32_16x16x32_bf16 a[120:123], a[216:219], v[204:207], 0
v_lshrrev_b32 v248, 2, v248
v_mov_b32 v250, 0x20000
v_mfma_f32_16x16x32_bf16 a[124:127], a[220:223], v[204:207], 0
v_mov_b32 v252, 0x20001
v_lshlrev_b32 v6, 3, v249
v_mfma_f32_16x16x32_bf16 a[92:95], a[220:223], v[200:203], 0
v_lshrrev_b32 v6, v6, v252
v_and_b32 v6, 3, v6
v_mfma_f32_16x16x32_bf16 a[60:63], a[220:223], v[196:199], 0
v_cmp_ne_u32 vcc, 1, v249
v_mul_u32_u24 v6, 16640, v6
v_mfma_f32_16x16x32_bf16 a[28:31], a[220:223], v[192:195], 0
v_add_u32 v6, s92, v6
v_cndmask_b32 v6, v250, v6, vcc
v_mfma_f32_16x16x32_bf16 v[224:227], v[120:123], v[192:195], 0
v_add_u32 v253, s58, v249
v_and_b32 v253, 3, v253
v_mfma_f32_16x16x32_bf16 v[228:231], v[120:123], v[196:199], 0
v_mul_u32_u24 v253, 4160, v253
v_add_u32 v6, v6, v253
v_mfma_f32_16x16x32_bf16 v[232:235], v[120:123], v[200:203], 0
s_waitcnt vmcnt(12) lgkmcnt(8)
v_mfma_f32_16x16x32_bf16 v[236:239], v[120:123], v[204:207], 0
s_barrier
s_lshl_b32 s75, s59, 4
s_and_b32 s76, s84, 15
s_add_u32 s75, s75, s76
s_lshl_b32 s75, s75, 14
s_cmp_ge_u32 s60, 4
s_cselect_b32 s75, s75, 0x40001000
s_lshl_b32 s83, s60, 1
s_sub_u32 s83, 2, s83
s_cmp_eq_u32 s83, 0
s_cbranch_scc1 LLT1
.p2align 5
s_nop 0
s_nop 0
LloopI:
v_mfma_f32_16x16x32_bf16 v[160:163], a[160:163], v[16:19], v[80:83]
s_xor_b32 s74, s82, 0x10000
v_exp_f32 v128, v128
v_mfma_f32_16x16x32_bf16 v[160:163], a[164:167], v[20:23], v[160:163]
s_add_u32 s74, s74, s64
ds_read_b128 a[128:131], v2 offset:16384
v_mfma_f32_16x16x32_bf16 v[160:163], a[168:171], v[24:27], v[160:163]
s_add_u32 s81, s81, 0x8000
v_exp_f32 v129, v129
v_mfma_f32_16x16x32_bf16 v[160:163], a[172:175], v[28:31], v[160:163]
s_add_u32 m0, s74, 16384
v_exp_f32 v130, v130
v_mfma_f32_16x16x32_bf16 v[164:167], a[172:175], v[44:47], v[84:87]
s_add_u32 s72, s81, 16384
ds_read_b128 a[132:135], v2 offset:17408
v_cvt_pk_bf16_f32 v192, v128, v129
v_mfma_f32_16x16x32_bf16 v[164:167], a[168:171], v[40:43], v[164:167]
v_exp_f32 v131, v131
v_mfma_f32_16x16x32_bf16 v[164:167], a[164:167], v[36:39], v[164:167]
v_exp_f32 v144, v144
v_mfma_f32_16x16x32_bf16 v[164:167], a[160:163], v[32:35], v[164:167]
ds_read_b128 a[136:139], v2 offset:18432
v_cvt_pk_bf16_f32 v193, v130, v131
v_mfma_f32_16x16x32_bf16 v[168:171], a[160:163], v[48:51], v[88:91]
buffer_load_dwordx4 v1, s[44:47], s72 offen sc1 lds
v_mfma_f32_16x16x32_bf16 v[168:171], a[164:167], v[52:55], v[168:171]
v_exp_f32 v145, v145
v_mfma_f32_16x16x32_bf16 v[168:171], a[168:171], v[56:59], v[168:171]
v_exp_f32 v146, v146
v_mfma_f32_16x16x32_bf16 v[168:171], a[172:175], v[60:63], v[168:171]
ds_read_b128 a[140:143], v2 offset:19456
v_cvt_pk_bf16_f32 v194, v144, v145
v_mfma_f32_16x16x32_bf16 v[172:175], a[172:175], v[76:79], v[92:95]
v_exp_f32 v147, v147
v_mfma_f32_16x16x32_bf16 v[172:175], a[168:171], v[72:75], v[172:175]
v_exp_f32 v132, v132
v_mfma_f32_16x16x32_bf16 v[172:175], a[164:167], v[68:71], v[172:175]
ds_read_b128 a[144:147], v2 offset:20480
v_cvt_pk_bf16_f32 v195, v146, v147
v_mfma_f32_16x16x32_bf16 v[172:175], a[160:163], v[64:67], v[172:175]
v_exp_f32 v133, v133
v_mfma_f32_16x16x32_bf16 v[188:191], a[176:179], v[64:67], v[92:95]
v_exp_f32 v134, v134
v_mfma_f32_16x16x32_bf16 v[188:191], a[180:183], v[68:71], v[188:191]
ds_read_b128 a[148:151], v2 offset:21504
v_cvt_pk_bf16_f32 v196, v132, v133
v_mfma_f32_16x16x32_bf16 v[188:191], a[184:187], v[72:75], v[188:191]
v_exp_f32 v135, v135
v_mfma_f32_16x16x32_bf16 v[188:191], a[188:191], v[76:79], v[188:191]
v_exp_f32 v148, v148
v_mfma_f32_16x16x32_bf16 v[184:187], a[188:191], v[60:63], v[88:91]
ds_read_b128 a[152:155], v2 offset:22528
v_cvt_pk_bf16_f32 v197, v134, v135
v_mfma_f32_16x16x32_bf16 v[184:187], a[184:187], v[56:59], v[184:187]
buffer_load_dwordx4 v1, s[44:47], s72 offen offset:1024 sc1 lds
v_mfma_f32_16x16x32_bf16 v[184:187], a[180:183], v[52:55], v[184:187]
v_exp_f32 v149, v149
v_mfma_f32_16x16x32_bf16 v[184:187], a[176:179], v[48:51], v[184:187]
v_exp_f32 v150, v150
v_mfma_f32_16x16x32_bf16 v[180:183], a[176:179], v[32:35], v[84:87]
ds_read_b128 a[156:159], v2 offset:23552
v_cvt_pk_bf16_f32 v198, v148, v149
v_mfma_f32_16x16x32_bf16 v[180:183], a[180:183], v[36:39], v[180:183]
v_exp_f32 v151, v151
v_mfma_f32_16x16x32_bf16 v[180:183], a[184:187], v[40:43], v[180:183]
v_exp_f32 v136, v136
v_mfma_f32_16x16x32_bf16 v[180:183], a[188:191], v[44:47], v[180:183]
ds_read_b128 a[192:195], v2 offset:0
v_cvt_pk_bf16_f32 v199, v150, v151
v_mfma_f32_16x16x32_bf16 v[176:179], a[188:191], v[28:31], v[80:83]
v_exp_f32 v137, v137
v_mfma_f32_16x16x32_bf16 v[176:179], a[184:187], v[24:27], v[176:179]
v_exp_f32 v138, v138
v_mfma_f32_16x16x32_bf16 v[176:179], a[180:183], v[20:23], v[176:179]
ds_read_b128 a[196:199], v2 offset:1024
v_cvt_pk_bf16_f32 v200, v136, v137
v_mfma_f32_16x16x32_bf16 v[176:179], a[176:179], v[16:19], v[176:179]
s_waitcnt lgkmcnt(10)
v_exp_f32 v139, v139
v_mfma_f32_16x16x32_bf16 a[0:3], a[224:227], v[208:211], a[0:3]
v_exp_f32 v152, v152
v_mfma_f32_16x16x32_bf16 a[32:35], a[224:227], v[212:215], a[32:35]
ds_read_b128 a[200:203], v2 offset:2048
v_cvt_pk_bf16_f32 v201, v138, v139
v_mfma_f32_16x16x32_bf16 a[64:67], a[224:227], v[216:219], a[64:67]
buffer_load_dwordx4 v1, s[44:47], s72 offen offset:2048 sc1 lds
v_mfma_f32_16x16x32_bf16 a[96:99], a[224:227], v[220:223], a[96:99]
v_exp_f32 v153, v153
v_mfma_f32_16x16x32_bf16 a[100:103], a[228:231], v[220:223], a[100:103]
v_exp_f32 v154, v154
v_mfma_f32_16x16x32_bf16 a[68:71], a[228:231], v[216:219], a[68:71]
ds_read_b128 a[204:207], v2 offset:3072
v_cvt_pk_bf16_f32 v202, v152, v153
v_mfma_f32_16x16x32_bf16 a[36:39], a[228:231], v[212:215], a[36:39]
v_exp_f32 v155, v155
v_mfma_f32_16x16x32_bf16 a[4:7], a[228:231], v[208:211], a[4:7]
v_exp_f32 v140, v140
v_mfma_f32_16x16x32_bf16 a[8:11], a[232:235], v[208:211], a[8:11]
ds_read_b128 a[208:211], v2 offset:4096
v_cvt_pk_bf16_f32 v203, v154, v155
v_mfma_f32_16x16x32_bf16 a[40:43], a[232:235], v[212:215], a[40:43]
v_exp_f32 v141, v141
v_mfma_f32_16x16x32_bf16 a[72:75], a[232:235], v[216:219], a[72:75]
v_exp_f32 v142, v142
v_mfma_f32_16x16x32_bf16 a[104:107], a[232:235], v[220:223], a[104:107]
ds_read_b128 a[212:215], v2 offset:5120
v_cvt_pk_bf16_f32 v204, v140, v141
v_mfma_f32_16x16x32_bf16 a[108:111], a[236:239], v[220:223], a[108:111]
v_exp_f32 v143, v143
v_mfma_f32_16x16x32_bf16 a[76:79], a[236:239], v[216:219], a[76:79]
v_exp_f32 v156, v156
v_mfma_f32_16x16x32_bf16 a[44:47], a[236:239], v[212:215], a[44:47]
ds_read_b128 a[216:219], v2 offset:6144
v_cvt_pk_bf16_f32 v205, v142, v143
v_mfma_f32_16x16x32_bf16 a[12:15], a[236:239], v[208:211], a[12:15]
buffer_load_dwordx4 v1, s[44:47], s72 offen offset:3072 sc1 lds
v_mfma_f32_16x16x32_bf16 a[16:19], a[240:243], v[208:211], a[16:19]
v_exp_f32 v157, v157
v_mfma_f32_16x16x32_bf16 a[48:51], a[240:243], v[212:215], a[48:51]
v_exp_f32 v158, v158
v_mfma_f32_16x16x32_bf16 a[80:83], a[240:243], v[216:219], a[80:83]
ds_read_b128 a[220:223], v2 offset:7168
v_cvt_pk_bf16_f32 v206, v156, v157
v_mfma_f32_16x16x32_bf16 a[112:115], a[240:243], v[220:223], a[112:115]
v_exp_f32 v159, v159
v_mfma_f32_16x16x32_bf16 a[116:119], a[244:247], v[220:223], a[116:119]
v_cvt_pk_bf16_f32 v207, v158, v159
v_add_u32 v15, s75, v3
v_mfma_f32_16x16x32_bf16 a[84:87], a[244:247], v[216:219], a[84:87]
v_mfma_f32_16x16x32_bf16 a[52:55], a[244:247], v[212:215], a[52:55]
v_mfma_f32_16x16x32_bf16 a[20:23], a[244:247], v[208:211], a[20:23]
v_mfma_f32_16x16x32_bf16 a[24:27], a[248:251], v[208:211], a[24:27]
v_mfma_f32_16x16x32_bf16 a[56:59], a[248:251], v[212:215], a[56:59]
v_mfma_f32_16x16x32_bf16 a[88:91], a[248:251], v[216:219], a[88:91]
v_mfma_f32_16x16x32_bf16 a[120:123], a[248:251], v[220:223], a[120:123]
v_mfma_f32_16x16x32_bf16 a[124:127], a[252:255], v[220:223], a[124:127]
v_mfma_f32_16x16x32_bf16 a[92:95], a[252:255], v[216:219], a[92:95]
v_mfma_f32_16x16x32_bf16 a[60:63], a[252:255], v[212:215], a[60:63]
v_mfma_f32_16x16x32_bf16 a[28:31], a[252:255], v[208:211], a[28:31]
v_mfma_f32_16x16x32_bf16 v[224:227], v[120:123], v[208:211], v[224:227]
v_mfma_f32_16x16x32_bf16 v[228:231], v[120:123], v[212:215], v[228:231]
v_mfma_f32_16x16x32_bf16 v[232:235], v[120:123], v[216:219], v[232:235]
v_mfma_f32_16x16x32_bf16 v[236:239], v[120:123], v[220:223], v[236:239]
s_waitcnt lgkmcnt(8)
v_mfma_f32_16x16x32_bf16 v[128:131], a[128:131], v[16:19], v[80:83]
s_add_u32 s82, s82, 0x8000
ds_read_b128 a[160:163], v2 offset:24576
v_mfma_f32_16x16x32_bf16 v[128:131], a[132:135], v[20:23], v[128:131]
s_and_b32 s82, s82, 0x1ffff
v_exp_f32 v160, v160
v_mfma_f32_16x16x32_bf16 v[128:131], a[136:139], v[24:27], v[128:131]
s_add_u32 m0, s74, 0
v_exp_f32 v161, v161
v_mfma_f32_16x16x32_bf16 v[128:131], a[140:143], v[28:31], v[128:131]
s_add_u32 s72, s81, 0
ds_read_b128 a[164:167], v2 offset:25600
v_cvt_pk_bf16_f32 v208, v160, v161
v_mfma_f32_16x16x32_bf16 v[132:135], a[140:143], v[44:47], v[84:87]
v_exp_f32 v162, v162
v_mfma_f32_16x16x32_bf16 v[132:135], a[136:139], v[40:43], v[132:135]
v_exp_f32 v163, v163
v_mfma_f32_16x16x32_bf16 v[132:135], a[132:135], v[36:39], v[132:135]
buffer_load_dwordx4 v1, s[44:47], s72 offen sc1 lds
v_mfma_f32_16x16x32_bf16 v[132:135], a[128:131], v[32:35], v[132:135]
ds_read_b128 a[168:171], v2 offset:26624
v_cvt_pk_bf16_f32 v209, v162, v163
v_mfma_f32_16x16x32_bf16 v[136:139], a[128:131], v[48:51], v[88:91]
v_exp_f32 v176, v176
v_mfma_f32_16x16x32_bf16 v[136:139], a[132:135], v[52:55], v[136:139]
v_exp_f32 v177, v177
v_mfma_f32_16x16x32_bf16 v[136:139], a[136:139], v[56:59], v[136:139]
ds_read_b128 a[172:175], v2 offset:27648
v_cvt_pk_bf16_f32 v210, v176, v177
v_mfma_f32_16x16x32_bf16 v[136:139], a[140:143], v[60:63], v[136:139]
v_exp_f32 v178, v178
v_mfma_f32_16x16x32_bf16 v[140:143], a[140:143], v[76:79], v[92:95]
v_exp_f32 v179, v179
v_mfma_f32_16x16x32_bf16 v[140:143], a[136:139], v[72:75], v[140:143]
ds_read_b128 a[176:179], v2 offset:28672
v_cvt_pk_bf16_f32 v211, v178, v179
v_mfma_f32_16x16x32_bf16 v[140:143], a[132:135], v[68:71], v[140:143]
v_exp_f32 v164, v164
v_mfma_f32_16x16x32_bf16 v[140:143], a[128:131], v[64:67], v[140:143]
v_exp_f32 v165, v165
v_mfma_f32_16x16x32_bf16 v[156:159], a[144:147], v[64:67], v[92:95]
ds_read_b128 a[180:183], v2 offset:29696
v_cvt_pk_bf16_f32 v212, v164, v165
v_mfma_f32_16x16x32_bf16 v[156:159], a[148:151], v[68:71], v[156:159]
buffer_load_dwordx4 v1, s[44:47], s72 offen offset:1024 sc1 lds
v_mfma_f32_16x16x32_bf16 v[156:159], a[152:155], v[72:75], v[156:159]
v_exp_f32 v166, v166
v_mfma_f32_16x16x32_bf16 v[156:159], a[156:159], v[76:79], v[156:159]
v_exp_f32 v167, v167
v_mfma_f32_16x16x32_bf16 v[152:155], a[156:159], v[60:63], v[88:91]
ds_read_b128 a[184:187], v2 offset:30720
v_cvt_pk_bf16_f32 v213, v166, v167
v_mfma_f32_16x16x32_bf16 v[152:155], a[152:155], v[56:59], v[152:155]
v_exp_f32 v180, v180
v_mfma_f32_16x16x32_bf16 v[152:155], a[148:151], v[52:55], v[152:155]
v_exp_f32 v181, v181
v_mfma_f32_16x16x32_bf16 v[152:155], a[144:147], v[48:51], v[152:155]
ds_read_b128 a[188:191], v2 offset:31744
v_cvt_pk_bf16_f32 v214, v180, v181
v_mfma_f32_16x16x32_bf16 v[148:151], a[144:147], v[32:35], v[84:87]
v_exp_f32 v182, v182
v_mfma_f32_16x16x32_bf16 v[148:151], a[148:151], v[36:39], v[148:151]
v_exp_f32 v183, v183
v_mfma_f32_16x16x32_bf16 v[148:151], a[152:155], v[40:43], v[148:151]
ds_read_b128 a[224:227], v2 offset:8192
v_cvt_pk_bf16_f32 v215, v182, v183
v_mfma_f32_16x16x32_bf16 v[148:151], a[156:159], v[44:47], v[148:151]
v_exp_f32 v168, v168
v_mfma_f32_16x16x32_bf16 v[144:147], a[156:159], v[28:31], v[80:83]
buffer_load_dwordx4 v1, s[44:47], s72 offen offset:2048 sc1 lds
v_mfma_f32_16x16x32_bf16 v[144:147], a[152:155], v[24:27], v[144:147]
v_exp_f32 v169, v169
v_mfma_f32_16x16x32_bf16 v[144:147], a[148:151], v[20:23], v[144:147]
ds_read_b128 a[228:231], v2 offset:9216
v_cvt_pk_bf16_f32 v216, v168, v169
v_mfma_f32_16x16x32_bf16 v[144:147], a[144:147], v[16:19], v[144:147]
s_waitcnt lgkmcnt(10)
v_exp_f32 v170, v170
v_mfma_f32_16x16x32_bf16 a[0:3], a[192:195], v[192:195], a[0:3]
v_exp_f32 v171, v171
v_mfma_f32_16x16x32_bf16 a[32:35], a[192:195], v[196:199], a[32:35]
ds_read_b128 a[232:235], v2 offset:10240
v_cvt_pk_bf16_f32 v217, v170, v171
v_mfma_f32_16x16x32_bf16 a[64:67], a[192:195], v[200:203], a[64:67]
v_exp_f32 v184, v184
v_mfma_f32_16x16x32_bf16 a[96:99], a[192:195], v[204:207], a[96:99]
v_exp_f32 v185, v185
v_mfma_f32_16x16x32_bf16 a[100:103], a[196:199], v[204:207], a[100:103]
ds_read_b128 a[236:239], v2 offset:11264
v_cvt_pk_bf16_f32 v218, v184, v185
v_mfma_f32_16x16x32_bf16 a[68:71], a[196:199], v[200:203], a[68:71]
v_exp_f32 v186, v186
v_mfma_f32_16x16x32_bf16 a[36:39], a[196:199], v[196:199], a[36:39]
buffer_load_dwordx4 v1, s[44:47], s72 offen offset:3072 sc1 lds
v_mfma_f32_16x16x32_bf16 a[4:7], a[196:199], v[192:195], a[4:7]
s_add_u32 s75, s75, 0x1000
v_exp_f32 v187, v187
v_mfma_f32_16x16x32_bf16 a[8:11], a[200:203], v[192:195], a[8:11]
s_and_b32 s76, s75, 0x3000
ds_read_b128 a[240:243], v2 offset:12288
v_cvt_pk_bf16_f32 v219, v186, v187
v_mfma_f32_16x16x32_bf16 a[40:43], a[200:203], v[196:199], a[40:43]
s_cselect_b32 s75, s75, 0x40001000
v_exp_f32 v172, v172
v_mfma_f32_16x16x32_bf16 a[72:75], a[200:203], v[200:203], a[72:75]
v_exp_f32 v173, v173
v_mfma_f32_16x16x32_bf16 a[104:107], a[200:203], v[204:207], a[104:107]
ds_read_b128 a[244:247], v2 offset:13312
v_cvt_pk_bf16_f32 v220, v172, v173
v_mfma_f32_16x16x32_bf16 a[108:111], a[204:207], v[204:207], a[108:111]
v_exp_f32 v174, v174
v_mfma_f32_16x16x32_bf16 a[76:79], a[204:207], v[200:203], a[76:79]
v_exp_f32 v175, v175
v_mfma_f32_16x16x32_bf16 a[44:47], a[204:207], v[196:199], a[44:47]
ds_read_b128 a[248:251], v2 offset:14336
v_cvt_pk_bf16_f32 v221, v174, v175
v_mfma_f32_16x16x32_bf16 a[12:15], a[204:207], v[192:195], a[12:15]
v_exp_f32 v188, v188
v_mfma_f32_16x16x32_bf16 a[16:19], a[208:211], v[192:195], a[16:19]
buffer_load_dword v4, v15, s[24:27], 0 offen
v_mfma_f32_16x16x32_bf16 a[48:51], a[208:211], v[196:199], a[48:51]
v_exp_f32 v189, v189
v_mfma_f32_16x16x32_bf16 a[80:83], a[208:211], v[200:203], a[80:83]
ds_read_b128 a[252:255], v2 offset:15360
v_cvt_pk_bf16_f32 v222, v188, v189
v_mfma_f32_16x16x32_bf16 a[112:115], a[208:211], v[204:207], a[112:115]
v_exp_f32 v190, v190
v_mfma_f32_16x16x32_bf16 a[116:119], a[212:215], v[204:207], a[116:119]
v_exp_f32 v191, v191
v_mfma_f32_16x16x32_bf16 a[84:87], a[212:215], v[200:203], a[84:87]
v_cvt_pk_bf16_f32 v223, v190, v191
v_add_u32 v2, s82, v1
v_mfma_f32_16x16x32_bf16 a[52:55], a[212:215], v[196:199], a[52:55]
v_mfma_f32_16x16x32_bf16 a[20:23], a[212:215], v[192:195], a[20:23]
v_mfma_f32_16x16x32_bf16 a[24:27], a[216:219], v[192:195], a[24:27]
v_mfma_f32_16x16x32_bf16 a[56:59], a[216:219], v[196:199], a[56:59]
v_mfma_f32_16x16x32_bf16 a[88:91], a[216:219], v[200:203], a[88:91]
v_mfma_f32_16x16x32_bf16 a[120:123], a[216:219], v[204:207], a[120:123]
v_mfma_f32_16x16x32_bf16 a[124:127], a[220:223], v[204:207], a[124:127]
v_mfma_f32_16x16x32_bf16 a[92:95], a[220:223], v[200:203], a[92:95]
v_mfma_f32_16x16x32_bf16 a[60:63], a[220:223], v[196:199], a[60:63]
v_mfma_f32_16x16x32_bf16 a[28:31], a[220:223], v[192:195], a[28:31]
v_mfma_f32_16x16x32_bf16 v[224:227], v[120:123], v[192:195], v[224:227]
s_waitcnt vmcnt(9) lgkmcnt(8)
v_mfma_f32_16x16x32_bf16 v[228:231], v[120:123], v[196:199], v[228:231]
s_barrier
v_mfma_f32_16x16x32_bf16 v[232:235], v[120:123], v[200:203], v[232:235]
s_add_u32 s83, s83, 1
v_mfma_f32_16x16x32_bf16 v[236:239], v[120:123], v[204:207], v[236:239]
s_cbranch_scc0 LloopI
LLT1:
Lstub1:
s_cbranch_execz Lstub5
v_mfma_f32_16x16x32_bf16 v[160:163], a[160:163], v[16:19], v[80:83]
s_xor_b32 s74, s82, 0x10000
v_exp_f32 v128, v128
v_mfma_f32_16x16x32_bf16 v[160:163], a[164:167], v[20:23], v[160:163]
s_add_u32 s74, s74, s64
ds_read_b128 a[128:131], v2 offset:16384
v_mfma_f32_16x16x32_bf16 v[160:163], a[168:171], v[24:27], v[160:163]
s_add_u32 s81, s81, 0x8000
v_exp_f32 v129, v129
v_mfma_f32_16x16x32_bf16 v[160:163], a[172:175], v[28:31], v[160:163]
s_add_u32 m0, s74, 16384
v_exp_f32 v130, v130
v_mfma_f32_16x16x32_bf16 v[164:167], a[172:175], v[44:47], v[84:87]
s_add_u32 s72, s81, 16384
ds_read_b128 a[132:135], v2 offset:17408
v_cvt_pk_bf16_f32 v192, v128, v129
v_mfma_f32_16x16x32_bf16 v[164:167], a[168:171], v[40:43], v[164:167]
v_exp_f32 v131, v131
v_mfma_f32_16x16x32_bf16 v[164:167], a[164:167], v[36:39], v[164:167]
v_exp_f32 v144, v144
v_mfma_f32_16x16x32_bf16 v[164:167], a[160:163], v[32:35], v[164:167]
ds_read_b128 a[136:139], v2 offset:18432
v_cvt_pk_bf16_f32 v193, v130, v131
v_mfma_f32_16x16x32_bf16 v[168:171], a[160:163], v[48:51], v[88:91]
buffer_load_dwordx4 v1, s[44:47], s72 offen sc1 lds
v_mfma_f32_16x16x32_bf16 v[168:171], a[164:167], v[52:55], v[168:171]
v_exp_f32 v145, v145
v_mfma_f32_16x16x32_bf16 v[168:171], a[168:171], v[56:59], v[168:171]
v_exp_f32 v146, v146
v_mfma_f32_16x16x32_bf16 v[168:171], a[172:175], v[60:63], v[168:171]
ds_read_b128 a[140:143], v2 offset:19456
v_cvt_pk_bf16_f32 v194, v144, v145
v_mfma_f32_16x16x32_bf16 v[172:175], a[172:175], v[76:79], v[92:95]
v_exp_f32 v147, v147
v_mfma_f32_16x16x32_bf16 v[172:175], a[168:171], v[72:75], v[172:175]
v_exp_f32 v132, v132
v_mfma_f32_16x16x32_bf16 v[172:175], a[164:167], v[68:71], v[172:175]
ds_read_b128 a[144:147], v2 offset:20480
v_cvt_pk_bf16_f32 v195, v146, v147
v_mfma_f32_16x16x32_bf16 v[172:175], a[160:163], v[64:67], v[172:175]
v_exp_f32 v133, v133
v_mfma_f32_16x16x32_bf16 v[188:191], a[176:179], v[64:67], v[92:95]
v_exp_f32 v134, v134
v_mfma_f32_16x16x32_bf16 v[188:191], a[180:183], v[68:71], v[188:191]
ds_read_b128 a[148:151], v2 offset:21504
v_cvt_pk_bf16_f32 v196, v132, v133
v_mfma_f32_16x16x32_bf16 v[188:191], a[184:187], v[72:75], v[188:191]
v_exp_f32 v135, v135
v_mfma_f32_16x16x32_bf16 v[188:191], a[188:191], v[76:79], v[188:191]
v_exp_f32 v148, v148
v_mfma_f32_16x16x32_bf16 v[184:187], a[188:191], v[60:63], v[88:91]
ds_read_b128 a[152:155], v2 offset:22528
v_cvt_pk_bf16_f32 v197, v134, v135
v_mfma_f32_16x16x32_bf16 v[184:187], a[184:187], v[56:59], v[184:187]
buffer_load_dwordx4 v1, s[44:47], s72 offen offset:1024 sc1 lds
v_mfma_f32_16x16x32_bf16 v[184:187], a[180:183], v[52:55], v[184:187]
v_exp_f32 v149, v149
v_mfma_f32_16x16x32_bf16 v[184:187], a[176:179], v[48:51], v[184:187]
v_exp_f32 v150, v150
v_mfma_f32_16x16x32_bf16 v[180:183], a[176:179], v[32:35], v[84:87]
ds_read_b128 a[156:159], v2 offset:23552
v_cvt_pk_bf16_f32 v198, v148, v149
v_mfma_f32_16x16x32_bf16 v[180:183], a[180:183], v[36:39], v[180:183]
v_exp_f32 v151, v151
v_mfma_f32_16x16x32_bf16 v[180:183], a[184:187], v[40:43], v[180:183]
v_exp_f32 v136, v136
v_mfma_f32_16x16x32_bf16 v[180:183], a[188:191], v[44:47], v[180:183]
ds_read_b128 a[192:195], v2 offset:0
v_cvt_pk_bf16_f32 v199, v150, v151
v_mfma_f32_16x16x32_bf16 v[176:179], a[188:191], v[28:31], v[80:83]
v_exp_f32 v137, v137
v_mfma_f32_16x16x32_bf16 v[176:179], a[184:187], v[24:27], v[176:179]
v_exp_f32 v138, v138
v_mfma_f32_16x16x32_bf16 v[176:179], a[180:183], v[20:23], v[176:179]
ds_read_b128 a[196:199], v2 offset:1024
v_cvt_pk_bf16_f32 v200, v136, v137
v_mfma_f32_16x16x32_bf16 v[176:179], a[176:179], v[16:19], v[176:179]
s_waitcnt lgkmcnt(10)
v_exp_f32 v139, v139
v_mfma_f32_16x16x32_bf16 a[0:3], a[224:227], v[208:211], a[0:3]
v_exp_f32 v152, v152
v_mfma_f32_16x16x32_bf16 a[32:35], a[224:227], v[212:215], a[32:35]
ds_read_b128 a[200:203], v2 offset:2048
v_cvt_pk_bf16_f32 v201, v138, v139
v_mfma_f32_16x16x32_bf16 a[64:67], a[224:227], v[216:219], a[64:67]
buffer_load_dwordx4 v1, s[44:47], s72 offen offset:2048 sc1 lds
v_mfma_f32_16x16x32_bf16 a[96:99], a[224:227], v[220:223], a[96:99]
Lstub2:
s_cbranch_execz Lstub6
v_exp_f32 v153, v153
v_mfma_f32_16x16x32_bf16 a[100:103], a[228:231], v[220:223], a[100:103]
v_exp_f32 v154, v154
v_mfma_f32_16x16x32_bf16 a[68:71], a[228:231], v[216:219], a[68:71]
ds_read_b128 a[204:207], v2 offset:3072
v_cvt_pk_bf16_f32 v202, v152, v153
v_mfma_f32_16x16x32_bf16 a[36:39], a[228:231], v[212:215], a[36:39]
v_exp_f32 v155, v155
v_mfma_f32_16x16x32_bf16 a[4:7], a[228:231], v[208:211], a[4:7]
v_exp_f32 v140, v140
v_mfma_f32_16x16x32_bf16 a[8:11], a[232:235], v[208:211], a[8:11]
ds_read_b128 a[208:211], v2 offset:4096
v_cvt_pk_bf16_f32 v203, v154, v155
v_mfma_f32_16x16x32_bf16 a[40:43], a[232:235], v[212:215], a[40:43]
v_exp_f32 v141, v141
v_mfma_f32_16x16x32_bf16 a[72:75], a[232:235], v[216:219], a[72:75]
v_exp_f32 v142, v142
v_mfma_f32_16x16x32_bf16 a[104:107], a[232:235], v[220:223], a[104:107]
ds_read_b128 a[212:215], v2 offset:5120
v_cvt_pk_bf16_f32 v204, v140, v141
v_mfma_f32_16x16x32_bf16 a[108:111], a[236:239], v[220:223], a[108:111]
v_exp_f32 v143, v143
v_mfma_f32_16x16x32_bf16 a[76:79], a[236:239], v[216:219], a[76:79]
v_exp_f32 v156, v156
v_mfma_f32_16x16x32_bf16 a[44:47], a[236:239], v[212:215], a[44:47]
ds_read_b128 a[216:219], v2 offset:6144
v_cvt_pk_bf16_f32 v205, v142, v143
v_mfma_f32_16x16x32_bf16 a[12:15], a[236:239], v[208:211], a[12:15]
buffer_load_dwordx4 v1, s[44:47], s72 offen offset:3072 sc1 lds
v_mfma_f32_16x16x32_bf16 a[16:19], a[240:243], v[208:211], a[16:19]
v_exp_f32 v157, v157
v_mfma_f32_16x16x32_bf16 a[48:51], a[240:243], v[212:215], a[48:51]
v_exp_f32 v158, v158
v_mfma_f32_16x16x32_bf16 a[80:83], a[240:243], v[216:219], a[80:83]
ds_read_b128 a[220:223], v2 offset:7168
v_cvt_pk_bf16_f32 v206, v156, v157
v_mfma_f32_16x16x32_bf16 a[112:115], a[240:243], v[220:223], a[112:115]
v_exp_f32 v159, v159
v_mfma_f32_16x16x32_bf16 a[116:119], a[244:247], v[220:223], a[116:119]
v_cvt_pk_bf16_f32 v207, v158, v159
v_mfma_f32_16x16x32_bf16 a[84:87], a[244:247], v[216:219], a[84:87]
v_mfma_f32_16x16x32_bf16 a[52:55], a[244:247], v[212:215], a[52:55]
v_mfma_f32_16x16x32_bf16 a[20:23], a[244:247], v[208:211], a[20:23]
v_mfma_f32_16x16x32_bf16 a[24:27], a[248:251], v[208:211], a[24:27]
v_mfma_f32_16x16x32_bf16 a[56:59], a[248:251], v[212:215], a[56:59]
v_mfma_f32_16x16x32_bf16 a[88:91], a[248:251], v[216:219], a[88:91]
v_mfma_f32_16x16x32_bf16 a[120:123], a[248:251], v[220:223], a[120:123]
v_mfma_f32_16x16x32_bf16 a[124:127], a[252:255], v[220:223], a[124:127]
v_mfma_f32_16x16x32_bf16 a[92:95], a[252:255], v[216:219], a[92:95]
v_mfma_f32_16x16x32_bf16 a[60:63], a[252:255], v[212:215], a[60:63]
v_mfma_f32_16x16x32_bf16 a[28:31], a[252:255], v[208:211], a[28:31]
v_mfma_f32_16x16x32_bf16 v[224:227], v[120:123], v[208:211], v[224:227]
v_mfma_f32_16x16x32_bf16 v[228:231], v[120:123], v[212:215], v[228:231]
v_mfma_f32_16x16x32_bf16 v[232:235], v[120:123], v[216:219], v[232:235]
v_mfma_f32_16x16x32_bf16 v[236:239], v[120:123], v[220:223], v[236:239]
s_waitcnt lgkmcnt(8)
s_cmp_eq_u32 s58, 0
s_cbranch_scc1 Lta16
s_cmp_eq_u32 s58, 1
s_cbranch_scc1 Lnt17
v_mfma_f32_16x16x32_bf16 v[128:131], a[128:131], v[16:19], v[80:83]
s_add_u32 s82, s82, 0x8000
ds_read_b128 a[160:163], v2 offset:24576
v_mfma_f32_16x16x32_bf16 v[144:147], a[144:147], v[16:19], v[80:83]
s_and_b32 s82, s82, 0x1ffff
v_exp_f32 v160, v160
s_branch Ljoin18
Lta16:
v_mfma_f32_16x16x32_bf16 v[128:131], a[128:131], v[16:19], v[96:99]
s_add_u32 s82, s82, 0x8000
ds_read_b128 a[160:163], v2 offset:24576
v_mfma_f32_16x16x32_bf16 v[144:147], a[144:147], v[16:19], v[112:115]
s_and_b32 s82, s82, 0x1ffff
v_exp_f32 v160, v160
s_branch Ljoin18
Lnt17:
v_mfma_f32_16x16x32_bf16 v[128:131], a[128:131], v[16:19], v[80:83]
s_add_u32 s82, s82, 0x8000
ds_read_b128 a[160:163], v2 offset:24576
v_mfma_f32_16x16x32_bf16 v[144:147], a[144:147], v[16:19], v[96:99]
s_and_b32 s82, s82, 0x1ffff
v_exp_f32 v160, v160
Ljoin18:
v_mfma_f32_16x16x32_bf16 v[128:131], a[132:135], v[20:23], v[128:131]
s_add_u32 m0, s74, 0
v_exp_f32 v161, v161
v_mfma_f32_16x16x32_bf16 v[128:131], a[136:139], v[24:27], v[128:131]
s_add_u32 s72, s81, 0
ds_read_b128 a[164:167], v2 offset:25600
v_cvt_pk_bf16_f32 v208, v160, v161
v_mfma_f32_16x16x32_bf16 v[128:131], a[140:143], v[28:31], v[128:131]
v_exp_f32 v162, v162
v_mfma_f32_16x16x32_bf16 v[132:135], a[140:143], v[44:47], v[84:87]
v_exp_f32 v163, v163
v_mfma_f32_16x16x32_bf16 v[132:135], a[136:139], v[40:43], v[132:135]
ds_read_b128 a[168:171], v2 offset:26624
v_cvt_pk_bf16_f32 v209, v162, v163
v_mfma_f32_16x16x32_bf16 v[132:135], a[132:135], v[36:39], v[132:135]
v_exp_f32 v176, v176
v_mfma_f32_16x16x32_bf16 v[132:135], a[128:131], v[32:35], v[132:135]
buffer_load_dwordx4 v1, s[44:47], s72 offen sc1 lds
v_mfma_f32_16x16x32_bf16 v[136:139], a[128:131], v[48:51], v[88:91]
v_exp_f32 v177, v177
v_mfma_f32_16x16x32_bf16 v[136:139], a[132:135], v[52:55], v[136:139]
ds_read_b128 a[172:175], v2 offset:27648
v_cvt_pk_bf16_f32 v210, v176, v177
v_mfma_f32_16x16x32_bf16 v[136:139], a[136:139], v[56:59], v[136:139]
v_exp_f32 v178, v178
v_mfma_f32_16x16x32_bf16 v[136:139], a[140:143], v[60:63], v[136:139]
v_exp_f32 v179, v179
v_mfma_f32_16x16x32_bf16 v[140:143], a[140:143], v[76:79], v[92:95]
ds_read_b128 a[176:179], v2 offset:28672
v_cvt_pk_bf16_f32 v211, v178, v179
v_mfma_f32_16x16x32_bf16 v[140:143], a[136:139], v[72:75], v[140:143]
v_exp_f32 v164, v164
v_mfma_f32_16x16x32_bf16 v[140:143], a[132:135], v[68:71], v[140:143]
v_exp_f32 v165, v165
v_mfma_f32_16x16x32_bf16 v[140:143], a[128:131], v[64:67], v[140:143]
ds_read_b128 a[180:183], v2 offset:29696
v_cvt_pk_bf16_f32 v212, v164, v165
v_mfma_f32_16x16x32_bf16 v[156:159], a[144:147], v[64:67], v[92:95]
v_exp_f32 v166, v166
v_mfma_f32_16x16x32_bf16 v[156:159], a[148:151], v[68:71], v[156:159]
v_exp_f32 v167, v167
v_mfma_f32_16x16x32_bf16 v[156:159], a[152:155], v[72:75], v[156:159]
ds_read_b128 a[184:187], v2 offset:30720
v_cvt_pk_bf16_f32 v213, v166, v167
v_mfma_f32_16x16x32_bf16 v[156:159], a[156:159], v[76:79], v[156:159]
v_exp_f32 v180, v180
v_mfma_f32_16x16x32_bf16 v[152:155], a[156:159], v[60:63], v[88:91]
buffer_load_dwordx4 v1, s[44:47], s72 offen offset:1024 sc1 lds
v_mfma_f32_16x16x32_bf16 v[152:155], a[152:155], v[56:59], v[152:155]
v_exp_f32 v181, v181
v_mfma_f32_16x16x32_bf16 v[152:155], a[148:151], v[52:55], v[152:155]
ds_read_b128 a[188:191], v2 offset:31744
v_cvt_pk_bf16_f32 v214, v180, v181
v_mfma_f32_16x16x32_bf16 v[152:155], a[144:147], v[48:51], v[152:155]
v_exp_f32 v182, v182
v_mfma_f32_16x16x32_bf16 v[148:151], a[144:147], v[32:35], v[84:87]
v_exp_f32 v183, v183
v_mfma_f32_16x16x32_bf16 v[148:151], a[148:151], v[36:39], v[148:151]
ds_read_b128 a[224:227], v2 offset:8192
v_cvt_pk_bf16_f32 v215, v182, v183
v_mfma_f32_16x16x32_bf16 v[148:151], a[152:155], v[40:43], v[148:151]
v_exp_f32 v168, v168
v_mfma_f32_16x16x32_bf16 v[148:151], a[156:159], v[44:47], v[148:151]
v_exp_f32 v169, v169
v_mfma_f32_16x16x32_bf16 v[144:147], a[156:159], v[28:31], v[144:147]
ds_read_b128 a[228:231], v2 offset:9216
v_cvt_pk_bf16_f32 v216, v168, v169
v_mfma_f32_16x16x32_bf16 v[144:147], a[152:155], v[24:27], v[144:147]
v_exp_f32 v170, v170
v_mfma_f32_16x16x32_bf16 v[144:147], a[148:151], v[20:23], v[144:147]
s_waitcnt lgkmcnt(10)
v_exp_f32 v171, v171
v_mfma_f32_16x16x32_bf16 a[0:3], a[192:195], v[192:195], a[0:3]
ds_read_b128 a[232:235], v2 offset:10240
v_cvt_pk_bf16_f32 v217, v170, v171
v_mfma_f32_16x16x32_bf16 a[32:35], a[192:195], v[196:199], a[32:35]
v_exp_f32 v184, v184
v_mfma_f32_16x16x32_bf16 a[64:67], a[192:195], v[200:203], a[64:67]
buffer_load_dwordx4 v1, s[44:47], s72 offen offset:2048 sc1 lds
v_mfma_f32_16x16x32_bf16 a[96:99], a[192:195], v[204:207], a[96:99]
v_exp_f32 v185, v185
v_mfma_f32_16x16x32_bf16 a[100:103], a[196:199], v[204:207], a[100:103]
ds_read_b128 a[236:239], v2 offset:11264
v_cvt_pk_bf16_f32 v218, v184, v185
v_mfma_f32_16x16x32_bf16 a[68:71], a[196:199], v[200:203], a[68:71]
v_exp_f32 v186, v186
v_mfma_f32_16x16x32_bf16 a[36:39], a[196:199], v[196:199], a[36:39]
v_exp_f32 v187, v187
v_mfma_f32_16x16x32_bf16 a[4:7], a[196:199], v[192:195], a[4:7]
ds_read_b128 a[240:243], v2 offset:12288
v_cvt_pk_bf16_f32 v219, v186, v187
v_mfma_f32_16x16x32_bf16 a[8:11], a[200:203], v[192:195], a[8:11]
v_exp_f32 v172, v172
v_mfma_f32_16x16x32_bf16 a[40:43], a[200:203], v[196:199], a[40:43]
v_exp_f32 v173, v173
v_mfma_f32_16x16x32_bf16 a[72:75], a[200:203], v[200:203], a[72:75]
ds_read_b128 a[244:247], v2 offset:13312
v_cvt_pk_bf16_f32 v220, v172, v173
v_mfma_f32_16x16x32_bf16 a[104:107], a[200:203], v[204:207], a[104:107]
v_exp_f32 v174, v174
v_mfma_f32_16x16x32_bf16 a[108:111], a[204:207], v[204:207], a[108:111]
v_exp_f32 v175, v175
v_mfma_f32_16x16x32_bf16 a[76:79], a[204:207], v[200:203], a[76:79]
ds_read_b128 a[248:251], v2 offset:14336
v_cvt_pk_bf16_f32 v221, v174, v175
v_mfma_f32_16x16x32_bf16 a[44:47], a[204:207], v[196:199], a[44:47]
v_exp_f32 v188, v188
v_mfma_f32_16x16x32_bf16 a[12:15], a[204:207], v[192:195], a[12:15]
buffer_load_dwordx4 v1, s[44:47], s72 offen offset:3072 sc1 lds
v_mfma_f32_16x16x32_bf16 a[16:19], a[208:211], v[192:195], a[16:19]
v_exp_f32 v189, v189
v_mfma_f32_16x16x32_bf16 a[48:51], a[208:211], v[196:199], a[48:51]
ds_read_b128 a[252:255], v2 offset:15360
v_cvt_pk_bf16_f32 v222, v188, v189
v_mfma_f32_16x16x32_bf16 a[80:83], a[208:211], v[200:203], a[80:83]
v_exp_f32 v190, v190
v_mfma_f32_16x16x32_bf16 a[112:115], a[208:211], v[204:207], a[112:115]
v_exp_f32 v191, v191
v_mfma_f32_16x16x32_bf16 a[116:119], a[212:215], v[204:207], a[116:119]
v_cvt_pk_bf16_f32 v223, v190, v191
v_add_u32 v2, s82, v1
v_mfma_f32_16x16x32_bf16 a[84:87], a[212:215], v[200:203], a[84:87]
v_mfma_f32_16x16x32_bf16 a[52:55], a[212:215], v[196:199], a[52:55]
v_mfma_f32_16x16x32_bf16 a[20:23], a[212:215], v[192:195], a[20:23]
v_mfma_f32_16x16x32_bf16 a[24:27], a[216:219], v[192:195], a[24:27]
v_mfma_f32_16x16x32_bf16 a[56:59], a[216:219], v[196:199], a[56:59]
v_mfma_f32_16x16x32_bf16 a[88:91], a[216:219], v[200:203], a[88:91]
v_mfma_f32_16x16x32_bf16 a[120:123], a[216:219], v[204:207], a[120:123]
v_mfma_f32_16x16x32_bf16 a[124:127], a[220:223], v[204:207], a[124:127]
v_mfma_f32_16x16x32_bf16 a[92:95], a[220:223], v[200:203], a[92:95]
v_mfma_f32_16x16x32_bf16 a[60:63], a[220:223], v[196:199], a[60:63]
v_mfma_f32_16x16x32_bf16 a[28:31], a[220:223], v[192:195], a[28:31]
v_mfma_f32_16x16x32_bf16 v[224:227], v[120:123], v[192:195], v[224:227]
v_mfma_f32_16x16x32_bf16 v[228:231], v[120:123], v[196:199], v[228:231]
v_mfma_f32_16x16x32_bf16 v[232:235], v[120:123], v[200:203], v[232:235]
s_waitcnt vmcnt(8) lgkmcnt(8)
v_mfma_f32_16x16x32_bf16 v[236:239], v[120:123], v[204:207], v[236:239]
s_barrier
s_cmp_eq_u32 s58, 2
s_cbranch_scc1 Lta19
s_cmp_eq_u32 s58, 3
s_cbranch_scc1 Lnt20
v_mfma_f32_16x16x32_bf16 v[160:163], a[160:163], v[16:19], v[112:115]
s_xor_b32 s74, s82, 0x10000
v_exp_f32 v128, v128
v_mfma_f32_16x16x32_bf16 v[176:179], a[176:179], v[16:19], v[112:115]
s_add_u32 s74, s74, s64
ds_read_b128 a[128:131], v2 offset:16384
s_branch Ljoin21
Lta19:
v_mfma_f32_16x16x32_bf16 v[160:163], a[160:163], v[16:19], v[96:99]
s_xor_b32 s74, s82, 0x10000
v_exp_f32 v128, v128
v_mfma_f32_16x16x32_bf16 v[176:179], a[176:179], v[16:19], v[112:115]
s_add_u32 s74, s74, s64
ds_read_b128 a[128:131], v2 offset:16384
s_branch Ljoin21
Lnt20:
v_mfma_f32_16x16x32_bf16 v[160:163], a[160:163], v[16:19], v[80:83]
s_xor_b32 s74, s82, 0x10000
v_exp_f32 v128, v128
v_mfma_f32_16x16x32_bf16 v[176:179], a[176:179], v[16:19], v[96:99]
s_add_u32 s74, s74, s64
ds_read_b128 a[128:131], v2 offset:16384
Ljoin21:
v_mfma_f32_16x16x32_bf16 v[160:163], a[164:167], v[20:23], v[160:163]
s_add_u32 s81, s81, 0x8000
v_exp_f32 v129, v129
v_mfma_f32_16x16x32_bf16 v[160:163], a[168:171], v[24:27], v[160:163]
s_add_u32 m0, s74, 16384
v_exp_f32 v130, v130
v_mfma_f32_16x16x32_bf16 v[160:163], a[172:175], v[28:31], v[160:163]
s_add_u32 s72, s81, 16384
ds_read_b128 a[132:135], v2 offset:17408
v_cvt_pk_bf16_f32 v192, v128, v129
v_mfma_f32_16x16x32_bf16 v[164:167], a[172:175], v[44:47], v[84:87]
v_exp_f32 v131, v131
v_mfma_f32_16x16x32_bf16 v[164:167], a[168:171], v[40:43], v[164:167]
v_exp_f32 v144, v144
v_mfma_f32_16x16x32_bf16 v[164:167], a[164:167], v[36:39], v[164:167]
ds_read_b128 a[136:139], v2 offset:18432
v_cvt_pk_bf16_f32 v193, v130, v131
v_mfma_f32_16x16x32_bf16 v[164:167], a[160:163], v[32:35], v[164:167]
buffer_load_dwordx4 v1, s[44:47], s72 offen sc1 lds
v_mfma_f32_16x16x32_bf16 v[168:171], a[160:163], v[48:51], v[88:91]
v_exp_f32 v145, v145
v_mfma_f32_16x16x32_bf16 v[168:171], a[164:167], v[52:55], v[168:171]
v_exp_f32 v146, v146
v_mfma_f32_16x16x32_bf16 v[168:171], a[168:171], v[56:59], v[168:171]
ds_read_b128 a[140:143], v2 offset:19456
v_cvt_pk_bf16_f32 v194, v144, v145
v_mfma_f32_16x16x32_bf16 v[168:171], a[172:175], v[60:63], v[168:171]
v_exp_f32 v147, v147
v_mfma_f32_16x16x32_bf16 v[172:175], a[172:175], v[76:79], v[92:95]
v_exp_f32 v132, v132
v_mfma_f32_16x16x32_bf16 v[172:175], a[168:171], v[72:75], v[172:175]
ds_read_b128 a[144:147], v2 offset:20480
v_cvt_pk_bf16_f32 v195, v146, v147
v_mfma_f32_16x16x32_bf16 v[172:175], a[164:167], v[68:71], v[172:175]
v_exp_f32 v133, v133
v_mfma_f32_16x16x32_bf16 v[172:175], a[160:163], v[64:67], v[172:175]
v_exp_f32 v134, v134
v_mfma_f32_16x16x32_bf16 v[188:191], a[176:179], v[64:67], v[92:95]
ds_read_b128 a[148:151], v2 offset:21504
v_cvt_pk_bf16_f32 v196, v132, v133
v_mfma_f32_16x16x32_bf16 v[188:191], a[180:183], v[68:71], v[188:191]
v_exp_f32 v135, v135
v_mfma_f32_16x16x32_bf16 v[188:191], a[184:187], v[72:75], v[188:191]
v_exp_f32 v148, v148
v_mfma_f32_16x16x32_bf16 v[188:191], a[188:191], v[76:79], v[188:191]
ds_read_b128 a[152:155], v2 offset:22528
v_cvt_pk_bf16_f32 v197, v134, v135
v_mfma_f32_16x16x32_bf16 v[184:187], a[188:191], v[60:63], v[88:91]
buffer_load_dwordx4 v1, s[44:47], s72 offen offset:1024 sc1 lds
v_mfma_f32_16x16x32_bf16 v[184:187], a[184:187], v[56:59], v[184:187]
v_exp_f32 v149, v149
v_mfma_f32_16x16x32_bf16 v[184:187], a[180:183], v[52:55], v[184:187]
v_exp_f32 v150, v150
v_mfma_f32_16x16x32_bf16 v[184:187], a[176:179], v[48:51], v[184:187]
ds_read_b128 a[156:159], v2 offset:23552
v_cvt_pk_bf16_f32 v198, v148, v149
v_mfma_f32_16x16x32_bf16 v[180:183], a[176:179], v[32:35], v[84:87]
v_exp_f32 v151, v151
v_mfma_f32_16x16x32_bf16 v[180:183], a[180:183], v[36:39], v[180:183]
v_exp_f32 v136, v136
v_mfma_f32_16x16x32_bf16 v[180:183], a[184:187], v[40:43], v[180:183]
ds_read_b128 a[192:195], v2 offset:0
v_cvt_pk_bf16_f32 v199, v150, v151
v_mfma_f32_16x16x32_bf16 v[180:183], a[188:191], v[44:47], v[180:183]
v_exp_f32 v137, v137
v_mfma_f32_16x16x32_bf16 v[176:179], a[188:191], v[28:31], v[176:179]
v_exp_f32 v138, v138
v_mfma_f32_16x16x32_bf16 v[176:179], a[184:187], v[24:27], v[176:179]
ds_read_b128 a[196:199], v2 offset:1024
v_cvt_pk_bf16_f32 v200, v136, v137
v_mfma_f32_16x16x32_bf16 v[176:179], a[180:183], v[20:23], v[176:179]
s_waitcnt lgkmcnt(10)
v_exp_f32 v139, v139
v_mfma_f32_16x16x32_bf16 a[0:3], a[224:227], v[208:211], a[0:3]
v_exp_f32 v152, v152
v_mfma_f32_16x16x32_bf16 a[32:35], a[224:227], v[212:215], a[32:35]
ds_read_b128 a[200:203], v2 offset:2048
v_cvt_pk_bf16_f32 v201, v138, v139
v_mfma_f32_16x16x32_bf16 a[64:67], a[224:227], v[216:219], a[64:67]
buffer_load_dwordx4 v1, s[44:47], s72 offen offset:2048 sc1 lds
v_mfma_f32_16x16x32_bf16 a[96:99], a[224:227], v[220:223], a[96:99]
v_exp_f32 v153, v153
v_mfma_f32_16x16x32_bf16 a[100:103], a[228:231], v[220:223], a[100:103]
v_exp_f32 v154, v154
v_mfma_f32_16x16x32_bf16 a[68:71], a[228:231], v[216:219], a[68:71]
ds_read_b128 a[204:207], v2 offset:3072
v_cvt_pk_bf16_f32 v202, v152, v153
v_mfma_f32_16x16x32_bf16 a[36:39], a[228:231], v[212:215], a[36:39]
v_exp_f32 v155, v155
v_mfma_f32_16x16x32_bf16 a[4:7], a[228:231], v[208:211], a[4:7]
v_exp_f32 v140, v140
v_mfma_f32_16x16x32_bf16 a[8:11], a[232:235], v[208:211], a[8:11]
ds_read_b128 a[208:211], v2 offset:4096
v_cvt_pk_bf16_f32 v203, v154, v155
v_mfma_f32_16x16x32_bf16 a[40:43], a[232:235], v[212:215], a[40:43]
v_exp_f32 v141, v141
v_mfma_f32_16x16x32_bf16 a[72:75], a[232:235], v[216:219], a[72:75]
v_exp_f32 v142, v142
v_mfma_f32_16x16x32_bf16 a[104:107], a[232:235], v[220:223], a[104:107]
ds_read_b128 a[212:215], v2 offset:5120
v_cvt_pk_bf16_f32 v204, v140, v141
v_mfma_f32_16x16x32_bf16 a[108:111], a[236:239], v[220:223], a[108:111]
v_exp_f32 v143, v143
v_mfma_f32_16x16x32_bf16 a[76:79], a[236:239], v[216:219], a[76:79]
v_exp_f32 v156, v156
v_mfma_f32_16x16x32_bf16 a[44:47], a[236:239], v[212:215], a[44:47]
ds_read_b128 a[216:219], v2 offset:6144
v_cvt_pk_bf16_f32 v205, v142, v143
v_mfma_f32_16x16x32_bf16 a[12:15], a[236:239], v[208:211], a[12:15]
buffer_load_dwordx4 v1, s[44:47], s72 offen offset:3072 sc1 lds
v_mfma_f32_16x16x32_bf16 a[16:19], a[240:243], v[208:211], a[16:19]
v_exp_f32 v157, v157
v_mfma_f32_16x16x32_bf16 a[48:51], a[240:243], v[212:215], a[48:51]
v_exp_f32 v158, v158
v_mfma_f32_16x16x32_bf16 a[80:83], a[240:243], v[216:219], a[80:83]
ds_read_b128 a[220:223], v2 offset:7168
v_cvt_pk_bf16_f32 v206, v156, v157
v_mfma_f32_16x16x32_bf16 a[112:115], a[240:243], v[220:223], a[112:115]
v_exp_f32 v159, v159
v_mfma_f32_16x16x32_bf16 a[116:119], a[244:247], v[220:223], a[116:119]
v_cvt_pk_bf16_f32 v207, v158, v159
v_mfma_f32_16x16x32_bf16 a[84:87], a[244:247], v[216:219], a[84:87]
v_mfma_f32_16x16x32_bf16 a[52:55], a[244:247], v[212:215], a[52:55]
v_mfma_f32_16x16x32_bf16 a[20:23], a[244:247], v[208:211], a[20:23]
v_mfma_f32_16x16x32_bf16 a[24:27], a[248:251], v[208:211], a[24:27]
v_mfma_f32_16x16x32_bf16 a[56:59], a[248:251], v[212:215], a[56:59]
v_mfma_f32_16x16x32_bf16 a[88:91], a[248:251], v[216:219], a[88:91]
v_mfma_f32_16x16x32_bf16 a[120:123], a[248:251], v[220:223], a[120:123]
v_mfma_f32_16x16x32_bf16 a[124:127], a[252:255], v[220:223], a[124:127]
v_mfma_f32_16x16x32_bf16 a[92:95], a[252:255], v[216:219], a[92:95]
v_mfma_f32_16x16x32_bf16 a[60:63], a[252:255], v[212:215], a[60:63]
v_mfma_f32_16x16x32_bf16 a[28:31], a[252:255], v[208:211], a[28:31]
v_mfma_f32_16x16x32_bf16 v[224:227], v[120:123], v[208:211], v[224:227]
v_mfma_f32_16x16x32_bf16 v[228:231], v[120:123], v[212:215], v[228:231]
v_mfma_f32_16x16x32_bf16 v[232:235], v[120:123], v[216:219], v[232:235]
v_mfma_f32_16x16x32_bf16 v[236:239], v[120:123], v[220:223], v[236:239]
s_waitcnt lgkmcnt(8)
s_cmp_eq_u32 s58, 0
s_cbranch_scc1 Lta22
s_cmp_eq_u32 s58, 1
s_cbranch_scc1 Lnt23
v_mfma_f32_16x16x32_bf16 v[132:135], a[128:131], v[32:35], v[84:87]
s_add_u32 s82, s82, 0x8000
ds_read_b128 a[160:163], v2 offset:24576
v_mfma_f32_16x16x32_bf16 v[148:151], a[144:147], v[32:35], v[84:87]
s_and_b32 s82, s82, 0x1ffff
v_exp_f32 v160, v160
s_branch Ljoin24
Lta22:
v_mfma_f32_16x16x32_bf16 v[132:135], a[128:131], v[32:35], v[100:103]
s_add_u32 s82, s82, 0x8000
ds_read_b128 a[160:163], v2 offset:24576
v_mfma_f32_16x16x32_bf16 v[148:151], a[144:147], v[32:35], v[112:115]
s_and_b32 s82, s82, 0x1ffff
v_exp_f32 v160, v160
s_branch Ljoin24
Lnt23:
v_mfma_f32_16x16x32_bf16 v[132:135], a[128:131], v[32:35], v[84:87]
s_add_u32 s82, s82, 0x8000
ds_read_b128 a[160:163], v2 offset:24576
v_mfma_f32_16x16x32_bf16 v[148:151], a[144:147], v[32:35], v[100:103]
s_and_b32 s82, s82, 0x1ffff
v_exp_f32 v160, v160
Ljoin24:
v_mfma_f32_16x16x32_bf16 v[132:135], a[132:135], v[36:39], v[132:135]
s_add_u32 m0, s74, 0
v_exp_f32 v161, v161
v_mfma_f32_16x16x32_bf16 v[132:135], a[136:139], v[40:43], v[132:135]
s_add_u32 s72, s81, 0
ds_read_b128 a[164:167], v2 offset:25600
v_cvt_pk_bf16_f32 v208, v160, v161
v_mfma_f32_16x16x32_bf16 v[132:135], a[140:143], v[44:47], v[132:135]
v_exp_f32 v162, v162
v_mfma_f32_16x16x32_bf16 v[136:139], a[140:143], v[60:63], v[88:91]
v_exp_f32 v163, v163
v_mfma_f32_16x16x32_bf16 v[136:139], a[136:139], v[56:59], v[136:139]
ds_read_b128 a[168:171], v2 offset:26624
v_cvt_pk_bf16_f32 v209, v162, v163
v_mfma_f32_16x16x32_bf16 v[136:139], a[132:135], v[52:55], v[136:139]
v_exp_f32 v176, v176
v_mfma_f32_16x16x32_bf16 v[136:139], a[128:131], v[48:51], v[136:139]
buffer_load_dwordx4 v1, s[44:47], s72 offen sc1 lds
v_mfma_f32_16x16x32_bf16 v[140:143], a[128:131], v[64:67], v[92:95]
v_exp_f32 v177, v177
v_mfma_f32_16x16x32_bf16 v[140:143], a[132:135], v[68:71], v[140:143]
ds_read_b128 a[172:175], v2 offset:27648
v_cvt_pk_bf16_f32 v210, v176, v177
v_mfma_f32_16x16x32_bf16 v[140:143], a[136:139], v[72:75], v[140:143]
v_exp_f32 v178, v178
v_mfma_f32_16x16x32_bf16 v[140:143], a[140:143], v[76:79], v[140:143]
v_exp_f32 v179, v179
v_mfma_f32_16x16x32_bf16 v[156:159], a[156:159], v[76:79], v[92:95]
ds_read_b128 a[176:179], v2 offset:28672
v_cvt_pk_bf16_f32 v211, v178, v179
v_mfma_f32_16x16x32_bf16 v[156:159], a[152:155], v[72:75], v[156:159]
v_exp_f32 v164, v164
v_mfma_f32_16x16x32_bf16 v[156:159], a[148:151], v[68:71], v[156:159]
v_exp_f32 v165, v165
v_mfma_f32_16x16x32_bf16 v[156:159], a[144:147], v[64:67], v[156:159]
ds_read_b128 a[180:183], v2 offset:29696
v_cvt_pk_bf16_f32 v212, v164, v165
v_mfma_f32_16x16x32_bf16 v[152:155], a[144:147], v[48:51], v[88:91]
v_exp_f32 v166, v166
v_mfma_f32_16x16x32_bf16 v[152:155], a[148:151], v[52:55], v[152:155]
v_exp_f32 v167, v167
v_mfma_f32_16x16x32_bf16 v[152:155], a[152:155], v[56:59], v[152:155]
ds_read_b128 a[184:187], v2 offset:30720
v_cvt_pk_bf16_f32 v213, v166, v167
v_mfma_f32_16x16x32_bf16 v[152:155], a[156:159], v[60:63], v[152:155]
v_exp_f32 v180, v180
v_mfma_f32_16x16x32_bf16 v[148:151], a[156:159], v[44:47], v[148:151]
buffer_load_dwordx4 v1, s[44:47], s72 offen offset:1024 sc1 lds
v_mfma_f32_16x16x32_bf16 v[148:151], a[152:155], v[40:43], v[148:151]
v_exp_f32 v181, v181
v_mfma_f32_16x16x32_bf16 v[148:151], a[148:151], v[36:39], v[148:151]
s_waitcnt lgkmcnt(7)
ds_read_b128 a[188:191], v2 offset:31744
v_cvt_pk_bf16_f32 v214, v180, v181
v_mfma_f32_16x16x32_bf16 a[0:3], a[192:195], v[192:195], a[0:3]
v_exp_f32 v182, v182
v_mfma_f32_16x16x32_bf16 a[32:35], a[192:195], v[196:199], a[32:35]
v_exp_f32 v183, v183
v_mfma_f32_16x16x32_bf16 a[64:67], a[192:195], v[200:203], a[64:67]
ds_read_b128 a[224:227], v2 offset:8192
v_cvt_pk_bf16_f32 v215, v182, v183
v_mfma_f32_16x16x32_bf16 a[96:99], a[192:195], v[204:207], a[96:99]
v_exp_f32 v168, v168
v_mfma_f32_16x16x32_bf16 a[100:103], a[196:199], v[204:207], a[100:103]
v_exp_f32 v169, v169
v_mfma_f32_16x16x32_bf16 a[68:71], a[196:199], v[200:203], a[68:71]
ds_read_b128 a[228:231], v2 offset:9216
v_cvt_pk_bf16_f32 v216, v168, v169
v_mfma_f32_16x16x32_bf16 a[36:39], a[196:199], v[196:199], a[36:39]
v_exp_f32 v170, v170
v_mfma_f32_16x16x32_bf16 a[4:7], a[196:199], v[192:195], a[4:7]
v_exp_f32 v171, v171
v_mfma_f32_16x16x32_bf16 a[8:11], a[200:203], v[192:195], a[8:11]
ds_read_b128 a[232:235], v2 offset:10240
v_cvt_pk_bf16_f32 v217, v170, v171
v_mfma_f32_16x16x32_bf16 a[40:43], a[200:203], v[196:199], a[40:43]
v_exp_f32 v184, v184
v_mfma_f32_16x16x32_bf16 a[72:75], a[200:203], v[200:203], a[72:75]
buffer_load_dwordx4 v1, s[44:47], s72 offen offset:2048 sc1 lds
v_mfma_f32_16x16x32_bf16 a[104:107], a[200:203], v[204:207], a[104:107]
v_exp_f32 v185, v185
v_mfma_f32_16x16x32_bf16 a[108:111], a[204:207], v[204:207], a[108:111]
ds_read_b128 a[236:239], v2 offset:11264
v_cvt_pk_bf16_f32 v218, v184, v185
v_mfma_f32_16x16x32_bf16 a[76:79], a[204:207], v[200:203], a[76:79]
v_exp_f32 v186, v186
v_mfma_f32_16x16x32_bf16 a[44:47], a[204:207], v[196:199], a[44:47]
v_exp_f32 v187, v187
v_mfma_f32_16x16x32_bf16 a[12:15], a[204:207], v[192:195], a[12:15]
ds_read_b128 a[240:243], v2 offset:12288
v_cvt_pk_bf16_f32 v219, v186, v187
v_mfma_f32_16x16x32_bf16 a[16:19], a[208:211], v[192:195], a[16:19]
v_exp_f32 v172, v172
v_mfma_f32_16x16x32_bf16 a[48:51], a[208:211], v[196:199], a[48:51]
v_exp_f32 v173, v173
v_mfma_f32_16x16x32_bf16 a[80:83], a[208:211], v[200:203], a[80:83]
ds_read_b128 a[244:247], v2 offset:13312
v_cvt_pk_bf16_f32 v220, v172, v173
v_mfma_f32_16x16x32_bf16 a[112:115], a[208:211], v[204:207], a[112:115]
v_exp_f32 v174, v174
v_mfma_f32_16x16x32_bf16 a[116:119], a[212:215], v[204:207], a[116:119]
v_exp_f32 v175, v175
v_mfma_f32_16x16x32_bf16 a[84:87], a[212:215], v[200:203], a[84:87]
ds_read_b128 a[248:251], v2 offset:14336
v_cvt_pk_bf16_f32 v221, v174, v175
v_mfma_f32_16x16x32_bf16 a[52:55], a[212:215], v[196:199], a[52:55]
v_exp_f32 v188, v188
v_mfma_f32_16x16x32_bf16 a[20:23], a[212:215], v[192:195], a[20:23]
buffer_load_dwordx4 v1, s[44:47], s72 offen offset:3072 sc1 lds
v_mfma_f32_16x16x32_bf16 a[24:27], a[216:219], v[192:195], a[24:27]
v_exp_f32 v189, v189
v_mfma_f32_16x16x32_bf16 a[56:59], a[216:219], v[196:199], a[56:59]
ds_read_b128 a[252:255], v2 offset:15360
v_cvt_pk_bf16_f32 v222, v188, v189
v_mfma_f32_16x16x32_bf16 a[88:91], a[216:219], v[200:203], a[88:91]
v_exp_f32 v190, v190
v_mfma_f32_16x16x32_bf16 a[120:123], a[216:219], v[204:207], a[120:123]
v_exp_f32 v191, v191
v_mfma_f32_16x16x32_bf16 a[124:127], a[220:223], v[204:207], a[124:127]
v_cvt_pk_bf16_f32 v223, v190, v191
v_add_u32 v2, s82, v1
v_mfma_f32_16x16x32_bf16 a[92:95], a[220:223], v[200:203], a[92:95]
v_mfma_f32_16x16x32_bf16 a[60:63], a[220:223], v[196:199], a[60:63]
v_mfma_f32_16x16x32_bf16 a[28:31], a[220:223], v[192:195], a[28:31]
v_mfma_f32_16x16x32_bf16 v[224:227], v[120:123], v[192:195], v[224:227]
v_mfma_f32_16x16x32_bf16 v[228:231], v[120:123], v[196:199], v[228:231]
v_mfma_f32_16x16x32_bf16 v[232:235], v[120:123], v[200:203], v[232:235]
s_waitcnt vmcnt(8) lgkmcnt(8)
v_mfma_f32_16x16x32_bf16 v[236:239], v[120:123], v[204:207], v[236:239]
s_barrier
s_cmp_eq_u32 s60, 7
s_cbranch_scc1 LLT3x
LLT3:
Lstub3:
s_cbranch_execz Lstub7
s_cmp_eq_u32 s58, 2
s_cbranch_scc1 Lta25
s_cmp_eq_u32 s58, 3
s_cbranch_scc1 Lnt26
v_mfma_f32_16x16x32_bf16 v[164:167], a[160:163], v[32:35], v[112:115]
s_xor_b32 s74, s82, 0x10000
v_exp_f32 v132, v132
v_mfma_f32_16x16x32_bf16 v[180:183], a[176:179], v[32:35], v[112:115]
s_add_u32 s74, s74, s64
ds_read_b128 a[128:131], v2 offset:16384
s_branch Ljoin27
Lta25:
v_mfma_f32_16x16x32_bf16 v[164:167], a[160:163], v[32:35], v[100:103]
s_xor_b32 s74, s82, 0x10000
v_exp_f32 v132, v132
v_mfma_f32_16x16x32_bf16 v[180:183], a[176:179], v[32:35], v[112:115]
s_add_u32 s74, s74, s64
ds_read_b128 a[128:131], v2 offset:16384
s_branch Ljoin27
Lnt26:
v_mfma_f32_16x16x32_bf16 v[164:167], a[160:163], v[32:35], v[84:87]
s_xor_b32 s74, s82, 0x10000
v_exp_f32 v132, v132
v_mfma_f32_16x16x32_bf16 v[180:183], a[176:179], v[32:35], v[100:103]
s_add_u32 s74, s74, s64
ds_read_b128 a[128:131], v2 offset:16384
Ljoin27:
v_mfma_f32_16x16x32_bf16 v[164:167], a[164:167], v[36:39], v[164:167]
s_add_u32 s81, s81, 0x8000
v_exp_f32 v133, v133
v_mfma_f32_16x16x32_bf16 v[164:167], a[168:171], v[40:43], v[164:167]
s_add_u32 m0, s74, 16384
ds_read_b128 a[132:135], v2 offset:17408
v_cvt_pk_bf16_f32 v196, v132, v133
v_mfma_f32_16x16x32_bf16 v[164:167], a[172:175], v[44:47], v[164:167]
s_add_u32 s72, s81, 16384
v_exp_f32 v134, v134
v_mfma_f32_16x16x32_bf16 v[168:171], a[172:175], v[60:63], v[88:91]
v_exp_f32 v135, v135
v_mfma_f32_16x16x32_bf16 v[168:171], a[168:171], v[56:59], v[168:171]
ds_read_b128 a[136:139], v2 offset:18432
v_cvt_pk_bf16_f32 v197, v134, v135
v_mfma_f32_16x16x32_bf16 v[168:171], a[164:167], v[52:55], v[168:171]
buffer_load_dwordx4 v1, s[44:47], s72 offen sc1 lds
v_mfma_f32_16x16x32_bf16 v[168:171], a[160:163], v[48:51], v[168:171]
v_exp_f32 v148, v148
v_mfma_f32_16x16x32_bf16 v[172:175], a[160:163], v[64:67], v[92:95]
ds_read_b128 a[140:143], v2 offset:19456
v_bfe_u32 v251, v0, 2, 2
v_mfma_f32_16x16x32_bf16 v[172:175], a[164:167], v[68:71], v[172:175]
v_exp_f32 v149, v149
v_mfma_f32_16x16x32_bf16 v[172:175], a[168:171], v[72:75], v[172:175]
v_exp_f32 v150, v150
v_mfma_f32_16x16x32_bf16 v[172:175], a[172:175], v[76:79], v[172:175]
ds_read_b128 a[144:147], v2 offset:20480
v_cvt_pk_bf16_f32 v198, v148, v149
v_mfma_f32_16x16x32_bf16 v[188:191], a[188:191], v[76:79], v[92:95]
v_exp_f32 v151, v151
v_mfma_f32_16x16x32_bf16 v[188:191], a[184:187], v[72:75], v[188:191]
ds_read_b128 a[148:151], v2 offset:21504
v_cvt_pk_bf16_f32 v199, v150, v151
v_mfma_f32_16x16x32_bf16 v[188:191], a[180:183], v[68:71], v[188:191]
v_exp_f32 v136, v136
v_mfma_f32_16x16x32_bf16 v[188:191], a[176:179], v[64:67], v[188:191]
Lstub4:
s_cbranch_execz Lstub8
v_exp_f32 v137, v137
v_mfma_f32_16x16x32_bf16 v[184:187], a[176:179], v[48:51], v[88:91]
ds_read_b128 a[152:155], v2 offset:22528
v_cvt_pk_bf16_f32 v200, v136, v137
v_mfma_f32_16x16x32_bf16 v[184:187], a[180:183], v[52:55], v[184:187]
buffer_load_dwordx4 v1, s[44:47], s72 offen offset:1024 sc1 lds
v_mfma_f32_16x16x32_bf16 v[184:187], a[184:187], v[56:59], v[184:187]
v_exp_f32 v138, v138
v_mfma_f32_16x16x32_bf16 v[184:187], a[188:191], v[60:63], v[184:187]
ds_read_b128 a[156:159], v2 offset:23552
v_lshl_add_u32 v6, v248, 3, v6
v_mfma_f32_16x16x32_bf16 v[180:183], a[188:191], v[44:47], v[180:183]
v_exp_f32 v139, v139
v_mfma_f32_16x16x32_bf16 v[180:183], a[184:187], v[40:43], v[180:183]
v_exp_f32 v152, v152
v_mfma_f32_16x16x32_bf16 v[180:183], a[180:183], v[36:39], v[180:183]
s_waitcnt lgkmcnt(8)
ds_read_b128 a[192:195], v2 offset:0
v_cvt_pk_bf16_f32 v201, v138, v139
v_mfma_f32_16x16x32_bf16 a[0:3], a[224:227], v[208:211], a[0:3]
v_exp_f32 v153, v153
v_mfma_f32_16x16x32_bf16 a[32:35], a[224:227], v[212:215], a[32:35]
ds_read_b128 a[196:199], v2 offset:1024
v_cvt_pk_bf16_f32 v202, v152, v153
v_mfma_f32_16x16x32_bf16 a[64:67], a[224:227], v[216:219], a[64:67]
v_exp_f32 v154, v154
v_mfma_f32_16x16x32_bf16 a[96:99], a[224:227], v[220:223], a[96:99]
v_exp_f32 v155, v155
v_mfma_f32_16x16x32_bf16 a[100:103], a[228:231], v[220:223], a[100:103]
ds_read_b128 a[200:203], v2 offset:2048
v_cvt_pk_bf16_f32 v203, v154, v155
v_mfma_f32_16x16x32_bf16 a[68:71], a[228:231], v[216:219], a[68:71]
buffer_load_dwordx4 v1, s[44:47], s72 offen offset:2048 sc1 lds
v_mfma_f32_16x16x32_bf16 a[36:39], a[228:231], v[212:215], a[36:39]
v_exp_f32 v140, v140
v_mfma_f32_16x16x32_bf16 a[4:7], a[228:231], v[208:211], a[4:7]
ds_read_b128 a[204:207], v2 offset:3072
v_lshl_add_u32 v6, v241, 4, v6
v_mfma_f32_16x16x32_bf16 a[8:11], a[232:235], v[208:211], a[8:11]
v_exp_f32 v141, v141
v_mfma_f32_16x16x32_bf16 a[40:43], a[232:235], v[212:215], a[40:43]
v_exp_f32 v142, v142
v_mfma_f32_16x16x32_bf16 a[72:75], a[232:235], v[216:219], a[72:75]
ds_read_b128 a[208:211], v2 offset:4096
v_cvt_pk_bf16_f32 v204, v140, v141
v_mfma_f32_16x16x32_bf16 a[104:107], a[232:235], v[220:223], a[104:107]
v_exp_f32 v143, v143
v_mfma_f32_16x16x32_bf16 a[108:111], a[236:239], v[220:223], a[108:111]
ds_read_b128 a[212:215], v2 offset:5120
v_cvt_pk_bf16_f32 v205, v142, v143
v_mfma_f32_16x16x32_bf16 a[76:79], a[236:239], v[216:219], a[76:79]
v_exp_f32 v156, v156
v_mfma_f32_16x16x32_bf16 a[44:47], a[236:239], v[212:215], a[44:47]
v_exp_f32 v157, v157
v_mfma_f32_16x16x32_bf16 a[12:15], a[236:239], v[208:211], a[12:15]
ds_read_b128 a[216:219], v2 offset:6144
v_cvt_pk_bf16_f32 v206, v156, v157
v_mfma_f32_16x16x32_bf16 a[16:19], a[240:243], v[208:211], a[16:19]
buffer_load_dwordx4 v1, s[44:47], s72 offen offset:3072 sc1 lds
v_mfma_f32_16x16x32_bf16 a[48:51], a[240:243], v[212:215], a[48:51]
v_exp_f32 v158, v158
v_mfma_f32_16x16x32_bf16 a[80:83], a[240:243], v[216:219], a[80:83]
ds_read_b128 a[220:223], v2 offset:7168
v_lshlrev_b32 v5, 3, v251
v_mfma_f32_16x16x32_bf16 a[112:115], a[240:243], v[220:223], a[112:115]
v_exp_f32 v159, v159
v_mfma_f32_16x16x32_bf16 a[116:119], a[244:247], v[220:223], a[116:119]
v_cvt_pk_bf16_f32 v207, v158, v159
v_lshrrev_b32 v5, v5, v252
v_mfma_f32_16x16x32_bf16 a[84:87], a[244:247], v[216:219], a[84:87]
v_and_b32 v5, 3, v5
v_cmp_ne_u32 vcc, 1, v251
v_mfma_f32_16x16x32_bf16 a[52:55], a[244:247], v[212:215], a[52:55]
v_mul_u32_u24 v5, 16640, v5
v_add_u32 v5, s92, v5
v_mfma_f32_16x16x32_bf16 a[20:23], a[244:247], v[208:211], a[20:23]
v_cndmask_b32 v5, v250, v5, vcc
v_add_u32 v253, s58, v251
v_mfma_f32_16x16x32_bf16 a[24:27], a[248:251], v[208:211], a[24:27]
v_and_b32 v253, 3, v253
v_mul_u32_u24 v253, 4160, v253
v_mfma_f32_16x16x32_bf16 a[56:59], a[248:251], v[212:215], a[56:59]
v_add_u32 v5, v5, v253
v_mfma_f32_16x16x32_bf16 a[88:91], a[248:251], v[216:219], a[88:91]
s_add_u32 s73, s62, 480
v_lshlrev_b32 v248, 5, v240
v_sub_u32 v248, s73, v248
v_mfma_f32_16x16x32_bf16 a[120:123], a[248:251], v[220:223], a[120:123]
v_lshl_add_u32 v7, v241, 4, v248
v_mfma_f32_16x16x32_bf16 a[124:127], a[252:255], v[220:223], a[124:127]
s_and_b32 s73, s58, 1
v_mfma_f32_16x16x32_bf16 a[92:95], a[252:255], v[216:219], a[92:95]
s_lshl_b32 s73, s73, 4
v_mfma_f32_16x16x32_bf16 a[60:63], a[252:255], v[212:215], a[60:63]
s_lshr_b32 s73, s90, s73
v_mfma_f32_16x16x32_bf16 a[28:31], a[252:255], v[208:211], a[28:31]
s_and_b32 s73, s73, 0xffff
v_lshl_add_u32 v248, v241, 3, v240
v_sub_u32 v248, 15, v248
v_mfma_f32_16x16x32_bf16 v[224:227], v[120:123], v[208:211], v[224:227]
v_and_b32 v249, 1, v248
v_lshlrev_b32 v249, 4, v249
v_mfma_f32_16x16x32_bf16 v[228:231], v[120:123], v[212:215], v[228:231]
v_lshlrev_b32 v249, v249, s73
v_lshrrev_b32 v248, 1, v248
v_mfma_f32_16x16x32_bf16 v[232:235], v[120:123], v[216:219], v[232:235]
v_and_b32 v241, 3, v0
v_cmp_eq_u32 vcc, 0, v248
v_mfma_f32_16x16x32_bf16 v[236:239], v[120:123], v[220:223], v[236:239]
s_waitcnt lgkmcnt(8)
v_mfma_f32_16x16x32_bf16 v[136:139], a[128:131], v[48:51], v[88:91]
s_add_u32 s82, s82, 0x8000
ds_read_b128 a[160:163], v2 offset:24576
ds_read_b128 a[164:167], v2 offset:25600
v_mfma_f32_16x16x32_bf16 v[136:139], a[132:135], v[52:55], v[136:139]
s_and_b32 s82, s82, 0x1ffff
v_exp_f32 v164, v164
v_mfma_f32_16x16x32_bf16 v[136:139], a[136:139], v[56:59], v[136:139]
s_add_u32 m0, s74, 0
v_exp_f32 v165, v165
v_mfma_f32_16x16x32_bf16 v[136:139], a[140:143], v[60:63], v[136:139]
s_add_u32 s72, s81, 0
v_exp_f32 v166, v166
v_mfma_f32_16x16x32_bf16 v[140:143], a[140:143], v[76:79], v[92:95]
ds_read_b128 a[168:171], v2 offset:26624
v_cvt_pk_bf16_f32 v212, v164, v165
v_mfma_f32_16x16x32_bf16 v[140:143], a[136:139], v[72:75], v[140:143]
v_exp_f32 v167, v167
v_mfma_f32_16x16x32_bf16 v[140:143], a[132:135], v[68:71], v[140:143]
buffer_load_dwordx4 v1, s[44:47], s72 offen sc1 lds
v_mfma_f32_16x16x32_bf16 v[140:143], a[128:131], v[64:67], v[140:143]
v_exp_f32 v180, v180
v_mfma_f32_16x16x32_bf16 v[156:159], a[144:147], v[64:67], v[92:95]
ds_read_b128 a[172:175], v2 offset:27648
v_cvt_pk_bf16_f32 v213, v166, v167
v_mfma_f32_16x16x32_bf16 v[156:159], a[148:151], v[68:71], v[156:159]
v_exp_f32 v181, v181
v_mfma_f32_16x16x32_bf16 v[156:159], a[152:155], v[72:75], v[156:159]
ds_read_b128 a[176:179], v2 offset:28672
v_cvt_pk_bf16_f32 v214, v180, v181
v_mfma_f32_16x16x32_bf16 v[156:159], a[156:159], v[76:79], v[156:159]
v_exp_f32 v182, v182
v_mfma_f32_16x16x32_bf16 v[152:155], a[156:159], v[60:63], v[88:91]
v_exp_f32 v183, v183
v_mfma_f32_16x16x32_bf16 v[152:155], a[152:155], v[56:59], v[152:155]
ds_read_b128 a[180:183], v2 offset:29696
v_cvt_pk_bf16_f32 v215, v182, v183
v_mfma_f32_16x16x32_bf16 v[152:155], a[148:151], v[52:55], v[152:155]
v_exp_f32 v168, v168
v_mfma_f32_16x16x32_bf16 v[152:155], a[144:147], v[48:51], v[152:155]
s_waitcnt lgkmcnt(6)
ds_read_b128 a[184:187], v2 offset:30720
ds_read_b128 a[188:191], v2 offset:31744
v_mfma_f32_16x16x32_bf16 a[32:35], a[192:195], v[196:199], a[32:35]
v_exp_f32 v169, v169
v_mfma_f32_16x16x32_bf16 a[64:67], a[192:195], v[200:203], a[64:67]
buffer_load_dwordx4 v1, s[44:47], s72 offen offset:1024 sc1 lds
v_mfma_f32_16x16x32_bf16 a[96:99], a[192:195], v[204:207], a[96:99]
v_exp_f32 v170, v170
v_mfma_f32_16x16x32_bf16 a[100:103], a[196:199], v[204:207], a[100:103]
v_exp_f32 v171, v171
v_mfma_f32_16x16x32_bf16 a[68:71], a[196:199], v[200:203], a[68:71]
ds_read_b128 a[224:227], v2 offset:8192
v_cvt_pk_bf16_f32 v216, v168, v169
v_mfma_f32_16x16x32_bf16 a[36:39], a[196:199], v[196:199], a[36:39]
v_exp_f32 v184, v184
v_mfma_f32_16x16x32_bf16 a[40:43], a[200:203], v[196:199], a[40:43]
v_exp_f32 v185, v185
v_mfma_f32_16x16x32_bf16 a[72:75], a[200:203], v[200:203], a[72:75]
ds_read_b128 a[228:231], v2 offset:9216
v_cvt_pk_bf16_f32 v217, v170, v171
v_mfma_f32_16x16x32_bf16 a[104:107], a[200:203], v[204:207], a[104:107]
v_exp_f32 v186, v186
v_mfma_f32_16x16x32_bf16 a[108:111], a[204:207], v[204:207], a[108:111]
ds_read_b128 a[232:235], v2 offset:10240
v_cvt_pk_bf16_f32 v218, v184, v185
v_mfma_f32_16x16x32_bf16 a[76:79], a[204:207], v[200:203], a[76:79]
v_exp_f32 v187, v187
v_mfma_f32_16x16x32_bf16 a[44:47], a[204:207], v[196:199], a[44:47]
buffer_load_dwordx4 v1, s[44:47], s72 offen offset:2048 sc1 lds
v_mfma_f32_16x16x32_bf16 a[48:51], a[208:211], v[196:199], a[48:51]
v_exp_f32 v172, v172
v_mfma_f32_16x16x32_bf16 a[80:83], a[208:211], v[200:203], a[80:83]
ds_read_b128 a[236:239], v2 offset:11264
v_cvt_pk_bf16_f32 v219, v186, v187
v_mfma_f32_16x16x32_bf16 a[112:115], a[208:211], v[204:207], a[112:115]
v_exp_f32 v173, v173
v_mfma_f32_16x16x32_bf16 a[116:119], a[212:215], v[204:207], a[116:119]
ds_read_b128 a[240:243], v2 offset:12288
v_cvt_pk_bf16_f32 v220, v172, v173
v_mfma_f32_16x16x32_bf16 a[84:87], a[212:215], v[200:203], a[84:87]
v_exp_f32 v174, v174
v_mfma_f32_16x16x32_bf16 a[52:55], a[212:215], v[196:199], a[52:55]
v_exp_f32 v175, v175
v_mfma_f32_16x16x32_bf16 a[56:59], a[216:219], v[196:199], a[56:59]
ds_read_b128 a[244:247], v2 offset:13312
v_cvt_pk_bf16_f32 v221, v174, v175
v_mfma_f32_16x16x32_bf16 a[88:91], a[216:219], v[200:203], a[88:91]
v_exp_f32 v188, v188
v_mfma_f32_16x16x32_bf16 a[120:123], a[216:219], v[204:207], a[120:123]
ds_read_b128 a[248:251], v2 offset:14336
v_mfma_f32_16x16x32_bf16 a[124:127], a[220:223], v[204:207], a[124:127]
v_exp_f32 v189, v189
v_mfma_f32_16x16x32_bf16 a[92:95], a[220:223], v[200:203], a[92:95]
buffer_load_dwordx4 v1, s[44:47], s72 offen offset:3072 sc1 lds
v_mfma_f32_16x16x32_bf16 a[60:63], a[220:223], v[196:199], a[60:63]
ds_read_b128 a[252:255], v2 offset:15360
v_cvt_pk_bf16_f32 v222, v188, v189
v_mfma_f32_16x16x32_bf16 v[228:231], v[120:123], v[196:199], v[228:231]
v_exp_f32 v190, v190
v_mfma_f32_16x16x32_bf16 v[232:235], v[120:123], v[200:203], v[232:235]
s_waitcnt vmcnt(8) lgkmcnt(8)
v_exp_f32 v191, v191
v_mfma_f32_16x16x32_bf16 v[236:239], v[120:123], v[204:207], v[236:239]
s_barrier
v_cvt_pk_bf16_f32 v223, v190, v191
v_add_u32 v2, s82, v1
v_mfma_f32_16x16x32_bf16 v[168:171], a[160:163], v[48:51], v[88:91]
s_xor_b32 s74, s82, 0x10000
v_exp_f32 v136, v136
v_mfma_f32_16x16x32_bf16 v[168:171], a[164:167], v[52:55], v[168:171]
s_add_u32 s74, s74, s64
ds_read_b128 a[128:131], v2 offset:16384
v_mfma_f32_16x16x32_bf16 v[168:171], a[168:171], v[56:59], v[168:171]
s_add_u32 s81, s81, 0x8000
v_exp_f32 v137, v137
v_mfma_f32_16x16x32_bf16 v[168:171], a[172:175], v[60:63], v[168:171]
s_add_u32 m0, s74, 16384
ds_read_b128 a[132:135], v2 offset:17408
v_cvt_pk_bf16_f32 v200, v136, v137
v_mfma_f32_16x16x32_bf16 v[172:175], a[172:175], v[76:79], v[92:95]
s_add_u32 s72, s81, 16384
v_exp_f32 v138, v138
v_mfma_f32_16x16x32_bf16 v[172:175], a[168:171], v[72:75], v[172:175]
ds_read_b128 a[136:139], v2 offset:18432
v_lshl_add_u32 v5, v241, 3, v5
v_mfma_f32_16x16x32_bf16 v[172:175], a[164:167], v[68:71], v[172:175]
buffer_load_dwordx4 v1, s[44:47], s72 offen sc1 lds
v_mfma_f32_16x16x32_bf16 v[172:175], a[160:163], v[64:67], v[172:175]
v_exp_f32 v139, v139
v_mfma_f32_16x16x32_bf16 v[188:191], a[176:179], v[64:67], v[92:95]
ds_read_b128 a[140:143], v2 offset:19456
v_cvt_pk_bf16_f32 v201, v138, v139
v_mfma_f32_16x16x32_bf16 v[188:191], a[180:183], v[68:71], v[188:191]
v_exp_f32 v152, v152
v_mfma_f32_16x16x32_bf16 v[188:191], a[184:187], v[72:75], v[188:191]
ds_read_b128 a[144:147], v2 offset:20480
v_cndmask_b32 v8, 0, v249, vcc
v_mfma_f32_16x16x32_bf16 v[188:191], a[188:191], v[76:79], v[188:191]
v_exp_f32 v153, v153
v_mfma_f32_16x16x32_bf16 v[184:187], a[188:191], v[60:63], v[88:91]
ds_read_b128 a[148:151], v2 offset:21504
v_cvt_pk_bf16_f32 v202, v152, v153
v_mfma_f32_16x16x32_bf16 v[184:187], a[184:187], v[56:59], v[184:187]
v_exp_f32 v154, v154
v_mfma_f32_16x16x32_bf16 v[184:187], a[180:183], v[52:55], v[184:187]
ds_read_b128 a[152:155], v2 offset:22528
v_cmp_eq_u32 vcc, 1, v248
v_mfma_f32_16x16x32_bf16 v[184:187], a[176:179], v[48:51], v[184:187]
s_waitcnt lgkmcnt(7)
buffer_load_dwordx4 v1, s[44:47], s72 offen offset:1024 sc1 lds
v_mfma_f32_16x16x32_bf16 a[32:35], a[224:227], v[212:215], a[32:35]
v_exp_f32 v155, v155
v_mfma_f32_16x16x32_bf16 a[64:67], a[224:227], v[216:219], a[64:67]
ds_read_b128 a[156:159], v2 offset:23552
v_cvt_pk_bf16_f32 v203, v154, v155
v_mfma_f32_16x16x32_bf16 a[96:99], a[224:227], v[220:223], a[96:99]
v_exp_f32 v140, v140
v_mfma_f32_16x16x32_bf16 a[100:103], a[228:231], v[220:223], a[100:103]
ds_read_b128 a[192:195], v2 offset:0
v_lshlrev_b32 v240, 4, v251
v_mfma_f32_16x16x32_bf16 a[68:71], a[228:231], v[216:219], a[68:71]
v_exp_f32 v141, v141
v_mfma_f32_16x16x32_bf16 a[36:39], a[228:231], v[212:215], a[36:39]
ds_read_b128 a[196:199], v2 offset:1024
v_cvt_pk_bf16_f32 v204, v140, v141
v_mfma_f32_16x16x32_bf16 a[40:43], a[232:235], v[212:215], a[40:43]
v_exp_f32 v142, v142
v_mfma_f32_16x16x32_bf16 a[72:75], a[232:235], v[216:219], a[72:75]
ds_read_b128 a[200:203], v2 offset:2048
v_cndmask_b32 v9, 0, v249, vcc
v_mfma_f32_16x16x32_bf16 a[104:107], a[232:235], v[220:223], a[104:107]
buffer_load_dwordx4 v1, s[44:47], s72 offen offset:2048 sc1 lds
v_mfma_f32_16x16x32_bf16 a[108:111], a[236:239], v[220:223], a[108:111]
v_exp_f32 v143, v143
v_mfma_f32_16x16x32_bf16 a[76:79], a[236:239], v[216:219], a[76:79]
ds_read_b128 a[204:207], v2 offset:3072
v_cvt_pk_bf16_f32 v205, v142, v143
v_mfma_f32_16x16x32_bf16 a[44:47], a[236:239], v[212:215], a[44:47]
v_exp_f32 v156, v156
v_mfma_f32_16x16x32_bf16 a[48:51], a[240:243], v[212:215], a[48:51]
ds_read_b128 a[208:211], v2 offset:4096
v_cmp_eq_u32 vcc, 2, v248
v_mfma_f32_16x16x32_bf16 a[80:83], a[240:243], v[216:219], a[80:83]
v_exp_f32 v157, v157
v_mfma_f32_16x16x32_bf16 a[112:115], a[240:243], v[220:223], a[112:115]
ds_read_b128 a[212:215], v2 offset:5120
v_cvt_pk_bf16_f32 v206, v156, v157
v_mfma_f32_16x16x32_bf16 a[116:119], a[244:247], v[220:223], a[116:119]
v_exp_f32 v158, v158
v_mfma_f32_16x16x32_bf16 a[84:87], a[244:247], v[216:219], a[84:87]
ds_read_b128 a[216:219], v2 offset:6144
v_sub_u32 v240, 48, v240
v_mfma_f32_16x16x32_bf16 a[52:55], a[244:247], v[212:215], a[52:55]
buffer_load_dwordx4 v1, s[44:47], s72 offen offset:3072 sc1 lds
v_mfma_f32_16x16x32_bf16 a[56:59], a[248:251], v[212:215], a[56:59]
v_exp_f32 v159, v159
v_mfma_f32_16x16x32_bf16 a[88:91], a[248:251], v[216:219], a[88:91]
ds_read_b128 a[220:223], v2 offset:7168
v_cvt_pk_bf16_f32 v207, v158, v159
v_mfma_f32_16x16x32_bf16 a[120:123], a[248:251], v[220:223], a[120:123]
v_lshlrev_b64 v[12:13], 16, s[88:89]
v_cndmask_b32 v10, 0, v249, vcc
v_mfma_f32_16x16x32_bf16 a[124:127], a[252:255], v[220:223], a[124:127]
v_cmp_eq_u32 vcc, 3, v248
v_lshlrev_b64 v[12:13], v240, v[12:13]
v_mfma_f32_16x16x32_bf16 a[92:95], a[252:255], v[216:219], a[92:95]
v_cndmask_b32 v11, 0, v249, vcc
v_cmp_eq_u32 vcc, 3, v241
v_mfma_f32_16x16x32_bf16 a[60:63], a[252:255], v[212:215], a[60:63]
s_add_u32 s73, s62, 4096
v_lshl_add_u32 v14, v0, 3, s73
v_cndmask_b32 v12, 0, v12, vcc
v_mfma_f32_16x16x32_bf16 v[228:231], v[120:123], v[212:215], v[228:231]
v_cndmask_b32 v13, 0, v13, vcc
v_lshrrev_b32 v15, 4, v0
v_mfma_f32_16x16x32_bf16 v[232:235], v[120:123], v[216:219], v[232:235]
v_lshlrev_b32 v15, 1, v15
v_and_b32 v240, 7, v0
v_mfma_f32_16x16x32_bf16 v[236:239], v[120:123], v[220:223], v[236:239]
s_waitcnt lgkmcnt(8)
v_xor_b32 v15, v15, v240
v_lshlrev_b32 v15, 4, v15
v_lshrrev_b32 v240, 3, v0
v_lshl_add_u32 v15, v240, 11, v15
s_and_b32 s75, s59, 8
s_add_u32 s75, s75, s60
s_lshr_b32 s76, s59, 4
s_lshl_b32 s76, s76, 2
s_add_u32 s76, s76, s65
s_lshl_b32 s76, s76, 1
s_lshr_b32 s80, s59, 2
s_and_b32 s80, s80, 1
s_add_u32 s76, s76, s80
s_lshl_b32 s94, s58, 16
s_lshl_b32 s80, s76, 7
s_add_u32 s94, s94, s80
s_lshl_b32 s80, s75, 18
s_add_u32 s80, s80, s94
v_rcp_f32 v224, v224
v_rcp_f32 v228, v228
s_lshl_b32 s73, s59, 12
s_add_u32 s73, s73, 0x2000000
s_lshl_b32 s70, s67, 2
s_add_u32 s70, s70, s73
v_mov_b32 v225, v224
v_accvgpr_read_b32 v240, a0
v_accvgpr_read_b32 v241, a1
v_accvgpr_read_b32 v242, a2
v_accvgpr_read_b32 v243, a3
v_accvgpr_read_b32 v244, a4
v_accvgpr_read_b32 v245, a5
v_accvgpr_read_b32 v246, a6
v_accvgpr_read_b32 v247, a7
v_pk_mul_f32 v[240:241], v[240:241], v[224:225]
v_pk_mul_f32 v[242:243], v[242:243], v[224:225]
v_pk_mul_f32 v[244:245], v[244:245], v[224:225]
v_pk_mul_f32 v[246:247], v[246:247], v[224:225]
v_cvt_pk_bf16_f32 v128, v240, v241
v_cvt_pk_bf16_f32 v129, v242, v243
v_cvt_pk_bf16_f32 v130, v244, v245
v_cvt_pk_bf16_f32 v131, v246, v247
v_accvgpr_read_b32 v248, a8
v_accvgpr_read_b32 v249, a9
v_accvgpr_read_b32 v250, a10
v_accvgpr_read_b32 v251, a11
v_accvgpr_read_b32 v252, a12
v_accvgpr_read_b32 v253, a13
v_accvgpr_read_b32 v254, a14
v_accvgpr_read_b32 v255, a15
v_pk_mul_f32 v[248:249], v[248:249], v[224:225]
v_pk_mul_f32 v[250:251], v[250:251], v[224:225]
v_pk_mul_f32 v[252:253], v[252:253], v[224:225]
v_pk_mul_f32 v[254:255], v[254:255], v[224:225]
v_cvt_pk_bf16_f32 v144, v248, v249
v_cvt_pk_bf16_f32 v145, v250, v251
v_cvt_pk_bf16_f32 v146, v252, v253
v_cvt_pk_bf16_f32 v147, v254, v255
v_accvgpr_read_b32 v240, a16
v_accvgpr_read_b32 v241, a17
v_accvgpr_read_b32 v242, a18
v_accvgpr_read_b32 v243, a19
v_accvgpr_read_b32 v244, a20
v_accvgpr_read_b32 v245, a21
v_accvgpr_read_b32 v246, a22
v_accvgpr_read_b32 v247, a23
v_pk_mul_f32 v[240:241], v[240:241], v[224:225]
v_pk_mul_f32 v[242:243], v[242:243], v[224:225]
v_pk_mul_f32 v[244:245], v[244:245], v[224:225]
v_pk_mul_f32 v[246:247], v[246:247], v[224:225]
v_cvt_pk_bf16_f32 v160, v240, v241
v_cvt_pk_bf16_f32 v161, v242, v243
v_cvt_pk_bf16_f32 v162, v244, v245
v_cvt_pk_bf16_f32 v163, v246, v247
v_accvgpr_read_b32 v248, a24
v_accvgpr_read_b32 v249, a25
v_accvgpr_read_b32 v250, a26
v_accvgpr_read_b32 v251, a27
v_accvgpr_read_b32 v252, a28
v_accvgpr_read_b32 v253, a29
v_accvgpr_read_b32 v254, a30
v_accvgpr_read_b32 v255, a31
v_pk_mul_f32 v[248:249], v[248:249], v[224:225]
v_pk_mul_f32 v[250:251], v[250:251], v[224:225]
v_pk_mul_f32 v[252:253], v[252:253], v[224:225]
v_pk_mul_f32 v[254:255], v[254:255], v[224:225]
v_cvt_pk_bf16_f32 v176, v248, v249
v_cvt_pk_bf16_f32 v177, v250, v251
v_cvt_pk_bf16_f32 v178, v252, v253
v_cvt_pk_bf16_f32 v179, v254, v255
v_mov_b32 v229, v228
v_accvgpr_read_b32 v240, a32
v_accvgpr_read_b32 v241, a33
v_accvgpr_read_b32 v242, a34
v_accvgpr_read_b32 v243, a35
v_accvgpr_read_b32 v244, a36
v_accvgpr_read_b32 v245, a37
v_accvgpr_read_b32 v246, a38
v_accvgpr_read_b32 v247, a39
v_pk_mul_f32 v[240:241], v[240:241], v[228:229]
v_pk_mul_f32 v[242:243], v[242:243], v[228:229]
v_pk_mul_f32 v[244:245], v[244:245], v[228:229]
v_pk_mul_f32 v[246:247], v[246:247], v[228:229]
v_cvt_pk_bf16_f32 v132, v240, v241
v_cvt_pk_bf16_f32 v133, v242, v243
v_cvt_pk_bf16_f32 v134, v244, v245
v_cvt_pk_bf16_f32 v135, v246, v247
v_accvgpr_read_b32 v248, a40
v_accvgpr_read_b32 v249, a41
v_accvgpr_read_b32 v250, a42
v_accvgpr_read_b32 v251, a43
v_accvgpr_read_b32 v252, a44
v_accvgpr_read_b32 v253, a45
v_accvgpr_read_b32 v254, a46
v_accvgpr_read_b32 v255, a47
v_pk_mul_f32 v[248:249], v[248:249], v[228:229]
v_pk_mul_f32 v[250:251], v[250:251], v[228:229]
v_pk_mul_f32 v[252:253], v[252:253], v[228:229]
v_pk_mul_f32 v[254:255], v[254:255], v[228:229]
v_cvt_pk_bf16_f32 v148, v248, v249
v_cvt_pk_bf16_f32 v149, v250, v251
v_cvt_pk_bf16_f32 v150, v252, v253
v_cvt_pk_bf16_f32 v151, v254, v255
v_accvgpr_read_b32 v240, a48
v_accvgpr_read_b32 v241, a49
v_accvgpr_read_b32 v242, a50
v_accvgpr_read_b32 v243, a51
v_accvgpr_read_b32 v244, a52
v_accvgpr_read_b32 v245, a53
v_accvgpr_read_b32 v246, a54
v_accvgpr_read_b32 v247, a55
v_pk_mul_f32 v[240:241], v[240:241], v[228:229]
v_pk_mul_f32 v[242:243], v[242:243], v[228:229]
v_pk_mul_f32 v[244:245], v[244:245], v[228:229]
v_pk_mul_f32 v[246:247], v[246:247], v[228:229]
v_cvt_pk_bf16_f32 v164, v240, v241
v_cvt_pk_bf16_f32 v165, v242, v243
v_cvt_pk_bf16_f32 v166, v244, v245
v_cvt_pk_bf16_f32 v167, v246, v247
v_accvgpr_read_b32 v248, a56
v_accvgpr_read_b32 v249, a57
v_accvgpr_read_b32 v250, a58
v_accvgpr_read_b32 v251, a59
v_accvgpr_read_b32 v252, a60
v_accvgpr_read_b32 v253, a61
v_accvgpr_read_b32 v254, a62
v_accvgpr_read_b32 v255, a63
v_pk_mul_f32 v[248:249], v[248:249], v[228:229]
v_pk_mul_f32 v[250:251], v[250:251], v[228:229]
v_pk_mul_f32 v[252:253], v[252:253], v[228:229]
v_pk_mul_f32 v[254:255], v[254:255], v[228:229]
v_cvt_pk_bf16_f32 v180, v248, v249
v_cvt_pk_bf16_f32 v181, v250, v251
v_cvt_pk_bf16_f32 v182, v252, v253
v_cvt_pk_bf16_f32 v183, v254, v255
v_mfma_f32_16x16x32_bf16 v[136:139], a[128:131], v[48:51], v[88:91]
s_add_u32 s82, s82, 0x8000
ds_read_b128 a[160:163], v2 offset:24576
ds_read_b128 a[164:167], v2 offset:25600
v_mfma_f32_16x16x32_bf16 v[136:139], a[132:135], v[52:55], v[136:139]
s_and_b32 s82, s82, 0x1ffff
v_exp_f32 v168, v168
v_mfma_f32_16x16x32_bf16 v[136:139], a[136:139], v[56:59], v[136:139]
s_add_u32 m0, s74, 0
v_exp_f32 v169, v169
v_mfma_f32_16x16x32_bf16 v[136:139], a[140:143], v[60:63], v[136:139]
s_add_u32 s72, s81, 0
buffer_load_dwordx4 v1, s[44:47], s72 offen sc1 lds
v_mfma_f32_16x16x32_bf16 v[140:143], a[140:143], v[76:79], v[92:95]
ds_read_b128 a[168:171], v2 offset:26624
v_cvt_pk_bf16_f32 v216, v168, v169
v_mfma_f32_16x16x32_bf16 v[140:143], a[136:139], v[72:75], v[140:143]
v_exp_f32 v170, v170
v_mfma_f32_16x16x32_bf16 v[140:143], a[132:135], v[68:71], v[140:143]
ds_read_b128 a[172:175], v2 offset:27648
ds_read_b128 a[176:179], v2 offset:28672
v_mfma_f32_16x16x32_bf16 v[140:143], a[128:131], v[64:67], v[140:143]
v_exp_f32 v171, v171
v_mfma_f32_16x16x32_bf16 v[156:159], a[144:147], v[64:67], v[92:95]
v_exp_f32 v184, v184
v_mfma_f32_16x16x32_bf16 v[156:159], a[148:151], v[68:71], v[156:159]
buffer_store_dwordx4 v[128:131], v1, s[44:47], s70 offen sc1
v_mfma_f32_16x16x32_bf16 v[156:159], a[152:155], v[72:75], v[156:159]
ds_read_b128 a[180:183], v2 offset:29696
v_cvt_pk_bf16_f32 v217, v170, v171
v_mfma_f32_16x16x32_bf16 v[156:159], a[156:159], v[76:79], v[156:159]
v_exp_f32 v185, v185
v_mfma_f32_16x16x32_bf16 v[152:155], a[156:159], v[60:63], v[88:91]
ds_read_b128 a[184:187], v2 offset:30720
v_cvt_pk_bf16_f32 v218, v184, v185
v_mfma_f32_16x16x32_bf16 v[152:155], a[152:155], v[56:59], v[152:155]
v_exp_f32 v186, v186
v_mfma_f32_16x16x32_bf16 v[152:155], a[148:151], v[52:55], v[152:155]
buffer_load_dwordx4 v1, s[44:47], s72 offen offset:1024 sc1 lds
v_mfma_f32_16x16x32_bf16 v[152:155], a[144:147], v[48:51], v[152:155]
s_waitcnt lgkmcnt(7)
ds_read_b128 a[188:191], v2 offset:31744
ds_read_b128 a[224:227], v2 offset:8192
v_mfma_f32_16x16x32_bf16 a[64:67], a[192:195], v[200:203], a[64:67]
v_exp_f32 v187, v187
v_mfma_f32_16x16x32_bf16 a[96:99], a[192:195], v[204:207], a[96:99]
v_exp_f32 v172, v172
v_mfma_f32_16x16x32_bf16 a[100:103], a[196:199], v[204:207], a[100:103]
ds_read_b128 a[228:231], v2 offset:9216
v_cvt_pk_bf16_f32 v219, v186, v187
v_mfma_f32_16x16x32_bf16 a[68:71], a[196:199], v[200:203], a[68:71]
v_exp_f32 v173, v173
v_mfma_f32_16x16x32_bf16 a[72:75], a[200:203], v[200:203], a[72:75]
buffer_store_dwordx4 v[144:147], v1, s[44:47], s70 offen offset:1024 sc1
v_mfma_f32_16x16x32_bf16 a[104:107], a[200:203], v[204:207], a[104:107]
ds_read_b128 a[232:235], v2 offset:10240
v_cvt_pk_bf16_f32 v220, v172, v173
v_mfma_f32_16x16x32_bf16 a[108:111], a[204:207], v[204:207], a[108:111]
v_exp_f32 v174, v174
v_mfma_f32_16x16x32_bf16 a[76:79], a[204:207], v[200:203], a[76:79]
ds_read_b128 a[236:239], v2 offset:11264
ds_read_b128 a[240:243], v2 offset:12288
v_mfma_f32_16x16x32_bf16 a[80:83], a[208:211], v[200:203], a[80:83]
v_exp_f32 v175, v175
v_mfma_f32_16x16x32_bf16 a[112:115], a[208:211], v[204:207], a[112:115]
buffer_load_dwordx4 v1, s[44:47], s72 offen offset:2048 sc1 lds
v_mfma_f32_16x16x32_bf16 a[116:119], a[212:215], v[204:207], a[116:119]
v_exp_f32 v188, v188
v_mfma_f32_16x16x32_bf16 a[84:87], a[212:215], v[200:203], a[84:87]
ds_read_b128 a[244:247], v2 offset:13312
v_cvt_pk_bf16_f32 v221, v174, v175
v_mfma_f32_16x16x32_bf16 a[88:91], a[216:219], v[200:203], a[88:91]
v_exp_f32 v189, v189
v_mfma_f32_16x16x32_bf16 a[120:123], a[216:219], v[204:207], a[120:123]
ds_read_b128 a[248:251], v2 offset:14336
ds_read_b128 a[252:255], v2 offset:15360
v_mfma_f32_16x16x32_bf16 a[124:127], a[220:223], v[204:207], a[124:127]
v_exp_f32 v190, v190
v_mfma_f32_16x16x32_bf16 a[92:95], a[220:223], v[200:203], a[92:95]
buffer_load_dwordx4 v1, s[44:47], s72 offen offset:3072 sc1 lds
v_mfma_f32_16x16x32_bf16 v[232:235], v[120:123], v[200:203], v[232:235]
s_waitcnt vmcnt(10) lgkmcnt(8)
v_exp_f32 v191, v191
v_mfma_f32_16x16x32_bf16 v[236:239], v[120:123], v[204:207], v[236:239]
s_barrier
v_cvt_pk_bf16_f32 v222, v188, v189
v_cvt_pk_bf16_f32 v223, v190, v191
v_add_u32 v2, s82, v1
v_mfma_f32_16x16x32_bf16 v[168:171], a[160:163], v[48:51], v[88:91]
s_xor_b32 s74, s82, 0x10000
v_exp_f32 v136, v136
v_mfma_f32_16x16x32_bf16 v[168:171], a[164:167], v[52:55], v[168:171]
s_add_u32 s74, s74, s64
ds_read_b128 a[128:131], v2 offset:16384
ds_read_b128 a[132:135], v2 offset:17408
v_mfma_f32_16x16x32_bf16 v[168:171], a[168:171], v[56:59], v[168:171]
s_add_u32 s81, s81, 0x8000
v_exp_f32 v137, v137
v_mfma_f32_16x16x32_bf16 v[168:171], a[172:175], v[60:63], v[168:171]
s_add_u32 m0, s74, 16384
v_exp_f32 v138, v138
v_mfma_f32_16x16x32_bf16 v[172:175], a[172:175], v[76:79], v[92:95]
s_add_u32 s72, s81, 16384
buffer_load_dwordx4 v1, s[44:47], s72 offen sc1 lds
v_mfma_f32_16x16x32_bf16 v[172:175], a[168:171], v[72:75], v[172:175]
Lstub5:
s_cbranch_execz Lstub9
ds_read_b128 a[136:139], v2 offset:18432
v_cvt_pk_bf16_f32 v200, v136, v137
v_mfma_f32_16x16x32_bf16 v[172:175], a[164:167], v[68:71], v[172:175]
v_exp_f32 v139, v139
v_mfma_f32_16x16x32_bf16 v[172:175], a[160:163], v[64:67], v[172:175]
ds_read_b128 a[140:143], v2 offset:19456
v_cvt_pk_bf16_f32 v201, v138, v139
v_mfma_f32_16x16x32_bf16 v[188:191], a[176:179], v[64:67], v[92:95]
buffer_store_dwordx4 v[160:163], v1, s[44:47], s70 offen offset:2048 sc1
v_mfma_f32_16x16x32_bf16 v[188:191], a[180:183], v[68:71], v[188:191]
v_exp_f32 v152, v152
v_mfma_f32_16x16x32_bf16 v[188:191], a[184:187], v[72:75], v[188:191]
ds_read_b128 a[144:147], v2 offset:20480
ds_read_b128 a[148:151], v2 offset:21504
v_mfma_f32_16x16x32_bf16 v[188:191], a[188:191], v[76:79], v[188:191]
v_exp_f32 v153, v153
v_mfma_f32_16x16x32_bf16 v[184:187], a[188:191], v[60:63], v[88:91]
buffer_load_dwordx4 v1, s[44:47], s72 offen offset:1024 sc1 lds
v_mfma_f32_16x16x32_bf16 v[184:187], a[184:187], v[56:59], v[184:187]
v_exp_f32 v154, v154
v_mfma_f32_16x16x32_bf16 v[184:187], a[180:183], v[52:55], v[184:187]
ds_read_b128 a[152:155], v2 offset:22528
v_cvt_pk_bf16_f32 v202, v152, v153
v_mfma_f32_16x16x32_bf16 v[184:187], a[176:179], v[48:51], v[184:187]
s_waitcnt lgkmcnt(7)
v_exp_f32 v155, v155
v_mfma_f32_16x16x32_bf16 a[64:67], a[224:227], v[216:219], a[64:67]
ds_read_b128 a[156:159], v2 offset:23552
v_cvt_pk_bf16_f32 v203, v154, v155
v_mfma_f32_16x16x32_bf16 a[96:99], a[224:227], v[220:223], a[96:99]
v_exp_f32 v140, v140
v_mfma_f32_16x16x32_bf16 a[100:103], a[228:231], v[220:223], a[100:103]
ds_read_b128 a[192:195], v2 offset:0
ds_read_b128 a[196:199], v2 offset:1024
v_mfma_f32_16x16x32_bf16 a[68:71], a[228:231], v[216:219], a[68:71]
buffer_store_dwordx4 v[176:179], v1, s[44:47], s70 offen offset:3072 sc1
v_mfma_f32_16x16x32_bf16 a[72:75], a[232:235], v[216:219], a[72:75]
v_exp_f32 v141, v141
v_mfma_f32_16x16x32_bf16 a[104:107], a[232:235], v[220:223], a[104:107]
v_exp_f32 v142, v142
v_mfma_f32_16x16x32_bf16 a[108:111], a[236:239], v[220:223], a[108:111]
ds_read_b128 a[200:203], v2 offset:2048
ds_read_b128 a[204:207], v2 offset:3072
v_mfma_f32_16x16x32_bf16 a[76:79], a[236:239], v[216:219], a[76:79]
buffer_load_dwordx4 v1, s[44:47], s72 offen offset:2048 sc1 lds
v_mfma_f32_16x16x32_bf16 a[80:83], a[240:243], v[216:219], a[80:83]
s_add_u32 s70, s70, 0x80000
v_exp_f32 v143, v143
v_mfma_f32_16x16x32_bf16 a[112:115], a[240:243], v[220:223], a[112:115]
v_exp_f32 v156, v156
v_mfma_f32_16x16x32_bf16 a[116:119], a[244:247], v[220:223], a[116:119]
ds_read_b128 a[208:211], v2 offset:4096
ds_read_b128 a[212:215], v2 offset:5120
v_mfma_f32_16x16x32_bf16 a[84:87], a[244:247], v[216:219], a[84:87]
ds_read_b128 a[216:219], v2 offset:6144
ds_read_b128 a[220:223], v2 offset:7168
v_mfma_f32_16x16x32_bf16 a[88:91], a[248:251], v[216:219], a[88:91]
v_cvt_pk_bf16_f32 v204, v140, v141
v_cvt_pk_bf16_f32 v205, v142, v143
v_mfma_f32_16x16x32_bf16 a[120:123], a[248:251], v[220:223], a[120:123]
buffer_store_dwordx4 v[132:135], v1, s[44:47], s70 offen sc1
v_mfma_f32_16x16x32_bf16 a[124:127], a[252:255], v[220:223], a[124:127]
v_exp_f32 v157, v157
v_mfma_f32_16x16x32_bf16 a[92:95], a[252:255], v[216:219], a[92:95]
v_exp_f32 v158, v158
v_mfma_f32_16x16x32_bf16 v[232:235], v[120:123], v[216:219], v[232:235]
buffer_load_dwordx4 v1, s[44:47], s72 offen offset:3072 sc1 lds
v_mfma_f32_16x16x32_bf16 v[236:239], v[120:123], v[220:223], v[236:239]
s_waitcnt lgkmcnt(8)
v_exp_f32 v159, v159
v_cvt_pk_bf16_f32 v206, v156, v157
v_cvt_pk_bf16_f32 v207, v158, v159
v_mfma_f32_16x16x32_bf16 v[136:139], a[128:131], v[48:51], v[88:91]
s_add_u32 s82, s82, 0x8000
ds_read_b128 a[160:163], v2 offset:24576
ds_read_b128 a[164:167], v2 offset:25600
v_mfma_f32_16x16x32_bf16 v[136:139], a[132:135], v[52:55], v[136:139]
s_and_b32 s82, s82, 0x1ffff
v_exp_f32 v168, v168
v_mfma_f32_16x16x32_bf16 v[136:139], a[136:139], v[56:59], v[136:139]
s_add_u32 m0, s74, 0
v_exp_f32 v169, v169
v_mfma_f32_16x16x32_bf16 v[136:139], a[140:143], v[60:63], v[136:139]
s_add_u32 s72, s81, 0
buffer_load_dwordx4 v1, s[44:47], s72 offen sc1 lds
v_mfma_f32_16x16x32_bf16 v[140:143], a[140:143], v[76:79], v[92:95]
ds_read_b128 a[168:171], v2 offset:26624
v_cvt_pk_bf16_f32 v216, v168, v169
v_mfma_f32_16x16x32_bf16 v[140:143], a[136:139], v[72:75], v[140:143]
v_exp_f32 v170, v170
v_mfma_f32_16x16x32_bf16 v[140:143], a[132:135], v[68:71], v[140:143]
ds_read_b128 a[172:175], v2 offset:27648
ds_read_b128 a[176:179], v2 offset:28672
v_mfma_f32_16x16x32_bf16 v[140:143], a[128:131], v[64:67], v[140:143]
v_exp_f32 v171, v171
v_mfma_f32_16x16x32_bf16 v[156:159], a[144:147], v[64:67], v[92:95]
buffer_store_dwordx4 v[148:151], v1, s[44:47], s70 offen offset:1024 sc1
v_mfma_f32_16x16x32_bf16 v[156:159], a[148:151], v[68:71], v[156:159]
v_exp_f32 v184, v184
v_mfma_f32_16x16x32_bf16 v[156:159], a[152:155], v[72:75], v[156:159]
ds_read_b128 a[180:183], v2 offset:29696
v_cvt_pk_bf16_f32 v217, v170, v171
v_mfma_f32_16x16x32_bf16 v[156:159], a[156:159], v[76:79], v[156:159]
v_exp_f32 v185, v185
v_mfma_f32_16x16x32_bf16 v[152:155], a[156:159], v[60:63], v[88:91]
buffer_load_dwordx4 v1, s[44:47], s72 offen offset:1024 sc1 lds
v_mfma_f32_16x16x32_bf16 v[152:155], a[152:155], v[56:59], v[152:155]
ds_read_b128 a[184:187], v2 offset:30720
v_cvt_pk_bf16_f32 v218, v184, v185
v_mfma_f32_16x16x32_bf16 v[152:155], a[148:151], v[52:55], v[152:155]
v_exp_f32 v186, v186
v_mfma_f32_16x16x32_bf16 v[152:155], a[144:147], v[48:51], v[152:155]
s_waitcnt lgkmcnt(7)
ds_read_b128 a[188:191], v2 offset:31744
ds_read_b128 a[224:227], v2 offset:8192
v_mfma_f32_16x16x32_bf16 a[64:67], a[192:195], v[200:203], a[64:67]
v_exp_f32 v187, v187
v_mfma_f32_16x16x32_bf16 a[96:99], a[192:195], v[204:207], a[96:99]
buffer_store_dwordx4 v[164:167], v1, s[44:47], s70 offen offset:2048 sc1
v_mfma_f32_16x16x32_bf16 a[100:103], a[196:199], v[204:207], a[100:103]
v_exp_f32 v172, v172
v_mfma_f32_16x16x32_bf16 a[68:71], a[196:199], v[200:203], a[68:71]
ds_read_b128 a[228:231], v2 offset:9216
v_cvt_pk_bf16_f32 v219, v186, v187
v_mfma_f32_16x16x32_bf16 a[72:75], a[200:203], v[200:203], a[72:75]
v_exp_f32 v173, v173
v_mfma_f32_16x16x32_bf16 a[104:107], a[200:203], v[204:207], a[104:107]
ds_read_b128 a[232:235], v2 offset:10240
ds_read_b128 a[236:239], v2 offset:11264
v_mfma_f32_16x16x32_bf16 a[108:111], a[204:207], v[204:207], a[108:111]
v_exp_f32 v174, v174
v_mfma_f32_16x16x32_bf16 a[76:79], a[204:207], v[200:203], a[76:79]
buffer_load_dwordx4 v1, s[44:47], s72 offen offset:2048 sc1 lds
v_mfma_f32_16x16x32_bf16 a[80:83], a[208:211], v[200:203], a[80:83]
v_exp_f32 v175, v175
v_mfma_f32_16x16x32_bf16 a[112:115], a[208:211], v[204:207], a[112:115]
ds_read_b128 a[240:243], v2 offset:12288
ds_read_b128 a[244:247], v2 offset:13312
v_mfma_f32_16x16x32_bf16 a[116:119], a[212:215], v[204:207], a[116:119]
v_exp_f32 v188, v188
v_mfma_f32_16x16x32_bf16 a[84:87], a[212:215], v[200:203], a[84:87]
ds_read_b128 a[248:251], v2 offset:14336
ds_read_b128 a[252:255], v2 offset:15360
v_mfma_f32_16x16x32_bf16 a[88:91], a[216:219], v[200:203], a[88:91]
v_cvt_pk_bf16_f32 v220, v172, v173
v_cvt_pk_bf16_f32 v221, v174, v175
v_mfma_f32_16x16x32_bf16 a[120:123], a[216:219], v[204:207], a[120:123]
buffer_store_dwordx4 v[180:183], v1, s[44:47], s70 offen offset:3072 sc1
v_mfma_f32_16x16x32_bf16 a[124:127], a[220:223], v[204:207], a[124:127]
v_exp_f32 v189, v189
v_mfma_f32_16x16x32_bf16 a[92:95], a[220:223], v[200:203], a[92:95]
buffer_load_dwordx4 v1, s[44:47], s72 offen offset:3072 sc1 lds
v_mfma_f32_16x16x32_bf16 v[232:235], v[120:123], v[200:203], v[232:235]
s_waitcnt vmcnt(14) lgkmcnt(8)
v_exp_f32 v190, v190
v_mfma_f32_16x16x32_bf16 v[236:239], v[120:123], v[204:207], v[236:239]
s_barrier
v_exp_f32 v191, v191
v_add_u32 v2, s82, v1
v_cvt_pk_bf16_f32 v222, v188, v189
v_cvt_pk_bf16_f32 v223, v190, v191
s_lshl_b32 s83, s60, 2
s_sub_u32 s83, s83, 25
.p2align 5
s_nop 0
s_nop 0
LloopII:
v_mfma_f32_16x16x32_bf16 v[168:171], a[160:163], v[48:51], v[88:91]
s_xor_b32 s74, s82, 0x10000
v_exp_f32 v136, v136
v_mfma_f32_16x16x32_bf16 v[168:171], a[164:167], v[52:55], v[168:171]
s_add_u32 s74, s74, s64
ds_read_b128 a[128:131], v2 offset:16384
ds_read_b128 a[132:135], v2 offset:17408
v_mfma_f32_16x16x32_bf16 v[168:171], a[168:171], v[56:59], v[168:171]
s_add_u32 s81, s81, 0x8000
v_exp_f32 v137, v137
v_mfma_f32_16x16x32_bf16 v[168:171], a[172:175], v[60:63], v[168:171]
s_add_u32 m0, s74, 16384
v_exp_f32 v138, v138
v_mfma_f32_16x16x32_bf16 v[172:175], a[172:175], v[76:79], v[92:95]
s_add_u32 s72, s81, 16384
ds_read_b128 a[136:139], v2 offset:18432
v_cvt_pk_bf16_f32 v200, v136, v137
v_mfma_f32_16x16x32_bf16 v[172:175], a[168:171], v[72:75], v[172:175]
buffer_load_dwordx4 v1, s[44:47], s72 offen sc1 lds
v_mfma_f32_16x16x32_bf16 v[172:175], a[164:167], v[68:71], v[172:175]
v_exp_f32 v139, v139
v_mfma_f32_16x16x32_bf16 v[172:175], a[160:163], v[64:67], v[172:175]
ds_read_b128 a[140:143], v2 offset:19456
v_cvt_pk_bf16_f32 v201, v138, v139
v_mfma_f32_16x16x32_bf16 v[188:191], a[176:179], v[64:67], v[92:95]
v_exp_f32 v152, v152
v_mfma_f32_16x16x32_bf16 v[188:191], a[180:183], v[68:71], v[188:191]
ds_read_b128 a[144:147], v2 offset:20480
ds_read_b128 a[148:151], v2 offset:21504
v_mfma_f32_16x16x32_bf16 v[188:191], a[184:187], v[72:75], v[188:191]
v_exp_f32 v153, v153
v_mfma_f32_16x16x32_bf16 v[188:191], a[188:191], v[76:79], v[188:191]
v_exp_f32 v154, v154
v_mfma_f32_16x16x32_bf16 v[184:187], a[188:191], v[60:63], v[88:91]
ds_read_b128 a[152:155], v2 offset:22528
v_cvt_pk_bf16_f32 v202, v152, v153
v_mfma_f32_16x16x32_bf16 v[184:187], a[184:187], v[56:59], v[184:187]
buffer_load_dwordx4 v1, s[44:47], s72 offen offset:1024 sc1 lds
v_mfma_f32_16x16x32_bf16 v[184:187], a[180:183], v[52:55], v[184:187]
v_exp_f32 v155, v155
v_mfma_f32_16x16x32_bf16 v[184:187], a[176:179], v[48:51], v[184:187]
s_waitcnt lgkmcnt(7)
ds_read_b128 a[156:159], v2 offset:23552
v_cvt_pk_bf16_f32 v203, v154, v155
v_mfma_f32_16x16x32_bf16 a[64:67], a[224:227], v[216:219], a[64:67]
v_exp_f32 v140, v140
v_mfma_f32_16x16x32_bf16 a[96:99], a[224:227], v[220:223], a[96:99]
ds_read_b128 a[192:195], v2 offset:0
ds_read_b128 a[196:199], v2 offset:1024
v_mfma_f32_16x16x32_bf16 a[100:103], a[228:231], v[220:223], a[100:103]
v_exp_f32 v141, v141
v_mfma_f32_16x16x32_bf16 a[68:71], a[228:231], v[216:219], a[68:71]
v_exp_f32 v142, v142
v_mfma_f32_16x16x32_bf16 a[72:75], a[232:235], v[216:219], a[72:75]
ds_read_b128 a[200:203], v2 offset:2048
v_cvt_pk_bf16_f32 v204, v140, v141
v_mfma_f32_16x16x32_bf16 a[104:107], a[232:235], v[220:223], a[104:107]
buffer_load_dwordx4 v1, s[44:47], s72 offen offset:2048 sc1 lds
v_mfma_f32_16x16x32_bf16 a[108:111], a[236:239], v[220:223], a[108:111]
v_exp_f32 v143, v143
v_mfma_f32_16x16x32_bf16 a[76:79], a[236:239], v[216:219], a[76:79]
ds_read_b128 a[204:207], v2 offset:3072
v_cvt_pk_bf16_f32 v205, v142, v143
v_mfma_f32_16x16x32_bf16 a[80:83], a[240:243], v[216:219], a[80:83]
v_exp_f32 v156, v156
v_mfma_f32_16x16x32_bf16 a[112:115], a[240:243], v[220:223], a[112:115]
ds_read_b128 a[208:211], v2 offset:4096
v_mfma_f32_16x16x32_bf16 a[116:119], a[244:247], v[220:223], a[116:119]
v_exp_f32 v157, v157
v_mfma_f32_16x16x32_bf16 a[84:87], a[244:247], v[216:219], a[84:87]
ds_read_b128 a[212:215], v2 offset:5120
v_cvt_pk_bf16_f32 v206, v156, v157
v_mfma_f32_16x16x32_bf16 a[88:91], a[248:251], v[216:219], a[88:91]
v_exp_f32 v158, v158
v_mfma_f32_16x16x32_bf16 a[120:123], a[248:251], v[220:223], a[120:123]
ds_read_b128 a[216:219], v2 offset:6144
v_mfma_f32_16x16x32_bf16 a[124:127], a[252:255], v[220:223], a[124:127]
buffer_load_dwordx4 v1, s[44:47], s72 offen offset:3072 sc1 lds
v_mfma_f32_16x16x32_bf16 a[92:95], a[252:255], v[216:219], a[92:95]
v_exp_f32 v159, v159
v_mfma_f32_16x16x32_bf16 v[232:235], v[120:123], v[216:219], v[232:235]
ds_read_b128 a[220:223], v2 offset:7168
v_cvt_pk_bf16_f32 v207, v158, v159
v_mfma_f32_16x16x32_bf16 v[236:239], v[120:123], v[220:223], v[236:239]
s_waitcnt lgkmcnt(8)
v_mfma_f32_16x16x32_bf16 v[136:139], a[128:131], v[48:51], v[88:91]
s_add_u32 s82, s82, 0x8000
ds_read_b128 a[160:163], v2 offset:24576
ds_read_b128 a[164:167], v2 offset:25600
v_mfma_f32_16x16x32_bf16 v[136:139], a[132:135], v[52:55], v[136:139]
s_and_b32 s82, s82, 0x1ffff
v_exp_f32 v168, v168
v_mfma_f32_16x16x32_bf16 v[136:139], a[136:139], v[56:59], v[136:139]
s_add_u32 m0, s74, 0
v_exp_f32 v169, v169
v_mfma_f32_16x16x32_bf16 v[136:139], a[140:143], v[60:63], v[136:139]
s_add_u32 s72, s81, 0
ds_read_b128 a[168:171], v2 offset:26624
v_cvt_pk_bf16_f32 v216, v168, v169
v_mfma_f32_16x16x32_bf16 v[140:143], a[140:143], v[76:79], v[92:95]
v_exp_f32 v170, v170
v_mfma_f32_16x16x32_bf16 v[140:143], a[136:139], v[72:75], v[140:143]
buffer_load_dwordx4 v1, s[44:47], s72 offen sc1 lds
v_mfma_f32_16x16x32_bf16 v[140:143], a[132:135], v[68:71], v[140:143]
ds_read_b128 a[172:175], v2 offset:27648
ds_read_b128 a[176:179], v2 offset:28672
v_mfma_f32_16x16x32_bf16 v[140:143], a[128:131], v[64:67], v[140:143]
v_exp_f32 v171, v171
v_mfma_f32_16x16x32_bf16 v[156:159], a[144:147], v[64:67], v[92:95]
v_exp_f32 v184, v184
v_mfma_f32_16x16x32_bf16 v[156:159], a[148:151], v[68:71], v[156:159]
ds_read_b128 a[180:183], v2 offset:29696
v_cvt_pk_bf16_f32 v217, v170, v171
v_mfma_f32_16x16x32_bf16 v[156:159], a[152:155], v[72:75], v[156:159]
v_exp_f32 v185, v185
v_mfma_f32_16x16x32_bf16 v[156:159], a[156:159], v[76:79], v[156:159]
ds_read_b128 a[184:187], v2 offset:30720
v_cvt_pk_bf16_f32 v218, v184, v185
v_mfma_f32_16x16x32_bf16 v[152:155], a[156:159], v[60:63], v[88:91]
buffer_load_dwordx4 v1, s[44:47], s72 offen offset:1024 sc1 lds
v_mfma_f32_16x16x32_bf16 v[152:155], a[152:155], v[56:59], v[152:155]
v_exp_f32 v186, v186
v_mfma_f32_16x16x32_bf16 v[152:155], a[148:151], v[52:55], v[152:155]
ds_read_b128 a[188:191], v2 offset:31744
ds_read_b128 a[224:227], v2 offset:8192
v_mfma_f32_16x16x32_bf16 v[152:155], a[144:147], v[48:51], v[152:155]
s_waitcnt lgkmcnt(9)
v_exp_f32 v187, v187
v_mfma_f32_16x16x32_bf16 a[64:67], a[192:195], v[200:203], a[64:67]
v_exp_f32 v172, v172
v_mfma_f32_16x16x32_bf16 a[96:99], a[192:195], v[204:207], a[96:99]
ds_read_b128 a[228:231], v2 offset:9216
v_cvt_pk_bf16_f32 v219, v186, v187
v_mfma_f32_16x16x32_bf16 a[100:103], a[196:199], v[204:207], a[100:103]
v_exp_f32 v173, v173
v_mfma_f32_16x16x32_bf16 a[68:71], a[196:199], v[200:203], a[68:71]
ds_read_b128 a[232:235], v2 offset:10240
v_cvt_pk_bf16_f32 v220, v172, v173
v_mfma_f32_16x16x32_bf16 a[72:75], a[200:203], v[200:203], a[72:75]
buffer_load_dwordx4 v1, s[44:47], s72 offen offset:2048 sc1 lds
v_mfma_f32_16x16x32_bf16 a[104:107], a[200:203], v[204:207], a[104:107]
v_exp_f32 v174, v174
v_mfma_f32_16x16x32_bf16 a[108:111], a[204:207], v[204:207], a[108:111]
ds_read_b128 a[236:239], v2 offset:11264
ds_read_b128 a[240:243], v2 offset:12288
v_mfma_f32_16x16x32_bf16 a[76:79], a[204:207], v[200:203], a[76:79]
v_exp_f32 v175, v175
v_mfma_f32_16x16x32_bf16 a[80:83], a[208:211], v[200:203], a[80:83]
v_exp_f32 v188, v188
v_mfma_f32_16x16x32_bf16 a[112:115], a[208:211], v[204:207], a[112:115]
ds_read_b128 a[244:247], v2 offset:13312
v_cvt_pk_bf16_f32 v221, v174, v175
v_mfma_f32_16x16x32_bf16 a[116:119], a[212:215], v[204:207], a[116:119]
v_exp_f32 v189, v189
v_mfma_f32_16x16x32_bf16 a[84:87], a[212:215], v[200:203], a[84:87]
ds_read_b128 a[248:251], v2 offset:14336
v_cvt_pk_bf16_f32 v222, v188, v189
v_mfma_f32_16x16x32_bf16 a[88:91], a[216:219], v[200:203], a[88:91]
buffer_load_dwordx4 v1, s[44:47], s72 offen offset:3072 sc1 lds
v_mfma_f32_16x16x32_bf16 a[120:123], a[216:219], v[204:207], a[120:123]
ds_read_b128 a[252:255], v2 offset:15360
v_add_u32 v2, s82, v1
v_mfma_f32_16x16x32_bf16 a[124:127], a[220:223], v[204:207], a[124:127]
s_waitcnt vmcnt(8) lgkmcnt(8)
v_exp_f32 v190, v190
v_mfma_f32_16x16x32_bf16 a[92:95], a[220:223], v[200:203], a[92:95]
s_barrier
v_exp_f32 v191, v191
v_mfma_f32_16x16x32_bf16 v[232:235], v[120:123], v[200:203], v[232:235]
s_add_u32 s83, s83, 1
v_cvt_pk_bf16_f32 v223, v190, v191
v_mfma_f32_16x16x32_bf16 v[236:239], v[120:123], v[204:207], v[236:239]
s_cbranch_scc0 LloopII
v_mfma_f32_16x16x32_bf16 v[168:171], a[160:163], v[48:51], v[88:91]
s_xor_b32 s74, s82, 0x10000
ds_read_b128 a[128:131], v2 offset:16384
ds_read_b128 a[132:135], v2 offset:17408
v_mfma_f32_16x16x32_bf16 v[168:171], a[164:167], v[52:55], v[168:171]
s_add_u32 s74, s74, s64
v_exp_f32 v136, v136
v_mfma_f32_16x16x32_bf16 v[168:171], a[168:171], v[56:59], v[168:171]
s_add_u32 s81, s81, 0x8000
v_exp_f32 v137, v137
v_mfma_f32_16x16x32_bf16 v[168:171], a[172:175], v[60:63], v[168:171]
s_add_u32 m0, s74, 0
ds_read_b128 a[136:139], v2 offset:18432
v_cvt_pk_bf16_f32 v200, v136, v137
v_mfma_f32_16x16x32_bf16 v[172:175], a[172:175], v[76:79], v[92:95]
s_add_u32 s72, s81, 0
v_exp_f32 v138, v138
v_mfma_f32_16x16x32_bf16 v[172:175], a[168:171], v[72:75], v[172:175]
buffer_load_dwordx4 v1, s[44:47], s72 offen sc1 lds
v_mfma_f32_16x16x32_bf16 v[172:175], a[164:167], v[68:71], v[172:175]
ds_read_b128 a[140:143], v2 offset:19456
ds_read_b128 a[144:147], v2 offset:20480
v_mfma_f32_16x16x32_bf16 v[172:175], a[160:163], v[64:67], v[172:175]
v_exp_f32 v139, v139
v_mfma_f32_16x16x32_bf16 v[188:191], a[176:179], v[64:67], v[92:95]
v_exp_f32 v152, v152
v_mfma_f32_16x16x32_bf16 v[188:191], a[180:183], v[68:71], v[188:191]
ds_read_b128 a[148:151], v2 offset:21504
v_cvt_pk_bf16_f32 v201, v138, v139
v_mfma_f32_16x16x32_bf16 v[188:191], a[184:187], v[72:75], v[188:191]
v_exp_f32 v153, v153
v_mfma_f32_16x16x32_bf16 v[188:191], a[188:191], v[76:79], v[188:191]
ds_read_b128 a[152:155], v2 offset:22528
v_cvt_pk_bf16_f32 v202, v152, v153
v_mfma_f32_16x16x32_bf16 v[184:187], a[188:191], v[60:63], v[88:91]
v_exp_f32 v154, v154
v_mfma_f32_16x16x32_bf16 v[184:187], a[184:187], v[56:59], v[184:187]
buffer_load_dwordx4 v1, s[44:47], s72 offen offset:1024 sc1 lds
v_mfma_f32_16x16x32_bf16 v[184:187], a[180:183], v[52:55], v[184:187]
ds_read_b128 a[156:159], v2 offset:23552
ds_read_b128 a[192:195], v2 offset:0
v_mfma_f32_16x16x32_bf16 v[184:187], a[176:179], v[48:51], v[184:187]
s_waitcnt lgkmcnt(9)
v_exp_f32 v155, v155
v_mfma_f32_16x16x32_bf16 a[64:67], a[224:227], v[216:219], a[64:67]
v_exp_f32 v140, v140
v_mfma_f32_16x16x32_bf16 a[96:99], a[224:227], v[220:223], a[96:99]
ds_read_b128 a[196:199], v2 offset:1024
v_cvt_pk_bf16_f32 v203, v154, v155
v_mfma_f32_16x16x32_bf16 a[100:103], a[228:231], v[220:223], a[100:103]
v_exp_f32 v141, v141
v_mfma_f32_16x16x32_bf16 a[68:71], a[228:231], v[216:219], a[68:71]
ds_read_b128 a[200:203], v2 offset:2048
v_cvt_pk_bf16_f32 v204, v140, v141
v_mfma_f32_16x16x32_bf16 a[72:75], a[232:235], v[216:219], a[72:75]
v_exp_f32 v142, v142
v_mfma_f32_16x16x32_bf16 a[104:107], a[232:235], v[220:223], a[104:107]
buffer_load_dwordx4 v1, s[44:47], s72 offen offset:2048 sc1 lds
v_mfma_f32_16x16x32_bf16 a[108:111], a[236:239], v[220:223], a[108:111]
ds_read_b128 a[204:207], v2 offset:3072
v_mfma_f32_16x16x32_bf16 a[76:79], a[236:239], v[216:219], a[76:79]
v_exp_f32 v143, v143
v_mfma_f32_16x16x32_bf16 a[80:83], a[240:243], v[216:219], a[80:83]
ds_read_b128 a[208:211], v2 offset:4096
v_cvt_pk_bf16_f32 v205, v142, v143
v_mfma_f32_16x16x32_bf16 a[112:115], a[240:243], v[220:223], a[112:115]
v_exp_f32 v156, v156
v_mfma_f32_16x16x32_bf16 a[116:119], a[244:247], v[220:223], a[116:119]
ds_read_b128 a[212:215], v2 offset:5120
v_mfma_f32_16x16x32_bf16 a[84:87], a[244:247], v[216:219], a[84:87]
v_exp_f32 v157, v157
v_mfma_f32_16x16x32_bf16 a[88:91], a[248:251], v[216:219], a[88:91]
ds_read_b128 a[216:219], v2 offset:6144
v_cvt_pk_bf16_f32 v206, v156, v157
v_mfma_f32_16x16x32_bf16 a[120:123], a[248:251], v[220:223], a[120:123]
buffer_load_dwordx4 v1, s[44:47], s72 offen offset:3072 sc1 lds
v_mfma_f32_16x16x32_bf16 a[124:127], a[252:255], v[220:223], a[124:127]
v_exp_f32 v158, v158
v_mfma_f32_16x16x32_bf16 a[92:95], a[252:255], v[216:219], a[92:95]
ds_read_b128 a[220:223], v2 offset:7168
v_mfma_f32_16x16x32_bf16 v[232:235], v[120:123], v[216:219], v[232:235]
s_waitcnt lgkmcnt(8)
v_exp_f32 v159, v159
v_mfma_f32_16x16x32_bf16 v[236:239], v[120:123], v[220:223], v[236:239]
s_barrier
v_cvt_pk_bf16_f32 v207, v158, v159
s_lshr_b32 s69, s93, 4
s_and_b32 s69, s69, 0x7f00
s_add_u32 s69, s69, LHT4-Lpc0
v_lshrrev_b32 v3, 5, v0
v_lshlrev_b32 v3, 7, v3
v_add_u32 v3, s69, v3
v_min_u32 v3, Lcode_end-Lpc0, v3
global_load_dword v4, v3, s[98:99]
s_cmp_eq_u32 s58, 0
s_cbranch_scc1 Lta28
s_cmp_eq_u32 s58, 1
s_cbranch_scc1 Lnt29
v_mfma_f32_16x16x32_bf16 v[136:139], a[128:131], v[48:51], v[88:91]
s_add_u32 s82, s82, 0x8000
ds_read_b128 a[160:163], v2 offset:24576
ds_read_b128 a[164:167], v2 offset:25600
v_mfma_f32_16x16x32_bf16 v[152:155], a[144:147], v[48:51], v[88:91]
s_and_b32 s82, s82, 0x1ffff
v_exp_f32 v168, v168
s_branch Ljoin30
Lta28:
v_mfma_f32_16x16x32_bf16 v[136:139], a[128:131], v[48:51], v[104:107]
s_add_u32 s82, s82, 0x8000
ds_read_b128 a[160:163], v2 offset:24576
ds_read_b128 a[164:167], v2 offset:25600
v_mfma_f32_16x16x32_bf16 v[152:155], a[144:147], v[48:51], v[112:115]
s_and_b32 s82, s82, 0x1ffff
v_exp_f32 v168, v168
s_branch Ljoin30
Lnt29:
v_mfma_f32_16x16x32_bf16 v[136:139], a[128:131], v[48:51], v[88:91]
s_add_u32 s82, s82, 0x8000
ds_read_b128 a[160:163], v2 offset:24576
ds_read_b128 a[164:167], v2 offset:25600
v_mfma_f32_16x16x32_bf16 v[152:155], a[144:147], v[48:51], v[104:107]
s_and_b32 s82, s82, 0x1ffff
v_exp_f32 v168, v168
Ljoin30:
v_mfma_f32_16x16x32_bf16 v[136:139], a[132:135], v[52:55], v[136:139]
s_add_u32 s66, s58, 3
v_exp_f32 v169, v169
v_mfma_f32_16x16x32_bf16 v[136:139], a[136:139], v[56:59], v[136:139]
s_and_b32 s66, s66, 3
ds_read_b128 a[168:171], v2 offset:26624
v_cvt_pk_bf16_f32 v216, v168, v169
v_mfma_f32_16x16x32_bf16 v[136:139], a[140:143], v[60:63], v[136:139]
s_mul_i32 s66, s66, 4160
v_exp_f32 v170, v170
v_mfma_f32_16x16x32_bf16 v[140:143], a[140:143], v[76:79], v[92:95]
s_add_u32 s66, s66, s92
ds_read_b128 a[172:175], v2 offset:27648
ds_read_b128 a[176:179], v2 offset:28672
v_mfma_f32_16x16x32_bf16 v[140:143], a[136:139], v[72:75], v[140:143]
s_add_u32 m0, s66, 32
v_exp_f32 v171, v171
v_mfma_f32_16x16x32_bf16 v[140:143], a[132:135], v[68:71], v[140:143]
s_add_u32 s72, s93, 0x6
buffer_load_dwordx4 v1, s[36:39], s72 offen lds
v_mfma_f32_16x16x32_bf16 v[140:143], a[128:131], v[64:67], v[140:143]
v_exp_f32 v184, v184
v_mfma_f32_16x16x32_bf16 v[156:159], a[144:147], v[64:67], v[92:95]
ds_read_b128 a[180:183], v2 offset:29696
v_cvt_pk_bf16_f32 v217, v170, v171
v_mfma_f32_16x16x32_bf16 v[156:159], a[148:151], v[68:71], v[156:159]
v_exp_f32 v185, v185
v_mfma_f32_16x16x32_bf16 v[156:159], a[152:155], v[72:75], v[156:159]
ds_read_b128 a[184:187], v2 offset:30720
v_cvt_pk_bf16_f32 v218, v184, v185
v_mfma_f32_16x16x32_bf16 v[156:159], a[156:159], v[76:79], v[156:159]
v_exp_f32 v186, v186
v_mfma_f32_16x16x32_bf16 v[152:155], a[156:159], v[60:63], v[152:155]
buffer_load_dwordx4 v1, s[36:39], s72 offen offset:1024 lds
v_mfma_f32_16x16x32_bf16 v[152:155], a[152:155], v[56:59], v[152:155]
ds_read_b128 a[188:191], v2 offset:31744
ds_read_b128 a[224:227], v2 offset:8192
v_mfma_f32_16x16x32_bf16 v[152:155], a[148:151], v[52:55], v[152:155]
s_waitcnt lgkmcnt(9)
v_exp_f32 v187, v187
v_mfma_f32_16x16x32_bf16 a[64:67], a[192:195], v[200:203], a[64:67]
v_exp_f32 v172, v172
v_mfma_f32_16x16x32_bf16 a[96:99], a[192:195], v[204:207], a[96:99]
ds_read_b128 a[228:231], v2 offset:9216
v_cvt_pk_bf16_f32 v219, v186, v187
v_mfma_f32_16x16x32_bf16 a[100:103], a[196:199], v[204:207], a[100:103]
v_exp_f32 v173, v173
v_mfma_f32_16x16x32_bf16 a[68:71], a[196:199], v[200:203], a[68:71]
ds_read_b128 a[232:235], v2 offset:10240
v_cvt_pk_bf16_f32 v220, v172, v173
v_mfma_f32_16x16x32_bf16 a[72:75], a[200:203], v[200:203], a[72:75]
v_exp_f32 v174, v174
v_mfma_f32_16x16x32_bf16 a[104:107], a[200:203], v[204:207], a[104:107]
buffer_load_dwordx4 v1, s[36:39], s72 offen offset:2048 lds
v_mfma_f32_16x16x32_bf16 a[108:111], a[204:207], v[204:207], a[108:111]
ds_read_b128 a[236:239], v2 offset:11264
v_mfma_f32_16x16x32_bf16 a[76:79], a[204:207], v[200:203], a[76:79]
v_exp_f32 v175, v175
v_mfma_f32_16x16x32_bf16 a[80:83], a[208:211], v[200:203], a[80:83]
ds_read_b128 a[240:243], v2 offset:12288
v_cvt_pk_bf16_f32 v221, v174, v175
v_mfma_f32_16x16x32_bf16 a[112:115], a[208:211], v[204:207], a[112:115]
v_exp_f32 v188, v188
v_mfma_f32_16x16x32_bf16 a[116:119], a[212:215], v[204:207], a[116:119]
ds_read_b128 a[244:247], v2 offset:13312
v_mfma_f32_16x16x32_bf16 a[84:87], a[212:215], v[200:203], a[84:87]
v_exp_f32 v189, v189
v_mfma_f32_16x16x32_bf16 a[88:91], a[216:219], v[200:203], a[88:91]
ds_read_b128 a[248:251], v2 offset:14336
v_cvt_pk_bf16_f32 v222, v188, v189
v_mfma_f32_16x16x32_bf16 a[120:123], a[216:219], v[204:207], a[120:123]
buffer_load_dwordx4 v1, s[36:39], s72 offen offset:3072 lds
v_mfma_f32_16x16x32_bf16 a[124:127], a[220:223], v[204:207], a[124:127]
v_exp_f32 v190, v190
v_mfma_f32_16x16x32_bf16 a[92:95], a[220:223], v[200:203], a[92:95]
ds_read_b128 a[252:255], v2 offset:15360
v_add_u32 v2, s82, v1
v_mfma_f32_16x16x32_bf16 v[232:235], v[120:123], v[200:203], v[232:235]
s_waitcnt vmcnt(9) lgkmcnt(0)
v_exp_f32 v191, v191
v_mfma_f32_16x16x32_bf16 v[236:239], v[120:123], v[204:207], v[236:239]
s_barrier
v_cvt_pk_bf16_f32 v223, v190, v191
s_cmp_eq_u32 s58, 2
s_cbranch_scc1 Lta31
s_cmp_eq_u32 s58, 3
s_cbranch_scc1 Lnt32
v_mfma_f32_16x16x32_bf16 v[168:171], a[160:163], v[48:51], v[112:115]
s_mov_b32 m0, s62
v_exp_f32 v136, v136
v_mfma_f32_16x16x32_bf16 v[184:187], a[176:179], v[48:51], v[112:115]
s_add_u32 s72, s93, 0x3000000
ds_read_b128 a[128:131], v2 offset:16384
ds_read_b128 a[132:135], v2 offset:17408
s_branch Ljoin33
Lta31:
v_mfma_f32_16x16x32_bf16 v[168:171], a[160:163], v[48:51], v[104:107]
s_mov_b32 m0, s62
v_exp_f32 v136, v136
v_mfma_f32_16x16x32_bf16 v[184:187], a[176:179], v[48:51], v[112:115]
s_add_u32 s72, s93, 0x3000000
ds_read_b128 a[128:131], v2 offset:16384
ds_read_b128 a[132:135], v2 offset:17408
s_branch Ljoin33
Lnt32:
v_mfma_f32_16x16x32_bf16 v[168:171], a[160:163], v[48:51], v[88:91]
s_mov_b32 m0, s62
v_exp_f32 v136, v136
v_mfma_f32_16x16x32_bf16 v[184:187], a[176:179], v[48:51], v[104:107]
s_add_u32 s72, s93, 0x3000000
ds_read_b128 a[128:131], v2 offset:16384
ds_read_b128 a[132:135], v2 offset:17408
Ljoin33:
v_mfma_f32_16x16x32_bf16 v[168:171], a[164:167], v[52:55], v[168:171]
v_exp_f32 v137, v137
v_mfma_f32_16x16x32_bf16 v[168:171], a[168:171], v[56:59], v[168:171]
buffer_load_dwordx4 v1, s[44:47], s72 offen sc1 lds
v_mfma_f32_16x16x32_bf16 v[168:171], a[172:175], v[60:63], v[168:171]
s_add_u32 s78, s59, 4
v_exp_f32 v138, v138
v_mfma_f32_16x16x32_bf16 v[172:175], a[172:175], v[76:79], v[92:95]
s_and_b32 s78, s78, 28
ds_read_b128 a[136:139], v2 offset:18432
v_cvt_pk_bf16_f32 v200, v136, v137
v_mfma_f32_16x16x32_bf16 v[172:175], a[168:171], v[72:75], v[172:175]
s_add_u32 s12, s61, 0
v_exp_f32 v139, v139
v_mfma_f32_16x16x32_bf16 v[172:175], a[164:167], v[68:71], v[172:175]
s_and_b32 s12, s12, 3
ds_read_b128 a[140:143], v2 offset:19456
v_cvt_pk_bf16_f32 v201, v138, v139
v_mfma_f32_16x16x32_bf16 v[172:175], a[160:163], v[64:67], v[172:175]
s_add_u32 s12, s12, s78
v_exp_f32 v152, v152
v_mfma_f32_16x16x32_bf16 v[188:191], a[176:179], v[64:67], v[92:95]
s_lshl_b32 s12, s12, 18
ds_read_b128 a[144:147], v2 offset:20480
ds_read_b128 a[148:151], v2 offset:21504
v_mfma_f32_16x16x32_bf16 v[188:191], a[180:183], v[68:71], v[188:191]
Lstub6:
s_cbranch_execz Lstub10
s_add_u32 s13, s61, 1
buffer_load_dwordx4 v1, s[44:47], s72 offen offset:1024 sc1 lds
v_mfma_f32_16x16x32_bf16 v[188:191], a[184:187], v[72:75], v[188:191]
s_and_b32 s13, s13, 3
v_exp_f32 v153, v153
v_mfma_f32_16x16x32_bf16 v[188:191], a[188:191], v[76:79], v[188:191]
s_add_u32 s13, s13, s78
v_exp_f32 v154, v154
v_mfma_f32_16x16x32_bf16 v[184:187], a[188:191], v[60:63], v[184:187]
s_lshl_b32 s13, s13, 18
ds_read_b128 a[152:155], v2 offset:22528
v_cvt_pk_bf16_f32 v202, v152, v153
v_mfma_f32_16x16x32_bf16 v[184:187], a[184:187], v[56:59], v[184:187]
s_add_u32 s14, s61, 2
buffer_load_dwordx4 v1, s[44:47], s72 offen offset:2048 sc1 lds
v_mfma_f32_16x16x32_bf16 v[184:187], a[180:183], v[52:55], v[184:187]
s_waitcnt lgkmcnt(7)
v_exp_f32 v155, v155
v_mfma_f32_16x16x32_bf16 a[64:67], a[224:227], v[216:219], a[64:67]
s_and_b32 s14, s14, 3
ds_read_b128 a[156:159], v2 offset:23552
v_cvt_pk_bf16_f32 v203, v154, v155
v_mfma_f32_16x16x32_bf16 a[96:99], a[224:227], v[220:223], a[96:99]
s_add_u32 s14, s14, s78
v_exp_f32 v140, v140
v_mfma_f32_16x16x32_bf16 a[100:103], a[228:231], v[220:223], a[100:103]
s_lshl_b32 s14, s14, 18
ds_read_b128 a[192:195], v2 offset:0
ds_read_b128 a[196:199], v2 offset:1024
v_mfma_f32_16x16x32_bf16 a[68:71], a[228:231], v[216:219], a[68:71]
s_add_u32 s15, s61, 3
v_exp_f32 v141, v141
v_mfma_f32_16x16x32_bf16 a[72:75], a[232:235], v[216:219], a[72:75]
s_and_b32 s15, s15, 3
buffer_load_dwordx4 v1, s[44:47], s72 offen offset:3072 sc1 lds
v_mfma_f32_16x16x32_bf16 a[104:107], a[232:235], v[220:223], a[104:107]
s_add_u32 s66, s58, 0
v_exp_f32 v142, v142
v_mfma_f32_16x16x32_bf16 a[108:111], a[236:239], v[220:223], a[108:111]
s_and_b32 s66, s66, 3
ds_read_b128 a[200:203], v2 offset:2048
v_cvt_pk_bf16_f32 v204, v140, v141
v_mfma_f32_16x16x32_bf16 a[76:79], a[236:239], v[216:219], a[76:79]
s_mul_i32 s66, s66, 4160
v_exp_f32 v143, v143
v_mfma_f32_16x16x32_bf16 a[80:83], a[240:243], v[216:219], a[80:83]
s_add_u32 s66, s66, s92
ds_read_b128 a[204:207], v2 offset:3072
v_cvt_pk_bf16_f32 v205, v142, v143
v_mfma_f32_16x16x32_bf16 a[112:115], a[240:243], v[220:223], a[112:115]
s_add_u32 m0, s66, 16672
v_exp_f32 v156, v156
v_mfma_f32_16x16x32_bf16 a[116:119], a[244:247], v[220:223], a[116:119]
s_add_u32 s72, s93, 0x0
ds_read_b128 a[208:211], v2 offset:4096
ds_read_b128 a[212:215], v2 offset:5120
v_mfma_f32_16x16x32_bf16 a[84:87], a[244:247], v[216:219], a[84:87]
s_add_u32 s15, s15, s78
buffer_load_dwordx4 v1, s[36:39], s72 offen lds
v_mfma_f32_16x16x32_bf16 a[88:91], a[248:251], v[216:219], a[88:91]
s_lshl_b32 s15, s15, 18
v_exp_f32 v157, v157
v_mfma_f32_16x16x32_bf16 a[120:123], a[248:251], v[220:223], a[120:123]
s_xor_b32 s78, s94, 0x80
v_exp_f32 v158, v158
v_mfma_f32_16x16x32_bf16 a[124:127], a[252:255], v[220:223], a[124:127]
ds_read_b128 a[216:219], v2 offset:6144
ds_read_b128 a[220:223], v2 offset:7168
v_mfma_f32_16x16x32_bf16 a[92:95], a[252:255], v[216:219], a[92:95]
buffer_load_dwordx4 v1, s[36:39], s72 offen offset:1024 lds
v_mfma_f32_16x16x32_bf16 v[232:235], v[120:123], v[216:219], v[232:235]
v_exp_f32 v159, v159
v_mfma_f32_16x16x32_bf16 v[236:239], v[120:123], v[220:223], v[236:239]
s_waitcnt lgkmcnt(8)
v_cvt_pk_bf16_f32 v206, v156, v157
v_cvt_pk_bf16_f32 v207, v158, v159
s_cmp_eq_u32 s58, 0
s_cbranch_scc1 Lta34
s_cmp_eq_u32 s58, 1
s_cbranch_scc1 Lnt35
v_mfma_f32_16x16x32_bf16 v[140:143], a[128:131], v[64:67], v[92:95]
s_add_u32 s82, s82, 0x8000
ds_read_b128 a[160:163], v2 offset:24576
ds_read_b128 a[164:167], v2 offset:25600
v_mfma_f32_16x16x32_bf16 v[156:159], a[144:147], v[64:67], v[92:95]
s_and_b32 s82, s82, 0x1ffff
v_exp_f32 v168, v168
s_branch Ljoin36
Lta34:
v_mfma_f32_16x16x32_bf16 v[140:143], a[128:131], v[64:67], v[108:111]
s_add_u32 s82, s82, 0x8000
ds_read_b128 a[160:163], v2 offset:24576
ds_read_b128 a[164:167], v2 offset:25600
v_mfma_f32_16x16x32_bf16 v[156:159], a[144:147], v[64:67], v[112:115]
s_and_b32 s82, s82, 0x1ffff
v_exp_f32 v168, v168
s_branch Ljoin36
Lnt35:
v_mfma_f32_16x16x32_bf16 v[140:143], a[128:131], v[64:67], v[92:95]
s_add_u32 s82, s82, 0x8000
ds_read_b128 a[160:163], v2 offset:24576
ds_read_b128 a[164:167], v2 offset:25600
v_mfma_f32_16x16x32_bf16 v[156:159], a[144:147], v[64:67], v[108:111]
s_and_b32 s82, s82, 0x1ffff
v_exp_f32 v168, v168
Ljoin36:
v_mfma_f32_16x16x32_bf16 v[140:143], a[132:135], v[68:71], v[140:143]
v_exp_f32 v169, v169
v_mfma_f32_16x16x32_bf16 v[140:143], a[136:139], v[72:75], v[140:143]
ds_read_b128 a[168:171], v2 offset:26624
ds_read_b128 a[172:175], v2 offset:27648
v_mfma_f32_16x16x32_bf16 v[140:143], a[140:143], v[76:79], v[140:143]
v_exp_f32 v170, v170
v_mfma_f32_16x16x32_bf16 v[156:159], a[156:159], v[76:79], v[156:159]
v_exp_f32 v171, v171
v_mfma_f32_16x16x32_bf16 v[156:159], a[152:155], v[72:75], v[156:159]
ds_read_b128 a[176:179], v2 offset:28672
ds_read_b128 a[180:183], v2 offset:29696
v_mfma_f32_16x16x32_bf16 v[156:159], a[148:151], v[68:71], v[156:159]
s_waitcnt lgkmcnt(6)
v_exp_f32 v184, v184
v_mfma_f32_16x16x32_bf16 a[64:67], a[192:195], v[200:203], a[64:67]
ds_read_b128 a[184:187], v2 offset:30720
ds_read_b128 a[188:191], v2 offset:31744
v_mfma_f32_16x16x32_bf16 a[96:99], a[192:195], v[204:207], a[96:99]
ds_read_b128 a[224:227], v2 offset:8192
ds_read_b128 a[228:231], v2 offset:9216
v_mfma_f32_16x16x32_bf16 a[100:103], a[196:199], v[204:207], a[100:103]
ds_read_b128 a[232:235], v2 offset:10240
ds_read_b128 a[236:239], v2 offset:11264
v_mfma_f32_16x16x32_bf16 a[68:71], a[196:199], v[200:203], a[68:71]
ds_read_b128 a[240:243], v2 offset:12288
ds_read_b128 a[244:247], v2 offset:13312
v_mfma_f32_16x16x32_bf16 a[72:75], a[200:203], v[200:203], a[72:75]
ds_read_b128 a[248:251], v2 offset:14336
ds_read_b128 a[252:255], v2 offset:15360
v_mfma_f32_16x16x32_bf16 a[104:107], a[200:203], v[204:207], a[104:107]
v_cvt_pk_bf16_f32 v216, v168, v169
v_cvt_pk_bf16_f32 v217, v170, v171
v_mfma_f32_16x16x32_bf16 a[108:111], a[204:207], v[204:207], a[108:111]
buffer_load_dwordx4 v1, s[36:39], s72 offen offset:2048 lds
v_mfma_f32_16x16x32_bf16 a[76:79], a[204:207], v[200:203], a[76:79]
v_exp_f32 v185, v185
v_mfma_f32_16x16x32_bf16 a[80:83], a[208:211], v[200:203], a[80:83]
v_exp_f32 v186, v186
v_mfma_f32_16x16x32_bf16 a[112:115], a[208:211], v[204:207], a[112:115]
v_exp_f32 v187, v187
v_mfma_f32_16x16x32_bf16 a[116:119], a[212:215], v[204:207], a[116:119]
v_exp_f32 v172, v172
v_mfma_f32_16x16x32_bf16 a[84:87], a[212:215], v[200:203], a[84:87]
v_cvt_pk_bf16_f32 v218, v184, v185
v_cvt_pk_bf16_f32 v219, v186, v187
v_mfma_f32_16x16x32_bf16 a[88:91], a[216:219], v[200:203], a[88:91]
v_exp_f32 v173, v173
v_mfma_f32_16x16x32_bf16 a[120:123], a[216:219], v[204:207], a[120:123]
v_exp_f32 v174, v174
v_mfma_f32_16x16x32_bf16 a[124:127], a[220:223], v[204:207], a[124:127]
v_exp_f32 v175, v175
v_mfma_f32_16x16x32_bf16 a[92:95], a[220:223], v[200:203], a[92:95]
buffer_load_dwordx4 v1, s[36:39], s72 offen offset:3072 lds
v_mfma_f32_16x16x32_bf16 v[232:235], v[120:123], v[200:203], v[232:235]
s_waitcnt vmcnt(13) lgkmcnt(8)
v_exp_f32 v188, v188
v_mfma_f32_16x16x32_bf16 v[236:239], v[120:123], v[204:207], v[236:239]
s_barrier
v_cvt_pk_bf16_f32 v220, v172, v173
v_cvt_pk_bf16_f32 v221, v174, v175
v_add_u32 v2, s82, v1
v_exp_f32 v189, v189
v_exp_f32 v190, v190
v_cvt_pk_bf16_f32 v222, v188, v189
v_exp_f32 v191, v191
s_nop 0
v_cvt_pk_bf16_f32 v223, v190, v191
s_cmp_eq_u32 s58, 2
s_cbranch_scc1 Lta37
s_cmp_eq_u32 s58, 3
s_cbranch_scc1 Lnt38
v_mfma_f32_16x16x32_bf16 v[172:175], a[160:163], v[64:67], v[112:115]
s_add_u32 s66, s58, 2
v_exp_f32 v140, v140
v_mfma_f32_16x16x32_bf16 v[188:191], a[176:179], v[64:67], v[112:115]
s_and_b32 s66, s66, 3
ds_read_b128 a[192:195], v2 offset:0
s_branch Ljoin39
Lta37:
v_mfma_f32_16x16x32_bf16 v[172:175], a[160:163], v[64:67], v[108:111]
s_add_u32 s66, s58, 2
v_exp_f32 v140, v140
v_mfma_f32_16x16x32_bf16 v[188:191], a[176:179], v[64:67], v[112:115]
s_and_b32 s66, s66, 3
ds_read_b128 a[192:195], v2 offset:0
s_branch Ljoin39
Lnt38:
v_mfma_f32_16x16x32_bf16 v[172:175], a[160:163], v[64:67], v[92:95]
s_add_u32 s66, s58, 2
v_exp_f32 v140, v140
v_mfma_f32_16x16x32_bf16 v[188:191], a[176:179], v[64:67], v[108:111]
s_and_b32 s66, s66, 3
ds_read_b128 a[192:195], v2 offset:0
Ljoin39:
v_mfma_f32_16x16x32_bf16 v[172:175], a[164:167], v[68:71], v[172:175]
s_mul_i32 s66, s66, 4160
v_exp_f32 v141, v141
v_mfma_f32_16x16x32_bf16 v[172:175], a[168:171], v[72:75], v[172:175]
s_add_u32 s66, s66, s92
ds_read_b128 a[196:199], v2 offset:1024
v_cvt_pk_bf16_f32 v204, v140, v141
v_mfma_f32_16x16x32_bf16 v[172:175], a[172:175], v[76:79], v[172:175]
s_add_u32 m0, s66, 33312
v_exp_f32 v142, v142
v_mfma_f32_16x16x32_bf16 v[188:191], a[188:191], v[76:79], v[188:191]
s_add_u32 s72, s93, 0x4
buffer_load_dwordx4 v1, s[36:39], s72 offen lds
v_mfma_f32_16x16x32_bf16 v[188:191], a[184:187], v[72:75], v[188:191]
buffer_load_dwordx4 v1, s[36:39], s72 offen offset:1024 lds
v_mfma_f32_16x16x32_bf16 v[188:191], a[180:183], v[68:71], v[188:191]
s_waitcnt lgkmcnt(2)
ds_read_b128 a[200:203], v2 offset:2048
v_mfma_f32_16x16x32_bf16 a[64:67], a[224:227], v[216:219], a[64:67]
buffer_load_dwordx4 v1, s[36:39], s72 offen offset:2048 lds
v_mfma_f32_16x16x32_bf16 a[96:99], a[224:227], v[220:223], a[96:99]
v_exp_f32 v143, v143
v_mfma_f32_16x16x32_bf16 a[100:103], a[228:231], v[220:223], a[100:103]
ds_read_b128 a[204:207], v2 offset:3072
v_cvt_pk_bf16_f32 v205, v142, v143
v_mfma_f32_16x16x32_bf16 a[68:71], a[228:231], v[216:219], a[68:71]
buffer_load_dwordx4 v1, s[36:39], s72 offen offset:3072 lds
v_mfma_f32_16x16x32_bf16 a[72:75], a[232:235], v[216:219], a[72:75]
v_exp_f32 v156, v156
v_mfma_f32_16x16x32_bf16 a[104:107], a[232:235], v[220:223], a[104:107]
ds_read_b128 a[208:211], v2 offset:4096
v_mfma_f32_16x16x32_bf16 a[108:111], a[236:239], v[220:223], a[108:111]
buffer_load_dwordx4 v[80:83], v15, s[4:7], s80 offen
v_mfma_f32_16x16x32_bf16 a[76:79], a[236:239], v[216:219], a[76:79]
s_add_u32 s80, s80, 0x4000
v_exp_f32 v157, v157
v_mfma_f32_16x16x32_bf16 a[80:83], a[240:243], v[216:219], a[80:83]
ds_read_b128 a[212:215], v2 offset:5120
v_cvt_pk_bf16_f32 v206, v156, v157
v_mfma_f32_16x16x32_bf16 a[112:115], a[240:243], v[220:223], a[112:115]
buffer_load_dwordx4 v[84:87], v15, s[4:7], s80 offen
v_mfma_f32_16x16x32_bf16 a[116:119], a[244:247], v[220:223], a[116:119]
s_add_u32 s80, s80, 0x4000
v_exp_f32 v158, v158
v_mfma_f32_16x16x32_bf16 a[84:87], a[244:247], v[216:219], a[84:87]
ds_read_b128 a[216:219], v2 offset:6144
v_mfma_f32_16x16x32_bf16 a[88:91], a[248:251], v[216:219], a[88:91]
buffer_load_dwordx4 v[96:99], v15, s[4:7], s80 offen
v_mfma_f32_16x16x32_bf16 a[120:123], a[248:251], v[220:223], a[120:123]
s_add_u32 s80, s80, 0x4000
v_exp_f32 v159, v159
v_mfma_f32_16x16x32_bf16 a[124:127], a[252:255], v[220:223], a[124:127]
ds_read_b128 a[220:223], v2 offset:7168
v_cvt_pk_bf16_f32 v207, v158, v159
v_mfma_f32_16x16x32_bf16 a[92:95], a[252:255], v[216:219], a[92:95]
buffer_load_dwordx4 v[100:103], v15, s[4:7], s80 offen
v_mfma_f32_16x16x32_bf16 v[232:235], v[120:123], v[216:219], v[232:235]
v_mfma_f32_16x16x32_bf16 v[236:239], v[120:123], v[220:223], v[236:239]
s_waitcnt lgkmcnt(0)
v_mfma_f32_16x16x32_bf16 a[96:99], a[192:195], v[204:207], a[96:99]
s_add_u32 s82, s82, 0x8000
ds_read_b128 a[224:227], v2 offset:8192
ds_read_b128 a[228:231], v2 offset:9216
v_mfma_f32_16x16x32_bf16 a[100:103], a[196:199], v[204:207], a[100:103]
s_and_b32 s82, s82, 0x1ffff
v_exp_f32 v172, v172
v_mfma_f32_16x16x32_bf16 a[104:107], a[200:203], v[204:207], a[104:107]
v_exp_f32 v173, v173
v_mfma_f32_16x16x32_bf16 a[108:111], a[204:207], v[204:207], a[108:111]
ds_read_b128 a[232:235], v2 offset:10240
ds_read_b128 a[236:239], v2 offset:11264
v_mfma_f32_16x16x32_bf16 a[112:115], a[208:211], v[204:207], a[112:115]
v_exp_f32 v174, v174
v_mfma_f32_16x16x32_bf16 a[116:119], a[212:215], v[204:207], a[116:119]
ds_read_b128 a[240:243], v2 offset:12288
ds_read_b128 a[244:247], v2 offset:13312
v_mfma_f32_16x16x32_bf16 a[120:123], a[216:219], v[204:207], a[120:123]
ds_read_b128 a[248:251], v2 offset:14336
ds_read_b128 a[252:255], v2 offset:15360
v_mfma_f32_16x16x32_bf16 a[124:127], a[220:223], v[204:207], a[124:127]
s_waitcnt vmcnt(4) lgkmcnt(0)
v_exp_f32 v175, v175
v_mfma_f32_16x16x32_bf16 v[236:239], v[120:123], v[204:207], v[236:239]
s_barrier
v_exp_f32 v188, v188
v_add_u32 v2, s82, v1
v_cvt_pk_bf16_f32 v220, v172, v173
v_cvt_pk_bf16_f32 v221, v174, v175
v_exp_f32 v189, v189
v_exp_f32 v190, v190
v_cvt_pk_bf16_f32 v222, v188, v189
v_exp_f32 v191, v191
s_nop 0
v_cvt_pk_bf16_f32 v223, v190, v191
LHT4:
Lstub7:
s_cbranch_execz Lstub11
s_nop 1
v_mfma_f32_16x16x32_bf16 a[96:99], a[224:227], v[220:223], a[96:99]
ds_write_b64 v5, v[12:13]
v_mov_b32 v240, 0
v_mfma_f32_16x16x32_bf16 a[100:103], a[228:231], v[220:223], a[100:103]
s_lshl_b32 s73, s59, 12
v_mov_b32 v241, 0
v_mfma_f32_16x16x32_bf16 a[104:107], a[232:235], v[220:223], a[104:107]
s_add_u32 s73, s73, 0x2000000
ds_write_b64 v14, v[240:241]
ds_read_b128 a[192:195], v7 offset:3584
v_mfma_f32_16x16x32_bf16 a[108:111], a[236:239], v[220:223], a[108:111]
s_lshl_b32 s70, s68, 2
ds_read_b64 a[128:129], v6 offset:0
ds_read_b64 a[130:131], v6 offset:8
v_mfma_f32_16x16x32_bf16 a[112:115], a[240:243], v[220:223], a[112:115]
s_add_u32 s70, s70, s73
ds_read_b128 a[196:199], v7 offset:3072
ds_read_b64 a[132:133], v6 offset:512
v_mfma_f32_16x16x32_bf16 a[116:119], a[244:247], v[220:223], a[116:119]
ds_read_b64 a[134:135], v6 offset:520
ds_read_b128 a[200:203], v7 offset:2560
v_mfma_f32_16x16x32_bf16 a[120:123], a[248:251], v[220:223], a[120:123]
ds_read_b64 a[136:137], v6 offset:1024
ds_read_b64 a[138:139], v6 offset:1032
v_mfma_f32_16x16x32_bf16 a[124:127], a[252:255], v[220:223], a[124:127]
s_add_u32 s71, s12, s78
ds_read_b128 a[204:207], v7 offset:2048
ds_read_b64 a[140:141], v6 offset:1536
v_mfma_f32_16x16x32_bf16 v[236:239], v[120:123], v[220:223], v[236:239]
s_add_u32 m0, s77, 0
ds_read_b64 a[142:143], v6 offset:1544
ds_read_b128 a[208:211], v7 offset:1536
ds_read_b64 a[144:145], v6 offset:2048
ds_read_b64 a[146:147], v6 offset:2056
ds_read_b128 a[212:215], v7 offset:1024
ds_read_b64 a[148:149], v6 offset:2560
ds_read_b64 a[150:151], v6 offset:2568
ds_read_b128 a[216:219], v7 offset:512
ds_read_b64 a[152:153], v6 offset:3072
ds_read_b64 a[154:155], v6 offset:3080
ds_read_b128 a[220:223], v7 offset:0
ds_read_b64 a[156:157], v6 offset:3584
ds_read_b64 a[158:159], v6 offset:3592
s_waitcnt lgkmcnt(0)
v_mfma_f32_16x16x32_bf16 v[128:131], v[8:11], a[192:195], 0
s_add_u32 s72, s71, 0
buffer_load_dwordx4 v15, s[24:27], s72 offen lds
v_mfma_f32_16x16x32_bf16 v[128:131], a[128:131], a[192:195], v[128:131]
v_mfma_f32_16x16x32_bf16 v[132:135], v[8:11], a[196:199], 0
ds_read_b128 a[224:227], v7 offset:3648
ds_read_b64 a[160:161], v6 offset:64
v_mfma_f32_16x16x32_bf16 v[132:135], a[128:131], a[196:199], v[132:135]
v_accvgpr_read_b32 v240, a64
v_accvgpr_read_b32 v241, a65
v_accvgpr_read_b32 v242, a66
v_mfma_f32_16x16x32_bf16 v[132:135], a[132:135], a[192:195], v[132:135]
s_add_u32 s72, s71, 15360
buffer_load_dwordx4 v15, s[24:27], s72 offen offset:1024 lds
v_accvgpr_read_b32 v243, a67
v_mfma_f32_16x16x32_bf16 v[136:139], v[8:11], a[200:203], 0
ds_read_b64 a[162:163], v6 offset:72
ds_read_b128 a[228:231], v7 offset:3136
v_mfma_f32_16x16x32_bf16 v[136:139], a[128:131], a[200:203], v[136:139]
v_rcp_f32 v232, v232
v_mfma_f32_16x16x32_bf16 v[136:139], a[132:135], a[196:199], v[136:139]
v_rcp_f32 v236, v236
v_accvgpr_read_b32 v244, a68
v_mfma_f32_16x16x32_bf16 v[136:139], a[136:139], a[192:195], v[136:139]
ds_read_b64 a[164:165], v6 offset:576
ds_read_b64 a[166:167], v6 offset:584
v_accvgpr_read_b32 v245, a69
v_mfma_f32_16x16x32_bf16 v[140:143], v[8:11], a[204:207], 0
s_add_u32 s72, s71, 30720
buffer_load_dwordx4 v15, s[24:27], s72 offen offset:2048 lds
v_accvgpr_read_b32 v246, a70
v_mfma_f32_16x16x32_bf16 v[140:143], a[128:131], a[204:207], v[140:143]
v_accvgpr_read_b32 v247, a71
v_mul_f32 v240, v240, v232
v_mul_f32 v241, v241, v232
v_mfma_f32_16x16x32_bf16 v[140:143], a[132:135], a[200:203], v[140:143]
ds_read_b128 a[232:235], v7 offset:2624
ds_read_b64 a[168:169], v6 offset:1088
v_mul_f32 v242, v242, v232
v_mfma_f32_16x16x32_bf16 v[140:143], a[136:139], a[196:199], v[140:143]
s_add_u32 s72, s71, 46080
buffer_load_dwordx4 v15, s[24:27], s72 offen offset:3072 lds
v_mul_f32 v243, v243, v232
v_mfma_f32_16x16x32_bf16 v[140:143], a[140:143], a[192:195], v[140:143]
v_mul_f32 v244, v244, v232
v_mul_f32 v245, v245, v232
v_mul_f32 v246, v246, v232
v_mfma_f32_16x16x32_bf16 v[144:147], v[8:11], a[208:211], 0
ds_read_b64 a[170:171], v6 offset:1096
ds_read_b128 a[236:239], v7 offset:2112
v_mul_f32 v247, v247, v232
v_mfma_f32_16x16x32_bf16 v[144:147], a[128:131], a[208:211], v[144:147]
s_lshl_b32 s95, s75, 20
v_cvt_pk_bf16_f32 v240, v240, v241
v_cvt_pk_bf16_f32 v241, v242, v243
v_cvt_pk_bf16_f32 v242, v244, v245
v_mfma_f32_16x16x32_bf16 v[144:147], a[132:135], a[204:207], v[144:147]
s_lshl_b32 s74, s58, 18
v_cvt_pk_bf16_f32 v243, v246, v247
v_mfma_f32_16x16x32_bf16 v[144:147], a[136:139], a[200:203], v[144:147]
s_add_u32 s95, s95, s74
ds_read_b64 a[172:173], v6 offset:1600
ds_read_b64 a[174:175], v6 offset:1608
v_mfma_f32_16x16x32_bf16 v[144:147], a[140:143], a[196:199], v[144:147]
s_add_u32 s95, s95, 0x2000000
buffer_store_dwordx4 v[240:243], v1, s[44:47], s70 offen sc1
v_mfma_f32_16x16x32_bf16 v[144:147], a[144:147], a[192:195], v[144:147]
s_sub_u32 s74, 15, s75
v_accvgpr_read_b32 v248, a72
v_accvgpr_read_b32 v249, a73
v_accvgpr_read_b32 v250, a74
v_mfma_f32_16x16x32_bf16 v[148:151], v[8:11], a[212:215], 0
s_min_u32 s74, s74, s75
ds_read_b128 a[240:243], v7 offset:1600
ds_read_b64 a[176:177], v6 offset:2112
v_accvgpr_read_b32 v251, a75
v_mfma_f32_16x16x32_bf16 v[148:151], a[128:131], a[212:215], v[148:151]
s_lshl_b32 s74, s74, 7
v_accvgpr_read_b32 v252, a76
v_accvgpr_read_b32 v253, a77
v_accvgpr_read_b32 v254, a78
v_mfma_f32_16x16x32_bf16 v[148:151], a[132:135], a[208:211], v[148:151]
s_add_u32 s74, s74, 0x3810000
v_accvgpr_read_b32 v255, a79
v_mul_f32 v248, v248, v232
v_mul_f32 v249, v249, v232
v_mfma_f32_16x16x32_bf16 v[148:151], a[136:139], a[204:207], v[148:151]
ds_read_b64 a[178:179], v6 offset:2120
ds_read_b128 a[244:247], v7 offset:1088
v_mul_f32 v250, v250, v232
v_mfma_f32_16x16x32_bf16 v[148:151], a[140:143], a[200:203], v[148:151]
v_mul_f32 v251, v251, v232
v_mul_f32 v252, v252, v232
v_mul_f32 v253, v253, v232
v_mfma_f32_16x16x32_bf16 v[148:151], a[144:147], a[196:199], v[148:151]
v_mul_f32 v254, v254, v232
v_mul_f32 v255, v255, v232
v_cvt_pk_bf16_f32 v248, v248, v249
v_mfma_f32_16x16x32_bf16 v[148:151], a[148:151], a[192:195], v[148:151]
ds_read_b64 a[180:181], v6 offset:2624
ds_read_b64 a[182:183], v6 offset:2632
v_cvt_pk_bf16_f32 v249, v250, v251
v_mfma_f32_16x16x32_bf16 v[152:155], v[8:11], a[216:219], 0
v_cvt_pk_bf16_f32 v250, v252, v253
v_cvt_pk_bf16_f32 v251, v254, v255
v_mfma_f32_16x16x32_bf16 v[152:155], a[128:131], a[216:219], v[152:155]
buffer_store_dwordx4 v[248:251], v1, s[44:47], s70 offen offset:1024 sc1
v_mfma_f32_16x16x32_bf16 v[152:155], a[132:135], a[212:215], v[152:155]
ds_read_b128 a[248:251], v7 offset:576
ds_read_b64 a[184:185], v6 offset:3136
v_accvgpr_read_b32 v240, a80
v_mfma_f32_16x16x32_bf16 v[152:155], a[136:139], a[208:211], v[152:155]
v_accvgpr_read_b32 v241, a81
v_accvgpr_read_b32 v242, a82
v_accvgpr_read_b32 v243, a83
v_mfma_f32_16x16x32_bf16 v[152:155], a[140:143], a[204:207], v[152:155]
v_accvgpr_read_b32 v244, a84
v_accvgpr_read_b32 v245, a85
v_accvgpr_read_b32 v246, a86
v_mfma_f32_16x16x32_bf16 v[152:155], a[144:147], a[200:203], v[152:155]
ds_read_b64 a[186:187], v6 offset:3144
ds_read_b128 a[252:255], v7 offset:64
v_accvgpr_read_b32 v247, a87
v_mfma_f32_16x16x32_bf16 v[152:155], a[148:151], a[196:199], v[152:155]
v_mul_f32 v240, v240, v232
v_mul_f32 v241, v241, v232
v_mul_f32 v242, v242, v232
v_mfma_f32_16x16x32_bf16 v[152:155], a[152:155], a[192:195], v[152:155]
v_mul_f32 v243, v243, v232
v_mul_f32 v244, v244, v232
v_mul_f32 v245, v245, v232
v_mfma_f32_16x16x32_bf16 v[156:159], v[8:11], a[220:223], 0
ds_read_b64 a[188:189], v6 offset:3648
ds_read_b64 a[190:191], v6 offset:3656
v_mul_f32 v246, v246, v232
v_mfma_f32_16x16x32_bf16 v[156:159], a[128:131], a[220:223], v[156:159]
v_mul_f32 v247, v247, v232
v_cvt_pk_bf16_f32 v240, v240, v241
v_cvt_pk_bf16_f32 v241, v242, v243
v_mfma_f32_16x16x32_bf16 v[156:159], a[132:135], a[216:219], v[156:159]
v_cvt_pk_bf16_f32 v242, v244, v245
v_cvt_pk_bf16_f32 v243, v246, v247
v_mfma_f32_16x16x32_bf16 v[156:159], a[136:139], a[212:215], v[156:159]
buffer_store_dwordx4 v[240:243], v1, s[44:47], s70 offen offset:2048 sc1
v_mfma_f32_16x16x32_bf16 v[156:159], a[140:143], a[208:211], v[156:159]
v_accvgpr_read_b32 v248, a88
v_accvgpr_read_b32 v249, a89
v_accvgpr_read_b32 v250, a90
v_mfma_f32_16x16x32_bf16 v[156:159], a[144:147], a[204:207], v[156:159]
v_accvgpr_read_b32 v251, a91
v_accvgpr_read_b32 v252, a92
v_accvgpr_read_b32 v253, a93
v_mfma_f32_16x16x32_bf16 v[156:159], a[148:151], a[200:203], v[156:159]
v_accvgpr_read_b32 v254, a94
v_accvgpr_read_b32 v255, a95
v_mul_f32 v248, v248, v232
v_mfma_f32_16x16x32_bf16 v[156:159], a[152:155], a[196:199], v[156:159]
v_mul_f32 v249, v249, v232
v_mul_f32 v250, v250, v232
v_mul_f32 v251, v251, v232
v_mfma_f32_16x16x32_bf16 v[156:159], a[156:159], a[192:195], v[156:159]
s_waitcnt lgkmcnt(0)
v_mul_f32 v252, v252, v232
v_mul_f32 v253, v253, v232
v_mul_f32 v254, v254, v232
v_mfma_f32_16x16x32_bf16 v[128:131], a[160:163], a[224:227], v[128:131]
ds_read_b128 a[192:195], v7 offset:3712
ds_read_b64 a[128:129], v6 offset:128
v_mul_f32 v255, v255, v232
v_mfma_f32_16x16x32_bf16 v[132:135], a[164:167], a[224:227], v[132:135]
v_cvt_pk_bf16_f32 v248, v248, v249
v_cvt_pk_bf16_f32 v249, v250, v251
v_cvt_pk_bf16_f32 v250, v252, v253
v_mfma_f32_16x16x32_bf16 v[132:135], a[160:163], a[228:231], v[132:135]
ds_read_b64 a[130:131], v6 offset:136
ds_read_b128 a[196:199], v7 offset:3200
v_cvt_pk_bf16_f32 v251, v254, v255
v_mfma_f32_16x16x32_bf16 v[136:139], a[160:163], a[232:235], v[136:139]
buffer_store_dwordx4 v[248:251], v1, s[44:47], s70 offen offset:3072 sc1
v_mfma_f32_16x16x32_bf16 v[136:139], a[164:167], a[228:231], v[136:139]
s_add_u32 s70, s70, 0x80000
v_accvgpr_read_b32 v240, a96
v_accvgpr_read_b32 v241, a97
v_accvgpr_read_b32 v242, a98
v_mfma_f32_16x16x32_bf16 v[136:139], a[168:171], a[224:227], v[136:139]
ds_read_b64 a[132:133], v6 offset:640
ds_read_b64 a[134:135], v6 offset:648
v_accvgpr_read_b32 v243, a99
v_mfma_f32_16x16x32_bf16 v[140:143], a[172:175], a[224:227], v[140:143]
v_accvgpr_read_b32 v244, a100
v_accvgpr_read_b32 v245, a101
v_accvgpr_read_b32 v246, a102
v_mfma_f32_16x16x32_bf16 v[140:143], a[168:171], a[228:231], v[140:143]
ds_read_b128 a[200:203], v7 offset:2688
ds_read_b64 a[136:137], v6 offset:1152
v_accvgpr_read_b32 v247, a103
v_mfma_f32_16x16x32_bf16 v[140:143], a[164:167], a[232:235], v[140:143]
v_mul_f32 v240, v240, v236
v_mul_f32 v241, v241, v236
v_mul_f32 v242, v242, v236
v_mfma_f32_16x16x32_bf16 v[140:143], a[160:163], a[236:239], v[140:143]
v_mul_f32 v243, v243, v236
v_mul_f32 v244, v244, v236
v_mul_f32 v245, v245, v236
v_mfma_f32_16x16x32_bf16 v[144:147], a[160:163], a[240:243], v[144:147]
ds_read_b64 a[138:139], v6 offset:1160
ds_read_b128 a[204:207], v7 offset:2176
v_mul_f32 v246, v246, v236
v_mfma_f32_16x16x32_bf16 v[144:147], a[164:167], a[236:239], v[144:147]
v_mul_f32 v247, v247, v236
v_cvt_pk_bf16_f32 v240, v240, v241
v_cvt_pk_bf16_f32 v241, v242, v243
v_mfma_f32_16x16x32_bf16 v[144:147], a[168:171], a[232:235], v[144:147]
ds_read_b64 a[140:141], v6 offset:1664
ds_read_b64 a[142:143], v6 offset:1672
v_cvt_pk_bf16_f32 v242, v244, v245
v_mfma_f32_16x16x32_bf16 v[144:147], a[172:175], a[228:231], v[144:147]
v_cvt_pk_bf16_f32 v243, v246, v247
v_mfma_f32_16x16x32_bf16 v[144:147], a[176:179], a[224:227], v[144:147]
buffer_store_dwordx4 v[240:243], v1, s[44:47], s70 offen sc1
v_mfma_f32_16x16x32_bf16 v[148:151], a[180:183], a[224:227], v[148:151]
ds_read_b128 a[208:211], v7 offset:1664
ds_read_b64 a[144:145], v6 offset:2176
v_accvgpr_read_b32 v248, a104
v_mfma_f32_16x16x32_bf16 v[148:151], a[176:179], a[228:231], v[148:151]
v_accvgpr_read_b32 v249, a105
v_accvgpr_read_b32 v250, a106
v_accvgpr_read_b32 v251, a107
v_mfma_f32_16x16x32_bf16 v[148:151], a[172:175], a[232:235], v[148:151]
v_accvgpr_read_b32 v252, a108
v_accvgpr_read_b32 v253, a109
v_accvgpr_read_b32 v254, a110
v_mfma_f32_16x16x32_bf16 v[148:151], a[168:171], a[236:239], v[148:151]
ds_read_b64 a[146:147], v6 offset:2184
ds_read_b128 a[212:215], v7 offset:1152
v_accvgpr_read_b32 v255, a111
v_mfma_f32_16x16x32_bf16 v[148:151], a[164:167], a[240:243], v[148:151]
v_mul_f32 v248, v248, v236
v_mul_f32 v249, v249, v236
v_mul_f32 v250, v250, v236
v_mfma_f32_16x16x32_bf16 v[148:151], a[160:163], a[244:247], v[148:151]
ds_read_b64 a[148:149], v6 offset:2688
ds_read_b64 a[150:151], v6 offset:2696
v_mul_f32 v251, v251, v236
v_mfma_f32_16x16x32_bf16 v[152:155], a[160:163], a[248:251], v[152:155]
v_mul_f32 v252, v252, v236
v_mul_f32 v253, v253, v236
v_mul_f32 v254, v254, v236
v_mfma_f32_16x16x32_bf16 v[152:155], a[164:167], a[244:247], v[152:155]
v_mul_f32 v255, v255, v236
v_cvt_pk_bf16_f32 v248, v248, v249
v_cvt_pk_bf16_f32 v249, v250, v251
v_mfma_f32_16x16x32_bf16 v[152:155], a[168:171], a[240:243], v[152:155]
ds_read_b128 a[216:219], v7 offset:640
ds_read_b64 a[152:153], v6 offset:3200
v_cvt_pk_bf16_f32 v250, v252, v253
v_mfma_f32_16x16x32_bf16 v[152:155], a[172:175], a[236:239], v[152:155]
Lstub8:
s_cbranch_execz Lret
v_cvt_pk_bf16_f32 v251, v254, v255
v_mfma_f32_16x16x32_bf16 v[152:155], a[176:179], a[232:235], v[152:155]
ds_read_b64 a[154:155], v6 offset:3208
ds_read_b128 a[220:223], v7 offset:128
v_mfma_f32_16x16x32_bf16 v[152:155], a[180:183], a[228:231], v[152:155]
buffer_store_dwordx4 v[248:251], v1, s[44:47], s70 offen offset:1024 sc1
v_mfma_f32_16x16x32_bf16 v[152:155], a[184:187], a[224:227], v[152:155]
v_accvgpr_read_b32 v240, a112
v_accvgpr_read_b32 v241, a113
v_accvgpr_read_b32 v242, a114
v_mfma_f32_16x16x32_bf16 v[156:159], a[188:191], a[224:227], v[156:159]
ds_read_b64 a[156:157], v6 offset:3712
ds_read_b64 a[158:159], v6 offset:3720
v_accvgpr_read_b32 v243, a115
v_mfma_f32_16x16x32_bf16 v[156:159], a[184:187], a[228:231], v[156:159]
v_accvgpr_read_b32 v244, a116
v_accvgpr_read_b32 v245, a117
v_accvgpr_read_b32 v246, a118
v_mfma_f32_16x16x32_bf16 v[156:159], a[180:183], a[232:235], v[156:159]
v_accvgpr_read_b32 v247, a119
v_mul_f32 v240, v240, v236
v_mul_f32 v241, v241, v236
v_mfma_f32_16x16x32_bf16 v[156:159], a[176:179], a[236:239], v[156:159]
v_mul_f32 v242, v242, v236
v_mul_f32 v243, v243, v236
v_mul_f32 v244, v244, v236
v_mfma_f32_16x16x32_bf16 v[156:159], a[172:175], a[240:243], v[156:159]
v_mul_f32 v245, v245, v236
v_mul_f32 v246, v246, v236
v_mul_f32 v247, v247, v236
v_mfma_f32_16x16x32_bf16 v[156:159], a[168:171], a[244:247], v[156:159]
v_cvt_pk_bf16_f32 v240, v240, v241
v_cvt_pk_bf16_f32 v241, v242, v243
v_cvt_pk_bf16_f32 v242, v244, v245
v_mfma_f32_16x16x32_bf16 v[156:159], a[164:167], a[248:251], v[156:159]
v_cvt_pk_bf16_f32 v243, v246, v247
v_mfma_f32_16x16x32_bf16 v[156:159], a[160:163], a[252:255], v[156:159]
s_waitcnt lgkmcnt(0)
buffer_store_dwordx4 v[240:243], v1, s[44:47], s70 offen offset:2048 sc1
v_mfma_f32_16x16x32_bf16 v[128:131], a[128:131], a[192:195], v[128:131]
ds_read_b128 a[224:227], v7 offset:3776
ds_read_b64 a[160:161], v6 offset:192
v_accvgpr_read_b32 v248, a120
v_mfma_f32_16x16x32_bf16 v[132:135], a[132:135], a[192:195], v[132:135]
v_accvgpr_read_b32 v249, a121
v_accvgpr_read_b32 v250, a122
v_accvgpr_read_b32 v251, a123
v_mfma_f32_16x16x32_bf16 v[132:135], a[128:131], a[196:199], v[132:135]
ds_read_b64 a[162:163], v6 offset:200
ds_read_b128 a[228:231], v7 offset:3264
v_accvgpr_read_b32 v252, a124
v_mfma_f32_16x16x32_bf16 v[136:139], a[128:131], a[200:203], v[136:139]
v_accvgpr_read_b32 v253, a125
v_accvgpr_read_b32 v254, a126
v_accvgpr_read_b32 v255, a127
v_mfma_f32_16x16x32_bf16 v[136:139], a[132:135], a[196:199], v[136:139]
v_mul_f32 v248, v248, v236
v_mul_f32 v249, v249, v236
v_mul_f32 v250, v250, v236
v_mfma_f32_16x16x32_bf16 v[136:139], a[136:139], a[192:195], v[136:139]
ds_read_b64 a[164:165], v6 offset:704
ds_read_b64 a[166:167], v6 offset:712
v_mul_f32 v251, v251, v236
v_mfma_f32_16x16x32_bf16 v[140:143], a[140:143], a[192:195], v[140:143]
v_mul_f32 v252, v252, v236
v_mul_f32 v253, v253, v236
v_mul_f32 v254, v254, v236
v_mfma_f32_16x16x32_bf16 v[140:143], a[136:139], a[196:199], v[140:143]
ds_read_b128 a[232:235], v7 offset:2752
ds_read_b64 a[168:169], v6 offset:1216
v_mul_f32 v255, v255, v236
v_mfma_f32_16x16x32_bf16 v[140:143], a[132:135], a[200:203], v[140:143]
v_cvt_pk_bf16_f32 v248, v248, v249
v_cvt_pk_bf16_f32 v249, v250, v251
v_cvt_pk_bf16_f32 v250, v252, v253
v_mfma_f32_16x16x32_bf16 v[140:143], a[128:131], a[204:207], v[140:143]
v_cvt_pk_bf16_f32 v251, v254, v255
v_mfma_f32_16x16x32_bf16 v[144:147], a[128:131], a[208:211], v[144:147]
ds_read_b64 a[170:171], v6 offset:1224
ds_read_b128 a[236:239], v7 offset:2240
v_mfma_f32_16x16x32_bf16 v[144:147], a[132:135], a[204:207], v[144:147]
buffer_store_dwordx4 v[248:251], v1, s[44:47], s70 offen offset:3072 sc1
v_mfma_f32_16x16x32_bf16 v[144:147], a[136:139], a[200:203], v[144:147]
s_mov_b32 s73, 0x5d800000
ds_read_b64 a[172:173], v6 offset:1728
ds_read_b64 a[174:175], v6 offset:1736
v_add_f32 v227, v226, v230
v_mfma_f32_16x16x32_bf16 v[144:147], a[140:143], a[196:199], v[144:147]
v_add_f32 v231, v234, v238
v_add_f32 v227, v227, v231
v_cmp_nlt_f32 vcc, v227, s73
v_mfma_f32_16x16x32_bf16 v[144:147], a[144:147], a[192:195], v[144:147]
s_lshl_b32 s73, s58, 2
v_mfma_f32_16x16x32_bf16 v[148:151], a[148:151], a[192:195], v[148:151]
s_add_u32 s73, s73, 163328
ds_read_b128 a[240:243], v7 offset:1728
ds_read_b64 a[176:177], v6 offset:2240
v_mov_b32 v231, s73
v_mfma_f32_16x16x32_bf16 v[148:151], a[144:147], a[196:199], v[148:151]
s_or_b32 s73, vcc_lo, vcc_hi
v_mfma_f32_16x16x32_bf16 v[148:151], a[140:143], a[200:203], v[148:151]
s_min_u32 s73, s73, 1
v_mov_b32 v227, s73
v_mfma_f32_16x16x32_bf16 v[148:151], a[136:139], a[204:207], v[148:151]
ds_read_b64 a[178:179], v6 offset:2248
ds_read_b128 a[244:247], v7 offset:1216
ds_write_b32 v231, v227
v_mfma_f32_16x16x32_bf16 v[148:151], a[132:135], a[208:211], v[148:151]
v_mfma_f32_16x16x32_bf16 v[148:151], a[128:131], a[212:215], v[148:151]
ds_read_b64 a[180:181], v6 offset:2752
ds_read_b64 a[182:183], v6 offset:2760
v_mfma_f32_16x16x32_bf16 v[152:155], a[128:131], a[216:219], v[152:155]
v_mfma_f32_16x16x32_bf16 v[152:155], a[132:135], a[212:215], v[152:155]
v_mfma_f32_16x16x32_bf16 v[152:155], a[136:139], a[208:211], v[152:155]
ds_read_b128 a[248:251], v7 offset:704
ds_read_b64 a[184:185], v6 offset:3264
v_mfma_f32_16x16x32_bf16 v[152:155], a[140:143], a[204:207], v[152:155]
v_mfma_f32_16x16x32_bf16 v[152:155], a[144:147], a[200:203], v[152:155]
s_add_u32 s71, s12, s94
ds_read_b64 a[186:187], v6 offset:3272
ds_read_b128 a[252:255], v7 offset:192
v_mfma_f32_16x16x32_bf16 v[152:155], a[148:151], a[196:199], v[152:155]
s_add_u32 m0, s77, 16384
v_mfma_f32_16x16x32_bf16 v[152:155], a[152:155], a[192:195], v[152:155]
s_add_u32 s72, s71, 0
buffer_load_dwordx4 v15, s[24:27], s72 offen lds
v_mfma_f32_16x16x32_bf16 v[156:159], a[156:159], a[192:195], v[156:159]
ds_read_b64 a[188:189], v6 offset:3776
ds_read_b64 a[190:191], v6 offset:3784
v_mfma_f32_16x16x32_bf16 v[156:159], a[152:155], a[196:199], v[156:159]
v_mfma_f32_16x16x32_bf16 v[156:159], a[148:151], a[200:203], v[156:159]
s_add_u32 s72, s71, 15360
buffer_load_dwordx4 v15, s[24:27], s72 offen offset:1024 lds
v_mfma_f32_16x16x32_bf16 v[156:159], a[144:147], a[204:207], v[156:159]
v_mfma_f32_16x16x32_bf16 v[156:159], a[140:143], a[208:211], v[156:159]
v_mfma_f32_16x16x32_bf16 v[156:159], a[136:139], a[212:215], v[156:159]
v_mfma_f32_16x16x32_bf16 v[156:159], a[132:135], a[216:219], v[156:159]
v_mfma_f32_16x16x32_bf16 v[156:159], a[128:131], a[220:223], v[156:159]
s_waitcnt lgkmcnt(0)
v_mfma_f32_16x16x32_bf16 v[128:131], a[160:163], a[224:227], v[128:131]
s_add_u32 s72, s71, 30720
ds_read_b128 a[192:195], v7 offset:3840
ds_read_b64 a[128:129], v6 offset:256
v_mfma_f32_16x16x32_bf16 v[132:135], a[164:167], a[224:227], v[132:135]
s_waitcnt vmcnt(2) lgkmcnt(10)
buffer_load_dwordx4 v15, s[24:27], s72 offen offset:2048 lds
v_mfma_f32_16x16x32_bf16 v[132:135], a[160:163], a[228:231], v[132:135]
s_barrier
ds_read_b64 a[130:131], v6 offset:264
ds_read_b128 a[196:199], v7 offset:3328
v_mfma_f32_16x16x32_bf16 v[136:139], a[160:163], a[232:235], v[136:139]
v_mov_b32 v244, 163328
v_mfma_f32_16x16x32_bf16 v[136:139], a[164:167], a[228:231], v[136:139]
ds_read_b128 v[240:243], v244
v_mfma_f32_16x16x32_bf16 v[136:139], a[168:171], a[224:227], v[136:139]
ds_read_b64 a[132:133], v6 offset:768
ds_read_b64 a[134:135], v6 offset:776
v_mfma_f32_16x16x32_bf16 v[140:143], a[172:175], a[224:227], v[140:143]
s_add_u32 s72, s71, 46080
buffer_load_dwordx4 v15, s[24:27], s72 offen offset:3072 lds
v_mfma_f32_16x16x32_bf16 v[140:143], a[168:171], a[228:231], v[140:143]
ds_read_b128 a[200:203], v7 offset:2816
ds_read_b64 a[136:137], v6 offset:1280
v_mfma_f32_16x16x32_bf16 v[140:143], a[164:167], a[232:235], v[140:143]
v_mfma_f32_16x16x32_bf16 v[140:143], a[160:163], a[236:239], v[140:143]
s_waitcnt lgkmcnt(4)
v_or3_b32 v240, v240, v241, v242
v_or_b32 v240, v240, v243
v_mfma_f32_16x16x32_bf16 v[144:147], a[160:163], a[240:243], v[144:147]
ds_read_b64 a[138:139], v6 offset:1288
ds_read_b128 a[204:207], v7 offset:2304
v_cmp_lt_u32 vcc, s86, v240
s_cbranch_vccnz Lslow
v_mfma_f32_16x16x32_bf16 v[144:147], a[164:167], a[236:239], v[144:147]
v_or_b32 v240, s58, v0
v_mov_b32 v241, 2
v_mfma_f32_16x16x32_bf16 v[144:147], a[168:171], a[232:235], v[144:147]
s_add_u32 s71, s13, s78
ds_read_b64 a[140:141], v6 offset:1792
ds_read_b64 a[142:143], v6 offset:1800
v_mfma_f32_16x16x32_bf16 v[144:147], a[172:175], a[228:231], v[144:147]
s_add_u32 m0, s77, 32768
v_min_u32 v240, 1, v240
v_lshlrev_b32 v240, 30, v240
v_mfma_f32_16x16x32_bf16 v[144:147], a[176:179], a[224:227], v[144:147]
s_add_u32 s72, s71, 0
buffer_load_dwordx4 v15, s[24:27], s72 offen lds
v_mfma_f32_16x16x32_bf16 v[148:151], a[180:183], a[224:227], v[148:151]
ds_read_b128 a[208:211], v7 offset:1792
ds_read_b64 a[144:145], v6 offset:2304
v_mfma_f32_16x16x32_bf16 v[148:151], a[176:179], a[228:231], v[148:151]
buffer_store_dword v241, v240, s[44:47], s91 offen sc1
v_mfma_f32_16x16x32_bf16 v[148:151], a[172:175], a[232:235], v[148:151]
s_add_u32 s80, s93, 0x3400000
v_and_b32 v166, 7, v0
v_lshlrev_b32 v166, 4, v166
v_mfma_f32_16x16x32_bf16 v[148:151], a[168:171], a[236:239], v[148:151]
s_add_u32 s72, s71, 15360
ds_read_b64 a[146:147], v6 offset:2312
ds_read_b128 a[212:215], v7 offset:1280
v_mfma_f32_16x16x32_bf16 v[148:151], a[164:167], a[240:243], v[148:151]
buffer_load_dwordx4 v15, s[24:27], s72 offen offset:1024 lds
v_mfma_f32_16x16x32_bf16 v[148:151], a[160:163], a[244:247], v[148:151]
ds_read_b64 a[148:149], v6 offset:2816
ds_read_b64 a[150:151], v6 offset:2824
v_mfma_f32_16x16x32_bf16 v[152:155], a[160:163], a[248:251], v[152:155]
v_bfe_u32 v112, v0, 3, 1
v_lshl_add_u32 v166, v112, 8, v166
v_mfma_f32_16x16x32_bf16 v[152:155], a[164:167], a[244:247], v[152:155]
v_bfe_u32 v112, v0, 4, 1
v_lshl_add_u32 v166, v112, 7, v166
v_mfma_f32_16x16x32_bf16 v[152:155], a[168:171], a[240:243], v[152:155]
ds_read_b128 a[216:219], v7 offset:768
ds_read_b64 a[152:153], v6 offset:3328
v_mfma_f32_16x16x32_bf16 v[152:155], a[172:175], a[236:239], v[152:155]
s_add_u32 s72, s71, 30720
buffer_load_dwordx4 v15, s[24:27], s72 offen offset:2048 lds
v_mfma_f32_16x16x32_bf16 v[152:155], a[176:179], a[232:235], v[152:155]
ds_read_b64 a[154:155], v6 offset:3336
ds_read_b128 a[220:223], v7 offset:256
v_mfma_f32_16x16x32_bf16 v[152:155], a[180:183], a[228:231], v[152:155]
v_lshrrev_b32 v112, 5, v0
v_lshl_add_u32 v166, v112, 9, v166
v_mfma_f32_16x16x32_bf16 v[152:155], a[184:187], a[224:227], v[152:155]
v_and_b32 v112, 15, v0
v_lshrrev_b32 v113, 2, v0
v_mfma_f32_16x16x32_bf16 v[156:159], a[188:191], a[224:227], v[156:159]
ds_read_b64 a[156:157], v6 offset:3840
ds_read_b64 a[158:159], v6 offset:3848
v_mfma_f32_16x16x32_bf16 v[156:159], a[184:187], a[228:231], v[156:159]
v_bfe_u32 v114, v0, 3, 2
v_and_b32 v115, 3, v0
v_mfma_f32_16x16x32_bf16 v[156:159], a[180:183], a[232:235], v[156:159]
s_add_u32 s72, s71, 46080
buffer_load_dwordx4 v15, s[24:27], s72 offen offset:3072 lds
v_mfma_f32_16x16x32_bf16 v[156:159], a[176:179], a[236:239], v[156:159]
v_lshlrev_b32 v8, 7, v113
v_lshl_add_u32 v8, v114, 5, v8
v_mfma_f32_16x16x32_bf16 v[156:159], a[172:175], a[240:243], v[156:159]
v_lshl_add_u32 v8, v115, 3, v8
v_add_u32 v8, s77, v8
v_mfma_f32_16x16x32_bf16 v[156:159], a[168:171], a[244:247], v[156:159]
v_subrev_u32 v8, s64, v8
v_xor_b32 v9, 32, v8
v_mfma_f32_16x16x32_bf16 v[156:159], a[164:167], a[248:251], v[156:159]
v_lshrrev_b32 v2, 4, v0
v_lshlrev_b32 v2, 10, v2
v_mfma_f32_16x16x32_bf16 v[156:159], a[160:163], a[252:255], v[156:159]
s_waitcnt lgkmcnt(0)
v_xor_b32 v10, 64, v8
v_xor_b32 v11, 0x60, v8
v_mfma_f32_16x16x32_bf16 v[128:131], a[128:131], a[192:195], v[128:131]
s_add_u32 s71, s13, s94
ds_read_b128 a[224:227], v7 offset:3904
ds_read_b64 a[160:161], v6 offset:320
v_mfma_f32_16x16x32_bf16 v[132:135], a[132:135], a[192:195], v[132:135]
s_add_u32 m0, s77, 49152
v_lshlrev_b32 v5, 8, v113
v_and_b32 v114, 1, v0
v_mfma_f32_16x16x32_bf16 v[132:135], a[128:131], a[196:199], v[132:135]
s_add_u32 s72, s71, 0
ds_read_b64 a[162:163], v6 offset:328
ds_read_b128 a[228:231], v7 offset:3392
v_mfma_f32_16x16x32_bf16 v[136:139], a[128:131], a[200:203], v[136:139]
s_add_u32 s82, s59, 4
buffer_load_dwordx4 v15, s[24:27], s72 offen lds
v_mfma_f32_16x16x32_bf16 v[136:139], a[132:135], a[196:199], v[136:139]
s_and_b32 s82, s82, 28
v_lshl_add_u32 v5, v114, 7, v5
v_bfe_u32 v114, v0, 1, 1
v_mfma_f32_16x16x32_bf16 v[136:139], a[136:139], a[192:195], v[136:139]
s_lshl_b32 s82, s82, 10
ds_read_b64 a[164:165], v6 offset:832
ds_read_b64 a[166:167], v6 offset:840
v_mfma_f32_16x16x32_bf16 v[140:143], a[140:143], a[192:195], v[140:143]
s_add_u32 s72, s71, 15360
buffer_load_dwordx4 v15, s[24:27], s72 offen offset:1024 lds
v_mfma_f32_16x16x32_bf16 v[140:143], a[136:139], a[196:199], v[140:143]
s_add_u32 s82, s82, s74
ds_read_b128 a[232:235], v7 offset:2880
ds_read_b64 a[168:169], v6 offset:1344
v_mfma_f32_16x16x32_bf16 v[140:143], a[132:135], a[200:203], v[140:143]
buffer_load_dword v3, v2, s[44:47], s82 offen sc1
v_mfma_f32_16x16x32_bf16 v[140:143], a[128:131], a[204:207], v[140:143]
v_lshl_add_u32 v5, v114, 3, v5
v_mov_b32 v114, s58
v_mfma_f32_16x16x32_bf16 v[144:147], a[128:131], a[208:211], v[144:147]
ds_read_b64 a[170:171], v6 offset:1352
ds_read_b128 a[236:239], v7 offset:2368
v_mfma_f32_16x16x32_bf16 v[144:147], a[132:135], a[204:207], v[144:147]
v_lshl_add_u32 v5, v114, 5, v5
v_add_u32 v5, 147456, v5
v_mfma_f32_16x16x32_bf16 v[144:147], a[136:139], a[200:203], v[144:147]
s_add_u32 s72, s71, 30720
ds_read_b64 a[172:173], v6 offset:1856
ds_read_b64 a[174:175], v6 offset:1864
v_mfma_f32_16x16x32_bf16 v[144:147], a[140:143], a[196:199], v[144:147]
buffer_load_dwordx4 v15, s[24:27], s72 offen offset:2048 lds
v_mfma_f32_16x16x32_bf16 v[144:147], a[144:147], a[192:195], v[144:147]
v_bfe_u32 v114, v0, 1, 2
v_lshrrev_b32 v115, 4, v0
v_mfma_f32_16x16x32_bf16 v[148:151], a[148:151], a[192:195], v[148:151]
ds_read_b128 a[240:243], v7 offset:1856
ds_read_b64 a[176:177], v6 offset:2368
v_mfma_f32_16x16x32_bf16 v[148:151], a[144:147], a[196:199], v[148:151]
v_lshlrev_b32 v116, 7, v112
v_lshl_add_u32 v116, v114, 5, v116
v_mfma_f32_16x16x32_bf16 v[148:151], a[140:143], a[200:203], v[148:151]
v_lshl_add_u32 v116, v115, 3, v116
v_add_u32 v116, s64, v116
v_mfma_f32_16x16x32_bf16 v[148:151], a[136:139], a[204:207], v[148:151]
s_add_u32 s72, s71, 46080
ds_read_b64 a[178:179], v6 offset:2376
ds_read_b128 a[244:247], v7 offset:1344
v_mfma_f32_16x16x32_bf16 v[148:151], a[132:135], a[208:211], v[148:151]
buffer_load_dwordx4 v15, s[24:27], s72 offen offset:3072 lds
v_mfma_f32_16x16x32_bf16 v[148:151], a[128:131], a[212:215], v[148:151]
ds_read_b64 a[180:181], v6 offset:2880
ds_read_b64 a[182:183], v6 offset:2888
v_mfma_f32_16x16x32_bf16 v[152:155], a[128:131], a[216:219], v[152:155]
v_add_u32 v116, 131072, v116
v_xor_b32 v117, 32, v116
v_mfma_f32_16x16x32_bf16 v[152:155], a[132:135], a[212:215], v[152:155]
v_xor_b32 v118, 64, v116
v_xor_b32 v119, 0x60, v116
v_mfma_f32_16x16x32_bf16 v[152:155], a[136:139], a[208:211], v[152:155]
ds_read_b128 a[248:251], v7 offset:832
ds_read_b64 a[184:185], v6 offset:3392
v_mfma_f32_16x16x32_bf16 v[152:155], a[140:143], a[204:207], v[152:155]
v_mfma_f32_16x16x32_bf16 v[152:155], a[144:147], a[200:203], v[152:155]
ds_read_b64 a[186:187], v6 offset:3400
ds_read_b128 a[252:255], v7 offset:320
v_mfma_f32_16x16x32_bf16 v[152:155], a[148:151], a[196:199], v[152:155]
v_mfma_f32_16x16x32_bf16 v[152:155], a[152:155], a[192:195], v[152:155]
v_mfma_f32_16x16x32_bf16 v[156:159], a[156:159], a[192:195], v[156:159]
ds_read_b64 a[188:189], v6 offset:3904
ds_read_b64 a[190:191], v6 offset:3912
v_mfma_f32_16x16x32_bf16 v[156:159], a[152:155], a[196:199], v[156:159]
v_mfma_f32_16x16x32_bf16 v[156:159], a[148:151], a[200:203], v[156:159]
v_mfma_f32_16x16x32_bf16 v[156:159], a[144:147], a[204:207], v[156:159]
v_mfma_f32_16x16x32_bf16 v[156:159], a[140:143], a[208:211], v[156:159]
v_mfma_f32_16x16x32_bf16 v[156:159], a[136:139], a[212:215], v[156:159]
v_mfma_f32_16x16x32_bf16 v[156:159], a[132:135], a[216:219], v[156:159]
v_mfma_f32_16x16x32_bf16 v[156:159], a[128:131], a[220:223], v[156:159]
s_waitcnt lgkmcnt(0)
v_mfma_f32_16x16x32_bf16 v[128:131], a[160:163], a[224:227], v[128:131]
ds_read_b128 a[192:195], v7 offset:3968
ds_read_b64 a[128:129], v6 offset:384
v_mfma_f32_16x16x32_bf16 v[132:135], a[164:167], a[224:227], v[132:135]
v_mfma_f32_16x16x32_bf16 v[132:135], a[160:163], a[228:231], v[132:135]
ds_read_b64 a[130:131], v6 offset:392
ds_read_b128 a[196:199], v7 offset:3456
v_mfma_f32_16x16x32_bf16 v[136:139], a[160:163], a[232:235], v[136:139]
v_mfma_f32_16x16x32_bf16 v[136:139], a[164:167], a[228:231], v[136:139]
v_mfma_f32_16x16x32_bf16 v[136:139], a[168:171], a[224:227], v[136:139]
ds_read_b64 a[132:133], v6 offset:896
ds_read_b64 a[134:135], v6 offset:904
v_mfma_f32_16x16x32_bf16 v[140:143], a[172:175], a[224:227], v[140:143]
v_mfma_f32_16x16x32_bf16 v[140:143], a[168:171], a[228:231], v[140:143]
ds_read_b128 a[200:203], v7 offset:2944
ds_read_b64 a[136:137], v6 offset:1408
v_mfma_f32_16x16x32_bf16 v[140:143], a[164:167], a[232:235], v[140:143]
v_mfma_f32_16x16x32_bf16 v[140:143], a[160:163], a[236:239], v[140:143]
v_mfma_f32_16x16x32_bf16 v[144:147], a[160:163], a[240:243], v[144:147]
ds_read_b64 a[138:139], v6 offset:1416
ds_read_b128 a[204:207], v7 offset:2432
v_mfma_f32_16x16x32_bf16 v[144:147], a[164:167], a[236:239], v[144:147]
v_mfma_f32_16x16x32_bf16 v[144:147], a[168:171], a[232:235], v[144:147]
ds_read_b64 a[140:141], v6 offset:1920
ds_read_b64 a[142:143], v6 offset:1928
v_mfma_f32_16x16x32_bf16 v[144:147], a[172:175], a[228:231], v[144:147]
v_mfma_f32_16x16x32_bf16 v[144:147], a[176:179], a[224:227], v[144:147]
v_mfma_f32_16x16x32_bf16 v[148:151], a[180:183], a[224:227], v[148:151]
ds_read_b128 a[208:211], v7 offset:1920
ds_read_b64 a[144:145], v6 offset:2432
v_mfma_f32_16x16x32_bf16 v[148:151], a[176:179], a[228:231], v[148:151]
v_mfma_f32_16x16x32_bf16 v[148:151], a[172:175], a[232:235], v[148:151]
s_waitcnt vmcnt(2)
v_cmp_gt_u32 vcc, 2, v3
s_or_b32 s81, vcc_lo, vcc_hi
s_cselect_b32 s81, 0x40000000, 0
v_or_b32 v4, s81, v1
v_mfma_f32_16x16x32_bf16 v[148:151], a[168:171], a[236:239], v[148:151]
ds_read_b64 a[146:147], v6 offset:2440
ds_read_b128 a[212:215], v7 offset:1408
v_mfma_f32_16x16x32_bf16 v[148:151], a[164:167], a[240:243], v[148:151]
v_mfma_f32_16x16x32_bf16 v[148:151], a[160:163], a[244:247], v[148:151]
ds_read_b64 a[148:149], v6 offset:2944
ds_read_b64 a[150:151], v6 offset:2952
v_mfma_f32_16x16x32_bf16 v[152:155], a[160:163], a[248:251], v[152:155]
v_mfma_f32_16x16x32_bf16 v[152:155], a[164:167], a[244:247], v[152:155]
v_mfma_f32_16x16x32_bf16 v[152:155], a[168:171], a[240:243], v[152:155]
s_lshr_b32 s69, s12, 6
ds_read_b128 a[216:219], v7 offset:896
ds_read_b64 a[152:153], v6 offset:3456
v_mfma_f32_16x16x32_bf16 v[152:155], a[172:175], a[236:239], v[152:155]
s_add_u32 s69, s69, s95
buffer_load_dwordx4 a[0:3], v4, s[44:47], s69 offen sc1
v_mfma_f32_16x16x32_bf16 v[152:155], a[176:179], a[232:235], v[152:155]
ds_read_b64 a[154:155], v6 offset:3464
ds_read_b128 a[220:223], v7 offset:384
v_mfma_f32_16x16x32_bf16 v[152:155], a[180:183], a[228:231], v[152:155]
v_mfma_f32_16x16x32_bf16 v[152:155], a[184:187], a[224:227], v[152:155]
buffer_load_dwordx4 a[4:7], v4, s[44:47], s69 offen offset:1024 sc1
v_mfma_f32_16x16x32_bf16 v[156:159], a[188:191], a[224:227], v[156:159]
ds_read_b64 a[156:157], v6 offset:3968
ds_read_b64 a[158:159], v6 offset:3976
v_mfma_f32_16x16x32_bf16 v[156:159], a[184:187], a[228:231], v[156:159]
v_mfma_f32_16x16x32_bf16 v[156:159], a[180:183], a[232:235], v[156:159]
v_mfma_f32_16x16x32_bf16 v[156:159], a[176:179], a[236:239], v[156:159]
v_mfma_f32_16x16x32_bf16 v[156:159], a[172:175], a[240:243], v[156:159]
buffer_load_dwordx4 a[8:11], v4, s[44:47], s69 offen offset:2048 sc1
v_mfma_f32_16x16x32_bf16 v[156:159], a[168:171], a[244:247], v[156:159]
v_mfma_f32_16x16x32_bf16 v[156:159], a[164:167], a[248:251], v[156:159]
v_mfma_f32_16x16x32_bf16 v[156:159], a[160:163], a[252:255], v[156:159]
s_waitcnt lgkmcnt(0)
v_mfma_f32_16x16x32_bf16 v[128:131], a[128:131], a[192:195], v[128:131]
ds_read_b128 a[224:227], v7 offset:4032
ds_read_b64 a[160:161], v6 offset:448
v_mfma_f32_16x16x32_bf16 v[132:135], a[132:135], a[192:195], v[132:135]
buffer_load_dwordx4 a[12:15], v4, s[44:47], s69 offen offset:3072 sc1
v_mfma_f32_16x16x32_bf16 v[132:135], a[128:131], a[196:199], v[132:135]
ds_read_b64 a[162:163], v6 offset:456
ds_read_b128 a[228:231], v7 offset:3520
v_mfma_f32_16x16x32_bf16 v[136:139], a[128:131], a[200:203], v[136:139]
v_mfma_f32_16x16x32_bf16 v[136:139], a[132:135], a[196:199], v[136:139]
v_mfma_f32_16x16x32_bf16 v[136:139], a[136:139], a[192:195], v[136:139]
ds_read_b64 a[164:165], v6 offset:960
ds_read_b64 a[166:167], v6 offset:968
v_mfma_f32_16x16x32_bf16 v[140:143], a[140:143], a[192:195], v[140:143]
s_add_u32 s69, s69, 0x20000
buffer_load_dwordx4 a[16:19], v4, s[44:47], s69 offen sc1
v_mfma_f32_16x16x32_bf16 v[140:143], a[136:139], a[196:199], v[140:143]
ds_read_b128 a[232:235], v7 offset:3008
ds_read_b64 a[168:169], v6 offset:1472
v_mfma_f32_16x16x32_bf16 v[140:143], a[132:135], a[200:203], v[140:143]
v_mfma_f32_16x16x32_bf16 v[140:143], a[128:131], a[204:207], v[140:143]
v_mfma_f32_16x16x32_bf16 v[144:147], a[128:131], a[208:211], v[144:147]
ds_read_b64 a[170:171], v6 offset:1480
ds_read_b128 a[236:239], v7 offset:2496
v_mfma_f32_16x16x32_bf16 v[144:147], a[132:135], a[204:207], v[144:147]
buffer_load_dwordx4 a[20:23], v4, s[44:47], s69 offen offset:1024 sc1
v_mfma_f32_16x16x32_bf16 v[144:147], a[136:139], a[200:203], v[144:147]
ds_read_b64 a[172:173], v6 offset:1984
ds_read_b64 a[174:175], v6 offset:1992
v_mfma_f32_16x16x32_bf16 v[144:147], a[140:143], a[196:199], v[144:147]
v_mfma_f32_16x16x32_bf16 v[144:147], a[144:147], a[192:195], v[144:147]
v_mfma_f32_16x16x32_bf16 v[148:151], a[148:151], a[192:195], v[148:151]
ds_read_b128 a[240:243], v7 offset:1984
ds_read_b64 a[176:177], v6 offset:2496
v_mfma_f32_16x16x32_bf16 v[148:151], a[144:147], a[196:199], v[148:151]
buffer_load_dwordx4 a[24:27], v4, s[44:47], s69 offen offset:2048 sc1
v_mfma_f32_16x16x32_bf16 v[148:151], a[140:143], a[200:203], v[148:151]
v_mfma_f32_16x16x32_bf16 v[148:151], a[136:139], a[204:207], v[148:151]
ds_read_b64 a[178:179], v6 offset:2504
ds_read_b128 a[244:247], v7 offset:1472
v_mfma_f32_16x16x32_bf16 v[148:151], a[132:135], a[208:211], v[148:151]
v_mfma_f32_16x16x32_bf16 v[148:151], a[128:131], a[212:215], v[148:151]
ds_read_b64 a[180:181], v6 offset:3008
ds_read_b64 a[182:183], v6 offset:3016
v_mfma_f32_16x16x32_bf16 v[152:155], a[128:131], a[216:219], v[152:155]
buffer_load_dwordx4 a[28:31], v4, s[44:47], s69 offen offset:3072 sc1
v_mfma_f32_16x16x32_bf16 v[152:155], a[132:135], a[212:215], v[152:155]
v_mfma_f32_16x16x32_bf16 v[152:155], a[136:139], a[208:211], v[152:155]
s_add_u32 s79, s59, 12
ds_read_b128 a[248:251], v7 offset:960
ds_read_b64 a[184:185], v6 offset:3520
v_mfma_f32_16x16x32_bf16 v[152:155], a[140:143], a[204:207], v[152:155]
s_and_b32 s79, s79, 28
v_mfma_f32_16x16x32_bf16 v[152:155], a[144:147], a[200:203], v[152:155]
s_lshl_b32 s79, s79, 10
ds_read_b64 a[186:187], v6 offset:3528
ds_read_b128 a[252:255], v7 offset:448
v_mfma_f32_16x16x32_bf16 v[152:155], a[148:151], a[196:199], v[152:155]
s_add_u32 s79, s79, s74
buffer_load_dword v14, v2, s[44:47], s79 offen sc1
v_mfma_f32_16x16x32_bf16 v[152:155], a[152:155], a[192:195], v[152:155]
v_mfma_f32_16x16x32_bf16 v[156:159], a[156:159], a[192:195], v[156:159]
ds_read_b64 a[188:189], v6 offset:4032
ds_read_b64 a[190:191], v6 offset:4040
v_mfma_f32_16x16x32_bf16 v[156:159], a[152:155], a[196:199], v[156:159]
s_lshr_b32 s69, s13, 6
v_mfma_f32_16x16x32_bf16 v[156:159], a[148:151], a[200:203], v[156:159]
s_add_u32 s69, s69, s95
buffer_load_dwordx4 a[32:35], v4, s[44:47], s69 offen sc1
v_mfma_f32_16x16x32_bf16 v[156:159], a[144:147], a[204:207], v[156:159]
v_mfma_f32_16x16x32_bf16 v[156:159], a[140:143], a[208:211], v[156:159]
v_mfma_f32_16x16x32_bf16 v[156:159], a[136:139], a[212:215], v[156:159]
v_mfma_f32_16x16x32_bf16 v[156:159], a[132:135], a[216:219], v[156:159]
v_mfma_f32_16x16x32_bf16 v[156:159], a[128:131], a[220:223], v[156:159]
s_waitcnt lgkmcnt(0)
buffer_load_dwordx4 a[36:39], v4, s[44:47], s69 offen offset:1024 sc1
v_mfma_f32_16x16x32_bf16 v[128:131], a[160:163], a[224:227], v[128:131]
ds_read_b64_tr_b16 v[192:193], v8 offset:0
ds_read_b64_tr_b16 v[194:195], v8 offset:2048
v_mfma_f32_16x16x32_bf16 v[132:135], a[164:167], a[224:227], v[132:135]
v_mfma_f32_16x16x32_bf16 v[132:135], a[160:163], a[228:231], v[132:135]
ds_read_b64_tr_b16 v[196:197], v9 offset:0
ds_read_b64_tr_b16 v[198:199], v9 offset:2048
v_mfma_f32_16x16x32_bf16 v[136:139], a[160:163], a[232:235], v[136:139]
v_mfma_f32_16x16x32_bf16 v[136:139], a[164:167], a[228:231], v[136:139]
ds_read_b64_tr_b16 v[200:201], v10 offset:0
ds_read_b64_tr_b16 v[202:203], v10 offset:2048
v_mfma_f32_16x16x32_bf16 v[136:139], a[168:171], a[224:227], v[136:139]
buffer_load_dwordx4 a[40:43], v4, s[44:47], s69 offen offset:2048 sc1
v_mfma_f32_16x16x32_bf16 v[140:143], a[172:175], a[224:227], v[140:143]
ds_read_b64_tr_b16 v[204:205], v11 offset:0
ds_read_b64_tr_b16 v[206:207], v11 offset:2048
v_mfma_f32_16x16x32_bf16 v[140:143], a[168:171], a[228:231], v[140:143]
v_cvt_pk_bf16_f32 v128, v128, v129
v_cvt_pk_bf16_f32 v129, v130, v131
v_cvt_pk_bf16_f32 v130, v132, v133
v_mfma_f32_16x16x32_bf16 v[140:143], a[164:167], a[232:235], v[140:143]
ds_read_b64_tr_b16 v[208:209], v8 offset:4096
ds_read_b64_tr_b16 v[210:211], v8 offset:6144
v_cvt_pk_bf16_f32 v131, v134, v135
v_mfma_f32_16x16x32_bf16 v[140:143], a[160:163], a[236:239], v[140:143]
buffer_load_dwordx4 a[44:47], v4, s[44:47], s69 offen offset:3072 sc1
v_permlane32_swap_b32 v128, v130
v_mfma_f32_16x16x32_bf16 v[144:147], a[160:163], a[240:243], v[144:147]
ds_read_b64_tr_b16 v[212:213], v9 offset:4096
ds_read_b64_tr_b16 v[214:215], v9 offset:6144
v_permlane32_swap_b32 v129, v131
v_mfma_f32_16x16x32_bf16 v[144:147], a[164:167], a[236:239], v[144:147]
buffer_store_dwordx4 v[128:131], v166, s[44:47], s80 offen sc1
v_mfma_f32_16x16x32_bf16 v[144:147], a[168:171], a[232:235], v[144:147]
ds_read_b64_tr_b16 v[216:217], v10 offset:4096
ds_read_b64_tr_b16 v[218:219], v10 offset:6144
v_mfma_f32_16x16x32_bf16 v[144:147], a[172:175], a[228:231], v[144:147]
v_mfma_f32_16x16x32_bf16 v[144:147], a[176:179], a[224:227], v[144:147]
ds_read_b64_tr_b16 v[220:221], v11 offset:4096
ds_read_b64_tr_b16 v[222:223], v11 offset:6144
v_cvt_pk_bf16_f32 v136, v136, v137
v_mfma_f32_16x16x32_bf16 v[148:151], a[180:183], a[224:227], v[148:151]
s_add_u32 s69, s69, 0x20000
buffer_load_dwordx4 a[48:51], v4, s[44:47], s69 offen sc1
v_cvt_pk_bf16_f32 v137, v138, v139
v_mfma_f32_16x16x32_bf16 v[148:151], a[176:179], a[228:231], v[148:151]
ds_read_b64_tr_b16 v[224:225], v8 offset:8192
ds_read_b64_tr_b16 v[226:227], v8 offset:10240
v_cvt_pk_bf16_f32 v138, v140, v141
v_mfma_f32_16x16x32_bf16 v[148:151], a[172:175], a[232:235], v[148:151]
v_cvt_pk_bf16_f32 v139, v142, v143
v_permlane32_swap_b32 v136, v138
s_nop 0
v_permlane32_swap_b32 v137, v139
v_mfma_f32_16x16x32_bf16 v[148:151], a[168:171], a[236:239], v[148:151]
ds_read_b64_tr_b16 v[228:229], v9 offset:8192
ds_read_b64_tr_b16 v[230:231], v9 offset:10240
v_mfma_f32_16x16x32_bf16 v[148:151], a[164:167], a[240:243], v[148:151]
buffer_load_dwordx4 a[52:55], v4, s[44:47], s69 offen offset:1024 sc1
v_mfma_f32_16x16x32_bf16 v[148:151], a[160:163], a[244:247], v[148:151]
ds_read_b64_tr_b16 v[232:233], v10 offset:8192
ds_read_b64_tr_b16 v[234:235], v10 offset:10240
v_mfma_f32_16x16x32_bf16 v[152:155], a[160:163], a[248:251], v[152:155]
Lstub9:
s_cbranch_execz Lret
buffer_store_dwordx4 v[136:139], v166, s[44:47], s80 offen offset:1024 sc1
v_mfma_f32_16x16x32_bf16 v[152:155], a[164:167], a[244:247], v[152:155]
ds_read_b64_tr_b16 v[236:237], v11 offset:8192
ds_read_b64_tr_b16 v[238:239], v11 offset:10240
v_mfma_f32_16x16x32_bf16 v[152:155], a[168:171], a[240:243], v[152:155]
v_mfma_f32_16x16x32_bf16 v[152:155], a[172:175], a[236:239], v[152:155]
ds_read_b64_tr_b16 v[240:241], v8 offset:12288
ds_read_b64_tr_b16 v[242:243], v8 offset:14336
v_mfma_f32_16x16x32_bf16 v[152:155], a[176:179], a[232:235], v[152:155]
buffer_load_dwordx4 a[56:59], v4, s[44:47], s69 offen offset:2048 sc1
v_cvt_pk_bf16_f32 v144, v144, v145
v_mfma_f32_16x16x32_bf16 v[152:155], a[180:183], a[228:231], v[152:155]
ds_read_b64_tr_b16 v[244:245], v9 offset:12288
ds_read_b64_tr_b16 v[246:247], v9 offset:14336
v_cvt_pk_bf16_f32 v145, v146, v147
v_mfma_f32_16x16x32_bf16 v[152:155], a[184:187], a[224:227], v[152:155]
v_cvt_pk_bf16_f32 v146, v148, v149
v_cvt_pk_bf16_f32 v147, v150, v151
s_nop 0
v_permlane32_swap_b32 v144, v146
v_mfma_f32_16x16x32_bf16 v[156:159], a[188:191], a[224:227], v[156:159]
ds_read_b64_tr_b16 v[248:249], v10 offset:12288
ds_read_b64_tr_b16 v[250:251], v10 offset:14336
v_permlane32_swap_b32 v145, v147
v_mfma_f32_16x16x32_bf16 v[156:159], a[184:187], a[228:231], v[156:159]
buffer_load_dwordx4 a[60:63], v4, s[44:47], s69 offen offset:3072 sc1
v_mfma_f32_16x16x32_bf16 v[156:159], a[180:183], a[232:235], v[156:159]
ds_read_b64_tr_b16 v[252:253], v11 offset:12288
ds_read_b64_tr_b16 v[254:255], v11 offset:14336
v_mfma_f32_16x16x32_bf16 v[156:159], a[176:179], a[236:239], v[156:159]
buffer_store_dwordx4 v[144:147], v166, s[44:47], s80 offen offset:2048 sc1
v_mfma_f32_16x16x32_bf16 v[156:159], a[172:175], a[240:243], v[156:159]
v_mfma_f32_16x16x32_bf16 v[156:159], a[168:171], a[244:247], v[156:159]
v_mfma_f32_16x16x32_bf16 v[156:159], a[164:167], a[248:251], v[156:159]
v_mfma_f32_16x16x32_bf16 v[156:159], a[160:163], a[252:255], v[156:159]
v_cvt_pk_bf16_f32 v152, v152, v153
v_cvt_pk_bf16_f32 v153, v154, v155
s_nop 5
v_cvt_pk_bf16_f32 v154, v156, v157
v_cvt_pk_bf16_f32 v155, v158, v159
s_nop 0
v_permlane32_swap_b32 v152, v154
v_permlane32_swap_b32 v153, v155
buffer_store_dwordx4 v[152:155], v166, s[44:47], s80 offen offset:3072 sc1
s_waitcnt vmcnt(13) lgkmcnt(0)
s_cmp_lg_u32 s81, 0
s_cbranch_scc1 Lredo0
Lredo0b:
s_barrier
v_mfma_f32_16x16x32_bf16 v[48:51], v[192:195], a[0:3], 0
s_nop 0
ds_read_b64_tr_b16 v[128:129], v8 offset:16384
ds_read_b64_tr_b16 v[130:131], v8 offset:18432
v_mfma_f32_16x16x32_bf16 v[48:51], v[208:211], a[4:7], v[48:51]
s_add_u32 s71, s14, s78
ds_read_b64_tr_b16 v[132:133], v9 offset:16384
ds_read_b64_tr_b16 v[134:135], v9 offset:18432
v_mfma_f32_16x16x32_bf16 v[48:51], v[224:227], a[8:11], v[48:51]
s_add_u32 m0, s77, 0
ds_read_b64_tr_b16 v[136:137], v10 offset:16384
ds_read_b64_tr_b16 v[138:139], v10 offset:18432
v_mfma_f32_16x16x32_bf16 v[48:51], v[240:243], a[12:15], v[48:51]
s_add_u32 s72, s71, 0
buffer_load_dwordx4 v15, s[24:27], s72 offen lds
v_mfma_f32_16x16x32_bf16 v[64:67], v[240:243], a[28:31], 0
s_nop 0
ds_read_b64_tr_b16 v[140:141], v11 offset:16384
ds_read_b64_tr_b16 v[142:143], v11 offset:18432
v_mfma_f32_16x16x32_bf16 v[64:67], v[224:227], a[24:27], v[64:67]
s_lshr_b32 s69, s14, 6
ds_read_b64_tr_b16 v[144:145], v8 offset:20480
ds_read_b64_tr_b16 v[146:147], v8 offset:22528
v_mfma_f32_16x16x32_bf16 v[64:67], v[208:211], a[20:23], v[64:67]
s_add_u32 s69, s69, s95
buffer_load_dwordx4 a[64:67], v1, s[44:47], s69 offen sc1
v_mfma_f32_16x16x32_bf16 v[64:67], v[192:195], a[16:19], v[64:67]
s_nop 0
ds_read_b64_tr_b16 v[148:149], v9 offset:20480
ds_read_b64_tr_b16 v[150:151], v9 offset:22528
v_mfma_f32_16x16x32_bf16 v[68:71], v[196:199], a[16:19], 0
v_mfma_f32_16x16x32_bf16 v[68:71], v[212:215], a[20:23], v[68:71]
s_nop 0
ds_read_b64_tr_b16 v[152:153], v10 offset:20480
ds_read_b64_tr_b16 v[154:155], v10 offset:22528
v_mfma_f32_16x16x32_bf16 v[68:71], v[228:231], a[24:27], v[68:71]
s_add_u32 s72, s71, 15360
buffer_load_dwordx4 v15, s[24:27], s72 offen offset:1024 lds
v_mfma_f32_16x16x32_bf16 v[68:71], v[244:247], a[28:31], v[68:71]
s_nop 0
ds_read_b64_tr_b16 v[156:157], v11 offset:20480
ds_read_b64_tr_b16 v[158:159], v11 offset:22528
v_mfma_f32_16x16x32_bf16 v[52:55], v[244:247], a[12:15], 0
buffer_load_dwordx4 a[68:71], v1, s[44:47], s69 offen offset:1024 sc1
v_mfma_f32_16x16x32_bf16 v[52:55], v[228:231], a[8:11], v[52:55]
s_nop 0
ds_read_b64_tr_b16 v[160:161], v8 offset:24576
ds_read_b64_tr_b16 v[162:163], v8 offset:26624
v_mfma_f32_16x16x32_bf16 v[52:55], v[212:215], a[4:7], v[52:55]
s_nop 0
ds_read_b64_tr_b16 v[164:165], v9 offset:24576
ds_read_b64_tr_b16 v[166:167], v9 offset:26624
v_mfma_f32_16x16x32_bf16 v[52:55], v[196:199], a[0:3], v[52:55]
s_nop 0
ds_read_b64_tr_b16 v[168:169], v10 offset:24576
ds_read_b64_tr_b16 v[170:171], v10 offset:26624
v_mfma_f32_16x16x32_bf16 v[56:59], v[200:203], a[0:3], 0
v_mfma_f32_16x16x32_bf16 v[56:59], v[216:219], a[4:7], v[56:59]
s_add_u32 s72, s71, 30720
buffer_load_dwordx4 v15, s[24:27], s72 offen offset:2048 lds
v_mfma_f32_16x16x32_bf16 v[56:59], v[232:235], a[8:11], v[56:59]
s_nop 0
ds_read_b64_tr_b16 v[172:173], v11 offset:24576
ds_read_b64_tr_b16 v[174:175], v11 offset:26624
v_mfma_f32_16x16x32_bf16 v[56:59], v[248:251], a[12:15], v[56:59]
buffer_load_dwordx4 a[72:75], v1, s[44:47], s69 offen offset:2048 sc1
v_mfma_f32_16x16x32_bf16 v[72:75], v[248:251], a[28:31], 0
s_nop 0
ds_read_b64_tr_b16 v[176:177], v8 offset:28672
ds_read_b64_tr_b16 v[178:179], v8 offset:30720
v_mfma_f32_16x16x32_bf16 v[72:75], v[232:235], a[24:27], v[72:75]
s_nop 0
ds_read_b64_tr_b16 v[180:181], v9 offset:28672
ds_read_b64_tr_b16 v[182:183], v9 offset:30720
v_mfma_f32_16x16x32_bf16 v[72:75], v[216:219], a[20:23], v[72:75]
s_nop 0
ds_read_b64_tr_b16 v[184:185], v10 offset:28672
ds_read_b64_tr_b16 v[186:187], v10 offset:30720
v_mfma_f32_16x16x32_bf16 v[72:75], v[200:203], a[16:19], v[72:75]
s_nop 0
ds_read_b64_tr_b16 v[188:189], v11 offset:28672
ds_read_b64_tr_b16 v[190:191], v11 offset:30720
v_mfma_f32_16x16x32_bf16 v[76:79], v[204:207], a[16:19], 0
s_add_u32 s72, s71, 46080
buffer_load_dwordx4 v15, s[24:27], s72 offen offset:3072 lds
v_mfma_f32_16x16x32_bf16 v[76:79], v[220:223], a[20:23], v[76:79]
v_mfma_f32_16x16x32_bf16 v[76:79], v[236:239], a[24:27], v[76:79]
buffer_load_dwordx4 a[76:79], v1, s[44:47], s69 offen offset:3072 sc1
v_mfma_f32_16x16x32_bf16 v[76:79], v[252:255], a[28:31], v[76:79]
v_mfma_f32_16x16x32_bf16 v[60:63], v[252:255], a[12:15], 0
v_mfma_f32_16x16x32_bf16 v[60:63], v[236:239], a[8:11], v[60:63]
v_mfma_f32_16x16x32_bf16 v[60:63], v[220:223], a[4:7], v[60:63]
s_waitcnt vmcnt(16) lgkmcnt(0)
v_mfma_f32_16x16x32_bf16 v[60:63], v[204:207], a[0:3], v[60:63]
s_barrier
v_mfma_f32_16x16x32_bf16 v[16:19], v[128:131], a[0:3], 0
s_add_u32 s69, s69, 0x20000
ds_read_b64_tr_b16 v[192:193], v8 offset:32768
ds_read_b64_tr_b16 v[194:195], v8 offset:34816
v_mfma_f32_16x16x32_bf16 v[16:19], v[144:147], a[4:7], v[16:19]
s_add_u32 s71, s14, s94
buffer_load_dwordx4 a[80:83], v1, s[44:47], s69 offen sc1
v_mfma_f32_16x16x32_bf16 v[16:19], v[160:163], a[8:11], v[16:19]
s_add_u32 m0, s77, 16384
ds_read_b64_tr_b16 v[196:197], v9 offset:32768
ds_read_b64_tr_b16 v[198:199], v9 offset:34816
v_mfma_f32_16x16x32_bf16 v[16:19], v[176:179], a[12:15], v[16:19]
s_add_u32 s72, s71, 0
buffer_load_dwordx4 v15, s[24:27], s72 offen lds
v_mfma_f32_16x16x32_bf16 v[32:35], v[176:179], a[28:31], 0
s_nop 0
ds_read_b64_tr_b16 v[200:201], v10 offset:32768
ds_read_b64_tr_b16 v[202:203], v10 offset:34816
v_mfma_f32_16x16x32_bf16 v[32:35], v[160:163], a[24:27], v[32:35]
s_nop 0
ds_read_b64_tr_b16 v[204:205], v11 offset:32768
ds_read_b64_tr_b16 v[206:207], v11 offset:34816
v_mfma_f32_16x16x32_bf16 v[32:35], v[144:147], a[20:23], v[32:35]
s_nop 0
ds_read_b64_tr_b16 v[208:209], v8 offset:36864
ds_read_b64_tr_b16 v[210:211], v8 offset:38912
v_mfma_f32_16x16x32_bf16 v[32:35], v[128:131], a[16:19], v[32:35]
s_nop 0
ds_read_b64_tr_b16 v[212:213], v9 offset:36864
ds_read_b64_tr_b16 v[214:215], v9 offset:38912
v_mfma_f32_16x16x32_bf16 v[36:39], v[132:135], a[16:19], 0
buffer_load_dwordx4 a[84:87], v1, s[44:47], s69 offen offset:1024 sc1
v_mfma_f32_16x16x32_bf16 v[36:39], v[148:151], a[20:23], v[36:39]
v_mfma_f32_16x16x32_bf16 v[36:39], v[164:167], a[24:27], v[36:39]
s_add_u32 s72, s71, 15360
buffer_load_dwordx4 v15, s[24:27], s72 offen offset:1024 lds
v_mfma_f32_16x16x32_bf16 v[36:39], v[180:183], a[28:31], v[36:39]
s_nop 0
ds_read_b64_tr_b16 v[216:217], v10 offset:36864
ds_read_b64_tr_b16 v[218:219], v10 offset:38912
v_mfma_f32_16x16x32_bf16 v[20:23], v[180:183], a[12:15], 0
s_nop 0
ds_read_b64_tr_b16 v[220:221], v11 offset:36864
ds_read_b64_tr_b16 v[222:223], v11 offset:38912
v_mfma_f32_16x16x32_bf16 v[20:23], v[164:167], a[8:11], v[20:23]
s_nop 0
ds_read_b64_tr_b16 v[224:225], v8 offset:40960
ds_read_b64_tr_b16 v[226:227], v8 offset:43008
v_mfma_f32_16x16x32_bf16 v[20:23], v[148:151], a[4:7], v[20:23]
s_nop 0
ds_read_b64_tr_b16 v[228:229], v9 offset:40960
ds_read_b64_tr_b16 v[230:231], v9 offset:43008
v_mfma_f32_16x16x32_bf16 v[20:23], v[132:135], a[0:3], v[20:23]
buffer_load_dwordx4 a[88:91], v1, s[44:47], s69 offen offset:2048 sc1
v_mfma_f32_16x16x32_bf16 v[24:27], v[136:139], a[0:3], 0
s_nop 0
ds_read_b64_tr_b16 v[232:233], v10 offset:40960
ds_read_b64_tr_b16 v[234:235], v10 offset:43008
v_mfma_f32_16x16x32_bf16 v[24:27], v[152:155], a[4:7], v[24:27]
s_add_u32 s72, s71, 30720
buffer_load_dwordx4 v15, s[24:27], s72 offen offset:2048 lds
v_mfma_f32_16x16x32_bf16 v[24:27], v[168:171], a[8:11], v[24:27]
v_mfma_f32_16x16x32_bf16 v[24:27], v[184:187], a[12:15], v[24:27]
s_nop 0
ds_read_b64_tr_b16 v[236:237], v11 offset:40960
ds_read_b64_tr_b16 v[238:239], v11 offset:43008
v_mfma_f32_16x16x32_bf16 v[40:43], v[184:187], a[28:31], 0
s_nop 0
ds_read_b64_tr_b16 v[240:241], v8 offset:45056
ds_read_b64_tr_b16 v[242:243], v8 offset:47104
v_mfma_f32_16x16x32_bf16 v[40:43], v[168:171], a[24:27], v[40:43]
s_nop 0
ds_read_b64_tr_b16 v[244:245], v9 offset:45056
ds_read_b64_tr_b16 v[246:247], v9 offset:47104
v_mfma_f32_16x16x32_bf16 v[40:43], v[152:155], a[20:23], v[40:43]
buffer_load_dwordx4 a[92:95], v1, s[44:47], s69 offen offset:3072 sc1
v_mfma_f32_16x16x32_bf16 v[40:43], v[136:139], a[16:19], v[40:43]
s_nop 0
ds_read_b64_tr_b16 v[248:249], v10 offset:45056
ds_read_b64_tr_b16 v[250:251], v10 offset:47104
v_mfma_f32_16x16x32_bf16 v[44:47], v[140:143], a[16:19], 0
s_add_u32 s72, s71, 46080
buffer_load_dwordx4 v15, s[24:27], s72 offen offset:3072 lds
v_mfma_f32_16x16x32_bf16 v[44:47], v[156:159], a[20:23], v[44:47]
s_nop 0
ds_read_b64_tr_b16 v[252:253], v11 offset:45056
ds_read_b64_tr_b16 v[254:255], v11 offset:47104
v_mfma_f32_16x16x32_bf16 v[44:47], v[172:175], a[24:27], v[44:47]
v_mfma_f32_16x16x32_bf16 v[44:47], v[188:191], a[28:31], v[44:47]
v_mfma_f32_16x16x32_bf16 v[28:31], v[188:191], a[12:15], 0
s_lshr_b32 s69, s15, 6
v_mfma_f32_16x16x32_bf16 v[28:31], v[172:175], a[8:11], v[28:31]
s_add_u32 s69, s69, s95
buffer_load_dwordx4 a[96:99], v1, s[44:47], s69 offen sc1
v_mfma_f32_16x16x32_bf16 v[28:31], v[156:159], a[4:7], v[28:31]
s_waitcnt vmcnt(17) lgkmcnt(0)
v_mfma_f32_16x16x32_bf16 v[28:31], v[140:143], a[0:3], v[28:31]
s_barrier
v_mfma_f32_16x16x32_bf16 v[48:51], v[192:195], a[32:35], v[48:51]
s_nop 0
ds_read_b64_tr_b16 v[128:129], v8 offset:49152
ds_read_b64_tr_b16 v[130:131], v8 offset:51200
v_mfma_f32_16x16x32_bf16 v[48:51], v[208:211], a[36:39], v[48:51]
s_add_u32 s71, s15, s78
ds_read_b64_tr_b16 v[132:133], v9 offset:49152
ds_read_b64_tr_b16 v[134:135], v9 offset:51200
v_mfma_f32_16x16x32_bf16 v[48:51], v[224:227], a[40:43], v[48:51]
s_add_u32 m0, s77, 32768
ds_read_b64_tr_b16 v[136:137], v10 offset:49152
ds_read_b64_tr_b16 v[138:139], v10 offset:51200
v_mfma_f32_16x16x32_bf16 v[48:51], v[240:243], a[44:47], v[48:51]
s_add_u32 s72, s71, 0
buffer_load_dwordx4 v15, s[24:27], s72 offen lds
v_mfma_f32_16x16x32_bf16 v[64:67], v[240:243], a[60:63], v[64:67]
buffer_load_dwordx4 a[100:103], v1, s[44:47], s69 offen offset:1024 sc1
v_mfma_f32_16x16x32_bf16 v[64:67], v[224:227], a[56:59], v[64:67]
s_nop 0
ds_read_b64_tr_b16 v[140:141], v11 offset:49152
ds_read_b64_tr_b16 v[142:143], v11 offset:51200
v_mfma_f32_16x16x32_bf16 v[64:67], v[208:211], a[52:55], v[64:67]
s_nop 0
ds_read_b64_tr_b16 v[144:145], v8 offset:53248
ds_read_b64_tr_b16 v[146:147], v8 offset:55296
v_mfma_f32_16x16x32_bf16 v[64:67], v[192:195], a[48:51], v[64:67]
s_nop 0
ds_read_b64_tr_b16 v[148:149], v9 offset:53248
ds_read_b64_tr_b16 v[150:151], v9 offset:55296
v_mfma_f32_16x16x32_bf16 v[68:71], v[196:199], a[48:51], v[68:71]
v_mfma_f32_16x16x32_bf16 v[68:71], v[212:215], a[52:55], v[68:71]
s_nop 0
ds_read_b64_tr_b16 v[152:153], v10 offset:53248
ds_read_b64_tr_b16 v[154:155], v10 offset:55296
v_mfma_f32_16x16x32_bf16 v[68:71], v[228:231], a[56:59], v[68:71]
s_add_u32 s72, s71, 15360
buffer_load_dwordx4 v15, s[24:27], s72 offen offset:1024 lds
v_mfma_f32_16x16x32_bf16 v[68:71], v[244:247], a[60:63], v[68:71]
buffer_load_dwordx4 a[104:107], v1, s[44:47], s69 offen offset:2048 sc1
v_mfma_f32_16x16x32_bf16 v[52:55], v[244:247], a[44:47], v[52:55]
s_nop 0
ds_read_b64_tr_b16 v[156:157], v11 offset:53248
ds_read_b64_tr_b16 v[158:159], v11 offset:55296
v_mfma_f32_16x16x32_bf16 v[52:55], v[228:231], a[40:43], v[52:55]
s_nop 0
ds_read_b64_tr_b16 v[160:161], v8 offset:57344
ds_read_b64_tr_b16 v[162:163], v8 offset:59392
v_mfma_f32_16x16x32_bf16 v[52:55], v[212:215], a[36:39], v[52:55]
s_nop 0
ds_read_b64_tr_b16 v[164:165], v9 offset:57344
ds_read_b64_tr_b16 v[166:167], v9 offset:59392
v_mfma_f32_16x16x32_bf16 v[52:55], v[196:199], a[32:35], v[52:55]
s_nop 0
ds_read_b64_tr_b16 v[168:169], v10 offset:57344
ds_read_b64_tr_b16 v[170:171], v10 offset:59392
v_mfma_f32_16x16x32_bf16 v[56:59], v[200:203], a[32:35], v[56:59]
v_mfma_f32_16x16x32_bf16 v[56:59], v[216:219], a[36:39], v[56:59]
s_add_u32 s72, s71, 30720
buffer_load_dwordx4 v15, s[24:27], s72 offen offset:2048 lds
v_mfma_f32_16x16x32_bf16 v[56:59], v[232:235], a[40:43], v[56:59]
buffer_load_dwordx4 a[108:111], v1, s[44:47], s69 offen offset:3072 sc1
v_mfma_f32_16x16x32_bf16 v[56:59], v[248:251], a[44:47], v[56:59]
s_nop 0
ds_read_b64_tr_b16 v[172:173], v11 offset:57344
ds_read_b64_tr_b16 v[174:175], v11 offset:59392
v_mfma_f32_16x16x32_bf16 v[72:75], v[248:251], a[60:63], v[72:75]
s_nop 0
ds_read_b64_tr_b16 v[176:177], v8 offset:61440
ds_read_b64_tr_b16 v[178:179], v8 offset:63488
v_mfma_f32_16x16x32_bf16 v[72:75], v[232:235], a[56:59], v[72:75]
s_nop 0
ds_read_b64_tr_b16 v[180:181], v9 offset:61440
ds_read_b64_tr_b16 v[182:183], v9 offset:63488
v_mfma_f32_16x16x32_bf16 v[72:75], v[216:219], a[52:55], v[72:75]
s_nop 0
ds_read_b64_tr_b16 v[184:185], v10 offset:61440
ds_read_b64_tr_b16 v[186:187], v10 offset:63488
v_mfma_f32_16x16x32_bf16 v[72:75], v[200:203], a[48:51], v[72:75]
s_nop 0
ds_read_b64_tr_b16 v[188:189], v11 offset:61440
ds_read_b64_tr_b16 v[190:191], v11 offset:63488
v_mfma_f32_16x16x32_bf16 v[76:79], v[204:207], a[48:51], v[76:79]
s_add_u32 s72, s71, 46080
buffer_load_dwordx4 v15, s[24:27], s72 offen offset:3072 lds
v_mfma_f32_16x16x32_bf16 v[76:79], v[220:223], a[52:55], v[76:79]
s_add_u32 s69, s69, 0x20000
buffer_load_dwordx4 a[112:115], v1, s[44:47], s69 offen sc1
v_mfma_f32_16x16x32_bf16 v[76:79], v[236:239], a[56:59], v[76:79]
v_mfma_f32_16x16x32_bf16 v[76:79], v[252:255], a[60:63], v[76:79]
v_mfma_f32_16x16x32_bf16 v[60:63], v[252:255], a[44:47], v[60:63]
v_mfma_f32_16x16x32_bf16 v[60:63], v[236:239], a[40:43], v[60:63]
s_add_u32 s71, s12, 0x200000
v_mfma_f32_16x16x32_bf16 v[60:63], v[220:223], a[36:39], v[60:63]
s_waitcnt vmcnt(18) lgkmcnt(0)
v_mfma_f32_16x16x32_bf16 v[60:63], v[204:207], a[32:35], v[60:63]
s_barrier
buffer_load_dwordx4 a[116:119], v1, s[44:47], s69 offen offset:1024 sc1
v_mfma_f32_16x16x32_bf16 v[16:19], v[128:131], a[32:35], v[16:19]
s_and_b32 s71, s71, 0x7c0000
ds_read_b64_tr_b16 v[192:193], v8 offset:0
ds_read_b64_tr_b16 v[194:195], v8 offset:2048
v_or_b32 v112, s58, v0
v_mov_b32 v113, 3
v_min_u32 v112, 1, v112
v_lshlrev_b32 v112, 30, v112
buffer_store_dword v113, v112, s[44:47], s91 offen sc1
v_mfma_f32_16x16x32_bf16 v[16:19], v[144:147], a[36:39], v[16:19]
s_add_u32 s71, s71, s78
ds_read_b64_tr_b16 v[196:197], v9 offset:0
ds_read_b64_tr_b16 v[198:199], v9 offset:2048
v_mfma_f32_16x16x32_bf16 v[16:19], v[160:163], a[40:43], v[16:19]
s_add_u32 m0, s77, 49152
ds_read_b64_tr_b16 v[200:201], v10 offset:0
ds_read_b64_tr_b16 v[202:203], v10 offset:2048
v_mfma_f32_16x16x32_bf16 v[16:19], v[176:179], a[44:47], v[16:19]
s_add_u32 s72, s71, 0
buffer_load_dwordx4 v15, s[24:27], s72 offen lds
v_mfma_f32_16x16x32_bf16 v[32:35], v[176:179], a[60:63], v[32:35]
s_nop 0
ds_read_b64_tr_b16 v[204:205], v11 offset:0
ds_read_b64_tr_b16 v[206:207], v11 offset:2048
v_mfma_f32_16x16x32_bf16 v[32:35], v[160:163], a[56:59], v[32:35]
s_nop 0
ds_read_b64_tr_b16 v[208:209], v8 offset:4096
ds_read_b64_tr_b16 v[210:211], v8 offset:6144
v_mfma_f32_16x16x32_bf16 v[32:35], v[144:147], a[52:55], v[32:35]
buffer_load_dwordx4 a[120:123], v1, s[44:47], s69 offen offset:2048 sc1
v_mfma_f32_16x16x32_bf16 v[32:35], v[128:131], a[48:51], v[32:35]
s_nop 0
ds_read_b64_tr_b16 v[212:213], v9 offset:4096
ds_read_b64_tr_b16 v[214:215], v9 offset:6144
v_mfma_f32_16x16x32_bf16 v[36:39], v[132:135], a[48:51], v[36:39]
v_mfma_f32_16x16x32_bf16 v[36:39], v[148:151], a[52:55], v[36:39]
s_nop 0
ds_read_b64_tr_b16 v[216:217], v10 offset:4096
ds_read_b64_tr_b16 v[218:219], v10 offset:6144
v_mfma_f32_16x16x32_bf16 v[36:39], v[164:167], a[56:59], v[36:39]
s_add_u32 s72, s71, 15360
buffer_load_dwordx4 v15, s[24:27], s72 offen offset:1024 lds
v_mfma_f32_16x16x32_bf16 v[36:39], v[180:183], a[60:63], v[36:39]
s_nop 0
ds_read_b64_tr_b16 v[220:221], v11 offset:4096
ds_read_b64_tr_b16 v[222:223], v11 offset:6144
v_mfma_f32_16x16x32_bf16 v[20:23], v[180:183], a[44:47], v[20:23]
s_nop 0
ds_read_b64_tr_b16 v[224:225], v8 offset:8192
ds_read_b64_tr_b16 v[226:227], v8 offset:10240
v_mfma_f32_16x16x32_bf16 v[20:23], v[164:167], a[40:43], v[20:23]
buffer_load_dwordx4 a[124:127], v1, s[44:47], s69 offen offset:3072 sc1
v_mfma_f32_16x16x32_bf16 v[20:23], v[148:151], a[36:39], v[20:23]
s_nop 0
ds_read_b64_tr_b16 v[228:229], v9 offset:8192
ds_read_b64_tr_b16 v[230:231], v9 offset:10240
v_mfma_f32_16x16x32_bf16 v[20:23], v[132:135], a[32:35], v[20:23]
s_nop 0
ds_read_b64_tr_b16 v[232:233], v10 offset:8192
ds_read_b64_tr_b16 v[234:235], v10 offset:10240
v_mfma_f32_16x16x32_bf16 v[24:27], v[136:139], a[32:35], v[24:27]
v_mfma_f32_16x16x32_bf16 v[24:27], v[152:155], a[36:39], v[24:27]
s_add_u32 s72, s71, 30720
buffer_load_dwordx4 v15, s[24:27], s72 offen offset:2048 lds
v_mfma_f32_16x16x32_bf16 v[24:27], v[168:171], a[40:43], v[24:27]
s_nop 0
ds_read_b64_tr_b16 v[236:237], v11 offset:8192
ds_read_b64_tr_b16 v[238:239], v11 offset:10240
v_mfma_f32_16x16x32_bf16 v[24:27], v[184:187], a[44:47], v[24:27]
s_nop 0
ds_read_b64_tr_b16 v[240:241], v8 offset:12288
ds_read_b64_tr_b16 v[242:243], v8 offset:14336
v_mfma_f32_16x16x32_bf16 v[40:43], v[184:187], a[60:63], v[40:43]
s_waitcnt vmcnt(44)
v_cmp_gt_u32 vcc, 2, v14
s_cbranch_vccnz Lspin106
Lback107:
s_add_u32 s82, s59, 20
s_and_b32 s82, s82, 28
s_lshl_b32 s82, s82, 10
s_add_u32 s82, s82, s74
buffer_load_dword v3, v2, s[44:47], s82 offen sc1
s_add_u32 s69, s12, 0x200000
s_and_b32 s69, s69, 0x7c0000
s_lshr_b32 s69, s69, 6
s_add_u32 s69, s69, s95
buffer_load_dwordx4 a[128:131], v1, s[44:47], s69 offen sc1
v_mfma_f32_16x16x32_bf16 v[40:43], v[168:171], a[56:59], v[40:43]
s_nop 0
ds_read_b64_tr_b16 v[244:245], v9 offset:12288
ds_read_b64_tr_b16 v[246:247], v9 offset:14336
v_mfma_f32_16x16x32_bf16 v[40:43], v[152:155], a[52:55], v[40:43]
s_nop 0
ds_read_b64_tr_b16 v[248:249], v10 offset:12288
ds_read_b64_tr_b16 v[250:251], v10 offset:14336
v_mfma_f32_16x16x32_bf16 v[40:43], v[136:139], a[48:51], v[40:43]
s_nop 0
ds_read_b64_tr_b16 v[252:253], v11 offset:12288
ds_read_b64_tr_b16 v[254:255], v11 offset:14336
v_mfma_f32_16x16x32_bf16 v[44:47], v[140:143], a[48:51], v[44:47]
s_add_u32 s72, s71, 46080
buffer_load_dwordx4 v15, s[24:27], s72 offen offset:3072 lds
v_mfma_f32_16x16x32_bf16 v[44:47], v[156:159], a[52:55], v[44:47]
v_mfma_f32_16x16x32_bf16 v[44:47], v[172:175], a[56:59], v[44:47]
buffer_load_dwordx4 a[132:135], v1, s[44:47], s69 offen offset:1024 sc1
v_mfma_f32_16x16x32_bf16 v[44:47], v[188:191], a[60:63], v[44:47]
v_mfma_f32_16x16x32_bf16 v[28:31], v[188:191], a[44:47], v[28:31]
v_mfma_f32_16x16x32_bf16 v[28:31], v[172:175], a[40:43], v[28:31]
v_mfma_f32_16x16x32_bf16 v[28:31], v[156:159], a[36:39], v[28:31]
s_waitcnt vmcnt(20) lgkmcnt(0)
v_mfma_f32_16x16x32_bf16 v[28:31], v[140:143], a[32:35], v[28:31]
s_barrier
v_mfma_f32_16x16x32_bf16 v[48:51], v[192:195], a[64:67], v[48:51]
s_nop 0
ds_read_b64_tr_b16 v[128:129], v8 offset:16384
ds_read_b64_tr_b16 v[130:131], v8 offset:18432
v_mfma_f32_16x16x32_bf16 v[48:51], v[208:211], a[68:71], v[48:51]
s_add_u32 s71, s15, s94
buffer_load_dwordx4 a[136:139], v1, s[44:47], s69 offen offset:2048 sc1
v_mfma_f32_16x16x32_bf16 v[48:51], v[224:227], a[72:75], v[48:51]
s_add_u32 m0, s77, 0
ds_read_b64_tr_b16 v[132:133], v9 offset:16384
ds_read_b64_tr_b16 v[134:135], v9 offset:18432
v_mfma_f32_16x16x32_bf16 v[48:51], v[240:243], a[76:79], v[48:51]
s_add_u32 s72, s71, 0
buffer_load_dwordx4 v15, s[24:27], s72 offen lds
v_mfma_f32_16x16x32_bf16 v[64:67], v[240:243], a[92:95], v[64:67]
s_nop 0
ds_read_b64_tr_b16 v[136:137], v10 offset:16384
ds_read_b64_tr_b16 v[138:139], v10 offset:18432
v_mfma_f32_16x16x32_bf16 v[64:67], v[224:227], a[88:91], v[64:67]
s_nop 0
ds_read_b64_tr_b16 v[140:141], v11 offset:16384
ds_read_b64_tr_b16 v[142:143], v11 offset:18432
v_mfma_f32_16x16x32_bf16 v[64:67], v[208:211], a[84:87], v[64:67]
s_nop 0
ds_read_b64_tr_b16 v[144:145], v8 offset:20480
ds_read_b64_tr_b16 v[146:147], v8 offset:22528
v_mfma_f32_16x16x32_bf16 v[64:67], v[192:195], a[80:83], v[64:67]
s_nop 0
ds_read_b64_tr_b16 v[148:149], v9 offset:20480
ds_read_b64_tr_b16 v[150:151], v9 offset:22528
v_mfma_f32_16x16x32_bf16 v[68:71], v[196:199], a[80:83], v[68:71]
buffer_load_dwordx4 a[140:143], v1, s[44:47], s69 offen offset:3072 sc1
v_mfma_f32_16x16x32_bf16 v[68:71], v[212:215], a[84:87], v[68:71]
v_and_b32 v122, 15, v0
v_lshrrev_b32 v123, 4, v0
v_mfma_f32_16x16x32_bf16 v[68:71], v[228:231], a[88:91], v[68:71]
s_add_u32 s72, s71, 15360
buffer_load_dwordx4 v15, s[24:27], s72 offen offset:1024 lds
v_mfma_f32_16x16x32_bf16 v[68:71], v[244:247], a[92:95], v[68:71]
s_nop 0
ds_read_b64_tr_b16 v[152:153], v10 offset:20480
ds_read_b64_tr_b16 v[154:155], v10 offset:22528
v_mfma_f32_16x16x32_bf16 v[52:55], v[244:247], a[76:79], v[52:55]
s_nop 0
ds_read_b64_tr_b16 v[156:157], v11 offset:20480
ds_read_b64_tr_b16 v[158:159], v11 offset:22528
v_mfma_f32_16x16x32_bf16 v[52:55], v[228:231], a[72:75], v[52:55]
s_nop 0
ds_read_b64_tr_b16 v[160:161], v8 offset:24576
ds_read_b64_tr_b16 v[162:163], v8 offset:26624
v_mfma_f32_16x16x32_bf16 v[52:55], v[212:215], a[68:71], v[52:55]
s_nop 0
ds_read_b64_tr_b16 v[164:165], v9 offset:24576
ds_read_b64_tr_b16 v[166:167], v9 offset:26624
v_mfma_f32_16x16x32_bf16 v[52:55], v[196:199], a[64:67], v[52:55]
s_add_u32 s69, s69, 0x20000
buffer_load_dwordx4 a[144:147], v1, s[44:47], s69 offen sc1
v_mfma_f32_16x16x32_bf16 v[56:59], v[200:203], a[64:67], v[56:59]
s_nop 0
ds_read_b64_tr_b16 v[168:169], v10 offset:24576
ds_read_b64_tr_b16 v[170:171], v10 offset:26624
v_mfma_f32_16x16x32_bf16 v[56:59], v[216:219], a[68:71], v[56:59]
s_add_u32 s72, s71, 30720
buffer_load_dwordx4 v15, s[24:27], s72 offen offset:2048 lds
v_mfma_f32_16x16x32_bf16 v[56:59], v[232:235], a[72:75], v[56:59]
v_lshlrev_b32 v123, 2, v123
v_sub_u32 v122, v122, v123
v_mfma_f32_16x16x32_bf16 v[56:59], v[248:251], a[76:79], v[56:59]
s_nop 0
ds_read_b64_tr_b16 v[172:173], v11 offset:24576
ds_read_b64_tr_b16 v[174:175], v11 offset:26624
v_mfma_f32_16x16x32_bf16 v[72:75], v[248:251], a[92:95], v[72:75]
s_nop 0
ds_read_b64_tr_b16 v[176:177], v8 offset:28672
ds_read_b64_tr_b16 v[178:179], v8 offset:30720
v_mfma_f32_16x16x32_bf16 v[72:75], v[232:235], a[88:91], v[72:75]
s_nop 0
ds_read_b64_tr_b16 v[180:181], v9 offset:28672
ds_read_b64_tr_b16 v[182:183], v9 offset:30720
v_mfma_f32_16x16x32_bf16 v[72:75], v[216:219], a[84:87], v[72:75]
buffer_load_dwordx4 a[148:151], v1, s[44:47], s69 offen offset:1024 sc1
v_mfma_f32_16x16x32_bf16 v[72:75], v[200:203], a[80:83], v[72:75]
s_nop 0
ds_read_b64_tr_b16 v[184:185], v10 offset:28672
ds_read_b64_tr_b16 v[186:187], v10 offset:30720
v_mfma_f32_16x16x32_bf16 v[76:79], v[204:207], a[80:83], v[76:79]
s_add_u32 s72, s71, 46080
buffer_load_dwordx4 v15, s[24:27], s72 offen offset:3072 lds
v_mfma_f32_16x16x32_bf16 v[76:79], v[220:223], a[84:87], v[76:79]
s_nop 0
ds_read_b64_tr_b16 v[188:189], v11 offset:28672
ds_read_b64_tr_b16 v[190:191], v11 offset:30720
v_mfma_f32_16x16x32_bf16 v[76:79], v[236:239], a[88:91], v[76:79]
v_min_u32 v122, 4, v122
v_lshlrev_b32 v122, 3, v122
v_mfma_f32_16x16x32_bf16 v[76:79], v[252:255], a[92:95], v[76:79]
v_mov_b32 v124, 0x3f80
v_mov_b32 v125, 0
v_mfma_f32_16x16x32_bf16 v[60:63], v[252:255], a[76:79], v[60:63]
v_lshlrev_b64 v[124:125], v122, v[124:125]
v_mov_b32 v126, 0
v_mfma_f32_16x16x32_bf16 v[60:63], v[236:239], a[72:75], v[60:63]
s_add_u32 s71, s13, 0x200000
buffer_load_dwordx4 a[152:155], v1, s[44:47], s69 offen offset:2048 sc1
v_mfma_f32_16x16x32_bf16 v[60:63], v[220:223], a[68:71], v[60:63]
s_waitcnt vmcnt(21) lgkmcnt(0)
v_lshlrev_b64 v[124:125], v122, v[124:125]
v_mov_b32 v127, 0
v_mfma_f32_16x16x32_bf16 v[60:63], v[204:207], a[64:67], v[60:63]
s_barrier
v_mov_b32 v122, 0
v_mov_b32 v123, 0
v_mfma_f32_16x16x32_bf16 v[16:19], v[128:131], a[64:67], v[16:19]
s_and_b32 s71, s71, 0x7c0000
ds_read_b64_tr_b16 v[192:193], v8 offset:32768
ds_read_b64_tr_b16 v[194:195], v8 offset:34816
v_mfma_f32_16x16x32_bf16 v[16:19], v[144:147], a[68:71], v[16:19]
s_add_u32 s71, s71, s78
ds_read_b64_tr_b16 v[196:197], v9 offset:32768
ds_read_b64_tr_b16 v[198:199], v9 offset:34816
v_mfma_f32_16x16x32_bf16 v[16:19], v[160:163], a[72:75], v[16:19]
s_add_u32 m0, s77, 16384
ds_read_b64_tr_b16 v[200:201], v10 offset:32768
ds_read_b64_tr_b16 v[202:203], v10 offset:34816
v_mfma_f32_16x16x32_bf16 v[16:19], v[176:179], a[76:79], v[16:19]
s_add_u32 s72, s71, 0
buffer_load_dwordx4 v15, s[24:27], s72 offen lds
v_mfma_f32_16x16x32_bf16 v[32:35], v[176:179], a[92:95], v[32:35]
buffer_load_dwordx4 a[156:159], v1, s[44:47], s69 offen offset:3072 sc1
v_mfma_f32_16x16x32_bf16 v[32:35], v[160:163], a[88:91], v[32:35]
s_nop 0
ds_read_b64_tr_b16 v[204:205], v11 offset:32768
ds_read_b64_tr_b16 v[206:207], v11 offset:34816
v_mfma_f32_16x16x32_bf16 v[32:35], v[144:147], a[84:87], v[32:35]
s_nop 0
ds_read_b64_tr_b16 v[208:209], v8 offset:36864
ds_read_b64_tr_b16 v[210:211], v8 offset:38912
v_mfma_f32_16x16x32_bf16 v[32:35], v[128:131], a[80:83], v[32:35]
s_add_u32 s69, s13, 0x200000
ds_read_b64_tr_b16 v[212:213], v9 offset:36864
ds_read_b64_tr_b16 v[214:215], v9 offset:38912
v_mfma_f32_16x16x32_bf16 v[36:39], v[132:135], a[80:83], v[36:39]
s_and_b32 s69, s69, 0x7c0000
v_mfma_f32_16x16x32_bf16 v[36:39], v[148:151], a[84:87], v[36:39]
s_lshr_b32 s69, s69, 6
ds_read_b64_tr_b16 v[216:217], v10 offset:36864
ds_read_b64_tr_b16 v[218:219], v10 offset:38912
v_mfma_f32_16x16x32_bf16 v[36:39], v[164:167], a[88:91], v[36:39]
s_add_u32 s72, s71, 15360
buffer_load_dwordx4 v15, s[24:27], s72 offen offset:1024 lds
v_mfma_f32_16x16x32_bf16 v[36:39], v[180:183], a[92:95], v[36:39]
s_add_u32 s69, s69, s95
buffer_load_dwordx4 a[160:163], v1, s[44:47], s69 offen sc1
v_mfma_f32_16x16x32_bf16 v[20:23], v[180:183], a[76:79], v[20:23]
s_nop 0
ds_read_b64_tr_b16 v[220:221], v11 offset:36864
ds_read_b64_tr_b16 v[222:223], v11 offset:38912
v_mfma_f32_16x16x32_bf16 v[20:23], v[164:167], a[72:75], v[20:23]
s_nop 0
ds_read_b64_tr_b16 v[224:225], v8 offset:40960
ds_read_b64_tr_b16 v[226:227], v8 offset:43008
v_mfma_f32_16x16x32_bf16 v[20:23], v[148:151], a[68:71], v[20:23]
s_nop 0
ds_read_b64_tr_b16 v[228:229], v9 offset:40960
ds_read_b64_tr_b16 v[230:231], v9 offset:43008
v_mfma_f32_16x16x32_bf16 v[20:23], v[132:135], a[64:67], v[20:23]
s_nop 0
ds_read_b64_tr_b16 v[232:233], v10 offset:40960
ds_read_b64_tr_b16 v[234:235], v10 offset:43008
v_mfma_f32_16x16x32_bf16 v[24:27], v[136:139], a[64:67], v[24:27]
v_mfma_f32_16x16x32_bf16 v[24:27], v[152:155], a[68:71], v[24:27]
s_add_u32 s72, s71, 30720
buffer_load_dwordx4 v15, s[24:27], s72 offen offset:2048 lds
v_mfma_f32_16x16x32_bf16 v[24:27], v[168:171], a[72:75], v[24:27]
buffer_load_dwordx4 a[164:167], v1, s[44:47], s69 offen offset:1024 sc1
v_mfma_f32_16x16x32_bf16 v[24:27], v[184:187], a[76:79], v[24:27]
s_nop 0
ds_read_b64_tr_b16 v[236:237], v11 offset:40960
ds_read_b64_tr_b16 v[238:239], v11 offset:43008
v_mfma_f32_16x16x32_bf16 v[40:43], v[184:187], a[92:95], v[40:43]
s_nop 0
ds_read_b64_tr_b16 v[240:241], v8 offset:45056
ds_read_b64_tr_b16 v[242:243], v8 offset:47104
v_mfma_f32_16x16x32_bf16 v[40:43], v[168:171], a[88:91], v[40:43]
s_nop 0
ds_read_b64_tr_b16 v[244:245], v9 offset:45056
ds_read_b64_tr_b16 v[246:247], v9 offset:47104
v_mfma_f32_16x16x32_bf16 v[40:43], v[152:155], a[84:87], v[40:43]
s_nop 0
ds_read_b64_tr_b16 v[248:249], v10 offset:45056
ds_read_b64_tr_b16 v[250:251], v10 offset:47104
v_mfma_f32_16x16x32_bf16 v[40:43], v[136:139], a[80:83], v[40:43]
s_nop 0
ds_read_b64_tr_b16 v[252:253], v11 offset:45056
ds_read_b64_tr_b16 v[254:255], v11 offset:47104
v_mfma_f32_16x16x32_bf16 v[44:47], v[140:143], a[80:83], v[44:47]
s_add_u32 s72, s71, 46080
buffer_load_dwordx4 v15, s[24:27], s72 offen offset:3072 lds
v_mfma_f32_16x16x32_bf16 v[44:47], v[156:159], a[84:87], v[44:47]
buffer_load_dwordx4 a[168:171], v1, s[44:47], s69 offen offset:2048 sc1
v_mfma_f32_16x16x32_bf16 v[44:47], v[172:175], a[88:91], v[44:47]
v_mfma_f32_16x16x32_bf16 v[44:47], v[188:191], a[92:95], v[44:47]
v_mfma_f32_16x16x32_bf16 v[28:31], v[188:191], a[76:79], v[28:31]
v_mfma_f32_16x16x32_bf16 v[28:31], v[172:175], a[72:75], v[28:31]
s_add_u32 s71, s12, 0x200000
v_mfma_f32_16x16x32_bf16 v[28:31], v[156:159], a[68:71], v[28:31]
s_waitcnt vmcnt(18) lgkmcnt(0)
v_mfma_f32_16x16x32_bf16 v[28:31], v[140:143], a[64:67], v[28:31]
s_barrier
buffer_load_dwordx4 a[172:175], v1, s[44:47], s69 offen offset:3072 sc1
v_mfma_f32_16x16x32_bf16 v[48:51], v[192:195], a[96:99], v[48:51]
s_and_b32 s71, s71, 0x7c0000
ds_read_b64_tr_b16 v[128:129], v8 offset:49152
ds_read_b64_tr_b16 v[130:131], v8 offset:51200
v_mfma_f32_16x16x32_bf16 v[48:51], v[208:211], a[100:103], v[48:51]
s_add_u32 s71, s71, s94
ds_read_b64_tr_b16 v[132:133], v9 offset:49152
ds_read_b64_tr_b16 v[134:135], v9 offset:51200
v_mfma_f32_16x16x32_bf16 v[48:51], v[224:227], a[104:107], v[48:51]
s_add_u32 m0, s77, 32768
ds_read_b64_tr_b16 v[136:137], v10 offset:49152
ds_read_b64_tr_b16 v[138:139], v10 offset:51200
v_mfma_f32_16x16x32_bf16 v[48:51], v[240:243], a[108:111], v[48:51]
s_add_u32 s72, s71, 0
buffer_load_dwordx4 v15, s[24:27], s72 offen lds
v_mfma_f32_16x16x32_bf16 v[64:67], v[240:243], a[124:127], v[64:67]
s_nop 0
ds_read_b64_tr_b16 v[140:141], v11 offset:49152
ds_read_b64_tr_b16 v[142:143], v11 offset:51200
v_mfma_f32_16x16x32_bf16 v[64:67], v[224:227], a[120:123], v[64:67]
v_mfma_f32_16x16x32_bf16 v[64:67], v[208:211], a[116:119], v[64:67]
s_add_u32 s69, s69, 0x20000
buffer_load_dwordx4 a[176:179], v1, s[44:47], s69 offen sc1
v_mfma_f32_16x16x32_bf16 v[64:67], v[192:195], a[112:115], v[64:67]
s_nop 0
ds_read_b64_tr_b16 v[144:145], v8 offset:53248
ds_read_b64_tr_b16 v[146:147], v8 offset:55296
v_mfma_f32_16x16x32_bf16 v[68:71], v[196:199], a[112:115], v[68:71]
s_nop 0
ds_read_b64_tr_b16 v[148:149], v9 offset:53248
ds_read_b64_tr_b16 v[150:151], v9 offset:55296
v_mfma_f32_16x16x32_bf16 v[68:71], v[212:215], a[116:119], v[68:71]
s_nop 0
ds_read_b64_tr_b16 v[152:153], v10 offset:53248
ds_read_b64_tr_b16 v[154:155], v10 offset:55296
v_mfma_f32_16x16x32_bf16 v[68:71], v[228:231], a[120:123], v[68:71]
s_add_u32 s72, s71, 15360
buffer_load_dwordx4 v15, s[24:27], s72 offen offset:1024 lds
v_mfma_f32_16x16x32_bf16 v[68:71], v[244:247], a[124:127], v[68:71]
s_nop 0
ds_read_b64_tr_b16 v[156:157], v11 offset:53248
ds_read_b64_tr_b16 v[158:159], v11 offset:55296
v_mfma_f32_16x16x32_bf16 v[52:55], v[244:247], a[108:111], v[52:55]
v_mfma_f32_16x16x32_bf16 v[52:55], v[228:231], a[104:107], v[52:55]
buffer_load_dwordx4 a[180:183], v1, s[44:47], s69 offen offset:1024 sc1
v_mfma_f32_16x16x32_bf16 v[52:55], v[212:215], a[100:103], v[52:55]
s_nop 0
ds_read_b64_tr_b16 v[160:161], v8 offset:57344
ds_read_b64_tr_b16 v[162:163], v8 offset:59392
v_mfma_f32_16x16x32_bf16 v[52:55], v[196:199], a[96:99], v[52:55]
s_nop 0
ds_read_b64_tr_b16 v[164:165], v9 offset:57344
ds_read_b64_tr_b16 v[166:167], v9 offset:59392
v_mfma_f32_16x16x32_bf16 v[56:59], v[200:203], a[96:99], v[56:59]
s_nop 0
ds_read_b64_tr_b16 v[168:169], v10 offset:57344
ds_read_b64_tr_b16 v[170:171], v10 offset:59392
v_mfma_f32_16x16x32_bf16 v[56:59], v[216:219], a[100:103], v[56:59]
s_add_u32 s72, s71, 30720
buffer_load_dwordx4 v15, s[24:27], s72 offen offset:2048 lds
v_mfma_f32_16x16x32_bf16 v[56:59], v[232:235], a[104:107], v[56:59]
s_nop 0
ds_read_b64_tr_b16 v[172:173], v11 offset:57344
ds_read_b64_tr_b16 v[174:175], v11 offset:59392
v_mfma_f32_16x16x32_bf16 v[56:59], v[248:251], a[108:111], v[56:59]
v_mfma_f32_16x16x32_bf16 v[72:75], v[248:251], a[124:127], v[72:75]
buffer_load_dwordx4 a[184:187], v1, s[44:47], s69 offen offset:2048 sc1
v_mfma_f32_16x16x32_bf16 v[72:75], v[232:235], a[120:123], v[72:75]
s_nop 0
ds_read_b64_tr_b16 v[176:177], v8 offset:61440
ds_read_b64_tr_b16 v[178:179], v8 offset:63488
v_mfma_f32_16x16x32_bf16 v[72:75], v[216:219], a[116:119], v[72:75]
s_nop 0
ds_read_b64_tr_b16 v[180:181], v9 offset:61440
ds_read_b64_tr_b16 v[182:183], v9 offset:63488
v_mfma_f32_16x16x32_bf16 v[72:75], v[200:203], a[112:115], v[72:75]
s_nop 0
ds_read_b64_tr_b16 v[184:185], v10 offset:61440
ds_read_b64_tr_b16 v[186:187], v10 offset:63488
v_mfma_f32_16x16x32_bf16 v[76:79], v[204:207], a[112:115], v[76:79]
s_add_u32 s72, s71, 46080
buffer_load_dwordx4 v15, s[24:27], s72 offen offset:3072 lds
v_mfma_f32_16x16x32_bf16 v[76:79], v[220:223], a[116:119], v[76:79]
s_nop 0
ds_read_b64_tr_b16 v[188:189], v11 offset:61440
ds_read_b64_tr_b16 v[190:191], v11 offset:63488
v_mfma_f32_16x16x32_bf16 v[76:79], v[236:239], a[120:123], v[76:79]
v_mfma_f32_16x16x32_bf16 v[76:79], v[252:255], a[124:127], v[76:79]
buffer_load_dwordx4 a[188:191], v1, s[44:47], s69 offen offset:3072 sc1
v_mfma_f32_16x16x32_bf16 v[60:63], v[252:255], a[108:111], v[60:63]
s_add_u32 s69, s14, 0x200000
v_mfma_f32_16x16x32_bf16 v[60:63], v[236:239], a[104:107], v[60:63]
s_add_u32 s71, s14, 0x200000
v_mfma_f32_16x16x32_bf16 v[60:63], v[220:223], a[100:103], v[60:63]
s_waitcnt vmcnt(15) lgkmcnt(0)
v_mfma_f32_16x16x32_bf16 v[60:63], v[204:207], a[96:99], v[60:63]
s_barrier
v_mfma_f32_16x16x32_bf16 v[48:51], v[128:131], a[128:131], v[48:51]
s_and_b32 s71, s71, 0x7c0000
ds_read_b64_tr_b16 v[192:193], v8 offset:0
ds_read_b64_tr_b16 v[194:195], v8 offset:2048
v_mfma_f32_16x16x32_bf16 v[48:51], v[144:147], a[132:135], v[48:51]
s_add_u32 s71, s71, s78
ds_read_b64_tr_b16 v[196:197], v9 offset:0
ds_read_b64_tr_b16 v[198:199], v9 offset:2048
v_mfma_f32_16x16x32_bf16 v[48:51], v[160:163], a[136:139], v[48:51]
s_add_u32 m0, s77, 49152
s_and_b32 s69, s69, 0x7c0000
s_lshr_b32 s69, s69, 6
s_add_u32 s69, s69, s95
buffer_load_dwordx4 a[192:195], v1, s[44:47], s69 offen sc1
v_mfma_f32_16x16x32_bf16 v[48:51], v[176:179], a[140:143], v[48:51]
s_add_u32 s72, s71, 0
buffer_load_dwordx4 v15, s[24:27], s72 offen lds
v_mfma_f32_16x16x32_bf16 v[64:67], v[176:179], a[156:159], v[64:67]
s_nop 0
ds_read_b64_tr_b16 v[200:201], v10 offset:0
ds_read_b64_tr_b16 v[202:203], v10 offset:2048
v_mfma_f32_16x16x32_bf16 v[64:67], v[160:163], a[152:155], v[64:67]
s_nop 0
ds_read_b64_tr_b16 v[204:205], v11 offset:0
ds_read_b64_tr_b16 v[206:207], v11 offset:2048
v_mfma_f32_16x16x32_bf16 v[64:67], v[144:147], a[148:151], v[64:67]
s_nop 0
ds_read_b64_tr_b16 v[208:209], v8 offset:4096
ds_read_b64_tr_b16 v[210:211], v8 offset:6144
v_mfma_f32_16x16x32_bf16 v[64:67], v[128:131], a[144:147], v[64:67]
s_nop 0
ds_read_b64_tr_b16 v[212:213], v9 offset:4096
ds_read_b64_tr_b16 v[214:215], v9 offset:6144
v_mfma_f32_16x16x32_bf16 v[68:71], v[132:135], a[144:147], v[68:71]
buffer_load_dwordx4 a[196:199], v1, s[44:47], s69 offen offset:1024 sc1
v_mfma_f32_16x16x32_bf16 v[68:71], v[148:151], a[148:151], v[68:71]
v_add_u32 v120, s64, v1
v_add_u32 v120, 131072, v120
v_mfma_f32_16x16x32_bf16 v[68:71], v[164:167], a[152:155], v[68:71]
s_add_u32 s72, s71, 15360
buffer_load_dwordx4 v15, s[24:27], s72 offen offset:1024 lds
v_mfma_f32_16x16x32_bf16 v[68:71], v[180:183], a[156:159], v[68:71]
s_lshl_b32 s70, s75, 18
ds_read_b64_tr_b16 v[216:217], v10 offset:4096
ds_read_b64_tr_b16 v[218:219], v10 offset:6144
v_mfma_f32_16x16x32_bf16 v[52:55], v[180:183], a[140:143], v[52:55]
s_add_u32 s70, s70, s94
ds_read_b64_tr_b16 v[220:221], v11 offset:4096
ds_read_b64_tr_b16 v[222:223], v11 offset:6144
v_mfma_f32_16x16x32_bf16 v[52:55], v[164:167], a[136:139], v[52:55]
s_nop 0
ds_read_b64_tr_b16 v[224:225], v8 offset:8192
ds_read_b64_tr_b16 v[226:227], v8 offset:10240
v_mfma_f32_16x16x32_bf16 v[52:55], v[148:151], a[132:135], v[52:55]
s_nop 0
ds_read_b64_tr_b16 v[228:229], v9 offset:8192
ds_read_b64_tr_b16 v[230:231], v9 offset:10240
v_mfma_f32_16x16x32_bf16 v[52:55], v[132:135], a[128:131], v[52:55]
buffer_load_dwordx4 a[200:203], v1, s[44:47], s69 offen offset:2048 sc1
v_mfma_f32_16x16x32_bf16 v[56:59], v[136:139], a[128:131], v[56:59]
s_nop 0
ds_read_b64_tr_b16 v[232:233], v10 offset:8192
ds_read_b64_tr_b16 v[234:235], v10 offset:10240
v_mfma_f32_16x16x32_bf16 v[56:59], v[152:155], a[132:135], v[56:59]
s_add_u32 s72, s71, 30720
buffer_load_dwordx4 v15, s[24:27], s72 offen offset:2048 lds
v_mfma_f32_16x16x32_bf16 v[56:59], v[168:171], a[136:139], v[56:59]
ds_write_b128 v120, v[80:83] offset:0
v_mfma_f32_16x16x32_bf16 v[56:59], v[184:187], a[140:143], v[56:59]
s_nop 0
ds_read_b64_tr_b16 v[236:237], v11 offset:8192
ds_read_b64_tr_b16 v[238:239], v11 offset:10240
v_mfma_f32_16x16x32_bf16 v[72:75], v[184:187], a[156:159], v[72:75]
s_nop 0
ds_read_b64_tr_b16 v[240:241], v8 offset:12288
ds_read_b64_tr_b16 v[242:243], v8 offset:14336
v_mfma_f32_16x16x32_bf16 v[72:75], v[168:171], a[152:155], v[72:75]
s_nop 0
ds_read_b64_tr_b16 v[244:245], v9 offset:12288
ds_read_b64_tr_b16 v[246:247], v9 offset:14336
v_mfma_f32_16x16x32_bf16 v[72:75], v[152:155], a[148:151], v[72:75]
buffer_load_dwordx4 a[204:207], v1, s[44:47], s69 offen offset:3072 sc1
v_mfma_f32_16x16x32_bf16 v[72:75], v[136:139], a[144:147], v[72:75]
s_nop 0
ds_read_b64_tr_b16 v[248:249], v10 offset:12288
ds_read_b64_tr_b16 v[250:251], v10 offset:14336
v_mfma_f32_16x16x32_bf16 v[76:79], v[140:143], a[144:147], v[76:79]
s_add_u32 s72, s71, 46080
buffer_load_dwordx4 v15, s[24:27], s72 offen offset:3072 lds
v_mfma_f32_16x16x32_bf16 v[76:79], v[156:159], a[148:151], v[76:79]
s_nop 0
ds_read_b64_tr_b16 v[252:253], v11 offset:12288
ds_read_b64_tr_b16 v[254:255], v11 offset:14336
v_mfma_f32_16x16x32_bf16 v[76:79], v[172:175], a[152:155], v[76:79]
ds_write_b128 v120, v[84:87] offset:1024
v_mfma_f32_16x16x32_bf16 v[76:79], v[188:191], a[156:159], v[76:79]
v_mfma_f32_16x16x32_bf16 v[60:63], v[188:191], a[140:143], v[60:63]
s_add_u32 s69, s69, 0x20000
ds_write_b128 v120, v[96:99] offset:2048
v_mfma_f32_16x16x32_bf16 v[60:63], v[172:175], a[136:139], v[60:63]
s_add_u32 s71, s13, 0x200000
buffer_load_dwordx4 a[208:211], v1, s[44:47], s69 offen sc1
v_mfma_f32_16x16x32_bf16 v[60:63], v[156:159], a[132:135], v[60:63]
s_waitcnt vmcnt(19) lgkmcnt(0)
ds_write_b128 v120, v[100:103] offset:3072
v_mfma_f32_16x16x32_bf16 v[60:63], v[140:143], a[128:131], v[60:63]
s_barrier
v_mfma_f32_16x16x32_bf16 v[16:19], v[192:195], a[96:99], v[16:19]
s_and_b32 s71, s71, 0x7c0000
ds_read_b64_tr_b16 v[128:129], v8 offset:16384
ds_read_b64_tr_b16 v[130:131], v8 offset:18432
v_mfma_f32_16x16x32_bf16 v[16:19], v[208:211], a[100:103], v[16:19]
s_add_u32 s71, s71, s94
ds_read_b64_tr_b16 v[132:133], v9 offset:16384
ds_read_b64_tr_b16 v[134:135], v9 offset:18432
v_mfma_f32_16x16x32_bf16 v[16:19], v[224:227], a[104:107], v[16:19]
s_add_u32 m0, s77, 0
ds_read_b64_tr_b16 v[136:137], v10 offset:16384
ds_read_b64_tr_b16 v[138:139], v10 offset:18432
v_mfma_f32_16x16x32_bf16 v[16:19], v[240:243], a[108:111], v[16:19]
s_add_u32 s72, s71, 0
buffer_load_dwordx4 v15, s[24:27], s72 offen lds
v_mfma_f32_16x16x32_bf16 v[32:35], v[240:243], a[124:127], v[32:35]
buffer_load_dwordx4 a[212:215], v1, s[44:47], s69 offen offset:1024 sc1
v_mfma_f32_16x16x32_bf16 v[32:35], v[224:227], a[120:123], v[32:35]
s_nop 0
ds_read_b64_tr_b16 v[140:141], v11 offset:16384
ds_read_b64_tr_b16 v[142:143], v11 offset:18432
v_mfma_f32_16x16x32_bf16 v[32:35], v[208:211], a[116:119], v[32:35]
s_nop 0
ds_read_b64_tr_b16 v[144:145], v8 offset:20480
ds_read_b64_tr_b16 v[146:147], v8 offset:22528
v_mfma_f32_16x16x32_bf16 v[32:35], v[192:195], a[112:115], v[32:35]
s_nop 0
ds_read_b64_tr_b16 v[148:149], v9 offset:20480
ds_read_b64_tr_b16 v[150:151], v9 offset:22528
v_mfma_f32_16x16x32_bf16 v[36:39], v[196:199], a[112:115], v[36:39]
v_mfma_f32_16x16x32_bf16 v[36:39], v[212:215], a[116:119], v[36:39]
s_nop 0
ds_read_b64_tr_b16 v[152:153], v10 offset:20480
ds_read_b64_tr_b16 v[154:155], v10 offset:22528
v_mfma_f32_16x16x32_bf16 v[36:39], v[228:231], a[120:123], v[36:39]
s_add_u32 s72, s71, 15360
buffer_load_dwordx4 v15, s[24:27], s72 offen offset:1024 lds
v_mfma_f32_16x16x32_bf16 v[36:39], v[244:247], a[124:127], v[36:39]
buffer_load_dwordx4 a[216:219], v1, s[44:47], s69 offen offset:2048 sc1
v_mfma_f32_16x16x32_bf16 v[20:23], v[244:247], a[108:111], v[20:23]
s_nop 0
ds_read_b64_tr_b16 v[156:157], v11 offset:20480
ds_read_b64_tr_b16 v[158:159], v11 offset:22528
v_mfma_f32_16x16x32_bf16 v[20:23], v[228:231], a[104:107], v[20:23]
s_nop 0
ds_read_b64_tr_b16 v[160:161], v8 offset:24576
ds_read_b64_tr_b16 v[162:163], v8 offset:26624
v_mfma_f32_16x16x32_bf16 v[20:23], v[212:215], a[100:103], v[20:23]
s_nop 0
ds_read_b64_tr_b16 v[164:165], v9 offset:24576
ds_read_b64_tr_b16 v[166:167], v9 offset:26624
v_mfma_f32_16x16x32_bf16 v[20:23], v[196:199], a[96:99], v[20:23]
s_nop 0
ds_read_b64_tr_b16 v[168:169], v10 offset:24576
ds_read_b64_tr_b16 v[170:171], v10 offset:26624
v_mfma_f32_16x16x32_bf16 v[24:27], v[200:203], a[96:99], v[24:27]
v_mfma_f32_16x16x32_bf16 v[24:27], v[216:219], a[100:103], v[24:27]
s_add_u32 s72, s71, 30720
buffer_load_dwordx4 v15, s[24:27], s72 offen offset:2048 lds
v_mfma_f32_16x16x32_bf16 v[24:27], v[232:235], a[104:107], v[24:27]
buffer_load_dwordx4 a[220:223], v1, s[44:47], s69 offen offset:3072 sc1
v_mfma_f32_16x16x32_bf16 v[24:27], v[248:251], a[108:111], v[24:27]
s_nop 0
ds_read_b64_tr_b16 v[172:173], v11 offset:24576
ds_read_b64_tr_b16 v[174:175], v11 offset:26624
v_mfma_f32_16x16x32_bf16 v[40:43], v[248:251], a[124:127], v[40:43]
s_nop 0
ds_read_b64_tr_b16 v[176:177], v8 offset:28672
ds_read_b64_tr_b16 v[178:179], v8 offset:30720
v_mfma_f32_16x16x32_bf16 v[40:43], v[232:235], a[120:123], v[40:43]
s_add_u32 s69, s15, 0x200000
ds_read_b64_tr_b16 v[180:181], v9 offset:28672
ds_read_b64_tr_b16 v[182:183], v9 offset:30720
v_mfma_f32_16x16x32_bf16 v[40:43], v[216:219], a[116:119], v[40:43]
s_and_b32 s69, s69, 0x7c0000
ds_read_b64_tr_b16 v[184:185], v10 offset:28672
ds_read_b64_tr_b16 v[186:187], v10 offset:30720
v_mfma_f32_16x16x32_bf16 v[40:43], v[200:203], a[112:115], v[40:43]
s_lshr_b32 s69, s69, 6
ds_read_b64_tr_b16 v[188:189], v11 offset:28672
ds_read_b64_tr_b16 v[190:191], v11 offset:30720
v_mfma_f32_16x16x32_bf16 v[44:47], v[204:207], a[112:115], v[44:47]
s_add_u32 s72, s71, 46080
buffer_load_dwordx4 v15, s[24:27], s72 offen offset:3072 lds
v_mfma_f32_16x16x32_bf16 v[44:47], v[220:223], a[116:119], v[44:47]
s_add_u32 s69, s69, s95
buffer_load_dwordx4 a[224:227], v1, s[44:47], s69 offen sc1
v_mfma_f32_16x16x32_bf16 v[44:47], v[236:239], a[120:123], v[44:47]
v_mfma_f32_16x16x32_bf16 v[44:47], v[252:255], a[124:127], v[44:47]
v_mfma_f32_16x16x32_bf16 v[28:31], v[252:255], a[108:111], v[28:31]
v_mfma_f32_16x16x32_bf16 v[28:31], v[236:239], a[104:107], v[28:31]
s_add_u32 s71, s15, 0x200000
v_mfma_f32_16x16x32_bf16 v[28:31], v[220:223], a[100:103], v[28:31]
s_waitcnt vmcnt(17) lgkmcnt(0)
v_mfma_f32_16x16x32_bf16 v[28:31], v[204:207], a[96:99], v[28:31]
s_barrier
buffer_load_dwordx4 a[228:231], v1, s[44:47], s69 offen offset:1024 sc1
v_mfma_f32_16x16x32_bf16 v[48:51], v[128:131], a[160:163], v[48:51]
s_and_b32 s71, s71, 0x7c0000
ds_read_b64_tr_b16 v[192:193], v8 offset:32768
ds_read_b64_tr_b16 v[194:195], v8 offset:34816
v_mfma_f32_16x16x32_bf16 v[48:51], v[144:147], a[164:167], v[48:51]
s_add_u32 s71, s71, s78
ds_read_b64_tr_b16 v[196:197], v9 offset:32768
ds_read_b64_tr_b16 v[198:199], v9 offset:34816
v_mfma_f32_16x16x32_bf16 v[48:51], v[160:163], a[168:171], v[48:51]
s_add_u32 m0, s77, 16384
ds_read_b64_tr_b16 v[200:201], v10 offset:32768
ds_read_b64_tr_b16 v[202:203], v10 offset:34816
v_mfma_f32_16x16x32_bf16 v[48:51], v[176:179], a[172:175], v[48:51]
s_add_u32 s72, s71, 0
buffer_load_dwordx4 v15, s[24:27], s72 offen lds
v_mfma_f32_16x16x32_bf16 v[64:67], v[176:179], a[188:191], v[64:67]
s_nop 0
ds_read_b64_tr_b16 v[204:205], v11 offset:32768
ds_read_b64_tr_b16 v[206:207], v11 offset:34816
v_mfma_f32_16x16x32_bf16 v[64:67], v[160:163], a[184:187], v[64:67]
v_mfma_f32_16x16x32_bf16 v[64:67], v[144:147], a[180:183], v[64:67]
buffer_load_dwordx4 a[232:235], v1, s[44:47], s69 offen offset:2048 sc1
v_mfma_f32_16x16x32_bf16 v[64:67], v[128:131], a[176:179], v[64:67]
s_nop 0
ds_read_b64_tr_b16 v[208:209], v8 offset:36864
ds_read_b64_tr_b16 v[210:211], v8 offset:38912
v_mfma_f32_16x16x32_bf16 v[68:71], v[132:135], a[176:179], v[68:71]
s_nop 0
ds_read_b64_tr_b16 v[212:213], v9 offset:36864
ds_read_b64_tr_b16 v[214:215], v9 offset:38912
v_mfma_f32_16x16x32_bf16 v[68:71], v[148:151], a[180:183], v[68:71]
s_nop 0
ds_read_b64_tr_b16 v[216:217], v10 offset:36864
ds_read_b64_tr_b16 v[218:219], v10 offset:38912
v_mfma_f32_16x16x32_bf16 v[68:71], v[164:167], a[184:187], v[68:71]
s_add_u32 s72, s71, 15360
buffer_load_dwordx4 v15, s[24:27], s72 offen offset:1024 lds
v_mfma_f32_16x16x32_bf16 v[68:71], v[180:183], a[188:191], v[68:71]
s_nop 0
ds_read_b64_tr_b16 v[220:221], v11 offset:36864
ds_read_b64_tr_b16 v[222:223], v11 offset:38912
v_mfma_f32_16x16x32_bf16 v[52:55], v[180:183], a[172:175], v[52:55]
v_mfma_f32_16x16x32_bf16 v[52:55], v[164:167], a[168:171], v[52:55]
buffer_load_dwordx4 a[236:239], v1, s[44:47], s69 offen offset:3072 sc1
v_mfma_f32_16x16x32_bf16 v[52:55], v[148:151], a[164:167], v[52:55]
s_nop 0
ds_read_b64_tr_b16 v[224:225], v8 offset:40960
ds_read_b64_tr_b16 v[226:227], v8 offset:43008
v_mfma_f32_16x16x32_bf16 v[52:55], v[132:135], a[160:163], v[52:55]
s_nop 0
ds_read_b64_tr_b16 v[228:229], v9 offset:40960
ds_read_b64_tr_b16 v[230:231], v9 offset:43008
v_mfma_f32_16x16x32_bf16 v[56:59], v[136:139], a[160:163], v[56:59]
s_nop 0
ds_read_b64_tr_b16 v[232:233], v10 offset:40960
ds_read_b64_tr_b16 v[234:235], v10 offset:43008
v_mfma_f32_16x16x32_bf16 v[56:59], v[152:155], a[164:167], v[56:59]
s_add_u32 s72, s71, 30720
buffer_load_dwordx4 v15, s[24:27], s72 offen offset:2048 lds
v_mfma_f32_16x16x32_bf16 v[56:59], v[168:171], a[168:171], v[56:59]
s_nop 0
ds_read_b64_tr_b16 v[236:237], v11 offset:40960
ds_read_b64_tr_b16 v[238:239], v11 offset:43008
v_mfma_f32_16x16x32_bf16 v[56:59], v[184:187], a[172:175], v[56:59]
v_mfma_f32_16x16x32_bf16 v[72:75], v[184:187], a[188:191], v[72:75]
s_add_u32 s69, s69, 0x20000
buffer_load_dwordx4 a[240:243], v1, s[44:47], s69 offen sc1
v_mfma_f32_16x16x32_bf16 v[72:75], v[168:171], a[184:187], v[72:75]
s_nop 0
ds_read_b64_tr_b16 v[240:241], v8 offset:45056
ds_read_b64_tr_b16 v[242:243], v8 offset:47104
v_mfma_f32_16x16x32_bf16 v[72:75], v[152:155], a[180:183], v[72:75]
s_nop 0
ds_read_b64_tr_b16 v[244:245], v9 offset:45056
ds_read_b64_tr_b16 v[246:247], v9 offset:47104
v_mfma_f32_16x16x32_bf16 v[72:75], v[136:139], a[176:179], v[72:75]
s_nop 0
ds_read_b64_tr_b16 v[248:249], v10 offset:45056
ds_read_b64_tr_b16 v[250:251], v10 offset:47104
v_mfma_f32_16x16x32_bf16 v[76:79], v[140:143], a[176:179], v[76:79]
s_add_u32 s72, s71, 46080
buffer_load_dwordx4 v15, s[24:27], s72 offen offset:3072 lds
v_mfma_f32_16x16x32_bf16 v[76:79], v[156:159], a[180:183], v[76:79]
s_nop 0
ds_read_b64_tr_b16 v[252:253], v11 offset:45056
ds_read_b64_tr_b16 v[254:255], v11 offset:47104
v_mfma_f32_16x16x32_bf16 v[76:79], v[172:175], a[184:187], v[76:79]
v_mfma_f32_16x16x32_bf16 v[76:79], v[188:191], a[188:191], v[76:79]
buffer_load_dwordx4 a[244:247], v1, s[44:47], s69 offen offset:1024 sc1
v_mfma_f32_16x16x32_bf16 v[60:63], v[188:191], a[172:175], v[60:63]
v_mfma_f32_16x16x32_bf16 v[60:63], v[172:175], a[168:171], v[60:63]
s_add_u32 s71, s12, 0x400000
v_mfma_f32_16x16x32_bf16 v[60:63], v[156:159], a[164:167], v[60:63]
s_waitcnt vmcnt(18) lgkmcnt(0)
v_mfma_f32_16x16x32_bf16 v[60:63], v[140:143], a[160:163], v[60:63]
s_barrier
v_mfma_f32_16x16x32_bf16 v[16:19], v[192:195], a[128:131], v[16:19]
s_and_b32 s71, s71, 0x7c0000
ds_read_b64_tr_b16 v[128:129], v8 offset:49152
ds_read_b64_tr_b16 v[130:131], v8 offset:51200
v_mfma_f32_16x16x32_bf16 v[16:19], v[208:211], a[132:135], v[16:19]
s_add_u32 s71, s71, s78
ds_read_b64_tr_b16 v[132:133], v9 offset:49152
ds_read_b64_tr_b16 v[134:135], v9 offset:51200
v_mfma_f32_16x16x32_bf16 v[16:19], v[224:227], a[136:139], v[16:19]
s_add_u32 m0, s77, 32768
buffer_load_dwordx4 a[248:251], v1, s[44:47], s69 offen offset:2048 sc1
v_mfma_f32_16x16x32_bf16 v[16:19], v[240:243], a[140:143], v[16:19]
s_add_u32 s72, s71, 0
buffer_load_dwordx4 v15, s[24:27], s72 offen lds
v_mfma_f32_16x16x32_bf16 v[32:35], v[240:243], a[156:159], v[32:35]
s_nop 0
ds_read_b64_tr_b16 v[136:137], v10 offset:49152
ds_read_b64_tr_b16 v[138:139], v10 offset:51200
v_mfma_f32_16x16x32_bf16 v[32:35], v[224:227], a[152:155], v[32:35]
s_nop 0
ds_read_b64_tr_b16 v[140:141], v11 offset:49152
ds_read_b64_tr_b16 v[142:143], v11 offset:51200
v_mfma_f32_16x16x32_bf16 v[32:35], v[208:211], a[148:151], v[32:35]
s_nop 0
ds_read_b64_tr_b16 v[144:145], v8 offset:53248
ds_read_b64_tr_b16 v[146:147], v8 offset:55296
v_mfma_f32_16x16x32_bf16 v[32:35], v[192:195], a[144:147], v[32:35]
s_nop 0
ds_read_b64_tr_b16 v[148:149], v9 offset:53248
ds_read_b64_tr_b16 v[150:151], v9 offset:55296
v_mfma_f32_16x16x32_bf16 v[36:39], v[196:199], a[144:147], v[36:39]
v_mfma_f32_16x16x32_bf16 v[36:39], v[212:215], a[148:151], v[36:39]
buffer_load_dwordx4 a[252:255], v1, s[44:47], s69 offen offset:3072 sc1
v_mfma_f32_16x16x32_bf16 v[36:39], v[228:231], a[152:155], v[36:39]
s_add_u32 s72, s71, 15360
buffer_load_dwordx4 v15, s[24:27], s72 offen offset:1024 lds
v_mfma_f32_16x16x32_bf16 v[36:39], v[244:247], a[156:159], v[36:39]
s_nop 0
ds_read_b64_tr_b16 v[152:153], v10 offset:53248
ds_read_b64_tr_b16 v[154:155], v10 offset:55296
v_mfma_f32_16x16x32_bf16 v[20:23], v[244:247], a[140:143], v[20:23]
s_nop 0
ds_read_b64_tr_b16 v[156:157], v11 offset:53248
ds_read_b64_tr_b16 v[158:159], v11 offset:55296
v_mfma_f32_16x16x32_bf16 v[20:23], v[228:231], a[136:139], v[20:23]
s_nop 0
ds_read_b64_tr_b16 v[160:161], v8 offset:57344
ds_read_b64_tr_b16 v[162:163], v8 offset:59392
v_mfma_f32_16x16x32_bf16 v[20:23], v[212:215], a[132:135], v[20:23]
s_nop 0
ds_read_b64_tr_b16 v[164:165], v9 offset:57344
ds_read_b64_tr_b16 v[166:167], v9 offset:59392
v_mfma_f32_16x16x32_bf16 v[20:23], v[196:199], a[128:131], v[20:23]
s_nop 0
ds_read_b64_tr_b16 v[168:169], v10 offset:57344
ds_read_b64_tr_b16 v[170:171], v10 offset:59392
v_mfma_f32_16x16x32_bf16 v[24:27], v[200:203], a[128:131], v[24:27]
s_waitcnt vmcnt(59)
v_cmp_gt_u32 vcc, 2, v3
s_cbranch_vccnz Lspin109
Lback110:
s_add_u32 s82, s59, 28
s_and_b32 s82, s82, 28
s_lshl_b32 s82, s82, 10
s_add_u32 s82, s82, s74
buffer_load_dword v3, v2, s[44:47], s82 offen sc1
s_add_u32 s69, s12, 0x400000
s_and_b32 s69, s69, 0x7c0000
s_lshr_b32 s69, s69, 6
s_add_u32 s69, s69, s95
buffer_load_dwordx4 a[0:3], v1, s[44:47], s69 offen sc1
v_mfma_f32_16x16x32_bf16 v[24:27], v[216:219], a[132:135], v[24:27]
s_add_u32 s72, s71, 30720
buffer_load_dwordx4 v15, s[24:27], s72 offen offset:2048 lds
v_mfma_f32_16x16x32_bf16 v[24:27], v[232:235], a[136:139], v[24:27]
v_mfma_f32_16x16x32_bf16 v[24:27], v[248:251], a[140:143], v[24:27]
s_nop 0
ds_read_b64_tr_b16 v[172:173], v11 offset:57344
ds_read_b64_tr_b16 v[174:175], v11 offset:59392
v_mfma_f32_16x16x32_bf16 v[40:43], v[248:251], a[156:159], v[40:43]
s_nop 0
ds_read_b64_tr_b16 v[176:177], v8 offset:61440
ds_read_b64_tr_b16 v[178:179], v8 offset:63488
v_mfma_f32_16x16x32_bf16 v[40:43], v[232:235], a[152:155], v[40:43]
s_nop 0
ds_read_b64_tr_b16 v[180:181], v9 offset:61440
ds_read_b64_tr_b16 v[182:183], v9 offset:63488
v_mfma_f32_16x16x32_bf16 v[40:43], v[216:219], a[148:151], v[40:43]
buffer_load_dwordx4 a[4:7], v1, s[44:47], s69 offen offset:1024 sc1
v_mfma_f32_16x16x32_bf16 v[40:43], v[200:203], a[144:147], v[40:43]
s_nop 0
ds_read_b64_tr_b16 v[184:185], v10 offset:61440
ds_read_b64_tr_b16 v[186:187], v10 offset:63488
v_mfma_f32_16x16x32_bf16 v[44:47], v[204:207], a[144:147], v[44:47]
s_add_u32 s72, s71, 46080
buffer_load_dwordx4 v15, s[24:27], s72 offen offset:3072 lds
v_mfma_f32_16x16x32_bf16 v[44:47], v[220:223], a[148:151], v[44:47]
s_nop 0
ds_read_b64_tr_b16 v[188:189], v11 offset:61440
ds_read_b64_tr_b16 v[190:191], v11 offset:63488
v_mfma_f32_16x16x32_bf16 v[44:47], v[236:239], a[152:155], v[44:47]
v_mfma_f32_16x16x32_bf16 v[44:47], v[252:255], a[156:159], v[44:47]
v_mfma_f32_16x16x32_bf16 v[28:31], v[252:255], a[140:143], v[28:31]
v_mfma_f32_16x16x32_bf16 v[28:31], v[236:239], a[136:139], v[28:31]
s_add_u32 s71, s14, 0x200000
buffer_load_dwordx4 a[8:11], v1, s[44:47], s69 offen offset:2048 sc1
v_mfma_f32_16x16x32_bf16 v[28:31], v[220:223], a[132:135], v[28:31]
s_waitcnt vmcnt(20) lgkmcnt(0)
v_mfma_f32_16x16x32_bf16 v[28:31], v[204:207], a[128:131], v[28:31]
s_barrier
v_mfma_f32_16x16x32_bf16 v[48:51], v[128:131], a[192:195], v[48:51]
s_and_b32 s71, s71, 0x7c0000
ds_read_b64_tr_b16 v[192:193], v8 offset:0
ds_read_b64_tr_b16 v[194:195], v8 offset:2048
s_lshl_b32 s84, s76, 11
s_add_u32 s84, s84, 0x3810000
v_lshrrev_b32 v115, 2, v0
v_lshlrev_b32 v115, 7, v115
buffer_load_dword v114, v115, s[44:47], s84 offen sc1
v_mfma_f32_16x16x32_bf16 v[48:51], v[144:147], a[196:199], v[48:51]
s_add_u32 s71, s71, s94
ds_read_b64_tr_b16 v[196:197], v9 offset:0
ds_read_b64_tr_b16 v[198:199], v9 offset:2048
v_mfma_f32_16x16x32_bf16 v[48:51], v[160:163], a[200:203], v[48:51]
s_add_u32 m0, s77, 49152
ds_read_b64_tr_b16 v[200:201], v10 offset:0
ds_read_b64_tr_b16 v[202:203], v10 offset:2048
v_mfma_f32_16x16x32_bf16 v[48:51], v[176:179], a[204:207], v[48:51]
s_add_u32 s72, s71, 0
buffer_load_dwordx4 v15, s[24:27], s72 offen lds
v_mfma_f32_16x16x32_bf16 v[64:67], v[176:179], a[220:223], v[64:67]
buffer_load_dwordx4 a[12:15], v1, s[44:47], s69 offen offset:3072 sc1
v_mfma_f32_16x16x32_bf16 v[64:67], v[160:163], a[216:219], v[64:67]
s_nop 0
ds_read_b64_tr_b16 v[204:205], v11 offset:0
ds_read_b64_tr_b16 v[206:207], v11 offset:2048
v_mfma_f32_16x16x32_bf16 v[64:67], v[144:147], a[212:215], v[64:67]
s_nop 0
ds_read_b64_tr_b16 v[208:209], v8 offset:4096
ds_read_b64_tr_b16 v[210:211], v8 offset:6144
v_mfma_f32_16x16x32_bf16 v[64:67], v[128:131], a[208:211], v[64:67]
s_nop 0
ds_read_b64_tr_b16 v[212:213], v9 offset:4096
ds_read_b64_tr_b16 v[214:215], v9 offset:6144
v_mfma_f32_16x16x32_bf16 v[68:71], v[132:135], a[208:211], v[68:71]
s_nop 0
ds_read_b64 v[80:81], v116 offset:0
ds_read_b64 v[82:83], v117 offset:0
v_mfma_f32_16x16x32_bf16 v[68:71], v[148:151], a[212:215], v[68:71]
s_nop 0
ds_read_b64_tr_b16 v[216:217], v10 offset:4096
ds_read_b64_tr_b16 v[218:219], v10 offset:6144
v_mfma_f32_16x16x32_bf16 v[68:71], v[164:167], a[216:219], v[68:71]
s_add_u32 s72, s71, 15360
buffer_load_dwordx4 v15, s[24:27], s72 offen offset:1024 lds
v_mfma_f32_16x16x32_bf16 v[68:71], v[180:183], a[220:223], v[68:71]
s_add_u32 s69, s69, 0x20000
buffer_load_dwordx4 a[16:19], v1, s[44:47], s69 offen sc1
v_mfma_f32_16x16x32_bf16 v[52:55], v[180:183], a[204:207], v[52:55]
s_nop 0
ds_read_b64_tr_b16 v[220:221], v11 offset:4096
ds_read_b64_tr_b16 v[222:223], v11 offset:6144
v_mfma_f32_16x16x32_bf16 v[52:55], v[164:167], a[200:203], v[52:55]
s_nop 0
ds_read_b64_tr_b16 v[224:225], v8 offset:8192
ds_read_b64_tr_b16 v[226:227], v8 offset:10240
v_mfma_f32_16x16x32_bf16 v[52:55], v[148:151], a[196:199], v[52:55]
s_nop 0
ds_read_b64_tr_b16 v[228:229], v9 offset:8192
ds_read_b64_tr_b16 v[230:231], v9 offset:10240
v_mfma_f32_16x16x32_bf16 v[52:55], v[132:135], a[192:195], v[52:55]
s_nop 0
ds_read_b64_tr_b16 v[232:233], v10 offset:8192
ds_read_b64_tr_b16 v[234:235], v10 offset:10240
v_mfma_f32_16x16x32_bf16 v[56:59], v[136:139], a[192:195], v[56:59]
s_nop 0
ds_read_b64 v[84:85], v118 offset:0
ds_read_b64 v[86:87], v119 offset:0
v_mfma_f32_16x16x32_bf16 v[56:59], v[152:155], a[196:199], v[56:59]
s_add_u32 s72, s71, 30720
buffer_load_dwordx4 v15, s[24:27], s72 offen offset:2048 lds
v_mfma_f32_16x16x32_bf16 v[56:59], v[168:171], a[200:203], v[56:59]
buffer_load_dwordx4 a[20:23], v1, s[44:47], s69 offen offset:1024 sc1
v_mfma_f32_16x16x32_bf16 v[56:59], v[184:187], a[204:207], v[56:59]
s_nop 0
ds_read_b64_tr_b16 v[236:237], v11 offset:8192
ds_read_b64_tr_b16 v[238:239], v11 offset:10240
v_mfma_f32_16x16x32_bf16 v[72:75], v[184:187], a[220:223], v[72:75]
s_nop 0
ds_read_b64_tr_b16 v[240:241], v8 offset:12288
ds_read_b64_tr_b16 v[242:243], v8 offset:14336
v_mfma_f32_16x16x32_bf16 v[72:75], v[168:171], a[216:219], v[72:75]
s_nop 0
ds_read_b64_tr_b16 v[244:245], v9 offset:12288
ds_read_b64_tr_b16 v[246:247], v9 offset:14336
v_mfma_f32_16x16x32_bf16 v[72:75], v[152:155], a[212:215], v[72:75]
s_nop 0
ds_read_b64_tr_b16 v[248:249], v10 offset:12288
ds_read_b64_tr_b16 v[250:251], v10 offset:14336
v_mfma_f32_16x16x32_bf16 v[72:75], v[136:139], a[208:211], v[72:75]
s_nop 0
ds_read_b64_tr_b16 v[252:253], v11 offset:12288
ds_read_b64_tr_b16 v[254:255], v11 offset:14336
v_mfma_f32_16x16x32_bf16 v[76:79], v[140:143], a[208:211], v[76:79]
s_add_u32 s72, s71, 46080
buffer_load_dwordx4 v15, s[24:27], s72 offen offset:3072 lds
v_mfma_f32_16x16x32_bf16 v[76:79], v[156:159], a[212:215], v[76:79]
buffer_load_dwordx4 a[24:27], v1, s[44:47], s69 offen offset:2048 sc1
v_mfma_f32_16x16x32_bf16 v[76:79], v[172:175], a[216:219], v[76:79]
s_nop 0
ds_read_b64 v[96:97], v116 offset:2048
ds_read_b64 v[98:99], v117 offset:2048
v_mfma_f32_16x16x32_bf16 v[76:79], v[188:191], a[220:223], v[76:79]
s_nop 0
ds_read_b64 v[100:101], v118 offset:2048
ds_read_b64 v[102:103], v119 offset:2048
v_mfma_f32_16x16x32_bf16 v[60:63], v[188:191], a[204:207], v[60:63]
v_mfma_f32_16x16x32_bf16 v[60:63], v[172:175], a[200:203], v[60:63]
s_add_u32 s71, s13, 0x400000
v_mfma_f32_16x16x32_bf16 v[60:63], v[156:159], a[196:199], v[60:63]
s_waitcnt vmcnt(20) lgkmcnt(0)
v_mfma_f32_16x16x32_bf16 v[60:63], v[140:143], a[192:195], v[60:63]
s_barrier
v_mfma_f32_16x16x32_bf16 v[16:19], v[192:195], a[160:163], v[16:19]
s_and_b32 s71, s71, 0x7c0000
buffer_load_dwordx4 a[28:31], v1, s[44:47], s69 offen offset:3072 sc1
v_mfma_f32_16x16x32_bf16 v[16:19], v[208:211], a[164:167], v[16:19]
s_add_u32 s71, s71, s78
ds_read_b64_tr_b16 v[128:129], v8 offset:16384
ds_read_b64_tr_b16 v[130:131], v8 offset:18432
v_mfma_f32_16x16x32_bf16 v[16:19], v[224:227], a[168:171], v[16:19]
s_add_u32 m0, s77, 0
ds_read_b64_tr_b16 v[132:133], v9 offset:16384
ds_read_b64_tr_b16 v[134:135], v9 offset:18432
v_mfma_f32_16x16x32_bf16 v[16:19], v[240:243], a[172:175], v[16:19]
s_add_u32 s72, s71, 0
buffer_load_dwordx4 v15, s[24:27], s72 offen lds
v_mfma_f32_16x16x32_bf16 v[32:35], v[240:243], a[188:191], v[32:35]
s_add_u32 s69, s13, 0x400000
ds_read_b64_tr_b16 v[136:137], v10 offset:16384
ds_read_b64_tr_b16 v[138:139], v10 offset:18432
v_mfma_f32_16x16x32_bf16 v[32:35], v[224:227], a[184:187], v[32:35]
s_and_b32 s69, s69, 0x7c0000
ds_read_b64_tr_b16 v[140:141], v11 offset:16384
ds_read_b64_tr_b16 v[142:143], v11 offset:18432
v_mfma_f32_16x16x32_bf16 v[32:35], v[208:211], a[180:183], v[32:35]
s_lshr_b32 s69, s69, 6
ds_read_b64_tr_b16 v[144:145], v8 offset:20480
ds_read_b64_tr_b16 v[146:147], v8 offset:22528
v_mfma_f32_16x16x32_bf16 v[32:35], v[192:195], a[176:179], v[32:35]
s_add_u32 s69, s69, s95
buffer_load_dwordx4 a[32:35], v1, s[44:47], s69 offen sc1
v_mfma_f32_16x16x32_bf16 v[36:39], v[196:199], a[176:179], v[36:39]
s_nop 0
ds_read_b64_tr_b16 v[148:149], v9 offset:20480
ds_read_b64_tr_b16 v[150:151], v9 offset:22528
v_mfma_f32_16x16x32_bf16 v[36:39], v[212:215], a[180:183], v[36:39]
v_mfma_f32_16x16x32_bf16 v[36:39], v[228:231], a[184:187], v[36:39]
s_add_u32 s72, s71, 15360
buffer_load_dwordx4 v15, s[24:27], s72 offen offset:1024 lds
v_mfma_f32_16x16x32_bf16 v[36:39], v[244:247], a[188:191], v[36:39]
s_nop 0
ds_read_b64_tr_b16 v[152:153], v10 offset:20480
ds_read_b64_tr_b16 v[154:155], v10 offset:22528
v_mfma_f32_16x16x32_bf16 v[20:23], v[244:247], a[172:175], v[20:23]
s_nop 0
ds_read_b64_tr_b16 v[156:157], v11 offset:20480
ds_read_b64_tr_b16 v[158:159], v11 offset:22528
v_mfma_f32_16x16x32_bf16 v[20:23], v[228:231], a[168:171], v[20:23]
buffer_load_dwordx4 a[36:39], v1, s[44:47], s69 offen offset:1024 sc1
v_mfma_f32_16x16x32_bf16 v[20:23], v[212:215], a[164:167], v[20:23]
s_nop 0
ds_read_b64_tr_b16 v[160:161], v8 offset:24576
ds_read_b64_tr_b16 v[162:163], v8 offset:26624
v_mfma_f32_16x16x32_bf16 v[20:23], v[196:199], a[160:163], v[20:23]
s_nop 0
ds_read_b64_tr_b16 v[164:165], v9 offset:24576
ds_read_b64_tr_b16 v[166:167], v9 offset:26624
v_mfma_f32_16x16x32_bf16 v[24:27], v[200:203], a[160:163], v[24:27]
s_nop 0
ds_read_b64_tr_b16 v[168:169], v10 offset:24576
ds_read_b64_tr_b16 v[170:171], v10 offset:26624
v_mfma_f32_16x16x32_bf16 v[24:27], v[216:219], a[164:167], v[24:27]
s_add_u32 s72, s71, 30720
buffer_load_dwordx4 v15, s[24:27], s72 offen offset:2048 lds
v_mfma_f32_16x16x32_bf16 v[24:27], v[232:235], a[168:171], v[24:27]
v_mfma_f32_16x16x32_bf16 v[24:27], v[248:251], a[172:175], v[24:27]
s_nop 0
ds_read_b64_tr_b16 v[172:173], v11 offset:24576
ds_read_b64_tr_b16 v[174:175], v11 offset:26624
v_mfma_f32_16x16x32_bf16 v[40:43], v[248:251], a[188:191], v[40:43]
buffer_load_dwordx4 a[40:43], v1, s[44:47], s69 offen offset:2048 sc1
v_mfma_f32_16x16x32_bf16 v[40:43], v[232:235], a[184:187], v[40:43]
s_nop 0
ds_read_b64_tr_b16 v[176:177], v8 offset:28672
ds_read_b64_tr_b16 v[178:179], v8 offset:30720
v_mfma_f32_16x16x32_bf16 v[40:43], v[216:219], a[180:183], v[40:43]
s_nop 0
ds_read_b64_tr_b16 v[180:181], v9 offset:28672
ds_read_b64_tr_b16 v[182:183], v9 offset:30720
v_mfma_f32_16x16x32_bf16 v[40:43], v[200:203], a[176:179], v[40:43]
s_nop 0
ds_read_b64_tr_b16 v[184:185], v10 offset:28672
ds_read_b64_tr_b16 v[186:187], v10 offset:30720
v_mfma_f32_16x16x32_bf16 v[44:47], v[204:207], a[176:179], v[44:47]
s_add_u32 s72, s71, 46080
buffer_load_dwordx4 v15, s[24:27], s72 offen offset:3072 lds
v_mfma_f32_16x16x32_bf16 v[44:47], v[220:223], a[180:183], v[44:47]
s_nop 0
ds_read_b64_tr_b16 v[188:189], v11 offset:28672
ds_read_b64_tr_b16 v[190:191], v11 offset:30720
v_mfma_f32_16x16x32_bf16 v[44:47], v[236:239], a[184:187], v[44:47]
v_mfma_f32_16x16x32_bf16 v[44:47], v[252:255], a[188:191], v[44:47]
buffer_load_dwordx4 a[44:47], v1, s[44:47], s69 offen offset:3072 sc1
v_mfma_f32_16x16x32_bf16 v[28:31], v[252:255], a[172:175], v[28:31]
s_add_u32 s69, s69, 0x20000
v_mfma_f32_16x16x32_bf16 v[28:31], v[236:239], a[168:171], v[28:31]
s_add_u32 s71, s15, 0x200000
v_mfma_f32_16x16x32_bf16 v[28:31], v[220:223], a[164:167], v[28:31]
s_waitcnt vmcnt(19) lgkmcnt(0)
v_mfma_f32_16x16x32_bf16 v[28:31], v[204:207], a[160:163], v[28:31]
s_barrier
v_mfma_f32_16x16x32_bf16 v[48:51], v[128:131], a[224:227], v[48:51]
s_and_b32 s71, s71, 0x7c0000
ds_read_b64_tr_b16 v[192:193], v8 offset:32768
ds_read_b64_tr_b16 v[194:195], v8 offset:34816
v_mfma_f32_16x16x32_bf16 v[48:51], v[144:147], a[228:231], v[48:51]
s_add_u32 s71, s71, s94
ds_read_b64_tr_b16 v[196:197], v9 offset:32768
ds_read_b64_tr_b16 v[198:199], v9 offset:34816
v_mfma_f32_16x16x32_bf16 v[48:51], v[160:163], a[232:235], v[48:51]
s_add_u32 m0, s77, 16384
buffer_load_dwordx4 a[48:51], v1, s[44:47], s69 offen sc1
v_mfma_f32_16x16x32_bf16 v[48:51], v[176:179], a[236:239], v[48:51]
s_add_u32 s72, s71, 0
buffer_load_dwordx4 v15, s[24:27], s72 offen lds
v_mfma_f32_16x16x32_bf16 v[64:67], v[176:179], a[252:255], v[64:67]
s_nop 0
ds_read_b64_tr_b16 v[200:201], v10 offset:32768
ds_read_b64_tr_b16 v[202:203], v10 offset:34816
v_mfma_f32_16x16x32_bf16 v[64:67], v[160:163], a[248:251], v[64:67]
s_nop 0
ds_read_b64_tr_b16 v[204:205], v11 offset:32768
ds_read_b64_tr_b16 v[206:207], v11 offset:34816
v_mfma_f32_16x16x32_bf16 v[64:67], v[144:147], a[244:247], v[64:67]
s_nop 0
ds_read_b64_tr_b16 v[208:209], v8 offset:36864
ds_read_b64_tr_b16 v[210:211], v8 offset:38912
v_mfma_f32_16x16x32_bf16 v[64:67], v[128:131], a[240:243], v[64:67]
s_nop 0
ds_read_b64_tr_b16 v[212:213], v9 offset:36864
ds_read_b64_tr_b16 v[214:215], v9 offset:38912
v_mfma_f32_16x16x32_bf16 v[68:71], v[132:135], a[240:243], v[68:71]
s_waitcnt vmcnt(19)
v_cmp_gt_u32 vcc, 3, v114
s_cbranch_vccnz Lspin115
Lback116:
s_lshl_b32 s73, s76, 18
s_lshl_b32 s84, s58, 16
s_add_u32 s73, s73, s84
s_lshl_b32 s84, s75, 8
s_add_u32 s73, s73, s84
s_add_u32 s73, s73, 0x3400000
v_lshrrev_b32 v112, 4, v0
v_and_b32 v113, 15, v0
v_lshlrev_b32 v114, 4, v113
v_lshl_add_u32 v112, v112, 12, v114
v_lshlrev_b32 v113, 2, v113
v_mfma_f32_16x16x32_bf16 v[68:71], v[148:151], a[244:247], v[68:71]
buffer_load_dwordx4 a[52:55], v1, s[44:47], s69 offen offset:1024 sc1
v_mfma_f32_16x16x32_bf16 v[68:71], v[164:167], a[248:251], v[68:71]
s_add_u32 s72, s71, 15360
buffer_load_dwordx4 v15, s[24:27], s72 offen offset:1024 lds
v_mfma_f32_16x16x32_bf16 v[68:71], v[180:183], a[252:255], v[68:71]
s_nop 0
ds_read_b64_tr_b16 v[216:217], v10 offset:36864
ds_read_b64_tr_b16 v[218:219], v10 offset:38912
v_mfma_f32_16x16x32_bf16 v[52:55], v[180:183], a[236:239], v[52:55]
s_nop 0
ds_read_b64_tr_b16 v[220:221], v11 offset:36864
ds_read_b64_tr_b16 v[222:223], v11 offset:38912
v_mfma_f32_16x16x32_bf16 v[52:55], v[164:167], a[232:235], v[52:55]
s_nop 0
ds_read_b64_tr_b16 v[224:225], v8 offset:40960
ds_read_b64_tr_b16 v[226:227], v8 offset:43008
v_mfma_f32_16x16x32_bf16 v[52:55], v[148:151], a[228:231], v[52:55]
s_nop 0
ds_read_b64_tr_b16 v[228:229], v9 offset:40960
ds_read_b64_tr_b16 v[230:231], v9 offset:43008
v_mfma_f32_16x16x32_bf16 v[52:55], v[132:135], a[224:227], v[52:55]
s_nop 0
ds_read_b64_tr_b16 v[232:233], v10 offset:40960
ds_read_b64_tr_b16 v[234:235], v10 offset:43008
v_mfma_f32_16x16x32_bf16 v[56:59], v[136:139], a[224:227], v[56:59]
buffer_load_dwordx4 a[56:59], v1, s[44:47], s69 offen offset:2048 sc1
v_mfma_f32_16x16x32_bf16 v[56:59], v[152:155], a[228:231], v[56:59]
s_add_u32 s72, s71, 30720
buffer_load_dwordx4 v15, s[24:27], s72 offen offset:2048 lds
v_mfma_f32_16x16x32_bf16 v[56:59], v[168:171], a[232:235], v[56:59]
v_mfma_f32_16x16x32_bf16 v[56:59], v[184:187], a[236:239], v[56:59]
s_nop 0
ds_read_b64_tr_b16 v[236:237], v11 offset:40960
ds_read_b64_tr_b16 v[238:239], v11 offset:43008
v_mfma_f32_16x16x32_bf16 v[72:75], v[184:187], a[252:255], v[72:75]
s_nop 0
ds_read_b64_tr_b16 v[240:241], v8 offset:45056
ds_read_b64_tr_b16 v[242:243], v8 offset:47104
v_mfma_f32_16x16x32_bf16 v[72:75], v[168:171], a[248:251], v[72:75]
s_nop 0
ds_read_b64_tr_b16 v[244:245], v9 offset:45056
ds_read_b64_tr_b16 v[246:247], v9 offset:47104
v_mfma_f32_16x16x32_bf16 v[72:75], v[152:155], a[244:247], v[72:75]
s_nop 0
ds_read_b64_tr_b16 v[248:249], v10 offset:45056
ds_read_b64_tr_b16 v[250:251], v10 offset:47104
v_mfma_f32_16x16x32_bf16 v[72:75], v[136:139], a[240:243], v[72:75]
buffer_load_dwordx4 a[60:63], v1, s[44:47], s69 offen offset:3072 sc1
v_mfma_f32_16x16x32_bf16 v[76:79], v[140:143], a[240:243], v[76:79]
s_add_u32 s72, s71, 46080
buffer_load_dwordx4 v15, s[24:27], s72 offen offset:3072 lds
v_mfma_f32_16x16x32_bf16 v[76:79], v[156:159], a[244:247], v[76:79]
s_add_u32 s69, s14, 0x400000
ds_read_b64_tr_b16 v[252:253], v11 offset:45056
ds_read_b64_tr_b16 v[254:255], v11 offset:47104
v_mfma_f32_16x16x32_bf16 v[76:79], v[172:175], a[248:251], v[76:79]
s_and_b32 s69, s69, 0x7c0000
v_mfma_f32_16x16x32_bf16 v[76:79], v[188:191], a[252:255], v[76:79]
s_lshr_b32 s69, s69, 6
v_mfma_f32_16x16x32_bf16 v[60:63], v[188:191], a[236:239], v[60:63]
s_add_u32 s69, s69, s95
v_mfma_f32_16x16x32_bf16 v[60:63], v[172:175], a[232:235], v[60:63]
s_add_u32 s71, s14, 0x400000
v_mfma_f32_16x16x32_bf16 v[60:63], v[156:159], a[228:231], v[60:63]
s_waitcnt vmcnt(16) lgkmcnt(0)
buffer_load_dwordx4 a[64:67], v1, s[44:47], s69 offen sc1
v_mfma_f32_16x16x32_bf16 v[60:63], v[140:143], a[224:227], v[60:63]
s_barrier
v_mfma_f32_16x16x32_bf16 v[48:51], v[192:195], a[0:3], v[48:51]
s_and_b32 s71, s71, 0x7c0000
ds_read_b64_tr_b16 v[128:129], v8 offset:49152
ds_read_b64_tr_b16 v[130:131], v8 offset:51200
v_mfma_f32_16x16x32_bf16 v[48:51], v[208:211], a[4:7], v[48:51]
s_add_u32 s71, s71, s78
ds_read_b64_tr_b16 v[132:133], v9 offset:49152
ds_read_b64_tr_b16 v[134:135], v9 offset:51200
v_mfma_f32_16x16x32_bf16 v[48:51], v[224:227], a[8:11], v[48:51]
s_add_u32 m0, s77, 32768
ds_read_b64_tr_b16 v[136:137], v10 offset:49152
ds_read_b64_tr_b16 v[138:139], v10 offset:51200
v_mfma_f32_16x16x32_bf16 v[48:51], v[240:243], a[12:15], v[48:51]
s_add_u32 s72, s71, 0
buffer_load_dwordx4 v15, s[24:27], s72 offen lds
v_mfma_f32_16x16x32_bf16 v[64:67], v[240:243], a[28:31], v[64:67]
buffer_load_dwordx4 a[68:71], v1, s[44:47], s69 offen offset:1024 sc1
v_mfma_f32_16x16x32_bf16 v[64:67], v[224:227], a[24:27], v[64:67]
s_nop 0
ds_read_b64_tr_b16 v[140:141], v11 offset:49152
ds_read_b64_tr_b16 v[142:143], v11 offset:51200
v_mfma_f32_16x16x32_bf16 v[64:67], v[208:211], a[20:23], v[64:67]
s_add_u32 s72, s71, 15360
buffer_load_dwordx4 v15, s[24:27], s72 offen offset:1024 lds
v_mfma_f32_16x16x32_bf16 v[64:67], v[192:195], a[16:19], v[64:67]
s_nop 0
ds_read_b64_tr_b16 v[144:145], v8 offset:53248
ds_read_b64_tr_b16 v[146:147], v8 offset:55296
v_mfma_f32_16x16x32_bf16 v[68:71], v[196:199], a[16:19], v[68:71]
s_nop 0
ds_read_b64_tr_b16 v[148:149], v9 offset:53248
ds_read_b64_tr_b16 v[150:151], v9 offset:55296
v_mfma_f32_16x16x32_bf16 v[68:71], v[212:215], a[20:23], v[68:71]
s_nop 0
ds_read_b64_tr_b16 v[152:153], v10 offset:53248
ds_read_b64_tr_b16 v[154:155], v10 offset:55296
v_mfma_f32_16x16x32_bf16 v[68:71], v[228:231], a[24:27], v[68:71]
s_add_u32 s72, s71, 30720
buffer_load_dwordx4 v15, s[24:27], s72 offen offset:2048 lds
v_mfma_f32_16x16x32_bf16 v[68:71], v[244:247], a[28:31], v[68:71]
buffer_load_dwordx4 a[72:75], v1, s[44:47], s69 offen offset:2048 sc1
v_mfma_f32_16x16x32_bf16 v[52:55], v[244:247], a[12:15], v[52:55]
s_nop 0
ds_read_b64_tr_b16 v[156:157], v11 offset:53248
ds_read_b64_tr_b16 v[158:159], v11 offset:55296
v_mfma_f32_16x16x32_bf16 v[52:55], v[228:231], a[8:11], v[52:55]
s_add_u32 s72, s71, 46080
buffer_load_dwordx4 v15, s[24:27], s72 offen offset:3072 lds
v_mfma_f32_16x16x32_bf16 v[52:55], v[212:215], a[4:7], v[52:55]
s_nop 0
ds_read_b64_tr_b16 v[160:161], v8 offset:57344
ds_read_b64_tr_b16 v[162:163], v8 offset:59392
v_mfma_f32_16x16x32_bf16 v[52:55], v[196:199], a[0:3], v[52:55]
s_nop 0
ds_read_b64_tr_b16 v[164:165], v9 offset:57344
ds_read_b64_tr_b16 v[166:167], v9 offset:59392
v_mfma_f32_16x16x32_bf16 v[56:59], v[200:203], a[0:3], v[56:59]
s_add_u32 m0, s64, 147456
ds_read_b64_tr_b16 v[168:169], v10 offset:57344
ds_read_b64_tr_b16 v[170:171], v10 offset:59392
v_mfma_f32_16x16x32_bf16 v[56:59], v[216:219], a[4:7], v[56:59]
s_add_u32 s72, s73, 0
buffer_load_dwordx4 v112, s[44:47], s72 offen sc1 lds
v_mfma_f32_16x16x32_bf16 v[56:59], v[232:235], a[8:11], v[56:59]
buffer_load_dwordx4 a[76:79], v1, s[44:47], s69 offen offset:3072 sc1
v_mfma_f32_16x16x32_bf16 v[56:59], v[248:251], a[12:15], v[56:59]
s_nop 0
ds_read_b64_tr_b16 v[172:173], v11 offset:57344
ds_read_b64_tr_b16 v[174:175], v11 offset:59392
v_mfma_f32_16x16x32_bf16 v[72:75], v[248:251], a[28:31], v[72:75]
s_add_u32 s72, s73, 15360
buffer_load_dwordx4 v112, s[44:47], s72 offen offset:1024 sc1 lds
v_mfma_f32_16x16x32_bf16 v[72:75], v[232:235], a[24:27], v[72:75]
s_nop 0
ds_read_b64_tr_b16 v[176:177], v8 offset:61440
ds_read_b64_tr_b16 v[178:179], v8 offset:63488
v_mfma_f32_16x16x32_bf16 v[72:75], v[216:219], a[20:23], v[72:75]
s_nop 0
ds_read_b64_tr_b16 v[180:181], v9 offset:61440
ds_read_b64_tr_b16 v[182:183], v9 offset:63488
v_mfma_f32_16x16x32_bf16 v[72:75], v[200:203], a[16:19], v[72:75]
s_nop 0
ds_read_b64_tr_b16 v[184:185], v10 offset:61440
ds_read_b64_tr_b16 v[186:187], v10 offset:63488
v_mfma_f32_16x16x32_bf16 v[76:79], v[204:207], a[16:19], v[76:79]
s_add_u32 s72, s73, 30720
buffer_load_dwordx4 v112, s[44:47], s72 offen offset:2048 sc1 lds
v_mfma_f32_16x16x32_bf16 v[76:79], v[220:223], a[20:23], v[76:79]
s_add_u32 s69, s69, 0x20000
buffer_load_dwordx4 a[80:83], v1, s[44:47], s69 offen sc1
v_mfma_f32_16x16x32_bf16 v[76:79], v[236:239], a[24:27], v[76:79]
s_nop 0
ds_read_b64_tr_b16 v[188:189], v11 offset:61440
ds_read_b64_tr_b16 v[190:191], v11 offset:63488
v_mfma_f32_16x16x32_bf16 v[76:79], v[252:255], a[28:31], v[76:79]
s_add_u32 s72, s73, 46080
buffer_load_dwordx4 v112, s[44:47], s72 offen offset:3072 sc1 lds
v_mfma_f32_16x16x32_bf16 v[60:63], v[252:255], a[12:15], v[60:63]
v_mfma_f32_16x16x32_bf16 v[60:63], v[236:239], a[8:11], v[60:63]
s_add_u32 s71, s12, 0x400000
v_mfma_f32_16x16x32_bf16 v[60:63], v[220:223], a[4:7], v[60:63]
s_waitcnt vmcnt(22) lgkmcnt(0)
v_mfma_f32_16x16x32_bf16 v[60:63], v[204:207], a[0:3], v[60:63]
s_barrier
v_mfma_f32_16x16x32_bf16 v[16:19], v[128:131], a[192:195], v[16:19]
s_and_b32 s71, s71, 0x7c0000
buffer_load_dwordx4 a[84:87], v1, s[44:47], s69 offen offset:1024 sc1
v_mfma_f32_16x16x32_bf16 v[16:19], v[144:147], a[196:199], v[16:19]
s_add_u32 s71, s71, s94
ds_read_b64_tr_b16 v[192:193], v8 offset:0
ds_read_b64_tr_b16 v[194:195], v8 offset:2048
v_mfma_f32_16x16x32_bf16 v[16:19], v[160:163], a[200:203], v[16:19]
s_add_u32 m0, s77, 49152
ds_read_b64_tr_b16 v[196:197], v9 offset:0
ds_read_b64_tr_b16 v[198:199], v9 offset:2048
s_lshl_b32 s73, s75, 9
s_lshl_b32 s84, s58, 7
s_add_u32 s73, s73, s84
s_add_u32 s73, s73, 0x3800000
buffer_load_dword v6, v113, s[44:47], s73 offen sc1
buffer_load_dword v7, v113, s[44:47], s73 offen offset:64 sc1
v_mfma_f32_16x16x32_bf16 v[16:19], v[176:179], a[204:207], v[16:19]
s_add_u32 s72, s71, 0
buffer_load_dwordx4 v15, s[24:27], s72 offen lds
v_mfma_f32_16x16x32_bf16 v[32:35], v[176:179], a[220:223], v[32:35]
s_nop 0
ds_read_b64_tr_b16 v[200:201], v10 offset:0
ds_read_b64_tr_b16 v[202:203], v10 offset:2048
v_mfma_f32_16x16x32_bf16 v[32:35], v[160:163], a[216:219], v[32:35]
s_nop 0
ds_read_b64_tr_b16 v[204:205], v11 offset:0
ds_read_b64_tr_b16 v[206:207], v11 offset:2048
v_mfma_f32_16x16x32_bf16 v[32:35], v[144:147], a[212:215], v[32:35]
s_nop 0
ds_read_b64_tr_b16 v[208:209], v8 offset:4096
ds_read_b64_tr_b16 v[210:211], v8 offset:6144
v_mfma_f32_16x16x32_bf16 v[32:35], v[128:131], a[208:211], v[32:35]
buffer_load_dwordx4 a[88:91], v1, s[44:47], s69 offen offset:2048 sc1
v_mfma_f32_16x16x32_bf16 v[36:39], v[132:135], a[208:211], v[36:39]
s_nop 0
ds_read_b64_tr_b16 v[212:213], v9 offset:4096
ds_read_b64_tr_b16 v[214:215], v9 offset:6144
v_mfma_f32_16x16x32_bf16 v[36:39], v[148:151], a[212:215], v[36:39]
v_mfma_f32_16x16x32_bf16 v[36:39], v[164:167], a[216:219], v[36:39]
s_add_u32 s72, s71, 15360
buffer_load_dwordx4 v15, s[24:27], s72 offen offset:1024 lds
v_mfma_f32_16x16x32_bf16 v[36:39], v[180:183], a[220:223], v[36:39]
s_nop 0
ds_read_b64_tr_b16 v[216:217], v10 offset:4096
ds_read_b64_tr_b16 v[218:219], v10 offset:6144
v_mfma_f32_16x16x32_bf16 v[20:23], v[180:183], a[204:207], v[20:23]
s_nop 0
ds_read_b64_tr_b16 v[220:221], v11 offset:4096
ds_read_b64_tr_b16 v[222:223], v11 offset:6144
v_mfma_f32_16x16x32_bf16 v[20:23], v[164:167], a[200:203], v[20:23]
s_nop 0
ds_read_b64_tr_b16 v[224:225], v8 offset:8192
ds_read_b64_tr_b16 v[226:227], v8 offset:10240
v_mfma_f32_16x16x32_bf16 v[20:23], v[148:151], a[196:199], v[20:23]
buffer_load_dwordx4 a[92:95], v1, s[44:47], s69 offen offset:3072 sc1
v_mfma_f32_16x16x32_bf16 v[20:23], v[132:135], a[192:195], v[20:23]
s_nop 0
ds_read_b64_tr_b16 v[228:229], v9 offset:8192
ds_read_b64_tr_b16 v[230:231], v9 offset:10240
v_mfma_f32_16x16x32_bf16 v[24:27], v[136:139], a[192:195], v[24:27]
s_nop 0
ds_read_b64_tr_b16 v[232:233], v10 offset:8192
ds_read_b64_tr_b16 v[234:235], v10 offset:10240
v_mfma_f32_16x16x32_bf16 v[24:27], v[152:155], a[196:199], v[24:27]
s_add_u32 s72, s71, 30720
buffer_load_dwordx4 v15, s[24:27], s72 offen offset:2048 lds
v_mfma_f32_16x16x32_bf16 v[24:27], v[168:171], a[200:203], v[24:27]
s_add_u32 s69, s15, 0x400000
v_mfma_f32_16x16x32_bf16 v[24:27], v[184:187], a[204:207], v[24:27]
s_and_b32 s69, s69, 0x7c0000
ds_read_b64_tr_b16 v[236:237], v11 offset:8192
ds_read_b64_tr_b16 v[238:239], v11 offset:10240
v_mfma_f32_16x16x32_bf16 v[40:43], v[184:187], a[220:223], v[40:43]
s_lshr_b32 s69, s69, 6
ds_read_b64_tr_b16 v[240:241], v8 offset:12288
ds_read_b64_tr_b16 v[242:243], v8 offset:14336
v_mfma_f32_16x16x32_bf16 v[40:43], v[168:171], a[216:219], v[40:43]
s_add_u32 s69, s69, s95
buffer_load_dwordx4 a[96:99], v1, s[44:47], s69 offen sc1
v_mfma_f32_16x16x32_bf16 v[40:43], v[152:155], a[212:215], v[40:43]
s_nop 0
ds_read_b64_tr_b16 v[244:245], v9 offset:12288
ds_read_b64_tr_b16 v[246:247], v9 offset:14336
v_mfma_f32_16x16x32_bf16 v[40:43], v[136:139], a[208:211], v[40:43]
s_nop 0
ds_read_b64_tr_b16 v[248:249], v10 offset:12288
ds_read_b64_tr_b16 v[250:251], v10 offset:14336
v_mfma_f32_16x16x32_bf16 v[44:47], v[140:143], a[208:211], v[44:47]
s_add_u32 s72, s71, 46080
buffer_load_dwordx4 v15, s[24:27], s72 offen offset:3072 lds
v_mfma_f32_16x16x32_bf16 v[44:47], v[156:159], a[212:215], v[44:47]
s_nop 0
ds_read_b64_tr_b16 v[252:253], v11 offset:12288
ds_read_b64_tr_b16 v[254:255], v11 offset:14336
v_mfma_f32_16x16x32_bf16 v[44:47], v[172:175], a[216:219], v[44:47]
v_mfma_f32_16x16x32_bf16 v[44:47], v[188:191], a[220:223], v[44:47]
buffer_load_dwordx4 a[100:103], v1, s[44:47], s69 offen offset:1024 sc1
v_mfma_f32_16x16x32_bf16 v[28:31], v[188:191], a[204:207], v[28:31]
v_mfma_f32_16x16x32_bf16 v[28:31], v[172:175], a[200:203], v[28:31]
s_add_u32 s71, s15, 0x400000
v_mfma_f32_16x16x32_bf16 v[28:31], v[156:159], a[196:199], v[28:31]
s_waitcnt vmcnt(24) lgkmcnt(0)
v_mfma_f32_16x16x32_bf16 v[28:31], v[140:143], a[192:195], v[28:31]
s_barrier
v_mfma_f32_16x16x32_bf16 v[48:51], v[192:195], a[32:35], v[48:51]
s_and_b32 s71, s71, 0x7c0000
ds_read_b64_tr_b16 v[128:129], v8 offset:16384
ds_read_b64_tr_b16 v[130:131], v8 offset:18432
v_mfma_f32_16x16x32_bf16 v[48:51], v[208:211], a[36:39], v[48:51]
s_add_u32 s71, s71, s78
ds_read_b64_tr_b16 v[132:133], v9 offset:16384
ds_read_b64_tr_b16 v[134:135], v9 offset:18432
v_mfma_f32_16x16x32_bf16 v[48:51], v[224:227], a[40:43], v[48:51]
s_add_u32 m0, s77, 0
buffer_load_dwordx4 a[104:107], v1, s[44:47], s69 offen offset:2048 sc1
v_mfma_f32_16x16x32_bf16 v[48:51], v[240:243], a[44:47], v[48:51]
s_add_u32 s72, s71, 0
buffer_load_dwordx4 v15, s[24:27], s72 offen lds
v_mfma_f32_16x16x32_bf16 v[64:67], v[240:243], a[60:63], v[64:67]
s_nop 0
ds_read_b64_tr_b16 v[136:137], v10 offset:16384
ds_read_b64_tr_b16 v[138:139], v10 offset:18432
v_mfma_f32_16x16x32_bf16 v[64:67], v[224:227], a[56:59], v[64:67]
s_nop 0
ds_read_b64_tr_b16 v[140:141], v11 offset:16384
ds_read_b64_tr_b16 v[142:143], v11 offset:18432
v_mfma_f32_16x16x32_bf16 v[64:67], v[208:211], a[52:55], v[64:67]
s_nop 0
ds_read_b64_tr_b16 v[144:145], v8 offset:20480
ds_read_b64_tr_b16 v[146:147], v8 offset:22528
v_mfma_f32_16x16x32_bf16 v[64:67], v[192:195], a[48:51], v[64:67]
s_nop 0
ds_read_b64_tr_b16 v[148:149], v9 offset:20480
ds_read_b64_tr_b16 v[150:151], v9 offset:22528
v_mfma_f32_16x16x32_bf16 v[68:71], v[196:199], a[48:51], v[68:71]
v_mfma_f32_16x16x32_bf16 v[68:71], v[212:215], a[52:55], v[68:71]
buffer_load_dwordx4 a[108:111], v1, s[44:47], s69 offen offset:3072 sc1
v_mfma_f32_16x16x32_bf16 v[68:71], v[228:231], a[56:59], v[68:71]
s_add_u32 s72, s71, 15360
buffer_load_dwordx4 v15, s[24:27], s72 offen offset:1024 lds
v_mfma_f32_16x16x32_bf16 v[68:71], v[244:247], a[60:63], v[68:71]
s_nop 0
ds_read_b64_tr_b16 v[152:153], v10 offset:20480
ds_read_b64_tr_b16 v[154:155], v10 offset:22528
v_mfma_f32_16x16x32_bf16 v[52:55], v[244:247], a[44:47], v[52:55]
s_nop 0
ds_read_b64_tr_b16 v[156:157], v11 offset:20480
ds_read_b64_tr_b16 v[158:159], v11 offset:22528
v_mfma_f32_16x16x32_bf16 v[52:55], v[228:231], a[40:43], v[52:55]
s_nop 0
ds_read_b64_tr_b16 v[160:161], v8 offset:24576
ds_read_b64_tr_b16 v[162:163], v8 offset:26624
v_mfma_f32_16x16x32_bf16 v[52:55], v[212:215], a[36:39], v[52:55]
s_nop 0
ds_read_b64_tr_b16 v[164:165], v9 offset:24576
ds_read_b64_tr_b16 v[166:167], v9 offset:26624
v_mfma_f32_16x16x32_bf16 v[52:55], v[196:199], a[32:35], v[52:55]
s_nop 0
ds_read_b64_tr_b16 v[168:169], v10 offset:24576
ds_read_b64_tr_b16 v[170:171], v10 offset:26624
v_mfma_f32_16x16x32_bf16 v[56:59], v[200:203], a[32:35], v[56:59]
s_add_u32 s69, s69, 0x20000
buffer_load_dwordx4 a[112:115], v1, s[44:47], s69 offen sc1
v_mfma_f32_16x16x32_bf16 v[56:59], v[216:219], a[36:39], v[56:59]
s_add_u32 s72, s71, 30720
buffer_load_dwordx4 v15, s[24:27], s72 offen offset:2048 lds
v_mfma_f32_16x16x32_bf16 v[56:59], v[232:235], a[40:43], v[56:59]
v_mfma_f32_16x16x32_bf16 v[56:59], v[248:251], a[44:47], v[56:59]
s_nop 0
ds_read_b64_tr_b16 v[172:173], v11 offset:24576
ds_read_b64_tr_b16 v[174:175], v11 offset:26624
v_mfma_f32_16x16x32_bf16 v[72:75], v[248:251], a[60:63], v[72:75]
s_nop 0
ds_read_b64_tr_b16 v[176:177], v8 offset:28672
ds_read_b64_tr_b16 v[178:179], v8 offset:30720
v_mfma_f32_16x16x32_bf16 v[72:75], v[232:235], a[56:59], v[72:75]
s_nop 0
ds_read_b64_tr_b16 v[180:181], v9 offset:28672
ds_read_b64_tr_b16 v[182:183], v9 offset:30720
v_mfma_f32_16x16x32_bf16 v[72:75], v[216:219], a[52:55], v[72:75]
s_nop 0
ds_read_b64_tr_b16 v[184:185], v10 offset:28672
ds_read_b64_tr_b16 v[186:187], v10 offset:30720
v_mfma_f32_16x16x32_bf16 v[72:75], v[200:203], a[48:51], v[72:75]
buffer_load_dwordx4 a[116:119], v1, s[44:47], s69 offen offset:1024 sc1
v_mfma_f32_16x16x32_bf16 v[76:79], v[204:207], a[48:51], v[76:79]
s_add_u32 s72, s71, 46080
buffer_load_dwordx4 v15, s[24:27], s72 offen offset:3072 lds
v_mfma_f32_16x16x32_bf16 v[76:79], v[220:223], a[52:55], v[76:79]
s_nop 0
ds_read_b64_tr_b16 v[188:189], v11 offset:28672
ds_read_b64_tr_b16 v[190:191], v11 offset:30720
v_mfma_f32_16x16x32_bf16 v[76:79], v[236:239], a[56:59], v[76:79]
v_mfma_f32_16x16x32_bf16 v[76:79], v[252:255], a[60:63], v[76:79]
v_mfma_f32_16x16x32_bf16 v[60:63], v[252:255], a[44:47], v[60:63]
v_mfma_f32_16x16x32_bf16 v[60:63], v[236:239], a[40:43], v[60:63]
s_add_u32 s71, s12, 0x600000
v_mfma_f32_16x16x32_bf16 v[60:63], v[220:223], a[36:39], v[60:63]
s_waitcnt vmcnt(19) lgkmcnt(0)
buffer_load_dwordx4 a[120:123], v1, s[44:47], s69 offen offset:2048 sc1
v_mfma_f32_16x16x32_bf16 v[60:63], v[204:207], a[32:35], v[60:63]
s_barrier
v_mfma_f32_16x16x32_bf16 v[16:19], v[128:131], a[224:227], v[16:19]
s_and_b32 s71, s71, 0x7c0000
ds_read_b64_tr_b16 v[192:193], v8 offset:32768
ds_read_b64_tr_b16 v[194:195], v8 offset:34816
v_mfma_f32_16x16x32_bf16 v[16:19], v[144:147], a[228:231], v[16:19]
s_add_u32 s71, s71, s78
ds_read_b64_tr_b16 v[196:197], v9 offset:32768
ds_read_b64_tr_b16 v[198:199], v9 offset:34816
v_mfma_f32_16x16x32_bf16 v[16:19], v[160:163], a[232:235], v[16:19]
s_add_u32 m0, s77, 16384
ds_read_b64_tr_b16 v[200:201], v10 offset:32768
ds_read_b64_tr_b16 v[202:203], v10 offset:34816
v_mfma_f32_16x16x32_bf16 v[16:19], v[176:179], a[236:239], v[16:19]
s_add_u32 s72, s71, 0
buffer_load_dwordx4 v15, s[24:27], s72 offen lds
v_mfma_f32_16x16x32_bf16 v[32:35], v[176:179], a[252:255], v[32:35]
s_nop 0
ds_read_b64_tr_b16 v[204:205], v11 offset:32768
ds_read_b64_tr_b16 v[206:207], v11 offset:34816
v_mfma_f32_16x16x32_bf16 v[32:35], v[160:163], a[248:251], v[32:35]
buffer_load_dwordx4 a[124:127], v1, s[44:47], s69 offen offset:3072 sc1
v_mfma_f32_16x16x32_bf16 v[32:35], v[144:147], a[244:247], v[32:35]
s_nop 0
ds_read_b64_tr_b16 v[208:209], v8 offset:36864
ds_read_b64_tr_b16 v[210:211], v8 offset:38912
v_mfma_f32_16x16x32_bf16 v[32:35], v[128:131], a[240:243], v[32:35]
s_nop 0
ds_read_b64_tr_b16 v[212:213], v9 offset:36864
ds_read_b64_tr_b16 v[214:215], v9 offset:38912
v_mfma_f32_16x16x32_bf16 v[36:39], v[132:135], a[240:243], v[36:39]
s_nop 0
ds_read_b64_tr_b16 v[88:89], v5 offset:0
ds_read_b64_tr_b16 v[90:91], v5 offset:4096
v_mfma_f32_16x16x32_bf16 v[36:39], v[148:151], a[244:247], v[36:39]
s_nop 0
ds_read_b64_tr_b16 v[216:217], v10 offset:36864
ds_read_b64_tr_b16 v[218:219], v10 offset:38912
v_mfma_f32_16x16x32_bf16 v[36:39], v[164:167], a[248:251], v[36:39]
s_add_u32 s72, s71, 15360
buffer_load_dwordx4 v15, s[24:27], s72 offen offset:1024 lds
v_mfma_f32_16x16x32_bf16 v[36:39], v[180:183], a[252:255], v[36:39]
s_nop 0
ds_read_b64_tr_b16 v[220:221], v11 offset:36864
ds_read_b64_tr_b16 v[222:223], v11 offset:38912
v_mfma_f32_16x16x32_bf16 v[20:23], v[180:183], a[236:239], v[20:23]
s_waitcnt vmcnt(63)
v_cmp_gt_u32 vcc, 2, v3
s_cbranch_vccnz Lspin112
Lback113:
s_add_u32 s69, s12, 0x600000
s_and_b32 s69, s69, 0x7c0000
s_lshr_b32 s69, s69, 6
s_add_u32 s69, s69, s95
buffer_load_dwordx4 a[128:131], v1, s[44:47], s69 offen sc1
v_mfma_f32_16x16x32_bf16 v[20:23], v[164:167], a[232:235], v[20:23]
s_nop 0
ds_read_b64_tr_b16 v[224:225], v8 offset:40960
ds_read_b64_tr_b16 v[226:227], v8 offset:43008
v_mfma_f32_16x16x32_bf16 v[20:23], v[148:151], a[228:231], v[20:23]
s_nop 0
ds_read_b64_tr_b16 v[228:229], v9 offset:40960
ds_read_b64_tr_b16 v[230:231], v9 offset:43008
v_mfma_f32_16x16x32_bf16 v[20:23], v[132:135], a[224:227], v[20:23]
s_nop 0
ds_read_b64_tr_b16 v[232:233], v10 offset:40960
ds_read_b64_tr_b16 v[234:235], v10 offset:43008
v_mfma_f32_16x16x32_bf16 v[24:27], v[136:139], a[224:227], v[24:27]
s_nop 0
ds_read_b64_tr_b16 v[92:93], v5 offset:8192
ds_read_b64_tr_b16 v[94:95], v5 offset:12288
v_mfma_f32_16x16x32_bf16 v[24:27], v[152:155], a[228:231], v[24:27]
s_add_u32 s72, s71, 30720
buffer_load_dwordx4 v15, s[24:27], s72 offen offset:2048 lds
v_mfma_f32_16x16x32_bf16 v[24:27], v[168:171], a[232:235], v[24:27]
buffer_load_dwordx4 a[132:135], v1, s[44:47], s69 offen offset:1024 sc1
v_mfma_f32_16x16x32_bf16 v[24:27], v[184:187], a[236:239], v[24:27]
s_nop 0
ds_read_b64_tr_b16 v[236:237], v11 offset:40960
ds_read_b64_tr_b16 v[238:239], v11 offset:43008
v_mfma_f32_16x16x32_bf16 v[40:43], v[184:187], a[252:255], v[40:43]
s_nop 0
ds_read_b64_tr_b16 v[240:241], v8 offset:45056
ds_read_b64_tr_b16 v[242:243], v8 offset:47104
v_mfma_f32_16x16x32_bf16 v[40:43], v[168:171], a[248:251], v[40:43]
s_nop 0
ds_read_b64_tr_b16 v[244:245], v9 offset:45056
ds_read_b64_tr_b16 v[246:247], v9 offset:47104
v_mfma_f32_16x16x32_bf16 v[40:43], v[152:155], a[244:247], v[40:43]
s_nop 0
ds_read_b64_tr_b16 v[248:249], v10 offset:45056
ds_read_b64_tr_b16 v[250:251], v10 offset:47104
v_mfma_f32_16x16x32_bf16 v[40:43], v[136:139], a[240:243], v[40:43]
s_nop 0
ds_read_b64_tr_b16 v[252:253], v11 offset:45056
ds_read_b64_tr_b16 v[254:255], v11 offset:47104
v_mfma_f32_16x16x32_bf16 v[44:47], v[140:143], a[240:243], v[44:47]
s_add_u32 s72, s71, 46080
buffer_load_dwordx4 v15, s[24:27], s72 offen offset:3072 lds
v_mfma_f32_16x16x32_bf16 v[44:47], v[156:159], a[244:247], v[44:47]
buffer_load_dwordx4 a[136:139], v1, s[44:47], s69 offen offset:2048 sc1
v_mfma_f32_16x16x32_bf16 v[44:47], v[172:175], a[248:251], v[44:47]
s_nop 0
ds_read_b64_tr_b16 v[104:105], v5 offset:16
ds_read_b64_tr_b16 v[106:107], v5 offset:4112
v_mfma_f32_16x16x32_bf16 v[44:47], v[188:191], a[252:255], v[44:47]
s_nop 0
ds_read_b64_tr_b16 v[108:109], v5 offset:8208
ds_read_b64_tr_b16 v[110:111], v5 offset:12304
v_mfma_f32_16x16x32_bf16 v[28:31], v[188:191], a[236:239], v[28:31]
v_mfma_f32_16x16x32_bf16 v[28:31], v[172:175], a[232:235], v[28:31]
s_add_u32 s71, s13, 0x400000
v_mfma_f32_16x16x32_bf16 v[28:31], v[156:159], a[228:231], v[28:31]
s_waitcnt vmcnt(18) lgkmcnt(0)
v_mfma_f32_16x16x32_bf16 v[28:31], v[140:143], a[224:227], v[28:31]
s_barrier
v_mfma_f32_16x16x32_bf16 v[48:51], v[192:195], a[64:67], v[48:51]
s_and_b32 s71, s71, 0x7c0000
buffer_load_dwordx4 a[140:143], v1, s[44:47], s69 offen offset:3072 sc1
v_mfma_f32_16x16x32_bf16 v[48:51], v[208:211], a[68:71], v[48:51]
s_add_u32 s71, s71, s94
ds_read_b64_tr_b16 v[128:129], v8 offset:49152
ds_read_b64_tr_b16 v[130:131], v8 offset:51200
v_mfma_f32_16x16x32_bf16 v[48:51], v[224:227], a[72:75], v[48:51]
s_add_u32 m0, s77, 32768
ds_read_b64_tr_b16 v[132:133], v9 offset:49152
ds_read_b64_tr_b16 v[134:135], v9 offset:51200
v_mfma_f32_16x16x32_bf16 v[48:51], v[240:243], a[76:79], v[48:51]
s_add_u32 s72, s71, 0
buffer_load_dwordx4 v15, s[24:27], s72 offen lds
v_mfma_f32_16x16x32_bf16 v[64:67], v[240:243], a[92:95], v[64:67]
s_waitcnt vmcnt(27) lgkmcnt(4)
ds_read_b64_tr_b16 v[136:137], v10 offset:49152
ds_read_b64_tr_b16 v[138:139], v10 offset:51200
v_mfma_f32_16x16x32_bf16 v[64:67], v[224:227], a[88:91], v[64:67]
s_nop 0
ds_read_b64_tr_b16 v[140:141], v11 offset:49152
ds_read_b64_tr_b16 v[142:143], v11 offset:51200
v_mfma_f32_16x16x32_bf16 v[64:67], v[208:211], a[84:87], v[64:67]
s_nop 0
ds_read_b64_tr_b16 v[144:145], v8 offset:53248
ds_read_b64_tr_b16 v[146:147], v8 offset:55296
v_mfma_f32_16x16x32_bf16 v[64:67], v[192:195], a[80:83], v[64:67]
s_add_u32 s69, s69, 0x20000
buffer_load_dwordx4 a[144:147], v1, s[44:47], s69 offen sc1
v_mfma_f32_16x16x32_bf16 v[68:71], v[196:199], a[80:83], v[68:71]
s_nop 0
ds_read_b64_tr_b16 v[148:149], v9 offset:53248
ds_read_b64_tr_b16 v[150:151], v9 offset:55296
v_mfma_f32_16x16x32_bf16 v[68:71], v[212:215], a[84:87], v[68:71]
v_sub_f32 v112, 1.0, v6
v_sub_f32 v113, 1.0, v7
v_mfma_f32_16x16x32_bf16 v[68:71], v[228:231], a[88:91], v[68:71]
s_add_u32 s72, s71, 15360
buffer_load_dwordx4 v15, s[24:27], s72 offen offset:1024 lds
v_mfma_f32_16x16x32_bf16 v[68:71], v[244:247], a[92:95], v[68:71]
s_nop 0
ds_read_b64_tr_b16 v[152:153], v10 offset:53248
ds_read_b64_tr_b16 v[154:155], v10 offset:55296
v_mfma_f32_16x16x32_bf16 v[52:55], v[244:247], a[76:79], v[52:55]
s_nop 0
ds_read_b64_tr_b16 v[156:157], v11 offset:53248
ds_read_b64_tr_b16 v[158:159], v11 offset:55296
v_mfma_f32_16x16x32_bf16 v[52:55], v[228:231], a[72:75], v[52:55]
s_nop 0
ds_read_b64_tr_b16 v[160:161], v8 offset:57344
ds_read_b64_tr_b16 v[162:163], v8 offset:59392
v_mfma_f32_16x16x32_bf16 v[52:55], v[212:215], a[68:71], v[52:55]
buffer_load_dwordx4 a[148:151], v1, s[44:47], s69 offen offset:1024 sc1
v_mfma_f32_16x16x32_bf16 v[52:55], v[196:199], a[64:67], v[52:55]
s_nop 0
ds_read_b64_tr_b16 v[164:165], v9 offset:57344
ds_read_b64_tr_b16 v[166:167], v9 offset:59392
v_mfma_f32_16x16x32_bf16 v[56:59], v[200:203], a[64:67], v[56:59]
s_nop 0
ds_read_b64_tr_b16 v[168:169], v10 offset:57344
ds_read_b64_tr_b16 v[170:171], v10 offset:59392
v_mfma_f32_16x16x32_bf16 v[56:59], v[216:219], a[68:71], v[56:59]
s_add_u32 s72, s71, 30720
buffer_load_dwordx4 v15, s[24:27], s72 offen offset:2048 lds
v_mfma_f32_16x16x32_bf16 v[56:59], v[232:235], a[72:75], v[56:59]
v_and_b32 v114, 0xffff0000, v80
v_lshlrev_b32 v115, 16, v88
v_mfma_f32_16x16x32_bf16 v[56:59], v[248:251], a[76:79], v[56:59]
s_nop 0
ds_read_b64_tr_b16 v[172:173], v11 offset:57344
ds_read_b64_tr_b16 v[174:175], v11 offset:59392
v_mfma_f32_16x16x32_bf16 v[72:75], v[248:251], a[92:95], v[72:75]
s_nop 0
ds_read_b64_tr_b16 v[176:177], v8 offset:61440
ds_read_b64_tr_b16 v[178:179], v8 offset:63488
v_mfma_f32_16x16x32_bf16 v[72:75], v[232:235], a[88:91], v[72:75]
buffer_load_dwordx4 a[152:155], v1, s[44:47], s69 offen offset:2048 sc1
v_mfma_f32_16x16x32_bf16 v[72:75], v[216:219], a[84:87], v[72:75]
s_nop 0
ds_read_b64_tr_b16 v[180:181], v9 offset:61440
ds_read_b64_tr_b16 v[182:183], v9 offset:63488
v_mfma_f32_16x16x32_bf16 v[72:75], v[200:203], a[80:83], v[72:75]
s_nop 0
ds_read_b64_tr_b16 v[184:185], v10 offset:61440
ds_read_b64_tr_b16 v[186:187], v10 offset:63488
v_mfma_f32_16x16x32_bf16 v[76:79], v[204:207], a[80:83], v[76:79]
s_add_u32 s72, s71, 46080
buffer_load_dwordx4 v15, s[24:27], s72 offen offset:3072 lds
v_mfma_f32_16x16x32_bf16 v[76:79], v[220:223], a[84:87], v[76:79]
s_nop 0
ds_read_b64_tr_b16 v[188:189], v11 offset:61440
ds_read_b64_tr_b16 v[190:191], v11 offset:63488
v_mfma_f32_16x16x32_bf16 v[76:79], v[236:239], a[88:91], v[76:79]
v_lshlrev_b32 v80, 16, v80
v_and_b32 v88, 0xffff0000, v88
v_mfma_f32_16x16x32_bf16 v[76:79], v[252:255], a[92:95], v[76:79]
v_mul_f32 v80, v80, v112
v_mul_f32 v114, v114, v112
v_mfma_f32_16x16x32_bf16 v[60:63], v[252:255], a[76:79], v[60:63]
buffer_load_dwordx4 a[156:159], v1, s[44:47], s69 offen offset:3072 sc1
v_mfma_f32_16x16x32_bf16 v[60:63], v[236:239], a[72:75], v[60:63]
s_add_u32 s71, s13, 0x600000
v_mul_f32 v80, v80, v115
v_mul_f32 v88, v88, v114
v_mfma_f32_16x16x32_bf16 v[60:63], v[220:223], a[68:71], v[60:63]
s_waitcnt vmcnt(18) lgkmcnt(0)
v_and_b32 v114, 0xffff0000, v81
v_lshlrev_b32 v115, 16, v89
v_mfma_f32_16x16x32_bf16 v[60:63], v[204:207], a[64:67], v[60:63]
s_barrier
v_lshlrev_b32 v81, 16, v81
v_and_b32 v89, 0xffff0000, v89
v_mfma_f32_16x16x32_bf16 v[16:19], v[128:131], a[0:3], v[16:19]
s_and_b32 s71, s71, 0x7c0000
ds_read_b64_tr_b16 v[192:193], v8 offset:0
ds_read_b64_tr_b16 v[194:195], v8 offset:2048
v_mfma_f32_16x16x32_bf16 v[16:19], v[144:147], a[4:7], v[16:19]
s_add_u32 s71, s71, s78
ds_read_b64_tr_b16 v[196:197], v9 offset:0
ds_read_b64_tr_b16 v[198:199], v9 offset:2048
v_mfma_f32_16x16x32_bf16 v[16:19], v[160:163], a[8:11], v[16:19]
s_add_u32 m0, s77, 49152
ds_read_b64_tr_b16 v[200:201], v10 offset:0
ds_read_b64_tr_b16 v[202:203], v10 offset:2048
v_mfma_f32_16x16x32_bf16 v[16:19], v[176:179], a[12:15], v[16:19]
s_add_u32 s72, s71, 0
buffer_load_dwordx4 v15, s[24:27], s72 offen lds
v_mfma_f32_16x16x32_bf16 v[32:35], v[176:179], a[28:31], v[32:35]
s_add_u32 s69, s13, 0x600000
s_and_b32 s69, s69, 0x7c0000
s_lshr_b32 s69, s69, 6
s_add_u32 s69, s69, s95
buffer_load_dwordx4 a[160:163], v1, s[44:47], s69 offen sc1
v_mfma_f32_16x16x32_bf16 v[32:35], v[160:163], a[24:27], v[32:35]
s_nop 0
ds_read_b64_tr_b16 v[204:205], v11 offset:0
ds_read_b64_tr_b16 v[206:207], v11 offset:2048
v_mfma_f32_16x16x32_bf16 v[32:35], v[144:147], a[20:23], v[32:35]
s_nop 0
ds_read_b64_tr_b16 v[208:209], v8 offset:4096
ds_read_b64_tr_b16 v[210:211], v8 offset:6144
v_mfma_f32_16x16x32_bf16 v[32:35], v[128:131], a[16:19], v[32:35]
s_nop 0
ds_read_b64_tr_b16 v[212:213], v9 offset:4096
ds_read_b64_tr_b16 v[214:215], v9 offset:6144
v_mfma_f32_16x16x32_bf16 v[36:39], v[132:135], a[16:19], v[36:39]
v_mul_f32 v81, v81, v112
v_mul_f32 v114, v114, v112
v_mfma_f32_16x16x32_bf16 v[36:39], v[148:151], a[20:23], v[36:39]
buffer_load_dwordx4 a[164:167], v1, s[44:47], s69 offen offset:1024 sc1
v_mfma_f32_16x16x32_bf16 v[36:39], v[164:167], a[24:27], v[36:39]
s_add_u32 s72, s71, 15360
buffer_load_dwordx4 v15, s[24:27], s72 offen offset:1024 lds
v_mfma_f32_16x16x32_bf16 v[36:39], v[180:183], a[28:31], v[36:39]
s_nop 0
ds_read_b64_tr_b16 v[216:217], v10 offset:4096
ds_read_b64_tr_b16 v[218:219], v10 offset:6144
v_mfma_f32_16x16x32_bf16 v[20:23], v[180:183], a[12:15], v[20:23]
s_nop 0
ds_read_b64_tr_b16 v[220:221], v11 offset:4096
ds_read_b64_tr_b16 v[222:223], v11 offset:6144
v_mfma_f32_16x16x32_bf16 v[20:23], v[164:167], a[8:11], v[20:23]
s_nop 0
ds_read_b64_tr_b16 v[224:225], v8 offset:8192
ds_read_b64_tr_b16 v[226:227], v8 offset:10240
v_mfma_f32_16x16x32_bf16 v[20:23], v[148:151], a[4:7], v[20:23]
s_nop 0
ds_read_b64_tr_b16 v[228:229], v9 offset:8192
ds_read_b64_tr_b16 v[230:231], v9 offset:10240
v_mfma_f32_16x16x32_bf16 v[20:23], v[132:135], a[0:3], v[20:23]
s_nop 0
ds_read_b64_tr_b16 v[232:233], v10 offset:8192
ds_read_b64_tr_b16 v[234:235], v10 offset:10240
v_mfma_f32_16x16x32_bf16 v[24:27], v[136:139], a[0:3], v[24:27]
buffer_load_dwordx4 a[168:171], v1, s[44:47], s69 offen offset:2048 sc1
v_mfma_f32_16x16x32_bf16 v[24:27], v[152:155], a[4:7], v[24:27]
s_add_u32 s72, s71, 30720
buffer_load_dwordx4 v15, s[24:27], s72 offen offset:2048 lds
v_mfma_f32_16x16x32_bf16 v[24:27], v[168:171], a[8:11], v[24:27]
v_mul_f32 v81, v81, v115
v_mul_f32 v89, v89, v114
v_mfma_f32_16x16x32_bf16 v[24:27], v[184:187], a[12:15], v[24:27]
s_nop 0
ds_read_b64_tr_b16 v[236:237], v11 offset:8192
ds_read_b64_tr_b16 v[238:239], v11 offset:10240
v_mfma_f32_16x16x32_bf16 v[40:43], v[184:187], a[28:31], v[40:43]
s_nop 0
ds_read_b64_tr_b16 v[240:241], v8 offset:12288
ds_read_b64_tr_b16 v[242:243], v8 offset:14336
v_mfma_f32_16x16x32_bf16 v[40:43], v[168:171], a[24:27], v[40:43]
s_nop 0
ds_read_b64_tr_b16 v[244:245], v9 offset:12288
ds_read_b64_tr_b16 v[246:247], v9 offset:14336
v_mfma_f32_16x16x32_bf16 v[40:43], v[152:155], a[20:23], v[40:43]
s_nop 0
ds_read_b64_tr_b16 v[248:249], v10 offset:12288
ds_read_b64_tr_b16 v[250:251], v10 offset:14336
v_mfma_f32_16x16x32_bf16 v[40:43], v[136:139], a[16:19], v[40:43]
buffer_load_dwordx4 a[172:175], v1, s[44:47], s69 offen offset:3072 sc1
v_mfma_f32_16x16x32_bf16 v[44:47], v[140:143], a[16:19], v[44:47]
s_add_u32 s72, s71, 46080
buffer_load_dwordx4 v15, s[24:27], s72 offen offset:3072 lds
v_mfma_f32_16x16x32_bf16 v[44:47], v[156:159], a[20:23], v[44:47]
s_nop 0
ds_read_b64_tr_b16 v[252:253], v11 offset:12288
ds_read_b64_tr_b16 v[254:255], v11 offset:14336
v_mfma_f32_16x16x32_bf16 v[44:47], v[172:175], a[24:27], v[44:47]
v_and_b32 v114, 0xffff0000, v82
v_lshlrev_b32 v115, 16, v90
v_mfma_f32_16x16x32_bf16 v[44:47], v[188:191], a[28:31], v[44:47]
v_lshlrev_b32 v82, 16, v82
v_and_b32 v90, 0xffff0000, v90
v_mfma_f32_16x16x32_bf16 v[28:31], v[188:191], a[12:15], v[28:31]
s_add_u32 s69, s69, 0x20000
v_mul_f32 v82, v82, v112
v_mul_f32 v114, v114, v112
v_mfma_f32_16x16x32_bf16 v[28:31], v[172:175], a[8:11], v[28:31]
s_add_u32 s71, s14, 0x400000
v_mul_f32 v82, v82, v115
v_mul_f32 v90, v90, v114
v_mfma_f32_16x16x32_bf16 v[28:31], v[156:159], a[4:7], v[28:31]
s_waitcnt vmcnt(18) lgkmcnt(0)
buffer_load_dwordx4 a[176:179], v1, s[44:47], s69 offen sc1
v_mfma_f32_16x16x32_bf16 v[28:31], v[140:143], a[0:3], v[28:31]
s_barrier
v_and_b32 v114, 0xffff0000, v83
v_lshlrev_b32 v115, 16, v91
v_mfma_f32_16x16x32_bf16 v[48:51], v[192:195], a[96:99], v[48:51]
s_and_b32 s71, s71, 0x7c0000
s_xor_b32 s79, s91, 0x1000
v_mov_b32 v13, 0
buffer_load_dword v14, v13, s[44:47], s79 offen sc1
v_mfma_f32_16x16x32_bf16 v[48:51], v[208:211], a[100:103], v[48:51]
s_add_u32 s71, s71, s94
ds_read_b64_tr_b16 v[128:129], v8 offset:16384
ds_read_b64_tr_b16 v[130:131], v8 offset:18432
v_mfma_f32_16x16x32_bf16 v[48:51], v[224:227], a[104:107], v[48:51]
s_add_u32 m0, s77, 0
ds_read_b64_tr_b16 v[132:133], v9 offset:16384
ds_read_b64_tr_b16 v[134:135], v9 offset:18432
v_mfma_f32_16x16x32_bf16 v[48:51], v[240:243], a[108:111], v[48:51]
s_add_u32 s72, s71, 0
buffer_load_dwordx4 v15, s[24:27], s72 offen lds
v_mfma_f32_16x16x32_bf16 v[64:67], v[240:243], a[124:127], v[64:67]
s_nop 0
ds_read_b64_tr_b16 v[136:137], v10 offset:16384
ds_read_b64_tr_b16 v[138:139], v10 offset:18432
v_mfma_f32_16x16x32_bf16 v[64:67], v[224:227], a[120:123], v[64:67]
buffer_load_dwordx4 a[180:183], v1, s[44:47], s69 offen offset:1024 sc1
v_mfma_f32_16x16x32_bf16 v[64:67], v[208:211], a[116:119], v[64:67]
s_nop 0
ds_read_b64_tr_b16 v[140:141], v11 offset:16384
ds_read_b64_tr_b16 v[142:143], v11 offset:18432
v_mfma_f32_16x16x32_bf16 v[64:67], v[192:195], a[112:115], v[64:67]
s_nop 0
ds_read_b64_tr_b16 v[144:145], v8 offset:20480
ds_read_b64_tr_b16 v[146:147], v8 offset:22528
v_mfma_f32_16x16x32_bf16 v[68:71], v[196:199], a[112:115], v[68:71]
s_nop 0
ds_read_b64_tr_b16 v[148:149], v9 offset:20480
ds_read_b64_tr_b16 v[150:151], v9 offset:22528
v_mfma_f32_16x16x32_bf16 v[68:71], v[212:215], a[116:119], v[68:71]
s_nop 0
ds_read_b64_tr_b16 v[152:153], v10 offset:20480
ds_read_b64_tr_b16 v[154:155], v10 offset:22528
v_mfma_f32_16x16x32_bf16 v[68:71], v[228:231], a[120:123], v[68:71]
s_add_u32 s72, s71, 15360
buffer_load_dwordx4 v15, s[24:27], s72 offen offset:1024 lds
v_mfma_f32_16x16x32_bf16 v[68:71], v[244:247], a[124:127], v[68:71]
s_nop 0
ds_read_b64_tr_b16 v[156:157], v11 offset:20480
ds_read_b64_tr_b16 v[158:159], v11 offset:22528
v_mfma_f32_16x16x32_bf16 v[52:55], v[244:247], a[108:111], v[52:55]
buffer_load_dwordx4 a[184:187], v1, s[44:47], s69 offen offset:2048 sc1
v_mfma_f32_16x16x32_bf16 v[52:55], v[228:231], a[104:107], v[52:55]
v_lshlrev_b32 v83, 16, v83
v_and_b32 v91, 0xffff0000, v91
v_mfma_f32_16x16x32_bf16 v[52:55], v[212:215], a[100:103], v[52:55]
s_nop 0
ds_read_b64_tr_b16 v[160:161], v8 offset:24576
ds_read_b64_tr_b16 v[162:163], v8 offset:26624
v_mfma_f32_16x16x32_bf16 v[52:55], v[196:199], a[96:99], v[52:55]
s_nop 0
ds_read_b64_tr_b16 v[164:165], v9 offset:24576
ds_read_b64_tr_b16 v[166:167], v9 offset:26624
v_mfma_f32_16x16x32_bf16 v[56:59], v[200:203], a[96:99], v[56:59]
s_nop 0
ds_read_b64_tr_b16 v[168:169], v10 offset:24576
ds_read_b64_tr_b16 v[170:171], v10 offset:26624
v_mfma_f32_16x16x32_bf16 v[56:59], v[216:219], a[100:103], v[56:59]
s_add_u32 s72, s71, 30720
buffer_load_dwordx4 v15, s[24:27], s72 offen offset:2048 lds
v_mfma_f32_16x16x32_bf16 v[56:59], v[232:235], a[104:107], v[56:59]
s_nop 0
ds_read_b64_tr_b16 v[172:173], v11 offset:24576
ds_read_b64_tr_b16 v[174:175], v11 offset:26624
v_mfma_f32_16x16x32_bf16 v[56:59], v[248:251], a[108:111], v[56:59]
buffer_load_dwordx4 a[188:191], v1, s[44:47], s69 offen offset:3072 sc1
v_mfma_f32_16x16x32_bf16 v[72:75], v[248:251], a[124:127], v[72:75]
s_nop 0
ds_read_b64_tr_b16 v[176:177], v8 offset:28672
ds_read_b64_tr_b16 v[178:179], v8 offset:30720
v_mfma_f32_16x16x32_bf16 v[72:75], v[232:235], a[120:123], v[72:75]
s_nop 0
ds_read_b64_tr_b16 v[180:181], v9 offset:28672
ds_read_b64_tr_b16 v[182:183], v9 offset:30720
v_mfma_f32_16x16x32_bf16 v[72:75], v[216:219], a[116:119], v[72:75]
s_add_u32 s69, s14, 0x600000
ds_read_b64_tr_b16 v[184:185], v10 offset:28672
ds_read_b64_tr_b16 v[186:187], v10 offset:30720
v_mfma_f32_16x16x32_bf16 v[72:75], v[200:203], a[112:115], v[72:75]
s_and_b32 s69, s69, 0x7c0000
ds_read_b64_tr_b16 v[188:189], v11 offset:28672
ds_read_b64_tr_b16 v[190:191], v11 offset:30720
v_mfma_f32_16x16x32_bf16 v[76:79], v[204:207], a[112:115], v[76:79]
s_add_u32 s72, s71, 46080
buffer_load_dwordx4 v15, s[24:27], s72 offen offset:3072 lds
v_mfma_f32_16x16x32_bf16 v[76:79], v[220:223], a[116:119], v[76:79]
s_lshr_b32 s69, s69, 6
v_mul_f32 v83, v83, v112
v_mul_f32 v114, v114, v112
v_mfma_f32_16x16x32_bf16 v[76:79], v[236:239], a[120:123], v[76:79]
s_add_u32 s69, s69, s95
buffer_load_dwordx4 a[192:195], v1, s[44:47], s69 offen sc1
v_mfma_f32_16x16x32_bf16 v[76:79], v[252:255], a[124:127], v[76:79]
v_mul_f32 v83, v83, v115
v_mul_f32 v91, v91, v114
v_mfma_f32_16x16x32_bf16 v[60:63], v[252:255], a[108:111], v[60:63]
v_and_b32 v114, 0xffff0000, v84
v_lshlrev_b32 v115, 16, v92
v_mfma_f32_16x16x32_bf16 v[60:63], v[236:239], a[104:107], v[60:63]
s_add_u32 s71, s14, 0x600000
v_lshlrev_b32 v84, 16, v84
v_and_b32 v92, 0xffff0000, v92
v_mfma_f32_16x16x32_bf16 v[60:63], v[220:223], a[100:103], v[60:63]
s_waitcnt vmcnt(18) lgkmcnt(0)
v_mul_f32 v84, v84, v112
v_mul_f32 v114, v114, v112
v_mfma_f32_16x16x32_bf16 v[60:63], v[204:207], a[96:99], v[60:63]
s_barrier
v_mul_f32 v84, v84, v115
v_mul_f32 v92, v92, v114
v_mfma_f32_16x16x32_bf16 v[48:51], v[128:131], a[128:131], v[48:51]
s_and_b32 s71, s71, 0x7c0000
buffer_load_dwordx4 a[196:199], v1, s[44:47], s69 offen offset:1024 sc1
v_mfma_f32_16x16x32_bf16 v[48:51], v[144:147], a[132:135], v[48:51]
s_add_u32 s71, s71, s78
ds_read_b64_tr_b16 v[192:193], v8 offset:32768
ds_read_b64_tr_b16 v[194:195], v8 offset:34816
v_mfma_f32_16x16x32_bf16 v[48:51], v[160:163], a[136:139], v[48:51]
s_add_u32 m0, s77, 16384
ds_read_b64_tr_b16 v[196:197], v9 offset:32768
ds_read_b64_tr_b16 v[198:199], v9 offset:34816
v_mfma_f32_16x16x32_bf16 v[48:51], v[176:179], a[140:143], v[48:51]
s_add_u32 s72, s71, 0
buffer_load_dwordx4 v15, s[24:27], s72 offen lds
v_mfma_f32_16x16x32_bf16 v[64:67], v[176:179], a[156:159], v[64:67]
s_nop 0
ds_read_b64_tr_b16 v[200:201], v10 offset:32768
ds_read_b64_tr_b16 v[202:203], v10 offset:34816
v_mfma_f32_16x16x32_bf16 v[64:67], v[160:163], a[152:155], v[64:67]
s_nop 0
ds_read_b64_tr_b16 v[204:205], v11 offset:32768
ds_read_b64_tr_b16 v[206:207], v11 offset:34816
v_mfma_f32_16x16x32_bf16 v[64:67], v[144:147], a[148:151], v[64:67]
s_nop 0
ds_read_b64_tr_b16 v[208:209], v8 offset:36864
ds_read_b64_tr_b16 v[210:211], v8 offset:38912
v_mfma_f32_16x16x32_bf16 v[64:67], v[128:131], a[144:147], v[64:67]
buffer_load_dwordx4 a[200:203], v1, s[44:47], s69 offen offset:2048 sc1
v_mfma_f32_16x16x32_bf16 v[68:71], v[132:135], a[144:147], v[68:71]
s_nop 0
ds_read_b64_tr_b16 v[212:213], v9 offset:36864
ds_read_b64_tr_b16 v[214:215], v9 offset:38912
v_mfma_f32_16x16x32_bf16 v[68:71], v[148:151], a[148:151], v[68:71]
v_and_b32 v114, 0xffff0000, v85
v_lshlrev_b32 v115, 16, v93
v_mfma_f32_16x16x32_bf16 v[68:71], v[164:167], a[152:155], v[68:71]
s_add_u32 s72, s71, 15360
buffer_load_dwordx4 v15, s[24:27], s72 offen offset:1024 lds
v_mfma_f32_16x16x32_bf16 v[68:71], v[180:183], a[156:159], v[68:71]
s_nop 0
ds_read_b64_tr_b16 v[216:217], v10 offset:36864
ds_read_b64_tr_b16 v[218:219], v10 offset:38912
v_mfma_f32_16x16x32_bf16 v[52:55], v[180:183], a[140:143], v[52:55]
s_nop 0
ds_read_b64_tr_b16 v[220:221], v11 offset:36864
ds_read_b64_tr_b16 v[222:223], v11 offset:38912
v_mfma_f32_16x16x32_bf16 v[52:55], v[164:167], a[136:139], v[52:55]
s_nop 0
ds_read_b64_tr_b16 v[224:225], v8 offset:40960
ds_read_b64_tr_b16 v[226:227], v8 offset:43008
v_mfma_f32_16x16x32_bf16 v[52:55], v[148:151], a[132:135], v[52:55]
buffer_load_dwordx4 a[204:207], v1, s[44:47], s69 offen offset:3072 sc1
v_mfma_f32_16x16x32_bf16 v[52:55], v[132:135], a[128:131], v[52:55]
s_nop 0
ds_read_b64_tr_b16 v[228:229], v9 offset:40960
ds_read_b64_tr_b16 v[230:231], v9 offset:43008
v_mfma_f32_16x16x32_bf16 v[56:59], v[136:139], a[128:131], v[56:59]
s_nop 0
ds_read_b64_tr_b16 v[232:233], v10 offset:40960
ds_read_b64_tr_b16 v[234:235], v10 offset:43008
v_mfma_f32_16x16x32_bf16 v[56:59], v[152:155], a[132:135], v[56:59]
s_add_u32 s72, s71, 30720
buffer_load_dwordx4 v15, s[24:27], s72 offen offset:2048 lds
v_mfma_f32_16x16x32_bf16 v[56:59], v[168:171], a[136:139], v[56:59]
v_lshlrev_b32 v85, 16, v85
v_and_b32 v93, 0xffff0000, v93
v_mfma_f32_16x16x32_bf16 v[56:59], v[184:187], a[140:143], v[56:59]
s_nop 0
ds_read_b64_tr_b16 v[236:237], v11 offset:40960
ds_read_b64_tr_b16 v[238:239], v11 offset:43008
v_mfma_f32_16x16x32_bf16 v[72:75], v[184:187], a[156:159], v[72:75]
s_nop 0
ds_read_b64_tr_b16 v[240:241], v8 offset:45056
ds_read_b64_tr_b16 v[242:243], v8 offset:47104
v_mfma_f32_16x16x32_bf16 v[72:75], v[168:171], a[152:155], v[72:75]
s_add_u32 s69, s69, 0x20000
buffer_load_dwordx4 a[208:211], v1, s[44:47], s69 offen sc1
v_mfma_f32_16x16x32_bf16 v[72:75], v[152:155], a[148:151], v[72:75]
s_nop 0
ds_read_b64_tr_b16 v[244:245], v9 offset:45056
ds_read_b64_tr_b16 v[246:247], v9 offset:47104
v_mfma_f32_16x16x32_bf16 v[72:75], v[136:139], a[144:147], v[72:75]
s_nop 0
ds_read_b64_tr_b16 v[248:249], v10 offset:45056
ds_read_b64_tr_b16 v[250:251], v10 offset:47104
v_mfma_f32_16x16x32_bf16 v[76:79], v[140:143], a[144:147], v[76:79]
s_add_u32 s72, s71, 46080
buffer_load_dwordx4 v15, s[24:27], s72 offen offset:3072 lds
v_mfma_f32_16x16x32_bf16 v[76:79], v[156:159], a[148:151], v[76:79]
s_nop 0
ds_read_b64_tr_b16 v[252:253], v11 offset:45056
ds_read_b64_tr_b16 v[254:255], v11 offset:47104
v_mfma_f32_16x16x32_bf16 v[76:79], v[172:175], a[152:155], v[76:79]
v_mul_f32 v85, v85, v112
v_mul_f32 v114, v114, v112
v_mfma_f32_16x16x32_bf16 v[76:79], v[188:191], a[156:159], v[76:79]
v_mul_f32 v85, v85, v115
v_mul_f32 v93, v93, v114
v_mfma_f32_16x16x32_bf16 v[60:63], v[188:191], a[140:143], v[60:63]
buffer_load_dwordx4 a[212:215], v1, s[44:47], s69 offen offset:1024 sc1
v_mfma_f32_16x16x32_bf16 v[60:63], v[172:175], a[136:139], v[60:63]
s_add_u32 s71, s15, 0x600000
v_and_b32 v114, 0xffff0000, v86
v_lshlrev_b32 v115, 16, v94
v_mfma_f32_16x16x32_bf16 v[60:63], v[156:159], a[132:135], v[60:63]
s_waitcnt vmcnt(19) lgkmcnt(0)
v_lshlrev_b32 v86, 16, v86
v_and_b32 v94, 0xffff0000, v94
v_mfma_f32_16x16x32_bf16 v[60:63], v[140:143], a[128:131], v[60:63]
s_barrier
v_mul_f32 v86, v86, v112
v_mul_f32 v114, v114, v112
v_mfma_f32_16x16x32_bf16 v[16:19], v[192:195], a[32:35], v[16:19]
s_and_b32 s71, s71, 0x7c0000
ds_read_b64_tr_b16 v[128:129], v8 offset:49152
ds_read_b64_tr_b16 v[130:131], v8 offset:51200
v_mfma_f32_16x16x32_bf16 v[16:19], v[208:211], a[36:39], v[16:19]
s_add_u32 s71, s71, s78
ds_read_b64_tr_b16 v[132:133], v9 offset:49152
ds_read_b64_tr_b16 v[134:135], v9 offset:51200
v_mfma_f32_16x16x32_bf16 v[16:19], v[224:227], a[40:43], v[16:19]
s_add_u32 m0, s77, 32768
ds_read_b64_tr_b16 v[136:137], v10 offset:49152
ds_read_b64_tr_b16 v[138:139], v10 offset:51200
v_mfma_f32_16x16x32_bf16 v[16:19], v[240:243], a[44:47], v[16:19]
s_add_u32 s72, s71, 0
buffer_load_dwordx4 v15, s[24:27], s72 offen lds
v_mfma_f32_16x16x32_bf16 v[32:35], v[240:243], a[60:63], v[32:35]
buffer_load_dwordx4 a[216:219], v1, s[44:47], s69 offen offset:2048 sc1
v_mfma_f32_16x16x32_bf16 v[32:35], v[224:227], a[56:59], v[32:35]
s_nop 0
ds_read_b64_tr_b16 v[140:141], v11 offset:49152
ds_read_b64_tr_b16 v[142:143], v11 offset:51200
v_mfma_f32_16x16x32_bf16 v[32:35], v[208:211], a[52:55], v[32:35]
s_nop 0
ds_read_b64_tr_b16 v[144:145], v8 offset:53248
ds_read_b64_tr_b16 v[146:147], v8 offset:55296
v_mfma_f32_16x16x32_bf16 v[32:35], v[192:195], a[48:51], v[32:35]
s_nop 0
ds_read_b64_tr_b16 v[148:149], v9 offset:53248
ds_read_b64_tr_b16 v[150:151], v9 offset:55296
v_mfma_f32_16x16x32_bf16 v[36:39], v[196:199], a[48:51], v[36:39]
v_mul_f32 v86, v86, v115
v_mul_f32 v94, v94, v114
v_mfma_f32_16x16x32_bf16 v[36:39], v[212:215], a[52:55], v[36:39]
s_nop 0
ds_read_b64_tr_b16 v[152:153], v10 offset:53248
ds_read_b64_tr_b16 v[154:155], v10 offset:55296
v_mfma_f32_16x16x32_bf16 v[36:39], v[228:231], a[56:59], v[36:39]
s_add_u32 s72, s71, 15360
buffer_load_dwordx4 v15, s[24:27], s72 offen offset:1024 lds
v_mfma_f32_16x16x32_bf16 v[36:39], v[244:247], a[60:63], v[36:39]
buffer_load_dwordx4 a[220:223], v1, s[44:47], s69 offen offset:3072 sc1
v_mfma_f32_16x16x32_bf16 v[20:23], v[244:247], a[44:47], v[20:23]
s_nop 0
ds_read_b64_tr_b16 v[156:157], v11 offset:53248
ds_read_b64_tr_b16 v[158:159], v11 offset:55296
v_mfma_f32_16x16x32_bf16 v[20:23], v[228:231], a[40:43], v[20:23]
s_nop 0
ds_read_b64_tr_b16 v[160:161], v8 offset:57344
ds_read_b64_tr_b16 v[162:163], v8 offset:59392
v_mfma_f32_16x16x32_bf16 v[20:23], v[212:215], a[36:39], v[20:23]
s_add_u32 s69, s15, 0x600000
ds_read_b64_tr_b16 v[164:165], v9 offset:57344
ds_read_b64_tr_b16 v[166:167], v9 offset:59392
v_mfma_f32_16x16x32_bf16 v[20:23], v[196:199], a[32:35], v[20:23]
s_and_b32 s69, s69, 0x7c0000
ds_read_b64_tr_b16 v[168:169], v10 offset:57344
ds_read_b64_tr_b16 v[170:171], v10 offset:59392
v_mfma_f32_16x16x32_bf16 v[24:27], v[200:203], a[32:35], v[24:27]
s_lshr_b32 s69, s69, 6
v_and_b32 v114, 0xffff0000, v87
v_lshlrev_b32 v115, 16, v95
v_mfma_f32_16x16x32_bf16 v[24:27], v[216:219], a[36:39], v[24:27]
s_add_u32 s72, s71, 30720
buffer_load_dwordx4 v15, s[24:27], s72 offen offset:2048 lds
v_mfma_f32_16x16x32_bf16 v[24:27], v[232:235], a[40:43], v[24:27]
s_add_u32 s69, s69, s95
buffer_load_dwordx4 a[224:227], v1, s[44:47], s69 offen sc1
v_mfma_f32_16x16x32_bf16 v[24:27], v[248:251], a[44:47], v[24:27]
s_nop 0
ds_read_b64_tr_b16 v[172:173], v11 offset:57344
ds_read_b64_tr_b16 v[174:175], v11 offset:59392
v_mfma_f32_16x16x32_bf16 v[40:43], v[248:251], a[60:63], v[40:43]
s_nop 0
ds_read_b64_tr_b16 v[176:177], v8 offset:61440
ds_read_b64_tr_b16 v[178:179], v8 offset:63488
v_mfma_f32_16x16x32_bf16 v[40:43], v[232:235], a[56:59], v[40:43]
s_nop 0
ds_read_b64_tr_b16 v[180:181], v9 offset:61440
ds_read_b64_tr_b16 v[182:183], v9 offset:63488
v_mfma_f32_16x16x32_bf16 v[40:43], v[216:219], a[52:55], v[40:43]
s_nop 0
ds_read_b64_tr_b16 v[184:185], v10 offset:61440
ds_read_b64_tr_b16 v[186:187], v10 offset:63488
v_mfma_f32_16x16x32_bf16 v[40:43], v[200:203], a[48:51], v[40:43]
buffer_load_dwordx4 a[228:231], v1, s[44:47], s69 offen offset:1024 sc1
v_mfma_f32_16x16x32_bf16 v[44:47], v[204:207], a[48:51], v[44:47]
s_add_u32 s72, s71, 46080
buffer_load_dwordx4 v15, s[24:27], s72 offen offset:3072 lds
v_mfma_f32_16x16x32_bf16 v[44:47], v[220:223], a[52:55], v[44:47]
s_nop 0
ds_read_b64_tr_b16 v[188:189], v11 offset:61440
ds_read_b64_tr_b16 v[190:191], v11 offset:63488
v_mfma_f32_16x16x32_bf16 v[44:47], v[236:239], a[56:59], v[44:47]
v_lshlrev_b32 v87, 16, v87
v_and_b32 v95, 0xffff0000, v95
v_mfma_f32_16x16x32_bf16 v[44:47], v[252:255], a[60:63], v[44:47]
v_mul_f32 v87, v87, v112
v_mul_f32 v114, v114, v112
v_mfma_f32_16x16x32_bf16 v[28:31], v[252:255], a[44:47], v[28:31]
v_mul_f32 v87, v87, v115
v_mul_f32 v95, v95, v114
v_mfma_f32_16x16x32_bf16 v[28:31], v[236:239], a[40:43], v[28:31]
s_add_u32 s71, s15, 0x400000
v_and_b32 v114, 0xffff0000, v96
v_lshlrev_b32 v115, 16, v104
v_mfma_f32_16x16x32_bf16 v[28:31], v[220:223], a[36:39], v[28:31]
s_waitcnt vmcnt(18) lgkmcnt(0)
buffer_load_dwordx4 a[232:235], v1, s[44:47], s69 offen offset:2048 sc1
v_mfma_f32_16x16x32_bf16 v[28:31], v[204:207], a[32:35], v[28:31]
s_barrier
v_lshlrev_b32 v96, 16, v96
v_and_b32 v104, 0xffff0000, v104
v_mfma_f32_16x16x32_bf16 v[48:51], v[128:131], a[160:163], v[48:51]
s_and_b32 s71, s71, 0x7c0000
s_waitcnt vmcnt(26)
v_cmp_gt_u32 vcc, 2, v14
s_cbranch_vccnz Lspin118
Lback119:
v_mfma_f32_16x16x32_bf16 v[48:51], v[144:147], a[164:167], v[48:51]
s_add_u32 s71, s71, s94
ds_read_b64_tr_b16 v[192:193], v8 offset:0
ds_read_b64_tr_b16 v[194:195], v8 offset:2048
v_mfma_f32_16x16x32_bf16 v[48:51], v[160:163], a[168:171], v[48:51]
s_add_u32 m0, s77, 49152
ds_read_b64_tr_b16 v[196:197], v9 offset:0
ds_read_b64_tr_b16 v[198:199], v9 offset:2048
v_mfma_f32_16x16x32_bf16 v[48:51], v[176:179], a[172:175], v[48:51]
s_add_u32 s72, s71, 0
buffer_load_dwordx4 v15, s[24:27], s72 offen lds
v_mfma_f32_16x16x32_bf16 v[64:67], v[176:179], a[188:191], v[64:67]
s_xor_b32 s80, s93, 0x80000
ds_read_b64_tr_b16 v[200:201], v10 offset:0
ds_read_b64_tr_b16 v[202:203], v10 offset:2048
v_mfma_f32_16x16x32_bf16 v[64:67], v[160:163], a[184:187], v[64:67]
s_add_u32 s80, s80, 0x3a00000
buffer_load_dwordx4 a[236:239], v1, s[44:47], s69 offen offset:3072 sc1
v_mfma_f32_16x16x32_bf16 v[64:67], v[144:147], a[180:183], v[64:67]
s_add_u32 s79, s93, 0x3a00000
ds_read_b64_tr_b16 v[204:205], v11 offset:0
ds_read_b64_tr_b16 v[206:207], v11 offset:2048
v_mfma_f32_16x16x32_bf16 v[64:67], v[128:131], a[176:179], v[64:67]
s_nop 0
ds_read_b64_tr_b16 v[208:209], v8 offset:4096
ds_read_b64_tr_b16 v[210:211], v8 offset:6144
v_mfma_f32_16x16x32_bf16 v[68:71], v[132:135], a[176:179], v[68:71]
s_nop 0
ds_read_b64_tr_b16 v[212:213], v9 offset:4096
ds_read_b64_tr_b16 v[214:215], v9 offset:6144
v_mfma_f32_16x16x32_bf16 v[68:71], v[148:151], a[180:183], v[68:71]
s_nop 0
ds_read_b64_tr_b16 v[216:217], v10 offset:4096
ds_read_b64_tr_b16 v[218:219], v10 offset:6144
v_mfma_f32_16x16x32_bf16 v[68:71], v[164:167], a[184:187], v[68:71]
s_add_u32 s72, s71, 15360
buffer_load_dwordx4 v15, s[24:27], s72 offen offset:1024 lds
v_mfma_f32_16x16x32_bf16 v[68:71], v[180:183], a[188:191], v[68:71]
s_nop 0
ds_read_b64_tr_b16 v[220:221], v11 offset:4096
ds_read_b64_tr_b16 v[222:223], v11 offset:6144
v_mfma_f32_16x16x32_bf16 v[52:55], v[180:183], a[172:175], v[52:55]
s_add_u32 s69, s69, 0x20000
buffer_load_dwordx4 a[240:243], v1, s[44:47], s69 offen sc1
v_mfma_f32_16x16x32_bf16 v[52:55], v[164:167], a[168:171], v[52:55]
v_mul_f32 v96, v96, v113
v_mul_f32 v114, v114, v113
v_mfma_f32_16x16x32_bf16 v[52:55], v[148:151], a[164:167], v[52:55]
s_nop 0
ds_read_b64_tr_b16 v[224:225], v8 offset:8192
ds_read_b64_tr_b16 v[226:227], v8 offset:10240
v_mfma_f32_16x16x32_bf16 v[52:55], v[132:135], a[160:163], v[52:55]
s_nop 0
ds_read_b64_tr_b16 v[228:229], v9 offset:8192
ds_read_b64_tr_b16 v[230:231], v9 offset:10240
v_mfma_f32_16x16x32_bf16 v[56:59], v[136:139], a[160:163], v[56:59]
s_nop 0
ds_read_b64_tr_b16 v[232:233], v10 offset:8192
ds_read_b64_tr_b16 v[234:235], v10 offset:10240
v_mfma_f32_16x16x32_bf16 v[56:59], v[152:155], a[164:167], v[56:59]
s_add_u32 s72, s71, 30720
buffer_load_dwordx4 v15, s[24:27], s72 offen offset:2048 lds
v_mfma_f32_16x16x32_bf16 v[56:59], v[168:171], a[168:171], v[56:59]
s_nop 0
ds_read_b64_tr_b16 v[236:237], v11 offset:8192
ds_read_b64_tr_b16 v[238:239], v11 offset:10240
v_mfma_f32_16x16x32_bf16 v[56:59], v[184:187], a[172:175], v[56:59]
buffer_load_dwordx4 a[244:247], v1, s[44:47], s69 offen offset:1024 sc1
v_mfma_f32_16x16x32_bf16 v[72:75], v[184:187], a[188:191], v[72:75]
s_nop 0
ds_read_b64_tr_b16 v[240:241], v8 offset:12288
ds_read_b64_tr_b16 v[242:243], v8 offset:14336
v_mfma_f32_16x16x32_bf16 v[72:75], v[168:171], a[184:187], v[72:75]
s_nop 0
ds_read_b64_tr_b16 v[244:245], v9 offset:12288
ds_read_b64_tr_b16 v[246:247], v9 offset:14336
v_mfma_f32_16x16x32_bf16 v[72:75], v[152:155], a[180:183], v[72:75]
s_nop 0
ds_read_b64_tr_b16 v[248:249], v10 offset:12288
ds_read_b64_tr_b16 v[250:251], v10 offset:14336
v_mfma_f32_16x16x32_bf16 v[72:75], v[136:139], a[176:179], v[72:75]
s_nop 0
ds_read_b64_tr_b16 v[252:253], v11 offset:12288
ds_read_b64_tr_b16 v[254:255], v11 offset:14336
v_mfma_f32_16x16x32_bf16 v[76:79], v[140:143], a[176:179], v[76:79]
s_add_u32 s72, s71, 46080
buffer_load_dwordx4 v15, s[24:27], s72 offen offset:3072 lds
v_mfma_f32_16x16x32_bf16 v[76:79], v[156:159], a[180:183], v[76:79]
v_mul_f32 v96, v96, v115
v_mul_f32 v104, v104, v114
v_mfma_f32_16x16x32_bf16 v[76:79], v[172:175], a[184:187], v[76:79]
buffer_load_dwordx4 a[248:251], v1, s[44:47], s69 offen offset:2048 sc1
v_mfma_f32_16x16x32_bf16 v[76:79], v[188:191], a[188:191], v[76:79]
v_and_b32 v114, 0xffff0000, v97
v_lshlrev_b32 v115, 16, v105
v_mfma_f32_16x16x32_bf16 v[60:63], v[188:191], a[172:175], v[60:63]
v_lshlrev_b32 v97, 16, v97
v_and_b32 v105, 0xffff0000, v105
v_mfma_f32_16x16x32_bf16 v[60:63], v[172:175], a[168:171], v[60:63]
s_add_u32 s71, s12, 0x600000
v_mul_f32 v97, v97, v113
v_mul_f32 v114, v114, v113
v_mfma_f32_16x16x32_bf16 v[60:63], v[156:159], a[164:167], v[60:63]
s_waitcnt vmcnt(18) lgkmcnt(0)
v_mul_f32 v97, v97, v115
v_mul_f32 v105, v105, v114
v_mfma_f32_16x16x32_bf16 v[60:63], v[140:143], a[160:163], v[60:63]
s_barrier
v_and_b32 v114, 0xffff0000, v98
v_lshlrev_b32 v115, 16, v106
v_mfma_f32_16x16x32_bf16 v[16:19], v[192:195], a[64:67], v[16:19]
s_and_b32 s71, s71, 0x7c0000
ds_read_b64_tr_b16 v[128:129], v8 offset:16384
ds_read_b64_tr_b16 v[130:131], v8 offset:18432
v_mfma_f32_16x16x32_bf16 v[16:19], v[208:211], a[68:71], v[16:19]
s_add_u32 s71, s71, s94
buffer_load_dwordx4 a[252:255], v1, s[44:47], s69 offen offset:3072 sc1
v_mfma_f32_16x16x32_bf16 v[16:19], v[224:227], a[72:75], v[16:19]
s_add_u32 m0, s77, 0
ds_read_b64_tr_b16 v[132:133], v9 offset:16384
ds_read_b64_tr_b16 v[134:135], v9 offset:18432
v_mfma_f32_16x16x32_bf16 v[16:19], v[240:243], a[76:79], v[16:19]
s_add_u32 s72, s71, 0
buffer_load_dwordx4 v15, s[24:27], s72 offen lds
v_mfma_f32_16x16x32_bf16 v[32:35], v[240:243], a[92:95], v[32:35]
s_nop 0
ds_read_b64_tr_b16 v[136:137], v10 offset:16384
ds_read_b64_tr_b16 v[138:139], v10 offset:18432
v_mfma_f32_16x16x32_bf16 v[32:35], v[224:227], a[88:91], v[32:35]
v_lshlrev_b32 v98, 16, v98
v_and_b32 v106, 0xffff0000, v106
v_mfma_f32_16x16x32_bf16 v[32:35], v[208:211], a[84:87], v[32:35]
s_nop 0
ds_read_b64_tr_b16 v[140:141], v11 offset:16384
ds_read_b64_tr_b16 v[142:143], v11 offset:18432
v_mfma_f32_16x16x32_bf16 v[32:35], v[192:195], a[80:83], v[32:35]
s_nop 0
ds_read_b64_tr_b16 v[144:145], v8 offset:20480
ds_read_b64_tr_b16 v[146:147], v8 offset:22528
v_mfma_f32_16x16x32_bf16 v[36:39], v[196:199], a[80:83], v[36:39]
s_nop 0
ds_read_b64_tr_b16 v[148:149], v9 offset:20480
ds_read_b64_tr_b16 v[150:151], v9 offset:22528
v_mfma_f32_16x16x32_bf16 v[36:39], v[212:215], a[84:87], v[36:39]
v_mul_f32 v98, v98, v113
v_mul_f32 v114, v114, v113
v_mfma_f32_16x16x32_bf16 v[36:39], v[228:231], a[88:91], v[36:39]
s_add_u32 s72, s71, 15360
buffer_load_dwordx4 v15, s[24:27], s72 offen offset:1024 lds
v_mfma_f32_16x16x32_bf16 v[36:39], v[244:247], a[92:95], v[36:39]
s_nop 0
ds_read_b64_tr_b16 v[152:153], v10 offset:20480
ds_read_b64_tr_b16 v[154:155], v10 offset:22528
v_mfma_f32_16x16x32_bf16 v[20:23], v[244:247], a[76:79], v[20:23]
s_nop 0
ds_read_b64_tr_b16 v[156:157], v11 offset:20480
ds_read_b64_tr_b16 v[158:159], v11 offset:22528
v_mfma_f32_16x16x32_bf16 v[20:23], v[228:231], a[72:75], v[20:23]
v_mul_f32 v98, v98, v115
v_mul_f32 v106, v106, v114
v_mfma_f32_16x16x32_bf16 v[20:23], v[212:215], a[68:71], v[20:23]
s_nop 0
ds_read_b64_tr_b16 v[160:161], v8 offset:24576
ds_read_b64_tr_b16 v[162:163], v8 offset:26624
v_mfma_f32_16x16x32_bf16 v[20:23], v[196:199], a[64:67], v[20:23]
s_nop 0
ds_read_b64_tr_b16 v[164:165], v9 offset:24576
ds_read_b64_tr_b16 v[166:167], v9 offset:26624
v_mfma_f32_16x16x32_bf16 v[24:27], v[200:203], a[64:67], v[24:27]
s_nop 0
ds_read_b64_tr_b16 v[168:169], v10 offset:24576
ds_read_b64_tr_b16 v[170:171], v10 offset:26624
v_mfma_f32_16x16x32_bf16 v[24:27], v[216:219], a[68:71], v[24:27]
s_add_u32 s72, s71, 30720
buffer_load_dwordx4 v15, s[24:27], s72 offen offset:2048 lds
v_mfma_f32_16x16x32_bf16 v[24:27], v[232:235], a[72:75], v[24:27]
v_and_b32 v114, 0xffff0000, v99
v_lshlrev_b32 v115, 16, v107
v_mfma_f32_16x16x32_bf16 v[24:27], v[248:251], a[76:79], v[24:27]
s_nop 0
ds_read_b64_tr_b16 v[172:173], v11 offset:24576
ds_read_b64_tr_b16 v[174:175], v11 offset:26624
v_mfma_f32_16x16x32_bf16 v[40:43], v[248:251], a[92:95], v[40:43]
s_nop 0
ds_read_b64_tr_b16 v[176:177], v8 offset:28672
ds_read_b64_tr_b16 v[178:179], v8 offset:30720
v_mfma_f32_16x16x32_bf16 v[40:43], v[232:235], a[88:91], v[40:43]
s_nop 0
ds_read_b64_tr_b16 v[180:181], v9 offset:28672
ds_read_b64_tr_b16 v[182:183], v9 offset:30720
v_mfma_f32_16x16x32_bf16 v[40:43], v[216:219], a[84:87], v[40:43]
v_lshlrev_b32 v99, 16, v99
v_and_b32 v107, 0xffff0000, v107
v_mfma_f32_16x16x32_bf16 v[40:43], v[200:203], a[80:83], v[40:43]
s_nop 0
ds_read_b64_tr_b16 v[184:185], v10 offset:28672
ds_read_b64_tr_b16 v[186:187], v10 offset:30720
v_mfma_f32_16x16x32_bf16 v[44:47], v[204:207], a[80:83], v[44:47]
s_add_u32 s72, s71, 46080
buffer_load_dwordx4 v15, s[24:27], s72 offen offset:3072 lds
v_mfma_f32_16x16x32_bf16 v[44:47], v[220:223], a[84:87], v[44:47]
s_nop 0
ds_read_b64_tr_b16 v[188:189], v11 offset:28672
ds_read_b64_tr_b16 v[190:191], v11 offset:30720
v_mfma_f32_16x16x32_bf16 v[44:47], v[236:239], a[88:91], v[44:47]
v_mul_f32 v99, v99, v113
v_mul_f32 v114, v114, v113
v_mfma_f32_16x16x32_bf16 v[44:47], v[252:255], a[92:95], v[44:47]
v_mul_f32 v99, v99, v115
v_mul_f32 v107, v107, v114
v_mfma_f32_16x16x32_bf16 v[28:31], v[252:255], a[76:79], v[28:31]
v_and_b32 v114, 0xffff0000, v100
v_lshlrev_b32 v115, 16, v108
v_mfma_f32_16x16x32_bf16 v[28:31], v[236:239], a[72:75], v[28:31]
s_add_u32 s71, s13, 0x600000
v_lshlrev_b32 v100, 16, v100
v_and_b32 v108, 0xffff0000, v108
v_mfma_f32_16x16x32_bf16 v[28:31], v[220:223], a[68:71], v[28:31]
s_waitcnt vmcnt(14) lgkmcnt(0)
v_mul_f32 v100, v100, v113
v_mul_f32 v114, v114, v113
v_mfma_f32_16x16x32_bf16 v[28:31], v[204:207], a[64:67], v[28:31]
s_barrier
v_mul_f32 v100, v100, v115
v_mul_f32 v108, v108, v114
v_mfma_f32_16x16x32_bf16 v[48:51], v[128:131], a[192:195], v[48:51]
s_and_b32 s71, s71, 0x7c0000
ds_read_b64_tr_b16 v[192:193], v8 offset:32768
ds_read_b64_tr_b16 v[194:195], v8 offset:34816
v_mfma_f32_16x16x32_bf16 v[48:51], v[144:147], a[196:199], v[48:51]
s_add_u32 s71, s71, s94
ds_read_b64_tr_b16 v[196:197], v9 offset:32768
ds_read_b64_tr_b16 v[198:199], v9 offset:34816
v_mfma_f32_16x16x32_bf16 v[48:51], v[160:163], a[200:203], v[48:51]
s_add_u32 m0, s77, 16384
ds_read_b64_tr_b16 v[200:201], v10 offset:32768
ds_read_b64_tr_b16 v[202:203], v10 offset:34816
v_mfma_f32_16x16x32_bf16 v[48:51], v[176:179], a[204:207], v[48:51]
s_add_u32 s72, s71, 0
buffer_load_dwordx4 v15, s[24:27], s72 offen lds
v_mfma_f32_16x16x32_bf16 v[64:67], v[176:179], a[220:223], v[64:67]
v_and_b32 v114, 0xffff0000, v101
v_lshlrev_b32 v115, 16, v109
v_mfma_f32_16x16x32_bf16 v[64:67], v[160:163], a[216:219], v[64:67]
s_nop 0
ds_read_b64_tr_b16 v[204:205], v11 offset:32768
ds_read_b64_tr_b16 v[206:207], v11 offset:34816
v_mfma_f32_16x16x32_bf16 v[64:67], v[144:147], a[212:215], v[64:67]
s_nop 0
ds_read_b64_tr_b16 v[208:209], v8 offset:36864
ds_read_b64_tr_b16 v[210:211], v8 offset:38912
v_mfma_f32_16x16x32_bf16 v[64:67], v[128:131], a[208:211], v[64:67]
v_lshlrev_b32 v101, 16, v101
v_and_b32 v109, 0xffff0000, v109
v_mfma_f32_16x16x32_bf16 v[68:71], v[132:135], a[208:211], v[68:71]
s_nop 0
ds_read_b64_tr_b16 v[212:213], v9 offset:36864
ds_read_b64_tr_b16 v[214:215], v9 offset:38912
v_mfma_f32_16x16x32_bf16 v[68:71], v[148:151], a[212:215], v[68:71]
s_nop 0
ds_read_b64_tr_b16 v[216:217], v10 offset:36864
ds_read_b64_tr_b16 v[218:219], v10 offset:38912
v_mfma_f32_16x16x32_bf16 v[68:71], v[164:167], a[216:219], v[68:71]
s_add_u32 s72, s71, 15360
buffer_load_dwordx4 v15, s[24:27], s72 offen offset:1024 lds
v_mfma_f32_16x16x32_bf16 v[68:71], v[180:183], a[220:223], v[68:71]
v_mul_f32 v101, v101, v113
v_mul_f32 v114, v114, v113
v_mfma_f32_16x16x32_bf16 v[52:55], v[180:183], a[204:207], v[52:55]
s_nop 0
ds_read_b64_tr_b16 v[220:221], v11 offset:36864
ds_read_b64_tr_b16 v[222:223], v11 offset:38912
v_mfma_f32_16x16x32_bf16 v[52:55], v[164:167], a[200:203], v[52:55]
s_nop 0
ds_read_b64_tr_b16 v[224:225], v8 offset:40960
ds_read_b64_tr_b16 v[226:227], v8 offset:43008
v_mfma_f32_16x16x32_bf16 v[52:55], v[148:151], a[196:199], v[52:55]
s_nop 0
ds_read_b64_tr_b16 v[228:229], v9 offset:40960
ds_read_b64_tr_b16 v[230:231], v9 offset:43008
v_mfma_f32_16x16x32_bf16 v[52:55], v[132:135], a[192:195], v[52:55]
v_mul_f32 v101, v101, v115
v_mul_f32 v109, v109, v114
v_mfma_f32_16x16x32_bf16 v[56:59], v[136:139], a[192:195], v[56:59]
s_nop 0
ds_read_b64_tr_b16 v[232:233], v10 offset:40960
ds_read_b64_tr_b16 v[234:235], v10 offset:43008
v_mfma_f32_16x16x32_bf16 v[56:59], v[152:155], a[196:199], v[56:59]
s_add_u32 s72, s71, 30720
buffer_load_dwordx4 v15, s[24:27], s72 offen offset:2048 lds
v_mfma_f32_16x16x32_bf16 v[56:59], v[168:171], a[200:203], v[56:59]
s_nop 0
ds_read_b64_tr_b16 v[236:237], v11 offset:40960
ds_read_b64_tr_b16 v[238:239], v11 offset:43008
v_mfma_f32_16x16x32_bf16 v[56:59], v[184:187], a[204:207], v[56:59]
v_and_b32 v114, 0xffff0000, v102
v_lshlrev_b32 v115, 16, v110
v_mfma_f32_16x16x32_bf16 v[72:75], v[184:187], a[220:223], v[72:75]
s_nop 0
ds_read_b64_tr_b16 v[240:241], v8 offset:45056
ds_read_b64_tr_b16 v[242:243], v8 offset:47104
v_mfma_f32_16x16x32_bf16 v[72:75], v[168:171], a[216:219], v[72:75]
s_nop 0
ds_read_b64_tr_b16 v[244:245], v9 offset:45056
ds_read_b64_tr_b16 v[246:247], v9 offset:47104
v_mfma_f32_16x16x32_bf16 v[72:75], v[152:155], a[212:215], v[72:75]
v_lshlrev_b32 v102, 16, v102
v_and_b32 v110, 0xffff0000, v110
v_mfma_f32_16x16x32_bf16 v[72:75], v[136:139], a[208:211], v[72:75]
s_nop 0
ds_read_b64_tr_b16 v[248:249], v10 offset:45056
ds_read_b64_tr_b16 v[250:251], v10 offset:47104
v_mfma_f32_16x16x32_bf16 v[76:79], v[140:143], a[208:211], v[76:79]
s_add_u32 s72, s71, 46080
buffer_load_dwordx4 v15, s[24:27], s72 offen offset:3072 lds
v_mfma_f32_16x16x32_bf16 v[76:79], v[156:159], a[212:215], v[76:79]
s_nop 0
ds_read_b64_tr_b16 v[252:253], v11 offset:45056
ds_read_b64_tr_b16 v[254:255], v11 offset:47104
v_mfma_f32_16x16x32_bf16 v[76:79], v[172:175], a[216:219], v[76:79]
v_mul_f32 v102, v102, v113
v_mul_f32 v114, v114, v113
v_mfma_f32_16x16x32_bf16 v[76:79], v[188:191], a[220:223], v[76:79]
v_mul_f32 v102, v102, v115
v_mul_f32 v110, v110, v114
v_mfma_f32_16x16x32_bf16 v[60:63], v[188:191], a[204:207], v[60:63]
v_and_b32 v114, 0xffff0000, v103
v_lshlrev_b32 v115, 16, v111
v_mfma_f32_16x16x32_bf16 v[60:63], v[172:175], a[200:203], v[60:63]
s_add_u32 s71, s14, 0x600000
v_lshlrev_b32 v103, 16, v103
v_and_b32 v111, 0xffff0000, v111
v_mfma_f32_16x16x32_bf16 v[60:63], v[156:159], a[196:199], v[60:63]
s_waitcnt vmcnt(8) lgkmcnt(0)
v_mul_f32 v103, v103, v113
v_mul_f32 v114, v114, v113
v_mfma_f32_16x16x32_bf16 v[60:63], v[140:143], a[192:195], v[60:63]
s_barrier
v_mul_f32 v103, v103, v115
v_mul_f32 v111, v111, v114
v_mfma_f32_16x16x32_bf16 v[48:51], v[192:195], a[224:227], v[48:51]
s_and_b32 s71, s71, 0x7c0000
ds_read_b64_tr_b16 v[128:129], v8 offset:49152
ds_read_b64_tr_b16 v[130:131], v8 offset:51200
v_mfma_f32_16x16x32_bf16 v[48:51], v[208:211], a[228:231], v[48:51]
s_add_u32 s71, s71, s94
ds_read_b64_tr_b16 v[132:133], v9 offset:49152
ds_read_b64_tr_b16 v[134:135], v9 offset:51200
v_mfma_f32_16x16x32_bf16 v[48:51], v[224:227], a[232:235], v[48:51]
s_add_u32 m0, s77, 32768
ds_read_b64_tr_b16 v[136:137], v10 offset:49152
ds_read_b64_tr_b16 v[138:139], v10 offset:51200
v_mfma_f32_16x16x32_bf16 v[48:51], v[240:243], a[236:239], v[48:51]
s_add_u32 s72, s71, 0
buffer_load_dwordx4 v15, s[24:27], s72 offen lds
v_mfma_f32_16x16x32_bf16 v[52:55], v[244:247], a[236:239], v[52:55]
v_mfma_f32_16x16x32_bf16 v[52:55], v[228:231], a[232:235], v[52:55]
s_nop 0
ds_read_b64_tr_b16 v[140:141], v11 offset:49152
ds_read_b64_tr_b16 v[142:143], v11 offset:51200
v_mfma_f32_16x16x32_bf16 v[52:55], v[212:215], a[228:231], v[52:55]
s_nop 0
ds_read_b64_tr_b16 v[144:145], v8 offset:53248
ds_read_b64_tr_b16 v[146:147], v8 offset:55296
v_mfma_f32_16x16x32_bf16 v[52:55], v[196:199], a[224:227], v[52:55]
s_nop 0
ds_read_b64_tr_b16 v[148:149], v9 offset:53248
ds_read_b64_tr_b16 v[150:151], v9 offset:55296
v_mfma_f32_16x16x32_bf16 v[56:59], v[200:203], a[224:227], v[56:59]
v_mfma_f32_16x16x32_bf16 v[56:59], v[216:219], a[228:231], v[56:59]
s_nop 0
ds_read_b64_tr_b16 v[152:153], v10 offset:53248
ds_read_b64_tr_b16 v[154:155], v10 offset:55296
v_mfma_f32_16x16x32_bf16 v[56:59], v[232:235], a[232:235], v[56:59]
s_add_u32 s72, s71, 15360
buffer_load_dwordx4 v15, s[24:27], s72 offen offset:1024 lds
v_mfma_f32_16x16x32_bf16 v[56:59], v[248:251], a[236:239], v[56:59]
s_nop 0
ds_read_b64_tr_b16 v[156:157], v11 offset:53248
ds_read_b64_tr_b16 v[158:159], v11 offset:55296
v_cvt_pk_bf16_f32 v48, v48, v49
v_mfma_f32_16x16x32_bf16 v[60:63], v[252:255], a[236:239], v[60:63]
v_cvt_pk_bf16_f32 v49, v50, v51
v_cvt_pk_bf16_f32 v50, v52, v53
v_cvt_pk_bf16_f32 v51, v54, v55
v_mfma_f32_16x16x32_bf16 v[60:63], v[236:239], a[232:235], v[60:63]
s_nop 0
ds_read_b64_tr_b16 v[160:161], v8 offset:57344
ds_read_b64_tr_b16 v[162:163], v8 offset:59392
v_mfma_f32_16x16x32_bf16 v[60:63], v[220:223], a[228:231], v[60:63]
s_nop 0
ds_read_b64_tr_b16 v[164:165], v9 offset:57344
ds_read_b64_tr_b16 v[166:167], v9 offset:59392
v_mfma_f32_16x16x32_bf16 v[60:63], v[204:207], a[224:227], v[60:63]
s_nop 0
ds_read_b64_tr_b16 v[168:169], v10 offset:57344
ds_read_b64_tr_b16 v[170:171], v10 offset:59392
v_mfma_f32_16x16x32_bf16 v[64:67], v[192:195], a[240:243], v[64:67]
v_mfma_f32_16x16x32_bf16 v[64:67], v[208:211], a[244:247], v[64:67]
s_add_u32 s72, s71, 30720
buffer_load_dwordx4 v15, s[24:27], s72 offen offset:2048 lds
v_mfma_f32_16x16x32_bf16 v[64:67], v[224:227], a[248:251], v[64:67]
buffer_store_dwordx4 v[48:51], v1, s[44:47], s80 offen sc1
v_mfma_f32_16x16x32_bf16 v[64:67], v[240:243], a[252:255], v[64:67]
s_nop 0
ds_read_b64_tr_b16 v[172:173], v11 offset:57344
ds_read_b64_tr_b16 v[174:175], v11 offset:59392
v_cvt_pk_bf16_f32 v52, v56, v57
v_mfma_f32_16x16x32_bf16 v[68:71], v[244:247], a[252:255], v[68:71]
s_nop 0
ds_read_b64_tr_b16 v[176:177], v8 offset:61440
ds_read_b64_tr_b16 v[178:179], v8 offset:63488
v_cvt_pk_bf16_f32 v53, v58, v59
v_mfma_f32_16x16x32_bf16 v[68:71], v[228:231], a[248:251], v[68:71]
s_nop 0
ds_read_b64_tr_b16 v[180:181], v9 offset:61440
ds_read_b64_tr_b16 v[182:183], v9 offset:63488
v_cvt_pk_bf16_f32 v54, v60, v61
v_mfma_f32_16x16x32_bf16 v[68:71], v[212:215], a[244:247], v[68:71]
v_cvt_pk_bf16_f32 v55, v62, v63
v_mfma_f32_16x16x32_bf16 v[68:71], v[196:199], a[240:243], v[68:71]
s_nop 0
ds_read_b64_tr_b16 v[184:185], v10 offset:61440
ds_read_b64_tr_b16 v[186:187], v10 offset:63488
v_mfma_f32_16x16x32_bf16 v[72:75], v[200:203], a[240:243], v[72:75]
s_add_u32 s72, s71, 46080
buffer_load_dwordx4 v15, s[24:27], s72 offen offset:3072 lds
v_mfma_f32_16x16x32_bf16 v[72:75], v[216:219], a[244:247], v[72:75]
s_nop 0
ds_read_b64_tr_b16 v[188:189], v11 offset:61440
ds_read_b64_tr_b16 v[190:191], v11 offset:63488
v_mfma_f32_16x16x32_bf16 v[72:75], v[232:235], a[248:251], v[72:75]
v_mfma_f32_16x16x32_bf16 v[72:75], v[248:251], a[252:255], v[72:75]
v_cvt_pk_bf16_f32 v56, v64, v65
v_cvt_pk_bf16_f32 v57, v66, v67
v_cvt_pk_bf16_f32 v58, v68, v69
v_mfma_f32_16x16x32_bf16 v[76:79], v[252:255], a[252:255], v[76:79]
v_cvt_pk_bf16_f32 v59, v70, v71
v_mfma_f32_16x16x32_bf16 v[76:79], v[236:239], a[248:251], v[76:79]
s_add_u32 s71, s15, 0x600000
v_mfma_f32_16x16x32_bf16 v[76:79], v[220:223], a[244:247], v[76:79]
s_waitcnt vmcnt(9) lgkmcnt(0)
v_mfma_f32_16x16x32_bf16 v[76:79], v[204:207], a[240:243], v[76:79]
s_barrier
buffer_store_dwordx4 v[52:55], v1, s[44:47], s80 offen offset:1024 sc1
v_mfma_f32_16x16x32_bf16 v[16:19], v[128:131], a[96:99], v[16:19]
s_and_b32 s71, s71, 0x7c0000
ds_read_b64_tr_b16 v[192:193], v8 offset:0
ds_read_b64_tr_b16 v[194:195], v8 offset:2048
v_mfma_f32_16x16x32_bf16 v[16:19], v[144:147], a[100:103], v[16:19]
s_add_u32 s71, s71, s94
ds_read_b64_tr_b16 v[196:197], v9 offset:0
ds_read_b64_tr_b16 v[198:199], v9 offset:2048
v_mfma_f32_16x16x32_bf16 v[16:19], v[160:163], a[104:107], v[16:19]
s_add_u32 m0, s77, 49152
ds_read_b64_tr_b16 v[200:201], v10 offset:0
ds_read_b64_tr_b16 v[202:203], v10 offset:2048
v_mfma_f32_16x16x32_bf16 v[16:19], v[176:179], a[108:111], v[16:19]
s_add_u32 s72, s71, 0
buffer_load_dwordx4 v15, s[24:27], s72 offen lds
v_cvt_pk_bf16_f32 v60, v72, v73
v_mfma_f32_16x16x32_bf16 v[32:35], v[176:179], a[124:127], v[32:35]
s_nop 0
ds_read_b64_tr_b16 v[204:205], v11 offset:0
ds_read_b64_tr_b16 v[206:207], v11 offset:2048
v_cvt_pk_bf16_f32 v61, v74, v75
v_mfma_f32_16x16x32_bf16 v[32:35], v[160:163], a[120:123], v[32:35]
v_cvt_pk_bf16_f32 v62, v76, v77
v_cvt_pk_bf16_f32 v63, v78, v79
v_mfma_f32_16x16x32_bf16 v[32:35], v[144:147], a[116:119], v[32:35]
s_nop 0
ds_read_b64_tr_b16 v[208:209], v8 offset:4096
ds_read_b64_tr_b16 v[210:211], v8 offset:6144
v_mfma_f32_16x16x32_bf16 v[32:35], v[128:131], a[112:115], v[32:35]
s_nop 0
ds_read_b64_tr_b16 v[212:213], v9 offset:4096
ds_read_b64_tr_b16 v[214:215], v9 offset:6144
v_mfma_f32_16x16x32_bf16 v[36:39], v[132:135], a[112:115], v[36:39]
s_nop 0
ds_read_b64_tr_b16 v[216:217], v10 offset:4096
ds_read_b64_tr_b16 v[218:219], v10 offset:6144
v_mfma_f32_16x16x32_bf16 v[36:39], v[148:151], a[116:119], v[36:39]
v_mfma_f32_16x16x32_bf16 v[36:39], v[164:167], a[120:123], v[36:39]
s_add_u32 s72, s71, 15360
buffer_load_dwordx4 v15, s[24:27], s72 offen offset:1024 lds
v_mfma_f32_16x16x32_bf16 v[36:39], v[180:183], a[124:127], v[36:39]
s_nop 0
ds_read_b64_tr_b16 v[220:221], v11 offset:4096
ds_read_b64_tr_b16 v[222:223], v11 offset:6144
v_mfma_f32_16x16x32_bf16 v[20:23], v[180:183], a[108:111], v[20:23]
buffer_store_dwordx4 v[56:59], v1, s[44:47], s80 offen offset:2048 sc1
v_mfma_f32_16x16x32_bf16 v[20:23], v[164:167], a[104:107], v[20:23]
s_nop 0
ds_read_b64_tr_b16 v[224:225], v8 offset:8192
ds_read_b64_tr_b16 v[226:227], v8 offset:10240
v_mfma_f32_16x16x32_bf16 v[20:23], v[148:151], a[100:103], v[20:23]
s_nop 0
ds_read_b64_tr_b16 v[228:229], v9 offset:8192
ds_read_b64_tr_b16 v[230:231], v9 offset:10240
v_mfma_f32_16x16x32_bf16 v[20:23], v[132:135], a[96:99], v[20:23]
v_mfma_f32_16x16x32_bf16 v[24:27], v[136:139], a[96:99], v[24:27]
s_nop 0
ds_read_b64_tr_b16 v[232:233], v10 offset:8192
ds_read_b64_tr_b16 v[234:235], v10 offset:10240
v_mfma_f32_16x16x32_bf16 v[24:27], v[152:155], a[100:103], v[24:27]
s_add_u32 s72, s71, 30720
buffer_load_dwordx4 v15, s[24:27], s72 offen offset:2048 lds
v_mfma_f32_16x16x32_bf16 v[24:27], v[168:171], a[104:107], v[24:27]
s_nop 0
ds_read_b64_tr_b16 v[236:237], v11 offset:8192
ds_read_b64_tr_b16 v[238:239], v11 offset:10240
v_mfma_f32_16x16x32_bf16 v[24:27], v[184:187], a[108:111], v[24:27]
s_nop 0
ds_read_b64_tr_b16 v[240:241], v8 offset:12288
ds_read_b64_tr_b16 v[242:243], v8 offset:14336
v_mfma_f32_16x16x32_bf16 v[40:43], v[184:187], a[124:127], v[40:43]
v_mfma_f32_16x16x32_bf16 v[40:43], v[168:171], a[120:123], v[40:43]
s_nop 0
ds_read_b64_tr_b16 v[244:245], v9 offset:12288
ds_read_b64_tr_b16 v[246:247], v9 offset:14336
v_mfma_f32_16x16x32_bf16 v[40:43], v[152:155], a[116:119], v[40:43]
s_nop 0
ds_read_b64_tr_b16 v[248:249], v10 offset:12288
ds_read_b64_tr_b16 v[250:251], v10 offset:14336
v_mfma_f32_16x16x32_bf16 v[40:43], v[136:139], a[112:115], v[40:43]
s_nop 0
ds_read_b64_tr_b16 v[252:253], v11 offset:12288
ds_read_b64_tr_b16 v[254:255], v11 offset:14336
v_mfma_f32_16x16x32_bf16 v[44:47], v[140:143], a[112:115], v[44:47]
s_add_u32 s72, s71, 46080
buffer_load_dwordx4 v15, s[24:27], s72 offen offset:3072 lds
v_mfma_f32_16x16x32_bf16 v[44:47], v[156:159], a[116:119], v[44:47]
buffer_store_dwordx4 v[60:63], v1, s[44:47], s80 offen offset:3072 sc1
v_mfma_f32_16x16x32_bf16 v[44:47], v[172:175], a[120:123], v[44:47]
v_mfma_f32_16x16x32_bf16 v[44:47], v[188:191], a[124:127], v[44:47]
v_mfma_f32_16x16x32_bf16 v[28:31], v[188:191], a[108:111], v[28:31]
v_mfma_f32_16x16x32_bf16 v[28:31], v[172:175], a[104:107], v[28:31]
v_mfma_f32_16x16x32_bf16 v[28:31], v[156:159], a[100:103], v[28:31]
s_waitcnt vmcnt(12) lgkmcnt(0)
v_mfma_f32_16x16x32_bf16 v[28:31], v[140:143], a[96:99], v[28:31]
s_barrier
v_mfma_f32_16x16x32_bf16 v[16:19], v[192:195], a[128:131], v[16:19]
s_nop 0
ds_read_b64_tr_b16 v[128:129], v8 offset:16384
ds_read_b64_tr_b16 v[130:131], v8 offset:18432
v_mfma_f32_16x16x32_bf16 v[16:19], v[208:211], a[132:135], v[16:19]
s_nop 0
ds_read_b64_tr_b16 v[132:133], v9 offset:16384
ds_read_b64_tr_b16 v[134:135], v9 offset:18432
v_mfma_f32_16x16x32_bf16 v[16:19], v[224:227], a[136:139], v[16:19]
v_mfma_f32_16x16x32_bf16 v[16:19], v[240:243], a[140:143], v[16:19]
s_nop 0
ds_read_b64_tr_b16 v[136:137], v10 offset:16384
ds_read_b64_tr_b16 v[138:139], v10 offset:18432
v_mfma_f32_16x16x32_bf16 v[32:35], v[240:243], a[156:159], v[32:35]
v_mfma_f32_16x16x32_bf16 v[32:35], v[224:227], a[152:155], v[32:35]
s_nop 0
ds_read_b64_tr_b16 v[140:141], v11 offset:16384
ds_read_b64_tr_b16 v[142:143], v11 offset:18432
v_mfma_f32_16x16x32_bf16 v[32:35], v[208:211], a[148:151], v[32:35]
s_nop 0
ds_read_b64_tr_b16 v[144:145], v8 offset:20480
ds_read_b64_tr_b16 v[146:147], v8 offset:22528
v_mfma_f32_16x16x32_bf16 v[32:35], v[192:195], a[144:147], v[32:35]
v_mfma_f32_16x16x32_bf16 v[36:39], v[196:199], a[144:147], v[36:39]
s_nop 0
ds_read_b64_tr_b16 v[148:149], v9 offset:20480
ds_read_b64_tr_b16 v[150:151], v9 offset:22528
v_mfma_f32_16x16x32_bf16 v[36:39], v[212:215], a[148:151], v[36:39]
v_mfma_f32_16x16x32_bf16 v[36:39], v[228:231], a[152:155], v[36:39]
s_nop 0
ds_read_b64_tr_b16 v[152:153], v10 offset:20480
ds_read_b64_tr_b16 v[154:155], v10 offset:22528
v_mfma_f32_16x16x32_bf16 v[36:39], v[244:247], a[156:159], v[36:39]
s_nop 0
ds_read_b64_tr_b16 v[156:157], v11 offset:20480
ds_read_b64_tr_b16 v[158:159], v11 offset:22528
v_mfma_f32_16x16x32_bf16 v[20:23], v[244:247], a[140:143], v[20:23]
v_mfma_f32_16x16x32_bf16 v[20:23], v[228:231], a[136:139], v[20:23]
s_nop 0
ds_read_b64_tr_b16 v[160:161], v8 offset:24576
ds_read_b64_tr_b16 v[162:163], v8 offset:26624
v_mfma_f32_16x16x32_bf16 v[20:23], v[212:215], a[132:135], v[20:23]
v_mfma_f32_16x16x32_bf16 v[20:23], v[196:199], a[128:131], v[20:23]
s_nop 0
ds_read_b64_tr_b16 v[164:165], v9 offset:24576
ds_read_b64_tr_b16 v[166:167], v9 offset:26624
v_mfma_f32_16x16x32_bf16 v[24:27], v[200:203], a[128:131], v[24:27]
s_nop 0
ds_read_b64_tr_b16 v[168:169], v10 offset:24576
ds_read_b64_tr_b16 v[170:171], v10 offset:26624
v_mfma_f32_16x16x32_bf16 v[24:27], v[216:219], a[132:135], v[24:27]
v_mfma_f32_16x16x32_bf16 v[24:27], v[232:235], a[136:139], v[24:27]
s_nop 0
ds_read_b64_tr_b16 v[172:173], v11 offset:24576
ds_read_b64_tr_b16 v[174:175], v11 offset:26624
v_mfma_f32_16x16x32_bf16 v[24:27], v[248:251], a[140:143], v[24:27]
v_mfma_f32_16x16x32_bf16 v[40:43], v[248:251], a[156:159], v[40:43]
s_nop 0
ds_read_b64_tr_b16 v[176:177], v8 offset:28672
ds_read_b64_tr_b16 v[178:179], v8 offset:30720
v_mfma_f32_16x16x32_bf16 v[40:43], v[232:235], a[152:155], v[40:43]
s_nop 0
ds_read_b64_tr_b16 v[180:181], v9 offset:28672
ds_read_b64_tr_b16 v[182:183], v9 offset:30720
v_mfma_f32_16x16x32_bf16 v[40:43], v[216:219], a[148:151], v[40:43]
v_mfma_f32_16x16x32_bf16 v[40:43], v[200:203], a[144:147], v[40:43]
s_nop 0
ds_read_b64_tr_b16 v[184:185], v10 offset:28672
ds_read_b64_tr_b16 v[186:187], v10 offset:30720
v_mfma_f32_16x16x32_bf16 v[44:47], v[204:207], a[144:147], v[44:47]
v_mfma_f32_16x16x32_bf16 v[44:47], v[220:223], a[148:151], v[44:47]
s_nop 0
ds_read_b64_tr_b16 v[188:189], v11 offset:28672
ds_read_b64_tr_b16 v[190:191], v11 offset:30720
v_mfma_f32_16x16x32_bf16 v[44:47], v[236:239], a[152:155], v[44:47]
v_mfma_f32_16x16x32_bf16 v[44:47], v[252:255], a[156:159], v[44:47]
v_mfma_f32_16x16x32_bf16 v[28:31], v[252:255], a[140:143], v[28:31]
v_mfma_f32_16x16x32_bf16 v[28:31], v[236:239], a[136:139], v[28:31]
v_mfma_f32_16x16x32_bf16 v[28:31], v[220:223], a[132:135], v[28:31]
s_waitcnt vmcnt(7) lgkmcnt(0)
v_mfma_f32_16x16x32_bf16 v[28:31], v[204:207], a[128:131], v[28:31]
s_barrier
v_mfma_f32_16x16x32_bf16 v[16:19], v[128:131], a[160:163], v[16:19]
s_nop 0
ds_read_b64_tr_b16 v[192:193], v8 offset:32768
ds_read_b64_tr_b16 v[194:195], v8 offset:34816
v_mfma_f32_16x16x32_bf16 v[16:19], v[144:147], a[164:167], v[16:19]
s_nop 0
ds_read_b64_tr_b16 v[196:197], v9 offset:32768
ds_read_b64_tr_b16 v[198:199], v9 offset:34816
v_mfma_f32_16x16x32_bf16 v[16:19], v[160:163], a[168:171], v[16:19]
s_nop 0
ds_read_b64_tr_b16 v[200:201], v10 offset:32768
ds_read_b64_tr_b16 v[202:203], v10 offset:34816
v_mfma_f32_16x16x32_bf16 v[16:19], v[176:179], a[172:175], v[16:19]
v_mfma_f32_16x16x32_bf16 v[32:35], v[176:179], a[188:191], v[32:35]
s_nop 0
ds_read_b64_tr_b16 v[204:205], v11 offset:32768
ds_read_b64_tr_b16 v[206:207], v11 offset:34816
v_mfma_f32_16x16x32_bf16 v[32:35], v[160:163], a[184:187], v[32:35]
s_nop 0
ds_read_b64_tr_b16 v[208:209], v8 offset:36864
ds_read_b64_tr_b16 v[210:211], v8 offset:38912
v_mfma_f32_16x16x32_bf16 v[32:35], v[144:147], a[180:183], v[32:35]
v_mfma_f32_16x16x32_bf16 v[32:35], v[128:131], a[176:179], v[32:35]
s_nop 0
ds_read_b64_tr_b16 v[212:213], v9 offset:36864
ds_read_b64_tr_b16 v[214:215], v9 offset:38912
v_mfma_f32_16x16x32_bf16 v[36:39], v[132:135], a[176:179], v[36:39]
s_nop 0
ds_read_b64_tr_b16 v[216:217], v10 offset:36864
ds_read_b64_tr_b16 v[218:219], v10 offset:38912
v_mfma_f32_16x16x32_bf16 v[36:39], v[148:151], a[180:183], v[36:39]
v_mfma_f32_16x16x32_bf16 v[36:39], v[164:167], a[184:187], v[36:39]
s_nop 0
ds_read_b64_tr_b16 v[220:221], v11 offset:36864
ds_read_b64_tr_b16 v[222:223], v11 offset:38912
v_mfma_f32_16x16x32_bf16 v[36:39], v[180:183], a[188:191], v[36:39]
s_nop 0
ds_read_b64_tr_b16 v[224:225], v8 offset:40960
ds_read_b64_tr_b16 v[226:227], v8 offset:43008
v_mfma_f32_16x16x32_bf16 v[20:23], v[180:183], a[172:175], v[20:23]
s_nop 0
ds_read_b64_tr_b16 v[228:229], v9 offset:40960
ds_read_b64_tr_b16 v[230:231], v9 offset:43008
v_mfma_f32_16x16x32_bf16 v[20:23], v[164:167], a[168:171], v[20:23]
v_mfma_f32_16x16x32_bf16 v[20:23], v[148:151], a[164:167], v[20:23]
buffer_load_dwordx4 v[64:67], v1, s[44:47], s79 offen sc1
v_mfma_f32_16x16x32_bf16 v[20:23], v[132:135], a[160:163], v[20:23]
s_nop 0
ds_read_b64_tr_b16 v[232:233], v10 offset:40960
ds_read_b64_tr_b16 v[234:235], v10 offset:43008
v_mfma_f32_16x16x32_bf16 v[24:27], v[136:139], a[160:163], v[24:27]
buffer_load_dwordx4 v[68:71], v1, s[44:47], s79 offen offset:1024 sc1
v_mfma_f32_16x16x32_bf16 v[24:27], v[152:155], a[164:167], v[24:27]
s_nop 0
ds_read_b64_tr_b16 v[236:237], v11 offset:40960
ds_read_b64_tr_b16 v[238:239], v11 offset:43008
v_mfma_f32_16x16x32_bf16 v[24:27], v[168:171], a[168:171], v[24:27]
buffer_load_dwordx4 v[72:75], v1, s[44:47], s79 offen offset:2048 sc1
v_mfma_f32_16x16x32_bf16 v[24:27], v[184:187], a[172:175], v[24:27]
v_mfma_f32_16x16x32_bf16 v[40:43], v[184:187], a[188:191], v[40:43]
buffer_load_dwordx4 v[76:79], v1, s[44:47], s79 offen offset:3072 sc1
v_mfma_f32_16x16x32_bf16 v[40:43], v[168:171], a[184:187], v[40:43]
s_nop 0
ds_read_b64_tr_b16 v[240:241], v8 offset:45056
ds_read_b64_tr_b16 v[242:243], v8 offset:47104
v_mfma_f32_16x16x32_bf16 v[40:43], v[152:155], a[180:183], v[40:43]
s_nop 0
ds_read_b64_tr_b16 v[244:245], v9 offset:45056
ds_read_b64_tr_b16 v[246:247], v9 offset:47104
v_mfma_f32_16x16x32_bf16 v[40:43], v[136:139], a[176:179], v[40:43]
v_mfma_f32_16x16x32_bf16 v[44:47], v[140:143], a[176:179], v[44:47]
s_nop 0
ds_read_b64_tr_b16 v[248:249], v10 offset:45056
ds_read_b64_tr_b16 v[250:251], v10 offset:47104
v_mfma_f32_16x16x32_bf16 v[44:47], v[156:159], a[180:183], v[44:47]
s_nop 0
ds_read_b64_tr_b16 v[252:253], v11 offset:45056
ds_read_b64_tr_b16 v[254:255], v11 offset:47104
v_mfma_f32_16x16x32_bf16 v[44:47], v[172:175], a[184:187], v[44:47]
v_mfma_f32_16x16x32_bf16 v[44:47], v[188:191], a[188:191], v[44:47]
v_mfma_f32_16x16x32_bf16 v[28:31], v[188:191], a[172:175], v[28:31]
v_mfma_f32_16x16x32_bf16 v[28:31], v[172:175], a[168:171], v[28:31]
v_mfma_f32_16x16x32_bf16 v[28:31], v[156:159], a[164:167], v[28:31]
s_waitcnt vmcnt(5) lgkmcnt(0)
v_mfma_f32_16x16x32_bf16 v[28:31], v[140:143], a[160:163], v[28:31]
s_barrier
v_mfma_f32_16x16x32_bf16 v[16:19], v[192:195], a[192:195], v[16:19]
s_nop 0
ds_read_b64_tr_b16 v[128:129], v8 offset:49152
ds_read_b64_tr_b16 v[130:131], v8 offset:51200
v_mfma_f32_16x16x32_bf16 v[16:19], v[208:211], a[196:199], v[16:19]
s_nop 0
ds_read_b64_tr_b16 v[132:133], v9 offset:49152
ds_read_b64_tr_b16 v[134:135], v9 offset:51200
v_mfma_f32_16x16x32_bf16 v[16:19], v[224:227], a[200:203], v[16:19]
v_mfma_f32_16x16x32_bf16 v[16:19], v[240:243], a[204:207], v[16:19]
s_nop 0
ds_read_b64_tr_b16 v[136:137], v10 offset:49152
ds_read_b64_tr_b16 v[138:139], v10 offset:51200
v_mfma_f32_16x16x32_bf16 v[32:35], v[240:243], a[220:223], v[32:35]
v_mfma_f32_16x16x32_bf16 v[32:35], v[224:227], a[216:219], v[32:35]
s_nop 0
ds_read_b64_tr_b16 v[140:141], v11 offset:49152
ds_read_b64_tr_b16 v[142:143], v11 offset:51200
v_mfma_f32_16x16x32_bf16 v[32:35], v[208:211], a[212:215], v[32:35]
s_nop 0
ds_read_b64_tr_b16 v[144:145], v8 offset:53248
ds_read_b64_tr_b16 v[146:147], v8 offset:55296
v_mfma_f32_16x16x32_bf16 v[32:35], v[192:195], a[208:211], v[32:35]
v_mfma_f32_16x16x32_bf16 v[36:39], v[196:199], a[208:211], v[36:39]
s_nop 0
ds_read_b64_tr_b16 v[148:149], v9 offset:53248
ds_read_b64_tr_b16 v[150:151], v9 offset:55296
v_mfma_f32_16x16x32_bf16 v[36:39], v[212:215], a[212:215], v[36:39]
v_mfma_f32_16x16x32_bf16 v[36:39], v[228:231], a[216:219], v[36:39]
s_nop 0
ds_read_b64_tr_b16 v[152:153], v10 offset:53248
ds_read_b64_tr_b16 v[154:155], v10 offset:55296
v_mfma_f32_16x16x32_bf16 v[36:39], v[244:247], a[220:223], v[36:39]
s_nop 0
ds_read_b64_tr_b16 v[156:157], v11 offset:53248
ds_read_b64_tr_b16 v[158:159], v11 offset:55296
v_mfma_f32_16x16x32_bf16 v[20:23], v[244:247], a[204:207], v[20:23]
v_mfma_f32_16x16x32_bf16 v[20:23], v[228:231], a[200:203], v[20:23]
s_nop 0
ds_read_b64_tr_b16 v[160:161], v8 offset:57344
ds_read_b64_tr_b16 v[162:163], v8 offset:59392
v_mfma_f32_16x16x32_bf16 v[20:23], v[212:215], a[196:199], v[20:23]
v_mfma_f32_16x16x32_bf16 v[20:23], v[196:199], a[192:195], v[20:23]
s_nop 0
ds_read_b64_tr_b16 v[164:165], v9 offset:57344
ds_read_b64_tr_b16 v[166:167], v9 offset:59392
v_mfma_f32_16x16x32_bf16 v[24:27], v[200:203], a[192:195], v[24:27]
s_nop 0
ds_read_b64_tr_b16 v[168:169], v10 offset:57344
ds_read_b64_tr_b16 v[170:171], v10 offset:59392
v_mfma_f32_16x16x32_bf16 v[24:27], v[216:219], a[196:199], v[24:27]
v_mfma_f32_16x16x32_bf16 v[24:27], v[232:235], a[200:203], v[24:27]
s_nop 0
ds_read_b64_tr_b16 v[172:173], v11 offset:57344
ds_read_b64_tr_b16 v[174:175], v11 offset:59392
v_mfma_f32_16x16x32_bf16 v[24:27], v[248:251], a[204:207], v[24:27]
v_mfma_f32_16x16x32_bf16 v[40:43], v[248:251], a[220:223], v[40:43]
s_nop 0
ds_read_b64_tr_b16 v[176:177], v8 offset:61440
ds_read_b64_tr_b16 v[178:179], v8 offset:63488
v_mfma_f32_16x16x32_bf16 v[40:43], v[232:235], a[216:219], v[40:43]
s_nop 0
ds_read_b64_tr_b16 v[180:181], v9 offset:61440
ds_read_b64_tr_b16 v[182:183], v9 offset:63488
v_mfma_f32_16x16x32_bf16 v[40:43], v[216:219], a[212:215], v[40:43]
v_mfma_f32_16x16x32_bf16 v[40:43], v[200:203], a[208:211], v[40:43]
s_nop 0
ds_read_b64_tr_b16 v[184:185], v10 offset:61440
ds_read_b64_tr_b16 v[186:187], v10 offset:63488
v_mfma_f32_16x16x32_bf16 v[44:47], v[204:207], a[208:211], v[44:47]
v_mfma_f32_16x16x32_bf16 v[44:47], v[220:223], a[212:215], v[44:47]
s_nop 0
ds_read_b64_tr_b16 v[188:189], v11 offset:61440
ds_read_b64_tr_b16 v[190:191], v11 offset:63488
v_mfma_f32_16x16x32_bf16 v[44:47], v[236:239], a[216:219], v[44:47]
v_mfma_f32_16x16x32_bf16 v[44:47], v[252:255], a[220:223], v[44:47]
v_mfma_f32_16x16x32_bf16 v[28:31], v[252:255], a[204:207], v[28:31]
v_mfma_f32_16x16x32_bf16 v[28:31], v[236:239], a[200:203], v[28:31]
v_mfma_f32_16x16x32_bf16 v[28:31], v[220:223], a[196:199], v[28:31]
s_waitcnt lgkmcnt(0)
v_mfma_f32_16x16x32_bf16 v[28:31], v[204:207], a[192:195], v[28:31]
v_mfma_f32_16x16x32_bf16 v[16:19], v[128:131], a[224:227], v[16:19]
v_mfma_f32_16x16x32_bf16 v[16:19], v[144:147], a[228:231], v[16:19]
s_waitcnt vmcnt(0)
v_max3_u32 v112, v64, v65, v66
v_max3_u32 v112, v112, v67, v68
v_max3_u32 v112, v112, v69, v70
v_max3_u32 v112, v112, v71, v72
v_max3_u32 v112, v112, v73, v74
v_max3_u32 v112, v112, v75, v76
v_max3_u32 v112, v112, v77, v78
v_max3_u32 v112, v112, v79, v79
v_cmp_eq_u32 vcc, -1, v112
s_cbranch_vccnz Lxspin
Lxback:
v_mfma_f32_16x16x32_bf16 v[16:19], v[160:163], a[232:235], v[16:19]
v_mfma_f32_16x16x32_bf16 v[16:19], v[176:179], a[236:239], v[16:19]
v_mfma_f32_16x16x32_bf16 v[16:19], v[124:127], v[64:67], v[16:19]
v_mfma_f32_16x16x32_bf16 v[20:23], v[180:183], a[236:239], v[20:23]
v_mfma_f32_16x16x32_bf16 v[20:23], v[164:167], a[232:235], v[20:23]
v_mfma_f32_16x16x32_bf16 v[20:23], v[148:151], a[228:231], v[20:23]
v_mfma_f32_16x16x32_bf16 v[20:23], v[132:135], a[224:227], v[20:23]
s_nop 3
v_fma_f32 v16, v16, v6, v80
v_fma_f32 v17, v17, v6, v88
v_mfma_f32_16x16x32_bf16 v[20:23], v[122:125], v[64:67], v[20:23]
v_fma_f32 v18, v18, v6, v81
v_fma_f32 v19, v19, v6, v89
v_mfma_f32_16x16x32_bf16 v[24:27], v[136:139], a[224:227], v[24:27]
v_cvt_pk_bf16_f32 v16, v16, v17
v_cvt_pk_bf16_f32 v17, v18, v19
v_mfma_f32_16x16x32_bf16 v[24:27], v[152:155], a[228:231], v[24:27]
ds_write_b64 v116, v[16:17] offset:0
v_mfma_f32_16x16x32_bf16 v[24:27], v[168:171], a[232:235], v[24:27]
v_mfma_f32_16x16x32_bf16 v[24:27], v[184:187], a[236:239], v[24:27]
v_fma_f32 v20, v20, v6, v82
v_fma_f32 v21, v21, v6, v90
v_mfma_f32_16x16x32_bf16 v[24:27], v[124:127], v[68:71], v[24:27]
v_fma_f32 v22, v22, v6, v83
v_fma_f32 v23, v23, v6, v91
v_mfma_f32_16x16x32_bf16 v[28:31], v[188:191], a[236:239], v[28:31]
v_cvt_pk_bf16_f32 v20, v20, v21
v_cvt_pk_bf16_f32 v21, v22, v23
v_mfma_f32_16x16x32_bf16 v[28:31], v[172:175], a[232:235], v[28:31]
ds_write_b64 v117, v[20:21] offset:0
v_mfma_f32_16x16x32_bf16 v[28:31], v[156:159], a[228:231], v[28:31]
v_mfma_f32_16x16x32_bf16 v[28:31], v[140:143], a[224:227], v[28:31]
v_fma_f32 v24, v24, v6, v84
v_fma_f32 v25, v25, v6, v92
v_mfma_f32_16x16x32_bf16 v[28:31], v[122:125], v[68:71], v[28:31]
v_fma_f32 v26, v26, v6, v85
v_fma_f32 v27, v27, v6, v93
v_mfma_f32_16x16x32_bf16 v[32:35], v[128:131], a[240:243], v[32:35]
v_cvt_pk_bf16_f32 v24, v24, v25
v_cvt_pk_bf16_f32 v25, v26, v27
v_mfma_f32_16x16x32_bf16 v[32:35], v[144:147], a[244:247], v[32:35]
ds_write_b64 v118, v[24:25] offset:0
v_mfma_f32_16x16x32_bf16 v[32:35], v[160:163], a[248:251], v[32:35]
v_mfma_f32_16x16x32_bf16 v[32:35], v[176:179], a[252:255], v[32:35]
v_fma_f32 v28, v28, v6, v86
v_fma_f32 v29, v29, v6, v94
v_mfma_f32_16x16x32_bf16 v[32:35], v[124:127], v[72:75], v[32:35]
v_fma_f32 v30, v30, v6, v87
v_fma_f32 v31, v31, v6, v95
v_mfma_f32_16x16x32_bf16 v[36:39], v[180:183], a[252:255], v[36:39]
v_cvt_pk_bf16_f32 v28, v28, v29
v_cvt_pk_bf16_f32 v29, v30, v31
v_mfma_f32_16x16x32_bf16 v[36:39], v[164:167], a[248:251], v[36:39]
s_nop 0
ds_write_b64 v119, v[28:29] offset:0
ds_read_b128 v[48:51], v120 offset:0
v_mfma_f32_16x16x32_bf16 v[36:39], v[148:151], a[244:247], v[36:39]
ds_read_b128 v[52:55], v120 offset:1024
v_mfma_f32_16x16x32_bf16 v[36:39], v[132:135], a[240:243], v[36:39]
v_fma_f32 v32, v32, v7, v96
v_fma_f32 v33, v33, v7, v104
v_mfma_f32_16x16x32_bf16 v[36:39], v[122:125], v[72:75], v[36:39]
v_fma_f32 v34, v34, v7, v97
v_fma_f32 v35, v35, v7, v105
v_mfma_f32_16x16x32_bf16 v[40:43], v[136:139], a[240:243], v[40:43]
v_cvt_pk_bf16_f32 v32, v32, v33
v_cvt_pk_bf16_f32 v33, v34, v35
v_mfma_f32_16x16x32_bf16 v[40:43], v[152:155], a[244:247], v[40:43]
ds_write_b64 v116, v[32:33] offset:2048
v_mfma_f32_16x16x32_bf16 v[40:43], v[168:171], a[248:251], v[40:43]
s_waitcnt lgkmcnt(2)
buffer_store_dwordx4 v[48:51], v15, s[40:43], s70 offen sc1
v_mfma_f32_16x16x32_bf16 v[40:43], v[184:187], a[252:255], v[40:43]
s_add_u32 s70, s70, 0x4000
v_mfma_f32_16x16x32_bf16 v[40:43], v[124:127], v[76:79], v[40:43]
v_fma_f32 v36, v36, v7, v98
v_fma_f32 v37, v37, v7, v106
v_mfma_f32_16x16x32_bf16 v[44:47], v[188:191], a[252:255], v[44:47]
v_fma_f32 v38, v38, v7, v99
v_fma_f32 v39, v39, v7, v107
v_mfma_f32_16x16x32_bf16 v[44:47], v[172:175], a[248:251], v[44:47]
v_cvt_pk_bf16_f32 v36, v36, v37
v_cvt_pk_bf16_f32 v37, v38, v39
v_mfma_f32_16x16x32_bf16 v[44:47], v[156:159], a[244:247], v[44:47]
ds_write_b64 v117, v[36:37] offset:2048
v_mfma_f32_16x16x32_bf16 v[44:47], v[140:143], a[240:243], v[44:47]
v_fma_f32 v40, v40, v7, v100
v_fma_f32 v41, v41, v7, v108
v_mfma_f32_16x16x32_bf16 v[44:47], v[122:125], v[76:79], v[44:47]
v_fma_f32 v42, v42, v7, v101
v_fma_f32 v43, v43, v7, v109
v_cvt_pk_bf16_f32 v40, v40, v41
v_cvt_pk_bf16_f32 v41, v42, v43
ds_write_b64 v118, v[40:41] offset:2048
s_waitcnt lgkmcnt(3)
buffer_store_dwordx4 v[52:55], v15, s[40:43], s70 offen sc1
s_add_u32 s70, s70, 0x4000
v_fma_f32 v44, v44, v7, v102
v_fma_f32 v45, v45, v7, v110
v_fma_f32 v46, v46, v7, v103
v_fma_f32 v47, v47, v7, v111
v_cvt_pk_bf16_f32 v44, v44, v45
v_cvt_pk_bf16_f32 v45, v46, v47
ds_write_b64 v119, v[44:45] offset:2048
ds_read_b128 v[56:59], v120 offset:2048
ds_read_b128 v[60:63], v120 offset:3072
s_waitcnt lgkmcnt(1)
buffer_store_dwordx4 v[56:59], v15, s[40:43], s70 offen sc1
s_add_u32 s70, s70, 0x4000
s_waitcnt lgkmcnt(0)
buffer_store_dwordx4 v[60:63], v15, s[40:43], s70 offen sc1
s_add_u32 s70, s70, 0x4000
Lend:
s_endpgm
Lspin1:
s_mov_b32 s83, 262144
Lsl3:
s_sleep 2
buffer_load_dword v3, v2, s[48:51], 0 offen sc1
s_sub_u32 s83, s83, 1
s_cmp_eq_u32 s83, 0
s_waitcnt vmcnt(0)
s_cbranch_scc1 Lback2
v_cmp_gt_u32 vcc, 8, v3
s_cbranch_vccnz Lsl3
s_branch Lback2
Lspin4:
s_mov_b32 s83, 262144
Lsl6:
s_sleep 2
buffer_load_dword v3, v2, s[44:47], s75 offen sc1
s_sub_u32 s83, s83, 1
s_cmp_eq_u32 s83, 0
s_waitcnt vmcnt(0)
s_cbranch_scc1 Lback5
v_cmp_gt_u32 vcc, 1, v3
s_cbranch_vccnz Lsl6
s_branch Lback5
.p2align 12
s_endpgm
.p2align 7
LP0x:
Lstub10:
s_cbranch_execz Lret
s_cmp_eq_u32 s58, 2
s_cbranch_scc1 Lta10
s_cmp_eq_u32 s58, 3
s_cbranch_scc1 Lnt11
v_mfma_f32_16x16x32_bf16 v[160:163], a[160:163], v[16:19], v[112:115]
s_xor_b32 s74, s82, 0x10000
v_exp_f32 v128, v128
v_mfma_f32_16x16x32_bf16 v[176:179], a[176:179], v[16:19], v[112:115]
s_add_u32 s74, s74, s64
ds_read_b128 a[128:131], v2 offset:16384
ds_read_b128 a[132:135], v2 offset:17408
s_branch Ljoin12
Lta10:
v_mfma_f32_16x16x32_bf16 v[160:163], a[160:163], v[16:19], v[96:99]
s_xor_b32 s74, s82, 0x10000
v_exp_f32 v128, v128
v_mfma_f32_16x16x32_bf16 v[176:179], a[176:179], v[16:19], v[112:115]
s_add_u32 s74, s74, s64
ds_read_b128 a[128:131], v2 offset:16384
ds_read_b128 a[132:135], v2 offset:17408
s_branch Ljoin12
Lnt11:
v_mfma_f32_16x16x32_bf16 v[160:163], a[160:163], v[16:19], v[80:83]
s_xor_b32 s74, s82, 0x10000
v_exp_f32 v128, v128
v_mfma_f32_16x16x32_bf16 v[176:179], a[176:179], v[16:19], v[96:99]
s_add_u32 s74, s74, s64
ds_read_b128 a[128:131], v2 offset:16384
ds_read_b128 a[132:135], v2 offset:17408
Ljoin12:
v_mfma_f32_16x16x32_bf16 v[160:163], a[164:167], v[20:23], v[160:163]
s_add_u32 s81, s81, 0x8000
v_exp_f32 v129, v129
v_mfma_f32_16x16x32_bf16 v[160:163], a[168:171], v[24:27], v[160:163]
s_add_u32 m0, s74, 16384
v_exp_f32 v130, v130
v_mfma_f32_16x16x32_bf16 v[160:163], a[172:175], v[28:31], v[160:163]
s_add_u32 s72, s81, 16384
v_exp_f32 v131, v131
v_mfma_f32_16x16x32_bf16 v[164:167], a[172:175], v[44:47], v[84:87]
v_exp_f32 v144, v144
v_mfma_f32_16x16x32_bf16 v[164:167], a[168:171], v[40:43], v[164:167]
ds_read_b128 a[136:139], v2 offset:18432
ds_read_b128 a[140:143], v2 offset:19456
v_mfma_f32_16x16x32_bf16 v[164:167], a[164:167], v[36:39], v[164:167]
ds_read_b128 a[144:147], v2 offset:20480
ds_read_b128 a[148:151], v2 offset:21504
v_mfma_f32_16x16x32_bf16 v[164:167], a[160:163], v[32:35], v[164:167]
ds_read_b128 a[152:155], v2 offset:22528
ds_read_b128 a[156:159], v2 offset:23552
v_mfma_f32_16x16x32_bf16 v[168:171], a[160:163], v[48:51], v[88:91]
ds_read_b128 a[192:195], v2 offset:0
ds_read_b128 a[196:199], v2 offset:1024
v_mfma_f32_16x16x32_bf16 v[168:171], a[164:167], v[52:55], v[168:171]
ds_read_b128 a[200:203], v2 offset:2048
ds_read_b128 a[204:207], v2 offset:3072
v_mfma_f32_16x16x32_bf16 v[168:171], a[168:171], v[56:59], v[168:171]
ds_read_b128 a[208:211], v2 offset:4096
ds_read_b128 a[212:215], v2 offset:5120
v_mfma_f32_16x16x32_bf16 v[168:171], a[172:175], v[60:63], v[168:171]
ds_read_b128 a[216:219], v2 offset:6144
ds_read_b128 a[220:223], v2 offset:7168
v_mfma_f32_16x16x32_bf16 v[172:175], a[172:175], v[76:79], v[92:95]
v_cvt_pk_bf16_f32 v192, v128, v129
v_cvt_pk_bf16_f32 v193, v130, v131
v_mfma_f32_16x16x32_bf16 v[172:175], a[168:171], v[72:75], v[172:175]
buffer_load_dwordx4 v1, s[44:47], s72 offen sc1 lds
v_mfma_f32_16x16x32_bf16 v[172:175], a[164:167], v[68:71], v[172:175]
v_exp_f32 v145, v145
v_mfma_f32_16x16x32_bf16 v[172:175], a[160:163], v[64:67], v[172:175]
v_exp_f32 v146, v146
v_mfma_f32_16x16x32_bf16 v[188:191], a[176:179], v[64:67], v[92:95]
v_exp_f32 v147, v147
v_mfma_f32_16x16x32_bf16 v[188:191], a[180:183], v[68:71], v[188:191]
v_exp_f32 v132, v132
v_mfma_f32_16x16x32_bf16 v[188:191], a[184:187], v[72:75], v[188:191]
v_cvt_pk_bf16_f32 v194, v144, v145
v_cvt_pk_bf16_f32 v195, v146, v147
v_mfma_f32_16x16x32_bf16 v[188:191], a[188:191], v[76:79], v[188:191]
v_exp_f32 v133, v133
v_mfma_f32_16x16x32_bf16 v[184:187], a[188:191], v[60:63], v[88:91]
v_exp_f32 v134, v134
v_mfma_f32_16x16x32_bf16 v[184:187], a[184:187], v[56:59], v[184:187]
v_exp_f32 v135, v135
v_mfma_f32_16x16x32_bf16 v[184:187], a[180:183], v[52:55], v[184:187]
v_exp_f32 v148, v148
v_mfma_f32_16x16x32_bf16 v[184:187], a[176:179], v[48:51], v[184:187]
v_cvt_pk_bf16_f32 v196, v132, v133
v_cvt_pk_bf16_f32 v197, v134, v135
v_mfma_f32_16x16x32_bf16 v[180:183], a[176:179], v[32:35], v[84:87]
buffer_load_dwordx4 v1, s[44:47], s72 offen offset:1024 sc1 lds
v_mfma_f32_16x16x32_bf16 v[180:183], a[180:183], v[36:39], v[180:183]
v_exp_f32 v149, v149
v_mfma_f32_16x16x32_bf16 v[180:183], a[184:187], v[40:43], v[180:183]
v_exp_f32 v150, v150
v_mfma_f32_16x16x32_bf16 v[180:183], a[188:191], v[44:47], v[180:183]
v_exp_f32 v151, v151
v_mfma_f32_16x16x32_bf16 v[176:179], a[188:191], v[28:31], v[176:179]
buffer_load_dwordx4 v1, s[44:47], s72 offen offset:2048 sc1 lds
v_mfma_f32_16x16x32_bf16 v[176:179], a[184:187], v[24:27], v[176:179]
buffer_load_dwordx4 v1, s[44:47], s72 offen offset:3072 sc1 lds
v_mfma_f32_16x16x32_bf16 v[176:179], a[180:183], v[20:23], v[176:179]
s_waitcnt lgkmcnt(8)
v_exp_f32 v136, v136
v_cvt_pk_bf16_f32 v198, v148, v149
v_cvt_pk_bf16_f32 v199, v150, v151
v_exp_f32 v137, v137
v_exp_f32 v138, v138
v_cvt_pk_bf16_f32 v200, v136, v137
v_exp_f32 v139, v139
v_exp_f32 v152, v152
v_cvt_pk_bf16_f32 v201, v138, v139
v_exp_f32 v153, v153
v_exp_f32 v154, v154
v_cvt_pk_bf16_f32 v202, v152, v153
v_exp_f32 v155, v155
v_exp_f32 v140, v140
v_cvt_pk_bf16_f32 v203, v154, v155
v_exp_f32 v141, v141
v_exp_f32 v142, v142
v_cvt_pk_bf16_f32 v204, v140, v141
v_exp_f32 v143, v143
v_exp_f32 v156, v156
v_cvt_pk_bf16_f32 v205, v142, v143
v_exp_f32 v157, v157
v_exp_f32 v158, v158
v_cvt_pk_bf16_f32 v206, v156, v157
v_exp_f32 v159, v159
s_nop 0
v_cvt_pk_bf16_f32 v207, v158, v159
s_cmp_eq_u32 s58, 0
s_cbranch_scc1 Lta13
s_cmp_eq_u32 s58, 1
s_cbranch_scc1 Lnt14
v_mfma_f32_16x16x32_bf16 v[132:135], a[128:131], v[32:35], v[84:87]
s_add_u32 s82, s82, 0x8000
ds_read_b128 a[160:163], v2 offset:24576
v_mfma_f32_16x16x32_bf16 v[148:151], a[144:147], v[32:35], v[84:87]
s_and_b32 s82, s82, 0x1ffff
v_exp_f32 v160, v160
s_branch Ljoin15
Lta13:
v_mfma_f32_16x16x32_bf16 v[132:135], a[128:131], v[32:35], v[100:103]
s_add_u32 s82, s82, 0x8000
ds_read_b128 a[160:163], v2 offset:24576
v_mfma_f32_16x16x32_bf16 v[148:151], a[144:147], v[32:35], v[112:115]
s_and_b32 s82, s82, 0x1ffff
v_exp_f32 v160, v160
s_branch Ljoin15
Lnt14:
v_mfma_f32_16x16x32_bf16 v[132:135], a[128:131], v[32:35], v[84:87]
s_add_u32 s82, s82, 0x8000
ds_read_b128 a[160:163], v2 offset:24576
v_mfma_f32_16x16x32_bf16 v[148:151], a[144:147], v[32:35], v[100:103]
s_and_b32 s82, s82, 0x1ffff
v_exp_f32 v160, v160
Ljoin15:
v_mfma_f32_16x16x32_bf16 v[132:135], a[132:135], v[36:39], v[132:135]
s_add_u32 m0, s74, 0
v_exp_f32 v161, v161
v_mfma_f32_16x16x32_bf16 v[132:135], a[136:139], v[40:43], v[132:135]
s_add_u32 s72, s81, 0
ds_read_b128 a[164:167], v2 offset:25600
v_cvt_pk_bf16_f32 v208, v160, v161
v_mfma_f32_16x16x32_bf16 v[132:135], a[140:143], v[44:47], v[132:135]
v_exp_f32 v162, v162
v_mfma_f32_16x16x32_bf16 v[136:139], a[140:143], v[60:63], v[88:91]
buffer_load_dwordx4 v1, s[44:47], s72 offen sc1 lds
v_mfma_f32_16x16x32_bf16 v[136:139], a[136:139], v[56:59], v[136:139]
v_exp_f32 v163, v163
v_mfma_f32_16x16x32_bf16 v[136:139], a[132:135], v[52:55], v[136:139]
ds_read_b128 a[168:171], v2 offset:26624
v_cvt_pk_bf16_f32 v209, v162, v163
v_mfma_f32_16x16x32_bf16 v[136:139], a[128:131], v[48:51], v[136:139]
v_exp_f32 v176, v176
v_mfma_f32_16x16x32_bf16 v[140:143], a[128:131], v[64:67], v[92:95]
v_exp_f32 v177, v177
v_mfma_f32_16x16x32_bf16 v[140:143], a[132:135], v[68:71], v[140:143]
ds_read_b128 a[172:175], v2 offset:27648
v_cvt_pk_bf16_f32 v210, v176, v177
v_mfma_f32_16x16x32_bf16 v[140:143], a[136:139], v[72:75], v[140:143]
v_exp_f32 v178, v178
v_mfma_f32_16x16x32_bf16 v[140:143], a[140:143], v[76:79], v[140:143]
buffer_load_dwordx4 v1, s[44:47], s72 offen offset:1024 sc1 lds
v_mfma_f32_16x16x32_bf16 v[156:159], a[156:159], v[76:79], v[92:95]
v_exp_f32 v179, v179
v_mfma_f32_16x16x32_bf16 v[156:159], a[152:155], v[72:75], v[156:159]
ds_read_b128 a[176:179], v2 offset:28672
v_cvt_pk_bf16_f32 v211, v178, v179
v_mfma_f32_16x16x32_bf16 v[156:159], a[148:151], v[68:71], v[156:159]
v_exp_f32 v164, v164
v_mfma_f32_16x16x32_bf16 v[156:159], a[144:147], v[64:67], v[156:159]
v_exp_f32 v165, v165
v_mfma_f32_16x16x32_bf16 v[152:155], a[144:147], v[48:51], v[88:91]
ds_read_b128 a[180:183], v2 offset:29696
v_cvt_pk_bf16_f32 v212, v164, v165
v_mfma_f32_16x16x32_bf16 v[152:155], a[148:151], v[52:55], v[152:155]
v_exp_f32 v166, v166
v_mfma_f32_16x16x32_bf16 v[152:155], a[152:155], v[56:59], v[152:155]
buffer_load_dwordx4 v1, s[44:47], s72 offen offset:2048 sc1 lds
v_mfma_f32_16x16x32_bf16 v[152:155], a[156:159], v[60:63], v[152:155]
v_exp_f32 v167, v167
v_mfma_f32_16x16x32_bf16 v[148:151], a[156:159], v[44:47], v[148:151]
ds_read_b128 a[184:187], v2 offset:30720
v_cvt_pk_bf16_f32 v213, v166, v167
v_mfma_f32_16x16x32_bf16 v[148:151], a[152:155], v[40:43], v[148:151]
v_exp_f32 v180, v180
v_mfma_f32_16x16x32_bf16 v[148:151], a[148:151], v[36:39], v[148:151]
s_waitcnt lgkmcnt(7)
v_exp_f32 v181, v181
v_mfma_f32_16x16x32_bf16 a[0:3], a[192:195], v[192:195], 0
ds_read_b128 a[188:191], v2 offset:31744
v_cvt_pk_bf16_f32 v214, v180, v181
v_mfma_f32_16x16x32_bf16 a[32:35], a[192:195], v[196:199], 0
v_exp_f32 v182, v182
v_mfma_f32_16x16x32_bf16 a[64:67], a[192:195], v[200:203], 0
buffer_load_dwordx4 v1, s[44:47], s72 offen offset:3072 sc1 lds
v_mfma_f32_16x16x32_bf16 a[96:99], a[192:195], v[204:207], 0
s_add_u32 s66, s58, 1
v_exp_f32 v183, v183
v_mfma_f32_16x16x32_bf16 a[100:103], a[196:199], v[204:207], 0
s_and_b32 s66, s66, 3
ds_read_b128 a[224:227], v2 offset:8192
v_cvt_pk_bf16_f32 v215, v182, v183
v_mfma_f32_16x16x32_bf16 a[68:71], a[196:199], v[200:203], 0
s_mul_i32 s66, s66, 4160
v_exp_f32 v168, v168
v_mfma_f32_16x16x32_bf16 a[36:39], a[196:199], v[196:199], 0
s_add_u32 m0, s66, 131104
v_exp_f32 v169, v169
v_mfma_f32_16x16x32_bf16 a[4:7], a[196:199], v[192:195], 0
s_add_u32 s72, s93, 0x2
ds_read_b128 a[228:231], v2 offset:9216
v_cvt_pk_bf16_f32 v216, v168, v169
v_mfma_f32_16x16x32_bf16 a[8:11], a[200:203], v[192:195], 0
v_exp_f32 v170, v170
v_mfma_f32_16x16x32_bf16 a[40:43], a[200:203], v[196:199], 0
buffer_load_dwordx4 v1, s[36:39], s72 offen lds
v_mfma_f32_16x16x32_bf16 a[72:75], a[200:203], v[200:203], 0
v_exp_f32 v171, v171
v_mfma_f32_16x16x32_bf16 a[104:107], a[200:203], v[204:207], 0
ds_read_b128 a[232:235], v2 offset:10240
v_cvt_pk_bf16_f32 v217, v170, v171
v_mfma_f32_16x16x32_bf16 a[108:111], a[204:207], v[204:207], 0
v_exp_f32 v184, v184
v_mfma_f32_16x16x32_bf16 a[76:79], a[204:207], v[200:203], 0
v_exp_f32 v185, v185
v_mfma_f32_16x16x32_bf16 a[44:47], a[204:207], v[196:199], 0
ds_read_b128 a[236:239], v2 offset:11264
v_cvt_pk_bf16_f32 v218, v184, v185
v_mfma_f32_16x16x32_bf16 a[12:15], a[204:207], v[192:195], 0
v_exp_f32 v186, v186
v_mfma_f32_16x16x32_bf16 a[16:19], a[208:211], v[192:195], 0
buffer_load_dwordx4 v1, s[36:39], s72 offen offset:1024 lds
v_mfma_f32_16x16x32_bf16 a[48:51], a[208:211], v[196:199], 0
v_exp_f32 v187, v187
v_mfma_f32_16x16x32_bf16 a[80:83], a[208:211], v[200:203], 0
ds_read_b128 a[240:243], v2 offset:12288
v_cvt_pk_bf16_f32 v219, v186, v187
v_mfma_f32_16x16x32_bf16 a[112:115], a[208:211], v[204:207], 0
v_exp_f32 v172, v172
v_mfma_f32_16x16x32_bf16 a[116:119], a[212:215], v[204:207], 0
v_exp_f32 v173, v173
v_mfma_f32_16x16x32_bf16 a[84:87], a[212:215], v[200:203], 0
ds_read_b128 a[244:247], v2 offset:13312
v_cvt_pk_bf16_f32 v220, v172, v173
v_mfma_f32_16x16x32_bf16 a[52:55], a[212:215], v[196:199], 0
buffer_load_dwordx4 v1, s[36:39], s72 offen offset:2048 lds
v_mfma_f32_16x16x32_bf16 a[20:23], a[212:215], v[192:195], 0
v_exp_f32 v174, v174
v_mfma_f32_16x16x32_bf16 a[24:27], a[216:219], v[192:195], 0
v_exp_f32 v175, v175
v_mfma_f32_16x16x32_bf16 a[56:59], a[216:219], v[196:199], 0
ds_read_b128 a[248:251], v2 offset:14336
v_cvt_pk_bf16_f32 v221, v174, v175
v_mfma_f32_16x16x32_bf16 a[88:91], a[216:219], v[200:203], 0
v_exp_f32 v188, v188
v_mfma_f32_16x16x32_bf16 a[120:123], a[216:219], v[204:207], 0
v_exp_f32 v189, v189
v_mfma_f32_16x16x32_bf16 a[124:127], a[220:223], v[204:207], 0
ds_read_b128 a[252:255], v2 offset:15360
v_cvt_pk_bf16_f32 v222, v188, v189
v_mfma_f32_16x16x32_bf16 a[92:95], a[220:223], v[200:203], 0
buffer_load_dwordx4 v1, s[36:39], s72 offen offset:3072 lds
v_mfma_f32_16x16x32_bf16 a[60:63], a[220:223], v[196:199], 0
v_exp_f32 v190, v190
v_mfma_f32_16x16x32_bf16 a[28:31], a[220:223], v[192:195], 0
v_exp_f32 v191, v191
v_mfma_f32_16x16x32_bf16 v[224:227], v[120:123], v[192:195], 0
v_cvt_pk_bf16_f32 v223, v190, v191
v_add_u32 v2, s82, v1
v_mfma_f32_16x16x32_bf16 v[228:231], v[120:123], v[196:199], 0
v_and_b32 v240, 15, v0
v_lshrrev_b32 v241, 4, v0
v_mfma_f32_16x16x32_bf16 v[232:235], v[120:123], v[200:203], 0
s_waitcnt vmcnt(12) lgkmcnt(8)
v_mfma_f32_16x16x32_bf16 v[236:239], v[120:123], v[204:207], 0
s_barrier
v_add_u32 v248, 1, v240
v_and_b32 v249, 3, v248
v_lshrrev_b32 v248, 2, v248
v_mov_b32 v250, 0x20000
v_mov_b32 v252, 0x20001
v_lshlrev_b32 v6, 3, v249
v_lshrrev_b32 v6, v6, v252
v_and_b32 v6, 3, v6
v_cmp_ne_u32 vcc, 1, v249
v_mul_u32_u24 v6, 16640, v6
v_add_u32 v6, s92, v6
v_cndmask_b32 v6, v250, v6, vcc
v_add_u32 v253, s58, v249
v_and_b32 v253, 3, v253
v_mul_u32_u24 v253, 4160, v253
v_add_u32 v6, v6, v253
s_branch LLT3
.p2align 12
s_endpgm
.p2align 7
LLT3x:
Lstub11:
s_cbranch_execz Lret
s_cmp_eq_u32 s58, 2
s_cbranch_scc1 Lta40
s_cmp_eq_u32 s58, 3
s_cbranch_scc1 Lnt41
v_mfma_f32_16x16x32_bf16 v[164:167], a[160:163], v[32:35], v[112:115]
s_xor_b32 s74, s82, 0x10000
ds_read_b128 a[128:131], v2 offset:16384
v_mfma_f32_16x16x32_bf16 v[180:183], a[176:179], v[32:35], v[112:115]
s_add_u32 s74, s74, s64
v_exp_f32 v132, v132
s_branch Ljoin42
Lta40:
v_mfma_f32_16x16x32_bf16 v[164:167], a[160:163], v[32:35], v[100:103]
s_xor_b32 s74, s82, 0x10000
ds_read_b128 a[128:131], v2 offset:16384
v_mfma_f32_16x16x32_bf16 v[180:183], a[176:179], v[32:35], v[112:115]
s_add_u32 s74, s74, s64
v_exp_f32 v132, v132
s_branch Ljoin42
Lnt41:
v_mfma_f32_16x16x32_bf16 v[164:167], a[160:163], v[32:35], v[84:87]
s_xor_b32 s74, s82, 0x10000
ds_read_b128 a[128:131], v2 offset:16384
v_mfma_f32_16x16x32_bf16 v[180:183], a[176:179], v[32:35], v[100:103]
s_add_u32 s74, s74, s64
v_exp_f32 v132, v132
Ljoin42:
v_mfma_f32_16x16x32_bf16 v[164:167], a[164:167], v[36:39], v[164:167]
s_add_u32 s81, s81, 0x8000
v_exp_f32 v133, v133
v_mfma_f32_16x16x32_bf16 v[164:167], a[168:171], v[40:43], v[164:167]
s_add_u32 m0, s74, 0
ds_read_b128 a[132:135], v2 offset:17408
v_cvt_pk_bf16_f32 v196, v132, v133
v_mfma_f32_16x16x32_bf16 v[164:167], a[172:175], v[44:47], v[164:167]
s_add_u32 s72, s81, 0
v_exp_f32 v134, v134
v_mfma_f32_16x16x32_bf16 v[168:171], a[172:175], v[60:63], v[88:91]
ds_read_b128 a[136:139], v2 offset:18432
v_bfe_u32 v251, v0, 2, 2
v_mfma_f32_16x16x32_bf16 v[168:171], a[168:171], v[56:59], v[168:171]
v_exp_f32 v135, v135
v_mfma_f32_16x16x32_bf16 v[168:171], a[164:167], v[52:55], v[168:171]
buffer_load_dwordx4 v1, s[44:47], s72 offen sc1 lds
v_mfma_f32_16x16x32_bf16 v[168:171], a[160:163], v[48:51], v[168:171]
v_exp_f32 v148, v148
v_mfma_f32_16x16x32_bf16 v[172:175], a[160:163], v[64:67], v[92:95]
ds_read_b128 a[140:143], v2 offset:19456
v_cvt_pk_bf16_f32 v197, v134, v135
v_mfma_f32_16x16x32_bf16 v[172:175], a[164:167], v[68:71], v[172:175]
v_exp_f32 v149, v149
v_mfma_f32_16x16x32_bf16 v[172:175], a[168:171], v[72:75], v[172:175]
ds_read_b128 a[144:147], v2 offset:20480
v_cvt_pk_bf16_f32 v198, v148, v149
v_mfma_f32_16x16x32_bf16 v[172:175], a[172:175], v[76:79], v[172:175]
v_exp_f32 v150, v150
v_mfma_f32_16x16x32_bf16 v[188:191], a[188:191], v[76:79], v[92:95]
v_exp_f32 v151, v151
v_mfma_f32_16x16x32_bf16 v[188:191], a[184:187], v[72:75], v[188:191]
ds_read_b128 a[148:151], v2 offset:21504
v_cvt_pk_bf16_f32 v199, v150, v151
v_mfma_f32_16x16x32_bf16 v[188:191], a[180:183], v[68:71], v[188:191]
v_exp_f32 v136, v136
v_mfma_f32_16x16x32_bf16 v[188:191], a[176:179], v[64:67], v[188:191]
ds_read_b128 a[152:155], v2 offset:22528
v_lshl_add_u32 v6, v248, 3, v6
v_mfma_f32_16x16x32_bf16 v[184:187], a[176:179], v[48:51], v[88:91]
v_exp_f32 v137, v137
v_mfma_f32_16x16x32_bf16 v[184:187], a[180:183], v[52:55], v[184:187]
buffer_load_dwordx4 v1, s[44:47], s72 offen offset:1024 sc1 lds
v_mfma_f32_16x16x32_bf16 v[184:187], a[184:187], v[56:59], v[184:187]
v_exp_f32 v138, v138
v_mfma_f32_16x16x32_bf16 v[184:187], a[188:191], v[60:63], v[184:187]
ds_read_b128 a[156:159], v2 offset:23552
v_cvt_pk_bf16_f32 v200, v136, v137
v_mfma_f32_16x16x32_bf16 v[180:183], a[188:191], v[44:47], v[180:183]
v_exp_f32 v139, v139
v_mfma_f32_16x16x32_bf16 v[180:183], a[184:187], v[40:43], v[180:183]
ds_read_b128 a[192:195], v2 offset:0
v_cvt_pk_bf16_f32 v201, v138, v139
v_mfma_f32_16x16x32_bf16 v[180:183], a[180:183], v[36:39], v[180:183]
s_waitcnt lgkmcnt(9)
v_exp_f32 v152, v152
v_mfma_f32_16x16x32_bf16 a[0:3], a[224:227], v[208:211], a[0:3]
v_exp_f32 v153, v153
v_mfma_f32_16x16x32_bf16 a[32:35], a[224:227], v[212:215], a[32:35]
ds_read_b128 a[196:199], v2 offset:1024
v_cvt_pk_bf16_f32 v202, v152, v153
v_mfma_f32_16x16x32_bf16 a[64:67], a[224:227], v[216:219], a[64:67]
v_exp_f32 v154, v154
v_mfma_f32_16x16x32_bf16 a[96:99], a[224:227], v[220:223], a[96:99]
ds_read_b128 a[200:203], v2 offset:2048
v_lshl_add_u32 v6, v241, 4, v6
v_mfma_f32_16x16x32_bf16 a[100:103], a[228:231], v[220:223], a[100:103]
v_exp_f32 v155, v155
v_mfma_f32_16x16x32_bf16 a[68:71], a[228:231], v[216:219], a[68:71]
buffer_load_dwordx4 v1, s[44:47], s72 offen offset:2048 sc1 lds
v_mfma_f32_16x16x32_bf16 a[36:39], a[228:231], v[212:215], a[36:39]
v_exp_f32 v140, v140
v_mfma_f32_16x16x32_bf16 a[4:7], a[228:231], v[208:211], a[4:7]
ds_read_b128 a[204:207], v2 offset:3072
v_cvt_pk_bf16_f32 v203, v154, v155
v_mfma_f32_16x16x32_bf16 a[8:11], a[232:235], v[208:211], a[8:11]
v_exp_f32 v141, v141
v_mfma_f32_16x16x32_bf16 a[40:43], a[232:235], v[212:215], a[40:43]
ds_read_b128 a[208:211], v2 offset:4096
v_cvt_pk_bf16_f32 v204, v140, v141
v_mfma_f32_16x16x32_bf16 a[72:75], a[232:235], v[216:219], a[72:75]
v_exp_f32 v142, v142
v_mfma_f32_16x16x32_bf16 a[104:107], a[232:235], v[220:223], a[104:107]
v_exp_f32 v143, v143
v_mfma_f32_16x16x32_bf16 a[108:111], a[236:239], v[220:223], a[108:111]
ds_read_b128 a[212:215], v2 offset:5120
v_cvt_pk_bf16_f32 v205, v142, v143
v_mfma_f32_16x16x32_bf16 a[76:79], a[236:239], v[216:219], a[76:79]
v_exp_f32 v156, v156
v_mfma_f32_16x16x32_bf16 a[44:47], a[236:239], v[212:215], a[44:47]
ds_read_b128 a[216:219], v2 offset:6144
v_lshlrev_b32 v5, 3, v251
v_mfma_f32_16x16x32_bf16 a[12:15], a[236:239], v[208:211], a[12:15]
v_exp_f32 v157, v157
v_mfma_f32_16x16x32_bf16 a[16:19], a[240:243], v[208:211], a[16:19]
buffer_load_dwordx4 v1, s[44:47], s72 offen offset:3072 sc1 lds
v_mfma_f32_16x16x32_bf16 a[48:51], a[240:243], v[212:215], a[48:51]
v_exp_f32 v158, v158
v_mfma_f32_16x16x32_bf16 a[80:83], a[240:243], v[216:219], a[80:83]
ds_read_b128 a[220:223], v2 offset:7168
v_cvt_pk_bf16_f32 v206, v156, v157
v_mfma_f32_16x16x32_bf16 a[112:115], a[240:243], v[220:223], a[112:115]
v_exp_f32 v159, v159
v_mfma_f32_16x16x32_bf16 a[116:119], a[244:247], v[220:223], a[116:119]
v_cvt_pk_bf16_f32 v207, v158, v159
v_lshrrev_b32 v5, v5, v252
v_mfma_f32_16x16x32_bf16 a[84:87], a[244:247], v[216:219], a[84:87]
v_and_b32 v5, 3, v5
v_cmp_ne_u32 vcc, 1, v251
v_mfma_f32_16x16x32_bf16 a[52:55], a[244:247], v[212:215], a[52:55]
v_mul_u32_u24 v5, 16640, v5
v_add_u32 v5, s92, v5
v_mfma_f32_16x16x32_bf16 a[20:23], a[244:247], v[208:211], a[20:23]
v_cndmask_b32 v5, v250, v5, vcc
v_add_u32 v253, s58, v251
v_mfma_f32_16x16x32_bf16 a[24:27], a[248:251], v[208:211], a[24:27]
v_and_b32 v253, 3, v253
v_mul_u32_u24 v253, 4160, v253
v_mfma_f32_16x16x32_bf16 a[56:59], a[248:251], v[212:215], a[56:59]
v_add_u32 v5, v5, v253
v_mfma_f32_16x16x32_bf16 a[88:91], a[248:251], v[216:219], a[88:91]
s_add_u32 s73, s62, 480
v_lshlrev_b32 v248, 5, v240
v_sub_u32 v248, s73, v248
v_mfma_f32_16x16x32_bf16 a[120:123], a[248:251], v[220:223], a[120:123]
v_lshl_add_u32 v7, v241, 4, v248
v_mfma_f32_16x16x32_bf16 a[124:127], a[252:255], v[220:223], a[124:127]
s_and_b32 s73, s58, 1
v_mfma_f32_16x16x32_bf16 a[92:95], a[252:255], v[216:219], a[92:95]
s_lshl_b32 s73, s73, 4
v_mfma_f32_16x16x32_bf16 a[60:63], a[252:255], v[212:215], a[60:63]
s_lshr_b32 s73, s90, s73
v_mfma_f32_16x16x32_bf16 a[28:31], a[252:255], v[208:211], a[28:31]
s_and_b32 s73, s73, 0xffff
v_lshl_add_u32 v248, v241, 3, v240
v_sub_u32 v248, 15, v248
v_mfma_f32_16x16x32_bf16 v[224:227], v[120:123], v[208:211], v[224:227]
v_and_b32 v249, 1, v248
v_lshlrev_b32 v249, 4, v249
v_mfma_f32_16x16x32_bf16 v[228:231], v[120:123], v[212:215], v[228:231]
v_lshlrev_b32 v249, v249, s73
v_lshrrev_b32 v248, 1, v248
v_mfma_f32_16x16x32_bf16 v[232:235], v[120:123], v[216:219], v[232:235]
s_waitcnt lgkmcnt(8)
v_mfma_f32_16x16x32_bf16 v[236:239], v[120:123], v[220:223], v[236:239]
s_barrier
s_lshr_b32 s69, s93, 4
s_and_b32 s69, s69, 0x7f00
s_add_u32 s69, s69, LHT4-Lpc0
v_lshrrev_b32 v3, 5, v0
v_lshlrev_b32 v3, 7, v3
v_add_u32 v3, s69, v3
v_min_u32 v3, Lcode_end-Lpc0, v3
global_load_dword v4, v3, s[98:99]
s_cmp_eq_u32 s58, 0
s_cbranch_scc1 Lta43
s_cmp_eq_u32 s58, 1
s_cbranch_scc1 Lnt44
v_mfma_f32_16x16x32_bf16 v[136:139], a[128:131], v[48:51], v[88:91]
s_add_u32 s82, s82, 0x8000
ds_read_b128 a[160:163], v2 offset:24576
ds_read_b128 a[164:167], v2 offset:25600
v_mfma_f32_16x16x32_bf16 v[152:155], a[144:147], v[48:51], v[88:91]
s_and_b32 s82, s82, 0x1ffff
v_exp_f32 v164, v164
s_branch Ljoin45
Lta43:
v_mfma_f32_16x16x32_bf16 v[136:139], a[128:131], v[48:51], v[104:107]
s_add_u32 s82, s82, 0x8000
ds_read_b128 a[160:163], v2 offset:24576
ds_read_b128 a[164:167], v2 offset:25600
v_mfma_f32_16x16x32_bf16 v[152:155], a[144:147], v[48:51], v[112:115]
s_and_b32 s82, s82, 0x1ffff
v_exp_f32 v164, v164
s_branch Ljoin45
Lnt44:
v_mfma_f32_16x16x32_bf16 v[136:139], a[128:131], v[48:51], v[88:91]
s_add_u32 s82, s82, 0x8000
ds_read_b128 a[160:163], v2 offset:24576
ds_read_b128 a[164:167], v2 offset:25600
v_mfma_f32_16x16x32_bf16 v[152:155], a[144:147], v[48:51], v[104:107]
s_and_b32 s82, s82, 0x1ffff
v_exp_f32 v164, v164
Ljoin45:
v_mfma_f32_16x16x32_bf16 v[136:139], a[132:135], v[52:55], v[136:139]
s_add_u32 s66, s58, 3
v_exp_f32 v165, v165
v_mfma_f32_16x16x32_bf16 v[136:139], a[136:139], v[56:59], v[136:139]
s_and_b32 s66, s66, 3
v_exp_f32 v166, v166
v_mfma_f32_16x16x32_bf16 v[136:139], a[140:143], v[60:63], v[136:139]
s_mul_i32 s66, s66, 4160
ds_read_b128 a[168:171], v2 offset:26624
v_cvt_pk_bf16_f32 v212, v164, v165
v_mfma_f32_16x16x32_bf16 v[140:143], a[140:143], v[76:79], v[92:95]
s_add_u32 s66, s66, s92
v_exp_f32 v167, v167
v_mfma_f32_16x16x32_bf16 v[140:143], a[136:139], v[72:75], v[140:143]
s_add_u32 m0, s66, 32
v_exp_f32 v180, v180
v_mfma_f32_16x16x32_bf16 v[140:143], a[132:135], v[68:71], v[140:143]
s_add_u32 s72, s93, 0x6
buffer_load_dwordx4 v1, s[36:39], s72 offen lds
v_mfma_f32_16x16x32_bf16 v[140:143], a[128:131], v[64:67], v[140:143]
ds_read_b128 a[172:175], v2 offset:27648
v_cvt_pk_bf16_f32 v213, v166, v167
v_mfma_f32_16x16x32_bf16 v[156:159], a[144:147], v[64:67], v[92:95]
v_exp_f32 v181, v181
v_mfma_f32_16x16x32_bf16 v[156:159], a[148:151], v[68:71], v[156:159]
ds_read_b128 a[176:179], v2 offset:28672
v_cvt_pk_bf16_f32 v214, v180, v181
v_mfma_f32_16x16x32_bf16 v[156:159], a[152:155], v[72:75], v[156:159]
v_exp_f32 v182, v182
v_mfma_f32_16x16x32_bf16 v[156:159], a[156:159], v[76:79], v[156:159]
v_exp_f32 v183, v183
v_mfma_f32_16x16x32_bf16 v[152:155], a[156:159], v[60:63], v[152:155]
ds_read_b128 a[180:183], v2 offset:29696
v_cvt_pk_bf16_f32 v215, v182, v183
v_mfma_f32_16x16x32_bf16 v[152:155], a[152:155], v[56:59], v[152:155]
v_exp_f32 v168, v168
v_mfma_f32_16x16x32_bf16 v[152:155], a[148:151], v[52:55], v[152:155]
s_waitcnt lgkmcnt(6)
ds_read_b128 a[184:187], v2 offset:30720
ds_read_b128 a[188:191], v2 offset:31744
v_mfma_f32_16x16x32_bf16 a[32:35], a[192:195], v[196:199], a[32:35]
v_exp_f32 v169, v169
v_mfma_f32_16x16x32_bf16 a[64:67], a[192:195], v[200:203], a[64:67]
buffer_load_dwordx4 v1, s[36:39], s72 offen offset:1024 lds
v_mfma_f32_16x16x32_bf16 a[96:99], a[192:195], v[204:207], a[96:99]
v_exp_f32 v170, v170
v_mfma_f32_16x16x32_bf16 a[100:103], a[196:199], v[204:207], a[100:103]
v_exp_f32 v171, v171
v_mfma_f32_16x16x32_bf16 a[68:71], a[196:199], v[200:203], a[68:71]
ds_read_b128 a[224:227], v2 offset:8192
v_cvt_pk_bf16_f32 v216, v168, v169
v_mfma_f32_16x16x32_bf16 a[36:39], a[196:199], v[196:199], a[36:39]
v_exp_f32 v184, v184
v_mfma_f32_16x16x32_bf16 a[40:43], a[200:203], v[196:199], a[40:43]
v_exp_f32 v185, v185
v_mfma_f32_16x16x32_bf16 a[72:75], a[200:203], v[200:203], a[72:75]
ds_read_b128 a[228:231], v2 offset:9216
v_cvt_pk_bf16_f32 v217, v170, v171
v_mfma_f32_16x16x32_bf16 a[104:107], a[200:203], v[204:207], a[104:107]
v_exp_f32 v186, v186
v_mfma_f32_16x16x32_bf16 a[108:111], a[204:207], v[204:207], a[108:111]
ds_read_b128 a[232:235], v2 offset:10240
v_cvt_pk_bf16_f32 v218, v184, v185
v_mfma_f32_16x16x32_bf16 a[76:79], a[204:207], v[200:203], a[76:79]
v_exp_f32 v187, v187
v_mfma_f32_16x16x32_bf16 a[44:47], a[204:207], v[196:199], a[44:47]
buffer_load_dwordx4 v1, s[36:39], s72 offen offset:2048 lds
v_mfma_f32_16x16x32_bf16 a[48:51], a[208:211], v[196:199], a[48:51]
v_exp_f32 v172, v172
v_mfma_f32_16x16x32_bf16 a[80:83], a[208:211], v[200:203], a[80:83]
ds_read_b128 a[236:239], v2 offset:11264
v_cvt_pk_bf16_f32 v219, v186, v187
v_mfma_f32_16x16x32_bf16 a[112:115], a[208:211], v[204:207], a[112:115]
v_exp_f32 v173, v173
v_mfma_f32_16x16x32_bf16 a[116:119], a[212:215], v[204:207], a[116:119]
ds_read_b128 a[240:243], v2 offset:12288
v_cvt_pk_bf16_f32 v220, v172, v173
v_mfma_f32_16x16x32_bf16 a[84:87], a[212:215], v[200:203], a[84:87]
v_exp_f32 v174, v174
v_mfma_f32_16x16x32_bf16 a[52:55], a[212:215], v[196:199], a[52:55]
v_exp_f32 v175, v175
v_mfma_f32_16x16x32_bf16 a[56:59], a[216:219], v[196:199], a[56:59]
ds_read_b128 a[244:247], v2 offset:13312
v_cvt_pk_bf16_f32 v221, v174, v175
v_mfma_f32_16x16x32_bf16 a[88:91], a[216:219], v[200:203], a[88:91]
v_exp_f32 v188, v188
v_mfma_f32_16x16x32_bf16 a[120:123], a[216:219], v[204:207], a[120:123]
ds_read_b128 a[248:251], v2 offset:14336
v_mfma_f32_16x16x32_bf16 a[124:127], a[220:223], v[204:207], a[124:127]
v_exp_f32 v189, v189
v_mfma_f32_16x16x32_bf16 a[92:95], a[220:223], v[200:203], a[92:95]
buffer_load_dwordx4 v1, s[36:39], s72 offen offset:3072 lds
v_mfma_f32_16x16x32_bf16 a[60:63], a[220:223], v[196:199], a[60:63]
ds_read_b128 a[252:255], v2 offset:15360
v_cvt_pk_bf16_f32 v222, v188, v189
v_mfma_f32_16x16x32_bf16 v[228:231], v[120:123], v[196:199], v[228:231]
v_exp_f32 v190, v190
v_mfma_f32_16x16x32_bf16 v[232:235], v[120:123], v[200:203], v[232:235]
s_waitcnt vmcnt(9) lgkmcnt(0)
v_exp_f32 v191, v191
v_mfma_f32_16x16x32_bf16 v[236:239], v[120:123], v[204:207], v[236:239]
s_barrier
v_cvt_pk_bf16_f32 v223, v190, v191
v_add_u32 v2, s82, v1
s_cmp_eq_u32 s58, 2
s_cbranch_scc1 Lta46
s_cmp_eq_u32 s58, 3
s_cbranch_scc1 Lnt47
v_mfma_f32_16x16x32_bf16 v[168:171], a[160:163], v[48:51], v[112:115]
s_mov_b32 m0, s62
v_exp_f32 v136, v136
v_mfma_f32_16x16x32_bf16 v[184:187], a[176:179], v[48:51], v[112:115]
s_add_u32 s72, s93, 0x3000000
ds_read_b128 a[128:131], v2 offset:16384
s_branch Ljoin48
Lta46:
v_mfma_f32_16x16x32_bf16 v[168:171], a[160:163], v[48:51], v[104:107]
s_mov_b32 m0, s62
v_exp_f32 v136, v136
v_mfma_f32_16x16x32_bf16 v[184:187], a[176:179], v[48:51], v[112:115]
s_add_u32 s72, s93, 0x3000000
ds_read_b128 a[128:131], v2 offset:16384
s_branch Ljoin48
Lnt47:
v_mfma_f32_16x16x32_bf16 v[168:171], a[160:163], v[48:51], v[88:91]
s_mov_b32 m0, s62
v_exp_f32 v136, v136
v_mfma_f32_16x16x32_bf16 v[184:187], a[176:179], v[48:51], v[104:107]
s_add_u32 s72, s93, 0x3000000
ds_read_b128 a[128:131], v2 offset:16384
Ljoin48:
v_mfma_f32_16x16x32_bf16 v[168:171], a[164:167], v[52:55], v[168:171]
buffer_load_dwordx4 v1, s[44:47], s72 offen sc1 lds
v_mfma_f32_16x16x32_bf16 v[168:171], a[168:171], v[56:59], v[168:171]
v_exp_f32 v137, v137
v_mfma_f32_16x16x32_bf16 v[168:171], a[172:175], v[60:63], v[168:171]
ds_read_b128 a[132:135], v2 offset:17408
v_cvt_pk_bf16_f32 v200, v136, v137
v_mfma_f32_16x16x32_bf16 v[172:175], a[172:175], v[76:79], v[92:95]
v_exp_f32 v138, v138
v_mfma_f32_16x16x32_bf16 v[172:175], a[168:171], v[72:75], v[172:175]
ds_read_b128 a[136:139], v2 offset:18432
v_and_b32 v241, 3, v0
v_mfma_f32_16x16x32_bf16 v[172:175], a[164:167], v[68:71], v[172:175]
buffer_load_dwordx4 v1, s[44:47], s72 offen offset:1024 sc1 lds
v_mfma_f32_16x16x32_bf16 v[172:175], a[160:163], v[64:67], v[172:175]
v_exp_f32 v139, v139
v_mfma_f32_16x16x32_bf16 v[188:191], a[176:179], v[64:67], v[92:95]
ds_read_b128 a[140:143], v2 offset:19456
v_cvt_pk_bf16_f32 v201, v138, v139
v_mfma_f32_16x16x32_bf16 v[188:191], a[180:183], v[68:71], v[188:191]
v_exp_f32 v152, v152
v_mfma_f32_16x16x32_bf16 v[188:191], a[184:187], v[72:75], v[188:191]
ds_read_b128 a[144:147], v2 offset:20480
v_cmp_eq_u32 vcc, 0, v248
v_mfma_f32_16x16x32_bf16 v[188:191], a[188:191], v[76:79], v[188:191]
buffer_load_dwordx4 v1, s[44:47], s72 offen offset:2048 sc1 lds
v_mfma_f32_16x16x32_bf16 v[184:187], a[188:191], v[60:63], v[184:187]
v_exp_f32 v153, v153
v_mfma_f32_16x16x32_bf16 v[184:187], a[184:187], v[56:59], v[184:187]
ds_read_b128 a[148:151], v2 offset:21504
v_cvt_pk_bf16_f32 v202, v152, v153
v_mfma_f32_16x16x32_bf16 v[184:187], a[180:183], v[52:55], v[184:187]
s_waitcnt lgkmcnt(6)
buffer_load_dwordx4 v1, s[44:47], s72 offen offset:3072 sc1 lds
v_mfma_f32_16x16x32_bf16 a[32:35], a[224:227], v[212:215], a[32:35]
s_add_u32 s66, s58, 0
v_exp_f32 v154, v154
v_mfma_f32_16x16x32_bf16 a[64:67], a[224:227], v[216:219], a[64:67]
s_and_b32 s66, s66, 3
ds_read_b128 a[152:155], v2 offset:22528
v_lshl_add_u32 v5, v241, 3, v5
v_mfma_f32_16x16x32_bf16 a[96:99], a[224:227], v[220:223], a[96:99]
s_mul_i32 s66, s66, 4160
v_exp_f32 v155, v155
v_mfma_f32_16x16x32_bf16 a[100:103], a[228:231], v[220:223], a[100:103]
s_add_u32 s66, s66, s92
ds_read_b128 a[156:159], v2 offset:23552
v_cvt_pk_bf16_f32 v203, v154, v155
v_mfma_f32_16x16x32_bf16 a[68:71], a[228:231], v[216:219], a[68:71]
s_add_u32 m0, s66, 16672
v_exp_f32 v140, v140
v_mfma_f32_16x16x32_bf16 a[36:39], a[228:231], v[212:215], a[36:39]
s_add_u32 s72, s93, 0x0
buffer_load_dwordx4 v1, s[36:39], s72 offen lds
v_mfma_f32_16x16x32_bf16 a[40:43], a[232:235], v[212:215], a[40:43]
ds_read_b128 a[192:195], v2 offset:0
v_cndmask_b32 v8, 0, v249, vcc
v_mfma_f32_16x16x32_bf16 a[72:75], a[232:235], v[216:219], a[72:75]
buffer_load_dwordx4 v1, s[36:39], s72 offen offset:1024 lds
v_mfma_f32_16x16x32_bf16 a[104:107], a[232:235], v[220:223], a[104:107]
v_exp_f32 v141, v141
v_mfma_f32_16x16x32_bf16 a[108:111], a[236:239], v[220:223], a[108:111]
ds_read_b128 a[196:199], v2 offset:1024
v_cvt_pk_bf16_f32 v204, v140, v141
v_mfma_f32_16x16x32_bf16 a[76:79], a[236:239], v[216:219], a[76:79]
v_exp_f32 v142, v142
v_mfma_f32_16x16x32_bf16 a[44:47], a[236:239], v[212:215], a[44:47]
ds_read_b128 a[200:203], v2 offset:2048
v_cmp_eq_u32 vcc, 1, v248
v_mfma_f32_16x16x32_bf16 a[48:51], a[240:243], v[212:215], a[48:51]
buffer_load_dwordx4 v1, s[36:39], s72 offen offset:2048 lds
v_mfma_f32_16x16x32_bf16 a[80:83], a[240:243], v[216:219], a[80:83]
v_exp_f32 v143, v143
v_mfma_f32_16x16x32_bf16 a[112:115], a[240:243], v[220:223], a[112:115]
ds_read_b128 a[204:207], v2 offset:3072
v_cvt_pk_bf16_f32 v205, v142, v143
v_mfma_f32_16x16x32_bf16 a[116:119], a[244:247], v[220:223], a[116:119]
v_exp_f32 v156, v156
v_mfma_f32_16x16x32_bf16 a[84:87], a[244:247], v[216:219], a[84:87]
ds_read_b128 a[208:211], v2 offset:4096
v_lshlrev_b32 v240, 4, v251
v_mfma_f32_16x16x32_bf16 a[52:55], a[244:247], v[212:215], a[52:55]
buffer_load_dwordx4 v1, s[36:39], s72 offen offset:3072 lds
v_mfma_f32_16x16x32_bf16 a[56:59], a[248:251], v[212:215], a[56:59]
s_add_u32 s66, s58, 2
v_exp_f32 v157, v157
v_mfma_f32_16x16x32_bf16 a[88:91], a[248:251], v[216:219], a[88:91]
s_and_b32 s66, s66, 3
ds_read_b128 a[212:215], v2 offset:5120
v_cvt_pk_bf16_f32 v206, v156, v157
v_mfma_f32_16x16x32_bf16 a[120:123], a[248:251], v[220:223], a[120:123]
s_mul_i32 s66, s66, 4160
v_exp_f32 v158, v158
v_mfma_f32_16x16x32_bf16 a[124:127], a[252:255], v[220:223], a[124:127]
s_add_u32 s66, s66, s92
ds_read_b128 a[216:219], v2 offset:6144
v_cndmask_b32 v9, 0, v249, vcc
v_mfma_f32_16x16x32_bf16 a[92:95], a[252:255], v[216:219], a[92:95]
s_add_u32 m0, s66, 33312
v_exp_f32 v159, v159
v_mfma_f32_16x16x32_bf16 a[60:63], a[252:255], v[212:215], a[60:63]
s_add_u32 s72, s93, 0x4
buffer_load_dwordx4 v1, s[36:39], s72 offen lds
v_mfma_f32_16x16x32_bf16 v[228:231], v[120:123], v[212:215], v[228:231]
ds_read_b128 a[220:223], v2 offset:7168
v_cvt_pk_bf16_f32 v207, v158, v159
v_mfma_f32_16x16x32_bf16 v[232:235], v[120:123], v[216:219], v[232:235]
buffer_load_dwordx4 v1, s[36:39], s72 offen offset:1024 lds
v_mfma_f32_16x16x32_bf16 v[236:239], v[120:123], v[220:223], v[236:239]
s_waitcnt lgkmcnt(8)
v_cmp_eq_u32 vcc, 2, v248
v_sub_u32 v240, 48, v240
v_lshlrev_b64 v[12:13], 16, s[88:89]
v_cndmask_b32 v10, 0, v249, vcc
v_cmp_eq_u32 vcc, 3, v248
v_lshlrev_b64 v[12:13], v240, v[12:13]
s_nop 0
v_cndmask_b32 v11, 0, v249, vcc
v_cmp_eq_u32 vcc, 3, v241
s_add_u32 s73, s62, 4096
v_lshl_add_u32 v14, v0, 3, s73
v_cndmask_b32 v12, 0, v12, vcc
v_cndmask_b32 v13, 0, v13, vcc
v_lshrrev_b32 v15, 4, v0
v_lshlrev_b32 v15, 1, v15
v_and_b32 v240, 7, v0
v_xor_b32 v15, v15, v240
v_lshlrev_b32 v15, 4, v15
v_lshrrev_b32 v240, 3, v0
v_lshl_add_u32 v15, v240, 11, v15
s_and_b32 s75, s59, 8
s_add_u32 s75, s75, s60
s_lshr_b32 s76, s59, 4
s_lshl_b32 s76, s76, 2
s_add_u32 s76, s76, s65
s_lshl_b32 s76, s76, 1
s_lshr_b32 s80, s59, 2
s_and_b32 s80, s80, 1
s_add_u32 s76, s76, s80
s_lshl_b32 s94, s58, 16
s_lshl_b32 s80, s76, 7
s_add_u32 s94, s94, s80
s_lshl_b32 s80, s75, 18
s_add_u32 s80, s80, s94
v_rcp_f32 v224, v224
v_rcp_f32 v228, v228
s_lshl_b32 s73, s59, 12
s_add_u32 s73, s73, 0x2000000
s_lshl_b32 s70, s67, 2
s_add_u32 s70, s70, s73
v_mov_b32 v225, v224
v_accvgpr_read_b32 v240, a0
v_accvgpr_read_b32 v241, a1
v_accvgpr_read_b32 v242, a2
v_accvgpr_read_b32 v243, a3
v_accvgpr_read_b32 v244, a4
v_accvgpr_read_b32 v245, a5
v_accvgpr_read_b32 v246, a6
v_accvgpr_read_b32 v247, a7
v_pk_mul_f32 v[240:241], v[240:241], v[224:225]
v_pk_mul_f32 v[242:243], v[242:243], v[224:225]
v_pk_mul_f32 v[244:245], v[244:245], v[224:225]
v_pk_mul_f32 v[246:247], v[246:247], v[224:225]
buffer_load_dwordx4 v1, s[36:39], s72 offen offset:2048 lds
v_cvt_pk_bf16_f32 v128, v240, v241
v_cvt_pk_bf16_f32 v129, v242, v243
v_cvt_pk_bf16_f32 v130, v244, v245
v_cvt_pk_bf16_f32 v131, v246, v247
v_accvgpr_read_b32 v248, a8
v_accvgpr_read_b32 v249, a9
v_accvgpr_read_b32 v250, a10
v_accvgpr_read_b32 v251, a11
v_accvgpr_read_b32 v252, a12
v_accvgpr_read_b32 v253, a13
v_accvgpr_read_b32 v254, a14
v_accvgpr_read_b32 v255, a15
v_pk_mul_f32 v[248:249], v[248:249], v[224:225]
v_pk_mul_f32 v[250:251], v[250:251], v[224:225]
v_pk_mul_f32 v[252:253], v[252:253], v[224:225]
v_pk_mul_f32 v[254:255], v[254:255], v[224:225]
v_cvt_pk_bf16_f32 v144, v248, v249
v_cvt_pk_bf16_f32 v145, v250, v251
buffer_load_dwordx4 v1, s[36:39], s72 offen offset:3072 lds
v_cvt_pk_bf16_f32 v146, v252, v253
v_cvt_pk_bf16_f32 v147, v254, v255
v_accvgpr_read_b32 v240, a16
v_accvgpr_read_b32 v241, a17
v_accvgpr_read_b32 v242, a18
v_accvgpr_read_b32 v243, a19
v_accvgpr_read_b32 v244, a20
v_accvgpr_read_b32 v245, a21
v_accvgpr_read_b32 v246, a22
v_accvgpr_read_b32 v247, a23
v_pk_mul_f32 v[240:241], v[240:241], v[224:225]
v_pk_mul_f32 v[242:243], v[242:243], v[224:225]
v_pk_mul_f32 v[244:245], v[244:245], v[224:225]
v_pk_mul_f32 v[246:247], v[246:247], v[224:225]
v_cvt_pk_bf16_f32 v160, v240, v241
v_cvt_pk_bf16_f32 v161, v242, v243
v_cvt_pk_bf16_f32 v162, v244, v245
v_cvt_pk_bf16_f32 v163, v246, v247
buffer_load_dwordx4 v[80:83], v15, s[4:7], s80 offen
v_accvgpr_read_b32 v248, a24
v_accvgpr_read_b32 v249, a25
v_accvgpr_read_b32 v250, a26
v_accvgpr_read_b32 v251, a27
v_accvgpr_read_b32 v252, a28
v_accvgpr_read_b32 v253, a29
v_accvgpr_read_b32 v254, a30
v_accvgpr_read_b32 v255, a31
v_pk_mul_f32 v[248:249], v[248:249], v[224:225]
v_pk_mul_f32 v[250:251], v[250:251], v[224:225]
v_pk_mul_f32 v[252:253], v[252:253], v[224:225]
v_pk_mul_f32 v[254:255], v[254:255], v[224:225]
v_cvt_pk_bf16_f32 v176, v248, v249
v_cvt_pk_bf16_f32 v177, v250, v251
v_cvt_pk_bf16_f32 v178, v252, v253
v_cvt_pk_bf16_f32 v179, v254, v255
v_mov_b32 v229, v228
v_accvgpr_read_b32 v240, a32
s_add_u32 s80, s80, 0x4000
buffer_load_dwordx4 v[84:87], v15, s[4:7], s80 offen
v_accvgpr_read_b32 v241, a33
v_accvgpr_read_b32 v242, a34
v_accvgpr_read_b32 v243, a35
v_accvgpr_read_b32 v244, a36
v_accvgpr_read_b32 v245, a37
v_accvgpr_read_b32 v246, a38
v_accvgpr_read_b32 v247, a39
v_pk_mul_f32 v[240:241], v[240:241], v[228:229]
v_pk_mul_f32 v[242:243], v[242:243], v[228:229]
v_pk_mul_f32 v[244:245], v[244:245], v[228:229]
v_pk_mul_f32 v[246:247], v[246:247], v[228:229]
v_cvt_pk_bf16_f32 v132, v240, v241
v_cvt_pk_bf16_f32 v133, v242, v243
v_cvt_pk_bf16_f32 v134, v244, v245
v_cvt_pk_bf16_f32 v135, v246, v247
v_accvgpr_read_b32 v248, a40
v_accvgpr_read_b32 v249, a41
v_accvgpr_read_b32 v250, a42
s_add_u32 s80, s80, 0x4000
buffer_load_dwordx4 v[96:99], v15, s[4:7], s80 offen
v_accvgpr_read_b32 v251, a43
v_accvgpr_read_b32 v252, a44
v_accvgpr_read_b32 v253, a45
v_accvgpr_read_b32 v254, a46
v_accvgpr_read_b32 v255, a47
v_pk_mul_f32 v[248:249], v[248:249], v[228:229]
v_pk_mul_f32 v[250:251], v[250:251], v[228:229]
v_pk_mul_f32 v[252:253], v[252:253], v[228:229]
v_pk_mul_f32 v[254:255], v[254:255], v[228:229]
v_cvt_pk_bf16_f32 v148, v248, v249
v_cvt_pk_bf16_f32 v149, v250, v251
v_cvt_pk_bf16_f32 v150, v252, v253
v_cvt_pk_bf16_f32 v151, v254, v255
v_accvgpr_read_b32 v240, a48
v_accvgpr_read_b32 v241, a49
v_accvgpr_read_b32 v242, a50
v_accvgpr_read_b32 v243, a51
v_accvgpr_read_b32 v244, a52
s_add_u32 s80, s80, 0x4000
buffer_load_dwordx4 v[100:103], v15, s[4:7], s80 offen
v_accvgpr_read_b32 v245, a53
v_accvgpr_read_b32 v246, a54
v_accvgpr_read_b32 v247, a55
v_pk_mul_f32 v[240:241], v[240:241], v[228:229]
v_pk_mul_f32 v[242:243], v[242:243], v[228:229]
v_pk_mul_f32 v[244:245], v[244:245], v[228:229]
v_pk_mul_f32 v[246:247], v[246:247], v[228:229]
v_cvt_pk_bf16_f32 v164, v240, v241
v_cvt_pk_bf16_f32 v165, v242, v243
v_cvt_pk_bf16_f32 v166, v244, v245
v_cvt_pk_bf16_f32 v167, v246, v247
v_accvgpr_read_b32 v248, a56
v_accvgpr_read_b32 v249, a57
v_accvgpr_read_b32 v250, a58
v_accvgpr_read_b32 v251, a59
v_accvgpr_read_b32 v252, a60
v_accvgpr_read_b32 v253, a61
v_accvgpr_read_b32 v254, a62
v_accvgpr_read_b32 v255, a63
v_pk_mul_f32 v[248:249], v[248:249], v[228:229]
v_pk_mul_f32 v[250:251], v[250:251], v[228:229]
v_pk_mul_f32 v[252:253], v[252:253], v[228:229]
v_pk_mul_f32 v[254:255], v[254:255], v[228:229]
v_cvt_pk_bf16_f32 v180, v248, v249
v_cvt_pk_bf16_f32 v181, v250, v251
v_cvt_pk_bf16_f32 v182, v252, v253
v_cvt_pk_bf16_f32 v183, v254, v255
s_cmp_eq_u32 s58, 0
s_cbranch_scc1 Lta49
s_cmp_eq_u32 s58, 1
s_cbranch_scc1 Lnt50
v_mfma_f32_16x16x32_bf16 v[140:143], a[128:131], v[64:67], v[92:95]
s_add_u32 s82, s82, 0x8000
ds_read_b128 a[160:163], v2 offset:24576
ds_read_b128 a[164:167], v2 offset:25600
v_mfma_f32_16x16x32_bf16 v[156:159], a[144:147], v[64:67], v[92:95]
s_and_b32 s82, s82, 0x1ffff
v_exp_f32 v168, v168
s_branch Ljoin51
Lta49:
v_mfma_f32_16x16x32_bf16 v[140:143], a[128:131], v[64:67], v[108:111]
s_add_u32 s82, s82, 0x8000
ds_read_b128 a[160:163], v2 offset:24576
ds_read_b128 a[164:167], v2 offset:25600
v_mfma_f32_16x16x32_bf16 v[156:159], a[144:147], v[64:67], v[112:115]
s_and_b32 s82, s82, 0x1ffff
v_exp_f32 v168, v168
s_branch Ljoin51
Lnt50:
v_mfma_f32_16x16x32_bf16 v[140:143], a[128:131], v[64:67], v[92:95]
s_add_u32 s82, s82, 0x8000
ds_read_b128 a[160:163], v2 offset:24576
ds_read_b128 a[164:167], v2 offset:25600
v_mfma_f32_16x16x32_bf16 v[156:159], a[144:147], v[64:67], v[108:111]
s_and_b32 s82, s82, 0x1ffff
v_exp_f32 v168, v168
Ljoin51:
v_mfma_f32_16x16x32_bf16 v[140:143], a[132:135], v[68:71], v[140:143]
v_exp_f32 v169, v169
v_mfma_f32_16x16x32_bf16 v[140:143], a[136:139], v[72:75], v[140:143]
ds_read_b128 a[168:171], v2 offset:26624
ds_read_b128 a[172:175], v2 offset:27648
v_mfma_f32_16x16x32_bf16 v[140:143], a[140:143], v[76:79], v[140:143]
v_exp_f32 v170, v170
v_mfma_f32_16x16x32_bf16 v[156:159], a[156:159], v[76:79], v[156:159]
v_exp_f32 v171, v171
v_mfma_f32_16x16x32_bf16 v[156:159], a[152:155], v[72:75], v[156:159]
buffer_store_dwordx4 v[128:131], v1, s[44:47], s70 offen sc1
v_mfma_f32_16x16x32_bf16 v[156:159], a[148:151], v[68:71], v[156:159]
s_waitcnt lgkmcnt(4)
ds_read_b128 a[176:179], v2 offset:28672
ds_read_b128 a[180:183], v2 offset:29696
v_mfma_f32_16x16x32_bf16 a[64:67], a[192:195], v[200:203], a[64:67]
v_exp_f32 v184, v184
v_mfma_f32_16x16x32_bf16 a[96:99], a[192:195], v[204:207], a[96:99]
ds_read_b128 a[184:187], v2 offset:30720
ds_read_b128 a[188:191], v2 offset:31744
v_mfma_f32_16x16x32_bf16 a[100:103], a[196:199], v[204:207], a[100:103]
ds_read_b128 a[224:227], v2 offset:8192
ds_read_b128 a[228:231], v2 offset:9216
v_mfma_f32_16x16x32_bf16 a[68:71], a[196:199], v[200:203], a[68:71]
ds_read_b128 a[232:235], v2 offset:10240
ds_read_b128 a[236:239], v2 offset:11264
v_mfma_f32_16x16x32_bf16 a[72:75], a[200:203], v[200:203], a[72:75]
ds_read_b128 a[240:243], v2 offset:12288
ds_read_b128 a[244:247], v2 offset:13312
v_mfma_f32_16x16x32_bf16 a[104:107], a[200:203], v[204:207], a[104:107]
ds_read_b128 a[248:251], v2 offset:14336
ds_read_b128 a[252:255], v2 offset:15360
v_mfma_f32_16x16x32_bf16 a[108:111], a[204:207], v[204:207], a[108:111]
v_cvt_pk_bf16_f32 v216, v168, v169
v_cvt_pk_bf16_f32 v217, v170, v171
v_mfma_f32_16x16x32_bf16 a[76:79], a[204:207], v[200:203], a[76:79]
v_exp_f32 v185, v185
v_mfma_f32_16x16x32_bf16 a[80:83], a[208:211], v[200:203], a[80:83]
v_exp_f32 v186, v186
v_mfma_f32_16x16x32_bf16 a[112:115], a[208:211], v[204:207], a[112:115]
v_exp_f32 v187, v187
v_mfma_f32_16x16x32_bf16 a[116:119], a[212:215], v[204:207], a[116:119]
v_exp_f32 v172, v172
v_mfma_f32_16x16x32_bf16 a[84:87], a[212:215], v[200:203], a[84:87]
buffer_store_dwordx4 v[144:147], v1, s[44:47], s70 offen offset:1024 sc1
v_mfma_f32_16x16x32_bf16 a[88:91], a[216:219], v[200:203], a[88:91]
v_cvt_pk_bf16_f32 v218, v184, v185
v_cvt_pk_bf16_f32 v219, v186, v187
v_mfma_f32_16x16x32_bf16 a[120:123], a[216:219], v[204:207], a[120:123]
v_exp_f32 v173, v173
v_mfma_f32_16x16x32_bf16 a[124:127], a[220:223], v[204:207], a[124:127]
v_exp_f32 v174, v174
v_mfma_f32_16x16x32_bf16 a[92:95], a[220:223], v[200:203], a[92:95]
buffer_store_dwordx4 v[160:163], v1, s[44:47], s70 offen offset:2048 sc1
v_mfma_f32_16x16x32_bf16 v[232:235], v[120:123], v[200:203], v[232:235]
s_waitcnt vmcnt(24) lgkmcnt(8)
v_exp_f32 v175, v175
v_mfma_f32_16x16x32_bf16 v[236:239], v[120:123], v[204:207], v[236:239]
s_barrier
v_exp_f32 v188, v188
v_add_u32 v2, s82, v1
v_cvt_pk_bf16_f32 v220, v172, v173
v_cvt_pk_bf16_f32 v221, v174, v175
v_exp_f32 v189, v189
v_exp_f32 v190, v190
v_cvt_pk_bf16_f32 v222, v188, v189
v_exp_f32 v191, v191
s_nop 0
v_cvt_pk_bf16_f32 v223, v190, v191
s_cmp_eq_u32 s58, 2
s_cbranch_scc1 Lta52
s_cmp_eq_u32 s58, 3
s_cbranch_scc1 Lnt53
v_mfma_f32_16x16x32_bf16 v[172:175], a[160:163], v[64:67], v[112:115]
v_exp_f32 v140, v140
v_mfma_f32_16x16x32_bf16 v[188:191], a[176:179], v[64:67], v[112:115]
ds_read_b128 a[192:195], v2 offset:0
s_branch Ljoin54
Lta52:
v_mfma_f32_16x16x32_bf16 v[172:175], a[160:163], v[64:67], v[108:111]
v_exp_f32 v140, v140
v_mfma_f32_16x16x32_bf16 v[188:191], a[176:179], v[64:67], v[112:115]
ds_read_b128 a[192:195], v2 offset:0
s_branch Ljoin54
Lnt53:
v_mfma_f32_16x16x32_bf16 v[172:175], a[160:163], v[64:67], v[92:95]
v_exp_f32 v140, v140
v_mfma_f32_16x16x32_bf16 v[188:191], a[176:179], v[64:67], v[108:111]
ds_read_b128 a[192:195], v2 offset:0
Ljoin54:
v_mfma_f32_16x16x32_bf16 v[172:175], a[164:167], v[68:71], v[172:175]
v_exp_f32 v141, v141
v_mfma_f32_16x16x32_bf16 v[172:175], a[168:171], v[72:75], v[172:175]
ds_read_b128 a[196:199], v2 offset:1024
v_cvt_pk_bf16_f32 v204, v140, v141
v_mfma_f32_16x16x32_bf16 v[172:175], a[172:175], v[76:79], v[172:175]
s_add_u32 s78, s59, 4
buffer_store_dwordx4 v[176:179], v1, s[44:47], s70 offen offset:3072 sc1
v_mfma_f32_16x16x32_bf16 v[188:191], a[188:191], v[76:79], v[188:191]
s_add_u32 s70, s70, 0x80000
v_exp_f32 v142, v142
v_mfma_f32_16x16x32_bf16 v[188:191], a[184:187], v[72:75], v[188:191]
s_and_b32 s78, s78, 28
ds_read_b128 a[200:203], v2 offset:2048
v_mfma_f32_16x16x32_bf16 v[188:191], a[180:183], v[68:71], v[188:191]
s_waitcnt lgkmcnt(3)
v_exp_f32 v143, v143
v_mfma_f32_16x16x32_bf16 a[64:67], a[224:227], v[216:219], a[64:67]
s_add_u32 s12, s61, 0
ds_read_b128 a[204:207], v2 offset:3072
v_cvt_pk_bf16_f32 v205, v142, v143
v_mfma_f32_16x16x32_bf16 a[96:99], a[224:227], v[220:223], a[96:99]
s_and_b32 s12, s12, 3
v_exp_f32 v156, v156
v_mfma_f32_16x16x32_bf16 a[100:103], a[228:231], v[220:223], a[100:103]
s_add_u32 s12, s12, s78
ds_read_b128 a[208:211], v2 offset:4096
v_mfma_f32_16x16x32_bf16 a[68:71], a[228:231], v[216:219], a[68:71]
s_lshl_b32 s12, s12, 18
buffer_store_dwordx4 v[132:135], v1, s[44:47], s70 offen sc1
v_mfma_f32_16x16x32_bf16 a[72:75], a[232:235], v[216:219], a[72:75]
s_add_u32 s13, s61, 1
v_exp_f32 v157, v157
v_mfma_f32_16x16x32_bf16 a[104:107], a[232:235], v[220:223], a[104:107]
s_and_b32 s13, s13, 3
ds_read_b128 a[212:215], v2 offset:5120
v_cvt_pk_bf16_f32 v206, v156, v157
v_mfma_f32_16x16x32_bf16 a[108:111], a[236:239], v[220:223], a[108:111]
s_add_u32 s13, s13, s78
v_exp_f32 v158, v158
v_mfma_f32_16x16x32_bf16 a[76:79], a[236:239], v[216:219], a[76:79]
s_lshl_b32 s13, s13, 18
ds_read_b128 a[216:219], v2 offset:6144
v_mfma_f32_16x16x32_bf16 a[80:83], a[240:243], v[216:219], a[80:83]
s_add_u32 s14, s61, 2
buffer_store_dwordx4 v[148:151], v1, s[44:47], s70 offen offset:1024 sc1
v_mfma_f32_16x16x32_bf16 a[112:115], a[240:243], v[220:223], a[112:115]
s_and_b32 s14, s14, 3
v_exp_f32 v159, v159
v_mfma_f32_16x16x32_bf16 a[116:119], a[244:247], v[220:223], a[116:119]
s_add_u32 s14, s14, s78
ds_read_b128 a[220:223], v2 offset:7168
v_cvt_pk_bf16_f32 v207, v158, v159
v_mfma_f32_16x16x32_bf16 a[84:87], a[244:247], v[216:219], a[84:87]
s_lshl_b32 s14, s14, 18
v_mfma_f32_16x16x32_bf16 a[88:91], a[248:251], v[216:219], a[88:91]
s_add_u32 s15, s61, 3
v_mfma_f32_16x16x32_bf16 a[120:123], a[248:251], v[220:223], a[120:123]
s_and_b32 s15, s15, 3
v_mfma_f32_16x16x32_bf16 a[124:127], a[252:255], v[220:223], a[124:127]
s_add_u32 s15, s15, s78
v_mfma_f32_16x16x32_bf16 a[92:95], a[252:255], v[216:219], a[92:95]
s_lshl_b32 s15, s15, 18
v_mfma_f32_16x16x32_bf16 v[232:235], v[120:123], v[216:219], v[232:235]
s_xor_b32 s78, s94, 0x80
v_mfma_f32_16x16x32_bf16 v[236:239], v[120:123], v[220:223], v[236:239]
s_waitcnt lgkmcnt(0)
v_mfma_f32_16x16x32_bf16 a[96:99], a[192:195], v[204:207], a[96:99]
s_add_u32 s82, s82, 0x8000
ds_read_b128 a[224:227], v2 offset:8192
ds_read_b128 a[228:231], v2 offset:9216
v_mfma_f32_16x16x32_bf16 a[100:103], a[196:199], v[204:207], a[100:103]
s_and_b32 s82, s82, 0x1ffff
v_exp_f32 v172, v172
v_mfma_f32_16x16x32_bf16 a[104:107], a[200:203], v[204:207], a[104:107]
ds_read_b128 a[232:235], v2 offset:10240
ds_read_b128 a[236:239], v2 offset:11264
v_mfma_f32_16x16x32_bf16 a[108:111], a[204:207], v[204:207], a[108:111]
buffer_store_dwordx4 v[164:167], v1, s[44:47], s70 offen offset:2048 sc1
v_mfma_f32_16x16x32_bf16 a[112:115], a[208:211], v[204:207], a[112:115]
ds_read_b128 a[240:243], v2 offset:12288
ds_read_b128 a[244:247], v2 offset:13312
v_mfma_f32_16x16x32_bf16 a[116:119], a[212:215], v[204:207], a[116:119]
ds_read_b128 a[248:251], v2 offset:14336
ds_read_b128 a[252:255], v2 offset:15360
v_mfma_f32_16x16x32_bf16 a[120:123], a[216:219], v[204:207], a[120:123]
buffer_store_dwordx4 v[180:183], v1, s[44:47], s70 offen offset:3072 sc1
v_mfma_f32_16x16x32_bf16 a[124:127], a[220:223], v[204:207], a[124:127]
s_waitcnt vmcnt(8) lgkmcnt(0)
v_exp_f32 v173, v173
v_mfma_f32_16x16x32_bf16 v[236:239], v[120:123], v[204:207], v[236:239]
s_barrier
v_exp_f32 v174, v174
v_add_u32 v2, s82, v1
v_cvt_pk_bf16_f32 v220, v172, v173
v_exp_f32 v175, v175
v_exp_f32 v188, v188
v_cvt_pk_bf16_f32 v221, v174, v175
v_exp_f32 v189, v189
v_exp_f32 v190, v190
v_cvt_pk_bf16_f32 v222, v188, v189
v_exp_f32 v191, v191
s_nop 0
v_cvt_pk_bf16_f32 v223, v190, v191
s_branch LHT4
Lslow:
s_waitcnt vmcnt(0) lgkmcnt(0)
s_barrier
s_mov_b32 s86, 1
s_lshl_b32 s81, s59, 20
s_add_u32 s81, s81, s64
s_sub_u32 s81, s81, 0x4000
s_mov_b32 s83, 0
s_lshl_b32 s75, s60, 3
s_sub_u32 s76, 128, s75
s_add_u32 s74, s75, s58
s_sub_u32 s75, s76, 8
s_add_u32 s75, s75, s58
v_mov_b32 v2, v1
v_lshrrev_b32 v240, 4, v0
v_and_b32 v241, 15, v0
v_lshlrev_b32 v240, 2, v240
v_sub_u32 v240, v241, v240
v_mov_b32 v112, 0xff800000
v_mov_b32 v113, 0xff800000
v_mov_b32 v114, 0xff800000
v_mov_b32 v115, 0xff800000
v_cmp_gt_i32 vcc, 0, v240
v_mov_b32 v120, 0x3f803f80
s_nop 0
v_cndmask_b32 v116, 0, v112, vcc
v_cmp_gt_i32 vcc, 1, v240
v_mov_b32 v121, 0x3f803f80
s_nop 0
v_cndmask_b32 v117, 0, v112, vcc
v_cmp_gt_i32 vcc, 2, v240
v_mov_b32 v122, 0x3f803f80
s_nop 0
v_cndmask_b32 v118, 0, v112, vcc
v_cmp_gt_i32 vcc, 3, v240
v_mov_b32 v123, 0x3f803f80
s_nop 0
v_cndmask_b32 v119, 0, v112, vcc
Lslow1:
s_add_u32 m0, s64, 16384
s_add_u32 s72, s81, 16384
buffer_load_dwordx4 v1, s[44:47], s72 offen sc1 lds
buffer_load_dwordx4 v1, s[44:47], s72 offen offset:1024 sc1 lds
buffer_load_dwordx4 v1, s[44:47], s72 offen offset:2048 sc1 lds
buffer_load_dwordx4 v1, s[44:47], s72 offen offset:3072 sc1 lds
s_add_u32 s81, s81, 0x8000
s_waitcnt vmcnt(0)
s_barrier
ds_read_b128 a[128:131], v2 offset:16384
ds_read_b128 a[132:135], v2 offset:17408
ds_read_b128 a[136:139], v2 offset:18432
ds_read_b128 a[140:143], v2 offset:19456
ds_read_b128 a[144:147], v2 offset:20480
ds_read_b128 a[148:151], v2 offset:21504
ds_read_b128 a[152:155], v2 offset:22528
ds_read_b128 a[156:159], v2 offset:23552
s_waitcnt lgkmcnt(0)
s_add_u32 s73, s74, 0
s_cmp_lt_u32 s73, s83
s_cbranch_scc1 Lsa55
s_cmp_eq_u32 s73, s83
s_cbranch_scc1 Lst56
v_mfma_f32_16x16x32_bf16 v[128:131], a[128:131], v[16:19], 0
s_branch Lsj57
Lst56:
v_mfma_f32_16x16x32_bf16 v[128:131], a[128:131], v[16:19], v[116:119]
Lsj57:
v_mfma_f32_16x16x32_bf16 v[128:131], a[132:135], v[20:23], v[128:131]
v_mfma_f32_16x16x32_bf16 v[128:131], a[136:139], v[24:27], v[128:131]
v_mfma_f32_16x16x32_bf16 v[128:131], a[140:143], v[28:31], v[128:131]
s_nop 7
v_max3_f32 v124, v124, v128, v129
v_max3_f32 v124, v124, v130, v131
Lsa55:
s_add_u32 s73, s74, 4
s_cmp_lt_u32 s73, s83
s_cbranch_scc1 Lsa58
s_cmp_eq_u32 s73, s83
s_cbranch_scc1 Lst59
v_mfma_f32_16x16x32_bf16 v[132:135], a[128:131], v[32:35], 0
s_branch Lsj60
Lst59:
v_mfma_f32_16x16x32_bf16 v[132:135], a[128:131], v[32:35], v[116:119]
Lsj60:
v_mfma_f32_16x16x32_bf16 v[132:135], a[132:135], v[36:39], v[132:135]
v_mfma_f32_16x16x32_bf16 v[132:135], a[136:139], v[40:43], v[132:135]
v_mfma_f32_16x16x32_bf16 v[132:135], a[140:143], v[44:47], v[132:135]
s_nop 7
v_max3_f32 v125, v125, v132, v133
v_max3_f32 v125, v125, v134, v135
Lsa58:
s_add_u32 s73, s75, 0
s_cmp_lt_u32 s73, s83
s_cbranch_scc1 Lsa61
s_cmp_eq_u32 s73, s83
s_cbranch_scc1 Lst62
v_mfma_f32_16x16x32_bf16 v[136:139], a[128:131], v[48:51], 0
s_branch Lsj63
Lst62:
v_mfma_f32_16x16x32_bf16 v[136:139], a[128:131], v[48:51], v[116:119]
Lsj63:
v_mfma_f32_16x16x32_bf16 v[136:139], a[132:135], v[52:55], v[136:139]
v_mfma_f32_16x16x32_bf16 v[136:139], a[136:139], v[56:59], v[136:139]
v_mfma_f32_16x16x32_bf16 v[136:139], a[140:143], v[60:63], v[136:139]
s_nop 7
v_max3_f32 v126, v126, v136, v137
v_max3_f32 v126, v126, v138, v139
Lsa61:
s_add_u32 s73, s75, 4
s_cmp_lt_u32 s73, s83
s_cbranch_scc1 Lsa64
s_cmp_eq_u32 s73, s83
s_cbranch_scc1 Lst65
v_mfma_f32_16x16x32_bf16 v[140:143], a[128:131], v[64:67], 0
s_branch Lsj66
Lst65:
v_mfma_f32_16x16x32_bf16 v[140:143], a[128:131], v[64:67], v[116:119]
Lsj66:
v_mfma_f32_16x16x32_bf16 v[140:143], a[132:135], v[68:71], v[140:143]
v_mfma_f32_16x16x32_bf16 v[140:143], a[136:139], v[72:75], v[140:143]
v_mfma_f32_16x16x32_bf16 v[140:143], a[140:143], v[76:79], v[140:143]
s_nop 7
v_max3_f32 v127, v127, v140, v141
v_max3_f32 v127, v127, v142, v143
Lsa64:
s_add_u32 s83, s83, 1
s_add_u32 s73, s74, 0
s_cmp_lt_u32 s73, s83
s_cbranch_scc1 Lsa67
s_cmp_eq_u32 s73, s83
s_cbranch_scc1 Lst68
v_mfma_f32_16x16x32_bf16 v[144:147], a[144:147], v[16:19], 0
s_branch Lsj69
Lst68:
v_mfma_f32_16x16x32_bf16 v[144:147], a[144:147], v[16:19], v[116:119]
Lsj69:
v_mfma_f32_16x16x32_bf16 v[144:147], a[148:151], v[20:23], v[144:147]
v_mfma_f32_16x16x32_bf16 v[144:147], a[152:155], v[24:27], v[144:147]
v_mfma_f32_16x16x32_bf16 v[144:147], a[156:159], v[28:31], v[144:147]
s_nop 7
v_max3_f32 v124, v124, v144, v145
v_max3_f32 v124, v124, v146, v147
Lsa67:
s_add_u32 s73, s74, 4
s_cmp_lt_u32 s73, s83
s_cbranch_scc1 Lsa70
s_cmp_eq_u32 s73, s83
s_cbranch_scc1 Lst71
v_mfma_f32_16x16x32_bf16 v[148:151], a[144:147], v[32:35], 0
s_branch Lsj72
Lst71:
v_mfma_f32_16x16x32_bf16 v[148:151], a[144:147], v[32:35], v[116:119]
Lsj72:
v_mfma_f32_16x16x32_bf16 v[148:151], a[148:151], v[36:39], v[148:151]
v_mfma_f32_16x16x32_bf16 v[148:151], a[152:155], v[40:43], v[148:151]
v_mfma_f32_16x16x32_bf16 v[148:151], a[156:159], v[44:47], v[148:151]
s_nop 7
v_max3_f32 v125, v125, v148, v149
v_max3_f32 v125, v125, v150, v151
Lsa70:
s_add_u32 s73, s75, 0
s_cmp_lt_u32 s73, s83
s_cbranch_scc1 Lsa73
s_cmp_eq_u32 s73, s83
s_cbranch_scc1 Lst74
v_mfma_f32_16x16x32_bf16 v[152:155], a[144:147], v[48:51], 0
s_branch Lsj75
Lst74:
v_mfma_f32_16x16x32_bf16 v[152:155], a[144:147], v[48:51], v[116:119]
Lsj75:
v_mfma_f32_16x16x32_bf16 v[152:155], a[148:151], v[52:55], v[152:155]
v_mfma_f32_16x16x32_bf16 v[152:155], a[152:155], v[56:59], v[152:155]
v_mfma_f32_16x16x32_bf16 v[152:155], a[156:159], v[60:63], v[152:155]
s_nop 7
v_max3_f32 v126, v126, v152, v153
v_max3_f32 v126, v126, v154, v155
Lsa73:
s_add_u32 s73, s75, 4
s_cmp_lt_u32 s73, s83
s_cbranch_scc1 Lsa76
s_cmp_eq_u32 s73, s83
s_cbranch_scc1 Lst77
v_mfma_f32_16x16x32_bf16 v[156:159], a[144:147], v[64:67], 0
s_branch Lsj78
Lst77:
v_mfma_f32_16x16x32_bf16 v[156:159], a[144:147], v[64:67], v[116:119]
Lsj78:
v_mfma_f32_16x16x32_bf16 v[156:159], a[148:151], v[68:71], v[156:159]
v_mfma_f32_16x16x32_bf16 v[156:159], a[152:155], v[72:75], v[156:159]
v_mfma_f32_16x16x32_bf16 v[156:159], a[156:159], v[76:79], v[156:159]
s_nop 7
v_max3_f32 v127, v127, v156, v157
v_max3_f32 v127, v127, v158, v159
Lsa76:
s_add_u32 s83, s83, 1
ds_read_b128 a[128:131], v2 offset:24576
ds_read_b128 a[132:135], v2 offset:25600
ds_read_b128 a[136:139], v2 offset:26624
ds_read_b128 a[140:143], v2 offset:27648
ds_read_b128 a[144:147], v2 offset:28672
ds_read_b128 a[148:151], v2 offset:29696
ds_read_b128 a[152:155], v2 offset:30720
ds_read_b128 a[156:159], v2 offset:31744
s_waitcnt lgkmcnt(0)
s_add_u32 s73, s74, 0
s_cmp_lt_u32 s73, s83
s_cbranch_scc1 Lsa79
s_cmp_eq_u32 s73, s83
s_cbranch_scc1 Lst80
v_mfma_f32_16x16x32_bf16 v[128:131], a[128:131], v[16:19], 0
s_branch Lsj81
Lst80:
v_mfma_f32_16x16x32_bf16 v[128:131], a[128:131], v[16:19], v[116:119]
Lsj81:
v_mfma_f32_16x16x32_bf16 v[128:131], a[132:135], v[20:23], v[128:131]
v_mfma_f32_16x16x32_bf16 v[128:131], a[136:139], v[24:27], v[128:131]
v_mfma_f32_16x16x32_bf16 v[128:131], a[140:143], v[28:31], v[128:131]
s_nop 7
v_max3_f32 v124, v124, v128, v129
v_max3_f32 v124, v124, v130, v131
Lsa79:
s_add_u32 s73, s74, 4
s_cmp_lt_u32 s73, s83
s_cbranch_scc1 Lsa82
s_cmp_eq_u32 s73, s83
s_cbranch_scc1 Lst83
v_mfma_f32_16x16x32_bf16 v[132:135], a[128:131], v[32:35], 0
s_branch Lsj84
Lst83:
v_mfma_f32_16x16x32_bf16 v[132:135], a[128:131], v[32:35], v[116:119]
Lsj84:
v_mfma_f32_16x16x32_bf16 v[132:135], a[132:135], v[36:39], v[132:135]
v_mfma_f32_16x16x32_bf16 v[132:135], a[136:139], v[40:43], v[132:135]
v_mfma_f32_16x16x32_bf16 v[132:135], a[140:143], v[44:47], v[132:135]
s_nop 7
v_max3_f32 v125, v125, v132, v133
v_max3_f32 v125, v125, v134, v135
Lsa82:
s_add_u32 s73, s75, 0
s_cmp_lt_u32 s73, s83
s_cbranch_scc1 Lsa85
s_cmp_eq_u32 s73, s83
s_cbranch_scc1 Lst86
v_mfma_f32_16x16x32_bf16 v[136:139], a[128:131], v[48:51], 0
s_branch Lsj87
Lst86:
v_mfma_f32_16x16x32_bf16 v[136:139], a[128:131], v[48:51], v[116:119]
Lsj87:
v_mfma_f32_16x16x32_bf16 v[136:139], a[132:135], v[52:55], v[136:139]
v_mfma_f32_16x16x32_bf16 v[136:139], a[136:139], v[56:59], v[136:139]
v_mfma_f32_16x16x32_bf16 v[136:139], a[140:143], v[60:63], v[136:139]
s_nop 7
v_max3_f32 v126, v126, v136, v137
v_max3_f32 v126, v126, v138, v139
Lsa85:
s_add_u32 s73, s75, 4
s_cmp_lt_u32 s73, s83
s_cbranch_scc1 Lsa88
s_cmp_eq_u32 s73, s83
s_cbranch_scc1 Lst89
v_mfma_f32_16x16x32_bf16 v[140:143], a[128:131], v[64:67], 0
s_branch Lsj90
Lst89:
v_mfma_f32_16x16x32_bf16 v[140:143], a[128:131], v[64:67], v[116:119]
Lsj90:
v_mfma_f32_16x16x32_bf16 v[140:143], a[132:135], v[68:71], v[140:143]
v_mfma_f32_16x16x32_bf16 v[140:143], a[136:139], v[72:75], v[140:143]
v_mfma_f32_16x16x32_bf16 v[140:143], a[140:143], v[76:79], v[140:143]
s_nop 7
v_max3_f32 v127, v127, v140, v141
v_max3_f32 v127, v127, v142, v143
Lsa88:
s_add_u32 s83, s83, 1
s_add_u32 s73, s74, 0
s_cmp_lt_u32 s73, s83
s_cbranch_scc1 Lsa91
s_cmp_eq_u32 s73, s83
s_cbranch_scc1 Lst92
v_mfma_f32_16x16x32_bf16 v[144:147], a[144:147], v[16:19], 0
s_branch Lsj93
Lst92:
v_mfma_f32_16x16x32_bf16 v[144:147], a[144:147], v[16:19], v[116:119]
Lsj93:
v_mfma_f32_16x16x32_bf16 v[144:147], a[148:151], v[20:23], v[144:147]
v_mfma_f32_16x16x32_bf16 v[144:147], a[152:155], v[24:27], v[144:147]
v_mfma_f32_16x16x32_bf16 v[144:147], a[156:159], v[28:31], v[144:147]
s_nop 7
v_max3_f32 v124, v124, v144, v145
v_max3_f32 v124, v124, v146, v147
Lsa91:
s_add_u32 s73, s74, 4
s_cmp_lt_u32 s73, s83
s_cbranch_scc1 Lsa94
s_cmp_eq_u32 s73, s83
s_cbranch_scc1 Lst95
v_mfma_f32_16x16x32_bf16 v[148:151], a[144:147], v[32:35], 0
s_branch Lsj96
Lst95:
v_mfma_f32_16x16x32_bf16 v[148:151], a[144:147], v[32:35], v[116:119]
Lsj96:
v_mfma_f32_16x16x32_bf16 v[148:151], a[148:151], v[36:39], v[148:151]
v_mfma_f32_16x16x32_bf16 v[148:151], a[152:155], v[40:43], v[148:151]
v_mfma_f32_16x16x32_bf16 v[148:151], a[156:159], v[44:47], v[148:151]
s_nop 7
v_max3_f32 v125, v125, v148, v149
v_max3_f32 v125, v125, v150, v151
Lsa94:
s_add_u32 s73, s75, 0
s_cmp_lt_u32 s73, s83
s_cbranch_scc1 Lsa97
s_cmp_eq_u32 s73, s83
s_cbranch_scc1 Lst98
v_mfma_f32_16x16x32_bf16 v[152:155], a[144:147], v[48:51], 0
s_branch Lsj99
Lst98:
v_mfma_f32_16x16x32_bf16 v[152:155], a[144:147], v[48:51], v[116:119]
Lsj99:
v_mfma_f32_16x16x32_bf16 v[152:155], a[148:151], v[52:55], v[152:155]
v_mfma_f32_16x16x32_bf16 v[152:155], a[152:155], v[56:59], v[152:155]
v_mfma_f32_16x16x32_bf16 v[152:155], a[156:159], v[60:63], v[152:155]
s_nop 7
v_max3_f32 v126, v126, v152, v153
v_max3_f32 v126, v126, v154, v155
Lsa97:
s_add_u32 s73, s75, 4
s_cmp_lt_u32 s73, s83
s_cbranch_scc1 Lsa100
s_cmp_eq_u32 s73, s83
s_cbranch_scc1 Lst101
v_mfma_f32_16x16x32_bf16 v[156:159], a[144:147], v[64:67], 0
s_branch Lsj102
Lst101:
v_mfma_f32_16x16x32_bf16 v[156:159], a[144:147], v[64:67], v[116:119]
Lsj102:
v_mfma_f32_16x16x32_bf16 v[156:159], a[148:151], v[68:71], v[156:159]
v_mfma_f32_16x16x32_bf16 v[156:159], a[152:155], v[72:75], v[156:159]
v_mfma_f32_16x16x32_bf16 v[156:159], a[156:159], v[76:79], v[156:159]
s_nop 7
v_max3_f32 v127, v127, v156, v157
v_max3_f32 v127, v127, v158, v159
Lsa100:
s_add_u32 s83, s83, 1
s_barrier
s_cmp_lt_u32 s83, s76
s_cbranch_scc1 Lslow1
s_lshl_b32 s81, s59, 20
s_add_u32 s81, s81, s64
s_sub_u32 s81, s81, 0x4000
s_add_u32 m0, s64, 49152
s_add_u32 s72, s81, 16384
buffer_load_dwordx4 v1, s[44:47], s72 offen sc1 lds
buffer_load_dwordx4 v1, s[44:47], s72 offen offset:1024 sc1 lds
buffer_load_dwordx4 v1, s[44:47], s72 offen offset:2048 sc1 lds
buffer_load_dwordx4 v1, s[44:47], s72 offen offset:3072 sc1 lds
s_add_u32 s81, s81, 0x8000
s_add_u32 m0, s64, 81920
s_add_u32 s72, s81, 16384
buffer_load_dwordx4 v1, s[44:47], s72 offen sc1 lds
buffer_load_dwordx4 v1, s[44:47], s72 offen offset:1024 sc1 lds
buffer_load_dwordx4 v1, s[44:47], s72 offen offset:2048 sc1 lds
buffer_load_dwordx4 v1, s[44:47], s72 offen offset:3072 sc1 lds
s_add_u32 m0, s64, 65536
s_add_u32 s72, s81, 0
buffer_load_dwordx4 v1, s[44:47], s72 offen sc1 lds
buffer_load_dwordx4 v1, s[44:47], s72 offen offset:1024 sc1 lds
buffer_load_dwordx4 v1, s[44:47], s72 offen offset:2048 sc1 lds
buffer_load_dwordx4 v1, s[44:47], s72 offen offset:3072 sc1 lds
s_add_u32 s81, s81, 0x8000
s_add_u32 m0, s64, 114688
s_add_u32 s72, s81, 16384
buffer_load_dwordx4 v1, s[44:47], s72 offen sc1 lds
buffer_load_dwordx4 v1, s[44:47], s72 offen offset:1024 sc1 lds
buffer_load_dwordx4 v1, s[44:47], s72 offen offset:2048 sc1 lds
buffer_load_dwordx4 v1, s[44:47], s72 offen offset:3072 sc1 lds
s_add_u32 m0, s64, 98304
s_add_u32 s72, s81, 0
buffer_load_dwordx4 v1, s[44:47], s72 offen sc1 lds
buffer_load_dwordx4 v1, s[44:47], s72 offen offset:1024 sc1 lds
buffer_load_dwordx4 v1, s[44:47], s72 offen offset:2048 sc1 lds
buffer_load_dwordx4 v1, s[44:47], s72 offen offset:3072 sc1 lds
v_add_u32 v2, 0x8000, v1
v_lshrrev_b32 v3, 1, v0
v_lshlrev_b32 v3, 7, v3
s_waitcnt vmcnt(0)
s_barrier
ds_read_b128 a[128:131], v2 offset:16384
ds_read_b128 a[132:135], v2 offset:17408
ds_read_b128 a[136:139], v2 offset:18432
ds_read_b128 a[140:143], v2 offset:19456
ds_read_b128 a[144:147], v2 offset:20480
ds_read_b128 a[148:151], v2 offset:21504
ds_read_b128 a[152:155], v2 offset:22528
ds_read_b128 a[156:159], v2 offset:23552
s_branch Lattn
Lspin103:
s_mov_b32 s83, 262144
Lsl105:
s_sleep 2
buffer_load_dword v3, v2, s[44:47], s82 offen sc1
s_sub_u32 s83, s83, 1
s_cmp_eq_u32 s83, 0
s_waitcnt vmcnt(0)
s_cbranch_scc1 Lback104
v_cmp_gt_u32 vcc, 2, v3
s_cbranch_vccnz Lsl105
s_branch Lback104
Lspin106:
s_mov_b32 s83, 262144
Lsl108:
s_sleep 2
buffer_load_dword v14, v2, s[44:47], s79 offen sc1
s_sub_u32 s83, s83, 1
s_cmp_eq_u32 s83, 0
s_waitcnt vmcnt(0)
s_cbranch_scc1 Lback107
v_cmp_gt_u32 vcc, 2, v14
s_cbranch_vccnz Lsl108
s_branch Lback107
Lspin109:
s_mov_b32 s83, 262144
Lsl111:
s_sleep 2
buffer_load_dword v3, v2, s[44:47], s82 offen sc1
s_sub_u32 s83, s83, 1
s_cmp_eq_u32 s83, 0
s_waitcnt vmcnt(0)
s_cbranch_scc1 Lback110
v_cmp_gt_u32 vcc, 2, v3
s_cbranch_vccnz Lsl111
s_branch Lback110
Lspin112:
s_mov_b32 s83, 262144
Lsl114:
s_sleep 2
buffer_load_dword v3, v2, s[44:47], s82 offen sc1
s_sub_u32 s83, s83, 1
s_cmp_eq_u32 s83, 0
s_waitcnt vmcnt(0)
s_cbranch_scc1 Lback113
v_cmp_gt_u32 vcc, 2, v3
s_cbranch_vccnz Lsl114
s_branch Lback113
Lredo0:
s_add_u32 s82, s59, 4
s_and_b32 s82, s82, 28
s_lshl_b32 s82, s82, 10
s_add_u32 s82, s82, s74
buffer_load_dword v3, v2, s[44:47], s82 offen sc1
s_waitcnt vmcnt(0)
v_cmp_gt_u32 vcc, 2, v3
s_cbranch_vccnz Lspin103
Lback104:
s_lshr_b32 s69, s12, 6
s_add_u32 s69, s69, s95
buffer_load_dwordx4 a[0:3], v1, s[44:47], s69 offen sc1
buffer_load_dwordx4 a[4:7], v1, s[44:47], s69 offen offset:1024 sc1
buffer_load_dwordx4 a[8:11], v1, s[44:47], s69 offen offset:2048 sc1
buffer_load_dwordx4 a[12:15], v1, s[44:47], s69 offen offset:3072 sc1
s_add_u32 s69, s69, 0x20000
buffer_load_dwordx4 a[16:19], v1, s[44:47], s69 offen sc1
buffer_load_dwordx4 a[20:23], v1, s[44:47], s69 offen offset:1024 sc1
buffer_load_dwordx4 a[24:27], v1, s[44:47], s69 offen offset:2048 sc1
buffer_load_dwordx4 a[28:31], v1, s[44:47], s69 offen offset:3072 sc1
s_lshr_b32 s69, s13, 6
s_add_u32 s69, s69, s95
buffer_load_dwordx4 a[32:35], v1, s[44:47], s69 offen sc1
buffer_load_dwordx4 a[36:39], v1, s[44:47], s69 offen offset:1024 sc1
buffer_load_dwordx4 a[40:43], v1, s[44:47], s69 offen offset:2048 sc1
buffer_load_dwordx4 a[44:47], v1, s[44:47], s69 offen offset:3072 sc1
s_add_u32 s69, s69, 0x20000
buffer_load_dwordx4 a[48:51], v1, s[44:47], s69 offen sc1
buffer_load_dwordx4 a[52:55], v1, s[44:47], s69 offen offset:1024 sc1
buffer_load_dwordx4 a[56:59], v1, s[44:47], s69 offen offset:2048 sc1
buffer_load_dwordx4 a[60:63], v1, s[44:47], s69 offen offset:3072 sc1
s_waitcnt vmcnt(8)
s_branch Lredo0b
Lspin115:
s_mov_b32 s83, 262144
Lsl117:
s_sleep 2
buffer_load_dword v114, v115, s[44:47], s84 offen sc1
s_sub_u32 s83, s83, 1
s_cmp_eq_u32 s83, 0
s_waitcnt vmcnt(0)
s_cbranch_scc1 Lback116
v_cmp_gt_u32 vcc, 3, v114
s_cbranch_vccnz Lsl117
s_branch Lback116
Lspin118:
s_mov_b32 s83, 262144
Lsl120:
s_sleep 2
buffer_load_dword v14, v13, s[44:47], s79 offen sc1
s_sub_u32 s83, s83, 1
s_cmp_eq_u32 s83, 0
s_waitcnt vmcnt(0)
s_cbranch_scc1 Lback119
v_cmp_gt_u32 vcc, 2, v14
s_cbranch_vccnz Lsl120
s_branch Lback119
Lxspin:
s_mov_b32 s83, 262144
Lxsl:
buffer_load_dwordx4 v[64:67], v1, s[44:47], s79 offen sc1
buffer_load_dwordx4 v[68:71], v1, s[44:47], s79 offen offset:1024 sc1
buffer_load_dwordx4 v[72:75], v1, s[44:47], s79 offen offset:2048 sc1
buffer_load_dwordx4 v[76:79], v1, s[44:47], s79 offen offset:3072 sc1
s_sub_u32 s83, s83, 1
s_cmp_eq_u32 s83, 0
s_waitcnt vmcnt(0)
s_cbranch_scc1 Lxback
v_max3_u32 v112, v64, v65, v66
v_max3_u32 v112, v112, v67, v68
v_max3_u32 v112, v112, v69, v70
v_max3_u32 v112, v112, v71, v72
v_max3_u32 v112, v112, v73, v74
v_max3_u32 v112, v112, v75, v76
v_max3_u32 v112, v112, v77, v78
v_max3_u32 v112, v112, v79, v79
v_cmp_eq_u32 vcc, -1, v112
s_cbranch_vccnz Lxsl
s_branch Lxback
Lcode_end:
s_endpgm
.section .rodata,"a"
.p2align 6
.amdhsa_kernel gated_mix__compressed_kv_cla__ssm_conv_h3__prompt_kernel
  .amdhsa_next_free_vgpr 512
  .amdhsa_next_free_sgpr 102
  .amdhsa_accum_offset 256
  .amdhsa_group_segment_fixed_size 0
  .amdhsa_kernarg_size 128
  .amdhsa_user_sgpr_count 2
  .amdhsa_user_sgpr_kernarg_segment_ptr 1
  .amdhsa_system_sgpr_workgroup_id_x 1
  .amdhsa_float_denorm_mode_32 3
.end_amdhsa_kernel
```

```asm
; @launch grid=(256,1,1) block=(256,1,1) lds=163840
.amdgcn_target "amdgcn-amd-amdhsa--gfx950"
.text
.globl gated_mix__compressed_kv_cla__ssm_conv_h3__prompt_kernel
.p2align 8
.type gated_mix__compressed_kv_cla__ssm_conv_h3__prompt_kernel,@function
gated_mix__compressed_kv_cla__ssm_conv_h3__prompt_kernel:
s_cmp_ge_u32 s2, 256
s_cbranch_scc1 Lend
s_load_dwordx2 s[8:9], s[0:1], 8
s_load_dwordx2 s[16:17], s[0:1], 24
s_load_dwordx2 s[20:21], s[0:1], 32
s_load_dwordx2 s[4:5], s[0:1], 0
s_load_dwordx2 s[12:13], s[0:1], 16
s_load_dwordx2 s[24:25], s[0:1], 40
s_load_dwordx2 s[28:29], s[0:1], 56
s_load_dwordx2 s[32:33], s[0:1], 64
s_load_dwordx2 s[52:53], s[0:1], 72
s_load_dwordx2 s[36:37], s[0:1], 80
s_load_dwordx2 s[54:55], s[0:1], 88
s_load_dwordx2 s[56:57], s[0:1], 96
s_load_dwordx2 s[40:41], s[0:1], 104
s_load_dwordx2 s[48:49], s[0:1], 112
s_load_dwordx2 s[44:45], s[0:1], 120
s_getpc_b64 s[98:99]
Lpc0:
s_lshr_b32 s75, s2, 3
v_lshrrev_b32 v26, 3, v0
s_lshl_b32 s73, s75, 12
v_lshlrev_b32 v26, 7, v26
v_add_u32 v26, s73, v26
v_min_u32 v26, Lcode_end-Lpc0, v26
global_load_dword v31, v26, s[98:99]
v_lshrrev_b32 v26, 6, v0
v_and_b32 v0, 63, v0
s_and_b32 s73, s2, 7
v_readfirstlane_b32 s58, v26
s_lshr_b32 s65, s75, 3
s_and_b32 s60, s75, 7
s_lshl_b32 s59, s73, 2
s_add_u32 s59, s59, s65
s_lshl_b32 s61, s65, 1
s_lshl_b32 s63, s58, 13
s_lshl_b32 s64, s58, 12
s_lshl_b32 s67, s60, 18
s_lshl_b32 s76, s58, 16
s_add_u32 s84, s67, s76
s_lshl_b32 s66, s58, 17
s_lshl_b32 s73, s59, 8
s_add_u32 s66, s66, s73
v_lshrrev_b32 v26, 4, v0
v_and_b32 v27, 7, v0
v_xor_b32 v27, v27, v26
v_lshlrev_b32 v27, 4, v27
v_lshrrev_b32 v28, 3, v0
v_lshl_add_u32 v2, v28, 10, v27
v_xor_b32 v3, 64, v2
v_and_b32 v29, 15, v0
v_lshlrev_b32 v30, 1, v26
v_xor_b32 v30, v30, v29
v_lshlrev_b32 v30, 4, v30
v_lshl_add_u32 v6, v26, 13, v30
v_xor_b32 v7, 0x80, v6
s_mov_b32 s10, 0x200000
s_mov_b32 s11, 0x20000
s_mov_b32 s18, 0x400000
s_mov_b32 s19, 0x20000
s_mov_b32 s22, 0x400000
s_mov_b32 s23, 0x20000
s_lshl_b32 s73, s2, 2
s_add_u32 s73, s73, s58
s_lshl_b32 s73, s73, 11
v_lshrrev_b32 v124, 2, v0
v_lshlrev_b32 v124, 7, v124
v_add_u32 v124, s73, v124
s_lshl_b32 s73, s60, 2
s_add_u32 s73, s73, s58
s_lshl_b32 s73, s73, 13
s_lshl_b32 s74, s59, 8
s_add_u32 s73, s73, s74
v_lshrrev_b32 v125, 4, v0
v_lshlrev_b32 v125, 18, v125
v_bfe_u32 v126, v0, 3, 1
v_lshl_add_u32 v125, v126, 7, v125
v_add_u32 v125, s73, v125
s_waitcnt lgkmcnt(0)
s_mov_b32 s80, 0x0
buffer_load_dword v126, v125, s[16:19], s80 offen
buffer_load_dword v126, v125, s[20:23], s80 offen
s_and_b32 s73, s65, 1
s_xor_b32 s73, s73, 0
s_lshl_b32 s69, s73, 7
s_add_u32 s69, s69, s84
s_lshl_b32 s71, s73, 19
s_add_u32 s71, s71, s66
s_add_u32 m0, s63, 65536
s_add_u32 s72, s69, 0
buffer_load_dwordx4 v2, s[8:11], s72 offen lds
s_add_u32 s72, s69, 7168
buffer_load_dwordx4 v3, s[8:11], s72 offen offset:1024 lds
s_add_u32 s72, s69, 14336
buffer_load_dwordx4 v2, s[8:11], s72 offen offset:2048 lds
s_add_u32 s72, s69, 21504
buffer_load_dwordx4 v3, s[8:11], s72 offen offset:3072 lds
s_add_u32 m0, s64, 0
s_add_u32 s72, s71, 0
buffer_load_dwordx4 v6, s[16:19], s72 offen lds
s_add_u32 s72, s71, 31744
buffer_load_dwordx4 v6, s[16:19], s72 offen offset:1024 lds
s_add_u32 s72, s71, 63488
buffer_load_dwordx4 v7, s[16:19], s72 offen offset:2048 lds
s_add_u32 s72, s71, 95232
buffer_load_dwordx4 v7, s[16:19], s72 offen offset:3072 lds
s_add_u32 m0, s63, 69632
s_add_u32 s72, s69, 32768
buffer_load_dwordx4 v2, s[8:11], s72 offen lds
s_add_u32 s72, s69, 39936
buffer_load_dwordx4 v3, s[8:11], s72 offen offset:1024 lds
s_add_u32 s72, s69, 47104
buffer_load_dwordx4 v2, s[8:11], s72 offen offset:2048 lds
s_add_u32 s72, s69, 54272
buffer_load_dwordx4 v3, s[8:11], s72 offen offset:3072 lds
s_add_u32 m0, s64, 16384
s_add_u32 s72, s71, 0
buffer_load_dwordx4 v6, s[20:23], s72 offen lds
s_add_u32 s72, s71, 31744
buffer_load_dwordx4 v6, s[20:23], s72 offen offset:1024 lds
s_add_u32 s72, s71, 63488
buffer_load_dwordx4 v7, s[20:23], s72 offen offset:2048 lds
s_add_u32 s72, s71, 95232
buffer_load_dwordx4 v7, s[20:23], s72 offen offset:3072 lds
buffer_load_dword v126, v124, s[8:11], 0 offen
s_and_b32 s73, s65, 1
s_xor_b32 s73, s73, 1
s_lshl_b32 s69, s73, 7
s_add_u32 s69, s69, s84
s_lshl_b32 s71, s73, 19
s_add_u32 s71, s71, s66
s_add_u32 m0, s63, 98304
s_add_u32 s72, s69, 0
buffer_load_dwordx4 v2, s[8:11], s72 offen lds
s_add_u32 s72, s69, 7168
buffer_load_dwordx4 v3, s[8:11], s72 offen offset:1024 lds
s_add_u32 s72, s69, 14336
buffer_load_dwordx4 v2, s[8:11], s72 offen offset:2048 lds
s_add_u32 s72, s69, 21504
buffer_load_dwordx4 v3, s[8:11], s72 offen offset:3072 lds
s_branch Lmain
.p2align 12
Lmain:
s_mov_b32 s6, 0x400000
s_mov_b32 s7, 0x20000
s_mov_b32 s14, 0x800000
s_mov_b32 s15, 0x20000
s_mov_b32 s26, 0x800000
s_mov_b32 s27, 0x20000
s_mov_b32 s30, 0x400000
s_mov_b32 s31, 0x20000
s_mov_b32 s34, 0x400000
s_mov_b32 s35, 0x20000
s_mov_b32 s38, 0x400000
s_mov_b32 s39, 0x20000
s_mov_b32 s42, 0x400000
s_mov_b32 s43, 0x20000
s_mov_b32 s46, 0x5800000
s_mov_b32 s47, 0x20000
s_mov_b32 s50, 0x100
s_mov_b32 s51, 0x20000
v_lshl_add_u32 v4, v28, 11, v27
v_xor_b32 v5, 64, v4
v_lshlrev_b32 v1, 4, v0
s_sub_u32 s74, 15, s60
s_lshl_b32 s68, s74, 18
s_lshl_b32 s76, s58, 15
s_add_u32 s68, s68, s76
s_add_u32 s67, s67, s76
s_and_b32 s62, s60, 3
s_sub_u32 s62, 16, s62
s_lshl_b32 s91, s59, 3
s_add_u32 s91, s91, s60
s_lshl_b32 s93, s91, 2
s_add_u32 s93, s93, s58
s_lshl_b32 s91, s91, 7
s_add_u32 s91, s91, 0x3810000
s_lshl_b32 s75, s93, 1
s_and_b32 s75, s75, 0xffc
s_lshl_b32 s93, s93, 12
s_load_dwordx2 s[88:89], s[36:37], s93
s_load_dword s90, s[54:55], s75
v_or_b32 v29, s58, v0
v_mov_b32 v30, 0
v_min_u32 v29, 1, v29
v_lshlrev_b32 v29, 30, v29
buffer_store_dword v30, v29, s[44:47], s91 offen sc1
s_and_b32 s73, s2, 15
s_lshr_b32 s74, s2, 4
s_lshl_b32 s74, s74, 7
s_lshl_b32 s75, s58, 5
s_add_u32 s74, s74, s75
s_mov_b32 s75, 131072
v_lshrrev_b32 v29, 5, v0
v_lshlrev_b32 v29, 4, v29
v_add_u32 v29, s74, v29
v_and_b32 v30, 31, v0
s_lshl_b32 s73, s73, 5
v_add_u32 v30, s73, v30
v_lshlrev_b32 v26, 11, v29
v_lshl_add_u32 v26, v30, 2, v26
v_subrev_u32 v27, 0x1800, v26
s_lshl_b32 s82, s74, 11
s_lshl_b32 s73, s73, 2
s_add_u32 s82, s82, s73
v_lshrrev_b32 v26, 3, v0
v_and_b32 v32, 7, v0
v_lshlrev_b32 v32, 4, v32
v_lshl_add_u32 v26, v26, 11, v32
v_lshrrev_b32 v98, 5, v0
v_lshlrev_b32 v98, 11, v98
v_and_b32 v32, 31, v0
v_lshl_add_u32 v98, v32, 2, v98
v_add_u32 v98, s63, v98
v_add_u32 v98, s75, v98
v_and_b32 v29, 0x7f, v29
v_sub_u32 v29, 0x70, v29
v_lshlrev_b32 v29, 1, v29
v_and_b32 v32, 31, v0
v_mul_u32_u24 v32, 544, v32
v_add3_u32 v28, v32, v29, s75
v_lshlrev_b32 v30, 4, v30
s_lshl_b32 s73, s2, 14
s_lshl_b32 s74, s58, 12
s_add_u32 s76, s73, s74
v_and_b32 v29, 15, v0
v_lshrrev_b32 v32, 4, v0
v_lshrrev_b32 v24, 1, v29
v_xor_b32 v24, v24, v32
v_lshlrev_b32 v24, 4, v24
v_lshl_add_u32 v24, v29, 7, v24
s_add_u32 s73, s63, 131072
v_add_u32 v16, s73, v24
v_xor_b32 v17, 64, v16
v_subrev_u32 v18, 0x10000, v16
v_subrev_u32 v19, 0x10000, v17
s_lshr_b32 s73, s58, 1
s_lshl_b32 s74, s73, 14
s_add_u32 s74, s74, 0x10000
v_add_u32 v24, s74, v24
v_xor_b32 v25, 64, v24
v_lshrrev_b32 v8, 2, v29
v_and_b32 v9, 1, v32
v_lshl_add_u32 v9, v9, 2, v8
v_lshl_add_u32 v8, v32, 3, v8
v_lshlrev_b32 v8, 8, v8
v_lshl_add_u32 v8, v9, 5, v8
v_and_b32 v29, 3, v0
v_lshl_add_u32 v8, v29, 3, v8
s_and_b32 s74, s58, 1
s_lshl_b32 s75, s74, 7
v_xor_b32 v20, s75, v8
v_xor_b32 v9, 32, v8
v_xor_b32 v10, 64, v8
v_xor_b32 v11, 96, v8
v_xor_b32 v12, 128, v8
v_xor_b32 v13, 160, v8
v_xor_b32 v14, 192, v8
v_xor_b32 v15, 224, v8
v_xor_b32 v21, 32, v20
v_xor_b32 v22, 64, v20
v_xor_b32 v23, 96, v20
s_lshl_b32 s77, s59, 20
s_add_u32 s81, s77, s64
s_sub_u32 s81, s81, 0x4000
s_lshl_b32 s75, s60, 17
s_add_u32 s77, s77, s75
s_lshl_b32 s73, s73, 16
s_add_u32 s77, s77, s73
s_lshl_b32 s75, s74, 12
s_add_u32 s78, s77, s75
s_add_u32 s78, s78, 0x4000
s_lshl_b32 s75, s74, 11
s_add_u32 s77, s77, s75
s_mov_b32 s79, 0x3e0293ee
s_waitcnt vmcnt(6)
s_barrier
ds_read_b64_tr_b16 v[160:161], v20 offset:0
ds_read_b64_tr_b16 v[162:163], v20 offset:1024
ds_read_b128 v[128:131], v24 offset:0
ds_read_b128 v[132:135], v24 offset:2048
ds_read_b128 v[136:139], v24 offset:4096
ds_read_b128 v[140:143], v24 offset:6144
ds_read_b128 v[144:147], v24 offset:8192
ds_read_b128 v[148:151], v24 offset:10240
ds_read_b128 v[152:155], v24 offset:12288
ds_read_b128 v[156:159], v24 offset:14336
ds_read_b64_tr_b16 v[164:165], v21 offset:0
ds_read_b64_tr_b16 v[166:167], v21 offset:1024
ds_read_b64_tr_b16 v[168:169], v22 offset:0
ds_read_b64_tr_b16 v[170:171], v22 offset:1024
ds_read_b64_tr_b16 v[172:173], v23 offset:0
ds_read_b64_tr_b16 v[174:175], v23 offset:1024
ds_read_b64_tr_b16 v[176:177], v20 offset:16384
ds_read_b64_tr_b16 v[178:179], v20 offset:17408
ds_read_b64_tr_b16 v[180:181], v21 offset:16384
ds_read_b64_tr_b16 v[182:183], v21 offset:17408
ds_read_b64_tr_b16 v[184:185], v22 offset:16384
ds_read_b64_tr_b16 v[186:187], v22 offset:17408
ds_read_b64_tr_b16 v[188:189], v23 offset:16384
ds_read_b64_tr_b16 v[190:191], v23 offset:17408
s_waitcnt lgkmcnt(0)
v_mfma_f32_16x16x32_bf16 a[0:3], v[160:163], v[128:131], 0
s_add_u32 m0, s64, 32768
ds_read_b64_tr_b16 v[224:225], v20 offset:8192
v_mfma_f32_16x16x32_bf16 a[4:7], v[160:163], v[132:135], 0
s_add_u32 s72, s71, 0
buffer_load_dwordx4 v6, s[16:19], s72 offen lds
v_mfma_f32_16x16x32_bf16 a[8:11], v[160:163], v[136:139], 0
s_add_u32 s72, s71, 31744
buffer_load_dwordx4 v6, s[16:19], s72 offen offset:1024 lds
v_mfma_f32_16x16x32_bf16 a[12:15], v[160:163], v[140:143], 0
ds_read_b64_tr_b16 v[226:227], v20 offset:9216
v_mfma_f32_16x16x32_bf16 a[16:19], v[160:163], v[144:147], 0
s_add_u32 s72, s71, 63488
buffer_load_dwordx4 v7, s[16:19], s72 offen offset:2048 lds
v_mfma_f32_16x16x32_bf16 a[20:23], v[160:163], v[148:151], 0
ds_read_b128 v[192:195], v25 offset:0
v_mfma_f32_16x16x32_bf16 a[24:27], v[160:163], v[152:155], 0
s_add_u32 s72, s71, 95232
buffer_load_dwordx4 v7, s[16:19], s72 offen offset:3072 lds
v_mfma_f32_16x16x32_bf16 a[28:31], v[160:163], v[156:159], 0
ds_read_b128 v[196:199], v25 offset:2048
v_mfma_f32_16x16x32_bf16 a[60:63], v[164:167], v[156:159], 0
s_add_u32 m0, s63, 102400
ds_read_b128 v[200:203], v25 offset:4096
v_mfma_f32_16x16x32_bf16 a[56:59], v[164:167], v[152:155], 0
s_add_u32 s72, s69, 32768
buffer_load_dwordx4 v2, s[8:11], s72 offen lds
v_mfma_f32_16x16x32_bf16 a[52:55], v[164:167], v[148:151], 0
s_add_u32 s72, s69, 39936
buffer_load_dwordx4 v3, s[8:11], s72 offen offset:1024 lds
v_mfma_f32_16x16x32_bf16 a[48:51], v[164:167], v[144:147], 0
ds_read_b128 v[204:207], v25 offset:6144
v_mfma_f32_16x16x32_bf16 a[44:47], v[164:167], v[140:143], 0
s_add_u32 s72, s69, 47104
buffer_load_dwordx4 v2, s[8:11], s72 offen offset:2048 lds
v_mfma_f32_16x16x32_bf16 a[40:43], v[164:167], v[136:139], 0
ds_read_b128 v[208:211], v25 offset:8192
v_mfma_f32_16x16x32_bf16 a[36:39], v[164:167], v[132:135], 0
s_add_u32 s72, s69, 54272
buffer_load_dwordx4 v3, s[8:11], s72 offen offset:3072 lds
v_mfma_f32_16x16x32_bf16 a[32:35], v[164:167], v[128:131], 0
ds_read_b128 v[212:215], v25 offset:10240
v_mfma_f32_16x16x32_bf16 a[64:67], v[168:171], v[128:131], 0
s_add_u32 m0, s64, 49152
ds_read_b128 v[216:219], v25 offset:12288
v_mfma_f32_16x16x32_bf16 a[68:71], v[168:171], v[132:135], 0
s_add_u32 s72, s71, 0
buffer_load_dwordx4 v6, s[20:23], s72 offen lds
v_mfma_f32_16x16x32_bf16 a[72:75], v[168:171], v[136:139], 0
s_add_u32 s72, s71, 31744
buffer_load_dwordx4 v6, s[20:23], s72 offen offset:1024 lds
v_mfma_f32_16x16x32_bf16 a[76:79], v[168:171], v[140:143], 0
ds_read_b128 v[220:223], v25 offset:14336
v_mfma_f32_16x16x32_bf16 a[80:83], v[168:171], v[144:147], 0
s_add_u32 s72, s71, 63488
buffer_load_dwordx4 v7, s[20:23], s72 offen offset:2048 lds
v_mfma_f32_16x16x32_bf16 a[84:87], v[168:171], v[148:151], 0
ds_read_b64_tr_b16 v[228:229], v21 offset:8192
v_mfma_f32_16x16x32_bf16 a[88:91], v[168:171], v[152:155], 0
s_add_u32 s72, s71, 95232
buffer_load_dwordx4 v7, s[20:23], s72 offen offset:3072 lds
v_mfma_f32_16x16x32_bf16 a[92:95], v[168:171], v[156:159], 0
s_mov_b32 s80, 0x100000
buffer_load_dword v126, v125, s[16:19], s80 offen
v_mfma_f32_16x16x32_bf16 a[124:127], v[172:175], v[156:159], 0
buffer_load_dword v126, v125, s[20:23], s80 offen
v_mfma_f32_16x16x32_bf16 a[120:123], v[172:175], v[152:155], 0
ds_read_b64_tr_b16 v[230:231], v21 offset:9216
v_mfma_f32_16x16x32_bf16 a[116:119], v[172:175], v[148:151], 0
ds_read_b64_tr_b16 v[232:233], v22 offset:8192
v_mfma_f32_16x16x32_bf16 a[112:115], v[172:175], v[144:147], 0
ds_read_b64_tr_b16 v[234:235], v22 offset:9216
v_mfma_f32_16x16x32_bf16 a[108:111], v[172:175], v[140:143], 0
ds_read_b64_tr_b16 v[236:237], v23 offset:8192
v_mfma_f32_16x16x32_bf16 a[104:107], v[172:175], v[136:139], 0
ds_read_b64_tr_b16 v[238:239], v23 offset:9216
v_mfma_f32_16x16x32_bf16 a[100:103], v[172:175], v[132:135], 0
ds_read_b64_tr_b16 v[240:241], v20 offset:24576
v_mfma_f32_16x16x32_bf16 a[96:99], v[172:175], v[128:131], 0
ds_read_b64_tr_b16 v[242:243], v20 offset:25600
v_mfma_f32_16x16x32_bf16 a[128:131], v[128:131], v[176:179], 0
ds_read_b64_tr_b16 v[244:245], v21 offset:24576
v_mfma_f32_16x16x32_bf16 a[132:135], v[132:135], v[176:179], 0
ds_read_b64_tr_b16 v[246:247], v21 offset:25600
v_mfma_f32_16x16x32_bf16 a[136:139], v[136:139], v[176:179], 0
ds_read_b64_tr_b16 v[248:249], v22 offset:24576
v_mfma_f32_16x16x32_bf16 a[140:143], v[140:143], v[176:179], 0
ds_read_b64_tr_b16 v[250:251], v22 offset:25600
v_mfma_f32_16x16x32_bf16 a[144:147], v[144:147], v[176:179], 0
ds_read_b64_tr_b16 v[252:253], v23 offset:24576
v_mfma_f32_16x16x32_bf16 a[148:151], v[148:151], v[176:179], 0
ds_read_b64_tr_b16 v[254:255], v23 offset:25600
v_mfma_f32_16x16x32_bf16 a[152:155], v[152:155], v[176:179], 0
v_mfma_f32_16x16x32_bf16 a[156:159], v[156:159], v[176:179], 0
v_mfma_f32_16x16x32_bf16 a[188:191], v[156:159], v[180:183], 0
v_mfma_f32_16x16x32_bf16 a[184:187], v[152:155], v[180:183], 0
v_mfma_f32_16x16x32_bf16 a[180:183], v[148:151], v[180:183], 0
v_mfma_f32_16x16x32_bf16 a[176:179], v[144:147], v[180:183], 0
v_mfma_f32_16x16x32_bf16 a[172:175], v[140:143], v[180:183], 0
v_mfma_f32_16x16x32_bf16 a[168:171], v[136:139], v[180:183], 0
v_mfma_f32_16x16x32_bf16 a[164:167], v[132:135], v[180:183], 0
v_mfma_f32_16x16x32_bf16 a[160:163], v[128:131], v[180:183], 0
v_mfma_f32_16x16x32_bf16 a[192:195], v[128:131], v[184:187], 0
v_mfma_f32_16x16x32_bf16 a[196:199], v[132:135], v[184:187], 0
v_mfma_f32_16x16x32_bf16 a[200:203], v[136:139], v[184:187], 0
v_mfma_f32_16x16x32_bf16 a[204:207], v[140:143], v[184:187], 0
v_mfma_f32_16x16x32_bf16 a[208:211], v[144:147], v[184:187], 0
v_mfma_f32_16x16x32_bf16 a[212:215], v[148:151], v[184:187], 0
v_mfma_f32_16x16x32_bf16 a[216:219], v[152:155], v[184:187], 0
v_mfma_f32_16x16x32_bf16 a[220:223], v[156:159], v[184:187], 0
v_mfma_f32_16x16x32_bf16 a[252:255], v[156:159], v[188:191], 0
v_mfma_f32_16x16x32_bf16 a[248:251], v[152:155], v[188:191], 0
v_mfma_f32_16x16x32_bf16 a[244:247], v[148:151], v[188:191], 0
v_mfma_f32_16x16x32_bf16 a[240:243], v[144:147], v[188:191], 0
v_mfma_f32_16x16x32_bf16 a[236:239], v[140:143], v[188:191], 0
v_mfma_f32_16x16x32_bf16 a[232:235], v[136:139], v[188:191], 0
s_nop 3
s_mov_b64 exec, 0
s_cmp_eq_u32 s58, 0
s_cbranch_scc1 Lstub0
s_cmp_eq_u32 s58, 1
s_cbranch_scc1 Lstub1
s_cmp_eq_u32 s58, 2
s_cbranch_scc1 Lstub2
s_branch Lstub3
Lret:
s_mov_b64 exec, -1
s_nop 3
v_mfma_f32_16x16x32_bf16 a[228:231], v[132:135], v[188:191], 0
s_waitcnt vmcnt(2) lgkmcnt(0)
v_mfma_f32_16x16x32_bf16 a[224:227], v[128:131], v[188:191], 0
s_barrier
v_mfma_f32_16x16x32_bf16 a[0:3], v[224:227], v[192:195], a[0:3]
s_and_b32 s73, s65, 1
ds_read_b64_tr_b16 v[160:161], v20 offset:32768
v_mfma_f32_16x16x32_bf16 a[4:7], v[224:227], v[196:199], a[4:7]
s_xor_b32 s73, s73, 2
ds_read_b64_tr_b16 v[162:163], v20 offset:33792
v_mfma_f32_16x16x32_bf16 a[8:11], v[224:227], v[200:203], a[8:11]
s_lshl_b32 s69, s73, 7
ds_read_b128 v[128:131], v24 offset:32768
v_mfma_f32_16x16x32_bf16 a[12:15], v[224:227], v[204:207], a[12:15]
s_add_u32 s69, s69, s84
ds_read_b128 v[132:135], v24 offset:34816
v_mfma_f32_16x16x32_bf16 a[16:19], v[224:227], v[208:211], a[16:19]
s_lshl_b32 s71, s73, 19
ds_read_b128 v[136:139], v24 offset:36864
v_mfma_f32_16x16x32_bf16 a[20:23], v[224:227], v[212:215], a[20:23]
s_add_u32 s71, s71, s66
ds_read_b128 v[140:143], v24 offset:38912
v_mfma_f32_16x16x32_bf16 a[24:27], v[224:227], v[216:219], a[24:27]
s_add_u32 m0, s63, 65536
ds_read_b128 v[144:147], v24 offset:40960
v_mfma_f32_16x16x32_bf16 a[28:31], v[224:227], v[220:223], a[28:31]
s_add_u32 s72, s69, 0
buffer_load_dwordx4 v2, s[8:11], s72 offen lds
v_mfma_f32_16x16x32_bf16 a[60:63], v[228:231], v[220:223], a[60:63]
s_add_u32 s72, s69, 7168
buffer_load_dwordx4 v3, s[8:11], s72 offen offset:1024 lds
v_mfma_f32_16x16x32_bf16 a[56:59], v[228:231], v[216:219], a[56:59]
s_add_u32 s72, s69, 14336
buffer_load_dwordx4 v2, s[8:11], s72 offen offset:2048 lds
v_mfma_f32_16x16x32_bf16 a[52:55], v[228:231], v[212:215], a[52:55]
ds_read_b128 v[148:151], v24 offset:43008
v_mfma_f32_16x16x32_bf16 a[48:51], v[228:231], v[208:211], a[48:51]
ds_read_b128 v[152:155], v24 offset:45056
v_mfma_f32_16x16x32_bf16 a[44:47], v[228:231], v[204:207], a[44:47]
s_add_u32 s72, s69, 21504
buffer_load_dwordx4 v3, s[8:11], s72 offen offset:3072 lds
v_mfma_f32_16x16x32_bf16 a[40:43], v[228:231], v[200:203], a[40:43]
ds_read_b128 v[156:159], v24 offset:47104
v_mfma_f32_16x16x32_bf16 a[36:39], v[228:231], v[196:199], a[36:39]
ds_read_b64_tr_b16 v[164:165], v21 offset:32768
v_mfma_f32_16x16x32_bf16 a[32:35], v[228:231], v[192:195], a[32:35]
ds_read_b64_tr_b16 v[166:167], v21 offset:33792
v_mfma_f32_16x16x32_bf16 a[64:67], v[232:235], v[192:195], a[64:67]
ds_read_b64_tr_b16 v[168:169], v22 offset:32768
v_mfma_f32_16x16x32_bf16 a[68:71], v[232:235], v[196:199], a[68:71]
s_add_u32 m0, s64, 0
ds_read_b64_tr_b16 v[170:171], v22 offset:33792
v_mfma_f32_16x16x32_bf16 a[72:75], v[232:235], v[200:203], a[72:75]
s_add_u32 s72, s71, 0
buffer_load_dwordx4 v6, s[16:19], s72 offen lds
v_mfma_f32_16x16x32_bf16 a[76:79], v[232:235], v[204:207], a[76:79]
ds_read_b64_tr_b16 v[172:173], v23 offset:32768
v_mfma_f32_16x16x32_bf16 a[80:83], v[232:235], v[208:211], a[80:83]
ds_read_b64_tr_b16 v[174:175], v23 offset:33792
v_mfma_f32_16x16x32_bf16 a[84:87], v[232:235], v[212:215], a[84:87]
s_add_u32 s72, s71, 31744
buffer_load_dwordx4 v6, s[16:19], s72 offen offset:1024 lds
v_mfma_f32_16x16x32_bf16 a[88:91], v[232:235], v[216:219], a[88:91]
ds_read_b64_tr_b16 v[176:177], v20 offset:49152
v_mfma_f32_16x16x32_bf16 a[92:95], v[232:235], v[220:223], a[92:95]
ds_read_b64_tr_b16 v[178:179], v20 offset:50176
v_mfma_f32_16x16x32_bf16 a[124:127], v[236:239], v[220:223], a[124:127]
ds_read_b64_tr_b16 v[180:181], v21 offset:49152
v_mfma_f32_16x16x32_bf16 a[120:123], v[236:239], v[216:219], a[120:123]
s_add_u32 s72, s71, 63488
buffer_load_dwordx4 v7, s[16:19], s72 offen offset:2048 lds
v_mfma_f32_16x16x32_bf16 a[116:119], v[236:239], v[212:215], a[116:119]
ds_read_b64_tr_b16 v[182:183], v21 offset:50176
v_mfma_f32_16x16x32_bf16 a[112:115], v[236:239], v[208:211], a[112:115]
ds_read_b64_tr_b16 v[184:185], v22 offset:49152
v_mfma_f32_16x16x32_bf16 a[108:111], v[236:239], v[204:207], a[108:111]
ds_read_b64_tr_b16 v[186:187], v22 offset:50176
v_mfma_f32_16x16x32_bf16 a[104:107], v[236:239], v[200:203], a[104:107]
ds_read_b64_tr_b16 v[188:189], v23 offset:49152
v_mfma_f32_16x16x32_bf16 a[100:103], v[236:239], v[196:199], a[100:103]
s_add_u32 s72, s71, 95232
buffer_load_dwordx4 v7, s[16:19], s72 offen offset:3072 lds
v_mfma_f32_16x16x32_bf16 a[96:99], v[236:239], v[192:195], a[96:99]
ds_read_b64_tr_b16 v[190:191], v23 offset:50176
v_mfma_f32_16x16x32_bf16 a[128:131], v[192:195], v[240:243], a[128:131]
v_mfma_f32_16x16x32_bf16 a[132:135], v[196:199], v[240:243], a[132:135]
v_mfma_f32_16x16x32_bf16 a[136:139], v[200:203], v[240:243], a[136:139]
s_add_u32 m0, s63, 69632
v_mfma_f32_16x16x32_bf16 a[140:143], v[204:207], v[240:243], a[140:143]
s_add_u32 s72, s69, 32768
buffer_load_dwordx4 v2, s[8:11], s72 offen lds
v_mfma_f32_16x16x32_bf16 a[144:147], v[208:211], v[240:243], a[144:147]
v_mfma_f32_16x16x32_bf16 a[148:151], v[212:215], v[240:243], a[148:151]
v_mfma_f32_16x16x32_bf16 a[152:155], v[216:219], v[240:243], a[152:155]
s_add_u32 s72, s69, 39936
buffer_load_dwordx4 v3, s[8:11], s72 offen offset:1024 lds
v_mfma_f32_16x16x32_bf16 a[156:159], v[220:223], v[240:243], a[156:159]
v_mfma_f32_16x16x32_bf16 a[188:191], v[220:223], v[244:247], a[188:191]
v_mfma_f32_16x16x32_bf16 a[184:187], v[216:219], v[244:247], a[184:187]
v_mfma_f32_16x16x32_bf16 a[180:183], v[212:215], v[244:247], a[180:183]
v_mfma_f32_16x16x32_bf16 a[176:179], v[208:211], v[244:247], a[176:179]
s_add_u32 s72, s69, 47104
buffer_load_dwordx4 v2, s[8:11], s72 offen offset:2048 lds
v_mfma_f32_16x16x32_bf16 a[172:175], v[204:207], v[244:247], a[172:175]
v_mfma_f32_16x16x32_bf16 a[168:171], v[200:203], v[244:247], a[168:171]
v_mfma_f32_16x16x32_bf16 a[164:167], v[196:199], v[244:247], a[164:167]
v_mfma_f32_16x16x32_bf16 a[160:163], v[192:195], v[244:247], a[160:163]
s_add_u32 s72, s69, 54272
buffer_load_dwordx4 v3, s[8:11], s72 offen offset:3072 lds
v_mfma_f32_16x16x32_bf16 a[192:195], v[192:195], v[248:251], a[192:195]
v_mfma_f32_16x16x32_bf16 a[196:199], v[196:199], v[248:251], a[196:199]
v_mfma_f32_16x16x32_bf16 a[200:203], v[200:203], v[248:251], a[200:203]
v_mfma_f32_16x16x32_bf16 a[204:207], v[204:207], v[248:251], a[204:207]
s_add_u32 m0, s64, 16384
v_mfma_f32_16x16x32_bf16 a[208:211], v[208:211], v[248:251], a[208:211]
s_add_u32 s72, s71, 0
buffer_load_dwordx4 v6, s[20:23], s72 offen lds
v_mfma_f32_16x16x32_bf16 a[212:215], v[212:215], v[248:251], a[212:215]
v_mfma_f32_16x16x32_bf16 a[216:219], v[216:219], v[248:251], a[216:219]
v_mfma_f32_16x16x32_bf16 a[220:223], v[220:223], v[248:251], a[220:223]
v_mfma_f32_16x16x32_bf16 a[252:255], v[220:223], v[252:255], a[252:255]
s_add_u32 s72, s71, 31744
buffer_load_dwordx4 v6, s[20:23], s72 offen offset:1024 lds
v_mfma_f32_16x16x32_bf16 a[248:251], v[216:219], v[252:255], a[248:251]
v_mfma_f32_16x16x32_bf16 a[244:247], v[212:215], v[252:255], a[244:247]
v_mfma_f32_16x16x32_bf16 a[240:243], v[208:211], v[252:255], a[240:243]
v_mfma_f32_16x16x32_bf16 a[236:239], v[204:207], v[252:255], a[236:239]
s_add_u32 s72, s71, 63488
buffer_load_dwordx4 v7, s[20:23], s72 offen offset:2048 lds
v_mfma_f32_16x16x32_bf16 a[232:235], v[200:203], v[252:255], a[232:235]
v_mfma_f32_16x16x32_bf16 a[228:231], v[196:199], v[252:255], a[228:231]
v_mfma_f32_16x16x32_bf16 a[224:227], v[192:195], v[252:255], a[224:227]
s_waitcnt lgkmcnt(0)
v_mfma_f32_16x16x32_bf16 a[0:3], v[160:163], v[128:131], a[0:3]
s_add_u32 s72, s71, 95232
buffer_load_dwordx4 v7, s[20:23], s72 offen offset:3072 lds
v_mfma_f32_16x16x32_bf16 a[4:7], v[160:163], v[132:135], a[4:7]
s_mov_b32 s80, 0x200000
buffer_load_dword v126, v125, s[16:19], s80 offen
v_mfma_f32_16x16x32_bf16 a[8:11], v[160:163], v[136:139], a[8:11]
buffer_load_dword v126, v125, s[20:23], s80 offen
v_mfma_f32_16x16x32_bf16 a[12:15], v[160:163], v[140:143], a[12:15]
global_load_dwordx4 v[68:71], v30, s[52:53]
v_mfma_f32_16x16x32_bf16 a[16:19], v[160:163], v[144:147], a[16:19]
buffer_load_dword v33, v27, s[28:31], 0 offen nt
v_mfma_f32_16x16x32_bf16 a[20:23], v[160:163], v[148:151], a[20:23]
buffer_load_dword v34, v27, s[28:31], 0 offen offset:2048 nt
v_mfma_f32_16x16x32_bf16 a[24:27], v[160:163], v[152:155], a[24:27]
ds_read_b64_tr_b16 v[224:225], v20 offset:40960
v_add_u32 v27, 0x1000, v27
v_mfma_f32_16x16x32_bf16 a[28:31], v[160:163], v[156:159], a[28:31]
buffer_load_dword v35, v27, s[28:31], 0 offen nt
v_mfma_f32_16x16x32_bf16 a[60:63], v[164:167], v[156:159], a[60:63]
s_add_u32 m0, s63, 131072
ds_read_b64_tr_b16 v[226:227], v20 offset:41984
v_mfma_f32_16x16x32_bf16 a[56:59], v[164:167], v[152:155], a[56:59]
s_add_u32 s80, s82, 0
buffer_load_dwordx4 v26, s[28:31], s80 offen nt lds
v_mfma_f32_16x16x32_bf16 a[52:55], v[164:167], v[148:151], a[52:55]
s_add_u32 s80, s82, 15360
buffer_load_dwordx4 v26, s[28:31], s80 offen offset:1024 nt lds
v_mfma_f32_16x16x32_bf16 a[48:51], v[164:167], v[144:147], a[48:51]
s_add_u32 s80, s82, 30720
buffer_load_dwordx4 v26, s[28:31], s80 offen offset:2048 nt lds
v_mfma_f32_16x16x32_bf16 a[44:47], v[164:167], v[140:143], a[44:47]
s_add_u32 s80, s82, 46080
buffer_load_dwordx4 v26, s[28:31], s80 offen offset:3072 nt lds
v_mfma_f32_16x16x32_bf16 a[40:43], v[164:167], v[136:139], a[40:43]
ds_read_b128 v[192:195], v25 offset:32768
v_mfma_f32_16x16x32_bf16 a[36:39], v[164:167], v[132:135], a[36:39]
ds_read_b128 v[196:199], v25 offset:34816
v_mfma_f32_16x16x32_bf16 a[32:35], v[164:167], v[128:131], a[32:35]
ds_read_b128 v[200:203], v25 offset:36864
v_mfma_f32_16x16x32_bf16 a[64:67], v[168:171], v[128:131], a[64:67]
ds_read_b128 v[204:207], v25 offset:38912
v_mfma_f32_16x16x32_bf16 a[68:71], v[168:171], v[132:135], a[68:71]
ds_read_b128 v[208:211], v25 offset:40960
v_mfma_f32_16x16x32_bf16 a[72:75], v[168:171], v[136:139], a[72:75]
ds_read_b128 v[212:215], v25 offset:43008
v_mfma_f32_16x16x32_bf16 a[76:79], v[168:171], v[140:143], a[76:79]
ds_read_b128 v[216:219], v25 offset:45056
v_mfma_f32_16x16x32_bf16 a[80:83], v[168:171], v[144:147], a[80:83]
ds_read_b128 v[220:223], v25 offset:47104
v_mfma_f32_16x16x32_bf16 a[84:87], v[168:171], v[148:151], a[84:87]
ds_read_b64_tr_b16 v[228:229], v21 offset:40960
v_mfma_f32_16x16x32_bf16 a[88:91], v[168:171], v[152:155], a[88:91]
ds_read_b64_tr_b16 v[230:231], v21 offset:41984
v_mfma_f32_16x16x32_bf16 a[92:95], v[168:171], v[156:159], a[92:95]
ds_read_b64_tr_b16 v[232:233], v22 offset:40960
v_mfma_f32_16x16x32_bf16 a[124:127], v[172:175], v[156:159], a[124:127]
ds_read_b64_tr_b16 v[234:235], v22 offset:41984
v_mfma_f32_16x16x32_bf16 a[120:123], v[172:175], v[152:155], a[120:123]
ds_read_b64_tr_b16 v[236:237], v23 offset:40960
v_mfma_f32_16x16x32_bf16 a[116:119], v[172:175], v[148:151], a[116:119]
ds_read_b64_tr_b16 v[238:239], v23 offset:41984
v_mfma_f32_16x16x32_bf16 a[112:115], v[172:175], v[144:147], a[112:115]
ds_read_b64_tr_b16 v[240:241], v20 offset:57344
v_mfma_f32_16x16x32_bf16 a[108:111], v[172:175], v[140:143], a[108:111]
ds_read_b64_tr_b16 v[242:243], v20 offset:58368
v_mfma_f32_16x16x32_bf16 a[104:107], v[172:175], v[136:139], a[104:107]
ds_read_b64_tr_b16 v[244:245], v21 offset:57344
v_mfma_f32_16x16x32_bf16 a[100:103], v[172:175], v[132:135], a[100:103]
ds_read_b64_tr_b16 v[246:247], v21 offset:58368
v_mfma_f32_16x16x32_bf16 a[96:99], v[172:175], v[128:131], a[96:99]
ds_read_b64_tr_b16 v[248:249], v22 offset:57344
v_mfma_f32_16x16x32_bf16 a[128:131], v[128:131], v[176:179], a[128:131]
ds_read_b64_tr_b16 v[250:251], v22 offset:58368
v_mfma_f32_16x16x32_bf16 a[132:135], v[132:135], v[176:179], a[132:135]
ds_read_b64_tr_b16 v[252:253], v23 offset:57344
v_mfma_f32_16x16x32_bf16 a[136:139], v[136:139], v[176:179], a[136:139]
ds_read_b64_tr_b16 v[254:255], v23 offset:58368
v_mfma_f32_16x16x32_bf16 a[140:143], v[140:143], v[176:179], a[140:143]
v_mfma_f32_16x16x32_bf16 a[144:147], v[144:147], v[176:179], a[144:147]
v_mfma_f32_16x16x32_bf16 a[148:151], v[148:151], v[176:179], a[148:151]
v_mfma_f32_16x16x32_bf16 a[152:155], v[152:155], v[176:179], a[152:155]
v_mfma_f32_16x16x32_bf16 a[156:159], v[156:159], v[176:179], a[156:159]
v_mfma_f32_16x16x32_bf16 a[188:191], v[156:159], v[180:183], a[188:191]
v_mfma_f32_16x16x32_bf16 a[184:187], v[152:155], v[180:183], a[184:187]
v_mfma_f32_16x16x32_bf16 a[180:183], v[148:151], v[180:183], a[180:183]
v_mfma_f32_16x16x32_bf16 a[176:179], v[144:147], v[180:183], a[176:179]
v_mfma_f32_16x16x32_bf16 a[172:175], v[140:143], v[180:183], a[172:175]
v_mfma_f32_16x16x32_bf16 a[168:171], v[136:139], v[180:183], a[168:171]
v_mfma_f32_16x16x32_bf16 a[164:167], v[132:135], v[180:183], a[164:167]
v_mfma_f32_16x16x32_bf16 a[160:163], v[128:131], v[180:183], a[160:163]
v_mfma_f32_16x16x32_bf16 a[192:195], v[128:131], v[184:187], a[192:195]
v_mfma_f32_16x16x32_bf16 a[196:199], v[132:135], v[184:187], a[196:199]
v_mfma_f32_16x16x32_bf16 a[200:203], v[136:139], v[184:187], a[200:203]
v_mfma_f32_16x16x32_bf16 a[204:207], v[140:143], v[184:187], a[204:207]
v_mfma_f32_16x16x32_bf16 a[208:211], v[144:147], v[184:187], a[208:211]
v_mfma_f32_16x16x32_bf16 a[212:215], v[148:151], v[184:187], a[212:215]
v_mfma_f32_16x16x32_bf16 a[216:219], v[152:155], v[184:187], a[216:219]
v_mfma_f32_16x16x32_bf16 a[220:223], v[156:159], v[184:187], a[220:223]
v_mfma_f32_16x16x32_bf16 a[252:255], v[156:159], v[188:191], a[252:255]
v_mfma_f32_16x16x32_bf16 a[248:251], v[152:155], v[188:191], a[248:251]
v_mfma_f32_16x16x32_bf16 a[244:247], v[148:151], v[188:191], a[244:247]
v_mfma_f32_16x16x32_bf16 a[240:243], v[144:147], v[188:191], a[240:243]
v_mfma_f32_16x16x32_bf16 a[236:239], v[140:143], v[188:191], a[236:239]
v_mfma_f32_16x16x32_bf16 a[232:235], v[136:139], v[188:191], a[232:235]
v_mfma_f32_16x16x32_bf16 a[228:231], v[132:135], v[188:191], a[228:231]
s_waitcnt vmcnt(10) lgkmcnt(0)
v_mfma_f32_16x16x32_bf16 a[224:227], v[128:131], v[188:191], a[224:227]
s_barrier
v_mfma_f32_16x16x32_bf16 a[0:3], v[224:227], v[192:195], a[0:3]
s_and_b32 s73, s65, 1
ds_read_b64_tr_b16 v[160:161], v20 offset:0
v_mfma_f32_16x16x32_bf16 a[4:7], v[224:227], v[196:199], a[4:7]
s_xor_b32 s73, s73, 3
ds_read_b64_tr_b16 v[162:163], v20 offset:1024
v_mfma_f32_16x16x32_bf16 a[8:11], v[224:227], v[200:203], a[8:11]
s_lshl_b32 s69, s73, 7
ds_read_b128 v[128:131], v24 offset:0
v_mfma_f32_16x16x32_bf16 a[12:15], v[224:227], v[204:207], a[12:15]
s_add_u32 s69, s69, s84
ds_read_b128 v[132:135], v24 offset:2048
v_mfma_f32_16x16x32_bf16 a[16:19], v[224:227], v[208:211], a[16:19]
s_lshl_b32 s71, s73, 19
ds_read_b128 v[136:139], v24 offset:4096
v_mfma_f32_16x16x32_bf16 a[20:23], v[224:227], v[212:215], a[20:23]
s_add_u32 s71, s71, s66
ds_read_b128 v[140:143], v24 offset:6144
v_mfma_f32_16x16x32_bf16 a[24:27], v[224:227], v[216:219], a[24:27]
s_add_u32 m0, s63, 98304
ds_read_b128 v[144:147], v24 offset:8192
v_mfma_f32_16x16x32_bf16 a[28:31], v[224:227], v[220:223], a[28:31]
s_add_u32 s72, s69, 0
buffer_load_dwordx4 v2, s[8:11], s72 offen lds
v_mfma_f32_16x16x32_bf16 a[60:63], v[228:231], v[220:223], a[60:63]
s_add_u32 s72, s69, 7168
buffer_load_dwordx4 v3, s[8:11], s72 offen offset:1024 lds
v_mfma_f32_16x16x32_bf16 a[56:59], v[228:231], v[216:219], a[56:59]
s_add_u32 s72, s69, 14336
buffer_load_dwordx4 v2, s[8:11], s72 offen offset:2048 lds
v_mfma_f32_16x16x32_bf16 a[52:55], v[228:231], v[212:215], a[52:55]
ds_read_b128 v[148:151], v24 offset:10240
v_mfma_f32_16x16x32_bf16 a[48:51], v[228:231], v[208:211], a[48:51]
ds_read_b128 v[152:155], v24 offset:12288
v_mfma_f32_16x16x32_bf16 a[44:47], v[228:231], v[204:207], a[44:47]
s_add_u32 s72, s69, 21504
buffer_load_dwordx4 v3, s[8:11], s72 offen offset:3072 lds
v_mfma_f32_16x16x32_bf16 a[40:43], v[228:231], v[200:203], a[40:43]
ds_read_b128 v[156:159], v24 offset:14336
v_mfma_f32_16x16x32_bf16 a[36:39], v[228:231], v[196:199], a[36:39]
ds_read_b64_tr_b16 v[164:165], v21 offset:0
v_mfma_f32_16x16x32_bf16 a[32:35], v[228:231], v[192:195], a[32:35]
ds_read_b64_tr_b16 v[166:167], v21 offset:1024
v_mfma_f32_16x16x32_bf16 a[64:67], v[232:235], v[192:195], a[64:67]
ds_read_b64_tr_b16 v[168:169], v22 offset:0
v_mfma_f32_16x16x32_bf16 a[68:71], v[232:235], v[196:199], a[68:71]
s_add_u32 m0, s64, 32768
ds_read_b64_tr_b16 v[170:171], v22 offset:1024
v_mfma_f32_16x16x32_bf16 a[72:75], v[232:235], v[200:203], a[72:75]
s_add_u32 s72, s71, 0
buffer_load_dwordx4 v6, s[16:19], s72 offen lds
v_mfma_f32_16x16x32_bf16 a[76:79], v[232:235], v[204:207], a[76:79]
ds_read_b64_tr_b16 v[172:173], v23 offset:0
v_mfma_f32_16x16x32_bf16 a[80:83], v[232:235], v[208:211], a[80:83]
ds_read_b64_tr_b16 v[174:175], v23 offset:1024
v_mfma_f32_16x16x32_bf16 a[84:87], v[232:235], v[212:215], a[84:87]
s_add_u32 s72, s71, 31744
buffer_load_dwordx4 v6, s[16:19], s72 offen offset:1024 lds
v_mfma_f32_16x16x32_bf16 a[88:91], v[232:235], v[216:219], a[88:91]
ds_read_b64_tr_b16 v[176:177], v20 offset:16384
v_mfma_f32_16x16x32_bf16 a[92:95], v[232:235], v[220:223], a[92:95]
ds_read_b64_tr_b16 v[178:179], v20 offset:17408
v_mfma_f32_16x16x32_bf16 a[124:127], v[236:239], v[220:223], a[124:127]
ds_read_b64_tr_b16 v[180:181], v21 offset:16384
v_mfma_f32_16x16x32_bf16 a[120:123], v[236:239], v[216:219], a[120:123]
s_add_u32 s72, s71, 63488
buffer_load_dwordx4 v7, s[16:19], s72 offen offset:2048 lds
v_mfma_f32_16x16x32_bf16 a[116:119], v[236:239], v[212:215], a[116:119]
ds_read_b64_tr_b16 v[182:183], v21 offset:17408
v_mfma_f32_16x16x32_bf16 a[112:115], v[236:239], v[208:211], a[112:115]
ds_read_b64_tr_b16 v[184:185], v22 offset:16384
v_mfma_f32_16x16x32_bf16 a[108:111], v[236:239], v[204:207], a[108:111]
ds_read_b64_tr_b16 v[186:187], v22 offset:17408
v_mfma_f32_16x16x32_bf16 a[104:107], v[236:239], v[200:203], a[104:107]
ds_read_b64_tr_b16 v[188:189], v23 offset:16384
v_mfma_f32_16x16x32_bf16 a[100:103], v[236:239], v[196:199], a[100:103]
s_add_u32 s72, s71, 95232
buffer_load_dwordx4 v7, s[16:19], s72 offen offset:3072 lds
v_mfma_f32_16x16x32_bf16 a[96:99], v[236:239], v[192:195], a[96:99]
ds_read_b64_tr_b16 v[190:191], v23 offset:17408
v_mfma_f32_16x16x32_bf16 a[128:131], v[192:195], v[240:243], a[128:131]
v_mfma_f32_16x16x32_bf16 a[132:135], v[196:199], v[240:243], a[132:135]
v_mfma_f32_16x16x32_bf16 a[136:139], v[200:203], v[240:243], a[136:139]
s_add_u32 m0, s63, 102400
v_mfma_f32_16x16x32_bf16 a[140:143], v[204:207], v[240:243], a[140:143]
s_add_u32 s72, s69, 32768
buffer_load_dwordx4 v2, s[8:11], s72 offen lds
v_mfma_f32_16x16x32_bf16 a[144:147], v[208:211], v[240:243], a[144:147]
v_mfma_f32_16x16x32_bf16 a[148:151], v[212:215], v[240:243], a[148:151]
v_mfma_f32_16x16x32_bf16 a[152:155], v[216:219], v[240:243], a[152:155]
s_add_u32 s72, s69, 39936
buffer_load_dwordx4 v3, s[8:11], s72 offen offset:1024 lds
v_mfma_f32_16x16x32_bf16 a[156:159], v[220:223], v[240:243], a[156:159]
v_mfma_f32_16x16x32_bf16 a[188:191], v[220:223], v[244:247], a[188:191]
v_mfma_f32_16x16x32_bf16 a[184:187], v[216:219], v[244:247], a[184:187]
v_mfma_f32_16x16x32_bf16 a[180:183], v[212:215], v[244:247], a[180:183]
v_mfma_f32_16x16x32_bf16 a[176:179], v[208:211], v[244:247], a[176:179]
s_add_u32 s72, s69, 47104
buffer_load_dwordx4 v2, s[8:11], s72 offen offset:2048 lds
v_mfma_f32_16x16x32_bf16 a[172:175], v[204:207], v[244:247], a[172:175]
v_mfma_f32_16x16x32_bf16 a[168:171], v[200:203], v[244:247], a[168:171]
v_mfma_f32_16x16x32_bf16 a[164:167], v[196:199], v[244:247], a[164:167]
v_mfma_f32_16x16x32_bf16 a[160:163], v[192:195], v[244:247], a[160:163]
s_add_u32 s72, s69, 54272
buffer_load_dwordx4 v3, s[8:11], s72 offen offset:3072 lds
v_mfma_f32_16x16x32_bf16 a[192:195], v[192:195], v[248:251], a[192:195]
v_mfma_f32_16x16x32_bf16 a[196:199], v[196:199], v[248:251], a[196:199]
v_mfma_f32_16x16x32_bf16 a[200:203], v[200:203], v[248:251], a[200:203]
v_mfma_f32_16x16x32_bf16 a[204:207], v[204:207], v[248:251], a[204:207]
s_add_u32 m0, s64, 49152
v_mfma_f32_16x16x32_bf16 a[208:211], v[208:211], v[248:251], a[208:211]
s_add_u32 s72, s71, 0
buffer_load_dwordx4 v6, s[20:23], s72 offen lds
v_mfma_f32_16x16x32_bf16 a[212:215], v[212:215], v[248:251], a[212:215]
v_mfma_f32_16x16x32_bf16 a[216:219], v[216:219], v[248:251], a[216:219]
v_mfma_f32_16x16x32_bf16 a[220:223], v[220:223], v[248:251], a[220:223]
v_mfma_f32_16x16x32_bf16 a[252:255], v[220:223], v[252:255], a[252:255]
s_add_u32 s72, s71, 31744
buffer_load_dwordx4 v6, s[20:23], s72 offen offset:1024 lds
v_mfma_f32_16x16x32_bf16 a[248:251], v[216:219], v[252:255], a[248:251]
v_mfma_f32_16x16x32_bf16 a[244:247], v[212:215], v[252:255], a[244:247]
v_mfma_f32_16x16x32_bf16 a[240:243], v[208:211], v[252:255], a[240:243]
v_mfma_f32_16x16x32_bf16 a[236:239], v[204:207], v[252:255], a[236:239]
s_add_u32 s72, s71, 63488
buffer_load_dwordx4 v7, s[20:23], s72 offen offset:2048 lds
v_mfma_f32_16x16x32_bf16 a[232:235], v[200:203], v[252:255], a[232:235]
v_mfma_f32_16x16x32_bf16 a[228:231], v[196:199], v[252:255], a[228:231]
v_mfma_f32_16x16x32_bf16 a[224:227], v[192:195], v[252:255], a[224:227]
s_waitcnt lgkmcnt(0)
v_mfma_f32_16x16x32_bf16 a[0:3], v[160:163], v[128:131], a[0:3]
s_add_u32 s72, s71, 95232
buffer_load_dwordx4 v7, s[20:23], s72 offen offset:3072 lds
v_mfma_f32_16x16x32_bf16 a[4:7], v[160:163], v[132:135], a[4:7]
s_mov_b32 s80, 0x300000
buffer_load_dword v126, v125, s[16:19], s80 offen
v_mfma_f32_16x16x32_bf16 a[8:11], v[160:163], v[136:139], a[8:11]
buffer_load_dword v126, v125, s[20:23], s80 offen
v_mfma_f32_16x16x32_bf16 a[12:15], v[160:163], v[140:143], a[12:15]
s_add_u32 m0, s63, 135168
ds_read_b64_tr_b16 v[224:225], v20 offset:8192
v_mfma_f32_16x16x32_bf16 a[16:19], v[160:163], v[144:147], a[16:19]
s_add_u32 s80, s82, 0
buffer_load_dwordx4 v26, s[32:35], s80 offen nt lds
v_mfma_f32_16x16x32_bf16 a[20:23], v[160:163], v[148:151], a[20:23]
s_add_u32 s80, s82, 15360
buffer_load_dwordx4 v26, s[32:35], s80 offen offset:1024 nt lds
v_mfma_f32_16x16x32_bf16 a[24:27], v[160:163], v[152:155], a[24:27]
s_add_u32 s80, s82, 30720
buffer_load_dwordx4 v26, s[32:35], s80 offen offset:2048 nt lds
v_mfma_f32_16x16x32_bf16 a[28:31], v[160:163], v[156:159], a[28:31]
s_add_u32 s80, s82, 46080
buffer_load_dwordx4 v26, s[32:35], s80 offen offset:3072 nt lds
v_mfma_f32_16x16x32_bf16 a[60:63], v[164:167], v[156:159], a[60:63]
ds_read_b64_tr_b16 v[226:227], v20 offset:9216
v_mfma_f32_16x16x32_bf16 a[56:59], v[164:167], v[152:155], a[56:59]
ds_read_b128 v[192:195], v25 offset:0
v_mfma_f32_16x16x32_bf16 a[52:55], v[164:167], v[148:151], a[52:55]
ds_read_b128 v[196:199], v25 offset:2048
v_mfma_f32_16x16x32_bf16 a[48:51], v[164:167], v[144:147], a[48:51]
ds_read_b128 v[200:203], v25 offset:4096
v_mfma_f32_16x16x32_bf16 a[44:47], v[164:167], v[140:143], a[44:47]
ds_read_b128 v[204:207], v25 offset:6144
v_mfma_f32_16x16x32_bf16 a[40:43], v[164:167], v[136:139], a[40:43]
ds_read_b128 v[208:211], v25 offset:8192
v_mfma_f32_16x16x32_bf16 a[36:39], v[164:167], v[132:135], a[36:39]
ds_read_b128 v[212:215], v25 offset:10240
v_mfma_f32_16x16x32_bf16 a[32:35], v[164:167], v[128:131], a[32:35]
ds_read_b128 v[216:219], v25 offset:12288
v_mfma_f32_16x16x32_bf16 a[64:67], v[168:171], v[128:131], a[64:67]
ds_read_b128 v[220:223], v25 offset:14336
v_mfma_f32_16x16x32_bf16 a[68:71], v[168:171], v[132:135], a[68:71]
ds_read_b64_tr_b16 v[228:229], v21 offset:8192
v_mfma_f32_16x16x32_bf16 a[72:75], v[168:171], v[136:139], a[72:75]
ds_read_b64_tr_b16 v[230:231], v21 offset:9216
v_mfma_f32_16x16x32_bf16 a[76:79], v[168:171], v[140:143], a[76:79]
ds_read_b64_tr_b16 v[232:233], v22 offset:8192
v_mfma_f32_16x16x32_bf16 a[80:83], v[168:171], v[144:147], a[80:83]
ds_read_b64_tr_b16 v[234:235], v22 offset:9216
v_mfma_f32_16x16x32_bf16 a[84:87], v[168:171], v[148:151], a[84:87]
ds_read_b64_tr_b16 v[236:237], v23 offset:8192
v_mfma_f32_16x16x32_bf16 a[88:91], v[168:171], v[152:155], a[88:91]
ds_read_b64_tr_b16 v[238:239], v23 offset:9216
v_mfma_f32_16x16x32_bf16 a[92:95], v[168:171], v[156:159], a[92:95]
ds_read_b64_tr_b16 v[240:241], v20 offset:24576
v_mfma_f32_16x16x32_bf16 a[124:127], v[172:175], v[156:159], a[124:127]
ds_read_b64_tr_b16 v[242:243], v20 offset:25600
v_mfma_f32_16x16x32_bf16 a[120:123], v[172:175], v[152:155], a[120:123]
ds_read_b64_tr_b16 v[244:245], v21 offset:24576
v_mfma_f32_16x16x32_bf16 a[116:119], v[172:175], v[148:151], a[116:119]
ds_read_b64_tr_b16 v[246:247], v21 offset:25600
v_mfma_f32_16x16x32_bf16 a[112:115], v[172:175], v[144:147], a[112:115]
ds_read_b64_tr_b16 v[248:249], v22 offset:24576
v_mfma_f32_16x16x32_bf16 a[108:111], v[172:175], v[140:143], a[108:111]
ds_read_b64_tr_b16 v[250:251], v22 offset:25600
v_mfma_f32_16x16x32_bf16 a[104:107], v[172:175], v[136:139], a[104:107]
ds_read_b64_tr_b16 v[252:253], v23 offset:24576
v_mfma_f32_16x16x32_bf16 a[100:103], v[172:175], v[132:135], a[100:103]
ds_read_b64_tr_b16 v[254:255], v23 offset:25600
v_mfma_f32_16x16x32_bf16 a[96:99], v[172:175], v[128:131], a[96:99]
v_mfma_f32_16x16x32_bf16 a[128:131], v[128:131], v[176:179], a[128:131]
v_mfma_f32_16x16x32_bf16 a[132:135], v[132:135], v[176:179], a[132:135]
v_mfma_f32_16x16x32_bf16 a[136:139], v[136:139], v[176:179], a[136:139]
v_mfma_f32_16x16x32_bf16 a[140:143], v[140:143], v[176:179], a[140:143]
v_mfma_f32_16x16x32_bf16 a[144:147], v[144:147], v[176:179], a[144:147]
v_mfma_f32_16x16x32_bf16 a[148:151], v[148:151], v[176:179], a[148:151]
v_mfma_f32_16x16x32_bf16 a[152:155], v[152:155], v[176:179], a[152:155]
v_mfma_f32_16x16x32_bf16 a[156:159], v[156:159], v[176:179], a[156:159]
v_mfma_f32_16x16x32_bf16 a[188:191], v[156:159], v[180:183], a[188:191]
v_mfma_f32_16x16x32_bf16 a[184:187], v[152:155], v[180:183], a[184:187]
v_mfma_f32_16x16x32_bf16 a[180:183], v[148:151], v[180:183], a[180:183]
v_mfma_f32_16x16x32_bf16 a[176:179], v[144:147], v[180:183], a[176:179]
v_mfma_f32_16x16x32_bf16 a[172:175], v[140:143], v[180:183], a[172:175]
v_mfma_f32_16x16x32_bf16 a[168:171], v[136:139], v[180:183], a[168:171]
v_mfma_f32_16x16x32_bf16 a[164:167], v[132:135], v[180:183], a[164:167]
v_mfma_f32_16x16x32_bf16 a[160:163], v[128:131], v[180:183], a[160:163]
v_mfma_f32_16x16x32_bf16 a[192:195], v[128:131], v[184:187], a[192:195]
v_mfma_f32_16x16x32_bf16 a[196:199], v[132:135], v[184:187], a[196:199]
v_mfma_f32_16x16x32_bf16 a[200:203], v[136:139], v[184:187], a[200:203]
v_mfma_f32_16x16x32_bf16 a[204:207], v[140:143], v[184:187], a[204:207]
v_mfma_f32_16x16x32_bf16 a[208:211], v[144:147], v[184:187], a[208:211]
v_mfma_f32_16x16x32_bf16 a[212:215], v[148:151], v[184:187], a[212:215]
v_mfma_f32_16x16x32_bf16 a[216:219], v[152:155], v[184:187], a[216:219]
v_mfma_f32_16x16x32_bf16 a[220:223], v[156:159], v[184:187], a[220:223]
v_mfma_f32_16x16x32_bf16 a[252:255], v[156:159], v[188:191], a[252:255]
v_mfma_f32_16x16x32_bf16 a[248:251], v[152:155], v[188:191], a[248:251]
v_mfma_f32_16x16x32_bf16 a[244:247], v[148:151], v[188:191], a[244:247]
v_mfma_f32_16x16x32_bf16 a[240:243], v[144:147], v[188:191], a[240:243]
v_mfma_f32_16x16x32_bf16 a[236:239], v[140:143], v[188:191], a[236:239]
v_mfma_f32_16x16x32_bf16 a[232:235], v[136:139], v[188:191], a[232:235]
v_mfma_f32_16x16x32_bf16 a[228:231], v[132:135], v[188:191], a[228:231]
s_waitcnt vmcnt(6) lgkmcnt(0)
v_mfma_f32_16x16x32_bf16 a[224:227], v[128:131], v[188:191], a[224:227]
s_barrier
v_mfma_f32_16x16x32_bf16 a[0:3], v[224:227], v[192:195], a[0:3]
s_and_b32 s73, s65, 1
ds_read_b64_tr_b16 v[160:161], v20 offset:32768
v_mfma_f32_16x16x32_bf16 a[4:7], v[224:227], v[196:199], a[4:7]
s_xor_b32 s73, s73, 4
ds_read_b64_tr_b16 v[162:163], v20 offset:33792
v_mfma_f32_16x16x32_bf16 a[8:11], v[224:227], v[200:203], a[8:11]
s_lshl_b32 s69, s73, 7
ds_read_b128 v[128:131], v24 offset:32768
v_mfma_f32_16x16x32_bf16 a[12:15], v[224:227], v[204:207], a[12:15]
s_add_u32 s69, s69, s84
ds_read_b128 v[132:135], v24 offset:34816
v_mfma_f32_16x16x32_bf16 a[16:19], v[224:227], v[208:211], a[16:19]
s_lshl_b32 s71, s73, 19
ds_read_b128 v[136:139], v24 offset:36864
v_mfma_f32_16x16x32_bf16 a[20:23], v[224:227], v[212:215], a[20:23]
s_add_u32 s71, s71, s66
ds_read_b128 v[140:143], v24 offset:38912
v_mfma_f32_16x16x32_bf16 a[24:27], v[224:227], v[216:219], a[24:27]
s_add_u32 m0, s63, 65536
ds_read_b128 v[144:147], v24 offset:40960
v_mfma_f32_16x16x32_bf16 a[28:31], v[224:227], v[220:223], a[28:31]
s_add_u32 s72, s69, 0
buffer_load_dwordx4 v2, s[8:11], s72 offen lds
v_mfma_f32_16x16x32_bf16 a[60:63], v[228:231], v[220:223], a[60:63]
s_add_u32 s72, s69, 7168
buffer_load_dwordx4 v3, s[8:11], s72 offen offset:1024 lds
v_mfma_f32_16x16x32_bf16 a[56:59], v[228:231], v[216:219], a[56:59]
s_add_u32 s72, s69, 14336
buffer_load_dwordx4 v2, s[8:11], s72 offen offset:2048 lds
v_mfma_f32_16x16x32_bf16 a[52:55], v[228:231], v[212:215], a[52:55]
ds_read_b128 v[148:151], v24 offset:43008
v_mfma_f32_16x16x32_bf16 a[48:51], v[228:231], v[208:211], a[48:51]
ds_read_b128 v[152:155], v24 offset:45056
v_mfma_f32_16x16x32_bf16 a[44:47], v[228:231], v[204:207], a[44:47]
s_add_u32 s72, s69, 21504
buffer_load_dwordx4 v3, s[8:11], s72 offen offset:3072 lds
v_mfma_f32_16x16x32_bf16 a[40:43], v[228:231], v[200:203], a[40:43]
ds_read_b128 v[156:159], v24 offset:47104
v_mfma_f32_16x16x32_bf16 a[36:39], v[228:231], v[196:199], a[36:39]
ds_read_b64_tr_b16 v[164:165], v21 offset:32768
v_mfma_f32_16x16x32_bf16 a[32:35], v[228:231], v[192:195], a[32:35]
ds_read_b64_tr_b16 v[166:167], v21 offset:33792
v_mfma_f32_16x16x32_bf16 a[64:67], v[232:235], v[192:195], a[64:67]
ds_read_b64_tr_b16 v[168:169], v22 offset:32768
v_mfma_f32_16x16x32_bf16 a[68:71], v[232:235], v[196:199], a[68:71]
s_add_u32 m0, s64, 0
ds_read_b64_tr_b16 v[170:171], v22 offset:33792
v_mfma_f32_16x16x32_bf16 a[72:75], v[232:235], v[200:203], a[72:75]
s_add_u32 s72, s71, 0
buffer_load_dwordx4 v6, s[16:19], s72 offen lds
v_mfma_f32_16x16x32_bf16 a[76:79], v[232:235], v[204:207], a[76:79]
ds_read_b64_tr_b16 v[172:173], v23 offset:32768
v_mfma_f32_16x16x32_bf16 a[80:83], v[232:235], v[208:211], a[80:83]
ds_read_b64_tr_b16 v[174:175], v23 offset:33792
v_mfma_f32_16x16x32_bf16 a[84:87], v[232:235], v[212:215], a[84:87]
s_add_u32 s72, s71, 31744
buffer_load_dwordx4 v6, s[16:19], s72 offen offset:1024 lds
v_mfma_f32_16x16x32_bf16 a[88:91], v[232:235], v[216:219], a[88:91]
ds_read_b64_tr_b16 v[176:177], v20 offset:49152
v_mfma_f32_16x16x32_bf16 a[92:95], v[232:235], v[220:223], a[92:95]
ds_read_b64_tr_b16 v[178:179], v20 offset:50176
v_mfma_f32_16x16x32_bf16 a[124:127], v[236:239], v[220:223], a[124:127]
ds_read_b64_tr_b16 v[180:181], v21 offset:49152
v_mfma_f32_16x16x32_bf16 a[120:123], v[236:239], v[216:219], a[120:123]
s_add_u32 s72, s71, 63488
buffer_load_dwordx4 v7, s[16:19], s72 offen offset:2048 lds
v_mfma_f32_16x16x32_bf16 a[116:119], v[236:239], v[212:215], a[116:119]
ds_read_b64_tr_b16 v[182:183], v21 offset:50176
v_mfma_f32_16x16x32_bf16 a[112:115], v[236:239], v[208:211], a[112:115]
ds_read_b64_tr_b16 v[184:185], v22 offset:49152
v_mfma_f32_16x16x32_bf16 a[108:111], v[236:239], v[204:207], a[108:111]
ds_read_b64_tr_b16 v[186:187], v22 offset:50176
v_mfma_f32_16x16x32_bf16 a[104:107], v[236:239], v[200:203], a[104:107]
ds_read_b64_tr_b16 v[188:189], v23 offset:49152
v_mfma_f32_16x16x32_bf16 a[100:103], v[236:239], v[196:199], a[100:103]
s_add_u32 s72, s71, 95232
buffer_load_dwordx4 v7, s[16:19], s72 offen offset:3072 lds
v_mfma_f32_16x16x32_bf16 a[96:99], v[236:239], v[192:195], a[96:99]
ds_read_b64_tr_b16 v[190:191], v23 offset:50176
v_mfma_f32_16x16x32_bf16 a[128:131], v[192:195], v[240:243], a[128:131]
v_mfma_f32_16x16x32_bf16 a[132:135], v[196:199], v[240:243], a[132:135]
v_mfma_f32_16x16x32_bf16 a[136:139], v[200:203], v[240:243], a[136:139]
s_add_u32 m0, s63, 69632
v_mfma_f32_16x16x32_bf16 a[140:143], v[204:207], v[240:243], a[140:143]
s_add_u32 s72, s69, 32768
buffer_load_dwordx4 v2, s[8:11], s72 offen lds
v_mfma_f32_16x16x32_bf16 a[144:147], v[208:211], v[240:243], a[144:147]
v_mfma_f32_16x16x32_bf16 a[148:151], v[212:215], v[240:243], a[148:151]
v_mfma_f32_16x16x32_bf16 a[152:155], v[216:219], v[240:243], a[152:155]
s_add_u32 s72, s69, 39936
buffer_load_dwordx4 v3, s[8:11], s72 offen offset:1024 lds
v_mfma_f32_16x16x32_bf16 a[156:159], v[220:223], v[240:243], a[156:159]
v_mfma_f32_16x16x32_bf16 a[188:191], v[220:223], v[244:247], a[188:191]
v_mfma_f32_16x16x32_bf16 a[184:187], v[216:219], v[244:247], a[184:187]
v_mfma_f32_16x16x32_bf16 a[180:183], v[212:215], v[244:247], a[180:183]
v_mfma_f32_16x16x32_bf16 a[176:179], v[208:211], v[244:247], a[176:179]
s_add_u32 s72, s69, 47104
buffer_load_dwordx4 v2, s[8:11], s72 offen offset:2048 lds
v_mfma_f32_16x16x32_bf16 a[172:175], v[204:207], v[244:247], a[172:175]
v_mfma_f32_16x16x32_bf16 a[168:171], v[200:203], v[244:247], a[168:171]
v_mfma_f32_16x16x32_bf16 a[164:167], v[196:199], v[244:247], a[164:167]
v_mfma_f32_16x16x32_bf16 a[160:163], v[192:195], v[244:247], a[160:163]
s_add_u32 s72, s69, 54272
buffer_load_dwordx4 v3, s[8:11], s72 offen offset:3072 lds
v_mfma_f32_16x16x32_bf16 a[192:195], v[192:195], v[248:251], a[192:195]
v_mfma_f32_16x16x32_bf16 a[196:199], v[196:199], v[248:251], a[196:199]
v_mfma_f32_16x16x32_bf16 a[200:203], v[200:203], v[248:251], a[200:203]
v_mfma_f32_16x16x32_bf16 a[204:207], v[204:207], v[248:251], a[204:207]
s_add_u32 m0, s64, 16384
v_mfma_f32_16x16x32_bf16 a[208:211], v[208:211], v[248:251], a[208:211]
s_add_u32 s72, s71, 0
buffer_load_dwordx4 v6, s[20:23], s72 offen lds
v_mfma_f32_16x16x32_bf16 a[212:215], v[212:215], v[248:251], a[212:215]
v_mfma_f32_16x16x32_bf16 a[216:219], v[216:219], v[248:251], a[216:219]
v_mfma_f32_16x16x32_bf16 a[220:223], v[220:223], v[248:251], a[220:223]
v_mfma_f32_16x16x32_bf16 a[252:255], v[220:223], v[252:255], a[252:255]
s_add_u32 s72, s71, 31744
buffer_load_dwordx4 v6, s[20:23], s72 offen offset:1024 lds
v_mfma_f32_16x16x32_bf16 a[248:251], v[216:219], v[252:255], a[248:251]
v_mfma_f32_16x16x32_bf16 a[244:247], v[212:215], v[252:255], a[244:247]
v_mfma_f32_16x16x32_bf16 a[240:243], v[208:211], v[252:255], a[240:243]
v_mfma_f32_16x16x32_bf16 a[236:239], v[204:207], v[252:255], a[236:239]
s_add_u32 s72, s71, 63488
buffer_load_dwordx4 v7, s[20:23], s72 offen offset:2048 lds
v_mfma_f32_16x16x32_bf16 a[232:235], v[200:203], v[252:255], a[232:235]
v_mfma_f32_16x16x32_bf16 a[228:231], v[196:199], v[252:255], a[228:231]
v_mfma_f32_16x16x32_bf16 a[224:227], v[192:195], v[252:255], a[224:227]
s_waitcnt lgkmcnt(0)
v_mfma_f32_16x16x32_bf16 a[0:3], v[160:163], v[128:131], a[0:3]
s_add_u32 s72, s71, 95232
buffer_load_dwordx4 v7, s[20:23], s72 offen offset:3072 lds
v_mfma_f32_16x16x32_bf16 a[4:7], v[160:163], v[132:135], a[4:7]
buffer_load_dwordx4 v[108:111], v1, s[4:7], s76 offen
v_mfma_f32_16x16x32_bf16 a[8:11], v[160:163], v[136:139], a[8:11]
buffer_load_dwordx4 v[112:115], v1, s[4:7], s76 offen offset:1024
v_mfma_f32_16x16x32_bf16 a[12:15], v[160:163], v[140:143], a[12:15]
buffer_load_dwordx4 v[116:119], v1, s[4:7], s76 offen offset:2048
v_mfma_f32_16x16x32_bf16 a[16:19], v[160:163], v[144:147], a[16:19]
buffer_load_dwordx4 v[120:123], v1, s[4:7], s76 offen offset:3072
v_mfma_f32_16x16x32_bf16 a[20:23], v[160:163], v[148:151], a[20:23]
ds_read_b64_tr_b16 v[224:225], v20 offset:40960
v_mfma_f32_16x16x32_bf16 a[24:27], v[160:163], v[152:155], a[24:27]
v_mfma_f32_16x16x32_bf16 a[28:31], v[160:163], v[156:159], a[28:31]
ds_read_b64_tr_b16 v[226:227], v20 offset:41984
v_mfma_f32_16x16x32_bf16 a[60:63], v[164:167], v[156:159], a[60:63]
v_mfma_f32_16x16x32_bf16 a[56:59], v[164:167], v[152:155], a[56:59]
ds_read_b128 v[192:195], v25 offset:32768
v_mfma_f32_16x16x32_bf16 a[52:55], v[164:167], v[148:151], a[52:55]
v_mfma_f32_16x16x32_bf16 a[48:51], v[164:167], v[144:147], a[48:51]
ds_read_b128 v[196:199], v25 offset:34816
v_mfma_f32_16x16x32_bf16 a[44:47], v[164:167], v[140:143], a[44:47]
v_mfma_f32_16x16x32_bf16 a[40:43], v[164:167], v[136:139], a[40:43]
ds_read_b128 v[200:203], v25 offset:36864
v_mfma_f32_16x16x32_bf16 a[36:39], v[164:167], v[132:135], a[36:39]
v_mfma_f32_16x16x32_bf16 a[32:35], v[164:167], v[128:131], a[32:35]
ds_read_b128 v[204:207], v25 offset:38912
v_mfma_f32_16x16x32_bf16 a[64:67], v[168:171], v[128:131], a[64:67]
v_mfma_f32_16x16x32_bf16 a[68:71], v[168:171], v[132:135], a[68:71]
ds_read_b128 v[208:211], v25 offset:40960
v_mfma_f32_16x16x32_bf16 a[72:75], v[168:171], v[136:139], a[72:75]
v_mfma_f32_16x16x32_bf16 a[76:79], v[168:171], v[140:143], a[76:79]
ds_read_b128 v[212:215], v25 offset:43008
v_mfma_f32_16x16x32_bf16 a[80:83], v[168:171], v[144:147], a[80:83]
s_waitcnt vmcnt(20)
ds_read2_b32 v[36:37], v98 offset0:0 offset1:32
ds_read2_b32 v[38:39], v98 offset0:64 offset1:96
v_mfma_f32_16x16x32_bf16 a[84:87], v[168:171], v[148:151], a[84:87]
ds_read_b128 v[216:219], v25 offset:45056
ds_read2_b32 v[40:41], v98 offset0:128 offset1:160
v_mfma_f32_16x16x32_bf16 a[88:91], v[168:171], v[152:155], a[88:91]
ds_read2_b32 v[42:43], v98 offset0:192 offset1:224
v_add_u32 v98, 1024, v98
v_mfma_f32_16x16x32_bf16 a[92:95], v[168:171], v[156:159], a[92:95]
ds_read_b128 v[220:223], v25 offset:47104
ds_read2_b32 v[44:45], v98 offset0:0 offset1:32
v_mfma_f32_16x16x32_bf16 a[124:127], v[172:175], v[156:159], a[124:127]
ds_read2_b32 v[46:47], v98 offset0:64 offset1:96
ds_read2_b32 v[48:49], v98 offset0:128 offset1:160
v_mfma_f32_16x16x32_bf16 a[120:123], v[172:175], v[152:155], a[120:123]
ds_read_b64_tr_b16 v[228:229], v21 offset:40960
ds_read2_b32 v[50:51], v98 offset0:192 offset1:224
v_mfma_f32_16x16x32_bf16 a[116:119], v[172:175], v[148:151], a[116:119]
v_add_u32 v98, 3072, v98
v_mfma_f32_16x16x32_bf16 a[112:115], v[172:175], v[144:147], a[112:115]
ds_read_b64_tr_b16 v[230:231], v21 offset:41984
ds_read2_b32 v[52:53], v98 offset0:0 offset1:32
v_mfma_f32_16x16x32_bf16 a[108:111], v[172:175], v[140:143], a[108:111]
ds_read2_b32 v[54:55], v98 offset0:64 offset1:96
ds_read2_b32 v[56:57], v98 offset0:128 offset1:160
v_mfma_f32_16x16x32_bf16 a[104:107], v[172:175], v[136:139], a[104:107]
ds_read_b64_tr_b16 v[232:233], v22 offset:40960
ds_read2_b32 v[58:59], v98 offset0:192 offset1:224
v_mfma_f32_16x16x32_bf16 a[100:103], v[172:175], v[132:135], a[100:103]
v_add_u32 v98, 1024, v98
v_mfma_f32_16x16x32_bf16 a[96:99], v[172:175], v[128:131], a[96:99]
ds_read_b64_tr_b16 v[234:235], v22 offset:41984
ds_read2_b32 v[60:61], v98 offset0:0 offset1:32
v_mfma_f32_16x16x32_bf16 a[128:131], v[128:131], v[176:179], a[128:131]
ds_read2_b32 v[62:63], v98 offset0:64 offset1:96
ds_read2_b32 v[64:65], v98 offset0:128 offset1:160
v_mfma_f32_16x16x32_bf16 a[132:135], v[132:135], v[176:179], a[132:135]
ds_read_b64_tr_b16 v[236:237], v23 offset:40960
ds_read2_b32 v[66:67], v98 offset0:192 offset1:224
v_mfma_f32_16x16x32_bf16 a[136:139], v[136:139], v[176:179], a[136:139]
v_mfma_f32_16x16x32_bf16 a[140:143], v[140:143], v[176:179], a[140:143]
ds_read_b64_tr_b16 v[238:239], v23 offset:41984
v_mfma_f32_16x16x32_bf16 a[144:147], v[144:147], v[176:179], a[144:147]
v_mfma_f32_16x16x32_bf16 a[148:151], v[148:151], v[176:179], a[148:151]
ds_read_b64_tr_b16 v[240:241], v20 offset:57344
v_mfma_f32_16x16x32_bf16 a[152:155], v[152:155], v[176:179], a[152:155]
v_mfma_f32_16x16x32_bf16 a[156:159], v[156:159], v[176:179], a[156:159]
ds_read_b64_tr_b16 v[242:243], v20 offset:58368
v_mfma_f32_16x16x32_bf16 a[188:191], v[156:159], v[180:183], a[188:191]
v_mfma_f32_16x16x32_bf16 a[184:187], v[152:155], v[180:183], a[184:187]
ds_read_b64_tr_b16 v[244:245], v21 offset:57344
v_mfma_f32_16x16x32_bf16 a[180:183], v[148:151], v[180:183], a[180:183]
v_mfma_f32_16x16x32_bf16 a[176:179], v[144:147], v[180:183], a[176:179]
ds_read_b64_tr_b16 v[246:247], v21 offset:58368
v_mfma_f32_16x16x32_bf16 a[172:175], v[140:143], v[180:183], a[172:175]
v_mfma_f32_16x16x32_bf16 a[168:171], v[136:139], v[180:183], a[168:171]
ds_read_b64_tr_b16 v[248:249], v22 offset:57344
v_mfma_f32_16x16x32_bf16 a[164:167], v[132:135], v[180:183], a[164:167]
v_mfma_f32_16x16x32_bf16 a[160:163], v[128:131], v[180:183], a[160:163]
ds_read_b64_tr_b16 v[250:251], v22 offset:58368
v_mfma_f32_16x16x32_bf16 a[192:195], v[128:131], v[184:187], a[192:195]
v_mfma_f32_16x16x32_bf16 a[196:199], v[132:135], v[184:187], a[196:199]
ds_read_b64_tr_b16 v[252:253], v23 offset:57344
v_mfma_f32_16x16x32_bf16 a[200:203], v[136:139], v[184:187], a[200:203]
v_mfma_f32_16x16x32_bf16 a[204:207], v[140:143], v[184:187], a[204:207]
ds_read_b64_tr_b16 v[254:255], v23 offset:58368
v_mfma_f32_16x16x32_bf16 a[208:211], v[144:147], v[184:187], a[208:211]
v_mfma_f32_16x16x32_bf16 a[212:215], v[148:151], v[184:187], a[212:215]
v_mfma_f32_16x16x32_bf16 a[216:219], v[152:155], v[184:187], a[216:219]
v_mfma_f32_16x16x32_bf16 a[220:223], v[156:159], v[184:187], a[220:223]
v_mfma_f32_16x16x32_bf16 a[252:255], v[156:159], v[188:191], a[252:255]
v_mfma_f32_16x16x32_bf16 a[248:251], v[152:155], v[188:191], a[248:251]
v_mfma_f32_16x16x32_bf16 a[244:247], v[148:151], v[188:191], a[244:247]
v_mfma_f32_16x16x32_bf16 a[240:243], v[144:147], v[188:191], a[240:243]
v_mfma_f32_16x16x32_bf16 a[236:239], v[140:143], v[188:191], a[236:239]
v_mfma_f32_16x16x32_bf16 a[232:235], v[136:139], v[188:191], a[232:235]
v_mfma_f32_16x16x32_bf16 a[228:231], v[132:135], v[188:191], a[228:231]
s_waitcnt vmcnt(4) lgkmcnt(0)
v_mfma_f32_16x16x32_bf16 a[224:227], v[128:131], v[188:191], a[224:227]
s_barrier
v_mfma_f32_16x16x32_bf16 a[0:3], v[224:227], v[192:195], a[0:3]
s_and_b32 s73, s65, 1
ds_read_b64_tr_b16 v[160:161], v20 offset:0
v_lshlrev_b32 v72, 16, v68
v_mfma_f32_16x16x32_bf16 a[4:7], v[224:227], v[196:199], a[4:7]
s_xor_b32 s73, s73, 5
ds_read_b64_tr_b16 v[162:163], v20 offset:1024
v_and_b32 v73, 0xffff0000, v68
v_mfma_f32_16x16x32_bf16 a[8:11], v[224:227], v[200:203], a[8:11]
s_lshl_b32 s69, s73, 7
ds_read_b128 v[128:131], v24 offset:0
v_lshlrev_b32 v74, 16, v69
v_mfma_f32_16x16x32_bf16 a[12:15], v[224:227], v[204:207], a[12:15]
s_add_u32 s69, s69, s84
ds_read_b128 v[132:135], v24 offset:2048
v_and_b32 v75, 0xffff0000, v69
v_mfma_f32_16x16x32_bf16 a[16:19], v[224:227], v[208:211], a[16:19]
s_lshl_b32 s71, s73, 19
ds_read_b128 v[136:139], v24 offset:4096
v_lshlrev_b32 v76, 16, v33
v_mfma_f32_16x16x32_bf16 a[20:23], v[224:227], v[212:215], a[20:23]
s_add_u32 s71, s71, s66
ds_read_b128 v[140:143], v24 offset:6144
v_lshlrev_b32 v77, 16, v34
v_mfma_f32_16x16x32_bf16 a[24:27], v[224:227], v[216:219], a[24:27]
s_add_u32 m0, s63, 98304
ds_read_b128 v[144:147], v24 offset:8192
v_lshlrev_b32 v78, 16, v35
v_mfma_f32_16x16x32_bf16 a[28:31], v[224:227], v[220:223], a[28:31]
s_add_u32 s72, s69, 0
buffer_load_dwordx4 v2, s[8:11], s72 offen lds
v_mfma_f32_16x16x32_bf16 a[60:63], v[228:231], v[220:223], a[60:63]
s_add_u32 s72, s69, 7168
buffer_load_dwordx4 v3, s[8:11], s72 offen offset:1024 lds
v_mfma_f32_16x16x32_bf16 a[56:59], v[228:231], v[216:219], a[56:59]
s_add_u32 s72, s69, 14336
buffer_load_dwordx4 v2, s[8:11], s72 offen offset:2048 lds
v_mfma_f32_16x16x32_bf16 a[52:55], v[228:231], v[212:215], a[52:55]
ds_read_b128 v[148:151], v24 offset:10240
v_lshlrev_b32 v79, 16, v36
v_mfma_f32_16x16x32_bf16 a[48:51], v[228:231], v[208:211], a[48:51]
ds_read_b128 v[152:155], v24 offset:12288
v_lshlrev_b32 v80, 16, v37
v_mfma_f32_16x16x32_bf16 a[44:47], v[228:231], v[204:207], a[44:47]
s_add_u32 s72, s69, 21504
buffer_load_dwordx4 v3, s[8:11], s72 offen offset:3072 lds
v_mfma_f32_16x16x32_bf16 a[40:43], v[228:231], v[200:203], a[40:43]
ds_read_b128 v[156:159], v24 offset:14336
v_lshlrev_b32 v81, 16, v38
v_mfma_f32_16x16x32_bf16 a[36:39], v[228:231], v[196:199], a[36:39]
ds_read_b64_tr_b16 v[164:165], v21 offset:0
v_lshlrev_b32 v82, 16, v39
v_mfma_f32_16x16x32_bf16 a[32:35], v[228:231], v[192:195], a[32:35]
ds_read_b64_tr_b16 v[166:167], v21 offset:1024
v_lshlrev_b32 v83, 16, v40
v_mfma_f32_16x16x32_bf16 a[64:67], v[232:235], v[192:195], a[64:67]
ds_read_b64_tr_b16 v[168:169], v22 offset:0
v_lshlrev_b32 v84, 16, v41
v_mfma_f32_16x16x32_bf16 a[68:71], v[232:235], v[196:199], a[68:71]
s_add_u32 m0, s64, 32768
ds_read_b64_tr_b16 v[170:171], v22 offset:1024
v_lshlrev_b32 v85, 16, v42
v_mfma_f32_16x16x32_bf16 a[72:75], v[232:235], v[200:203], a[72:75]
s_add_u32 s72, s71, 0
buffer_load_dwordx4 v6, s[16:19], s72 offen lds
v_mfma_f32_16x16x32_bf16 a[76:79], v[232:235], v[204:207], a[76:79]
ds_read_b64_tr_b16 v[172:173], v23 offset:0
v_lshlrev_b32 v86, 16, v43
v_mfma_f32_16x16x32_bf16 a[80:83], v[232:235], v[208:211], a[80:83]
ds_read_b64_tr_b16 v[174:175], v23 offset:1024
v_lshlrev_b32 v87, 16, v44
v_mfma_f32_16x16x32_bf16 a[84:87], v[232:235], v[212:215], a[84:87]
s_add_u32 s72, s71, 31744
buffer_load_dwordx4 v6, s[16:19], s72 offen offset:1024 lds
v_mfma_f32_16x16x32_bf16 a[88:91], v[232:235], v[216:219], a[88:91]
ds_read_b64_tr_b16 v[176:177], v20 offset:16384
v_lshlrev_b32 v88, 16, v45
v_mfma_f32_16x16x32_bf16 a[92:95], v[232:235], v[220:223], a[92:95]
ds_read_b64_tr_b16 v[178:179], v20 offset:17408
v_lshlrev_b32 v89, 16, v46
v_mfma_f32_16x16x32_bf16 a[124:127], v[236:239], v[220:223], a[124:127]
ds_read_b64_tr_b16 v[180:181], v21 offset:16384
v_lshlrev_b32 v90, 16, v47
v_mfma_f32_16x16x32_bf16 a[120:123], v[236:239], v[216:219], a[120:123]
s_add_u32 s72, s71, 63488
buffer_load_dwordx4 v7, s[16:19], s72 offen offset:2048 lds
v_mfma_f32_16x16x32_bf16 a[116:119], v[236:239], v[212:215], a[116:119]
ds_read_b64_tr_b16 v[182:183], v21 offset:17408
v_lshlrev_b32 v91, 16, v48
v_mfma_f32_16x16x32_bf16 a[112:115], v[236:239], v[208:211], a[112:115]
ds_read_b64_tr_b16 v[184:185], v22 offset:16384
v_lshlrev_b32 v92, 16, v49
v_mfma_f32_16x16x32_bf16 a[108:111], v[236:239], v[204:207], a[108:111]
ds_read_b64_tr_b16 v[186:187], v22 offset:17408
v_lshlrev_b32 v93, 16, v50
v_mfma_f32_16x16x32_bf16 a[104:107], v[236:239], v[200:203], a[104:107]
ds_read_b64_tr_b16 v[188:189], v23 offset:16384
v_lshlrev_b32 v94, 16, v51
v_mfma_f32_16x16x32_bf16 a[100:103], v[236:239], v[196:199], a[100:103]
s_add_u32 s72, s71, 95232
buffer_load_dwordx4 v7, s[16:19], s72 offen offset:3072 lds
v_mfma_f32_16x16x32_bf16 a[96:99], v[236:239], v[192:195], a[96:99]
ds_read_b64_tr_b16 v[190:191], v23 offset:17408
v_mul_f32 v95, v75, v91
v_mfma_f32_16x16x32_bf16 a[128:131], v[192:195], v[240:243], a[128:131]
v_lshlrev_b32 v97, 16, v67
v_fmac_f32 v95, v74, v92
v_mfma_f32_16x16x32_bf16 a[132:135], v[196:199], v[240:243], a[132:135]
v_fmac_f32 v95, v73, v93
v_fmac_f32 v95, v72, v94
v_mfma_f32_16x16x32_bf16 a[136:139], v[200:203], v[240:243], a[136:139]
s_add_u32 m0, s63, 102400
v_mul_f32 v95, v95, v97
v_mul_f32 v96, v75, v90
v_mfma_f32_16x16x32_bf16 a[140:143], v[204:207], v[240:243], a[140:143]
s_add_u32 s72, s69, 32768
buffer_load_dwordx4 v2, s[8:11], s72 offen lds
v_mfma_f32_16x16x32_bf16 a[144:147], v[208:211], v[240:243], a[144:147]
v_lshlrev_b32 v97, 16, v66
v_fmac_f32 v96, v74, v91
v_mfma_f32_16x16x32_bf16 a[148:151], v[212:215], v[240:243], a[148:151]
v_fmac_f32 v96, v73, v92
v_fmac_f32 v96, v72, v93
v_mfma_f32_16x16x32_bf16 a[152:155], v[216:219], v[240:243], a[152:155]
s_add_u32 s72, s69, 39936
buffer_load_dwordx4 v3, s[8:11], s72 offen offset:1024 lds
v_mfma_f32_16x16x32_bf16 a[156:159], v[220:223], v[240:243], a[156:159]
v_mul_f32 v96, v96, v97
v_cvt_pk_bf16_f32 v100, v95, v96
v_mfma_f32_16x16x32_bf16 a[188:191], v[220:223], v[244:247], a[188:191]
v_mul_f32 v95, v75, v89
v_lshlrev_b32 v97, 16, v65
v_mfma_f32_16x16x32_bf16 a[184:187], v[216:219], v[244:247], a[184:187]
v_fmac_f32 v95, v74, v90
v_fmac_f32 v95, v73, v91
v_mfma_f32_16x16x32_bf16 a[180:183], v[212:215], v[244:247], a[180:183]
v_fmac_f32 v95, v72, v92
v_mul_f32 v95, v95, v97
v_mfma_f32_16x16x32_bf16 a[176:179], v[208:211], v[244:247], a[176:179]
s_add_u32 s72, s69, 47104
buffer_load_dwordx4 v2, s[8:11], s72 offen offset:2048 lds
v_mfma_f32_16x16x32_bf16 a[172:175], v[204:207], v[244:247], a[172:175]
v_mul_f32 v96, v75, v88
v_lshlrev_b32 v97, 16, v64
v_mfma_f32_16x16x32_bf16 a[168:171], v[200:203], v[244:247], a[168:171]
v_fmac_f32 v96, v74, v89
v_fmac_f32 v96, v73, v90
v_mfma_f32_16x16x32_bf16 a[164:167], v[196:199], v[244:247], a[164:167]
v_fmac_f32 v96, v72, v91
v_mul_f32 v96, v96, v97
v_mfma_f32_16x16x32_bf16 a[160:163], v[192:195], v[244:247], a[160:163]
s_add_u32 s72, s69, 54272
buffer_load_dwordx4 v3, s[8:11], s72 offen offset:3072 lds
v_mfma_f32_16x16x32_bf16 a[192:195], v[192:195], v[248:251], a[192:195]
v_cvt_pk_bf16_f32 v101, v95, v96
v_mul_f32 v95, v75, v87
v_mfma_f32_16x16x32_bf16 a[196:199], v[196:199], v[248:251], a[196:199]
v_lshlrev_b32 v97, 16, v63
v_fmac_f32 v95, v74, v88
v_mfma_f32_16x16x32_bf16 a[200:203], v[200:203], v[248:251], a[200:203]
v_fmac_f32 v95, v73, v89
v_fmac_f32 v95, v72, v90
v_mfma_f32_16x16x32_bf16 a[204:207], v[204:207], v[248:251], a[204:207]
s_add_u32 m0, s64, 49152
v_mul_f32 v95, v95, v97
v_mul_f32 v96, v75, v86
v_mfma_f32_16x16x32_bf16 a[208:211], v[208:211], v[248:251], a[208:211]
s_add_u32 s72, s71, 0
buffer_load_dwordx4 v6, s[20:23], s72 offen lds
v_mfma_f32_16x16x32_bf16 a[212:215], v[212:215], v[248:251], a[212:215]
v_lshlrev_b32 v97, 16, v62
v_fmac_f32 v96, v74, v87
v_mfma_f32_16x16x32_bf16 a[216:219], v[216:219], v[248:251], a[216:219]
v_fmac_f32 v96, v73, v88
v_fmac_f32 v96, v72, v89
v_mfma_f32_16x16x32_bf16 a[220:223], v[220:223], v[248:251], a[220:223]
v_mul_f32 v96, v96, v97
v_cvt_pk_bf16_f32 v102, v95, v96
v_mfma_f32_16x16x32_bf16 a[252:255], v[220:223], v[252:255], a[252:255]
s_add_u32 s72, s71, 31744
buffer_load_dwordx4 v6, s[20:23], s72 offen offset:1024 lds
v_mfma_f32_16x16x32_bf16 a[248:251], v[216:219], v[252:255], a[248:251]
v_mul_f32 v95, v75, v85
v_lshlrev_b32 v97, 16, v61
v_mfma_f32_16x16x32_bf16 a[244:247], v[212:215], v[252:255], a[244:247]
v_fmac_f32 v95, v74, v86
v_fmac_f32 v95, v73, v87
v_mfma_f32_16x16x32_bf16 a[240:243], v[208:211], v[252:255], a[240:243]
v_fmac_f32 v95, v72, v88
v_mul_f32 v95, v95, v97
v_mfma_f32_16x16x32_bf16 a[236:239], v[204:207], v[252:255], a[236:239]
s_add_u32 s72, s71, 63488
buffer_load_dwordx4 v7, s[20:23], s72 offen offset:2048 lds
v_mfma_f32_16x16x32_bf16 a[232:235], v[200:203], v[252:255], a[232:235]
v_mul_f32 v96, v75, v84
v_lshlrev_b32 v97, 16, v60
v_mfma_f32_16x16x32_bf16 a[228:231], v[196:199], v[252:255], a[228:231]
v_fmac_f32 v96, v74, v85
v_fmac_f32 v96, v73, v86
v_mfma_f32_16x16x32_bf16 a[224:227], v[192:195], v[252:255], a[224:227]
s_waitcnt lgkmcnt(0)
v_fmac_f32 v96, v72, v87
v_mul_f32 v96, v96, v97
v_mfma_f32_16x16x32_bf16 a[0:3], v[160:163], v[128:131], a[0:3]
s_add_u32 s72, s71, 95232
buffer_load_dwordx4 v7, s[20:23], s72 offen offset:3072 lds
v_mfma_f32_16x16x32_bf16 a[4:7], v[160:163], v[132:135], a[4:7]
s_mov_b32 s80, 0x0
buffer_load_dword v126, v125, s[12:15], s80 offen
v_mfma_f32_16x16x32_bf16 a[8:11], v[160:163], v[136:139], a[8:11]
s_mov_b32 s80, 0x100000
buffer_load_dword v126, v125, s[12:15], s80 offen
v_mfma_f32_16x16x32_bf16 a[12:15], v[160:163], v[140:143], a[12:15]
s_mov_b32 s80, 0x200000
buffer_load_dword v126, v125, s[12:15], s80 offen
v_mfma_f32_16x16x32_bf16 a[16:19], v[160:163], v[144:147], a[16:19]
s_mov_b32 s80, 0x300000
buffer_load_dword v126, v125, s[12:15], s80 offen
v_mfma_f32_16x16x32_bf16 a[20:23], v[160:163], v[148:151], a[20:23]
ds_read_b64_tr_b16 v[224:225], v20 offset:8192
v_cvt_pk_bf16_f32 v103, v95, v96
v_mfma_f32_16x16x32_bf16 a[24:27], v[160:163], v[152:155], a[24:27]
ds_write_b128 v28, v[100:103] offset:0
v_mul_f32 v95, v75, v83
v_mfma_f32_16x16x32_bf16 a[28:31], v[160:163], v[156:159], a[28:31]
ds_read_b64_tr_b16 v[226:227], v20 offset:9216
v_lshlrev_b32 v97, 16, v59
v_mfma_f32_16x16x32_bf16 a[60:63], v[164:167], v[156:159], a[60:63]
v_fmac_f32 v95, v74, v84
v_fmac_f32 v95, v73, v85
v_mfma_f32_16x16x32_bf16 a[56:59], v[164:167], v[152:155], a[56:59]
ds_read_b128 v[192:195], v25 offset:0
v_fmac_f32 v95, v72, v86
v_mfma_f32_16x16x32_bf16 a[52:55], v[164:167], v[148:151], a[52:55]
v_mul_f32 v95, v95, v97
v_mul_f32 v96, v75, v82
v_mfma_f32_16x16x32_bf16 a[48:51], v[164:167], v[144:147], a[48:51]
ds_read_b128 v[196:199], v25 offset:2048
v_lshlrev_b32 v97, 16, v58
v_mfma_f32_16x16x32_bf16 a[44:47], v[164:167], v[140:143], a[44:47]
v_fmac_f32 v96, v74, v83
v_fmac_f32 v96, v73, v84
v_mfma_f32_16x16x32_bf16 a[40:43], v[164:167], v[136:139], a[40:43]
ds_read_b128 v[200:203], v25 offset:4096
v_fmac_f32 v96, v72, v85
v_mfma_f32_16x16x32_bf16 a[36:39], v[164:167], v[132:135], a[36:39]
v_mul_f32 v96, v96, v97
v_cvt_pk_bf16_f32 v104, v95, v96
v_mfma_f32_16x16x32_bf16 a[32:35], v[164:167], v[128:131], a[32:35]
ds_read_b128 v[204:207], v25 offset:6144
v_mul_f32 v95, v75, v81
v_mfma_f32_16x16x32_bf16 a[64:67], v[168:171], v[128:131], a[64:67]
v_lshlrev_b32 v97, 16, v57
v_fmac_f32 v95, v74, v82
v_mfma_f32_16x16x32_bf16 a[68:71], v[168:171], v[132:135], a[68:71]
ds_read_b128 v[208:211], v25 offset:8192
v_fmac_f32 v95, v73, v83
v_mfma_f32_16x16x32_bf16 a[72:75], v[168:171], v[136:139], a[72:75]
v_fmac_f32 v95, v72, v84
v_mul_f32 v95, v95, v97
v_mfma_f32_16x16x32_bf16 a[76:79], v[168:171], v[140:143], a[76:79]
ds_read_b128 v[212:215], v25 offset:10240
v_mul_f32 v96, v75, v80
v_mfma_f32_16x16x32_bf16 a[80:83], v[168:171], v[144:147], a[80:83]
v_lshlrev_b32 v97, 16, v56
v_fmac_f32 v96, v74, v81
v_mfma_f32_16x16x32_bf16 a[84:87], v[168:171], v[148:151], a[84:87]
ds_read_b128 v[216:219], v25 offset:12288
v_fmac_f32 v96, v73, v82
v_mfma_f32_16x16x32_bf16 a[88:91], v[168:171], v[152:155], a[88:91]
v_fmac_f32 v96, v72, v83
v_mul_f32 v96, v96, v97
v_mfma_f32_16x16x32_bf16 a[92:95], v[168:171], v[156:159], a[92:95]
ds_read_b128 v[220:223], v25 offset:14336
v_cvt_pk_bf16_f32 v105, v95, v96
v_mfma_f32_16x16x32_bf16 a[124:127], v[172:175], v[156:159], a[124:127]
v_mul_f32 v95, v75, v79
v_lshlrev_b32 v97, 16, v55
v_mfma_f32_16x16x32_bf16 a[120:123], v[172:175], v[152:155], a[120:123]
ds_read_b64_tr_b16 v[228:229], v21 offset:8192
v_fmac_f32 v95, v74, v80
v_mfma_f32_16x16x32_bf16 a[116:119], v[172:175], v[148:151], a[116:119]
v_fmac_f32 v95, v73, v81
v_fmac_f32 v95, v72, v82
v_mfma_f32_16x16x32_bf16 a[112:115], v[172:175], v[144:147], a[112:115]
ds_read_b64_tr_b16 v[230:231], v21 offset:9216
v_mul_f32 v95, v95, v97
v_mfma_f32_16x16x32_bf16 a[108:111], v[172:175], v[140:143], a[108:111]
v_mul_f32 v96, v75, v78
v_lshlrev_b32 v97, 16, v54
v_mfma_f32_16x16x32_bf16 a[104:107], v[172:175], v[136:139], a[104:107]
ds_read_b64_tr_b16 v[232:233], v22 offset:8192
v_fmac_f32 v96, v74, v79
v_mfma_f32_16x16x32_bf16 a[100:103], v[172:175], v[132:135], a[100:103]
v_fmac_f32 v96, v73, v80
v_fmac_f32 v96, v72, v81
v_mfma_f32_16x16x32_bf16 a[96:99], v[172:175], v[128:131], a[96:99]
ds_read_b64_tr_b16 v[234:235], v22 offset:9216
v_mul_f32 v96, v96, v97
v_mfma_f32_16x16x32_bf16 a[128:131], v[128:131], v[176:179], a[128:131]
v_cvt_pk_bf16_f32 v106, v95, v96
v_mul_f32 v95, v75, v77
v_mfma_f32_16x16x32_bf16 a[132:135], v[132:135], v[176:179], a[132:135]
ds_read_b64_tr_b16 v[236:237], v23 offset:8192
v_lshlrev_b32 v97, 16, v53
v_mfma_f32_16x16x32_bf16 a[136:139], v[136:139], v[176:179], a[136:139]
v_fmac_f32 v95, v74, v78
v_fmac_f32 v95, v73, v79
v_mfma_f32_16x16x32_bf16 a[140:143], v[140:143], v[176:179], a[140:143]
ds_read_b64_tr_b16 v[238:239], v23 offset:9216
v_fmac_f32 v95, v72, v80
v_mfma_f32_16x16x32_bf16 a[144:147], v[144:147], v[176:179], a[144:147]
v_mul_f32 v95, v95, v97
v_mul_f32 v96, v75, v76
v_mfma_f32_16x16x32_bf16 a[148:151], v[148:151], v[176:179], a[148:151]
ds_read_b64_tr_b16 v[240:241], v20 offset:24576
v_lshlrev_b32 v97, 16, v52
v_mfma_f32_16x16x32_bf16 a[152:155], v[152:155], v[176:179], a[152:155]
v_fmac_f32 v96, v74, v77
v_fmac_f32 v96, v73, v78
v_mfma_f32_16x16x32_bf16 a[156:159], v[156:159], v[176:179], a[156:159]
ds_read_b64_tr_b16 v[242:243], v20 offset:25600
v_fmac_f32 v96, v72, v79
v_mfma_f32_16x16x32_bf16 a[188:191], v[156:159], v[180:183], a[188:191]
v_mul_f32 v96, v96, v97
v_cvt_pk_bf16_f32 v107, v95, v96
v_mfma_f32_16x16x32_bf16 a[184:187], v[152:155], v[180:183], a[184:187]
ds_read_b64_tr_b16 v[244:245], v21 offset:24576
ds_write_b128 v28, v[104:107] offset:16
v_mfma_f32_16x16x32_bf16 a[180:183], v[148:151], v[180:183], a[180:183]
global_load_dwordx4 v[84:87], v1, s[56:57]
v_mfma_f32_16x16x32_bf16 a[176:179], v[144:147], v[180:183], a[176:179]
ds_read_b64_tr_b16 v[246:247], v21 offset:25600
v_mfma_f32_16x16x32_bf16 a[172:175], v[140:143], v[180:183], a[172:175]
global_load_dwordx4 v[88:91], v1, s[56:57] offset:1024
v_mfma_f32_16x16x32_bf16 a[168:171], v[136:139], v[180:183], a[168:171]
ds_read_b64_tr_b16 v[248:249], v22 offset:24576
v_lshlrev_b32 v72, 16, v70
v_mfma_f32_16x16x32_bf16 a[164:167], v[132:135], v[180:183], a[164:167]
v_and_b32 v73, 0xffff0000, v70
v_lshlrev_b32 v74, 16, v71
v_mfma_f32_16x16x32_bf16 a[160:163], v[128:131], v[180:183], a[160:163]
ds_read_b64_tr_b16 v[250:251], v22 offset:25600
v_and_b32 v75, 0xffff0000, v71
v_mfma_f32_16x16x32_bf16 a[192:195], v[128:131], v[184:187], a[192:195]
v_and_b32 v33, 0xffff0000, v33
v_and_b32 v34, 0xffff0000, v34
v_mfma_f32_16x16x32_bf16 a[196:199], v[132:135], v[184:187], a[196:199]
ds_read_b64_tr_b16 v[252:253], v23 offset:24576
v_and_b32 v35, 0xffff0000, v35
v_mfma_f32_16x16x32_bf16 a[200:203], v[136:139], v[184:187], a[200:203]
v_and_b32 v36, 0xffff0000, v36
v_and_b32 v37, 0xffff0000, v37
v_mfma_f32_16x16x32_bf16 a[204:207], v[140:143], v[184:187], a[204:207]
ds_read_b64_tr_b16 v[254:255], v23 offset:25600
v_and_b32 v38, 0xffff0000, v38
v_mfma_f32_16x16x32_bf16 a[208:211], v[144:147], v[184:187], a[208:211]
v_and_b32 v39, 0xffff0000, v39
v_and_b32 v40, 0xffff0000, v40
v_mfma_f32_16x16x32_bf16 a[212:215], v[148:151], v[184:187], a[212:215]
v_and_b32 v41, 0xffff0000, v41
v_and_b32 v42, 0xffff0000, v42
v_mfma_f32_16x16x32_bf16 a[216:219], v[152:155], v[184:187], a[216:219]
v_and_b32 v43, 0xffff0000, v43
v_and_b32 v44, 0xffff0000, v44
v_mfma_f32_16x16x32_bf16 a[220:223], v[156:159], v[184:187], a[220:223]
v_and_b32 v45, 0xffff0000, v45
v_and_b32 v46, 0xffff0000, v46
v_mfma_f32_16x16x32_bf16 a[252:255], v[156:159], v[188:191], a[252:255]
v_and_b32 v47, 0xffff0000, v47
v_and_b32 v48, 0xffff0000, v48
v_mfma_f32_16x16x32_bf16 a[248:251], v[152:155], v[188:191], a[248:251]
v_and_b32 v49, 0xffff0000, v49
v_and_b32 v50, 0xffff0000, v50
v_mfma_f32_16x16x32_bf16 a[244:247], v[148:151], v[188:191], a[244:247]
v_and_b32 v51, 0xffff0000, v51
v_mul_f32 v95, v75, v48
v_mfma_f32_16x16x32_bf16 a[240:243], v[144:147], v[188:191], a[240:243]
v_and_b32 v97, 0xffff0000, v67
v_fmac_f32 v95, v74, v49
v_mfma_f32_16x16x32_bf16 a[236:239], v[140:143], v[188:191], a[236:239]
v_fmac_f32 v95, v73, v50
v_fmac_f32 v95, v72, v51
v_mfma_f32_16x16x32_bf16 a[232:235], v[136:139], v[188:191], a[232:235]
v_mul_f32 v95, v95, v97
v_mul_f32 v96, v75, v47
v_mfma_f32_16x16x32_bf16 a[228:231], v[132:135], v[188:191], a[228:231]
s_waitcnt vmcnt(6) lgkmcnt(0)
v_and_b32 v97, 0xffff0000, v66
v_fmac_f32 v96, v74, v48
v_mfma_f32_16x16x32_bf16 a[224:227], v[128:131], v[188:191], a[224:227]
s_barrier
v_fmac_f32 v96, v73, v49
v_fmac_f32 v96, v72, v50
v_mfma_f32_16x16x32_bf16 a[0:3], v[224:227], v[192:195], a[0:3]
s_and_b32 s73, s65, 1
ds_read_b64_tr_b16 v[160:161], v20 offset:32768
v_mul_f32 v96, v96, v97
v_mfma_f32_16x16x32_bf16 a[4:7], v[224:227], v[196:199], a[4:7]
s_xor_b32 s73, s73, 6
ds_read_b64_tr_b16 v[162:163], v20 offset:33792
v_cvt_pk_bf16_f32 v100, v95, v96
v_mfma_f32_16x16x32_bf16 a[8:11], v[224:227], v[200:203], a[8:11]
s_lshl_b32 s69, s73, 7
ds_read_b128 v[128:131], v24 offset:32768
v_mul_f32 v95, v75, v46
v_mfma_f32_16x16x32_bf16 a[12:15], v[224:227], v[204:207], a[12:15]
s_add_u32 s69, s69, s84
ds_read_b128 v[132:135], v24 offset:34816
v_and_b32 v97, 0xffff0000, v65
v_mfma_f32_16x16x32_bf16 a[16:19], v[224:227], v[208:211], a[16:19]
s_lshl_b32 s71, s73, 19
ds_read_b128 v[136:139], v24 offset:36864
v_fmac_f32 v95, v74, v47
v_mfma_f32_16x16x32_bf16 a[20:23], v[224:227], v[212:215], a[20:23]
s_add_u32 s71, s71, s66
ds_read_b128 v[140:143], v24 offset:38912
v_fmac_f32 v95, v73, v48
v_mfma_f32_16x16x32_bf16 a[24:27], v[224:227], v[216:219], a[24:27]
s_add_u32 m0, s63, 65536
ds_read_b128 v[144:147], v24 offset:40960
v_fmac_f32 v95, v72, v49
v_mfma_f32_16x16x32_bf16 a[28:31], v[224:227], v[220:223], a[28:31]
s_add_u32 s72, s69, 0
buffer_load_dwordx4 v2, s[8:11], s72 offen lds
v_mfma_f32_16x16x32_bf16 a[60:63], v[228:231], v[220:223], a[60:63]
s_add_u32 s72, s69, 7168
buffer_load_dwordx4 v3, s[8:11], s72 offen offset:1024 lds
v_mfma_f32_16x16x32_bf16 a[56:59], v[228:231], v[216:219], a[56:59]
s_add_u32 s72, s69, 14336
buffer_load_dwordx4 v2, s[8:11], s72 offen offset:2048 lds
v_mfma_f32_16x16x32_bf16 a[52:55], v[228:231], v[212:215], a[52:55]
ds_read_b128 v[148:151], v24 offset:43008
v_mul_f32 v95, v95, v97
v_mfma_f32_16x16x32_bf16 a[48:51], v[228:231], v[208:211], a[48:51]
ds_read_b128 v[152:155], v24 offset:45056
v_mul_f32 v96, v75, v45
v_mfma_f32_16x16x32_bf16 a[44:47], v[228:231], v[204:207], a[44:47]
s_add_u32 s72, s69, 21504
buffer_load_dwordx4 v3, s[8:11], s72 offen offset:3072 lds
v_mfma_f32_16x16x32_bf16 a[40:43], v[228:231], v[200:203], a[40:43]
ds_read_b128 v[156:159], v24 offset:47104
v_and_b32 v97, 0xffff0000, v64
v_mfma_f32_16x16x32_bf16 a[36:39], v[228:231], v[196:199], a[36:39]
ds_read_b64_tr_b16 v[164:165], v21 offset:32768
v_fmac_f32 v96, v74, v46
v_mfma_f32_16x16x32_bf16 a[32:35], v[228:231], v[192:195], a[32:35]
ds_read_b64_tr_b16 v[166:167], v21 offset:33792
v_fmac_f32 v96, v73, v47
v_mfma_f32_16x16x32_bf16 a[64:67], v[232:235], v[192:195], a[64:67]
ds_read_b64_tr_b16 v[168:169], v22 offset:32768
v_fmac_f32 v96, v72, v48
v_mfma_f32_16x16x32_bf16 a[68:71], v[232:235], v[196:199], a[68:71]
s_add_u32 m0, s64, 0
ds_read_b64_tr_b16 v[170:171], v22 offset:33792
v_mul_f32 v96, v96, v97
v_mfma_f32_16x16x32_bf16 a[72:75], v[232:235], v[200:203], a[72:75]
s_add_u32 s72, s71, 0
buffer_load_dwordx4 v6, s[16:19], s72 offen lds
v_mfma_f32_16x16x32_bf16 a[76:79], v[232:235], v[204:207], a[76:79]
ds_read_b64_tr_b16 v[172:173], v23 offset:32768
v_cvt_pk_bf16_f32 v101, v95, v96
v_mfma_f32_16x16x32_bf16 a[80:83], v[232:235], v[208:211], a[80:83]
ds_read_b64_tr_b16 v[174:175], v23 offset:33792
v_mul_f32 v95, v75, v44
v_mfma_f32_16x16x32_bf16 a[84:87], v[232:235], v[212:215], a[84:87]
s_add_u32 s72, s71, 31744
buffer_load_dwordx4 v6, s[16:19], s72 offen offset:1024 lds
v_mfma_f32_16x16x32_bf16 a[88:91], v[232:235], v[216:219], a[88:91]
ds_read_b64_tr_b16 v[176:177], v20 offset:49152
v_and_b32 v97, 0xffff0000, v63
v_mfma_f32_16x16x32_bf16 a[92:95], v[232:235], v[220:223], a[92:95]
ds_read_b64_tr_b16 v[178:179], v20 offset:50176
v_fmac_f32 v95, v74, v45
v_mfma_f32_16x16x32_bf16 a[124:127], v[236:239], v[220:223], a[124:127]
ds_read_b64_tr_b16 v[180:181], v21 offset:49152
v_fmac_f32 v95, v73, v46
v_mfma_f32_16x16x32_bf16 a[120:123], v[236:239], v[216:219], a[120:123]
s_add_u32 s72, s71, 63488
buffer_load_dwordx4 v7, s[16:19], s72 offen offset:2048 lds
v_mfma_f32_16x16x32_bf16 a[116:119], v[236:239], v[212:215], a[116:119]
ds_read_b64_tr_b16 v[182:183], v21 offset:50176
v_fmac_f32 v95, v72, v47
v_mfma_f32_16x16x32_bf16 a[112:115], v[236:239], v[208:211], a[112:115]
ds_read_b64_tr_b16 v[184:185], v22 offset:49152
v_mul_f32 v95, v95, v97
v_mfma_f32_16x16x32_bf16 a[108:111], v[236:239], v[204:207], a[108:111]
ds_read_b64_tr_b16 v[186:187], v22 offset:50176
v_mul_f32 v96, v75, v43
v_mfma_f32_16x16x32_bf16 a[104:107], v[236:239], v[200:203], a[104:107]
ds_read_b64_tr_b16 v[188:189], v23 offset:49152
v_and_b32 v97, 0xffff0000, v62
v_mfma_f32_16x16x32_bf16 a[100:103], v[236:239], v[196:199], a[100:103]
s_add_u32 s72, s71, 95232
buffer_load_dwordx4 v7, s[16:19], s72 offen offset:3072 lds
v_mfma_f32_16x16x32_bf16 a[96:99], v[236:239], v[192:195], a[96:99]
ds_read_b64_tr_b16 v[190:191], v23 offset:50176
v_fmac_f32 v96, v74, v44
v_mfma_f32_16x16x32_bf16 a[128:131], v[192:195], v[240:243], a[128:131]
v_fmac_f32 v96, v73, v45
v_fmac_f32 v96, v72, v46
v_mfma_f32_16x16x32_bf16 a[132:135], v[196:199], v[240:243], a[132:135]
v_mul_f32 v96, v96, v97
v_cvt_pk_bf16_f32 v102, v95, v96
v_mfma_f32_16x16x32_bf16 a[136:139], v[200:203], v[240:243], a[136:139]
s_add_u32 m0, s63, 69632
v_mul_f32 v95, v75, v42
v_and_b32 v97, 0xffff0000, v61
v_mfma_f32_16x16x32_bf16 a[140:143], v[204:207], v[240:243], a[140:143]
s_add_u32 s72, s69, 32768
buffer_load_dwordx4 v2, s[8:11], s72 offen lds
v_mfma_f32_16x16x32_bf16 a[144:147], v[208:211], v[240:243], a[144:147]
v_fmac_f32 v95, v74, v43
v_fmac_f32 v95, v73, v44
v_mfma_f32_16x16x32_bf16 a[148:151], v[212:215], v[240:243], a[148:151]
v_fmac_f32 v95, v72, v45
v_mul_f32 v95, v95, v97
v_mfma_f32_16x16x32_bf16 a[152:155], v[216:219], v[240:243], a[152:155]
s_add_u32 s72, s69, 39936
buffer_load_dwordx4 v3, s[8:11], s72 offen offset:1024 lds
v_mfma_f32_16x16x32_bf16 a[156:159], v[220:223], v[240:243], a[156:159]
v_mul_f32 v96, v75, v41
v_and_b32 v97, 0xffff0000, v60
v_mfma_f32_16x16x32_bf16 a[188:191], v[220:223], v[244:247], a[188:191]
v_fmac_f32 v96, v74, v42
v_fmac_f32 v96, v73, v43
v_mfma_f32_16x16x32_bf16 a[184:187], v[216:219], v[244:247], a[184:187]
v_fmac_f32 v96, v72, v44
v_mul_f32 v96, v96, v97
v_mfma_f32_16x16x32_bf16 a[180:183], v[212:215], v[244:247], a[180:183]
v_cvt_pk_bf16_f32 v103, v95, v96
v_mfma_f32_16x16x32_bf16 a[176:179], v[208:211], v[244:247], a[176:179]
s_add_u32 s72, s69, 47104
buffer_load_dwordx4 v2, s[8:11], s72 offen offset:2048 lds
v_mfma_f32_16x16x32_bf16 a[172:175], v[204:207], v[244:247], a[172:175]
ds_write_b128 v28, v[100:103] offset:272
v_mul_f32 v95, v75, v40
v_mfma_f32_16x16x32_bf16 a[168:171], v[200:203], v[244:247], a[168:171]
v_and_b32 v97, 0xffff0000, v59
v_fmac_f32 v95, v74, v41
v_mfma_f32_16x16x32_bf16 a[164:167], v[196:199], v[244:247], a[164:167]
v_fmac_f32 v95, v73, v42
v_fmac_f32 v95, v72, v43
v_mfma_f32_16x16x32_bf16 a[160:163], v[192:195], v[244:247], a[160:163]
s_add_u32 s72, s69, 54272
buffer_load_dwordx4 v3, s[8:11], s72 offen offset:3072 lds
v_mfma_f32_16x16x32_bf16 a[192:195], v[192:195], v[248:251], a[192:195]
v_mul_f32 v95, v95, v97
v_mul_f32 v96, v75, v39
v_mfma_f32_16x16x32_bf16 a[196:199], v[196:199], v[248:251], a[196:199]
v_and_b32 v97, 0xffff0000, v58
v_fmac_f32 v96, v74, v40
v_mfma_f32_16x16x32_bf16 a[200:203], v[200:203], v[248:251], a[200:203]
v_fmac_f32 v96, v73, v41
v_fmac_f32 v96, v72, v42
v_mfma_f32_16x16x32_bf16 a[204:207], v[204:207], v[248:251], a[204:207]
s_add_u32 m0, s64, 16384
v_mul_f32 v96, v96, v97
v_cvt_pk_bf16_f32 v104, v95, v96
v_mfma_f32_16x16x32_bf16 a[208:211], v[208:211], v[248:251], a[208:211]
s_add_u32 s72, s71, 0
buffer_load_dwordx4 v6, s[20:23], s72 offen lds
v_mfma_f32_16x16x32_bf16 a[212:215], v[212:215], v[248:251], a[212:215]
v_mul_f32 v95, v75, v38
v_and_b32 v97, 0xffff0000, v57
v_mfma_f32_16x16x32_bf16 a[216:219], v[216:219], v[248:251], a[216:219]
v_fmac_f32 v95, v74, v39
v_fmac_f32 v95, v73, v40
v_mfma_f32_16x16x32_bf16 a[220:223], v[220:223], v[248:251], a[220:223]
v_fmac_f32 v95, v72, v41
v_mul_f32 v95, v95, v97
v_mfma_f32_16x16x32_bf16 a[252:255], v[220:223], v[252:255], a[252:255]
s_add_u32 s72, s71, 31744
buffer_load_dwordx4 v6, s[20:23], s72 offen offset:1024 lds
v_mfma_f32_16x16x32_bf16 a[248:251], v[216:219], v[252:255], a[248:251]
v_mul_f32 v96, v75, v37
v_and_b32 v97, 0xffff0000, v56
v_mfma_f32_16x16x32_bf16 a[244:247], v[212:215], v[252:255], a[244:247]
v_fmac_f32 v96, v74, v38
v_fmac_f32 v96, v73, v39
v_mfma_f32_16x16x32_bf16 a[240:243], v[208:211], v[252:255], a[240:243]
v_fmac_f32 v96, v72, v40
v_mul_f32 v96, v96, v97
v_mfma_f32_16x16x32_bf16 a[236:239], v[204:207], v[252:255], a[236:239]
s_add_u32 s72, s71, 63488
buffer_load_dwordx4 v7, s[20:23], s72 offen offset:2048 lds
v_mfma_f32_16x16x32_bf16 a[232:235], v[200:203], v[252:255], a[232:235]
v_cvt_pk_bf16_f32 v105, v95, v96
v_mul_f32 v95, v75, v36
v_mfma_f32_16x16x32_bf16 a[228:231], v[196:199], v[252:255], a[228:231]
v_and_b32 v97, 0xffff0000, v55
v_fmac_f32 v95, v74, v37
v_mfma_f32_16x16x32_bf16 a[224:227], v[192:195], v[252:255], a[224:227]
s_waitcnt lgkmcnt(0)
v_fmac_f32 v95, v73, v38
v_fmac_f32 v95, v72, v39
v_mfma_f32_16x16x32_bf16 a[0:3], v[160:163], v[128:131], a[0:3]
s_add_u32 s72, s71, 95232
buffer_load_dwordx4 v7, s[20:23], s72 offen offset:3072 lds
v_mfma_f32_16x16x32_bf16 a[4:7], v[160:163], v[132:135], a[4:7]
s_mov_b32 s80, 0x400000
buffer_load_dword v126, v125, s[12:15], s80 offen
v_mfma_f32_16x16x32_bf16 a[8:11], v[160:163], v[136:139], a[8:11]
s_mov_b32 s80, 0x500000
buffer_load_dword v126, v125, s[12:15], s80 offen
v_mfma_f32_16x16x32_bf16 a[12:15], v[160:163], v[140:143], a[12:15]
s_mov_b32 s80, 0x600000
buffer_load_dword v126, v125, s[12:15], s80 offen
v_mfma_f32_16x16x32_bf16 a[16:19], v[160:163], v[144:147], a[16:19]
s_mov_b32 s80, 0x700000
buffer_load_dword v126, v125, s[12:15], s80 offen
v_mfma_f32_16x16x32_bf16 a[20:23], v[160:163], v[148:151], a[20:23]
ds_read_b64_tr_b16 v[224:225], v20 offset:40960
v_mul_f32 v95, v95, v97
v_mfma_f32_16x16x32_bf16 a[24:27], v[160:163], v[152:155], a[24:27]
v_mul_f32 v96, v75, v35
v_and_b32 v97, 0xffff0000, v54
v_mfma_f32_16x16x32_bf16 a[28:31], v[160:163], v[156:159], a[28:31]
ds_read_b64_tr_b16 v[226:227], v20 offset:41984
v_fmac_f32 v96, v74, v36
v_mfma_f32_16x16x32_bf16 a[60:63], v[164:167], v[156:159], a[60:63]
v_fmac_f32 v96, v73, v37
v_fmac_f32 v96, v72, v38
v_mfma_f32_16x16x32_bf16 a[56:59], v[164:167], v[152:155], a[56:59]
ds_read_b128 v[192:195], v25 offset:32768
v_mul_f32 v96, v96, v97
v_mfma_f32_16x16x32_bf16 a[52:55], v[164:167], v[148:151], a[52:55]
v_cvt_pk_bf16_f32 v106, v95, v96
v_mul_f32 v95, v75, v34
v_mfma_f32_16x16x32_bf16 a[48:51], v[164:167], v[144:147], a[48:51]
ds_read_b128 v[196:199], v25 offset:34816
v_and_b32 v97, 0xffff0000, v53
v_mfma_f32_16x16x32_bf16 a[44:47], v[164:167], v[140:143], a[44:47]
v_fmac_f32 v95, v74, v35
v_fmac_f32 v95, v73, v36
v_mfma_f32_16x16x32_bf16 a[40:43], v[164:167], v[136:139], a[40:43]
ds_read_b128 v[200:203], v25 offset:36864
v_fmac_f32 v95, v72, v37
v_mfma_f32_16x16x32_bf16 a[36:39], v[164:167], v[132:135], a[36:39]
v_mul_f32 v95, v95, v97
v_mul_f32 v96, v75, v33
v_mfma_f32_16x16x32_bf16 a[32:35], v[164:167], v[128:131], a[32:35]
ds_read_b128 v[204:207], v25 offset:38912
v_and_b32 v97, 0xffff0000, v52
v_mfma_f32_16x16x32_bf16 a[64:67], v[168:171], v[128:131], a[64:67]
v_fmac_f32 v96, v74, v34
v_fmac_f32 v96, v73, v35
v_mfma_f32_16x16x32_bf16 a[68:71], v[168:171], v[132:135], a[68:71]
ds_read_b128 v[208:211], v25 offset:40960
v_fmac_f32 v96, v72, v36
v_mfma_f32_16x16x32_bf16 a[72:75], v[168:171], v[136:139], a[72:75]
v_mul_f32 v96, v96, v97
v_cvt_pk_bf16_f32 v107, v95, v96
v_mfma_f32_16x16x32_bf16 a[76:79], v[168:171], v[140:143], a[76:79]
ds_read_b128 v[212:215], v25 offset:43008
ds_write_b128 v28, v[104:107] offset:288
v_mfma_f32_16x16x32_bf16 a[80:83], v[168:171], v[144:147], a[80:83]
v_mfma_f32_16x16x32_bf16 a[84:87], v[168:171], v[148:151], a[84:87]
ds_read_b128 v[216:219], v25 offset:45056
v_mfma_f32_16x16x32_bf16 a[88:91], v[168:171], v[152:155], a[88:91]
v_mfma_f32_16x16x32_bf16 a[92:95], v[168:171], v[156:159], a[92:95]
ds_read_b128 v[220:223], v25 offset:47104
v_mfma_f32_16x16x32_bf16 a[124:127], v[172:175], v[156:159], a[124:127]
v_mfma_f32_16x16x32_bf16 a[120:123], v[172:175], v[152:155], a[120:123]
ds_read_b64_tr_b16 v[228:229], v21 offset:40960
v_mfma_f32_16x16x32_bf16 a[116:119], v[172:175], v[148:151], a[116:119]
v_mfma_f32_16x16x32_bf16 a[112:115], v[172:175], v[144:147], a[112:115]
ds_read_b64_tr_b16 v[230:231], v21 offset:41984
v_mfma_f32_16x16x32_bf16 a[108:111], v[172:175], v[140:143], a[108:111]
v_mfma_f32_16x16x32_bf16 a[104:107], v[172:175], v[136:139], a[104:107]
ds_read_b64_tr_b16 v[232:233], v22 offset:40960
v_mfma_f32_16x16x32_bf16 a[100:103], v[172:175], v[132:135], a[100:103]
v_mfma_f32_16x16x32_bf16 a[96:99], v[172:175], v[128:131], a[96:99]
ds_read_b64_tr_b16 v[234:235], v22 offset:41984
v_mfma_f32_16x16x32_bf16 a[128:131], v[128:131], v[176:179], a[128:131]
v_mfma_f32_16x16x32_bf16 a[132:135], v[132:135], v[176:179], a[132:135]
ds_read_b64_tr_b16 v[236:237], v23 offset:40960
v_mfma_f32_16x16x32_bf16 a[136:139], v[136:139], v[176:179], a[136:139]
v_mfma_f32_16x16x32_bf16 a[140:143], v[140:143], v[176:179], a[140:143]
ds_read_b64_tr_b16 v[238:239], v23 offset:41984
v_mfma_f32_16x16x32_bf16 a[144:147], v[144:147], v[176:179], a[144:147]
v_mfma_f32_16x16x32_bf16 a[148:151], v[148:151], v[176:179], a[148:151]
ds_read_b64_tr_b16 v[240:241], v20 offset:57344
v_mfma_f32_16x16x32_bf16 a[152:155], v[152:155], v[176:179], a[152:155]
v_mfma_f32_16x16x32_bf16 a[156:159], v[156:159], v[176:179], a[156:159]
ds_read_b64_tr_b16 v[242:243], v20 offset:58368
v_mfma_f32_16x16x32_bf16 a[188:191], v[156:159], v[180:183], a[188:191]
v_mfma_f32_16x16x32_bf16 a[184:187], v[152:155], v[180:183], a[184:187]
ds_read_b64_tr_b16 v[244:245], v21 offset:57344
v_mfma_f32_16x16x32_bf16 a[180:183], v[148:151], v[180:183], a[180:183]
v_mfma_f32_16x16x32_bf16 a[176:179], v[144:147], v[180:183], a[176:179]
ds_read_b64_tr_b16 v[246:247], v21 offset:58368
v_mfma_f32_16x16x32_bf16 a[172:175], v[140:143], v[180:183], a[172:175]
v_mfma_f32_16x16x32_bf16 a[168:171], v[136:139], v[180:183], a[168:171]
ds_read_b64_tr_b16 v[248:249], v22 offset:57344
v_mfma_f32_16x16x32_bf16 a[164:167], v[132:135], v[180:183], a[164:167]
v_mfma_f32_16x16x32_bf16 a[160:163], v[128:131], v[180:183], a[160:163]
ds_read_b64_tr_b16 v[250:251], v22 offset:58368
v_mfma_f32_16x16x32_bf16 a[192:195], v[128:131], v[184:187], a[192:195]
v_mfma_f32_16x16x32_bf16 a[196:199], v[132:135], v[184:187], a[196:199]
ds_read_b64_tr_b16 v[252:253], v23 offset:57344
v_mfma_f32_16x16x32_bf16 a[200:203], v[136:139], v[184:187], a[200:203]
v_mfma_f32_16x16x32_bf16 a[204:207], v[140:143], v[184:187], a[204:207]
ds_read_b64_tr_b16 v[254:255], v23 offset:58368
v_mfma_f32_16x16x32_bf16 a[208:211], v[144:147], v[184:187], a[208:211]
v_mfma_f32_16x16x32_bf16 a[212:215], v[148:151], v[184:187], a[212:215]
v_mfma_f32_16x16x32_bf16 a[216:219], v[152:155], v[184:187], a[216:219]
v_mfma_f32_16x16x32_bf16 a[220:223], v[156:159], v[184:187], a[220:223]
v_mfma_f32_16x16x32_bf16 a[252:255], v[156:159], v[188:191], a[252:255]
v_mfma_f32_16x16x32_bf16 a[248:251], v[152:155], v[188:191], a[248:251]
v_mfma_f32_16x16x32_bf16 a[244:247], v[148:151], v[188:191], a[244:247]
v_mfma_f32_16x16x32_bf16 a[240:243], v[144:147], v[188:191], a[240:243]
v_mfma_f32_16x16x32_bf16 a[236:239], v[140:143], v[188:191], a[236:239]
v_mfma_f32_16x16x32_bf16 a[232:235], v[136:139], v[188:191], a[232:235]
v_mfma_f32_16x16x32_bf16 a[228:231], v[132:135], v[188:191], a[228:231]
s_waitcnt vmcnt(4) lgkmcnt(0)
v_mfma_f32_16x16x32_bf16 a[224:227], v[128:131], v[188:191], a[224:227]
s_barrier
v_mfma_f32_16x16x32_bf16 a[0:3], v[224:227], v[192:195], a[0:3]
s_and_b32 s73, s65, 1
ds_read_b64_tr_b16 v[160:161], v20 offset:0
v_mfma_f32_16x16x32_bf16 a[4:7], v[224:227], v[196:199], a[4:7]
s_xor_b32 s73, s73, 7
ds_read_b64_tr_b16 v[162:163], v20 offset:1024
v_mfma_f32_16x16x32_bf16 a[8:11], v[224:227], v[200:203], a[8:11]
s_lshl_b32 s69, s73, 7
ds_read_b128 v[128:131], v24 offset:0
v_mfma_f32_16x16x32_bf16 a[12:15], v[224:227], v[204:207], a[12:15]
s_add_u32 s69, s69, s84
ds_read_b128 v[132:135], v24 offset:2048
v_mfma_f32_16x16x32_bf16 a[16:19], v[224:227], v[208:211], a[16:19]
s_lshl_b32 s71, s73, 19
ds_read_b128 v[136:139], v24 offset:4096
v_mfma_f32_16x16x32_bf16 a[20:23], v[224:227], v[212:215], a[20:23]
s_add_u32 s71, s71, s66
ds_read_b128 v[140:143], v24 offset:6144
v_mfma_f32_16x16x32_bf16 a[24:27], v[224:227], v[216:219], a[24:27]
s_add_u32 m0, s63, 98304
ds_read_b128 v[144:147], v24 offset:8192
v_mfma_f32_16x16x32_bf16 a[28:31], v[224:227], v[220:223], a[28:31]
s_add_u32 s72, s69, 0
buffer_load_dwordx4 v2, s[8:11], s72 offen lds
v_mfma_f32_16x16x32_bf16 a[60:63], v[228:231], v[220:223], a[60:63]
s_add_u32 s72, s69, 7168
buffer_load_dwordx4 v3, s[8:11], s72 offen offset:1024 lds
v_mfma_f32_16x16x32_bf16 a[56:59], v[228:231], v[216:219], a[56:59]
s_add_u32 s72, s69, 14336
buffer_load_dwordx4 v2, s[8:11], s72 offen offset:2048 lds
v_mfma_f32_16x16x32_bf16 a[52:55], v[228:231], v[212:215], a[52:55]
s_mul_i32 s74, s58, 4352
ds_read_b128 v[148:151], v24 offset:10240
v_mfma_f32_16x16x32_bf16 a[48:51], v[228:231], v[208:211], a[48:51]
s_add_u32 s74, s74, 131072
ds_read_b128 v[152:155], v24 offset:12288
v_lshrrev_b32 v26, 4, v0
v_mfma_f32_16x16x32_bf16 a[44:47], v[228:231], v[204:207], a[44:47]
s_add_u32 s72, s69, 21504
buffer_load_dwordx4 v3, s[8:11], s72 offen offset:3072 lds
v_mfma_f32_16x16x32_bf16 a[40:43], v[228:231], v[200:203], a[40:43]
ds_read_b128 v[156:159], v24 offset:14336
v_and_b32 v27, 15, v0
v_mfma_f32_16x16x32_bf16 a[36:39], v[228:231], v[196:199], a[36:39]
ds_read_b64_tr_b16 v[164:165], v21 offset:0
v_lshlrev_b32 v27, 4, v27
v_mfma_f32_16x16x32_bf16 a[32:35], v[228:231], v[192:195], a[32:35]
ds_read_b64_tr_b16 v[166:167], v21 offset:1024
v_mul_u32_u24 v28, 272, v26
v_mfma_f32_16x16x32_bf16 a[64:67], v[232:235], v[192:195], a[64:67]
ds_read_b64_tr_b16 v[168:169], v22 offset:0
v_add3_u32 v28, v28, v27, s74
v_mfma_f32_16x16x32_bf16 a[68:71], v[232:235], v[196:199], a[68:71]
s_add_u32 m0, s64, 32768
ds_read_b64_tr_b16 v[170:171], v22 offset:1024
v_lshl_add_u32 v26, v26, 12, v27
v_mfma_f32_16x16x32_bf16 a[72:75], v[232:235], v[200:203], a[72:75]
s_add_u32 s72, s71, 0
buffer_load_dwordx4 v6, s[16:19], s72 offen lds
v_mfma_f32_16x16x32_bf16 a[76:79], v[232:235], v[204:207], a[76:79]
ds_read_b64_tr_b16 v[172:173], v23 offset:0
ds_read_b128 v[36:39], v28 offset:0
v_mfma_f32_16x16x32_bf16 a[80:83], v[232:235], v[208:211], a[80:83]
ds_read_b64_tr_b16 v[174:175], v23 offset:1024
ds_read_b128 v[40:43], v28 offset:1088
v_mfma_f32_16x16x32_bf16 a[84:87], v[232:235], v[212:215], a[84:87]
s_add_u32 s72, s71, 31744
buffer_load_dwordx4 v6, s[16:19], s72 offen offset:1024 lds
v_mfma_f32_16x16x32_bf16 a[88:91], v[232:235], v[216:219], a[88:91]
ds_read_b64_tr_b16 v[176:177], v20 offset:16384
ds_read_b128 v[44:47], v28 offset:2176
v_mfma_f32_16x16x32_bf16 a[92:95], v[232:235], v[220:223], a[92:95]
ds_read_b64_tr_b16 v[178:179], v20 offset:17408
ds_read_b128 v[48:51], v28 offset:3264
v_mfma_f32_16x16x32_bf16 a[124:127], v[236:239], v[220:223], a[124:127]
s_and_b32 s74, s2, 15
ds_read_b64_tr_b16 v[180:181], v21 offset:16384
v_mfma_f32_16x16x32_bf16 a[120:123], v[236:239], v[216:219], a[120:123]
s_add_u32 s72, s71, 63488
buffer_load_dwordx4 v7, s[16:19], s72 offen offset:2048 lds
v_mfma_f32_16x16x32_bf16 a[116:119], v[236:239], v[212:215], a[116:119]
s_lshl_b32 s74, s74, 2
ds_read_b64_tr_b16 v[182:183], v21 offset:17408
v_mfma_f32_16x16x32_bf16 a[112:115], v[236:239], v[208:211], a[112:115]
s_add_u32 s74, s74, s58
ds_read_b64_tr_b16 v[184:185], v22 offset:16384
v_mfma_f32_16x16x32_bf16 a[108:111], v[236:239], v[204:207], a[108:111]
s_lshl_b32 s74, s74, 16
ds_read_b64_tr_b16 v[186:187], v22 offset:17408
v_mfma_f32_16x16x32_bf16 a[104:107], v[236:239], v[200:203], a[104:107]
s_lshr_b32 s75, s2, 4
ds_read_b64_tr_b16 v[188:189], v23 offset:16384
v_mfma_f32_16x16x32_bf16 a[100:103], v[236:239], v[196:199], a[100:103]
s_add_u32 s72, s71, 95232
buffer_load_dwordx4 v7, s[16:19], s72 offen offset:3072 lds
v_mfma_f32_16x16x32_bf16 a[96:99], v[236:239], v[192:195], a[96:99]
s_lshl_b32 s75, s75, 8
ds_read_b64_tr_b16 v[190:191], v23 offset:17408
v_mfma_f32_16x16x32_bf16 a[128:131], v[192:195], v[240:243], a[128:131]
s_sub_u32 s74, s74, s75
v_mfma_f32_16x16x32_bf16 a[132:135], v[196:199], v[240:243], a[132:135]
s_add_u32 s74, s74, 0x3000f00
v_mfma_f32_16x16x32_bf16 a[136:139], v[200:203], v[240:243], a[136:139]
s_add_u32 m0, s63, 102400
v_mfma_f32_16x16x32_bf16 a[140:143], v[204:207], v[240:243], a[140:143]
s_add_u32 s72, s69, 32768
buffer_load_dwordx4 v2, s[8:11], s72 offen lds
v_mfma_f32_16x16x32_bf16 a[144:147], v[208:211], v[240:243], a[144:147]
s_waitcnt vmcnt(29)
v_lshlrev_b32 v78, 16, v84
v_lshlrev_b32 v79, 16, v108
v_mfma_f32_16x16x32_bf16 a[148:151], v[212:215], v[240:243], a[148:151]
v_mul_f32 v76, v78, v79
v_lshlrev_b32 v80, 16, v116
v_mfma_f32_16x16x32_bf16 a[152:155], v[216:219], v[240:243], a[152:155]
s_add_u32 s72, s69, 39936
buffer_load_dwordx4 v3, s[8:11], s72 offen offset:1024 lds
v_mfma_f32_16x16x32_bf16 a[156:159], v[220:223], v[240:243], a[156:159]
v_mul_f32 v77, v78, v80
v_and_b32 v78, 0xffff0000, v84
v_mfma_f32_16x16x32_bf16 a[188:191], v[220:223], v[244:247], a[188:191]
v_and_b32 v79, 0xffff0000, v108
v_fmac_f32 v76, v78, v79
v_mfma_f32_16x16x32_bf16 a[184:187], v[216:219], v[244:247], a[184:187]
v_and_b32 v80, 0xffff0000, v116
v_fmac_f32 v77, v78, v80
v_mfma_f32_16x16x32_bf16 a[180:183], v[212:215], v[244:247], a[180:183]
v_lshlrev_b32 v78, 16, v85
v_lshlrev_b32 v79, 16, v109
v_mfma_f32_16x16x32_bf16 a[176:179], v[208:211], v[244:247], a[176:179]
s_add_u32 s72, s69, 47104
buffer_load_dwordx4 v2, s[8:11], s72 offen offset:2048 lds
v_mfma_f32_16x16x32_bf16 a[172:175], v[204:207], v[244:247], a[172:175]
v_fmac_f32 v76, v78, v79
v_lshlrev_b32 v80, 16, v117
v_mfma_f32_16x16x32_bf16 a[168:171], v[200:203], v[244:247], a[168:171]
v_fmac_f32 v77, v78, v80
v_and_b32 v78, 0xffff0000, v85
v_mfma_f32_16x16x32_bf16 a[164:167], v[196:199], v[244:247], a[164:167]
v_and_b32 v79, 0xffff0000, v109
v_fmac_f32 v76, v78, v79
v_mfma_f32_16x16x32_bf16 a[160:163], v[192:195], v[244:247], a[160:163]
s_add_u32 s72, s69, 54272
buffer_load_dwordx4 v3, s[8:11], s72 offen offset:3072 lds
v_mfma_f32_16x16x32_bf16 a[192:195], v[192:195], v[248:251], a[192:195]
v_and_b32 v80, 0xffff0000, v117
v_fmac_f32 v77, v78, v80
v_mfma_f32_16x16x32_bf16 a[196:199], v[196:199], v[248:251], a[196:199]
v_lshlrev_b32 v78, 16, v86
v_lshlrev_b32 v79, 16, v110
v_mfma_f32_16x16x32_bf16 a[200:203], v[200:203], v[248:251], a[200:203]
v_fmac_f32 v76, v78, v79
v_lshlrev_b32 v80, 16, v118
v_mfma_f32_16x16x32_bf16 a[204:207], v[204:207], v[248:251], a[204:207]
s_add_u32 m0, s64, 49152
v_fmac_f32 v77, v78, v80
v_and_b32 v78, 0xffff0000, v86
v_mfma_f32_16x16x32_bf16 a[208:211], v[208:211], v[248:251], a[208:211]
s_add_u32 s72, s71, 0
buffer_load_dwordx4 v6, s[20:23], s72 offen lds
v_mfma_f32_16x16x32_bf16 a[212:215], v[212:215], v[248:251], a[212:215]
v_and_b32 v79, 0xffff0000, v110
v_fmac_f32 v76, v78, v79
v_mfma_f32_16x16x32_bf16 a[216:219], v[216:219], v[248:251], a[216:219]
v_and_b32 v80, 0xffff0000, v118
v_fmac_f32 v77, v78, v80
v_mfma_f32_16x16x32_bf16 a[220:223], v[220:223], v[248:251], a[220:223]
v_lshlrev_b32 v78, 16, v87
v_lshlrev_b32 v79, 16, v111
v_mfma_f32_16x16x32_bf16 a[252:255], v[220:223], v[252:255], a[252:255]
s_add_u32 s72, s71, 31744
buffer_load_dwordx4 v6, s[20:23], s72 offen offset:1024 lds
v_mfma_f32_16x16x32_bf16 a[248:251], v[216:219], v[252:255], a[248:251]
v_fmac_f32 v76, v78, v79
v_lshlrev_b32 v80, 16, v119
v_mfma_f32_16x16x32_bf16 a[244:247], v[212:215], v[252:255], a[244:247]
v_fmac_f32 v77, v78, v80
v_and_b32 v78, 0xffff0000, v87
v_mfma_f32_16x16x32_bf16 a[240:243], v[208:211], v[252:255], a[240:243]
v_and_b32 v79, 0xffff0000, v111
v_fmac_f32 v76, v78, v79
v_mfma_f32_16x16x32_bf16 a[236:239], v[204:207], v[252:255], a[236:239]
s_add_u32 s72, s71, 63488
buffer_load_dwordx4 v7, s[20:23], s72 offen offset:2048 lds
v_mfma_f32_16x16x32_bf16 a[232:235], v[200:203], v[252:255], a[232:235]
v_and_b32 v80, 0xffff0000, v119
v_fmac_f32 v77, v78, v80
v_mfma_f32_16x16x32_bf16 a[228:231], v[196:199], v[252:255], a[228:231]
v_lshlrev_b32 v78, 16, v88
v_lshlrev_b32 v79, 16, v112
v_mfma_f32_16x16x32_bf16 a[224:227], v[192:195], v[252:255], a[224:227]
s_waitcnt lgkmcnt(0)
v_fmac_f32 v76, v78, v79
v_lshlrev_b32 v80, 16, v120
v_mfma_f32_16x16x32_bf16 a[0:3], v[160:163], v[128:131], a[0:3]
s_add_u32 s72, s71, 95232
buffer_load_dwordx4 v7, s[20:23], s72 offen offset:3072 lds
v_mfma_f32_16x16x32_bf16 a[4:7], v[160:163], v[132:135], a[4:7]
ds_read_b64_tr_b16 v[224:225], v20 offset:8192
v_fmac_f32 v77, v78, v80
v_mfma_f32_16x16x32_bf16 a[8:11], v[160:163], v[136:139], a[8:11]
ds_read_b64_tr_b16 v[226:227], v20 offset:9216
v_and_b32 v78, 0xffff0000, v88
v_mfma_f32_16x16x32_bf16 a[12:15], v[160:163], v[140:143], a[12:15]
ds_read_b128 v[192:195], v25 offset:0
v_and_b32 v79, 0xffff0000, v112
v_mfma_f32_16x16x32_bf16 a[16:19], v[160:163], v[144:147], a[16:19]
ds_read_b128 v[196:199], v25 offset:2048
v_fmac_f32 v76, v78, v79
v_mfma_f32_16x16x32_bf16 a[20:23], v[160:163], v[148:151], a[20:23]
ds_read_b128 v[200:203], v25 offset:4096
v_and_b32 v80, 0xffff0000, v120
v_mfma_f32_16x16x32_bf16 a[24:27], v[160:163], v[152:155], a[24:27]
ds_read_b128 v[204:207], v25 offset:6144
v_fmac_f32 v77, v78, v80
v_mfma_f32_16x16x32_bf16 a[28:31], v[160:163], v[156:159], a[28:31]
ds_read_b128 v[208:211], v25 offset:8192
v_lshlrev_b32 v78, 16, v89
v_mfma_f32_16x16x32_bf16 a[60:63], v[164:167], v[156:159], a[60:63]
buffer_store_dwordx4 v[36:39], v26, s[44:47], s74 offen sc1
v_mfma_f32_16x16x32_bf16 a[56:59], v[164:167], v[152:155], a[56:59]
ds_read_b128 v[212:215], v25 offset:10240
v_lshlrev_b32 v79, 16, v113
v_mfma_f32_16x16x32_bf16 a[52:55], v[164:167], v[148:151], a[52:55]
ds_read_b128 v[216:219], v25 offset:12288
v_fmac_f32 v76, v78, v79
v_mfma_f32_16x16x32_bf16 a[48:51], v[164:167], v[144:147], a[48:51]
ds_read_b128 v[220:223], v25 offset:14336
v_lshlrev_b32 v80, 16, v121
v_mfma_f32_16x16x32_bf16 a[44:47], v[164:167], v[140:143], a[44:47]
ds_read_b64_tr_b16 v[228:229], v21 offset:8192
v_fmac_f32 v77, v78, v80
v_mfma_f32_16x16x32_bf16 a[40:43], v[164:167], v[136:139], a[40:43]
ds_read_b64_tr_b16 v[230:231], v21 offset:9216
v_and_b32 v78, 0xffff0000, v89
v_mfma_f32_16x16x32_bf16 a[36:39], v[164:167], v[132:135], a[36:39]
ds_read_b64_tr_b16 v[232:233], v22 offset:8192
v_and_b32 v79, 0xffff0000, v113
v_mfma_f32_16x16x32_bf16 a[32:35], v[164:167], v[128:131], a[32:35]
ds_read_b64_tr_b16 v[234:235], v22 offset:9216
v_fmac_f32 v76, v78, v79
v_mfma_f32_16x16x32_bf16 a[64:67], v[168:171], v[128:131], a[64:67]
ds_read_b64_tr_b16 v[236:237], v23 offset:8192
v_and_b32 v80, 0xffff0000, v121
v_mfma_f32_16x16x32_bf16 a[68:71], v[168:171], v[132:135], a[68:71]
ds_read_b64_tr_b16 v[238:239], v23 offset:9216
v_fmac_f32 v77, v78, v80
v_mfma_f32_16x16x32_bf16 a[72:75], v[168:171], v[136:139], a[72:75]
ds_read_b64_tr_b16 v[240:241], v20 offset:24576
v_lshlrev_b32 v78, 16, v90
v_mfma_f32_16x16x32_bf16 a[76:79], v[168:171], v[140:143], a[76:79]
ds_read_b64_tr_b16 v[242:243], v20 offset:25600
v_lshlrev_b32 v79, 16, v114
v_mfma_f32_16x16x32_bf16 a[80:83], v[168:171], v[144:147], a[80:83]
s_lshr_b32 s75, s93, 5
ds_read_b64_tr_b16 v[244:245], v21 offset:24576
v_fmac_f32 v76, v78, v79
v_mfma_f32_16x16x32_bf16 a[84:87], v[168:171], v[148:151], a[84:87]
s_add_u32 s74, s74, 0x4000
buffer_store_dwordx4 v[40:43], v26, s[44:47], s74 offen sc1
v_mfma_f32_16x16x32_bf16 a[88:91], v[168:171], v[152:155], a[88:91]
s_and_b32 s75, s75, 0x3f80
ds_read_b64_tr_b16 v[246:247], v21 offset:25600
v_lshlrev_b32 v80, 16, v122
v_mfma_f32_16x16x32_bf16 a[92:95], v[168:171], v[156:159], a[92:95]
s_add_u32 s75, s75, LcB0-Lpc0
v_lshrrev_b32 v2, 6, v0
v_lshlrev_b32 v2, 7, v2
v_mfma_f32_16x16x32_bf16 a[124:127], v[172:175], v[156:159], a[124:127]
v_add_u32 v2, s75, v2
v_min_u32 v2, Lcode_end-Lpc0, v2
v_mfma_f32_16x16x32_bf16 a[120:123], v[172:175], v[152:155], a[120:123]
global_load_dword v3, v2, s[98:99]
v_mfma_f32_16x16x32_bf16 a[116:119], v[172:175], v[148:151], a[116:119]
ds_read_b64_tr_b16 v[248:249], v22 offset:24576
v_fmac_f32 v77, v78, v80
v_mfma_f32_16x16x32_bf16 a[112:115], v[172:175], v[144:147], a[112:115]
ds_read_b64_tr_b16 v[250:251], v22 offset:25600
v_and_b32 v78, 0xffff0000, v90
v_mfma_f32_16x16x32_bf16 a[108:111], v[172:175], v[140:143], a[108:111]
ds_read_b64_tr_b16 v[252:253], v23 offset:24576
v_and_b32 v79, 0xffff0000, v114
v_mfma_f32_16x16x32_bf16 a[104:107], v[172:175], v[136:139], a[104:107]
ds_read_b64_tr_b16 v[254:255], v23 offset:25600
v_fmac_f32 v76, v78, v79
v_mfma_f32_16x16x32_bf16 a[100:103], v[172:175], v[132:135], a[100:103]
v_and_b32 v80, 0xffff0000, v122
v_fmac_f32 v77, v78, v80
v_mfma_f32_16x16x32_bf16 a[96:99], v[172:175], v[128:131], a[96:99]
v_lshlrev_b32 v78, 16, v91
v_lshlrev_b32 v79, 16, v115
v_mfma_f32_16x16x32_bf16 a[128:131], v[128:131], v[176:179], a[128:131]
v_fmac_f32 v76, v78, v79
v_lshlrev_b32 v80, 16, v123
v_mfma_f32_16x16x32_bf16 a[132:135], v[132:135], v[176:179], a[132:135]
v_fmac_f32 v77, v78, v80
v_and_b32 v78, 0xffff0000, v91
v_mfma_f32_16x16x32_bf16 a[136:139], v[136:139], v[176:179], a[136:139]
v_and_b32 v79, 0xffff0000, v115
v_fmac_f32 v76, v78, v79
v_mfma_f32_16x16x32_bf16 a[140:143], v[140:143], v[176:179], a[140:143]
s_add_u32 s74, s74, 0x4000
buffer_store_dwordx4 v[44:47], v26, s[44:47], s74 offen sc1
v_mfma_f32_16x16x32_bf16 a[144:147], v[144:147], v[176:179], a[144:147]
v_and_b32 v80, 0xffff0000, v123
v_fmac_f32 v77, v78, v80
v_mfma_f32_16x16x32_bf16 a[148:151], v[148:151], v[176:179], a[148:151]
v_add_f32_dpp v76, v76, v76 row_ror:8 row_mask:0xf bank_mask:0xf
v_add_f32_dpp v77, v77, v77 row_ror:8 row_mask:0xf bank_mask:0xf
v_mfma_f32_16x16x32_bf16 a[152:155], v[152:155], v[176:179], a[152:155]
v_add_f32_dpp v76, v76, v76 row_ror:4 row_mask:0xf bank_mask:0xf
v_add_f32_dpp v77, v77, v77 row_ror:4 row_mask:0xf bank_mask:0xf
v_mfma_f32_16x16x32_bf16 a[156:159], v[156:159], v[176:179], a[156:159]
v_add_f32_dpp v76, v76, v76 row_ror:2 row_mask:0xf bank_mask:0xf
v_add_f32_dpp v77, v77, v77 row_ror:2 row_mask:0xf bank_mask:0xf
v_mfma_f32_16x16x32_bf16 a[188:191], v[156:159], v[180:183], a[188:191]
v_add_f32_dpp v76, v76, v76 row_ror:1 row_mask:0xf bank_mask:0xf
v_add_f32_dpp v77, v77, v77 row_ror:1 row_mask:0xf bank_mask:0xf
v_mfma_f32_16x16x32_bf16 a[184:187], v[152:155], v[180:183], a[184:187]
v_mov_b32 v78, v76
v_mov_b32 v79, v77
v_mfma_f32_16x16x32_bf16 a[180:183], v[148:151], v[180:183], a[180:183]
v_permlane16_swap_b32 v76, v78
v_permlane16_swap_b32 v77, v79
v_mfma_f32_16x16x32_bf16 a[176:179], v[144:147], v[180:183], a[176:179]
v_add_f32 v76, v76, v78
v_add_f32 v77, v77, v79
v_mfma_f32_16x16x32_bf16 a[172:175], v[140:143], v[180:183], a[172:175]
v_mov_b32 v78, v76
v_mov_b32 v79, v77
v_mfma_f32_16x16x32_bf16 a[168:171], v[136:139], v[180:183], a[168:171]
v_permlane32_swap_b32 v76, v78
v_permlane32_swap_b32 v77, v79
v_mfma_f32_16x16x32_bf16 a[164:167], v[132:135], v[180:183], a[164:167]
v_add_f32 v76, v76, v78
v_add_f32 v77, v77, v79
v_mfma_f32_16x16x32_bf16 a[160:163], v[128:131], v[180:183], a[160:163]
v_mul_f32 v76, 0xbfb8aa3b, v76
v_mul_f32 v77, 0xbfb8aa3b, v77
v_mfma_f32_16x16x32_bf16 a[192:195], v[128:131], v[184:187], a[192:195]
v_exp_f32 v76, v76
v_mfma_f32_16x16x32_bf16 a[196:199], v[132:135], v[184:187], a[196:199]
s_add_u32 s74, s74, 0x4000
buffer_store_dwordx4 v[48:51], v26, s[44:47], s74 offen sc1
v_mfma_f32_16x16x32_bf16 a[200:203], v[136:139], v[184:187], a[200:203]
v_exp_f32 v77, v77
v_mfma_f32_16x16x32_bf16 a[204:207], v[140:143], v[184:187], a[204:207]
v_add_f32 v76, 1.0, v76
v_add_f32 v77, 1.0, v77
v_mfma_f32_16x16x32_bf16 a[208:211], v[144:147], v[184:187], a[208:211]
v_rcp_f32 v76, v76
v_mfma_f32_16x16x32_bf16 a[212:215], v[148:151], v[184:187], a[212:215]
v_rcp_f32 v77, v77
v_mfma_f32_16x16x32_bf16 a[216:219], v[152:155], v[184:187], a[216:219]
s_lshr_b32 s80, s76, 9
v_mfma_f32_16x16x32_bf16 a[220:223], v[156:159], v[184:187], a[220:223]
s_add_u32 s80, s80, 0x3800000
v_min_u32 v78, 1, v0
v_lshlrev_b32 v78, 30, v78
v_mfma_f32_16x16x32_bf16 a[252:255], v[156:159], v[188:191], a[252:255]
buffer_store_dwordx2 v[76:77], v78, s[44:47], s80 offen sc1
v_mfma_f32_16x16x32_bf16 a[248:251], v[152:155], v[188:191], a[248:251]
v_mfma_f32_16x16x32_bf16 a[244:247], v[148:151], v[188:191], a[244:247]
v_mfma_f32_16x16x32_bf16 a[240:243], v[144:147], v[188:191], a[240:243]
v_mfma_f32_16x16x32_bf16 a[236:239], v[140:143], v[188:191], a[236:239]
v_mfma_f32_16x16x32_bf16 a[232:235], v[136:139], v[188:191], a[232:235]
v_mfma_f32_16x16x32_bf16 a[228:231], v[132:135], v[188:191], a[228:231]
s_waitcnt vmcnt(6) lgkmcnt(0)
v_mfma_f32_16x16x32_bf16 a[224:227], v[128:131], v[188:191], a[224:227]
s_barrier
v_mfma_f32_16x16x32_bf16 a[0:3], v[224:227], v[192:195], a[0:3]
s_add_u32 s73, s62, 0
ds_read_b64_tr_b16 v[160:161], v20 offset:32768
v_mfma_f32_16x16x32_bf16 a[4:7], v[224:227], v[196:199], a[4:7]
s_add_u32 s70, s73, s65
ds_read_b64_tr_b16 v[162:163], v20 offset:33792
v_mfma_f32_16x16x32_bf16 a[8:11], v[224:227], v[200:203], a[8:11]
s_and_b32 s70, s70, 3
ds_read_b128 v[128:131], v24 offset:32768
v_mfma_f32_16x16x32_bf16 a[12:15], v[224:227], v[204:207], a[12:15]
s_and_b32 s73, s73, 12
ds_read_b128 v[132:135], v24 offset:34816
v_mfma_f32_16x16x32_bf16 a[16:19], v[224:227], v[208:211], a[16:19]
s_or_b32 s73, s73, s70
ds_read_b128 v[136:139], v24 offset:36864
v_mfma_f32_16x16x32_bf16 a[20:23], v[224:227], v[212:215], a[20:23]
s_lshl_b32 s71, s73, 19
ds_read_b128 v[140:143], v24 offset:38912
v_mfma_f32_16x16x32_bf16 a[24:27], v[224:227], v[216:219], a[24:27]
s_add_u32 s71, s71, s66
ds_read_b128 v[144:147], v24 offset:40960
v_mfma_f32_16x16x32_bf16 a[28:31], v[224:227], v[220:223], a[28:31]
s_lshl_b32 s73, s73, 7
ds_read_b128 v[148:151], v24 offset:43008
v_mfma_f32_16x16x32_bf16 a[60:63], v[228:231], v[220:223], a[60:63]
s_add_u32 s69, s73, s67
ds_read_b128 v[152:155], v24 offset:45056
v_mfma_f32_16x16x32_bf16 a[56:59], v[228:231], v[216:219], a[56:59]
s_add_u32 s70, s73, s68
ds_read_b128 v[156:159], v24 offset:47104
v_mfma_f32_16x16x32_bf16 a[52:55], v[228:231], v[212:215], a[52:55]
s_add_u32 m0, s64, 0
ds_read_b64_tr_b16 v[164:165], v21 offset:32768
v_mfma_f32_16x16x32_bf16 a[48:51], v[228:231], v[208:211], a[48:51]
s_add_u32 s72, s71, 0
buffer_load_dwordx4 v6, s[12:15], s72 offen lds
v_mfma_f32_16x16x32_bf16 a[44:47], v[228:231], v[204:207], a[44:47]
s_add_u32 s72, s71, 31744
buffer_load_dwordx4 v6, s[12:15], s72 offen offset:1024 lds
v_mfma_f32_16x16x32_bf16 a[40:43], v[228:231], v[200:203], a[40:43]
s_add_u32 s72, s71, 63488
buffer_load_dwordx4 v7, s[12:15], s72 offen offset:2048 lds
v_mfma_f32_16x16x32_bf16 a[36:39], v[228:231], v[196:199], a[36:39]
ds_read_b64_tr_b16 v[166:167], v21 offset:33792
v_mfma_f32_16x16x32_bf16 a[32:35], v[228:231], v[192:195], a[32:35]
s_add_u32 s72, s71, 95232
buffer_load_dwordx4 v7, s[12:15], s72 offen offset:3072 lds
v_mfma_f32_16x16x32_bf16 a[64:67], v[232:235], v[192:195], a[64:67]
ds_read_b64_tr_b16 v[168:169], v22 offset:32768
v_mfma_f32_16x16x32_bf16 a[68:71], v[232:235], v[196:199], a[68:71]
ds_read_b64_tr_b16 v[170:171], v22 offset:33792
v_mfma_f32_16x16x32_bf16 a[72:75], v[232:235], v[200:203], a[72:75]
ds_read_b64_tr_b16 v[172:173], v23 offset:32768
v_mfma_f32_16x16x32_bf16 a[76:79], v[232:235], v[204:207], a[76:79]
ds_read_b64_tr_b16 v[174:175], v23 offset:33792
v_mfma_f32_16x16x32_bf16 a[80:83], v[232:235], v[208:211], a[80:83]
s_add_u32 m0, s63, 131072
ds_read_b64_tr_b16 v[176:177], v20 offset:49152
v_mfma_f32_16x16x32_bf16 a[84:87], v[232:235], v[212:215], a[84:87]
s_add_u32 s72, s69, 0
buffer_load_dwordx4 v4, s[4:7], s72 offen lds
v_mfma_f32_16x16x32_bf16 a[88:91], v[232:235], v[216:219], a[88:91]
ds_read_b64_tr_b16 v[178:179], v20 offset:50176
v_mfma_f32_16x16x32_bf16 a[92:95], v[232:235], v[220:223], a[92:95]
ds_read_b64_tr_b16 v[180:181], v21 offset:49152
v_mfma_f32_16x16x32_bf16 a[124:127], v[236:239], v[220:223], a[124:127]
ds_read_b64_tr_b16 v[182:183], v21 offset:50176
v_mfma_f32_16x16x32_bf16 a[120:123], v[236:239], v[216:219], a[120:123]
s_add_u32 s72, s69, 15360
buffer_load_dwordx4 v5, s[4:7], s72 offen offset:1024 lds
v_mfma_f32_16x16x32_bf16 a[116:119], v[236:239], v[212:215], a[116:119]
ds_read_b64_tr_b16 v[184:185], v22 offset:49152
v_mfma_f32_16x16x32_bf16 a[112:115], v[236:239], v[208:211], a[112:115]
ds_read_b64_tr_b16 v[186:187], v22 offset:50176
v_mfma_f32_16x16x32_bf16 a[108:111], v[236:239], v[204:207], a[108:111]
ds_read_b64_tr_b16 v[188:189], v23 offset:49152
v_mfma_f32_16x16x32_bf16 a[104:107], v[236:239], v[200:203], a[104:107]
ds_read_b64_tr_b16 v[190:191], v23 offset:50176
v_mfma_f32_16x16x32_bf16 a[100:103], v[236:239], v[196:199], a[100:103]
s_add_u32 s72, s69, 129024
buffer_load_dwordx4 v4, s[4:7], s72 offen offset:2048 lds
v_mfma_f32_16x16x32_bf16 a[96:99], v[236:239], v[192:195], a[96:99]
v_mfma_f32_16x16x32_bf16 a[128:131], v[192:195], v[240:243], a[128:131]
v_mfma_f32_16x16x32_bf16 a[132:135], v[196:199], v[240:243], a[132:135]
v_mfma_f32_16x16x32_bf16 a[136:139], v[200:203], v[240:243], a[136:139]
v_mfma_f32_16x16x32_bf16 a[140:143], v[204:207], v[240:243], a[140:143]
s_add_u32 s72, s69, 144384
buffer_load_dwordx4 v5, s[4:7], s72 offen offset:3072 lds
v_mfma_f32_16x16x32_bf16 a[144:147], v[208:211], v[240:243], a[144:147]
v_mfma_f32_16x16x32_bf16 a[148:151], v[212:215], v[240:243], a[148:151]
v_mfma_f32_16x16x32_bf16 a[152:155], v[216:219], v[240:243], a[152:155]
v_mfma_f32_16x16x32_bf16 a[156:159], v[220:223], v[240:243], a[156:159]
v_mfma_f32_16x16x32_bf16 a[188:191], v[220:223], v[244:247], a[188:191]
s_add_u32 m0, s63, 135168
v_mfma_f32_16x16x32_bf16 a[184:187], v[216:219], v[244:247], a[184:187]
s_add_u32 s72, s70, 0
buffer_load_dwordx4 v4, s[4:7], s72 offen lds
v_mfma_f32_16x16x32_bf16 a[180:183], v[212:215], v[244:247], a[180:183]
v_mfma_f32_16x16x32_bf16 a[176:179], v[208:211], v[244:247], a[176:179]
v_mfma_f32_16x16x32_bf16 a[172:175], v[204:207], v[244:247], a[172:175]
v_mfma_f32_16x16x32_bf16 a[168:171], v[200:203], v[244:247], a[168:171]
s_add_u32 s72, s70, 15360
buffer_load_dwordx4 v5, s[4:7], s72 offen offset:1024 lds
v_mfma_f32_16x16x32_bf16 a[164:167], v[196:199], v[244:247], a[164:167]
v_mfma_f32_16x16x32_bf16 a[160:163], v[192:195], v[244:247], a[160:163]
v_mfma_f32_16x16x32_bf16 a[192:195], v[192:195], v[248:251], a[192:195]
v_mfma_f32_16x16x32_bf16 a[196:199], v[196:199], v[248:251], a[196:199]
v_mfma_f32_16x16x32_bf16 a[200:203], v[200:203], v[248:251], a[200:203]
s_add_u32 s72, s70, 129024
buffer_load_dwordx4 v4, s[4:7], s72 offen offset:2048 lds
v_mfma_f32_16x16x32_bf16 a[204:207], v[204:207], v[248:251], a[204:207]
v_mfma_f32_16x16x32_bf16 a[208:211], v[208:211], v[248:251], a[208:211]
v_mfma_f32_16x16x32_bf16 a[212:215], v[212:215], v[248:251], a[212:215]
v_mfma_f32_16x16x32_bf16 a[216:219], v[216:219], v[248:251], a[216:219]
v_mfma_f32_16x16x32_bf16 a[220:223], v[220:223], v[248:251], a[220:223]
s_add_u32 s72, s70, 144384
buffer_load_dwordx4 v5, s[4:7], s72 offen offset:3072 lds
v_mfma_f32_16x16x32_bf16 a[252:255], v[220:223], v[252:255], a[252:255]
v_mfma_f32_16x16x32_bf16 a[248:251], v[216:219], v[252:255], a[248:251]
v_mfma_f32_16x16x32_bf16 a[244:247], v[212:215], v[252:255], a[244:247]
v_mfma_f32_16x16x32_bf16 a[240:243], v[208:211], v[252:255], a[240:243]
v_mfma_f32_16x16x32_bf16 a[236:239], v[204:207], v[252:255], a[236:239]
s_add_u32 s73, s62, 1
v_mfma_f32_16x16x32_bf16 a[232:235], v[200:203], v[252:255], a[232:235]
s_add_u32 s70, s73, s65
v_mfma_f32_16x16x32_bf16 a[228:231], v[196:199], v[252:255], a[228:231]
s_and_b32 s70, s70, 3
v_mfma_f32_16x16x32_bf16 a[224:227], v[192:195], v[252:255], a[224:227]
s_waitcnt lgkmcnt(0)
v_mfma_f32_16x16x32_bf16 a[0:3], v[160:163], v[128:131], a[0:3]
s_and_b32 s73, s73, 12
ds_read_b64_tr_b16 v[224:225], v20 offset:40960
v_mfma_f32_16x16x32_bf16 a[4:7], v[160:163], v[132:135], a[4:7]
s_or_b32 s73, s73, s70
ds_read_b64_tr_b16 v[226:227], v20 offset:41984
v_mfma_f32_16x16x32_bf16 a[8:11], v[160:163], v[136:139], a[8:11]
s_lshl_b32 s71, s73, 19
ds_read_b128 v[192:195], v25 offset:32768
v_mfma_f32_16x16x32_bf16 a[12:15], v[160:163], v[140:143], a[12:15]
s_add_u32 s71, s71, s66
ds_read_b128 v[196:199], v25 offset:34816
v_mfma_f32_16x16x32_bf16 a[16:19], v[160:163], v[144:147], a[16:19]
s_lshl_b32 s73, s73, 7
ds_read_b128 v[200:203], v25 offset:36864
v_mfma_f32_16x16x32_bf16 a[20:23], v[160:163], v[148:151], a[20:23]
s_add_u32 s69, s73, s67
ds_read_b128 v[204:207], v25 offset:38912
v_mfma_f32_16x16x32_bf16 a[24:27], v[160:163], v[152:155], a[24:27]
s_add_u32 s70, s73, s68
ds_read_b128 v[208:211], v25 offset:40960
v_mfma_f32_16x16x32_bf16 a[28:31], v[160:163], v[156:159], a[28:31]
s_add_u32 m0, s64, 16384
ds_read_b128 v[212:215], v25 offset:43008
v_mfma_f32_16x16x32_bf16 a[60:63], v[164:167], v[156:159], a[60:63]
s_add_u32 s72, s71, 0
buffer_load_dwordx4 v6, s[12:15], s72 offen lds
v_mfma_f32_16x16x32_bf16 a[56:59], v[164:167], v[152:155], a[56:59]
s_add_u32 s72, s71, 31744
buffer_load_dwordx4 v6, s[12:15], s72 offen offset:1024 lds
v_mfma_f32_16x16x32_bf16 a[52:55], v[164:167], v[148:151], a[52:55]
s_add_u32 s72, s71, 63488
buffer_load_dwordx4 v7, s[12:15], s72 offen offset:2048 lds
v_mfma_f32_16x16x32_bf16 a[48:51], v[164:167], v[144:147], a[48:51]
s_add_u32 s72, s71, 95232
buffer_load_dwordx4 v7, s[12:15], s72 offen offset:3072 lds
v_mfma_f32_16x16x32_bf16 a[44:47], v[164:167], v[140:143], a[44:47]
ds_read_b128 v[216:219], v25 offset:45056
v_mfma_f32_16x16x32_bf16 a[40:43], v[164:167], v[136:139], a[40:43]
ds_read_b128 v[220:223], v25 offset:47104
v_mfma_f32_16x16x32_bf16 a[36:39], v[164:167], v[132:135], a[36:39]
ds_read_b64_tr_b16 v[228:229], v21 offset:40960
v_mfma_f32_16x16x32_bf16 a[32:35], v[164:167], v[128:131], a[32:35]
ds_read_b64_tr_b16 v[230:231], v21 offset:41984
v_mfma_f32_16x16x32_bf16 a[64:67], v[168:171], v[128:131], a[64:67]
s_add_u32 m0, s63, 65536
ds_read_b64_tr_b16 v[232:233], v22 offset:40960
v_mfma_f32_16x16x32_bf16 a[68:71], v[168:171], v[132:135], a[68:71]
s_add_u32 s72, s69, 0
buffer_load_dwordx4 v4, s[4:7], s72 offen lds
v_mfma_f32_16x16x32_bf16 a[72:75], v[168:171], v[136:139], a[72:75]
ds_read_b64_tr_b16 v[234:235], v22 offset:41984
v_mfma_f32_16x16x32_bf16 a[76:79], v[168:171], v[140:143], a[76:79]
ds_read_b64_tr_b16 v[236:237], v23 offset:40960
v_mfma_f32_16x16x32_bf16 a[80:83], v[168:171], v[144:147], a[80:83]
ds_read_b64_tr_b16 v[238:239], v23 offset:41984
v_mfma_f32_16x16x32_bf16 a[84:87], v[168:171], v[148:151], a[84:87]
s_add_u32 s72, s69, 15360
buffer_load_dwordx4 v5, s[4:7], s72 offen offset:1024 lds
v_mfma_f32_16x16x32_bf16 a[88:91], v[168:171], v[152:155], a[88:91]
ds_read_b64_tr_b16 v[240:241], v20 offset:57344
v_mfma_f32_16x16x32_bf16 a[92:95], v[168:171], v[156:159], a[92:95]
ds_read_b64_tr_b16 v[242:243], v20 offset:58368
v_mfma_f32_16x16x32_bf16 a[124:127], v[172:175], v[156:159], a[124:127]
ds_read_b64_tr_b16 v[244:245], v21 offset:57344
v_mfma_f32_16x16x32_bf16 a[120:123], v[172:175], v[152:155], a[120:123]
ds_read_b64_tr_b16 v[246:247], v21 offset:58368
v_mfma_f32_16x16x32_bf16 a[116:119], v[172:175], v[148:151], a[116:119]
s_add_u32 s72, s69, 129024
buffer_load_dwordx4 v4, s[4:7], s72 offen offset:2048 lds
v_mfma_f32_16x16x32_bf16 a[112:115], v[172:175], v[144:147], a[112:115]
ds_read_b64_tr_b16 v[248:249], v22 offset:57344
v_mfma_f32_16x16x32_bf16 a[108:111], v[172:175], v[140:143], a[108:111]
ds_read_b64_tr_b16 v[250:251], v22 offset:58368
v_mfma_f32_16x16x32_bf16 a[104:107], v[172:175], v[136:139], a[104:107]
ds_read_b64_tr_b16 v[252:253], v23 offset:57344
v_mfma_f32_16x16x32_bf16 a[100:103], v[172:175], v[132:135], a[100:103]
ds_read_b64_tr_b16 v[254:255], v23 offset:58368
v_mfma_f32_16x16x32_bf16 a[96:99], v[172:175], v[128:131], a[96:99]
s_add_u32 s72, s69, 144384
buffer_load_dwordx4 v5, s[4:7], s72 offen offset:3072 lds
v_mfma_f32_16x16x32_bf16 a[128:131], v[128:131], v[176:179], a[128:131]
v_mfma_f32_16x16x32_bf16 a[132:135], v[132:135], v[176:179], a[132:135]
v_mfma_f32_16x16x32_bf16 a[136:139], v[136:139], v[176:179], a[136:139]
v_mfma_f32_16x16x32_bf16 a[140:143], v[140:143], v[176:179], a[140:143]
v_mfma_f32_16x16x32_bf16 a[144:147], v[144:147], v[176:179], a[144:147]
s_add_u32 m0, s63, 69632
v_mfma_f32_16x16x32_bf16 a[148:151], v[148:151], v[176:179], a[148:151]
s_add_u32 s72, s70, 0
buffer_load_dwordx4 v4, s[4:7], s72 offen lds
v_mfma_f32_16x16x32_bf16 a[152:155], v[152:155], v[176:179], a[152:155]
v_mfma_f32_16x16x32_bf16 a[156:159], v[156:159], v[176:179], a[156:159]
v_mfma_f32_16x16x32_bf16 a[188:191], v[156:159], v[180:183], a[188:191]
v_mfma_f32_16x16x32_bf16 a[184:187], v[152:155], v[180:183], a[184:187]
s_add_u32 s72, s70, 15360
buffer_load_dwordx4 v5, s[4:7], s72 offen offset:1024 lds
v_mfma_f32_16x16x32_bf16 a[180:183], v[148:151], v[180:183], a[180:183]
v_mfma_f32_16x16x32_bf16 a[176:179], v[144:147], v[180:183], a[176:179]
v_mfma_f32_16x16x32_bf16 a[172:175], v[140:143], v[180:183], a[172:175]
v_mfma_f32_16x16x32_bf16 a[168:171], v[136:139], v[180:183], a[168:171]
v_mfma_f32_16x16x32_bf16 a[164:167], v[132:135], v[180:183], a[164:167]
s_add_u32 s72, s70, 129024
buffer_load_dwordx4 v4, s[4:7], s72 offen offset:2048 lds
v_mfma_f32_16x16x32_bf16 a[160:163], v[128:131], v[180:183], a[160:163]
v_mfma_f32_16x16x32_bf16 a[192:195], v[128:131], v[184:187], a[192:195]
v_mfma_f32_16x16x32_bf16 a[196:199], v[132:135], v[184:187], a[196:199]
v_mfma_f32_16x16x32_bf16 a[200:203], v[136:139], v[184:187], a[200:203]
v_mfma_f32_16x16x32_bf16 a[204:207], v[140:143], v[184:187], a[204:207]
s_add_u32 s72, s70, 144384
buffer_load_dwordx4 v5, s[4:7], s72 offen offset:3072 lds
v_mfma_f32_16x16x32_bf16 a[208:211], v[144:147], v[184:187], a[208:211]
v_mfma_f32_16x16x32_bf16 a[212:215], v[148:151], v[184:187], a[212:215]
v_mfma_f32_16x16x32_bf16 a[216:219], v[152:155], v[184:187], a[216:219]
v_mfma_f32_16x16x32_bf16 a[220:223], v[156:159], v[184:187], a[220:223]
v_mfma_f32_16x16x32_bf16 a[252:255], v[156:159], v[188:191], a[252:255]
v_mfma_f32_16x16x32_bf16 a[248:251], v[152:155], v[188:191], a[248:251]
v_mfma_f32_16x16x32_bf16 a[244:247], v[148:151], v[188:191], a[244:247]
v_mfma_f32_16x16x32_bf16 a[240:243], v[144:147], v[188:191], a[240:243]
v_mfma_f32_16x16x32_bf16 a[236:239], v[140:143], v[188:191], a[236:239]
v_mfma_f32_16x16x32_bf16 a[232:235], v[136:139], v[188:191], a[232:235]
v_mfma_f32_16x16x32_bf16 a[228:231], v[132:135], v[188:191], a[228:231]
s_waitcnt vmcnt(12) lgkmcnt(0)
v_mfma_f32_16x16x32_bf16 a[224:227], v[128:131], v[188:191], a[224:227]
s_barrier
LcB0:
v_mfma_f32_16x16x32_bf16 a[0:3], v[224:227], v[192:195], a[0:3]
s_add_u32 s73, s62, 2
ds_read_b64_tr_b16 v[32:33], v8 offset:0
v_mfma_f32_16x16x32_bf16 a[4:7], v[224:227], v[196:199], a[4:7]
s_add_u32 s70, s73, s65
ds_read_b64_tr_b16 v[34:35], v8 offset:1024
v_mfma_f32_16x16x32_bf16 a[8:11], v[224:227], v[200:203], a[8:11]
s_and_b32 s70, s70, 3
ds_read_b128 v[64:67], v16 offset:0
v_mfma_f32_16x16x32_bf16 a[12:15], v[224:227], v[204:207], a[12:15]
s_and_b32 s73, s73, 12
ds_read_b128 v[68:71], v16 offset:2048
v_mfma_f32_16x16x32_bf16 a[16:19], v[224:227], v[208:211], a[16:19]
s_or_b32 s73, s73, s70
ds_read_b128 v[72:75], v16 offset:4096
v_mfma_f32_16x16x32_bf16 a[20:23], v[224:227], v[212:215], a[20:23]
s_lshl_b32 s71, s73, 19
ds_read_b128 v[76:79], v16 offset:6144
v_mfma_f32_16x16x32_bf16 a[24:27], v[224:227], v[216:219], a[24:27]
s_add_u32 s71, s71, s66
ds_read_b64_tr_b16 v[36:37], v9 offset:0
v_mfma_f32_16x16x32_bf16 a[28:31], v[224:227], v[220:223], a[28:31]
s_lshl_b32 s73, s73, 7
ds_read_b64_tr_b16 v[38:39], v9 offset:1024
v_mfma_f32_16x16x32_bf16 a[60:63], v[228:231], v[220:223], a[60:63]
s_add_u32 s69, s73, s67
ds_read_b64_tr_b16 v[40:41], v10 offset:0
v_mfma_f32_16x16x32_bf16 a[56:59], v[228:231], v[216:219], a[56:59]
s_add_u32 s70, s73, s68
ds_read_b64_tr_b16 v[42:43], v10 offset:1024
v_mfma_f32_16x16x32_bf16 a[52:55], v[228:231], v[212:215], a[52:55]
s_add_u32 m0, s64, 32768
ds_read_b64_tr_b16 v[44:45], v11 offset:0
v_mfma_f32_16x16x32_bf16 a[48:51], v[228:231], v[208:211], a[48:51]
s_add_u32 s72, s71, 0
buffer_load_dwordx4 v6, s[12:15], s72 offen lds
v_mfma_f32_16x16x32_bf16 a[44:47], v[228:231], v[204:207], a[44:47]
s_add_u32 s72, s71, 31744
buffer_load_dwordx4 v6, s[12:15], s72 offen offset:1024 lds
v_mfma_f32_16x16x32_bf16 a[40:43], v[228:231], v[200:203], a[40:43]
s_add_u32 s72, s71, 63488
buffer_load_dwordx4 v7, s[12:15], s72 offen offset:2048 lds
v_mfma_f32_16x16x32_bf16 a[36:39], v[228:231], v[196:199], a[36:39]
s_lshl_b32 s80, s59, 2
ds_read_b64_tr_b16 v[46:47], v11 offset:1024
v_or_b32 v26, s58, v0
v_mfma_f32_16x16x32_bf16 a[32:35], v[228:231], v[192:195], a[32:35]
s_add_u32 s72, s71, 95232
buffer_load_dwordx4 v7, s[12:15], s72 offen offset:3072 lds
v_mfma_f32_16x16x32_bf16 a[64:67], v[232:235], v[192:195], a[64:67]
ds_read_b64_tr_b16 v[48:49], v12 offset:0
v_mov_b32 v27, 1
v_mfma_f32_16x16x32_bf16 a[68:71], v[232:235], v[196:199], a[68:71]
ds_read_b64_tr_b16 v[50:51], v12 offset:1024
v_lshlrev_b32 v26, 8, v26
v_mfma_f32_16x16x32_bf16 a[72:75], v[232:235], v[200:203], a[72:75]
ds_read_b64_tr_b16 v[52:53], v13 offset:0
v_mfma_f32_16x16x32_bf16 a[76:79], v[232:235], v[204:207], a[76:79]
ds_read_b64_tr_b16 v[54:55], v13 offset:1024
v_mfma_f32_16x16x32_bf16 a[80:83], v[232:235], v[208:211], a[80:83]
s_add_u32 m0, s63, 98304
ds_read_b64_tr_b16 v[56:57], v14 offset:0
v_mfma_f32_16x16x32_bf16 a[84:87], v[232:235], v[212:215], a[84:87]
s_add_u32 s72, s69, 0
buffer_load_dwordx4 v4, s[4:7], s72 offen lds
v_mfma_f32_16x16x32_bf16 a[88:91], v[232:235], v[216:219], a[88:91]
ds_read_b64_tr_b16 v[58:59], v14 offset:1024
v_mfma_f32_16x16x32_bf16 a[92:95], v[232:235], v[220:223], a[92:95]
ds_read_b64_tr_b16 v[60:61], v15 offset:0
v_mfma_f32_16x16x32_bf16 a[124:127], v[236:239], v[220:223], a[124:127]
ds_read_b64_tr_b16 v[62:63], v15 offset:1024
v_mfma_f32_16x16x32_bf16 a[120:123], v[236:239], v[216:219], a[120:123]
s_add_u32 s72, s69, 15360
buffer_load_dwordx4 v5, s[4:7], s72 offen offset:1024 lds
v_mfma_f32_16x16x32_bf16 a[116:119], v[236:239], v[212:215], a[116:119]
buffer_atomic_add v27, v26, s[48:51], s80 offen sc1
v_mfma_f32_16x16x32_bf16 a[112:115], v[236:239], v[208:211], a[112:115]
v_accvgpr_read_b32 v20, a0
v_accvgpr_read_b32 v28, a1
v_mfma_f32_16x16x32_bf16 a[108:111], v[236:239], v[204:207], a[108:111]
v_accvgpr_read_b32 v21, a2
v_accvgpr_read_b32 v29, a3
v_mfma_f32_16x16x32_bf16 a[104:107], v[236:239], v[200:203], a[104:107]
v_accvgpr_read_b32 v22, a32
v_accvgpr_read_b32 v30, a33
v_mfma_f32_16x16x32_bf16 a[100:103], v[236:239], v[196:199], a[100:103]
s_add_u32 s72, s69, 129024
buffer_load_dwordx4 v4, s[4:7], s72 offen offset:2048 lds
v_mfma_f32_16x16x32_bf16 a[96:99], v[236:239], v[192:195], a[96:99]
v_accvgpr_read_b32 v23, a34
v_accvgpr_read_b32 v31, a35
v_mfma_f32_16x16x32_bf16 a[128:131], v[192:195], v[240:243], a[128:131]
v_mul_f32 v20, s79, v20
v_mul_f32 v28, s79, v28
v_mfma_f32_16x16x32_bf16 a[132:135], v[196:199], v[240:243], a[132:135]
v_mul_f32 v21, s79, v21
v_mul_f32 v29, s79, v29
v_mfma_f32_16x16x32_bf16 a[136:139], v[200:203], v[240:243], a[136:139]
v_mul_f32 v22, s79, v22
v_mul_f32 v30, s79, v30
v_mfma_f32_16x16x32_bf16 a[140:143], v[204:207], v[240:243], a[140:143]
s_add_u32 s72, s69, 144384
buffer_load_dwordx4 v5, s[4:7], s72 offen offset:3072 lds
v_mfma_f32_16x16x32_bf16 a[144:147], v[208:211], v[240:243], a[144:147]
v_mul_f32 v23, s79, v23
v_mul_f32 v31, s79, v31
v_mfma_f32_16x16x32_bf16 a[148:151], v[212:215], v[240:243], a[148:151]
v_cvt_pk_bf16_f32 v20, v20, v28
v_cvt_pk_bf16_f32 v21, v21, v29
v_mfma_f32_16x16x32_bf16 a[152:155], v[216:219], v[240:243], a[152:155]
v_cvt_pk_bf16_f32 v22, v22, v30
v_cvt_pk_bf16_f32 v23, v23, v31
v_mfma_f32_16x16x32_bf16 a[156:159], v[220:223], v[240:243], a[156:159]
s_add_u32 s80, s77, 0
buffer_store_dwordx4 v[20:23], v1, s[44:47], s80 offen sc1
v_mfma_f32_16x16x32_bf16 a[188:191], v[220:223], v[244:247], a[188:191]
s_add_u32 m0, s63, 102400
v_mfma_f32_16x16x32_bf16 a[184:187], v[216:219], v[244:247], a[184:187]
s_add_u32 s72, s70, 0
buffer_load_dwordx4 v4, s[4:7], s72 offen lds
v_mfma_f32_16x16x32_bf16 a[180:183], v[212:215], v[244:247], a[180:183]
v_mfma_f32_16x16x32_bf16 a[176:179], v[208:211], v[244:247], a[176:179]
v_mfma_f32_16x16x32_bf16 a[172:175], v[204:207], v[244:247], a[172:175]
v_mfma_f32_16x16x32_bf16 a[168:171], v[200:203], v[244:247], a[168:171]
s_add_u32 s72, s70, 15360
buffer_load_dwordx4 v5, s[4:7], s72 offen offset:1024 lds
v_mfma_f32_16x16x32_bf16 a[164:167], v[196:199], v[244:247], a[164:167]
v_accvgpr_read_b32 v24, a4
v_accvgpr_read_b32 v28, a5
v_mfma_f32_16x16x32_bf16 a[160:163], v[192:195], v[244:247], a[160:163]
v_accvgpr_read_b32 v25, a6
v_accvgpr_read_b32 v29, a7
v_mfma_f32_16x16x32_bf16 a[192:195], v[192:195], v[248:251], a[192:195]
v_accvgpr_read_b32 v26, a36
v_accvgpr_read_b32 v30, a37
v_mfma_f32_16x16x32_bf16 a[196:199], v[196:199], v[248:251], a[196:199]
v_accvgpr_read_b32 v27, a38
v_accvgpr_read_b32 v31, a39
v_mfma_f32_16x16x32_bf16 a[200:203], v[200:203], v[248:251], a[200:203]
s_add_u32 s72, s70, 129024
buffer_load_dwordx4 v4, s[4:7], s72 offen offset:2048 lds
v_mfma_f32_16x16x32_bf16 a[204:207], v[204:207], v[248:251], a[204:207]
v_mul_f32 v24, s79, v24
v_mul_f32 v28, s79, v28
v_mfma_f32_16x16x32_bf16 a[208:211], v[208:211], v[248:251], a[208:211]
v_mul_f32 v25, s79, v25
v_mul_f32 v29, s79, v29
v_mfma_f32_16x16x32_bf16 a[212:215], v[212:215], v[248:251], a[212:215]
v_mul_f32 v26, s79, v26
v_mul_f32 v30, s79, v30
v_mfma_f32_16x16x32_bf16 a[216:219], v[216:219], v[248:251], a[216:219]
v_mul_f32 v27, s79, v27
v_mul_f32 v31, s79, v31
v_mfma_f32_16x16x32_bf16 a[220:223], v[220:223], v[248:251], a[220:223]
s_add_u32 s72, s70, 144384
buffer_load_dwordx4 v5, s[4:7], s72 offen offset:3072 lds
v_mfma_f32_16x16x32_bf16 a[252:255], v[220:223], v[252:255], a[252:255]
v_cvt_pk_bf16_f32 v24, v24, v28
v_cvt_pk_bf16_f32 v25, v25, v29
v_mfma_f32_16x16x32_bf16 a[248:251], v[216:219], v[252:255], a[248:251]
v_cvt_pk_bf16_f32 v26, v26, v30
v_cvt_pk_bf16_f32 v27, v27, v31
v_mfma_f32_16x16x32_bf16 a[244:247], v[212:215], v[252:255], a[244:247]
s_add_u32 s80, s77, 4096
buffer_store_dwordx4 v[24:27], v1, s[44:47], s80 offen sc1
v_mfma_f32_16x16x32_bf16 a[240:243], v[208:211], v[252:255], a[240:243]
v_mfma_f32_16x16x32_bf16 a[236:239], v[204:207], v[252:255], a[236:239]
v_mfma_f32_16x16x32_bf16 a[232:235], v[200:203], v[252:255], a[232:235]
v_mfma_f32_16x16x32_bf16 a[228:231], v[196:199], v[252:255], a[228:231]
v_mfma_f32_16x16x32_bf16 a[224:227], v[192:195], v[252:255], a[224:227]
s_waitcnt lgkmcnt(0)
v_mfma_f32_16x16x32_bf16 v[128:131], v[32:35], v[64:67], 0
ds_read_b64_tr_b16 v[80:81], v8 offset:8192
ds_read_b64_tr_b16 v[82:83], v8 offset:9216
v_mfma_f32_16x16x32_bf16 v[132:135], v[32:35], v[68:71], 0
ds_read_b128 v[112:115], v17 offset:0
ds_read_b128 v[116:119], v17 offset:2048
v_mfma_f32_16x16x32_bf16 v[136:139], v[32:35], v[72:75], 0
ds_read_b128 v[120:123], v17 offset:4096
ds_read_b128 v[124:127], v17 offset:6144
v_mfma_f32_16x16x32_bf16 v[140:143], v[32:35], v[76:79], 0
ds_read_b64_tr_b16 v[84:85], v9 offset:8192
ds_read_b64_tr_b16 v[86:87], v9 offset:9216
v_mfma_f32_16x16x32_bf16 v[156:159], v[36:39], v[76:79], 0
ds_read_b64_tr_b16 v[88:89], v10 offset:8192
v_accvgpr_read_b32 v20, a8
v_mfma_f32_16x16x32_bf16 v[152:155], v[36:39], v[72:75], 0
ds_read_b64_tr_b16 v[90:91], v10 offset:9216
v_accvgpr_read_b32 v28, a9
v_mfma_f32_16x16x32_bf16 v[148:151], v[36:39], v[68:71], 0
ds_read_b64_tr_b16 v[92:93], v11 offset:8192
v_accvgpr_read_b32 v21, a10
v_mfma_f32_16x16x32_bf16 v[144:147], v[36:39], v[64:67], 0
ds_read_b64_tr_b16 v[94:95], v11 offset:9216
v_accvgpr_read_b32 v29, a11
v_mfma_f32_16x16x32_bf16 v[160:163], v[40:43], v[64:67], 0
ds_read_b64_tr_b16 v[96:97], v12 offset:8192
v_accvgpr_read_b32 v22, a40
v_mfma_f32_16x16x32_bf16 v[164:167], v[40:43], v[68:71], 0
ds_read_b64_tr_b16 v[98:99], v12 offset:9216
v_accvgpr_read_b32 v30, a41
v_mfma_f32_16x16x32_bf16 v[168:171], v[40:43], v[72:75], 0
ds_read_b64_tr_b16 v[100:101], v13 offset:8192
v_accvgpr_read_b32 v23, a42
v_mfma_f32_16x16x32_bf16 v[172:175], v[40:43], v[76:79], 0
ds_read_b64_tr_b16 v[102:103], v13 offset:9216
v_accvgpr_read_b32 v31, a43
v_mfma_f32_16x16x32_bf16 v[188:191], v[44:47], v[76:79], 0
ds_read_b64_tr_b16 v[104:105], v14 offset:8192
v_mul_f32 v20, s79, v20
v_mfma_f32_16x16x32_bf16 v[184:187], v[44:47], v[72:75], 0
ds_read_b64_tr_b16 v[106:107], v14 offset:9216
v_mul_f32 v28, s79, v28
v_mfma_f32_16x16x32_bf16 v[180:183], v[44:47], v[68:71], 0
ds_read_b64_tr_b16 v[108:109], v15 offset:8192
v_mul_f32 v21, s79, v21
v_mfma_f32_16x16x32_bf16 v[176:179], v[44:47], v[64:67], 0
ds_read_b64_tr_b16 v[110:111], v15 offset:9216
v_mul_f32 v29, s79, v29
v_mfma_f32_16x16x32_bf16 v[192:195], v[48:51], v[64:67], 0
v_mul_f32 v22, s79, v22
v_mul_f32 v30, s79, v30
v_mfma_f32_16x16x32_bf16 v[196:199], v[48:51], v[68:71], 0
v_mul_f32 v23, s79, v23
v_mul_f32 v31, s79, v31
v_mfma_f32_16x16x32_bf16 v[200:203], v[48:51], v[72:75], 0
v_cvt_pk_bf16_f32 v20, v20, v28
v_cvt_pk_bf16_f32 v21, v21, v29
v_mfma_f32_16x16x32_bf16 v[204:207], v[48:51], v[76:79], 0
v_cvt_pk_bf16_f32 v22, v22, v30
v_cvt_pk_bf16_f32 v23, v23, v31
v_mfma_f32_16x16x32_bf16 v[220:223], v[52:55], v[76:79], 0
s_add_u32 s80, s77, 8192
buffer_store_dwordx4 v[20:23], v1, s[44:47], s80 offen sc1
v_mfma_f32_16x16x32_bf16 v[216:219], v[52:55], v[72:75], 0
v_mfma_f32_16x16x32_bf16 v[212:215], v[52:55], v[68:71], 0
v_accvgpr_read_b32 v24, a128
v_accvgpr_read_b32 v28, a129
v_mfma_f32_16x16x32_bf16 v[208:211], v[52:55], v[64:67], 0
v_accvgpr_read_b32 v25, a130
v_accvgpr_read_b32 v29, a131
v_mfma_f32_16x16x32_bf16 v[224:227], v[56:59], v[64:67], 0
v_accvgpr_read_b32 v26, a132
v_accvgpr_read_b32 v30, a133
v_mfma_f32_16x16x32_bf16 v[228:231], v[56:59], v[68:71], 0
v_accvgpr_read_b32 v27, a134
v_accvgpr_read_b32 v31, a135
v_mfma_f32_16x16x32_bf16 v[232:235], v[56:59], v[72:75], 0
v_cvt_pk_bf16_f32 v24, v24, v28
v_cvt_pk_bf16_f32 v25, v25, v29
v_mfma_f32_16x16x32_bf16 v[236:239], v[56:59], v[76:79], 0
v_cvt_pk_bf16_f32 v26, v26, v30
v_cvt_pk_bf16_f32 v27, v27, v31
v_mfma_f32_16x16x32_bf16 v[252:255], v[60:63], v[76:79], 0
s_add_u32 s80, s78, 0
buffer_store_dwordx4 v[24:27], v1, s[44:47], s80 offen sc1
v_mfma_f32_16x16x32_bf16 v[248:251], v[60:63], v[72:75], 0
v_mfma_f32_16x16x32_bf16 v[244:247], v[60:63], v[68:71], 0
s_waitcnt vmcnt(17) lgkmcnt(0)
v_mfma_f32_16x16x32_bf16 v[240:243], v[60:63], v[64:67], 0
s_barrier
v_mfma_f32_16x16x32_bf16 v[128:131], v[80:83], v[112:115], v[128:131]
s_add_u32 s73, s62, 3
ds_read_b64_tr_b16 v[32:33], v8 offset:16384
ds_read_b64_tr_b16 v[34:35], v8 offset:17408
v_mfma_f32_16x16x32_bf16 v[132:135], v[80:83], v[116:119], v[132:135]
s_add_u32 s70, s73, s65
ds_read_b128 v[64:67], v18 offset:0
ds_read_b128 v[68:71], v18 offset:2048
v_mfma_f32_16x16x32_bf16 v[136:139], v[80:83], v[120:123], v[136:139]
s_and_b32 s70, s70, 3
ds_read_b128 v[72:75], v18 offset:4096
ds_read_b128 v[76:79], v18 offset:6144
v_mfma_f32_16x16x32_bf16 v[140:143], v[80:83], v[124:127], v[140:143]
s_and_b32 s73, s73, 12
ds_read_b64_tr_b16 v[36:37], v9 offset:16384
ds_read_b64_tr_b16 v[38:39], v9 offset:17408
v_mfma_f32_16x16x32_bf16 v[156:159], v[84:87], v[124:127], v[156:159]
s_or_b32 s73, s73, s70
ds_read_b64_tr_b16 v[40:41], v10 offset:16384
v_mfma_f32_16x16x32_bf16 v[152:155], v[84:87], v[120:123], v[152:155]
s_lshl_b32 s71, s73, 19
ds_read_b64_tr_b16 v[42:43], v10 offset:17408
v_mfma_f32_16x16x32_bf16 v[148:151], v[84:87], v[116:119], v[148:151]
s_add_u32 s71, s71, s66
ds_read_b64_tr_b16 v[44:45], v11 offset:16384
v_mfma_f32_16x16x32_bf16 v[144:147], v[84:87], v[112:115], v[144:147]
s_lshl_b32 s73, s73, 7
ds_read_b64_tr_b16 v[46:47], v11 offset:17408
v_mfma_f32_16x16x32_bf16 v[160:163], v[88:91], v[112:115], v[160:163]
s_add_u32 s69, s73, s67
ds_read_b64_tr_b16 v[48:49], v12 offset:16384
v_mfma_f32_16x16x32_bf16 v[164:167], v[88:91], v[116:119], v[164:167]
s_add_u32 s70, s73, s68
ds_read_b64_tr_b16 v[50:51], v12 offset:17408
v_mfma_f32_16x16x32_bf16 v[168:171], v[88:91], v[120:123], v[168:171]
s_add_u32 m0, s64, 0
ds_read_b64_tr_b16 v[52:53], v13 offset:16384
v_mfma_f32_16x16x32_bf16 v[172:175], v[88:91], v[124:127], v[172:175]
s_add_u32 s72, s71, 0
buffer_load_dwordx4 v6, s[12:15], s72 offen lds
v_mfma_f32_16x16x32_bf16 v[188:191], v[92:95], v[124:127], v[188:191]
s_add_u32 s72, s71, 31744
buffer_load_dwordx4 v6, s[12:15], s72 offen offset:1024 lds
v_mfma_f32_16x16x32_bf16 v[184:187], v[92:95], v[120:123], v[184:187]
s_add_u32 s72, s71, 63488
buffer_load_dwordx4 v7, s[12:15], s72 offen offset:2048 lds
v_mfma_f32_16x16x32_bf16 v[180:183], v[92:95], v[116:119], v[180:183]
s_add_u32 s72, s71, 95232
buffer_load_dwordx4 v7, s[12:15], s72 offen offset:3072 lds
v_mfma_f32_16x16x32_bf16 v[176:179], v[92:95], v[112:115], v[176:179]
ds_read_b64_tr_b16 v[54:55], v13 offset:17408
v_accvgpr_read_b32 v20, a12
v_mfma_f32_16x16x32_bf16 v[192:195], v[96:99], v[112:115], v[192:195]
ds_read_b64_tr_b16 v[56:57], v14 offset:16384
v_accvgpr_read_b32 v28, a13
v_mfma_f32_16x16x32_bf16 v[196:199], v[96:99], v[116:119], v[196:199]
ds_read_b64_tr_b16 v[58:59], v14 offset:17408
v_accvgpr_read_b32 v21, a14
v_mfma_f32_16x16x32_bf16 v[200:203], v[96:99], v[120:123], v[200:203]
ds_read_b64_tr_b16 v[60:61], v15 offset:16384
v_accvgpr_read_b32 v29, a15
v_mfma_f32_16x16x32_bf16 v[204:207], v[96:99], v[124:127], v[204:207]
s_add_u32 m0, s63, 131072
ds_read_b64_tr_b16 v[62:63], v15 offset:17408
v_accvgpr_read_b32 v22, a44
v_mfma_f32_16x16x32_bf16 v[220:223], v[100:103], v[124:127], v[220:223]
s_add_u32 s72, s69, 0
buffer_load_dwordx4 v4, s[4:7], s72 offen lds
v_mfma_f32_16x16x32_bf16 v[216:219], v[100:103], v[120:123], v[216:219]
v_accvgpr_read_b32 v30, a45
v_accvgpr_read_b32 v23, a46
v_mfma_f32_16x16x32_bf16 v[212:215], v[100:103], v[116:119], v[212:215]
v_accvgpr_read_b32 v31, a47
v_mul_f32 v20, s79, v20
v_mfma_f32_16x16x32_bf16 v[208:211], v[100:103], v[112:115], v[208:211]
v_mul_f32 v28, s79, v28
v_mul_f32 v21, s79, v21
v_mfma_f32_16x16x32_bf16 v[224:227], v[104:107], v[112:115], v[224:227]
s_add_u32 s72, s69, 15360
buffer_load_dwordx4 v5, s[4:7], s72 offen offset:1024 lds
v_mfma_f32_16x16x32_bf16 v[228:231], v[104:107], v[116:119], v[228:231]
v_mul_f32 v29, s79, v29
v_mul_f32 v22, s79, v22
v_mfma_f32_16x16x32_bf16 v[232:235], v[104:107], v[120:123], v[232:235]
v_mul_f32 v30, s79, v30
v_mul_f32 v23, s79, v23
v_mfma_f32_16x16x32_bf16 v[236:239], v[104:107], v[124:127], v[236:239]
v_mul_f32 v31, s79, v31
v_cvt_pk_bf16_f32 v20, v20, v28
v_mfma_f32_16x16x32_bf16 v[252:255], v[108:111], v[124:127], v[252:255]
v_cvt_pk_bf16_f32 v21, v21, v29
v_cvt_pk_bf16_f32 v22, v22, v30
v_mfma_f32_16x16x32_bf16 v[248:251], v[108:111], v[120:123], v[248:251]
s_add_u32 s72, s69, 129024
buffer_load_dwordx4 v4, s[4:7], s72 offen offset:2048 lds
v_mfma_f32_16x16x32_bf16 v[244:247], v[108:111], v[116:119], v[244:247]
v_cvt_pk_bf16_f32 v23, v23, v31
v_mfma_f32_16x16x32_bf16 v[240:243], v[108:111], v[112:115], v[240:243]
s_waitcnt lgkmcnt(0)
v_accvgpr_read_b32 v24, a136
v_accvgpr_read_b32 v28, a137
v_mfma_f32_16x16x32_bf16 v[128:131], v[32:35], v[64:67], v[128:131]
s_add_u32 s80, s77, 12288
ds_read_b64_tr_b16 v[80:81], v8 offset:24576
ds_read_b64_tr_b16 v[82:83], v8 offset:25600
v_mfma_f32_16x16x32_bf16 v[132:135], v[32:35], v[68:71], v[132:135]
ds_read_b128 v[112:115], v19 offset:0
ds_read_b128 v[116:119], v19 offset:2048
v_mfma_f32_16x16x32_bf16 v[136:139], v[32:35], v[72:75], v[136:139]
s_add_u32 s72, s69, 144384
buffer_load_dwordx4 v5, s[4:7], s72 offen offset:3072 lds
v_mfma_f32_16x16x32_bf16 v[140:143], v[32:35], v[76:79], v[140:143]
ds_read_b128 v[120:123], v19 offset:4096
ds_read_b128 v[124:127], v19 offset:6144
v_mfma_f32_16x16x32_bf16 v[156:159], v[36:39], v[76:79], v[156:159]
ds_read_b64_tr_b16 v[84:85], v9 offset:24576
ds_read_b64_tr_b16 v[86:87], v9 offset:25600
v_mfma_f32_16x16x32_bf16 v[152:155], v[36:39], v[72:75], v[152:155]
ds_read_b64_tr_b16 v[88:89], v10 offset:24576
v_accvgpr_read_b32 v25, a138
v_mfma_f32_16x16x32_bf16 v[148:151], v[36:39], v[68:71], v[148:151]
ds_read_b64_tr_b16 v[90:91], v10 offset:25600
v_accvgpr_read_b32 v29, a139
v_mfma_f32_16x16x32_bf16 v[144:147], v[36:39], v[64:67], v[144:147]
s_add_u32 m0, s63, 135168
ds_read_b64_tr_b16 v[92:93], v11 offset:24576
v_accvgpr_read_b32 v26, a140
v_mfma_f32_16x16x32_bf16 v[160:163], v[40:43], v[64:67], v[160:163]
s_add_u32 s72, s70, 0
buffer_load_dwordx4 v4, s[4:7], s72 offen lds
v_mfma_f32_16x16x32_bf16 v[164:167], v[40:43], v[68:71], v[164:167]
ds_read_b64_tr_b16 v[94:95], v11 offset:25600
v_accvgpr_read_b32 v30, a141
v_mfma_f32_16x16x32_bf16 v[168:171], v[40:43], v[72:75], v[168:171]
ds_read_b64_tr_b16 v[96:97], v12 offset:24576
v_accvgpr_read_b32 v27, a142
v_mfma_f32_16x16x32_bf16 v[172:175], v[40:43], v[76:79], v[172:175]
ds_read_b64_tr_b16 v[98:99], v12 offset:25600
v_accvgpr_read_b32 v31, a143
v_mfma_f32_16x16x32_bf16 v[188:191], v[44:47], v[76:79], v[188:191]
s_add_u32 s72, s70, 15360
buffer_load_dwordx4 v5, s[4:7], s72 offen offset:1024 lds
v_mfma_f32_16x16x32_bf16 v[184:187], v[44:47], v[72:75], v[184:187]
ds_read_b64_tr_b16 v[100:101], v13 offset:24576
v_cvt_pk_bf16_f32 v24, v24, v28
v_mfma_f32_16x16x32_bf16 v[180:183], v[44:47], v[68:71], v[180:183]
ds_read_b64_tr_b16 v[102:103], v13 offset:25600
v_cvt_pk_bf16_f32 v25, v25, v29
v_mfma_f32_16x16x32_bf16 v[176:179], v[44:47], v[64:67], v[176:179]
ds_read_b64_tr_b16 v[104:105], v14 offset:24576
v_cvt_pk_bf16_f32 v26, v26, v30
v_mfma_f32_16x16x32_bf16 v[192:195], v[48:51], v[64:67], v[192:195]
ds_read_b64_tr_b16 v[106:107], v14 offset:25600
v_cvt_pk_bf16_f32 v27, v27, v31
v_mfma_f32_16x16x32_bf16 v[196:199], v[48:51], v[68:71], v[196:199]
s_add_u32 s72, s70, 129024
buffer_load_dwordx4 v4, s[4:7], s72 offen offset:2048 lds
v_mfma_f32_16x16x32_bf16 v[200:203], v[48:51], v[72:75], v[200:203]
ds_read_b64_tr_b16 v[108:109], v15 offset:24576
v_mfma_f32_16x16x32_bf16 v[204:207], v[48:51], v[76:79], v[204:207]
ds_read_b64_tr_b16 v[110:111], v15 offset:25600
v_mfma_f32_16x16x32_bf16 v[220:223], v[52:55], v[76:79], v[220:223]
buffer_store_dwordx4 v[20:23], v1, s[44:47], s80 offen sc1
v_mfma_f32_16x16x32_bf16 v[216:219], v[52:55], v[72:75], v[216:219]
s_add_u32 s80, s78, 8192
buffer_store_dwordx4 v[24:27], v1, s[44:47], s80 offen sc1
v_mfma_f32_16x16x32_bf16 v[212:215], v[52:55], v[68:71], v[212:215]
s_add_u32 s72, s70, 144384
buffer_load_dwordx4 v5, s[4:7], s72 offen offset:3072 lds
v_mfma_f32_16x16x32_bf16 v[208:211], v[52:55], v[64:67], v[208:211]
v_accvgpr_read_b32 v20, a16
v_accvgpr_read_b32 v28, a17
v_mfma_f32_16x16x32_bf16 v[224:227], v[56:59], v[64:67], v[224:227]
v_accvgpr_read_b32 v21, a18
v_accvgpr_read_b32 v29, a19
v_mfma_f32_16x16x32_bf16 v[228:231], v[56:59], v[68:71], v[228:231]
v_accvgpr_read_b32 v22, a48
v_accvgpr_read_b32 v30, a49
v_mfma_f32_16x16x32_bf16 v[232:235], v[56:59], v[72:75], v[232:235]
v_accvgpr_read_b32 v23, a50
v_accvgpr_read_b32 v31, a51
v_mfma_f32_16x16x32_bf16 v[236:239], v[56:59], v[76:79], v[236:239]
v_mul_f32 v20, s79, v20
v_mul_f32 v28, s79, v28
v_mfma_f32_16x16x32_bf16 v[252:255], v[60:63], v[76:79], v[252:255]
v_mul_f32 v21, s79, v21
v_mul_f32 v29, s79, v29
v_mfma_f32_16x16x32_bf16 v[248:251], v[60:63], v[72:75], v[248:251]
v_mul_f32 v22, s79, v22
v_mul_f32 v30, s79, v30
v_mfma_f32_16x16x32_bf16 v[244:247], v[60:63], v[68:71], v[244:247]
s_waitcnt vmcnt(17) lgkmcnt(0)
v_mul_f32 v23, s79, v23
v_mul_f32 v31, s79, v31
v_mfma_f32_16x16x32_bf16 v[240:243], v[60:63], v[64:67], v[240:243]
s_barrier
v_cvt_pk_bf16_f32 v20, v20, v28
v_cvt_pk_bf16_f32 v21, v21, v29
v_mfma_f32_16x16x32_bf16 v[128:131], v[80:83], v[112:115], v[128:131]
s_add_u32 s73, s62, 4
ds_read_b64_tr_b16 v[32:33], v8 offset:32768
ds_read_b64_tr_b16 v[34:35], v8 offset:33792
v_mfma_f32_16x16x32_bf16 v[132:135], v[80:83], v[116:119], v[132:135]
s_add_u32 s70, s73, s65
ds_read_b128 v[64:67], v18 offset:32768
ds_read_b128 v[68:71], v18 offset:34816
v_mfma_f32_16x16x32_bf16 v[136:139], v[80:83], v[120:123], v[136:139]
s_and_b32 s70, s70, 3
ds_read_b128 v[72:75], v18 offset:36864
ds_read_b128 v[76:79], v18 offset:38912
v_mfma_f32_16x16x32_bf16 v[140:143], v[80:83], v[124:127], v[140:143]
s_and_b32 s73, s73, 12
ds_read_b64_tr_b16 v[36:37], v9 offset:32768
ds_read_b64_tr_b16 v[38:39], v9 offset:33792
v_mfma_f32_16x16x32_bf16 v[156:159], v[84:87], v[124:127], v[156:159]
s_or_b32 s73, s73, s70
ds_read_b64_tr_b16 v[40:41], v10 offset:32768
v_cvt_pk_bf16_f32 v22, v22, v30
v_mfma_f32_16x16x32_bf16 v[152:155], v[84:87], v[120:123], v[152:155]
s_lshl_b32 s71, s73, 19
ds_read_b64_tr_b16 v[42:43], v10 offset:33792
v_cvt_pk_bf16_f32 v23, v23, v31
v_mfma_f32_16x16x32_bf16 v[148:151], v[84:87], v[116:119], v[148:151]
s_add_u32 s71, s71, s66
ds_read_b64_tr_b16 v[44:45], v11 offset:32768
v_mfma_f32_16x16x32_bf16 v[144:147], v[84:87], v[112:115], v[144:147]
s_lshl_b32 s73, s73, 7
ds_read_b64_tr_b16 v[46:47], v11 offset:33792
v_accvgpr_read_b32 v24, a144
v_mfma_f32_16x16x32_bf16 v[160:163], v[88:91], v[112:115], v[160:163]
s_add_u32 s69, s73, s67
ds_read_b64_tr_b16 v[48:49], v12 offset:32768
v_accvgpr_read_b32 v28, a145
v_mfma_f32_16x16x32_bf16 v[164:167], v[88:91], v[116:119], v[164:167]
s_add_u32 s70, s73, s68
ds_read_b64_tr_b16 v[50:51], v12 offset:33792
v_accvgpr_read_b32 v25, a146
v_mfma_f32_16x16x32_bf16 v[168:171], v[88:91], v[120:123], v[168:171]
s_add_u32 m0, s64, 16384
ds_read_b64_tr_b16 v[52:53], v13 offset:32768
v_accvgpr_read_b32 v29, a147
v_mfma_f32_16x16x32_bf16 v[172:175], v[88:91], v[124:127], v[172:175]
s_add_u32 s72, s71, 0
buffer_load_dwordx4 v6, s[12:15], s72 offen lds
v_mfma_f32_16x16x32_bf16 v[188:191], v[92:95], v[124:127], v[188:191]
s_add_u32 s72, s71, 31744
buffer_load_dwordx4 v6, s[12:15], s72 offen offset:1024 lds
v_mfma_f32_16x16x32_bf16 v[184:187], v[92:95], v[120:123], v[184:187]
s_add_u32 s72, s71, 63488
buffer_load_dwordx4 v7, s[12:15], s72 offen offset:2048 lds
v_mfma_f32_16x16x32_bf16 v[180:183], v[92:95], v[116:119], v[180:183]
s_add_u32 s72, s71, 95232
buffer_load_dwordx4 v7, s[12:15], s72 offen offset:3072 lds
v_mfma_f32_16x16x32_bf16 v[176:179], v[92:95], v[112:115], v[176:179]
s_add_u32 s80, s77, 32768
ds_read_b64_tr_b16 v[54:55], v13 offset:33792
v_accvgpr_read_b32 v26, a148
v_mfma_f32_16x16x32_bf16 v[192:195], v[96:99], v[112:115], v[192:195]
ds_read_b64_tr_b16 v[56:57], v14 offset:32768
v_accvgpr_read_b32 v30, a149
v_mfma_f32_16x16x32_bf16 v[196:199], v[96:99], v[116:119], v[196:199]
ds_read_b64_tr_b16 v[58:59], v14 offset:33792
v_accvgpr_read_b32 v27, a150
v_mfma_f32_16x16x32_bf16 v[200:203], v[96:99], v[120:123], v[200:203]
ds_read_b64_tr_b16 v[60:61], v15 offset:32768
v_accvgpr_read_b32 v31, a151
v_mfma_f32_16x16x32_bf16 v[204:207], v[96:99], v[124:127], v[204:207]
s_add_u32 m0, s63, 65536
ds_read_b64_tr_b16 v[62:63], v15 offset:33792
v_cvt_pk_bf16_f32 v24, v24, v28
v_mfma_f32_16x16x32_bf16 v[220:223], v[100:103], v[124:127], v[220:223]
s_add_u32 s72, s69, 0
buffer_load_dwordx4 v4, s[4:7], s72 offen lds
v_mfma_f32_16x16x32_bf16 v[216:219], v[100:103], v[120:123], v[216:219]
buffer_store_dwordx4 v[20:23], v1, s[44:47], s80 offen sc1
v_mfma_f32_16x16x32_bf16 v[212:215], v[100:103], v[116:119], v[212:215]
v_cvt_pk_bf16_f32 v25, v25, v29
v_cvt_pk_bf16_f32 v26, v26, v30
v_mfma_f32_16x16x32_bf16 v[208:211], v[100:103], v[112:115], v[208:211]
v_cvt_pk_bf16_f32 v27, v27, v31
v_mfma_f32_16x16x32_bf16 v[224:227], v[104:107], v[112:115], v[224:227]
s_add_u32 s72, s69, 15360
buffer_load_dwordx4 v5, s[4:7], s72 offen offset:1024 lds
v_mfma_f32_16x16x32_bf16 v[228:231], v[104:107], v[116:119], v[228:231]
s_add_u32 s80, s78, 32768
buffer_store_dwordx4 v[24:27], v1, s[44:47], s80 offen sc1
v_mfma_f32_16x16x32_bf16 v[232:235], v[104:107], v[120:123], v[232:235]
v_mfma_f32_16x16x32_bf16 v[236:239], v[104:107], v[124:127], v[236:239]
v_mfma_f32_16x16x32_bf16 v[252:255], v[108:111], v[124:127], v[252:255]
v_accvgpr_read_b32 v20, a20
v_accvgpr_read_b32 v28, a21
v_mfma_f32_16x16x32_bf16 v[248:251], v[108:111], v[120:123], v[248:251]
s_add_u32 s72, s69, 129024
buffer_load_dwordx4 v4, s[4:7], s72 offen offset:2048 lds
v_mfma_f32_16x16x32_bf16 v[244:247], v[108:111], v[116:119], v[244:247]
v_accvgpr_read_b32 v21, a22
v_accvgpr_read_b32 v29, a23
v_mfma_f32_16x16x32_bf16 v[240:243], v[108:111], v[112:115], v[240:243]
s_waitcnt lgkmcnt(0)
v_accvgpr_read_b32 v22, a52
v_accvgpr_read_b32 v30, a53
v_mfma_f32_16x16x32_bf16 v[128:131], v[32:35], v[64:67], v[128:131]
ds_read_b64_tr_b16 v[80:81], v8 offset:40960
ds_read_b64_tr_b16 v[82:83], v8 offset:41984
v_mfma_f32_16x16x32_bf16 v[132:135], v[32:35], v[68:71], v[132:135]
ds_read_b128 v[112:115], v19 offset:32768
ds_read_b128 v[116:119], v19 offset:34816
v_mfma_f32_16x16x32_bf16 v[136:139], v[32:35], v[72:75], v[136:139]
s_add_u32 s72, s69, 144384
buffer_load_dwordx4 v5, s[4:7], s72 offen offset:3072 lds
v_mfma_f32_16x16x32_bf16 v[140:143], v[32:35], v[76:79], v[140:143]
ds_read_b128 v[120:123], v19 offset:36864
ds_read_b128 v[124:127], v19 offset:38912
v_mfma_f32_16x16x32_bf16 v[156:159], v[36:39], v[76:79], v[156:159]
ds_read_b64_tr_b16 v[84:85], v9 offset:40960
ds_read_b64_tr_b16 v[86:87], v9 offset:41984
v_mfma_f32_16x16x32_bf16 v[152:155], v[36:39], v[72:75], v[152:155]
ds_read_b64_tr_b16 v[88:89], v10 offset:40960
v_accvgpr_read_b32 v23, a54
v_mfma_f32_16x16x32_bf16 v[148:151], v[36:39], v[68:71], v[148:151]
ds_read_b64_tr_b16 v[90:91], v10 offset:41984
v_accvgpr_read_b32 v31, a55
v_mfma_f32_16x16x32_bf16 v[144:147], v[36:39], v[64:67], v[144:147]
s_add_u32 m0, s63, 69632
ds_read_b64_tr_b16 v[92:93], v11 offset:40960
v_mul_f32 v20, s79, v20
v_mfma_f32_16x16x32_bf16 v[160:163], v[40:43], v[64:67], v[160:163]
s_add_u32 s72, s70, 0
buffer_load_dwordx4 v4, s[4:7], s72 offen lds
v_mfma_f32_16x16x32_bf16 v[164:167], v[40:43], v[68:71], v[164:167]
ds_read_b64_tr_b16 v[94:95], v11 offset:41984
v_mul_f32 v28, s79, v28
v_mfma_f32_16x16x32_bf16 v[168:171], v[40:43], v[72:75], v[168:171]
ds_read_b64_tr_b16 v[96:97], v12 offset:40960
v_mul_f32 v21, s79, v21
v_mfma_f32_16x16x32_bf16 v[172:175], v[40:43], v[76:79], v[172:175]
ds_read_b64_tr_b16 v[98:99], v12 offset:41984
v_mul_f32 v29, s79, v29
v_mfma_f32_16x16x32_bf16 v[188:191], v[44:47], v[76:79], v[188:191]
s_add_u32 s72, s70, 15360
buffer_load_dwordx4 v5, s[4:7], s72 offen offset:1024 lds
v_mfma_f32_16x16x32_bf16 v[184:187], v[44:47], v[72:75], v[184:187]
ds_read_b64_tr_b16 v[100:101], v13 offset:40960
v_mul_f32 v22, s79, v22
v_mfma_f32_16x16x32_bf16 v[180:183], v[44:47], v[68:71], v[180:183]
ds_read_b64_tr_b16 v[102:103], v13 offset:41984
v_mul_f32 v30, s79, v30
v_mfma_f32_16x16x32_bf16 v[176:179], v[44:47], v[64:67], v[176:179]
ds_read_b64_tr_b16 v[104:105], v14 offset:40960
v_mul_f32 v23, s79, v23
v_mfma_f32_16x16x32_bf16 v[192:195], v[48:51], v[64:67], v[192:195]
ds_read_b64_tr_b16 v[106:107], v14 offset:41984
v_mul_f32 v31, s79, v31
v_mfma_f32_16x16x32_bf16 v[196:199], v[48:51], v[68:71], v[196:199]
s_add_u32 s72, s70, 129024
buffer_load_dwordx4 v4, s[4:7], s72 offen offset:2048 lds
v_mfma_f32_16x16x32_bf16 v[200:203], v[48:51], v[72:75], v[200:203]
ds_read_b64_tr_b16 v[108:109], v15 offset:40960
v_cvt_pk_bf16_f32 v20, v20, v28
v_mfma_f32_16x16x32_bf16 v[204:207], v[48:51], v[76:79], v[204:207]
ds_read_b64_tr_b16 v[110:111], v15 offset:41984
v_cvt_pk_bf16_f32 v21, v21, v29
v_mfma_f32_16x16x32_bf16 v[220:223], v[52:55], v[76:79], v[220:223]
v_cvt_pk_bf16_f32 v22, v22, v30
v_cvt_pk_bf16_f32 v23, v23, v31
v_mfma_f32_16x16x32_bf16 v[216:219], v[52:55], v[72:75], v[216:219]
s_add_u32 s80, s77, 36864
buffer_store_dwordx4 v[20:23], v1, s[44:47], s80 offen sc1
v_mfma_f32_16x16x32_bf16 v[212:215], v[52:55], v[68:71], v[212:215]
s_add_u32 s72, s70, 144384
buffer_load_dwordx4 v5, s[4:7], s72 offen offset:3072 lds
v_mfma_f32_16x16x32_bf16 v[208:211], v[52:55], v[64:67], v[208:211]
v_accvgpr_read_b32 v24, a152
v_accvgpr_read_b32 v28, a153
v_mfma_f32_16x16x32_bf16 v[224:227], v[56:59], v[64:67], v[224:227]
v_accvgpr_read_b32 v25, a154
v_accvgpr_read_b32 v29, a155
v_mfma_f32_16x16x32_bf16 v[228:231], v[56:59], v[68:71], v[228:231]
v_accvgpr_read_b32 v26, a156
v_accvgpr_read_b32 v30, a157
v_mfma_f32_16x16x32_bf16 v[232:235], v[56:59], v[72:75], v[232:235]
v_accvgpr_read_b32 v27, a158
v_accvgpr_read_b32 v31, a159
v_mfma_f32_16x16x32_bf16 v[236:239], v[56:59], v[76:79], v[236:239]
v_cvt_pk_bf16_f32 v24, v24, v28
v_cvt_pk_bf16_f32 v25, v25, v29
v_mfma_f32_16x16x32_bf16 v[252:255], v[60:63], v[76:79], v[252:255]
v_cvt_pk_bf16_f32 v26, v26, v30
v_cvt_pk_bf16_f32 v27, v27, v31
v_mfma_f32_16x16x32_bf16 v[248:251], v[60:63], v[72:75], v[248:251]
s_add_u32 s80, s78, 40960
buffer_store_dwordx4 v[24:27], v1, s[44:47], s80 offen sc1
v_mfma_f32_16x16x32_bf16 v[244:247], v[60:63], v[68:71], v[244:247]
s_waitcnt vmcnt(16) lgkmcnt(0)
v_mfma_f32_16x16x32_bf16 v[240:243], v[60:63], v[64:67], v[240:243]
s_barrier
v_mfma_f32_16x16x32_bf16 v[128:131], v[80:83], v[112:115], v[128:131]
s_add_u32 s73, s62, 5
ds_read_b64_tr_b16 v[32:33], v8 offset:0
ds_read_b64_tr_b16 v[34:35], v8 offset:1024
v_mfma_f32_16x16x32_bf16 v[132:135], v[80:83], v[116:119], v[132:135]
s_add_u32 s70, s73, s65
ds_read_b128 v[64:67], v16 offset:0
ds_read_b128 v[68:71], v16 offset:2048
v_mfma_f32_16x16x32_bf16 v[136:139], v[80:83], v[120:123], v[136:139]
s_and_b32 s70, s70, 3
ds_read_b128 v[72:75], v16 offset:4096
ds_read_b128 v[76:79], v16 offset:6144
v_mfma_f32_16x16x32_bf16 v[140:143], v[80:83], v[124:127], v[140:143]
s_and_b32 s73, s73, 12
ds_read_b64_tr_b16 v[36:37], v9 offset:0
ds_read_b64_tr_b16 v[38:39], v9 offset:1024
v_mfma_f32_16x16x32_bf16 v[156:159], v[84:87], v[124:127], v[156:159]
s_or_b32 s73, s73, s70
ds_read_b64_tr_b16 v[40:41], v10 offset:0
v_accvgpr_read_b32 v20, a24
v_mfma_f32_16x16x32_bf16 v[152:155], v[84:87], v[120:123], v[152:155]
s_lshl_b32 s71, s73, 19
ds_read_b64_tr_b16 v[42:43], v10 offset:1024
v_accvgpr_read_b32 v28, a25
v_mfma_f32_16x16x32_bf16 v[148:151], v[84:87], v[116:119], v[148:151]
s_add_u32 s71, s71, s66
ds_read_b64_tr_b16 v[44:45], v11 offset:0
v_accvgpr_read_b32 v21, a26
v_mfma_f32_16x16x32_bf16 v[144:147], v[84:87], v[112:115], v[144:147]
s_lshl_b32 s73, s73, 7
ds_read_b64_tr_b16 v[46:47], v11 offset:1024
v_accvgpr_read_b32 v29, a27
v_mfma_f32_16x16x32_bf16 v[160:163], v[88:91], v[112:115], v[160:163]
s_add_u32 s69, s73, s67
ds_read_b64_tr_b16 v[48:49], v12 offset:0
v_accvgpr_read_b32 v22, a56
v_mfma_f32_16x16x32_bf16 v[164:167], v[88:91], v[116:119], v[164:167]
s_add_u32 s70, s73, s68
ds_read_b64_tr_b16 v[50:51], v12 offset:1024
v_accvgpr_read_b32 v30, a57
v_mfma_f32_16x16x32_bf16 v[168:171], v[88:91], v[120:123], v[168:171]
s_add_u32 m0, s64, 32768
ds_read_b64_tr_b16 v[52:53], v13 offset:0
v_accvgpr_read_b32 v23, a58
v_mfma_f32_16x16x32_bf16 v[172:175], v[88:91], v[124:127], v[172:175]
s_add_u32 s72, s71, 0
buffer_load_dwordx4 v6, s[12:15], s72 offen lds
v_mfma_f32_16x16x32_bf16 v[188:191], v[92:95], v[124:127], v[188:191]
s_add_u32 s72, s71, 31744
buffer_load_dwordx4 v6, s[12:15], s72 offen offset:1024 lds
v_mfma_f32_16x16x32_bf16 v[184:187], v[92:95], v[120:123], v[184:187]
s_add_u32 s72, s71, 63488
buffer_load_dwordx4 v7, s[12:15], s72 offen offset:2048 lds
v_mfma_f32_16x16x32_bf16 v[180:183], v[92:95], v[116:119], v[180:183]
s_add_u32 s72, s71, 95232
buffer_load_dwordx4 v7, s[12:15], s72 offen offset:3072 lds
v_mfma_f32_16x16x32_bf16 v[176:179], v[92:95], v[112:115], v[176:179]
ds_read_b64_tr_b16 v[54:55], v13 offset:1024
v_accvgpr_read_b32 v31, a59
v_mfma_f32_16x16x32_bf16 v[192:195], v[96:99], v[112:115], v[192:195]
ds_read_b64_tr_b16 v[56:57], v14 offset:0
v_mul_f32 v20, s79, v20
v_mfma_f32_16x16x32_bf16 v[196:199], v[96:99], v[116:119], v[196:199]
ds_read_b64_tr_b16 v[58:59], v14 offset:1024
v_mul_f32 v28, s79, v28
v_mfma_f32_16x16x32_bf16 v[200:203], v[96:99], v[120:123], v[200:203]
ds_read_b64_tr_b16 v[60:61], v15 offset:0
v_mul_f32 v21, s79, v21
v_mfma_f32_16x16x32_bf16 v[204:207], v[96:99], v[124:127], v[204:207]
s_add_u32 m0, s63, 98304
ds_read_b64_tr_b16 v[62:63], v15 offset:1024
v_mul_f32 v29, s79, v29
v_mfma_f32_16x16x32_bf16 v[220:223], v[100:103], v[124:127], v[220:223]
s_add_u32 s72, s69, 0
buffer_load_dwordx4 v4, s[4:7], s72 offen lds
v_mfma_f32_16x16x32_bf16 v[216:219], v[100:103], v[120:123], v[216:219]
v_mul_f32 v22, s79, v22
v_mul_f32 v30, s79, v30
v_mfma_f32_16x16x32_bf16 v[212:215], v[100:103], v[116:119], v[212:215]
v_mul_f32 v23, s79, v23
v_mul_f32 v31, s79, v31
v_mfma_f32_16x16x32_bf16 v[208:211], v[100:103], v[112:115], v[208:211]
v_cvt_pk_bf16_f32 v20, v20, v28
v_cvt_pk_bf16_f32 v21, v21, v29
v_mfma_f32_16x16x32_bf16 v[224:227], v[104:107], v[112:115], v[224:227]
s_add_u32 s72, s69, 15360
buffer_load_dwordx4 v5, s[4:7], s72 offen offset:1024 lds
v_mfma_f32_16x16x32_bf16 v[228:231], v[104:107], v[116:119], v[228:231]
v_cvt_pk_bf16_f32 v22, v22, v30
v_cvt_pk_bf16_f32 v23, v23, v31
v_mfma_f32_16x16x32_bf16 v[232:235], v[104:107], v[120:123], v[232:235]
s_add_u32 s80, s77, 40960
buffer_store_dwordx4 v[20:23], v1, s[44:47], s80 offen sc1
v_mfma_f32_16x16x32_bf16 v[236:239], v[104:107], v[124:127], v[236:239]
v_accvgpr_read_b32 v24, a160
v_accvgpr_read_b32 v28, a161
v_mfma_f32_16x16x32_bf16 v[252:255], v[108:111], v[124:127], v[252:255]
v_accvgpr_read_b32 v25, a162
v_accvgpr_read_b32 v29, a163
v_mfma_f32_16x16x32_bf16 v[248:251], v[108:111], v[120:123], v[248:251]
s_add_u32 s72, s69, 129024
buffer_load_dwordx4 v4, s[4:7], s72 offen offset:2048 lds
v_mfma_f32_16x16x32_bf16 v[244:247], v[108:111], v[116:119], v[244:247]
v_accvgpr_read_b32 v26, a164
v_accvgpr_read_b32 v30, a165
v_mfma_f32_16x16x32_bf16 v[240:243], v[108:111], v[112:115], v[240:243]
s_waitcnt lgkmcnt(0)
v_accvgpr_read_b32 v27, a166
v_accvgpr_read_b32 v31, a167
v_mfma_f32_16x16x32_bf16 v[128:131], v[32:35], v[64:67], v[128:131]
ds_read_b64_tr_b16 v[80:81], v8 offset:8192
ds_read_b64_tr_b16 v[82:83], v8 offset:9216
v_mfma_f32_16x16x32_bf16 v[132:135], v[32:35], v[68:71], v[132:135]
ds_read_b128 v[112:115], v17 offset:0
ds_read_b128 v[116:119], v17 offset:2048
v_mfma_f32_16x16x32_bf16 v[136:139], v[32:35], v[72:75], v[136:139]
s_add_u32 s72, s69, 144384
buffer_load_dwordx4 v5, s[4:7], s72 offen offset:3072 lds
v_mfma_f32_16x16x32_bf16 v[140:143], v[32:35], v[76:79], v[140:143]
ds_read_b128 v[120:123], v17 offset:4096
ds_read_b128 v[124:127], v17 offset:6144
v_mfma_f32_16x16x32_bf16 v[156:159], v[36:39], v[76:79], v[156:159]
ds_read_b64_tr_b16 v[84:85], v9 offset:8192
ds_read_b64_tr_b16 v[86:87], v9 offset:9216
v_mfma_f32_16x16x32_bf16 v[152:155], v[36:39], v[72:75], v[152:155]
ds_read_b64_tr_b16 v[88:89], v10 offset:8192
v_cvt_pk_bf16_f32 v24, v24, v28
v_mfma_f32_16x16x32_bf16 v[148:151], v[36:39], v[68:71], v[148:151]
ds_read_b64_tr_b16 v[90:91], v10 offset:9216
v_cvt_pk_bf16_f32 v25, v25, v29
v_mfma_f32_16x16x32_bf16 v[144:147], v[36:39], v[64:67], v[144:147]
s_add_u32 m0, s63, 102400
ds_read_b64_tr_b16 v[92:93], v11 offset:8192
v_cvt_pk_bf16_f32 v26, v26, v30
v_mfma_f32_16x16x32_bf16 v[160:163], v[40:43], v[64:67], v[160:163]
s_add_u32 s72, s70, 0
buffer_load_dwordx4 v4, s[4:7], s72 offen lds
v_mfma_f32_16x16x32_bf16 v[164:167], v[40:43], v[68:71], v[164:167]
ds_read_b64_tr_b16 v[94:95], v11 offset:9216
v_cvt_pk_bf16_f32 v27, v27, v31
v_mfma_f32_16x16x32_bf16 v[168:171], v[40:43], v[72:75], v[168:171]
s_add_u32 s80, s78, 1024
ds_read_b64_tr_b16 v[96:97], v12 offset:8192
v_mfma_f32_16x16x32_bf16 v[172:175], v[40:43], v[76:79], v[172:175]
ds_read_b64_tr_b16 v[98:99], v12 offset:9216
v_mfma_f32_16x16x32_bf16 v[188:191], v[44:47], v[76:79], v[188:191]
s_add_u32 s72, s70, 15360
buffer_load_dwordx4 v5, s[4:7], s72 offen offset:1024 lds
v_mfma_f32_16x16x32_bf16 v[184:187], v[44:47], v[72:75], v[184:187]
ds_read_b64_tr_b16 v[100:101], v13 offset:8192
v_accvgpr_read_b32 v20, a28
v_mfma_f32_16x16x32_bf16 v[180:183], v[44:47], v[68:71], v[180:183]
ds_read_b64_tr_b16 v[102:103], v13 offset:9216
v_accvgpr_read_b32 v28, a29
v_mfma_f32_16x16x32_bf16 v[176:179], v[44:47], v[64:67], v[176:179]
ds_read_b64_tr_b16 v[104:105], v14 offset:8192
v_accvgpr_read_b32 v21, a30
v_mfma_f32_16x16x32_bf16 v[192:195], v[48:51], v[64:67], v[192:195]
ds_read_b64_tr_b16 v[106:107], v14 offset:9216
v_accvgpr_read_b32 v29, a31
v_mfma_f32_16x16x32_bf16 v[196:199], v[48:51], v[68:71], v[196:199]
s_add_u32 s72, s70, 129024
buffer_load_dwordx4 v4, s[4:7], s72 offen offset:2048 lds
v_mfma_f32_16x16x32_bf16 v[200:203], v[48:51], v[72:75], v[200:203]
ds_read_b64_tr_b16 v[108:109], v15 offset:8192
v_accvgpr_read_b32 v22, a60
v_mfma_f32_16x16x32_bf16 v[204:207], v[48:51], v[76:79], v[204:207]
ds_read_b64_tr_b16 v[110:111], v15 offset:9216
v_accvgpr_read_b32 v30, a61
v_mfma_f32_16x16x32_bf16 v[220:223], v[52:55], v[76:79], v[220:223]
buffer_store_dwordx4 v[24:27], v1, s[44:47], s80 offen sc1
v_mfma_f32_16x16x32_bf16 v[216:219], v[52:55], v[72:75], v[216:219]
v_accvgpr_read_b32 v23, a62
v_accvgpr_read_b32 v31, a63
v_mfma_f32_16x16x32_bf16 v[212:215], v[52:55], v[68:71], v[212:215]
s_add_u32 s72, s70, 144384
buffer_load_dwordx4 v5, s[4:7], s72 offen offset:3072 lds
v_mfma_f32_16x16x32_bf16 v[208:211], v[52:55], v[64:67], v[208:211]
v_mul_f32 v20, s79, v20
v_mul_f32 v28, s79, v28
v_mfma_f32_16x16x32_bf16 v[224:227], v[56:59], v[64:67], v[224:227]
v_mul_f32 v21, s79, v21
v_mul_f32 v29, s79, v29
v_mfma_f32_16x16x32_bf16 v[228:231], v[56:59], v[68:71], v[228:231]
v_mul_f32 v22, s79, v22
v_mul_f32 v30, s79, v30
v_mfma_f32_16x16x32_bf16 v[232:235], v[56:59], v[72:75], v[232:235]
v_mul_f32 v23, s79, v23
v_mul_f32 v31, s79, v31
v_mfma_f32_16x16x32_bf16 v[236:239], v[56:59], v[76:79], v[236:239]
v_cvt_pk_bf16_f32 v20, v20, v28
v_cvt_pk_bf16_f32 v21, v21, v29
v_mfma_f32_16x16x32_bf16 v[252:255], v[60:63], v[76:79], v[252:255]
v_cvt_pk_bf16_f32 v22, v22, v30
v_cvt_pk_bf16_f32 v23, v23, v31
v_mfma_f32_16x16x32_bf16 v[248:251], v[60:63], v[72:75], v[248:251]
s_add_u32 s80, s77, 45056
buffer_store_dwordx4 v[20:23], v1, s[44:47], s80 offen sc1
v_mfma_f32_16x16x32_bf16 v[244:247], v[60:63], v[68:71], v[244:247]
s_waitcnt vmcnt(16) lgkmcnt(0)
v_mfma_f32_16x16x32_bf16 v[240:243], v[60:63], v[64:67], v[240:243]
s_barrier
v_mfma_f32_16x16x32_bf16 v[128:131], v[80:83], v[112:115], v[128:131]
s_add_u32 s73, s62, 6
ds_read_b64_tr_b16 v[32:33], v8 offset:16384
ds_read_b64_tr_b16 v[34:35], v8 offset:17408
v_mfma_f32_16x16x32_bf16 v[132:135], v[80:83], v[116:119], v[132:135]
s_add_u32 s70, s73, s65
ds_read_b128 v[64:67], v18 offset:0
ds_read_b128 v[68:71], v18 offset:2048
v_mfma_f32_16x16x32_bf16 v[136:139], v[80:83], v[120:123], v[136:139]
s_and_b32 s70, s70, 3
ds_read_b128 v[72:75], v18 offset:4096
ds_read_b128 v[76:79], v18 offset:6144
v_mfma_f32_16x16x32_bf16 v[140:143], v[80:83], v[124:127], v[140:143]
s_and_b32 s73, s73, 12
ds_read_b64_tr_b16 v[36:37], v9 offset:16384
ds_read_b64_tr_b16 v[38:39], v9 offset:17408
v_mfma_f32_16x16x32_bf16 v[156:159], v[84:87], v[124:127], v[156:159]
s_or_b32 s73, s73, s70
ds_read_b64_tr_b16 v[40:41], v10 offset:16384
v_accvgpr_read_b32 v24, a168
v_mfma_f32_16x16x32_bf16 v[152:155], v[84:87], v[120:123], v[152:155]
s_lshl_b32 s71, s73, 19
ds_read_b64_tr_b16 v[42:43], v10 offset:17408
v_accvgpr_read_b32 v28, a169
v_mfma_f32_16x16x32_bf16 v[148:151], v[84:87], v[116:119], v[148:151]
s_add_u32 s71, s71, s66
ds_read_b64_tr_b16 v[44:45], v11 offset:16384
v_accvgpr_read_b32 v25, a170
v_mfma_f32_16x16x32_bf16 v[144:147], v[84:87], v[112:115], v[144:147]
s_lshl_b32 s73, s73, 7
ds_read_b64_tr_b16 v[46:47], v11 offset:17408
v_accvgpr_read_b32 v29, a171
v_mfma_f32_16x16x32_bf16 v[160:163], v[88:91], v[112:115], v[160:163]
s_add_u32 s69, s73, s67
ds_read_b64_tr_b16 v[48:49], v12 offset:16384
v_accvgpr_read_b32 v26, a172
v_mfma_f32_16x16x32_bf16 v[164:167], v[88:91], v[116:119], v[164:167]
s_add_u32 s70, s73, s68
ds_read_b64_tr_b16 v[50:51], v12 offset:17408
v_accvgpr_read_b32 v30, a173
v_mfma_f32_16x16x32_bf16 v[168:171], v[88:91], v[120:123], v[168:171]
s_add_u32 m0, s64, 0
ds_read_b64_tr_b16 v[52:53], v13 offset:16384
v_accvgpr_read_b32 v27, a174
v_mfma_f32_16x16x32_bf16 v[172:175], v[88:91], v[124:127], v[172:175]
s_add_u32 s72, s71, 0
buffer_load_dwordx4 v6, s[12:15], s72 offen lds
v_mfma_f32_16x16x32_bf16 v[188:191], v[92:95], v[124:127], v[188:191]
s_add_u32 s72, s71, 31744
buffer_load_dwordx4 v6, s[12:15], s72 offen offset:1024 lds
v_mfma_f32_16x16x32_bf16 v[184:187], v[92:95], v[120:123], v[184:187]
s_add_u32 s72, s71, 63488
buffer_load_dwordx4 v7, s[12:15], s72 offen offset:2048 lds
v_mfma_f32_16x16x32_bf16 v[180:183], v[92:95], v[116:119], v[180:183]
s_add_u32 s72, s71, 95232
buffer_load_dwordx4 v7, s[12:15], s72 offen offset:3072 lds
v_mfma_f32_16x16x32_bf16 v[176:179], v[92:95], v[112:115], v[176:179]
ds_read_b64_tr_b16 v[54:55], v13 offset:17408
v_accvgpr_read_b32 v31, a175
v_mfma_f32_16x16x32_bf16 v[192:195], v[96:99], v[112:115], v[192:195]
ds_read_b64_tr_b16 v[56:57], v14 offset:16384
v_cvt_pk_bf16_f32 v24, v24, v28
v_mfma_f32_16x16x32_bf16 v[196:199], v[96:99], v[116:119], v[196:199]
ds_read_b64_tr_b16 v[58:59], v14 offset:17408
v_cvt_pk_bf16_f32 v25, v25, v29
v_mfma_f32_16x16x32_bf16 v[200:203], v[96:99], v[120:123], v[200:203]
ds_read_b64_tr_b16 v[60:61], v15 offset:16384
v_cvt_pk_bf16_f32 v26, v26, v30
v_mfma_f32_16x16x32_bf16 v[204:207], v[96:99], v[124:127], v[204:207]
s_add_u32 m0, s63, 131072
ds_read_b64_tr_b16 v[62:63], v15 offset:17408
v_cvt_pk_bf16_f32 v27, v27, v31
v_mfma_f32_16x16x32_bf16 v[220:223], v[100:103], v[124:127], v[220:223]
s_add_u32 s72, s69, 0
buffer_load_dwordx4 v4, s[4:7], s72 offen lds
v_mfma_f32_16x16x32_bf16 v[216:219], v[100:103], v[120:123], v[216:219]
s_add_u32 s80, s78, 9216
buffer_store_dwordx4 v[24:27], v1, s[44:47], s80 offen sc1
v_mfma_f32_16x16x32_bf16 v[212:215], v[100:103], v[116:119], v[212:215]
v_accvgpr_read_b32 v20, a64
v_accvgpr_read_b32 v28, a65
v_mfma_f32_16x16x32_bf16 v[208:211], v[100:103], v[112:115], v[208:211]
v_accvgpr_read_b32 v21, a66
v_accvgpr_read_b32 v29, a67
v_mfma_f32_16x16x32_bf16 v[224:227], v[104:107], v[112:115], v[224:227]
s_add_u32 s72, s69, 15360
buffer_load_dwordx4 v5, s[4:7], s72 offen offset:1024 lds
v_mfma_f32_16x16x32_bf16 v[228:231], v[104:107], v[116:119], v[228:231]
v_accvgpr_read_b32 v22, a96
v_accvgpr_read_b32 v30, a97
v_mfma_f32_16x16x32_bf16 v[232:235], v[104:107], v[120:123], v[232:235]
v_accvgpr_read_b32 v23, a98
v_accvgpr_read_b32 v31, a99
v_mfma_f32_16x16x32_bf16 v[236:239], v[104:107], v[124:127], v[236:239]
v_mul_f32 v20, s79, v20
v_mul_f32 v28, s79, v28
v_mfma_f32_16x16x32_bf16 v[252:255], v[108:111], v[124:127], v[252:255]
v_mul_f32 v21, s79, v21
v_mul_f32 v29, s79, v29
v_mfma_f32_16x16x32_bf16 v[248:251], v[108:111], v[120:123], v[248:251]
s_add_u32 s72, s69, 129024
buffer_load_dwordx4 v4, s[4:7], s72 offen offset:2048 lds
v_mfma_f32_16x16x32_bf16 v[244:247], v[108:111], v[116:119], v[244:247]
v_mul_f32 v22, s79, v22
v_mul_f32 v30, s79, v30
v_mfma_f32_16x16x32_bf16 v[240:243], v[108:111], v[112:115], v[240:243]
s_waitcnt lgkmcnt(0)
v_mul_f32 v23, s79, v23
v_mul_f32 v31, s79, v31
v_mfma_f32_16x16x32_bf16 v[128:131], v[32:35], v[64:67], v[128:131]
ds_read_b64_tr_b16 v[80:81], v8 offset:24576
ds_read_b64_tr_b16 v[82:83], v8 offset:25600
v_mfma_f32_16x16x32_bf16 v[132:135], v[32:35], v[68:71], v[132:135]
ds_read_b128 v[112:115], v19 offset:0
ds_read_b128 v[116:119], v19 offset:2048
v_mfma_f32_16x16x32_bf16 v[136:139], v[32:35], v[72:75], v[136:139]
s_add_u32 s72, s69, 144384
buffer_load_dwordx4 v5, s[4:7], s72 offen offset:3072 lds
v_mfma_f32_16x16x32_bf16 v[140:143], v[32:35], v[76:79], v[140:143]
ds_read_b128 v[120:123], v19 offset:4096
ds_read_b128 v[124:127], v19 offset:6144
v_mfma_f32_16x16x32_bf16 v[156:159], v[36:39], v[76:79], v[156:159]
ds_read_b64_tr_b16 v[84:85], v9 offset:24576
ds_read_b64_tr_b16 v[86:87], v9 offset:25600
v_mfma_f32_16x16x32_bf16 v[152:155], v[36:39], v[72:75], v[152:155]
ds_read_b64_tr_b16 v[88:89], v10 offset:24576
v_cvt_pk_bf16_f32 v20, v20, v28
v_mfma_f32_16x16x32_bf16 v[148:151], v[36:39], v[68:71], v[148:151]
ds_read_b64_tr_b16 v[90:91], v10 offset:25600
v_cvt_pk_bf16_f32 v21, v21, v29
v_mfma_f32_16x16x32_bf16 v[144:147], v[36:39], v[64:67], v[144:147]
s_add_u32 m0, s63, 135168
ds_read_b64_tr_b16 v[92:93], v11 offset:24576
v_cvt_pk_bf16_f32 v22, v22, v30
v_mfma_f32_16x16x32_bf16 v[160:163], v[40:43], v[64:67], v[160:163]
s_add_u32 s72, s70, 0
buffer_load_dwordx4 v4, s[4:7], s72 offen lds
v_mfma_f32_16x16x32_bf16 v[164:167], v[40:43], v[68:71], v[164:167]
ds_read_b64_tr_b16 v[94:95], v11 offset:25600
v_cvt_pk_bf16_f32 v23, v23, v31
v_mfma_f32_16x16x32_bf16 v[168:171], v[40:43], v[72:75], v[168:171]
s_add_u32 s80, s77, 1024
ds_read_b64_tr_b16 v[96:97], v12 offset:24576
v_accvgpr_read_b32 v24, a176
v_mfma_f32_16x16x32_bf16 v[172:175], v[40:43], v[76:79], v[172:175]
ds_read_b64_tr_b16 v[98:99], v12 offset:25600
v_accvgpr_read_b32 v28, a177
v_mfma_f32_16x16x32_bf16 v[188:191], v[44:47], v[76:79], v[188:191]
s_add_u32 s72, s70, 15360
buffer_load_dwordx4 v5, s[4:7], s72 offen offset:1024 lds
v_mfma_f32_16x16x32_bf16 v[184:187], v[44:47], v[72:75], v[184:187]
ds_read_b64_tr_b16 v[100:101], v13 offset:24576
v_accvgpr_read_b32 v25, a178
v_mfma_f32_16x16x32_bf16 v[180:183], v[44:47], v[68:71], v[180:183]
ds_read_b64_tr_b16 v[102:103], v13 offset:25600
v_accvgpr_read_b32 v29, a179
v_mfma_f32_16x16x32_bf16 v[176:179], v[44:47], v[64:67], v[176:179]
ds_read_b64_tr_b16 v[104:105], v14 offset:24576
v_accvgpr_read_b32 v26, a180
v_mfma_f32_16x16x32_bf16 v[192:195], v[48:51], v[64:67], v[192:195]
ds_read_b64_tr_b16 v[106:107], v14 offset:25600
v_accvgpr_read_b32 v30, a181
v_mfma_f32_16x16x32_bf16 v[196:199], v[48:51], v[68:71], v[196:199]
s_add_u32 s72, s70, 129024
buffer_load_dwordx4 v4, s[4:7], s72 offen offset:2048 lds
v_mfma_f32_16x16x32_bf16 v[200:203], v[48:51], v[72:75], v[200:203]
ds_read_b64_tr_b16 v[108:109], v15 offset:24576
v_accvgpr_read_b32 v27, a182
v_mfma_f32_16x16x32_bf16 v[204:207], v[48:51], v[76:79], v[204:207]
ds_read_b64_tr_b16 v[110:111], v15 offset:25600
v_accvgpr_read_b32 v31, a183
v_mfma_f32_16x16x32_bf16 v[220:223], v[52:55], v[76:79], v[220:223]
buffer_store_dwordx4 v[20:23], v1, s[44:47], s80 offen sc1
v_mfma_f32_16x16x32_bf16 v[216:219], v[52:55], v[72:75], v[216:219]
v_cvt_pk_bf16_f32 v24, v24, v28
v_cvt_pk_bf16_f32 v25, v25, v29
v_mfma_f32_16x16x32_bf16 v[212:215], v[52:55], v[68:71], v[212:215]
s_add_u32 s72, s70, 144384
buffer_load_dwordx4 v5, s[4:7], s72 offen offset:3072 lds
v_mfma_f32_16x16x32_bf16 v[208:211], v[52:55], v[64:67], v[208:211]
v_cvt_pk_bf16_f32 v26, v26, v30
v_cvt_pk_bf16_f32 v27, v27, v31
v_mfma_f32_16x16x32_bf16 v[224:227], v[56:59], v[64:67], v[224:227]
s_add_u32 s80, s78, 33792
buffer_store_dwordx4 v[24:27], v1, s[44:47], s80 offen sc1
v_mfma_f32_16x16x32_bf16 v[228:231], v[56:59], v[68:71], v[228:231]
v_mfma_f32_16x16x32_bf16 v[232:235], v[56:59], v[72:75], v[232:235]
v_mfma_f32_16x16x32_bf16 v[236:239], v[56:59], v[76:79], v[236:239]
v_mfma_f32_16x16x32_bf16 v[252:255], v[60:63], v[76:79], v[252:255]
v_mfma_f32_16x16x32_bf16 v[248:251], v[60:63], v[72:75], v[248:251]
v_mfma_f32_16x16x32_bf16 v[244:247], v[60:63], v[68:71], v[244:247]
s_waitcnt vmcnt(16) lgkmcnt(0)
v_accvgpr_read_b32 v20, a68
v_accvgpr_read_b32 v28, a69
v_mfma_f32_16x16x32_bf16 v[240:243], v[60:63], v[64:67], v[240:243]
s_barrier
v_accvgpr_read_b32 v21, a70
v_accvgpr_read_b32 v29, a71
v_mfma_f32_16x16x32_bf16 v[128:131], v[80:83], v[112:115], v[128:131]
s_add_u32 s73, s62, 7
ds_read_b64_tr_b16 v[32:33], v8 offset:32768
ds_read_b64_tr_b16 v[34:35], v8 offset:33792
v_mfma_f32_16x16x32_bf16 v[132:135], v[80:83], v[116:119], v[132:135]
s_add_u32 s70, s73, s65
ds_read_b128 v[64:67], v18 offset:32768
ds_read_b128 v[68:71], v18 offset:34816
v_mfma_f32_16x16x32_bf16 v[136:139], v[80:83], v[120:123], v[136:139]
s_and_b32 s70, s70, 3
ds_read_b128 v[72:75], v18 offset:36864
ds_read_b128 v[76:79], v18 offset:38912
v_mfma_f32_16x16x32_bf16 v[140:143], v[80:83], v[124:127], v[140:143]
s_and_b32 s73, s73, 12
ds_read_b64_tr_b16 v[36:37], v9 offset:32768
ds_read_b64_tr_b16 v[38:39], v9 offset:33792
v_mfma_f32_16x16x32_bf16 v[156:159], v[84:87], v[124:127], v[156:159]
s_or_b32 s73, s73, s70
ds_read_b64_tr_b16 v[40:41], v10 offset:32768
v_accvgpr_read_b32 v22, a100
v_mfma_f32_16x16x32_bf16 v[152:155], v[84:87], v[120:123], v[152:155]
s_lshl_b32 s71, s73, 19
ds_read_b64_tr_b16 v[42:43], v10 offset:33792
v_accvgpr_read_b32 v30, a101
v_mfma_f32_16x16x32_bf16 v[148:151], v[84:87], v[116:119], v[148:151]
s_add_u32 s71, s71, s66
ds_read_b64_tr_b16 v[44:45], v11 offset:32768
v_accvgpr_read_b32 v23, a102
v_mfma_f32_16x16x32_bf16 v[144:147], v[84:87], v[112:115], v[144:147]
s_lshl_b32 s73, s73, 7
ds_read_b64_tr_b16 v[46:47], v11 offset:33792
v_accvgpr_read_b32 v31, a103
v_mfma_f32_16x16x32_bf16 v[160:163], v[88:91], v[112:115], v[160:163]
s_add_u32 s69, s73, s67
ds_read_b64_tr_b16 v[48:49], v12 offset:32768
v_mul_f32 v20, s79, v20
v_mfma_f32_16x16x32_bf16 v[164:167], v[88:91], v[116:119], v[164:167]
s_add_u32 s70, s73, s68
ds_read_b64_tr_b16 v[50:51], v12 offset:33792
v_mul_f32 v28, s79, v28
v_mfma_f32_16x16x32_bf16 v[168:171], v[88:91], v[120:123], v[168:171]
s_add_u32 m0, s64, 16384
ds_read_b64_tr_b16 v[52:53], v13 offset:32768
v_mul_f32 v21, s79, v21
v_mfma_f32_16x16x32_bf16 v[172:175], v[88:91], v[124:127], v[172:175]
s_add_u32 s72, s71, 0
buffer_load_dwordx4 v6, s[12:15], s72 offen lds
v_mfma_f32_16x16x32_bf16 v[188:191], v[92:95], v[124:127], v[188:191]
s_add_u32 s72, s71, 31744
buffer_load_dwordx4 v6, s[12:15], s72 offen offset:1024 lds
v_mfma_f32_16x16x32_bf16 v[184:187], v[92:95], v[120:123], v[184:187]
s_add_u32 s72, s71, 63488
buffer_load_dwordx4 v7, s[12:15], s72 offen offset:2048 lds
v_mfma_f32_16x16x32_bf16 v[180:183], v[92:95], v[116:119], v[180:183]
s_add_u32 s72, s71, 95232
buffer_load_dwordx4 v7, s[12:15], s72 offen offset:3072 lds
v_mfma_f32_16x16x32_bf16 v[176:179], v[92:95], v[112:115], v[176:179]
ds_read_b64_tr_b16 v[54:55], v13 offset:33792
v_mul_f32 v29, s79, v29
v_mfma_f32_16x16x32_bf16 v[192:195], v[96:99], v[112:115], v[192:195]
ds_read_b64_tr_b16 v[56:57], v14 offset:32768
v_mul_f32 v22, s79, v22
v_mfma_f32_16x16x32_bf16 v[196:199], v[96:99], v[116:119], v[196:199]
ds_read_b64_tr_b16 v[58:59], v14 offset:33792
v_mul_f32 v30, s79, v30
v_mfma_f32_16x16x32_bf16 v[200:203], v[96:99], v[120:123], v[200:203]
ds_read_b64_tr_b16 v[60:61], v15 offset:32768
v_mul_f32 v23, s79, v23
v_mfma_f32_16x16x32_bf16 v[204:207], v[96:99], v[124:127], v[204:207]
s_add_u32 m0, s63, 65536
ds_read_b64_tr_b16 v[62:63], v15 offset:33792
v_mul_f32 v31, s79, v31
v_mfma_f32_16x16x32_bf16 v[220:223], v[100:103], v[124:127], v[220:223]
s_add_u32 s72, s69, 0
buffer_load_dwordx4 v4, s[4:7], s72 offen lds
v_mfma_f32_16x16x32_bf16 v[216:219], v[100:103], v[120:123], v[216:219]
v_cvt_pk_bf16_f32 v20, v20, v28
v_cvt_pk_bf16_f32 v21, v21, v29
v_mfma_f32_16x16x32_bf16 v[212:215], v[100:103], v[116:119], v[212:215]
v_cvt_pk_bf16_f32 v22, v22, v30
v_cvt_pk_bf16_f32 v23, v23, v31
v_mfma_f32_16x16x32_bf16 v[208:211], v[100:103], v[112:115], v[208:211]
s_add_u32 s80, s77, 5120
buffer_store_dwordx4 v[20:23], v1, s[44:47], s80 offen sc1
v_mfma_f32_16x16x32_bf16 v[224:227], v[104:107], v[112:115], v[224:227]
s_add_u32 s72, s69, 15360
buffer_load_dwordx4 v5, s[4:7], s72 offen offset:1024 lds
v_mfma_f32_16x16x32_bf16 v[228:231], v[104:107], v[116:119], v[228:231]
v_accvgpr_read_b32 v24, a184
v_accvgpr_read_b32 v28, a185
v_mfma_f32_16x16x32_bf16 v[232:235], v[104:107], v[120:123], v[232:235]
v_accvgpr_read_b32 v25, a186
v_accvgpr_read_b32 v29, a187
v_mfma_f32_16x16x32_bf16 v[236:239], v[104:107], v[124:127], v[236:239]
v_accvgpr_read_b32 v26, a188
v_accvgpr_read_b32 v30, a189
v_mfma_f32_16x16x32_bf16 v[252:255], v[108:111], v[124:127], v[252:255]
v_accvgpr_read_b32 v27, a190
v_accvgpr_read_b32 v31, a191
v_mfma_f32_16x16x32_bf16 v[248:251], v[108:111], v[120:123], v[248:251]
s_add_u32 s72, s69, 129024
buffer_load_dwordx4 v4, s[4:7], s72 offen offset:2048 lds
v_mfma_f32_16x16x32_bf16 v[244:247], v[108:111], v[116:119], v[244:247]
v_cvt_pk_bf16_f32 v24, v24, v28
v_cvt_pk_bf16_f32 v25, v25, v29
v_mfma_f32_16x16x32_bf16 v[240:243], v[108:111], v[112:115], v[240:243]
s_waitcnt lgkmcnt(0)
v_cvt_pk_bf16_f32 v26, v26, v30
v_cvt_pk_bf16_f32 v27, v27, v31
v_mfma_f32_16x16x32_bf16 v[128:131], v[32:35], v[64:67], v[128:131]
s_lshr_b32 s75, s93, 4
ds_read_b64_tr_b16 v[80:81], v8 offset:40960
ds_read_b64_tr_b16 v[82:83], v8 offset:41984
v_mfma_f32_16x16x32_bf16 v[132:135], v[32:35], v[68:71], v[132:135]
s_and_b32 s75, s75, 0x7f00
ds_read_b128 v[112:115], v19 offset:32768
ds_read_b128 v[116:119], v19 offset:34816
v_mfma_f32_16x16x32_bf16 v[136:139], v[32:35], v[72:75], v[136:139]
s_add_u32 s72, s69, 144384
buffer_load_dwordx4 v5, s[4:7], s72 offen offset:3072 lds
v_mfma_f32_16x16x32_bf16 v[140:143], v[32:35], v[76:79], v[140:143]
s_add_u32 s75, s75, LcB1-Lpc0
v_lshrrev_b32 v2, 5, v0
v_lshlrev_b32 v2, 7, v2
v_mfma_f32_16x16x32_bf16 v[156:159], v[36:39], v[76:79], v[156:159]
s_add_u32 s80, s78, 41984
v_add_u32 v2, s75, v2
v_min_u32 v2, Lcode_end-Lpc0, v2
v_mfma_f32_16x16x32_bf16 v[152:155], v[36:39], v[72:75], v[152:155]
global_load_dword v3, v2, s[98:99]
v_mfma_f32_16x16x32_bf16 v[148:151], v[36:39], v[68:71], v[148:151]
ds_read_b128 v[120:123], v19 offset:36864
ds_read_b128 v[124:127], v19 offset:38912
v_mfma_f32_16x16x32_bf16 v[144:147], v[36:39], v[64:67], v[144:147]
s_add_u32 m0, s63, 69632
ds_read_b64_tr_b16 v[84:85], v9 offset:40960
ds_read_b64_tr_b16 v[86:87], v9 offset:41984
v_mfma_f32_16x16x32_bf16 v[160:163], v[40:43], v[64:67], v[160:163]
s_add_u32 s72, s70, 0
buffer_load_dwordx4 v4, s[4:7], s72 offen lds
v_mfma_f32_16x16x32_bf16 v[164:167], v[40:43], v[68:71], v[164:167]
ds_read_b64_tr_b16 v[88:89], v10 offset:40960
v_accvgpr_read_b32 v20, a72
v_mfma_f32_16x16x32_bf16 v[168:171], v[40:43], v[72:75], v[168:171]
ds_read_b64_tr_b16 v[90:91], v10 offset:41984
v_accvgpr_read_b32 v28, a73
v_mfma_f32_16x16x32_bf16 v[172:175], v[40:43], v[76:79], v[172:175]
ds_read_b64_tr_b16 v[92:93], v11 offset:40960
v_accvgpr_read_b32 v21, a74
v_mfma_f32_16x16x32_bf16 v[188:191], v[44:47], v[76:79], v[188:191]
s_add_u32 s72, s70, 15360
buffer_load_dwordx4 v5, s[4:7], s72 offen offset:1024 lds
v_mfma_f32_16x16x32_bf16 v[184:187], v[44:47], v[72:75], v[184:187]
ds_read_b64_tr_b16 v[94:95], v11 offset:41984
v_accvgpr_read_b32 v29, a75
v_mfma_f32_16x16x32_bf16 v[180:183], v[44:47], v[68:71], v[180:183]
ds_read_b64_tr_b16 v[96:97], v12 offset:40960
v_accvgpr_read_b32 v22, a104
v_mfma_f32_16x16x32_bf16 v[176:179], v[44:47], v[64:67], v[176:179]
ds_read_b64_tr_b16 v[98:99], v12 offset:41984
v_accvgpr_read_b32 v30, a105
v_mfma_f32_16x16x32_bf16 v[192:195], v[48:51], v[64:67], v[192:195]
ds_read_b64_tr_b16 v[100:101], v13 offset:40960
v_accvgpr_read_b32 v23, a106
v_mfma_f32_16x16x32_bf16 v[196:199], v[48:51], v[68:71], v[196:199]
s_add_u32 s72, s70, 129024
buffer_load_dwordx4 v4, s[4:7], s72 offen offset:2048 lds
v_mfma_f32_16x16x32_bf16 v[200:203], v[48:51], v[72:75], v[200:203]
ds_read_b64_tr_b16 v[102:103], v13 offset:41984
v_accvgpr_read_b32 v31, a107
v_mfma_f32_16x16x32_bf16 v[204:207], v[48:51], v[76:79], v[204:207]
ds_read_b64_tr_b16 v[104:105], v14 offset:40960
v_mul_f32 v20, s79, v20
v_mfma_f32_16x16x32_bf16 v[220:223], v[52:55], v[76:79], v[220:223]
ds_read_b64_tr_b16 v[106:107], v14 offset:41984
v_mul_f32 v28, s79, v28
v_mfma_f32_16x16x32_bf16 v[216:219], v[52:55], v[72:75], v[216:219]
ds_read_b64_tr_b16 v[108:109], v15 offset:40960
v_mul_f32 v21, s79, v21
v_mfma_f32_16x16x32_bf16 v[212:215], v[52:55], v[68:71], v[212:215]
s_add_u32 s72, s70, 144384
buffer_load_dwordx4 v5, s[4:7], s72 offen offset:3072 lds
v_mfma_f32_16x16x32_bf16 v[208:211], v[52:55], v[64:67], v[208:211]
ds_read_b64_tr_b16 v[110:111], v15 offset:41984
v_mul_f32 v29, s79, v29
v_mfma_f32_16x16x32_bf16 v[224:227], v[56:59], v[64:67], v[224:227]
buffer_store_dwordx4 v[24:27], v1, s[44:47], s80 offen sc1
v_mfma_f32_16x16x32_bf16 v[228:231], v[56:59], v[68:71], v[228:231]
v_mul_f32 v22, s79, v22
v_mul_f32 v30, s79, v30
v_mfma_f32_16x16x32_bf16 v[232:235], v[56:59], v[72:75], v[232:235]
v_mul_f32 v23, s79, v23
v_mul_f32 v31, s79, v31
v_mfma_f32_16x16x32_bf16 v[236:239], v[56:59], v[76:79], v[236:239]
v_cvt_pk_bf16_f32 v20, v20, v28
v_cvt_pk_bf16_f32 v21, v21, v29
v_mfma_f32_16x16x32_bf16 v[252:255], v[60:63], v[76:79], v[252:255]
v_cvt_pk_bf16_f32 v22, v22, v30
v_cvt_pk_bf16_f32 v23, v23, v31
v_mfma_f32_16x16x32_bf16 v[248:251], v[60:63], v[72:75], v[248:251]
s_add_u32 s80, s77, 9216
buffer_store_dwordx4 v[20:23], v1, s[44:47], s80 offen sc1
v_mfma_f32_16x16x32_bf16 v[244:247], v[60:63], v[68:71], v[244:247]
s_waitcnt vmcnt(17) lgkmcnt(0)
v_accvgpr_read_b32 v24, a192
v_accvgpr_read_b32 v28, a193
v_mfma_f32_16x16x32_bf16 v[240:243], v[60:63], v[64:67], v[240:243]
s_barrier
v_accvgpr_read_b32 v25, a194
v_accvgpr_read_b32 v29, a195
v_mfma_f32_16x16x32_bf16 v[128:131], v[80:83], v[112:115], v[128:131]
s_add_u32 s73, s62, 8
ds_read_b64_tr_b16 v[32:33], v8 offset:0
ds_read_b64_tr_b16 v[34:35], v8 offset:1024
v_mfma_f32_16x16x32_bf16 v[132:135], v[80:83], v[116:119], v[132:135]
s_add_u32 s70, s73, s65
ds_read_b128 v[64:67], v16 offset:0
ds_read_b128 v[68:71], v16 offset:2048
v_mfma_f32_16x16x32_bf16 v[136:139], v[80:83], v[120:123], v[136:139]
s_and_b32 s70, s70, 3
ds_read_b128 v[72:75], v16 offset:4096
ds_read_b128 v[76:79], v16 offset:6144
v_mfma_f32_16x16x32_bf16 v[140:143], v[80:83], v[124:127], v[140:143]
s_and_b32 s73, s73, 12
ds_read_b64_tr_b16 v[36:37], v9 offset:0
ds_read_b64_tr_b16 v[38:39], v9 offset:1024
v_mfma_f32_16x16x32_bf16 v[156:159], v[84:87], v[124:127], v[156:159]
s_or_b32 s73, s73, s70
ds_read_b64_tr_b16 v[40:41], v10 offset:0
v_accvgpr_read_b32 v26, a196
v_mfma_f32_16x16x32_bf16 v[152:155], v[84:87], v[120:123], v[152:155]
s_lshl_b32 s71, s73, 19
ds_read_b64_tr_b16 v[42:43], v10 offset:1024
v_accvgpr_read_b32 v30, a197
v_mfma_f32_16x16x32_bf16 v[148:151], v[84:87], v[116:119], v[148:151]
s_add_u32 s71, s71, s66
ds_read_b64_tr_b16 v[44:45], v11 offset:0
v_accvgpr_read_b32 v27, a198
v_mfma_f32_16x16x32_bf16 v[144:147], v[84:87], v[112:115], v[144:147]
s_lshl_b32 s73, s73, 7
ds_read_b64_tr_b16 v[46:47], v11 offset:1024
v_accvgpr_read_b32 v31, a199
v_mfma_f32_16x16x32_bf16 v[160:163], v[88:91], v[112:115], v[160:163]
s_add_u32 s69, s73, s67
ds_read_b64_tr_b16 v[48:49], v12 offset:0
v_cvt_pk_bf16_f32 v24, v24, v28
v_mfma_f32_16x16x32_bf16 v[164:167], v[88:91], v[116:119], v[164:167]
s_add_u32 s70, s73, s68
ds_read_b64_tr_b16 v[50:51], v12 offset:1024
v_cvt_pk_bf16_f32 v25, v25, v29
v_mfma_f32_16x16x32_bf16 v[168:171], v[88:91], v[120:123], v[168:171]
s_add_u32 m0, s64, 32768
ds_read_b64_tr_b16 v[52:53], v13 offset:0
v_cvt_pk_bf16_f32 v26, v26, v30
v_mfma_f32_16x16x32_bf16 v[172:175], v[88:91], v[124:127], v[172:175]
s_add_u32 s72, s71, 0
buffer_load_dwordx4 v6, s[12:15], s72 offen lds
v_mfma_f32_16x16x32_bf16 v[188:191], v[92:95], v[124:127], v[188:191]
s_add_u32 s72, s71, 31744
buffer_load_dwordx4 v6, s[12:15], s72 offen offset:1024 lds
v_mfma_f32_16x16x32_bf16 v[184:187], v[92:95], v[120:123], v[184:187]
s_add_u32 s72, s71, 63488
buffer_load_dwordx4 v7, s[12:15], s72 offen offset:2048 lds
v_mfma_f32_16x16x32_bf16 v[180:183], v[92:95], v[116:119], v[180:183]
s_add_u32 s72, s71, 95232
buffer_load_dwordx4 v7, s[12:15], s72 offen offset:3072 lds
v_mfma_f32_16x16x32_bf16 v[176:179], v[92:95], v[112:115], v[176:179]
ds_read_b64_tr_b16 v[54:55], v13 offset:1024
v_cvt_pk_bf16_f32 v27, v27, v31
v_mfma_f32_16x16x32_bf16 v[192:195], v[96:99], v[112:115], v[192:195]
s_add_u32 s80, s78, 2048
ds_read_b64_tr_b16 v[56:57], v14 offset:0
v_accvgpr_read_b32 v20, a76
v_mfma_f32_16x16x32_bf16 v[196:199], v[96:99], v[116:119], v[196:199]
ds_read_b64_tr_b16 v[58:59], v14 offset:1024
v_accvgpr_read_b32 v28, a77
v_mfma_f32_16x16x32_bf16 v[200:203], v[96:99], v[120:123], v[200:203]
ds_read_b64_tr_b16 v[60:61], v15 offset:0
v_accvgpr_read_b32 v21, a78
v_mfma_f32_16x16x32_bf16 v[204:207], v[96:99], v[124:127], v[204:207]
s_add_u32 m0, s63, 98304
ds_read_b64_tr_b16 v[62:63], v15 offset:1024
v_accvgpr_read_b32 v29, a79
v_mfma_f32_16x16x32_bf16 v[220:223], v[100:103], v[124:127], v[220:223]
s_add_u32 s72, s69, 0
buffer_load_dwordx4 v4, s[4:7], s72 offen lds
v_mfma_f32_16x16x32_bf16 v[216:219], v[100:103], v[120:123], v[216:219]
buffer_store_dwordx4 v[24:27], v1, s[44:47], s80 offen sc1
v_mfma_f32_16x16x32_bf16 v[212:215], v[100:103], v[116:119], v[212:215]
v_accvgpr_read_b32 v22, a108
v_accvgpr_read_b32 v30, a109
v_mfma_f32_16x16x32_bf16 v[208:211], v[100:103], v[112:115], v[208:211]
v_accvgpr_read_b32 v23, a110
v_accvgpr_read_b32 v31, a111
v_mfma_f32_16x16x32_bf16 v[224:227], v[104:107], v[112:115], v[224:227]
s_add_u32 s72, s69, 15360
buffer_load_dwordx4 v5, s[4:7], s72 offen offset:1024 lds
v_mfma_f32_16x16x32_bf16 v[228:231], v[104:107], v[116:119], v[228:231]
v_mul_f32 v20, s79, v20
v_mul_f32 v28, s79, v28
v_mfma_f32_16x16x32_bf16 v[232:235], v[104:107], v[120:123], v[232:235]
v_mul_f32 v21, s79, v21
v_mul_f32 v29, s79, v29
v_mfma_f32_16x16x32_bf16 v[236:239], v[104:107], v[124:127], v[236:239]
v_mul_f32 v22, s79, v22
v_mul_f32 v30, s79, v30
v_mfma_f32_16x16x32_bf16 v[252:255], v[108:111], v[124:127], v[252:255]
v_mul_f32 v23, s79, v23
v_mul_f32 v31, s79, v31
v_mfma_f32_16x16x32_bf16 v[248:251], v[108:111], v[120:123], v[248:251]
s_add_u32 s72, s69, 129024
buffer_load_dwordx4 v4, s[4:7], s72 offen offset:2048 lds
v_mfma_f32_16x16x32_bf16 v[244:247], v[108:111], v[116:119], v[244:247]
v_cvt_pk_bf16_f32 v20, v20, v28
v_cvt_pk_bf16_f32 v21, v21, v29
v_mfma_f32_16x16x32_bf16 v[240:243], v[108:111], v[112:115], v[240:243]
s_waitcnt lgkmcnt(0)
v_cvt_pk_bf16_f32 v22, v22, v30
v_cvt_pk_bf16_f32 v23, v23, v31
v_mfma_f32_16x16x32_bf16 v[128:131], v[32:35], v[64:67], v[128:131]
s_add_u32 s80, s77, 13312
ds_read_b64_tr_b16 v[80:81], v8 offset:8192
ds_read_b64_tr_b16 v[82:83], v8 offset:9216
v_mfma_f32_16x16x32_bf16 v[132:135], v[32:35], v[68:71], v[132:135]
ds_read_b128 v[112:115], v17 offset:0
ds_read_b128 v[116:119], v17 offset:2048
v_mfma_f32_16x16x32_bf16 v[136:139], v[32:35], v[72:75], v[136:139]
s_add_u32 s72, s69, 144384
buffer_load_dwordx4 v5, s[4:7], s72 offen offset:3072 lds
v_mfma_f32_16x16x32_bf16 v[140:143], v[32:35], v[76:79], v[140:143]
ds_read_b128 v[120:123], v17 offset:4096
ds_read_b128 v[124:127], v17 offset:6144
v_mfma_f32_16x16x32_bf16 v[156:159], v[36:39], v[76:79], v[156:159]
ds_read_b64_tr_b16 v[84:85], v9 offset:8192
ds_read_b64_tr_b16 v[86:87], v9 offset:9216
v_mfma_f32_16x16x32_bf16 v[152:155], v[36:39], v[72:75], v[152:155]
ds_read_b64_tr_b16 v[88:89], v10 offset:8192
v_accvgpr_read_b32 v24, a200
v_mfma_f32_16x16x32_bf16 v[148:151], v[36:39], v[68:71], v[148:151]
ds_read_b64_tr_b16 v[90:91], v10 offset:9216
v_accvgpr_read_b32 v28, a201
v_mfma_f32_16x16x32_bf16 v[144:147], v[36:39], v[64:67], v[144:147]
s_add_u32 m0, s63, 102400
ds_read_b64_tr_b16 v[92:93], v11 offset:8192
v_accvgpr_read_b32 v25, a202
v_mfma_f32_16x16x32_bf16 v[160:163], v[40:43], v[64:67], v[160:163]
s_add_u32 s72, s70, 0
buffer_load_dwordx4 v4, s[4:7], s72 offen lds
v_mfma_f32_16x16x32_bf16 v[164:167], v[40:43], v[68:71], v[164:167]
ds_read_b64_tr_b16 v[94:95], v11 offset:9216
v_accvgpr_read_b32 v29, a203
v_mfma_f32_16x16x32_bf16 v[168:171], v[40:43], v[72:75], v[168:171]
ds_read_b64_tr_b16 v[96:97], v12 offset:8192
v_accvgpr_read_b32 v26, a204
v_mfma_f32_16x16x32_bf16 v[172:175], v[40:43], v[76:79], v[172:175]
ds_read_b64_tr_b16 v[98:99], v12 offset:9216
v_accvgpr_read_b32 v30, a205
v_mfma_f32_16x16x32_bf16 v[188:191], v[44:47], v[76:79], v[188:191]
s_add_u32 s72, s70, 15360
buffer_load_dwordx4 v5, s[4:7], s72 offen offset:1024 lds
v_mfma_f32_16x16x32_bf16 v[184:187], v[44:47], v[72:75], v[184:187]
ds_read_b64_tr_b16 v[100:101], v13 offset:8192
v_accvgpr_read_b32 v27, a206
v_mfma_f32_16x16x32_bf16 v[180:183], v[44:47], v[68:71], v[180:183]
ds_read_b64_tr_b16 v[102:103], v13 offset:9216
v_accvgpr_read_b32 v31, a207
v_mfma_f32_16x16x32_bf16 v[176:179], v[44:47], v[64:67], v[176:179]
ds_read_b64_tr_b16 v[104:105], v14 offset:8192
v_cvt_pk_bf16_f32 v24, v24, v28
v_mfma_f32_16x16x32_bf16 v[192:195], v[48:51], v[64:67], v[192:195]
ds_read_b64_tr_b16 v[106:107], v14 offset:9216
v_cvt_pk_bf16_f32 v25, v25, v29
v_mfma_f32_16x16x32_bf16 v[196:199], v[48:51], v[68:71], v[196:199]
s_add_u32 s72, s70, 129024
buffer_load_dwordx4 v4, s[4:7], s72 offen offset:2048 lds
v_mfma_f32_16x16x32_bf16 v[200:203], v[48:51], v[72:75], v[200:203]
ds_read_b64_tr_b16 v[108:109], v15 offset:8192
v_cvt_pk_bf16_f32 v26, v26, v30
v_mfma_f32_16x16x32_bf16 v[204:207], v[48:51], v[76:79], v[204:207]
ds_read_b64_tr_b16 v[110:111], v15 offset:9216
v_cvt_pk_bf16_f32 v27, v27, v31
v_mfma_f32_16x16x32_bf16 v[220:223], v[52:55], v[76:79], v[220:223]
buffer_store_dwordx4 v[20:23], v1, s[44:47], s80 offen sc1
v_mfma_f32_16x16x32_bf16 v[216:219], v[52:55], v[72:75], v[216:219]
s_add_u32 s80, s78, 10240
buffer_store_dwordx4 v[24:27], v1, s[44:47], s80 offen sc1
v_mfma_f32_16x16x32_bf16 v[212:215], v[52:55], v[68:71], v[212:215]
s_add_u32 s72, s70, 144384
buffer_load_dwordx4 v5, s[4:7], s72 offen offset:3072 lds
v_mfma_f32_16x16x32_bf16 v[208:211], v[52:55], v[64:67], v[208:211]
v_accvgpr_read_b32 v20, a80
v_accvgpr_read_b32 v28, a81
v_mfma_f32_16x16x32_bf16 v[224:227], v[56:59], v[64:67], v[224:227]
v_accvgpr_read_b32 v21, a82
v_accvgpr_read_b32 v29, a83
v_mfma_f32_16x16x32_bf16 v[228:231], v[56:59], v[68:71], v[228:231]
v_accvgpr_read_b32 v22, a112
v_accvgpr_read_b32 v30, a113
v_mfma_f32_16x16x32_bf16 v[232:235], v[56:59], v[72:75], v[232:235]
v_accvgpr_read_b32 v23, a114
v_accvgpr_read_b32 v31, a115
v_mfma_f32_16x16x32_bf16 v[236:239], v[56:59], v[76:79], v[236:239]
v_mul_f32 v20, s79, v20
v_mul_f32 v28, s79, v28
v_mfma_f32_16x16x32_bf16 v[252:255], v[60:63], v[76:79], v[252:255]
v_mul_f32 v21, s79, v21
v_mul_f32 v29, s79, v29
v_mfma_f32_16x16x32_bf16 v[248:251], v[60:63], v[72:75], v[248:251]
v_mul_f32 v22, s79, v22
v_mul_f32 v30, s79, v30
v_mfma_f32_16x16x32_bf16 v[244:247], v[60:63], v[68:71], v[244:247]
s_waitcnt vmcnt(17) lgkmcnt(0)
v_mul_f32 v23, s79, v23
v_mul_f32 v31, s79, v31
v_mfma_f32_16x16x32_bf16 v[240:243], v[60:63], v[64:67], v[240:243]
s_barrier
v_cvt_pk_bf16_f32 v20, v20, v28
v_cvt_pk_bf16_f32 v21, v21, v29
v_mfma_f32_16x16x32_bf16 v[128:131], v[80:83], v[112:115], v[128:131]
s_add_u32 s73, s62, 9
ds_read_b64_tr_b16 v[32:33], v8 offset:16384
ds_read_b64_tr_b16 v[34:35], v8 offset:17408
v_mfma_f32_16x16x32_bf16 v[132:135], v[80:83], v[116:119], v[132:135]
s_add_u32 s70, s73, s65
ds_read_b128 v[64:67], v18 offset:0
ds_read_b128 v[68:71], v18 offset:2048
v_mfma_f32_16x16x32_bf16 v[136:139], v[80:83], v[120:123], v[136:139]
s_and_b32 s70, s70, 3
ds_read_b128 v[72:75], v18 offset:4096
ds_read_b128 v[76:79], v18 offset:6144
v_mfma_f32_16x16x32_bf16 v[140:143], v[80:83], v[124:127], v[140:143]
s_and_b32 s73, s73, 12
ds_read_b64_tr_b16 v[36:37], v9 offset:16384
ds_read_b64_tr_b16 v[38:39], v9 offset:17408
v_mfma_f32_16x16x32_bf16 v[156:159], v[84:87], v[124:127], v[156:159]
s_or_b32 s73, s73, s70
ds_read_b64_tr_b16 v[40:41], v10 offset:16384
v_cvt_pk_bf16_f32 v22, v22, v30
v_mfma_f32_16x16x32_bf16 v[152:155], v[84:87], v[120:123], v[152:155]
s_lshl_b32 s71, s73, 19
ds_read_b64_tr_b16 v[42:43], v10 offset:17408
v_cvt_pk_bf16_f32 v23, v23, v31
v_mfma_f32_16x16x32_bf16 v[148:151], v[84:87], v[116:119], v[148:151]
s_add_u32 s71, s71, s66
ds_read_b64_tr_b16 v[44:45], v11 offset:16384
v_mfma_f32_16x16x32_bf16 v[144:147], v[84:87], v[112:115], v[144:147]
s_lshl_b32 s73, s73, 7
ds_read_b64_tr_b16 v[46:47], v11 offset:17408
v_mfma_f32_16x16x32_bf16 v[160:163], v[88:91], v[112:115], v[160:163]
s_add_u32 s69, s73, s67
ds_read_b64_tr_b16 v[48:49], v12 offset:16384
v_mfma_f32_16x16x32_bf16 v[164:167], v[88:91], v[116:119], v[164:167]
s_add_u32 s70, s73, s68
ds_read_b64_tr_b16 v[50:51], v12 offset:17408
v_mfma_f32_16x16x32_bf16 v[168:171], v[88:91], v[120:123], v[168:171]
s_add_u32 m0, s64, 0
ds_read_b64_tr_b16 v[52:53], v13 offset:16384
v_mfma_f32_16x16x32_bf16 v[172:175], v[88:91], v[124:127], v[172:175]
s_add_u32 s72, s71, 0
buffer_load_dwordx4 v6, s[12:15], s72 offen lds
v_mfma_f32_16x16x32_bf16 v[188:191], v[92:95], v[124:127], v[188:191]
s_add_u32 s72, s71, 31744
buffer_load_dwordx4 v6, s[12:15], s72 offen offset:1024 lds
v_mfma_f32_16x16x32_bf16 v[184:187], v[92:95], v[120:123], v[184:187]
s_add_u32 s72, s71, 63488
buffer_load_dwordx4 v7, s[12:15], s72 offen offset:2048 lds
v_mfma_f32_16x16x32_bf16 v[180:183], v[92:95], v[116:119], v[180:183]
s_add_u32 s72, s71, 95232
buffer_load_dwordx4 v7, s[12:15], s72 offen offset:3072 lds
v_mfma_f32_16x16x32_bf16 v[176:179], v[92:95], v[112:115], v[176:179]
s_add_u32 s80, s77, 33792
ds_read_b64_tr_b16 v[54:55], v13 offset:17408
v_accvgpr_read_b32 v24, a208
v_mfma_f32_16x16x32_bf16 v[192:195], v[96:99], v[112:115], v[192:195]
ds_read_b64_tr_b16 v[56:57], v14 offset:16384
v_accvgpr_read_b32 v28, a209
v_mfma_f32_16x16x32_bf16 v[196:199], v[96:99], v[116:119], v[196:199]
ds_read_b64_tr_b16 v[58:59], v14 offset:17408
v_accvgpr_read_b32 v25, a210
v_mfma_f32_16x16x32_bf16 v[200:203], v[96:99], v[120:123], v[200:203]
ds_read_b64_tr_b16 v[60:61], v15 offset:16384
v_accvgpr_read_b32 v29, a211
v_mfma_f32_16x16x32_bf16 v[204:207], v[96:99], v[124:127], v[204:207]
s_add_u32 m0, s63, 131072
ds_read_b64_tr_b16 v[62:63], v15 offset:17408
v_accvgpr_read_b32 v26, a212
v_mfma_f32_16x16x32_bf16 v[220:223], v[100:103], v[124:127], v[220:223]
s_add_u32 s72, s69, 0
buffer_load_dwordx4 v4, s[4:7], s72 offen lds
v_mfma_f32_16x16x32_bf16 v[216:219], v[100:103], v[120:123], v[216:219]
buffer_store_dwordx4 v[20:23], v1, s[44:47], s80 offen sc1
v_mfma_f32_16x16x32_bf16 v[212:215], v[100:103], v[116:119], v[212:215]
v_accvgpr_read_b32 v30, a213
v_accvgpr_read_b32 v27, a214
v_mfma_f32_16x16x32_bf16 v[208:211], v[100:103], v[112:115], v[208:211]
v_accvgpr_read_b32 v31, a215
v_cvt_pk_bf16_f32 v24, v24, v28
v_mfma_f32_16x16x32_bf16 v[224:227], v[104:107], v[112:115], v[224:227]
s_add_u32 s72, s69, 15360
buffer_load_dwordx4 v5, s[4:7], s72 offen offset:1024 lds
v_mfma_f32_16x16x32_bf16 v[228:231], v[104:107], v[116:119], v[228:231]
v_cvt_pk_bf16_f32 v25, v25, v29
v_cvt_pk_bf16_f32 v26, v26, v30
v_mfma_f32_16x16x32_bf16 v[232:235], v[104:107], v[120:123], v[232:235]
v_cvt_pk_bf16_f32 v27, v27, v31
v_mfma_f32_16x16x32_bf16 v[236:239], v[104:107], v[124:127], v[236:239]
s_add_u32 s80, s78, 34816
buffer_store_dwordx4 v[24:27], v1, s[44:47], s80 offen sc1
v_mfma_f32_16x16x32_bf16 v[252:255], v[108:111], v[124:127], v[252:255]
v_mfma_f32_16x16x32_bf16 v[248:251], v[108:111], v[120:123], v[248:251]
s_add_u32 s72, s69, 129024
buffer_load_dwordx4 v4, s[4:7], s72 offen offset:2048 lds
v_mfma_f32_16x16x32_bf16 v[244:247], v[108:111], v[116:119], v[244:247]
v_mfma_f32_16x16x32_bf16 v[240:243], v[108:111], v[112:115], v[240:243]
s_waitcnt lgkmcnt(0)
v_mfma_f32_16x16x32_bf16 v[128:131], v[32:35], v[64:67], v[128:131]
ds_read_b64_tr_b16 v[80:81], v8 offset:24576
ds_read_b64_tr_b16 v[82:83], v8 offset:25600
v_mfma_f32_16x16x32_bf16 v[132:135], v[32:35], v[68:71], v[132:135]
ds_read_b128 v[112:115], v19 offset:0
ds_read_b128 v[116:119], v19 offset:2048
v_mfma_f32_16x16x32_bf16 v[136:139], v[32:35], v[72:75], v[136:139]
s_add_u32 s72, s69, 144384
buffer_load_dwordx4 v5, s[4:7], s72 offen offset:3072 lds
v_mfma_f32_16x16x32_bf16 v[140:143], v[32:35], v[76:79], v[140:143]
ds_read_b128 v[120:123], v19 offset:4096
ds_read_b128 v[124:127], v19 offset:6144
v_mfma_f32_16x16x32_bf16 v[156:159], v[36:39], v[76:79], v[156:159]
ds_read_b64_tr_b16 v[84:85], v9 offset:24576
ds_read_b64_tr_b16 v[86:87], v9 offset:25600
v_mfma_f32_16x16x32_bf16 v[152:155], v[36:39], v[72:75], v[152:155]
ds_read_b64_tr_b16 v[88:89], v10 offset:24576
v_accvgpr_read_b32 v20, a84
v_mfma_f32_16x16x32_bf16 v[148:151], v[36:39], v[68:71], v[148:151]
ds_read_b64_tr_b16 v[90:91], v10 offset:25600
v_accvgpr_read_b32 v28, a85
v_mfma_f32_16x16x32_bf16 v[144:147], v[36:39], v[64:67], v[144:147]
s_add_u32 m0, s63, 135168
ds_read_b64_tr_b16 v[92:93], v11 offset:24576
v_accvgpr_read_b32 v21, a86
v_mfma_f32_16x16x32_bf16 v[160:163], v[40:43], v[64:67], v[160:163]
s_add_u32 s72, s70, 0
buffer_load_dwordx4 v4, s[4:7], s72 offen lds
v_mfma_f32_16x16x32_bf16 v[164:167], v[40:43], v[68:71], v[164:167]
ds_read_b64_tr_b16 v[94:95], v11 offset:25600
v_accvgpr_read_b32 v29, a87
v_mfma_f32_16x16x32_bf16 v[168:171], v[40:43], v[72:75], v[168:171]
ds_read_b64_tr_b16 v[96:97], v12 offset:24576
v_accvgpr_read_b32 v22, a116
v_mfma_f32_16x16x32_bf16 v[172:175], v[40:43], v[76:79], v[172:175]
ds_read_b64_tr_b16 v[98:99], v12 offset:25600
v_accvgpr_read_b32 v30, a117
v_mfma_f32_16x16x32_bf16 v[188:191], v[44:47], v[76:79], v[188:191]
s_add_u32 s72, s70, 15360
buffer_load_dwordx4 v5, s[4:7], s72 offen offset:1024 lds
v_mfma_f32_16x16x32_bf16 v[184:187], v[44:47], v[72:75], v[184:187]
ds_read_b64_tr_b16 v[100:101], v13 offset:24576
v_accvgpr_read_b32 v23, a118
v_mfma_f32_16x16x32_bf16 v[180:183], v[44:47], v[68:71], v[180:183]
ds_read_b64_tr_b16 v[102:103], v13 offset:25600
v_accvgpr_read_b32 v31, a119
v_mfma_f32_16x16x32_bf16 v[176:179], v[44:47], v[64:67], v[176:179]
ds_read_b64_tr_b16 v[104:105], v14 offset:24576
v_mul_f32 v20, s79, v20
v_mfma_f32_16x16x32_bf16 v[192:195], v[48:51], v[64:67], v[192:195]
ds_read_b64_tr_b16 v[106:107], v14 offset:25600
v_mul_f32 v28, s79, v28
v_mfma_f32_16x16x32_bf16 v[196:199], v[48:51], v[68:71], v[196:199]
s_add_u32 s72, s70, 129024
buffer_load_dwordx4 v4, s[4:7], s72 offen offset:2048 lds
v_mfma_f32_16x16x32_bf16 v[200:203], v[48:51], v[72:75], v[200:203]
ds_read_b64_tr_b16 v[108:109], v15 offset:24576
v_mul_f32 v21, s79, v21
v_mfma_f32_16x16x32_bf16 v[204:207], v[48:51], v[76:79], v[204:207]
ds_read_b64_tr_b16 v[110:111], v15 offset:25600
v_mul_f32 v29, s79, v29
v_mfma_f32_16x16x32_bf16 v[220:223], v[52:55], v[76:79], v[220:223]
v_mul_f32 v22, s79, v22
v_mul_f32 v30, s79, v30
v_mfma_f32_16x16x32_bf16 v[216:219], v[52:55], v[72:75], v[216:219]
v_mul_f32 v23, s79, v23
v_mul_f32 v31, s79, v31
v_mfma_f32_16x16x32_bf16 v[212:215], v[52:55], v[68:71], v[212:215]
s_add_u32 s72, s70, 144384
buffer_load_dwordx4 v5, s[4:7], s72 offen offset:3072 lds
v_mfma_f32_16x16x32_bf16 v[208:211], v[52:55], v[64:67], v[208:211]
v_cvt_pk_bf16_f32 v20, v20, v28
v_cvt_pk_bf16_f32 v21, v21, v29
v_mfma_f32_16x16x32_bf16 v[224:227], v[56:59], v[64:67], v[224:227]
v_cvt_pk_bf16_f32 v22, v22, v30
v_cvt_pk_bf16_f32 v23, v23, v31
v_mfma_f32_16x16x32_bf16 v[228:231], v[56:59], v[68:71], v[228:231]
s_add_u32 s80, s77, 37888
buffer_store_dwordx4 v[20:23], v1, s[44:47], s80 offen sc1
v_mfma_f32_16x16x32_bf16 v[232:235], v[56:59], v[72:75], v[232:235]
v_accvgpr_read_b32 v24, a216
v_accvgpr_read_b32 v28, a217
v_mfma_f32_16x16x32_bf16 v[236:239], v[56:59], v[76:79], v[236:239]
v_accvgpr_read_b32 v25, a218
v_accvgpr_read_b32 v29, a219
v_mfma_f32_16x16x32_bf16 v[252:255], v[60:63], v[76:79], v[252:255]
v_accvgpr_read_b32 v26, a220
v_accvgpr_read_b32 v30, a221
v_mfma_f32_16x16x32_bf16 v[248:251], v[60:63], v[72:75], v[248:251]
v_accvgpr_read_b32 v27, a222
v_accvgpr_read_b32 v31, a223
v_mfma_f32_16x16x32_bf16 v[244:247], v[60:63], v[68:71], v[244:247]
s_waitcnt vmcnt(15) lgkmcnt(0)
v_cvt_pk_bf16_f32 v24, v24, v28
v_cvt_pk_bf16_f32 v25, v25, v29
v_mfma_f32_16x16x32_bf16 v[240:243], v[60:63], v[64:67], v[240:243]
s_barrier
v_cvt_pk_bf16_f32 v26, v26, v30
v_cvt_pk_bf16_f32 v27, v27, v31
v_mfma_f32_16x16x32_bf16 v[128:131], v[80:83], v[112:115], v[128:131]
s_add_u32 s73, s62, 10
ds_read_b64_tr_b16 v[32:33], v8 offset:32768
ds_read_b64_tr_b16 v[34:35], v8 offset:33792
v_mfma_f32_16x16x32_bf16 v[132:135], v[80:83], v[116:119], v[132:135]
s_add_u32 s70, s73, s65
ds_read_b128 v[64:67], v18 offset:32768
ds_read_b128 v[68:71], v18 offset:34816
v_mfma_f32_16x16x32_bf16 v[136:139], v[80:83], v[120:123], v[136:139]
s_and_b32 s70, s70, 3
ds_read_b128 v[72:75], v18 offset:36864
ds_read_b128 v[76:79], v18 offset:38912
v_mfma_f32_16x16x32_bf16 v[140:143], v[80:83], v[124:127], v[140:143]
s_and_b32 s73, s73, 12
ds_read_b64_tr_b16 v[36:37], v9 offset:32768
ds_read_b64_tr_b16 v[38:39], v9 offset:33792
v_mfma_f32_16x16x32_bf16 v[156:159], v[84:87], v[124:127], v[156:159]
s_or_b32 s73, s73, s70
ds_read_b64_tr_b16 v[40:41], v10 offset:32768
v_mfma_f32_16x16x32_bf16 v[152:155], v[84:87], v[120:123], v[152:155]
s_lshl_b32 s71, s73, 19
ds_read_b64_tr_b16 v[42:43], v10 offset:33792
v_mfma_f32_16x16x32_bf16 v[148:151], v[84:87], v[116:119], v[148:151]
s_add_u32 s71, s71, s66
ds_read_b64_tr_b16 v[44:45], v11 offset:32768
v_mfma_f32_16x16x32_bf16 v[144:147], v[84:87], v[112:115], v[144:147]
s_lshl_b32 s73, s73, 7
ds_read_b64_tr_b16 v[46:47], v11 offset:33792
v_mfma_f32_16x16x32_bf16 v[160:163], v[88:91], v[112:115], v[160:163]
s_add_u32 s69, s73, s67
ds_read_b64_tr_b16 v[48:49], v12 offset:32768
v_accvgpr_read_b32 v20, a88
v_mfma_f32_16x16x32_bf16 v[164:167], v[88:91], v[116:119], v[164:167]
s_add_u32 s70, s73, s68
ds_read_b64_tr_b16 v[50:51], v12 offset:33792
v_accvgpr_read_b32 v28, a89
v_mfma_f32_16x16x32_bf16 v[168:171], v[88:91], v[120:123], v[168:171]
s_add_u32 m0, s64, 16384
ds_read_b64_tr_b16 v[52:53], v13 offset:32768
v_accvgpr_read_b32 v21, a90
v_mfma_f32_16x16x32_bf16 v[172:175], v[88:91], v[124:127], v[172:175]
s_add_u32 s72, s71, 0
buffer_load_dwordx4 v6, s[12:15], s72 offen lds
v_mfma_f32_16x16x32_bf16 v[188:191], v[92:95], v[124:127], v[188:191]
s_add_u32 s72, s71, 31744
buffer_load_dwordx4 v6, s[12:15], s72 offen offset:1024 lds
v_mfma_f32_16x16x32_bf16 v[184:187], v[92:95], v[120:123], v[184:187]
s_add_u32 s72, s71, 63488
buffer_load_dwordx4 v7, s[12:15], s72 offen offset:2048 lds
v_mfma_f32_16x16x32_bf16 v[180:183], v[92:95], v[116:119], v[180:183]
s_add_u32 s72, s71, 95232
buffer_load_dwordx4 v7, s[12:15], s72 offen offset:3072 lds
v_mfma_f32_16x16x32_bf16 v[176:179], v[92:95], v[112:115], v[176:179]
s_add_u32 s80, s78, 43008
ds_read_b64_tr_b16 v[54:55], v13 offset:33792
v_accvgpr_read_b32 v29, a91
v_mfma_f32_16x16x32_bf16 v[192:195], v[96:99], v[112:115], v[192:195]
ds_read_b64_tr_b16 v[56:57], v14 offset:32768
v_accvgpr_read_b32 v22, a120
v_mfma_f32_16x16x32_bf16 v[196:199], v[96:99], v[116:119], v[196:199]
ds_read_b64_tr_b16 v[58:59], v14 offset:33792
v_accvgpr_read_b32 v30, a121
v_mfma_f32_16x16x32_bf16 v[200:203], v[96:99], v[120:123], v[200:203]
ds_read_b64_tr_b16 v[60:61], v15 offset:32768
v_accvgpr_read_b32 v23, a122
v_mfma_f32_16x16x32_bf16 v[204:207], v[96:99], v[124:127], v[204:207]
s_add_u32 m0, s63, 65536
ds_read_b64_tr_b16 v[62:63], v15 offset:33792
v_accvgpr_read_b32 v31, a123
v_mfma_f32_16x16x32_bf16 v[220:223], v[100:103], v[124:127], v[220:223]
s_add_u32 s72, s69, 0
buffer_load_dwordx4 v4, s[4:7], s72 offen lds
v_mfma_f32_16x16x32_bf16 v[216:219], v[100:103], v[120:123], v[216:219]
buffer_store_dwordx4 v[24:27], v1, s[44:47], s80 offen sc1
v_mfma_f32_16x16x32_bf16 v[212:215], v[100:103], v[116:119], v[212:215]
v_mul_f32 v20, s79, v20
v_mul_f32 v28, s79, v28
v_mfma_f32_16x16x32_bf16 v[208:211], v[100:103], v[112:115], v[208:211]
v_mul_f32 v21, s79, v21
v_mul_f32 v29, s79, v29
v_mfma_f32_16x16x32_bf16 v[224:227], v[104:107], v[112:115], v[224:227]
s_add_u32 s72, s69, 15360
buffer_load_dwordx4 v5, s[4:7], s72 offen offset:1024 lds
v_mfma_f32_16x16x32_bf16 v[228:231], v[104:107], v[116:119], v[228:231]
v_mul_f32 v22, s79, v22
v_mul_f32 v30, s79, v30
v_mfma_f32_16x16x32_bf16 v[232:235], v[104:107], v[120:123], v[232:235]
v_mul_f32 v23, s79, v23
v_mul_f32 v31, s79, v31
v_mfma_f32_16x16x32_bf16 v[236:239], v[104:107], v[124:127], v[236:239]
v_cvt_pk_bf16_f32 v20, v20, v28
v_cvt_pk_bf16_f32 v21, v21, v29
v_mfma_f32_16x16x32_bf16 v[252:255], v[108:111], v[124:127], v[252:255]
v_cvt_pk_bf16_f32 v22, v22, v30
v_cvt_pk_bf16_f32 v23, v23, v31
v_mfma_f32_16x16x32_bf16 v[248:251], v[108:111], v[120:123], v[248:251]
s_add_u32 s72, s69, 129024
buffer_load_dwordx4 v4, s[4:7], s72 offen offset:2048 lds
v_mfma_f32_16x16x32_bf16 v[244:247], v[108:111], v[116:119], v[244:247]
s_add_u32 s80, s77, 41984
buffer_store_dwordx4 v[20:23], v1, s[44:47], s80 offen sc1
v_mfma_f32_16x16x32_bf16 v[240:243], v[108:111], v[112:115], v[240:243]
s_waitcnt lgkmcnt(0)
v_accvgpr_read_b32 v24, a224
v_accvgpr_read_b32 v28, a225
LcB1:
v_mfma_f32_16x16x32_bf16 v[128:131], v[32:35], v[64:67], v[128:131]
ds_read_b64_tr_b16 v[80:81], v8 offset:40960
ds_read_b64_tr_b16 v[82:83], v8 offset:41984
v_mfma_f32_16x16x32_bf16 v[132:135], v[32:35], v[68:71], v[132:135]
ds_read_b128 v[112:115], v19 offset:32768
ds_read_b128 v[116:119], v19 offset:34816
v_mfma_f32_16x16x32_bf16 v[136:139], v[32:35], v[72:75], v[136:139]
s_add_u32 s72, s69, 144384
buffer_load_dwordx4 v5, s[4:7], s72 offen offset:3072 lds
v_mfma_f32_16x16x32_bf16 v[140:143], v[32:35], v[76:79], v[140:143]
ds_read_b128 v[120:123], v19 offset:36864
ds_read_b128 v[124:127], v19 offset:38912
v_mfma_f32_16x16x32_bf16 v[156:159], v[36:39], v[76:79], v[156:159]
ds_read_b64_tr_b16 v[84:85], v9 offset:40960
ds_read_b64_tr_b16 v[86:87], v9 offset:41984
v_mfma_f32_16x16x32_bf16 v[152:155], v[36:39], v[72:75], v[152:155]
ds_read_b64_tr_b16 v[88:89], v10 offset:40960
v_accvgpr_read_b32 v25, a226
v_mfma_f32_16x16x32_bf16 v[148:151], v[36:39], v[68:71], v[148:151]
ds_read_b64_tr_b16 v[90:91], v10 offset:41984
v_accvgpr_read_b32 v29, a227
v_mfma_f32_16x16x32_bf16 v[144:147], v[36:39], v[64:67], v[144:147]
s_add_u32 m0, s63, 69632
ds_read_b64_tr_b16 v[92:93], v11 offset:40960
v_accvgpr_read_b32 v26, a228
v_mfma_f32_16x16x32_bf16 v[160:163], v[40:43], v[64:67], v[160:163]
s_add_u32 s72, s70, 0
buffer_load_dwordx4 v4, s[4:7], s72 offen lds
v_mfma_f32_16x16x32_bf16 v[164:167], v[40:43], v[68:71], v[164:167]
ds_read_b64_tr_b16 v[94:95], v11 offset:41984
v_accvgpr_read_b32 v30, a229
v_mfma_f32_16x16x32_bf16 v[168:171], v[40:43], v[72:75], v[168:171]
ds_read_b64_tr_b16 v[96:97], v12 offset:40960
v_accvgpr_read_b32 v27, a230
v_mfma_f32_16x16x32_bf16 v[172:175], v[40:43], v[76:79], v[172:175]
ds_read_b64_tr_b16 v[98:99], v12 offset:41984
v_accvgpr_read_b32 v31, a231
v_mfma_f32_16x16x32_bf16 v[188:191], v[44:47], v[76:79], v[188:191]
s_add_u32 s72, s70, 15360
buffer_load_dwordx4 v5, s[4:7], s72 offen offset:1024 lds
v_mfma_f32_16x16x32_bf16 v[184:187], v[44:47], v[72:75], v[184:187]
ds_read_b64_tr_b16 v[100:101], v13 offset:40960
v_cvt_pk_bf16_f32 v24, v24, v28
v_mfma_f32_16x16x32_bf16 v[180:183], v[44:47], v[68:71], v[180:183]
ds_read_b64_tr_b16 v[102:103], v13 offset:41984
v_cvt_pk_bf16_f32 v25, v25, v29
v_mfma_f32_16x16x32_bf16 v[176:179], v[44:47], v[64:67], v[176:179]
ds_read_b64_tr_b16 v[104:105], v14 offset:40960
v_cvt_pk_bf16_f32 v26, v26, v30
v_mfma_f32_16x16x32_bf16 v[192:195], v[48:51], v[64:67], v[192:195]
ds_read_b64_tr_b16 v[106:107], v14 offset:41984
v_cvt_pk_bf16_f32 v27, v27, v31
v_mfma_f32_16x16x32_bf16 v[196:199], v[48:51], v[68:71], v[196:199]
s_add_u32 s72, s70, 129024
buffer_load_dwordx4 v4, s[4:7], s72 offen offset:2048 lds
v_mfma_f32_16x16x32_bf16 v[200:203], v[48:51], v[72:75], v[200:203]
s_add_u32 s80, s78, 3072
ds_read_b64_tr_b16 v[108:109], v15 offset:40960
v_accvgpr_read_b32 v20, a92
v_mfma_f32_16x16x32_bf16 v[204:207], v[48:51], v[76:79], v[204:207]
ds_read_b64_tr_b16 v[110:111], v15 offset:41984
v_accvgpr_read_b32 v28, a93
v_mfma_f32_16x16x32_bf16 v[220:223], v[52:55], v[76:79], v[220:223]
buffer_store_dwordx4 v[24:27], v1, s[44:47], s80 offen sc1
v_mfma_f32_16x16x32_bf16 v[216:219], v[52:55], v[72:75], v[216:219]
v_accvgpr_read_b32 v21, a94
v_accvgpr_read_b32 v29, a95
v_mfma_f32_16x16x32_bf16 v[212:215], v[52:55], v[68:71], v[212:215]
s_add_u32 s72, s70, 144384
buffer_load_dwordx4 v5, s[4:7], s72 offen offset:3072 lds
v_mfma_f32_16x16x32_bf16 v[208:211], v[52:55], v[64:67], v[208:211]
v_accvgpr_read_b32 v22, a124
v_accvgpr_read_b32 v30, a125
v_mfma_f32_16x16x32_bf16 v[224:227], v[56:59], v[64:67], v[224:227]
v_accvgpr_read_b32 v23, a126
v_accvgpr_read_b32 v31, a127
v_mfma_f32_16x16x32_bf16 v[228:231], v[56:59], v[68:71], v[228:231]
v_mul_f32 v20, s79, v20
v_mul_f32 v28, s79, v28
v_mfma_f32_16x16x32_bf16 v[232:235], v[56:59], v[72:75], v[232:235]
v_mul_f32 v21, s79, v21
v_mul_f32 v29, s79, v29
v_mfma_f32_16x16x32_bf16 v[236:239], v[56:59], v[76:79], v[236:239]
v_mul_f32 v22, s79, v22
v_mul_f32 v30, s79, v30
v_mfma_f32_16x16x32_bf16 v[252:255], v[60:63], v[76:79], v[252:255]
v_mul_f32 v23, s79, v23
v_mul_f32 v31, s79, v31
v_mfma_f32_16x16x32_bf16 v[248:251], v[60:63], v[72:75], v[248:251]
v_cvt_pk_bf16_f32 v20, v20, v28
v_cvt_pk_bf16_f32 v21, v21, v29
v_mfma_f32_16x16x32_bf16 v[244:247], v[60:63], v[68:71], v[244:247]
s_waitcnt vmcnt(16) lgkmcnt(0)
v_cvt_pk_bf16_f32 v22, v22, v30
v_cvt_pk_bf16_f32 v23, v23, v31
v_mfma_f32_16x16x32_bf16 v[240:243], v[60:63], v[64:67], v[240:243]
s_barrier
v_mfma_f32_16x16x32_bf16 v[128:131], v[80:83], v[112:115], v[128:131]
s_add_u32 s73, s62, 11
ds_read_b64_tr_b16 v[32:33], v8 offset:0
ds_read_b64_tr_b16 v[34:35], v8 offset:1024
v_mfma_f32_16x16x32_bf16 v[132:135], v[80:83], v[116:119], v[132:135]
s_add_u32 s70, s73, s65
ds_read_b128 v[64:67], v16 offset:0
ds_read_b128 v[68:71], v16 offset:2048
v_mfma_f32_16x16x32_bf16 v[136:139], v[80:83], v[120:123], v[136:139]
s_and_b32 s70, s70, 3
ds_read_b128 v[72:75], v16 offset:4096
ds_read_b128 v[76:79], v16 offset:6144
v_mfma_f32_16x16x32_bf16 v[140:143], v[80:83], v[124:127], v[140:143]
s_and_b32 s73, s73, 12
ds_read_b64_tr_b16 v[36:37], v9 offset:0
ds_read_b64_tr_b16 v[38:39], v9 offset:1024
v_mfma_f32_16x16x32_bf16 v[156:159], v[84:87], v[124:127], v[156:159]
s_or_b32 s73, s73, s70
ds_read_b64_tr_b16 v[40:41], v10 offset:0
v_mfma_f32_16x16x32_bf16 v[152:155], v[84:87], v[120:123], v[152:155]
s_lshl_b32 s71, s73, 19
ds_read_b64_tr_b16 v[42:43], v10 offset:1024
v_accvgpr_read_b32 v24, a232
v_mfma_f32_16x16x32_bf16 v[148:151], v[84:87], v[116:119], v[148:151]
s_add_u32 s71, s71, s66
ds_read_b64_tr_b16 v[44:45], v11 offset:0
v_accvgpr_read_b32 v28, a233
v_mfma_f32_16x16x32_bf16 v[144:147], v[84:87], v[112:115], v[144:147]
s_lshl_b32 s73, s73, 7
ds_read_b64_tr_b16 v[46:47], v11 offset:1024
v_accvgpr_read_b32 v25, a234
v_mfma_f32_16x16x32_bf16 v[160:163], v[88:91], v[112:115], v[160:163]
s_add_u32 s69, s73, s67
ds_read_b64_tr_b16 v[48:49], v12 offset:0
v_accvgpr_read_b32 v29, a235
v_mfma_f32_16x16x32_bf16 v[164:167], v[88:91], v[116:119], v[164:167]
s_add_u32 s70, s73, s68
ds_read_b64_tr_b16 v[50:51], v12 offset:1024
v_accvgpr_read_b32 v26, a236
v_mfma_f32_16x16x32_bf16 v[168:171], v[88:91], v[120:123], v[168:171]
s_add_u32 m0, s64, 32768
ds_read_b64_tr_b16 v[52:53], v13 offset:0
v_accvgpr_read_b32 v30, a237
v_mfma_f32_16x16x32_bf16 v[172:175], v[88:91], v[124:127], v[172:175]
s_add_u32 s72, s71, 0
buffer_load_dwordx4 v6, s[12:15], s72 offen lds
v_mfma_f32_16x16x32_bf16 v[188:191], v[92:95], v[124:127], v[188:191]
s_add_u32 s72, s71, 31744
buffer_load_dwordx4 v6, s[12:15], s72 offen offset:1024 lds
v_mfma_f32_16x16x32_bf16 v[184:187], v[92:95], v[120:123], v[184:187]
s_add_u32 s72, s71, 63488
buffer_load_dwordx4 v7, s[12:15], s72 offen offset:2048 lds
v_mfma_f32_16x16x32_bf16 v[180:183], v[92:95], v[116:119], v[180:183]
s_add_u32 s72, s71, 95232
buffer_load_dwordx4 v7, s[12:15], s72 offen offset:3072 lds
v_mfma_f32_16x16x32_bf16 v[176:179], v[92:95], v[112:115], v[176:179]
s_add_u32 s80, s77, 46080
ds_read_b64_tr_b16 v[54:55], v13 offset:1024
v_accvgpr_read_b32 v27, a238
v_mfma_f32_16x16x32_bf16 v[192:195], v[96:99], v[112:115], v[192:195]
ds_read_b64_tr_b16 v[56:57], v14 offset:0
v_accvgpr_read_b32 v31, a239
v_mfma_f32_16x16x32_bf16 v[196:199], v[96:99], v[116:119], v[196:199]
ds_read_b64_tr_b16 v[58:59], v14 offset:1024
v_cvt_pk_bf16_f32 v24, v24, v28
v_mfma_f32_16x16x32_bf16 v[200:203], v[96:99], v[120:123], v[200:203]
ds_read_b64_tr_b16 v[60:61], v15 offset:0
v_cvt_pk_bf16_f32 v25, v25, v29
v_mfma_f32_16x16x32_bf16 v[204:207], v[96:99], v[124:127], v[204:207]
s_add_u32 m0, s63, 98304
ds_read_b64_tr_b16 v[62:63], v15 offset:1024
v_cvt_pk_bf16_f32 v26, v26, v30
v_mfma_f32_16x16x32_bf16 v[220:223], v[100:103], v[124:127], v[220:223]
s_add_u32 s72, s69, 0
buffer_load_dwordx4 v4, s[4:7], s72 offen lds
v_mfma_f32_16x16x32_bf16 v[216:219], v[100:103], v[120:123], v[216:219]
buffer_store_dwordx4 v[20:23], v1, s[44:47], s80 offen sc1
v_mfma_f32_16x16x32_bf16 v[212:215], v[100:103], v[116:119], v[212:215]
v_cvt_pk_bf16_f32 v27, v27, v31
v_mfma_f32_16x16x32_bf16 v[208:211], v[100:103], v[112:115], v[208:211]
s_add_u32 s80, s78, 11264
buffer_store_dwordx4 v[24:27], v1, s[44:47], s80 offen sc1
v_mfma_f32_16x16x32_bf16 v[224:227], v[104:107], v[112:115], v[224:227]
s_add_u32 s72, s69, 15360
buffer_load_dwordx4 v5, s[4:7], s72 offen offset:1024 lds
v_mfma_f32_16x16x32_bf16 v[228:231], v[104:107], v[116:119], v[228:231]
v_accvgpr_read_b32 v20, a240
v_accvgpr_read_b32 v28, a241
v_mfma_f32_16x16x32_bf16 v[232:235], v[104:107], v[120:123], v[232:235]
v_accvgpr_read_b32 v21, a242
v_accvgpr_read_b32 v29, a243
v_mfma_f32_16x16x32_bf16 v[236:239], v[104:107], v[124:127], v[236:239]
v_accvgpr_read_b32 v22, a244
v_accvgpr_read_b32 v30, a245
v_mfma_f32_16x16x32_bf16 v[252:255], v[108:111], v[124:127], v[252:255]
v_accvgpr_read_b32 v23, a246
v_accvgpr_read_b32 v31, a247
v_mfma_f32_16x16x32_bf16 v[248:251], v[108:111], v[120:123], v[248:251]
s_add_u32 s72, s69, 129024
buffer_load_dwordx4 v4, s[4:7], s72 offen offset:2048 lds
v_mfma_f32_16x16x32_bf16 v[244:247], v[108:111], v[116:119], v[244:247]
v_cvt_pk_bf16_f32 v20, v20, v28
v_cvt_pk_bf16_f32 v21, v21, v29
v_mfma_f32_16x16x32_bf16 v[240:243], v[108:111], v[112:115], v[240:243]
s_waitcnt lgkmcnt(0)
v_cvt_pk_bf16_f32 v22, v22, v30
v_cvt_pk_bf16_f32 v23, v23, v31
v_mfma_f32_16x16x32_bf16 v[128:131], v[32:35], v[64:67], v[128:131]
s_add_u32 s80, s78, 35840
ds_read_b64_tr_b16 v[80:81], v8 offset:8192
ds_read_b64_tr_b16 v[82:83], v8 offset:9216
v_mfma_f32_16x16x32_bf16 v[132:135], v[32:35], v[68:71], v[132:135]
ds_read_b128 v[112:115], v17 offset:0
ds_read_b128 v[116:119], v17 offset:2048
v_mfma_f32_16x16x32_bf16 v[136:139], v[32:35], v[72:75], v[136:139]
s_add_u32 s72, s69, 144384
buffer_load_dwordx4 v5, s[4:7], s72 offen offset:3072 lds
v_mfma_f32_16x16x32_bf16 v[140:143], v[32:35], v[76:79], v[140:143]
ds_read_b128 v[120:123], v17 offset:4096
ds_read_b128 v[124:127], v17 offset:6144
v_mfma_f32_16x16x32_bf16 v[156:159], v[36:39], v[76:79], v[156:159]
ds_read_b64_tr_b16 v[84:85], v9 offset:8192
ds_read_b64_tr_b16 v[86:87], v9 offset:9216
v_mfma_f32_16x16x32_bf16 v[152:155], v[36:39], v[72:75], v[152:155]
ds_read_b64_tr_b16 v[88:89], v10 offset:8192
v_mfma_f32_16x16x32_bf16 v[148:151], v[36:39], v[68:71], v[148:151]
ds_read_b64_tr_b16 v[90:91], v10 offset:9216
v_mfma_f32_16x16x32_bf16 v[144:147], v[36:39], v[64:67], v[144:147]
s_add_u32 m0, s63, 102400
ds_read_b64_tr_b16 v[92:93], v11 offset:8192
v_mfma_f32_16x16x32_bf16 v[160:163], v[40:43], v[64:67], v[160:163]
s_add_u32 s72, s70, 0
buffer_load_dwordx4 v4, s[4:7], s72 offen lds
v_mfma_f32_16x16x32_bf16 v[164:167], v[40:43], v[68:71], v[164:167]
ds_read_b64_tr_b16 v[94:95], v11 offset:9216
v_mfma_f32_16x16x32_bf16 v[168:171], v[40:43], v[72:75], v[168:171]
ds_read_b64_tr_b16 v[96:97], v12 offset:8192
v_mfma_f32_16x16x32_bf16 v[172:175], v[40:43], v[76:79], v[172:175]
ds_read_b64_tr_b16 v[98:99], v12 offset:9216
v_mfma_f32_16x16x32_bf16 v[188:191], v[44:47], v[76:79], v[188:191]
s_add_u32 s72, s70, 15360
buffer_load_dwordx4 v5, s[4:7], s72 offen offset:1024 lds
v_mfma_f32_16x16x32_bf16 v[184:187], v[44:47], v[72:75], v[184:187]
ds_read_b64_tr_b16 v[100:101], v13 offset:8192
v_accvgpr_read_b32 v24, a248
v_mfma_f32_16x16x32_bf16 v[180:183], v[44:47], v[68:71], v[180:183]
ds_read_b64_tr_b16 v[102:103], v13 offset:9216
v_accvgpr_read_b32 v28, a249
v_mfma_f32_16x16x32_bf16 v[176:179], v[44:47], v[64:67], v[176:179]
ds_read_b64_tr_b16 v[104:105], v14 offset:8192
v_accvgpr_read_b32 v25, a250
v_mfma_f32_16x16x32_bf16 v[192:195], v[48:51], v[64:67], v[192:195]
ds_read_b64_tr_b16 v[106:107], v14 offset:9216
v_accvgpr_read_b32 v29, a251
v_mfma_f32_16x16x32_bf16 v[196:199], v[48:51], v[68:71], v[196:199]
s_add_u32 s72, s70, 129024
buffer_load_dwordx4 v4, s[4:7], s72 offen offset:2048 lds
v_mfma_f32_16x16x32_bf16 v[200:203], v[48:51], v[72:75], v[200:203]
ds_read_b64_tr_b16 v[108:109], v15 offset:8192
v_accvgpr_read_b32 v26, a252
v_mfma_f32_16x16x32_bf16 v[204:207], v[48:51], v[76:79], v[204:207]
ds_read_b64_tr_b16 v[110:111], v15 offset:9216
v_accvgpr_read_b32 v30, a253
v_mfma_f32_16x16x32_bf16 v[220:223], v[52:55], v[76:79], v[220:223]
buffer_store_dwordx4 v[20:23], v1, s[44:47], s80 offen sc1
v_mfma_f32_16x16x32_bf16 v[216:219], v[52:55], v[72:75], v[216:219]
v_accvgpr_read_b32 v27, a254
v_accvgpr_read_b32 v31, a255
v_mfma_f32_16x16x32_bf16 v[212:215], v[52:55], v[68:71], v[212:215]
s_add_u32 s72, s70, 144384
buffer_load_dwordx4 v5, s[4:7], s72 offen offset:3072 lds
v_mfma_f32_16x16x32_bf16 v[208:211], v[52:55], v[64:67], v[208:211]
v_cvt_pk_bf16_f32 v24, v24, v28
v_cvt_pk_bf16_f32 v25, v25, v29
v_mfma_f32_16x16x32_bf16 v[224:227], v[56:59], v[64:67], v[224:227]
v_cvt_pk_bf16_f32 v26, v26, v30
v_cvt_pk_bf16_f32 v27, v27, v31
v_mfma_f32_16x16x32_bf16 v[228:231], v[56:59], v[68:71], v[228:231]
s_add_u32 s80, s78, 44032
buffer_store_dwordx4 v[24:27], v1, s[44:47], s80 offen sc1
v_mfma_f32_16x16x32_bf16 v[232:235], v[56:59], v[72:75], v[232:235]
v_mfma_f32_16x16x32_bf16 v[236:239], v[56:59], v[76:79], v[236:239]
v_mfma_f32_16x16x32_bf16 v[252:255], v[60:63], v[76:79], v[252:255]
v_mfma_f32_16x16x32_bf16 v[248:251], v[60:63], v[72:75], v[248:251]
v_mfma_f32_16x16x32_bf16 v[244:247], v[60:63], v[68:71], v[244:247]
s_waitcnt vmcnt(16) lgkmcnt(0)
v_mfma_f32_16x16x32_bf16 v[240:243], v[60:63], v[64:67], v[240:243]
s_barrier
v_mfma_f32_16x16x32_bf16 v[128:131], v[80:83], v[112:115], v[128:131]
s_add_u32 s73, s62, 12
ds_read_b64_tr_b16 v[32:33], v8 offset:16384
ds_read_b64_tr_b16 v[34:35], v8 offset:17408
v_mfma_f32_16x16x32_bf16 v[132:135], v[80:83], v[116:119], v[132:135]
s_add_u32 s70, s73, s65
ds_read_b128 v[64:67], v18 offset:0
ds_read_b128 v[68:71], v18 offset:2048
v_mfma_f32_16x16x32_bf16 v[136:139], v[80:83], v[120:123], v[136:139]
s_and_b32 s70, s70, 3
v_and_b32 v2, 31, v0
v_lshlrev_b32 v2, 2, v2
v_mfma_f32_16x16x32_bf16 v[140:143], v[80:83], v[124:127], v[140:143]
s_and_b32 s73, s73, 12
buffer_load_dword v3, v2, s[48:51], 0 offen sc1
v_mfma_f32_16x16x32_bf16 v[156:159], v[84:87], v[124:127], v[156:159]
s_or_b32 s73, s73, s70
ds_read_b128 v[72:75], v18 offset:4096
ds_read_b128 v[76:79], v18 offset:6144
v_mfma_f32_16x16x32_bf16 v[152:155], v[84:87], v[120:123], v[152:155]
s_lshl_b32 s71, s73, 19
ds_read_b64_tr_b16 v[36:37], v9 offset:16384
ds_read_b64_tr_b16 v[38:39], v9 offset:17408
v_mfma_f32_16x16x32_bf16 v[148:151], v[84:87], v[116:119], v[148:151]
s_add_u32 s71, s71, s66
ds_read_b64_tr_b16 v[40:41], v10 offset:16384
v_mfma_f32_16x16x32_bf16 v[144:147], v[84:87], v[112:115], v[144:147]
s_lshl_b32 s73, s73, 7
ds_read_b64_tr_b16 v[42:43], v10 offset:17408
v_mfma_f32_16x16x32_bf16 v[160:163], v[88:91], v[112:115], v[160:163]
s_add_u32 s69, s73, s67
ds_read_b64_tr_b16 v[44:45], v11 offset:16384
v_mfma_f32_16x16x32_bf16 v[164:167], v[88:91], v[116:119], v[164:167]
s_add_u32 s70, s73, s68
ds_read_b64_tr_b16 v[46:47], v11 offset:17408
v_mfma_f32_16x16x32_bf16 v[168:171], v[88:91], v[120:123], v[168:171]
s_add_u32 m0, s64, 0
ds_read_b64_tr_b16 v[48:49], v12 offset:16384
v_mfma_f32_16x16x32_bf16 v[172:175], v[88:91], v[124:127], v[172:175]
s_add_u32 s72, s71, 0
buffer_load_dwordx4 v6, s[12:15], s72 offen lds
v_mfma_f32_16x16x32_bf16 v[188:191], v[92:95], v[124:127], v[188:191]
s_add_u32 s72, s71, 31744
buffer_load_dwordx4 v6, s[12:15], s72 offen offset:1024 lds
v_mfma_f32_16x16x32_bf16 v[184:187], v[92:95], v[120:123], v[184:187]
s_add_u32 s72, s71, 63488
buffer_load_dwordx4 v7, s[12:15], s72 offen offset:2048 lds
v_mfma_f32_16x16x32_bf16 v[180:183], v[92:95], v[116:119], v[180:183]
s_add_u32 s72, s71, 95232
buffer_load_dwordx4 v7, s[12:15], s72 offen offset:3072 lds
v_mfma_f32_16x16x32_bf16 v[176:179], v[92:95], v[112:115], v[176:179]
ds_read_b64_tr_b16 v[50:51], v12 offset:17408
v_mfma_f32_16x16x32_bf16 v[192:195], v[96:99], v[112:115], v[192:195]
ds_read_b64_tr_b16 v[52:53], v13 offset:16384
v_mfma_f32_16x16x32_bf16 v[196:199], v[96:99], v[116:119], v[196:199]
ds_read_b64_tr_b16 v[54:55], v13 offset:17408
v_mfma_f32_16x16x32_bf16 v[200:203], v[96:99], v[120:123], v[200:203]
ds_read_b64_tr_b16 v[56:57], v14 offset:16384
v_mfma_f32_16x16x32_bf16 v[204:207], v[96:99], v[124:127], v[204:207]
s_add_u32 m0, s63, 131072
ds_read_b64_tr_b16 v[58:59], v14 offset:17408
v_mfma_f32_16x16x32_bf16 v[220:223], v[100:103], v[124:127], v[220:223]
s_add_u32 s72, s69, 0
buffer_load_dwordx4 v4, s[4:7], s72 offen lds
v_mfma_f32_16x16x32_bf16 v[216:219], v[100:103], v[120:123], v[216:219]
ds_read_b64_tr_b16 v[60:61], v15 offset:16384
v_mfma_f32_16x16x32_bf16 v[212:215], v[100:103], v[116:119], v[212:215]
ds_read_b64_tr_b16 v[62:63], v15 offset:17408
v_mfma_f32_16x16x32_bf16 v[208:211], v[100:103], v[112:115], v[208:211]
v_mfma_f32_16x16x32_bf16 v[224:227], v[104:107], v[112:115], v[224:227]
s_add_u32 s72, s69, 15360
buffer_load_dwordx4 v5, s[4:7], s72 offen offset:1024 lds
v_mfma_f32_16x16x32_bf16 v[228:231], v[104:107], v[116:119], v[228:231]
v_mfma_f32_16x16x32_bf16 v[232:235], v[104:107], v[120:123], v[232:235]
v_mfma_f32_16x16x32_bf16 v[236:239], v[104:107], v[124:127], v[236:239]
v_mfma_f32_16x16x32_bf16 v[252:255], v[108:111], v[124:127], v[252:255]
v_mfma_f32_16x16x32_bf16 v[248:251], v[108:111], v[120:123], v[248:251]
s_add_u32 s72, s69, 129024
buffer_load_dwordx4 v4, s[4:7], s72 offen offset:2048 lds
v_mfma_f32_16x16x32_bf16 v[244:247], v[108:111], v[116:119], v[244:247]
v_mfma_f32_16x16x32_bf16 v[240:243], v[108:111], v[112:115], v[240:243]
s_waitcnt lgkmcnt(0)
v_mfma_f32_16x16x32_bf16 v[128:131], v[32:35], v[64:67], v[128:131]
ds_read_b64_tr_b16 v[80:81], v8 offset:24576
ds_read_b64_tr_b16 v[82:83], v8 offset:25600
v_mfma_f32_16x16x32_bf16 v[132:135], v[32:35], v[68:71], v[132:135]
ds_read_b128 v[112:115], v19 offset:0
ds_read_b128 v[116:119], v19 offset:2048
v_mfma_f32_16x16x32_bf16 v[136:139], v[32:35], v[72:75], v[136:139]
s_add_u32 s72, s69, 144384
buffer_load_dwordx4 v5, s[4:7], s72 offen offset:3072 lds
v_mfma_f32_16x16x32_bf16 v[140:143], v[32:35], v[76:79], v[140:143]
ds_read_b128 v[120:123], v19 offset:4096
ds_read_b128 v[124:127], v19 offset:6144
v_mfma_f32_16x16x32_bf16 v[156:159], v[36:39], v[76:79], v[156:159]
ds_read_b64_tr_b16 v[84:85], v9 offset:24576
ds_read_b64_tr_b16 v[86:87], v9 offset:25600
v_mfma_f32_16x16x32_bf16 v[152:155], v[36:39], v[72:75], v[152:155]
ds_read_b64_tr_b16 v[88:89], v10 offset:24576
v_mfma_f32_16x16x32_bf16 v[148:151], v[36:39], v[68:71], v[148:151]
ds_read_b64_tr_b16 v[90:91], v10 offset:25600
v_mfma_f32_16x16x32_bf16 v[144:147], v[36:39], v[64:67], v[144:147]
s_add_u32 m0, s63, 135168
ds_read_b64_tr_b16 v[92:93], v11 offset:24576
v_mfma_f32_16x16x32_bf16 v[160:163], v[40:43], v[64:67], v[160:163]
s_add_u32 s72, s70, 0
buffer_load_dwordx4 v4, s[4:7], s72 offen lds
v_mfma_f32_16x16x32_bf16 v[164:167], v[40:43], v[68:71], v[164:167]
ds_read_b64_tr_b16 v[94:95], v11 offset:25600
v_mfma_f32_16x16x32_bf16 v[168:171], v[40:43], v[72:75], v[168:171]
ds_read_b64_tr_b16 v[96:97], v12 offset:24576
v_mfma_f32_16x16x32_bf16 v[172:175], v[40:43], v[76:79], v[172:175]
ds_read_b64_tr_b16 v[98:99], v12 offset:25600
v_mfma_f32_16x16x32_bf16 v[188:191], v[44:47], v[76:79], v[188:191]
s_add_u32 s72, s70, 15360
buffer_load_dwordx4 v5, s[4:7], s72 offen offset:1024 lds
v_mfma_f32_16x16x32_bf16 v[184:187], v[44:47], v[72:75], v[184:187]
ds_read_b64_tr_b16 v[100:101], v13 offset:24576
v_mfma_f32_16x16x32_bf16 v[180:183], v[44:47], v[68:71], v[180:183]
ds_read_b64_tr_b16 v[102:103], v13 offset:25600
v_mfma_f32_16x16x32_bf16 v[176:179], v[44:47], v[64:67], v[176:179]
ds_read_b64_tr_b16 v[104:105], v14 offset:24576
v_mfma_f32_16x16x32_bf16 v[192:195], v[48:51], v[64:67], v[192:195]
ds_read_b64_tr_b16 v[106:107], v14 offset:25600
v_mfma_f32_16x16x32_bf16 v[196:199], v[48:51], v[68:71], v[196:199]
s_add_u32 s72, s70, 129024
buffer_load_dwordx4 v4, s[4:7], s72 offen offset:2048 lds
v_mfma_f32_16x16x32_bf16 v[200:203], v[48:51], v[72:75], v[200:203]
ds_read_b64_tr_b16 v[108:109], v15 offset:24576
v_mfma_f32_16x16x32_bf16 v[204:207], v[48:51], v[76:79], v[204:207]
ds_read_b64_tr_b16 v[110:111], v15 offset:25600
v_mfma_f32_16x16x32_bf16 v[220:223], v[52:55], v[76:79], v[220:223]
v_mfma_f32_16x16x32_bf16 v[216:219], v[52:55], v[72:75], v[216:219]
v_mfma_f32_16x16x32_bf16 v[212:215], v[52:55], v[68:71], v[212:215]
s_add_u32 s72, s70, 144384
buffer_load_dwordx4 v5, s[4:7], s72 offen offset:3072 lds
v_mfma_f32_16x16x32_bf16 v[208:211], v[52:55], v[64:67], v[208:211]
v_mfma_f32_16x16x32_bf16 v[224:227], v[56:59], v[64:67], v[224:227]
v_mfma_f32_16x16x32_bf16 v[228:231], v[56:59], v[68:71], v[228:231]
v_mfma_f32_16x16x32_bf16 v[232:235], v[56:59], v[72:75], v[232:235]
v_mfma_f32_16x16x32_bf16 v[236:239], v[56:59], v[76:79], v[236:239]
v_mfma_f32_16x16x32_bf16 v[252:255], v[60:63], v[76:79], v[252:255]
v_mfma_f32_16x16x32_bf16 v[248:251], v[60:63], v[72:75], v[248:251]
v_mfma_f32_16x16x32_bf16 v[244:247], v[60:63], v[68:71], v[244:247]
s_waitcnt vmcnt(13) lgkmcnt(0)
v_mfma_f32_16x16x32_bf16 v[240:243], v[60:63], v[64:67], v[240:243]
s_barrier
v_mfma_f32_16x16x32_bf16 v[128:131], v[80:83], v[112:115], v[128:131]
s_add_u32 s73, s62, 13
ds_read_b64_tr_b16 v[32:33], v8 offset:32768
ds_read_b64_tr_b16 v[34:35], v8 offset:33792
v_mfma_f32_16x16x32_bf16 v[132:135], v[80:83], v[116:119], v[132:135]
s_add_u32 s70, s73, s65
ds_read_b128 v[64:67], v18 offset:32768
ds_read_b128 v[68:71], v18 offset:34816
v_mfma_f32_16x16x32_bf16 v[136:139], v[80:83], v[120:123], v[136:139]
s_and_b32 s70, s70, 3
ds_read_b128 v[72:75], v18 offset:36864
ds_read_b128 v[76:79], v18 offset:38912
v_mfma_f32_16x16x32_bf16 v[140:143], v[80:83], v[124:127], v[140:143]
s_and_b32 s73, s73, 12
ds_read_b64_tr_b16 v[36:37], v9 offset:32768
ds_read_b64_tr_b16 v[38:39], v9 offset:33792
v_mfma_f32_16x16x32_bf16 v[156:159], v[84:87], v[124:127], v[156:159]
s_or_b32 s73, s73, s70
ds_read_b64_tr_b16 v[40:41], v10 offset:32768
v_or_b32 v20, s58, v0
v_mfma_f32_16x16x32_bf16 v[152:155], v[84:87], v[120:123], v[152:155]
s_lshl_b32 s71, s73, 19
ds_read_b64_tr_b16 v[42:43], v10 offset:33792
v_mov_b32 v21, 1
v_mfma_f32_16x16x32_bf16 v[148:151], v[84:87], v[116:119], v[148:151]
s_add_u32 s71, s71, s66
ds_read_b64_tr_b16 v[44:45], v11 offset:32768
v_min_u32 v20, 1, v20
v_mfma_f32_16x16x32_bf16 v[144:147], v[84:87], v[112:115], v[144:147]
s_lshl_b32 s73, s73, 7
ds_read_b64_tr_b16 v[46:47], v11 offset:33792
v_lshlrev_b32 v20, 30, v20
v_mfma_f32_16x16x32_bf16 v[160:163], v[88:91], v[112:115], v[160:163]
s_add_u32 s69, s73, s67
ds_read_b64_tr_b16 v[48:49], v12 offset:32768
v_mfma_f32_16x16x32_bf16 v[164:167], v[88:91], v[116:119], v[164:167]
s_add_u32 s70, s73, s68
ds_read_b64_tr_b16 v[50:51], v12 offset:33792
v_mfma_f32_16x16x32_bf16 v[168:171], v[88:91], v[120:123], v[168:171]
s_add_u32 m0, s64, 16384
ds_read_b64_tr_b16 v[52:53], v13 offset:32768
v_mfma_f32_16x16x32_bf16 v[172:175], v[88:91], v[124:127], v[172:175]
s_add_u32 s72, s71, 0
buffer_load_dwordx4 v6, s[12:15], s72 offen lds
v_mfma_f32_16x16x32_bf16 v[188:191], v[92:95], v[124:127], v[188:191]
s_add_u32 s72, s71, 31744
buffer_load_dwordx4 v6, s[12:15], s72 offen offset:1024 lds
v_mfma_f32_16x16x32_bf16 v[184:187], v[92:95], v[120:123], v[184:187]
s_add_u32 s72, s71, 63488
buffer_load_dwordx4 v7, s[12:15], s72 offen offset:2048 lds
v_mfma_f32_16x16x32_bf16 v[180:183], v[92:95], v[116:119], v[180:183]
s_add_u32 s72, s71, 95232
buffer_load_dwordx4 v7, s[12:15], s72 offen offset:3072 lds
v_mfma_f32_16x16x32_bf16 v[176:179], v[92:95], v[112:115], v[176:179]
ds_read_b64_tr_b16 v[54:55], v13 offset:33792
v_mfma_f32_16x16x32_bf16 v[192:195], v[96:99], v[112:115], v[192:195]
ds_read_b64_tr_b16 v[56:57], v14 offset:32768
v_mfma_f32_16x16x32_bf16 v[196:199], v[96:99], v[116:119], v[196:199]
ds_read_b64_tr_b16 v[58:59], v14 offset:33792
v_mfma_f32_16x16x32_bf16 v[200:203], v[96:99], v[120:123], v[200:203]
ds_read_b64_tr_b16 v[60:61], v15 offset:32768
v_mfma_f32_16x16x32_bf16 v[204:207], v[96:99], v[124:127], v[204:207]
s_add_u32 m0, s63, 65536
ds_read_b64_tr_b16 v[62:63], v15 offset:33792
v_mfma_f32_16x16x32_bf16 v[220:223], v[100:103], v[124:127], v[220:223]
s_add_u32 s72, s69, 0
buffer_load_dwordx4 v4, s[4:7], s72 offen lds
v_mfma_f32_16x16x32_bf16 v[216:219], v[100:103], v[120:123], v[216:219]
buffer_store_dword v21, v20, s[44:47], s91 offen sc1
v_mfma_f32_16x16x32_bf16 v[212:215], v[100:103], v[116:119], v[212:215]
v_mfma_f32_16x16x32_bf16 v[208:211], v[100:103], v[112:115], v[208:211]
v_mfma_f32_16x16x32_bf16 v[224:227], v[104:107], v[112:115], v[224:227]
s_add_u32 s72, s69, 15360
buffer_load_dwordx4 v5, s[4:7], s72 offen offset:1024 lds
v_mfma_f32_16x16x32_bf16 v[228:231], v[104:107], v[116:119], v[228:231]
v_mfma_f32_16x16x32_bf16 v[232:235], v[104:107], v[120:123], v[232:235]
v_mfma_f32_16x16x32_bf16 v[236:239], v[104:107], v[124:127], v[236:239]
v_mfma_f32_16x16x32_bf16 v[252:255], v[108:111], v[124:127], v[252:255]
v_mfma_f32_16x16x32_bf16 v[248:251], v[108:111], v[120:123], v[248:251]
s_add_u32 s72, s69, 129024
buffer_load_dwordx4 v4, s[4:7], s72 offen offset:2048 lds
v_mfma_f32_16x16x32_bf16 v[244:247], v[108:111], v[116:119], v[244:247]
v_mfma_f32_16x16x32_bf16 v[240:243], v[108:111], v[112:115], v[240:243]
s_waitcnt lgkmcnt(0)
v_mfma_f32_16x16x32_bf16 v[128:131], v[32:35], v[64:67], v[128:131]
ds_read_b64_tr_b16 v[80:81], v8 offset:40960
ds_read_b64_tr_b16 v[82:83], v8 offset:41984
v_mfma_f32_16x16x32_bf16 v[132:135], v[32:35], v[68:71], v[132:135]
ds_read_b128 v[112:115], v19 offset:32768
ds_read_b128 v[116:119], v19 offset:34816
v_mfma_f32_16x16x32_bf16 v[136:139], v[32:35], v[72:75], v[136:139]
s_add_u32 s72, s69, 144384
buffer_load_dwordx4 v5, s[4:7], s72 offen offset:3072 lds
v_mfma_f32_16x16x32_bf16 v[140:143], v[32:35], v[76:79], v[140:143]
ds_read_b128 v[120:123], v19 offset:36864
ds_read_b128 v[124:127], v19 offset:38912
v_mfma_f32_16x16x32_bf16 v[156:159], v[36:39], v[76:79], v[156:159]
ds_read_b64_tr_b16 v[84:85], v9 offset:40960
ds_read_b64_tr_b16 v[86:87], v9 offset:41984
v_mfma_f32_16x16x32_bf16 v[152:155], v[36:39], v[72:75], v[152:155]
ds_read_b64_tr_b16 v[88:89], v10 offset:40960
v_mfma_f32_16x16x32_bf16 v[148:151], v[36:39], v[68:71], v[148:151]
ds_read_b64_tr_b16 v[90:91], v10 offset:41984
v_mfma_f32_16x16x32_bf16 v[144:147], v[36:39], v[64:67], v[144:147]
s_add_u32 m0, s63, 69632
ds_read_b64_tr_b16 v[92:93], v11 offset:40960
v_mfma_f32_16x16x32_bf16 v[160:163], v[40:43], v[64:67], v[160:163]
s_add_u32 s72, s70, 0
buffer_load_dwordx4 v4, s[4:7], s72 offen lds
v_mfma_f32_16x16x32_bf16 v[164:167], v[40:43], v[68:71], v[164:167]
ds_read_b64_tr_b16 v[94:95], v11 offset:41984
v_mfma_f32_16x16x32_bf16 v[168:171], v[40:43], v[72:75], v[168:171]
ds_read_b64_tr_b16 v[96:97], v12 offset:40960
v_mfma_f32_16x16x32_bf16 v[172:175], v[40:43], v[76:79], v[172:175]
ds_read_b64_tr_b16 v[98:99], v12 offset:41984
v_mfma_f32_16x16x32_bf16 v[188:191], v[44:47], v[76:79], v[188:191]
s_add_u32 s72, s70, 15360
buffer_load_dwordx4 v5, s[4:7], s72 offen offset:1024 lds
v_mfma_f32_16x16x32_bf16 v[184:187], v[44:47], v[72:75], v[184:187]
ds_read_b64_tr_b16 v[100:101], v13 offset:40960
v_mfma_f32_16x16x32_bf16 v[180:183], v[44:47], v[68:71], v[180:183]
ds_read_b64_tr_b16 v[102:103], v13 offset:41984
v_mfma_f32_16x16x32_bf16 v[176:179], v[44:47], v[64:67], v[176:179]
ds_read_b64_tr_b16 v[104:105], v14 offset:40960
v_mfma_f32_16x16x32_bf16 v[192:195], v[48:51], v[64:67], v[192:195]
ds_read_b64_tr_b16 v[106:107], v14 offset:41984
v_mfma_f32_16x16x32_bf16 v[196:199], v[48:51], v[68:71], v[196:199]
s_add_u32 s72, s70, 129024
buffer_load_dwordx4 v4, s[4:7], s72 offen offset:2048 lds
v_mfma_f32_16x16x32_bf16 v[200:203], v[48:51], v[72:75], v[200:203]
ds_read_b64_tr_b16 v[108:109], v15 offset:40960
v_mfma_f32_16x16x32_bf16 v[204:207], v[48:51], v[76:79], v[204:207]
ds_read_b64_tr_b16 v[110:111], v15 offset:41984
v_mfma_f32_16x16x32_bf16 v[220:223], v[52:55], v[76:79], v[220:223]
v_mfma_f32_16x16x32_bf16 v[216:219], v[52:55], v[72:75], v[216:219]
v_mfma_f32_16x16x32_bf16 v[212:215], v[52:55], v[68:71], v[212:215]
s_add_u32 s72, s70, 144384
buffer_load_dwordx4 v5, s[4:7], s72 offen offset:3072 lds
v_mfma_f32_16x16x32_bf16 v[208:211], v[52:55], v[64:67], v[208:211]
v_mfma_f32_16x16x32_bf16 v[224:227], v[56:59], v[64:67], v[224:227]
v_mfma_f32_16x16x32_bf16 v[228:231], v[56:59], v[68:71], v[228:231]
v_mfma_f32_16x16x32_bf16 v[232:235], v[56:59], v[72:75], v[232:235]
v_mfma_f32_16x16x32_bf16 v[236:239], v[56:59], v[76:79], v[236:239]
v_mfma_f32_16x16x32_bf16 v[252:255], v[60:63], v[76:79], v[252:255]
v_mfma_f32_16x16x32_bf16 v[248:251], v[60:63], v[72:75], v[248:251]
v_mfma_f32_16x16x32_bf16 v[244:247], v[60:63], v[68:71], v[244:247]
s_waitcnt vmcnt(13) lgkmcnt(0)
v_mfma_f32_16x16x32_bf16 v[240:243], v[60:63], v[64:67], v[240:243]
s_barrier
v_mfma_f32_16x16x32_bf16 v[128:131], v[80:83], v[112:115], v[128:131]
s_add_u32 s73, s62, 14
s_waitcnt vmcnt(25)
v_cmp_gt_u32 vcc, 8, v3
s_cbranch_vccnz Lspin1
Lback2:
v_mfma_f32_16x16x32_bf16 v[132:135], v[80:83], v[116:119], v[132:135]
s_add_u32 s70, s73, s65
ds_read_b64_tr_b16 v[32:33], v8 offset:0
ds_read_b64_tr_b16 v[34:35], v8 offset:1024
v_mfma_f32_16x16x32_bf16 v[136:139], v[80:83], v[120:123], v[136:139]
s_and_b32 s70, s70, 3
ds_read_b128 v[64:67], v16 offset:0
ds_read_b128 v[68:71], v16 offset:2048
v_mfma_f32_16x16x32_bf16 v[140:143], v[80:83], v[124:127], v[140:143]
s_and_b32 s73, s73, 12
ds_read_b128 v[72:75], v16 offset:4096
ds_read_b128 v[76:79], v16 offset:6144
v_mfma_f32_16x16x32_bf16 v[156:159], v[84:87], v[124:127], v[156:159]
s_or_b32 s73, s73, s70
ds_read_b64_tr_b16 v[36:37], v9 offset:0
ds_read_b64_tr_b16 v[38:39], v9 offset:1024
v_mfma_f32_16x16x32_bf16 v[152:155], v[84:87], v[120:123], v[152:155]
s_lshl_b32 s71, s73, 19
ds_read_b64_tr_b16 v[40:41], v10 offset:0
v_mfma_f32_16x16x32_bf16 v[148:151], v[84:87], v[116:119], v[148:151]
s_add_u32 s71, s71, s66
ds_read_b64_tr_b16 v[42:43], v10 offset:1024
v_mfma_f32_16x16x32_bf16 v[144:147], v[84:87], v[112:115], v[144:147]
s_lshl_b32 s73, s73, 7
ds_read_b64_tr_b16 v[44:45], v11 offset:0
v_mfma_f32_16x16x32_bf16 v[160:163], v[88:91], v[112:115], v[160:163]
s_add_u32 s69, s73, s67
ds_read_b64_tr_b16 v[46:47], v11 offset:1024
v_mfma_f32_16x16x32_bf16 v[164:167], v[88:91], v[116:119], v[164:167]
s_add_u32 s70, s73, s68
ds_read_b64_tr_b16 v[48:49], v12 offset:0
v_mfma_f32_16x16x32_bf16 v[168:171], v[88:91], v[120:123], v[168:171]
s_add_u32 m0, s64, 32768
ds_read_b64_tr_b16 v[50:51], v12 offset:1024
v_mfma_f32_16x16x32_bf16 v[172:175], v[88:91], v[124:127], v[172:175]
s_add_u32 s72, s71, 0
buffer_load_dwordx4 v6, s[12:15], s72 offen lds
v_mfma_f32_16x16x32_bf16 v[188:191], v[92:95], v[124:127], v[188:191]
s_add_u32 s72, s71, 31744
buffer_load_dwordx4 v6, s[12:15], s72 offen offset:1024 lds
v_mfma_f32_16x16x32_bf16 v[184:187], v[92:95], v[120:123], v[184:187]
s_add_u32 s72, s71, 63488
buffer_load_dwordx4 v7, s[12:15], s72 offen offset:2048 lds
v_mfma_f32_16x16x32_bf16 v[180:183], v[92:95], v[116:119], v[180:183]
s_add_u32 s72, s71, 95232
buffer_load_dwordx4 v7, s[12:15], s72 offen offset:3072 lds
v_mfma_f32_16x16x32_bf16 v[176:179], v[92:95], v[112:115], v[176:179]
ds_read_b64_tr_b16 v[52:53], v13 offset:0
v_mfma_f32_16x16x32_bf16 v[192:195], v[96:99], v[112:115], v[192:195]
ds_read_b64_tr_b16 v[54:55], v13 offset:1024
v_mfma_f32_16x16x32_bf16 v[196:199], v[96:99], v[116:119], v[196:199]
ds_read_b64_tr_b16 v[56:57], v14 offset:0
v_mfma_f32_16x16x32_bf16 v[200:203], v[96:99], v[120:123], v[200:203]
ds_read_b64_tr_b16 v[58:59], v14 offset:1024
v_mfma_f32_16x16x32_bf16 v[204:207], v[96:99], v[124:127], v[204:207]
s_add_u32 m0, s63, 98304
ds_read_b64_tr_b16 v[60:61], v15 offset:0
v_mfma_f32_16x16x32_bf16 v[220:223], v[100:103], v[124:127], v[220:223]
s_add_u32 s72, s69, 0
buffer_load_dwordx4 v4, s[4:7], s72 offen lds
v_mfma_f32_16x16x32_bf16 v[216:219], v[100:103], v[120:123], v[216:219]
ds_read_b64_tr_b16 v[62:63], v15 offset:1024
v_mfma_f32_16x16x32_bf16 v[212:215], v[100:103], v[116:119], v[212:215]
v_mfma_f32_16x16x32_bf16 v[208:211], v[100:103], v[112:115], v[208:211]
v_mfma_f32_16x16x32_bf16 v[224:227], v[104:107], v[112:115], v[224:227]
s_add_u32 s72, s69, 15360
buffer_load_dwordx4 v5, s[4:7], s72 offen offset:1024 lds
v_mfma_f32_16x16x32_bf16 v[228:231], v[104:107], v[116:119], v[228:231]
v_mfma_f32_16x16x32_bf16 v[232:235], v[104:107], v[120:123], v[232:235]
v_mfma_f32_16x16x32_bf16 v[236:239], v[104:107], v[124:127], v[236:239]
v_mfma_f32_16x16x32_bf16 v[252:255], v[108:111], v[124:127], v[252:255]
v_mfma_f32_16x16x32_bf16 v[248:251], v[108:111], v[120:123], v[248:251]
s_add_u32 s72, s69, 129024
buffer_load_dwordx4 v4, s[4:7], s72 offen offset:2048 lds
v_mfma_f32_16x16x32_bf16 v[244:247], v[108:111], v[116:119], v[244:247]
v_mfma_f32_16x16x32_bf16 v[240:243], v[108:111], v[112:115], v[240:243]
s_waitcnt lgkmcnt(0)
v_mfma_f32_16x16x32_bf16 v[128:131], v[32:35], v[64:67], v[128:131]
ds_read_b64_tr_b16 v[80:81], v8 offset:8192
ds_read_b64_tr_b16 v[82:83], v8 offset:9216
v_mfma_f32_16x16x32_bf16 v[132:135], v[32:35], v[68:71], v[132:135]
ds_read_b128 v[112:115], v17 offset:0
ds_read_b128 v[116:119], v17 offset:2048
v_mfma_f32_16x16x32_bf16 v[136:139], v[32:35], v[72:75], v[136:139]
s_add_u32 s72, s69, 144384
buffer_load_dwordx4 v5, s[4:7], s72 offen offset:3072 lds
v_mfma_f32_16x16x32_bf16 v[140:143], v[32:35], v[76:79], v[140:143]
ds_read_b128 v[120:123], v17 offset:4096
ds_read_b128 v[124:127], v17 offset:6144
v_mfma_f32_16x16x32_bf16 v[156:159], v[36:39], v[76:79], v[156:159]
ds_read_b64_tr_b16 v[84:85], v9 offset:8192
ds_read_b64_tr_b16 v[86:87], v9 offset:9216
v_mfma_f32_16x16x32_bf16 v[152:155], v[36:39], v[72:75], v[152:155]
ds_read_b64_tr_b16 v[88:89], v10 offset:8192
v_mfma_f32_16x16x32_bf16 v[148:151], v[36:39], v[68:71], v[148:151]
ds_read_b64_tr_b16 v[90:91], v10 offset:9216
v_mfma_f32_16x16x32_bf16 v[144:147], v[36:39], v[64:67], v[144:147]
s_add_u32 m0, s63, 102400
ds_read_b64_tr_b16 v[92:93], v11 offset:8192
v_mfma_f32_16x16x32_bf16 v[160:163], v[40:43], v[64:67], v[160:163]
s_add_u32 s72, s70, 0
buffer_load_dwordx4 v4, s[4:7], s72 offen lds
v_mfma_f32_16x16x32_bf16 v[164:167], v[40:43], v[68:71], v[164:167]
ds_read_b64_tr_b16 v[94:95], v11 offset:9216
v_mfma_f32_16x16x32_bf16 v[168:171], v[40:43], v[72:75], v[168:171]
ds_read_b64_tr_b16 v[96:97], v12 offset:8192
v_mfma_f32_16x16x32_bf16 v[172:175], v[40:43], v[76:79], v[172:175]
ds_read_b64_tr_b16 v[98:99], v12 offset:9216
v_mfma_f32_16x16x32_bf16 v[188:191], v[44:47], v[76:79], v[188:191]
s_add_u32 s72, s70, 15360
buffer_load_dwordx4 v5, s[4:7], s72 offen offset:1024 lds
v_mfma_f32_16x16x32_bf16 v[184:187], v[44:47], v[72:75], v[184:187]
ds_read_b64_tr_b16 v[100:101], v13 offset:8192
v_mfma_f32_16x16x32_bf16 v[180:183], v[44:47], v[68:71], v[180:183]
ds_read_b64_tr_b16 v[102:103], v13 offset:9216
v_mfma_f32_16x16x32_bf16 v[176:179], v[44:47], v[64:67], v[176:179]
ds_read_b64_tr_b16 v[104:105], v14 offset:8192
v_mfma_f32_16x16x32_bf16 v[192:195], v[48:51], v[64:67], v[192:195]
ds_read_b64_tr_b16 v[106:107], v14 offset:9216
v_mfma_f32_16x16x32_bf16 v[196:199], v[48:51], v[68:71], v[196:199]
s_add_u32 s72, s70, 129024
buffer_load_dwordx4 v4, s[4:7], s72 offen offset:2048 lds
v_mfma_f32_16x16x32_bf16 v[200:203], v[48:51], v[72:75], v[200:203]
ds_read_b64_tr_b16 v[108:109], v15 offset:8192
v_mfma_f32_16x16x32_bf16 v[204:207], v[48:51], v[76:79], v[204:207]
ds_read_b64_tr_b16 v[110:111], v15 offset:9216
v_mfma_f32_16x16x32_bf16 v[220:223], v[52:55], v[76:79], v[220:223]
v_mfma_f32_16x16x32_bf16 v[216:219], v[52:55], v[72:75], v[216:219]
v_mfma_f32_16x16x32_bf16 v[212:215], v[52:55], v[68:71], v[212:215]
s_add_u32 s72, s70, 144384
buffer_load_dwordx4 v5, s[4:7], s72 offen offset:3072 lds
v_mfma_f32_16x16x32_bf16 v[208:211], v[52:55], v[64:67], v[208:211]
v_mfma_f32_16x16x32_bf16 v[224:227], v[56:59], v[64:67], v[224:227]
v_mfma_f32_16x16x32_bf16 v[228:231], v[56:59], v[68:71], v[228:231]
v_mfma_f32_16x16x32_bf16 v[232:235], v[56:59], v[72:75], v[232:235]
v_mfma_f32_16x16x32_bf16 v[236:239], v[56:59], v[76:79], v[236:239]
v_mfma_f32_16x16x32_bf16 v[252:255], v[60:63], v[76:79], v[252:255]
v_mfma_f32_16x16x32_bf16 v[248:251], v[60:63], v[72:75], v[248:251]
v_mfma_f32_16x16x32_bf16 v[244:247], v[60:63], v[68:71], v[244:247]
s_waitcnt vmcnt(12) lgkmcnt(0)
v_mfma_f32_16x16x32_bf16 v[240:243], v[60:63], v[64:67], v[240:243]
s_barrier
v_mfma_f32_16x16x32_bf16 v[128:131], v[80:83], v[112:115], v[128:131]
s_add_u32 s73, s62, 15
ds_read_b64_tr_b16 v[32:33], v8 offset:16384
ds_read_b64_tr_b16 v[34:35], v8 offset:17408
v_mfma_f32_16x16x32_bf16 v[132:135], v[80:83], v[116:119], v[132:135]
s_add_u32 s70, s73, s65
ds_read_b128 v[64:67], v18 offset:0
ds_read_b128 v[68:71], v18 offset:2048
v_mfma_f32_16x16x32_bf16 v[136:139], v[80:83], v[120:123], v[136:139]
s_and_b32 s70, s70, 3
ds_read_b128 v[72:75], v18 offset:4096
ds_read_b128 v[76:79], v18 offset:6144
v_mfma_f32_16x16x32_bf16 v[140:143], v[80:83], v[124:127], v[140:143]
s_and_b32 s73, s73, 12
ds_read_b64_tr_b16 v[36:37], v9 offset:16384
ds_read_b64_tr_b16 v[38:39], v9 offset:17408
v_mfma_f32_16x16x32_bf16 v[156:159], v[84:87], v[124:127], v[156:159]
s_or_b32 s73, s73, s70
ds_read_b64_tr_b16 v[40:41], v10 offset:16384
v_mfma_f32_16x16x32_bf16 v[152:155], v[84:87], v[120:123], v[152:155]
s_lshl_b32 s71, s73, 19
ds_read_b64_tr_b16 v[42:43], v10 offset:17408
v_mfma_f32_16x16x32_bf16 v[148:151], v[84:87], v[116:119], v[148:151]
s_add_u32 s71, s71, s66
ds_read_b64_tr_b16 v[44:45], v11 offset:16384
v_mfma_f32_16x16x32_bf16 v[144:147], v[84:87], v[112:115], v[144:147]
s_lshl_b32 s73, s73, 7
ds_read_b64_tr_b16 v[46:47], v11 offset:17408
v_mfma_f32_16x16x32_bf16 v[160:163], v[88:91], v[112:115], v[160:163]
s_add_u32 s69, s73, s67
ds_read_b64_tr_b16 v[48:49], v12 offset:16384
v_mfma_f32_16x16x32_bf16 v[164:167], v[88:91], v[116:119], v[164:167]
s_add_u32 s70, s73, s68
ds_read_b64_tr_b16 v[50:51], v12 offset:17408
v_mfma_f32_16x16x32_bf16 v[168:171], v[88:91], v[120:123], v[168:171]
s_add_u32 m0, s64, 0
ds_read_b64_tr_b16 v[52:53], v13 offset:16384
v_mfma_f32_16x16x32_bf16 v[172:175], v[88:91], v[124:127], v[172:175]
s_add_u32 s72, s71, 0
buffer_load_dwordx4 v6, s[12:15], s72 offen lds
v_mfma_f32_16x16x32_bf16 v[188:191], v[92:95], v[124:127], v[188:191]
s_add_u32 s72, s71, 31744
buffer_load_dwordx4 v6, s[12:15], s72 offen offset:1024 lds
v_mfma_f32_16x16x32_bf16 v[184:187], v[92:95], v[120:123], v[184:187]
s_add_u32 s72, s71, 63488
buffer_load_dwordx4 v7, s[12:15], s72 offen offset:2048 lds
v_mfma_f32_16x16x32_bf16 v[180:183], v[92:95], v[116:119], v[180:183]
s_add_u32 s72, s71, 95232
buffer_load_dwordx4 v7, s[12:15], s72 offen offset:3072 lds
v_mfma_f32_16x16x32_bf16 v[176:179], v[92:95], v[112:115], v[176:179]
s_and_b32 s75, s91, 0xfffffc7f
v_lshrrev_b32 v2, 3, v0
v_lshlrev_b32 v2, 7, v2
v_mfma_f32_16x16x32_bf16 v[192:195], v[96:99], v[112:115], v[192:195]
buffer_load_dword v3, v2, s[44:47], s75 offen sc1
v_mfma_f32_16x16x32_bf16 v[196:199], v[96:99], v[116:119], v[196:199]
ds_read_b64_tr_b16 v[54:55], v13 offset:17408
v_mfma_f32_16x16x32_bf16 v[200:203], v[96:99], v[120:123], v[200:203]
ds_read_b64_tr_b16 v[56:57], v14 offset:16384
v_mfma_f32_16x16x32_bf16 v[204:207], v[96:99], v[124:127], v[204:207]
s_add_u32 m0, s63, 131072
ds_read_b64_tr_b16 v[58:59], v14 offset:17408
v_mfma_f32_16x16x32_bf16 v[220:223], v[100:103], v[124:127], v[220:223]
s_add_u32 s72, s69, 0
buffer_load_dwordx4 v4, s[4:7], s72 offen lds
v_mfma_f32_16x16x32_bf16 v[216:219], v[100:103], v[120:123], v[216:219]
ds_read_b64_tr_b16 v[60:61], v15 offset:16384
v_mfma_f32_16x16x32_bf16 v[212:215], v[100:103], v[116:119], v[212:215]
ds_read_b64_tr_b16 v[62:63], v15 offset:17408
v_mfma_f32_16x16x32_bf16 v[208:211], v[100:103], v[112:115], v[208:211]
v_mfma_f32_16x16x32_bf16 v[224:227], v[104:107], v[112:115], v[224:227]
s_add_u32 s72, s69, 15360
buffer_load_dwordx4 v5, s[4:7], s72 offen offset:1024 lds
v_mfma_f32_16x16x32_bf16 v[228:231], v[104:107], v[116:119], v[228:231]
v_mfma_f32_16x16x32_bf16 v[232:235], v[104:107], v[120:123], v[232:235]
v_mfma_f32_16x16x32_bf16 v[236:239], v[104:107], v[124:127], v[236:239]
v_mfma_f32_16x16x32_bf16 v[252:255], v[108:111], v[124:127], v[252:255]
v_mfma_f32_16x16x32_bf16 v[248:251], v[108:111], v[120:123], v[248:251]
s_add_u32 s72, s69, 129024
buffer_load_dwordx4 v4, s[4:7], s72 offen offset:2048 lds
v_mfma_f32_16x16x32_bf16 v[244:247], v[108:111], v[116:119], v[244:247]
v_mfma_f32_16x16x32_bf16 v[240:243], v[108:111], v[112:115], v[240:243]
s_waitcnt lgkmcnt(0)
v_mfma_f32_16x16x32_bf16 v[128:131], v[32:35], v[64:67], v[128:131]
v_accvgpr_write_b32 a0, -1
v_accvgpr_write_b32 a1, -1
v_mfma_f32_16x16x32_bf16 v[132:135], v[32:35], v[68:71], v[132:135]
v_accvgpr_write_b32 a2, -1
v_accvgpr_write_b32 a3, -1
v_mfma_f32_16x16x32_bf16 v[136:139], v[32:35], v[72:75], v[136:139]
s_add_u32 s72, s69, 144384
buffer_load_dwordx4 v5, s[4:7], s72 offen offset:3072 lds
v_mfma_f32_16x16x32_bf16 v[140:143], v[32:35], v[76:79], v[140:143]
s_add_u32 s80, s93, 0x3a00000
ds_read_b64_tr_b16 v[80:81], v8 offset:24576
ds_read_b64_tr_b16 v[82:83], v8 offset:25600
v_mfma_f32_16x16x32_bf16 v[156:159], v[36:39], v[76:79], v[156:159]
ds_read_b128 v[112:115], v19 offset:0
ds_read_b128 v[116:119], v19 offset:2048
v_mfma_f32_16x16x32_bf16 v[152:155], v[36:39], v[72:75], v[152:155]
ds_read_b128 v[120:123], v19 offset:4096
ds_read_b128 v[124:127], v19 offset:6144
v_mfma_f32_16x16x32_bf16 v[148:151], v[36:39], v[68:71], v[148:151]
ds_read_b64_tr_b16 v[84:85], v9 offset:24576
ds_read_b64_tr_b16 v[86:87], v9 offset:25600
v_mfma_f32_16x16x32_bf16 v[144:147], v[36:39], v[64:67], v[144:147]
s_add_u32 m0, s63, 135168
ds_read_b64_tr_b16 v[88:89], v10 offset:24576
v_mfma_f32_16x16x32_bf16 v[160:163], v[40:43], v[64:67], v[160:163]
s_add_u32 s72, s70, 0
buffer_load_dwordx4 v4, s[4:7], s72 offen lds
v_mfma_f32_16x16x32_bf16 v[164:167], v[40:43], v[68:71], v[164:167]
ds_read_b64_tr_b16 v[90:91], v10 offset:25600
v_mfma_f32_16x16x32_bf16 v[168:171], v[40:43], v[72:75], v[168:171]
ds_read_b64_tr_b16 v[92:93], v11 offset:24576
v_mfma_f32_16x16x32_bf16 v[172:175], v[40:43], v[76:79], v[172:175]
ds_read_b64_tr_b16 v[94:95], v11 offset:25600
v_mfma_f32_16x16x32_bf16 v[188:191], v[44:47], v[76:79], v[188:191]
s_add_u32 s72, s70, 15360
buffer_load_dwordx4 v5, s[4:7], s72 offen offset:1024 lds
v_mfma_f32_16x16x32_bf16 v[184:187], v[44:47], v[72:75], v[184:187]
ds_read_b64_tr_b16 v[96:97], v12 offset:24576
v_mfma_f32_16x16x32_bf16 v[180:183], v[44:47], v[68:71], v[180:183]
ds_read_b64_tr_b16 v[98:99], v12 offset:25600
v_mfma_f32_16x16x32_bf16 v[176:179], v[44:47], v[64:67], v[176:179]
ds_read_b64_tr_b16 v[100:101], v13 offset:24576
v_mfma_f32_16x16x32_bf16 v[192:195], v[48:51], v[64:67], v[192:195]
ds_read_b64_tr_b16 v[102:103], v13 offset:25600
v_mfma_f32_16x16x32_bf16 v[196:199], v[48:51], v[68:71], v[196:199]
s_add_u32 s72, s70, 129024
buffer_load_dwordx4 v4, s[4:7], s72 offen offset:2048 lds
v_mfma_f32_16x16x32_bf16 v[200:203], v[48:51], v[72:75], v[200:203]
ds_read_b64_tr_b16 v[104:105], v14 offset:24576
v_mfma_f32_16x16x32_bf16 v[204:207], v[48:51], v[76:79], v[204:207]
ds_read_b64_tr_b16 v[106:107], v14 offset:25600
v_mfma_f32_16x16x32_bf16 v[220:223], v[52:55], v[76:79], v[220:223]
ds_read_b64_tr_b16 v[108:109], v15 offset:24576
v_mfma_f32_16x16x32_bf16 v[216:219], v[52:55], v[72:75], v[216:219]
ds_read_b64_tr_b16 v[110:111], v15 offset:25600
v_mfma_f32_16x16x32_bf16 v[212:215], v[52:55], v[68:71], v[212:215]
s_add_u32 s72, s70, 144384
buffer_load_dwordx4 v5, s[4:7], s72 offen offset:3072 lds
v_mfma_f32_16x16x32_bf16 v[208:211], v[52:55], v[64:67], v[208:211]
v_mfma_f32_16x16x32_bf16 v[224:227], v[56:59], v[64:67], v[224:227]
v_mfma_f32_16x16x32_bf16 v[228:231], v[56:59], v[68:71], v[228:231]
v_mfma_f32_16x16x32_bf16 v[232:235], v[56:59], v[72:75], v[232:235]
v_mfma_f32_16x16x32_bf16 v[236:239], v[56:59], v[76:79], v[236:239]
v_mfma_f32_16x16x32_bf16 v[252:255], v[60:63], v[76:79], v[252:255]
v_mfma_f32_16x16x32_bf16 v[248:251], v[60:63], v[72:75], v[248:251]
v_mfma_f32_16x16x32_bf16 v[244:247], v[60:63], v[68:71], v[244:247]
s_waitcnt vmcnt(13) lgkmcnt(0)
v_mfma_f32_16x16x32_bf16 v[240:243], v[60:63], v[64:67], v[240:243]
s_barrier
v_mfma_f32_16x16x32_bf16 v[128:131], v[80:83], v[112:115], v[128:131]
s_waitcnt vmcnt(8)
v_cmp_gt_u32 vcc, 1, v3
s_cbranch_vccnz Lspin4
Lback5:
v_mfma_f32_16x16x32_bf16 v[132:135], v[80:83], v[116:119], v[132:135]
s_add_u32 m0, s64, 49152
ds_read_b64_tr_b16 v[32:33], v8 offset:32768
ds_read_b64_tr_b16 v[34:35], v8 offset:33792
v_mfma_f32_16x16x32_bf16 v[136:139], v[80:83], v[120:123], v[136:139]
s_add_u32 s72, s81, 16384
buffer_load_dwordx4 v1, s[44:47], s72 offen sc1 lds
v_mfma_f32_16x16x32_bf16 v[140:143], v[80:83], v[124:127], v[140:143]
ds_read_b128 v[64:67], v18 offset:32768
ds_read_b128 v[68:71], v18 offset:34816
v_mfma_f32_16x16x32_bf16 v[156:159], v[84:87], v[124:127], v[156:159]
ds_read_b128 v[72:75], v18 offset:36864
ds_read_b128 v[76:79], v18 offset:38912
v_mfma_f32_16x16x32_bf16 v[152:155], v[84:87], v[120:123], v[152:155]
buffer_load_dwordx4 v1, s[44:47], s72 offen offset:1024 sc1 lds
v_mfma_f32_16x16x32_bf16 v[148:151], v[84:87], v[116:119], v[148:151]
ds_read_b64_tr_b16 v[36:37], v9 offset:32768
ds_read_b64_tr_b16 v[38:39], v9 offset:33792
v_mfma_f32_16x16x32_bf16 v[144:147], v[84:87], v[112:115], v[144:147]
ds_read_b64_tr_b16 v[40:41], v10 offset:32768
v_mfma_f32_16x16x32_bf16 v[160:163], v[88:91], v[112:115], v[160:163]
ds_read_b64_tr_b16 v[42:43], v10 offset:33792
v_mfma_f32_16x16x32_bf16 v[164:167], v[88:91], v[116:119], v[164:167]
ds_read_b64_tr_b16 v[44:45], v11 offset:32768
v_mfma_f32_16x16x32_bf16 v[168:171], v[88:91], v[120:123], v[168:171]
buffer_load_dwordx4 v1, s[44:47], s72 offen offset:2048 sc1 lds
v_mfma_f32_16x16x32_bf16 v[172:175], v[88:91], v[124:127], v[172:175]
ds_read_b64_tr_b16 v[46:47], v11 offset:33792
v_mfma_f32_16x16x32_bf16 v[188:191], v[92:95], v[124:127], v[188:191]
ds_read_b64_tr_b16 v[48:49], v12 offset:32768
v_mfma_f32_16x16x32_bf16 v[184:187], v[92:95], v[120:123], v[184:187]
ds_read_b64_tr_b16 v[50:51], v12 offset:33792
v_mfma_f32_16x16x32_bf16 v[180:183], v[92:95], v[116:119], v[180:183]
ds_read_b64_tr_b16 v[52:53], v13 offset:32768
v_mfma_f32_16x16x32_bf16 v[176:179], v[92:95], v[112:115], v[176:179]
buffer_load_dwordx4 v1, s[44:47], s72 offen offset:3072 sc1 lds
v_mfma_f32_16x16x32_bf16 v[192:195], v[96:99], v[112:115], v[192:195]
ds_read_b64_tr_b16 v[54:55], v13 offset:33792
v_mfma_f32_16x16x32_bf16 v[196:199], v[96:99], v[116:119], v[196:199]
ds_read_b64_tr_b16 v[56:57], v14 offset:32768
v_mfma_f32_16x16x32_bf16 v[200:203], v[96:99], v[120:123], v[200:203]
ds_read_b64_tr_b16 v[58:59], v14 offset:33792
v_mfma_f32_16x16x32_bf16 v[204:207], v[96:99], v[124:127], v[204:207]
ds_read_b64_tr_b16 v[60:61], v15 offset:32768
v_mfma_f32_16x16x32_bf16 v[220:223], v[100:103], v[124:127], v[220:223]
s_add_u32 s81, s81, 0x8000
ds_read_b64_tr_b16 v[62:63], v15 offset:33792
v_mfma_f32_16x16x32_bf16 v[216:219], v[100:103], v[120:123], v[216:219]
s_add_u32 m0, s64, 81920
v_mfma_f32_16x16x32_bf16 v[212:215], v[100:103], v[116:119], v[212:215]
s_add_u32 s72, s81, 16384
buffer_load_dwordx4 v1, s[44:47], s72 offen sc1 lds
v_mfma_f32_16x16x32_bf16 v[208:211], v[100:103], v[112:115], v[208:211]
v_mfma_f32_16x16x32_bf16 v[224:227], v[104:107], v[112:115], v[224:227]
v_mfma_f32_16x16x32_bf16 v[228:231], v[104:107], v[116:119], v[228:231]
buffer_load_dwordx4 v1, s[44:47], s72 offen offset:1024 sc1 lds
v_mfma_f32_16x16x32_bf16 v[232:235], v[104:107], v[120:123], v[232:235]
v_mfma_f32_16x16x32_bf16 v[236:239], v[104:107], v[124:127], v[236:239]
v_mfma_f32_16x16x32_bf16 v[252:255], v[108:111], v[124:127], v[252:255]
v_mfma_f32_16x16x32_bf16 v[248:251], v[108:111], v[120:123], v[248:251]
v_mfma_f32_16x16x32_bf16 v[244:247], v[108:111], v[116:119], v[244:247]
buffer_load_dwordx4 v1, s[44:47], s72 offen offset:2048 sc1 lds
v_mfma_f32_16x16x32_bf16 v[240:243], v[108:111], v[112:115], v[240:243]
s_waitcnt lgkmcnt(0)
v_mfma_f32_16x16x32_bf16 v[128:131], v[32:35], v[64:67], v[128:131]
ds_read_b64_tr_b16 v[80:81], v8 offset:40960
ds_read_b64_tr_b16 v[82:83], v8 offset:41984
v_mfma_f32_16x16x32_bf16 v[132:135], v[32:35], v[68:71], v[132:135]
ds_read_b128 v[112:115], v19 offset:32768
ds_read_b128 v[116:119], v19 offset:34816
v_mfma_f32_16x16x32_bf16 v[136:139], v[32:35], v[72:75], v[136:139]
buffer_load_dwordx4 v1, s[44:47], s72 offen offset:3072 sc1 lds
v_mfma_f32_16x16x32_bf16 v[140:143], v[32:35], v[76:79], v[140:143]
ds_read_b128 v[120:123], v19 offset:36864
ds_read_b128 v[124:127], v19 offset:38912
v_mfma_f32_16x16x32_bf16 v[156:159], v[36:39], v[76:79], v[156:159]
ds_read_b64_tr_b16 v[84:85], v9 offset:40960
ds_read_b64_tr_b16 v[86:87], v9 offset:41984
v_mfma_f32_16x16x32_bf16 v[152:155], v[36:39], v[72:75], v[152:155]
ds_read_b64_tr_b16 v[88:89], v10 offset:40960
v_mfma_f32_16x16x32_bf16 v[148:151], v[36:39], v[68:71], v[148:151]
ds_read_b64_tr_b16 v[90:91], v10 offset:41984
v_mfma_f32_16x16x32_bf16 v[144:147], v[36:39], v[64:67], v[144:147]
s_add_u32 m0, s64, 65536
ds_read_b64_tr_b16 v[92:93], v11 offset:40960
v_mfma_f32_16x16x32_bf16 v[160:163], v[40:43], v[64:67], v[160:163]
s_add_u32 s72, s81, 0
buffer_load_dwordx4 v1, s[44:47], s72 offen sc1 lds
v_mfma_f32_16x16x32_bf16 v[164:167], v[40:43], v[68:71], v[164:167]
ds_read_b64_tr_b16 v[94:95], v11 offset:41984
v_mfma_f32_16x16x32_bf16 v[168:171], v[40:43], v[72:75], v[168:171]
ds_read_b64_tr_b16 v[96:97], v12 offset:40960
v_mfma_f32_16x16x32_bf16 v[172:175], v[40:43], v[76:79], v[172:175]
ds_read_b64_tr_b16 v[98:99], v12 offset:41984
v_mfma_f32_16x16x32_bf16 v[188:191], v[44:47], v[76:79], v[188:191]
buffer_load_dwordx4 v1, s[44:47], s72 offen offset:1024 sc1 lds
v_mfma_f32_16x16x32_bf16 v[184:187], v[44:47], v[72:75], v[184:187]
ds_read_b64_tr_b16 v[100:101], v13 offset:40960
v_mfma_f32_16x16x32_bf16 v[180:183], v[44:47], v[68:71], v[180:183]
ds_read_b64_tr_b16 v[102:103], v13 offset:41984
v_mfma_f32_16x16x32_bf16 v[176:179], v[44:47], v[64:67], v[176:179]
ds_read_b64_tr_b16 v[104:105], v14 offset:40960
v_mfma_f32_16x16x32_bf16 v[192:195], v[48:51], v[64:67], v[192:195]
ds_read_b64_tr_b16 v[106:107], v14 offset:41984
v_mfma_f32_16x16x32_bf16 v[196:199], v[48:51], v[68:71], v[196:199]
buffer_load_dwordx4 v1, s[44:47], s72 offen offset:2048 sc1 lds
v_mfma_f32_16x16x32_bf16 v[200:203], v[48:51], v[72:75], v[200:203]
ds_read_b64_tr_b16 v[108:109], v15 offset:40960
v_mfma_f32_16x16x32_bf16 v[204:207], v[48:51], v[76:79], v[204:207]
ds_read_b64_tr_b16 v[110:111], v15 offset:41984
v_mfma_f32_16x16x32_bf16 v[220:223], v[52:55], v[76:79], v[220:223]
v_mfma_f32_16x16x32_bf16 v[216:219], v[52:55], v[72:75], v[216:219]
v_mfma_f32_16x16x32_bf16 v[212:215], v[52:55], v[68:71], v[212:215]
buffer_load_dwordx4 v1, s[44:47], s72 offen offset:3072 sc1 lds
v_mfma_f32_16x16x32_bf16 v[208:211], v[52:55], v[64:67], v[208:211]
v_mfma_f32_16x16x32_bf16 v[224:227], v[56:59], v[64:67], v[224:227]
v_mfma_f32_16x16x32_bf16 v[228:231], v[56:59], v[68:71], v[228:231]
v_mfma_f32_16x16x32_bf16 v[232:235], v[56:59], v[72:75], v[232:235]
v_mfma_f32_16x16x32_bf16 v[236:239], v[56:59], v[76:79], v[236:239]
v_mfma_f32_16x16x32_bf16 v[252:255], v[60:63], v[76:79], v[252:255]
v_mfma_f32_16x16x32_bf16 v[248:251], v[60:63], v[72:75], v[248:251]
v_mfma_f32_16x16x32_bf16 v[244:247], v[60:63], v[68:71], v[244:247]
s_waitcnt vmcnt(12) lgkmcnt(0)
v_mfma_f32_16x16x32_bf16 v[240:243], v[60:63], v[64:67], v[240:243]
s_barrier
v_mfma_f32_16x16x32_bf16 v[128:131], v[80:83], v[112:115], v[128:131]
s_add_u32 s81, s81, 0x8000
ds_read_b64_tr_b16 v[32:33], v8 offset:0
ds_read_b64_tr_b16 v[34:35], v8 offset:1024
v_mfma_f32_16x16x32_bf16 v[132:135], v[80:83], v[116:119], v[132:135]
s_add_u32 m0, s64, 114688
ds_read_b128 v[64:67], v16 offset:0
ds_read_b128 v[68:71], v16 offset:2048
v_mfma_f32_16x16x32_bf16 v[136:139], v[80:83], v[120:123], v[136:139]
s_add_u32 s72, s81, 16384
buffer_load_dwordx4 v1, s[44:47], s72 offen sc1 lds
v_mfma_f32_16x16x32_bf16 v[140:143], v[80:83], v[124:127], v[140:143]
ds_read_b128 v[72:75], v16 offset:4096
ds_read_b128 v[76:79], v16 offset:6144
v_mfma_f32_16x16x32_bf16 v[156:159], v[84:87], v[124:127], v[156:159]
ds_read_b64_tr_b16 v[36:37], v9 offset:0
ds_read_b64_tr_b16 v[38:39], v9 offset:1024
v_mfma_f32_16x16x32_bf16 v[152:155], v[84:87], v[120:123], v[152:155]
buffer_load_dwordx4 v1, s[44:47], s72 offen offset:1024 sc1 lds
v_mfma_f32_16x16x32_bf16 v[148:151], v[84:87], v[116:119], v[148:151]
ds_read_b64_tr_b16 v[40:41], v10 offset:0
v_mfma_f32_16x16x32_bf16 v[144:147], v[84:87], v[112:115], v[144:147]
ds_read_b64_tr_b16 v[42:43], v10 offset:1024
v_mfma_f32_16x16x32_bf16 v[160:163], v[88:91], v[112:115], v[160:163]
ds_read_b64_tr_b16 v[44:45], v11 offset:0
v_mfma_f32_16x16x32_bf16 v[164:167], v[88:91], v[116:119], v[164:167]
ds_read_b64_tr_b16 v[46:47], v11 offset:1024
v_mfma_f32_16x16x32_bf16 v[168:171], v[88:91], v[120:123], v[168:171]
buffer_store_dwordx4 a[0:3], v1, s[44:47], s80 offen sc1
v_mfma_f32_16x16x32_bf16 v[172:175], v[88:91], v[124:127], v[172:175]
ds_read_b64_tr_b16 v[48:49], v12 offset:0
v_mfma_f32_16x16x32_bf16 v[188:191], v[92:95], v[124:127], v[188:191]
ds_read_b64_tr_b16 v[50:51], v12 offset:1024
v_mfma_f32_16x16x32_bf16 v[184:187], v[92:95], v[120:123], v[184:187]
ds_read_b64_tr_b16 v[52:53], v13 offset:0
v_mfma_f32_16x16x32_bf16 v[180:183], v[92:95], v[116:119], v[180:183]
ds_read_b64_tr_b16 v[54:55], v13 offset:1024
v_mfma_f32_16x16x32_bf16 v[176:179], v[92:95], v[112:115], v[176:179]
buffer_load_dwordx4 v1, s[44:47], s72 offen offset:2048 sc1 lds
v_mfma_f32_16x16x32_bf16 v[192:195], v[96:99], v[112:115], v[192:195]
ds_read_b64_tr_b16 v[56:57], v14 offset:0
v_mfma_f32_16x16x32_bf16 v[196:199], v[96:99], v[116:119], v[196:199]
ds_read_b64_tr_b16 v[58:59], v14 offset:1024
v_mfma_f32_16x16x32_bf16 v[200:203], v[96:99], v[120:123], v[200:203]
ds_read_b64_tr_b16 v[60:61], v15 offset:0
v_mfma_f32_16x16x32_bf16 v[204:207], v[96:99], v[124:127], v[204:207]
ds_read_b64_tr_b16 v[62:63], v15 offset:1024
v_mfma_f32_16x16x32_bf16 v[220:223], v[100:103], v[124:127], v[220:223]
buffer_load_dwordx4 v1, s[44:47], s72 offen offset:3072 sc1 lds
v_mfma_f32_16x16x32_bf16 v[216:219], v[100:103], v[120:123], v[216:219]
v_mfma_f32_16x16x32_bf16 v[212:215], v[100:103], v[116:119], v[212:215]
v_mfma_f32_16x16x32_bf16 v[208:211], v[100:103], v[112:115], v[208:211]
v_mfma_f32_16x16x32_bf16 v[224:227], v[104:107], v[112:115], v[224:227]
v_mfma_f32_16x16x32_bf16 v[228:231], v[104:107], v[116:119], v[228:231]
buffer_store_dwordx4 a[0:3], v1, s[44:47], s80 offen offset:1024 sc1
v_mfma_f32_16x16x32_bf16 v[232:235], v[104:107], v[120:123], v[232:235]
v_mfma_f32_16x16x32_bf16 v[236:239], v[104:107], v[124:127], v[236:239]
v_mfma_f32_16x16x32_bf16 v[252:255], v[108:111], v[124:127], v[252:255]
v_mfma_f32_16x16x32_bf16 v[248:251], v[108:111], v[120:123], v[248:251]
v_mfma_f32_16x16x32_bf16 v[244:247], v[108:111], v[116:119], v[244:247]
s_add_u32 m0, s64, 98304
v_mfma_f32_16x16x32_bf16 v[240:243], v[108:111], v[112:115], v[240:243]
s_waitcnt lgkmcnt(0)
v_mfma_f32_16x16x32_bf16 v[128:131], v[32:35], v[64:67], v[128:131]
s_add_u32 s72, s81, 0
buffer_load_dwordx4 v1, s[44:47], s72 offen sc1 lds
v_mfma_f32_16x16x32_bf16 v[132:135], v[32:35], v[68:71], v[132:135]
ds_read_b64_tr_b16 v[80:81], v8 offset:8192
v_add_u32 v2, 0x8000, v1
v_mfma_f32_16x16x32_bf16 v[136:139], v[32:35], v[72:75], v[136:139]
ds_read_b64_tr_b16 v[82:83], v8 offset:9216
ds_read_b128 v[112:115], v17 offset:0
v_mfma_f32_16x16x32_bf16 v[140:143], v[32:35], v[76:79], v[140:143]
ds_read_b128 v[116:119], v17 offset:2048
ds_read_b128 v[120:123], v17 offset:4096
v_mfma_f32_16x16x32_bf16 v[156:159], v[36:39], v[76:79], v[156:159]
buffer_load_dwordx4 v1, s[44:47], s72 offen offset:1024 sc1 lds
v_mfma_f32_16x16x32_bf16 v[152:155], v[36:39], v[72:75], v[152:155]
ds_read_b128 v[124:127], v17 offset:6144
ds_read_b64_tr_b16 v[84:85], v9 offset:8192
v_mfma_f32_16x16x32_bf16 v[148:151], v[36:39], v[68:71], v[148:151]
ds_read_b64_tr_b16 v[86:87], v9 offset:9216
v_mfma_f32_16x16x32_bf16 v[144:147], v[36:39], v[64:67], v[144:147]
ds_read_b64_tr_b16 v[88:89], v10 offset:8192
v_mfma_f32_16x16x32_bf16 v[160:163], v[40:43], v[64:67], v[160:163]
ds_read_b64_tr_b16 v[90:91], v10 offset:9216
v_mfma_f32_16x16x32_bf16 v[164:167], v[40:43], v[68:71], v[164:167]
buffer_store_dwordx4 a[0:3], v1, s[44:47], s80 offen offset:2048 sc1
v_mfma_f32_16x16x32_bf16 v[168:171], v[40:43], v[72:75], v[168:171]
ds_read_b64_tr_b16 v[92:93], v11 offset:8192
v_mfma_f32_16x16x32_bf16 v[172:175], v[40:43], v[76:79], v[172:175]
ds_read_b64_tr_b16 v[94:95], v11 offset:9216
v_mfma_f32_16x16x32_bf16 v[188:191], v[44:47], v[76:79], v[188:191]
ds_read_b64_tr_b16 v[96:97], v12 offset:8192
v_mfma_f32_16x16x32_bf16 v[184:187], v[44:47], v[72:75], v[184:187]
ds_read_b64_tr_b16 v[98:99], v12 offset:9216
v_mfma_f32_16x16x32_bf16 v[180:183], v[44:47], v[68:71], v[180:183]
buffer_load_dwordx4 v1, s[44:47], s72 offen offset:2048 sc1 lds
v_mfma_f32_16x16x32_bf16 v[176:179], v[44:47], v[64:67], v[176:179]
ds_read_b64_tr_b16 v[100:101], v13 offset:8192
v_mfma_f32_16x16x32_bf16 v[192:195], v[48:51], v[64:67], v[192:195]
ds_read_b64_tr_b16 v[102:103], v13 offset:9216
v_mfma_f32_16x16x32_bf16 v[196:199], v[48:51], v[68:71], v[196:199]
ds_read_b64_tr_b16 v[104:105], v14 offset:8192
v_mfma_f32_16x16x32_bf16 v[200:203], v[48:51], v[72:75], v[200:203]
ds_read_b64_tr_b16 v[106:107], v14 offset:9216
v_mfma_f32_16x16x32_bf16 v[204:207], v[48:51], v[76:79], v[204:207]
buffer_load_dwordx4 v1, s[44:47], s72 offen offset:3072 sc1 lds
v_mfma_f32_16x16x32_bf16 v[220:223], v[52:55], v[76:79], v[220:223]
ds_read_b64_tr_b16 v[108:109], v15 offset:8192
v_mfma_f32_16x16x32_bf16 v[216:219], v[52:55], v[72:75], v[216:219]
ds_read_b64_tr_b16 v[110:111], v15 offset:9216
v_mfma_f32_16x16x32_bf16 v[212:215], v[52:55], v[68:71], v[212:215]
v_mfma_f32_16x16x32_bf16 v[208:211], v[52:55], v[64:67], v[208:211]
v_mfma_f32_16x16x32_bf16 v[224:227], v[56:59], v[64:67], v[224:227]
buffer_store_dwordx4 a[0:3], v1, s[44:47], s80 offen offset:3072 sc1
v_mfma_f32_16x16x32_bf16 v[228:231], v[56:59], v[68:71], v[228:231]
v_mfma_f32_16x16x32_bf16 v[232:235], v[56:59], v[72:75], v[232:235]
v_mfma_f32_16x16x32_bf16 v[236:239], v[56:59], v[76:79], v[236:239]
v_mfma_f32_16x16x32_bf16 v[252:255], v[60:63], v[76:79], v[252:255]
v_mfma_f32_16x16x32_bf16 v[248:251], v[60:63], v[72:75], v[248:251]
v_lshrrev_b32 v3, 1, v0
v_lshlrev_b32 v3, 7, v3
v_mfma_f32_16x16x32_bf16 v[244:247], v[60:63], v[68:71], v[244:247]
s_waitcnt vmcnt(20) lgkmcnt(0)
buffer_load_dword v4, v3, s[36:39], s93 offen
v_mfma_f32_16x16x32_bf16 v[240:243], v[60:63], v[64:67], v[240:243]
s_barrier
v_mfma_f32_16x16x32_bf16 v[128:131], v[80:83], v[112:115], v[128:131]
ds_read_b128 a[128:131], v2 offset:16384
v_mfma_f32_16x16x32_bf16 v[132:135], v[80:83], v[116:119], v[132:135]
ds_read_b128 a[132:135], v2 offset:17408
v_mfma_f32_16x16x32_bf16 v[136:139], v[80:83], v[120:123], v[136:139]
ds_read_b128 a[136:139], v2 offset:18432
v_mfma_f32_16x16x32_bf16 v[140:143], v[80:83], v[124:127], v[140:143]
ds_read_b128 a[140:143], v2 offset:19456
v_mfma_f32_16x16x32_bf16 v[156:159], v[84:87], v[124:127], v[156:159]
ds_read_b128 a[144:147], v2 offset:20480
v_mfma_f32_16x16x32_bf16 v[152:155], v[84:87], v[120:123], v[152:155]
ds_read_b128 a[148:151], v2 offset:21504
v_mfma_f32_16x16x32_bf16 v[148:151], v[84:87], v[116:119], v[148:151]
ds_read_b128 a[152:155], v2 offset:22528
v_mfma_f32_16x16x32_bf16 v[144:147], v[84:87], v[112:115], v[144:147]
ds_read_b128 a[156:159], v2 offset:23552
v_mfma_f32_16x16x32_bf16 v[160:163], v[88:91], v[112:115], v[160:163]
v_mfma_f32_16x16x32_bf16 v[164:167], v[88:91], v[116:119], v[164:167]
v_mfma_f32_16x16x32_bf16 v[168:171], v[88:91], v[120:123], v[168:171]
v_mfma_f32_16x16x32_bf16 v[172:175], v[88:91], v[124:127], v[172:175]
v_mfma_f32_16x16x32_bf16 v[188:191], v[92:95], v[124:127], v[188:191]
v_cvt_pk_bf16_f32 v64, v140, v141
v_cvt_pk_bf16_f32 v65, v142, v143
v_mfma_f32_16x16x32_bf16 v[184:187], v[92:95], v[120:123], v[184:187]
v_cvt_pk_bf16_f32 v66, v156, v157
v_cvt_pk_bf16_f32 v67, v158, v159
v_mfma_f32_16x16x32_bf16 v[180:183], v[92:95], v[116:119], v[180:183]
v_cvt_pk_bf16_f32 v48, v136, v137
v_cvt_pk_bf16_f32 v49, v138, v139
v_mfma_f32_16x16x32_bf16 v[176:179], v[92:95], v[112:115], v[176:179]
v_cvt_pk_bf16_f32 v50, v152, v153
v_cvt_pk_bf16_f32 v51, v154, v155
v_mfma_f32_16x16x32_bf16 v[192:195], v[96:99], v[112:115], v[192:195]
v_cvt_pk_bf16_f32 v32, v132, v133
v_cvt_pk_bf16_f32 v33, v134, v135
v_mfma_f32_16x16x32_bf16 v[196:199], v[96:99], v[116:119], v[196:199]
v_cvt_pk_bf16_f32 v34, v148, v149
v_cvt_pk_bf16_f32 v35, v150, v151
v_mfma_f32_16x16x32_bf16 v[200:203], v[96:99], v[120:123], v[200:203]
v_cvt_pk_bf16_f32 v16, v128, v129
v_cvt_pk_bf16_f32 v17, v130, v131
v_mfma_f32_16x16x32_bf16 v[204:207], v[96:99], v[124:127], v[204:207]
v_cvt_pk_bf16_f32 v18, v144, v145
v_cvt_pk_bf16_f32 v19, v146, v147
v_mfma_f32_16x16x32_bf16 v[220:223], v[100:103], v[124:127], v[220:223]
v_cvt_pk_bf16_f32 v68, v172, v173
v_cvt_pk_bf16_f32 v69, v174, v175
v_mfma_f32_16x16x32_bf16 v[216:219], v[100:103], v[120:123], v[216:219]
v_cvt_pk_bf16_f32 v70, v188, v189
v_cvt_pk_bf16_f32 v71, v190, v191
v_mfma_f32_16x16x32_bf16 v[212:215], v[100:103], v[116:119], v[212:215]
v_cvt_pk_bf16_f32 v52, v168, v169
v_cvt_pk_bf16_f32 v53, v170, v171
v_mfma_f32_16x16x32_bf16 v[208:211], v[100:103], v[112:115], v[208:211]
v_cvt_pk_bf16_f32 v54, v184, v185
v_cvt_pk_bf16_f32 v55, v186, v187
v_mfma_f32_16x16x32_bf16 v[224:227], v[104:107], v[112:115], v[224:227]
v_cvt_pk_bf16_f32 v36, v164, v165
v_cvt_pk_bf16_f32 v37, v166, v167
v_mfma_f32_16x16x32_bf16 v[228:231], v[104:107], v[116:119], v[228:231]
v_cvt_pk_bf16_f32 v38, v180, v181
v_cvt_pk_bf16_f32 v39, v182, v183
v_mfma_f32_16x16x32_bf16 v[232:235], v[104:107], v[120:123], v[232:235]
v_cvt_pk_bf16_f32 v20, v160, v161
v_cvt_pk_bf16_f32 v21, v162, v163
v_mfma_f32_16x16x32_bf16 v[236:239], v[104:107], v[124:127], v[236:239]
v_cvt_pk_bf16_f32 v22, v176, v177
v_cvt_pk_bf16_f32 v23, v178, v179
v_mfma_f32_16x16x32_bf16 v[252:255], v[108:111], v[124:127], v[252:255]
v_cvt_pk_bf16_f32 v72, v204, v205
v_cvt_pk_bf16_f32 v73, v206, v207
v_mfma_f32_16x16x32_bf16 v[248:251], v[108:111], v[120:123], v[248:251]
v_cvt_pk_bf16_f32 v74, v220, v221
v_cvt_pk_bf16_f32 v75, v222, v223
v_mfma_f32_16x16x32_bf16 v[244:247], v[108:111], v[116:119], v[244:247]
v_cvt_pk_bf16_f32 v56, v200, v201
v_cvt_pk_bf16_f32 v57, v202, v203
v_mfma_f32_16x16x32_bf16 v[240:243], v[108:111], v[112:115], v[240:243]
v_cvt_pk_bf16_f32 v58, v216, v217
v_cvt_pk_bf16_f32 v59, v218, v219
v_cvt_pk_bf16_f32 v40, v196, v197
v_cvt_pk_bf16_f32 v41, v198, v199
v_cvt_pk_bf16_f32 v42, v212, v213
v_cvt_pk_bf16_f32 v43, v214, v215
v_cvt_pk_bf16_f32 v24, v192, v193
v_cvt_pk_bf16_f32 v25, v194, v195
v_cvt_pk_bf16_f32 v26, v208, v209
v_cvt_pk_bf16_f32 v27, v210, v211
v_cvt_pk_bf16_f32 v76, v236, v237
v_cvt_pk_bf16_f32 v77, v238, v239
v_cvt_pk_bf16_f32 v78, v252, v253
v_cvt_pk_bf16_f32 v79, v254, v255
v_cvt_pk_bf16_f32 v60, v232, v233
v_cvt_pk_bf16_f32 v61, v234, v235
v_cvt_pk_bf16_f32 v62, v248, v249
v_cvt_pk_bf16_f32 v63, v250, v251
v_cvt_pk_bf16_f32 v44, v228, v229
v_cvt_pk_bf16_f32 v45, v230, v231
v_cvt_pk_bf16_f32 v46, v244, v245
v_cvt_pk_bf16_f32 v47, v246, v247
v_cvt_pk_bf16_f32 v28, v224, v225
v_cvt_pk_bf16_f32 v29, v226, v227
v_cvt_pk_bf16_f32 v30, v240, v241
v_cvt_pk_bf16_f32 v31, v242, v243
v_mov_b32 v124, 0xff800000
v_mov_b32 v125, 0xff800000
v_mov_b32 v126, 0xff800000
v_mov_b32 v127, 0xff800000
s_lshl_b32 s84, s60, 2
s_add_u32 s84, s84, s58
s_mov_b32 s86, 0
s_add_u32 s61, s65, s60
s_and_b32 s73, s60, 1
s_lshl_b32 s73, s73, 16
s_add_u32 s77, s73, s64
s_xor_b32 s73, s73, 0x10000
s_mov_b32 s92, s73
s_mul_i32 s62, s58, 4608
s_add_u32 s62, s62, 143104
s_add_u32 s73, s73, 49920
s_cmp_eq_u32 s58, 0
s_cselect_b32 s62, s73, s62
Lattn:
s_mov_b32 s82, 0x10000
s_waitcnt lgkmcnt(0)
v_mfma_f32_16x16x32_bf16 v[136:139], a[128:131], v[48:51], 0
ds_read_b128 a[160:163], v2 offset:24576
v_lshrrev_b32 v240, 4, v0
v_mfma_f32_16x16x32_bf16 v[136:139], a[132:135], v[52:55], v[136:139]
ds_read_b128 a[164:167], v2 offset:25600
v_and_b32 v241, 15, v0
v_mfma_f32_16x16x32_bf16 v[136:139], a[136:139], v[56:59], v[136:139]
ds_read_b128 a[168:171], v2 offset:26624
v_lshlrev_b32 v240, 2, v240
v_mfma_f32_16x16x32_bf16 v[136:139], a[140:143], v[60:63], v[136:139]
ds_read_b128 a[172:175], v2 offset:27648
v_sub_u32 v240, v241, v240
v_mfma_f32_16x16x32_bf16 v[140:143], a[140:143], v[76:79], 0
ds_read_b128 a[176:179], v2 offset:28672
v_mov_b32 v112, 0xff800000
v_mfma_f32_16x16x32_bf16 v[140:143], a[136:139], v[72:75], v[140:143]
ds_read_b128 a[180:183], v2 offset:29696
v_mov_b32 v113, 0xff800000
v_mfma_f32_16x16x32_bf16 v[140:143], a[132:135], v[68:71], v[140:143]
ds_read_b128 a[184:187], v2 offset:30720
v_mov_b32 v114, 0xff800000
v_mfma_f32_16x16x32_bf16 v[140:143], a[128:131], v[64:67], v[140:143]
ds_read_b128 a[188:191], v2 offset:31744
v_mov_b32 v115, 0xff800000
v_mfma_f32_16x16x32_bf16 v[156:159], a[144:147], v[64:67], 0
v_cmp_gt_i32 vcc, 0, v240
v_mov_b32 v120, 0x3f803f80
v_mfma_f32_16x16x32_bf16 v[156:159], a[148:151], v[68:71], v[156:159]
v_cndmask_b32 v116, 0, v112, vcc
v_cmp_gt_i32 vcc, 1, v240
v_mfma_f32_16x16x32_bf16 v[156:159], a[152:155], v[72:75], v[156:159]
v_mov_b32 v121, 0x3f803f80
v_cndmask_b32 v117, 0, v112, vcc
v_mfma_f32_16x16x32_bf16 v[156:159], a[156:159], v[76:79], v[156:159]
v_cmp_gt_i32 vcc, 2, v240
v_mov_b32 v122, 0x3f803f80
v_mfma_f32_16x16x32_bf16 v[152:155], a[156:159], v[60:63], 0
v_cndmask_b32 v118, 0, v112, vcc
v_cmp_gt_i32 vcc, 3, v240
v_mfma_f32_16x16x32_bf16 v[152:155], a[152:155], v[56:59], v[152:155]
v_mov_b32 v123, 0x3f803f80
v_cndmask_b32 v119, 0, v112, vcc
v_mfma_f32_16x16x32_bf16 v[152:155], a[148:151], v[52:55], v[152:155]
v_mfma_f32_16x16x32_bf16 v[152:155], a[144:147], v[48:51], v[152:155]
s_cmp_eq_u32 s84, 0
s_cbranch_scc1 Lta7
s_cmp_eq_u32 s84, 1
s_cbranch_scc1 Lnt8
v_mfma_f32_16x16x32_bf16 v[128:131], a[128:131], v[16:19], 0
v_mfma_f32_16x16x32_bf16 v[144:147], a[144:147], v[16:19], 0
s_branch Ljoin9
Lta7:
v_mfma_f32_16x16x32_bf16 v[128:131], a[128:131], v[16:19], v[116:119]
v_mfma_f32_16x16x32_bf16 v[144:147], a[144:147], v[16:19], v[112:115]
s_branch Ljoin9
Lnt8:
v_mfma_f32_16x16x32_bf16 v[128:131], a[128:131], v[16:19], 0
v_mfma_f32_16x16x32_bf16 v[144:147], a[144:147], v[16:19], v[116:119]
Ljoin9:
v_mfma_f32_16x16x32_bf16 v[128:131], a[132:135], v[20:23], v[128:131]
v_mfma_f32_16x16x32_bf16 v[128:131], a[136:139], v[24:27], v[128:131]
v_mfma_f32_16x16x32_bf16 v[128:131], a[140:143], v[28:31], v[128:131]
v_max3_f32 v240, v136, v137, v126
v_max3_f32 v242, v140, v141, v127
v_mfma_f32_16x16x32_bf16 v[132:135], a[140:143], v[44:47], 0
v_max3_f32 v240, v240, v138, v139
v_max3_f32 v242, v242, v142, v143
v_mfma_f32_16x16x32_bf16 v[132:135], a[136:139], v[40:43], v[132:135]
v_max3_f32 v240, v240, v152, v153
v_max3_f32 v242, v242, v156, v157
v_mfma_f32_16x16x32_bf16 v[132:135], a[132:135], v[36:39], v[132:135]
v_max3_f32 v240, v240, v154, v155
v_max3_f32 v242, v242, v158, v159
v_mfma_f32_16x16x32_bf16 v[132:135], a[128:131], v[32:35], v[132:135]
v_mov_b32 v241, v240
v_mov_b32 v243, v242
v_mfma_f32_16x16x32_bf16 v[148:151], a[144:147], v[32:35], 0
v_permlane16_swap_b32 v240, v241
v_permlane16_swap_b32 v242, v243
v_mfma_f32_16x16x32_bf16 v[148:151], a[148:151], v[36:39], v[148:151]
v_max_f32 v240, v240, v241
v_max_f32 v242, v242, v243
v_mfma_f32_16x16x32_bf16 v[148:151], a[152:155], v[40:43], v[148:151]
v_mov_b32 v241, v240
v_mov_b32 v243, v242
v_mfma_f32_16x16x32_bf16 v[148:151], a[156:159], v[44:47], v[148:151]
v_permlane32_swap_b32 v240, v241
v_permlane32_swap_b32 v242, v243
v_mfma_f32_16x16x32_bf16 v[144:147], a[156:159], v[28:31], v[144:147]
v_max_f32 v240, v240, v241
v_max_f32 v242, v242, v243
v_mfma_f32_16x16x32_bf16 v[144:147], a[152:155], v[24:27], v[144:147]
v_mfma_f32_16x16x32_bf16 v[144:147], a[148:151], v[20:23], v[144:147]
v_sub_f32 v88, 0, v240
v_sub_f32 v89, 0, v240
v_pk_add_f32 v[90:91], v[88:89], 0
v_pk_add_f32 v[104:105], v[116:117], v[88:89]
v_pk_add_f32 v[106:107], v[118:119], v[88:89]
v_pk_add_f32 v[136:137], v[136:137], v[88:89]
v_pk_add_f32 v[138:139], v[138:139], v[88:89]
v_pk_add_f32 v[152:153], v[152:153], v[88:89]
v_pk_add_f32 v[154:155], v[154:155], v[88:89]
v_sub_f32 v92, 0, v242
v_sub_f32 v93, 0, v242
v_pk_add_f32 v[94:95], v[92:93], 0
v_pk_add_f32 v[108:109], v[116:117], v[92:93]
v_pk_add_f32 v[110:111], v[118:119], v[92:93]
v_pk_add_f32 v[140:141], v[140:141], v[92:93]
v_pk_add_f32 v[142:143], v[142:143], v[92:93]
v_pk_add_f32 v[156:157], v[156:157], v[92:93]
v_pk_add_f32 v[158:159], v[158:159], v[92:93]
v_max3_f32 v240, v128, v129, v124
v_max3_f32 v242, v132, v133, v125
v_max3_f32 v240, v240, v130, v131
v_max3_f32 v242, v242, v134, v135
v_max3_f32 v240, v240, v144, v145
v_max3_f32 v242, v242, v148, v149
v_max3_f32 v240, v240, v146, v147
v_max3_f32 v242, v242, v150, v151
v_mov_b32 v241, v240
v_mov_b32 v243, v242
s_nop 0
v_permlane16_swap_b32 v240, v241
v_permlane16_swap_b32 v242, v243
v_max_f32 v240, v240, v241
v_max_f32 v242, v242, v243
v_mov_b32 v241, v240
v_mov_b32 v243, v242
s_nop 0
v_permlane32_swap_b32 v240, v241
v_permlane32_swap_b32 v242, v243
v_max_f32 v240, v240, v241
v_max_f32 v242, v242, v243
v_sub_f32 v80, 0, v240
v_sub_f32 v81, 0, v240
v_pk_add_f32 v[82:83], v[80:81], 0
v_pk_add_f32 v[96:97], v[116:117], v[80:81]
v_pk_add_f32 v[98:99], v[118:119], v[80:81]
v_pk_add_f32 v[128:129], v[128:129], v[80:81]
v_pk_add_f32 v[130:131], v[130:131], v[80:81]
v_pk_add_f32 v[144:145], v[144:145], v[80:81]
v_pk_add_f32 v[146:147], v[146:147], v[80:81]
v_sub_f32 v84, 0, v242
v_sub_f32 v85, 0, v242
v_pk_add_f32 v[86:87], v[84:85], 0
v_pk_add_f32 v[100:101], v[116:117], v[84:85]
v_pk_add_f32 v[102:103], v[118:119], v[84:85]
v_pk_add_f32 v[132:133], v[132:133], v[84:85]
v_pk_add_f32 v[134:135], v[134:135], v[84:85]
v_pk_add_f32 v[148:149], v[148:149], v[84:85]
v_pk_add_f32 v[150:151], v[150:151], v[84:85]
v_add_u32 v2, s82, v1
s_waitcnt vmcnt(13) lgkmcnt(0)
s_barrier
s_cmp_eq_u32 s60, 0
s_cbranch_scc1 LP0x
v_mfma_f32_16x16x32_bf16 v[160:163], a[160:163], v[16:19], v[80:83]
s_xor_b32 s74, s82, 0x10000
v_exp_f32 v128, v128
v_mfma_f32_16x16x32_bf16 v[160:163], a[164:167], v[20:23], v[160:163]
s_add_u32 s74, s74, s64
ds_read_b128 a[128:131], v2 offset:16384
ds_read_b128 a[132:135], v2 offset:17408
v_mfma_f32_16x16x32_bf16 v[160:163], a[168:171], v[24:27], v[160:163]
s_add_u32 s81, s81, 0x8000
v_exp_f32 v129, v129
v_mfma_f32_16x16x32_bf16 v[160:163], a[172:175], v[28:31], v[160:163]
s_add_u32 m0, s74, 16384
v_exp_f32 v130, v130
v_mfma_f32_16x16x32_bf16 v[164:167], a[172:175], v[44:47], v[84:87]
s_add_u32 s72, s81, 16384
v_exp_f32 v131, v131
v_mfma_f32_16x16x32_bf16 v[164:167], a[168:171], v[40:43], v[164:167]
v_exp_f32 v144, v144
v_mfma_f32_16x16x32_bf16 v[164:167], a[164:167], v[36:39], v[164:167]
ds_read_b128 a[136:139], v2 offset:18432
ds_read_b128 a[140:143], v2 offset:19456
v_mfma_f32_16x16x32_bf16 v[164:167], a[160:163], v[32:35], v[164:167]
ds_read_b128 a[144:147], v2 offset:20480
ds_read_b128 a[148:151], v2 offset:21504
v_mfma_f32_16x16x32_bf16 v[168:171], a[160:163], v[48:51], v[88:91]
ds_read_b128 a[152:155], v2 offset:22528
ds_read_b128 a[156:159], v2 offset:23552
v_mfma_f32_16x16x32_bf16 v[168:171], a[164:167], v[52:55], v[168:171]
ds_read_b128 a[192:195], v2 offset:0
ds_read_b128 a[196:199], v2 offset:1024
v_mfma_f32_16x16x32_bf16 v[168:171], a[168:171], v[56:59], v[168:171]
ds_read_b128 a[200:203], v2 offset:2048
ds_read_b128 a[204:207], v2 offset:3072
v_mfma_f32_16x16x32_bf16 v[168:171], a[172:175], v[60:63], v[168:171]
ds_read_b128 a[208:211], v2 offset:4096
ds_read_b128 a[212:215], v2 offset:5120
v_mfma_f32_16x16x32_bf16 v[172:175], a[172:175], v[76:79], v[92:95]
ds_read_b128 a[216:219], v2 offset:6144
ds_read_b128 a[220:223], v2 offset:7168
v_mfma_f32_16x16x32_bf16 v[172:175], a[168:171], v[72:75], v[172:175]
v_cvt_pk_bf16_f32 v192, v128, v129
v_cvt_pk_bf16_f32 v193, v130, v131
v_mfma_f32_16x16x32_bf16 v[172:175], a[164:167], v[68:71], v[172:175]
buffer_load_dwordx4 v1, s[44:47], s72 offen sc1 lds
v_mfma_f32_16x16x32_bf16 v[172:175], a[160:163], v[64:67], v[172:175]
v_exp_f32 v145, v145
v_mfma_f32_16x16x32_bf16 v[188:191], a[176:179], v[64:67], v[92:95]
v_exp_f32 v146, v146
v_mfma_f32_16x16x32_bf16 v[188:191], a[180:183], v[68:71], v[188:191]
v_exp_f32 v147, v147
v_mfma_f32_16x16x32_bf16 v[188:191], a[184:187], v[72:75], v[188:191]
v_exp_f32 v132, v132
v_mfma_f32_16x16x32_bf16 v[188:191], a[188:191], v[76:79], v[188:191]
v_cvt_pk_bf16_f32 v194, v144, v145
v_cvt_pk_bf16_f32 v195, v146, v147
v_mfma_f32_16x16x32_bf16 v[184:187], a[188:191], v[60:63], v[88:91]
v_exp_f32 v133, v133
v_mfma_f32_16x16x32_bf16 v[184:187], a[184:187], v[56:59], v[184:187]
v_exp_f32 v134, v134
v_mfma_f32_16x16x32_bf16 v[184:187], a[180:183], v[52:55], v[184:187]
v_exp_f32 v135, v135
v_mfma_f32_16x16x32_bf16 v[184:187], a[176:179], v[48:51], v[184:187]
v_exp_f32 v148, v148
v_mfma_f32_16x16x32_bf16 v[180:183], a[176:179], v[32:35], v[84:87]
v_cvt_pk_bf16_f32 v196, v132, v133
v_cvt_pk_bf16_f32 v197, v134, v135
v_mfma_f32_16x16x32_bf16 v[180:183], a[180:183], v[36:39], v[180:183]
buffer_load_dwordx4 v1, s[44:47], s72 offen offset:1024 sc1 lds
v_mfma_f32_16x16x32_bf16 v[180:183], a[184:187], v[40:43], v[180:183]
Lstub0:
s_cbranch_execz Lstub4
v_exp_f32 v149, v149
v_mfma_f32_16x16x32_bf16 v[180:183], a[188:191], v[44:47], v[180:183]
v_exp_f32 v150, v150
v_mfma_f32_16x16x32_bf16 v[176:179], a[188:191], v[28:31], v[80:83]
v_exp_f32 v151, v151
v_mfma_f32_16x16x32_bf16 v[176:179], a[184:187], v[24:27], v[176:179]
buffer_load_dwordx4 v1, s[44:47], s72 offen offset:2048 sc1 lds
v_mfma_f32_16x16x32_bf16 v[176:179], a[180:183], v[20:23], v[176:179]
buffer_load_dwordx4 v1, s[44:47], s72 offen offset:3072 sc1 lds
v_mfma_f32_16x16x32_bf16 v[176:179], a[176:179], v[16:19], v[176:179]
s_waitcnt lgkmcnt(8)
v_exp_f32 v136, v136
v_cvt_pk_bf16_f32 v198, v148, v149
v_cvt_pk_bf16_f32 v199, v150, v151
v_exp_f32 v137, v137
v_exp_f32 v138, v138
v_cvt_pk_bf16_f32 v200, v136, v137
v_exp_f32 v139, v139
v_exp_f32 v152, v152
v_cvt_pk_bf16_f32 v201, v138, v139
v_exp_f32 v153, v153
v_exp_f32 v154, v154
v_cvt_pk_bf16_f32 v202, v152, v153
v_exp_f32 v155, v155
v_exp_f32 v140, v140
v_cvt_pk_bf16_f32 v203, v154, v155
v_exp_f32 v141, v141
v_exp_f32 v142, v142
v_cvt_pk_bf16_f32 v204, v140, v141
v_exp_f32 v143, v143
v_exp_f32 v156, v156
v_cvt_pk_bf16_f32 v205, v142, v143
v_exp_f32 v157, v157
v_exp_f32 v158, v158
v_cvt_pk_bf16_f32 v206, v156, v157
v_exp_f32 v159, v159
s_nop 0
v_cvt_pk_bf16_f32 v207, v158, v159
v_mfma_f32_16x16x32_bf16 v[128:131], a[128:131], v[16:19], v[80:83]
s_add_u32 s82, s82, 0x8000
ds_read_b128 a[160:163], v2 offset:24576
v_mfma_f32_16x16x32_bf16 v[128:131], a[132:135], v[20:23], v[128:131]
s_and_b32 s82, s82, 0x1ffff
v_exp_f32 v160, v160
v_mfma_f32_16x16x32_bf16 v[128:131], a[136:139], v[24:27], v[128:131]
s_add_u32 m0, s74, 0
v_exp_f32 v161, v161
v_mfma_f32_16x16x32_bf16 v[128:131], a[140:143], v[28:31], v[128:131]
s_add_u32 s72, s81, 0
ds_read_b128 a[164:167], v2 offset:25600
v_cvt_pk_bf16_f32 v208, v160, v161
v_mfma_f32_16x16x32_bf16 v[132:135], a[140:143], v[44:47], v[84:87]
v_exp_f32 v162, v162
v_mfma_f32_16x16x32_bf16 v[132:135], a[136:139], v[40:43], v[132:135]
buffer_load_dwordx4 v1, s[44:47], s72 offen sc1 lds
v_mfma_f32_16x16x32_bf16 v[132:135], a[132:135], v[36:39], v[132:135]
v_exp_f32 v163, v163
v_mfma_f32_16x16x32_bf16 v[132:135], a[128:131], v[32:35], v[132:135]
ds_read_b128 a[168:171], v2 offset:26624
v_cvt_pk_bf16_f32 v209, v162, v163
v_mfma_f32_16x16x32_bf16 v[136:139], a[128:131], v[48:51], v[88:91]
v_exp_f32 v176, v176
v_mfma_f32_16x16x32_bf16 v[136:139], a[132:135], v[52:55], v[136:139]
v_exp_f32 v177, v177
v_mfma_f32_16x16x32_bf16 v[136:139], a[136:139], v[56:59], v[136:139]
ds_read_b128 a[172:175], v2 offset:27648
v_cvt_pk_bf16_f32 v210, v176, v177
v_mfma_f32_16x16x32_bf16 v[136:139], a[140:143], v[60:63], v[136:139]
v_exp_f32 v178, v178
v_mfma_f32_16x16x32_bf16 v[140:143], a[140:143], v[76:79], v[92:95]
buffer_load_dwordx4 v1, s[44:47], s72 offen offset:1024 sc1 lds
v_mfma_f32_16x16x32_bf16 v[140:143], a[136:139], v[72:75], v[140:143]
v_exp_f32 v179, v179
v_mfma_f32_16x16x32_bf16 v[140:143], a[132:135], v[68:71], v[140:143]
ds_read_b128 a[176:179], v2 offset:28672
v_cvt_pk_bf16_f32 v211, v178, v179
v_mfma_f32_16x16x32_bf16 v[140:143], a[128:131], v[64:67], v[140:143]
v_exp_f32 v164, v164
v_mfma_f32_16x16x32_bf16 v[156:159], a[144:147], v[64:67], v[92:95]
v_exp_f32 v165, v165
v_mfma_f32_16x16x32_bf16 v[156:159], a[148:151], v[68:71], v[156:159]
ds_read_b128 a[180:183], v2 offset:29696
v_cvt_pk_bf16_f32 v212, v164, v165
v_mfma_f32_16x16x32_bf16 v[156:159], a[152:155], v[72:75], v[156:159]
v_exp_f32 v166, v166
v_mfma_f32_16x16x32_bf16 v[156:159], a[156:159], v[76:79], v[156:159]
buffer_load_dwordx4 v1, s[44:47], s72 offen offset:2048 sc1 lds
v_mfma_f32_16x16x32_bf16 v[152:155], a[156:159], v[60:63], v[88:91]
v_exp_f32 v167, v167
v_mfma_f32_16x16x32_bf16 v[152:155], a[152:155], v[56:59], v[152:155]
ds_read_b128 a[184:187], v2 offset:30720
v_cvt_pk_bf16_f32 v213, v166, v167
v_mfma_f32_16x16x32_bf16 v[152:155], a[148:151], v[52:55], v[152:155]
v_exp_f32 v180, v180
v_mfma_f32_16x16x32_bf16 v[152:155], a[144:147], v[48:51], v[152:155]
v_exp_f32 v181, v181
v_mfma_f32_16x16x32_bf16 v[148:151], a[144:147], v[32:35], v[84:87]
ds_read_b128 a[188:191], v2 offset:31744
v_cvt_pk_bf16_f32 v214, v180, v181
v_mfma_f32_16x16x32_bf16 v[148:151], a[148:151], v[36:39], v[148:151]
v_exp_f32 v182, v182
v_mfma_f32_16x16x32_bf16 v[148:151], a[152:155], v[40:43], v[148:151]
buffer_load_dwordx4 v1, s[44:47], s72 offen offset:3072 sc1 lds
v_mfma_f32_16x16x32_bf16 v[148:151], a[156:159], v[44:47], v[148:151]
s_add_u32 s66, s58, 1
v_exp_f32 v183, v183
v_mfma_f32_16x16x32_bf16 v[144:147], a[156:159], v[28:31], v[80:83]
s_and_b32 s66, s66, 3
ds_read_b128 a[224:227], v2 offset:8192
v_cvt_pk_bf16_f32 v215, v182, v183
v_mfma_f32_16x16x32_bf16 v[144:147], a[152:155], v[24:27], v[144:147]
s_mul_i32 s66, s66, 4160
v_exp_f32 v168, v168
v_mfma_f32_16x16x32_bf16 v[144:147], a[148:151], v[20:23], v[144:147]
s_add_u32 m0, s66, 131104
v_exp_f32 v169, v169
v_mfma_f32_16x16x32_bf16 v[144:147], a[144:147], v[16:19], v[144:147]
s_waitcnt lgkmcnt(9)
ds_read_b128 a[228:231], v2 offset:9216
v_cvt_pk_bf16_f32 v216, v168, v169
v_mfma_f32_16x16x32_bf16 a[0:3], a[192:195], v[192:195], 0
s_add_u32 s72, s93, 0x2
v_exp_f32 v170, v170
v_mfma_f32_16x16x32_bf16 a[32:35], a[192:195], v[196:199], 0
buffer_load_dwordx4 v1, s[36:39], s72 offen lds
v_mfma_f32_16x16x32_bf16 a[64:67], a[192:195], v[200:203], 0
v_exp_f32 v171, v171
v_mfma_f32_16x16x32_bf16 a[96:99], a[192:195], v[204:207], 0
ds_read_b128 a[232:235], v2 offset:10240
v_cvt_pk_bf16_f32 v217, v170, v171
v_mfma_f32_16x16x32_bf16 a[100:103], a[196:199], v[204:207], 0
v_exp_f32 v184, v184
v_mfma_f32_16x16x32_bf16 a[68:71], a[196:199], v[200:203], 0
v_exp_f32 v185, v185
v_mfma_f32_16x16x32_bf16 a[36:39], a[196:199], v[196:199], 0
ds_read_b128 a[236:239], v2 offset:11264
v_cvt_pk_bf16_f32 v218, v184, v185
v_mfma_f32_16x16x32_bf16 a[4:7], a[196:199], v[192:195], 0
v_exp_f32 v186, v186
v_mfma_f32_16x16x32_bf16 a[8:11], a[200:203], v[192:195], 0
buffer_load_dwordx4 v1, s[36:39], s72 offen offset:1024 lds
v_mfma_f32_16x16x32_bf16 a[40:43], a[200:203], v[196:199], 0
v_exp_f32 v187, v187
v_mfma_f32_16x16x32_bf16 a[72:75], a[200:203], v[200:203], 0
ds_read_b128 a[240:243], v2 offset:12288
v_cvt_pk_bf16_f32 v219, v186, v187
v_mfma_f32_16x16x32_bf16 a[104:107], a[200:203], v[204:207], 0
v_exp_f32 v172, v172
v_mfma_f32_16x16x32_bf16 a[108:111], a[204:207], v[204:207], 0
v_exp_f32 v173, v173
v_mfma_f32_16x16x32_bf16 a[76:79], a[204:207], v[200:203], 0
ds_read_b128 a[244:247], v2 offset:13312
v_cvt_pk_bf16_f32 v220, v172, v173
v_mfma_f32_16x16x32_bf16 a[44:47], a[204:207], v[196:199], 0
v_exp_f32 v174, v174
v_mfma_f32_16x16x32_bf16 a[12:15], a[204:207], v[192:195], 0
buffer_load_dwordx4 v1, s[36:39], s72 offen offset:2048 lds
v_mfma_f32_16x16x32_bf16 a[16:19], a[208:211], v[192:195], 0
v_exp_f32 v175, v175
v_mfma_f32_16x16x32_bf16 a[48:51], a[208:211], v[196:199], 0
ds_read_b128 a[248:251], v2 offset:14336
v_cvt_pk_bf16_f32 v221, v174, v175
v_mfma_f32_16x16x32_bf16 a[80:83], a[208:211], v[200:203], 0
v_exp_f32 v188, v188
v_mfma_f32_16x16x32_bf16 a[112:115], a[208:211], v[204:207], 0
v_exp_f32 v189, v189
v_mfma_f32_16x16x32_bf16 a[116:119], a[212:215], v[204:207], 0
ds_read_b128 a[252:255], v2 offset:15360
v_cvt_pk_bf16_f32 v222, v188, v189
v_mfma_f32_16x16x32_bf16 a[84:87], a[212:215], v[200:203], 0
v_exp_f32 v190, v190
v_mfma_f32_16x16x32_bf16 a[52:55], a[212:215], v[196:199], 0
buffer_load_dwordx4 v1, s[36:39], s72 offen offset:3072 lds
v_mfma_f32_16x16x32_bf16 a[20:23], a[212:215], v[192:195], 0
v_exp_f32 v191, v191
v_mfma_f32_16x16x32_bf16 a[24:27], a[216:219], v[192:195], 0
v_cvt_pk_bf16_f32 v223, v190, v191
v_add_u32 v2, s82, v1
v_mfma_f32_16x16x32_bf16 a[56:59], a[216:219], v[196:199], 0
v_and_b32 v240, 15, v0
v_lshrrev_b32 v241, 4, v0
v_mfma_f32_16x16x32_bf16 a[88:91], a[216:219], v[200:203], 0
v_add_u32 v248, 1, v240
v_and_b32 v249, 3, v248
v_mfma_f32_16x16x32_bf16 a[120:123], a[216:219], v[204:207], 0
v_lshrrev_b32 v248, 2, v248
v_mov_b32 v250, 0x20000
v_mfma_f32_16x16x32_bf16 a[124:127], a[220:223], v[204:207], 0
v_mov_b32 v252, 0x20001
v_lshlrev_b32 v6, 3, v249
v_mfma_f32_16x16x32_bf16 a[92:95], a[220:223], v[200:203], 0
v_lshrrev_b32 v6, v6, v252
v_and_b32 v6, 3, v6
v_mfma_f32_16x16x32_bf16 a[60:63], a[220:223], v[196:199], 0
v_cmp_ne_u32 vcc, 1, v249
v_mul_u32_u24 v6, 16640, v6
v_mfma_f32_16x16x32_bf16 a[28:31], a[220:223], v[192:195], 0
v_add_u32 v6, s92, v6
v_cndmask_b32 v6, v250, v6, vcc
v_mfma_f32_16x16x32_bf16 v[224:227], v[120:123], v[192:195], 0
v_add_u32 v253, s58, v249
v_and_b32 v253, 3, v253
v_mfma_f32_16x16x32_bf16 v[228:231], v[120:123], v[196:199], 0
v_mul_u32_u24 v253, 4160, v253
v_add_u32 v6, v6, v253
v_mfma_f32_16x16x32_bf16 v[232:235], v[120:123], v[200:203], 0
s_waitcnt vmcnt(12) lgkmcnt(8)
v_mfma_f32_16x16x32_bf16 v[236:239], v[120:123], v[204:207], 0
s_barrier
s_lshl_b32 s75, s59, 4
s_and_b32 s76, s84, 15
s_add_u32 s75, s75, s76
s_lshl_b32 s75, s75, 14
s_cmp_ge_u32 s60, 4
s_cselect_b32 s75, s75, 0x40001000
s_lshl_b32 s83, s60, 1
s_sub_u32 s83, 2, s83
s_cmp_eq_u32 s83, 0
s_cbranch_scc1 LLT1
.p2align 5
s_nop 0
s_nop 0
LloopI:
v_mfma_f32_16x16x32_bf16 v[160:163], a[160:163], v[16:19], v[80:83]
s_xor_b32 s74, s82, 0x10000
v_exp_f32 v128, v128
v_mfma_f32_16x16x32_bf16 v[160:163], a[164:167], v[20:23], v[160:163]
s_add_u32 s74, s74, s64
ds_read_b128 a[128:131], v2 offset:16384
v_mfma_f32_16x16x32_bf16 v[160:163], a[168:171], v[24:27], v[160:163]
s_add_u32 s81, s81, 0x8000
v_exp_f32 v129, v129
v_mfma_f32_16x16x32_bf16 v[160:163], a[172:175], v[28:31], v[160:163]
s_add_u32 m0, s74, 16384
v_exp_f32 v130, v130
v_mfma_f32_16x16x32_bf16 v[164:167], a[172:175], v[44:47], v[84:87]
s_add_u32 s72, s81, 16384
ds_read_b128 a[132:135], v2 offset:17408
v_cvt_pk_bf16_f32 v192, v128, v129
v_mfma_f32_16x16x32_bf16 v[164:167], a[168:171], v[40:43], v[164:167]
v_exp_f32 v131, v131
v_mfma_f32_16x16x32_bf16 v[164:167], a[164:167], v[36:39], v[164:167]
v_exp_f32 v144, v144
v_mfma_f32_16x16x32_bf16 v[164:167], a[160:163], v[32:35], v[164:167]
ds_read_b128 a[136:139], v2 offset:18432
v_cvt_pk_bf16_f32 v193, v130, v131
v_mfma_f32_16x16x32_bf16 v[168:171], a[160:163], v[48:51], v[88:91]
buffer_load_dwordx4 v1, s[44:47], s72 offen sc1 lds
v_mfma_f32_16x16x32_bf16 v[168:171], a[164:167], v[52:55], v[168:171]
v_exp_f32 v145, v145
v_mfma_f32_16x16x32_bf16 v[168:171], a[168:171], v[56:59], v[168:171]
v_exp_f32 v146, v146
v_mfma_f32_16x16x32_bf16 v[168:171], a[172:175], v[60:63], v[168:171]
ds_read_b128 a[140:143], v2 offset:19456
v_cvt_pk_bf16_f32 v194, v144, v145
v_mfma_f32_16x16x32_bf16 v[172:175], a[172:175], v[76:79], v[92:95]
v_exp_f32 v147, v147
v_mfma_f32_16x16x32_bf16 v[172:175], a[168:171], v[72:75], v[172:175]
v_exp_f32 v132, v132
v_mfma_f32_16x16x32_bf16 v[172:175], a[164:167], v[68:71], v[172:175]
ds_read_b128 a[144:147], v2 offset:20480
v_cvt_pk_bf16_f32 v195, v146, v147
v_mfma_f32_16x16x32_bf16 v[172:175], a[160:163], v[64:67], v[172:175]
v_exp_f32 v133, v133
v_mfma_f32_16x16x32_bf16 v[188:191], a[176:179], v[64:67], v[92:95]
v_exp_f32 v134, v134
v_mfma_f32_16x16x32_bf16 v[188:191], a[180:183], v[68:71], v[188:191]
ds_read_b128 a[148:151], v2 offset:21504
v_cvt_pk_bf16_f32 v196, v132, v133
v_mfma_f32_16x16x32_bf16 v[188:191], a[184:187], v[72:75], v[188:191]
v_exp_f32 v135, v135
v_mfma_f32_16x16x32_bf16 v[188:191], a[188:191], v[76:79], v[188:191]
v_exp_f32 v148, v148
v_mfma_f32_16x16x32_bf16 v[184:187], a[188:191], v[60:63], v[88:91]
ds_read_b128 a[152:155], v2 offset:22528
v_cvt_pk_bf16_f32 v197, v134, v135
v_mfma_f32_16x16x32_bf16 v[184:187], a[184:187], v[56:59], v[184:187]
buffer_load_dwordx4 v1, s[44:47], s72 offen offset:1024 sc1 lds
v_mfma_f32_16x16x32_bf16 v[184:187], a[180:183], v[52:55], v[184:187]
v_exp_f32 v149, v149
v_mfma_f32_16x16x32_bf16 v[184:187], a[176:179], v[48:51], v[184:187]
v_exp_f32 v150, v150
v_mfma_f32_16x16x32_bf16 v[180:183], a[176:179], v[32:35], v[84:87]
ds_read_b128 a[156:159], v2 offset:23552
v_cvt_pk_bf16_f32 v198, v148, v149
v_mfma_f32_16x16x32_bf16 v[180:183], a[180:183], v[36:39], v[180:183]
v_exp_f32 v151, v151
v_mfma_f32_16x16x32_bf16 v[180:183], a[184:187], v[40:43], v[180:183]
v_exp_f32 v136, v136
v_mfma_f32_16x16x32_bf16 v[180:183], a[188:191], v[44:47], v[180:183]
ds_read_b128 a[192:195], v2 offset:0
v_cvt_pk_bf16_f32 v199, v150, v151
v_mfma_f32_16x16x32_bf16 v[176:179], a[188:191], v[28:31], v[80:83]
v_exp_f32 v137, v137
v_mfma_f32_16x16x32_bf16 v[176:179], a[184:187], v[24:27], v[176:179]
v_exp_f32 v138, v138
v_mfma_f32_16x16x32_bf16 v[176:179], a[180:183], v[20:23], v[176:179]
ds_read_b128 a[196:199], v2 offset:1024
v_cvt_pk_bf16_f32 v200, v136, v137
v_mfma_f32_16x16x32_bf16 v[176:179], a[176:179], v[16:19], v[176:179]
s_waitcnt lgkmcnt(10)
v_exp_f32 v139, v139
v_mfma_f32_16x16x32_bf16 a[0:3], a[224:227], v[208:211], a[0:3]
v_exp_f32 v152, v152
v_mfma_f32_16x16x32_bf16 a[32:35], a[224:227], v[212:215], a[32:35]
ds_read_b128 a[200:203], v2 offset:2048
v_cvt_pk_bf16_f32 v201, v138, v139
v_mfma_f32_16x16x32_bf16 a[64:67], a[224:227], v[216:219], a[64:67]
buffer_load_dwordx4 v1, s[44:47], s72 offen offset:2048 sc1 lds
v_mfma_f32_16x16x32_bf16 a[96:99], a[224:227], v[220:223], a[96:99]
v_exp_f32 v153, v153
v_mfma_f32_16x16x32_bf16 a[100:103], a[228:231], v[220:223], a[100:103]
v_exp_f32 v154, v154
v_mfma_f32_16x16x32_bf16 a[68:71], a[228:231], v[216:219], a[68:71]
ds_read_b128 a[204:207], v2 offset:3072
v_cvt_pk_bf16_f32 v202, v152, v153
v_mfma_f32_16x16x32_bf16 a[36:39], a[228:231], v[212:215], a[36:39]
v_exp_f32 v155, v155
v_mfma_f32_16x16x32_bf16 a[4:7], a[228:231], v[208:211], a[4:7]
v_exp_f32 v140, v140
v_mfma_f32_16x16x32_bf16 a[8:11], a[232:235], v[208:211], a[8:11]
ds_read_b128 a[208:211], v2 offset:4096
v_cvt_pk_bf16_f32 v203, v154, v155
v_mfma_f32_16x16x32_bf16 a[40:43], a[232:235], v[212:215], a[40:43]
v_exp_f32 v141, v141
v_mfma_f32_16x16x32_bf16 a[72:75], a[232:235], v[216:219], a[72:75]
v_exp_f32 v142, v142
v_mfma_f32_16x16x32_bf16 a[104:107], a[232:235], v[220:223], a[104:107]
ds_read_b128 a[212:215], v2 offset:5120
v_cvt_pk_bf16_f32 v204, v140, v141
v_mfma_f32_16x16x32_bf16 a[108:111], a[236:239], v[220:223], a[108:111]
v_exp_f32 v143, v143
v_mfma_f32_16x16x32_bf16 a[76:79], a[236:239], v[216:219], a[76:79]
v_exp_f32 v156, v156
v_mfma_f32_16x16x32_bf16 a[44:47], a[236:239], v[212:215], a[44:47]
ds_read_b128 a[216:219], v2 offset:6144
v_cvt_pk_bf16_f32 v205, v142, v143
v_mfma_f32_16x16x32_bf16 a[12:15], a[236:239], v[208:211], a[12:15]
buffer_load_dwordx4 v1, s[44:47], s72 offen offset:3072 sc1 lds
v_mfma_f32_16x16x32_bf16 a[16:19], a[240:243], v[208:211], a[16:19]
v_exp_f32 v157, v157
v_mfma_f32_16x16x32_bf16 a[48:51], a[240:243], v[212:215], a[48:51]
v_exp_f32 v158, v158
v_mfma_f32_16x16x32_bf16 a[80:83], a[240:243], v[216:219], a[80:83]
ds_read_b128 a[220:223], v2 offset:7168
v_cvt_pk_bf16_f32 v206, v156, v157
v_mfma_f32_16x16x32_bf16 a[112:115], a[240:243], v[220:223], a[112:115]
v_exp_f32 v159, v159
v_mfma_f32_16x16x32_bf16 a[116:119], a[244:247], v[220:223], a[116:119]
v_cvt_pk_bf16_f32 v207, v158, v159
v_add_u32 v15, s75, v3
v_mfma_f32_16x16x32_bf16 a[84:87], a[244:247], v[216:219], a[84:87]
v_mfma_f32_16x16x32_bf16 a[52:55], a[244:247], v[212:215], a[52:55]
v_mfma_f32_16x16x32_bf16 a[20:23], a[244:247], v[208:211], a[20:23]
v_mfma_f32_16x16x32_bf16 a[24:27], a[248:251], v[208:211], a[24:27]
v_mfma_f32_16x16x32_bf16 a[56:59], a[248:251], v[212:215], a[56:59]
v_mfma_f32_16x16x32_bf16 a[88:91], a[248:251], v[216:219], a[88:91]
v_mfma_f32_16x16x32_bf16 a[120:123], a[248:251], v[220:223], a[120:123]
v_mfma_f32_16x16x32_bf16 a[124:127], a[252:255], v[220:223], a[124:127]
v_mfma_f32_16x16x32_bf16 a[92:95], a[252:255], v[216:219], a[92:95]
v_mfma_f32_16x16x32_bf16 a[60:63], a[252:255], v[212:215], a[60:63]
v_mfma_f32_16x16x32_bf16 a[28:31], a[252:255], v[208:211], a[28:31]
v_mfma_f32_16x16x32_bf16 v[224:227], v[120:123], v[208:211], v[224:227]
v_mfma_f32_16x16x32_bf16 v[228:231], v[120:123], v[212:215], v[228:231]
v_mfma_f32_16x16x32_bf16 v[232:235], v[120:123], v[216:219], v[232:235]
v_mfma_f32_16x16x32_bf16 v[236:239], v[120:123], v[220:223], v[236:239]
s_waitcnt lgkmcnt(8)
v_mfma_f32_16x16x32_bf16 v[128:131], a[128:131], v[16:19], v[80:83]
s_add_u32 s82, s82, 0x8000
ds_read_b128 a[160:163], v2 offset:24576
v_mfma_f32_16x16x32_bf16 v[128:131], a[132:135], v[20:23], v[128:131]
s_and_b32 s82, s82, 0x1ffff
v_exp_f32 v160, v160
v_mfma_f32_16x16x32_bf16 v[128:131], a[136:139], v[24:27], v[128:131]
s_add_u32 m0, s74, 0
v_exp_f32 v161, v161
v_mfma_f32_16x16x32_bf16 v[128:131], a[140:143], v[28:31], v[128:131]
s_add_u32 s72, s81, 0
ds_read_b128 a[164:167], v2 offset:25600
v_cvt_pk_bf16_f32 v208, v160, v161
v_mfma_f32_16x16x32_bf16 v[132:135], a[140:143], v[44:47], v[84:87]
v_exp_f32 v162, v162
v_mfma_f32_16x16x32_bf16 v[132:135], a[136:139], v[40:43], v[132:135]
v_exp_f32 v163, v163
v_mfma_f32_16x16x32_bf16 v[132:135], a[132:135], v[36:39], v[132:135]
buffer_load_dwordx4 v1, s[44:47], s72 offen sc1 lds
v_mfma_f32_16x16x32_bf16 v[132:135], a[128:131], v[32:35], v[132:135]
ds_read_b128 a[168:171], v2 offset:26624
v_cvt_pk_bf16_f32 v209, v162, v163
v_mfma_f32_16x16x32_bf16 v[136:139], a[128:131], v[48:51], v[88:91]
v_exp_f32 v176, v176
v_mfma_f32_16x16x32_bf16 v[136:139], a[132:135], v[52:55], v[136:139]
v_exp_f32 v177, v177
v_mfma_f32_16x16x32_bf16 v[136:139], a[136:139], v[56:59], v[136:139]
ds_read_b128 a[172:175], v2 offset:27648
v_cvt_pk_bf16_f32 v210, v176, v177
v_mfma_f32_16x16x32_bf16 v[136:139], a[140:143], v[60:63], v[136:139]
v_exp_f32 v178, v178
v_mfma_f32_16x16x32_bf16 v[140:143], a[140:143], v[76:79], v[92:95]
v_exp_f32 v179, v179
v_mfma_f32_16x16x32_bf16 v[140:143], a[136:139], v[72:75], v[140:143]
ds_read_b128 a[176:179], v2 offset:28672
v_cvt_pk_bf16_f32 v211, v178, v179
v_mfma_f32_16x16x32_bf16 v[140:143], a[132:135], v[68:71], v[140:143]
v_exp_f32 v164, v164
v_mfma_f32_16x16x32_bf16 v[140:143], a[128:131], v[64:67], v[140:143]
v_exp_f32 v165, v165
v_mfma_f32_16x16x32_bf16 v[156:159], a[144:147], v[64:67], v[92:95]
ds_read_b128 a[180:183], v2 offset:29696
v_cvt_pk_bf16_f32 v212, v164, v165
v_mfma_f32_16x16x32_bf16 v[156:159], a[148:151], v[68:71], v[156:159]
buffer_load_dwordx4 v1, s[44:47], s72 offen offset:1024 sc1 lds
v_mfma_f32_16x16x32_bf16 v[156:159], a[152:155], v[72:75], v[156:159]
v_exp_f32 v166, v166
v_mfma_f32_16x16x32_bf16 v[156:159], a[156:159], v[76:79], v[156:159]
v_exp_f32 v167, v167
v_mfma_f32_16x16x32_bf16 v[152:155], a[156:159], v[60:63], v[88:91]
ds_read_b128 a[184:187], v2 offset:30720
v_cvt_pk_bf16_f32 v213, v166, v167
v_mfma_f32_16x16x32_bf16 v[152:155], a[152:155], v[56:59], v[152:155]
v_exp_f32 v180, v180
v_mfma_f32_16x16x32_bf16 v[152:155], a[148:151], v[52:55], v[152:155]
v_exp_f32 v181, v181
v_mfma_f32_16x16x32_bf16 v[152:155], a[144:147], v[48:51], v[152:155]
ds_read_b128 a[188:191], v2 offset:31744
v_cvt_pk_bf16_f32 v214, v180, v181
v_mfma_f32_16x16x32_bf16 v[148:151], a[144:147], v[32:35], v[84:87]
v_exp_f32 v182, v182
v_mfma_f32_16x16x32_bf16 v[148:151], a[148:151], v[36:39], v[148:151]
v_exp_f32 v183, v183
v_mfma_f32_16x16x32_bf16 v[148:151], a[152:155], v[40:43], v[148:151]
ds_read_b128 a[224:227], v2 offset:8192
v_cvt_pk_bf16_f32 v215, v182, v183
v_mfma_f32_16x16x32_bf16 v[148:151], a[156:159], v[44:47], v[148:151]
v_exp_f32 v168, v168
v_mfma_f32_16x16x32_bf16 v[144:147], a[156:159], v[28:31], v[80:83]
buffer_load_dwordx4 v1, s[44:47], s72 offen offset:2048 sc1 lds
v_mfma_f32_16x16x32_bf16 v[144:147], a[152:155], v[24:27], v[144:147]
v_exp_f32 v169, v169
v_mfma_f32_16x16x32_bf16 v[144:147], a[148:151], v[20:23], v[144:147]
ds_read_b128 a[228:231], v2 offset:9216
v_cvt_pk_bf16_f32 v216, v168, v169
v_mfma_f32_16x16x32_bf16 v[144:147], a[144:147], v[16:19], v[144:147]
s_waitcnt lgkmcnt(10)
v_exp_f32 v170, v170
v_mfma_f32_16x16x32_bf16 a[0:3], a[192:195], v[192:195], a[0:3]
v_exp_f32 v171, v171
v_mfma_f32_16x16x32_bf16 a[32:35], a[192:195], v[196:199], a[32:35]
ds_read_b128 a[232:235], v2 offset:10240
v_cvt_pk_bf16_f32 v217, v170, v171
v_mfma_f32_16x16x32_bf16 a[64:67], a[192:195], v[200:203], a[64:67]
v_exp_f32 v184, v184
v_mfma_f32_16x16x32_bf16 a[96:99], a[192:195], v[204:207], a[96:99]
v_exp_f32 v185, v185
v_mfma_f32_16x16x32_bf16 a[100:103], a[196:199], v[204:207], a[100:103]
ds_read_b128 a[236:239], v2 offset:11264
v_cvt_pk_bf16_f32 v218, v184, v185
v_mfma_f32_16x16x32_bf16 a[68:71], a[196:199], v[200:203], a[68:71]
v_exp_f32 v186, v186
v_mfma_f32_16x16x32_bf16 a[36:39], a[196:199], v[196:199], a[36:39]
buffer_load_dwordx4 v1, s[44:47], s72 offen offset:3072 sc1 lds
v_mfma_f32_16x16x32_bf16 a[4:7], a[196:199], v[192:195], a[4:7]
s_add_u32 s75, s75, 0x1000
v_exp_f32 v187, v187
v_mfma_f32_16x16x32_bf16 a[8:11], a[200:203], v[192:195], a[8:11]
s_and_b32 s76, s75, 0x3000
ds_read_b128 a[240:243], v2 offset:12288
v_cvt_pk_bf16_f32 v219, v186, v187
v_mfma_f32_16x16x32_bf16 a[40:43], a[200:203], v[196:199], a[40:43]
s_cselect_b32 s75, s75, 0x40001000
v_exp_f32 v172, v172
v_mfma_f32_16x16x32_bf16 a[72:75], a[200:203], v[200:203], a[72:75]
v_exp_f32 v173, v173
v_mfma_f32_16x16x32_bf16 a[104:107], a[200:203], v[204:207], a[104:107]
ds_read_b128 a[244:247], v2 offset:13312
v_cvt_pk_bf16_f32 v220, v172, v173
v_mfma_f32_16x16x32_bf16 a[108:111], a[204:207], v[204:207], a[108:111]
v_exp_f32 v174, v174
v_mfma_f32_16x16x32_bf16 a[76:79], a[204:207], v[200:203], a[76:79]
v_exp_f32 v175, v175
v_mfma_f32_16x16x32_bf16 a[44:47], a[204:207], v[196:199], a[44:47]
ds_read_b128 a[248:251], v2 offset:14336
v_cvt_pk_bf16_f32 v221, v174, v175
v_mfma_f32_16x16x32_bf16 a[12:15], a[204:207], v[192:195], a[12:15]
v_exp_f32 v188, v188
v_mfma_f32_16x16x32_bf16 a[16:19], a[208:211], v[192:195], a[16:19]
buffer_load_dword v4, v15, s[24:27], 0 offen
v_mfma_f32_16x16x32_bf16 a[48:51], a[208:211], v[196:199], a[48:51]
v_exp_f32 v189, v189
v_mfma_f32_16x16x32_bf16 a[80:83], a[208:211], v[200:203], a[80:83]
ds_read_b128 a[252:255], v2 offset:15360
v_cvt_pk_bf16_f32 v222, v188, v189
v_mfma_f32_16x16x32_bf16 a[112:115], a[208:211], v[204:207], a[112:115]
v_exp_f32 v190, v190
v_mfma_f32_16x16x32_bf16 a[116:119], a[212:215], v[204:207], a[116:119]
v_exp_f32 v191, v191
v_mfma_f32_16x16x32_bf16 a[84:87], a[212:215], v[200:203], a[84:87]
v_cvt_pk_bf16_f32 v223, v190, v191
v_add_u32 v2, s82, v1
v_mfma_f32_16x16x32_bf16 a[52:55], a[212:215], v[196:199], a[52:55]
v_mfma_f32_16x16x32_bf16 a[20:23], a[212:215], v[192:195], a[20:23]
v_mfma_f32_16x16x32_bf16 a[24:27], a[216:219], v[192:195], a[24:27]
v_mfma_f32_16x16x32_bf16 a[56:59], a[216:219], v[196:199], a[56:59]
v_mfma_f32_16x16x32_bf16 a[88:91], a[216:219], v[200:203], a[88:91]
v_mfma_f32_16x16x32_bf16 a[120:123], a[216:219], v[204:207], a[120:123]
v_mfma_f32_16x16x32_bf16 a[124:127], a[220:223], v[204:207], a[124:127]
v_mfma_f32_16x16x32_bf16 a[92:95], a[220:223], v[200:203], a[92:95]
v_mfma_f32_16x16x32_bf16 a[60:63], a[220:223], v[196:199], a[60:63]
v_mfma_f32_16x16x32_bf16 a[28:31], a[220:223], v[192:195], a[28:31]
v_mfma_f32_16x16x32_bf16 v[224:227], v[120:123], v[192:195], v[224:227]
s_waitcnt vmcnt(9) lgkmcnt(8)
v_mfma_f32_16x16x32_bf16 v[228:231], v[120:123], v[196:199], v[228:231]
s_barrier
v_mfma_f32_16x16x32_bf16 v[232:235], v[120:123], v[200:203], v[232:235]
s_add_u32 s83, s83, 1
v_mfma_f32_16x16x32_bf16 v[236:239], v[120:123], v[204:207], v[236:239]
s_cbranch_scc0 LloopI
LLT1:
Lstub1:
s_cbranch_execz Lstub5
v_mfma_f32_16x16x32_bf16 v[160:163], a[160:163], v[16:19], v[80:83]
s_xor_b32 s74, s82, 0x10000
v_exp_f32 v128, v128
v_mfma_f32_16x16x32_bf16 v[160:163], a[164:167], v[20:23], v[160:163]
s_add_u32 s74, s74, s64
ds_read_b128 a[128:131], v2 offset:16384
v_mfma_f32_16x16x32_bf16 v[160:163], a[168:171], v[24:27], v[160:163]
s_add_u32 s81, s81, 0x8000
v_exp_f32 v129, v129
v_mfma_f32_16x16x32_bf16 v[160:163], a[172:175], v[28:31], v[160:163]
s_add_u32 m0, s74, 16384
v_exp_f32 v130, v130
v_mfma_f32_16x16x32_bf16 v[164:167], a[172:175], v[44:47], v[84:87]
s_add_u32 s72, s81, 16384
ds_read_b128 a[132:135], v2 offset:17408
v_cvt_pk_bf16_f32 v192, v128, v129
v_mfma_f32_16x16x32_bf16 v[164:167], a[168:171], v[40:43], v[164:167]
v_exp_f32 v131, v131
v_mfma_f32_16x16x32_bf16 v[164:167], a[164:167], v[36:39], v[164:167]
v_exp_f32 v144, v144
v_mfma_f32_16x16x32_bf16 v[164:167], a[160:163], v[32:35], v[164:167]
ds_read_b128 a[136:139], v2 offset:18432
v_cvt_pk_bf16_f32 v193, v130, v131
v_mfma_f32_16x16x32_bf16 v[168:171], a[160:163], v[48:51], v[88:91]
buffer_load_dwordx4 v1, s[44:47], s72 offen sc1 lds
v_mfma_f32_16x16x32_bf16 v[168:171], a[164:167], v[52:55], v[168:171]
v_exp_f32 v145, v145
v_mfma_f32_16x16x32_bf16 v[168:171], a[168:171], v[56:59], v[168:171]
v_exp_f32 v146, v146
v_mfma_f32_16x16x32_bf16 v[168:171], a[172:175], v[60:63], v[168:171]
ds_read_b128 a[140:143], v2 offset:19456
v_cvt_pk_bf16_f32 v194, v144, v145
v_mfma_f32_16x16x32_bf16 v[172:175], a[172:175], v[76:79], v[92:95]
v_exp_f32 v147, v147
v_mfma_f32_16x16x32_bf16 v[172:175], a[168:171], v[72:75], v[172:175]
v_exp_f32 v132, v132
v_mfma_f32_16x16x32_bf16 v[172:175], a[164:167], v[68:71], v[172:175]
ds_read_b128 a[144:147], v2 offset:20480
v_cvt_pk_bf16_f32 v195, v146, v147
v_mfma_f32_16x16x32_bf16 v[172:175], a[160:163], v[64:67], v[172:175]
v_exp_f32 v133, v133
v_mfma_f32_16x16x32_bf16 v[188:191], a[176:179], v[64:67], v[92:95]
v_exp_f32 v134, v134
v_mfma_f32_16x16x32_bf16 v[188:191], a[180:183], v[68:71], v[188:191]
ds_read_b128 a[148:151], v2 offset:21504
v_cvt_pk_bf16_f32 v196, v132, v133
v_mfma_f32_16x16x32_bf16 v[188:191], a[184:187], v[72:75], v[188:191]
v_exp_f32 v135, v135
v_mfma_f32_16x16x32_bf16 v[188:191], a[188:191], v[76:79], v[188:191]
v_exp_f32 v148, v148
v_mfma_f32_16x16x32_bf16 v[184:187], a[188:191], v[60:63], v[88:91]
ds_read_b128 a[152:155], v2 offset:22528
v_cvt_pk_bf16_f32 v197, v134, v135
v_mfma_f32_16x16x32_bf16 v[184:187], a[184:187], v[56:59], v[184:187]
buffer_load_dwordx4 v1, s[44:47], s72 offen offset:1024 sc1 lds
v_mfma_f32_16x16x32_bf16 v[184:187], a[180:183], v[52:55], v[184:187]
v_exp_f32 v149, v149
v_mfma_f32_16x16x32_bf16 v[184:187], a[176:179], v[48:51], v[184:187]
v_exp_f32 v150, v150
v_mfma_f32_16x16x32_bf16 v[180:183], a[176:179], v[32:35], v[84:87]
ds_read_b128 a[156:159], v2 offset:23552
v_cvt_pk_bf16_f32 v198, v148, v149
v_mfma_f32_16x16x32_bf16 v[180:183], a[180:183], v[36:39], v[180:183]
v_exp_f32 v151, v151
v_mfma_f32_16x16x32_bf16 v[180:183], a[184:187], v[40:43], v[180:183]
v_exp_f32 v136, v136
v_mfma_f32_16x16x32_bf16 v[180:183], a[188:191], v[44:47], v[180:183]
ds_read_b128 a[192:195], v2 offset:0
v_cvt_pk_bf16_f32 v199, v150, v151
v_mfma_f32_16x16x32_bf16 v[176:179], a[188:191], v[28:31], v[80:83]
v_exp_f32 v137, v137
v_mfma_f32_16x16x32_bf16 v[176:179], a[184:187], v[24:27], v[176:179]
v_exp_f32 v138, v138
v_mfma_f32_16x16x32_bf16 v[176:179], a[180:183], v[20:23], v[176:179]
ds_read_b128 a[196:199], v2 offset:1024
v_cvt_pk_bf16_f32 v200, v136, v137
v_mfma_f32_16x16x32_bf16 v[176:179], a[176:179], v[16:19], v[176:179]
s_waitcnt lgkmcnt(10)
v_exp_f32 v139, v139
v_mfma_f32_16x16x32_bf16 a[0:3], a[224:227], v[208:211], a[0:3]
v_exp_f32 v152, v152
v_mfma_f32_16x16x32_bf16 a[32:35], a[224:227], v[212:215], a[32:35]
ds_read_b128 a[200:203], v2 offset:2048
v_cvt_pk_bf16_f32 v201, v138, v139
v_mfma_f32_16x16x32_bf16 a[64:67], a[224:227], v[216:219], a[64:67]
buffer_load_dwordx4 v1, s[44:47], s72 offen offset:2048 sc1 lds
v_mfma_f32_16x16x32_bf16 a[96:99], a[224:227], v[220:223], a[96:99]
Lstub2:
s_cbranch_execz Lstub6
v_exp_f32 v153, v153
v_mfma_f32_16x16x32_bf16 a[100:103], a[228:231], v[220:223], a[100:103]
v_exp_f32 v154, v154
v_mfma_f32_16x16x32_bf16 a[68:71], a[228:231], v[216:219], a[68:71]
ds_read_b128 a[204:207], v2 offset:3072
v_cvt_pk_bf16_f32 v202, v152, v153
v_mfma_f32_16x16x32_bf16 a[36:39], a[228:231], v[212:215], a[36:39]
v_exp_f32 v155, v155
v_mfma_f32_16x16x32_bf16 a[4:7], a[228:231], v[208:211], a[4:7]
v_exp_f32 v140, v140
v_mfma_f32_16x16x32_bf16 a[8:11], a[232:235], v[208:211], a[8:11]
ds_read_b128 a[208:211], v2 offset:4096
v_cvt_pk_bf16_f32 v203, v154, v155
v_mfma_f32_16x16x32_bf16 a[40:43], a[232:235], v[212:215], a[40:43]
v_exp_f32 v141, v141
v_mfma_f32_16x16x32_bf16 a[72:75], a[232:235], v[216:219], a[72:75]
v_exp_f32 v142, v142
v_mfma_f32_16x16x32_bf16 a[104:107], a[232:235], v[220:223], a[104:107]
ds_read_b128 a[212:215], v2 offset:5120
v_cvt_pk_bf16_f32 v204, v140, v141
v_mfma_f32_16x16x32_bf16 a[108:111], a[236:239], v[220:223], a[108:111]
v_exp_f32 v143, v143
v_mfma_f32_16x16x32_bf16 a[76:79], a[236:239], v[216:219], a[76:79]
v_exp_f32 v156, v156
v_mfma_f32_16x16x32_bf16 a[44:47], a[236:239], v[212:215], a[44:47]
ds_read_b128 a[216:219], v2 offset:6144
v_cvt_pk_bf16_f32 v205, v142, v143
v_mfma_f32_16x16x32_bf16 a[12:15], a[236:239], v[208:211], a[12:15]
buffer_load_dwordx4 v1, s[44:47], s72 offen offset:3072 sc1 lds
v_mfma_f32_16x16x32_bf16 a[16:19], a[240:243], v[208:211], a[16:19]
v_exp_f32 v157, v157
v_mfma_f32_16x16x32_bf16 a[48:51], a[240:243], v[212:215], a[48:51]
v_exp_f32 v158, v158
v_mfma_f32_16x16x32_bf16 a[80:83], a[240:243], v[216:219], a[80:83]
ds_read_b128 a[220:223], v2 offset:7168
v_cvt_pk_bf16_f32 v206, v156, v157
v_mfma_f32_16x16x32_bf16 a[112:115], a[240:243], v[220:223], a[112:115]
v_exp_f32 v159, v159
v_mfma_f32_16x16x32_bf16 a[116:119], a[244:247], v[220:223], a[116:119]
v_cvt_pk_bf16_f32 v207, v158, v159
v_mfma_f32_16x16x32_bf16 a[84:87], a[244:247], v[216:219], a[84:87]
v_mfma_f32_16x16x32_bf16 a[52:55], a[244:247], v[212:215], a[52:55]
v_mfma_f32_16x16x32_bf16 a[20:23], a[244:247], v[208:211], a[20:23]
v_mfma_f32_16x16x32_bf16 a[24:27], a[248:251], v[208:211], a[24:27]
v_mfma_f32_16x16x32_bf16 a[56:59], a[248:251], v[212:215], a[56:59]
v_mfma_f32_16x16x32_bf16 a[88:91], a[248:251], v[216:219], a[88:91]
v_mfma_f32_16x16x32_bf16 a[120:123], a[248:251], v[220:223], a[120:123]
v_mfma_f32_16x16x32_bf16 a[124:127], a[252:255], v[220:223], a[124:127]
v_mfma_f32_16x16x32_bf16 a[92:95], a[252:255], v[216:219], a[92:95]
v_mfma_f32_16x16x32_bf16 a[60:63], a[252:255], v[212:215], a[60:63]
v_mfma_f32_16x16x32_bf16 a[28:31], a[252:255], v[208:211], a[28:31]
v_mfma_f32_16x16x32_bf16 v[224:227], v[120:123], v[208:211], v[224:227]
v_mfma_f32_16x16x32_bf16 v[228:231], v[120:123], v[212:215], v[228:231]
v_mfma_f32_16x16x32_bf16 v[232:235], v[120:123], v[216:219], v[232:235]
v_mfma_f32_16x16x32_bf16 v[236:239], v[120:123], v[220:223], v[236:239]
s_waitcnt lgkmcnt(8)
s_cmp_eq_u32 s58, 0
s_cbranch_scc1 Lta16
s_cmp_eq_u32 s58, 1
s_cbranch_scc1 Lnt17
v_mfma_f32_16x16x32_bf16 v[128:131], a[128:131], v[16:19], v[80:83]
s_add_u32 s82, s82, 0x8000
ds_read_b128 a[160:163], v2 offset:24576
v_mfma_f32_16x16x32_bf16 v[144:147], a[144:147], v[16:19], v[80:83]
s_and_b32 s82, s82, 0x1ffff
v_exp_f32 v160, v160
s_branch Ljoin18
Lta16:
v_mfma_f32_16x16x32_bf16 v[128:131], a[128:131], v[16:19], v[96:99]
s_add_u32 s82, s82, 0x8000
ds_read_b128 a[160:163], v2 offset:24576
v_mfma_f32_16x16x32_bf16 v[144:147], a[144:147], v[16:19], v[112:115]
s_and_b32 s82, s82, 0x1ffff
v_exp_f32 v160, v160
s_branch Ljoin18
Lnt17:
v_mfma_f32_16x16x32_bf16 v[128:131], a[128:131], v[16:19], v[80:83]
s_add_u32 s82, s82, 0x8000
ds_read_b128 a[160:163], v2 offset:24576
v_mfma_f32_16x16x32_bf16 v[144:147], a[144:147], v[16:19], v[96:99]
s_and_b32 s82, s82, 0x1ffff
v_exp_f32 v160, v160
Ljoin18:
v_mfma_f32_16x16x32_bf16 v[128:131], a[132:135], v[20:23], v[128:131]
s_add_u32 m0, s74, 0
v_exp_f32 v161, v161
v_mfma_f32_16x16x32_bf16 v[128:131], a[136:139], v[24:27], v[128:131]
s_add_u32 s72, s81, 0
ds_read_b128 a[164:167], v2 offset:25600
v_cvt_pk_bf16_f32 v208, v160, v161
v_mfma_f32_16x16x32_bf16 v[128:131], a[140:143], v[28:31], v[128:131]
v_exp_f32 v162, v162
v_mfma_f32_16x16x32_bf16 v[132:135], a[140:143], v[44:47], v[84:87]
v_exp_f32 v163, v163
v_mfma_f32_16x16x32_bf16 v[132:135], a[136:139], v[40:43], v[132:135]
ds_read_b128 a[168:171], v2 offset:26624
v_cvt_pk_bf16_f32 v209, v162, v163
v_mfma_f32_16x16x32_bf16 v[132:135], a[132:135], v[36:39], v[132:135]
v_exp_f32 v176, v176
v_mfma_f32_16x16x32_bf16 v[132:135], a[128:131], v[32:35], v[132:135]
buffer_load_dwordx4 v1, s[44:47], s72 offen sc1 lds
v_mfma_f32_16x16x32_bf16 v[136:139], a[128:131], v[48:51], v[88:91]
v_exp_f32 v177, v177
v_mfma_f32_16x16x32_bf16 v[136:139], a[132:135], v[52:55], v[136:139]
ds_read_b128 a[172:175], v2 offset:27648
v_cvt_pk_bf16_f32 v210, v176, v177
v_mfma_f32_16x16x32_bf16 v[136:139], a[136:139], v[56:59], v[136:139]
v_exp_f32 v178, v178
v_mfma_f32_16x16x32_bf16 v[136:139], a[140:143], v[60:63], v[136:139]
v_exp_f32 v179, v179
v_mfma_f32_16x16x32_bf16 v[140:143], a[140:143], v[76:79], v[92:95]
ds_read_b128 a[176:179], v2 offset:28672
v_cvt_pk_bf16_f32 v211, v178, v179
v_mfma_f32_16x16x32_bf16 v[140:143], a[136:139], v[72:75], v[140:143]
v_exp_f32 v164, v164
v_mfma_f32_16x16x32_bf16 v[140:143], a[132:135], v[68:71], v[140:143]
v_exp_f32 v165, v165
v_mfma_f32_16x16x32_bf16 v[140:143], a[128:131], v[64:67], v[140:143]
ds_read_b128 a[180:183], v2 offset:29696
v_cvt_pk_bf16_f32 v212, v164, v165
v_mfma_f32_16x16x32_bf16 v[156:159], a[144:147], v[64:67], v[92:95]
v_exp_f32 v166, v166
v_mfma_f32_16x16x32_bf16 v[156:159], a[148:151], v[68:71], v[156:159]
v_exp_f32 v167, v167
v_mfma_f32_16x16x32_bf16 v[156:159], a[152:155], v[72:75], v[156:159]
ds_read_b128 a[184:187], v2 offset:30720
v_cvt_pk_bf16_f32 v213, v166, v167
v_mfma_f32_16x16x32_bf16 v[156:159], a[156:159], v[76:79], v[156:159]
v_exp_f32 v180, v180
v_mfma_f32_16x16x32_bf16 v[152:155], a[156:159], v[60:63], v[88:91]
buffer_load_dwordx4 v1, s[44:47], s72 offen offset:1024 sc1 lds
v_mfma_f32_16x16x32_bf16 v[152:155], a[152:155], v[56:59], v[152:155]
v_exp_f32 v181, v181
v_mfma_f32_16x16x32_bf16 v[152:155], a[148:151], v[52:55], v[152:155]
ds_read_b128 a[188:191], v2 offset:31744
v_cvt_pk_bf16_f32 v214, v180, v181
v_mfma_f32_16x16x32_bf16 v[152:155], a[144:147], v[48:51], v[152:155]
v_exp_f32 v182, v182
v_mfma_f32_16x16x32_bf16 v[148:151], a[144:147], v[32:35], v[84:87]
v_exp_f32 v183, v183
v_mfma_f32_16x16x32_bf16 v[148:151], a[148:151], v[36:39], v[148:151]
ds_read_b128 a[224:227], v2 offset:8192
v_cvt_pk_bf16_f32 v215, v182, v183
v_mfma_f32_16x16x32_bf16 v[148:151], a[152:155], v[40:43], v[148:151]
v_exp_f32 v168, v168
v_mfma_f32_16x16x32_bf16 v[148:151], a[156:159], v[44:47], v[148:151]
v_exp_f32 v169, v169
v_mfma_f32_16x16x32_bf16 v[144:147], a[156:159], v[28:31], v[144:147]
ds_read_b128 a[228:231], v2 offset:9216
v_cvt_pk_bf16_f32 v216, v168, v169
v_mfma_f32_16x16x32_bf16 v[144:147], a[152:155], v[24:27], v[144:147]
v_exp_f32 v170, v170
v_mfma_f32_16x16x32_bf16 v[144:147], a[148:151], v[20:23], v[144:147]
s_waitcnt lgkmcnt(10)
v_exp_f32 v171, v171
v_mfma_f32_16x16x32_bf16 a[0:3], a[192:195], v[192:195], a[0:3]
ds_read_b128 a[232:235], v2 offset:10240
v_cvt_pk_bf16_f32 v217, v170, v171
v_mfma_f32_16x16x32_bf16 a[32:35], a[192:195], v[196:199], a[32:35]
v_exp_f32 v184, v184
v_mfma_f32_16x16x32_bf16 a[64:67], a[192:195], v[200:203], a[64:67]
buffer_load_dwordx4 v1, s[44:47], s72 offen offset:2048 sc1 lds
v_mfma_f32_16x16x32_bf16 a[96:99], a[192:195], v[204:207], a[96:99]
v_exp_f32 v185, v185
v_mfma_f32_16x16x32_bf16 a[100:103], a[196:199], v[204:207], a[100:103]
ds_read_b128 a[236:239], v2 offset:11264
v_cvt_pk_bf16_f32 v218, v184, v185
v_mfma_f32_16x16x32_bf16 a[68:71], a[196:199], v[200:203], a[68:71]
v_exp_f32 v186, v186
v_mfma_f32_16x16x32_bf16 a[36:39], a[196:199], v[196:199], a[36:39]
v_exp_f32 v187, v187
v_mfma_f32_16x16x32_bf16 a[4:7], a[196:199], v[192:195], a[4:7]
ds_read_b128 a[240:243], v2 offset:12288
v_cvt_pk_bf16_f32 v219, v186, v187
v_mfma_f32_16x16x32_bf16 a[8:11], a[200:203], v[192:195], a[8:11]
v_exp_f32 v172, v172
v_mfma_f32_16x16x32_bf16 a[40:43], a[200:203], v[196:199], a[40:43]
v_exp_f32 v173, v173
v_mfma_f32_16x16x32_bf16 a[72:75], a[200:203], v[200:203], a[72:75]
ds_read_b128 a[244:247], v2 offset:13312
v_cvt_pk_bf16_f32 v220, v172, v173
v_mfma_f32_16x16x32_bf16 a[104:107], a[200:203], v[204:207], a[104:107]
v_exp_f32 v174, v174
v_mfma_f32_16x16x32_bf16 a[108:111], a[204:207], v[204:207], a[108:111]
v_exp_f32 v175, v175
v_mfma_f32_16x16x32_bf16 a[76:79], a[204:207], v[200:203], a[76:79]
ds_read_b128 a[248:251], v2 offset:14336
v_cvt_pk_bf16_f32 v221, v174, v175
v_mfma_f32_16x16x32_bf16 a[44:47], a[204:207], v[196:199], a[44:47]
v_exp_f32 v188, v188
v_mfma_f32_16x16x32_bf16 a[12:15], a[204:207], v[192:195], a[12:15]
buffer_load_dwordx4 v1, s[44:47], s72 offen offset:3072 sc1 lds
v_mfma_f32_16x16x32_bf16 a[16:19], a[208:211], v[192:195], a[16:19]
v_exp_f32 v189, v189
v_mfma_f32_16x16x32_bf16 a[48:51], a[208:211], v[196:199], a[48:51]
ds_read_b128 a[252:255], v2 offset:15360
v_cvt_pk_bf16_f32 v222, v188, v189
v_mfma_f32_16x16x32_bf16 a[80:83], a[208:211], v[200:203], a[80:83]
v_exp_f32 v190, v190
v_mfma_f32_16x16x32_bf16 a[112:115], a[208:211], v[204:207], a[112:115]
v_exp_f32 v191, v191
v_mfma_f32_16x16x32_bf16 a[116:119], a[212:215], v[204:207], a[116:119]
v_cvt_pk_bf16_f32 v223, v190, v191
v_add_u32 v2, s82, v1
v_mfma_f32_16x16x32_bf16 a[84:87], a[212:215], v[200:203], a[84:87]
v_mfma_f32_16x16x32_bf16 a[52:55], a[212:215], v[196:199], a[52:55]
v_mfma_f32_16x16x32_bf16 a[20:23], a[212:215], v[192:195], a[20:23]
v_mfma_f32_16x16x32_bf16 a[24:27], a[216:219], v[192:195], a[24:27]
v_mfma_f32_16x16x32_bf16 a[56:59], a[216:219], v[196:199], a[56:59]
v_mfma_f32_16x16x32_bf16 a[88:91], a[216:219], v[200:203], a[88:91]
v_mfma_f32_16x16x32_bf16 a[120:123], a[216:219], v[204:207], a[120:123]
v_mfma_f32_16x16x32_bf16 a[124:127], a[220:223], v[204:207], a[124:127]
v_mfma_f32_16x16x32_bf16 a[92:95], a[220:223], v[200:203], a[92:95]
v_mfma_f32_16x16x32_bf16 a[60:63], a[220:223], v[196:199], a[60:63]
v_mfma_f32_16x16x32_bf16 a[28:31], a[220:223], v[192:195], a[28:31]
v_mfma_f32_16x16x32_bf16 v[224:227], v[120:123], v[192:195], v[224:227]
v_mfma_f32_16x16x32_bf16 v[228:231], v[120:123], v[196:199], v[228:231]
v_mfma_f32_16x16x32_bf16 v[232:235], v[120:123], v[200:203], v[232:235]
s_waitcnt vmcnt(8) lgkmcnt(8)
v_mfma_f32_16x16x32_bf16 v[236:239], v[120:123], v[204:207], v[236:239]
s_barrier
s_cmp_eq_u32 s58, 2
s_cbranch_scc1 Lta19
s_cmp_eq_u32 s58, 3
s_cbranch_scc1 Lnt20
v_mfma_f32_16x16x32_bf16 v[160:163], a[160:163], v[16:19], v[112:115]
s_xor_b32 s74, s82, 0x10000
v_exp_f32 v128, v128
v_mfma_f32_16x16x32_bf16 v[176:179], a[176:179], v[16:19], v[112:115]
s_add_u32 s74, s74, s64
ds_read_b128 a[128:131], v2 offset:16384
s_branch Ljoin21
Lta19:
v_mfma_f32_16x16x32_bf16 v[160:163], a[160:163], v[16:19], v[96:99]
s_xor_b32 s74, s82, 0x10000
v_exp_f32 v128, v128
v_mfma_f32_16x16x32_bf16 v[176:179], a[176:179], v[16:19], v[112:115]
s_add_u32 s74, s74, s64
ds_read_b128 a[128:131], v2 offset:16384
s_branch Ljoin21
Lnt20:
v_mfma_f32_16x16x32_bf16 v[160:163], a[160:163], v[16:19], v[80:83]
s_xor_b32 s74, s82, 0x10000
v_exp_f32 v128, v128
v_mfma_f32_16x16x32_bf16 v[176:179], a[176:179], v[16:19], v[96:99]
s_add_u32 s74, s74, s64
ds_read_b128 a[128:131], v2 offset:16384
Ljoin21:
v_mfma_f32_16x16x32_bf16 v[160:163], a[164:167], v[20:23], v[160:163]
s_add_u32 s81, s81, 0x8000
v_exp_f32 v129, v129
v_mfma_f32_16x16x32_bf16 v[160:163], a[168:171], v[24:27], v[160:163]
s_add_u32 m0, s74, 16384
v_exp_f32 v130, v130
v_mfma_f32_16x16x32_bf16 v[160:163], a[172:175], v[28:31], v[160:163]
s_add_u32 s72, s81, 16384
ds_read_b128 a[132:135], v2 offset:17408
v_cvt_pk_bf16_f32 v192, v128, v129
v_mfma_f32_16x16x32_bf16 v[164:167], a[172:175], v[44:47], v[84:87]
v_exp_f32 v131, v131
v_mfma_f32_16x16x32_bf16 v[164:167], a[168:171], v[40:43], v[164:167]
v_exp_f32 v144, v144
v_mfma_f32_16x16x32_bf16 v[164:167], a[164:167], v[36:39], v[164:167]
ds_read_b128 a[136:139], v2 offset:18432
v_cvt_pk_bf16_f32 v193, v130, v131
v_mfma_f32_16x16x32_bf16 v[164:167], a[160:163], v[32:35], v[164:167]
buffer_load_dwordx4 v1, s[44:47], s72 offen sc1 lds
v_mfma_f32_16x16x32_bf16 v[168:171], a[160:163], v[48:51], v[88:91]
v_exp_f32 v145, v145
v_mfma_f32_16x16x32_bf16 v[168:171], a[164:167], v[52:55], v[168:171]
v_exp_f32 v146, v146
v_mfma_f32_16x16x32_bf16 v[168:171], a[168:171], v[56:59], v[168:171]
ds_read_b128 a[140:143], v2 offset:19456
v_cvt_pk_bf16_f32 v194, v144, v145
v_mfma_f32_16x16x32_bf16 v[168:171], a[172:175], v[60:63], v[168:171]
v_exp_f32 v147, v147
v_mfma_f32_16x16x32_bf16 v[172:175], a[172:175], v[76:79], v[92:95]
v_exp_f32 v132, v132
v_mfma_f32_16x16x32_bf16 v[172:175], a[168:171], v[72:75], v[172:175]
ds_read_b128 a[144:147], v2 offset:20480
v_cvt_pk_bf16_f32 v195, v146, v147
v_mfma_f32_16x16x32_bf16 v[172:175], a[164:167], v[68:71], v[172:175]
v_exp_f32 v133, v133
v_mfma_f32_16x16x32_bf16 v[172:175], a[160:163], v[64:67], v[172:175]
v_exp_f32 v134, v134
v_mfma_f32_16x16x32_bf16 v[188:191], a[176:179], v[64:67], v[92:95]
ds_read_b128 a[148:151], v2 offset:21504
v_cvt_pk_bf16_f32 v196, v132, v133
v_mfma_f32_16x16x32_bf16 v[188:191], a[180:183], v[68:71], v[188:191]
v_exp_f32 v135, v135
v_mfma_f32_16x16x32_bf16 v[188:191], a[184:187], v[72:75], v[188:191]
v_exp_f32 v148, v148
v_mfma_f32_16x16x32_bf16 v[188:191], a[188:191], v[76:79], v[188:191]
ds_read_b128 a[152:155], v2 offset:22528
v_cvt_pk_bf16_f32 v197, v134, v135
v_mfma_f32_16x16x32_bf16 v[184:187], a[188:191], v[60:63], v[88:91]
buffer_load_dwordx4 v1, s[44:47], s72 offen offset:1024 sc1 lds
v_mfma_f32_16x16x32_bf16 v[184:187], a[184:187], v[56:59], v[184:187]
v_exp_f32 v149, v149
v_mfma_f32_16x16x32_bf16 v[184:187], a[180:183], v[52:55], v[184:187]
v_exp_f32 v150, v150
v_mfma_f32_16x16x32_bf16 v[184:187], a[176:179], v[48:51], v[184:187]
ds_read_b128 a[156:159], v2 offset:23552
v_cvt_pk_bf16_f32 v198, v148, v149
v_mfma_f32_16x16x32_bf16 v[180:183], a[176:179], v[32:35], v[84:87]
v_exp_f32 v151, v151
v_mfma_f32_16x16x32_bf16 v[180:183], a[180:183], v[36:39], v[180:183]
v_exp_f32 v136, v136
v_mfma_f32_16x16x32_bf16 v[180:183], a[184:187], v[40:43], v[180:183]
ds_read_b128 a[192:195], v2 offset:0
v_cvt_pk_bf16_f32 v199, v150, v151
v_mfma_f32_16x16x32_bf16 v[180:183], a[188:191], v[44:47], v[180:183]
v_exp_f32 v137, v137
v_mfma_f32_16x16x32_bf16 v[176:179], a[188:191], v[28:31], v[176:179]
v_exp_f32 v138, v138
v_mfma_f32_16x16x32_bf16 v[176:179], a[184:187], v[24:27], v[176:179]
ds_read_b128 a[196:199], v2 offset:1024
v_cvt_pk_bf16_f32 v200, v136, v137
v_mfma_f32_16x16x32_bf16 v[176:179], a[180:183], v[20:23], v[176:179]
s_waitcnt lgkmcnt(10)
v_exp_f32 v139, v139
v_mfma_f32_16x16x32_bf16 a[0:3], a[224:227], v[208:211], a[0:3]
v_exp_f32 v152, v152
v_mfma_f32_16x16x32_bf16 a[32:35], a[224:227], v[212:215], a[32:35]
ds_read_b128 a[200:203], v2 offset:2048
v_cvt_pk_bf16_f32 v201, v138, v139
v_mfma_f32_16x16x32_bf16 a[64:67], a[224:227], v[216:219], a[64:67]
buffer_load_dwordx4 v1, s[44:47], s72 offen offset:2048 sc1 lds
v_mfma_f32_16x16x32_bf16 a[96:99], a[224:227], v[220:223], a[96:99]
v_exp_f32 v153, v153
v_mfma_f32_16x16x32_bf16 a[100:103], a[228:231], v[220:223], a[100:103]
v_exp_f32 v154, v154
v_mfma_f32_16x16x32_bf16 a[68:71], a[228:231], v[216:219], a[68:71]
ds_read_b128 a[204:207], v2 offset:3072
v_cvt_pk_bf16_f32 v202, v152, v153
v_mfma_f32_16x16x32_bf16 a[36:39], a[228:231], v[212:215], a[36:39]
v_exp_f32 v155, v155
v_mfma_f32_16x16x32_bf16 a[4:7], a[228:231], v[208:211], a[4:7]
v_exp_f32 v140, v140
v_mfma_f32_16x16x32_bf16 a[8:11], a[232:235], v[208:211], a[8:11]
ds_read_b128 a[208:211], v2 offset:4096
v_cvt_pk_bf16_f32 v203, v154, v155
v_mfma_f32_16x16x32_bf16 a[40:43], a[232:235], v[212:215], a[40:43]
v_exp_f32 v141, v141
v_mfma_f32_16x16x32_bf16 a[72:75], a[232:235], v[216:219], a[72:75]
v_exp_f32 v142, v142
v_mfma_f32_16x16x32_bf16 a[104:107], a[232:235], v[220:223], a[104:107]
ds_read_b128 a[212:215], v2 offset:5120
v_cvt_pk_bf16_f32 v204, v140, v141
v_mfma_f32_16x16x32_bf16 a[108:111], a[236:239], v[220:223], a[108:111]
v_exp_f32 v143, v143
v_mfma_f32_16x16x32_bf16 a[76:79], a[236:239], v[216:219], a[76:79]
v_exp_f32 v156, v156
v_mfma_f32_16x16x32_bf16 a[44:47], a[236:239], v[212:215], a[44:47]
ds_read_b128 a[216:219], v2 offset:6144
v_cvt_pk_bf16_f32 v205, v142, v143
v_mfma_f32_16x16x32_bf16 a[12:15], a[236:239], v[208:211], a[12:15]
buffer_load_dwordx4 v1, s[44:47], s72 offen offset:3072 sc1 lds
v_mfma_f32_16x16x32_bf16 a[16:19], a[240:243], v[208:211], a[16:19]
v_exp_f32 v157, v157
v_mfma_f32_16x16x32_bf16 a[48:51], a[240:243], v[212:215], a[48:51]
v_exp_f32 v158, v158
v_mfma_f32_16x16x32_bf16 a[80:83], a[240:243], v[216:219], a[80:83]
ds_read_b128 a[220:223], v2 offset:7168
v_cvt_pk_bf16_f32 v206, v156, v157
v_mfma_f32_16x16x32_bf16 a[112:115], a[240:243], v[220:223], a[112:115]
v_exp_f32 v159, v159
v_mfma_f32_16x16x32_bf16 a[116:119], a[244:247], v[220:223], a[116:119]
v_cvt_pk_bf16_f32 v207, v158, v159
v_mfma_f32_16x16x32_bf16 a[84:87], a[244:247], v[216:219], a[84:87]
v_mfma_f32_16x16x32_bf16 a[52:55], a[244:247], v[212:215], a[52:55]
v_mfma_f32_16x16x32_bf16 a[20:23], a[244:247], v[208:211], a[20:23]
v_mfma_f32_16x16x32_bf16 a[24:27], a[248:251], v[208:211], a[24:27]
v_mfma_f32_16x16x32_bf16 a[56:59], a[248:251], v[212:215], a[56:59]
v_mfma_f32_16x16x32_bf16 a[88:91], a[248:251], v[216:219], a[88:91]
v_mfma_f32_16x16x32_bf16 a[120:123], a[248:251], v[220:223], a[120:123]
v_mfma_f32_16x16x32_bf16 a[124:127], a[252:255], v[220:223], a[124:127]
v_mfma_f32_16x16x32_bf16 a[92:95], a[252:255], v[216:219], a[92:95]
v_mfma_f32_16x16x32_bf16 a[60:63], a[252:255], v[212:215], a[60:63]
v_mfma_f32_16x16x32_bf16 a[28:31], a[252:255], v[208:211], a[28:31]
v_mfma_f32_16x16x32_bf16 v[224:227], v[120:123], v[208:211], v[224:227]
v_mfma_f32_16x16x32_bf16 v[228:231], v[120:123], v[212:215], v[228:231]
v_mfma_f32_16x16x32_bf16 v[232:235], v[120:123], v[216:219], v[232:235]
v_mfma_f32_16x16x32_bf16 v[236:239], v[120:123], v[220:223], v[236:239]
s_waitcnt lgkmcnt(8)
s_cmp_eq_u32 s58, 0
s_cbranch_scc1 Lta22
s_cmp_eq_u32 s58, 1
s_cbranch_scc1 Lnt23
v_mfma_f32_16x16x32_bf16 v[132:135], a[128:131], v[32:35], v[84:87]
s_add_u32 s82, s82, 0x8000
ds_read_b128 a[160:163], v2 offset:24576
v_mfma_f32_16x16x32_bf16 v[148:151], a[144:147], v[32:35], v[84:87]
s_and_b32 s82, s82, 0x1ffff
v_exp_f32 v160, v160
s_branch Ljoin24
Lta22:
v_mfma_f32_16x16x32_bf16 v[132:135], a[128:131], v[32:35], v[100:103]
s_add_u32 s82, s82, 0x8000
ds_read_b128 a[160:163], v2 offset:24576
v_mfma_f32_16x16x32_bf16 v[148:151], a[144:147], v[32:35], v[112:115]
s_and_b32 s82, s82, 0x1ffff
v_exp_f32 v160, v160
s_branch Ljoin24
Lnt23:
v_mfma_f32_16x16x32_bf16 v[132:135], a[128:131], v[32:35], v[84:87]
s_add_u32 s82, s82, 0x8000
ds_read_b128 a[160:163], v2 offset:24576
v_mfma_f32_16x16x32_bf16 v[148:151], a[144:147], v[32:35], v[100:103]
s_and_b32 s82, s82, 0x1ffff
v_exp_f32 v160, v160
Ljoin24:
v_mfma_f32_16x16x32_bf16 v[132:135], a[132:135], v[36:39], v[132:135]
s_add_u32 m0, s74, 0
v_exp_f32 v161, v161
v_mfma_f32_16x16x32_bf16 v[132:135], a[136:139], v[40:43], v[132:135]
s_add_u32 s72, s81, 0
ds_read_b128 a[164:167], v2 offset:25600
v_cvt_pk_bf16_f32 v208, v160, v161
v_mfma_f32_16x16x32_bf16 v[132:135], a[140:143], v[44:47], v[132:135]
v_exp_f32 v162, v162
v_mfma_f32_16x16x32_bf16 v[136:139], a[140:143], v[60:63], v[88:91]
v_exp_f32 v163, v163
v_mfma_f32_16x16x32_bf16 v[136:139], a[136:139], v[56:59], v[136:139]
ds_read_b128 a[168:171], v2 offset:26624
v_cvt_pk_bf16_f32 v209, v162, v163
v_mfma_f32_16x16x32_bf16 v[136:139], a[132:135], v[52:55], v[136:139]
v_exp_f32 v176, v176
v_mfma_f32_16x16x32_bf16 v[136:139], a[128:131], v[48:51], v[136:139]
buffer_load_dwordx4 v1, s[44:47], s72 offen sc1 lds
v_mfma_f32_16x16x32_bf16 v[140:143], a[128:131], v[64:67], v[92:95]
v_exp_f32 v177, v177
v_mfma_f32_16x16x32_bf16 v[140:143], a[132:135], v[68:71], v[140:143]
ds_read_b128 a[172:175], v2 offset:27648
v_cvt_pk_bf16_f32 v210, v176, v177
v_mfma_f32_16x16x32_bf16 v[140:143], a[136:139], v[72:75], v[140:143]
v_exp_f32 v178, v178
v_mfma_f32_16x16x32_bf16 v[140:143], a[140:143], v[76:79], v[140:143]
v_exp_f32 v179, v179
v_mfma_f32_16x16x32_bf16 v[156:159], a[156:159], v[76:79], v[92:95]
ds_read_b128 a[176:179], v2 offset:28672
v_cvt_pk_bf16_f32 v211, v178, v179
v_mfma_f32_16x16x32_bf16 v[156:159], a[152:155], v[72:75], v[156:159]
v_exp_f32 v164, v164
v_mfma_f32_16x16x32_bf16 v[156:159], a[148:151], v[68:71], v[156:159]
v_exp_f32 v165, v165
v_mfma_f32_16x16x32_bf16 v[156:159], a[144:147], v[64:67], v[156:159]
ds_read_b128 a[180:183], v2 offset:29696
v_cvt_pk_bf16_f32 v212, v164, v165
v_mfma_f32_16x16x32_bf16 v[152:155], a[144:147], v[48:51], v[88:91]
v_exp_f32 v166, v166
v_mfma_f32_16x16x32_bf16 v[152:155], a[148:151], v[52:55], v[152:155]
v_exp_f32 v167, v167
v_mfma_f32_16x16x32_bf16 v[152:155], a[152:155], v[56:59], v[152:155]
ds_read_b128 a[184:187], v2 offset:30720
v_cvt_pk_bf16_f32 v213, v166, v167
v_mfma_f32_16x16x32_bf16 v[152:155], a[156:159], v[60:63], v[152:155]
v_exp_f32 v180, v180
v_mfma_f32_16x16x32_bf16 v[148:151], a[156:159], v[44:47], v[148:151]
buffer_load_dwordx4 v1, s[44:47], s72 offen offset:1024 sc1 lds
v_mfma_f32_16x16x32_bf16 v[148:151], a[152:155], v[40:43], v[148:151]
v_exp_f32 v181, v181
v_mfma_f32_16x16x32_bf16 v[148:151], a[148:151], v[36:39], v[148:151]
s_waitcnt lgkmcnt(7)
ds_read_b128 a[188:191], v2 offset:31744
v_cvt_pk_bf16_f32 v214, v180, v181
v_mfma_f32_16x16x32_bf16 a[0:3], a[192:195], v[192:195], a[0:3]
v_exp_f32 v182, v182
v_mfma_f32_16x16x32_bf16 a[32:35], a[192:195], v[196:199], a[32:35]
v_exp_f32 v183, v183
v_mfma_f32_16x16x32_bf16 a[64:67], a[192:195], v[200:203], a[64:67]
ds_read_b128 a[224:227], v2 offset:8192
v_cvt_pk_bf16_f32 v215, v182, v183
v_mfma_f32_16x16x32_bf16 a[96:99], a[192:195], v[204:207], a[96:99]
v_exp_f32 v168, v168
v_mfma_f32_16x16x32_bf16 a[100:103], a[196:199], v[204:207], a[100:103]
v_exp_f32 v169, v169
v_mfma_f32_16x16x32_bf16 a[68:71], a[196:199], v[200:203], a[68:71]
ds_read_b128 a[228:231], v2 offset:9216
v_cvt_pk_bf16_f32 v216, v168, v169
v_mfma_f32_16x16x32_bf16 a[36:39], a[196:199], v[196:199], a[36:39]
v_exp_f32 v170, v170
v_mfma_f32_16x16x32_bf16 a[4:7], a[196:199], v[192:195], a[4:7]
v_exp_f32 v171, v171
v_mfma_f32_16x16x32_bf16 a[8:11], a[200:203], v[192:195], a[8:11]
ds_read_b128 a[232:235], v2 offset:10240
v_cvt_pk_bf16_f32 v217, v170, v171
v_mfma_f32_16x16x32_bf16 a[40:43], a[200:203], v[196:199], a[40:43]
v_exp_f32 v184, v184
v_mfma_f32_16x16x32_bf16 a[72:75], a[200:203], v[200:203], a[72:75]
buffer_load_dwordx4 v1, s[44:47], s72 offen offset:2048 sc1 lds
v_mfma_f32_16x16x32_bf16 a[104:107], a[200:203], v[204:207], a[104:107]
v_exp_f32 v185, v185
v_mfma_f32_16x16x32_bf16 a[108:111], a[204:207], v[204:207], a[108:111]
ds_read_b128 a[236:239], v2 offset:11264
v_cvt_pk_bf16_f32 v218, v184, v185
v_mfma_f32_16x16x32_bf16 a[76:79], a[204:207], v[200:203], a[76:79]
v_exp_f32 v186, v186
v_mfma_f32_16x16x32_bf16 a[44:47], a[204:207], v[196:199], a[44:47]
v_exp_f32 v187, v187
v_mfma_f32_16x16x32_bf16 a[12:15], a[204:207], v[192:195], a[12:15]
ds_read_b128 a[240:243], v2 offset:12288
v_cvt_pk_bf16_f32 v219, v186, v187
v_mfma_f32_16x16x32_bf16 a[16:19], a[208:211], v[192:195], a[16:19]
v_exp_f32 v172, v172
v_mfma_f32_16x16x32_bf16 a[48:51], a[208:211], v[196:199], a[48:51]
v_exp_f32 v173, v173
v_mfma_f32_16x16x32_bf16 a[80:83], a[208:211], v[200:203], a[80:83]
ds_read_b128 a[244:247], v2 offset:13312
v_cvt_pk_bf16_f32 v220, v172, v173
v_mfma_f32_16x16x32_bf16 a[112:115], a[208:211], v[204:207], a[112:115]
v_exp_f32 v174, v174
v_mfma_f32_16x16x32_bf16 a[116:119], a[212:215], v[204:207], a[116:119]
v_exp_f32 v175, v175
v_mfma_f32_16x16x32_bf16 a[84:87], a[212:215], v[200:203], a[84:87]
ds_read_b128 a[248:251], v2 offset:14336
v_cvt_pk_bf16_f32 v221, v174, v175
v_mfma_f32_16x16x32_bf16 a[52:55], a[212:215], v[196:199], a[52:55]
v_exp_f32 v188, v188
v_mfma_f32_16x16x32_bf16 a[20:23], a[212:215], v[192:195], a[20:23]
buffer_load_dwordx4 v1, s[44:47], s72 offen offset:3072 sc1 lds
v_mfma_f32_16x16x32_bf16 a[24:27], a[216:219], v[192:195], a[24:27]
v_exp_f32 v189, v189
v_mfma_f32_16x16x32_bf16 a[56:59], a[216:219], v[196:199], a[56:59]
ds_read_b128 a[252:255], v2 offset:15360
v_cvt_pk_bf16_f32 v222, v188, v189
v_mfma_f32_16x16x32_bf16 a[88:91], a[216:219], v[200:203], a[88:91]
v_exp_f32 v190, v190
v_mfma_f32_16x16x32_bf16 a[120:123], a[216:219], v[204:207], a[120:123]
v_exp_f32 v191, v191
v_mfma_f32_16x16x32_bf16 a[124:127], a[220:223], v[204:207], a[124:127]
v_cvt_pk_bf16_f32 v223, v190, v191
v_add_u32 v2, s82, v1
v_mfma_f32_16x16x32_bf16 a[92:95], a[220:223], v[200:203], a[92:95]
v_mfma_f32_16x16x32_bf16 a[60:63], a[220:223], v[196:199], a[60:63]
v_mfma_f32_16x16x32_bf16 a[28:31], a[220:223], v[192:195], a[28:31]
v_mfma_f32_16x16x32_bf16 v[224:227], v[120:123], v[192:195], v[224:227]
v_mfma_f32_16x16x32_bf16 v[228:231], v[120:123], v[196:199], v[228:231]
v_mfma_f32_16x16x32_bf16 v[232:235], v[120:123], v[200:203], v[232:235]
s_waitcnt vmcnt(8) lgkmcnt(8)
v_mfma_f32_16x16x32_bf16 v[236:239], v[120:123], v[204:207], v[236:239]
s_barrier
s_cmp_eq_u32 s60, 7
s_cbranch_scc1 LLT3x
LLT3:
Lstub3:
s_cbranch_execz Lstub7
s_cmp_eq_u32 s58, 2
s_cbranch_scc1 Lta25
s_cmp_eq_u32 s58, 3
s_cbranch_scc1 Lnt26
v_mfma_f32_16x16x32_bf16 v[164:167], a[160:163], v[32:35], v[112:115]
s_xor_b32 s74, s82, 0x10000
v_exp_f32 v132, v132
v_mfma_f32_16x16x32_bf16 v[180:183], a[176:179], v[32:35], v[112:115]
s_add_u32 s74, s74, s64
ds_read_b128 a[128:131], v2 offset:16384
s_branch Ljoin27
Lta25:
v_mfma_f32_16x16x32_bf16 v[164:167], a[160:163], v[32:35], v[100:103]
s_xor_b32 s74, s82, 0x10000
v_exp_f32 v132, v132
v_mfma_f32_16x16x32_bf16 v[180:183], a[176:179], v[32:35], v[112:115]
s_add_u32 s74, s74, s64
ds_read_b128 a[128:131], v2 offset:16384
s_branch Ljoin27
Lnt26:
v_mfma_f32_16x16x32_bf16 v[164:167], a[160:163], v[32:35], v[84:87]
s_xor_b32 s74, s82, 0x10000
v_exp_f32 v132, v132
v_mfma_f32_16x16x32_bf16 v[180:183], a[176:179], v[32:35], v[100:103]
s_add_u32 s74, s74, s64
ds_read_b128 a[128:131], v2 offset:16384
Ljoin27:
v_mfma_f32_16x16x32_bf16 v[164:167], a[164:167], v[36:39], v[164:167]
s_add_u32 s81, s81, 0x8000
v_exp_f32 v133, v133
v_mfma_f32_16x16x32_bf16 v[164:167], a[168:171], v[40:43], v[164:167]
s_add_u32 m0, s74, 16384
ds_read_b128 a[132:135], v2 offset:17408
v_cvt_pk_bf16_f32 v196, v132, v133
v_mfma_f32_16x16x32_bf16 v[164:167], a[172:175], v[44:47], v[164:167]
s_add_u32 s72, s81, 16384
buffer_load_dwordx4 v1, s[44:47], s72 offen sc1 lds
v_mfma_f32_16x16x32_bf16 v[168:171], a[172:175], v[60:63], v[88:91]
s_add_u32 s69, s93, 0x3e00000
v_exp_f32 v134, v134
v_mfma_f32_16x16x32_bf16 v[168:171], a[168:171], v[56:59], v[168:171]
v_exp_f32 v135, v135
v_mfma_f32_16x16x32_bf16 v[168:171], a[164:167], v[52:55], v[168:171]
ds_read_b128 a[136:139], v2 offset:18432
v_cvt_pk_bf16_f32 v197, v134, v135
v_mfma_f32_16x16x32_bf16 v[168:171], a[160:163], v[48:51], v[168:171]
v_exp_f32 v148, v148
v_mfma_f32_16x16x32_bf16 v[172:175], a[160:163], v[64:67], v[92:95]
ds_read_b128 a[140:143], v2 offset:19456
v_bfe_u32 v251, v0, 2, 2
v_mfma_f32_16x16x32_bf16 v[172:175], a[164:167], v[68:71], v[172:175]
buffer_store_dwordx4 v[112:115], v1, s[44:47], s69 offen sc1
v_mfma_f32_16x16x32_bf16 v[172:175], a[168:171], v[72:75], v[172:175]
v_exp_f32 v149, v149
v_mfma_f32_16x16x32_bf16 v[172:175], a[172:175], v[76:79], v[172:175]
v_exp_f32 v150, v150
v_mfma_f32_16x16x32_bf16 v[188:191], a[188:191], v[76:79], v[92:95]
ds_read_b128 a[144:147], v2 offset:20480
v_cvt_pk_bf16_f32 v198, v148, v149
v_mfma_f32_16x16x32_bf16 v[188:191], a[184:187], v[72:75], v[188:191]
v_exp_f32 v151, v151
v_mfma_f32_16x16x32_bf16 v[188:191], a[180:183], v[68:71], v[188:191]
ds_read_b128 a[148:151], v2 offset:21504
v_cvt_pk_bf16_f32 v199, v150, v151
v_mfma_f32_16x16x32_bf16 v[188:191], a[176:179], v[64:67], v[188:191]
Lstub4:
s_cbranch_execz Lstub8
buffer_load_dwordx4 v1, s[44:47], s72 offen offset:1024 sc1 lds
v_mfma_f32_16x16x32_bf16 v[184:187], a[176:179], v[48:51], v[88:91]
v_exp_f32 v136, v136
v_mfma_f32_16x16x32_bf16 v[184:187], a[180:183], v[52:55], v[184:187]
v_exp_f32 v137, v137
v_mfma_f32_16x16x32_bf16 v[184:187], a[184:187], v[56:59], v[184:187]
ds_read_b128 a[152:155], v2 offset:22528
v_cvt_pk_bf16_f32 v200, v136, v137
v_mfma_f32_16x16x32_bf16 v[184:187], a[188:191], v[60:63], v[184:187]
v_exp_f32 v138, v138
v_mfma_f32_16x16x32_bf16 v[180:183], a[188:191], v[44:47], v[180:183]
ds_read_b128 a[156:159], v2 offset:23552
v_lshl_add_u32 v6, v248, 3, v6
v_mfma_f32_16x16x32_bf16 v[180:183], a[184:187], v[40:43], v[180:183]
buffer_store_dwordx4 v[112:115], v1, s[44:47], s69 offen offset:1024 sc1
v_mfma_f32_16x16x32_bf16 v[180:183], a[180:183], v[36:39], v[180:183]
s_waitcnt lgkmcnt(8)
v_exp_f32 v139, v139
v_mfma_f32_16x16x32_bf16 a[0:3], a[224:227], v[208:211], a[0:3]
v_exp_f32 v152, v152
v_mfma_f32_16x16x32_bf16 a[32:35], a[224:227], v[212:215], a[32:35]
ds_read_b128 a[192:195], v2 offset:0
v_cvt_pk_bf16_f32 v201, v138, v139
v_mfma_f32_16x16x32_bf16 a[64:67], a[224:227], v[216:219], a[64:67]
v_exp_f32 v153, v153
v_mfma_f32_16x16x32_bf16 a[96:99], a[224:227], v[220:223], a[96:99]
ds_read_b128 a[196:199], v2 offset:1024
v_cvt_pk_bf16_f32 v202, v152, v153
v_mfma_f32_16x16x32_bf16 a[100:103], a[228:231], v[220:223], a[100:103]
buffer_load_dwordx4 v1, s[44:47], s72 offen offset:2048 sc1 lds
v_mfma_f32_16x16x32_bf16 a[68:71], a[228:231], v[216:219], a[68:71]
v_exp_f32 v154, v154
v_mfma_f32_16x16x32_bf16 a[36:39], a[228:231], v[212:215], a[36:39]
v_exp_f32 v155, v155
v_mfma_f32_16x16x32_bf16 a[4:7], a[228:231], v[208:211], a[4:7]
ds_read_b128 a[200:203], v2 offset:2048
v_cvt_pk_bf16_f32 v203, v154, v155
v_mfma_f32_16x16x32_bf16 a[8:11], a[232:235], v[208:211], a[8:11]
v_exp_f32 v140, v140
v_mfma_f32_16x16x32_bf16 a[40:43], a[232:235], v[212:215], a[40:43]
ds_read_b128 a[204:207], v2 offset:3072
v_lshl_add_u32 v6, v241, 4, v6
v_mfma_f32_16x16x32_bf16 a[72:75], a[232:235], v[216:219], a[72:75]
buffer_store_dwordx4 v[112:115], v1, s[44:47], s69 offen offset:2048 sc1
v_mfma_f32_16x16x32_bf16 a[104:107], a[232:235], v[220:223], a[104:107]
v_exp_f32 v141, v141
v_mfma_f32_16x16x32_bf16 a[108:111], a[236:239], v[220:223], a[108:111]
v_exp_f32 v142, v142
v_mfma_f32_16x16x32_bf16 a[76:79], a[236:239], v[216:219], a[76:79]
ds_read_b128 a[208:211], v2 offset:4096
v_cvt_pk_bf16_f32 v204, v140, v141
v_mfma_f32_16x16x32_bf16 a[44:47], a[236:239], v[212:215], a[44:47]
v_exp_f32 v143, v143
v_mfma_f32_16x16x32_bf16 a[12:15], a[236:239], v[208:211], a[12:15]
ds_read_b128 a[212:215], v2 offset:5120
v_cvt_pk_bf16_f32 v205, v142, v143
v_mfma_f32_16x16x32_bf16 a[16:19], a[240:243], v[208:211], a[16:19]
buffer_load_dwordx4 v1, s[44:47], s72 offen offset:3072 sc1 lds
v_mfma_f32_16x16x32_bf16 a[48:51], a[240:243], v[212:215], a[48:51]
v_exp_f32 v156, v156
v_mfma_f32_16x16x32_bf16 a[80:83], a[240:243], v[216:219], a[80:83]
v_exp_f32 v157, v157
v_mfma_f32_16x16x32_bf16 a[112:115], a[240:243], v[220:223], a[112:115]
ds_read_b128 a[216:219], v2 offset:6144
v_cvt_pk_bf16_f32 v206, v156, v157
v_mfma_f32_16x16x32_bf16 a[116:119], a[244:247], v[220:223], a[116:119]
v_exp_f32 v158, v158
v_mfma_f32_16x16x32_bf16 a[84:87], a[244:247], v[216:219], a[84:87]
ds_read_b128 a[220:223], v2 offset:7168
v_lshlrev_b32 v5, 3, v251
v_mfma_f32_16x16x32_bf16 a[52:55], a[244:247], v[212:215], a[52:55]
buffer_store_dwordx4 v[112:115], v1, s[44:47], s69 offen offset:3072 sc1
v_mfma_f32_16x16x32_bf16 a[20:23], a[244:247], v[208:211], a[20:23]
v_exp_f32 v159, v159
v_mfma_f32_16x16x32_bf16 a[24:27], a[248:251], v[208:211], a[24:27]
v_cvt_pk_bf16_f32 v207, v158, v159
v_lshrrev_b32 v5, v5, v252
v_mfma_f32_16x16x32_bf16 a[56:59], a[248:251], v[212:215], a[56:59]
v_and_b32 v5, 3, v5
v_cmp_ne_u32 vcc, 1, v251
v_mfma_f32_16x16x32_bf16 a[88:91], a[248:251], v[216:219], a[88:91]
v_mul_u32_u24 v5, 16640, v5
v_add_u32 v5, s92, v5
v_mfma_f32_16x16x32_bf16 a[120:123], a[248:251], v[220:223], a[120:123]
v_cndmask_b32 v5, v250, v5, vcc
v_add_u32 v253, s58, v251
v_mfma_f32_16x16x32_bf16 a[124:127], a[252:255], v[220:223], a[124:127]
v_and_b32 v253, 3, v253
v_mul_u32_u24 v253, 4160, v253
v_mfma_f32_16x16x32_bf16 a[92:95], a[252:255], v[216:219], a[92:95]
v_add_u32 v5, v5, v253
v_mfma_f32_16x16x32_bf16 a[60:63], a[252:255], v[212:215], a[60:63]
s_add_u32 s73, s62, 480
v_lshlrev_b32 v248, 5, v240
v_sub_u32 v248, s73, v248
v_mfma_f32_16x16x32_bf16 a[28:31], a[252:255], v[208:211], a[28:31]
v_lshl_add_u32 v7, v241, 4, v248
v_mfma_f32_16x16x32_bf16 v[224:227], v[120:123], v[208:211], v[224:227]
s_and_b32 s73, s58, 1
v_mfma_f32_16x16x32_bf16 v[228:231], v[120:123], v[212:215], v[228:231]
s_lshl_b32 s73, s73, 4
v_mfma_f32_16x16x32_bf16 v[232:235], v[120:123], v[216:219], v[232:235]
s_lshr_b32 s73, s90, s73
v_mfma_f32_16x16x32_bf16 v[236:239], v[120:123], v[220:223], v[236:239]
s_waitcnt lgkmcnt(8)
v_mfma_f32_16x16x32_bf16 v[136:139], a[128:131], v[48:51], v[88:91]
s_add_u32 s82, s82, 0x8000
ds_read_b128 a[160:163], v2 offset:24576
ds_read_b128 a[164:167], v2 offset:25600
v_mfma_f32_16x16x32_bf16 v[136:139], a[132:135], v[52:55], v[136:139]
s_and_b32 s82, s82, 0x1ffff
v_exp_f32 v164, v164
v_mfma_f32_16x16x32_bf16 v[136:139], a[136:139], v[56:59], v[136:139]
s_add_u32 m0, s74, 0
v_exp_f32 v165, v165
v_mfma_f32_16x16x32_bf16 v[136:139], a[140:143], v[60:63], v[136:139]
s_add_u32 s72, s81, 0
v_exp_f32 v166, v166
v_mfma_f32_16x16x32_bf16 v[140:143], a[140:143], v[76:79], v[92:95]
ds_read_b128 a[168:171], v2 offset:26624
v_cvt_pk_bf16_f32 v212, v164, v165
v_mfma_f32_16x16x32_bf16 v[140:143], a[136:139], v[72:75], v[140:143]
v_exp_f32 v167, v167
v_mfma_f32_16x16x32_bf16 v[140:143], a[132:135], v[68:71], v[140:143]
buffer_load_dwordx4 v1, s[44:47], s72 offen sc1 lds
v_mfma_f32_16x16x32_bf16 v[140:143], a[128:131], v[64:67], v[140:143]
v_exp_f32 v180, v180
v_mfma_f32_16x16x32_bf16 v[156:159], a[144:147], v[64:67], v[92:95]
ds_read_b128 a[172:175], v2 offset:27648
v_cvt_pk_bf16_f32 v213, v166, v167
v_mfma_f32_16x16x32_bf16 v[156:159], a[148:151], v[68:71], v[156:159]
v_exp_f32 v181, v181
v_mfma_f32_16x16x32_bf16 v[156:159], a[152:155], v[72:75], v[156:159]
ds_read_b128 a[176:179], v2 offset:28672
v_cvt_pk_bf16_f32 v214, v180, v181
v_mfma_f32_16x16x32_bf16 v[156:159], a[156:159], v[76:79], v[156:159]
v_exp_f32 v182, v182
v_mfma_f32_16x16x32_bf16 v[152:155], a[156:159], v[60:63], v[88:91]
v_exp_f32 v183, v183
v_mfma_f32_16x16x32_bf16 v[152:155], a[152:155], v[56:59], v[152:155]
ds_read_b128 a[180:183], v2 offset:29696
v_cvt_pk_bf16_f32 v215, v182, v183
v_mfma_f32_16x16x32_bf16 v[152:155], a[148:151], v[52:55], v[152:155]
v_exp_f32 v168, v168
v_mfma_f32_16x16x32_bf16 v[152:155], a[144:147], v[48:51], v[152:155]
s_waitcnt lgkmcnt(6)
ds_read_b128 a[184:187], v2 offset:30720
ds_read_b128 a[188:191], v2 offset:31744
v_mfma_f32_16x16x32_bf16 a[32:35], a[192:195], v[196:199], a[32:35]
v_exp_f32 v169, v169
v_mfma_f32_16x16x32_bf16 a[64:67], a[192:195], v[200:203], a[64:67]
buffer_load_dwordx4 v1, s[44:47], s72 offen offset:1024 sc1 lds
v_mfma_f32_16x16x32_bf16 a[96:99], a[192:195], v[204:207], a[96:99]
v_exp_f32 v170, v170
v_mfma_f32_16x16x32_bf16 a[100:103], a[196:199], v[204:207], a[100:103]
v_exp_f32 v171, v171
v_mfma_f32_16x16x32_bf16 a[68:71], a[196:199], v[200:203], a[68:71]
ds_read_b128 a[224:227], v2 offset:8192
v_cvt_pk_bf16_f32 v216, v168, v169
v_mfma_f32_16x16x32_bf16 a[36:39], a[196:199], v[196:199], a[36:39]
v_exp_f32 v184, v184
v_mfma_f32_16x16x32_bf16 a[40:43], a[200:203], v[196:199], a[40:43]
v_exp_f32 v185, v185
v_mfma_f32_16x16x32_bf16 a[72:75], a[200:203], v[200:203], a[72:75]
ds_read_b128 a[228:231], v2 offset:9216
v_cvt_pk_bf16_f32 v217, v170, v171
v_mfma_f32_16x16x32_bf16 a[104:107], a[200:203], v[204:207], a[104:107]
v_exp_f32 v186, v186
v_mfma_f32_16x16x32_bf16 a[108:111], a[204:207], v[204:207], a[108:111]
ds_read_b128 a[232:235], v2 offset:10240
v_cvt_pk_bf16_f32 v218, v184, v185
v_mfma_f32_16x16x32_bf16 a[76:79], a[204:207], v[200:203], a[76:79]
v_exp_f32 v187, v187
v_mfma_f32_16x16x32_bf16 a[44:47], a[204:207], v[196:199], a[44:47]
buffer_load_dwordx4 v1, s[44:47], s72 offen offset:2048 sc1 lds
v_mfma_f32_16x16x32_bf16 a[48:51], a[208:211], v[196:199], a[48:51]
v_exp_f32 v172, v172
v_mfma_f32_16x16x32_bf16 a[80:83], a[208:211], v[200:203], a[80:83]
ds_read_b128 a[236:239], v2 offset:11264
v_cvt_pk_bf16_f32 v219, v186, v187
v_mfma_f32_16x16x32_bf16 a[112:115], a[208:211], v[204:207], a[112:115]
v_exp_f32 v173, v173
v_mfma_f32_16x16x32_bf16 a[116:119], a[212:215], v[204:207], a[116:119]
ds_read_b128 a[240:243], v2 offset:12288
v_cvt_pk_bf16_f32 v220, v172, v173
v_mfma_f32_16x16x32_bf16 a[84:87], a[212:215], v[200:203], a[84:87]
v_exp_f32 v174, v174
v_mfma_f32_16x16x32_bf16 a[52:55], a[212:215], v[196:199], a[52:55]
v_exp_f32 v175, v175
v_mfma_f32_16x16x32_bf16 a[56:59], a[216:219], v[196:199], a[56:59]
ds_read_b128 a[244:247], v2 offset:13312
v_cvt_pk_bf16_f32 v221, v174, v175
v_mfma_f32_16x16x32_bf16 a[88:91], a[216:219], v[200:203], a[88:91]
v_exp_f32 v188, v188
v_mfma_f32_16x16x32_bf16 a[120:123], a[216:219], v[204:207], a[120:123]
ds_read_b128 a[248:251], v2 offset:14336
v_mfma_f32_16x16x32_bf16 a[124:127], a[220:223], v[204:207], a[124:127]
v_exp_f32 v189, v189
v_mfma_f32_16x16x32_bf16 a[92:95], a[220:223], v[200:203], a[92:95]
buffer_load_dwordx4 v1, s[44:47], s72 offen offset:3072 sc1 lds
v_mfma_f32_16x16x32_bf16 a[60:63], a[220:223], v[196:199], a[60:63]
ds_read_b128 a[252:255], v2 offset:15360
v_cvt_pk_bf16_f32 v222, v188, v189
v_mfma_f32_16x16x32_bf16 v[228:231], v[120:123], v[196:199], v[228:231]
v_exp_f32 v190, v190
v_mfma_f32_16x16x32_bf16 v[232:235], v[120:123], v[200:203], v[232:235]
s_waitcnt vmcnt(12) lgkmcnt(8)
v_exp_f32 v191, v191
v_mfma_f32_16x16x32_bf16 v[236:239], v[120:123], v[204:207], v[236:239]
s_barrier
v_cvt_pk_bf16_f32 v223, v190, v191
v_add_u32 v2, s82, v1
v_mfma_f32_16x16x32_bf16 v[168:171], a[160:163], v[48:51], v[88:91]
s_xor_b32 s74, s82, 0x10000
v_exp_f32 v136, v136
v_mfma_f32_16x16x32_bf16 v[168:171], a[164:167], v[52:55], v[168:171]
s_add_u32 s74, s74, s64
ds_read_b128 a[128:131], v2 offset:16384
v_mfma_f32_16x16x32_bf16 v[168:171], a[168:171], v[56:59], v[168:171]
s_add_u32 s81, s81, 0x8000
v_exp_f32 v137, v137
v_mfma_f32_16x16x32_bf16 v[168:171], a[172:175], v[60:63], v[168:171]
s_add_u32 m0, s74, 16384
ds_read_b128 a[132:135], v2 offset:17408
v_cvt_pk_bf16_f32 v200, v136, v137
v_mfma_f32_16x16x32_bf16 v[172:175], a[172:175], v[76:79], v[92:95]
s_add_u32 s72, s81, 16384
buffer_load_dwordx4 v1, s[44:47], s72 offen sc1 lds
v_mfma_f32_16x16x32_bf16 v[172:175], a[168:171], v[72:75], v[172:175]
s_add_u32 s69, s93, 0x4200000
v_exp_f32 v138, v138
v_mfma_f32_16x16x32_bf16 v[172:175], a[164:167], v[68:71], v[172:175]
s_and_b32 s73, s73, 0xffff
ds_read_b128 a[136:139], v2 offset:18432
v_lshl_add_u32 v248, v241, 3, v240
v_mfma_f32_16x16x32_bf16 v[172:175], a[160:163], v[64:67], v[172:175]
v_exp_f32 v139, v139
v_mfma_f32_16x16x32_bf16 v[188:191], a[176:179], v[64:67], v[92:95]
ds_read_b128 a[140:143], v2 offset:19456
v_cvt_pk_bf16_f32 v201, v138, v139
v_mfma_f32_16x16x32_bf16 v[188:191], a[180:183], v[68:71], v[188:191]
buffer_store_dwordx4 v[112:115], v1, s[44:47], s69 offen sc1
v_mfma_f32_16x16x32_bf16 v[188:191], a[184:187], v[72:75], v[188:191]
v_exp_f32 v152, v152
v_mfma_f32_16x16x32_bf16 v[188:191], a[188:191], v[76:79], v[188:191]
ds_read_b128 a[144:147], v2 offset:20480
v_sub_u32 v248, 15, v248
v_mfma_f32_16x16x32_bf16 v[184:187], a[188:191], v[60:63], v[88:91]
v_exp_f32 v153, v153
v_mfma_f32_16x16x32_bf16 v[184:187], a[184:187], v[56:59], v[184:187]
ds_read_b128 a[148:151], v2 offset:21504
v_cvt_pk_bf16_f32 v202, v152, v153
v_mfma_f32_16x16x32_bf16 v[184:187], a[180:183], v[52:55], v[184:187]
buffer_load_dwordx4 v1, s[44:47], s72 offen offset:1024 sc1 lds
v_mfma_f32_16x16x32_bf16 v[184:187], a[176:179], v[48:51], v[184:187]
s_waitcnt lgkmcnt(6)
v_exp_f32 v154, v154
v_mfma_f32_16x16x32_bf16 a[32:35], a[224:227], v[212:215], a[32:35]
ds_read_b128 a[152:155], v2 offset:22528
v_and_b32 v249, 1, v248
v_mfma_f32_16x16x32_bf16 a[64:67], a[224:227], v[216:219], a[64:67]
v_exp_f32 v155, v155
v_mfma_f32_16x16x32_bf16 a[96:99], a[224:227], v[220:223], a[96:99]
ds_read_b128 a[156:159], v2 offset:23552
v_cvt_pk_bf16_f32 v203, v154, v155
v_mfma_f32_16x16x32_bf16 a[100:103], a[228:231], v[220:223], a[100:103]
buffer_store_dwordx4 v[112:115], v1, s[44:47], s69 offen offset:1024 sc1
v_mfma_f32_16x16x32_bf16 a[68:71], a[228:231], v[216:219], a[68:71]
v_exp_f32 v140, v140
v_mfma_f32_16x16x32_bf16 a[36:39], a[228:231], v[212:215], a[36:39]
ds_read_b128 a[192:195], v2 offset:0
v_lshlrev_b32 v249, 4, v249
v_mfma_f32_16x16x32_bf16 a[40:43], a[232:235], v[212:215], a[40:43]
v_exp_f32 v141, v141
v_mfma_f32_16x16x32_bf16 a[72:75], a[232:235], v[216:219], a[72:75]
ds_read_b128 a[196:199], v2 offset:1024
v_cvt_pk_bf16_f32 v204, v140, v141
v_mfma_f32_16x16x32_bf16 a[104:107], a[232:235], v[220:223], a[104:107]
buffer_load_dwordx4 v1, s[44:47], s72 offen offset:2048 sc1 lds
v_mfma_f32_16x16x32_bf16 a[108:111], a[236:239], v[220:223], a[108:111]
v_exp_f32 v142, v142
v_mfma_f32_16x16x32_bf16 a[76:79], a[236:239], v[216:219], a[76:79]
ds_read_b128 a[200:203], v2 offset:2048
v_lshlrev_b32 v249, v249, s73
v_mfma_f32_16x16x32_bf16 a[44:47], a[236:239], v[212:215], a[44:47]
v_exp_f32 v143, v143
v_mfma_f32_16x16x32_bf16 a[48:51], a[240:243], v[212:215], a[48:51]
ds_read_b128 a[204:207], v2 offset:3072
v_cvt_pk_bf16_f32 v205, v142, v143
v_mfma_f32_16x16x32_bf16 a[80:83], a[240:243], v[216:219], a[80:83]
buffer_store_dwordx4 v[112:115], v1, s[44:47], s69 offen offset:2048 sc1
v_mfma_f32_16x16x32_bf16 a[112:115], a[240:243], v[220:223], a[112:115]
v_exp_f32 v156, v156
v_mfma_f32_16x16x32_bf16 a[116:119], a[244:247], v[220:223], a[116:119]
ds_read_b128 a[208:211], v2 offset:4096
v_lshrrev_b32 v248, 1, v248
v_mfma_f32_16x16x32_bf16 a[84:87], a[244:247], v[216:219], a[84:87]
v_exp_f32 v157, v157
v_mfma_f32_16x16x32_bf16 a[52:55], a[244:247], v[212:215], a[52:55]
ds_read_b128 a[212:215], v2 offset:5120
v_cvt_pk_bf16_f32 v206, v156, v157
v_mfma_f32_16x16x32_bf16 a[56:59], a[248:251], v[212:215], a[56:59]
buffer_load_dwordx4 v1, s[44:47], s72 offen offset:3072 sc1 lds
v_mfma_f32_16x16x32_bf16 a[88:91], a[248:251], v[216:219], a[88:91]
v_exp_f32 v158, v158
v_mfma_f32_16x16x32_bf16 a[120:123], a[248:251], v[220:223], a[120:123]
ds_read_b128 a[216:219], v2 offset:6144
v_and_b32 v241, 3, v0
v_mfma_f32_16x16x32_bf16 a[124:127], a[252:255], v[220:223], a[124:127]
v_exp_f32 v159, v159
v_mfma_f32_16x16x32_bf16 a[92:95], a[252:255], v[216:219], a[92:95]
ds_read_b128 a[220:223], v2 offset:7168
v_cvt_pk_bf16_f32 v207, v158, v159
v_mfma_f32_16x16x32_bf16 a[60:63], a[252:255], v[212:215], a[60:63]
buffer_store_dwordx4 v[112:115], v1, s[44:47], s69 offen offset:3072 sc1
v_mfma_f32_16x16x32_bf16 v[228:231], v[120:123], v[212:215], v[228:231]
v_cmp_eq_u32 vcc, 0, v248
v_lshl_add_u32 v5, v241, 3, v5
v_mfma_f32_16x16x32_bf16 v[232:235], v[120:123], v[216:219], v[232:235]
v_cndmask_b32 v8, 0, v249, vcc
v_cmp_eq_u32 vcc, 1, v248
v_mfma_f32_16x16x32_bf16 v[236:239], v[120:123], v[220:223], v[236:239]
s_waitcnt lgkmcnt(8)
v_lshlrev_b32 v240, 4, v251
v_cndmask_b32 v9, 0, v249, vcc
v_cmp_eq_u32 vcc, 2, v248
v_sub_u32 v240, 48, v240
v_lshlrev_b64 v[12:13], 16, s[88:89]
v_cndmask_b32 v10, 0, v249, vcc
v_cmp_eq_u32 vcc, 3, v248
v_lshlrev_b64 v[12:13], v240, v[12:13]
s_nop 0
v_cndmask_b32 v11, 0, v249, vcc
v_cmp_eq_u32 vcc, 3, v241
s_add_u32 s73, s62, 4096
v_lshl_add_u32 v14, v0, 3, s73
v_cndmask_b32 v12, 0, v12, vcc
v_cndmask_b32 v13, 0, v13, vcc
v_lshrrev_b32 v15, 4, v0
v_lshlrev_b32 v15, 1, v15
v_and_b32 v240, 7, v0
v_xor_b32 v15, v15, v240
v_lshlrev_b32 v15, 4, v15
v_lshrrev_b32 v240, 3, v0
v_lshl_add_u32 v15, v240, 11, v15
s_lshr_b32 s75, s59, 1
s_and_b32 s75, s75, 8
s_add_u32 s75, s75, s60
s_lshl_b32 s76, s65, 2
s_lshr_b32 s80, s59, 2
s_and_b32 s80, s80, 3
s_add_u32 s76, s76, s80
s_lshl_b32 s94, s58, 16
s_lshl_b32 s80, s76, 7
s_add_u32 s94, s94, s80
s_lshl_b32 s80, s75, 18
s_add_u32 s80, s80, s94
v_rcp_f32 v224, v224
v_rcp_f32 v228, v228
s_lshl_b32 s73, s59, 12
s_add_u32 s73, s73, 0x2000000
s_lshl_b32 s70, s67, 2
s_add_u32 s70, s70, s73
v_mov_b32 v225, v224
v_accvgpr_read_b32 v240, a0
v_accvgpr_read_b32 v241, a1
v_accvgpr_read_b32 v242, a2
v_accvgpr_read_b32 v243, a3
v_accvgpr_read_b32 v244, a4
v_accvgpr_read_b32 v245, a5
v_accvgpr_read_b32 v246, a6
v_accvgpr_read_b32 v247, a7
v_pk_mul_f32 v[240:241], v[240:241], v[224:225]
v_pk_mul_f32 v[242:243], v[242:243], v[224:225]
v_pk_mul_f32 v[244:245], v[244:245], v[224:225]
v_pk_mul_f32 v[246:247], v[246:247], v[224:225]
v_cvt_pk_bf16_f32 v128, v240, v241
v_cvt_pk_bf16_f32 v129, v242, v243
v_cvt_pk_bf16_f32 v130, v244, v245
v_cvt_pk_bf16_f32 v131, v246, v247
v_accvgpr_read_b32 v248, a8
v_accvgpr_read_b32 v249, a9
v_accvgpr_read_b32 v250, a10
v_accvgpr_read_b32 v251, a11
v_accvgpr_read_b32 v252, a12
v_accvgpr_read_b32 v253, a13
v_accvgpr_read_b32 v254, a14
v_accvgpr_read_b32 v255, a15
v_pk_mul_f32 v[248:249], v[248:249], v[224:225]
v_pk_mul_f32 v[250:251], v[250:251], v[224:225]
v_pk_mul_f32 v[252:253], v[252:253], v[224:225]
v_pk_mul_f32 v[254:255], v[254:255], v[224:225]
v_cvt_pk_bf16_f32 v144, v248, v249
v_cvt_pk_bf16_f32 v145, v250, v251
v_cvt_pk_bf16_f32 v146, v252, v253
v_cvt_pk_bf16_f32 v147, v254, v255
v_accvgpr_read_b32 v240, a16
v_accvgpr_read_b32 v241, a17
v_accvgpr_read_b32 v242, a18
v_accvgpr_read_b32 v243, a19
v_accvgpr_read_b32 v244, a20
v_accvgpr_read_b32 v245, a21
v_accvgpr_read_b32 v246, a22
v_accvgpr_read_b32 v247, a23
v_pk_mul_f32 v[240:241], v[240:241], v[224:225]
v_pk_mul_f32 v[242:243], v[242:243], v[224:225]
v_pk_mul_f32 v[244:245], v[244:245], v[224:225]
v_pk_mul_f32 v[246:247], v[246:247], v[224:225]
v_cvt_pk_bf16_f32 v160, v240, v241
v_cvt_pk_bf16_f32 v161, v242, v243
v_cvt_pk_bf16_f32 v162, v244, v245
v_cvt_pk_bf16_f32 v163, v246, v247
v_accvgpr_read_b32 v248, a24
v_accvgpr_read_b32 v249, a25
v_accvgpr_read_b32 v250, a26
v_accvgpr_read_b32 v251, a27
v_accvgpr_read_b32 v252, a28
v_accvgpr_read_b32 v253, a29
v_accvgpr_read_b32 v254, a30
v_accvgpr_read_b32 v255, a31
v_pk_mul_f32 v[248:249], v[248:249], v[224:225]
v_pk_mul_f32 v[250:251], v[250:251], v[224:225]
v_pk_mul_f32 v[252:253], v[252:253], v[224:225]
v_pk_mul_f32 v[254:255], v[254:255], v[224:225]
v_cvt_pk_bf16_f32 v176, v248, v249
v_cvt_pk_bf16_f32 v177, v250, v251
v_cvt_pk_bf16_f32 v178, v252, v253
v_cvt_pk_bf16_f32 v179, v254, v255
v_mov_b32 v229, v228
v_accvgpr_read_b32 v240, a32
v_accvgpr_read_b32 v241, a33
v_accvgpr_read_b32 v242, a34
v_accvgpr_read_b32 v243, a35
v_accvgpr_read_b32 v244, a36
v_accvgpr_read_b32 v245, a37
v_accvgpr_read_b32 v246, a38
v_accvgpr_read_b32 v247, a39
v_pk_mul_f32 v[240:241], v[240:241], v[228:229]
v_pk_mul_f32 v[242:243], v[242:243], v[228:229]
v_pk_mul_f32 v[244:245], v[244:245], v[228:229]
v_pk_mul_f32 v[246:247], v[246:247], v[228:229]
v_cvt_pk_bf16_f32 v132, v240, v241
v_cvt_pk_bf16_f32 v133, v242, v243
v_cvt_pk_bf16_f32 v134, v244, v245
v_cvt_pk_bf16_f32 v135, v246, v247
v_accvgpr_read_b32 v248, a40
v_accvgpr_read_b32 v249, a41
v_accvgpr_read_b32 v250, a42
v_accvgpr_read_b32 v251, a43
v_accvgpr_read_b32 v252, a44
v_accvgpr_read_b32 v253, a45
v_accvgpr_read_b32 v254, a46
v_accvgpr_read_b32 v255, a47
v_pk_mul_f32 v[248:249], v[248:249], v[228:229]
v_pk_mul_f32 v[250:251], v[250:251], v[228:229]
v_pk_mul_f32 v[252:253], v[252:253], v[228:229]
v_pk_mul_f32 v[254:255], v[254:255], v[228:229]
v_cvt_pk_bf16_f32 v148, v248, v249
v_cvt_pk_bf16_f32 v149, v250, v251
v_cvt_pk_bf16_f32 v150, v252, v253
v_cvt_pk_bf16_f32 v151, v254, v255
v_accvgpr_read_b32 v240, a48
v_accvgpr_read_b32 v241, a49
v_accvgpr_read_b32 v242, a50
v_accvgpr_read_b32 v243, a51
v_accvgpr_read_b32 v244, a52
v_accvgpr_read_b32 v245, a53
v_accvgpr_read_b32 v246, a54
v_accvgpr_read_b32 v247, a55
v_pk_mul_f32 v[240:241], v[240:241], v[228:229]
v_pk_mul_f32 v[242:243], v[242:243], v[228:229]
v_pk_mul_f32 v[244:245], v[244:245], v[228:229]
v_pk_mul_f32 v[246:247], v[246:247], v[228:229]
v_cvt_pk_bf16_f32 v164, v240, v241
v_cvt_pk_bf16_f32 v165, v242, v243
v_cvt_pk_bf16_f32 v166, v244, v245
v_cvt_pk_bf16_f32 v167, v246, v247
v_accvgpr_read_b32 v248, a56
v_accvgpr_read_b32 v249, a57
v_accvgpr_read_b32 v250, a58
v_accvgpr_read_b32 v251, a59
v_accvgpr_read_b32 v252, a60
v_accvgpr_read_b32 v253, a61
v_accvgpr_read_b32 v254, a62
v_accvgpr_read_b32 v255, a63
v_pk_mul_f32 v[248:249], v[248:249], v[228:229]
v_pk_mul_f32 v[250:251], v[250:251], v[228:229]
v_pk_mul_f32 v[252:253], v[252:253], v[228:229]
v_pk_mul_f32 v[254:255], v[254:255], v[228:229]
v_cvt_pk_bf16_f32 v180, v248, v249
v_cvt_pk_bf16_f32 v181, v250, v251
v_cvt_pk_bf16_f32 v182, v252, v253
v_cvt_pk_bf16_f32 v183, v254, v255
v_mfma_f32_16x16x32_bf16 v[136:139], a[128:131], v[48:51], v[88:91]
s_add_u32 s82, s82, 0x8000
ds_read_b128 a[160:163], v2 offset:24576
ds_read_b128 a[164:167], v2 offset:25600
v_mfma_f32_16x16x32_bf16 v[136:139], a[132:135], v[52:55], v[136:139]
s_and_b32 s82, s82, 0x1ffff
v_exp_f32 v168, v168
v_mfma_f32_16x16x32_bf16 v[136:139], a[136:139], v[56:59], v[136:139]
s_add_u32 m0, s74, 0
v_exp_f32 v169, v169
v_mfma_f32_16x16x32_bf16 v[136:139], a[140:143], v[60:63], v[136:139]
s_add_u32 s72, s81, 0
buffer_load_dwordx4 v1, s[44:47], s72 offen sc1 lds
v_mfma_f32_16x16x32_bf16 v[140:143], a[140:143], v[76:79], v[92:95]
ds_read_b128 a[168:171], v2 offset:26624
v_cvt_pk_bf16_f32 v216, v168, v169
v_mfma_f32_16x16x32_bf16 v[140:143], a[136:139], v[72:75], v[140:143]
v_exp_f32 v170, v170
v_mfma_f32_16x16x32_bf16 v[140:143], a[132:135], v[68:71], v[140:143]
ds_read_b128 a[172:175], v2 offset:27648
ds_read_b128 a[176:179], v2 offset:28672
v_mfma_f32_16x16x32_bf16 v[140:143], a[128:131], v[64:67], v[140:143]
v_exp_f32 v171, v171
v_mfma_f32_16x16x32_bf16 v[156:159], a[144:147], v[64:67], v[92:95]
v_exp_f32 v184, v184
v_mfma_f32_16x16x32_bf16 v[156:159], a[148:151], v[68:71], v[156:159]
buffer_store_dwordx4 v[128:131], v1, s[44:47], s70 offen sc1
v_mfma_f32_16x16x32_bf16 v[156:159], a[152:155], v[72:75], v[156:159]
ds_read_b128 a[180:183], v2 offset:29696
v_cvt_pk_bf16_f32 v217, v170, v171
v_mfma_f32_16x16x32_bf16 v[156:159], a[156:159], v[76:79], v[156:159]
v_exp_f32 v185, v185
v_mfma_f32_16x16x32_bf16 v[152:155], a[156:159], v[60:63], v[88:91]
ds_read_b128 a[184:187], v2 offset:30720
v_cvt_pk_bf16_f32 v218, v184, v185
v_mfma_f32_16x16x32_bf16 v[152:155], a[152:155], v[56:59], v[152:155]
v_exp_f32 v186, v186
v_mfma_f32_16x16x32_bf16 v[152:155], a[148:151], v[52:55], v[152:155]
buffer_load_dwordx4 v1, s[44:47], s72 offen offset:1024 sc1 lds
v_mfma_f32_16x16x32_bf16 v[152:155], a[144:147], v[48:51], v[152:155]
s_waitcnt lgkmcnt(7)
ds_read_b128 a[188:191], v2 offset:31744
ds_read_b128 a[224:227], v2 offset:8192
v_mfma_f32_16x16x32_bf16 a[64:67], a[192:195], v[200:203], a[64:67]
v_exp_f32 v187, v187
v_mfma_f32_16x16x32_bf16 a[96:99], a[192:195], v[204:207], a[96:99]
v_exp_f32 v172, v172
v_mfma_f32_16x16x32_bf16 a[100:103], a[196:199], v[204:207], a[100:103]
ds_read_b128 a[228:231], v2 offset:9216
v_cvt_pk_bf16_f32 v219, v186, v187
v_mfma_f32_16x16x32_bf16 a[68:71], a[196:199], v[200:203], a[68:71]
v_exp_f32 v173, v173
v_mfma_f32_16x16x32_bf16 a[72:75], a[200:203], v[200:203], a[72:75]
buffer_store_dwordx4 v[144:147], v1, s[44:47], s70 offen offset:1024 sc1
v_mfma_f32_16x16x32_bf16 a[104:107], a[200:203], v[204:207], a[104:107]
ds_read_b128 a[232:235], v2 offset:10240
v_cvt_pk_bf16_f32 v220, v172, v173
v_mfma_f32_16x16x32_bf16 a[108:111], a[204:207], v[204:207], a[108:111]
v_exp_f32 v174, v174
v_mfma_f32_16x16x32_bf16 a[76:79], a[204:207], v[200:203], a[76:79]
ds_read_b128 a[236:239], v2 offset:11264
ds_read_b128 a[240:243], v2 offset:12288
v_mfma_f32_16x16x32_bf16 a[80:83], a[208:211], v[200:203], a[80:83]
v_exp_f32 v175, v175
v_mfma_f32_16x16x32_bf16 a[112:115], a[208:211], v[204:207], a[112:115]
buffer_load_dwordx4 v1, s[44:47], s72 offen offset:2048 sc1 lds
v_mfma_f32_16x16x32_bf16 a[116:119], a[212:215], v[204:207], a[116:119]
v_exp_f32 v188, v188
v_mfma_f32_16x16x32_bf16 a[84:87], a[212:215], v[200:203], a[84:87]
ds_read_b128 a[244:247], v2 offset:13312
v_cvt_pk_bf16_f32 v221, v174, v175
v_mfma_f32_16x16x32_bf16 a[88:91], a[216:219], v[200:203], a[88:91]
v_exp_f32 v189, v189
v_mfma_f32_16x16x32_bf16 a[120:123], a[216:219], v[204:207], a[120:123]
ds_read_b128 a[248:251], v2 offset:14336
ds_read_b128 a[252:255], v2 offset:15360
v_mfma_f32_16x16x32_bf16 a[124:127], a[220:223], v[204:207], a[124:127]
v_exp_f32 v190, v190
v_mfma_f32_16x16x32_bf16 a[92:95], a[220:223], v[200:203], a[92:95]
buffer_load_dwordx4 v1, s[44:47], s72 offen offset:3072 sc1 lds
v_mfma_f32_16x16x32_bf16 v[232:235], v[120:123], v[200:203], v[232:235]
s_waitcnt vmcnt(14) lgkmcnt(8)
v_exp_f32 v191, v191
v_mfma_f32_16x16x32_bf16 v[236:239], v[120:123], v[204:207], v[236:239]
s_barrier
v_cvt_pk_bf16_f32 v222, v188, v189
v_cvt_pk_bf16_f32 v223, v190, v191
v_add_u32 v2, s82, v1
v_mfma_f32_16x16x32_bf16 v[168:171], a[160:163], v[48:51], v[88:91]
s_xor_b32 s74, s82, 0x10000
v_exp_f32 v136, v136
v_mfma_f32_16x16x32_bf16 v[168:171], a[164:167], v[52:55], v[168:171]
s_add_u32 s74, s74, s64
ds_read_b128 a[128:131], v2 offset:16384
ds_read_b128 a[132:135], v2 offset:17408
v_mfma_f32_16x16x32_bf16 v[168:171], a[168:171], v[56:59], v[168:171]
Lstub5:
s_cbranch_execz Lstub9
s_add_u32 s81, s81, 0x8000
v_exp_f32 v137, v137
v_mfma_f32_16x16x32_bf16 v[168:171], a[172:175], v[60:63], v[168:171]
s_add_u32 m0, s74, 16384
v_exp_f32 v138, v138
v_mfma_f32_16x16x32_bf16 v[172:175], a[172:175], v[76:79], v[92:95]
s_add_u32 s72, s81, 16384
buffer_load_dwordx4 v1, s[44:47], s72 offen sc1 lds
v_mfma_f32_16x16x32_bf16 v[172:175], a[168:171], v[72:75], v[172:175]
ds_read_b128 a[136:139], v2 offset:18432
v_cvt_pk_bf16_f32 v200, v136, v137
v_mfma_f32_16x16x32_bf16 v[172:175], a[164:167], v[68:71], v[172:175]
v_exp_f32 v139, v139
v_mfma_f32_16x16x32_bf16 v[172:175], a[160:163], v[64:67], v[172:175]
ds_read_b128 a[140:143], v2 offset:19456
v_cvt_pk_bf16_f32 v201, v138, v139
v_mfma_f32_16x16x32_bf16 v[188:191], a[176:179], v[64:67], v[92:95]
buffer_store_dwordx4 v[160:163], v1, s[44:47], s70 offen offset:2048 sc1
v_mfma_f32_16x16x32_bf16 v[188:191], a[180:183], v[68:71], v[188:191]
v_exp_f32 v152, v152
v_mfma_f32_16x16x32_bf16 v[188:191], a[184:187], v[72:75], v[188:191]
ds_read_b128 a[144:147], v2 offset:20480
ds_read_b128 a[148:151], v2 offset:21504
v_mfma_f32_16x16x32_bf16 v[188:191], a[188:191], v[76:79], v[188:191]
v_exp_f32 v153, v153
v_mfma_f32_16x16x32_bf16 v[184:187], a[188:191], v[60:63], v[88:91]
buffer_load_dwordx4 v1, s[44:47], s72 offen offset:1024 sc1 lds
v_mfma_f32_16x16x32_bf16 v[184:187], a[184:187], v[56:59], v[184:187]
v_exp_f32 v154, v154
v_mfma_f32_16x16x32_bf16 v[184:187], a[180:183], v[52:55], v[184:187]
ds_read_b128 a[152:155], v2 offset:22528
v_cvt_pk_bf16_f32 v202, v152, v153
v_mfma_f32_16x16x32_bf16 v[184:187], a[176:179], v[48:51], v[184:187]
s_waitcnt lgkmcnt(7)
v_exp_f32 v155, v155
v_mfma_f32_16x16x32_bf16 a[64:67], a[224:227], v[216:219], a[64:67]
ds_read_b128 a[156:159], v2 offset:23552
v_cvt_pk_bf16_f32 v203, v154, v155
v_mfma_f32_16x16x32_bf16 a[96:99], a[224:227], v[220:223], a[96:99]
v_exp_f32 v140, v140
v_mfma_f32_16x16x32_bf16 a[100:103], a[228:231], v[220:223], a[100:103]
ds_read_b128 a[192:195], v2 offset:0
ds_read_b128 a[196:199], v2 offset:1024
v_mfma_f32_16x16x32_bf16 a[68:71], a[228:231], v[216:219], a[68:71]
buffer_store_dwordx4 v[176:179], v1, s[44:47], s70 offen offset:3072 sc1
v_mfma_f32_16x16x32_bf16 a[72:75], a[232:235], v[216:219], a[72:75]
v_exp_f32 v141, v141
v_mfma_f32_16x16x32_bf16 a[104:107], a[232:235], v[220:223], a[104:107]
v_exp_f32 v142, v142
v_mfma_f32_16x16x32_bf16 a[108:111], a[236:239], v[220:223], a[108:111]
ds_read_b128 a[200:203], v2 offset:2048
ds_read_b128 a[204:207], v2 offset:3072
v_mfma_f32_16x16x32_bf16 a[76:79], a[236:239], v[216:219], a[76:79]
buffer_load_dwordx4 v1, s[44:47], s72 offen offset:2048 sc1 lds
v_mfma_f32_16x16x32_bf16 a[80:83], a[240:243], v[216:219], a[80:83]
s_add_u32 s70, s70, 0x80000
v_exp_f32 v143, v143
v_mfma_f32_16x16x32_bf16 a[112:115], a[240:243], v[220:223], a[112:115]
v_exp_f32 v156, v156
v_mfma_f32_16x16x32_bf16 a[116:119], a[244:247], v[220:223], a[116:119]
ds_read_b128 a[208:211], v2 offset:4096
ds_read_b128 a[212:215], v2 offset:5120
v_mfma_f32_16x16x32_bf16 a[84:87], a[244:247], v[216:219], a[84:87]
ds_read_b128 a[216:219], v2 offset:6144
ds_read_b128 a[220:223], v2 offset:7168
v_mfma_f32_16x16x32_bf16 a[88:91], a[248:251], v[216:219], a[88:91]
v_cvt_pk_bf16_f32 v204, v140, v141
v_cvt_pk_bf16_f32 v205, v142, v143
v_mfma_f32_16x16x32_bf16 a[120:123], a[248:251], v[220:223], a[120:123]
buffer_store_dwordx4 v[132:135], v1, s[44:47], s70 offen sc1
v_mfma_f32_16x16x32_bf16 a[124:127], a[252:255], v[220:223], a[124:127]
v_exp_f32 v157, v157
v_mfma_f32_16x16x32_bf16 a[92:95], a[252:255], v[216:219], a[92:95]
v_exp_f32 v158, v158
v_mfma_f32_16x16x32_bf16 v[232:235], v[120:123], v[216:219], v[232:235]
buffer_load_dwordx4 v1, s[44:47], s72 offen offset:3072 sc1 lds
v_mfma_f32_16x16x32_bf16 v[236:239], v[120:123], v[220:223], v[236:239]
s_waitcnt lgkmcnt(8)
v_exp_f32 v159, v159
v_cvt_pk_bf16_f32 v206, v156, v157
v_cvt_pk_bf16_f32 v207, v158, v159
v_mfma_f32_16x16x32_bf16 v[136:139], a[128:131], v[48:51], v[88:91]
s_add_u32 s82, s82, 0x8000
ds_read_b128 a[160:163], v2 offset:24576
ds_read_b128 a[164:167], v2 offset:25600
v_mfma_f32_16x16x32_bf16 v[136:139], a[132:135], v[52:55], v[136:139]
s_and_b32 s82, s82, 0x1ffff
v_exp_f32 v168, v168
v_mfma_f32_16x16x32_bf16 v[136:139], a[136:139], v[56:59], v[136:139]
s_add_u32 m0, s74, 0
v_exp_f32 v169, v169
v_mfma_f32_16x16x32_bf16 v[136:139], a[140:143], v[60:63], v[136:139]
s_add_u32 s72, s81, 0
buffer_load_dwordx4 v1, s[44:47], s72 offen sc1 lds
v_mfma_f32_16x16x32_bf16 v[140:143], a[140:143], v[76:79], v[92:95]
ds_read_b128 a[168:171], v2 offset:26624
v_cvt_pk_bf16_f32 v216, v168, v169
v_mfma_f32_16x16x32_bf16 v[140:143], a[136:139], v[72:75], v[140:143]
v_exp_f32 v170, v170
v_mfma_f32_16x16x32_bf16 v[140:143], a[132:135], v[68:71], v[140:143]
ds_read_b128 a[172:175], v2 offset:27648
ds_read_b128 a[176:179], v2 offset:28672
v_mfma_f32_16x16x32_bf16 v[140:143], a[128:131], v[64:67], v[140:143]
v_exp_f32 v171, v171
v_mfma_f32_16x16x32_bf16 v[156:159], a[144:147], v[64:67], v[92:95]
buffer_store_dwordx4 v[148:151], v1, s[44:47], s70 offen offset:1024 sc1
v_mfma_f32_16x16x32_bf16 v[156:159], a[148:151], v[68:71], v[156:159]
v_exp_f32 v184, v184
v_mfma_f32_16x16x32_bf16 v[156:159], a[152:155], v[72:75], v[156:159]
ds_read_b128 a[180:183], v2 offset:29696
v_cvt_pk_bf16_f32 v217, v170, v171
v_mfma_f32_16x16x32_bf16 v[156:159], a[156:159], v[76:79], v[156:159]
v_exp_f32 v185, v185
v_mfma_f32_16x16x32_bf16 v[152:155], a[156:159], v[60:63], v[88:91]
buffer_load_dwordx4 v1, s[44:47], s72 offen offset:1024 sc1 lds
v_mfma_f32_16x16x32_bf16 v[152:155], a[152:155], v[56:59], v[152:155]
ds_read_b128 a[184:187], v2 offset:30720
v_cvt_pk_bf16_f32 v218, v184, v185
v_mfma_f32_16x16x32_bf16 v[152:155], a[148:151], v[52:55], v[152:155]
v_exp_f32 v186, v186
v_mfma_f32_16x16x32_bf16 v[152:155], a[144:147], v[48:51], v[152:155]
s_waitcnt lgkmcnt(7)
ds_read_b128 a[188:191], v2 offset:31744
ds_read_b128 a[224:227], v2 offset:8192
v_mfma_f32_16x16x32_bf16 a[64:67], a[192:195], v[200:203], a[64:67]
v_exp_f32 v187, v187
v_mfma_f32_16x16x32_bf16 a[96:99], a[192:195], v[204:207], a[96:99]
buffer_store_dwordx4 v[164:167], v1, s[44:47], s70 offen offset:2048 sc1
v_mfma_f32_16x16x32_bf16 a[100:103], a[196:199], v[204:207], a[100:103]
v_exp_f32 v172, v172
v_mfma_f32_16x16x32_bf16 a[68:71], a[196:199], v[200:203], a[68:71]
ds_read_b128 a[228:231], v2 offset:9216
v_cvt_pk_bf16_f32 v219, v186, v187
v_mfma_f32_16x16x32_bf16 a[72:75], a[200:203], v[200:203], a[72:75]
v_exp_f32 v173, v173
v_mfma_f32_16x16x32_bf16 a[104:107], a[200:203], v[204:207], a[104:107]
ds_read_b128 a[232:235], v2 offset:10240
ds_read_b128 a[236:239], v2 offset:11264
v_mfma_f32_16x16x32_bf16 a[108:111], a[204:207], v[204:207], a[108:111]
v_exp_f32 v174, v174
v_mfma_f32_16x16x32_bf16 a[76:79], a[204:207], v[200:203], a[76:79]
buffer_load_dwordx4 v1, s[44:47], s72 offen offset:2048 sc1 lds
v_mfma_f32_16x16x32_bf16 a[80:83], a[208:211], v[200:203], a[80:83]
v_exp_f32 v175, v175
v_mfma_f32_16x16x32_bf16 a[112:115], a[208:211], v[204:207], a[112:115]
ds_read_b128 a[240:243], v2 offset:12288
ds_read_b128 a[244:247], v2 offset:13312
v_mfma_f32_16x16x32_bf16 a[116:119], a[212:215], v[204:207], a[116:119]
v_exp_f32 v188, v188
v_mfma_f32_16x16x32_bf16 a[84:87], a[212:215], v[200:203], a[84:87]
ds_read_b128 a[248:251], v2 offset:14336
ds_read_b128 a[252:255], v2 offset:15360
v_mfma_f32_16x16x32_bf16 a[88:91], a[216:219], v[200:203], a[88:91]
v_cvt_pk_bf16_f32 v220, v172, v173
v_cvt_pk_bf16_f32 v221, v174, v175
v_mfma_f32_16x16x32_bf16 a[120:123], a[216:219], v[204:207], a[120:123]
buffer_store_dwordx4 v[180:183], v1, s[44:47], s70 offen offset:3072 sc1
v_mfma_f32_16x16x32_bf16 a[124:127], a[220:223], v[204:207], a[124:127]
v_exp_f32 v189, v189
v_mfma_f32_16x16x32_bf16 a[92:95], a[220:223], v[200:203], a[92:95]
buffer_load_dwordx4 v1, s[44:47], s72 offen offset:3072 sc1 lds
v_mfma_f32_16x16x32_bf16 v[232:235], v[120:123], v[200:203], v[232:235]
s_waitcnt vmcnt(14) lgkmcnt(8)
v_exp_f32 v190, v190
v_mfma_f32_16x16x32_bf16 v[236:239], v[120:123], v[204:207], v[236:239]
s_barrier
v_exp_f32 v191, v191
v_add_u32 v2, s82, v1
v_cvt_pk_bf16_f32 v222, v188, v189
v_cvt_pk_bf16_f32 v223, v190, v191
s_lshl_b32 s83, s60, 2
s_sub_u32 s83, s83, 25
.p2align 5
s_nop 0
s_nop 0
LloopII:
v_mfma_f32_16x16x32_bf16 v[168:171], a[160:163], v[48:51], v[88:91]
s_xor_b32 s74, s82, 0x10000
v_exp_f32 v136, v136
v_mfma_f32_16x16x32_bf16 v[168:171], a[164:167], v[52:55], v[168:171]
s_add_u32 s74, s74, s64
ds_read_b128 a[128:131], v2 offset:16384
ds_read_b128 a[132:135], v2 offset:17408
v_mfma_f32_16x16x32_bf16 v[168:171], a[168:171], v[56:59], v[168:171]
s_add_u32 s81, s81, 0x8000
v_exp_f32 v137, v137
v_mfma_f32_16x16x32_bf16 v[168:171], a[172:175], v[60:63], v[168:171]
s_add_u32 m0, s74, 16384
v_exp_f32 v138, v138
v_mfma_f32_16x16x32_bf16 v[172:175], a[172:175], v[76:79], v[92:95]
s_add_u32 s72, s81, 16384
ds_read_b128 a[136:139], v2 offset:18432
v_cvt_pk_bf16_f32 v200, v136, v137
v_mfma_f32_16x16x32_bf16 v[172:175], a[168:171], v[72:75], v[172:175]
buffer_load_dwordx4 v1, s[44:47], s72 offen sc1 lds
v_mfma_f32_16x16x32_bf16 v[172:175], a[164:167], v[68:71], v[172:175]
v_exp_f32 v139, v139
v_mfma_f32_16x16x32_bf16 v[172:175], a[160:163], v[64:67], v[172:175]
ds_read_b128 a[140:143], v2 offset:19456
v_cvt_pk_bf16_f32 v201, v138, v139
v_mfma_f32_16x16x32_bf16 v[188:191], a[176:179], v[64:67], v[92:95]
v_exp_f32 v152, v152
v_mfma_f32_16x16x32_bf16 v[188:191], a[180:183], v[68:71], v[188:191]
ds_read_b128 a[144:147], v2 offset:20480
ds_read_b128 a[148:151], v2 offset:21504
v_mfma_f32_16x16x32_bf16 v[188:191], a[184:187], v[72:75], v[188:191]
v_exp_f32 v153, v153
v_mfma_f32_16x16x32_bf16 v[188:191], a[188:191], v[76:79], v[188:191]
v_exp_f32 v154, v154
v_mfma_f32_16x16x32_bf16 v[184:187], a[188:191], v[60:63], v[88:91]
ds_read_b128 a[152:155], v2 offset:22528
v_cvt_pk_bf16_f32 v202, v152, v153
v_mfma_f32_16x16x32_bf16 v[184:187], a[184:187], v[56:59], v[184:187]
buffer_load_dwordx4 v1, s[44:47], s72 offen offset:1024 sc1 lds
v_mfma_f32_16x16x32_bf16 v[184:187], a[180:183], v[52:55], v[184:187]
v_exp_f32 v155, v155
v_mfma_f32_16x16x32_bf16 v[184:187], a[176:179], v[48:51], v[184:187]
s_waitcnt lgkmcnt(7)
ds_read_b128 a[156:159], v2 offset:23552
v_cvt_pk_bf16_f32 v203, v154, v155
v_mfma_f32_16x16x32_bf16 a[64:67], a[224:227], v[216:219], a[64:67]
v_exp_f32 v140, v140
v_mfma_f32_16x16x32_bf16 a[96:99], a[224:227], v[220:223], a[96:99]
ds_read_b128 a[192:195], v2 offset:0
ds_read_b128 a[196:199], v2 offset:1024
v_mfma_f32_16x16x32_bf16 a[100:103], a[228:231], v[220:223], a[100:103]
v_exp_f32 v141, v141
v_mfma_f32_16x16x32_bf16 a[68:71], a[228:231], v[216:219], a[68:71]
v_exp_f32 v142, v142
v_mfma_f32_16x16x32_bf16 a[72:75], a[232:235], v[216:219], a[72:75]
ds_read_b128 a[200:203], v2 offset:2048
v_cvt_pk_bf16_f32 v204, v140, v141
v_mfma_f32_16x16x32_bf16 a[104:107], a[232:235], v[220:223], a[104:107]
buffer_load_dwordx4 v1, s[44:47], s72 offen offset:2048 sc1 lds
v_mfma_f32_16x16x32_bf16 a[108:111], a[236:239], v[220:223], a[108:111]
v_exp_f32 v143, v143
v_mfma_f32_16x16x32_bf16 a[76:79], a[236:239], v[216:219], a[76:79]
ds_read_b128 a[204:207], v2 offset:3072
v_cvt_pk_bf16_f32 v205, v142, v143
v_mfma_f32_16x16x32_bf16 a[80:83], a[240:243], v[216:219], a[80:83]
v_exp_f32 v156, v156
v_mfma_f32_16x16x32_bf16 a[112:115], a[240:243], v[220:223], a[112:115]
ds_read_b128 a[208:211], v2 offset:4096
v_mfma_f32_16x16x32_bf16 a[116:119], a[244:247], v[220:223], a[116:119]
v_exp_f32 v157, v157
v_mfma_f32_16x16x32_bf16 a[84:87], a[244:247], v[216:219], a[84:87]
ds_read_b128 a[212:215], v2 offset:5120
v_cvt_pk_bf16_f32 v206, v156, v157
v_mfma_f32_16x16x32_bf16 a[88:91], a[248:251], v[216:219], a[88:91]
v_exp_f32 v158, v158
v_mfma_f32_16x16x32_bf16 a[120:123], a[248:251], v[220:223], a[120:123]
ds_read_b128 a[216:219], v2 offset:6144
v_mfma_f32_16x16x32_bf16 a[124:127], a[252:255], v[220:223], a[124:127]
buffer_load_dwordx4 v1, s[44:47], s72 offen offset:3072 sc1 lds
v_mfma_f32_16x16x32_bf16 a[92:95], a[252:255], v[216:219], a[92:95]
v_exp_f32 v159, v159
v_mfma_f32_16x16x32_bf16 v[232:235], v[120:123], v[216:219], v[232:235]
ds_read_b128 a[220:223], v2 offset:7168
v_cvt_pk_bf16_f32 v207, v158, v159
v_mfma_f32_16x16x32_bf16 v[236:239], v[120:123], v[220:223], v[236:239]
s_waitcnt lgkmcnt(8)
v_mfma_f32_16x16x32_bf16 v[136:139], a[128:131], v[48:51], v[88:91]
s_add_u32 s82, s82, 0x8000
ds_read_b128 a[160:163], v2 offset:24576
ds_read_b128 a[164:167], v2 offset:25600
v_mfma_f32_16x16x32_bf16 v[136:139], a[132:135], v[52:55], v[136:139]
s_and_b32 s82, s82, 0x1ffff
v_exp_f32 v168, v168
v_mfma_f32_16x16x32_bf16 v[136:139], a[136:139], v[56:59], v[136:139]
s_add_u32 m0, s74, 0
v_exp_f32 v169, v169
v_mfma_f32_16x16x32_bf16 v[136:139], a[140:143], v[60:63], v[136:139]
s_add_u32 s72, s81, 0
ds_read_b128 a[168:171], v2 offset:26624
v_cvt_pk_bf16_f32 v216, v168, v169
v_mfma_f32_16x16x32_bf16 v[140:143], a[140:143], v[76:79], v[92:95]
v_exp_f32 v170, v170
v_mfma_f32_16x16x32_bf16 v[140:143], a[136:139], v[72:75], v[140:143]
buffer_load_dwordx4 v1, s[44:47], s72 offen sc1 lds
v_mfma_f32_16x16x32_bf16 v[140:143], a[132:135], v[68:71], v[140:143]
ds_read_b128 a[172:175], v2 offset:27648
ds_read_b128 a[176:179], v2 offset:28672
v_mfma_f32_16x16x32_bf16 v[140:143], a[128:131], v[64:67], v[140:143]
v_exp_f32 v171, v171
v_mfma_f32_16x16x32_bf16 v[156:159], a[144:147], v[64:67], v[92:95]
v_exp_f32 v184, v184
v_mfma_f32_16x16x32_bf16 v[156:159], a[148:151], v[68:71], v[156:159]
ds_read_b128 a[180:183], v2 offset:29696
v_cvt_pk_bf16_f32 v217, v170, v171
v_mfma_f32_16x16x32_bf16 v[156:159], a[152:155], v[72:75], v[156:159]
v_exp_f32 v185, v185
v_mfma_f32_16x16x32_bf16 v[156:159], a[156:159], v[76:79], v[156:159]
ds_read_b128 a[184:187], v2 offset:30720
v_cvt_pk_bf16_f32 v218, v184, v185
v_mfma_f32_16x16x32_bf16 v[152:155], a[156:159], v[60:63], v[88:91]
buffer_load_dwordx4 v1, s[44:47], s72 offen offset:1024 sc1 lds
v_mfma_f32_16x16x32_bf16 v[152:155], a[152:155], v[56:59], v[152:155]
v_exp_f32 v186, v186
v_mfma_f32_16x16x32_bf16 v[152:155], a[148:151], v[52:55], v[152:155]
ds_read_b128 a[188:191], v2 offset:31744
ds_read_b128 a[224:227], v2 offset:8192
v_mfma_f32_16x16x32_bf16 v[152:155], a[144:147], v[48:51], v[152:155]
s_waitcnt lgkmcnt(9)
v_exp_f32 v187, v187
v_mfma_f32_16x16x32_bf16 a[64:67], a[192:195], v[200:203], a[64:67]
v_exp_f32 v172, v172
v_mfma_f32_16x16x32_bf16 a[96:99], a[192:195], v[204:207], a[96:99]
ds_read_b128 a[228:231], v2 offset:9216
v_cvt_pk_bf16_f32 v219, v186, v187
v_mfma_f32_16x16x32_bf16 a[100:103], a[196:199], v[204:207], a[100:103]
v_exp_f32 v173, v173
v_mfma_f32_16x16x32_bf16 a[68:71], a[196:199], v[200:203], a[68:71]
ds_read_b128 a[232:235], v2 offset:10240
v_cvt_pk_bf16_f32 v220, v172, v173
v_mfma_f32_16x16x32_bf16 a[72:75], a[200:203], v[200:203], a[72:75]
buffer_load_dwordx4 v1, s[44:47], s72 offen offset:2048 sc1 lds
v_mfma_f32_16x16x32_bf16 a[104:107], a[200:203], v[204:207], a[104:107]
v_exp_f32 v174, v174
v_mfma_f32_16x16x32_bf16 a[108:111], a[204:207], v[204:207], a[108:111]
ds_read_b128 a[236:239], v2 offset:11264
ds_read_b128 a[240:243], v2 offset:12288
v_mfma_f32_16x16x32_bf16 a[76:79], a[204:207], v[200:203], a[76:79]
v_exp_f32 v175, v175
v_mfma_f32_16x16x32_bf16 a[80:83], a[208:211], v[200:203], a[80:83]
v_exp_f32 v188, v188
v_mfma_f32_16x16x32_bf16 a[112:115], a[208:211], v[204:207], a[112:115]
ds_read_b128 a[244:247], v2 offset:13312
v_cvt_pk_bf16_f32 v221, v174, v175
v_mfma_f32_16x16x32_bf16 a[116:119], a[212:215], v[204:207], a[116:119]
v_exp_f32 v189, v189
v_mfma_f32_16x16x32_bf16 a[84:87], a[212:215], v[200:203], a[84:87]
ds_read_b128 a[248:251], v2 offset:14336
v_cvt_pk_bf16_f32 v222, v188, v189
v_mfma_f32_16x16x32_bf16 a[88:91], a[216:219], v[200:203], a[88:91]
buffer_load_dwordx4 v1, s[44:47], s72 offen offset:3072 sc1 lds
v_mfma_f32_16x16x32_bf16 a[120:123], a[216:219], v[204:207], a[120:123]
ds_read_b128 a[252:255], v2 offset:15360
v_add_u32 v2, s82, v1
v_mfma_f32_16x16x32_bf16 a[124:127], a[220:223], v[204:207], a[124:127]
s_waitcnt vmcnt(8) lgkmcnt(8)
v_exp_f32 v190, v190
v_mfma_f32_16x16x32_bf16 a[92:95], a[220:223], v[200:203], a[92:95]
s_barrier
v_exp_f32 v191, v191
v_mfma_f32_16x16x32_bf16 v[232:235], v[120:123], v[200:203], v[232:235]
s_add_u32 s83, s83, 1
v_cvt_pk_bf16_f32 v223, v190, v191
v_mfma_f32_16x16x32_bf16 v[236:239], v[120:123], v[204:207], v[236:239]
s_cbranch_scc0 LloopII
v_mfma_f32_16x16x32_bf16 v[168:171], a[160:163], v[48:51], v[88:91]
s_xor_b32 s74, s82, 0x10000
ds_read_b128 a[128:131], v2 offset:16384
ds_read_b128 a[132:135], v2 offset:17408
v_mfma_f32_16x16x32_bf16 v[168:171], a[164:167], v[52:55], v[168:171]
s_add_u32 s74, s74, s64
v_exp_f32 v136, v136
v_mfma_f32_16x16x32_bf16 v[168:171], a[168:171], v[56:59], v[168:171]
s_add_u32 s81, s81, 0x8000
v_exp_f32 v137, v137
v_mfma_f32_16x16x32_bf16 v[168:171], a[172:175], v[60:63], v[168:171]
s_add_u32 m0, s74, 0
ds_read_b128 a[136:139], v2 offset:18432
v_cvt_pk_bf16_f32 v200, v136, v137
v_mfma_f32_16x16x32_bf16 v[172:175], a[172:175], v[76:79], v[92:95]
s_add_u32 s72, s81, 0
v_exp_f32 v138, v138
v_mfma_f32_16x16x32_bf16 v[172:175], a[168:171], v[72:75], v[172:175]
buffer_load_dwordx4 v1, s[44:47], s72 offen sc1 lds
v_mfma_f32_16x16x32_bf16 v[172:175], a[164:167], v[68:71], v[172:175]
ds_read_b128 a[140:143], v2 offset:19456
ds_read_b128 a[144:147], v2 offset:20480
v_mfma_f32_16x16x32_bf16 v[172:175], a[160:163], v[64:67], v[172:175]
v_exp_f32 v139, v139
v_mfma_f32_16x16x32_bf16 v[188:191], a[176:179], v[64:67], v[92:95]
v_exp_f32 v152, v152
v_mfma_f32_16x16x32_bf16 v[188:191], a[180:183], v[68:71], v[188:191]
ds_read_b128 a[148:151], v2 offset:21504
v_cvt_pk_bf16_f32 v201, v138, v139
v_mfma_f32_16x16x32_bf16 v[188:191], a[184:187], v[72:75], v[188:191]
v_exp_f32 v153, v153
v_mfma_f32_16x16x32_bf16 v[188:191], a[188:191], v[76:79], v[188:191]
ds_read_b128 a[152:155], v2 offset:22528
v_cvt_pk_bf16_f32 v202, v152, v153
v_mfma_f32_16x16x32_bf16 v[184:187], a[188:191], v[60:63], v[88:91]
v_exp_f32 v154, v154
v_mfma_f32_16x16x32_bf16 v[184:187], a[184:187], v[56:59], v[184:187]
buffer_load_dwordx4 v1, s[44:47], s72 offen offset:1024 sc1 lds
v_mfma_f32_16x16x32_bf16 v[184:187], a[180:183], v[52:55], v[184:187]
ds_read_b128 a[156:159], v2 offset:23552
ds_read_b128 a[192:195], v2 offset:0
v_mfma_f32_16x16x32_bf16 v[184:187], a[176:179], v[48:51], v[184:187]
s_waitcnt lgkmcnt(9)
v_exp_f32 v155, v155
v_mfma_f32_16x16x32_bf16 a[64:67], a[224:227], v[216:219], a[64:67]
v_exp_f32 v140, v140
v_mfma_f32_16x16x32_bf16 a[96:99], a[224:227], v[220:223], a[96:99]
ds_read_b128 a[196:199], v2 offset:1024
v_cvt_pk_bf16_f32 v203, v154, v155
v_mfma_f32_16x16x32_bf16 a[100:103], a[228:231], v[220:223], a[100:103]
v_exp_f32 v141, v141
v_mfma_f32_16x16x32_bf16 a[68:71], a[228:231], v[216:219], a[68:71]
ds_read_b128 a[200:203], v2 offset:2048
v_cvt_pk_bf16_f32 v204, v140, v141
v_mfma_f32_16x16x32_bf16 a[72:75], a[232:235], v[216:219], a[72:75]
v_exp_f32 v142, v142
v_mfma_f32_16x16x32_bf16 a[104:107], a[232:235], v[220:223], a[104:107]
buffer_load_dwordx4 v1, s[44:47], s72 offen offset:2048 sc1 lds
v_mfma_f32_16x16x32_bf16 a[108:111], a[236:239], v[220:223], a[108:111]
ds_read_b128 a[204:207], v2 offset:3072
v_mfma_f32_16x16x32_bf16 a[76:79], a[236:239], v[216:219], a[76:79]
v_exp_f32 v143, v143
v_mfma_f32_16x16x32_bf16 a[80:83], a[240:243], v[216:219], a[80:83]
ds_read_b128 a[208:211], v2 offset:4096
v_cvt_pk_bf16_f32 v205, v142, v143
v_mfma_f32_16x16x32_bf16 a[112:115], a[240:243], v[220:223], a[112:115]
v_exp_f32 v156, v156
v_mfma_f32_16x16x32_bf16 a[116:119], a[244:247], v[220:223], a[116:119]
ds_read_b128 a[212:215], v2 offset:5120
v_mfma_f32_16x16x32_bf16 a[84:87], a[244:247], v[216:219], a[84:87]
v_exp_f32 v157, v157
v_mfma_f32_16x16x32_bf16 a[88:91], a[248:251], v[216:219], a[88:91]
ds_read_b128 a[216:219], v2 offset:6144
v_cvt_pk_bf16_f32 v206, v156, v157
v_mfma_f32_16x16x32_bf16 a[120:123], a[248:251], v[220:223], a[120:123]
buffer_load_dwordx4 v1, s[44:47], s72 offen offset:3072 sc1 lds
v_mfma_f32_16x16x32_bf16 a[124:127], a[252:255], v[220:223], a[124:127]
v_exp_f32 v158, v158
v_mfma_f32_16x16x32_bf16 a[92:95], a[252:255], v[216:219], a[92:95]
ds_read_b128 a[220:223], v2 offset:7168
v_mfma_f32_16x16x32_bf16 v[232:235], v[120:123], v[216:219], v[232:235]
s_waitcnt lgkmcnt(8)
v_exp_f32 v159, v159
v_mfma_f32_16x16x32_bf16 v[236:239], v[120:123], v[220:223], v[236:239]
s_barrier
v_cvt_pk_bf16_f32 v207, v158, v159
s_lshr_b32 s69, s93, 4
s_and_b32 s69, s69, 0x7f00
s_add_u32 s69, s69, LHT4-Lpc0
v_lshrrev_b32 v3, 5, v0
v_lshlrev_b32 v3, 7, v3
v_add_u32 v3, s69, v3
v_min_u32 v3, Lcode_end-Lpc0, v3
global_load_dword v4, v3, s[98:99]
s_cmp_eq_u32 s58, 0
s_cbranch_scc1 Lta28
s_cmp_eq_u32 s58, 1
s_cbranch_scc1 Lnt29
v_mfma_f32_16x16x32_bf16 v[136:139], a[128:131], v[48:51], v[88:91]
s_add_u32 s82, s82, 0x8000
ds_read_b128 a[160:163], v2 offset:24576
ds_read_b128 a[164:167], v2 offset:25600
v_mfma_f32_16x16x32_bf16 v[152:155], a[144:147], v[48:51], v[88:91]
s_and_b32 s82, s82, 0x1ffff
v_exp_f32 v168, v168
s_branch Ljoin30
Lta28:
v_mfma_f32_16x16x32_bf16 v[136:139], a[128:131], v[48:51], v[104:107]
s_add_u32 s82, s82, 0x8000
ds_read_b128 a[160:163], v2 offset:24576
ds_read_b128 a[164:167], v2 offset:25600
v_mfma_f32_16x16x32_bf16 v[152:155], a[144:147], v[48:51], v[112:115]
s_and_b32 s82, s82, 0x1ffff
v_exp_f32 v168, v168
s_branch Ljoin30
Lnt29:
v_mfma_f32_16x16x32_bf16 v[136:139], a[128:131], v[48:51], v[88:91]
s_add_u32 s82, s82, 0x8000
ds_read_b128 a[160:163], v2 offset:24576
ds_read_b128 a[164:167], v2 offset:25600
v_mfma_f32_16x16x32_bf16 v[152:155], a[144:147], v[48:51], v[104:107]
s_and_b32 s82, s82, 0x1ffff
v_exp_f32 v168, v168
Ljoin30:
v_mfma_f32_16x16x32_bf16 v[136:139], a[132:135], v[52:55], v[136:139]
s_add_u32 s66, s58, 3
v_exp_f32 v169, v169
v_mfma_f32_16x16x32_bf16 v[136:139], a[136:139], v[56:59], v[136:139]
s_and_b32 s66, s66, 3
ds_read_b128 a[168:171], v2 offset:26624
v_cvt_pk_bf16_f32 v216, v168, v169
v_mfma_f32_16x16x32_bf16 v[136:139], a[140:143], v[60:63], v[136:139]
s_mul_i32 s66, s66, 4160
v_exp_f32 v170, v170
v_mfma_f32_16x16x32_bf16 v[140:143], a[140:143], v[76:79], v[92:95]
s_add_u32 s66, s66, s92
ds_read_b128 a[172:175], v2 offset:27648
ds_read_b128 a[176:179], v2 offset:28672
v_mfma_f32_16x16x32_bf16 v[140:143], a[136:139], v[72:75], v[140:143]
s_add_u32 m0, s66, 32
v_exp_f32 v171, v171
v_mfma_f32_16x16x32_bf16 v[140:143], a[132:135], v[68:71], v[140:143]
s_add_u32 s72, s93, 0x6
buffer_load_dwordx4 v1, s[36:39], s72 offen lds
v_mfma_f32_16x16x32_bf16 v[140:143], a[128:131], v[64:67], v[140:143]
v_exp_f32 v184, v184
v_mfma_f32_16x16x32_bf16 v[156:159], a[144:147], v[64:67], v[92:95]
ds_read_b128 a[180:183], v2 offset:29696
v_cvt_pk_bf16_f32 v217, v170, v171
v_mfma_f32_16x16x32_bf16 v[156:159], a[148:151], v[68:71], v[156:159]
v_exp_f32 v185, v185
v_mfma_f32_16x16x32_bf16 v[156:159], a[152:155], v[72:75], v[156:159]
ds_read_b128 a[184:187], v2 offset:30720
v_cvt_pk_bf16_f32 v218, v184, v185
v_mfma_f32_16x16x32_bf16 v[156:159], a[156:159], v[76:79], v[156:159]
v_exp_f32 v186, v186
v_mfma_f32_16x16x32_bf16 v[152:155], a[156:159], v[60:63], v[152:155]
buffer_load_dwordx4 v1, s[36:39], s72 offen offset:1024 lds
v_mfma_f32_16x16x32_bf16 v[152:155], a[152:155], v[56:59], v[152:155]
ds_read_b128 a[188:191], v2 offset:31744
ds_read_b128 a[224:227], v2 offset:8192
v_mfma_f32_16x16x32_bf16 v[152:155], a[148:151], v[52:55], v[152:155]
s_waitcnt lgkmcnt(9)
v_exp_f32 v187, v187
v_mfma_f32_16x16x32_bf16 a[64:67], a[192:195], v[200:203], a[64:67]
v_exp_f32 v172, v172
v_mfma_f32_16x16x32_bf16 a[96:99], a[192:195], v[204:207], a[96:99]
ds_read_b128 a[228:231], v2 offset:9216
v_cvt_pk_bf16_f32 v219, v186, v187
v_mfma_f32_16x16x32_bf16 a[100:103], a[196:199], v[204:207], a[100:103]
v_exp_f32 v173, v173
v_mfma_f32_16x16x32_bf16 a[68:71], a[196:199], v[200:203], a[68:71]
ds_read_b128 a[232:235], v2 offset:10240
v_cvt_pk_bf16_f32 v220, v172, v173
v_mfma_f32_16x16x32_bf16 a[72:75], a[200:203], v[200:203], a[72:75]
v_exp_f32 v174, v174
v_mfma_f32_16x16x32_bf16 a[104:107], a[200:203], v[204:207], a[104:107]
buffer_load_dwordx4 v1, s[36:39], s72 offen offset:2048 lds
v_mfma_f32_16x16x32_bf16 a[108:111], a[204:207], v[204:207], a[108:111]
ds_read_b128 a[236:239], v2 offset:11264
v_mfma_f32_16x16x32_bf16 a[76:79], a[204:207], v[200:203], a[76:79]
v_exp_f32 v175, v175
v_mfma_f32_16x16x32_bf16 a[80:83], a[208:211], v[200:203], a[80:83]
ds_read_b128 a[240:243], v2 offset:12288
v_cvt_pk_bf16_f32 v221, v174, v175
v_mfma_f32_16x16x32_bf16 a[112:115], a[208:211], v[204:207], a[112:115]
v_exp_f32 v188, v188
v_mfma_f32_16x16x32_bf16 a[116:119], a[212:215], v[204:207], a[116:119]
ds_read_b128 a[244:247], v2 offset:13312
v_mfma_f32_16x16x32_bf16 a[84:87], a[212:215], v[200:203], a[84:87]
v_exp_f32 v189, v189
v_mfma_f32_16x16x32_bf16 a[88:91], a[216:219], v[200:203], a[88:91]
ds_read_b128 a[248:251], v2 offset:14336
v_cvt_pk_bf16_f32 v222, v188, v189
v_mfma_f32_16x16x32_bf16 a[120:123], a[216:219], v[204:207], a[120:123]
buffer_load_dwordx4 v1, s[36:39], s72 offen offset:3072 lds
v_mfma_f32_16x16x32_bf16 a[124:127], a[220:223], v[204:207], a[124:127]
v_exp_f32 v190, v190
v_mfma_f32_16x16x32_bf16 a[92:95], a[220:223], v[200:203], a[92:95]
ds_read_b128 a[252:255], v2 offset:15360
v_add_u32 v2, s82, v1
v_mfma_f32_16x16x32_bf16 v[232:235], v[120:123], v[200:203], v[232:235]
s_waitcnt vmcnt(9) lgkmcnt(0)
v_exp_f32 v191, v191
v_mfma_f32_16x16x32_bf16 v[236:239], v[120:123], v[204:207], v[236:239]
s_barrier
v_cvt_pk_bf16_f32 v223, v190, v191
s_cmp_eq_u32 s58, 2
s_cbranch_scc1 Lta31
s_cmp_eq_u32 s58, 3
s_cbranch_scc1 Lnt32
v_mfma_f32_16x16x32_bf16 v[168:171], a[160:163], v[48:51], v[112:115]
s_mov_b32 m0, s62
v_exp_f32 v136, v136
v_mfma_f32_16x16x32_bf16 v[184:187], a[176:179], v[48:51], v[112:115]
s_add_u32 s72, s93, 0x3000000
ds_read_b128 a[128:131], v2 offset:16384
ds_read_b128 a[132:135], v2 offset:17408
s_branch Ljoin33
Lta31:
v_mfma_f32_16x16x32_bf16 v[168:171], a[160:163], v[48:51], v[104:107]
s_mov_b32 m0, s62
v_exp_f32 v136, v136
v_mfma_f32_16x16x32_bf16 v[184:187], a[176:179], v[48:51], v[112:115]
s_add_u32 s72, s93, 0x3000000
ds_read_b128 a[128:131], v2 offset:16384
ds_read_b128 a[132:135], v2 offset:17408
s_branch Ljoin33
Lnt32:
v_mfma_f32_16x16x32_bf16 v[168:171], a[160:163], v[48:51], v[88:91]
s_mov_b32 m0, s62
v_exp_f32 v136, v136
v_mfma_f32_16x16x32_bf16 v[184:187], a[176:179], v[48:51], v[104:107]
s_add_u32 s72, s93, 0x3000000
ds_read_b128 a[128:131], v2 offset:16384
ds_read_b128 a[132:135], v2 offset:17408
Ljoin33:
v_mfma_f32_16x16x32_bf16 v[168:171], a[164:167], v[52:55], v[168:171]
v_exp_f32 v137, v137
v_mfma_f32_16x16x32_bf16 v[168:171], a[168:171], v[56:59], v[168:171]
buffer_load_dwordx4 v1, s[44:47], s72 offen sc1 lds
v_mfma_f32_16x16x32_bf16 v[168:171], a[172:175], v[60:63], v[168:171]
s_add_u32 s78, s59, 4
v_exp_f32 v138, v138
v_mfma_f32_16x16x32_bf16 v[172:175], a[172:175], v[76:79], v[92:95]
s_and_b32 s78, s78, 12
ds_read_b128 a[136:139], v2 offset:18432
v_cvt_pk_bf16_f32 v200, v136, v137
Lstub6:
s_cbranch_execz Lstub10
v_mfma_f32_16x16x32_bf16 v[172:175], a[168:171], v[72:75], v[172:175]
s_and_b32 s12, s59, 16
v_exp_f32 v139, v139
v_mfma_f32_16x16x32_bf16 v[172:175], a[164:167], v[68:71], v[172:175]
s_or_b32 s78, s78, s12
ds_read_b128 a[140:143], v2 offset:19456
v_cvt_pk_bf16_f32 v201, v138, v139
v_mfma_f32_16x16x32_bf16 v[172:175], a[160:163], v[64:67], v[172:175]
s_add_u32 s12, s61, 0
v_exp_f32 v152, v152
v_mfma_f32_16x16x32_bf16 v[188:191], a[176:179], v[64:67], v[92:95]
s_and_b32 s12, s12, 3
ds_read_b128 a[144:147], v2 offset:20480
ds_read_b128 a[148:151], v2 offset:21504
v_mfma_f32_16x16x32_bf16 v[188:191], a[180:183], v[68:71], v[188:191]
s_add_u32 s12, s12, s78
buffer_load_dwordx4 v1, s[44:47], s72 offen offset:1024 sc1 lds
v_mfma_f32_16x16x32_bf16 v[188:191], a[184:187], v[72:75], v[188:191]
s_lshl_b32 s12, s12, 18
v_exp_f32 v153, v153
v_mfma_f32_16x16x32_bf16 v[188:191], a[188:191], v[76:79], v[188:191]
s_add_u32 s12, s12, s94
v_exp_f32 v154, v154
v_mfma_f32_16x16x32_bf16 v[184:187], a[188:191], v[60:63], v[184:187]
s_add_u32 s13, s61, 1
ds_read_b128 a[152:155], v2 offset:22528
v_cvt_pk_bf16_f32 v202, v152, v153
v_mfma_f32_16x16x32_bf16 v[184:187], a[184:187], v[56:59], v[184:187]
s_and_b32 s13, s13, 3
buffer_load_dwordx4 v1, s[44:47], s72 offen offset:2048 sc1 lds
v_mfma_f32_16x16x32_bf16 v[184:187], a[180:183], v[52:55], v[184:187]
s_waitcnt lgkmcnt(7)
v_exp_f32 v155, v155
v_mfma_f32_16x16x32_bf16 a[64:67], a[224:227], v[216:219], a[64:67]
s_add_u32 s13, s13, s78
ds_read_b128 a[156:159], v2 offset:23552
v_cvt_pk_bf16_f32 v203, v154, v155
v_mfma_f32_16x16x32_bf16 a[96:99], a[224:227], v[220:223], a[96:99]
s_lshl_b32 s13, s13, 18
v_exp_f32 v140, v140
v_mfma_f32_16x16x32_bf16 a[100:103], a[228:231], v[220:223], a[100:103]
s_add_u32 s13, s13, s94
ds_read_b128 a[192:195], v2 offset:0
ds_read_b128 a[196:199], v2 offset:1024
v_mfma_f32_16x16x32_bf16 a[68:71], a[228:231], v[216:219], a[68:71]
s_add_u32 s14, s61, 2
v_exp_f32 v141, v141
v_mfma_f32_16x16x32_bf16 a[72:75], a[232:235], v[216:219], a[72:75]
s_and_b32 s14, s14, 3
buffer_load_dwordx4 v1, s[44:47], s72 offen offset:3072 sc1 lds
v_mfma_f32_16x16x32_bf16 a[104:107], a[232:235], v[220:223], a[104:107]
s_add_u32 s66, s58, 0
v_exp_f32 v142, v142
v_mfma_f32_16x16x32_bf16 a[108:111], a[236:239], v[220:223], a[108:111]
s_and_b32 s66, s66, 3
ds_read_b128 a[200:203], v2 offset:2048
v_cvt_pk_bf16_f32 v204, v140, v141
v_mfma_f32_16x16x32_bf16 a[76:79], a[236:239], v[216:219], a[76:79]
s_mul_i32 s66, s66, 4160
v_exp_f32 v143, v143
v_mfma_f32_16x16x32_bf16 a[80:83], a[240:243], v[216:219], a[80:83]
s_add_u32 s66, s66, s92
ds_read_b128 a[204:207], v2 offset:3072
v_cvt_pk_bf16_f32 v205, v142, v143
v_mfma_f32_16x16x32_bf16 a[112:115], a[240:243], v[220:223], a[112:115]
s_add_u32 m0, s66, 16672
v_exp_f32 v156, v156
v_mfma_f32_16x16x32_bf16 a[116:119], a[244:247], v[220:223], a[116:119]
s_add_u32 s72, s93, 0x0
ds_read_b128 a[208:211], v2 offset:4096
ds_read_b128 a[212:215], v2 offset:5120
v_mfma_f32_16x16x32_bf16 a[84:87], a[244:247], v[216:219], a[84:87]
s_add_u32 s14, s14, s78
buffer_load_dwordx4 v1, s[36:39], s72 offen lds
v_mfma_f32_16x16x32_bf16 a[88:91], a[248:251], v[216:219], a[88:91]
s_lshl_b32 s14, s14, 18
v_exp_f32 v157, v157
v_mfma_f32_16x16x32_bf16 a[120:123], a[248:251], v[220:223], a[120:123]
s_add_u32 s14, s14, s94
v_exp_f32 v158, v158
v_mfma_f32_16x16x32_bf16 a[124:127], a[252:255], v[220:223], a[124:127]
s_add_u32 s15, s61, 3
ds_read_b128 a[216:219], v2 offset:6144
ds_read_b128 a[220:223], v2 offset:7168
v_mfma_f32_16x16x32_bf16 a[92:95], a[252:255], v[216:219], a[92:95]
s_and_b32 s15, s15, 3
buffer_load_dwordx4 v1, s[36:39], s72 offen offset:1024 lds
v_mfma_f32_16x16x32_bf16 v[232:235], v[120:123], v[216:219], v[232:235]
s_add_u32 s15, s15, s78
v_exp_f32 v159, v159
v_mfma_f32_16x16x32_bf16 v[236:239], v[120:123], v[220:223], v[236:239]
s_waitcnt lgkmcnt(8)
v_cvt_pk_bf16_f32 v206, v156, v157
v_cvt_pk_bf16_f32 v207, v158, v159
s_lshl_b32 s15, s15, 18
s_add_u32 s15, s15, s94
s_cmp_eq_u32 s58, 0
s_cbranch_scc1 Lta34
s_cmp_eq_u32 s58, 1
s_cbranch_scc1 Lnt35
v_mfma_f32_16x16x32_bf16 v[140:143], a[128:131], v[64:67], v[92:95]
s_add_u32 s82, s82, 0x8000
ds_read_b128 a[160:163], v2 offset:24576
ds_read_b128 a[164:167], v2 offset:25600
v_mfma_f32_16x16x32_bf16 v[156:159], a[144:147], v[64:67], v[92:95]
s_and_b32 s82, s82, 0x1ffff
v_exp_f32 v168, v168
s_branch Ljoin36
Lta34:
v_mfma_f32_16x16x32_bf16 v[140:143], a[128:131], v[64:67], v[108:111]
s_add_u32 s82, s82, 0x8000
ds_read_b128 a[160:163], v2 offset:24576
ds_read_b128 a[164:167], v2 offset:25600
v_mfma_f32_16x16x32_bf16 v[156:159], a[144:147], v[64:67], v[112:115]
s_and_b32 s82, s82, 0x1ffff
v_exp_f32 v168, v168
s_branch Ljoin36
Lnt35:
v_mfma_f32_16x16x32_bf16 v[140:143], a[128:131], v[64:67], v[92:95]
s_add_u32 s82, s82, 0x8000
ds_read_b128 a[160:163], v2 offset:24576
ds_read_b128 a[164:167], v2 offset:25600
v_mfma_f32_16x16x32_bf16 v[156:159], a[144:147], v[64:67], v[108:111]
s_and_b32 s82, s82, 0x1ffff
v_exp_f32 v168, v168
Ljoin36:
v_mfma_f32_16x16x32_bf16 v[140:143], a[132:135], v[68:71], v[140:143]
v_exp_f32 v169, v169
v_mfma_f32_16x16x32_bf16 v[140:143], a[136:139], v[72:75], v[140:143]
ds_read_b128 a[168:171], v2 offset:26624
ds_read_b128 a[172:175], v2 offset:27648
v_mfma_f32_16x16x32_bf16 v[140:143], a[140:143], v[76:79], v[140:143]
v_exp_f32 v170, v170
v_mfma_f32_16x16x32_bf16 v[156:159], a[156:159], v[76:79], v[156:159]
v_exp_f32 v171, v171
v_mfma_f32_16x16x32_bf16 v[156:159], a[152:155], v[72:75], v[156:159]
ds_read_b128 a[176:179], v2 offset:28672
ds_read_b128 a[180:183], v2 offset:29696
v_mfma_f32_16x16x32_bf16 v[156:159], a[148:151], v[68:71], v[156:159]
s_waitcnt lgkmcnt(6)
v_exp_f32 v184, v184
v_mfma_f32_16x16x32_bf16 a[64:67], a[192:195], v[200:203], a[64:67]
ds_read_b128 a[184:187], v2 offset:30720
ds_read_b128 a[188:191], v2 offset:31744
v_mfma_f32_16x16x32_bf16 a[96:99], a[192:195], v[204:207], a[96:99]
ds_read_b128 a[224:227], v2 offset:8192
ds_read_b128 a[228:231], v2 offset:9216
v_mfma_f32_16x16x32_bf16 a[100:103], a[196:199], v[204:207], a[100:103]
ds_read_b128 a[232:235], v2 offset:10240
ds_read_b128 a[236:239], v2 offset:11264
v_mfma_f32_16x16x32_bf16 a[68:71], a[196:199], v[200:203], a[68:71]
ds_read_b128 a[240:243], v2 offset:12288
ds_read_b128 a[244:247], v2 offset:13312
v_mfma_f32_16x16x32_bf16 a[72:75], a[200:203], v[200:203], a[72:75]
ds_read_b128 a[248:251], v2 offset:14336
ds_read_b128 a[252:255], v2 offset:15360
v_mfma_f32_16x16x32_bf16 a[104:107], a[200:203], v[204:207], a[104:107]
v_cvt_pk_bf16_f32 v216, v168, v169
v_cvt_pk_bf16_f32 v217, v170, v171
v_mfma_f32_16x16x32_bf16 a[108:111], a[204:207], v[204:207], a[108:111]
buffer_load_dwordx4 v1, s[36:39], s72 offen offset:2048 lds
v_mfma_f32_16x16x32_bf16 a[76:79], a[204:207], v[200:203], a[76:79]
v_exp_f32 v185, v185
v_mfma_f32_16x16x32_bf16 a[80:83], a[208:211], v[200:203], a[80:83]
v_exp_f32 v186, v186
v_mfma_f32_16x16x32_bf16 a[112:115], a[208:211], v[204:207], a[112:115]
v_exp_f32 v187, v187
v_mfma_f32_16x16x32_bf16 a[116:119], a[212:215], v[204:207], a[116:119]
v_exp_f32 v172, v172
v_mfma_f32_16x16x32_bf16 a[84:87], a[212:215], v[200:203], a[84:87]
v_cvt_pk_bf16_f32 v218, v184, v185
v_cvt_pk_bf16_f32 v219, v186, v187
v_mfma_f32_16x16x32_bf16 a[88:91], a[216:219], v[200:203], a[88:91]
v_exp_f32 v173, v173
v_mfma_f32_16x16x32_bf16 a[120:123], a[216:219], v[204:207], a[120:123]
v_exp_f32 v174, v174
v_mfma_f32_16x16x32_bf16 a[124:127], a[220:223], v[204:207], a[124:127]
v_exp_f32 v175, v175
v_mfma_f32_16x16x32_bf16 a[92:95], a[220:223], v[200:203], a[92:95]
buffer_load_dwordx4 v1, s[36:39], s72 offen offset:3072 lds
v_mfma_f32_16x16x32_bf16 v[232:235], v[120:123], v[200:203], v[232:235]
s_waitcnt vmcnt(13) lgkmcnt(8)
v_exp_f32 v188, v188
v_mfma_f32_16x16x32_bf16 v[236:239], v[120:123], v[204:207], v[236:239]
s_barrier
v_cvt_pk_bf16_f32 v220, v172, v173
v_cvt_pk_bf16_f32 v221, v174, v175
v_add_u32 v2, s82, v1
v_exp_f32 v189, v189
v_exp_f32 v190, v190
v_cvt_pk_bf16_f32 v222, v188, v189
v_exp_f32 v191, v191
s_nop 0
v_cvt_pk_bf16_f32 v223, v190, v191
s_cmp_eq_u32 s58, 2
s_cbranch_scc1 Lta37
s_cmp_eq_u32 s58, 3
s_cbranch_scc1 Lnt38
v_mfma_f32_16x16x32_bf16 v[172:175], a[160:163], v[64:67], v[112:115]
s_add_u32 s66, s58, 2
v_exp_f32 v140, v140
v_mfma_f32_16x16x32_bf16 v[188:191], a[176:179], v[64:67], v[112:115]
s_and_b32 s66, s66, 3
ds_read_b128 a[192:195], v2 offset:0
s_branch Ljoin39
Lta37:
v_mfma_f32_16x16x32_bf16 v[172:175], a[160:163], v[64:67], v[108:111]
s_add_u32 s66, s58, 2
v_exp_f32 v140, v140
v_mfma_f32_16x16x32_bf16 v[188:191], a[176:179], v[64:67], v[112:115]
s_and_b32 s66, s66, 3
ds_read_b128 a[192:195], v2 offset:0
s_branch Ljoin39
Lnt38:
v_mfma_f32_16x16x32_bf16 v[172:175], a[160:163], v[64:67], v[92:95]
s_add_u32 s66, s58, 2
v_exp_f32 v140, v140
v_mfma_f32_16x16x32_bf16 v[188:191], a[176:179], v[64:67], v[108:111]
s_and_b32 s66, s66, 3
ds_read_b128 a[192:195], v2 offset:0
Ljoin39:
v_mfma_f32_16x16x32_bf16 v[172:175], a[164:167], v[68:71], v[172:175]
s_mul_i32 s66, s66, 4160
v_exp_f32 v141, v141
v_mfma_f32_16x16x32_bf16 v[172:175], a[168:171], v[72:75], v[172:175]
s_add_u32 s66, s66, s92
ds_read_b128 a[196:199], v2 offset:1024
v_cvt_pk_bf16_f32 v204, v140, v141
v_mfma_f32_16x16x32_bf16 v[172:175], a[172:175], v[76:79], v[172:175]
s_add_u32 m0, s66, 33312
v_exp_f32 v142, v142
v_mfma_f32_16x16x32_bf16 v[188:191], a[188:191], v[76:79], v[188:191]
s_add_u32 s72, s93, 0x4
buffer_load_dwordx4 v1, s[36:39], s72 offen lds
v_mfma_f32_16x16x32_bf16 v[188:191], a[184:187], v[72:75], v[188:191]
buffer_load_dwordx4 v1, s[36:39], s72 offen offset:1024 lds
v_mfma_f32_16x16x32_bf16 v[188:191], a[180:183], v[68:71], v[188:191]
s_waitcnt lgkmcnt(2)
ds_read_b128 a[200:203], v2 offset:2048
v_mfma_f32_16x16x32_bf16 a[64:67], a[224:227], v[216:219], a[64:67]
buffer_load_dwordx4 v1, s[36:39], s72 offen offset:2048 lds
v_mfma_f32_16x16x32_bf16 a[96:99], a[224:227], v[220:223], a[96:99]
v_exp_f32 v143, v143
v_mfma_f32_16x16x32_bf16 a[100:103], a[228:231], v[220:223], a[100:103]
ds_read_b128 a[204:207], v2 offset:3072
v_cvt_pk_bf16_f32 v205, v142, v143
v_mfma_f32_16x16x32_bf16 a[68:71], a[228:231], v[216:219], a[68:71]
buffer_load_dwordx4 v1, s[36:39], s72 offen offset:3072 lds
v_mfma_f32_16x16x32_bf16 a[72:75], a[232:235], v[216:219], a[72:75]
v_exp_f32 v156, v156
v_mfma_f32_16x16x32_bf16 a[104:107], a[232:235], v[220:223], a[104:107]
ds_read_b128 a[208:211], v2 offset:4096
v_mfma_f32_16x16x32_bf16 a[108:111], a[236:239], v[220:223], a[108:111]
buffer_load_dwordx4 v[80:83], v15, s[4:7], s80 offen
v_mfma_f32_16x16x32_bf16 a[76:79], a[236:239], v[216:219], a[76:79]
s_add_u32 s80, s80, 0x4000
v_exp_f32 v157, v157
v_mfma_f32_16x16x32_bf16 a[80:83], a[240:243], v[216:219], a[80:83]
ds_read_b128 a[212:215], v2 offset:5120
v_cvt_pk_bf16_f32 v206, v156, v157
v_mfma_f32_16x16x32_bf16 a[112:115], a[240:243], v[220:223], a[112:115]
buffer_load_dwordx4 v[84:87], v15, s[4:7], s80 offen
v_mfma_f32_16x16x32_bf16 a[116:119], a[244:247], v[220:223], a[116:119]
s_add_u32 s80, s80, 0x4000
v_exp_f32 v158, v158
v_mfma_f32_16x16x32_bf16 a[84:87], a[244:247], v[216:219], a[84:87]
ds_read_b128 a[216:219], v2 offset:6144
v_mfma_f32_16x16x32_bf16 a[88:91], a[248:251], v[216:219], a[88:91]
buffer_load_dwordx4 v[96:99], v15, s[4:7], s80 offen
v_mfma_f32_16x16x32_bf16 a[120:123], a[248:251], v[220:223], a[120:123]
s_add_u32 s80, s80, 0x4000
v_exp_f32 v159, v159
v_mfma_f32_16x16x32_bf16 a[124:127], a[252:255], v[220:223], a[124:127]
ds_read_b128 a[220:223], v2 offset:7168
v_cvt_pk_bf16_f32 v207, v158, v159
v_mfma_f32_16x16x32_bf16 a[92:95], a[252:255], v[216:219], a[92:95]
buffer_load_dwordx4 v[100:103], v15, s[4:7], s80 offen
v_mfma_f32_16x16x32_bf16 v[232:235], v[120:123], v[216:219], v[232:235]
v_mfma_f32_16x16x32_bf16 v[236:239], v[120:123], v[220:223], v[236:239]
s_waitcnt lgkmcnt(0)
v_mfma_f32_16x16x32_bf16 a[96:99], a[192:195], v[204:207], a[96:99]
s_add_u32 s82, s82, 0x8000
ds_read_b128 a[224:227], v2 offset:8192
ds_read_b128 a[228:231], v2 offset:9216
v_mfma_f32_16x16x32_bf16 a[100:103], a[196:199], v[204:207], a[100:103]
s_and_b32 s82, s82, 0x1ffff
v_exp_f32 v172, v172
v_mfma_f32_16x16x32_bf16 a[104:107], a[200:203], v[204:207], a[104:107]
v_exp_f32 v173, v173
v_mfma_f32_16x16x32_bf16 a[108:111], a[204:207], v[204:207], a[108:111]
ds_read_b128 a[232:235], v2 offset:10240
ds_read_b128 a[236:239], v2 offset:11264
v_mfma_f32_16x16x32_bf16 a[112:115], a[208:211], v[204:207], a[112:115]
v_exp_f32 v174, v174
v_mfma_f32_16x16x32_bf16 a[116:119], a[212:215], v[204:207], a[116:119]
ds_read_b128 a[240:243], v2 offset:12288
ds_read_b128 a[244:247], v2 offset:13312
v_mfma_f32_16x16x32_bf16 a[120:123], a[216:219], v[204:207], a[120:123]
ds_read_b128 a[248:251], v2 offset:14336
ds_read_b128 a[252:255], v2 offset:15360
v_mfma_f32_16x16x32_bf16 a[124:127], a[220:223], v[204:207], a[124:127]
s_waitcnt vmcnt(4) lgkmcnt(0)
v_exp_f32 v175, v175
v_mfma_f32_16x16x32_bf16 v[236:239], v[120:123], v[204:207], v[236:239]
s_barrier
v_exp_f32 v188, v188
v_add_u32 v2, s82, v1
v_cvt_pk_bf16_f32 v220, v172, v173
v_cvt_pk_bf16_f32 v221, v174, v175
v_exp_f32 v189, v189
v_exp_f32 v190, v190
v_cvt_pk_bf16_f32 v222, v188, v189
v_exp_f32 v191, v191
s_nop 0
v_cvt_pk_bf16_f32 v223, v190, v191
LHT4:
Lstub7:
s_cbranch_execz Lstub11
s_nop 1
v_mfma_f32_16x16x32_bf16 a[96:99], a[224:227], v[220:223], a[96:99]
ds_write_b64 v5, v[12:13]
v_mov_b32 v240, 0
v_mfma_f32_16x16x32_bf16 a[100:103], a[228:231], v[220:223], a[100:103]
s_lshl_b32 s73, s59, 12
v_mov_b32 v241, 0
v_mfma_f32_16x16x32_bf16 a[104:107], a[232:235], v[220:223], a[104:107]
s_add_u32 s73, s73, 0x2000000
ds_write_b64 v14, v[240:241]
ds_read_b128 a[192:195], v7 offset:3584
v_mfma_f32_16x16x32_bf16 a[108:111], a[236:239], v[220:223], a[108:111]
s_lshl_b32 s70, s68, 2
ds_read_b64 a[128:129], v6 offset:0
ds_read_b64 a[130:131], v6 offset:8
v_mfma_f32_16x16x32_bf16 a[112:115], a[240:243], v[220:223], a[112:115]
s_add_u32 s70, s70, s73
ds_read_b128 a[196:199], v7 offset:3072
ds_read_b64 a[132:133], v6 offset:512
v_mfma_f32_16x16x32_bf16 a[116:119], a[244:247], v[220:223], a[116:119]
ds_read_b64 a[134:135], v6 offset:520
ds_read_b128 a[200:203], v7 offset:2560
v_mfma_f32_16x16x32_bf16 a[120:123], a[248:251], v[220:223], a[120:123]
ds_read_b64 a[136:137], v6 offset:1024
ds_read_b64 a[138:139], v6 offset:1032
v_mfma_f32_16x16x32_bf16 a[124:127], a[252:255], v[220:223], a[124:127]
s_xor_b32 s71, s12, 0x80
ds_read_b128 a[204:207], v7 offset:2048
ds_read_b64 a[140:141], v6 offset:1536
v_mfma_f32_16x16x32_bf16 v[236:239], v[120:123], v[220:223], v[236:239]
s_add_u32 m0, s77, 0
ds_read_b64 a[142:143], v6 offset:1544
ds_read_b128 a[208:211], v7 offset:1536
ds_read_b64 a[144:145], v6 offset:2048
ds_read_b64 a[146:147], v6 offset:2056
ds_read_b128 a[212:215], v7 offset:1024
ds_read_b64 a[148:149], v6 offset:2560
ds_read_b64 a[150:151], v6 offset:2568
ds_read_b128 a[216:219], v7 offset:512
ds_read_b64 a[152:153], v6 offset:3072
ds_read_b64 a[154:155], v6 offset:3080
ds_read_b128 a[220:223], v7 offset:0
ds_read_b64 a[156:157], v6 offset:3584
ds_read_b64 a[158:159], v6 offset:3592
s_waitcnt lgkmcnt(0)
v_mfma_f32_16x16x32_bf16 v[128:131], v[8:11], a[192:195], 0
s_add_u32 s72, s71, 0
buffer_load_dwordx4 v15, s[24:27], s72 offen lds
v_mfma_f32_16x16x32_bf16 v[128:131], a[128:131], a[192:195], v[128:131]
v_mfma_f32_16x16x32_bf16 v[132:135], v[8:11], a[196:199], 0
ds_read_b128 a[224:227], v7 offset:3648
ds_read_b64 a[160:161], v6 offset:64
v_mfma_f32_16x16x32_bf16 v[132:135], a[128:131], a[196:199], v[132:135]
v_accvgpr_read_b32 v240, a64
v_accvgpr_read_b32 v241, a65
v_accvgpr_read_b32 v242, a66
v_mfma_f32_16x16x32_bf16 v[132:135], a[132:135], a[192:195], v[132:135]
s_add_u32 s72, s71, 15360
buffer_load_dwordx4 v15, s[24:27], s72 offen offset:1024 lds
v_accvgpr_read_b32 v243, a67
v_mfma_f32_16x16x32_bf16 v[136:139], v[8:11], a[200:203], 0
ds_read_b64 a[162:163], v6 offset:72
ds_read_b128 a[228:231], v7 offset:3136
v_mfma_f32_16x16x32_bf16 v[136:139], a[128:131], a[200:203], v[136:139]
v_rcp_f32 v232, v232
v_mfma_f32_16x16x32_bf16 v[136:139], a[132:135], a[196:199], v[136:139]
v_rcp_f32 v236, v236
v_accvgpr_read_b32 v244, a68
v_mfma_f32_16x16x32_bf16 v[136:139], a[136:139], a[192:195], v[136:139]
ds_read_b64 a[164:165], v6 offset:576
ds_read_b64 a[166:167], v6 offset:584
v_accvgpr_read_b32 v245, a69
v_mfma_f32_16x16x32_bf16 v[140:143], v[8:11], a[204:207], 0
s_add_u32 s72, s71, 30720
buffer_load_dwordx4 v15, s[24:27], s72 offen offset:2048 lds
v_accvgpr_read_b32 v246, a70
v_mfma_f32_16x16x32_bf16 v[140:143], a[128:131], a[204:207], v[140:143]
v_accvgpr_read_b32 v247, a71
v_mul_f32 v240, v240, v232
v_mul_f32 v241, v241, v232
v_mfma_f32_16x16x32_bf16 v[140:143], a[132:135], a[200:203], v[140:143]
ds_read_b128 a[232:235], v7 offset:2624
ds_read_b64 a[168:169], v6 offset:1088
v_mul_f32 v242, v242, v232
v_mfma_f32_16x16x32_bf16 v[140:143], a[136:139], a[196:199], v[140:143]
s_add_u32 s72, s71, 46080
buffer_load_dwordx4 v15, s[24:27], s72 offen offset:3072 lds
v_mul_f32 v243, v243, v232
v_mfma_f32_16x16x32_bf16 v[140:143], a[140:143], a[192:195], v[140:143]
v_mul_f32 v244, v244, v232
v_mul_f32 v245, v245, v232
v_mul_f32 v246, v246, v232
v_mfma_f32_16x16x32_bf16 v[144:147], v[8:11], a[208:211], 0
ds_read_b64 a[170:171], v6 offset:1096
ds_read_b128 a[236:239], v7 offset:2112
v_mul_f32 v247, v247, v232
v_mfma_f32_16x16x32_bf16 v[144:147], a[128:131], a[208:211], v[144:147]
s_lshl_b32 s95, s75, 20
v_cvt_pk_bf16_f32 v240, v240, v241
v_cvt_pk_bf16_f32 v241, v242, v243
v_cvt_pk_bf16_f32 v242, v244, v245
v_mfma_f32_16x16x32_bf16 v[144:147], a[132:135], a[204:207], v[144:147]
s_lshl_b32 s74, s58, 18
v_cvt_pk_bf16_f32 v243, v246, v247
v_mfma_f32_16x16x32_bf16 v[144:147], a[136:139], a[200:203], v[144:147]
s_add_u32 s95, s95, s74
ds_read_b64 a[172:173], v6 offset:1600
ds_read_b64 a[174:175], v6 offset:1608
v_mfma_f32_16x16x32_bf16 v[144:147], a[140:143], a[196:199], v[144:147]
s_add_u32 s95, s95, 0x2000000
buffer_store_dwordx4 v[240:243], v1, s[44:47], s70 offen sc1
v_mfma_f32_16x16x32_bf16 v[144:147], a[144:147], a[192:195], v[144:147]
s_sub_u32 s74, 15, s75
v_accvgpr_read_b32 v248, a72
v_accvgpr_read_b32 v249, a73
v_accvgpr_read_b32 v250, a74
v_mfma_f32_16x16x32_bf16 v[148:151], v[8:11], a[212:215], 0
s_min_u32 s74, s74, s75
ds_read_b128 a[240:243], v7 offset:1600
ds_read_b64 a[176:177], v6 offset:2112
v_accvgpr_read_b32 v251, a75
v_mfma_f32_16x16x32_bf16 v[148:151], a[128:131], a[212:215], v[148:151]
s_lshl_b32 s74, s74, 7
v_accvgpr_read_b32 v252, a76
v_accvgpr_read_b32 v253, a77
v_accvgpr_read_b32 v254, a78
v_mfma_f32_16x16x32_bf16 v[148:151], a[132:135], a[208:211], v[148:151]
s_add_u32 s74, s74, 0x3810000
v_accvgpr_read_b32 v255, a79
v_mul_f32 v248, v248, v232
v_mul_f32 v249, v249, v232
v_mfma_f32_16x16x32_bf16 v[148:151], a[136:139], a[204:207], v[148:151]
s_xor_b32 s85, s77, 0x10000
ds_read_b64 a[178:179], v6 offset:2120
ds_read_b128 a[244:247], v7 offset:1088
v_mul_f32 v250, v250, v232
v_mfma_f32_16x16x32_bf16 v[148:151], a[140:143], a[200:203], v[148:151]
v_mul_f32 v251, v251, v232
v_mul_f32 v252, v252, v232
v_mul_f32 v253, v253, v232
v_mfma_f32_16x16x32_bf16 v[148:151], a[144:147], a[196:199], v[148:151]
v_mul_f32 v254, v254, v232
v_mul_f32 v255, v255, v232
v_cvt_pk_bf16_f32 v248, v248, v249
v_mfma_f32_16x16x32_bf16 v[148:151], a[148:151], a[192:195], v[148:151]
ds_read_b64 a[180:181], v6 offset:2624
ds_read_b64 a[182:183], v6 offset:2632
v_cvt_pk_bf16_f32 v249, v250, v251
v_mfma_f32_16x16x32_bf16 v[152:155], v[8:11], a[216:219], 0
v_cvt_pk_bf16_f32 v250, v252, v253
v_cvt_pk_bf16_f32 v251, v254, v255
v_mfma_f32_16x16x32_bf16 v[152:155], a[128:131], a[216:219], v[152:155]
buffer_store_dwordx4 v[248:251], v1, s[44:47], s70 offen offset:1024 sc1
v_mfma_f32_16x16x32_bf16 v[152:155], a[132:135], a[212:215], v[152:155]
ds_read_b128 a[248:251], v7 offset:576
ds_read_b64 a[184:185], v6 offset:3136
v_accvgpr_read_b32 v240, a80
v_mfma_f32_16x16x32_bf16 v[152:155], a[136:139], a[208:211], v[152:155]
v_accvgpr_read_b32 v241, a81
v_accvgpr_read_b32 v242, a82
v_accvgpr_read_b32 v243, a83
v_mfma_f32_16x16x32_bf16 v[152:155], a[140:143], a[204:207], v[152:155]
v_accvgpr_read_b32 v244, a84
v_accvgpr_read_b32 v245, a85
v_accvgpr_read_b32 v246, a86
v_mfma_f32_16x16x32_bf16 v[152:155], a[144:147], a[200:203], v[152:155]
ds_read_b64 a[186:187], v6 offset:3144
ds_read_b128 a[252:255], v7 offset:64
v_accvgpr_read_b32 v247, a87
v_mfma_f32_16x16x32_bf16 v[152:155], a[148:151], a[196:199], v[152:155]
v_mul_f32 v240, v240, v232
v_mul_f32 v241, v241, v232
v_mul_f32 v242, v242, v232
v_mfma_f32_16x16x32_bf16 v[152:155], a[152:155], a[192:195], v[152:155]
v_mul_f32 v243, v243, v232
v_mul_f32 v244, v244, v232
v_mul_f32 v245, v245, v232
v_mfma_f32_16x16x32_bf16 v[156:159], v[8:11], a[220:223], 0
ds_read_b64 a[188:189], v6 offset:3648
ds_read_b64 a[190:191], v6 offset:3656
v_mul_f32 v246, v246, v232
v_mfma_f32_16x16x32_bf16 v[156:159], a[128:131], a[220:223], v[156:159]
v_mul_f32 v247, v247, v232
v_cvt_pk_bf16_f32 v240, v240, v241
v_cvt_pk_bf16_f32 v241, v242, v243
v_mfma_f32_16x16x32_bf16 v[156:159], a[132:135], a[216:219], v[156:159]
v_cvt_pk_bf16_f32 v242, v244, v245
v_cvt_pk_bf16_f32 v243, v246, v247
v_mfma_f32_16x16x32_bf16 v[156:159], a[136:139], a[212:215], v[156:159]
buffer_store_dwordx4 v[240:243], v1, s[44:47], s70 offen offset:2048 sc1
v_mfma_f32_16x16x32_bf16 v[156:159], a[140:143], a[208:211], v[156:159]
v_accvgpr_read_b32 v248, a88
v_accvgpr_read_b32 v249, a89
v_accvgpr_read_b32 v250, a90
v_mfma_f32_16x16x32_bf16 v[156:159], a[144:147], a[204:207], v[156:159]
v_accvgpr_read_b32 v251, a91
v_accvgpr_read_b32 v252, a92
v_accvgpr_read_b32 v253, a93
v_mfma_f32_16x16x32_bf16 v[156:159], a[148:151], a[200:203], v[156:159]
v_accvgpr_read_b32 v254, a94
v_accvgpr_read_b32 v255, a95
v_mul_f32 v248, v248, v232
v_mfma_f32_16x16x32_bf16 v[156:159], a[152:155], a[196:199], v[156:159]
v_mul_f32 v249, v249, v232
v_mul_f32 v250, v250, v232
v_mul_f32 v251, v251, v232
v_mfma_f32_16x16x32_bf16 v[156:159], a[156:159], a[192:195], v[156:159]
s_waitcnt lgkmcnt(0)
v_mul_f32 v252, v252, v232
v_mul_f32 v253, v253, v232
v_mul_f32 v254, v254, v232
v_mfma_f32_16x16x32_bf16 v[128:131], a[160:163], a[224:227], v[128:131]
ds_read_b128 a[192:195], v7 offset:3712
ds_read_b64 a[128:129], v6 offset:128
v_mul_f32 v255, v255, v232
v_mfma_f32_16x16x32_bf16 v[132:135], a[164:167], a[224:227], v[132:135]
v_cvt_pk_bf16_f32 v248, v248, v249
v_cvt_pk_bf16_f32 v249, v250, v251
v_cvt_pk_bf16_f32 v250, v252, v253
v_mfma_f32_16x16x32_bf16 v[132:135], a[160:163], a[228:231], v[132:135]
ds_read_b64 a[130:131], v6 offset:136
ds_read_b128 a[196:199], v7 offset:3200
v_cvt_pk_bf16_f32 v251, v254, v255
v_mfma_f32_16x16x32_bf16 v[136:139], a[160:163], a[232:235], v[136:139]
buffer_store_dwordx4 v[248:251], v1, s[44:47], s70 offen offset:3072 sc1
v_mfma_f32_16x16x32_bf16 v[136:139], a[164:167], a[228:231], v[136:139]
s_add_u32 s70, s70, 0x80000
v_accvgpr_read_b32 v240, a96
v_accvgpr_read_b32 v241, a97
v_accvgpr_read_b32 v242, a98
v_mfma_f32_16x16x32_bf16 v[136:139], a[168:171], a[224:227], v[136:139]
ds_read_b64 a[132:133], v6 offset:640
ds_read_b64 a[134:135], v6 offset:648
v_accvgpr_read_b32 v243, a99
v_mfma_f32_16x16x32_bf16 v[140:143], a[172:175], a[224:227], v[140:143]
v_accvgpr_read_b32 v244, a100
v_accvgpr_read_b32 v245, a101
v_accvgpr_read_b32 v246, a102
v_mfma_f32_16x16x32_bf16 v[140:143], a[168:171], a[228:231], v[140:143]
ds_read_b128 a[200:203], v7 offset:2688
ds_read_b64 a[136:137], v6 offset:1152
v_accvgpr_read_b32 v247, a103
v_mfma_f32_16x16x32_bf16 v[140:143], a[164:167], a[232:235], v[140:143]
v_mul_f32 v240, v240, v236
v_mul_f32 v241, v241, v236
v_mul_f32 v242, v242, v236
v_mfma_f32_16x16x32_bf16 v[140:143], a[160:163], a[236:239], v[140:143]
v_mul_f32 v243, v243, v236
v_mul_f32 v244, v244, v236
v_mul_f32 v245, v245, v236
v_mfma_f32_16x16x32_bf16 v[144:147], a[160:163], a[240:243], v[144:147]
ds_read_b64 a[138:139], v6 offset:1160
ds_read_b128 a[204:207], v7 offset:2176
v_mul_f32 v246, v246, v236
v_mfma_f32_16x16x32_bf16 v[144:147], a[164:167], a[236:239], v[144:147]
v_mul_f32 v247, v247, v236
v_cvt_pk_bf16_f32 v240, v240, v241
v_cvt_pk_bf16_f32 v241, v242, v243
v_mfma_f32_16x16x32_bf16 v[144:147], a[168:171], a[232:235], v[144:147]
ds_read_b64 a[140:141], v6 offset:1664
ds_read_b64 a[142:143], v6 offset:1672
v_cvt_pk_bf16_f32 v242, v244, v245
v_mfma_f32_16x16x32_bf16 v[144:147], a[172:175], a[228:231], v[144:147]
v_cvt_pk_bf16_f32 v243, v246, v247
v_mfma_f32_16x16x32_bf16 v[144:147], a[176:179], a[224:227], v[144:147]
buffer_store_dwordx4 v[240:243], v1, s[44:47], s70 offen sc1
v_mfma_f32_16x16x32_bf16 v[148:151], a[180:183], a[224:227], v[148:151]
ds_read_b128 a[208:211], v7 offset:1664
ds_read_b64 a[144:145], v6 offset:2176
v_accvgpr_read_b32 v248, a104
v_mfma_f32_16x16x32_bf16 v[148:151], a[176:179], a[228:231], v[148:151]
v_accvgpr_read_b32 v249, a105
v_accvgpr_read_b32 v250, a106
v_accvgpr_read_b32 v251, a107
v_mfma_f32_16x16x32_bf16 v[148:151], a[172:175], a[232:235], v[148:151]
v_accvgpr_read_b32 v252, a108
v_accvgpr_read_b32 v253, a109
v_accvgpr_read_b32 v254, a110
v_mfma_f32_16x16x32_bf16 v[148:151], a[168:171], a[236:239], v[148:151]
ds_read_b64 a[146:147], v6 offset:2184
ds_read_b128 a[212:215], v7 offset:1152
v_accvgpr_read_b32 v255, a111
v_mfma_f32_16x16x32_bf16 v[148:151], a[164:167], a[240:243], v[148:151]
Lstub8:
s_cbranch_execz Lret
v_mul_f32 v248, v248, v236
v_mul_f32 v249, v249, v236
v_mul_f32 v250, v250, v236
v_mfma_f32_16x16x32_bf16 v[148:151], a[160:163], a[244:247], v[148:151]
ds_read_b64 a[148:149], v6 offset:2688
ds_read_b64 a[150:151], v6 offset:2696
v_mul_f32 v251, v251, v236
v_mfma_f32_16x16x32_bf16 v[152:155], a[160:163], a[248:251], v[152:155]
v_mul_f32 v252, v252, v236
v_mul_f32 v253, v253, v236
v_mul_f32 v254, v254, v236
v_mfma_f32_16x16x32_bf16 v[152:155], a[164:167], a[244:247], v[152:155]
v_mul_f32 v255, v255, v236
v_cvt_pk_bf16_f32 v248, v248, v249
v_cvt_pk_bf16_f32 v249, v250, v251
v_mfma_f32_16x16x32_bf16 v[152:155], a[168:171], a[240:243], v[152:155]
ds_read_b128 a[216:219], v7 offset:640
ds_read_b64 a[152:153], v6 offset:3200
v_cvt_pk_bf16_f32 v250, v252, v253
v_mfma_f32_16x16x32_bf16 v[152:155], a[172:175], a[236:239], v[152:155]
v_cvt_pk_bf16_f32 v251, v254, v255
v_mfma_f32_16x16x32_bf16 v[152:155], a[176:179], a[232:235], v[152:155]
ds_read_b64 a[154:155], v6 offset:3208
ds_read_b128 a[220:223], v7 offset:128
v_mfma_f32_16x16x32_bf16 v[152:155], a[180:183], a[228:231], v[152:155]
buffer_store_dwordx4 v[248:251], v1, s[44:47], s70 offen offset:1024 sc1
v_mfma_f32_16x16x32_bf16 v[152:155], a[184:187], a[224:227], v[152:155]
v_accvgpr_read_b32 v240, a112
v_accvgpr_read_b32 v241, a113
v_accvgpr_read_b32 v242, a114
v_mfma_f32_16x16x32_bf16 v[156:159], a[188:191], a[224:227], v[156:159]
ds_read_b64 a[156:157], v6 offset:3712
ds_read_b64 a[158:159], v6 offset:3720
v_accvgpr_read_b32 v243, a115
v_mfma_f32_16x16x32_bf16 v[156:159], a[184:187], a[228:231], v[156:159]
v_accvgpr_read_b32 v244, a116
v_accvgpr_read_b32 v245, a117
v_accvgpr_read_b32 v246, a118
v_mfma_f32_16x16x32_bf16 v[156:159], a[180:183], a[232:235], v[156:159]
v_accvgpr_read_b32 v247, a119
v_mul_f32 v240, v240, v236
v_mul_f32 v241, v241, v236
v_mfma_f32_16x16x32_bf16 v[156:159], a[176:179], a[236:239], v[156:159]
v_mul_f32 v242, v242, v236
v_mul_f32 v243, v243, v236
v_mul_f32 v244, v244, v236
v_mfma_f32_16x16x32_bf16 v[156:159], a[172:175], a[240:243], v[156:159]
v_mul_f32 v245, v245, v236
v_mul_f32 v246, v246, v236
v_mul_f32 v247, v247, v236
v_mfma_f32_16x16x32_bf16 v[156:159], a[168:171], a[244:247], v[156:159]
v_cvt_pk_bf16_f32 v240, v240, v241
v_cvt_pk_bf16_f32 v241, v242, v243
v_cvt_pk_bf16_f32 v242, v244, v245
v_mfma_f32_16x16x32_bf16 v[156:159], a[164:167], a[248:251], v[156:159]
v_cvt_pk_bf16_f32 v243, v246, v247
v_mfma_f32_16x16x32_bf16 v[156:159], a[160:163], a[252:255], v[156:159]
s_waitcnt lgkmcnt(0)
buffer_store_dwordx4 v[240:243], v1, s[44:47], s70 offen offset:2048 sc1
v_mfma_f32_16x16x32_bf16 v[128:131], a[128:131], a[192:195], v[128:131]
ds_read_b128 a[224:227], v7 offset:3776
ds_read_b64 a[160:161], v6 offset:192
v_accvgpr_read_b32 v248, a120
v_mfma_f32_16x16x32_bf16 v[132:135], a[132:135], a[192:195], v[132:135]
v_accvgpr_read_b32 v249, a121
v_accvgpr_read_b32 v250, a122
v_accvgpr_read_b32 v251, a123
v_mfma_f32_16x16x32_bf16 v[132:135], a[128:131], a[196:199], v[132:135]
ds_read_b64 a[162:163], v6 offset:200
ds_read_b128 a[228:231], v7 offset:3264
v_accvgpr_read_b32 v252, a124
v_mfma_f32_16x16x32_bf16 v[136:139], a[128:131], a[200:203], v[136:139]
v_accvgpr_read_b32 v253, a125
v_accvgpr_read_b32 v254, a126
v_accvgpr_read_b32 v255, a127
v_mfma_f32_16x16x32_bf16 v[136:139], a[132:135], a[196:199], v[136:139]
v_mul_f32 v248, v248, v236
v_mul_f32 v249, v249, v236
v_mul_f32 v250, v250, v236
v_mfma_f32_16x16x32_bf16 v[136:139], a[136:139], a[192:195], v[136:139]
ds_read_b64 a[164:165], v6 offset:704
ds_read_b64 a[166:167], v6 offset:712
v_mul_f32 v251, v251, v236
v_mfma_f32_16x16x32_bf16 v[140:143], a[140:143], a[192:195], v[140:143]
v_mul_f32 v252, v252, v236
v_mul_f32 v253, v253, v236
v_mul_f32 v254, v254, v236
v_mfma_f32_16x16x32_bf16 v[140:143], a[136:139], a[196:199], v[140:143]
ds_read_b128 a[232:235], v7 offset:2752
ds_read_b64 a[168:169], v6 offset:1216
v_mul_f32 v255, v255, v236
v_mfma_f32_16x16x32_bf16 v[140:143], a[132:135], a[200:203], v[140:143]
v_cvt_pk_bf16_f32 v248, v248, v249
v_cvt_pk_bf16_f32 v249, v250, v251
v_cvt_pk_bf16_f32 v250, v252, v253
v_mfma_f32_16x16x32_bf16 v[140:143], a[128:131], a[204:207], v[140:143]
v_cvt_pk_bf16_f32 v251, v254, v255
v_mfma_f32_16x16x32_bf16 v[144:147], a[128:131], a[208:211], v[144:147]
ds_read_b64 a[170:171], v6 offset:1224
ds_read_b128 a[236:239], v7 offset:2240
v_mfma_f32_16x16x32_bf16 v[144:147], a[132:135], a[204:207], v[144:147]
buffer_store_dwordx4 v[248:251], v1, s[44:47], s70 offen offset:3072 sc1
v_mfma_f32_16x16x32_bf16 v[144:147], a[136:139], a[200:203], v[144:147]
s_mov_b32 s73, 0x5d800000
ds_read_b64 a[172:173], v6 offset:1728
ds_read_b64 a[174:175], v6 offset:1736
v_add_f32 v227, v226, v230
v_mfma_f32_16x16x32_bf16 v[144:147], a[140:143], a[196:199], v[144:147]
v_add_f32 v231, v234, v238
v_add_f32 v227, v227, v231
v_cmp_nlt_f32 vcc, v227, s73
v_mfma_f32_16x16x32_bf16 v[144:147], a[144:147], a[192:195], v[144:147]
s_lshl_b32 s73, s58, 2
v_mfma_f32_16x16x32_bf16 v[148:151], a[148:151], a[192:195], v[148:151]
s_add_u32 s73, s73, 163328
ds_read_b128 a[240:243], v7 offset:1728
ds_read_b64 a[176:177], v6 offset:2240
v_mov_b32 v231, s73
v_mfma_f32_16x16x32_bf16 v[148:151], a[144:147], a[196:199], v[148:151]
s_or_b32 s73, vcc_lo, vcc_hi
v_mfma_f32_16x16x32_bf16 v[148:151], a[140:143], a[200:203], v[148:151]
s_min_u32 s73, s73, 1
v_mov_b32 v227, s73
v_mfma_f32_16x16x32_bf16 v[148:151], a[136:139], a[204:207], v[148:151]
ds_read_b64 a[178:179], v6 offset:2248
ds_read_b128 a[244:247], v7 offset:1216
ds_write_b32 v231, v227
v_mfma_f32_16x16x32_bf16 v[148:151], a[132:135], a[208:211], v[148:151]
v_mfma_f32_16x16x32_bf16 v[148:151], a[128:131], a[212:215], v[148:151]
ds_read_b64 a[180:181], v6 offset:2752
ds_read_b64 a[182:183], v6 offset:2760
v_mfma_f32_16x16x32_bf16 v[152:155], a[128:131], a[216:219], v[152:155]
v_mfma_f32_16x16x32_bf16 v[152:155], a[132:135], a[212:215], v[152:155]
v_mfma_f32_16x16x32_bf16 v[152:155], a[136:139], a[208:211], v[152:155]
ds_read_b128 a[248:251], v7 offset:704
ds_read_b64 a[184:185], v6 offset:3264
v_mfma_f32_16x16x32_bf16 v[152:155], a[140:143], a[204:207], v[152:155]
v_mfma_f32_16x16x32_bf16 v[152:155], a[144:147], a[200:203], v[152:155]
s_xor_b32 s71, s12, 0x100
ds_read_b64 a[186:187], v6 offset:3272
ds_read_b128 a[252:255], v7 offset:192
v_mfma_f32_16x16x32_bf16 v[152:155], a[148:151], a[196:199], v[152:155]
s_add_u32 m0, s77, 16384
v_mfma_f32_16x16x32_bf16 v[152:155], a[152:155], a[192:195], v[152:155]
s_add_u32 s72, s71, 0
buffer_load_dwordx4 v15, s[24:27], s72 offen lds
v_mfma_f32_16x16x32_bf16 v[156:159], a[156:159], a[192:195], v[156:159]
ds_read_b64 a[188:189], v6 offset:3776
ds_read_b64 a[190:191], v6 offset:3784
v_mfma_f32_16x16x32_bf16 v[156:159], a[152:155], a[196:199], v[156:159]
v_mfma_f32_16x16x32_bf16 v[156:159], a[148:151], a[200:203], v[156:159]
s_add_u32 s72, s71, 15360
buffer_load_dwordx4 v15, s[24:27], s72 offen offset:1024 lds
v_mfma_f32_16x16x32_bf16 v[156:159], a[144:147], a[204:207], v[156:159]
v_mfma_f32_16x16x32_bf16 v[156:159], a[140:143], a[208:211], v[156:159]
v_mfma_f32_16x16x32_bf16 v[156:159], a[136:139], a[212:215], v[156:159]
v_mfma_f32_16x16x32_bf16 v[156:159], a[132:135], a[216:219], v[156:159]
v_mfma_f32_16x16x32_bf16 v[156:159], a[128:131], a[220:223], v[156:159]
s_waitcnt lgkmcnt(0)
v_mfma_f32_16x16x32_bf16 v[128:131], a[160:163], a[224:227], v[128:131]
s_add_u32 s72, s71, 30720
ds_read_b128 a[192:195], v7 offset:3840
ds_read_b64 a[128:129], v6 offset:256
s_nop 3
s_mov_b64 exec, 0
s_cmp_eq_u32 s58, 0
s_cbranch_scc1 Lstube0
s_cmp_eq_u32 s58, 1
s_cbranch_scc1 Lstube1
s_cmp_eq_u32 s58, 2
s_cbranch_scc1 Lstube2
s_branch Lstube3
Lrete:
s_mov_b64 exec, -1
s_nop 3
v_mfma_f32_16x16x32_bf16 v[132:135], a[164:167], a[224:227], v[132:135]
s_waitcnt vmcnt(2) lgkmcnt(10)
buffer_load_dwordx4 v15, s[24:27], s72 offen offset:2048 lds
v_mfma_f32_16x16x32_bf16 v[132:135], a[160:163], a[228:231], v[132:135]
s_barrier
ds_read_b64 a[130:131], v6 offset:264
ds_read_b128 a[196:199], v7 offset:3328
v_mfma_f32_16x16x32_bf16 v[136:139], a[160:163], a[232:235], v[136:139]
v_mov_b32 v244, 163328
v_mfma_f32_16x16x32_bf16 v[136:139], a[164:167], a[228:231], v[136:139]
ds_read_b128 v[240:243], v244
v_mfma_f32_16x16x32_bf16 v[136:139], a[168:171], a[224:227], v[136:139]
ds_read_b64 a[132:133], v6 offset:768
ds_read_b64 a[134:135], v6 offset:776
v_mfma_f32_16x16x32_bf16 v[140:143], a[172:175], a[224:227], v[140:143]
s_add_u32 s72, s71, 46080
buffer_load_dwordx4 v15, s[24:27], s72 offen offset:3072 lds
v_mfma_f32_16x16x32_bf16 v[140:143], a[168:171], a[228:231], v[140:143]
ds_read_b128 a[200:203], v7 offset:2816
ds_read_b64 a[136:137], v6 offset:1280
v_mfma_f32_16x16x32_bf16 v[140:143], a[164:167], a[232:235], v[140:143]
v_mfma_f32_16x16x32_bf16 v[140:143], a[160:163], a[236:239], v[140:143]
s_waitcnt lgkmcnt(4)
v_or3_b32 v240, v240, v241, v242
v_or_b32 v240, v240, v243
v_mfma_f32_16x16x32_bf16 v[144:147], a[160:163], a[240:243], v[144:147]
ds_read_b64 a[138:139], v6 offset:1288
ds_read_b128 a[204:207], v7 offset:2304
v_cmp_lt_u32 vcc, s86, v240
s_cbranch_vccnz Lslow
v_mfma_f32_16x16x32_bf16 v[144:147], a[164:167], a[236:239], v[144:147]
v_or_b32 v240, s58, v0
v_mov_b32 v241, 2
v_mfma_f32_16x16x32_bf16 v[144:147], a[168:171], a[232:235], v[144:147]
s_xor_b32 s71, s12, 0x180
ds_read_b64 a[140:141], v6 offset:1792
ds_read_b64 a[142:143], v6 offset:1800
v_mfma_f32_16x16x32_bf16 v[144:147], a[172:175], a[228:231], v[144:147]
s_add_u32 m0, s77, 32768
v_min_u32 v240, 1, v240
v_lshlrev_b32 v240, 30, v240
v_mfma_f32_16x16x32_bf16 v[144:147], a[176:179], a[224:227], v[144:147]
s_add_u32 s72, s71, 0
buffer_load_dwordx4 v15, s[24:27], s72 offen lds
v_mfma_f32_16x16x32_bf16 v[148:151], a[180:183], a[224:227], v[148:151]
ds_read_b128 a[208:211], v7 offset:1792
ds_read_b64 a[144:145], v6 offset:2304
v_mfma_f32_16x16x32_bf16 v[148:151], a[176:179], a[228:231], v[148:151]
buffer_store_dword v241, v240, s[44:47], s91 offen sc1
v_mfma_f32_16x16x32_bf16 v[148:151], a[172:175], a[232:235], v[148:151]
s_add_u32 s80, s93, 0x3400000
v_and_b32 v166, 7, v0
v_lshlrev_b32 v166, 4, v166
v_mfma_f32_16x16x32_bf16 v[148:151], a[168:171], a[236:239], v[148:151]
s_add_u32 s72, s71, 15360
ds_read_b64 a[146:147], v6 offset:2312
ds_read_b128 a[212:215], v7 offset:1280
v_mfma_f32_16x16x32_bf16 v[148:151], a[164:167], a[240:243], v[148:151]
buffer_load_dwordx4 v15, s[24:27], s72 offen offset:1024 lds
v_mfma_f32_16x16x32_bf16 v[148:151], a[160:163], a[244:247], v[148:151]
ds_read_b64 a[148:149], v6 offset:2816
ds_read_b64 a[150:151], v6 offset:2824
v_mfma_f32_16x16x32_bf16 v[152:155], a[160:163], a[248:251], v[152:155]
v_bfe_u32 v112, v0, 3, 1
v_lshl_add_u32 v166, v112, 8, v166
v_mfma_f32_16x16x32_bf16 v[152:155], a[164:167], a[244:247], v[152:155]
v_bfe_u32 v112, v0, 4, 1
v_lshl_add_u32 v166, v112, 7, v166
v_mfma_f32_16x16x32_bf16 v[152:155], a[168:171], a[240:243], v[152:155]
ds_read_b128 a[216:219], v7 offset:768
ds_read_b64 a[152:153], v6 offset:3328
v_mfma_f32_16x16x32_bf16 v[152:155], a[172:175], a[236:239], v[152:155]
s_add_u32 s72, s71, 30720
buffer_load_dwordx4 v15, s[24:27], s72 offen offset:2048 lds
v_mfma_f32_16x16x32_bf16 v[152:155], a[176:179], a[232:235], v[152:155]
ds_read_b64 a[154:155], v6 offset:3336
ds_read_b128 a[220:223], v7 offset:256
v_mfma_f32_16x16x32_bf16 v[152:155], a[180:183], a[228:231], v[152:155]
v_lshrrev_b32 v112, 5, v0
v_lshl_add_u32 v166, v112, 9, v166
v_mfma_f32_16x16x32_bf16 v[152:155], a[184:187], a[224:227], v[152:155]
v_and_b32 v112, 15, v0
v_lshrrev_b32 v113, 2, v0
v_mfma_f32_16x16x32_bf16 v[156:159], a[188:191], a[224:227], v[156:159]
ds_read_b64 a[156:157], v6 offset:3840
ds_read_b64 a[158:159], v6 offset:3848
v_mfma_f32_16x16x32_bf16 v[156:159], a[184:187], a[228:231], v[156:159]
v_bfe_u32 v114, v0, 3, 2
v_and_b32 v115, 3, v0
v_mfma_f32_16x16x32_bf16 v[156:159], a[180:183], a[232:235], v[156:159]
s_add_u32 s72, s71, 46080
buffer_load_dwordx4 v15, s[24:27], s72 offen offset:3072 lds
v_mfma_f32_16x16x32_bf16 v[156:159], a[176:179], a[236:239], v[156:159]
v_lshlrev_b32 v8, 7, v113
v_lshl_add_u32 v8, v114, 5, v8
v_mfma_f32_16x16x32_bf16 v[156:159], a[172:175], a[240:243], v[156:159]
v_lshl_add_u32 v8, v115, 3, v8
v_add_u32 v8, s77, v8
v_mfma_f32_16x16x32_bf16 v[156:159], a[168:171], a[244:247], v[156:159]
v_subrev_u32 v8, s64, v8
v_xor_b32 v9, 32, v8
v_mfma_f32_16x16x32_bf16 v[156:159], a[164:167], a[248:251], v[156:159]
v_lshrrev_b32 v2, 4, v0
v_lshlrev_b32 v2, 10, v2
v_mfma_f32_16x16x32_bf16 v[156:159], a[160:163], a[252:255], v[156:159]
s_waitcnt lgkmcnt(0)
v_xor_b32 v10, 64, v8
v_xor_b32 v11, 0x60, v8
v_mfma_f32_16x16x32_bf16 v[128:131], a[128:131], a[192:195], v[128:131]
s_xor_b32 s71, s13, 0x80
ds_read_b128 a[224:227], v7 offset:3904
ds_read_b64 a[160:161], v6 offset:320
v_mfma_f32_16x16x32_bf16 v[132:135], a[132:135], a[192:195], v[132:135]
s_add_u32 m0, s77, 49152
v_lshlrev_b32 v5, 8, v113
v_and_b32 v114, 1, v0
v_mfma_f32_16x16x32_bf16 v[132:135], a[128:131], a[196:199], v[132:135]
s_add_u32 s72, s71, 0
ds_read_b64 a[162:163], v6 offset:328
ds_read_b128 a[228:231], v7 offset:3392
v_mfma_f32_16x16x32_bf16 v[136:139], a[128:131], a[200:203], v[136:139]
s_xor_b32 s82, s78, 0
buffer_load_dwordx4 v15, s[24:27], s72 offen lds
v_mfma_f32_16x16x32_bf16 v[136:139], a[132:135], a[196:199], v[136:139]
s_lshl_b32 s82, s82, 10
v_lshl_add_u32 v5, v114, 7, v5
v_bfe_u32 v114, v0, 1, 1
v_mfma_f32_16x16x32_bf16 v[136:139], a[136:139], a[192:195], v[136:139]
s_add_u32 s82, s82, s74
ds_read_b64 a[164:165], v6 offset:832
ds_read_b64 a[166:167], v6 offset:840
v_mfma_f32_16x16x32_bf16 v[140:143], a[140:143], a[192:195], v[140:143]
s_add_u32 s72, s71, 15360
buffer_load_dwordx4 v15, s[24:27], s72 offen offset:1024 lds
v_mfma_f32_16x16x32_bf16 v[140:143], a[136:139], a[196:199], v[140:143]
ds_read_b128 a[232:235], v7 offset:2880
ds_read_b64 a[168:169], v6 offset:1344
v_mfma_f32_16x16x32_bf16 v[140:143], a[132:135], a[200:203], v[140:143]
buffer_load_dword v3, v2, s[44:47], s82 offen sc1
v_mfma_f32_16x16x32_bf16 v[140:143], a[128:131], a[204:207], v[140:143]
v_lshl_add_u32 v5, v114, 3, v5
v_lshlrev_b32 v114, 1, s58
v_mfma_f32_16x16x32_bf16 v[144:147], a[128:131], a[208:211], v[144:147]
ds_read_b64 a[170:171], v6 offset:1352
ds_read_b128 a[236:239], v7 offset:2368
v_mfma_f32_16x16x32_bf16 v[144:147], a[132:135], a[204:207], v[144:147]
v_xor_b32 v114, v114, v113
v_and_b32 v114, 7, v114
v_mfma_f32_16x16x32_bf16 v[144:147], a[136:139], a[200:203], v[144:147]
s_add_u32 s72, s71, 30720
ds_read_b64 a[172:173], v6 offset:1856
ds_read_b64 a[174:175], v6 offset:1864
v_mfma_f32_16x16x32_bf16 v[144:147], a[140:143], a[196:199], v[144:147]
buffer_load_dwordx4 v15, s[24:27], s72 offen offset:2048 lds
v_mfma_f32_16x16x32_bf16 v[144:147], a[144:147], a[192:195], v[144:147]
v_lshl_add_u32 v5, v114, 4, v5
v_add_u32 v5, 147456, v5
v_mfma_f32_16x16x32_bf16 v[148:151], a[148:151], a[192:195], v[148:151]
ds_read_b128 a[240:243], v7 offset:1856
ds_read_b64 a[176:177], v6 offset:2368
v_mfma_f32_16x16x32_bf16 v[148:151], a[144:147], a[196:199], v[148:151]
v_bfe_u32 v114, v0, 1, 2
v_lshrrev_b32 v115, 4, v0
v_mfma_f32_16x16x32_bf16 v[148:151], a[140:143], a[200:203], v[148:151]
v_lshlrev_b32 v116, 7, v112
v_lshl_add_u32 v116, v114, 5, v116
v_mfma_f32_16x16x32_bf16 v[148:151], a[136:139], a[204:207], v[148:151]
s_add_u32 s72, s71, 46080
ds_read_b64 a[178:179], v6 offset:2376
ds_read_b128 a[244:247], v7 offset:1344
v_mfma_f32_16x16x32_bf16 v[148:151], a[132:135], a[208:211], v[148:151]
buffer_load_dwordx4 v15, s[24:27], s72 offen offset:3072 lds
v_mfma_f32_16x16x32_bf16 v[148:151], a[128:131], a[212:215], v[148:151]
ds_read_b64 a[180:181], v6 offset:2880
ds_read_b64 a[182:183], v6 offset:2888
v_mfma_f32_16x16x32_bf16 v[152:155], a[128:131], a[216:219], v[152:155]
v_lshl_add_u32 v116, v115, 3, v116
v_add_u32 v116, s64, v116
v_mfma_f32_16x16x32_bf16 v[152:155], a[132:135], a[212:215], v[152:155]
v_add_u32 v116, 131072, v116
v_xor_b32 v117, 32, v116
v_mfma_f32_16x16x32_bf16 v[152:155], a[136:139], a[208:211], v[152:155]
ds_read_b128 a[248:251], v7 offset:832
ds_read_b64 a[184:185], v6 offset:3392
v_mfma_f32_16x16x32_bf16 v[152:155], a[140:143], a[204:207], v[152:155]
v_xor_b32 v118, 64, v116
v_xor_b32 v119, 0x60, v116
v_mfma_f32_16x16x32_bf16 v[152:155], a[144:147], a[200:203], v[152:155]
ds_read_b64 a[186:187], v6 offset:3400
ds_read_b128 a[252:255], v7 offset:320
v_mfma_f32_16x16x32_bf16 v[152:155], a[148:151], a[196:199], v[152:155]
v_mfma_f32_16x16x32_bf16 v[152:155], a[152:155], a[192:195], v[152:155]
v_mfma_f32_16x16x32_bf16 v[156:159], a[156:159], a[192:195], v[156:159]
ds_read_b64 a[188:189], v6 offset:3904
ds_read_b64 a[190:191], v6 offset:3912
v_mfma_f32_16x16x32_bf16 v[156:159], a[152:155], a[196:199], v[156:159]
v_mfma_f32_16x16x32_bf16 v[156:159], a[148:151], a[200:203], v[156:159]
v_mfma_f32_16x16x32_bf16 v[156:159], a[144:147], a[204:207], v[156:159]
v_mfma_f32_16x16x32_bf16 v[156:159], a[140:143], a[208:211], v[156:159]
v_mfma_f32_16x16x32_bf16 v[156:159], a[136:139], a[212:215], v[156:159]
v_mfma_f32_16x16x32_bf16 v[156:159], a[132:135], a[216:219], v[156:159]
v_mfma_f32_16x16x32_bf16 v[156:159], a[128:131], a[220:223], v[156:159]
s_waitcnt lgkmcnt(0)
v_mfma_f32_16x16x32_bf16 v[128:131], a[160:163], a[224:227], v[128:131]
ds_read_b128 a[192:195], v7 offset:3968
ds_read_b64 a[128:129], v6 offset:384
v_mfma_f32_16x16x32_bf16 v[132:135], a[164:167], a[224:227], v[132:135]
v_mfma_f32_16x16x32_bf16 v[132:135], a[160:163], a[228:231], v[132:135]
ds_read_b64 a[130:131], v6 offset:392
ds_read_b128 a[196:199], v7 offset:3456
v_mfma_f32_16x16x32_bf16 v[136:139], a[160:163], a[232:235], v[136:139]
v_mfma_f32_16x16x32_bf16 v[136:139], a[164:167], a[228:231], v[136:139]
v_mfma_f32_16x16x32_bf16 v[136:139], a[168:171], a[224:227], v[136:139]
ds_read_b64 a[132:133], v6 offset:896
ds_read_b64 a[134:135], v6 offset:904
v_mfma_f32_16x16x32_bf16 v[140:143], a[172:175], a[224:227], v[140:143]
v_mfma_f32_16x16x32_bf16 v[140:143], a[168:171], a[228:231], v[140:143]
ds_read_b128 a[200:203], v7 offset:2944
ds_read_b64 a[136:137], v6 offset:1408
v_mfma_f32_16x16x32_bf16 v[140:143], a[164:167], a[232:235], v[140:143]
v_mfma_f32_16x16x32_bf16 v[140:143], a[160:163], a[236:239], v[140:143]
v_mfma_f32_16x16x32_bf16 v[144:147], a[160:163], a[240:243], v[144:147]
ds_read_b64 a[138:139], v6 offset:1416
ds_read_b128 a[204:207], v7 offset:2432
v_mfma_f32_16x16x32_bf16 v[144:147], a[164:167], a[236:239], v[144:147]
v_mfma_f32_16x16x32_bf16 v[144:147], a[168:171], a[232:235], v[144:147]
ds_read_b64 a[140:141], v6 offset:1920
ds_read_b64 a[142:143], v6 offset:1928
v_mfma_f32_16x16x32_bf16 v[144:147], a[172:175], a[228:231], v[144:147]
v_mfma_f32_16x16x32_bf16 v[144:147], a[176:179], a[224:227], v[144:147]
v_mfma_f32_16x16x32_bf16 v[148:151], a[180:183], a[224:227], v[148:151]
ds_read_b128 a[208:211], v7 offset:1920
ds_read_b64 a[144:145], v6 offset:2432
v_mfma_f32_16x16x32_bf16 v[148:151], a[176:179], a[228:231], v[148:151]
v_mfma_f32_16x16x32_bf16 v[148:151], a[172:175], a[232:235], v[148:151]
s_waitcnt vmcnt(2)
v_cmp_gt_u32 vcc, 2, v3
s_or_b32 s81, vcc_lo, vcc_hi
s_cselect_b32 s81, 0x40000000, 0
v_or_b32 v4, s81, v1
v_mfma_f32_16x16x32_bf16 v[148:151], a[168:171], a[236:239], v[148:151]
ds_read_b64 a[146:147], v6 offset:2440
ds_read_b128 a[212:215], v7 offset:1408
v_mfma_f32_16x16x32_bf16 v[148:151], a[164:167], a[240:243], v[148:151]
v_mfma_f32_16x16x32_bf16 v[148:151], a[160:163], a[244:247], v[148:151]
ds_read_b64 a[148:149], v6 offset:2944
ds_read_b64 a[150:151], v6 offset:2952
v_mfma_f32_16x16x32_bf16 v[152:155], a[160:163], a[248:251], v[152:155]
v_mfma_f32_16x16x32_bf16 v[152:155], a[164:167], a[244:247], v[152:155]
s_lshr_b32 s69, s12, 18
v_mfma_f32_16x16x32_bf16 v[152:155], a[168:171], a[240:243], v[152:155]
s_lshl_b32 s69, s69, 12
ds_read_b128 a[216:219], v7 offset:896
ds_read_b64 a[152:153], v6 offset:3456
v_mfma_f32_16x16x32_bf16 v[152:155], a[172:175], a[236:239], v[152:155]
s_add_u32 s69, s69, s95
buffer_load_dwordx4 a[0:3], v4, s[44:47], s69 offen sc1
v_mfma_f32_16x16x32_bf16 v[152:155], a[176:179], a[232:235], v[152:155]
ds_read_b64 a[154:155], v6 offset:3464
ds_read_b128 a[220:223], v7 offset:384
v_mfma_f32_16x16x32_bf16 v[152:155], a[180:183], a[228:231], v[152:155]
v_mfma_f32_16x16x32_bf16 v[152:155], a[184:187], a[224:227], v[152:155]
v_mfma_f32_16x16x32_bf16 v[156:159], a[188:191], a[224:227], v[156:159]
ds_read_b64 a[156:157], v6 offset:3968
ds_read_b64 a[158:159], v6 offset:3976
v_mfma_f32_16x16x32_bf16 v[156:159], a[184:187], a[228:231], v[156:159]
buffer_load_dwordx4 a[4:7], v4, s[44:47], s69 offen offset:1024 sc1
v_mfma_f32_16x16x32_bf16 v[156:159], a[180:183], a[232:235], v[156:159]
v_mfma_f32_16x16x32_bf16 v[156:159], a[176:179], a[236:239], v[156:159]
v_mfma_f32_16x16x32_bf16 v[156:159], a[172:175], a[240:243], v[156:159]
v_mfma_f32_16x16x32_bf16 v[156:159], a[168:171], a[244:247], v[156:159]
buffer_load_dwordx4 a[8:11], v4, s[44:47], s69 offen offset:2048 sc1
v_mfma_f32_16x16x32_bf16 v[156:159], a[164:167], a[248:251], v[156:159]
v_mfma_f32_16x16x32_bf16 v[156:159], a[160:163], a[252:255], v[156:159]
s_waitcnt lgkmcnt(0)
v_mfma_f32_16x16x32_bf16 v[128:131], a[128:131], a[192:195], v[128:131]
ds_read_b128 a[224:227], v7 offset:4032
ds_read_b64 a[160:161], v6 offset:448
v_mfma_f32_16x16x32_bf16 v[132:135], a[132:135], a[192:195], v[132:135]
v_mfma_f32_16x16x32_bf16 v[132:135], a[128:131], a[196:199], v[132:135]
ds_read_b64 a[162:163], v6 offset:456
ds_read_b128 a[228:231], v7 offset:3520
v_mfma_f32_16x16x32_bf16 v[136:139], a[128:131], a[200:203], v[136:139]
buffer_load_dwordx4 a[12:15], v4, s[44:47], s69 offen offset:3072 sc1
v_mfma_f32_16x16x32_bf16 v[136:139], a[132:135], a[196:199], v[136:139]
v_mfma_f32_16x16x32_bf16 v[136:139], a[136:139], a[192:195], v[136:139]
ds_read_b64 a[164:165], v6 offset:960
ds_read_b64 a[166:167], v6 offset:968
v_mfma_f32_16x16x32_bf16 v[140:143], a[140:143], a[192:195], v[140:143]
v_mfma_f32_16x16x32_bf16 v[140:143], a[136:139], a[196:199], v[140:143]
ds_read_b128 a[232:235], v7 offset:3008
ds_read_b64 a[168:169], v6 offset:1472
v_mfma_f32_16x16x32_bf16 v[140:143], a[132:135], a[200:203], v[140:143]
s_add_u32 s69, s69, 0x20000
buffer_load_dwordx4 a[16:19], v4, s[44:47], s69 offen sc1
v_mfma_f32_16x16x32_bf16 v[140:143], a[128:131], a[204:207], v[140:143]
v_mfma_f32_16x16x32_bf16 v[144:147], a[128:131], a[208:211], v[144:147]
ds_read_b64 a[170:171], v6 offset:1480
ds_read_b128 a[236:239], v7 offset:2496
v_mfma_f32_16x16x32_bf16 v[144:147], a[132:135], a[204:207], v[144:147]
v_mfma_f32_16x16x32_bf16 v[144:147], a[136:139], a[200:203], v[144:147]
ds_read_b64 a[172:173], v6 offset:1984
ds_read_b64 a[174:175], v6 offset:1992
v_mfma_f32_16x16x32_bf16 v[144:147], a[140:143], a[196:199], v[144:147]
buffer_load_dwordx4 a[20:23], v4, s[44:47], s69 offen offset:1024 sc1
v_mfma_f32_16x16x32_bf16 v[144:147], a[144:147], a[192:195], v[144:147]
v_mfma_f32_16x16x32_bf16 v[148:151], a[148:151], a[192:195], v[148:151]
ds_read_b128 a[240:243], v7 offset:1984
ds_read_b64 a[176:177], v6 offset:2496
v_mfma_f32_16x16x32_bf16 v[148:151], a[144:147], a[196:199], v[148:151]
v_mfma_f32_16x16x32_bf16 v[148:151], a[140:143], a[200:203], v[148:151]
v_mfma_f32_16x16x32_bf16 v[148:151], a[136:139], a[204:207], v[148:151]
ds_read_b64 a[178:179], v6 offset:2504
ds_read_b128 a[244:247], v7 offset:1472
v_mfma_f32_16x16x32_bf16 v[148:151], a[132:135], a[208:211], v[148:151]
buffer_load_dwordx4 a[24:27], v4, s[44:47], s69 offen offset:2048 sc1
v_mfma_f32_16x16x32_bf16 v[148:151], a[128:131], a[212:215], v[148:151]
ds_read_b64 a[180:181], v6 offset:3008
ds_read_b64 a[182:183], v6 offset:3016
v_mfma_f32_16x16x32_bf16 v[152:155], a[128:131], a[216:219], v[152:155]
v_mfma_f32_16x16x32_bf16 v[152:155], a[132:135], a[212:215], v[152:155]
v_mfma_f32_16x16x32_bf16 v[152:155], a[136:139], a[208:211], v[152:155]
ds_read_b128 a[248:251], v7 offset:960
ds_read_b64 a[184:185], v6 offset:3520
v_mfma_f32_16x16x32_bf16 v[152:155], a[140:143], a[204:207], v[152:155]
buffer_load_dwordx4 a[28:31], v4, s[44:47], s69 offen offset:3072 sc1
v_mfma_f32_16x16x32_bf16 v[152:155], a[144:147], a[200:203], v[152:155]
ds_read_b64 a[186:187], v6 offset:3528
ds_read_b128 a[252:255], v7 offset:448
v_mfma_f32_16x16x32_bf16 v[152:155], a[148:151], a[196:199], v[152:155]
v_mfma_f32_16x16x32_bf16 v[152:155], a[152:155], a[192:195], v[152:155]
s_lshr_b32 s69, s13, 18
v_mfma_f32_16x16x32_bf16 v[156:159], a[156:159], a[192:195], v[156:159]
s_lshl_b32 s69, s69, 12
ds_read_b64 a[188:189], v6 offset:4032
ds_read_b64 a[190:191], v6 offset:4040
v_mfma_f32_16x16x32_bf16 v[156:159], a[152:155], a[196:199], v[156:159]
s_add_u32 s69, s69, s95
buffer_load_dwordx4 a[32:35], v4, s[44:47], s69 offen sc1
v_mfma_f32_16x16x32_bf16 v[156:159], a[148:151], a[200:203], v[156:159]
v_mfma_f32_16x16x32_bf16 v[156:159], a[144:147], a[204:207], v[156:159]
v_mfma_f32_16x16x32_bf16 v[156:159], a[140:143], a[208:211], v[156:159]
v_mfma_f32_16x16x32_bf16 v[156:159], a[136:139], a[212:215], v[156:159]
buffer_load_dwordx4 a[36:39], v4, s[44:47], s69 offen offset:1024 sc1
v_mfma_f32_16x16x32_bf16 v[156:159], a[132:135], a[216:219], v[156:159]
v_mfma_f32_16x16x32_bf16 v[156:159], a[128:131], a[220:223], v[156:159]
s_waitcnt lgkmcnt(0)
v_mfma_f32_16x16x32_bf16 v[128:131], a[160:163], a[224:227], v[128:131]
ds_read_b64_tr_b16 v[192:193], v8 offset:0
ds_read_b64_tr_b16 v[194:195], v8 offset:2048
v_mfma_f32_16x16x32_bf16 v[132:135], a[164:167], a[224:227], v[132:135]
v_mfma_f32_16x16x32_bf16 v[132:135], a[160:163], a[228:231], v[132:135]
ds_read_b64_tr_b16 v[196:197], v9 offset:0
ds_read_b64_tr_b16 v[198:199], v9 offset:2048
v_mfma_f32_16x16x32_bf16 v[136:139], a[160:163], a[232:235], v[136:139]
buffer_load_dwordx4 a[40:43], v4, s[44:47], s69 offen offset:2048 sc1
v_mfma_f32_16x16x32_bf16 v[136:139], a[164:167], a[228:231], v[136:139]
ds_read_b64_tr_b16 v[200:201], v10 offset:0
ds_read_b64_tr_b16 v[202:203], v10 offset:2048
v_mfma_f32_16x16x32_bf16 v[136:139], a[168:171], a[224:227], v[136:139]
v_mfma_f32_16x16x32_bf16 v[140:143], a[172:175], a[224:227], v[140:143]
ds_read_b64_tr_b16 v[204:205], v11 offset:0
ds_read_b64_tr_b16 v[206:207], v11 offset:2048
v_mfma_f32_16x16x32_bf16 v[140:143], a[168:171], a[228:231], v[140:143]
v_cvt_pk_bf16_f32 v128, v128, v129
v_cvt_pk_bf16_f32 v129, v130, v131
v_cvt_pk_bf16_f32 v130, v132, v133
v_mfma_f32_16x16x32_bf16 v[140:143], a[164:167], a[232:235], v[140:143]
ds_read_b64_tr_b16 v[208:209], v8 offset:4096
ds_read_b64_tr_b16 v[210:211], v8 offset:6144
v_cvt_pk_bf16_f32 v131, v134, v135
v_mfma_f32_16x16x32_bf16 v[140:143], a[160:163], a[236:239], v[140:143]
buffer_load_dwordx4 a[44:47], v4, s[44:47], s69 offen offset:3072 sc1
v_permlane32_swap_b32 v128, v130
v_mfma_f32_16x16x32_bf16 v[144:147], a[160:163], a[240:243], v[144:147]
ds_read_b64_tr_b16 v[212:213], v9 offset:4096
ds_read_b64_tr_b16 v[214:215], v9 offset:6144
v_permlane32_swap_b32 v129, v131
v_mfma_f32_16x16x32_bf16 v[144:147], a[164:167], a[236:239], v[144:147]
buffer_store_dwordx4 v[128:131], v166, s[44:47], s80 offen sc1
v_mfma_f32_16x16x32_bf16 v[144:147], a[168:171], a[232:235], v[144:147]
ds_read_b64_tr_b16 v[216:217], v10 offset:4096
ds_read_b64_tr_b16 v[218:219], v10 offset:6144
v_mfma_f32_16x16x32_bf16 v[144:147], a[172:175], a[228:231], v[144:147]
s_add_u32 s69, s69, 0x20000
buffer_load_dwordx4 a[48:51], v4, s[44:47], s69 offen sc1
v_mfma_f32_16x16x32_bf16 v[144:147], a[176:179], a[224:227], v[144:147]
Lstub9:
s_cbranch_execz Lret
ds_read_b64_tr_b16 v[220:221], v11 offset:4096
ds_read_b64_tr_b16 v[222:223], v11 offset:6144
v_cvt_pk_bf16_f32 v136, v136, v137
v_mfma_f32_16x16x32_bf16 v[148:151], a[180:183], a[224:227], v[148:151]
v_cvt_pk_bf16_f32 v137, v138, v139
v_cvt_pk_bf16_f32 v138, v140, v141
v_cvt_pk_bf16_f32 v139, v142, v143
v_mfma_f32_16x16x32_bf16 v[148:151], a[176:179], a[228:231], v[148:151]
ds_read_b64_tr_b16 v[224:225], v8 offset:8192
ds_read_b64_tr_b16 v[226:227], v8 offset:10240
v_permlane32_swap_b32 v136, v138
v_mfma_f32_16x16x32_bf16 v[148:151], a[172:175], a[232:235], v[148:151]
v_permlane32_swap_b32 v137, v139
v_mfma_f32_16x16x32_bf16 v[148:151], a[168:171], a[236:239], v[148:151]
ds_read_b64_tr_b16 v[228:229], v9 offset:8192
ds_read_b64_tr_b16 v[230:231], v9 offset:10240
v_mfma_f32_16x16x32_bf16 v[148:151], a[164:167], a[240:243], v[148:151]
buffer_load_dwordx4 a[52:55], v4, s[44:47], s69 offen offset:1024 sc1
v_mfma_f32_16x16x32_bf16 v[148:151], a[160:163], a[244:247], v[148:151]
ds_read_b64_tr_b16 v[232:233], v10 offset:8192
ds_read_b64_tr_b16 v[234:235], v10 offset:10240
v_mfma_f32_16x16x32_bf16 v[152:155], a[160:163], a[248:251], v[152:155]
buffer_store_dwordx4 v[136:139], v166, s[44:47], s80 offen offset:1024 sc1
v_mfma_f32_16x16x32_bf16 v[152:155], a[164:167], a[244:247], v[152:155]
ds_read_b64_tr_b16 v[236:237], v11 offset:8192
ds_read_b64_tr_b16 v[238:239], v11 offset:10240
v_mfma_f32_16x16x32_bf16 v[152:155], a[168:171], a[240:243], v[152:155]
buffer_load_dwordx4 a[56:59], v4, s[44:47], s69 offen offset:2048 sc1
v_mfma_f32_16x16x32_bf16 v[152:155], a[172:175], a[236:239], v[152:155]
ds_read_b64_tr_b16 v[240:241], v8 offset:12288
ds_read_b64_tr_b16 v[242:243], v8 offset:14336
v_mfma_f32_16x16x32_bf16 v[152:155], a[176:179], a[232:235], v[152:155]
v_cvt_pk_bf16_f32 v144, v144, v145
v_cvt_pk_bf16_f32 v145, v146, v147
v_cvt_pk_bf16_f32 v146, v148, v149
v_mfma_f32_16x16x32_bf16 v[152:155], a[180:183], a[228:231], v[152:155]
ds_read_b64_tr_b16 v[244:245], v9 offset:12288
ds_read_b64_tr_b16 v[246:247], v9 offset:14336
v_cvt_pk_bf16_f32 v147, v150, v151
v_mfma_f32_16x16x32_bf16 v[152:155], a[184:187], a[224:227], v[152:155]
v_permlane32_swap_b32 v144, v146
v_permlane32_swap_b32 v145, v147
v_mfma_f32_16x16x32_bf16 v[156:159], a[188:191], a[224:227], v[156:159]
ds_read_b64_tr_b16 v[248:249], v10 offset:12288
ds_read_b64_tr_b16 v[250:251], v10 offset:14336
v_mfma_f32_16x16x32_bf16 v[156:159], a[184:187], a[228:231], v[156:159]
buffer_load_dwordx4 a[60:63], v4, s[44:47], s69 offen offset:3072 sc1
v_mfma_f32_16x16x32_bf16 v[156:159], a[180:183], a[232:235], v[156:159]
ds_read_b64_tr_b16 v[252:253], v11 offset:12288
ds_read_b64_tr_b16 v[254:255], v11 offset:14336
v_mfma_f32_16x16x32_bf16 v[156:159], a[176:179], a[236:239], v[156:159]
buffer_store_dwordx4 v[144:147], v166, s[44:47], s80 offen offset:2048 sc1
v_mfma_f32_16x16x32_bf16 v[156:159], a[172:175], a[240:243], v[156:159]
v_mfma_f32_16x16x32_bf16 v[156:159], a[168:171], a[244:247], v[156:159]
v_mfma_f32_16x16x32_bf16 v[156:159], a[164:167], a[248:251], v[156:159]
v_mfma_f32_16x16x32_bf16 v[156:159], a[160:163], a[252:255], v[156:159]
v_cvt_pk_bf16_f32 v152, v152, v153
v_cvt_pk_bf16_f32 v153, v154, v155
s_nop 5
v_cvt_pk_bf16_f32 v154, v156, v157
v_cvt_pk_bf16_f32 v155, v158, v159
s_nop 0
v_permlane32_swap_b32 v152, v154
v_permlane32_swap_b32 v153, v155
buffer_store_dwordx4 v[152:155], v166, s[44:47], s80 offen offset:3072 sc1
s_waitcnt vmcnt(12) lgkmcnt(0)
s_cmp_lg_u32 s81, 0
s_cbranch_scc1 Lredo0
Lredo0b:
s_barrier
v_mfma_f32_16x16x32_bf16 v[16:19], v[192:195], a[0:3], 0
s_nop 0
ds_read_b64_tr_b16 v[128:129], v8 offset:16384
ds_read_b64_tr_b16 v[130:131], v8 offset:18432
v_mfma_f32_16x16x32_bf16 v[16:19], v[208:211], a[4:7], v[16:19]
s_xor_b32 s71, s13, 0x100
ds_read_b64_tr_b16 v[132:133], v9 offset:16384
ds_read_b64_tr_b16 v[134:135], v9 offset:18432
v_mfma_f32_16x16x32_bf16 v[16:19], v[224:227], a[8:11], v[16:19]
s_add_u32 m0, s85, 0
ds_read_b64_tr_b16 v[136:137], v10 offset:16384
ds_read_b64_tr_b16 v[138:139], v10 offset:18432
v_mfma_f32_16x16x32_bf16 v[16:19], v[240:243], a[12:15], v[16:19]
s_add_u32 s72, s71, 0
buffer_load_dwordx4 v15, s[24:27], s72 offen lds
v_mfma_f32_16x16x32_bf16 v[32:35], v[240:243], a[28:31], 0
s_lshr_b32 s69, s14, 18
ds_read_b64_tr_b16 v[140:141], v11 offset:16384
ds_read_b64_tr_b16 v[142:143], v11 offset:18432
v_mfma_f32_16x16x32_bf16 v[32:35], v[224:227], a[24:27], v[32:35]
s_lshl_b32 s69, s69, 12
v_add_u32 v4, s64, v1
v_add_u32 v4, 131072, v4
v_mfma_f32_16x16x32_bf16 v[32:35], v[208:211], a[20:23], v[32:35]
s_add_u32 s69, s69, s95
buffer_load_dwordx4 a[64:67], v1, s[44:47], s69 offen sc1
v_mfma_f32_16x16x32_bf16 v[32:35], v[192:195], a[16:19], v[32:35]
s_lshl_b32 s70, s75, 18
ds_read_b64_tr_b16 v[144:145], v8 offset:20480
ds_read_b64_tr_b16 v[146:147], v8 offset:22528
v_mfma_f32_16x16x32_bf16 v[36:39], v[196:199], a[16:19], 0
s_add_u32 s72, s71, 15360
buffer_load_dwordx4 v15, s[24:27], s72 offen offset:1024 lds
v_mfma_f32_16x16x32_bf16 v[36:39], v[212:215], a[20:23], v[36:39]
s_add_u32 s70, s70, s94
ds_read_b64_tr_b16 v[148:149], v9 offset:20480
ds_read_b64_tr_b16 v[150:151], v9 offset:22528
v_mfma_f32_16x16x32_bf16 v[36:39], v[228:231], a[24:27], v[36:39]
s_nop 0
ds_read_b64_tr_b16 v[152:153], v10 offset:20480
ds_read_b64_tr_b16 v[154:155], v10 offset:22528
v_mfma_f32_16x16x32_bf16 v[36:39], v[244:247], a[28:31], v[36:39]
s_nop 0
ds_read_b64_tr_b16 v[156:157], v11 offset:20480
ds_read_b64_tr_b16 v[158:159], v11 offset:22528
v_mfma_f32_16x16x32_bf16 v[20:23], v[244:247], a[12:15], 0
ds_write_b128 v4, v[80:83] offset:0
v_mfma_f32_16x16x32_bf16 v[20:23], v[228:231], a[8:11], v[20:23]
s_nop 0
ds_read_b64_tr_b16 v[160:161], v8 offset:24576
ds_read_b64_tr_b16 v[162:163], v8 offset:26624
v_mfma_f32_16x16x32_bf16 v[20:23], v[212:215], a[4:7], v[20:23]
s_add_u32 s72, s71, 30720
buffer_load_dwordx4 v15, s[24:27], s72 offen offset:2048 lds
v_mfma_f32_16x16x32_bf16 v[20:23], v[196:199], a[0:3], v[20:23]
buffer_load_dwordx4 a[68:71], v1, s[44:47], s69 offen offset:1024 sc1
v_mfma_f32_16x16x32_bf16 v[24:27], v[200:203], a[0:3], 0
s_nop 0
ds_read_b64_tr_b16 v[164:165], v9 offset:24576
ds_read_b64_tr_b16 v[166:167], v9 offset:26624
v_mfma_f32_16x16x32_bf16 v[24:27], v[216:219], a[4:7], v[24:27]
s_nop 0
ds_read_b64_tr_b16 v[168:169], v10 offset:24576
ds_read_b64_tr_b16 v[170:171], v10 offset:26624
v_mfma_f32_16x16x32_bf16 v[24:27], v[232:235], a[8:11], v[24:27]
s_nop 0
ds_read_b64_tr_b16 v[172:173], v11 offset:24576
ds_read_b64_tr_b16 v[174:175], v11 offset:26624
v_mfma_f32_16x16x32_bf16 v[24:27], v[248:251], a[12:15], v[24:27]
ds_write_b128 v4, v[84:87] offset:1024
v_mfma_f32_16x16x32_bf16 v[40:43], v[248:251], a[28:31], 0
s_add_u32 s72, s71, 46080
buffer_load_dwordx4 v15, s[24:27], s72 offen offset:3072 lds
v_mfma_f32_16x16x32_bf16 v[40:43], v[232:235], a[24:27], v[40:43]
s_nop 0
ds_read_b64_tr_b16 v[176:177], v8 offset:28672
ds_read_b64_tr_b16 v[178:179], v8 offset:30720
v_mfma_f32_16x16x32_bf16 v[40:43], v[216:219], a[20:23], v[40:43]
s_nop 0
ds_read_b64_tr_b16 v[180:181], v9 offset:28672
ds_read_b64_tr_b16 v[182:183], v9 offset:30720
v_mfma_f32_16x16x32_bf16 v[40:43], v[200:203], a[16:19], v[40:43]
s_nop 0
ds_read_b64_tr_b16 v[184:185], v10 offset:28672
ds_read_b64_tr_b16 v[186:187], v10 offset:30720
v_mfma_f32_16x16x32_bf16 v[44:47], v[204:207], a[16:19], 0
s_nop 0
ds_read_b64_tr_b16 v[188:189], v11 offset:28672
ds_read_b64_tr_b16 v[190:191], v11 offset:30720
v_mfma_f32_16x16x32_bf16 v[44:47], v[220:223], a[20:23], v[44:47]
buffer_load_dwordx4 a[72:75], v1, s[44:47], s69 offen offset:2048 sc1
v_mfma_f32_16x16x32_bf16 v[44:47], v[236:239], a[24:27], v[44:47]
ds_write_b128 v4, v[96:99] offset:2048
v_mfma_f32_16x16x32_bf16 v[44:47], v[252:255], a[28:31], v[44:47]
s_xor_b32 s71, s13, 0x180
v_mfma_f32_16x16x32_bf16 v[28:31], v[252:255], a[12:15], 0
s_add_u32 m0, s85, 16384
ds_write_b128 v4, v[100:103] offset:3072
v_mfma_f32_16x16x32_bf16 v[28:31], v[236:239], a[8:11], v[28:31]
s_add_u32 s72, s71, 0
v_mfma_f32_16x16x32_bf16 v[28:31], v[220:223], a[4:7], v[28:31]
s_waitcnt vmcnt(32) lgkmcnt(0)
buffer_load_dwordx4 v15, s[24:27], s72 offen lds
v_mfma_f32_16x16x32_bf16 v[28:31], v[204:207], a[0:3], v[28:31]
s_barrier
v_mfma_f32_16x16x32_bf16 v[48:51], v[128:131], a[0:3], 0
s_nop 0
ds_read_b64_tr_b16 v[192:193], v8 offset:32768
ds_read_b64_tr_b16 v[194:195], v8 offset:34816
v_mfma_f32_16x16x32_bf16 v[48:51], v[144:147], a[4:7], v[48:51]
s_nop 0
ds_read_b64_tr_b16 v[196:197], v9 offset:32768
ds_read_b64_tr_b16 v[198:199], v9 offset:34816
v_mfma_f32_16x16x32_bf16 v[48:51], v[160:163], a[8:11], v[48:51]
s_nop 0
ds_read_b64_tr_b16 v[200:201], v10 offset:32768
ds_read_b64_tr_b16 v[202:203], v10 offset:34816
v_mfma_f32_16x16x32_bf16 v[48:51], v[176:179], a[12:15], v[48:51]
s_add_u32 s72, s71, 15360
buffer_load_dwordx4 v15, s[24:27], s72 offen offset:1024 lds
v_mfma_f32_16x16x32_bf16 v[64:67], v[176:179], a[28:31], 0
buffer_load_dwordx4 a[76:79], v1, s[44:47], s69 offen offset:3072 sc1
v_mfma_f32_16x16x32_bf16 v[64:67], v[160:163], a[24:27], v[64:67]
s_nop 0
ds_read_b64_tr_b16 v[204:205], v11 offset:32768
ds_read_b64_tr_b16 v[206:207], v11 offset:34816
v_mfma_f32_16x16x32_bf16 v[64:67], v[144:147], a[20:23], v[64:67]
v_mfma_f32_16x16x32_bf16 v[64:67], v[128:131], a[16:19], v[64:67]
s_nop 0
ds_read_b64_tr_b16 v[208:209], v8 offset:36864
ds_read_b64_tr_b16 v[210:211], v8 offset:38912
v_mfma_f32_16x16x32_bf16 v[68:71], v[132:135], a[16:19], 0
s_nop 0
ds_read_b64_tr_b16 v[212:213], v9 offset:36864
ds_read_b64_tr_b16 v[214:215], v9 offset:38912
v_mfma_f32_16x16x32_bf16 v[68:71], v[148:151], a[20:23], v[68:71]
s_add_u32 s72, s71, 30720
buffer_load_dwordx4 v15, s[24:27], s72 offen offset:2048 lds
v_mfma_f32_16x16x32_bf16 v[68:71], v[164:167], a[24:27], v[68:71]
s_nop 0
ds_read_b64_tr_b16 v[216:217], v10 offset:36864
ds_read_b64_tr_b16 v[218:219], v10 offset:38912
v_mfma_f32_16x16x32_bf16 v[68:71], v[180:183], a[28:31], v[68:71]
s_nop 0
ds_read_b64_tr_b16 v[220:221], v11 offset:36864
ds_read_b64_tr_b16 v[222:223], v11 offset:38912
v_mfma_f32_16x16x32_bf16 v[52:55], v[180:183], a[12:15], 0
v_mfma_f32_16x16x32_bf16 v[52:55], v[164:167], a[8:11], v[52:55]
s_add_u32 s69, s69, 0x20000
buffer_load_dwordx4 a[80:83], v1, s[44:47], s69 offen sc1
v_mfma_f32_16x16x32_bf16 v[52:55], v[148:151], a[4:7], v[52:55]
s_nop 0
ds_read_b64_tr_b16 v[224:225], v8 offset:40960
ds_read_b64_tr_b16 v[226:227], v8 offset:43008
v_mfma_f32_16x16x32_bf16 v[52:55], v[132:135], a[0:3], v[52:55]
s_add_u32 s72, s71, 46080
buffer_load_dwordx4 v15, s[24:27], s72 offen offset:3072 lds
v_mfma_f32_16x16x32_bf16 v[56:59], v[136:139], a[0:3], 0
s_nop 0
ds_read_b64_tr_b16 v[228:229], v9 offset:40960
ds_read_b64_tr_b16 v[230:231], v9 offset:43008
v_mfma_f32_16x16x32_bf16 v[56:59], v[152:155], a[4:7], v[56:59]
s_nop 0
ds_read_b64_tr_b16 v[232:233], v10 offset:40960
ds_read_b64_tr_b16 v[234:235], v10 offset:43008
v_mfma_f32_16x16x32_bf16 v[56:59], v[168:171], a[8:11], v[56:59]
s_nop 0
ds_read_b64_tr_b16 v[236:237], v11 offset:40960
ds_read_b64_tr_b16 v[238:239], v11 offset:43008
v_mfma_f32_16x16x32_bf16 v[56:59], v[184:187], a[12:15], v[56:59]
v_mfma_f32_16x16x32_bf16 v[72:75], v[184:187], a[28:31], 0
s_nop 0
ds_read_b64_tr_b16 v[240:241], v8 offset:45056
ds_read_b64_tr_b16 v[242:243], v8 offset:47104
v_mfma_f32_16x16x32_bf16 v[72:75], v[168:171], a[24:27], v[72:75]
s_nop 0
ds_read_b64_tr_b16 v[244:245], v9 offset:45056
ds_read_b64_tr_b16 v[246:247], v9 offset:47104
v_mfma_f32_16x16x32_bf16 v[72:75], v[152:155], a[20:23], v[72:75]
s_nop 0
ds_read_b64_tr_b16 v[248:249], v10 offset:45056
ds_read_b64_tr_b16 v[250:251], v10 offset:47104
v_mfma_f32_16x16x32_bf16 v[72:75], v[136:139], a[16:19], v[72:75]
s_xor_b32 s71, s14, 0x80
buffer_load_dwordx4 a[84:87], v1, s[44:47], s69 offen offset:1024 sc1
v_mfma_f32_16x16x32_bf16 v[76:79], v[140:143], a[16:19], 0
s_add_u32 m0, s85, 32768
ds_read_b64_tr_b16 v[252:253], v11 offset:45056
ds_read_b64_tr_b16 v[254:255], v11 offset:47104
v_mfma_f32_16x16x32_bf16 v[76:79], v[156:159], a[20:23], v[76:79]
s_add_u32 s72, s71, 0
buffer_load_dwordx4 v15, s[24:27], s72 offen lds
v_mfma_f32_16x16x32_bf16 v[76:79], v[172:175], a[24:27], v[76:79]
v_mfma_f32_16x16x32_bf16 v[76:79], v[188:191], a[28:31], v[76:79]
v_mfma_f32_16x16x32_bf16 v[60:63], v[188:191], a[12:15], 0
v_mfma_f32_16x16x32_bf16 v[60:63], v[172:175], a[8:11], v[60:63]
s_add_u32 s72, s71, 15360
v_mfma_f32_16x16x32_bf16 v[60:63], v[156:159], a[4:7], v[60:63]
s_waitcnt vmcnt(35) lgkmcnt(0)
v_mfma_f32_16x16x32_bf16 v[60:63], v[140:143], a[0:3], v[60:63]
s_barrier
buffer_load_dwordx4 v15, s[24:27], s72 offen offset:1024 lds
v_mfma_f32_16x16x32_bf16 v[80:83], v[192:195], a[0:3], 0
s_nop 0
ds_read_b64_tr_b16 v[128:129], v8 offset:49152
ds_read_b64_tr_b16 v[130:131], v8 offset:51200
v_mfma_f32_16x16x32_bf16 v[80:83], v[208:211], a[4:7], v[80:83]
buffer_load_dwordx4 a[88:91], v1, s[44:47], s69 offen offset:2048 sc1
v_mfma_f32_16x16x32_bf16 v[80:83], v[224:227], a[8:11], v[80:83]
s_nop 0
ds_read_b64_tr_b16 v[132:133], v9 offset:49152
ds_read_b64_tr_b16 v[134:135], v9 offset:51200
v_mfma_f32_16x16x32_bf16 v[80:83], v[240:243], a[12:15], v[80:83]
s_nop 0
ds_read_b64_tr_b16 v[136:137], v10 offset:49152
ds_read_b64_tr_b16 v[138:139], v10 offset:51200
v_mfma_f32_16x16x32_bf16 v[96:99], v[240:243], a[28:31], 0
s_nop 0
ds_read_b64_tr_b16 v[140:141], v11 offset:49152
ds_read_b64_tr_b16 v[142:143], v11 offset:51200
v_mfma_f32_16x16x32_bf16 v[96:99], v[224:227], a[24:27], v[96:99]
s_add_u32 s72, s71, 30720
buffer_load_dwordx4 v15, s[24:27], s72 offen offset:2048 lds
v_mfma_f32_16x16x32_bf16 v[96:99], v[208:211], a[20:23], v[96:99]
v_mfma_f32_16x16x32_bf16 v[96:99], v[192:195], a[16:19], v[96:99]
s_nop 0
ds_read_b64_tr_b16 v[144:145], v8 offset:53248
ds_read_b64_tr_b16 v[146:147], v8 offset:55296
v_mfma_f32_16x16x32_bf16 v[100:103], v[196:199], a[16:19], 0
s_nop 0
ds_read_b64_tr_b16 v[148:149], v9 offset:53248
ds_read_b64_tr_b16 v[150:151], v9 offset:55296
v_mfma_f32_16x16x32_bf16 v[100:103], v[212:215], a[20:23], v[100:103]
s_nop 0
ds_read_b64_tr_b16 v[152:153], v10 offset:53248
ds_read_b64_tr_b16 v[154:155], v10 offset:55296
v_mfma_f32_16x16x32_bf16 v[100:103], v[228:231], a[24:27], v[100:103]
s_nop 0
ds_read_b64_tr_b16 v[156:157], v11 offset:53248
ds_read_b64_tr_b16 v[158:159], v11 offset:55296
v_mfma_f32_16x16x32_bf16 v[100:103], v[244:247], a[28:31], v[100:103]
s_add_u32 s72, s71, 46080
buffer_load_dwordx4 v15, s[24:27], s72 offen offset:3072 lds
v_mfma_f32_16x16x32_bf16 v[84:87], v[244:247], a[12:15], 0
buffer_load_dwordx4 a[92:95], v1, s[44:47], s69 offen offset:3072 sc1
v_mfma_f32_16x16x32_bf16 v[84:87], v[228:231], a[8:11], v[84:87]
v_mfma_f32_16x16x32_bf16 v[84:87], v[212:215], a[4:7], v[84:87]
s_nop 0
ds_read_b64_tr_b16 v[160:161], v8 offset:57344
ds_read_b64_tr_b16 v[162:163], v8 offset:59392
v_mfma_f32_16x16x32_bf16 v[84:87], v[196:199], a[0:3], v[84:87]
s_nop 0
ds_read_b64_tr_b16 v[164:165], v9 offset:57344
ds_read_b64_tr_b16 v[166:167], v9 offset:59392
v_mfma_f32_16x16x32_bf16 v[88:91], v[200:203], a[0:3], 0
s_nop 0
ds_read_b64_tr_b16 v[168:169], v10 offset:57344
ds_read_b64_tr_b16 v[170:171], v10 offset:59392
v_mfma_f32_16x16x32_bf16 v[88:91], v[216:219], a[4:7], v[88:91]
s_xor_b32 s82, s78, 16
ds_read_b64_tr_b16 v[172:173], v11 offset:57344
ds_read_b64_tr_b16 v[174:175], v11 offset:59392
v_mfma_f32_16x16x32_bf16 v[88:91], v[232:235], a[8:11], v[88:91]
s_lshl_b32 s82, s82, 10
v_mfma_f32_16x16x32_bf16 v[88:91], v[248:251], a[12:15], v[88:91]
s_xor_b32 s71, s14, 0x100
ds_read_b64_tr_b16 v[176:177], v8 offset:61440
ds_read_b64_tr_b16 v[178:179], v8 offset:63488
v_mfma_f32_16x16x32_bf16 v[104:107], v[248:251], a[28:31], 0
s_add_u32 m0, s85, 49152
ds_read_b64_tr_b16 v[180:181], v9 offset:61440
ds_read_b64_tr_b16 v[182:183], v9 offset:63488
v_mfma_f32_16x16x32_bf16 v[104:107], v[232:235], a[24:27], v[104:107]
s_add_u32 s72, s71, 0
buffer_load_dwordx4 v15, s[24:27], s72 offen lds
v_mfma_f32_16x16x32_bf16 v[104:107], v[216:219], a[20:23], v[104:107]
s_add_u32 s82, s82, s74
buffer_load_dword v3, v2, s[44:47], s82 offen sc1
v_mfma_f32_16x16x32_bf16 v[104:107], v[200:203], a[16:19], v[104:107]
s_nop 0
ds_read_b64_tr_b16 v[184:185], v10 offset:61440
ds_read_b64_tr_b16 v[186:187], v10 offset:63488
v_mfma_f32_16x16x32_bf16 v[108:111], v[204:207], a[16:19], 0
s_nop 0
ds_read_b64_tr_b16 v[188:189], v11 offset:61440
ds_read_b64_tr_b16 v[190:191], v11 offset:63488
v_mfma_f32_16x16x32_bf16 v[108:111], v[220:223], a[20:23], v[108:111]
v_mfma_f32_16x16x32_bf16 v[108:111], v[236:239], a[24:27], v[108:111]
s_add_u32 s72, s71, 15360
buffer_load_dwordx4 v15, s[24:27], s72 offen offset:1024 lds
v_mfma_f32_16x16x32_bf16 v[108:111], v[252:255], a[28:31], v[108:111]
s_lshr_b32 s69, s15, 18
v_mfma_f32_16x16x32_bf16 v[92:95], v[252:255], a[12:15], 0
s_lshl_b32 s69, s69, 12
v_xor_b32 v8, 0x10000, v8
v_mfma_f32_16x16x32_bf16 v[92:95], v[236:239], a[8:11], v[92:95]
s_add_u32 s69, s69, s95
v_xor_b32 v9, 0x10000, v9
v_mfma_f32_16x16x32_bf16 v[92:95], v[220:223], a[4:7], v[92:95]
s_waitcnt vmcnt(17) lgkmcnt(0)
v_xor_b32 v10, 0x10000, v10
v_mfma_f32_16x16x32_bf16 v[92:95], v[204:207], a[0:3], v[92:95]
s_barrier
buffer_load_dwordx4 a[96:99], v1, s[44:47], s69 offen sc1
v_xor_b32 v11, 0x10000, v11
v_mfma_f32_16x16x32_bf16 v[16:19], v[128:131], a[32:35], v[16:19]
s_add_u32 s72, s71, 30720
buffer_load_dwordx4 v15, s[24:27], s72 offen offset:2048 lds
v_mfma_f32_16x16x32_bf16 v[16:19], v[144:147], a[36:39], v[16:19]
s_nop 0
ds_read_b64_tr_b16 v[192:193], v8 offset:0
ds_read_b64_tr_b16 v[194:195], v8 offset:2048
v_mfma_f32_16x16x32_bf16 v[16:19], v[160:163], a[40:43], v[16:19]
s_nop 0
ds_read_b64_tr_b16 v[196:197], v9 offset:0
ds_read_b64_tr_b16 v[198:199], v9 offset:2048
v_mfma_f32_16x16x32_bf16 v[16:19], v[176:179], a[44:47], v[16:19]
s_nop 0
ds_read_b64_tr_b16 v[200:201], v10 offset:0
ds_read_b64_tr_b16 v[202:203], v10 offset:2048
v_mfma_f32_16x16x32_bf16 v[32:35], v[176:179], a[60:63], v[32:35]
s_nop 0
ds_read_b64_tr_b16 v[204:205], v11 offset:0
ds_read_b64_tr_b16 v[206:207], v11 offset:2048
v_mfma_f32_16x16x32_bf16 v[32:35], v[160:163], a[56:59], v[32:35]
v_or_b32 v112, s58, v0
v_mov_b32 v113, 3
v_mfma_f32_16x16x32_bf16 v[32:35], v[144:147], a[52:55], v[32:35]
s_add_u32 s72, s71, 46080
buffer_load_dwordx4 v15, s[24:27], s72 offen offset:3072 lds
v_mfma_f32_16x16x32_bf16 v[32:35], v[128:131], a[48:51], v[32:35]
s_nop 0
ds_read_b64_tr_b16 v[208:209], v8 offset:4096
ds_read_b64_tr_b16 v[210:211], v8 offset:6144
v_mfma_f32_16x16x32_bf16 v[36:39], v[132:135], a[48:51], v[36:39]
s_nop 0
ds_read_b64_tr_b16 v[212:213], v9 offset:4096
ds_read_b64_tr_b16 v[214:215], v9 offset:6144
v_mfma_f32_16x16x32_bf16 v[36:39], v[148:151], a[52:55], v[36:39]
buffer_load_dwordx4 a[100:103], v1, s[44:47], s69 offen offset:1024 sc1
v_mfma_f32_16x16x32_bf16 v[36:39], v[164:167], a[56:59], v[36:39]
s_nop 0
ds_read_b64_tr_b16 v[216:217], v10 offset:4096
ds_read_b64_tr_b16 v[218:219], v10 offset:6144
v_mfma_f32_16x16x32_bf16 v[36:39], v[180:183], a[60:63], v[36:39]
v_min_u32 v112, 1, v112
v_lshlrev_b32 v112, 30, v112
v_mfma_f32_16x16x32_bf16 v[20:23], v[180:183], a[44:47], v[20:23]
s_nop 0
ds_read_b64_tr_b16 v[220:221], v11 offset:4096
ds_read_b64_tr_b16 v[222:223], v11 offset:6144
v_mfma_f32_16x16x32_bf16 v[20:23], v[164:167], a[40:43], v[20:23]
s_nop 0
ds_read_b64_tr_b16 v[224:225], v8 offset:8192
ds_read_b64_tr_b16 v[226:227], v8 offset:10240
v_mfma_f32_16x16x32_bf16 v[20:23], v[148:151], a[36:39], v[20:23]
s_xor_b32 s71, s14, 0x180
ds_read_b64_tr_b16 v[228:229], v9 offset:8192
ds_read_b64_tr_b16 v[230:231], v9 offset:10240
v_mfma_f32_16x16x32_bf16 v[20:23], v[132:135], a[32:35], v[20:23]
s_add_u32 m0, s77, 0
buffer_store_dword v113, v112, s[44:47], s91 offen sc1
v_mfma_f32_16x16x32_bf16 v[24:27], v[136:139], a[32:35], v[24:27]
s_add_u32 s72, s71, 0
buffer_load_dwordx4 v15, s[24:27], s72 offen lds
v_mfma_f32_16x16x32_bf16 v[24:27], v[152:155], a[36:39], v[24:27]
s_nop 0
ds_read_b64_tr_b16 v[232:233], v10 offset:8192
ds_read_b64_tr_b16 v[234:235], v10 offset:10240
v_mfma_f32_16x16x32_bf16 v[24:27], v[168:171], a[40:43], v[24:27]
s_nop 0
ds_read_b64_tr_b16 v[236:237], v11 offset:8192
ds_read_b64_tr_b16 v[238:239], v11 offset:10240
v_mfma_f32_16x16x32_bf16 v[24:27], v[184:187], a[44:47], v[24:27]
buffer_load_dwordx4 a[104:107], v1, s[44:47], s69 offen offset:2048 sc1
v_mfma_f32_16x16x32_bf16 v[40:43], v[184:187], a[60:63], v[40:43]
s_nop 0
ds_read_b64_tr_b16 v[240:241], v8 offset:12288
ds_read_b64_tr_b16 v[242:243], v8 offset:14336
v_mfma_f32_16x16x32_bf16 v[40:43], v[168:171], a[56:59], v[40:43]
v_mfma_f32_16x16x32_bf16 v[40:43], v[152:155], a[52:55], v[40:43]
s_add_u32 s72, s71, 15360
buffer_load_dwordx4 v15, s[24:27], s72 offen offset:1024 lds
v_mfma_f32_16x16x32_bf16 v[40:43], v[136:139], a[48:51], v[40:43]
s_nop 0
ds_read_b64_tr_b16 v[244:245], v9 offset:12288
ds_read_b64_tr_b16 v[246:247], v9 offset:14336
v_mfma_f32_16x16x32_bf16 v[44:47], v[140:143], a[48:51], v[44:47]
s_nop 0
ds_read_b64_tr_b16 v[248:249], v10 offset:12288
ds_read_b64_tr_b16 v[250:251], v10 offset:14336
v_mfma_f32_16x16x32_bf16 v[44:47], v[156:159], a[52:55], v[44:47]
s_nop 0
ds_read_b64_tr_b16 v[252:253], v11 offset:12288
ds_read_b64_tr_b16 v[254:255], v11 offset:14336
v_mfma_f32_16x16x32_bf16 v[44:47], v[172:175], a[56:59], v[44:47]
v_mfma_f32_16x16x32_bf16 v[44:47], v[188:191], a[60:63], v[44:47]
v_mfma_f32_16x16x32_bf16 v[28:31], v[188:191], a[44:47], v[28:31]
s_add_u32 s72, s71, 30720
buffer_load_dwordx4 v15, s[24:27], s72 offen offset:2048 lds
v_mfma_f32_16x16x32_bf16 v[28:31], v[172:175], a[40:43], v[28:31]
buffer_load_dwordx4 a[108:111], v1, s[44:47], s69 offen offset:3072 sc1
v_mfma_f32_16x16x32_bf16 v[28:31], v[156:159], a[36:39], v[28:31]
s_waitcnt vmcnt(20) lgkmcnt(0)
v_mfma_f32_16x16x32_bf16 v[28:31], v[140:143], a[32:35], v[28:31]
s_barrier
v_mfma_f32_16x16x32_bf16 v[48:51], v[192:195], a[32:35], v[48:51]
s_nop 0
ds_read_b64_tr_b16 v[128:129], v8 offset:16384
ds_read_b64_tr_b16 v[130:131], v8 offset:18432
v_mfma_f32_16x16x32_bf16 v[48:51], v[208:211], a[36:39], v[48:51]
s_nop 0
ds_read_b64_tr_b16 v[132:133], v9 offset:16384
ds_read_b64_tr_b16 v[134:135], v9 offset:18432
v_mfma_f32_16x16x32_bf16 v[48:51], v[224:227], a[40:43], v[48:51]
s_add_u32 s72, s71, 46080
buffer_load_dwordx4 v15, s[24:27], s72 offen offset:3072 lds
v_mfma_f32_16x16x32_bf16 v[48:51], v[240:243], a[44:47], v[48:51]
s_nop 0
ds_read_b64_tr_b16 v[136:137], v10 offset:16384
ds_read_b64_tr_b16 v[138:139], v10 offset:18432
v_mfma_f32_16x16x32_bf16 v[64:67], v[240:243], a[60:63], v[64:67]
s_nop 0
ds_read_b64_tr_b16 v[140:141], v11 offset:16384
ds_read_b64_tr_b16 v[142:143], v11 offset:18432
v_mfma_f32_16x16x32_bf16 v[64:67], v[224:227], a[56:59], v[64:67]
v_and_b32 v120, 15, v0
v_lshrrev_b32 v121, 4, v0
v_mfma_f32_16x16x32_bf16 v[64:67], v[208:211], a[52:55], v[64:67]
s_nop 0
ds_read_b64_tr_b16 v[144:145], v8 offset:20480
ds_read_b64_tr_b16 v[146:147], v8 offset:22528
v_mfma_f32_16x16x32_bf16 v[64:67], v[192:195], a[48:51], v[64:67]
s_add_u32 s69, s69, 0x20000
buffer_load_dwordx4 a[112:115], v1, s[44:47], s69 offen sc1
v_mfma_f32_16x16x32_bf16 v[68:71], v[196:199], a[48:51], v[68:71]
s_nop 0
ds_read_b64_tr_b16 v[148:149], v9 offset:20480
ds_read_b64_tr_b16 v[150:151], v9 offset:22528
v_mfma_f32_16x16x32_bf16 v[68:71], v[212:215], a[52:55], v[68:71]
s_nop 0
ds_read_b64_tr_b16 v[152:153], v10 offset:20480
ds_read_b64_tr_b16 v[154:155], v10 offset:22528
v_mfma_f32_16x16x32_bf16 v[68:71], v[228:231], a[56:59], v[68:71]
s_xor_b32 s71, s15, 0x80
v_lshlrev_b32 v121, 2, v121
v_sub_u32 v120, v120, v121
v_mfma_f32_16x16x32_bf16 v[68:71], v[244:247], a[60:63], v[68:71]
s_add_u32 m0, s77, 16384
ds_read_b64_tr_b16 v[156:157], v11 offset:20480
ds_read_b64_tr_b16 v[158:159], v11 offset:22528
v_mfma_f32_16x16x32_bf16 v[52:55], v[244:247], a[44:47], v[52:55]
s_add_u32 s72, s71, 0
buffer_load_dwordx4 v15, s[24:27], s72 offen lds
v_mfma_f32_16x16x32_bf16 v[52:55], v[228:231], a[40:43], v[52:55]
s_nop 0
ds_read_b64_tr_b16 v[160:161], v8 offset:24576
ds_read_b64_tr_b16 v[162:163], v8 offset:26624
v_mfma_f32_16x16x32_bf16 v[52:55], v[212:215], a[36:39], v[52:55]
s_nop 0
ds_read_b64_tr_b16 v[164:165], v9 offset:24576
ds_read_b64_tr_b16 v[166:167], v9 offset:26624
v_mfma_f32_16x16x32_bf16 v[52:55], v[196:199], a[32:35], v[52:55]
v_min_u32 v120, 4, v120
v_lshlrev_b32 v120, 3, v120
v_mfma_f32_16x16x32_bf16 v[56:59], v[200:203], a[32:35], v[56:59]
s_nop 0
ds_read_b64_tr_b16 v[168:169], v10 offset:24576
ds_read_b64_tr_b16 v[170:171], v10 offset:26624
v_mfma_f32_16x16x32_bf16 v[56:59], v[216:219], a[36:39], v[56:59]
s_add_u32 s72, s71, 15360
buffer_load_dwordx4 v15, s[24:27], s72 offen offset:1024 lds
v_mfma_f32_16x16x32_bf16 v[56:59], v[232:235], a[40:43], v[56:59]
buffer_load_dwordx4 a[116:119], v1, s[44:47], s69 offen offset:1024 sc1
v_mfma_f32_16x16x32_bf16 v[56:59], v[248:251], a[44:47], v[56:59]
s_nop 0
ds_read_b64_tr_b16 v[172:173], v11 offset:24576
ds_read_b64_tr_b16 v[174:175], v11 offset:26624
v_mfma_f32_16x16x32_bf16 v[72:75], v[248:251], a[60:63], v[72:75]
s_nop 0
ds_read_b64_tr_b16 v[176:177], v8 offset:28672
ds_read_b64_tr_b16 v[178:179], v8 offset:30720
v_mfma_f32_16x16x32_bf16 v[72:75], v[232:235], a[56:59], v[72:75]
v_mov_b32 v122, 0x3f80
v_mov_b32 v123, 0
v_mfma_f32_16x16x32_bf16 v[72:75], v[216:219], a[52:55], v[72:75]
s_nop 0
ds_read_b64_tr_b16 v[180:181], v9 offset:28672
ds_read_b64_tr_b16 v[182:183], v9 offset:30720
v_mfma_f32_16x16x32_bf16 v[72:75], v[200:203], a[48:51], v[72:75]
s_add_u32 s72, s71, 30720
buffer_load_dwordx4 v15, s[24:27], s72 offen offset:2048 lds
v_mfma_f32_16x16x32_bf16 v[76:79], v[204:207], a[48:51], v[76:79]
s_nop 0
ds_read_b64_tr_b16 v[184:185], v10 offset:28672
ds_read_b64_tr_b16 v[186:187], v10 offset:30720
v_mfma_f32_16x16x32_bf16 v[76:79], v[220:223], a[52:55], v[76:79]
s_nop 0
ds_read_b64_tr_b16 v[188:189], v11 offset:28672
ds_read_b64_tr_b16 v[190:191], v11 offset:30720
v_mfma_f32_16x16x32_bf16 v[76:79], v[236:239], a[56:59], v[76:79]
Lstube0:
s_cbranch_execz Lstube4
v_lshlrev_b64 v[122:123], v120, v[122:123]
v_mov_b32 v126, 0
v_mfma_f32_16x16x32_bf16 v[76:79], v[252:255], a[60:63], v[76:79]
buffer_load_dwordx4 a[120:123], v1, s[44:47], s69 offen offset:2048 sc1
v_mfma_f32_16x16x32_bf16 v[60:63], v[252:255], a[44:47], v[60:63]
v_lshlrev_b64 v[122:123], v120, v[122:123]
v_mov_b32 v127, 0
v_mfma_f32_16x16x32_bf16 v[60:63], v[236:239], a[40:43], v[60:63]
s_add_u32 s72, s71, 46080
buffer_load_dwordx4 v15, s[24:27], s72 offen offset:3072 lds
v_mfma_f32_16x16x32_bf16 v[60:63], v[220:223], a[36:39], v[60:63]
s_waitcnt vmcnt(22) lgkmcnt(0)
v_mov_b32 v120, 0
v_mov_b32 v121, 0
v_mfma_f32_16x16x32_bf16 v[60:63], v[204:207], a[32:35], v[60:63]
s_barrier
v_mov_b32 v124, v122
v_mov_b32 v125, v123
v_mfma_f32_16x16x32_bf16 v[80:83], v[128:131], a[32:35], v[80:83]
s_nop 0
ds_read_b64_tr_b16 v[192:193], v8 offset:32768
ds_read_b64_tr_b16 v[194:195], v8 offset:34816
v_mfma_f32_16x16x32_bf16 v[80:83], v[144:147], a[36:39], v[80:83]
s_nop 0
ds_read_b64_tr_b16 v[196:197], v9 offset:32768
ds_read_b64_tr_b16 v[198:199], v9 offset:34816
v_mfma_f32_16x16x32_bf16 v[80:83], v[160:163], a[40:43], v[80:83]
s_nop 0
ds_read_b64_tr_b16 v[200:201], v10 offset:32768
ds_read_b64_tr_b16 v[202:203], v10 offset:34816
v_mfma_f32_16x16x32_bf16 v[80:83], v[176:179], a[44:47], v[80:83]
s_nop 0
ds_read_b64_tr_b16 v[204:205], v11 offset:32768
ds_read_b64_tr_b16 v[206:207], v11 offset:34816
v_mfma_f32_16x16x32_bf16 v[96:99], v[176:179], a[60:63], v[96:99]
v_mfma_f32_16x16x32_bf16 v[96:99], v[160:163], a[56:59], v[96:99]
s_xor_b32 s71, s15, 0x100
buffer_load_dwordx4 a[124:127], v1, s[44:47], s69 offen offset:3072 sc1
v_mfma_f32_16x16x32_bf16 v[96:99], v[144:147], a[52:55], v[96:99]
s_add_u32 m0, s77, 32768
ds_read_b64_tr_b16 v[208:209], v8 offset:36864
ds_read_b64_tr_b16 v[210:211], v8 offset:38912
v_mfma_f32_16x16x32_bf16 v[96:99], v[128:131], a[48:51], v[96:99]
s_add_u32 s72, s71, 0
buffer_load_dwordx4 v15, s[24:27], s72 offen lds
v_mfma_f32_16x16x32_bf16 v[100:103], v[132:135], a[48:51], v[100:103]
s_nop 0
ds_read_b64_tr_b16 v[212:213], v9 offset:36864
ds_read_b64_tr_b16 v[214:215], v9 offset:38912
v_mfma_f32_16x16x32_bf16 v[100:103], v[148:151], a[52:55], v[100:103]
s_nop 0
ds_read_b64_tr_b16 v[216:217], v10 offset:36864
ds_read_b64_tr_b16 v[218:219], v10 offset:38912
v_mfma_f32_16x16x32_bf16 v[100:103], v[164:167], a[56:59], v[100:103]
s_nop 0
ds_read_b64_tr_b16 v[220:221], v11 offset:36864
ds_read_b64_tr_b16 v[222:223], v11 offset:38912
v_mfma_f32_16x16x32_bf16 v[100:103], v[180:183], a[60:63], v[100:103]
v_mfma_f32_16x16x32_bf16 v[84:87], v[180:183], a[44:47], v[84:87]
s_nop 0
ds_read_b64_tr_b16 v[224:225], v8 offset:40960
ds_read_b64_tr_b16 v[226:227], v8 offset:43008
v_mfma_f32_16x16x32_bf16 v[84:87], v[164:167], a[40:43], v[84:87]
s_add_u32 s72, s71, 15360
buffer_load_dwordx4 v15, s[24:27], s72 offen offset:1024 lds
v_mfma_f32_16x16x32_bf16 v[84:87], v[148:151], a[36:39], v[84:87]
s_nop 0
ds_read_b64_tr_b16 v[228:229], v9 offset:40960
ds_read_b64_tr_b16 v[230:231], v9 offset:43008
v_mfma_f32_16x16x32_bf16 v[84:87], v[132:135], a[32:35], v[84:87]
s_waitcnt vmcnt(22)
v_cmp_gt_u32 vcc, 2, v3
s_cbranch_vccnz Lspin106
Lback107:
s_lshr_b32 s69, s12, 18
s_lshl_b32 s69, s69, 12
s_add_u32 s69, s69, s95
s_xor_b32 s69, s69, 0x10000
buffer_load_dwordx4 a[128:131], v1, s[44:47], s69 offen sc1
v_mfma_f32_16x16x32_bf16 v[88:91], v[136:139], a[32:35], v[88:91]
s_nop 0
ds_read_b64_tr_b16 v[232:233], v10 offset:40960
ds_read_b64_tr_b16 v[234:235], v10 offset:43008
v_mfma_f32_16x16x32_bf16 v[88:91], v[152:155], a[36:39], v[88:91]
s_nop 0
ds_read_b64_tr_b16 v[236:237], v11 offset:40960
ds_read_b64_tr_b16 v[238:239], v11 offset:43008
v_mfma_f32_16x16x32_bf16 v[88:91], v[168:171], a[40:43], v[88:91]
v_mfma_f32_16x16x32_bf16 v[88:91], v[184:187], a[44:47], v[88:91]
s_add_u32 s72, s71, 30720
buffer_load_dwordx4 v15, s[24:27], s72 offen offset:2048 lds
v_mfma_f32_16x16x32_bf16 v[104:107], v[184:187], a[60:63], v[104:107]
s_nop 0
ds_read_b64_tr_b16 v[240:241], v8 offset:45056
ds_read_b64_tr_b16 v[242:243], v8 offset:47104
v_mfma_f32_16x16x32_bf16 v[104:107], v[168:171], a[56:59], v[104:107]
s_nop 0
ds_read_b64_tr_b16 v[244:245], v9 offset:45056
ds_read_b64_tr_b16 v[246:247], v9 offset:47104
v_mfma_f32_16x16x32_bf16 v[104:107], v[152:155], a[52:55], v[104:107]
s_nop 0
ds_read_b64_tr_b16 v[248:249], v10 offset:45056
ds_read_b64_tr_b16 v[250:251], v10 offset:47104
v_mfma_f32_16x16x32_bf16 v[104:107], v[136:139], a[48:51], v[104:107]
s_nop 0
ds_read_b64_tr_b16 v[252:253], v11 offset:45056
ds_read_b64_tr_b16 v[254:255], v11 offset:47104
v_mfma_f32_16x16x32_bf16 v[108:111], v[140:143], a[48:51], v[108:111]
v_mfma_f32_16x16x32_bf16 v[108:111], v[156:159], a[52:55], v[108:111]
s_add_u32 s72, s71, 46080
buffer_load_dwordx4 v15, s[24:27], s72 offen offset:3072 lds
v_mfma_f32_16x16x32_bf16 v[108:111], v[172:175], a[56:59], v[108:111]
buffer_load_dwordx4 a[132:135], v1, s[44:47], s69 offen offset:1024 sc1
v_mfma_f32_16x16x32_bf16 v[108:111], v[188:191], a[60:63], v[108:111]
v_mfma_f32_16x16x32_bf16 v[92:95], v[188:191], a[44:47], v[92:95]
v_mfma_f32_16x16x32_bf16 v[92:95], v[172:175], a[40:43], v[92:95]
v_mfma_f32_16x16x32_bf16 v[92:95], v[156:159], a[36:39], v[92:95]
s_waitcnt vmcnt(22) lgkmcnt(0)
v_mfma_f32_16x16x32_bf16 v[92:95], v[140:143], a[32:35], v[92:95]
s_barrier
v_mfma_f32_16x16x32_bf16 v[16:19], v[192:195], a[64:67], v[16:19]
s_nop 0
ds_read_b64_tr_b16 v[128:129], v8 offset:49152
ds_read_b64_tr_b16 v[130:131], v8 offset:51200
v_mfma_f32_16x16x32_bf16 v[16:19], v[208:211], a[68:71], v[16:19]
s_xor_b32 s71, s15, 0x180
ds_read_b64_tr_b16 v[132:133], v9 offset:49152
ds_read_b64_tr_b16 v[134:135], v9 offset:51200
v_mfma_f32_16x16x32_bf16 v[16:19], v[224:227], a[72:75], v[16:19]
s_add_u32 m0, s77, 49152
ds_read_b64_tr_b16 v[136:137], v10 offset:49152
ds_read_b64_tr_b16 v[138:139], v10 offset:51200
v_mfma_f32_16x16x32_bf16 v[16:19], v[240:243], a[76:79], v[16:19]
s_add_u32 s72, s71, 0
buffer_load_dwordx4 v15, s[24:27], s72 offen lds
v_mfma_f32_16x16x32_bf16 v[32:35], v[240:243], a[92:95], v[32:35]
buffer_load_dwordx4 a[136:139], v1, s[44:47], s69 offen offset:2048 sc1
v_mfma_f32_16x16x32_bf16 v[32:35], v[224:227], a[88:91], v[32:35]
s_nop 0
ds_read_b64_tr_b16 v[140:141], v11 offset:49152
ds_read_b64_tr_b16 v[142:143], v11 offset:51200
v_mfma_f32_16x16x32_bf16 v[32:35], v[208:211], a[84:87], v[32:35]
v_mfma_f32_16x16x32_bf16 v[32:35], v[192:195], a[80:83], v[32:35]
s_nop 0
ds_read_b64_tr_b16 v[144:145], v8 offset:53248
ds_read_b64_tr_b16 v[146:147], v8 offset:55296
v_mfma_f32_16x16x32_bf16 v[36:39], v[196:199], a[80:83], v[36:39]
s_add_u32 s72, s71, 15360
buffer_load_dwordx4 v15, s[24:27], s72 offen offset:1024 lds
v_mfma_f32_16x16x32_bf16 v[36:39], v[212:215], a[84:87], v[36:39]
s_nop 0
ds_read_b64_tr_b16 v[148:149], v9 offset:53248
ds_read_b64_tr_b16 v[150:151], v9 offset:55296
v_mfma_f32_16x16x32_bf16 v[36:39], v[228:231], a[88:91], v[36:39]
s_nop 0
ds_read_b64_tr_b16 v[152:153], v10 offset:53248
ds_read_b64_tr_b16 v[154:155], v10 offset:55296
v_mfma_f32_16x16x32_bf16 v[36:39], v[244:247], a[92:95], v[36:39]
s_nop 0
ds_read_b64_tr_b16 v[156:157], v11 offset:53248
ds_read_b64_tr_b16 v[158:159], v11 offset:55296
v_mfma_f32_16x16x32_bf16 v[20:23], v[244:247], a[76:79], v[20:23]
v_mfma_f32_16x16x32_bf16 v[20:23], v[228:231], a[72:75], v[20:23]
buffer_load_dwordx4 a[140:143], v1, s[44:47], s69 offen offset:3072 sc1
v_mfma_f32_16x16x32_bf16 v[20:23], v[212:215], a[68:71], v[20:23]
s_add_u32 s72, s71, 30720
buffer_load_dwordx4 v15, s[24:27], s72 offen offset:2048 lds
v_mfma_f32_16x16x32_bf16 v[20:23], v[196:199], a[64:67], v[20:23]
s_nop 0
ds_read_b64_tr_b16 v[160:161], v8 offset:57344
ds_read_b64_tr_b16 v[162:163], v8 offset:59392
v_mfma_f32_16x16x32_bf16 v[24:27], v[200:203], a[64:67], v[24:27]
s_nop 0
ds_read_b64_tr_b16 v[164:165], v9 offset:57344
ds_read_b64_tr_b16 v[166:167], v9 offset:59392
v_mfma_f32_16x16x32_bf16 v[24:27], v[216:219], a[68:71], v[24:27]
s_nop 0
ds_read_b64_tr_b16 v[168:169], v10 offset:57344
ds_read_b64_tr_b16 v[170:171], v10 offset:59392
v_mfma_f32_16x16x32_bf16 v[24:27], v[232:235], a[72:75], v[24:27]
s_nop 0
ds_read_b64_tr_b16 v[172:173], v11 offset:57344
ds_read_b64_tr_b16 v[174:175], v11 offset:59392
v_mfma_f32_16x16x32_bf16 v[24:27], v[248:251], a[76:79], v[24:27]
v_mfma_f32_16x16x32_bf16 v[40:43], v[248:251], a[92:95], v[40:43]
s_add_u32 s72, s71, 46080
buffer_load_dwordx4 v15, s[24:27], s72 offen offset:3072 lds
v_mfma_f32_16x16x32_bf16 v[40:43], v[232:235], a[88:91], v[40:43]
s_nop 0
ds_read_b64_tr_b16 v[176:177], v8 offset:61440
ds_read_b64_tr_b16 v[178:179], v8 offset:63488
v_mfma_f32_16x16x32_bf16 v[40:43], v[216:219], a[84:87], v[40:43]
s_nop 0
ds_read_b64_tr_b16 v[180:181], v9 offset:61440
ds_read_b64_tr_b16 v[182:183], v9 offset:63488
v_mfma_f32_16x16x32_bf16 v[40:43], v[200:203], a[80:83], v[40:43]
s_add_u32 s69, s69, 0x20000
buffer_load_dwordx4 a[144:147], v1, s[44:47], s69 offen sc1
v_mfma_f32_16x16x32_bf16 v[44:47], v[204:207], a[80:83], v[44:47]
s_nop 0
ds_read_b64_tr_b16 v[184:185], v10 offset:61440
ds_read_b64_tr_b16 v[186:187], v10 offset:63488
v_mfma_f32_16x16x32_bf16 v[44:47], v[220:223], a[84:87], v[44:47]
s_nop 0
ds_read_b64_tr_b16 v[188:189], v11 offset:61440
ds_read_b64_tr_b16 v[190:191], v11 offset:63488
v_mfma_f32_16x16x32_bf16 v[44:47], v[236:239], a[88:91], v[44:47]
v_mfma_f32_16x16x32_bf16 v[44:47], v[252:255], a[92:95], v[44:47]
s_xor_b32 s71, s12, 0x400080
v_mfma_f32_16x16x32_bf16 v[28:31], v[252:255], a[76:79], v[28:31]
s_add_u32 m0, s85, 0
v_xor_b32 v8, 0x10000, v8
v_mfma_f32_16x16x32_bf16 v[28:31], v[236:239], a[72:75], v[28:31]
s_add_u32 s72, s71, 0
v_xor_b32 v9, 0x10000, v9
v_mfma_f32_16x16x32_bf16 v[28:31], v[220:223], a[68:71], v[28:31]
s_waitcnt vmcnt(21) lgkmcnt(0)
buffer_load_dwordx4 v15, s[24:27], s72 offen lds
v_xor_b32 v10, 0x10000, v10
v_mfma_f32_16x16x32_bf16 v[28:31], v[204:207], a[64:67], v[28:31]
s_barrier
v_xor_b32 v11, 0x10000, v11
v_mfma_f32_16x16x32_bf16 v[48:51], v[128:131], a[64:67], v[48:51]
s_nop 0
ds_read_b64_tr_b16 v[192:193], v8 offset:0
ds_read_b64_tr_b16 v[194:195], v8 offset:2048
v_mfma_f32_16x16x32_bf16 v[48:51], v[144:147], a[68:71], v[48:51]
buffer_load_dwordx4 a[148:151], v1, s[44:47], s69 offen offset:1024 sc1
v_mfma_f32_16x16x32_bf16 v[48:51], v[160:163], a[72:75], v[48:51]
s_nop 0
ds_read_b64_tr_b16 v[196:197], v9 offset:0
ds_read_b64_tr_b16 v[198:199], v9 offset:2048
v_mfma_f32_16x16x32_bf16 v[48:51], v[176:179], a[76:79], v[48:51]
s_add_u32 s72, s71, 15360
buffer_load_dwordx4 v15, s[24:27], s72 offen offset:1024 lds
v_mfma_f32_16x16x32_bf16 v[64:67], v[176:179], a[92:95], v[64:67]
s_nop 0
ds_read_b64_tr_b16 v[200:201], v10 offset:0
ds_read_b64_tr_b16 v[202:203], v10 offset:2048
v_mfma_f32_16x16x32_bf16 v[64:67], v[160:163], a[88:91], v[64:67]
s_nop 0
ds_read_b64_tr_b16 v[204:205], v11 offset:0
ds_read_b64_tr_b16 v[206:207], v11 offset:2048
v_mfma_f32_16x16x32_bf16 v[64:67], v[144:147], a[84:87], v[64:67]
v_mfma_f32_16x16x32_bf16 v[64:67], v[128:131], a[80:83], v[64:67]
s_nop 0
ds_read_b64_tr_b16 v[208:209], v8 offset:4096
ds_read_b64_tr_b16 v[210:211], v8 offset:6144
v_mfma_f32_16x16x32_bf16 v[68:71], v[132:135], a[80:83], v[68:71]
s_nop 0
ds_read_b64_tr_b16 v[212:213], v9 offset:4096
ds_read_b64_tr_b16 v[214:215], v9 offset:6144
v_mfma_f32_16x16x32_bf16 v[68:71], v[148:151], a[84:87], v[68:71]
s_add_u32 s72, s71, 30720
buffer_load_dwordx4 v15, s[24:27], s72 offen offset:2048 lds
v_mfma_f32_16x16x32_bf16 v[68:71], v[164:167], a[88:91], v[68:71]
s_nop 0
ds_read_b64_tr_b16 v[216:217], v10 offset:4096
ds_read_b64_tr_b16 v[218:219], v10 offset:6144
v_mfma_f32_16x16x32_bf16 v[68:71], v[180:183], a[92:95], v[68:71]
buffer_load_dwordx4 a[152:155], v1, s[44:47], s69 offen offset:2048 sc1
v_mfma_f32_16x16x32_bf16 v[52:55], v[180:183], a[76:79], v[52:55]
s_nop 0
ds_read_b64_tr_b16 v[220:221], v11 offset:4096
ds_read_b64_tr_b16 v[222:223], v11 offset:6144
v_mfma_f32_16x16x32_bf16 v[52:55], v[164:167], a[72:75], v[52:55]
v_mfma_f32_16x16x32_bf16 v[52:55], v[148:151], a[68:71], v[52:55]
s_nop 0
ds_read_b64_tr_b16 v[224:225], v8 offset:8192
ds_read_b64_tr_b16 v[226:227], v8 offset:10240
v_mfma_f32_16x16x32_bf16 v[52:55], v[132:135], a[64:67], v[52:55]
s_add_u32 s72, s71, 46080
buffer_load_dwordx4 v15, s[24:27], s72 offen offset:3072 lds
v_mfma_f32_16x16x32_bf16 v[56:59], v[136:139], a[64:67], v[56:59]
s_nop 0
ds_read_b64_tr_b16 v[228:229], v9 offset:8192
ds_read_b64_tr_b16 v[230:231], v9 offset:10240
v_mfma_f32_16x16x32_bf16 v[56:59], v[152:155], a[68:71], v[56:59]
s_nop 0
ds_read_b64_tr_b16 v[232:233], v10 offset:8192
ds_read_b64_tr_b16 v[234:235], v10 offset:10240
v_mfma_f32_16x16x32_bf16 v[56:59], v[168:171], a[72:75], v[56:59]
s_nop 0
ds_read_b64_tr_b16 v[236:237], v11 offset:8192
ds_read_b64_tr_b16 v[238:239], v11 offset:10240
v_mfma_f32_16x16x32_bf16 v[56:59], v[184:187], a[76:79], v[56:59]
v_mfma_f32_16x16x32_bf16 v[72:75], v[184:187], a[92:95], v[72:75]
s_nop 0
ds_read_b64_tr_b16 v[240:241], v8 offset:12288
ds_read_b64_tr_b16 v[242:243], v8 offset:14336
v_mfma_f32_16x16x32_bf16 v[72:75], v[168:171], a[88:91], v[72:75]
buffer_load_dwordx4 a[156:159], v1, s[44:47], s69 offen offset:3072 sc1
v_mfma_f32_16x16x32_bf16 v[72:75], v[152:155], a[84:87], v[72:75]
s_lshr_b32 s69, s13, 18
ds_read_b64_tr_b16 v[244:245], v9 offset:12288
ds_read_b64_tr_b16 v[246:247], v9 offset:14336
v_mfma_f32_16x16x32_bf16 v[72:75], v[136:139], a[80:83], v[72:75]
s_xor_b32 s71, s12, 0x400100
ds_read_b64_tr_b16 v[248:249], v10 offset:12288
ds_read_b64_tr_b16 v[250:251], v10 offset:14336
v_mfma_f32_16x16x32_bf16 v[76:79], v[140:143], a[80:83], v[76:79]
s_add_u32 m0, s85, 16384
ds_read_b64_tr_b16 v[252:253], v11 offset:12288
ds_read_b64_tr_b16 v[254:255], v11 offset:14336
v_mfma_f32_16x16x32_bf16 v[76:79], v[156:159], a[84:87], v[76:79]
s_add_u32 s72, s71, 0
buffer_load_dwordx4 v15, s[24:27], s72 offen lds
v_mfma_f32_16x16x32_bf16 v[76:79], v[172:175], a[88:91], v[76:79]
s_lshl_b32 s69, s69, 12
v_mfma_f32_16x16x32_bf16 v[76:79], v[188:191], a[92:95], v[76:79]
s_add_u32 s69, s69, s95
v_mfma_f32_16x16x32_bf16 v[60:63], v[188:191], a[76:79], v[60:63]
s_xor_b32 s69, s69, 0x10000
v_mfma_f32_16x16x32_bf16 v[60:63], v[172:175], a[72:75], v[60:63]
s_add_u32 s72, s71, 15360
v_mfma_f32_16x16x32_bf16 v[60:63], v[156:159], a[68:71], v[60:63]
s_waitcnt vmcnt(22) lgkmcnt(0)
buffer_load_dwordx4 a[160:163], v1, s[44:47], s69 offen sc1
v_mfma_f32_16x16x32_bf16 v[60:63], v[140:143], a[64:67], v[60:63]
s_barrier
buffer_load_dwordx4 v15, s[24:27], s72 offen offset:1024 lds
v_mfma_f32_16x16x32_bf16 v[80:83], v[192:195], a[64:67], v[80:83]
s_and_b32 s79, s91, 0xffffcfff
v_lshlrev_b32 v13, 2, v2
buffer_load_dword v14, v13, s[44:47], s79 offen sc1
v_mfma_f32_16x16x32_bf16 v[80:83], v[208:211], a[68:71], v[80:83]
s_nop 0
ds_read_b64_tr_b16 v[128:129], v8 offset:16384
ds_read_b64_tr_b16 v[130:131], v8 offset:18432
v_mfma_f32_16x16x32_bf16 v[80:83], v[224:227], a[72:75], v[80:83]
s_nop 0
ds_read_b64_tr_b16 v[132:133], v9 offset:16384
ds_read_b64_tr_b16 v[134:135], v9 offset:18432
v_mfma_f32_16x16x32_bf16 v[80:83], v[240:243], a[76:79], v[80:83]
s_nop 0
ds_read_b64_tr_b16 v[136:137], v10 offset:16384
ds_read_b64_tr_b16 v[138:139], v10 offset:18432
v_mfma_f32_16x16x32_bf16 v[96:99], v[240:243], a[92:95], v[96:99]
s_nop 0
ds_read_b64_tr_b16 v[140:141], v11 offset:16384
ds_read_b64_tr_b16 v[142:143], v11 offset:18432
v_mfma_f32_16x16x32_bf16 v[96:99], v[224:227], a[88:91], v[96:99]
s_add_u32 s72, s71, 30720
buffer_load_dwordx4 v15, s[24:27], s72 offen offset:2048 lds
v_mfma_f32_16x16x32_bf16 v[96:99], v[208:211], a[84:87], v[96:99]
v_mfma_f32_16x16x32_bf16 v[96:99], v[192:195], a[80:83], v[96:99]
s_nop 0
ds_read_b64_tr_b16 v[144:145], v8 offset:20480
ds_read_b64_tr_b16 v[146:147], v8 offset:22528
v_mfma_f32_16x16x32_bf16 v[100:103], v[196:199], a[80:83], v[100:103]
buffer_load_dwordx4 a[164:167], v1, s[44:47], s69 offen offset:1024 sc1
v_mfma_f32_16x16x32_bf16 v[100:103], v[212:215], a[84:87], v[100:103]
s_nop 0
ds_read_b64_tr_b16 v[148:149], v9 offset:20480
ds_read_b64_tr_b16 v[150:151], v9 offset:22528
v_mfma_f32_16x16x32_bf16 v[100:103], v[228:231], a[88:91], v[100:103]
s_nop 0
ds_read_b64_tr_b16 v[152:153], v10 offset:20480
ds_read_b64_tr_b16 v[154:155], v10 offset:22528
v_mfma_f32_16x16x32_bf16 v[100:103], v[244:247], a[92:95], v[100:103]
s_add_u32 s72, s71, 46080
buffer_load_dwordx4 v15, s[24:27], s72 offen offset:3072 lds
v_mfma_f32_16x16x32_bf16 v[84:87], v[244:247], a[76:79], v[84:87]
s_nop 0
ds_read_b64_tr_b16 v[156:157], v11 offset:20480
ds_read_b64_tr_b16 v[158:159], v11 offset:22528
v_mfma_f32_16x16x32_bf16 v[84:87], v[228:231], a[72:75], v[84:87]
v_mfma_f32_16x16x32_bf16 v[84:87], v[212:215], a[68:71], v[84:87]
s_nop 0
ds_read_b64_tr_b16 v[160:161], v8 offset:24576
ds_read_b64_tr_b16 v[162:163], v8 offset:26624
v_mfma_f32_16x16x32_bf16 v[84:87], v[196:199], a[64:67], v[84:87]
s_nop 0
ds_read_b64_tr_b16 v[164:165], v9 offset:24576
ds_read_b64_tr_b16 v[166:167], v9 offset:26624
v_mfma_f32_16x16x32_bf16 v[88:91], v[200:203], a[64:67], v[88:91]
s_nop 0
ds_read_b64_tr_b16 v[168:169], v10 offset:24576
ds_read_b64_tr_b16 v[170:171], v10 offset:26624
v_mfma_f32_16x16x32_bf16 v[88:91], v[216:219], a[68:71], v[88:91]
s_nop 0
ds_read_b64_tr_b16 v[172:173], v11 offset:24576
ds_read_b64_tr_b16 v[174:175], v11 offset:26624
v_mfma_f32_16x16x32_bf16 v[88:91], v[232:235], a[72:75], v[88:91]
buffer_load_dwordx4 a[168:171], v1, s[44:47], s69 offen offset:2048 sc1
v_mfma_f32_16x16x32_bf16 v[88:91], v[248:251], a[76:79], v[88:91]
s_xor_b32 s71, s12, 0x400180
v_mfma_f32_16x16x32_bf16 v[104:107], v[248:251], a[92:95], v[104:107]
s_add_u32 m0, s85, 32768
ds_read_b64_tr_b16 v[176:177], v8 offset:28672
ds_read_b64_tr_b16 v[178:179], v8 offset:30720
v_mfma_f32_16x16x32_bf16 v[104:107], v[232:235], a[88:91], v[104:107]
s_add_u32 s72, s71, 0
buffer_load_dwordx4 v15, s[24:27], s72 offen lds
v_mfma_f32_16x16x32_bf16 v[104:107], v[216:219], a[84:87], v[104:107]
s_nop 0
ds_read_b64_tr_b16 v[180:181], v9 offset:28672
ds_read_b64_tr_b16 v[182:183], v9 offset:30720
v_mfma_f32_16x16x32_bf16 v[104:107], v[200:203], a[80:83], v[104:107]
s_nop 0
ds_read_b64_tr_b16 v[184:185], v10 offset:28672
ds_read_b64_tr_b16 v[186:187], v10 offset:30720
v_mfma_f32_16x16x32_bf16 v[108:111], v[204:207], a[80:83], v[108:111]
s_nop 0
ds_read_b64_tr_b16 v[188:189], v11 offset:28672
ds_read_b64_tr_b16 v[190:191], v11 offset:30720
v_mfma_f32_16x16x32_bf16 v[108:111], v[220:223], a[84:87], v[108:111]
v_mfma_f32_16x16x32_bf16 v[108:111], v[236:239], a[88:91], v[108:111]
s_add_u32 s72, s71, 15360
buffer_load_dwordx4 v15, s[24:27], s72 offen offset:1024 lds
v_mfma_f32_16x16x32_bf16 v[108:111], v[252:255], a[92:95], v[108:111]
v_mfma_f32_16x16x32_bf16 v[92:95], v[252:255], a[76:79], v[92:95]
buffer_load_dwordx4 a[172:175], v1, s[44:47], s69 offen offset:3072 sc1
v_mfma_f32_16x16x32_bf16 v[92:95], v[236:239], a[72:75], v[92:95]
v_mfma_f32_16x16x32_bf16 v[92:95], v[220:223], a[68:71], v[92:95]
s_waitcnt vmcnt(26) lgkmcnt(0)
v_mfma_f32_16x16x32_bf16 v[92:95], v[204:207], a[64:67], v[92:95]
s_barrier
v_mfma_f32_16x16x32_bf16 v[16:19], v[128:131], a[96:99], v[16:19]
s_add_u32 s72, s71, 30720
buffer_load_dwordx4 v15, s[24:27], s72 offen offset:2048 lds
v_mfma_f32_16x16x32_bf16 v[16:19], v[144:147], a[100:103], v[16:19]
s_nop 0
ds_read_b64_tr_b16 v[192:193], v8 offset:32768
ds_read_b64_tr_b16 v[194:195], v8 offset:34816
v_mfma_f32_16x16x32_bf16 v[16:19], v[160:163], a[104:107], v[16:19]
s_nop 0
ds_read_b64_tr_b16 v[196:197], v9 offset:32768
ds_read_b64_tr_b16 v[198:199], v9 offset:34816
v_mfma_f32_16x16x32_bf16 v[16:19], v[176:179], a[108:111], v[16:19]
s_nop 0
ds_read_b64_tr_b16 v[200:201], v10 offset:32768
ds_read_b64_tr_b16 v[202:203], v10 offset:34816
v_mfma_f32_16x16x32_bf16 v[32:35], v[176:179], a[124:127], v[32:35]
s_nop 0
ds_read_b64_tr_b16 v[204:205], v11 offset:32768
ds_read_b64_tr_b16 v[206:207], v11 offset:34816
v_mfma_f32_16x16x32_bf16 v[32:35], v[160:163], a[120:123], v[32:35]
v_mfma_f32_16x16x32_bf16 v[32:35], v[144:147], a[116:119], v[32:35]
s_add_u32 s72, s71, 46080
buffer_load_dwordx4 v15, s[24:27], s72 offen offset:3072 lds
v_mfma_f32_16x16x32_bf16 v[32:35], v[128:131], a[112:115], v[32:35]
s_add_u32 s69, s69, 0x20000
buffer_load_dwordx4 a[176:179], v1, s[44:47], s69 offen sc1
v_mfma_f32_16x16x32_bf16 v[36:39], v[132:135], a[112:115], v[36:39]
s_nop 0
ds_read_b64_tr_b16 v[208:209], v8 offset:36864
ds_read_b64_tr_b16 v[210:211], v8 offset:38912
v_mfma_f32_16x16x32_bf16 v[36:39], v[148:151], a[116:119], v[36:39]
s_nop 0
ds_read_b64_tr_b16 v[212:213], v9 offset:36864
ds_read_b64_tr_b16 v[214:215], v9 offset:38912
v_mfma_f32_16x16x32_bf16 v[36:39], v[164:167], a[120:123], v[36:39]
s_nop 0
ds_read_b64_tr_b16 v[216:217], v10 offset:36864
ds_read_b64_tr_b16 v[218:219], v10 offset:38912
v_mfma_f32_16x16x32_bf16 v[36:39], v[180:183], a[124:127], v[36:39]
s_nop 0
ds_read_b64_tr_b16 v[220:221], v11 offset:36864
ds_read_b64_tr_b16 v[222:223], v11 offset:38912
v_mfma_f32_16x16x32_bf16 v[20:23], v[180:183], a[108:111], v[20:23]
v_mfma_f32_16x16x32_bf16 v[20:23], v[164:167], a[104:107], v[20:23]
s_nop 0
ds_read_b64_tr_b16 v[224:225], v8 offset:40960
ds_read_b64_tr_b16 v[226:227], v8 offset:43008
v_mfma_f32_16x16x32_bf16 v[20:23], v[148:151], a[100:103], v[20:23]
s_xor_b32 s71, s13, 0x400080
ds_read_b64_tr_b16 v[228:229], v9 offset:40960
ds_read_b64_tr_b16 v[230:231], v9 offset:43008
v_mfma_f32_16x16x32_bf16 v[20:23], v[132:135], a[96:99], v[20:23]
s_add_u32 m0, s85, 49152
ds_read_b64_tr_b16 v[232:233], v10 offset:40960
ds_read_b64_tr_b16 v[234:235], v10 offset:43008
v_mfma_f32_16x16x32_bf16 v[24:27], v[136:139], a[96:99], v[24:27]
s_add_u32 s72, s71, 0
buffer_load_dwordx4 v15, s[24:27], s72 offen lds
v_mfma_f32_16x16x32_bf16 v[24:27], v[152:155], a[100:103], v[24:27]
buffer_load_dwordx4 a[180:183], v1, s[44:47], s69 offen offset:1024 sc1
v_mfma_f32_16x16x32_bf16 v[24:27], v[168:171], a[104:107], v[24:27]
s_nop 0
ds_read_b64_tr_b16 v[236:237], v11 offset:40960
ds_read_b64_tr_b16 v[238:239], v11 offset:43008
v_mfma_f32_16x16x32_bf16 v[24:27], v[184:187], a[108:111], v[24:27]
v_mfma_f32_16x16x32_bf16 v[40:43], v[184:187], a[124:127], v[40:43]
s_nop 0
ds_read_b64_tr_b16 v[240:241], v8 offset:45056
ds_read_b64_tr_b16 v[242:243], v8 offset:47104
v_mfma_f32_16x16x32_bf16 v[40:43], v[168:171], a[120:123], v[40:43]
s_nop 0
ds_read_b64_tr_b16 v[244:245], v9 offset:45056
ds_read_b64_tr_b16 v[246:247], v9 offset:47104
v_mfma_f32_16x16x32_bf16 v[40:43], v[152:155], a[116:119], v[40:43]
s_add_u32 s72, s71, 15360
buffer_load_dwordx4 v15, s[24:27], s72 offen offset:1024 lds
v_mfma_f32_16x16x32_bf16 v[40:43], v[136:139], a[112:115], v[40:43]
s_nop 0
ds_read_b64_tr_b16 v[248:249], v10 offset:45056
ds_read_b64_tr_b16 v[250:251], v10 offset:47104
v_mfma_f32_16x16x32_bf16 v[44:47], v[140:143], a[112:115], v[44:47]
s_nop 0
ds_read_b64_tr_b16 v[252:253], v11 offset:45056
ds_read_b64_tr_b16 v[254:255], v11 offset:47104
v_mfma_f32_16x16x32_bf16 v[44:47], v[156:159], a[116:119], v[44:47]
v_mfma_f32_16x16x32_bf16 v[44:47], v[172:175], a[120:123], v[44:47]
buffer_load_dwordx4 a[184:187], v1, s[44:47], s69 offen offset:2048 sc1
v_mfma_f32_16x16x32_bf16 v[44:47], v[188:191], a[124:127], v[44:47]
v_mfma_f32_16x16x32_bf16 v[28:31], v[188:191], a[108:111], v[28:31]
s_add_u32 s72, s71, 30720
buffer_load_dwordx4 v15, s[24:27], s72 offen offset:2048 lds
v_mfma_f32_16x16x32_bf16 v[28:31], v[172:175], a[104:107], v[28:31]
v_mfma_f32_16x16x32_bf16 v[28:31], v[156:159], a[100:103], v[28:31]
s_waitcnt vmcnt(27) lgkmcnt(0)
v_mfma_f32_16x16x32_bf16 v[28:31], v[140:143], a[96:99], v[28:31]
s_barrier
v_mfma_f32_16x16x32_bf16 v[48:51], v[192:195], a[96:99], v[48:51]
s_nop 0
ds_read_b64_tr_b16 v[128:129], v8 offset:49152
ds_read_b64_tr_b16 v[130:131], v8 offset:51200
v_mfma_f32_16x16x32_bf16 v[48:51], v[208:211], a[100:103], v[48:51]
s_nop 0
ds_read_b64_tr_b16 v[132:133], v9 offset:49152
ds_read_b64_tr_b16 v[134:135], v9 offset:51200
v_mfma_f32_16x16x32_bf16 v[48:51], v[224:227], a[104:107], v[48:51]
s_add_u32 s72, s71, 46080
buffer_load_dwordx4 v15, s[24:27], s72 offen offset:3072 lds
v_mfma_f32_16x16x32_bf16 v[48:51], v[240:243], a[108:111], v[48:51]
s_nop 0
ds_read_b64_tr_b16 v[136:137], v10 offset:49152
ds_read_b64_tr_b16 v[138:139], v10 offset:51200
v_mfma_f32_16x16x32_bf16 v[64:67], v[240:243], a[124:127], v[64:67]
buffer_load_dwordx4 a[188:191], v1, s[44:47], s69 offen offset:3072 sc1
v_mfma_f32_16x16x32_bf16 v[64:67], v[224:227], a[120:123], v[64:67]
s_nop 0
ds_read_b64_tr_b16 v[140:141], v11 offset:49152
ds_read_b64_tr_b16 v[142:143], v11 offset:51200
v_mfma_f32_16x16x32_bf16 v[64:67], v[208:211], a[116:119], v[64:67]
s_nop 0
ds_read_b64_tr_b16 v[144:145], v8 offset:53248
ds_read_b64_tr_b16 v[146:147], v8 offset:55296
v_mfma_f32_16x16x32_bf16 v[64:67], v[192:195], a[112:115], v[64:67]
s_nop 0
ds_read_b64_tr_b16 v[148:149], v9 offset:53248
ds_read_b64_tr_b16 v[150:151], v9 offset:55296
v_mfma_f32_16x16x32_bf16 v[68:71], v[196:199], a[112:115], v[68:71]
s_lshr_b32 s69, s14, 18
v_mfma_f32_16x16x32_bf16 v[68:71], v[212:215], a[116:119], v[68:71]
s_lshl_b32 s69, s69, 12
ds_read_b64_tr_b16 v[152:153], v10 offset:53248
ds_read_b64_tr_b16 v[154:155], v10 offset:55296
v_mfma_f32_16x16x32_bf16 v[68:71], v[228:231], a[120:123], v[68:71]
s_xor_b32 s71, s14, 0x400080
ds_read_b64_tr_b16 v[156:157], v11 offset:53248
ds_read_b64_tr_b16 v[158:159], v11 offset:55296
v_mfma_f32_16x16x32_bf16 v[68:71], v[244:247], a[124:127], v[68:71]
s_add_u32 m0, s77, 0
ds_read_b64_tr_b16 v[160:161], v8 offset:57344
ds_read_b64_tr_b16 v[162:163], v8 offset:59392
v_mfma_f32_16x16x32_bf16 v[52:55], v[244:247], a[108:111], v[52:55]
s_add_u32 s72, s71, 0
buffer_load_dwordx4 v15, s[24:27], s72 offen lds
v_mfma_f32_16x16x32_bf16 v[52:55], v[228:231], a[104:107], v[52:55]
s_add_u32 s69, s69, s95
ds_read_b64_tr_b16 v[164:165], v9 offset:57344
ds_read_b64_tr_b16 v[166:167], v9 offset:59392
v_mfma_f32_16x16x32_bf16 v[52:55], v[212:215], a[100:103], v[52:55]
s_xor_b32 s69, s69, 0x10000
buffer_load_dwordx4 a[192:195], v1, s[44:47], s69 offen sc1
v_mfma_f32_16x16x32_bf16 v[52:55], v[196:199], a[96:99], v[52:55]
s_nop 0
ds_read_b64_tr_b16 v[168:169], v10 offset:57344
ds_read_b64_tr_b16 v[170:171], v10 offset:59392
v_mfma_f32_16x16x32_bf16 v[56:59], v[200:203], a[96:99], v[56:59]
s_waitcnt vmcnt(19)
v_cmp_gt_u32 vcc, 2, v14
s_cbranch_vccnz Lspin112
Lback113:
v_mfma_f32_16x16x32_bf16 v[56:59], v[216:219], a[100:103], v[56:59]
s_add_u32 s72, s71, 15360
Lstube1:
s_cbranch_execz Lrete
buffer_load_dwordx4 v15, s[24:27], s72 offen offset:1024 lds
v_mfma_f32_16x16x32_bf16 v[56:59], v[232:235], a[104:107], v[56:59]
v_mfma_f32_16x16x32_bf16 v[56:59], v[248:251], a[108:111], v[56:59]
s_nop 0
ds_read_b64_tr_b16 v[172:173], v11 offset:57344
ds_read_b64_tr_b16 v[174:175], v11 offset:59392
v_mfma_f32_16x16x32_bf16 v[72:75], v[248:251], a[124:127], v[72:75]
s_nop 0
ds_read_b64_tr_b16 v[176:177], v8 offset:61440
ds_read_b64_tr_b16 v[178:179], v8 offset:63488
v_mfma_f32_16x16x32_bf16 v[72:75], v[232:235], a[120:123], v[72:75]
s_nop 0
ds_read_b64_tr_b16 v[180:181], v9 offset:61440
ds_read_b64_tr_b16 v[182:183], v9 offset:63488
v_mfma_f32_16x16x32_bf16 v[72:75], v[216:219], a[116:119], v[72:75]
s_nop 0
ds_read_b64_tr_b16 v[184:185], v10 offset:61440
ds_read_b64_tr_b16 v[186:187], v10 offset:63488
v_mfma_f32_16x16x32_bf16 v[72:75], v[200:203], a[112:115], v[72:75]
s_add_u32 s72, s71, 30720
buffer_load_dwordx4 v15, s[24:27], s72 offen offset:2048 lds
v_mfma_f32_16x16x32_bf16 v[76:79], v[204:207], a[112:115], v[76:79]
buffer_load_dwordx4 a[196:199], v1, s[44:47], s69 offen offset:1024 sc1
v_mfma_f32_16x16x32_bf16 v[76:79], v[220:223], a[116:119], v[76:79]
s_nop 0
ds_read_b64_tr_b16 v[188:189], v11 offset:61440
ds_read_b64_tr_b16 v[190:191], v11 offset:63488
v_mfma_f32_16x16x32_bf16 v[76:79], v[236:239], a[120:123], v[76:79]
v_mfma_f32_16x16x32_bf16 v[76:79], v[252:255], a[124:127], v[76:79]
v_mfma_f32_16x16x32_bf16 v[60:63], v[252:255], a[108:111], v[60:63]
v_xor_b32 v8, 0x10000, v8
v_mfma_f32_16x16x32_bf16 v[60:63], v[236:239], a[104:107], v[60:63]
s_add_u32 s72, s71, 46080
buffer_load_dwordx4 v15, s[24:27], s72 offen offset:3072 lds
v_xor_b32 v9, 0x10000, v9
v_mfma_f32_16x16x32_bf16 v[60:63], v[220:223], a[100:103], v[60:63]
s_waitcnt vmcnt(28) lgkmcnt(0)
v_xor_b32 v10, 0x10000, v10
v_mfma_f32_16x16x32_bf16 v[60:63], v[204:207], a[96:99], v[60:63]
s_barrier
v_xor_b32 v11, 0x10000, v11
v_mfma_f32_16x16x32_bf16 v[80:83], v[128:131], a[96:99], v[80:83]
s_lshl_b32 s84, s76, 11
ds_read_b64_tr_b16 v[192:193], v8 offset:0
ds_read_b64_tr_b16 v[194:195], v8 offset:2048
v_mfma_f32_16x16x32_bf16 v[80:83], v[144:147], a[100:103], v[80:83]
s_add_u32 s84, s84, 0x3810000
ds_read_b64_tr_b16 v[196:197], v9 offset:0
ds_read_b64_tr_b16 v[198:199], v9 offset:2048
v_mfma_f32_16x16x32_bf16 v[80:83], v[160:163], a[104:107], v[80:83]
buffer_load_dwordx4 a[200:203], v1, s[44:47], s69 offen offset:2048 sc1
v_mfma_f32_16x16x32_bf16 v[80:83], v[176:179], a[108:111], v[80:83]
s_nop 0
ds_read_b64_tr_b16 v[200:201], v10 offset:0
ds_read_b64_tr_b16 v[202:203], v10 offset:2048
v_mfma_f32_16x16x32_bf16 v[96:99], v[176:179], a[124:127], v[96:99]
s_nop 0
ds_read_b64_tr_b16 v[204:205], v11 offset:0
ds_read_b64_tr_b16 v[206:207], v11 offset:2048
v_mfma_f32_16x16x32_bf16 v[96:99], v[160:163], a[120:123], v[96:99]
s_xor_b32 s71, s15, 0x400080
v_lshrrev_b32 v115, 2, v0
v_lshlrev_b32 v115, 7, v115
v_mfma_f32_16x16x32_bf16 v[96:99], v[144:147], a[116:119], v[96:99]
s_add_u32 m0, s77, 16384
ds_read_b64_tr_b16 v[208:209], v8 offset:4096
ds_read_b64_tr_b16 v[210:211], v8 offset:6144
v_mfma_f32_16x16x32_bf16 v[96:99], v[128:131], a[112:115], v[96:99]
s_add_u32 s72, s71, 0
buffer_load_dwordx4 v15, s[24:27], s72 offen lds
v_mfma_f32_16x16x32_bf16 v[100:103], v[132:135], a[112:115], v[100:103]
s_nop 0
ds_read_b64_tr_b16 v[212:213], v9 offset:4096
ds_read_b64_tr_b16 v[214:215], v9 offset:6144
v_mfma_f32_16x16x32_bf16 v[100:103], v[148:151], a[116:119], v[100:103]
s_nop 0
ds_read_b64_tr_b16 v[216:217], v10 offset:4096
ds_read_b64_tr_b16 v[218:219], v10 offset:6144
v_mfma_f32_16x16x32_bf16 v[100:103], v[164:167], a[120:123], v[100:103]
s_nop 0
ds_read_b64_tr_b16 v[220:221], v11 offset:4096
ds_read_b64_tr_b16 v[222:223], v11 offset:6144
v_mfma_f32_16x16x32_bf16 v[100:103], v[180:183], a[124:127], v[100:103]
buffer_load_dword v114, v115, s[44:47], s84 offen sc1
v_mfma_f32_16x16x32_bf16 v[84:87], v[180:183], a[108:111], v[84:87]
buffer_load_dwordx4 a[204:207], v1, s[44:47], s69 offen offset:3072 sc1
v_mfma_f32_16x16x32_bf16 v[84:87], v[164:167], a[104:107], v[84:87]
s_add_u32 s72, s71, 15360
buffer_load_dwordx4 v15, s[24:27], s72 offen offset:1024 lds
v_mfma_f32_16x16x32_bf16 v[84:87], v[148:151], a[100:103], v[84:87]
s_nop 0
ds_read_b64_tr_b16 v[224:225], v8 offset:8192
ds_read_b64_tr_b16 v[226:227], v8 offset:10240
v_mfma_f32_16x16x32_bf16 v[84:87], v[132:135], a[96:99], v[84:87]
s_nop 0
ds_read_b64_tr_b16 v[228:229], v9 offset:8192
ds_read_b64_tr_b16 v[230:231], v9 offset:10240
v_mfma_f32_16x16x32_bf16 v[88:91], v[136:139], a[96:99], v[88:91]
s_nop 0
ds_read_b64_tr_b16 v[232:233], v10 offset:8192
ds_read_b64_tr_b16 v[234:235], v10 offset:10240
v_mfma_f32_16x16x32_bf16 v[88:91], v[152:155], a[100:103], v[88:91]
s_nop 0
ds_read_b64_tr_b16 v[236:237], v11 offset:8192
ds_read_b64_tr_b16 v[238:239], v11 offset:10240
v_mfma_f32_16x16x32_bf16 v[88:91], v[168:171], a[104:107], v[88:91]
v_mfma_f32_16x16x32_bf16 v[88:91], v[184:187], a[108:111], v[88:91]
s_add_u32 s72, s71, 30720
buffer_load_dwordx4 v15, s[24:27], s72 offen offset:2048 lds
v_mfma_f32_16x16x32_bf16 v[104:107], v[184:187], a[124:127], v[104:107]
s_nop 0
ds_read_b64_tr_b16 v[240:241], v8 offset:12288
ds_read_b64_tr_b16 v[242:243], v8 offset:14336
v_mfma_f32_16x16x32_bf16 v[104:107], v[168:171], a[120:123], v[104:107]
s_nop 0
ds_read_b64_tr_b16 v[244:245], v9 offset:12288
ds_read_b64_tr_b16 v[246:247], v9 offset:14336
v_mfma_f32_16x16x32_bf16 v[104:107], v[152:155], a[116:119], v[104:107]
s_add_u32 s69, s69, 0x20000
buffer_load_dwordx4 a[208:211], v1, s[44:47], s69 offen sc1
v_mfma_f32_16x16x32_bf16 v[104:107], v[136:139], a[112:115], v[104:107]
s_nop 0
ds_read_b64_tr_b16 v[248:249], v10 offset:12288
ds_read_b64_tr_b16 v[250:251], v10 offset:14336
v_mfma_f32_16x16x32_bf16 v[108:111], v[140:143], a[112:115], v[108:111]
s_nop 0
ds_read_b64_tr_b16 v[252:253], v11 offset:12288
ds_read_b64_tr_b16 v[254:255], v11 offset:14336
v_mfma_f32_16x16x32_bf16 v[108:111], v[156:159], a[116:119], v[108:111]
s_add_u32 s72, s71, 46080
buffer_load_dwordx4 v15, s[24:27], s72 offen offset:3072 lds
v_mfma_f32_16x16x32_bf16 v[108:111], v[172:175], a[120:123], v[108:111]
v_mfma_f32_16x16x32_bf16 v[108:111], v[188:191], a[124:127], v[108:111]
v_mfma_f32_16x16x32_bf16 v[92:95], v[188:191], a[108:111], v[92:95]
v_mfma_f32_16x16x32_bf16 v[92:95], v[172:175], a[104:107], v[92:95]
v_mfma_f32_16x16x32_bf16 v[92:95], v[156:159], a[100:103], v[92:95]
s_waitcnt vmcnt(28) lgkmcnt(0)
v_mfma_f32_16x16x32_bf16 v[92:95], v[140:143], a[96:99], v[92:95]
s_barrier
v_mfma_f32_16x16x32_bf16 v[16:19], v[192:195], a[128:131], v[16:19]
buffer_load_dwordx4 a[212:215], v1, s[44:47], s69 offen offset:1024 sc1
v_mfma_f32_16x16x32_bf16 v[16:19], v[208:211], a[132:135], v[16:19]
s_xor_b32 s71, s13, 0x400100
ds_read_b64_tr_b16 v[128:129], v8 offset:16384
ds_read_b64_tr_b16 v[130:131], v8 offset:18432
v_mfma_f32_16x16x32_bf16 v[16:19], v[224:227], a[136:139], v[16:19]
s_add_u32 m0, s77, 32768
ds_read_b64_tr_b16 v[132:133], v9 offset:16384
ds_read_b64_tr_b16 v[134:135], v9 offset:18432
v_mfma_f32_16x16x32_bf16 v[16:19], v[240:243], a[140:143], v[16:19]
s_add_u32 s72, s71, 0
buffer_load_dwordx4 v15, s[24:27], s72 offen lds
v_mfma_f32_16x16x32_bf16 v[32:35], v[240:243], a[156:159], v[32:35]
s_nop 0
ds_read_b64_tr_b16 v[136:137], v10 offset:16384
ds_read_b64_tr_b16 v[138:139], v10 offset:18432
v_mfma_f32_16x16x32_bf16 v[32:35], v[224:227], a[152:155], v[32:35]
s_nop 0
ds_read_b64_tr_b16 v[140:141], v11 offset:16384
ds_read_b64_tr_b16 v[142:143], v11 offset:18432
v_mfma_f32_16x16x32_bf16 v[32:35], v[208:211], a[148:151], v[32:35]
v_mfma_f32_16x16x32_bf16 v[32:35], v[192:195], a[144:147], v[32:35]
s_nop 0
ds_read_b64_tr_b16 v[144:145], v8 offset:20480
ds_read_b64_tr_b16 v[146:147], v8 offset:22528
v_mfma_f32_16x16x32_bf16 v[36:39], v[196:199], a[144:147], v[36:39]
s_add_u32 s72, s71, 15360
buffer_load_dwordx4 v15, s[24:27], s72 offen offset:1024 lds
v_mfma_f32_16x16x32_bf16 v[36:39], v[212:215], a[148:151], v[36:39]
s_nop 0
ds_read_b64_tr_b16 v[148:149], v9 offset:20480
ds_read_b64_tr_b16 v[150:151], v9 offset:22528
v_mfma_f32_16x16x32_bf16 v[36:39], v[228:231], a[152:155], v[36:39]
buffer_load_dwordx4 a[216:219], v1, s[44:47], s69 offen offset:2048 sc1
v_mfma_f32_16x16x32_bf16 v[36:39], v[244:247], a[156:159], v[36:39]
s_nop 0
ds_read_b64_tr_b16 v[152:153], v10 offset:20480
ds_read_b64_tr_b16 v[154:155], v10 offset:22528
v_mfma_f32_16x16x32_bf16 v[20:23], v[244:247], a[140:143], v[20:23]
s_nop 0
ds_read_b64_tr_b16 v[156:157], v11 offset:20480
ds_read_b64_tr_b16 v[158:159], v11 offset:22528
v_mfma_f32_16x16x32_bf16 v[20:23], v[228:231], a[136:139], v[20:23]
v_mfma_f32_16x16x32_bf16 v[20:23], v[212:215], a[132:135], v[20:23]
s_add_u32 s72, s71, 30720
buffer_load_dwordx4 v15, s[24:27], s72 offen offset:2048 lds
v_mfma_f32_16x16x32_bf16 v[20:23], v[196:199], a[128:131], v[20:23]
s_nop 0
ds_read_b64_tr_b16 v[160:161], v8 offset:24576
ds_read_b64_tr_b16 v[162:163], v8 offset:26624
v_mfma_f32_16x16x32_bf16 v[24:27], v[200:203], a[128:131], v[24:27]
s_nop 0
ds_read_b64_tr_b16 v[164:165], v9 offset:24576
ds_read_b64_tr_b16 v[166:167], v9 offset:26624
v_mfma_f32_16x16x32_bf16 v[24:27], v[216:219], a[132:135], v[24:27]
s_nop 0
ds_read_b64_tr_b16 v[168:169], v10 offset:24576
ds_read_b64_tr_b16 v[170:171], v10 offset:26624
v_mfma_f32_16x16x32_bf16 v[24:27], v[232:235], a[136:139], v[24:27]
s_nop 0
ds_read_b64_tr_b16 v[172:173], v11 offset:24576
ds_read_b64_tr_b16 v[174:175], v11 offset:26624
v_mfma_f32_16x16x32_bf16 v[24:27], v[248:251], a[140:143], v[24:27]
v_mfma_f32_16x16x32_bf16 v[40:43], v[248:251], a[156:159], v[40:43]
s_add_u32 s72, s71, 46080
buffer_load_dwordx4 v15, s[24:27], s72 offen offset:3072 lds
v_mfma_f32_16x16x32_bf16 v[40:43], v[232:235], a[152:155], v[40:43]
buffer_load_dwordx4 a[220:223], v1, s[44:47], s69 offen offset:3072 sc1
v_mfma_f32_16x16x32_bf16 v[40:43], v[216:219], a[148:151], v[40:43]
s_nop 0
ds_read_b64_tr_b16 v[176:177], v8 offset:28672
ds_read_b64_tr_b16 v[178:179], v8 offset:30720
v_mfma_f32_16x16x32_bf16 v[40:43], v[200:203], a[144:147], v[40:43]
s_lshr_b32 s69, s15, 18
ds_read_b64_tr_b16 v[180:181], v9 offset:28672
ds_read_b64_tr_b16 v[182:183], v9 offset:30720
v_mfma_f32_16x16x32_bf16 v[44:47], v[204:207], a[144:147], v[44:47]
s_lshl_b32 s69, s69, 12
ds_read_b64_tr_b16 v[184:185], v10 offset:28672
ds_read_b64_tr_b16 v[186:187], v10 offset:30720
v_mfma_f32_16x16x32_bf16 v[44:47], v[220:223], a[148:151], v[44:47]
s_add_u32 s69, s69, s95
ds_read_b64_tr_b16 v[188:189], v11 offset:28672
ds_read_b64_tr_b16 v[190:191], v11 offset:30720
v_mfma_f32_16x16x32_bf16 v[44:47], v[236:239], a[152:155], v[44:47]
s_xor_b32 s69, s69, 0x10000
v_mfma_f32_16x16x32_bf16 v[44:47], v[252:255], a[156:159], v[44:47]
s_xor_b32 s71, s14, 0x400100
v_mfma_f32_16x16x32_bf16 v[28:31], v[252:255], a[140:143], v[28:31]
s_add_u32 m0, s77, 49152
v_mfma_f32_16x16x32_bf16 v[28:31], v[236:239], a[136:139], v[28:31]
s_add_u32 s72, s71, 0
v_mfma_f32_16x16x32_bf16 v[28:31], v[220:223], a[132:135], v[28:31]
s_waitcnt vmcnt(29) lgkmcnt(0)
buffer_load_dwordx4 v15, s[24:27], s72 offen lds
v_mfma_f32_16x16x32_bf16 v[28:31], v[204:207], a[128:131], v[28:31]
s_barrier
buffer_load_dwordx4 a[224:227], v1, s[44:47], s69 offen sc1
v_mfma_f32_16x16x32_bf16 v[48:51], v[128:131], a[128:131], v[48:51]
s_nop 0
ds_read_b64_tr_b16 v[192:193], v8 offset:32768
ds_read_b64_tr_b16 v[194:195], v8 offset:34816
v_mfma_f32_16x16x32_bf16 v[48:51], v[144:147], a[132:135], v[48:51]
s_nop 0
ds_read_b64_tr_b16 v[196:197], v9 offset:32768
ds_read_b64_tr_b16 v[198:199], v9 offset:34816
v_mfma_f32_16x16x32_bf16 v[48:51], v[160:163], a[136:139], v[48:51]
s_nop 0
ds_read_b64_tr_b16 v[200:201], v10 offset:32768
ds_read_b64_tr_b16 v[202:203], v10 offset:34816
v_mfma_f32_16x16x32_bf16 v[48:51], v[176:179], a[140:143], v[48:51]
s_add_u32 s72, s71, 15360
buffer_load_dwordx4 v15, s[24:27], s72 offen offset:1024 lds
v_mfma_f32_16x16x32_bf16 v[64:67], v[176:179], a[156:159], v[64:67]
s_nop 0
ds_read_b64_tr_b16 v[204:205], v11 offset:32768
ds_read_b64_tr_b16 v[206:207], v11 offset:34816
v_mfma_f32_16x16x32_bf16 v[64:67], v[160:163], a[152:155], v[64:67]
v_mfma_f32_16x16x32_bf16 v[64:67], v[144:147], a[148:151], v[64:67]
s_nop 0
ds_read_b64_tr_b16 v[208:209], v8 offset:36864
ds_read_b64_tr_b16 v[210:211], v8 offset:38912
v_mfma_f32_16x16x32_bf16 v[64:67], v[128:131], a[144:147], v[64:67]
s_nop 0
ds_read_b64_tr_b16 v[212:213], v9 offset:36864
ds_read_b64_tr_b16 v[214:215], v9 offset:38912
v_mfma_f32_16x16x32_bf16 v[68:71], v[132:135], a[144:147], v[68:71]
buffer_load_dwordx4 a[228:231], v1, s[44:47], s69 offen offset:1024 sc1
v_mfma_f32_16x16x32_bf16 v[68:71], v[148:151], a[148:151], v[68:71]
s_add_u32 s72, s71, 30720
buffer_load_dwordx4 v15, s[24:27], s72 offen offset:2048 lds
v_mfma_f32_16x16x32_bf16 v[68:71], v[164:167], a[152:155], v[68:71]
s_nop 0
ds_read_b64_tr_b16 v[216:217], v10 offset:36864
ds_read_b64_tr_b16 v[218:219], v10 offset:38912
v_mfma_f32_16x16x32_bf16 v[68:71], v[180:183], a[156:159], v[68:71]
v_mfma_f32_16x16x32_bf16 v[52:55], v[180:183], a[140:143], v[52:55]
s_nop 0
ds_read_b64_tr_b16 v[220:221], v11 offset:36864
ds_read_b64_tr_b16 v[222:223], v11 offset:38912
v_mfma_f32_16x16x32_bf16 v[52:55], v[164:167], a[136:139], v[52:55]
s_nop 0
ds_read_b64_tr_b16 v[224:225], v8 offset:40960
ds_read_b64_tr_b16 v[226:227], v8 offset:43008
v_mfma_f32_16x16x32_bf16 v[52:55], v[148:151], a[132:135], v[52:55]
s_nop 0
ds_read_b64_tr_b16 v[228:229], v9 offset:40960
ds_read_b64_tr_b16 v[230:231], v9 offset:43008
v_mfma_f32_16x16x32_bf16 v[52:55], v[132:135], a[128:131], v[52:55]
s_add_u32 s72, s71, 46080
buffer_load_dwordx4 v15, s[24:27], s72 offen offset:3072 lds
v_mfma_f32_16x16x32_bf16 v[56:59], v[136:139], a[128:131], v[56:59]
v_mfma_f32_16x16x32_bf16 v[56:59], v[152:155], a[132:135], v[56:59]
s_nop 0
ds_read_b64_tr_b16 v[232:233], v10 offset:40960
ds_read_b64_tr_b16 v[234:235], v10 offset:43008
v_mfma_f32_16x16x32_bf16 v[56:59], v[168:171], a[136:139], v[56:59]
buffer_load_dwordx4 a[232:235], v1, s[44:47], s69 offen offset:2048 sc1
v_mfma_f32_16x16x32_bf16 v[56:59], v[184:187], a[140:143], v[56:59]
s_nop 0
ds_read_b64_tr_b16 v[236:237], v11 offset:40960
ds_read_b64_tr_b16 v[238:239], v11 offset:43008
v_mfma_f32_16x16x32_bf16 v[72:75], v[184:187], a[156:159], v[72:75]
s_nop 0
ds_read_b64_tr_b16 v[240:241], v8 offset:45056
ds_read_b64_tr_b16 v[242:243], v8 offset:47104
v_mfma_f32_16x16x32_bf16 v[72:75], v[168:171], a[152:155], v[72:75]
v_mfma_f32_16x16x32_bf16 v[72:75], v[152:155], a[148:151], v[72:75]
s_nop 0
ds_read_b64_tr_b16 v[244:245], v9 offset:45056
ds_read_b64_tr_b16 v[246:247], v9 offset:47104
v_mfma_f32_16x16x32_bf16 v[72:75], v[136:139], a[144:147], v[72:75]
s_xor_b32 s71, s15, 0x400100
ds_read_b64_tr_b16 v[248:249], v10 offset:45056
ds_read_b64_tr_b16 v[250:251], v10 offset:47104
v_mfma_f32_16x16x32_bf16 v[76:79], v[140:143], a[144:147], v[76:79]
s_add_u32 m0, s85, 0
ds_read_b64_tr_b16 v[252:253], v11 offset:45056
ds_read_b64_tr_b16 v[254:255], v11 offset:47104
v_mfma_f32_16x16x32_bf16 v[76:79], v[156:159], a[148:151], v[76:79]
s_add_u32 s72, s71, 0
buffer_load_dwordx4 v15, s[24:27], s72 offen lds
v_mfma_f32_16x16x32_bf16 v[76:79], v[172:175], a[152:155], v[76:79]
v_mfma_f32_16x16x32_bf16 v[76:79], v[188:191], a[156:159], v[76:79]
v_mfma_f32_16x16x32_bf16 v[60:63], v[188:191], a[140:143], v[60:63]
buffer_load_dwordx4 a[236:239], v1, s[44:47], s69 offen offset:3072 sc1
v_mfma_f32_16x16x32_bf16 v[60:63], v[172:175], a[136:139], v[60:63]
s_add_u32 s72, s71, 15360
v_mfma_f32_16x16x32_bf16 v[60:63], v[156:159], a[132:135], v[60:63]
s_waitcnt vmcnt(31) lgkmcnt(0)
v_mfma_f32_16x16x32_bf16 v[60:63], v[140:143], a[128:131], v[60:63]
s_barrier
buffer_load_dwordx4 v15, s[24:27], s72 offen offset:1024 lds
v_mfma_f32_16x16x32_bf16 v[80:83], v[192:195], a[128:131], v[80:83]
s_nop 0
ds_read_b64_tr_b16 v[128:129], v8 offset:49152
ds_read_b64_tr_b16 v[130:131], v8 offset:51200
v_mfma_f32_16x16x32_bf16 v[80:83], v[208:211], a[132:135], v[80:83]
s_nop 0
ds_read_b64_tr_b16 v[132:133], v9 offset:49152
ds_read_b64_tr_b16 v[134:135], v9 offset:51200
v_mfma_f32_16x16x32_bf16 v[80:83], v[224:227], a[136:139], v[80:83]
s_nop 0
ds_read_b64_tr_b16 v[136:137], v10 offset:49152
ds_read_b64_tr_b16 v[138:139], v10 offset:51200
s_waitcnt vmcnt(22)
v_cmp_gt_u32 vcc, 3, v114
s_cbranch_vccnz Lspin109
Lback110:
v_mfma_f32_16x16x32_bf16 v[80:83], v[240:243], a[140:143], v[80:83]
s_lshl_b32 s73, s76, 18
ds_read_b64_tr_b16 v[140:141], v11 offset:49152
ds_read_b64_tr_b16 v[142:143], v11 offset:51200
v_mfma_f32_16x16x32_bf16 v[96:99], v[240:243], a[156:159], v[96:99]
s_lshl_b32 s84, s58, 16
v_mfma_f32_16x16x32_bf16 v[96:99], v[224:227], a[152:155], v[96:99]
s_add_u32 s72, s71, 30720
buffer_load_dwordx4 v15, s[24:27], s72 offen offset:2048 lds
v_mfma_f32_16x16x32_bf16 v[96:99], v[208:211], a[148:151], v[96:99]
s_add_u32 s69, s69, 0x20000
buffer_load_dwordx4 a[240:243], v1, s[44:47], s69 offen sc1
v_mfma_f32_16x16x32_bf16 v[96:99], v[192:195], a[144:147], v[96:99]
s_add_u32 s73, s73, s84
ds_read_b64_tr_b16 v[144:145], v8 offset:53248
ds_read_b64_tr_b16 v[146:147], v8 offset:55296
v_mfma_f32_16x16x32_bf16 v[100:103], v[196:199], a[144:147], v[100:103]
s_lshl_b32 s84, s75, 8
ds_read_b64_tr_b16 v[148:149], v9 offset:53248
ds_read_b64_tr_b16 v[150:151], v9 offset:55296
v_mfma_f32_16x16x32_bf16 v[100:103], v[212:215], a[148:151], v[100:103]
s_add_u32 s73, s73, s84
ds_read_b64_tr_b16 v[152:153], v10 offset:53248
ds_read_b64_tr_b16 v[154:155], v10 offset:55296
v_mfma_f32_16x16x32_bf16 v[100:103], v[228:231], a[152:155], v[100:103]
s_add_u32 s73, s73, 0x3400000
v_lshrrev_b32 v112, 4, v0
v_and_b32 v113, 15, v0
v_mfma_f32_16x16x32_bf16 v[100:103], v[244:247], a[156:159], v[100:103]
s_add_u32 s72, s71, 46080
buffer_load_dwordx4 v15, s[24:27], s72 offen offset:3072 lds
v_mfma_f32_16x16x32_bf16 v[84:87], v[244:247], a[140:143], v[84:87]
s_nop 0
ds_read_b64_tr_b16 v[156:157], v11 offset:53248
ds_read_b64_tr_b16 v[158:159], v11 offset:55296
v_mfma_f32_16x16x32_bf16 v[84:87], v[228:231], a[136:139], v[84:87]
s_nop 0
ds_read_b64_tr_b16 v[160:161], v8 offset:57344
ds_read_b64_tr_b16 v[162:163], v8 offset:59392
v_mfma_f32_16x16x32_bf16 v[84:87], v[212:215], a[132:135], v[84:87]
s_nop 0
ds_read_b64_tr_b16 v[164:165], v9 offset:57344
ds_read_b64_tr_b16 v[166:167], v9 offset:59392
v_mfma_f32_16x16x32_bf16 v[84:87], v[196:199], a[128:131], v[84:87]
v_xor_b32 v12, v113, v112
v_lshlrev_b32 v12, 4, v12
v_mfma_f32_16x16x32_bf16 v[88:91], v[200:203], a[128:131], v[88:91]
buffer_load_dwordx4 a[244:247], v1, s[44:47], s69 offen offset:1024 sc1
v_mfma_f32_16x16x32_bf16 v[88:91], v[216:219], a[132:135], v[88:91]
s_nop 0
ds_read_b64_tr_b16 v[168:169], v10 offset:57344
ds_read_b64_tr_b16 v[170:171], v10 offset:59392
v_mfma_f32_16x16x32_bf16 v[88:91], v[232:235], a[136:139], v[88:91]
s_nop 0
ds_read_b64_tr_b16 v[172:173], v11 offset:57344
ds_read_b64_tr_b16 v[174:175], v11 offset:59392
v_mfma_f32_16x16x32_bf16 v[88:91], v[248:251], a[140:143], v[88:91]
s_xor_b32 s71, s13, 0x400180
ds_read_b64_tr_b16 v[176:177], v8 offset:61440
ds_read_b64_tr_b16 v[178:179], v8 offset:63488
v_mfma_f32_16x16x32_bf16 v[104:107], v[248:251], a[156:159], v[104:107]
s_add_u32 m0, s85, 16384
v_lshl_add_u32 v112, v112, 12, v12
v_xor_b32 v12, 64, v112
v_mfma_f32_16x16x32_bf16 v[104:107], v[232:235], a[152:155], v[104:107]
s_add_u32 s72, s71, 0
buffer_load_dwordx4 v15, s[24:27], s72 offen lds
v_mfma_f32_16x16x32_bf16 v[104:107], v[216:219], a[148:151], v[104:107]
s_nop 0
ds_read_b64_tr_b16 v[180:181], v9 offset:61440
ds_read_b64_tr_b16 v[182:183], v9 offset:63488
v_mfma_f32_16x16x32_bf16 v[104:107], v[200:203], a[144:147], v[104:107]
s_nop 0
ds_read_b64_tr_b16 v[184:185], v10 offset:61440
ds_read_b64_tr_b16 v[186:187], v10 offset:63488
v_mfma_f32_16x16x32_bf16 v[108:111], v[204:207], a[144:147], v[108:111]
s_nop 0
ds_read_b64_tr_b16 v[188:189], v11 offset:61440
ds_read_b64_tr_b16 v[190:191], v11 offset:63488
v_mfma_f32_16x16x32_bf16 v[108:111], v[220:223], a[148:151], v[108:111]
v_lshlrev_b32 v113, 2, v113
v_mfma_f32_16x16x32_bf16 v[108:111], v[236:239], a[152:155], v[108:111]
s_add_u32 s72, s71, 15360
buffer_load_dwordx4 v15, s[24:27], s72 offen offset:1024 lds
v_mfma_f32_16x16x32_bf16 v[108:111], v[252:255], a[156:159], v[108:111]
buffer_load_dwordx4 a[248:251], v1, s[44:47], s69 offen offset:2048 sc1
v_mfma_f32_16x16x32_bf16 v[92:95], v[252:255], a[140:143], v[92:95]
v_xor_b32 v8, 0x10000, v8
v_mfma_f32_16x16x32_bf16 v[92:95], v[236:239], a[136:139], v[92:95]
v_xor_b32 v9, 0x10000, v9
v_mfma_f32_16x16x32_bf16 v[92:95], v[220:223], a[132:135], v[92:95]
s_waitcnt vmcnt(32) lgkmcnt(0)
v_xor_b32 v10, 0x10000, v10
v_mfma_f32_16x16x32_bf16 v[92:95], v[204:207], a[128:131], v[92:95]
s_barrier
v_xor_b32 v11, 0x10000, v11
v_mfma_f32_16x16x32_bf16 v[16:19], v[128:131], a[160:163], v[16:19]
s_add_u32 s72, s71, 30720
buffer_load_dwordx4 v15, s[24:27], s72 offen offset:2048 lds
v_mfma_f32_16x16x32_bf16 v[16:19], v[144:147], a[164:167], v[16:19]
s_nop 0
ds_read_b64_tr_b16 v[192:193], v8 offset:0
ds_read_b64_tr_b16 v[194:195], v8 offset:2048
v_mfma_f32_16x16x32_bf16 v[16:19], v[160:163], a[168:171], v[16:19]
s_nop 0
ds_read_b64_tr_b16 v[196:197], v9 offset:0
ds_read_b64_tr_b16 v[198:199], v9 offset:2048
v_mfma_f32_16x16x32_bf16 v[16:19], v[176:179], a[172:175], v[16:19]
s_nop 0
ds_read_b64_tr_b16 v[200:201], v10 offset:0
ds_read_b64_tr_b16 v[202:203], v10 offset:2048
v_mfma_f32_16x16x32_bf16 v[32:35], v[176:179], a[188:191], v[32:35]
buffer_load_dwordx4 a[252:255], v1, s[44:47], s69 offen offset:3072 sc1
v_mfma_f32_16x16x32_bf16 v[32:35], v[160:163], a[184:187], v[32:35]
v_mfma_f32_16x16x32_bf16 v[32:35], v[144:147], a[180:183], v[32:35]
s_add_u32 s72, s71, 46080
buffer_load_dwordx4 v15, s[24:27], s72 offen offset:3072 lds
v_mfma_f32_16x16x32_bf16 v[32:35], v[128:131], a[176:179], v[32:35]
s_nop 0
ds_read_b64_tr_b16 v[204:205], v11 offset:0
ds_read_b64_tr_b16 v[206:207], v11 offset:2048
v_mfma_f32_16x16x32_bf16 v[36:39], v[132:135], a[176:179], v[36:39]
s_nop 0
ds_read_b64_tr_b16 v[208:209], v8 offset:4096
ds_read_b64_tr_b16 v[210:211], v8 offset:6144
v_mfma_f32_16x16x32_bf16 v[36:39], v[148:151], a[180:183], v[36:39]
s_nop 0
ds_read_b64_tr_b16 v[212:213], v9 offset:4096
ds_read_b64_tr_b16 v[214:215], v9 offset:6144
v_mfma_f32_16x16x32_bf16 v[36:39], v[164:167], a[184:187], v[36:39]
v_mfma_f32_16x16x32_bf16 v[36:39], v[180:183], a[188:191], v[36:39]
s_nop 0
ds_read_b64_tr_b16 v[216:217], v10 offset:4096
ds_read_b64_tr_b16 v[218:219], v10 offset:6144
v_mfma_f32_16x16x32_bf16 v[20:23], v[180:183], a[172:175], v[20:23]
s_nop 0
ds_read_b64_tr_b16 v[220:221], v11 offset:4096
ds_read_b64_tr_b16 v[222:223], v11 offset:6144
v_mfma_f32_16x16x32_bf16 v[20:23], v[164:167], a[168:171], v[20:23]
v_mfma_f32_16x16x32_bf16 v[20:23], v[148:151], a[164:167], v[20:23]
s_xor_b32 s71, s14, 0x400180
ds_read_b64_tr_b16 v[224:225], v8 offset:8192
ds_read_b64_tr_b16 v[226:227], v8 offset:10240
v_mfma_f32_16x16x32_bf16 v[20:23], v[132:135], a[160:163], v[20:23]
s_add_u32 m0, s85, 32768
ds_read_b64_tr_b16 v[228:229], v9 offset:8192
ds_read_b64_tr_b16 v[230:231], v9 offset:10240
v_mfma_f32_16x16x32_bf16 v[24:27], v[136:139], a[160:163], v[24:27]
s_add_u32 s72, s71, 0
buffer_load_dwordx4 v15, s[24:27], s72 offen lds
v_mfma_f32_16x16x32_bf16 v[24:27], v[152:155], a[164:167], v[24:27]
s_nop 0
ds_read_b64_tr_b16 v[232:233], v10 offset:8192
ds_read_b64_tr_b16 v[234:235], v10 offset:10240
v_mfma_f32_16x16x32_bf16 v[24:27], v[168:171], a[168:171], v[24:27]
v_mfma_f32_16x16x32_bf16 v[24:27], v[184:187], a[172:175], v[24:27]
s_nop 0
ds_read_b64_tr_b16 v[236:237], v11 offset:8192
ds_read_b64_tr_b16 v[238:239], v11 offset:10240
v_mfma_f32_16x16x32_bf16 v[40:43], v[184:187], a[188:191], v[40:43]
s_nop 0
ds_read_b64_tr_b16 v[240:241], v8 offset:12288
ds_read_b64_tr_b16 v[242:243], v8 offset:14336
v_mfma_f32_16x16x32_bf16 v[40:43], v[168:171], a[184:187], v[40:43]
s_nop 0
ds_read_b64_tr_b16 v[244:245], v9 offset:12288
ds_read_b64_tr_b16 v[246:247], v9 offset:14336
v_mfma_f32_16x16x32_bf16 v[40:43], v[152:155], a[180:183], v[40:43]
s_add_u32 s72, s71, 15360
buffer_load_dwordx4 v15, s[24:27], s72 offen offset:1024 lds
v_mfma_f32_16x16x32_bf16 v[40:43], v[136:139], a[176:179], v[40:43]
v_mfma_f32_16x16x32_bf16 v[44:47], v[140:143], a[176:179], v[44:47]
s_nop 0
ds_read_b64_tr_b16 v[248:249], v10 offset:12288
ds_read_b64_tr_b16 v[250:251], v10 offset:14336
v_mfma_f32_16x16x32_bf16 v[44:47], v[156:159], a[180:183], v[44:47]
s_nop 0
ds_read_b64_tr_b16 v[252:253], v11 offset:12288
ds_read_b64_tr_b16 v[254:255], v11 offset:14336
v_mfma_f32_16x16x32_bf16 v[44:47], v[172:175], a[184:187], v[44:47]
v_mfma_f32_16x16x32_bf16 v[44:47], v[188:191], a[188:191], v[44:47]
v_mfma_f32_16x16x32_bf16 v[28:31], v[188:191], a[172:175], v[28:31]
s_add_u32 s72, s71, 30720
buffer_load_dwordx4 v15, s[24:27], s72 offen offset:2048 lds
v_mfma_f32_16x16x32_bf16 v[28:31], v[172:175], a[168:171], v[28:31]
v_mfma_f32_16x16x32_bf16 v[28:31], v[156:159], a[164:167], v[28:31]
s_waitcnt vmcnt(23) lgkmcnt(0)
v_mfma_f32_16x16x32_bf16 v[28:31], v[140:143], a[160:163], v[28:31]
s_barrier
v_mfma_f32_16x16x32_bf16 v[16:19], v[192:195], a[192:195], v[16:19]
s_nop 0
ds_read_b64_tr_b16 v[128:129], v8 offset:16384
ds_read_b64_tr_b16 v[130:131], v8 offset:18432
v_mfma_f32_16x16x32_bf16 v[16:19], v[208:211], a[196:199], v[16:19]
s_nop 0
ds_read_b64_tr_b16 v[132:133], v9 offset:16384
ds_read_b64_tr_b16 v[134:135], v9 offset:18432
v_mfma_f32_16x16x32_bf16 v[16:19], v[224:227], a[200:203], v[16:19]
s_add_u32 s72, s71, 46080
buffer_load_dwordx4 v15, s[24:27], s72 offen offset:3072 lds
v_mfma_f32_16x16x32_bf16 v[16:19], v[240:243], a[204:207], v[16:19]
s_nop 0
ds_read_b64_tr_b16 v[136:137], v10 offset:16384
ds_read_b64_tr_b16 v[138:139], v10 offset:18432
v_mfma_f32_16x16x32_bf16 v[32:35], v[240:243], a[220:223], v[32:35]
s_nop 0
ds_read_b64_tr_b16 v[140:141], v11 offset:16384
ds_read_b64_tr_b16 v[142:143], v11 offset:18432
v_mfma_f32_16x16x32_bf16 v[32:35], v[224:227], a[216:219], v[32:35]
v_mfma_f32_16x16x32_bf16 v[32:35], v[208:211], a[212:215], v[32:35]
s_nop 0
ds_read_b64_tr_b16 v[144:145], v8 offset:20480
ds_read_b64_tr_b16 v[146:147], v8 offset:22528
v_mfma_f32_16x16x32_bf16 v[32:35], v[192:195], a[208:211], v[32:35]
s_nop 0
ds_read_b64_tr_b16 v[148:149], v9 offset:20480
ds_read_b64_tr_b16 v[150:151], v9 offset:22528
v_mfma_f32_16x16x32_bf16 v[36:39], v[196:199], a[208:211], v[36:39]
s_nop 0
ds_read_b64_tr_b16 v[152:153], v10 offset:20480
ds_read_b64_tr_b16 v[154:155], v10 offset:22528
Lstube2:
s_cbranch_execz Lrete
v_mfma_f32_16x16x32_bf16 v[36:39], v[212:215], a[212:215], v[36:39]
s_nop 0
ds_read_b64_tr_b16 v[156:157], v11 offset:20480
ds_read_b64_tr_b16 v[158:159], v11 offset:22528
v_mfma_f32_16x16x32_bf16 v[36:39], v[228:231], a[216:219], v[36:39]
v_mfma_f32_16x16x32_bf16 v[36:39], v[244:247], a[220:223], v[36:39]
s_add_u32 m0, s64, 147456
ds_read_b64_tr_b16 v[160:161], v8 offset:24576
ds_read_b64_tr_b16 v[162:163], v8 offset:26624
v_mfma_f32_16x16x32_bf16 v[20:23], v[244:247], a[204:207], v[20:23]
s_add_u32 s72, s73, 0
buffer_load_dwordx4 v112, s[44:47], s72 offen sc1 lds
v_mfma_f32_16x16x32_bf16 v[20:23], v[228:231], a[200:203], v[20:23]
s_nop 0
ds_read_b64_tr_b16 v[164:165], v9 offset:24576
ds_read_b64_tr_b16 v[166:167], v9 offset:26624
v_mfma_f32_16x16x32_bf16 v[20:23], v[212:215], a[196:199], v[20:23]
s_add_u32 s72, s73, 15360
buffer_load_dwordx4 v12, s[44:47], s72 offen offset:1024 sc1 lds
v_mfma_f32_16x16x32_bf16 v[20:23], v[196:199], a[192:195], v[20:23]
s_nop 0
ds_read_b64_tr_b16 v[168:169], v10 offset:24576
ds_read_b64_tr_b16 v[170:171], v10 offset:26624
v_mfma_f32_16x16x32_bf16 v[24:27], v[200:203], a[192:195], v[24:27]
s_nop 0
ds_read_b64_tr_b16 v[172:173], v11 offset:24576
ds_read_b64_tr_b16 v[174:175], v11 offset:26624
v_mfma_f32_16x16x32_bf16 v[24:27], v[216:219], a[196:199], v[24:27]
s_add_u32 s72, s73, 30720
buffer_load_dwordx4 v112, s[44:47], s72 offen offset:2048 sc1 lds
v_mfma_f32_16x16x32_bf16 v[24:27], v[232:235], a[200:203], v[24:27]
v_mfma_f32_16x16x32_bf16 v[24:27], v[248:251], a[204:207], v[24:27]
s_nop 0
ds_read_b64_tr_b16 v[176:177], v8 offset:28672
ds_read_b64_tr_b16 v[178:179], v8 offset:30720
v_mfma_f32_16x16x32_bf16 v[40:43], v[248:251], a[220:223], v[40:43]
s_add_u32 s72, s73, 46080
buffer_load_dwordx4 v12, s[44:47], s72 offen offset:3072 sc1 lds
v_mfma_f32_16x16x32_bf16 v[40:43], v[232:235], a[216:219], v[40:43]
s_xor_b32 s71, s15, 0x400180
ds_read_b64_tr_b16 v[180:181], v9 offset:28672
ds_read_b64_tr_b16 v[182:183], v9 offset:30720
v_mfma_f32_16x16x32_bf16 v[40:43], v[216:219], a[212:215], v[40:43]
s_add_u32 m0, s85, 49152
ds_read_b64_tr_b16 v[184:185], v10 offset:28672
ds_read_b64_tr_b16 v[186:187], v10 offset:30720
v_mfma_f32_16x16x32_bf16 v[40:43], v[200:203], a[208:211], v[40:43]
s_add_u32 s72, s71, 0
buffer_load_dwordx4 v15, s[24:27], s72 offen lds
v_mfma_f32_16x16x32_bf16 v[44:47], v[204:207], a[208:211], v[44:47]
s_nop 0
ds_read_b64_tr_b16 v[188:189], v11 offset:28672
ds_read_b64_tr_b16 v[190:191], v11 offset:30720
v_mfma_f32_16x16x32_bf16 v[44:47], v[220:223], a[212:215], v[44:47]
v_mfma_f32_16x16x32_bf16 v[44:47], v[236:239], a[216:219], v[44:47]
s_add_u32 s72, s71, 15360
buffer_load_dwordx4 v15, s[24:27], s72 offen offset:1024 lds
v_mfma_f32_16x16x32_bf16 v[44:47], v[252:255], a[220:223], v[44:47]
v_mfma_f32_16x16x32_bf16 v[28:31], v[252:255], a[204:207], v[28:31]
v_mfma_f32_16x16x32_bf16 v[28:31], v[236:239], a[200:203], v[28:31]
s_add_u32 s72, s71, 30720
buffer_load_dwordx4 v15, s[24:27], s72 offen offset:2048 lds
v_mfma_f32_16x16x32_bf16 v[28:31], v[220:223], a[196:199], v[28:31]
s_waitcnt vmcnt(12) lgkmcnt(0)
v_mfma_f32_16x16x32_bf16 v[28:31], v[204:207], a[192:195], v[28:31]
s_barrier
v_mfma_f32_16x16x32_bf16 v[16:19], v[128:131], a[224:227], v[16:19]
s_add_u32 s72, s71, 46080
buffer_load_dwordx4 v15, s[24:27], s72 offen offset:3072 lds
v_mfma_f32_16x16x32_bf16 v[16:19], v[144:147], a[228:231], v[16:19]
s_lshl_b32 s73, s75, 9
ds_read_b64_tr_b16 v[192:193], v8 offset:32768
ds_read_b64_tr_b16 v[194:195], v8 offset:34816
v_mfma_f32_16x16x32_bf16 v[16:19], v[160:163], a[232:235], v[16:19]
s_lshl_b32 s84, s58, 7
ds_read_b64_tr_b16 v[196:197], v9 offset:32768
ds_read_b64_tr_b16 v[198:199], v9 offset:34816
v_mfma_f32_16x16x32_bf16 v[16:19], v[176:179], a[236:239], v[16:19]
s_add_u32 s73, s73, s84
ds_read_b64_tr_b16 v[200:201], v10 offset:32768
ds_read_b64_tr_b16 v[202:203], v10 offset:34816
v_mfma_f32_16x16x32_bf16 v[20:23], v[180:183], a[236:239], v[20:23]
s_add_u32 s73, s73, 0x3800000
ds_read_b64_tr_b16 v[204:205], v11 offset:32768
ds_read_b64_tr_b16 v[206:207], v11 offset:34816
v_mfma_f32_16x16x32_bf16 v[20:23], v[164:167], a[232:235], v[20:23]
s_xor_b32 s71, s12, 0x0
buffer_load_dword v6, v113, s[44:47], s73 offen sc1
v_mfma_f32_16x16x32_bf16 v[20:23], v[148:151], a[228:231], v[20:23]
s_add_u32 m0, s77, 0
ds_read_b64_tr_b16 v[208:209], v8 offset:36864
ds_read_b64_tr_b16 v[210:211], v8 offset:38912
v_mfma_f32_16x16x32_bf16 v[20:23], v[132:135], a[224:227], v[20:23]
s_add_u32 s72, s71, 0
buffer_load_dwordx4 v15, s[24:27], s72 offen lds
v_mfma_f32_16x16x32_bf16 v[24:27], v[136:139], a[224:227], v[24:27]
s_nop 0
ds_read_b64_tr_b16 v[212:213], v9 offset:36864
ds_read_b64_tr_b16 v[214:215], v9 offset:38912
v_mfma_f32_16x16x32_bf16 v[24:27], v[152:155], a[228:231], v[24:27]
s_nop 0
ds_read_b64_tr_b16 v[216:217], v10 offset:36864
ds_read_b64_tr_b16 v[218:219], v10 offset:38912
v_mfma_f32_16x16x32_bf16 v[24:27], v[168:171], a[232:235], v[24:27]
buffer_load_dword v7, v113, s[44:47], s73 offen offset:64 sc1
v_mfma_f32_16x16x32_bf16 v[24:27], v[184:187], a[236:239], v[24:27]
s_nop 0
ds_read_b64_tr_b16 v[220:221], v11 offset:36864
ds_read_b64_tr_b16 v[222:223], v11 offset:38912
v_cvt_pk_bf16_f32 v16, v16, v17
v_mfma_f32_16x16x32_bf16 v[28:31], v[188:191], a[236:239], v[28:31]
s_nop 0
ds_read_b64_tr_b16 v[224:225], v8 offset:40960
ds_read_b64_tr_b16 v[226:227], v8 offset:43008
v_cvt_pk_bf16_f32 v17, v18, v19
v_mfma_f32_16x16x32_bf16 v[28:31], v[172:175], a[232:235], v[28:31]
s_add_u32 s72, s71, 15360
buffer_load_dwordx4 v15, s[24:27], s72 offen offset:1024 lds
v_cvt_pk_bf16_f32 v18, v20, v21
v_mfma_f32_16x16x32_bf16 v[28:31], v[156:159], a[228:231], v[28:31]
s_nop 0
ds_read_b64_tr_b16 v[228:229], v9 offset:40960
ds_read_b64_tr_b16 v[230:231], v9 offset:43008
v_cvt_pk_bf16_f32 v19, v22, v23
v_mfma_f32_16x16x32_bf16 v[28:31], v[140:143], a[224:227], v[28:31]
v_mfma_f32_16x16x32_bf16 v[32:35], v[128:131], a[240:243], v[32:35]
s_xor_b32 s80, s93, 0x80000
ds_read_b64_tr_b16 v[232:233], v10 offset:40960
ds_read_b64_tr_b16 v[234:235], v10 offset:43008
v_mfma_f32_16x16x32_bf16 v[32:35], v[144:147], a[244:247], v[32:35]
s_add_u32 s80, s80, 0x3a00000
buffer_store_dwordx4 v[16:19], v1, s[44:47], s80 offen sc1
v_mfma_f32_16x16x32_bf16 v[32:35], v[160:163], a[248:251], v[32:35]
s_nop 0
ds_read_b64_tr_b16 v[236:237], v11 offset:40960
ds_read_b64_tr_b16 v[238:239], v11 offset:43008
v_mfma_f32_16x16x32_bf16 v[32:35], v[176:179], a[252:255], v[32:35]
s_add_u32 s72, s71, 30720
buffer_load_dwordx4 v15, s[24:27], s72 offen offset:2048 lds
v_cvt_pk_bf16_f32 v20, v24, v25
v_mfma_f32_16x16x32_bf16 v[36:39], v[180:183], a[252:255], v[36:39]
s_nop 0
ds_read_b64_tr_b16 v[240:241], v8 offset:45056
ds_read_b64_tr_b16 v[242:243], v8 offset:47104
v_cvt_pk_bf16_f32 v21, v26, v27
v_mfma_f32_16x16x32_bf16 v[36:39], v[164:167], a[248:251], v[36:39]
v_cvt_pk_bf16_f32 v22, v28, v29
v_cvt_pk_bf16_f32 v23, v30, v31
v_mfma_f32_16x16x32_bf16 v[36:39], v[148:151], a[244:247], v[36:39]
s_nop 0
ds_read_b64_tr_b16 v[244:245], v9 offset:45056
ds_read_b64_tr_b16 v[246:247], v9 offset:47104
v_mfma_f32_16x16x32_bf16 v[36:39], v[132:135], a[240:243], v[36:39]
s_nop 0
ds_read_b64_tr_b16 v[248:249], v10 offset:45056
ds_read_b64_tr_b16 v[250:251], v10 offset:47104
v_mfma_f32_16x16x32_bf16 v[40:43], v[136:139], a[240:243], v[40:43]
s_nop 0
ds_read_b64_tr_b16 v[252:253], v11 offset:45056
ds_read_b64_tr_b16 v[254:255], v11 offset:47104
v_mfma_f32_16x16x32_bf16 v[40:43], v[152:155], a[244:247], v[40:43]
s_add_u32 s72, s71, 46080
buffer_load_dwordx4 v15, s[24:27], s72 offen offset:3072 lds
v_mfma_f32_16x16x32_bf16 v[40:43], v[168:171], a[248:251], v[40:43]
v_mfma_f32_16x16x32_bf16 v[40:43], v[184:187], a[252:255], v[40:43]
v_cvt_pk_bf16_f32 v24, v32, v33
v_cvt_pk_bf16_f32 v25, v34, v35
v_cvt_pk_bf16_f32 v26, v36, v37
v_mfma_f32_16x16x32_bf16 v[44:47], v[188:191], a[252:255], v[44:47]
v_cvt_pk_bf16_f32 v27, v38, v39
v_mfma_f32_16x16x32_bf16 v[44:47], v[172:175], a[248:251], v[44:47]
v_mfma_f32_16x16x32_bf16 v[44:47], v[156:159], a[244:247], v[44:47]
s_waitcnt vmcnt(33) lgkmcnt(0)
v_mfma_f32_16x16x32_bf16 v[44:47], v[140:143], a[240:243], v[44:47]
s_barrier
v_mfma_f32_16x16x32_bf16 v[48:51], v[192:195], a[160:163], v[48:51]
s_nop 0
ds_read_b64_tr_b16 v[128:129], v8 offset:49152
ds_read_b64_tr_b16 v[130:131], v8 offset:51200
v_mfma_f32_16x16x32_bf16 v[48:51], v[208:211], a[164:167], v[48:51]
s_xor_b32 s71, s13, 0x0
buffer_store_dwordx4 v[20:23], v1, s[44:47], s80 offen offset:1024 sc1
v_mfma_f32_16x16x32_bf16 v[48:51], v[224:227], a[168:171], v[48:51]
s_add_u32 m0, s77, 16384
ds_read_b64_tr_b16 v[132:133], v9 offset:49152
ds_read_b64_tr_b16 v[134:135], v9 offset:51200
v_mfma_f32_16x16x32_bf16 v[48:51], v[240:243], a[172:175], v[48:51]
s_add_u32 s72, s71, 0
buffer_load_dwordx4 v15, s[24:27], s72 offen lds
v_cvt_pk_bf16_f32 v28, v40, v41
v_mfma_f32_16x16x32_bf16 v[64:67], v[240:243], a[188:191], v[64:67]
s_nop 0
ds_read_b64_tr_b16 v[136:137], v10 offset:49152
ds_read_b64_tr_b16 v[138:139], v10 offset:51200
v_cvt_pk_bf16_f32 v29, v42, v43
v_mfma_f32_16x16x32_bf16 v[64:67], v[224:227], a[184:187], v[64:67]
s_nop 0
ds_read_b64_tr_b16 v[140:141], v11 offset:49152
ds_read_b64_tr_b16 v[142:143], v11 offset:51200
v_cvt_pk_bf16_f32 v30, v44, v45
v_mfma_f32_16x16x32_bf16 v[64:67], v[208:211], a[180:183], v[64:67]
v_cvt_pk_bf16_f32 v31, v46, v47
v_mfma_f32_16x16x32_bf16 v[64:67], v[192:195], a[176:179], v[64:67]
s_nop 0
ds_read_b64_tr_b16 v[144:145], v8 offset:53248
ds_read_b64_tr_b16 v[146:147], v8 offset:55296
v_mfma_f32_16x16x32_bf16 v[68:71], v[196:199], a[176:179], v[68:71]
s_add_u32 s72, s71, 15360
buffer_load_dwordx4 v15, s[24:27], s72 offen offset:1024 lds
v_mfma_f32_16x16x32_bf16 v[68:71], v[212:215], a[180:183], v[68:71]
s_nop 0
ds_read_b64_tr_b16 v[148:149], v9 offset:53248
ds_read_b64_tr_b16 v[150:151], v9 offset:55296
v_mfma_f32_16x16x32_bf16 v[68:71], v[228:231], a[184:187], v[68:71]
s_nop 0
ds_read_b64_tr_b16 v[152:153], v10 offset:53248
ds_read_b64_tr_b16 v[154:155], v10 offset:55296
v_mfma_f32_16x16x32_bf16 v[68:71], v[244:247], a[188:191], v[68:71]
v_mfma_f32_16x16x32_bf16 v[52:55], v[244:247], a[172:175], v[52:55]
s_nop 0
ds_read_b64_tr_b16 v[156:157], v11 offset:53248
ds_read_b64_tr_b16 v[158:159], v11 offset:55296
v_mfma_f32_16x16x32_bf16 v[52:55], v[228:231], a[168:171], v[52:55]
s_nop 0
ds_read_b64_tr_b16 v[160:161], v8 offset:57344
ds_read_b64_tr_b16 v[162:163], v8 offset:59392
v_mfma_f32_16x16x32_bf16 v[52:55], v[212:215], a[164:167], v[52:55]
s_add_u32 s72, s71, 30720
buffer_load_dwordx4 v15, s[24:27], s72 offen offset:2048 lds
v_mfma_f32_16x16x32_bf16 v[52:55], v[196:199], a[160:163], v[52:55]
s_nop 0
ds_read_b64_tr_b16 v[164:165], v9 offset:57344
ds_read_b64_tr_b16 v[166:167], v9 offset:59392
v_mfma_f32_16x16x32_bf16 v[56:59], v[200:203], a[160:163], v[56:59]
v_mfma_f32_16x16x32_bf16 v[56:59], v[216:219], a[164:167], v[56:59]
buffer_store_dwordx4 v[24:27], v1, s[44:47], s80 offen offset:2048 sc1
v_mfma_f32_16x16x32_bf16 v[56:59], v[232:235], a[168:171], v[56:59]
s_nop 0
ds_read_b64_tr_b16 v[168:169], v10 offset:57344
ds_read_b64_tr_b16 v[170:171], v10 offset:59392
v_mfma_f32_16x16x32_bf16 v[56:59], v[248:251], a[172:175], v[56:59]
s_nop 0
ds_read_b64_tr_b16 v[172:173], v11 offset:57344
ds_read_b64_tr_b16 v[174:175], v11 offset:59392
v_mfma_f32_16x16x32_bf16 v[72:75], v[248:251], a[188:191], v[72:75]
s_add_u32 s72, s71, 46080
buffer_load_dwordx4 v15, s[24:27], s72 offen offset:3072 lds
v_mfma_f32_16x16x32_bf16 v[72:75], v[232:235], a[184:187], v[72:75]
s_nop 0
ds_read_b64_tr_b16 v[176:177], v8 offset:61440
ds_read_b64_tr_b16 v[178:179], v8 offset:63488
v_mfma_f32_16x16x32_bf16 v[72:75], v[216:219], a[180:183], v[72:75]
v_mfma_f32_16x16x32_bf16 v[72:75], v[200:203], a[176:179], v[72:75]
s_nop 0
ds_read_b64_tr_b16 v[180:181], v9 offset:61440
ds_read_b64_tr_b16 v[182:183], v9 offset:63488
v_mfma_f32_16x16x32_bf16 v[76:79], v[204:207], a[176:179], v[76:79]
s_nop 0
ds_read_b64_tr_b16 v[184:185], v10 offset:61440
ds_read_b64_tr_b16 v[186:187], v10 offset:63488
v_mfma_f32_16x16x32_bf16 v[76:79], v[220:223], a[180:183], v[76:79]
s_nop 0
ds_read_b64_tr_b16 v[188:189], v11 offset:61440
ds_read_b64_tr_b16 v[190:191], v11 offset:63488
v_mfma_f32_16x16x32_bf16 v[76:79], v[236:239], a[184:187], v[76:79]
v_mfma_f32_16x16x32_bf16 v[76:79], v[252:255], a[188:191], v[76:79]
s_xor_b32 s71, s14, 0x0
v_mfma_f32_16x16x32_bf16 v[60:63], v[252:255], a[172:175], v[60:63]
s_add_u32 m0, s77, 32768
v_xor_b32 v8, 0x10000, v8
v_mfma_f32_16x16x32_bf16 v[60:63], v[236:239], a[168:171], v[60:63]
s_add_u32 s72, s71, 0
v_xor_b32 v9, 0x10000, v9
v_mfma_f32_16x16x32_bf16 v[60:63], v[220:223], a[164:167], v[60:63]
s_waitcnt vmcnt(32) lgkmcnt(0)
buffer_load_dwordx4 v15, s[24:27], s72 offen lds
v_xor_b32 v10, 0x10000, v10
v_mfma_f32_16x16x32_bf16 v[60:63], v[204:207], a[160:163], v[60:63]
s_barrier
v_xor_b32 v11, 0x10000, v11
v_mfma_f32_16x16x32_bf16 v[48:51], v[128:131], a[192:195], v[48:51]
s_nop 0
ds_read_b64_tr_b16 v[192:193], v8 offset:0
ds_read_b64_tr_b16 v[194:195], v8 offset:2048
v_mfma_f32_16x16x32_bf16 v[48:51], v[144:147], a[196:199], v[48:51]
buffer_store_dwordx4 v[28:31], v1, s[44:47], s80 offen offset:3072 sc1
v_mfma_f32_16x16x32_bf16 v[48:51], v[160:163], a[200:203], v[48:51]
s_nop 0
ds_read_b64_tr_b16 v[196:197], v9 offset:0
ds_read_b64_tr_b16 v[198:199], v9 offset:2048
v_mfma_f32_16x16x32_bf16 v[48:51], v[176:179], a[204:207], v[48:51]
s_add_u32 s72, s71, 15360
buffer_load_dwordx4 v15, s[24:27], s72 offen offset:1024 lds
v_mfma_f32_16x16x32_bf16 v[64:67], v[176:179], a[220:223], v[64:67]
s_nop 0
ds_read_b64_tr_b16 v[200:201], v10 offset:0
ds_read_b64_tr_b16 v[202:203], v10 offset:2048
v_mfma_f32_16x16x32_bf16 v[64:67], v[160:163], a[216:219], v[64:67]
v_mfma_f32_16x16x32_bf16 v[64:67], v[144:147], a[212:215], v[64:67]
s_nop 0
ds_read_b64_tr_b16 v[204:205], v11 offset:0
ds_read_b64_tr_b16 v[206:207], v11 offset:2048
v_mfma_f32_16x16x32_bf16 v[64:67], v[128:131], a[208:211], v[64:67]
s_nop 0
ds_read_b64_tr_b16 v[208:209], v8 offset:4096
ds_read_b64_tr_b16 v[210:211], v8 offset:6144
v_mfma_f32_16x16x32_bf16 v[68:71], v[132:135], a[208:211], v[68:71]
s_nop 0
ds_read_b64_tr_b16 v[212:213], v9 offset:4096
ds_read_b64_tr_b16 v[214:215], v9 offset:6144
v_mfma_f32_16x16x32_bf16 v[68:71], v[148:151], a[212:215], v[68:71]
s_add_u32 s72, s71, 30720
buffer_load_dwordx4 v15, s[24:27], s72 offen offset:2048 lds
v_mfma_f32_16x16x32_bf16 v[68:71], v[164:167], a[216:219], v[68:71]
v_mfma_f32_16x16x32_bf16 v[68:71], v[180:183], a[220:223], v[68:71]
s_nop 0
ds_read_b64_tr_b16 v[216:217], v10 offset:4096
ds_read_b64_tr_b16 v[218:219], v10 offset:6144
v_mfma_f32_16x16x32_bf16 v[52:55], v[180:183], a[204:207], v[52:55]
s_nop 0
ds_read_b64_tr_b16 v[220:221], v11 offset:4096
ds_read_b64_tr_b16 v[222:223], v11 offset:6144
v_mfma_f32_16x16x32_bf16 v[52:55], v[164:167], a[200:203], v[52:55]
v_mfma_f32_16x16x32_bf16 v[52:55], v[148:151], a[196:199], v[52:55]
s_nop 0
ds_read_b64_tr_b16 v[224:225], v8 offset:8192
ds_read_b64_tr_b16 v[226:227], v8 offset:10240
v_mfma_f32_16x16x32_bf16 v[52:55], v[132:135], a[192:195], v[52:55]
s_add_u32 s72, s71, 46080
buffer_load_dwordx4 v15, s[24:27], s72 offen offset:3072 lds
v_mfma_f32_16x16x32_bf16 v[56:59], v[136:139], a[192:195], v[56:59]
s_nop 0
ds_read_b64_tr_b16 v[228:229], v9 offset:8192
ds_read_b64_tr_b16 v[230:231], v9 offset:10240
v_mfma_f32_16x16x32_bf16 v[56:59], v[152:155], a[196:199], v[56:59]
s_nop 0
ds_read_b64_tr_b16 v[232:233], v10 offset:8192
ds_read_b64_tr_b16 v[234:235], v10 offset:10240
v_mfma_f32_16x16x32_bf16 v[56:59], v[168:171], a[200:203], v[56:59]
v_mfma_f32_16x16x32_bf16 v[56:59], v[184:187], a[204:207], v[56:59]
s_nop 0
ds_read_b64_tr_b16 v[236:237], v11 offset:8192
ds_read_b64_tr_b16 v[238:239], v11 offset:10240
v_mfma_f32_16x16x32_bf16 v[72:75], v[184:187], a[220:223], v[72:75]
s_nop 0
ds_read_b64_tr_b16 v[240:241], v8 offset:12288
ds_read_b64_tr_b16 v[242:243], v8 offset:14336
v_mfma_f32_16x16x32_bf16 v[72:75], v[168:171], a[216:219], v[72:75]
s_nop 0
ds_read_b64_tr_b16 v[244:245], v9 offset:12288
ds_read_b64_tr_b16 v[246:247], v9 offset:14336
v_mfma_f32_16x16x32_bf16 v[72:75], v[152:155], a[212:215], v[72:75]
v_mfma_f32_16x16x32_bf16 v[72:75], v[136:139], a[208:211], v[72:75]
s_xor_b32 s71, s15, 0x0
ds_read_b64_tr_b16 v[248:249], v10 offset:12288
ds_read_b64_tr_b16 v[250:251], v10 offset:14336
v_mfma_f32_16x16x32_bf16 v[76:79], v[140:143], a[208:211], v[76:79]
s_add_u32 m0, s77, 49152
ds_read_b64_tr_b16 v[252:253], v11 offset:12288
ds_read_b64_tr_b16 v[254:255], v11 offset:14336
v_mfma_f32_16x16x32_bf16 v[76:79], v[156:159], a[212:215], v[76:79]
s_add_u32 s72, s71, 0
buffer_load_dwordx4 v15, s[24:27], s72 offen lds
v_mfma_f32_16x16x32_bf16 v[76:79], v[172:175], a[216:219], v[76:79]
v_mfma_f32_16x16x32_bf16 v[76:79], v[188:191], a[220:223], v[76:79]
v_mfma_f32_16x16x32_bf16 v[60:63], v[188:191], a[204:207], v[60:63]
v_mfma_f32_16x16x32_bf16 v[60:63], v[172:175], a[200:203], v[60:63]
s_add_u32 s72, s71, 15360
v_mfma_f32_16x16x32_bf16 v[60:63], v[156:159], a[196:199], v[60:63]
s_waitcnt vmcnt(31) lgkmcnt(0)
v_mfma_f32_16x16x32_bf16 v[60:63], v[140:143], a[192:195], v[60:63]
s_barrier
buffer_load_dwordx4 v15, s[24:27], s72 offen offset:1024 lds
v_mfma_f32_16x16x32_bf16 v[48:51], v[192:195], a[224:227], v[48:51]
s_nop 0
ds_read_b64_tr_b16 v[128:129], v8 offset:16384
ds_read_b64_tr_b16 v[130:131], v8 offset:18432
v_mfma_f32_16x16x32_bf16 v[48:51], v[208:211], a[228:231], v[48:51]
s_nop 0
ds_read_b64_tr_b16 v[132:133], v9 offset:16384
ds_read_b64_tr_b16 v[134:135], v9 offset:18432
v_mfma_f32_16x16x32_bf16 v[48:51], v[224:227], a[232:235], v[48:51]
s_nop 0
ds_read_b64_tr_b16 v[136:137], v10 offset:16384
ds_read_b64_tr_b16 v[138:139], v10 offset:18432
v_mfma_f32_16x16x32_bf16 v[48:51], v[240:243], a[236:239], v[48:51]
v_mfma_f32_16x16x32_bf16 v[52:55], v[244:247], a[236:239], v[52:55]
s_nop 0
ds_read_b64_tr_b16 v[140:141], v11 offset:16384
ds_read_b64_tr_b16 v[142:143], v11 offset:18432
v_mfma_f32_16x16x32_bf16 v[52:55], v[228:231], a[232:235], v[52:55]
s_add_u32 s72, s71, 30720
buffer_load_dwordx4 v15, s[24:27], s72 offen offset:2048 lds
v_mfma_f32_16x16x32_bf16 v[52:55], v[212:215], a[228:231], v[52:55]
s_nop 0
ds_read_b64_tr_b16 v[144:145], v8 offset:20480
ds_read_b64_tr_b16 v[146:147], v8 offset:22528
v_mfma_f32_16x16x32_bf16 v[52:55], v[196:199], a[224:227], v[52:55]
s_nop 0
ds_read_b64_tr_b16 v[148:149], v9 offset:20480
ds_read_b64_tr_b16 v[150:151], v9 offset:22528
v_mfma_f32_16x16x32_bf16 v[56:59], v[200:203], a[224:227], v[56:59]
v_mfma_f32_16x16x32_bf16 v[56:59], v[216:219], a[228:231], v[56:59]
s_nop 0
ds_read_b64_tr_b16 v[152:153], v10 offset:20480
ds_read_b64_tr_b16 v[154:155], v10 offset:22528
v_mfma_f32_16x16x32_bf16 v[56:59], v[232:235], a[232:235], v[56:59]
s_nop 0
ds_read_b64_tr_b16 v[156:157], v11 offset:20480
ds_read_b64_tr_b16 v[158:159], v11 offset:22528
v_mfma_f32_16x16x32_bf16 v[56:59], v[248:251], a[236:239], v[56:59]
s_add_u32 s72, s71, 46080
buffer_load_dwordx4 v15, s[24:27], s72 offen offset:3072 lds
v_cvt_pk_bf16_f32 v48, v48, v49
v_mfma_f32_16x16x32_bf16 v[60:63], v[252:255], a[236:239], v[60:63]
v_cvt_pk_bf16_f32 v49, v50, v51
v_cvt_pk_bf16_f32 v50, v52, v53
v_cvt_pk_bf16_f32 v51, v54, v55
v_mfma_f32_16x16x32_bf16 v[60:63], v[236:239], a[232:235], v[60:63]
s_nop 0
ds_read_b64_tr_b16 v[160:161], v8 offset:24576
ds_read_b64_tr_b16 v[162:163], v8 offset:26624
v_mfma_f32_16x16x32_bf16 v[60:63], v[220:223], a[228:231], v[60:63]
s_nop 0
ds_read_b64_tr_b16 v[164:165], v9 offset:24576
ds_read_b64_tr_b16 v[166:167], v9 offset:26624
v_mfma_f32_16x16x32_bf16 v[60:63], v[204:207], a[224:227], v[60:63]
s_nop 0
ds_read_b64_tr_b16 v[168:169], v10 offset:24576
ds_read_b64_tr_b16 v[170:171], v10 offset:26624
v_mfma_f32_16x16x32_bf16 v[64:67], v[192:195], a[240:243], v[64:67]
s_xor_b32 s80, s93, 0x100000
v_mfma_f32_16x16x32_bf16 v[64:67], v[208:211], a[244:247], v[64:67]
s_add_u32 s80, s80, 0x3e00000
buffer_store_dwordx4 v[48:51], v1, s[44:47], s80 offen sc1
v_mfma_f32_16x16x32_bf16 v[64:67], v[224:227], a[248:251], v[64:67]
s_nop 0
ds_read_b64_tr_b16 v[172:173], v11 offset:24576
ds_read_b64_tr_b16 v[174:175], v11 offset:26624
v_mfma_f32_16x16x32_bf16 v[64:67], v[240:243], a[252:255], v[64:67]
s_xor_b32 s71, s12, 0x400000
ds_read_b64_tr_b16 v[176:177], v8 offset:28672
ds_read_b64_tr_b16 v[178:179], v8 offset:30720
v_cvt_pk_bf16_f32 v52, v56, v57
v_mfma_f32_16x16x32_bf16 v[68:71], v[244:247], a[252:255], v[68:71]
s_add_u32 m0, s85, 0
ds_read_b64_tr_b16 v[180:181], v9 offset:28672
ds_read_b64_tr_b16 v[182:183], v9 offset:30720
v_cvt_pk_bf16_f32 v53, v58, v59
v_mfma_f32_16x16x32_bf16 v[68:71], v[228:231], a[248:251], v[68:71]
s_add_u32 s72, s71, 0
buffer_load_dwordx4 v15, s[24:27], s72 offen lds
v_cvt_pk_bf16_f32 v54, v60, v61
v_mfma_f32_16x16x32_bf16 v[68:71], v[212:215], a[244:247], v[68:71]
v_cvt_pk_bf16_f32 v55, v62, v63
v_mfma_f32_16x16x32_bf16 v[68:71], v[196:199], a[240:243], v[68:71]
s_nop 0
ds_read_b64_tr_b16 v[184:185], v10 offset:28672
ds_read_b64_tr_b16 v[186:187], v10 offset:30720
v_mfma_f32_16x16x32_bf16 v[72:75], v[200:203], a[240:243], v[72:75]
s_nop 0
ds_read_b64_tr_b16 v[188:189], v11 offset:28672
ds_read_b64_tr_b16 v[190:191], v11 offset:30720
v_mfma_f32_16x16x32_bf16 v[72:75], v[216:219], a[244:247], v[72:75]
v_mfma_f32_16x16x32_bf16 v[72:75], v[232:235], a[248:251], v[72:75]
s_add_u32 s72, s71, 15360
buffer_load_dwordx4 v15, s[24:27], s72 offen offset:1024 lds
v_mfma_f32_16x16x32_bf16 v[72:75], v[248:251], a[252:255], v[72:75]
v_cvt_pk_bf16_f32 v56, v64, v65
v_cvt_pk_bf16_f32 v57, v66, v67
v_cvt_pk_bf16_f32 v58, v68, v69
v_mfma_f32_16x16x32_bf16 v[76:79], v[252:255], a[252:255], v[76:79]
v_cvt_pk_bf16_f32 v59, v70, v71
v_mfma_f32_16x16x32_bf16 v[76:79], v[236:239], a[248:251], v[76:79]
v_mfma_f32_16x16x32_bf16 v[76:79], v[220:223], a[244:247], v[76:79]
s_waitcnt vmcnt(29) lgkmcnt(0)
v_mfma_f32_16x16x32_bf16 v[76:79], v[204:207], a[240:243], v[76:79]
s_barrier
v_mfma_f32_16x16x32_bf16 v[80:83], v[128:131], a[160:163], v[80:83]
s_add_u32 s72, s71, 30720
buffer_load_dwordx4 v15, s[24:27], s72 offen offset:2048 lds
v_mfma_f32_16x16x32_bf16 v[80:83], v[144:147], a[164:167], v[80:83]
s_waitcnt vmcnt(23)
buffer_store_dwordx4 v[52:55], v1, s[44:47], s80 offen offset:1024 sc1
v_mfma_f32_16x16x32_bf16 v[80:83], v[160:163], a[168:171], v[80:83]
s_nop 0
ds_read_b64_tr_b16 v[192:193], v8 offset:32768
ds_read_b64_tr_b16 v[194:195], v8 offset:34816
v_mfma_f32_16x16x32_bf16 v[80:83], v[176:179], a[172:175], v[80:83]
s_nop 0
ds_read_b64_tr_b16 v[196:197], v9 offset:32768
ds_read_b64_tr_b16 v[198:199], v9 offset:34816
v_cvt_pk_bf16_f32 v60, v72, v73
v_mfma_f32_16x16x32_bf16 v[96:99], v[176:179], a[188:191], v[96:99]
s_nop 0
ds_read_b64_tr_b16 v[200:201], v10 offset:32768
ds_read_b64_tr_b16 v[202:203], v10 offset:34816
v_cvt_pk_bf16_f32 v61, v74, v75
v_mfma_f32_16x16x32_bf16 v[96:99], v[160:163], a[184:187], v[96:99]
s_nop 0
ds_read_b64_tr_b16 v[204:205], v11 offset:32768
ds_read_b64_tr_b16 v[206:207], v11 offset:34816
v_cvt_pk_bf16_f32 v62, v76, v77
v_mfma_f32_16x16x32_bf16 v[96:99], v[144:147], a[180:183], v[96:99]
s_add_u32 s72, s71, 46080
buffer_load_dwordx4 v15, s[24:27], s72 offen offset:3072 lds
v_cvt_pk_bf16_f32 v63, v78, v79
v_mfma_f32_16x16x32_bf16 v[96:99], v[128:131], a[176:179], v[96:99]
v_sub_f32 v112, 1.0, v6
v_sub_f32 v113, 1.0, v7
v_mfma_f32_16x16x32_bf16 v[100:103], v[132:135], a[176:179], v[100:103]
s_nop 0
ds_read_b64_tr_b16 v[208:209], v8 offset:36864
ds_read_b64_tr_b16 v[210:211], v8 offset:38912
v_mfma_f32_16x16x32_bf16 v[100:103], v[148:151], a[180:183], v[100:103]
s_nop 0
ds_read_b64_tr_b16 v[212:213], v9 offset:36864
ds_read_b64_tr_b16 v[214:215], v9 offset:38912
v_mfma_f32_16x16x32_bf16 v[100:103], v[164:167], a[184:187], v[100:103]
s_nop 0
ds_read_b64_tr_b16 v[216:217], v10 offset:36864
ds_read_b64_tr_b16 v[218:219], v10 offset:38912
v_mfma_f32_16x16x32_bf16 v[100:103], v[180:183], a[188:191], v[100:103]
v_mfma_f32_16x16x32_bf16 v[84:87], v[180:183], a[172:175], v[84:87]
s_nop 0
ds_read_b64_tr_b16 v[220:221], v11 offset:36864
ds_read_b64_tr_b16 v[222:223], v11 offset:38912
v_mfma_f32_16x16x32_bf16 v[84:87], v[164:167], a[168:171], v[84:87]
s_nop 0
ds_read_b64_tr_b16 v[224:225], v8 offset:40960
ds_read_b64_tr_b16 v[226:227], v8 offset:43008
v_mfma_f32_16x16x32_bf16 v[84:87], v[148:151], a[164:167], v[84:87]
s_xor_b32 s71, s13, 0x400000
ds_read_b64_tr_b16 v[228:229], v9 offset:40960
ds_read_b64_tr_b16 v[230:231], v9 offset:43008
v_mfma_f32_16x16x32_bf16 v[84:87], v[132:135], a[160:163], v[84:87]
s_add_u32 m0, s85, 16384
v_mfma_f32_16x16x32_bf16 v[88:91], v[136:139], a[160:163], v[88:91]
s_add_u32 s72, s71, 0
buffer_load_dwordx4 v15, s[24:27], s72 offen lds
v_mfma_f32_16x16x32_bf16 v[88:91], v[152:155], a[164:167], v[88:91]
buffer_store_dwordx4 v[56:59], v1, s[44:47], s80 offen offset:2048 sc1
v_mfma_f32_16x16x32_bf16 v[88:91], v[168:171], a[168:171], v[88:91]
s_nop 0
ds_read_b64_tr_b16 v[232:233], v10 offset:40960
ds_read_b64_tr_b16 v[234:235], v10 offset:43008
v_mfma_f32_16x16x32_bf16 v[88:91], v[184:187], a[172:175], v[88:91]
s_nop 0
ds_read_b64_tr_b16 v[236:237], v11 offset:40960
ds_read_b64_tr_b16 v[238:239], v11 offset:43008
v_mfma_f32_16x16x32_bf16 v[104:107], v[184:187], a[188:191], v[104:107]
s_nop 0
ds_read_b64_tr_b16 v[240:241], v8 offset:45056
ds_read_b64_tr_b16 v[242:243], v8 offset:47104
v_mfma_f32_16x16x32_bf16 v[104:107], v[168:171], a[184:187], v[104:107]
v_mfma_f32_16x16x32_bf16 v[104:107], v[152:155], a[180:183], v[104:107]
s_add_u32 s72, s71, 15360
buffer_load_dwordx4 v15, s[24:27], s72 offen offset:1024 lds
v_mfma_f32_16x16x32_bf16 v[104:107], v[136:139], a[176:179], v[104:107]
s_nop 0
ds_read_b64_tr_b16 v[244:245], v9 offset:45056
ds_read_b64_tr_b16 v[246:247], v9 offset:47104
Lstube3:
s_cbranch_execz Lrete
v_mfma_f32_16x16x32_bf16 v[108:111], v[140:143], a[176:179], v[108:111]
s_nop 0
ds_read_b64_tr_b16 v[248:249], v10 offset:45056
ds_read_b64_tr_b16 v[250:251], v10 offset:47104
v_mfma_f32_16x16x32_bf16 v[108:111], v[156:159], a[180:183], v[108:111]
s_nop 0
ds_read_b64_tr_b16 v[252:253], v11 offset:45056
ds_read_b64_tr_b16 v[254:255], v11 offset:47104
v_mfma_f32_16x16x32_bf16 v[108:111], v[172:175], a[184:187], v[108:111]
v_mfma_f32_16x16x32_bf16 v[108:111], v[188:191], a[188:191], v[108:111]
v_mfma_f32_16x16x32_bf16 v[92:95], v[188:191], a[172:175], v[92:95]
s_add_u32 s72, s71, 30720
buffer_load_dwordx4 v15, s[24:27], s72 offen offset:2048 lds
v_mfma_f32_16x16x32_bf16 v[92:95], v[172:175], a[168:171], v[92:95]
v_mfma_f32_16x16x32_bf16 v[92:95], v[156:159], a[164:167], v[92:95]
s_waitcnt vmcnt(32) lgkmcnt(0)
v_mfma_f32_16x16x32_bf16 v[92:95], v[140:143], a[160:163], v[92:95]
s_barrier
v_mfma_f32_16x16x32_bf16 v[80:83], v[192:195], a[192:195], v[80:83]
s_nop 0
ds_read_b64_tr_b16 v[128:129], v8 offset:49152
ds_read_b64_tr_b16 v[130:131], v8 offset:51200
v_mfma_f32_16x16x32_bf16 v[80:83], v[208:211], a[196:199], v[80:83]
buffer_store_dwordx4 v[60:63], v1, s[44:47], s80 offen offset:3072 sc1
v_mfma_f32_16x16x32_bf16 v[80:83], v[224:227], a[200:203], v[80:83]
s_add_u32 s72, s71, 46080
buffer_load_dwordx4 v15, s[24:27], s72 offen offset:3072 lds
v_mfma_f32_16x16x32_bf16 v[80:83], v[240:243], a[204:207], v[80:83]
s_nop 0
ds_read_b64_tr_b16 v[132:133], v9 offset:49152
ds_read_b64_tr_b16 v[134:135], v9 offset:51200
v_mfma_f32_16x16x32_bf16 v[96:99], v[240:243], a[220:223], v[96:99]
s_nop 0
ds_read_b64_tr_b16 v[136:137], v10 offset:49152
ds_read_b64_tr_b16 v[138:139], v10 offset:51200
v_mfma_f32_16x16x32_bf16 v[96:99], v[224:227], a[216:219], v[96:99]
s_nop 0
ds_read_b64 v[48:49], v116 offset:0
ds_read_b64_tr_b16 v[64:65], v5 offset:0
v_mfma_f32_16x16x32_bf16 v[96:99], v[208:211], a[212:215], v[96:99]
s_nop 0
ds_read_b64_tr_b16 v[140:141], v11 offset:49152
ds_read_b64_tr_b16 v[142:143], v11 offset:51200
v_mfma_f32_16x16x32_bf16 v[96:99], v[192:195], a[208:211], v[96:99]
s_nop 0
ds_read_b64_tr_b16 v[144:145], v8 offset:53248
ds_read_b64_tr_b16 v[146:147], v8 offset:55296
v_mfma_f32_16x16x32_bf16 v[100:103], v[196:199], a[208:211], v[100:103]
s_nop 0
ds_read_b64_tr_b16 v[148:149], v9 offset:53248
ds_read_b64_tr_b16 v[150:151], v9 offset:55296
v_mfma_f32_16x16x32_bf16 v[100:103], v[212:215], a[212:215], v[100:103]
s_nop 0
ds_read_b64 v[50:51], v117 offset:0
ds_read_b64_tr_b16 v[66:67], v5 offset:4096
v_mfma_f32_16x16x32_bf16 v[100:103], v[228:231], a[216:219], v[100:103]
s_xor_b32 s71, s14, 0x400000
ds_read_b64_tr_b16 v[152:153], v10 offset:53248
ds_read_b64_tr_b16 v[154:155], v10 offset:55296
v_mfma_f32_16x16x32_bf16 v[100:103], v[244:247], a[220:223], v[100:103]
s_add_u32 m0, s85, 32768
ds_read_b64_tr_b16 v[156:157], v11 offset:53248
ds_read_b64_tr_b16 v[158:159], v11 offset:55296
v_mfma_f32_16x16x32_bf16 v[84:87], v[244:247], a[204:207], v[84:87]
s_add_u32 s72, s71, 0
buffer_load_dwordx4 v15, s[24:27], s72 offen lds
v_mfma_f32_16x16x32_bf16 v[84:87], v[228:231], a[200:203], v[84:87]
s_nop 0
ds_read_b64 v[52:53], v118 offset:0
ds_read_b64_tr_b16 v[68:69], v5 offset:8192
v_mfma_f32_16x16x32_bf16 v[84:87], v[212:215], a[196:199], v[84:87]
s_nop 0
ds_read_b64_tr_b16 v[160:161], v8 offset:57344
ds_read_b64_tr_b16 v[162:163], v8 offset:59392
v_mfma_f32_16x16x32_bf16 v[84:87], v[196:199], a[192:195], v[84:87]
s_nop 0
ds_read_b64_tr_b16 v[164:165], v9 offset:57344
ds_read_b64_tr_b16 v[166:167], v9 offset:59392
v_mfma_f32_16x16x32_bf16 v[88:91], v[200:203], a[192:195], v[88:91]
s_nop 0
ds_read_b64_tr_b16 v[168:169], v10 offset:57344
ds_read_b64_tr_b16 v[170:171], v10 offset:59392
v_mfma_f32_16x16x32_bf16 v[88:91], v[216:219], a[196:199], v[88:91]
s_add_u32 s72, s71, 15360
buffer_load_dwordx4 v15, s[24:27], s72 offen offset:1024 lds
v_mfma_f32_16x16x32_bf16 v[88:91], v[232:235], a[200:203], v[88:91]
s_nop 0
ds_read_b64 v[54:55], v119 offset:0
ds_read_b64_tr_b16 v[70:71], v5 offset:12288
v_mfma_f32_16x16x32_bf16 v[88:91], v[248:251], a[204:207], v[88:91]
s_nop 0
ds_read_b64_tr_b16 v[172:173], v11 offset:57344
ds_read_b64_tr_b16 v[174:175], v11 offset:59392
v_mfma_f32_16x16x32_bf16 v[104:107], v[248:251], a[220:223], v[104:107]
s_nop 0
ds_read_b64_tr_b16 v[176:177], v8 offset:61440
ds_read_b64_tr_b16 v[178:179], v8 offset:63488
v_mfma_f32_16x16x32_bf16 v[104:107], v[232:235], a[216:219], v[104:107]
s_nop 0
ds_read_b64_tr_b16 v[180:181], v9 offset:61440
ds_read_b64_tr_b16 v[182:183], v9 offset:63488
v_mfma_f32_16x16x32_bf16 v[104:107], v[216:219], a[212:215], v[104:107]
v_xor_b32 v5, 16, v5
v_mfma_f32_16x16x32_bf16 v[104:107], v[200:203], a[208:211], v[104:107]
s_add_u32 s72, s71, 30720
buffer_load_dwordx4 v15, s[24:27], s72 offen offset:2048 lds
v_mfma_f32_16x16x32_bf16 v[108:111], v[204:207], a[208:211], v[108:111]
s_nop 0
ds_read_b64_tr_b16 v[184:185], v10 offset:61440
ds_read_b64_tr_b16 v[186:187], v10 offset:63488
v_mfma_f32_16x16x32_bf16 v[108:111], v[220:223], a[212:215], v[108:111]
s_nop 0
ds_read_b64_tr_b16 v[188:189], v11 offset:61440
ds_read_b64_tr_b16 v[190:191], v11 offset:63488
v_mfma_f32_16x16x32_bf16 v[108:111], v[236:239], a[216:219], v[108:111]
s_nop 0
ds_read_b64 v[56:57], v116 offset:2048
ds_read_b64_tr_b16 v[72:73], v5 offset:0
v_mfma_f32_16x16x32_bf16 v[108:111], v[252:255], a[220:223], v[108:111]
s_nop 0
ds_read_b64 v[58:59], v117 offset:2048
ds_read_b64_tr_b16 v[74:75], v5 offset:4096
v_mfma_f32_16x16x32_bf16 v[92:95], v[252:255], a[204:207], v[92:95]
ds_read_b64 v[60:61], v118 offset:2048
v_xor_b32 v8, 0x10000, v8
v_mfma_f32_16x16x32_bf16 v[92:95], v[236:239], a[200:203], v[92:95]
s_add_u32 s72, s71, 46080
buffer_load_dwordx4 v15, s[24:27], s72 offen offset:3072 lds
v_xor_b32 v9, 0x10000, v9
v_mfma_f32_16x16x32_bf16 v[92:95], v[220:223], a[196:199], v[92:95]
s_waitcnt vmcnt(31) lgkmcnt(0)
ds_read_b64_tr_b16 v[76:77], v5 offset:8192
v_xor_b32 v10, 0x10000, v10
v_mfma_f32_16x16x32_bf16 v[92:95], v[204:207], a[192:195], v[92:95]
s_barrier
ds_read_b64 v[62:63], v119 offset:2048
v_xor_b32 v11, 0x10000, v11
v_mfma_f32_16x16x32_bf16 v[80:83], v[128:131], a[224:227], v[80:83]
s_nop 0
ds_read_b64_tr_b16 v[192:193], v8 offset:0
ds_read_b64_tr_b16 v[194:195], v8 offset:2048
v_mfma_f32_16x16x32_bf16 v[80:83], v[144:147], a[228:231], v[80:83]
s_nop 0
ds_read_b64_tr_b16 v[196:197], v9 offset:0
ds_read_b64_tr_b16 v[198:199], v9 offset:2048
v_mfma_f32_16x16x32_bf16 v[80:83], v[160:163], a[232:235], v[80:83]
s_nop 0
ds_read_b64_tr_b16 v[200:201], v10 offset:0
ds_read_b64_tr_b16 v[202:203], v10 offset:2048
v_mfma_f32_16x16x32_bf16 v[80:83], v[176:179], a[236:239], v[80:83]
ds_read_b64_tr_b16 v[78:79], v5 offset:12288
v_mfma_f32_16x16x32_bf16 v[84:87], v[180:183], a[236:239], v[84:87]
s_nop 0
ds_read_b64_tr_b16 v[204:205], v11 offset:0
ds_read_b64_tr_b16 v[206:207], v11 offset:2048
v_mfma_f32_16x16x32_bf16 v[84:87], v[164:167], a[232:235], v[84:87]
s_xor_b32 s71, s15, 0x400000
ds_read_b64_tr_b16 v[208:209], v8 offset:4096
ds_read_b64_tr_b16 v[210:211], v8 offset:6144
v_mfma_f32_16x16x32_bf16 v[84:87], v[148:151], a[228:231], v[84:87]
s_add_u32 m0, s85, 49152
ds_read_b64_tr_b16 v[212:213], v9 offset:4096
ds_read_b64_tr_b16 v[214:215], v9 offset:6144
v_mfma_f32_16x16x32_bf16 v[84:87], v[132:135], a[224:227], v[84:87]
s_add_u32 s72, s71, 0
buffer_load_dwordx4 v15, s[24:27], s72 offen lds
v_mfma_f32_16x16x32_bf16 v[88:91], v[136:139], a[224:227], v[88:91]
v_mfma_f32_16x16x32_bf16 v[88:91], v[152:155], a[228:231], v[88:91]
s_waitcnt lgkmcnt(6)
ds_read_b64_tr_b16 v[216:217], v10 offset:4096
ds_read_b64_tr_b16 v[218:219], v10 offset:6144
v_mfma_f32_16x16x32_bf16 v[88:91], v[168:171], a[232:235], v[88:91]
s_nop 0
ds_read_b64_tr_b16 v[220:221], v11 offset:4096
ds_read_b64_tr_b16 v[222:223], v11 offset:6144
v_mfma_f32_16x16x32_bf16 v[88:91], v[184:187], a[236:239], v[88:91]
v_cvt_pk_bf16_f32 v80, v80, v81
v_cvt_pk_bf16_f32 v81, v82, v83
v_cvt_pk_bf16_f32 v82, v84, v85
v_mfma_f32_16x16x32_bf16 v[92:95], v[188:191], a[236:239], v[92:95]
s_nop 0
ds_read_b64_tr_b16 v[224:225], v8 offset:8192
ds_read_b64_tr_b16 v[226:227], v8 offset:10240
v_cvt_pk_bf16_f32 v83, v86, v87
v_mfma_f32_16x16x32_bf16 v[92:95], v[172:175], a[232:235], v[92:95]
s_add_u32 s72, s71, 15360
buffer_load_dwordx4 v15, s[24:27], s72 offen offset:1024 lds
v_mfma_f32_16x16x32_bf16 v[92:95], v[156:159], a[228:231], v[92:95]
s_nop 0
ds_read_b64_tr_b16 v[228:229], v9 offset:8192
ds_read_b64_tr_b16 v[230:231], v9 offset:10240
v_mfma_f32_16x16x32_bf16 v[92:95], v[140:143], a[224:227], v[92:95]
s_nop 0
ds_read_b64_tr_b16 v[232:233], v10 offset:8192
ds_read_b64_tr_b16 v[234:235], v10 offset:10240
v_mfma_f32_16x16x32_bf16 v[96:99], v[128:131], a[240:243], v[96:99]
s_xor_b32 s80, s93, 0x180000
v_and_b32 v114, 0xffff0000, v48
v_lshlrev_b32 v115, 16, v64
v_mfma_f32_16x16x32_bf16 v[96:99], v[144:147], a[244:247], v[96:99]
s_add_u32 s80, s80, 0x4200000
buffer_store_dwordx4 v[80:83], v1, s[44:47], s80 offen sc1
v_mfma_f32_16x16x32_bf16 v[96:99], v[160:163], a[248:251], v[96:99]
s_nop 0
ds_read_b64_tr_b16 v[236:237], v11 offset:8192
ds_read_b64_tr_b16 v[238:239], v11 offset:10240
v_mfma_f32_16x16x32_bf16 v[96:99], v[176:179], a[252:255], v[96:99]
s_add_u32 s72, s71, 30720
buffer_load_dwordx4 v15, s[24:27], s72 offen offset:2048 lds
v_cvt_pk_bf16_f32 v84, v88, v89
v_mfma_f32_16x16x32_bf16 v[100:103], v[180:183], a[252:255], v[100:103]
s_nop 0
ds_read_b64_tr_b16 v[240:241], v8 offset:12288
ds_read_b64_tr_b16 v[242:243], v8 offset:14336
v_cvt_pk_bf16_f32 v85, v90, v91
v_mfma_f32_16x16x32_bf16 v[100:103], v[164:167], a[248:251], v[100:103]
s_nop 0
ds_read_b64_tr_b16 v[244:245], v9 offset:12288
ds_read_b64_tr_b16 v[246:247], v9 offset:14336
v_cvt_pk_bf16_f32 v86, v92, v93
v_mfma_f32_16x16x32_bf16 v[100:103], v[148:151], a[244:247], v[100:103]
v_cvt_pk_bf16_f32 v87, v94, v95
v_lshlrev_b32 v48, 16, v48
v_mfma_f32_16x16x32_bf16 v[100:103], v[132:135], a[240:243], v[100:103]
s_nop 0
ds_read_b64_tr_b16 v[248:249], v10 offset:12288
ds_read_b64_tr_b16 v[250:251], v10 offset:14336
v_mfma_f32_16x16x32_bf16 v[104:107], v[136:139], a[240:243], v[104:107]
s_nop 0
ds_read_b64_tr_b16 v[252:253], v11 offset:12288
ds_read_b64_tr_b16 v[254:255], v11 offset:14336
v_mfma_f32_16x16x32_bf16 v[104:107], v[152:155], a[244:247], v[104:107]
s_add_u32 s72, s71, 46080
buffer_load_dwordx4 v15, s[24:27], s72 offen offset:3072 lds
v_mfma_f32_16x16x32_bf16 v[104:107], v[168:171], a[248:251], v[104:107]
v_and_b32 v64, 0xffff0000, v64
v_mul_f32 v48, v48, v112
v_mfma_f32_16x16x32_bf16 v[104:107], v[184:187], a[252:255], v[104:107]
v_cvt_pk_bf16_f32 v88, v96, v97
v_cvt_pk_bf16_f32 v89, v98, v99
v_cvt_pk_bf16_f32 v90, v100, v101
v_mfma_f32_16x16x32_bf16 v[108:111], v[188:191], a[252:255], v[108:111]
v_cvt_pk_bf16_f32 v91, v102, v103
v_mul_f32 v114, v114, v112
v_mfma_f32_16x16x32_bf16 v[108:111], v[172:175], a[248:251], v[108:111]
v_mul_f32 v48, v48, v115
v_mul_f32 v64, v64, v114
v_mfma_f32_16x16x32_bf16 v[108:111], v[156:159], a[244:247], v[108:111]
s_waitcnt vmcnt(30) lgkmcnt(0)
v_and_b32 v114, 0xffff0000, v49
v_lshlrev_b32 v115, 16, v65
v_mfma_f32_16x16x32_bf16 v[108:111], v[140:143], a[240:243], v[108:111]
s_barrier
v_lshlrev_b32 v49, 16, v49
v_and_b32 v65, 0xffff0000, v65
v_mfma_f32_16x16x32_bf16 v[16:19], v[192:195], a[0:3], 0
s_nop 0
ds_read_b64_tr_b16 v[128:129], v8 offset:16384
ds_read_b64_tr_b16 v[130:131], v8 offset:18432
v_mfma_f32_16x16x32_bf16 v[16:19], v[208:211], a[4:7], v[16:19]
buffer_store_dwordx4 v[84:87], v1, s[44:47], s80 offen offset:1024 sc1
v_mfma_f32_16x16x32_bf16 v[16:19], v[224:227], a[8:11], v[16:19]
s_nop 0
ds_read_b64_tr_b16 v[132:133], v9 offset:16384
ds_read_b64_tr_b16 v[134:135], v9 offset:18432
v_mfma_f32_16x16x32_bf16 v[16:19], v[240:243], a[12:15], v[16:19]
v_cvt_pk_bf16_f32 v92, v104, v105
v_cvt_pk_bf16_f32 v93, v106, v107
v_cvt_pk_bf16_f32 v94, v108, v109
v_mfma_f32_16x16x32_bf16 v[32:35], v[240:243], a[28:31], 0
s_nop 0
ds_read_b64_tr_b16 v[136:137], v10 offset:16384
ds_read_b64_tr_b16 v[138:139], v10 offset:18432
v_cvt_pk_bf16_f32 v95, v110, v111
v_mfma_f32_16x16x32_bf16 v[32:35], v[224:227], a[24:27], v[32:35]
s_nop 0
ds_read_b64_tr_b16 v[140:141], v11 offset:16384
ds_read_b64_tr_b16 v[142:143], v11 offset:18432
v_mfma_f32_16x16x32_bf16 v[32:35], v[208:211], a[20:23], v[32:35]
v_mul_f32 v49, v49, v112
v_mul_f32 v114, v114, v112
v_mfma_f32_16x16x32_bf16 v[32:35], v[192:195], a[16:19], v[32:35]
s_nop 0
ds_read_b64_tr_b16 v[144:145], v8 offset:20480
ds_read_b64_tr_b16 v[146:147], v8 offset:22528
v_mfma_f32_16x16x32_bf16 v[36:39], v[196:199], a[16:19], 0
s_nop 0
ds_read_b64_tr_b16 v[148:149], v9 offset:20480
ds_read_b64_tr_b16 v[150:151], v9 offset:22528
v_mfma_f32_16x16x32_bf16 v[36:39], v[212:215], a[20:23], v[36:39]
v_mul_f32 v49, v49, v115
v_mul_f32 v65, v65, v114
v_mfma_f32_16x16x32_bf16 v[36:39], v[228:231], a[24:27], v[36:39]
s_nop 0
ds_read_b64_tr_b16 v[152:153], v10 offset:20480
ds_read_b64_tr_b16 v[154:155], v10 offset:22528
v_mfma_f32_16x16x32_bf16 v[36:39], v[244:247], a[28:31], v[36:39]
s_nop 0
ds_read_b64_tr_b16 v[156:157], v11 offset:20480
ds_read_b64_tr_b16 v[158:159], v11 offset:22528
v_mfma_f32_16x16x32_bf16 v[20:23], v[244:247], a[12:15], 0
v_and_b32 v114, 0xffff0000, v50
v_lshlrev_b32 v115, 16, v66
v_mfma_f32_16x16x32_bf16 v[20:23], v[228:231], a[8:11], v[20:23]
s_nop 0
ds_read_b64_tr_b16 v[160:161], v8 offset:24576
ds_read_b64_tr_b16 v[162:163], v8 offset:26624
v_mfma_f32_16x16x32_bf16 v[20:23], v[212:215], a[4:7], v[20:23]
v_lshlrev_b32 v50, 16, v50
v_and_b32 v66, 0xffff0000, v66
v_mfma_f32_16x16x32_bf16 v[20:23], v[196:199], a[0:3], v[20:23]
s_nop 0
ds_read_b64_tr_b16 v[164:165], v9 offset:24576
ds_read_b64_tr_b16 v[166:167], v9 offset:26624
v_mfma_f32_16x16x32_bf16 v[24:27], v[200:203], a[0:3], 0
s_nop 0
ds_read_b64_tr_b16 v[168:169], v10 offset:24576
ds_read_b64_tr_b16 v[170:171], v10 offset:26624
v_mfma_f32_16x16x32_bf16 v[24:27], v[216:219], a[4:7], v[24:27]
buffer_store_dwordx4 v[88:91], v1, s[44:47], s80 offen offset:2048 sc1
v_mfma_f32_16x16x32_bf16 v[24:27], v[232:235], a[8:11], v[24:27]
v_mul_f32 v50, v50, v112
v_mul_f32 v114, v114, v112
v_mfma_f32_16x16x32_bf16 v[24:27], v[248:251], a[12:15], v[24:27]
s_nop 0
ds_read_b64_tr_b16 v[172:173], v11 offset:24576
ds_read_b64_tr_b16 v[174:175], v11 offset:26624
v_mfma_f32_16x16x32_bf16 v[40:43], v[248:251], a[28:31], 0
s_nop 0
ds_read_b64_tr_b16 v[176:177], v8 offset:28672
ds_read_b64_tr_b16 v[178:179], v8 offset:30720
v_mfma_f32_16x16x32_bf16 v[40:43], v[232:235], a[24:27], v[40:43]
v_mul_f32 v50, v50, v115
v_mul_f32 v66, v66, v114
v_mfma_f32_16x16x32_bf16 v[40:43], v[216:219], a[20:23], v[40:43]
s_nop 0
ds_read_b64_tr_b16 v[180:181], v9 offset:28672
ds_read_b64_tr_b16 v[182:183], v9 offset:30720
v_mfma_f32_16x16x32_bf16 v[40:43], v[200:203], a[16:19], v[40:43]
s_nop 0
ds_read_b64_tr_b16 v[184:185], v10 offset:28672
ds_read_b64_tr_b16 v[186:187], v10 offset:30720
v_mfma_f32_16x16x32_bf16 v[44:47], v[204:207], a[16:19], 0
v_and_b32 v114, 0xffff0000, v51
v_lshlrev_b32 v115, 16, v67
v_mfma_f32_16x16x32_bf16 v[44:47], v[220:223], a[20:23], v[44:47]
s_nop 0
ds_read_b64_tr_b16 v[188:189], v11 offset:28672
ds_read_b64_tr_b16 v[190:191], v11 offset:30720
v_mfma_f32_16x16x32_bf16 v[44:47], v[236:239], a[24:27], v[44:47]
v_lshlrev_b32 v51, 16, v51
v_and_b32 v67, 0xffff0000, v67
v_mfma_f32_16x16x32_bf16 v[44:47], v[252:255], a[28:31], v[44:47]
v_mul_f32 v51, v51, v112
v_mul_f32 v114, v114, v112
v_mfma_f32_16x16x32_bf16 v[28:31], v[252:255], a[12:15], 0
v_mul_f32 v51, v51, v115
v_mul_f32 v67, v67, v114
v_mfma_f32_16x16x32_bf16 v[28:31], v[236:239], a[8:11], v[28:31]
v_and_b32 v114, 0xffff0000, v52
v_lshlrev_b32 v115, 16, v68
v_mfma_f32_16x16x32_bf16 v[28:31], v[220:223], a[4:7], v[28:31]
s_waitcnt vmcnt(27) lgkmcnt(0)
v_lshlrev_b32 v52, 16, v52
v_and_b32 v68, 0xffff0000, v68
v_mfma_f32_16x16x32_bf16 v[28:31], v[204:207], a[0:3], v[28:31]
s_barrier
v_mul_f32 v52, v52, v112
v_mul_f32 v114, v114, v112
v_mfma_f32_16x16x32_bf16 v[16:19], v[128:131], a[32:35], v[16:19]
s_nop 0
ds_read_b64_tr_b16 v[192:193], v8 offset:32768
ds_read_b64_tr_b16 v[194:195], v8 offset:34816
v_mfma_f32_16x16x32_bf16 v[16:19], v[144:147], a[36:39], v[16:19]
buffer_store_dwordx4 v[92:95], v1, s[44:47], s80 offen offset:3072 sc1
v_mfma_f32_16x16x32_bf16 v[16:19], v[160:163], a[40:43], v[16:19]
s_nop 0
ds_read_b64_tr_b16 v[196:197], v9 offset:32768
ds_read_b64_tr_b16 v[198:199], v9 offset:34816
v_mfma_f32_16x16x32_bf16 v[16:19], v[176:179], a[44:47], v[16:19]
v_mul_f32 v52, v52, v115
v_mul_f32 v68, v68, v114
v_mfma_f32_16x16x32_bf16 v[32:35], v[176:179], a[60:63], v[32:35]
s_nop 0
ds_read_b64_tr_b16 v[200:201], v10 offset:32768
ds_read_b64_tr_b16 v[202:203], v10 offset:34816
v_mfma_f32_16x16x32_bf16 v[32:35], v[160:163], a[56:59], v[32:35]
s_nop 0
ds_read_b64_tr_b16 v[204:205], v11 offset:32768
ds_read_b64_tr_b16 v[206:207], v11 offset:34816
v_mfma_f32_16x16x32_bf16 v[32:35], v[144:147], a[52:55], v[32:35]
v_and_b32 v114, 0xffff0000, v53
v_lshlrev_b32 v115, 16, v69
v_mfma_f32_16x16x32_bf16 v[32:35], v[128:131], a[48:51], v[32:35]
s_nop 0
ds_read_b64_tr_b16 v[208:209], v8 offset:36864
ds_read_b64_tr_b16 v[210:211], v8 offset:38912
v_mfma_f32_16x16x32_bf16 v[36:39], v[132:135], a[48:51], v[36:39]
v_lshlrev_b32 v53, 16, v53
v_and_b32 v69, 0xffff0000, v69
v_mfma_f32_16x16x32_bf16 v[36:39], v[148:151], a[52:55], v[36:39]
s_nop 0
ds_read_b64_tr_b16 v[212:213], v9 offset:36864
ds_read_b64_tr_b16 v[214:215], v9 offset:38912
v_mfma_f32_16x16x32_bf16 v[36:39], v[164:167], a[56:59], v[36:39]
s_nop 0
ds_read_b64_tr_b16 v[216:217], v10 offset:36864
ds_read_b64_tr_b16 v[218:219], v10 offset:38912
v_mfma_f32_16x16x32_bf16 v[36:39], v[180:183], a[60:63], v[36:39]
v_mul_f32 v53, v53, v112
v_mul_f32 v114, v114, v112
v_mfma_f32_16x16x32_bf16 v[20:23], v[180:183], a[44:47], v[20:23]
s_nop 0
ds_read_b64_tr_b16 v[220:221], v11 offset:36864
ds_read_b64_tr_b16 v[222:223], v11 offset:38912
v_mfma_f32_16x16x32_bf16 v[20:23], v[164:167], a[40:43], v[20:23]
v_mul_f32 v53, v53, v115
v_mul_f32 v69, v69, v114
v_mfma_f32_16x16x32_bf16 v[20:23], v[148:151], a[36:39], v[20:23]
s_nop 0
ds_read_b64_tr_b16 v[224:225], v8 offset:40960
ds_read_b64_tr_b16 v[226:227], v8 offset:43008
v_mfma_f32_16x16x32_bf16 v[20:23], v[132:135], a[32:35], v[20:23]
s_nop 0
ds_read_b64_tr_b16 v[228:229], v9 offset:40960
ds_read_b64_tr_b16 v[230:231], v9 offset:43008
v_mfma_f32_16x16x32_bf16 v[24:27], v[136:139], a[32:35], v[24:27]
v_and_b32 v114, 0xffff0000, v54
v_lshlrev_b32 v115, 16, v70
v_mfma_f32_16x16x32_bf16 v[24:27], v[152:155], a[36:39], v[24:27]
s_nop 0
ds_read_b64_tr_b16 v[232:233], v10 offset:40960
ds_read_b64_tr_b16 v[234:235], v10 offset:43008
v_mfma_f32_16x16x32_bf16 v[24:27], v[168:171], a[40:43], v[24:27]
s_nop 0
ds_read_b64_tr_b16 v[236:237], v11 offset:40960
ds_read_b64_tr_b16 v[238:239], v11 offset:43008
v_mfma_f32_16x16x32_bf16 v[24:27], v[184:187], a[44:47], v[24:27]
v_lshlrev_b32 v54, 16, v54
v_and_b32 v70, 0xffff0000, v70
v_mfma_f32_16x16x32_bf16 v[40:43], v[184:187], a[60:63], v[40:43]
s_nop 0
ds_read_b64_tr_b16 v[240:241], v8 offset:45056
ds_read_b64_tr_b16 v[242:243], v8 offset:47104
v_mfma_f32_16x16x32_bf16 v[40:43], v[168:171], a[56:59], v[40:43]
v_mul_f32 v54, v54, v112
v_mul_f32 v114, v114, v112
v_mfma_f32_16x16x32_bf16 v[40:43], v[152:155], a[52:55], v[40:43]
s_nop 0
ds_read_b64_tr_b16 v[244:245], v9 offset:45056
ds_read_b64_tr_b16 v[246:247], v9 offset:47104
v_mfma_f32_16x16x32_bf16 v[40:43], v[136:139], a[48:51], v[40:43]
s_nop 0
ds_read_b64_tr_b16 v[248:249], v10 offset:45056
ds_read_b64_tr_b16 v[250:251], v10 offset:47104
v_mfma_f32_16x16x32_bf16 v[44:47], v[140:143], a[48:51], v[44:47]
v_mul_f32 v54, v54, v115
v_mul_f32 v70, v70, v114
v_mfma_f32_16x16x32_bf16 v[44:47], v[156:159], a[52:55], v[44:47]
s_nop 0
ds_read_b64_tr_b16 v[252:253], v11 offset:45056
ds_read_b64_tr_b16 v[254:255], v11 offset:47104
v_mfma_f32_16x16x32_bf16 v[44:47], v[172:175], a[56:59], v[44:47]
v_and_b32 v114, 0xffff0000, v55
v_lshlrev_b32 v115, 16, v71
v_mfma_f32_16x16x32_bf16 v[44:47], v[188:191], a[60:63], v[44:47]
v_lshlrev_b32 v55, 16, v55
v_and_b32 v71, 0xffff0000, v71
v_mfma_f32_16x16x32_bf16 v[28:31], v[188:191], a[44:47], v[28:31]
v_mul_f32 v55, v55, v112
v_mul_f32 v114, v114, v112
v_mfma_f32_16x16x32_bf16 v[28:31], v[172:175], a[40:43], v[28:31]
s_add_u32 s79, s93, 0x3a00000
v_mul_f32 v55, v55, v115
v_mul_f32 v71, v71, v114
v_mfma_f32_16x16x32_bf16 v[28:31], v[156:159], a[36:39], v[28:31]
s_waitcnt vmcnt(24) lgkmcnt(0)
buffer_load_dwordx4 v[96:99], v1, s[44:47], s79 offen sc1
v_mfma_f32_16x16x32_bf16 v[28:31], v[140:143], a[32:35], v[28:31]
s_barrier
v_and_b32 v114, 0xffff0000, v56
v_lshlrev_b32 v115, 16, v72
v_mfma_f32_16x16x32_bf16 v[16:19], v[192:195], a[64:67], v[16:19]
s_nop 0
ds_read_b64_tr_b16 v[128:129], v8 offset:49152
ds_read_b64_tr_b16 v[130:131], v8 offset:51200
v_mfma_f32_16x16x32_bf16 v[16:19], v[208:211], a[68:71], v[16:19]
s_nop 0
ds_read_b64_tr_b16 v[132:133], v9 offset:49152
ds_read_b64_tr_b16 v[134:135], v9 offset:51200
v_mfma_f32_16x16x32_bf16 v[16:19], v[224:227], a[72:75], v[16:19]
v_lshlrev_b32 v56, 16, v56
v_and_b32 v72, 0xffff0000, v72
v_mfma_f32_16x16x32_bf16 v[16:19], v[240:243], a[76:79], v[16:19]
buffer_load_dwordx4 v[100:103], v1, s[44:47], s79 offen offset:1024 sc1
v_mfma_f32_16x16x32_bf16 v[32:35], v[240:243], a[92:95], v[32:35]
s_nop 0
ds_read_b64_tr_b16 v[136:137], v10 offset:49152
ds_read_b64_tr_b16 v[138:139], v10 offset:51200
v_mfma_f32_16x16x32_bf16 v[32:35], v[224:227], a[88:91], v[32:35]
s_nop 0
ds_read_b64_tr_b16 v[140:141], v11 offset:49152
ds_read_b64_tr_b16 v[142:143], v11 offset:51200
v_mfma_f32_16x16x32_bf16 v[32:35], v[208:211], a[84:87], v[32:35]
v_mul_f32 v56, v56, v113
v_mul_f32 v114, v114, v113
v_mfma_f32_16x16x32_bf16 v[32:35], v[192:195], a[80:83], v[32:35]
s_nop 0
ds_read_b64_tr_b16 v[144:145], v8 offset:53248
ds_read_b64_tr_b16 v[146:147], v8 offset:55296
v_mfma_f32_16x16x32_bf16 v[36:39], v[196:199], a[80:83], v[36:39]
buffer_load_dwordx4 v[104:107], v1, s[44:47], s79 offen offset:2048 sc1
v_mfma_f32_16x16x32_bf16 v[36:39], v[212:215], a[84:87], v[36:39]
s_nop 0
ds_read_b64_tr_b16 v[148:149], v9 offset:53248
ds_read_b64_tr_b16 v[150:151], v9 offset:55296
v_mfma_f32_16x16x32_bf16 v[36:39], v[228:231], a[88:91], v[36:39]
v_mul_f32 v56, v56, v115
v_mul_f32 v72, v72, v114
v_mfma_f32_16x16x32_bf16 v[36:39], v[244:247], a[92:95], v[36:39]
s_nop 0
ds_read_b64_tr_b16 v[152:153], v10 offset:53248
ds_read_b64_tr_b16 v[154:155], v10 offset:55296
v_mfma_f32_16x16x32_bf16 v[20:23], v[244:247], a[76:79], v[20:23]
s_nop 0
ds_read_b64_tr_b16 v[156:157], v11 offset:53248
ds_read_b64_tr_b16 v[158:159], v11 offset:55296
v_mfma_f32_16x16x32_bf16 v[20:23], v[228:231], a[72:75], v[20:23]
buffer_load_dwordx4 v[108:111], v1, s[44:47], s79 offen offset:3072 sc1
v_mfma_f32_16x16x32_bf16 v[20:23], v[212:215], a[68:71], v[20:23]
v_and_b32 v114, 0xffff0000, v57
v_lshlrev_b32 v115, 16, v73
v_mfma_f32_16x16x32_bf16 v[20:23], v[196:199], a[64:67], v[20:23]
s_nop 0
ds_read_b64_tr_b16 v[160:161], v8 offset:57344
ds_read_b64_tr_b16 v[162:163], v8 offset:59392
v_mfma_f32_16x16x32_bf16 v[24:27], v[200:203], a[64:67], v[24:27]
s_nop 0
ds_read_b64_tr_b16 v[164:165], v9 offset:57344
ds_read_b64_tr_b16 v[166:167], v9 offset:59392
v_mfma_f32_16x16x32_bf16 v[24:27], v[216:219], a[68:71], v[24:27]
v_lshlrev_b32 v57, 16, v57
v_and_b32 v73, 0xffff0000, v73
v_mfma_f32_16x16x32_bf16 v[24:27], v[232:235], a[72:75], v[24:27]
s_nop 0
ds_read_b64_tr_b16 v[168:169], v10 offset:57344
ds_read_b64_tr_b16 v[170:171], v10 offset:59392
v_mfma_f32_16x16x32_bf16 v[24:27], v[248:251], a[76:79], v[24:27]
s_nop 0
ds_read_b64_tr_b16 v[172:173], v11 offset:57344
ds_read_b64_tr_b16 v[174:175], v11 offset:59392
v_mfma_f32_16x16x32_bf16 v[40:43], v[248:251], a[92:95], v[40:43]
v_mul_f32 v57, v57, v113
v_mul_f32 v114, v114, v113
v_mfma_f32_16x16x32_bf16 v[40:43], v[232:235], a[88:91], v[40:43]
s_nop 0
ds_read_b64_tr_b16 v[176:177], v8 offset:61440
ds_read_b64_tr_b16 v[178:179], v8 offset:63488
v_mfma_f32_16x16x32_bf16 v[40:43], v[216:219], a[84:87], v[40:43]
s_nop 0
ds_read_b64_tr_b16 v[180:181], v9 offset:61440
ds_read_b64_tr_b16 v[182:183], v9 offset:63488
v_mfma_f32_16x16x32_bf16 v[40:43], v[200:203], a[80:83], v[40:43]
v_mul_f32 v57, v57, v115
v_mul_f32 v73, v73, v114
v_mfma_f32_16x16x32_bf16 v[44:47], v[204:207], a[80:83], v[44:47]
s_nop 0
ds_read_b64_tr_b16 v[184:185], v10 offset:61440
ds_read_b64_tr_b16 v[186:187], v10 offset:63488
v_mfma_f32_16x16x32_bf16 v[44:47], v[220:223], a[84:87], v[44:47]
s_nop 0
ds_read_b64_tr_b16 v[188:189], v11 offset:61440
ds_read_b64_tr_b16 v[190:191], v11 offset:63488
v_mfma_f32_16x16x32_bf16 v[44:47], v[236:239], a[88:91], v[44:47]
v_and_b32 v114, 0xffff0000, v58
v_lshlrev_b32 v115, 16, v74
v_mfma_f32_16x16x32_bf16 v[44:47], v[252:255], a[92:95], v[44:47]
v_lshlrev_b32 v58, 16, v58
v_and_b32 v74, 0xffff0000, v74
v_mfma_f32_16x16x32_bf16 v[28:31], v[252:255], a[76:79], v[28:31]
v_xor_b32 v8, 0x10000, v8
v_mul_f32 v58, v58, v113
v_mfma_f32_16x16x32_bf16 v[28:31], v[236:239], a[72:75], v[28:31]
v_xor_b32 v9, 0x10000, v9
v_mul_f32 v114, v114, v113
v_mfma_f32_16x16x32_bf16 v[28:31], v[220:223], a[68:71], v[28:31]
s_waitcnt vmcnt(22) lgkmcnt(0)
v_xor_b32 v10, 0x10000, v10
v_mul_f32 v58, v58, v115
v_mfma_f32_16x16x32_bf16 v[28:31], v[204:207], a[64:67], v[28:31]
s_barrier
v_xor_b32 v11, 0x10000, v11
v_mul_f32 v74, v74, v114
v_mfma_f32_16x16x32_bf16 v[16:19], v[128:131], a[96:99], v[16:19]
Lstube4:
s_cbranch_execz Lrete
s_nop 0
ds_read_b64_tr_b16 v[192:193], v8 offset:0
ds_read_b64_tr_b16 v[194:195], v8 offset:2048
v_mfma_f32_16x16x32_bf16 v[16:19], v[144:147], a[100:103], v[16:19]
s_nop 0
ds_read_b64_tr_b16 v[196:197], v9 offset:0
ds_read_b64_tr_b16 v[198:199], v9 offset:2048
v_mfma_f32_16x16x32_bf16 v[16:19], v[160:163], a[104:107], v[16:19]
v_and_b32 v114, 0xffff0000, v59
v_lshlrev_b32 v115, 16, v75
v_mfma_f32_16x16x32_bf16 v[16:19], v[176:179], a[108:111], v[16:19]
s_nop 0
ds_read_b64_tr_b16 v[200:201], v10 offset:0
ds_read_b64_tr_b16 v[202:203], v10 offset:2048
v_mfma_f32_16x16x32_bf16 v[32:35], v[176:179], a[124:127], v[32:35]
v_lshlrev_b32 v59, 16, v59
v_and_b32 v75, 0xffff0000, v75
v_mfma_f32_16x16x32_bf16 v[32:35], v[160:163], a[120:123], v[32:35]
s_nop 0
ds_read_b64_tr_b16 v[204:205], v11 offset:0
ds_read_b64_tr_b16 v[206:207], v11 offset:2048
v_mfma_f32_16x16x32_bf16 v[32:35], v[144:147], a[116:119], v[32:35]
s_nop 0
ds_read_b64_tr_b16 v[208:209], v8 offset:4096
ds_read_b64_tr_b16 v[210:211], v8 offset:6144
v_mfma_f32_16x16x32_bf16 v[32:35], v[128:131], a[112:115], v[32:35]
v_mul_f32 v59, v59, v113
v_mul_f32 v114, v114, v113
v_mfma_f32_16x16x32_bf16 v[36:39], v[132:135], a[112:115], v[36:39]
s_nop 0
ds_read_b64_tr_b16 v[212:213], v9 offset:4096
ds_read_b64_tr_b16 v[214:215], v9 offset:6144
v_mfma_f32_16x16x32_bf16 v[36:39], v[148:151], a[116:119], v[36:39]
v_mul_f32 v59, v59, v115
v_mul_f32 v75, v75, v114
v_mfma_f32_16x16x32_bf16 v[36:39], v[164:167], a[120:123], v[36:39]
s_nop 0
ds_read_b64_tr_b16 v[216:217], v10 offset:4096
ds_read_b64_tr_b16 v[218:219], v10 offset:6144
v_mfma_f32_16x16x32_bf16 v[36:39], v[180:183], a[124:127], v[36:39]
s_nop 0
ds_read_b64_tr_b16 v[220:221], v11 offset:4096
ds_read_b64_tr_b16 v[222:223], v11 offset:6144
v_mfma_f32_16x16x32_bf16 v[20:23], v[180:183], a[108:111], v[20:23]
v_and_b32 v114, 0xffff0000, v60
v_lshlrev_b32 v115, 16, v76
v_mfma_f32_16x16x32_bf16 v[20:23], v[164:167], a[104:107], v[20:23]
s_nop 0
ds_read_b64_tr_b16 v[224:225], v8 offset:8192
ds_read_b64_tr_b16 v[226:227], v8 offset:10240
v_mfma_f32_16x16x32_bf16 v[20:23], v[148:151], a[100:103], v[20:23]
v_lshlrev_b32 v60, 16, v60
v_and_b32 v76, 0xffff0000, v76
v_mfma_f32_16x16x32_bf16 v[20:23], v[132:135], a[96:99], v[20:23]
s_nop 0
ds_read_b64_tr_b16 v[228:229], v9 offset:8192
ds_read_b64_tr_b16 v[230:231], v9 offset:10240
v_mfma_f32_16x16x32_bf16 v[24:27], v[136:139], a[96:99], v[24:27]
s_nop 0
ds_read_b64_tr_b16 v[232:233], v10 offset:8192
ds_read_b64_tr_b16 v[234:235], v10 offset:10240
v_mfma_f32_16x16x32_bf16 v[24:27], v[152:155], a[100:103], v[24:27]
v_mul_f32 v60, v60, v113
v_mul_f32 v114, v114, v113
v_mfma_f32_16x16x32_bf16 v[24:27], v[168:171], a[104:107], v[24:27]
s_nop 0
ds_read_b64_tr_b16 v[236:237], v11 offset:8192
ds_read_b64_tr_b16 v[238:239], v11 offset:10240
v_mfma_f32_16x16x32_bf16 v[24:27], v[184:187], a[108:111], v[24:27]
v_mul_f32 v60, v60, v115
v_mul_f32 v76, v76, v114
v_mfma_f32_16x16x32_bf16 v[40:43], v[184:187], a[124:127], v[40:43]
s_nop 0
ds_read_b64_tr_b16 v[240:241], v8 offset:12288
ds_read_b64_tr_b16 v[242:243], v8 offset:14336
v_mfma_f32_16x16x32_bf16 v[40:43], v[168:171], a[120:123], v[40:43]
s_nop 0
ds_read_b64_tr_b16 v[244:245], v9 offset:12288
ds_read_b64_tr_b16 v[246:247], v9 offset:14336
v_mfma_f32_16x16x32_bf16 v[40:43], v[152:155], a[116:119], v[40:43]
v_and_b32 v114, 0xffff0000, v61
v_lshlrev_b32 v115, 16, v77
v_mfma_f32_16x16x32_bf16 v[40:43], v[136:139], a[112:115], v[40:43]
s_nop 0
ds_read_b64_tr_b16 v[248:249], v10 offset:12288
ds_read_b64_tr_b16 v[250:251], v10 offset:14336
v_mfma_f32_16x16x32_bf16 v[44:47], v[140:143], a[112:115], v[44:47]
v_lshlrev_b32 v61, 16, v61
v_and_b32 v77, 0xffff0000, v77
v_mfma_f32_16x16x32_bf16 v[44:47], v[156:159], a[116:119], v[44:47]
s_nop 0
ds_read_b64_tr_b16 v[252:253], v11 offset:12288
ds_read_b64_tr_b16 v[254:255], v11 offset:14336
v_mfma_f32_16x16x32_bf16 v[44:47], v[172:175], a[120:123], v[44:47]
v_mul_f32 v61, v61, v113
v_mul_f32 v114, v114, v113
v_mfma_f32_16x16x32_bf16 v[44:47], v[188:191], a[124:127], v[44:47]
s_waitcnt vmcnt(0)
v_max3_u32 v12, v96, v97, v98
v_max3_u32 v13, v99, v100, v101
v_mfma_f32_16x16x32_bf16 v[28:31], v[188:191], a[108:111], v[28:31]
v_max3_u32 v12, v12, v102, v103
v_max3_u32 v13, v13, v104, v105
v_mfma_f32_16x16x32_bf16 v[28:31], v[172:175], a[104:107], v[28:31]
v_max3_u32 v12, v12, v106, v107
v_max3_u32 v13, v13, v108, v109
v_mfma_f32_16x16x32_bf16 v[28:31], v[156:159], a[100:103], v[28:31]
s_waitcnt vmcnt(16) lgkmcnt(0)
v_max3_u32 v12, v12, v110, v111
v_mul_f32 v61, v61, v115
v_mfma_f32_16x16x32_bf16 v[28:31], v[140:143], a[96:99], v[28:31]
s_barrier
v_max_u32 v12, v12, v13
v_mul_f32 v77, v77, v114
v_mfma_f32_16x16x32_bf16 v[16:19], v[192:195], a[128:131], v[16:19]
v_cmp_le_u32 vcc, 0xff800000, v12
v_and_b32 v114, 0xffff0000, v62
v_mfma_f32_16x16x32_bf16 v[16:19], v[208:211], a[132:135], v[16:19]
s_nop 0
ds_read_b64_tr_b16 v[128:129], v8 offset:16384
ds_read_b64_tr_b16 v[130:131], v8 offset:18432
v_mfma_f32_16x16x32_bf16 v[16:19], v[224:227], a[136:139], v[16:19]
s_cbranch_vccnz Lxspin1
Lxback1:
ds_read_b64_tr_b16 v[132:133], v9 offset:16384
ds_read_b64_tr_b16 v[134:135], v9 offset:18432
v_mfma_f32_16x16x32_bf16 v[16:19], v[240:243], a[140:143], v[16:19]
v_lshlrev_b32 v115, 16, v78
v_lshlrev_b32 v62, 16, v62
v_mfma_f32_16x16x32_bf16 v[16:19], v[124:127], v[96:99], v[16:19]
s_nop 0
ds_read_b64_tr_b16 v[136:137], v10 offset:16384
ds_read_b64_tr_b16 v[138:139], v10 offset:18432
v_mfma_f32_16x16x32_bf16 v[32:35], v[240:243], a[156:159], v[32:35]
v_and_b32 v78, 0xffff0000, v78
v_mul_f32 v62, v62, v113
v_mfma_f32_16x16x32_bf16 v[32:35], v[224:227], a[152:155], v[32:35]
s_add_u32 s82, s93, 0x3e00000
buffer_load_dwordx4 v[80:83], v1, s[44:47], s82 offen sc1
v_mfma_f32_16x16x32_bf16 v[32:35], v[208:211], a[148:151], v[32:35]
s_nop 0
ds_read_b64_tr_b16 v[140:141], v11 offset:16384
ds_read_b64_tr_b16 v[142:143], v11 offset:18432
v_mfma_f32_16x16x32_bf16 v[32:35], v[192:195], a[144:147], v[32:35]
v_mul_f32 v114, v114, v113
v_mul_f32 v62, v62, v115
v_mfma_f32_16x16x32_bf16 v[32:35], v[124:127], v[104:107], v[32:35]
s_nop 0
ds_read_b64_tr_b16 v[144:145], v8 offset:20480
ds_read_b64_tr_b16 v[146:147], v8 offset:22528
v_mfma_f32_16x16x32_bf16 v[36:39], v[196:199], a[144:147], v[36:39]
v_mul_f32 v78, v78, v114
v_and_b32 v114, 0xffff0000, v63
v_mfma_f32_16x16x32_bf16 v[36:39], v[212:215], a[148:151], v[36:39]
buffer_load_dwordx4 v[84:87], v1, s[44:47], s82 offen offset:1024 sc1
v_mfma_f32_16x16x32_bf16 v[36:39], v[228:231], a[152:155], v[36:39]
s_nop 0
ds_read_b64_tr_b16 v[148:149], v9 offset:20480
ds_read_b64_tr_b16 v[150:151], v9 offset:22528
v_mfma_f32_16x16x32_bf16 v[36:39], v[244:247], a[156:159], v[36:39]
v_lshlrev_b32 v115, 16, v79
v_lshlrev_b32 v63, 16, v63
v_mfma_f32_16x16x32_bf16 v[36:39], v[120:123], v[104:107], v[36:39]
s_nop 0
ds_read_b64_tr_b16 v[152:153], v10 offset:20480
ds_read_b64_tr_b16 v[154:155], v10 offset:22528
v_mfma_f32_16x16x32_bf16 v[20:23], v[244:247], a[140:143], v[20:23]
v_and_b32 v79, 0xffff0000, v79
v_mul_f32 v63, v63, v113
v_mfma_f32_16x16x32_bf16 v[20:23], v[228:231], a[136:139], v[20:23]
buffer_load_dwordx4 v[88:91], v1, s[44:47], s82 offen offset:2048 sc1
v_mfma_f32_16x16x32_bf16 v[20:23], v[212:215], a[132:135], v[20:23]
s_nop 0
ds_read_b64_tr_b16 v[156:157], v11 offset:20480
ds_read_b64_tr_b16 v[158:159], v11 offset:22528
v_mfma_f32_16x16x32_bf16 v[20:23], v[196:199], a[128:131], v[20:23]
v_mul_f32 v114, v114, v113
v_mul_f32 v63, v63, v115
v_mfma_f32_16x16x32_bf16 v[20:23], v[120:123], v[96:99], v[20:23]
s_nop 0
ds_read_b64_tr_b16 v[160:161], v8 offset:24576
ds_read_b64_tr_b16 v[162:163], v8 offset:26624
v_mfma_f32_16x16x32_bf16 v[24:27], v[200:203], a[128:131], v[24:27]
s_nop 0
ds_read_b64_tr_b16 v[164:165], v9 offset:24576
ds_read_b64_tr_b16 v[166:167], v9 offset:26624
v_mfma_f32_16x16x32_bf16 v[24:27], v[216:219], a[132:135], v[24:27]
buffer_load_dwordx4 v[92:95], v1, s[44:47], s82 offen offset:3072 sc1
v_mfma_f32_16x16x32_bf16 v[24:27], v[232:235], a[136:139], v[24:27]
v_mul_f32 v79, v79, v114
v_mfma_f32_16x16x32_bf16 v[24:27], v[248:251], a[140:143], v[24:27]
s_nop 0
ds_read_b64_tr_b16 v[168:169], v10 offset:24576
ds_read_b64_tr_b16 v[170:171], v10 offset:26624
v_mfma_f32_16x16x32_bf16 v[24:27], v[124:127], v[100:103], v[24:27]
v_mfma_f32_16x16x32_bf16 v[40:43], v[248:251], a[156:159], v[40:43]
s_nop 0
ds_read_b64_tr_b16 v[172:173], v11 offset:24576
ds_read_b64_tr_b16 v[174:175], v11 offset:26624
v_mfma_f32_16x16x32_bf16 v[40:43], v[232:235], a[152:155], v[40:43]
v_mfma_f32_16x16x32_bf16 v[40:43], v[216:219], a[148:151], v[40:43]
s_nop 0
ds_read_b64_tr_b16 v[176:177], v8 offset:28672
ds_read_b64_tr_b16 v[178:179], v8 offset:30720
v_mfma_f32_16x16x32_bf16 v[40:43], v[200:203], a[144:147], v[40:43]
v_mfma_f32_16x16x32_bf16 v[40:43], v[124:127], v[108:111], v[40:43]
s_nop 0
ds_read_b64_tr_b16 v[180:181], v9 offset:28672
ds_read_b64_tr_b16 v[182:183], v9 offset:30720
v_mfma_f32_16x16x32_bf16 v[44:47], v[204:207], a[144:147], v[44:47]
v_mfma_f32_16x16x32_bf16 v[44:47], v[220:223], a[148:151], v[44:47]
s_nop 0
ds_read_b64_tr_b16 v[184:185], v10 offset:28672
ds_read_b64_tr_b16 v[186:187], v10 offset:30720
v_mfma_f32_16x16x32_bf16 v[44:47], v[236:239], a[152:155], v[44:47]
v_mfma_f32_16x16x32_bf16 v[44:47], v[252:255], a[156:159], v[44:47]
s_nop 0
ds_read_b64_tr_b16 v[188:189], v11 offset:28672
ds_read_b64_tr_b16 v[190:191], v11 offset:30720
v_mfma_f32_16x16x32_bf16 v[44:47], v[120:123], v[108:111], v[44:47]
v_mfma_f32_16x16x32_bf16 v[28:31], v[252:255], a[140:143], v[28:31]
v_mfma_f32_16x16x32_bf16 v[28:31], v[236:239], a[136:139], v[28:31]
v_mfma_f32_16x16x32_bf16 v[28:31], v[220:223], a[132:135], v[28:31]
v_mfma_f32_16x16x32_bf16 v[28:31], v[204:207], a[128:131], v[28:31]
s_waitcnt vmcnt(16) lgkmcnt(0)
v_mfma_f32_16x16x32_bf16 v[28:31], v[120:123], v[100:103], v[28:31]
s_barrier
v_mfma_f32_16x16x32_bf16 v[16:19], v[128:131], a[160:163], v[16:19]
s_nop 0
ds_read_b64_tr_b16 v[192:193], v8 offset:32768
ds_read_b64_tr_b16 v[194:195], v8 offset:34816
v_mfma_f32_16x16x32_bf16 v[16:19], v[144:147], a[164:167], v[16:19]
s_nop 0
ds_read_b64_tr_b16 v[196:197], v9 offset:32768
ds_read_b64_tr_b16 v[198:199], v9 offset:34816
v_mfma_f32_16x16x32_bf16 v[16:19], v[160:163], a[168:171], v[16:19]
s_nop 0
ds_read_b64_tr_b16 v[200:201], v10 offset:32768
ds_read_b64_tr_b16 v[202:203], v10 offset:34816
v_mfma_f32_16x16x32_bf16 v[16:19], v[176:179], a[172:175], v[16:19]
v_mfma_f32_16x16x32_bf16 v[32:35], v[176:179], a[188:191], v[32:35]
s_nop 0
ds_read_b64_tr_b16 v[204:205], v11 offset:32768
ds_read_b64_tr_b16 v[206:207], v11 offset:34816
v_mfma_f32_16x16x32_bf16 v[32:35], v[160:163], a[184:187], v[32:35]
s_nop 0
ds_read_b64_tr_b16 v[208:209], v8 offset:36864
ds_read_b64_tr_b16 v[210:211], v8 offset:38912
v_mfma_f32_16x16x32_bf16 v[32:35], v[144:147], a[180:183], v[32:35]
s_add_u32 s81, s93, 0x4200000
buffer_load_dwordx4 v[96:99], v1, s[44:47], s81 offen sc1
v_mfma_f32_16x16x32_bf16 v[32:35], v[128:131], a[176:179], v[32:35]
v_mfma_f32_16x16x32_bf16 v[36:39], v[132:135], a[176:179], v[36:39]
s_nop 0
ds_read_b64_tr_b16 v[212:213], v9 offset:36864
ds_read_b64_tr_b16 v[214:215], v9 offset:38912
v_mfma_f32_16x16x32_bf16 v[36:39], v[148:151], a[180:183], v[36:39]
s_nop 0
ds_read_b64_tr_b16 v[216:217], v10 offset:36864
ds_read_b64_tr_b16 v[218:219], v10 offset:38912
v_mfma_f32_16x16x32_bf16 v[36:39], v[164:167], a[184:187], v[36:39]
v_mfma_f32_16x16x32_bf16 v[36:39], v[180:183], a[188:191], v[36:39]
buffer_load_dwordx4 v[100:103], v1, s[44:47], s81 offen offset:1024 sc1
v_mfma_f32_16x16x32_bf16 v[20:23], v[180:183], a[172:175], v[20:23]
s_nop 0
ds_read_b64_tr_b16 v[220:221], v11 offset:36864
ds_read_b64_tr_b16 v[222:223], v11 offset:38912
v_mfma_f32_16x16x32_bf16 v[20:23], v[164:167], a[168:171], v[20:23]
s_nop 0
ds_read_b64_tr_b16 v[224:225], v8 offset:40960
ds_read_b64_tr_b16 v[226:227], v8 offset:43008
v_mfma_f32_16x16x32_bf16 v[20:23], v[148:151], a[164:167], v[20:23]
s_nop 0
ds_read_b64_tr_b16 v[228:229], v9 offset:40960
ds_read_b64_tr_b16 v[230:231], v9 offset:43008
v_mfma_f32_16x16x32_bf16 v[20:23], v[132:135], a[160:163], v[20:23]
v_mfma_f32_16x16x32_bf16 v[24:27], v[136:139], a[160:163], v[24:27]
buffer_load_dwordx4 v[104:107], v1, s[44:47], s81 offen offset:2048 sc1
v_mfma_f32_16x16x32_bf16 v[24:27], v[152:155], a[164:167], v[24:27]
s_nop 0
ds_read_b64_tr_b16 v[232:233], v10 offset:40960
ds_read_b64_tr_b16 v[234:235], v10 offset:43008
v_mfma_f32_16x16x32_bf16 v[24:27], v[168:171], a[168:171], v[24:27]
s_nop 0
ds_read_b64_tr_b16 v[236:237], v11 offset:40960
ds_read_b64_tr_b16 v[238:239], v11 offset:43008
v_mfma_f32_16x16x32_bf16 v[24:27], v[184:187], a[172:175], v[24:27]
v_mfma_f32_16x16x32_bf16 v[40:43], v[184:187], a[188:191], v[40:43]
s_nop 0
ds_read_b64_tr_b16 v[240:241], v8 offset:45056
ds_read_b64_tr_b16 v[242:243], v8 offset:47104
v_mfma_f32_16x16x32_bf16 v[40:43], v[168:171], a[184:187], v[40:43]
buffer_load_dwordx4 v[108:111], v1, s[44:47], s81 offen offset:3072 sc1
v_mfma_f32_16x16x32_bf16 v[40:43], v[152:155], a[180:183], v[40:43]
s_nop 0
ds_read_b64_tr_b16 v[244:245], v9 offset:45056
ds_read_b64_tr_b16 v[246:247], v9 offset:47104
v_mfma_f32_16x16x32_bf16 v[40:43], v[136:139], a[176:179], v[40:43]
v_mfma_f32_16x16x32_bf16 v[44:47], v[140:143], a[176:179], v[44:47]
s_nop 0
ds_read_b64_tr_b16 v[248:249], v10 offset:45056
ds_read_b64_tr_b16 v[250:251], v10 offset:47104
v_mfma_f32_16x16x32_bf16 v[44:47], v[156:159], a[180:183], v[44:47]
s_nop 0
ds_read_b64_tr_b16 v[252:253], v11 offset:45056
ds_read_b64_tr_b16 v[254:255], v11 offset:47104
v_mfma_f32_16x16x32_bf16 v[44:47], v[172:175], a[184:187], v[44:47]
v_mfma_f32_16x16x32_bf16 v[44:47], v[188:191], a[188:191], v[44:47]
s_waitcnt vmcnt(4)
v_max3_u32 v12, v80, v81, v82
v_max3_u32 v13, v83, v84, v85
v_mfma_f32_16x16x32_bf16 v[28:31], v[188:191], a[172:175], v[28:31]
v_max3_u32 v12, v12, v86, v87
v_max3_u32 v13, v13, v88, v89
v_mfma_f32_16x16x32_bf16 v[28:31], v[172:175], a[168:171], v[28:31]
v_max3_u32 v12, v12, v90, v91
v_max3_u32 v13, v13, v92, v93
v_mfma_f32_16x16x32_bf16 v[28:31], v[156:159], a[164:167], v[28:31]
s_waitcnt vmcnt(15) lgkmcnt(0)
v_max3_u32 v12, v12, v94, v95
v_mfma_f32_16x16x32_bf16 v[28:31], v[140:143], a[160:163], v[28:31]
s_barrier
v_max_u32 v12, v12, v13
v_mfma_f32_16x16x32_bf16 v[16:19], v[192:195], a[192:195], v[16:19]
v_cmp_le_u32 vcc, 0xff800000, v12
v_mfma_f32_16x16x32_bf16 v[16:19], v[208:211], a[196:199], v[16:19]
s_nop 0
ds_read_b64_tr_b16 v[128:129], v8 offset:49152
ds_read_b64_tr_b16 v[130:131], v8 offset:51200
v_mfma_f32_16x16x32_bf16 v[16:19], v[224:227], a[200:203], v[16:19]
s_cbranch_vccnz Lxspin2
Lxback2:
v_mfma_f32_16x16x32_bf16 v[16:19], v[240:243], a[204:207], v[16:19]
s_nop 0
ds_read_b64_tr_b16 v[132:133], v9 offset:49152
ds_read_b64_tr_b16 v[134:135], v9 offset:51200
v_mfma_f32_16x16x32_bf16 v[16:19], v[124:127], v[80:83], v[16:19]
v_mfma_f32_16x16x32_bf16 v[32:35], v[240:243], a[220:223], v[32:35]
s_nop 0
ds_read_b64_tr_b16 v[136:137], v10 offset:49152
ds_read_b64_tr_b16 v[138:139], v10 offset:51200
v_mfma_f32_16x16x32_bf16 v[32:35], v[224:227], a[216:219], v[32:35]
v_mfma_f32_16x16x32_bf16 v[32:35], v[208:211], a[212:215], v[32:35]
s_nop 0
ds_read_b64_tr_b16 v[140:141], v11 offset:49152
ds_read_b64_tr_b16 v[142:143], v11 offset:51200
v_mfma_f32_16x16x32_bf16 v[32:35], v[192:195], a[208:211], v[32:35]
v_mfma_f32_16x16x32_bf16 v[32:35], v[124:127], v[88:91], v[32:35]
s_nop 0
ds_read_b64_tr_b16 v[144:145], v8 offset:53248
ds_read_b64_tr_b16 v[146:147], v8 offset:55296
v_mfma_f32_16x16x32_bf16 v[36:39], v[196:199], a[208:211], v[36:39]
v_mfma_f32_16x16x32_bf16 v[36:39], v[212:215], a[212:215], v[36:39]
s_nop 0
ds_read_b64_tr_b16 v[148:149], v9 offset:53248
ds_read_b64_tr_b16 v[150:151], v9 offset:55296
v_mfma_f32_16x16x32_bf16 v[36:39], v[228:231], a[216:219], v[36:39]
v_mfma_f32_16x16x32_bf16 v[36:39], v[244:247], a[220:223], v[36:39]
s_nop 0
ds_read_b64_tr_b16 v[152:153], v10 offset:53248
ds_read_b64_tr_b16 v[154:155], v10 offset:55296
v_mfma_f32_16x16x32_bf16 v[36:39], v[120:123], v[88:91], v[36:39]
v_mfma_f32_16x16x32_bf16 v[20:23], v[244:247], a[204:207], v[20:23]
s_nop 0
ds_read_b64_tr_b16 v[156:157], v11 offset:53248
ds_read_b64_tr_b16 v[158:159], v11 offset:55296
v_mfma_f32_16x16x32_bf16 v[20:23], v[228:231], a[200:203], v[20:23]
v_mfma_f32_16x16x32_bf16 v[20:23], v[212:215], a[196:199], v[20:23]
v_mfma_f32_16x16x32_bf16 v[20:23], v[196:199], a[192:195], v[20:23]
s_nop 0
ds_read_b64_tr_b16 v[160:161], v8 offset:57344
ds_read_b64_tr_b16 v[162:163], v8 offset:59392
v_mfma_f32_16x16x32_bf16 v[20:23], v[120:123], v[80:83], v[20:23]
v_mfma_f32_16x16x32_bf16 v[24:27], v[200:203], a[192:195], v[24:27]
s_nop 0
ds_read_b64_tr_b16 v[164:165], v9 offset:57344
ds_read_b64_tr_b16 v[166:167], v9 offset:59392
v_mfma_f32_16x16x32_bf16 v[24:27], v[216:219], a[196:199], v[24:27]
v_mfma_f32_16x16x32_bf16 v[24:27], v[232:235], a[200:203], v[24:27]
s_nop 0
ds_read_b64_tr_b16 v[168:169], v10 offset:57344
ds_read_b64_tr_b16 v[170:171], v10 offset:59392
v_mfma_f32_16x16x32_bf16 v[24:27], v[248:251], a[204:207], v[24:27]
v_mfma_f32_16x16x32_bf16 v[24:27], v[124:127], v[84:87], v[24:27]
s_nop 0
ds_read_b64_tr_b16 v[172:173], v11 offset:57344
ds_read_b64_tr_b16 v[174:175], v11 offset:59392
v_mfma_f32_16x16x32_bf16 v[40:43], v[248:251], a[220:223], v[40:43]
v_mfma_f32_16x16x32_bf16 v[40:43], v[232:235], a[216:219], v[40:43]
s_nop 0
ds_read_b64_tr_b16 v[176:177], v8 offset:61440
ds_read_b64_tr_b16 v[178:179], v8 offset:63488
v_mfma_f32_16x16x32_bf16 v[40:43], v[216:219], a[212:215], v[40:43]
v_mfma_f32_16x16x32_bf16 v[40:43], v[200:203], a[208:211], v[40:43]
s_nop 0
ds_read_b64_tr_b16 v[180:181], v9 offset:61440
ds_read_b64_tr_b16 v[182:183], v9 offset:63488
v_mfma_f32_16x16x32_bf16 v[40:43], v[124:127], v[92:95], v[40:43]
v_mfma_f32_16x16x32_bf16 v[44:47], v[204:207], a[208:211], v[44:47]
s_nop 0
ds_read_b64_tr_b16 v[184:185], v10 offset:61440
ds_read_b64_tr_b16 v[186:187], v10 offset:63488
v_mfma_f32_16x16x32_bf16 v[44:47], v[220:223], a[212:215], v[44:47]
v_mfma_f32_16x16x32_bf16 v[44:47], v[236:239], a[216:219], v[44:47]
s_nop 0
ds_read_b64_tr_b16 v[188:189], v11 offset:61440
ds_read_b64_tr_b16 v[190:191], v11 offset:63488
v_mfma_f32_16x16x32_bf16 v[44:47], v[252:255], a[220:223], v[44:47]
v_mfma_f32_16x16x32_bf16 v[44:47], v[120:123], v[92:95], v[44:47]
v_mfma_f32_16x16x32_bf16 v[28:31], v[252:255], a[204:207], v[28:31]
s_waitcnt vmcnt(0)
v_max3_u32 v12, v96, v97, v98
v_max3_u32 v13, v99, v100, v101
v_mfma_f32_16x16x32_bf16 v[28:31], v[236:239], a[200:203], v[28:31]
v_max3_u32 v12, v12, v102, v103
v_max3_u32 v13, v13, v104, v105
v_mfma_f32_16x16x32_bf16 v[28:31], v[220:223], a[196:199], v[28:31]
v_max3_u32 v12, v12, v106, v107
v_max3_u32 v13, v13, v108, v109
v_mfma_f32_16x16x32_bf16 v[28:31], v[204:207], a[192:195], v[28:31]
s_waitcnt lgkmcnt(0)
v_max3_u32 v12, v12, v110, v111
v_mfma_f32_16x16x32_bf16 v[28:31], v[120:123], v[84:87], v[28:31]
v_max_u32 v12, v12, v13
v_mfma_f32_16x16x32_bf16 v[16:19], v[128:131], a[224:227], v[16:19]
v_cmp_le_u32 vcc, 0xff800000, v12
v_mfma_f32_16x16x32_bf16 v[16:19], v[144:147], a[228:231], v[16:19]
v_mfma_f32_16x16x32_bf16 v[16:19], v[160:163], a[232:235], v[16:19]
s_cbranch_vccnz Lxspin3
Lxback3:
v_mfma_f32_16x16x32_bf16 v[16:19], v[176:179], a[236:239], v[16:19]
v_mfma_f32_16x16x32_bf16 v[16:19], v[124:127], v[96:99], v[16:19]
v_mfma_f32_16x16x32_bf16 v[20:23], v[180:183], a[236:239], v[20:23]
v_mfma_f32_16x16x32_bf16 v[20:23], v[164:167], a[232:235], v[20:23]
v_mfma_f32_16x16x32_bf16 v[20:23], v[148:151], a[228:231], v[20:23]
v_mfma_f32_16x16x32_bf16 v[20:23], v[132:135], a[224:227], v[20:23]
s_nop 3
v_fma_f32 v16, v16, v6, v48
v_fma_f32 v17, v17, v6, v64
v_mfma_f32_16x16x32_bf16 v[20:23], v[120:123], v[96:99], v[20:23]
v_fma_f32 v18, v18, v6, v49
v_fma_f32 v19, v19, v6, v65
v_mfma_f32_16x16x32_bf16 v[24:27], v[136:139], a[224:227], v[24:27]
v_cvt_pk_bf16_f32 v16, v16, v17
v_cvt_pk_bf16_f32 v17, v18, v19
v_mfma_f32_16x16x32_bf16 v[24:27], v[152:155], a[228:231], v[24:27]
ds_write_b64 v116, v[16:17] offset:0
v_mfma_f32_16x16x32_bf16 v[24:27], v[168:171], a[232:235], v[24:27]
v_mfma_f32_16x16x32_bf16 v[24:27], v[184:187], a[236:239], v[24:27]
v_fma_f32 v20, v20, v6, v50
v_fma_f32 v21, v21, v6, v66
v_mfma_f32_16x16x32_bf16 v[24:27], v[124:127], v[100:103], v[24:27]
v_fma_f32 v22, v22, v6, v51
v_fma_f32 v23, v23, v6, v67
v_mfma_f32_16x16x32_bf16 v[28:31], v[188:191], a[236:239], v[28:31]
v_cvt_pk_bf16_f32 v20, v20, v21
v_cvt_pk_bf16_f32 v21, v22, v23
v_mfma_f32_16x16x32_bf16 v[28:31], v[172:175], a[232:235], v[28:31]
ds_write_b64 v117, v[20:21] offset:0
v_mfma_f32_16x16x32_bf16 v[28:31], v[156:159], a[228:231], v[28:31]
v_mfma_f32_16x16x32_bf16 v[28:31], v[140:143], a[224:227], v[28:31]
v_fma_f32 v24, v24, v6, v52
v_fma_f32 v25, v25, v6, v68
v_mfma_f32_16x16x32_bf16 v[28:31], v[120:123], v[100:103], v[28:31]
v_fma_f32 v26, v26, v6, v53
v_fma_f32 v27, v27, v6, v69
v_mfma_f32_16x16x32_bf16 v[32:35], v[128:131], a[240:243], v[32:35]
v_cvt_pk_bf16_f32 v24, v24, v25
v_cvt_pk_bf16_f32 v25, v26, v27
v_mfma_f32_16x16x32_bf16 v[32:35], v[144:147], a[244:247], v[32:35]
ds_write_b64 v118, v[24:25] offset:0
v_mfma_f32_16x16x32_bf16 v[32:35], v[160:163], a[248:251], v[32:35]
v_mfma_f32_16x16x32_bf16 v[32:35], v[176:179], a[252:255], v[32:35]
v_fma_f32 v28, v28, v6, v54
v_fma_f32 v29, v29, v6, v70
v_mfma_f32_16x16x32_bf16 v[32:35], v[124:127], v[104:107], v[32:35]
v_fma_f32 v30, v30, v6, v55
v_fma_f32 v31, v31, v6, v71
v_mfma_f32_16x16x32_bf16 v[36:39], v[180:183], a[252:255], v[36:39]
v_cvt_pk_bf16_f32 v28, v28, v29
v_cvt_pk_bf16_f32 v29, v30, v31
v_mfma_f32_16x16x32_bf16 v[36:39], v[164:167], a[248:251], v[36:39]
s_nop 0
ds_write_b64 v119, v[28:29] offset:0
ds_read_b128 v[192:195], v4 offset:0
v_mfma_f32_16x16x32_bf16 v[36:39], v[148:151], a[244:247], v[36:39]
ds_read_b128 v[196:199], v4 offset:1024
v_mfma_f32_16x16x32_bf16 v[36:39], v[132:135], a[240:243], v[36:39]
v_fma_f32 v32, v32, v7, v56
v_fma_f32 v33, v33, v7, v72
v_mfma_f32_16x16x32_bf16 v[36:39], v[120:123], v[104:107], v[36:39]
v_fma_f32 v34, v34, v7, v57
v_fma_f32 v35, v35, v7, v73
v_mfma_f32_16x16x32_bf16 v[40:43], v[136:139], a[240:243], v[40:43]
v_cvt_pk_bf16_f32 v32, v32, v33
v_cvt_pk_bf16_f32 v33, v34, v35
v_mfma_f32_16x16x32_bf16 v[40:43], v[152:155], a[244:247], v[40:43]
ds_write_b64 v116, v[32:33] offset:2048
v_mfma_f32_16x16x32_bf16 v[40:43], v[168:171], a[248:251], v[40:43]
s_waitcnt lgkmcnt(2)
buffer_store_dwordx4 v[192:195], v15, s[40:43], s70 offen sc1
v_mfma_f32_16x16x32_bf16 v[40:43], v[184:187], a[252:255], v[40:43]
s_add_u32 s70, s70, 0x4000
v_mfma_f32_16x16x32_bf16 v[40:43], v[124:127], v[108:111], v[40:43]
v_fma_f32 v36, v36, v7, v58
v_fma_f32 v37, v37, v7, v74
v_mfma_f32_16x16x32_bf16 v[44:47], v[188:191], a[252:255], v[44:47]
v_fma_f32 v38, v38, v7, v59
v_fma_f32 v39, v39, v7, v75
v_mfma_f32_16x16x32_bf16 v[44:47], v[172:175], a[248:251], v[44:47]
v_cvt_pk_bf16_f32 v36, v36, v37
v_cvt_pk_bf16_f32 v37, v38, v39
v_mfma_f32_16x16x32_bf16 v[44:47], v[156:159], a[244:247], v[44:47]
ds_write_b64 v117, v[36:37] offset:2048
v_mfma_f32_16x16x32_bf16 v[44:47], v[140:143], a[240:243], v[44:47]
v_fma_f32 v40, v40, v7, v60
v_fma_f32 v41, v41, v7, v76
v_mfma_f32_16x16x32_bf16 v[44:47], v[120:123], v[108:111], v[44:47]
v_fma_f32 v42, v42, v7, v61
v_fma_f32 v43, v43, v7, v77
v_cvt_pk_bf16_f32 v40, v40, v41
v_cvt_pk_bf16_f32 v41, v42, v43
ds_write_b64 v118, v[40:41] offset:2048
s_waitcnt lgkmcnt(3)
buffer_store_dwordx4 v[196:199], v15, s[40:43], s70 offen sc1
s_add_u32 s70, s70, 0x4000
v_fma_f32 v44, v44, v7, v62
v_fma_f32 v45, v45, v7, v78
v_fma_f32 v46, v46, v7, v63
v_fma_f32 v47, v47, v7, v79
v_cvt_pk_bf16_f32 v44, v44, v45
v_cvt_pk_bf16_f32 v45, v46, v47
ds_write_b64 v119, v[44:45] offset:2048
ds_read_b128 v[200:203], v4 offset:2048
ds_read_b128 v[204:207], v4 offset:3072
s_waitcnt lgkmcnt(1)
buffer_store_dwordx4 v[200:203], v15, s[40:43], s70 offen sc1
s_add_u32 s70, s70, 0x4000
s_waitcnt lgkmcnt(0)
buffer_store_dwordx4 v[204:207], v15, s[40:43], s70 offen sc1
s_add_u32 s70, s70, 0x4000
Lend:
s_endpgm
Lspin1:
s_mov_b32 s83, 262144
Lsl3:
s_sleep 2
buffer_load_dword v3, v2, s[48:51], 0 offen sc1
s_sub_u32 s83, s83, 1
s_cmp_eq_u32 s83, 0
s_waitcnt vmcnt(0)
s_cbranch_scc1 Lback2
v_cmp_gt_u32 vcc, 8, v3
s_cbranch_vccnz Lsl3
s_branch Lback2
Lspin4:
s_mov_b32 s83, 262144
Lsl6:
s_sleep 2
buffer_load_dword v3, v2, s[44:47], s75 offen sc1
s_sub_u32 s83, s83, 1
s_cmp_eq_u32 s83, 0
s_waitcnt vmcnt(0)
s_cbranch_scc1 Lback5
v_cmp_gt_u32 vcc, 1, v3
s_cbranch_vccnz Lsl6
s_branch Lback5
.p2align 12
s_endpgm
.p2align 7
LP0x:
Lstub10:
s_cbranch_execz Lret
s_cmp_eq_u32 s58, 2
s_cbranch_scc1 Lta10
s_cmp_eq_u32 s58, 3
s_cbranch_scc1 Lnt11
v_mfma_f32_16x16x32_bf16 v[160:163], a[160:163], v[16:19], v[112:115]
s_xor_b32 s74, s82, 0x10000
v_exp_f32 v128, v128
v_mfma_f32_16x16x32_bf16 v[176:179], a[176:179], v[16:19], v[112:115]
s_add_u32 s74, s74, s64
ds_read_b128 a[128:131], v2 offset:16384
ds_read_b128 a[132:135], v2 offset:17408
s_branch Ljoin12
Lta10:
v_mfma_f32_16x16x32_bf16 v[160:163], a[160:163], v[16:19], v[96:99]
s_xor_b32 s74, s82, 0x10000
v_exp_f32 v128, v128
v_mfma_f32_16x16x32_bf16 v[176:179], a[176:179], v[16:19], v[112:115]
s_add_u32 s74, s74, s64
ds_read_b128 a[128:131], v2 offset:16384
ds_read_b128 a[132:135], v2 offset:17408
s_branch Ljoin12
Lnt11:
v_mfma_f32_16x16x32_bf16 v[160:163], a[160:163], v[16:19], v[80:83]
s_xor_b32 s74, s82, 0x10000
v_exp_f32 v128, v128
v_mfma_f32_16x16x32_bf16 v[176:179], a[176:179], v[16:19], v[96:99]
s_add_u32 s74, s74, s64
ds_read_b128 a[128:131], v2 offset:16384
ds_read_b128 a[132:135], v2 offset:17408
Ljoin12:
v_mfma_f32_16x16x32_bf16 v[160:163], a[164:167], v[20:23], v[160:163]
s_add_u32 s81, s81, 0x8000
v_exp_f32 v129, v129
v_mfma_f32_16x16x32_bf16 v[160:163], a[168:171], v[24:27], v[160:163]
s_add_u32 m0, s74, 16384
v_exp_f32 v130, v130
v_mfma_f32_16x16x32_bf16 v[160:163], a[172:175], v[28:31], v[160:163]
s_add_u32 s72, s81, 16384
v_exp_f32 v131, v131
v_mfma_f32_16x16x32_bf16 v[164:167], a[172:175], v[44:47], v[84:87]
v_exp_f32 v144, v144
v_mfma_f32_16x16x32_bf16 v[164:167], a[168:171], v[40:43], v[164:167]
ds_read_b128 a[136:139], v2 offset:18432
ds_read_b128 a[140:143], v2 offset:19456
v_mfma_f32_16x16x32_bf16 v[164:167], a[164:167], v[36:39], v[164:167]
ds_read_b128 a[144:147], v2 offset:20480
ds_read_b128 a[148:151], v2 offset:21504
v_mfma_f32_16x16x32_bf16 v[164:167], a[160:163], v[32:35], v[164:167]
ds_read_b128 a[152:155], v2 offset:22528
ds_read_b128 a[156:159], v2 offset:23552
v_mfma_f32_16x16x32_bf16 v[168:171], a[160:163], v[48:51], v[88:91]
ds_read_b128 a[192:195], v2 offset:0
ds_read_b128 a[196:199], v2 offset:1024
v_mfma_f32_16x16x32_bf16 v[168:171], a[164:167], v[52:55], v[168:171]
ds_read_b128 a[200:203], v2 offset:2048
ds_read_b128 a[204:207], v2 offset:3072
v_mfma_f32_16x16x32_bf16 v[168:171], a[168:171], v[56:59], v[168:171]
ds_read_b128 a[208:211], v2 offset:4096
ds_read_b128 a[212:215], v2 offset:5120
v_mfma_f32_16x16x32_bf16 v[168:171], a[172:175], v[60:63], v[168:171]
ds_read_b128 a[216:219], v2 offset:6144
ds_read_b128 a[220:223], v2 offset:7168
v_mfma_f32_16x16x32_bf16 v[172:175], a[172:175], v[76:79], v[92:95]
v_cvt_pk_bf16_f32 v192, v128, v129
v_cvt_pk_bf16_f32 v193, v130, v131
v_mfma_f32_16x16x32_bf16 v[172:175], a[168:171], v[72:75], v[172:175]
buffer_load_dwordx4 v1, s[44:47], s72 offen sc1 lds
v_mfma_f32_16x16x32_bf16 v[172:175], a[164:167], v[68:71], v[172:175]
v_exp_f32 v145, v145
v_mfma_f32_16x16x32_bf16 v[172:175], a[160:163], v[64:67], v[172:175]
v_exp_f32 v146, v146
v_mfma_f32_16x16x32_bf16 v[188:191], a[176:179], v[64:67], v[92:95]
v_exp_f32 v147, v147
v_mfma_f32_16x16x32_bf16 v[188:191], a[180:183], v[68:71], v[188:191]
v_exp_f32 v132, v132
v_mfma_f32_16x16x32_bf16 v[188:191], a[184:187], v[72:75], v[188:191]
v_cvt_pk_bf16_f32 v194, v144, v145
v_cvt_pk_bf16_f32 v195, v146, v147
v_mfma_f32_16x16x32_bf16 v[188:191], a[188:191], v[76:79], v[188:191]
v_exp_f32 v133, v133
v_mfma_f32_16x16x32_bf16 v[184:187], a[188:191], v[60:63], v[88:91]
v_exp_f32 v134, v134
v_mfma_f32_16x16x32_bf16 v[184:187], a[184:187], v[56:59], v[184:187]
v_exp_f32 v135, v135
v_mfma_f32_16x16x32_bf16 v[184:187], a[180:183], v[52:55], v[184:187]
v_exp_f32 v148, v148
v_mfma_f32_16x16x32_bf16 v[184:187], a[176:179], v[48:51], v[184:187]
v_cvt_pk_bf16_f32 v196, v132, v133
v_cvt_pk_bf16_f32 v197, v134, v135
v_mfma_f32_16x16x32_bf16 v[180:183], a[176:179], v[32:35], v[84:87]
buffer_load_dwordx4 v1, s[44:47], s72 offen offset:1024 sc1 lds
v_mfma_f32_16x16x32_bf16 v[180:183], a[180:183], v[36:39], v[180:183]
v_exp_f32 v149, v149
v_mfma_f32_16x16x32_bf16 v[180:183], a[184:187], v[40:43], v[180:183]
v_exp_f32 v150, v150
v_mfma_f32_16x16x32_bf16 v[180:183], a[188:191], v[44:47], v[180:183]
v_exp_f32 v151, v151
v_mfma_f32_16x16x32_bf16 v[176:179], a[188:191], v[28:31], v[176:179]
buffer_load_dwordx4 v1, s[44:47], s72 offen offset:2048 sc1 lds
v_mfma_f32_16x16x32_bf16 v[176:179], a[184:187], v[24:27], v[176:179]
buffer_load_dwordx4 v1, s[44:47], s72 offen offset:3072 sc1 lds
v_mfma_f32_16x16x32_bf16 v[176:179], a[180:183], v[20:23], v[176:179]
s_waitcnt lgkmcnt(8)
v_exp_f32 v136, v136
v_cvt_pk_bf16_f32 v198, v148, v149
v_cvt_pk_bf16_f32 v199, v150, v151
v_exp_f32 v137, v137
v_exp_f32 v138, v138
v_cvt_pk_bf16_f32 v200, v136, v137
v_exp_f32 v139, v139
v_exp_f32 v152, v152
v_cvt_pk_bf16_f32 v201, v138, v139
v_exp_f32 v153, v153
v_exp_f32 v154, v154
v_cvt_pk_bf16_f32 v202, v152, v153
v_exp_f32 v155, v155
v_exp_f32 v140, v140
v_cvt_pk_bf16_f32 v203, v154, v155
v_exp_f32 v141, v141
v_exp_f32 v142, v142
v_cvt_pk_bf16_f32 v204, v140, v141
v_exp_f32 v143, v143
v_exp_f32 v156, v156
v_cvt_pk_bf16_f32 v205, v142, v143
v_exp_f32 v157, v157
v_exp_f32 v158, v158
v_cvt_pk_bf16_f32 v206, v156, v157
v_exp_f32 v159, v159
s_nop 0
v_cvt_pk_bf16_f32 v207, v158, v159
s_cmp_eq_u32 s58, 0
s_cbranch_scc1 Lta13
s_cmp_eq_u32 s58, 1
s_cbranch_scc1 Lnt14
v_mfma_f32_16x16x32_bf16 v[132:135], a[128:131], v[32:35], v[84:87]
s_add_u32 s82, s82, 0x8000
ds_read_b128 a[160:163], v2 offset:24576
v_mfma_f32_16x16x32_bf16 v[148:151], a[144:147], v[32:35], v[84:87]
s_and_b32 s82, s82, 0x1ffff
v_exp_f32 v160, v160
s_branch Ljoin15
Lta13:
v_mfma_f32_16x16x32_bf16 v[132:135], a[128:131], v[32:35], v[100:103]
s_add_u32 s82, s82, 0x8000
ds_read_b128 a[160:163], v2 offset:24576
v_mfma_f32_16x16x32_bf16 v[148:151], a[144:147], v[32:35], v[112:115]
s_and_b32 s82, s82, 0x1ffff
v_exp_f32 v160, v160
s_branch Ljoin15
Lnt14:
v_mfma_f32_16x16x32_bf16 v[132:135], a[128:131], v[32:35], v[84:87]
s_add_u32 s82, s82, 0x8000
ds_read_b128 a[160:163], v2 offset:24576
v_mfma_f32_16x16x32_bf16 v[148:151], a[144:147], v[32:35], v[100:103]
s_and_b32 s82, s82, 0x1ffff
v_exp_f32 v160, v160
Ljoin15:
v_mfma_f32_16x16x32_bf16 v[132:135], a[132:135], v[36:39], v[132:135]
s_add_u32 m0, s74, 0
v_exp_f32 v161, v161
v_mfma_f32_16x16x32_bf16 v[132:135], a[136:139], v[40:43], v[132:135]
s_add_u32 s72, s81, 0
ds_read_b128 a[164:167], v2 offset:25600
v_cvt_pk_bf16_f32 v208, v160, v161
v_mfma_f32_16x16x32_bf16 v[132:135], a[140:143], v[44:47], v[132:135]
v_exp_f32 v162, v162
v_mfma_f32_16x16x32_bf16 v[136:139], a[140:143], v[60:63], v[88:91]
buffer_load_dwordx4 v1, s[44:47], s72 offen sc1 lds
v_mfma_f32_16x16x32_bf16 v[136:139], a[136:139], v[56:59], v[136:139]
v_exp_f32 v163, v163
v_mfma_f32_16x16x32_bf16 v[136:139], a[132:135], v[52:55], v[136:139]
ds_read_b128 a[168:171], v2 offset:26624
v_cvt_pk_bf16_f32 v209, v162, v163
v_mfma_f32_16x16x32_bf16 v[136:139], a[128:131], v[48:51], v[136:139]
v_exp_f32 v176, v176
v_mfma_f32_16x16x32_bf16 v[140:143], a[128:131], v[64:67], v[92:95]
v_exp_f32 v177, v177
v_mfma_f32_16x16x32_bf16 v[140:143], a[132:135], v[68:71], v[140:143]
ds_read_b128 a[172:175], v2 offset:27648
v_cvt_pk_bf16_f32 v210, v176, v177
v_mfma_f32_16x16x32_bf16 v[140:143], a[136:139], v[72:75], v[140:143]
v_exp_f32 v178, v178
v_mfma_f32_16x16x32_bf16 v[140:143], a[140:143], v[76:79], v[140:143]
buffer_load_dwordx4 v1, s[44:47], s72 offen offset:1024 sc1 lds
v_mfma_f32_16x16x32_bf16 v[156:159], a[156:159], v[76:79], v[92:95]
v_exp_f32 v179, v179
v_mfma_f32_16x16x32_bf16 v[156:159], a[152:155], v[72:75], v[156:159]
ds_read_b128 a[176:179], v2 offset:28672
v_cvt_pk_bf16_f32 v211, v178, v179
v_mfma_f32_16x16x32_bf16 v[156:159], a[148:151], v[68:71], v[156:159]
v_exp_f32 v164, v164
v_mfma_f32_16x16x32_bf16 v[156:159], a[144:147], v[64:67], v[156:159]
v_exp_f32 v165, v165
v_mfma_f32_16x16x32_bf16 v[152:155], a[144:147], v[48:51], v[88:91]
ds_read_b128 a[180:183], v2 offset:29696
v_cvt_pk_bf16_f32 v212, v164, v165
v_mfma_f32_16x16x32_bf16 v[152:155], a[148:151], v[52:55], v[152:155]
v_exp_f32 v166, v166
v_mfma_f32_16x16x32_bf16 v[152:155], a[152:155], v[56:59], v[152:155]
buffer_load_dwordx4 v1, s[44:47], s72 offen offset:2048 sc1 lds
v_mfma_f32_16x16x32_bf16 v[152:155], a[156:159], v[60:63], v[152:155]
v_exp_f32 v167, v167
v_mfma_f32_16x16x32_bf16 v[148:151], a[156:159], v[44:47], v[148:151]
ds_read_b128 a[184:187], v2 offset:30720
v_cvt_pk_bf16_f32 v213, v166, v167
v_mfma_f32_16x16x32_bf16 v[148:151], a[152:155], v[40:43], v[148:151]
v_exp_f32 v180, v180
v_mfma_f32_16x16x32_bf16 v[148:151], a[148:151], v[36:39], v[148:151]
s_waitcnt lgkmcnt(7)
v_exp_f32 v181, v181
v_mfma_f32_16x16x32_bf16 a[0:3], a[192:195], v[192:195], 0
ds_read_b128 a[188:191], v2 offset:31744
v_cvt_pk_bf16_f32 v214, v180, v181
v_mfma_f32_16x16x32_bf16 a[32:35], a[192:195], v[196:199], 0
v_exp_f32 v182, v182
v_mfma_f32_16x16x32_bf16 a[64:67], a[192:195], v[200:203], 0
buffer_load_dwordx4 v1, s[44:47], s72 offen offset:3072 sc1 lds
v_mfma_f32_16x16x32_bf16 a[96:99], a[192:195], v[204:207], 0
s_add_u32 s66, s58, 1
v_exp_f32 v183, v183
v_mfma_f32_16x16x32_bf16 a[100:103], a[196:199], v[204:207], 0
s_and_b32 s66, s66, 3
ds_read_b128 a[224:227], v2 offset:8192
v_cvt_pk_bf16_f32 v215, v182, v183
v_mfma_f32_16x16x32_bf16 a[68:71], a[196:199], v[200:203], 0
s_mul_i32 s66, s66, 4160
v_exp_f32 v168, v168
v_mfma_f32_16x16x32_bf16 a[36:39], a[196:199], v[196:199], 0
s_add_u32 m0, s66, 131104
v_exp_f32 v169, v169
v_mfma_f32_16x16x32_bf16 a[4:7], a[196:199], v[192:195], 0
s_add_u32 s72, s93, 0x2
ds_read_b128 a[228:231], v2 offset:9216
v_cvt_pk_bf16_f32 v216, v168, v169
v_mfma_f32_16x16x32_bf16 a[8:11], a[200:203], v[192:195], 0
v_exp_f32 v170, v170
v_mfma_f32_16x16x32_bf16 a[40:43], a[200:203], v[196:199], 0
buffer_load_dwordx4 v1, s[36:39], s72 offen lds
v_mfma_f32_16x16x32_bf16 a[72:75], a[200:203], v[200:203], 0
v_exp_f32 v171, v171
v_mfma_f32_16x16x32_bf16 a[104:107], a[200:203], v[204:207], 0
ds_read_b128 a[232:235], v2 offset:10240
v_cvt_pk_bf16_f32 v217, v170, v171
v_mfma_f32_16x16x32_bf16 a[108:111], a[204:207], v[204:207], 0
v_exp_f32 v184, v184
v_mfma_f32_16x16x32_bf16 a[76:79], a[204:207], v[200:203], 0
v_exp_f32 v185, v185
v_mfma_f32_16x16x32_bf16 a[44:47], a[204:207], v[196:199], 0
ds_read_b128 a[236:239], v2 offset:11264
v_cvt_pk_bf16_f32 v218, v184, v185
v_mfma_f32_16x16x32_bf16 a[12:15], a[204:207], v[192:195], 0
v_exp_f32 v186, v186
v_mfma_f32_16x16x32_bf16 a[16:19], a[208:211], v[192:195], 0
buffer_load_dwordx4 v1, s[36:39], s72 offen offset:1024 lds
v_mfma_f32_16x16x32_bf16 a[48:51], a[208:211], v[196:199], 0
v_exp_f32 v187, v187
v_mfma_f32_16x16x32_bf16 a[80:83], a[208:211], v[200:203], 0
ds_read_b128 a[240:243], v2 offset:12288
v_cvt_pk_bf16_f32 v219, v186, v187
v_mfma_f32_16x16x32_bf16 a[112:115], a[208:211], v[204:207], 0
v_exp_f32 v172, v172
v_mfma_f32_16x16x32_bf16 a[116:119], a[212:215], v[204:207], 0
v_exp_f32 v173, v173
v_mfma_f32_16x16x32_bf16 a[84:87], a[212:215], v[200:203], 0
ds_read_b128 a[244:247], v2 offset:13312
v_cvt_pk_bf16_f32 v220, v172, v173
v_mfma_f32_16x16x32_bf16 a[52:55], a[212:215], v[196:199], 0
buffer_load_dwordx4 v1, s[36:39], s72 offen offset:2048 lds
v_mfma_f32_16x16x32_bf16 a[20:23], a[212:215], v[192:195], 0
v_exp_f32 v174, v174
v_mfma_f32_16x16x32_bf16 a[24:27], a[216:219], v[192:195], 0
v_exp_f32 v175, v175
v_mfma_f32_16x16x32_bf16 a[56:59], a[216:219], v[196:199], 0
ds_read_b128 a[248:251], v2 offset:14336
v_cvt_pk_bf16_f32 v221, v174, v175
v_mfma_f32_16x16x32_bf16 a[88:91], a[216:219], v[200:203], 0
v_exp_f32 v188, v188
v_mfma_f32_16x16x32_bf16 a[120:123], a[216:219], v[204:207], 0
v_exp_f32 v189, v189
v_mfma_f32_16x16x32_bf16 a[124:127], a[220:223], v[204:207], 0
ds_read_b128 a[252:255], v2 offset:15360
v_cvt_pk_bf16_f32 v222, v188, v189
v_mfma_f32_16x16x32_bf16 a[92:95], a[220:223], v[200:203], 0
buffer_load_dwordx4 v1, s[36:39], s72 offen offset:3072 lds
v_mfma_f32_16x16x32_bf16 a[60:63], a[220:223], v[196:199], 0
v_exp_f32 v190, v190
v_mfma_f32_16x16x32_bf16 a[28:31], a[220:223], v[192:195], 0
v_exp_f32 v191, v191
v_mfma_f32_16x16x32_bf16 v[224:227], v[120:123], v[192:195], 0
v_cvt_pk_bf16_f32 v223, v190, v191
v_add_u32 v2, s82, v1
v_mfma_f32_16x16x32_bf16 v[228:231], v[120:123], v[196:199], 0
v_and_b32 v240, 15, v0
v_lshrrev_b32 v241, 4, v0
v_mfma_f32_16x16x32_bf16 v[232:235], v[120:123], v[200:203], 0
s_waitcnt vmcnt(12) lgkmcnt(8)
v_mfma_f32_16x16x32_bf16 v[236:239], v[120:123], v[204:207], 0
s_barrier
v_add_u32 v248, 1, v240
v_and_b32 v249, 3, v248
v_lshrrev_b32 v248, 2, v248
v_mov_b32 v250, 0x20000
v_mov_b32 v252, 0x20001
v_lshlrev_b32 v6, 3, v249
v_lshrrev_b32 v6, v6, v252
v_and_b32 v6, 3, v6
v_cmp_ne_u32 vcc, 1, v249
v_mul_u32_u24 v6, 16640, v6
v_add_u32 v6, s92, v6
v_cndmask_b32 v6, v250, v6, vcc
v_add_u32 v253, s58, v249
v_and_b32 v253, 3, v253
v_mul_u32_u24 v253, 4160, v253
v_add_u32 v6, v6, v253
s_branch LLT3
.p2align 12
s_endpgm
.p2align 7
LLT3x:
Lstub11:
s_cbranch_execz Lret
s_cmp_eq_u32 s58, 2
s_cbranch_scc1 Lta40
s_cmp_eq_u32 s58, 3
s_cbranch_scc1 Lnt41
v_mfma_f32_16x16x32_bf16 v[164:167], a[160:163], v[32:35], v[112:115]
s_xor_b32 s74, s82, 0x10000
ds_read_b128 a[128:131], v2 offset:16384
v_mfma_f32_16x16x32_bf16 v[180:183], a[176:179], v[32:35], v[112:115]
s_add_u32 s74, s74, s64
v_exp_f32 v132, v132
s_branch Ljoin42
Lta40:
v_mfma_f32_16x16x32_bf16 v[164:167], a[160:163], v[32:35], v[100:103]
s_xor_b32 s74, s82, 0x10000
ds_read_b128 a[128:131], v2 offset:16384
v_mfma_f32_16x16x32_bf16 v[180:183], a[176:179], v[32:35], v[112:115]
s_add_u32 s74, s74, s64
v_exp_f32 v132, v132
s_branch Ljoin42
Lnt41:
v_mfma_f32_16x16x32_bf16 v[164:167], a[160:163], v[32:35], v[84:87]
s_xor_b32 s74, s82, 0x10000
ds_read_b128 a[128:131], v2 offset:16384
v_mfma_f32_16x16x32_bf16 v[180:183], a[176:179], v[32:35], v[100:103]
s_add_u32 s74, s74, s64
v_exp_f32 v132, v132
Ljoin42:
v_mfma_f32_16x16x32_bf16 v[164:167], a[164:167], v[36:39], v[164:167]
s_add_u32 s81, s81, 0x8000
v_exp_f32 v133, v133
v_mfma_f32_16x16x32_bf16 v[164:167], a[168:171], v[40:43], v[164:167]
s_add_u32 m0, s74, 0
ds_read_b128 a[132:135], v2 offset:17408
v_cvt_pk_bf16_f32 v196, v132, v133
v_mfma_f32_16x16x32_bf16 v[164:167], a[172:175], v[44:47], v[164:167]
s_add_u32 s72, s81, 0
buffer_load_dwordx4 v1, s[44:47], s72 offen sc1 lds
v_mfma_f32_16x16x32_bf16 v[168:171], a[172:175], v[60:63], v[88:91]
s_add_u32 s69, s93, 0x3e00000
v_exp_f32 v134, v134
v_mfma_f32_16x16x32_bf16 v[168:171], a[168:171], v[56:59], v[168:171]
ds_read_b128 a[136:139], v2 offset:18432
v_bfe_u32 v251, v0, 2, 2
v_mfma_f32_16x16x32_bf16 v[168:171], a[164:167], v[52:55], v[168:171]
v_exp_f32 v135, v135
v_mfma_f32_16x16x32_bf16 v[168:171], a[160:163], v[48:51], v[168:171]
buffer_store_dwordx4 v[112:115], v1, s[44:47], s69 offen sc1
v_mfma_f32_16x16x32_bf16 v[172:175], a[160:163], v[64:67], v[92:95]
v_exp_f32 v148, v148
v_mfma_f32_16x16x32_bf16 v[172:175], a[164:167], v[68:71], v[172:175]
ds_read_b128 a[140:143], v2 offset:19456
v_cvt_pk_bf16_f32 v197, v134, v135
v_mfma_f32_16x16x32_bf16 v[172:175], a[168:171], v[72:75], v[172:175]
v_exp_f32 v149, v149
v_mfma_f32_16x16x32_bf16 v[172:175], a[172:175], v[76:79], v[172:175]
buffer_load_dwordx4 v1, s[44:47], s72 offen offset:1024 sc1 lds
v_mfma_f32_16x16x32_bf16 v[188:191], a[188:191], v[76:79], v[92:95]
ds_read_b128 a[144:147], v2 offset:20480
v_cvt_pk_bf16_f32 v198, v148, v149
v_mfma_f32_16x16x32_bf16 v[188:191], a[184:187], v[72:75], v[188:191]
v_exp_f32 v150, v150
v_mfma_f32_16x16x32_bf16 v[188:191], a[180:183], v[68:71], v[188:191]
v_exp_f32 v151, v151
v_mfma_f32_16x16x32_bf16 v[188:191], a[176:179], v[64:67], v[188:191]
buffer_store_dwordx4 v[112:115], v1, s[44:47], s69 offen offset:1024 sc1
v_mfma_f32_16x16x32_bf16 v[184:187], a[176:179], v[48:51], v[88:91]
ds_read_b128 a[148:151], v2 offset:21504
v_cvt_pk_bf16_f32 v199, v150, v151
v_mfma_f32_16x16x32_bf16 v[184:187], a[180:183], v[52:55], v[184:187]
v_exp_f32 v136, v136
v_mfma_f32_16x16x32_bf16 v[184:187], a[184:187], v[56:59], v[184:187]
ds_read_b128 a[152:155], v2 offset:22528
v_lshl_add_u32 v6, v248, 3, v6
v_mfma_f32_16x16x32_bf16 v[184:187], a[188:191], v[60:63], v[184:187]
v_exp_f32 v137, v137
v_mfma_f32_16x16x32_bf16 v[180:183], a[188:191], v[44:47], v[180:183]
buffer_load_dwordx4 v1, s[44:47], s72 offen offset:2048 sc1 lds
v_mfma_f32_16x16x32_bf16 v[180:183], a[184:187], v[40:43], v[180:183]
v_exp_f32 v138, v138
v_mfma_f32_16x16x32_bf16 v[180:183], a[180:183], v[36:39], v[180:183]
s_waitcnt lgkmcnt(7)
ds_read_b128 a[156:159], v2 offset:23552
v_cvt_pk_bf16_f32 v200, v136, v137
v_mfma_f32_16x16x32_bf16 a[0:3], a[224:227], v[208:211], a[0:3]
v_exp_f32 v139, v139
v_mfma_f32_16x16x32_bf16 a[32:35], a[224:227], v[212:215], a[32:35]
buffer_store_dwordx4 v[112:115], v1, s[44:47], s69 offen offset:2048 sc1
v_mfma_f32_16x16x32_bf16 a[64:67], a[224:227], v[216:219], a[64:67]
ds_read_b128 a[192:195], v2 offset:0
v_cvt_pk_bf16_f32 v201, v138, v139
v_mfma_f32_16x16x32_bf16 a[96:99], a[224:227], v[220:223], a[96:99]
v_exp_f32 v152, v152
v_mfma_f32_16x16x32_bf16 a[100:103], a[228:231], v[220:223], a[100:103]
buffer_load_dwordx4 v1, s[44:47], s72 offen offset:3072 sc1 lds
v_mfma_f32_16x16x32_bf16 a[68:71], a[228:231], v[216:219], a[68:71]
v_exp_f32 v153, v153
v_mfma_f32_16x16x32_bf16 a[36:39], a[228:231], v[212:215], a[36:39]
ds_read_b128 a[196:199], v2 offset:1024
v_cvt_pk_bf16_f32 v202, v152, v153
v_mfma_f32_16x16x32_bf16 a[4:7], a[228:231], v[208:211], a[4:7]
v_exp_f32 v154, v154
v_mfma_f32_16x16x32_bf16 a[8:11], a[232:235], v[208:211], a[8:11]
ds_read_b128 a[200:203], v2 offset:2048
v_lshl_add_u32 v6, v241, 4, v6
v_mfma_f32_16x16x32_bf16 a[40:43], a[232:235], v[212:215], a[40:43]
buffer_store_dwordx4 v[112:115], v1, s[44:47], s69 offen offset:3072 sc1
v_mfma_f32_16x16x32_bf16 a[72:75], a[232:235], v[216:219], a[72:75]
s_add_u32 s69, s93, 0x4200000
v_exp_f32 v155, v155
v_mfma_f32_16x16x32_bf16 a[104:107], a[232:235], v[220:223], a[104:107]
v_exp_f32 v140, v140
v_mfma_f32_16x16x32_bf16 a[108:111], a[236:239], v[220:223], a[108:111]
ds_read_b128 a[204:207], v2 offset:3072
v_cvt_pk_bf16_f32 v203, v154, v155
v_mfma_f32_16x16x32_bf16 a[76:79], a[236:239], v[216:219], a[76:79]
buffer_store_dwordx4 v[112:115], v1, s[44:47], s69 offen sc1
v_mfma_f32_16x16x32_bf16 a[44:47], a[236:239], v[212:215], a[44:47]
v_exp_f32 v141, v141
v_mfma_f32_16x16x32_bf16 a[12:15], a[236:239], v[208:211], a[12:15]
ds_read_b128 a[208:211], v2 offset:4096
v_cvt_pk_bf16_f32 v204, v140, v141
v_mfma_f32_16x16x32_bf16 a[16:19], a[240:243], v[208:211], a[16:19]
v_exp_f32 v142, v142
v_mfma_f32_16x16x32_bf16 a[48:51], a[240:243], v[212:215], a[48:51]
buffer_store_dwordx4 v[112:115], v1, s[44:47], s69 offen offset:1024 sc1
v_mfma_f32_16x16x32_bf16 a[80:83], a[240:243], v[216:219], a[80:83]
v_exp_f32 v143, v143
v_mfma_f32_16x16x32_bf16 a[112:115], a[240:243], v[220:223], a[112:115]
ds_read_b128 a[212:215], v2 offset:5120
v_cvt_pk_bf16_f32 v205, v142, v143
v_mfma_f32_16x16x32_bf16 a[116:119], a[244:247], v[220:223], a[116:119]
v_exp_f32 v156, v156
v_mfma_f32_16x16x32_bf16 a[84:87], a[244:247], v[216:219], a[84:87]
ds_read_b128 a[216:219], v2 offset:6144
v_lshlrev_b32 v5, 3, v251
v_mfma_f32_16x16x32_bf16 a[52:55], a[244:247], v[212:215], a[52:55]
buffer_store_dwordx4 v[112:115], v1, s[44:47], s69 offen offset:2048 sc1
v_mfma_f32_16x16x32_bf16 a[20:23], a[244:247], v[208:211], a[20:23]
v_exp_f32 v157, v157
v_mfma_f32_16x16x32_bf16 a[24:27], a[248:251], v[208:211], a[24:27]
v_exp_f32 v158, v158
v_mfma_f32_16x16x32_bf16 a[56:59], a[248:251], v[212:215], a[56:59]
ds_read_b128 a[220:223], v2 offset:7168
v_cvt_pk_bf16_f32 v206, v156, v157
v_mfma_f32_16x16x32_bf16 a[88:91], a[248:251], v[216:219], a[88:91]
buffer_store_dwordx4 v[112:115], v1, s[44:47], s69 offen offset:3072 sc1
v_mfma_f32_16x16x32_bf16 a[120:123], a[248:251], v[220:223], a[120:123]
v_exp_f32 v159, v159
v_mfma_f32_16x16x32_bf16 a[124:127], a[252:255], v[220:223], a[124:127]
v_cvt_pk_bf16_f32 v207, v158, v159
v_lshrrev_b32 v5, v5, v252
v_mfma_f32_16x16x32_bf16 a[92:95], a[252:255], v[216:219], a[92:95]
v_and_b32 v5, 3, v5
v_cmp_ne_u32 vcc, 1, v251
v_mfma_f32_16x16x32_bf16 a[60:63], a[252:255], v[212:215], a[60:63]
v_mul_u32_u24 v5, 16640, v5
v_add_u32 v5, s92, v5
v_mfma_f32_16x16x32_bf16 a[28:31], a[252:255], v[208:211], a[28:31]
v_cndmask_b32 v5, v250, v5, vcc
v_add_u32 v253, s58, v251
v_mfma_f32_16x16x32_bf16 v[224:227], v[120:123], v[208:211], v[224:227]
v_and_b32 v253, 3, v253
v_mul_u32_u24 v253, 4160, v253
v_mfma_f32_16x16x32_bf16 v[228:231], v[120:123], v[212:215], v[228:231]
v_add_u32 v5, v5, v253
v_mfma_f32_16x16x32_bf16 v[232:235], v[120:123], v[216:219], v[232:235]
s_waitcnt lgkmcnt(8)
v_mfma_f32_16x16x32_bf16 v[236:239], v[120:123], v[220:223], v[236:239]
s_barrier
s_lshr_b32 s69, s93, 4
s_and_b32 s69, s69, 0x7f00
s_add_u32 s69, s69, LHT4-Lpc0
v_lshrrev_b32 v3, 5, v0
v_lshlrev_b32 v3, 7, v3
v_add_u32 v3, s69, v3
v_min_u32 v3, Lcode_end-Lpc0, v3
global_load_dword v4, v3, s[98:99]
s_cmp_eq_u32 s58, 0
s_cbranch_scc1 Lta43
s_cmp_eq_u32 s58, 1
s_cbranch_scc1 Lnt44
v_mfma_f32_16x16x32_bf16 v[136:139], a[128:131], v[48:51], v[88:91]
s_add_u32 s82, s82, 0x8000
ds_read_b128 a[160:163], v2 offset:24576
ds_read_b128 a[164:167], v2 offset:25600
v_mfma_f32_16x16x32_bf16 v[152:155], a[144:147], v[48:51], v[88:91]
s_and_b32 s82, s82, 0x1ffff
v_exp_f32 v164, v164
s_branch Ljoin45
Lta43:
v_mfma_f32_16x16x32_bf16 v[136:139], a[128:131], v[48:51], v[104:107]
s_add_u32 s82, s82, 0x8000
ds_read_b128 a[160:163], v2 offset:24576
ds_read_b128 a[164:167], v2 offset:25600
v_mfma_f32_16x16x32_bf16 v[152:155], a[144:147], v[48:51], v[112:115]
s_and_b32 s82, s82, 0x1ffff
v_exp_f32 v164, v164
s_branch Ljoin45
Lnt44:
v_mfma_f32_16x16x32_bf16 v[136:139], a[128:131], v[48:51], v[88:91]
s_add_u32 s82, s82, 0x8000
ds_read_b128 a[160:163], v2 offset:24576
ds_read_b128 a[164:167], v2 offset:25600
v_mfma_f32_16x16x32_bf16 v[152:155], a[144:147], v[48:51], v[104:107]
s_and_b32 s82, s82, 0x1ffff
v_exp_f32 v164, v164
Ljoin45:
v_mfma_f32_16x16x32_bf16 v[136:139], a[132:135], v[52:55], v[136:139]
s_add_u32 s66, s58, 3
v_exp_f32 v165, v165
v_mfma_f32_16x16x32_bf16 v[136:139], a[136:139], v[56:59], v[136:139]
s_and_b32 s66, s66, 3
v_exp_f32 v166, v166
v_mfma_f32_16x16x32_bf16 v[136:139], a[140:143], v[60:63], v[136:139]
s_mul_i32 s66, s66, 4160
ds_read_b128 a[168:171], v2 offset:26624
v_cvt_pk_bf16_f32 v212, v164, v165
v_mfma_f32_16x16x32_bf16 v[140:143], a[140:143], v[76:79], v[92:95]
s_add_u32 s66, s66, s92
v_exp_f32 v167, v167
v_mfma_f32_16x16x32_bf16 v[140:143], a[136:139], v[72:75], v[140:143]
s_add_u32 m0, s66, 32
v_exp_f32 v180, v180
v_mfma_f32_16x16x32_bf16 v[140:143], a[132:135], v[68:71], v[140:143]
s_add_u32 s72, s93, 0x6
buffer_load_dwordx4 v1, s[36:39], s72 offen lds
v_mfma_f32_16x16x32_bf16 v[140:143], a[128:131], v[64:67], v[140:143]
ds_read_b128 a[172:175], v2 offset:27648
v_cvt_pk_bf16_f32 v213, v166, v167
v_mfma_f32_16x16x32_bf16 v[156:159], a[144:147], v[64:67], v[92:95]
v_exp_f32 v181, v181
v_mfma_f32_16x16x32_bf16 v[156:159], a[148:151], v[68:71], v[156:159]
ds_read_b128 a[176:179], v2 offset:28672
v_cvt_pk_bf16_f32 v214, v180, v181
v_mfma_f32_16x16x32_bf16 v[156:159], a[152:155], v[72:75], v[156:159]
v_exp_f32 v182, v182
v_mfma_f32_16x16x32_bf16 v[156:159], a[156:159], v[76:79], v[156:159]
v_exp_f32 v183, v183
v_mfma_f32_16x16x32_bf16 v[152:155], a[156:159], v[60:63], v[152:155]
ds_read_b128 a[180:183], v2 offset:29696
v_cvt_pk_bf16_f32 v215, v182, v183
v_mfma_f32_16x16x32_bf16 v[152:155], a[152:155], v[56:59], v[152:155]
v_exp_f32 v168, v168
v_mfma_f32_16x16x32_bf16 v[152:155], a[148:151], v[52:55], v[152:155]
s_waitcnt lgkmcnt(6)
ds_read_b128 a[184:187], v2 offset:30720
ds_read_b128 a[188:191], v2 offset:31744
v_mfma_f32_16x16x32_bf16 a[32:35], a[192:195], v[196:199], a[32:35]
v_exp_f32 v169, v169
v_mfma_f32_16x16x32_bf16 a[64:67], a[192:195], v[200:203], a[64:67]
buffer_load_dwordx4 v1, s[36:39], s72 offen offset:1024 lds
v_mfma_f32_16x16x32_bf16 a[96:99], a[192:195], v[204:207], a[96:99]
v_exp_f32 v170, v170
v_mfma_f32_16x16x32_bf16 a[100:103], a[196:199], v[204:207], a[100:103]
v_exp_f32 v171, v171
v_mfma_f32_16x16x32_bf16 a[68:71], a[196:199], v[200:203], a[68:71]
ds_read_b128 a[224:227], v2 offset:8192
v_cvt_pk_bf16_f32 v216, v168, v169
v_mfma_f32_16x16x32_bf16 a[36:39], a[196:199], v[196:199], a[36:39]
v_exp_f32 v184, v184
v_mfma_f32_16x16x32_bf16 a[40:43], a[200:203], v[196:199], a[40:43]
v_exp_f32 v185, v185
v_mfma_f32_16x16x32_bf16 a[72:75], a[200:203], v[200:203], a[72:75]
ds_read_b128 a[228:231], v2 offset:9216
v_cvt_pk_bf16_f32 v217, v170, v171
v_mfma_f32_16x16x32_bf16 a[104:107], a[200:203], v[204:207], a[104:107]
v_exp_f32 v186, v186
v_mfma_f32_16x16x32_bf16 a[108:111], a[204:207], v[204:207], a[108:111]
ds_read_b128 a[232:235], v2 offset:10240
v_cvt_pk_bf16_f32 v218, v184, v185
v_mfma_f32_16x16x32_bf16 a[76:79], a[204:207], v[200:203], a[76:79]
v_exp_f32 v187, v187
v_mfma_f32_16x16x32_bf16 a[44:47], a[204:207], v[196:199], a[44:47]
buffer_load_dwordx4 v1, s[36:39], s72 offen offset:2048 lds
v_mfma_f32_16x16x32_bf16 a[48:51], a[208:211], v[196:199], a[48:51]
v_exp_f32 v172, v172
v_mfma_f32_16x16x32_bf16 a[80:83], a[208:211], v[200:203], a[80:83]
ds_read_b128 a[236:239], v2 offset:11264
v_cvt_pk_bf16_f32 v219, v186, v187
v_mfma_f32_16x16x32_bf16 a[112:115], a[208:211], v[204:207], a[112:115]
v_exp_f32 v173, v173
v_mfma_f32_16x16x32_bf16 a[116:119], a[212:215], v[204:207], a[116:119]
ds_read_b128 a[240:243], v2 offset:12288
v_cvt_pk_bf16_f32 v220, v172, v173
v_mfma_f32_16x16x32_bf16 a[84:87], a[212:215], v[200:203], a[84:87]
v_exp_f32 v174, v174
v_mfma_f32_16x16x32_bf16 a[52:55], a[212:215], v[196:199], a[52:55]
v_exp_f32 v175, v175
v_mfma_f32_16x16x32_bf16 a[56:59], a[216:219], v[196:199], a[56:59]
ds_read_b128 a[244:247], v2 offset:13312
v_cvt_pk_bf16_f32 v221, v174, v175
v_mfma_f32_16x16x32_bf16 a[88:91], a[216:219], v[200:203], a[88:91]
v_exp_f32 v188, v188
v_mfma_f32_16x16x32_bf16 a[120:123], a[216:219], v[204:207], a[120:123]
ds_read_b128 a[248:251], v2 offset:14336
v_mfma_f32_16x16x32_bf16 a[124:127], a[220:223], v[204:207], a[124:127]
v_exp_f32 v189, v189
v_mfma_f32_16x16x32_bf16 a[92:95], a[220:223], v[200:203], a[92:95]
buffer_load_dwordx4 v1, s[36:39], s72 offen offset:3072 lds
v_mfma_f32_16x16x32_bf16 a[60:63], a[220:223], v[196:199], a[60:63]
ds_read_b128 a[252:255], v2 offset:15360
v_cvt_pk_bf16_f32 v222, v188, v189
v_mfma_f32_16x16x32_bf16 v[228:231], v[120:123], v[196:199], v[228:231]
v_exp_f32 v190, v190
v_mfma_f32_16x16x32_bf16 v[232:235], v[120:123], v[200:203], v[232:235]
s_waitcnt vmcnt(17) lgkmcnt(0)
v_exp_f32 v191, v191
v_mfma_f32_16x16x32_bf16 v[236:239], v[120:123], v[204:207], v[236:239]
s_barrier
v_cvt_pk_bf16_f32 v223, v190, v191
v_add_u32 v2, s82, v1
s_cmp_eq_u32 s58, 2
s_cbranch_scc1 Lta46
s_cmp_eq_u32 s58, 3
s_cbranch_scc1 Lnt47
v_mfma_f32_16x16x32_bf16 v[168:171], a[160:163], v[48:51], v[112:115]
s_mov_b32 m0, s62
v_exp_f32 v136, v136
v_mfma_f32_16x16x32_bf16 v[184:187], a[176:179], v[48:51], v[112:115]
s_add_u32 s72, s93, 0x3000000
ds_read_b128 a[128:131], v2 offset:16384
s_branch Ljoin48
Lta46:
v_mfma_f32_16x16x32_bf16 v[168:171], a[160:163], v[48:51], v[104:107]
s_mov_b32 m0, s62
v_exp_f32 v136, v136
v_mfma_f32_16x16x32_bf16 v[184:187], a[176:179], v[48:51], v[112:115]
s_add_u32 s72, s93, 0x3000000
ds_read_b128 a[128:131], v2 offset:16384
s_branch Ljoin48
Lnt47:
v_mfma_f32_16x16x32_bf16 v[168:171], a[160:163], v[48:51], v[88:91]
s_mov_b32 m0, s62
v_exp_f32 v136, v136
v_mfma_f32_16x16x32_bf16 v[184:187], a[176:179], v[48:51], v[104:107]
s_add_u32 s72, s93, 0x3000000
ds_read_b128 a[128:131], v2 offset:16384
Ljoin48:
v_mfma_f32_16x16x32_bf16 v[168:171], a[164:167], v[52:55], v[168:171]
buffer_load_dwordx4 v1, s[44:47], s72 offen sc1 lds
v_mfma_f32_16x16x32_bf16 v[168:171], a[168:171], v[56:59], v[168:171]
v_exp_f32 v137, v137
v_mfma_f32_16x16x32_bf16 v[168:171], a[172:175], v[60:63], v[168:171]
s_add_u32 s73, s62, 480
ds_read_b128 a[132:135], v2 offset:17408
v_cvt_pk_bf16_f32 v200, v136, v137
v_mfma_f32_16x16x32_bf16 v[172:175], a[172:175], v[76:79], v[92:95]
v_exp_f32 v138, v138
v_mfma_f32_16x16x32_bf16 v[172:175], a[168:171], v[72:75], v[172:175]
ds_read_b128 a[136:139], v2 offset:18432
v_lshlrev_b32 v248, 5, v240
v_mfma_f32_16x16x32_bf16 v[172:175], a[164:167], v[68:71], v[172:175]
buffer_load_dwordx4 v1, s[44:47], s72 offen offset:1024 sc1 lds
v_mfma_f32_16x16x32_bf16 v[172:175], a[160:163], v[64:67], v[172:175]
v_exp_f32 v139, v139
v_mfma_f32_16x16x32_bf16 v[188:191], a[176:179], v[64:67], v[92:95]
ds_read_b128 a[140:143], v2 offset:19456
v_cvt_pk_bf16_f32 v201, v138, v139
v_mfma_f32_16x16x32_bf16 v[188:191], a[180:183], v[68:71], v[188:191]
v_exp_f32 v152, v152
v_mfma_f32_16x16x32_bf16 v[188:191], a[184:187], v[72:75], v[188:191]
ds_read_b128 a[144:147], v2 offset:20480
v_sub_u32 v248, s73, v248
v_mfma_f32_16x16x32_bf16 v[188:191], a[188:191], v[76:79], v[188:191]
buffer_load_dwordx4 v1, s[44:47], s72 offen offset:2048 sc1 lds
v_mfma_f32_16x16x32_bf16 v[184:187], a[188:191], v[60:63], v[184:187]
v_exp_f32 v153, v153
v_mfma_f32_16x16x32_bf16 v[184:187], a[184:187], v[56:59], v[184:187]
ds_read_b128 a[148:151], v2 offset:21504
v_cvt_pk_bf16_f32 v202, v152, v153
v_mfma_f32_16x16x32_bf16 v[184:187], a[180:183], v[52:55], v[184:187]
s_waitcnt lgkmcnt(6)
buffer_load_dwordx4 v1, s[44:47], s72 offen offset:3072 sc1 lds
v_mfma_f32_16x16x32_bf16 a[32:35], a[224:227], v[212:215], a[32:35]
s_add_u32 s66, s58, 0
v_exp_f32 v154, v154
v_mfma_f32_16x16x32_bf16 a[64:67], a[224:227], v[216:219], a[64:67]
s_and_b32 s66, s66, 3
ds_read_b128 a[152:155], v2 offset:22528
v_lshl_add_u32 v7, v241, 4, v248
v_mfma_f32_16x16x32_bf16 a[96:99], a[224:227], v[220:223], a[96:99]
s_mul_i32 s66, s66, 4160
v_exp_f32 v155, v155
v_mfma_f32_16x16x32_bf16 a[100:103], a[228:231], v[220:223], a[100:103]
s_add_u32 s66, s66, s92
ds_read_b128 a[156:159], v2 offset:23552
v_cvt_pk_bf16_f32 v203, v154, v155
v_mfma_f32_16x16x32_bf16 a[68:71], a[228:231], v[216:219], a[68:71]
s_add_u32 m0, s66, 16672
v_exp_f32 v140, v140
v_mfma_f32_16x16x32_bf16 a[36:39], a[228:231], v[212:215], a[36:39]
s_add_u32 s72, s93, 0x0
buffer_load_dwordx4 v1, s[36:39], s72 offen lds
v_mfma_f32_16x16x32_bf16 a[40:43], a[232:235], v[212:215], a[40:43]
s_and_b32 s73, s58, 1
ds_read_b128 a[192:195], v2 offset:0
v_mfma_f32_16x16x32_bf16 a[72:75], a[232:235], v[216:219], a[72:75]
s_lshl_b32 s73, s73, 4
buffer_load_dwordx4 v1, s[36:39], s72 offen offset:1024 lds
v_mfma_f32_16x16x32_bf16 a[104:107], a[232:235], v[220:223], a[104:107]
s_lshr_b32 s73, s90, s73
v_exp_f32 v141, v141
v_mfma_f32_16x16x32_bf16 a[108:111], a[236:239], v[220:223], a[108:111]
s_and_b32 s73, s73, 0xffff
ds_read_b128 a[196:199], v2 offset:1024
v_cvt_pk_bf16_f32 v204, v140, v141
v_mfma_f32_16x16x32_bf16 a[76:79], a[236:239], v[216:219], a[76:79]
v_exp_f32 v142, v142
v_mfma_f32_16x16x32_bf16 a[44:47], a[236:239], v[212:215], a[44:47]
ds_read_b128 a[200:203], v2 offset:2048
v_lshl_add_u32 v248, v241, 3, v240
v_mfma_f32_16x16x32_bf16 a[48:51], a[240:243], v[212:215], a[48:51]
buffer_load_dwordx4 v1, s[36:39], s72 offen offset:2048 lds
v_mfma_f32_16x16x32_bf16 a[80:83], a[240:243], v[216:219], a[80:83]
v_exp_f32 v143, v143
v_mfma_f32_16x16x32_bf16 a[112:115], a[240:243], v[220:223], a[112:115]
ds_read_b128 a[204:207], v2 offset:3072
v_cvt_pk_bf16_f32 v205, v142, v143
v_mfma_f32_16x16x32_bf16 a[116:119], a[244:247], v[220:223], a[116:119]
v_exp_f32 v156, v156
v_mfma_f32_16x16x32_bf16 a[84:87], a[244:247], v[216:219], a[84:87]
ds_read_b128 a[208:211], v2 offset:4096
v_sub_u32 v248, 15, v248
v_mfma_f32_16x16x32_bf16 a[52:55], a[244:247], v[212:215], a[52:55]
buffer_load_dwordx4 v1, s[36:39], s72 offen offset:3072 lds
v_mfma_f32_16x16x32_bf16 a[56:59], a[248:251], v[212:215], a[56:59]
s_add_u32 s66, s58, 2
v_exp_f32 v157, v157
v_mfma_f32_16x16x32_bf16 a[88:91], a[248:251], v[216:219], a[88:91]
s_and_b32 s66, s66, 3
ds_read_b128 a[212:215], v2 offset:5120
v_cvt_pk_bf16_f32 v206, v156, v157
v_mfma_f32_16x16x32_bf16 a[120:123], a[248:251], v[220:223], a[120:123]
s_mul_i32 s66, s66, 4160
v_exp_f32 v158, v158
v_mfma_f32_16x16x32_bf16 a[124:127], a[252:255], v[220:223], a[124:127]
s_add_u32 s66, s66, s92
ds_read_b128 a[216:219], v2 offset:6144
v_and_b32 v249, 1, v248
v_mfma_f32_16x16x32_bf16 a[92:95], a[252:255], v[216:219], a[92:95]
s_add_u32 m0, s66, 33312
v_exp_f32 v159, v159
v_mfma_f32_16x16x32_bf16 a[60:63], a[252:255], v[212:215], a[60:63]
s_add_u32 s72, s93, 0x4
buffer_load_dwordx4 v1, s[36:39], s72 offen lds
v_mfma_f32_16x16x32_bf16 v[228:231], v[120:123], v[212:215], v[228:231]
ds_read_b128 a[220:223], v2 offset:7168
v_cvt_pk_bf16_f32 v207, v158, v159
v_mfma_f32_16x16x32_bf16 v[232:235], v[120:123], v[216:219], v[232:235]
buffer_load_dwordx4 v1, s[36:39], s72 offen offset:1024 lds
v_mfma_f32_16x16x32_bf16 v[236:239], v[120:123], v[220:223], v[236:239]
s_waitcnt lgkmcnt(8)
v_lshlrev_b32 v249, 4, v249
v_lshlrev_b32 v249, v249, s73
v_lshrrev_b32 v248, 1, v248
v_and_b32 v241, 3, v0
v_cmp_eq_u32 vcc, 0, v248
v_lshl_add_u32 v5, v241, 3, v5
s_nop 0
v_cndmask_b32 v8, 0, v249, vcc
v_cmp_eq_u32 vcc, 1, v248
v_lshlrev_b32 v240, 4, v251
s_nop 0
v_cndmask_b32 v9, 0, v249, vcc
v_cmp_eq_u32 vcc, 2, v248
v_sub_u32 v240, 48, v240
v_lshlrev_b64 v[12:13], 16, s[88:89]
v_cndmask_b32 v10, 0, v249, vcc
v_cmp_eq_u32 vcc, 3, v248
v_lshlrev_b64 v[12:13], v240, v[12:13]
s_nop 0
v_cndmask_b32 v11, 0, v249, vcc
v_cmp_eq_u32 vcc, 3, v241
s_add_u32 s73, s62, 4096
v_lshl_add_u32 v14, v0, 3, s73
v_cndmask_b32 v12, 0, v12, vcc
v_cndmask_b32 v13, 0, v13, vcc
v_lshrrev_b32 v15, 4, v0
v_lshlrev_b32 v15, 1, v15
v_and_b32 v240, 7, v0
v_xor_b32 v15, v15, v240
v_lshlrev_b32 v15, 4, v15
v_lshrrev_b32 v240, 3, v0
v_lshl_add_u32 v15, v240, 11, v15
s_lshr_b32 s75, s59, 1
s_and_b32 s75, s75, 8
s_add_u32 s75, s75, s60
s_lshl_b32 s76, s65, 2
s_lshr_b32 s80, s59, 2
s_and_b32 s80, s80, 3
s_add_u32 s76, s76, s80
s_lshl_b32 s94, s58, 16
s_lshl_b32 s80, s76, 7
s_add_u32 s94, s94, s80
s_lshl_b32 s80, s75, 18
s_add_u32 s80, s80, s94
v_rcp_f32 v224, v224
v_rcp_f32 v228, v228
s_lshl_b32 s73, s59, 12
s_add_u32 s73, s73, 0x2000000
s_lshl_b32 s70, s67, 2
s_add_u32 s70, s70, s73
v_mov_b32 v225, v224
v_accvgpr_read_b32 v240, a0
v_accvgpr_read_b32 v241, a1
v_accvgpr_read_b32 v242, a2
v_accvgpr_read_b32 v243, a3
v_accvgpr_read_b32 v244, a4
v_accvgpr_read_b32 v245, a5
v_accvgpr_read_b32 v246, a6
v_accvgpr_read_b32 v247, a7
v_pk_mul_f32 v[240:241], v[240:241], v[224:225]
v_pk_mul_f32 v[242:243], v[242:243], v[224:225]
v_pk_mul_f32 v[244:245], v[244:245], v[224:225]
v_pk_mul_f32 v[246:247], v[246:247], v[224:225]
buffer_load_dwordx4 v1, s[36:39], s72 offen offset:2048 lds
v_cvt_pk_bf16_f32 v128, v240, v241
v_cvt_pk_bf16_f32 v129, v242, v243
v_cvt_pk_bf16_f32 v130, v244, v245
v_cvt_pk_bf16_f32 v131, v246, v247
v_accvgpr_read_b32 v248, a8
v_accvgpr_read_b32 v249, a9
v_accvgpr_read_b32 v250, a10
v_accvgpr_read_b32 v251, a11
v_accvgpr_read_b32 v252, a12
v_accvgpr_read_b32 v253, a13
v_accvgpr_read_b32 v254, a14
v_accvgpr_read_b32 v255, a15
v_pk_mul_f32 v[248:249], v[248:249], v[224:225]
v_pk_mul_f32 v[250:251], v[250:251], v[224:225]
v_pk_mul_f32 v[252:253], v[252:253], v[224:225]
v_pk_mul_f32 v[254:255], v[254:255], v[224:225]
v_cvt_pk_bf16_f32 v144, v248, v249
v_cvt_pk_bf16_f32 v145, v250, v251
buffer_load_dwordx4 v1, s[36:39], s72 offen offset:3072 lds
v_cvt_pk_bf16_f32 v146, v252, v253
v_cvt_pk_bf16_f32 v147, v254, v255
v_accvgpr_read_b32 v240, a16
v_accvgpr_read_b32 v241, a17
v_accvgpr_read_b32 v242, a18
v_accvgpr_read_b32 v243, a19
v_accvgpr_read_b32 v244, a20
v_accvgpr_read_b32 v245, a21
v_accvgpr_read_b32 v246, a22
v_accvgpr_read_b32 v247, a23
v_pk_mul_f32 v[240:241], v[240:241], v[224:225]
v_pk_mul_f32 v[242:243], v[242:243], v[224:225]
v_pk_mul_f32 v[244:245], v[244:245], v[224:225]
v_pk_mul_f32 v[246:247], v[246:247], v[224:225]
v_cvt_pk_bf16_f32 v160, v240, v241
v_cvt_pk_bf16_f32 v161, v242, v243
v_cvt_pk_bf16_f32 v162, v244, v245
v_cvt_pk_bf16_f32 v163, v246, v247
buffer_load_dwordx4 v[80:83], v15, s[4:7], s80 offen
v_accvgpr_read_b32 v248, a24
v_accvgpr_read_b32 v249, a25
v_accvgpr_read_b32 v250, a26
v_accvgpr_read_b32 v251, a27
v_accvgpr_read_b32 v252, a28
v_accvgpr_read_b32 v253, a29
v_accvgpr_read_b32 v254, a30
v_accvgpr_read_b32 v255, a31
v_pk_mul_f32 v[248:249], v[248:249], v[224:225]
v_pk_mul_f32 v[250:251], v[250:251], v[224:225]
v_pk_mul_f32 v[252:253], v[252:253], v[224:225]
v_pk_mul_f32 v[254:255], v[254:255], v[224:225]
v_cvt_pk_bf16_f32 v176, v248, v249
v_cvt_pk_bf16_f32 v177, v250, v251
v_cvt_pk_bf16_f32 v178, v252, v253
v_cvt_pk_bf16_f32 v179, v254, v255
v_mov_b32 v229, v228
v_accvgpr_read_b32 v240, a32
s_add_u32 s80, s80, 0x4000
buffer_load_dwordx4 v[84:87], v15, s[4:7], s80 offen
v_accvgpr_read_b32 v241, a33
v_accvgpr_read_b32 v242, a34
v_accvgpr_read_b32 v243, a35
v_accvgpr_read_b32 v244, a36
v_accvgpr_read_b32 v245, a37
v_accvgpr_read_b32 v246, a38
v_accvgpr_read_b32 v247, a39
v_pk_mul_f32 v[240:241], v[240:241], v[228:229]
v_pk_mul_f32 v[242:243], v[242:243], v[228:229]
v_pk_mul_f32 v[244:245], v[244:245], v[228:229]
v_pk_mul_f32 v[246:247], v[246:247], v[228:229]
v_cvt_pk_bf16_f32 v132, v240, v241
v_cvt_pk_bf16_f32 v133, v242, v243
v_cvt_pk_bf16_f32 v134, v244, v245
v_cvt_pk_bf16_f32 v135, v246, v247
v_accvgpr_read_b32 v248, a40
v_accvgpr_read_b32 v249, a41
v_accvgpr_read_b32 v250, a42
s_add_u32 s80, s80, 0x4000
buffer_load_dwordx4 v[96:99], v15, s[4:7], s80 offen
v_accvgpr_read_b32 v251, a43
v_accvgpr_read_b32 v252, a44
v_accvgpr_read_b32 v253, a45
v_accvgpr_read_b32 v254, a46
v_accvgpr_read_b32 v255, a47
v_pk_mul_f32 v[248:249], v[248:249], v[228:229]
v_pk_mul_f32 v[250:251], v[250:251], v[228:229]
v_pk_mul_f32 v[252:253], v[252:253], v[228:229]
v_pk_mul_f32 v[254:255], v[254:255], v[228:229]
v_cvt_pk_bf16_f32 v148, v248, v249
v_cvt_pk_bf16_f32 v149, v250, v251
v_cvt_pk_bf16_f32 v150, v252, v253
v_cvt_pk_bf16_f32 v151, v254, v255
v_accvgpr_read_b32 v240, a48
v_accvgpr_read_b32 v241, a49
v_accvgpr_read_b32 v242, a50
v_accvgpr_read_b32 v243, a51
v_accvgpr_read_b32 v244, a52
s_add_u32 s80, s80, 0x4000
buffer_load_dwordx4 v[100:103], v15, s[4:7], s80 offen
v_accvgpr_read_b32 v245, a53
v_accvgpr_read_b32 v246, a54
v_accvgpr_read_b32 v247, a55
v_pk_mul_f32 v[240:241], v[240:241], v[228:229]
v_pk_mul_f32 v[242:243], v[242:243], v[228:229]
v_pk_mul_f32 v[244:245], v[244:245], v[228:229]
v_pk_mul_f32 v[246:247], v[246:247], v[228:229]
v_cvt_pk_bf16_f32 v164, v240, v241
v_cvt_pk_bf16_f32 v165, v242, v243
v_cvt_pk_bf16_f32 v166, v244, v245
v_cvt_pk_bf16_f32 v167, v246, v247
v_accvgpr_read_b32 v248, a56
v_accvgpr_read_b32 v249, a57
v_accvgpr_read_b32 v250, a58
v_accvgpr_read_b32 v251, a59
v_accvgpr_read_b32 v252, a60
v_accvgpr_read_b32 v253, a61
v_accvgpr_read_b32 v254, a62
v_accvgpr_read_b32 v255, a63
v_pk_mul_f32 v[248:249], v[248:249], v[228:229]
v_pk_mul_f32 v[250:251], v[250:251], v[228:229]
v_pk_mul_f32 v[252:253], v[252:253], v[228:229]
v_pk_mul_f32 v[254:255], v[254:255], v[228:229]
v_cvt_pk_bf16_f32 v180, v248, v249
v_cvt_pk_bf16_f32 v181, v250, v251
v_cvt_pk_bf16_f32 v182, v252, v253
v_cvt_pk_bf16_f32 v183, v254, v255
s_cmp_eq_u32 s58, 0
s_cbranch_scc1 Lta49
s_cmp_eq_u32 s58, 1
s_cbranch_scc1 Lnt50
v_mfma_f32_16x16x32_bf16 v[140:143], a[128:131], v[64:67], v[92:95]
s_add_u32 s82, s82, 0x8000
ds_read_b128 a[160:163], v2 offset:24576
ds_read_b128 a[164:167], v2 offset:25600
v_mfma_f32_16x16x32_bf16 v[156:159], a[144:147], v[64:67], v[92:95]
s_and_b32 s82, s82, 0x1ffff
v_exp_f32 v168, v168
s_branch Ljoin51
Lta49:
v_mfma_f32_16x16x32_bf16 v[140:143], a[128:131], v[64:67], v[108:111]
s_add_u32 s82, s82, 0x8000
ds_read_b128 a[160:163], v2 offset:24576
ds_read_b128 a[164:167], v2 offset:25600
v_mfma_f32_16x16x32_bf16 v[156:159], a[144:147], v[64:67], v[112:115]
s_and_b32 s82, s82, 0x1ffff
v_exp_f32 v168, v168
s_branch Ljoin51
Lnt50:
v_mfma_f32_16x16x32_bf16 v[140:143], a[128:131], v[64:67], v[92:95]
s_add_u32 s82, s82, 0x8000
ds_read_b128 a[160:163], v2 offset:24576
ds_read_b128 a[164:167], v2 offset:25600
v_mfma_f32_16x16x32_bf16 v[156:159], a[144:147], v[64:67], v[108:111]
s_and_b32 s82, s82, 0x1ffff
v_exp_f32 v168, v168
Ljoin51:
v_mfma_f32_16x16x32_bf16 v[140:143], a[132:135], v[68:71], v[140:143]
v_exp_f32 v169, v169
v_mfma_f32_16x16x32_bf16 v[140:143], a[136:139], v[72:75], v[140:143]
ds_read_b128 a[168:171], v2 offset:26624
ds_read_b128 a[172:175], v2 offset:27648
v_mfma_f32_16x16x32_bf16 v[140:143], a[140:143], v[76:79], v[140:143]
v_exp_f32 v170, v170
v_mfma_f32_16x16x32_bf16 v[156:159], a[156:159], v[76:79], v[156:159]
v_exp_f32 v171, v171
v_mfma_f32_16x16x32_bf16 v[156:159], a[152:155], v[72:75], v[156:159]
buffer_store_dwordx4 v[128:131], v1, s[44:47], s70 offen sc1
v_mfma_f32_16x16x32_bf16 v[156:159], a[148:151], v[68:71], v[156:159]
s_waitcnt lgkmcnt(4)
ds_read_b128 a[176:179], v2 offset:28672
ds_read_b128 a[180:183], v2 offset:29696
v_mfma_f32_16x16x32_bf16 a[64:67], a[192:195], v[200:203], a[64:67]
v_exp_f32 v184, v184
v_mfma_f32_16x16x32_bf16 a[96:99], a[192:195], v[204:207], a[96:99]
ds_read_b128 a[184:187], v2 offset:30720
ds_read_b128 a[188:191], v2 offset:31744
v_mfma_f32_16x16x32_bf16 a[100:103], a[196:199], v[204:207], a[100:103]
ds_read_b128 a[224:227], v2 offset:8192
ds_read_b128 a[228:231], v2 offset:9216
v_mfma_f32_16x16x32_bf16 a[68:71], a[196:199], v[200:203], a[68:71]
ds_read_b128 a[232:235], v2 offset:10240
ds_read_b128 a[236:239], v2 offset:11264
v_mfma_f32_16x16x32_bf16 a[72:75], a[200:203], v[200:203], a[72:75]
ds_read_b128 a[240:243], v2 offset:12288
ds_read_b128 a[244:247], v2 offset:13312
v_mfma_f32_16x16x32_bf16 a[104:107], a[200:203], v[204:207], a[104:107]
ds_read_b128 a[248:251], v2 offset:14336
ds_read_b128 a[252:255], v2 offset:15360
v_mfma_f32_16x16x32_bf16 a[108:111], a[204:207], v[204:207], a[108:111]
v_cvt_pk_bf16_f32 v216, v168, v169
v_cvt_pk_bf16_f32 v217, v170, v171
v_mfma_f32_16x16x32_bf16 a[76:79], a[204:207], v[200:203], a[76:79]
v_exp_f32 v185, v185
v_mfma_f32_16x16x32_bf16 a[80:83], a[208:211], v[200:203], a[80:83]
v_exp_f32 v186, v186
v_mfma_f32_16x16x32_bf16 a[112:115], a[208:211], v[204:207], a[112:115]
v_exp_f32 v187, v187
v_mfma_f32_16x16x32_bf16 a[116:119], a[212:215], v[204:207], a[116:119]
v_exp_f32 v172, v172
v_mfma_f32_16x16x32_bf16 a[84:87], a[212:215], v[200:203], a[84:87]
buffer_store_dwordx4 v[144:147], v1, s[44:47], s70 offen offset:1024 sc1
v_mfma_f32_16x16x32_bf16 a[88:91], a[216:219], v[200:203], a[88:91]
v_cvt_pk_bf16_f32 v218, v184, v185
v_cvt_pk_bf16_f32 v219, v186, v187
v_mfma_f32_16x16x32_bf16 a[120:123], a[216:219], v[204:207], a[120:123]
v_exp_f32 v173, v173
v_mfma_f32_16x16x32_bf16 a[124:127], a[220:223], v[204:207], a[124:127]
v_exp_f32 v174, v174
v_mfma_f32_16x16x32_bf16 a[92:95], a[220:223], v[200:203], a[92:95]
buffer_store_dwordx4 v[160:163], v1, s[44:47], s70 offen offset:2048 sc1
v_mfma_f32_16x16x32_bf16 v[232:235], v[120:123], v[200:203], v[232:235]
s_waitcnt vmcnt(24) lgkmcnt(8)
v_exp_f32 v175, v175
v_mfma_f32_16x16x32_bf16 v[236:239], v[120:123], v[204:207], v[236:239]
s_barrier
v_exp_f32 v188, v188
v_add_u32 v2, s82, v1
v_cvt_pk_bf16_f32 v220, v172, v173
v_cvt_pk_bf16_f32 v221, v174, v175
v_exp_f32 v189, v189
v_exp_f32 v190, v190
v_cvt_pk_bf16_f32 v222, v188, v189
v_exp_f32 v191, v191
s_nop 0
v_cvt_pk_bf16_f32 v223, v190, v191
s_cmp_eq_u32 s58, 2
s_cbranch_scc1 Lta52
s_cmp_eq_u32 s58, 3
s_cbranch_scc1 Lnt53
v_mfma_f32_16x16x32_bf16 v[172:175], a[160:163], v[64:67], v[112:115]
v_exp_f32 v140, v140
v_mfma_f32_16x16x32_bf16 v[188:191], a[176:179], v[64:67], v[112:115]
ds_read_b128 a[192:195], v2 offset:0
s_branch Ljoin54
Lta52:
v_mfma_f32_16x16x32_bf16 v[172:175], a[160:163], v[64:67], v[108:111]
v_exp_f32 v140, v140
v_mfma_f32_16x16x32_bf16 v[188:191], a[176:179], v[64:67], v[112:115]
ds_read_b128 a[192:195], v2 offset:0
s_branch Ljoin54
Lnt53:
v_mfma_f32_16x16x32_bf16 v[172:175], a[160:163], v[64:67], v[92:95]
v_exp_f32 v140, v140
v_mfma_f32_16x16x32_bf16 v[188:191], a[176:179], v[64:67], v[108:111]
ds_read_b128 a[192:195], v2 offset:0
Ljoin54:
v_mfma_f32_16x16x32_bf16 v[172:175], a[164:167], v[68:71], v[172:175]
v_exp_f32 v141, v141
v_mfma_f32_16x16x32_bf16 v[172:175], a[168:171], v[72:75], v[172:175]
ds_read_b128 a[196:199], v2 offset:1024
v_cvt_pk_bf16_f32 v204, v140, v141
v_mfma_f32_16x16x32_bf16 v[172:175], a[172:175], v[76:79], v[172:175]
s_add_u32 s78, s59, 4
buffer_store_dwordx4 v[176:179], v1, s[44:47], s70 offen offset:3072 sc1
v_mfma_f32_16x16x32_bf16 v[188:191], a[188:191], v[76:79], v[188:191]
s_add_u32 s70, s70, 0x80000
v_exp_f32 v142, v142
v_mfma_f32_16x16x32_bf16 v[188:191], a[184:187], v[72:75], v[188:191]
s_and_b32 s78, s78, 12
ds_read_b128 a[200:203], v2 offset:2048
v_mfma_f32_16x16x32_bf16 v[188:191], a[180:183], v[68:71], v[188:191]
s_waitcnt lgkmcnt(3)
v_exp_f32 v143, v143
v_mfma_f32_16x16x32_bf16 a[64:67], a[224:227], v[216:219], a[64:67]
s_and_b32 s12, s59, 16
ds_read_b128 a[204:207], v2 offset:3072
v_cvt_pk_bf16_f32 v205, v142, v143
v_mfma_f32_16x16x32_bf16 a[96:99], a[224:227], v[220:223], a[96:99]
s_or_b32 s78, s78, s12
v_exp_f32 v156, v156
v_mfma_f32_16x16x32_bf16 a[100:103], a[228:231], v[220:223], a[100:103]
s_add_u32 s12, s61, 0
ds_read_b128 a[208:211], v2 offset:4096
v_mfma_f32_16x16x32_bf16 a[68:71], a[228:231], v[216:219], a[68:71]
s_and_b32 s12, s12, 3
buffer_store_dwordx4 v[132:135], v1, s[44:47], s70 offen sc1
v_mfma_f32_16x16x32_bf16 a[72:75], a[232:235], v[216:219], a[72:75]
s_add_u32 s12, s12, s78
v_exp_f32 v157, v157
v_mfma_f32_16x16x32_bf16 a[104:107], a[232:235], v[220:223], a[104:107]
s_lshl_b32 s12, s12, 18
ds_read_b128 a[212:215], v2 offset:5120
v_cvt_pk_bf16_f32 v206, v156, v157
v_mfma_f32_16x16x32_bf16 a[108:111], a[236:239], v[220:223], a[108:111]
s_add_u32 s12, s12, s94
v_exp_f32 v158, v158
v_mfma_f32_16x16x32_bf16 a[76:79], a[236:239], v[216:219], a[76:79]
s_add_u32 s13, s61, 1
ds_read_b128 a[216:219], v2 offset:6144
v_mfma_f32_16x16x32_bf16 a[80:83], a[240:243], v[216:219], a[80:83]
s_and_b32 s13, s13, 3
buffer_store_dwordx4 v[148:151], v1, s[44:47], s70 offen offset:1024 sc1
v_mfma_f32_16x16x32_bf16 a[112:115], a[240:243], v[220:223], a[112:115]
s_add_u32 s13, s13, s78
v_exp_f32 v159, v159
v_mfma_f32_16x16x32_bf16 a[116:119], a[244:247], v[220:223], a[116:119]
s_lshl_b32 s13, s13, 18
ds_read_b128 a[220:223], v2 offset:7168
v_cvt_pk_bf16_f32 v207, v158, v159
v_mfma_f32_16x16x32_bf16 a[84:87], a[244:247], v[216:219], a[84:87]
s_add_u32 s13, s13, s94
v_mfma_f32_16x16x32_bf16 a[88:91], a[248:251], v[216:219], a[88:91]
s_add_u32 s14, s61, 2
v_mfma_f32_16x16x32_bf16 a[120:123], a[248:251], v[220:223], a[120:123]
s_and_b32 s14, s14, 3
v_mfma_f32_16x16x32_bf16 a[124:127], a[252:255], v[220:223], a[124:127]
s_add_u32 s14, s14, s78
v_mfma_f32_16x16x32_bf16 a[92:95], a[252:255], v[216:219], a[92:95]
s_lshl_b32 s14, s14, 18
v_mfma_f32_16x16x32_bf16 v[232:235], v[120:123], v[216:219], v[232:235]
s_add_u32 s14, s14, s94
v_mfma_f32_16x16x32_bf16 v[236:239], v[120:123], v[220:223], v[236:239]
s_waitcnt lgkmcnt(0)
s_add_u32 s15, s61, 3
s_and_b32 s15, s15, 3
s_add_u32 s15, s15, s78
s_lshl_b32 s15, s15, 18
s_add_u32 s15, s15, s94
v_mfma_f32_16x16x32_bf16 a[96:99], a[192:195], v[204:207], a[96:99]
s_add_u32 s82, s82, 0x8000
ds_read_b128 a[224:227], v2 offset:8192
ds_read_b128 a[228:231], v2 offset:9216
v_mfma_f32_16x16x32_bf16 a[100:103], a[196:199], v[204:207], a[100:103]
s_and_b32 s82, s82, 0x1ffff
v_exp_f32 v172, v172
v_mfma_f32_16x16x32_bf16 a[104:107], a[200:203], v[204:207], a[104:107]
ds_read_b128 a[232:235], v2 offset:10240
ds_read_b128 a[236:239], v2 offset:11264
v_mfma_f32_16x16x32_bf16 a[108:111], a[204:207], v[204:207], a[108:111]
buffer_store_dwordx4 v[164:167], v1, s[44:47], s70 offen offset:2048 sc1
v_mfma_f32_16x16x32_bf16 a[112:115], a[208:211], v[204:207], a[112:115]
ds_read_b128 a[240:243], v2 offset:12288
ds_read_b128 a[244:247], v2 offset:13312
v_mfma_f32_16x16x32_bf16 a[116:119], a[212:215], v[204:207], a[116:119]
ds_read_b128 a[248:251], v2 offset:14336
ds_read_b128 a[252:255], v2 offset:15360
v_mfma_f32_16x16x32_bf16 a[120:123], a[216:219], v[204:207], a[120:123]
buffer_store_dwordx4 v[180:183], v1, s[44:47], s70 offen offset:3072 sc1
v_mfma_f32_16x16x32_bf16 a[124:127], a[220:223], v[204:207], a[124:127]
s_waitcnt vmcnt(8) lgkmcnt(0)
v_exp_f32 v173, v173
v_mfma_f32_16x16x32_bf16 v[236:239], v[120:123], v[204:207], v[236:239]
s_barrier
v_exp_f32 v174, v174
v_add_u32 v2, s82, v1
v_cvt_pk_bf16_f32 v220, v172, v173
v_exp_f32 v175, v175
v_exp_f32 v188, v188
v_cvt_pk_bf16_f32 v221, v174, v175
v_exp_f32 v189, v189
v_exp_f32 v190, v190
v_cvt_pk_bf16_f32 v222, v188, v189
v_exp_f32 v191, v191
s_nop 0
v_cvt_pk_bf16_f32 v223, v190, v191
s_branch LHT4
Lslow:
s_waitcnt vmcnt(0) lgkmcnt(0)
s_barrier
s_mov_b32 s86, 1
s_lshl_b32 s81, s59, 20
s_add_u32 s81, s81, s64
s_sub_u32 s81, s81, 0x4000
s_mov_b32 s83, 0
s_lshl_b32 s75, s60, 3
s_sub_u32 s76, 128, s75
s_add_u32 s74, s75, s58
s_sub_u32 s75, s76, 8
s_add_u32 s75, s75, s58
v_mov_b32 v2, v1
v_lshrrev_b32 v240, 4, v0
v_and_b32 v241, 15, v0
v_lshlrev_b32 v240, 2, v240
v_sub_u32 v240, v241, v240
v_mov_b32 v112, 0xff800000
v_mov_b32 v113, 0xff800000
v_mov_b32 v114, 0xff800000
v_mov_b32 v115, 0xff800000
v_cmp_gt_i32 vcc, 0, v240
v_mov_b32 v120, 0x3f803f80
s_nop 0
v_cndmask_b32 v116, 0, v112, vcc
v_cmp_gt_i32 vcc, 1, v240
v_mov_b32 v121, 0x3f803f80
s_nop 0
v_cndmask_b32 v117, 0, v112, vcc
v_cmp_gt_i32 vcc, 2, v240
v_mov_b32 v122, 0x3f803f80
s_nop 0
v_cndmask_b32 v118, 0, v112, vcc
v_cmp_gt_i32 vcc, 3, v240
v_mov_b32 v123, 0x3f803f80
s_nop 0
v_cndmask_b32 v119, 0, v112, vcc
Lslow1:
s_add_u32 m0, s64, 16384
s_add_u32 s72, s81, 16384
buffer_load_dwordx4 v1, s[44:47], s72 offen sc1 lds
buffer_load_dwordx4 v1, s[44:47], s72 offen offset:1024 sc1 lds
buffer_load_dwordx4 v1, s[44:47], s72 offen offset:2048 sc1 lds
buffer_load_dwordx4 v1, s[44:47], s72 offen offset:3072 sc1 lds
s_add_u32 s81, s81, 0x8000
s_waitcnt vmcnt(0)
s_barrier
ds_read_b128 a[128:131], v2 offset:16384
ds_read_b128 a[132:135], v2 offset:17408
ds_read_b128 a[136:139], v2 offset:18432
ds_read_b128 a[140:143], v2 offset:19456
ds_read_b128 a[144:147], v2 offset:20480
ds_read_b128 a[148:151], v2 offset:21504
ds_read_b128 a[152:155], v2 offset:22528
ds_read_b128 a[156:159], v2 offset:23552
s_waitcnt lgkmcnt(0)
s_add_u32 s73, s74, 0
s_cmp_lt_u32 s73, s83
s_cbranch_scc1 Lsa55
s_cmp_eq_u32 s73, s83
s_cbranch_scc1 Lst56
v_mfma_f32_16x16x32_bf16 v[128:131], a[128:131], v[16:19], 0
s_branch Lsj57
Lst56:
v_mfma_f32_16x16x32_bf16 v[128:131], a[128:131], v[16:19], v[116:119]
Lsj57:
v_mfma_f32_16x16x32_bf16 v[128:131], a[132:135], v[20:23], v[128:131]
v_mfma_f32_16x16x32_bf16 v[128:131], a[136:139], v[24:27], v[128:131]
v_mfma_f32_16x16x32_bf16 v[128:131], a[140:143], v[28:31], v[128:131]
s_nop 7
v_max3_f32 v124, v124, v128, v129
v_max3_f32 v124, v124, v130, v131
Lsa55:
s_add_u32 s73, s74, 4
s_cmp_lt_u32 s73, s83
s_cbranch_scc1 Lsa58
s_cmp_eq_u32 s73, s83
s_cbranch_scc1 Lst59
v_mfma_f32_16x16x32_bf16 v[132:135], a[128:131], v[32:35], 0
s_branch Lsj60
Lst59:
v_mfma_f32_16x16x32_bf16 v[132:135], a[128:131], v[32:35], v[116:119]
Lsj60:
v_mfma_f32_16x16x32_bf16 v[132:135], a[132:135], v[36:39], v[132:135]
v_mfma_f32_16x16x32_bf16 v[132:135], a[136:139], v[40:43], v[132:135]
v_mfma_f32_16x16x32_bf16 v[132:135], a[140:143], v[44:47], v[132:135]
s_nop 7
v_max3_f32 v125, v125, v132, v133
v_max3_f32 v125, v125, v134, v135
Lsa58:
s_add_u32 s73, s75, 0
s_cmp_lt_u32 s73, s83
s_cbranch_scc1 Lsa61
s_cmp_eq_u32 s73, s83
s_cbranch_scc1 Lst62
v_mfma_f32_16x16x32_bf16 v[136:139], a[128:131], v[48:51], 0
s_branch Lsj63
Lst62:
v_mfma_f32_16x16x32_bf16 v[136:139], a[128:131], v[48:51], v[116:119]
Lsj63:
v_mfma_f32_16x16x32_bf16 v[136:139], a[132:135], v[52:55], v[136:139]
v_mfma_f32_16x16x32_bf16 v[136:139], a[136:139], v[56:59], v[136:139]
v_mfma_f32_16x16x32_bf16 v[136:139], a[140:143], v[60:63], v[136:139]
s_nop 7
v_max3_f32 v126, v126, v136, v137
v_max3_f32 v126, v126, v138, v139
Lsa61:
s_add_u32 s73, s75, 4
s_cmp_lt_u32 s73, s83
s_cbranch_scc1 Lsa64
s_cmp_eq_u32 s73, s83
s_cbranch_scc1 Lst65
v_mfma_f32_16x16x32_bf16 v[140:143], a[128:131], v[64:67], 0
s_branch Lsj66
Lst65:
v_mfma_f32_16x16x32_bf16 v[140:143], a[128:131], v[64:67], v[116:119]
Lsj66:
v_mfma_f32_16x16x32_bf16 v[140:143], a[132:135], v[68:71], v[140:143]
v_mfma_f32_16x16x32_bf16 v[140:143], a[136:139], v[72:75], v[140:143]
v_mfma_f32_16x16x32_bf16 v[140:143], a[140:143], v[76:79], v[140:143]
s_nop 7
v_max3_f32 v127, v127, v140, v141
v_max3_f32 v127, v127, v142, v143
Lsa64:
s_add_u32 s83, s83, 1
s_add_u32 s73, s74, 0
s_cmp_lt_u32 s73, s83
s_cbranch_scc1 Lsa67
s_cmp_eq_u32 s73, s83
s_cbranch_scc1 Lst68
v_mfma_f32_16x16x32_bf16 v[144:147], a[144:147], v[16:19], 0
s_branch Lsj69
Lst68:
v_mfma_f32_16x16x32_bf16 v[144:147], a[144:147], v[16:19], v[116:119]
Lsj69:
v_mfma_f32_16x16x32_bf16 v[144:147], a[148:151], v[20:23], v[144:147]
v_mfma_f32_16x16x32_bf16 v[144:147], a[152:155], v[24:27], v[144:147]
v_mfma_f32_16x16x32_bf16 v[144:147], a[156:159], v[28:31], v[144:147]
s_nop 7
v_max3_f32 v124, v124, v144, v145
v_max3_f32 v124, v124, v146, v147
Lsa67:
s_add_u32 s73, s74, 4
s_cmp_lt_u32 s73, s83
s_cbranch_scc1 Lsa70
s_cmp_eq_u32 s73, s83
s_cbranch_scc1 Lst71
v_mfma_f32_16x16x32_bf16 v[148:151], a[144:147], v[32:35], 0
s_branch Lsj72
Lst71:
v_mfma_f32_16x16x32_bf16 v[148:151], a[144:147], v[32:35], v[116:119]
Lsj72:
v_mfma_f32_16x16x32_bf16 v[148:151], a[148:151], v[36:39], v[148:151]
v_mfma_f32_16x16x32_bf16 v[148:151], a[152:155], v[40:43], v[148:151]
v_mfma_f32_16x16x32_bf16 v[148:151], a[156:159], v[44:47], v[148:151]
s_nop 7
v_max3_f32 v125, v125, v148, v149
v_max3_f32 v125, v125, v150, v151
Lsa70:
s_add_u32 s73, s75, 0
s_cmp_lt_u32 s73, s83
s_cbranch_scc1 Lsa73
s_cmp_eq_u32 s73, s83
s_cbranch_scc1 Lst74
v_mfma_f32_16x16x32_bf16 v[152:155], a[144:147], v[48:51], 0
s_branch Lsj75
Lst74:
v_mfma_f32_16x16x32_bf16 v[152:155], a[144:147], v[48:51], v[116:119]
Lsj75:
v_mfma_f32_16x16x32_bf16 v[152:155], a[148:151], v[52:55], v[152:155]
v_mfma_f32_16x16x32_bf16 v[152:155], a[152:155], v[56:59], v[152:155]
v_mfma_f32_16x16x32_bf16 v[152:155], a[156:159], v[60:63], v[152:155]
s_nop 7
v_max3_f32 v126, v126, v152, v153
v_max3_f32 v126, v126, v154, v155
Lsa73:
s_add_u32 s73, s75, 4
s_cmp_lt_u32 s73, s83
s_cbranch_scc1 Lsa76
s_cmp_eq_u32 s73, s83
s_cbranch_scc1 Lst77
v_mfma_f32_16x16x32_bf16 v[156:159], a[144:147], v[64:67], 0
s_branch Lsj78
Lst77:
v_mfma_f32_16x16x32_bf16 v[156:159], a[144:147], v[64:67], v[116:119]
Lsj78:
v_mfma_f32_16x16x32_bf16 v[156:159], a[148:151], v[68:71], v[156:159]
v_mfma_f32_16x16x32_bf16 v[156:159], a[152:155], v[72:75], v[156:159]
v_mfma_f32_16x16x32_bf16 v[156:159], a[156:159], v[76:79], v[156:159]
s_nop 7
v_max3_f32 v127, v127, v156, v157
v_max3_f32 v127, v127, v158, v159
Lsa76:
s_add_u32 s83, s83, 1
ds_read_b128 a[128:131], v2 offset:24576
ds_read_b128 a[132:135], v2 offset:25600
ds_read_b128 a[136:139], v2 offset:26624
ds_read_b128 a[140:143], v2 offset:27648
ds_read_b128 a[144:147], v2 offset:28672
ds_read_b128 a[148:151], v2 offset:29696
ds_read_b128 a[152:155], v2 offset:30720
ds_read_b128 a[156:159], v2 offset:31744
s_waitcnt lgkmcnt(0)
s_add_u32 s73, s74, 0
s_cmp_lt_u32 s73, s83
s_cbranch_scc1 Lsa79
s_cmp_eq_u32 s73, s83
s_cbranch_scc1 Lst80
v_mfma_f32_16x16x32_bf16 v[128:131], a[128:131], v[16:19], 0
s_branch Lsj81
Lst80:
v_mfma_f32_16x16x32_bf16 v[128:131], a[128:131], v[16:19], v[116:119]
Lsj81:
v_mfma_f32_16x16x32_bf16 v[128:131], a[132:135], v[20:23], v[128:131]
v_mfma_f32_16x16x32_bf16 v[128:131], a[136:139], v[24:27], v[128:131]
v_mfma_f32_16x16x32_bf16 v[128:131], a[140:143], v[28:31], v[128:131]
s_nop 7
v_max3_f32 v124, v124, v128, v129
v_max3_f32 v124, v124, v130, v131
Lsa79:
s_add_u32 s73, s74, 4
s_cmp_lt_u32 s73, s83
s_cbranch_scc1 Lsa82
s_cmp_eq_u32 s73, s83
s_cbranch_scc1 Lst83
v_mfma_f32_16x16x32_bf16 v[132:135], a[128:131], v[32:35], 0
s_branch Lsj84
Lst83:
v_mfma_f32_16x16x32_bf16 v[132:135], a[128:131], v[32:35], v[116:119]
Lsj84:
v_mfma_f32_16x16x32_bf16 v[132:135], a[132:135], v[36:39], v[132:135]
v_mfma_f32_16x16x32_bf16 v[132:135], a[136:139], v[40:43], v[132:135]
v_mfma_f32_16x16x32_bf16 v[132:135], a[140:143], v[44:47], v[132:135]
s_nop 7
v_max3_f32 v125, v125, v132, v133
v_max3_f32 v125, v125, v134, v135
Lsa82:
s_add_u32 s73, s75, 0
s_cmp_lt_u32 s73, s83
s_cbranch_scc1 Lsa85
s_cmp_eq_u32 s73, s83
s_cbranch_scc1 Lst86
v_mfma_f32_16x16x32_bf16 v[136:139], a[128:131], v[48:51], 0
s_branch Lsj87
Lst86:
v_mfma_f32_16x16x32_bf16 v[136:139], a[128:131], v[48:51], v[116:119]
Lsj87:
v_mfma_f32_16x16x32_bf16 v[136:139], a[132:135], v[52:55], v[136:139]
v_mfma_f32_16x16x32_bf16 v[136:139], a[136:139], v[56:59], v[136:139]
v_mfma_f32_16x16x32_bf16 v[136:139], a[140:143], v[60:63], v[136:139]
s_nop 7
v_max3_f32 v126, v126, v136, v137
v_max3_f32 v126, v126, v138, v139
Lsa85:
s_add_u32 s73, s75, 4
s_cmp_lt_u32 s73, s83
s_cbranch_scc1 Lsa88
s_cmp_eq_u32 s73, s83
s_cbranch_scc1 Lst89
v_mfma_f32_16x16x32_bf16 v[140:143], a[128:131], v[64:67], 0
s_branch Lsj90
Lst89:
v_mfma_f32_16x16x32_bf16 v[140:143], a[128:131], v[64:67], v[116:119]
Lsj90:
v_mfma_f32_16x16x32_bf16 v[140:143], a[132:135], v[68:71], v[140:143]
v_mfma_f32_16x16x32_bf16 v[140:143], a[136:139], v[72:75], v[140:143]
v_mfma_f32_16x16x32_bf16 v[140:143], a[140:143], v[76:79], v[140:143]
s_nop 7
v_max3_f32 v127, v127, v140, v141
v_max3_f32 v127, v127, v142, v143
Lsa88:
s_add_u32 s83, s83, 1
s_add_u32 s73, s74, 0
s_cmp_lt_u32 s73, s83
s_cbranch_scc1 Lsa91
s_cmp_eq_u32 s73, s83
s_cbranch_scc1 Lst92
v_mfma_f32_16x16x32_bf16 v[144:147], a[144:147], v[16:19], 0
s_branch Lsj93
Lst92:
v_mfma_f32_16x16x32_bf16 v[144:147], a[144:147], v[16:19], v[116:119]
Lsj93:
v_mfma_f32_16x16x32_bf16 v[144:147], a[148:151], v[20:23], v[144:147]
v_mfma_f32_16x16x32_bf16 v[144:147], a[152:155], v[24:27], v[144:147]
v_mfma_f32_16x16x32_bf16 v[144:147], a[156:159], v[28:31], v[144:147]
s_nop 7
v_max3_f32 v124, v124, v144, v145
v_max3_f32 v124, v124, v146, v147
Lsa91:
s_add_u32 s73, s74, 4
s_cmp_lt_u32 s73, s83
s_cbranch_scc1 Lsa94
s_cmp_eq_u32 s73, s83
s_cbranch_scc1 Lst95
v_mfma_f32_16x16x32_bf16 v[148:151], a[144:147], v[32:35], 0
s_branch Lsj96
Lst95:
v_mfma_f32_16x16x32_bf16 v[148:151], a[144:147], v[32:35], v[116:119]
Lsj96:
v_mfma_f32_16x16x32_bf16 v[148:151], a[148:151], v[36:39], v[148:151]
v_mfma_f32_16x16x32_bf16 v[148:151], a[152:155], v[40:43], v[148:151]
v_mfma_f32_16x16x32_bf16 v[148:151], a[156:159], v[44:47], v[148:151]
s_nop 7
v_max3_f32 v125, v125, v148, v149
v_max3_f32 v125, v125, v150, v151
Lsa94:
s_add_u32 s73, s75, 0
s_cmp_lt_u32 s73, s83
s_cbranch_scc1 Lsa97
s_cmp_eq_u32 s73, s83
s_cbranch_scc1 Lst98
v_mfma_f32_16x16x32_bf16 v[152:155], a[144:147], v[48:51], 0
s_branch Lsj99
Lst98:
v_mfma_f32_16x16x32_bf16 v[152:155], a[144:147], v[48:51], v[116:119]
Lsj99:
v_mfma_f32_16x16x32_bf16 v[152:155], a[148:151], v[52:55], v[152:155]
v_mfma_f32_16x16x32_bf16 v[152:155], a[152:155], v[56:59], v[152:155]
v_mfma_f32_16x16x32_bf16 v[152:155], a[156:159], v[60:63], v[152:155]
s_nop 7
v_max3_f32 v126, v126, v152, v153
v_max3_f32 v126, v126, v154, v155
Lsa97:
s_add_u32 s73, s75, 4
s_cmp_lt_u32 s73, s83
s_cbranch_scc1 Lsa100
s_cmp_eq_u32 s73, s83
s_cbranch_scc1 Lst101
v_mfma_f32_16x16x32_bf16 v[156:159], a[144:147], v[64:67], 0
s_branch Lsj102
Lst101:
v_mfma_f32_16x16x32_bf16 v[156:159], a[144:147], v[64:67], v[116:119]
Lsj102:
v_mfma_f32_16x16x32_bf16 v[156:159], a[148:151], v[68:71], v[156:159]
v_mfma_f32_16x16x32_bf16 v[156:159], a[152:155], v[72:75], v[156:159]
v_mfma_f32_16x16x32_bf16 v[156:159], a[156:159], v[76:79], v[156:159]
s_nop 7
v_max3_f32 v127, v127, v156, v157
v_max3_f32 v127, v127, v158, v159
Lsa100:
s_add_u32 s83, s83, 1
s_barrier
s_cmp_lt_u32 s83, s76
s_cbranch_scc1 Lslow1
s_lshl_b32 s81, s59, 20
s_add_u32 s81, s81, s64
s_sub_u32 s81, s81, 0x4000
s_add_u32 m0, s64, 49152
s_add_u32 s72, s81, 16384
buffer_load_dwordx4 v1, s[44:47], s72 offen sc1 lds
buffer_load_dwordx4 v1, s[44:47], s72 offen offset:1024 sc1 lds
buffer_load_dwordx4 v1, s[44:47], s72 offen offset:2048 sc1 lds
buffer_load_dwordx4 v1, s[44:47], s72 offen offset:3072 sc1 lds
s_add_u32 s81, s81, 0x8000
s_add_u32 m0, s64, 81920
s_add_u32 s72, s81, 16384
buffer_load_dwordx4 v1, s[44:47], s72 offen sc1 lds
buffer_load_dwordx4 v1, s[44:47], s72 offen offset:1024 sc1 lds
buffer_load_dwordx4 v1, s[44:47], s72 offen offset:2048 sc1 lds
buffer_load_dwordx4 v1, s[44:47], s72 offen offset:3072 sc1 lds
s_add_u32 m0, s64, 65536
s_add_u32 s72, s81, 0
buffer_load_dwordx4 v1, s[44:47], s72 offen sc1 lds
buffer_load_dwordx4 v1, s[44:47], s72 offen offset:1024 sc1 lds
buffer_load_dwordx4 v1, s[44:47], s72 offen offset:2048 sc1 lds
buffer_load_dwordx4 v1, s[44:47], s72 offen offset:3072 sc1 lds
s_add_u32 s81, s81, 0x8000
s_add_u32 m0, s64, 114688
s_add_u32 s72, s81, 16384
buffer_load_dwordx4 v1, s[44:47], s72 offen sc1 lds
buffer_load_dwordx4 v1, s[44:47], s72 offen offset:1024 sc1 lds
buffer_load_dwordx4 v1, s[44:47], s72 offen offset:2048 sc1 lds
buffer_load_dwordx4 v1, s[44:47], s72 offen offset:3072 sc1 lds
s_add_u32 m0, s64, 98304
s_add_u32 s72, s81, 0
buffer_load_dwordx4 v1, s[44:47], s72 offen sc1 lds
buffer_load_dwordx4 v1, s[44:47], s72 offen offset:1024 sc1 lds
buffer_load_dwordx4 v1, s[44:47], s72 offen offset:2048 sc1 lds
buffer_load_dwordx4 v1, s[44:47], s72 offen offset:3072 sc1 lds
v_add_u32 v2, 0x8000, v1
v_lshrrev_b32 v3, 1, v0
v_lshlrev_b32 v3, 7, v3
s_waitcnt vmcnt(0)
s_barrier
ds_read_b128 a[128:131], v2 offset:16384
ds_read_b128 a[132:135], v2 offset:17408
ds_read_b128 a[136:139], v2 offset:18432
ds_read_b128 a[140:143], v2 offset:19456
ds_read_b128 a[144:147], v2 offset:20480
ds_read_b128 a[148:151], v2 offset:21504
ds_read_b128 a[152:155], v2 offset:22528
ds_read_b128 a[156:159], v2 offset:23552
s_branch Lattn
Lspin103:
s_mov_b32 s83, 262144
Lsl105:
s_sleep 2
buffer_load_dword v3, v2, s[44:47], s82 offen sc1
s_sub_u32 s83, s83, 1
s_cmp_eq_u32 s83, 0
s_waitcnt vmcnt(0)
s_cbranch_scc1 Lback104
v_cmp_gt_u32 vcc, 2, v3
s_cbranch_vccnz Lsl105
s_branch Lback104
Lspin106:
s_mov_b32 s83, 262144
Lsl108:
s_sleep 2
buffer_load_dword v3, v2, s[44:47], s82 offen sc1
s_sub_u32 s83, s83, 1
s_cmp_eq_u32 s83, 0
s_waitcnt vmcnt(0)
s_cbranch_scc1 Lback107
v_cmp_gt_u32 vcc, 2, v3
s_cbranch_vccnz Lsl108
s_branch Lback107
Lredo0:
s_xor_b32 s82, s78, 0
s_lshl_b32 s82, s82, 10
s_add_u32 s82, s82, s74
buffer_load_dword v3, v2, s[44:47], s82 offen sc1
s_waitcnt vmcnt(0)
v_cmp_gt_u32 vcc, 2, v3
s_cbranch_vccnz Lspin103
Lback104:
s_lshr_b32 s69, s12, 18
s_lshl_b32 s69, s69, 12
s_add_u32 s69, s69, s95
buffer_load_dwordx4 a[0:3], v1, s[44:47], s69 offen sc1
buffer_load_dwordx4 a[4:7], v1, s[44:47], s69 offen offset:1024 sc1
buffer_load_dwordx4 a[8:11], v1, s[44:47], s69 offen offset:2048 sc1
buffer_load_dwordx4 a[12:15], v1, s[44:47], s69 offen offset:3072 sc1
s_add_u32 s69, s69, 0x20000
buffer_load_dwordx4 a[16:19], v1, s[44:47], s69 offen sc1
buffer_load_dwordx4 a[20:23], v1, s[44:47], s69 offen offset:1024 sc1
buffer_load_dwordx4 a[24:27], v1, s[44:47], s69 offen offset:2048 sc1
buffer_load_dwordx4 a[28:31], v1, s[44:47], s69 offen offset:3072 sc1
s_lshr_b32 s69, s13, 18
s_lshl_b32 s69, s69, 12
s_add_u32 s69, s69, s95
buffer_load_dwordx4 a[32:35], v1, s[44:47], s69 offen sc1
buffer_load_dwordx4 a[36:39], v1, s[44:47], s69 offen offset:1024 sc1
buffer_load_dwordx4 a[40:43], v1, s[44:47], s69 offen offset:2048 sc1
buffer_load_dwordx4 a[44:47], v1, s[44:47], s69 offen offset:3072 sc1
s_add_u32 s69, s69, 0x20000
buffer_load_dwordx4 a[48:51], v1, s[44:47], s69 offen sc1
buffer_load_dwordx4 a[52:55], v1, s[44:47], s69 offen offset:1024 sc1
buffer_load_dwordx4 a[56:59], v1, s[44:47], s69 offen offset:2048 sc1
buffer_load_dwordx4 a[60:63], v1, s[44:47], s69 offen offset:3072 sc1
s_waitcnt vmcnt(8)
s_branch Lredo0b
Lspin109:
s_mov_b32 s83, 262144
Lsl111:
s_sleep 2
buffer_load_dword v114, v115, s[44:47], s84 offen sc1
s_sub_u32 s83, s83, 1
s_cmp_eq_u32 s83, 0
s_waitcnt vmcnt(0)
s_cbranch_scc1 Lback110
v_cmp_gt_u32 vcc, 3, v114
s_cbranch_vccnz Lsl111
s_branch Lback110
Lspin112:
s_mov_b32 s83, 262144
Lsl114:
s_sleep 2
buffer_load_dword v14, v13, s[44:47], s79 offen sc1
s_sub_u32 s83, s83, 1
s_cmp_eq_u32 s83, 0
s_waitcnt vmcnt(0)
s_cbranch_scc1 Lback113
v_cmp_gt_u32 vcc, 2, v14
s_cbranch_vccnz Lsl114
s_branch Lback113
Lxspin1:
s_mov_b32 s83, 262144
Lxsl1:
buffer_load_dwordx4 v[96:99], v1, s[44:47], s79 offen sc1
buffer_load_dwordx4 v[100:103], v1, s[44:47], s79 offen offset:1024 sc1
buffer_load_dwordx4 v[104:107], v1, s[44:47], s79 offen offset:2048 sc1
buffer_load_dwordx4 v[108:111], v1, s[44:47], s79 offen offset:3072 sc1
s_sub_u32 s83, s83, 1
s_cmp_eq_u32 s83, 0
s_waitcnt vmcnt(0)
s_cbranch_scc1 Lxback1
v_max3_u32 v12, v96, v97, v98
v_max3_u32 v13, v99, v100, v101
v_max3_u32 v12, v12, v102, v103
v_max3_u32 v13, v13, v104, v105
v_max3_u32 v12, v12, v106, v107
v_max3_u32 v13, v13, v108, v109
v_max3_u32 v12, v12, v110, v111
v_max_u32 v12, v12, v13
v_cmp_le_u32 vcc, 0xff800000, v12
s_cbranch_vccnz Lxsl1
s_branch Lxback1
Lxspin2:
s_mov_b32 s83, 262144
Lxsl2:
buffer_load_dwordx4 v[80:83], v1, s[44:47], s82 offen sc1
buffer_load_dwordx4 v[84:87], v1, s[44:47], s82 offen offset:1024 sc1
buffer_load_dwordx4 v[88:91], v1, s[44:47], s82 offen offset:2048 sc1
buffer_load_dwordx4 v[92:95], v1, s[44:47], s82 offen offset:3072 sc1
s_sub_u32 s83, s83, 1
s_cmp_eq_u32 s83, 0
s_waitcnt vmcnt(0)
s_cbranch_scc1 Lxback2
v_max3_u32 v12, v80, v81, v82
v_max3_u32 v13, v83, v84, v85
v_max3_u32 v12, v12, v86, v87
v_max3_u32 v13, v13, v88, v89
v_max3_u32 v12, v12, v90, v91
v_max3_u32 v13, v13, v92, v93
v_max3_u32 v12, v12, v94, v95
v_max_u32 v12, v12, v13
v_cmp_le_u32 vcc, 0xff800000, v12
s_cbranch_vccnz Lxsl2
s_branch Lxback2
Lxspin3:
s_mov_b32 s83, 262144
Lxsl3:
buffer_load_dwordx4 v[96:99], v1, s[44:47], s81 offen sc1
buffer_load_dwordx4 v[100:103], v1, s[44:47], s81 offen offset:1024 sc1
buffer_load_dwordx4 v[104:107], v1, s[44:47], s81 offen offset:2048 sc1
buffer_load_dwordx4 v[108:111], v1, s[44:47], s81 offen offset:3072 sc1
s_sub_u32 s83, s83, 1
s_cmp_eq_u32 s83, 0
s_waitcnt vmcnt(0)
s_cbranch_scc1 Lxback3
v_max3_u32 v12, v96, v97, v98
v_max3_u32 v13, v99, v100, v101
v_max3_u32 v12, v12, v102, v103
v_max3_u32 v13, v13, v104, v105
v_max3_u32 v12, v12, v106, v107
v_max3_u32 v13, v13, v108, v109
v_max3_u32 v12, v12, v110, v111
v_max_u32 v12, v12, v13
v_cmp_le_u32 vcc, 0xff800000, v12
s_cbranch_vccnz Lxsl3
s_branch Lxback3
Lcode_end:
s_endpgm
.section .rodata,"a"
.p2align 6
.amdhsa_kernel gated_mix__compressed_kv_cla__ssm_conv_h3__prompt_kernel
  .amdhsa_next_free_vgpr 512
  .amdhsa_next_free_sgpr 102
  .amdhsa_accum_offset 256
  .amdhsa_group_segment_fixed_size 0
  .amdhsa_kernarg_size 128
  .amdhsa_user_sgpr_count 2
  .amdhsa_user_sgpr_kernarg_segment_ptr 1
  .amdhsa_system_sgpr_workgroup_id_x 1
  .amdhsa_float_denorm_mode_32 3
.end_amdhsa_kernel
```

```asm
; @launch grid=(256,1,1) block=(256,1,1) lds=163840
.amdgcn_target "amdgcn-amd-amdhsa--gfx950"
.text
.globl gated_mix__compressed_kv_cla__ssm_conv_h3__prompt_kernel
.p2align 8
.type gated_mix__compressed_kv_cla__ssm_conv_h3__prompt_kernel,@function
gated_mix__compressed_kv_cla__ssm_conv_h3__prompt_kernel:
s_cmp_ge_u32 s2, 256
s_cbranch_scc1 Lend
s_load_dwordx2 s[8:9], s[0:1], 8
s_load_dwordx2 s[16:17], s[0:1], 24
s_load_dwordx2 s[20:21], s[0:1], 32
s_load_dwordx2 s[4:5], s[0:1], 0
s_load_dwordx2 s[12:13], s[0:1], 16
s_load_dwordx2 s[24:25], s[0:1], 40
s_load_dwordx2 s[28:29], s[0:1], 56
s_load_dwordx2 s[32:33], s[0:1], 64
s_load_dwordx2 s[52:53], s[0:1], 72
s_load_dwordx2 s[36:37], s[0:1], 80
s_load_dwordx2 s[54:55], s[0:1], 88
s_load_dwordx2 s[56:57], s[0:1], 96
s_load_dwordx2 s[40:41], s[0:1], 104
s_load_dwordx2 s[48:49], s[0:1], 112
s_load_dwordx2 s[44:45], s[0:1], 120
s_getpc_b64 s[98:99]
Lpc0:
s_lshr_b32 s75, s2, 3
v_lshrrev_b32 v26, 3, v0
s_lshl_b32 s73, s75, 12
v_lshlrev_b32 v26, 7, v26
v_add_u32 v26, s73, v26
v_min_u32 v26, Lcode_end-Lpc0, v26
global_load_dword v31, v26, s[98:99]
v_lshrrev_b32 v26, 6, v0
v_and_b32 v0, 63, v0
s_and_b32 s73, s2, 7
v_readfirstlane_b32 s58, v26
s_lshr_b32 s65, s75, 3
s_and_b32 s60, s75, 7
s_lshl_b32 s59, s73, 2
s_add_u32 s59, s59, s65
s_lshl_b32 s61, s65, 1
s_lshl_b32 s63, s58, 13
s_lshl_b32 s64, s58, 12
s_lshl_b32 s67, s60, 18
s_lshl_b32 s76, s58, 16
s_add_u32 s84, s67, s76
s_lshl_b32 s66, s58, 17
s_lshl_b32 s73, s59, 8
s_add_u32 s66, s66, s73
v_lshrrev_b32 v26, 4, v0
v_and_b32 v27, 7, v0
v_xor_b32 v27, v27, v26
v_lshlrev_b32 v27, 4, v27
v_lshrrev_b32 v28, 3, v0
v_lshl_add_u32 v2, v28, 10, v27
v_xor_b32 v3, 64, v2
v_and_b32 v29, 15, v0
v_lshlrev_b32 v30, 1, v26
v_xor_b32 v30, v30, v29
v_lshlrev_b32 v30, 4, v30
v_lshl_add_u32 v6, v26, 13, v30
v_xor_b32 v7, 0x80, v6
s_mov_b32 s10, 0x200000
s_mov_b32 s11, 0x20000
s_mov_b32 s18, 0x400000
s_mov_b32 s19, 0x20000
s_mov_b32 s22, 0x400000
s_mov_b32 s23, 0x20000
s_lshl_b32 s73, s2, 2
s_add_u32 s73, s73, s58
s_lshl_b32 s73, s73, 11
v_lshrrev_b32 v124, 2, v0
v_lshlrev_b32 v124, 7, v124
v_add_u32 v124, s73, v124
s_lshl_b32 s73, s60, 2
s_add_u32 s73, s73, s58
s_lshl_b32 s73, s73, 13
s_lshl_b32 s74, s59, 8
s_add_u32 s73, s73, s74
v_lshrrev_b32 v125, 4, v0
v_lshlrev_b32 v125, 18, v125
v_bfe_u32 v126, v0, 3, 1
v_lshl_add_u32 v125, v126, 7, v125
v_add_u32 v125, s73, v125
s_waitcnt lgkmcnt(0)
s_mov_b32 s80, 0x0
buffer_load_dword v126, v125, s[16:19], s80 offen
buffer_load_dword v126, v125, s[20:23], s80 offen
s_and_b32 s73, s65, 1
s_xor_b32 s73, s73, 0
s_lshl_b32 s69, s73, 7
s_add_u32 s69, s69, s84
s_lshl_b32 s71, s73, 19
s_add_u32 s71, s71, s66
s_add_u32 m0, s63, 65536
s_add_u32 s72, s69, 0
buffer_load_dwordx4 v2, s[8:11], s72 offen lds
s_add_u32 s72, s69, 7168
buffer_load_dwordx4 v3, s[8:11], s72 offen offset:1024 lds
s_add_u32 s72, s69, 14336
buffer_load_dwordx4 v2, s[8:11], s72 offen offset:2048 lds
s_add_u32 s72, s69, 21504
buffer_load_dwordx4 v3, s[8:11], s72 offen offset:3072 lds
s_add_u32 m0, s64, 0
s_add_u32 s72, s71, 0
buffer_load_dwordx4 v6, s[16:19], s72 offen lds
s_add_u32 s72, s71, 31744
buffer_load_dwordx4 v6, s[16:19], s72 offen offset:1024 lds
s_add_u32 s72, s71, 63488
buffer_load_dwordx4 v7, s[16:19], s72 offen offset:2048 lds
s_add_u32 s72, s71, 95232
buffer_load_dwordx4 v7, s[16:19], s72 offen offset:3072 lds
s_add_u32 m0, s63, 69632
s_add_u32 s72, s69, 32768
buffer_load_dwordx4 v2, s[8:11], s72 offen lds
s_add_u32 s72, s69, 39936
buffer_load_dwordx4 v3, s[8:11], s72 offen offset:1024 lds
s_add_u32 s72, s69, 47104
buffer_load_dwordx4 v2, s[8:11], s72 offen offset:2048 lds
s_add_u32 s72, s69, 54272
buffer_load_dwordx4 v3, s[8:11], s72 offen offset:3072 lds
s_add_u32 m0, s64, 16384
s_add_u32 s72, s71, 0
buffer_load_dwordx4 v6, s[20:23], s72 offen lds
s_add_u32 s72, s71, 31744
buffer_load_dwordx4 v6, s[20:23], s72 offen offset:1024 lds
s_add_u32 s72, s71, 63488
buffer_load_dwordx4 v7, s[20:23], s72 offen offset:2048 lds
s_add_u32 s72, s71, 95232
buffer_load_dwordx4 v7, s[20:23], s72 offen offset:3072 lds
buffer_load_dword v126, v124, s[8:11], 0 offen
s_and_b32 s73, s65, 1
s_xor_b32 s73, s73, 1
s_lshl_b32 s69, s73, 7
s_add_u32 s69, s69, s84
s_lshl_b32 s71, s73, 19
s_add_u32 s71, s71, s66
s_add_u32 m0, s63, 98304
s_add_u32 s72, s69, 0
buffer_load_dwordx4 v2, s[8:11], s72 offen lds
s_add_u32 s72, s69, 7168
buffer_load_dwordx4 v3, s[8:11], s72 offen offset:1024 lds
s_add_u32 s72, s69, 14336
buffer_load_dwordx4 v2, s[8:11], s72 offen offset:2048 lds
s_add_u32 s72, s69, 21504
buffer_load_dwordx4 v3, s[8:11], s72 offen offset:3072 lds
s_branch Lmain
.p2align 12
Lmain:
s_mov_b32 s6, 0x400000
s_mov_b32 s7, 0x20000
s_mov_b32 s14, 0x800000
s_mov_b32 s15, 0x20000
s_mov_b32 s26, 0x800000
s_mov_b32 s27, 0x20000
s_mov_b32 s30, 0x400000
s_mov_b32 s31, 0x20000
s_mov_b32 s34, 0x400000
s_mov_b32 s35, 0x20000
s_mov_b32 s38, 0x400000
s_mov_b32 s39, 0x20000
s_mov_b32 s42, 0x400000
s_mov_b32 s43, 0x20000
s_mov_b32 s46, 0x5800000
s_mov_b32 s47, 0x20000
s_mov_b32 s50, 0x100
s_mov_b32 s51, 0x20000
v_lshl_add_u32 v4, v28, 11, v27
v_xor_b32 v5, 64, v4
v_lshlrev_b32 v1, 4, v0
s_sub_u32 s74, 15, s60
s_lshl_b32 s68, s74, 18
s_lshl_b32 s76, s58, 15
s_add_u32 s68, s68, s76
s_add_u32 s67, s67, s76
s_and_b32 s62, s60, 3
s_sub_u32 s62, 16, s62
s_lshl_b32 s91, s59, 3
s_add_u32 s91, s91, s60
s_lshl_b32 s93, s91, 2
s_add_u32 s93, s93, s58
s_lshl_b32 s91, s91, 7
s_add_u32 s91, s91, 0x3810000
s_lshl_b32 s75, s93, 1
s_and_b32 s75, s75, 0xffc
s_lshl_b32 s93, s93, 12
s_load_dwordx2 s[88:89], s[36:37], s93
s_load_dword s90, s[54:55], s75
v_or_b32 v29, s58, v0
v_mov_b32 v30, 0
v_min_u32 v29, 1, v29
v_lshlrev_b32 v29, 30, v29
buffer_store_dword v30, v29, s[44:47], s91 offen sc1
s_and_b32 s73, s2, 15
s_lshr_b32 s74, s2, 4
s_lshl_b32 s74, s74, 7
s_lshl_b32 s75, s58, 5
s_add_u32 s74, s74, s75
s_mov_b32 s75, 131072
v_lshrrev_b32 v29, 5, v0
v_lshlrev_b32 v29, 4, v29
v_add_u32 v29, s74, v29
v_and_b32 v30, 31, v0
s_lshl_b32 s73, s73, 5
v_add_u32 v30, s73, v30
v_lshlrev_b32 v26, 11, v29
v_lshl_add_u32 v26, v30, 2, v26
v_subrev_u32 v27, 0x1800, v26
s_lshl_b32 s82, s74, 11
s_lshl_b32 s73, s73, 2
s_add_u32 s82, s82, s73
v_lshrrev_b32 v26, 3, v0
v_and_b32 v32, 7, v0
v_lshlrev_b32 v32, 4, v32
v_lshl_add_u32 v26, v26, 11, v32
v_lshrrev_b32 v98, 5, v0
v_lshlrev_b32 v98, 11, v98
v_and_b32 v32, 31, v0
v_lshl_add_u32 v98, v32, 2, v98
v_add_u32 v98, s63, v98
v_add_u32 v98, s75, v98
v_and_b32 v29, 0x7f, v29
v_sub_u32 v29, 0x70, v29
v_lshlrev_b32 v29, 1, v29
v_and_b32 v32, 31, v0
v_mul_u32_u24 v32, 544, v32
v_add3_u32 v28, v32, v29, s75
v_lshlrev_b32 v30, 4, v30
s_lshl_b32 s73, s2, 14
s_lshl_b32 s74, s58, 12
s_add_u32 s76, s73, s74
v_and_b32 v29, 15, v0
v_lshrrev_b32 v32, 4, v0
v_lshrrev_b32 v24, 1, v29
v_xor_b32 v24, v24, v32
v_lshlrev_b32 v24, 4, v24
v_lshl_add_u32 v24, v29, 7, v24
s_add_u32 s73, s63, 131072
v_add_u32 v16, s73, v24
v_xor_b32 v17, 64, v16
v_subrev_u32 v18, 0x10000, v16
v_subrev_u32 v19, 0x10000, v17
s_lshr_b32 s73, s58, 1
s_lshl_b32 s74, s73, 14
s_add_u32 s74, s74, 0x10000
v_add_u32 v24, s74, v24
v_xor_b32 v25, 64, v24
v_lshrrev_b32 v8, 2, v29
v_and_b32 v9, 1, v32
v_lshl_add_u32 v9, v9, 2, v8
v_lshl_add_u32 v8, v32, 3, v8
v_lshlrev_b32 v8, 8, v8
v_lshl_add_u32 v8, v9, 5, v8
v_and_b32 v29, 3, v0
v_lshl_add_u32 v8, v29, 3, v8
s_and_b32 s74, s58, 1
s_lshl_b32 s75, s74, 7
v_xor_b32 v20, s75, v8
v_xor_b32 v9, 32, v8
v_xor_b32 v10, 64, v8
v_xor_b32 v11, 96, v8
v_xor_b32 v12, 128, v8
v_xor_b32 v13, 160, v8
v_xor_b32 v14, 192, v8
v_xor_b32 v15, 224, v8
v_xor_b32 v21, 32, v20
v_xor_b32 v22, 64, v20
v_xor_b32 v23, 96, v20
s_lshl_b32 s77, s59, 20
s_add_u32 s81, s77, s64
s_sub_u32 s81, s81, 0x4000
s_lshl_b32 s75, s60, 17
s_add_u32 s77, s77, s75
s_lshl_b32 s73, s73, 16
s_add_u32 s77, s77, s73
s_lshl_b32 s75, s74, 12
s_add_u32 s78, s77, s75
s_add_u32 s78, s78, 0x4000
s_lshl_b32 s75, s74, 11
s_add_u32 s77, s77, s75
s_mov_b32 s79, 0x3e0293ee
s_waitcnt vmcnt(6)
s_barrier
ds_read_b64_tr_b16 v[224:225], v20 offset:0
ds_read_b64_tr_b16 v[226:227], v20 offset:1024
ds_read_b64_tr_b16 v[228:229], v20 offset:8192
ds_read_b64_tr_b16 v[230:231], v20 offset:9216
ds_read_b128 v[128:131], v24 offset:0
ds_read_b128 v[132:135], v25 offset:0
ds_read_b128 v[136:139], v24 offset:2048
ds_read_b128 v[140:143], v25 offset:2048
ds_read_b128 v[144:147], v24 offset:4096
ds_read_b128 v[148:151], v25 offset:4096
ds_read_b128 v[152:155], v24 offset:6144
ds_read_b128 v[156:159], v25 offset:6144
ds_read_b128 v[160:163], v24 offset:8192
ds_read_b128 v[164:167], v25 offset:8192
ds_read_b128 v[168:171], v24 offset:10240
ds_read_b128 v[172:175], v25 offset:10240
ds_read_b128 v[176:179], v24 offset:12288
ds_read_b128 v[180:183], v25 offset:12288
ds_read_b128 v[184:187], v24 offset:14336
ds_read_b128 v[188:191], v25 offset:14336
ds_read_b64_tr_b16 v[232:233], v21 offset:0
ds_read_b64_tr_b16 v[234:235], v21 offset:1024
ds_read_b64_tr_b16 v[236:237], v21 offset:8192
ds_read_b64_tr_b16 v[238:239], v21 offset:9216
s_waitcnt lgkmcnt(0)
v_mfma_f32_16x16x32_bf16 a[0:3], v[224:227], v[128:131], 0
s_add_u32 m0, s64, 32768
ds_read_b64_tr_b16 v[240:241], v22 offset:0
v_mfma_f32_16x16x32_bf16 a[0:3], v[228:231], v[132:135], a[0:3]
s_add_u32 s72, s71, 0
buffer_load_dwordx4 v6, s[16:19], s72 offen lds
v_mfma_f32_16x16x32_bf16 a[4:7], v[228:231], v[140:143], 0
s_add_u32 s72, s71, 31744
buffer_load_dwordx4 v6, s[16:19], s72 offen offset:1024 lds
v_mfma_f32_16x16x32_bf16 a[4:7], v[224:227], v[136:139], a[4:7]
ds_read_b64_tr_b16 v[242:243], v22 offset:1024
v_mfma_f32_16x16x32_bf16 a[8:11], v[224:227], v[144:147], 0
s_add_u32 s72, s71, 63488
buffer_load_dwordx4 v7, s[16:19], s72 offen offset:2048 lds
v_mfma_f32_16x16x32_bf16 a[8:11], v[228:231], v[148:151], a[8:11]
v_mfma_f32_16x16x32_bf16 a[12:15], v[228:231], v[156:159], 0
s_add_u32 s72, s71, 95232
buffer_load_dwordx4 v7, s[16:19], s72 offen offset:3072 lds
v_mfma_f32_16x16x32_bf16 a[12:15], v[224:227], v[152:155], a[12:15]
ds_read_b64_tr_b16 v[244:245], v22 offset:8192
v_mfma_f32_16x16x32_bf16 a[16:19], v[224:227], v[160:163], 0
s_add_u32 m0, s63, 102400
v_mfma_f32_16x16x32_bf16 a[16:19], v[228:231], v[164:167], a[16:19]
s_add_u32 s72, s69, 32768
buffer_load_dwordx4 v2, s[8:11], s72 offen lds
v_mfma_f32_16x16x32_bf16 a[20:23], v[228:231], v[172:175], 0
s_add_u32 s72, s69, 39936
buffer_load_dwordx4 v3, s[8:11], s72 offen offset:1024 lds
v_mfma_f32_16x16x32_bf16 a[20:23], v[224:227], v[168:171], a[20:23]
ds_read_b64_tr_b16 v[246:247], v22 offset:9216
v_mfma_f32_16x16x32_bf16 a[24:27], v[224:227], v[176:179], 0
s_add_u32 s72, s69, 47104
buffer_load_dwordx4 v2, s[8:11], s72 offen offset:2048 lds
v_mfma_f32_16x16x32_bf16 a[24:27], v[228:231], v[180:183], a[24:27]
v_mfma_f32_16x16x32_bf16 a[28:31], v[228:231], v[188:191], 0
s_add_u32 s72, s69, 54272
buffer_load_dwordx4 v3, s[8:11], s72 offen offset:3072 lds
v_mfma_f32_16x16x32_bf16 a[28:31], v[224:227], v[184:187], a[28:31]
v_mfma_f32_16x16x32_bf16 a[60:63], v[232:235], v[184:187], 0
s_add_u32 m0, s64, 49152
ds_read_b64_tr_b16 v[248:249], v23 offset:0
v_mfma_f32_16x16x32_bf16 a[60:63], v[236:239], v[188:191], a[60:63]
s_add_u32 s72, s71, 0
buffer_load_dwordx4 v6, s[20:23], s72 offen lds
v_mfma_f32_16x16x32_bf16 a[56:59], v[236:239], v[180:183], 0
s_add_u32 s72, s71, 31744
buffer_load_dwordx4 v6, s[20:23], s72 offen offset:1024 lds
v_mfma_f32_16x16x32_bf16 a[56:59], v[232:235], v[176:179], a[56:59]
v_mfma_f32_16x16x32_bf16 a[52:55], v[232:235], v[168:171], 0
s_add_u32 s72, s71, 63488
buffer_load_dwordx4 v7, s[20:23], s72 offen offset:2048 lds
v_mfma_f32_16x16x32_bf16 a[52:55], v[236:239], v[172:175], a[52:55]
ds_read_b64_tr_b16 v[250:251], v23 offset:1024
v_mfma_f32_16x16x32_bf16 a[48:51], v[236:239], v[164:167], 0
s_add_u32 s72, s71, 95232
buffer_load_dwordx4 v7, s[20:23], s72 offen offset:3072 lds
v_mfma_f32_16x16x32_bf16 a[48:51], v[232:235], v[160:163], a[48:51]
s_mov_b32 s80, 0x100000
buffer_load_dword v126, v125, s[16:19], s80 offen
v_mfma_f32_16x16x32_bf16 a[44:47], v[232:235], v[152:155], 0
buffer_load_dword v126, v125, s[20:23], s80 offen
v_mfma_f32_16x16x32_bf16 a[44:47], v[236:239], v[156:159], a[44:47]
v_mfma_f32_16x16x32_bf16 a[40:43], v[236:239], v[148:151], 0
ds_read_b64_tr_b16 v[252:253], v23 offset:8192
v_mfma_f32_16x16x32_bf16 a[40:43], v[232:235], v[144:147], a[40:43]
v_mfma_f32_16x16x32_bf16 a[36:39], v[232:235], v[136:139], 0
ds_read_b64_tr_b16 v[254:255], v23 offset:9216
v_mfma_f32_16x16x32_bf16 a[36:39], v[236:239], v[140:143], a[36:39]
v_mfma_f32_16x16x32_bf16 a[32:35], v[236:239], v[132:135], 0
v_mfma_f32_16x16x32_bf16 a[32:35], v[232:235], v[128:131], a[32:35]
s_waitcnt lgkmcnt(4)
v_mfma_f32_16x16x32_bf16 a[64:67], v[240:243], v[128:131], 0
ds_read_b64_tr_b16 v[224:225], v20 offset:16384
v_mfma_f32_16x16x32_bf16 a[64:67], v[244:247], v[132:135], a[64:67]
v_mfma_f32_16x16x32_bf16 a[68:71], v[244:247], v[140:143], 0
v_mfma_f32_16x16x32_bf16 a[68:71], v[240:243], v[136:139], a[68:71]
ds_read_b64_tr_b16 v[226:227], v20 offset:17408
v_mfma_f32_16x16x32_bf16 a[72:75], v[240:243], v[144:147], 0
v_mfma_f32_16x16x32_bf16 a[72:75], v[244:247], v[148:151], a[72:75]
v_mfma_f32_16x16x32_bf16 a[76:79], v[244:247], v[156:159], 0
v_mfma_f32_16x16x32_bf16 a[76:79], v[240:243], v[152:155], a[76:79]
ds_read_b64_tr_b16 v[228:229], v20 offset:24576
v_mfma_f32_16x16x32_bf16 a[80:83], v[240:243], v[160:163], 0
v_mfma_f32_16x16x32_bf16 a[80:83], v[244:247], v[164:167], a[80:83]
v_mfma_f32_16x16x32_bf16 a[84:87], v[244:247], v[172:175], 0
ds_read_b64_tr_b16 v[230:231], v20 offset:25600
v_mfma_f32_16x16x32_bf16 a[84:87], v[240:243], v[168:171], a[84:87]
v_mfma_f32_16x16x32_bf16 a[88:91], v[240:243], v[176:179], 0
v_mfma_f32_16x16x32_bf16 a[88:91], v[244:247], v[180:183], a[88:91]
v_mfma_f32_16x16x32_bf16 a[92:95], v[244:247], v[188:191], 0
v_mfma_f32_16x16x32_bf16 a[92:95], v[240:243], v[184:187], a[92:95]
s_waitcnt lgkmcnt(4)
v_mfma_f32_16x16x32_bf16 a[124:127], v[248:251], v[184:187], 0
ds_read_b64_tr_b16 v[232:233], v21 offset:16384
v_mfma_f32_16x16x32_bf16 a[124:127], v[252:255], v[188:191], a[124:127]
v_mfma_f32_16x16x32_bf16 a[120:123], v[252:255], v[180:183], 0
v_mfma_f32_16x16x32_bf16 a[120:123], v[248:251], v[176:179], a[120:123]
ds_read_b64_tr_b16 v[234:235], v21 offset:17408
v_mfma_f32_16x16x32_bf16 a[116:119], v[248:251], v[168:171], 0
v_mfma_f32_16x16x32_bf16 a[116:119], v[252:255], v[172:175], a[116:119]
v_mfma_f32_16x16x32_bf16 a[112:115], v[252:255], v[164:167], 0
v_mfma_f32_16x16x32_bf16 a[112:115], v[248:251], v[160:163], a[112:115]
ds_read_b64_tr_b16 v[236:237], v21 offset:24576
v_mfma_f32_16x16x32_bf16 a[108:111], v[248:251], v[152:155], 0
v_mfma_f32_16x16x32_bf16 a[108:111], v[252:255], v[156:159], a[108:111]
v_mfma_f32_16x16x32_bf16 a[104:107], v[252:255], v[148:151], 0
ds_read_b64_tr_b16 v[238:239], v21 offset:25600
v_mfma_f32_16x16x32_bf16 a[104:107], v[248:251], v[144:147], a[104:107]
v_mfma_f32_16x16x32_bf16 a[100:103], v[248:251], v[136:139], 0
v_mfma_f32_16x16x32_bf16 a[100:103], v[252:255], v[140:143], a[100:103]
v_mfma_f32_16x16x32_bf16 a[96:99], v[252:255], v[132:135], 0
v_mfma_f32_16x16x32_bf16 a[96:99], v[248:251], v[128:131], a[96:99]
s_waitcnt lgkmcnt(4)
v_mfma_f32_16x16x32_bf16 a[128:131], v[128:131], v[224:227], 0
ds_read_b64_tr_b16 v[240:241], v22 offset:16384
v_mfma_f32_16x16x32_bf16 a[128:131], v[132:135], v[228:231], a[128:131]
v_mfma_f32_16x16x32_bf16 a[132:135], v[140:143], v[228:231], 0
v_mfma_f32_16x16x32_bf16 a[132:135], v[136:139], v[224:227], a[132:135]
ds_read_b64_tr_b16 v[242:243], v22 offset:17408
v_mfma_f32_16x16x32_bf16 a[136:139], v[144:147], v[224:227], 0
v_mfma_f32_16x16x32_bf16 a[136:139], v[148:151], v[228:231], a[136:139]
v_mfma_f32_16x16x32_bf16 a[140:143], v[156:159], v[228:231], 0
v_mfma_f32_16x16x32_bf16 a[140:143], v[152:155], v[224:227], a[140:143]
ds_read_b64_tr_b16 v[244:245], v22 offset:24576
v_mfma_f32_16x16x32_bf16 a[144:147], v[160:163], v[224:227], 0
v_mfma_f32_16x16x32_bf16 a[144:147], v[164:167], v[228:231], a[144:147]
v_mfma_f32_16x16x32_bf16 a[148:151], v[172:175], v[228:231], 0
ds_read_b64_tr_b16 v[246:247], v22 offset:25600
v_mfma_f32_16x16x32_bf16 a[148:151], v[168:171], v[224:227], a[148:151]
v_mfma_f32_16x16x32_bf16 a[152:155], v[176:179], v[224:227], 0
v_mfma_f32_16x16x32_bf16 a[152:155], v[180:183], v[228:231], a[152:155]
v_mfma_f32_16x16x32_bf16 a[156:159], v[188:191], v[228:231], 0
v_mfma_f32_16x16x32_bf16 a[156:159], v[184:187], v[224:227], a[156:159]
s_waitcnt lgkmcnt(4)
v_mfma_f32_16x16x32_bf16 a[188:191], v[184:187], v[232:235], 0
ds_read_b64_tr_b16 v[248:249], v23 offset:16384
v_mfma_f32_16x16x32_bf16 a[188:191], v[188:191], v[236:239], a[188:191]
v_mfma_f32_16x16x32_bf16 a[184:187], v[180:183], v[236:239], 0
ds_read_b64_tr_b16 v[250:251], v23 offset:17408
v_mfma_f32_16x16x32_bf16 a[184:187], v[176:179], v[232:235], a[184:187]
v_mfma_f32_16x16x32_bf16 a[180:183], v[168:171], v[232:235], 0
ds_read_b64_tr_b16 v[252:253], v23 offset:24576
v_mfma_f32_16x16x32_bf16 a[180:183], v[172:175], v[236:239], a[180:183]
v_mfma_f32_16x16x32_bf16 a[176:179], v[164:167], v[236:239], 0
ds_read_b64_tr_b16 v[254:255], v23 offset:25600
v_mfma_f32_16x16x32_bf16 a[176:179], v[160:163], v[232:235], a[176:179]
v_mfma_f32_16x16x32_bf16 a[172:175], v[152:155], v[232:235], 0
v_mfma_f32_16x16x32_bf16 a[172:175], v[156:159], v[236:239], a[172:175]
v_mfma_f32_16x16x32_bf16 a[168:171], v[148:151], v[236:239], 0
v_mfma_f32_16x16x32_bf16 a[168:171], v[144:147], v[232:235], a[168:171]
v_mfma_f32_16x16x32_bf16 a[164:167], v[136:139], v[232:235], 0
v_mfma_f32_16x16x32_bf16 a[164:167], v[140:143], v[236:239], a[164:167]
s_nop 3
s_mov_b64 exec, 0
s_cmp_eq_u32 s58, 0
s_cbranch_scc1 Lstub0
s_cmp_eq_u32 s58, 1
s_cbranch_scc1 Lstub1
s_cmp_eq_u32 s58, 2
s_cbranch_scc1 Lstub2
s_branch Lstub3
Lret:
s_mov_b64 exec, -1
s_nop 3
v_mfma_f32_16x16x32_bf16 a[160:163], v[132:135], v[236:239], 0
s_waitcnt vmcnt(2) lgkmcnt(0)
v_mfma_f32_16x16x32_bf16 a[160:163], v[128:131], v[232:235], a[160:163]
s_barrier
v_mfma_f32_16x16x32_bf16 a[192:195], v[128:131], v[240:243], 0
s_and_b32 s73, s65, 1
ds_read_b64_tr_b16 v[224:225], v20 offset:32768
v_mfma_f32_16x16x32_bf16 a[192:195], v[132:135], v[244:247], a[192:195]
s_xor_b32 s73, s73, 2
ds_read_b64_tr_b16 v[226:227], v20 offset:33792
v_mfma_f32_16x16x32_bf16 a[196:199], v[140:143], v[244:247], 0
s_lshl_b32 s69, s73, 7
ds_read_b64_tr_b16 v[228:229], v20 offset:40960
v_mfma_f32_16x16x32_bf16 a[196:199], v[136:139], v[240:243], a[196:199]
s_add_u32 s69, s69, s84
ds_read_b64_tr_b16 v[230:231], v20 offset:41984
v_mfma_f32_16x16x32_bf16 a[200:203], v[144:147], v[240:243], 0
s_lshl_b32 s71, s73, 19
ds_read_b128 v[192:195], v24 offset:32768
v_mfma_f32_16x16x32_bf16 a[200:203], v[148:151], v[244:247], a[200:203]
s_add_u32 s71, s71, s66
ds_read_b128 v[196:199], v25 offset:32768
v_mfma_f32_16x16x32_bf16 a[204:207], v[156:159], v[244:247], 0
s_add_u32 m0, s63, 65536
v_mfma_f32_16x16x32_bf16 a[204:207], v[152:155], v[240:243], a[204:207]
s_add_u32 s72, s69, 0
buffer_load_dwordx4 v2, s[8:11], s72 offen lds
v_mfma_f32_16x16x32_bf16 a[208:211], v[160:163], v[240:243], 0
s_add_u32 s72, s69, 7168
buffer_load_dwordx4 v3, s[8:11], s72 offen offset:1024 lds
v_mfma_f32_16x16x32_bf16 a[208:211], v[164:167], v[244:247], a[208:211]
s_add_u32 s72, s69, 14336
buffer_load_dwordx4 v2, s[8:11], s72 offen offset:2048 lds
v_mfma_f32_16x16x32_bf16 a[212:215], v[172:175], v[244:247], 0
ds_read_b128 v[200:203], v24 offset:34816
v_mfma_f32_16x16x32_bf16 a[212:215], v[168:171], v[240:243], a[212:215]
ds_read_b128 v[204:207], v25 offset:34816
v_mfma_f32_16x16x32_bf16 a[216:219], v[176:179], v[240:243], 0
s_add_u32 s72, s69, 21504
buffer_load_dwordx4 v3, s[8:11], s72 offen offset:3072 lds
v_mfma_f32_16x16x32_bf16 a[216:219], v[180:183], v[244:247], a[216:219]
ds_read_b128 v[208:211], v24 offset:36864
v_mfma_f32_16x16x32_bf16 a[220:223], v[188:191], v[244:247], 0
ds_read_b128 v[212:215], v25 offset:36864
v_mfma_f32_16x16x32_bf16 a[220:223], v[184:187], v[240:243], a[220:223]
ds_read_b128 v[216:219], v24 offset:38912
v_mfma_f32_16x16x32_bf16 a[252:255], v[184:187], v[248:251], 0
ds_read_b128 v[220:223], v25 offset:38912
v_mfma_f32_16x16x32_bf16 a[252:255], v[188:191], v[252:255], a[252:255]
s_add_u32 m0, s64, 0
v_mfma_f32_16x16x32_bf16 a[248:251], v[180:183], v[252:255], 0
s_add_u32 s72, s71, 0
buffer_load_dwordx4 v6, s[16:19], s72 offen lds
v_mfma_f32_16x16x32_bf16 a[248:251], v[176:179], v[248:251], a[248:251]
ds_read_b128 v[184:187], v24 offset:40960
v_mfma_f32_16x16x32_bf16 a[244:247], v[168:171], v[248:251], 0
ds_read_b128 v[188:191], v25 offset:40960
v_mfma_f32_16x16x32_bf16 a[244:247], v[172:175], v[252:255], a[244:247]
s_add_u32 s72, s71, 31744
buffer_load_dwordx4 v6, s[16:19], s72 offen offset:1024 lds
v_mfma_f32_16x16x32_bf16 a[240:243], v[164:167], v[252:255], 0
ds_read_b128 v[176:179], v24 offset:43008
v_mfma_f32_16x16x32_bf16 a[240:243], v[160:163], v[248:251], a[240:243]
ds_read_b128 v[180:183], v25 offset:43008
v_mfma_f32_16x16x32_bf16 a[236:239], v[152:155], v[248:251], 0
ds_read_b128 v[168:171], v24 offset:45056
v_mfma_f32_16x16x32_bf16 a[236:239], v[156:159], v[252:255], a[236:239]
s_add_u32 s72, s71, 63488
buffer_load_dwordx4 v7, s[16:19], s72 offen offset:2048 lds
v_mfma_f32_16x16x32_bf16 a[232:235], v[148:151], v[252:255], 0
ds_read_b128 v[172:175], v25 offset:45056
v_mfma_f32_16x16x32_bf16 a[232:235], v[144:147], v[248:251], a[232:235]
ds_read_b128 v[160:163], v24 offset:47104
v_mfma_f32_16x16x32_bf16 a[228:231], v[136:139], v[248:251], 0
ds_read_b128 v[164:167], v25 offset:47104
v_mfma_f32_16x16x32_bf16 a[228:231], v[140:143], v[252:255], a[228:231]
v_mfma_f32_16x16x32_bf16 a[224:227], v[132:135], v[252:255], 0
s_add_u32 s72, s71, 95232
buffer_load_dwordx4 v7, s[16:19], s72 offen offset:3072 lds
v_mfma_f32_16x16x32_bf16 a[224:227], v[128:131], v[248:251], a[224:227]
s_waitcnt lgkmcnt(8)
ds_read_b64_tr_b16 v[232:233], v21 offset:32768
v_mfma_f32_16x16x32_bf16 a[0:3], v[224:227], v[192:195], a[0:3]
ds_read_b64_tr_b16 v[234:235], v21 offset:33792
v_mfma_f32_16x16x32_bf16 a[0:3], v[228:231], v[196:199], a[0:3]
ds_read_b64_tr_b16 v[240:241], v22 offset:32768
v_mfma_f32_16x16x32_bf16 a[4:7], v[228:231], v[204:207], a[4:7]
s_add_u32 m0, s63, 69632
ds_read_b64_tr_b16 v[236:237], v21 offset:40960
v_mfma_f32_16x16x32_bf16 a[4:7], v[224:227], v[200:203], a[4:7]
s_add_u32 s72, s69, 32768
buffer_load_dwordx4 v2, s[8:11], s72 offen lds
v_mfma_f32_16x16x32_bf16 a[8:11], v[224:227], v[208:211], a[8:11]
ds_read_b64_tr_b16 v[238:239], v21 offset:41984
v_mfma_f32_16x16x32_bf16 a[8:11], v[228:231], v[212:215], a[8:11]
v_mfma_f32_16x16x32_bf16 a[12:15], v[228:231], v[220:223], a[12:15]
s_add_u32 s72, s69, 39936
buffer_load_dwordx4 v3, s[8:11], s72 offen offset:1024 lds
v_mfma_f32_16x16x32_bf16 a[12:15], v[224:227], v[216:219], a[12:15]
s_waitcnt lgkmcnt(5)
ds_read_b64_tr_b16 v[242:243], v22 offset:33792
v_mfma_f32_16x16x32_bf16 a[16:19], v[224:227], v[184:187], a[16:19]
v_mfma_f32_16x16x32_bf16 a[16:19], v[228:231], v[188:191], a[16:19]
ds_read_b64_tr_b16 v[244:245], v22 offset:40960
v_mfma_f32_16x16x32_bf16 a[20:23], v[228:231], v[180:183], a[20:23]
v_mfma_f32_16x16x32_bf16 a[20:23], v[224:227], v[176:179], a[20:23]
s_add_u32 s72, s69, 47104
buffer_load_dwordx4 v2, s[8:11], s72 offen offset:2048 lds
v_mfma_f32_16x16x32_bf16 a[24:27], v[224:227], v[168:171], a[24:27]
ds_read_b64_tr_b16 v[246:247], v22 offset:41984
v_mfma_f32_16x16x32_bf16 a[24:27], v[228:231], v[172:175], a[24:27]
v_mfma_f32_16x16x32_bf16 a[28:31], v[228:231], v[164:167], a[28:31]
v_mfma_f32_16x16x32_bf16 a[28:31], v[224:227], v[160:163], a[28:31]
s_waitcnt lgkmcnt(3)
v_mfma_f32_16x16x32_bf16 a[60:63], v[232:235], v[160:163], a[60:63]
s_add_u32 s72, s69, 54272
buffer_load_dwordx4 v3, s[8:11], s72 offen offset:3072 lds
v_mfma_f32_16x16x32_bf16 a[60:63], v[236:239], v[164:167], a[60:63]
ds_read_b64_tr_b16 v[248:249], v23 offset:32768
v_mfma_f32_16x16x32_bf16 a[56:59], v[236:239], v[172:175], a[56:59]
v_mfma_f32_16x16x32_bf16 a[56:59], v[232:235], v[168:171], a[56:59]
s_add_u32 m0, s64, 16384
ds_read_b64_tr_b16 v[250:251], v23 offset:33792
v_mfma_f32_16x16x32_bf16 a[52:55], v[232:235], v[176:179], a[52:55]
s_add_u32 s72, s71, 0
buffer_load_dwordx4 v6, s[20:23], s72 offen lds
v_mfma_f32_16x16x32_bf16 a[52:55], v[236:239], v[180:183], a[52:55]
v_mfma_f32_16x16x32_bf16 a[48:51], v[236:239], v[188:191], a[48:51]
v_mfma_f32_16x16x32_bf16 a[48:51], v[232:235], v[184:187], a[48:51]
ds_read_b64_tr_b16 v[252:253], v23 offset:40960
v_mfma_f32_16x16x32_bf16 a[44:47], v[232:235], v[216:219], a[44:47]
s_add_u32 s72, s71, 31744
buffer_load_dwordx4 v6, s[20:23], s72 offen offset:1024 lds
v_mfma_f32_16x16x32_bf16 a[44:47], v[236:239], v[220:223], a[44:47]
v_mfma_f32_16x16x32_bf16 a[40:43], v[236:239], v[212:215], a[40:43]
ds_read_b64_tr_b16 v[254:255], v23 offset:41984
v_mfma_f32_16x16x32_bf16 a[40:43], v[232:235], v[208:211], a[40:43]
v_mfma_f32_16x16x32_bf16 a[36:39], v[232:235], v[200:203], a[36:39]
s_add_u32 s72, s71, 63488
buffer_load_dwordx4 v7, s[20:23], s72 offen offset:2048 lds
v_mfma_f32_16x16x32_bf16 a[36:39], v[236:239], v[204:207], a[36:39]
v_mfma_f32_16x16x32_bf16 a[32:35], v[236:239], v[196:199], a[32:35]
v_mfma_f32_16x16x32_bf16 a[32:35], v[232:235], v[192:195], a[32:35]
s_waitcnt lgkmcnt(4)
v_mfma_f32_16x16x32_bf16 a[64:67], v[240:243], v[192:195], a[64:67]
s_add_u32 s72, s71, 95232
buffer_load_dwordx4 v7, s[20:23], s72 offen offset:3072 lds
v_mfma_f32_16x16x32_bf16 a[64:67], v[244:247], v[196:199], a[64:67]
s_mov_b32 s80, 0x200000
buffer_load_dword v126, v125, s[16:19], s80 offen
v_mfma_f32_16x16x32_bf16 a[68:71], v[244:247], v[204:207], a[68:71]
buffer_load_dword v126, v125, s[20:23], s80 offen
v_mfma_f32_16x16x32_bf16 a[68:71], v[240:243], v[200:203], a[68:71]
global_load_dwordx4 v[68:71], v30, s[52:53]
v_mfma_f32_16x16x32_bf16 a[72:75], v[240:243], v[208:211], a[72:75]
buffer_load_dword v33, v27, s[28:31], 0 offen nt
v_mfma_f32_16x16x32_bf16 a[72:75], v[244:247], v[212:215], a[72:75]
buffer_load_dword v34, v27, s[28:31], 0 offen offset:2048 nt
v_mfma_f32_16x16x32_bf16 a[76:79], v[244:247], v[220:223], a[76:79]
v_add_u32 v27, 0x1000, v27
v_mfma_f32_16x16x32_bf16 a[76:79], v[240:243], v[216:219], a[76:79]
buffer_load_dword v35, v27, s[28:31], 0 offen nt
v_mfma_f32_16x16x32_bf16 a[80:83], v[240:243], v[184:187], a[80:83]
s_add_u32 m0, s63, 131072
ds_read_b64_tr_b16 v[224:225], v20 offset:49152
ds_read_b64_tr_b16 v[226:227], v20 offset:50176
v_mfma_f32_16x16x32_bf16 a[80:83], v[244:247], v[188:191], a[80:83]
s_add_u32 s80, s82, 0
buffer_load_dwordx4 v26, s[28:31], s80 offen nt lds
v_mfma_f32_16x16x32_bf16 a[84:87], v[244:247], v[180:183], a[84:87]
s_add_u32 s80, s82, 15360
buffer_load_dwordx4 v26, s[28:31], s80 offen offset:1024 nt lds
v_mfma_f32_16x16x32_bf16 a[84:87], v[240:243], v[176:179], a[84:87]
s_add_u32 s80, s82, 30720
buffer_load_dwordx4 v26, s[28:31], s80 offen offset:2048 nt lds
v_mfma_f32_16x16x32_bf16 a[88:91], v[240:243], v[168:171], a[88:91]
s_add_u32 s80, s82, 46080
buffer_load_dwordx4 v26, s[28:31], s80 offen offset:3072 nt lds
v_mfma_f32_16x16x32_bf16 a[88:91], v[244:247], v[172:175], a[88:91]
ds_read_b64_tr_b16 v[228:229], v20 offset:57344
ds_read_b64_tr_b16 v[230:231], v20 offset:58368
v_mfma_f32_16x16x32_bf16 a[92:95], v[244:247], v[164:167], a[92:95]
v_mfma_f32_16x16x32_bf16 a[92:95], v[240:243], v[160:163], a[92:95]
s_waitcnt lgkmcnt(4)
v_mfma_f32_16x16x32_bf16 a[124:127], v[248:251], v[160:163], a[124:127]
ds_read_b64_tr_b16 v[232:233], v21 offset:49152
v_mfma_f32_16x16x32_bf16 a[124:127], v[252:255], v[164:167], a[124:127]
v_mfma_f32_16x16x32_bf16 a[120:123], v[252:255], v[172:175], a[120:123]
v_mfma_f32_16x16x32_bf16 a[120:123], v[248:251], v[168:171], a[120:123]
ds_read_b64_tr_b16 v[234:235], v21 offset:50176
v_mfma_f32_16x16x32_bf16 a[116:119], v[248:251], v[176:179], a[116:119]
v_mfma_f32_16x16x32_bf16 a[116:119], v[252:255], v[180:183], a[116:119]
v_mfma_f32_16x16x32_bf16 a[112:115], v[252:255], v[188:191], a[112:115]
v_mfma_f32_16x16x32_bf16 a[112:115], v[248:251], v[184:187], a[112:115]
ds_read_b64_tr_b16 v[236:237], v21 offset:57344
v_mfma_f32_16x16x32_bf16 a[108:111], v[248:251], v[216:219], a[108:111]
v_mfma_f32_16x16x32_bf16 a[108:111], v[252:255], v[220:223], a[108:111]
v_mfma_f32_16x16x32_bf16 a[104:107], v[252:255], v[212:215], a[104:107]
ds_read_b64_tr_b16 v[238:239], v21 offset:58368
v_mfma_f32_16x16x32_bf16 a[104:107], v[248:251], v[208:211], a[104:107]
v_mfma_f32_16x16x32_bf16 a[100:103], v[248:251], v[200:203], a[100:103]
v_mfma_f32_16x16x32_bf16 a[100:103], v[252:255], v[204:207], a[100:103]
v_mfma_f32_16x16x32_bf16 a[96:99], v[252:255], v[196:199], a[96:99]
v_mfma_f32_16x16x32_bf16 a[96:99], v[248:251], v[192:195], a[96:99]
s_waitcnt lgkmcnt(4)
v_mfma_f32_16x16x32_bf16 a[128:131], v[192:195], v[224:227], a[128:131]
ds_read_b64_tr_b16 v[240:241], v22 offset:49152
v_mfma_f32_16x16x32_bf16 a[128:131], v[196:199], v[228:231], a[128:131]
v_mfma_f32_16x16x32_bf16 a[132:135], v[204:207], v[228:231], a[132:135]
v_mfma_f32_16x16x32_bf16 a[132:135], v[200:203], v[224:227], a[132:135]
ds_read_b64_tr_b16 v[242:243], v22 offset:50176
v_mfma_f32_16x16x32_bf16 a[136:139], v[208:211], v[224:227], a[136:139]
v_mfma_f32_16x16x32_bf16 a[136:139], v[212:215], v[228:231], a[136:139]
v_mfma_f32_16x16x32_bf16 a[140:143], v[220:223], v[228:231], a[140:143]
v_mfma_f32_16x16x32_bf16 a[140:143], v[216:219], v[224:227], a[140:143]
ds_read_b64_tr_b16 v[244:245], v22 offset:57344
v_mfma_f32_16x16x32_bf16 a[144:147], v[184:187], v[224:227], a[144:147]
v_mfma_f32_16x16x32_bf16 a[144:147], v[188:191], v[228:231], a[144:147]
v_mfma_f32_16x16x32_bf16 a[148:151], v[180:183], v[228:231], a[148:151]
ds_read_b64_tr_b16 v[246:247], v22 offset:58368
v_mfma_f32_16x16x32_bf16 a[148:151], v[176:179], v[224:227], a[148:151]
v_mfma_f32_16x16x32_bf16 a[152:155], v[168:171], v[224:227], a[152:155]
v_mfma_f32_16x16x32_bf16 a[152:155], v[172:175], v[228:231], a[152:155]
v_mfma_f32_16x16x32_bf16 a[156:159], v[164:167], v[228:231], a[156:159]
v_mfma_f32_16x16x32_bf16 a[156:159], v[160:163], v[224:227], a[156:159]
s_waitcnt lgkmcnt(4)
v_mfma_f32_16x16x32_bf16 a[188:191], v[160:163], v[232:235], a[188:191]
ds_read_b64_tr_b16 v[248:249], v23 offset:49152
v_mfma_f32_16x16x32_bf16 a[188:191], v[164:167], v[236:239], a[188:191]
v_mfma_f32_16x16x32_bf16 a[184:187], v[172:175], v[236:239], a[184:187]
ds_read_b64_tr_b16 v[250:251], v23 offset:50176
v_mfma_f32_16x16x32_bf16 a[184:187], v[168:171], v[232:235], a[184:187]
v_mfma_f32_16x16x32_bf16 a[180:183], v[176:179], v[232:235], a[180:183]
ds_read_b64_tr_b16 v[252:253], v23 offset:57344
v_mfma_f32_16x16x32_bf16 a[180:183], v[180:183], v[236:239], a[180:183]
v_mfma_f32_16x16x32_bf16 a[176:179], v[188:191], v[236:239], a[176:179]
ds_read_b64_tr_b16 v[254:255], v23 offset:58368
v_mfma_f32_16x16x32_bf16 a[176:179], v[184:187], v[232:235], a[176:179]
v_mfma_f32_16x16x32_bf16 a[172:175], v[216:219], v[232:235], a[172:175]
v_mfma_f32_16x16x32_bf16 a[172:175], v[220:223], v[236:239], a[172:175]
v_mfma_f32_16x16x32_bf16 a[168:171], v[212:215], v[236:239], a[168:171]
v_mfma_f32_16x16x32_bf16 a[168:171], v[208:211], v[232:235], a[168:171]
v_mfma_f32_16x16x32_bf16 a[164:167], v[200:203], v[232:235], a[164:167]
v_mfma_f32_16x16x32_bf16 a[164:167], v[204:207], v[236:239], a[164:167]
v_mfma_f32_16x16x32_bf16 a[160:163], v[196:199], v[236:239], a[160:163]
s_waitcnt vmcnt(10) lgkmcnt(0)
v_mfma_f32_16x16x32_bf16 a[160:163], v[192:195], v[232:235], a[160:163]
s_barrier
v_mfma_f32_16x16x32_bf16 a[192:195], v[192:195], v[240:243], a[192:195]
s_and_b32 s73, s65, 1
ds_read_b64_tr_b16 v[224:225], v20 offset:0
v_mfma_f32_16x16x32_bf16 a[192:195], v[196:199], v[244:247], a[192:195]
s_xor_b32 s73, s73, 3
ds_read_b64_tr_b16 v[226:227], v20 offset:1024
v_mfma_f32_16x16x32_bf16 a[196:199], v[204:207], v[244:247], a[196:199]
s_lshl_b32 s69, s73, 7
ds_read_b64_tr_b16 v[228:229], v20 offset:8192
v_mfma_f32_16x16x32_bf16 a[196:199], v[200:203], v[240:243], a[196:199]
s_add_u32 s69, s69, s84
ds_read_b64_tr_b16 v[230:231], v20 offset:9216
v_mfma_f32_16x16x32_bf16 a[200:203], v[208:211], v[240:243], a[200:203]
s_lshl_b32 s71, s73, 19
ds_read_b128 v[128:131], v24 offset:0
v_mfma_f32_16x16x32_bf16 a[200:203], v[212:215], v[244:247], a[200:203]
s_add_u32 s71, s71, s66
ds_read_b128 v[132:135], v25 offset:0
v_mfma_f32_16x16x32_bf16 a[204:207], v[220:223], v[244:247], a[204:207]
s_add_u32 m0, s63, 98304
v_mfma_f32_16x16x32_bf16 a[204:207], v[216:219], v[240:243], a[204:207]
s_add_u32 s72, s69, 0
buffer_load_dwordx4 v2, s[8:11], s72 offen lds
v_mfma_f32_16x16x32_bf16 a[208:211], v[184:187], v[240:243], a[208:211]
s_add_u32 s72, s69, 7168
buffer_load_dwordx4 v3, s[8:11], s72 offen offset:1024 lds
v_mfma_f32_16x16x32_bf16 a[208:211], v[188:191], v[244:247], a[208:211]
s_add_u32 s72, s69, 14336
buffer_load_dwordx4 v2, s[8:11], s72 offen offset:2048 lds
v_mfma_f32_16x16x32_bf16 a[212:215], v[180:183], v[244:247], a[212:215]
ds_read_b128 v[136:139], v24 offset:2048
v_mfma_f32_16x16x32_bf16 a[212:215], v[176:179], v[240:243], a[212:215]
ds_read_b128 v[140:143], v25 offset:2048
v_mfma_f32_16x16x32_bf16 a[216:219], v[168:171], v[240:243], a[216:219]
s_add_u32 s72, s69, 21504
buffer_load_dwordx4 v3, s[8:11], s72 offen offset:3072 lds
v_mfma_f32_16x16x32_bf16 a[216:219], v[172:175], v[244:247], a[216:219]
ds_read_b128 v[144:147], v24 offset:4096
v_mfma_f32_16x16x32_bf16 a[220:223], v[164:167], v[244:247], a[220:223]
ds_read_b128 v[148:151], v25 offset:4096
v_mfma_f32_16x16x32_bf16 a[220:223], v[160:163], v[240:243], a[220:223]
ds_read_b128 v[152:155], v24 offset:6144
v_mfma_f32_16x16x32_bf16 a[252:255], v[160:163], v[248:251], a[252:255]
ds_read_b128 v[156:159], v25 offset:6144
v_mfma_f32_16x16x32_bf16 a[252:255], v[164:167], v[252:255], a[252:255]
s_add_u32 m0, s64, 32768
v_mfma_f32_16x16x32_bf16 a[248:251], v[172:175], v[252:255], a[248:251]
s_add_u32 s72, s71, 0
buffer_load_dwordx4 v6, s[16:19], s72 offen lds
v_mfma_f32_16x16x32_bf16 a[248:251], v[168:171], v[248:251], a[248:251]
ds_read_b128 v[160:163], v24 offset:8192
v_mfma_f32_16x16x32_bf16 a[244:247], v[176:179], v[248:251], a[244:247]
ds_read_b128 v[164:167], v25 offset:8192
v_mfma_f32_16x16x32_bf16 a[244:247], v[180:183], v[252:255], a[244:247]
s_add_u32 s72, s71, 31744
buffer_load_dwordx4 v6, s[16:19], s72 offen offset:1024 lds
v_mfma_f32_16x16x32_bf16 a[240:243], v[188:191], v[252:255], a[240:243]
ds_read_b128 v[168:171], v24 offset:10240
v_mfma_f32_16x16x32_bf16 a[240:243], v[184:187], v[248:251], a[240:243]
ds_read_b128 v[172:175], v25 offset:10240
v_mfma_f32_16x16x32_bf16 a[236:239], v[216:219], v[248:251], a[236:239]
ds_read_b128 v[176:179], v24 offset:12288
v_mfma_f32_16x16x32_bf16 a[236:239], v[220:223], v[252:255], a[236:239]
s_add_u32 s72, s71, 63488
buffer_load_dwordx4 v7, s[16:19], s72 offen offset:2048 lds
v_mfma_f32_16x16x32_bf16 a[232:235], v[212:215], v[252:255], a[232:235]
ds_read_b128 v[180:183], v25 offset:12288
v_mfma_f32_16x16x32_bf16 a[232:235], v[208:211], v[248:251], a[232:235]
ds_read_b128 v[184:187], v24 offset:14336
v_mfma_f32_16x16x32_bf16 a[228:231], v[200:203], v[248:251], a[228:231]
ds_read_b128 v[188:191], v25 offset:14336
v_mfma_f32_16x16x32_bf16 a[228:231], v[204:207], v[252:255], a[228:231]
v_mfma_f32_16x16x32_bf16 a[224:227], v[196:199], v[252:255], a[224:227]
s_add_u32 s72, s71, 95232
buffer_load_dwordx4 v7, s[16:19], s72 offen offset:3072 lds
v_mfma_f32_16x16x32_bf16 a[224:227], v[192:195], v[248:251], a[224:227]
s_waitcnt lgkmcnt(8)
ds_read_b64_tr_b16 v[232:233], v21 offset:0
v_mfma_f32_16x16x32_bf16 a[0:3], v[224:227], v[128:131], a[0:3]
ds_read_b64_tr_b16 v[234:235], v21 offset:1024
v_mfma_f32_16x16x32_bf16 a[0:3], v[228:231], v[132:135], a[0:3]
ds_read_b64_tr_b16 v[240:241], v22 offset:0
v_mfma_f32_16x16x32_bf16 a[4:7], v[228:231], v[140:143], a[4:7]
s_add_u32 m0, s63, 102400
ds_read_b64_tr_b16 v[236:237], v21 offset:8192
v_mfma_f32_16x16x32_bf16 a[4:7], v[224:227], v[136:139], a[4:7]
s_add_u32 s72, s69, 32768
buffer_load_dwordx4 v2, s[8:11], s72 offen lds
v_mfma_f32_16x16x32_bf16 a[8:11], v[224:227], v[144:147], a[8:11]
ds_read_b64_tr_b16 v[238:239], v21 offset:9216
v_mfma_f32_16x16x32_bf16 a[8:11], v[228:231], v[148:151], a[8:11]
v_mfma_f32_16x16x32_bf16 a[12:15], v[228:231], v[156:159], a[12:15]
s_add_u32 s72, s69, 39936
buffer_load_dwordx4 v3, s[8:11], s72 offen offset:1024 lds
v_mfma_f32_16x16x32_bf16 a[12:15], v[224:227], v[152:155], a[12:15]
s_waitcnt lgkmcnt(5)
ds_read_b64_tr_b16 v[242:243], v22 offset:1024
v_mfma_f32_16x16x32_bf16 a[16:19], v[224:227], v[160:163], a[16:19]
v_mfma_f32_16x16x32_bf16 a[16:19], v[228:231], v[164:167], a[16:19]
ds_read_b64_tr_b16 v[244:245], v22 offset:8192
v_mfma_f32_16x16x32_bf16 a[20:23], v[228:231], v[172:175], a[20:23]
v_mfma_f32_16x16x32_bf16 a[20:23], v[224:227], v[168:171], a[20:23]
s_add_u32 s72, s69, 47104
buffer_load_dwordx4 v2, s[8:11], s72 offen offset:2048 lds
v_mfma_f32_16x16x32_bf16 a[24:27], v[224:227], v[176:179], a[24:27]
ds_read_b64_tr_b16 v[246:247], v22 offset:9216
v_mfma_f32_16x16x32_bf16 a[24:27], v[228:231], v[180:183], a[24:27]
v_mfma_f32_16x16x32_bf16 a[28:31], v[228:231], v[188:191], a[28:31]
v_mfma_f32_16x16x32_bf16 a[28:31], v[224:227], v[184:187], a[28:31]
s_waitcnt lgkmcnt(3)
v_mfma_f32_16x16x32_bf16 a[60:63], v[232:235], v[184:187], a[60:63]
s_add_u32 s72, s69, 54272
buffer_load_dwordx4 v3, s[8:11], s72 offen offset:3072 lds
v_mfma_f32_16x16x32_bf16 a[60:63], v[236:239], v[188:191], a[60:63]
ds_read_b64_tr_b16 v[248:249], v23 offset:0
v_mfma_f32_16x16x32_bf16 a[56:59], v[236:239], v[180:183], a[56:59]
v_mfma_f32_16x16x32_bf16 a[56:59], v[232:235], v[176:179], a[56:59]
s_add_u32 m0, s64, 49152
ds_read_b64_tr_b16 v[250:251], v23 offset:1024
v_mfma_f32_16x16x32_bf16 a[52:55], v[232:235], v[168:171], a[52:55]
s_add_u32 s72, s71, 0
buffer_load_dwordx4 v6, s[20:23], s72 offen lds
v_mfma_f32_16x16x32_bf16 a[52:55], v[236:239], v[172:175], a[52:55]
v_mfma_f32_16x16x32_bf16 a[48:51], v[236:239], v[164:167], a[48:51]
v_mfma_f32_16x16x32_bf16 a[48:51], v[232:235], v[160:163], a[48:51]
ds_read_b64_tr_b16 v[252:253], v23 offset:8192
v_mfma_f32_16x16x32_bf16 a[44:47], v[232:235], v[152:155], a[44:47]
s_add_u32 s72, s71, 31744
buffer_load_dwordx4 v6, s[20:23], s72 offen offset:1024 lds
v_mfma_f32_16x16x32_bf16 a[44:47], v[236:239], v[156:159], a[44:47]
v_mfma_f32_16x16x32_bf16 a[40:43], v[236:239], v[148:151], a[40:43]
ds_read_b64_tr_b16 v[254:255], v23 offset:9216
v_mfma_f32_16x16x32_bf16 a[40:43], v[232:235], v[144:147], a[40:43]
v_mfma_f32_16x16x32_bf16 a[36:39], v[232:235], v[136:139], a[36:39]
s_add_u32 s72, s71, 63488
buffer_load_dwordx4 v7, s[20:23], s72 offen offset:2048 lds
v_mfma_f32_16x16x32_bf16 a[36:39], v[236:239], v[140:143], a[36:39]
v_mfma_f32_16x16x32_bf16 a[32:35], v[236:239], v[132:135], a[32:35]
v_mfma_f32_16x16x32_bf16 a[32:35], v[232:235], v[128:131], a[32:35]
s_waitcnt lgkmcnt(4)
v_mfma_f32_16x16x32_bf16 a[64:67], v[240:243], v[128:131], a[64:67]
s_add_u32 s72, s71, 95232
buffer_load_dwordx4 v7, s[20:23], s72 offen offset:3072 lds
v_mfma_f32_16x16x32_bf16 a[64:67], v[244:247], v[132:135], a[64:67]
s_mov_b32 s80, 0x300000
buffer_load_dword v126, v125, s[16:19], s80 offen
v_mfma_f32_16x16x32_bf16 a[68:71], v[244:247], v[140:143], a[68:71]
buffer_load_dword v126, v125, s[20:23], s80 offen
v_mfma_f32_16x16x32_bf16 a[68:71], v[240:243], v[136:139], a[68:71]
s_add_u32 m0, s63, 135168
ds_read_b64_tr_b16 v[224:225], v20 offset:16384
v_mfma_f32_16x16x32_bf16 a[72:75], v[240:243], v[144:147], a[72:75]
s_add_u32 s80, s82, 0
buffer_load_dwordx4 v26, s[32:35], s80 offen nt lds
v_mfma_f32_16x16x32_bf16 a[72:75], v[244:247], v[148:151], a[72:75]
s_add_u32 s80, s82, 15360
buffer_load_dwordx4 v26, s[32:35], s80 offen offset:1024 nt lds
v_mfma_f32_16x16x32_bf16 a[76:79], v[244:247], v[156:159], a[76:79]
s_add_u32 s80, s82, 30720
buffer_load_dwordx4 v26, s[32:35], s80 offen offset:2048 nt lds
v_mfma_f32_16x16x32_bf16 a[76:79], v[240:243], v[152:155], a[76:79]
s_add_u32 s80, s82, 46080
buffer_load_dwordx4 v26, s[32:35], s80 offen offset:3072 nt lds
v_mfma_f32_16x16x32_bf16 a[80:83], v[240:243], v[160:163], a[80:83]
ds_read_b64_tr_b16 v[226:227], v20 offset:17408
v_mfma_f32_16x16x32_bf16 a[80:83], v[244:247], v[164:167], a[80:83]
v_mfma_f32_16x16x32_bf16 a[84:87], v[244:247], v[172:175], a[84:87]
ds_read_b64_tr_b16 v[228:229], v20 offset:24576
v_mfma_f32_16x16x32_bf16 a[84:87], v[240:243], v[168:171], a[84:87]
v_mfma_f32_16x16x32_bf16 a[88:91], v[240:243], v[176:179], a[88:91]
ds_read_b64_tr_b16 v[230:231], v20 offset:25600
v_mfma_f32_16x16x32_bf16 a[88:91], v[244:247], v[180:183], a[88:91]
v_mfma_f32_16x16x32_bf16 a[92:95], v[244:247], v[188:191], a[92:95]
v_mfma_f32_16x16x32_bf16 a[92:95], v[240:243], v[184:187], a[92:95]
s_waitcnt lgkmcnt(4)
v_mfma_f32_16x16x32_bf16 a[124:127], v[248:251], v[184:187], a[124:127]
ds_read_b64_tr_b16 v[232:233], v21 offset:16384
v_mfma_f32_16x16x32_bf16 a[124:127], v[252:255], v[188:191], a[124:127]
v_mfma_f32_16x16x32_bf16 a[120:123], v[252:255], v[180:183], a[120:123]
v_mfma_f32_16x16x32_bf16 a[120:123], v[248:251], v[176:179], a[120:123]
ds_read_b64_tr_b16 v[234:235], v21 offset:17408
v_mfma_f32_16x16x32_bf16 a[116:119], v[248:251], v[168:171], a[116:119]
v_mfma_f32_16x16x32_bf16 a[116:119], v[252:255], v[172:175], a[116:119]
v_mfma_f32_16x16x32_bf16 a[112:115], v[252:255], v[164:167], a[112:115]
v_mfma_f32_16x16x32_bf16 a[112:115], v[248:251], v[160:163], a[112:115]
ds_read_b64_tr_b16 v[236:237], v21 offset:24576
v_mfma_f32_16x16x32_bf16 a[108:111], v[248:251], v[152:155], a[108:111]
v_mfma_f32_16x16x32_bf16 a[108:111], v[252:255], v[156:159], a[108:111]
v_mfma_f32_16x16x32_bf16 a[104:107], v[252:255], v[148:151], a[104:107]
ds_read_b64_tr_b16 v[238:239], v21 offset:25600
v_mfma_f32_16x16x32_bf16 a[104:107], v[248:251], v[144:147], a[104:107]
v_mfma_f32_16x16x32_bf16 a[100:103], v[248:251], v[136:139], a[100:103]
v_mfma_f32_16x16x32_bf16 a[100:103], v[252:255], v[140:143], a[100:103]
v_mfma_f32_16x16x32_bf16 a[96:99], v[252:255], v[132:135], a[96:99]
v_mfma_f32_16x16x32_bf16 a[96:99], v[248:251], v[128:131], a[96:99]
s_waitcnt lgkmcnt(4)
v_mfma_f32_16x16x32_bf16 a[128:131], v[128:131], v[224:227], a[128:131]
ds_read_b64_tr_b16 v[240:241], v22 offset:16384
v_mfma_f32_16x16x32_bf16 a[128:131], v[132:135], v[228:231], a[128:131]
v_mfma_f32_16x16x32_bf16 a[132:135], v[140:143], v[228:231], a[132:135]
v_mfma_f32_16x16x32_bf16 a[132:135], v[136:139], v[224:227], a[132:135]
ds_read_b64_tr_b16 v[242:243], v22 offset:17408
v_mfma_f32_16x16x32_bf16 a[136:139], v[144:147], v[224:227], a[136:139]
v_mfma_f32_16x16x32_bf16 a[136:139], v[148:151], v[228:231], a[136:139]
v_mfma_f32_16x16x32_bf16 a[140:143], v[156:159], v[228:231], a[140:143]
v_mfma_f32_16x16x32_bf16 a[140:143], v[152:155], v[224:227], a[140:143]
ds_read_b64_tr_b16 v[244:245], v22 offset:24576
v_mfma_f32_16x16x32_bf16 a[144:147], v[160:163], v[224:227], a[144:147]
v_mfma_f32_16x16x32_bf16 a[144:147], v[164:167], v[228:231], a[144:147]
v_mfma_f32_16x16x32_bf16 a[148:151], v[172:175], v[228:231], a[148:151]
ds_read_b64_tr_b16 v[246:247], v22 offset:25600
v_mfma_f32_16x16x32_bf16 a[148:151], v[168:171], v[224:227], a[148:151]
v_mfma_f32_16x16x32_bf16 a[152:155], v[176:179], v[224:227], a[152:155]
v_mfma_f32_16x16x32_bf16 a[152:155], v[180:183], v[228:231], a[152:155]
v_mfma_f32_16x16x32_bf16 a[156:159], v[188:191], v[228:231], a[156:159]
v_mfma_f32_16x16x32_bf16 a[156:159], v[184:187], v[224:227], a[156:159]
s_waitcnt lgkmcnt(4)
v_mfma_f32_16x16x32_bf16 a[188:191], v[184:187], v[232:235], a[188:191]
ds_read_b64_tr_b16 v[248:249], v23 offset:16384
v_mfma_f32_16x16x32_bf16 a[188:191], v[188:191], v[236:239], a[188:191]
v_mfma_f32_16x16x32_bf16 a[184:187], v[180:183], v[236:239], a[184:187]
ds_read_b64_tr_b16 v[250:251], v23 offset:17408
v_mfma_f32_16x16x32_bf16 a[184:187], v[176:179], v[232:235], a[184:187]
v_mfma_f32_16x16x32_bf16 a[180:183], v[168:171], v[232:235], a[180:183]
ds_read_b64_tr_b16 v[252:253], v23 offset:24576
v_mfma_f32_16x16x32_bf16 a[180:183], v[172:175], v[236:239], a[180:183]
v_mfma_f32_16x16x32_bf16 a[176:179], v[164:167], v[236:239], a[176:179]
ds_read_b64_tr_b16 v[254:255], v23 offset:25600
v_mfma_f32_16x16x32_bf16 a[176:179], v[160:163], v[232:235], a[176:179]
v_mfma_f32_16x16x32_bf16 a[172:175], v[152:155], v[232:235], a[172:175]
v_mfma_f32_16x16x32_bf16 a[172:175], v[156:159], v[236:239], a[172:175]
v_mfma_f32_16x16x32_bf16 a[168:171], v[148:151], v[236:239], a[168:171]
v_mfma_f32_16x16x32_bf16 a[168:171], v[144:147], v[232:235], a[168:171]
v_mfma_f32_16x16x32_bf16 a[164:167], v[136:139], v[232:235], a[164:167]
v_mfma_f32_16x16x32_bf16 a[164:167], v[140:143], v[236:239], a[164:167]
v_mfma_f32_16x16x32_bf16 a[160:163], v[132:135], v[236:239], a[160:163]
s_waitcnt vmcnt(6) lgkmcnt(0)
v_mfma_f32_16x16x32_bf16 a[160:163], v[128:131], v[232:235], a[160:163]
s_barrier
v_mfma_f32_16x16x32_bf16 a[192:195], v[128:131], v[240:243], a[192:195]
s_and_b32 s73, s65, 1
ds_read_b64_tr_b16 v[224:225], v20 offset:32768
v_mfma_f32_16x16x32_bf16 a[192:195], v[132:135], v[244:247], a[192:195]
s_xor_b32 s73, s73, 4
ds_read_b64_tr_b16 v[226:227], v20 offset:33792
v_mfma_f32_16x16x32_bf16 a[196:199], v[140:143], v[244:247], a[196:199]
s_lshl_b32 s69, s73, 7
ds_read_b64_tr_b16 v[228:229], v20 offset:40960
v_mfma_f32_16x16x32_bf16 a[196:199], v[136:139], v[240:243], a[196:199]
s_add_u32 s69, s69, s84
ds_read_b64_tr_b16 v[230:231], v20 offset:41984
v_mfma_f32_16x16x32_bf16 a[200:203], v[144:147], v[240:243], a[200:203]
s_lshl_b32 s71, s73, 19
ds_read_b128 v[192:195], v24 offset:32768
v_mfma_f32_16x16x32_bf16 a[200:203], v[148:151], v[244:247], a[200:203]
s_add_u32 s71, s71, s66
ds_read_b128 v[196:199], v25 offset:32768
v_mfma_f32_16x16x32_bf16 a[204:207], v[156:159], v[244:247], a[204:207]
s_add_u32 m0, s63, 65536
v_mfma_f32_16x16x32_bf16 a[204:207], v[152:155], v[240:243], a[204:207]
s_add_u32 s72, s69, 0
buffer_load_dwordx4 v2, s[8:11], s72 offen lds
v_mfma_f32_16x16x32_bf16 a[208:211], v[160:163], v[240:243], a[208:211]
s_add_u32 s72, s69, 7168
buffer_load_dwordx4 v3, s[8:11], s72 offen offset:1024 lds
v_mfma_f32_16x16x32_bf16 a[208:211], v[164:167], v[244:247], a[208:211]
s_add_u32 s72, s69, 14336
buffer_load_dwordx4 v2, s[8:11], s72 offen offset:2048 lds
v_mfma_f32_16x16x32_bf16 a[212:215], v[172:175], v[244:247], a[212:215]
ds_read_b128 v[200:203], v24 offset:34816
v_mfma_f32_16x16x32_bf16 a[212:215], v[168:171], v[240:243], a[212:215]
ds_read_b128 v[204:207], v25 offset:34816
v_mfma_f32_16x16x32_bf16 a[216:219], v[176:179], v[240:243], a[216:219]
s_add_u32 s72, s69, 21504
buffer_load_dwordx4 v3, s[8:11], s72 offen offset:3072 lds
v_mfma_f32_16x16x32_bf16 a[216:219], v[180:183], v[244:247], a[216:219]
ds_read_b128 v[208:211], v24 offset:36864
v_mfma_f32_16x16x32_bf16 a[220:223], v[188:191], v[244:247], a[220:223]
ds_read_b128 v[212:215], v25 offset:36864
v_mfma_f32_16x16x32_bf16 a[220:223], v[184:187], v[240:243], a[220:223]
ds_read_b128 v[216:219], v24 offset:38912
v_mfma_f32_16x16x32_bf16 a[252:255], v[184:187], v[248:251], a[252:255]
ds_read_b128 v[220:223], v25 offset:38912
v_mfma_f32_16x16x32_bf16 a[252:255], v[188:191], v[252:255], a[252:255]
s_add_u32 m0, s64, 0
v_mfma_f32_16x16x32_bf16 a[248:251], v[180:183], v[252:255], a[248:251]
s_add_u32 s72, s71, 0
buffer_load_dwordx4 v6, s[16:19], s72 offen lds
v_mfma_f32_16x16x32_bf16 a[248:251], v[176:179], v[248:251], a[248:251]
ds_read_b128 v[184:187], v24 offset:40960
v_mfma_f32_16x16x32_bf16 a[244:247], v[168:171], v[248:251], a[244:247]
ds_read_b128 v[188:191], v25 offset:40960
v_mfma_f32_16x16x32_bf16 a[244:247], v[172:175], v[252:255], a[244:247]
s_add_u32 s72, s71, 31744
buffer_load_dwordx4 v6, s[16:19], s72 offen offset:1024 lds
v_mfma_f32_16x16x32_bf16 a[240:243], v[164:167], v[252:255], a[240:243]
ds_read_b128 v[176:179], v24 offset:43008
v_mfma_f32_16x16x32_bf16 a[240:243], v[160:163], v[248:251], a[240:243]
ds_read_b128 v[180:183], v25 offset:43008
v_mfma_f32_16x16x32_bf16 a[236:239], v[152:155], v[248:251], a[236:239]
ds_read_b128 v[168:171], v24 offset:45056
v_mfma_f32_16x16x32_bf16 a[236:239], v[156:159], v[252:255], a[236:239]
s_add_u32 s72, s71, 63488
buffer_load_dwordx4 v7, s[16:19], s72 offen offset:2048 lds
v_mfma_f32_16x16x32_bf16 a[232:235], v[148:151], v[252:255], a[232:235]
ds_read_b128 v[172:175], v25 offset:45056
v_mfma_f32_16x16x32_bf16 a[232:235], v[144:147], v[248:251], a[232:235]
ds_read_b128 v[160:163], v24 offset:47104
v_mfma_f32_16x16x32_bf16 a[228:231], v[136:139], v[248:251], a[228:231]
ds_read_b128 v[164:167], v25 offset:47104
v_mfma_f32_16x16x32_bf16 a[228:231], v[140:143], v[252:255], a[228:231]
v_mfma_f32_16x16x32_bf16 a[224:227], v[132:135], v[252:255], a[224:227]
s_add_u32 s72, s71, 95232
buffer_load_dwordx4 v7, s[16:19], s72 offen offset:3072 lds
v_mfma_f32_16x16x32_bf16 a[224:227], v[128:131], v[248:251], a[224:227]
s_waitcnt lgkmcnt(8)
ds_read_b64_tr_b16 v[232:233], v21 offset:32768
v_mfma_f32_16x16x32_bf16 a[0:3], v[224:227], v[192:195], a[0:3]
ds_read_b64_tr_b16 v[234:235], v21 offset:33792
v_mfma_f32_16x16x32_bf16 a[0:3], v[228:231], v[196:199], a[0:3]
ds_read_b64_tr_b16 v[240:241], v22 offset:32768
v_mfma_f32_16x16x32_bf16 a[4:7], v[228:231], v[204:207], a[4:7]
s_add_u32 m0, s63, 69632
ds_read_b64_tr_b16 v[236:237], v21 offset:40960
v_mfma_f32_16x16x32_bf16 a[4:7], v[224:227], v[200:203], a[4:7]
s_add_u32 s72, s69, 32768
buffer_load_dwordx4 v2, s[8:11], s72 offen lds
v_mfma_f32_16x16x32_bf16 a[8:11], v[224:227], v[208:211], a[8:11]
ds_read_b64_tr_b16 v[238:239], v21 offset:41984
v_mfma_f32_16x16x32_bf16 a[8:11], v[228:231], v[212:215], a[8:11]
v_mfma_f32_16x16x32_bf16 a[12:15], v[228:231], v[220:223], a[12:15]
s_add_u32 s72, s69, 39936
buffer_load_dwordx4 v3, s[8:11], s72 offen offset:1024 lds
v_mfma_f32_16x16x32_bf16 a[12:15], v[224:227], v[216:219], a[12:15]
s_waitcnt lgkmcnt(5)
ds_read_b64_tr_b16 v[242:243], v22 offset:33792
v_mfma_f32_16x16x32_bf16 a[16:19], v[224:227], v[184:187], a[16:19]
v_mfma_f32_16x16x32_bf16 a[16:19], v[228:231], v[188:191], a[16:19]
ds_read_b64_tr_b16 v[244:245], v22 offset:40960
v_mfma_f32_16x16x32_bf16 a[20:23], v[228:231], v[180:183], a[20:23]
v_mfma_f32_16x16x32_bf16 a[20:23], v[224:227], v[176:179], a[20:23]
s_add_u32 s72, s69, 47104
buffer_load_dwordx4 v2, s[8:11], s72 offen offset:2048 lds
v_mfma_f32_16x16x32_bf16 a[24:27], v[224:227], v[168:171], a[24:27]
ds_read_b64_tr_b16 v[246:247], v22 offset:41984
v_mfma_f32_16x16x32_bf16 a[24:27], v[228:231], v[172:175], a[24:27]
v_mfma_f32_16x16x32_bf16 a[28:31], v[228:231], v[164:167], a[28:31]
v_mfma_f32_16x16x32_bf16 a[28:31], v[224:227], v[160:163], a[28:31]
s_waitcnt lgkmcnt(3)
v_mfma_f32_16x16x32_bf16 a[60:63], v[232:235], v[160:163], a[60:63]
s_add_u32 s72, s69, 54272
buffer_load_dwordx4 v3, s[8:11], s72 offen offset:3072 lds
v_mfma_f32_16x16x32_bf16 a[60:63], v[236:239], v[164:167], a[60:63]
ds_read_b64_tr_b16 v[248:249], v23 offset:32768
v_mfma_f32_16x16x32_bf16 a[56:59], v[236:239], v[172:175], a[56:59]
v_mfma_f32_16x16x32_bf16 a[56:59], v[232:235], v[168:171], a[56:59]
s_add_u32 m0, s64, 16384
ds_read_b64_tr_b16 v[250:251], v23 offset:33792
v_mfma_f32_16x16x32_bf16 a[52:55], v[232:235], v[176:179], a[52:55]
s_add_u32 s72, s71, 0
buffer_load_dwordx4 v6, s[20:23], s72 offen lds
v_mfma_f32_16x16x32_bf16 a[52:55], v[236:239], v[180:183], a[52:55]
v_mfma_f32_16x16x32_bf16 a[48:51], v[236:239], v[188:191], a[48:51]
v_mfma_f32_16x16x32_bf16 a[48:51], v[232:235], v[184:187], a[48:51]
ds_read_b64_tr_b16 v[252:253], v23 offset:40960
v_mfma_f32_16x16x32_bf16 a[44:47], v[232:235], v[216:219], a[44:47]
s_add_u32 s72, s71, 31744
buffer_load_dwordx4 v6, s[20:23], s72 offen offset:1024 lds
v_mfma_f32_16x16x32_bf16 a[44:47], v[236:239], v[220:223], a[44:47]
v_mfma_f32_16x16x32_bf16 a[40:43], v[236:239], v[212:215], a[40:43]
ds_read_b64_tr_b16 v[254:255], v23 offset:41984
v_mfma_f32_16x16x32_bf16 a[40:43], v[232:235], v[208:211], a[40:43]
v_mfma_f32_16x16x32_bf16 a[36:39], v[232:235], v[200:203], a[36:39]
s_add_u32 s72, s71, 63488
buffer_load_dwordx4 v7, s[20:23], s72 offen offset:2048 lds
v_mfma_f32_16x16x32_bf16 a[36:39], v[236:239], v[204:207], a[36:39]
v_mfma_f32_16x16x32_bf16 a[32:35], v[236:239], v[196:199], a[32:35]
v_mfma_f32_16x16x32_bf16 a[32:35], v[232:235], v[192:195], a[32:35]
s_waitcnt lgkmcnt(4)
v_mfma_f32_16x16x32_bf16 a[64:67], v[240:243], v[192:195], a[64:67]
s_add_u32 s72, s71, 95232
buffer_load_dwordx4 v7, s[20:23], s72 offen offset:3072 lds
v_mfma_f32_16x16x32_bf16 a[64:67], v[244:247], v[196:199], a[64:67]
buffer_load_dwordx4 v[108:111], v1, s[4:7], s76 offen
v_mfma_f32_16x16x32_bf16 a[68:71], v[244:247], v[204:207], a[68:71]
buffer_load_dwordx4 v[112:115], v1, s[4:7], s76 offen offset:1024
v_mfma_f32_16x16x32_bf16 a[68:71], v[240:243], v[200:203], a[68:71]
buffer_load_dwordx4 v[116:119], v1, s[4:7], s76 offen offset:2048
v_mfma_f32_16x16x32_bf16 a[72:75], v[240:243], v[208:211], a[72:75]
buffer_load_dwordx4 v[120:123], v1, s[4:7], s76 offen offset:3072
v_mfma_f32_16x16x32_bf16 a[72:75], v[244:247], v[212:215], a[72:75]
ds_read_b64_tr_b16 v[224:225], v20 offset:49152
v_mfma_f32_16x16x32_bf16 a[76:79], v[244:247], v[220:223], a[76:79]
v_mfma_f32_16x16x32_bf16 a[76:79], v[240:243], v[216:219], a[76:79]
ds_read_b64_tr_b16 v[226:227], v20 offset:50176
v_mfma_f32_16x16x32_bf16 a[80:83], v[240:243], v[184:187], a[80:83]
v_mfma_f32_16x16x32_bf16 a[80:83], v[244:247], v[188:191], a[80:83]
ds_read_b64_tr_b16 v[228:229], v20 offset:57344
v_mfma_f32_16x16x32_bf16 a[84:87], v[244:247], v[180:183], a[84:87]
v_mfma_f32_16x16x32_bf16 a[84:87], v[240:243], v[176:179], a[84:87]
ds_read_b64_tr_b16 v[230:231], v20 offset:58368
v_mfma_f32_16x16x32_bf16 a[88:91], v[240:243], v[168:171], a[88:91]
v_mfma_f32_16x16x32_bf16 a[88:91], v[244:247], v[172:175], a[88:91]
v_mfma_f32_16x16x32_bf16 a[92:95], v[244:247], v[164:167], a[92:95]
v_mfma_f32_16x16x32_bf16 a[92:95], v[240:243], v[160:163], a[92:95]
s_waitcnt lgkmcnt(4)
v_mfma_f32_16x16x32_bf16 a[124:127], v[248:251], v[160:163], a[124:127]
ds_read_b64_tr_b16 v[232:233], v21 offset:49152
v_mfma_f32_16x16x32_bf16 a[124:127], v[252:255], v[164:167], a[124:127]
v_mfma_f32_16x16x32_bf16 a[120:123], v[252:255], v[172:175], a[120:123]
v_mfma_f32_16x16x32_bf16 a[120:123], v[248:251], v[168:171], a[120:123]
ds_read_b64_tr_b16 v[234:235], v21 offset:50176
v_mfma_f32_16x16x32_bf16 a[116:119], v[248:251], v[176:179], a[116:119]
s_waitcnt vmcnt(20)
ds_read2_b32 v[36:37], v98 offset0:0 offset1:32
ds_read2_b32 v[38:39], v98 offset0:64 offset1:96
v_mfma_f32_16x16x32_bf16 a[116:119], v[252:255], v[180:183], a[116:119]
ds_read2_b32 v[40:41], v98 offset0:128 offset1:160
ds_read2_b32 v[42:43], v98 offset0:192 offset1:224
v_mfma_f32_16x16x32_bf16 a[112:115], v[252:255], v[188:191], a[112:115]
v_add_u32 v98, 1024, v98
v_mfma_f32_16x16x32_bf16 a[112:115], v[248:251], v[184:187], a[112:115]
ds_read_b64_tr_b16 v[236:237], v21 offset:57344
ds_read2_b32 v[44:45], v98 offset0:0 offset1:32
v_mfma_f32_16x16x32_bf16 a[108:111], v[248:251], v[216:219], a[108:111]
ds_read2_b32 v[46:47], v98 offset0:64 offset1:96
ds_read2_b32 v[48:49], v98 offset0:128 offset1:160
v_mfma_f32_16x16x32_bf16 a[108:111], v[252:255], v[220:223], a[108:111]
ds_read2_b32 v[50:51], v98 offset0:192 offset1:224
v_add_u32 v98, 3072, v98
v_mfma_f32_16x16x32_bf16 a[104:107], v[252:255], v[212:215], a[104:107]
ds_read_b64_tr_b16 v[238:239], v21 offset:58368
ds_read2_b32 v[52:53], v98 offset0:0 offset1:32
v_mfma_f32_16x16x32_bf16 a[104:107], v[248:251], v[208:211], a[104:107]
ds_read2_b32 v[54:55], v98 offset0:64 offset1:96
ds_read2_b32 v[56:57], v98 offset0:128 offset1:160
v_mfma_f32_16x16x32_bf16 a[100:103], v[248:251], v[200:203], a[100:103]
ds_read2_b32 v[58:59], v98 offset0:192 offset1:224
v_add_u32 v98, 1024, v98
v_mfma_f32_16x16x32_bf16 a[100:103], v[252:255], v[204:207], a[100:103]
ds_read2_b32 v[60:61], v98 offset0:0 offset1:32
ds_read2_b32 v[62:63], v98 offset0:64 offset1:96
v_mfma_f32_16x16x32_bf16 a[96:99], v[252:255], v[196:199], a[96:99]
ds_read2_b32 v[64:65], v98 offset0:128 offset1:160
ds_read2_b32 v[66:67], v98 offset0:192 offset1:224
v_mfma_f32_16x16x32_bf16 a[96:99], v[248:251], v[192:195], a[96:99]
s_waitcnt lgkmcnt(15)
v_mfma_f32_16x16x32_bf16 a[128:131], v[192:195], v[224:227], a[128:131]
ds_read_b64_tr_b16 v[240:241], v22 offset:49152
v_mfma_f32_16x16x32_bf16 a[128:131], v[196:199], v[228:231], a[128:131]
v_mfma_f32_16x16x32_bf16 a[132:135], v[204:207], v[228:231], a[132:135]
v_mfma_f32_16x16x32_bf16 a[132:135], v[200:203], v[224:227], a[132:135]
ds_read_b64_tr_b16 v[242:243], v22 offset:50176
v_mfma_f32_16x16x32_bf16 a[136:139], v[208:211], v[224:227], a[136:139]
v_mfma_f32_16x16x32_bf16 a[136:139], v[212:215], v[228:231], a[136:139]
v_mfma_f32_16x16x32_bf16 a[140:143], v[220:223], v[228:231], a[140:143]
v_mfma_f32_16x16x32_bf16 a[140:143], v[216:219], v[224:227], a[140:143]
ds_read_b64_tr_b16 v[244:245], v22 offset:57344
v_mfma_f32_16x16x32_bf16 a[144:147], v[184:187], v[224:227], a[144:147]
v_mfma_f32_16x16x32_bf16 a[144:147], v[188:191], v[228:231], a[144:147]
v_mfma_f32_16x16x32_bf16 a[148:151], v[180:183], v[228:231], a[148:151]
ds_read_b64_tr_b16 v[246:247], v22 offset:58368
v_mfma_f32_16x16x32_bf16 a[148:151], v[176:179], v[224:227], a[148:151]
v_mfma_f32_16x16x32_bf16 a[152:155], v[168:171], v[224:227], a[152:155]
v_mfma_f32_16x16x32_bf16 a[152:155], v[172:175], v[228:231], a[152:155]
v_mfma_f32_16x16x32_bf16 a[156:159], v[164:167], v[228:231], a[156:159]
v_mfma_f32_16x16x32_bf16 a[156:159], v[160:163], v[224:227], a[156:159]
s_waitcnt lgkmcnt(12)
v_mfma_f32_16x16x32_bf16 a[188:191], v[160:163], v[232:235], a[188:191]
ds_read_b64_tr_b16 v[248:249], v23 offset:49152
v_mfma_f32_16x16x32_bf16 a[188:191], v[164:167], v[236:239], a[188:191]
v_mfma_f32_16x16x32_bf16 a[184:187], v[172:175], v[236:239], a[184:187]
ds_read_b64_tr_b16 v[250:251], v23 offset:50176
v_mfma_f32_16x16x32_bf16 a[184:187], v[168:171], v[232:235], a[184:187]
v_mfma_f32_16x16x32_bf16 a[180:183], v[176:179], v[232:235], a[180:183]
ds_read_b64_tr_b16 v[252:253], v23 offset:57344
v_mfma_f32_16x16x32_bf16 a[180:183], v[180:183], v[236:239], a[180:183]
v_mfma_f32_16x16x32_bf16 a[176:179], v[188:191], v[236:239], a[176:179]
ds_read_b64_tr_b16 v[254:255], v23 offset:58368
v_mfma_f32_16x16x32_bf16 a[176:179], v[184:187], v[232:235], a[176:179]
v_mfma_f32_16x16x32_bf16 a[172:175], v[216:219], v[232:235], a[172:175]
v_mfma_f32_16x16x32_bf16 a[172:175], v[220:223], v[236:239], a[172:175]
v_mfma_f32_16x16x32_bf16 a[168:171], v[212:215], v[236:239], a[168:171]
v_mfma_f32_16x16x32_bf16 a[168:171], v[208:211], v[232:235], a[168:171]
v_mfma_f32_16x16x32_bf16 a[164:167], v[200:203], v[232:235], a[164:167]
v_mfma_f32_16x16x32_bf16 a[164:167], v[204:207], v[236:239], a[164:167]
v_mfma_f32_16x16x32_bf16 a[160:163], v[196:199], v[236:239], a[160:163]
s_waitcnt vmcnt(4) lgkmcnt(0)
v_mfma_f32_16x16x32_bf16 a[160:163], v[192:195], v[232:235], a[160:163]
s_barrier
v_mfma_f32_16x16x32_bf16 a[192:195], v[192:195], v[240:243], a[192:195]
s_and_b32 s73, s65, 1
ds_read_b64_tr_b16 v[224:225], v20 offset:0
v_lshlrev_b32 v72, 16, v68
v_mfma_f32_16x16x32_bf16 a[192:195], v[196:199], v[244:247], a[192:195]
s_xor_b32 s73, s73, 5
ds_read_b64_tr_b16 v[226:227], v20 offset:1024
v_and_b32 v73, 0xffff0000, v68
v_mfma_f32_16x16x32_bf16 a[196:199], v[204:207], v[244:247], a[196:199]
s_lshl_b32 s69, s73, 7
ds_read_b64_tr_b16 v[228:229], v20 offset:8192
v_lshlrev_b32 v74, 16, v69
v_mfma_f32_16x16x32_bf16 a[196:199], v[200:203], v[240:243], a[196:199]
s_add_u32 s69, s69, s84
ds_read_b64_tr_b16 v[230:231], v20 offset:9216
v_and_b32 v75, 0xffff0000, v69
v_mfma_f32_16x16x32_bf16 a[200:203], v[208:211], v[240:243], a[200:203]
s_lshl_b32 s71, s73, 19
ds_read_b128 v[128:131], v24 offset:0
v_lshlrev_b32 v76, 16, v33
v_mfma_f32_16x16x32_bf16 a[200:203], v[212:215], v[244:247], a[200:203]
s_add_u32 s71, s71, s66
ds_read_b128 v[132:135], v25 offset:0
v_lshlrev_b32 v77, 16, v34
v_mfma_f32_16x16x32_bf16 a[204:207], v[220:223], v[244:247], a[204:207]
s_add_u32 m0, s63, 98304
v_lshlrev_b32 v78, 16, v35
v_lshlrev_b32 v79, 16, v36
v_mfma_f32_16x16x32_bf16 a[204:207], v[216:219], v[240:243], a[204:207]
s_add_u32 s72, s69, 0
buffer_load_dwordx4 v2, s[8:11], s72 offen lds
v_mfma_f32_16x16x32_bf16 a[208:211], v[184:187], v[240:243], a[208:211]
s_add_u32 s72, s69, 7168
buffer_load_dwordx4 v3, s[8:11], s72 offen offset:1024 lds
v_mfma_f32_16x16x32_bf16 a[208:211], v[188:191], v[244:247], a[208:211]
s_add_u32 s72, s69, 14336
buffer_load_dwordx4 v2, s[8:11], s72 offen offset:2048 lds
v_mfma_f32_16x16x32_bf16 a[212:215], v[180:183], v[244:247], a[212:215]
ds_read_b128 v[136:139], v24 offset:2048
v_lshlrev_b32 v80, 16, v37
v_mfma_f32_16x16x32_bf16 a[212:215], v[176:179], v[240:243], a[212:215]
ds_read_b128 v[140:143], v25 offset:2048
v_lshlrev_b32 v81, 16, v38
v_mfma_f32_16x16x32_bf16 a[216:219], v[168:171], v[240:243], a[216:219]
s_add_u32 s72, s69, 21504
buffer_load_dwordx4 v3, s[8:11], s72 offen offset:3072 lds
v_mfma_f32_16x16x32_bf16 a[216:219], v[172:175], v[244:247], a[216:219]
ds_read_b128 v[144:147], v24 offset:4096
v_lshlrev_b32 v82, 16, v39
v_mfma_f32_16x16x32_bf16 a[220:223], v[164:167], v[244:247], a[220:223]
ds_read_b128 v[148:151], v25 offset:4096
v_lshlrev_b32 v83, 16, v40
v_mfma_f32_16x16x32_bf16 a[220:223], v[160:163], v[240:243], a[220:223]
ds_read_b128 v[152:155], v24 offset:6144
v_lshlrev_b32 v84, 16, v41
v_mfma_f32_16x16x32_bf16 a[252:255], v[160:163], v[248:251], a[252:255]
ds_read_b128 v[156:159], v25 offset:6144
v_lshlrev_b32 v85, 16, v42
v_mfma_f32_16x16x32_bf16 a[252:255], v[164:167], v[252:255], a[252:255]
s_add_u32 m0, s64, 32768
v_lshlrev_b32 v86, 16, v43
v_lshlrev_b32 v87, 16, v44
v_mfma_f32_16x16x32_bf16 a[248:251], v[172:175], v[252:255], a[248:251]
s_add_u32 s72, s71, 0
buffer_load_dwordx4 v6, s[16:19], s72 offen lds
v_mfma_f32_16x16x32_bf16 a[248:251], v[168:171], v[248:251], a[248:251]
ds_read_b128 v[160:163], v24 offset:8192
v_lshlrev_b32 v88, 16, v45
v_mfma_f32_16x16x32_bf16 a[244:247], v[176:179], v[248:251], a[244:247]
ds_read_b128 v[164:167], v25 offset:8192
v_lshlrev_b32 v89, 16, v46
v_mfma_f32_16x16x32_bf16 a[244:247], v[180:183], v[252:255], a[244:247]
s_add_u32 s72, s71, 31744
buffer_load_dwordx4 v6, s[16:19], s72 offen offset:1024 lds
v_mfma_f32_16x16x32_bf16 a[240:243], v[188:191], v[252:255], a[240:243]
ds_read_b128 v[168:171], v24 offset:10240
v_lshlrev_b32 v90, 16, v47
v_mfma_f32_16x16x32_bf16 a[240:243], v[184:187], v[248:251], a[240:243]
ds_read_b128 v[172:175], v25 offset:10240
v_lshlrev_b32 v91, 16, v48
v_mfma_f32_16x16x32_bf16 a[236:239], v[216:219], v[248:251], a[236:239]
ds_read_b128 v[176:179], v24 offset:12288
v_lshlrev_b32 v92, 16, v49
v_mfma_f32_16x16x32_bf16 a[236:239], v[220:223], v[252:255], a[236:239]
s_add_u32 s72, s71, 63488
buffer_load_dwordx4 v7, s[16:19], s72 offen offset:2048 lds
v_mfma_f32_16x16x32_bf16 a[232:235], v[212:215], v[252:255], a[232:235]
ds_read_b128 v[180:183], v25 offset:12288
v_lshlrev_b32 v93, 16, v50
v_mfma_f32_16x16x32_bf16 a[232:235], v[208:211], v[248:251], a[232:235]
ds_read_b128 v[184:187], v24 offset:14336
v_lshlrev_b32 v94, 16, v51
v_mfma_f32_16x16x32_bf16 a[228:231], v[200:203], v[248:251], a[228:231]
ds_read_b128 v[188:191], v25 offset:14336
v_mul_f32 v95, v75, v91
v_mfma_f32_16x16x32_bf16 a[228:231], v[204:207], v[252:255], a[228:231]
v_lshlrev_b32 v97, 16, v67
v_fmac_f32 v95, v74, v92
v_mfma_f32_16x16x32_bf16 a[224:227], v[196:199], v[252:255], a[224:227]
s_add_u32 s72, s71, 95232
buffer_load_dwordx4 v7, s[16:19], s72 offen offset:3072 lds
v_mfma_f32_16x16x32_bf16 a[224:227], v[192:195], v[248:251], a[224:227]
s_waitcnt lgkmcnt(8)
ds_read_b64_tr_b16 v[232:233], v21 offset:0
v_fmac_f32 v95, v73, v93
v_mfma_f32_16x16x32_bf16 a[0:3], v[224:227], v[128:131], a[0:3]
ds_read_b64_tr_b16 v[234:235], v21 offset:1024
v_fmac_f32 v95, v72, v94
v_mfma_f32_16x16x32_bf16 a[0:3], v[228:231], v[132:135], a[0:3]
ds_read_b64_tr_b16 v[240:241], v22 offset:0
v_mul_f32 v95, v95, v97
v_mfma_f32_16x16x32_bf16 a[4:7], v[228:231], v[140:143], a[4:7]
s_add_u32 m0, s63, 102400
ds_read_b64_tr_b16 v[236:237], v21 offset:8192
v_mul_f32 v96, v75, v90
v_mfma_f32_16x16x32_bf16 a[4:7], v[224:227], v[136:139], a[4:7]
s_add_u32 s72, s69, 32768
buffer_load_dwordx4 v2, s[8:11], s72 offen lds
v_mfma_f32_16x16x32_bf16 a[8:11], v[224:227], v[144:147], a[8:11]
ds_read_b64_tr_b16 v[238:239], v21 offset:9216
v_lshlrev_b32 v97, 16, v66
v_mfma_f32_16x16x32_bf16 a[8:11], v[228:231], v[148:151], a[8:11]
v_fmac_f32 v96, v74, v91
v_fmac_f32 v96, v73, v92
v_mfma_f32_16x16x32_bf16 a[12:15], v[228:231], v[156:159], a[12:15]
s_add_u32 s72, s69, 39936
buffer_load_dwordx4 v3, s[8:11], s72 offen offset:1024 lds
v_mfma_f32_16x16x32_bf16 a[12:15], v[224:227], v[152:155], a[12:15]
s_waitcnt lgkmcnt(5)
ds_read_b64_tr_b16 v[242:243], v22 offset:1024
v_fmac_f32 v96, v72, v93
v_mfma_f32_16x16x32_bf16 a[16:19], v[224:227], v[160:163], a[16:19]
v_mul_f32 v96, v96, v97
v_cvt_pk_bf16_f32 v100, v95, v96
v_mfma_f32_16x16x32_bf16 a[16:19], v[228:231], v[164:167], a[16:19]
ds_read_b64_tr_b16 v[244:245], v22 offset:8192
v_mul_f32 v95, v75, v89
v_mfma_f32_16x16x32_bf16 a[20:23], v[228:231], v[172:175], a[20:23]
v_lshlrev_b32 v97, 16, v65
v_fmac_f32 v95, v74, v90
v_mfma_f32_16x16x32_bf16 a[20:23], v[224:227], v[168:171], a[20:23]
s_add_u32 s72, s69, 47104
buffer_load_dwordx4 v2, s[8:11], s72 offen offset:2048 lds
v_mfma_f32_16x16x32_bf16 a[24:27], v[224:227], v[176:179], a[24:27]
ds_read_b64_tr_b16 v[246:247], v22 offset:9216
v_fmac_f32 v95, v73, v91
v_mfma_f32_16x16x32_bf16 a[24:27], v[228:231], v[180:183], a[24:27]
v_fmac_f32 v95, v72, v92
v_mul_f32 v95, v95, v97
v_mfma_f32_16x16x32_bf16 a[28:31], v[228:231], v[188:191], a[28:31]
v_mul_f32 v96, v75, v88
v_lshlrev_b32 v97, 16, v64
v_mfma_f32_16x16x32_bf16 a[28:31], v[224:227], v[184:187], a[28:31]
s_waitcnt lgkmcnt(3)
v_fmac_f32 v96, v74, v89
v_fmac_f32 v96, v73, v90
v_mfma_f32_16x16x32_bf16 a[60:63], v[232:235], v[184:187], a[60:63]
s_add_u32 s72, s69, 54272
buffer_load_dwordx4 v3, s[8:11], s72 offen offset:3072 lds
v_mfma_f32_16x16x32_bf16 a[60:63], v[236:239], v[188:191], a[60:63]
ds_read_b64_tr_b16 v[248:249], v23 offset:0
v_fmac_f32 v96, v72, v91
v_mfma_f32_16x16x32_bf16 a[56:59], v[236:239], v[180:183], a[56:59]
v_mul_f32 v96, v96, v97
v_cvt_pk_bf16_f32 v101, v95, v96
v_mfma_f32_16x16x32_bf16 a[56:59], v[232:235], v[176:179], a[56:59]
s_add_u32 m0, s64, 49152
ds_read_b64_tr_b16 v[250:251], v23 offset:1024
v_mul_f32 v95, v75, v87
v_mfma_f32_16x16x32_bf16 a[52:55], v[232:235], v[168:171], a[52:55]
s_add_u32 s72, s71, 0
buffer_load_dwordx4 v6, s[20:23], s72 offen lds
v_mfma_f32_16x16x32_bf16 a[52:55], v[236:239], v[172:175], a[52:55]
v_lshlrev_b32 v97, 16, v63
v_fmac_f32 v95, v74, v88
v_mfma_f32_16x16x32_bf16 a[48:51], v[236:239], v[164:167], a[48:51]
v_fmac_f32 v95, v73, v89
v_fmac_f32 v95, v72, v90
v_mfma_f32_16x16x32_bf16 a[48:51], v[232:235], v[160:163], a[48:51]
ds_read_b64_tr_b16 v[252:253], v23 offset:8192
v_mul_f32 v95, v95, v97
v_mfma_f32_16x16x32_bf16 a[44:47], v[232:235], v[152:155], a[44:47]
s_add_u32 s72, s71, 31744
buffer_load_dwordx4 v6, s[20:23], s72 offen offset:1024 lds
v_mfma_f32_16x16x32_bf16 a[44:47], v[236:239], v[156:159], a[44:47]
v_mul_f32 v96, v75, v86
v_lshlrev_b32 v97, 16, v62
v_mfma_f32_16x16x32_bf16 a[40:43], v[236:239], v[148:151], a[40:43]
ds_read_b64_tr_b16 v[254:255], v23 offset:9216
v_fmac_f32 v96, v74, v87
v_mfma_f32_16x16x32_bf16 a[40:43], v[232:235], v[144:147], a[40:43]
v_fmac_f32 v96, v73, v88
v_fmac_f32 v96, v72, v89
v_mfma_f32_16x16x32_bf16 a[36:39], v[232:235], v[136:139], a[36:39]
s_add_u32 s72, s71, 63488
buffer_load_dwordx4 v7, s[20:23], s72 offen offset:2048 lds
v_mfma_f32_16x16x32_bf16 a[36:39], v[236:239], v[140:143], a[36:39]
v_mul_f32 v96, v96, v97
v_cvt_pk_bf16_f32 v102, v95, v96
v_mfma_f32_16x16x32_bf16 a[32:35], v[236:239], v[132:135], a[32:35]
v_mul_f32 v95, v75, v85
v_lshlrev_b32 v97, 16, v61
v_mfma_f32_16x16x32_bf16 a[32:35], v[232:235], v[128:131], a[32:35]
s_waitcnt lgkmcnt(4)
v_fmac_f32 v95, v74, v86
v_fmac_f32 v95, v73, v87
v_mfma_f32_16x16x32_bf16 a[64:67], v[240:243], v[128:131], a[64:67]
s_add_u32 s72, s71, 95232
buffer_load_dwordx4 v7, s[20:23], s72 offen offset:3072 lds
v_mfma_f32_16x16x32_bf16 a[64:67], v[244:247], v[132:135], a[64:67]
s_mov_b32 s80, 0x0
buffer_load_dword v126, v125, s[12:15], s80 offen
v_mfma_f32_16x16x32_bf16 a[68:71], v[244:247], v[140:143], a[68:71]
s_mov_b32 s80, 0x100000
buffer_load_dword v126, v125, s[12:15], s80 offen
v_mfma_f32_16x16x32_bf16 a[68:71], v[240:243], v[136:139], a[68:71]
s_mov_b32 s80, 0x200000
buffer_load_dword v126, v125, s[12:15], s80 offen
v_mfma_f32_16x16x32_bf16 a[72:75], v[240:243], v[144:147], a[72:75]
s_mov_b32 s80, 0x300000
buffer_load_dword v126, v125, s[12:15], s80 offen
v_mfma_f32_16x16x32_bf16 a[72:75], v[244:247], v[148:151], a[72:75]
ds_read_b64_tr_b16 v[224:225], v20 offset:16384
v_fmac_f32 v95, v72, v88
v_mfma_f32_16x16x32_bf16 a[76:79], v[244:247], v[156:159], a[76:79]
v_mul_f32 v95, v95, v97
v_mul_f32 v96, v75, v84
v_mfma_f32_16x16x32_bf16 a[76:79], v[240:243], v[152:155], a[76:79]
ds_read_b64_tr_b16 v[226:227], v20 offset:17408
v_lshlrev_b32 v97, 16, v60
v_mfma_f32_16x16x32_bf16 a[80:83], v[240:243], v[160:163], a[80:83]
v_fmac_f32 v96, v74, v85
v_fmac_f32 v96, v73, v86
v_mfma_f32_16x16x32_bf16 a[80:83], v[244:247], v[164:167], a[80:83]
ds_read_b64_tr_b16 v[228:229], v20 offset:24576
v_fmac_f32 v96, v72, v87
v_mfma_f32_16x16x32_bf16 a[84:87], v[244:247], v[172:175], a[84:87]
v_mul_f32 v96, v96, v97
v_cvt_pk_bf16_f32 v103, v95, v96
v_mfma_f32_16x16x32_bf16 a[84:87], v[240:243], v[168:171], a[84:87]
ds_read_b64_tr_b16 v[230:231], v20 offset:25600
ds_write_b128 v28, v[100:103] offset:0
v_mfma_f32_16x16x32_bf16 a[88:91], v[240:243], v[176:179], a[88:91]
v_mul_f32 v95, v75, v83
v_lshlrev_b32 v97, 16, v59
v_mfma_f32_16x16x32_bf16 a[88:91], v[244:247], v[180:183], a[88:91]
v_fmac_f32 v95, v74, v84
v_fmac_f32 v95, v73, v85
v_mfma_f32_16x16x32_bf16 a[92:95], v[244:247], v[188:191], a[92:95]
v_fmac_f32 v95, v72, v86
v_mul_f32 v95, v95, v97
v_mfma_f32_16x16x32_bf16 a[92:95], v[240:243], v[184:187], a[92:95]
s_waitcnt lgkmcnt(5)
v_mul_f32 v96, v75, v82
v_lshlrev_b32 v97, 16, v58
v_mfma_f32_16x16x32_bf16 a[124:127], v[248:251], v[184:187], a[124:127]
ds_read_b64_tr_b16 v[232:233], v21 offset:16384
v_fmac_f32 v96, v74, v83
v_mfma_f32_16x16x32_bf16 a[124:127], v[252:255], v[188:191], a[124:127]
v_fmac_f32 v96, v73, v84
v_fmac_f32 v96, v72, v85
v_mfma_f32_16x16x32_bf16 a[120:123], v[252:255], v[180:183], a[120:123]
v_mul_f32 v96, v96, v97
v_cvt_pk_bf16_f32 v104, v95, v96
v_mfma_f32_16x16x32_bf16 a[120:123], v[248:251], v[176:179], a[120:123]
ds_read_b64_tr_b16 v[234:235], v21 offset:17408
v_mul_f32 v95, v75, v81
v_mfma_f32_16x16x32_bf16 a[116:119], v[248:251], v[168:171], a[116:119]
v_lshlrev_b32 v97, 16, v57
v_fmac_f32 v95, v74, v82
v_mfma_f32_16x16x32_bf16 a[116:119], v[252:255], v[172:175], a[116:119]
v_fmac_f32 v95, v73, v83
v_fmac_f32 v95, v72, v84
v_mfma_f32_16x16x32_bf16 a[112:115], v[252:255], v[164:167], a[112:115]
v_mul_f32 v95, v95, v97
v_mul_f32 v96, v75, v80
v_mfma_f32_16x16x32_bf16 a[112:115], v[248:251], v[160:163], a[112:115]
ds_read_b64_tr_b16 v[236:237], v21 offset:24576
v_lshlrev_b32 v97, 16, v56
v_mfma_f32_16x16x32_bf16 a[108:111], v[248:251], v[152:155], a[108:111]
v_fmac_f32 v96, v74, v81
v_fmac_f32 v96, v73, v82
v_mfma_f32_16x16x32_bf16 a[108:111], v[252:255], v[156:159], a[108:111]
v_fmac_f32 v96, v72, v83
v_mul_f32 v96, v96, v97
v_mfma_f32_16x16x32_bf16 a[104:107], v[252:255], v[148:151], a[104:107]
ds_read_b64_tr_b16 v[238:239], v21 offset:25600
v_cvt_pk_bf16_f32 v105, v95, v96
v_mfma_f32_16x16x32_bf16 a[104:107], v[248:251], v[144:147], a[104:107]
v_mul_f32 v95, v75, v79
v_lshlrev_b32 v97, 16, v55
v_mfma_f32_16x16x32_bf16 a[100:103], v[248:251], v[136:139], a[100:103]
v_fmac_f32 v95, v74, v80
v_fmac_f32 v95, v73, v81
v_mfma_f32_16x16x32_bf16 a[100:103], v[252:255], v[140:143], a[100:103]
v_fmac_f32 v95, v72, v82
v_mul_f32 v95, v95, v97
v_mfma_f32_16x16x32_bf16 a[96:99], v[252:255], v[132:135], a[96:99]
v_mul_f32 v96, v75, v78
v_lshlrev_b32 v97, 16, v54
v_mfma_f32_16x16x32_bf16 a[96:99], v[248:251], v[128:131], a[96:99]
s_waitcnt lgkmcnt(5)
v_fmac_f32 v96, v74, v79
v_fmac_f32 v96, v73, v80
v_mfma_f32_16x16x32_bf16 a[128:131], v[128:131], v[224:227], a[128:131]
ds_read_b64_tr_b16 v[240:241], v22 offset:16384
v_fmac_f32 v96, v72, v81
v_mfma_f32_16x16x32_bf16 a[128:131], v[132:135], v[228:231], a[128:131]
v_mul_f32 v96, v96, v97
v_cvt_pk_bf16_f32 v106, v95, v96
v_mfma_f32_16x16x32_bf16 a[132:135], v[140:143], v[228:231], a[132:135]
v_mul_f32 v95, v75, v77
v_lshlrev_b32 v97, 16, v53
v_mfma_f32_16x16x32_bf16 a[132:135], v[136:139], v[224:227], a[132:135]
ds_read_b64_tr_b16 v[242:243], v22 offset:17408
v_fmac_f32 v95, v74, v78
v_mfma_f32_16x16x32_bf16 a[136:139], v[144:147], v[224:227], a[136:139]
v_fmac_f32 v95, v73, v79
v_fmac_f32 v95, v72, v80
v_mfma_f32_16x16x32_bf16 a[136:139], v[148:151], v[228:231], a[136:139]
v_mul_f32 v95, v95, v97
v_mul_f32 v96, v75, v76
v_mfma_f32_16x16x32_bf16 a[140:143], v[156:159], v[228:231], a[140:143]
v_lshlrev_b32 v97, 16, v52
v_fmac_f32 v96, v74, v77
v_mfma_f32_16x16x32_bf16 a[140:143], v[152:155], v[224:227], a[140:143]
ds_read_b64_tr_b16 v[244:245], v22 offset:24576
v_fmac_f32 v96, v73, v78
v_mfma_f32_16x16x32_bf16 a[144:147], v[160:163], v[224:227], a[144:147]
v_fmac_f32 v96, v72, v79
v_mul_f32 v96, v96, v97
v_mfma_f32_16x16x32_bf16 a[144:147], v[164:167], v[228:231], a[144:147]
v_cvt_pk_bf16_f32 v107, v95, v96
v_mfma_f32_16x16x32_bf16 a[148:151], v[172:175], v[228:231], a[148:151]
ds_read_b64_tr_b16 v[246:247], v22 offset:25600
ds_write_b128 v28, v[104:107] offset:16
v_mfma_f32_16x16x32_bf16 a[148:151], v[168:171], v[224:227], a[148:151]
global_load_dwordx4 v[84:87], v1, s[56:57]
v_mfma_f32_16x16x32_bf16 a[152:155], v[176:179], v[224:227], a[152:155]
global_load_dwordx4 v[88:91], v1, s[56:57] offset:1024
v_mfma_f32_16x16x32_bf16 a[152:155], v[180:183], v[228:231], a[152:155]
v_lshlrev_b32 v72, 16, v70
v_and_b32 v73, 0xffff0000, v70
v_mfma_f32_16x16x32_bf16 a[156:159], v[188:191], v[228:231], a[156:159]
v_lshlrev_b32 v74, 16, v71
v_and_b32 v75, 0xffff0000, v71
v_mfma_f32_16x16x32_bf16 a[156:159], v[184:187], v[224:227], a[156:159]
s_waitcnt lgkmcnt(5)
v_and_b32 v33, 0xffff0000, v33
v_and_b32 v34, 0xffff0000, v34
v_mfma_f32_16x16x32_bf16 a[188:191], v[184:187], v[232:235], a[188:191]
ds_read_b64_tr_b16 v[248:249], v23 offset:16384
v_and_b32 v35, 0xffff0000, v35
v_mfma_f32_16x16x32_bf16 a[188:191], v[188:191], v[236:239], a[188:191]
v_and_b32 v36, 0xffff0000, v36
v_and_b32 v37, 0xffff0000, v37
v_mfma_f32_16x16x32_bf16 a[184:187], v[180:183], v[236:239], a[184:187]
ds_read_b64_tr_b16 v[250:251], v23 offset:17408
v_and_b32 v38, 0xffff0000, v38
v_mfma_f32_16x16x32_bf16 a[184:187], v[176:179], v[232:235], a[184:187]
v_and_b32 v39, 0xffff0000, v39
v_and_b32 v40, 0xffff0000, v40
v_mfma_f32_16x16x32_bf16 a[180:183], v[168:171], v[232:235], a[180:183]
ds_read_b64_tr_b16 v[252:253], v23 offset:24576
v_and_b32 v41, 0xffff0000, v41
v_mfma_f32_16x16x32_bf16 a[180:183], v[172:175], v[236:239], a[180:183]
v_and_b32 v42, 0xffff0000, v42
v_and_b32 v43, 0xffff0000, v43
v_mfma_f32_16x16x32_bf16 a[176:179], v[164:167], v[236:239], a[176:179]
ds_read_b64_tr_b16 v[254:255], v23 offset:25600
v_and_b32 v44, 0xffff0000, v44
v_mfma_f32_16x16x32_bf16 a[176:179], v[160:163], v[232:235], a[176:179]
v_and_b32 v45, 0xffff0000, v45
v_and_b32 v46, 0xffff0000, v46
v_mfma_f32_16x16x32_bf16 a[172:175], v[152:155], v[232:235], a[172:175]
v_and_b32 v47, 0xffff0000, v47
v_and_b32 v48, 0xffff0000, v48
v_mfma_f32_16x16x32_bf16 a[172:175], v[156:159], v[236:239], a[172:175]
v_and_b32 v49, 0xffff0000, v49
v_and_b32 v50, 0xffff0000, v50
v_mfma_f32_16x16x32_bf16 a[168:171], v[148:151], v[236:239], a[168:171]
v_and_b32 v51, 0xffff0000, v51
v_mul_f32 v95, v75, v48
v_mfma_f32_16x16x32_bf16 a[168:171], v[144:147], v[232:235], a[168:171]
v_and_b32 v97, 0xffff0000, v67
v_fmac_f32 v95, v74, v49
v_mfma_f32_16x16x32_bf16 a[164:167], v[136:139], v[232:235], a[164:167]
v_fmac_f32 v95, v73, v50
v_fmac_f32 v95, v72, v51
v_mfma_f32_16x16x32_bf16 a[164:167], v[140:143], v[236:239], a[164:167]
v_mul_f32 v95, v95, v97
v_mul_f32 v96, v75, v47
v_mfma_f32_16x16x32_bf16 a[160:163], v[132:135], v[236:239], a[160:163]
s_waitcnt vmcnt(6) lgkmcnt(0)
v_and_b32 v97, 0xffff0000, v66
v_fmac_f32 v96, v74, v48
v_mfma_f32_16x16x32_bf16 a[160:163], v[128:131], v[232:235], a[160:163]
s_barrier
v_fmac_f32 v96, v73, v49
v_fmac_f32 v96, v72, v50
v_mfma_f32_16x16x32_bf16 a[192:195], v[128:131], v[240:243], a[192:195]
s_and_b32 s73, s65, 1
ds_read_b64_tr_b16 v[224:225], v20 offset:32768
v_mul_f32 v96, v96, v97
v_mfma_f32_16x16x32_bf16 a[192:195], v[132:135], v[244:247], a[192:195]
s_xor_b32 s73, s73, 6
ds_read_b64_tr_b16 v[226:227], v20 offset:33792
v_cvt_pk_bf16_f32 v100, v95, v96
v_mfma_f32_16x16x32_bf16 a[196:199], v[140:143], v[244:247], a[196:199]
s_lshl_b32 s69, s73, 7
ds_read_b64_tr_b16 v[228:229], v20 offset:40960
v_mul_f32 v95, v75, v46
v_mfma_f32_16x16x32_bf16 a[196:199], v[136:139], v[240:243], a[196:199]
s_add_u32 s69, s69, s84
ds_read_b64_tr_b16 v[230:231], v20 offset:41984
v_and_b32 v97, 0xffff0000, v65
v_mfma_f32_16x16x32_bf16 a[200:203], v[144:147], v[240:243], a[200:203]
s_lshl_b32 s71, s73, 19
ds_read_b128 v[192:195], v24 offset:32768
v_fmac_f32 v95, v74, v47
v_mfma_f32_16x16x32_bf16 a[200:203], v[148:151], v[244:247], a[200:203]
s_add_u32 s71, s71, s66
ds_read_b128 v[196:199], v25 offset:32768
v_fmac_f32 v95, v73, v48
v_mfma_f32_16x16x32_bf16 a[204:207], v[156:159], v[244:247], a[204:207]
s_add_u32 m0, s63, 65536
v_fmac_f32 v95, v72, v49
v_mul_f32 v95, v95, v97
v_mfma_f32_16x16x32_bf16 a[204:207], v[152:155], v[240:243], a[204:207]
s_add_u32 s72, s69, 0
buffer_load_dwordx4 v2, s[8:11], s72 offen lds
v_mfma_f32_16x16x32_bf16 a[208:211], v[160:163], v[240:243], a[208:211]
s_add_u32 s72, s69, 7168
buffer_load_dwordx4 v3, s[8:11], s72 offen offset:1024 lds
v_mfma_f32_16x16x32_bf16 a[208:211], v[164:167], v[244:247], a[208:211]
s_add_u32 s72, s69, 14336
buffer_load_dwordx4 v2, s[8:11], s72 offen offset:2048 lds
v_mfma_f32_16x16x32_bf16 a[212:215], v[172:175], v[244:247], a[212:215]
ds_read_b128 v[200:203], v24 offset:34816
v_mul_f32 v96, v75, v45
v_mfma_f32_16x16x32_bf16 a[212:215], v[168:171], v[240:243], a[212:215]
ds_read_b128 v[204:207], v25 offset:34816
v_and_b32 v97, 0xffff0000, v64
v_mfma_f32_16x16x32_bf16 a[216:219], v[176:179], v[240:243], a[216:219]
s_add_u32 s72, s69, 21504
buffer_load_dwordx4 v3, s[8:11], s72 offen offset:3072 lds
v_mfma_f32_16x16x32_bf16 a[216:219], v[180:183], v[244:247], a[216:219]
ds_read_b128 v[208:211], v24 offset:36864
v_fmac_f32 v96, v74, v46
v_mfma_f32_16x16x32_bf16 a[220:223], v[188:191], v[244:247], a[220:223]
ds_read_b128 v[212:215], v25 offset:36864
v_fmac_f32 v96, v73, v47
v_mfma_f32_16x16x32_bf16 a[220:223], v[184:187], v[240:243], a[220:223]
ds_read_b128 v[216:219], v24 offset:38912
v_fmac_f32 v96, v72, v48
v_mfma_f32_16x16x32_bf16 a[252:255], v[184:187], v[248:251], a[252:255]
ds_read_b128 v[220:223], v25 offset:38912
v_mul_f32 v96, v96, v97
v_mfma_f32_16x16x32_bf16 a[252:255], v[188:191], v[252:255], a[252:255]
s_add_u32 m0, s64, 0
v_cvt_pk_bf16_f32 v101, v95, v96
v_mul_f32 v95, v75, v44
v_mfma_f32_16x16x32_bf16 a[248:251], v[180:183], v[252:255], a[248:251]
s_add_u32 s72, s71, 0
buffer_load_dwordx4 v6, s[16:19], s72 offen lds
v_mfma_f32_16x16x32_bf16 a[248:251], v[176:179], v[248:251], a[248:251]
ds_read_b128 v[184:187], v24 offset:40960
v_and_b32 v97, 0xffff0000, v63
v_mfma_f32_16x16x32_bf16 a[244:247], v[168:171], v[248:251], a[244:247]
ds_read_b128 v[188:191], v25 offset:40960
v_fmac_f32 v95, v74, v45
v_mfma_f32_16x16x32_bf16 a[244:247], v[172:175], v[252:255], a[244:247]
s_add_u32 s72, s71, 31744
buffer_load_dwordx4 v6, s[16:19], s72 offen offset:1024 lds
v_mfma_f32_16x16x32_bf16 a[240:243], v[164:167], v[252:255], a[240:243]
ds_read_b128 v[176:179], v24 offset:43008
v_fmac_f32 v95, v73, v46
v_mfma_f32_16x16x32_bf16 a[240:243], v[160:163], v[248:251], a[240:243]
ds_read_b128 v[180:183], v25 offset:43008
v_fmac_f32 v95, v72, v47
v_mfma_f32_16x16x32_bf16 a[236:239], v[152:155], v[248:251], a[236:239]
ds_read_b128 v[168:171], v24 offset:45056
v_mul_f32 v95, v95, v97
v_mfma_f32_16x16x32_bf16 a[236:239], v[156:159], v[252:255], a[236:239]
s_add_u32 s72, s71, 63488
buffer_load_dwordx4 v7, s[16:19], s72 offen offset:2048 lds
v_mfma_f32_16x16x32_bf16 a[232:235], v[148:151], v[252:255], a[232:235]
ds_read_b128 v[172:175], v25 offset:45056
v_mul_f32 v96, v75, v43
v_mfma_f32_16x16x32_bf16 a[232:235], v[144:147], v[248:251], a[232:235]
ds_read_b128 v[160:163], v24 offset:47104
v_and_b32 v97, 0xffff0000, v62
v_mfma_f32_16x16x32_bf16 a[228:231], v[136:139], v[248:251], a[228:231]
ds_read_b128 v[164:167], v25 offset:47104
v_fmac_f32 v96, v74, v44
v_mfma_f32_16x16x32_bf16 a[228:231], v[140:143], v[252:255], a[228:231]
v_fmac_f32 v96, v73, v45
v_fmac_f32 v96, v72, v46
v_mfma_f32_16x16x32_bf16 a[224:227], v[132:135], v[252:255], a[224:227]
s_add_u32 s72, s71, 95232
buffer_load_dwordx4 v7, s[16:19], s72 offen offset:3072 lds
v_mfma_f32_16x16x32_bf16 a[224:227], v[128:131], v[248:251], a[224:227]
s_waitcnt lgkmcnt(8)
ds_read_b64_tr_b16 v[232:233], v21 offset:32768
v_mul_f32 v96, v96, v97
v_mfma_f32_16x16x32_bf16 a[0:3], v[224:227], v[192:195], a[0:3]
ds_read_b64_tr_b16 v[234:235], v21 offset:33792
v_cvt_pk_bf16_f32 v102, v95, v96
v_mfma_f32_16x16x32_bf16 a[0:3], v[228:231], v[196:199], a[0:3]
ds_read_b64_tr_b16 v[240:241], v22 offset:32768
v_mul_f32 v95, v75, v42
v_mfma_f32_16x16x32_bf16 a[4:7], v[228:231], v[204:207], a[4:7]
s_add_u32 m0, s63, 69632
ds_read_b64_tr_b16 v[236:237], v21 offset:40960
v_and_b32 v97, 0xffff0000, v61
v_mfma_f32_16x16x32_bf16 a[4:7], v[224:227], v[200:203], a[4:7]
s_add_u32 s72, s69, 32768
buffer_load_dwordx4 v2, s[8:11], s72 offen lds
v_mfma_f32_16x16x32_bf16 a[8:11], v[224:227], v[208:211], a[8:11]
ds_read_b64_tr_b16 v[238:239], v21 offset:41984
v_fmac_f32 v95, v74, v43
v_mfma_f32_16x16x32_bf16 a[8:11], v[228:231], v[212:215], a[8:11]
v_fmac_f32 v95, v73, v44
v_fmac_f32 v95, v72, v45
v_mfma_f32_16x16x32_bf16 a[12:15], v[228:231], v[220:223], a[12:15]
s_add_u32 s72, s69, 39936
buffer_load_dwordx4 v3, s[8:11], s72 offen offset:1024 lds
v_mfma_f32_16x16x32_bf16 a[12:15], v[224:227], v[216:219], a[12:15]
s_waitcnt lgkmcnt(5)
ds_read_b64_tr_b16 v[242:243], v22 offset:33792
v_mul_f32 v95, v95, v97
v_mfma_f32_16x16x32_bf16 a[16:19], v[224:227], v[184:187], a[16:19]
v_mul_f32 v96, v75, v41
v_and_b32 v97, 0xffff0000, v60
v_mfma_f32_16x16x32_bf16 a[16:19], v[228:231], v[188:191], a[16:19]
ds_read_b64_tr_b16 v[244:245], v22 offset:40960
v_fmac_f32 v96, v74, v42
v_mfma_f32_16x16x32_bf16 a[20:23], v[228:231], v[180:183], a[20:23]
v_fmac_f32 v96, v73, v43
v_fmac_f32 v96, v72, v44
v_mfma_f32_16x16x32_bf16 a[20:23], v[224:227], v[176:179], a[20:23]
s_add_u32 s72, s69, 47104
buffer_load_dwordx4 v2, s[8:11], s72 offen offset:2048 lds
v_mfma_f32_16x16x32_bf16 a[24:27], v[224:227], v[168:171], a[24:27]
ds_read_b64_tr_b16 v[246:247], v22 offset:41984
v_mul_f32 v96, v96, v97
v_mfma_f32_16x16x32_bf16 a[24:27], v[228:231], v[172:175], a[24:27]
v_cvt_pk_bf16_f32 v103, v95, v96
v_mfma_f32_16x16x32_bf16 a[28:31], v[228:231], v[164:167], a[28:31]
ds_write_b128 v28, v[100:103] offset:272
v_mul_f32 v95, v75, v40
v_mfma_f32_16x16x32_bf16 a[28:31], v[224:227], v[160:163], a[28:31]
s_waitcnt lgkmcnt(4)
v_and_b32 v97, 0xffff0000, v59
v_fmac_f32 v95, v74, v41
v_mfma_f32_16x16x32_bf16 a[60:63], v[232:235], v[160:163], a[60:63]
s_add_u32 s72, s69, 54272
buffer_load_dwordx4 v3, s[8:11], s72 offen offset:3072 lds
v_mfma_f32_16x16x32_bf16 a[60:63], v[236:239], v[164:167], a[60:63]
ds_read_b64_tr_b16 v[248:249], v23 offset:32768
v_fmac_f32 v95, v73, v42
v_mfma_f32_16x16x32_bf16 a[56:59], v[236:239], v[172:175], a[56:59]
v_fmac_f32 v95, v72, v43
v_mul_f32 v95, v95, v97
v_mfma_f32_16x16x32_bf16 a[56:59], v[232:235], v[168:171], a[56:59]
s_add_u32 m0, s64, 16384
ds_read_b64_tr_b16 v[250:251], v23 offset:33792
v_mul_f32 v96, v75, v39
v_mfma_f32_16x16x32_bf16 a[52:55], v[232:235], v[176:179], a[52:55]
s_add_u32 s72, s71, 0
buffer_load_dwordx4 v6, s[20:23], s72 offen lds
v_mfma_f32_16x16x32_bf16 a[52:55], v[236:239], v[180:183], a[52:55]
v_and_b32 v97, 0xffff0000, v58
v_fmac_f32 v96, v74, v40
v_mfma_f32_16x16x32_bf16 a[48:51], v[236:239], v[188:191], a[48:51]
v_fmac_f32 v96, v73, v41
v_fmac_f32 v96, v72, v42
v_mfma_f32_16x16x32_bf16 a[48:51], v[232:235], v[184:187], a[48:51]
ds_read_b64_tr_b16 v[252:253], v23 offset:40960
v_mul_f32 v96, v96, v97
v_mfma_f32_16x16x32_bf16 a[44:47], v[232:235], v[216:219], a[44:47]
s_add_u32 s72, s71, 31744
buffer_load_dwordx4 v6, s[20:23], s72 offen offset:1024 lds
v_mfma_f32_16x16x32_bf16 a[44:47], v[236:239], v[220:223], a[44:47]
v_cvt_pk_bf16_f32 v104, v95, v96
v_mul_f32 v95, v75, v38
v_mfma_f32_16x16x32_bf16 a[40:43], v[236:239], v[212:215], a[40:43]
ds_read_b64_tr_b16 v[254:255], v23 offset:41984
v_and_b32 v97, 0xffff0000, v57
v_mfma_f32_16x16x32_bf16 a[40:43], v[232:235], v[208:211], a[40:43]
v_fmac_f32 v95, v74, v39
v_fmac_f32 v95, v73, v40
v_mfma_f32_16x16x32_bf16 a[36:39], v[232:235], v[200:203], a[36:39]
s_add_u32 s72, s71, 63488
buffer_load_dwordx4 v7, s[20:23], s72 offen offset:2048 lds
v_mfma_f32_16x16x32_bf16 a[36:39], v[236:239], v[204:207], a[36:39]
v_fmac_f32 v95, v72, v41
v_mul_f32 v95, v95, v97
v_mfma_f32_16x16x32_bf16 a[32:35], v[236:239], v[196:199], a[32:35]
v_mul_f32 v96, v75, v37
v_and_b32 v97, 0xffff0000, v56
v_mfma_f32_16x16x32_bf16 a[32:35], v[232:235], v[192:195], a[32:35]
s_waitcnt lgkmcnt(5)
v_fmac_f32 v96, v74, v38
v_fmac_f32 v96, v73, v39
v_mfma_f32_16x16x32_bf16 a[64:67], v[240:243], v[192:195], a[64:67]
s_add_u32 s72, s71, 95232
buffer_load_dwordx4 v7, s[20:23], s72 offen offset:3072 lds
v_mfma_f32_16x16x32_bf16 a[64:67], v[244:247], v[196:199], a[64:67]
s_mov_b32 s80, 0x400000
buffer_load_dword v126, v125, s[12:15], s80 offen
v_mfma_f32_16x16x32_bf16 a[68:71], v[244:247], v[204:207], a[68:71]
s_mov_b32 s80, 0x500000
buffer_load_dword v126, v125, s[12:15], s80 offen
v_mfma_f32_16x16x32_bf16 a[68:71], v[240:243], v[200:203], a[68:71]
s_mov_b32 s80, 0x600000
buffer_load_dword v126, v125, s[12:15], s80 offen
v_mfma_f32_16x16x32_bf16 a[72:75], v[240:243], v[208:211], a[72:75]
s_mov_b32 s80, 0x700000
buffer_load_dword v126, v125, s[12:15], s80 offen
v_mfma_f32_16x16x32_bf16 a[72:75], v[244:247], v[212:215], a[72:75]
ds_read_b64_tr_b16 v[224:225], v20 offset:49152
v_fmac_f32 v96, v72, v40
v_mfma_f32_16x16x32_bf16 a[76:79], v[244:247], v[220:223], a[76:79]
v_mul_f32 v96, v96, v97
v_cvt_pk_bf16_f32 v105, v95, v96
v_mfma_f32_16x16x32_bf16 a[76:79], v[240:243], v[216:219], a[76:79]
ds_read_b64_tr_b16 v[226:227], v20 offset:50176
v_mul_f32 v95, v75, v36
v_mfma_f32_16x16x32_bf16 a[80:83], v[240:243], v[184:187], a[80:83]
v_and_b32 v97, 0xffff0000, v55
v_fmac_f32 v95, v74, v37
v_mfma_f32_16x16x32_bf16 a[80:83], v[244:247], v[188:191], a[80:83]
ds_read_b64_tr_b16 v[228:229], v20 offset:57344
v_fmac_f32 v95, v73, v38
v_mfma_f32_16x16x32_bf16 a[84:87], v[244:247], v[180:183], a[84:87]
v_fmac_f32 v95, v72, v39
v_mul_f32 v95, v95, v97
v_mfma_f32_16x16x32_bf16 a[84:87], v[240:243], v[176:179], a[84:87]
ds_read_b64_tr_b16 v[230:231], v20 offset:58368
v_mul_f32 v96, v75, v35
v_mfma_f32_16x16x32_bf16 a[88:91], v[240:243], v[168:171], a[88:91]
v_and_b32 v97, 0xffff0000, v54
v_fmac_f32 v96, v74, v36
v_mfma_f32_16x16x32_bf16 a[88:91], v[244:247], v[172:175], a[88:91]
v_fmac_f32 v96, v73, v37
v_fmac_f32 v96, v72, v38
v_mfma_f32_16x16x32_bf16 a[92:95], v[244:247], v[164:167], a[92:95]
v_mul_f32 v96, v96, v97
v_cvt_pk_bf16_f32 v106, v95, v96
v_mfma_f32_16x16x32_bf16 a[92:95], v[240:243], v[160:163], a[92:95]
s_waitcnt lgkmcnt(4)
v_mul_f32 v95, v75, v34
v_and_b32 v97, 0xffff0000, v53
v_mfma_f32_16x16x32_bf16 a[124:127], v[248:251], v[160:163], a[124:127]
ds_read_b64_tr_b16 v[232:233], v21 offset:49152
v_fmac_f32 v95, v74, v35
v_mfma_f32_16x16x32_bf16 a[124:127], v[252:255], v[164:167], a[124:127]
v_fmac_f32 v95, v73, v36
v_fmac_f32 v95, v72, v37
v_mfma_f32_16x16x32_bf16 a[120:123], v[252:255], v[172:175], a[120:123]
v_mul_f32 v95, v95, v97
v_mul_f32 v96, v75, v33
v_mfma_f32_16x16x32_bf16 a[120:123], v[248:251], v[168:171], a[120:123]
ds_read_b64_tr_b16 v[234:235], v21 offset:50176
v_and_b32 v97, 0xffff0000, v52
v_mfma_f32_16x16x32_bf16 a[116:119], v[248:251], v[176:179], a[116:119]
v_fmac_f32 v96, v74, v34
v_fmac_f32 v96, v73, v35
v_mfma_f32_16x16x32_bf16 a[116:119], v[252:255], v[180:183], a[116:119]
v_fmac_f32 v96, v72, v36
v_mul_f32 v96, v96, v97
v_mfma_f32_16x16x32_bf16 a[112:115], v[252:255], v[188:191], a[112:115]
v_cvt_pk_bf16_f32 v107, v95, v96
v_mfma_f32_16x16x32_bf16 a[112:115], v[248:251], v[184:187], a[112:115]
ds_read_b64_tr_b16 v[236:237], v21 offset:57344
ds_write_b128 v28, v[104:107] offset:288
v_mfma_f32_16x16x32_bf16 a[108:111], v[248:251], v[216:219], a[108:111]
v_mfma_f32_16x16x32_bf16 a[108:111], v[252:255], v[220:223], a[108:111]
v_mfma_f32_16x16x32_bf16 a[104:107], v[252:255], v[212:215], a[104:107]
ds_read_b64_tr_b16 v[238:239], v21 offset:58368
v_mfma_f32_16x16x32_bf16 a[104:107], v[248:251], v[208:211], a[104:107]
v_mfma_f32_16x16x32_bf16 a[100:103], v[248:251], v[200:203], a[100:103]
v_mfma_f32_16x16x32_bf16 a[100:103], v[252:255], v[204:207], a[100:103]
v_mfma_f32_16x16x32_bf16 a[96:99], v[252:255], v[196:199], a[96:99]
v_mfma_f32_16x16x32_bf16 a[96:99], v[248:251], v[192:195], a[96:99]
s_waitcnt lgkmcnt(5)
v_mfma_f32_16x16x32_bf16 a[128:131], v[192:195], v[224:227], a[128:131]
ds_read_b64_tr_b16 v[240:241], v22 offset:49152
v_mfma_f32_16x16x32_bf16 a[128:131], v[196:199], v[228:231], a[128:131]
v_mfma_f32_16x16x32_bf16 a[132:135], v[204:207], v[228:231], a[132:135]
v_mfma_f32_16x16x32_bf16 a[132:135], v[200:203], v[224:227], a[132:135]
ds_read_b64_tr_b16 v[242:243], v22 offset:50176
v_mfma_f32_16x16x32_bf16 a[136:139], v[208:211], v[224:227], a[136:139]
v_mfma_f32_16x16x32_bf16 a[136:139], v[212:215], v[228:231], a[136:139]
v_mfma_f32_16x16x32_bf16 a[140:143], v[220:223], v[228:231], a[140:143]
v_mfma_f32_16x16x32_bf16 a[140:143], v[216:219], v[224:227], a[140:143]
ds_read_b64_tr_b16 v[244:245], v22 offset:57344
v_mfma_f32_16x16x32_bf16 a[144:147], v[184:187], v[224:227], a[144:147]
v_mfma_f32_16x16x32_bf16 a[144:147], v[188:191], v[228:231], a[144:147]
v_mfma_f32_16x16x32_bf16 a[148:151], v[180:183], v[228:231], a[148:151]
ds_read_b64_tr_b16 v[246:247], v22 offset:58368
v_mfma_f32_16x16x32_bf16 a[148:151], v[176:179], v[224:227], a[148:151]
v_mfma_f32_16x16x32_bf16 a[152:155], v[168:171], v[224:227], a[152:155]
v_mfma_f32_16x16x32_bf16 a[152:155], v[172:175], v[228:231], a[152:155]
v_mfma_f32_16x16x32_bf16 a[156:159], v[164:167], v[228:231], a[156:159]
v_mfma_f32_16x16x32_bf16 a[156:159], v[160:163], v[224:227], a[156:159]
s_waitcnt lgkmcnt(4)
v_mfma_f32_16x16x32_bf16 a[188:191], v[160:163], v[232:235], a[188:191]
ds_read_b64_tr_b16 v[248:249], v23 offset:49152
v_mfma_f32_16x16x32_bf16 a[188:191], v[164:167], v[236:239], a[188:191]
v_mfma_f32_16x16x32_bf16 a[184:187], v[172:175], v[236:239], a[184:187]
ds_read_b64_tr_b16 v[250:251], v23 offset:50176
v_mfma_f32_16x16x32_bf16 a[184:187], v[168:171], v[232:235], a[184:187]
v_mfma_f32_16x16x32_bf16 a[180:183], v[176:179], v[232:235], a[180:183]
ds_read_b64_tr_b16 v[252:253], v23 offset:57344
v_mfma_f32_16x16x32_bf16 a[180:183], v[180:183], v[236:239], a[180:183]
v_mfma_f32_16x16x32_bf16 a[176:179], v[188:191], v[236:239], a[176:179]
ds_read_b64_tr_b16 v[254:255], v23 offset:58368
v_mfma_f32_16x16x32_bf16 a[176:179], v[184:187], v[232:235], a[176:179]
v_mfma_f32_16x16x32_bf16 a[172:175], v[216:219], v[232:235], a[172:175]
v_mfma_f32_16x16x32_bf16 a[172:175], v[220:223], v[236:239], a[172:175]
v_mfma_f32_16x16x32_bf16 a[168:171], v[212:215], v[236:239], a[168:171]
v_mfma_f32_16x16x32_bf16 a[168:171], v[208:211], v[232:235], a[168:171]
v_mfma_f32_16x16x32_bf16 a[164:167], v[200:203], v[232:235], a[164:167]
v_mfma_f32_16x16x32_bf16 a[164:167], v[204:207], v[236:239], a[164:167]
v_mfma_f32_16x16x32_bf16 a[160:163], v[196:199], v[236:239], a[160:163]
s_waitcnt vmcnt(4) lgkmcnt(0)
v_mfma_f32_16x16x32_bf16 a[160:163], v[192:195], v[232:235], a[160:163]
s_barrier
v_mfma_f32_16x16x32_bf16 a[192:195], v[192:195], v[240:243], a[192:195]
s_and_b32 s73, s65, 1
ds_read_b64_tr_b16 v[224:225], v20 offset:0
v_mfma_f32_16x16x32_bf16 a[192:195], v[196:199], v[244:247], a[192:195]
s_xor_b32 s73, s73, 7
ds_read_b64_tr_b16 v[226:227], v20 offset:1024
v_mfma_f32_16x16x32_bf16 a[196:199], v[204:207], v[244:247], a[196:199]
s_lshl_b32 s69, s73, 7
ds_read_b64_tr_b16 v[228:229], v20 offset:8192
v_mfma_f32_16x16x32_bf16 a[196:199], v[200:203], v[240:243], a[196:199]
s_add_u32 s69, s69, s84
ds_read_b64_tr_b16 v[230:231], v20 offset:9216
v_mfma_f32_16x16x32_bf16 a[200:203], v[208:211], v[240:243], a[200:203]
s_lshl_b32 s71, s73, 19
ds_read_b128 v[128:131], v24 offset:0
v_mfma_f32_16x16x32_bf16 a[200:203], v[212:215], v[244:247], a[200:203]
s_add_u32 s71, s71, s66
ds_read_b128 v[132:135], v25 offset:0
v_mfma_f32_16x16x32_bf16 a[204:207], v[220:223], v[244:247], a[204:207]
s_add_u32 m0, s63, 98304
v_mfma_f32_16x16x32_bf16 a[204:207], v[216:219], v[240:243], a[204:207]
s_add_u32 s72, s69, 0
buffer_load_dwordx4 v2, s[8:11], s72 offen lds
v_mfma_f32_16x16x32_bf16 a[208:211], v[184:187], v[240:243], a[208:211]
s_add_u32 s72, s69, 7168
buffer_load_dwordx4 v3, s[8:11], s72 offen offset:1024 lds
v_mfma_f32_16x16x32_bf16 a[208:211], v[188:191], v[244:247], a[208:211]
s_add_u32 s72, s69, 14336
buffer_load_dwordx4 v2, s[8:11], s72 offen offset:2048 lds
v_mfma_f32_16x16x32_bf16 a[212:215], v[180:183], v[244:247], a[212:215]
s_mul_i32 s74, s58, 4352
ds_read_b128 v[136:139], v24 offset:2048
v_mfma_f32_16x16x32_bf16 a[212:215], v[176:179], v[240:243], a[212:215]
s_add_u32 s74, s74, 131072
ds_read_b128 v[140:143], v25 offset:2048
v_lshrrev_b32 v26, 4, v0
v_mfma_f32_16x16x32_bf16 a[216:219], v[168:171], v[240:243], a[216:219]
s_add_u32 s72, s69, 21504
buffer_load_dwordx4 v3, s[8:11], s72 offen offset:3072 lds
v_mfma_f32_16x16x32_bf16 a[216:219], v[172:175], v[244:247], a[216:219]
ds_read_b128 v[144:147], v24 offset:4096
v_and_b32 v27, 15, v0
v_mfma_f32_16x16x32_bf16 a[220:223], v[164:167], v[244:247], a[220:223]
ds_read_b128 v[148:151], v25 offset:4096
v_lshlrev_b32 v27, 4, v27
v_mfma_f32_16x16x32_bf16 a[220:223], v[160:163], v[240:243], a[220:223]
ds_read_b128 v[152:155], v24 offset:6144
v_mul_u32_u24 v28, 272, v26
v_mfma_f32_16x16x32_bf16 a[252:255], v[160:163], v[248:251], a[252:255]
ds_read_b128 v[156:159], v25 offset:6144
v_add3_u32 v28, v28, v27, s74
v_mfma_f32_16x16x32_bf16 a[252:255], v[164:167], v[252:255], a[252:255]
s_add_u32 m0, s64, 32768
v_lshl_add_u32 v26, v26, 12, v27
v_mfma_f32_16x16x32_bf16 a[248:251], v[172:175], v[252:255], a[248:251]
s_add_u32 s72, s71, 0
buffer_load_dwordx4 v6, s[16:19], s72 offen lds
v_mfma_f32_16x16x32_bf16 a[248:251], v[168:171], v[248:251], a[248:251]
ds_read_b128 v[160:163], v24 offset:8192
ds_read_b128 v[36:39], v28 offset:0
v_mfma_f32_16x16x32_bf16 a[244:247], v[176:179], v[248:251], a[244:247]
ds_read_b128 v[164:167], v25 offset:8192
ds_read_b128 v[40:43], v28 offset:1088
v_mfma_f32_16x16x32_bf16 a[244:247], v[180:183], v[252:255], a[244:247]
s_add_u32 s72, s71, 31744
buffer_load_dwordx4 v6, s[16:19], s72 offen offset:1024 lds
v_mfma_f32_16x16x32_bf16 a[240:243], v[188:191], v[252:255], a[240:243]
ds_read_b128 v[168:171], v24 offset:10240
ds_read_b128 v[44:47], v28 offset:2176
v_mfma_f32_16x16x32_bf16 a[240:243], v[184:187], v[248:251], a[240:243]
ds_read_b128 v[172:175], v25 offset:10240
ds_read_b128 v[48:51], v28 offset:3264
v_mfma_f32_16x16x32_bf16 a[236:239], v[216:219], v[248:251], a[236:239]
s_and_b32 s74, s2, 15
ds_read_b128 v[176:179], v24 offset:12288
v_mfma_f32_16x16x32_bf16 a[236:239], v[220:223], v[252:255], a[236:239]
s_add_u32 s72, s71, 63488
buffer_load_dwordx4 v7, s[16:19], s72 offen offset:2048 lds
v_mfma_f32_16x16x32_bf16 a[232:235], v[212:215], v[252:255], a[232:235]
s_lshl_b32 s74, s74, 2
ds_read_b128 v[180:183], v25 offset:12288
v_mfma_f32_16x16x32_bf16 a[232:235], v[208:211], v[248:251], a[232:235]
s_add_u32 s74, s74, s58
ds_read_b128 v[184:187], v24 offset:14336
v_mfma_f32_16x16x32_bf16 a[228:231], v[200:203], v[248:251], a[228:231]
s_lshl_b32 s74, s74, 16
ds_read_b128 v[188:191], v25 offset:14336
v_mfma_f32_16x16x32_bf16 a[228:231], v[204:207], v[252:255], a[228:231]
s_lshr_b32 s75, s2, 4
v_mfma_f32_16x16x32_bf16 a[224:227], v[196:199], v[252:255], a[224:227]
s_add_u32 s72, s71, 95232
buffer_load_dwordx4 v7, s[16:19], s72 offen offset:3072 lds
v_mfma_f32_16x16x32_bf16 a[224:227], v[192:195], v[248:251], a[224:227]
s_waitcnt lgkmcnt(12)
ds_read_b64_tr_b16 v[232:233], v21 offset:0
v_mfma_f32_16x16x32_bf16 a[0:3], v[224:227], v[128:131], a[0:3]
s_lshl_b32 s75, s75, 8
ds_read_b64_tr_b16 v[234:235], v21 offset:1024
v_mfma_f32_16x16x32_bf16 a[0:3], v[228:231], v[132:135], a[0:3]
s_sub_u32 s74, s74, s75
ds_read_b64_tr_b16 v[240:241], v22 offset:0
v_mfma_f32_16x16x32_bf16 a[4:7], v[228:231], v[140:143], a[4:7]
s_add_u32 m0, s63, 102400
ds_read_b64_tr_b16 v[236:237], v21 offset:8192
v_mfma_f32_16x16x32_bf16 a[4:7], v[224:227], v[136:139], a[4:7]
s_add_u32 s72, s69, 32768
buffer_load_dwordx4 v2, s[8:11], s72 offen lds
v_mfma_f32_16x16x32_bf16 a[8:11], v[224:227], v[144:147], a[8:11]
s_add_u32 s74, s74, 0x3000f00
ds_read_b64_tr_b16 v[238:239], v21 offset:9216
v_mfma_f32_16x16x32_bf16 a[8:11], v[228:231], v[148:151], a[8:11]
s_waitcnt vmcnt(29)
v_lshlrev_b32 v78, 16, v84
v_lshlrev_b32 v79, 16, v108
v_mfma_f32_16x16x32_bf16 a[12:15], v[228:231], v[156:159], a[12:15]
s_add_u32 s72, s69, 39936
buffer_load_dwordx4 v3, s[8:11], s72 offen offset:1024 lds
v_mfma_f32_16x16x32_bf16 a[12:15], v[224:227], v[152:155], a[12:15]
s_waitcnt lgkmcnt(5)
ds_read_b64_tr_b16 v[242:243], v22 offset:1024
v_mul_f32 v76, v78, v79
v_mfma_f32_16x16x32_bf16 a[16:19], v[224:227], v[160:163], a[16:19]
v_lshlrev_b32 v80, 16, v116
v_mul_f32 v77, v78, v80
v_mfma_f32_16x16x32_bf16 a[16:19], v[228:231], v[164:167], a[16:19]
ds_read_b64_tr_b16 v[244:245], v22 offset:8192
v_and_b32 v78, 0xffff0000, v84
v_mfma_f32_16x16x32_bf16 a[20:23], v[228:231], v[172:175], a[20:23]
v_and_b32 v79, 0xffff0000, v108
v_fmac_f32 v76, v78, v79
v_mfma_f32_16x16x32_bf16 a[20:23], v[224:227], v[168:171], a[20:23]
s_add_u32 s72, s69, 47104
buffer_load_dwordx4 v2, s[8:11], s72 offen offset:2048 lds
v_mfma_f32_16x16x32_bf16 a[24:27], v[224:227], v[176:179], a[24:27]
ds_read_b64_tr_b16 v[246:247], v22 offset:9216
v_and_b32 v80, 0xffff0000, v116
v_mfma_f32_16x16x32_bf16 a[24:27], v[228:231], v[180:183], a[24:27]
v_fmac_f32 v77, v78, v80
v_lshlrev_b32 v78, 16, v85
v_mfma_f32_16x16x32_bf16 a[28:31], v[228:231], v[188:191], a[28:31]
v_lshlrev_b32 v79, 16, v109
v_fmac_f32 v76, v78, v79
v_mfma_f32_16x16x32_bf16 a[28:31], v[224:227], v[184:187], a[28:31]
s_waitcnt lgkmcnt(3)
v_lshlrev_b32 v80, 16, v117
v_fmac_f32 v77, v78, v80
v_mfma_f32_16x16x32_bf16 a[60:63], v[232:235], v[184:187], a[60:63]
s_add_u32 s72, s69, 54272
buffer_load_dwordx4 v3, s[8:11], s72 offen offset:3072 lds
v_mfma_f32_16x16x32_bf16 a[60:63], v[236:239], v[188:191], a[60:63]
ds_read_b64_tr_b16 v[248:249], v23 offset:0
v_and_b32 v78, 0xffff0000, v85
v_mfma_f32_16x16x32_bf16 a[56:59], v[236:239], v[180:183], a[56:59]
v_and_b32 v79, 0xffff0000, v109
v_fmac_f32 v76, v78, v79
v_mfma_f32_16x16x32_bf16 a[56:59], v[232:235], v[176:179], a[56:59]
s_add_u32 m0, s64, 49152
ds_read_b64_tr_b16 v[250:251], v23 offset:1024
v_and_b32 v80, 0xffff0000, v117
v_mfma_f32_16x16x32_bf16 a[52:55], v[232:235], v[168:171], a[52:55]
s_add_u32 s72, s71, 0
buffer_load_dwordx4 v6, s[20:23], s72 offen lds
v_mfma_f32_16x16x32_bf16 a[52:55], v[236:239], v[172:175], a[52:55]
v_fmac_f32 v77, v78, v80
v_lshlrev_b32 v78, 16, v86
v_mfma_f32_16x16x32_bf16 a[48:51], v[236:239], v[164:167], a[48:51]
v_lshlrev_b32 v79, 16, v110
v_fmac_f32 v76, v78, v79
v_mfma_f32_16x16x32_bf16 a[48:51], v[232:235], v[160:163], a[48:51]
ds_read_b64_tr_b16 v[252:253], v23 offset:8192
v_lshlrev_b32 v80, 16, v118
v_mfma_f32_16x16x32_bf16 a[44:47], v[232:235], v[152:155], a[44:47]
s_add_u32 s72, s71, 31744
buffer_load_dwordx4 v6, s[20:23], s72 offen offset:1024 lds
v_mfma_f32_16x16x32_bf16 a[44:47], v[236:239], v[156:159], a[44:47]
v_fmac_f32 v77, v78, v80
v_and_b32 v78, 0xffff0000, v86
v_mfma_f32_16x16x32_bf16 a[40:43], v[236:239], v[148:151], a[40:43]
ds_read_b64_tr_b16 v[254:255], v23 offset:9216
v_and_b32 v79, 0xffff0000, v110
v_mfma_f32_16x16x32_bf16 a[40:43], v[232:235], v[144:147], a[40:43]
v_fmac_f32 v76, v78, v79
v_and_b32 v80, 0xffff0000, v118
v_mfma_f32_16x16x32_bf16 a[36:39], v[232:235], v[136:139], a[36:39]
s_add_u32 s72, s71, 63488
buffer_load_dwordx4 v7, s[20:23], s72 offen offset:2048 lds
v_mfma_f32_16x16x32_bf16 a[36:39], v[236:239], v[140:143], a[36:39]
v_fmac_f32 v77, v78, v80
v_lshlrev_b32 v78, 16, v87
v_mfma_f32_16x16x32_bf16 a[32:35], v[236:239], v[132:135], a[32:35]
v_lshlrev_b32 v79, 16, v111
v_fmac_f32 v76, v78, v79
v_mfma_f32_16x16x32_bf16 a[32:35], v[232:235], v[128:131], a[32:35]
s_waitcnt lgkmcnt(4)
v_lshlrev_b32 v80, 16, v119
v_fmac_f32 v77, v78, v80
v_mfma_f32_16x16x32_bf16 a[64:67], v[240:243], v[128:131], a[64:67]
s_add_u32 s72, s71, 95232
buffer_load_dwordx4 v7, s[20:23], s72 offen offset:3072 lds
v_mfma_f32_16x16x32_bf16 a[64:67], v[244:247], v[132:135], a[64:67]
ds_read_b64_tr_b16 v[224:225], v20 offset:16384
v_and_b32 v78, 0xffff0000, v87
v_mfma_f32_16x16x32_bf16 a[68:71], v[244:247], v[140:143], a[68:71]
v_and_b32 v79, 0xffff0000, v111
v_fmac_f32 v76, v78, v79
v_mfma_f32_16x16x32_bf16 a[68:71], v[240:243], v[136:139], a[68:71]
v_and_b32 v80, 0xffff0000, v119
v_fmac_f32 v77, v78, v80
v_mfma_f32_16x16x32_bf16 a[72:75], v[240:243], v[144:147], a[72:75]
ds_read_b64_tr_b16 v[226:227], v20 offset:17408
v_lshlrev_b32 v78, 16, v88
v_mfma_f32_16x16x32_bf16 a[72:75], v[244:247], v[148:151], a[72:75]
v_lshlrev_b32 v79, 16, v112
v_fmac_f32 v76, v78, v79
v_mfma_f32_16x16x32_bf16 a[76:79], v[244:247], v[156:159], a[76:79]
v_lshlrev_b32 v80, 16, v120
v_fmac_f32 v77, v78, v80
v_mfma_f32_16x16x32_bf16 a[76:79], v[240:243], v[152:155], a[76:79]
ds_read_b64_tr_b16 v[228:229], v20 offset:24576
v_and_b32 v78, 0xffff0000, v88
v_mfma_f32_16x16x32_bf16 a[80:83], v[240:243], v[160:163], a[80:83]
s_waitcnt lgkmcnt(15)
buffer_store_dwordx4 v[36:39], v26, s[44:47], s74 offen sc1
v_mfma_f32_16x16x32_bf16 a[80:83], v[244:247], v[164:167], a[80:83]
v_and_b32 v79, 0xffff0000, v112
v_fmac_f32 v76, v78, v79
v_mfma_f32_16x16x32_bf16 a[84:87], v[244:247], v[172:175], a[84:87]
v_and_b32 v80, 0xffff0000, v120
v_fmac_f32 v77, v78, v80
v_mfma_f32_16x16x32_bf16 a[84:87], v[240:243], v[168:171], a[84:87]
ds_read_b64_tr_b16 v[230:231], v20 offset:25600
v_lshlrev_b32 v78, 16, v89
v_mfma_f32_16x16x32_bf16 a[88:91], v[240:243], v[176:179], a[88:91]
v_lshlrev_b32 v79, 16, v113
v_fmac_f32 v76, v78, v79
v_mfma_f32_16x16x32_bf16 a[88:91], v[244:247], v[180:183], a[88:91]
v_lshlrev_b32 v80, 16, v121
v_fmac_f32 v77, v78, v80
v_mfma_f32_16x16x32_bf16 a[92:95], v[244:247], v[188:191], a[92:95]
v_and_b32 v78, 0xffff0000, v89
v_and_b32 v79, 0xffff0000, v113
v_mfma_f32_16x16x32_bf16 a[92:95], v[240:243], v[184:187], a[92:95]
s_waitcnt lgkmcnt(4)
v_fmac_f32 v76, v78, v79
v_and_b32 v80, 0xffff0000, v121
v_mfma_f32_16x16x32_bf16 a[124:127], v[248:251], v[184:187], a[124:127]
ds_read_b64_tr_b16 v[232:233], v21 offset:16384
v_fmac_f32 v77, v78, v80
v_mfma_f32_16x16x32_bf16 a[124:127], v[252:255], v[188:191], a[124:127]
v_lshlrev_b32 v78, 16, v90
v_lshlrev_b32 v79, 16, v114
v_mfma_f32_16x16x32_bf16 a[120:123], v[252:255], v[180:183], a[120:123]
ds_read_b64_tr_b16 v[234:235], v21 offset:17408
v_fmac_f32 v76, v78, v79
v_mfma_f32_16x16x32_bf16 a[120:123], v[248:251], v[176:179], a[120:123]
v_lshlrev_b32 v80, 16, v122
v_fmac_f32 v77, v78, v80
v_mfma_f32_16x16x32_bf16 a[116:119], v[248:251], v[168:171], a[116:119]
s_lshr_b32 s75, s93, 5
v_and_b32 v78, 0xffff0000, v90
v_and_b32 v79, 0xffff0000, v114
v_mfma_f32_16x16x32_bf16 a[116:119], v[252:255], v[172:175], a[116:119]
s_add_u32 s74, s74, 0x4000
buffer_store_dwordx4 v[40:43], v26, s[44:47], s74 offen sc1
v_mfma_f32_16x16x32_bf16 a[112:115], v[252:255], v[164:167], a[112:115]
s_and_b32 s75, s75, 0x3f80
ds_read_b64_tr_b16 v[236:237], v21 offset:24576
v_fmac_f32 v76, v78, v79
v_mfma_f32_16x16x32_bf16 a[112:115], v[248:251], v[160:163], a[112:115]
s_add_u32 s75, s75, LcB0-Lpc0
v_lshrrev_b32 v2, 6, v0
v_lshlrev_b32 v2, 7, v2
v_mfma_f32_16x16x32_bf16 a[108:111], v[248:251], v[152:155], a[108:111]
v_add_u32 v2, s75, v2
v_min_u32 v2, Lcode_end-Lpc0, v2
v_mfma_f32_16x16x32_bf16 a[108:111], v[252:255], v[156:159], a[108:111]
global_load_dword v3, v2, s[98:99]
v_mfma_f32_16x16x32_bf16 a[104:107], v[252:255], v[148:151], a[104:107]
v_and_b32 v80, 0xffff0000, v122
v_fmac_f32 v77, v78, v80
v_mfma_f32_16x16x32_bf16 a[104:107], v[248:251], v[144:147], a[104:107]
ds_read_b64_tr_b16 v[238:239], v21 offset:25600
v_lshlrev_b32 v78, 16, v91
v_mfma_f32_16x16x32_bf16 a[100:103], v[248:251], v[136:139], a[100:103]
v_lshlrev_b32 v79, 16, v115
v_fmac_f32 v76, v78, v79
v_mfma_f32_16x16x32_bf16 a[100:103], v[252:255], v[140:143], a[100:103]
v_lshlrev_b32 v80, 16, v123
v_fmac_f32 v77, v78, v80
v_mfma_f32_16x16x32_bf16 a[96:99], v[252:255], v[132:135], a[96:99]
v_and_b32 v78, 0xffff0000, v91
v_and_b32 v79, 0xffff0000, v115
v_mfma_f32_16x16x32_bf16 a[96:99], v[248:251], v[128:131], a[96:99]
s_waitcnt lgkmcnt(4)
v_fmac_f32 v76, v78, v79
v_and_b32 v80, 0xffff0000, v123
v_mfma_f32_16x16x32_bf16 a[128:131], v[128:131], v[224:227], a[128:131]
ds_read_b64_tr_b16 v[240:241], v22 offset:16384
v_fmac_f32 v77, v78, v80
v_mfma_f32_16x16x32_bf16 a[128:131], v[132:135], v[228:231], a[128:131]
v_add_f32_dpp v76, v76, v76 row_ror:8 row_mask:0xf bank_mask:0xf
v_add_f32_dpp v77, v77, v77 row_ror:8 row_mask:0xf bank_mask:0xf
v_mfma_f32_16x16x32_bf16 a[132:135], v[140:143], v[228:231], a[132:135]
s_add_u32 s74, s74, 0x4000
buffer_store_dwordx4 v[44:47], v26, s[44:47], s74 offen sc1
v_mfma_f32_16x16x32_bf16 a[132:135], v[136:139], v[224:227], a[132:135]
v_add_f32_dpp v76, v76, v76 row_ror:4 row_mask:0xf bank_mask:0xf
v_add_f32_dpp v77, v77, v77 row_ror:4 row_mask:0xf bank_mask:0xf
v_mfma_f32_16x16x32_bf16 a[136:139], v[144:147], v[224:227], a[136:139]
ds_read_b64_tr_b16 v[242:243], v22 offset:17408
v_add_f32_dpp v76, v76, v76 row_ror:2 row_mask:0xf bank_mask:0xf
v_mfma_f32_16x16x32_bf16 a[136:139], v[148:151], v[228:231], a[136:139]
v_add_f32_dpp v77, v77, v77 row_ror:2 row_mask:0xf bank_mask:0xf
v_add_f32_dpp v76, v76, v76 row_ror:1 row_mask:0xf bank_mask:0xf
v_mfma_f32_16x16x32_bf16 a[140:143], v[156:159], v[228:231], a[140:143]
v_add_f32_dpp v77, v77, v77 row_ror:1 row_mask:0xf bank_mask:0xf
v_mov_b32 v78, v76
v_mfma_f32_16x16x32_bf16 a[140:143], v[152:155], v[224:227], a[140:143]
ds_read_b64_tr_b16 v[244:245], v22 offset:24576
v_mov_b32 v79, v77
v_mfma_f32_16x16x32_bf16 a[144:147], v[160:163], v[224:227], a[144:147]
v_permlane16_swap_b32 v76, v78
v_permlane16_swap_b32 v77, v79
v_mfma_f32_16x16x32_bf16 a[144:147], v[164:167], v[228:231], a[144:147]
v_add_f32 v76, v76, v78
v_add_f32 v77, v77, v79
v_mfma_f32_16x16x32_bf16 a[148:151], v[172:175], v[228:231], a[148:151]
ds_read_b64_tr_b16 v[246:247], v22 offset:25600
v_mov_b32 v78, v76
v_mfma_f32_16x16x32_bf16 a[148:151], v[168:171], v[224:227], a[148:151]
v_mov_b32 v79, v77
v_permlane32_swap_b32 v76, v78
v_mfma_f32_16x16x32_bf16 a[152:155], v[176:179], v[224:227], a[152:155]
v_permlane32_swap_b32 v77, v79
v_add_f32 v76, v76, v78
v_mfma_f32_16x16x32_bf16 a[152:155], v[180:183], v[228:231], a[152:155]
v_add_f32 v77, v77, v79
v_mul_f32 v76, 0xbfb8aa3b, v76
v_mfma_f32_16x16x32_bf16 a[156:159], v[188:191], v[228:231], a[156:159]
v_mul_f32 v77, 0xbfb8aa3b, v77
v_mfma_f32_16x16x32_bf16 a[156:159], v[184:187], v[224:227], a[156:159]
s_waitcnt lgkmcnt(4)
v_exp_f32 v76, v76
v_mfma_f32_16x16x32_bf16 a[188:191], v[184:187], v[232:235], a[188:191]
s_add_u32 s74, s74, 0x4000
buffer_store_dwordx4 v[48:51], v26, s[44:47], s74 offen sc1
v_mfma_f32_16x16x32_bf16 a[188:191], v[188:191], v[236:239], a[188:191]
ds_read_b64_tr_b16 v[248:249], v23 offset:16384
v_mfma_f32_16x16x32_bf16 a[184:187], v[180:183], v[236:239], a[184:187]
ds_read_b64_tr_b16 v[250:251], v23 offset:17408
v_mfma_f32_16x16x32_bf16 a[184:187], v[176:179], v[232:235], a[184:187]
v_exp_f32 v77, v77
v_mfma_f32_16x16x32_bf16 a[180:183], v[168:171], v[232:235], a[180:183]
ds_read_b64_tr_b16 v[252:253], v23 offset:24576
v_add_f32 v76, 1.0, v76
v_mfma_f32_16x16x32_bf16 a[180:183], v[172:175], v[236:239], a[180:183]
v_add_f32 v77, 1.0, v77
v_mfma_f32_16x16x32_bf16 a[176:179], v[164:167], v[236:239], a[176:179]
ds_read_b64_tr_b16 v[254:255], v23 offset:25600
v_mfma_f32_16x16x32_bf16 a[176:179], v[160:163], v[232:235], a[176:179]
v_rcp_f32 v76, v76
v_mfma_f32_16x16x32_bf16 a[172:175], v[152:155], v[232:235], a[172:175]
v_rcp_f32 v77, v77
v_mfma_f32_16x16x32_bf16 a[172:175], v[156:159], v[236:239], a[172:175]
s_lshr_b32 s80, s76, 9
v_mfma_f32_16x16x32_bf16 a[168:171], v[148:151], v[236:239], a[168:171]
s_add_u32 s80, s80, 0x3800000
v_min_u32 v78, 1, v0
v_lshlrev_b32 v78, 30, v78
v_mfma_f32_16x16x32_bf16 a[168:171], v[144:147], v[232:235], a[168:171]
buffer_store_dwordx2 v[76:77], v78, s[44:47], s80 offen sc1
v_mfma_f32_16x16x32_bf16 a[164:167], v[136:139], v[232:235], a[164:167]
v_mfma_f32_16x16x32_bf16 a[164:167], v[140:143], v[236:239], a[164:167]
v_mfma_f32_16x16x32_bf16 a[160:163], v[132:135], v[236:239], a[160:163]
s_waitcnt vmcnt(6) lgkmcnt(0)
v_mfma_f32_16x16x32_bf16 a[160:163], v[128:131], v[232:235], a[160:163]
s_barrier
v_mfma_f32_16x16x32_bf16 a[192:195], v[128:131], v[240:243], a[192:195]
s_add_u32 s73, s62, 0
ds_read_b64_tr_b16 v[224:225], v20 offset:32768
v_mfma_f32_16x16x32_bf16 a[192:195], v[132:135], v[244:247], a[192:195]
s_add_u32 s70, s73, s65
ds_read_b64_tr_b16 v[226:227], v20 offset:33792
v_mfma_f32_16x16x32_bf16 a[196:199], v[140:143], v[244:247], a[196:199]
s_and_b32 s70, s70, 3
v_mov_b32 v100, v20
v_mov_b32 v101, v21
v_mfma_f32_16x16x32_bf16 a[196:199], v[136:139], v[240:243], a[196:199]
s_and_b32 s73, s73, 12
v_mov_b32 v102, v22
v_mov_b32 v103, v23
v_mfma_f32_16x16x32_bf16 a[200:203], v[144:147], v[240:243], a[200:203]
s_or_b32 s73, s73, s70
ds_read_b64_tr_b16 v[228:229], v20 offset:40960
v_mfma_f32_16x16x32_bf16 a[200:203], v[148:151], v[244:247], a[200:203]
s_lshl_b32 s73, s73, 7
ds_read_b64_tr_b16 v[230:231], v20 offset:41984
v_mfma_f32_16x16x32_bf16 a[204:207], v[156:159], v[244:247], a[204:207]
s_add_u32 s69, s73, s67
ds_read_b128 v[192:195], v24 offset:32768
v_mfma_f32_16x16x32_bf16 a[204:207], v[152:155], v[240:243], a[204:207]
s_add_u32 s70, s73, s68
ds_read_b128 v[196:199], v25 offset:32768
v_mfma_f32_16x16x32_bf16 a[208:211], v[160:163], v[240:243], a[208:211]
s_add_u32 m0, s63, 131072
ds_read_b128 v[200:203], v24 offset:34816
v_mfma_f32_16x16x32_bf16 a[208:211], v[164:167], v[244:247], a[208:211]
s_add_u32 s72, s69, 0
buffer_load_dwordx4 v4, s[4:7], s72 offen lds
v_mfma_f32_16x16x32_bf16 a[212:215], v[172:175], v[244:247], a[212:215]
s_add_u32 s72, s69, 15360
buffer_load_dwordx4 v5, s[4:7], s72 offen offset:1024 lds
v_mfma_f32_16x16x32_bf16 a[212:215], v[168:171], v[240:243], a[212:215]
s_add_u32 s72, s69, 129024
buffer_load_dwordx4 v4, s[4:7], s72 offen offset:2048 lds
v_mfma_f32_16x16x32_bf16 a[216:219], v[176:179], v[240:243], a[216:219]
ds_read_b128 v[204:207], v25 offset:34816
v_mfma_f32_16x16x32_bf16 a[216:219], v[180:183], v[244:247], a[216:219]
ds_read_b128 v[208:211], v24 offset:36864
v_mfma_f32_16x16x32_bf16 a[220:223], v[188:191], v[244:247], a[220:223]
s_add_u32 s72, s69, 144384
buffer_load_dwordx4 v5, s[4:7], s72 offen offset:3072 lds
v_mfma_f32_16x16x32_bf16 a[220:223], v[184:187], v[240:243], a[220:223]
ds_read_b128 v[212:215], v25 offset:36864
v_mfma_f32_16x16x32_bf16 a[252:255], v[184:187], v[248:251], a[252:255]
ds_read_b128 v[216:219], v24 offset:38912
v_mfma_f32_16x16x32_bf16 a[252:255], v[188:191], v[252:255], a[252:255]
ds_read_b128 v[220:223], v25 offset:38912
v_mfma_f32_16x16x32_bf16 a[248:251], v[180:183], v[252:255], a[248:251]
s_add_u32 m0, s63, 135168
ds_read_b128 v[184:187], v24 offset:40960
v_mfma_f32_16x16x32_bf16 a[248:251], v[176:179], v[248:251], a[248:251]
s_add_u32 s72, s70, 0
buffer_load_dwordx4 v4, s[4:7], s72 offen lds
v_mfma_f32_16x16x32_bf16 a[244:247], v[168:171], v[248:251], a[244:247]
ds_read_b128 v[188:191], v25 offset:40960
v_mfma_f32_16x16x32_bf16 a[244:247], v[172:175], v[252:255], a[244:247]
ds_read_b128 v[176:179], v24 offset:43008
v_mfma_f32_16x16x32_bf16 a[240:243], v[164:167], v[252:255], a[240:243]
ds_read_b128 v[180:183], v25 offset:43008
v_mfma_f32_16x16x32_bf16 a[240:243], v[160:163], v[248:251], a[240:243]
s_add_u32 s72, s70, 15360
buffer_load_dwordx4 v5, s[4:7], s72 offen offset:1024 lds
v_mfma_f32_16x16x32_bf16 a[236:239], v[152:155], v[248:251], a[236:239]
ds_read_b128 v[168:171], v24 offset:45056
v_mfma_f32_16x16x32_bf16 a[236:239], v[156:159], v[252:255], a[236:239]
ds_read_b128 v[172:175], v25 offset:45056
v_mfma_f32_16x16x32_bf16 a[232:235], v[148:151], v[252:255], a[232:235]
v_mfma_f32_16x16x32_bf16 a[232:235], v[144:147], v[248:251], a[232:235]
ds_read_b128 v[160:163], v24 offset:47104
v_mfma_f32_16x16x32_bf16 a[228:231], v[136:139], v[248:251], a[228:231]
s_add_u32 s72, s70, 129024
buffer_load_dwordx4 v4, s[4:7], s72 offen offset:2048 lds
v_mfma_f32_16x16x32_bf16 a[228:231], v[140:143], v[252:255], a[228:231]
ds_read_b128 v[164:167], v25 offset:47104
v_mfma_f32_16x16x32_bf16 a[224:227], v[132:135], v[252:255], a[224:227]
ds_read_b64_tr_b16 v[232:233], v101 offset:32768
v_mfma_f32_16x16x32_bf16 a[224:227], v[128:131], v[248:251], a[224:227]
s_waitcnt lgkmcnt(9)
ds_read_b64_tr_b16 v[234:235], v101 offset:33792
v_mfma_f32_16x16x32_bf16 a[0:3], v[224:227], v[192:195], a[0:3]
s_add_u32 s72, s70, 144384
buffer_load_dwordx4 v5, s[4:7], s72 offen offset:3072 lds
v_mfma_f32_16x16x32_bf16 a[0:3], v[228:231], v[196:199], a[0:3]
ds_read_b64_tr_b16 v[240:241], v102 offset:32768
v_mfma_f32_16x16x32_bf16 a[4:7], v[228:231], v[204:207], a[4:7]
ds_read_b64_tr_b16 v[236:237], v101 offset:40960
v_mfma_f32_16x16x32_bf16 a[4:7], v[224:227], v[200:203], a[4:7]
v_mfma_f32_16x16x32_bf16 a[8:11], v[224:227], v[208:211], a[8:11]
ds_read_b64_tr_b16 v[238:239], v101 offset:41984
v_mfma_f32_16x16x32_bf16 a[8:11], v[228:231], v[212:215], a[8:11]
s_lshl_b32 s71, s73, 12
ds_read_b64_tr_b16 v[242:243], v102 offset:33792
v_mfma_f32_16x16x32_bf16 a[12:15], v[228:231], v[220:223], a[12:15]
s_add_u32 s71, s71, s66
v_mfma_f32_16x16x32_bf16 a[12:15], v[224:227], v[216:219], a[12:15]
s_waitcnt lgkmcnt(6)
ds_read_b64_tr_b16 v[244:245], v102 offset:40960
v_mfma_f32_16x16x32_bf16 a[16:19], v[224:227], v[184:187], a[16:19]
s_add_u32 m0, s64, 0
v_mfma_f32_16x16x32_bf16 a[16:19], v[228:231], v[188:191], a[16:19]
s_add_u32 s72, s71, 0
buffer_load_dwordx4 v6, s[12:15], s72 offen lds
v_mfma_f32_16x16x32_bf16 a[20:23], v[228:231], v[180:183], a[20:23]
s_add_u32 s72, s71, 31744
buffer_load_dwordx4 v6, s[12:15], s72 offen offset:1024 lds
v_mfma_f32_16x16x32_bf16 a[20:23], v[224:227], v[176:179], a[20:23]
ds_read_b64_tr_b16 v[246:247], v102 offset:41984
v_mfma_f32_16x16x32_bf16 a[24:27], v[224:227], v[168:171], a[24:27]
v_mfma_f32_16x16x32_bf16 a[24:27], v[228:231], v[172:175], a[24:27]
v_mfma_f32_16x16x32_bf16 a[28:31], v[228:231], v[164:167], a[28:31]
v_mfma_f32_16x16x32_bf16 a[28:31], v[224:227], v[160:163], a[28:31]
s_waitcnt lgkmcnt(3)
v_mfma_f32_16x16x32_bf16 a[60:63], v[232:235], v[160:163], a[60:63]
s_add_u32 s72, s71, 63488
buffer_load_dwordx4 v7, s[12:15], s72 offen offset:2048 lds
v_mfma_f32_16x16x32_bf16 a[60:63], v[236:239], v[164:167], a[60:63]
ds_read_b64_tr_b16 v[248:249], v103 offset:32768
v_mfma_f32_16x16x32_bf16 a[56:59], v[236:239], v[172:175], a[56:59]
v_mfma_f32_16x16x32_bf16 a[56:59], v[232:235], v[168:171], a[56:59]
s_add_u32 s72, s71, 95232
buffer_load_dwordx4 v7, s[12:15], s72 offen offset:3072 lds
v_mfma_f32_16x16x32_bf16 a[52:55], v[232:235], v[176:179], a[52:55]
v_mfma_f32_16x16x32_bf16 a[52:55], v[236:239], v[180:183], a[52:55]
ds_read_b64_tr_b16 v[250:251], v103 offset:33792
v_mfma_f32_16x16x32_bf16 a[48:51], v[236:239], v[188:191], a[48:51]
v_mfma_f32_16x16x32_bf16 a[48:51], v[232:235], v[184:187], a[48:51]
v_mfma_f32_16x16x32_bf16 a[44:47], v[232:235], v[216:219], a[44:47]
s_add_u32 s73, s62, 1
ds_read_b64_tr_b16 v[252:253], v103 offset:40960
v_mfma_f32_16x16x32_bf16 a[44:47], v[236:239], v[220:223], a[44:47]
s_add_u32 s70, s73, s65
v_mfma_f32_16x16x32_bf16 a[40:43], v[236:239], v[212:215], a[40:43]
s_and_b32 s70, s70, 3
v_mfma_f32_16x16x32_bf16 a[40:43], v[232:235], v[208:211], a[40:43]
s_and_b32 s73, s73, 12
ds_read_b64_tr_b16 v[254:255], v103 offset:41984
v_mfma_f32_16x16x32_bf16 a[36:39], v[232:235], v[200:203], a[36:39]
s_or_b32 s73, s73, s70
v_mfma_f32_16x16x32_bf16 a[36:39], v[236:239], v[204:207], a[36:39]
s_lshl_b32 s73, s73, 7
v_mfma_f32_16x16x32_bf16 a[32:35], v[236:239], v[196:199], a[32:35]
s_add_u32 s69, s73, s67
v_mfma_f32_16x16x32_bf16 a[32:35], v[232:235], v[192:195], a[32:35]
s_waitcnt lgkmcnt(4)
v_mfma_f32_16x16x32_bf16 a[64:67], v[240:243], v[192:195], a[64:67]
s_add_u32 s70, s73, s68
ds_read_b64_tr_b16 v[224:225], v100 offset:49152
v_mfma_f32_16x16x32_bf16 a[64:67], v[244:247], v[196:199], a[64:67]
s_add_u32 m0, s63, 65536
v_mfma_f32_16x16x32_bf16 a[68:71], v[244:247], v[204:207], a[68:71]
s_add_u32 s72, s69, 0
buffer_load_dwordx4 v4, s[4:7], s72 offen lds
v_mfma_f32_16x16x32_bf16 a[68:71], v[240:243], v[200:203], a[68:71]
s_add_u32 s72, s69, 15360
buffer_load_dwordx4 v5, s[4:7], s72 offen offset:1024 lds
v_mfma_f32_16x16x32_bf16 a[72:75], v[240:243], v[208:211], a[72:75]
s_add_u32 s72, s69, 129024
buffer_load_dwordx4 v4, s[4:7], s72 offen offset:2048 lds
v_mfma_f32_16x16x32_bf16 a[72:75], v[244:247], v[212:215], a[72:75]
ds_read_b64_tr_b16 v[226:227], v100 offset:50176
v_mfma_f32_16x16x32_bf16 a[76:79], v[244:247], v[220:223], a[76:79]
s_add_u32 s72, s69, 144384
buffer_load_dwordx4 v5, s[4:7], s72 offen offset:3072 lds
v_mfma_f32_16x16x32_bf16 a[76:79], v[240:243], v[216:219], a[76:79]
v_mfma_f32_16x16x32_bf16 a[80:83], v[240:243], v[184:187], a[80:83]
ds_read_b64_tr_b16 v[228:229], v100 offset:57344
v_mfma_f32_16x16x32_bf16 a[80:83], v[244:247], v[188:191], a[80:83]
v_mfma_f32_16x16x32_bf16 a[84:87], v[244:247], v[180:183], a[84:87]
ds_read_b64_tr_b16 v[230:231], v100 offset:58368
v_accvgpr_read_b32 v20, a0
v_mfma_f32_16x16x32_bf16 a[84:87], v[240:243], v[176:179], a[84:87]
s_add_u32 m0, s63, 69632
v_accvgpr_read_b32 v28, a1
v_accvgpr_read_b32 v21, a2
v_mfma_f32_16x16x32_bf16 a[88:91], v[240:243], v[168:171], a[88:91]
s_add_u32 s72, s70, 0
buffer_load_dwordx4 v4, s[4:7], s72 offen lds
v_mfma_f32_16x16x32_bf16 a[88:91], v[244:247], v[172:175], a[88:91]
v_accvgpr_read_b32 v29, a3
v_accvgpr_read_b32 v22, a32
v_mfma_f32_16x16x32_bf16 a[92:95], v[244:247], v[164:167], a[92:95]
v_accvgpr_read_b32 v30, a33
v_accvgpr_read_b32 v23, a34
v_mfma_f32_16x16x32_bf16 a[92:95], v[240:243], v[160:163], a[92:95]
s_waitcnt lgkmcnt(4)
v_accvgpr_read_b32 v31, a35
v_mul_f32 v20, s79, v20
v_mfma_f32_16x16x32_bf16 a[124:127], v[248:251], v[160:163], a[124:127]
s_add_u32 s72, s70, 15360
buffer_load_dwordx4 v5, s[4:7], s72 offen offset:1024 lds
v_mfma_f32_16x16x32_bf16 a[124:127], v[252:255], v[164:167], a[124:127]
ds_read_b64_tr_b16 v[232:233], v101 offset:49152
v_mul_f32 v28, s79, v28
v_mfma_f32_16x16x32_bf16 a[120:123], v[252:255], v[172:175], a[120:123]
v_mul_f32 v21, s79, v21
v_mul_f32 v29, s79, v29
v_mfma_f32_16x16x32_bf16 a[120:123], v[248:251], v[168:171], a[120:123]
ds_read_b64_tr_b16 v[234:235], v101 offset:50176
v_mul_f32 v22, s79, v22
v_mfma_f32_16x16x32_bf16 a[116:119], v[248:251], v[176:179], a[116:119]
s_add_u32 s72, s70, 129024
buffer_load_dwordx4 v4, s[4:7], s72 offen offset:2048 lds
v_mfma_f32_16x16x32_bf16 a[116:119], v[252:255], v[180:183], a[116:119]
v_mul_f32 v30, s79, v30
v_mul_f32 v23, s79, v23
v_mfma_f32_16x16x32_bf16 a[112:115], v[252:255], v[188:191], a[112:115]
v_mul_f32 v31, s79, v31
v_cvt_pk_bf16_f32 v20, v20, v28
v_mfma_f32_16x16x32_bf16 a[112:115], v[248:251], v[184:187], a[112:115]
ds_read_b64_tr_b16 v[236:237], v101 offset:57344
v_cvt_pk_bf16_f32 v21, v21, v29
v_mfma_f32_16x16x32_bf16 a[108:111], v[248:251], v[216:219], a[108:111]
v_cvt_pk_bf16_f32 v22, v22, v30
v_cvt_pk_bf16_f32 v23, v23, v31
v_mfma_f32_16x16x32_bf16 a[108:111], v[252:255], v[220:223], a[108:111]
s_add_u32 s72, s70, 144384
buffer_load_dwordx4 v5, s[4:7], s72 offen offset:3072 lds
v_mfma_f32_16x16x32_bf16 a[104:107], v[252:255], v[212:215], a[104:107]
s_add_u32 s80, s77, 0
buffer_store_dwordx4 v[20:23], v1, s[44:47], s80 offen sc1
v_mfma_f32_16x16x32_bf16 a[104:107], v[248:251], v[208:211], a[104:107]
ds_read_b64_tr_b16 v[238:239], v101 offset:58368
v_mfma_f32_16x16x32_bf16 a[100:103], v[248:251], v[200:203], a[100:103]
v_mfma_f32_16x16x32_bf16 a[100:103], v[252:255], v[204:207], a[100:103]
v_mfma_f32_16x16x32_bf16 a[96:99], v[252:255], v[196:199], a[96:99]
s_lshl_b32 s71, s73, 12
v_mfma_f32_16x16x32_bf16 a[96:99], v[248:251], v[192:195], a[96:99]
s_waitcnt lgkmcnt(4)
LcB0:
v_mfma_f32_16x16x32_bf16 a[128:131], v[192:195], v[224:227], a[128:131]
s_add_u32 s71, s71, s66
ds_read_b64_tr_b16 v[240:241], v102 offset:49152
v_accvgpr_read_b32 v24, a4
v_mfma_f32_16x16x32_bf16 a[128:131], v[196:199], v[228:231], a[128:131]
s_add_u32 m0, s64, 16384
v_accvgpr_read_b32 v28, a5
v_accvgpr_read_b32 v25, a6
v_mfma_f32_16x16x32_bf16 a[132:135], v[204:207], v[228:231], a[132:135]
s_add_u32 s72, s71, 0
buffer_load_dwordx4 v6, s[12:15], s72 offen lds
v_mfma_f32_16x16x32_bf16 a[132:135], v[200:203], v[224:227], a[132:135]
s_add_u32 s72, s71, 31744
buffer_load_dwordx4 v6, s[12:15], s72 offen offset:1024 lds
v_mfma_f32_16x16x32_bf16 a[136:139], v[208:211], v[224:227], a[136:139]
ds_read_b64_tr_b16 v[242:243], v102 offset:50176
v_accvgpr_read_b32 v29, a7
v_mfma_f32_16x16x32_bf16 a[136:139], v[212:215], v[228:231], a[136:139]
v_accvgpr_read_b32 v26, a36
v_accvgpr_read_b32 v30, a37
v_mfma_f32_16x16x32_bf16 a[140:143], v[220:223], v[228:231], a[140:143]
v_accvgpr_read_b32 v27, a38
v_accvgpr_read_b32 v31, a39
v_mfma_f32_16x16x32_bf16 a[140:143], v[216:219], v[224:227], a[140:143]
s_add_u32 s72, s71, 63488
buffer_load_dwordx4 v7, s[12:15], s72 offen offset:2048 lds
v_mfma_f32_16x16x32_bf16 a[144:147], v[184:187], v[224:227], a[144:147]
ds_read_b64_tr_b16 v[244:245], v102 offset:57344
v_mul_f32 v24, s79, v24
v_mfma_f32_16x16x32_bf16 a[144:147], v[188:191], v[228:231], a[144:147]
v_mul_f32 v28, s79, v28
v_mul_f32 v25, s79, v25
v_mfma_f32_16x16x32_bf16 a[148:151], v[180:183], v[228:231], a[148:151]
ds_read_b64_tr_b16 v[246:247], v102 offset:58368
v_mul_f32 v29, s79, v29
v_mfma_f32_16x16x32_bf16 a[148:151], v[176:179], v[224:227], a[148:151]
v_mul_f32 v26, s79, v26
v_mul_f32 v30, s79, v30
v_mfma_f32_16x16x32_bf16 a[152:155], v[168:171], v[224:227], a[152:155]
s_add_u32 s72, s71, 95232
buffer_load_dwordx4 v7, s[12:15], s72 offen offset:3072 lds
v_mfma_f32_16x16x32_bf16 a[152:155], v[172:175], v[228:231], a[152:155]
v_mul_f32 v27, s79, v27
v_mul_f32 v31, s79, v31
v_mfma_f32_16x16x32_bf16 a[156:159], v[164:167], v[228:231], a[156:159]
v_cvt_pk_bf16_f32 v24, v24, v28
v_cvt_pk_bf16_f32 v25, v25, v29
v_mfma_f32_16x16x32_bf16 a[156:159], v[160:163], v[224:227], a[156:159]
s_waitcnt lgkmcnt(4)
v_cvt_pk_bf16_f32 v26, v26, v30
v_cvt_pk_bf16_f32 v27, v27, v31
v_mfma_f32_16x16x32_bf16 a[188:191], v[160:163], v[232:235], a[188:191]
s_add_u32 s80, s77, 4096
ds_read_b64_tr_b16 v[248:249], v103 offset:49152
v_mfma_f32_16x16x32_bf16 a[188:191], v[164:167], v[236:239], a[188:191]
buffer_store_dwordx4 v[24:27], v1, s[44:47], s80 offen sc1
v_mfma_f32_16x16x32_bf16 a[184:187], v[172:175], v[236:239], a[184:187]
ds_read_b64_tr_b16 v[250:251], v103 offset:50176
v_mfma_f32_16x16x32_bf16 a[184:187], v[168:171], v[232:235], a[184:187]
v_mfma_f32_16x16x32_bf16 a[180:183], v[176:179], v[232:235], a[180:183]
ds_read_b64_tr_b16 v[252:253], v103 offset:57344
v_mfma_f32_16x16x32_bf16 a[180:183], v[180:183], v[236:239], a[180:183]
s_add_u32 s73, s62, 2
v_mfma_f32_16x16x32_bf16 a[176:179], v[188:191], v[236:239], a[176:179]
s_add_u32 s70, s73, s65
ds_read_b64_tr_b16 v[254:255], v103 offset:58368
v_accvgpr_read_b32 v20, a8
v_mfma_f32_16x16x32_bf16 a[176:179], v[184:187], v[232:235], a[176:179]
s_and_b32 s70, s70, 3
v_accvgpr_read_b32 v28, a9
v_accvgpr_read_b32 v21, a10
v_mfma_f32_16x16x32_bf16 a[172:175], v[216:219], v[232:235], a[172:175]
s_and_b32 s73, s73, 12
v_accvgpr_read_b32 v29, a11
v_accvgpr_read_b32 v22, a40
v_mfma_f32_16x16x32_bf16 a[172:175], v[220:223], v[236:239], a[172:175]
s_or_b32 s73, s73, s70
v_accvgpr_read_b32 v30, a41
v_accvgpr_read_b32 v23, a42
v_mfma_f32_16x16x32_bf16 a[168:171], v[212:215], v[236:239], a[168:171]
s_lshl_b32 s73, s73, 7
v_accvgpr_read_b32 v31, a43
v_mul_f32 v20, s79, v20
v_mfma_f32_16x16x32_bf16 a[168:171], v[208:211], v[232:235], a[168:171]
s_add_u32 s69, s73, s67
v_mul_f32 v28, s79, v28
v_mul_f32 v21, s79, v21
v_mfma_f32_16x16x32_bf16 a[164:167], v[200:203], v[232:235], a[164:167]
s_add_u32 s70, s73, s68
v_mul_f32 v29, s79, v29
v_mul_f32 v22, s79, v22
v_mfma_f32_16x16x32_bf16 a[164:167], v[204:207], v[236:239], a[164:167]
s_add_u32 m0, s63, 98304
v_mul_f32 v30, s79, v30
v_mul_f32 v23, s79, v23
v_mfma_f32_16x16x32_bf16 a[160:163], v[196:199], v[236:239], a[160:163]
s_waitcnt vmcnt(14) lgkmcnt(0)
v_mul_f32 v31, s79, v31
v_cvt_pk_bf16_f32 v20, v20, v28
v_mfma_f32_16x16x32_bf16 a[160:163], v[192:195], v[232:235], a[160:163]
s_barrier
v_cvt_pk_bf16_f32 v21, v21, v29
v_cvt_pk_bf16_f32 v22, v22, v30
v_mfma_f32_16x16x32_bf16 a[192:195], v[192:195], v[240:243], a[192:195]
s_add_u32 s72, s69, 0
buffer_load_dwordx4 v4, s[4:7], s72 offen lds
v_mfma_f32_16x16x32_bf16 a[192:195], v[196:199], v[244:247], a[192:195]
s_lshl_b32 s74, s59, 2
ds_read_b64_tr_b16 v[64:65], v8 offset:0
v_or_b32 v106, s58, v0
v_mfma_f32_16x16x32_bf16 a[196:199], v[204:207], v[244:247], a[196:199]
ds_read_b64_tr_b16 v[66:67], v8 offset:1024
v_mov_b32 v107, 1
v_mfma_f32_16x16x32_bf16 a[196:199], v[200:203], v[240:243], a[196:199]
ds_read_b64_tr_b16 v[68:69], v8 offset:8192
v_lshlrev_b32 v106, 8, v106
v_mfma_f32_16x16x32_bf16 a[200:203], v[208:211], v[240:243], a[200:203]
ds_read_b64_tr_b16 v[70:71], v8 offset:9216
v_cvt_pk_bf16_f32 v23, v23, v31
v_mfma_f32_16x16x32_bf16 a[200:203], v[212:215], v[244:247], a[200:203]
s_add_u32 s72, s69, 15360
buffer_load_dwordx4 v5, s[4:7], s72 offen offset:1024 lds
v_mfma_f32_16x16x32_bf16 a[204:207], v[220:223], v[244:247], a[204:207]
s_add_u32 s80, s77, 8192
ds_read_b128 v[32:35], v16 offset:0
v_mfma_f32_16x16x32_bf16 a[204:207], v[216:219], v[240:243], a[204:207]
buffer_atomic_add v107, v106, s[48:51], s74 offen sc1
v_mfma_f32_16x16x32_bf16 a[208:211], v[184:187], v[240:243], a[208:211]
ds_read_b128 v[36:39], v17 offset:0
v_mfma_f32_16x16x32_bf16 a[208:211], v[188:191], v[244:247], a[208:211]
ds_read_b128 v[40:43], v16 offset:2048
v_mfma_f32_16x16x32_bf16 a[212:215], v[180:183], v[244:247], a[212:215]
s_add_u32 s72, s69, 129024
buffer_load_dwordx4 v4, s[4:7], s72 offen offset:2048 lds
v_mfma_f32_16x16x32_bf16 a[212:215], v[176:179], v[240:243], a[212:215]
ds_read_b128 v[44:47], v17 offset:2048
v_mfma_f32_16x16x32_bf16 a[216:219], v[168:171], v[240:243], a[216:219]
ds_read_b128 v[48:51], v16 offset:4096
v_accvgpr_read_b32 v24, a128
v_mfma_f32_16x16x32_bf16 a[216:219], v[172:175], v[244:247], a[216:219]
ds_read_b128 v[52:55], v17 offset:4096
v_accvgpr_read_b32 v28, a129
v_mfma_f32_16x16x32_bf16 a[220:223], v[164:167], v[244:247], a[220:223]
buffer_store_dwordx4 v[20:23], v1, s[44:47], s80 offen sc1
v_mfma_f32_16x16x32_bf16 a[220:223], v[160:163], v[240:243], a[220:223]
s_add_u32 s72, s69, 144384
buffer_load_dwordx4 v5, s[4:7], s72 offen offset:3072 lds
v_mfma_f32_16x16x32_bf16 a[252:255], v[160:163], v[248:251], a[252:255]
ds_read_b128 v[56:59], v16 offset:6144
v_accvgpr_read_b32 v25, a130
v_mfma_f32_16x16x32_bf16 a[252:255], v[164:167], v[252:255], a[252:255]
ds_read_b128 v[60:63], v17 offset:6144
v_accvgpr_read_b32 v29, a131
v_mfma_f32_16x16x32_bf16 a[248:251], v[172:175], v[252:255], a[248:251]
ds_read_b64_tr_b16 v[72:73], v9 offset:0
v_accvgpr_read_b32 v26, a132
v_mfma_f32_16x16x32_bf16 a[248:251], v[168:171], v[248:251], a[248:251]
s_add_u32 m0, s63, 102400
ds_read_b64_tr_b16 v[74:75], v9 offset:1024
v_accvgpr_read_b32 v30, a133
v_mfma_f32_16x16x32_bf16 a[244:247], v[176:179], v[248:251], a[244:247]
s_add_u32 s72, s70, 0
buffer_load_dwordx4 v4, s[4:7], s72 offen lds
v_mfma_f32_16x16x32_bf16 a[244:247], v[180:183], v[252:255], a[244:247]
ds_read_b64_tr_b16 v[76:77], v9 offset:8192
v_accvgpr_read_b32 v27, a134
v_mfma_f32_16x16x32_bf16 a[240:243], v[188:191], v[252:255], a[240:243]
v_accvgpr_read_b32 v31, a135
v_cvt_pk_bf16_f32 v24, v24, v28
v_mfma_f32_16x16x32_bf16 a[240:243], v[184:187], v[248:251], a[240:243]
ds_read_b64_tr_b16 v[78:79], v9 offset:9216
v_cvt_pk_bf16_f32 v25, v25, v29
v_mfma_f32_16x16x32_bf16 a[236:239], v[216:219], v[248:251], a[236:239]
ds_read_b64_tr_b16 v[80:81], v10 offset:0
v_cvt_pk_bf16_f32 v26, v26, v30
v_mfma_f32_16x16x32_bf16 a[236:239], v[220:223], v[252:255], a[236:239]
s_add_u32 s72, s70, 15360
buffer_load_dwordx4 v5, s[4:7], s72 offen offset:1024 lds
v_mfma_f32_16x16x32_bf16 a[232:235], v[212:215], v[252:255], a[232:235]
ds_read_b64_tr_b16 v[82:83], v10 offset:1024
v_cvt_pk_bf16_f32 v27, v27, v31
v_mfma_f32_16x16x32_bf16 a[232:235], v[208:211], v[248:251], a[232:235]
s_add_u32 s80, s78, 0
ds_read_b64_tr_b16 v[84:85], v10 offset:8192
v_mfma_f32_16x16x32_bf16 a[228:231], v[200:203], v[248:251], a[228:231]
ds_read_b64_tr_b16 v[86:87], v10 offset:9216
v_mfma_f32_16x16x32_bf16 a[228:231], v[204:207], v[252:255], a[228:231]
buffer_store_dwordx4 v[24:27], v1, s[44:47], s80 offen sc1
v_mfma_f32_16x16x32_bf16 a[224:227], v[196:199], v[252:255], a[224:227]
s_add_u32 s72, s70, 129024
buffer_load_dwordx4 v4, s[4:7], s72 offen offset:2048 lds
v_mfma_f32_16x16x32_bf16 a[224:227], v[192:195], v[248:251], a[224:227]
s_waitcnt lgkmcnt(8)
v_mfma_f32_16x16x32_bf16 v[128:131], v[64:67], v[32:35], 0
ds_read_b64_tr_b16 v[88:89], v11 offset:0
v_mfma_f32_16x16x32_bf16 v[128:131], v[68:71], v[36:39], v[128:131]
ds_read_b64_tr_b16 v[90:91], v11 offset:1024
v_mfma_f32_16x16x32_bf16 v[132:135], v[68:71], v[44:47], 0
v_accvgpr_read_b32 v20, a12
v_accvgpr_read_b32 v28, a13
v_mfma_f32_16x16x32_bf16 v[132:135], v[64:67], v[40:43], v[132:135]
s_add_u32 s72, s70, 144384
buffer_load_dwordx4 v5, s[4:7], s72 offen offset:3072 lds
v_mfma_f32_16x16x32_bf16 v[136:139], v[64:67], v[48:51], 0
s_lshl_b32 s71, s73, 12
ds_read_b64_tr_b16 v[92:93], v11 offset:8192
v_accvgpr_read_b32 v21, a14
v_mfma_f32_16x16x32_bf16 v[136:139], v[68:71], v[52:55], v[136:139]
s_add_u32 s71, s71, s66
v_accvgpr_read_b32 v29, a15
v_accvgpr_read_b32 v22, a44
v_mfma_f32_16x16x32_bf16 v[140:143], v[68:71], v[60:63], 0
s_add_u32 m0, s64, 32768
ds_read_b64_tr_b16 v[94:95], v11 offset:9216
v_accvgpr_read_b32 v30, a45
v_mfma_f32_16x16x32_bf16 v[140:143], v[64:67], v[56:59], v[140:143]
s_waitcnt lgkmcnt(8)
v_accvgpr_read_b32 v23, a46
v_accvgpr_read_b32 v31, a47
v_mfma_f32_16x16x32_bf16 v[156:159], v[72:75], v[56:59], 0
s_add_u32 s72, s71, 0
buffer_load_dwordx4 v6, s[12:15], s72 offen lds
v_mfma_f32_16x16x32_bf16 v[156:159], v[76:79], v[60:63], v[156:159]
s_add_u32 s73, s62, 3
ds_read_b64_tr_b16 v[64:65], v12 offset:0
v_mul_f32 v20, s79, v20
v_mfma_f32_16x16x32_bf16 v[152:155], v[76:79], v[52:55], 0
s_add_u32 s70, s73, s65
ds_read_b64_tr_b16 v[66:67], v12 offset:1024
v_mul_f32 v28, s79, v28
v_mfma_f32_16x16x32_bf16 v[152:155], v[72:75], v[48:51], v[152:155]
s_add_u32 s72, s71, 31744
buffer_load_dwordx4 v6, s[12:15], s72 offen offset:1024 lds
v_mfma_f32_16x16x32_bf16 v[148:151], v[72:75], v[40:43], 0
s_and_b32 s70, s70, 3
v_mul_f32 v21, s79, v21
v_mul_f32 v29, s79, v29
v_mfma_f32_16x16x32_bf16 v[148:151], v[76:79], v[44:47], v[148:151]
s_and_b32 s73, s73, 12
ds_read_b64_tr_b16 v[68:69], v12 offset:8192
v_mul_f32 v22, s79, v22
v_mfma_f32_16x16x32_bf16 v[144:147], v[76:79], v[36:39], 0
s_or_b32 s73, s73, s70
ds_read_b64_tr_b16 v[70:71], v12 offset:9216
v_mul_f32 v30, s79, v30
v_mfma_f32_16x16x32_bf16 v[144:147], v[72:75], v[32:35], v[144:147]
s_waitcnt lgkmcnt(8)
v_mul_f32 v23, s79, v23
v_mul_f32 v31, s79, v31
v_mfma_f32_16x16x32_bf16 v[160:163], v[80:83], v[32:35], 0
s_lshl_b32 s73, s73, 7
ds_read_b64_tr_b16 v[72:73], v13 offset:0
v_cvt_pk_bf16_f32 v20, v20, v28
v_mfma_f32_16x16x32_bf16 v[160:163], v[84:87], v[36:39], v[160:163]
s_add_u32 s72, s71, 63488
buffer_load_dwordx4 v7, s[12:15], s72 offen offset:2048 lds
v_mfma_f32_16x16x32_bf16 v[164:167], v[84:87], v[44:47], 0
s_add_u32 s69, s73, s67
ds_read_b64_tr_b16 v[74:75], v13 offset:1024
v_cvt_pk_bf16_f32 v21, v21, v29
v_mfma_f32_16x16x32_bf16 v[164:167], v[80:83], v[40:43], v[164:167]
s_add_u32 s70, s73, s68
v_cvt_pk_bf16_f32 v22, v22, v30
v_cvt_pk_bf16_f32 v23, v23, v31
v_mfma_f32_16x16x32_bf16 v[168:171], v[80:83], v[48:51], 0
s_waitcnt vmcnt(20)
ds_read_b64_tr_b16 v[76:77], v13 offset:8192
v_mfma_f32_16x16x32_bf16 v[168:171], v[84:87], v[52:55], v[168:171]
s_add_u32 s80, s77, 12288
ds_read_b64_tr_b16 v[78:79], v13 offset:9216
v_mfma_f32_16x16x32_bf16 v[172:175], v[84:87], v[60:63], 0
s_add_u32 s72, s71, 95232
ds_read_b128 v[96:99], v18 offset:0
v_mfma_f32_16x16x32_bf16 v[172:175], v[80:83], v[56:59], v[172:175]
s_waitcnt lgkmcnt(9)
buffer_load_dwordx4 v7, s[12:15], s72 offen offset:3072 lds
v_mfma_f32_16x16x32_bf16 v[188:191], v[88:91], v[56:59], 0
ds_read_b64_tr_b16 v[80:81], v14 offset:0
v_accvgpr_read_b32 v24, a136
v_mfma_f32_16x16x32_bf16 v[188:191], v[92:95], v[60:63], v[188:191]
ds_read_b64_tr_b16 v[82:83], v14 offset:1024
v_accvgpr_read_b32 v28, a137
v_mfma_f32_16x16x32_bf16 v[184:187], v[92:95], v[52:55], 0
ds_read_b128 v[100:103], v19 offset:0
v_accvgpr_read_b32 v25, a138
v_mfma_f32_16x16x32_bf16 v[184:187], v[88:91], v[48:51], v[184:187]
ds_read_b64_tr_b16 v[84:85], v14 offset:8192
v_accvgpr_read_b32 v29, a139
v_mfma_f32_16x16x32_bf16 v[180:183], v[88:91], v[40:43], 0
buffer_store_dwordx4 v[20:23], v1, s[44:47], s80 offen sc1
v_mfma_f32_16x16x32_bf16 v[180:183], v[92:95], v[44:47], v[180:183]
s_add_u32 m0, s63, 131072
ds_read_b64_tr_b16 v[86:87], v14 offset:9216
v_accvgpr_read_b32 v26, a140
v_mfma_f32_16x16x32_bf16 v[176:179], v[92:95], v[36:39], 0
s_add_u32 s72, s69, 0
buffer_load_dwordx4 v4, s[4:7], s72 offen lds
v_mfma_f32_16x16x32_bf16 v[176:179], v[88:91], v[32:35], v[176:179]
s_waitcnt lgkmcnt(10)
ds_read_b128 v[104:107], v18 offset:2048
v_accvgpr_read_b32 v30, a141
v_mfma_f32_16x16x32_bf16 v[192:195], v[64:67], v[32:35], 0
ds_read_b64_tr_b16 v[88:89], v15 offset:0
v_accvgpr_read_b32 v27, a142
v_mfma_f32_16x16x32_bf16 v[192:195], v[68:71], v[36:39], v[192:195]
ds_read_b64_tr_b16 v[90:91], v15 offset:1024
v_accvgpr_read_b32 v31, a143
v_mfma_f32_16x16x32_bf16 v[196:199], v[68:71], v[44:47], 0
ds_read_b64_tr_b16 v[92:93], v15 offset:8192
v_cvt_pk_bf16_f32 v24, v24, v28
v_mfma_f32_16x16x32_bf16 v[196:199], v[64:67], v[40:43], v[196:199]
s_add_u32 s72, s69, 15360
buffer_load_dwordx4 v5, s[4:7], s72 offen offset:1024 lds
v_mfma_f32_16x16x32_bf16 v[200:203], v[64:67], v[48:51], 0
ds_read_b64_tr_b16 v[94:95], v15 offset:9216
v_cvt_pk_bf16_f32 v25, v25, v29
v_mfma_f32_16x16x32_bf16 v[200:203], v[68:71], v[52:55], v[200:203]
ds_read_b128 v[108:111], v19 offset:2048
v_cvt_pk_bf16_f32 v26, v26, v30
v_mfma_f32_16x16x32_bf16 v[204:207], v[68:71], v[60:63], 0
v_cvt_pk_bf16_f32 v27, v27, v31
v_mfma_f32_16x16x32_bf16 v[204:207], v[64:67], v[56:59], v[204:207]
s_waitcnt lgkmcnt(12)
ds_read_b128 v[112:115], v18 offset:4096
v_mfma_f32_16x16x32_bf16 v[220:223], v[72:75], v[56:59], 0
s_add_u32 s72, s69, 129024
buffer_load_dwordx4 v4, s[4:7], s72 offen offset:2048 lds
v_mfma_f32_16x16x32_bf16 v[220:223], v[76:79], v[60:63], v[220:223]
s_add_u32 s80, s78, 8192
buffer_store_dwordx4 v[24:27], v1, s[44:47], s80 offen sc1
v_mfma_f32_16x16x32_bf16 v[216:219], v[76:79], v[52:55], 0
s_waitcnt vmcnt(21) lgkmcnt(2)
ds_read_b128 v[116:119], v19 offset:4096
v_mfma_f32_16x16x32_bf16 v[216:219], v[72:75], v[48:51], v[216:219]
s_barrier
ds_read_b128 v[120:123], v18 offset:6144
v_mfma_f32_16x16x32_bf16 v[212:215], v[72:75], v[40:43], 0
ds_read_b64_tr_b16 v[64:65], v8 offset:16384
ds_read_b64_tr_b16 v[66:67], v8 offset:17408
v_mfma_f32_16x16x32_bf16 v[212:215], v[76:79], v[44:47], v[212:215]
ds_read_b64_tr_b16 v[68:69], v8 offset:24576
v_mfma_f32_16x16x32_bf16 v[208:211], v[76:79], v[36:39], 0
s_add_u32 s72, s69, 144384
buffer_load_dwordx4 v5, s[4:7], s72 offen offset:3072 lds
v_mfma_f32_16x16x32_bf16 v[208:211], v[72:75], v[32:35], v[208:211]
ds_read_b64_tr_b16 v[70:71], v8 offset:25600
v_accvgpr_read_b32 v20, a16
v_mfma_f32_16x16x32_bf16 v[224:227], v[80:83], v[32:35], 0
ds_read_b64_tr_b16 v[72:73], v9 offset:16384
v_accvgpr_read_b32 v28, a17
v_mfma_f32_16x16x32_bf16 v[224:227], v[84:87], v[36:39], v[224:227]
ds_read_b64_tr_b16 v[74:75], v9 offset:17408
v_accvgpr_read_b32 v21, a18
v_mfma_f32_16x16x32_bf16 v[228:231], v[84:87], v[44:47], 0
s_add_u32 m0, s63, 135168
v_accvgpr_read_b32 v29, a19
v_accvgpr_read_b32 v22, a48
v_mfma_f32_16x16x32_bf16 v[228:231], v[80:83], v[40:43], v[228:231]
s_add_u32 s72, s70, 0
buffer_load_dwordx4 v4, s[4:7], s72 offen lds
v_mfma_f32_16x16x32_bf16 v[232:235], v[80:83], v[48:51], 0
ds_read_b64_tr_b16 v[76:77], v9 offset:24576
v_accvgpr_read_b32 v30, a49
v_mfma_f32_16x16x32_bf16 v[232:235], v[84:87], v[52:55], v[232:235]
ds_read_b128 v[124:127], v19 offset:6144
v_accvgpr_read_b32 v23, a50
v_mfma_f32_16x16x32_bf16 v[236:239], v[84:87], v[60:63], 0
ds_read_b64_tr_b16 v[78:79], v9 offset:25600
v_accvgpr_read_b32 v31, a51
v_mfma_f32_16x16x32_bf16 v[236:239], v[80:83], v[56:59], v[236:239]
v_mul_f32 v20, s79, v20
v_mul_f32 v28, s79, v28
v_mfma_f32_16x16x32_bf16 v[252:255], v[88:91], v[56:59], 0
s_add_u32 s72, s70, 15360
buffer_load_dwordx4 v5, s[4:7], s72 offen offset:1024 lds
v_mfma_f32_16x16x32_bf16 v[252:255], v[92:95], v[60:63], v[252:255]
ds_read_b64_tr_b16 v[80:81], v10 offset:16384
v_mul_f32 v21, s79, v21
v_mfma_f32_16x16x32_bf16 v[248:251], v[92:95], v[52:55], 0
ds_read_b64_tr_b16 v[82:83], v10 offset:17408
v_mul_f32 v29, s79, v29
v_mfma_f32_16x16x32_bf16 v[248:251], v[88:91], v[48:51], v[248:251]
v_mul_f32 v22, s79, v22
v_mul_f32 v30, s79, v30
v_mfma_f32_16x16x32_bf16 v[244:247], v[88:91], v[40:43], 0
ds_read_b64_tr_b16 v[84:85], v10 offset:24576
v_mul_f32 v23, s79, v23
v_mfma_f32_16x16x32_bf16 v[244:247], v[92:95], v[44:47], v[244:247]
ds_read_b64_tr_b16 v[86:87], v10 offset:25600
v_mul_f32 v31, s79, v31
v_mfma_f32_16x16x32_bf16 v[240:243], v[92:95], v[36:39], 0
s_add_u32 s72, s70, 129024
buffer_load_dwordx4 v4, s[4:7], s72 offen offset:2048 lds
v_mfma_f32_16x16x32_bf16 v[240:243], v[88:91], v[32:35], v[240:243]
s_waitcnt lgkmcnt(5)
v_cvt_pk_bf16_f32 v20, v20, v28
v_cvt_pk_bf16_f32 v21, v21, v29
v_mfma_f32_16x16x32_bf16 v[128:131], v[64:67], v[96:99], v[128:131]
ds_read_b64_tr_b16 v[88:89], v11 offset:16384
v_cvt_pk_bf16_f32 v22, v22, v30
v_mfma_f32_16x16x32_bf16 v[128:131], v[68:71], v[100:103], v[128:131]
ds_read_b64_tr_b16 v[90:91], v11 offset:17408
v_cvt_pk_bf16_f32 v23, v23, v31
v_mfma_f32_16x16x32_bf16 v[132:135], v[68:71], v[108:111], v[132:135]
s_add_u32 s80, s77, 32768
buffer_store_dwordx4 v[20:23], v1, s[44:47], s80 offen sc1
v_mfma_f32_16x16x32_bf16 v[132:135], v[64:67], v[104:107], v[132:135]
s_add_u32 s72, s70, 144384
buffer_load_dwordx4 v5, s[4:7], s72 offen offset:3072 lds
v_mfma_f32_16x16x32_bf16 v[136:139], v[64:67], v[112:115], v[136:139]
ds_read_b64_tr_b16 v[92:93], v11 offset:24576
v_accvgpr_read_b32 v24, a144
v_mfma_f32_16x16x32_bf16 v[136:139], v[68:71], v[116:119], v[136:139]
s_lshl_b32 s71, s73, 12
v_accvgpr_read_b32 v28, a145
v_accvgpr_read_b32 v25, a146
v_mfma_f32_16x16x32_bf16 v[140:143], v[68:71], v[124:127], v[140:143]
s_add_u32 s71, s71, s66
ds_read_b64_tr_b16 v[94:95], v11 offset:25600
v_accvgpr_read_b32 v29, a147
v_mfma_f32_16x16x32_bf16 v[140:143], v[64:67], v[120:123], v[140:143]
s_waitcnt lgkmcnt(8)
v_accvgpr_read_b32 v26, a148
v_accvgpr_read_b32 v30, a149
v_mfma_f32_16x16x32_bf16 v[156:159], v[72:75], v[120:123], v[156:159]
s_add_u32 m0, s64, 0
ds_read_b64_tr_b16 v[64:65], v12 offset:16384
v_accvgpr_read_b32 v27, a150
v_mfma_f32_16x16x32_bf16 v[156:159], v[76:79], v[124:127], v[156:159]
s_add_u32 s72, s71, 0
buffer_load_dwordx4 v6, s[12:15], s72 offen lds
v_mfma_f32_16x16x32_bf16 v[152:155], v[76:79], v[116:119], v[152:155]
s_add_u32 s73, s62, 4
ds_read_b64_tr_b16 v[66:67], v12 offset:17408
v_accvgpr_read_b32 v31, a151
v_mfma_f32_16x16x32_bf16 v[152:155], v[72:75], v[112:115], v[152:155]
s_add_u32 s70, s73, s65
v_cvt_pk_bf16_f32 v24, v24, v28
v_cvt_pk_bf16_f32 v25, v25, v29
v_mfma_f32_16x16x32_bf16 v[148:151], v[72:75], v[104:107], v[148:151]
s_and_b32 s70, s70, 3
ds_read_b64_tr_b16 v[68:69], v12 offset:24576
v_cvt_pk_bf16_f32 v26, v26, v30
v_mfma_f32_16x16x32_bf16 v[148:151], v[76:79], v[108:111], v[148:151]
s_and_b32 s73, s73, 12
ds_read_b64_tr_b16 v[70:71], v12 offset:25600
v_cvt_pk_bf16_f32 v27, v27, v31
v_mfma_f32_16x16x32_bf16 v[144:147], v[76:79], v[100:103], v[144:147]
s_add_u32 s72, s71, 31744
buffer_load_dwordx4 v6, s[12:15], s72 offen offset:1024 lds
v_mfma_f32_16x16x32_bf16 v[144:147], v[72:75], v[96:99], v[144:147]
s_waitcnt lgkmcnt(8)
v_mfma_f32_16x16x32_bf16 v[160:163], v[80:83], v[96:99], v[160:163]
s_or_b32 s73, s73, s70
ds_read_b64_tr_b16 v[72:73], v13 offset:16384
v_mfma_f32_16x16x32_bf16 v[160:163], v[84:87], v[100:103], v[160:163]
s_lshl_b32 s73, s73, 7
ds_read_b64_tr_b16 v[74:75], v13 offset:17408
v_mfma_f32_16x16x32_bf16 v[164:167], v[84:87], v[108:111], v[164:167]
s_add_u32 s69, s73, s67
v_mfma_f32_16x16x32_bf16 v[164:167], v[80:83], v[104:107], v[164:167]
s_add_u32 s72, s71, 63488
buffer_load_dwordx4 v7, s[12:15], s72 offen offset:2048 lds
v_mfma_f32_16x16x32_bf16 v[168:171], v[80:83], v[112:115], v[168:171]
s_waitcnt vmcnt(18)
ds_read_b64_tr_b16 v[76:77], v13 offset:24576
v_mfma_f32_16x16x32_bf16 v[168:171], v[84:87], v[116:119], v[168:171]
s_add_u32 s70, s73, s68
ds_read_b128 v[32:35], v18 offset:32768
v_mfma_f32_16x16x32_bf16 v[172:175], v[84:87], v[124:127], v[172:175]
s_add_u32 s80, s78, 32768
ds_read_b64_tr_b16 v[78:79], v13 offset:25600
v_mfma_f32_16x16x32_bf16 v[172:175], v[80:83], v[120:123], v[172:175]
s_waitcnt lgkmcnt(9)
ds_read_b128 v[36:39], v19 offset:32768
v_mfma_f32_16x16x32_bf16 v[188:191], v[88:91], v[120:123], v[188:191]
s_add_u32 s72, s71, 95232
buffer_load_dwordx4 v7, s[12:15], s72 offen offset:3072 lds
v_mfma_f32_16x16x32_bf16 v[188:191], v[92:95], v[124:127], v[188:191]
ds_read_b64_tr_b16 v[80:81], v14 offset:16384
v_mfma_f32_16x16x32_bf16 v[184:187], v[92:95], v[116:119], v[184:187]
ds_read_b64_tr_b16 v[82:83], v14 offset:17408
v_mfma_f32_16x16x32_bf16 v[184:187], v[88:91], v[112:115], v[184:187]
buffer_store_dwordx4 v[24:27], v1, s[44:47], s80 offen sc1
v_mfma_f32_16x16x32_bf16 v[180:183], v[88:91], v[104:107], v[180:183]
ds_read_b64_tr_b16 v[84:85], v14 offset:24576
v_accvgpr_read_b32 v20, a20
v_mfma_f32_16x16x32_bf16 v[180:183], v[92:95], v[108:111], v[180:183]
s_add_u32 m0, s63, 65536
ds_read_b64_tr_b16 v[86:87], v14 offset:25600
v_accvgpr_read_b32 v28, a21
v_mfma_f32_16x16x32_bf16 v[176:179], v[92:95], v[100:103], v[176:179]
s_add_u32 s72, s69, 0
buffer_load_dwordx4 v4, s[4:7], s72 offen lds
v_mfma_f32_16x16x32_bf16 v[176:179], v[88:91], v[96:99], v[176:179]
s_waitcnt lgkmcnt(10)
ds_read_b128 v[40:43], v18 offset:34816
v_accvgpr_read_b32 v21, a22
v_mfma_f32_16x16x32_bf16 v[192:195], v[64:67], v[96:99], v[192:195]
ds_read_b64_tr_b16 v[88:89], v15 offset:16384
v_accvgpr_read_b32 v29, a23
v_mfma_f32_16x16x32_bf16 v[192:195], v[68:71], v[100:103], v[192:195]
ds_read_b64_tr_b16 v[90:91], v15 offset:17408
v_accvgpr_read_b32 v22, a52
v_mfma_f32_16x16x32_bf16 v[196:199], v[68:71], v[108:111], v[196:199]
ds_read_b64_tr_b16 v[92:93], v15 offset:24576
v_accvgpr_read_b32 v30, a53
v_mfma_f32_16x16x32_bf16 v[196:199], v[64:67], v[104:107], v[196:199]
s_add_u32 s72, s69, 15360
buffer_load_dwordx4 v5, s[4:7], s72 offen offset:1024 lds
v_mfma_f32_16x16x32_bf16 v[200:203], v[64:67], v[112:115], v[200:203]
ds_read_b64_tr_b16 v[94:95], v15 offset:25600
v_accvgpr_read_b32 v23, a54
v_mfma_f32_16x16x32_bf16 v[200:203], v[68:71], v[116:119], v[200:203]
ds_read_b128 v[44:47], v19 offset:34816
v_accvgpr_read_b32 v31, a55
v_mfma_f32_16x16x32_bf16 v[204:207], v[68:71], v[124:127], v[204:207]
v_mul_f32 v20, s79, v20
v_mul_f32 v28, s79, v28
v_mfma_f32_16x16x32_bf16 v[204:207], v[64:67], v[120:123], v[204:207]
s_waitcnt lgkmcnt(11)
ds_read_b128 v[48:51], v18 offset:36864
v_mul_f32 v21, s79, v21
v_mfma_f32_16x16x32_bf16 v[220:223], v[72:75], v[120:123], v[220:223]
s_add_u32 s72, s69, 129024
buffer_load_dwordx4 v4, s[4:7], s72 offen offset:2048 lds
v_mfma_f32_16x16x32_bf16 v[220:223], v[76:79], v[124:127], v[220:223]
v_mul_f32 v29, s79, v29
v_mul_f32 v22, s79, v22
v_mfma_f32_16x16x32_bf16 v[216:219], v[76:79], v[116:119], v[216:219]
s_waitcnt vmcnt(19) lgkmcnt(2)
ds_read_b128 v[52:55], v19 offset:36864
v_mul_f32 v30, s79, v30
v_mfma_f32_16x16x32_bf16 v[216:219], v[72:75], v[112:115], v[216:219]
s_barrier
ds_read_b128 v[56:59], v18 offset:38912
v_mul_f32 v23, s79, v23
v_mfma_f32_16x16x32_bf16 v[212:215], v[72:75], v[104:107], v[212:215]
ds_read_b64_tr_b16 v[64:65], v8 offset:32768
ds_read_b64_tr_b16 v[66:67], v8 offset:33792
v_mfma_f32_16x16x32_bf16 v[212:215], v[76:79], v[108:111], v[212:215]
ds_read_b64_tr_b16 v[68:69], v8 offset:40960
v_mul_f32 v31, s79, v31
v_mfma_f32_16x16x32_bf16 v[208:211], v[76:79], v[100:103], v[208:211]
s_add_u32 s72, s69, 144384
buffer_load_dwordx4 v5, s[4:7], s72 offen offset:3072 lds
v_mfma_f32_16x16x32_bf16 v[208:211], v[72:75], v[96:99], v[208:211]
ds_read_b64_tr_b16 v[70:71], v8 offset:41984
v_cvt_pk_bf16_f32 v20, v20, v28
v_mfma_f32_16x16x32_bf16 v[224:227], v[80:83], v[96:99], v[224:227]
ds_read_b64_tr_b16 v[72:73], v9 offset:32768
v_cvt_pk_bf16_f32 v21, v21, v29
v_mfma_f32_16x16x32_bf16 v[224:227], v[84:87], v[100:103], v[224:227]
ds_read_b64_tr_b16 v[74:75], v9 offset:33792
v_cvt_pk_bf16_f32 v22, v22, v30
v_mfma_f32_16x16x32_bf16 v[228:231], v[84:87], v[108:111], v[228:231]
s_add_u32 m0, s63, 69632
v_cvt_pk_bf16_f32 v23, v23, v31
v_accvgpr_read_b32 v24, a152
v_mfma_f32_16x16x32_bf16 v[228:231], v[80:83], v[104:107], v[228:231]
s_add_u32 s72, s70, 0
buffer_load_dwordx4 v4, s[4:7], s72 offen lds
v_mfma_f32_16x16x32_bf16 v[232:235], v[80:83], v[112:115], v[232:235]
s_add_u32 s80, s77, 36864
ds_read_b64_tr_b16 v[76:77], v9 offset:40960
v_accvgpr_read_b32 v28, a153
v_mfma_f32_16x16x32_bf16 v[232:235], v[84:87], v[116:119], v[232:235]
ds_read_b128 v[60:63], v19 offset:38912
v_accvgpr_read_b32 v25, a154
v_mfma_f32_16x16x32_bf16 v[236:239], v[84:87], v[124:127], v[236:239]
ds_read_b64_tr_b16 v[78:79], v9 offset:41984
v_accvgpr_read_b32 v29, a155
v_mfma_f32_16x16x32_bf16 v[236:239], v[80:83], v[120:123], v[236:239]
buffer_store_dwordx4 v[20:23], v1, s[44:47], s80 offen sc1
v_mfma_f32_16x16x32_bf16 v[252:255], v[88:91], v[120:123], v[252:255]
s_add_u32 s72, s70, 15360
buffer_load_dwordx4 v5, s[4:7], s72 offen offset:1024 lds
v_mfma_f32_16x16x32_bf16 v[252:255], v[92:95], v[124:127], v[252:255]
ds_read_b64_tr_b16 v[80:81], v10 offset:32768
v_accvgpr_read_b32 v26, a156
v_mfma_f32_16x16x32_bf16 v[248:251], v[92:95], v[116:119], v[248:251]
ds_read_b64_tr_b16 v[82:83], v10 offset:33792
v_accvgpr_read_b32 v30, a157
v_mfma_f32_16x16x32_bf16 v[248:251], v[88:91], v[112:115], v[248:251]
v_accvgpr_read_b32 v27, a158
v_accvgpr_read_b32 v31, a159
v_mfma_f32_16x16x32_bf16 v[244:247], v[88:91], v[104:107], v[244:247]
ds_read_b64_tr_b16 v[84:85], v10 offset:40960
v_cvt_pk_bf16_f32 v24, v24, v28
v_mfma_f32_16x16x32_bf16 v[244:247], v[92:95], v[108:111], v[244:247]
ds_read_b64_tr_b16 v[86:87], v10 offset:41984
v_cvt_pk_bf16_f32 v25, v25, v29
v_mfma_f32_16x16x32_bf16 v[240:243], v[92:95], v[100:103], v[240:243]
s_add_u32 s72, s70, 129024
buffer_load_dwordx4 v4, s[4:7], s72 offen offset:2048 lds
v_mfma_f32_16x16x32_bf16 v[240:243], v[88:91], v[96:99], v[240:243]
s_waitcnt lgkmcnt(5)
v_cvt_pk_bf16_f32 v26, v26, v30
v_cvt_pk_bf16_f32 v27, v27, v31
v_mfma_f32_16x16x32_bf16 v[128:131], v[64:67], v[32:35], v[128:131]
s_add_u32 s80, s78, 40960
ds_read_b64_tr_b16 v[88:89], v11 offset:32768
v_mfma_f32_16x16x32_bf16 v[128:131], v[68:71], v[36:39], v[128:131]
ds_read_b64_tr_b16 v[90:91], v11 offset:33792
v_mfma_f32_16x16x32_bf16 v[132:135], v[68:71], v[44:47], v[132:135]
buffer_store_dwordx4 v[24:27], v1, s[44:47], s80 offen sc1
v_mfma_f32_16x16x32_bf16 v[132:135], v[64:67], v[40:43], v[132:135]
s_add_u32 s72, s70, 144384
buffer_load_dwordx4 v5, s[4:7], s72 offen offset:3072 lds
v_mfma_f32_16x16x32_bf16 v[136:139], v[64:67], v[48:51], v[136:139]
ds_read_b64_tr_b16 v[92:93], v11 offset:40960
v_mfma_f32_16x16x32_bf16 v[136:139], v[68:71], v[52:55], v[136:139]
s_lshl_b32 s71, s73, 12
v_mfma_f32_16x16x32_bf16 v[140:143], v[68:71], v[60:63], v[140:143]
s_add_u32 s71, s71, s66
ds_read_b64_tr_b16 v[94:95], v11 offset:41984
v_mfma_f32_16x16x32_bf16 v[140:143], v[64:67], v[56:59], v[140:143]
s_waitcnt lgkmcnt(8)
v_accvgpr_read_b32 v20, a24
v_accvgpr_read_b32 v28, a25
v_mfma_f32_16x16x32_bf16 v[156:159], v[72:75], v[56:59], v[156:159]
s_add_u32 m0, s64, 16384
ds_read_b64_tr_b16 v[64:65], v12 offset:32768
v_accvgpr_read_b32 v21, a26
v_mfma_f32_16x16x32_bf16 v[156:159], v[76:79], v[60:63], v[156:159]
s_add_u32 s72, s71, 0
buffer_load_dwordx4 v6, s[12:15], s72 offen lds
v_mfma_f32_16x16x32_bf16 v[152:155], v[76:79], v[52:55], v[152:155]
s_add_u32 s73, s62, 5
ds_read_b64_tr_b16 v[66:67], v12 offset:33792
v_accvgpr_read_b32 v29, a27
v_mfma_f32_16x16x32_bf16 v[152:155], v[72:75], v[48:51], v[152:155]
s_add_u32 s70, s73, s65
v_accvgpr_read_b32 v22, a56
v_accvgpr_read_b32 v30, a57
v_mfma_f32_16x16x32_bf16 v[148:151], v[72:75], v[40:43], v[148:151]
s_and_b32 s70, s70, 3
ds_read_b64_tr_b16 v[68:69], v12 offset:40960
v_accvgpr_read_b32 v23, a58
v_mfma_f32_16x16x32_bf16 v[148:151], v[76:79], v[44:47], v[148:151]
s_and_b32 s73, s73, 12
ds_read_b64_tr_b16 v[70:71], v12 offset:41984
v_accvgpr_read_b32 v31, a59
v_mfma_f32_16x16x32_bf16 v[144:147], v[76:79], v[36:39], v[144:147]
s_add_u32 s72, s71, 31744
buffer_load_dwordx4 v6, s[12:15], s72 offen offset:1024 lds
v_mfma_f32_16x16x32_bf16 v[144:147], v[72:75], v[32:35], v[144:147]
s_waitcnt lgkmcnt(8)
v_mul_f32 v20, s79, v20
v_mul_f32 v28, s79, v28
v_mfma_f32_16x16x32_bf16 v[160:163], v[80:83], v[32:35], v[160:163]
s_or_b32 s73, s73, s70
ds_read_b64_tr_b16 v[72:73], v13 offset:32768
v_mul_f32 v21, s79, v21
v_mfma_f32_16x16x32_bf16 v[160:163], v[84:87], v[36:39], v[160:163]
s_lshl_b32 s73, s73, 7
ds_read_b64_tr_b16 v[74:75], v13 offset:33792
v_mul_f32 v29, s79, v29
v_mfma_f32_16x16x32_bf16 v[164:167], v[84:87], v[44:47], v[164:167]
s_add_u32 s69, s73, s67
v_mul_f32 v22, s79, v22
v_mul_f32 v30, s79, v30
v_mfma_f32_16x16x32_bf16 v[164:167], v[80:83], v[40:43], v[164:167]
s_add_u32 s72, s71, 63488
buffer_load_dwordx4 v7, s[12:15], s72 offen offset:2048 lds
v_mfma_f32_16x16x32_bf16 v[168:171], v[80:83], v[48:51], v[168:171]
s_waitcnt vmcnt(18)
ds_read_b64_tr_b16 v[76:77], v13 offset:40960
v_mul_f32 v23, s79, v23
v_mfma_f32_16x16x32_bf16 v[168:171], v[84:87], v[52:55], v[168:171]
s_add_u32 s70, s73, s68
ds_read_b128 v[96:99], v16 offset:0
v_mul_f32 v31, s79, v31
v_mfma_f32_16x16x32_bf16 v[172:175], v[84:87], v[60:63], v[172:175]
ds_read_b64_tr_b16 v[78:79], v13 offset:41984
v_cvt_pk_bf16_f32 v20, v20, v28
v_mfma_f32_16x16x32_bf16 v[172:175], v[80:83], v[56:59], v[172:175]
s_waitcnt lgkmcnt(9)
ds_read_b128 v[100:103], v17 offset:0
v_cvt_pk_bf16_f32 v21, v21, v29
v_mfma_f32_16x16x32_bf16 v[188:191], v[88:91], v[56:59], v[188:191]
s_add_u32 s72, s71, 95232
buffer_load_dwordx4 v7, s[12:15], s72 offen offset:3072 lds
v_mfma_f32_16x16x32_bf16 v[188:191], v[92:95], v[60:63], v[188:191]
ds_read_b64_tr_b16 v[80:81], v14 offset:32768
v_cvt_pk_bf16_f32 v22, v22, v30
v_mfma_f32_16x16x32_bf16 v[184:187], v[92:95], v[52:55], v[184:187]
ds_read_b64_tr_b16 v[82:83], v14 offset:33792
v_cvt_pk_bf16_f32 v23, v23, v31
v_mfma_f32_16x16x32_bf16 v[184:187], v[88:91], v[48:51], v[184:187]
s_add_u32 s80, s77, 40960
buffer_store_dwordx4 v[20:23], v1, s[44:47], s80 offen sc1
v_mfma_f32_16x16x32_bf16 v[180:183], v[88:91], v[40:43], v[180:183]
ds_read_b64_tr_b16 v[84:85], v14 offset:40960
v_mfma_f32_16x16x32_bf16 v[180:183], v[92:95], v[44:47], v[180:183]
s_add_u32 m0, s63, 98304
ds_read_b64_tr_b16 v[86:87], v14 offset:41984
v_accvgpr_read_b32 v24, a160
v_mfma_f32_16x16x32_bf16 v[176:179], v[92:95], v[36:39], v[176:179]
s_add_u32 s72, s69, 0
buffer_load_dwordx4 v4, s[4:7], s72 offen lds
v_mfma_f32_16x16x32_bf16 v[176:179], v[88:91], v[32:35], v[176:179]
s_waitcnt lgkmcnt(10)
ds_read_b128 v[104:107], v16 offset:2048
v_accvgpr_read_b32 v28, a161
v_mfma_f32_16x16x32_bf16 v[192:195], v[64:67], v[32:35], v[192:195]
ds_read_b64_tr_b16 v[88:89], v15 offset:32768
v_accvgpr_read_b32 v25, a162
v_mfma_f32_16x16x32_bf16 v[192:195], v[68:71], v[36:39], v[192:195]
ds_read_b64_tr_b16 v[90:91], v15 offset:33792
v_accvgpr_read_b32 v29, a163
v_mfma_f32_16x16x32_bf16 v[196:199], v[68:71], v[44:47], v[196:199]
ds_read_b64_tr_b16 v[92:93], v15 offset:40960
v_accvgpr_read_b32 v26, a164
v_mfma_f32_16x16x32_bf16 v[196:199], v[64:67], v[40:43], v[196:199]
s_add_u32 s72, s69, 15360
buffer_load_dwordx4 v5, s[4:7], s72 offen offset:1024 lds
v_mfma_f32_16x16x32_bf16 v[200:203], v[64:67], v[48:51], v[200:203]
ds_read_b64_tr_b16 v[94:95], v15 offset:41984
v_accvgpr_read_b32 v30, a165
v_mfma_f32_16x16x32_bf16 v[200:203], v[68:71], v[52:55], v[200:203]
ds_read_b128 v[108:111], v17 offset:2048
v_accvgpr_read_b32 v27, a166
v_mfma_f32_16x16x32_bf16 v[204:207], v[68:71], v[60:63], v[204:207]
v_accvgpr_read_b32 v31, a167
v_cvt_pk_bf16_f32 v24, v24, v28
v_mfma_f32_16x16x32_bf16 v[204:207], v[64:67], v[56:59], v[204:207]
s_waitcnt lgkmcnt(11)
ds_read_b128 v[112:115], v16 offset:4096
v_cvt_pk_bf16_f32 v25, v25, v29
v_mfma_f32_16x16x32_bf16 v[220:223], v[72:75], v[56:59], v[220:223]
s_add_u32 s72, s69, 129024
buffer_load_dwordx4 v4, s[4:7], s72 offen offset:2048 lds
v_mfma_f32_16x16x32_bf16 v[220:223], v[76:79], v[60:63], v[220:223]
v_cvt_pk_bf16_f32 v26, v26, v30
v_cvt_pk_bf16_f32 v27, v27, v31
v_mfma_f32_16x16x32_bf16 v[216:219], v[76:79], v[52:55], v[216:219]
s_waitcnt vmcnt(19) lgkmcnt(2)
ds_read_b128 v[116:119], v17 offset:4096
v_mfma_f32_16x16x32_bf16 v[216:219], v[72:75], v[48:51], v[216:219]
s_barrier
ds_read_b128 v[120:123], v16 offset:6144
v_mfma_f32_16x16x32_bf16 v[212:215], v[72:75], v[40:43], v[212:215]
s_add_u32 s80, s78, 1024
ds_read_b64_tr_b16 v[64:65], v8 offset:0
ds_read_b64_tr_b16 v[66:67], v8 offset:1024
v_mfma_f32_16x16x32_bf16 v[212:215], v[76:79], v[44:47], v[212:215]
ds_read_b64_tr_b16 v[68:69], v8 offset:8192
v_mfma_f32_16x16x32_bf16 v[208:211], v[76:79], v[36:39], v[208:211]
s_add_u32 s72, s69, 144384
buffer_load_dwordx4 v5, s[4:7], s72 offen offset:3072 lds
v_mfma_f32_16x16x32_bf16 v[208:211], v[72:75], v[32:35], v[208:211]
ds_read_b64_tr_b16 v[70:71], v8 offset:9216
v_mfma_f32_16x16x32_bf16 v[224:227], v[80:83], v[32:35], v[224:227]
ds_read_b64_tr_b16 v[72:73], v9 offset:0
v_mfma_f32_16x16x32_bf16 v[224:227], v[84:87], v[36:39], v[224:227]
ds_read_b64_tr_b16 v[74:75], v9 offset:1024
v_mfma_f32_16x16x32_bf16 v[228:231], v[84:87], v[44:47], v[228:231]
s_add_u32 m0, s63, 102400
buffer_store_dwordx4 v[24:27], v1, s[44:47], s80 offen sc1
v_mfma_f32_16x16x32_bf16 v[228:231], v[80:83], v[40:43], v[228:231]
s_add_u32 s72, s70, 0
buffer_load_dwordx4 v4, s[4:7], s72 offen lds
v_mfma_f32_16x16x32_bf16 v[232:235], v[80:83], v[48:51], v[232:235]
ds_read_b64_tr_b16 v[76:77], v9 offset:8192
v_accvgpr_read_b32 v20, a28
v_mfma_f32_16x16x32_bf16 v[232:235], v[84:87], v[52:55], v[232:235]
ds_read_b128 v[124:127], v17 offset:6144
v_accvgpr_read_b32 v28, a29
v_mfma_f32_16x16x32_bf16 v[236:239], v[84:87], v[60:63], v[236:239]
ds_read_b64_tr_b16 v[78:79], v9 offset:9216
v_accvgpr_read_b32 v21, a30
v_mfma_f32_16x16x32_bf16 v[236:239], v[80:83], v[56:59], v[236:239]
v_accvgpr_read_b32 v29, a31
v_accvgpr_read_b32 v22, a60
v_mfma_f32_16x16x32_bf16 v[252:255], v[88:91], v[56:59], v[252:255]
s_add_u32 s72, s70, 15360
buffer_load_dwordx4 v5, s[4:7], s72 offen offset:1024 lds
v_mfma_f32_16x16x32_bf16 v[252:255], v[92:95], v[60:63], v[252:255]
ds_read_b64_tr_b16 v[80:81], v10 offset:0
v_accvgpr_read_b32 v30, a61
v_mfma_f32_16x16x32_bf16 v[248:251], v[92:95], v[52:55], v[248:251]
ds_read_b64_tr_b16 v[82:83], v10 offset:1024
v_accvgpr_read_b32 v23, a62
v_mfma_f32_16x16x32_bf16 v[248:251], v[88:91], v[48:51], v[248:251]
v_accvgpr_read_b32 v31, a63
v_mul_f32 v20, s79, v20
v_mfma_f32_16x16x32_bf16 v[244:247], v[88:91], v[40:43], v[244:247]
ds_read_b64_tr_b16 v[84:85], v10 offset:8192
v_mul_f32 v28, s79, v28
v_mfma_f32_16x16x32_bf16 v[244:247], v[92:95], v[44:47], v[244:247]
ds_read_b64_tr_b16 v[86:87], v10 offset:9216
v_mul_f32 v21, s79, v21
v_mfma_f32_16x16x32_bf16 v[240:243], v[92:95], v[36:39], v[240:243]
s_add_u32 s72, s70, 129024
buffer_load_dwordx4 v4, s[4:7], s72 offen offset:2048 lds
v_mfma_f32_16x16x32_bf16 v[240:243], v[88:91], v[32:35], v[240:243]
s_waitcnt lgkmcnt(5)
v_mul_f32 v29, s79, v29
v_mul_f32 v22, s79, v22
v_mfma_f32_16x16x32_bf16 v[128:131], v[64:67], v[96:99], v[128:131]
ds_read_b64_tr_b16 v[88:89], v11 offset:0
v_mul_f32 v30, s79, v30
v_mfma_f32_16x16x32_bf16 v[128:131], v[68:71], v[100:103], v[128:131]
ds_read_b64_tr_b16 v[90:91], v11 offset:1024
v_mul_f32 v23, s79, v23
v_mfma_f32_16x16x32_bf16 v[132:135], v[68:71], v[108:111], v[132:135]
v_mul_f32 v31, s79, v31
v_cvt_pk_bf16_f32 v20, v20, v28
v_mfma_f32_16x16x32_bf16 v[132:135], v[64:67], v[104:107], v[132:135]
s_add_u32 s72, s70, 144384
buffer_load_dwordx4 v5, s[4:7], s72 offen offset:3072 lds
v_mfma_f32_16x16x32_bf16 v[136:139], v[64:67], v[112:115], v[136:139]
ds_read_b64_tr_b16 v[92:93], v11 offset:8192
v_cvt_pk_bf16_f32 v21, v21, v29
v_mfma_f32_16x16x32_bf16 v[136:139], v[68:71], v[116:119], v[136:139]
s_lshl_b32 s71, s73, 12
v_cvt_pk_bf16_f32 v22, v22, v30
v_cvt_pk_bf16_f32 v23, v23, v31
v_mfma_f32_16x16x32_bf16 v[140:143], v[68:71], v[124:127], v[140:143]
s_add_u32 s71, s71, s66
ds_read_b64_tr_b16 v[94:95], v11 offset:9216
v_mfma_f32_16x16x32_bf16 v[140:143], v[64:67], v[120:123], v[140:143]
s_waitcnt lgkmcnt(8)
v_mfma_f32_16x16x32_bf16 v[156:159], v[72:75], v[120:123], v[156:159]
s_add_u32 m0, s64, 32768
ds_read_b64_tr_b16 v[64:65], v12 offset:0
v_mfma_f32_16x16x32_bf16 v[156:159], v[76:79], v[124:127], v[156:159]
s_add_u32 s72, s71, 0
buffer_load_dwordx4 v6, s[12:15], s72 offen lds
v_mfma_f32_16x16x32_bf16 v[152:155], v[76:79], v[116:119], v[152:155]
s_add_u32 s73, s62, 6
ds_read_b64_tr_b16 v[66:67], v12 offset:1024
v_accvgpr_read_b32 v24, a168
v_mfma_f32_16x16x32_bf16 v[152:155], v[72:75], v[112:115], v[152:155]
s_add_u32 s70, s73, s65
v_accvgpr_read_b32 v28, a169
v_accvgpr_read_b32 v25, a170
v_mfma_f32_16x16x32_bf16 v[148:151], v[72:75], v[104:107], v[148:151]
s_and_b32 s70, s70, 3
ds_read_b64_tr_b16 v[68:69], v12 offset:8192
v_accvgpr_read_b32 v29, a171
v_mfma_f32_16x16x32_bf16 v[148:151], v[76:79], v[108:111], v[148:151]
s_and_b32 s73, s73, 12
ds_read_b64_tr_b16 v[70:71], v12 offset:9216
v_accvgpr_read_b32 v26, a172
v_mfma_f32_16x16x32_bf16 v[144:147], v[76:79], v[100:103], v[144:147]
s_add_u32 s72, s71, 31744
buffer_load_dwordx4 v6, s[12:15], s72 offen offset:1024 lds
v_mfma_f32_16x16x32_bf16 v[144:147], v[72:75], v[96:99], v[144:147]
s_waitcnt lgkmcnt(8)
v_accvgpr_read_b32 v30, a173
v_accvgpr_read_b32 v27, a174
v_mfma_f32_16x16x32_bf16 v[160:163], v[80:83], v[96:99], v[160:163]
s_or_b32 s73, s73, s70
ds_read_b64_tr_b16 v[72:73], v13 offset:0
v_accvgpr_read_b32 v31, a175
v_mfma_f32_16x16x32_bf16 v[160:163], v[84:87], v[100:103], v[160:163]
s_lshl_b32 s73, s73, 7
ds_read_b64_tr_b16 v[74:75], v13 offset:1024
v_cvt_pk_bf16_f32 v24, v24, v28
v_mfma_f32_16x16x32_bf16 v[164:167], v[84:87], v[108:111], v[164:167]
s_add_u32 s69, s73, s67
v_cvt_pk_bf16_f32 v25, v25, v29
v_cvt_pk_bf16_f32 v26, v26, v30
v_mfma_f32_16x16x32_bf16 v[164:167], v[80:83], v[104:107], v[164:167]
s_add_u32 s72, s71, 63488
buffer_load_dwordx4 v7, s[12:15], s72 offen offset:2048 lds
v_mfma_f32_16x16x32_bf16 v[168:171], v[80:83], v[112:115], v[168:171]
s_waitcnt vmcnt(17)
ds_read_b64_tr_b16 v[76:77], v13 offset:8192
v_cvt_pk_bf16_f32 v27, v27, v31
v_mfma_f32_16x16x32_bf16 v[168:171], v[84:87], v[116:119], v[168:171]
s_add_u32 s70, s73, s68
ds_read_b128 v[32:35], v18 offset:0
v_mfma_f32_16x16x32_bf16 v[172:175], v[84:87], v[124:127], v[172:175]
s_add_u32 s80, s77, 45056
ds_read_b64_tr_b16 v[78:79], v13 offset:9216
v_mfma_f32_16x16x32_bf16 v[172:175], v[80:83], v[120:123], v[172:175]
s_waitcnt lgkmcnt(9)
ds_read_b128 v[36:39], v19 offset:0
v_mfma_f32_16x16x32_bf16 v[188:191], v[88:91], v[120:123], v[188:191]
s_add_u32 s72, s71, 95232
buffer_load_dwordx4 v7, s[12:15], s72 offen offset:3072 lds
v_mfma_f32_16x16x32_bf16 v[188:191], v[92:95], v[124:127], v[188:191]
ds_read_b64_tr_b16 v[80:81], v14 offset:0
v_mfma_f32_16x16x32_bf16 v[184:187], v[92:95], v[116:119], v[184:187]
ds_read_b64_tr_b16 v[82:83], v14 offset:1024
v_mfma_f32_16x16x32_bf16 v[184:187], v[88:91], v[112:115], v[184:187]
buffer_store_dwordx4 v[20:23], v1, s[44:47], s80 offen sc1
v_mfma_f32_16x16x32_bf16 v[180:183], v[88:91], v[104:107], v[180:183]
s_add_u32 s80, s78, 9216
ds_read_b64_tr_b16 v[84:85], v14 offset:8192
v_mfma_f32_16x16x32_bf16 v[180:183], v[92:95], v[108:111], v[180:183]
s_add_u32 m0, s63, 131072
ds_read_b64_tr_b16 v[86:87], v14 offset:9216
v_mfma_f32_16x16x32_bf16 v[176:179], v[92:95], v[100:103], v[176:179]
s_add_u32 s72, s69, 0
buffer_load_dwordx4 v4, s[4:7], s72 offen lds
v_mfma_f32_16x16x32_bf16 v[176:179], v[88:91], v[96:99], v[176:179]
s_waitcnt lgkmcnt(10)
ds_read_b128 v[40:43], v18 offset:2048
v_accvgpr_read_b32 v20, a64
v_mfma_f32_16x16x32_bf16 v[192:195], v[64:67], v[96:99], v[192:195]
ds_read_b64_tr_b16 v[88:89], v15 offset:0
v_accvgpr_read_b32 v28, a65
v_mfma_f32_16x16x32_bf16 v[192:195], v[68:71], v[100:103], v[192:195]
ds_read_b64_tr_b16 v[90:91], v15 offset:1024
v_accvgpr_read_b32 v21, a66
v_mfma_f32_16x16x32_bf16 v[196:199], v[68:71], v[108:111], v[196:199]
ds_read_b64_tr_b16 v[92:93], v15 offset:8192
v_accvgpr_read_b32 v29, a67
v_mfma_f32_16x16x32_bf16 v[196:199], v[64:67], v[104:107], v[196:199]
s_add_u32 s72, s69, 15360
buffer_load_dwordx4 v5, s[4:7], s72 offen offset:1024 lds
v_mfma_f32_16x16x32_bf16 v[200:203], v[64:67], v[112:115], v[200:203]
ds_read_b64_tr_b16 v[94:95], v15 offset:9216
v_accvgpr_read_b32 v22, a96
v_mfma_f32_16x16x32_bf16 v[200:203], v[68:71], v[116:119], v[200:203]
ds_read_b128 v[44:47], v19 offset:2048
v_accvgpr_read_b32 v30, a97
v_mfma_f32_16x16x32_bf16 v[204:207], v[68:71], v[124:127], v[204:207]
buffer_store_dwordx4 v[24:27], v1, s[44:47], s80 offen sc1
v_mfma_f32_16x16x32_bf16 v[204:207], v[64:67], v[120:123], v[204:207]
s_waitcnt lgkmcnt(11)
ds_read_b128 v[48:51], v18 offset:4096
v_accvgpr_read_b32 v23, a98
v_mfma_f32_16x16x32_bf16 v[220:223], v[72:75], v[120:123], v[220:223]
s_add_u32 s72, s69, 129024
buffer_load_dwordx4 v4, s[4:7], s72 offen offset:2048 lds
v_mfma_f32_16x16x32_bf16 v[220:223], v[76:79], v[124:127], v[220:223]
v_accvgpr_read_b32 v31, a99
v_mul_f32 v20, s79, v20
v_mfma_f32_16x16x32_bf16 v[216:219], v[76:79], v[116:119], v[216:219]
s_waitcnt vmcnt(19) lgkmcnt(2)
ds_read_b128 v[52:55], v19 offset:4096
v_mul_f32 v28, s79, v28
v_mfma_f32_16x16x32_bf16 v[216:219], v[72:75], v[112:115], v[216:219]
s_barrier
ds_read_b128 v[56:59], v18 offset:6144
v_mul_f32 v21, s79, v21
v_mfma_f32_16x16x32_bf16 v[212:215], v[72:75], v[104:107], v[212:215]
ds_read_b64_tr_b16 v[64:65], v8 offset:16384
ds_read_b64_tr_b16 v[66:67], v8 offset:17408
v_mfma_f32_16x16x32_bf16 v[212:215], v[76:79], v[108:111], v[212:215]
ds_read_b64_tr_b16 v[68:69], v8 offset:24576
v_mul_f32 v29, s79, v29
v_mfma_f32_16x16x32_bf16 v[208:211], v[76:79], v[100:103], v[208:211]
s_add_u32 s72, s69, 144384
buffer_load_dwordx4 v5, s[4:7], s72 offen offset:3072 lds
v_mfma_f32_16x16x32_bf16 v[208:211], v[72:75], v[96:99], v[208:211]
ds_read_b64_tr_b16 v[70:71], v8 offset:25600
v_mul_f32 v22, s79, v22
v_mfma_f32_16x16x32_bf16 v[224:227], v[80:83], v[96:99], v[224:227]
ds_read_b64_tr_b16 v[72:73], v9 offset:16384
v_mul_f32 v30, s79, v30
v_mfma_f32_16x16x32_bf16 v[224:227], v[84:87], v[100:103], v[224:227]
ds_read_b64_tr_b16 v[74:75], v9 offset:17408
v_mul_f32 v23, s79, v23
v_mfma_f32_16x16x32_bf16 v[228:231], v[84:87], v[108:111], v[228:231]
s_add_u32 m0, s63, 135168
v_mul_f32 v31, s79, v31
v_cvt_pk_bf16_f32 v20, v20, v28
v_mfma_f32_16x16x32_bf16 v[228:231], v[80:83], v[104:107], v[228:231]
s_add_u32 s72, s70, 0
buffer_load_dwordx4 v4, s[4:7], s72 offen lds
v_mfma_f32_16x16x32_bf16 v[232:235], v[80:83], v[112:115], v[232:235]
ds_read_b64_tr_b16 v[76:77], v9 offset:24576
v_cvt_pk_bf16_f32 v21, v21, v29
v_mfma_f32_16x16x32_bf16 v[232:235], v[84:87], v[116:119], v[232:235]
ds_read_b128 v[60:63], v19 offset:6144
v_cvt_pk_bf16_f32 v22, v22, v30
v_mfma_f32_16x16x32_bf16 v[236:239], v[84:87], v[124:127], v[236:239]
ds_read_b64_tr_b16 v[78:79], v9 offset:25600
v_cvt_pk_bf16_f32 v23, v23, v31
v_mfma_f32_16x16x32_bf16 v[236:239], v[80:83], v[120:123], v[236:239]
s_add_u32 s80, s77, 1024
buffer_store_dwordx4 v[20:23], v1, s[44:47], s80 offen sc1
v_mfma_f32_16x16x32_bf16 v[252:255], v[88:91], v[120:123], v[252:255]
s_add_u32 s72, s70, 15360
buffer_load_dwordx4 v5, s[4:7], s72 offen offset:1024 lds
v_mfma_f32_16x16x32_bf16 v[252:255], v[92:95], v[124:127], v[252:255]
ds_read_b64_tr_b16 v[80:81], v10 offset:16384
v_accvgpr_read_b32 v24, a176
v_mfma_f32_16x16x32_bf16 v[248:251], v[92:95], v[116:119], v[248:251]
ds_read_b64_tr_b16 v[82:83], v10 offset:17408
v_accvgpr_read_b32 v28, a177
v_mfma_f32_16x16x32_bf16 v[248:251], v[88:91], v[112:115], v[248:251]
v_accvgpr_read_b32 v25, a178
v_accvgpr_read_b32 v29, a179
v_mfma_f32_16x16x32_bf16 v[244:247], v[88:91], v[104:107], v[244:247]
ds_read_b64_tr_b16 v[84:85], v10 offset:24576
v_accvgpr_read_b32 v26, a180
v_mfma_f32_16x16x32_bf16 v[244:247], v[92:95], v[108:111], v[244:247]
ds_read_b64_tr_b16 v[86:87], v10 offset:25600
v_accvgpr_read_b32 v30, a181
v_mfma_f32_16x16x32_bf16 v[240:243], v[92:95], v[100:103], v[240:243]
s_add_u32 s72, s70, 129024
buffer_load_dwordx4 v4, s[4:7], s72 offen offset:2048 lds
v_mfma_f32_16x16x32_bf16 v[240:243], v[88:91], v[96:99], v[240:243]
s_waitcnt lgkmcnt(5)
v_accvgpr_read_b32 v27, a182
v_accvgpr_read_b32 v31, a183
v_mfma_f32_16x16x32_bf16 v[128:131], v[64:67], v[32:35], v[128:131]
ds_read_b64_tr_b16 v[88:89], v11 offset:16384
v_cvt_pk_bf16_f32 v24, v24, v28
v_mfma_f32_16x16x32_bf16 v[128:131], v[68:71], v[36:39], v[128:131]
ds_read_b64_tr_b16 v[90:91], v11 offset:17408
v_cvt_pk_bf16_f32 v25, v25, v29
v_mfma_f32_16x16x32_bf16 v[132:135], v[68:71], v[44:47], v[132:135]
v_cvt_pk_bf16_f32 v26, v26, v30
v_cvt_pk_bf16_f32 v27, v27, v31
v_mfma_f32_16x16x32_bf16 v[132:135], v[64:67], v[40:43], v[132:135]
s_add_u32 s72, s70, 144384
buffer_load_dwordx4 v5, s[4:7], s72 offen offset:3072 lds
v_mfma_f32_16x16x32_bf16 v[136:139], v[64:67], v[48:51], v[136:139]
s_add_u32 s80, s78, 33792
ds_read_b64_tr_b16 v[92:93], v11 offset:24576
v_mfma_f32_16x16x32_bf16 v[136:139], v[68:71], v[52:55], v[136:139]
s_lshl_b32 s71, s73, 12
buffer_store_dwordx4 v[24:27], v1, s[44:47], s80 offen sc1
v_mfma_f32_16x16x32_bf16 v[140:143], v[68:71], v[60:63], v[140:143]
s_add_u32 s71, s71, s66
ds_read_b64_tr_b16 v[94:95], v11 offset:25600
v_mfma_f32_16x16x32_bf16 v[140:143], v[64:67], v[56:59], v[140:143]
s_waitcnt lgkmcnt(8)
v_mfma_f32_16x16x32_bf16 v[156:159], v[72:75], v[56:59], v[156:159]
s_add_u32 m0, s64, 0
ds_read_b64_tr_b16 v[64:65], v12 offset:16384
v_mfma_f32_16x16x32_bf16 v[156:159], v[76:79], v[60:63], v[156:159]
s_add_u32 s72, s71, 0
buffer_load_dwordx4 v6, s[12:15], s72 offen lds
v_mfma_f32_16x16x32_bf16 v[152:155], v[76:79], v[52:55], v[152:155]
s_add_u32 s73, s62, 7
ds_read_b64_tr_b16 v[66:67], v12 offset:17408
v_mfma_f32_16x16x32_bf16 v[152:155], v[72:75], v[48:51], v[152:155]
s_add_u32 s70, s73, s65
v_mfma_f32_16x16x32_bf16 v[148:151], v[72:75], v[40:43], v[148:151]
s_and_b32 s70, s70, 3
ds_read_b64_tr_b16 v[68:69], v12 offset:24576
v_accvgpr_read_b32 v20, a68
v_mfma_f32_16x16x32_bf16 v[148:151], v[76:79], v[44:47], v[148:151]
s_and_b32 s73, s73, 12
ds_read_b64_tr_b16 v[70:71], v12 offset:25600
v_accvgpr_read_b32 v28, a69
v_mfma_f32_16x16x32_bf16 v[144:147], v[76:79], v[36:39], v[144:147]
s_add_u32 s72, s71, 31744
buffer_load_dwordx4 v6, s[12:15], s72 offen offset:1024 lds
v_mfma_f32_16x16x32_bf16 v[144:147], v[72:75], v[32:35], v[144:147]
s_waitcnt lgkmcnt(8)
v_accvgpr_read_b32 v21, a70
v_accvgpr_read_b32 v29, a71
v_mfma_f32_16x16x32_bf16 v[160:163], v[80:83], v[32:35], v[160:163]
s_or_b32 s73, s73, s70
ds_read_b64_tr_b16 v[72:73], v13 offset:16384
v_accvgpr_read_b32 v22, a100
v_mfma_f32_16x16x32_bf16 v[160:163], v[84:87], v[36:39], v[160:163]
s_lshl_b32 s73, s73, 7
ds_read_b64_tr_b16 v[74:75], v13 offset:17408
v_accvgpr_read_b32 v30, a101
v_mfma_f32_16x16x32_bf16 v[164:167], v[84:87], v[44:47], v[164:167]
s_add_u32 s69, s73, s67
v_accvgpr_read_b32 v23, a102
v_accvgpr_read_b32 v31, a103
v_mfma_f32_16x16x32_bf16 v[164:167], v[80:83], v[40:43], v[164:167]
s_add_u32 s72, s71, 63488
buffer_load_dwordx4 v7, s[12:15], s72 offen offset:2048 lds
v_mfma_f32_16x16x32_bf16 v[168:171], v[80:83], v[48:51], v[168:171]
s_waitcnt vmcnt(19)
ds_read_b64_tr_b16 v[76:77], v13 offset:24576
v_mul_f32 v20, s79, v20
v_mfma_f32_16x16x32_bf16 v[168:171], v[84:87], v[52:55], v[168:171]
s_add_u32 s70, s73, s68
ds_read_b128 v[96:99], v18 offset:32768
v_mul_f32 v28, s79, v28
v_mfma_f32_16x16x32_bf16 v[172:175], v[84:87], v[60:63], v[172:175]
ds_read_b64_tr_b16 v[78:79], v13 offset:25600
v_mul_f32 v21, s79, v21
v_mfma_f32_16x16x32_bf16 v[172:175], v[80:83], v[56:59], v[172:175]
s_waitcnt lgkmcnt(9)
ds_read_b128 v[100:103], v19 offset:32768
v_mul_f32 v29, s79, v29
v_mfma_f32_16x16x32_bf16 v[188:191], v[88:91], v[56:59], v[188:191]
s_add_u32 s72, s71, 95232
buffer_load_dwordx4 v7, s[12:15], s72 offen offset:3072 lds
v_mfma_f32_16x16x32_bf16 v[188:191], v[92:95], v[60:63], v[188:191]
ds_read_b64_tr_b16 v[80:81], v14 offset:16384
v_mul_f32 v22, s79, v22
v_mfma_f32_16x16x32_bf16 v[184:187], v[92:95], v[52:55], v[184:187]
ds_read_b64_tr_b16 v[82:83], v14 offset:17408
v_mul_f32 v30, s79, v30
v_mfma_f32_16x16x32_bf16 v[184:187], v[88:91], v[48:51], v[184:187]
v_mul_f32 v23, s79, v23
v_mul_f32 v31, s79, v31
v_mfma_f32_16x16x32_bf16 v[180:183], v[88:91], v[40:43], v[180:183]
ds_read_b64_tr_b16 v[84:85], v14 offset:24576
v_cvt_pk_bf16_f32 v20, v20, v28
v_mfma_f32_16x16x32_bf16 v[180:183], v[92:95], v[44:47], v[180:183]
s_add_u32 m0, s63, 65536
ds_read_b64_tr_b16 v[86:87], v14 offset:25600
v_cvt_pk_bf16_f32 v21, v21, v29
v_mfma_f32_16x16x32_bf16 v[176:179], v[92:95], v[36:39], v[176:179]
s_add_u32 s72, s69, 0
buffer_load_dwordx4 v4, s[4:7], s72 offen lds
v_mfma_f32_16x16x32_bf16 v[176:179], v[88:91], v[32:35], v[176:179]
s_waitcnt lgkmcnt(10)
ds_read_b128 v[104:107], v18 offset:34816
v_cvt_pk_bf16_f32 v22, v22, v30
v_mfma_f32_16x16x32_bf16 v[192:195], v[64:67], v[32:35], v[192:195]
ds_read_b64_tr_b16 v[88:89], v15 offset:16384
v_cvt_pk_bf16_f32 v23, v23, v31
v_mfma_f32_16x16x32_bf16 v[192:195], v[68:71], v[36:39], v[192:195]
s_add_u32 s80, s77, 5120
ds_read_b64_tr_b16 v[90:91], v15 offset:17408
v_mfma_f32_16x16x32_bf16 v[196:199], v[68:71], v[44:47], v[196:199]
ds_read_b64_tr_b16 v[92:93], v15 offset:24576
v_accvgpr_read_b32 v24, a184
v_mfma_f32_16x16x32_bf16 v[196:199], v[64:67], v[40:43], v[196:199]
s_add_u32 s72, s69, 15360
buffer_load_dwordx4 v5, s[4:7], s72 offen offset:1024 lds
v_mfma_f32_16x16x32_bf16 v[200:203], v[64:67], v[48:51], v[200:203]
ds_read_b64_tr_b16 v[94:95], v15 offset:25600
v_accvgpr_read_b32 v28, a185
v_mfma_f32_16x16x32_bf16 v[200:203], v[68:71], v[52:55], v[200:203]
ds_read_b128 v[108:111], v19 offset:34816
v_accvgpr_read_b32 v25, a186
v_mfma_f32_16x16x32_bf16 v[204:207], v[68:71], v[60:63], v[204:207]
buffer_store_dwordx4 v[20:23], v1, s[44:47], s80 offen sc1
v_mfma_f32_16x16x32_bf16 v[204:207], v[64:67], v[56:59], v[204:207]
s_waitcnt lgkmcnt(11)
ds_read_b128 v[112:115], v18 offset:36864
v_accvgpr_read_b32 v29, a187
v_mfma_f32_16x16x32_bf16 v[220:223], v[72:75], v[56:59], v[220:223]
s_add_u32 s72, s69, 129024
buffer_load_dwordx4 v4, s[4:7], s72 offen offset:2048 lds
v_mfma_f32_16x16x32_bf16 v[220:223], v[76:79], v[60:63], v[220:223]
v_accvgpr_read_b32 v26, a188
v_accvgpr_read_b32 v30, a189
v_mfma_f32_16x16x32_bf16 v[216:219], v[76:79], v[52:55], v[216:219]
s_waitcnt vmcnt(20) lgkmcnt(2)
ds_read_b128 v[116:119], v19 offset:36864
v_accvgpr_read_b32 v27, a190
v_mfma_f32_16x16x32_bf16 v[216:219], v[72:75], v[48:51], v[216:219]
s_barrier
ds_read_b128 v[120:123], v18 offset:38912
v_accvgpr_read_b32 v31, a191
v_mfma_f32_16x16x32_bf16 v[212:215], v[72:75], v[40:43], v[212:215]
ds_read_b64_tr_b16 v[64:65], v8 offset:32768
ds_read_b64_tr_b16 v[66:67], v8 offset:33792
v_mfma_f32_16x16x32_bf16 v[212:215], v[76:79], v[44:47], v[212:215]
ds_read_b64_tr_b16 v[68:69], v8 offset:40960
v_cvt_pk_bf16_f32 v24, v24, v28
v_mfma_f32_16x16x32_bf16 v[208:211], v[76:79], v[36:39], v[208:211]
s_add_u32 s72, s69, 144384
buffer_load_dwordx4 v5, s[4:7], s72 offen offset:3072 lds
v_mfma_f32_16x16x32_bf16 v[208:211], v[72:75], v[32:35], v[208:211]
ds_read_b64_tr_b16 v[70:71], v8 offset:41984
v_cvt_pk_bf16_f32 v25, v25, v29
v_mfma_f32_16x16x32_bf16 v[224:227], v[80:83], v[32:35], v[224:227]
ds_read_b64_tr_b16 v[72:73], v9 offset:32768
v_cvt_pk_bf16_f32 v26, v26, v30
v_mfma_f32_16x16x32_bf16 v[224:227], v[84:87], v[36:39], v[224:227]
ds_read_b64_tr_b16 v[74:75], v9 offset:33792
v_cvt_pk_bf16_f32 v27, v27, v31
v_mfma_f32_16x16x32_bf16 v[228:231], v[84:87], v[44:47], v[228:231]
s_add_u32 m0, s63, 69632
v_mfma_f32_16x16x32_bf16 v[228:231], v[80:83], v[40:43], v[228:231]
s_add_u32 s72, s70, 0
buffer_load_dwordx4 v4, s[4:7], s72 offen lds
v_mfma_f32_16x16x32_bf16 v[232:235], v[80:83], v[48:51], v[232:235]
s_add_u32 s80, s78, 41984
ds_read_b64_tr_b16 v[76:77], v9 offset:40960
v_mfma_f32_16x16x32_bf16 v[232:235], v[84:87], v[52:55], v[232:235]
ds_read_b128 v[124:127], v19 offset:38912
v_mfma_f32_16x16x32_bf16 v[236:239], v[84:87], v[60:63], v[236:239]
ds_read_b64_tr_b16 v[78:79], v9 offset:41984
v_mfma_f32_16x16x32_bf16 v[236:239], v[80:83], v[56:59], v[236:239]
buffer_store_dwordx4 v[24:27], v1, s[44:47], s80 offen sc1
v_mfma_f32_16x16x32_bf16 v[252:255], v[88:91], v[56:59], v[252:255]
s_add_u32 s72, s70, 15360
buffer_load_dwordx4 v5, s[4:7], s72 offen offset:1024 lds
v_mfma_f32_16x16x32_bf16 v[252:255], v[92:95], v[60:63], v[252:255]
ds_read_b64_tr_b16 v[80:81], v10 offset:32768
v_accvgpr_read_b32 v20, a72
v_mfma_f32_16x16x32_bf16 v[248:251], v[92:95], v[52:55], v[248:251]
ds_read_b64_tr_b16 v[82:83], v10 offset:33792
v_accvgpr_read_b32 v28, a73
v_mfma_f32_16x16x32_bf16 v[248:251], v[88:91], v[48:51], v[248:251]
v_accvgpr_read_b32 v21, a74
v_accvgpr_read_b32 v29, a75
v_mfma_f32_16x16x32_bf16 v[244:247], v[88:91], v[40:43], v[244:247]
ds_read_b64_tr_b16 v[84:85], v10 offset:40960
v_accvgpr_read_b32 v22, a104
v_mfma_f32_16x16x32_bf16 v[244:247], v[92:95], v[44:47], v[244:247]
ds_read_b64_tr_b16 v[86:87], v10 offset:41984
v_accvgpr_read_b32 v30, a105
v_mfma_f32_16x16x32_bf16 v[240:243], v[92:95], v[36:39], v[240:243]
s_add_u32 s72, s70, 129024
buffer_load_dwordx4 v4, s[4:7], s72 offen offset:2048 lds
v_mfma_f32_16x16x32_bf16 v[240:243], v[88:91], v[32:35], v[240:243]
s_waitcnt lgkmcnt(5)
v_accvgpr_read_b32 v23, a106
v_accvgpr_read_b32 v31, a107
v_mfma_f32_16x16x32_bf16 v[128:131], v[64:67], v[96:99], v[128:131]
s_lshr_b32 s75, s93, 4
ds_read_b64_tr_b16 v[88:89], v11 offset:32768
v_mul_f32 v20, s79, v20
v_mfma_f32_16x16x32_bf16 v[128:131], v[68:71], v[100:103], v[128:131]
s_and_b32 s75, s75, 0x7f00
ds_read_b64_tr_b16 v[90:91], v11 offset:33792
v_mul_f32 v28, s79, v28
v_mfma_f32_16x16x32_bf16 v[132:135], v[68:71], v[108:111], v[132:135]
s_add_u32 s75, s75, LcB1-Lpc0
v_lshrrev_b32 v2, 5, v0
v_lshlrev_b32 v2, 7, v2
v_mfma_f32_16x16x32_bf16 v[132:135], v[64:67], v[104:107], v[132:135]
s_add_u32 s72, s70, 144384
buffer_load_dwordx4 v5, s[4:7], s72 offen offset:3072 lds
v_mfma_f32_16x16x32_bf16 v[136:139], v[64:67], v[112:115], v[136:139]
v_add_u32 v2, s75, v2
v_min_u32 v2, Lcode_end-Lpc0, v2
v_mfma_f32_16x16x32_bf16 v[136:139], v[68:71], v[116:119], v[136:139]
s_lshl_b32 s71, s73, 12
global_load_dword v3, v2, s[98:99]
v_mfma_f32_16x16x32_bf16 v[140:143], v[68:71], v[124:127], v[140:143]
s_add_u32 s71, s71, s66
ds_read_b64_tr_b16 v[92:93], v11 offset:40960
v_mul_f32 v21, s79, v21
v_mfma_f32_16x16x32_bf16 v[140:143], v[64:67], v[120:123], v[140:143]
s_waitcnt lgkmcnt(7)
ds_read_b64_tr_b16 v[94:95], v11 offset:41984
v_mul_f32 v29, s79, v29
v_mfma_f32_16x16x32_bf16 v[156:159], v[72:75], v[120:123], v[156:159]
s_add_u32 m0, s64, 16384
ds_read_b64_tr_b16 v[64:65], v12 offset:32768
v_mul_f32 v22, s79, v22
v_mfma_f32_16x16x32_bf16 v[156:159], v[76:79], v[124:127], v[156:159]
s_add_u32 s72, s71, 0
buffer_load_dwordx4 v6, s[12:15], s72 offen lds
v_mfma_f32_16x16x32_bf16 v[152:155], v[76:79], v[116:119], v[152:155]
s_add_u32 s73, s62, 8
ds_read_b64_tr_b16 v[66:67], v12 offset:33792
v_mul_f32 v30, s79, v30
v_mfma_f32_16x16x32_bf16 v[152:155], v[72:75], v[112:115], v[152:155]
s_add_u32 s70, s73, s65
v_mul_f32 v23, s79, v23
v_mul_f32 v31, s79, v31
v_mfma_f32_16x16x32_bf16 v[148:151], v[72:75], v[104:107], v[148:151]
s_and_b32 s70, s70, 3
ds_read_b64_tr_b16 v[68:69], v12 offset:40960
v_cvt_pk_bf16_f32 v20, v20, v28
v_mfma_f32_16x16x32_bf16 v[148:151], v[76:79], v[108:111], v[148:151]
s_and_b32 s73, s73, 12
ds_read_b64_tr_b16 v[70:71], v12 offset:41984
v_cvt_pk_bf16_f32 v21, v21, v29
v_mfma_f32_16x16x32_bf16 v[144:147], v[76:79], v[100:103], v[144:147]
s_add_u32 s72, s71, 31744
buffer_load_dwordx4 v6, s[12:15], s72 offen offset:1024 lds
v_mfma_f32_16x16x32_bf16 v[144:147], v[72:75], v[96:99], v[144:147]
s_waitcnt lgkmcnt(8)
v_cvt_pk_bf16_f32 v22, v22, v30
v_cvt_pk_bf16_f32 v23, v23, v31
v_mfma_f32_16x16x32_bf16 v[160:163], v[80:83], v[96:99], v[160:163]
s_or_b32 s73, s73, s70
ds_read_b64_tr_b16 v[72:73], v13 offset:32768
v_accvgpr_read_b32 v24, a192
v_mfma_f32_16x16x32_bf16 v[160:163], v[84:87], v[100:103], v[160:163]
s_lshl_b32 s73, s73, 7
ds_read_b64_tr_b16 v[74:75], v13 offset:33792
v_accvgpr_read_b32 v28, a193
v_mfma_f32_16x16x32_bf16 v[164:167], v[84:87], v[108:111], v[164:167]
s_add_u32 s69, s73, s67
v_accvgpr_read_b32 v25, a194
v_accvgpr_read_b32 v29, a195
v_mfma_f32_16x16x32_bf16 v[164:167], v[80:83], v[104:107], v[164:167]
s_add_u32 s72, s71, 63488
buffer_load_dwordx4 v7, s[12:15], s72 offen offset:2048 lds
v_mfma_f32_16x16x32_bf16 v[168:171], v[80:83], v[112:115], v[168:171]
s_waitcnt vmcnt(19)
ds_read_b64_tr_b16 v[76:77], v13 offset:40960
v_accvgpr_read_b32 v26, a196
v_mfma_f32_16x16x32_bf16 v[168:171], v[84:87], v[116:119], v[168:171]
s_add_u32 s70, s73, s68
ds_read_b128 v[32:35], v16 offset:0
v_accvgpr_read_b32 v30, a197
v_mfma_f32_16x16x32_bf16 v[172:175], v[84:87], v[124:127], v[172:175]
s_add_u32 s80, s77, 9216
ds_read_b64_tr_b16 v[78:79], v13 offset:41984
v_accvgpr_read_b32 v27, a198
v_mfma_f32_16x16x32_bf16 v[172:175], v[80:83], v[120:123], v[172:175]
s_waitcnt lgkmcnt(9)
ds_read_b128 v[36:39], v17 offset:0
v_accvgpr_read_b32 v31, a199
v_mfma_f32_16x16x32_bf16 v[188:191], v[88:91], v[120:123], v[188:191]
s_add_u32 s72, s71, 95232
buffer_load_dwordx4 v7, s[12:15], s72 offen offset:3072 lds
v_mfma_f32_16x16x32_bf16 v[188:191], v[92:95], v[124:127], v[188:191]
ds_read_b64_tr_b16 v[80:81], v14 offset:32768
v_cvt_pk_bf16_f32 v24, v24, v28
v_mfma_f32_16x16x32_bf16 v[184:187], v[92:95], v[116:119], v[184:187]
ds_read_b64_tr_b16 v[82:83], v14 offset:33792
v_cvt_pk_bf16_f32 v25, v25, v29
v_mfma_f32_16x16x32_bf16 v[184:187], v[88:91], v[112:115], v[184:187]
buffer_store_dwordx4 v[20:23], v1, s[44:47], s80 offen sc1
v_mfma_f32_16x16x32_bf16 v[180:183], v[88:91], v[104:107], v[180:183]
ds_read_b64_tr_b16 v[84:85], v14 offset:40960
v_cvt_pk_bf16_f32 v26, v26, v30
v_mfma_f32_16x16x32_bf16 v[180:183], v[92:95], v[108:111], v[180:183]
s_add_u32 m0, s63, 98304
ds_read_b64_tr_b16 v[86:87], v14 offset:41984
v_cvt_pk_bf16_f32 v27, v27, v31
v_mfma_f32_16x16x32_bf16 v[176:179], v[92:95], v[100:103], v[176:179]
s_add_u32 s72, s69, 0
buffer_load_dwordx4 v4, s[4:7], s72 offen lds
v_mfma_f32_16x16x32_bf16 v[176:179], v[88:91], v[96:99], v[176:179]
s_waitcnt lgkmcnt(10)
ds_read_b128 v[40:43], v16 offset:2048
v_mfma_f32_16x16x32_bf16 v[192:195], v[64:67], v[96:99], v[192:195]
s_add_u32 s80, s78, 2048
ds_read_b64_tr_b16 v[88:89], v15 offset:32768
v_mfma_f32_16x16x32_bf16 v[192:195], v[68:71], v[100:103], v[192:195]
ds_read_b64_tr_b16 v[90:91], v15 offset:33792
v_mfma_f32_16x16x32_bf16 v[196:199], v[68:71], v[108:111], v[196:199]
ds_read_b64_tr_b16 v[92:93], v15 offset:40960
v_mfma_f32_16x16x32_bf16 v[196:199], v[64:67], v[104:107], v[196:199]
s_add_u32 s72, s69, 15360
buffer_load_dwordx4 v5, s[4:7], s72 offen offset:1024 lds
v_mfma_f32_16x16x32_bf16 v[200:203], v[64:67], v[112:115], v[200:203]
ds_read_b64_tr_b16 v[94:95], v15 offset:41984
v_accvgpr_read_b32 v20, a76
v_mfma_f32_16x16x32_bf16 v[200:203], v[68:71], v[116:119], v[200:203]
ds_read_b128 v[44:47], v17 offset:2048
v_accvgpr_read_b32 v28, a77
v_mfma_f32_16x16x32_bf16 v[204:207], v[68:71], v[124:127], v[204:207]
buffer_store_dwordx4 v[24:27], v1, s[44:47], s80 offen sc1
v_mfma_f32_16x16x32_bf16 v[204:207], v[64:67], v[120:123], v[204:207]
s_waitcnt lgkmcnt(11)
ds_read_b128 v[48:51], v16 offset:4096
v_accvgpr_read_b32 v21, a78
v_mfma_f32_16x16x32_bf16 v[220:223], v[72:75], v[120:123], v[220:223]
s_add_u32 s72, s69, 129024
buffer_load_dwordx4 v4, s[4:7], s72 offen offset:2048 lds
v_mfma_f32_16x16x32_bf16 v[220:223], v[76:79], v[124:127], v[220:223]
v_accvgpr_read_b32 v29, a79
v_accvgpr_read_b32 v22, a108
v_mfma_f32_16x16x32_bf16 v[216:219], v[76:79], v[116:119], v[216:219]
s_waitcnt vmcnt(20) lgkmcnt(2)
ds_read_b128 v[52:55], v17 offset:4096
v_accvgpr_read_b32 v30, a109
v_mfma_f32_16x16x32_bf16 v[216:219], v[72:75], v[112:115], v[216:219]
s_barrier
ds_read_b128 v[56:59], v16 offset:6144
v_accvgpr_read_b32 v23, a110
v_mfma_f32_16x16x32_bf16 v[212:215], v[72:75], v[104:107], v[212:215]
ds_read_b64_tr_b16 v[64:65], v8 offset:0
ds_read_b64_tr_b16 v[66:67], v8 offset:1024
v_mfma_f32_16x16x32_bf16 v[212:215], v[76:79], v[108:111], v[212:215]
ds_read_b64_tr_b16 v[68:69], v8 offset:8192
v_accvgpr_read_b32 v31, a111
v_mfma_f32_16x16x32_bf16 v[208:211], v[76:79], v[100:103], v[208:211]
s_add_u32 s72, s69, 144384
buffer_load_dwordx4 v5, s[4:7], s72 offen offset:3072 lds
v_mfma_f32_16x16x32_bf16 v[208:211], v[72:75], v[96:99], v[208:211]
ds_read_b64_tr_b16 v[70:71], v8 offset:9216
v_mul_f32 v20, s79, v20
v_mfma_f32_16x16x32_bf16 v[224:227], v[80:83], v[96:99], v[224:227]
ds_read_b64_tr_b16 v[72:73], v9 offset:0
v_mul_f32 v28, s79, v28
v_mfma_f32_16x16x32_bf16 v[224:227], v[84:87], v[100:103], v[224:227]
ds_read_b64_tr_b16 v[74:75], v9 offset:1024
v_mul_f32 v21, s79, v21
v_mfma_f32_16x16x32_bf16 v[228:231], v[84:87], v[108:111], v[228:231]
s_add_u32 m0, s63, 102400
v_mul_f32 v29, s79, v29
v_mul_f32 v22, s79, v22
v_mfma_f32_16x16x32_bf16 v[228:231], v[80:83], v[104:107], v[228:231]
s_add_u32 s72, s70, 0
buffer_load_dwordx4 v4, s[4:7], s72 offen lds
v_mfma_f32_16x16x32_bf16 v[232:235], v[80:83], v[112:115], v[232:235]
ds_read_b64_tr_b16 v[76:77], v9 offset:8192
v_mul_f32 v30, s79, v30
v_mfma_f32_16x16x32_bf16 v[232:235], v[84:87], v[116:119], v[232:235]
ds_read_b128 v[60:63], v17 offset:6144
v_mul_f32 v23, s79, v23
v_mfma_f32_16x16x32_bf16 v[236:239], v[84:87], v[124:127], v[236:239]
ds_read_b64_tr_b16 v[78:79], v9 offset:9216
v_mul_f32 v31, s79, v31
v_mfma_f32_16x16x32_bf16 v[236:239], v[80:83], v[120:123], v[236:239]
v_cvt_pk_bf16_f32 v20, v20, v28
v_cvt_pk_bf16_f32 v21, v21, v29
v_mfma_f32_16x16x32_bf16 v[252:255], v[88:91], v[120:123], v[252:255]
s_add_u32 s72, s70, 15360
buffer_load_dwordx4 v5, s[4:7], s72 offen offset:1024 lds
v_mfma_f32_16x16x32_bf16 v[252:255], v[92:95], v[124:127], v[252:255]
ds_read_b64_tr_b16 v[80:81], v10 offset:0
v_cvt_pk_bf16_f32 v22, v22, v30
v_mfma_f32_16x16x32_bf16 v[248:251], v[92:95], v[116:119], v[248:251]
ds_read_b64_tr_b16 v[82:83], v10 offset:1024
v_cvt_pk_bf16_f32 v23, v23, v31
v_mfma_f32_16x16x32_bf16 v[248:251], v[88:91], v[112:115], v[248:251]
s_add_u32 s80, s77, 13312
buffer_store_dwordx4 v[20:23], v1, s[44:47], s80 offen sc1
v_mfma_f32_16x16x32_bf16 v[244:247], v[88:91], v[104:107], v[244:247]
ds_read_b64_tr_b16 v[84:85], v10 offset:8192
v_accvgpr_read_b32 v24, a200
v_mfma_f32_16x16x32_bf16 v[244:247], v[92:95], v[108:111], v[244:247]
ds_read_b64_tr_b16 v[86:87], v10 offset:9216
v_accvgpr_read_b32 v28, a201
v_mfma_f32_16x16x32_bf16 v[240:243], v[92:95], v[100:103], v[240:243]
s_add_u32 s72, s70, 129024
buffer_load_dwordx4 v4, s[4:7], s72 offen offset:2048 lds
v_mfma_f32_16x16x32_bf16 v[240:243], v[88:91], v[96:99], v[240:243]
s_waitcnt lgkmcnt(5)
v_accvgpr_read_b32 v25, a202
v_accvgpr_read_b32 v29, a203
v_mfma_f32_16x16x32_bf16 v[128:131], v[64:67], v[32:35], v[128:131]
ds_read_b64_tr_b16 v[88:89], v11 offset:0
v_accvgpr_read_b32 v26, a204
v_mfma_f32_16x16x32_bf16 v[128:131], v[68:71], v[36:39], v[128:131]
ds_read_b64_tr_b16 v[90:91], v11 offset:1024
v_accvgpr_read_b32 v30, a205
v_mfma_f32_16x16x32_bf16 v[132:135], v[68:71], v[44:47], v[132:135]
v_accvgpr_read_b32 v27, a206
v_accvgpr_read_b32 v31, a207
v_mfma_f32_16x16x32_bf16 v[132:135], v[64:67], v[40:43], v[132:135]
s_add_u32 s72, s70, 144384
buffer_load_dwordx4 v5, s[4:7], s72 offen offset:3072 lds
v_mfma_f32_16x16x32_bf16 v[136:139], v[64:67], v[48:51], v[136:139]
ds_read_b64_tr_b16 v[92:93], v11 offset:8192
v_cvt_pk_bf16_f32 v24, v24, v28
v_mfma_f32_16x16x32_bf16 v[136:139], v[68:71], v[52:55], v[136:139]
s_lshl_b32 s71, s73, 12
v_cvt_pk_bf16_f32 v25, v25, v29
v_cvt_pk_bf16_f32 v26, v26, v30
v_mfma_f32_16x16x32_bf16 v[140:143], v[68:71], v[60:63], v[140:143]
s_add_u32 s71, s71, s66
ds_read_b64_tr_b16 v[94:95], v11 offset:9216
v_cvt_pk_bf16_f32 v27, v27, v31
v_mfma_f32_16x16x32_bf16 v[140:143], v[64:67], v[56:59], v[140:143]
s_waitcnt lgkmcnt(8)
v_mfma_f32_16x16x32_bf16 v[156:159], v[72:75], v[56:59], v[156:159]
s_add_u32 m0, s64, 32768
ds_read_b64_tr_b16 v[64:65], v12 offset:0
v_mfma_f32_16x16x32_bf16 v[156:159], v[76:79], v[60:63], v[156:159]
s_add_u32 s72, s71, 0
buffer_load_dwordx4 v6, s[12:15], s72 offen lds
v_mfma_f32_16x16x32_bf16 v[152:155], v[76:79], v[52:55], v[152:155]
s_add_u32 s73, s62, 9
ds_read_b64_tr_b16 v[66:67], v12 offset:1024
v_mfma_f32_16x16x32_bf16 v[152:155], v[72:75], v[48:51], v[152:155]
s_add_u32 s70, s73, s65
v_mfma_f32_16x16x32_bf16 v[148:151], v[72:75], v[40:43], v[148:151]
s_and_b32 s70, s70, 3
ds_read_b64_tr_b16 v[68:69], v12 offset:8192
v_mfma_f32_16x16x32_bf16 v[148:151], v[76:79], v[44:47], v[148:151]
s_and_b32 s73, s73, 12
ds_read_b64_tr_b16 v[70:71], v12 offset:9216
v_mfma_f32_16x16x32_bf16 v[144:147], v[76:79], v[36:39], v[144:147]
s_add_u32 s72, s71, 31744
buffer_load_dwordx4 v6, s[12:15], s72 offen offset:1024 lds
v_mfma_f32_16x16x32_bf16 v[144:147], v[72:75], v[32:35], v[144:147]
s_waitcnt lgkmcnt(8)
v_mfma_f32_16x16x32_bf16 v[160:163], v[80:83], v[32:35], v[160:163]
s_or_b32 s73, s73, s70
ds_read_b64_tr_b16 v[72:73], v13 offset:0
v_accvgpr_read_b32 v20, a80
v_mfma_f32_16x16x32_bf16 v[160:163], v[84:87], v[36:39], v[160:163]
s_lshl_b32 s73, s73, 7
ds_read_b64_tr_b16 v[74:75], v13 offset:1024
v_accvgpr_read_b32 v28, a81
v_mfma_f32_16x16x32_bf16 v[164:167], v[84:87], v[44:47], v[164:167]
s_add_u32 s69, s73, s67
v_accvgpr_read_b32 v21, a82
v_accvgpr_read_b32 v29, a83
v_mfma_f32_16x16x32_bf16 v[164:167], v[80:83], v[40:43], v[164:167]
s_add_u32 s72, s71, 63488
buffer_load_dwordx4 v7, s[12:15], s72 offen offset:2048 lds
v_mfma_f32_16x16x32_bf16 v[168:171], v[80:83], v[48:51], v[168:171]
s_waitcnt vmcnt(19)
ds_read_b64_tr_b16 v[76:77], v13 offset:8192
v_accvgpr_read_b32 v22, a112
v_mfma_f32_16x16x32_bf16 v[168:171], v[84:87], v[52:55], v[168:171]
s_add_u32 s70, s73, s68
ds_read_b128 v[96:99], v18 offset:0
v_accvgpr_read_b32 v30, a113
v_mfma_f32_16x16x32_bf16 v[172:175], v[84:87], v[60:63], v[172:175]
s_add_u32 s80, s78, 10240
ds_read_b64_tr_b16 v[78:79], v13 offset:9216
v_accvgpr_read_b32 v23, a114
v_mfma_f32_16x16x32_bf16 v[172:175], v[80:83], v[56:59], v[172:175]
s_waitcnt lgkmcnt(9)
ds_read_b128 v[100:103], v19 offset:0
v_accvgpr_read_b32 v31, a115
v_mfma_f32_16x16x32_bf16 v[188:191], v[88:91], v[56:59], v[188:191]
s_add_u32 s72, s71, 95232
buffer_load_dwordx4 v7, s[12:15], s72 offen offset:3072 lds
v_mfma_f32_16x16x32_bf16 v[188:191], v[92:95], v[60:63], v[188:191]
ds_read_b64_tr_b16 v[80:81], v14 offset:0
v_mul_f32 v20, s79, v20
v_mfma_f32_16x16x32_bf16 v[184:187], v[92:95], v[52:55], v[184:187]
ds_read_b64_tr_b16 v[82:83], v14 offset:1024
v_mul_f32 v28, s79, v28
v_mfma_f32_16x16x32_bf16 v[184:187], v[88:91], v[48:51], v[184:187]
buffer_store_dwordx4 v[24:27], v1, s[44:47], s80 offen sc1
v_mfma_f32_16x16x32_bf16 v[180:183], v[88:91], v[40:43], v[180:183]
ds_read_b64_tr_b16 v[84:85], v14 offset:8192
v_mul_f32 v21, s79, v21
v_mfma_f32_16x16x32_bf16 v[180:183], v[92:95], v[44:47], v[180:183]
s_add_u32 m0, s63, 131072
ds_read_b64_tr_b16 v[86:87], v14 offset:9216
v_mul_f32 v29, s79, v29
v_mfma_f32_16x16x32_bf16 v[176:179], v[92:95], v[36:39], v[176:179]
s_add_u32 s72, s69, 0
buffer_load_dwordx4 v4, s[4:7], s72 offen lds
v_mfma_f32_16x16x32_bf16 v[176:179], v[88:91], v[32:35], v[176:179]
s_waitcnt lgkmcnt(10)
ds_read_b128 v[104:107], v18 offset:2048
v_mul_f32 v22, s79, v22
v_mfma_f32_16x16x32_bf16 v[192:195], v[64:67], v[32:35], v[192:195]
ds_read_b64_tr_b16 v[88:89], v15 offset:0
v_mul_f32 v30, s79, v30
v_mfma_f32_16x16x32_bf16 v[192:195], v[68:71], v[36:39], v[192:195]
ds_read_b64_tr_b16 v[90:91], v15 offset:1024
v_mul_f32 v23, s79, v23
v_mfma_f32_16x16x32_bf16 v[196:199], v[68:71], v[44:47], v[196:199]
ds_read_b64_tr_b16 v[92:93], v15 offset:8192
v_mul_f32 v31, s79, v31
v_mfma_f32_16x16x32_bf16 v[196:199], v[64:67], v[40:43], v[196:199]
s_add_u32 s72, s69, 15360
buffer_load_dwordx4 v5, s[4:7], s72 offen offset:1024 lds
v_mfma_f32_16x16x32_bf16 v[200:203], v[64:67], v[48:51], v[200:203]
ds_read_b64_tr_b16 v[94:95], v15 offset:9216
v_cvt_pk_bf16_f32 v20, v20, v28
v_mfma_f32_16x16x32_bf16 v[200:203], v[68:71], v[52:55], v[200:203]
ds_read_b128 v[108:111], v19 offset:2048
v_cvt_pk_bf16_f32 v21, v21, v29
v_mfma_f32_16x16x32_bf16 v[204:207], v[68:71], v[60:63], v[204:207]
v_cvt_pk_bf16_f32 v22, v22, v30
v_cvt_pk_bf16_f32 v23, v23, v31
v_mfma_f32_16x16x32_bf16 v[204:207], v[64:67], v[56:59], v[204:207]
s_waitcnt lgkmcnt(11)
ds_read_b128 v[112:115], v18 offset:4096
v_accvgpr_read_b32 v24, a208
v_mfma_f32_16x16x32_bf16 v[220:223], v[72:75], v[56:59], v[220:223]
s_add_u32 s72, s69, 129024
buffer_load_dwordx4 v4, s[4:7], s72 offen offset:2048 lds
v_mfma_f32_16x16x32_bf16 v[220:223], v[76:79], v[60:63], v[220:223]
s_add_u32 s80, s77, 33792
buffer_store_dwordx4 v[20:23], v1, s[44:47], s80 offen sc1
v_mfma_f32_16x16x32_bf16 v[216:219], v[76:79], v[52:55], v[216:219]
s_waitcnt vmcnt(20) lgkmcnt(2)
ds_read_b128 v[116:119], v19 offset:4096
v_accvgpr_read_b32 v28, a209
v_mfma_f32_16x16x32_bf16 v[216:219], v[72:75], v[48:51], v[216:219]
s_barrier
ds_read_b128 v[120:123], v18 offset:6144
v_accvgpr_read_b32 v25, a210
v_mfma_f32_16x16x32_bf16 v[212:215], v[72:75], v[40:43], v[212:215]
ds_read_b64_tr_b16 v[64:65], v8 offset:16384
ds_read_b64_tr_b16 v[66:67], v8 offset:17408
v_mfma_f32_16x16x32_bf16 v[212:215], v[76:79], v[44:47], v[212:215]
ds_read_b64_tr_b16 v[68:69], v8 offset:24576
v_accvgpr_read_b32 v29, a211
v_mfma_f32_16x16x32_bf16 v[208:211], v[76:79], v[36:39], v[208:211]
s_add_u32 s72, s69, 144384
buffer_load_dwordx4 v5, s[4:7], s72 offen offset:3072 lds
v_mfma_f32_16x16x32_bf16 v[208:211], v[72:75], v[32:35], v[208:211]
ds_read_b64_tr_b16 v[70:71], v8 offset:25600
v_accvgpr_read_b32 v26, a212
v_mfma_f32_16x16x32_bf16 v[224:227], v[80:83], v[32:35], v[224:227]
ds_read_b64_tr_b16 v[72:73], v9 offset:16384
v_accvgpr_read_b32 v30, a213
v_mfma_f32_16x16x32_bf16 v[224:227], v[84:87], v[36:39], v[224:227]
ds_read_b64_tr_b16 v[74:75], v9 offset:17408
v_accvgpr_read_b32 v27, a214
v_mfma_f32_16x16x32_bf16 v[228:231], v[84:87], v[44:47], v[228:231]
s_add_u32 m0, s63, 135168
v_accvgpr_read_b32 v31, a215
v_cvt_pk_bf16_f32 v24, v24, v28
v_mfma_f32_16x16x32_bf16 v[228:231], v[80:83], v[40:43], v[228:231]
s_add_u32 s72, s70, 0
buffer_load_dwordx4 v4, s[4:7], s72 offen lds
v_mfma_f32_16x16x32_bf16 v[232:235], v[80:83], v[48:51], v[232:235]
ds_read_b64_tr_b16 v[76:77], v9 offset:24576
v_cvt_pk_bf16_f32 v25, v25, v29
v_mfma_f32_16x16x32_bf16 v[232:235], v[84:87], v[52:55], v[232:235]
ds_read_b128 v[124:127], v19 offset:6144
v_cvt_pk_bf16_f32 v26, v26, v30
v_mfma_f32_16x16x32_bf16 v[236:239], v[84:87], v[60:63], v[236:239]
ds_read_b64_tr_b16 v[78:79], v9 offset:25600
v_cvt_pk_bf16_f32 v27, v27, v31
v_mfma_f32_16x16x32_bf16 v[236:239], v[80:83], v[56:59], v[236:239]
s_add_u32 s80, s78, 34816
buffer_store_dwordx4 v[24:27], v1, s[44:47], s80 offen sc1
v_mfma_f32_16x16x32_bf16 v[252:255], v[88:91], v[56:59], v[252:255]
s_add_u32 s72, s70, 15360
buffer_load_dwordx4 v5, s[4:7], s72 offen offset:1024 lds
v_mfma_f32_16x16x32_bf16 v[252:255], v[92:95], v[60:63], v[252:255]
ds_read_b64_tr_b16 v[80:81], v10 offset:16384
v_mfma_f32_16x16x32_bf16 v[248:251], v[92:95], v[52:55], v[248:251]
ds_read_b64_tr_b16 v[82:83], v10 offset:17408
v_mfma_f32_16x16x32_bf16 v[248:251], v[88:91], v[48:51], v[248:251]
v_mfma_f32_16x16x32_bf16 v[244:247], v[88:91], v[40:43], v[244:247]
ds_read_b64_tr_b16 v[84:85], v10 offset:24576
v_mfma_f32_16x16x32_bf16 v[244:247], v[92:95], v[44:47], v[244:247]
ds_read_b64_tr_b16 v[86:87], v10 offset:25600
v_accvgpr_read_b32 v20, a84
v_mfma_f32_16x16x32_bf16 v[240:243], v[92:95], v[36:39], v[240:243]
s_add_u32 s72, s70, 129024
buffer_load_dwordx4 v4, s[4:7], s72 offen offset:2048 lds
v_mfma_f32_16x16x32_bf16 v[240:243], v[88:91], v[32:35], v[240:243]
s_waitcnt lgkmcnt(5)
v_accvgpr_read_b32 v28, a85
v_accvgpr_read_b32 v21, a86
v_mfma_f32_16x16x32_bf16 v[128:131], v[64:67], v[96:99], v[128:131]
ds_read_b64_tr_b16 v[88:89], v11 offset:16384
v_accvgpr_read_b32 v29, a87
v_mfma_f32_16x16x32_bf16 v[128:131], v[68:71], v[100:103], v[128:131]
ds_read_b64_tr_b16 v[90:91], v11 offset:17408
v_accvgpr_read_b32 v22, a116
v_mfma_f32_16x16x32_bf16 v[132:135], v[68:71], v[108:111], v[132:135]
v_accvgpr_read_b32 v30, a117
v_accvgpr_read_b32 v23, a118
v_mfma_f32_16x16x32_bf16 v[132:135], v[64:67], v[104:107], v[132:135]
s_add_u32 s72, s70, 144384
buffer_load_dwordx4 v5, s[4:7], s72 offen offset:3072 lds
v_mfma_f32_16x16x32_bf16 v[136:139], v[64:67], v[112:115], v[136:139]
ds_read_b64_tr_b16 v[92:93], v11 offset:24576
v_accvgpr_read_b32 v31, a119
v_mfma_f32_16x16x32_bf16 v[136:139], v[68:71], v[116:119], v[136:139]
s_lshl_b32 s71, s73, 12
v_mul_f32 v20, s79, v20
v_mul_f32 v28, s79, v28
v_mfma_f32_16x16x32_bf16 v[140:143], v[68:71], v[124:127], v[140:143]
s_add_u32 s71, s71, s66
ds_read_b64_tr_b16 v[94:95], v11 offset:25600
v_mul_f32 v21, s79, v21
v_mfma_f32_16x16x32_bf16 v[140:143], v[64:67], v[120:123], v[140:143]
s_waitcnt lgkmcnt(8)
v_mul_f32 v29, s79, v29
v_mul_f32 v22, s79, v22
v_mfma_f32_16x16x32_bf16 v[156:159], v[72:75], v[120:123], v[156:159]
s_add_u32 m0, s64, 0
ds_read_b64_tr_b16 v[64:65], v12 offset:16384
v_mul_f32 v30, s79, v30
v_mfma_f32_16x16x32_bf16 v[156:159], v[76:79], v[124:127], v[156:159]
s_add_u32 s72, s71, 0
buffer_load_dwordx4 v6, s[12:15], s72 offen lds
v_mfma_f32_16x16x32_bf16 v[152:155], v[76:79], v[116:119], v[152:155]
s_add_u32 s73, s62, 10
ds_read_b64_tr_b16 v[66:67], v12 offset:17408
v_mul_f32 v23, s79, v23
v_mfma_f32_16x16x32_bf16 v[152:155], v[72:75], v[112:115], v[152:155]
s_add_u32 s70, s73, s65
v_mul_f32 v31, s79, v31
v_cvt_pk_bf16_f32 v20, v20, v28
v_mfma_f32_16x16x32_bf16 v[148:151], v[72:75], v[104:107], v[148:151]
s_and_b32 s70, s70, 3
ds_read_b64_tr_b16 v[68:69], v12 offset:24576
v_cvt_pk_bf16_f32 v21, v21, v29
v_mfma_f32_16x16x32_bf16 v[148:151], v[76:79], v[108:111], v[148:151]
s_and_b32 s73, s73, 12
ds_read_b64_tr_b16 v[70:71], v12 offset:25600
v_cvt_pk_bf16_f32 v22, v22, v30
v_mfma_f32_16x16x32_bf16 v[144:147], v[76:79], v[100:103], v[144:147]
s_add_u32 s72, s71, 31744
buffer_load_dwordx4 v6, s[12:15], s72 offen offset:1024 lds
v_mfma_f32_16x16x32_bf16 v[144:147], v[72:75], v[96:99], v[144:147]
s_waitcnt lgkmcnt(8)
v_cvt_pk_bf16_f32 v23, v23, v31
v_mfma_f32_16x16x32_bf16 v[160:163], v[80:83], v[96:99], v[160:163]
s_or_b32 s73, s73, s70
ds_read_b64_tr_b16 v[72:73], v13 offset:16384
v_mfma_f32_16x16x32_bf16 v[160:163], v[84:87], v[100:103], v[160:163]
s_lshl_b32 s73, s73, 7
ds_read_b64_tr_b16 v[74:75], v13 offset:17408
v_mfma_f32_16x16x32_bf16 v[164:167], v[84:87], v[108:111], v[164:167]
s_add_u32 s69, s73, s67
v_mfma_f32_16x16x32_bf16 v[164:167], v[80:83], v[104:107], v[164:167]
s_add_u32 s72, s71, 63488
buffer_load_dwordx4 v7, s[12:15], s72 offen offset:2048 lds
v_mfma_f32_16x16x32_bf16 v[168:171], v[80:83], v[112:115], v[168:171]
s_waitcnt vmcnt(18)
ds_read_b64_tr_b16 v[76:77], v13 offset:24576
v_accvgpr_read_b32 v24, a216
v_mfma_f32_16x16x32_bf16 v[168:171], v[84:87], v[116:119], v[168:171]
s_add_u32 s70, s73, s68
ds_read_b128 v[32:35], v18 offset:32768
v_accvgpr_read_b32 v28, a217
v_mfma_f32_16x16x32_bf16 v[172:175], v[84:87], v[124:127], v[172:175]
s_add_u32 s80, s77, 37888
ds_read_b64_tr_b16 v[78:79], v13 offset:25600
v_accvgpr_read_b32 v25, a218
v_mfma_f32_16x16x32_bf16 v[172:175], v[80:83], v[120:123], v[172:175]
s_waitcnt lgkmcnt(9)
ds_read_b128 v[36:39], v19 offset:32768
v_accvgpr_read_b32 v29, a219
v_mfma_f32_16x16x32_bf16 v[188:191], v[88:91], v[120:123], v[188:191]
s_add_u32 s72, s71, 95232
buffer_load_dwordx4 v7, s[12:15], s72 offen offset:3072 lds
v_mfma_f32_16x16x32_bf16 v[188:191], v[92:95], v[124:127], v[188:191]
ds_read_b64_tr_b16 v[80:81], v14 offset:16384
v_accvgpr_read_b32 v26, a220
v_mfma_f32_16x16x32_bf16 v[184:187], v[92:95], v[116:119], v[184:187]
ds_read_b64_tr_b16 v[82:83], v14 offset:17408
v_accvgpr_read_b32 v30, a221
v_mfma_f32_16x16x32_bf16 v[184:187], v[88:91], v[112:115], v[184:187]
buffer_store_dwordx4 v[20:23], v1, s[44:47], s80 offen sc1
v_mfma_f32_16x16x32_bf16 v[180:183], v[88:91], v[104:107], v[180:183]
ds_read_b64_tr_b16 v[84:85], v14 offset:24576
v_accvgpr_read_b32 v27, a222
v_mfma_f32_16x16x32_bf16 v[180:183], v[92:95], v[108:111], v[180:183]
s_add_u32 m0, s63, 65536
ds_read_b64_tr_b16 v[86:87], v14 offset:25600
v_accvgpr_read_b32 v31, a223
v_mfma_f32_16x16x32_bf16 v[176:179], v[92:95], v[100:103], v[176:179]
s_add_u32 s72, s69, 0
buffer_load_dwordx4 v4, s[4:7], s72 offen lds
v_mfma_f32_16x16x32_bf16 v[176:179], v[88:91], v[96:99], v[176:179]
s_waitcnt lgkmcnt(10)
ds_read_b128 v[40:43], v18 offset:34816
v_cvt_pk_bf16_f32 v24, v24, v28
v_mfma_f32_16x16x32_bf16 v[192:195], v[64:67], v[96:99], v[192:195]
ds_read_b64_tr_b16 v[88:89], v15 offset:16384
v_cvt_pk_bf16_f32 v25, v25, v29
v_mfma_f32_16x16x32_bf16 v[192:195], v[68:71], v[100:103], v[192:195]
ds_read_b64_tr_b16 v[90:91], v15 offset:17408
v_cvt_pk_bf16_f32 v26, v26, v30
v_mfma_f32_16x16x32_bf16 v[196:199], v[68:71], v[108:111], v[196:199]
ds_read_b64_tr_b16 v[92:93], v15 offset:24576
v_cvt_pk_bf16_f32 v27, v27, v31
v_mfma_f32_16x16x32_bf16 v[196:199], v[64:67], v[104:107], v[196:199]
s_add_u32 s72, s69, 15360
buffer_load_dwordx4 v5, s[4:7], s72 offen offset:1024 lds
v_mfma_f32_16x16x32_bf16 v[200:203], v[64:67], v[112:115], v[200:203]
s_add_u32 s80, s78, 43008
ds_read_b64_tr_b16 v[94:95], v15 offset:25600
v_mfma_f32_16x16x32_bf16 v[200:203], v[68:71], v[116:119], v[200:203]
ds_read_b128 v[44:47], v19 offset:34816
v_mfma_f32_16x16x32_bf16 v[204:207], v[68:71], v[124:127], v[204:207]
buffer_store_dwordx4 v[24:27], v1, s[44:47], s80 offen sc1
v_mfma_f32_16x16x32_bf16 v[204:207], v[64:67], v[120:123], v[204:207]
s_waitcnt lgkmcnt(11)
ds_read_b128 v[48:51], v18 offset:36864
v_mfma_f32_16x16x32_bf16 v[220:223], v[72:75], v[120:123], v[220:223]
s_add_u32 s72, s69, 129024
buffer_load_dwordx4 v4, s[4:7], s72 offen offset:2048 lds
v_mfma_f32_16x16x32_bf16 v[220:223], v[76:79], v[124:127], v[220:223]
v_accvgpr_read_b32 v20, a88
v_accvgpr_read_b32 v28, a89
v_mfma_f32_16x16x32_bf16 v[216:219], v[76:79], v[116:119], v[216:219]
s_waitcnt vmcnt(20) lgkmcnt(2)
ds_read_b128 v[52:55], v19 offset:36864
v_accvgpr_read_b32 v21, a90
v_mfma_f32_16x16x32_bf16 v[216:219], v[72:75], v[112:115], v[216:219]
s_barrier
ds_read_b128 v[56:59], v18 offset:38912
v_accvgpr_read_b32 v29, a91
v_mfma_f32_16x16x32_bf16 v[212:215], v[72:75], v[104:107], v[212:215]
ds_read_b64_tr_b16 v[64:65], v8 offset:32768
ds_read_b64_tr_b16 v[66:67], v8 offset:33792
v_mfma_f32_16x16x32_bf16 v[212:215], v[76:79], v[108:111], v[212:215]
ds_read_b64_tr_b16 v[68:69], v8 offset:40960
v_accvgpr_read_b32 v22, a120
v_mfma_f32_16x16x32_bf16 v[208:211], v[76:79], v[100:103], v[208:211]
s_add_u32 s72, s69, 144384
buffer_load_dwordx4 v5, s[4:7], s72 offen offset:3072 lds
v_mfma_f32_16x16x32_bf16 v[208:211], v[72:75], v[96:99], v[208:211]
ds_read_b64_tr_b16 v[70:71], v8 offset:41984
v_accvgpr_read_b32 v30, a121
v_mfma_f32_16x16x32_bf16 v[224:227], v[80:83], v[96:99], v[224:227]
ds_read_b64_tr_b16 v[72:73], v9 offset:32768
v_accvgpr_read_b32 v23, a122
v_mfma_f32_16x16x32_bf16 v[224:227], v[84:87], v[100:103], v[224:227]
ds_read_b64_tr_b16 v[74:75], v9 offset:33792
v_accvgpr_read_b32 v31, a123
v_mfma_f32_16x16x32_bf16 v[228:231], v[84:87], v[108:111], v[228:231]
s_add_u32 m0, s63, 69632
v_mul_f32 v20, s79, v20
v_mul_f32 v28, s79, v28
v_mfma_f32_16x16x32_bf16 v[228:231], v[80:83], v[104:107], v[228:231]
s_add_u32 s72, s70, 0
buffer_load_dwordx4 v4, s[4:7], s72 offen lds
v_mfma_f32_16x16x32_bf16 v[232:235], v[80:83], v[112:115], v[232:235]
ds_read_b64_tr_b16 v[76:77], v9 offset:40960
v_mul_f32 v21, s79, v21
v_mfma_f32_16x16x32_bf16 v[232:235], v[84:87], v[116:119], v[232:235]
ds_read_b128 v[60:63], v19 offset:38912
v_mul_f32 v29, s79, v29
v_mfma_f32_16x16x32_bf16 v[236:239], v[84:87], v[124:127], v[236:239]
ds_read_b64_tr_b16 v[78:79], v9 offset:41984
v_mul_f32 v22, s79, v22
v_mfma_f32_16x16x32_bf16 v[236:239], v[80:83], v[120:123], v[236:239]
v_mul_f32 v30, s79, v30
v_mul_f32 v23, s79, v23
v_mfma_f32_16x16x32_bf16 v[252:255], v[88:91], v[120:123], v[252:255]
s_add_u32 s72, s70, 15360
buffer_load_dwordx4 v5, s[4:7], s72 offen offset:1024 lds
v_mfma_f32_16x16x32_bf16 v[252:255], v[92:95], v[124:127], v[252:255]
ds_read_b64_tr_b16 v[80:81], v10 offset:32768
v_mul_f32 v31, s79, v31
v_mfma_f32_16x16x32_bf16 v[248:251], v[92:95], v[116:119], v[248:251]
ds_read_b64_tr_b16 v[82:83], v10 offset:33792
v_cvt_pk_bf16_f32 v20, v20, v28
v_mfma_f32_16x16x32_bf16 v[248:251], v[88:91], v[112:115], v[248:251]
v_cvt_pk_bf16_f32 v21, v21, v29
v_cvt_pk_bf16_f32 v22, v22, v30
v_mfma_f32_16x16x32_bf16 v[244:247], v[88:91], v[104:107], v[244:247]
ds_read_b64_tr_b16 v[84:85], v10 offset:40960
v_cvt_pk_bf16_f32 v23, v23, v31
v_mfma_f32_16x16x32_bf16 v[244:247], v[92:95], v[108:111], v[244:247]
s_add_u32 s80, s77, 41984
ds_read_b64_tr_b16 v[86:87], v10 offset:41984
v_mfma_f32_16x16x32_bf16 v[240:243], v[92:95], v[100:103], v[240:243]
s_add_u32 s72, s70, 129024
buffer_load_dwordx4 v4, s[4:7], s72 offen offset:2048 lds
v_mfma_f32_16x16x32_bf16 v[240:243], v[88:91], v[96:99], v[240:243]
s_waitcnt lgkmcnt(5)
buffer_store_dwordx4 v[20:23], v1, s[44:47], s80 offen sc1
LcB1:
v_mfma_f32_16x16x32_bf16 v[128:131], v[64:67], v[32:35], v[128:131]
ds_read_b64_tr_b16 v[88:89], v11 offset:32768
v_accvgpr_read_b32 v24, a224
v_mfma_f32_16x16x32_bf16 v[128:131], v[68:71], v[36:39], v[128:131]
ds_read_b64_tr_b16 v[90:91], v11 offset:33792
v_accvgpr_read_b32 v28, a225
v_mfma_f32_16x16x32_bf16 v[132:135], v[68:71], v[44:47], v[132:135]
v_accvgpr_read_b32 v25, a226
v_accvgpr_read_b32 v29, a227
v_mfma_f32_16x16x32_bf16 v[132:135], v[64:67], v[40:43], v[132:135]
s_add_u32 s72, s70, 144384
buffer_load_dwordx4 v5, s[4:7], s72 offen offset:3072 lds
v_mfma_f32_16x16x32_bf16 v[136:139], v[64:67], v[48:51], v[136:139]
ds_read_b64_tr_b16 v[92:93], v11 offset:40960
v_accvgpr_read_b32 v26, a228
v_mfma_f32_16x16x32_bf16 v[136:139], v[68:71], v[52:55], v[136:139]
s_lshl_b32 s71, s73, 12
v_accvgpr_read_b32 v30, a229
v_accvgpr_read_b32 v27, a230
v_mfma_f32_16x16x32_bf16 v[140:143], v[68:71], v[60:63], v[140:143]
s_add_u32 s71, s71, s66
ds_read_b64_tr_b16 v[94:95], v11 offset:41984
v_accvgpr_read_b32 v31, a231
v_mfma_f32_16x16x32_bf16 v[140:143], v[64:67], v[56:59], v[140:143]
s_waitcnt lgkmcnt(8)
v_cvt_pk_bf16_f32 v24, v24, v28
v_cvt_pk_bf16_f32 v25, v25, v29
v_mfma_f32_16x16x32_bf16 v[156:159], v[72:75], v[56:59], v[156:159]
s_add_u32 m0, s64, 16384
ds_read_b64_tr_b16 v[64:65], v12 offset:32768
v_cvt_pk_bf16_f32 v26, v26, v30
v_mfma_f32_16x16x32_bf16 v[156:159], v[76:79], v[60:63], v[156:159]
s_add_u32 s72, s71, 0
buffer_load_dwordx4 v6, s[12:15], s72 offen lds
v_mfma_f32_16x16x32_bf16 v[152:155], v[76:79], v[52:55], v[152:155]
s_add_u32 s73, s62, 11
ds_read_b64_tr_b16 v[66:67], v12 offset:33792
v_cvt_pk_bf16_f32 v27, v27, v31
v_mfma_f32_16x16x32_bf16 v[152:155], v[72:75], v[48:51], v[152:155]
s_add_u32 s70, s73, s65
v_mfma_f32_16x16x32_bf16 v[148:151], v[72:75], v[40:43], v[148:151]
s_and_b32 s70, s70, 3
ds_read_b64_tr_b16 v[68:69], v12 offset:40960
v_mfma_f32_16x16x32_bf16 v[148:151], v[76:79], v[44:47], v[148:151]
s_and_b32 s73, s73, 12
ds_read_b64_tr_b16 v[70:71], v12 offset:41984
v_mfma_f32_16x16x32_bf16 v[144:147], v[76:79], v[36:39], v[144:147]
s_add_u32 s72, s71, 31744
buffer_load_dwordx4 v6, s[12:15], s72 offen offset:1024 lds
v_mfma_f32_16x16x32_bf16 v[144:147], v[72:75], v[32:35], v[144:147]
s_waitcnt lgkmcnt(8)
v_mfma_f32_16x16x32_bf16 v[160:163], v[80:83], v[32:35], v[160:163]
s_or_b32 s73, s73, s70
ds_read_b64_tr_b16 v[72:73], v13 offset:32768
v_mfma_f32_16x16x32_bf16 v[160:163], v[84:87], v[36:39], v[160:163]
s_lshl_b32 s73, s73, 7
ds_read_b64_tr_b16 v[74:75], v13 offset:33792
v_mfma_f32_16x16x32_bf16 v[164:167], v[84:87], v[44:47], v[164:167]
s_add_u32 s69, s73, s67
v_mfma_f32_16x16x32_bf16 v[164:167], v[80:83], v[40:43], v[164:167]
s_add_u32 s72, s71, 63488
buffer_load_dwordx4 v7, s[12:15], s72 offen offset:2048 lds
v_mfma_f32_16x16x32_bf16 v[168:171], v[80:83], v[48:51], v[168:171]
s_waitcnt vmcnt(18)
ds_read_b64_tr_b16 v[76:77], v13 offset:40960
v_mfma_f32_16x16x32_bf16 v[168:171], v[84:87], v[52:55], v[168:171]
s_add_u32 s70, s73, s68
ds_read_b128 v[96:99], v16 offset:0
v_accvgpr_read_b32 v20, a92
v_mfma_f32_16x16x32_bf16 v[172:175], v[84:87], v[60:63], v[172:175]
s_add_u32 s80, s78, 3072
ds_read_b64_tr_b16 v[78:79], v13 offset:41984
v_accvgpr_read_b32 v28, a93
v_mfma_f32_16x16x32_bf16 v[172:175], v[80:83], v[56:59], v[172:175]
s_waitcnt lgkmcnt(9)
ds_read_b128 v[100:103], v17 offset:0
v_accvgpr_read_b32 v21, a94
v_mfma_f32_16x16x32_bf16 v[188:191], v[88:91], v[56:59], v[188:191]
s_add_u32 s72, s71, 95232
buffer_load_dwordx4 v7, s[12:15], s72 offen offset:3072 lds
v_mfma_f32_16x16x32_bf16 v[188:191], v[92:95], v[60:63], v[188:191]
ds_read_b64_tr_b16 v[80:81], v14 offset:32768
v_accvgpr_read_b32 v29, a95
v_mfma_f32_16x16x32_bf16 v[184:187], v[92:95], v[52:55], v[184:187]
ds_read_b64_tr_b16 v[82:83], v14 offset:33792
v_accvgpr_read_b32 v22, a124
v_mfma_f32_16x16x32_bf16 v[184:187], v[88:91], v[48:51], v[184:187]
buffer_store_dwordx4 v[24:27], v1, s[44:47], s80 offen sc1
v_mfma_f32_16x16x32_bf16 v[180:183], v[88:91], v[40:43], v[180:183]
ds_read_b64_tr_b16 v[84:85], v14 offset:40960
v_accvgpr_read_b32 v30, a125
v_mfma_f32_16x16x32_bf16 v[180:183], v[92:95], v[44:47], v[180:183]
s_add_u32 m0, s63, 98304
ds_read_b64_tr_b16 v[86:87], v14 offset:41984
v_accvgpr_read_b32 v23, a126
v_mfma_f32_16x16x32_bf16 v[176:179], v[92:95], v[36:39], v[176:179]
s_add_u32 s72, s69, 0
buffer_load_dwordx4 v4, s[4:7], s72 offen lds
v_mfma_f32_16x16x32_bf16 v[176:179], v[88:91], v[32:35], v[176:179]
s_waitcnt lgkmcnt(10)
ds_read_b128 v[104:107], v16 offset:2048
v_accvgpr_read_b32 v31, a127
v_mfma_f32_16x16x32_bf16 v[192:195], v[64:67], v[32:35], v[192:195]
ds_read_b64_tr_b16 v[88:89], v15 offset:32768
v_mul_f32 v20, s79, v20
v_mfma_f32_16x16x32_bf16 v[192:195], v[68:71], v[36:39], v[192:195]
ds_read_b64_tr_b16 v[90:91], v15 offset:33792
v_mul_f32 v28, s79, v28
v_mfma_f32_16x16x32_bf16 v[196:199], v[68:71], v[44:47], v[196:199]
ds_read_b64_tr_b16 v[92:93], v15 offset:40960
v_mul_f32 v21, s79, v21
v_mfma_f32_16x16x32_bf16 v[196:199], v[64:67], v[40:43], v[196:199]
s_add_u32 s72, s69, 15360
buffer_load_dwordx4 v5, s[4:7], s72 offen offset:1024 lds
v_mfma_f32_16x16x32_bf16 v[200:203], v[64:67], v[48:51], v[200:203]
ds_read_b64_tr_b16 v[94:95], v15 offset:41984
v_mul_f32 v29, s79, v29
v_mfma_f32_16x16x32_bf16 v[200:203], v[68:71], v[52:55], v[200:203]
ds_read_b128 v[108:111], v17 offset:2048
v_mul_f32 v22, s79, v22
v_mfma_f32_16x16x32_bf16 v[204:207], v[68:71], v[60:63], v[204:207]
v_mul_f32 v30, s79, v30
v_mul_f32 v23, s79, v23
v_mfma_f32_16x16x32_bf16 v[204:207], v[64:67], v[56:59], v[204:207]
s_waitcnt lgkmcnt(11)
ds_read_b128 v[112:115], v16 offset:4096
v_mul_f32 v31, s79, v31
v_mfma_f32_16x16x32_bf16 v[220:223], v[72:75], v[56:59], v[220:223]
s_add_u32 s72, s69, 129024
buffer_load_dwordx4 v4, s[4:7], s72 offen offset:2048 lds
v_mfma_f32_16x16x32_bf16 v[220:223], v[76:79], v[60:63], v[220:223]
v_cvt_pk_bf16_f32 v20, v20, v28
v_cvt_pk_bf16_f32 v21, v21, v29
v_mfma_f32_16x16x32_bf16 v[216:219], v[76:79], v[52:55], v[216:219]
s_waitcnt vmcnt(19) lgkmcnt(2)
ds_read_b128 v[116:119], v17 offset:4096
v_cvt_pk_bf16_f32 v22, v22, v30
v_mfma_f32_16x16x32_bf16 v[216:219], v[72:75], v[48:51], v[216:219]
s_barrier
ds_read_b128 v[120:123], v16 offset:6144
v_cvt_pk_bf16_f32 v23, v23, v31
v_mfma_f32_16x16x32_bf16 v[212:215], v[72:75], v[40:43], v[212:215]
s_add_u32 s80, s77, 46080
ds_read_b64_tr_b16 v[64:65], v8 offset:0
ds_read_b64_tr_b16 v[66:67], v8 offset:1024
v_mfma_f32_16x16x32_bf16 v[212:215], v[76:79], v[44:47], v[212:215]
ds_read_b64_tr_b16 v[68:69], v8 offset:8192
v_accvgpr_read_b32 v24, a232
v_mfma_f32_16x16x32_bf16 v[208:211], v[76:79], v[36:39], v[208:211]
s_add_u32 s72, s69, 144384
buffer_load_dwordx4 v5, s[4:7], s72 offen offset:3072 lds
v_mfma_f32_16x16x32_bf16 v[208:211], v[72:75], v[32:35], v[208:211]
ds_read_b64_tr_b16 v[70:71], v8 offset:9216
v_accvgpr_read_b32 v28, a233
v_mfma_f32_16x16x32_bf16 v[224:227], v[80:83], v[32:35], v[224:227]
ds_read_b64_tr_b16 v[72:73], v9 offset:0
v_accvgpr_read_b32 v25, a234
v_mfma_f32_16x16x32_bf16 v[224:227], v[84:87], v[36:39], v[224:227]
ds_read_b64_tr_b16 v[74:75], v9 offset:1024
v_accvgpr_read_b32 v29, a235
v_mfma_f32_16x16x32_bf16 v[228:231], v[84:87], v[44:47], v[228:231]
s_add_u32 m0, s63, 102400
buffer_store_dwordx4 v[20:23], v1, s[44:47], s80 offen sc1
v_mfma_f32_16x16x32_bf16 v[228:231], v[80:83], v[40:43], v[228:231]
s_add_u32 s72, s70, 0
buffer_load_dwordx4 v4, s[4:7], s72 offen lds
v_mfma_f32_16x16x32_bf16 v[232:235], v[80:83], v[48:51], v[232:235]
ds_read_b64_tr_b16 v[76:77], v9 offset:8192
v_accvgpr_read_b32 v26, a236
v_mfma_f32_16x16x32_bf16 v[232:235], v[84:87], v[52:55], v[232:235]
ds_read_b128 v[124:127], v17 offset:6144
v_accvgpr_read_b32 v30, a237
v_mfma_f32_16x16x32_bf16 v[236:239], v[84:87], v[60:63], v[236:239]
ds_read_b64_tr_b16 v[78:79], v9 offset:9216
v_accvgpr_read_b32 v27, a238
v_mfma_f32_16x16x32_bf16 v[236:239], v[80:83], v[56:59], v[236:239]
v_accvgpr_read_b32 v31, a239
v_cvt_pk_bf16_f32 v24, v24, v28
v_mfma_f32_16x16x32_bf16 v[252:255], v[88:91], v[56:59], v[252:255]
s_add_u32 s72, s70, 15360
buffer_load_dwordx4 v5, s[4:7], s72 offen offset:1024 lds
v_mfma_f32_16x16x32_bf16 v[252:255], v[92:95], v[60:63], v[252:255]
ds_read_b64_tr_b16 v[80:81], v10 offset:0
v_cvt_pk_bf16_f32 v25, v25, v29
v_mfma_f32_16x16x32_bf16 v[248:251], v[92:95], v[52:55], v[248:251]
ds_read_b64_tr_b16 v[82:83], v10 offset:1024
v_cvt_pk_bf16_f32 v26, v26, v30
v_mfma_f32_16x16x32_bf16 v[248:251], v[88:91], v[48:51], v[248:251]
v_cvt_pk_bf16_f32 v27, v27, v31
v_mfma_f32_16x16x32_bf16 v[244:247], v[88:91], v[40:43], v[244:247]
s_add_u32 s80, s78, 11264
ds_read_b64_tr_b16 v[84:85], v10 offset:8192
v_mfma_f32_16x16x32_bf16 v[244:247], v[92:95], v[44:47], v[244:247]
ds_read_b64_tr_b16 v[86:87], v10 offset:9216
v_mfma_f32_16x16x32_bf16 v[240:243], v[92:95], v[36:39], v[240:243]
s_add_u32 s72, s70, 129024
buffer_load_dwordx4 v4, s[4:7], s72 offen offset:2048 lds
v_mfma_f32_16x16x32_bf16 v[240:243], v[88:91], v[32:35], v[240:243]
s_waitcnt lgkmcnt(5)
buffer_store_dwordx4 v[24:27], v1, s[44:47], s80 offen sc1
v_mfma_f32_16x16x32_bf16 v[128:131], v[64:67], v[96:99], v[128:131]
ds_read_b64_tr_b16 v[88:89], v11 offset:0
v_mfma_f32_16x16x32_bf16 v[128:131], v[68:71], v[100:103], v[128:131]
ds_read_b64_tr_b16 v[90:91], v11 offset:1024
v_accvgpr_read_b32 v20, a240
v_mfma_f32_16x16x32_bf16 v[132:135], v[68:71], v[108:111], v[132:135]
v_accvgpr_read_b32 v28, a241
v_accvgpr_read_b32 v21, a242
v_mfma_f32_16x16x32_bf16 v[132:135], v[64:67], v[104:107], v[132:135]
s_add_u32 s72, s70, 144384
buffer_load_dwordx4 v5, s[4:7], s72 offen offset:3072 lds
v_mfma_f32_16x16x32_bf16 v[136:139], v[64:67], v[112:115], v[136:139]
ds_read_b64_tr_b16 v[92:93], v11 offset:8192
v_accvgpr_read_b32 v29, a243
v_mfma_f32_16x16x32_bf16 v[136:139], v[68:71], v[116:119], v[136:139]
s_lshl_b32 s71, s73, 12
v_accvgpr_read_b32 v22, a244
v_accvgpr_read_b32 v30, a245
v_mfma_f32_16x16x32_bf16 v[140:143], v[68:71], v[124:127], v[140:143]
s_add_u32 s71, s71, s66
ds_read_b64_tr_b16 v[94:95], v11 offset:9216
v_accvgpr_read_b32 v23, a246
v_mfma_f32_16x16x32_bf16 v[140:143], v[64:67], v[120:123], v[140:143]
s_waitcnt lgkmcnt(8)
v_accvgpr_read_b32 v31, a247
v_cvt_pk_bf16_f32 v20, v20, v28
v_mfma_f32_16x16x32_bf16 v[156:159], v[72:75], v[120:123], v[156:159]
s_add_u32 m0, s64, 32768
ds_read_b64_tr_b16 v[64:65], v12 offset:0
v_cvt_pk_bf16_f32 v21, v21, v29
v_mfma_f32_16x16x32_bf16 v[156:159], v[76:79], v[124:127], v[156:159]
s_add_u32 s72, s71, 0
buffer_load_dwordx4 v6, s[12:15], s72 offen lds
v_mfma_f32_16x16x32_bf16 v[152:155], v[76:79], v[116:119], v[152:155]
s_add_u32 s73, s62, 12
ds_read_b64_tr_b16 v[66:67], v12 offset:1024
v_cvt_pk_bf16_f32 v22, v22, v30
v_mfma_f32_16x16x32_bf16 v[152:155], v[72:75], v[112:115], v[152:155]
s_add_u32 s70, s73, s65
v_cvt_pk_bf16_f32 v23, v23, v31
v_mfma_f32_16x16x32_bf16 v[148:151], v[72:75], v[104:107], v[148:151]
s_and_b32 s70, s70, 3
ds_read_b64_tr_b16 v[68:69], v12 offset:8192
v_mfma_f32_16x16x32_bf16 v[148:151], v[76:79], v[108:111], v[148:151]
s_and_b32 s73, s73, 12
ds_read_b64_tr_b16 v[70:71], v12 offset:9216
v_mfma_f32_16x16x32_bf16 v[144:147], v[76:79], v[100:103], v[144:147]
s_add_u32 s72, s71, 31744
buffer_load_dwordx4 v6, s[12:15], s72 offen offset:1024 lds
v_mfma_f32_16x16x32_bf16 v[144:147], v[72:75], v[96:99], v[144:147]
s_waitcnt lgkmcnt(8)
v_mfma_f32_16x16x32_bf16 v[160:163], v[80:83], v[96:99], v[160:163]
s_or_b32 s73, s73, s70
ds_read_b64_tr_b16 v[72:73], v13 offset:0
v_mfma_f32_16x16x32_bf16 v[160:163], v[84:87], v[100:103], v[160:163]
s_lshl_b32 s73, s73, 7
ds_read_b64_tr_b16 v[74:75], v13 offset:1024
v_mfma_f32_16x16x32_bf16 v[164:167], v[84:87], v[108:111], v[164:167]
s_add_u32 s69, s73, s67
v_mfma_f32_16x16x32_bf16 v[164:167], v[80:83], v[104:107], v[164:167]
s_add_u32 s72, s71, 63488
buffer_load_dwordx4 v7, s[12:15], s72 offen offset:2048 lds
v_mfma_f32_16x16x32_bf16 v[168:171], v[80:83], v[112:115], v[168:171]
s_waitcnt vmcnt(18)
ds_read_b64_tr_b16 v[76:77], v13 offset:8192
v_mfma_f32_16x16x32_bf16 v[168:171], v[84:87], v[116:119], v[168:171]
s_add_u32 s70, s73, s68
ds_read_b128 v[32:35], v18 offset:0
v_mfma_f32_16x16x32_bf16 v[172:175], v[84:87], v[124:127], v[172:175]
s_add_u32 s80, s78, 35840
ds_read_b64_tr_b16 v[78:79], v13 offset:9216
v_mfma_f32_16x16x32_bf16 v[172:175], v[80:83], v[120:123], v[172:175]
s_waitcnt lgkmcnt(9)
ds_read_b128 v[36:39], v19 offset:0
v_accvgpr_read_b32 v24, a248
v_mfma_f32_16x16x32_bf16 v[188:191], v[88:91], v[120:123], v[188:191]
s_add_u32 s72, s71, 95232
buffer_load_dwordx4 v7, s[12:15], s72 offen offset:3072 lds
v_mfma_f32_16x16x32_bf16 v[188:191], v[92:95], v[124:127], v[188:191]
ds_read_b64_tr_b16 v[80:81], v14 offset:0
v_accvgpr_read_b32 v28, a249
v_mfma_f32_16x16x32_bf16 v[184:187], v[92:95], v[116:119], v[184:187]
ds_read_b64_tr_b16 v[82:83], v14 offset:1024
v_accvgpr_read_b32 v25, a250
v_mfma_f32_16x16x32_bf16 v[184:187], v[88:91], v[112:115], v[184:187]
buffer_store_dwordx4 v[20:23], v1, s[44:47], s80 offen sc1
v_mfma_f32_16x16x32_bf16 v[180:183], v[88:91], v[104:107], v[180:183]
ds_read_b64_tr_b16 v[84:85], v14 offset:8192
v_accvgpr_read_b32 v29, a251
v_mfma_f32_16x16x32_bf16 v[180:183], v[92:95], v[108:111], v[180:183]
s_add_u32 m0, s63, 131072
ds_read_b64_tr_b16 v[86:87], v14 offset:9216
v_accvgpr_read_b32 v26, a252
v_mfma_f32_16x16x32_bf16 v[176:179], v[92:95], v[100:103], v[176:179]
s_add_u32 s72, s69, 0
buffer_load_dwordx4 v4, s[4:7], s72 offen lds
v_mfma_f32_16x16x32_bf16 v[176:179], v[88:91], v[96:99], v[176:179]
s_waitcnt lgkmcnt(10)
ds_read_b128 v[40:43], v18 offset:2048
v_accvgpr_read_b32 v30, a253
v_mfma_f32_16x16x32_bf16 v[192:195], v[64:67], v[96:99], v[192:195]
ds_read_b64_tr_b16 v[88:89], v15 offset:0
v_accvgpr_read_b32 v27, a254
v_mfma_f32_16x16x32_bf16 v[192:195], v[68:71], v[100:103], v[192:195]
ds_read_b64_tr_b16 v[90:91], v15 offset:1024
v_accvgpr_read_b32 v31, a255
v_mfma_f32_16x16x32_bf16 v[196:199], v[68:71], v[108:111], v[196:199]
ds_read_b64_tr_b16 v[92:93], v15 offset:8192
v_cvt_pk_bf16_f32 v24, v24, v28
v_mfma_f32_16x16x32_bf16 v[196:199], v[64:67], v[104:107], v[196:199]
s_add_u32 s72, s69, 15360
buffer_load_dwordx4 v5, s[4:7], s72 offen offset:1024 lds
v_mfma_f32_16x16x32_bf16 v[200:203], v[64:67], v[112:115], v[200:203]
ds_read_b64_tr_b16 v[94:95], v15 offset:9216
v_cvt_pk_bf16_f32 v25, v25, v29
v_mfma_f32_16x16x32_bf16 v[200:203], v[68:71], v[116:119], v[200:203]
ds_read_b128 v[44:47], v19 offset:2048
v_cvt_pk_bf16_f32 v26, v26, v30
v_mfma_f32_16x16x32_bf16 v[204:207], v[68:71], v[124:127], v[204:207]
v_cvt_pk_bf16_f32 v27, v27, v31
v_mfma_f32_16x16x32_bf16 v[204:207], v[64:67], v[120:123], v[204:207]
s_waitcnt lgkmcnt(11)
ds_read_b128 v[48:51], v18 offset:4096
v_mfma_f32_16x16x32_bf16 v[220:223], v[72:75], v[120:123], v[220:223]
s_add_u32 s72, s69, 129024
buffer_load_dwordx4 v4, s[4:7], s72 offen offset:2048 lds
v_mfma_f32_16x16x32_bf16 v[220:223], v[76:79], v[124:127], v[220:223]
s_add_u32 s80, s78, 44032
ds_read_b128 v[52:55], v19 offset:4096
v_mfma_f32_16x16x32_bf16 v[216:219], v[76:79], v[116:119], v[216:219]
s_waitcnt vmcnt(19) lgkmcnt(3)
buffer_store_dwordx4 v[24:27], v1, s[44:47], s80 offen sc1
v_mfma_f32_16x16x32_bf16 v[216:219], v[72:75], v[112:115], v[216:219]
s_barrier
ds_read_b128 v[56:59], v18 offset:6144
v_mfma_f32_16x16x32_bf16 v[212:215], v[72:75], v[104:107], v[212:215]
ds_read_b64_tr_b16 v[64:65], v8 offset:16384
ds_read_b64_tr_b16 v[66:67], v8 offset:17408
v_mfma_f32_16x16x32_bf16 v[212:215], v[76:79], v[108:111], v[212:215]
ds_read_b64_tr_b16 v[68:69], v8 offset:24576
ds_read_b64_tr_b16 v[70:71], v8 offset:25600
v_mfma_f32_16x16x32_bf16 v[208:211], v[76:79], v[100:103], v[208:211]
s_add_u32 s72, s69, 144384
buffer_load_dwordx4 v5, s[4:7], s72 offen offset:3072 lds
v_mfma_f32_16x16x32_bf16 v[208:211], v[72:75], v[96:99], v[208:211]
v_and_b32 v2, 31, v0
v_lshlrev_b32 v2, 2, v2
v_mfma_f32_16x16x32_bf16 v[224:227], v[80:83], v[96:99], v[224:227]
buffer_load_dword v3, v2, s[48:51], 0 offen sc1
v_mfma_f32_16x16x32_bf16 v[224:227], v[84:87], v[100:103], v[224:227]
ds_read_b64_tr_b16 v[72:73], v9 offset:16384
v_mfma_f32_16x16x32_bf16 v[228:231], v[84:87], v[108:111], v[228:231]
s_add_u32 m0, s63, 135168
ds_read_b64_tr_b16 v[74:75], v9 offset:17408
v_mfma_f32_16x16x32_bf16 v[228:231], v[80:83], v[104:107], v[228:231]
s_add_u32 s72, s70, 0
buffer_load_dwordx4 v4, s[4:7], s72 offen lds
v_mfma_f32_16x16x32_bf16 v[232:235], v[80:83], v[112:115], v[232:235]
ds_read_b128 v[60:63], v19 offset:6144
v_mfma_f32_16x16x32_bf16 v[232:235], v[84:87], v[116:119], v[232:235]
ds_read_b64_tr_b16 v[76:77], v9 offset:24576
v_mfma_f32_16x16x32_bf16 v[236:239], v[84:87], v[124:127], v[236:239]
ds_read_b64_tr_b16 v[78:79], v9 offset:25600
v_mfma_f32_16x16x32_bf16 v[236:239], v[80:83], v[120:123], v[236:239]
v_mfma_f32_16x16x32_bf16 v[252:255], v[88:91], v[120:123], v[252:255]
s_add_u32 s72, s70, 15360
buffer_load_dwordx4 v5, s[4:7], s72 offen offset:1024 lds
v_mfma_f32_16x16x32_bf16 v[252:255], v[92:95], v[124:127], v[252:255]
ds_read_b64_tr_b16 v[80:81], v10 offset:16384
v_mfma_f32_16x16x32_bf16 v[248:251], v[92:95], v[116:119], v[248:251]
ds_read_b64_tr_b16 v[82:83], v10 offset:17408
v_mfma_f32_16x16x32_bf16 v[248:251], v[88:91], v[112:115], v[248:251]
v_mfma_f32_16x16x32_bf16 v[244:247], v[88:91], v[104:107], v[244:247]
ds_read_b64_tr_b16 v[84:85], v10 offset:24576
v_mfma_f32_16x16x32_bf16 v[244:247], v[92:95], v[108:111], v[244:247]
ds_read_b64_tr_b16 v[86:87], v10 offset:25600
v_mfma_f32_16x16x32_bf16 v[240:243], v[92:95], v[100:103], v[240:243]
s_add_u32 s72, s70, 129024
buffer_load_dwordx4 v4, s[4:7], s72 offen offset:2048 lds
v_mfma_f32_16x16x32_bf16 v[240:243], v[88:91], v[96:99], v[240:243]
s_waitcnt lgkmcnt(6)
v_mfma_f32_16x16x32_bf16 v[128:131], v[64:67], v[32:35], v[128:131]
ds_read_b64_tr_b16 v[88:89], v11 offset:16384
v_mfma_f32_16x16x32_bf16 v[128:131], v[68:71], v[36:39], v[128:131]
ds_read_b64_tr_b16 v[90:91], v11 offset:17408
v_mfma_f32_16x16x32_bf16 v[132:135], v[68:71], v[44:47], v[132:135]
v_mfma_f32_16x16x32_bf16 v[132:135], v[64:67], v[40:43], v[132:135]
s_add_u32 s72, s70, 144384
buffer_load_dwordx4 v5, s[4:7], s72 offen offset:3072 lds
v_mfma_f32_16x16x32_bf16 v[136:139], v[64:67], v[48:51], v[136:139]
ds_read_b64_tr_b16 v[92:93], v11 offset:24576
v_mfma_f32_16x16x32_bf16 v[136:139], v[68:71], v[52:55], v[136:139]
s_lshl_b32 s71, s73, 12
v_mfma_f32_16x16x32_bf16 v[140:143], v[68:71], v[60:63], v[140:143]
s_add_u32 s71, s71, s66
ds_read_b64_tr_b16 v[94:95], v11 offset:25600
v_mfma_f32_16x16x32_bf16 v[140:143], v[64:67], v[56:59], v[140:143]
s_waitcnt lgkmcnt(8)
v_mfma_f32_16x16x32_bf16 v[156:159], v[72:75], v[56:59], v[156:159]
s_add_u32 m0, s64, 0
ds_read_b64_tr_b16 v[64:65], v12 offset:16384
v_mfma_f32_16x16x32_bf16 v[156:159], v[76:79], v[60:63], v[156:159]
s_add_u32 s72, s71, 0
buffer_load_dwordx4 v6, s[12:15], s72 offen lds
v_mfma_f32_16x16x32_bf16 v[152:155], v[76:79], v[52:55], v[152:155]
s_add_u32 s73, s62, 13
ds_read_b64_tr_b16 v[66:67], v12 offset:17408
v_mfma_f32_16x16x32_bf16 v[152:155], v[72:75], v[48:51], v[152:155]
s_add_u32 s70, s73, s65
v_mfma_f32_16x16x32_bf16 v[148:151], v[72:75], v[40:43], v[148:151]
s_and_b32 s70, s70, 3
ds_read_b64_tr_b16 v[68:69], v12 offset:24576
v_mfma_f32_16x16x32_bf16 v[148:151], v[76:79], v[44:47], v[148:151]
s_and_b32 s73, s73, 12
ds_read_b64_tr_b16 v[70:71], v12 offset:25600
v_mfma_f32_16x16x32_bf16 v[144:147], v[76:79], v[36:39], v[144:147]
s_add_u32 s72, s71, 31744
buffer_load_dwordx4 v6, s[12:15], s72 offen offset:1024 lds
v_mfma_f32_16x16x32_bf16 v[144:147], v[72:75], v[32:35], v[144:147]
s_waitcnt lgkmcnt(8)
v_mfma_f32_16x16x32_bf16 v[160:163], v[80:83], v[32:35], v[160:163]
s_or_b32 s73, s73, s70
ds_read_b64_tr_b16 v[72:73], v13 offset:16384
v_mfma_f32_16x16x32_bf16 v[160:163], v[84:87], v[36:39], v[160:163]
s_lshl_b32 s73, s73, 7
ds_read_b64_tr_b16 v[74:75], v13 offset:17408
v_mfma_f32_16x16x32_bf16 v[164:167], v[84:87], v[44:47], v[164:167]
s_add_u32 s69, s73, s67
v_mfma_f32_16x16x32_bf16 v[164:167], v[80:83], v[40:43], v[164:167]
s_add_u32 s72, s71, 63488
buffer_load_dwordx4 v7, s[12:15], s72 offen offset:2048 lds
v_mfma_f32_16x16x32_bf16 v[168:171], v[80:83], v[48:51], v[168:171]
s_waitcnt vmcnt(18)
ds_read_b64_tr_b16 v[76:77], v13 offset:24576
v_mfma_f32_16x16x32_bf16 v[168:171], v[84:87], v[52:55], v[168:171]
s_add_u32 s70, s73, s68
ds_read_b128 v[96:99], v18 offset:32768
v_mfma_f32_16x16x32_bf16 v[172:175], v[84:87], v[60:63], v[172:175]
ds_read_b64_tr_b16 v[78:79], v13 offset:25600
v_mfma_f32_16x16x32_bf16 v[172:175], v[80:83], v[56:59], v[172:175]
s_waitcnt lgkmcnt(9)
ds_read_b128 v[100:103], v19 offset:32768
v_mfma_f32_16x16x32_bf16 v[188:191], v[88:91], v[56:59], v[188:191]
s_add_u32 s72, s71, 95232
buffer_load_dwordx4 v7, s[12:15], s72 offen offset:3072 lds
v_mfma_f32_16x16x32_bf16 v[188:191], v[92:95], v[60:63], v[188:191]
ds_read_b64_tr_b16 v[80:81], v14 offset:16384
v_mfma_f32_16x16x32_bf16 v[184:187], v[92:95], v[52:55], v[184:187]
ds_read_b64_tr_b16 v[82:83], v14 offset:17408
v_mfma_f32_16x16x32_bf16 v[184:187], v[88:91], v[48:51], v[184:187]
v_mfma_f32_16x16x32_bf16 v[180:183], v[88:91], v[40:43], v[180:183]
ds_read_b64_tr_b16 v[84:85], v14 offset:24576
v_mfma_f32_16x16x32_bf16 v[180:183], v[92:95], v[44:47], v[180:183]
s_add_u32 m0, s63, 65536
ds_read_b64_tr_b16 v[86:87], v14 offset:25600
v_mfma_f32_16x16x32_bf16 v[176:179], v[92:95], v[36:39], v[176:179]
s_add_u32 s72, s69, 0
buffer_load_dwordx4 v4, s[4:7], s72 offen lds
v_mfma_f32_16x16x32_bf16 v[176:179], v[88:91], v[32:35], v[176:179]
s_waitcnt lgkmcnt(10)
ds_read_b128 v[104:107], v18 offset:34816
v_mfma_f32_16x16x32_bf16 v[192:195], v[64:67], v[32:35], v[192:195]
ds_read_b64_tr_b16 v[88:89], v15 offset:16384
v_mfma_f32_16x16x32_bf16 v[192:195], v[68:71], v[36:39], v[192:195]
ds_read_b64_tr_b16 v[90:91], v15 offset:17408
v_mfma_f32_16x16x32_bf16 v[196:199], v[68:71], v[44:47], v[196:199]
ds_read_b64_tr_b16 v[92:93], v15 offset:24576
v_mfma_f32_16x16x32_bf16 v[196:199], v[64:67], v[40:43], v[196:199]
s_add_u32 s72, s69, 15360
buffer_load_dwordx4 v5, s[4:7], s72 offen offset:1024 lds
v_mfma_f32_16x16x32_bf16 v[200:203], v[64:67], v[48:51], v[200:203]
ds_read_b64_tr_b16 v[94:95], v15 offset:25600
v_mfma_f32_16x16x32_bf16 v[200:203], v[68:71], v[52:55], v[200:203]
ds_read_b128 v[108:111], v19 offset:34816
v_mfma_f32_16x16x32_bf16 v[204:207], v[68:71], v[60:63], v[204:207]
v_mfma_f32_16x16x32_bf16 v[204:207], v[64:67], v[56:59], v[204:207]
s_waitcnt lgkmcnt(11)
ds_read_b128 v[112:115], v18 offset:36864
v_mfma_f32_16x16x32_bf16 v[220:223], v[72:75], v[56:59], v[220:223]
s_add_u32 s72, s69, 129024
buffer_load_dwordx4 v4, s[4:7], s72 offen offset:2048 lds
v_mfma_f32_16x16x32_bf16 v[220:223], v[76:79], v[60:63], v[220:223]
v_mfma_f32_16x16x32_bf16 v[216:219], v[76:79], v[52:55], v[216:219]
s_waitcnt vmcnt(13) lgkmcnt(2)
ds_read_b128 v[116:119], v19 offset:36864
v_mfma_f32_16x16x32_bf16 v[216:219], v[72:75], v[48:51], v[216:219]
s_barrier
ds_read_b128 v[120:123], v18 offset:38912
v_mfma_f32_16x16x32_bf16 v[212:215], v[72:75], v[40:43], v[212:215]
ds_read_b64_tr_b16 v[64:65], v8 offset:32768
ds_read_b64_tr_b16 v[66:67], v8 offset:33792
v_mfma_f32_16x16x32_bf16 v[212:215], v[76:79], v[44:47], v[212:215]
ds_read_b64_tr_b16 v[68:69], v8 offset:40960
v_or_b32 v20, s58, v0
v_mfma_f32_16x16x32_bf16 v[208:211], v[76:79], v[36:39], v[208:211]
s_add_u32 s72, s69, 144384
buffer_load_dwordx4 v5, s[4:7], s72 offen offset:3072 lds
v_mfma_f32_16x16x32_bf16 v[208:211], v[72:75], v[32:35], v[208:211]
ds_read_b64_tr_b16 v[70:71], v8 offset:41984
v_mov_b32 v21, 1
v_mfma_f32_16x16x32_bf16 v[224:227], v[80:83], v[32:35], v[224:227]
ds_read_b64_tr_b16 v[72:73], v9 offset:32768
v_min_u32 v20, 1, v20
v_mfma_f32_16x16x32_bf16 v[224:227], v[84:87], v[36:39], v[224:227]
ds_read_b64_tr_b16 v[74:75], v9 offset:33792
v_lshlrev_b32 v20, 30, v20
v_mfma_f32_16x16x32_bf16 v[228:231], v[84:87], v[44:47], v[228:231]
s_add_u32 m0, s63, 69632
buffer_store_dword v21, v20, s[44:47], s91 offen sc1
v_mfma_f32_16x16x32_bf16 v[228:231], v[80:83], v[40:43], v[228:231]
s_add_u32 s72, s70, 0
buffer_load_dwordx4 v4, s[4:7], s72 offen lds
v_mfma_f32_16x16x32_bf16 v[232:235], v[80:83], v[48:51], v[232:235]
ds_read_b64_tr_b16 v[76:77], v9 offset:40960
v_mfma_f32_16x16x32_bf16 v[232:235], v[84:87], v[52:55], v[232:235]
ds_read_b128 v[124:127], v19 offset:38912
v_mfma_f32_16x16x32_bf16 v[236:239], v[84:87], v[60:63], v[236:239]
ds_read_b64_tr_b16 v[78:79], v9 offset:41984
v_mfma_f32_16x16x32_bf16 v[236:239], v[80:83], v[56:59], v[236:239]
v_mfma_f32_16x16x32_bf16 v[252:255], v[88:91], v[56:59], v[252:255]
s_add_u32 s72, s70, 15360
buffer_load_dwordx4 v5, s[4:7], s72 offen offset:1024 lds
v_mfma_f32_16x16x32_bf16 v[252:255], v[92:95], v[60:63], v[252:255]
ds_read_b64_tr_b16 v[80:81], v10 offset:32768
v_mfma_f32_16x16x32_bf16 v[248:251], v[92:95], v[52:55], v[248:251]
ds_read_b64_tr_b16 v[82:83], v10 offset:33792
v_mfma_f32_16x16x32_bf16 v[248:251], v[88:91], v[48:51], v[248:251]
v_mfma_f32_16x16x32_bf16 v[244:247], v[88:91], v[40:43], v[244:247]
ds_read_b64_tr_b16 v[84:85], v10 offset:40960
v_mfma_f32_16x16x32_bf16 v[244:247], v[92:95], v[44:47], v[244:247]
ds_read_b64_tr_b16 v[86:87], v10 offset:41984
v_mfma_f32_16x16x32_bf16 v[240:243], v[92:95], v[36:39], v[240:243]
s_add_u32 s72, s70, 129024
buffer_load_dwordx4 v4, s[4:7], s72 offen offset:2048 lds
v_mfma_f32_16x16x32_bf16 v[240:243], v[88:91], v[32:35], v[240:243]
s_waitcnt lgkmcnt(5)
v_mfma_f32_16x16x32_bf16 v[128:131], v[64:67], v[96:99], v[128:131]
ds_read_b64_tr_b16 v[88:89], v11 offset:32768
v_mfma_f32_16x16x32_bf16 v[128:131], v[68:71], v[100:103], v[128:131]
ds_read_b64_tr_b16 v[90:91], v11 offset:33792
v_mfma_f32_16x16x32_bf16 v[132:135], v[68:71], v[108:111], v[132:135]
v_mfma_f32_16x16x32_bf16 v[132:135], v[64:67], v[104:107], v[132:135]
s_add_u32 s72, s70, 144384
buffer_load_dwordx4 v5, s[4:7], s72 offen offset:3072 lds
v_mfma_f32_16x16x32_bf16 v[136:139], v[64:67], v[112:115], v[136:139]
ds_read_b64_tr_b16 v[92:93], v11 offset:40960
v_mfma_f32_16x16x32_bf16 v[136:139], v[68:71], v[116:119], v[136:139]
s_lshl_b32 s71, s73, 12
v_mfma_f32_16x16x32_bf16 v[140:143], v[68:71], v[124:127], v[140:143]
s_add_u32 s71, s71, s66
ds_read_b64_tr_b16 v[94:95], v11 offset:41984
v_mfma_f32_16x16x32_bf16 v[140:143], v[64:67], v[120:123], v[140:143]
s_waitcnt lgkmcnt(8)
v_mfma_f32_16x16x32_bf16 v[156:159], v[72:75], v[120:123], v[156:159]
s_add_u32 m0, s64, 16384
ds_read_b64_tr_b16 v[64:65], v12 offset:32768
v_mfma_f32_16x16x32_bf16 v[156:159], v[76:79], v[124:127], v[156:159]
s_add_u32 s72, s71, 0
buffer_load_dwordx4 v6, s[12:15], s72 offen lds
v_mfma_f32_16x16x32_bf16 v[152:155], v[76:79], v[116:119], v[152:155]
s_add_u32 s73, s62, 14
ds_read_b64_tr_b16 v[66:67], v12 offset:33792
v_mfma_f32_16x16x32_bf16 v[152:155], v[72:75], v[112:115], v[152:155]
s_add_u32 s70, s73, s65
v_mfma_f32_16x16x32_bf16 v[148:151], v[72:75], v[104:107], v[148:151]
s_and_b32 s70, s70, 3
ds_read_b64_tr_b16 v[68:69], v12 offset:40960
v_mfma_f32_16x16x32_bf16 v[148:151], v[76:79], v[108:111], v[148:151]
s_and_b32 s73, s73, 12
ds_read_b64_tr_b16 v[70:71], v12 offset:41984
v_mfma_f32_16x16x32_bf16 v[144:147], v[76:79], v[100:103], v[144:147]
s_add_u32 s72, s71, 31744
buffer_load_dwordx4 v6, s[12:15], s72 offen offset:1024 lds
v_mfma_f32_16x16x32_bf16 v[144:147], v[72:75], v[96:99], v[144:147]
s_waitcnt lgkmcnt(8)
v_mfma_f32_16x16x32_bf16 v[160:163], v[80:83], v[96:99], v[160:163]
s_or_b32 s73, s73, s70
ds_read_b64_tr_b16 v[72:73], v13 offset:32768
v_mfma_f32_16x16x32_bf16 v[160:163], v[84:87], v[100:103], v[160:163]
s_lshl_b32 s73, s73, 7
ds_read_b64_tr_b16 v[74:75], v13 offset:33792
v_mfma_f32_16x16x32_bf16 v[164:167], v[84:87], v[108:111], v[164:167]
s_add_u32 s69, s73, s67
v_mfma_f32_16x16x32_bf16 v[164:167], v[80:83], v[104:107], v[164:167]
s_add_u32 s72, s71, 63488
buffer_load_dwordx4 v7, s[12:15], s72 offen offset:2048 lds
v_mfma_f32_16x16x32_bf16 v[168:171], v[80:83], v[112:115], v[168:171]
s_waitcnt vmcnt(16)
ds_read_b64_tr_b16 v[76:77], v13 offset:40960
v_mfma_f32_16x16x32_bf16 v[168:171], v[84:87], v[116:119], v[168:171]
s_add_u32 s70, s73, s68
ds_read_b128 v[32:35], v16 offset:0
v_mfma_f32_16x16x32_bf16 v[172:175], v[84:87], v[124:127], v[172:175]
ds_read_b64_tr_b16 v[78:79], v13 offset:41984
v_mfma_f32_16x16x32_bf16 v[172:175], v[80:83], v[120:123], v[172:175]
s_waitcnt lgkmcnt(9)
ds_read_b128 v[36:39], v17 offset:0
v_mfma_f32_16x16x32_bf16 v[188:191], v[88:91], v[120:123], v[188:191]
s_add_u32 s72, s71, 95232
buffer_load_dwordx4 v7, s[12:15], s72 offen offset:3072 lds
v_mfma_f32_16x16x32_bf16 v[188:191], v[92:95], v[124:127], v[188:191]
ds_read_b64_tr_b16 v[80:81], v14 offset:32768
v_mfma_f32_16x16x32_bf16 v[184:187], v[92:95], v[116:119], v[184:187]
ds_read_b64_tr_b16 v[82:83], v14 offset:33792
v_mfma_f32_16x16x32_bf16 v[184:187], v[88:91], v[112:115], v[184:187]
v_mfma_f32_16x16x32_bf16 v[180:183], v[88:91], v[104:107], v[180:183]
ds_read_b64_tr_b16 v[84:85], v14 offset:40960
v_mfma_f32_16x16x32_bf16 v[180:183], v[92:95], v[108:111], v[180:183]
s_add_u32 m0, s63, 98304
ds_read_b64_tr_b16 v[86:87], v14 offset:41984
v_mfma_f32_16x16x32_bf16 v[176:179], v[92:95], v[100:103], v[176:179]
s_add_u32 s72, s69, 0
buffer_load_dwordx4 v4, s[4:7], s72 offen lds
v_mfma_f32_16x16x32_bf16 v[176:179], v[88:91], v[96:99], v[176:179]
s_waitcnt lgkmcnt(10)
ds_read_b128 v[40:43], v16 offset:2048
v_mfma_f32_16x16x32_bf16 v[192:195], v[64:67], v[96:99], v[192:195]
ds_read_b64_tr_b16 v[88:89], v15 offset:32768
v_mfma_f32_16x16x32_bf16 v[192:195], v[68:71], v[100:103], v[192:195]
ds_read_b64_tr_b16 v[90:91], v15 offset:33792
v_mfma_f32_16x16x32_bf16 v[196:199], v[68:71], v[108:111], v[196:199]
ds_read_b64_tr_b16 v[92:93], v15 offset:40960
v_mfma_f32_16x16x32_bf16 v[196:199], v[64:67], v[104:107], v[196:199]
s_add_u32 s72, s69, 15360
buffer_load_dwordx4 v5, s[4:7], s72 offen offset:1024 lds
v_mfma_f32_16x16x32_bf16 v[200:203], v[64:67], v[112:115], v[200:203]
ds_read_b64_tr_b16 v[94:95], v15 offset:41984
v_mfma_f32_16x16x32_bf16 v[200:203], v[68:71], v[116:119], v[200:203]
ds_read_b128 v[44:47], v17 offset:2048
v_mfma_f32_16x16x32_bf16 v[204:207], v[68:71], v[124:127], v[204:207]
v_mfma_f32_16x16x32_bf16 v[204:207], v[64:67], v[120:123], v[204:207]
s_waitcnt lgkmcnt(11)
ds_read_b128 v[48:51], v16 offset:4096
v_mfma_f32_16x16x32_bf16 v[220:223], v[72:75], v[120:123], v[220:223]
s_add_u32 s72, s69, 129024
buffer_load_dwordx4 v4, s[4:7], s72 offen offset:2048 lds
v_mfma_f32_16x16x32_bf16 v[220:223], v[76:79], v[124:127], v[220:223]
v_mfma_f32_16x16x32_bf16 v[216:219], v[76:79], v[116:119], v[216:219]
s_waitcnt vmcnt(16) lgkmcnt(2)
ds_read_b128 v[52:55], v17 offset:4096
v_mfma_f32_16x16x32_bf16 v[216:219], v[72:75], v[112:115], v[216:219]
s_barrier
ds_read_b128 v[56:59], v16 offset:6144
v_mfma_f32_16x16x32_bf16 v[212:215], v[72:75], v[104:107], v[212:215]
s_waitcnt vmcnt(24)
v_cmp_gt_u32 vcc, 8, v3
s_cbranch_vccnz Lspin1
Lback2:
v_mfma_f32_16x16x32_bf16 v[212:215], v[76:79], v[108:111], v[212:215]
ds_read_b64_tr_b16 v[64:65], v8 offset:0
ds_read_b64_tr_b16 v[66:67], v8 offset:1024
v_mfma_f32_16x16x32_bf16 v[208:211], v[76:79], v[100:103], v[208:211]
s_add_u32 s72, s69, 144384
buffer_load_dwordx4 v5, s[4:7], s72 offen offset:3072 lds
v_mfma_f32_16x16x32_bf16 v[208:211], v[72:75], v[96:99], v[208:211]
ds_read_b64_tr_b16 v[68:69], v8 offset:8192
ds_read_b64_tr_b16 v[70:71], v8 offset:9216
v_mfma_f32_16x16x32_bf16 v[224:227], v[80:83], v[96:99], v[224:227]
ds_read_b64_tr_b16 v[72:73], v9 offset:0
v_mfma_f32_16x16x32_bf16 v[224:227], v[84:87], v[100:103], v[224:227]
ds_read_b64_tr_b16 v[74:75], v9 offset:1024
v_mfma_f32_16x16x32_bf16 v[228:231], v[84:87], v[108:111], v[228:231]
s_add_u32 m0, s63, 102400
v_mfma_f32_16x16x32_bf16 v[228:231], v[80:83], v[104:107], v[228:231]
s_add_u32 s72, s70, 0
buffer_load_dwordx4 v4, s[4:7], s72 offen lds
v_mfma_f32_16x16x32_bf16 v[232:235], v[80:83], v[112:115], v[232:235]
ds_read_b64_tr_b16 v[76:77], v9 offset:8192
v_mfma_f32_16x16x32_bf16 v[232:235], v[84:87], v[116:119], v[232:235]
ds_read_b128 v[60:63], v17 offset:6144
v_mfma_f32_16x16x32_bf16 v[236:239], v[84:87], v[124:127], v[236:239]
ds_read_b64_tr_b16 v[78:79], v9 offset:9216
v_mfma_f32_16x16x32_bf16 v[236:239], v[80:83], v[120:123], v[236:239]
v_mfma_f32_16x16x32_bf16 v[252:255], v[88:91], v[120:123], v[252:255]
s_add_u32 s72, s70, 15360
buffer_load_dwordx4 v5, s[4:7], s72 offen offset:1024 lds
v_mfma_f32_16x16x32_bf16 v[252:255], v[92:95], v[124:127], v[252:255]
ds_read_b64_tr_b16 v[80:81], v10 offset:0
v_mfma_f32_16x16x32_bf16 v[248:251], v[92:95], v[116:119], v[248:251]
ds_read_b64_tr_b16 v[82:83], v10 offset:1024
v_mfma_f32_16x16x32_bf16 v[248:251], v[88:91], v[112:115], v[248:251]
v_mfma_f32_16x16x32_bf16 v[244:247], v[88:91], v[104:107], v[244:247]
ds_read_b64_tr_b16 v[84:85], v10 offset:8192
v_mfma_f32_16x16x32_bf16 v[244:247], v[92:95], v[108:111], v[244:247]
ds_read_b64_tr_b16 v[86:87], v10 offset:9216
v_mfma_f32_16x16x32_bf16 v[240:243], v[92:95], v[100:103], v[240:243]
s_add_u32 s72, s70, 129024
buffer_load_dwordx4 v4, s[4:7], s72 offen offset:2048 lds
v_mfma_f32_16x16x32_bf16 v[240:243], v[88:91], v[96:99], v[240:243]
s_waitcnt lgkmcnt(5)
v_mfma_f32_16x16x32_bf16 v[128:131], v[64:67], v[32:35], v[128:131]
ds_read_b64_tr_b16 v[88:89], v11 offset:0
v_mfma_f32_16x16x32_bf16 v[128:131], v[68:71], v[36:39], v[128:131]
ds_read_b64_tr_b16 v[90:91], v11 offset:1024
v_mfma_f32_16x16x32_bf16 v[132:135], v[68:71], v[44:47], v[132:135]
v_mfma_f32_16x16x32_bf16 v[132:135], v[64:67], v[40:43], v[132:135]
s_add_u32 s72, s70, 144384
buffer_load_dwordx4 v5, s[4:7], s72 offen offset:3072 lds
v_mfma_f32_16x16x32_bf16 v[136:139], v[64:67], v[48:51], v[136:139]
ds_read_b64_tr_b16 v[92:93], v11 offset:8192
v_mfma_f32_16x16x32_bf16 v[136:139], v[68:71], v[52:55], v[136:139]
s_lshl_b32 s71, s73, 12
v_mfma_f32_16x16x32_bf16 v[140:143], v[68:71], v[60:63], v[140:143]
s_add_u32 s71, s71, s66
ds_read_b64_tr_b16 v[94:95], v11 offset:9216
v_mfma_f32_16x16x32_bf16 v[140:143], v[64:67], v[56:59], v[140:143]
s_waitcnt lgkmcnt(8)
v_mfma_f32_16x16x32_bf16 v[156:159], v[72:75], v[56:59], v[156:159]
s_add_u32 m0, s64, 32768
ds_read_b64_tr_b16 v[64:65], v12 offset:0
v_mfma_f32_16x16x32_bf16 v[156:159], v[76:79], v[60:63], v[156:159]
s_add_u32 s72, s71, 0
buffer_load_dwordx4 v6, s[12:15], s72 offen lds
v_mfma_f32_16x16x32_bf16 v[152:155], v[76:79], v[52:55], v[152:155]
s_add_u32 s73, s62, 15
ds_read_b64_tr_b16 v[66:67], v12 offset:1024
v_mfma_f32_16x16x32_bf16 v[152:155], v[72:75], v[48:51], v[152:155]
s_add_u32 s70, s73, s65
v_mfma_f32_16x16x32_bf16 v[148:151], v[72:75], v[40:43], v[148:151]
s_and_b32 s70, s70, 3
ds_read_b64_tr_b16 v[68:69], v12 offset:8192
v_mfma_f32_16x16x32_bf16 v[148:151], v[76:79], v[44:47], v[148:151]
s_and_b32 s73, s73, 12
ds_read_b64_tr_b16 v[70:71], v12 offset:9216
v_mfma_f32_16x16x32_bf16 v[144:147], v[76:79], v[36:39], v[144:147]
s_add_u32 s72, s71, 31744
buffer_load_dwordx4 v6, s[12:15], s72 offen offset:1024 lds
v_mfma_f32_16x16x32_bf16 v[144:147], v[72:75], v[32:35], v[144:147]
s_waitcnt lgkmcnt(8)
v_mfma_f32_16x16x32_bf16 v[160:163], v[80:83], v[32:35], v[160:163]
s_or_b32 s73, s73, s70
ds_read_b64_tr_b16 v[72:73], v13 offset:0
v_mfma_f32_16x16x32_bf16 v[160:163], v[84:87], v[36:39], v[160:163]
s_lshl_b32 s73, s73, 7
ds_read_b64_tr_b16 v[74:75], v13 offset:1024
v_mfma_f32_16x16x32_bf16 v[164:167], v[84:87], v[44:47], v[164:167]
s_add_u32 s69, s73, s67
v_mfma_f32_16x16x32_bf16 v[164:167], v[80:83], v[40:43], v[164:167]
s_add_u32 s72, s71, 63488
buffer_load_dwordx4 v7, s[12:15], s72 offen offset:2048 lds
v_mfma_f32_16x16x32_bf16 v[168:171], v[80:83], v[48:51], v[168:171]
s_waitcnt vmcnt(15)
ds_read_b64_tr_b16 v[76:77], v13 offset:8192
v_mfma_f32_16x16x32_bf16 v[168:171], v[84:87], v[52:55], v[168:171]
s_add_u32 s70, s73, s68
ds_read_b128 v[96:99], v18 offset:0
v_mfma_f32_16x16x32_bf16 v[172:175], v[84:87], v[60:63], v[172:175]
ds_read_b64_tr_b16 v[78:79], v13 offset:9216
v_mfma_f32_16x16x32_bf16 v[172:175], v[80:83], v[56:59], v[172:175]
s_waitcnt lgkmcnt(9)
ds_read_b128 v[100:103], v19 offset:0
v_mfma_f32_16x16x32_bf16 v[188:191], v[88:91], v[56:59], v[188:191]
s_add_u32 s72, s71, 95232
buffer_load_dwordx4 v7, s[12:15], s72 offen offset:3072 lds
v_mfma_f32_16x16x32_bf16 v[188:191], v[92:95], v[60:63], v[188:191]
ds_read_b64_tr_b16 v[80:81], v14 offset:0
v_mfma_f32_16x16x32_bf16 v[184:187], v[92:95], v[52:55], v[184:187]
ds_read_b64_tr_b16 v[82:83], v14 offset:1024
v_mfma_f32_16x16x32_bf16 v[184:187], v[88:91], v[48:51], v[184:187]
v_mfma_f32_16x16x32_bf16 v[180:183], v[88:91], v[40:43], v[180:183]
ds_read_b64_tr_b16 v[84:85], v14 offset:8192
v_mfma_f32_16x16x32_bf16 v[180:183], v[92:95], v[44:47], v[180:183]
s_add_u32 m0, s63, 131072
ds_read_b64_tr_b16 v[86:87], v14 offset:9216
v_mfma_f32_16x16x32_bf16 v[176:179], v[92:95], v[36:39], v[176:179]
s_add_u32 s72, s69, 0
buffer_load_dwordx4 v4, s[4:7], s72 offen lds
v_mfma_f32_16x16x32_bf16 v[176:179], v[88:91], v[32:35], v[176:179]
s_waitcnt lgkmcnt(10)
ds_read_b128 v[104:107], v18 offset:2048
v_mfma_f32_16x16x32_bf16 v[192:195], v[64:67], v[32:35], v[192:195]
ds_read_b64_tr_b16 v[88:89], v15 offset:0
ds_read_b64_tr_b16 v[90:91], v15 offset:1024
v_mfma_f32_16x16x32_bf16 v[192:195], v[68:71], v[36:39], v[192:195]
ds_read_b64_tr_b16 v[92:93], v15 offset:8192
v_mfma_f32_16x16x32_bf16 v[196:199], v[68:71], v[44:47], v[196:199]
s_and_b32 s75, s91, 0xfffffc7f
v_lshrrev_b32 v2, 3, v0
v_lshlrev_b32 v2, 7, v2
v_mfma_f32_16x16x32_bf16 v[196:199], v[64:67], v[40:43], v[196:199]
s_add_u32 s72, s69, 15360
buffer_load_dwordx4 v5, s[4:7], s72 offen offset:1024 lds
v_mfma_f32_16x16x32_bf16 v[200:203], v[64:67], v[48:51], v[200:203]
buffer_load_dword v3, v2, s[44:47], s75 offen sc1
v_mfma_f32_16x16x32_bf16 v[200:203], v[68:71], v[52:55], v[200:203]
ds_read_b64_tr_b16 v[94:95], v15 offset:9216
v_mfma_f32_16x16x32_bf16 v[204:207], v[68:71], v[60:63], v[204:207]
ds_read_b128 v[108:111], v19 offset:2048
v_mfma_f32_16x16x32_bf16 v[204:207], v[64:67], v[56:59], v[204:207]
s_waitcnt lgkmcnt(11)
v_mfma_f32_16x16x32_bf16 v[220:223], v[72:75], v[56:59], v[220:223]
s_add_u32 s72, s69, 129024
buffer_load_dwordx4 v4, s[4:7], s72 offen offset:2048 lds
v_mfma_f32_16x16x32_bf16 v[220:223], v[76:79], v[60:63], v[220:223]
ds_read_b128 v[112:115], v18 offset:4096
v_mfma_f32_16x16x32_bf16 v[216:219], v[76:79], v[52:55], v[216:219]
s_waitcnt vmcnt(16) lgkmcnt(2)
ds_read_b128 v[116:119], v19 offset:4096
v_mfma_f32_16x16x32_bf16 v[216:219], v[72:75], v[48:51], v[216:219]
s_barrier
v_mfma_f32_16x16x32_bf16 v[212:215], v[72:75], v[40:43], v[212:215]
ds_read_b64_tr_b16 v[64:65], v8 offset:16384
ds_read_b64_tr_b16 v[66:67], v8 offset:17408
v_mfma_f32_16x16x32_bf16 v[212:215], v[76:79], v[44:47], v[212:215]
ds_read_b64_tr_b16 v[68:69], v8 offset:24576
v_mfma_f32_16x16x32_bf16 v[208:211], v[76:79], v[36:39], v[208:211]
s_add_u32 s72, s69, 144384
buffer_load_dwordx4 v5, s[4:7], s72 offen offset:3072 lds
v_mfma_f32_16x16x32_bf16 v[208:211], v[72:75], v[32:35], v[208:211]
ds_read_b64_tr_b16 v[70:71], v8 offset:25600
v_mfma_f32_16x16x32_bf16 v[224:227], v[80:83], v[32:35], v[224:227]
ds_read_b64_tr_b16 v[72:73], v9 offset:16384
v_mfma_f32_16x16x32_bf16 v[224:227], v[84:87], v[36:39], v[224:227]
ds_read_b64_tr_b16 v[74:75], v9 offset:17408
v_mfma_f32_16x16x32_bf16 v[228:231], v[84:87], v[44:47], v[228:231]
s_add_u32 m0, s63, 135168
ds_read_b128 v[120:123], v18 offset:6144
v_mfma_f32_16x16x32_bf16 v[228:231], v[80:83], v[40:43], v[228:231]
s_add_u32 s72, s70, 0
buffer_load_dwordx4 v4, s[4:7], s72 offen lds
v_mfma_f32_16x16x32_bf16 v[232:235], v[80:83], v[48:51], v[232:235]
ds_read_b64_tr_b16 v[76:77], v9 offset:24576
v_mfma_f32_16x16x32_bf16 v[232:235], v[84:87], v[52:55], v[232:235]
ds_read_b128 v[124:127], v19 offset:6144
v_mfma_f32_16x16x32_bf16 v[236:239], v[84:87], v[60:63], v[236:239]
ds_read_b64_tr_b16 v[78:79], v9 offset:25600
v_mfma_f32_16x16x32_bf16 v[236:239], v[80:83], v[56:59], v[236:239]
v_mfma_f32_16x16x32_bf16 v[252:255], v[88:91], v[56:59], v[252:255]
s_add_u32 s72, s70, 15360
buffer_load_dwordx4 v5, s[4:7], s72 offen offset:1024 lds
v_mfma_f32_16x16x32_bf16 v[252:255], v[92:95], v[60:63], v[252:255]
ds_read_b64_tr_b16 v[80:81], v10 offset:16384
v_mfma_f32_16x16x32_bf16 v[248:251], v[92:95], v[52:55], v[248:251]
ds_read_b64_tr_b16 v[82:83], v10 offset:17408
v_mfma_f32_16x16x32_bf16 v[248:251], v[88:91], v[48:51], v[248:251]
v_mfma_f32_16x16x32_bf16 v[244:247], v[88:91], v[40:43], v[244:247]
ds_read_b64_tr_b16 v[84:85], v10 offset:24576
v_mfma_f32_16x16x32_bf16 v[244:247], v[92:95], v[44:47], v[244:247]
ds_read_b64_tr_b16 v[86:87], v10 offset:25600
v_mfma_f32_16x16x32_bf16 v[240:243], v[92:95], v[36:39], v[240:243]
s_add_u32 s72, s70, 129024
buffer_load_dwordx4 v4, s[4:7], s72 offen offset:2048 lds
v_mfma_f32_16x16x32_bf16 v[240:243], v[88:91], v[32:35], v[240:243]
s_waitcnt lgkmcnt(5)
v_mfma_f32_16x16x32_bf16 v[128:131], v[64:67], v[96:99], v[128:131]
ds_read_b64_tr_b16 v[88:89], v11 offset:16384
v_mfma_f32_16x16x32_bf16 v[128:131], v[68:71], v[100:103], v[128:131]
ds_read_b64_tr_b16 v[90:91], v11 offset:17408
v_mfma_f32_16x16x32_bf16 v[132:135], v[68:71], v[108:111], v[132:135]
v_mfma_f32_16x16x32_bf16 v[132:135], v[64:67], v[104:107], v[132:135]
s_add_u32 s72, s70, 144384
buffer_load_dwordx4 v5, s[4:7], s72 offen offset:3072 lds
v_mfma_f32_16x16x32_bf16 v[136:139], v[64:67], v[112:115], v[136:139]
ds_read_b64_tr_b16 v[92:93], v11 offset:24576
v_mfma_f32_16x16x32_bf16 v[136:139], v[68:71], v[116:119], v[136:139]
s_lshl_b32 s71, s73, 12
v_mfma_f32_16x16x32_bf16 v[140:143], v[68:71], v[124:127], v[140:143]
s_add_u32 s71, s71, s66
ds_read_b64_tr_b16 v[94:95], v11 offset:25600
v_mfma_f32_16x16x32_bf16 v[140:143], v[64:67], v[120:123], v[140:143]
s_waitcnt lgkmcnt(8)
v_mfma_f32_16x16x32_bf16 v[156:159], v[72:75], v[120:123], v[156:159]
s_add_u32 m0, s64, 0
ds_read_b64_tr_b16 v[64:65], v12 offset:16384
v_mfma_f32_16x16x32_bf16 v[156:159], v[76:79], v[124:127], v[156:159]
s_add_u32 s72, s71, 0
buffer_load_dwordx4 v6, s[12:15], s72 offen lds
v_mfma_f32_16x16x32_bf16 v[152:155], v[76:79], v[116:119], v[152:155]
ds_read_b64_tr_b16 v[66:67], v12 offset:17408
v_mfma_f32_16x16x32_bf16 v[152:155], v[72:75], v[112:115], v[152:155]
v_mfma_f32_16x16x32_bf16 v[148:151], v[72:75], v[104:107], v[148:151]
ds_read_b64_tr_b16 v[68:69], v12 offset:24576
v_mfma_f32_16x16x32_bf16 v[148:151], v[76:79], v[108:111], v[148:151]
ds_read_b64_tr_b16 v[70:71], v12 offset:25600
v_mfma_f32_16x16x32_bf16 v[144:147], v[76:79], v[100:103], v[144:147]
s_add_u32 s72, s71, 31744
buffer_load_dwordx4 v6, s[12:15], s72 offen offset:1024 lds
v_mfma_f32_16x16x32_bf16 v[144:147], v[72:75], v[96:99], v[144:147]
s_waitcnt lgkmcnt(8)
v_mfma_f32_16x16x32_bf16 v[160:163], v[80:83], v[96:99], v[160:163]
ds_read_b64_tr_b16 v[72:73], v13 offset:16384
v_mfma_f32_16x16x32_bf16 v[160:163], v[84:87], v[100:103], v[160:163]
ds_read_b64_tr_b16 v[74:75], v13 offset:17408
v_mfma_f32_16x16x32_bf16 v[164:167], v[84:87], v[108:111], v[164:167]
v_mfma_f32_16x16x32_bf16 v[164:167], v[80:83], v[104:107], v[164:167]
s_add_u32 s72, s71, 63488
buffer_load_dwordx4 v7, s[12:15], s72 offen offset:2048 lds
v_mfma_f32_16x16x32_bf16 v[168:171], v[80:83], v[112:115], v[168:171]
s_waitcnt vmcnt(16)
ds_read_b64_tr_b16 v[76:77], v13 offset:24576
v_mfma_f32_16x16x32_bf16 v[168:171], v[84:87], v[116:119], v[168:171]
ds_read_b128 v[32:35], v18 offset:32768
v_mfma_f32_16x16x32_bf16 v[172:175], v[84:87], v[124:127], v[172:175]
ds_read_b64_tr_b16 v[78:79], v13 offset:25600
v_mfma_f32_16x16x32_bf16 v[172:175], v[80:83], v[120:123], v[172:175]
s_waitcnt lgkmcnt(9)
ds_read_b128 v[36:39], v19 offset:32768
v_mfma_f32_16x16x32_bf16 v[188:191], v[88:91], v[120:123], v[188:191]
s_add_u32 s72, s71, 95232
buffer_load_dwordx4 v7, s[12:15], s72 offen offset:3072 lds
v_mfma_f32_16x16x32_bf16 v[188:191], v[92:95], v[124:127], v[188:191]
v_accvgpr_write_b32 a0, -1
v_accvgpr_write_b32 a1, -1
v_mfma_f32_16x16x32_bf16 v[184:187], v[92:95], v[116:119], v[184:187]
v_accvgpr_write_b32 a2, -1
v_accvgpr_write_b32 a3, -1
v_mfma_f32_16x16x32_bf16 v[184:187], v[88:91], v[112:115], v[184:187]
s_add_u32 s80, s93, 0x3a00000
ds_read_b64_tr_b16 v[80:81], v14 offset:16384
v_mfma_f32_16x16x32_bf16 v[180:183], v[88:91], v[104:107], v[180:183]
ds_read_b64_tr_b16 v[82:83], v14 offset:17408
v_mfma_f32_16x16x32_bf16 v[180:183], v[92:95], v[108:111], v[180:183]
ds_read_b64_tr_b16 v[84:85], v14 offset:24576
v_mfma_f32_16x16x32_bf16 v[176:179], v[92:95], v[100:103], v[176:179]
ds_read_b64_tr_b16 v[86:87], v14 offset:25600
v_mfma_f32_16x16x32_bf16 v[176:179], v[88:91], v[96:99], v[176:179]
s_waitcnt lgkmcnt(10)
ds_read_b128 v[40:43], v18 offset:34816
v_mfma_f32_16x16x32_bf16 v[192:195], v[64:67], v[96:99], v[192:195]
s_waitcnt vmcnt(10)
v_cmp_gt_u32 vcc, 1, v3
s_cbranch_vccnz Lspin4
Lback5:
v_mfma_f32_16x16x32_bf16 v[192:195], v[68:71], v[100:103], v[192:195]
s_add_u32 m0, s64, 49152
ds_read_b64_tr_b16 v[88:89], v15 offset:16384
ds_read_b64_tr_b16 v[90:91], v15 offset:17408
v_mfma_f32_16x16x32_bf16 v[196:199], v[68:71], v[108:111], v[196:199]
s_add_u32 s72, s81, 16384
buffer_load_dwordx4 v1, s[44:47], s72 offen sc1 lds
v_mfma_f32_16x16x32_bf16 v[196:199], v[64:67], v[104:107], v[196:199]
ds_read_b64_tr_b16 v[92:93], v15 offset:24576
v_mfma_f32_16x16x32_bf16 v[200:203], v[64:67], v[112:115], v[200:203]
ds_read_b64_tr_b16 v[94:95], v15 offset:25600
v_mfma_f32_16x16x32_bf16 v[200:203], v[68:71], v[116:119], v[200:203]
buffer_load_dwordx4 v1, s[44:47], s72 offen offset:1024 sc1 lds
v_mfma_f32_16x16x32_bf16 v[204:207], v[68:71], v[124:127], v[204:207]
ds_read_b128 v[44:47], v19 offset:34816
v_mfma_f32_16x16x32_bf16 v[204:207], v[64:67], v[120:123], v[204:207]
s_waitcnt lgkmcnt(11)
v_mfma_f32_16x16x32_bf16 v[220:223], v[72:75], v[120:123], v[220:223]
ds_read_b128 v[48:51], v18 offset:36864
v_mfma_f32_16x16x32_bf16 v[220:223], v[76:79], v[124:127], v[220:223]
ds_read_b128 v[52:55], v19 offset:36864
v_mfma_f32_16x16x32_bf16 v[216:219], v[76:79], v[116:119], v[216:219]
s_waitcnt vmcnt(15) lgkmcnt(3)
buffer_load_dwordx4 v1, s[44:47], s72 offen offset:2048 sc1 lds
v_mfma_f32_16x16x32_bf16 v[216:219], v[72:75], v[112:115], v[216:219]
s_barrier
ds_read_b128 v[56:59], v18 offset:38912
v_mfma_f32_16x16x32_bf16 v[212:215], v[72:75], v[104:107], v[212:215]
ds_read_b64_tr_b16 v[64:65], v8 offset:32768
ds_read_b64_tr_b16 v[66:67], v8 offset:33792
v_mfma_f32_16x16x32_bf16 v[212:215], v[76:79], v[108:111], v[212:215]
ds_read_b64_tr_b16 v[68:69], v8 offset:40960
v_mfma_f32_16x16x32_bf16 v[208:211], v[76:79], v[100:103], v[208:211]
ds_read_b64_tr_b16 v[70:71], v8 offset:41984
v_mfma_f32_16x16x32_bf16 v[208:211], v[72:75], v[96:99], v[208:211]
buffer_load_dwordx4 v1, s[44:47], s72 offen offset:3072 sc1 lds
v_mfma_f32_16x16x32_bf16 v[224:227], v[80:83], v[96:99], v[224:227]
s_add_u32 s81, s81, 0x8000
ds_read_b64_tr_b16 v[72:73], v9 offset:32768
v_mfma_f32_16x16x32_bf16 v[224:227], v[84:87], v[100:103], v[224:227]
s_add_u32 m0, s64, 81920
ds_read_b64_tr_b16 v[74:75], v9 offset:33792
v_mfma_f32_16x16x32_bf16 v[228:231], v[84:87], v[108:111], v[228:231]
s_add_u32 s72, s81, 16384
buffer_load_dwordx4 v1, s[44:47], s72 offen sc1 lds
v_mfma_f32_16x16x32_bf16 v[228:231], v[80:83], v[104:107], v[228:231]
ds_read_b128 v[60:63], v19 offset:38912
v_mfma_f32_16x16x32_bf16 v[232:235], v[80:83], v[112:115], v[232:235]
buffer_load_dwordx4 v1, s[44:47], s72 offen offset:1024 sc1 lds
v_mfma_f32_16x16x32_bf16 v[232:235], v[84:87], v[116:119], v[232:235]
ds_read_b64_tr_b16 v[76:77], v9 offset:40960
v_mfma_f32_16x16x32_bf16 v[236:239], v[84:87], v[124:127], v[236:239]
ds_read_b64_tr_b16 v[78:79], v9 offset:41984
v_mfma_f32_16x16x32_bf16 v[236:239], v[80:83], v[120:123], v[236:239]
v_mfma_f32_16x16x32_bf16 v[252:255], v[88:91], v[120:123], v[252:255]
ds_read_b64_tr_b16 v[80:81], v10 offset:32768
v_mfma_f32_16x16x32_bf16 v[252:255], v[92:95], v[124:127], v[252:255]
buffer_load_dwordx4 v1, s[44:47], s72 offen offset:2048 sc1 lds
v_mfma_f32_16x16x32_bf16 v[248:251], v[92:95], v[116:119], v[248:251]
ds_read_b64_tr_b16 v[82:83], v10 offset:33792
v_mfma_f32_16x16x32_bf16 v[248:251], v[88:91], v[112:115], v[248:251]
v_mfma_f32_16x16x32_bf16 v[244:247], v[88:91], v[104:107], v[244:247]
ds_read_b64_tr_b16 v[84:85], v10 offset:40960
v_mfma_f32_16x16x32_bf16 v[244:247], v[92:95], v[108:111], v[244:247]
buffer_load_dwordx4 v1, s[44:47], s72 offen offset:3072 sc1 lds
v_mfma_f32_16x16x32_bf16 v[240:243], v[92:95], v[100:103], v[240:243]
ds_read_b64_tr_b16 v[86:87], v10 offset:41984
v_mfma_f32_16x16x32_bf16 v[240:243], v[88:91], v[96:99], v[240:243]
s_waitcnt lgkmcnt(6)
v_mfma_f32_16x16x32_bf16 v[128:131], v[64:67], v[32:35], v[128:131]
ds_read_b64_tr_b16 v[88:89], v11 offset:32768
v_mfma_f32_16x16x32_bf16 v[128:131], v[68:71], v[36:39], v[128:131]
ds_read_b64_tr_b16 v[90:91], v11 offset:33792
v_mfma_f32_16x16x32_bf16 v[132:135], v[68:71], v[44:47], v[132:135]
s_add_u32 m0, s64, 65536
v_mfma_f32_16x16x32_bf16 v[132:135], v[64:67], v[40:43], v[132:135]
s_add_u32 s72, s81, 0
buffer_load_dwordx4 v1, s[44:47], s72 offen sc1 lds
v_mfma_f32_16x16x32_bf16 v[136:139], v[64:67], v[48:51], v[136:139]
ds_read_b64_tr_b16 v[92:93], v11 offset:40960
v_mfma_f32_16x16x32_bf16 v[136:139], v[68:71], v[52:55], v[136:139]
ds_read_b64_tr_b16 v[94:95], v11 offset:41984
v_mfma_f32_16x16x32_bf16 v[140:143], v[68:71], v[60:63], v[140:143]
v_mfma_f32_16x16x32_bf16 v[140:143], v[64:67], v[56:59], v[140:143]
s_waitcnt lgkmcnt(8)
buffer_load_dwordx4 v1, s[44:47], s72 offen offset:1024 sc1 lds
v_mfma_f32_16x16x32_bf16 v[156:159], v[72:75], v[56:59], v[156:159]
ds_read_b64_tr_b16 v[64:65], v12 offset:32768
v_mfma_f32_16x16x32_bf16 v[156:159], v[76:79], v[60:63], v[156:159]
ds_read_b64_tr_b16 v[66:67], v12 offset:33792
v_mfma_f32_16x16x32_bf16 v[152:155], v[76:79], v[52:55], v[152:155]
v_mfma_f32_16x16x32_bf16 v[152:155], v[72:75], v[48:51], v[152:155]
buffer_load_dwordx4 v1, s[44:47], s72 offen offset:2048 sc1 lds
v_mfma_f32_16x16x32_bf16 v[148:151], v[72:75], v[40:43], v[148:151]
ds_read_b64_tr_b16 v[68:69], v12 offset:40960
v_mfma_f32_16x16x32_bf16 v[148:151], v[76:79], v[44:47], v[148:151]
v_mfma_f32_16x16x32_bf16 v[144:147], v[76:79], v[36:39], v[144:147]
ds_read_b64_tr_b16 v[70:71], v12 offset:41984
v_mfma_f32_16x16x32_bf16 v[144:147], v[72:75], v[32:35], v[144:147]
s_waitcnt lgkmcnt(8)
v_mfma_f32_16x16x32_bf16 v[160:163], v[80:83], v[32:35], v[160:163]
buffer_load_dwordx4 v1, s[44:47], s72 offen offset:3072 sc1 lds
v_mfma_f32_16x16x32_bf16 v[160:163], v[84:87], v[36:39], v[160:163]
ds_read_b64_tr_b16 v[72:73], v13 offset:32768
v_mfma_f32_16x16x32_bf16 v[164:167], v[84:87], v[44:47], v[164:167]
ds_read_b64_tr_b16 v[74:75], v13 offset:33792
v_mfma_f32_16x16x32_bf16 v[164:167], v[80:83], v[40:43], v[164:167]
v_mfma_f32_16x16x32_bf16 v[168:171], v[80:83], v[48:51], v[168:171]
s_waitcnt vmcnt(16)
ds_read_b64_tr_b16 v[76:77], v13 offset:40960
v_mfma_f32_16x16x32_bf16 v[168:171], v[84:87], v[52:55], v[168:171]
ds_read_b128 v[96:99], v16 offset:0
v_mfma_f32_16x16x32_bf16 v[172:175], v[84:87], v[60:63], v[172:175]
ds_read_b64_tr_b16 v[78:79], v13 offset:41984
v_mfma_f32_16x16x32_bf16 v[172:175], v[80:83], v[56:59], v[172:175]
s_waitcnt lgkmcnt(9)
v_mfma_f32_16x16x32_bf16 v[188:191], v[88:91], v[56:59], v[188:191]
ds_read_b64_tr_b16 v[80:81], v14 offset:32768
v_mfma_f32_16x16x32_bf16 v[188:191], v[92:95], v[60:63], v[188:191]
ds_read_b128 v[100:103], v17 offset:0
v_mfma_f32_16x16x32_bf16 v[184:187], v[92:95], v[52:55], v[184:187]
ds_read_b64_tr_b16 v[82:83], v14 offset:33792
v_mfma_f32_16x16x32_bf16 v[184:187], v[88:91], v[48:51], v[184:187]
v_mfma_f32_16x16x32_bf16 v[180:183], v[88:91], v[40:43], v[180:183]
ds_read_b64_tr_b16 v[84:85], v14 offset:40960
v_mfma_f32_16x16x32_bf16 v[180:183], v[92:95], v[44:47], v[180:183]
ds_read_b128 v[104:107], v16 offset:2048
v_mfma_f32_16x16x32_bf16 v[176:179], v[92:95], v[36:39], v[176:179]
ds_read_b64_tr_b16 v[86:87], v14 offset:41984
v_mfma_f32_16x16x32_bf16 v[176:179], v[88:91], v[32:35], v[176:179]
s_waitcnt lgkmcnt(11)
v_mfma_f32_16x16x32_bf16 v[192:195], v[64:67], v[32:35], v[192:195]
ds_read_b64_tr_b16 v[88:89], v15 offset:32768
v_mfma_f32_16x16x32_bf16 v[192:195], v[68:71], v[36:39], v[192:195]
ds_read_b64_tr_b16 v[90:91], v15 offset:33792
v_mfma_f32_16x16x32_bf16 v[196:199], v[68:71], v[44:47], v[196:199]
ds_read_b128 v[108:111], v17 offset:2048
v_mfma_f32_16x16x32_bf16 v[196:199], v[64:67], v[40:43], v[196:199]
ds_read_b64_tr_b16 v[92:93], v15 offset:40960
v_mfma_f32_16x16x32_bf16 v[200:203], v[64:67], v[48:51], v[200:203]
ds_read_b64_tr_b16 v[94:95], v15 offset:41984
v_mfma_f32_16x16x32_bf16 v[200:203], v[68:71], v[52:55], v[200:203]
v_mfma_f32_16x16x32_bf16 v[204:207], v[68:71], v[60:63], v[204:207]
ds_read_b128 v[112:115], v16 offset:4096
v_mfma_f32_16x16x32_bf16 v[204:207], v[64:67], v[56:59], v[204:207]
s_waitcnt lgkmcnt(12)
v_mfma_f32_16x16x32_bf16 v[220:223], v[72:75], v[56:59], v[220:223]
ds_read_b128 v[116:119], v17 offset:4096
v_mfma_f32_16x16x32_bf16 v[220:223], v[76:79], v[60:63], v[220:223]
v_mfma_f32_16x16x32_bf16 v[216:219], v[76:79], v[52:55], v[216:219]
s_waitcnt vmcnt(12) lgkmcnt(2)
ds_read_b128 v[120:123], v16 offset:6144
v_mfma_f32_16x16x32_bf16 v[216:219], v[72:75], v[48:51], v[216:219]
s_barrier
v_mfma_f32_16x16x32_bf16 v[212:215], v[72:75], v[40:43], v[212:215]
s_add_u32 s81, s81, 0x8000
ds_read_b64_tr_b16 v[64:65], v8 offset:0
ds_read_b64_tr_b16 v[66:67], v8 offset:1024
v_mfma_f32_16x16x32_bf16 v[212:215], v[76:79], v[44:47], v[212:215]
s_add_u32 m0, s64, 114688
ds_read_b64_tr_b16 v[68:69], v8 offset:8192
v_mfma_f32_16x16x32_bf16 v[208:211], v[76:79], v[36:39], v[208:211]
s_add_u32 s72, s81, 16384
buffer_load_dwordx4 v1, s[44:47], s72 offen sc1 lds
v_mfma_f32_16x16x32_bf16 v[208:211], v[72:75], v[32:35], v[208:211]
ds_read_b64_tr_b16 v[70:71], v8 offset:9216
v_mfma_f32_16x16x32_bf16 v[224:227], v[80:83], v[32:35], v[224:227]
buffer_load_dwordx4 v1, s[44:47], s72 offen offset:1024 sc1 lds
v_mfma_f32_16x16x32_bf16 v[224:227], v[84:87], v[36:39], v[224:227]
ds_read_b64_tr_b16 v[72:73], v9 offset:0
v_mfma_f32_16x16x32_bf16 v[228:231], v[84:87], v[44:47], v[228:231]
ds_read_b64_tr_b16 v[74:75], v9 offset:1024
v_mfma_f32_16x16x32_bf16 v[228:231], v[80:83], v[40:43], v[228:231]
ds_read_b128 v[124:127], v17 offset:6144
v_mfma_f32_16x16x32_bf16 v[232:235], v[80:83], v[48:51], v[232:235]
ds_read_b64_tr_b16 v[76:77], v9 offset:8192
v_mfma_f32_16x16x32_bf16 v[232:235], v[84:87], v[52:55], v[232:235]
buffer_store_dwordx4 a[0:3], v1, s[44:47], s80 offen sc1
v_mfma_f32_16x16x32_bf16 v[236:239], v[84:87], v[60:63], v[236:239]
ds_read_b64_tr_b16 v[78:79], v9 offset:9216
v_mfma_f32_16x16x32_bf16 v[236:239], v[80:83], v[56:59], v[236:239]
v_mfma_f32_16x16x32_bf16 v[252:255], v[88:91], v[56:59], v[252:255]
ds_read_b64_tr_b16 v[80:81], v10 offset:0
v_mfma_f32_16x16x32_bf16 v[252:255], v[92:95], v[60:63], v[252:255]
ds_read_b64_tr_b16 v[82:83], v10 offset:1024
v_mfma_f32_16x16x32_bf16 v[248:251], v[92:95], v[52:55], v[248:251]
buffer_load_dwordx4 v1, s[44:47], s72 offen offset:2048 sc1 lds
v_mfma_f32_16x16x32_bf16 v[248:251], v[88:91], v[48:51], v[248:251]
v_mfma_f32_16x16x32_bf16 v[244:247], v[88:91], v[40:43], v[244:247]
ds_read_b64_tr_b16 v[84:85], v10 offset:8192
v_mfma_f32_16x16x32_bf16 v[244:247], v[92:95], v[44:47], v[244:247]
ds_read_b64_tr_b16 v[86:87], v10 offset:9216
v_mfma_f32_16x16x32_bf16 v[240:243], v[92:95], v[36:39], v[240:243]
buffer_load_dwordx4 v1, s[44:47], s72 offen offset:3072 sc1 lds
v_mfma_f32_16x16x32_bf16 v[240:243], v[88:91], v[32:35], v[240:243]
s_waitcnt lgkmcnt(6)
v_mfma_f32_16x16x32_bf16 v[128:131], v[64:67], v[96:99], v[128:131]
ds_read_b64_tr_b16 v[88:89], v11 offset:0
v_mfma_f32_16x16x32_bf16 v[128:131], v[68:71], v[100:103], v[128:131]
ds_read_b64_tr_b16 v[90:91], v11 offset:1024
v_mfma_f32_16x16x32_bf16 v[132:135], v[68:71], v[108:111], v[132:135]
v_mfma_f32_16x16x32_bf16 v[132:135], v[64:67], v[104:107], v[132:135]
buffer_store_dwordx4 a[0:3], v1, s[44:47], s80 offen offset:1024 sc1
v_mfma_f32_16x16x32_bf16 v[136:139], v[64:67], v[112:115], v[136:139]
ds_read_b64_tr_b16 v[92:93], v11 offset:8192
v_mfma_f32_16x16x32_bf16 v[136:139], v[68:71], v[116:119], v[136:139]
v_mfma_f32_16x16x32_bf16 v[140:143], v[68:71], v[124:127], v[140:143]
ds_read_b64_tr_b16 v[94:95], v11 offset:9216
v_mfma_f32_16x16x32_bf16 v[140:143], v[64:67], v[120:123], v[140:143]
s_waitcnt lgkmcnt(8)
v_mfma_f32_16x16x32_bf16 v[156:159], v[72:75], v[120:123], v[156:159]
s_add_u32 m0, s64, 98304
ds_read_b64_tr_b16 v[64:65], v12 offset:0
v_mfma_f32_16x16x32_bf16 v[156:159], v[76:79], v[124:127], v[156:159]
s_add_u32 s72, s81, 0
buffer_load_dwordx4 v1, s[44:47], s72 offen sc1 lds
v_mfma_f32_16x16x32_bf16 v[152:155], v[76:79], v[116:119], v[152:155]
ds_read_b64_tr_b16 v[66:67], v12 offset:1024
v_mfma_f32_16x16x32_bf16 v[152:155], v[72:75], v[112:115], v[152:155]
v_mfma_f32_16x16x32_bf16 v[148:151], v[72:75], v[104:107], v[148:151]
buffer_load_dwordx4 v1, s[44:47], s72 offen offset:1024 sc1 lds
v_mfma_f32_16x16x32_bf16 v[148:151], v[76:79], v[108:111], v[148:151]
ds_read_b64_tr_b16 v[68:69], v12 offset:8192
v_mfma_f32_16x16x32_bf16 v[144:147], v[76:79], v[100:103], v[144:147]
ds_read_b64_tr_b16 v[70:71], v12 offset:9216
v_mfma_f32_16x16x32_bf16 v[144:147], v[72:75], v[96:99], v[144:147]
s_waitcnt lgkmcnt(8)
v_mfma_f32_16x16x32_bf16 v[160:163], v[80:83], v[96:99], v[160:163]
ds_read_b64_tr_b16 v[72:73], v13 offset:0
v_mfma_f32_16x16x32_bf16 v[160:163], v[84:87], v[100:103], v[160:163]
buffer_store_dwordx4 a[0:3], v1, s[44:47], s80 offen offset:2048 sc1
v_mfma_f32_16x16x32_bf16 v[164:167], v[84:87], v[108:111], v[164:167]
ds_read_b64_tr_b16 v[74:75], v13 offset:1024
v_mfma_f32_16x16x32_bf16 v[164:167], v[80:83], v[104:107], v[164:167]
v_mfma_f32_16x16x32_bf16 v[168:171], v[80:83], v[112:115], v[168:171]
ds_read_b64_tr_b16 v[76:77], v13 offset:8192
v_cvt_pk_bf16_f32 v48, v136, v137
v_mfma_f32_16x16x32_bf16 v[168:171], v[84:87], v[116:119], v[168:171]
ds_read_b64_tr_b16 v[78:79], v13 offset:9216
v_cvt_pk_bf16_f32 v49, v138, v139
v_mfma_f32_16x16x32_bf16 v[172:175], v[84:87], v[124:127], v[172:175]
buffer_load_dwordx4 v1, s[44:47], s72 offen offset:2048 sc1 lds
v_mfma_f32_16x16x32_bf16 v[172:175], v[80:83], v[120:123], v[172:175]
s_waitcnt lgkmcnt(8)
v_cvt_pk_bf16_f32 v50, v152, v153
v_cvt_pk_bf16_f32 v51, v154, v155
v_mfma_f32_16x16x32_bf16 v[188:191], v[88:91], v[120:123], v[188:191]
v_add_u32 v2, 0x8000, v1
v_cvt_pk_bf16_f32 v32, v132, v133
v_mfma_f32_16x16x32_bf16 v[188:191], v[92:95], v[124:127], v[188:191]
ds_read_b64_tr_b16 v[80:81], v14 offset:0
v_cvt_pk_bf16_f32 v33, v134, v135
v_mfma_f32_16x16x32_bf16 v[184:187], v[92:95], v[116:119], v[184:187]
buffer_load_dwordx4 v1, s[44:47], s72 offen offset:3072 sc1 lds
v_mfma_f32_16x16x32_bf16 v[184:187], v[88:91], v[112:115], v[184:187]
ds_read_b64_tr_b16 v[82:83], v14 offset:1024
v_cvt_pk_bf16_f32 v34, v148, v149
v_mfma_f32_16x16x32_bf16 v[180:183], v[88:91], v[104:107], v[180:183]
ds_read_b64_tr_b16 v[84:85], v14 offset:8192
v_cvt_pk_bf16_f32 v35, v150, v151
v_mfma_f32_16x16x32_bf16 v[180:183], v[92:95], v[108:111], v[180:183]
ds_read_b64_tr_b16 v[86:87], v14 offset:9216
v_cvt_pk_bf16_f32 v16, v128, v129
v_mfma_f32_16x16x32_bf16 v[176:179], v[92:95], v[100:103], v[176:179]
v_cvt_pk_bf16_f32 v17, v130, v131
v_cvt_pk_bf16_f32 v18, v144, v145
v_mfma_f32_16x16x32_bf16 v[176:179], v[88:91], v[96:99], v[176:179]
s_waitcnt lgkmcnt(8)
buffer_store_dwordx4 a[0:3], v1, s[44:47], s80 offen offset:3072 sc1
v_mfma_f32_16x16x32_bf16 v[192:195], v[64:67], v[96:99], v[192:195]
ds_read_b64_tr_b16 v[88:89], v15 offset:0
v_cvt_pk_bf16_f32 v19, v146, v147
v_mfma_f32_16x16x32_bf16 v[192:195], v[68:71], v[100:103], v[192:195]
ds_read_b64_tr_b16 v[90:91], v15 offset:1024
v_mfma_f32_16x16x32_bf16 v[196:199], v[68:71], v[108:111], v[196:199]
ds_read_b64_tr_b16 v[92:93], v15 offset:8192
v_mfma_f32_16x16x32_bf16 v[196:199], v[64:67], v[104:107], v[196:199]
ds_read_b64_tr_b16 v[94:95], v15 offset:9216
v_mfma_f32_16x16x32_bf16 v[200:203], v[64:67], v[112:115], v[200:203]
v_lshrrev_b32 v3, 1, v0
v_lshlrev_b32 v3, 7, v3
v_mfma_f32_16x16x32_bf16 v[200:203], v[68:71], v[116:119], v[200:203]
buffer_load_dword v4, v3, s[36:39], s93 offen
v_mfma_f32_16x16x32_bf16 v[204:207], v[68:71], v[124:127], v[204:207]
v_cvt_pk_bf16_f32 v52, v168, v169
v_cvt_pk_bf16_f32 v53, v170, v171
v_mfma_f32_16x16x32_bf16 v[204:207], v[64:67], v[120:123], v[204:207]
s_waitcnt lgkmcnt(8)
v_cvt_pk_bf16_f32 v54, v184, v185
v_cvt_pk_bf16_f32 v55, v186, v187
v_mfma_f32_16x16x32_bf16 v[220:223], v[72:75], v[120:123], v[220:223]
v_cvt_pk_bf16_f32 v36, v164, v165
v_cvt_pk_bf16_f32 v37, v166, v167
v_mfma_f32_16x16x32_bf16 v[220:223], v[76:79], v[124:127], v[220:223]
v_cvt_pk_bf16_f32 v38, v180, v181
v_cvt_pk_bf16_f32 v39, v182, v183
v_mfma_f32_16x16x32_bf16 v[216:219], v[76:79], v[116:119], v[216:219]
s_waitcnt vmcnt(21) lgkmcnt(0)
v_cvt_pk_bf16_f32 v20, v160, v161
v_cvt_pk_bf16_f32 v21, v162, v163
v_mfma_f32_16x16x32_bf16 v[216:219], v[72:75], v[112:115], v[216:219]
s_barrier
v_cvt_pk_bf16_f32 v22, v176, v177
v_cvt_pk_bf16_f32 v23, v178, v179
v_mfma_f32_16x16x32_bf16 v[212:215], v[72:75], v[104:107], v[212:215]
ds_read_b128 a[128:131], v2 offset:16384
v_cvt_pk_bf16_f32 v64, v140, v141
v_mfma_f32_16x16x32_bf16 v[212:215], v[76:79], v[108:111], v[212:215]
v_cvt_pk_bf16_f32 v65, v142, v143
v_cvt_pk_bf16_f32 v66, v156, v157
v_mfma_f32_16x16x32_bf16 v[208:211], v[76:79], v[100:103], v[208:211]
ds_read_b128 a[132:135], v2 offset:17408
v_cvt_pk_bf16_f32 v67, v158, v159
v_mfma_f32_16x16x32_bf16 v[208:211], v[72:75], v[96:99], v[208:211]
v_cvt_pk_bf16_f32 v68, v172, v173
v_cvt_pk_bf16_f32 v69, v174, v175
v_mfma_f32_16x16x32_bf16 v[224:227], v[80:83], v[96:99], v[224:227]
ds_read_b128 a[136:139], v2 offset:18432
v_cvt_pk_bf16_f32 v70, v188, v189
v_mfma_f32_16x16x32_bf16 v[224:227], v[84:87], v[100:103], v[224:227]
v_cvt_pk_bf16_f32 v71, v190, v191
v_mfma_f32_16x16x32_bf16 v[228:231], v[84:87], v[108:111], v[228:231]
ds_read_b128 a[140:143], v2 offset:19456
v_mfma_f32_16x16x32_bf16 v[228:231], v[80:83], v[104:107], v[228:231]
v_mfma_f32_16x16x32_bf16 v[232:235], v[80:83], v[112:115], v[232:235]
ds_read_b128 a[144:147], v2 offset:20480
v_cvt_pk_bf16_f32 v72, v204, v205
v_mfma_f32_16x16x32_bf16 v[232:235], v[84:87], v[116:119], v[232:235]
v_cvt_pk_bf16_f32 v73, v206, v207
v_cvt_pk_bf16_f32 v74, v220, v221
v_mfma_f32_16x16x32_bf16 v[236:239], v[84:87], v[124:127], v[236:239]
ds_read_b128 a[148:151], v2 offset:21504
v_cvt_pk_bf16_f32 v75, v222, v223
v_mfma_f32_16x16x32_bf16 v[236:239], v[80:83], v[120:123], v[236:239]
v_cvt_pk_bf16_f32 v56, v200, v201
v_cvt_pk_bf16_f32 v57, v202, v203
v_mfma_f32_16x16x32_bf16 v[252:255], v[88:91], v[120:123], v[252:255]
ds_read_b128 a[152:155], v2 offset:22528
v_cvt_pk_bf16_f32 v58, v216, v217
v_mfma_f32_16x16x32_bf16 v[252:255], v[92:95], v[124:127], v[252:255]
v_cvt_pk_bf16_f32 v59, v218, v219
v_cvt_pk_bf16_f32 v40, v196, v197
v_mfma_f32_16x16x32_bf16 v[248:251], v[92:95], v[116:119], v[248:251]
ds_read_b128 a[156:159], v2 offset:23552
v_cvt_pk_bf16_f32 v41, v198, v199
v_mfma_f32_16x16x32_bf16 v[248:251], v[88:91], v[112:115], v[248:251]
v_cvt_pk_bf16_f32 v42, v212, v213
v_cvt_pk_bf16_f32 v43, v214, v215
v_mfma_f32_16x16x32_bf16 v[244:247], v[88:91], v[104:107], v[244:247]
v_cvt_pk_bf16_f32 v24, v192, v193
v_cvt_pk_bf16_f32 v25, v194, v195
v_mfma_f32_16x16x32_bf16 v[244:247], v[92:95], v[108:111], v[244:247]
v_cvt_pk_bf16_f32 v26, v208, v209
v_cvt_pk_bf16_f32 v27, v210, v211
v_mfma_f32_16x16x32_bf16 v[240:243], v[92:95], v[100:103], v[240:243]
v_mfma_f32_16x16x32_bf16 v[240:243], v[88:91], v[96:99], v[240:243]
v_cvt_pk_bf16_f32 v76, v236, v237
v_cvt_pk_bf16_f32 v77, v238, v239
v_cvt_pk_bf16_f32 v78, v252, v253
v_cvt_pk_bf16_f32 v79, v254, v255
v_cvt_pk_bf16_f32 v60, v232, v233
v_cvt_pk_bf16_f32 v61, v234, v235
v_cvt_pk_bf16_f32 v62, v248, v249
v_cvt_pk_bf16_f32 v63, v250, v251
v_cvt_pk_bf16_f32 v44, v228, v229
v_cvt_pk_bf16_f32 v45, v230, v231
v_cvt_pk_bf16_f32 v46, v244, v245
v_cvt_pk_bf16_f32 v47, v246, v247
v_cvt_pk_bf16_f32 v28, v224, v225
v_cvt_pk_bf16_f32 v29, v226, v227
v_cvt_pk_bf16_f32 v30, v240, v241
v_cvt_pk_bf16_f32 v31, v242, v243
v_mov_b32 v124, 0xff800000
v_mov_b32 v125, 0xff800000
v_mov_b32 v126, 0xff800000
v_mov_b32 v127, 0xff800000
s_lshl_b32 s84, s60, 2
s_add_u32 s84, s84, s58
s_mov_b32 s86, 0
s_add_u32 s61, s65, s60
s_and_b32 s73, s60, 1
s_lshl_b32 s73, s73, 16
s_add_u32 s77, s73, s64
s_xor_b32 s73, s73, 0x10000
s_mov_b32 s92, s73
s_mul_i32 s62, s58, 4608
s_add_u32 s62, s62, 143104
s_add_u32 s73, s73, 49920
s_cmp_eq_u32 s58, 0
s_cselect_b32 s62, s73, s62
Lattn:
s_mov_b32 s82, 0x10000
s_waitcnt lgkmcnt(0)
v_mfma_f32_16x16x32_bf16 v[136:139], a[128:131], v[48:51], 0
ds_read_b128 a[160:163], v2 offset:24576
v_lshrrev_b32 v240, 4, v0
v_mfma_f32_16x16x32_bf16 v[136:139], a[132:135], v[52:55], v[136:139]
ds_read_b128 a[164:167], v2 offset:25600
v_and_b32 v241, 15, v0
v_mfma_f32_16x16x32_bf16 v[136:139], a[136:139], v[56:59], v[136:139]
ds_read_b128 a[168:171], v2 offset:26624
v_lshlrev_b32 v240, 2, v240
v_mfma_f32_16x16x32_bf16 v[136:139], a[140:143], v[60:63], v[136:139]
ds_read_b128 a[172:175], v2 offset:27648
v_sub_u32 v240, v241, v240
v_mfma_f32_16x16x32_bf16 v[140:143], a[140:143], v[76:79], 0
ds_read_b128 a[176:179], v2 offset:28672
v_mov_b32 v112, 0xff800000
v_mfma_f32_16x16x32_bf16 v[140:143], a[136:139], v[72:75], v[140:143]
ds_read_b128 a[180:183], v2 offset:29696
v_mov_b32 v113, 0xff800000
v_mfma_f32_16x16x32_bf16 v[140:143], a[132:135], v[68:71], v[140:143]
ds_read_b128 a[184:187], v2 offset:30720
v_mov_b32 v114, 0xff800000
v_mfma_f32_16x16x32_bf16 v[140:143], a[128:131], v[64:67], v[140:143]
ds_read_b128 a[188:191], v2 offset:31744
v_mov_b32 v115, 0xff800000
v_mfma_f32_16x16x32_bf16 v[156:159], a[144:147], v[64:67], 0
v_cmp_gt_i32 vcc, 0, v240
v_mov_b32 v120, 0x3f803f80
v_mfma_f32_16x16x32_bf16 v[156:159], a[148:151], v[68:71], v[156:159]
v_cndmask_b32 v116, 0, v112, vcc
v_cmp_gt_i32 vcc, 1, v240
v_mfma_f32_16x16x32_bf16 v[156:159], a[152:155], v[72:75], v[156:159]
v_mov_b32 v121, 0x3f803f80
v_cndmask_b32 v117, 0, v112, vcc
v_mfma_f32_16x16x32_bf16 v[156:159], a[156:159], v[76:79], v[156:159]
v_cmp_gt_i32 vcc, 2, v240
v_mov_b32 v122, 0x3f803f80
v_mfma_f32_16x16x32_bf16 v[152:155], a[156:159], v[60:63], 0
v_cndmask_b32 v118, 0, v112, vcc
v_cmp_gt_i32 vcc, 3, v240
v_mfma_f32_16x16x32_bf16 v[152:155], a[152:155], v[56:59], v[152:155]
v_mov_b32 v123, 0x3f803f80
v_cndmask_b32 v119, 0, v112, vcc
v_mfma_f32_16x16x32_bf16 v[152:155], a[148:151], v[52:55], v[152:155]
v_mfma_f32_16x16x32_bf16 v[152:155], a[144:147], v[48:51], v[152:155]
s_cmp_eq_u32 s84, 0
s_cbranch_scc1 Lta7
s_cmp_eq_u32 s84, 1
s_cbranch_scc1 Lnt8
v_mfma_f32_16x16x32_bf16 v[128:131], a[128:131], v[16:19], 0
v_mfma_f32_16x16x32_bf16 v[144:147], a[144:147], v[16:19], 0
s_branch Ljoin9
Lta7:
v_mfma_f32_16x16x32_bf16 v[128:131], a[128:131], v[16:19], v[116:119]
v_mfma_f32_16x16x32_bf16 v[144:147], a[144:147], v[16:19], v[112:115]
s_branch Ljoin9
Lnt8:
v_mfma_f32_16x16x32_bf16 v[128:131], a[128:131], v[16:19], 0
v_mfma_f32_16x16x32_bf16 v[144:147], a[144:147], v[16:19], v[116:119]
Ljoin9:
v_mfma_f32_16x16x32_bf16 v[128:131], a[132:135], v[20:23], v[128:131]
v_mfma_f32_16x16x32_bf16 v[128:131], a[136:139], v[24:27], v[128:131]
v_mfma_f32_16x16x32_bf16 v[128:131], a[140:143], v[28:31], v[128:131]
v_max3_f32 v240, v136, v137, v126
v_max3_f32 v242, v140, v141, v127
v_mfma_f32_16x16x32_bf16 v[132:135], a[140:143], v[44:47], 0
v_max3_f32 v240, v240, v138, v139
v_max3_f32 v242, v242, v142, v143
v_mfma_f32_16x16x32_bf16 v[132:135], a[136:139], v[40:43], v[132:135]
v_max3_f32 v240, v240, v152, v153
v_max3_f32 v242, v242, v156, v157
v_mfma_f32_16x16x32_bf16 v[132:135], a[132:135], v[36:39], v[132:135]
v_max3_f32 v240, v240, v154, v155
v_max3_f32 v242, v242, v158, v159
v_mfma_f32_16x16x32_bf16 v[132:135], a[128:131], v[32:35], v[132:135]
v_mov_b32 v241, v240
v_mov_b32 v243, v242
v_mfma_f32_16x16x32_bf16 v[148:151], a[144:147], v[32:35], 0
v_permlane16_swap_b32 v240, v241
v_permlane16_swap_b32 v242, v243
v_mfma_f32_16x16x32_bf16 v[148:151], a[148:151], v[36:39], v[148:151]
v_max_f32 v240, v240, v241
v_max_f32 v242, v242, v243
v_mfma_f32_16x16x32_bf16 v[148:151], a[152:155], v[40:43], v[148:151]
v_mov_b32 v241, v240
v_mov_b32 v243, v242
v_mfma_f32_16x16x32_bf16 v[148:151], a[156:159], v[44:47], v[148:151]
v_permlane32_swap_b32 v240, v241
v_permlane32_swap_b32 v242, v243
v_mfma_f32_16x16x32_bf16 v[144:147], a[156:159], v[28:31], v[144:147]
v_max_f32 v240, v240, v241
v_max_f32 v242, v242, v243
v_mfma_f32_16x16x32_bf16 v[144:147], a[152:155], v[24:27], v[144:147]
v_mfma_f32_16x16x32_bf16 v[144:147], a[148:151], v[20:23], v[144:147]
v_sub_f32 v88, 0, v240
v_sub_f32 v89, 0, v240
v_pk_add_f32 v[90:91], v[88:89], 0
v_pk_add_f32 v[104:105], v[116:117], v[88:89]
v_pk_add_f32 v[106:107], v[118:119], v[88:89]
v_pk_add_f32 v[136:137], v[136:137], v[88:89]
v_pk_add_f32 v[138:139], v[138:139], v[88:89]
v_pk_add_f32 v[152:153], v[152:153], v[88:89]
v_pk_add_f32 v[154:155], v[154:155], v[88:89]
v_sub_f32 v92, 0, v242
v_sub_f32 v93, 0, v242
v_pk_add_f32 v[94:95], v[92:93], 0
v_pk_add_f32 v[108:109], v[116:117], v[92:93]
v_pk_add_f32 v[110:111], v[118:119], v[92:93]
v_pk_add_f32 v[140:141], v[140:141], v[92:93]
v_pk_add_f32 v[142:143], v[142:143], v[92:93]
v_pk_add_f32 v[156:157], v[156:157], v[92:93]
v_pk_add_f32 v[158:159], v[158:159], v[92:93]
v_max3_f32 v240, v128, v129, v124
v_max3_f32 v242, v132, v133, v125
v_max3_f32 v240, v240, v130, v131
v_max3_f32 v242, v242, v134, v135
v_max3_f32 v240, v240, v144, v145
v_max3_f32 v242, v242, v148, v149
v_max3_f32 v240, v240, v146, v147
v_max3_f32 v242, v242, v150, v151
v_mov_b32 v241, v240
v_mov_b32 v243, v242
s_nop 0
v_permlane16_swap_b32 v240, v241
v_permlane16_swap_b32 v242, v243
v_max_f32 v240, v240, v241
v_max_f32 v242, v242, v243
v_mov_b32 v241, v240
v_mov_b32 v243, v242
s_nop 0
v_permlane32_swap_b32 v240, v241
v_permlane32_swap_b32 v242, v243
v_max_f32 v240, v240, v241
v_max_f32 v242, v242, v243
v_sub_f32 v80, 0, v240
v_sub_f32 v81, 0, v240
v_pk_add_f32 v[82:83], v[80:81], 0
v_pk_add_f32 v[96:97], v[116:117], v[80:81]
v_pk_add_f32 v[98:99], v[118:119], v[80:81]
v_pk_add_f32 v[128:129], v[128:129], v[80:81]
v_pk_add_f32 v[130:131], v[130:131], v[80:81]
v_pk_add_f32 v[144:145], v[144:145], v[80:81]
v_pk_add_f32 v[146:147], v[146:147], v[80:81]
v_sub_f32 v84, 0, v242
v_sub_f32 v85, 0, v242
v_pk_add_f32 v[86:87], v[84:85], 0
v_pk_add_f32 v[100:101], v[116:117], v[84:85]
v_pk_add_f32 v[102:103], v[118:119], v[84:85]
Lstub0:
s_cbranch_execz Lstub4
v_pk_add_f32 v[132:133], v[132:133], v[84:85]
v_pk_add_f32 v[134:135], v[134:135], v[84:85]
v_pk_add_f32 v[148:149], v[148:149], v[84:85]
v_pk_add_f32 v[150:151], v[150:151], v[84:85]
v_add_u32 v2, s82, v1
s_waitcnt vmcnt(13) lgkmcnt(0)
s_barrier
s_cmp_eq_u32 s60, 0
s_cbranch_scc1 LP0x
v_mfma_f32_16x16x32_bf16 v[160:163], a[160:163], v[16:19], v[80:83]
s_xor_b32 s74, s82, 0x10000
v_exp_f32 v128, v128
v_mfma_f32_16x16x32_bf16 v[160:163], a[164:167], v[20:23], v[160:163]
s_add_u32 s74, s74, s64
ds_read_b128 a[128:131], v2 offset:16384
ds_read_b128 a[132:135], v2 offset:17408
v_mfma_f32_16x16x32_bf16 v[160:163], a[168:171], v[24:27], v[160:163]
s_add_u32 s81, s81, 0x8000
v_exp_f32 v129, v129
v_mfma_f32_16x16x32_bf16 v[160:163], a[172:175], v[28:31], v[160:163]
s_add_u32 m0, s74, 16384
v_exp_f32 v130, v130
v_mfma_f32_16x16x32_bf16 v[164:167], a[172:175], v[44:47], v[84:87]
s_add_u32 s72, s81, 16384
v_exp_f32 v131, v131
v_mfma_f32_16x16x32_bf16 v[164:167], a[168:171], v[40:43], v[164:167]
v_exp_f32 v144, v144
v_mfma_f32_16x16x32_bf16 v[164:167], a[164:167], v[36:39], v[164:167]
ds_read_b128 a[136:139], v2 offset:18432
ds_read_b128 a[140:143], v2 offset:19456
v_mfma_f32_16x16x32_bf16 v[164:167], a[160:163], v[32:35], v[164:167]
ds_read_b128 a[144:147], v2 offset:20480
ds_read_b128 a[148:151], v2 offset:21504
v_mfma_f32_16x16x32_bf16 v[168:171], a[160:163], v[48:51], v[88:91]
ds_read_b128 a[152:155], v2 offset:22528
ds_read_b128 a[156:159], v2 offset:23552
v_mfma_f32_16x16x32_bf16 v[168:171], a[164:167], v[52:55], v[168:171]
ds_read_b128 a[192:195], v2 offset:0
ds_read_b128 a[196:199], v2 offset:1024
v_mfma_f32_16x16x32_bf16 v[168:171], a[168:171], v[56:59], v[168:171]
ds_read_b128 a[200:203], v2 offset:2048
ds_read_b128 a[204:207], v2 offset:3072
v_mfma_f32_16x16x32_bf16 v[168:171], a[172:175], v[60:63], v[168:171]
ds_read_b128 a[208:211], v2 offset:4096
ds_read_b128 a[212:215], v2 offset:5120
v_mfma_f32_16x16x32_bf16 v[172:175], a[172:175], v[76:79], v[92:95]
ds_read_b128 a[216:219], v2 offset:6144
ds_read_b128 a[220:223], v2 offset:7168
v_mfma_f32_16x16x32_bf16 v[172:175], a[168:171], v[72:75], v[172:175]
v_cvt_pk_bf16_f32 v192, v128, v129
v_cvt_pk_bf16_f32 v193, v130, v131
v_mfma_f32_16x16x32_bf16 v[172:175], a[164:167], v[68:71], v[172:175]
buffer_load_dwordx4 v1, s[44:47], s72 offen sc1 lds
v_mfma_f32_16x16x32_bf16 v[172:175], a[160:163], v[64:67], v[172:175]
v_exp_f32 v145, v145
v_mfma_f32_16x16x32_bf16 v[188:191], a[176:179], v[64:67], v[92:95]
v_exp_f32 v146, v146
v_mfma_f32_16x16x32_bf16 v[188:191], a[180:183], v[68:71], v[188:191]
v_exp_f32 v147, v147
v_mfma_f32_16x16x32_bf16 v[188:191], a[184:187], v[72:75], v[188:191]
v_exp_f32 v132, v132
v_mfma_f32_16x16x32_bf16 v[188:191], a[188:191], v[76:79], v[188:191]
v_cvt_pk_bf16_f32 v194, v144, v145
v_cvt_pk_bf16_f32 v195, v146, v147
v_mfma_f32_16x16x32_bf16 v[184:187], a[188:191], v[60:63], v[88:91]
v_exp_f32 v133, v133
v_mfma_f32_16x16x32_bf16 v[184:187], a[184:187], v[56:59], v[184:187]
v_exp_f32 v134, v134
v_mfma_f32_16x16x32_bf16 v[184:187], a[180:183], v[52:55], v[184:187]
v_exp_f32 v135, v135
v_mfma_f32_16x16x32_bf16 v[184:187], a[176:179], v[48:51], v[184:187]
v_exp_f32 v148, v148
v_mfma_f32_16x16x32_bf16 v[180:183], a[176:179], v[32:35], v[84:87]
v_cvt_pk_bf16_f32 v196, v132, v133
v_cvt_pk_bf16_f32 v197, v134, v135
v_mfma_f32_16x16x32_bf16 v[180:183], a[180:183], v[36:39], v[180:183]
buffer_load_dwordx4 v1, s[44:47], s72 offen offset:1024 sc1 lds
v_mfma_f32_16x16x32_bf16 v[180:183], a[184:187], v[40:43], v[180:183]
v_exp_f32 v149, v149
v_mfma_f32_16x16x32_bf16 v[180:183], a[188:191], v[44:47], v[180:183]
v_exp_f32 v150, v150
v_mfma_f32_16x16x32_bf16 v[176:179], a[188:191], v[28:31], v[80:83]
v_exp_f32 v151, v151
v_mfma_f32_16x16x32_bf16 v[176:179], a[184:187], v[24:27], v[176:179]
buffer_load_dwordx4 v1, s[44:47], s72 offen offset:2048 sc1 lds
v_mfma_f32_16x16x32_bf16 v[176:179], a[180:183], v[20:23], v[176:179]
buffer_load_dwordx4 v1, s[44:47], s72 offen offset:3072 sc1 lds
v_mfma_f32_16x16x32_bf16 v[176:179], a[176:179], v[16:19], v[176:179]
s_waitcnt lgkmcnt(8)
v_exp_f32 v136, v136
v_cvt_pk_bf16_f32 v198, v148, v149
v_cvt_pk_bf16_f32 v199, v150, v151
v_exp_f32 v137, v137
v_exp_f32 v138, v138
v_cvt_pk_bf16_f32 v200, v136, v137
v_exp_f32 v139, v139
v_exp_f32 v152, v152
v_cvt_pk_bf16_f32 v201, v138, v139
v_exp_f32 v153, v153
v_exp_f32 v154, v154
v_cvt_pk_bf16_f32 v202, v152, v153
v_exp_f32 v155, v155
v_exp_f32 v140, v140
v_cvt_pk_bf16_f32 v203, v154, v155
v_exp_f32 v141, v141
v_exp_f32 v142, v142
v_cvt_pk_bf16_f32 v204, v140, v141
v_exp_f32 v143, v143
v_exp_f32 v156, v156
v_cvt_pk_bf16_f32 v205, v142, v143
v_exp_f32 v157, v157
v_exp_f32 v158, v158
v_cvt_pk_bf16_f32 v206, v156, v157
v_exp_f32 v159, v159
s_nop 0
v_cvt_pk_bf16_f32 v207, v158, v159
v_mfma_f32_16x16x32_bf16 v[128:131], a[128:131], v[16:19], v[80:83]
s_add_u32 s82, s82, 0x8000
ds_read_b128 a[160:163], v2 offset:24576
v_mfma_f32_16x16x32_bf16 v[128:131], a[132:135], v[20:23], v[128:131]
s_and_b32 s82, s82, 0x1ffff
v_exp_f32 v160, v160
v_mfma_f32_16x16x32_bf16 v[128:131], a[136:139], v[24:27], v[128:131]
s_add_u32 m0, s74, 0
v_exp_f32 v161, v161
v_mfma_f32_16x16x32_bf16 v[128:131], a[140:143], v[28:31], v[128:131]
s_add_u32 s72, s81, 0
ds_read_b128 a[164:167], v2 offset:25600
v_cvt_pk_bf16_f32 v208, v160, v161
v_mfma_f32_16x16x32_bf16 v[132:135], a[140:143], v[44:47], v[84:87]
v_exp_f32 v162, v162
v_mfma_f32_16x16x32_bf16 v[132:135], a[136:139], v[40:43], v[132:135]
buffer_load_dwordx4 v1, s[44:47], s72 offen sc1 lds
v_mfma_f32_16x16x32_bf16 v[132:135], a[132:135], v[36:39], v[132:135]
v_exp_f32 v163, v163
v_mfma_f32_16x16x32_bf16 v[132:135], a[128:131], v[32:35], v[132:135]
ds_read_b128 a[168:171], v2 offset:26624
v_cvt_pk_bf16_f32 v209, v162, v163
v_mfma_f32_16x16x32_bf16 v[136:139], a[128:131], v[48:51], v[88:91]
v_exp_f32 v176, v176
v_mfma_f32_16x16x32_bf16 v[136:139], a[132:135], v[52:55], v[136:139]
v_exp_f32 v177, v177
v_mfma_f32_16x16x32_bf16 v[136:139], a[136:139], v[56:59], v[136:139]
ds_read_b128 a[172:175], v2 offset:27648
v_cvt_pk_bf16_f32 v210, v176, v177
v_mfma_f32_16x16x32_bf16 v[136:139], a[140:143], v[60:63], v[136:139]
v_exp_f32 v178, v178
v_mfma_f32_16x16x32_bf16 v[140:143], a[140:143], v[76:79], v[92:95]
buffer_load_dwordx4 v1, s[44:47], s72 offen offset:1024 sc1 lds
v_mfma_f32_16x16x32_bf16 v[140:143], a[136:139], v[72:75], v[140:143]
v_exp_f32 v179, v179
v_mfma_f32_16x16x32_bf16 v[140:143], a[132:135], v[68:71], v[140:143]
ds_read_b128 a[176:179], v2 offset:28672
v_cvt_pk_bf16_f32 v211, v178, v179
v_mfma_f32_16x16x32_bf16 v[140:143], a[128:131], v[64:67], v[140:143]
v_exp_f32 v164, v164
v_mfma_f32_16x16x32_bf16 v[156:159], a[144:147], v[64:67], v[92:95]
v_exp_f32 v165, v165
v_mfma_f32_16x16x32_bf16 v[156:159], a[148:151], v[68:71], v[156:159]
ds_read_b128 a[180:183], v2 offset:29696
v_cvt_pk_bf16_f32 v212, v164, v165
v_mfma_f32_16x16x32_bf16 v[156:159], a[152:155], v[72:75], v[156:159]
v_exp_f32 v166, v166
v_mfma_f32_16x16x32_bf16 v[156:159], a[156:159], v[76:79], v[156:159]
buffer_load_dwordx4 v1, s[44:47], s72 offen offset:2048 sc1 lds
v_mfma_f32_16x16x32_bf16 v[152:155], a[156:159], v[60:63], v[88:91]
v_exp_f32 v167, v167
v_mfma_f32_16x16x32_bf16 v[152:155], a[152:155], v[56:59], v[152:155]
ds_read_b128 a[184:187], v2 offset:30720
v_cvt_pk_bf16_f32 v213, v166, v167
v_mfma_f32_16x16x32_bf16 v[152:155], a[148:151], v[52:55], v[152:155]
v_exp_f32 v180, v180
v_mfma_f32_16x16x32_bf16 v[152:155], a[144:147], v[48:51], v[152:155]
v_exp_f32 v181, v181
v_mfma_f32_16x16x32_bf16 v[148:151], a[144:147], v[32:35], v[84:87]
ds_read_b128 a[188:191], v2 offset:31744
v_cvt_pk_bf16_f32 v214, v180, v181
v_mfma_f32_16x16x32_bf16 v[148:151], a[148:151], v[36:39], v[148:151]
v_exp_f32 v182, v182
v_mfma_f32_16x16x32_bf16 v[148:151], a[152:155], v[40:43], v[148:151]
buffer_load_dwordx4 v1, s[44:47], s72 offen offset:3072 sc1 lds
v_mfma_f32_16x16x32_bf16 v[148:151], a[156:159], v[44:47], v[148:151]
s_add_u32 s66, s58, 1
v_exp_f32 v183, v183
v_mfma_f32_16x16x32_bf16 v[144:147], a[156:159], v[28:31], v[80:83]
s_and_b32 s66, s66, 3
ds_read_b128 a[224:227], v2 offset:8192
v_cvt_pk_bf16_f32 v215, v182, v183
v_mfma_f32_16x16x32_bf16 v[144:147], a[152:155], v[24:27], v[144:147]
s_mul_i32 s66, s66, 4160
v_exp_f32 v168, v168
v_mfma_f32_16x16x32_bf16 v[144:147], a[148:151], v[20:23], v[144:147]
s_add_u32 m0, s66, 131104
v_exp_f32 v169, v169
v_mfma_f32_16x16x32_bf16 v[144:147], a[144:147], v[16:19], v[144:147]
s_waitcnt lgkmcnt(9)
ds_read_b128 a[228:231], v2 offset:9216
v_cvt_pk_bf16_f32 v216, v168, v169
v_mfma_f32_16x16x32_bf16 a[0:3], a[192:195], v[192:195], 0
s_add_u32 s72, s93, 0x2
v_exp_f32 v170, v170
v_mfma_f32_16x16x32_bf16 a[32:35], a[192:195], v[196:199], 0
buffer_load_dwordx4 v1, s[36:39], s72 offen lds
v_mfma_f32_16x16x32_bf16 a[64:67], a[192:195], v[200:203], 0
v_exp_f32 v171, v171
v_mfma_f32_16x16x32_bf16 a[96:99], a[192:195], v[204:207], 0
ds_read_b128 a[232:235], v2 offset:10240
v_cvt_pk_bf16_f32 v217, v170, v171
v_mfma_f32_16x16x32_bf16 a[100:103], a[196:199], v[204:207], 0
v_exp_f32 v184, v184
v_mfma_f32_16x16x32_bf16 a[68:71], a[196:199], v[200:203], 0
v_exp_f32 v185, v185
v_mfma_f32_16x16x32_bf16 a[36:39], a[196:199], v[196:199], 0
ds_read_b128 a[236:239], v2 offset:11264
v_cvt_pk_bf16_f32 v218, v184, v185
v_mfma_f32_16x16x32_bf16 a[4:7], a[196:199], v[192:195], 0
v_exp_f32 v186, v186
v_mfma_f32_16x16x32_bf16 a[8:11], a[200:203], v[192:195], 0
buffer_load_dwordx4 v1, s[36:39], s72 offen offset:1024 lds
v_mfma_f32_16x16x32_bf16 a[40:43], a[200:203], v[196:199], 0
v_exp_f32 v187, v187
v_mfma_f32_16x16x32_bf16 a[72:75], a[200:203], v[200:203], 0
ds_read_b128 a[240:243], v2 offset:12288
v_cvt_pk_bf16_f32 v219, v186, v187
v_mfma_f32_16x16x32_bf16 a[104:107], a[200:203], v[204:207], 0
v_exp_f32 v172, v172
v_mfma_f32_16x16x32_bf16 a[108:111], a[204:207], v[204:207], 0
v_exp_f32 v173, v173
v_mfma_f32_16x16x32_bf16 a[76:79], a[204:207], v[200:203], 0
ds_read_b128 a[244:247], v2 offset:13312
v_cvt_pk_bf16_f32 v220, v172, v173
v_mfma_f32_16x16x32_bf16 a[44:47], a[204:207], v[196:199], 0
v_exp_f32 v174, v174
v_mfma_f32_16x16x32_bf16 a[12:15], a[204:207], v[192:195], 0
buffer_load_dwordx4 v1, s[36:39], s72 offen offset:2048 lds
v_mfma_f32_16x16x32_bf16 a[16:19], a[208:211], v[192:195], 0
v_exp_f32 v175, v175
v_mfma_f32_16x16x32_bf16 a[48:51], a[208:211], v[196:199], 0
ds_read_b128 a[248:251], v2 offset:14336
v_cvt_pk_bf16_f32 v221, v174, v175
v_mfma_f32_16x16x32_bf16 a[80:83], a[208:211], v[200:203], 0
v_exp_f32 v188, v188
v_mfma_f32_16x16x32_bf16 a[112:115], a[208:211], v[204:207], 0
v_exp_f32 v189, v189
v_mfma_f32_16x16x32_bf16 a[116:119], a[212:215], v[204:207], 0
ds_read_b128 a[252:255], v2 offset:15360
v_cvt_pk_bf16_f32 v222, v188, v189
v_mfma_f32_16x16x32_bf16 a[84:87], a[212:215], v[200:203], 0
v_exp_f32 v190, v190
v_mfma_f32_16x16x32_bf16 a[52:55], a[212:215], v[196:199], 0
buffer_load_dwordx4 v1, s[36:39], s72 offen offset:3072 lds
v_mfma_f32_16x16x32_bf16 a[20:23], a[212:215], v[192:195], 0
v_exp_f32 v191, v191
v_mfma_f32_16x16x32_bf16 a[24:27], a[216:219], v[192:195], 0
v_cvt_pk_bf16_f32 v223, v190, v191
v_add_u32 v2, s82, v1
v_mfma_f32_16x16x32_bf16 a[56:59], a[216:219], v[196:199], 0
v_and_b32 v240, 15, v0
v_lshrrev_b32 v241, 4, v0
v_mfma_f32_16x16x32_bf16 a[88:91], a[216:219], v[200:203], 0
v_add_u32 v248, 1, v240
v_and_b32 v249, 3, v248
v_mfma_f32_16x16x32_bf16 a[120:123], a[216:219], v[204:207], 0
v_lshrrev_b32 v248, 2, v248
v_mov_b32 v250, 0x20000
v_mfma_f32_16x16x32_bf16 a[124:127], a[220:223], v[204:207], 0
v_mov_b32 v252, 0x20001
v_lshlrev_b32 v6, 3, v249
v_mfma_f32_16x16x32_bf16 a[92:95], a[220:223], v[200:203], 0
v_lshrrev_b32 v6, v6, v252
v_and_b32 v6, 3, v6
v_mfma_f32_16x16x32_bf16 a[60:63], a[220:223], v[196:199], 0
v_cmp_ne_u32 vcc, 1, v249
v_mul_u32_u24 v6, 16640, v6
v_mfma_f32_16x16x32_bf16 a[28:31], a[220:223], v[192:195], 0
v_add_u32 v6, s92, v6
v_cndmask_b32 v6, v250, v6, vcc
v_mfma_f32_16x16x32_bf16 v[224:227], v[120:123], v[192:195], 0
v_add_u32 v253, s58, v249
v_and_b32 v253, 3, v253
v_mfma_f32_16x16x32_bf16 v[228:231], v[120:123], v[196:199], 0
v_mul_u32_u24 v253, 4160, v253
v_add_u32 v6, v6, v253
v_mfma_f32_16x16x32_bf16 v[232:235], v[120:123], v[200:203], 0
s_waitcnt vmcnt(12) lgkmcnt(8)
v_mfma_f32_16x16x32_bf16 v[236:239], v[120:123], v[204:207], 0
s_barrier
s_lshl_b32 s75, s59, 4
s_and_b32 s76, s84, 15
s_add_u32 s75, s75, s76
s_lshl_b32 s75, s75, 14
s_cmp_ge_u32 s60, 4
s_cselect_b32 s75, s75, 0x40001000
s_lshl_b32 s83, s60, 1
s_sub_u32 s83, 2, s83
s_cmp_eq_u32 s83, 0
s_cbranch_scc1 LLT1
.p2align 5
s_nop 0
s_nop 0
LloopI:
v_mfma_f32_16x16x32_bf16 v[160:163], a[160:163], v[16:19], v[80:83]
s_xor_b32 s74, s82, 0x10000
v_exp_f32 v128, v128
v_mfma_f32_16x16x32_bf16 v[160:163], a[164:167], v[20:23], v[160:163]
s_add_u32 s74, s74, s64
ds_read_b128 a[128:131], v2 offset:16384
v_mfma_f32_16x16x32_bf16 v[160:163], a[168:171], v[24:27], v[160:163]
s_add_u32 s81, s81, 0x8000
v_exp_f32 v129, v129
v_mfma_f32_16x16x32_bf16 v[160:163], a[172:175], v[28:31], v[160:163]
s_add_u32 m0, s74, 16384
v_exp_f32 v130, v130
v_mfma_f32_16x16x32_bf16 v[164:167], a[172:175], v[44:47], v[84:87]
s_add_u32 s72, s81, 16384
ds_read_b128 a[132:135], v2 offset:17408
v_cvt_pk_bf16_f32 v192, v128, v129
v_mfma_f32_16x16x32_bf16 v[164:167], a[168:171], v[40:43], v[164:167]
v_exp_f32 v131, v131
v_mfma_f32_16x16x32_bf16 v[164:167], a[164:167], v[36:39], v[164:167]
v_exp_f32 v144, v144
v_mfma_f32_16x16x32_bf16 v[164:167], a[160:163], v[32:35], v[164:167]
ds_read_b128 a[136:139], v2 offset:18432
v_cvt_pk_bf16_f32 v193, v130, v131
v_mfma_f32_16x16x32_bf16 v[168:171], a[160:163], v[48:51], v[88:91]
buffer_load_dwordx4 v1, s[44:47], s72 offen sc1 lds
v_mfma_f32_16x16x32_bf16 v[168:171], a[164:167], v[52:55], v[168:171]
v_exp_f32 v145, v145
v_mfma_f32_16x16x32_bf16 v[168:171], a[168:171], v[56:59], v[168:171]
v_exp_f32 v146, v146
v_mfma_f32_16x16x32_bf16 v[168:171], a[172:175], v[60:63], v[168:171]
ds_read_b128 a[140:143], v2 offset:19456
v_cvt_pk_bf16_f32 v194, v144, v145
v_mfma_f32_16x16x32_bf16 v[172:175], a[172:175], v[76:79], v[92:95]
v_exp_f32 v147, v147
v_mfma_f32_16x16x32_bf16 v[172:175], a[168:171], v[72:75], v[172:175]
v_exp_f32 v132, v132
v_mfma_f32_16x16x32_bf16 v[172:175], a[164:167], v[68:71], v[172:175]
ds_read_b128 a[144:147], v2 offset:20480
v_cvt_pk_bf16_f32 v195, v146, v147
v_mfma_f32_16x16x32_bf16 v[172:175], a[160:163], v[64:67], v[172:175]
v_exp_f32 v133, v133
v_mfma_f32_16x16x32_bf16 v[188:191], a[176:179], v[64:67], v[92:95]
v_exp_f32 v134, v134
v_mfma_f32_16x16x32_bf16 v[188:191], a[180:183], v[68:71], v[188:191]
ds_read_b128 a[148:151], v2 offset:21504
v_cvt_pk_bf16_f32 v196, v132, v133
v_mfma_f32_16x16x32_bf16 v[188:191], a[184:187], v[72:75], v[188:191]
v_exp_f32 v135, v135
v_mfma_f32_16x16x32_bf16 v[188:191], a[188:191], v[76:79], v[188:191]
v_exp_f32 v148, v148
v_mfma_f32_16x16x32_bf16 v[184:187], a[188:191], v[60:63], v[88:91]
ds_read_b128 a[152:155], v2 offset:22528
v_cvt_pk_bf16_f32 v197, v134, v135
v_mfma_f32_16x16x32_bf16 v[184:187], a[184:187], v[56:59], v[184:187]
buffer_load_dwordx4 v1, s[44:47], s72 offen offset:1024 sc1 lds
v_mfma_f32_16x16x32_bf16 v[184:187], a[180:183], v[52:55], v[184:187]
v_exp_f32 v149, v149
v_mfma_f32_16x16x32_bf16 v[184:187], a[176:179], v[48:51], v[184:187]
v_exp_f32 v150, v150
v_mfma_f32_16x16x32_bf16 v[180:183], a[176:179], v[32:35], v[84:87]
ds_read_b128 a[156:159], v2 offset:23552
v_cvt_pk_bf16_f32 v198, v148, v149
v_mfma_f32_16x16x32_bf16 v[180:183], a[180:183], v[36:39], v[180:183]
v_exp_f32 v151, v151
v_mfma_f32_16x16x32_bf16 v[180:183], a[184:187], v[40:43], v[180:183]
v_exp_f32 v136, v136
v_mfma_f32_16x16x32_bf16 v[180:183], a[188:191], v[44:47], v[180:183]
ds_read_b128 a[192:195], v2 offset:0
v_cvt_pk_bf16_f32 v199, v150, v151
v_mfma_f32_16x16x32_bf16 v[176:179], a[188:191], v[28:31], v[80:83]
v_exp_f32 v137, v137
v_mfma_f32_16x16x32_bf16 v[176:179], a[184:187], v[24:27], v[176:179]
v_exp_f32 v138, v138
v_mfma_f32_16x16x32_bf16 v[176:179], a[180:183], v[20:23], v[176:179]
ds_read_b128 a[196:199], v2 offset:1024
v_cvt_pk_bf16_f32 v200, v136, v137
v_mfma_f32_16x16x32_bf16 v[176:179], a[176:179], v[16:19], v[176:179]
s_waitcnt lgkmcnt(10)
v_exp_f32 v139, v139
v_mfma_f32_16x16x32_bf16 a[0:3], a[224:227], v[208:211], a[0:3]
v_exp_f32 v152, v152
v_mfma_f32_16x16x32_bf16 a[32:35], a[224:227], v[212:215], a[32:35]
ds_read_b128 a[200:203], v2 offset:2048
v_cvt_pk_bf16_f32 v201, v138, v139
v_mfma_f32_16x16x32_bf16 a[64:67], a[224:227], v[216:219], a[64:67]
buffer_load_dwordx4 v1, s[44:47], s72 offen offset:2048 sc1 lds
v_mfma_f32_16x16x32_bf16 a[96:99], a[224:227], v[220:223], a[96:99]
v_exp_f32 v153, v153
v_mfma_f32_16x16x32_bf16 a[100:103], a[228:231], v[220:223], a[100:103]
v_exp_f32 v154, v154
v_mfma_f32_16x16x32_bf16 a[68:71], a[228:231], v[216:219], a[68:71]
ds_read_b128 a[204:207], v2 offset:3072
v_cvt_pk_bf16_f32 v202, v152, v153
v_mfma_f32_16x16x32_bf16 a[36:39], a[228:231], v[212:215], a[36:39]
v_exp_f32 v155, v155
v_mfma_f32_16x16x32_bf16 a[4:7], a[228:231], v[208:211], a[4:7]
v_exp_f32 v140, v140
v_mfma_f32_16x16x32_bf16 a[8:11], a[232:235], v[208:211], a[8:11]
ds_read_b128 a[208:211], v2 offset:4096
v_cvt_pk_bf16_f32 v203, v154, v155
v_mfma_f32_16x16x32_bf16 a[40:43], a[232:235], v[212:215], a[40:43]
v_exp_f32 v141, v141
v_mfma_f32_16x16x32_bf16 a[72:75], a[232:235], v[216:219], a[72:75]
v_exp_f32 v142, v142
v_mfma_f32_16x16x32_bf16 a[104:107], a[232:235], v[220:223], a[104:107]
ds_read_b128 a[212:215], v2 offset:5120
v_cvt_pk_bf16_f32 v204, v140, v141
v_mfma_f32_16x16x32_bf16 a[108:111], a[236:239], v[220:223], a[108:111]
v_exp_f32 v143, v143
v_mfma_f32_16x16x32_bf16 a[76:79], a[236:239], v[216:219], a[76:79]
v_exp_f32 v156, v156
v_mfma_f32_16x16x32_bf16 a[44:47], a[236:239], v[212:215], a[44:47]
ds_read_b128 a[216:219], v2 offset:6144
v_cvt_pk_bf16_f32 v205, v142, v143
v_mfma_f32_16x16x32_bf16 a[12:15], a[236:239], v[208:211], a[12:15]
buffer_load_dwordx4 v1, s[44:47], s72 offen offset:3072 sc1 lds
v_mfma_f32_16x16x32_bf16 a[16:19], a[240:243], v[208:211], a[16:19]
v_exp_f32 v157, v157
v_mfma_f32_16x16x32_bf16 a[48:51], a[240:243], v[212:215], a[48:51]
v_exp_f32 v158, v158
v_mfma_f32_16x16x32_bf16 a[80:83], a[240:243], v[216:219], a[80:83]
ds_read_b128 a[220:223], v2 offset:7168
v_cvt_pk_bf16_f32 v206, v156, v157
v_mfma_f32_16x16x32_bf16 a[112:115], a[240:243], v[220:223], a[112:115]
v_exp_f32 v159, v159
v_mfma_f32_16x16x32_bf16 a[116:119], a[244:247], v[220:223], a[116:119]
v_cvt_pk_bf16_f32 v207, v158, v159
v_add_u32 v15, s75, v3
v_mfma_f32_16x16x32_bf16 a[84:87], a[244:247], v[216:219], a[84:87]
v_mfma_f32_16x16x32_bf16 a[52:55], a[244:247], v[212:215], a[52:55]
v_mfma_f32_16x16x32_bf16 a[20:23], a[244:247], v[208:211], a[20:23]
v_mfma_f32_16x16x32_bf16 a[24:27], a[248:251], v[208:211], a[24:27]
v_mfma_f32_16x16x32_bf16 a[56:59], a[248:251], v[212:215], a[56:59]
v_mfma_f32_16x16x32_bf16 a[88:91], a[248:251], v[216:219], a[88:91]
v_mfma_f32_16x16x32_bf16 a[120:123], a[248:251], v[220:223], a[120:123]
v_mfma_f32_16x16x32_bf16 a[124:127], a[252:255], v[220:223], a[124:127]
v_mfma_f32_16x16x32_bf16 a[92:95], a[252:255], v[216:219], a[92:95]
v_mfma_f32_16x16x32_bf16 a[60:63], a[252:255], v[212:215], a[60:63]
v_mfma_f32_16x16x32_bf16 a[28:31], a[252:255], v[208:211], a[28:31]
v_mfma_f32_16x16x32_bf16 v[224:227], v[120:123], v[208:211], v[224:227]
v_mfma_f32_16x16x32_bf16 v[228:231], v[120:123], v[212:215], v[228:231]
v_mfma_f32_16x16x32_bf16 v[232:235], v[120:123], v[216:219], v[232:235]
v_mfma_f32_16x16x32_bf16 v[236:239], v[120:123], v[220:223], v[236:239]
s_waitcnt lgkmcnt(8)
v_mfma_f32_16x16x32_bf16 v[128:131], a[128:131], v[16:19], v[80:83]
s_add_u32 s82, s82, 0x8000
ds_read_b128 a[160:163], v2 offset:24576
v_mfma_f32_16x16x32_bf16 v[128:131], a[132:135], v[20:23], v[128:131]
s_and_b32 s82, s82, 0x1ffff
v_exp_f32 v160, v160
v_mfma_f32_16x16x32_bf16 v[128:131], a[136:139], v[24:27], v[128:131]
s_add_u32 m0, s74, 0
v_exp_f32 v161, v161
v_mfma_f32_16x16x32_bf16 v[128:131], a[140:143], v[28:31], v[128:131]
s_add_u32 s72, s81, 0
ds_read_b128 a[164:167], v2 offset:25600
v_cvt_pk_bf16_f32 v208, v160, v161
v_mfma_f32_16x16x32_bf16 v[132:135], a[140:143], v[44:47], v[84:87]
v_exp_f32 v162, v162
v_mfma_f32_16x16x32_bf16 v[132:135], a[136:139], v[40:43], v[132:135]
v_exp_f32 v163, v163
v_mfma_f32_16x16x32_bf16 v[132:135], a[132:135], v[36:39], v[132:135]
buffer_load_dwordx4 v1, s[44:47], s72 offen sc1 lds
v_mfma_f32_16x16x32_bf16 v[132:135], a[128:131], v[32:35], v[132:135]
ds_read_b128 a[168:171], v2 offset:26624
v_cvt_pk_bf16_f32 v209, v162, v163
v_mfma_f32_16x16x32_bf16 v[136:139], a[128:131], v[48:51], v[88:91]
v_exp_f32 v176, v176
v_mfma_f32_16x16x32_bf16 v[136:139], a[132:135], v[52:55], v[136:139]
v_exp_f32 v177, v177
v_mfma_f32_16x16x32_bf16 v[136:139], a[136:139], v[56:59], v[136:139]
ds_read_b128 a[172:175], v2 offset:27648
v_cvt_pk_bf16_f32 v210, v176, v177
v_mfma_f32_16x16x32_bf16 v[136:139], a[140:143], v[60:63], v[136:139]
v_exp_f32 v178, v178
v_mfma_f32_16x16x32_bf16 v[140:143], a[140:143], v[76:79], v[92:95]
v_exp_f32 v179, v179
v_mfma_f32_16x16x32_bf16 v[140:143], a[136:139], v[72:75], v[140:143]
ds_read_b128 a[176:179], v2 offset:28672
v_cvt_pk_bf16_f32 v211, v178, v179
v_mfma_f32_16x16x32_bf16 v[140:143], a[132:135], v[68:71], v[140:143]
v_exp_f32 v164, v164
v_mfma_f32_16x16x32_bf16 v[140:143], a[128:131], v[64:67], v[140:143]
v_exp_f32 v165, v165
v_mfma_f32_16x16x32_bf16 v[156:159], a[144:147], v[64:67], v[92:95]
ds_read_b128 a[180:183], v2 offset:29696
v_cvt_pk_bf16_f32 v212, v164, v165
v_mfma_f32_16x16x32_bf16 v[156:159], a[148:151], v[68:71], v[156:159]
buffer_load_dwordx4 v1, s[44:47], s72 offen offset:1024 sc1 lds
v_mfma_f32_16x16x32_bf16 v[156:159], a[152:155], v[72:75], v[156:159]
v_exp_f32 v166, v166
v_mfma_f32_16x16x32_bf16 v[156:159], a[156:159], v[76:79], v[156:159]
v_exp_f32 v167, v167
v_mfma_f32_16x16x32_bf16 v[152:155], a[156:159], v[60:63], v[88:91]
ds_read_b128 a[184:187], v2 offset:30720
v_cvt_pk_bf16_f32 v213, v166, v167
v_mfma_f32_16x16x32_bf16 v[152:155], a[152:155], v[56:59], v[152:155]
v_exp_f32 v180, v180
v_mfma_f32_16x16x32_bf16 v[152:155], a[148:151], v[52:55], v[152:155]
v_exp_f32 v181, v181
v_mfma_f32_16x16x32_bf16 v[152:155], a[144:147], v[48:51], v[152:155]
ds_read_b128 a[188:191], v2 offset:31744
v_cvt_pk_bf16_f32 v214, v180, v181
v_mfma_f32_16x16x32_bf16 v[148:151], a[144:147], v[32:35], v[84:87]
v_exp_f32 v182, v182
v_mfma_f32_16x16x32_bf16 v[148:151], a[148:151], v[36:39], v[148:151]
v_exp_f32 v183, v183
v_mfma_f32_16x16x32_bf16 v[148:151], a[152:155], v[40:43], v[148:151]
ds_read_b128 a[224:227], v2 offset:8192
v_cvt_pk_bf16_f32 v215, v182, v183
v_mfma_f32_16x16x32_bf16 v[148:151], a[156:159], v[44:47], v[148:151]
v_exp_f32 v168, v168
v_mfma_f32_16x16x32_bf16 v[144:147], a[156:159], v[28:31], v[80:83]
buffer_load_dwordx4 v1, s[44:47], s72 offen offset:2048 sc1 lds
v_mfma_f32_16x16x32_bf16 v[144:147], a[152:155], v[24:27], v[144:147]
v_exp_f32 v169, v169
v_mfma_f32_16x16x32_bf16 v[144:147], a[148:151], v[20:23], v[144:147]
ds_read_b128 a[228:231], v2 offset:9216
v_cvt_pk_bf16_f32 v216, v168, v169
v_mfma_f32_16x16x32_bf16 v[144:147], a[144:147], v[16:19], v[144:147]
s_waitcnt lgkmcnt(10)
v_exp_f32 v170, v170
v_mfma_f32_16x16x32_bf16 a[0:3], a[192:195], v[192:195], a[0:3]
v_exp_f32 v171, v171
v_mfma_f32_16x16x32_bf16 a[32:35], a[192:195], v[196:199], a[32:35]
ds_read_b128 a[232:235], v2 offset:10240
v_cvt_pk_bf16_f32 v217, v170, v171
v_mfma_f32_16x16x32_bf16 a[64:67], a[192:195], v[200:203], a[64:67]
v_exp_f32 v184, v184
v_mfma_f32_16x16x32_bf16 a[96:99], a[192:195], v[204:207], a[96:99]
v_exp_f32 v185, v185
v_mfma_f32_16x16x32_bf16 a[100:103], a[196:199], v[204:207], a[100:103]
ds_read_b128 a[236:239], v2 offset:11264
v_cvt_pk_bf16_f32 v218, v184, v185
v_mfma_f32_16x16x32_bf16 a[68:71], a[196:199], v[200:203], a[68:71]
v_exp_f32 v186, v186
v_mfma_f32_16x16x32_bf16 a[36:39], a[196:199], v[196:199], a[36:39]
buffer_load_dwordx4 v1, s[44:47], s72 offen offset:3072 sc1 lds
v_mfma_f32_16x16x32_bf16 a[4:7], a[196:199], v[192:195], a[4:7]
s_add_u32 s75, s75, 0x1000
v_exp_f32 v187, v187
v_mfma_f32_16x16x32_bf16 a[8:11], a[200:203], v[192:195], a[8:11]
s_and_b32 s76, s75, 0x3000
ds_read_b128 a[240:243], v2 offset:12288
v_cvt_pk_bf16_f32 v219, v186, v187
v_mfma_f32_16x16x32_bf16 a[40:43], a[200:203], v[196:199], a[40:43]
s_cselect_b32 s75, s75, 0x40001000
v_exp_f32 v172, v172
v_mfma_f32_16x16x32_bf16 a[72:75], a[200:203], v[200:203], a[72:75]
v_exp_f32 v173, v173
v_mfma_f32_16x16x32_bf16 a[104:107], a[200:203], v[204:207], a[104:107]
ds_read_b128 a[244:247], v2 offset:13312
v_cvt_pk_bf16_f32 v220, v172, v173
v_mfma_f32_16x16x32_bf16 a[108:111], a[204:207], v[204:207], a[108:111]
v_exp_f32 v174, v174
v_mfma_f32_16x16x32_bf16 a[76:79], a[204:207], v[200:203], a[76:79]
v_exp_f32 v175, v175
v_mfma_f32_16x16x32_bf16 a[44:47], a[204:207], v[196:199], a[44:47]
ds_read_b128 a[248:251], v2 offset:14336
v_cvt_pk_bf16_f32 v221, v174, v175
v_mfma_f32_16x16x32_bf16 a[12:15], a[204:207], v[192:195], a[12:15]
v_exp_f32 v188, v188
v_mfma_f32_16x16x32_bf16 a[16:19], a[208:211], v[192:195], a[16:19]
buffer_load_dword v4, v15, s[24:27], 0 offen
v_mfma_f32_16x16x32_bf16 a[48:51], a[208:211], v[196:199], a[48:51]
v_exp_f32 v189, v189
v_mfma_f32_16x16x32_bf16 a[80:83], a[208:211], v[200:203], a[80:83]
ds_read_b128 a[252:255], v2 offset:15360
v_cvt_pk_bf16_f32 v222, v188, v189
v_mfma_f32_16x16x32_bf16 a[112:115], a[208:211], v[204:207], a[112:115]
v_exp_f32 v190, v190
v_mfma_f32_16x16x32_bf16 a[116:119], a[212:215], v[204:207], a[116:119]
v_exp_f32 v191, v191
v_mfma_f32_16x16x32_bf16 a[84:87], a[212:215], v[200:203], a[84:87]
v_cvt_pk_bf16_f32 v223, v190, v191
v_add_u32 v2, s82, v1
v_mfma_f32_16x16x32_bf16 a[52:55], a[212:215], v[196:199], a[52:55]
v_mfma_f32_16x16x32_bf16 a[20:23], a[212:215], v[192:195], a[20:23]
v_mfma_f32_16x16x32_bf16 a[24:27], a[216:219], v[192:195], a[24:27]
v_mfma_f32_16x16x32_bf16 a[56:59], a[216:219], v[196:199], a[56:59]
v_mfma_f32_16x16x32_bf16 a[88:91], a[216:219], v[200:203], a[88:91]
v_mfma_f32_16x16x32_bf16 a[120:123], a[216:219], v[204:207], a[120:123]
v_mfma_f32_16x16x32_bf16 a[124:127], a[220:223], v[204:207], a[124:127]
v_mfma_f32_16x16x32_bf16 a[92:95], a[220:223], v[200:203], a[92:95]
v_mfma_f32_16x16x32_bf16 a[60:63], a[220:223], v[196:199], a[60:63]
v_mfma_f32_16x16x32_bf16 a[28:31], a[220:223], v[192:195], a[28:31]
v_mfma_f32_16x16x32_bf16 v[224:227], v[120:123], v[192:195], v[224:227]
s_waitcnt vmcnt(9) lgkmcnt(8)
v_mfma_f32_16x16x32_bf16 v[228:231], v[120:123], v[196:199], v[228:231]
s_barrier
v_mfma_f32_16x16x32_bf16 v[232:235], v[120:123], v[200:203], v[232:235]
s_add_u32 s83, s83, 1
v_mfma_f32_16x16x32_bf16 v[236:239], v[120:123], v[204:207], v[236:239]
s_cbranch_scc0 LloopI
LLT1:
Lstub1:
s_cbranch_execz Lstub5
v_mfma_f32_16x16x32_bf16 v[160:163], a[160:163], v[16:19], v[80:83]
s_xor_b32 s74, s82, 0x10000
v_exp_f32 v128, v128
v_mfma_f32_16x16x32_bf16 v[160:163], a[164:167], v[20:23], v[160:163]
s_add_u32 s74, s74, s64
ds_read_b128 a[128:131], v2 offset:16384
v_mfma_f32_16x16x32_bf16 v[160:163], a[168:171], v[24:27], v[160:163]
s_add_u32 s81, s81, 0x8000
v_exp_f32 v129, v129
Lstub2:
s_cbranch_execz Lstub6
v_mfma_f32_16x16x32_bf16 v[160:163], a[172:175], v[28:31], v[160:163]
s_add_u32 m0, s74, 16384
v_exp_f32 v130, v130
v_mfma_f32_16x16x32_bf16 v[164:167], a[172:175], v[44:47], v[84:87]
s_add_u32 s72, s81, 16384
ds_read_b128 a[132:135], v2 offset:17408
v_cvt_pk_bf16_f32 v192, v128, v129
v_mfma_f32_16x16x32_bf16 v[164:167], a[168:171], v[40:43], v[164:167]
v_exp_f32 v131, v131
v_mfma_f32_16x16x32_bf16 v[164:167], a[164:167], v[36:39], v[164:167]
v_exp_f32 v144, v144
v_mfma_f32_16x16x32_bf16 v[164:167], a[160:163], v[32:35], v[164:167]
ds_read_b128 a[136:139], v2 offset:18432
v_cvt_pk_bf16_f32 v193, v130, v131
v_mfma_f32_16x16x32_bf16 v[168:171], a[160:163], v[48:51], v[88:91]
buffer_load_dwordx4 v1, s[44:47], s72 offen sc1 lds
v_mfma_f32_16x16x32_bf16 v[168:171], a[164:167], v[52:55], v[168:171]
v_exp_f32 v145, v145
v_mfma_f32_16x16x32_bf16 v[168:171], a[168:171], v[56:59], v[168:171]
v_exp_f32 v146, v146
v_mfma_f32_16x16x32_bf16 v[168:171], a[172:175], v[60:63], v[168:171]
ds_read_b128 a[140:143], v2 offset:19456
v_cvt_pk_bf16_f32 v194, v144, v145
v_mfma_f32_16x16x32_bf16 v[172:175], a[172:175], v[76:79], v[92:95]
v_exp_f32 v147, v147
v_mfma_f32_16x16x32_bf16 v[172:175], a[168:171], v[72:75], v[172:175]
v_exp_f32 v132, v132
v_mfma_f32_16x16x32_bf16 v[172:175], a[164:167], v[68:71], v[172:175]
ds_read_b128 a[144:147], v2 offset:20480
v_cvt_pk_bf16_f32 v195, v146, v147
v_mfma_f32_16x16x32_bf16 v[172:175], a[160:163], v[64:67], v[172:175]
v_exp_f32 v133, v133
v_mfma_f32_16x16x32_bf16 v[188:191], a[176:179], v[64:67], v[92:95]
v_exp_f32 v134, v134
v_mfma_f32_16x16x32_bf16 v[188:191], a[180:183], v[68:71], v[188:191]
ds_read_b128 a[148:151], v2 offset:21504
v_cvt_pk_bf16_f32 v196, v132, v133
v_mfma_f32_16x16x32_bf16 v[188:191], a[184:187], v[72:75], v[188:191]
v_exp_f32 v135, v135
v_mfma_f32_16x16x32_bf16 v[188:191], a[188:191], v[76:79], v[188:191]
v_exp_f32 v148, v148
v_mfma_f32_16x16x32_bf16 v[184:187], a[188:191], v[60:63], v[88:91]
ds_read_b128 a[152:155], v2 offset:22528
v_cvt_pk_bf16_f32 v197, v134, v135
v_mfma_f32_16x16x32_bf16 v[184:187], a[184:187], v[56:59], v[184:187]
buffer_load_dwordx4 v1, s[44:47], s72 offen offset:1024 sc1 lds
v_mfma_f32_16x16x32_bf16 v[184:187], a[180:183], v[52:55], v[184:187]
v_exp_f32 v149, v149
v_mfma_f32_16x16x32_bf16 v[184:187], a[176:179], v[48:51], v[184:187]
v_exp_f32 v150, v150
v_mfma_f32_16x16x32_bf16 v[180:183], a[176:179], v[32:35], v[84:87]
ds_read_b128 a[156:159], v2 offset:23552
v_cvt_pk_bf16_f32 v198, v148, v149
v_mfma_f32_16x16x32_bf16 v[180:183], a[180:183], v[36:39], v[180:183]
v_exp_f32 v151, v151
v_mfma_f32_16x16x32_bf16 v[180:183], a[184:187], v[40:43], v[180:183]
v_exp_f32 v136, v136
v_mfma_f32_16x16x32_bf16 v[180:183], a[188:191], v[44:47], v[180:183]
ds_read_b128 a[192:195], v2 offset:0
v_cvt_pk_bf16_f32 v199, v150, v151
v_mfma_f32_16x16x32_bf16 v[176:179], a[188:191], v[28:31], v[80:83]
v_exp_f32 v137, v137
v_mfma_f32_16x16x32_bf16 v[176:179], a[184:187], v[24:27], v[176:179]
v_exp_f32 v138, v138
v_mfma_f32_16x16x32_bf16 v[176:179], a[180:183], v[20:23], v[176:179]
ds_read_b128 a[196:199], v2 offset:1024
v_cvt_pk_bf16_f32 v200, v136, v137
v_mfma_f32_16x16x32_bf16 v[176:179], a[176:179], v[16:19], v[176:179]
s_waitcnt lgkmcnt(10)
v_exp_f32 v139, v139
v_mfma_f32_16x16x32_bf16 a[0:3], a[224:227], v[208:211], a[0:3]
v_exp_f32 v152, v152
v_mfma_f32_16x16x32_bf16 a[32:35], a[224:227], v[212:215], a[32:35]
ds_read_b128 a[200:203], v2 offset:2048
v_cvt_pk_bf16_f32 v201, v138, v139
v_mfma_f32_16x16x32_bf16 a[64:67], a[224:227], v[216:219], a[64:67]
buffer_load_dwordx4 v1, s[44:47], s72 offen offset:2048 sc1 lds
v_mfma_f32_16x16x32_bf16 a[96:99], a[224:227], v[220:223], a[96:99]
v_exp_f32 v153, v153
v_mfma_f32_16x16x32_bf16 a[100:103], a[228:231], v[220:223], a[100:103]
v_exp_f32 v154, v154
v_mfma_f32_16x16x32_bf16 a[68:71], a[228:231], v[216:219], a[68:71]
ds_read_b128 a[204:207], v2 offset:3072
v_cvt_pk_bf16_f32 v202, v152, v153
v_mfma_f32_16x16x32_bf16 a[36:39], a[228:231], v[212:215], a[36:39]
v_exp_f32 v155, v155
v_mfma_f32_16x16x32_bf16 a[4:7], a[228:231], v[208:211], a[4:7]
v_exp_f32 v140, v140
v_mfma_f32_16x16x32_bf16 a[8:11], a[232:235], v[208:211], a[8:11]
ds_read_b128 a[208:211], v2 offset:4096
v_cvt_pk_bf16_f32 v203, v154, v155
v_mfma_f32_16x16x32_bf16 a[40:43], a[232:235], v[212:215], a[40:43]
v_exp_f32 v141, v141
v_mfma_f32_16x16x32_bf16 a[72:75], a[232:235], v[216:219], a[72:75]
v_exp_f32 v142, v142
v_mfma_f32_16x16x32_bf16 a[104:107], a[232:235], v[220:223], a[104:107]
ds_read_b128 a[212:215], v2 offset:5120
v_cvt_pk_bf16_f32 v204, v140, v141
v_mfma_f32_16x16x32_bf16 a[108:111], a[236:239], v[220:223], a[108:111]
v_exp_f32 v143, v143
v_mfma_f32_16x16x32_bf16 a[76:79], a[236:239], v[216:219], a[76:79]
v_exp_f32 v156, v156
v_mfma_f32_16x16x32_bf16 a[44:47], a[236:239], v[212:215], a[44:47]
ds_read_b128 a[216:219], v2 offset:6144
v_cvt_pk_bf16_f32 v205, v142, v143
v_mfma_f32_16x16x32_bf16 a[12:15], a[236:239], v[208:211], a[12:15]
buffer_load_dwordx4 v1, s[44:47], s72 offen offset:3072 sc1 lds
v_mfma_f32_16x16x32_bf16 a[16:19], a[240:243], v[208:211], a[16:19]
v_exp_f32 v157, v157
v_mfma_f32_16x16x32_bf16 a[48:51], a[240:243], v[212:215], a[48:51]
v_exp_f32 v158, v158
v_mfma_f32_16x16x32_bf16 a[80:83], a[240:243], v[216:219], a[80:83]
ds_read_b128 a[220:223], v2 offset:7168
v_cvt_pk_bf16_f32 v206, v156, v157
v_mfma_f32_16x16x32_bf16 a[112:115], a[240:243], v[220:223], a[112:115]
v_exp_f32 v159, v159
v_mfma_f32_16x16x32_bf16 a[116:119], a[244:247], v[220:223], a[116:119]
v_cvt_pk_bf16_f32 v207, v158, v159
v_mfma_f32_16x16x32_bf16 a[84:87], a[244:247], v[216:219], a[84:87]
v_mfma_f32_16x16x32_bf16 a[52:55], a[244:247], v[212:215], a[52:55]
v_mfma_f32_16x16x32_bf16 a[20:23], a[244:247], v[208:211], a[20:23]
v_mfma_f32_16x16x32_bf16 a[24:27], a[248:251], v[208:211], a[24:27]
v_mfma_f32_16x16x32_bf16 a[56:59], a[248:251], v[212:215], a[56:59]
v_mfma_f32_16x16x32_bf16 a[88:91], a[248:251], v[216:219], a[88:91]
v_mfma_f32_16x16x32_bf16 a[120:123], a[248:251], v[220:223], a[120:123]
v_mfma_f32_16x16x32_bf16 a[124:127], a[252:255], v[220:223], a[124:127]
v_mfma_f32_16x16x32_bf16 a[92:95], a[252:255], v[216:219], a[92:95]
v_mfma_f32_16x16x32_bf16 a[60:63], a[252:255], v[212:215], a[60:63]
v_mfma_f32_16x16x32_bf16 a[28:31], a[252:255], v[208:211], a[28:31]
v_mfma_f32_16x16x32_bf16 v[224:227], v[120:123], v[208:211], v[224:227]
v_mfma_f32_16x16x32_bf16 v[228:231], v[120:123], v[212:215], v[228:231]
v_mfma_f32_16x16x32_bf16 v[232:235], v[120:123], v[216:219], v[232:235]
v_mfma_f32_16x16x32_bf16 v[236:239], v[120:123], v[220:223], v[236:239]
s_waitcnt lgkmcnt(8)
s_cmp_eq_u32 s58, 0
s_cbranch_scc1 Lta16
s_cmp_eq_u32 s58, 1
s_cbranch_scc1 Lnt17
v_mfma_f32_16x16x32_bf16 v[128:131], a[128:131], v[16:19], v[80:83]
s_add_u32 s82, s82, 0x8000
ds_read_b128 a[160:163], v2 offset:24576
v_mfma_f32_16x16x32_bf16 v[144:147], a[144:147], v[16:19], v[80:83]
s_and_b32 s82, s82, 0x1ffff
v_exp_f32 v160, v160
s_branch Ljoin18
Lta16:
v_mfma_f32_16x16x32_bf16 v[128:131], a[128:131], v[16:19], v[96:99]
s_add_u32 s82, s82, 0x8000
ds_read_b128 a[160:163], v2 offset:24576
v_mfma_f32_16x16x32_bf16 v[144:147], a[144:147], v[16:19], v[112:115]
s_and_b32 s82, s82, 0x1ffff
v_exp_f32 v160, v160
s_branch Ljoin18
Lnt17:
v_mfma_f32_16x16x32_bf16 v[128:131], a[128:131], v[16:19], v[80:83]
s_add_u32 s82, s82, 0x8000
ds_read_b128 a[160:163], v2 offset:24576
v_mfma_f32_16x16x32_bf16 v[144:147], a[144:147], v[16:19], v[96:99]
s_and_b32 s82, s82, 0x1ffff
v_exp_f32 v160, v160
Ljoin18:
v_mfma_f32_16x16x32_bf16 v[128:131], a[132:135], v[20:23], v[128:131]
s_add_u32 m0, s74, 0
v_exp_f32 v161, v161
v_mfma_f32_16x16x32_bf16 v[128:131], a[136:139], v[24:27], v[128:131]
s_add_u32 s72, s81, 0
ds_read_b128 a[164:167], v2 offset:25600
v_cvt_pk_bf16_f32 v208, v160, v161
v_mfma_f32_16x16x32_bf16 v[128:131], a[140:143], v[28:31], v[128:131]
v_exp_f32 v162, v162
v_mfma_f32_16x16x32_bf16 v[132:135], a[140:143], v[44:47], v[84:87]
v_exp_f32 v163, v163
v_mfma_f32_16x16x32_bf16 v[132:135], a[136:139], v[40:43], v[132:135]
ds_read_b128 a[168:171], v2 offset:26624
v_cvt_pk_bf16_f32 v209, v162, v163
v_mfma_f32_16x16x32_bf16 v[132:135], a[132:135], v[36:39], v[132:135]
v_exp_f32 v176, v176
v_mfma_f32_16x16x32_bf16 v[132:135], a[128:131], v[32:35], v[132:135]
buffer_load_dwordx4 v1, s[44:47], s72 offen sc1 lds
v_mfma_f32_16x16x32_bf16 v[136:139], a[128:131], v[48:51], v[88:91]
v_exp_f32 v177, v177
v_mfma_f32_16x16x32_bf16 v[136:139], a[132:135], v[52:55], v[136:139]
ds_read_b128 a[172:175], v2 offset:27648
v_cvt_pk_bf16_f32 v210, v176, v177
v_mfma_f32_16x16x32_bf16 v[136:139], a[136:139], v[56:59], v[136:139]
v_exp_f32 v178, v178
v_mfma_f32_16x16x32_bf16 v[136:139], a[140:143], v[60:63], v[136:139]
v_exp_f32 v179, v179
v_mfma_f32_16x16x32_bf16 v[140:143], a[140:143], v[76:79], v[92:95]
ds_read_b128 a[176:179], v2 offset:28672
v_cvt_pk_bf16_f32 v211, v178, v179
v_mfma_f32_16x16x32_bf16 v[140:143], a[136:139], v[72:75], v[140:143]
v_exp_f32 v164, v164
v_mfma_f32_16x16x32_bf16 v[140:143], a[132:135], v[68:71], v[140:143]
v_exp_f32 v165, v165
v_mfma_f32_16x16x32_bf16 v[140:143], a[128:131], v[64:67], v[140:143]
ds_read_b128 a[180:183], v2 offset:29696
v_cvt_pk_bf16_f32 v212, v164, v165
v_mfma_f32_16x16x32_bf16 v[156:159], a[144:147], v[64:67], v[92:95]
v_exp_f32 v166, v166
v_mfma_f32_16x16x32_bf16 v[156:159], a[148:151], v[68:71], v[156:159]
v_exp_f32 v167, v167
v_mfma_f32_16x16x32_bf16 v[156:159], a[152:155], v[72:75], v[156:159]
ds_read_b128 a[184:187], v2 offset:30720
v_cvt_pk_bf16_f32 v213, v166, v167
v_mfma_f32_16x16x32_bf16 v[156:159], a[156:159], v[76:79], v[156:159]
v_exp_f32 v180, v180
v_mfma_f32_16x16x32_bf16 v[152:155], a[156:159], v[60:63], v[88:91]
buffer_load_dwordx4 v1, s[44:47], s72 offen offset:1024 sc1 lds
v_mfma_f32_16x16x32_bf16 v[152:155], a[152:155], v[56:59], v[152:155]
v_exp_f32 v181, v181
v_mfma_f32_16x16x32_bf16 v[152:155], a[148:151], v[52:55], v[152:155]
ds_read_b128 a[188:191], v2 offset:31744
v_cvt_pk_bf16_f32 v214, v180, v181
v_mfma_f32_16x16x32_bf16 v[152:155], a[144:147], v[48:51], v[152:155]
v_exp_f32 v182, v182
v_mfma_f32_16x16x32_bf16 v[148:151], a[144:147], v[32:35], v[84:87]
v_exp_f32 v183, v183
v_mfma_f32_16x16x32_bf16 v[148:151], a[148:151], v[36:39], v[148:151]
ds_read_b128 a[224:227], v2 offset:8192
v_cvt_pk_bf16_f32 v215, v182, v183
v_mfma_f32_16x16x32_bf16 v[148:151], a[152:155], v[40:43], v[148:151]
v_exp_f32 v168, v168
v_mfma_f32_16x16x32_bf16 v[148:151], a[156:159], v[44:47], v[148:151]
v_exp_f32 v169, v169
v_mfma_f32_16x16x32_bf16 v[144:147], a[156:159], v[28:31], v[144:147]
ds_read_b128 a[228:231], v2 offset:9216
v_cvt_pk_bf16_f32 v216, v168, v169
v_mfma_f32_16x16x32_bf16 v[144:147], a[152:155], v[24:27], v[144:147]
v_exp_f32 v170, v170
v_mfma_f32_16x16x32_bf16 v[144:147], a[148:151], v[20:23], v[144:147]
s_waitcnt lgkmcnt(10)
v_exp_f32 v171, v171
v_mfma_f32_16x16x32_bf16 a[0:3], a[192:195], v[192:195], a[0:3]
ds_read_b128 a[232:235], v2 offset:10240
v_cvt_pk_bf16_f32 v217, v170, v171
v_mfma_f32_16x16x32_bf16 a[32:35], a[192:195], v[196:199], a[32:35]
v_exp_f32 v184, v184
v_mfma_f32_16x16x32_bf16 a[64:67], a[192:195], v[200:203], a[64:67]
buffer_load_dwordx4 v1, s[44:47], s72 offen offset:2048 sc1 lds
v_mfma_f32_16x16x32_bf16 a[96:99], a[192:195], v[204:207], a[96:99]
v_exp_f32 v185, v185
v_mfma_f32_16x16x32_bf16 a[100:103], a[196:199], v[204:207], a[100:103]
ds_read_b128 a[236:239], v2 offset:11264
v_cvt_pk_bf16_f32 v218, v184, v185
v_mfma_f32_16x16x32_bf16 a[68:71], a[196:199], v[200:203], a[68:71]
v_exp_f32 v186, v186
v_mfma_f32_16x16x32_bf16 a[36:39], a[196:199], v[196:199], a[36:39]
v_exp_f32 v187, v187
v_mfma_f32_16x16x32_bf16 a[4:7], a[196:199], v[192:195], a[4:7]
ds_read_b128 a[240:243], v2 offset:12288
v_cvt_pk_bf16_f32 v219, v186, v187
v_mfma_f32_16x16x32_bf16 a[8:11], a[200:203], v[192:195], a[8:11]
v_exp_f32 v172, v172
v_mfma_f32_16x16x32_bf16 a[40:43], a[200:203], v[196:199], a[40:43]
v_exp_f32 v173, v173
v_mfma_f32_16x16x32_bf16 a[72:75], a[200:203], v[200:203], a[72:75]
ds_read_b128 a[244:247], v2 offset:13312
v_cvt_pk_bf16_f32 v220, v172, v173
v_mfma_f32_16x16x32_bf16 a[104:107], a[200:203], v[204:207], a[104:107]
v_exp_f32 v174, v174
v_mfma_f32_16x16x32_bf16 a[108:111], a[204:207], v[204:207], a[108:111]
v_exp_f32 v175, v175
v_mfma_f32_16x16x32_bf16 a[76:79], a[204:207], v[200:203], a[76:79]
ds_read_b128 a[248:251], v2 offset:14336
v_cvt_pk_bf16_f32 v221, v174, v175
v_mfma_f32_16x16x32_bf16 a[44:47], a[204:207], v[196:199], a[44:47]
v_exp_f32 v188, v188
v_mfma_f32_16x16x32_bf16 a[12:15], a[204:207], v[192:195], a[12:15]
buffer_load_dwordx4 v1, s[44:47], s72 offen offset:3072 sc1 lds
v_mfma_f32_16x16x32_bf16 a[16:19], a[208:211], v[192:195], a[16:19]
v_exp_f32 v189, v189
v_mfma_f32_16x16x32_bf16 a[48:51], a[208:211], v[196:199], a[48:51]
ds_read_b128 a[252:255], v2 offset:15360
v_cvt_pk_bf16_f32 v222, v188, v189
v_mfma_f32_16x16x32_bf16 a[80:83], a[208:211], v[200:203], a[80:83]
v_exp_f32 v190, v190
v_mfma_f32_16x16x32_bf16 a[112:115], a[208:211], v[204:207], a[112:115]
v_exp_f32 v191, v191
v_mfma_f32_16x16x32_bf16 a[116:119], a[212:215], v[204:207], a[116:119]
v_cvt_pk_bf16_f32 v223, v190, v191
v_add_u32 v2, s82, v1
v_mfma_f32_16x16x32_bf16 a[84:87], a[212:215], v[200:203], a[84:87]
v_mfma_f32_16x16x32_bf16 a[52:55], a[212:215], v[196:199], a[52:55]
v_mfma_f32_16x16x32_bf16 a[20:23], a[212:215], v[192:195], a[20:23]
v_mfma_f32_16x16x32_bf16 a[24:27], a[216:219], v[192:195], a[24:27]
v_mfma_f32_16x16x32_bf16 a[56:59], a[216:219], v[196:199], a[56:59]
v_mfma_f32_16x16x32_bf16 a[88:91], a[216:219], v[200:203], a[88:91]
v_mfma_f32_16x16x32_bf16 a[120:123], a[216:219], v[204:207], a[120:123]
v_mfma_f32_16x16x32_bf16 a[124:127], a[220:223], v[204:207], a[124:127]
v_mfma_f32_16x16x32_bf16 a[92:95], a[220:223], v[200:203], a[92:95]
v_mfma_f32_16x16x32_bf16 a[60:63], a[220:223], v[196:199], a[60:63]
v_mfma_f32_16x16x32_bf16 a[28:31], a[220:223], v[192:195], a[28:31]
v_mfma_f32_16x16x32_bf16 v[224:227], v[120:123], v[192:195], v[224:227]
v_mfma_f32_16x16x32_bf16 v[228:231], v[120:123], v[196:199], v[228:231]
v_mfma_f32_16x16x32_bf16 v[232:235], v[120:123], v[200:203], v[232:235]
s_waitcnt vmcnt(8) lgkmcnt(8)
v_mfma_f32_16x16x32_bf16 v[236:239], v[120:123], v[204:207], v[236:239]
s_barrier
s_cmp_eq_u32 s58, 2
s_cbranch_scc1 Lta19
s_cmp_eq_u32 s58, 3
s_cbranch_scc1 Lnt20
v_mfma_f32_16x16x32_bf16 v[160:163], a[160:163], v[16:19], v[112:115]
s_xor_b32 s74, s82, 0x10000
v_exp_f32 v128, v128
v_mfma_f32_16x16x32_bf16 v[176:179], a[176:179], v[16:19], v[112:115]
s_add_u32 s74, s74, s64
ds_read_b128 a[128:131], v2 offset:16384
s_branch Ljoin21
Lta19:
v_mfma_f32_16x16x32_bf16 v[160:163], a[160:163], v[16:19], v[96:99]
s_xor_b32 s74, s82, 0x10000
v_exp_f32 v128, v128
v_mfma_f32_16x16x32_bf16 v[176:179], a[176:179], v[16:19], v[112:115]
s_add_u32 s74, s74, s64
ds_read_b128 a[128:131], v2 offset:16384
s_branch Ljoin21
Lnt20:
v_mfma_f32_16x16x32_bf16 v[160:163], a[160:163], v[16:19], v[80:83]
s_xor_b32 s74, s82, 0x10000
v_exp_f32 v128, v128
v_mfma_f32_16x16x32_bf16 v[176:179], a[176:179], v[16:19], v[96:99]
s_add_u32 s74, s74, s64
ds_read_b128 a[128:131], v2 offset:16384
Ljoin21:
v_mfma_f32_16x16x32_bf16 v[160:163], a[164:167], v[20:23], v[160:163]
s_add_u32 s81, s81, 0x8000
v_exp_f32 v129, v129
v_mfma_f32_16x16x32_bf16 v[160:163], a[168:171], v[24:27], v[160:163]
s_add_u32 m0, s74, 16384
v_exp_f32 v130, v130
v_mfma_f32_16x16x32_bf16 v[160:163], a[172:175], v[28:31], v[160:163]
s_add_u32 s72, s81, 16384
ds_read_b128 a[132:135], v2 offset:17408
v_cvt_pk_bf16_f32 v192, v128, v129
v_mfma_f32_16x16x32_bf16 v[164:167], a[172:175], v[44:47], v[84:87]
v_exp_f32 v131, v131
v_mfma_f32_16x16x32_bf16 v[164:167], a[168:171], v[40:43], v[164:167]
v_exp_f32 v144, v144
v_mfma_f32_16x16x32_bf16 v[164:167], a[164:167], v[36:39], v[164:167]
ds_read_b128 a[136:139], v2 offset:18432
v_cvt_pk_bf16_f32 v193, v130, v131
v_mfma_f32_16x16x32_bf16 v[164:167], a[160:163], v[32:35], v[164:167]
buffer_load_dwordx4 v1, s[44:47], s72 offen sc1 lds
v_mfma_f32_16x16x32_bf16 v[168:171], a[160:163], v[48:51], v[88:91]
v_exp_f32 v145, v145
v_mfma_f32_16x16x32_bf16 v[168:171], a[164:167], v[52:55], v[168:171]
v_exp_f32 v146, v146
v_mfma_f32_16x16x32_bf16 v[168:171], a[168:171], v[56:59], v[168:171]
ds_read_b128 a[140:143], v2 offset:19456
v_cvt_pk_bf16_f32 v194, v144, v145
v_mfma_f32_16x16x32_bf16 v[168:171], a[172:175], v[60:63], v[168:171]
v_exp_f32 v147, v147
v_mfma_f32_16x16x32_bf16 v[172:175], a[172:175], v[76:79], v[92:95]
v_exp_f32 v132, v132
v_mfma_f32_16x16x32_bf16 v[172:175], a[168:171], v[72:75], v[172:175]
ds_read_b128 a[144:147], v2 offset:20480
v_cvt_pk_bf16_f32 v195, v146, v147
v_mfma_f32_16x16x32_bf16 v[172:175], a[164:167], v[68:71], v[172:175]
v_exp_f32 v133, v133
v_mfma_f32_16x16x32_bf16 v[172:175], a[160:163], v[64:67], v[172:175]
v_exp_f32 v134, v134
v_mfma_f32_16x16x32_bf16 v[188:191], a[176:179], v[64:67], v[92:95]
ds_read_b128 a[148:151], v2 offset:21504
v_cvt_pk_bf16_f32 v196, v132, v133
v_mfma_f32_16x16x32_bf16 v[188:191], a[180:183], v[68:71], v[188:191]
v_exp_f32 v135, v135
v_mfma_f32_16x16x32_bf16 v[188:191], a[184:187], v[72:75], v[188:191]
v_exp_f32 v148, v148
v_mfma_f32_16x16x32_bf16 v[188:191], a[188:191], v[76:79], v[188:191]
ds_read_b128 a[152:155], v2 offset:22528
v_cvt_pk_bf16_f32 v197, v134, v135
v_mfma_f32_16x16x32_bf16 v[184:187], a[188:191], v[60:63], v[88:91]
buffer_load_dwordx4 v1, s[44:47], s72 offen offset:1024 sc1 lds
v_mfma_f32_16x16x32_bf16 v[184:187], a[184:187], v[56:59], v[184:187]
v_exp_f32 v149, v149
v_mfma_f32_16x16x32_bf16 v[184:187], a[180:183], v[52:55], v[184:187]
v_exp_f32 v150, v150
v_mfma_f32_16x16x32_bf16 v[184:187], a[176:179], v[48:51], v[184:187]
ds_read_b128 a[156:159], v2 offset:23552
v_cvt_pk_bf16_f32 v198, v148, v149
v_mfma_f32_16x16x32_bf16 v[180:183], a[176:179], v[32:35], v[84:87]
v_exp_f32 v151, v151
v_mfma_f32_16x16x32_bf16 v[180:183], a[180:183], v[36:39], v[180:183]
v_exp_f32 v136, v136
v_mfma_f32_16x16x32_bf16 v[180:183], a[184:187], v[40:43], v[180:183]
ds_read_b128 a[192:195], v2 offset:0
v_cvt_pk_bf16_f32 v199, v150, v151
v_mfma_f32_16x16x32_bf16 v[180:183], a[188:191], v[44:47], v[180:183]
v_exp_f32 v137, v137
v_mfma_f32_16x16x32_bf16 v[176:179], a[188:191], v[28:31], v[176:179]
v_exp_f32 v138, v138
v_mfma_f32_16x16x32_bf16 v[176:179], a[184:187], v[24:27], v[176:179]
ds_read_b128 a[196:199], v2 offset:1024
v_cvt_pk_bf16_f32 v200, v136, v137
v_mfma_f32_16x16x32_bf16 v[176:179], a[180:183], v[20:23], v[176:179]
s_waitcnt lgkmcnt(10)
v_exp_f32 v139, v139
v_mfma_f32_16x16x32_bf16 a[0:3], a[224:227], v[208:211], a[0:3]
v_exp_f32 v152, v152
v_mfma_f32_16x16x32_bf16 a[32:35], a[224:227], v[212:215], a[32:35]
ds_read_b128 a[200:203], v2 offset:2048
v_cvt_pk_bf16_f32 v201, v138, v139
v_mfma_f32_16x16x32_bf16 a[64:67], a[224:227], v[216:219], a[64:67]
buffer_load_dwordx4 v1, s[44:47], s72 offen offset:2048 sc1 lds
v_mfma_f32_16x16x32_bf16 a[96:99], a[224:227], v[220:223], a[96:99]
v_exp_f32 v153, v153
v_mfma_f32_16x16x32_bf16 a[100:103], a[228:231], v[220:223], a[100:103]
v_exp_f32 v154, v154
v_mfma_f32_16x16x32_bf16 a[68:71], a[228:231], v[216:219], a[68:71]
ds_read_b128 a[204:207], v2 offset:3072
v_cvt_pk_bf16_f32 v202, v152, v153
v_mfma_f32_16x16x32_bf16 a[36:39], a[228:231], v[212:215], a[36:39]
v_exp_f32 v155, v155
v_mfma_f32_16x16x32_bf16 a[4:7], a[228:231], v[208:211], a[4:7]
v_exp_f32 v140, v140
v_mfma_f32_16x16x32_bf16 a[8:11], a[232:235], v[208:211], a[8:11]
ds_read_b128 a[208:211], v2 offset:4096
v_cvt_pk_bf16_f32 v203, v154, v155
v_mfma_f32_16x16x32_bf16 a[40:43], a[232:235], v[212:215], a[40:43]
v_exp_f32 v141, v141
v_mfma_f32_16x16x32_bf16 a[72:75], a[232:235], v[216:219], a[72:75]
v_exp_f32 v142, v142
v_mfma_f32_16x16x32_bf16 a[104:107], a[232:235], v[220:223], a[104:107]
ds_read_b128 a[212:215], v2 offset:5120
v_cvt_pk_bf16_f32 v204, v140, v141
v_mfma_f32_16x16x32_bf16 a[108:111], a[236:239], v[220:223], a[108:111]
v_exp_f32 v143, v143
v_mfma_f32_16x16x32_bf16 a[76:79], a[236:239], v[216:219], a[76:79]
v_exp_f32 v156, v156
v_mfma_f32_16x16x32_bf16 a[44:47], a[236:239], v[212:215], a[44:47]
ds_read_b128 a[216:219], v2 offset:6144
v_cvt_pk_bf16_f32 v205, v142, v143
v_mfma_f32_16x16x32_bf16 a[12:15], a[236:239], v[208:211], a[12:15]
buffer_load_dwordx4 v1, s[44:47], s72 offen offset:3072 sc1 lds
v_mfma_f32_16x16x32_bf16 a[16:19], a[240:243], v[208:211], a[16:19]
v_exp_f32 v157, v157
v_mfma_f32_16x16x32_bf16 a[48:51], a[240:243], v[212:215], a[48:51]
v_exp_f32 v158, v158
v_mfma_f32_16x16x32_bf16 a[80:83], a[240:243], v[216:219], a[80:83]
ds_read_b128 a[220:223], v2 offset:7168
v_cvt_pk_bf16_f32 v206, v156, v157
v_mfma_f32_16x16x32_bf16 a[112:115], a[240:243], v[220:223], a[112:115]
v_exp_f32 v159, v159
v_mfma_f32_16x16x32_bf16 a[116:119], a[244:247], v[220:223], a[116:119]
v_cvt_pk_bf16_f32 v207, v158, v159
v_mfma_f32_16x16x32_bf16 a[84:87], a[244:247], v[216:219], a[84:87]
v_mfma_f32_16x16x32_bf16 a[52:55], a[244:247], v[212:215], a[52:55]
v_mfma_f32_16x16x32_bf16 a[20:23], a[244:247], v[208:211], a[20:23]
v_mfma_f32_16x16x32_bf16 a[24:27], a[248:251], v[208:211], a[24:27]
v_mfma_f32_16x16x32_bf16 a[56:59], a[248:251], v[212:215], a[56:59]
v_mfma_f32_16x16x32_bf16 a[88:91], a[248:251], v[216:219], a[88:91]
v_mfma_f32_16x16x32_bf16 a[120:123], a[248:251], v[220:223], a[120:123]
v_mfma_f32_16x16x32_bf16 a[124:127], a[252:255], v[220:223], a[124:127]
v_mfma_f32_16x16x32_bf16 a[92:95], a[252:255], v[216:219], a[92:95]
v_mfma_f32_16x16x32_bf16 a[60:63], a[252:255], v[212:215], a[60:63]
v_mfma_f32_16x16x32_bf16 a[28:31], a[252:255], v[208:211], a[28:31]
v_mfma_f32_16x16x32_bf16 v[224:227], v[120:123], v[208:211], v[224:227]
v_mfma_f32_16x16x32_bf16 v[228:231], v[120:123], v[212:215], v[228:231]
v_mfma_f32_16x16x32_bf16 v[232:235], v[120:123], v[216:219], v[232:235]
v_mfma_f32_16x16x32_bf16 v[236:239], v[120:123], v[220:223], v[236:239]
s_waitcnt lgkmcnt(8)
s_cmp_eq_u32 s58, 0
s_cbranch_scc1 Lta22
s_cmp_eq_u32 s58, 1
s_cbranch_scc1 Lnt23
v_mfma_f32_16x16x32_bf16 v[132:135], a[128:131], v[32:35], v[84:87]
s_add_u32 s82, s82, 0x8000
ds_read_b128 a[160:163], v2 offset:24576
v_mfma_f32_16x16x32_bf16 v[148:151], a[144:147], v[32:35], v[84:87]
s_and_b32 s82, s82, 0x1ffff
v_exp_f32 v160, v160
s_branch Ljoin24
Lta22:
v_mfma_f32_16x16x32_bf16 v[132:135], a[128:131], v[32:35], v[100:103]
s_add_u32 s82, s82, 0x8000
ds_read_b128 a[160:163], v2 offset:24576
v_mfma_f32_16x16x32_bf16 v[148:151], a[144:147], v[32:35], v[112:115]
s_and_b32 s82, s82, 0x1ffff
v_exp_f32 v160, v160
s_branch Ljoin24
Lnt23:
v_mfma_f32_16x16x32_bf16 v[132:135], a[128:131], v[32:35], v[84:87]
s_add_u32 s82, s82, 0x8000
ds_read_b128 a[160:163], v2 offset:24576
v_mfma_f32_16x16x32_bf16 v[148:151], a[144:147], v[32:35], v[100:103]
s_and_b32 s82, s82, 0x1ffff
v_exp_f32 v160, v160
Ljoin24:
v_mfma_f32_16x16x32_bf16 v[132:135], a[132:135], v[36:39], v[132:135]
s_add_u32 m0, s74, 0
v_exp_f32 v161, v161
v_mfma_f32_16x16x32_bf16 v[132:135], a[136:139], v[40:43], v[132:135]
s_add_u32 s72, s81, 0
ds_read_b128 a[164:167], v2 offset:25600
v_cvt_pk_bf16_f32 v208, v160, v161
v_mfma_f32_16x16x32_bf16 v[132:135], a[140:143], v[44:47], v[132:135]
v_exp_f32 v162, v162
v_mfma_f32_16x16x32_bf16 v[136:139], a[140:143], v[60:63], v[88:91]
v_exp_f32 v163, v163
v_mfma_f32_16x16x32_bf16 v[136:139], a[136:139], v[56:59], v[136:139]
ds_read_b128 a[168:171], v2 offset:26624
v_cvt_pk_bf16_f32 v209, v162, v163
v_mfma_f32_16x16x32_bf16 v[136:139], a[132:135], v[52:55], v[136:139]
v_exp_f32 v176, v176
v_mfma_f32_16x16x32_bf16 v[136:139], a[128:131], v[48:51], v[136:139]
buffer_load_dwordx4 v1, s[44:47], s72 offen sc1 lds
v_mfma_f32_16x16x32_bf16 v[140:143], a[128:131], v[64:67], v[92:95]
v_exp_f32 v177, v177
v_mfma_f32_16x16x32_bf16 v[140:143], a[132:135], v[68:71], v[140:143]
ds_read_b128 a[172:175], v2 offset:27648
v_cvt_pk_bf16_f32 v210, v176, v177
v_mfma_f32_16x16x32_bf16 v[140:143], a[136:139], v[72:75], v[140:143]
v_exp_f32 v178, v178
v_mfma_f32_16x16x32_bf16 v[140:143], a[140:143], v[76:79], v[140:143]
v_exp_f32 v179, v179
v_mfma_f32_16x16x32_bf16 v[156:159], a[156:159], v[76:79], v[92:95]
ds_read_b128 a[176:179], v2 offset:28672
v_cvt_pk_bf16_f32 v211, v178, v179
v_mfma_f32_16x16x32_bf16 v[156:159], a[152:155], v[72:75], v[156:159]
v_exp_f32 v164, v164
v_mfma_f32_16x16x32_bf16 v[156:159], a[148:151], v[68:71], v[156:159]
v_exp_f32 v165, v165
v_mfma_f32_16x16x32_bf16 v[156:159], a[144:147], v[64:67], v[156:159]
ds_read_b128 a[180:183], v2 offset:29696
v_cvt_pk_bf16_f32 v212, v164, v165
v_mfma_f32_16x16x32_bf16 v[152:155], a[144:147], v[48:51], v[88:91]
v_exp_f32 v166, v166
v_mfma_f32_16x16x32_bf16 v[152:155], a[148:151], v[52:55], v[152:155]
v_exp_f32 v167, v167
v_mfma_f32_16x16x32_bf16 v[152:155], a[152:155], v[56:59], v[152:155]
ds_read_b128 a[184:187], v2 offset:30720
v_cvt_pk_bf16_f32 v213, v166, v167
v_mfma_f32_16x16x32_bf16 v[152:155], a[156:159], v[60:63], v[152:155]
v_exp_f32 v180, v180
v_mfma_f32_16x16x32_bf16 v[148:151], a[156:159], v[44:47], v[148:151]
buffer_load_dwordx4 v1, s[44:47], s72 offen offset:1024 sc1 lds
v_mfma_f32_16x16x32_bf16 v[148:151], a[152:155], v[40:43], v[148:151]
v_exp_f32 v181, v181
v_mfma_f32_16x16x32_bf16 v[148:151], a[148:151], v[36:39], v[148:151]
s_waitcnt lgkmcnt(7)
ds_read_b128 a[188:191], v2 offset:31744
v_cvt_pk_bf16_f32 v214, v180, v181
v_mfma_f32_16x16x32_bf16 a[0:3], a[192:195], v[192:195], a[0:3]
v_exp_f32 v182, v182
v_mfma_f32_16x16x32_bf16 a[32:35], a[192:195], v[196:199], a[32:35]
v_exp_f32 v183, v183
v_mfma_f32_16x16x32_bf16 a[64:67], a[192:195], v[200:203], a[64:67]
ds_read_b128 a[224:227], v2 offset:8192
v_cvt_pk_bf16_f32 v215, v182, v183
v_mfma_f32_16x16x32_bf16 a[96:99], a[192:195], v[204:207], a[96:99]
v_exp_f32 v168, v168
v_mfma_f32_16x16x32_bf16 a[100:103], a[196:199], v[204:207], a[100:103]
v_exp_f32 v169, v169
v_mfma_f32_16x16x32_bf16 a[68:71], a[196:199], v[200:203], a[68:71]
ds_read_b128 a[228:231], v2 offset:9216
v_cvt_pk_bf16_f32 v216, v168, v169
v_mfma_f32_16x16x32_bf16 a[36:39], a[196:199], v[196:199], a[36:39]
v_exp_f32 v170, v170
v_mfma_f32_16x16x32_bf16 a[4:7], a[196:199], v[192:195], a[4:7]
v_exp_f32 v171, v171
v_mfma_f32_16x16x32_bf16 a[8:11], a[200:203], v[192:195], a[8:11]
ds_read_b128 a[232:235], v2 offset:10240
v_cvt_pk_bf16_f32 v217, v170, v171
v_mfma_f32_16x16x32_bf16 a[40:43], a[200:203], v[196:199], a[40:43]
v_exp_f32 v184, v184
v_mfma_f32_16x16x32_bf16 a[72:75], a[200:203], v[200:203], a[72:75]
buffer_load_dwordx4 v1, s[44:47], s72 offen offset:2048 sc1 lds
v_mfma_f32_16x16x32_bf16 a[104:107], a[200:203], v[204:207], a[104:107]
v_exp_f32 v185, v185
v_mfma_f32_16x16x32_bf16 a[108:111], a[204:207], v[204:207], a[108:111]
ds_read_b128 a[236:239], v2 offset:11264
v_cvt_pk_bf16_f32 v218, v184, v185
v_mfma_f32_16x16x32_bf16 a[76:79], a[204:207], v[200:203], a[76:79]
v_exp_f32 v186, v186
v_mfma_f32_16x16x32_bf16 a[44:47], a[204:207], v[196:199], a[44:47]
v_exp_f32 v187, v187
v_mfma_f32_16x16x32_bf16 a[12:15], a[204:207], v[192:195], a[12:15]
ds_read_b128 a[240:243], v2 offset:12288
v_cvt_pk_bf16_f32 v219, v186, v187
v_mfma_f32_16x16x32_bf16 a[16:19], a[208:211], v[192:195], a[16:19]
v_exp_f32 v172, v172
v_mfma_f32_16x16x32_bf16 a[48:51], a[208:211], v[196:199], a[48:51]
v_exp_f32 v173, v173
v_mfma_f32_16x16x32_bf16 a[80:83], a[208:211], v[200:203], a[80:83]
ds_read_b128 a[244:247], v2 offset:13312
v_cvt_pk_bf16_f32 v220, v172, v173
v_mfma_f32_16x16x32_bf16 a[112:115], a[208:211], v[204:207], a[112:115]
v_exp_f32 v174, v174
v_mfma_f32_16x16x32_bf16 a[116:119], a[212:215], v[204:207], a[116:119]
v_exp_f32 v175, v175
v_mfma_f32_16x16x32_bf16 a[84:87], a[212:215], v[200:203], a[84:87]
ds_read_b128 a[248:251], v2 offset:14336
v_cvt_pk_bf16_f32 v221, v174, v175
v_mfma_f32_16x16x32_bf16 a[52:55], a[212:215], v[196:199], a[52:55]
v_exp_f32 v188, v188
v_mfma_f32_16x16x32_bf16 a[20:23], a[212:215], v[192:195], a[20:23]
Lstub3:
s_cbranch_execz Lstub7
buffer_load_dwordx4 v1, s[44:47], s72 offen offset:3072 sc1 lds
v_mfma_f32_16x16x32_bf16 a[24:27], a[216:219], v[192:195], a[24:27]
v_exp_f32 v189, v189
v_mfma_f32_16x16x32_bf16 a[56:59], a[216:219], v[196:199], a[56:59]
ds_read_b128 a[252:255], v2 offset:15360
v_cvt_pk_bf16_f32 v222, v188, v189
v_mfma_f32_16x16x32_bf16 a[88:91], a[216:219], v[200:203], a[88:91]
v_exp_f32 v190, v190
v_mfma_f32_16x16x32_bf16 a[120:123], a[216:219], v[204:207], a[120:123]
v_exp_f32 v191, v191
v_mfma_f32_16x16x32_bf16 a[124:127], a[220:223], v[204:207], a[124:127]
v_cvt_pk_bf16_f32 v223, v190, v191
v_add_u32 v2, s82, v1
v_mfma_f32_16x16x32_bf16 a[92:95], a[220:223], v[200:203], a[92:95]
v_mfma_f32_16x16x32_bf16 a[60:63], a[220:223], v[196:199], a[60:63]
v_mfma_f32_16x16x32_bf16 a[28:31], a[220:223], v[192:195], a[28:31]
v_mfma_f32_16x16x32_bf16 v[224:227], v[120:123], v[192:195], v[224:227]
v_mfma_f32_16x16x32_bf16 v[228:231], v[120:123], v[196:199], v[228:231]
v_mfma_f32_16x16x32_bf16 v[232:235], v[120:123], v[200:203], v[232:235]
s_waitcnt vmcnt(8) lgkmcnt(8)
v_mfma_f32_16x16x32_bf16 v[236:239], v[120:123], v[204:207], v[236:239]
s_barrier
s_cmp_eq_u32 s60, 7
s_cbranch_scc1 LLT3x
LLT3:
Lstub4:
s_cbranch_execz Lstub8
s_cmp_eq_u32 s58, 2
s_cbranch_scc1 Lta25
s_cmp_eq_u32 s58, 3
s_cbranch_scc1 Lnt26
v_mfma_f32_16x16x32_bf16 v[164:167], a[160:163], v[32:35], v[112:115]
s_xor_b32 s74, s82, 0x10000
v_exp_f32 v132, v132
v_mfma_f32_16x16x32_bf16 v[180:183], a[176:179], v[32:35], v[112:115]
s_add_u32 s74, s74, s64
ds_read_b128 a[128:131], v2 offset:16384
s_branch Ljoin27
Lta25:
v_mfma_f32_16x16x32_bf16 v[164:167], a[160:163], v[32:35], v[100:103]
s_xor_b32 s74, s82, 0x10000
v_exp_f32 v132, v132
v_mfma_f32_16x16x32_bf16 v[180:183], a[176:179], v[32:35], v[112:115]
s_add_u32 s74, s74, s64
ds_read_b128 a[128:131], v2 offset:16384
s_branch Ljoin27
Lnt26:
v_mfma_f32_16x16x32_bf16 v[164:167], a[160:163], v[32:35], v[84:87]
s_xor_b32 s74, s82, 0x10000
v_exp_f32 v132, v132
v_mfma_f32_16x16x32_bf16 v[180:183], a[176:179], v[32:35], v[100:103]
s_add_u32 s74, s74, s64
ds_read_b128 a[128:131], v2 offset:16384
Ljoin27:
v_mfma_f32_16x16x32_bf16 v[164:167], a[164:167], v[36:39], v[164:167]
s_add_u32 s81, s81, 0x8000
v_exp_f32 v133, v133
v_mfma_f32_16x16x32_bf16 v[164:167], a[168:171], v[40:43], v[164:167]
s_add_u32 m0, s74, 16384
ds_read_b128 a[132:135], v2 offset:17408
v_cvt_pk_bf16_f32 v196, v132, v133
v_mfma_f32_16x16x32_bf16 v[164:167], a[172:175], v[44:47], v[164:167]
s_add_u32 s72, s81, 16384
buffer_load_dwordx4 v1, s[44:47], s72 offen sc1 lds
v_mfma_f32_16x16x32_bf16 v[168:171], a[172:175], v[60:63], v[88:91]
s_add_u32 s69, s93, 0x3e00000
v_exp_f32 v134, v134
v_mfma_f32_16x16x32_bf16 v[168:171], a[168:171], v[56:59], v[168:171]
v_exp_f32 v135, v135
v_mfma_f32_16x16x32_bf16 v[168:171], a[164:167], v[52:55], v[168:171]
ds_read_b128 a[136:139], v2 offset:18432
v_cvt_pk_bf16_f32 v197, v134, v135
v_mfma_f32_16x16x32_bf16 v[168:171], a[160:163], v[48:51], v[168:171]
v_exp_f32 v148, v148
v_mfma_f32_16x16x32_bf16 v[172:175], a[160:163], v[64:67], v[92:95]
ds_read_b128 a[140:143], v2 offset:19456
v_bfe_u32 v251, v0, 2, 2
v_mfma_f32_16x16x32_bf16 v[172:175], a[164:167], v[68:71], v[172:175]
buffer_store_dwordx4 v[112:115], v1, s[44:47], s69 offen sc1
v_mfma_f32_16x16x32_bf16 v[172:175], a[168:171], v[72:75], v[172:175]
v_exp_f32 v149, v149
v_mfma_f32_16x16x32_bf16 v[172:175], a[172:175], v[76:79], v[172:175]
v_exp_f32 v150, v150
v_mfma_f32_16x16x32_bf16 v[188:191], a[188:191], v[76:79], v[92:95]
ds_read_b128 a[144:147], v2 offset:20480
v_cvt_pk_bf16_f32 v198, v148, v149
v_mfma_f32_16x16x32_bf16 v[188:191], a[184:187], v[72:75], v[188:191]
v_exp_f32 v151, v151
v_mfma_f32_16x16x32_bf16 v[188:191], a[180:183], v[68:71], v[188:191]
ds_read_b128 a[148:151], v2 offset:21504
v_cvt_pk_bf16_f32 v199, v150, v151
v_mfma_f32_16x16x32_bf16 v[188:191], a[176:179], v[64:67], v[188:191]
buffer_load_dwordx4 v1, s[44:47], s72 offen offset:1024 sc1 lds
v_mfma_f32_16x16x32_bf16 v[184:187], a[176:179], v[48:51], v[88:91]
v_exp_f32 v136, v136
v_mfma_f32_16x16x32_bf16 v[184:187], a[180:183], v[52:55], v[184:187]
v_exp_f32 v137, v137
v_mfma_f32_16x16x32_bf16 v[184:187], a[184:187], v[56:59], v[184:187]
ds_read_b128 a[152:155], v2 offset:22528
v_cvt_pk_bf16_f32 v200, v136, v137
v_mfma_f32_16x16x32_bf16 v[184:187], a[188:191], v[60:63], v[184:187]
v_exp_f32 v138, v138
v_mfma_f32_16x16x32_bf16 v[180:183], a[188:191], v[44:47], v[180:183]
ds_read_b128 a[156:159], v2 offset:23552
v_lshl_add_u32 v6, v248, 3, v6
v_mfma_f32_16x16x32_bf16 v[180:183], a[184:187], v[40:43], v[180:183]
buffer_store_dwordx4 v[112:115], v1, s[44:47], s69 offen offset:1024 sc1
v_mfma_f32_16x16x32_bf16 v[180:183], a[180:183], v[36:39], v[180:183]
s_waitcnt lgkmcnt(8)
v_exp_f32 v139, v139
v_mfma_f32_16x16x32_bf16 a[0:3], a[224:227], v[208:211], a[0:3]
v_exp_f32 v152, v152
v_mfma_f32_16x16x32_bf16 a[32:35], a[224:227], v[212:215], a[32:35]
ds_read_b128 a[192:195], v2 offset:0
v_cvt_pk_bf16_f32 v201, v138, v139
v_mfma_f32_16x16x32_bf16 a[64:67], a[224:227], v[216:219], a[64:67]
v_exp_f32 v153, v153
v_mfma_f32_16x16x32_bf16 a[96:99], a[224:227], v[220:223], a[96:99]
ds_read_b128 a[196:199], v2 offset:1024
v_cvt_pk_bf16_f32 v202, v152, v153
v_mfma_f32_16x16x32_bf16 a[100:103], a[228:231], v[220:223], a[100:103]
buffer_load_dwordx4 v1, s[44:47], s72 offen offset:2048 sc1 lds
v_mfma_f32_16x16x32_bf16 a[68:71], a[228:231], v[216:219], a[68:71]
v_exp_f32 v154, v154
v_mfma_f32_16x16x32_bf16 a[36:39], a[228:231], v[212:215], a[36:39]
v_exp_f32 v155, v155
v_mfma_f32_16x16x32_bf16 a[4:7], a[228:231], v[208:211], a[4:7]
ds_read_b128 a[200:203], v2 offset:2048
v_cvt_pk_bf16_f32 v203, v154, v155
v_mfma_f32_16x16x32_bf16 a[8:11], a[232:235], v[208:211], a[8:11]
v_exp_f32 v140, v140
v_mfma_f32_16x16x32_bf16 a[40:43], a[232:235], v[212:215], a[40:43]
ds_read_b128 a[204:207], v2 offset:3072
v_lshl_add_u32 v6, v241, 4, v6
v_mfma_f32_16x16x32_bf16 a[72:75], a[232:235], v[216:219], a[72:75]
buffer_store_dwordx4 v[112:115], v1, s[44:47], s69 offen offset:2048 sc1
v_mfma_f32_16x16x32_bf16 a[104:107], a[232:235], v[220:223], a[104:107]
v_exp_f32 v141, v141
v_mfma_f32_16x16x32_bf16 a[108:111], a[236:239], v[220:223], a[108:111]
v_exp_f32 v142, v142
v_mfma_f32_16x16x32_bf16 a[76:79], a[236:239], v[216:219], a[76:79]
ds_read_b128 a[208:211], v2 offset:4096
v_cvt_pk_bf16_f32 v204, v140, v141
v_mfma_f32_16x16x32_bf16 a[44:47], a[236:239], v[212:215], a[44:47]
v_exp_f32 v143, v143
v_mfma_f32_16x16x32_bf16 a[12:15], a[236:239], v[208:211], a[12:15]
ds_read_b128 a[212:215], v2 offset:5120
v_cvt_pk_bf16_f32 v205, v142, v143
v_mfma_f32_16x16x32_bf16 a[16:19], a[240:243], v[208:211], a[16:19]
buffer_load_dwordx4 v1, s[44:47], s72 offen offset:3072 sc1 lds
v_mfma_f32_16x16x32_bf16 a[48:51], a[240:243], v[212:215], a[48:51]
v_exp_f32 v156, v156
v_mfma_f32_16x16x32_bf16 a[80:83], a[240:243], v[216:219], a[80:83]
v_exp_f32 v157, v157
v_mfma_f32_16x16x32_bf16 a[112:115], a[240:243], v[220:223], a[112:115]
ds_read_b128 a[216:219], v2 offset:6144
v_cvt_pk_bf16_f32 v206, v156, v157
v_mfma_f32_16x16x32_bf16 a[116:119], a[244:247], v[220:223], a[116:119]
v_exp_f32 v158, v158
v_mfma_f32_16x16x32_bf16 a[84:87], a[244:247], v[216:219], a[84:87]
ds_read_b128 a[220:223], v2 offset:7168
v_lshlrev_b32 v5, 3, v251
v_mfma_f32_16x16x32_bf16 a[52:55], a[244:247], v[212:215], a[52:55]
buffer_store_dwordx4 v[112:115], v1, s[44:47], s69 offen offset:3072 sc1
v_mfma_f32_16x16x32_bf16 a[20:23], a[244:247], v[208:211], a[20:23]
v_exp_f32 v159, v159
v_mfma_f32_16x16x32_bf16 a[24:27], a[248:251], v[208:211], a[24:27]
v_cvt_pk_bf16_f32 v207, v158, v159
v_lshrrev_b32 v5, v5, v252
v_mfma_f32_16x16x32_bf16 a[56:59], a[248:251], v[212:215], a[56:59]
v_and_b32 v5, 3, v5
v_cmp_ne_u32 vcc, 1, v251
v_mfma_f32_16x16x32_bf16 a[88:91], a[248:251], v[216:219], a[88:91]
v_mul_u32_u24 v5, 16640, v5
v_add_u32 v5, s92, v5
v_mfma_f32_16x16x32_bf16 a[120:123], a[248:251], v[220:223], a[120:123]
v_cndmask_b32 v5, v250, v5, vcc
v_add_u32 v253, s58, v251
v_mfma_f32_16x16x32_bf16 a[124:127], a[252:255], v[220:223], a[124:127]
v_and_b32 v253, 3, v253
v_mul_u32_u24 v253, 4160, v253
v_mfma_f32_16x16x32_bf16 a[92:95], a[252:255], v[216:219], a[92:95]
v_add_u32 v5, v5, v253
v_mfma_f32_16x16x32_bf16 a[60:63], a[252:255], v[212:215], a[60:63]
s_add_u32 s73, s62, 480
v_lshlrev_b32 v248, 5, v240
v_sub_u32 v248, s73, v248
v_mfma_f32_16x16x32_bf16 a[28:31], a[252:255], v[208:211], a[28:31]
v_lshl_add_u32 v7, v241, 4, v248
v_mfma_f32_16x16x32_bf16 v[224:227], v[120:123], v[208:211], v[224:227]
s_and_b32 s73, s58, 1
v_mfma_f32_16x16x32_bf16 v[228:231], v[120:123], v[212:215], v[228:231]
s_lshl_b32 s73, s73, 4
v_mfma_f32_16x16x32_bf16 v[232:235], v[120:123], v[216:219], v[232:235]
s_lshr_b32 s73, s90, s73
v_mfma_f32_16x16x32_bf16 v[236:239], v[120:123], v[220:223], v[236:239]
s_waitcnt lgkmcnt(8)
v_mfma_f32_16x16x32_bf16 v[136:139], a[128:131], v[48:51], v[88:91]
s_add_u32 s82, s82, 0x8000
ds_read_b128 a[160:163], v2 offset:24576
ds_read_b128 a[164:167], v2 offset:25600
v_mfma_f32_16x16x32_bf16 v[136:139], a[132:135], v[52:55], v[136:139]
s_and_b32 s82, s82, 0x1ffff
v_exp_f32 v164, v164
v_mfma_f32_16x16x32_bf16 v[136:139], a[136:139], v[56:59], v[136:139]
s_add_u32 m0, s74, 0
v_exp_f32 v165, v165
v_mfma_f32_16x16x32_bf16 v[136:139], a[140:143], v[60:63], v[136:139]
s_add_u32 s72, s81, 0
v_exp_f32 v166, v166
v_mfma_f32_16x16x32_bf16 v[140:143], a[140:143], v[76:79], v[92:95]
ds_read_b128 a[168:171], v2 offset:26624
v_cvt_pk_bf16_f32 v212, v164, v165
v_mfma_f32_16x16x32_bf16 v[140:143], a[136:139], v[72:75], v[140:143]
v_exp_f32 v167, v167
v_mfma_f32_16x16x32_bf16 v[140:143], a[132:135], v[68:71], v[140:143]
buffer_load_dwordx4 v1, s[44:47], s72 offen sc1 lds
v_mfma_f32_16x16x32_bf16 v[140:143], a[128:131], v[64:67], v[140:143]
v_exp_f32 v180, v180
v_mfma_f32_16x16x32_bf16 v[156:159], a[144:147], v[64:67], v[92:95]
ds_read_b128 a[172:175], v2 offset:27648
v_cvt_pk_bf16_f32 v213, v166, v167
v_mfma_f32_16x16x32_bf16 v[156:159], a[148:151], v[68:71], v[156:159]
v_exp_f32 v181, v181
v_mfma_f32_16x16x32_bf16 v[156:159], a[152:155], v[72:75], v[156:159]
ds_read_b128 a[176:179], v2 offset:28672
v_cvt_pk_bf16_f32 v214, v180, v181
v_mfma_f32_16x16x32_bf16 v[156:159], a[156:159], v[76:79], v[156:159]
v_exp_f32 v182, v182
v_mfma_f32_16x16x32_bf16 v[152:155], a[156:159], v[60:63], v[88:91]
v_exp_f32 v183, v183
v_mfma_f32_16x16x32_bf16 v[152:155], a[152:155], v[56:59], v[152:155]
ds_read_b128 a[180:183], v2 offset:29696
v_cvt_pk_bf16_f32 v215, v182, v183
v_mfma_f32_16x16x32_bf16 v[152:155], a[148:151], v[52:55], v[152:155]
v_exp_f32 v168, v168
v_mfma_f32_16x16x32_bf16 v[152:155], a[144:147], v[48:51], v[152:155]
s_waitcnt lgkmcnt(6)
ds_read_b128 a[184:187], v2 offset:30720
ds_read_b128 a[188:191], v2 offset:31744
v_mfma_f32_16x16x32_bf16 a[32:35], a[192:195], v[196:199], a[32:35]
v_exp_f32 v169, v169
v_mfma_f32_16x16x32_bf16 a[64:67], a[192:195], v[200:203], a[64:67]
buffer_load_dwordx4 v1, s[44:47], s72 offen offset:1024 sc1 lds
v_mfma_f32_16x16x32_bf16 a[96:99], a[192:195], v[204:207], a[96:99]
v_exp_f32 v170, v170
v_mfma_f32_16x16x32_bf16 a[100:103], a[196:199], v[204:207], a[100:103]
v_exp_f32 v171, v171
v_mfma_f32_16x16x32_bf16 a[68:71], a[196:199], v[200:203], a[68:71]
ds_read_b128 a[224:227], v2 offset:8192
v_cvt_pk_bf16_f32 v216, v168, v169
v_mfma_f32_16x16x32_bf16 a[36:39], a[196:199], v[196:199], a[36:39]
v_exp_f32 v184, v184
v_mfma_f32_16x16x32_bf16 a[40:43], a[200:203], v[196:199], a[40:43]
v_exp_f32 v185, v185
v_mfma_f32_16x16x32_bf16 a[72:75], a[200:203], v[200:203], a[72:75]
ds_read_b128 a[228:231], v2 offset:9216
v_cvt_pk_bf16_f32 v217, v170, v171
v_mfma_f32_16x16x32_bf16 a[104:107], a[200:203], v[204:207], a[104:107]
v_exp_f32 v186, v186
v_mfma_f32_16x16x32_bf16 a[108:111], a[204:207], v[204:207], a[108:111]
ds_read_b128 a[232:235], v2 offset:10240
v_cvt_pk_bf16_f32 v218, v184, v185
v_mfma_f32_16x16x32_bf16 a[76:79], a[204:207], v[200:203], a[76:79]
v_exp_f32 v187, v187
v_mfma_f32_16x16x32_bf16 a[44:47], a[204:207], v[196:199], a[44:47]
buffer_load_dwordx4 v1, s[44:47], s72 offen offset:2048 sc1 lds
v_mfma_f32_16x16x32_bf16 a[48:51], a[208:211], v[196:199], a[48:51]
v_exp_f32 v172, v172
v_mfma_f32_16x16x32_bf16 a[80:83], a[208:211], v[200:203], a[80:83]
ds_read_b128 a[236:239], v2 offset:11264
v_cvt_pk_bf16_f32 v219, v186, v187
v_mfma_f32_16x16x32_bf16 a[112:115], a[208:211], v[204:207], a[112:115]
v_exp_f32 v173, v173
v_mfma_f32_16x16x32_bf16 a[116:119], a[212:215], v[204:207], a[116:119]
ds_read_b128 a[240:243], v2 offset:12288
v_cvt_pk_bf16_f32 v220, v172, v173
v_mfma_f32_16x16x32_bf16 a[84:87], a[212:215], v[200:203], a[84:87]
v_exp_f32 v174, v174
v_mfma_f32_16x16x32_bf16 a[52:55], a[212:215], v[196:199], a[52:55]
v_exp_f32 v175, v175
v_mfma_f32_16x16x32_bf16 a[56:59], a[216:219], v[196:199], a[56:59]
ds_read_b128 a[244:247], v2 offset:13312
v_cvt_pk_bf16_f32 v221, v174, v175
v_mfma_f32_16x16x32_bf16 a[88:91], a[216:219], v[200:203], a[88:91]
v_exp_f32 v188, v188
v_mfma_f32_16x16x32_bf16 a[120:123], a[216:219], v[204:207], a[120:123]
ds_read_b128 a[248:251], v2 offset:14336
v_mfma_f32_16x16x32_bf16 a[124:127], a[220:223], v[204:207], a[124:127]
v_exp_f32 v189, v189
v_mfma_f32_16x16x32_bf16 a[92:95], a[220:223], v[200:203], a[92:95]
buffer_load_dwordx4 v1, s[44:47], s72 offen offset:3072 sc1 lds
v_mfma_f32_16x16x32_bf16 a[60:63], a[220:223], v[196:199], a[60:63]
ds_read_b128 a[252:255], v2 offset:15360
v_cvt_pk_bf16_f32 v222, v188, v189
v_mfma_f32_16x16x32_bf16 v[228:231], v[120:123], v[196:199], v[228:231]
v_exp_f32 v190, v190
v_mfma_f32_16x16x32_bf16 v[232:235], v[120:123], v[200:203], v[232:235]
s_waitcnt vmcnt(12) lgkmcnt(8)
v_exp_f32 v191, v191
v_mfma_f32_16x16x32_bf16 v[236:239], v[120:123], v[204:207], v[236:239]
s_barrier
v_cvt_pk_bf16_f32 v223, v190, v191
v_add_u32 v2, s82, v1
v_mfma_f32_16x16x32_bf16 v[168:171], a[160:163], v[48:51], v[88:91]
s_xor_b32 s74, s82, 0x10000
v_exp_f32 v136, v136
v_mfma_f32_16x16x32_bf16 v[168:171], a[164:167], v[52:55], v[168:171]
s_add_u32 s74, s74, s64
ds_read_b128 a[128:131], v2 offset:16384
v_mfma_f32_16x16x32_bf16 v[168:171], a[168:171], v[56:59], v[168:171]
s_add_u32 s81, s81, 0x8000
v_exp_f32 v137, v137
v_mfma_f32_16x16x32_bf16 v[168:171], a[172:175], v[60:63], v[168:171]
s_add_u32 m0, s74, 16384
ds_read_b128 a[132:135], v2 offset:17408
v_cvt_pk_bf16_f32 v200, v136, v137
v_mfma_f32_16x16x32_bf16 v[172:175], a[172:175], v[76:79], v[92:95]
s_add_u32 s72, s81, 16384
buffer_load_dwordx4 v1, s[44:47], s72 offen sc1 lds
v_mfma_f32_16x16x32_bf16 v[172:175], a[168:171], v[72:75], v[172:175]
s_add_u32 s69, s93, 0x4200000
v_exp_f32 v138, v138
v_mfma_f32_16x16x32_bf16 v[172:175], a[164:167], v[68:71], v[172:175]
s_and_b32 s73, s73, 0xffff
ds_read_b128 a[136:139], v2 offset:18432
v_lshl_add_u32 v248, v241, 3, v240
v_mfma_f32_16x16x32_bf16 v[172:175], a[160:163], v[64:67], v[172:175]
v_exp_f32 v139, v139
v_mfma_f32_16x16x32_bf16 v[188:191], a[176:179], v[64:67], v[92:95]
ds_read_b128 a[140:143], v2 offset:19456
v_cvt_pk_bf16_f32 v201, v138, v139
v_mfma_f32_16x16x32_bf16 v[188:191], a[180:183], v[68:71], v[188:191]
buffer_store_dwordx4 v[112:115], v1, s[44:47], s69 offen sc1
v_mfma_f32_16x16x32_bf16 v[188:191], a[184:187], v[72:75], v[188:191]
v_exp_f32 v152, v152
v_mfma_f32_16x16x32_bf16 v[188:191], a[188:191], v[76:79], v[188:191]
ds_read_b128 a[144:147], v2 offset:20480
v_sub_u32 v248, 15, v248
v_mfma_f32_16x16x32_bf16 v[184:187], a[188:191], v[60:63], v[88:91]
v_exp_f32 v153, v153
v_mfma_f32_16x16x32_bf16 v[184:187], a[184:187], v[56:59], v[184:187]
ds_read_b128 a[148:151], v2 offset:21504
v_cvt_pk_bf16_f32 v202, v152, v153
v_mfma_f32_16x16x32_bf16 v[184:187], a[180:183], v[52:55], v[184:187]
buffer_load_dwordx4 v1, s[44:47], s72 offen offset:1024 sc1 lds
v_mfma_f32_16x16x32_bf16 v[184:187], a[176:179], v[48:51], v[184:187]
s_waitcnt lgkmcnt(6)
v_exp_f32 v154, v154
v_mfma_f32_16x16x32_bf16 a[32:35], a[224:227], v[212:215], a[32:35]
ds_read_b128 a[152:155], v2 offset:22528
v_and_b32 v249, 1, v248
v_mfma_f32_16x16x32_bf16 a[64:67], a[224:227], v[216:219], a[64:67]
v_exp_f32 v155, v155
v_mfma_f32_16x16x32_bf16 a[96:99], a[224:227], v[220:223], a[96:99]
ds_read_b128 a[156:159], v2 offset:23552
v_cvt_pk_bf16_f32 v203, v154, v155
v_mfma_f32_16x16x32_bf16 a[100:103], a[228:231], v[220:223], a[100:103]
buffer_store_dwordx4 v[112:115], v1, s[44:47], s69 offen offset:1024 sc1
v_mfma_f32_16x16x32_bf16 a[68:71], a[228:231], v[216:219], a[68:71]
v_exp_f32 v140, v140
v_mfma_f32_16x16x32_bf16 a[36:39], a[228:231], v[212:215], a[36:39]
ds_read_b128 a[192:195], v2 offset:0
v_lshlrev_b32 v249, 4, v249
v_mfma_f32_16x16x32_bf16 a[40:43], a[232:235], v[212:215], a[40:43]
v_exp_f32 v141, v141
v_mfma_f32_16x16x32_bf16 a[72:75], a[232:235], v[216:219], a[72:75]
ds_read_b128 a[196:199], v2 offset:1024
v_cvt_pk_bf16_f32 v204, v140, v141
v_mfma_f32_16x16x32_bf16 a[104:107], a[232:235], v[220:223], a[104:107]
buffer_load_dwordx4 v1, s[44:47], s72 offen offset:2048 sc1 lds
v_mfma_f32_16x16x32_bf16 a[108:111], a[236:239], v[220:223], a[108:111]
v_exp_f32 v142, v142
v_mfma_f32_16x16x32_bf16 a[76:79], a[236:239], v[216:219], a[76:79]
ds_read_b128 a[200:203], v2 offset:2048
v_lshlrev_b32 v249, v249, s73
v_mfma_f32_16x16x32_bf16 a[44:47], a[236:239], v[212:215], a[44:47]
v_exp_f32 v143, v143
v_mfma_f32_16x16x32_bf16 a[48:51], a[240:243], v[212:215], a[48:51]
ds_read_b128 a[204:207], v2 offset:3072
v_cvt_pk_bf16_f32 v205, v142, v143
v_mfma_f32_16x16x32_bf16 a[80:83], a[240:243], v[216:219], a[80:83]
buffer_store_dwordx4 v[112:115], v1, s[44:47], s69 offen offset:2048 sc1
v_mfma_f32_16x16x32_bf16 a[112:115], a[240:243], v[220:223], a[112:115]
v_exp_f32 v156, v156
v_mfma_f32_16x16x32_bf16 a[116:119], a[244:247], v[220:223], a[116:119]
ds_read_b128 a[208:211], v2 offset:4096
v_lshrrev_b32 v248, 1, v248
v_mfma_f32_16x16x32_bf16 a[84:87], a[244:247], v[216:219], a[84:87]
v_exp_f32 v157, v157
v_mfma_f32_16x16x32_bf16 a[52:55], a[244:247], v[212:215], a[52:55]
ds_read_b128 a[212:215], v2 offset:5120
v_cvt_pk_bf16_f32 v206, v156, v157
v_mfma_f32_16x16x32_bf16 a[56:59], a[248:251], v[212:215], a[56:59]
buffer_load_dwordx4 v1, s[44:47], s72 offen offset:3072 sc1 lds
v_mfma_f32_16x16x32_bf16 a[88:91], a[248:251], v[216:219], a[88:91]
v_exp_f32 v158, v158
v_mfma_f32_16x16x32_bf16 a[120:123], a[248:251], v[220:223], a[120:123]
ds_read_b128 a[216:219], v2 offset:6144
v_and_b32 v241, 3, v0
v_mfma_f32_16x16x32_bf16 a[124:127], a[252:255], v[220:223], a[124:127]
v_exp_f32 v159, v159
v_mfma_f32_16x16x32_bf16 a[92:95], a[252:255], v[216:219], a[92:95]
ds_read_b128 a[220:223], v2 offset:7168
v_cvt_pk_bf16_f32 v207, v158, v159
v_mfma_f32_16x16x32_bf16 a[60:63], a[252:255], v[212:215], a[60:63]
buffer_store_dwordx4 v[112:115], v1, s[44:47], s69 offen offset:3072 sc1
v_mfma_f32_16x16x32_bf16 v[228:231], v[120:123], v[212:215], v[228:231]
v_cmp_eq_u32 vcc, 0, v248
v_lshl_add_u32 v5, v241, 3, v5
v_mfma_f32_16x16x32_bf16 v[232:235], v[120:123], v[216:219], v[232:235]
v_cndmask_b32 v8, 0, v249, vcc
v_cmp_eq_u32 vcc, 1, v248
v_mfma_f32_16x16x32_bf16 v[236:239], v[120:123], v[220:223], v[236:239]
s_waitcnt lgkmcnt(8)
v_lshlrev_b32 v240, 4, v251
v_cndmask_b32 v9, 0, v249, vcc
v_cmp_eq_u32 vcc, 2, v248
v_sub_u32 v240, 48, v240
v_lshlrev_b64 v[12:13], 16, s[88:89]
v_cndmask_b32 v10, 0, v249, vcc
v_cmp_eq_u32 vcc, 3, v248
v_lshlrev_b64 v[12:13], v240, v[12:13]
s_nop 0
v_cndmask_b32 v11, 0, v249, vcc
v_cmp_eq_u32 vcc, 3, v241
s_add_u32 s73, s62, 4096
v_lshl_add_u32 v14, v0, 3, s73
v_cndmask_b32 v12, 0, v12, vcc
v_cndmask_b32 v13, 0, v13, vcc
v_lshrrev_b32 v15, 4, v0
v_lshlrev_b32 v15, 1, v15
v_and_b32 v240, 7, v0
v_xor_b32 v15, v15, v240
v_lshlrev_b32 v15, 4, v15
v_lshrrev_b32 v240, 3, v0
v_lshl_add_u32 v15, v240, 11, v15
s_lshr_b32 s75, s59, 1
s_and_b32 s75, s75, 8
s_add_u32 s75, s75, s60
s_lshl_b32 s76, s65, 2
s_lshr_b32 s80, s59, 2
s_and_b32 s80, s80, 3
s_add_u32 s76, s76, s80
s_lshl_b32 s94, s58, 16
s_lshl_b32 s80, s76, 7
s_add_u32 s94, s94, s80
s_lshl_b32 s80, s75, 18
s_add_u32 s80, s80, s94
v_rcp_f32 v224, v224
v_rcp_f32 v228, v228
s_lshl_b32 s73, s59, 12
s_add_u32 s73, s73, 0x2000000
s_lshl_b32 s70, s67, 2
s_add_u32 s70, s70, s73
v_mov_b32 v225, v224
v_accvgpr_read_b32 v240, a0
v_accvgpr_read_b32 v241, a1
v_accvgpr_read_b32 v242, a2
v_accvgpr_read_b32 v243, a3
v_accvgpr_read_b32 v244, a4
v_accvgpr_read_b32 v245, a5
v_accvgpr_read_b32 v246, a6
v_accvgpr_read_b32 v247, a7
v_pk_mul_f32 v[240:241], v[240:241], v[224:225]
v_pk_mul_f32 v[242:243], v[242:243], v[224:225]
v_pk_mul_f32 v[244:245], v[244:245], v[224:225]
v_pk_mul_f32 v[246:247], v[246:247], v[224:225]
v_cvt_pk_bf16_f32 v128, v240, v241
v_cvt_pk_bf16_f32 v129, v242, v243
v_cvt_pk_bf16_f32 v130, v244, v245
v_cvt_pk_bf16_f32 v131, v246, v247
v_accvgpr_read_b32 v248, a8
v_accvgpr_read_b32 v249, a9
v_accvgpr_read_b32 v250, a10
v_accvgpr_read_b32 v251, a11
v_accvgpr_read_b32 v252, a12
v_accvgpr_read_b32 v253, a13
v_accvgpr_read_b32 v254, a14
v_accvgpr_read_b32 v255, a15
v_pk_mul_f32 v[248:249], v[248:249], v[224:225]
v_pk_mul_f32 v[250:251], v[250:251], v[224:225]
v_pk_mul_f32 v[252:253], v[252:253], v[224:225]
v_pk_mul_f32 v[254:255], v[254:255], v[224:225]
v_cvt_pk_bf16_f32 v144, v248, v249
v_cvt_pk_bf16_f32 v145, v250, v251
v_cvt_pk_bf16_f32 v146, v252, v253
v_cvt_pk_bf16_f32 v147, v254, v255
v_accvgpr_read_b32 v240, a16
v_accvgpr_read_b32 v241, a17
v_accvgpr_read_b32 v242, a18
v_accvgpr_read_b32 v243, a19
v_accvgpr_read_b32 v244, a20
v_accvgpr_read_b32 v245, a21
v_accvgpr_read_b32 v246, a22
v_accvgpr_read_b32 v247, a23
v_pk_mul_f32 v[240:241], v[240:241], v[224:225]
v_pk_mul_f32 v[242:243], v[242:243], v[224:225]
v_pk_mul_f32 v[244:245], v[244:245], v[224:225]
v_pk_mul_f32 v[246:247], v[246:247], v[224:225]
v_cvt_pk_bf16_f32 v160, v240, v241
v_cvt_pk_bf16_f32 v161, v242, v243
v_cvt_pk_bf16_f32 v162, v244, v245
v_cvt_pk_bf16_f32 v163, v246, v247
v_accvgpr_read_b32 v248, a24
v_accvgpr_read_b32 v249, a25
v_accvgpr_read_b32 v250, a26
v_accvgpr_read_b32 v251, a27
v_accvgpr_read_b32 v252, a28
v_accvgpr_read_b32 v253, a29
v_accvgpr_read_b32 v254, a30
v_accvgpr_read_b32 v255, a31
v_pk_mul_f32 v[248:249], v[248:249], v[224:225]
v_pk_mul_f32 v[250:251], v[250:251], v[224:225]
v_pk_mul_f32 v[252:253], v[252:253], v[224:225]
v_pk_mul_f32 v[254:255], v[254:255], v[224:225]
v_cvt_pk_bf16_f32 v176, v248, v249
v_cvt_pk_bf16_f32 v177, v250, v251
v_cvt_pk_bf16_f32 v178, v252, v253
v_cvt_pk_bf16_f32 v179, v254, v255
v_mov_b32 v229, v228
v_accvgpr_read_b32 v240, a32
v_accvgpr_read_b32 v241, a33
v_accvgpr_read_b32 v242, a34
v_accvgpr_read_b32 v243, a35
v_accvgpr_read_b32 v244, a36
v_accvgpr_read_b32 v245, a37
v_accvgpr_read_b32 v246, a38
v_accvgpr_read_b32 v247, a39
v_pk_mul_f32 v[240:241], v[240:241], v[228:229]
v_pk_mul_f32 v[242:243], v[242:243], v[228:229]
v_pk_mul_f32 v[244:245], v[244:245], v[228:229]
v_pk_mul_f32 v[246:247], v[246:247], v[228:229]
v_cvt_pk_bf16_f32 v132, v240, v241
v_cvt_pk_bf16_f32 v133, v242, v243
v_cvt_pk_bf16_f32 v134, v244, v245
v_cvt_pk_bf16_f32 v135, v246, v247
v_accvgpr_read_b32 v248, a40
v_accvgpr_read_b32 v249, a41
v_accvgpr_read_b32 v250, a42
v_accvgpr_read_b32 v251, a43
v_accvgpr_read_b32 v252, a44
v_accvgpr_read_b32 v253, a45
v_accvgpr_read_b32 v254, a46
v_accvgpr_read_b32 v255, a47
v_pk_mul_f32 v[248:249], v[248:249], v[228:229]
v_pk_mul_f32 v[250:251], v[250:251], v[228:229]
v_pk_mul_f32 v[252:253], v[252:253], v[228:229]
v_pk_mul_f32 v[254:255], v[254:255], v[228:229]
v_cvt_pk_bf16_f32 v148, v248, v249
v_cvt_pk_bf16_f32 v149, v250, v251
v_cvt_pk_bf16_f32 v150, v252, v253
v_cvt_pk_bf16_f32 v151, v254, v255
v_accvgpr_read_b32 v240, a48
v_accvgpr_read_b32 v241, a49
v_accvgpr_read_b32 v242, a50
v_accvgpr_read_b32 v243, a51
v_accvgpr_read_b32 v244, a52
v_accvgpr_read_b32 v245, a53
v_accvgpr_read_b32 v246, a54
v_accvgpr_read_b32 v247, a55
v_pk_mul_f32 v[240:241], v[240:241], v[228:229]
v_pk_mul_f32 v[242:243], v[242:243], v[228:229]
v_pk_mul_f32 v[244:245], v[244:245], v[228:229]
v_pk_mul_f32 v[246:247], v[246:247], v[228:229]
v_cvt_pk_bf16_f32 v164, v240, v241
v_cvt_pk_bf16_f32 v165, v242, v243
v_cvt_pk_bf16_f32 v166, v244, v245
v_cvt_pk_bf16_f32 v167, v246, v247
v_accvgpr_read_b32 v248, a56
v_accvgpr_read_b32 v249, a57
v_accvgpr_read_b32 v250, a58
v_accvgpr_read_b32 v251, a59
v_accvgpr_read_b32 v252, a60
v_accvgpr_read_b32 v253, a61
v_accvgpr_read_b32 v254, a62
v_accvgpr_read_b32 v255, a63
v_pk_mul_f32 v[248:249], v[248:249], v[228:229]
v_pk_mul_f32 v[250:251], v[250:251], v[228:229]
v_pk_mul_f32 v[252:253], v[252:253], v[228:229]
v_pk_mul_f32 v[254:255], v[254:255], v[228:229]
v_cvt_pk_bf16_f32 v180, v248, v249
v_cvt_pk_bf16_f32 v181, v250, v251
v_cvt_pk_bf16_f32 v182, v252, v253
v_cvt_pk_bf16_f32 v183, v254, v255
v_mfma_f32_16x16x32_bf16 v[136:139], a[128:131], v[48:51], v[88:91]
s_add_u32 s82, s82, 0x8000
ds_read_b128 a[160:163], v2 offset:24576
ds_read_b128 a[164:167], v2 offset:25600
v_mfma_f32_16x16x32_bf16 v[136:139], a[132:135], v[52:55], v[136:139]
s_and_b32 s82, s82, 0x1ffff
v_exp_f32 v168, v168
v_mfma_f32_16x16x32_bf16 v[136:139], a[136:139], v[56:59], v[136:139]
s_add_u32 m0, s74, 0
v_exp_f32 v169, v169
v_mfma_f32_16x16x32_bf16 v[136:139], a[140:143], v[60:63], v[136:139]
s_add_u32 s72, s81, 0
buffer_load_dwordx4 v1, s[44:47], s72 offen sc1 lds
v_mfma_f32_16x16x32_bf16 v[140:143], a[140:143], v[76:79], v[92:95]
Lstub5:
s_cbranch_execz Lstub9
ds_read_b128 a[168:171], v2 offset:26624
v_cvt_pk_bf16_f32 v216, v168, v169
v_mfma_f32_16x16x32_bf16 v[140:143], a[136:139], v[72:75], v[140:143]
v_exp_f32 v170, v170
v_mfma_f32_16x16x32_bf16 v[140:143], a[132:135], v[68:71], v[140:143]
ds_read_b128 a[172:175], v2 offset:27648
ds_read_b128 a[176:179], v2 offset:28672
v_mfma_f32_16x16x32_bf16 v[140:143], a[128:131], v[64:67], v[140:143]
v_exp_f32 v171, v171
v_mfma_f32_16x16x32_bf16 v[156:159], a[144:147], v[64:67], v[92:95]
v_exp_f32 v184, v184
v_mfma_f32_16x16x32_bf16 v[156:159], a[148:151], v[68:71], v[156:159]
buffer_store_dwordx4 v[128:131], v1, s[44:47], s70 offen sc1
v_mfma_f32_16x16x32_bf16 v[156:159], a[152:155], v[72:75], v[156:159]
ds_read_b128 a[180:183], v2 offset:29696
v_cvt_pk_bf16_f32 v217, v170, v171
v_mfma_f32_16x16x32_bf16 v[156:159], a[156:159], v[76:79], v[156:159]
v_exp_f32 v185, v185
v_mfma_f32_16x16x32_bf16 v[152:155], a[156:159], v[60:63], v[88:91]
ds_read_b128 a[184:187], v2 offset:30720
v_cvt_pk_bf16_f32 v218, v184, v185
v_mfma_f32_16x16x32_bf16 v[152:155], a[152:155], v[56:59], v[152:155]
v_exp_f32 v186, v186
v_mfma_f32_16x16x32_bf16 v[152:155], a[148:151], v[52:55], v[152:155]
buffer_load_dwordx4 v1, s[44:47], s72 offen offset:1024 sc1 lds
v_mfma_f32_16x16x32_bf16 v[152:155], a[144:147], v[48:51], v[152:155]
s_waitcnt lgkmcnt(7)
ds_read_b128 a[188:191], v2 offset:31744
ds_read_b128 a[224:227], v2 offset:8192
v_mfma_f32_16x16x32_bf16 a[64:67], a[192:195], v[200:203], a[64:67]
v_exp_f32 v187, v187
v_mfma_f32_16x16x32_bf16 a[96:99], a[192:195], v[204:207], a[96:99]
v_exp_f32 v172, v172
v_mfma_f32_16x16x32_bf16 a[100:103], a[196:199], v[204:207], a[100:103]
ds_read_b128 a[228:231], v2 offset:9216
v_cvt_pk_bf16_f32 v219, v186, v187
v_mfma_f32_16x16x32_bf16 a[68:71], a[196:199], v[200:203], a[68:71]
v_exp_f32 v173, v173
v_mfma_f32_16x16x32_bf16 a[72:75], a[200:203], v[200:203], a[72:75]
buffer_store_dwordx4 v[144:147], v1, s[44:47], s70 offen offset:1024 sc1
v_mfma_f32_16x16x32_bf16 a[104:107], a[200:203], v[204:207], a[104:107]
ds_read_b128 a[232:235], v2 offset:10240
v_cvt_pk_bf16_f32 v220, v172, v173
v_mfma_f32_16x16x32_bf16 a[108:111], a[204:207], v[204:207], a[108:111]
v_exp_f32 v174, v174
v_mfma_f32_16x16x32_bf16 a[76:79], a[204:207], v[200:203], a[76:79]
ds_read_b128 a[236:239], v2 offset:11264
ds_read_b128 a[240:243], v2 offset:12288
v_mfma_f32_16x16x32_bf16 a[80:83], a[208:211], v[200:203], a[80:83]
v_exp_f32 v175, v175
v_mfma_f32_16x16x32_bf16 a[112:115], a[208:211], v[204:207], a[112:115]
buffer_load_dwordx4 v1, s[44:47], s72 offen offset:2048 sc1 lds
v_mfma_f32_16x16x32_bf16 a[116:119], a[212:215], v[204:207], a[116:119]
v_exp_f32 v188, v188
v_mfma_f32_16x16x32_bf16 a[84:87], a[212:215], v[200:203], a[84:87]
ds_read_b128 a[244:247], v2 offset:13312
v_cvt_pk_bf16_f32 v221, v174, v175
v_mfma_f32_16x16x32_bf16 a[88:91], a[216:219], v[200:203], a[88:91]
v_exp_f32 v189, v189
v_mfma_f32_16x16x32_bf16 a[120:123], a[216:219], v[204:207], a[120:123]
ds_read_b128 a[248:251], v2 offset:14336
ds_read_b128 a[252:255], v2 offset:15360
v_mfma_f32_16x16x32_bf16 a[124:127], a[220:223], v[204:207], a[124:127]
v_exp_f32 v190, v190
v_mfma_f32_16x16x32_bf16 a[92:95], a[220:223], v[200:203], a[92:95]
buffer_load_dwordx4 v1, s[44:47], s72 offen offset:3072 sc1 lds
v_mfma_f32_16x16x32_bf16 v[232:235], v[120:123], v[200:203], v[232:235]
s_waitcnt vmcnt(14) lgkmcnt(8)
v_exp_f32 v191, v191
v_mfma_f32_16x16x32_bf16 v[236:239], v[120:123], v[204:207], v[236:239]
s_barrier
v_cvt_pk_bf16_f32 v222, v188, v189
v_cvt_pk_bf16_f32 v223, v190, v191
v_add_u32 v2, s82, v1
v_mfma_f32_16x16x32_bf16 v[168:171], a[160:163], v[48:51], v[88:91]
s_xor_b32 s74, s82, 0x10000
v_exp_f32 v136, v136
v_mfma_f32_16x16x32_bf16 v[168:171], a[164:167], v[52:55], v[168:171]
s_add_u32 s74, s74, s64
ds_read_b128 a[128:131], v2 offset:16384
ds_read_b128 a[132:135], v2 offset:17408
v_mfma_f32_16x16x32_bf16 v[168:171], a[168:171], v[56:59], v[168:171]
s_add_u32 s81, s81, 0x8000
v_exp_f32 v137, v137
v_mfma_f32_16x16x32_bf16 v[168:171], a[172:175], v[60:63], v[168:171]
s_add_u32 m0, s74, 16384
v_exp_f32 v138, v138
v_mfma_f32_16x16x32_bf16 v[172:175], a[172:175], v[76:79], v[92:95]
s_add_u32 s72, s81, 16384
buffer_load_dwordx4 v1, s[44:47], s72 offen sc1 lds
v_mfma_f32_16x16x32_bf16 v[172:175], a[168:171], v[72:75], v[172:175]
ds_read_b128 a[136:139], v2 offset:18432
v_cvt_pk_bf16_f32 v200, v136, v137
v_mfma_f32_16x16x32_bf16 v[172:175], a[164:167], v[68:71], v[172:175]
v_exp_f32 v139, v139
v_mfma_f32_16x16x32_bf16 v[172:175], a[160:163], v[64:67], v[172:175]
ds_read_b128 a[140:143], v2 offset:19456
v_cvt_pk_bf16_f32 v201, v138, v139
v_mfma_f32_16x16x32_bf16 v[188:191], a[176:179], v[64:67], v[92:95]
buffer_store_dwordx4 v[160:163], v1, s[44:47], s70 offen offset:2048 sc1
v_mfma_f32_16x16x32_bf16 v[188:191], a[180:183], v[68:71], v[188:191]
v_exp_f32 v152, v152
v_mfma_f32_16x16x32_bf16 v[188:191], a[184:187], v[72:75], v[188:191]
ds_read_b128 a[144:147], v2 offset:20480
ds_read_b128 a[148:151], v2 offset:21504
v_mfma_f32_16x16x32_bf16 v[188:191], a[188:191], v[76:79], v[188:191]
v_exp_f32 v153, v153
v_mfma_f32_16x16x32_bf16 v[184:187], a[188:191], v[60:63], v[88:91]
buffer_load_dwordx4 v1, s[44:47], s72 offen offset:1024 sc1 lds
v_mfma_f32_16x16x32_bf16 v[184:187], a[184:187], v[56:59], v[184:187]
v_exp_f32 v154, v154
v_mfma_f32_16x16x32_bf16 v[184:187], a[180:183], v[52:55], v[184:187]
ds_read_b128 a[152:155], v2 offset:22528
v_cvt_pk_bf16_f32 v202, v152, v153
v_mfma_f32_16x16x32_bf16 v[184:187], a[176:179], v[48:51], v[184:187]
s_waitcnt lgkmcnt(7)
v_exp_f32 v155, v155
v_mfma_f32_16x16x32_bf16 a[64:67], a[224:227], v[216:219], a[64:67]
ds_read_b128 a[156:159], v2 offset:23552
v_cvt_pk_bf16_f32 v203, v154, v155
v_mfma_f32_16x16x32_bf16 a[96:99], a[224:227], v[220:223], a[96:99]
v_exp_f32 v140, v140
v_mfma_f32_16x16x32_bf16 a[100:103], a[228:231], v[220:223], a[100:103]
ds_read_b128 a[192:195], v2 offset:0
ds_read_b128 a[196:199], v2 offset:1024
v_mfma_f32_16x16x32_bf16 a[68:71], a[228:231], v[216:219], a[68:71]
buffer_store_dwordx4 v[176:179], v1, s[44:47], s70 offen offset:3072 sc1
v_mfma_f32_16x16x32_bf16 a[72:75], a[232:235], v[216:219], a[72:75]
v_exp_f32 v141, v141
v_mfma_f32_16x16x32_bf16 a[104:107], a[232:235], v[220:223], a[104:107]
v_exp_f32 v142, v142
v_mfma_f32_16x16x32_bf16 a[108:111], a[236:239], v[220:223], a[108:111]
ds_read_b128 a[200:203], v2 offset:2048
ds_read_b128 a[204:207], v2 offset:3072
v_mfma_f32_16x16x32_bf16 a[76:79], a[236:239], v[216:219], a[76:79]
buffer_load_dwordx4 v1, s[44:47], s72 offen offset:2048 sc1 lds
v_mfma_f32_16x16x32_bf16 a[80:83], a[240:243], v[216:219], a[80:83]
s_add_u32 s70, s70, 0x80000
v_exp_f32 v143, v143
v_mfma_f32_16x16x32_bf16 a[112:115], a[240:243], v[220:223], a[112:115]
v_exp_f32 v156, v156
v_mfma_f32_16x16x32_bf16 a[116:119], a[244:247], v[220:223], a[116:119]
ds_read_b128 a[208:211], v2 offset:4096
ds_read_b128 a[212:215], v2 offset:5120
v_mfma_f32_16x16x32_bf16 a[84:87], a[244:247], v[216:219], a[84:87]
ds_read_b128 a[216:219], v2 offset:6144
ds_read_b128 a[220:223], v2 offset:7168
v_mfma_f32_16x16x32_bf16 a[88:91], a[248:251], v[216:219], a[88:91]
v_cvt_pk_bf16_f32 v204, v140, v141
v_cvt_pk_bf16_f32 v205, v142, v143
v_mfma_f32_16x16x32_bf16 a[120:123], a[248:251], v[220:223], a[120:123]
buffer_store_dwordx4 v[132:135], v1, s[44:47], s70 offen sc1
v_mfma_f32_16x16x32_bf16 a[124:127], a[252:255], v[220:223], a[124:127]
v_exp_f32 v157, v157
v_mfma_f32_16x16x32_bf16 a[92:95], a[252:255], v[216:219], a[92:95]
v_exp_f32 v158, v158
v_mfma_f32_16x16x32_bf16 v[232:235], v[120:123], v[216:219], v[232:235]
buffer_load_dwordx4 v1, s[44:47], s72 offen offset:3072 sc1 lds
v_mfma_f32_16x16x32_bf16 v[236:239], v[120:123], v[220:223], v[236:239]
s_waitcnt lgkmcnt(8)
v_exp_f32 v159, v159
v_cvt_pk_bf16_f32 v206, v156, v157
v_cvt_pk_bf16_f32 v207, v158, v159
v_mfma_f32_16x16x32_bf16 v[136:139], a[128:131], v[48:51], v[88:91]
s_add_u32 s82, s82, 0x8000
ds_read_b128 a[160:163], v2 offset:24576
ds_read_b128 a[164:167], v2 offset:25600
v_mfma_f32_16x16x32_bf16 v[136:139], a[132:135], v[52:55], v[136:139]
s_and_b32 s82, s82, 0x1ffff
v_exp_f32 v168, v168
v_mfma_f32_16x16x32_bf16 v[136:139], a[136:139], v[56:59], v[136:139]
s_add_u32 m0, s74, 0
v_exp_f32 v169, v169
v_mfma_f32_16x16x32_bf16 v[136:139], a[140:143], v[60:63], v[136:139]
s_add_u32 s72, s81, 0
buffer_load_dwordx4 v1, s[44:47], s72 offen sc1 lds
v_mfma_f32_16x16x32_bf16 v[140:143], a[140:143], v[76:79], v[92:95]
ds_read_b128 a[168:171], v2 offset:26624
v_cvt_pk_bf16_f32 v216, v168, v169
v_mfma_f32_16x16x32_bf16 v[140:143], a[136:139], v[72:75], v[140:143]
v_exp_f32 v170, v170
v_mfma_f32_16x16x32_bf16 v[140:143], a[132:135], v[68:71], v[140:143]
ds_read_b128 a[172:175], v2 offset:27648
ds_read_b128 a[176:179], v2 offset:28672
v_mfma_f32_16x16x32_bf16 v[140:143], a[128:131], v[64:67], v[140:143]
v_exp_f32 v171, v171
v_mfma_f32_16x16x32_bf16 v[156:159], a[144:147], v[64:67], v[92:95]
buffer_store_dwordx4 v[148:151], v1, s[44:47], s70 offen offset:1024 sc1
v_mfma_f32_16x16x32_bf16 v[156:159], a[148:151], v[68:71], v[156:159]
v_exp_f32 v184, v184
v_mfma_f32_16x16x32_bf16 v[156:159], a[152:155], v[72:75], v[156:159]
ds_read_b128 a[180:183], v2 offset:29696
v_cvt_pk_bf16_f32 v217, v170, v171
v_mfma_f32_16x16x32_bf16 v[156:159], a[156:159], v[76:79], v[156:159]
v_exp_f32 v185, v185
v_mfma_f32_16x16x32_bf16 v[152:155], a[156:159], v[60:63], v[88:91]
buffer_load_dwordx4 v1, s[44:47], s72 offen offset:1024 sc1 lds
v_mfma_f32_16x16x32_bf16 v[152:155], a[152:155], v[56:59], v[152:155]
ds_read_b128 a[184:187], v2 offset:30720
v_cvt_pk_bf16_f32 v218, v184, v185
v_mfma_f32_16x16x32_bf16 v[152:155], a[148:151], v[52:55], v[152:155]
v_exp_f32 v186, v186
v_mfma_f32_16x16x32_bf16 v[152:155], a[144:147], v[48:51], v[152:155]
s_waitcnt lgkmcnt(7)
ds_read_b128 a[188:191], v2 offset:31744
ds_read_b128 a[224:227], v2 offset:8192
v_mfma_f32_16x16x32_bf16 a[64:67], a[192:195], v[200:203], a[64:67]
v_exp_f32 v187, v187
v_mfma_f32_16x16x32_bf16 a[96:99], a[192:195], v[204:207], a[96:99]
buffer_store_dwordx4 v[164:167], v1, s[44:47], s70 offen offset:2048 sc1
v_mfma_f32_16x16x32_bf16 a[100:103], a[196:199], v[204:207], a[100:103]
v_exp_f32 v172, v172
v_mfma_f32_16x16x32_bf16 a[68:71], a[196:199], v[200:203], a[68:71]
ds_read_b128 a[228:231], v2 offset:9216
v_cvt_pk_bf16_f32 v219, v186, v187
v_mfma_f32_16x16x32_bf16 a[72:75], a[200:203], v[200:203], a[72:75]
v_exp_f32 v173, v173
v_mfma_f32_16x16x32_bf16 a[104:107], a[200:203], v[204:207], a[104:107]
ds_read_b128 a[232:235], v2 offset:10240
ds_read_b128 a[236:239], v2 offset:11264
v_mfma_f32_16x16x32_bf16 a[108:111], a[204:207], v[204:207], a[108:111]
v_exp_f32 v174, v174
v_mfma_f32_16x16x32_bf16 a[76:79], a[204:207], v[200:203], a[76:79]
buffer_load_dwordx4 v1, s[44:47], s72 offen offset:2048 sc1 lds
v_mfma_f32_16x16x32_bf16 a[80:83], a[208:211], v[200:203], a[80:83]
v_exp_f32 v175, v175
v_mfma_f32_16x16x32_bf16 a[112:115], a[208:211], v[204:207], a[112:115]
ds_read_b128 a[240:243], v2 offset:12288
ds_read_b128 a[244:247], v2 offset:13312
v_mfma_f32_16x16x32_bf16 a[116:119], a[212:215], v[204:207], a[116:119]
v_exp_f32 v188, v188
v_mfma_f32_16x16x32_bf16 a[84:87], a[212:215], v[200:203], a[84:87]
ds_read_b128 a[248:251], v2 offset:14336
ds_read_b128 a[252:255], v2 offset:15360
v_mfma_f32_16x16x32_bf16 a[88:91], a[216:219], v[200:203], a[88:91]
v_cvt_pk_bf16_f32 v220, v172, v173
v_cvt_pk_bf16_f32 v221, v174, v175
v_mfma_f32_16x16x32_bf16 a[120:123], a[216:219], v[204:207], a[120:123]
buffer_store_dwordx4 v[180:183], v1, s[44:47], s70 offen offset:3072 sc1
v_mfma_f32_16x16x32_bf16 a[124:127], a[220:223], v[204:207], a[124:127]
v_exp_f32 v189, v189
v_mfma_f32_16x16x32_bf16 a[92:95], a[220:223], v[200:203], a[92:95]
buffer_load_dwordx4 v1, s[44:47], s72 offen offset:3072 sc1 lds
v_mfma_f32_16x16x32_bf16 v[232:235], v[120:123], v[200:203], v[232:235]
s_waitcnt vmcnt(14) lgkmcnt(8)
v_exp_f32 v190, v190
v_mfma_f32_16x16x32_bf16 v[236:239], v[120:123], v[204:207], v[236:239]
s_barrier
v_exp_f32 v191, v191
v_add_u32 v2, s82, v1
v_cvt_pk_bf16_f32 v222, v188, v189
v_cvt_pk_bf16_f32 v223, v190, v191
s_lshl_b32 s83, s60, 2
s_sub_u32 s83, s83, 25
.p2align 5
s_nop 0
s_nop 0
LloopII:
v_mfma_f32_16x16x32_bf16 v[168:171], a[160:163], v[48:51], v[88:91]
s_xor_b32 s74, s82, 0x10000
v_exp_f32 v136, v136
v_mfma_f32_16x16x32_bf16 v[168:171], a[164:167], v[52:55], v[168:171]
s_add_u32 s74, s74, s64
ds_read_b128 a[128:131], v2 offset:16384
ds_read_b128 a[132:135], v2 offset:17408
v_mfma_f32_16x16x32_bf16 v[168:171], a[168:171], v[56:59], v[168:171]
s_add_u32 s81, s81, 0x8000
v_exp_f32 v137, v137
v_mfma_f32_16x16x32_bf16 v[168:171], a[172:175], v[60:63], v[168:171]
s_add_u32 m0, s74, 16384
v_exp_f32 v138, v138
v_mfma_f32_16x16x32_bf16 v[172:175], a[172:175], v[76:79], v[92:95]
s_add_u32 s72, s81, 16384
ds_read_b128 a[136:139], v2 offset:18432
v_cvt_pk_bf16_f32 v200, v136, v137
v_mfma_f32_16x16x32_bf16 v[172:175], a[168:171], v[72:75], v[172:175]
buffer_load_dwordx4 v1, s[44:47], s72 offen sc1 lds
v_mfma_f32_16x16x32_bf16 v[172:175], a[164:167], v[68:71], v[172:175]
v_exp_f32 v139, v139
v_mfma_f32_16x16x32_bf16 v[172:175], a[160:163], v[64:67], v[172:175]
ds_read_b128 a[140:143], v2 offset:19456
v_cvt_pk_bf16_f32 v201, v138, v139
v_mfma_f32_16x16x32_bf16 v[188:191], a[176:179], v[64:67], v[92:95]
v_exp_f32 v152, v152
v_mfma_f32_16x16x32_bf16 v[188:191], a[180:183], v[68:71], v[188:191]
ds_read_b128 a[144:147], v2 offset:20480
ds_read_b128 a[148:151], v2 offset:21504
v_mfma_f32_16x16x32_bf16 v[188:191], a[184:187], v[72:75], v[188:191]
v_exp_f32 v153, v153
v_mfma_f32_16x16x32_bf16 v[188:191], a[188:191], v[76:79], v[188:191]
v_exp_f32 v154, v154
v_mfma_f32_16x16x32_bf16 v[184:187], a[188:191], v[60:63], v[88:91]
ds_read_b128 a[152:155], v2 offset:22528
v_cvt_pk_bf16_f32 v202, v152, v153
v_mfma_f32_16x16x32_bf16 v[184:187], a[184:187], v[56:59], v[184:187]
buffer_load_dwordx4 v1, s[44:47], s72 offen offset:1024 sc1 lds
v_mfma_f32_16x16x32_bf16 v[184:187], a[180:183], v[52:55], v[184:187]
v_exp_f32 v155, v155
v_mfma_f32_16x16x32_bf16 v[184:187], a[176:179], v[48:51], v[184:187]
s_waitcnt lgkmcnt(7)
ds_read_b128 a[156:159], v2 offset:23552
v_cvt_pk_bf16_f32 v203, v154, v155
v_mfma_f32_16x16x32_bf16 a[64:67], a[224:227], v[216:219], a[64:67]
v_exp_f32 v140, v140
v_mfma_f32_16x16x32_bf16 a[96:99], a[224:227], v[220:223], a[96:99]
ds_read_b128 a[192:195], v2 offset:0
ds_read_b128 a[196:199], v2 offset:1024
v_mfma_f32_16x16x32_bf16 a[100:103], a[228:231], v[220:223], a[100:103]
v_exp_f32 v141, v141
v_mfma_f32_16x16x32_bf16 a[68:71], a[228:231], v[216:219], a[68:71]
v_exp_f32 v142, v142
v_mfma_f32_16x16x32_bf16 a[72:75], a[232:235], v[216:219], a[72:75]
ds_read_b128 a[200:203], v2 offset:2048
v_cvt_pk_bf16_f32 v204, v140, v141
v_mfma_f32_16x16x32_bf16 a[104:107], a[232:235], v[220:223], a[104:107]
buffer_load_dwordx4 v1, s[44:47], s72 offen offset:2048 sc1 lds
v_mfma_f32_16x16x32_bf16 a[108:111], a[236:239], v[220:223], a[108:111]
v_exp_f32 v143, v143
v_mfma_f32_16x16x32_bf16 a[76:79], a[236:239], v[216:219], a[76:79]
ds_read_b128 a[204:207], v2 offset:3072
v_cvt_pk_bf16_f32 v205, v142, v143
v_mfma_f32_16x16x32_bf16 a[80:83], a[240:243], v[216:219], a[80:83]
v_exp_f32 v156, v156
v_mfma_f32_16x16x32_bf16 a[112:115], a[240:243], v[220:223], a[112:115]
ds_read_b128 a[208:211], v2 offset:4096
v_mfma_f32_16x16x32_bf16 a[116:119], a[244:247], v[220:223], a[116:119]
v_exp_f32 v157, v157
v_mfma_f32_16x16x32_bf16 a[84:87], a[244:247], v[216:219], a[84:87]
ds_read_b128 a[212:215], v2 offset:5120
v_cvt_pk_bf16_f32 v206, v156, v157
v_mfma_f32_16x16x32_bf16 a[88:91], a[248:251], v[216:219], a[88:91]
v_exp_f32 v158, v158
v_mfma_f32_16x16x32_bf16 a[120:123], a[248:251], v[220:223], a[120:123]
ds_read_b128 a[216:219], v2 offset:6144
v_mfma_f32_16x16x32_bf16 a[124:127], a[252:255], v[220:223], a[124:127]
buffer_load_dwordx4 v1, s[44:47], s72 offen offset:3072 sc1 lds
v_mfma_f32_16x16x32_bf16 a[92:95], a[252:255], v[216:219], a[92:95]
v_exp_f32 v159, v159
v_mfma_f32_16x16x32_bf16 v[232:235], v[120:123], v[216:219], v[232:235]
ds_read_b128 a[220:223], v2 offset:7168
v_cvt_pk_bf16_f32 v207, v158, v159
v_mfma_f32_16x16x32_bf16 v[236:239], v[120:123], v[220:223], v[236:239]
s_waitcnt lgkmcnt(8)
v_mfma_f32_16x16x32_bf16 v[136:139], a[128:131], v[48:51], v[88:91]
s_add_u32 s82, s82, 0x8000
ds_read_b128 a[160:163], v2 offset:24576
ds_read_b128 a[164:167], v2 offset:25600
v_mfma_f32_16x16x32_bf16 v[136:139], a[132:135], v[52:55], v[136:139]
s_and_b32 s82, s82, 0x1ffff
v_exp_f32 v168, v168
v_mfma_f32_16x16x32_bf16 v[136:139], a[136:139], v[56:59], v[136:139]
s_add_u32 m0, s74, 0
v_exp_f32 v169, v169
v_mfma_f32_16x16x32_bf16 v[136:139], a[140:143], v[60:63], v[136:139]
s_add_u32 s72, s81, 0
ds_read_b128 a[168:171], v2 offset:26624
v_cvt_pk_bf16_f32 v216, v168, v169
v_mfma_f32_16x16x32_bf16 v[140:143], a[140:143], v[76:79], v[92:95]
v_exp_f32 v170, v170
v_mfma_f32_16x16x32_bf16 v[140:143], a[136:139], v[72:75], v[140:143]
buffer_load_dwordx4 v1, s[44:47], s72 offen sc1 lds
v_mfma_f32_16x16x32_bf16 v[140:143], a[132:135], v[68:71], v[140:143]
ds_read_b128 a[172:175], v2 offset:27648
ds_read_b128 a[176:179], v2 offset:28672
v_mfma_f32_16x16x32_bf16 v[140:143], a[128:131], v[64:67], v[140:143]
v_exp_f32 v171, v171
v_mfma_f32_16x16x32_bf16 v[156:159], a[144:147], v[64:67], v[92:95]
v_exp_f32 v184, v184
v_mfma_f32_16x16x32_bf16 v[156:159], a[148:151], v[68:71], v[156:159]
ds_read_b128 a[180:183], v2 offset:29696
v_cvt_pk_bf16_f32 v217, v170, v171
v_mfma_f32_16x16x32_bf16 v[156:159], a[152:155], v[72:75], v[156:159]
v_exp_f32 v185, v185
v_mfma_f32_16x16x32_bf16 v[156:159], a[156:159], v[76:79], v[156:159]
ds_read_b128 a[184:187], v2 offset:30720
v_cvt_pk_bf16_f32 v218, v184, v185
v_mfma_f32_16x16x32_bf16 v[152:155], a[156:159], v[60:63], v[88:91]
buffer_load_dwordx4 v1, s[44:47], s72 offen offset:1024 sc1 lds
v_mfma_f32_16x16x32_bf16 v[152:155], a[152:155], v[56:59], v[152:155]
v_exp_f32 v186, v186
v_mfma_f32_16x16x32_bf16 v[152:155], a[148:151], v[52:55], v[152:155]
ds_read_b128 a[188:191], v2 offset:31744
ds_read_b128 a[224:227], v2 offset:8192
v_mfma_f32_16x16x32_bf16 v[152:155], a[144:147], v[48:51], v[152:155]
s_waitcnt lgkmcnt(9)
v_exp_f32 v187, v187
v_mfma_f32_16x16x32_bf16 a[64:67], a[192:195], v[200:203], a[64:67]
v_exp_f32 v172, v172
v_mfma_f32_16x16x32_bf16 a[96:99], a[192:195], v[204:207], a[96:99]
ds_read_b128 a[228:231], v2 offset:9216
v_cvt_pk_bf16_f32 v219, v186, v187
v_mfma_f32_16x16x32_bf16 a[100:103], a[196:199], v[204:207], a[100:103]
v_exp_f32 v173, v173
v_mfma_f32_16x16x32_bf16 a[68:71], a[196:199], v[200:203], a[68:71]
ds_read_b128 a[232:235], v2 offset:10240
v_cvt_pk_bf16_f32 v220, v172, v173
v_mfma_f32_16x16x32_bf16 a[72:75], a[200:203], v[200:203], a[72:75]
buffer_load_dwordx4 v1, s[44:47], s72 offen offset:2048 sc1 lds
v_mfma_f32_16x16x32_bf16 a[104:107], a[200:203], v[204:207], a[104:107]
v_exp_f32 v174, v174
v_mfma_f32_16x16x32_bf16 a[108:111], a[204:207], v[204:207], a[108:111]
ds_read_b128 a[236:239], v2 offset:11264
ds_read_b128 a[240:243], v2 offset:12288
v_mfma_f32_16x16x32_bf16 a[76:79], a[204:207], v[200:203], a[76:79]
v_exp_f32 v175, v175
v_mfma_f32_16x16x32_bf16 a[80:83], a[208:211], v[200:203], a[80:83]
v_exp_f32 v188, v188
v_mfma_f32_16x16x32_bf16 a[112:115], a[208:211], v[204:207], a[112:115]
ds_read_b128 a[244:247], v2 offset:13312
v_cvt_pk_bf16_f32 v221, v174, v175
v_mfma_f32_16x16x32_bf16 a[116:119], a[212:215], v[204:207], a[116:119]
v_exp_f32 v189, v189
v_mfma_f32_16x16x32_bf16 a[84:87], a[212:215], v[200:203], a[84:87]
ds_read_b128 a[248:251], v2 offset:14336
v_cvt_pk_bf16_f32 v222, v188, v189
v_mfma_f32_16x16x32_bf16 a[88:91], a[216:219], v[200:203], a[88:91]
buffer_load_dwordx4 v1, s[44:47], s72 offen offset:3072 sc1 lds
v_mfma_f32_16x16x32_bf16 a[120:123], a[216:219], v[204:207], a[120:123]
ds_read_b128 a[252:255], v2 offset:15360
v_add_u32 v2, s82, v1
v_mfma_f32_16x16x32_bf16 a[124:127], a[220:223], v[204:207], a[124:127]
s_waitcnt vmcnt(8) lgkmcnt(8)
v_exp_f32 v190, v190
v_mfma_f32_16x16x32_bf16 a[92:95], a[220:223], v[200:203], a[92:95]
s_barrier
v_exp_f32 v191, v191
v_mfma_f32_16x16x32_bf16 v[232:235], v[120:123], v[200:203], v[232:235]
s_add_u32 s83, s83, 1
v_cvt_pk_bf16_f32 v223, v190, v191
v_mfma_f32_16x16x32_bf16 v[236:239], v[120:123], v[204:207], v[236:239]
s_cbranch_scc0 LloopII
v_mfma_f32_16x16x32_bf16 v[168:171], a[160:163], v[48:51], v[88:91]
s_xor_b32 s74, s82, 0x10000
ds_read_b128 a[128:131], v2 offset:16384
ds_read_b128 a[132:135], v2 offset:17408
v_mfma_f32_16x16x32_bf16 v[168:171], a[164:167], v[52:55], v[168:171]
s_add_u32 s74, s74, s64
v_exp_f32 v136, v136
v_mfma_f32_16x16x32_bf16 v[168:171], a[168:171], v[56:59], v[168:171]
s_add_u32 s81, s81, 0x8000
v_exp_f32 v137, v137
v_mfma_f32_16x16x32_bf16 v[168:171], a[172:175], v[60:63], v[168:171]
s_add_u32 m0, s74, 0
ds_read_b128 a[136:139], v2 offset:18432
v_cvt_pk_bf16_f32 v200, v136, v137
v_mfma_f32_16x16x32_bf16 v[172:175], a[172:175], v[76:79], v[92:95]
s_add_u32 s72, s81, 0
v_exp_f32 v138, v138
v_mfma_f32_16x16x32_bf16 v[172:175], a[168:171], v[72:75], v[172:175]
buffer_load_dwordx4 v1, s[44:47], s72 offen sc1 lds
v_mfma_f32_16x16x32_bf16 v[172:175], a[164:167], v[68:71], v[172:175]
ds_read_b128 a[140:143], v2 offset:19456
ds_read_b128 a[144:147], v2 offset:20480
v_mfma_f32_16x16x32_bf16 v[172:175], a[160:163], v[64:67], v[172:175]
v_exp_f32 v139, v139
v_mfma_f32_16x16x32_bf16 v[188:191], a[176:179], v[64:67], v[92:95]
v_exp_f32 v152, v152
v_mfma_f32_16x16x32_bf16 v[188:191], a[180:183], v[68:71], v[188:191]
ds_read_b128 a[148:151], v2 offset:21504
v_cvt_pk_bf16_f32 v201, v138, v139
v_mfma_f32_16x16x32_bf16 v[188:191], a[184:187], v[72:75], v[188:191]
v_exp_f32 v153, v153
v_mfma_f32_16x16x32_bf16 v[188:191], a[188:191], v[76:79], v[188:191]
ds_read_b128 a[152:155], v2 offset:22528
v_cvt_pk_bf16_f32 v202, v152, v153
v_mfma_f32_16x16x32_bf16 v[184:187], a[188:191], v[60:63], v[88:91]
v_exp_f32 v154, v154
v_mfma_f32_16x16x32_bf16 v[184:187], a[184:187], v[56:59], v[184:187]
buffer_load_dwordx4 v1, s[44:47], s72 offen offset:1024 sc1 lds
v_mfma_f32_16x16x32_bf16 v[184:187], a[180:183], v[52:55], v[184:187]
ds_read_b128 a[156:159], v2 offset:23552
ds_read_b128 a[192:195], v2 offset:0
v_mfma_f32_16x16x32_bf16 v[184:187], a[176:179], v[48:51], v[184:187]
s_waitcnt lgkmcnt(9)
v_exp_f32 v155, v155
v_mfma_f32_16x16x32_bf16 a[64:67], a[224:227], v[216:219], a[64:67]
v_exp_f32 v140, v140
v_mfma_f32_16x16x32_bf16 a[96:99], a[224:227], v[220:223], a[96:99]
ds_read_b128 a[196:199], v2 offset:1024
v_cvt_pk_bf16_f32 v203, v154, v155
v_mfma_f32_16x16x32_bf16 a[100:103], a[228:231], v[220:223], a[100:103]
v_exp_f32 v141, v141
v_mfma_f32_16x16x32_bf16 a[68:71], a[228:231], v[216:219], a[68:71]
ds_read_b128 a[200:203], v2 offset:2048
v_cvt_pk_bf16_f32 v204, v140, v141
v_mfma_f32_16x16x32_bf16 a[72:75], a[232:235], v[216:219], a[72:75]
v_exp_f32 v142, v142
v_mfma_f32_16x16x32_bf16 a[104:107], a[232:235], v[220:223], a[104:107]
buffer_load_dwordx4 v1, s[44:47], s72 offen offset:2048 sc1 lds
v_mfma_f32_16x16x32_bf16 a[108:111], a[236:239], v[220:223], a[108:111]
ds_read_b128 a[204:207], v2 offset:3072
v_mfma_f32_16x16x32_bf16 a[76:79], a[236:239], v[216:219], a[76:79]
v_exp_f32 v143, v143
v_mfma_f32_16x16x32_bf16 a[80:83], a[240:243], v[216:219], a[80:83]
ds_read_b128 a[208:211], v2 offset:4096
v_cvt_pk_bf16_f32 v205, v142, v143
v_mfma_f32_16x16x32_bf16 a[112:115], a[240:243], v[220:223], a[112:115]
v_exp_f32 v156, v156
v_mfma_f32_16x16x32_bf16 a[116:119], a[244:247], v[220:223], a[116:119]
ds_read_b128 a[212:215], v2 offset:5120
v_mfma_f32_16x16x32_bf16 a[84:87], a[244:247], v[216:219], a[84:87]
v_exp_f32 v157, v157
v_mfma_f32_16x16x32_bf16 a[88:91], a[248:251], v[216:219], a[88:91]
ds_read_b128 a[216:219], v2 offset:6144
v_cvt_pk_bf16_f32 v206, v156, v157
v_mfma_f32_16x16x32_bf16 a[120:123], a[248:251], v[220:223], a[120:123]
buffer_load_dwordx4 v1, s[44:47], s72 offen offset:3072 sc1 lds
v_mfma_f32_16x16x32_bf16 a[124:127], a[252:255], v[220:223], a[124:127]
v_exp_f32 v158, v158
v_mfma_f32_16x16x32_bf16 a[92:95], a[252:255], v[216:219], a[92:95]
ds_read_b128 a[220:223], v2 offset:7168
v_mfma_f32_16x16x32_bf16 v[232:235], v[120:123], v[216:219], v[232:235]
s_waitcnt lgkmcnt(8)
v_exp_f32 v159, v159
v_mfma_f32_16x16x32_bf16 v[236:239], v[120:123], v[220:223], v[236:239]
s_barrier
v_cvt_pk_bf16_f32 v207, v158, v159
s_lshr_b32 s69, s93, 4
s_and_b32 s69, s69, 0x7f00
s_add_u32 s69, s69, LHT4-Lpc0
v_lshrrev_b32 v3, 5, v0
v_lshlrev_b32 v3, 7, v3
v_add_u32 v3, s69, v3
v_min_u32 v3, Lcode_end-Lpc0, v3
global_load_dword v4, v3, s[98:99]
s_cmp_eq_u32 s58, 0
s_cbranch_scc1 Lta28
s_cmp_eq_u32 s58, 1
s_cbranch_scc1 Lnt29
v_mfma_f32_16x16x32_bf16 v[136:139], a[128:131], v[48:51], v[88:91]
s_add_u32 s82, s82, 0x8000
ds_read_b128 a[160:163], v2 offset:24576
ds_read_b128 a[164:167], v2 offset:25600
v_mfma_f32_16x16x32_bf16 v[152:155], a[144:147], v[48:51], v[88:91]
s_and_b32 s82, s82, 0x1ffff
v_exp_f32 v168, v168
s_branch Ljoin30
Lta28:
v_mfma_f32_16x16x32_bf16 v[136:139], a[128:131], v[48:51], v[104:107]
s_add_u32 s82, s82, 0x8000
ds_read_b128 a[160:163], v2 offset:24576
ds_read_b128 a[164:167], v2 offset:25600
v_mfma_f32_16x16x32_bf16 v[152:155], a[144:147], v[48:51], v[112:115]
s_and_b32 s82, s82, 0x1ffff
v_exp_f32 v168, v168
s_branch Ljoin30
Lnt29:
v_mfma_f32_16x16x32_bf16 v[136:139], a[128:131], v[48:51], v[88:91]
s_add_u32 s82, s82, 0x8000
ds_read_b128 a[160:163], v2 offset:24576
ds_read_b128 a[164:167], v2 offset:25600
v_mfma_f32_16x16x32_bf16 v[152:155], a[144:147], v[48:51], v[104:107]
s_and_b32 s82, s82, 0x1ffff
v_exp_f32 v168, v168
Ljoin30:
v_mfma_f32_16x16x32_bf16 v[136:139], a[132:135], v[52:55], v[136:139]
s_add_u32 s66, s58, 3
v_exp_f32 v169, v169
v_mfma_f32_16x16x32_bf16 v[136:139], a[136:139], v[56:59], v[136:139]
s_and_b32 s66, s66, 3
ds_read_b128 a[168:171], v2 offset:26624
v_cvt_pk_bf16_f32 v216, v168, v169
v_mfma_f32_16x16x32_bf16 v[136:139], a[140:143], v[60:63], v[136:139]
s_mul_i32 s66, s66, 4160
v_exp_f32 v170, v170
v_mfma_f32_16x16x32_bf16 v[140:143], a[140:143], v[76:79], v[92:95]
s_add_u32 s66, s66, s92
ds_read_b128 a[172:175], v2 offset:27648
ds_read_b128 a[176:179], v2 offset:28672
v_mfma_f32_16x16x32_bf16 v[140:143], a[136:139], v[72:75], v[140:143]
s_add_u32 m0, s66, 32
v_exp_f32 v171, v171
v_mfma_f32_16x16x32_bf16 v[140:143], a[132:135], v[68:71], v[140:143]
s_add_u32 s72, s93, 0x6
buffer_load_dwordx4 v1, s[36:39], s72 offen lds
v_mfma_f32_16x16x32_bf16 v[140:143], a[128:131], v[64:67], v[140:143]
v_exp_f32 v184, v184
v_mfma_f32_16x16x32_bf16 v[156:159], a[144:147], v[64:67], v[92:95]
ds_read_b128 a[180:183], v2 offset:29696
v_cvt_pk_bf16_f32 v217, v170, v171
v_mfma_f32_16x16x32_bf16 v[156:159], a[148:151], v[68:71], v[156:159]
v_exp_f32 v185, v185
v_mfma_f32_16x16x32_bf16 v[156:159], a[152:155], v[72:75], v[156:159]
ds_read_b128 a[184:187], v2 offset:30720
v_cvt_pk_bf16_f32 v218, v184, v185
v_mfma_f32_16x16x32_bf16 v[156:159], a[156:159], v[76:79], v[156:159]
Lstub6:
s_cbranch_execz Lstub10
v_exp_f32 v186, v186
v_mfma_f32_16x16x32_bf16 v[152:155], a[156:159], v[60:63], v[152:155]
buffer_load_dwordx4 v1, s[36:39], s72 offen offset:1024 lds
v_mfma_f32_16x16x32_bf16 v[152:155], a[152:155], v[56:59], v[152:155]
ds_read_b128 a[188:191], v2 offset:31744
ds_read_b128 a[224:227], v2 offset:8192
v_mfma_f32_16x16x32_bf16 v[152:155], a[148:151], v[52:55], v[152:155]
s_waitcnt lgkmcnt(9)
v_exp_f32 v187, v187
v_mfma_f32_16x16x32_bf16 a[64:67], a[192:195], v[200:203], a[64:67]
v_exp_f32 v172, v172
v_mfma_f32_16x16x32_bf16 a[96:99], a[192:195], v[204:207], a[96:99]
ds_read_b128 a[228:231], v2 offset:9216
v_cvt_pk_bf16_f32 v219, v186, v187
v_mfma_f32_16x16x32_bf16 a[100:103], a[196:199], v[204:207], a[100:103]
v_exp_f32 v173, v173
v_mfma_f32_16x16x32_bf16 a[68:71], a[196:199], v[200:203], a[68:71]
ds_read_b128 a[232:235], v2 offset:10240
v_cvt_pk_bf16_f32 v220, v172, v173
v_mfma_f32_16x16x32_bf16 a[72:75], a[200:203], v[200:203], a[72:75]
v_exp_f32 v174, v174
v_mfma_f32_16x16x32_bf16 a[104:107], a[200:203], v[204:207], a[104:107]
buffer_load_dwordx4 v1, s[36:39], s72 offen offset:2048 lds
v_mfma_f32_16x16x32_bf16 a[108:111], a[204:207], v[204:207], a[108:111]
ds_read_b128 a[236:239], v2 offset:11264
v_mfma_f32_16x16x32_bf16 a[76:79], a[204:207], v[200:203], a[76:79]
v_exp_f32 v175, v175
v_mfma_f32_16x16x32_bf16 a[80:83], a[208:211], v[200:203], a[80:83]
ds_read_b128 a[240:243], v2 offset:12288
v_cvt_pk_bf16_f32 v221, v174, v175
v_mfma_f32_16x16x32_bf16 a[112:115], a[208:211], v[204:207], a[112:115]
v_exp_f32 v188, v188
v_mfma_f32_16x16x32_bf16 a[116:119], a[212:215], v[204:207], a[116:119]
ds_read_b128 a[244:247], v2 offset:13312
v_mfma_f32_16x16x32_bf16 a[84:87], a[212:215], v[200:203], a[84:87]
v_exp_f32 v189, v189
v_mfma_f32_16x16x32_bf16 a[88:91], a[216:219], v[200:203], a[88:91]
ds_read_b128 a[248:251], v2 offset:14336
v_cvt_pk_bf16_f32 v222, v188, v189
v_mfma_f32_16x16x32_bf16 a[120:123], a[216:219], v[204:207], a[120:123]
buffer_load_dwordx4 v1, s[36:39], s72 offen offset:3072 lds
v_mfma_f32_16x16x32_bf16 a[124:127], a[220:223], v[204:207], a[124:127]
v_exp_f32 v190, v190
v_mfma_f32_16x16x32_bf16 a[92:95], a[220:223], v[200:203], a[92:95]
ds_read_b128 a[252:255], v2 offset:15360
v_add_u32 v2, s82, v1
v_mfma_f32_16x16x32_bf16 v[232:235], v[120:123], v[200:203], v[232:235]
s_waitcnt vmcnt(9) lgkmcnt(0)
v_exp_f32 v191, v191
v_mfma_f32_16x16x32_bf16 v[236:239], v[120:123], v[204:207], v[236:239]
s_barrier
v_cvt_pk_bf16_f32 v223, v190, v191
s_cmp_eq_u32 s58, 2
s_cbranch_scc1 Lta31
s_cmp_eq_u32 s58, 3
s_cbranch_scc1 Lnt32
v_mfma_f32_16x16x32_bf16 v[168:171], a[160:163], v[48:51], v[112:115]
s_mov_b32 m0, s62
v_exp_f32 v136, v136
v_mfma_f32_16x16x32_bf16 v[184:187], a[176:179], v[48:51], v[112:115]
s_add_u32 s72, s93, 0x3000000
ds_read_b128 a[128:131], v2 offset:16384
ds_read_b128 a[132:135], v2 offset:17408
s_branch Ljoin33
Lta31:
v_mfma_f32_16x16x32_bf16 v[168:171], a[160:163], v[48:51], v[104:107]
s_mov_b32 m0, s62
v_exp_f32 v136, v136
v_mfma_f32_16x16x32_bf16 v[184:187], a[176:179], v[48:51], v[112:115]
s_add_u32 s72, s93, 0x3000000
ds_read_b128 a[128:131], v2 offset:16384
ds_read_b128 a[132:135], v2 offset:17408
s_branch Ljoin33
Lnt32:
v_mfma_f32_16x16x32_bf16 v[168:171], a[160:163], v[48:51], v[88:91]
s_mov_b32 m0, s62
v_exp_f32 v136, v136
v_mfma_f32_16x16x32_bf16 v[184:187], a[176:179], v[48:51], v[104:107]
s_add_u32 s72, s93, 0x3000000
ds_read_b128 a[128:131], v2 offset:16384
ds_read_b128 a[132:135], v2 offset:17408
Ljoin33:
v_mfma_f32_16x16x32_bf16 v[168:171], a[164:167], v[52:55], v[168:171]
v_exp_f32 v137, v137
v_mfma_f32_16x16x32_bf16 v[168:171], a[168:171], v[56:59], v[168:171]
buffer_load_dwordx4 v1, s[44:47], s72 offen sc1 lds
v_mfma_f32_16x16x32_bf16 v[168:171], a[172:175], v[60:63], v[168:171]
s_add_u32 s78, s59, 4
v_exp_f32 v138, v138
v_mfma_f32_16x16x32_bf16 v[172:175], a[172:175], v[76:79], v[92:95]
s_and_b32 s78, s78, 12
ds_read_b128 a[136:139], v2 offset:18432
v_cvt_pk_bf16_f32 v200, v136, v137
v_mfma_f32_16x16x32_bf16 v[172:175], a[168:171], v[72:75], v[172:175]
s_and_b32 s12, s59, 16
v_exp_f32 v139, v139
v_mfma_f32_16x16x32_bf16 v[172:175], a[164:167], v[68:71], v[172:175]
s_or_b32 s78, s78, s12
ds_read_b128 a[140:143], v2 offset:19456
v_cvt_pk_bf16_f32 v201, v138, v139
v_mfma_f32_16x16x32_bf16 v[172:175], a[160:163], v[64:67], v[172:175]
s_add_u32 s12, s61, 0
v_exp_f32 v152, v152
v_mfma_f32_16x16x32_bf16 v[188:191], a[176:179], v[64:67], v[92:95]
s_and_b32 s12, s12, 3
ds_read_b128 a[144:147], v2 offset:20480
ds_read_b128 a[148:151], v2 offset:21504
v_mfma_f32_16x16x32_bf16 v[188:191], a[180:183], v[68:71], v[188:191]
s_add_u32 s12, s12, s78
buffer_load_dwordx4 v1, s[44:47], s72 offen offset:1024 sc1 lds
v_mfma_f32_16x16x32_bf16 v[188:191], a[184:187], v[72:75], v[188:191]
s_lshl_b32 s12, s12, 18
v_exp_f32 v153, v153
v_mfma_f32_16x16x32_bf16 v[188:191], a[188:191], v[76:79], v[188:191]
s_add_u32 s12, s12, s94
v_exp_f32 v154, v154
v_mfma_f32_16x16x32_bf16 v[184:187], a[188:191], v[60:63], v[184:187]
s_add_u32 s13, s61, 1
ds_read_b128 a[152:155], v2 offset:22528
v_cvt_pk_bf16_f32 v202, v152, v153
v_mfma_f32_16x16x32_bf16 v[184:187], a[184:187], v[56:59], v[184:187]
s_and_b32 s13, s13, 3
buffer_load_dwordx4 v1, s[44:47], s72 offen offset:2048 sc1 lds
v_mfma_f32_16x16x32_bf16 v[184:187], a[180:183], v[52:55], v[184:187]
s_waitcnt lgkmcnt(7)
v_exp_f32 v155, v155
v_mfma_f32_16x16x32_bf16 a[64:67], a[224:227], v[216:219], a[64:67]
s_add_u32 s13, s13, s78
ds_read_b128 a[156:159], v2 offset:23552
v_cvt_pk_bf16_f32 v203, v154, v155
v_mfma_f32_16x16x32_bf16 a[96:99], a[224:227], v[220:223], a[96:99]
s_lshl_b32 s13, s13, 18
v_exp_f32 v140, v140
v_mfma_f32_16x16x32_bf16 a[100:103], a[228:231], v[220:223], a[100:103]
s_add_u32 s13, s13, s94
ds_read_b128 a[192:195], v2 offset:0
ds_read_b128 a[196:199], v2 offset:1024
v_mfma_f32_16x16x32_bf16 a[68:71], a[228:231], v[216:219], a[68:71]
s_add_u32 s14, s61, 2
v_exp_f32 v141, v141
v_mfma_f32_16x16x32_bf16 a[72:75], a[232:235], v[216:219], a[72:75]
s_and_b32 s14, s14, 3
buffer_load_dwordx4 v1, s[44:47], s72 offen offset:3072 sc1 lds
v_mfma_f32_16x16x32_bf16 a[104:107], a[232:235], v[220:223], a[104:107]
s_add_u32 s66, s58, 0
v_exp_f32 v142, v142
v_mfma_f32_16x16x32_bf16 a[108:111], a[236:239], v[220:223], a[108:111]
s_and_b32 s66, s66, 3
ds_read_b128 a[200:203], v2 offset:2048
v_cvt_pk_bf16_f32 v204, v140, v141
v_mfma_f32_16x16x32_bf16 a[76:79], a[236:239], v[216:219], a[76:79]
s_mul_i32 s66, s66, 4160
v_exp_f32 v143, v143
v_mfma_f32_16x16x32_bf16 a[80:83], a[240:243], v[216:219], a[80:83]
s_add_u32 s66, s66, s92
ds_read_b128 a[204:207], v2 offset:3072
v_cvt_pk_bf16_f32 v205, v142, v143
v_mfma_f32_16x16x32_bf16 a[112:115], a[240:243], v[220:223], a[112:115]
s_add_u32 m0, s66, 16672
v_exp_f32 v156, v156
v_mfma_f32_16x16x32_bf16 a[116:119], a[244:247], v[220:223], a[116:119]
s_add_u32 s72, s93, 0x0
ds_read_b128 a[208:211], v2 offset:4096
ds_read_b128 a[212:215], v2 offset:5120
v_mfma_f32_16x16x32_bf16 a[84:87], a[244:247], v[216:219], a[84:87]
s_add_u32 s14, s14, s78
buffer_load_dwordx4 v1, s[36:39], s72 offen lds
v_mfma_f32_16x16x32_bf16 a[88:91], a[248:251], v[216:219], a[88:91]
s_lshl_b32 s14, s14, 18
v_exp_f32 v157, v157
v_mfma_f32_16x16x32_bf16 a[120:123], a[248:251], v[220:223], a[120:123]
s_add_u32 s14, s14, s94
v_exp_f32 v158, v158
v_mfma_f32_16x16x32_bf16 a[124:127], a[252:255], v[220:223], a[124:127]
s_add_u32 s15, s61, 3
ds_read_b128 a[216:219], v2 offset:6144
ds_read_b128 a[220:223], v2 offset:7168
v_mfma_f32_16x16x32_bf16 a[92:95], a[252:255], v[216:219], a[92:95]
s_and_b32 s15, s15, 3
buffer_load_dwordx4 v1, s[36:39], s72 offen offset:1024 lds
v_mfma_f32_16x16x32_bf16 v[232:235], v[120:123], v[216:219], v[232:235]
s_add_u32 s15, s15, s78
v_exp_f32 v159, v159
v_mfma_f32_16x16x32_bf16 v[236:239], v[120:123], v[220:223], v[236:239]
s_waitcnt lgkmcnt(8)
v_cvt_pk_bf16_f32 v206, v156, v157
v_cvt_pk_bf16_f32 v207, v158, v159
s_lshl_b32 s15, s15, 18
s_add_u32 s15, s15, s94
s_cmp_eq_u32 s58, 0
s_cbranch_scc1 Lta34
s_cmp_eq_u32 s58, 1
s_cbranch_scc1 Lnt35
v_mfma_f32_16x16x32_bf16 v[140:143], a[128:131], v[64:67], v[92:95]
s_add_u32 s82, s82, 0x8000
ds_read_b128 a[160:163], v2 offset:24576
ds_read_b128 a[164:167], v2 offset:25600
v_mfma_f32_16x16x32_bf16 v[156:159], a[144:147], v[64:67], v[92:95]
s_and_b32 s82, s82, 0x1ffff
v_exp_f32 v168, v168
s_branch Ljoin36
Lta34:
v_mfma_f32_16x16x32_bf16 v[140:143], a[128:131], v[64:67], v[108:111]
s_add_u32 s82, s82, 0x8000
ds_read_b128 a[160:163], v2 offset:24576
ds_read_b128 a[164:167], v2 offset:25600
v_mfma_f32_16x16x32_bf16 v[156:159], a[144:147], v[64:67], v[112:115]
s_and_b32 s82, s82, 0x1ffff
v_exp_f32 v168, v168
s_branch Ljoin36
Lnt35:
v_mfma_f32_16x16x32_bf16 v[140:143], a[128:131], v[64:67], v[92:95]
s_add_u32 s82, s82, 0x8000
ds_read_b128 a[160:163], v2 offset:24576
ds_read_b128 a[164:167], v2 offset:25600
v_mfma_f32_16x16x32_bf16 v[156:159], a[144:147], v[64:67], v[108:111]
s_and_b32 s82, s82, 0x1ffff
v_exp_f32 v168, v168
Ljoin36:
v_mfma_f32_16x16x32_bf16 v[140:143], a[132:135], v[68:71], v[140:143]
v_exp_f32 v169, v169
v_mfma_f32_16x16x32_bf16 v[140:143], a[136:139], v[72:75], v[140:143]
ds_read_b128 a[168:171], v2 offset:26624
ds_read_b128 a[172:175], v2 offset:27648
v_mfma_f32_16x16x32_bf16 v[140:143], a[140:143], v[76:79], v[140:143]
v_exp_f32 v170, v170
v_mfma_f32_16x16x32_bf16 v[156:159], a[156:159], v[76:79], v[156:159]
v_exp_f32 v171, v171
v_mfma_f32_16x16x32_bf16 v[156:159], a[152:155], v[72:75], v[156:159]
ds_read_b128 a[176:179], v2 offset:28672
ds_read_b128 a[180:183], v2 offset:29696
v_mfma_f32_16x16x32_bf16 v[156:159], a[148:151], v[68:71], v[156:159]
s_waitcnt lgkmcnt(6)
v_exp_f32 v184, v184
v_mfma_f32_16x16x32_bf16 a[64:67], a[192:195], v[200:203], a[64:67]
ds_read_b128 a[184:187], v2 offset:30720
ds_read_b128 a[188:191], v2 offset:31744
v_mfma_f32_16x16x32_bf16 a[96:99], a[192:195], v[204:207], a[96:99]
ds_read_b128 a[224:227], v2 offset:8192
ds_read_b128 a[228:231], v2 offset:9216
v_mfma_f32_16x16x32_bf16 a[100:103], a[196:199], v[204:207], a[100:103]
ds_read_b128 a[232:235], v2 offset:10240
ds_read_b128 a[236:239], v2 offset:11264
v_mfma_f32_16x16x32_bf16 a[68:71], a[196:199], v[200:203], a[68:71]
ds_read_b128 a[240:243], v2 offset:12288
ds_read_b128 a[244:247], v2 offset:13312
v_mfma_f32_16x16x32_bf16 a[72:75], a[200:203], v[200:203], a[72:75]
ds_read_b128 a[248:251], v2 offset:14336
ds_read_b128 a[252:255], v2 offset:15360
v_mfma_f32_16x16x32_bf16 a[104:107], a[200:203], v[204:207], a[104:107]
v_cvt_pk_bf16_f32 v216, v168, v169
v_cvt_pk_bf16_f32 v217, v170, v171
v_mfma_f32_16x16x32_bf16 a[108:111], a[204:207], v[204:207], a[108:111]
buffer_load_dwordx4 v1, s[36:39], s72 offen offset:2048 lds
v_mfma_f32_16x16x32_bf16 a[76:79], a[204:207], v[200:203], a[76:79]
v_exp_f32 v185, v185
v_mfma_f32_16x16x32_bf16 a[80:83], a[208:211], v[200:203], a[80:83]
v_exp_f32 v186, v186
v_mfma_f32_16x16x32_bf16 a[112:115], a[208:211], v[204:207], a[112:115]
v_exp_f32 v187, v187
v_mfma_f32_16x16x32_bf16 a[116:119], a[212:215], v[204:207], a[116:119]
v_exp_f32 v172, v172
v_mfma_f32_16x16x32_bf16 a[84:87], a[212:215], v[200:203], a[84:87]
v_cvt_pk_bf16_f32 v218, v184, v185
v_cvt_pk_bf16_f32 v219, v186, v187
v_mfma_f32_16x16x32_bf16 a[88:91], a[216:219], v[200:203], a[88:91]
v_exp_f32 v173, v173
v_mfma_f32_16x16x32_bf16 a[120:123], a[216:219], v[204:207], a[120:123]
v_exp_f32 v174, v174
v_mfma_f32_16x16x32_bf16 a[124:127], a[220:223], v[204:207], a[124:127]
v_exp_f32 v175, v175
v_mfma_f32_16x16x32_bf16 a[92:95], a[220:223], v[200:203], a[92:95]
buffer_load_dwordx4 v1, s[36:39], s72 offen offset:3072 lds
v_mfma_f32_16x16x32_bf16 v[232:235], v[120:123], v[200:203], v[232:235]
s_waitcnt vmcnt(13) lgkmcnt(8)
v_exp_f32 v188, v188
v_mfma_f32_16x16x32_bf16 v[236:239], v[120:123], v[204:207], v[236:239]
s_barrier
v_cvt_pk_bf16_f32 v220, v172, v173
v_cvt_pk_bf16_f32 v221, v174, v175
v_add_u32 v2, s82, v1
v_exp_f32 v189, v189
v_exp_f32 v190, v190
v_cvt_pk_bf16_f32 v222, v188, v189
v_exp_f32 v191, v191
s_nop 0
v_cvt_pk_bf16_f32 v223, v190, v191
s_cmp_eq_u32 s58, 2
s_cbranch_scc1 Lta37
s_cmp_eq_u32 s58, 3
s_cbranch_scc1 Lnt38
v_mfma_f32_16x16x32_bf16 v[172:175], a[160:163], v[64:67], v[112:115]
s_add_u32 s66, s58, 2
v_exp_f32 v140, v140
v_mfma_f32_16x16x32_bf16 v[188:191], a[176:179], v[64:67], v[112:115]
s_and_b32 s66, s66, 3
ds_read_b128 a[192:195], v2 offset:0
s_branch Ljoin39
Lta37:
v_mfma_f32_16x16x32_bf16 v[172:175], a[160:163], v[64:67], v[108:111]
s_add_u32 s66, s58, 2
v_exp_f32 v140, v140
v_mfma_f32_16x16x32_bf16 v[188:191], a[176:179], v[64:67], v[112:115]
s_and_b32 s66, s66, 3
ds_read_b128 a[192:195], v2 offset:0
s_branch Ljoin39
Lnt38:
v_mfma_f32_16x16x32_bf16 v[172:175], a[160:163], v[64:67], v[92:95]
s_add_u32 s66, s58, 2
v_exp_f32 v140, v140
v_mfma_f32_16x16x32_bf16 v[188:191], a[176:179], v[64:67], v[108:111]
s_and_b32 s66, s66, 3
ds_read_b128 a[192:195], v2 offset:0
Ljoin39:
v_mfma_f32_16x16x32_bf16 v[172:175], a[164:167], v[68:71], v[172:175]
s_mul_i32 s66, s66, 4160
v_exp_f32 v141, v141
v_mfma_f32_16x16x32_bf16 v[172:175], a[168:171], v[72:75], v[172:175]
s_add_u32 s66, s66, s92
ds_read_b128 a[196:199], v2 offset:1024
v_cvt_pk_bf16_f32 v204, v140, v141
v_mfma_f32_16x16x32_bf16 v[172:175], a[172:175], v[76:79], v[172:175]
s_add_u32 m0, s66, 33312
v_exp_f32 v142, v142
v_mfma_f32_16x16x32_bf16 v[188:191], a[188:191], v[76:79], v[188:191]
s_add_u32 s72, s93, 0x4
buffer_load_dwordx4 v1, s[36:39], s72 offen lds
v_mfma_f32_16x16x32_bf16 v[188:191], a[184:187], v[72:75], v[188:191]
buffer_load_dwordx4 v1, s[36:39], s72 offen offset:1024 lds
v_mfma_f32_16x16x32_bf16 v[188:191], a[180:183], v[68:71], v[188:191]
s_waitcnt lgkmcnt(2)
ds_read_b128 a[200:203], v2 offset:2048
v_mfma_f32_16x16x32_bf16 a[64:67], a[224:227], v[216:219], a[64:67]
buffer_load_dwordx4 v1, s[36:39], s72 offen offset:2048 lds
v_mfma_f32_16x16x32_bf16 a[96:99], a[224:227], v[220:223], a[96:99]
v_exp_f32 v143, v143
v_mfma_f32_16x16x32_bf16 a[100:103], a[228:231], v[220:223], a[100:103]
ds_read_b128 a[204:207], v2 offset:3072
v_cvt_pk_bf16_f32 v205, v142, v143
v_mfma_f32_16x16x32_bf16 a[68:71], a[228:231], v[216:219], a[68:71]
buffer_load_dwordx4 v1, s[36:39], s72 offen offset:3072 lds
v_mfma_f32_16x16x32_bf16 a[72:75], a[232:235], v[216:219], a[72:75]
v_exp_f32 v156, v156
v_mfma_f32_16x16x32_bf16 a[104:107], a[232:235], v[220:223], a[104:107]
ds_read_b128 a[208:211], v2 offset:4096
v_mfma_f32_16x16x32_bf16 a[108:111], a[236:239], v[220:223], a[108:111]
buffer_load_dwordx4 v[80:83], v15, s[4:7], s80 offen
v_mfma_f32_16x16x32_bf16 a[76:79], a[236:239], v[216:219], a[76:79]
s_add_u32 s80, s80, 0x4000
v_exp_f32 v157, v157
v_mfma_f32_16x16x32_bf16 a[80:83], a[240:243], v[216:219], a[80:83]
ds_read_b128 a[212:215], v2 offset:5120
v_cvt_pk_bf16_f32 v206, v156, v157
v_mfma_f32_16x16x32_bf16 a[112:115], a[240:243], v[220:223], a[112:115]
buffer_load_dwordx4 v[84:87], v15, s[4:7], s80 offen
v_mfma_f32_16x16x32_bf16 a[116:119], a[244:247], v[220:223], a[116:119]
s_add_u32 s80, s80, 0x4000
v_exp_f32 v158, v158
v_mfma_f32_16x16x32_bf16 a[84:87], a[244:247], v[216:219], a[84:87]
ds_read_b128 a[216:219], v2 offset:6144
v_mfma_f32_16x16x32_bf16 a[88:91], a[248:251], v[216:219], a[88:91]
buffer_load_dwordx4 v[96:99], v15, s[4:7], s80 offen
v_mfma_f32_16x16x32_bf16 a[120:123], a[248:251], v[220:223], a[120:123]
s_add_u32 s80, s80, 0x4000
v_exp_f32 v159, v159
v_mfma_f32_16x16x32_bf16 a[124:127], a[252:255], v[220:223], a[124:127]
ds_read_b128 a[220:223], v2 offset:7168
v_cvt_pk_bf16_f32 v207, v158, v159
v_mfma_f32_16x16x32_bf16 a[92:95], a[252:255], v[216:219], a[92:95]
buffer_load_dwordx4 v[100:103], v15, s[4:7], s80 offen
v_mfma_f32_16x16x32_bf16 v[232:235], v[120:123], v[216:219], v[232:235]
v_mfma_f32_16x16x32_bf16 v[236:239], v[120:123], v[220:223], v[236:239]
s_waitcnt lgkmcnt(0)
v_mfma_f32_16x16x32_bf16 a[96:99], a[192:195], v[204:207], a[96:99]
s_add_u32 s82, s82, 0x8000
ds_read_b128 a[224:227], v2 offset:8192
ds_read_b128 a[228:231], v2 offset:9216
v_mfma_f32_16x16x32_bf16 a[100:103], a[196:199], v[204:207], a[100:103]
s_and_b32 s82, s82, 0x1ffff
v_exp_f32 v172, v172
v_mfma_f32_16x16x32_bf16 a[104:107], a[200:203], v[204:207], a[104:107]
v_exp_f32 v173, v173
v_mfma_f32_16x16x32_bf16 a[108:111], a[204:207], v[204:207], a[108:111]
ds_read_b128 a[232:235], v2 offset:10240
ds_read_b128 a[236:239], v2 offset:11264
v_mfma_f32_16x16x32_bf16 a[112:115], a[208:211], v[204:207], a[112:115]
v_exp_f32 v174, v174
v_mfma_f32_16x16x32_bf16 a[116:119], a[212:215], v[204:207], a[116:119]
ds_read_b128 a[240:243], v2 offset:12288
ds_read_b128 a[244:247], v2 offset:13312
v_mfma_f32_16x16x32_bf16 a[120:123], a[216:219], v[204:207], a[120:123]
ds_read_b128 a[248:251], v2 offset:14336
ds_read_b128 a[252:255], v2 offset:15360
v_mfma_f32_16x16x32_bf16 a[124:127], a[220:223], v[204:207], a[124:127]
s_waitcnt vmcnt(4) lgkmcnt(0)
v_exp_f32 v175, v175
v_mfma_f32_16x16x32_bf16 v[236:239], v[120:123], v[204:207], v[236:239]
s_barrier
v_exp_f32 v188, v188
v_add_u32 v2, s82, v1
v_cvt_pk_bf16_f32 v220, v172, v173
v_cvt_pk_bf16_f32 v221, v174, v175
v_exp_f32 v189, v189
v_exp_f32 v190, v190
v_cvt_pk_bf16_f32 v222, v188, v189
v_exp_f32 v191, v191
s_nop 0
v_cvt_pk_bf16_f32 v223, v190, v191
LHT4:
Lstub7:
s_cbranch_execz Lstub11
s_nop 1
v_mfma_f32_16x16x32_bf16 a[96:99], a[224:227], v[220:223], a[96:99]
ds_write_b64 v5, v[12:13]
v_mov_b32 v240, 0
v_mfma_f32_16x16x32_bf16 a[100:103], a[228:231], v[220:223], a[100:103]
s_lshl_b32 s73, s59, 12
v_mov_b32 v241, 0
v_mfma_f32_16x16x32_bf16 a[104:107], a[232:235], v[220:223], a[104:107]
s_add_u32 s73, s73, 0x2000000
ds_write_b64 v14, v[240:241]
ds_read_b128 a[192:195], v7 offset:3584
v_mfma_f32_16x16x32_bf16 a[108:111], a[236:239], v[220:223], a[108:111]
s_lshl_b32 s70, s68, 2
ds_read_b64 a[128:129], v6 offset:0
ds_read_b64 a[130:131], v6 offset:8
v_mfma_f32_16x16x32_bf16 a[112:115], a[240:243], v[220:223], a[112:115]
s_add_u32 s70, s70, s73
ds_read_b128 a[196:199], v7 offset:3072
ds_read_b64 a[132:133], v6 offset:512
v_mfma_f32_16x16x32_bf16 a[116:119], a[244:247], v[220:223], a[116:119]
ds_read_b64 a[134:135], v6 offset:520
ds_read_b128 a[200:203], v7 offset:2560
v_mfma_f32_16x16x32_bf16 a[120:123], a[248:251], v[220:223], a[120:123]
ds_read_b64 a[136:137], v6 offset:1024
ds_read_b64 a[138:139], v6 offset:1032
v_mfma_f32_16x16x32_bf16 a[124:127], a[252:255], v[220:223], a[124:127]
s_xor_b32 s71, s12, 0x80
ds_read_b128 a[204:207], v7 offset:2048
ds_read_b64 a[140:141], v6 offset:1536
v_mfma_f32_16x16x32_bf16 v[236:239], v[120:123], v[220:223], v[236:239]
s_add_u32 m0, s77, 0
ds_read_b64 a[142:143], v6 offset:1544
ds_read_b128 a[208:211], v7 offset:1536
ds_read_b64 a[144:145], v6 offset:2048
ds_read_b64 a[146:147], v6 offset:2056
ds_read_b128 a[212:215], v7 offset:1024
ds_read_b64 a[148:149], v6 offset:2560
ds_read_b64 a[150:151], v6 offset:2568
ds_read_b128 a[216:219], v7 offset:512
ds_read_b64 a[152:153], v6 offset:3072
ds_read_b64 a[154:155], v6 offset:3080
ds_read_b128 a[220:223], v7 offset:0
ds_read_b64 a[156:157], v6 offset:3584
ds_read_b64 a[158:159], v6 offset:3592
s_waitcnt lgkmcnt(0)
v_mfma_f32_16x16x32_bf16 v[128:131], v[8:11], a[192:195], 0
s_add_u32 s72, s71, 0
buffer_load_dwordx4 v15, s[24:27], s72 offen lds
v_mfma_f32_16x16x32_bf16 v[128:131], a[128:131], a[192:195], v[128:131]
v_mfma_f32_16x16x32_bf16 v[132:135], v[8:11], a[196:199], 0
ds_read_b128 a[224:227], v7 offset:3648
ds_read_b64 a[160:161], v6 offset:64
v_mfma_f32_16x16x32_bf16 v[132:135], a[128:131], a[196:199], v[132:135]
v_accvgpr_read_b32 v240, a64
v_accvgpr_read_b32 v241, a65
v_accvgpr_read_b32 v242, a66
v_mfma_f32_16x16x32_bf16 v[132:135], a[132:135], a[192:195], v[132:135]
s_add_u32 s72, s71, 15360
buffer_load_dwordx4 v15, s[24:27], s72 offen offset:1024 lds
v_accvgpr_read_b32 v243, a67
v_mfma_f32_16x16x32_bf16 v[136:139], v[8:11], a[200:203], 0
ds_read_b64 a[162:163], v6 offset:72
ds_read_b128 a[228:231], v7 offset:3136
v_mfma_f32_16x16x32_bf16 v[136:139], a[128:131], a[200:203], v[136:139]
v_rcp_f32 v232, v232
v_mfma_f32_16x16x32_bf16 v[136:139], a[132:135], a[196:199], v[136:139]
v_rcp_f32 v236, v236
v_accvgpr_read_b32 v244, a68
v_mfma_f32_16x16x32_bf16 v[136:139], a[136:139], a[192:195], v[136:139]
ds_read_b64 a[164:165], v6 offset:576
ds_read_b64 a[166:167], v6 offset:584
v_accvgpr_read_b32 v245, a69
v_mfma_f32_16x16x32_bf16 v[140:143], v[8:11], a[204:207], 0
s_add_u32 s72, s71, 30720
buffer_load_dwordx4 v15, s[24:27], s72 offen offset:2048 lds
v_accvgpr_read_b32 v246, a70
v_mfma_f32_16x16x32_bf16 v[140:143], a[128:131], a[204:207], v[140:143]
v_accvgpr_read_b32 v247, a71
v_mul_f32 v240, v240, v232
v_mul_f32 v241, v241, v232
v_mfma_f32_16x16x32_bf16 v[140:143], a[132:135], a[200:203], v[140:143]
ds_read_b128 a[232:235], v7 offset:2624
ds_read_b64 a[168:169], v6 offset:1088
v_mul_f32 v242, v242, v232
v_mfma_f32_16x16x32_bf16 v[140:143], a[136:139], a[196:199], v[140:143]
s_add_u32 s72, s71, 46080
buffer_load_dwordx4 v15, s[24:27], s72 offen offset:3072 lds
v_mul_f32 v243, v243, v232
v_mfma_f32_16x16x32_bf16 v[140:143], a[140:143], a[192:195], v[140:143]
v_mul_f32 v244, v244, v232
v_mul_f32 v245, v245, v232
v_mul_f32 v246, v246, v232
v_mfma_f32_16x16x32_bf16 v[144:147], v[8:11], a[208:211], 0
ds_read_b64 a[170:171], v6 offset:1096
ds_read_b128 a[236:239], v7 offset:2112
v_mul_f32 v247, v247, v232
v_mfma_f32_16x16x32_bf16 v[144:147], a[128:131], a[208:211], v[144:147]
s_lshl_b32 s95, s75, 20
v_cvt_pk_bf16_f32 v240, v240, v241
v_cvt_pk_bf16_f32 v241, v242, v243
v_cvt_pk_bf16_f32 v242, v244, v245
v_mfma_f32_16x16x32_bf16 v[144:147], a[132:135], a[204:207], v[144:147]
s_lshl_b32 s74, s58, 18
v_cvt_pk_bf16_f32 v243, v246, v247
v_mfma_f32_16x16x32_bf16 v[144:147], a[136:139], a[200:203], v[144:147]
s_add_u32 s95, s95, s74
ds_read_b64 a[172:173], v6 offset:1600
ds_read_b64 a[174:175], v6 offset:1608
v_mfma_f32_16x16x32_bf16 v[144:147], a[140:143], a[196:199], v[144:147]
s_add_u32 s95, s95, 0x2000000
buffer_store_dwordx4 v[240:243], v1, s[44:47], s70 offen sc1
v_mfma_f32_16x16x32_bf16 v[144:147], a[144:147], a[192:195], v[144:147]
s_sub_u32 s74, 15, s75
v_accvgpr_read_b32 v248, a72
v_accvgpr_read_b32 v249, a73
v_accvgpr_read_b32 v250, a74
v_mfma_f32_16x16x32_bf16 v[148:151], v[8:11], a[212:215], 0
s_min_u32 s74, s74, s75
ds_read_b128 a[240:243], v7 offset:1600
ds_read_b64 a[176:177], v6 offset:2112
v_accvgpr_read_b32 v251, a75
v_mfma_f32_16x16x32_bf16 v[148:151], a[128:131], a[212:215], v[148:151]
s_lshl_b32 s74, s74, 7
v_accvgpr_read_b32 v252, a76
v_accvgpr_read_b32 v253, a77
v_accvgpr_read_b32 v254, a78
v_mfma_f32_16x16x32_bf16 v[148:151], a[132:135], a[208:211], v[148:151]
s_add_u32 s74, s74, 0x3810000
v_accvgpr_read_b32 v255, a79
v_mul_f32 v248, v248, v232
v_mul_f32 v249, v249, v232
v_mfma_f32_16x16x32_bf16 v[148:151], a[136:139], a[204:207], v[148:151]
s_xor_b32 s85, s77, 0x10000
ds_read_b64 a[178:179], v6 offset:2120
ds_read_b128 a[244:247], v7 offset:1088
v_mul_f32 v250, v250, v232
v_mfma_f32_16x16x32_bf16 v[148:151], a[140:143], a[200:203], v[148:151]
v_mul_f32 v251, v251, v232
v_mul_f32 v252, v252, v232
v_mul_f32 v253, v253, v232
v_mfma_f32_16x16x32_bf16 v[148:151], a[144:147], a[196:199], v[148:151]
v_mul_f32 v254, v254, v232
v_mul_f32 v255, v255, v232
v_cvt_pk_bf16_f32 v248, v248, v249
v_mfma_f32_16x16x32_bf16 v[148:151], a[148:151], a[192:195], v[148:151]
ds_read_b64 a[180:181], v6 offset:2624
ds_read_b64 a[182:183], v6 offset:2632
v_cvt_pk_bf16_f32 v249, v250, v251
v_mfma_f32_16x16x32_bf16 v[152:155], v[8:11], a[216:219], 0
v_cvt_pk_bf16_f32 v250, v252, v253
v_cvt_pk_bf16_f32 v251, v254, v255
v_mfma_f32_16x16x32_bf16 v[152:155], a[128:131], a[216:219], v[152:155]
buffer_store_dwordx4 v[248:251], v1, s[44:47], s70 offen offset:1024 sc1
v_mfma_f32_16x16x32_bf16 v[152:155], a[132:135], a[212:215], v[152:155]
ds_read_b128 a[248:251], v7 offset:576
ds_read_b64 a[184:185], v6 offset:3136
v_accvgpr_read_b32 v240, a80
v_mfma_f32_16x16x32_bf16 v[152:155], a[136:139], a[208:211], v[152:155]
v_accvgpr_read_b32 v241, a81
v_accvgpr_read_b32 v242, a82
v_accvgpr_read_b32 v243, a83
v_mfma_f32_16x16x32_bf16 v[152:155], a[140:143], a[204:207], v[152:155]
v_accvgpr_read_b32 v244, a84
v_accvgpr_read_b32 v245, a85
v_accvgpr_read_b32 v246, a86
v_mfma_f32_16x16x32_bf16 v[152:155], a[144:147], a[200:203], v[152:155]
ds_read_b64 a[186:187], v6 offset:3144
ds_read_b128 a[252:255], v7 offset:64
v_accvgpr_read_b32 v247, a87
v_mfma_f32_16x16x32_bf16 v[152:155], a[148:151], a[196:199], v[152:155]
v_mul_f32 v240, v240, v232
v_mul_f32 v241, v241, v232
v_mul_f32 v242, v242, v232
v_mfma_f32_16x16x32_bf16 v[152:155], a[152:155], a[192:195], v[152:155]
v_mul_f32 v243, v243, v232
v_mul_f32 v244, v244, v232
v_mul_f32 v245, v245, v232
v_mfma_f32_16x16x32_bf16 v[156:159], v[8:11], a[220:223], 0
ds_read_b64 a[188:189], v6 offset:3648
ds_read_b64 a[190:191], v6 offset:3656
v_mul_f32 v246, v246, v232
v_mfma_f32_16x16x32_bf16 v[156:159], a[128:131], a[220:223], v[156:159]
v_mul_f32 v247, v247, v232
v_cvt_pk_bf16_f32 v240, v240, v241
v_cvt_pk_bf16_f32 v241, v242, v243
v_mfma_f32_16x16x32_bf16 v[156:159], a[132:135], a[216:219], v[156:159]
v_cvt_pk_bf16_f32 v242, v244, v245
v_cvt_pk_bf16_f32 v243, v246, v247
v_mfma_f32_16x16x32_bf16 v[156:159], a[136:139], a[212:215], v[156:159]
buffer_store_dwordx4 v[240:243], v1, s[44:47], s70 offen offset:2048 sc1
v_mfma_f32_16x16x32_bf16 v[156:159], a[140:143], a[208:211], v[156:159]
v_accvgpr_read_b32 v248, a88
v_accvgpr_read_b32 v249, a89
v_accvgpr_read_b32 v250, a90
v_mfma_f32_16x16x32_bf16 v[156:159], a[144:147], a[204:207], v[156:159]
v_accvgpr_read_b32 v251, a91
v_accvgpr_read_b32 v252, a92
v_accvgpr_read_b32 v253, a93
v_mfma_f32_16x16x32_bf16 v[156:159], a[148:151], a[200:203], v[156:159]
v_accvgpr_read_b32 v254, a94
v_accvgpr_read_b32 v255, a95
v_mul_f32 v248, v248, v232
v_mfma_f32_16x16x32_bf16 v[156:159], a[152:155], a[196:199], v[156:159]
Lstub8:
s_cbranch_execz Lret
v_mul_f32 v249, v249, v232
v_mul_f32 v250, v250, v232
v_mul_f32 v251, v251, v232
v_mfma_f32_16x16x32_bf16 v[156:159], a[156:159], a[192:195], v[156:159]
s_waitcnt lgkmcnt(0)
v_mul_f32 v252, v252, v232
v_mul_f32 v253, v253, v232
v_mul_f32 v254, v254, v232
v_mfma_f32_16x16x32_bf16 v[128:131], a[160:163], a[224:227], v[128:131]
ds_read_b128 a[192:195], v7 offset:3712
ds_read_b64 a[128:129], v6 offset:128
v_mul_f32 v255, v255, v232
v_mfma_f32_16x16x32_bf16 v[132:135], a[164:167], a[224:227], v[132:135]
v_cvt_pk_bf16_f32 v248, v248, v249
v_cvt_pk_bf16_f32 v249, v250, v251
v_cvt_pk_bf16_f32 v250, v252, v253
v_mfma_f32_16x16x32_bf16 v[132:135], a[160:163], a[228:231], v[132:135]
ds_read_b64 a[130:131], v6 offset:136
ds_read_b128 a[196:199], v7 offset:3200
v_cvt_pk_bf16_f32 v251, v254, v255
v_mfma_f32_16x16x32_bf16 v[136:139], a[160:163], a[232:235], v[136:139]
buffer_store_dwordx4 v[248:251], v1, s[44:47], s70 offen offset:3072 sc1
v_mfma_f32_16x16x32_bf16 v[136:139], a[164:167], a[228:231], v[136:139]
s_add_u32 s70, s70, 0x80000
v_accvgpr_read_b32 v240, a96
v_accvgpr_read_b32 v241, a97
v_accvgpr_read_b32 v242, a98
v_mfma_f32_16x16x32_bf16 v[136:139], a[168:171], a[224:227], v[136:139]
ds_read_b64 a[132:133], v6 offset:640
ds_read_b64 a[134:135], v6 offset:648
v_accvgpr_read_b32 v243, a99
v_mfma_f32_16x16x32_bf16 v[140:143], a[172:175], a[224:227], v[140:143]
v_accvgpr_read_b32 v244, a100
v_accvgpr_read_b32 v245, a101
v_accvgpr_read_b32 v246, a102
v_mfma_f32_16x16x32_bf16 v[140:143], a[168:171], a[228:231], v[140:143]
ds_read_b128 a[200:203], v7 offset:2688
ds_read_b64 a[136:137], v6 offset:1152
v_accvgpr_read_b32 v247, a103
v_mfma_f32_16x16x32_bf16 v[140:143], a[164:167], a[232:235], v[140:143]
v_mul_f32 v240, v240, v236
v_mul_f32 v241, v241, v236
v_mul_f32 v242, v242, v236
v_mfma_f32_16x16x32_bf16 v[140:143], a[160:163], a[236:239], v[140:143]
v_mul_f32 v243, v243, v236
v_mul_f32 v244, v244, v236
v_mul_f32 v245, v245, v236
v_mfma_f32_16x16x32_bf16 v[144:147], a[160:163], a[240:243], v[144:147]
ds_read_b64 a[138:139], v6 offset:1160
ds_read_b128 a[204:207], v7 offset:2176
v_mul_f32 v246, v246, v236
v_mfma_f32_16x16x32_bf16 v[144:147], a[164:167], a[236:239], v[144:147]
v_mul_f32 v247, v247, v236
v_cvt_pk_bf16_f32 v240, v240, v241
v_cvt_pk_bf16_f32 v241, v242, v243
v_mfma_f32_16x16x32_bf16 v[144:147], a[168:171], a[232:235], v[144:147]
ds_read_b64 a[140:141], v6 offset:1664
ds_read_b64 a[142:143], v6 offset:1672
v_cvt_pk_bf16_f32 v242, v244, v245
v_mfma_f32_16x16x32_bf16 v[144:147], a[172:175], a[228:231], v[144:147]
v_cvt_pk_bf16_f32 v243, v246, v247
v_mfma_f32_16x16x32_bf16 v[144:147], a[176:179], a[224:227], v[144:147]
buffer_store_dwordx4 v[240:243], v1, s[44:47], s70 offen sc1
v_mfma_f32_16x16x32_bf16 v[148:151], a[180:183], a[224:227], v[148:151]
ds_read_b128 a[208:211], v7 offset:1664
ds_read_b64 a[144:145], v6 offset:2176
v_accvgpr_read_b32 v248, a104
v_mfma_f32_16x16x32_bf16 v[148:151], a[176:179], a[228:231], v[148:151]
v_accvgpr_read_b32 v249, a105
v_accvgpr_read_b32 v250, a106
v_accvgpr_read_b32 v251, a107
v_mfma_f32_16x16x32_bf16 v[148:151], a[172:175], a[232:235], v[148:151]
v_accvgpr_read_b32 v252, a108
v_accvgpr_read_b32 v253, a109
v_accvgpr_read_b32 v254, a110
v_mfma_f32_16x16x32_bf16 v[148:151], a[168:171], a[236:239], v[148:151]
ds_read_b64 a[146:147], v6 offset:2184
ds_read_b128 a[212:215], v7 offset:1152
v_accvgpr_read_b32 v255, a111
v_mfma_f32_16x16x32_bf16 v[148:151], a[164:167], a[240:243], v[148:151]
v_mul_f32 v248, v248, v236
v_mul_f32 v249, v249, v236
v_mul_f32 v250, v250, v236
v_mfma_f32_16x16x32_bf16 v[148:151], a[160:163], a[244:247], v[148:151]
ds_read_b64 a[148:149], v6 offset:2688
ds_read_b64 a[150:151], v6 offset:2696
v_mul_f32 v251, v251, v236
v_mfma_f32_16x16x32_bf16 v[152:155], a[160:163], a[248:251], v[152:155]
v_mul_f32 v252, v252, v236
v_mul_f32 v253, v253, v236
v_mul_f32 v254, v254, v236
v_mfma_f32_16x16x32_bf16 v[152:155], a[164:167], a[244:247], v[152:155]
v_mul_f32 v255, v255, v236
v_cvt_pk_bf16_f32 v248, v248, v249
v_cvt_pk_bf16_f32 v249, v250, v251
v_mfma_f32_16x16x32_bf16 v[152:155], a[168:171], a[240:243], v[152:155]
ds_read_b128 a[216:219], v7 offset:640
ds_read_b64 a[152:153], v6 offset:3200
v_cvt_pk_bf16_f32 v250, v252, v253
v_mfma_f32_16x16x32_bf16 v[152:155], a[172:175], a[236:239], v[152:155]
v_cvt_pk_bf16_f32 v251, v254, v255
v_mfma_f32_16x16x32_bf16 v[152:155], a[176:179], a[232:235], v[152:155]
ds_read_b64 a[154:155], v6 offset:3208
ds_read_b128 a[220:223], v7 offset:128
v_mfma_f32_16x16x32_bf16 v[152:155], a[180:183], a[228:231], v[152:155]
buffer_store_dwordx4 v[248:251], v1, s[44:47], s70 offen offset:1024 sc1
v_mfma_f32_16x16x32_bf16 v[152:155], a[184:187], a[224:227], v[152:155]
v_accvgpr_read_b32 v240, a112
v_accvgpr_read_b32 v241, a113
v_accvgpr_read_b32 v242, a114
v_mfma_f32_16x16x32_bf16 v[156:159], a[188:191], a[224:227], v[156:159]
ds_read_b64 a[156:157], v6 offset:3712
ds_read_b64 a[158:159], v6 offset:3720
v_accvgpr_read_b32 v243, a115
v_mfma_f32_16x16x32_bf16 v[156:159], a[184:187], a[228:231], v[156:159]
v_accvgpr_read_b32 v244, a116
v_accvgpr_read_b32 v245, a117
v_accvgpr_read_b32 v246, a118
v_mfma_f32_16x16x32_bf16 v[156:159], a[180:183], a[232:235], v[156:159]
v_accvgpr_read_b32 v247, a119
v_mul_f32 v240, v240, v236
v_mul_f32 v241, v241, v236
v_mfma_f32_16x16x32_bf16 v[156:159], a[176:179], a[236:239], v[156:159]
v_mul_f32 v242, v242, v236
v_mul_f32 v243, v243, v236
v_mul_f32 v244, v244, v236
v_mfma_f32_16x16x32_bf16 v[156:159], a[172:175], a[240:243], v[156:159]
v_mul_f32 v245, v245, v236
v_mul_f32 v246, v246, v236
v_mul_f32 v247, v247, v236
v_mfma_f32_16x16x32_bf16 v[156:159], a[168:171], a[244:247], v[156:159]
v_cvt_pk_bf16_f32 v240, v240, v241
v_cvt_pk_bf16_f32 v241, v242, v243
v_cvt_pk_bf16_f32 v242, v244, v245
v_mfma_f32_16x16x32_bf16 v[156:159], a[164:167], a[248:251], v[156:159]
v_cvt_pk_bf16_f32 v243, v246, v247
v_mfma_f32_16x16x32_bf16 v[156:159], a[160:163], a[252:255], v[156:159]
s_waitcnt lgkmcnt(0)
buffer_store_dwordx4 v[240:243], v1, s[44:47], s70 offen offset:2048 sc1
v_mfma_f32_16x16x32_bf16 v[128:131], a[128:131], a[192:195], v[128:131]
ds_read_b128 a[224:227], v7 offset:3776
ds_read_b64 a[160:161], v6 offset:192
v_accvgpr_read_b32 v248, a120
v_mfma_f32_16x16x32_bf16 v[132:135], a[132:135], a[192:195], v[132:135]
v_accvgpr_read_b32 v249, a121
v_accvgpr_read_b32 v250, a122
v_accvgpr_read_b32 v251, a123
v_mfma_f32_16x16x32_bf16 v[132:135], a[128:131], a[196:199], v[132:135]
ds_read_b64 a[162:163], v6 offset:200
ds_read_b128 a[228:231], v7 offset:3264
v_accvgpr_read_b32 v252, a124
v_mfma_f32_16x16x32_bf16 v[136:139], a[128:131], a[200:203], v[136:139]
v_accvgpr_read_b32 v253, a125
v_accvgpr_read_b32 v254, a126
v_accvgpr_read_b32 v255, a127
v_mfma_f32_16x16x32_bf16 v[136:139], a[132:135], a[196:199], v[136:139]
v_mul_f32 v248, v248, v236
v_mul_f32 v249, v249, v236
v_mul_f32 v250, v250, v236
v_mfma_f32_16x16x32_bf16 v[136:139], a[136:139], a[192:195], v[136:139]
ds_read_b64 a[164:165], v6 offset:704
ds_read_b64 a[166:167], v6 offset:712
v_mul_f32 v251, v251, v236
v_mfma_f32_16x16x32_bf16 v[140:143], a[140:143], a[192:195], v[140:143]
v_mul_f32 v252, v252, v236
v_mul_f32 v253, v253, v236
v_mul_f32 v254, v254, v236
v_mfma_f32_16x16x32_bf16 v[140:143], a[136:139], a[196:199], v[140:143]
ds_read_b128 a[232:235], v7 offset:2752
ds_read_b64 a[168:169], v6 offset:1216
v_mul_f32 v255, v255, v236
v_mfma_f32_16x16x32_bf16 v[140:143], a[132:135], a[200:203], v[140:143]
v_cvt_pk_bf16_f32 v248, v248, v249
v_cvt_pk_bf16_f32 v249, v250, v251
v_cvt_pk_bf16_f32 v250, v252, v253
v_mfma_f32_16x16x32_bf16 v[140:143], a[128:131], a[204:207], v[140:143]
v_cvt_pk_bf16_f32 v251, v254, v255
v_mfma_f32_16x16x32_bf16 v[144:147], a[128:131], a[208:211], v[144:147]
ds_read_b64 a[170:171], v6 offset:1224
ds_read_b128 a[236:239], v7 offset:2240
v_mfma_f32_16x16x32_bf16 v[144:147], a[132:135], a[204:207], v[144:147]
buffer_store_dwordx4 v[248:251], v1, s[44:47], s70 offen offset:3072 sc1
v_mfma_f32_16x16x32_bf16 v[144:147], a[136:139], a[200:203], v[144:147]
s_mov_b32 s73, 0x5d800000
ds_read_b64 a[172:173], v6 offset:1728
ds_read_b64 a[174:175], v6 offset:1736
v_add_f32 v227, v226, v230
v_mfma_f32_16x16x32_bf16 v[144:147], a[140:143], a[196:199], v[144:147]
v_add_f32 v231, v234, v238
v_add_f32 v227, v227, v231
v_cmp_nlt_f32 vcc, v227, s73
v_mfma_f32_16x16x32_bf16 v[144:147], a[144:147], a[192:195], v[144:147]
s_lshl_b32 s73, s58, 2
v_mfma_f32_16x16x32_bf16 v[148:151], a[148:151], a[192:195], v[148:151]
s_add_u32 s73, s73, 163328
ds_read_b128 a[240:243], v7 offset:1728
ds_read_b64 a[176:177], v6 offset:2240
v_mov_b32 v231, s73
v_mfma_f32_16x16x32_bf16 v[148:151], a[144:147], a[196:199], v[148:151]
s_or_b32 s73, vcc_lo, vcc_hi
v_mfma_f32_16x16x32_bf16 v[148:151], a[140:143], a[200:203], v[148:151]
s_min_u32 s73, s73, 1
v_mov_b32 v227, s73
v_mfma_f32_16x16x32_bf16 v[148:151], a[136:139], a[204:207], v[148:151]
ds_read_b64 a[178:179], v6 offset:2248
ds_read_b128 a[244:247], v7 offset:1216
ds_write_b32 v231, v227
v_mfma_f32_16x16x32_bf16 v[148:151], a[132:135], a[208:211], v[148:151]
v_mfma_f32_16x16x32_bf16 v[148:151], a[128:131], a[212:215], v[148:151]
ds_read_b64 a[180:181], v6 offset:2752
ds_read_b64 a[182:183], v6 offset:2760
v_mfma_f32_16x16x32_bf16 v[152:155], a[128:131], a[216:219], v[152:155]
v_mfma_f32_16x16x32_bf16 v[152:155], a[132:135], a[212:215], v[152:155]
v_mfma_f32_16x16x32_bf16 v[152:155], a[136:139], a[208:211], v[152:155]
ds_read_b128 a[248:251], v7 offset:704
ds_read_b64 a[184:185], v6 offset:3264
v_mfma_f32_16x16x32_bf16 v[152:155], a[140:143], a[204:207], v[152:155]
v_mfma_f32_16x16x32_bf16 v[152:155], a[144:147], a[200:203], v[152:155]
s_xor_b32 s71, s12, 0x100
ds_read_b64 a[186:187], v6 offset:3272
ds_read_b128 a[252:255], v7 offset:192
v_mfma_f32_16x16x32_bf16 v[152:155], a[148:151], a[196:199], v[152:155]
s_add_u32 m0, s77, 16384
v_mfma_f32_16x16x32_bf16 v[152:155], a[152:155], a[192:195], v[152:155]
s_add_u32 s72, s71, 0
buffer_load_dwordx4 v15, s[24:27], s72 offen lds
v_mfma_f32_16x16x32_bf16 v[156:159], a[156:159], a[192:195], v[156:159]
ds_read_b64 a[188:189], v6 offset:3776
ds_read_b64 a[190:191], v6 offset:3784
v_mfma_f32_16x16x32_bf16 v[156:159], a[152:155], a[196:199], v[156:159]
v_mfma_f32_16x16x32_bf16 v[156:159], a[148:151], a[200:203], v[156:159]
s_add_u32 s72, s71, 15360
buffer_load_dwordx4 v15, s[24:27], s72 offen offset:1024 lds
v_mfma_f32_16x16x32_bf16 v[156:159], a[144:147], a[204:207], v[156:159]
v_mfma_f32_16x16x32_bf16 v[156:159], a[140:143], a[208:211], v[156:159]
v_mfma_f32_16x16x32_bf16 v[156:159], a[136:139], a[212:215], v[156:159]
v_mfma_f32_16x16x32_bf16 v[156:159], a[132:135], a[216:219], v[156:159]
v_mfma_f32_16x16x32_bf16 v[156:159], a[128:131], a[220:223], v[156:159]
s_waitcnt lgkmcnt(0)
v_mfma_f32_16x16x32_bf16 v[128:131], a[160:163], a[224:227], v[128:131]
s_add_u32 s72, s71, 30720
ds_read_b128 a[192:195], v7 offset:3840
ds_read_b64 a[128:129], v6 offset:256
s_nop 3
s_mov_b64 exec, 0
s_cmp_eq_u32 s58, 0
s_cbranch_scc1 Lstube0
s_cmp_eq_u32 s58, 1
s_cbranch_scc1 Lstube1
s_cmp_eq_u32 s58, 2
s_cbranch_scc1 Lstube2
s_branch Lstube3
Lrete:
s_mov_b64 exec, -1
s_nop 3
v_mfma_f32_16x16x32_bf16 v[132:135], a[164:167], a[224:227], v[132:135]
s_waitcnt vmcnt(2) lgkmcnt(10)
buffer_load_dwordx4 v15, s[24:27], s72 offen offset:2048 lds
v_mfma_f32_16x16x32_bf16 v[132:135], a[160:163], a[228:231], v[132:135]
s_barrier
ds_read_b64 a[130:131], v6 offset:264
ds_read_b128 a[196:199], v7 offset:3328
v_mfma_f32_16x16x32_bf16 v[136:139], a[160:163], a[232:235], v[136:139]
v_mov_b32 v244, 163328
v_mfma_f32_16x16x32_bf16 v[136:139], a[164:167], a[228:231], v[136:139]
ds_read_b128 v[240:243], v244
v_mfma_f32_16x16x32_bf16 v[136:139], a[168:171], a[224:227], v[136:139]
ds_read_b64 a[132:133], v6 offset:768
ds_read_b64 a[134:135], v6 offset:776
v_mfma_f32_16x16x32_bf16 v[140:143], a[172:175], a[224:227], v[140:143]
s_add_u32 s72, s71, 46080
buffer_load_dwordx4 v15, s[24:27], s72 offen offset:3072 lds
v_mfma_f32_16x16x32_bf16 v[140:143], a[168:171], a[228:231], v[140:143]
ds_read_b128 a[200:203], v7 offset:2816
ds_read_b64 a[136:137], v6 offset:1280
v_mfma_f32_16x16x32_bf16 v[140:143], a[164:167], a[232:235], v[140:143]
v_mfma_f32_16x16x32_bf16 v[140:143], a[160:163], a[236:239], v[140:143]
s_waitcnt lgkmcnt(4)
v_or3_b32 v240, v240, v241, v242
v_or_b32 v240, v240, v243
v_mfma_f32_16x16x32_bf16 v[144:147], a[160:163], a[240:243], v[144:147]
ds_read_b64 a[138:139], v6 offset:1288
ds_read_b128 a[204:207], v7 offset:2304
v_cmp_lt_u32 vcc, s86, v240
s_cbranch_vccnz Lslow
v_mfma_f32_16x16x32_bf16 v[144:147], a[164:167], a[236:239], v[144:147]
v_or_b32 v240, s58, v0
v_mov_b32 v241, 2
v_mfma_f32_16x16x32_bf16 v[144:147], a[168:171], a[232:235], v[144:147]
s_xor_b32 s71, s12, 0x180
ds_read_b64 a[140:141], v6 offset:1792
ds_read_b64 a[142:143], v6 offset:1800
v_mfma_f32_16x16x32_bf16 v[144:147], a[172:175], a[228:231], v[144:147]
s_add_u32 m0, s77, 32768
v_min_u32 v240, 1, v240
v_lshlrev_b32 v240, 30, v240
v_mfma_f32_16x16x32_bf16 v[144:147], a[176:179], a[224:227], v[144:147]
s_add_u32 s72, s71, 0
buffer_load_dwordx4 v15, s[24:27], s72 offen lds
v_mfma_f32_16x16x32_bf16 v[148:151], a[180:183], a[224:227], v[148:151]
ds_read_b128 a[208:211], v7 offset:1792
ds_read_b64 a[144:145], v6 offset:2304
v_mfma_f32_16x16x32_bf16 v[148:151], a[176:179], a[228:231], v[148:151]
buffer_store_dword v241, v240, s[44:47], s91 offen sc1
v_mfma_f32_16x16x32_bf16 v[148:151], a[172:175], a[232:235], v[148:151]
s_add_u32 s80, s93, 0x3400000
v_and_b32 v166, 7, v0
v_lshlrev_b32 v166, 4, v166
v_mfma_f32_16x16x32_bf16 v[148:151], a[168:171], a[236:239], v[148:151]
s_add_u32 s72, s71, 15360
ds_read_b64 a[146:147], v6 offset:2312
ds_read_b128 a[212:215], v7 offset:1280
v_mfma_f32_16x16x32_bf16 v[148:151], a[164:167], a[240:243], v[148:151]
buffer_load_dwordx4 v15, s[24:27], s72 offen offset:1024 lds
v_mfma_f32_16x16x32_bf16 v[148:151], a[160:163], a[244:247], v[148:151]
ds_read_b64 a[148:149], v6 offset:2816
ds_read_b64 a[150:151], v6 offset:2824
v_mfma_f32_16x16x32_bf16 v[152:155], a[160:163], a[248:251], v[152:155]
v_bfe_u32 v112, v0, 3, 1
v_lshl_add_u32 v166, v112, 8, v166
v_mfma_f32_16x16x32_bf16 v[152:155], a[164:167], a[244:247], v[152:155]
v_bfe_u32 v112, v0, 4, 1
v_lshl_add_u32 v166, v112, 7, v166
v_mfma_f32_16x16x32_bf16 v[152:155], a[168:171], a[240:243], v[152:155]
ds_read_b128 a[216:219], v7 offset:768
ds_read_b64 a[152:153], v6 offset:3328
v_mfma_f32_16x16x32_bf16 v[152:155], a[172:175], a[236:239], v[152:155]
s_add_u32 s72, s71, 30720
buffer_load_dwordx4 v15, s[24:27], s72 offen offset:2048 lds
v_mfma_f32_16x16x32_bf16 v[152:155], a[176:179], a[232:235], v[152:155]
ds_read_b64 a[154:155], v6 offset:3336
ds_read_b128 a[220:223], v7 offset:256
v_mfma_f32_16x16x32_bf16 v[152:155], a[180:183], a[228:231], v[152:155]
v_lshrrev_b32 v112, 5, v0
v_lshl_add_u32 v166, v112, 9, v166
v_mfma_f32_16x16x32_bf16 v[152:155], a[184:187], a[224:227], v[152:155]
v_and_b32 v112, 15, v0
v_lshrrev_b32 v113, 2, v0
v_mfma_f32_16x16x32_bf16 v[156:159], a[188:191], a[224:227], v[156:159]
ds_read_b64 a[156:157], v6 offset:3840
ds_read_b64 a[158:159], v6 offset:3848
v_mfma_f32_16x16x32_bf16 v[156:159], a[184:187], a[228:231], v[156:159]
v_bfe_u32 v114, v0, 3, 2
v_and_b32 v115, 3, v0
v_mfma_f32_16x16x32_bf16 v[156:159], a[180:183], a[232:235], v[156:159]
s_add_u32 s72, s71, 46080
buffer_load_dwordx4 v15, s[24:27], s72 offen offset:3072 lds
v_mfma_f32_16x16x32_bf16 v[156:159], a[176:179], a[236:239], v[156:159]
v_lshlrev_b32 v8, 7, v113
v_lshl_add_u32 v8, v114, 5, v8
v_mfma_f32_16x16x32_bf16 v[156:159], a[172:175], a[240:243], v[156:159]
v_lshl_add_u32 v8, v115, 3, v8
v_add_u32 v8, s77, v8
v_mfma_f32_16x16x32_bf16 v[156:159], a[168:171], a[244:247], v[156:159]
v_subrev_u32 v8, s64, v8
v_xor_b32 v9, 32, v8
v_mfma_f32_16x16x32_bf16 v[156:159], a[164:167], a[248:251], v[156:159]
v_lshrrev_b32 v2, 4, v0
v_lshlrev_b32 v2, 10, v2
v_mfma_f32_16x16x32_bf16 v[156:159], a[160:163], a[252:255], v[156:159]
s_waitcnt lgkmcnt(0)
v_xor_b32 v10, 64, v8
v_xor_b32 v11, 0x60, v8
v_mfma_f32_16x16x32_bf16 v[128:131], a[128:131], a[192:195], v[128:131]
s_xor_b32 s71, s13, 0x80
ds_read_b128 a[224:227], v7 offset:3904
ds_read_b64 a[160:161], v6 offset:320
v_mfma_f32_16x16x32_bf16 v[132:135], a[132:135], a[192:195], v[132:135]
s_add_u32 m0, s77, 49152
v_lshlrev_b32 v5, 8, v113
v_and_b32 v114, 1, v0
v_mfma_f32_16x16x32_bf16 v[132:135], a[128:131], a[196:199], v[132:135]
s_add_u32 s72, s71, 0
ds_read_b64 a[162:163], v6 offset:328
ds_read_b128 a[228:231], v7 offset:3392
v_mfma_f32_16x16x32_bf16 v[136:139], a[128:131], a[200:203], v[136:139]
s_xor_b32 s82, s78, 0
buffer_load_dwordx4 v15, s[24:27], s72 offen lds
v_mfma_f32_16x16x32_bf16 v[136:139], a[132:135], a[196:199], v[136:139]
s_lshl_b32 s82, s82, 10
v_lshl_add_u32 v5, v114, 7, v5
v_bfe_u32 v114, v0, 1, 1
v_mfma_f32_16x16x32_bf16 v[136:139], a[136:139], a[192:195], v[136:139]
s_add_u32 s82, s82, s74
ds_read_b64 a[164:165], v6 offset:832
ds_read_b64 a[166:167], v6 offset:840
v_mfma_f32_16x16x32_bf16 v[140:143], a[140:143], a[192:195], v[140:143]
s_add_u32 s72, s71, 15360
buffer_load_dwordx4 v15, s[24:27], s72 offen offset:1024 lds
v_mfma_f32_16x16x32_bf16 v[140:143], a[136:139], a[196:199], v[140:143]
ds_read_b128 a[232:235], v7 offset:2880
ds_read_b64 a[168:169], v6 offset:1344
v_mfma_f32_16x16x32_bf16 v[140:143], a[132:135], a[200:203], v[140:143]
buffer_load_dword v3, v2, s[44:47], s82 offen sc1
v_mfma_f32_16x16x32_bf16 v[140:143], a[128:131], a[204:207], v[140:143]
v_lshl_add_u32 v5, v114, 3, v5
v_lshlrev_b32 v114, 1, s58
v_mfma_f32_16x16x32_bf16 v[144:147], a[128:131], a[208:211], v[144:147]
ds_read_b64 a[170:171], v6 offset:1352
ds_read_b128 a[236:239], v7 offset:2368
v_mfma_f32_16x16x32_bf16 v[144:147], a[132:135], a[204:207], v[144:147]
v_xor_b32 v114, v114, v113
v_and_b32 v114, 7, v114
v_mfma_f32_16x16x32_bf16 v[144:147], a[136:139], a[200:203], v[144:147]
s_add_u32 s72, s71, 30720
ds_read_b64 a[172:173], v6 offset:1856
ds_read_b64 a[174:175], v6 offset:1864
v_mfma_f32_16x16x32_bf16 v[144:147], a[140:143], a[196:199], v[144:147]
buffer_load_dwordx4 v15, s[24:27], s72 offen offset:2048 lds
v_mfma_f32_16x16x32_bf16 v[144:147], a[144:147], a[192:195], v[144:147]
v_lshl_add_u32 v5, v114, 4, v5
v_add_u32 v5, 147456, v5
v_mfma_f32_16x16x32_bf16 v[148:151], a[148:151], a[192:195], v[148:151]
ds_read_b128 a[240:243], v7 offset:1856
ds_read_b64 a[176:177], v6 offset:2368
v_mfma_f32_16x16x32_bf16 v[148:151], a[144:147], a[196:199], v[148:151]
v_bfe_u32 v114, v0, 1, 2
v_lshrrev_b32 v115, 4, v0
v_mfma_f32_16x16x32_bf16 v[148:151], a[140:143], a[200:203], v[148:151]
v_lshlrev_b32 v116, 7, v112
v_lshl_add_u32 v116, v114, 5, v116
v_mfma_f32_16x16x32_bf16 v[148:151], a[136:139], a[204:207], v[148:151]
s_add_u32 s72, s71, 46080
ds_read_b64 a[178:179], v6 offset:2376
ds_read_b128 a[244:247], v7 offset:1344
v_mfma_f32_16x16x32_bf16 v[148:151], a[132:135], a[208:211], v[148:151]
buffer_load_dwordx4 v15, s[24:27], s72 offen offset:3072 lds
v_mfma_f32_16x16x32_bf16 v[148:151], a[128:131], a[212:215], v[148:151]
ds_read_b64 a[180:181], v6 offset:2880
ds_read_b64 a[182:183], v6 offset:2888
v_mfma_f32_16x16x32_bf16 v[152:155], a[128:131], a[216:219], v[152:155]
v_lshl_add_u32 v116, v115, 3, v116
v_add_u32 v116, s64, v116
v_mfma_f32_16x16x32_bf16 v[152:155], a[132:135], a[212:215], v[152:155]
v_add_u32 v116, 131072, v116
v_xor_b32 v117, 32, v116
v_mfma_f32_16x16x32_bf16 v[152:155], a[136:139], a[208:211], v[152:155]
ds_read_b128 a[248:251], v7 offset:832
ds_read_b64 a[184:185], v6 offset:3392
v_mfma_f32_16x16x32_bf16 v[152:155], a[140:143], a[204:207], v[152:155]
v_xor_b32 v118, 64, v116
v_xor_b32 v119, 0x60, v116
v_mfma_f32_16x16x32_bf16 v[152:155], a[144:147], a[200:203], v[152:155]
ds_read_b64 a[186:187], v6 offset:3400
ds_read_b128 a[252:255], v7 offset:320
v_mfma_f32_16x16x32_bf16 v[152:155], a[148:151], a[196:199], v[152:155]
v_mfma_f32_16x16x32_bf16 v[152:155], a[152:155], a[192:195], v[152:155]
v_mfma_f32_16x16x32_bf16 v[156:159], a[156:159], a[192:195], v[156:159]
ds_read_b64 a[188:189], v6 offset:3904
ds_read_b64 a[190:191], v6 offset:3912
v_mfma_f32_16x16x32_bf16 v[156:159], a[152:155], a[196:199], v[156:159]
v_mfma_f32_16x16x32_bf16 v[156:159], a[148:151], a[200:203], v[156:159]
v_mfma_f32_16x16x32_bf16 v[156:159], a[144:147], a[204:207], v[156:159]
v_mfma_f32_16x16x32_bf16 v[156:159], a[140:143], a[208:211], v[156:159]
v_mfma_f32_16x16x32_bf16 v[156:159], a[136:139], a[212:215], v[156:159]
v_mfma_f32_16x16x32_bf16 v[156:159], a[132:135], a[216:219], v[156:159]
v_mfma_f32_16x16x32_bf16 v[156:159], a[128:131], a[220:223], v[156:159]
s_waitcnt lgkmcnt(0)
v_mfma_f32_16x16x32_bf16 v[128:131], a[160:163], a[224:227], v[128:131]
ds_read_b128 a[192:195], v7 offset:3968
ds_read_b64 a[128:129], v6 offset:384
v_mfma_f32_16x16x32_bf16 v[132:135], a[164:167], a[224:227], v[132:135]
v_mfma_f32_16x16x32_bf16 v[132:135], a[160:163], a[228:231], v[132:135]
ds_read_b64 a[130:131], v6 offset:392
ds_read_b128 a[196:199], v7 offset:3456
v_mfma_f32_16x16x32_bf16 v[136:139], a[160:163], a[232:235], v[136:139]
v_mfma_f32_16x16x32_bf16 v[136:139], a[164:167], a[228:231], v[136:139]
v_mfma_f32_16x16x32_bf16 v[136:139], a[168:171], a[224:227], v[136:139]
ds_read_b64 a[132:133], v6 offset:896
ds_read_b64 a[134:135], v6 offset:904
v_mfma_f32_16x16x32_bf16 v[140:143], a[172:175], a[224:227], v[140:143]
v_mfma_f32_16x16x32_bf16 v[140:143], a[168:171], a[228:231], v[140:143]
ds_read_b128 a[200:203], v7 offset:2944
ds_read_b64 a[136:137], v6 offset:1408
v_mfma_f32_16x16x32_bf16 v[140:143], a[164:167], a[232:235], v[140:143]
v_mfma_f32_16x16x32_bf16 v[140:143], a[160:163], a[236:239], v[140:143]
v_mfma_f32_16x16x32_bf16 v[144:147], a[160:163], a[240:243], v[144:147]
ds_read_b64 a[138:139], v6 offset:1416
ds_read_b128 a[204:207], v7 offset:2432
v_mfma_f32_16x16x32_bf16 v[144:147], a[164:167], a[236:239], v[144:147]
v_mfma_f32_16x16x32_bf16 v[144:147], a[168:171], a[232:235], v[144:147]
ds_read_b64 a[140:141], v6 offset:1920
ds_read_b64 a[142:143], v6 offset:1928
v_mfma_f32_16x16x32_bf16 v[144:147], a[172:175], a[228:231], v[144:147]
v_mfma_f32_16x16x32_bf16 v[144:147], a[176:179], a[224:227], v[144:147]
v_mfma_f32_16x16x32_bf16 v[148:151], a[180:183], a[224:227], v[148:151]
ds_read_b128 a[208:211], v7 offset:1920
ds_read_b64 a[144:145], v6 offset:2432
v_mfma_f32_16x16x32_bf16 v[148:151], a[176:179], a[228:231], v[148:151]
v_mfma_f32_16x16x32_bf16 v[148:151], a[172:175], a[232:235], v[148:151]
s_waitcnt vmcnt(2)
v_cmp_gt_u32 vcc, 2, v3
s_or_b32 s81, vcc_lo, vcc_hi
s_cselect_b32 s81, 0x40000000, 0
v_or_b32 v4, s81, v1
v_mfma_f32_16x16x32_bf16 v[148:151], a[168:171], a[236:239], v[148:151]
ds_read_b64 a[146:147], v6 offset:2440
ds_read_b128 a[212:215], v7 offset:1408
v_mfma_f32_16x16x32_bf16 v[148:151], a[164:167], a[240:243], v[148:151]
v_mfma_f32_16x16x32_bf16 v[148:151], a[160:163], a[244:247], v[148:151]
ds_read_b64 a[148:149], v6 offset:2944
ds_read_b64 a[150:151], v6 offset:2952
v_mfma_f32_16x16x32_bf16 v[152:155], a[160:163], a[248:251], v[152:155]
v_mfma_f32_16x16x32_bf16 v[152:155], a[164:167], a[244:247], v[152:155]
s_lshr_b32 s69, s12, 18
v_mfma_f32_16x16x32_bf16 v[152:155], a[168:171], a[240:243], v[152:155]
s_lshl_b32 s69, s69, 12
ds_read_b128 a[216:219], v7 offset:896
ds_read_b64 a[152:153], v6 offset:3456
v_mfma_f32_16x16x32_bf16 v[152:155], a[172:175], a[236:239], v[152:155]
s_add_u32 s69, s69, s95
buffer_load_dwordx4 a[0:3], v4, s[44:47], s69 offen sc1
v_mfma_f32_16x16x32_bf16 v[152:155], a[176:179], a[232:235], v[152:155]
ds_read_b64 a[154:155], v6 offset:3464
ds_read_b128 a[220:223], v7 offset:384
v_mfma_f32_16x16x32_bf16 v[152:155], a[180:183], a[228:231], v[152:155]
v_mfma_f32_16x16x32_bf16 v[152:155], a[184:187], a[224:227], v[152:155]
v_mfma_f32_16x16x32_bf16 v[156:159], a[188:191], a[224:227], v[156:159]
ds_read_b64 a[156:157], v6 offset:3968
ds_read_b64 a[158:159], v6 offset:3976
v_mfma_f32_16x16x32_bf16 v[156:159], a[184:187], a[228:231], v[156:159]
buffer_load_dwordx4 a[4:7], v4, s[44:47], s69 offen offset:1024 sc1
v_mfma_f32_16x16x32_bf16 v[156:159], a[180:183], a[232:235], v[156:159]
v_mfma_f32_16x16x32_bf16 v[156:159], a[176:179], a[236:239], v[156:159]
v_mfma_f32_16x16x32_bf16 v[156:159], a[172:175], a[240:243], v[156:159]
v_mfma_f32_16x16x32_bf16 v[156:159], a[168:171], a[244:247], v[156:159]
buffer_load_dwordx4 a[8:11], v4, s[44:47], s69 offen offset:2048 sc1
v_mfma_f32_16x16x32_bf16 v[156:159], a[164:167], a[248:251], v[156:159]
v_mfma_f32_16x16x32_bf16 v[156:159], a[160:163], a[252:255], v[156:159]
s_waitcnt lgkmcnt(0)
v_mfma_f32_16x16x32_bf16 v[128:131], a[128:131], a[192:195], v[128:131]
ds_read_b128 a[224:227], v7 offset:4032
ds_read_b64 a[160:161], v6 offset:448
v_mfma_f32_16x16x32_bf16 v[132:135], a[132:135], a[192:195], v[132:135]
v_mfma_f32_16x16x32_bf16 v[132:135], a[128:131], a[196:199], v[132:135]
ds_read_b64 a[162:163], v6 offset:456
ds_read_b128 a[228:231], v7 offset:3520
v_mfma_f32_16x16x32_bf16 v[136:139], a[128:131], a[200:203], v[136:139]
buffer_load_dwordx4 a[12:15], v4, s[44:47], s69 offen offset:3072 sc1
v_mfma_f32_16x16x32_bf16 v[136:139], a[132:135], a[196:199], v[136:139]
v_mfma_f32_16x16x32_bf16 v[136:139], a[136:139], a[192:195], v[136:139]
ds_read_b64 a[164:165], v6 offset:960
ds_read_b64 a[166:167], v6 offset:968
v_mfma_f32_16x16x32_bf16 v[140:143], a[140:143], a[192:195], v[140:143]
v_mfma_f32_16x16x32_bf16 v[140:143], a[136:139], a[196:199], v[140:143]
ds_read_b128 a[232:235], v7 offset:3008
ds_read_b64 a[168:169], v6 offset:1472
v_mfma_f32_16x16x32_bf16 v[140:143], a[132:135], a[200:203], v[140:143]
s_add_u32 s69, s69, 0x20000
buffer_load_dwordx4 a[16:19], v4, s[44:47], s69 offen sc1
v_mfma_f32_16x16x32_bf16 v[140:143], a[128:131], a[204:207], v[140:143]
v_mfma_f32_16x16x32_bf16 v[144:147], a[128:131], a[208:211], v[144:147]
ds_read_b64 a[170:171], v6 offset:1480
ds_read_b128 a[236:239], v7 offset:2496
v_mfma_f32_16x16x32_bf16 v[144:147], a[132:135], a[204:207], v[144:147]
v_mfma_f32_16x16x32_bf16 v[144:147], a[136:139], a[200:203], v[144:147]
ds_read_b64 a[172:173], v6 offset:1984
ds_read_b64 a[174:175], v6 offset:1992
v_mfma_f32_16x16x32_bf16 v[144:147], a[140:143], a[196:199], v[144:147]
buffer_load_dwordx4 a[20:23], v4, s[44:47], s69 offen offset:1024 sc1
v_mfma_f32_16x16x32_bf16 v[144:147], a[144:147], a[192:195], v[144:147]
v_mfma_f32_16x16x32_bf16 v[148:151], a[148:151], a[192:195], v[148:151]
ds_read_b128 a[240:243], v7 offset:1984
ds_read_b64 a[176:177], v6 offset:2496
v_mfma_f32_16x16x32_bf16 v[148:151], a[144:147], a[196:199], v[148:151]
Lstub9:
s_cbranch_execz Lret
v_mfma_f32_16x16x32_bf16 v[148:151], a[140:143], a[200:203], v[148:151]
v_mfma_f32_16x16x32_bf16 v[148:151], a[136:139], a[204:207], v[148:151]
ds_read_b64 a[178:179], v6 offset:2504
ds_read_b128 a[244:247], v7 offset:1472
v_mfma_f32_16x16x32_bf16 v[148:151], a[132:135], a[208:211], v[148:151]
buffer_load_dwordx4 a[24:27], v4, s[44:47], s69 offen offset:2048 sc1
v_mfma_f32_16x16x32_bf16 v[148:151], a[128:131], a[212:215], v[148:151]
ds_read_b64 a[180:181], v6 offset:3008
ds_read_b64 a[182:183], v6 offset:3016
v_mfma_f32_16x16x32_bf16 v[152:155], a[128:131], a[216:219], v[152:155]
v_mfma_f32_16x16x32_bf16 v[152:155], a[132:135], a[212:215], v[152:155]
v_mfma_f32_16x16x32_bf16 v[152:155], a[136:139], a[208:211], v[152:155]
ds_read_b128 a[248:251], v7 offset:960
ds_read_b64 a[184:185], v6 offset:3520
v_mfma_f32_16x16x32_bf16 v[152:155], a[140:143], a[204:207], v[152:155]
buffer_load_dwordx4 a[28:31], v4, s[44:47], s69 offen offset:3072 sc1
v_mfma_f32_16x16x32_bf16 v[152:155], a[144:147], a[200:203], v[152:155]
ds_read_b64 a[186:187], v6 offset:3528
ds_read_b128 a[252:255], v7 offset:448
v_mfma_f32_16x16x32_bf16 v[152:155], a[148:151], a[196:199], v[152:155]
v_mfma_f32_16x16x32_bf16 v[152:155], a[152:155], a[192:195], v[152:155]
s_lshr_b32 s69, s13, 18
v_mfma_f32_16x16x32_bf16 v[156:159], a[156:159], a[192:195], v[156:159]
s_lshl_b32 s69, s69, 12
ds_read_b64 a[188:189], v6 offset:4032
ds_read_b64 a[190:191], v6 offset:4040
v_mfma_f32_16x16x32_bf16 v[156:159], a[152:155], a[196:199], v[156:159]
s_add_u32 s69, s69, s95
buffer_load_dwordx4 a[32:35], v4, s[44:47], s69 offen sc1
v_mfma_f32_16x16x32_bf16 v[156:159], a[148:151], a[200:203], v[156:159]
v_mfma_f32_16x16x32_bf16 v[156:159], a[144:147], a[204:207], v[156:159]
v_mfma_f32_16x16x32_bf16 v[156:159], a[140:143], a[208:211], v[156:159]
v_mfma_f32_16x16x32_bf16 v[156:159], a[136:139], a[212:215], v[156:159]
buffer_load_dwordx4 a[36:39], v4, s[44:47], s69 offen offset:1024 sc1
v_mfma_f32_16x16x32_bf16 v[156:159], a[132:135], a[216:219], v[156:159]
v_mfma_f32_16x16x32_bf16 v[156:159], a[128:131], a[220:223], v[156:159]
s_waitcnt lgkmcnt(0)
v_mfma_f32_16x16x32_bf16 v[128:131], a[160:163], a[224:227], v[128:131]
ds_read_b64_tr_b16 v[192:193], v8 offset:0
ds_read_b64_tr_b16 v[194:195], v8 offset:2048
v_mfma_f32_16x16x32_bf16 v[132:135], a[164:167], a[224:227], v[132:135]
v_mfma_f32_16x16x32_bf16 v[132:135], a[160:163], a[228:231], v[132:135]
ds_read_b64_tr_b16 v[196:197], v9 offset:0
ds_read_b64_tr_b16 v[198:199], v9 offset:2048
v_mfma_f32_16x16x32_bf16 v[136:139], a[160:163], a[232:235], v[136:139]
buffer_load_dwordx4 a[40:43], v4, s[44:47], s69 offen offset:2048 sc1
v_mfma_f32_16x16x32_bf16 v[136:139], a[164:167], a[228:231], v[136:139]
ds_read_b64_tr_b16 v[200:201], v10 offset:0
ds_read_b64_tr_b16 v[202:203], v10 offset:2048
v_mfma_f32_16x16x32_bf16 v[136:139], a[168:171], a[224:227], v[136:139]
v_mfma_f32_16x16x32_bf16 v[140:143], a[172:175], a[224:227], v[140:143]
ds_read_b64_tr_b16 v[204:205], v11 offset:0
ds_read_b64_tr_b16 v[206:207], v11 offset:2048
v_mfma_f32_16x16x32_bf16 v[140:143], a[168:171], a[228:231], v[140:143]
v_cvt_pk_bf16_f32 v128, v128, v129
v_cvt_pk_bf16_f32 v129, v130, v131
v_cvt_pk_bf16_f32 v130, v132, v133
v_mfma_f32_16x16x32_bf16 v[140:143], a[164:167], a[232:235], v[140:143]
ds_read_b64_tr_b16 v[208:209], v8 offset:4096
ds_read_b64_tr_b16 v[210:211], v8 offset:6144
v_cvt_pk_bf16_f32 v131, v134, v135
v_mfma_f32_16x16x32_bf16 v[140:143], a[160:163], a[236:239], v[140:143]
buffer_load_dwordx4 a[44:47], v4, s[44:47], s69 offen offset:3072 sc1
v_permlane32_swap_b32 v128, v130
v_mfma_f32_16x16x32_bf16 v[144:147], a[160:163], a[240:243], v[144:147]
ds_read_b64_tr_b16 v[212:213], v9 offset:4096
ds_read_b64_tr_b16 v[214:215], v9 offset:6144
v_permlane32_swap_b32 v129, v131
v_mfma_f32_16x16x32_bf16 v[144:147], a[164:167], a[236:239], v[144:147]
buffer_store_dwordx4 v[128:131], v166, s[44:47], s80 offen sc1
v_mfma_f32_16x16x32_bf16 v[144:147], a[168:171], a[232:235], v[144:147]
ds_read_b64_tr_b16 v[216:217], v10 offset:4096
ds_read_b64_tr_b16 v[218:219], v10 offset:6144
v_mfma_f32_16x16x32_bf16 v[144:147], a[172:175], a[228:231], v[144:147]
s_add_u32 s69, s69, 0x20000
buffer_load_dwordx4 a[48:51], v4, s[44:47], s69 offen sc1
v_mfma_f32_16x16x32_bf16 v[144:147], a[176:179], a[224:227], v[144:147]
ds_read_b64_tr_b16 v[220:221], v11 offset:4096
ds_read_b64_tr_b16 v[222:223], v11 offset:6144
v_cvt_pk_bf16_f32 v136, v136, v137
v_mfma_f32_16x16x32_bf16 v[148:151], a[180:183], a[224:227], v[148:151]
v_cvt_pk_bf16_f32 v137, v138, v139
v_cvt_pk_bf16_f32 v138, v140, v141
v_cvt_pk_bf16_f32 v139, v142, v143
v_mfma_f32_16x16x32_bf16 v[148:151], a[176:179], a[228:231], v[148:151]
ds_read_b64_tr_b16 v[224:225], v8 offset:8192
ds_read_b64_tr_b16 v[226:227], v8 offset:10240
v_permlane32_swap_b32 v136, v138
v_mfma_f32_16x16x32_bf16 v[148:151], a[172:175], a[232:235], v[148:151]
v_permlane32_swap_b32 v137, v139
v_mfma_f32_16x16x32_bf16 v[148:151], a[168:171], a[236:239], v[148:151]
ds_read_b64_tr_b16 v[228:229], v9 offset:8192
ds_read_b64_tr_b16 v[230:231], v9 offset:10240
v_mfma_f32_16x16x32_bf16 v[148:151], a[164:167], a[240:243], v[148:151]
buffer_load_dwordx4 a[52:55], v4, s[44:47], s69 offen offset:1024 sc1
v_mfma_f32_16x16x32_bf16 v[148:151], a[160:163], a[244:247], v[148:151]
ds_read_b64_tr_b16 v[232:233], v10 offset:8192
ds_read_b64_tr_b16 v[234:235], v10 offset:10240
v_mfma_f32_16x16x32_bf16 v[152:155], a[160:163], a[248:251], v[152:155]
buffer_store_dwordx4 v[136:139], v166, s[44:47], s80 offen offset:1024 sc1
v_mfma_f32_16x16x32_bf16 v[152:155], a[164:167], a[244:247], v[152:155]
ds_read_b64_tr_b16 v[236:237], v11 offset:8192
ds_read_b64_tr_b16 v[238:239], v11 offset:10240
v_mfma_f32_16x16x32_bf16 v[152:155], a[168:171], a[240:243], v[152:155]
buffer_load_dwordx4 a[56:59], v4, s[44:47], s69 offen offset:2048 sc1
v_mfma_f32_16x16x32_bf16 v[152:155], a[172:175], a[236:239], v[152:155]
ds_read_b64_tr_b16 v[240:241], v8 offset:12288
ds_read_b64_tr_b16 v[242:243], v8 offset:14336
v_mfma_f32_16x16x32_bf16 v[152:155], a[176:179], a[232:235], v[152:155]
v_cvt_pk_bf16_f32 v144, v144, v145
v_cvt_pk_bf16_f32 v145, v146, v147
v_cvt_pk_bf16_f32 v146, v148, v149
v_mfma_f32_16x16x32_bf16 v[152:155], a[180:183], a[228:231], v[152:155]
ds_read_b64_tr_b16 v[244:245], v9 offset:12288
ds_read_b64_tr_b16 v[246:247], v9 offset:14336
v_cvt_pk_bf16_f32 v147, v150, v151
v_mfma_f32_16x16x32_bf16 v[152:155], a[184:187], a[224:227], v[152:155]
v_permlane32_swap_b32 v144, v146
v_permlane32_swap_b32 v145, v147
v_mfma_f32_16x16x32_bf16 v[156:159], a[188:191], a[224:227], v[156:159]
ds_read_b64_tr_b16 v[248:249], v10 offset:12288
ds_read_b64_tr_b16 v[250:251], v10 offset:14336
v_mfma_f32_16x16x32_bf16 v[156:159], a[184:187], a[228:231], v[156:159]
buffer_load_dwordx4 a[60:63], v4, s[44:47], s69 offen offset:3072 sc1
v_mfma_f32_16x16x32_bf16 v[156:159], a[180:183], a[232:235], v[156:159]
ds_read_b64_tr_b16 v[252:253], v11 offset:12288
ds_read_b64_tr_b16 v[254:255], v11 offset:14336
v_mfma_f32_16x16x32_bf16 v[156:159], a[176:179], a[236:239], v[156:159]
buffer_store_dwordx4 v[144:147], v166, s[44:47], s80 offen offset:2048 sc1
v_mfma_f32_16x16x32_bf16 v[156:159], a[172:175], a[240:243], v[156:159]
v_mfma_f32_16x16x32_bf16 v[156:159], a[168:171], a[244:247], v[156:159]
v_mfma_f32_16x16x32_bf16 v[156:159], a[164:167], a[248:251], v[156:159]
v_mfma_f32_16x16x32_bf16 v[156:159], a[160:163], a[252:255], v[156:159]
v_cvt_pk_bf16_f32 v152, v152, v153
v_cvt_pk_bf16_f32 v153, v154, v155
s_nop 5
v_cvt_pk_bf16_f32 v154, v156, v157
v_cvt_pk_bf16_f32 v155, v158, v159
s_nop 0
v_permlane32_swap_b32 v152, v154
v_permlane32_swap_b32 v153, v155
buffer_store_dwordx4 v[152:155], v166, s[44:47], s80 offen offset:3072 sc1
s_waitcnt vmcnt(12) lgkmcnt(0)
s_cmp_lg_u32 s81, 0
s_cbranch_scc1 Lredo0
Lredo0b:
s_barrier
v_mfma_f32_16x16x32_bf16 v[16:19], v[192:195], a[0:3], 0
s_nop 0
ds_read_b64_tr_b16 v[128:129], v8 offset:16384
ds_read_b64_tr_b16 v[130:131], v8 offset:18432
v_mfma_f32_16x16x32_bf16 v[16:19], v[208:211], a[4:7], v[16:19]
s_xor_b32 s71, s13, 0x100
ds_read_b64_tr_b16 v[132:133], v9 offset:16384
ds_read_b64_tr_b16 v[134:135], v9 offset:18432
v_mfma_f32_16x16x32_bf16 v[16:19], v[224:227], a[8:11], v[16:19]
s_add_u32 m0, s85, 0
ds_read_b64_tr_b16 v[136:137], v10 offset:16384
ds_read_b64_tr_b16 v[138:139], v10 offset:18432
v_mfma_f32_16x16x32_bf16 v[16:19], v[240:243], a[12:15], v[16:19]
s_add_u32 s72, s71, 0
buffer_load_dwordx4 v15, s[24:27], s72 offen lds
v_mfma_f32_16x16x32_bf16 v[32:35], v[240:243], a[28:31], 0
s_lshr_b32 s69, s14, 18
ds_read_b64_tr_b16 v[140:141], v11 offset:16384
ds_read_b64_tr_b16 v[142:143], v11 offset:18432
v_mfma_f32_16x16x32_bf16 v[32:35], v[224:227], a[24:27], v[32:35]
s_lshl_b32 s69, s69, 12
v_add_u32 v4, s64, v1
v_add_u32 v4, 131072, v4
v_mfma_f32_16x16x32_bf16 v[32:35], v[208:211], a[20:23], v[32:35]
s_add_u32 s69, s69, s95
buffer_load_dwordx4 a[64:67], v1, s[44:47], s69 offen sc1
v_mfma_f32_16x16x32_bf16 v[32:35], v[192:195], a[16:19], v[32:35]
s_lshl_b32 s70, s75, 18
ds_read_b64_tr_b16 v[144:145], v8 offset:20480
ds_read_b64_tr_b16 v[146:147], v8 offset:22528
v_mfma_f32_16x16x32_bf16 v[36:39], v[196:199], a[16:19], 0
s_add_u32 s72, s71, 15360
buffer_load_dwordx4 v15, s[24:27], s72 offen offset:1024 lds
v_mfma_f32_16x16x32_bf16 v[36:39], v[212:215], a[20:23], v[36:39]
s_add_u32 s70, s70, s94
ds_read_b64_tr_b16 v[148:149], v9 offset:20480
ds_read_b64_tr_b16 v[150:151], v9 offset:22528
v_mfma_f32_16x16x32_bf16 v[36:39], v[228:231], a[24:27], v[36:39]
s_nop 0
ds_read_b64_tr_b16 v[152:153], v10 offset:20480
ds_read_b64_tr_b16 v[154:155], v10 offset:22528
v_mfma_f32_16x16x32_bf16 v[36:39], v[244:247], a[28:31], v[36:39]
s_nop 0
ds_read_b64_tr_b16 v[156:157], v11 offset:20480
ds_read_b64_tr_b16 v[158:159], v11 offset:22528
v_mfma_f32_16x16x32_bf16 v[20:23], v[244:247], a[12:15], 0
ds_write_b128 v4, v[80:83] offset:0
v_mfma_f32_16x16x32_bf16 v[20:23], v[228:231], a[8:11], v[20:23]
s_nop 0
ds_read_b64_tr_b16 v[160:161], v8 offset:24576
ds_read_b64_tr_b16 v[162:163], v8 offset:26624
v_mfma_f32_16x16x32_bf16 v[20:23], v[212:215], a[4:7], v[20:23]
s_add_u32 s72, s71, 30720
buffer_load_dwordx4 v15, s[24:27], s72 offen offset:2048 lds
v_mfma_f32_16x16x32_bf16 v[20:23], v[196:199], a[0:3], v[20:23]
buffer_load_dwordx4 a[68:71], v1, s[44:47], s69 offen offset:1024 sc1
v_mfma_f32_16x16x32_bf16 v[24:27], v[200:203], a[0:3], 0
s_nop 0
ds_read_b64_tr_b16 v[164:165], v9 offset:24576
ds_read_b64_tr_b16 v[166:167], v9 offset:26624
v_mfma_f32_16x16x32_bf16 v[24:27], v[216:219], a[4:7], v[24:27]
s_nop 0
ds_read_b64_tr_b16 v[168:169], v10 offset:24576
ds_read_b64_tr_b16 v[170:171], v10 offset:26624
v_mfma_f32_16x16x32_bf16 v[24:27], v[232:235], a[8:11], v[24:27]
s_nop 0
ds_read_b64_tr_b16 v[172:173], v11 offset:24576
ds_read_b64_tr_b16 v[174:175], v11 offset:26624
v_mfma_f32_16x16x32_bf16 v[24:27], v[248:251], a[12:15], v[24:27]
ds_write_b128 v4, v[84:87] offset:1024
v_mfma_f32_16x16x32_bf16 v[40:43], v[248:251], a[28:31], 0
s_add_u32 s72, s71, 46080
buffer_load_dwordx4 v15, s[24:27], s72 offen offset:3072 lds
v_mfma_f32_16x16x32_bf16 v[40:43], v[232:235], a[24:27], v[40:43]
s_nop 0
ds_read_b64_tr_b16 v[176:177], v8 offset:28672
ds_read_b64_tr_b16 v[178:179], v8 offset:30720
v_mfma_f32_16x16x32_bf16 v[40:43], v[216:219], a[20:23], v[40:43]
s_nop 0
ds_read_b64_tr_b16 v[180:181], v9 offset:28672
ds_read_b64_tr_b16 v[182:183], v9 offset:30720
v_mfma_f32_16x16x32_bf16 v[40:43], v[200:203], a[16:19], v[40:43]
s_nop 0
ds_read_b64_tr_b16 v[184:185], v10 offset:28672
ds_read_b64_tr_b16 v[186:187], v10 offset:30720
v_mfma_f32_16x16x32_bf16 v[44:47], v[204:207], a[16:19], 0
s_nop 0
ds_read_b64_tr_b16 v[188:189], v11 offset:28672
ds_read_b64_tr_b16 v[190:191], v11 offset:30720
v_mfma_f32_16x16x32_bf16 v[44:47], v[220:223], a[20:23], v[44:47]
buffer_load_dwordx4 a[72:75], v1, s[44:47], s69 offen offset:2048 sc1
v_mfma_f32_16x16x32_bf16 v[44:47], v[236:239], a[24:27], v[44:47]
ds_write_b128 v4, v[96:99] offset:2048
v_mfma_f32_16x16x32_bf16 v[44:47], v[252:255], a[28:31], v[44:47]
s_xor_b32 s71, s13, 0x180
v_mfma_f32_16x16x32_bf16 v[28:31], v[252:255], a[12:15], 0
s_add_u32 m0, s85, 16384
ds_write_b128 v4, v[100:103] offset:3072
v_mfma_f32_16x16x32_bf16 v[28:31], v[236:239], a[8:11], v[28:31]
s_add_u32 s72, s71, 0
v_mfma_f32_16x16x32_bf16 v[28:31], v[220:223], a[4:7], v[28:31]
s_waitcnt vmcnt(32) lgkmcnt(0)
buffer_load_dwordx4 v15, s[24:27], s72 offen lds
v_mfma_f32_16x16x32_bf16 v[28:31], v[204:207], a[0:3], v[28:31]
s_barrier
v_mfma_f32_16x16x32_bf16 v[48:51], v[128:131], a[0:3], 0
s_nop 0
ds_read_b64_tr_b16 v[192:193], v8 offset:32768
ds_read_b64_tr_b16 v[194:195], v8 offset:34816
v_mfma_f32_16x16x32_bf16 v[48:51], v[144:147], a[4:7], v[48:51]
s_nop 0
ds_read_b64_tr_b16 v[196:197], v9 offset:32768
ds_read_b64_tr_b16 v[198:199], v9 offset:34816
v_mfma_f32_16x16x32_bf16 v[48:51], v[160:163], a[8:11], v[48:51]
s_nop 0
ds_read_b64_tr_b16 v[200:201], v10 offset:32768
ds_read_b64_tr_b16 v[202:203], v10 offset:34816
v_mfma_f32_16x16x32_bf16 v[48:51], v[176:179], a[12:15], v[48:51]
s_add_u32 s72, s71, 15360
buffer_load_dwordx4 v15, s[24:27], s72 offen offset:1024 lds
v_mfma_f32_16x16x32_bf16 v[64:67], v[176:179], a[28:31], 0
buffer_load_dwordx4 a[76:79], v1, s[44:47], s69 offen offset:3072 sc1
v_mfma_f32_16x16x32_bf16 v[64:67], v[160:163], a[24:27], v[64:67]
s_nop 0
ds_read_b64_tr_b16 v[204:205], v11 offset:32768
ds_read_b64_tr_b16 v[206:207], v11 offset:34816
v_mfma_f32_16x16x32_bf16 v[64:67], v[144:147], a[20:23], v[64:67]
v_mfma_f32_16x16x32_bf16 v[64:67], v[128:131], a[16:19], v[64:67]
s_nop 0
ds_read_b64_tr_b16 v[208:209], v8 offset:36864
ds_read_b64_tr_b16 v[210:211], v8 offset:38912
v_mfma_f32_16x16x32_bf16 v[68:71], v[132:135], a[16:19], 0
s_nop 0
ds_read_b64_tr_b16 v[212:213], v9 offset:36864
ds_read_b64_tr_b16 v[214:215], v9 offset:38912
v_mfma_f32_16x16x32_bf16 v[68:71], v[148:151], a[20:23], v[68:71]
s_add_u32 s72, s71, 30720
buffer_load_dwordx4 v15, s[24:27], s72 offen offset:2048 lds
v_mfma_f32_16x16x32_bf16 v[68:71], v[164:167], a[24:27], v[68:71]
s_nop 0
ds_read_b64_tr_b16 v[216:217], v10 offset:36864
ds_read_b64_tr_b16 v[218:219], v10 offset:38912
v_mfma_f32_16x16x32_bf16 v[68:71], v[180:183], a[28:31], v[68:71]
s_nop 0
ds_read_b64_tr_b16 v[220:221], v11 offset:36864
ds_read_b64_tr_b16 v[222:223], v11 offset:38912
v_mfma_f32_16x16x32_bf16 v[52:55], v[180:183], a[12:15], 0
v_mfma_f32_16x16x32_bf16 v[52:55], v[164:167], a[8:11], v[52:55]
s_add_u32 s69, s69, 0x20000
buffer_load_dwordx4 a[80:83], v1, s[44:47], s69 offen sc1
v_mfma_f32_16x16x32_bf16 v[52:55], v[148:151], a[4:7], v[52:55]
s_nop 0
ds_read_b64_tr_b16 v[224:225], v8 offset:40960
ds_read_b64_tr_b16 v[226:227], v8 offset:43008
v_mfma_f32_16x16x32_bf16 v[52:55], v[132:135], a[0:3], v[52:55]
s_add_u32 s72, s71, 46080
buffer_load_dwordx4 v15, s[24:27], s72 offen offset:3072 lds
v_mfma_f32_16x16x32_bf16 v[56:59], v[136:139], a[0:3], 0
s_nop 0
ds_read_b64_tr_b16 v[228:229], v9 offset:40960
ds_read_b64_tr_b16 v[230:231], v9 offset:43008
v_mfma_f32_16x16x32_bf16 v[56:59], v[152:155], a[4:7], v[56:59]
s_nop 0
ds_read_b64_tr_b16 v[232:233], v10 offset:40960
ds_read_b64_tr_b16 v[234:235], v10 offset:43008
v_mfma_f32_16x16x32_bf16 v[56:59], v[168:171], a[8:11], v[56:59]
s_nop 0
ds_read_b64_tr_b16 v[236:237], v11 offset:40960
ds_read_b64_tr_b16 v[238:239], v11 offset:43008
v_mfma_f32_16x16x32_bf16 v[56:59], v[184:187], a[12:15], v[56:59]
v_mfma_f32_16x16x32_bf16 v[72:75], v[184:187], a[28:31], 0
s_nop 0
ds_read_b64_tr_b16 v[240:241], v8 offset:45056
ds_read_b64_tr_b16 v[242:243], v8 offset:47104
v_mfma_f32_16x16x32_bf16 v[72:75], v[168:171], a[24:27], v[72:75]
s_nop 0
ds_read_b64_tr_b16 v[244:245], v9 offset:45056
ds_read_b64_tr_b16 v[246:247], v9 offset:47104
v_mfma_f32_16x16x32_bf16 v[72:75], v[152:155], a[20:23], v[72:75]
s_nop 0
ds_read_b64_tr_b16 v[248:249], v10 offset:45056
ds_read_b64_tr_b16 v[250:251], v10 offset:47104
v_mfma_f32_16x16x32_bf16 v[72:75], v[136:139], a[16:19], v[72:75]
s_xor_b32 s71, s14, 0x80
buffer_load_dwordx4 a[84:87], v1, s[44:47], s69 offen offset:1024 sc1
v_mfma_f32_16x16x32_bf16 v[76:79], v[140:143], a[16:19], 0
s_add_u32 m0, s85, 32768
ds_read_b64_tr_b16 v[252:253], v11 offset:45056
ds_read_b64_tr_b16 v[254:255], v11 offset:47104
v_mfma_f32_16x16x32_bf16 v[76:79], v[156:159], a[20:23], v[76:79]
s_add_u32 s72, s71, 0
buffer_load_dwordx4 v15, s[24:27], s72 offen lds
v_mfma_f32_16x16x32_bf16 v[76:79], v[172:175], a[24:27], v[76:79]
v_mfma_f32_16x16x32_bf16 v[76:79], v[188:191], a[28:31], v[76:79]
v_mfma_f32_16x16x32_bf16 v[60:63], v[188:191], a[12:15], 0
v_mfma_f32_16x16x32_bf16 v[60:63], v[172:175], a[8:11], v[60:63]
s_add_u32 s72, s71, 15360
v_mfma_f32_16x16x32_bf16 v[60:63], v[156:159], a[4:7], v[60:63]
s_waitcnt vmcnt(35) lgkmcnt(0)
v_mfma_f32_16x16x32_bf16 v[60:63], v[140:143], a[0:3], v[60:63]
s_barrier
buffer_load_dwordx4 v15, s[24:27], s72 offen offset:1024 lds
v_mfma_f32_16x16x32_bf16 v[80:83], v[192:195], a[0:3], 0
s_nop 0
ds_read_b64_tr_b16 v[128:129], v8 offset:49152
ds_read_b64_tr_b16 v[130:131], v8 offset:51200
v_mfma_f32_16x16x32_bf16 v[80:83], v[208:211], a[4:7], v[80:83]
buffer_load_dwordx4 a[88:91], v1, s[44:47], s69 offen offset:2048 sc1
v_mfma_f32_16x16x32_bf16 v[80:83], v[224:227], a[8:11], v[80:83]
s_nop 0
ds_read_b64_tr_b16 v[132:133], v9 offset:49152
ds_read_b64_tr_b16 v[134:135], v9 offset:51200
v_mfma_f32_16x16x32_bf16 v[80:83], v[240:243], a[12:15], v[80:83]
s_nop 0
ds_read_b64_tr_b16 v[136:137], v10 offset:49152
ds_read_b64_tr_b16 v[138:139], v10 offset:51200
v_mfma_f32_16x16x32_bf16 v[96:99], v[240:243], a[28:31], 0
s_nop 0
ds_read_b64_tr_b16 v[140:141], v11 offset:49152
ds_read_b64_tr_b16 v[142:143], v11 offset:51200
v_mfma_f32_16x16x32_bf16 v[96:99], v[224:227], a[24:27], v[96:99]
s_add_u32 s72, s71, 30720
buffer_load_dwordx4 v15, s[24:27], s72 offen offset:2048 lds
v_mfma_f32_16x16x32_bf16 v[96:99], v[208:211], a[20:23], v[96:99]
v_mfma_f32_16x16x32_bf16 v[96:99], v[192:195], a[16:19], v[96:99]
s_nop 0
ds_read_b64_tr_b16 v[144:145], v8 offset:53248
ds_read_b64_tr_b16 v[146:147], v8 offset:55296
v_mfma_f32_16x16x32_bf16 v[100:103], v[196:199], a[16:19], 0
s_nop 0
ds_read_b64_tr_b16 v[148:149], v9 offset:53248
ds_read_b64_tr_b16 v[150:151], v9 offset:55296
v_mfma_f32_16x16x32_bf16 v[100:103], v[212:215], a[20:23], v[100:103]
s_nop 0
ds_read_b64_tr_b16 v[152:153], v10 offset:53248
ds_read_b64_tr_b16 v[154:155], v10 offset:55296
v_mfma_f32_16x16x32_bf16 v[100:103], v[228:231], a[24:27], v[100:103]
s_nop 0
ds_read_b64_tr_b16 v[156:157], v11 offset:53248
ds_read_b64_tr_b16 v[158:159], v11 offset:55296
v_mfma_f32_16x16x32_bf16 v[100:103], v[244:247], a[28:31], v[100:103]
s_add_u32 s72, s71, 46080
buffer_load_dwordx4 v15, s[24:27], s72 offen offset:3072 lds
v_mfma_f32_16x16x32_bf16 v[84:87], v[244:247], a[12:15], 0
buffer_load_dwordx4 a[92:95], v1, s[44:47], s69 offen offset:3072 sc1
v_mfma_f32_16x16x32_bf16 v[84:87], v[228:231], a[8:11], v[84:87]
v_mfma_f32_16x16x32_bf16 v[84:87], v[212:215], a[4:7], v[84:87]
s_nop 0
ds_read_b64_tr_b16 v[160:161], v8 offset:57344
ds_read_b64_tr_b16 v[162:163], v8 offset:59392
v_mfma_f32_16x16x32_bf16 v[84:87], v[196:199], a[0:3], v[84:87]
s_nop 0
ds_read_b64_tr_b16 v[164:165], v9 offset:57344
ds_read_b64_tr_b16 v[166:167], v9 offset:59392
v_mfma_f32_16x16x32_bf16 v[88:91], v[200:203], a[0:3], 0
s_nop 0
ds_read_b64_tr_b16 v[168:169], v10 offset:57344
ds_read_b64_tr_b16 v[170:171], v10 offset:59392
v_mfma_f32_16x16x32_bf16 v[88:91], v[216:219], a[4:7], v[88:91]
s_xor_b32 s82, s78, 16
ds_read_b64_tr_b16 v[172:173], v11 offset:57344
ds_read_b64_tr_b16 v[174:175], v11 offset:59392
v_mfma_f32_16x16x32_bf16 v[88:91], v[232:235], a[8:11], v[88:91]
s_lshl_b32 s82, s82, 10
v_mfma_f32_16x16x32_bf16 v[88:91], v[248:251], a[12:15], v[88:91]
s_xor_b32 s71, s14, 0x100
ds_read_b64_tr_b16 v[176:177], v8 offset:61440
ds_read_b64_tr_b16 v[178:179], v8 offset:63488
v_mfma_f32_16x16x32_bf16 v[104:107], v[248:251], a[28:31], 0
s_add_u32 m0, s85, 49152
ds_read_b64_tr_b16 v[180:181], v9 offset:61440
ds_read_b64_tr_b16 v[182:183], v9 offset:63488
v_mfma_f32_16x16x32_bf16 v[104:107], v[232:235], a[24:27], v[104:107]
s_add_u32 s72, s71, 0
buffer_load_dwordx4 v15, s[24:27], s72 offen lds
v_mfma_f32_16x16x32_bf16 v[104:107], v[216:219], a[20:23], v[104:107]
s_add_u32 s82, s82, s74
buffer_load_dword v3, v2, s[44:47], s82 offen sc1
v_mfma_f32_16x16x32_bf16 v[104:107], v[200:203], a[16:19], v[104:107]
s_nop 0
ds_read_b64_tr_b16 v[184:185], v10 offset:61440
ds_read_b64_tr_b16 v[186:187], v10 offset:63488
v_mfma_f32_16x16x32_bf16 v[108:111], v[204:207], a[16:19], 0
s_nop 0
ds_read_b64_tr_b16 v[188:189], v11 offset:61440
ds_read_b64_tr_b16 v[190:191], v11 offset:63488
v_mfma_f32_16x16x32_bf16 v[108:111], v[220:223], a[20:23], v[108:111]
v_mfma_f32_16x16x32_bf16 v[108:111], v[236:239], a[24:27], v[108:111]
s_add_u32 s72, s71, 15360
buffer_load_dwordx4 v15, s[24:27], s72 offen offset:1024 lds
v_mfma_f32_16x16x32_bf16 v[108:111], v[252:255], a[28:31], v[108:111]
s_lshr_b32 s69, s15, 18
v_mfma_f32_16x16x32_bf16 v[92:95], v[252:255], a[12:15], 0
s_lshl_b32 s69, s69, 12
v_xor_b32 v8, 0x10000, v8
v_mfma_f32_16x16x32_bf16 v[92:95], v[236:239], a[8:11], v[92:95]
s_add_u32 s69, s69, s95
v_xor_b32 v9, 0x10000, v9
v_mfma_f32_16x16x32_bf16 v[92:95], v[220:223], a[4:7], v[92:95]
s_waitcnt vmcnt(17) lgkmcnt(0)
v_xor_b32 v10, 0x10000, v10
v_mfma_f32_16x16x32_bf16 v[92:95], v[204:207], a[0:3], v[92:95]
s_barrier
buffer_load_dwordx4 a[96:99], v1, s[44:47], s69 offen sc1
v_xor_b32 v11, 0x10000, v11
v_mfma_f32_16x16x32_bf16 v[16:19], v[128:131], a[32:35], v[16:19]
s_add_u32 s72, s71, 30720
buffer_load_dwordx4 v15, s[24:27], s72 offen offset:2048 lds
v_mfma_f32_16x16x32_bf16 v[16:19], v[144:147], a[36:39], v[16:19]
s_nop 0
ds_read_b64_tr_b16 v[192:193], v8 offset:0
ds_read_b64_tr_b16 v[194:195], v8 offset:2048
v_mfma_f32_16x16x32_bf16 v[16:19], v[160:163], a[40:43], v[16:19]
s_nop 0
ds_read_b64_tr_b16 v[196:197], v9 offset:0
ds_read_b64_tr_b16 v[198:199], v9 offset:2048
v_mfma_f32_16x16x32_bf16 v[16:19], v[176:179], a[44:47], v[16:19]
s_nop 0
ds_read_b64_tr_b16 v[200:201], v10 offset:0
ds_read_b64_tr_b16 v[202:203], v10 offset:2048
v_mfma_f32_16x16x32_bf16 v[32:35], v[176:179], a[60:63], v[32:35]
s_nop 0
ds_read_b64_tr_b16 v[204:205], v11 offset:0
ds_read_b64_tr_b16 v[206:207], v11 offset:2048
v_mfma_f32_16x16x32_bf16 v[32:35], v[160:163], a[56:59], v[32:35]
v_or_b32 v112, s58, v0
v_mov_b32 v113, 3
v_mfma_f32_16x16x32_bf16 v[32:35], v[144:147], a[52:55], v[32:35]
s_add_u32 s72, s71, 46080
buffer_load_dwordx4 v15, s[24:27], s72 offen offset:3072 lds
v_mfma_f32_16x16x32_bf16 v[32:35], v[128:131], a[48:51], v[32:35]
s_nop 0
ds_read_b64_tr_b16 v[208:209], v8 offset:4096
ds_read_b64_tr_b16 v[210:211], v8 offset:6144
v_mfma_f32_16x16x32_bf16 v[36:39], v[132:135], a[48:51], v[36:39]
s_nop 0
ds_read_b64_tr_b16 v[212:213], v9 offset:4096
ds_read_b64_tr_b16 v[214:215], v9 offset:6144
v_mfma_f32_16x16x32_bf16 v[36:39], v[148:151], a[52:55], v[36:39]
buffer_load_dwordx4 a[100:103], v1, s[44:47], s69 offen offset:1024 sc1
v_mfma_f32_16x16x32_bf16 v[36:39], v[164:167], a[56:59], v[36:39]
s_nop 0
ds_read_b64_tr_b16 v[216:217], v10 offset:4096
ds_read_b64_tr_b16 v[218:219], v10 offset:6144
v_mfma_f32_16x16x32_bf16 v[36:39], v[180:183], a[60:63], v[36:39]
v_min_u32 v112, 1, v112
v_lshlrev_b32 v112, 30, v112
v_mfma_f32_16x16x32_bf16 v[20:23], v[180:183], a[44:47], v[20:23]
s_nop 0
ds_read_b64_tr_b16 v[220:221], v11 offset:4096
ds_read_b64_tr_b16 v[222:223], v11 offset:6144
v_mfma_f32_16x16x32_bf16 v[20:23], v[164:167], a[40:43], v[20:23]
s_nop 0
ds_read_b64_tr_b16 v[224:225], v8 offset:8192
ds_read_b64_tr_b16 v[226:227], v8 offset:10240
v_mfma_f32_16x16x32_bf16 v[20:23], v[148:151], a[36:39], v[20:23]
s_xor_b32 s71, s14, 0x180
ds_read_b64_tr_b16 v[228:229], v9 offset:8192
ds_read_b64_tr_b16 v[230:231], v9 offset:10240
v_mfma_f32_16x16x32_bf16 v[20:23], v[132:135], a[32:35], v[20:23]
s_add_u32 m0, s77, 0
buffer_store_dword v113, v112, s[44:47], s91 offen sc1
v_mfma_f32_16x16x32_bf16 v[24:27], v[136:139], a[32:35], v[24:27]
s_add_u32 s72, s71, 0
buffer_load_dwordx4 v15, s[24:27], s72 offen lds
v_mfma_f32_16x16x32_bf16 v[24:27], v[152:155], a[36:39], v[24:27]
s_nop 0
ds_read_b64_tr_b16 v[232:233], v10 offset:8192
ds_read_b64_tr_b16 v[234:235], v10 offset:10240
v_mfma_f32_16x16x32_bf16 v[24:27], v[168:171], a[40:43], v[24:27]
s_nop 0
ds_read_b64_tr_b16 v[236:237], v11 offset:8192
ds_read_b64_tr_b16 v[238:239], v11 offset:10240
v_mfma_f32_16x16x32_bf16 v[24:27], v[184:187], a[44:47], v[24:27]
buffer_load_dwordx4 a[104:107], v1, s[44:47], s69 offen offset:2048 sc1
v_mfma_f32_16x16x32_bf16 v[40:43], v[184:187], a[60:63], v[40:43]
s_nop 0
ds_read_b64_tr_b16 v[240:241], v8 offset:12288
ds_read_b64_tr_b16 v[242:243], v8 offset:14336
v_mfma_f32_16x16x32_bf16 v[40:43], v[168:171], a[56:59], v[40:43]
v_mfma_f32_16x16x32_bf16 v[40:43], v[152:155], a[52:55], v[40:43]
s_add_u32 s72, s71, 15360
buffer_load_dwordx4 v15, s[24:27], s72 offen offset:1024 lds
v_mfma_f32_16x16x32_bf16 v[40:43], v[136:139], a[48:51], v[40:43]
s_nop 0
ds_read_b64_tr_b16 v[244:245], v9 offset:12288
ds_read_b64_tr_b16 v[246:247], v9 offset:14336
v_mfma_f32_16x16x32_bf16 v[44:47], v[140:143], a[48:51], v[44:47]
s_nop 0
ds_read_b64_tr_b16 v[248:249], v10 offset:12288
ds_read_b64_tr_b16 v[250:251], v10 offset:14336
v_mfma_f32_16x16x32_bf16 v[44:47], v[156:159], a[52:55], v[44:47]
s_nop 0
ds_read_b64_tr_b16 v[252:253], v11 offset:12288
ds_read_b64_tr_b16 v[254:255], v11 offset:14336
v_mfma_f32_16x16x32_bf16 v[44:47], v[172:175], a[56:59], v[44:47]
v_mfma_f32_16x16x32_bf16 v[44:47], v[188:191], a[60:63], v[44:47]
v_mfma_f32_16x16x32_bf16 v[28:31], v[188:191], a[44:47], v[28:31]
s_add_u32 s72, s71, 30720
buffer_load_dwordx4 v15, s[24:27], s72 offen offset:2048 lds
v_mfma_f32_16x16x32_bf16 v[28:31], v[172:175], a[40:43], v[28:31]
buffer_load_dwordx4 a[108:111], v1, s[44:47], s69 offen offset:3072 sc1
v_mfma_f32_16x16x32_bf16 v[28:31], v[156:159], a[36:39], v[28:31]
s_waitcnt vmcnt(20) lgkmcnt(0)
v_mfma_f32_16x16x32_bf16 v[28:31], v[140:143], a[32:35], v[28:31]
s_barrier
v_mfma_f32_16x16x32_bf16 v[48:51], v[192:195], a[32:35], v[48:51]
s_nop 0
ds_read_b64_tr_b16 v[128:129], v8 offset:16384
ds_read_b64_tr_b16 v[130:131], v8 offset:18432
v_mfma_f32_16x16x32_bf16 v[48:51], v[208:211], a[36:39], v[48:51]
s_nop 0
ds_read_b64_tr_b16 v[132:133], v9 offset:16384
ds_read_b64_tr_b16 v[134:135], v9 offset:18432
v_mfma_f32_16x16x32_bf16 v[48:51], v[224:227], a[40:43], v[48:51]
s_add_u32 s72, s71, 46080
buffer_load_dwordx4 v15, s[24:27], s72 offen offset:3072 lds
v_mfma_f32_16x16x32_bf16 v[48:51], v[240:243], a[44:47], v[48:51]
s_nop 0
ds_read_b64_tr_b16 v[136:137], v10 offset:16384
ds_read_b64_tr_b16 v[138:139], v10 offset:18432
v_mfma_f32_16x16x32_bf16 v[64:67], v[240:243], a[60:63], v[64:67]
s_nop 0
ds_read_b64_tr_b16 v[140:141], v11 offset:16384
Lstube0:
s_cbranch_execz Lstube4
ds_read_b64_tr_b16 v[142:143], v11 offset:18432
v_mfma_f32_16x16x32_bf16 v[64:67], v[224:227], a[56:59], v[64:67]
v_and_b32 v120, 15, v0
v_lshrrev_b32 v121, 4, v0
v_mfma_f32_16x16x32_bf16 v[64:67], v[208:211], a[52:55], v[64:67]
s_nop 0
ds_read_b64_tr_b16 v[144:145], v8 offset:20480
ds_read_b64_tr_b16 v[146:147], v8 offset:22528
v_mfma_f32_16x16x32_bf16 v[64:67], v[192:195], a[48:51], v[64:67]
s_add_u32 s69, s69, 0x20000
buffer_load_dwordx4 a[112:115], v1, s[44:47], s69 offen sc1
v_mfma_f32_16x16x32_bf16 v[68:71], v[196:199], a[48:51], v[68:71]
s_nop 0
ds_read_b64_tr_b16 v[148:149], v9 offset:20480
ds_read_b64_tr_b16 v[150:151], v9 offset:22528
v_mfma_f32_16x16x32_bf16 v[68:71], v[212:215], a[52:55], v[68:71]
s_nop 0
ds_read_b64_tr_b16 v[152:153], v10 offset:20480
ds_read_b64_tr_b16 v[154:155], v10 offset:22528
v_mfma_f32_16x16x32_bf16 v[68:71], v[228:231], a[56:59], v[68:71]
s_xor_b32 s71, s15, 0x80
v_lshlrev_b32 v121, 2, v121
v_sub_u32 v120, v120, v121
v_mfma_f32_16x16x32_bf16 v[68:71], v[244:247], a[60:63], v[68:71]
s_add_u32 m0, s77, 16384
ds_read_b64_tr_b16 v[156:157], v11 offset:20480
ds_read_b64_tr_b16 v[158:159], v11 offset:22528
v_mfma_f32_16x16x32_bf16 v[52:55], v[244:247], a[44:47], v[52:55]
s_add_u32 s72, s71, 0
buffer_load_dwordx4 v15, s[24:27], s72 offen lds
v_mfma_f32_16x16x32_bf16 v[52:55], v[228:231], a[40:43], v[52:55]
s_nop 0
ds_read_b64_tr_b16 v[160:161], v8 offset:24576
ds_read_b64_tr_b16 v[162:163], v8 offset:26624
v_mfma_f32_16x16x32_bf16 v[52:55], v[212:215], a[36:39], v[52:55]
s_nop 0
ds_read_b64_tr_b16 v[164:165], v9 offset:24576
ds_read_b64_tr_b16 v[166:167], v9 offset:26624
v_mfma_f32_16x16x32_bf16 v[52:55], v[196:199], a[32:35], v[52:55]
v_min_u32 v120, 4, v120
v_lshlrev_b32 v120, 3, v120
v_mfma_f32_16x16x32_bf16 v[56:59], v[200:203], a[32:35], v[56:59]
s_nop 0
ds_read_b64_tr_b16 v[168:169], v10 offset:24576
ds_read_b64_tr_b16 v[170:171], v10 offset:26624
v_mfma_f32_16x16x32_bf16 v[56:59], v[216:219], a[36:39], v[56:59]
s_add_u32 s72, s71, 15360
buffer_load_dwordx4 v15, s[24:27], s72 offen offset:1024 lds
v_mfma_f32_16x16x32_bf16 v[56:59], v[232:235], a[40:43], v[56:59]
buffer_load_dwordx4 a[116:119], v1, s[44:47], s69 offen offset:1024 sc1
v_mfma_f32_16x16x32_bf16 v[56:59], v[248:251], a[44:47], v[56:59]
s_nop 0
ds_read_b64_tr_b16 v[172:173], v11 offset:24576
ds_read_b64_tr_b16 v[174:175], v11 offset:26624
v_mfma_f32_16x16x32_bf16 v[72:75], v[248:251], a[60:63], v[72:75]
s_nop 0
ds_read_b64_tr_b16 v[176:177], v8 offset:28672
ds_read_b64_tr_b16 v[178:179], v8 offset:30720
v_mfma_f32_16x16x32_bf16 v[72:75], v[232:235], a[56:59], v[72:75]
v_mov_b32 v122, 0x3f80
v_mov_b32 v123, 0
v_mfma_f32_16x16x32_bf16 v[72:75], v[216:219], a[52:55], v[72:75]
s_nop 0
ds_read_b64_tr_b16 v[180:181], v9 offset:28672
ds_read_b64_tr_b16 v[182:183], v9 offset:30720
v_mfma_f32_16x16x32_bf16 v[72:75], v[200:203], a[48:51], v[72:75]
s_add_u32 s72, s71, 30720
buffer_load_dwordx4 v15, s[24:27], s72 offen offset:2048 lds
v_mfma_f32_16x16x32_bf16 v[76:79], v[204:207], a[48:51], v[76:79]
s_nop 0
ds_read_b64_tr_b16 v[184:185], v10 offset:28672
ds_read_b64_tr_b16 v[186:187], v10 offset:30720
v_mfma_f32_16x16x32_bf16 v[76:79], v[220:223], a[52:55], v[76:79]
s_nop 0
ds_read_b64_tr_b16 v[188:189], v11 offset:28672
ds_read_b64_tr_b16 v[190:191], v11 offset:30720
v_mfma_f32_16x16x32_bf16 v[76:79], v[236:239], a[56:59], v[76:79]
v_lshlrev_b64 v[122:123], v120, v[122:123]
v_mov_b32 v126, 0
v_mfma_f32_16x16x32_bf16 v[76:79], v[252:255], a[60:63], v[76:79]
buffer_load_dwordx4 a[120:123], v1, s[44:47], s69 offen offset:2048 sc1
v_mfma_f32_16x16x32_bf16 v[60:63], v[252:255], a[44:47], v[60:63]
v_lshlrev_b64 v[122:123], v120, v[122:123]
v_mov_b32 v127, 0
v_mfma_f32_16x16x32_bf16 v[60:63], v[236:239], a[40:43], v[60:63]
s_add_u32 s72, s71, 46080
buffer_load_dwordx4 v15, s[24:27], s72 offen offset:3072 lds
v_mfma_f32_16x16x32_bf16 v[60:63], v[220:223], a[36:39], v[60:63]
s_waitcnt vmcnt(22) lgkmcnt(0)
v_mov_b32 v120, 0
v_mov_b32 v121, 0
v_mfma_f32_16x16x32_bf16 v[60:63], v[204:207], a[32:35], v[60:63]
s_barrier
v_mov_b32 v124, v122
v_mov_b32 v125, v123
v_mfma_f32_16x16x32_bf16 v[80:83], v[128:131], a[32:35], v[80:83]
s_nop 0
ds_read_b64_tr_b16 v[192:193], v8 offset:32768
ds_read_b64_tr_b16 v[194:195], v8 offset:34816
v_mfma_f32_16x16x32_bf16 v[80:83], v[144:147], a[36:39], v[80:83]
s_nop 0
ds_read_b64_tr_b16 v[196:197], v9 offset:32768
ds_read_b64_tr_b16 v[198:199], v9 offset:34816
v_mfma_f32_16x16x32_bf16 v[80:83], v[160:163], a[40:43], v[80:83]
s_nop 0
ds_read_b64_tr_b16 v[200:201], v10 offset:32768
ds_read_b64_tr_b16 v[202:203], v10 offset:34816
v_mfma_f32_16x16x32_bf16 v[80:83], v[176:179], a[44:47], v[80:83]
s_nop 0
ds_read_b64_tr_b16 v[204:205], v11 offset:32768
ds_read_b64_tr_b16 v[206:207], v11 offset:34816
v_mfma_f32_16x16x32_bf16 v[96:99], v[176:179], a[60:63], v[96:99]
v_mfma_f32_16x16x32_bf16 v[96:99], v[160:163], a[56:59], v[96:99]
s_xor_b32 s71, s15, 0x100
buffer_load_dwordx4 a[124:127], v1, s[44:47], s69 offen offset:3072 sc1
v_mfma_f32_16x16x32_bf16 v[96:99], v[144:147], a[52:55], v[96:99]
s_add_u32 m0, s77, 32768
ds_read_b64_tr_b16 v[208:209], v8 offset:36864
ds_read_b64_tr_b16 v[210:211], v8 offset:38912
v_mfma_f32_16x16x32_bf16 v[96:99], v[128:131], a[48:51], v[96:99]
s_add_u32 s72, s71, 0
buffer_load_dwordx4 v15, s[24:27], s72 offen lds
v_mfma_f32_16x16x32_bf16 v[100:103], v[132:135], a[48:51], v[100:103]
s_nop 0
ds_read_b64_tr_b16 v[212:213], v9 offset:36864
ds_read_b64_tr_b16 v[214:215], v9 offset:38912
v_mfma_f32_16x16x32_bf16 v[100:103], v[148:151], a[52:55], v[100:103]
s_nop 0
ds_read_b64_tr_b16 v[216:217], v10 offset:36864
ds_read_b64_tr_b16 v[218:219], v10 offset:38912
v_mfma_f32_16x16x32_bf16 v[100:103], v[164:167], a[56:59], v[100:103]
s_nop 0
ds_read_b64_tr_b16 v[220:221], v11 offset:36864
ds_read_b64_tr_b16 v[222:223], v11 offset:38912
v_mfma_f32_16x16x32_bf16 v[100:103], v[180:183], a[60:63], v[100:103]
v_mfma_f32_16x16x32_bf16 v[84:87], v[180:183], a[44:47], v[84:87]
s_nop 0
ds_read_b64_tr_b16 v[224:225], v8 offset:40960
ds_read_b64_tr_b16 v[226:227], v8 offset:43008
v_mfma_f32_16x16x32_bf16 v[84:87], v[164:167], a[40:43], v[84:87]
s_add_u32 s72, s71, 15360
buffer_load_dwordx4 v15, s[24:27], s72 offen offset:1024 lds
v_mfma_f32_16x16x32_bf16 v[84:87], v[148:151], a[36:39], v[84:87]
s_nop 0
ds_read_b64_tr_b16 v[228:229], v9 offset:40960
ds_read_b64_tr_b16 v[230:231], v9 offset:43008
v_mfma_f32_16x16x32_bf16 v[84:87], v[132:135], a[32:35], v[84:87]
s_waitcnt vmcnt(22)
v_cmp_gt_u32 vcc, 2, v3
s_cbranch_vccnz Lspin106
Lback107:
s_lshr_b32 s69, s12, 18
s_lshl_b32 s69, s69, 12
s_add_u32 s69, s69, s95
s_xor_b32 s69, s69, 0x10000
buffer_load_dwordx4 a[128:131], v1, s[44:47], s69 offen sc1
v_mfma_f32_16x16x32_bf16 v[88:91], v[136:139], a[32:35], v[88:91]
s_nop 0
ds_read_b64_tr_b16 v[232:233], v10 offset:40960
ds_read_b64_tr_b16 v[234:235], v10 offset:43008
v_mfma_f32_16x16x32_bf16 v[88:91], v[152:155], a[36:39], v[88:91]
s_nop 0
ds_read_b64_tr_b16 v[236:237], v11 offset:40960
ds_read_b64_tr_b16 v[238:239], v11 offset:43008
v_mfma_f32_16x16x32_bf16 v[88:91], v[168:171], a[40:43], v[88:91]
v_mfma_f32_16x16x32_bf16 v[88:91], v[184:187], a[44:47], v[88:91]
s_add_u32 s72, s71, 30720
buffer_load_dwordx4 v15, s[24:27], s72 offen offset:2048 lds
v_mfma_f32_16x16x32_bf16 v[104:107], v[184:187], a[60:63], v[104:107]
s_nop 0
ds_read_b64_tr_b16 v[240:241], v8 offset:45056
ds_read_b64_tr_b16 v[242:243], v8 offset:47104
v_mfma_f32_16x16x32_bf16 v[104:107], v[168:171], a[56:59], v[104:107]
s_nop 0
ds_read_b64_tr_b16 v[244:245], v9 offset:45056
ds_read_b64_tr_b16 v[246:247], v9 offset:47104
v_mfma_f32_16x16x32_bf16 v[104:107], v[152:155], a[52:55], v[104:107]
s_nop 0
ds_read_b64_tr_b16 v[248:249], v10 offset:45056
ds_read_b64_tr_b16 v[250:251], v10 offset:47104
v_mfma_f32_16x16x32_bf16 v[104:107], v[136:139], a[48:51], v[104:107]
s_nop 0
ds_read_b64_tr_b16 v[252:253], v11 offset:45056
ds_read_b64_tr_b16 v[254:255], v11 offset:47104
v_mfma_f32_16x16x32_bf16 v[108:111], v[140:143], a[48:51], v[108:111]
v_mfma_f32_16x16x32_bf16 v[108:111], v[156:159], a[52:55], v[108:111]
s_add_u32 s72, s71, 46080
buffer_load_dwordx4 v15, s[24:27], s72 offen offset:3072 lds
v_mfma_f32_16x16x32_bf16 v[108:111], v[172:175], a[56:59], v[108:111]
buffer_load_dwordx4 a[132:135], v1, s[44:47], s69 offen offset:1024 sc1
v_mfma_f32_16x16x32_bf16 v[108:111], v[188:191], a[60:63], v[108:111]
v_mfma_f32_16x16x32_bf16 v[92:95], v[188:191], a[44:47], v[92:95]
v_mfma_f32_16x16x32_bf16 v[92:95], v[172:175], a[40:43], v[92:95]
v_mfma_f32_16x16x32_bf16 v[92:95], v[156:159], a[36:39], v[92:95]
s_waitcnt vmcnt(22) lgkmcnt(0)
v_mfma_f32_16x16x32_bf16 v[92:95], v[140:143], a[32:35], v[92:95]
s_barrier
v_mfma_f32_16x16x32_bf16 v[16:19], v[192:195], a[64:67], v[16:19]
s_nop 0
ds_read_b64_tr_b16 v[128:129], v8 offset:49152
ds_read_b64_tr_b16 v[130:131], v8 offset:51200
v_mfma_f32_16x16x32_bf16 v[16:19], v[208:211], a[68:71], v[16:19]
s_xor_b32 s71, s15, 0x180
ds_read_b64_tr_b16 v[132:133], v9 offset:49152
ds_read_b64_tr_b16 v[134:135], v9 offset:51200
v_mfma_f32_16x16x32_bf16 v[16:19], v[224:227], a[72:75], v[16:19]
s_add_u32 m0, s77, 49152
ds_read_b64_tr_b16 v[136:137], v10 offset:49152
ds_read_b64_tr_b16 v[138:139], v10 offset:51200
v_mfma_f32_16x16x32_bf16 v[16:19], v[240:243], a[76:79], v[16:19]
s_add_u32 s72, s71, 0
buffer_load_dwordx4 v15, s[24:27], s72 offen lds
v_mfma_f32_16x16x32_bf16 v[32:35], v[240:243], a[92:95], v[32:35]
buffer_load_dwordx4 a[136:139], v1, s[44:47], s69 offen offset:2048 sc1
v_mfma_f32_16x16x32_bf16 v[32:35], v[224:227], a[88:91], v[32:35]
s_nop 0
ds_read_b64_tr_b16 v[140:141], v11 offset:49152
ds_read_b64_tr_b16 v[142:143], v11 offset:51200
v_mfma_f32_16x16x32_bf16 v[32:35], v[208:211], a[84:87], v[32:35]
v_mfma_f32_16x16x32_bf16 v[32:35], v[192:195], a[80:83], v[32:35]
s_nop 0
ds_read_b64_tr_b16 v[144:145], v8 offset:53248
ds_read_b64_tr_b16 v[146:147], v8 offset:55296
v_mfma_f32_16x16x32_bf16 v[36:39], v[196:199], a[80:83], v[36:39]
s_add_u32 s72, s71, 15360
buffer_load_dwordx4 v15, s[24:27], s72 offen offset:1024 lds
v_mfma_f32_16x16x32_bf16 v[36:39], v[212:215], a[84:87], v[36:39]
s_nop 0
ds_read_b64_tr_b16 v[148:149], v9 offset:53248
ds_read_b64_tr_b16 v[150:151], v9 offset:55296
v_mfma_f32_16x16x32_bf16 v[36:39], v[228:231], a[88:91], v[36:39]
s_nop 0
ds_read_b64_tr_b16 v[152:153], v10 offset:53248
ds_read_b64_tr_b16 v[154:155], v10 offset:55296
v_mfma_f32_16x16x32_bf16 v[36:39], v[244:247], a[92:95], v[36:39]
s_nop 0
ds_read_b64_tr_b16 v[156:157], v11 offset:53248
ds_read_b64_tr_b16 v[158:159], v11 offset:55296
v_mfma_f32_16x16x32_bf16 v[20:23], v[244:247], a[76:79], v[20:23]
v_mfma_f32_16x16x32_bf16 v[20:23], v[228:231], a[72:75], v[20:23]
buffer_load_dwordx4 a[140:143], v1, s[44:47], s69 offen offset:3072 sc1
v_mfma_f32_16x16x32_bf16 v[20:23], v[212:215], a[68:71], v[20:23]
s_add_u32 s72, s71, 30720
buffer_load_dwordx4 v15, s[24:27], s72 offen offset:2048 lds
v_mfma_f32_16x16x32_bf16 v[20:23], v[196:199], a[64:67], v[20:23]
s_nop 0
ds_read_b64_tr_b16 v[160:161], v8 offset:57344
ds_read_b64_tr_b16 v[162:163], v8 offset:59392
v_mfma_f32_16x16x32_bf16 v[24:27], v[200:203], a[64:67], v[24:27]
s_nop 0
ds_read_b64_tr_b16 v[164:165], v9 offset:57344
ds_read_b64_tr_b16 v[166:167], v9 offset:59392
v_mfma_f32_16x16x32_bf16 v[24:27], v[216:219], a[68:71], v[24:27]
s_nop 0
ds_read_b64_tr_b16 v[168:169], v10 offset:57344
ds_read_b64_tr_b16 v[170:171], v10 offset:59392
v_mfma_f32_16x16x32_bf16 v[24:27], v[232:235], a[72:75], v[24:27]
s_nop 0
ds_read_b64_tr_b16 v[172:173], v11 offset:57344
ds_read_b64_tr_b16 v[174:175], v11 offset:59392
v_mfma_f32_16x16x32_bf16 v[24:27], v[248:251], a[76:79], v[24:27]
v_mfma_f32_16x16x32_bf16 v[40:43], v[248:251], a[92:95], v[40:43]
s_add_u32 s72, s71, 46080
buffer_load_dwordx4 v15, s[24:27], s72 offen offset:3072 lds
v_mfma_f32_16x16x32_bf16 v[40:43], v[232:235], a[88:91], v[40:43]
s_nop 0
ds_read_b64_tr_b16 v[176:177], v8 offset:61440
ds_read_b64_tr_b16 v[178:179], v8 offset:63488
v_mfma_f32_16x16x32_bf16 v[40:43], v[216:219], a[84:87], v[40:43]
s_nop 0
ds_read_b64_tr_b16 v[180:181], v9 offset:61440
ds_read_b64_tr_b16 v[182:183], v9 offset:63488
v_mfma_f32_16x16x32_bf16 v[40:43], v[200:203], a[80:83], v[40:43]
s_add_u32 s69, s69, 0x20000
buffer_load_dwordx4 a[144:147], v1, s[44:47], s69 offen sc1
v_mfma_f32_16x16x32_bf16 v[44:47], v[204:207], a[80:83], v[44:47]
s_nop 0
ds_read_b64_tr_b16 v[184:185], v10 offset:61440
ds_read_b64_tr_b16 v[186:187], v10 offset:63488
v_mfma_f32_16x16x32_bf16 v[44:47], v[220:223], a[84:87], v[44:47]
s_nop 0
ds_read_b64_tr_b16 v[188:189], v11 offset:61440
ds_read_b64_tr_b16 v[190:191], v11 offset:63488
v_mfma_f32_16x16x32_bf16 v[44:47], v[236:239], a[88:91], v[44:47]
v_mfma_f32_16x16x32_bf16 v[44:47], v[252:255], a[92:95], v[44:47]
s_xor_b32 s71, s12, 0x400080
v_mfma_f32_16x16x32_bf16 v[28:31], v[252:255], a[76:79], v[28:31]
s_add_u32 m0, s85, 0
v_xor_b32 v8, 0x10000, v8
v_mfma_f32_16x16x32_bf16 v[28:31], v[236:239], a[72:75], v[28:31]
s_add_u32 s72, s71, 0
v_xor_b32 v9, 0x10000, v9
v_mfma_f32_16x16x32_bf16 v[28:31], v[220:223], a[68:71], v[28:31]
s_waitcnt vmcnt(21) lgkmcnt(0)
buffer_load_dwordx4 v15, s[24:27], s72 offen lds
v_xor_b32 v10, 0x10000, v10
v_mfma_f32_16x16x32_bf16 v[28:31], v[204:207], a[64:67], v[28:31]
s_barrier
v_xor_b32 v11, 0x10000, v11
v_mfma_f32_16x16x32_bf16 v[48:51], v[128:131], a[64:67], v[48:51]
s_nop 0
ds_read_b64_tr_b16 v[192:193], v8 offset:0
ds_read_b64_tr_b16 v[194:195], v8 offset:2048
v_mfma_f32_16x16x32_bf16 v[48:51], v[144:147], a[68:71], v[48:51]
buffer_load_dwordx4 a[148:151], v1, s[44:47], s69 offen offset:1024 sc1
v_mfma_f32_16x16x32_bf16 v[48:51], v[160:163], a[72:75], v[48:51]
s_nop 0
ds_read_b64_tr_b16 v[196:197], v9 offset:0
ds_read_b64_tr_b16 v[198:199], v9 offset:2048
v_mfma_f32_16x16x32_bf16 v[48:51], v[176:179], a[76:79], v[48:51]
s_add_u32 s72, s71, 15360
buffer_load_dwordx4 v15, s[24:27], s72 offen offset:1024 lds
v_mfma_f32_16x16x32_bf16 v[64:67], v[176:179], a[92:95], v[64:67]
s_nop 0
ds_read_b64_tr_b16 v[200:201], v10 offset:0
ds_read_b64_tr_b16 v[202:203], v10 offset:2048
v_mfma_f32_16x16x32_bf16 v[64:67], v[160:163], a[88:91], v[64:67]
s_nop 0
ds_read_b64_tr_b16 v[204:205], v11 offset:0
ds_read_b64_tr_b16 v[206:207], v11 offset:2048
v_mfma_f32_16x16x32_bf16 v[64:67], v[144:147], a[84:87], v[64:67]
v_mfma_f32_16x16x32_bf16 v[64:67], v[128:131], a[80:83], v[64:67]
s_nop 0
ds_read_b64_tr_b16 v[208:209], v8 offset:4096
ds_read_b64_tr_b16 v[210:211], v8 offset:6144
v_mfma_f32_16x16x32_bf16 v[68:71], v[132:135], a[80:83], v[68:71]
s_nop 0
ds_read_b64_tr_b16 v[212:213], v9 offset:4096
ds_read_b64_tr_b16 v[214:215], v9 offset:6144
v_mfma_f32_16x16x32_bf16 v[68:71], v[148:151], a[84:87], v[68:71]
s_add_u32 s72, s71, 30720
buffer_load_dwordx4 v15, s[24:27], s72 offen offset:2048 lds
v_mfma_f32_16x16x32_bf16 v[68:71], v[164:167], a[88:91], v[68:71]
s_nop 0
ds_read_b64_tr_b16 v[216:217], v10 offset:4096
ds_read_b64_tr_b16 v[218:219], v10 offset:6144
v_mfma_f32_16x16x32_bf16 v[68:71], v[180:183], a[92:95], v[68:71]
buffer_load_dwordx4 a[152:155], v1, s[44:47], s69 offen offset:2048 sc1
v_mfma_f32_16x16x32_bf16 v[52:55], v[180:183], a[76:79], v[52:55]
s_nop 0
ds_read_b64_tr_b16 v[220:221], v11 offset:4096
ds_read_b64_tr_b16 v[222:223], v11 offset:6144
v_mfma_f32_16x16x32_bf16 v[52:55], v[164:167], a[72:75], v[52:55]
v_mfma_f32_16x16x32_bf16 v[52:55], v[148:151], a[68:71], v[52:55]
s_nop 0
ds_read_b64_tr_b16 v[224:225], v8 offset:8192
ds_read_b64_tr_b16 v[226:227], v8 offset:10240
v_mfma_f32_16x16x32_bf16 v[52:55], v[132:135], a[64:67], v[52:55]
s_add_u32 s72, s71, 46080
buffer_load_dwordx4 v15, s[24:27], s72 offen offset:3072 lds
v_mfma_f32_16x16x32_bf16 v[56:59], v[136:139], a[64:67], v[56:59]
s_nop 0
ds_read_b64_tr_b16 v[228:229], v9 offset:8192
ds_read_b64_tr_b16 v[230:231], v9 offset:10240
v_mfma_f32_16x16x32_bf16 v[56:59], v[152:155], a[68:71], v[56:59]
s_nop 0
ds_read_b64_tr_b16 v[232:233], v10 offset:8192
ds_read_b64_tr_b16 v[234:235], v10 offset:10240
v_mfma_f32_16x16x32_bf16 v[56:59], v[168:171], a[72:75], v[56:59]
s_nop 0
ds_read_b64_tr_b16 v[236:237], v11 offset:8192
ds_read_b64_tr_b16 v[238:239], v11 offset:10240
v_mfma_f32_16x16x32_bf16 v[56:59], v[184:187], a[76:79], v[56:59]
v_mfma_f32_16x16x32_bf16 v[72:75], v[184:187], a[92:95], v[72:75]
s_nop 0
ds_read_b64_tr_b16 v[240:241], v8 offset:12288
ds_read_b64_tr_b16 v[242:243], v8 offset:14336
v_mfma_f32_16x16x32_bf16 v[72:75], v[168:171], a[88:91], v[72:75]
buffer_load_dwordx4 a[156:159], v1, s[44:47], s69 offen offset:3072 sc1
v_mfma_f32_16x16x32_bf16 v[72:75], v[152:155], a[84:87], v[72:75]
s_lshr_b32 s69, s13, 18
ds_read_b64_tr_b16 v[244:245], v9 offset:12288
ds_read_b64_tr_b16 v[246:247], v9 offset:14336
v_mfma_f32_16x16x32_bf16 v[72:75], v[136:139], a[80:83], v[72:75]
s_xor_b32 s71, s12, 0x400100
ds_read_b64_tr_b16 v[248:249], v10 offset:12288
ds_read_b64_tr_b16 v[250:251], v10 offset:14336
v_mfma_f32_16x16x32_bf16 v[76:79], v[140:143], a[80:83], v[76:79]
s_add_u32 m0, s85, 16384
ds_read_b64_tr_b16 v[252:253], v11 offset:12288
ds_read_b64_tr_b16 v[254:255], v11 offset:14336
v_mfma_f32_16x16x32_bf16 v[76:79], v[156:159], a[84:87], v[76:79]
s_add_u32 s72, s71, 0
buffer_load_dwordx4 v15, s[24:27], s72 offen lds
v_mfma_f32_16x16x32_bf16 v[76:79], v[172:175], a[88:91], v[76:79]
s_lshl_b32 s69, s69, 12
v_mfma_f32_16x16x32_bf16 v[76:79], v[188:191], a[92:95], v[76:79]
s_add_u32 s69, s69, s95
v_mfma_f32_16x16x32_bf16 v[60:63], v[188:191], a[76:79], v[60:63]
s_xor_b32 s69, s69, 0x10000
v_mfma_f32_16x16x32_bf16 v[60:63], v[172:175], a[72:75], v[60:63]
s_add_u32 s72, s71, 15360
v_mfma_f32_16x16x32_bf16 v[60:63], v[156:159], a[68:71], v[60:63]
s_waitcnt vmcnt(22) lgkmcnt(0)
buffer_load_dwordx4 a[160:163], v1, s[44:47], s69 offen sc1
v_mfma_f32_16x16x32_bf16 v[60:63], v[140:143], a[64:67], v[60:63]
s_barrier
buffer_load_dwordx4 v15, s[24:27], s72 offen offset:1024 lds
v_mfma_f32_16x16x32_bf16 v[80:83], v[192:195], a[64:67], v[80:83]
s_and_b32 s79, s91, 0xffffcfff
v_lshlrev_b32 v13, 2, v2
buffer_load_dword v14, v13, s[44:47], s79 offen sc1
v_mfma_f32_16x16x32_bf16 v[80:83], v[208:211], a[68:71], v[80:83]
s_nop 0
ds_read_b64_tr_b16 v[128:129], v8 offset:16384
ds_read_b64_tr_b16 v[130:131], v8 offset:18432
v_mfma_f32_16x16x32_bf16 v[80:83], v[224:227], a[72:75], v[80:83]
s_nop 0
ds_read_b64_tr_b16 v[132:133], v9 offset:16384
ds_read_b64_tr_b16 v[134:135], v9 offset:18432
v_mfma_f32_16x16x32_bf16 v[80:83], v[240:243], a[76:79], v[80:83]
s_nop 0
ds_read_b64_tr_b16 v[136:137], v10 offset:16384
ds_read_b64_tr_b16 v[138:139], v10 offset:18432
v_mfma_f32_16x16x32_bf16 v[96:99], v[240:243], a[92:95], v[96:99]
s_nop 0
ds_read_b64_tr_b16 v[140:141], v11 offset:16384
ds_read_b64_tr_b16 v[142:143], v11 offset:18432
v_mfma_f32_16x16x32_bf16 v[96:99], v[224:227], a[88:91], v[96:99]
s_add_u32 s72, s71, 30720
buffer_load_dwordx4 v15, s[24:27], s72 offen offset:2048 lds
v_mfma_f32_16x16x32_bf16 v[96:99], v[208:211], a[84:87], v[96:99]
v_mfma_f32_16x16x32_bf16 v[96:99], v[192:195], a[80:83], v[96:99]
s_nop 0
ds_read_b64_tr_b16 v[144:145], v8 offset:20480
ds_read_b64_tr_b16 v[146:147], v8 offset:22528
v_mfma_f32_16x16x32_bf16 v[100:103], v[196:199], a[80:83], v[100:103]
buffer_load_dwordx4 a[164:167], v1, s[44:47], s69 offen offset:1024 sc1
v_mfma_f32_16x16x32_bf16 v[100:103], v[212:215], a[84:87], v[100:103]
s_nop 0
ds_read_b64_tr_b16 v[148:149], v9 offset:20480
ds_read_b64_tr_b16 v[150:151], v9 offset:22528
v_mfma_f32_16x16x32_bf16 v[100:103], v[228:231], a[88:91], v[100:103]
s_nop 0
ds_read_b64_tr_b16 v[152:153], v10 offset:20480
ds_read_b64_tr_b16 v[154:155], v10 offset:22528
v_mfma_f32_16x16x32_bf16 v[100:103], v[244:247], a[92:95], v[100:103]
s_add_u32 s72, s71, 46080
buffer_load_dwordx4 v15, s[24:27], s72 offen offset:3072 lds
v_mfma_f32_16x16x32_bf16 v[84:87], v[244:247], a[76:79], v[84:87]
s_nop 0
ds_read_b64_tr_b16 v[156:157], v11 offset:20480
ds_read_b64_tr_b16 v[158:159], v11 offset:22528
v_mfma_f32_16x16x32_bf16 v[84:87], v[228:231], a[72:75], v[84:87]
v_mfma_f32_16x16x32_bf16 v[84:87], v[212:215], a[68:71], v[84:87]
s_nop 0
ds_read_b64_tr_b16 v[160:161], v8 offset:24576
ds_read_b64_tr_b16 v[162:163], v8 offset:26624
v_mfma_f32_16x16x32_bf16 v[84:87], v[196:199], a[64:67], v[84:87]
s_nop 0
ds_read_b64_tr_b16 v[164:165], v9 offset:24576
ds_read_b64_tr_b16 v[166:167], v9 offset:26624
v_mfma_f32_16x16x32_bf16 v[88:91], v[200:203], a[64:67], v[88:91]
s_nop 0
ds_read_b64_tr_b16 v[168:169], v10 offset:24576
ds_read_b64_tr_b16 v[170:171], v10 offset:26624
v_mfma_f32_16x16x32_bf16 v[88:91], v[216:219], a[68:71], v[88:91]
s_nop 0
ds_read_b64_tr_b16 v[172:173], v11 offset:24576
ds_read_b64_tr_b16 v[174:175], v11 offset:26624
v_mfma_f32_16x16x32_bf16 v[88:91], v[232:235], a[72:75], v[88:91]
buffer_load_dwordx4 a[168:171], v1, s[44:47], s69 offen offset:2048 sc1
v_mfma_f32_16x16x32_bf16 v[88:91], v[248:251], a[76:79], v[88:91]
s_xor_b32 s71, s12, 0x400180
v_mfma_f32_16x16x32_bf16 v[104:107], v[248:251], a[92:95], v[104:107]
s_add_u32 m0, s85, 32768
ds_read_b64_tr_b16 v[176:177], v8 offset:28672
ds_read_b64_tr_b16 v[178:179], v8 offset:30720
v_mfma_f32_16x16x32_bf16 v[104:107], v[232:235], a[88:91], v[104:107]
s_add_u32 s72, s71, 0
buffer_load_dwordx4 v15, s[24:27], s72 offen lds
v_mfma_f32_16x16x32_bf16 v[104:107], v[216:219], a[84:87], v[104:107]
s_nop 0
ds_read_b64_tr_b16 v[180:181], v9 offset:28672
ds_read_b64_tr_b16 v[182:183], v9 offset:30720
v_mfma_f32_16x16x32_bf16 v[104:107], v[200:203], a[80:83], v[104:107]
s_nop 0
ds_read_b64_tr_b16 v[184:185], v10 offset:28672
ds_read_b64_tr_b16 v[186:187], v10 offset:30720
v_mfma_f32_16x16x32_bf16 v[108:111], v[204:207], a[80:83], v[108:111]
s_nop 0
ds_read_b64_tr_b16 v[188:189], v11 offset:28672
ds_read_b64_tr_b16 v[190:191], v11 offset:30720
v_mfma_f32_16x16x32_bf16 v[108:111], v[220:223], a[84:87], v[108:111]
v_mfma_f32_16x16x32_bf16 v[108:111], v[236:239], a[88:91], v[108:111]
s_add_u32 s72, s71, 15360
buffer_load_dwordx4 v15, s[24:27], s72 offen offset:1024 lds
v_mfma_f32_16x16x32_bf16 v[108:111], v[252:255], a[92:95], v[108:111]
v_mfma_f32_16x16x32_bf16 v[92:95], v[252:255], a[76:79], v[92:95]
buffer_load_dwordx4 a[172:175], v1, s[44:47], s69 offen offset:3072 sc1
v_mfma_f32_16x16x32_bf16 v[92:95], v[236:239], a[72:75], v[92:95]
v_mfma_f32_16x16x32_bf16 v[92:95], v[220:223], a[68:71], v[92:95]
s_waitcnt vmcnt(26) lgkmcnt(0)
v_mfma_f32_16x16x32_bf16 v[92:95], v[204:207], a[64:67], v[92:95]
s_barrier
v_mfma_f32_16x16x32_bf16 v[16:19], v[128:131], a[96:99], v[16:19]
s_add_u32 s72, s71, 30720
buffer_load_dwordx4 v15, s[24:27], s72 offen offset:2048 lds
v_mfma_f32_16x16x32_bf16 v[16:19], v[144:147], a[100:103], v[16:19]
s_nop 0
ds_read_b64_tr_b16 v[192:193], v8 offset:32768
ds_read_b64_tr_b16 v[194:195], v8 offset:34816
v_mfma_f32_16x16x32_bf16 v[16:19], v[160:163], a[104:107], v[16:19]
s_nop 0
ds_read_b64_tr_b16 v[196:197], v9 offset:32768
ds_read_b64_tr_b16 v[198:199], v9 offset:34816
v_mfma_f32_16x16x32_bf16 v[16:19], v[176:179], a[108:111], v[16:19]
s_nop 0
ds_read_b64_tr_b16 v[200:201], v10 offset:32768
ds_read_b64_tr_b16 v[202:203], v10 offset:34816
v_mfma_f32_16x16x32_bf16 v[32:35], v[176:179], a[124:127], v[32:35]
s_nop 0
ds_read_b64_tr_b16 v[204:205], v11 offset:32768
ds_read_b64_tr_b16 v[206:207], v11 offset:34816
v_mfma_f32_16x16x32_bf16 v[32:35], v[160:163], a[120:123], v[32:35]
v_mfma_f32_16x16x32_bf16 v[32:35], v[144:147], a[116:119], v[32:35]
s_add_u32 s72, s71, 46080
buffer_load_dwordx4 v15, s[24:27], s72 offen offset:3072 lds
v_mfma_f32_16x16x32_bf16 v[32:35], v[128:131], a[112:115], v[32:35]
s_add_u32 s69, s69, 0x20000
buffer_load_dwordx4 a[176:179], v1, s[44:47], s69 offen sc1
v_mfma_f32_16x16x32_bf16 v[36:39], v[132:135], a[112:115], v[36:39]
s_nop 0
ds_read_b64_tr_b16 v[208:209], v8 offset:36864
ds_read_b64_tr_b16 v[210:211], v8 offset:38912
v_mfma_f32_16x16x32_bf16 v[36:39], v[148:151], a[116:119], v[36:39]
s_nop 0
ds_read_b64_tr_b16 v[212:213], v9 offset:36864
ds_read_b64_tr_b16 v[214:215], v9 offset:38912
v_mfma_f32_16x16x32_bf16 v[36:39], v[164:167], a[120:123], v[36:39]
s_nop 0
ds_read_b64_tr_b16 v[216:217], v10 offset:36864
ds_read_b64_tr_b16 v[218:219], v10 offset:38912
v_mfma_f32_16x16x32_bf16 v[36:39], v[180:183], a[124:127], v[36:39]
s_nop 0
ds_read_b64_tr_b16 v[220:221], v11 offset:36864
ds_read_b64_tr_b16 v[222:223], v11 offset:38912
v_mfma_f32_16x16x32_bf16 v[20:23], v[180:183], a[108:111], v[20:23]
v_mfma_f32_16x16x32_bf16 v[20:23], v[164:167], a[104:107], v[20:23]
s_nop 0
ds_read_b64_tr_b16 v[224:225], v8 offset:40960
ds_read_b64_tr_b16 v[226:227], v8 offset:43008
v_mfma_f32_16x16x32_bf16 v[20:23], v[148:151], a[100:103], v[20:23]
s_xor_b32 s71, s13, 0x400080
ds_read_b64_tr_b16 v[228:229], v9 offset:40960
ds_read_b64_tr_b16 v[230:231], v9 offset:43008
v_mfma_f32_16x16x32_bf16 v[20:23], v[132:135], a[96:99], v[20:23]
s_add_u32 m0, s85, 49152
ds_read_b64_tr_b16 v[232:233], v10 offset:40960
ds_read_b64_tr_b16 v[234:235], v10 offset:43008
v_mfma_f32_16x16x32_bf16 v[24:27], v[136:139], a[96:99], v[24:27]
s_add_u32 s72, s71, 0
buffer_load_dwordx4 v15, s[24:27], s72 offen lds
v_mfma_f32_16x16x32_bf16 v[24:27], v[152:155], a[100:103], v[24:27]
buffer_load_dwordx4 a[180:183], v1, s[44:47], s69 offen offset:1024 sc1
v_mfma_f32_16x16x32_bf16 v[24:27], v[168:171], a[104:107], v[24:27]
s_nop 0
ds_read_b64_tr_b16 v[236:237], v11 offset:40960
ds_read_b64_tr_b16 v[238:239], v11 offset:43008
v_mfma_f32_16x16x32_bf16 v[24:27], v[184:187], a[108:111], v[24:27]
v_mfma_f32_16x16x32_bf16 v[40:43], v[184:187], a[124:127], v[40:43]
s_nop 0
ds_read_b64_tr_b16 v[240:241], v8 offset:45056
ds_read_b64_tr_b16 v[242:243], v8 offset:47104
v_mfma_f32_16x16x32_bf16 v[40:43], v[168:171], a[120:123], v[40:43]
s_nop 0
ds_read_b64_tr_b16 v[244:245], v9 offset:45056
ds_read_b64_tr_b16 v[246:247], v9 offset:47104
v_mfma_f32_16x16x32_bf16 v[40:43], v[152:155], a[116:119], v[40:43]
s_add_u32 s72, s71, 15360
buffer_load_dwordx4 v15, s[24:27], s72 offen offset:1024 lds
v_mfma_f32_16x16x32_bf16 v[40:43], v[136:139], a[112:115], v[40:43]
s_nop 0
Lstube1:
s_cbranch_execz Lrete
ds_read_b64_tr_b16 v[248:249], v10 offset:45056
ds_read_b64_tr_b16 v[250:251], v10 offset:47104
v_mfma_f32_16x16x32_bf16 v[44:47], v[140:143], a[112:115], v[44:47]
s_nop 0
ds_read_b64_tr_b16 v[252:253], v11 offset:45056
ds_read_b64_tr_b16 v[254:255], v11 offset:47104
v_mfma_f32_16x16x32_bf16 v[44:47], v[156:159], a[116:119], v[44:47]
v_mfma_f32_16x16x32_bf16 v[44:47], v[172:175], a[120:123], v[44:47]
buffer_load_dwordx4 a[184:187], v1, s[44:47], s69 offen offset:2048 sc1
v_mfma_f32_16x16x32_bf16 v[44:47], v[188:191], a[124:127], v[44:47]
v_mfma_f32_16x16x32_bf16 v[28:31], v[188:191], a[108:111], v[28:31]
s_add_u32 s72, s71, 30720
buffer_load_dwordx4 v15, s[24:27], s72 offen offset:2048 lds
v_mfma_f32_16x16x32_bf16 v[28:31], v[172:175], a[104:107], v[28:31]
v_mfma_f32_16x16x32_bf16 v[28:31], v[156:159], a[100:103], v[28:31]
s_waitcnt vmcnt(27) lgkmcnt(0)
v_mfma_f32_16x16x32_bf16 v[28:31], v[140:143], a[96:99], v[28:31]
s_barrier
v_mfma_f32_16x16x32_bf16 v[48:51], v[192:195], a[96:99], v[48:51]
s_nop 0
ds_read_b64_tr_b16 v[128:129], v8 offset:49152
ds_read_b64_tr_b16 v[130:131], v8 offset:51200
v_mfma_f32_16x16x32_bf16 v[48:51], v[208:211], a[100:103], v[48:51]
s_nop 0
ds_read_b64_tr_b16 v[132:133], v9 offset:49152
ds_read_b64_tr_b16 v[134:135], v9 offset:51200
v_mfma_f32_16x16x32_bf16 v[48:51], v[224:227], a[104:107], v[48:51]
s_add_u32 s72, s71, 46080
buffer_load_dwordx4 v15, s[24:27], s72 offen offset:3072 lds
v_mfma_f32_16x16x32_bf16 v[48:51], v[240:243], a[108:111], v[48:51]
s_nop 0
ds_read_b64_tr_b16 v[136:137], v10 offset:49152
ds_read_b64_tr_b16 v[138:139], v10 offset:51200
v_mfma_f32_16x16x32_bf16 v[64:67], v[240:243], a[124:127], v[64:67]
buffer_load_dwordx4 a[188:191], v1, s[44:47], s69 offen offset:3072 sc1
v_mfma_f32_16x16x32_bf16 v[64:67], v[224:227], a[120:123], v[64:67]
s_nop 0
ds_read_b64_tr_b16 v[140:141], v11 offset:49152
ds_read_b64_tr_b16 v[142:143], v11 offset:51200
v_mfma_f32_16x16x32_bf16 v[64:67], v[208:211], a[116:119], v[64:67]
s_nop 0
ds_read_b64_tr_b16 v[144:145], v8 offset:53248
ds_read_b64_tr_b16 v[146:147], v8 offset:55296
v_mfma_f32_16x16x32_bf16 v[64:67], v[192:195], a[112:115], v[64:67]
s_nop 0
ds_read_b64_tr_b16 v[148:149], v9 offset:53248
ds_read_b64_tr_b16 v[150:151], v9 offset:55296
v_mfma_f32_16x16x32_bf16 v[68:71], v[196:199], a[112:115], v[68:71]
s_lshr_b32 s69, s14, 18
v_mfma_f32_16x16x32_bf16 v[68:71], v[212:215], a[116:119], v[68:71]
s_lshl_b32 s69, s69, 12
ds_read_b64_tr_b16 v[152:153], v10 offset:53248
ds_read_b64_tr_b16 v[154:155], v10 offset:55296
v_mfma_f32_16x16x32_bf16 v[68:71], v[228:231], a[120:123], v[68:71]
s_xor_b32 s71, s14, 0x400080
ds_read_b64_tr_b16 v[156:157], v11 offset:53248
ds_read_b64_tr_b16 v[158:159], v11 offset:55296
v_mfma_f32_16x16x32_bf16 v[68:71], v[244:247], a[124:127], v[68:71]
s_add_u32 m0, s77, 0
ds_read_b64_tr_b16 v[160:161], v8 offset:57344
ds_read_b64_tr_b16 v[162:163], v8 offset:59392
v_mfma_f32_16x16x32_bf16 v[52:55], v[244:247], a[108:111], v[52:55]
s_add_u32 s72, s71, 0
buffer_load_dwordx4 v15, s[24:27], s72 offen lds
v_mfma_f32_16x16x32_bf16 v[52:55], v[228:231], a[104:107], v[52:55]
s_add_u32 s69, s69, s95
ds_read_b64_tr_b16 v[164:165], v9 offset:57344
ds_read_b64_tr_b16 v[166:167], v9 offset:59392
v_mfma_f32_16x16x32_bf16 v[52:55], v[212:215], a[100:103], v[52:55]
s_xor_b32 s69, s69, 0x10000
buffer_load_dwordx4 a[192:195], v1, s[44:47], s69 offen sc1
v_mfma_f32_16x16x32_bf16 v[52:55], v[196:199], a[96:99], v[52:55]
s_nop 0
ds_read_b64_tr_b16 v[168:169], v10 offset:57344
ds_read_b64_tr_b16 v[170:171], v10 offset:59392
v_mfma_f32_16x16x32_bf16 v[56:59], v[200:203], a[96:99], v[56:59]
s_waitcnt vmcnt(19)
v_cmp_gt_u32 vcc, 2, v14
s_cbranch_vccnz Lspin112
Lback113:
v_mfma_f32_16x16x32_bf16 v[56:59], v[216:219], a[100:103], v[56:59]
s_add_u32 s72, s71, 15360
buffer_load_dwordx4 v15, s[24:27], s72 offen offset:1024 lds
v_mfma_f32_16x16x32_bf16 v[56:59], v[232:235], a[104:107], v[56:59]
v_mfma_f32_16x16x32_bf16 v[56:59], v[248:251], a[108:111], v[56:59]
s_nop 0
ds_read_b64_tr_b16 v[172:173], v11 offset:57344
ds_read_b64_tr_b16 v[174:175], v11 offset:59392
v_mfma_f32_16x16x32_bf16 v[72:75], v[248:251], a[124:127], v[72:75]
s_nop 0
ds_read_b64_tr_b16 v[176:177], v8 offset:61440
ds_read_b64_tr_b16 v[178:179], v8 offset:63488
v_mfma_f32_16x16x32_bf16 v[72:75], v[232:235], a[120:123], v[72:75]
s_nop 0
ds_read_b64_tr_b16 v[180:181], v9 offset:61440
ds_read_b64_tr_b16 v[182:183], v9 offset:63488
v_mfma_f32_16x16x32_bf16 v[72:75], v[216:219], a[116:119], v[72:75]
s_nop 0
ds_read_b64_tr_b16 v[184:185], v10 offset:61440
ds_read_b64_tr_b16 v[186:187], v10 offset:63488
v_mfma_f32_16x16x32_bf16 v[72:75], v[200:203], a[112:115], v[72:75]
s_add_u32 s72, s71, 30720
buffer_load_dwordx4 v15, s[24:27], s72 offen offset:2048 lds
v_mfma_f32_16x16x32_bf16 v[76:79], v[204:207], a[112:115], v[76:79]
buffer_load_dwordx4 a[196:199], v1, s[44:47], s69 offen offset:1024 sc1
v_mfma_f32_16x16x32_bf16 v[76:79], v[220:223], a[116:119], v[76:79]
s_nop 0
ds_read_b64_tr_b16 v[188:189], v11 offset:61440
ds_read_b64_tr_b16 v[190:191], v11 offset:63488
v_mfma_f32_16x16x32_bf16 v[76:79], v[236:239], a[120:123], v[76:79]
v_mfma_f32_16x16x32_bf16 v[76:79], v[252:255], a[124:127], v[76:79]
v_mfma_f32_16x16x32_bf16 v[60:63], v[252:255], a[108:111], v[60:63]
v_xor_b32 v8, 0x10000, v8
v_mfma_f32_16x16x32_bf16 v[60:63], v[236:239], a[104:107], v[60:63]
s_add_u32 s72, s71, 46080
buffer_load_dwordx4 v15, s[24:27], s72 offen offset:3072 lds
v_xor_b32 v9, 0x10000, v9
v_mfma_f32_16x16x32_bf16 v[60:63], v[220:223], a[100:103], v[60:63]
s_waitcnt vmcnt(28) lgkmcnt(0)
v_xor_b32 v10, 0x10000, v10
v_mfma_f32_16x16x32_bf16 v[60:63], v[204:207], a[96:99], v[60:63]
s_barrier
v_xor_b32 v11, 0x10000, v11
v_mfma_f32_16x16x32_bf16 v[80:83], v[128:131], a[96:99], v[80:83]
s_lshl_b32 s84, s76, 11
ds_read_b64_tr_b16 v[192:193], v8 offset:0
ds_read_b64_tr_b16 v[194:195], v8 offset:2048
v_mfma_f32_16x16x32_bf16 v[80:83], v[144:147], a[100:103], v[80:83]
s_add_u32 s84, s84, 0x3810000
ds_read_b64_tr_b16 v[196:197], v9 offset:0
ds_read_b64_tr_b16 v[198:199], v9 offset:2048
v_mfma_f32_16x16x32_bf16 v[80:83], v[160:163], a[104:107], v[80:83]
buffer_load_dwordx4 a[200:203], v1, s[44:47], s69 offen offset:2048 sc1
v_mfma_f32_16x16x32_bf16 v[80:83], v[176:179], a[108:111], v[80:83]
s_nop 0
ds_read_b64_tr_b16 v[200:201], v10 offset:0
ds_read_b64_tr_b16 v[202:203], v10 offset:2048
v_mfma_f32_16x16x32_bf16 v[96:99], v[176:179], a[124:127], v[96:99]
s_nop 0
ds_read_b64_tr_b16 v[204:205], v11 offset:0
ds_read_b64_tr_b16 v[206:207], v11 offset:2048
v_mfma_f32_16x16x32_bf16 v[96:99], v[160:163], a[120:123], v[96:99]
s_xor_b32 s71, s15, 0x400080
v_lshrrev_b32 v115, 2, v0
v_lshlrev_b32 v115, 7, v115
v_mfma_f32_16x16x32_bf16 v[96:99], v[144:147], a[116:119], v[96:99]
s_add_u32 m0, s77, 16384
ds_read_b64_tr_b16 v[208:209], v8 offset:4096
ds_read_b64_tr_b16 v[210:211], v8 offset:6144
v_mfma_f32_16x16x32_bf16 v[96:99], v[128:131], a[112:115], v[96:99]
s_add_u32 s72, s71, 0
buffer_load_dwordx4 v15, s[24:27], s72 offen lds
v_mfma_f32_16x16x32_bf16 v[100:103], v[132:135], a[112:115], v[100:103]
s_nop 0
ds_read_b64_tr_b16 v[212:213], v9 offset:4096
ds_read_b64_tr_b16 v[214:215], v9 offset:6144
v_mfma_f32_16x16x32_bf16 v[100:103], v[148:151], a[116:119], v[100:103]
s_nop 0
ds_read_b64_tr_b16 v[216:217], v10 offset:4096
ds_read_b64_tr_b16 v[218:219], v10 offset:6144
v_mfma_f32_16x16x32_bf16 v[100:103], v[164:167], a[120:123], v[100:103]
s_nop 0
ds_read_b64_tr_b16 v[220:221], v11 offset:4096
ds_read_b64_tr_b16 v[222:223], v11 offset:6144
v_mfma_f32_16x16x32_bf16 v[100:103], v[180:183], a[124:127], v[100:103]
buffer_load_dword v114, v115, s[44:47], s84 offen sc1
v_mfma_f32_16x16x32_bf16 v[84:87], v[180:183], a[108:111], v[84:87]
buffer_load_dwordx4 a[204:207], v1, s[44:47], s69 offen offset:3072 sc1
v_mfma_f32_16x16x32_bf16 v[84:87], v[164:167], a[104:107], v[84:87]
s_add_u32 s72, s71, 15360
buffer_load_dwordx4 v15, s[24:27], s72 offen offset:1024 lds
v_mfma_f32_16x16x32_bf16 v[84:87], v[148:151], a[100:103], v[84:87]
s_nop 0
ds_read_b64_tr_b16 v[224:225], v8 offset:8192
ds_read_b64_tr_b16 v[226:227], v8 offset:10240
v_mfma_f32_16x16x32_bf16 v[84:87], v[132:135], a[96:99], v[84:87]
s_nop 0
ds_read_b64_tr_b16 v[228:229], v9 offset:8192
ds_read_b64_tr_b16 v[230:231], v9 offset:10240
v_mfma_f32_16x16x32_bf16 v[88:91], v[136:139], a[96:99], v[88:91]
s_nop 0
ds_read_b64_tr_b16 v[232:233], v10 offset:8192
ds_read_b64_tr_b16 v[234:235], v10 offset:10240
v_mfma_f32_16x16x32_bf16 v[88:91], v[152:155], a[100:103], v[88:91]
s_nop 0
ds_read_b64_tr_b16 v[236:237], v11 offset:8192
ds_read_b64_tr_b16 v[238:239], v11 offset:10240
v_mfma_f32_16x16x32_bf16 v[88:91], v[168:171], a[104:107], v[88:91]
v_mfma_f32_16x16x32_bf16 v[88:91], v[184:187], a[108:111], v[88:91]
s_add_u32 s72, s71, 30720
buffer_load_dwordx4 v15, s[24:27], s72 offen offset:2048 lds
v_mfma_f32_16x16x32_bf16 v[104:107], v[184:187], a[124:127], v[104:107]
s_nop 0
ds_read_b64_tr_b16 v[240:241], v8 offset:12288
ds_read_b64_tr_b16 v[242:243], v8 offset:14336
v_mfma_f32_16x16x32_bf16 v[104:107], v[168:171], a[120:123], v[104:107]
s_nop 0
ds_read_b64_tr_b16 v[244:245], v9 offset:12288
ds_read_b64_tr_b16 v[246:247], v9 offset:14336
v_mfma_f32_16x16x32_bf16 v[104:107], v[152:155], a[116:119], v[104:107]
s_add_u32 s69, s69, 0x20000
buffer_load_dwordx4 a[208:211], v1, s[44:47], s69 offen sc1
v_mfma_f32_16x16x32_bf16 v[104:107], v[136:139], a[112:115], v[104:107]
s_nop 0
ds_read_b64_tr_b16 v[248:249], v10 offset:12288
ds_read_b64_tr_b16 v[250:251], v10 offset:14336
v_mfma_f32_16x16x32_bf16 v[108:111], v[140:143], a[112:115], v[108:111]
s_nop 0
ds_read_b64_tr_b16 v[252:253], v11 offset:12288
ds_read_b64_tr_b16 v[254:255], v11 offset:14336
v_mfma_f32_16x16x32_bf16 v[108:111], v[156:159], a[116:119], v[108:111]
s_add_u32 s72, s71, 46080
buffer_load_dwordx4 v15, s[24:27], s72 offen offset:3072 lds
v_mfma_f32_16x16x32_bf16 v[108:111], v[172:175], a[120:123], v[108:111]
v_mfma_f32_16x16x32_bf16 v[108:111], v[188:191], a[124:127], v[108:111]
v_mfma_f32_16x16x32_bf16 v[92:95], v[188:191], a[108:111], v[92:95]
v_mfma_f32_16x16x32_bf16 v[92:95], v[172:175], a[104:107], v[92:95]
v_mfma_f32_16x16x32_bf16 v[92:95], v[156:159], a[100:103], v[92:95]
s_waitcnt vmcnt(28) lgkmcnt(0)
v_mfma_f32_16x16x32_bf16 v[92:95], v[140:143], a[96:99], v[92:95]
s_barrier
v_mfma_f32_16x16x32_bf16 v[16:19], v[192:195], a[128:131], v[16:19]
buffer_load_dwordx4 a[212:215], v1, s[44:47], s69 offen offset:1024 sc1
v_mfma_f32_16x16x32_bf16 v[16:19], v[208:211], a[132:135], v[16:19]
s_xor_b32 s71, s13, 0x400100
ds_read_b64_tr_b16 v[128:129], v8 offset:16384
ds_read_b64_tr_b16 v[130:131], v8 offset:18432
v_mfma_f32_16x16x32_bf16 v[16:19], v[224:227], a[136:139], v[16:19]
s_add_u32 m0, s77, 32768
ds_read_b64_tr_b16 v[132:133], v9 offset:16384
ds_read_b64_tr_b16 v[134:135], v9 offset:18432
v_mfma_f32_16x16x32_bf16 v[16:19], v[240:243], a[140:143], v[16:19]
s_add_u32 s72, s71, 0
buffer_load_dwordx4 v15, s[24:27], s72 offen lds
v_mfma_f32_16x16x32_bf16 v[32:35], v[240:243], a[156:159], v[32:35]
s_nop 0
ds_read_b64_tr_b16 v[136:137], v10 offset:16384
ds_read_b64_tr_b16 v[138:139], v10 offset:18432
v_mfma_f32_16x16x32_bf16 v[32:35], v[224:227], a[152:155], v[32:35]
s_nop 0
ds_read_b64_tr_b16 v[140:141], v11 offset:16384
ds_read_b64_tr_b16 v[142:143], v11 offset:18432
v_mfma_f32_16x16x32_bf16 v[32:35], v[208:211], a[148:151], v[32:35]
v_mfma_f32_16x16x32_bf16 v[32:35], v[192:195], a[144:147], v[32:35]
s_nop 0
ds_read_b64_tr_b16 v[144:145], v8 offset:20480
ds_read_b64_tr_b16 v[146:147], v8 offset:22528
v_mfma_f32_16x16x32_bf16 v[36:39], v[196:199], a[144:147], v[36:39]
s_add_u32 s72, s71, 15360
buffer_load_dwordx4 v15, s[24:27], s72 offen offset:1024 lds
v_mfma_f32_16x16x32_bf16 v[36:39], v[212:215], a[148:151], v[36:39]
s_nop 0
ds_read_b64_tr_b16 v[148:149], v9 offset:20480
ds_read_b64_tr_b16 v[150:151], v9 offset:22528
v_mfma_f32_16x16x32_bf16 v[36:39], v[228:231], a[152:155], v[36:39]
buffer_load_dwordx4 a[216:219], v1, s[44:47], s69 offen offset:2048 sc1
v_mfma_f32_16x16x32_bf16 v[36:39], v[244:247], a[156:159], v[36:39]
s_nop 0
ds_read_b64_tr_b16 v[152:153], v10 offset:20480
ds_read_b64_tr_b16 v[154:155], v10 offset:22528
v_mfma_f32_16x16x32_bf16 v[20:23], v[244:247], a[140:143], v[20:23]
s_nop 0
ds_read_b64_tr_b16 v[156:157], v11 offset:20480
ds_read_b64_tr_b16 v[158:159], v11 offset:22528
v_mfma_f32_16x16x32_bf16 v[20:23], v[228:231], a[136:139], v[20:23]
v_mfma_f32_16x16x32_bf16 v[20:23], v[212:215], a[132:135], v[20:23]
s_add_u32 s72, s71, 30720
buffer_load_dwordx4 v15, s[24:27], s72 offen offset:2048 lds
v_mfma_f32_16x16x32_bf16 v[20:23], v[196:199], a[128:131], v[20:23]
s_nop 0
ds_read_b64_tr_b16 v[160:161], v8 offset:24576
ds_read_b64_tr_b16 v[162:163], v8 offset:26624
v_mfma_f32_16x16x32_bf16 v[24:27], v[200:203], a[128:131], v[24:27]
s_nop 0
ds_read_b64_tr_b16 v[164:165], v9 offset:24576
ds_read_b64_tr_b16 v[166:167], v9 offset:26624
v_mfma_f32_16x16x32_bf16 v[24:27], v[216:219], a[132:135], v[24:27]
s_nop 0
ds_read_b64_tr_b16 v[168:169], v10 offset:24576
ds_read_b64_tr_b16 v[170:171], v10 offset:26624
v_mfma_f32_16x16x32_bf16 v[24:27], v[232:235], a[136:139], v[24:27]
s_nop 0
ds_read_b64_tr_b16 v[172:173], v11 offset:24576
ds_read_b64_tr_b16 v[174:175], v11 offset:26624
v_mfma_f32_16x16x32_bf16 v[24:27], v[248:251], a[140:143], v[24:27]
v_mfma_f32_16x16x32_bf16 v[40:43], v[248:251], a[156:159], v[40:43]
s_add_u32 s72, s71, 46080
buffer_load_dwordx4 v15, s[24:27], s72 offen offset:3072 lds
v_mfma_f32_16x16x32_bf16 v[40:43], v[232:235], a[152:155], v[40:43]
buffer_load_dwordx4 a[220:223], v1, s[44:47], s69 offen offset:3072 sc1
v_mfma_f32_16x16x32_bf16 v[40:43], v[216:219], a[148:151], v[40:43]
s_nop 0
ds_read_b64_tr_b16 v[176:177], v8 offset:28672
ds_read_b64_tr_b16 v[178:179], v8 offset:30720
v_mfma_f32_16x16x32_bf16 v[40:43], v[200:203], a[144:147], v[40:43]
s_lshr_b32 s69, s15, 18
ds_read_b64_tr_b16 v[180:181], v9 offset:28672
ds_read_b64_tr_b16 v[182:183], v9 offset:30720
v_mfma_f32_16x16x32_bf16 v[44:47], v[204:207], a[144:147], v[44:47]
s_lshl_b32 s69, s69, 12
ds_read_b64_tr_b16 v[184:185], v10 offset:28672
ds_read_b64_tr_b16 v[186:187], v10 offset:30720
v_mfma_f32_16x16x32_bf16 v[44:47], v[220:223], a[148:151], v[44:47]
s_add_u32 s69, s69, s95
ds_read_b64_tr_b16 v[188:189], v11 offset:28672
ds_read_b64_tr_b16 v[190:191], v11 offset:30720
v_mfma_f32_16x16x32_bf16 v[44:47], v[236:239], a[152:155], v[44:47]
s_xor_b32 s69, s69, 0x10000
v_mfma_f32_16x16x32_bf16 v[44:47], v[252:255], a[156:159], v[44:47]
s_xor_b32 s71, s14, 0x400100
v_mfma_f32_16x16x32_bf16 v[28:31], v[252:255], a[140:143], v[28:31]
s_add_u32 m0, s77, 49152
v_mfma_f32_16x16x32_bf16 v[28:31], v[236:239], a[136:139], v[28:31]
s_add_u32 s72, s71, 0
v_mfma_f32_16x16x32_bf16 v[28:31], v[220:223], a[132:135], v[28:31]
s_waitcnt vmcnt(29) lgkmcnt(0)
buffer_load_dwordx4 v15, s[24:27], s72 offen lds
v_mfma_f32_16x16x32_bf16 v[28:31], v[204:207], a[128:131], v[28:31]
s_barrier
buffer_load_dwordx4 a[224:227], v1, s[44:47], s69 offen sc1
v_mfma_f32_16x16x32_bf16 v[48:51], v[128:131], a[128:131], v[48:51]
s_nop 0
ds_read_b64_tr_b16 v[192:193], v8 offset:32768
ds_read_b64_tr_b16 v[194:195], v8 offset:34816
v_mfma_f32_16x16x32_bf16 v[48:51], v[144:147], a[132:135], v[48:51]
s_nop 0
ds_read_b64_tr_b16 v[196:197], v9 offset:32768
ds_read_b64_tr_b16 v[198:199], v9 offset:34816
v_mfma_f32_16x16x32_bf16 v[48:51], v[160:163], a[136:139], v[48:51]
s_nop 0
ds_read_b64_tr_b16 v[200:201], v10 offset:32768
ds_read_b64_tr_b16 v[202:203], v10 offset:34816
v_mfma_f32_16x16x32_bf16 v[48:51], v[176:179], a[140:143], v[48:51]
s_add_u32 s72, s71, 15360
buffer_load_dwordx4 v15, s[24:27], s72 offen offset:1024 lds
v_mfma_f32_16x16x32_bf16 v[64:67], v[176:179], a[156:159], v[64:67]
s_nop 0
ds_read_b64_tr_b16 v[204:205], v11 offset:32768
ds_read_b64_tr_b16 v[206:207], v11 offset:34816
v_mfma_f32_16x16x32_bf16 v[64:67], v[160:163], a[152:155], v[64:67]
v_mfma_f32_16x16x32_bf16 v[64:67], v[144:147], a[148:151], v[64:67]
s_nop 0
ds_read_b64_tr_b16 v[208:209], v8 offset:36864
ds_read_b64_tr_b16 v[210:211], v8 offset:38912
v_mfma_f32_16x16x32_bf16 v[64:67], v[128:131], a[144:147], v[64:67]
s_nop 0
ds_read_b64_tr_b16 v[212:213], v9 offset:36864
ds_read_b64_tr_b16 v[214:215], v9 offset:38912
v_mfma_f32_16x16x32_bf16 v[68:71], v[132:135], a[144:147], v[68:71]
buffer_load_dwordx4 a[228:231], v1, s[44:47], s69 offen offset:1024 sc1
v_mfma_f32_16x16x32_bf16 v[68:71], v[148:151], a[148:151], v[68:71]
s_add_u32 s72, s71, 30720
buffer_load_dwordx4 v15, s[24:27], s72 offen offset:2048 lds
v_mfma_f32_16x16x32_bf16 v[68:71], v[164:167], a[152:155], v[68:71]
s_nop 0
ds_read_b64_tr_b16 v[216:217], v10 offset:36864
ds_read_b64_tr_b16 v[218:219], v10 offset:38912
v_mfma_f32_16x16x32_bf16 v[68:71], v[180:183], a[156:159], v[68:71]
v_mfma_f32_16x16x32_bf16 v[52:55], v[180:183], a[140:143], v[52:55]
s_nop 0
ds_read_b64_tr_b16 v[220:221], v11 offset:36864
ds_read_b64_tr_b16 v[222:223], v11 offset:38912
v_mfma_f32_16x16x32_bf16 v[52:55], v[164:167], a[136:139], v[52:55]
s_nop 0
ds_read_b64_tr_b16 v[224:225], v8 offset:40960
ds_read_b64_tr_b16 v[226:227], v8 offset:43008
v_mfma_f32_16x16x32_bf16 v[52:55], v[148:151], a[132:135], v[52:55]
s_nop 0
ds_read_b64_tr_b16 v[228:229], v9 offset:40960
ds_read_b64_tr_b16 v[230:231], v9 offset:43008
v_mfma_f32_16x16x32_bf16 v[52:55], v[132:135], a[128:131], v[52:55]
s_add_u32 s72, s71, 46080
buffer_load_dwordx4 v15, s[24:27], s72 offen offset:3072 lds
v_mfma_f32_16x16x32_bf16 v[56:59], v[136:139], a[128:131], v[56:59]
v_mfma_f32_16x16x32_bf16 v[56:59], v[152:155], a[132:135], v[56:59]
s_nop 0
ds_read_b64_tr_b16 v[232:233], v10 offset:40960
ds_read_b64_tr_b16 v[234:235], v10 offset:43008
v_mfma_f32_16x16x32_bf16 v[56:59], v[168:171], a[136:139], v[56:59]
buffer_load_dwordx4 a[232:235], v1, s[44:47], s69 offen offset:2048 sc1
v_mfma_f32_16x16x32_bf16 v[56:59], v[184:187], a[140:143], v[56:59]
s_nop 0
ds_read_b64_tr_b16 v[236:237], v11 offset:40960
ds_read_b64_tr_b16 v[238:239], v11 offset:43008
v_mfma_f32_16x16x32_bf16 v[72:75], v[184:187], a[156:159], v[72:75]
s_nop 0
ds_read_b64_tr_b16 v[240:241], v8 offset:45056
ds_read_b64_tr_b16 v[242:243], v8 offset:47104
v_mfma_f32_16x16x32_bf16 v[72:75], v[168:171], a[152:155], v[72:75]
v_mfma_f32_16x16x32_bf16 v[72:75], v[152:155], a[148:151], v[72:75]
s_nop 0
ds_read_b64_tr_b16 v[244:245], v9 offset:45056
ds_read_b64_tr_b16 v[246:247], v9 offset:47104
v_mfma_f32_16x16x32_bf16 v[72:75], v[136:139], a[144:147], v[72:75]
s_xor_b32 s71, s15, 0x400100
ds_read_b64_tr_b16 v[248:249], v10 offset:45056
ds_read_b64_tr_b16 v[250:251], v10 offset:47104
v_mfma_f32_16x16x32_bf16 v[76:79], v[140:143], a[144:147], v[76:79]
s_add_u32 m0, s85, 0
ds_read_b64_tr_b16 v[252:253], v11 offset:45056
ds_read_b64_tr_b16 v[254:255], v11 offset:47104
v_mfma_f32_16x16x32_bf16 v[76:79], v[156:159], a[148:151], v[76:79]
s_add_u32 s72, s71, 0
buffer_load_dwordx4 v15, s[24:27], s72 offen lds
v_mfma_f32_16x16x32_bf16 v[76:79], v[172:175], a[152:155], v[76:79]
v_mfma_f32_16x16x32_bf16 v[76:79], v[188:191], a[156:159], v[76:79]
v_mfma_f32_16x16x32_bf16 v[60:63], v[188:191], a[140:143], v[60:63]
buffer_load_dwordx4 a[236:239], v1, s[44:47], s69 offen offset:3072 sc1
v_mfma_f32_16x16x32_bf16 v[60:63], v[172:175], a[136:139], v[60:63]
s_add_u32 s72, s71, 15360
v_mfma_f32_16x16x32_bf16 v[60:63], v[156:159], a[132:135], v[60:63]
s_waitcnt vmcnt(31) lgkmcnt(0)
v_mfma_f32_16x16x32_bf16 v[60:63], v[140:143], a[128:131], v[60:63]
s_barrier
buffer_load_dwordx4 v15, s[24:27], s72 offen offset:1024 lds
v_mfma_f32_16x16x32_bf16 v[80:83], v[192:195], a[128:131], v[80:83]
s_nop 0
ds_read_b64_tr_b16 v[128:129], v8 offset:49152
ds_read_b64_tr_b16 v[130:131], v8 offset:51200
v_mfma_f32_16x16x32_bf16 v[80:83], v[208:211], a[132:135], v[80:83]
s_nop 0
ds_read_b64_tr_b16 v[132:133], v9 offset:49152
ds_read_b64_tr_b16 v[134:135], v9 offset:51200
v_mfma_f32_16x16x32_bf16 v[80:83], v[224:227], a[136:139], v[80:83]
s_nop 0
ds_read_b64_tr_b16 v[136:137], v10 offset:49152
ds_read_b64_tr_b16 v[138:139], v10 offset:51200
s_waitcnt vmcnt(22)
v_cmp_gt_u32 vcc, 3, v114
s_cbranch_vccnz Lspin109
Lback110:
v_mfma_f32_16x16x32_bf16 v[80:83], v[240:243], a[140:143], v[80:83]
s_lshl_b32 s73, s76, 18
ds_read_b64_tr_b16 v[140:141], v11 offset:49152
ds_read_b64_tr_b16 v[142:143], v11 offset:51200
v_mfma_f32_16x16x32_bf16 v[96:99], v[240:243], a[156:159], v[96:99]
s_lshl_b32 s84, s58, 16
v_mfma_f32_16x16x32_bf16 v[96:99], v[224:227], a[152:155], v[96:99]
s_add_u32 s72, s71, 30720
buffer_load_dwordx4 v15, s[24:27], s72 offen offset:2048 lds
v_mfma_f32_16x16x32_bf16 v[96:99], v[208:211], a[148:151], v[96:99]
s_add_u32 s69, s69, 0x20000
buffer_load_dwordx4 a[240:243], v1, s[44:47], s69 offen sc1
v_mfma_f32_16x16x32_bf16 v[96:99], v[192:195], a[144:147], v[96:99]
s_add_u32 s73, s73, s84
ds_read_b64_tr_b16 v[144:145], v8 offset:53248
ds_read_b64_tr_b16 v[146:147], v8 offset:55296
v_mfma_f32_16x16x32_bf16 v[100:103], v[196:199], a[144:147], v[100:103]
s_lshl_b32 s84, s75, 8
ds_read_b64_tr_b16 v[148:149], v9 offset:53248
ds_read_b64_tr_b16 v[150:151], v9 offset:55296
v_mfma_f32_16x16x32_bf16 v[100:103], v[212:215], a[148:151], v[100:103]
s_add_u32 s73, s73, s84
ds_read_b64_tr_b16 v[152:153], v10 offset:53248
ds_read_b64_tr_b16 v[154:155], v10 offset:55296
v_mfma_f32_16x16x32_bf16 v[100:103], v[228:231], a[152:155], v[100:103]
s_add_u32 s73, s73, 0x3400000
v_lshrrev_b32 v112, 4, v0
v_and_b32 v113, 15, v0
v_mfma_f32_16x16x32_bf16 v[100:103], v[244:247], a[156:159], v[100:103]
s_add_u32 s72, s71, 46080
buffer_load_dwordx4 v15, s[24:27], s72 offen offset:3072 lds
v_mfma_f32_16x16x32_bf16 v[84:87], v[244:247], a[140:143], v[84:87]
s_nop 0
ds_read_b64_tr_b16 v[156:157], v11 offset:53248
ds_read_b64_tr_b16 v[158:159], v11 offset:55296
v_mfma_f32_16x16x32_bf16 v[84:87], v[228:231], a[136:139], v[84:87]
s_nop 0
ds_read_b64_tr_b16 v[160:161], v8 offset:57344
ds_read_b64_tr_b16 v[162:163], v8 offset:59392
v_mfma_f32_16x16x32_bf16 v[84:87], v[212:215], a[132:135], v[84:87]
s_nop 0
ds_read_b64_tr_b16 v[164:165], v9 offset:57344
ds_read_b64_tr_b16 v[166:167], v9 offset:59392
v_mfma_f32_16x16x32_bf16 v[84:87], v[196:199], a[128:131], v[84:87]
v_xor_b32 v12, v113, v112
v_lshlrev_b32 v12, 4, v12
v_mfma_f32_16x16x32_bf16 v[88:91], v[200:203], a[128:131], v[88:91]
buffer_load_dwordx4 a[244:247], v1, s[44:47], s69 offen offset:1024 sc1
v_mfma_f32_16x16x32_bf16 v[88:91], v[216:219], a[132:135], v[88:91]
s_nop 0
ds_read_b64_tr_b16 v[168:169], v10 offset:57344
ds_read_b64_tr_b16 v[170:171], v10 offset:59392
v_mfma_f32_16x16x32_bf16 v[88:91], v[232:235], a[136:139], v[88:91]
s_nop 0
ds_read_b64_tr_b16 v[172:173], v11 offset:57344
ds_read_b64_tr_b16 v[174:175], v11 offset:59392
v_mfma_f32_16x16x32_bf16 v[88:91], v[248:251], a[140:143], v[88:91]
s_xor_b32 s71, s13, 0x400180
ds_read_b64_tr_b16 v[176:177], v8 offset:61440
ds_read_b64_tr_b16 v[178:179], v8 offset:63488
v_mfma_f32_16x16x32_bf16 v[104:107], v[248:251], a[156:159], v[104:107]
s_add_u32 m0, s85, 16384
v_lshl_add_u32 v112, v112, 12, v12
v_xor_b32 v12, 64, v112
v_mfma_f32_16x16x32_bf16 v[104:107], v[232:235], a[152:155], v[104:107]
s_add_u32 s72, s71, 0
buffer_load_dwordx4 v15, s[24:27], s72 offen lds
v_mfma_f32_16x16x32_bf16 v[104:107], v[216:219], a[148:151], v[104:107]
s_nop 0
ds_read_b64_tr_b16 v[180:181], v9 offset:61440
ds_read_b64_tr_b16 v[182:183], v9 offset:63488
v_mfma_f32_16x16x32_bf16 v[104:107], v[200:203], a[144:147], v[104:107]
s_nop 0
ds_read_b64_tr_b16 v[184:185], v10 offset:61440
ds_read_b64_tr_b16 v[186:187], v10 offset:63488
v_mfma_f32_16x16x32_bf16 v[108:111], v[204:207], a[144:147], v[108:111]
s_nop 0
ds_read_b64_tr_b16 v[188:189], v11 offset:61440
ds_read_b64_tr_b16 v[190:191], v11 offset:63488
v_mfma_f32_16x16x32_bf16 v[108:111], v[220:223], a[148:151], v[108:111]
v_lshlrev_b32 v113, 2, v113
v_mfma_f32_16x16x32_bf16 v[108:111], v[236:239], a[152:155], v[108:111]
s_add_u32 s72, s71, 15360
buffer_load_dwordx4 v15, s[24:27], s72 offen offset:1024 lds
v_mfma_f32_16x16x32_bf16 v[108:111], v[252:255], a[156:159], v[108:111]
buffer_load_dwordx4 a[248:251], v1, s[44:47], s69 offen offset:2048 sc1
v_mfma_f32_16x16x32_bf16 v[92:95], v[252:255], a[140:143], v[92:95]
v_xor_b32 v8, 0x10000, v8
v_mfma_f32_16x16x32_bf16 v[92:95], v[236:239], a[136:139], v[92:95]
v_xor_b32 v9, 0x10000, v9
v_mfma_f32_16x16x32_bf16 v[92:95], v[220:223], a[132:135], v[92:95]
s_waitcnt vmcnt(32) lgkmcnt(0)
v_xor_b32 v10, 0x10000, v10
v_mfma_f32_16x16x32_bf16 v[92:95], v[204:207], a[128:131], v[92:95]
s_barrier
v_xor_b32 v11, 0x10000, v11
v_mfma_f32_16x16x32_bf16 v[16:19], v[128:131], a[160:163], v[16:19]
s_add_u32 s72, s71, 30720
buffer_load_dwordx4 v15, s[24:27], s72 offen offset:2048 lds
v_mfma_f32_16x16x32_bf16 v[16:19], v[144:147], a[164:167], v[16:19]
s_nop 0
ds_read_b64_tr_b16 v[192:193], v8 offset:0
ds_read_b64_tr_b16 v[194:195], v8 offset:2048
v_mfma_f32_16x16x32_bf16 v[16:19], v[160:163], a[168:171], v[16:19]
s_nop 0
ds_read_b64_tr_b16 v[196:197], v9 offset:0
ds_read_b64_tr_b16 v[198:199], v9 offset:2048
v_mfma_f32_16x16x32_bf16 v[16:19], v[176:179], a[172:175], v[16:19]
s_nop 0
ds_read_b64_tr_b16 v[200:201], v10 offset:0
ds_read_b64_tr_b16 v[202:203], v10 offset:2048
v_mfma_f32_16x16x32_bf16 v[32:35], v[176:179], a[188:191], v[32:35]
buffer_load_dwordx4 a[252:255], v1, s[44:47], s69 offen offset:3072 sc1
v_mfma_f32_16x16x32_bf16 v[32:35], v[160:163], a[184:187], v[32:35]
v_mfma_f32_16x16x32_bf16 v[32:35], v[144:147], a[180:183], v[32:35]
s_add_u32 s72, s71, 46080
buffer_load_dwordx4 v15, s[24:27], s72 offen offset:3072 lds
v_mfma_f32_16x16x32_bf16 v[32:35], v[128:131], a[176:179], v[32:35]
s_nop 0
ds_read_b64_tr_b16 v[204:205], v11 offset:0
ds_read_b64_tr_b16 v[206:207], v11 offset:2048
v_mfma_f32_16x16x32_bf16 v[36:39], v[132:135], a[176:179], v[36:39]
s_nop 0
ds_read_b64_tr_b16 v[208:209], v8 offset:4096
ds_read_b64_tr_b16 v[210:211], v8 offset:6144
v_mfma_f32_16x16x32_bf16 v[36:39], v[148:151], a[180:183], v[36:39]
s_nop 0
ds_read_b64_tr_b16 v[212:213], v9 offset:4096
ds_read_b64_tr_b16 v[214:215], v9 offset:6144
v_mfma_f32_16x16x32_bf16 v[36:39], v[164:167], a[184:187], v[36:39]
v_mfma_f32_16x16x32_bf16 v[36:39], v[180:183], a[188:191], v[36:39]
s_nop 0
ds_read_b64_tr_b16 v[216:217], v10 offset:4096
ds_read_b64_tr_b16 v[218:219], v10 offset:6144
v_mfma_f32_16x16x32_bf16 v[20:23], v[180:183], a[172:175], v[20:23]
s_nop 0
ds_read_b64_tr_b16 v[220:221], v11 offset:4096
ds_read_b64_tr_b16 v[222:223], v11 offset:6144
v_mfma_f32_16x16x32_bf16 v[20:23], v[164:167], a[168:171], v[20:23]
Lstube2:
s_cbranch_execz Lrete
v_mfma_f32_16x16x32_bf16 v[20:23], v[148:151], a[164:167], v[20:23]
s_xor_b32 s71, s14, 0x400180
ds_read_b64_tr_b16 v[224:225], v8 offset:8192
ds_read_b64_tr_b16 v[226:227], v8 offset:10240
v_mfma_f32_16x16x32_bf16 v[20:23], v[132:135], a[160:163], v[20:23]
s_add_u32 m0, s85, 32768
ds_read_b64_tr_b16 v[228:229], v9 offset:8192
ds_read_b64_tr_b16 v[230:231], v9 offset:10240
v_mfma_f32_16x16x32_bf16 v[24:27], v[136:139], a[160:163], v[24:27]
s_add_u32 s72, s71, 0
buffer_load_dwordx4 v15, s[24:27], s72 offen lds
v_mfma_f32_16x16x32_bf16 v[24:27], v[152:155], a[164:167], v[24:27]
s_nop 0
ds_read_b64_tr_b16 v[232:233], v10 offset:8192
ds_read_b64_tr_b16 v[234:235], v10 offset:10240
v_mfma_f32_16x16x32_bf16 v[24:27], v[168:171], a[168:171], v[24:27]
v_mfma_f32_16x16x32_bf16 v[24:27], v[184:187], a[172:175], v[24:27]
s_nop 0
ds_read_b64_tr_b16 v[236:237], v11 offset:8192
ds_read_b64_tr_b16 v[238:239], v11 offset:10240
v_mfma_f32_16x16x32_bf16 v[40:43], v[184:187], a[188:191], v[40:43]
s_nop 0
ds_read_b64_tr_b16 v[240:241], v8 offset:12288
ds_read_b64_tr_b16 v[242:243], v8 offset:14336
v_mfma_f32_16x16x32_bf16 v[40:43], v[168:171], a[184:187], v[40:43]
s_nop 0
ds_read_b64_tr_b16 v[244:245], v9 offset:12288
ds_read_b64_tr_b16 v[246:247], v9 offset:14336
v_mfma_f32_16x16x32_bf16 v[40:43], v[152:155], a[180:183], v[40:43]
s_add_u32 s72, s71, 15360
buffer_load_dwordx4 v15, s[24:27], s72 offen offset:1024 lds
v_mfma_f32_16x16x32_bf16 v[40:43], v[136:139], a[176:179], v[40:43]
v_mfma_f32_16x16x32_bf16 v[44:47], v[140:143], a[176:179], v[44:47]
s_nop 0
ds_read_b64_tr_b16 v[248:249], v10 offset:12288
ds_read_b64_tr_b16 v[250:251], v10 offset:14336
v_mfma_f32_16x16x32_bf16 v[44:47], v[156:159], a[180:183], v[44:47]
s_nop 0
ds_read_b64_tr_b16 v[252:253], v11 offset:12288
ds_read_b64_tr_b16 v[254:255], v11 offset:14336
v_mfma_f32_16x16x32_bf16 v[44:47], v[172:175], a[184:187], v[44:47]
v_mfma_f32_16x16x32_bf16 v[44:47], v[188:191], a[188:191], v[44:47]
v_mfma_f32_16x16x32_bf16 v[28:31], v[188:191], a[172:175], v[28:31]
s_add_u32 s72, s71, 30720
buffer_load_dwordx4 v15, s[24:27], s72 offen offset:2048 lds
v_mfma_f32_16x16x32_bf16 v[28:31], v[172:175], a[168:171], v[28:31]
v_mfma_f32_16x16x32_bf16 v[28:31], v[156:159], a[164:167], v[28:31]
s_waitcnt vmcnt(23) lgkmcnt(0)
v_mfma_f32_16x16x32_bf16 v[28:31], v[140:143], a[160:163], v[28:31]
s_barrier
v_mfma_f32_16x16x32_bf16 v[16:19], v[192:195], a[192:195], v[16:19]
s_nop 0
ds_read_b64_tr_b16 v[128:129], v8 offset:16384
ds_read_b64_tr_b16 v[130:131], v8 offset:18432
v_mfma_f32_16x16x32_bf16 v[16:19], v[208:211], a[196:199], v[16:19]
s_nop 0
ds_read_b64_tr_b16 v[132:133], v9 offset:16384
ds_read_b64_tr_b16 v[134:135], v9 offset:18432
v_mfma_f32_16x16x32_bf16 v[16:19], v[224:227], a[200:203], v[16:19]
s_add_u32 s72, s71, 46080
buffer_load_dwordx4 v15, s[24:27], s72 offen offset:3072 lds
v_mfma_f32_16x16x32_bf16 v[16:19], v[240:243], a[204:207], v[16:19]
s_nop 0
ds_read_b64_tr_b16 v[136:137], v10 offset:16384
ds_read_b64_tr_b16 v[138:139], v10 offset:18432
v_mfma_f32_16x16x32_bf16 v[32:35], v[240:243], a[220:223], v[32:35]
s_nop 0
ds_read_b64_tr_b16 v[140:141], v11 offset:16384
ds_read_b64_tr_b16 v[142:143], v11 offset:18432
v_mfma_f32_16x16x32_bf16 v[32:35], v[224:227], a[216:219], v[32:35]
v_mfma_f32_16x16x32_bf16 v[32:35], v[208:211], a[212:215], v[32:35]
s_nop 0
ds_read_b64_tr_b16 v[144:145], v8 offset:20480
ds_read_b64_tr_b16 v[146:147], v8 offset:22528
v_mfma_f32_16x16x32_bf16 v[32:35], v[192:195], a[208:211], v[32:35]
s_nop 0
ds_read_b64_tr_b16 v[148:149], v9 offset:20480
ds_read_b64_tr_b16 v[150:151], v9 offset:22528
v_mfma_f32_16x16x32_bf16 v[36:39], v[196:199], a[208:211], v[36:39]
s_nop 0
ds_read_b64_tr_b16 v[152:153], v10 offset:20480
ds_read_b64_tr_b16 v[154:155], v10 offset:22528
v_mfma_f32_16x16x32_bf16 v[36:39], v[212:215], a[212:215], v[36:39]
s_nop 0
ds_read_b64_tr_b16 v[156:157], v11 offset:20480
ds_read_b64_tr_b16 v[158:159], v11 offset:22528
v_mfma_f32_16x16x32_bf16 v[36:39], v[228:231], a[216:219], v[36:39]
v_mfma_f32_16x16x32_bf16 v[36:39], v[244:247], a[220:223], v[36:39]
s_add_u32 m0, s64, 147456
ds_read_b64_tr_b16 v[160:161], v8 offset:24576
ds_read_b64_tr_b16 v[162:163], v8 offset:26624
v_mfma_f32_16x16x32_bf16 v[20:23], v[244:247], a[204:207], v[20:23]
s_add_u32 s72, s73, 0
buffer_load_dwordx4 v112, s[44:47], s72 offen sc1 lds
v_mfma_f32_16x16x32_bf16 v[20:23], v[228:231], a[200:203], v[20:23]
s_nop 0
ds_read_b64_tr_b16 v[164:165], v9 offset:24576
ds_read_b64_tr_b16 v[166:167], v9 offset:26624
v_mfma_f32_16x16x32_bf16 v[20:23], v[212:215], a[196:199], v[20:23]
s_add_u32 s72, s73, 15360
buffer_load_dwordx4 v12, s[44:47], s72 offen offset:1024 sc1 lds
v_mfma_f32_16x16x32_bf16 v[20:23], v[196:199], a[192:195], v[20:23]
s_nop 0
ds_read_b64_tr_b16 v[168:169], v10 offset:24576
ds_read_b64_tr_b16 v[170:171], v10 offset:26624
v_mfma_f32_16x16x32_bf16 v[24:27], v[200:203], a[192:195], v[24:27]
s_nop 0
ds_read_b64_tr_b16 v[172:173], v11 offset:24576
ds_read_b64_tr_b16 v[174:175], v11 offset:26624
v_mfma_f32_16x16x32_bf16 v[24:27], v[216:219], a[196:199], v[24:27]
s_add_u32 s72, s73, 30720
buffer_load_dwordx4 v112, s[44:47], s72 offen offset:2048 sc1 lds
v_mfma_f32_16x16x32_bf16 v[24:27], v[232:235], a[200:203], v[24:27]
v_mfma_f32_16x16x32_bf16 v[24:27], v[248:251], a[204:207], v[24:27]
s_nop 0
ds_read_b64_tr_b16 v[176:177], v8 offset:28672
ds_read_b64_tr_b16 v[178:179], v8 offset:30720
v_mfma_f32_16x16x32_bf16 v[40:43], v[248:251], a[220:223], v[40:43]
s_add_u32 s72, s73, 46080
buffer_load_dwordx4 v12, s[44:47], s72 offen offset:3072 sc1 lds
v_mfma_f32_16x16x32_bf16 v[40:43], v[232:235], a[216:219], v[40:43]
s_xor_b32 s71, s15, 0x400180
ds_read_b64_tr_b16 v[180:181], v9 offset:28672
ds_read_b64_tr_b16 v[182:183], v9 offset:30720
v_mfma_f32_16x16x32_bf16 v[40:43], v[216:219], a[212:215], v[40:43]
s_add_u32 m0, s85, 49152
ds_read_b64_tr_b16 v[184:185], v10 offset:28672
ds_read_b64_tr_b16 v[186:187], v10 offset:30720
v_mfma_f32_16x16x32_bf16 v[40:43], v[200:203], a[208:211], v[40:43]
s_add_u32 s72, s71, 0
buffer_load_dwordx4 v15, s[24:27], s72 offen lds
v_mfma_f32_16x16x32_bf16 v[44:47], v[204:207], a[208:211], v[44:47]
s_nop 0
ds_read_b64_tr_b16 v[188:189], v11 offset:28672
ds_read_b64_tr_b16 v[190:191], v11 offset:30720
v_mfma_f32_16x16x32_bf16 v[44:47], v[220:223], a[212:215], v[44:47]
v_mfma_f32_16x16x32_bf16 v[44:47], v[236:239], a[216:219], v[44:47]
s_add_u32 s72, s71, 15360
buffer_load_dwordx4 v15, s[24:27], s72 offen offset:1024 lds
v_mfma_f32_16x16x32_bf16 v[44:47], v[252:255], a[220:223], v[44:47]
v_mfma_f32_16x16x32_bf16 v[28:31], v[252:255], a[204:207], v[28:31]
v_mfma_f32_16x16x32_bf16 v[28:31], v[236:239], a[200:203], v[28:31]
s_add_u32 s72, s71, 30720
buffer_load_dwordx4 v15, s[24:27], s72 offen offset:2048 lds
v_mfma_f32_16x16x32_bf16 v[28:31], v[220:223], a[196:199], v[28:31]
s_waitcnt vmcnt(12) lgkmcnt(0)
v_mfma_f32_16x16x32_bf16 v[28:31], v[204:207], a[192:195], v[28:31]
s_barrier
v_mfma_f32_16x16x32_bf16 v[16:19], v[128:131], a[224:227], v[16:19]
s_add_u32 s72, s71, 46080
buffer_load_dwordx4 v15, s[24:27], s72 offen offset:3072 lds
v_mfma_f32_16x16x32_bf16 v[16:19], v[144:147], a[228:231], v[16:19]
s_lshl_b32 s73, s75, 9
ds_read_b64_tr_b16 v[192:193], v8 offset:32768
ds_read_b64_tr_b16 v[194:195], v8 offset:34816
v_mfma_f32_16x16x32_bf16 v[16:19], v[160:163], a[232:235], v[16:19]
s_lshl_b32 s84, s58, 7
ds_read_b64_tr_b16 v[196:197], v9 offset:32768
ds_read_b64_tr_b16 v[198:199], v9 offset:34816
v_mfma_f32_16x16x32_bf16 v[16:19], v[176:179], a[236:239], v[16:19]
s_add_u32 s73, s73, s84
ds_read_b64_tr_b16 v[200:201], v10 offset:32768
ds_read_b64_tr_b16 v[202:203], v10 offset:34816
v_mfma_f32_16x16x32_bf16 v[20:23], v[180:183], a[236:239], v[20:23]
s_add_u32 s73, s73, 0x3800000
ds_read_b64_tr_b16 v[204:205], v11 offset:32768
ds_read_b64_tr_b16 v[206:207], v11 offset:34816
v_mfma_f32_16x16x32_bf16 v[20:23], v[164:167], a[232:235], v[20:23]
s_xor_b32 s71, s12, 0x0
buffer_load_dword v6, v113, s[44:47], s73 offen sc1
v_mfma_f32_16x16x32_bf16 v[20:23], v[148:151], a[228:231], v[20:23]
s_add_u32 m0, s77, 0
ds_read_b64_tr_b16 v[208:209], v8 offset:36864
ds_read_b64_tr_b16 v[210:211], v8 offset:38912
v_mfma_f32_16x16x32_bf16 v[20:23], v[132:135], a[224:227], v[20:23]
s_add_u32 s72, s71, 0
buffer_load_dwordx4 v15, s[24:27], s72 offen lds
v_mfma_f32_16x16x32_bf16 v[24:27], v[136:139], a[224:227], v[24:27]
s_nop 0
ds_read_b64_tr_b16 v[212:213], v9 offset:36864
ds_read_b64_tr_b16 v[214:215], v9 offset:38912
v_mfma_f32_16x16x32_bf16 v[24:27], v[152:155], a[228:231], v[24:27]
s_nop 0
ds_read_b64_tr_b16 v[216:217], v10 offset:36864
ds_read_b64_tr_b16 v[218:219], v10 offset:38912
v_mfma_f32_16x16x32_bf16 v[24:27], v[168:171], a[232:235], v[24:27]
buffer_load_dword v7, v113, s[44:47], s73 offen offset:64 sc1
v_mfma_f32_16x16x32_bf16 v[24:27], v[184:187], a[236:239], v[24:27]
s_nop 0
ds_read_b64_tr_b16 v[220:221], v11 offset:36864
ds_read_b64_tr_b16 v[222:223], v11 offset:38912
v_cvt_pk_bf16_f32 v16, v16, v17
v_mfma_f32_16x16x32_bf16 v[28:31], v[188:191], a[236:239], v[28:31]
s_nop 0
ds_read_b64_tr_b16 v[224:225], v8 offset:40960
ds_read_b64_tr_b16 v[226:227], v8 offset:43008
v_cvt_pk_bf16_f32 v17, v18, v19
v_mfma_f32_16x16x32_bf16 v[28:31], v[172:175], a[232:235], v[28:31]
s_add_u32 s72, s71, 15360
buffer_load_dwordx4 v15, s[24:27], s72 offen offset:1024 lds
v_cvt_pk_bf16_f32 v18, v20, v21
v_mfma_f32_16x16x32_bf16 v[28:31], v[156:159], a[228:231], v[28:31]
s_nop 0
ds_read_b64_tr_b16 v[228:229], v9 offset:40960
ds_read_b64_tr_b16 v[230:231], v9 offset:43008
v_cvt_pk_bf16_f32 v19, v22, v23
v_mfma_f32_16x16x32_bf16 v[28:31], v[140:143], a[224:227], v[28:31]
v_mfma_f32_16x16x32_bf16 v[32:35], v[128:131], a[240:243], v[32:35]
s_xor_b32 s80, s93, 0x80000
ds_read_b64_tr_b16 v[232:233], v10 offset:40960
ds_read_b64_tr_b16 v[234:235], v10 offset:43008
v_mfma_f32_16x16x32_bf16 v[32:35], v[144:147], a[244:247], v[32:35]
s_add_u32 s80, s80, 0x3a00000
buffer_store_dwordx4 v[16:19], v1, s[44:47], s80 offen sc1
v_mfma_f32_16x16x32_bf16 v[32:35], v[160:163], a[248:251], v[32:35]
s_nop 0
ds_read_b64_tr_b16 v[236:237], v11 offset:40960
ds_read_b64_tr_b16 v[238:239], v11 offset:43008
v_mfma_f32_16x16x32_bf16 v[32:35], v[176:179], a[252:255], v[32:35]
s_add_u32 s72, s71, 30720
buffer_load_dwordx4 v15, s[24:27], s72 offen offset:2048 lds
v_cvt_pk_bf16_f32 v20, v24, v25
v_mfma_f32_16x16x32_bf16 v[36:39], v[180:183], a[252:255], v[36:39]
s_nop 0
ds_read_b64_tr_b16 v[240:241], v8 offset:45056
ds_read_b64_tr_b16 v[242:243], v8 offset:47104
v_cvt_pk_bf16_f32 v21, v26, v27
v_mfma_f32_16x16x32_bf16 v[36:39], v[164:167], a[248:251], v[36:39]
v_cvt_pk_bf16_f32 v22, v28, v29
v_cvt_pk_bf16_f32 v23, v30, v31
v_mfma_f32_16x16x32_bf16 v[36:39], v[148:151], a[244:247], v[36:39]
s_nop 0
ds_read_b64_tr_b16 v[244:245], v9 offset:45056
ds_read_b64_tr_b16 v[246:247], v9 offset:47104
v_mfma_f32_16x16x32_bf16 v[36:39], v[132:135], a[240:243], v[36:39]
s_nop 0
ds_read_b64_tr_b16 v[248:249], v10 offset:45056
ds_read_b64_tr_b16 v[250:251], v10 offset:47104
v_mfma_f32_16x16x32_bf16 v[40:43], v[136:139], a[240:243], v[40:43]
s_nop 0
ds_read_b64_tr_b16 v[252:253], v11 offset:45056
ds_read_b64_tr_b16 v[254:255], v11 offset:47104
v_mfma_f32_16x16x32_bf16 v[40:43], v[152:155], a[244:247], v[40:43]
s_add_u32 s72, s71, 46080
buffer_load_dwordx4 v15, s[24:27], s72 offen offset:3072 lds
v_mfma_f32_16x16x32_bf16 v[40:43], v[168:171], a[248:251], v[40:43]
v_mfma_f32_16x16x32_bf16 v[40:43], v[184:187], a[252:255], v[40:43]
v_cvt_pk_bf16_f32 v24, v32, v33
v_cvt_pk_bf16_f32 v25, v34, v35
v_cvt_pk_bf16_f32 v26, v36, v37
v_mfma_f32_16x16x32_bf16 v[44:47], v[188:191], a[252:255], v[44:47]
v_cvt_pk_bf16_f32 v27, v38, v39
v_mfma_f32_16x16x32_bf16 v[44:47], v[172:175], a[248:251], v[44:47]
v_mfma_f32_16x16x32_bf16 v[44:47], v[156:159], a[244:247], v[44:47]
s_waitcnt vmcnt(33) lgkmcnt(0)
v_mfma_f32_16x16x32_bf16 v[44:47], v[140:143], a[240:243], v[44:47]
s_barrier
v_mfma_f32_16x16x32_bf16 v[48:51], v[192:195], a[160:163], v[48:51]
s_nop 0
ds_read_b64_tr_b16 v[128:129], v8 offset:49152
ds_read_b64_tr_b16 v[130:131], v8 offset:51200
v_mfma_f32_16x16x32_bf16 v[48:51], v[208:211], a[164:167], v[48:51]
s_xor_b32 s71, s13, 0x0
buffer_store_dwordx4 v[20:23], v1, s[44:47], s80 offen offset:1024 sc1
v_mfma_f32_16x16x32_bf16 v[48:51], v[224:227], a[168:171], v[48:51]
s_add_u32 m0, s77, 16384
ds_read_b64_tr_b16 v[132:133], v9 offset:49152
ds_read_b64_tr_b16 v[134:135], v9 offset:51200
v_mfma_f32_16x16x32_bf16 v[48:51], v[240:243], a[172:175], v[48:51]
s_add_u32 s72, s71, 0
buffer_load_dwordx4 v15, s[24:27], s72 offen lds
v_cvt_pk_bf16_f32 v28, v40, v41
v_mfma_f32_16x16x32_bf16 v[64:67], v[240:243], a[188:191], v[64:67]
s_nop 0
ds_read_b64_tr_b16 v[136:137], v10 offset:49152
ds_read_b64_tr_b16 v[138:139], v10 offset:51200
v_cvt_pk_bf16_f32 v29, v42, v43
v_mfma_f32_16x16x32_bf16 v[64:67], v[224:227], a[184:187], v[64:67]
s_nop 0
ds_read_b64_tr_b16 v[140:141], v11 offset:49152
ds_read_b64_tr_b16 v[142:143], v11 offset:51200
v_cvt_pk_bf16_f32 v30, v44, v45
v_mfma_f32_16x16x32_bf16 v[64:67], v[208:211], a[180:183], v[64:67]
v_cvt_pk_bf16_f32 v31, v46, v47
v_mfma_f32_16x16x32_bf16 v[64:67], v[192:195], a[176:179], v[64:67]
s_nop 0
ds_read_b64_tr_b16 v[144:145], v8 offset:53248
ds_read_b64_tr_b16 v[146:147], v8 offset:55296
v_mfma_f32_16x16x32_bf16 v[68:71], v[196:199], a[176:179], v[68:71]
s_add_u32 s72, s71, 15360
buffer_load_dwordx4 v15, s[24:27], s72 offen offset:1024 lds
v_mfma_f32_16x16x32_bf16 v[68:71], v[212:215], a[180:183], v[68:71]
s_nop 0
ds_read_b64_tr_b16 v[148:149], v9 offset:53248
ds_read_b64_tr_b16 v[150:151], v9 offset:55296
v_mfma_f32_16x16x32_bf16 v[68:71], v[228:231], a[184:187], v[68:71]
s_nop 0
ds_read_b64_tr_b16 v[152:153], v10 offset:53248
ds_read_b64_tr_b16 v[154:155], v10 offset:55296
v_mfma_f32_16x16x32_bf16 v[68:71], v[244:247], a[188:191], v[68:71]
v_mfma_f32_16x16x32_bf16 v[52:55], v[244:247], a[172:175], v[52:55]
s_nop 0
ds_read_b64_tr_b16 v[156:157], v11 offset:53248
ds_read_b64_tr_b16 v[158:159], v11 offset:55296
v_mfma_f32_16x16x32_bf16 v[52:55], v[228:231], a[168:171], v[52:55]
s_nop 0
ds_read_b64_tr_b16 v[160:161], v8 offset:57344
ds_read_b64_tr_b16 v[162:163], v8 offset:59392
v_mfma_f32_16x16x32_bf16 v[52:55], v[212:215], a[164:167], v[52:55]
s_add_u32 s72, s71, 30720
buffer_load_dwordx4 v15, s[24:27], s72 offen offset:2048 lds
v_mfma_f32_16x16x32_bf16 v[52:55], v[196:199], a[160:163], v[52:55]
s_nop 0
ds_read_b64_tr_b16 v[164:165], v9 offset:57344
ds_read_b64_tr_b16 v[166:167], v9 offset:59392
v_mfma_f32_16x16x32_bf16 v[56:59], v[200:203], a[160:163], v[56:59]
v_mfma_f32_16x16x32_bf16 v[56:59], v[216:219], a[164:167], v[56:59]
buffer_store_dwordx4 v[24:27], v1, s[44:47], s80 offen offset:2048 sc1
v_mfma_f32_16x16x32_bf16 v[56:59], v[232:235], a[168:171], v[56:59]
s_nop 0
ds_read_b64_tr_b16 v[168:169], v10 offset:57344
ds_read_b64_tr_b16 v[170:171], v10 offset:59392
v_mfma_f32_16x16x32_bf16 v[56:59], v[248:251], a[172:175], v[56:59]
s_nop 0
ds_read_b64_tr_b16 v[172:173], v11 offset:57344
ds_read_b64_tr_b16 v[174:175], v11 offset:59392
v_mfma_f32_16x16x32_bf16 v[72:75], v[248:251], a[188:191], v[72:75]
s_add_u32 s72, s71, 46080
buffer_load_dwordx4 v15, s[24:27], s72 offen offset:3072 lds
v_mfma_f32_16x16x32_bf16 v[72:75], v[232:235], a[184:187], v[72:75]
s_nop 0
ds_read_b64_tr_b16 v[176:177], v8 offset:61440
ds_read_b64_tr_b16 v[178:179], v8 offset:63488
v_mfma_f32_16x16x32_bf16 v[72:75], v[216:219], a[180:183], v[72:75]
v_mfma_f32_16x16x32_bf16 v[72:75], v[200:203], a[176:179], v[72:75]
s_nop 0
ds_read_b64_tr_b16 v[180:181], v9 offset:61440
ds_read_b64_tr_b16 v[182:183], v9 offset:63488
v_mfma_f32_16x16x32_bf16 v[76:79], v[204:207], a[176:179], v[76:79]
s_nop 0
ds_read_b64_tr_b16 v[184:185], v10 offset:61440
ds_read_b64_tr_b16 v[186:187], v10 offset:63488
v_mfma_f32_16x16x32_bf16 v[76:79], v[220:223], a[180:183], v[76:79]
s_nop 0
ds_read_b64_tr_b16 v[188:189], v11 offset:61440
ds_read_b64_tr_b16 v[190:191], v11 offset:63488
v_mfma_f32_16x16x32_bf16 v[76:79], v[236:239], a[184:187], v[76:79]
v_mfma_f32_16x16x32_bf16 v[76:79], v[252:255], a[188:191], v[76:79]
s_xor_b32 s71, s14, 0x0
v_mfma_f32_16x16x32_bf16 v[60:63], v[252:255], a[172:175], v[60:63]
s_add_u32 m0, s77, 32768
v_xor_b32 v8, 0x10000, v8
v_mfma_f32_16x16x32_bf16 v[60:63], v[236:239], a[168:171], v[60:63]
s_add_u32 s72, s71, 0
v_xor_b32 v9, 0x10000, v9
v_mfma_f32_16x16x32_bf16 v[60:63], v[220:223], a[164:167], v[60:63]
s_waitcnt vmcnt(32) lgkmcnt(0)
buffer_load_dwordx4 v15, s[24:27], s72 offen lds
v_xor_b32 v10, 0x10000, v10
v_mfma_f32_16x16x32_bf16 v[60:63], v[204:207], a[160:163], v[60:63]
s_barrier
v_xor_b32 v11, 0x10000, v11
v_mfma_f32_16x16x32_bf16 v[48:51], v[128:131], a[192:195], v[48:51]
s_nop 0
ds_read_b64_tr_b16 v[192:193], v8 offset:0
ds_read_b64_tr_b16 v[194:195], v8 offset:2048
v_mfma_f32_16x16x32_bf16 v[48:51], v[144:147], a[196:199], v[48:51]
buffer_store_dwordx4 v[28:31], v1, s[44:47], s80 offen offset:3072 sc1
v_mfma_f32_16x16x32_bf16 v[48:51], v[160:163], a[200:203], v[48:51]
s_nop 0
ds_read_b64_tr_b16 v[196:197], v9 offset:0
ds_read_b64_tr_b16 v[198:199], v9 offset:2048
v_mfma_f32_16x16x32_bf16 v[48:51], v[176:179], a[204:207], v[48:51]
s_add_u32 s72, s71, 15360
buffer_load_dwordx4 v15, s[24:27], s72 offen offset:1024 lds
v_mfma_f32_16x16x32_bf16 v[64:67], v[176:179], a[220:223], v[64:67]
s_nop 0
ds_read_b64_tr_b16 v[200:201], v10 offset:0
ds_read_b64_tr_b16 v[202:203], v10 offset:2048
v_mfma_f32_16x16x32_bf16 v[64:67], v[160:163], a[216:219], v[64:67]
v_mfma_f32_16x16x32_bf16 v[64:67], v[144:147], a[212:215], v[64:67]
s_nop 0
ds_read_b64_tr_b16 v[204:205], v11 offset:0
ds_read_b64_tr_b16 v[206:207], v11 offset:2048
v_mfma_f32_16x16x32_bf16 v[64:67], v[128:131], a[208:211], v[64:67]
s_nop 0
ds_read_b64_tr_b16 v[208:209], v8 offset:4096
ds_read_b64_tr_b16 v[210:211], v8 offset:6144
v_mfma_f32_16x16x32_bf16 v[68:71], v[132:135], a[208:211], v[68:71]
s_nop 0
ds_read_b64_tr_b16 v[212:213], v9 offset:4096
ds_read_b64_tr_b16 v[214:215], v9 offset:6144
v_mfma_f32_16x16x32_bf16 v[68:71], v[148:151], a[212:215], v[68:71]
s_add_u32 s72, s71, 30720
buffer_load_dwordx4 v15, s[24:27], s72 offen offset:2048 lds
v_mfma_f32_16x16x32_bf16 v[68:71], v[164:167], a[216:219], v[68:71]
v_mfma_f32_16x16x32_bf16 v[68:71], v[180:183], a[220:223], v[68:71]
s_nop 0
ds_read_b64_tr_b16 v[216:217], v10 offset:4096
ds_read_b64_tr_b16 v[218:219], v10 offset:6144
v_mfma_f32_16x16x32_bf16 v[52:55], v[180:183], a[204:207], v[52:55]
s_nop 0
ds_read_b64_tr_b16 v[220:221], v11 offset:4096
ds_read_b64_tr_b16 v[222:223], v11 offset:6144
v_mfma_f32_16x16x32_bf16 v[52:55], v[164:167], a[200:203], v[52:55]
v_mfma_f32_16x16x32_bf16 v[52:55], v[148:151], a[196:199], v[52:55]
s_nop 0
ds_read_b64_tr_b16 v[224:225], v8 offset:8192
ds_read_b64_tr_b16 v[226:227], v8 offset:10240
v_mfma_f32_16x16x32_bf16 v[52:55], v[132:135], a[192:195], v[52:55]
s_add_u32 s72, s71, 46080
buffer_load_dwordx4 v15, s[24:27], s72 offen offset:3072 lds
v_mfma_f32_16x16x32_bf16 v[56:59], v[136:139], a[192:195], v[56:59]
s_nop 0
ds_read_b64_tr_b16 v[228:229], v9 offset:8192
ds_read_b64_tr_b16 v[230:231], v9 offset:10240
v_mfma_f32_16x16x32_bf16 v[56:59], v[152:155], a[196:199], v[56:59]
s_nop 0
ds_read_b64_tr_b16 v[232:233], v10 offset:8192
ds_read_b64_tr_b16 v[234:235], v10 offset:10240
v_mfma_f32_16x16x32_bf16 v[56:59], v[168:171], a[200:203], v[56:59]
v_mfma_f32_16x16x32_bf16 v[56:59], v[184:187], a[204:207], v[56:59]
s_nop 0
ds_read_b64_tr_b16 v[236:237], v11 offset:8192
ds_read_b64_tr_b16 v[238:239], v11 offset:10240
v_mfma_f32_16x16x32_bf16 v[72:75], v[184:187], a[220:223], v[72:75]
s_nop 0
ds_read_b64_tr_b16 v[240:241], v8 offset:12288
ds_read_b64_tr_b16 v[242:243], v8 offset:14336
v_mfma_f32_16x16x32_bf16 v[72:75], v[168:171], a[216:219], v[72:75]
s_nop 0
ds_read_b64_tr_b16 v[244:245], v9 offset:12288
ds_read_b64_tr_b16 v[246:247], v9 offset:14336
v_mfma_f32_16x16x32_bf16 v[72:75], v[152:155], a[212:215], v[72:75]
v_mfma_f32_16x16x32_bf16 v[72:75], v[136:139], a[208:211], v[72:75]
s_xor_b32 s71, s15, 0x0
ds_read_b64_tr_b16 v[248:249], v10 offset:12288
ds_read_b64_tr_b16 v[250:251], v10 offset:14336
v_mfma_f32_16x16x32_bf16 v[76:79], v[140:143], a[208:211], v[76:79]
s_add_u32 m0, s77, 49152
ds_read_b64_tr_b16 v[252:253], v11 offset:12288
ds_read_b64_tr_b16 v[254:255], v11 offset:14336
v_mfma_f32_16x16x32_bf16 v[76:79], v[156:159], a[212:215], v[76:79]
s_add_u32 s72, s71, 0
buffer_load_dwordx4 v15, s[24:27], s72 offen lds
v_mfma_f32_16x16x32_bf16 v[76:79], v[172:175], a[216:219], v[76:79]
v_mfma_f32_16x16x32_bf16 v[76:79], v[188:191], a[220:223], v[76:79]
v_mfma_f32_16x16x32_bf16 v[60:63], v[188:191], a[204:207], v[60:63]
v_mfma_f32_16x16x32_bf16 v[60:63], v[172:175], a[200:203], v[60:63]
s_add_u32 s72, s71, 15360
v_mfma_f32_16x16x32_bf16 v[60:63], v[156:159], a[196:199], v[60:63]
s_waitcnt vmcnt(31) lgkmcnt(0)
v_mfma_f32_16x16x32_bf16 v[60:63], v[140:143], a[192:195], v[60:63]
s_barrier
buffer_load_dwordx4 v15, s[24:27], s72 offen offset:1024 lds
v_mfma_f32_16x16x32_bf16 v[48:51], v[192:195], a[224:227], v[48:51]
s_nop 0
ds_read_b64_tr_b16 v[128:129], v8 offset:16384
ds_read_b64_tr_b16 v[130:131], v8 offset:18432
v_mfma_f32_16x16x32_bf16 v[48:51], v[208:211], a[228:231], v[48:51]
s_nop 0
ds_read_b64_tr_b16 v[132:133], v9 offset:16384
ds_read_b64_tr_b16 v[134:135], v9 offset:18432
v_mfma_f32_16x16x32_bf16 v[48:51], v[224:227], a[232:235], v[48:51]
s_nop 0
ds_read_b64_tr_b16 v[136:137], v10 offset:16384
ds_read_b64_tr_b16 v[138:139], v10 offset:18432
v_mfma_f32_16x16x32_bf16 v[48:51], v[240:243], a[236:239], v[48:51]
v_mfma_f32_16x16x32_bf16 v[52:55], v[244:247], a[236:239], v[52:55]
s_nop 0
ds_read_b64_tr_b16 v[140:141], v11 offset:16384
ds_read_b64_tr_b16 v[142:143], v11 offset:18432
v_mfma_f32_16x16x32_bf16 v[52:55], v[228:231], a[232:235], v[52:55]
s_add_u32 s72, s71, 30720
buffer_load_dwordx4 v15, s[24:27], s72 offen offset:2048 lds
v_mfma_f32_16x16x32_bf16 v[52:55], v[212:215], a[228:231], v[52:55]
s_nop 0
ds_read_b64_tr_b16 v[144:145], v8 offset:20480
ds_read_b64_tr_b16 v[146:147], v8 offset:22528
v_mfma_f32_16x16x32_bf16 v[52:55], v[196:199], a[224:227], v[52:55]
s_nop 0
ds_read_b64_tr_b16 v[148:149], v9 offset:20480
ds_read_b64_tr_b16 v[150:151], v9 offset:22528
v_mfma_f32_16x16x32_bf16 v[56:59], v[200:203], a[224:227], v[56:59]
v_mfma_f32_16x16x32_bf16 v[56:59], v[216:219], a[228:231], v[56:59]
s_nop 0
ds_read_b64_tr_b16 v[152:153], v10 offset:20480
ds_read_b64_tr_b16 v[154:155], v10 offset:22528
v_mfma_f32_16x16x32_bf16 v[56:59], v[232:235], a[232:235], v[56:59]
s_nop 0
ds_read_b64_tr_b16 v[156:157], v11 offset:20480
ds_read_b64_tr_b16 v[158:159], v11 offset:22528
v_mfma_f32_16x16x32_bf16 v[56:59], v[248:251], a[236:239], v[56:59]
s_add_u32 s72, s71, 46080
buffer_load_dwordx4 v15, s[24:27], s72 offen offset:3072 lds
v_cvt_pk_bf16_f32 v48, v48, v49
v_mfma_f32_16x16x32_bf16 v[60:63], v[252:255], a[236:239], v[60:63]
v_cvt_pk_bf16_f32 v49, v50, v51
v_cvt_pk_bf16_f32 v50, v52, v53
v_cvt_pk_bf16_f32 v51, v54, v55
v_mfma_f32_16x16x32_bf16 v[60:63], v[236:239], a[232:235], v[60:63]
s_nop 0
ds_read_b64_tr_b16 v[160:161], v8 offset:24576
ds_read_b64_tr_b16 v[162:163], v8 offset:26624
v_mfma_f32_16x16x32_bf16 v[60:63], v[220:223], a[228:231], v[60:63]
s_nop 0
ds_read_b64_tr_b16 v[164:165], v9 offset:24576
ds_read_b64_tr_b16 v[166:167], v9 offset:26624
v_mfma_f32_16x16x32_bf16 v[60:63], v[204:207], a[224:227], v[60:63]
s_nop 0
ds_read_b64_tr_b16 v[168:169], v10 offset:24576
ds_read_b64_tr_b16 v[170:171], v10 offset:26624
v_mfma_f32_16x16x32_bf16 v[64:67], v[192:195], a[240:243], v[64:67]
s_xor_b32 s80, s93, 0x100000
v_mfma_f32_16x16x32_bf16 v[64:67], v[208:211], a[244:247], v[64:67]
s_add_u32 s80, s80, 0x3e00000
buffer_store_dwordx4 v[48:51], v1, s[44:47], s80 offen sc1
v_mfma_f32_16x16x32_bf16 v[64:67], v[224:227], a[248:251], v[64:67]
s_nop 0
ds_read_b64_tr_b16 v[172:173], v11 offset:24576
ds_read_b64_tr_b16 v[174:175], v11 offset:26624
v_mfma_f32_16x16x32_bf16 v[64:67], v[240:243], a[252:255], v[64:67]
s_xor_b32 s71, s12, 0x400000
ds_read_b64_tr_b16 v[176:177], v8 offset:28672
ds_read_b64_tr_b16 v[178:179], v8 offset:30720
v_cvt_pk_bf16_f32 v52, v56, v57
v_mfma_f32_16x16x32_bf16 v[68:71], v[244:247], a[252:255], v[68:71]
s_add_u32 m0, s85, 0
ds_read_b64_tr_b16 v[180:181], v9 offset:28672
ds_read_b64_tr_b16 v[182:183], v9 offset:30720
v_cvt_pk_bf16_f32 v53, v58, v59
v_mfma_f32_16x16x32_bf16 v[68:71], v[228:231], a[248:251], v[68:71]
s_add_u32 s72, s71, 0
buffer_load_dwordx4 v15, s[24:27], s72 offen lds
v_cvt_pk_bf16_f32 v54, v60, v61
v_mfma_f32_16x16x32_bf16 v[68:71], v[212:215], a[244:247], v[68:71]
v_cvt_pk_bf16_f32 v55, v62, v63
v_mfma_f32_16x16x32_bf16 v[68:71], v[196:199], a[240:243], v[68:71]
s_nop 0
ds_read_b64_tr_b16 v[184:185], v10 offset:28672
ds_read_b64_tr_b16 v[186:187], v10 offset:30720
v_mfma_f32_16x16x32_bf16 v[72:75], v[200:203], a[240:243], v[72:75]
s_nop 0
ds_read_b64_tr_b16 v[188:189], v11 offset:28672
ds_read_b64_tr_b16 v[190:191], v11 offset:30720
v_mfma_f32_16x16x32_bf16 v[72:75], v[216:219], a[244:247], v[72:75]
v_mfma_f32_16x16x32_bf16 v[72:75], v[232:235], a[248:251], v[72:75]
s_add_u32 s72, s71, 15360
buffer_load_dwordx4 v15, s[24:27], s72 offen offset:1024 lds
v_mfma_f32_16x16x32_bf16 v[72:75], v[248:251], a[252:255], v[72:75]
v_cvt_pk_bf16_f32 v56, v64, v65
v_cvt_pk_bf16_f32 v57, v66, v67
v_cvt_pk_bf16_f32 v58, v68, v69
v_mfma_f32_16x16x32_bf16 v[76:79], v[252:255], a[252:255], v[76:79]
v_cvt_pk_bf16_f32 v59, v70, v71
v_mfma_f32_16x16x32_bf16 v[76:79], v[236:239], a[248:251], v[76:79]
v_mfma_f32_16x16x32_bf16 v[76:79], v[220:223], a[244:247], v[76:79]
s_waitcnt vmcnt(29) lgkmcnt(0)
v_mfma_f32_16x16x32_bf16 v[76:79], v[204:207], a[240:243], v[76:79]
s_barrier
v_mfma_f32_16x16x32_bf16 v[80:83], v[128:131], a[160:163], v[80:83]
s_add_u32 s72, s71, 30720
buffer_load_dwordx4 v15, s[24:27], s72 offen offset:2048 lds
v_mfma_f32_16x16x32_bf16 v[80:83], v[144:147], a[164:167], v[80:83]
Lstube3:
s_cbranch_execz Lrete
s_waitcnt vmcnt(23)
buffer_store_dwordx4 v[52:55], v1, s[44:47], s80 offen offset:1024 sc1
v_mfma_f32_16x16x32_bf16 v[80:83], v[160:163], a[168:171], v[80:83]
s_nop 0
ds_read_b64_tr_b16 v[192:193], v8 offset:32768
ds_read_b64_tr_b16 v[194:195], v8 offset:34816
v_mfma_f32_16x16x32_bf16 v[80:83], v[176:179], a[172:175], v[80:83]
s_nop 0
ds_read_b64_tr_b16 v[196:197], v9 offset:32768
ds_read_b64_tr_b16 v[198:199], v9 offset:34816
v_cvt_pk_bf16_f32 v60, v72, v73
v_mfma_f32_16x16x32_bf16 v[96:99], v[176:179], a[188:191], v[96:99]
s_nop 0
ds_read_b64_tr_b16 v[200:201], v10 offset:32768
ds_read_b64_tr_b16 v[202:203], v10 offset:34816
v_cvt_pk_bf16_f32 v61, v74, v75
v_mfma_f32_16x16x32_bf16 v[96:99], v[160:163], a[184:187], v[96:99]
s_nop 0
ds_read_b64_tr_b16 v[204:205], v11 offset:32768
ds_read_b64_tr_b16 v[206:207], v11 offset:34816
v_cvt_pk_bf16_f32 v62, v76, v77
v_mfma_f32_16x16x32_bf16 v[96:99], v[144:147], a[180:183], v[96:99]
s_add_u32 s72, s71, 46080
buffer_load_dwordx4 v15, s[24:27], s72 offen offset:3072 lds
v_cvt_pk_bf16_f32 v63, v78, v79
v_mfma_f32_16x16x32_bf16 v[96:99], v[128:131], a[176:179], v[96:99]
v_sub_f32 v112, 1.0, v6
v_sub_f32 v113, 1.0, v7
v_mfma_f32_16x16x32_bf16 v[100:103], v[132:135], a[176:179], v[100:103]
s_nop 0
ds_read_b64_tr_b16 v[208:209], v8 offset:36864
ds_read_b64_tr_b16 v[210:211], v8 offset:38912
v_mfma_f32_16x16x32_bf16 v[100:103], v[148:151], a[180:183], v[100:103]
s_nop 0
ds_read_b64_tr_b16 v[212:213], v9 offset:36864
ds_read_b64_tr_b16 v[214:215], v9 offset:38912
v_mfma_f32_16x16x32_bf16 v[100:103], v[164:167], a[184:187], v[100:103]
s_nop 0
ds_read_b64_tr_b16 v[216:217], v10 offset:36864
ds_read_b64_tr_b16 v[218:219], v10 offset:38912
v_mfma_f32_16x16x32_bf16 v[100:103], v[180:183], a[188:191], v[100:103]
v_mfma_f32_16x16x32_bf16 v[84:87], v[180:183], a[172:175], v[84:87]
s_nop 0
ds_read_b64_tr_b16 v[220:221], v11 offset:36864
ds_read_b64_tr_b16 v[222:223], v11 offset:38912
v_mfma_f32_16x16x32_bf16 v[84:87], v[164:167], a[168:171], v[84:87]
s_nop 0
ds_read_b64_tr_b16 v[224:225], v8 offset:40960
ds_read_b64_tr_b16 v[226:227], v8 offset:43008
v_mfma_f32_16x16x32_bf16 v[84:87], v[148:151], a[164:167], v[84:87]
s_xor_b32 s71, s13, 0x400000
ds_read_b64_tr_b16 v[228:229], v9 offset:40960
ds_read_b64_tr_b16 v[230:231], v9 offset:43008
v_mfma_f32_16x16x32_bf16 v[84:87], v[132:135], a[160:163], v[84:87]
s_add_u32 m0, s85, 16384
v_mfma_f32_16x16x32_bf16 v[88:91], v[136:139], a[160:163], v[88:91]
s_add_u32 s72, s71, 0
buffer_load_dwordx4 v15, s[24:27], s72 offen lds
v_mfma_f32_16x16x32_bf16 v[88:91], v[152:155], a[164:167], v[88:91]
buffer_store_dwordx4 v[56:59], v1, s[44:47], s80 offen offset:2048 sc1
v_mfma_f32_16x16x32_bf16 v[88:91], v[168:171], a[168:171], v[88:91]
s_nop 0
ds_read_b64_tr_b16 v[232:233], v10 offset:40960
ds_read_b64_tr_b16 v[234:235], v10 offset:43008
v_mfma_f32_16x16x32_bf16 v[88:91], v[184:187], a[172:175], v[88:91]
s_nop 0
ds_read_b64_tr_b16 v[236:237], v11 offset:40960
ds_read_b64_tr_b16 v[238:239], v11 offset:43008
v_mfma_f32_16x16x32_bf16 v[104:107], v[184:187], a[188:191], v[104:107]
s_nop 0
ds_read_b64_tr_b16 v[240:241], v8 offset:45056
ds_read_b64_tr_b16 v[242:243], v8 offset:47104
v_mfma_f32_16x16x32_bf16 v[104:107], v[168:171], a[184:187], v[104:107]
v_mfma_f32_16x16x32_bf16 v[104:107], v[152:155], a[180:183], v[104:107]
s_add_u32 s72, s71, 15360
buffer_load_dwordx4 v15, s[24:27], s72 offen offset:1024 lds
v_mfma_f32_16x16x32_bf16 v[104:107], v[136:139], a[176:179], v[104:107]
s_nop 0
ds_read_b64_tr_b16 v[244:245], v9 offset:45056
ds_read_b64_tr_b16 v[246:247], v9 offset:47104
v_mfma_f32_16x16x32_bf16 v[108:111], v[140:143], a[176:179], v[108:111]
s_nop 0
ds_read_b64_tr_b16 v[248:249], v10 offset:45056
ds_read_b64_tr_b16 v[250:251], v10 offset:47104
v_mfma_f32_16x16x32_bf16 v[108:111], v[156:159], a[180:183], v[108:111]
s_nop 0
ds_read_b64_tr_b16 v[252:253], v11 offset:45056
ds_read_b64_tr_b16 v[254:255], v11 offset:47104
v_mfma_f32_16x16x32_bf16 v[108:111], v[172:175], a[184:187], v[108:111]
v_mfma_f32_16x16x32_bf16 v[108:111], v[188:191], a[188:191], v[108:111]
v_mfma_f32_16x16x32_bf16 v[92:95], v[188:191], a[172:175], v[92:95]
s_add_u32 s72, s71, 30720
buffer_load_dwordx4 v15, s[24:27], s72 offen offset:2048 lds
v_mfma_f32_16x16x32_bf16 v[92:95], v[172:175], a[168:171], v[92:95]
v_mfma_f32_16x16x32_bf16 v[92:95], v[156:159], a[164:167], v[92:95]
s_waitcnt vmcnt(32) lgkmcnt(0)
v_mfma_f32_16x16x32_bf16 v[92:95], v[140:143], a[160:163], v[92:95]
s_barrier
v_mfma_f32_16x16x32_bf16 v[80:83], v[192:195], a[192:195], v[80:83]
s_nop 0
ds_read_b64_tr_b16 v[128:129], v8 offset:49152
ds_read_b64_tr_b16 v[130:131], v8 offset:51200
v_mfma_f32_16x16x32_bf16 v[80:83], v[208:211], a[196:199], v[80:83]
buffer_store_dwordx4 v[60:63], v1, s[44:47], s80 offen offset:3072 sc1
v_mfma_f32_16x16x32_bf16 v[80:83], v[224:227], a[200:203], v[80:83]
s_add_u32 s72, s71, 46080
buffer_load_dwordx4 v15, s[24:27], s72 offen offset:3072 lds
v_mfma_f32_16x16x32_bf16 v[80:83], v[240:243], a[204:207], v[80:83]
s_nop 0
ds_read_b64_tr_b16 v[132:133], v9 offset:49152
ds_read_b64_tr_b16 v[134:135], v9 offset:51200
v_mfma_f32_16x16x32_bf16 v[96:99], v[240:243], a[220:223], v[96:99]
s_nop 0
ds_read_b64_tr_b16 v[136:137], v10 offset:49152
ds_read_b64_tr_b16 v[138:139], v10 offset:51200
v_mfma_f32_16x16x32_bf16 v[96:99], v[224:227], a[216:219], v[96:99]
s_nop 0
ds_read_b64 v[48:49], v116 offset:0
ds_read_b64_tr_b16 v[64:65], v5 offset:0
v_mfma_f32_16x16x32_bf16 v[96:99], v[208:211], a[212:215], v[96:99]
s_nop 0
ds_read_b64_tr_b16 v[140:141], v11 offset:49152
ds_read_b64_tr_b16 v[142:143], v11 offset:51200
v_mfma_f32_16x16x32_bf16 v[96:99], v[192:195], a[208:211], v[96:99]
s_nop 0
ds_read_b64_tr_b16 v[144:145], v8 offset:53248
ds_read_b64_tr_b16 v[146:147], v8 offset:55296
v_mfma_f32_16x16x32_bf16 v[100:103], v[196:199], a[208:211], v[100:103]
s_nop 0
ds_read_b64_tr_b16 v[148:149], v9 offset:53248
ds_read_b64_tr_b16 v[150:151], v9 offset:55296
v_mfma_f32_16x16x32_bf16 v[100:103], v[212:215], a[212:215], v[100:103]
s_nop 0
ds_read_b64 v[50:51], v117 offset:0
ds_read_b64_tr_b16 v[66:67], v5 offset:4096
v_mfma_f32_16x16x32_bf16 v[100:103], v[228:231], a[216:219], v[100:103]
s_xor_b32 s71, s14, 0x400000
ds_read_b64_tr_b16 v[152:153], v10 offset:53248
ds_read_b64_tr_b16 v[154:155], v10 offset:55296
v_mfma_f32_16x16x32_bf16 v[100:103], v[244:247], a[220:223], v[100:103]
s_add_u32 m0, s85, 32768
ds_read_b64_tr_b16 v[156:157], v11 offset:53248
ds_read_b64_tr_b16 v[158:159], v11 offset:55296
v_mfma_f32_16x16x32_bf16 v[84:87], v[244:247], a[204:207], v[84:87]
s_add_u32 s72, s71, 0
buffer_load_dwordx4 v15, s[24:27], s72 offen lds
v_mfma_f32_16x16x32_bf16 v[84:87], v[228:231], a[200:203], v[84:87]
s_nop 0
ds_read_b64 v[52:53], v118 offset:0
ds_read_b64_tr_b16 v[68:69], v5 offset:8192
v_mfma_f32_16x16x32_bf16 v[84:87], v[212:215], a[196:199], v[84:87]
s_nop 0
ds_read_b64_tr_b16 v[160:161], v8 offset:57344
ds_read_b64_tr_b16 v[162:163], v8 offset:59392
v_mfma_f32_16x16x32_bf16 v[84:87], v[196:199], a[192:195], v[84:87]
s_nop 0
ds_read_b64_tr_b16 v[164:165], v9 offset:57344
ds_read_b64_tr_b16 v[166:167], v9 offset:59392
v_mfma_f32_16x16x32_bf16 v[88:91], v[200:203], a[192:195], v[88:91]
s_nop 0
ds_read_b64_tr_b16 v[168:169], v10 offset:57344
ds_read_b64_tr_b16 v[170:171], v10 offset:59392
v_mfma_f32_16x16x32_bf16 v[88:91], v[216:219], a[196:199], v[88:91]
s_add_u32 s72, s71, 15360
buffer_load_dwordx4 v15, s[24:27], s72 offen offset:1024 lds
v_mfma_f32_16x16x32_bf16 v[88:91], v[232:235], a[200:203], v[88:91]
s_nop 0
ds_read_b64 v[54:55], v119 offset:0
ds_read_b64_tr_b16 v[70:71], v5 offset:12288
v_mfma_f32_16x16x32_bf16 v[88:91], v[248:251], a[204:207], v[88:91]
s_nop 0
ds_read_b64_tr_b16 v[172:173], v11 offset:57344
ds_read_b64_tr_b16 v[174:175], v11 offset:59392
v_mfma_f32_16x16x32_bf16 v[104:107], v[248:251], a[220:223], v[104:107]
s_nop 0
ds_read_b64_tr_b16 v[176:177], v8 offset:61440
ds_read_b64_tr_b16 v[178:179], v8 offset:63488
v_mfma_f32_16x16x32_bf16 v[104:107], v[232:235], a[216:219], v[104:107]
s_nop 0
ds_read_b64_tr_b16 v[180:181], v9 offset:61440
ds_read_b64_tr_b16 v[182:183], v9 offset:63488
v_mfma_f32_16x16x32_bf16 v[104:107], v[216:219], a[212:215], v[104:107]
v_xor_b32 v5, 16, v5
v_mfma_f32_16x16x32_bf16 v[104:107], v[200:203], a[208:211], v[104:107]
s_add_u32 s72, s71, 30720
buffer_load_dwordx4 v15, s[24:27], s72 offen offset:2048 lds
v_mfma_f32_16x16x32_bf16 v[108:111], v[204:207], a[208:211], v[108:111]
s_nop 0
ds_read_b64_tr_b16 v[184:185], v10 offset:61440
ds_read_b64_tr_b16 v[186:187], v10 offset:63488
v_mfma_f32_16x16x32_bf16 v[108:111], v[220:223], a[212:215], v[108:111]
s_nop 0
ds_read_b64_tr_b16 v[188:189], v11 offset:61440
ds_read_b64_tr_b16 v[190:191], v11 offset:63488
v_mfma_f32_16x16x32_bf16 v[108:111], v[236:239], a[216:219], v[108:111]
s_nop 0
ds_read_b64 v[56:57], v116 offset:2048
ds_read_b64_tr_b16 v[72:73], v5 offset:0
v_mfma_f32_16x16x32_bf16 v[108:111], v[252:255], a[220:223], v[108:111]
s_nop 0
ds_read_b64 v[58:59], v117 offset:2048
ds_read_b64_tr_b16 v[74:75], v5 offset:4096
v_mfma_f32_16x16x32_bf16 v[92:95], v[252:255], a[204:207], v[92:95]
ds_read_b64 v[60:61], v118 offset:2048
v_xor_b32 v8, 0x10000, v8
v_mfma_f32_16x16x32_bf16 v[92:95], v[236:239], a[200:203], v[92:95]
s_add_u32 s72, s71, 46080
buffer_load_dwordx4 v15, s[24:27], s72 offen offset:3072 lds
v_xor_b32 v9, 0x10000, v9
v_mfma_f32_16x16x32_bf16 v[92:95], v[220:223], a[196:199], v[92:95]
s_waitcnt vmcnt(31) lgkmcnt(0)
ds_read_b64_tr_b16 v[76:77], v5 offset:8192
v_xor_b32 v10, 0x10000, v10
v_mfma_f32_16x16x32_bf16 v[92:95], v[204:207], a[192:195], v[92:95]
s_barrier
ds_read_b64 v[62:63], v119 offset:2048
v_xor_b32 v11, 0x10000, v11
v_mfma_f32_16x16x32_bf16 v[80:83], v[128:131], a[224:227], v[80:83]
s_nop 0
ds_read_b64_tr_b16 v[192:193], v8 offset:0
ds_read_b64_tr_b16 v[194:195], v8 offset:2048
v_mfma_f32_16x16x32_bf16 v[80:83], v[144:147], a[228:231], v[80:83]
s_nop 0
ds_read_b64_tr_b16 v[196:197], v9 offset:0
ds_read_b64_tr_b16 v[198:199], v9 offset:2048
v_mfma_f32_16x16x32_bf16 v[80:83], v[160:163], a[232:235], v[80:83]
s_nop 0
ds_read_b64_tr_b16 v[200:201], v10 offset:0
ds_read_b64_tr_b16 v[202:203], v10 offset:2048
v_mfma_f32_16x16x32_bf16 v[80:83], v[176:179], a[236:239], v[80:83]
ds_read_b64_tr_b16 v[78:79], v5 offset:12288
v_mfma_f32_16x16x32_bf16 v[84:87], v[180:183], a[236:239], v[84:87]
s_nop 0
ds_read_b64_tr_b16 v[204:205], v11 offset:0
ds_read_b64_tr_b16 v[206:207], v11 offset:2048
v_mfma_f32_16x16x32_bf16 v[84:87], v[164:167], a[232:235], v[84:87]
s_xor_b32 s71, s15, 0x400000
ds_read_b64_tr_b16 v[208:209], v8 offset:4096
ds_read_b64_tr_b16 v[210:211], v8 offset:6144
v_mfma_f32_16x16x32_bf16 v[84:87], v[148:151], a[228:231], v[84:87]
s_add_u32 m0, s85, 49152
ds_read_b64_tr_b16 v[212:213], v9 offset:4096
ds_read_b64_tr_b16 v[214:215], v9 offset:6144
v_mfma_f32_16x16x32_bf16 v[84:87], v[132:135], a[224:227], v[84:87]
s_add_u32 s72, s71, 0
buffer_load_dwordx4 v15, s[24:27], s72 offen lds
v_mfma_f32_16x16x32_bf16 v[88:91], v[136:139], a[224:227], v[88:91]
v_mfma_f32_16x16x32_bf16 v[88:91], v[152:155], a[228:231], v[88:91]
s_waitcnt lgkmcnt(6)
ds_read_b64_tr_b16 v[216:217], v10 offset:4096
ds_read_b64_tr_b16 v[218:219], v10 offset:6144
v_mfma_f32_16x16x32_bf16 v[88:91], v[168:171], a[232:235], v[88:91]
s_nop 0
ds_read_b64_tr_b16 v[220:221], v11 offset:4096
ds_read_b64_tr_b16 v[222:223], v11 offset:6144
v_mfma_f32_16x16x32_bf16 v[88:91], v[184:187], a[236:239], v[88:91]
v_cvt_pk_bf16_f32 v80, v80, v81
v_cvt_pk_bf16_f32 v81, v82, v83
v_cvt_pk_bf16_f32 v82, v84, v85
v_mfma_f32_16x16x32_bf16 v[92:95], v[188:191], a[236:239], v[92:95]
s_nop 0
ds_read_b64_tr_b16 v[224:225], v8 offset:8192
ds_read_b64_tr_b16 v[226:227], v8 offset:10240
v_cvt_pk_bf16_f32 v83, v86, v87
v_mfma_f32_16x16x32_bf16 v[92:95], v[172:175], a[232:235], v[92:95]
s_add_u32 s72, s71, 15360
buffer_load_dwordx4 v15, s[24:27], s72 offen offset:1024 lds
v_mfma_f32_16x16x32_bf16 v[92:95], v[156:159], a[228:231], v[92:95]
s_nop 0
ds_read_b64_tr_b16 v[228:229], v9 offset:8192
ds_read_b64_tr_b16 v[230:231], v9 offset:10240
v_mfma_f32_16x16x32_bf16 v[92:95], v[140:143], a[224:227], v[92:95]
s_nop 0
ds_read_b64_tr_b16 v[232:233], v10 offset:8192
ds_read_b64_tr_b16 v[234:235], v10 offset:10240
v_mfma_f32_16x16x32_bf16 v[96:99], v[128:131], a[240:243], v[96:99]
s_xor_b32 s80, s93, 0x180000
v_and_b32 v114, 0xffff0000, v48
v_lshlrev_b32 v115, 16, v64
v_mfma_f32_16x16x32_bf16 v[96:99], v[144:147], a[244:247], v[96:99]
s_add_u32 s80, s80, 0x4200000
buffer_store_dwordx4 v[80:83], v1, s[44:47], s80 offen sc1
v_mfma_f32_16x16x32_bf16 v[96:99], v[160:163], a[248:251], v[96:99]
s_nop 0
ds_read_b64_tr_b16 v[236:237], v11 offset:8192
ds_read_b64_tr_b16 v[238:239], v11 offset:10240
v_mfma_f32_16x16x32_bf16 v[96:99], v[176:179], a[252:255], v[96:99]
s_add_u32 s72, s71, 30720
buffer_load_dwordx4 v15, s[24:27], s72 offen offset:2048 lds
v_cvt_pk_bf16_f32 v84, v88, v89
v_mfma_f32_16x16x32_bf16 v[100:103], v[180:183], a[252:255], v[100:103]
s_nop 0
ds_read_b64_tr_b16 v[240:241], v8 offset:12288
ds_read_b64_tr_b16 v[242:243], v8 offset:14336
v_cvt_pk_bf16_f32 v85, v90, v91
v_mfma_f32_16x16x32_bf16 v[100:103], v[164:167], a[248:251], v[100:103]
s_nop 0
ds_read_b64_tr_b16 v[244:245], v9 offset:12288
ds_read_b64_tr_b16 v[246:247], v9 offset:14336
v_cvt_pk_bf16_f32 v86, v92, v93
v_mfma_f32_16x16x32_bf16 v[100:103], v[148:151], a[244:247], v[100:103]
v_cvt_pk_bf16_f32 v87, v94, v95
v_lshlrev_b32 v48, 16, v48
v_mfma_f32_16x16x32_bf16 v[100:103], v[132:135], a[240:243], v[100:103]
s_nop 0
ds_read_b64_tr_b16 v[248:249], v10 offset:12288
ds_read_b64_tr_b16 v[250:251], v10 offset:14336
v_mfma_f32_16x16x32_bf16 v[104:107], v[136:139], a[240:243], v[104:107]
s_nop 0
ds_read_b64_tr_b16 v[252:253], v11 offset:12288
ds_read_b64_tr_b16 v[254:255], v11 offset:14336
v_mfma_f32_16x16x32_bf16 v[104:107], v[152:155], a[244:247], v[104:107]
s_add_u32 s72, s71, 46080
buffer_load_dwordx4 v15, s[24:27], s72 offen offset:3072 lds
v_mfma_f32_16x16x32_bf16 v[104:107], v[168:171], a[248:251], v[104:107]
v_and_b32 v64, 0xffff0000, v64
v_mul_f32 v48, v48, v112
v_mfma_f32_16x16x32_bf16 v[104:107], v[184:187], a[252:255], v[104:107]
v_cvt_pk_bf16_f32 v88, v96, v97
v_cvt_pk_bf16_f32 v89, v98, v99
v_cvt_pk_bf16_f32 v90, v100, v101
v_mfma_f32_16x16x32_bf16 v[108:111], v[188:191], a[252:255], v[108:111]
v_cvt_pk_bf16_f32 v91, v102, v103
v_mul_f32 v114, v114, v112
v_mfma_f32_16x16x32_bf16 v[108:111], v[172:175], a[248:251], v[108:111]
v_mul_f32 v48, v48, v115
v_mul_f32 v64, v64, v114
v_mfma_f32_16x16x32_bf16 v[108:111], v[156:159], a[244:247], v[108:111]
s_waitcnt vmcnt(30) lgkmcnt(0)
v_and_b32 v114, 0xffff0000, v49
v_lshlrev_b32 v115, 16, v65
v_mfma_f32_16x16x32_bf16 v[108:111], v[140:143], a[240:243], v[108:111]
s_barrier
v_lshlrev_b32 v49, 16, v49
v_and_b32 v65, 0xffff0000, v65
v_mfma_f32_16x16x32_bf16 v[16:19], v[192:195], a[0:3], 0
s_nop 0
ds_read_b64_tr_b16 v[128:129], v8 offset:16384
ds_read_b64_tr_b16 v[130:131], v8 offset:18432
v_mfma_f32_16x16x32_bf16 v[16:19], v[208:211], a[4:7], v[16:19]
buffer_store_dwordx4 v[84:87], v1, s[44:47], s80 offen offset:1024 sc1
v_mfma_f32_16x16x32_bf16 v[16:19], v[224:227], a[8:11], v[16:19]
s_nop 0
ds_read_b64_tr_b16 v[132:133], v9 offset:16384
ds_read_b64_tr_b16 v[134:135], v9 offset:18432
v_mfma_f32_16x16x32_bf16 v[16:19], v[240:243], a[12:15], v[16:19]
v_cvt_pk_bf16_f32 v92, v104, v105
v_cvt_pk_bf16_f32 v93, v106, v107
v_cvt_pk_bf16_f32 v94, v108, v109
v_mfma_f32_16x16x32_bf16 v[32:35], v[240:243], a[28:31], 0
s_nop 0
ds_read_b64_tr_b16 v[136:137], v10 offset:16384
ds_read_b64_tr_b16 v[138:139], v10 offset:18432
v_cvt_pk_bf16_f32 v95, v110, v111
v_mfma_f32_16x16x32_bf16 v[32:35], v[224:227], a[24:27], v[32:35]
s_nop 0
ds_read_b64_tr_b16 v[140:141], v11 offset:16384
ds_read_b64_tr_b16 v[142:143], v11 offset:18432
v_mfma_f32_16x16x32_bf16 v[32:35], v[208:211], a[20:23], v[32:35]
v_mul_f32 v49, v49, v112
v_mul_f32 v114, v114, v112
v_mfma_f32_16x16x32_bf16 v[32:35], v[192:195], a[16:19], v[32:35]
s_nop 0
ds_read_b64_tr_b16 v[144:145], v8 offset:20480
ds_read_b64_tr_b16 v[146:147], v8 offset:22528
v_mfma_f32_16x16x32_bf16 v[36:39], v[196:199], a[16:19], 0
s_nop 0
ds_read_b64_tr_b16 v[148:149], v9 offset:20480
ds_read_b64_tr_b16 v[150:151], v9 offset:22528
v_mfma_f32_16x16x32_bf16 v[36:39], v[212:215], a[20:23], v[36:39]
v_mul_f32 v49, v49, v115
v_mul_f32 v65, v65, v114
v_mfma_f32_16x16x32_bf16 v[36:39], v[228:231], a[24:27], v[36:39]
s_nop 0
ds_read_b64_tr_b16 v[152:153], v10 offset:20480
ds_read_b64_tr_b16 v[154:155], v10 offset:22528
v_mfma_f32_16x16x32_bf16 v[36:39], v[244:247], a[28:31], v[36:39]
s_nop 0
ds_read_b64_tr_b16 v[156:157], v11 offset:20480
ds_read_b64_tr_b16 v[158:159], v11 offset:22528
v_mfma_f32_16x16x32_bf16 v[20:23], v[244:247], a[12:15], 0
v_and_b32 v114, 0xffff0000, v50
v_lshlrev_b32 v115, 16, v66
v_mfma_f32_16x16x32_bf16 v[20:23], v[228:231], a[8:11], v[20:23]
s_nop 0
ds_read_b64_tr_b16 v[160:161], v8 offset:24576
ds_read_b64_tr_b16 v[162:163], v8 offset:26624
v_mfma_f32_16x16x32_bf16 v[20:23], v[212:215], a[4:7], v[20:23]
v_lshlrev_b32 v50, 16, v50
v_and_b32 v66, 0xffff0000, v66
v_mfma_f32_16x16x32_bf16 v[20:23], v[196:199], a[0:3], v[20:23]
s_nop 0
ds_read_b64_tr_b16 v[164:165], v9 offset:24576
ds_read_b64_tr_b16 v[166:167], v9 offset:26624
v_mfma_f32_16x16x32_bf16 v[24:27], v[200:203], a[0:3], 0
s_nop 0
ds_read_b64_tr_b16 v[168:169], v10 offset:24576
ds_read_b64_tr_b16 v[170:171], v10 offset:26624
v_mfma_f32_16x16x32_bf16 v[24:27], v[216:219], a[4:7], v[24:27]
buffer_store_dwordx4 v[88:91], v1, s[44:47], s80 offen offset:2048 sc1
v_mfma_f32_16x16x32_bf16 v[24:27], v[232:235], a[8:11], v[24:27]
v_mul_f32 v50, v50, v112
v_mul_f32 v114, v114, v112
v_mfma_f32_16x16x32_bf16 v[24:27], v[248:251], a[12:15], v[24:27]
s_nop 0
ds_read_b64_tr_b16 v[172:173], v11 offset:24576
ds_read_b64_tr_b16 v[174:175], v11 offset:26624
v_mfma_f32_16x16x32_bf16 v[40:43], v[248:251], a[28:31], 0
s_nop 0
ds_read_b64_tr_b16 v[176:177], v8 offset:28672
ds_read_b64_tr_b16 v[178:179], v8 offset:30720
v_mfma_f32_16x16x32_bf16 v[40:43], v[232:235], a[24:27], v[40:43]
v_mul_f32 v50, v50, v115
v_mul_f32 v66, v66, v114
v_mfma_f32_16x16x32_bf16 v[40:43], v[216:219], a[20:23], v[40:43]
s_nop 0
ds_read_b64_tr_b16 v[180:181], v9 offset:28672
ds_read_b64_tr_b16 v[182:183], v9 offset:30720
v_mfma_f32_16x16x32_bf16 v[40:43], v[200:203], a[16:19], v[40:43]
s_nop 0
ds_read_b64_tr_b16 v[184:185], v10 offset:28672
ds_read_b64_tr_b16 v[186:187], v10 offset:30720
v_mfma_f32_16x16x32_bf16 v[44:47], v[204:207], a[16:19], 0
v_and_b32 v114, 0xffff0000, v51
v_lshlrev_b32 v115, 16, v67
v_mfma_f32_16x16x32_bf16 v[44:47], v[220:223], a[20:23], v[44:47]
s_nop 0
ds_read_b64_tr_b16 v[188:189], v11 offset:28672
ds_read_b64_tr_b16 v[190:191], v11 offset:30720
v_mfma_f32_16x16x32_bf16 v[44:47], v[236:239], a[24:27], v[44:47]
v_lshlrev_b32 v51, 16, v51
v_and_b32 v67, 0xffff0000, v67
v_mfma_f32_16x16x32_bf16 v[44:47], v[252:255], a[28:31], v[44:47]
v_mul_f32 v51, v51, v112
v_mul_f32 v114, v114, v112
v_mfma_f32_16x16x32_bf16 v[28:31], v[252:255], a[12:15], 0
v_mul_f32 v51, v51, v115
v_mul_f32 v67, v67, v114
v_mfma_f32_16x16x32_bf16 v[28:31], v[236:239], a[8:11], v[28:31]
v_and_b32 v114, 0xffff0000, v52
v_lshlrev_b32 v115, 16, v68
v_mfma_f32_16x16x32_bf16 v[28:31], v[220:223], a[4:7], v[28:31]
s_waitcnt vmcnt(27) lgkmcnt(0)
v_lshlrev_b32 v52, 16, v52
v_and_b32 v68, 0xffff0000, v68
v_mfma_f32_16x16x32_bf16 v[28:31], v[204:207], a[0:3], v[28:31]
s_barrier
v_mul_f32 v52, v52, v112
v_mul_f32 v114, v114, v112
v_mfma_f32_16x16x32_bf16 v[16:19], v[128:131], a[32:35], v[16:19]
s_nop 0
ds_read_b64_tr_b16 v[192:193], v8 offset:32768
ds_read_b64_tr_b16 v[194:195], v8 offset:34816
v_mfma_f32_16x16x32_bf16 v[16:19], v[144:147], a[36:39], v[16:19]
buffer_store_dwordx4 v[92:95], v1, s[44:47], s80 offen offset:3072 sc1
v_mfma_f32_16x16x32_bf16 v[16:19], v[160:163], a[40:43], v[16:19]
s_nop 0
ds_read_b64_tr_b16 v[196:197], v9 offset:32768
ds_read_b64_tr_b16 v[198:199], v9 offset:34816
v_mfma_f32_16x16x32_bf16 v[16:19], v[176:179], a[44:47], v[16:19]
v_mul_f32 v52, v52, v115
v_mul_f32 v68, v68, v114
v_mfma_f32_16x16x32_bf16 v[32:35], v[176:179], a[60:63], v[32:35]
s_nop 0
ds_read_b64_tr_b16 v[200:201], v10 offset:32768
ds_read_b64_tr_b16 v[202:203], v10 offset:34816
v_mfma_f32_16x16x32_bf16 v[32:35], v[160:163], a[56:59], v[32:35]
s_nop 0
ds_read_b64_tr_b16 v[204:205], v11 offset:32768
ds_read_b64_tr_b16 v[206:207], v11 offset:34816
v_mfma_f32_16x16x32_bf16 v[32:35], v[144:147], a[52:55], v[32:35]
v_and_b32 v114, 0xffff0000, v53
v_lshlrev_b32 v115, 16, v69
v_mfma_f32_16x16x32_bf16 v[32:35], v[128:131], a[48:51], v[32:35]
s_nop 0
ds_read_b64_tr_b16 v[208:209], v8 offset:36864
ds_read_b64_tr_b16 v[210:211], v8 offset:38912
v_mfma_f32_16x16x32_bf16 v[36:39], v[132:135], a[48:51], v[36:39]
v_lshlrev_b32 v53, 16, v53
v_and_b32 v69, 0xffff0000, v69
v_mfma_f32_16x16x32_bf16 v[36:39], v[148:151], a[52:55], v[36:39]
s_nop 0
ds_read_b64_tr_b16 v[212:213], v9 offset:36864
ds_read_b64_tr_b16 v[214:215], v9 offset:38912
v_mfma_f32_16x16x32_bf16 v[36:39], v[164:167], a[56:59], v[36:39]
s_nop 0
ds_read_b64_tr_b16 v[216:217], v10 offset:36864
ds_read_b64_tr_b16 v[218:219], v10 offset:38912
v_mfma_f32_16x16x32_bf16 v[36:39], v[180:183], a[60:63], v[36:39]
v_mul_f32 v53, v53, v112
v_mul_f32 v114, v114, v112
v_mfma_f32_16x16x32_bf16 v[20:23], v[180:183], a[44:47], v[20:23]
s_nop 0
ds_read_b64_tr_b16 v[220:221], v11 offset:36864
ds_read_b64_tr_b16 v[222:223], v11 offset:38912
v_mfma_f32_16x16x32_bf16 v[20:23], v[164:167], a[40:43], v[20:23]
v_mul_f32 v53, v53, v115
v_mul_f32 v69, v69, v114
v_mfma_f32_16x16x32_bf16 v[20:23], v[148:151], a[36:39], v[20:23]
s_nop 0
ds_read_b64_tr_b16 v[224:225], v8 offset:40960
ds_read_b64_tr_b16 v[226:227], v8 offset:43008
v_mfma_f32_16x16x32_bf16 v[20:23], v[132:135], a[32:35], v[20:23]
s_nop 0
ds_read_b64_tr_b16 v[228:229], v9 offset:40960
ds_read_b64_tr_b16 v[230:231], v9 offset:43008
v_mfma_f32_16x16x32_bf16 v[24:27], v[136:139], a[32:35], v[24:27]
v_and_b32 v114, 0xffff0000, v54
v_lshlrev_b32 v115, 16, v70
v_mfma_f32_16x16x32_bf16 v[24:27], v[152:155], a[36:39], v[24:27]
s_nop 0
ds_read_b64_tr_b16 v[232:233], v10 offset:40960
ds_read_b64_tr_b16 v[234:235], v10 offset:43008
v_mfma_f32_16x16x32_bf16 v[24:27], v[168:171], a[40:43], v[24:27]
s_nop 0
ds_read_b64_tr_b16 v[236:237], v11 offset:40960
ds_read_b64_tr_b16 v[238:239], v11 offset:43008
v_mfma_f32_16x16x32_bf16 v[24:27], v[184:187], a[44:47], v[24:27]
v_lshlrev_b32 v54, 16, v54
v_and_b32 v70, 0xffff0000, v70
v_mfma_f32_16x16x32_bf16 v[40:43], v[184:187], a[60:63], v[40:43]
s_nop 0
ds_read_b64_tr_b16 v[240:241], v8 offset:45056
ds_read_b64_tr_b16 v[242:243], v8 offset:47104
v_mfma_f32_16x16x32_bf16 v[40:43], v[168:171], a[56:59], v[40:43]
v_mul_f32 v54, v54, v112
v_mul_f32 v114, v114, v112
v_mfma_f32_16x16x32_bf16 v[40:43], v[152:155], a[52:55], v[40:43]
s_nop 0
ds_read_b64_tr_b16 v[244:245], v9 offset:45056
ds_read_b64_tr_b16 v[246:247], v9 offset:47104
v_mfma_f32_16x16x32_bf16 v[40:43], v[136:139], a[48:51], v[40:43]
s_nop 0
ds_read_b64_tr_b16 v[248:249], v10 offset:45056
ds_read_b64_tr_b16 v[250:251], v10 offset:47104
v_mfma_f32_16x16x32_bf16 v[44:47], v[140:143], a[48:51], v[44:47]
v_mul_f32 v54, v54, v115
v_mul_f32 v70, v70, v114
v_mfma_f32_16x16x32_bf16 v[44:47], v[156:159], a[52:55], v[44:47]
s_nop 0
ds_read_b64_tr_b16 v[252:253], v11 offset:45056
ds_read_b64_tr_b16 v[254:255], v11 offset:47104
v_mfma_f32_16x16x32_bf16 v[44:47], v[172:175], a[56:59], v[44:47]
v_and_b32 v114, 0xffff0000, v55
v_lshlrev_b32 v115, 16, v71
v_mfma_f32_16x16x32_bf16 v[44:47], v[188:191], a[60:63], v[44:47]
v_lshlrev_b32 v55, 16, v55
v_and_b32 v71, 0xffff0000, v71
v_mfma_f32_16x16x32_bf16 v[28:31], v[188:191], a[44:47], v[28:31]
v_mul_f32 v55, v55, v112
v_mul_f32 v114, v114, v112
v_mfma_f32_16x16x32_bf16 v[28:31], v[172:175], a[40:43], v[28:31]
s_add_u32 s79, s93, 0x3a00000
v_mul_f32 v55, v55, v115
v_mul_f32 v71, v71, v114
v_mfma_f32_16x16x32_bf16 v[28:31], v[156:159], a[36:39], v[28:31]
s_waitcnt vmcnt(24) lgkmcnt(0)
buffer_load_dwordx4 v[96:99], v1, s[44:47], s79 offen sc1
v_mfma_f32_16x16x32_bf16 v[28:31], v[140:143], a[32:35], v[28:31]
s_barrier
v_and_b32 v114, 0xffff0000, v56
v_lshlrev_b32 v115, 16, v72
v_mfma_f32_16x16x32_bf16 v[16:19], v[192:195], a[64:67], v[16:19]
s_nop 0
ds_read_b64_tr_b16 v[128:129], v8 offset:49152
ds_read_b64_tr_b16 v[130:131], v8 offset:51200
v_mfma_f32_16x16x32_bf16 v[16:19], v[208:211], a[68:71], v[16:19]
s_nop 0
ds_read_b64_tr_b16 v[132:133], v9 offset:49152
ds_read_b64_tr_b16 v[134:135], v9 offset:51200
v_mfma_f32_16x16x32_bf16 v[16:19], v[224:227], a[72:75], v[16:19]
v_lshlrev_b32 v56, 16, v56
v_and_b32 v72, 0xffff0000, v72
v_mfma_f32_16x16x32_bf16 v[16:19], v[240:243], a[76:79], v[16:19]
buffer_load_dwordx4 v[100:103], v1, s[44:47], s79 offen offset:1024 sc1
v_mfma_f32_16x16x32_bf16 v[32:35], v[240:243], a[92:95], v[32:35]
s_nop 0
ds_read_b64_tr_b16 v[136:137], v10 offset:49152
ds_read_b64_tr_b16 v[138:139], v10 offset:51200
v_mfma_f32_16x16x32_bf16 v[32:35], v[224:227], a[88:91], v[32:35]
s_nop 0
ds_read_b64_tr_b16 v[140:141], v11 offset:49152
ds_read_b64_tr_b16 v[142:143], v11 offset:51200
v_mfma_f32_16x16x32_bf16 v[32:35], v[208:211], a[84:87], v[32:35]
Lstube4:
s_cbranch_execz Lrete
v_mul_f32 v56, v56, v113
v_mul_f32 v114, v114, v113
v_mfma_f32_16x16x32_bf16 v[32:35], v[192:195], a[80:83], v[32:35]
s_nop 0
ds_read_b64_tr_b16 v[144:145], v8 offset:53248
ds_read_b64_tr_b16 v[146:147], v8 offset:55296
v_mfma_f32_16x16x32_bf16 v[36:39], v[196:199], a[80:83], v[36:39]
buffer_load_dwordx4 v[104:107], v1, s[44:47], s79 offen offset:2048 sc1
v_mfma_f32_16x16x32_bf16 v[36:39], v[212:215], a[84:87], v[36:39]
s_nop 0
ds_read_b64_tr_b16 v[148:149], v9 offset:53248
ds_read_b64_tr_b16 v[150:151], v9 offset:55296
v_mfma_f32_16x16x32_bf16 v[36:39], v[228:231], a[88:91], v[36:39]
v_mul_f32 v56, v56, v115
v_mul_f32 v72, v72, v114
v_mfma_f32_16x16x32_bf16 v[36:39], v[244:247], a[92:95], v[36:39]
s_nop 0
ds_read_b64_tr_b16 v[152:153], v10 offset:53248
ds_read_b64_tr_b16 v[154:155], v10 offset:55296
v_mfma_f32_16x16x32_bf16 v[20:23], v[244:247], a[76:79], v[20:23]
s_nop 0
ds_read_b64_tr_b16 v[156:157], v11 offset:53248
ds_read_b64_tr_b16 v[158:159], v11 offset:55296
v_mfma_f32_16x16x32_bf16 v[20:23], v[228:231], a[72:75], v[20:23]
buffer_load_dwordx4 v[108:111], v1, s[44:47], s79 offen offset:3072 sc1
v_mfma_f32_16x16x32_bf16 v[20:23], v[212:215], a[68:71], v[20:23]
v_and_b32 v114, 0xffff0000, v57
v_lshlrev_b32 v115, 16, v73
v_mfma_f32_16x16x32_bf16 v[20:23], v[196:199], a[64:67], v[20:23]
s_nop 0
ds_read_b64_tr_b16 v[160:161], v8 offset:57344
ds_read_b64_tr_b16 v[162:163], v8 offset:59392
v_mfma_f32_16x16x32_bf16 v[24:27], v[200:203], a[64:67], v[24:27]
s_nop 0
ds_read_b64_tr_b16 v[164:165], v9 offset:57344
ds_read_b64_tr_b16 v[166:167], v9 offset:59392
v_mfma_f32_16x16x32_bf16 v[24:27], v[216:219], a[68:71], v[24:27]
v_lshlrev_b32 v57, 16, v57
v_and_b32 v73, 0xffff0000, v73
v_mfma_f32_16x16x32_bf16 v[24:27], v[232:235], a[72:75], v[24:27]
s_nop 0
ds_read_b64_tr_b16 v[168:169], v10 offset:57344
ds_read_b64_tr_b16 v[170:171], v10 offset:59392
v_mfma_f32_16x16x32_bf16 v[24:27], v[248:251], a[76:79], v[24:27]
s_nop 0
ds_read_b64_tr_b16 v[172:173], v11 offset:57344
ds_read_b64_tr_b16 v[174:175], v11 offset:59392
v_mfma_f32_16x16x32_bf16 v[40:43], v[248:251], a[92:95], v[40:43]
v_mul_f32 v57, v57, v113
v_mul_f32 v114, v114, v113
v_mfma_f32_16x16x32_bf16 v[40:43], v[232:235], a[88:91], v[40:43]
s_nop 0
ds_read_b64_tr_b16 v[176:177], v8 offset:61440
ds_read_b64_tr_b16 v[178:179], v8 offset:63488
v_mfma_f32_16x16x32_bf16 v[40:43], v[216:219], a[84:87], v[40:43]
s_nop 0
ds_read_b64_tr_b16 v[180:181], v9 offset:61440
ds_read_b64_tr_b16 v[182:183], v9 offset:63488
v_mfma_f32_16x16x32_bf16 v[40:43], v[200:203], a[80:83], v[40:43]
v_mul_f32 v57, v57, v115
v_mul_f32 v73, v73, v114
v_mfma_f32_16x16x32_bf16 v[44:47], v[204:207], a[80:83], v[44:47]
s_nop 0
ds_read_b64_tr_b16 v[184:185], v10 offset:61440
ds_read_b64_tr_b16 v[186:187], v10 offset:63488
v_mfma_f32_16x16x32_bf16 v[44:47], v[220:223], a[84:87], v[44:47]
s_nop 0
ds_read_b64_tr_b16 v[188:189], v11 offset:61440
ds_read_b64_tr_b16 v[190:191], v11 offset:63488
v_mfma_f32_16x16x32_bf16 v[44:47], v[236:239], a[88:91], v[44:47]
v_and_b32 v114, 0xffff0000, v58
v_lshlrev_b32 v115, 16, v74
v_mfma_f32_16x16x32_bf16 v[44:47], v[252:255], a[92:95], v[44:47]
v_lshlrev_b32 v58, 16, v58
v_and_b32 v74, 0xffff0000, v74
v_mfma_f32_16x16x32_bf16 v[28:31], v[252:255], a[76:79], v[28:31]
v_xor_b32 v8, 0x10000, v8
v_mul_f32 v58, v58, v113
v_mfma_f32_16x16x32_bf16 v[28:31], v[236:239], a[72:75], v[28:31]
v_xor_b32 v9, 0x10000, v9
v_mul_f32 v114, v114, v113
v_mfma_f32_16x16x32_bf16 v[28:31], v[220:223], a[68:71], v[28:31]
s_waitcnt vmcnt(22) lgkmcnt(0)
v_xor_b32 v10, 0x10000, v10
v_mul_f32 v58, v58, v115
v_mfma_f32_16x16x32_bf16 v[28:31], v[204:207], a[64:67], v[28:31]
s_barrier
v_xor_b32 v11, 0x10000, v11
v_mul_f32 v74, v74, v114
v_mfma_f32_16x16x32_bf16 v[16:19], v[128:131], a[96:99], v[16:19]
s_nop 0
ds_read_b64_tr_b16 v[192:193], v8 offset:0
ds_read_b64_tr_b16 v[194:195], v8 offset:2048
v_mfma_f32_16x16x32_bf16 v[16:19], v[144:147], a[100:103], v[16:19]
s_nop 0
ds_read_b64_tr_b16 v[196:197], v9 offset:0
ds_read_b64_tr_b16 v[198:199], v9 offset:2048
v_mfma_f32_16x16x32_bf16 v[16:19], v[160:163], a[104:107], v[16:19]
v_and_b32 v114, 0xffff0000, v59
v_lshlrev_b32 v115, 16, v75
v_mfma_f32_16x16x32_bf16 v[16:19], v[176:179], a[108:111], v[16:19]
s_nop 0
ds_read_b64_tr_b16 v[200:201], v10 offset:0
ds_read_b64_tr_b16 v[202:203], v10 offset:2048
v_mfma_f32_16x16x32_bf16 v[32:35], v[176:179], a[124:127], v[32:35]
v_lshlrev_b32 v59, 16, v59
v_and_b32 v75, 0xffff0000, v75
v_mfma_f32_16x16x32_bf16 v[32:35], v[160:163], a[120:123], v[32:35]
s_nop 0
ds_read_b64_tr_b16 v[204:205], v11 offset:0
ds_read_b64_tr_b16 v[206:207], v11 offset:2048
v_mfma_f32_16x16x32_bf16 v[32:35], v[144:147], a[116:119], v[32:35]
s_nop 0
ds_read_b64_tr_b16 v[208:209], v8 offset:4096
ds_read_b64_tr_b16 v[210:211], v8 offset:6144
v_mfma_f32_16x16x32_bf16 v[32:35], v[128:131], a[112:115], v[32:35]
v_mul_f32 v59, v59, v113
v_mul_f32 v114, v114, v113
v_mfma_f32_16x16x32_bf16 v[36:39], v[132:135], a[112:115], v[36:39]
s_nop 0
ds_read_b64_tr_b16 v[212:213], v9 offset:4096
ds_read_b64_tr_b16 v[214:215], v9 offset:6144
v_mfma_f32_16x16x32_bf16 v[36:39], v[148:151], a[116:119], v[36:39]
v_mul_f32 v59, v59, v115
v_mul_f32 v75, v75, v114
v_mfma_f32_16x16x32_bf16 v[36:39], v[164:167], a[120:123], v[36:39]
s_nop 0
ds_read_b64_tr_b16 v[216:217], v10 offset:4096
ds_read_b64_tr_b16 v[218:219], v10 offset:6144
v_mfma_f32_16x16x32_bf16 v[36:39], v[180:183], a[124:127], v[36:39]
s_nop 0
ds_read_b64_tr_b16 v[220:221], v11 offset:4096
ds_read_b64_tr_b16 v[222:223], v11 offset:6144
v_mfma_f32_16x16x32_bf16 v[20:23], v[180:183], a[108:111], v[20:23]
v_and_b32 v114, 0xffff0000, v60
v_lshlrev_b32 v115, 16, v76
v_mfma_f32_16x16x32_bf16 v[20:23], v[164:167], a[104:107], v[20:23]
s_nop 0
ds_read_b64_tr_b16 v[224:225], v8 offset:8192
ds_read_b64_tr_b16 v[226:227], v8 offset:10240
v_mfma_f32_16x16x32_bf16 v[20:23], v[148:151], a[100:103], v[20:23]
v_lshlrev_b32 v60, 16, v60
v_and_b32 v76, 0xffff0000, v76
v_mfma_f32_16x16x32_bf16 v[20:23], v[132:135], a[96:99], v[20:23]
s_nop 0
ds_read_b64_tr_b16 v[228:229], v9 offset:8192
ds_read_b64_tr_b16 v[230:231], v9 offset:10240
v_mfma_f32_16x16x32_bf16 v[24:27], v[136:139], a[96:99], v[24:27]
s_nop 0
ds_read_b64_tr_b16 v[232:233], v10 offset:8192
ds_read_b64_tr_b16 v[234:235], v10 offset:10240
v_mfma_f32_16x16x32_bf16 v[24:27], v[152:155], a[100:103], v[24:27]
v_mul_f32 v60, v60, v113
v_mul_f32 v114, v114, v113
v_mfma_f32_16x16x32_bf16 v[24:27], v[168:171], a[104:107], v[24:27]
s_nop 0
ds_read_b64_tr_b16 v[236:237], v11 offset:8192
ds_read_b64_tr_b16 v[238:239], v11 offset:10240
v_mfma_f32_16x16x32_bf16 v[24:27], v[184:187], a[108:111], v[24:27]
v_mul_f32 v60, v60, v115
v_mul_f32 v76, v76, v114
v_mfma_f32_16x16x32_bf16 v[40:43], v[184:187], a[124:127], v[40:43]
s_nop 0
ds_read_b64_tr_b16 v[240:241], v8 offset:12288
ds_read_b64_tr_b16 v[242:243], v8 offset:14336
v_mfma_f32_16x16x32_bf16 v[40:43], v[168:171], a[120:123], v[40:43]
s_nop 0
ds_read_b64_tr_b16 v[244:245], v9 offset:12288
ds_read_b64_tr_b16 v[246:247], v9 offset:14336
v_mfma_f32_16x16x32_bf16 v[40:43], v[152:155], a[116:119], v[40:43]
v_and_b32 v114, 0xffff0000, v61
v_lshlrev_b32 v115, 16, v77
v_mfma_f32_16x16x32_bf16 v[40:43], v[136:139], a[112:115], v[40:43]
s_nop 0
ds_read_b64_tr_b16 v[248:249], v10 offset:12288
ds_read_b64_tr_b16 v[250:251], v10 offset:14336
v_mfma_f32_16x16x32_bf16 v[44:47], v[140:143], a[112:115], v[44:47]
v_lshlrev_b32 v61, 16, v61
v_and_b32 v77, 0xffff0000, v77
v_mfma_f32_16x16x32_bf16 v[44:47], v[156:159], a[116:119], v[44:47]
s_nop 0
ds_read_b64_tr_b16 v[252:253], v11 offset:12288
ds_read_b64_tr_b16 v[254:255], v11 offset:14336
v_mfma_f32_16x16x32_bf16 v[44:47], v[172:175], a[120:123], v[44:47]
v_mul_f32 v61, v61, v113
v_mul_f32 v114, v114, v113
v_mfma_f32_16x16x32_bf16 v[44:47], v[188:191], a[124:127], v[44:47]
s_waitcnt vmcnt(0)
v_max3_u32 v12, v96, v97, v98
v_max3_u32 v13, v99, v100, v101
v_mfma_f32_16x16x32_bf16 v[28:31], v[188:191], a[108:111], v[28:31]
v_max3_u32 v12, v12, v102, v103
v_max3_u32 v13, v13, v104, v105
v_mfma_f32_16x16x32_bf16 v[28:31], v[172:175], a[104:107], v[28:31]
v_max3_u32 v12, v12, v106, v107
v_max3_u32 v13, v13, v108, v109
v_mfma_f32_16x16x32_bf16 v[28:31], v[156:159], a[100:103], v[28:31]
s_waitcnt vmcnt(16) lgkmcnt(0)
v_max3_u32 v12, v12, v110, v111
v_mul_f32 v61, v61, v115
v_mfma_f32_16x16x32_bf16 v[28:31], v[140:143], a[96:99], v[28:31]
s_barrier
v_max_u32 v12, v12, v13
v_mul_f32 v77, v77, v114
v_mfma_f32_16x16x32_bf16 v[16:19], v[192:195], a[128:131], v[16:19]
v_cmp_le_u32 vcc, 0xff800000, v12
v_and_b32 v114, 0xffff0000, v62
v_mfma_f32_16x16x32_bf16 v[16:19], v[208:211], a[132:135], v[16:19]
s_nop 0
ds_read_b64_tr_b16 v[128:129], v8 offset:16384
ds_read_b64_tr_b16 v[130:131], v8 offset:18432
v_mfma_f32_16x16x32_bf16 v[16:19], v[224:227], a[136:139], v[16:19]
s_cbranch_vccnz Lxspin1
Lxback1:
ds_read_b64_tr_b16 v[132:133], v9 offset:16384
ds_read_b64_tr_b16 v[134:135], v9 offset:18432
v_mfma_f32_16x16x32_bf16 v[16:19], v[240:243], a[140:143], v[16:19]
v_lshlrev_b32 v115, 16, v78
v_lshlrev_b32 v62, 16, v62
v_mfma_f32_16x16x32_bf16 v[16:19], v[124:127], v[96:99], v[16:19]
s_nop 0
ds_read_b64_tr_b16 v[136:137], v10 offset:16384
ds_read_b64_tr_b16 v[138:139], v10 offset:18432
v_mfma_f32_16x16x32_bf16 v[32:35], v[240:243], a[156:159], v[32:35]
v_and_b32 v78, 0xffff0000, v78
v_mul_f32 v62, v62, v113
v_mfma_f32_16x16x32_bf16 v[32:35], v[224:227], a[152:155], v[32:35]
s_add_u32 s82, s93, 0x3e00000
buffer_load_dwordx4 v[80:83], v1, s[44:47], s82 offen sc1
v_mfma_f32_16x16x32_bf16 v[32:35], v[208:211], a[148:151], v[32:35]
s_nop 0
ds_read_b64_tr_b16 v[140:141], v11 offset:16384
ds_read_b64_tr_b16 v[142:143], v11 offset:18432
v_mfma_f32_16x16x32_bf16 v[32:35], v[192:195], a[144:147], v[32:35]
v_mul_f32 v114, v114, v113
v_mul_f32 v62, v62, v115
v_mfma_f32_16x16x32_bf16 v[32:35], v[124:127], v[104:107], v[32:35]
s_nop 0
ds_read_b64_tr_b16 v[144:145], v8 offset:20480
ds_read_b64_tr_b16 v[146:147], v8 offset:22528
v_mfma_f32_16x16x32_bf16 v[36:39], v[196:199], a[144:147], v[36:39]
v_mul_f32 v78, v78, v114
v_and_b32 v114, 0xffff0000, v63
v_mfma_f32_16x16x32_bf16 v[36:39], v[212:215], a[148:151], v[36:39]
buffer_load_dwordx4 v[84:87], v1, s[44:47], s82 offen offset:1024 sc1
v_mfma_f32_16x16x32_bf16 v[36:39], v[228:231], a[152:155], v[36:39]
s_nop 0
ds_read_b64_tr_b16 v[148:149], v9 offset:20480
ds_read_b64_tr_b16 v[150:151], v9 offset:22528
v_mfma_f32_16x16x32_bf16 v[36:39], v[244:247], a[156:159], v[36:39]
v_lshlrev_b32 v115, 16, v79
v_lshlrev_b32 v63, 16, v63
v_mfma_f32_16x16x32_bf16 v[36:39], v[120:123], v[104:107], v[36:39]
s_nop 0
ds_read_b64_tr_b16 v[152:153], v10 offset:20480
ds_read_b64_tr_b16 v[154:155], v10 offset:22528
v_mfma_f32_16x16x32_bf16 v[20:23], v[244:247], a[140:143], v[20:23]
v_and_b32 v79, 0xffff0000, v79
v_mul_f32 v63, v63, v113
v_mfma_f32_16x16x32_bf16 v[20:23], v[228:231], a[136:139], v[20:23]
buffer_load_dwordx4 v[88:91], v1, s[44:47], s82 offen offset:2048 sc1
v_mfma_f32_16x16x32_bf16 v[20:23], v[212:215], a[132:135], v[20:23]
s_nop 0
ds_read_b64_tr_b16 v[156:157], v11 offset:20480
ds_read_b64_tr_b16 v[158:159], v11 offset:22528
v_mfma_f32_16x16x32_bf16 v[20:23], v[196:199], a[128:131], v[20:23]
v_mul_f32 v114, v114, v113
v_mul_f32 v63, v63, v115
v_mfma_f32_16x16x32_bf16 v[20:23], v[120:123], v[96:99], v[20:23]
s_nop 0
ds_read_b64_tr_b16 v[160:161], v8 offset:24576
ds_read_b64_tr_b16 v[162:163], v8 offset:26624
v_mfma_f32_16x16x32_bf16 v[24:27], v[200:203], a[128:131], v[24:27]
s_nop 0
ds_read_b64_tr_b16 v[164:165], v9 offset:24576
ds_read_b64_tr_b16 v[166:167], v9 offset:26624
v_mfma_f32_16x16x32_bf16 v[24:27], v[216:219], a[132:135], v[24:27]
buffer_load_dwordx4 v[92:95], v1, s[44:47], s82 offen offset:3072 sc1
v_mfma_f32_16x16x32_bf16 v[24:27], v[232:235], a[136:139], v[24:27]
v_mul_f32 v79, v79, v114
v_mfma_f32_16x16x32_bf16 v[24:27], v[248:251], a[140:143], v[24:27]
s_nop 0
ds_read_b64_tr_b16 v[168:169], v10 offset:24576
ds_read_b64_tr_b16 v[170:171], v10 offset:26624
v_mfma_f32_16x16x32_bf16 v[24:27], v[124:127], v[100:103], v[24:27]
v_mfma_f32_16x16x32_bf16 v[40:43], v[248:251], a[156:159], v[40:43]
s_nop 0
ds_read_b64_tr_b16 v[172:173], v11 offset:24576
ds_read_b64_tr_b16 v[174:175], v11 offset:26624
v_mfma_f32_16x16x32_bf16 v[40:43], v[232:235], a[152:155], v[40:43]
v_mfma_f32_16x16x32_bf16 v[40:43], v[216:219], a[148:151], v[40:43]
s_nop 0
ds_read_b64_tr_b16 v[176:177], v8 offset:28672
ds_read_b64_tr_b16 v[178:179], v8 offset:30720
v_mfma_f32_16x16x32_bf16 v[40:43], v[200:203], a[144:147], v[40:43]
v_mfma_f32_16x16x32_bf16 v[40:43], v[124:127], v[108:111], v[40:43]
s_nop 0
ds_read_b64_tr_b16 v[180:181], v9 offset:28672
ds_read_b64_tr_b16 v[182:183], v9 offset:30720
v_mfma_f32_16x16x32_bf16 v[44:47], v[204:207], a[144:147], v[44:47]
v_mfma_f32_16x16x32_bf16 v[44:47], v[220:223], a[148:151], v[44:47]
s_nop 0
ds_read_b64_tr_b16 v[184:185], v10 offset:28672
ds_read_b64_tr_b16 v[186:187], v10 offset:30720
v_mfma_f32_16x16x32_bf16 v[44:47], v[236:239], a[152:155], v[44:47]
v_mfma_f32_16x16x32_bf16 v[44:47], v[252:255], a[156:159], v[44:47]
s_nop 0
ds_read_b64_tr_b16 v[188:189], v11 offset:28672
ds_read_b64_tr_b16 v[190:191], v11 offset:30720
v_mfma_f32_16x16x32_bf16 v[44:47], v[120:123], v[108:111], v[44:47]
v_mfma_f32_16x16x32_bf16 v[28:31], v[252:255], a[140:143], v[28:31]
v_mfma_f32_16x16x32_bf16 v[28:31], v[236:239], a[136:139], v[28:31]
v_mfma_f32_16x16x32_bf16 v[28:31], v[220:223], a[132:135], v[28:31]
v_mfma_f32_16x16x32_bf16 v[28:31], v[204:207], a[128:131], v[28:31]
s_waitcnt vmcnt(16) lgkmcnt(0)
v_mfma_f32_16x16x32_bf16 v[28:31], v[120:123], v[100:103], v[28:31]
s_barrier
v_mfma_f32_16x16x32_bf16 v[16:19], v[128:131], a[160:163], v[16:19]
s_nop 0
ds_read_b64_tr_b16 v[192:193], v8 offset:32768
ds_read_b64_tr_b16 v[194:195], v8 offset:34816
v_mfma_f32_16x16x32_bf16 v[16:19], v[144:147], a[164:167], v[16:19]
s_nop 0
ds_read_b64_tr_b16 v[196:197], v9 offset:32768
ds_read_b64_tr_b16 v[198:199], v9 offset:34816
v_mfma_f32_16x16x32_bf16 v[16:19], v[160:163], a[168:171], v[16:19]
s_nop 0
ds_read_b64_tr_b16 v[200:201], v10 offset:32768
ds_read_b64_tr_b16 v[202:203], v10 offset:34816
v_mfma_f32_16x16x32_bf16 v[16:19], v[176:179], a[172:175], v[16:19]
v_mfma_f32_16x16x32_bf16 v[32:35], v[176:179], a[188:191], v[32:35]
s_nop 0
ds_read_b64_tr_b16 v[204:205], v11 offset:32768
ds_read_b64_tr_b16 v[206:207], v11 offset:34816
v_mfma_f32_16x16x32_bf16 v[32:35], v[160:163], a[184:187], v[32:35]
s_nop 0
ds_read_b64_tr_b16 v[208:209], v8 offset:36864
ds_read_b64_tr_b16 v[210:211], v8 offset:38912
v_mfma_f32_16x16x32_bf16 v[32:35], v[144:147], a[180:183], v[32:35]
s_add_u32 s81, s93, 0x4200000
buffer_load_dwordx4 v[96:99], v1, s[44:47], s81 offen sc1
v_mfma_f32_16x16x32_bf16 v[32:35], v[128:131], a[176:179], v[32:35]
v_mfma_f32_16x16x32_bf16 v[36:39], v[132:135], a[176:179], v[36:39]
s_nop 0
ds_read_b64_tr_b16 v[212:213], v9 offset:36864
ds_read_b64_tr_b16 v[214:215], v9 offset:38912
v_mfma_f32_16x16x32_bf16 v[36:39], v[148:151], a[180:183], v[36:39]
s_nop 0
ds_read_b64_tr_b16 v[216:217], v10 offset:36864
ds_read_b64_tr_b16 v[218:219], v10 offset:38912
v_mfma_f32_16x16x32_bf16 v[36:39], v[164:167], a[184:187], v[36:39]
v_mfma_f32_16x16x32_bf16 v[36:39], v[180:183], a[188:191], v[36:39]
buffer_load_dwordx4 v[100:103], v1, s[44:47], s81 offen offset:1024 sc1
v_mfma_f32_16x16x32_bf16 v[20:23], v[180:183], a[172:175], v[20:23]
s_nop 0
ds_read_b64_tr_b16 v[220:221], v11 offset:36864
ds_read_b64_tr_b16 v[222:223], v11 offset:38912
v_mfma_f32_16x16x32_bf16 v[20:23], v[164:167], a[168:171], v[20:23]
s_nop 0
ds_read_b64_tr_b16 v[224:225], v8 offset:40960
ds_read_b64_tr_b16 v[226:227], v8 offset:43008
v_mfma_f32_16x16x32_bf16 v[20:23], v[148:151], a[164:167], v[20:23]
s_nop 0
ds_read_b64_tr_b16 v[228:229], v9 offset:40960
ds_read_b64_tr_b16 v[230:231], v9 offset:43008
v_mfma_f32_16x16x32_bf16 v[20:23], v[132:135], a[160:163], v[20:23]
v_mfma_f32_16x16x32_bf16 v[24:27], v[136:139], a[160:163], v[24:27]
buffer_load_dwordx4 v[104:107], v1, s[44:47], s81 offen offset:2048 sc1
v_mfma_f32_16x16x32_bf16 v[24:27], v[152:155], a[164:167], v[24:27]
s_nop 0
ds_read_b64_tr_b16 v[232:233], v10 offset:40960
ds_read_b64_tr_b16 v[234:235], v10 offset:43008
v_mfma_f32_16x16x32_bf16 v[24:27], v[168:171], a[168:171], v[24:27]
s_nop 0
ds_read_b64_tr_b16 v[236:237], v11 offset:40960
ds_read_b64_tr_b16 v[238:239], v11 offset:43008
v_mfma_f32_16x16x32_bf16 v[24:27], v[184:187], a[172:175], v[24:27]
v_mfma_f32_16x16x32_bf16 v[40:43], v[184:187], a[188:191], v[40:43]
s_nop 0
ds_read_b64_tr_b16 v[240:241], v8 offset:45056
ds_read_b64_tr_b16 v[242:243], v8 offset:47104
v_mfma_f32_16x16x32_bf16 v[40:43], v[168:171], a[184:187], v[40:43]
buffer_load_dwordx4 v[108:111], v1, s[44:47], s81 offen offset:3072 sc1
v_mfma_f32_16x16x32_bf16 v[40:43], v[152:155], a[180:183], v[40:43]
s_nop 0
ds_read_b64_tr_b16 v[244:245], v9 offset:45056
ds_read_b64_tr_b16 v[246:247], v9 offset:47104
v_mfma_f32_16x16x32_bf16 v[40:43], v[136:139], a[176:179], v[40:43]
v_mfma_f32_16x16x32_bf16 v[44:47], v[140:143], a[176:179], v[44:47]
s_nop 0
ds_read_b64_tr_b16 v[248:249], v10 offset:45056
ds_read_b64_tr_b16 v[250:251], v10 offset:47104
v_mfma_f32_16x16x32_bf16 v[44:47], v[156:159], a[180:183], v[44:47]
s_nop 0
ds_read_b64_tr_b16 v[252:253], v11 offset:45056
ds_read_b64_tr_b16 v[254:255], v11 offset:47104
v_mfma_f32_16x16x32_bf16 v[44:47], v[172:175], a[184:187], v[44:47]
v_mfma_f32_16x16x32_bf16 v[44:47], v[188:191], a[188:191], v[44:47]
s_waitcnt vmcnt(4)
v_max3_u32 v12, v80, v81, v82
v_max3_u32 v13, v83, v84, v85
v_mfma_f32_16x16x32_bf16 v[28:31], v[188:191], a[172:175], v[28:31]
v_max3_u32 v12, v12, v86, v87
v_max3_u32 v13, v13, v88, v89
v_mfma_f32_16x16x32_bf16 v[28:31], v[172:175], a[168:171], v[28:31]
v_max3_u32 v12, v12, v90, v91
v_max3_u32 v13, v13, v92, v93
v_mfma_f32_16x16x32_bf16 v[28:31], v[156:159], a[164:167], v[28:31]
s_waitcnt vmcnt(15) lgkmcnt(0)
v_max3_u32 v12, v12, v94, v95
v_mfma_f32_16x16x32_bf16 v[28:31], v[140:143], a[160:163], v[28:31]
s_barrier
v_max_u32 v12, v12, v13
v_mfma_f32_16x16x32_bf16 v[16:19], v[192:195], a[192:195], v[16:19]
v_cmp_le_u32 vcc, 0xff800000, v12
v_mfma_f32_16x16x32_bf16 v[16:19], v[208:211], a[196:199], v[16:19]
s_nop 0
ds_read_b64_tr_b16 v[128:129], v8 offset:49152
ds_read_b64_tr_b16 v[130:131], v8 offset:51200
v_mfma_f32_16x16x32_bf16 v[16:19], v[224:227], a[200:203], v[16:19]
s_cbranch_vccnz Lxspin2
Lxback2:
v_mfma_f32_16x16x32_bf16 v[16:19], v[240:243], a[204:207], v[16:19]
s_nop 0
ds_read_b64_tr_b16 v[132:133], v9 offset:49152
ds_read_b64_tr_b16 v[134:135], v9 offset:51200
v_mfma_f32_16x16x32_bf16 v[16:19], v[124:127], v[80:83], v[16:19]
v_mfma_f32_16x16x32_bf16 v[32:35], v[240:243], a[220:223], v[32:35]
s_nop 0
ds_read_b64_tr_b16 v[136:137], v10 offset:49152
ds_read_b64_tr_b16 v[138:139], v10 offset:51200
v_mfma_f32_16x16x32_bf16 v[32:35], v[224:227], a[216:219], v[32:35]
v_mfma_f32_16x16x32_bf16 v[32:35], v[208:211], a[212:215], v[32:35]
s_nop 0
ds_read_b64_tr_b16 v[140:141], v11 offset:49152
ds_read_b64_tr_b16 v[142:143], v11 offset:51200
v_mfma_f32_16x16x32_bf16 v[32:35], v[192:195], a[208:211], v[32:35]
v_mfma_f32_16x16x32_bf16 v[32:35], v[124:127], v[88:91], v[32:35]
s_nop 0
ds_read_b64_tr_b16 v[144:145], v8 offset:53248
ds_read_b64_tr_b16 v[146:147], v8 offset:55296
v_mfma_f32_16x16x32_bf16 v[36:39], v[196:199], a[208:211], v[36:39]
v_mfma_f32_16x16x32_bf16 v[36:39], v[212:215], a[212:215], v[36:39]
s_nop 0
ds_read_b64_tr_b16 v[148:149], v9 offset:53248
ds_read_b64_tr_b16 v[150:151], v9 offset:55296
v_mfma_f32_16x16x32_bf16 v[36:39], v[228:231], a[216:219], v[36:39]
v_mfma_f32_16x16x32_bf16 v[36:39], v[244:247], a[220:223], v[36:39]
s_nop 0
ds_read_b64_tr_b16 v[152:153], v10 offset:53248
ds_read_b64_tr_b16 v[154:155], v10 offset:55296
v_mfma_f32_16x16x32_bf16 v[36:39], v[120:123], v[88:91], v[36:39]
v_mfma_f32_16x16x32_bf16 v[20:23], v[244:247], a[204:207], v[20:23]
s_nop 0
ds_read_b64_tr_b16 v[156:157], v11 offset:53248
ds_read_b64_tr_b16 v[158:159], v11 offset:55296
v_mfma_f32_16x16x32_bf16 v[20:23], v[228:231], a[200:203], v[20:23]
v_mfma_f32_16x16x32_bf16 v[20:23], v[212:215], a[196:199], v[20:23]
v_mfma_f32_16x16x32_bf16 v[20:23], v[196:199], a[192:195], v[20:23]
s_nop 0
ds_read_b64_tr_b16 v[160:161], v8 offset:57344
ds_read_b64_tr_b16 v[162:163], v8 offset:59392
v_mfma_f32_16x16x32_bf16 v[20:23], v[120:123], v[80:83], v[20:23]
v_mfma_f32_16x16x32_bf16 v[24:27], v[200:203], a[192:195], v[24:27]
s_nop 0
ds_read_b64_tr_b16 v[164:165], v9 offset:57344
ds_read_b64_tr_b16 v[166:167], v9 offset:59392
v_mfma_f32_16x16x32_bf16 v[24:27], v[216:219], a[196:199], v[24:27]
v_mfma_f32_16x16x32_bf16 v[24:27], v[232:235], a[200:203], v[24:27]
s_nop 0
ds_read_b64_tr_b16 v[168:169], v10 offset:57344
ds_read_b64_tr_b16 v[170:171], v10 offset:59392
v_mfma_f32_16x16x32_bf16 v[24:27], v[248:251], a[204:207], v[24:27]
v_mfma_f32_16x16x32_bf16 v[24:27], v[124:127], v[84:87], v[24:27]
s_nop 0
ds_read_b64_tr_b16 v[172:173], v11 offset:57344
ds_read_b64_tr_b16 v[174:175], v11 offset:59392
v_mfma_f32_16x16x32_bf16 v[40:43], v[248:251], a[220:223], v[40:43]
v_mfma_f32_16x16x32_bf16 v[40:43], v[232:235], a[216:219], v[40:43]
s_nop 0
ds_read_b64_tr_b16 v[176:177], v8 offset:61440
ds_read_b64_tr_b16 v[178:179], v8 offset:63488
v_mfma_f32_16x16x32_bf16 v[40:43], v[216:219], a[212:215], v[40:43]
v_mfma_f32_16x16x32_bf16 v[40:43], v[200:203], a[208:211], v[40:43]
s_nop 0
ds_read_b64_tr_b16 v[180:181], v9 offset:61440
ds_read_b64_tr_b16 v[182:183], v9 offset:63488
v_mfma_f32_16x16x32_bf16 v[40:43], v[124:127], v[92:95], v[40:43]
v_mfma_f32_16x16x32_bf16 v[44:47], v[204:207], a[208:211], v[44:47]
s_nop 0
ds_read_b64_tr_b16 v[184:185], v10 offset:61440
ds_read_b64_tr_b16 v[186:187], v10 offset:63488
v_mfma_f32_16x16x32_bf16 v[44:47], v[220:223], a[212:215], v[44:47]
v_mfma_f32_16x16x32_bf16 v[44:47], v[236:239], a[216:219], v[44:47]
s_nop 0
ds_read_b64_tr_b16 v[188:189], v11 offset:61440
ds_read_b64_tr_b16 v[190:191], v11 offset:63488
v_mfma_f32_16x16x32_bf16 v[44:47], v[252:255], a[220:223], v[44:47]
v_mfma_f32_16x16x32_bf16 v[44:47], v[120:123], v[92:95], v[44:47]
v_mfma_f32_16x16x32_bf16 v[28:31], v[252:255], a[204:207], v[28:31]
s_waitcnt vmcnt(0)
v_max3_u32 v12, v96, v97, v98
v_max3_u32 v13, v99, v100, v101
v_mfma_f32_16x16x32_bf16 v[28:31], v[236:239], a[200:203], v[28:31]
v_max3_u32 v12, v12, v102, v103
v_max3_u32 v13, v13, v104, v105
v_mfma_f32_16x16x32_bf16 v[28:31], v[220:223], a[196:199], v[28:31]
v_max3_u32 v12, v12, v106, v107
v_max3_u32 v13, v13, v108, v109
v_mfma_f32_16x16x32_bf16 v[28:31], v[204:207], a[192:195], v[28:31]
s_waitcnt lgkmcnt(0)
v_max3_u32 v12, v12, v110, v111
v_mfma_f32_16x16x32_bf16 v[28:31], v[120:123], v[84:87], v[28:31]
v_max_u32 v12, v12, v13
v_mfma_f32_16x16x32_bf16 v[16:19], v[128:131], a[224:227], v[16:19]
v_cmp_le_u32 vcc, 0xff800000, v12
v_mfma_f32_16x16x32_bf16 v[16:19], v[144:147], a[228:231], v[16:19]
v_mfma_f32_16x16x32_bf16 v[16:19], v[160:163], a[232:235], v[16:19]
s_cbranch_vccnz Lxspin3
Lxback3:
v_mfma_f32_16x16x32_bf16 v[16:19], v[176:179], a[236:239], v[16:19]
v_mfma_f32_16x16x32_bf16 v[16:19], v[124:127], v[96:99], v[16:19]
v_mfma_f32_16x16x32_bf16 v[20:23], v[180:183], a[236:239], v[20:23]
v_mfma_f32_16x16x32_bf16 v[20:23], v[164:167], a[232:235], v[20:23]
v_mfma_f32_16x16x32_bf16 v[20:23], v[148:151], a[228:231], v[20:23]
v_mfma_f32_16x16x32_bf16 v[20:23], v[132:135], a[224:227], v[20:23]
s_nop 3
v_fma_f32 v16, v16, v6, v48
v_fma_f32 v17, v17, v6, v64
v_mfma_f32_16x16x32_bf16 v[20:23], v[120:123], v[96:99], v[20:23]
v_fma_f32 v18, v18, v6, v49
v_fma_f32 v19, v19, v6, v65
v_mfma_f32_16x16x32_bf16 v[24:27], v[136:139], a[224:227], v[24:27]
v_cvt_pk_bf16_f32 v16, v16, v17
v_cvt_pk_bf16_f32 v17, v18, v19
v_mfma_f32_16x16x32_bf16 v[24:27], v[152:155], a[228:231], v[24:27]
ds_write_b64 v116, v[16:17] offset:0
v_mfma_f32_16x16x32_bf16 v[24:27], v[168:171], a[232:235], v[24:27]
v_mfma_f32_16x16x32_bf16 v[24:27], v[184:187], a[236:239], v[24:27]
v_fma_f32 v20, v20, v6, v50
v_fma_f32 v21, v21, v6, v66
v_mfma_f32_16x16x32_bf16 v[24:27], v[124:127], v[100:103], v[24:27]
v_fma_f32 v22, v22, v6, v51
v_fma_f32 v23, v23, v6, v67
v_mfma_f32_16x16x32_bf16 v[28:31], v[188:191], a[236:239], v[28:31]
v_cvt_pk_bf16_f32 v20, v20, v21
v_cvt_pk_bf16_f32 v21, v22, v23
v_mfma_f32_16x16x32_bf16 v[28:31], v[172:175], a[232:235], v[28:31]
ds_write_b64 v117, v[20:21] offset:0
v_mfma_f32_16x16x32_bf16 v[28:31], v[156:159], a[228:231], v[28:31]
v_mfma_f32_16x16x32_bf16 v[28:31], v[140:143], a[224:227], v[28:31]
v_fma_f32 v24, v24, v6, v52
v_fma_f32 v25, v25, v6, v68
v_mfma_f32_16x16x32_bf16 v[28:31], v[120:123], v[100:103], v[28:31]
v_fma_f32 v26, v26, v6, v53
v_fma_f32 v27, v27, v6, v69
v_mfma_f32_16x16x32_bf16 v[32:35], v[128:131], a[240:243], v[32:35]
v_cvt_pk_bf16_f32 v24, v24, v25
v_cvt_pk_bf16_f32 v25, v26, v27
v_mfma_f32_16x16x32_bf16 v[32:35], v[144:147], a[244:247], v[32:35]
ds_write_b64 v118, v[24:25] offset:0
v_mfma_f32_16x16x32_bf16 v[32:35], v[160:163], a[248:251], v[32:35]
v_mfma_f32_16x16x32_bf16 v[32:35], v[176:179], a[252:255], v[32:35]
v_fma_f32 v28, v28, v6, v54
v_fma_f32 v29, v29, v6, v70
v_mfma_f32_16x16x32_bf16 v[32:35], v[124:127], v[104:107], v[32:35]
v_fma_f32 v30, v30, v6, v55
v_fma_f32 v31, v31, v6, v71
v_mfma_f32_16x16x32_bf16 v[36:39], v[180:183], a[252:255], v[36:39]
v_cvt_pk_bf16_f32 v28, v28, v29
v_cvt_pk_bf16_f32 v29, v30, v31
v_mfma_f32_16x16x32_bf16 v[36:39], v[164:167], a[248:251], v[36:39]
s_nop 0
ds_write_b64 v119, v[28:29] offset:0
ds_read_b128 v[192:195], v4 offset:0
v_mfma_f32_16x16x32_bf16 v[36:39], v[148:151], a[244:247], v[36:39]
ds_read_b128 v[196:199], v4 offset:1024
v_mfma_f32_16x16x32_bf16 v[36:39], v[132:135], a[240:243], v[36:39]
v_fma_f32 v32, v32, v7, v56
v_fma_f32 v33, v33, v7, v72
v_mfma_f32_16x16x32_bf16 v[36:39], v[120:123], v[104:107], v[36:39]
v_fma_f32 v34, v34, v7, v57
v_fma_f32 v35, v35, v7, v73
v_mfma_f32_16x16x32_bf16 v[40:43], v[136:139], a[240:243], v[40:43]
v_cvt_pk_bf16_f32 v32, v32, v33
v_cvt_pk_bf16_f32 v33, v34, v35
v_mfma_f32_16x16x32_bf16 v[40:43], v[152:155], a[244:247], v[40:43]
ds_write_b64 v116, v[32:33] offset:2048
v_mfma_f32_16x16x32_bf16 v[40:43], v[168:171], a[248:251], v[40:43]
s_waitcnt lgkmcnt(2)
buffer_store_dwordx4 v[192:195], v15, s[40:43], s70 offen sc1
v_mfma_f32_16x16x32_bf16 v[40:43], v[184:187], a[252:255], v[40:43]
s_add_u32 s70, s70, 0x4000
v_mfma_f32_16x16x32_bf16 v[40:43], v[124:127], v[108:111], v[40:43]
v_fma_f32 v36, v36, v7, v58
v_fma_f32 v37, v37, v7, v74
v_mfma_f32_16x16x32_bf16 v[44:47], v[188:191], a[252:255], v[44:47]
v_fma_f32 v38, v38, v7, v59
v_fma_f32 v39, v39, v7, v75
v_mfma_f32_16x16x32_bf16 v[44:47], v[172:175], a[248:251], v[44:47]
v_cvt_pk_bf16_f32 v36, v36, v37
v_cvt_pk_bf16_f32 v37, v38, v39
v_mfma_f32_16x16x32_bf16 v[44:47], v[156:159], a[244:247], v[44:47]
ds_write_b64 v117, v[36:37] offset:2048
v_mfma_f32_16x16x32_bf16 v[44:47], v[140:143], a[240:243], v[44:47]
v_fma_f32 v40, v40, v7, v60
v_fma_f32 v41, v41, v7, v76
v_mfma_f32_16x16x32_bf16 v[44:47], v[120:123], v[108:111], v[44:47]
v_fma_f32 v42, v42, v7, v61
v_fma_f32 v43, v43, v7, v77
v_cvt_pk_bf16_f32 v40, v40, v41
v_cvt_pk_bf16_f32 v41, v42, v43
ds_write_b64 v118, v[40:41] offset:2048
s_waitcnt lgkmcnt(3)
buffer_store_dwordx4 v[196:199], v15, s[40:43], s70 offen sc1
s_add_u32 s70, s70, 0x4000
v_fma_f32 v44, v44, v7, v62
v_fma_f32 v45, v45, v7, v78
v_fma_f32 v46, v46, v7, v63
v_fma_f32 v47, v47, v7, v79
v_cvt_pk_bf16_f32 v44, v44, v45
v_cvt_pk_bf16_f32 v45, v46, v47
ds_write_b64 v119, v[44:45] offset:2048
ds_read_b128 v[200:203], v4 offset:2048
ds_read_b128 v[204:207], v4 offset:3072
s_waitcnt lgkmcnt(1)
buffer_store_dwordx4 v[200:203], v15, s[40:43], s70 offen sc1
s_add_u32 s70, s70, 0x4000
s_waitcnt lgkmcnt(0)
buffer_store_dwordx4 v[204:207], v15, s[40:43], s70 offen sc1
s_add_u32 s70, s70, 0x4000
Lend:
s_endpgm
Lspin1:
s_mov_b32 s83, 262144
Lsl3:
s_sleep 2
buffer_load_dword v3, v2, s[48:51], 0 offen sc1
s_sub_u32 s83, s83, 1
s_cmp_eq_u32 s83, 0
s_waitcnt vmcnt(0)
s_cbranch_scc1 Lback2
v_cmp_gt_u32 vcc, 8, v3
s_cbranch_vccnz Lsl3
s_branch Lback2
Lspin4:
s_mov_b32 s83, 262144
Lsl6:
s_sleep 2
buffer_load_dword v3, v2, s[44:47], s75 offen sc1
s_sub_u32 s83, s83, 1
s_cmp_eq_u32 s83, 0
s_waitcnt vmcnt(0)
s_cbranch_scc1 Lback5
v_cmp_gt_u32 vcc, 1, v3
s_cbranch_vccnz Lsl6
s_branch Lback5
.p2align 12
s_endpgm
.p2align 7
LP0x:
Lstub10:
s_cbranch_execz Lret
s_cmp_eq_u32 s58, 2
s_cbranch_scc1 Lta10
s_cmp_eq_u32 s58, 3
s_cbranch_scc1 Lnt11
v_mfma_f32_16x16x32_bf16 v[160:163], a[160:163], v[16:19], v[112:115]
s_xor_b32 s74, s82, 0x10000
v_exp_f32 v128, v128
v_mfma_f32_16x16x32_bf16 v[176:179], a[176:179], v[16:19], v[112:115]
s_add_u32 s74, s74, s64
ds_read_b128 a[128:131], v2 offset:16384
ds_read_b128 a[132:135], v2 offset:17408
s_branch Ljoin12
Lta10:
v_mfma_f32_16x16x32_bf16 v[160:163], a[160:163], v[16:19], v[96:99]
s_xor_b32 s74, s82, 0x10000
v_exp_f32 v128, v128
v_mfma_f32_16x16x32_bf16 v[176:179], a[176:179], v[16:19], v[112:115]
s_add_u32 s74, s74, s64
ds_read_b128 a[128:131], v2 offset:16384
ds_read_b128 a[132:135], v2 offset:17408
s_branch Ljoin12
Lnt11:
v_mfma_f32_16x16x32_bf16 v[160:163], a[160:163], v[16:19], v[80:83]
s_xor_b32 s74, s82, 0x10000
v_exp_f32 v128, v128
v_mfma_f32_16x16x32_bf16 v[176:179], a[176:179], v[16:19], v[96:99]
s_add_u32 s74, s74, s64
ds_read_b128 a[128:131], v2 offset:16384
ds_read_b128 a[132:135], v2 offset:17408
Ljoin12:
v_mfma_f32_16x16x32_bf16 v[160:163], a[164:167], v[20:23], v[160:163]
s_add_u32 s81, s81, 0x8000
v_exp_f32 v129, v129
v_mfma_f32_16x16x32_bf16 v[160:163], a[168:171], v[24:27], v[160:163]
s_add_u32 m0, s74, 16384
v_exp_f32 v130, v130
v_mfma_f32_16x16x32_bf16 v[160:163], a[172:175], v[28:31], v[160:163]
s_add_u32 s72, s81, 16384
v_exp_f32 v131, v131
v_mfma_f32_16x16x32_bf16 v[164:167], a[172:175], v[44:47], v[84:87]
v_exp_f32 v144, v144
v_mfma_f32_16x16x32_bf16 v[164:167], a[168:171], v[40:43], v[164:167]
ds_read_b128 a[136:139], v2 offset:18432
ds_read_b128 a[140:143], v2 offset:19456
v_mfma_f32_16x16x32_bf16 v[164:167], a[164:167], v[36:39], v[164:167]
ds_read_b128 a[144:147], v2 offset:20480
ds_read_b128 a[148:151], v2 offset:21504
v_mfma_f32_16x16x32_bf16 v[164:167], a[160:163], v[32:35], v[164:167]
ds_read_b128 a[152:155], v2 offset:22528
ds_read_b128 a[156:159], v2 offset:23552
v_mfma_f32_16x16x32_bf16 v[168:171], a[160:163], v[48:51], v[88:91]
ds_read_b128 a[192:195], v2 offset:0
ds_read_b128 a[196:199], v2 offset:1024
v_mfma_f32_16x16x32_bf16 v[168:171], a[164:167], v[52:55], v[168:171]
ds_read_b128 a[200:203], v2 offset:2048
ds_read_b128 a[204:207], v2 offset:3072
v_mfma_f32_16x16x32_bf16 v[168:171], a[168:171], v[56:59], v[168:171]
ds_read_b128 a[208:211], v2 offset:4096
ds_read_b128 a[212:215], v2 offset:5120
v_mfma_f32_16x16x32_bf16 v[168:171], a[172:175], v[60:63], v[168:171]
ds_read_b128 a[216:219], v2 offset:6144
ds_read_b128 a[220:223], v2 offset:7168
v_mfma_f32_16x16x32_bf16 v[172:175], a[172:175], v[76:79], v[92:95]
v_cvt_pk_bf16_f32 v192, v128, v129
v_cvt_pk_bf16_f32 v193, v130, v131
v_mfma_f32_16x16x32_bf16 v[172:175], a[168:171], v[72:75], v[172:175]
buffer_load_dwordx4 v1, s[44:47], s72 offen sc1 lds
v_mfma_f32_16x16x32_bf16 v[172:175], a[164:167], v[68:71], v[172:175]
v_exp_f32 v145, v145
v_mfma_f32_16x16x32_bf16 v[172:175], a[160:163], v[64:67], v[172:175]
v_exp_f32 v146, v146
v_mfma_f32_16x16x32_bf16 v[188:191], a[176:179], v[64:67], v[92:95]
v_exp_f32 v147, v147
v_mfma_f32_16x16x32_bf16 v[188:191], a[180:183], v[68:71], v[188:191]
v_exp_f32 v132, v132
v_mfma_f32_16x16x32_bf16 v[188:191], a[184:187], v[72:75], v[188:191]
v_cvt_pk_bf16_f32 v194, v144, v145
v_cvt_pk_bf16_f32 v195, v146, v147
v_mfma_f32_16x16x32_bf16 v[188:191], a[188:191], v[76:79], v[188:191]
v_exp_f32 v133, v133
v_mfma_f32_16x16x32_bf16 v[184:187], a[188:191], v[60:63], v[88:91]
v_exp_f32 v134, v134
v_mfma_f32_16x16x32_bf16 v[184:187], a[184:187], v[56:59], v[184:187]
v_exp_f32 v135, v135
v_mfma_f32_16x16x32_bf16 v[184:187], a[180:183], v[52:55], v[184:187]
v_exp_f32 v148, v148
v_mfma_f32_16x16x32_bf16 v[184:187], a[176:179], v[48:51], v[184:187]
v_cvt_pk_bf16_f32 v196, v132, v133
v_cvt_pk_bf16_f32 v197, v134, v135
v_mfma_f32_16x16x32_bf16 v[180:183], a[176:179], v[32:35], v[84:87]
buffer_load_dwordx4 v1, s[44:47], s72 offen offset:1024 sc1 lds
v_mfma_f32_16x16x32_bf16 v[180:183], a[180:183], v[36:39], v[180:183]
v_exp_f32 v149, v149
v_mfma_f32_16x16x32_bf16 v[180:183], a[184:187], v[40:43], v[180:183]
v_exp_f32 v150, v150
v_mfma_f32_16x16x32_bf16 v[180:183], a[188:191], v[44:47], v[180:183]
v_exp_f32 v151, v151
v_mfma_f32_16x16x32_bf16 v[176:179], a[188:191], v[28:31], v[176:179]
buffer_load_dwordx4 v1, s[44:47], s72 offen offset:2048 sc1 lds
v_mfma_f32_16x16x32_bf16 v[176:179], a[184:187], v[24:27], v[176:179]
buffer_load_dwordx4 v1, s[44:47], s72 offen offset:3072 sc1 lds
v_mfma_f32_16x16x32_bf16 v[176:179], a[180:183], v[20:23], v[176:179]
s_waitcnt lgkmcnt(8)
v_exp_f32 v136, v136
v_cvt_pk_bf16_f32 v198, v148, v149
v_cvt_pk_bf16_f32 v199, v150, v151
v_exp_f32 v137, v137
v_exp_f32 v138, v138
v_cvt_pk_bf16_f32 v200, v136, v137
v_exp_f32 v139, v139
v_exp_f32 v152, v152
v_cvt_pk_bf16_f32 v201, v138, v139
v_exp_f32 v153, v153
v_exp_f32 v154, v154
v_cvt_pk_bf16_f32 v202, v152, v153
v_exp_f32 v155, v155
v_exp_f32 v140, v140
v_cvt_pk_bf16_f32 v203, v154, v155
v_exp_f32 v141, v141
v_exp_f32 v142, v142
v_cvt_pk_bf16_f32 v204, v140, v141
v_exp_f32 v143, v143
v_exp_f32 v156, v156
v_cvt_pk_bf16_f32 v205, v142, v143
v_exp_f32 v157, v157
v_exp_f32 v158, v158
v_cvt_pk_bf16_f32 v206, v156, v157
v_exp_f32 v159, v159
s_nop 0
v_cvt_pk_bf16_f32 v207, v158, v159
s_cmp_eq_u32 s58, 0
s_cbranch_scc1 Lta13
s_cmp_eq_u32 s58, 1
s_cbranch_scc1 Lnt14
v_mfma_f32_16x16x32_bf16 v[132:135], a[128:131], v[32:35], v[84:87]
s_add_u32 s82, s82, 0x8000
ds_read_b128 a[160:163], v2 offset:24576
v_mfma_f32_16x16x32_bf16 v[148:151], a[144:147], v[32:35], v[84:87]
s_and_b32 s82, s82, 0x1ffff
v_exp_f32 v160, v160
s_branch Ljoin15
Lta13:
v_mfma_f32_16x16x32_bf16 v[132:135], a[128:131], v[32:35], v[100:103]
s_add_u32 s82, s82, 0x8000
ds_read_b128 a[160:163], v2 offset:24576
v_mfma_f32_16x16x32_bf16 v[148:151], a[144:147], v[32:35], v[112:115]
s_and_b32 s82, s82, 0x1ffff
v_exp_f32 v160, v160
s_branch Ljoin15
Lnt14:
v_mfma_f32_16x16x32_bf16 v[132:135], a[128:131], v[32:35], v[84:87]
s_add_u32 s82, s82, 0x8000
ds_read_b128 a[160:163], v2 offset:24576
v_mfma_f32_16x16x32_bf16 v[148:151], a[144:147], v[32:35], v[100:103]
s_and_b32 s82, s82, 0x1ffff
v_exp_f32 v160, v160
Ljoin15:
v_mfma_f32_16x16x32_bf16 v[132:135], a[132:135], v[36:39], v[132:135]
s_add_u32 m0, s74, 0
v_exp_f32 v161, v161
v_mfma_f32_16x16x32_bf16 v[132:135], a[136:139], v[40:43], v[132:135]
s_add_u32 s72, s81, 0
ds_read_b128 a[164:167], v2 offset:25600
v_cvt_pk_bf16_f32 v208, v160, v161
v_mfma_f32_16x16x32_bf16 v[132:135], a[140:143], v[44:47], v[132:135]
v_exp_f32 v162, v162
v_mfma_f32_16x16x32_bf16 v[136:139], a[140:143], v[60:63], v[88:91]
buffer_load_dwordx4 v1, s[44:47], s72 offen sc1 lds
v_mfma_f32_16x16x32_bf16 v[136:139], a[136:139], v[56:59], v[136:139]
v_exp_f32 v163, v163
v_mfma_f32_16x16x32_bf16 v[136:139], a[132:135], v[52:55], v[136:139]
ds_read_b128 a[168:171], v2 offset:26624
v_cvt_pk_bf16_f32 v209, v162, v163
v_mfma_f32_16x16x32_bf16 v[136:139], a[128:131], v[48:51], v[136:139]
v_exp_f32 v176, v176
v_mfma_f32_16x16x32_bf16 v[140:143], a[128:131], v[64:67], v[92:95]
v_exp_f32 v177, v177
v_mfma_f32_16x16x32_bf16 v[140:143], a[132:135], v[68:71], v[140:143]
ds_read_b128 a[172:175], v2 offset:27648
v_cvt_pk_bf16_f32 v210, v176, v177
v_mfma_f32_16x16x32_bf16 v[140:143], a[136:139], v[72:75], v[140:143]
v_exp_f32 v178, v178
v_mfma_f32_16x16x32_bf16 v[140:143], a[140:143], v[76:79], v[140:143]
buffer_load_dwordx4 v1, s[44:47], s72 offen offset:1024 sc1 lds
v_mfma_f32_16x16x32_bf16 v[156:159], a[156:159], v[76:79], v[92:95]
v_exp_f32 v179, v179
v_mfma_f32_16x16x32_bf16 v[156:159], a[152:155], v[72:75], v[156:159]
ds_read_b128 a[176:179], v2 offset:28672
v_cvt_pk_bf16_f32 v211, v178, v179
v_mfma_f32_16x16x32_bf16 v[156:159], a[148:151], v[68:71], v[156:159]
v_exp_f32 v164, v164
v_mfma_f32_16x16x32_bf16 v[156:159], a[144:147], v[64:67], v[156:159]
v_exp_f32 v165, v165
v_mfma_f32_16x16x32_bf16 v[152:155], a[144:147], v[48:51], v[88:91]
ds_read_b128 a[180:183], v2 offset:29696
v_cvt_pk_bf16_f32 v212, v164, v165
v_mfma_f32_16x16x32_bf16 v[152:155], a[148:151], v[52:55], v[152:155]
v_exp_f32 v166, v166
v_mfma_f32_16x16x32_bf16 v[152:155], a[152:155], v[56:59], v[152:155]
buffer_load_dwordx4 v1, s[44:47], s72 offen offset:2048 sc1 lds
v_mfma_f32_16x16x32_bf16 v[152:155], a[156:159], v[60:63], v[152:155]
v_exp_f32 v167, v167
v_mfma_f32_16x16x32_bf16 v[148:151], a[156:159], v[44:47], v[148:151]
ds_read_b128 a[184:187], v2 offset:30720
v_cvt_pk_bf16_f32 v213, v166, v167
v_mfma_f32_16x16x32_bf16 v[148:151], a[152:155], v[40:43], v[148:151]
v_exp_f32 v180, v180
v_mfma_f32_16x16x32_bf16 v[148:151], a[148:151], v[36:39], v[148:151]
s_waitcnt lgkmcnt(7)
v_exp_f32 v181, v181
v_mfma_f32_16x16x32_bf16 a[0:3], a[192:195], v[192:195], 0
ds_read_b128 a[188:191], v2 offset:31744
v_cvt_pk_bf16_f32 v214, v180, v181
v_mfma_f32_16x16x32_bf16 a[32:35], a[192:195], v[196:199], 0
v_exp_f32 v182, v182
v_mfma_f32_16x16x32_bf16 a[64:67], a[192:195], v[200:203], 0
buffer_load_dwordx4 v1, s[44:47], s72 offen offset:3072 sc1 lds
v_mfma_f32_16x16x32_bf16 a[96:99], a[192:195], v[204:207], 0
s_add_u32 s66, s58, 1
v_exp_f32 v183, v183
v_mfma_f32_16x16x32_bf16 a[100:103], a[196:199], v[204:207], 0
s_and_b32 s66, s66, 3
ds_read_b128 a[224:227], v2 offset:8192
v_cvt_pk_bf16_f32 v215, v182, v183
v_mfma_f32_16x16x32_bf16 a[68:71], a[196:199], v[200:203], 0
s_mul_i32 s66, s66, 4160
v_exp_f32 v168, v168
v_mfma_f32_16x16x32_bf16 a[36:39], a[196:199], v[196:199], 0
s_add_u32 m0, s66, 131104
v_exp_f32 v169, v169
v_mfma_f32_16x16x32_bf16 a[4:7], a[196:199], v[192:195], 0
s_add_u32 s72, s93, 0x2
ds_read_b128 a[228:231], v2 offset:9216
v_cvt_pk_bf16_f32 v216, v168, v169
v_mfma_f32_16x16x32_bf16 a[8:11], a[200:203], v[192:195], 0
v_exp_f32 v170, v170
v_mfma_f32_16x16x32_bf16 a[40:43], a[200:203], v[196:199], 0
buffer_load_dwordx4 v1, s[36:39], s72 offen lds
v_mfma_f32_16x16x32_bf16 a[72:75], a[200:203], v[200:203], 0
v_exp_f32 v171, v171
v_mfma_f32_16x16x32_bf16 a[104:107], a[200:203], v[204:207], 0
ds_read_b128 a[232:235], v2 offset:10240
v_cvt_pk_bf16_f32 v217, v170, v171
v_mfma_f32_16x16x32_bf16 a[108:111], a[204:207], v[204:207], 0
v_exp_f32 v184, v184
v_mfma_f32_16x16x32_bf16 a[76:79], a[204:207], v[200:203], 0
v_exp_f32 v185, v185
v_mfma_f32_16x16x32_bf16 a[44:47], a[204:207], v[196:199], 0
ds_read_b128 a[236:239], v2 offset:11264
v_cvt_pk_bf16_f32 v218, v184, v185
v_mfma_f32_16x16x32_bf16 a[12:15], a[204:207], v[192:195], 0
v_exp_f32 v186, v186
v_mfma_f32_16x16x32_bf16 a[16:19], a[208:211], v[192:195], 0
buffer_load_dwordx4 v1, s[36:39], s72 offen offset:1024 lds
v_mfma_f32_16x16x32_bf16 a[48:51], a[208:211], v[196:199], 0
v_exp_f32 v187, v187
v_mfma_f32_16x16x32_bf16 a[80:83], a[208:211], v[200:203], 0
ds_read_b128 a[240:243], v2 offset:12288
v_cvt_pk_bf16_f32 v219, v186, v187
v_mfma_f32_16x16x32_bf16 a[112:115], a[208:211], v[204:207], 0
v_exp_f32 v172, v172
v_mfma_f32_16x16x32_bf16 a[116:119], a[212:215], v[204:207], 0
v_exp_f32 v173, v173
v_mfma_f32_16x16x32_bf16 a[84:87], a[212:215], v[200:203], 0
ds_read_b128 a[244:247], v2 offset:13312
v_cvt_pk_bf16_f32 v220, v172, v173
v_mfma_f32_16x16x32_bf16 a[52:55], a[212:215], v[196:199], 0
buffer_load_dwordx4 v1, s[36:39], s72 offen offset:2048 lds
v_mfma_f32_16x16x32_bf16 a[20:23], a[212:215], v[192:195], 0
v_exp_f32 v174, v174
v_mfma_f32_16x16x32_bf16 a[24:27], a[216:219], v[192:195], 0
v_exp_f32 v175, v175
v_mfma_f32_16x16x32_bf16 a[56:59], a[216:219], v[196:199], 0
ds_read_b128 a[248:251], v2 offset:14336
v_cvt_pk_bf16_f32 v221, v174, v175
v_mfma_f32_16x16x32_bf16 a[88:91], a[216:219], v[200:203], 0
v_exp_f32 v188, v188
v_mfma_f32_16x16x32_bf16 a[120:123], a[216:219], v[204:207], 0
v_exp_f32 v189, v189
v_mfma_f32_16x16x32_bf16 a[124:127], a[220:223], v[204:207], 0
ds_read_b128 a[252:255], v2 offset:15360
v_cvt_pk_bf16_f32 v222, v188, v189
v_mfma_f32_16x16x32_bf16 a[92:95], a[220:223], v[200:203], 0
buffer_load_dwordx4 v1, s[36:39], s72 offen offset:3072 lds
v_mfma_f32_16x16x32_bf16 a[60:63], a[220:223], v[196:199], 0
v_exp_f32 v190, v190
v_mfma_f32_16x16x32_bf16 a[28:31], a[220:223], v[192:195], 0
v_exp_f32 v191, v191
v_mfma_f32_16x16x32_bf16 v[224:227], v[120:123], v[192:195], 0
v_cvt_pk_bf16_f32 v223, v190, v191
v_add_u32 v2, s82, v1
v_mfma_f32_16x16x32_bf16 v[228:231], v[120:123], v[196:199], 0
v_and_b32 v240, 15, v0
v_lshrrev_b32 v241, 4, v0
v_mfma_f32_16x16x32_bf16 v[232:235], v[120:123], v[200:203], 0
s_waitcnt vmcnt(12) lgkmcnt(8)
v_mfma_f32_16x16x32_bf16 v[236:239], v[120:123], v[204:207], 0
s_barrier
v_add_u32 v248, 1, v240
v_and_b32 v249, 3, v248
v_lshrrev_b32 v248, 2, v248
v_mov_b32 v250, 0x20000
v_mov_b32 v252, 0x20001
v_lshlrev_b32 v6, 3, v249
v_lshrrev_b32 v6, v6, v252
v_and_b32 v6, 3, v6
v_cmp_ne_u32 vcc, 1, v249
v_mul_u32_u24 v6, 16640, v6
v_add_u32 v6, s92, v6
v_cndmask_b32 v6, v250, v6, vcc
v_add_u32 v253, s58, v249
v_and_b32 v253, 3, v253
v_mul_u32_u24 v253, 4160, v253
v_add_u32 v6, v6, v253
s_branch LLT3
.p2align 12
s_endpgm
.p2align 7
LLT3x:
Lstub11:
s_cbranch_execz Lret
s_cmp_eq_u32 s58, 2
s_cbranch_scc1 Lta40
s_cmp_eq_u32 s58, 3
s_cbranch_scc1 Lnt41
v_mfma_f32_16x16x32_bf16 v[164:167], a[160:163], v[32:35], v[112:115]
s_xor_b32 s74, s82, 0x10000
ds_read_b128 a[128:131], v2 offset:16384
v_mfma_f32_16x16x32_bf16 v[180:183], a[176:179], v[32:35], v[112:115]
s_add_u32 s74, s74, s64
v_exp_f32 v132, v132
s_branch Ljoin42
Lta40:
v_mfma_f32_16x16x32_bf16 v[164:167], a[160:163], v[32:35], v[100:103]
s_xor_b32 s74, s82, 0x10000
ds_read_b128 a[128:131], v2 offset:16384
v_mfma_f32_16x16x32_bf16 v[180:183], a[176:179], v[32:35], v[112:115]
s_add_u32 s74, s74, s64
v_exp_f32 v132, v132
s_branch Ljoin42
Lnt41:
v_mfma_f32_16x16x32_bf16 v[164:167], a[160:163], v[32:35], v[84:87]
s_xor_b32 s74, s82, 0x10000
ds_read_b128 a[128:131], v2 offset:16384
v_mfma_f32_16x16x32_bf16 v[180:183], a[176:179], v[32:35], v[100:103]
s_add_u32 s74, s74, s64
v_exp_f32 v132, v132
Ljoin42:
v_mfma_f32_16x16x32_bf16 v[164:167], a[164:167], v[36:39], v[164:167]
s_add_u32 s81, s81, 0x8000
v_exp_f32 v133, v133
v_mfma_f32_16x16x32_bf16 v[164:167], a[168:171], v[40:43], v[164:167]
s_add_u32 m0, s74, 0
ds_read_b128 a[132:135], v2 offset:17408
v_cvt_pk_bf16_f32 v196, v132, v133
v_mfma_f32_16x16x32_bf16 v[164:167], a[172:175], v[44:47], v[164:167]
s_add_u32 s72, s81, 0
buffer_load_dwordx4 v1, s[44:47], s72 offen sc1 lds
v_mfma_f32_16x16x32_bf16 v[168:171], a[172:175], v[60:63], v[88:91]
s_add_u32 s69, s93, 0x3e00000
v_exp_f32 v134, v134
v_mfma_f32_16x16x32_bf16 v[168:171], a[168:171], v[56:59], v[168:171]
ds_read_b128 a[136:139], v2 offset:18432
v_bfe_u32 v251, v0, 2, 2
v_mfma_f32_16x16x32_bf16 v[168:171], a[164:167], v[52:55], v[168:171]
v_exp_f32 v135, v135
v_mfma_f32_16x16x32_bf16 v[168:171], a[160:163], v[48:51], v[168:171]
buffer_store_dwordx4 v[112:115], v1, s[44:47], s69 offen sc1
v_mfma_f32_16x16x32_bf16 v[172:175], a[160:163], v[64:67], v[92:95]
v_exp_f32 v148, v148
v_mfma_f32_16x16x32_bf16 v[172:175], a[164:167], v[68:71], v[172:175]
ds_read_b128 a[140:143], v2 offset:19456
v_cvt_pk_bf16_f32 v197, v134, v135
v_mfma_f32_16x16x32_bf16 v[172:175], a[168:171], v[72:75], v[172:175]
v_exp_f32 v149, v149
v_mfma_f32_16x16x32_bf16 v[172:175], a[172:175], v[76:79], v[172:175]
buffer_load_dwordx4 v1, s[44:47], s72 offen offset:1024 sc1 lds
v_mfma_f32_16x16x32_bf16 v[188:191], a[188:191], v[76:79], v[92:95]
ds_read_b128 a[144:147], v2 offset:20480
v_cvt_pk_bf16_f32 v198, v148, v149
v_mfma_f32_16x16x32_bf16 v[188:191], a[184:187], v[72:75], v[188:191]
v_exp_f32 v150, v150
v_mfma_f32_16x16x32_bf16 v[188:191], a[180:183], v[68:71], v[188:191]
v_exp_f32 v151, v151
v_mfma_f32_16x16x32_bf16 v[188:191], a[176:179], v[64:67], v[188:191]
buffer_store_dwordx4 v[112:115], v1, s[44:47], s69 offen offset:1024 sc1
v_mfma_f32_16x16x32_bf16 v[184:187], a[176:179], v[48:51], v[88:91]
ds_read_b128 a[148:151], v2 offset:21504
v_cvt_pk_bf16_f32 v199, v150, v151
v_mfma_f32_16x16x32_bf16 v[184:187], a[180:183], v[52:55], v[184:187]
v_exp_f32 v136, v136
v_mfma_f32_16x16x32_bf16 v[184:187], a[184:187], v[56:59], v[184:187]
ds_read_b128 a[152:155], v2 offset:22528
v_lshl_add_u32 v6, v248, 3, v6
v_mfma_f32_16x16x32_bf16 v[184:187], a[188:191], v[60:63], v[184:187]
v_exp_f32 v137, v137
v_mfma_f32_16x16x32_bf16 v[180:183], a[188:191], v[44:47], v[180:183]
buffer_load_dwordx4 v1, s[44:47], s72 offen offset:2048 sc1 lds
v_mfma_f32_16x16x32_bf16 v[180:183], a[184:187], v[40:43], v[180:183]
v_exp_f32 v138, v138
v_mfma_f32_16x16x32_bf16 v[180:183], a[180:183], v[36:39], v[180:183]
s_waitcnt lgkmcnt(7)
ds_read_b128 a[156:159], v2 offset:23552
v_cvt_pk_bf16_f32 v200, v136, v137
v_mfma_f32_16x16x32_bf16 a[0:3], a[224:227], v[208:211], a[0:3]
v_exp_f32 v139, v139
v_mfma_f32_16x16x32_bf16 a[32:35], a[224:227], v[212:215], a[32:35]
buffer_store_dwordx4 v[112:115], v1, s[44:47], s69 offen offset:2048 sc1
v_mfma_f32_16x16x32_bf16 a[64:67], a[224:227], v[216:219], a[64:67]
ds_read_b128 a[192:195], v2 offset:0
v_cvt_pk_bf16_f32 v201, v138, v139
v_mfma_f32_16x16x32_bf16 a[96:99], a[224:227], v[220:223], a[96:99]
v_exp_f32 v152, v152
v_mfma_f32_16x16x32_bf16 a[100:103], a[228:231], v[220:223], a[100:103]
buffer_load_dwordx4 v1, s[44:47], s72 offen offset:3072 sc1 lds
v_mfma_f32_16x16x32_bf16 a[68:71], a[228:231], v[216:219], a[68:71]
v_exp_f32 v153, v153
v_mfma_f32_16x16x32_bf16 a[36:39], a[228:231], v[212:215], a[36:39]
ds_read_b128 a[196:199], v2 offset:1024
v_cvt_pk_bf16_f32 v202, v152, v153
v_mfma_f32_16x16x32_bf16 a[4:7], a[228:231], v[208:211], a[4:7]
v_exp_f32 v154, v154
v_mfma_f32_16x16x32_bf16 a[8:11], a[232:235], v[208:211], a[8:11]
ds_read_b128 a[200:203], v2 offset:2048
v_lshl_add_u32 v6, v241, 4, v6
v_mfma_f32_16x16x32_bf16 a[40:43], a[232:235], v[212:215], a[40:43]
buffer_store_dwordx4 v[112:115], v1, s[44:47], s69 offen offset:3072 sc1
v_mfma_f32_16x16x32_bf16 a[72:75], a[232:235], v[216:219], a[72:75]
s_add_u32 s69, s93, 0x4200000
v_exp_f32 v155, v155
v_mfma_f32_16x16x32_bf16 a[104:107], a[232:235], v[220:223], a[104:107]
v_exp_f32 v140, v140
v_mfma_f32_16x16x32_bf16 a[108:111], a[236:239], v[220:223], a[108:111]
ds_read_b128 a[204:207], v2 offset:3072
v_cvt_pk_bf16_f32 v203, v154, v155
v_mfma_f32_16x16x32_bf16 a[76:79], a[236:239], v[216:219], a[76:79]
buffer_store_dwordx4 v[112:115], v1, s[44:47], s69 offen sc1
v_mfma_f32_16x16x32_bf16 a[44:47], a[236:239], v[212:215], a[44:47]
v_exp_f32 v141, v141
v_mfma_f32_16x16x32_bf16 a[12:15], a[236:239], v[208:211], a[12:15]
ds_read_b128 a[208:211], v2 offset:4096
v_cvt_pk_bf16_f32 v204, v140, v141
v_mfma_f32_16x16x32_bf16 a[16:19], a[240:243], v[208:211], a[16:19]
v_exp_f32 v142, v142
v_mfma_f32_16x16x32_bf16 a[48:51], a[240:243], v[212:215], a[48:51]
buffer_store_dwordx4 v[112:115], v1, s[44:47], s69 offen offset:1024 sc1
v_mfma_f32_16x16x32_bf16 a[80:83], a[240:243], v[216:219], a[80:83]
v_exp_f32 v143, v143
v_mfma_f32_16x16x32_bf16 a[112:115], a[240:243], v[220:223], a[112:115]
ds_read_b128 a[212:215], v2 offset:5120
v_cvt_pk_bf16_f32 v205, v142, v143
v_mfma_f32_16x16x32_bf16 a[116:119], a[244:247], v[220:223], a[116:119]
v_exp_f32 v156, v156
v_mfma_f32_16x16x32_bf16 a[84:87], a[244:247], v[216:219], a[84:87]
ds_read_b128 a[216:219], v2 offset:6144
v_lshlrev_b32 v5, 3, v251
v_mfma_f32_16x16x32_bf16 a[52:55], a[244:247], v[212:215], a[52:55]
buffer_store_dwordx4 v[112:115], v1, s[44:47], s69 offen offset:2048 sc1
v_mfma_f32_16x16x32_bf16 a[20:23], a[244:247], v[208:211], a[20:23]
v_exp_f32 v157, v157
v_mfma_f32_16x16x32_bf16 a[24:27], a[248:251], v[208:211], a[24:27]
v_exp_f32 v158, v158
v_mfma_f32_16x16x32_bf16 a[56:59], a[248:251], v[212:215], a[56:59]
ds_read_b128 a[220:223], v2 offset:7168
v_cvt_pk_bf16_f32 v206, v156, v157
v_mfma_f32_16x16x32_bf16 a[88:91], a[248:251], v[216:219], a[88:91]
buffer_store_dwordx4 v[112:115], v1, s[44:47], s69 offen offset:3072 sc1
v_mfma_f32_16x16x32_bf16 a[120:123], a[248:251], v[220:223], a[120:123]
v_exp_f32 v159, v159
v_mfma_f32_16x16x32_bf16 a[124:127], a[252:255], v[220:223], a[124:127]
v_cvt_pk_bf16_f32 v207, v158, v159
v_lshrrev_b32 v5, v5, v252
v_mfma_f32_16x16x32_bf16 a[92:95], a[252:255], v[216:219], a[92:95]
v_and_b32 v5, 3, v5
v_cmp_ne_u32 vcc, 1, v251
v_mfma_f32_16x16x32_bf16 a[60:63], a[252:255], v[212:215], a[60:63]
v_mul_u32_u24 v5, 16640, v5
v_add_u32 v5, s92, v5
v_mfma_f32_16x16x32_bf16 a[28:31], a[252:255], v[208:211], a[28:31]
v_cndmask_b32 v5, v250, v5, vcc
v_add_u32 v253, s58, v251
v_mfma_f32_16x16x32_bf16 v[224:227], v[120:123], v[208:211], v[224:227]
v_and_b32 v253, 3, v253
v_mul_u32_u24 v253, 4160, v253
v_mfma_f32_16x16x32_bf16 v[228:231], v[120:123], v[212:215], v[228:231]
v_add_u32 v5, v5, v253
v_mfma_f32_16x16x32_bf16 v[232:235], v[120:123], v[216:219], v[232:235]
s_waitcnt lgkmcnt(8)
v_mfma_f32_16x16x32_bf16 v[236:239], v[120:123], v[220:223], v[236:239]
s_barrier
s_lshr_b32 s69, s93, 4
s_and_b32 s69, s69, 0x7f00
s_add_u32 s69, s69, LHT4-Lpc0
v_lshrrev_b32 v3, 5, v0
v_lshlrev_b32 v3, 7, v3
v_add_u32 v3, s69, v3
v_min_u32 v3, Lcode_end-Lpc0, v3
global_load_dword v4, v3, s[98:99]
s_cmp_eq_u32 s58, 0
s_cbranch_scc1 Lta43
s_cmp_eq_u32 s58, 1
s_cbranch_scc1 Lnt44
v_mfma_f32_16x16x32_bf16 v[136:139], a[128:131], v[48:51], v[88:91]
s_add_u32 s82, s82, 0x8000
ds_read_b128 a[160:163], v2 offset:24576
ds_read_b128 a[164:167], v2 offset:25600
v_mfma_f32_16x16x32_bf16 v[152:155], a[144:147], v[48:51], v[88:91]
s_and_b32 s82, s82, 0x1ffff
v_exp_f32 v164, v164
s_branch Ljoin45
Lta43:
v_mfma_f32_16x16x32_bf16 v[136:139], a[128:131], v[48:51], v[104:107]
s_add_u32 s82, s82, 0x8000
ds_read_b128 a[160:163], v2 offset:24576
ds_read_b128 a[164:167], v2 offset:25600
v_mfma_f32_16x16x32_bf16 v[152:155], a[144:147], v[48:51], v[112:115]
s_and_b32 s82, s82, 0x1ffff
v_exp_f32 v164, v164
s_branch Ljoin45
Lnt44:
v_mfma_f32_16x16x32_bf16 v[136:139], a[128:131], v[48:51], v[88:91]
s_add_u32 s82, s82, 0x8000
ds_read_b128 a[160:163], v2 offset:24576
ds_read_b128 a[164:167], v2 offset:25600
v_mfma_f32_16x16x32_bf16 v[152:155], a[144:147], v[48:51], v[104:107]
s_and_b32 s82, s82, 0x1ffff
v_exp_f32 v164, v164
Ljoin45:
v_mfma_f32_16x16x32_bf16 v[136:139], a[132:135], v[52:55], v[136:139]
s_add_u32 s66, s58, 3
v_exp_f32 v165, v165
v_mfma_f32_16x16x32_bf16 v[136:139], a[136:139], v[56:59], v[136:139]
s_and_b32 s66, s66, 3
v_exp_f32 v166, v166
v_mfma_f32_16x16x32_bf16 v[136:139], a[140:143], v[60:63], v[136:139]
s_mul_i32 s66, s66, 4160
ds_read_b128 a[168:171], v2 offset:26624
v_cvt_pk_bf16_f32 v212, v164, v165
v_mfma_f32_16x16x32_bf16 v[140:143], a[140:143], v[76:79], v[92:95]
s_add_u32 s66, s66, s92
v_exp_f32 v167, v167
v_mfma_f32_16x16x32_bf16 v[140:143], a[136:139], v[72:75], v[140:143]
s_add_u32 m0, s66, 32
v_exp_f32 v180, v180
v_mfma_f32_16x16x32_bf16 v[140:143], a[132:135], v[68:71], v[140:143]
s_add_u32 s72, s93, 0x6
buffer_load_dwordx4 v1, s[36:39], s72 offen lds
v_mfma_f32_16x16x32_bf16 v[140:143], a[128:131], v[64:67], v[140:143]
ds_read_b128 a[172:175], v2 offset:27648
v_cvt_pk_bf16_f32 v213, v166, v167
v_mfma_f32_16x16x32_bf16 v[156:159], a[144:147], v[64:67], v[92:95]
v_exp_f32 v181, v181
v_mfma_f32_16x16x32_bf16 v[156:159], a[148:151], v[68:71], v[156:159]
ds_read_b128 a[176:179], v2 offset:28672
v_cvt_pk_bf16_f32 v214, v180, v181
v_mfma_f32_16x16x32_bf16 v[156:159], a[152:155], v[72:75], v[156:159]
v_exp_f32 v182, v182
v_mfma_f32_16x16x32_bf16 v[156:159], a[156:159], v[76:79], v[156:159]
v_exp_f32 v183, v183
v_mfma_f32_16x16x32_bf16 v[152:155], a[156:159], v[60:63], v[152:155]
ds_read_b128 a[180:183], v2 offset:29696
v_cvt_pk_bf16_f32 v215, v182, v183
v_mfma_f32_16x16x32_bf16 v[152:155], a[152:155], v[56:59], v[152:155]
v_exp_f32 v168, v168
v_mfma_f32_16x16x32_bf16 v[152:155], a[148:151], v[52:55], v[152:155]
s_waitcnt lgkmcnt(6)
ds_read_b128 a[184:187], v2 offset:30720
ds_read_b128 a[188:191], v2 offset:31744
v_mfma_f32_16x16x32_bf16 a[32:35], a[192:195], v[196:199], a[32:35]
v_exp_f32 v169, v169
v_mfma_f32_16x16x32_bf16 a[64:67], a[192:195], v[200:203], a[64:67]
buffer_load_dwordx4 v1, s[36:39], s72 offen offset:1024 lds
v_mfma_f32_16x16x32_bf16 a[96:99], a[192:195], v[204:207], a[96:99]
v_exp_f32 v170, v170
v_mfma_f32_16x16x32_bf16 a[100:103], a[196:199], v[204:207], a[100:103]
v_exp_f32 v171, v171
v_mfma_f32_16x16x32_bf16 a[68:71], a[196:199], v[200:203], a[68:71]
ds_read_b128 a[224:227], v2 offset:8192
v_cvt_pk_bf16_f32 v216, v168, v169
v_mfma_f32_16x16x32_bf16 a[36:39], a[196:199], v[196:199], a[36:39]
v_exp_f32 v184, v184
v_mfma_f32_16x16x32_bf16 a[40:43], a[200:203], v[196:199], a[40:43]
v_exp_f32 v185, v185
v_mfma_f32_16x16x32_bf16 a[72:75], a[200:203], v[200:203], a[72:75]
ds_read_b128 a[228:231], v2 offset:9216
v_cvt_pk_bf16_f32 v217, v170, v171
v_mfma_f32_16x16x32_bf16 a[104:107], a[200:203], v[204:207], a[104:107]
v_exp_f32 v186, v186
v_mfma_f32_16x16x32_bf16 a[108:111], a[204:207], v[204:207], a[108:111]
ds_read_b128 a[232:235], v2 offset:10240
v_cvt_pk_bf16_f32 v218, v184, v185
v_mfma_f32_16x16x32_bf16 a[76:79], a[204:207], v[200:203], a[76:79]
v_exp_f32 v187, v187
v_mfma_f32_16x16x32_bf16 a[44:47], a[204:207], v[196:199], a[44:47]
buffer_load_dwordx4 v1, s[36:39], s72 offen offset:2048 lds
v_mfma_f32_16x16x32_bf16 a[48:51], a[208:211], v[196:199], a[48:51]
v_exp_f32 v172, v172
v_mfma_f32_16x16x32_bf16 a[80:83], a[208:211], v[200:203], a[80:83]
ds_read_b128 a[236:239], v2 offset:11264
v_cvt_pk_bf16_f32 v219, v186, v187
v_mfma_f32_16x16x32_bf16 a[112:115], a[208:211], v[204:207], a[112:115]
v_exp_f32 v173, v173
v_mfma_f32_16x16x32_bf16 a[116:119], a[212:215], v[204:207], a[116:119]
ds_read_b128 a[240:243], v2 offset:12288
v_cvt_pk_bf16_f32 v220, v172, v173
v_mfma_f32_16x16x32_bf16 a[84:87], a[212:215], v[200:203], a[84:87]
v_exp_f32 v174, v174
v_mfma_f32_16x16x32_bf16 a[52:55], a[212:215], v[196:199], a[52:55]
v_exp_f32 v175, v175
v_mfma_f32_16x16x32_bf16 a[56:59], a[216:219], v[196:199], a[56:59]
ds_read_b128 a[244:247], v2 offset:13312
v_cvt_pk_bf16_f32 v221, v174, v175
v_mfma_f32_16x16x32_bf16 a[88:91], a[216:219], v[200:203], a[88:91]
v_exp_f32 v188, v188
v_mfma_f32_16x16x32_bf16 a[120:123], a[216:219], v[204:207], a[120:123]
ds_read_b128 a[248:251], v2 offset:14336
v_mfma_f32_16x16x32_bf16 a[124:127], a[220:223], v[204:207], a[124:127]
v_exp_f32 v189, v189
v_mfma_f32_16x16x32_bf16 a[92:95], a[220:223], v[200:203], a[92:95]
buffer_load_dwordx4 v1, s[36:39], s72 offen offset:3072 lds
v_mfma_f32_16x16x32_bf16 a[60:63], a[220:223], v[196:199], a[60:63]
ds_read_b128 a[252:255], v2 offset:15360
v_cvt_pk_bf16_f32 v222, v188, v189
v_mfma_f32_16x16x32_bf16 v[228:231], v[120:123], v[196:199], v[228:231]
v_exp_f32 v190, v190
v_mfma_f32_16x16x32_bf16 v[232:235], v[120:123], v[200:203], v[232:235]
s_waitcnt vmcnt(17) lgkmcnt(0)
v_exp_f32 v191, v191
v_mfma_f32_16x16x32_bf16 v[236:239], v[120:123], v[204:207], v[236:239]
s_barrier
v_cvt_pk_bf16_f32 v223, v190, v191
v_add_u32 v2, s82, v1
s_cmp_eq_u32 s58, 2
s_cbranch_scc1 Lta46
s_cmp_eq_u32 s58, 3
s_cbranch_scc1 Lnt47
v_mfma_f32_16x16x32_bf16 v[168:171], a[160:163], v[48:51], v[112:115]
s_mov_b32 m0, s62
v_exp_f32 v136, v136
v_mfma_f32_16x16x32_bf16 v[184:187], a[176:179], v[48:51], v[112:115]
s_add_u32 s72, s93, 0x3000000
ds_read_b128 a[128:131], v2 offset:16384
s_branch Ljoin48
Lta46:
v_mfma_f32_16x16x32_bf16 v[168:171], a[160:163], v[48:51], v[104:107]
s_mov_b32 m0, s62
v_exp_f32 v136, v136
v_mfma_f32_16x16x32_bf16 v[184:187], a[176:179], v[48:51], v[112:115]
s_add_u32 s72, s93, 0x3000000
ds_read_b128 a[128:131], v2 offset:16384
s_branch Ljoin48
Lnt47:
v_mfma_f32_16x16x32_bf16 v[168:171], a[160:163], v[48:51], v[88:91]
s_mov_b32 m0, s62
v_exp_f32 v136, v136
v_mfma_f32_16x16x32_bf16 v[184:187], a[176:179], v[48:51], v[104:107]
s_add_u32 s72, s93, 0x3000000
ds_read_b128 a[128:131], v2 offset:16384
Ljoin48:
v_mfma_f32_16x16x32_bf16 v[168:171], a[164:167], v[52:55], v[168:171]
buffer_load_dwordx4 v1, s[44:47], s72 offen sc1 lds
v_mfma_f32_16x16x32_bf16 v[168:171], a[168:171], v[56:59], v[168:171]
v_exp_f32 v137, v137
v_mfma_f32_16x16x32_bf16 v[168:171], a[172:175], v[60:63], v[168:171]
s_add_u32 s73, s62, 480
ds_read_b128 a[132:135], v2 offset:17408
v_cvt_pk_bf16_f32 v200, v136, v137
v_mfma_f32_16x16x32_bf16 v[172:175], a[172:175], v[76:79], v[92:95]
v_exp_f32 v138, v138
v_mfma_f32_16x16x32_bf16 v[172:175], a[168:171], v[72:75], v[172:175]
ds_read_b128 a[136:139], v2 offset:18432
v_lshlrev_b32 v248, 5, v240
v_mfma_f32_16x16x32_bf16 v[172:175], a[164:167], v[68:71], v[172:175]
buffer_load_dwordx4 v1, s[44:47], s72 offen offset:1024 sc1 lds
v_mfma_f32_16x16x32_bf16 v[172:175], a[160:163], v[64:67], v[172:175]
v_exp_f32 v139, v139
v_mfma_f32_16x16x32_bf16 v[188:191], a[176:179], v[64:67], v[92:95]
ds_read_b128 a[140:143], v2 offset:19456
v_cvt_pk_bf16_f32 v201, v138, v139
v_mfma_f32_16x16x32_bf16 v[188:191], a[180:183], v[68:71], v[188:191]
v_exp_f32 v152, v152
v_mfma_f32_16x16x32_bf16 v[188:191], a[184:187], v[72:75], v[188:191]
ds_read_b128 a[144:147], v2 offset:20480
v_sub_u32 v248, s73, v248
v_mfma_f32_16x16x32_bf16 v[188:191], a[188:191], v[76:79], v[188:191]
buffer_load_dwordx4 v1, s[44:47], s72 offen offset:2048 sc1 lds
v_mfma_f32_16x16x32_bf16 v[184:187], a[188:191], v[60:63], v[184:187]
v_exp_f32 v153, v153
v_mfma_f32_16x16x32_bf16 v[184:187], a[184:187], v[56:59], v[184:187]
ds_read_b128 a[148:151], v2 offset:21504
v_cvt_pk_bf16_f32 v202, v152, v153
v_mfma_f32_16x16x32_bf16 v[184:187], a[180:183], v[52:55], v[184:187]
s_waitcnt lgkmcnt(6)
buffer_load_dwordx4 v1, s[44:47], s72 offen offset:3072 sc1 lds
v_mfma_f32_16x16x32_bf16 a[32:35], a[224:227], v[212:215], a[32:35]
s_add_u32 s66, s58, 0
v_exp_f32 v154, v154
v_mfma_f32_16x16x32_bf16 a[64:67], a[224:227], v[216:219], a[64:67]
s_and_b32 s66, s66, 3
ds_read_b128 a[152:155], v2 offset:22528
v_lshl_add_u32 v7, v241, 4, v248
v_mfma_f32_16x16x32_bf16 a[96:99], a[224:227], v[220:223], a[96:99]
s_mul_i32 s66, s66, 4160
v_exp_f32 v155, v155
v_mfma_f32_16x16x32_bf16 a[100:103], a[228:231], v[220:223], a[100:103]
s_add_u32 s66, s66, s92
ds_read_b128 a[156:159], v2 offset:23552
v_cvt_pk_bf16_f32 v203, v154, v155
v_mfma_f32_16x16x32_bf16 a[68:71], a[228:231], v[216:219], a[68:71]
s_add_u32 m0, s66, 16672
v_exp_f32 v140, v140
v_mfma_f32_16x16x32_bf16 a[36:39], a[228:231], v[212:215], a[36:39]
s_add_u32 s72, s93, 0x0
buffer_load_dwordx4 v1, s[36:39], s72 offen lds
v_mfma_f32_16x16x32_bf16 a[40:43], a[232:235], v[212:215], a[40:43]
s_and_b32 s73, s58, 1
ds_read_b128 a[192:195], v2 offset:0
v_mfma_f32_16x16x32_bf16 a[72:75], a[232:235], v[216:219], a[72:75]
s_lshl_b32 s73, s73, 4
buffer_load_dwordx4 v1, s[36:39], s72 offen offset:1024 lds
v_mfma_f32_16x16x32_bf16 a[104:107], a[232:235], v[220:223], a[104:107]
s_lshr_b32 s73, s90, s73
v_exp_f32 v141, v141
v_mfma_f32_16x16x32_bf16 a[108:111], a[236:239], v[220:223], a[108:111]
s_and_b32 s73, s73, 0xffff
ds_read_b128 a[196:199], v2 offset:1024
v_cvt_pk_bf16_f32 v204, v140, v141
v_mfma_f32_16x16x32_bf16 a[76:79], a[236:239], v[216:219], a[76:79]
v_exp_f32 v142, v142
v_mfma_f32_16x16x32_bf16 a[44:47], a[236:239], v[212:215], a[44:47]
ds_read_b128 a[200:203], v2 offset:2048
v_lshl_add_u32 v248, v241, 3, v240
v_mfma_f32_16x16x32_bf16 a[48:51], a[240:243], v[212:215], a[48:51]
buffer_load_dwordx4 v1, s[36:39], s72 offen offset:2048 lds
v_mfma_f32_16x16x32_bf16 a[80:83], a[240:243], v[216:219], a[80:83]
v_exp_f32 v143, v143
v_mfma_f32_16x16x32_bf16 a[112:115], a[240:243], v[220:223], a[112:115]
ds_read_b128 a[204:207], v2 offset:3072
v_cvt_pk_bf16_f32 v205, v142, v143
v_mfma_f32_16x16x32_bf16 a[116:119], a[244:247], v[220:223], a[116:119]
v_exp_f32 v156, v156
v_mfma_f32_16x16x32_bf16 a[84:87], a[244:247], v[216:219], a[84:87]
ds_read_b128 a[208:211], v2 offset:4096
v_sub_u32 v248, 15, v248
v_mfma_f32_16x16x32_bf16 a[52:55], a[244:247], v[212:215], a[52:55]
buffer_load_dwordx4 v1, s[36:39], s72 offen offset:3072 lds
v_mfma_f32_16x16x32_bf16 a[56:59], a[248:251], v[212:215], a[56:59]
s_add_u32 s66, s58, 2
v_exp_f32 v157, v157
v_mfma_f32_16x16x32_bf16 a[88:91], a[248:251], v[216:219], a[88:91]
s_and_b32 s66, s66, 3
ds_read_b128 a[212:215], v2 offset:5120
v_cvt_pk_bf16_f32 v206, v156, v157
v_mfma_f32_16x16x32_bf16 a[120:123], a[248:251], v[220:223], a[120:123]
s_mul_i32 s66, s66, 4160
v_exp_f32 v158, v158
v_mfma_f32_16x16x32_bf16 a[124:127], a[252:255], v[220:223], a[124:127]
s_add_u32 s66, s66, s92
ds_read_b128 a[216:219], v2 offset:6144
v_and_b32 v249, 1, v248
v_mfma_f32_16x16x32_bf16 a[92:95], a[252:255], v[216:219], a[92:95]
s_add_u32 m0, s66, 33312
v_exp_f32 v159, v159
v_mfma_f32_16x16x32_bf16 a[60:63], a[252:255], v[212:215], a[60:63]
s_add_u32 s72, s93, 0x4
buffer_load_dwordx4 v1, s[36:39], s72 offen lds
v_mfma_f32_16x16x32_bf16 v[228:231], v[120:123], v[212:215], v[228:231]
ds_read_b128 a[220:223], v2 offset:7168
v_cvt_pk_bf16_f32 v207, v158, v159
v_mfma_f32_16x16x32_bf16 v[232:235], v[120:123], v[216:219], v[232:235]
buffer_load_dwordx4 v1, s[36:39], s72 offen offset:1024 lds
v_mfma_f32_16x16x32_bf16 v[236:239], v[120:123], v[220:223], v[236:239]
s_waitcnt lgkmcnt(8)
v_lshlrev_b32 v249, 4, v249
v_lshlrev_b32 v249, v249, s73
v_lshrrev_b32 v248, 1, v248
v_and_b32 v241, 3, v0
v_cmp_eq_u32 vcc, 0, v248
v_lshl_add_u32 v5, v241, 3, v5
s_nop 0
v_cndmask_b32 v8, 0, v249, vcc
v_cmp_eq_u32 vcc, 1, v248
v_lshlrev_b32 v240, 4, v251
s_nop 0
v_cndmask_b32 v9, 0, v249, vcc
v_cmp_eq_u32 vcc, 2, v248
v_sub_u32 v240, 48, v240
v_lshlrev_b64 v[12:13], 16, s[88:89]
v_cndmask_b32 v10, 0, v249, vcc
v_cmp_eq_u32 vcc, 3, v248
v_lshlrev_b64 v[12:13], v240, v[12:13]
s_nop 0
v_cndmask_b32 v11, 0, v249, vcc
v_cmp_eq_u32 vcc, 3, v241
s_add_u32 s73, s62, 4096
v_lshl_add_u32 v14, v0, 3, s73
v_cndmask_b32 v12, 0, v12, vcc
v_cndmask_b32 v13, 0, v13, vcc
v_lshrrev_b32 v15, 4, v0
v_lshlrev_b32 v15, 1, v15
v_and_b32 v240, 7, v0
v_xor_b32 v15, v15, v240
v_lshlrev_b32 v15, 4, v15
v_lshrrev_b32 v240, 3, v0
v_lshl_add_u32 v15, v240, 11, v15
s_lshr_b32 s75, s59, 1
s_and_b32 s75, s75, 8
s_add_u32 s75, s75, s60
s_lshl_b32 s76, s65, 2
s_lshr_b32 s80, s59, 2
s_and_b32 s80, s80, 3
s_add_u32 s76, s76, s80
s_lshl_b32 s94, s58, 16
s_lshl_b32 s80, s76, 7
s_add_u32 s94, s94, s80
s_lshl_b32 s80, s75, 18
s_add_u32 s80, s80, s94
v_rcp_f32 v224, v224
v_rcp_f32 v228, v228
s_lshl_b32 s73, s59, 12
s_add_u32 s73, s73, 0x2000000
s_lshl_b32 s70, s67, 2
s_add_u32 s70, s70, s73
v_mov_b32 v225, v224
v_accvgpr_read_b32 v240, a0
v_accvgpr_read_b32 v241, a1
v_accvgpr_read_b32 v242, a2
v_accvgpr_read_b32 v243, a3
v_accvgpr_read_b32 v244, a4
v_accvgpr_read_b32 v245, a5
v_accvgpr_read_b32 v246, a6
v_accvgpr_read_b32 v247, a7
v_pk_mul_f32 v[240:241], v[240:241], v[224:225]
v_pk_mul_f32 v[242:243], v[242:243], v[224:225]
v_pk_mul_f32 v[244:245], v[244:245], v[224:225]
v_pk_mul_f32 v[246:247], v[246:247], v[224:225]
buffer_load_dwordx4 v1, s[36:39], s72 offen offset:2048 lds
v_cvt_pk_bf16_f32 v128, v240, v241
v_cvt_pk_bf16_f32 v129, v242, v243
v_cvt_pk_bf16_f32 v130, v244, v245
v_cvt_pk_bf16_f32 v131, v246, v247
v_accvgpr_read_b32 v248, a8
v_accvgpr_read_b32 v249, a9
v_accvgpr_read_b32 v250, a10
v_accvgpr_read_b32 v251, a11
v_accvgpr_read_b32 v252, a12
v_accvgpr_read_b32 v253, a13
v_accvgpr_read_b32 v254, a14
v_accvgpr_read_b32 v255, a15
v_pk_mul_f32 v[248:249], v[248:249], v[224:225]
v_pk_mul_f32 v[250:251], v[250:251], v[224:225]
v_pk_mul_f32 v[252:253], v[252:253], v[224:225]
v_pk_mul_f32 v[254:255], v[254:255], v[224:225]
v_cvt_pk_bf16_f32 v144, v248, v249
v_cvt_pk_bf16_f32 v145, v250, v251
buffer_load_dwordx4 v1, s[36:39], s72 offen offset:3072 lds
v_cvt_pk_bf16_f32 v146, v252, v253
v_cvt_pk_bf16_f32 v147, v254, v255
v_accvgpr_read_b32 v240, a16
v_accvgpr_read_b32 v241, a17
v_accvgpr_read_b32 v242, a18
v_accvgpr_read_b32 v243, a19
v_accvgpr_read_b32 v244, a20
v_accvgpr_read_b32 v245, a21
v_accvgpr_read_b32 v246, a22
v_accvgpr_read_b32 v247, a23
v_pk_mul_f32 v[240:241], v[240:241], v[224:225]
v_pk_mul_f32 v[242:243], v[242:243], v[224:225]
v_pk_mul_f32 v[244:245], v[244:245], v[224:225]
v_pk_mul_f32 v[246:247], v[246:247], v[224:225]
v_cvt_pk_bf16_f32 v160, v240, v241
v_cvt_pk_bf16_f32 v161, v242, v243
v_cvt_pk_bf16_f32 v162, v244, v245
v_cvt_pk_bf16_f32 v163, v246, v247
buffer_load_dwordx4 v[80:83], v15, s[4:7], s80 offen
v_accvgpr_read_b32 v248, a24
v_accvgpr_read_b32 v249, a25
v_accvgpr_read_b32 v250, a26
v_accvgpr_read_b32 v251, a27
v_accvgpr_read_b32 v252, a28
v_accvgpr_read_b32 v253, a29
v_accvgpr_read_b32 v254, a30
v_accvgpr_read_b32 v255, a31
v_pk_mul_f32 v[248:249], v[248:249], v[224:225]
v_pk_mul_f32 v[250:251], v[250:251], v[224:225]
v_pk_mul_f32 v[252:253], v[252:253], v[224:225]
v_pk_mul_f32 v[254:255], v[254:255], v[224:225]
v_cvt_pk_bf16_f32 v176, v248, v249
v_cvt_pk_bf16_f32 v177, v250, v251
v_cvt_pk_bf16_f32 v178, v252, v253
v_cvt_pk_bf16_f32 v179, v254, v255
v_mov_b32 v229, v228
v_accvgpr_read_b32 v240, a32
s_add_u32 s80, s80, 0x4000
buffer_load_dwordx4 v[84:87], v15, s[4:7], s80 offen
v_accvgpr_read_b32 v241, a33
v_accvgpr_read_b32 v242, a34
v_accvgpr_read_b32 v243, a35
v_accvgpr_read_b32 v244, a36
v_accvgpr_read_b32 v245, a37
v_accvgpr_read_b32 v246, a38
v_accvgpr_read_b32 v247, a39
v_pk_mul_f32 v[240:241], v[240:241], v[228:229]
v_pk_mul_f32 v[242:243], v[242:243], v[228:229]
v_pk_mul_f32 v[244:245], v[244:245], v[228:229]
v_pk_mul_f32 v[246:247], v[246:247], v[228:229]
v_cvt_pk_bf16_f32 v132, v240, v241
v_cvt_pk_bf16_f32 v133, v242, v243
v_cvt_pk_bf16_f32 v134, v244, v245
v_cvt_pk_bf16_f32 v135, v246, v247
v_accvgpr_read_b32 v248, a40
v_accvgpr_read_b32 v249, a41
v_accvgpr_read_b32 v250, a42
s_add_u32 s80, s80, 0x4000
buffer_load_dwordx4 v[96:99], v15, s[4:7], s80 offen
v_accvgpr_read_b32 v251, a43
v_accvgpr_read_b32 v252, a44
v_accvgpr_read_b32 v253, a45
v_accvgpr_read_b32 v254, a46
v_accvgpr_read_b32 v255, a47
v_pk_mul_f32 v[248:249], v[248:249], v[228:229]
v_pk_mul_f32 v[250:251], v[250:251], v[228:229]
v_pk_mul_f32 v[252:253], v[252:253], v[228:229]
v_pk_mul_f32 v[254:255], v[254:255], v[228:229]
v_cvt_pk_bf16_f32 v148, v248, v249
v_cvt_pk_bf16_f32 v149, v250, v251
v_cvt_pk_bf16_f32 v150, v252, v253
v_cvt_pk_bf16_f32 v151, v254, v255
v_accvgpr_read_b32 v240, a48
v_accvgpr_read_b32 v241, a49
v_accvgpr_read_b32 v242, a50
v_accvgpr_read_b32 v243, a51
v_accvgpr_read_b32 v244, a52
s_add_u32 s80, s80, 0x4000
buffer_load_dwordx4 v[100:103], v15, s[4:7], s80 offen
v_accvgpr_read_b32 v245, a53
v_accvgpr_read_b32 v246, a54
v_accvgpr_read_b32 v247, a55
v_pk_mul_f32 v[240:241], v[240:241], v[228:229]
v_pk_mul_f32 v[242:243], v[242:243], v[228:229]
v_pk_mul_f32 v[244:245], v[244:245], v[228:229]
v_pk_mul_f32 v[246:247], v[246:247], v[228:229]
v_cvt_pk_bf16_f32 v164, v240, v241
v_cvt_pk_bf16_f32 v165, v242, v243
v_cvt_pk_bf16_f32 v166, v244, v245
v_cvt_pk_bf16_f32 v167, v246, v247
v_accvgpr_read_b32 v248, a56
v_accvgpr_read_b32 v249, a57
v_accvgpr_read_b32 v250, a58
v_accvgpr_read_b32 v251, a59
v_accvgpr_read_b32 v252, a60
v_accvgpr_read_b32 v253, a61
v_accvgpr_read_b32 v254, a62
v_accvgpr_read_b32 v255, a63
v_pk_mul_f32 v[248:249], v[248:249], v[228:229]
v_pk_mul_f32 v[250:251], v[250:251], v[228:229]
v_pk_mul_f32 v[252:253], v[252:253], v[228:229]
v_pk_mul_f32 v[254:255], v[254:255], v[228:229]
v_cvt_pk_bf16_f32 v180, v248, v249
v_cvt_pk_bf16_f32 v181, v250, v251
v_cvt_pk_bf16_f32 v182, v252, v253
v_cvt_pk_bf16_f32 v183, v254, v255
s_cmp_eq_u32 s58, 0
s_cbranch_scc1 Lta49
s_cmp_eq_u32 s58, 1
s_cbranch_scc1 Lnt50
v_mfma_f32_16x16x32_bf16 v[140:143], a[128:131], v[64:67], v[92:95]
s_add_u32 s82, s82, 0x8000
ds_read_b128 a[160:163], v2 offset:24576
ds_read_b128 a[164:167], v2 offset:25600
v_mfma_f32_16x16x32_bf16 v[156:159], a[144:147], v[64:67], v[92:95]
s_and_b32 s82, s82, 0x1ffff
v_exp_f32 v168, v168
s_branch Ljoin51
Lta49:
v_mfma_f32_16x16x32_bf16 v[140:143], a[128:131], v[64:67], v[108:111]
s_add_u32 s82, s82, 0x8000
ds_read_b128 a[160:163], v2 offset:24576
ds_read_b128 a[164:167], v2 offset:25600
v_mfma_f32_16x16x32_bf16 v[156:159], a[144:147], v[64:67], v[112:115]
s_and_b32 s82, s82, 0x1ffff
v_exp_f32 v168, v168
s_branch Ljoin51
Lnt50:
v_mfma_f32_16x16x32_bf16 v[140:143], a[128:131], v[64:67], v[92:95]
s_add_u32 s82, s82, 0x8000
ds_read_b128 a[160:163], v2 offset:24576
ds_read_b128 a[164:167], v2 offset:25600
v_mfma_f32_16x16x32_bf16 v[156:159], a[144:147], v[64:67], v[108:111]
s_and_b32 s82, s82, 0x1ffff
v_exp_f32 v168, v168
Ljoin51:
v_mfma_f32_16x16x32_bf16 v[140:143], a[132:135], v[68:71], v[140:143]
v_exp_f32 v169, v169
v_mfma_f32_16x16x32_bf16 v[140:143], a[136:139], v[72:75], v[140:143]
ds_read_b128 a[168:171], v2 offset:26624
ds_read_b128 a[172:175], v2 offset:27648
v_mfma_f32_16x16x32_bf16 v[140:143], a[140:143], v[76:79], v[140:143]
v_exp_f32 v170, v170
v_mfma_f32_16x16x32_bf16 v[156:159], a[156:159], v[76:79], v[156:159]
v_exp_f32 v171, v171
v_mfma_f32_16x16x32_bf16 v[156:159], a[152:155], v[72:75], v[156:159]
buffer_store_dwordx4 v[128:131], v1, s[44:47], s70 offen sc1
v_mfma_f32_16x16x32_bf16 v[156:159], a[148:151], v[68:71], v[156:159]
s_waitcnt lgkmcnt(4)
ds_read_b128 a[176:179], v2 offset:28672
ds_read_b128 a[180:183], v2 offset:29696
v_mfma_f32_16x16x32_bf16 a[64:67], a[192:195], v[200:203], a[64:67]
v_exp_f32 v184, v184
v_mfma_f32_16x16x32_bf16 a[96:99], a[192:195], v[204:207], a[96:99]
ds_read_b128 a[184:187], v2 offset:30720
ds_read_b128 a[188:191], v2 offset:31744
v_mfma_f32_16x16x32_bf16 a[100:103], a[196:199], v[204:207], a[100:103]
ds_read_b128 a[224:227], v2 offset:8192
ds_read_b128 a[228:231], v2 offset:9216
v_mfma_f32_16x16x32_bf16 a[68:71], a[196:199], v[200:203], a[68:71]
ds_read_b128 a[232:235], v2 offset:10240
ds_read_b128 a[236:239], v2 offset:11264
v_mfma_f32_16x16x32_bf16 a[72:75], a[200:203], v[200:203], a[72:75]
ds_read_b128 a[240:243], v2 offset:12288
ds_read_b128 a[244:247], v2 offset:13312
v_mfma_f32_16x16x32_bf16 a[104:107], a[200:203], v[204:207], a[104:107]
ds_read_b128 a[248:251], v2 offset:14336
ds_read_b128 a[252:255], v2 offset:15360
v_mfma_f32_16x16x32_bf16 a[108:111], a[204:207], v[204:207], a[108:111]
v_cvt_pk_bf16_f32 v216, v168, v169
v_cvt_pk_bf16_f32 v217, v170, v171
v_mfma_f32_16x16x32_bf16 a[76:79], a[204:207], v[200:203], a[76:79]
v_exp_f32 v185, v185
v_mfma_f32_16x16x32_bf16 a[80:83], a[208:211], v[200:203], a[80:83]
v_exp_f32 v186, v186
v_mfma_f32_16x16x32_bf16 a[112:115], a[208:211], v[204:207], a[112:115]
v_exp_f32 v187, v187
v_mfma_f32_16x16x32_bf16 a[116:119], a[212:215], v[204:207], a[116:119]
v_exp_f32 v172, v172
v_mfma_f32_16x16x32_bf16 a[84:87], a[212:215], v[200:203], a[84:87]
buffer_store_dwordx4 v[144:147], v1, s[44:47], s70 offen offset:1024 sc1
v_mfma_f32_16x16x32_bf16 a[88:91], a[216:219], v[200:203], a[88:91]
v_cvt_pk_bf16_f32 v218, v184, v185
v_cvt_pk_bf16_f32 v219, v186, v187
v_mfma_f32_16x16x32_bf16 a[120:123], a[216:219], v[204:207], a[120:123]
v_exp_f32 v173, v173
v_mfma_f32_16x16x32_bf16 a[124:127], a[220:223], v[204:207], a[124:127]
v_exp_f32 v174, v174
v_mfma_f32_16x16x32_bf16 a[92:95], a[220:223], v[200:203], a[92:95]
buffer_store_dwordx4 v[160:163], v1, s[44:47], s70 offen offset:2048 sc1
v_mfma_f32_16x16x32_bf16 v[232:235], v[120:123], v[200:203], v[232:235]
s_waitcnt vmcnt(24) lgkmcnt(8)
v_exp_f32 v175, v175
v_mfma_f32_16x16x32_bf16 v[236:239], v[120:123], v[204:207], v[236:239]
s_barrier
v_exp_f32 v188, v188
v_add_u32 v2, s82, v1
v_cvt_pk_bf16_f32 v220, v172, v173
v_cvt_pk_bf16_f32 v221, v174, v175
v_exp_f32 v189, v189
v_exp_f32 v190, v190
v_cvt_pk_bf16_f32 v222, v188, v189
v_exp_f32 v191, v191
s_nop 0
v_cvt_pk_bf16_f32 v223, v190, v191
s_cmp_eq_u32 s58, 2
s_cbranch_scc1 Lta52
s_cmp_eq_u32 s58, 3
s_cbranch_scc1 Lnt53
v_mfma_f32_16x16x32_bf16 v[172:175], a[160:163], v[64:67], v[112:115]
v_exp_f32 v140, v140
v_mfma_f32_16x16x32_bf16 v[188:191], a[176:179], v[64:67], v[112:115]
ds_read_b128 a[192:195], v2 offset:0
s_branch Ljoin54
Lta52:
v_mfma_f32_16x16x32_bf16 v[172:175], a[160:163], v[64:67], v[108:111]
v_exp_f32 v140, v140
v_mfma_f32_16x16x32_bf16 v[188:191], a[176:179], v[64:67], v[112:115]
ds_read_b128 a[192:195], v2 offset:0
s_branch Ljoin54
Lnt53:
v_mfma_f32_16x16x32_bf16 v[172:175], a[160:163], v[64:67], v[92:95]
v_exp_f32 v140, v140
v_mfma_f32_16x16x32_bf16 v[188:191], a[176:179], v[64:67], v[108:111]
ds_read_b128 a[192:195], v2 offset:0
Ljoin54:
v_mfma_f32_16x16x32_bf16 v[172:175], a[164:167], v[68:71], v[172:175]
v_exp_f32 v141, v141
v_mfma_f32_16x16x32_bf16 v[172:175], a[168:171], v[72:75], v[172:175]
ds_read_b128 a[196:199], v2 offset:1024
v_cvt_pk_bf16_f32 v204, v140, v141
v_mfma_f32_16x16x32_bf16 v[172:175], a[172:175], v[76:79], v[172:175]
s_add_u32 s78, s59, 4
buffer_store_dwordx4 v[176:179], v1, s[44:47], s70 offen offset:3072 sc1
v_mfma_f32_16x16x32_bf16 v[188:191], a[188:191], v[76:79], v[188:191]
s_add_u32 s70, s70, 0x80000
v_exp_f32 v142, v142
v_mfma_f32_16x16x32_bf16 v[188:191], a[184:187], v[72:75], v[188:191]
s_and_b32 s78, s78, 12
ds_read_b128 a[200:203], v2 offset:2048
v_mfma_f32_16x16x32_bf16 v[188:191], a[180:183], v[68:71], v[188:191]
s_waitcnt lgkmcnt(3)
v_exp_f32 v143, v143
v_mfma_f32_16x16x32_bf16 a[64:67], a[224:227], v[216:219], a[64:67]
s_and_b32 s12, s59, 16
ds_read_b128 a[204:207], v2 offset:3072
v_cvt_pk_bf16_f32 v205, v142, v143
v_mfma_f32_16x16x32_bf16 a[96:99], a[224:227], v[220:223], a[96:99]
s_or_b32 s78, s78, s12
v_exp_f32 v156, v156
v_mfma_f32_16x16x32_bf16 a[100:103], a[228:231], v[220:223], a[100:103]
s_add_u32 s12, s61, 0
ds_read_b128 a[208:211], v2 offset:4096
v_mfma_f32_16x16x32_bf16 a[68:71], a[228:231], v[216:219], a[68:71]
s_and_b32 s12, s12, 3
buffer_store_dwordx4 v[132:135], v1, s[44:47], s70 offen sc1
v_mfma_f32_16x16x32_bf16 a[72:75], a[232:235], v[216:219], a[72:75]
s_add_u32 s12, s12, s78
v_exp_f32 v157, v157
v_mfma_f32_16x16x32_bf16 a[104:107], a[232:235], v[220:223], a[104:107]
s_lshl_b32 s12, s12, 18
ds_read_b128 a[212:215], v2 offset:5120
v_cvt_pk_bf16_f32 v206, v156, v157
v_mfma_f32_16x16x32_bf16 a[108:111], a[236:239], v[220:223], a[108:111]
s_add_u32 s12, s12, s94
v_exp_f32 v158, v158
v_mfma_f32_16x16x32_bf16 a[76:79], a[236:239], v[216:219], a[76:79]
s_add_u32 s13, s61, 1
ds_read_b128 a[216:219], v2 offset:6144
v_mfma_f32_16x16x32_bf16 a[80:83], a[240:243], v[216:219], a[80:83]
s_and_b32 s13, s13, 3
buffer_store_dwordx4 v[148:151], v1, s[44:47], s70 offen offset:1024 sc1
v_mfma_f32_16x16x32_bf16 a[112:115], a[240:243], v[220:223], a[112:115]
s_add_u32 s13, s13, s78
v_exp_f32 v159, v159
v_mfma_f32_16x16x32_bf16 a[116:119], a[244:247], v[220:223], a[116:119]
s_lshl_b32 s13, s13, 18
ds_read_b128 a[220:223], v2 offset:7168
v_cvt_pk_bf16_f32 v207, v158, v159
v_mfma_f32_16x16x32_bf16 a[84:87], a[244:247], v[216:219], a[84:87]
s_add_u32 s13, s13, s94
v_mfma_f32_16x16x32_bf16 a[88:91], a[248:251], v[216:219], a[88:91]
s_add_u32 s14, s61, 2
v_mfma_f32_16x16x32_bf16 a[120:123], a[248:251], v[220:223], a[120:123]
s_and_b32 s14, s14, 3
v_mfma_f32_16x16x32_bf16 a[124:127], a[252:255], v[220:223], a[124:127]
s_add_u32 s14, s14, s78
v_mfma_f32_16x16x32_bf16 a[92:95], a[252:255], v[216:219], a[92:95]
s_lshl_b32 s14, s14, 18
v_mfma_f32_16x16x32_bf16 v[232:235], v[120:123], v[216:219], v[232:235]
s_add_u32 s14, s14, s94
v_mfma_f32_16x16x32_bf16 v[236:239], v[120:123], v[220:223], v[236:239]
s_waitcnt lgkmcnt(0)
s_add_u32 s15, s61, 3
s_and_b32 s15, s15, 3
s_add_u32 s15, s15, s78
s_lshl_b32 s15, s15, 18
s_add_u32 s15, s15, s94
v_mfma_f32_16x16x32_bf16 a[96:99], a[192:195], v[204:207], a[96:99]
s_add_u32 s82, s82, 0x8000
ds_read_b128 a[224:227], v2 offset:8192
ds_read_b128 a[228:231], v2 offset:9216
v_mfma_f32_16x16x32_bf16 a[100:103], a[196:199], v[204:207], a[100:103]
s_and_b32 s82, s82, 0x1ffff
v_exp_f32 v172, v172
v_mfma_f32_16x16x32_bf16 a[104:107], a[200:203], v[204:207], a[104:107]
ds_read_b128 a[232:235], v2 offset:10240
ds_read_b128 a[236:239], v2 offset:11264
v_mfma_f32_16x16x32_bf16 a[108:111], a[204:207], v[204:207], a[108:111]
buffer_store_dwordx4 v[164:167], v1, s[44:47], s70 offen offset:2048 sc1
v_mfma_f32_16x16x32_bf16 a[112:115], a[208:211], v[204:207], a[112:115]
ds_read_b128 a[240:243], v2 offset:12288
ds_read_b128 a[244:247], v2 offset:13312
v_mfma_f32_16x16x32_bf16 a[116:119], a[212:215], v[204:207], a[116:119]
ds_read_b128 a[248:251], v2 offset:14336
ds_read_b128 a[252:255], v2 offset:15360
v_mfma_f32_16x16x32_bf16 a[120:123], a[216:219], v[204:207], a[120:123]
buffer_store_dwordx4 v[180:183], v1, s[44:47], s70 offen offset:3072 sc1
v_mfma_f32_16x16x32_bf16 a[124:127], a[220:223], v[204:207], a[124:127]
s_waitcnt vmcnt(8) lgkmcnt(0)
v_exp_f32 v173, v173
v_mfma_f32_16x16x32_bf16 v[236:239], v[120:123], v[204:207], v[236:239]
s_barrier
v_exp_f32 v174, v174
v_add_u32 v2, s82, v1
v_cvt_pk_bf16_f32 v220, v172, v173
v_exp_f32 v175, v175
v_exp_f32 v188, v188
v_cvt_pk_bf16_f32 v221, v174, v175
v_exp_f32 v189, v189
v_exp_f32 v190, v190
v_cvt_pk_bf16_f32 v222, v188, v189
v_exp_f32 v191, v191
s_nop 0
v_cvt_pk_bf16_f32 v223, v190, v191
s_branch LHT4
Lslow:
s_waitcnt vmcnt(0) lgkmcnt(0)
s_barrier
s_mov_b32 s86, 1
s_lshl_b32 s81, s59, 20
s_add_u32 s81, s81, s64
s_sub_u32 s81, s81, 0x4000
s_mov_b32 s83, 0
s_lshl_b32 s75, s60, 3
s_sub_u32 s76, 128, s75
s_add_u32 s74, s75, s58
s_sub_u32 s75, s76, 8
s_add_u32 s75, s75, s58
v_mov_b32 v2, v1
v_lshrrev_b32 v240, 4, v0
v_and_b32 v241, 15, v0
v_lshlrev_b32 v240, 2, v240
v_sub_u32 v240, v241, v240
v_mov_b32 v112, 0xff800000
v_mov_b32 v113, 0xff800000
v_mov_b32 v114, 0xff800000
v_mov_b32 v115, 0xff800000
v_cmp_gt_i32 vcc, 0, v240
v_mov_b32 v120, 0x3f803f80
s_nop 0
v_cndmask_b32 v116, 0, v112, vcc
v_cmp_gt_i32 vcc, 1, v240
v_mov_b32 v121, 0x3f803f80
s_nop 0
v_cndmask_b32 v117, 0, v112, vcc
v_cmp_gt_i32 vcc, 2, v240
v_mov_b32 v122, 0x3f803f80
s_nop 0
v_cndmask_b32 v118, 0, v112, vcc
v_cmp_gt_i32 vcc, 3, v240
v_mov_b32 v123, 0x3f803f80
s_nop 0
v_cndmask_b32 v119, 0, v112, vcc
Lslow1:
s_add_u32 m0, s64, 16384
s_add_u32 s72, s81, 16384
buffer_load_dwordx4 v1, s[44:47], s72 offen sc1 lds
buffer_load_dwordx4 v1, s[44:47], s72 offen offset:1024 sc1 lds
buffer_load_dwordx4 v1, s[44:47], s72 offen offset:2048 sc1 lds
buffer_load_dwordx4 v1, s[44:47], s72 offen offset:3072 sc1 lds
s_add_u32 s81, s81, 0x8000
s_waitcnt vmcnt(0)
s_barrier
ds_read_b128 a[128:131], v2 offset:16384
ds_read_b128 a[132:135], v2 offset:17408
ds_read_b128 a[136:139], v2 offset:18432
ds_read_b128 a[140:143], v2 offset:19456
ds_read_b128 a[144:147], v2 offset:20480
ds_read_b128 a[148:151], v2 offset:21504
ds_read_b128 a[152:155], v2 offset:22528
ds_read_b128 a[156:159], v2 offset:23552
s_waitcnt lgkmcnt(0)
s_add_u32 s73, s74, 0
s_cmp_lt_u32 s73, s83
s_cbranch_scc1 Lsa55
s_cmp_eq_u32 s73, s83
s_cbranch_scc1 Lst56
v_mfma_f32_16x16x32_bf16 v[128:131], a[128:131], v[16:19], 0
s_branch Lsj57
Lst56:
v_mfma_f32_16x16x32_bf16 v[128:131], a[128:131], v[16:19], v[116:119]
Lsj57:
v_mfma_f32_16x16x32_bf16 v[128:131], a[132:135], v[20:23], v[128:131]
v_mfma_f32_16x16x32_bf16 v[128:131], a[136:139], v[24:27], v[128:131]
v_mfma_f32_16x16x32_bf16 v[128:131], a[140:143], v[28:31], v[128:131]
s_nop 7
v_max3_f32 v124, v124, v128, v129
v_max3_f32 v124, v124, v130, v131
Lsa55:
s_add_u32 s73, s74, 4
s_cmp_lt_u32 s73, s83
s_cbranch_scc1 Lsa58
s_cmp_eq_u32 s73, s83
s_cbranch_scc1 Lst59
v_mfma_f32_16x16x32_bf16 v[132:135], a[128:131], v[32:35], 0
s_branch Lsj60
Lst59:
v_mfma_f32_16x16x32_bf16 v[132:135], a[128:131], v[32:35], v[116:119]
Lsj60:
v_mfma_f32_16x16x32_bf16 v[132:135], a[132:135], v[36:39], v[132:135]
v_mfma_f32_16x16x32_bf16 v[132:135], a[136:139], v[40:43], v[132:135]
v_mfma_f32_16x16x32_bf16 v[132:135], a[140:143], v[44:47], v[132:135]
s_nop 7
v_max3_f32 v125, v125, v132, v133
v_max3_f32 v125, v125, v134, v135
Lsa58:
s_add_u32 s73, s75, 0
s_cmp_lt_u32 s73, s83
s_cbranch_scc1 Lsa61
s_cmp_eq_u32 s73, s83
s_cbranch_scc1 Lst62
v_mfma_f32_16x16x32_bf16 v[136:139], a[128:131], v[48:51], 0
s_branch Lsj63
Lst62:
v_mfma_f32_16x16x32_bf16 v[136:139], a[128:131], v[48:51], v[116:119]
Lsj63:
v_mfma_f32_16x16x32_bf16 v[136:139], a[132:135], v[52:55], v[136:139]
v_mfma_f32_16x16x32_bf16 v[136:139], a[136:139], v[56:59], v[136:139]
v_mfma_f32_16x16x32_bf16 v[136:139], a[140:143], v[60:63], v[136:139]
s_nop 7
v_max3_f32 v126, v126, v136, v137
v_max3_f32 v126, v126, v138, v139
Lsa61:
s_add_u32 s73, s75, 4
s_cmp_lt_u32 s73, s83
s_cbranch_scc1 Lsa64
s_cmp_eq_u32 s73, s83
s_cbranch_scc1 Lst65
v_mfma_f32_16x16x32_bf16 v[140:143], a[128:131], v[64:67], 0
s_branch Lsj66
Lst65:
v_mfma_f32_16x16x32_bf16 v[140:143], a[128:131], v[64:67], v[116:119]
Lsj66:
v_mfma_f32_16x16x32_bf16 v[140:143], a[132:135], v[68:71], v[140:143]
v_mfma_f32_16x16x32_bf16 v[140:143], a[136:139], v[72:75], v[140:143]
v_mfma_f32_16x16x32_bf16 v[140:143], a[140:143], v[76:79], v[140:143]
s_nop 7
v_max3_f32 v127, v127, v140, v141
v_max3_f32 v127, v127, v142, v143
Lsa64:
s_add_u32 s83, s83, 1
s_add_u32 s73, s74, 0
s_cmp_lt_u32 s73, s83
s_cbranch_scc1 Lsa67
s_cmp_eq_u32 s73, s83
s_cbranch_scc1 Lst68
v_mfma_f32_16x16x32_bf16 v[144:147], a[144:147], v[16:19], 0
s_branch Lsj69
Lst68:
v_mfma_f32_16x16x32_bf16 v[144:147], a[144:147], v[16:19], v[116:119]
Lsj69:
v_mfma_f32_16x16x32_bf16 v[144:147], a[148:151], v[20:23], v[144:147]
v_mfma_f32_16x16x32_bf16 v[144:147], a[152:155], v[24:27], v[144:147]
v_mfma_f32_16x16x32_bf16 v[144:147], a[156:159], v[28:31], v[144:147]
s_nop 7
v_max3_f32 v124, v124, v144, v145
v_max3_f32 v124, v124, v146, v147
Lsa67:
s_add_u32 s73, s74, 4
s_cmp_lt_u32 s73, s83
s_cbranch_scc1 Lsa70
s_cmp_eq_u32 s73, s83
s_cbranch_scc1 Lst71
v_mfma_f32_16x16x32_bf16 v[148:151], a[144:147], v[32:35], 0
s_branch Lsj72
Lst71:
v_mfma_f32_16x16x32_bf16 v[148:151], a[144:147], v[32:35], v[116:119]
Lsj72:
v_mfma_f32_16x16x32_bf16 v[148:151], a[148:151], v[36:39], v[148:151]
v_mfma_f32_16x16x32_bf16 v[148:151], a[152:155], v[40:43], v[148:151]
v_mfma_f32_16x16x32_bf16 v[148:151], a[156:159], v[44:47], v[148:151]
s_nop 7
v_max3_f32 v125, v125, v148, v149
v_max3_f32 v125, v125, v150, v151
Lsa70:
s_add_u32 s73, s75, 0
s_cmp_lt_u32 s73, s83
s_cbranch_scc1 Lsa73
s_cmp_eq_u32 s73, s83
s_cbranch_scc1 Lst74
v_mfma_f32_16x16x32_bf16 v[152:155], a[144:147], v[48:51], 0
s_branch Lsj75
Lst74:
v_mfma_f32_16x16x32_bf16 v[152:155], a[144:147], v[48:51], v[116:119]
Lsj75:
v_mfma_f32_16x16x32_bf16 v[152:155], a[148:151], v[52:55], v[152:155]
v_mfma_f32_16x16x32_bf16 v[152:155], a[152:155], v[56:59], v[152:155]
v_mfma_f32_16x16x32_bf16 v[152:155], a[156:159], v[60:63], v[152:155]
s_nop 7
v_max3_f32 v126, v126, v152, v153
v_max3_f32 v126, v126, v154, v155
Lsa73:
s_add_u32 s73, s75, 4
s_cmp_lt_u32 s73, s83
s_cbranch_scc1 Lsa76
s_cmp_eq_u32 s73, s83
s_cbranch_scc1 Lst77
v_mfma_f32_16x16x32_bf16 v[156:159], a[144:147], v[64:67], 0
s_branch Lsj78
Lst77:
v_mfma_f32_16x16x32_bf16 v[156:159], a[144:147], v[64:67], v[116:119]
Lsj78:
v_mfma_f32_16x16x32_bf16 v[156:159], a[148:151], v[68:71], v[156:159]
v_mfma_f32_16x16x32_bf16 v[156:159], a[152:155], v[72:75], v[156:159]
v_mfma_f32_16x16x32_bf16 v[156:159], a[156:159], v[76:79], v[156:159]
s_nop 7
v_max3_f32 v127, v127, v156, v157
v_max3_f32 v127, v127, v158, v159
Lsa76:
s_add_u32 s83, s83, 1
ds_read_b128 a[128:131], v2 offset:24576
ds_read_b128 a[132:135], v2 offset:25600
ds_read_b128 a[136:139], v2 offset:26624
ds_read_b128 a[140:143], v2 offset:27648
ds_read_b128 a[144:147], v2 offset:28672
ds_read_b128 a[148:151], v2 offset:29696
ds_read_b128 a[152:155], v2 offset:30720
ds_read_b128 a[156:159], v2 offset:31744
s_waitcnt lgkmcnt(0)
s_add_u32 s73, s74, 0
s_cmp_lt_u32 s73, s83
s_cbranch_scc1 Lsa79
s_cmp_eq_u32 s73, s83
s_cbranch_scc1 Lst80
v_mfma_f32_16x16x32_bf16 v[128:131], a[128:131], v[16:19], 0
s_branch Lsj81
Lst80:
v_mfma_f32_16x16x32_bf16 v[128:131], a[128:131], v[16:19], v[116:119]
Lsj81:
v_mfma_f32_16x16x32_bf16 v[128:131], a[132:135], v[20:23], v[128:131]
v_mfma_f32_16x16x32_bf16 v[128:131], a[136:139], v[24:27], v[128:131]
v_mfma_f32_16x16x32_bf16 v[128:131], a[140:143], v[28:31], v[128:131]
s_nop 7
v_max3_f32 v124, v124, v128, v129
v_max3_f32 v124, v124, v130, v131
Lsa79:
s_add_u32 s73, s74, 4
s_cmp_lt_u32 s73, s83
s_cbranch_scc1 Lsa82
s_cmp_eq_u32 s73, s83
s_cbranch_scc1 Lst83
v_mfma_f32_16x16x32_bf16 v[132:135], a[128:131], v[32:35], 0
s_branch Lsj84
Lst83:
v_mfma_f32_16x16x32_bf16 v[132:135], a[128:131], v[32:35], v[116:119]
Lsj84:
v_mfma_f32_16x16x32_bf16 v[132:135], a[132:135], v[36:39], v[132:135]
v_mfma_f32_16x16x32_bf16 v[132:135], a[136:139], v[40:43], v[132:135]
v_mfma_f32_16x16x32_bf16 v[132:135], a[140:143], v[44:47], v[132:135]
s_nop 7
v_max3_f32 v125, v125, v132, v133
v_max3_f32 v125, v125, v134, v135
Lsa82:
s_add_u32 s73, s75, 0
s_cmp_lt_u32 s73, s83
s_cbranch_scc1 Lsa85
s_cmp_eq_u32 s73, s83
s_cbranch_scc1 Lst86
v_mfma_f32_16x16x32_bf16 v[136:139], a[128:131], v[48:51], 0
s_branch Lsj87
Lst86:
v_mfma_f32_16x16x32_bf16 v[136:139], a[128:131], v[48:51], v[116:119]
Lsj87:
v_mfma_f32_16x16x32_bf16 v[136:139], a[132:135], v[52:55], v[136:139]
v_mfma_f32_16x16x32_bf16 v[136:139], a[136:139], v[56:59], v[136:139]
v_mfma_f32_16x16x32_bf16 v[136:139], a[140:143], v[60:63], v[136:139]
s_nop 7
v_max3_f32 v126, v126, v136, v137
v_max3_f32 v126, v126, v138, v139
Lsa85:
s_add_u32 s73, s75, 4
s_cmp_lt_u32 s73, s83
s_cbranch_scc1 Lsa88
s_cmp_eq_u32 s73, s83
s_cbranch_scc1 Lst89
v_mfma_f32_16x16x32_bf16 v[140:143], a[128:131], v[64:67], 0
s_branch Lsj90
Lst89:
v_mfma_f32_16x16x32_bf16 v[140:143], a[128:131], v[64:67], v[116:119]
Lsj90:
v_mfma_f32_16x16x32_bf16 v[140:143], a[132:135], v[68:71], v[140:143]
v_mfma_f32_16x16x32_bf16 v[140:143], a[136:139], v[72:75], v[140:143]
v_mfma_f32_16x16x32_bf16 v[140:143], a[140:143], v[76:79], v[140:143]
s_nop 7
v_max3_f32 v127, v127, v140, v141
v_max3_f32 v127, v127, v142, v143
Lsa88:
s_add_u32 s83, s83, 1
s_add_u32 s73, s74, 0
s_cmp_lt_u32 s73, s83
s_cbranch_scc1 Lsa91
s_cmp_eq_u32 s73, s83
s_cbranch_scc1 Lst92
v_mfma_f32_16x16x32_bf16 v[144:147], a[144:147], v[16:19], 0
s_branch Lsj93
Lst92:
v_mfma_f32_16x16x32_bf16 v[144:147], a[144:147], v[16:19], v[116:119]
Lsj93:
v_mfma_f32_16x16x32_bf16 v[144:147], a[148:151], v[20:23], v[144:147]
v_mfma_f32_16x16x32_bf16 v[144:147], a[152:155], v[24:27], v[144:147]
v_mfma_f32_16x16x32_bf16 v[144:147], a[156:159], v[28:31], v[144:147]
s_nop 7
v_max3_f32 v124, v124, v144, v145
v_max3_f32 v124, v124, v146, v147
Lsa91:
s_add_u32 s73, s74, 4
s_cmp_lt_u32 s73, s83
s_cbranch_scc1 Lsa94
s_cmp_eq_u32 s73, s83
s_cbranch_scc1 Lst95
v_mfma_f32_16x16x32_bf16 v[148:151], a[144:147], v[32:35], 0
s_branch Lsj96
Lst95:
v_mfma_f32_16x16x32_bf16 v[148:151], a[144:147], v[32:35], v[116:119]
Lsj96:
v_mfma_f32_16x16x32_bf16 v[148:151], a[148:151], v[36:39], v[148:151]
v_mfma_f32_16x16x32_bf16 v[148:151], a[152:155], v[40:43], v[148:151]
v_mfma_f32_16x16x32_bf16 v[148:151], a[156:159], v[44:47], v[148:151]
s_nop 7
v_max3_f32 v125, v125, v148, v149
v_max3_f32 v125, v125, v150, v151
Lsa94:
s_add_u32 s73, s75, 0
s_cmp_lt_u32 s73, s83
s_cbranch_scc1 Lsa97
s_cmp_eq_u32 s73, s83
s_cbranch_scc1 Lst98
v_mfma_f32_16x16x32_bf16 v[152:155], a[144:147], v[48:51], 0
s_branch Lsj99
Lst98:
v_mfma_f32_16x16x32_bf16 v[152:155], a[144:147], v[48:51], v[116:119]
Lsj99:
v_mfma_f32_16x16x32_bf16 v[152:155], a[148:151], v[52:55], v[152:155]
v_mfma_f32_16x16x32_bf16 v[152:155], a[152:155], v[56:59], v[152:155]
v_mfma_f32_16x16x32_bf16 v[152:155], a[156:159], v[60:63], v[152:155]
s_nop 7
v_max3_f32 v126, v126, v152, v153
v_max3_f32 v126, v126, v154, v155
Lsa97:
s_add_u32 s73, s75, 4
s_cmp_lt_u32 s73, s83
s_cbranch_scc1 Lsa100
s_cmp_eq_u32 s73, s83
s_cbranch_scc1 Lst101
v_mfma_f32_16x16x32_bf16 v[156:159], a[144:147], v[64:67], 0
s_branch Lsj102
Lst101:
v_mfma_f32_16x16x32_bf16 v[156:159], a[144:147], v[64:67], v[116:119]
Lsj102:
v_mfma_f32_16x16x32_bf16 v[156:159], a[148:151], v[68:71], v[156:159]
v_mfma_f32_16x16x32_bf16 v[156:159], a[152:155], v[72:75], v[156:159]
v_mfma_f32_16x16x32_bf16 v[156:159], a[156:159], v[76:79], v[156:159]
s_nop 7
v_max3_f32 v127, v127, v156, v157
v_max3_f32 v127, v127, v158, v159
Lsa100:
s_add_u32 s83, s83, 1
s_barrier
s_cmp_lt_u32 s83, s76
s_cbranch_scc1 Lslow1
s_lshl_b32 s81, s59, 20
s_add_u32 s81, s81, s64
s_sub_u32 s81, s81, 0x4000
s_add_u32 m0, s64, 49152
s_add_u32 s72, s81, 16384
buffer_load_dwordx4 v1, s[44:47], s72 offen sc1 lds
buffer_load_dwordx4 v1, s[44:47], s72 offen offset:1024 sc1 lds
buffer_load_dwordx4 v1, s[44:47], s72 offen offset:2048 sc1 lds
buffer_load_dwordx4 v1, s[44:47], s72 offen offset:3072 sc1 lds
s_add_u32 s81, s81, 0x8000
s_add_u32 m0, s64, 81920
s_add_u32 s72, s81, 16384
buffer_load_dwordx4 v1, s[44:47], s72 offen sc1 lds
buffer_load_dwordx4 v1, s[44:47], s72 offen offset:1024 sc1 lds
buffer_load_dwordx4 v1, s[44:47], s72 offen offset:2048 sc1 lds
buffer_load_dwordx4 v1, s[44:47], s72 offen offset:3072 sc1 lds
s_add_u32 m0, s64, 65536
s_add_u32 s72, s81, 0
buffer_load_dwordx4 v1, s[44:47], s72 offen sc1 lds
buffer_load_dwordx4 v1, s[44:47], s72 offen offset:1024 sc1 lds
buffer_load_dwordx4 v1, s[44:47], s72 offen offset:2048 sc1 lds
buffer_load_dwordx4 v1, s[44:47], s72 offen offset:3072 sc1 lds
s_add_u32 s81, s81, 0x8000
s_add_u32 m0, s64, 114688
s_add_u32 s72, s81, 16384
buffer_load_dwordx4 v1, s[44:47], s72 offen sc1 lds
buffer_load_dwordx4 v1, s[44:47], s72 offen offset:1024 sc1 lds
buffer_load_dwordx4 v1, s[44:47], s72 offen offset:2048 sc1 lds
buffer_load_dwordx4 v1, s[44:47], s72 offen offset:3072 sc1 lds
s_add_u32 m0, s64, 98304
s_add_u32 s72, s81, 0
buffer_load_dwordx4 v1, s[44:47], s72 offen sc1 lds
buffer_load_dwordx4 v1, s[44:47], s72 offen offset:1024 sc1 lds
buffer_load_dwordx4 v1, s[44:47], s72 offen offset:2048 sc1 lds
buffer_load_dwordx4 v1, s[44:47], s72 offen offset:3072 sc1 lds
v_add_u32 v2, 0x8000, v1
v_lshrrev_b32 v3, 1, v0
v_lshlrev_b32 v3, 7, v3
s_waitcnt vmcnt(0)
s_barrier
ds_read_b128 a[128:131], v2 offset:16384
ds_read_b128 a[132:135], v2 offset:17408
ds_read_b128 a[136:139], v2 offset:18432
ds_read_b128 a[140:143], v2 offset:19456
ds_read_b128 a[144:147], v2 offset:20480
ds_read_b128 a[148:151], v2 offset:21504
ds_read_b128 a[152:155], v2 offset:22528
ds_read_b128 a[156:159], v2 offset:23552
s_branch Lattn
Lspin103:
s_mov_b32 s83, 262144
Lsl105:
s_sleep 2
buffer_load_dword v3, v2, s[44:47], s82 offen sc1
s_sub_u32 s83, s83, 1
s_cmp_eq_u32 s83, 0
s_waitcnt vmcnt(0)
s_cbranch_scc1 Lback104
v_cmp_gt_u32 vcc, 2, v3
s_cbranch_vccnz Lsl105
s_branch Lback104
Lspin106:
s_mov_b32 s83, 262144
Lsl108:
s_sleep 2
buffer_load_dword v3, v2, s[44:47], s82 offen sc1
s_sub_u32 s83, s83, 1
s_cmp_eq_u32 s83, 0
s_waitcnt vmcnt(0)
s_cbranch_scc1 Lback107
v_cmp_gt_u32 vcc, 2, v3
s_cbranch_vccnz Lsl108
s_branch Lback107
Lredo0:
s_xor_b32 s82, s78, 0
s_lshl_b32 s82, s82, 10
s_add_u32 s82, s82, s74
buffer_load_dword v3, v2, s[44:47], s82 offen sc1
s_waitcnt vmcnt(0)
v_cmp_gt_u32 vcc, 2, v3
s_cbranch_vccnz Lspin103
Lback104:
s_lshr_b32 s69, s12, 18
s_lshl_b32 s69, s69, 12
s_add_u32 s69, s69, s95
buffer_load_dwordx4 a[0:3], v1, s[44:47], s69 offen sc1
buffer_load_dwordx4 a[4:7], v1, s[44:47], s69 offen offset:1024 sc1
buffer_load_dwordx4 a[8:11], v1, s[44:47], s69 offen offset:2048 sc1
buffer_load_dwordx4 a[12:15], v1, s[44:47], s69 offen offset:3072 sc1
s_add_u32 s69, s69, 0x20000
buffer_load_dwordx4 a[16:19], v1, s[44:47], s69 offen sc1
buffer_load_dwordx4 a[20:23], v1, s[44:47], s69 offen offset:1024 sc1
buffer_load_dwordx4 a[24:27], v1, s[44:47], s69 offen offset:2048 sc1
buffer_load_dwordx4 a[28:31], v1, s[44:47], s69 offen offset:3072 sc1
s_lshr_b32 s69, s13, 18
s_lshl_b32 s69, s69, 12
s_add_u32 s69, s69, s95
buffer_load_dwordx4 a[32:35], v1, s[44:47], s69 offen sc1
buffer_load_dwordx4 a[36:39], v1, s[44:47], s69 offen offset:1024 sc1
buffer_load_dwordx4 a[40:43], v1, s[44:47], s69 offen offset:2048 sc1
buffer_load_dwordx4 a[44:47], v1, s[44:47], s69 offen offset:3072 sc1
s_add_u32 s69, s69, 0x20000
buffer_load_dwordx4 a[48:51], v1, s[44:47], s69 offen sc1
buffer_load_dwordx4 a[52:55], v1, s[44:47], s69 offen offset:1024 sc1
buffer_load_dwordx4 a[56:59], v1, s[44:47], s69 offen offset:2048 sc1
buffer_load_dwordx4 a[60:63], v1, s[44:47], s69 offen offset:3072 sc1
s_waitcnt vmcnt(8)
s_branch Lredo0b
Lspin109:
s_mov_b32 s83, 262144
Lsl111:
s_sleep 2
buffer_load_dword v114, v115, s[44:47], s84 offen sc1
s_sub_u32 s83, s83, 1
s_cmp_eq_u32 s83, 0
s_waitcnt vmcnt(0)
s_cbranch_scc1 Lback110
v_cmp_gt_u32 vcc, 3, v114
s_cbranch_vccnz Lsl111
s_branch Lback110
Lspin112:
s_mov_b32 s83, 262144
Lsl114:
s_sleep 2
buffer_load_dword v14, v13, s[44:47], s79 offen sc1
s_sub_u32 s83, s83, 1
s_cmp_eq_u32 s83, 0
s_waitcnt vmcnt(0)
s_cbranch_scc1 Lback113
v_cmp_gt_u32 vcc, 2, v14
s_cbranch_vccnz Lsl114
s_branch Lback113
Lxspin1:
s_mov_b32 s83, 262144
Lxsl1:
buffer_load_dwordx4 v[96:99], v1, s[44:47], s79 offen sc1
buffer_load_dwordx4 v[100:103], v1, s[44:47], s79 offen offset:1024 sc1
buffer_load_dwordx4 v[104:107], v1, s[44:47], s79 offen offset:2048 sc1
buffer_load_dwordx4 v[108:111], v1, s[44:47], s79 offen offset:3072 sc1
s_sub_u32 s83, s83, 1
s_cmp_eq_u32 s83, 0
s_waitcnt vmcnt(0)
s_cbranch_scc1 Lxback1
v_max3_u32 v12, v96, v97, v98
v_max3_u32 v13, v99, v100, v101
v_max3_u32 v12, v12, v102, v103
v_max3_u32 v13, v13, v104, v105
v_max3_u32 v12, v12, v106, v107
v_max3_u32 v13, v13, v108, v109
v_max3_u32 v12, v12, v110, v111
v_max_u32 v12, v12, v13
v_cmp_le_u32 vcc, 0xff800000, v12
s_cbranch_vccnz Lxsl1
s_branch Lxback1
Lxspin2:
s_mov_b32 s83, 262144
Lxsl2:
buffer_load_dwordx4 v[80:83], v1, s[44:47], s82 offen sc1
buffer_load_dwordx4 v[84:87], v1, s[44:47], s82 offen offset:1024 sc1
buffer_load_dwordx4 v[88:91], v1, s[44:47], s82 offen offset:2048 sc1
buffer_load_dwordx4 v[92:95], v1, s[44:47], s82 offen offset:3072 sc1
s_sub_u32 s83, s83, 1
s_cmp_eq_u32 s83, 0
s_waitcnt vmcnt(0)
s_cbranch_scc1 Lxback2
v_max3_u32 v12, v80, v81, v82
v_max3_u32 v13, v83, v84, v85
v_max3_u32 v12, v12, v86, v87
v_max3_u32 v13, v13, v88, v89
v_max3_u32 v12, v12, v90, v91
v_max3_u32 v13, v13, v92, v93
v_max3_u32 v12, v12, v94, v95
v_max_u32 v12, v12, v13
v_cmp_le_u32 vcc, 0xff800000, v12
s_cbranch_vccnz Lxsl2
s_branch Lxback2
Lxspin3:
s_mov_b32 s83, 262144
Lxsl3:
buffer_load_dwordx4 v[96:99], v1, s[44:47], s81 offen sc1
buffer_load_dwordx4 v[100:103], v1, s[44:47], s81 offen offset:1024 sc1
buffer_load_dwordx4 v[104:107], v1, s[44:47], s81 offen offset:2048 sc1
buffer_load_dwordx4 v[108:111], v1, s[44:47], s81 offen offset:3072 sc1
s_sub_u32 s83, s83, 1
s_cmp_eq_u32 s83, 0
s_waitcnt vmcnt(0)
s_cbranch_scc1 Lxback3
v_max3_u32 v12, v96, v97, v98
v_max3_u32 v13, v99, v100, v101
v_max3_u32 v12, v12, v102, v103
v_max3_u32 v13, v13, v104, v105
v_max3_u32 v12, v12, v106, v107
v_max3_u32 v13, v13, v108, v109
v_max3_u32 v12, v12, v110, v111
v_max_u32 v12, v12, v13
v_cmp_le_u32 vcc, 0xff800000, v12
s_cbranch_vccnz Lxsl3
s_branch Lxback3
Lcode_end:
s_endpgm
.section .rodata,"a"
.p2align 6
.amdhsa_kernel gated_mix__compressed_kv_cla__ssm_conv_h3__prompt_kernel
  .amdhsa_next_free_vgpr 512
  .amdhsa_next_free_sgpr 102
  .amdhsa_accum_offset 256
  .amdhsa_group_segment_fixed_size 0
  .amdhsa_kernarg_size 128
  .amdhsa_user_sgpr_count 2
  .amdhsa_user_sgpr_kernarg_segment_ptr 1
  .amdhsa_system_sgpr_workgroup_id_x 1
  .amdhsa_float_denorm_mode_32 3
.end_amdhsa_kernel
```

```asm
; @launch grid=(256,1,1) block=(256,1,1) lds=163840
.amdgcn_target "amdgcn-amd-amdhsa--gfx950"
.text
.globl gated_mix__compressed_kv_cla__ssm_conv_h3__prompt_kernel
.p2align 8
.type gated_mix__compressed_kv_cla__ssm_conv_h3__prompt_kernel,@function
gated_mix__compressed_kv_cla__ssm_conv_h3__prompt_kernel:
s_cmp_ge_u32 s2, 256
s_cbranch_scc1 Lend
s_load_dwordx2 s[8:9], s[0:1], 8
s_load_dwordx2 s[16:17], s[0:1], 24
s_load_dwordx2 s[20:21], s[0:1], 32
s_load_dwordx2 s[4:5], s[0:1], 0
s_load_dwordx2 s[12:13], s[0:1], 16
s_load_dwordx2 s[24:25], s[0:1], 40
s_load_dwordx2 s[28:29], s[0:1], 56
s_load_dwordx2 s[32:33], s[0:1], 64
s_load_dwordx2 s[52:53], s[0:1], 72
s_load_dwordx2 s[36:37], s[0:1], 80
s_load_dwordx2 s[54:55], s[0:1], 88
s_load_dwordx2 s[56:57], s[0:1], 96
s_load_dwordx2 s[40:41], s[0:1], 104
s_load_dwordx2 s[48:49], s[0:1], 112
s_load_dwordx2 s[44:45], s[0:1], 120
s_getpc_b64 s[98:99]
Lpc0:
s_lshr_b32 s75, s2, 3
v_lshrrev_b32 v26, 3, v0
s_lshl_b32 s73, s75, 12
v_lshlrev_b32 v26, 7, v26
v_add_u32 v26, s73, v26
v_min_u32 v26, Lcode_end-Lpc0, v26
global_load_dword v31, v26, s[98:99]
v_lshrrev_b32 v26, 6, v0
v_and_b32 v0, 63, v0
s_and_b32 s73, s2, 7
v_readfirstlane_b32 s58, v26
s_lshr_b32 s65, s75, 3
s_and_b32 s60, s75, 7
s_lshl_b32 s59, s73, 2
s_add_u32 s59, s59, s65
s_lshl_b32 s61, s65, 1
s_lshl_b32 s63, s58, 13
s_lshl_b32 s64, s58, 12
s_lshl_b32 s67, s60, 18
s_lshl_b32 s76, s58, 16
s_add_u32 s84, s67, s76
s_lshl_b32 s66, s58, 17
s_lshl_b32 s73, s59, 8
s_add_u32 s66, s66, s73
v_lshrrev_b32 v26, 4, v0
v_and_b32 v27, 7, v0
v_xor_b32 v27, v27, v26
v_lshlrev_b32 v27, 4, v27
v_lshrrev_b32 v28, 3, v0
v_lshl_add_u32 v2, v28, 10, v27
v_xor_b32 v3, 64, v2
v_and_b32 v29, 15, v0
v_lshlrev_b32 v30, 1, v26
v_xor_b32 v30, v30, v29
v_lshlrev_b32 v30, 4, v30
v_lshl_add_u32 v6, v26, 13, v30
v_xor_b32 v7, 0x80, v6
s_mov_b32 s10, 0x200000
s_mov_b32 s11, 0x20000
s_mov_b32 s18, 0x400000
s_mov_b32 s19, 0x20000
s_mov_b32 s22, 0x400000
s_mov_b32 s23, 0x20000
s_lshl_b32 s73, s2, 2
s_add_u32 s73, s73, s58
s_lshl_b32 s73, s73, 11
v_lshrrev_b32 v124, 2, v0
v_lshlrev_b32 v124, 7, v124
v_add_u32 v124, s73, v124
s_lshl_b32 s73, s60, 2
s_add_u32 s73, s73, s58
s_lshl_b32 s73, s73, 13
s_lshl_b32 s74, s59, 8
s_add_u32 s73, s73, s74
v_lshrrev_b32 v125, 4, v0
v_lshlrev_b32 v125, 18, v125
v_bfe_u32 v126, v0, 3, 1
v_lshl_add_u32 v125, v126, 7, v125
v_add_u32 v125, s73, v125
s_waitcnt lgkmcnt(0)
s_mov_b32 s80, 0x0
buffer_load_dword v126, v125, s[16:19], s80 offen
buffer_load_dword v126, v125, s[20:23], s80 offen
s_and_b32 s73, s65, 1
s_xor_b32 s73, s73, 0
s_lshl_b32 s69, s73, 7
s_add_u32 s69, s69, s84
s_lshl_b32 s71, s73, 19
s_add_u32 s71, s71, s66
s_add_u32 m0, s63, 65536
s_add_u32 s72, s69, 0
buffer_load_dwordx4 v2, s[8:11], s72 offen lds
s_add_u32 s72, s69, 7168
buffer_load_dwordx4 v3, s[8:11], s72 offen offset:1024 lds
s_add_u32 s72, s69, 14336
buffer_load_dwordx4 v2, s[8:11], s72 offen offset:2048 lds
s_add_u32 s72, s69, 21504
buffer_load_dwordx4 v3, s[8:11], s72 offen offset:3072 lds
s_add_u32 m0, s64, 0
s_add_u32 s72, s71, 0
buffer_load_dwordx4 v6, s[16:19], s72 offen lds
s_add_u32 s72, s71, 31744
buffer_load_dwordx4 v6, s[16:19], s72 offen offset:1024 lds
s_add_u32 s72, s71, 63488
buffer_load_dwordx4 v7, s[16:19], s72 offen offset:2048 lds
s_add_u32 s72, s71, 95232
buffer_load_dwordx4 v7, s[16:19], s72 offen offset:3072 lds
s_add_u32 m0, s63, 69632
s_add_u32 s72, s69, 32768
buffer_load_dwordx4 v2, s[8:11], s72 offen lds
s_add_u32 s72, s69, 39936
buffer_load_dwordx4 v3, s[8:11], s72 offen offset:1024 lds
s_add_u32 s72, s69, 47104
buffer_load_dwordx4 v2, s[8:11], s72 offen offset:2048 lds
s_add_u32 s72, s69, 54272
buffer_load_dwordx4 v3, s[8:11], s72 offen offset:3072 lds
s_add_u32 m0, s64, 16384
s_add_u32 s72, s71, 0
buffer_load_dwordx4 v6, s[20:23], s72 offen lds
s_add_u32 s72, s71, 31744
buffer_load_dwordx4 v6, s[20:23], s72 offen offset:1024 lds
s_add_u32 s72, s71, 63488
buffer_load_dwordx4 v7, s[20:23], s72 offen offset:2048 lds
s_add_u32 s72, s71, 95232
buffer_load_dwordx4 v7, s[20:23], s72 offen offset:3072 lds
buffer_load_dword v126, v124, s[8:11], 0 offen
s_and_b32 s73, s65, 1
s_xor_b32 s73, s73, 1
s_lshl_b32 s69, s73, 7
s_add_u32 s69, s69, s84
s_lshl_b32 s71, s73, 19
s_add_u32 s71, s71, s66
s_add_u32 m0, s63, 98304
s_add_u32 s72, s69, 0
buffer_load_dwordx4 v2, s[8:11], s72 offen lds
s_add_u32 s72, s69, 7168
buffer_load_dwordx4 v3, s[8:11], s72 offen offset:1024 lds
s_add_u32 s72, s69, 14336
buffer_load_dwordx4 v2, s[8:11], s72 offen offset:2048 lds
s_add_u32 s72, s69, 21504
buffer_load_dwordx4 v3, s[8:11], s72 offen offset:3072 lds
s_branch Lmain
.p2align 12
Lmain:
s_mov_b32 s6, 0x400000
s_mov_b32 s7, 0x20000
s_mov_b32 s14, 0x800000
s_mov_b32 s15, 0x20000
s_mov_b32 s26, 0x800000
s_mov_b32 s27, 0x20000
s_mov_b32 s30, 0x400000
s_mov_b32 s31, 0x20000
s_mov_b32 s34, 0x400000
s_mov_b32 s35, 0x20000
s_mov_b32 s38, 0x400000
s_mov_b32 s39, 0x20000
s_mov_b32 s42, 0x400000
s_mov_b32 s43, 0x20000
s_mov_b32 s46, 0x5800000
s_mov_b32 s47, 0x20000
s_mov_b32 s50, 0x100
s_mov_b32 s51, 0x20000
v_lshl_add_u32 v4, v28, 11, v27
v_xor_b32 v5, 64, v4
v_lshlrev_b32 v1, 4, v0
s_sub_u32 s74, 15, s60
s_lshl_b32 s68, s74, 18
s_lshl_b32 s76, s58, 15
s_add_u32 s68, s68, s76
s_add_u32 s67, s67, s76
s_and_b32 s62, s60, 3
s_sub_u32 s62, 16, s62
s_lshl_b32 s91, s59, 3
s_add_u32 s91, s91, s60
s_lshl_b32 s93, s91, 2
s_add_u32 s93, s93, s58
s_lshl_b32 s91, s91, 7
s_add_u32 s91, s91, 0x3810000
s_lshl_b32 s75, s93, 1
s_and_b32 s75, s75, 0xffc
s_lshl_b32 s93, s93, 12
s_load_dwordx2 s[88:89], s[36:37], s93
s_load_dword s90, s[54:55], s75
v_or_b32 v29, s58, v0
v_mov_b32 v30, 0
v_min_u32 v29, 1, v29
v_lshlrev_b32 v29, 30, v29
buffer_store_dword v30, v29, s[44:47], s91 offen sc1
s_and_b32 s73, s2, 15
s_lshr_b32 s74, s2, 4
s_lshl_b32 s74, s74, 7
s_lshl_b32 s75, s58, 5
s_add_u32 s74, s74, s75
s_mov_b32 s75, 131072
v_lshrrev_b32 v29, 5, v0
v_lshlrev_b32 v29, 4, v29
v_add_u32 v29, s74, v29
v_and_b32 v30, 31, v0
s_lshl_b32 s73, s73, 5
v_add_u32 v30, s73, v30
v_lshlrev_b32 v26, 11, v29
v_lshl_add_u32 v26, v30, 2, v26
v_subrev_u32 v27, 0x1800, v26
s_lshl_b32 s82, s74, 11
s_lshl_b32 s73, s73, 2
s_add_u32 s82, s82, s73
v_lshrrev_b32 v26, 3, v0
v_and_b32 v32, 7, v0
v_lshlrev_b32 v32, 4, v32
v_lshl_add_u32 v26, v26, 11, v32
v_lshrrev_b32 v98, 5, v0
v_lshlrev_b32 v98, 11, v98
v_and_b32 v32, 31, v0
v_lshl_add_u32 v98, v32, 2, v98
v_add_u32 v98, s63, v98
v_add_u32 v98, s75, v98
v_and_b32 v29, 0x7f, v29
v_sub_u32 v29, 0x70, v29
v_lshlrev_b32 v29, 1, v29
v_and_b32 v32, 31, v0
v_mul_u32_u24 v32, 544, v32
v_add3_u32 v28, v32, v29, s75
v_lshlrev_b32 v30, 4, v30
s_lshl_b32 s73, s2, 14
s_lshl_b32 s74, s58, 12
s_add_u32 s76, s73, s74
v_and_b32 v29, 15, v0
v_lshrrev_b32 v32, 4, v0
v_lshrrev_b32 v24, 1, v29
v_xor_b32 v24, v24, v32
v_lshlrev_b32 v24, 4, v24
v_lshl_add_u32 v24, v29, 7, v24
s_add_u32 s73, s63, 131072
v_add_u32 v16, s73, v24
v_xor_b32 v17, 64, v16
v_subrev_u32 v18, 0x10000, v16
v_subrev_u32 v19, 0x10000, v17
s_lshr_b32 s73, s58, 1
s_lshl_b32 s74, s73, 14
s_add_u32 s74, s74, 0x10000
v_add_u32 v24, s74, v24
v_xor_b32 v25, 64, v24
v_lshrrev_b32 v8, 2, v29
v_and_b32 v9, 1, v32
v_lshl_add_u32 v9, v9, 2, v8
v_lshl_add_u32 v8, v32, 3, v8
v_lshlrev_b32 v8, 8, v8
v_lshl_add_u32 v8, v9, 5, v8
v_and_b32 v29, 3, v0
v_lshl_add_u32 v8, v29, 3, v8
s_and_b32 s74, s58, 1
s_lshl_b32 s75, s74, 7
v_xor_b32 v20, s75, v8
v_xor_b32 v9, 32, v8
v_xor_b32 v10, 64, v8
v_xor_b32 v11, 96, v8
v_xor_b32 v12, 128, v8
v_xor_b32 v13, 160, v8
v_xor_b32 v14, 192, v8
v_xor_b32 v15, 224, v8
v_xor_b32 v21, 32, v20
v_xor_b32 v22, 64, v20
v_xor_b32 v23, 96, v20
s_lshl_b32 s77, s59, 20
s_add_u32 s81, s77, s64
s_sub_u32 s81, s81, 0x4000
s_lshl_b32 s75, s60, 17
s_add_u32 s77, s77, s75
s_lshl_b32 s73, s73, 16
s_add_u32 s77, s77, s73
s_lshl_b32 s75, s74, 12
s_add_u32 s78, s77, s75
s_add_u32 s78, s78, 0x4000
s_lshl_b32 s75, s74, 11
s_add_u32 s77, s77, s75
s_mov_b32 s79, 0x3e0293ee
s_waitcnt vmcnt(6)
s_barrier
ds_read_b64_tr_b16 v[224:225], v20 offset:0
ds_read_b64_tr_b16 v[226:227], v20 offset:1024
ds_read_b64_tr_b16 v[228:229], v20 offset:8192
ds_read_b64_tr_b16 v[230:231], v20 offset:9216
ds_read_b128 v[128:131], v24 offset:0
ds_read_b128 v[132:135], v25 offset:0
ds_read_b128 v[136:139], v24 offset:2048
ds_read_b128 v[140:143], v25 offset:2048
ds_read_b128 v[144:147], v24 offset:4096
ds_read_b128 v[148:151], v25 offset:4096
ds_read_b128 v[152:155], v24 offset:6144
ds_read_b128 v[156:159], v25 offset:6144
ds_read_b128 v[160:163], v24 offset:8192
ds_read_b128 v[164:167], v25 offset:8192
ds_read_b128 v[168:171], v24 offset:10240
ds_read_b128 v[172:175], v25 offset:10240
ds_read_b128 v[176:179], v24 offset:12288
ds_read_b128 v[180:183], v25 offset:12288
ds_read_b128 v[184:187], v24 offset:14336
ds_read_b128 v[188:191], v25 offset:14336
ds_read_b64_tr_b16 v[232:233], v21 offset:0
ds_read_b64_tr_b16 v[234:235], v21 offset:1024
ds_read_b64_tr_b16 v[236:237], v21 offset:8192
ds_read_b64_tr_b16 v[238:239], v21 offset:9216
s_waitcnt lgkmcnt(0)
v_mfma_f32_16x16x32_bf16 a[0:3], v[224:227], v[128:131], 0
s_add_u32 m0, s64, 32768
ds_read_b64_tr_b16 v[240:241], v22 offset:0
v_mfma_f32_16x16x32_bf16 a[0:3], v[228:231], v[132:135], a[0:3]
s_add_u32 s72, s71, 0
buffer_load_dwordx4 v6, s[16:19], s72 offen lds
v_mfma_f32_16x16x32_bf16 a[4:7], v[228:231], v[140:143], 0
s_add_u32 s72, s71, 31744
buffer_load_dwordx4 v6, s[16:19], s72 offen offset:1024 lds
v_mfma_f32_16x16x32_bf16 a[4:7], v[224:227], v[136:139], a[4:7]
ds_read_b64_tr_b16 v[242:243], v22 offset:1024
v_mfma_f32_16x16x32_bf16 a[8:11], v[224:227], v[144:147], 0
s_add_u32 s72, s71, 63488
buffer_load_dwordx4 v7, s[16:19], s72 offen offset:2048 lds
v_mfma_f32_16x16x32_bf16 a[8:11], v[228:231], v[148:151], a[8:11]
v_mfma_f32_16x16x32_bf16 a[12:15], v[228:231], v[156:159], 0
s_add_u32 s72, s71, 95232
buffer_load_dwordx4 v7, s[16:19], s72 offen offset:3072 lds
v_mfma_f32_16x16x32_bf16 a[12:15], v[224:227], v[152:155], a[12:15]
ds_read_b64_tr_b16 v[244:245], v22 offset:8192
v_mfma_f32_16x16x32_bf16 a[16:19], v[224:227], v[160:163], 0
s_add_u32 m0, s63, 102400
v_mfma_f32_16x16x32_bf16 a[16:19], v[228:231], v[164:167], a[16:19]
s_add_u32 s72, s69, 32768
buffer_load_dwordx4 v2, s[8:11], s72 offen lds
v_mfma_f32_16x16x32_bf16 a[20:23], v[228:231], v[172:175], 0
s_add_u32 s72, s69, 39936
buffer_load_dwordx4 v3, s[8:11], s72 offen offset:1024 lds
v_mfma_f32_16x16x32_bf16 a[20:23], v[224:227], v[168:171], a[20:23]
ds_read_b64_tr_b16 v[246:247], v22 offset:9216
v_mfma_f32_16x16x32_bf16 a[24:27], v[224:227], v[176:179], 0
s_add_u32 s72, s69, 47104
buffer_load_dwordx4 v2, s[8:11], s72 offen offset:2048 lds
v_mfma_f32_16x16x32_bf16 a[24:27], v[228:231], v[180:183], a[24:27]
v_mfma_f32_16x16x32_bf16 a[28:31], v[228:231], v[188:191], 0
s_add_u32 s72, s69, 54272
buffer_load_dwordx4 v3, s[8:11], s72 offen offset:3072 lds
v_mfma_f32_16x16x32_bf16 a[28:31], v[224:227], v[184:187], a[28:31]
v_mfma_f32_16x16x32_bf16 a[60:63], v[232:235], v[184:187], 0
s_add_u32 m0, s64, 49152
ds_read_b64_tr_b16 v[248:249], v23 offset:0
v_mfma_f32_16x16x32_bf16 a[60:63], v[236:239], v[188:191], a[60:63]
s_add_u32 s72, s71, 0
buffer_load_dwordx4 v6, s[20:23], s72 offen lds
v_mfma_f32_16x16x32_bf16 a[56:59], v[236:239], v[180:183], 0
s_add_u32 s72, s71, 31744
buffer_load_dwordx4 v6, s[20:23], s72 offen offset:1024 lds
v_mfma_f32_16x16x32_bf16 a[56:59], v[232:235], v[176:179], a[56:59]
v_mfma_f32_16x16x32_bf16 a[52:55], v[232:235], v[168:171], 0
s_add_u32 s72, s71, 63488
buffer_load_dwordx4 v7, s[20:23], s72 offen offset:2048 lds
v_mfma_f32_16x16x32_bf16 a[52:55], v[236:239], v[172:175], a[52:55]
ds_read_b64_tr_b16 v[250:251], v23 offset:1024
v_mfma_f32_16x16x32_bf16 a[48:51], v[236:239], v[164:167], 0
s_add_u32 s72, s71, 95232
buffer_load_dwordx4 v7, s[20:23], s72 offen offset:3072 lds
v_mfma_f32_16x16x32_bf16 a[48:51], v[232:235], v[160:163], a[48:51]
s_mov_b32 s80, 0x100000
buffer_load_dword v126, v125, s[16:19], s80 offen
v_mfma_f32_16x16x32_bf16 a[44:47], v[232:235], v[152:155], 0
buffer_load_dword v126, v125, s[20:23], s80 offen
v_mfma_f32_16x16x32_bf16 a[44:47], v[236:239], v[156:159], a[44:47]
v_mfma_f32_16x16x32_bf16 a[40:43], v[236:239], v[148:151], 0
ds_read_b64_tr_b16 v[252:253], v23 offset:8192
v_mfma_f32_16x16x32_bf16 a[40:43], v[232:235], v[144:147], a[40:43]
v_mfma_f32_16x16x32_bf16 a[36:39], v[232:235], v[136:139], 0
ds_read_b64_tr_b16 v[254:255], v23 offset:9216
v_mfma_f32_16x16x32_bf16 a[36:39], v[236:239], v[140:143], a[36:39]
v_mfma_f32_16x16x32_bf16 a[32:35], v[236:239], v[132:135], 0
v_mfma_f32_16x16x32_bf16 a[32:35], v[232:235], v[128:131], a[32:35]
s_waitcnt lgkmcnt(4)
v_mfma_f32_16x16x32_bf16 a[64:67], v[240:243], v[128:131], 0
ds_read_b64_tr_b16 v[224:225], v20 offset:16384
v_mfma_f32_16x16x32_bf16 a[64:67], v[244:247], v[132:135], a[64:67]
v_mfma_f32_16x16x32_bf16 a[68:71], v[244:247], v[140:143], 0
v_mfma_f32_16x16x32_bf16 a[68:71], v[240:243], v[136:139], a[68:71]
ds_read_b64_tr_b16 v[226:227], v20 offset:17408
v_mfma_f32_16x16x32_bf16 a[72:75], v[240:243], v[144:147], 0
v_mfma_f32_16x16x32_bf16 a[72:75], v[244:247], v[148:151], a[72:75]
v_mfma_f32_16x16x32_bf16 a[76:79], v[244:247], v[156:159], 0
v_mfma_f32_16x16x32_bf16 a[76:79], v[240:243], v[152:155], a[76:79]
ds_read_b64_tr_b16 v[228:229], v20 offset:24576
v_mfma_f32_16x16x32_bf16 a[80:83], v[240:243], v[160:163], 0
v_mfma_f32_16x16x32_bf16 a[80:83], v[244:247], v[164:167], a[80:83]
v_mfma_f32_16x16x32_bf16 a[84:87], v[244:247], v[172:175], 0
ds_read_b64_tr_b16 v[230:231], v20 offset:25600
v_mfma_f32_16x16x32_bf16 a[84:87], v[240:243], v[168:171], a[84:87]
v_mfma_f32_16x16x32_bf16 a[88:91], v[240:243], v[176:179], 0
v_mfma_f32_16x16x32_bf16 a[88:91], v[244:247], v[180:183], a[88:91]
v_mfma_f32_16x16x32_bf16 a[92:95], v[244:247], v[188:191], 0
v_mfma_f32_16x16x32_bf16 a[92:95], v[240:243], v[184:187], a[92:95]
s_waitcnt lgkmcnt(4)
v_mfma_f32_16x16x32_bf16 a[124:127], v[248:251], v[184:187], 0
ds_read_b64_tr_b16 v[232:233], v21 offset:16384
v_mfma_f32_16x16x32_bf16 a[124:127], v[252:255], v[188:191], a[124:127]
v_mfma_f32_16x16x32_bf16 a[120:123], v[252:255], v[180:183], 0
v_mfma_f32_16x16x32_bf16 a[120:123], v[248:251], v[176:179], a[120:123]
ds_read_b64_tr_b16 v[234:235], v21 offset:17408
v_mfma_f32_16x16x32_bf16 a[116:119], v[248:251], v[168:171], 0
v_mfma_f32_16x16x32_bf16 a[116:119], v[252:255], v[172:175], a[116:119]
v_mfma_f32_16x16x32_bf16 a[112:115], v[252:255], v[164:167], 0
v_mfma_f32_16x16x32_bf16 a[112:115], v[248:251], v[160:163], a[112:115]
ds_read_b64_tr_b16 v[236:237], v21 offset:24576
v_mfma_f32_16x16x32_bf16 a[108:111], v[248:251], v[152:155], 0
v_mfma_f32_16x16x32_bf16 a[108:111], v[252:255], v[156:159], a[108:111]
v_mfma_f32_16x16x32_bf16 a[104:107], v[252:255], v[148:151], 0
ds_read_b64_tr_b16 v[238:239], v21 offset:25600
v_mfma_f32_16x16x32_bf16 a[104:107], v[248:251], v[144:147], a[104:107]
v_mfma_f32_16x16x32_bf16 a[100:103], v[248:251], v[136:139], 0
v_mfma_f32_16x16x32_bf16 a[100:103], v[252:255], v[140:143], a[100:103]
v_mfma_f32_16x16x32_bf16 a[96:99], v[252:255], v[132:135], 0
v_mfma_f32_16x16x32_bf16 a[96:99], v[248:251], v[128:131], a[96:99]
s_waitcnt lgkmcnt(4)
v_mfma_f32_16x16x32_bf16 a[128:131], v[128:131], v[224:227], 0
ds_read_b64_tr_b16 v[240:241], v22 offset:16384
v_mfma_f32_16x16x32_bf16 a[128:131], v[132:135], v[228:231], a[128:131]
v_mfma_f32_16x16x32_bf16 a[132:135], v[140:143], v[228:231], 0
v_mfma_f32_16x16x32_bf16 a[132:135], v[136:139], v[224:227], a[132:135]
ds_read_b64_tr_b16 v[242:243], v22 offset:17408
v_mfma_f32_16x16x32_bf16 a[136:139], v[144:147], v[224:227], 0
v_mfma_f32_16x16x32_bf16 a[136:139], v[148:151], v[228:231], a[136:139]
v_mfma_f32_16x16x32_bf16 a[140:143], v[156:159], v[228:231], 0
v_mfma_f32_16x16x32_bf16 a[140:143], v[152:155], v[224:227], a[140:143]
ds_read_b64_tr_b16 v[244:245], v22 offset:24576
v_mfma_f32_16x16x32_bf16 a[144:147], v[160:163], v[224:227], 0
v_mfma_f32_16x16x32_bf16 a[144:147], v[164:167], v[228:231], a[144:147]
v_mfma_f32_16x16x32_bf16 a[148:151], v[172:175], v[228:231], 0
ds_read_b64_tr_b16 v[246:247], v22 offset:25600
v_mfma_f32_16x16x32_bf16 a[148:151], v[168:171], v[224:227], a[148:151]
v_mfma_f32_16x16x32_bf16 a[152:155], v[176:179], v[224:227], 0
v_mfma_f32_16x16x32_bf16 a[152:155], v[180:183], v[228:231], a[152:155]
v_mfma_f32_16x16x32_bf16 a[156:159], v[188:191], v[228:231], 0
v_mfma_f32_16x16x32_bf16 a[156:159], v[184:187], v[224:227], a[156:159]
s_waitcnt lgkmcnt(4)
v_mfma_f32_16x16x32_bf16 a[188:191], v[184:187], v[232:235], 0
ds_read_b64_tr_b16 v[248:249], v23 offset:16384
v_mfma_f32_16x16x32_bf16 a[188:191], v[188:191], v[236:239], a[188:191]
v_mfma_f32_16x16x32_bf16 a[184:187], v[180:183], v[236:239], 0
ds_read_b64_tr_b16 v[250:251], v23 offset:17408
v_mfma_f32_16x16x32_bf16 a[184:187], v[176:179], v[232:235], a[184:187]
v_mfma_f32_16x16x32_bf16 a[180:183], v[168:171], v[232:235], 0
ds_read_b64_tr_b16 v[252:253], v23 offset:24576
v_mfma_f32_16x16x32_bf16 a[180:183], v[172:175], v[236:239], a[180:183]
v_mfma_f32_16x16x32_bf16 a[176:179], v[164:167], v[236:239], 0
ds_read_b64_tr_b16 v[254:255], v23 offset:25600
v_mfma_f32_16x16x32_bf16 a[176:179], v[160:163], v[232:235], a[176:179]
v_mfma_f32_16x16x32_bf16 a[172:175], v[152:155], v[232:235], 0
v_mfma_f32_16x16x32_bf16 a[172:175], v[156:159], v[236:239], a[172:175]
v_mfma_f32_16x16x32_bf16 a[168:171], v[148:151], v[236:239], 0
v_mfma_f32_16x16x32_bf16 a[168:171], v[144:147], v[232:235], a[168:171]
v_mfma_f32_16x16x32_bf16 a[164:167], v[136:139], v[232:235], 0
v_mfma_f32_16x16x32_bf16 a[164:167], v[140:143], v[236:239], a[164:167]
s_nop 3
s_mov_b64 exec, 0
s_cmp_eq_u32 s58, 0
s_cbranch_scc1 Lstub0
s_cmp_eq_u32 s58, 1
s_cbranch_scc1 Lstub1
s_cmp_eq_u32 s58, 2
s_cbranch_scc1 Lstub2
s_branch Lstub3
Lret:
s_mov_b64 exec, -1
s_nop 3
v_mfma_f32_16x16x32_bf16 a[160:163], v[132:135], v[236:239], 0
s_waitcnt vmcnt(2) lgkmcnt(0)
v_mfma_f32_16x16x32_bf16 a[160:163], v[128:131], v[232:235], a[160:163]
s_barrier
v_mfma_f32_16x16x32_bf16 a[192:195], v[128:131], v[240:243], 0
s_and_b32 s73, s65, 1
ds_read_b64_tr_b16 v[224:225], v20 offset:32768
v_mfma_f32_16x16x32_bf16 a[192:195], v[132:135], v[244:247], a[192:195]
s_xor_b32 s73, s73, 2
ds_read_b64_tr_b16 v[226:227], v20 offset:33792
v_mfma_f32_16x16x32_bf16 a[196:199], v[140:143], v[244:247], 0
s_lshl_b32 s69, s73, 7
ds_read_b64_tr_b16 v[228:229], v20 offset:40960
v_mfma_f32_16x16x32_bf16 a[196:199], v[136:139], v[240:243], a[196:199]
s_add_u32 s69, s69, s84
ds_read_b64_tr_b16 v[230:231], v20 offset:41984
v_mfma_f32_16x16x32_bf16 a[200:203], v[144:147], v[240:243], 0
s_lshl_b32 s71, s73, 19
ds_read_b128 v[192:195], v24 offset:32768
v_mfma_f32_16x16x32_bf16 a[200:203], v[148:151], v[244:247], a[200:203]
s_add_u32 s71, s71, s66
ds_read_b128 v[196:199], v25 offset:32768
v_mfma_f32_16x16x32_bf16 a[204:207], v[156:159], v[244:247], 0
s_add_u32 m0, s63, 65536
v_mfma_f32_16x16x32_bf16 a[204:207], v[152:155], v[240:243], a[204:207]
s_add_u32 s72, s69, 0
buffer_load_dwordx4 v2, s[8:11], s72 offen lds
v_mfma_f32_16x16x32_bf16 a[208:211], v[160:163], v[240:243], 0
s_add_u32 s72, s69, 7168
buffer_load_dwordx4 v3, s[8:11], s72 offen offset:1024 lds
v_mfma_f32_16x16x32_bf16 a[208:211], v[164:167], v[244:247], a[208:211]
s_add_u32 s72, s69, 14336
buffer_load_dwordx4 v2, s[8:11], s72 offen offset:2048 lds
v_mfma_f32_16x16x32_bf16 a[212:215], v[172:175], v[244:247], 0
ds_read_b128 v[200:203], v24 offset:34816
v_mfma_f32_16x16x32_bf16 a[212:215], v[168:171], v[240:243], a[212:215]
ds_read_b128 v[204:207], v25 offset:34816
v_mfma_f32_16x16x32_bf16 a[216:219], v[176:179], v[240:243], 0
s_add_u32 s72, s69, 21504
buffer_load_dwordx4 v3, s[8:11], s72 offen offset:3072 lds
v_mfma_f32_16x16x32_bf16 a[216:219], v[180:183], v[244:247], a[216:219]
ds_read_b128 v[208:211], v24 offset:36864
v_mfma_f32_16x16x32_bf16 a[220:223], v[188:191], v[244:247], 0
ds_read_b128 v[212:215], v25 offset:36864
v_mfma_f32_16x16x32_bf16 a[220:223], v[184:187], v[240:243], a[220:223]
ds_read_b128 v[216:219], v24 offset:38912
v_mfma_f32_16x16x32_bf16 a[252:255], v[184:187], v[248:251], 0
ds_read_b128 v[220:223], v25 offset:38912
v_mfma_f32_16x16x32_bf16 a[252:255], v[188:191], v[252:255], a[252:255]
s_add_u32 m0, s64, 0
v_mfma_f32_16x16x32_bf16 a[248:251], v[180:183], v[252:255], 0
s_add_u32 s72, s71, 0
buffer_load_dwordx4 v6, s[16:19], s72 offen lds
v_mfma_f32_16x16x32_bf16 a[248:251], v[176:179], v[248:251], a[248:251]
ds_read_b128 v[184:187], v24 offset:40960
v_mfma_f32_16x16x32_bf16 a[244:247], v[168:171], v[248:251], 0
ds_read_b128 v[188:191], v25 offset:40960
v_mfma_f32_16x16x32_bf16 a[244:247], v[172:175], v[252:255], a[244:247]
s_add_u32 s72, s71, 31744
buffer_load_dwordx4 v6, s[16:19], s72 offen offset:1024 lds
v_mfma_f32_16x16x32_bf16 a[240:243], v[164:167], v[252:255], 0
ds_read_b128 v[176:179], v24 offset:43008
v_mfma_f32_16x16x32_bf16 a[240:243], v[160:163], v[248:251], a[240:243]
ds_read_b128 v[180:183], v25 offset:43008
v_mfma_f32_16x16x32_bf16 a[236:239], v[152:155], v[248:251], 0
ds_read_b128 v[168:171], v24 offset:45056
v_mfma_f32_16x16x32_bf16 a[236:239], v[156:159], v[252:255], a[236:239]
s_add_u32 s72, s71, 63488
buffer_load_dwordx4 v7, s[16:19], s72 offen offset:2048 lds
v_mfma_f32_16x16x32_bf16 a[232:235], v[148:151], v[252:255], 0
ds_read_b128 v[172:175], v25 offset:45056
v_mfma_f32_16x16x32_bf16 a[232:235], v[144:147], v[248:251], a[232:235]
ds_read_b128 v[160:163], v24 offset:47104
v_mfma_f32_16x16x32_bf16 a[228:231], v[136:139], v[248:251], 0
ds_read_b128 v[164:167], v25 offset:47104
v_mfma_f32_16x16x32_bf16 a[228:231], v[140:143], v[252:255], a[228:231]
v_mfma_f32_16x16x32_bf16 a[224:227], v[132:135], v[252:255], 0
s_add_u32 s72, s71, 95232
buffer_load_dwordx4 v7, s[16:19], s72 offen offset:3072 lds
v_mfma_f32_16x16x32_bf16 a[224:227], v[128:131], v[248:251], a[224:227]
s_waitcnt lgkmcnt(8)
ds_read_b64_tr_b16 v[232:233], v21 offset:32768
v_mfma_f32_16x16x32_bf16 a[0:3], v[224:227], v[192:195], a[0:3]
ds_read_b64_tr_b16 v[234:235], v21 offset:33792
v_mfma_f32_16x16x32_bf16 a[0:3], v[228:231], v[196:199], a[0:3]
ds_read_b64_tr_b16 v[240:241], v22 offset:32768
v_mfma_f32_16x16x32_bf16 a[4:7], v[228:231], v[204:207], a[4:7]
s_add_u32 m0, s63, 69632
ds_read_b64_tr_b16 v[236:237], v21 offset:40960
v_mfma_f32_16x16x32_bf16 a[4:7], v[224:227], v[200:203], a[4:7]
s_add_u32 s72, s69, 32768
buffer_load_dwordx4 v2, s[8:11], s72 offen lds
v_mfma_f32_16x16x32_bf16 a[8:11], v[224:227], v[208:211], a[8:11]
ds_read_b64_tr_b16 v[238:239], v21 offset:41984
v_mfma_f32_16x16x32_bf16 a[8:11], v[228:231], v[212:215], a[8:11]
v_mfma_f32_16x16x32_bf16 a[12:15], v[228:231], v[220:223], a[12:15]
s_add_u32 s72, s69, 39936
buffer_load_dwordx4 v3, s[8:11], s72 offen offset:1024 lds
v_mfma_f32_16x16x32_bf16 a[12:15], v[224:227], v[216:219], a[12:15]
s_waitcnt lgkmcnt(5)
ds_read_b64_tr_b16 v[242:243], v22 offset:33792
v_mfma_f32_16x16x32_bf16 a[16:19], v[224:227], v[184:187], a[16:19]
v_mfma_f32_16x16x32_bf16 a[16:19], v[228:231], v[188:191], a[16:19]
ds_read_b64_tr_b16 v[244:245], v22 offset:40960
v_mfma_f32_16x16x32_bf16 a[20:23], v[228:231], v[180:183], a[20:23]
v_mfma_f32_16x16x32_bf16 a[20:23], v[224:227], v[176:179], a[20:23]
s_add_u32 s72, s69, 47104
buffer_load_dwordx4 v2, s[8:11], s72 offen offset:2048 lds
v_mfma_f32_16x16x32_bf16 a[24:27], v[224:227], v[168:171], a[24:27]
ds_read_b64_tr_b16 v[246:247], v22 offset:41984
v_mfma_f32_16x16x32_bf16 a[24:27], v[228:231], v[172:175], a[24:27]
v_mfma_f32_16x16x32_bf16 a[28:31], v[228:231], v[164:167], a[28:31]
v_mfma_f32_16x16x32_bf16 a[28:31], v[224:227], v[160:163], a[28:31]
s_waitcnt lgkmcnt(3)
v_mfma_f32_16x16x32_bf16 a[60:63], v[232:235], v[160:163], a[60:63]
s_add_u32 s72, s69, 54272
buffer_load_dwordx4 v3, s[8:11], s72 offen offset:3072 lds
v_mfma_f32_16x16x32_bf16 a[60:63], v[236:239], v[164:167], a[60:63]
ds_read_b64_tr_b16 v[248:249], v23 offset:32768
v_mfma_f32_16x16x32_bf16 a[56:59], v[236:239], v[172:175], a[56:59]
v_mfma_f32_16x16x32_bf16 a[56:59], v[232:235], v[168:171], a[56:59]
s_add_u32 m0, s64, 16384
ds_read_b64_tr_b16 v[250:251], v23 offset:33792
v_mfma_f32_16x16x32_bf16 a[52:55], v[232:235], v[176:179], a[52:55]
s_add_u32 s72, s71, 0
buffer_load_dwordx4 v6, s[20:23], s72 offen lds
v_mfma_f32_16x16x32_bf16 a[52:55], v[236:239], v[180:183], a[52:55]
v_mfma_f32_16x16x32_bf16 a[48:51], v[236:239], v[188:191], a[48:51]
v_mfma_f32_16x16x32_bf16 a[48:51], v[232:235], v[184:187], a[48:51]
ds_read_b64_tr_b16 v[252:253], v23 offset:40960
v_mfma_f32_16x16x32_bf16 a[44:47], v[232:235], v[216:219], a[44:47]
s_add_u32 s72, s71, 31744
buffer_load_dwordx4 v6, s[20:23], s72 offen offset:1024 lds
v_mfma_f32_16x16x32_bf16 a[44:47], v[236:239], v[220:223], a[44:47]
v_mfma_f32_16x16x32_bf16 a[40:43], v[236:239], v[212:215], a[40:43]
ds_read_b64_tr_b16 v[254:255], v23 offset:41984
v_mfma_f32_16x16x32_bf16 a[40:43], v[232:235], v[208:211], a[40:43]
v_mfma_f32_16x16x32_bf16 a[36:39], v[232:235], v[200:203], a[36:39]
s_add_u32 s72, s71, 63488
buffer_load_dwordx4 v7, s[20:23], s72 offen offset:2048 lds
v_mfma_f32_16x16x32_bf16 a[36:39], v[236:239], v[204:207], a[36:39]
v_mfma_f32_16x16x32_bf16 a[32:35], v[236:239], v[196:199], a[32:35]
v_mfma_f32_16x16x32_bf16 a[32:35], v[232:235], v[192:195], a[32:35]
s_waitcnt lgkmcnt(4)
v_mfma_f32_16x16x32_bf16 a[64:67], v[240:243], v[192:195], a[64:67]
s_add_u32 s72, s71, 95232
buffer_load_dwordx4 v7, s[20:23], s72 offen offset:3072 lds
v_mfma_f32_16x16x32_bf16 a[64:67], v[244:247], v[196:199], a[64:67]
s_mov_b32 s80, 0x200000
buffer_load_dword v126, v125, s[16:19], s80 offen
v_mfma_f32_16x16x32_bf16 a[68:71], v[244:247], v[204:207], a[68:71]
buffer_load_dword v126, v125, s[20:23], s80 offen
v_mfma_f32_16x16x32_bf16 a[68:71], v[240:243], v[200:203], a[68:71]
global_load_dwordx4 v[68:71], v30, s[52:53]
v_mfma_f32_16x16x32_bf16 a[72:75], v[240:243], v[208:211], a[72:75]
buffer_load_dword v33, v27, s[28:31], 0 offen nt
v_mfma_f32_16x16x32_bf16 a[72:75], v[244:247], v[212:215], a[72:75]
buffer_load_dword v34, v27, s[28:31], 0 offen offset:2048 nt
v_mfma_f32_16x16x32_bf16 a[76:79], v[244:247], v[220:223], a[76:79]
v_add_u32 v27, 0x1000, v27
v_mfma_f32_16x16x32_bf16 a[76:79], v[240:243], v[216:219], a[76:79]
buffer_load_dword v35, v27, s[28:31], 0 offen nt
v_mfma_f32_16x16x32_bf16 a[80:83], v[240:243], v[184:187], a[80:83]
s_add_u32 m0, s63, 131072
ds_read_b64_tr_b16 v[224:225], v20 offset:49152
ds_read_b64_tr_b16 v[226:227], v20 offset:50176
v_mfma_f32_16x16x32_bf16 a[80:83], v[244:247], v[188:191], a[80:83]
s_add_u32 s80, s82, 0
buffer_load_dwordx4 v26, s[28:31], s80 offen nt lds
v_mfma_f32_16x16x32_bf16 a[84:87], v[244:247], v[180:183], a[84:87]
s_add_u32 s80, s82, 15360
buffer_load_dwordx4 v26, s[28:31], s80 offen offset:1024 nt lds
v_mfma_f32_16x16x32_bf16 a[84:87], v[240:243], v[176:179], a[84:87]
s_add_u32 s80, s82, 30720
buffer_load_dwordx4 v26, s[28:31], s80 offen offset:2048 nt lds
v_mfma_f32_16x16x32_bf16 a[88:91], v[240:243], v[168:171], a[88:91]
s_add_u32 s80, s82, 46080
buffer_load_dwordx4 v26, s[28:31], s80 offen offset:3072 nt lds
v_mfma_f32_16x16x32_bf16 a[88:91], v[244:247], v[172:175], a[88:91]
ds_read_b64_tr_b16 v[228:229], v20 offset:57344
ds_read_b64_tr_b16 v[230:231], v20 offset:58368
v_mfma_f32_16x16x32_bf16 a[92:95], v[244:247], v[164:167], a[92:95]
v_mfma_f32_16x16x32_bf16 a[92:95], v[240:243], v[160:163], a[92:95]
s_waitcnt lgkmcnt(4)
v_mfma_f32_16x16x32_bf16 a[124:127], v[248:251], v[160:163], a[124:127]
ds_read_b64_tr_b16 v[232:233], v21 offset:49152
v_mfma_f32_16x16x32_bf16 a[124:127], v[252:255], v[164:167], a[124:127]
v_mfma_f32_16x16x32_bf16 a[120:123], v[252:255], v[172:175], a[120:123]
v_mfma_f32_16x16x32_bf16 a[120:123], v[248:251], v[168:171], a[120:123]
ds_read_b64_tr_b16 v[234:235], v21 offset:50176
v_mfma_f32_16x16x32_bf16 a[116:119], v[248:251], v[176:179], a[116:119]
v_mfma_f32_16x16x32_bf16 a[116:119], v[252:255], v[180:183], a[116:119]
v_mfma_f32_16x16x32_bf16 a[112:115], v[252:255], v[188:191], a[112:115]
v_mfma_f32_16x16x32_bf16 a[112:115], v[248:251], v[184:187], a[112:115]
ds_read_b64_tr_b16 v[236:237], v21 offset:57344
v_mfma_f32_16x16x32_bf16 a[108:111], v[248:251], v[216:219], a[108:111]
v_mfma_f32_16x16x32_bf16 a[108:111], v[252:255], v[220:223], a[108:111]
v_mfma_f32_16x16x32_bf16 a[104:107], v[252:255], v[212:215], a[104:107]
ds_read_b64_tr_b16 v[238:239], v21 offset:58368
v_mfma_f32_16x16x32_bf16 a[104:107], v[248:251], v[208:211], a[104:107]
v_mfma_f32_16x16x32_bf16 a[100:103], v[248:251], v[200:203], a[100:103]
v_mfma_f32_16x16x32_bf16 a[100:103], v[252:255], v[204:207], a[100:103]
v_mfma_f32_16x16x32_bf16 a[96:99], v[252:255], v[196:199], a[96:99]
v_mfma_f32_16x16x32_bf16 a[96:99], v[248:251], v[192:195], a[96:99]
s_waitcnt lgkmcnt(4)
v_mfma_f32_16x16x32_bf16 a[128:131], v[192:195], v[224:227], a[128:131]
ds_read_b64_tr_b16 v[240:241], v22 offset:49152
v_mfma_f32_16x16x32_bf16 a[128:131], v[196:199], v[228:231], a[128:131]
v_mfma_f32_16x16x32_bf16 a[132:135], v[204:207], v[228:231], a[132:135]
v_mfma_f32_16x16x32_bf16 a[132:135], v[200:203], v[224:227], a[132:135]
ds_read_b64_tr_b16 v[242:243], v22 offset:50176
v_mfma_f32_16x16x32_bf16 a[136:139], v[208:211], v[224:227], a[136:139]
v_mfma_f32_16x16x32_bf16 a[136:139], v[212:215], v[228:231], a[136:139]
v_mfma_f32_16x16x32_bf16 a[140:143], v[220:223], v[228:231], a[140:143]
v_mfma_f32_16x16x32_bf16 a[140:143], v[216:219], v[224:227], a[140:143]
ds_read_b64_tr_b16 v[244:245], v22 offset:57344
v_mfma_f32_16x16x32_bf16 a[144:147], v[184:187], v[224:227], a[144:147]
v_mfma_f32_16x16x32_bf16 a[144:147], v[188:191], v[228:231], a[144:147]
v_mfma_f32_16x16x32_bf16 a[148:151], v[180:183], v[228:231], a[148:151]
ds_read_b64_tr_b16 v[246:247], v22 offset:58368
v_mfma_f32_16x16x32_bf16 a[148:151], v[176:179], v[224:227], a[148:151]
v_mfma_f32_16x16x32_bf16 a[152:155], v[168:171], v[224:227], a[152:155]
v_mfma_f32_16x16x32_bf16 a[152:155], v[172:175], v[228:231], a[152:155]
v_mfma_f32_16x16x32_bf16 a[156:159], v[164:167], v[228:231], a[156:159]
v_mfma_f32_16x16x32_bf16 a[156:159], v[160:163], v[224:227], a[156:159]
s_waitcnt lgkmcnt(4)
v_mfma_f32_16x16x32_bf16 a[188:191], v[160:163], v[232:235], a[188:191]
ds_read_b64_tr_b16 v[248:249], v23 offset:49152
v_mfma_f32_16x16x32_bf16 a[188:191], v[164:167], v[236:239], a[188:191]
v_mfma_f32_16x16x32_bf16 a[184:187], v[172:175], v[236:239], a[184:187]
ds_read_b64_tr_b16 v[250:251], v23 offset:50176
v_mfma_f32_16x16x32_bf16 a[184:187], v[168:171], v[232:235], a[184:187]
v_mfma_f32_16x16x32_bf16 a[180:183], v[176:179], v[232:235], a[180:183]
ds_read_b64_tr_b16 v[252:253], v23 offset:57344
v_mfma_f32_16x16x32_bf16 a[180:183], v[180:183], v[236:239], a[180:183]
v_mfma_f32_16x16x32_bf16 a[176:179], v[188:191], v[236:239], a[176:179]
ds_read_b64_tr_b16 v[254:255], v23 offset:58368
v_mfma_f32_16x16x32_bf16 a[176:179], v[184:187], v[232:235], a[176:179]
v_mfma_f32_16x16x32_bf16 a[172:175], v[216:219], v[232:235], a[172:175]
v_mfma_f32_16x16x32_bf16 a[172:175], v[220:223], v[236:239], a[172:175]
v_mfma_f32_16x16x32_bf16 a[168:171], v[212:215], v[236:239], a[168:171]
v_mfma_f32_16x16x32_bf16 a[168:171], v[208:211], v[232:235], a[168:171]
v_mfma_f32_16x16x32_bf16 a[164:167], v[200:203], v[232:235], a[164:167]
v_mfma_f32_16x16x32_bf16 a[164:167], v[204:207], v[236:239], a[164:167]
v_mfma_f32_16x16x32_bf16 a[160:163], v[196:199], v[236:239], a[160:163]
s_waitcnt vmcnt(10) lgkmcnt(0)
v_mfma_f32_16x16x32_bf16 a[160:163], v[192:195], v[232:235], a[160:163]
s_barrier
v_mfma_f32_16x16x32_bf16 a[192:195], v[192:195], v[240:243], a[192:195]
s_and_b32 s73, s65, 1
ds_read_b64_tr_b16 v[224:225], v20 offset:0
v_mfma_f32_16x16x32_bf16 a[192:195], v[196:199], v[244:247], a[192:195]
s_xor_b32 s73, s73, 3
ds_read_b64_tr_b16 v[226:227], v20 offset:1024
v_mfma_f32_16x16x32_bf16 a[196:199], v[204:207], v[244:247], a[196:199]
s_lshl_b32 s69, s73, 7
ds_read_b64_tr_b16 v[228:229], v20 offset:8192
v_mfma_f32_16x16x32_bf16 a[196:199], v[200:203], v[240:243], a[196:199]
s_add_u32 s69, s69, s84
ds_read_b64_tr_b16 v[230:231], v20 offset:9216
v_mfma_f32_16x16x32_bf16 a[200:203], v[208:211], v[240:243], a[200:203]
s_lshl_b32 s71, s73, 19
ds_read_b128 v[128:131], v24 offset:0
v_mfma_f32_16x16x32_bf16 a[200:203], v[212:215], v[244:247], a[200:203]
s_add_u32 s71, s71, s66
ds_read_b128 v[132:135], v25 offset:0
v_mfma_f32_16x16x32_bf16 a[204:207], v[220:223], v[244:247], a[204:207]
s_add_u32 m0, s63, 98304
v_mfma_f32_16x16x32_bf16 a[204:207], v[216:219], v[240:243], a[204:207]
s_add_u32 s72, s69, 0
buffer_load_dwordx4 v2, s[8:11], s72 offen lds
v_mfma_f32_16x16x32_bf16 a[208:211], v[184:187], v[240:243], a[208:211]
s_add_u32 s72, s69, 7168
buffer_load_dwordx4 v3, s[8:11], s72 offen offset:1024 lds
v_mfma_f32_16x16x32_bf16 a[208:211], v[188:191], v[244:247], a[208:211]
s_add_u32 s72, s69, 14336
buffer_load_dwordx4 v2, s[8:11], s72 offen offset:2048 lds
v_mfma_f32_16x16x32_bf16 a[212:215], v[180:183], v[244:247], a[212:215]
ds_read_b128 v[136:139], v24 offset:2048
v_mfma_f32_16x16x32_bf16 a[212:215], v[176:179], v[240:243], a[212:215]
ds_read_b128 v[140:143], v25 offset:2048
v_mfma_f32_16x16x32_bf16 a[216:219], v[168:171], v[240:243], a[216:219]
s_add_u32 s72, s69, 21504
buffer_load_dwordx4 v3, s[8:11], s72 offen offset:3072 lds
v_mfma_f32_16x16x32_bf16 a[216:219], v[172:175], v[244:247], a[216:219]
ds_read_b128 v[144:147], v24 offset:4096
v_mfma_f32_16x16x32_bf16 a[220:223], v[164:167], v[244:247], a[220:223]
ds_read_b128 v[148:151], v25 offset:4096
v_mfma_f32_16x16x32_bf16 a[220:223], v[160:163], v[240:243], a[220:223]
ds_read_b128 v[152:155], v24 offset:6144
v_mfma_f32_16x16x32_bf16 a[252:255], v[160:163], v[248:251], a[252:255]
ds_read_b128 v[156:159], v25 offset:6144
v_mfma_f32_16x16x32_bf16 a[252:255], v[164:167], v[252:255], a[252:255]
s_add_u32 m0, s64, 32768
v_mfma_f32_16x16x32_bf16 a[248:251], v[172:175], v[252:255], a[248:251]
s_add_u32 s72, s71, 0
buffer_load_dwordx4 v6, s[16:19], s72 offen lds
v_mfma_f32_16x16x32_bf16 a[248:251], v[168:171], v[248:251], a[248:251]
ds_read_b128 v[160:163], v24 offset:8192
v_mfma_f32_16x16x32_bf16 a[244:247], v[176:179], v[248:251], a[244:247]
ds_read_b128 v[164:167], v25 offset:8192
v_mfma_f32_16x16x32_bf16 a[244:247], v[180:183], v[252:255], a[244:247]
s_add_u32 s72, s71, 31744
buffer_load_dwordx4 v6, s[16:19], s72 offen offset:1024 lds
v_mfma_f32_16x16x32_bf16 a[240:243], v[188:191], v[252:255], a[240:243]
ds_read_b128 v[168:171], v24 offset:10240
v_mfma_f32_16x16x32_bf16 a[240:243], v[184:187], v[248:251], a[240:243]
ds_read_b128 v[172:175], v25 offset:10240
v_mfma_f32_16x16x32_bf16 a[236:239], v[216:219], v[248:251], a[236:239]
ds_read_b128 v[176:179], v24 offset:12288
v_mfma_f32_16x16x32_bf16 a[236:239], v[220:223], v[252:255], a[236:239]
s_add_u32 s72, s71, 63488
buffer_load_dwordx4 v7, s[16:19], s72 offen offset:2048 lds
v_mfma_f32_16x16x32_bf16 a[232:235], v[212:215], v[252:255], a[232:235]
ds_read_b128 v[180:183], v25 offset:12288
v_mfma_f32_16x16x32_bf16 a[232:235], v[208:211], v[248:251], a[232:235]
ds_read_b128 v[184:187], v24 offset:14336
v_mfma_f32_16x16x32_bf16 a[228:231], v[200:203], v[248:251], a[228:231]
ds_read_b128 v[188:191], v25 offset:14336
v_mfma_f32_16x16x32_bf16 a[228:231], v[204:207], v[252:255], a[228:231]
v_mfma_f32_16x16x32_bf16 a[224:227], v[196:199], v[252:255], a[224:227]
s_add_u32 s72, s71, 95232
buffer_load_dwordx4 v7, s[16:19], s72 offen offset:3072 lds
v_mfma_f32_16x16x32_bf16 a[224:227], v[192:195], v[248:251], a[224:227]
s_waitcnt lgkmcnt(8)
ds_read_b64_tr_b16 v[232:233], v21 offset:0
v_mfma_f32_16x16x32_bf16 a[0:3], v[224:227], v[128:131], a[0:3]
ds_read_b64_tr_b16 v[234:235], v21 offset:1024
v_mfma_f32_16x16x32_bf16 a[0:3], v[228:231], v[132:135], a[0:3]
ds_read_b64_tr_b16 v[240:241], v22 offset:0
v_mfma_f32_16x16x32_bf16 a[4:7], v[228:231], v[140:143], a[4:7]
s_add_u32 m0, s63, 102400
ds_read_b64_tr_b16 v[236:237], v21 offset:8192
v_mfma_f32_16x16x32_bf16 a[4:7], v[224:227], v[136:139], a[4:7]
s_add_u32 s72, s69, 32768
buffer_load_dwordx4 v2, s[8:11], s72 offen lds
v_mfma_f32_16x16x32_bf16 a[8:11], v[224:227], v[144:147], a[8:11]
ds_read_b64_tr_b16 v[238:239], v21 offset:9216
v_mfma_f32_16x16x32_bf16 a[8:11], v[228:231], v[148:151], a[8:11]
v_mfma_f32_16x16x32_bf16 a[12:15], v[228:231], v[156:159], a[12:15]
s_add_u32 s72, s69, 39936
buffer_load_dwordx4 v3, s[8:11], s72 offen offset:1024 lds
v_mfma_f32_16x16x32_bf16 a[12:15], v[224:227], v[152:155], a[12:15]
s_waitcnt lgkmcnt(5)
ds_read_b64_tr_b16 v[242:243], v22 offset:1024
v_mfma_f32_16x16x32_bf16 a[16:19], v[224:227], v[160:163], a[16:19]
v_mfma_f32_16x16x32_bf16 a[16:19], v[228:231], v[164:167], a[16:19]
ds_read_b64_tr_b16 v[244:245], v22 offset:8192
v_mfma_f32_16x16x32_bf16 a[20:23], v[228:231], v[172:175], a[20:23]
v_mfma_f32_16x16x32_bf16 a[20:23], v[224:227], v[168:171], a[20:23]
s_add_u32 s72, s69, 47104
buffer_load_dwordx4 v2, s[8:11], s72 offen offset:2048 lds
v_mfma_f32_16x16x32_bf16 a[24:27], v[224:227], v[176:179], a[24:27]
ds_read_b64_tr_b16 v[246:247], v22 offset:9216
v_mfma_f32_16x16x32_bf16 a[24:27], v[228:231], v[180:183], a[24:27]
v_mfma_f32_16x16x32_bf16 a[28:31], v[228:231], v[188:191], a[28:31]
v_mfma_f32_16x16x32_bf16 a[28:31], v[224:227], v[184:187], a[28:31]
s_waitcnt lgkmcnt(3)
v_mfma_f32_16x16x32_bf16 a[60:63], v[232:235], v[184:187], a[60:63]
s_add_u32 s72, s69, 54272
buffer_load_dwordx4 v3, s[8:11], s72 offen offset:3072 lds
v_mfma_f32_16x16x32_bf16 a[60:63], v[236:239], v[188:191], a[60:63]
ds_read_b64_tr_b16 v[248:249], v23 offset:0
v_mfma_f32_16x16x32_bf16 a[56:59], v[236:239], v[180:183], a[56:59]
v_mfma_f32_16x16x32_bf16 a[56:59], v[232:235], v[176:179], a[56:59]
s_add_u32 m0, s64, 49152
ds_read_b64_tr_b16 v[250:251], v23 offset:1024
v_mfma_f32_16x16x32_bf16 a[52:55], v[232:235], v[168:171], a[52:55]
s_add_u32 s72, s71, 0
buffer_load_dwordx4 v6, s[20:23], s72 offen lds
v_mfma_f32_16x16x32_bf16 a[52:55], v[236:239], v[172:175], a[52:55]
v_mfma_f32_16x16x32_bf16 a[48:51], v[236:239], v[164:167], a[48:51]
v_mfma_f32_16x16x32_bf16 a[48:51], v[232:235], v[160:163], a[48:51]
ds_read_b64_tr_b16 v[252:253], v23 offset:8192
v_mfma_f32_16x16x32_bf16 a[44:47], v[232:235], v[152:155], a[44:47]
s_add_u32 s72, s71, 31744
buffer_load_dwordx4 v6, s[20:23], s72 offen offset:1024 lds
v_mfma_f32_16x16x32_bf16 a[44:47], v[236:239], v[156:159], a[44:47]
v_mfma_f32_16x16x32_bf16 a[40:43], v[236:239], v[148:151], a[40:43]
ds_read_b64_tr_b16 v[254:255], v23 offset:9216
v_mfma_f32_16x16x32_bf16 a[40:43], v[232:235], v[144:147], a[40:43]
v_mfma_f32_16x16x32_bf16 a[36:39], v[232:235], v[136:139], a[36:39]
s_add_u32 s72, s71, 63488
buffer_load_dwordx4 v7, s[20:23], s72 offen offset:2048 lds
v_mfma_f32_16x16x32_bf16 a[36:39], v[236:239], v[140:143], a[36:39]
v_mfma_f32_16x16x32_bf16 a[32:35], v[236:239], v[132:135], a[32:35]
v_mfma_f32_16x16x32_bf16 a[32:35], v[232:235], v[128:131], a[32:35]
s_waitcnt lgkmcnt(4)
v_mfma_f32_16x16x32_bf16 a[64:67], v[240:243], v[128:131], a[64:67]
s_add_u32 s72, s71, 95232
buffer_load_dwordx4 v7, s[20:23], s72 offen offset:3072 lds
v_mfma_f32_16x16x32_bf16 a[64:67], v[244:247], v[132:135], a[64:67]
s_mov_b32 s80, 0x300000
buffer_load_dword v126, v125, s[16:19], s80 offen
v_mfma_f32_16x16x32_bf16 a[68:71], v[244:247], v[140:143], a[68:71]
buffer_load_dword v126, v125, s[20:23], s80 offen
v_mfma_f32_16x16x32_bf16 a[68:71], v[240:243], v[136:139], a[68:71]
s_add_u32 m0, s63, 135168
ds_read_b64_tr_b16 v[224:225], v20 offset:16384
v_mfma_f32_16x16x32_bf16 a[72:75], v[240:243], v[144:147], a[72:75]
s_add_u32 s80, s82, 0
buffer_load_dwordx4 v26, s[32:35], s80 offen nt lds
v_mfma_f32_16x16x32_bf16 a[72:75], v[244:247], v[148:151], a[72:75]
s_add_u32 s80, s82, 15360
buffer_load_dwordx4 v26, s[32:35], s80 offen offset:1024 nt lds
v_mfma_f32_16x16x32_bf16 a[76:79], v[244:247], v[156:159], a[76:79]
s_add_u32 s80, s82, 30720
buffer_load_dwordx4 v26, s[32:35], s80 offen offset:2048 nt lds
v_mfma_f32_16x16x32_bf16 a[76:79], v[240:243], v[152:155], a[76:79]
s_add_u32 s80, s82, 46080
buffer_load_dwordx4 v26, s[32:35], s80 offen offset:3072 nt lds
v_mfma_f32_16x16x32_bf16 a[80:83], v[240:243], v[160:163], a[80:83]
ds_read_b64_tr_b16 v[226:227], v20 offset:17408
v_mfma_f32_16x16x32_bf16 a[80:83], v[244:247], v[164:167], a[80:83]
v_mfma_f32_16x16x32_bf16 a[84:87], v[244:247], v[172:175], a[84:87]
ds_read_b64_tr_b16 v[228:229], v20 offset:24576
v_mfma_f32_16x16x32_bf16 a[84:87], v[240:243], v[168:171], a[84:87]
v_mfma_f32_16x16x32_bf16 a[88:91], v[240:243], v[176:179], a[88:91]
ds_read_b64_tr_b16 v[230:231], v20 offset:25600
v_mfma_f32_16x16x32_bf16 a[88:91], v[244:247], v[180:183], a[88:91]
v_mfma_f32_16x16x32_bf16 a[92:95], v[244:247], v[188:191], a[92:95]
v_mfma_f32_16x16x32_bf16 a[92:95], v[240:243], v[184:187], a[92:95]
s_waitcnt lgkmcnt(4)
v_mfma_f32_16x16x32_bf16 a[124:127], v[248:251], v[184:187], a[124:127]
ds_read_b64_tr_b16 v[232:233], v21 offset:16384
v_mfma_f32_16x16x32_bf16 a[124:127], v[252:255], v[188:191], a[124:127]
v_mfma_f32_16x16x32_bf16 a[120:123], v[252:255], v[180:183], a[120:123]
v_mfma_f32_16x16x32_bf16 a[120:123], v[248:251], v[176:179], a[120:123]
ds_read_b64_tr_b16 v[234:235], v21 offset:17408
v_mfma_f32_16x16x32_bf16 a[116:119], v[248:251], v[168:171], a[116:119]
v_mfma_f32_16x16x32_bf16 a[116:119], v[252:255], v[172:175], a[116:119]
v_mfma_f32_16x16x32_bf16 a[112:115], v[252:255], v[164:167], a[112:115]
v_mfma_f32_16x16x32_bf16 a[112:115], v[248:251], v[160:163], a[112:115]
ds_read_b64_tr_b16 v[236:237], v21 offset:24576
v_mfma_f32_16x16x32_bf16 a[108:111], v[248:251], v[152:155], a[108:111]
v_mfma_f32_16x16x32_bf16 a[108:111], v[252:255], v[156:159], a[108:111]
v_mfma_f32_16x16x32_bf16 a[104:107], v[252:255], v[148:151], a[104:107]
ds_read_b64_tr_b16 v[238:239], v21 offset:25600
v_mfma_f32_16x16x32_bf16 a[104:107], v[248:251], v[144:147], a[104:107]
v_mfma_f32_16x16x32_bf16 a[100:103], v[248:251], v[136:139], a[100:103]
v_mfma_f32_16x16x32_bf16 a[100:103], v[252:255], v[140:143], a[100:103]
v_mfma_f32_16x16x32_bf16 a[96:99], v[252:255], v[132:135], a[96:99]
v_mfma_f32_16x16x32_bf16 a[96:99], v[248:251], v[128:131], a[96:99]
s_waitcnt lgkmcnt(4)
v_mfma_f32_16x16x32_bf16 a[128:131], v[128:131], v[224:227], a[128:131]
ds_read_b64_tr_b16 v[240:241], v22 offset:16384
v_mfma_f32_16x16x32_bf16 a[128:131], v[132:135], v[228:231], a[128:131]
v_mfma_f32_16x16x32_bf16 a[132:135], v[140:143], v[228:231], a[132:135]
v_mfma_f32_16x16x32_bf16 a[132:135], v[136:139], v[224:227], a[132:135]
ds_read_b64_tr_b16 v[242:243], v22 offset:17408
v_mfma_f32_16x16x32_bf16 a[136:139], v[144:147], v[224:227], a[136:139]
v_mfma_f32_16x16x32_bf16 a[136:139], v[148:151], v[228:231], a[136:139]
v_mfma_f32_16x16x32_bf16 a[140:143], v[156:159], v[228:231], a[140:143]
v_mfma_f32_16x16x32_bf16 a[140:143], v[152:155], v[224:227], a[140:143]
ds_read_b64_tr_b16 v[244:245], v22 offset:24576
v_mfma_f32_16x16x32_bf16 a[144:147], v[160:163], v[224:227], a[144:147]
v_mfma_f32_16x16x32_bf16 a[144:147], v[164:167], v[228:231], a[144:147]
v_mfma_f32_16x16x32_bf16 a[148:151], v[172:175], v[228:231], a[148:151]
ds_read_b64_tr_b16 v[246:247], v22 offset:25600
v_mfma_f32_16x16x32_bf16 a[148:151], v[168:171], v[224:227], a[148:151]
v_mfma_f32_16x16x32_bf16 a[152:155], v[176:179], v[224:227], a[152:155]
v_mfma_f32_16x16x32_bf16 a[152:155], v[180:183], v[228:231], a[152:155]
v_mfma_f32_16x16x32_bf16 a[156:159], v[188:191], v[228:231], a[156:159]
v_mfma_f32_16x16x32_bf16 a[156:159], v[184:187], v[224:227], a[156:159]
s_waitcnt lgkmcnt(4)
v_mfma_f32_16x16x32_bf16 a[188:191], v[184:187], v[232:235], a[188:191]
ds_read_b64_tr_b16 v[248:249], v23 offset:16384
v_mfma_f32_16x16x32_bf16 a[188:191], v[188:191], v[236:239], a[188:191]
v_mfma_f32_16x16x32_bf16 a[184:187], v[180:183], v[236:239], a[184:187]
ds_read_b64_tr_b16 v[250:251], v23 offset:17408
v_mfma_f32_16x16x32_bf16 a[184:187], v[176:179], v[232:235], a[184:187]
v_mfma_f32_16x16x32_bf16 a[180:183], v[168:171], v[232:235], a[180:183]
ds_read_b64_tr_b16 v[252:253], v23 offset:24576
v_mfma_f32_16x16x32_bf16 a[180:183], v[172:175], v[236:239], a[180:183]
v_mfma_f32_16x16x32_bf16 a[176:179], v[164:167], v[236:239], a[176:179]
ds_read_b64_tr_b16 v[254:255], v23 offset:25600
v_mfma_f32_16x16x32_bf16 a[176:179], v[160:163], v[232:235], a[176:179]
v_mfma_f32_16x16x32_bf16 a[172:175], v[152:155], v[232:235], a[172:175]
v_mfma_f32_16x16x32_bf16 a[172:175], v[156:159], v[236:239], a[172:175]
v_mfma_f32_16x16x32_bf16 a[168:171], v[148:151], v[236:239], a[168:171]
v_mfma_f32_16x16x32_bf16 a[168:171], v[144:147], v[232:235], a[168:171]
v_mfma_f32_16x16x32_bf16 a[164:167], v[136:139], v[232:235], a[164:167]
v_mfma_f32_16x16x32_bf16 a[164:167], v[140:143], v[236:239], a[164:167]
v_mfma_f32_16x16x32_bf16 a[160:163], v[132:135], v[236:239], a[160:163]
s_waitcnt vmcnt(6) lgkmcnt(0)
v_mfma_f32_16x16x32_bf16 a[160:163], v[128:131], v[232:235], a[160:163]
s_barrier
v_mfma_f32_16x16x32_bf16 a[192:195], v[128:131], v[240:243], a[192:195]
s_and_b32 s73, s65, 1
ds_read_b64_tr_b16 v[224:225], v20 offset:32768
v_mfma_f32_16x16x32_bf16 a[192:195], v[132:135], v[244:247], a[192:195]
s_xor_b32 s73, s73, 4
ds_read_b64_tr_b16 v[226:227], v20 offset:33792
v_mfma_f32_16x16x32_bf16 a[196:199], v[140:143], v[244:247], a[196:199]
s_lshl_b32 s69, s73, 7
ds_read_b64_tr_b16 v[228:229], v20 offset:40960
v_mfma_f32_16x16x32_bf16 a[196:199], v[136:139], v[240:243], a[196:199]
s_add_u32 s69, s69, s84
ds_read_b64_tr_b16 v[230:231], v20 offset:41984
v_mfma_f32_16x16x32_bf16 a[200:203], v[144:147], v[240:243], a[200:203]
s_lshl_b32 s71, s73, 19
ds_read_b128 v[192:195], v24 offset:32768
v_mfma_f32_16x16x32_bf16 a[200:203], v[148:151], v[244:247], a[200:203]
s_add_u32 s71, s71, s66
ds_read_b128 v[196:199], v25 offset:32768
v_mfma_f32_16x16x32_bf16 a[204:207], v[156:159], v[244:247], a[204:207]
s_add_u32 m0, s63, 65536
v_mfma_f32_16x16x32_bf16 a[204:207], v[152:155], v[240:243], a[204:207]
s_add_u32 s72, s69, 0
buffer_load_dwordx4 v2, s[8:11], s72 offen lds
v_mfma_f32_16x16x32_bf16 a[208:211], v[160:163], v[240:243], a[208:211]
s_add_u32 s72, s69, 7168
buffer_load_dwordx4 v3, s[8:11], s72 offen offset:1024 lds
v_mfma_f32_16x16x32_bf16 a[208:211], v[164:167], v[244:247], a[208:211]
s_add_u32 s72, s69, 14336
buffer_load_dwordx4 v2, s[8:11], s72 offen offset:2048 lds
v_mfma_f32_16x16x32_bf16 a[212:215], v[172:175], v[244:247], a[212:215]
ds_read_b128 v[200:203], v24 offset:34816
v_mfma_f32_16x16x32_bf16 a[212:215], v[168:171], v[240:243], a[212:215]
ds_read_b128 v[204:207], v25 offset:34816
v_mfma_f32_16x16x32_bf16 a[216:219], v[176:179], v[240:243], a[216:219]
s_add_u32 s72, s69, 21504
buffer_load_dwordx4 v3, s[8:11], s72 offen offset:3072 lds
v_mfma_f32_16x16x32_bf16 a[216:219], v[180:183], v[244:247], a[216:219]
ds_read_b128 v[208:211], v24 offset:36864
v_mfma_f32_16x16x32_bf16 a[220:223], v[188:191], v[244:247], a[220:223]
ds_read_b128 v[212:215], v25 offset:36864
v_mfma_f32_16x16x32_bf16 a[220:223], v[184:187], v[240:243], a[220:223]
ds_read_b128 v[216:219], v24 offset:38912
v_mfma_f32_16x16x32_bf16 a[252:255], v[184:187], v[248:251], a[252:255]
ds_read_b128 v[220:223], v25 offset:38912
v_mfma_f32_16x16x32_bf16 a[252:255], v[188:191], v[252:255], a[252:255]
s_add_u32 m0, s64, 0
v_mfma_f32_16x16x32_bf16 a[248:251], v[180:183], v[252:255], a[248:251]
s_add_u32 s72, s71, 0
buffer_load_dwordx4 v6, s[16:19], s72 offen lds
v_mfma_f32_16x16x32_bf16 a[248:251], v[176:179], v[248:251], a[248:251]
ds_read_b128 v[184:187], v24 offset:40960
v_mfma_f32_16x16x32_bf16 a[244:247], v[168:171], v[248:251], a[244:247]
ds_read_b128 v[188:191], v25 offset:40960
v_mfma_f32_16x16x32_bf16 a[244:247], v[172:175], v[252:255], a[244:247]
s_add_u32 s72, s71, 31744
buffer_load_dwordx4 v6, s[16:19], s72 offen offset:1024 lds
v_mfma_f32_16x16x32_bf16 a[240:243], v[164:167], v[252:255], a[240:243]
ds_read_b128 v[176:179], v24 offset:43008
v_mfma_f32_16x16x32_bf16 a[240:243], v[160:163], v[248:251], a[240:243]
ds_read_b128 v[180:183], v25 offset:43008
v_mfma_f32_16x16x32_bf16 a[236:239], v[152:155], v[248:251], a[236:239]
ds_read_b128 v[168:171], v24 offset:45056
v_mfma_f32_16x16x32_bf16 a[236:239], v[156:159], v[252:255], a[236:239]
s_add_u32 s72, s71, 63488
buffer_load_dwordx4 v7, s[16:19], s72 offen offset:2048 lds
v_mfma_f32_16x16x32_bf16 a[232:235], v[148:151], v[252:255], a[232:235]
ds_read_b128 v[172:175], v25 offset:45056
v_mfma_f32_16x16x32_bf16 a[232:235], v[144:147], v[248:251], a[232:235]
ds_read_b128 v[160:163], v24 offset:47104
v_mfma_f32_16x16x32_bf16 a[228:231], v[136:139], v[248:251], a[228:231]
ds_read_b128 v[164:167], v25 offset:47104
v_mfma_f32_16x16x32_bf16 a[228:231], v[140:143], v[252:255], a[228:231]
v_mfma_f32_16x16x32_bf16 a[224:227], v[132:135], v[252:255], a[224:227]
s_add_u32 s72, s71, 95232
buffer_load_dwordx4 v7, s[16:19], s72 offen offset:3072 lds
v_mfma_f32_16x16x32_bf16 a[224:227], v[128:131], v[248:251], a[224:227]
s_waitcnt lgkmcnt(8)
ds_read_b64_tr_b16 v[232:233], v21 offset:32768
v_mfma_f32_16x16x32_bf16 a[0:3], v[224:227], v[192:195], a[0:3]
ds_read_b64_tr_b16 v[234:235], v21 offset:33792
v_mfma_f32_16x16x32_bf16 a[0:3], v[228:231], v[196:199], a[0:3]
ds_read_b64_tr_b16 v[240:241], v22 offset:32768
v_mfma_f32_16x16x32_bf16 a[4:7], v[228:231], v[204:207], a[4:7]
s_add_u32 m0, s63, 69632
ds_read_b64_tr_b16 v[236:237], v21 offset:40960
v_mfma_f32_16x16x32_bf16 a[4:7], v[224:227], v[200:203], a[4:7]
s_add_u32 s72, s69, 32768
buffer_load_dwordx4 v2, s[8:11], s72 offen lds
v_mfma_f32_16x16x32_bf16 a[8:11], v[224:227], v[208:211], a[8:11]
ds_read_b64_tr_b16 v[238:239], v21 offset:41984
v_mfma_f32_16x16x32_bf16 a[8:11], v[228:231], v[212:215], a[8:11]
v_mfma_f32_16x16x32_bf16 a[12:15], v[228:231], v[220:223], a[12:15]
s_add_u32 s72, s69, 39936
buffer_load_dwordx4 v3, s[8:11], s72 offen offset:1024 lds
v_mfma_f32_16x16x32_bf16 a[12:15], v[224:227], v[216:219], a[12:15]
s_waitcnt lgkmcnt(5)
ds_read_b64_tr_b16 v[242:243], v22 offset:33792
v_mfma_f32_16x16x32_bf16 a[16:19], v[224:227], v[184:187], a[16:19]
v_mfma_f32_16x16x32_bf16 a[16:19], v[228:231], v[188:191], a[16:19]
ds_read_b64_tr_b16 v[244:245], v22 offset:40960
v_mfma_f32_16x16x32_bf16 a[20:23], v[228:231], v[180:183], a[20:23]
v_mfma_f32_16x16x32_bf16 a[20:23], v[224:227], v[176:179], a[20:23]
s_add_u32 s72, s69, 47104
buffer_load_dwordx4 v2, s[8:11], s72 offen offset:2048 lds
v_mfma_f32_16x16x32_bf16 a[24:27], v[224:227], v[168:171], a[24:27]
ds_read_b64_tr_b16 v[246:247], v22 offset:41984
v_mfma_f32_16x16x32_bf16 a[24:27], v[228:231], v[172:175], a[24:27]
v_mfma_f32_16x16x32_bf16 a[28:31], v[228:231], v[164:167], a[28:31]
v_mfma_f32_16x16x32_bf16 a[28:31], v[224:227], v[160:163], a[28:31]
s_waitcnt lgkmcnt(3)
v_mfma_f32_16x16x32_bf16 a[60:63], v[232:235], v[160:163], a[60:63]
s_add_u32 s72, s69, 54272
buffer_load_dwordx4 v3, s[8:11], s72 offen offset:3072 lds
v_mfma_f32_16x16x32_bf16 a[60:63], v[236:239], v[164:167], a[60:63]
ds_read_b64_tr_b16 v[248:249], v23 offset:32768
v_mfma_f32_16x16x32_bf16 a[56:59], v[236:239], v[172:175], a[56:59]
v_mfma_f32_16x16x32_bf16 a[56:59], v[232:235], v[168:171], a[56:59]
s_add_u32 m0, s64, 16384
ds_read_b64_tr_b16 v[250:251], v23 offset:33792
v_mfma_f32_16x16x32_bf16 a[52:55], v[232:235], v[176:179], a[52:55]
s_add_u32 s72, s71, 0
buffer_load_dwordx4 v6, s[20:23], s72 offen lds
v_mfma_f32_16x16x32_bf16 a[52:55], v[236:239], v[180:183], a[52:55]
v_mfma_f32_16x16x32_bf16 a[48:51], v[236:239], v[188:191], a[48:51]
v_mfma_f32_16x16x32_bf16 a[48:51], v[232:235], v[184:187], a[48:51]
ds_read_b64_tr_b16 v[252:253], v23 offset:40960
v_mfma_f32_16x16x32_bf16 a[44:47], v[232:235], v[216:219], a[44:47]
s_add_u32 s72, s71, 31744
buffer_load_dwordx4 v6, s[20:23], s72 offen offset:1024 lds
v_mfma_f32_16x16x32_bf16 a[44:47], v[236:239], v[220:223], a[44:47]
v_mfma_f32_16x16x32_bf16 a[40:43], v[236:239], v[212:215], a[40:43]
ds_read_b64_tr_b16 v[254:255], v23 offset:41984
v_mfma_f32_16x16x32_bf16 a[40:43], v[232:235], v[208:211], a[40:43]
v_mfma_f32_16x16x32_bf16 a[36:39], v[232:235], v[200:203], a[36:39]
s_add_u32 s72, s71, 63488
buffer_load_dwordx4 v7, s[20:23], s72 offen offset:2048 lds
v_mfma_f32_16x16x32_bf16 a[36:39], v[236:239], v[204:207], a[36:39]
v_mfma_f32_16x16x32_bf16 a[32:35], v[236:239], v[196:199], a[32:35]
v_mfma_f32_16x16x32_bf16 a[32:35], v[232:235], v[192:195], a[32:35]
s_waitcnt lgkmcnt(4)
v_mfma_f32_16x16x32_bf16 a[64:67], v[240:243], v[192:195], a[64:67]
s_add_u32 s72, s71, 95232
buffer_load_dwordx4 v7, s[20:23], s72 offen offset:3072 lds
v_mfma_f32_16x16x32_bf16 a[64:67], v[244:247], v[196:199], a[64:67]
buffer_load_dwordx4 v[108:111], v1, s[4:7], s76 offen
v_mfma_f32_16x16x32_bf16 a[68:71], v[244:247], v[204:207], a[68:71]
buffer_load_dwordx4 v[112:115], v1, s[4:7], s76 offen offset:1024
v_mfma_f32_16x16x32_bf16 a[68:71], v[240:243], v[200:203], a[68:71]
buffer_load_dwordx4 v[116:119], v1, s[4:7], s76 offen offset:2048
v_mfma_f32_16x16x32_bf16 a[72:75], v[240:243], v[208:211], a[72:75]
buffer_load_dwordx4 v[120:123], v1, s[4:7], s76 offen offset:3072
v_mfma_f32_16x16x32_bf16 a[72:75], v[244:247], v[212:215], a[72:75]
ds_read_b64_tr_b16 v[224:225], v20 offset:49152
v_mfma_f32_16x16x32_bf16 a[76:79], v[244:247], v[220:223], a[76:79]
v_mfma_f32_16x16x32_bf16 a[76:79], v[240:243], v[216:219], a[76:79]
ds_read_b64_tr_b16 v[226:227], v20 offset:50176
v_mfma_f32_16x16x32_bf16 a[80:83], v[240:243], v[184:187], a[80:83]
v_mfma_f32_16x16x32_bf16 a[80:83], v[244:247], v[188:191], a[80:83]
ds_read_b64_tr_b16 v[228:229], v20 offset:57344
v_mfma_f32_16x16x32_bf16 a[84:87], v[244:247], v[180:183], a[84:87]
v_mfma_f32_16x16x32_bf16 a[84:87], v[240:243], v[176:179], a[84:87]
ds_read_b64_tr_b16 v[230:231], v20 offset:58368
v_mfma_f32_16x16x32_bf16 a[88:91], v[240:243], v[168:171], a[88:91]
v_mfma_f32_16x16x32_bf16 a[88:91], v[244:247], v[172:175], a[88:91]
v_mfma_f32_16x16x32_bf16 a[92:95], v[244:247], v[164:167], a[92:95]
v_mfma_f32_16x16x32_bf16 a[92:95], v[240:243], v[160:163], a[92:95]
s_waitcnt lgkmcnt(4)
v_mfma_f32_16x16x32_bf16 a[124:127], v[248:251], v[160:163], a[124:127]
ds_read_b64_tr_b16 v[232:233], v21 offset:49152
v_mfma_f32_16x16x32_bf16 a[124:127], v[252:255], v[164:167], a[124:127]
v_mfma_f32_16x16x32_bf16 a[120:123], v[252:255], v[172:175], a[120:123]
v_mfma_f32_16x16x32_bf16 a[120:123], v[248:251], v[168:171], a[120:123]
ds_read_b64_tr_b16 v[234:235], v21 offset:50176
v_mfma_f32_16x16x32_bf16 a[116:119], v[248:251], v[176:179], a[116:119]
s_waitcnt vmcnt(20)
ds_read2_b32 v[36:37], v98 offset0:0 offset1:32
ds_read2_b32 v[38:39], v98 offset0:64 offset1:96
v_mfma_f32_16x16x32_bf16 a[116:119], v[252:255], v[180:183], a[116:119]
ds_read2_b32 v[40:41], v98 offset0:128 offset1:160
ds_read2_b32 v[42:43], v98 offset0:192 offset1:224
v_mfma_f32_16x16x32_bf16 a[112:115], v[252:255], v[188:191], a[112:115]
v_add_u32 v98, 1024, v98
v_mfma_f32_16x16x32_bf16 a[112:115], v[248:251], v[184:187], a[112:115]
ds_read_b64_tr_b16 v[236:237], v21 offset:57344
ds_read2_b32 v[44:45], v98 offset0:0 offset1:32
v_mfma_f32_16x16x32_bf16 a[108:111], v[248:251], v[216:219], a[108:111]
ds_read2_b32 v[46:47], v98 offset0:64 offset1:96
ds_read2_b32 v[48:49], v98 offset0:128 offset1:160
v_mfma_f32_16x16x32_bf16 a[108:111], v[252:255], v[220:223], a[108:111]
ds_read2_b32 v[50:51], v98 offset0:192 offset1:224
v_add_u32 v98, 3072, v98
v_mfma_f32_16x16x32_bf16 a[104:107], v[252:255], v[212:215], a[104:107]
ds_read_b64_tr_b16 v[238:239], v21 offset:58368
ds_read2_b32 v[52:53], v98 offset0:0 offset1:32
v_mfma_f32_16x16x32_bf16 a[104:107], v[248:251], v[208:211], a[104:107]
ds_read2_b32 v[54:55], v98 offset0:64 offset1:96
ds_read2_b32 v[56:57], v98 offset0:128 offset1:160
v_mfma_f32_16x16x32_bf16 a[100:103], v[248:251], v[200:203], a[100:103]
ds_read2_b32 v[58:59], v98 offset0:192 offset1:224
v_add_u32 v98, 1024, v98
v_mfma_f32_16x16x32_bf16 a[100:103], v[252:255], v[204:207], a[100:103]
ds_read2_b32 v[60:61], v98 offset0:0 offset1:32
ds_read2_b32 v[62:63], v98 offset0:64 offset1:96
v_mfma_f32_16x16x32_bf16 a[96:99], v[252:255], v[196:199], a[96:99]
ds_read2_b32 v[64:65], v98 offset0:128 offset1:160
ds_read2_b32 v[66:67], v98 offset0:192 offset1:224
v_mfma_f32_16x16x32_bf16 a[96:99], v[248:251], v[192:195], a[96:99]
s_waitcnt lgkmcnt(15)
v_mfma_f32_16x16x32_bf16 a[128:131], v[192:195], v[224:227], a[128:131]
ds_read_b64_tr_b16 v[240:241], v22 offset:49152
v_mfma_f32_16x16x32_bf16 a[128:131], v[196:199], v[228:231], a[128:131]
v_mfma_f32_16x16x32_bf16 a[132:135], v[204:207], v[228:231], a[132:135]
v_mfma_f32_16x16x32_bf16 a[132:135], v[200:203], v[224:227], a[132:135]
ds_read_b64_tr_b16 v[242:243], v22 offset:50176
v_mfma_f32_16x16x32_bf16 a[136:139], v[208:211], v[224:227], a[136:139]
v_mfma_f32_16x16x32_bf16 a[136:139], v[212:215], v[228:231], a[136:139]
v_mfma_f32_16x16x32_bf16 a[140:143], v[220:223], v[228:231], a[140:143]
v_mfma_f32_16x16x32_bf16 a[140:143], v[216:219], v[224:227], a[140:143]
ds_read_b64_tr_b16 v[244:245], v22 offset:57344
v_mfma_f32_16x16x32_bf16 a[144:147], v[184:187], v[224:227], a[144:147]
v_mfma_f32_16x16x32_bf16 a[144:147], v[188:191], v[228:231], a[144:147]
v_mfma_f32_16x16x32_bf16 a[148:151], v[180:183], v[228:231], a[148:151]
ds_read_b64_tr_b16 v[246:247], v22 offset:58368
v_mfma_f32_16x16x32_bf16 a[148:151], v[176:179], v[224:227], a[148:151]
v_mfma_f32_16x16x32_bf16 a[152:155], v[168:171], v[224:227], a[152:155]
v_mfma_f32_16x16x32_bf16 a[152:155], v[172:175], v[228:231], a[152:155]
v_mfma_f32_16x16x32_bf16 a[156:159], v[164:167], v[228:231], a[156:159]
v_mfma_f32_16x16x32_bf16 a[156:159], v[160:163], v[224:227], a[156:159]
s_waitcnt lgkmcnt(12)
v_mfma_f32_16x16x32_bf16 a[188:191], v[160:163], v[232:235], a[188:191]
ds_read_b64_tr_b16 v[248:249], v23 offset:49152
v_mfma_f32_16x16x32_bf16 a[188:191], v[164:167], v[236:239], a[188:191]
v_mfma_f32_16x16x32_bf16 a[184:187], v[172:175], v[236:239], a[184:187]
ds_read_b64_tr_b16 v[250:251], v23 offset:50176
v_mfma_f32_16x16x32_bf16 a[184:187], v[168:171], v[232:235], a[184:187]
v_mfma_f32_16x16x32_bf16 a[180:183], v[176:179], v[232:235], a[180:183]
ds_read_b64_tr_b16 v[252:253], v23 offset:57344
v_mfma_f32_16x16x32_bf16 a[180:183], v[180:183], v[236:239], a[180:183]
v_mfma_f32_16x16x32_bf16 a[176:179], v[188:191], v[236:239], a[176:179]
ds_read_b64_tr_b16 v[254:255], v23 offset:58368
v_mfma_f32_16x16x32_bf16 a[176:179], v[184:187], v[232:235], a[176:179]
v_mfma_f32_16x16x32_bf16 a[172:175], v[216:219], v[232:235], a[172:175]
v_mfma_f32_16x16x32_bf16 a[172:175], v[220:223], v[236:239], a[172:175]
v_mfma_f32_16x16x32_bf16 a[168:171], v[212:215], v[236:239], a[168:171]
v_mfma_f32_16x16x32_bf16 a[168:171], v[208:211], v[232:235], a[168:171]
v_mfma_f32_16x16x32_bf16 a[164:167], v[200:203], v[232:235], a[164:167]
v_mfma_f32_16x16x32_bf16 a[164:167], v[204:207], v[236:239], a[164:167]
v_mfma_f32_16x16x32_bf16 a[160:163], v[196:199], v[236:239], a[160:163]
s_waitcnt vmcnt(4) lgkmcnt(0)
v_mfma_f32_16x16x32_bf16 a[160:163], v[192:195], v[232:235], a[160:163]
s_barrier
v_mfma_f32_16x16x32_bf16 a[192:195], v[192:195], v[240:243], a[192:195]
s_and_b32 s73, s65, 1
ds_read_b64_tr_b16 v[224:225], v20 offset:0
v_lshlrev_b32 v72, 16, v68
v_mfma_f32_16x16x32_bf16 a[192:195], v[196:199], v[244:247], a[192:195]
s_xor_b32 s73, s73, 5
ds_read_b64_tr_b16 v[226:227], v20 offset:1024
v_and_b32 v73, 0xffff0000, v68
v_mfma_f32_16x16x32_bf16 a[196:199], v[204:207], v[244:247], a[196:199]
s_lshl_b32 s69, s73, 7
ds_read_b64_tr_b16 v[228:229], v20 offset:8192
v_lshlrev_b32 v74, 16, v69
v_mfma_f32_16x16x32_bf16 a[196:199], v[200:203], v[240:243], a[196:199]
s_add_u32 s69, s69, s84
ds_read_b64_tr_b16 v[230:231], v20 offset:9216
v_and_b32 v75, 0xffff0000, v69
v_mfma_f32_16x16x32_bf16 a[200:203], v[208:211], v[240:243], a[200:203]
s_lshl_b32 s71, s73, 19
ds_read_b128 v[128:131], v24 offset:0
v_lshlrev_b32 v76, 16, v33
v_mfma_f32_16x16x32_bf16 a[200:203], v[212:215], v[244:247], a[200:203]
s_add_u32 s71, s71, s66
ds_read_b128 v[132:135], v25 offset:0
v_lshlrev_b32 v77, 16, v34
v_mfma_f32_16x16x32_bf16 a[204:207], v[220:223], v[244:247], a[204:207]
s_add_u32 m0, s63, 98304
v_lshlrev_b32 v78, 16, v35
v_lshlrev_b32 v79, 16, v36
v_mfma_f32_16x16x32_bf16 a[204:207], v[216:219], v[240:243], a[204:207]
s_add_u32 s72, s69, 0
buffer_load_dwordx4 v2, s[8:11], s72 offen lds
v_mfma_f32_16x16x32_bf16 a[208:211], v[184:187], v[240:243], a[208:211]
s_add_u32 s72, s69, 7168
buffer_load_dwordx4 v3, s[8:11], s72 offen offset:1024 lds
v_mfma_f32_16x16x32_bf16 a[208:211], v[188:191], v[244:247], a[208:211]
s_add_u32 s72, s69, 14336
buffer_load_dwordx4 v2, s[8:11], s72 offen offset:2048 lds
v_mfma_f32_16x16x32_bf16 a[212:215], v[180:183], v[244:247], a[212:215]
ds_read_b128 v[136:139], v24 offset:2048
v_lshlrev_b32 v80, 16, v37
v_mfma_f32_16x16x32_bf16 a[212:215], v[176:179], v[240:243], a[212:215]
ds_read_b128 v[140:143], v25 offset:2048
v_lshlrev_b32 v81, 16, v38
v_mfma_f32_16x16x32_bf16 a[216:219], v[168:171], v[240:243], a[216:219]
s_add_u32 s72, s69, 21504
buffer_load_dwordx4 v3, s[8:11], s72 offen offset:3072 lds
v_mfma_f32_16x16x32_bf16 a[216:219], v[172:175], v[244:247], a[216:219]
ds_read_b128 v[144:147], v24 offset:4096
v_lshlrev_b32 v82, 16, v39
v_mfma_f32_16x16x32_bf16 a[220:223], v[164:167], v[244:247], a[220:223]
ds_read_b128 v[148:151], v25 offset:4096
v_lshlrev_b32 v83, 16, v40
v_mfma_f32_16x16x32_bf16 a[220:223], v[160:163], v[240:243], a[220:223]
ds_read_b128 v[152:155], v24 offset:6144
v_lshlrev_b32 v84, 16, v41
v_mfma_f32_16x16x32_bf16 a[252:255], v[160:163], v[248:251], a[252:255]
ds_read_b128 v[156:159], v25 offset:6144
v_lshlrev_b32 v85, 16, v42
v_mfma_f32_16x16x32_bf16 a[252:255], v[164:167], v[252:255], a[252:255]
s_add_u32 m0, s64, 32768
v_lshlrev_b32 v86, 16, v43
v_lshlrev_b32 v87, 16, v44
v_mfma_f32_16x16x32_bf16 a[248:251], v[172:175], v[252:255], a[248:251]
s_add_u32 s72, s71, 0
buffer_load_dwordx4 v6, s[16:19], s72 offen lds
v_mfma_f32_16x16x32_bf16 a[248:251], v[168:171], v[248:251], a[248:251]
ds_read_b128 v[160:163], v24 offset:8192
v_lshlrev_b32 v88, 16, v45
v_mfma_f32_16x16x32_bf16 a[244:247], v[176:179], v[248:251], a[244:247]
ds_read_b128 v[164:167], v25 offset:8192
v_lshlrev_b32 v89, 16, v46
v_mfma_f32_16x16x32_bf16 a[244:247], v[180:183], v[252:255], a[244:247]
s_add_u32 s72, s71, 31744
buffer_load_dwordx4 v6, s[16:19], s72 offen offset:1024 lds
v_mfma_f32_16x16x32_bf16 a[240:243], v[188:191], v[252:255], a[240:243]
ds_read_b128 v[168:171], v24 offset:10240
v_lshlrev_b32 v90, 16, v47
v_mfma_f32_16x16x32_bf16 a[240:243], v[184:187], v[248:251], a[240:243]
ds_read_b128 v[172:175], v25 offset:10240
v_lshlrev_b32 v91, 16, v48
v_mfma_f32_16x16x32_bf16 a[236:239], v[216:219], v[248:251], a[236:239]
ds_read_b128 v[176:179], v24 offset:12288
v_lshlrev_b32 v92, 16, v49
v_mfma_f32_16x16x32_bf16 a[236:239], v[220:223], v[252:255], a[236:239]
s_add_u32 s72, s71, 63488
buffer_load_dwordx4 v7, s[16:19], s72 offen offset:2048 lds
v_mfma_f32_16x16x32_bf16 a[232:235], v[212:215], v[252:255], a[232:235]
ds_read_b128 v[180:183], v25 offset:12288
v_lshlrev_b32 v93, 16, v50
v_mfma_f32_16x16x32_bf16 a[232:235], v[208:211], v[248:251], a[232:235]
ds_read_b128 v[184:187], v24 offset:14336
v_lshlrev_b32 v94, 16, v51
v_mfma_f32_16x16x32_bf16 a[228:231], v[200:203], v[248:251], a[228:231]
ds_read_b128 v[188:191], v25 offset:14336
v_mul_f32 v95, v75, v91
v_mfma_f32_16x16x32_bf16 a[228:231], v[204:207], v[252:255], a[228:231]
v_lshlrev_b32 v97, 16, v67
v_fmac_f32 v95, v74, v92
v_mfma_f32_16x16x32_bf16 a[224:227], v[196:199], v[252:255], a[224:227]
s_add_u32 s72, s71, 95232
buffer_load_dwordx4 v7, s[16:19], s72 offen offset:3072 lds
v_mfma_f32_16x16x32_bf16 a[224:227], v[192:195], v[248:251], a[224:227]
s_waitcnt lgkmcnt(8)
ds_read_b64_tr_b16 v[232:233], v21 offset:0
v_fmac_f32 v95, v73, v93
v_mfma_f32_16x16x32_bf16 a[0:3], v[224:227], v[128:131], a[0:3]
ds_read_b64_tr_b16 v[234:235], v21 offset:1024
v_fmac_f32 v95, v72, v94
v_mfma_f32_16x16x32_bf16 a[0:3], v[228:231], v[132:135], a[0:3]
ds_read_b64_tr_b16 v[240:241], v22 offset:0
v_mul_f32 v95, v95, v97
v_mfma_f32_16x16x32_bf16 a[4:7], v[228:231], v[140:143], a[4:7]
s_add_u32 m0, s63, 102400
ds_read_b64_tr_b16 v[236:237], v21 offset:8192
v_mul_f32 v96, v75, v90
v_mfma_f32_16x16x32_bf16 a[4:7], v[224:227], v[136:139], a[4:7]
s_add_u32 s72, s69, 32768
buffer_load_dwordx4 v2, s[8:11], s72 offen lds
v_mfma_f32_16x16x32_bf16 a[8:11], v[224:227], v[144:147], a[8:11]
ds_read_b64_tr_b16 v[238:239], v21 offset:9216
v_lshlrev_b32 v97, 16, v66
v_mfma_f32_16x16x32_bf16 a[8:11], v[228:231], v[148:151], a[8:11]
v_fmac_f32 v96, v74, v91
v_fmac_f32 v96, v73, v92
v_mfma_f32_16x16x32_bf16 a[12:15], v[228:231], v[156:159], a[12:15]
s_add_u32 s72, s69, 39936
buffer_load_dwordx4 v3, s[8:11], s72 offen offset:1024 lds
v_mfma_f32_16x16x32_bf16 a[12:15], v[224:227], v[152:155], a[12:15]
s_waitcnt lgkmcnt(5)
ds_read_b64_tr_b16 v[242:243], v22 offset:1024
v_fmac_f32 v96, v72, v93
v_mfma_f32_16x16x32_bf16 a[16:19], v[224:227], v[160:163], a[16:19]
v_mul_f32 v96, v96, v97
v_cvt_pk_bf16_f32 v100, v95, v96
v_mfma_f32_16x16x32_bf16 a[16:19], v[228:231], v[164:167], a[16:19]
ds_read_b64_tr_b16 v[244:245], v22 offset:8192
v_mul_f32 v95, v75, v89
v_mfma_f32_16x16x32_bf16 a[20:23], v[228:231], v[172:175], a[20:23]
v_lshlrev_b32 v97, 16, v65
v_fmac_f32 v95, v74, v90
v_mfma_f32_16x16x32_bf16 a[20:23], v[224:227], v[168:171], a[20:23]
s_add_u32 s72, s69, 47104
buffer_load_dwordx4 v2, s[8:11], s72 offen offset:2048 lds
v_mfma_f32_16x16x32_bf16 a[24:27], v[224:227], v[176:179], a[24:27]
ds_read_b64_tr_b16 v[246:247], v22 offset:9216
v_fmac_f32 v95, v73, v91
v_mfma_f32_16x16x32_bf16 a[24:27], v[228:231], v[180:183], a[24:27]
v_fmac_f32 v95, v72, v92
v_mul_f32 v95, v95, v97
v_mfma_f32_16x16x32_bf16 a[28:31], v[228:231], v[188:191], a[28:31]
v_mul_f32 v96, v75, v88
v_lshlrev_b32 v97, 16, v64
v_mfma_f32_16x16x32_bf16 a[28:31], v[224:227], v[184:187], a[28:31]
s_waitcnt lgkmcnt(3)
v_fmac_f32 v96, v74, v89
v_fmac_f32 v96, v73, v90
v_mfma_f32_16x16x32_bf16 a[60:63], v[232:235], v[184:187], a[60:63]
s_add_u32 s72, s69, 54272
buffer_load_dwordx4 v3, s[8:11], s72 offen offset:3072 lds
v_mfma_f32_16x16x32_bf16 a[60:63], v[236:239], v[188:191], a[60:63]
ds_read_b64_tr_b16 v[248:249], v23 offset:0
v_fmac_f32 v96, v72, v91
v_mfma_f32_16x16x32_bf16 a[56:59], v[236:239], v[180:183], a[56:59]
v_mul_f32 v96, v96, v97
v_cvt_pk_bf16_f32 v101, v95, v96
v_mfma_f32_16x16x32_bf16 a[56:59], v[232:235], v[176:179], a[56:59]
s_add_u32 m0, s64, 49152
ds_read_b64_tr_b16 v[250:251], v23 offset:1024
v_mul_f32 v95, v75, v87
v_mfma_f32_16x16x32_bf16 a[52:55], v[232:235], v[168:171], a[52:55]
s_add_u32 s72, s71, 0
buffer_load_dwordx4 v6, s[20:23], s72 offen lds
v_mfma_f32_16x16x32_bf16 a[52:55], v[236:239], v[172:175], a[52:55]
v_lshlrev_b32 v97, 16, v63
v_fmac_f32 v95, v74, v88
v_mfma_f32_16x16x32_bf16 a[48:51], v[236:239], v[164:167], a[48:51]
v_fmac_f32 v95, v73, v89
v_fmac_f32 v95, v72, v90
v_mfma_f32_16x16x32_bf16 a[48:51], v[232:235], v[160:163], a[48:51]
ds_read_b64_tr_b16 v[252:253], v23 offset:8192
v_mul_f32 v95, v95, v97
v_mfma_f32_16x16x32_bf16 a[44:47], v[232:235], v[152:155], a[44:47]
s_add_u32 s72, s71, 31744
buffer_load_dwordx4 v6, s[20:23], s72 offen offset:1024 lds
v_mfma_f32_16x16x32_bf16 a[44:47], v[236:239], v[156:159], a[44:47]
v_mul_f32 v96, v75, v86
v_lshlrev_b32 v97, 16, v62
v_mfma_f32_16x16x32_bf16 a[40:43], v[236:239], v[148:151], a[40:43]
ds_read_b64_tr_b16 v[254:255], v23 offset:9216
v_fmac_f32 v96, v74, v87
v_mfma_f32_16x16x32_bf16 a[40:43], v[232:235], v[144:147], a[40:43]
v_fmac_f32 v96, v73, v88
v_fmac_f32 v96, v72, v89
v_mfma_f32_16x16x32_bf16 a[36:39], v[232:235], v[136:139], a[36:39]
s_add_u32 s72, s71, 63488
buffer_load_dwordx4 v7, s[20:23], s72 offen offset:2048 lds
v_mfma_f32_16x16x32_bf16 a[36:39], v[236:239], v[140:143], a[36:39]
v_mul_f32 v96, v96, v97
v_cvt_pk_bf16_f32 v102, v95, v96
v_mfma_f32_16x16x32_bf16 a[32:35], v[236:239], v[132:135], a[32:35]
v_mul_f32 v95, v75, v85
v_lshlrev_b32 v97, 16, v61
v_mfma_f32_16x16x32_bf16 a[32:35], v[232:235], v[128:131], a[32:35]
s_waitcnt lgkmcnt(4)
v_fmac_f32 v95, v74, v86
v_fmac_f32 v95, v73, v87
v_mfma_f32_16x16x32_bf16 a[64:67], v[240:243], v[128:131], a[64:67]
s_add_u32 s72, s71, 95232
buffer_load_dwordx4 v7, s[20:23], s72 offen offset:3072 lds
v_mfma_f32_16x16x32_bf16 a[64:67], v[244:247], v[132:135], a[64:67]
s_mov_b32 s80, 0x0
buffer_load_dword v126, v125, s[12:15], s80 offen
v_mfma_f32_16x16x32_bf16 a[68:71], v[244:247], v[140:143], a[68:71]
s_mov_b32 s80, 0x100000
buffer_load_dword v126, v125, s[12:15], s80 offen
v_mfma_f32_16x16x32_bf16 a[68:71], v[240:243], v[136:139], a[68:71]
s_mov_b32 s80, 0x200000
buffer_load_dword v126, v125, s[12:15], s80 offen
v_mfma_f32_16x16x32_bf16 a[72:75], v[240:243], v[144:147], a[72:75]
s_mov_b32 s80, 0x300000
buffer_load_dword v126, v125, s[12:15], s80 offen
v_mfma_f32_16x16x32_bf16 a[72:75], v[244:247], v[148:151], a[72:75]
ds_read_b64_tr_b16 v[224:225], v20 offset:16384
v_fmac_f32 v95, v72, v88
v_mfma_f32_16x16x32_bf16 a[76:79], v[244:247], v[156:159], a[76:79]
v_mul_f32 v95, v95, v97
v_mul_f32 v96, v75, v84
v_mfma_f32_16x16x32_bf16 a[76:79], v[240:243], v[152:155], a[76:79]
ds_read_b64_tr_b16 v[226:227], v20 offset:17408
v_lshlrev_b32 v97, 16, v60
v_mfma_f32_16x16x32_bf16 a[80:83], v[240:243], v[160:163], a[80:83]
v_fmac_f32 v96, v74, v85
v_fmac_f32 v96, v73, v86
v_mfma_f32_16x16x32_bf16 a[80:83], v[244:247], v[164:167], a[80:83]
ds_read_b64_tr_b16 v[228:229], v20 offset:24576
v_fmac_f32 v96, v72, v87
v_mfma_f32_16x16x32_bf16 a[84:87], v[244:247], v[172:175], a[84:87]
v_mul_f32 v96, v96, v97
v_cvt_pk_bf16_f32 v103, v95, v96
v_mfma_f32_16x16x32_bf16 a[84:87], v[240:243], v[168:171], a[84:87]
ds_read_b64_tr_b16 v[230:231], v20 offset:25600
ds_write_b128 v28, v[100:103] offset:0
v_mfma_f32_16x16x32_bf16 a[88:91], v[240:243], v[176:179], a[88:91]
v_mul_f32 v95, v75, v83
v_lshlrev_b32 v97, 16, v59
v_mfma_f32_16x16x32_bf16 a[88:91], v[244:247], v[180:183], a[88:91]
v_fmac_f32 v95, v74, v84
v_fmac_f32 v95, v73, v85
v_mfma_f32_16x16x32_bf16 a[92:95], v[244:247], v[188:191], a[92:95]
v_fmac_f32 v95, v72, v86
v_mul_f32 v95, v95, v97
v_mfma_f32_16x16x32_bf16 a[92:95], v[240:243], v[184:187], a[92:95]
s_waitcnt lgkmcnt(5)
v_mul_f32 v96, v75, v82
v_lshlrev_b32 v97, 16, v58
v_mfma_f32_16x16x32_bf16 a[124:127], v[248:251], v[184:187], a[124:127]
ds_read_b64_tr_b16 v[232:233], v21 offset:16384
v_fmac_f32 v96, v74, v83
v_mfma_f32_16x16x32_bf16 a[124:127], v[252:255], v[188:191], a[124:127]
v_fmac_f32 v96, v73, v84
v_fmac_f32 v96, v72, v85
v_mfma_f32_16x16x32_bf16 a[120:123], v[252:255], v[180:183], a[120:123]
v_mul_f32 v96, v96, v97
v_cvt_pk_bf16_f32 v104, v95, v96
v_mfma_f32_16x16x32_bf16 a[120:123], v[248:251], v[176:179], a[120:123]
ds_read_b64_tr_b16 v[234:235], v21 offset:17408
v_mul_f32 v95, v75, v81
v_mfma_f32_16x16x32_bf16 a[116:119], v[248:251], v[168:171], a[116:119]
v_lshlrev_b32 v97, 16, v57
v_fmac_f32 v95, v74, v82
v_mfma_f32_16x16x32_bf16 a[116:119], v[252:255], v[172:175], a[116:119]
v_fmac_f32 v95, v73, v83
v_fmac_f32 v95, v72, v84
v_mfma_f32_16x16x32_bf16 a[112:115], v[252:255], v[164:167], a[112:115]
v_mul_f32 v95, v95, v97
v_mul_f32 v96, v75, v80
v_mfma_f32_16x16x32_bf16 a[112:115], v[248:251], v[160:163], a[112:115]
ds_read_b64_tr_b16 v[236:237], v21 offset:24576
v_lshlrev_b32 v97, 16, v56
v_mfma_f32_16x16x32_bf16 a[108:111], v[248:251], v[152:155], a[108:111]
v_fmac_f32 v96, v74, v81
v_fmac_f32 v96, v73, v82
v_mfma_f32_16x16x32_bf16 a[108:111], v[252:255], v[156:159], a[108:111]
v_fmac_f32 v96, v72, v83
v_mul_f32 v96, v96, v97
v_mfma_f32_16x16x32_bf16 a[104:107], v[252:255], v[148:151], a[104:107]
ds_read_b64_tr_b16 v[238:239], v21 offset:25600
v_cvt_pk_bf16_f32 v105, v95, v96
v_mfma_f32_16x16x32_bf16 a[104:107], v[248:251], v[144:147], a[104:107]
v_mul_f32 v95, v75, v79
v_lshlrev_b32 v97, 16, v55
v_mfma_f32_16x16x32_bf16 a[100:103], v[248:251], v[136:139], a[100:103]
v_fmac_f32 v95, v74, v80
v_fmac_f32 v95, v73, v81
v_mfma_f32_16x16x32_bf16 a[100:103], v[252:255], v[140:143], a[100:103]
v_fmac_f32 v95, v72, v82
v_mul_f32 v95, v95, v97
v_mfma_f32_16x16x32_bf16 a[96:99], v[252:255], v[132:135], a[96:99]
v_mul_f32 v96, v75, v78
v_lshlrev_b32 v97, 16, v54
v_mfma_f32_16x16x32_bf16 a[96:99], v[248:251], v[128:131], a[96:99]
s_waitcnt lgkmcnt(5)
v_fmac_f32 v96, v74, v79
v_fmac_f32 v96, v73, v80
v_mfma_f32_16x16x32_bf16 a[128:131], v[128:131], v[224:227], a[128:131]
ds_read_b64_tr_b16 v[240:241], v22 offset:16384
v_fmac_f32 v96, v72, v81
v_mfma_f32_16x16x32_bf16 a[128:131], v[132:135], v[228:231], a[128:131]
v_mul_f32 v96, v96, v97
v_cvt_pk_bf16_f32 v106, v95, v96
v_mfma_f32_16x16x32_bf16 a[132:135], v[140:143], v[228:231], a[132:135]
v_mul_f32 v95, v75, v77
v_lshlrev_b32 v97, 16, v53
v_mfma_f32_16x16x32_bf16 a[132:135], v[136:139], v[224:227], a[132:135]
ds_read_b64_tr_b16 v[242:243], v22 offset:17408
v_fmac_f32 v95, v74, v78
v_mfma_f32_16x16x32_bf16 a[136:139], v[144:147], v[224:227], a[136:139]
v_fmac_f32 v95, v73, v79
v_fmac_f32 v95, v72, v80
v_mfma_f32_16x16x32_bf16 a[136:139], v[148:151], v[228:231], a[136:139]
v_mul_f32 v95, v95, v97
v_mul_f32 v96, v75, v76
v_mfma_f32_16x16x32_bf16 a[140:143], v[156:159], v[228:231], a[140:143]
v_lshlrev_b32 v97, 16, v52
v_fmac_f32 v96, v74, v77
v_mfma_f32_16x16x32_bf16 a[140:143], v[152:155], v[224:227], a[140:143]
ds_read_b64_tr_b16 v[244:245], v22 offset:24576
v_fmac_f32 v96, v73, v78
v_mfma_f32_16x16x32_bf16 a[144:147], v[160:163], v[224:227], a[144:147]
v_fmac_f32 v96, v72, v79
v_mul_f32 v96, v96, v97
v_mfma_f32_16x16x32_bf16 a[144:147], v[164:167], v[228:231], a[144:147]
v_cvt_pk_bf16_f32 v107, v95, v96
v_mfma_f32_16x16x32_bf16 a[148:151], v[172:175], v[228:231], a[148:151]
ds_read_b64_tr_b16 v[246:247], v22 offset:25600
ds_write_b128 v28, v[104:107] offset:16
v_mfma_f32_16x16x32_bf16 a[148:151], v[168:171], v[224:227], a[148:151]
global_load_dwordx4 v[84:87], v1, s[56:57]
v_mfma_f32_16x16x32_bf16 a[152:155], v[176:179], v[224:227], a[152:155]
global_load_dwordx4 v[88:91], v1, s[56:57] offset:1024
v_mfma_f32_16x16x32_bf16 a[152:155], v[180:183], v[228:231], a[152:155]
v_lshlrev_b32 v72, 16, v70
v_and_b32 v73, 0xffff0000, v70
v_mfma_f32_16x16x32_bf16 a[156:159], v[188:191], v[228:231], a[156:159]
v_lshlrev_b32 v74, 16, v71
v_and_b32 v75, 0xffff0000, v71
v_mfma_f32_16x16x32_bf16 a[156:159], v[184:187], v[224:227], a[156:159]
s_waitcnt lgkmcnt(5)
v_and_b32 v33, 0xffff0000, v33
v_and_b32 v34, 0xffff0000, v34
v_mfma_f32_16x16x32_bf16 a[188:191], v[184:187], v[232:235], a[188:191]
ds_read_b64_tr_b16 v[248:249], v23 offset:16384
v_and_b32 v35, 0xffff0000, v35
v_mfma_f32_16x16x32_bf16 a[188:191], v[188:191], v[236:239], a[188:191]
v_and_b32 v36, 0xffff0000, v36
v_and_b32 v37, 0xffff0000, v37
v_mfma_f32_16x16x32_bf16 a[184:187], v[180:183], v[236:239], a[184:187]
ds_read_b64_tr_b16 v[250:251], v23 offset:17408
v_and_b32 v38, 0xffff0000, v38
v_mfma_f32_16x16x32_bf16 a[184:187], v[176:179], v[232:235], a[184:187]
v_and_b32 v39, 0xffff0000, v39
v_and_b32 v40, 0xffff0000, v40
v_mfma_f32_16x16x32_bf16 a[180:183], v[168:171], v[232:235], a[180:183]
ds_read_b64_tr_b16 v[252:253], v23 offset:24576
v_and_b32 v41, 0xffff0000, v41
v_mfma_f32_16x16x32_bf16 a[180:183], v[172:175], v[236:239], a[180:183]
v_and_b32 v42, 0xffff0000, v42
v_and_b32 v43, 0xffff0000, v43
v_mfma_f32_16x16x32_bf16 a[176:179], v[164:167], v[236:239], a[176:179]
ds_read_b64_tr_b16 v[254:255], v23 offset:25600
v_and_b32 v44, 0xffff0000, v44
v_mfma_f32_16x16x32_bf16 a[176:179], v[160:163], v[232:235], a[176:179]
v_and_b32 v45, 0xffff0000, v45
v_and_b32 v46, 0xffff0000, v46
v_mfma_f32_16x16x32_bf16 a[172:175], v[152:155], v[232:235], a[172:175]
v_and_b32 v47, 0xffff0000, v47
v_and_b32 v48, 0xffff0000, v48
v_mfma_f32_16x16x32_bf16 a[172:175], v[156:159], v[236:239], a[172:175]
v_and_b32 v49, 0xffff0000, v49
v_and_b32 v50, 0xffff0000, v50
v_mfma_f32_16x16x32_bf16 a[168:171], v[148:151], v[236:239], a[168:171]
v_and_b32 v51, 0xffff0000, v51
v_mul_f32 v95, v75, v48
v_mfma_f32_16x16x32_bf16 a[168:171], v[144:147], v[232:235], a[168:171]
v_and_b32 v97, 0xffff0000, v67
v_fmac_f32 v95, v74, v49
v_mfma_f32_16x16x32_bf16 a[164:167], v[136:139], v[232:235], a[164:167]
v_fmac_f32 v95, v73, v50
v_fmac_f32 v95, v72, v51
v_mfma_f32_16x16x32_bf16 a[164:167], v[140:143], v[236:239], a[164:167]
v_mul_f32 v95, v95, v97
v_mul_f32 v96, v75, v47
v_mfma_f32_16x16x32_bf16 a[160:163], v[132:135], v[236:239], a[160:163]
s_waitcnt vmcnt(6) lgkmcnt(0)
v_and_b32 v97, 0xffff0000, v66
v_fmac_f32 v96, v74, v48
v_mfma_f32_16x16x32_bf16 a[160:163], v[128:131], v[232:235], a[160:163]
s_barrier
v_fmac_f32 v96, v73, v49
v_fmac_f32 v96, v72, v50
v_mfma_f32_16x16x32_bf16 a[192:195], v[128:131], v[240:243], a[192:195]
s_and_b32 s73, s65, 1
ds_read_b64_tr_b16 v[224:225], v20 offset:32768
v_mul_f32 v96, v96, v97
v_mfma_f32_16x16x32_bf16 a[192:195], v[132:135], v[244:247], a[192:195]
s_xor_b32 s73, s73, 6
ds_read_b64_tr_b16 v[226:227], v20 offset:33792
v_cvt_pk_bf16_f32 v100, v95, v96
v_mfma_f32_16x16x32_bf16 a[196:199], v[140:143], v[244:247], a[196:199]
s_lshl_b32 s69, s73, 7
ds_read_b64_tr_b16 v[228:229], v20 offset:40960
v_mul_f32 v95, v75, v46
v_mfma_f32_16x16x32_bf16 a[196:199], v[136:139], v[240:243], a[196:199]
s_add_u32 s69, s69, s84
ds_read_b64_tr_b16 v[230:231], v20 offset:41984
v_and_b32 v97, 0xffff0000, v65
v_mfma_f32_16x16x32_bf16 a[200:203], v[144:147], v[240:243], a[200:203]
s_lshl_b32 s71, s73, 19
ds_read_b128 v[192:195], v24 offset:32768
v_fmac_f32 v95, v74, v47
v_mfma_f32_16x16x32_bf16 a[200:203], v[148:151], v[244:247], a[200:203]
s_add_u32 s71, s71, s66
ds_read_b128 v[196:199], v25 offset:32768
v_fmac_f32 v95, v73, v48
v_mfma_f32_16x16x32_bf16 a[204:207], v[156:159], v[244:247], a[204:207]
s_add_u32 m0, s63, 65536
v_fmac_f32 v95, v72, v49
v_mul_f32 v95, v95, v97
v_mfma_f32_16x16x32_bf16 a[204:207], v[152:155], v[240:243], a[204:207]
s_add_u32 s72, s69, 0
buffer_load_dwordx4 v2, s[8:11], s72 offen lds
v_mfma_f32_16x16x32_bf16 a[208:211], v[160:163], v[240:243], a[208:211]
s_add_u32 s72, s69, 7168
buffer_load_dwordx4 v3, s[8:11], s72 offen offset:1024 lds
v_mfma_f32_16x16x32_bf16 a[208:211], v[164:167], v[244:247], a[208:211]
s_add_u32 s72, s69, 14336
buffer_load_dwordx4 v2, s[8:11], s72 offen offset:2048 lds
v_mfma_f32_16x16x32_bf16 a[212:215], v[172:175], v[244:247], a[212:215]
ds_read_b128 v[200:203], v24 offset:34816
v_mul_f32 v96, v75, v45
v_mfma_f32_16x16x32_bf16 a[212:215], v[168:171], v[240:243], a[212:215]
ds_read_b128 v[204:207], v25 offset:34816
v_and_b32 v97, 0xffff0000, v64
v_mfma_f32_16x16x32_bf16 a[216:219], v[176:179], v[240:243], a[216:219]
s_add_u32 s72, s69, 21504
buffer_load_dwordx4 v3, s[8:11], s72 offen offset:3072 lds
v_mfma_f32_16x16x32_bf16 a[216:219], v[180:183], v[244:247], a[216:219]
ds_read_b128 v[208:211], v24 offset:36864
v_fmac_f32 v96, v74, v46
v_mfma_f32_16x16x32_bf16 a[220:223], v[188:191], v[244:247], a[220:223]
ds_read_b128 v[212:215], v25 offset:36864
v_fmac_f32 v96, v73, v47
v_mfma_f32_16x16x32_bf16 a[220:223], v[184:187], v[240:243], a[220:223]
ds_read_b128 v[216:219], v24 offset:38912
v_fmac_f32 v96, v72, v48
v_mfma_f32_16x16x32_bf16 a[252:255], v[184:187], v[248:251], a[252:255]
ds_read_b128 v[220:223], v25 offset:38912
v_mul_f32 v96, v96, v97
v_mfma_f32_16x16x32_bf16 a[252:255], v[188:191], v[252:255], a[252:255]
s_add_u32 m0, s64, 0
v_cvt_pk_bf16_f32 v101, v95, v96
v_mul_f32 v95, v75, v44
v_mfma_f32_16x16x32_bf16 a[248:251], v[180:183], v[252:255], a[248:251]
s_add_u32 s72, s71, 0
buffer_load_dwordx4 v6, s[16:19], s72 offen lds
v_mfma_f32_16x16x32_bf16 a[248:251], v[176:179], v[248:251], a[248:251]
ds_read_b128 v[184:187], v24 offset:40960
v_and_b32 v97, 0xffff0000, v63
v_mfma_f32_16x16x32_bf16 a[244:247], v[168:171], v[248:251], a[244:247]
ds_read_b128 v[188:191], v25 offset:40960
v_fmac_f32 v95, v74, v45
v_mfma_f32_16x16x32_bf16 a[244:247], v[172:175], v[252:255], a[244:247]
s_add_u32 s72, s71, 31744
buffer_load_dwordx4 v6, s[16:19], s72 offen offset:1024 lds
v_mfma_f32_16x16x32_bf16 a[240:243], v[164:167], v[252:255], a[240:243]
ds_read_b128 v[176:179], v24 offset:43008
v_fmac_f32 v95, v73, v46
v_mfma_f32_16x16x32_bf16 a[240:243], v[160:163], v[248:251], a[240:243]
ds_read_b128 v[180:183], v25 offset:43008
v_fmac_f32 v95, v72, v47
v_mfma_f32_16x16x32_bf16 a[236:239], v[152:155], v[248:251], a[236:239]
ds_read_b128 v[168:171], v24 offset:45056
v_mul_f32 v95, v95, v97
v_mfma_f32_16x16x32_bf16 a[236:239], v[156:159], v[252:255], a[236:239]
s_add_u32 s72, s71, 63488
buffer_load_dwordx4 v7, s[16:19], s72 offen offset:2048 lds
v_mfma_f32_16x16x32_bf16 a[232:235], v[148:151], v[252:255], a[232:235]
ds_read_b128 v[172:175], v25 offset:45056
v_mul_f32 v96, v75, v43
v_mfma_f32_16x16x32_bf16 a[232:235], v[144:147], v[248:251], a[232:235]
ds_read_b128 v[160:163], v24 offset:47104
v_and_b32 v97, 0xffff0000, v62
v_mfma_f32_16x16x32_bf16 a[228:231], v[136:139], v[248:251], a[228:231]
ds_read_b128 v[164:167], v25 offset:47104
v_fmac_f32 v96, v74, v44
v_mfma_f32_16x16x32_bf16 a[228:231], v[140:143], v[252:255], a[228:231]
v_fmac_f32 v96, v73, v45
v_fmac_f32 v96, v72, v46
v_mfma_f32_16x16x32_bf16 a[224:227], v[132:135], v[252:255], a[224:227]
s_add_u32 s72, s71, 95232
buffer_load_dwordx4 v7, s[16:19], s72 offen offset:3072 lds
v_mfma_f32_16x16x32_bf16 a[224:227], v[128:131], v[248:251], a[224:227]
s_waitcnt lgkmcnt(8)
ds_read_b64_tr_b16 v[232:233], v21 offset:32768
v_mul_f32 v96, v96, v97
v_mfma_f32_16x16x32_bf16 a[0:3], v[224:227], v[192:195], a[0:3]
ds_read_b64_tr_b16 v[234:235], v21 offset:33792
v_cvt_pk_bf16_f32 v102, v95, v96
v_mfma_f32_16x16x32_bf16 a[0:3], v[228:231], v[196:199], a[0:3]
ds_read_b64_tr_b16 v[240:241], v22 offset:32768
v_mul_f32 v95, v75, v42
v_mfma_f32_16x16x32_bf16 a[4:7], v[228:231], v[204:207], a[4:7]
s_add_u32 m0, s63, 69632
ds_read_b64_tr_b16 v[236:237], v21 offset:40960
v_and_b32 v97, 0xffff0000, v61
v_mfma_f32_16x16x32_bf16 a[4:7], v[224:227], v[200:203], a[4:7]
s_add_u32 s72, s69, 32768
buffer_load_dwordx4 v2, s[8:11], s72 offen lds
v_mfma_f32_16x16x32_bf16 a[8:11], v[224:227], v[208:211], a[8:11]
ds_read_b64_tr_b16 v[238:239], v21 offset:41984
v_fmac_f32 v95, v74, v43
v_mfma_f32_16x16x32_bf16 a[8:11], v[228:231], v[212:215], a[8:11]
v_fmac_f32 v95, v73, v44
v_fmac_f32 v95, v72, v45
v_mfma_f32_16x16x32_bf16 a[12:15], v[228:231], v[220:223], a[12:15]
s_add_u32 s72, s69, 39936
buffer_load_dwordx4 v3, s[8:11], s72 offen offset:1024 lds
v_mfma_f32_16x16x32_bf16 a[12:15], v[224:227], v[216:219], a[12:15]
s_waitcnt lgkmcnt(5)
ds_read_b64_tr_b16 v[242:243], v22 offset:33792
v_mul_f32 v95, v95, v97
v_mfma_f32_16x16x32_bf16 a[16:19], v[224:227], v[184:187], a[16:19]
v_mul_f32 v96, v75, v41
v_and_b32 v97, 0xffff0000, v60
v_mfma_f32_16x16x32_bf16 a[16:19], v[228:231], v[188:191], a[16:19]
ds_read_b64_tr_b16 v[244:245], v22 offset:40960
v_fmac_f32 v96, v74, v42
v_mfma_f32_16x16x32_bf16 a[20:23], v[228:231], v[180:183], a[20:23]
v_fmac_f32 v96, v73, v43
v_fmac_f32 v96, v72, v44
v_mfma_f32_16x16x32_bf16 a[20:23], v[224:227], v[176:179], a[20:23]
s_add_u32 s72, s69, 47104
buffer_load_dwordx4 v2, s[8:11], s72 offen offset:2048 lds
v_mfma_f32_16x16x32_bf16 a[24:27], v[224:227], v[168:171], a[24:27]
ds_read_b64_tr_b16 v[246:247], v22 offset:41984
v_mul_f32 v96, v96, v97
v_mfma_f32_16x16x32_bf16 a[24:27], v[228:231], v[172:175], a[24:27]
v_cvt_pk_bf16_f32 v103, v95, v96
v_mfma_f32_16x16x32_bf16 a[28:31], v[228:231], v[164:167], a[28:31]
ds_write_b128 v28, v[100:103] offset:272
v_mul_f32 v95, v75, v40
v_mfma_f32_16x16x32_bf16 a[28:31], v[224:227], v[160:163], a[28:31]
s_waitcnt lgkmcnt(4)
v_and_b32 v97, 0xffff0000, v59
v_fmac_f32 v95, v74, v41
v_mfma_f32_16x16x32_bf16 a[60:63], v[232:235], v[160:163], a[60:63]
s_add_u32 s72, s69, 54272
buffer_load_dwordx4 v3, s[8:11], s72 offen offset:3072 lds
v_mfma_f32_16x16x32_bf16 a[60:63], v[236:239], v[164:167], a[60:63]
ds_read_b64_tr_b16 v[248:249], v23 offset:32768
v_fmac_f32 v95, v73, v42
v_mfma_f32_16x16x32_bf16 a[56:59], v[236:239], v[172:175], a[56:59]
v_fmac_f32 v95, v72, v43
v_mul_f32 v95, v95, v97
v_mfma_f32_16x16x32_bf16 a[56:59], v[232:235], v[168:171], a[56:59]
s_add_u32 m0, s64, 16384
ds_read_b64_tr_b16 v[250:251], v23 offset:33792
v_mul_f32 v96, v75, v39
v_mfma_f32_16x16x32_bf16 a[52:55], v[232:235], v[176:179], a[52:55]
s_add_u32 s72, s71, 0
buffer_load_dwordx4 v6, s[20:23], s72 offen lds
v_mfma_f32_16x16x32_bf16 a[52:55], v[236:239], v[180:183], a[52:55]
v_and_b32 v97, 0xffff0000, v58
v_fmac_f32 v96, v74, v40
v_mfma_f32_16x16x32_bf16 a[48:51], v[236:239], v[188:191], a[48:51]
v_fmac_f32 v96, v73, v41
v_fmac_f32 v96, v72, v42
v_mfma_f32_16x16x32_bf16 a[48:51], v[232:235], v[184:187], a[48:51]
ds_read_b64_tr_b16 v[252:253], v23 offset:40960
v_mul_f32 v96, v96, v97
v_mfma_f32_16x16x32_bf16 a[44:47], v[232:235], v[216:219], a[44:47]
s_add_u32 s72, s71, 31744
buffer_load_dwordx4 v6, s[20:23], s72 offen offset:1024 lds
v_mfma_f32_16x16x32_bf16 a[44:47], v[236:239], v[220:223], a[44:47]
v_cvt_pk_bf16_f32 v104, v95, v96
v_mul_f32 v95, v75, v38
v_mfma_f32_16x16x32_bf16 a[40:43], v[236:239], v[212:215], a[40:43]
ds_read_b64_tr_b16 v[254:255], v23 offset:41984
v_and_b32 v97, 0xffff0000, v57
v_mfma_f32_16x16x32_bf16 a[40:43], v[232:235], v[208:211], a[40:43]
v_fmac_f32 v95, v74, v39
v_fmac_f32 v95, v73, v40
v_mfma_f32_16x16x32_bf16 a[36:39], v[232:235], v[200:203], a[36:39]
s_add_u32 s72, s71, 63488
buffer_load_dwordx4 v7, s[20:23], s72 offen offset:2048 lds
v_mfma_f32_16x16x32_bf16 a[36:39], v[236:239], v[204:207], a[36:39]
v_fmac_f32 v95, v72, v41
v_mul_f32 v95, v95, v97
v_mfma_f32_16x16x32_bf16 a[32:35], v[236:239], v[196:199], a[32:35]
v_mul_f32 v96, v75, v37
v_and_b32 v97, 0xffff0000, v56
v_mfma_f32_16x16x32_bf16 a[32:35], v[232:235], v[192:195], a[32:35]
s_waitcnt lgkmcnt(5)
v_fmac_f32 v96, v74, v38
v_fmac_f32 v96, v73, v39
v_mfma_f32_16x16x32_bf16 a[64:67], v[240:243], v[192:195], a[64:67]
s_add_u32 s72, s71, 95232
buffer_load_dwordx4 v7, s[20:23], s72 offen offset:3072 lds
v_mfma_f32_16x16x32_bf16 a[64:67], v[244:247], v[196:199], a[64:67]
s_mov_b32 s80, 0x400000
buffer_load_dword v126, v125, s[12:15], s80 offen
v_mfma_f32_16x16x32_bf16 a[68:71], v[244:247], v[204:207], a[68:71]
s_mov_b32 s80, 0x500000
buffer_load_dword v126, v125, s[12:15], s80 offen
v_mfma_f32_16x16x32_bf16 a[68:71], v[240:243], v[200:203], a[68:71]
s_mov_b32 s80, 0x600000
buffer_load_dword v126, v125, s[12:15], s80 offen
v_mfma_f32_16x16x32_bf16 a[72:75], v[240:243], v[208:211], a[72:75]
s_mov_b32 s80, 0x700000
buffer_load_dword v126, v125, s[12:15], s80 offen
v_mfma_f32_16x16x32_bf16 a[72:75], v[244:247], v[212:215], a[72:75]
ds_read_b64_tr_b16 v[224:225], v20 offset:49152
v_fmac_f32 v96, v72, v40
v_mfma_f32_16x16x32_bf16 a[76:79], v[244:247], v[220:223], a[76:79]
v_mul_f32 v96, v96, v97
v_cvt_pk_bf16_f32 v105, v95, v96
v_mfma_f32_16x16x32_bf16 a[76:79], v[240:243], v[216:219], a[76:79]
ds_read_b64_tr_b16 v[226:227], v20 offset:50176
v_mul_f32 v95, v75, v36
v_mfma_f32_16x16x32_bf16 a[80:83], v[240:243], v[184:187], a[80:83]
v_and_b32 v97, 0xffff0000, v55
v_fmac_f32 v95, v74, v37
v_mfma_f32_16x16x32_bf16 a[80:83], v[244:247], v[188:191], a[80:83]
ds_read_b64_tr_b16 v[228:229], v20 offset:57344
v_fmac_f32 v95, v73, v38
v_mfma_f32_16x16x32_bf16 a[84:87], v[244:247], v[180:183], a[84:87]
v_fmac_f32 v95, v72, v39
v_mul_f32 v95, v95, v97
v_mfma_f32_16x16x32_bf16 a[84:87], v[240:243], v[176:179], a[84:87]
ds_read_b64_tr_b16 v[230:231], v20 offset:58368
v_mul_f32 v96, v75, v35
v_mfma_f32_16x16x32_bf16 a[88:91], v[240:243], v[168:171], a[88:91]
v_and_b32 v97, 0xffff0000, v54
v_fmac_f32 v96, v74, v36
v_mfma_f32_16x16x32_bf16 a[88:91], v[244:247], v[172:175], a[88:91]
v_fmac_f32 v96, v73, v37
v_fmac_f32 v96, v72, v38
v_mfma_f32_16x16x32_bf16 a[92:95], v[244:247], v[164:167], a[92:95]
v_mul_f32 v96, v96, v97
v_cvt_pk_bf16_f32 v106, v95, v96
v_mfma_f32_16x16x32_bf16 a[92:95], v[240:243], v[160:163], a[92:95]
s_waitcnt lgkmcnt(4)
v_mul_f32 v95, v75, v34
v_and_b32 v97, 0xffff0000, v53
v_mfma_f32_16x16x32_bf16 a[124:127], v[248:251], v[160:163], a[124:127]
ds_read_b64_tr_b16 v[232:233], v21 offset:49152
v_fmac_f32 v95, v74, v35
v_mfma_f32_16x16x32_bf16 a[124:127], v[252:255], v[164:167], a[124:127]
v_fmac_f32 v95, v73, v36
v_fmac_f32 v95, v72, v37
v_mfma_f32_16x16x32_bf16 a[120:123], v[252:255], v[172:175], a[120:123]
v_mul_f32 v95, v95, v97
v_mul_f32 v96, v75, v33
v_mfma_f32_16x16x32_bf16 a[120:123], v[248:251], v[168:171], a[120:123]
ds_read_b64_tr_b16 v[234:235], v21 offset:50176
v_and_b32 v97, 0xffff0000, v52
v_mfma_f32_16x16x32_bf16 a[116:119], v[248:251], v[176:179], a[116:119]
v_fmac_f32 v96, v74, v34
v_fmac_f32 v96, v73, v35
v_mfma_f32_16x16x32_bf16 a[116:119], v[252:255], v[180:183], a[116:119]
v_fmac_f32 v96, v72, v36
v_mul_f32 v96, v96, v97
v_mfma_f32_16x16x32_bf16 a[112:115], v[252:255], v[188:191], a[112:115]
v_cvt_pk_bf16_f32 v107, v95, v96
v_mfma_f32_16x16x32_bf16 a[112:115], v[248:251], v[184:187], a[112:115]
ds_read_b64_tr_b16 v[236:237], v21 offset:57344
ds_write_b128 v28, v[104:107] offset:288
v_mfma_f32_16x16x32_bf16 a[108:111], v[248:251], v[216:219], a[108:111]
v_mfma_f32_16x16x32_bf16 a[108:111], v[252:255], v[220:223], a[108:111]
v_mfma_f32_16x16x32_bf16 a[104:107], v[252:255], v[212:215], a[104:107]
ds_read_b64_tr_b16 v[238:239], v21 offset:58368
v_mfma_f32_16x16x32_bf16 a[104:107], v[248:251], v[208:211], a[104:107]
v_mfma_f32_16x16x32_bf16 a[100:103], v[248:251], v[200:203], a[100:103]
v_mfma_f32_16x16x32_bf16 a[100:103], v[252:255], v[204:207], a[100:103]
v_mfma_f32_16x16x32_bf16 a[96:99], v[252:255], v[196:199], a[96:99]
v_mfma_f32_16x16x32_bf16 a[96:99], v[248:251], v[192:195], a[96:99]
s_waitcnt lgkmcnt(5)
v_mfma_f32_16x16x32_bf16 a[128:131], v[192:195], v[224:227], a[128:131]
ds_read_b64_tr_b16 v[240:241], v22 offset:49152
v_mfma_f32_16x16x32_bf16 a[128:131], v[196:199], v[228:231], a[128:131]
v_mfma_f32_16x16x32_bf16 a[132:135], v[204:207], v[228:231], a[132:135]
v_mfma_f32_16x16x32_bf16 a[132:135], v[200:203], v[224:227], a[132:135]
ds_read_b64_tr_b16 v[242:243], v22 offset:50176
v_mfma_f32_16x16x32_bf16 a[136:139], v[208:211], v[224:227], a[136:139]
v_mfma_f32_16x16x32_bf16 a[136:139], v[212:215], v[228:231], a[136:139]
v_mfma_f32_16x16x32_bf16 a[140:143], v[220:223], v[228:231], a[140:143]
v_mfma_f32_16x16x32_bf16 a[140:143], v[216:219], v[224:227], a[140:143]
ds_read_b64_tr_b16 v[244:245], v22 offset:57344
v_mfma_f32_16x16x32_bf16 a[144:147], v[184:187], v[224:227], a[144:147]
v_mfma_f32_16x16x32_bf16 a[144:147], v[188:191], v[228:231], a[144:147]
v_mfma_f32_16x16x32_bf16 a[148:151], v[180:183], v[228:231], a[148:151]
ds_read_b64_tr_b16 v[246:247], v22 offset:58368
v_mfma_f32_16x16x32_bf16 a[148:151], v[176:179], v[224:227], a[148:151]
v_mfma_f32_16x16x32_bf16 a[152:155], v[168:171], v[224:227], a[152:155]
v_mfma_f32_16x16x32_bf16 a[152:155], v[172:175], v[228:231], a[152:155]
v_mfma_f32_16x16x32_bf16 a[156:159], v[164:167], v[228:231], a[156:159]
v_mfma_f32_16x16x32_bf16 a[156:159], v[160:163], v[224:227], a[156:159]
s_waitcnt lgkmcnt(4)
v_mfma_f32_16x16x32_bf16 a[188:191], v[160:163], v[232:235], a[188:191]
ds_read_b64_tr_b16 v[248:249], v23 offset:49152
v_mfma_f32_16x16x32_bf16 a[188:191], v[164:167], v[236:239], a[188:191]
v_mfma_f32_16x16x32_bf16 a[184:187], v[172:175], v[236:239], a[184:187]
ds_read_b64_tr_b16 v[250:251], v23 offset:50176
v_mfma_f32_16x16x32_bf16 a[184:187], v[168:171], v[232:235], a[184:187]
v_mfma_f32_16x16x32_bf16 a[180:183], v[176:179], v[232:235], a[180:183]
ds_read_b64_tr_b16 v[252:253], v23 offset:57344
v_mfma_f32_16x16x32_bf16 a[180:183], v[180:183], v[236:239], a[180:183]
v_mfma_f32_16x16x32_bf16 a[176:179], v[188:191], v[236:239], a[176:179]
ds_read_b64_tr_b16 v[254:255], v23 offset:58368
v_mfma_f32_16x16x32_bf16 a[176:179], v[184:187], v[232:235], a[176:179]
v_mfma_f32_16x16x32_bf16 a[172:175], v[216:219], v[232:235], a[172:175]
v_mfma_f32_16x16x32_bf16 a[172:175], v[220:223], v[236:239], a[172:175]
v_mfma_f32_16x16x32_bf16 a[168:171], v[212:215], v[236:239], a[168:171]
v_mfma_f32_16x16x32_bf16 a[168:171], v[208:211], v[232:235], a[168:171]
v_mfma_f32_16x16x32_bf16 a[164:167], v[200:203], v[232:235], a[164:167]
v_mfma_f32_16x16x32_bf16 a[164:167], v[204:207], v[236:239], a[164:167]
v_mfma_f32_16x16x32_bf16 a[160:163], v[196:199], v[236:239], a[160:163]
s_waitcnt vmcnt(4) lgkmcnt(0)
v_mfma_f32_16x16x32_bf16 a[160:163], v[192:195], v[232:235], a[160:163]
s_barrier
v_mfma_f32_16x16x32_bf16 a[192:195], v[192:195], v[240:243], a[192:195]
s_and_b32 s73, s65, 1
ds_read_b64_tr_b16 v[224:225], v20 offset:0
v_mfma_f32_16x16x32_bf16 a[192:195], v[196:199], v[244:247], a[192:195]
s_xor_b32 s73, s73, 7
ds_read_b64_tr_b16 v[226:227], v20 offset:1024
v_mfma_f32_16x16x32_bf16 a[196:199], v[204:207], v[244:247], a[196:199]
s_lshl_b32 s69, s73, 7
ds_read_b64_tr_b16 v[228:229], v20 offset:8192
v_mfma_f32_16x16x32_bf16 a[196:199], v[200:203], v[240:243], a[196:199]
s_add_u32 s69, s69, s84
ds_read_b64_tr_b16 v[230:231], v20 offset:9216
v_mfma_f32_16x16x32_bf16 a[200:203], v[208:211], v[240:243], a[200:203]
s_lshl_b32 s71, s73, 19
ds_read_b128 v[128:131], v24 offset:0
v_mfma_f32_16x16x32_bf16 a[200:203], v[212:215], v[244:247], a[200:203]
s_add_u32 s71, s71, s66
ds_read_b128 v[132:135], v25 offset:0
v_mfma_f32_16x16x32_bf16 a[204:207], v[220:223], v[244:247], a[204:207]
s_add_u32 m0, s63, 98304
v_mfma_f32_16x16x32_bf16 a[204:207], v[216:219], v[240:243], a[204:207]
s_add_u32 s72, s69, 0
buffer_load_dwordx4 v2, s[8:11], s72 offen lds
v_mfma_f32_16x16x32_bf16 a[208:211], v[184:187], v[240:243], a[208:211]
s_add_u32 s72, s69, 7168
buffer_load_dwordx4 v3, s[8:11], s72 offen offset:1024 lds
v_mfma_f32_16x16x32_bf16 a[208:211], v[188:191], v[244:247], a[208:211]
s_add_u32 s72, s69, 14336
buffer_load_dwordx4 v2, s[8:11], s72 offen offset:2048 lds
v_mfma_f32_16x16x32_bf16 a[212:215], v[180:183], v[244:247], a[212:215]
s_mul_i32 s74, s58, 4352
ds_read_b128 v[136:139], v24 offset:2048
v_mfma_f32_16x16x32_bf16 a[212:215], v[176:179], v[240:243], a[212:215]
s_add_u32 s74, s74, 131072
ds_read_b128 v[140:143], v25 offset:2048
v_lshrrev_b32 v26, 4, v0
v_mfma_f32_16x16x32_bf16 a[216:219], v[168:171], v[240:243], a[216:219]
s_add_u32 s72, s69, 21504
buffer_load_dwordx4 v3, s[8:11], s72 offen offset:3072 lds
v_mfma_f32_16x16x32_bf16 a[216:219], v[172:175], v[244:247], a[216:219]
ds_read_b128 v[144:147], v24 offset:4096
v_and_b32 v27, 15, v0
v_mfma_f32_16x16x32_bf16 a[220:223], v[164:167], v[244:247], a[220:223]
ds_read_b128 v[148:151], v25 offset:4096
v_lshlrev_b32 v27, 4, v27
v_mfma_f32_16x16x32_bf16 a[220:223], v[160:163], v[240:243], a[220:223]
ds_read_b128 v[152:155], v24 offset:6144
v_mul_u32_u24 v28, 272, v26
v_mfma_f32_16x16x32_bf16 a[252:255], v[160:163], v[248:251], a[252:255]
ds_read_b128 v[156:159], v25 offset:6144
v_add3_u32 v28, v28, v27, s74
v_mfma_f32_16x16x32_bf16 a[252:255], v[164:167], v[252:255], a[252:255]
s_add_u32 m0, s64, 32768
v_lshl_add_u32 v26, v26, 12, v27
v_mfma_f32_16x16x32_bf16 a[248:251], v[172:175], v[252:255], a[248:251]
s_add_u32 s72, s71, 0
buffer_load_dwordx4 v6, s[16:19], s72 offen lds
v_mfma_f32_16x16x32_bf16 a[248:251], v[168:171], v[248:251], a[248:251]
ds_read_b128 v[160:163], v24 offset:8192
ds_read_b128 v[36:39], v28 offset:0
v_mfma_f32_16x16x32_bf16 a[244:247], v[176:179], v[248:251], a[244:247]
ds_read_b128 v[164:167], v25 offset:8192
ds_read_b128 v[40:43], v28 offset:1088
v_mfma_f32_16x16x32_bf16 a[244:247], v[180:183], v[252:255], a[244:247]
s_add_u32 s72, s71, 31744
buffer_load_dwordx4 v6, s[16:19], s72 offen offset:1024 lds
v_mfma_f32_16x16x32_bf16 a[240:243], v[188:191], v[252:255], a[240:243]
ds_read_b128 v[168:171], v24 offset:10240
ds_read_b128 v[44:47], v28 offset:2176
v_mfma_f32_16x16x32_bf16 a[240:243], v[184:187], v[248:251], a[240:243]
ds_read_b128 v[172:175], v25 offset:10240
ds_read_b128 v[48:51], v28 offset:3264
v_mfma_f32_16x16x32_bf16 a[236:239], v[216:219], v[248:251], a[236:239]
s_and_b32 s74, s2, 15
ds_read_b128 v[176:179], v24 offset:12288
v_mfma_f32_16x16x32_bf16 a[236:239], v[220:223], v[252:255], a[236:239]
s_add_u32 s72, s71, 63488
buffer_load_dwordx4 v7, s[16:19], s72 offen offset:2048 lds
v_mfma_f32_16x16x32_bf16 a[232:235], v[212:215], v[252:255], a[232:235]
s_lshl_b32 s74, s74, 2
ds_read_b128 v[180:183], v25 offset:12288
v_mfma_f32_16x16x32_bf16 a[232:235], v[208:211], v[248:251], a[232:235]
s_add_u32 s74, s74, s58
ds_read_b128 v[184:187], v24 offset:14336
v_mfma_f32_16x16x32_bf16 a[228:231], v[200:203], v[248:251], a[228:231]
s_lshl_b32 s74, s74, 16
ds_read_b128 v[188:191], v25 offset:14336
v_mfma_f32_16x16x32_bf16 a[228:231], v[204:207], v[252:255], a[228:231]
s_lshr_b32 s75, s2, 4
v_mfma_f32_16x16x32_bf16 a[224:227], v[196:199], v[252:255], a[224:227]
s_add_u32 s72, s71, 95232
buffer_load_dwordx4 v7, s[16:19], s72 offen offset:3072 lds
v_mfma_f32_16x16x32_bf16 a[224:227], v[192:195], v[248:251], a[224:227]
s_waitcnt lgkmcnt(12)
ds_read_b64_tr_b16 v[232:233], v21 offset:0
v_mfma_f32_16x16x32_bf16 a[0:3], v[224:227], v[128:131], a[0:3]
s_lshl_b32 s75, s75, 8
ds_read_b64_tr_b16 v[234:235], v21 offset:1024
v_mfma_f32_16x16x32_bf16 a[0:3], v[228:231], v[132:135], a[0:3]
s_sub_u32 s74, s74, s75
ds_read_b64_tr_b16 v[240:241], v22 offset:0
v_mfma_f32_16x16x32_bf16 a[4:7], v[228:231], v[140:143], a[4:7]
s_add_u32 m0, s63, 102400
ds_read_b64_tr_b16 v[236:237], v21 offset:8192
v_mfma_f32_16x16x32_bf16 a[4:7], v[224:227], v[136:139], a[4:7]
s_add_u32 s72, s69, 32768
buffer_load_dwordx4 v2, s[8:11], s72 offen lds
v_mfma_f32_16x16x32_bf16 a[8:11], v[224:227], v[144:147], a[8:11]
s_add_u32 s74, s74, 0x3000f00
ds_read_b64_tr_b16 v[238:239], v21 offset:9216
v_mfma_f32_16x16x32_bf16 a[8:11], v[228:231], v[148:151], a[8:11]
s_waitcnt vmcnt(29)
v_lshlrev_b32 v78, 16, v84
v_lshlrev_b32 v79, 16, v108
v_mfma_f32_16x16x32_bf16 a[12:15], v[228:231], v[156:159], a[12:15]
s_add_u32 s72, s69, 39936
buffer_load_dwordx4 v3, s[8:11], s72 offen offset:1024 lds
v_mfma_f32_16x16x32_bf16 a[12:15], v[224:227], v[152:155], a[12:15]
s_waitcnt lgkmcnt(5)
ds_read_b64_tr_b16 v[242:243], v22 offset:1024
v_mul_f32 v76, v78, v79
v_mfma_f32_16x16x32_bf16 a[16:19], v[224:227], v[160:163], a[16:19]
v_lshlrev_b32 v80, 16, v116
v_mul_f32 v77, v78, v80
v_mfma_f32_16x16x32_bf16 a[16:19], v[228:231], v[164:167], a[16:19]
ds_read_b64_tr_b16 v[244:245], v22 offset:8192
v_and_b32 v78, 0xffff0000, v84
v_mfma_f32_16x16x32_bf16 a[20:23], v[228:231], v[172:175], a[20:23]
v_and_b32 v79, 0xffff0000, v108
v_fmac_f32 v76, v78, v79
v_mfma_f32_16x16x32_bf16 a[20:23], v[224:227], v[168:171], a[20:23]
s_add_u32 s72, s69, 47104
buffer_load_dwordx4 v2, s[8:11], s72 offen offset:2048 lds
v_mfma_f32_16x16x32_bf16 a[24:27], v[224:227], v[176:179], a[24:27]
ds_read_b64_tr_b16 v[246:247], v22 offset:9216
v_and_b32 v80, 0xffff0000, v116
v_mfma_f32_16x16x32_bf16 a[24:27], v[228:231], v[180:183], a[24:27]
v_fmac_f32 v77, v78, v80
v_lshlrev_b32 v78, 16, v85
v_mfma_f32_16x16x32_bf16 a[28:31], v[228:231], v[188:191], a[28:31]
v_lshlrev_b32 v79, 16, v109
v_fmac_f32 v76, v78, v79
v_mfma_f32_16x16x32_bf16 a[28:31], v[224:227], v[184:187], a[28:31]
s_waitcnt lgkmcnt(3)
v_lshlrev_b32 v80, 16, v117
v_fmac_f32 v77, v78, v80
v_mfma_f32_16x16x32_bf16 a[60:63], v[232:235], v[184:187], a[60:63]
s_add_u32 s72, s69, 54272
buffer_load_dwordx4 v3, s[8:11], s72 offen offset:3072 lds
v_mfma_f32_16x16x32_bf16 a[60:63], v[236:239], v[188:191], a[60:63]
ds_read_b64_tr_b16 v[248:249], v23 offset:0
v_and_b32 v78, 0xffff0000, v85
v_mfma_f32_16x16x32_bf16 a[56:59], v[236:239], v[180:183], a[56:59]
v_and_b32 v79, 0xffff0000, v109
v_fmac_f32 v76, v78, v79
v_mfma_f32_16x16x32_bf16 a[56:59], v[232:235], v[176:179], a[56:59]
s_add_u32 m0, s64, 49152
ds_read_b64_tr_b16 v[250:251], v23 offset:1024
v_and_b32 v80, 0xffff0000, v117
v_mfma_f32_16x16x32_bf16 a[52:55], v[232:235], v[168:171], a[52:55]
s_add_u32 s72, s71, 0
buffer_load_dwordx4 v6, s[20:23], s72 offen lds
v_mfma_f32_16x16x32_bf16 a[52:55], v[236:239], v[172:175], a[52:55]
v_fmac_f32 v77, v78, v80
v_lshlrev_b32 v78, 16, v86
v_mfma_f32_16x16x32_bf16 a[48:51], v[236:239], v[164:167], a[48:51]
v_lshlrev_b32 v79, 16, v110
v_fmac_f32 v76, v78, v79
v_mfma_f32_16x16x32_bf16 a[48:51], v[232:235], v[160:163], a[48:51]
ds_read_b64_tr_b16 v[252:253], v23 offset:8192
v_lshlrev_b32 v80, 16, v118
v_mfma_f32_16x16x32_bf16 a[44:47], v[232:235], v[152:155], a[44:47]
s_add_u32 s72, s71, 31744
buffer_load_dwordx4 v6, s[20:23], s72 offen offset:1024 lds
v_mfma_f32_16x16x32_bf16 a[44:47], v[236:239], v[156:159], a[44:47]
v_fmac_f32 v77, v78, v80
v_and_b32 v78, 0xffff0000, v86
v_mfma_f32_16x16x32_bf16 a[40:43], v[236:239], v[148:151], a[40:43]
ds_read_b64_tr_b16 v[254:255], v23 offset:9216
v_and_b32 v79, 0xffff0000, v110
v_mfma_f32_16x16x32_bf16 a[40:43], v[232:235], v[144:147], a[40:43]
v_fmac_f32 v76, v78, v79
v_and_b32 v80, 0xffff0000, v118
v_mfma_f32_16x16x32_bf16 a[36:39], v[232:235], v[136:139], a[36:39]
s_add_u32 s72, s71, 63488
buffer_load_dwordx4 v7, s[20:23], s72 offen offset:2048 lds
v_mfma_f32_16x16x32_bf16 a[36:39], v[236:239], v[140:143], a[36:39]
v_fmac_f32 v77, v78, v80
v_lshlrev_b32 v78, 16, v87
v_mfma_f32_16x16x32_bf16 a[32:35], v[236:239], v[132:135], a[32:35]
v_lshlrev_b32 v79, 16, v111
v_fmac_f32 v76, v78, v79
v_mfma_f32_16x16x32_bf16 a[32:35], v[232:235], v[128:131], a[32:35]
s_waitcnt lgkmcnt(4)
v_lshlrev_b32 v80, 16, v119
v_fmac_f32 v77, v78, v80
v_mfma_f32_16x16x32_bf16 a[64:67], v[240:243], v[128:131], a[64:67]
s_add_u32 s72, s71, 95232
buffer_load_dwordx4 v7, s[20:23], s72 offen offset:3072 lds
v_mfma_f32_16x16x32_bf16 a[64:67], v[244:247], v[132:135], a[64:67]
ds_read_b64_tr_b16 v[224:225], v20 offset:16384
v_and_b32 v78, 0xffff0000, v87
v_mfma_f32_16x16x32_bf16 a[68:71], v[244:247], v[140:143], a[68:71]
v_and_b32 v79, 0xffff0000, v111
v_fmac_f32 v76, v78, v79
v_mfma_f32_16x16x32_bf16 a[68:71], v[240:243], v[136:139], a[68:71]
v_and_b32 v80, 0xffff0000, v119
v_fmac_f32 v77, v78, v80
v_mfma_f32_16x16x32_bf16 a[72:75], v[240:243], v[144:147], a[72:75]
ds_read_b64_tr_b16 v[226:227], v20 offset:17408
v_lshlrev_b32 v78, 16, v88
v_mfma_f32_16x16x32_bf16 a[72:75], v[244:247], v[148:151], a[72:75]
v_lshlrev_b32 v79, 16, v112
v_fmac_f32 v76, v78, v79
v_mfma_f32_16x16x32_bf16 a[76:79], v[244:247], v[156:159], a[76:79]
v_lshlrev_b32 v80, 16, v120
v_fmac_f32 v77, v78, v80
v_mfma_f32_16x16x32_bf16 a[76:79], v[240:243], v[152:155], a[76:79]
ds_read_b64_tr_b16 v[228:229], v20 offset:24576
v_and_b32 v78, 0xffff0000, v88
v_mfma_f32_16x16x32_bf16 a[80:83], v[240:243], v[160:163], a[80:83]
s_waitcnt lgkmcnt(15)
buffer_store_dwordx4 v[36:39], v26, s[44:47], s74 offen sc1
v_mfma_f32_16x16x32_bf16 a[80:83], v[244:247], v[164:167], a[80:83]
v_and_b32 v79, 0xffff0000, v112
v_fmac_f32 v76, v78, v79
v_mfma_f32_16x16x32_bf16 a[84:87], v[244:247], v[172:175], a[84:87]
v_and_b32 v80, 0xffff0000, v120
v_fmac_f32 v77, v78, v80
v_mfma_f32_16x16x32_bf16 a[84:87], v[240:243], v[168:171], a[84:87]
ds_read_b64_tr_b16 v[230:231], v20 offset:25600
v_lshlrev_b32 v78, 16, v89
v_mfma_f32_16x16x32_bf16 a[88:91], v[240:243], v[176:179], a[88:91]
v_lshlrev_b32 v79, 16, v113
v_fmac_f32 v76, v78, v79
v_mfma_f32_16x16x32_bf16 a[88:91], v[244:247], v[180:183], a[88:91]
v_lshlrev_b32 v80, 16, v121
v_fmac_f32 v77, v78, v80
v_mfma_f32_16x16x32_bf16 a[92:95], v[244:247], v[188:191], a[92:95]
v_and_b32 v78, 0xffff0000, v89
v_and_b32 v79, 0xffff0000, v113
v_mfma_f32_16x16x32_bf16 a[92:95], v[240:243], v[184:187], a[92:95]
s_waitcnt lgkmcnt(4)
v_fmac_f32 v76, v78, v79
v_and_b32 v80, 0xffff0000, v121
v_mfma_f32_16x16x32_bf16 a[124:127], v[248:251], v[184:187], a[124:127]
ds_read_b64_tr_b16 v[232:233], v21 offset:16384
v_fmac_f32 v77, v78, v80
v_mfma_f32_16x16x32_bf16 a[124:127], v[252:255], v[188:191], a[124:127]
v_lshlrev_b32 v78, 16, v90
v_lshlrev_b32 v79, 16, v114
v_mfma_f32_16x16x32_bf16 a[120:123], v[252:255], v[180:183], a[120:123]
ds_read_b64_tr_b16 v[234:235], v21 offset:17408
v_fmac_f32 v76, v78, v79
v_mfma_f32_16x16x32_bf16 a[120:123], v[248:251], v[176:179], a[120:123]
v_lshlrev_b32 v80, 16, v122
v_fmac_f32 v77, v78, v80
v_mfma_f32_16x16x32_bf16 a[116:119], v[248:251], v[168:171], a[116:119]
s_lshr_b32 s75, s93, 5
v_and_b32 v78, 0xffff0000, v90
v_and_b32 v79, 0xffff0000, v114
v_mfma_f32_16x16x32_bf16 a[116:119], v[252:255], v[172:175], a[116:119]
s_add_u32 s74, s74, 0x4000
buffer_store_dwordx4 v[40:43], v26, s[44:47], s74 offen sc1
v_mfma_f32_16x16x32_bf16 a[112:115], v[252:255], v[164:167], a[112:115]
s_and_b32 s75, s75, 0x3f80
ds_read_b64_tr_b16 v[236:237], v21 offset:24576
v_fmac_f32 v76, v78, v79
v_mfma_f32_16x16x32_bf16 a[112:115], v[248:251], v[160:163], a[112:115]
s_add_u32 s75, s75, LcB0-Lpc0
v_lshrrev_b32 v2, 6, v0
v_lshlrev_b32 v2, 7, v2
v_mfma_f32_16x16x32_bf16 a[108:111], v[248:251], v[152:155], a[108:111]
v_add_u32 v2, s75, v2
v_min_u32 v2, Lcode_end-Lpc0, v2
v_mfma_f32_16x16x32_bf16 a[108:111], v[252:255], v[156:159], a[108:111]
global_load_dword v3, v2, s[98:99]
v_mfma_f32_16x16x32_bf16 a[104:107], v[252:255], v[148:151], a[104:107]
v_and_b32 v80, 0xffff0000, v122
v_fmac_f32 v77, v78, v80
v_mfma_f32_16x16x32_bf16 a[104:107], v[248:251], v[144:147], a[104:107]
ds_read_b64_tr_b16 v[238:239], v21 offset:25600
v_lshlrev_b32 v78, 16, v91
v_mfma_f32_16x16x32_bf16 a[100:103], v[248:251], v[136:139], a[100:103]
v_lshlrev_b32 v79, 16, v115
v_fmac_f32 v76, v78, v79
v_mfma_f32_16x16x32_bf16 a[100:103], v[252:255], v[140:143], a[100:103]
v_lshlrev_b32 v80, 16, v123
v_fmac_f32 v77, v78, v80
v_mfma_f32_16x16x32_bf16 a[96:99], v[252:255], v[132:135], a[96:99]
v_and_b32 v78, 0xffff0000, v91
v_and_b32 v79, 0xffff0000, v115
v_mfma_f32_16x16x32_bf16 a[96:99], v[248:251], v[128:131], a[96:99]
s_waitcnt lgkmcnt(4)
v_fmac_f32 v76, v78, v79
v_and_b32 v80, 0xffff0000, v123
v_mfma_f32_16x16x32_bf16 a[128:131], v[128:131], v[224:227], a[128:131]
ds_read_b64_tr_b16 v[240:241], v22 offset:16384
v_fmac_f32 v77, v78, v80
v_mfma_f32_16x16x32_bf16 a[128:131], v[132:135], v[228:231], a[128:131]
v_add_f32_dpp v76, v76, v76 row_ror:8 row_mask:0xf bank_mask:0xf
v_add_f32_dpp v77, v77, v77 row_ror:8 row_mask:0xf bank_mask:0xf
v_mfma_f32_16x16x32_bf16 a[132:135], v[140:143], v[228:231], a[132:135]
s_add_u32 s74, s74, 0x4000
buffer_store_dwordx4 v[44:47], v26, s[44:47], s74 offen sc1
v_mfma_f32_16x16x32_bf16 a[132:135], v[136:139], v[224:227], a[132:135]
v_add_f32_dpp v76, v76, v76 row_ror:4 row_mask:0xf bank_mask:0xf
v_add_f32_dpp v77, v77, v77 row_ror:4 row_mask:0xf bank_mask:0xf
v_mfma_f32_16x16x32_bf16 a[136:139], v[144:147], v[224:227], a[136:139]
ds_read_b64_tr_b16 v[242:243], v22 offset:17408
v_add_f32_dpp v76, v76, v76 row_ror:2 row_mask:0xf bank_mask:0xf
v_mfma_f32_16x16x32_bf16 a[136:139], v[148:151], v[228:231], a[136:139]
v_add_f32_dpp v77, v77, v77 row_ror:2 row_mask:0xf bank_mask:0xf
v_add_f32_dpp v76, v76, v76 row_ror:1 row_mask:0xf bank_mask:0xf
v_mfma_f32_16x16x32_bf16 a[140:143], v[156:159], v[228:231], a[140:143]
v_add_f32_dpp v77, v77, v77 row_ror:1 row_mask:0xf bank_mask:0xf
v_mov_b32 v78, v76
v_mfma_f32_16x16x32_bf16 a[140:143], v[152:155], v[224:227], a[140:143]
ds_read_b64_tr_b16 v[244:245], v22 offset:24576
v_mov_b32 v79, v77
v_mfma_f32_16x16x32_bf16 a[144:147], v[160:163], v[224:227], a[144:147]
v_permlane16_swap_b32 v76, v78
v_permlane16_swap_b32 v77, v79
v_mfma_f32_16x16x32_bf16 a[144:147], v[164:167], v[228:231], a[144:147]
v_add_f32 v76, v76, v78
v_add_f32 v77, v77, v79
v_mfma_f32_16x16x32_bf16 a[148:151], v[172:175], v[228:231], a[148:151]
ds_read_b64_tr_b16 v[246:247], v22 offset:25600
v_mov_b32 v78, v76
v_mfma_f32_16x16x32_bf16 a[148:151], v[168:171], v[224:227], a[148:151]
v_mov_b32 v79, v77
v_permlane32_swap_b32 v76, v78
v_mfma_f32_16x16x32_bf16 a[152:155], v[176:179], v[224:227], a[152:155]
v_permlane32_swap_b32 v77, v79
v_add_f32 v76, v76, v78
v_mfma_f32_16x16x32_bf16 a[152:155], v[180:183], v[228:231], a[152:155]
v_add_f32 v77, v77, v79
v_mul_f32 v76, 0xbfb8aa3b, v76
v_mfma_f32_16x16x32_bf16 a[156:159], v[188:191], v[228:231], a[156:159]
v_mul_f32 v77, 0xbfb8aa3b, v77
v_mfma_f32_16x16x32_bf16 a[156:159], v[184:187], v[224:227], a[156:159]
s_waitcnt lgkmcnt(4)
v_exp_f32 v76, v76
v_mfma_f32_16x16x32_bf16 a[188:191], v[184:187], v[232:235], a[188:191]
s_add_u32 s74, s74, 0x4000
buffer_store_dwordx4 v[48:51], v26, s[44:47], s74 offen sc1
v_mfma_f32_16x16x32_bf16 a[188:191], v[188:191], v[236:239], a[188:191]
ds_read_b64_tr_b16 v[248:249], v23 offset:16384
v_mfma_f32_16x16x32_bf16 a[184:187], v[180:183], v[236:239], a[184:187]
ds_read_b64_tr_b16 v[250:251], v23 offset:17408
v_mfma_f32_16x16x32_bf16 a[184:187], v[176:179], v[232:235], a[184:187]
v_exp_f32 v77, v77
v_mfma_f32_16x16x32_bf16 a[180:183], v[168:171], v[232:235], a[180:183]
ds_read_b64_tr_b16 v[252:253], v23 offset:24576
v_add_f32 v76, 1.0, v76
v_mfma_f32_16x16x32_bf16 a[180:183], v[172:175], v[236:239], a[180:183]
v_add_f32 v77, 1.0, v77
v_mfma_f32_16x16x32_bf16 a[176:179], v[164:167], v[236:239], a[176:179]
ds_read_b64_tr_b16 v[254:255], v23 offset:25600
v_mfma_f32_16x16x32_bf16 a[176:179], v[160:163], v[232:235], a[176:179]
v_rcp_f32 v76, v76
v_mfma_f32_16x16x32_bf16 a[172:175], v[152:155], v[232:235], a[172:175]
v_rcp_f32 v77, v77
v_mfma_f32_16x16x32_bf16 a[172:175], v[156:159], v[236:239], a[172:175]
s_lshr_b32 s80, s76, 9
v_mfma_f32_16x16x32_bf16 a[168:171], v[148:151], v[236:239], a[168:171]
s_add_u32 s80, s80, 0x3800000
v_min_u32 v78, 1, v0
v_lshlrev_b32 v78, 30, v78
v_mfma_f32_16x16x32_bf16 a[168:171], v[144:147], v[232:235], a[168:171]
buffer_store_dwordx2 v[76:77], v78, s[44:47], s80 offen sc1
v_mfma_f32_16x16x32_bf16 a[164:167], v[136:139], v[232:235], a[164:167]
v_mfma_f32_16x16x32_bf16 a[164:167], v[140:143], v[236:239], a[164:167]
v_mfma_f32_16x16x32_bf16 a[160:163], v[132:135], v[236:239], a[160:163]
s_waitcnt vmcnt(6) lgkmcnt(0)
v_mfma_f32_16x16x32_bf16 a[160:163], v[128:131], v[232:235], a[160:163]
s_barrier
v_mfma_f32_16x16x32_bf16 a[192:195], v[128:131], v[240:243], a[192:195]
s_add_u32 s73, s62, 0
ds_read_b64_tr_b16 v[224:225], v20 offset:32768
v_mfma_f32_16x16x32_bf16 a[192:195], v[132:135], v[244:247], a[192:195]
s_add_u32 s70, s73, s65
ds_read_b64_tr_b16 v[226:227], v20 offset:33792
v_mfma_f32_16x16x32_bf16 a[196:199], v[140:143], v[244:247], a[196:199]
s_and_b32 s70, s70, 3
v_mov_b32 v100, v20
v_mov_b32 v101, v21
v_mfma_f32_16x16x32_bf16 a[196:199], v[136:139], v[240:243], a[196:199]
s_and_b32 s73, s73, 12
v_mov_b32 v102, v22
v_mov_b32 v103, v23
v_mfma_f32_16x16x32_bf16 a[200:203], v[144:147], v[240:243], a[200:203]
s_or_b32 s73, s73, s70
ds_read_b64_tr_b16 v[228:229], v20 offset:40960
v_mfma_f32_16x16x32_bf16 a[200:203], v[148:151], v[244:247], a[200:203]
s_lshl_b32 s73, s73, 7
ds_read_b64_tr_b16 v[230:231], v20 offset:41984
v_mfma_f32_16x16x32_bf16 a[204:207], v[156:159], v[244:247], a[204:207]
s_add_u32 s69, s73, s67
ds_read_b128 v[192:195], v24 offset:32768
v_mfma_f32_16x16x32_bf16 a[204:207], v[152:155], v[240:243], a[204:207]
s_add_u32 s70, s73, s68
ds_read_b128 v[196:199], v25 offset:32768
v_mfma_f32_16x16x32_bf16 a[208:211], v[160:163], v[240:243], a[208:211]
s_add_u32 m0, s63, 131072
ds_read_b128 v[200:203], v24 offset:34816
v_mfma_f32_16x16x32_bf16 a[208:211], v[164:167], v[244:247], a[208:211]
s_add_u32 s72, s69, 0
buffer_load_dwordx4 v4, s[4:7], s72 offen lds
v_mfma_f32_16x16x32_bf16 a[212:215], v[172:175], v[244:247], a[212:215]
s_add_u32 s72, s69, 15360
buffer_load_dwordx4 v5, s[4:7], s72 offen offset:1024 lds
v_mfma_f32_16x16x32_bf16 a[212:215], v[168:171], v[240:243], a[212:215]
s_add_u32 s72, s69, 129024
buffer_load_dwordx4 v4, s[4:7], s72 offen offset:2048 lds
v_mfma_f32_16x16x32_bf16 a[216:219], v[176:179], v[240:243], a[216:219]
ds_read_b128 v[204:207], v25 offset:34816
v_mfma_f32_16x16x32_bf16 a[216:219], v[180:183], v[244:247], a[216:219]
ds_read_b128 v[208:211], v24 offset:36864
v_mfma_f32_16x16x32_bf16 a[220:223], v[188:191], v[244:247], a[220:223]
s_add_u32 s72, s69, 144384
buffer_load_dwordx4 v5, s[4:7], s72 offen offset:3072 lds
v_mfma_f32_16x16x32_bf16 a[220:223], v[184:187], v[240:243], a[220:223]
ds_read_b128 v[212:215], v25 offset:36864
v_mfma_f32_16x16x32_bf16 a[252:255], v[184:187], v[248:251], a[252:255]
ds_read_b128 v[216:219], v24 offset:38912
v_mfma_f32_16x16x32_bf16 a[252:255], v[188:191], v[252:255], a[252:255]
ds_read_b128 v[220:223], v25 offset:38912
v_mfma_f32_16x16x32_bf16 a[248:251], v[180:183], v[252:255], a[248:251]
s_add_u32 m0, s63, 135168
ds_read_b128 v[184:187], v24 offset:40960
v_mfma_f32_16x16x32_bf16 a[248:251], v[176:179], v[248:251], a[248:251]
s_add_u32 s72, s70, 0
buffer_load_dwordx4 v4, s[4:7], s72 offen lds
v_mfma_f32_16x16x32_bf16 a[244:247], v[168:171], v[248:251], a[244:247]
ds_read_b128 v[188:191], v25 offset:40960
v_mfma_f32_16x16x32_bf16 a[244:247], v[172:175], v[252:255], a[244:247]
ds_read_b128 v[176:179], v24 offset:43008
v_mfma_f32_16x16x32_bf16 a[240:243], v[164:167], v[252:255], a[240:243]
ds_read_b128 v[180:183], v25 offset:43008
v_mfma_f32_16x16x32_bf16 a[240:243], v[160:163], v[248:251], a[240:243]
s_add_u32 s72, s70, 15360
buffer_load_dwordx4 v5, s[4:7], s72 offen offset:1024 lds
v_mfma_f32_16x16x32_bf16 a[236:239], v[152:155], v[248:251], a[236:239]
ds_read_b128 v[168:171], v24 offset:45056
v_mfma_f32_16x16x32_bf16 a[236:239], v[156:159], v[252:255], a[236:239]
ds_read_b128 v[172:175], v25 offset:45056
v_mfma_f32_16x16x32_bf16 a[232:235], v[148:151], v[252:255], a[232:235]
v_mfma_f32_16x16x32_bf16 a[232:235], v[144:147], v[248:251], a[232:235]
ds_read_b128 v[160:163], v24 offset:47104
v_mfma_f32_16x16x32_bf16 a[228:231], v[136:139], v[248:251], a[228:231]
s_add_u32 s72, s70, 129024
buffer_load_dwordx4 v4, s[4:7], s72 offen offset:2048 lds
v_mfma_f32_16x16x32_bf16 a[228:231], v[140:143], v[252:255], a[228:231]
ds_read_b128 v[164:167], v25 offset:47104
v_mfma_f32_16x16x32_bf16 a[224:227], v[132:135], v[252:255], a[224:227]
ds_read_b64_tr_b16 v[232:233], v101 offset:32768
v_mfma_f32_16x16x32_bf16 a[224:227], v[128:131], v[248:251], a[224:227]
s_waitcnt lgkmcnt(9)
ds_read_b64_tr_b16 v[234:235], v101 offset:33792
v_mfma_f32_16x16x32_bf16 a[0:3], v[224:227], v[192:195], a[0:3]
s_add_u32 s72, s70, 144384
buffer_load_dwordx4 v5, s[4:7], s72 offen offset:3072 lds
v_mfma_f32_16x16x32_bf16 a[0:3], v[228:231], v[196:199], a[0:3]
ds_read_b64_tr_b16 v[240:241], v102 offset:32768
v_mfma_f32_16x16x32_bf16 a[4:7], v[228:231], v[204:207], a[4:7]
ds_read_b64_tr_b16 v[236:237], v101 offset:40960
v_mfma_f32_16x16x32_bf16 a[4:7], v[224:227], v[200:203], a[4:7]
v_mfma_f32_16x16x32_bf16 a[8:11], v[224:227], v[208:211], a[8:11]
ds_read_b64_tr_b16 v[238:239], v101 offset:41984
v_mfma_f32_16x16x32_bf16 a[8:11], v[228:231], v[212:215], a[8:11]
s_lshl_b32 s71, s73, 12
ds_read_b64_tr_b16 v[242:243], v102 offset:33792
v_mfma_f32_16x16x32_bf16 a[12:15], v[228:231], v[220:223], a[12:15]
s_add_u32 s71, s71, s66
v_mfma_f32_16x16x32_bf16 a[12:15], v[224:227], v[216:219], a[12:15]
s_waitcnt lgkmcnt(6)
ds_read_b64_tr_b16 v[244:245], v102 offset:40960
v_mfma_f32_16x16x32_bf16 a[16:19], v[224:227], v[184:187], a[16:19]
s_add_u32 m0, s64, 0
v_mfma_f32_16x16x32_bf16 a[16:19], v[228:231], v[188:191], a[16:19]
s_add_u32 s72, s71, 0
buffer_load_dwordx4 v6, s[12:15], s72 offen lds
v_mfma_f32_16x16x32_bf16 a[20:23], v[228:231], v[180:183], a[20:23]
s_add_u32 s72, s71, 31744
buffer_load_dwordx4 v6, s[12:15], s72 offen offset:1024 lds
v_mfma_f32_16x16x32_bf16 a[20:23], v[224:227], v[176:179], a[20:23]
ds_read_b64_tr_b16 v[246:247], v102 offset:41984
v_mfma_f32_16x16x32_bf16 a[24:27], v[224:227], v[168:171], a[24:27]
v_mfma_f32_16x16x32_bf16 a[24:27], v[228:231], v[172:175], a[24:27]
v_mfma_f32_16x16x32_bf16 a[28:31], v[228:231], v[164:167], a[28:31]
v_mfma_f32_16x16x32_bf16 a[28:31], v[224:227], v[160:163], a[28:31]
s_waitcnt lgkmcnt(3)
v_mfma_f32_16x16x32_bf16 a[60:63], v[232:235], v[160:163], a[60:63]
s_add_u32 s72, s71, 63488
buffer_load_dwordx4 v7, s[12:15], s72 offen offset:2048 lds
v_mfma_f32_16x16x32_bf16 a[60:63], v[236:239], v[164:167], a[60:63]
ds_read_b64_tr_b16 v[248:249], v103 offset:32768
v_mfma_f32_16x16x32_bf16 a[56:59], v[236:239], v[172:175], a[56:59]
v_mfma_f32_16x16x32_bf16 a[56:59], v[232:235], v[168:171], a[56:59]
s_add_u32 s72, s71, 95232
buffer_load_dwordx4 v7, s[12:15], s72 offen offset:3072 lds
v_mfma_f32_16x16x32_bf16 a[52:55], v[232:235], v[176:179], a[52:55]
v_mfma_f32_16x16x32_bf16 a[52:55], v[236:239], v[180:183], a[52:55]
ds_read_b64_tr_b16 v[250:251], v103 offset:33792
v_mfma_f32_16x16x32_bf16 a[48:51], v[236:239], v[188:191], a[48:51]
v_mfma_f32_16x16x32_bf16 a[48:51], v[232:235], v[184:187], a[48:51]
v_mfma_f32_16x16x32_bf16 a[44:47], v[232:235], v[216:219], a[44:47]
s_add_u32 s73, s62, 1
ds_read_b64_tr_b16 v[252:253], v103 offset:40960
v_mfma_f32_16x16x32_bf16 a[44:47], v[236:239], v[220:223], a[44:47]
s_add_u32 s70, s73, s65
v_mfma_f32_16x16x32_bf16 a[40:43], v[236:239], v[212:215], a[40:43]
s_and_b32 s70, s70, 3
v_mfma_f32_16x16x32_bf16 a[40:43], v[232:235], v[208:211], a[40:43]
s_and_b32 s73, s73, 12
ds_read_b64_tr_b16 v[254:255], v103 offset:41984
v_mfma_f32_16x16x32_bf16 a[36:39], v[232:235], v[200:203], a[36:39]
s_or_b32 s73, s73, s70
v_mfma_f32_16x16x32_bf16 a[36:39], v[236:239], v[204:207], a[36:39]
s_lshl_b32 s73, s73, 7
v_mfma_f32_16x16x32_bf16 a[32:35], v[236:239], v[196:199], a[32:35]
s_add_u32 s69, s73, s67
v_mfma_f32_16x16x32_bf16 a[32:35], v[232:235], v[192:195], a[32:35]
s_waitcnt lgkmcnt(4)
v_mfma_f32_16x16x32_bf16 a[64:67], v[240:243], v[192:195], a[64:67]
s_add_u32 s70, s73, s68
ds_read_b64_tr_b16 v[224:225], v100 offset:49152
v_mfma_f32_16x16x32_bf16 a[64:67], v[244:247], v[196:199], a[64:67]
s_add_u32 m0, s63, 65536
v_mfma_f32_16x16x32_bf16 a[68:71], v[244:247], v[204:207], a[68:71]
s_add_u32 s72, s69, 0
buffer_load_dwordx4 v4, s[4:7], s72 offen lds
v_mfma_f32_16x16x32_bf16 a[68:71], v[240:243], v[200:203], a[68:71]
s_add_u32 s72, s69, 15360
buffer_load_dwordx4 v5, s[4:7], s72 offen offset:1024 lds
v_mfma_f32_16x16x32_bf16 a[72:75], v[240:243], v[208:211], a[72:75]
s_add_u32 s72, s69, 129024
buffer_load_dwordx4 v4, s[4:7], s72 offen offset:2048 lds
v_mfma_f32_16x16x32_bf16 a[72:75], v[244:247], v[212:215], a[72:75]
ds_read_b64_tr_b16 v[226:227], v100 offset:50176
v_mfma_f32_16x16x32_bf16 a[76:79], v[244:247], v[220:223], a[76:79]
s_add_u32 s72, s69, 144384
buffer_load_dwordx4 v5, s[4:7], s72 offen offset:3072 lds
v_mfma_f32_16x16x32_bf16 a[76:79], v[240:243], v[216:219], a[76:79]
v_mfma_f32_16x16x32_bf16 a[80:83], v[240:243], v[184:187], a[80:83]
ds_read_b64_tr_b16 v[228:229], v100 offset:57344
v_mfma_f32_16x16x32_bf16 a[80:83], v[244:247], v[188:191], a[80:83]
v_mfma_f32_16x16x32_bf16 a[84:87], v[244:247], v[180:183], a[84:87]
ds_read_b64_tr_b16 v[230:231], v100 offset:58368
v_accvgpr_read_b32 v20, a0
v_mfma_f32_16x16x32_bf16 a[84:87], v[240:243], v[176:179], a[84:87]
s_add_u32 m0, s63, 69632
v_accvgpr_read_b32 v28, a1
v_accvgpr_read_b32 v21, a2
v_mfma_f32_16x16x32_bf16 a[88:91], v[240:243], v[168:171], a[88:91]
s_add_u32 s72, s70, 0
buffer_load_dwordx4 v4, s[4:7], s72 offen lds
v_mfma_f32_16x16x32_bf16 a[88:91], v[244:247], v[172:175], a[88:91]
v_accvgpr_read_b32 v29, a3
v_accvgpr_read_b32 v22, a32
v_mfma_f32_16x16x32_bf16 a[92:95], v[244:247], v[164:167], a[92:95]
v_accvgpr_read_b32 v30, a33
v_accvgpr_read_b32 v23, a34
v_mfma_f32_16x16x32_bf16 a[92:95], v[240:243], v[160:163], a[92:95]
s_waitcnt lgkmcnt(4)
v_accvgpr_read_b32 v31, a35
v_mul_f32 v20, s79, v20
v_mfma_f32_16x16x32_bf16 a[124:127], v[248:251], v[160:163], a[124:127]
s_add_u32 s72, s70, 15360
buffer_load_dwordx4 v5, s[4:7], s72 offen offset:1024 lds
v_mfma_f32_16x16x32_bf16 a[124:127], v[252:255], v[164:167], a[124:127]
ds_read_b64_tr_b16 v[232:233], v101 offset:49152
v_mul_f32 v28, s79, v28
v_mfma_f32_16x16x32_bf16 a[120:123], v[252:255], v[172:175], a[120:123]
v_mul_f32 v21, s79, v21
v_mul_f32 v29, s79, v29
v_mfma_f32_16x16x32_bf16 a[120:123], v[248:251], v[168:171], a[120:123]
ds_read_b64_tr_b16 v[234:235], v101 offset:50176
v_mul_f32 v22, s79, v22
v_mfma_f32_16x16x32_bf16 a[116:119], v[248:251], v[176:179], a[116:119]
s_add_u32 s72, s70, 129024
buffer_load_dwordx4 v4, s[4:7], s72 offen offset:2048 lds
v_mfma_f32_16x16x32_bf16 a[116:119], v[252:255], v[180:183], a[116:119]
v_mul_f32 v30, s79, v30
v_mul_f32 v23, s79, v23
v_mfma_f32_16x16x32_bf16 a[112:115], v[252:255], v[188:191], a[112:115]
v_mul_f32 v31, s79, v31
v_cvt_pk_bf16_f32 v20, v20, v28
v_mfma_f32_16x16x32_bf16 a[112:115], v[248:251], v[184:187], a[112:115]
ds_read_b64_tr_b16 v[236:237], v101 offset:57344
v_cvt_pk_bf16_f32 v21, v21, v29
v_mfma_f32_16x16x32_bf16 a[108:111], v[248:251], v[216:219], a[108:111]
v_cvt_pk_bf16_f32 v22, v22, v30
v_cvt_pk_bf16_f32 v23, v23, v31
v_mfma_f32_16x16x32_bf16 a[108:111], v[252:255], v[220:223], a[108:111]
s_add_u32 s72, s70, 144384
buffer_load_dwordx4 v5, s[4:7], s72 offen offset:3072 lds
v_mfma_f32_16x16x32_bf16 a[104:107], v[252:255], v[212:215], a[104:107]
s_add_u32 s80, s77, 0
buffer_store_dwordx4 v[20:23], v1, s[44:47], s80 offen sc1
v_mfma_f32_16x16x32_bf16 a[104:107], v[248:251], v[208:211], a[104:107]
ds_read_b64_tr_b16 v[238:239], v101 offset:58368
v_mfma_f32_16x16x32_bf16 a[100:103], v[248:251], v[200:203], a[100:103]
v_mfma_f32_16x16x32_bf16 a[100:103], v[252:255], v[204:207], a[100:103]
v_mfma_f32_16x16x32_bf16 a[96:99], v[252:255], v[196:199], a[96:99]
s_lshl_b32 s71, s73, 12
v_mfma_f32_16x16x32_bf16 a[96:99], v[248:251], v[192:195], a[96:99]
s_waitcnt lgkmcnt(4)
LcB0:
v_mfma_f32_16x16x32_bf16 a[128:131], v[192:195], v[224:227], a[128:131]
s_add_u32 s71, s71, s66
ds_read_b64_tr_b16 v[240:241], v102 offset:49152
v_accvgpr_read_b32 v24, a4
v_mfma_f32_16x16x32_bf16 a[128:131], v[196:199], v[228:231], a[128:131]
s_add_u32 m0, s64, 16384
v_accvgpr_read_b32 v28, a5
v_accvgpr_read_b32 v25, a6
v_mfma_f32_16x16x32_bf16 a[132:135], v[204:207], v[228:231], a[132:135]
s_add_u32 s72, s71, 0
buffer_load_dwordx4 v6, s[12:15], s72 offen lds
v_mfma_f32_16x16x32_bf16 a[132:135], v[200:203], v[224:227], a[132:135]
s_add_u32 s72, s71, 31744
buffer_load_dwordx4 v6, s[12:15], s72 offen offset:1024 lds
v_mfma_f32_16x16x32_bf16 a[136:139], v[208:211], v[224:227], a[136:139]
ds_read_b64_tr_b16 v[242:243], v102 offset:50176
v_accvgpr_read_b32 v29, a7
v_mfma_f32_16x16x32_bf16 a[136:139], v[212:215], v[228:231], a[136:139]
v_accvgpr_read_b32 v26, a36
v_accvgpr_read_b32 v30, a37
v_mfma_f32_16x16x32_bf16 a[140:143], v[220:223], v[228:231], a[140:143]
v_accvgpr_read_b32 v27, a38
v_accvgpr_read_b32 v31, a39
v_mfma_f32_16x16x32_bf16 a[140:143], v[216:219], v[224:227], a[140:143]
s_add_u32 s72, s71, 63488
buffer_load_dwordx4 v7, s[12:15], s72 offen offset:2048 lds
v_mfma_f32_16x16x32_bf16 a[144:147], v[184:187], v[224:227], a[144:147]
ds_read_b64_tr_b16 v[244:245], v102 offset:57344
v_mul_f32 v24, s79, v24
v_mfma_f32_16x16x32_bf16 a[144:147], v[188:191], v[228:231], a[144:147]
v_mul_f32 v28, s79, v28
v_mul_f32 v25, s79, v25
v_mfma_f32_16x16x32_bf16 a[148:151], v[180:183], v[228:231], a[148:151]
ds_read_b64_tr_b16 v[246:247], v102 offset:58368
v_mul_f32 v29, s79, v29
v_mfma_f32_16x16x32_bf16 a[148:151], v[176:179], v[224:227], a[148:151]
v_mul_f32 v26, s79, v26
v_mul_f32 v30, s79, v30
v_mfma_f32_16x16x32_bf16 a[152:155], v[168:171], v[224:227], a[152:155]
s_add_u32 s72, s71, 95232
buffer_load_dwordx4 v7, s[12:15], s72 offen offset:3072 lds
v_mfma_f32_16x16x32_bf16 a[152:155], v[172:175], v[228:231], a[152:155]
v_mul_f32 v27, s79, v27
v_mul_f32 v31, s79, v31
v_mfma_f32_16x16x32_bf16 a[156:159], v[164:167], v[228:231], a[156:159]
v_cvt_pk_bf16_f32 v24, v24, v28
v_cvt_pk_bf16_f32 v25, v25, v29
v_mfma_f32_16x16x32_bf16 a[156:159], v[160:163], v[224:227], a[156:159]
s_waitcnt lgkmcnt(4)
v_cvt_pk_bf16_f32 v26, v26, v30
v_cvt_pk_bf16_f32 v27, v27, v31
v_mfma_f32_16x16x32_bf16 a[188:191], v[160:163], v[232:235], a[188:191]
s_add_u32 s80, s77, 4096
ds_read_b64_tr_b16 v[248:249], v103 offset:49152
v_mfma_f32_16x16x32_bf16 a[188:191], v[164:167], v[236:239], a[188:191]
buffer_store_dwordx4 v[24:27], v1, s[44:47], s80 offen sc1
v_mfma_f32_16x16x32_bf16 a[184:187], v[172:175], v[236:239], a[184:187]
ds_read_b64_tr_b16 v[250:251], v103 offset:50176
v_mfma_f32_16x16x32_bf16 a[184:187], v[168:171], v[232:235], a[184:187]
v_mfma_f32_16x16x32_bf16 a[180:183], v[176:179], v[232:235], a[180:183]
ds_read_b64_tr_b16 v[252:253], v103 offset:57344
v_mfma_f32_16x16x32_bf16 a[180:183], v[180:183], v[236:239], a[180:183]
s_add_u32 s73, s62, 2
v_mfma_f32_16x16x32_bf16 a[176:179], v[188:191], v[236:239], a[176:179]
s_add_u32 s70, s73, s65
ds_read_b64_tr_b16 v[254:255], v103 offset:58368
v_accvgpr_read_b32 v20, a8
v_mfma_f32_16x16x32_bf16 a[176:179], v[184:187], v[232:235], a[176:179]
s_and_b32 s70, s70, 3
v_accvgpr_read_b32 v28, a9
v_accvgpr_read_b32 v21, a10
v_mfma_f32_16x16x32_bf16 a[172:175], v[216:219], v[232:235], a[172:175]
s_and_b32 s73, s73, 12
v_accvgpr_read_b32 v29, a11
v_accvgpr_read_b32 v22, a40
v_mfma_f32_16x16x32_bf16 a[172:175], v[220:223], v[236:239], a[172:175]
s_or_b32 s73, s73, s70
v_accvgpr_read_b32 v30, a41
v_accvgpr_read_b32 v23, a42
v_mfma_f32_16x16x32_bf16 a[168:171], v[212:215], v[236:239], a[168:171]
s_lshl_b32 s73, s73, 7
v_accvgpr_read_b32 v31, a43
v_mul_f32 v20, s79, v20
v_mfma_f32_16x16x32_bf16 a[168:171], v[208:211], v[232:235], a[168:171]
s_add_u32 s69, s73, s67
v_mul_f32 v28, s79, v28
v_mul_f32 v21, s79, v21
v_mfma_f32_16x16x32_bf16 a[164:167], v[200:203], v[232:235], a[164:167]
s_add_u32 s70, s73, s68
v_mul_f32 v29, s79, v29
v_mul_f32 v22, s79, v22
v_mfma_f32_16x16x32_bf16 a[164:167], v[204:207], v[236:239], a[164:167]
s_add_u32 m0, s63, 98304
v_mul_f32 v30, s79, v30
v_mul_f32 v23, s79, v23
v_mfma_f32_16x16x32_bf16 a[160:163], v[196:199], v[236:239], a[160:163]
s_waitcnt vmcnt(14) lgkmcnt(0)
v_mul_f32 v31, s79, v31
v_cvt_pk_bf16_f32 v20, v20, v28
v_mfma_f32_16x16x32_bf16 a[160:163], v[192:195], v[232:235], a[160:163]
s_barrier
v_cvt_pk_bf16_f32 v21, v21, v29
v_cvt_pk_bf16_f32 v22, v22, v30
v_mfma_f32_16x16x32_bf16 a[192:195], v[192:195], v[240:243], a[192:195]
s_add_u32 s72, s69, 0
buffer_load_dwordx4 v4, s[4:7], s72 offen lds
v_mfma_f32_16x16x32_bf16 a[192:195], v[196:199], v[244:247], a[192:195]
s_lshl_b32 s74, s59, 2
ds_read_b64_tr_b16 v[64:65], v8 offset:0
v_or_b32 v106, s58, v0
v_mfma_f32_16x16x32_bf16 a[196:199], v[204:207], v[244:247], a[196:199]
ds_read_b64_tr_b16 v[66:67], v8 offset:1024
v_mov_b32 v107, 1
v_mfma_f32_16x16x32_bf16 a[196:199], v[200:203], v[240:243], a[196:199]
ds_read_b64_tr_b16 v[68:69], v8 offset:8192
v_lshlrev_b32 v106, 8, v106
v_mfma_f32_16x16x32_bf16 a[200:203], v[208:211], v[240:243], a[200:203]
ds_read_b64_tr_b16 v[70:71], v8 offset:9216
v_cvt_pk_bf16_f32 v23, v23, v31
v_mfma_f32_16x16x32_bf16 a[200:203], v[212:215], v[244:247], a[200:203]
s_add_u32 s72, s69, 15360
buffer_load_dwordx4 v5, s[4:7], s72 offen offset:1024 lds
v_mfma_f32_16x16x32_bf16 a[204:207], v[220:223], v[244:247], a[204:207]
s_add_u32 s80, s77, 8192
ds_read_b128 v[32:35], v16 offset:0
v_mfma_f32_16x16x32_bf16 a[204:207], v[216:219], v[240:243], a[204:207]
buffer_atomic_add v107, v106, s[48:51], s74 offen sc1
v_mfma_f32_16x16x32_bf16 a[208:211], v[184:187], v[240:243], a[208:211]
ds_read_b128 v[36:39], v17 offset:0
v_mfma_f32_16x16x32_bf16 a[208:211], v[188:191], v[244:247], a[208:211]
ds_read_b128 v[40:43], v16 offset:2048
v_mfma_f32_16x16x32_bf16 a[212:215], v[180:183], v[244:247], a[212:215]
s_add_u32 s72, s69, 129024
buffer_load_dwordx4 v4, s[4:7], s72 offen offset:2048 lds
v_mfma_f32_16x16x32_bf16 a[212:215], v[176:179], v[240:243], a[212:215]
ds_read_b128 v[44:47], v17 offset:2048
v_mfma_f32_16x16x32_bf16 a[216:219], v[168:171], v[240:243], a[216:219]
ds_read_b128 v[48:51], v16 offset:4096
v_accvgpr_read_b32 v24, a128
v_mfma_f32_16x16x32_bf16 a[216:219], v[172:175], v[244:247], a[216:219]
ds_read_b128 v[52:55], v17 offset:4096
v_accvgpr_read_b32 v28, a129
v_mfma_f32_16x16x32_bf16 a[220:223], v[164:167], v[244:247], a[220:223]
buffer_store_dwordx4 v[20:23], v1, s[44:47], s80 offen sc1
v_mfma_f32_16x16x32_bf16 a[220:223], v[160:163], v[240:243], a[220:223]
s_add_u32 s72, s69, 144384
buffer_load_dwordx4 v5, s[4:7], s72 offen offset:3072 lds
v_mfma_f32_16x16x32_bf16 a[252:255], v[160:163], v[248:251], a[252:255]
ds_read_b128 v[56:59], v16 offset:6144
v_accvgpr_read_b32 v25, a130
v_mfma_f32_16x16x32_bf16 a[252:255], v[164:167], v[252:255], a[252:255]
ds_read_b128 v[60:63], v17 offset:6144
v_accvgpr_read_b32 v29, a131
v_mfma_f32_16x16x32_bf16 a[248:251], v[172:175], v[252:255], a[248:251]
ds_read_b64_tr_b16 v[72:73], v9 offset:0
v_accvgpr_read_b32 v26, a132
v_mfma_f32_16x16x32_bf16 a[248:251], v[168:171], v[248:251], a[248:251]
s_add_u32 m0, s63, 102400
ds_read_b64_tr_b16 v[74:75], v9 offset:1024
v_accvgpr_read_b32 v30, a133
v_mfma_f32_16x16x32_bf16 a[244:247], v[176:179], v[248:251], a[244:247]
s_add_u32 s72, s70, 0
buffer_load_dwordx4 v4, s[4:7], s72 offen lds
v_mfma_f32_16x16x32_bf16 a[244:247], v[180:183], v[252:255], a[244:247]
ds_read_b64_tr_b16 v[76:77], v9 offset:8192
v_accvgpr_read_b32 v27, a134
v_mfma_f32_16x16x32_bf16 a[240:243], v[188:191], v[252:255], a[240:243]
v_accvgpr_read_b32 v31, a135
v_cvt_pk_bf16_f32 v24, v24, v28
v_mfma_f32_16x16x32_bf16 a[240:243], v[184:187], v[248:251], a[240:243]
ds_read_b64_tr_b16 v[78:79], v9 offset:9216
v_cvt_pk_bf16_f32 v25, v25, v29
v_mfma_f32_16x16x32_bf16 a[236:239], v[216:219], v[248:251], a[236:239]
ds_read_b64_tr_b16 v[80:81], v10 offset:0
v_cvt_pk_bf16_f32 v26, v26, v30
v_mfma_f32_16x16x32_bf16 a[236:239], v[220:223], v[252:255], a[236:239]
s_add_u32 s72, s70, 15360
buffer_load_dwordx4 v5, s[4:7], s72 offen offset:1024 lds
v_mfma_f32_16x16x32_bf16 a[232:235], v[212:215], v[252:255], a[232:235]
ds_read_b64_tr_b16 v[82:83], v10 offset:1024
v_cvt_pk_bf16_f32 v27, v27, v31
v_mfma_f32_16x16x32_bf16 a[232:235], v[208:211], v[248:251], a[232:235]
s_add_u32 s80, s78, 0
ds_read_b64_tr_b16 v[84:85], v10 offset:8192
v_mfma_f32_16x16x32_bf16 a[228:231], v[200:203], v[248:251], a[228:231]
ds_read_b64_tr_b16 v[86:87], v10 offset:9216
v_mfma_f32_16x16x32_bf16 a[228:231], v[204:207], v[252:255], a[228:231]
buffer_store_dwordx4 v[24:27], v1, s[44:47], s80 offen sc1
v_mfma_f32_16x16x32_bf16 a[224:227], v[196:199], v[252:255], a[224:227]
s_add_u32 s72, s70, 129024
buffer_load_dwordx4 v4, s[4:7], s72 offen offset:2048 lds
v_mfma_f32_16x16x32_bf16 a[224:227], v[192:195], v[248:251], a[224:227]
s_waitcnt lgkmcnt(8)
v_mfma_f32_16x16x32_bf16 v[128:131], v[64:67], v[32:35], 0
ds_read_b64_tr_b16 v[88:89], v11 offset:0
v_mfma_f32_16x16x32_bf16 v[128:131], v[68:71], v[36:39], v[128:131]
ds_read_b64_tr_b16 v[90:91], v11 offset:1024
v_mfma_f32_16x16x32_bf16 v[132:135], v[68:71], v[44:47], 0
v_accvgpr_read_b32 v20, a12
v_accvgpr_read_b32 v28, a13
v_mfma_f32_16x16x32_bf16 v[132:135], v[64:67], v[40:43], v[132:135]
s_add_u32 s72, s70, 144384
buffer_load_dwordx4 v5, s[4:7], s72 offen offset:3072 lds
v_mfma_f32_16x16x32_bf16 v[136:139], v[64:67], v[48:51], 0
s_lshl_b32 s71, s73, 12
ds_read_b64_tr_b16 v[92:93], v11 offset:8192
v_accvgpr_read_b32 v21, a14
v_mfma_f32_16x16x32_bf16 v[136:139], v[68:71], v[52:55], v[136:139]
s_add_u32 s71, s71, s66
v_accvgpr_read_b32 v29, a15
v_accvgpr_read_b32 v22, a44
v_mfma_f32_16x16x32_bf16 v[140:143], v[68:71], v[60:63], 0
s_add_u32 m0, s64, 32768
ds_read_b64_tr_b16 v[94:95], v11 offset:9216
v_accvgpr_read_b32 v30, a45
v_mfma_f32_16x16x32_bf16 v[140:143], v[64:67], v[56:59], v[140:143]
s_waitcnt lgkmcnt(8)
v_accvgpr_read_b32 v23, a46
v_accvgpr_read_b32 v31, a47
v_mfma_f32_16x16x32_bf16 v[156:159], v[72:75], v[56:59], 0
s_add_u32 s72, s71, 0
buffer_load_dwordx4 v6, s[12:15], s72 offen lds
v_mfma_f32_16x16x32_bf16 v[156:159], v[76:79], v[60:63], v[156:159]
s_add_u32 s73, s62, 3
ds_read_b64_tr_b16 v[64:65], v12 offset:0
v_mul_f32 v20, s79, v20
v_mfma_f32_16x16x32_bf16 v[152:155], v[76:79], v[52:55], 0
s_add_u32 s70, s73, s65
ds_read_b64_tr_b16 v[66:67], v12 offset:1024
v_mul_f32 v28, s79, v28
v_mfma_f32_16x16x32_bf16 v[152:155], v[72:75], v[48:51], v[152:155]
s_add_u32 s72, s71, 31744
buffer_load_dwordx4 v6, s[12:15], s72 offen offset:1024 lds
v_mfma_f32_16x16x32_bf16 v[148:151], v[72:75], v[40:43], 0
s_and_b32 s70, s70, 3
v_mul_f32 v21, s79, v21
v_mul_f32 v29, s79, v29
v_mfma_f32_16x16x32_bf16 v[148:151], v[76:79], v[44:47], v[148:151]
s_and_b32 s73, s73, 12
ds_read_b64_tr_b16 v[68:69], v12 offset:8192
v_mul_f32 v22, s79, v22
v_mfma_f32_16x16x32_bf16 v[144:147], v[76:79], v[36:39], 0
s_or_b32 s73, s73, s70
ds_read_b64_tr_b16 v[70:71], v12 offset:9216
v_mul_f32 v30, s79, v30
v_mfma_f32_16x16x32_bf16 v[144:147], v[72:75], v[32:35], v[144:147]
s_waitcnt lgkmcnt(8)
v_mul_f32 v23, s79, v23
v_mul_f32 v31, s79, v31
v_mfma_f32_16x16x32_bf16 v[160:163], v[80:83], v[32:35], 0
s_lshl_b32 s73, s73, 7
ds_read_b64_tr_b16 v[72:73], v13 offset:0
v_cvt_pk_bf16_f32 v20, v20, v28
v_mfma_f32_16x16x32_bf16 v[160:163], v[84:87], v[36:39], v[160:163]
s_add_u32 s72, s71, 63488
buffer_load_dwordx4 v7, s[12:15], s72 offen offset:2048 lds
v_mfma_f32_16x16x32_bf16 v[164:167], v[84:87], v[44:47], 0
s_add_u32 s69, s73, s67
ds_read_b64_tr_b16 v[74:75], v13 offset:1024
v_cvt_pk_bf16_f32 v21, v21, v29
v_mfma_f32_16x16x32_bf16 v[164:167], v[80:83], v[40:43], v[164:167]
s_add_u32 s70, s73, s68
v_cvt_pk_bf16_f32 v22, v22, v30
v_cvt_pk_bf16_f32 v23, v23, v31
v_mfma_f32_16x16x32_bf16 v[168:171], v[80:83], v[48:51], 0
s_waitcnt vmcnt(20)
ds_read_b64_tr_b16 v[76:77], v13 offset:8192
v_mfma_f32_16x16x32_bf16 v[168:171], v[84:87], v[52:55], v[168:171]
s_add_u32 s80, s77, 12288
ds_read_b64_tr_b16 v[78:79], v13 offset:9216
v_mfma_f32_16x16x32_bf16 v[172:175], v[84:87], v[60:63], 0
s_add_u32 s72, s71, 95232
ds_read_b128 v[96:99], v18 offset:0
v_mfma_f32_16x16x32_bf16 v[172:175], v[80:83], v[56:59], v[172:175]
s_waitcnt lgkmcnt(9)
buffer_load_dwordx4 v7, s[12:15], s72 offen offset:3072 lds
v_mfma_f32_16x16x32_bf16 v[188:191], v[88:91], v[56:59], 0
ds_read_b64_tr_b16 v[80:81], v14 offset:0
v_accvgpr_read_b32 v24, a136
v_mfma_f32_16x16x32_bf16 v[188:191], v[92:95], v[60:63], v[188:191]
ds_read_b64_tr_b16 v[82:83], v14 offset:1024
v_accvgpr_read_b32 v28, a137
v_mfma_f32_16x16x32_bf16 v[184:187], v[92:95], v[52:55], 0
ds_read_b128 v[100:103], v19 offset:0
v_accvgpr_read_b32 v25, a138
v_mfma_f32_16x16x32_bf16 v[184:187], v[88:91], v[48:51], v[184:187]
ds_read_b64_tr_b16 v[84:85], v14 offset:8192
v_accvgpr_read_b32 v29, a139
v_mfma_f32_16x16x32_bf16 v[180:183], v[88:91], v[40:43], 0
buffer_store_dwordx4 v[20:23], v1, s[44:47], s80 offen sc1
v_mfma_f32_16x16x32_bf16 v[180:183], v[92:95], v[44:47], v[180:183]
s_add_u32 m0, s63, 131072
ds_read_b64_tr_b16 v[86:87], v14 offset:9216
v_accvgpr_read_b32 v26, a140
v_mfma_f32_16x16x32_bf16 v[176:179], v[92:95], v[36:39], 0
s_add_u32 s72, s69, 0
buffer_load_dwordx4 v4, s[4:7], s72 offen lds
v_mfma_f32_16x16x32_bf16 v[176:179], v[88:91], v[32:35], v[176:179]
s_waitcnt lgkmcnt(10)
ds_read_b128 v[104:107], v18 offset:2048
v_accvgpr_read_b32 v30, a141
v_mfma_f32_16x16x32_bf16 v[192:195], v[64:67], v[32:35], 0
ds_read_b64_tr_b16 v[88:89], v15 offset:0
v_accvgpr_read_b32 v27, a142
v_mfma_f32_16x16x32_bf16 v[192:195], v[68:71], v[36:39], v[192:195]
ds_read_b64_tr_b16 v[90:91], v15 offset:1024
v_accvgpr_read_b32 v31, a143
v_mfma_f32_16x16x32_bf16 v[196:199], v[68:71], v[44:47], 0
ds_read_b64_tr_b16 v[92:93], v15 offset:8192
v_cvt_pk_bf16_f32 v24, v24, v28
v_mfma_f32_16x16x32_bf16 v[196:199], v[64:67], v[40:43], v[196:199]
s_add_u32 s72, s69, 15360
buffer_load_dwordx4 v5, s[4:7], s72 offen offset:1024 lds
v_mfma_f32_16x16x32_bf16 v[200:203], v[64:67], v[48:51], 0
ds_read_b64_tr_b16 v[94:95], v15 offset:9216
v_cvt_pk_bf16_f32 v25, v25, v29
v_mfma_f32_16x16x32_bf16 v[200:203], v[68:71], v[52:55], v[200:203]
ds_read_b128 v[108:111], v19 offset:2048
v_cvt_pk_bf16_f32 v26, v26, v30
v_mfma_f32_16x16x32_bf16 v[204:207], v[68:71], v[60:63], 0
v_cvt_pk_bf16_f32 v27, v27, v31
v_mfma_f32_16x16x32_bf16 v[204:207], v[64:67], v[56:59], v[204:207]
s_waitcnt lgkmcnt(12)
ds_read_b128 v[112:115], v18 offset:4096
v_mfma_f32_16x16x32_bf16 v[220:223], v[72:75], v[56:59], 0
s_add_u32 s72, s69, 129024
buffer_load_dwordx4 v4, s[4:7], s72 offen offset:2048 lds
v_mfma_f32_16x16x32_bf16 v[220:223], v[76:79], v[60:63], v[220:223]
s_add_u32 s80, s78, 8192
buffer_store_dwordx4 v[24:27], v1, s[44:47], s80 offen sc1
v_mfma_f32_16x16x32_bf16 v[216:219], v[76:79], v[52:55], 0
s_waitcnt vmcnt(21) lgkmcnt(2)
ds_read_b128 v[116:119], v19 offset:4096
v_mfma_f32_16x16x32_bf16 v[216:219], v[72:75], v[48:51], v[216:219]
s_barrier
ds_read_b128 v[120:123], v18 offset:6144
v_mfma_f32_16x16x32_bf16 v[212:215], v[72:75], v[40:43], 0
ds_read_b64_tr_b16 v[64:65], v8 offset:16384
ds_read_b64_tr_b16 v[66:67], v8 offset:17408
v_mfma_f32_16x16x32_bf16 v[212:215], v[76:79], v[44:47], v[212:215]
ds_read_b64_tr_b16 v[68:69], v8 offset:24576
v_mfma_f32_16x16x32_bf16 v[208:211], v[76:79], v[36:39], 0
s_add_u32 s72, s69, 144384
buffer_load_dwordx4 v5, s[4:7], s72 offen offset:3072 lds
v_mfma_f32_16x16x32_bf16 v[208:211], v[72:75], v[32:35], v[208:211]
ds_read_b64_tr_b16 v[70:71], v8 offset:25600
v_accvgpr_read_b32 v20, a16
v_mfma_f32_16x16x32_bf16 v[224:227], v[80:83], v[32:35], 0
ds_read_b64_tr_b16 v[72:73], v9 offset:16384
v_accvgpr_read_b32 v28, a17
v_mfma_f32_16x16x32_bf16 v[224:227], v[84:87], v[36:39], v[224:227]
ds_read_b64_tr_b16 v[74:75], v9 offset:17408
v_accvgpr_read_b32 v21, a18
v_mfma_f32_16x16x32_bf16 v[228:231], v[84:87], v[44:47], 0
s_add_u32 m0, s63, 135168
v_accvgpr_read_b32 v29, a19
v_accvgpr_read_b32 v22, a48
v_mfma_f32_16x16x32_bf16 v[228:231], v[80:83], v[40:43], v[228:231]
s_add_u32 s72, s70, 0
buffer_load_dwordx4 v4, s[4:7], s72 offen lds
v_mfma_f32_16x16x32_bf16 v[232:235], v[80:83], v[48:51], 0
ds_read_b64_tr_b16 v[76:77], v9 offset:24576
v_accvgpr_read_b32 v30, a49
v_mfma_f32_16x16x32_bf16 v[232:235], v[84:87], v[52:55], v[232:235]
ds_read_b128 v[124:127], v19 offset:6144
v_accvgpr_read_b32 v23, a50
v_mfma_f32_16x16x32_bf16 v[236:239], v[84:87], v[60:63], 0
ds_read_b64_tr_b16 v[78:79], v9 offset:25600
v_accvgpr_read_b32 v31, a51
v_mfma_f32_16x16x32_bf16 v[236:239], v[80:83], v[56:59], v[236:239]
v_mul_f32 v20, s79, v20
v_mul_f32 v28, s79, v28
v_mfma_f32_16x16x32_bf16 v[252:255], v[88:91], v[56:59], 0
s_add_u32 s72, s70, 15360
buffer_load_dwordx4 v5, s[4:7], s72 offen offset:1024 lds
v_mfma_f32_16x16x32_bf16 v[252:255], v[92:95], v[60:63], v[252:255]
ds_read_b64_tr_b16 v[80:81], v10 offset:16384
v_mul_f32 v21, s79, v21
v_mfma_f32_16x16x32_bf16 v[248:251], v[92:95], v[52:55], 0
ds_read_b64_tr_b16 v[82:83], v10 offset:17408
v_mul_f32 v29, s79, v29
v_mfma_f32_16x16x32_bf16 v[248:251], v[88:91], v[48:51], v[248:251]
v_mul_f32 v22, s79, v22
v_mul_f32 v30, s79, v30
v_mfma_f32_16x16x32_bf16 v[244:247], v[88:91], v[40:43], 0
ds_read_b64_tr_b16 v[84:85], v10 offset:24576
v_mul_f32 v23, s79, v23
v_mfma_f32_16x16x32_bf16 v[244:247], v[92:95], v[44:47], v[244:247]
ds_read_b64_tr_b16 v[86:87], v10 offset:25600
v_mul_f32 v31, s79, v31
v_mfma_f32_16x16x32_bf16 v[240:243], v[92:95], v[36:39], 0
s_add_u32 s72, s70, 129024
buffer_load_dwordx4 v4, s[4:7], s72 offen offset:2048 lds
v_mfma_f32_16x16x32_bf16 v[240:243], v[88:91], v[32:35], v[240:243]
s_waitcnt lgkmcnt(5)
v_cvt_pk_bf16_f32 v20, v20, v28
v_cvt_pk_bf16_f32 v21, v21, v29
v_mfma_f32_16x16x32_bf16 v[128:131], v[64:67], v[96:99], v[128:131]
ds_read_b64_tr_b16 v[88:89], v11 offset:16384
v_cvt_pk_bf16_f32 v22, v22, v30
v_mfma_f32_16x16x32_bf16 v[128:131], v[68:71], v[100:103], v[128:131]
ds_read_b64_tr_b16 v[90:91], v11 offset:17408
v_cvt_pk_bf16_f32 v23, v23, v31
v_mfma_f32_16x16x32_bf16 v[132:135], v[68:71], v[108:111], v[132:135]
s_add_u32 s80, s77, 32768
buffer_store_dwordx4 v[20:23], v1, s[44:47], s80 offen sc1
v_mfma_f32_16x16x32_bf16 v[132:135], v[64:67], v[104:107], v[132:135]
s_add_u32 s72, s70, 144384
buffer_load_dwordx4 v5, s[4:7], s72 offen offset:3072 lds
v_mfma_f32_16x16x32_bf16 v[136:139], v[64:67], v[112:115], v[136:139]
ds_read_b64_tr_b16 v[92:93], v11 offset:24576
v_accvgpr_read_b32 v24, a144
v_mfma_f32_16x16x32_bf16 v[136:139], v[68:71], v[116:119], v[136:139]
s_lshl_b32 s71, s73, 12
v_accvgpr_read_b32 v28, a145
v_accvgpr_read_b32 v25, a146
v_mfma_f32_16x16x32_bf16 v[140:143], v[68:71], v[124:127], v[140:143]
s_add_u32 s71, s71, s66
ds_read_b64_tr_b16 v[94:95], v11 offset:25600
v_accvgpr_read_b32 v29, a147
v_mfma_f32_16x16x32_bf16 v[140:143], v[64:67], v[120:123], v[140:143]
s_waitcnt lgkmcnt(8)
v_accvgpr_read_b32 v26, a148
v_accvgpr_read_b32 v30, a149
v_mfma_f32_16x16x32_bf16 v[156:159], v[72:75], v[120:123], v[156:159]
s_add_u32 m0, s64, 0
ds_read_b64_tr_b16 v[64:65], v12 offset:16384
v_accvgpr_read_b32 v27, a150
v_mfma_f32_16x16x32_bf16 v[156:159], v[76:79], v[124:127], v[156:159]
s_add_u32 s72, s71, 0
buffer_load_dwordx4 v6, s[12:15], s72 offen lds
v_mfma_f32_16x16x32_bf16 v[152:155], v[76:79], v[116:119], v[152:155]
s_add_u32 s73, s62, 4
ds_read_b64_tr_b16 v[66:67], v12 offset:17408
v_accvgpr_read_b32 v31, a151
v_mfma_f32_16x16x32_bf16 v[152:155], v[72:75], v[112:115], v[152:155]
s_add_u32 s70, s73, s65
v_cvt_pk_bf16_f32 v24, v24, v28
v_cvt_pk_bf16_f32 v25, v25, v29
v_mfma_f32_16x16x32_bf16 v[148:151], v[72:75], v[104:107], v[148:151]
s_and_b32 s70, s70, 3
ds_read_b64_tr_b16 v[68:69], v12 offset:24576
v_cvt_pk_bf16_f32 v26, v26, v30
v_mfma_f32_16x16x32_bf16 v[148:151], v[76:79], v[108:111], v[148:151]
s_and_b32 s73, s73, 12
ds_read_b64_tr_b16 v[70:71], v12 offset:25600
v_cvt_pk_bf16_f32 v27, v27, v31
v_mfma_f32_16x16x32_bf16 v[144:147], v[76:79], v[100:103], v[144:147]
s_add_u32 s72, s71, 31744
buffer_load_dwordx4 v6, s[12:15], s72 offen offset:1024 lds
v_mfma_f32_16x16x32_bf16 v[144:147], v[72:75], v[96:99], v[144:147]
s_waitcnt lgkmcnt(8)
v_mfma_f32_16x16x32_bf16 v[160:163], v[80:83], v[96:99], v[160:163]
s_or_b32 s73, s73, s70
ds_read_b64_tr_b16 v[72:73], v13 offset:16384
v_mfma_f32_16x16x32_bf16 v[160:163], v[84:87], v[100:103], v[160:163]
s_lshl_b32 s73, s73, 7
ds_read_b64_tr_b16 v[74:75], v13 offset:17408
v_mfma_f32_16x16x32_bf16 v[164:167], v[84:87], v[108:111], v[164:167]
s_add_u32 s69, s73, s67
v_mfma_f32_16x16x32_bf16 v[164:167], v[80:83], v[104:107], v[164:167]
s_add_u32 s72, s71, 63488
buffer_load_dwordx4 v7, s[12:15], s72 offen offset:2048 lds
v_mfma_f32_16x16x32_bf16 v[168:171], v[80:83], v[112:115], v[168:171]
s_waitcnt vmcnt(18)
ds_read_b64_tr_b16 v[76:77], v13 offset:24576
v_mfma_f32_16x16x32_bf16 v[168:171], v[84:87], v[116:119], v[168:171]
s_add_u32 s70, s73, s68
ds_read_b128 v[32:35], v18 offset:32768
v_mfma_f32_16x16x32_bf16 v[172:175], v[84:87], v[124:127], v[172:175]
s_add_u32 s80, s78, 32768
ds_read_b64_tr_b16 v[78:79], v13 offset:25600
v_mfma_f32_16x16x32_bf16 v[172:175], v[80:83], v[120:123], v[172:175]
s_waitcnt lgkmcnt(9)
ds_read_b128 v[36:39], v19 offset:32768
v_mfma_f32_16x16x32_bf16 v[188:191], v[88:91], v[120:123], v[188:191]
s_add_u32 s72, s71, 95232
buffer_load_dwordx4 v7, s[12:15], s72 offen offset:3072 lds
v_mfma_f32_16x16x32_bf16 v[188:191], v[92:95], v[124:127], v[188:191]
ds_read_b64_tr_b16 v[80:81], v14 offset:16384
v_mfma_f32_16x16x32_bf16 v[184:187], v[92:95], v[116:119], v[184:187]
ds_read_b64_tr_b16 v[82:83], v14 offset:17408
v_mfma_f32_16x16x32_bf16 v[184:187], v[88:91], v[112:115], v[184:187]
buffer_store_dwordx4 v[24:27], v1, s[44:47], s80 offen sc1
v_mfma_f32_16x16x32_bf16 v[180:183], v[88:91], v[104:107], v[180:183]
ds_read_b64_tr_b16 v[84:85], v14 offset:24576
v_accvgpr_read_b32 v20, a20
v_mfma_f32_16x16x32_bf16 v[180:183], v[92:95], v[108:111], v[180:183]
s_add_u32 m0, s63, 65536
ds_read_b64_tr_b16 v[86:87], v14 offset:25600
v_accvgpr_read_b32 v28, a21
v_mfma_f32_16x16x32_bf16 v[176:179], v[92:95], v[100:103], v[176:179]
s_add_u32 s72, s69, 0
buffer_load_dwordx4 v4, s[4:7], s72 offen lds
v_mfma_f32_16x16x32_bf16 v[176:179], v[88:91], v[96:99], v[176:179]
s_waitcnt lgkmcnt(10)
ds_read_b128 v[40:43], v18 offset:34816
v_accvgpr_read_b32 v21, a22
v_mfma_f32_16x16x32_bf16 v[192:195], v[64:67], v[96:99], v[192:195]
ds_read_b64_tr_b16 v[88:89], v15 offset:16384
v_accvgpr_read_b32 v29, a23
v_mfma_f32_16x16x32_bf16 v[192:195], v[68:71], v[100:103], v[192:195]
ds_read_b64_tr_b16 v[90:91], v15 offset:17408
v_accvgpr_read_b32 v22, a52
v_mfma_f32_16x16x32_bf16 v[196:199], v[68:71], v[108:111], v[196:199]
ds_read_b64_tr_b16 v[92:93], v15 offset:24576
v_accvgpr_read_b32 v30, a53
v_mfma_f32_16x16x32_bf16 v[196:199], v[64:67], v[104:107], v[196:199]
s_add_u32 s72, s69, 15360
buffer_load_dwordx4 v5, s[4:7], s72 offen offset:1024 lds
v_mfma_f32_16x16x32_bf16 v[200:203], v[64:67], v[112:115], v[200:203]
ds_read_b64_tr_b16 v[94:95], v15 offset:25600
v_accvgpr_read_b32 v23, a54
v_mfma_f32_16x16x32_bf16 v[200:203], v[68:71], v[116:119], v[200:203]
ds_read_b128 v[44:47], v19 offset:34816
v_accvgpr_read_b32 v31, a55
v_mfma_f32_16x16x32_bf16 v[204:207], v[68:71], v[124:127], v[204:207]
v_mul_f32 v20, s79, v20
v_mul_f32 v28, s79, v28
v_mfma_f32_16x16x32_bf16 v[204:207], v[64:67], v[120:123], v[204:207]
s_waitcnt lgkmcnt(11)
ds_read_b128 v[48:51], v18 offset:36864
v_mul_f32 v21, s79, v21
v_mfma_f32_16x16x32_bf16 v[220:223], v[72:75], v[120:123], v[220:223]
s_add_u32 s72, s69, 129024
buffer_load_dwordx4 v4, s[4:7], s72 offen offset:2048 lds
v_mfma_f32_16x16x32_bf16 v[220:223], v[76:79], v[124:127], v[220:223]
v_mul_f32 v29, s79, v29
v_mul_f32 v22, s79, v22
v_mfma_f32_16x16x32_bf16 v[216:219], v[76:79], v[116:119], v[216:219]
s_waitcnt vmcnt(19) lgkmcnt(2)
ds_read_b128 v[52:55], v19 offset:36864
v_mul_f32 v30, s79, v30
v_mfma_f32_16x16x32_bf16 v[216:219], v[72:75], v[112:115], v[216:219]
s_barrier
ds_read_b128 v[56:59], v18 offset:38912
v_mul_f32 v23, s79, v23
v_mfma_f32_16x16x32_bf16 v[212:215], v[72:75], v[104:107], v[212:215]
ds_read_b64_tr_b16 v[64:65], v8 offset:32768
ds_read_b64_tr_b16 v[66:67], v8 offset:33792
v_mfma_f32_16x16x32_bf16 v[212:215], v[76:79], v[108:111], v[212:215]
ds_read_b64_tr_b16 v[68:69], v8 offset:40960
v_mul_f32 v31, s79, v31
v_mfma_f32_16x16x32_bf16 v[208:211], v[76:79], v[100:103], v[208:211]
s_add_u32 s72, s69, 144384
buffer_load_dwordx4 v5, s[4:7], s72 offen offset:3072 lds
v_mfma_f32_16x16x32_bf16 v[208:211], v[72:75], v[96:99], v[208:211]
ds_read_b64_tr_b16 v[70:71], v8 offset:41984
v_cvt_pk_bf16_f32 v20, v20, v28
v_mfma_f32_16x16x32_bf16 v[224:227], v[80:83], v[96:99], v[224:227]
ds_read_b64_tr_b16 v[72:73], v9 offset:32768
v_cvt_pk_bf16_f32 v21, v21, v29
v_mfma_f32_16x16x32_bf16 v[224:227], v[84:87], v[100:103], v[224:227]
ds_read_b64_tr_b16 v[74:75], v9 offset:33792
v_cvt_pk_bf16_f32 v22, v22, v30
v_mfma_f32_16x16x32_bf16 v[228:231], v[84:87], v[108:111], v[228:231]
s_add_u32 m0, s63, 69632
v_cvt_pk_bf16_f32 v23, v23, v31
v_accvgpr_read_b32 v24, a152
v_mfma_f32_16x16x32_bf16 v[228:231], v[80:83], v[104:107], v[228:231]
s_add_u32 s72, s70, 0
buffer_load_dwordx4 v4, s[4:7], s72 offen lds
v_mfma_f32_16x16x32_bf16 v[232:235], v[80:83], v[112:115], v[232:235]
s_add_u32 s80, s77, 36864
ds_read_b64_tr_b16 v[76:77], v9 offset:40960
v_accvgpr_read_b32 v28, a153
v_mfma_f32_16x16x32_bf16 v[232:235], v[84:87], v[116:119], v[232:235]
ds_read_b128 v[60:63], v19 offset:38912
v_accvgpr_read_b32 v25, a154
v_mfma_f32_16x16x32_bf16 v[236:239], v[84:87], v[124:127], v[236:239]
ds_read_b64_tr_b16 v[78:79], v9 offset:41984
v_accvgpr_read_b32 v29, a155
v_mfma_f32_16x16x32_bf16 v[236:239], v[80:83], v[120:123], v[236:239]
buffer_store_dwordx4 v[20:23], v1, s[44:47], s80 offen sc1
v_mfma_f32_16x16x32_bf16 v[252:255], v[88:91], v[120:123], v[252:255]
s_add_u32 s72, s70, 15360
buffer_load_dwordx4 v5, s[4:7], s72 offen offset:1024 lds
v_mfma_f32_16x16x32_bf16 v[252:255], v[92:95], v[124:127], v[252:255]
ds_read_b64_tr_b16 v[80:81], v10 offset:32768
v_accvgpr_read_b32 v26, a156
v_mfma_f32_16x16x32_bf16 v[248:251], v[92:95], v[116:119], v[248:251]
ds_read_b64_tr_b16 v[82:83], v10 offset:33792
v_accvgpr_read_b32 v30, a157
v_mfma_f32_16x16x32_bf16 v[248:251], v[88:91], v[112:115], v[248:251]
v_accvgpr_read_b32 v27, a158
v_accvgpr_read_b32 v31, a159
v_mfma_f32_16x16x32_bf16 v[244:247], v[88:91], v[104:107], v[244:247]
ds_read_b64_tr_b16 v[84:85], v10 offset:40960
v_cvt_pk_bf16_f32 v24, v24, v28
v_mfma_f32_16x16x32_bf16 v[244:247], v[92:95], v[108:111], v[244:247]
ds_read_b64_tr_b16 v[86:87], v10 offset:41984
v_cvt_pk_bf16_f32 v25, v25, v29
v_mfma_f32_16x16x32_bf16 v[240:243], v[92:95], v[100:103], v[240:243]
s_add_u32 s72, s70, 129024
buffer_load_dwordx4 v4, s[4:7], s72 offen offset:2048 lds
v_mfma_f32_16x16x32_bf16 v[240:243], v[88:91], v[96:99], v[240:243]
s_waitcnt lgkmcnt(5)
v_cvt_pk_bf16_f32 v26, v26, v30
v_cvt_pk_bf16_f32 v27, v27, v31
v_mfma_f32_16x16x32_bf16 v[128:131], v[64:67], v[32:35], v[128:131]
s_add_u32 s80, s78, 40960
ds_read_b64_tr_b16 v[88:89], v11 offset:32768
v_mfma_f32_16x16x32_bf16 v[128:131], v[68:71], v[36:39], v[128:131]
ds_read_b64_tr_b16 v[90:91], v11 offset:33792
v_mfma_f32_16x16x32_bf16 v[132:135], v[68:71], v[44:47], v[132:135]
buffer_store_dwordx4 v[24:27], v1, s[44:47], s80 offen sc1
v_mfma_f32_16x16x32_bf16 v[132:135], v[64:67], v[40:43], v[132:135]
s_add_u32 s72, s70, 144384
buffer_load_dwordx4 v5, s[4:7], s72 offen offset:3072 lds
v_mfma_f32_16x16x32_bf16 v[136:139], v[64:67], v[48:51], v[136:139]
ds_read_b64_tr_b16 v[92:93], v11 offset:40960
v_mfma_f32_16x16x32_bf16 v[136:139], v[68:71], v[52:55], v[136:139]
s_lshl_b32 s71, s73, 12
v_mfma_f32_16x16x32_bf16 v[140:143], v[68:71], v[60:63], v[140:143]
s_add_u32 s71, s71, s66
ds_read_b64_tr_b16 v[94:95], v11 offset:41984
v_mfma_f32_16x16x32_bf16 v[140:143], v[64:67], v[56:59], v[140:143]
s_waitcnt lgkmcnt(8)
v_accvgpr_read_b32 v20, a24
v_accvgpr_read_b32 v28, a25
v_mfma_f32_16x16x32_bf16 v[156:159], v[72:75], v[56:59], v[156:159]
s_add_u32 m0, s64, 16384
ds_read_b64_tr_b16 v[64:65], v12 offset:32768
v_accvgpr_read_b32 v21, a26
v_mfma_f32_16x16x32_bf16 v[156:159], v[76:79], v[60:63], v[156:159]
s_add_u32 s72, s71, 0
buffer_load_dwordx4 v6, s[12:15], s72 offen lds
v_mfma_f32_16x16x32_bf16 v[152:155], v[76:79], v[52:55], v[152:155]
s_add_u32 s73, s62, 5
ds_read_b64_tr_b16 v[66:67], v12 offset:33792
v_accvgpr_read_b32 v29, a27
v_mfma_f32_16x16x32_bf16 v[152:155], v[72:75], v[48:51], v[152:155]
s_add_u32 s70, s73, s65
v_accvgpr_read_b32 v22, a56
v_accvgpr_read_b32 v30, a57
v_mfma_f32_16x16x32_bf16 v[148:151], v[72:75], v[40:43], v[148:151]
s_and_b32 s70, s70, 3
ds_read_b64_tr_b16 v[68:69], v12 offset:40960
v_accvgpr_read_b32 v23, a58
v_mfma_f32_16x16x32_bf16 v[148:151], v[76:79], v[44:47], v[148:151]
s_and_b32 s73, s73, 12
ds_read_b64_tr_b16 v[70:71], v12 offset:41984
v_accvgpr_read_b32 v31, a59
v_mfma_f32_16x16x32_bf16 v[144:147], v[76:79], v[36:39], v[144:147]
s_add_u32 s72, s71, 31744
buffer_load_dwordx4 v6, s[12:15], s72 offen offset:1024 lds
v_mfma_f32_16x16x32_bf16 v[144:147], v[72:75], v[32:35], v[144:147]
s_waitcnt lgkmcnt(8)
v_mul_f32 v20, s79, v20
v_mul_f32 v28, s79, v28
v_mfma_f32_16x16x32_bf16 v[160:163], v[80:83], v[32:35], v[160:163]
s_or_b32 s73, s73, s70
ds_read_b64_tr_b16 v[72:73], v13 offset:32768
v_mul_f32 v21, s79, v21
v_mfma_f32_16x16x32_bf16 v[160:163], v[84:87], v[36:39], v[160:163]
s_lshl_b32 s73, s73, 7
ds_read_b64_tr_b16 v[74:75], v13 offset:33792
v_mul_f32 v29, s79, v29
v_mfma_f32_16x16x32_bf16 v[164:167], v[84:87], v[44:47], v[164:167]
s_add_u32 s69, s73, s67
v_mul_f32 v22, s79, v22
v_mul_f32 v30, s79, v30
v_mfma_f32_16x16x32_bf16 v[164:167], v[80:83], v[40:43], v[164:167]
s_add_u32 s72, s71, 63488
buffer_load_dwordx4 v7, s[12:15], s72 offen offset:2048 lds
v_mfma_f32_16x16x32_bf16 v[168:171], v[80:83], v[48:51], v[168:171]
s_waitcnt vmcnt(18)
ds_read_b64_tr_b16 v[76:77], v13 offset:40960
v_mul_f32 v23, s79, v23
v_mfma_f32_16x16x32_bf16 v[168:171], v[84:87], v[52:55], v[168:171]
s_add_u32 s70, s73, s68
ds_read_b128 v[96:99], v16 offset:0
v_mul_f32 v31, s79, v31
v_mfma_f32_16x16x32_bf16 v[172:175], v[84:87], v[60:63], v[172:175]
ds_read_b64_tr_b16 v[78:79], v13 offset:41984
v_cvt_pk_bf16_f32 v20, v20, v28
v_mfma_f32_16x16x32_bf16 v[172:175], v[80:83], v[56:59], v[172:175]
s_waitcnt lgkmcnt(9)
ds_read_b128 v[100:103], v17 offset:0
v_cvt_pk_bf16_f32 v21, v21, v29
v_mfma_f32_16x16x32_bf16 v[188:191], v[88:91], v[56:59], v[188:191]
s_add_u32 s72, s71, 95232
buffer_load_dwordx4 v7, s[12:15], s72 offen offset:3072 lds
v_mfma_f32_16x16x32_bf16 v[188:191], v[92:95], v[60:63], v[188:191]
ds_read_b64_tr_b16 v[80:81], v14 offset:32768
v_cvt_pk_bf16_f32 v22, v22, v30
v_mfma_f32_16x16x32_bf16 v[184:187], v[92:95], v[52:55], v[184:187]
ds_read_b64_tr_b16 v[82:83], v14 offset:33792
v_cvt_pk_bf16_f32 v23, v23, v31
v_mfma_f32_16x16x32_bf16 v[184:187], v[88:91], v[48:51], v[184:187]
s_add_u32 s80, s77, 40960
buffer_store_dwordx4 v[20:23], v1, s[44:47], s80 offen sc1
v_mfma_f32_16x16x32_bf16 v[180:183], v[88:91], v[40:43], v[180:183]
ds_read_b64_tr_b16 v[84:85], v14 offset:40960
v_mfma_f32_16x16x32_bf16 v[180:183], v[92:95], v[44:47], v[180:183]
s_add_u32 m0, s63, 98304
ds_read_b64_tr_b16 v[86:87], v14 offset:41984
v_accvgpr_read_b32 v24, a160
v_mfma_f32_16x16x32_bf16 v[176:179], v[92:95], v[36:39], v[176:179]
s_add_u32 s72, s69, 0
buffer_load_dwordx4 v4, s[4:7], s72 offen lds
v_mfma_f32_16x16x32_bf16 v[176:179], v[88:91], v[32:35], v[176:179]
s_waitcnt lgkmcnt(10)
ds_read_b128 v[104:107], v16 offset:2048
v_accvgpr_read_b32 v28, a161
v_mfma_f32_16x16x32_bf16 v[192:195], v[64:67], v[32:35], v[192:195]
ds_read_b64_tr_b16 v[88:89], v15 offset:32768
v_accvgpr_read_b32 v25, a162
v_mfma_f32_16x16x32_bf16 v[192:195], v[68:71], v[36:39], v[192:195]
ds_read_b64_tr_b16 v[90:91], v15 offset:33792
v_accvgpr_read_b32 v29, a163
v_mfma_f32_16x16x32_bf16 v[196:199], v[68:71], v[44:47], v[196:199]
ds_read_b64_tr_b16 v[92:93], v15 offset:40960
v_accvgpr_read_b32 v26, a164
v_mfma_f32_16x16x32_bf16 v[196:199], v[64:67], v[40:43], v[196:199]
s_add_u32 s72, s69, 15360
buffer_load_dwordx4 v5, s[4:7], s72 offen offset:1024 lds
v_mfma_f32_16x16x32_bf16 v[200:203], v[64:67], v[48:51], v[200:203]
ds_read_b64_tr_b16 v[94:95], v15 offset:41984
v_accvgpr_read_b32 v30, a165
v_mfma_f32_16x16x32_bf16 v[200:203], v[68:71], v[52:55], v[200:203]
ds_read_b128 v[108:111], v17 offset:2048
v_accvgpr_read_b32 v27, a166
v_mfma_f32_16x16x32_bf16 v[204:207], v[68:71], v[60:63], v[204:207]
v_accvgpr_read_b32 v31, a167
v_cvt_pk_bf16_f32 v24, v24, v28
v_mfma_f32_16x16x32_bf16 v[204:207], v[64:67], v[56:59], v[204:207]
s_waitcnt lgkmcnt(11)
ds_read_b128 v[112:115], v16 offset:4096
v_cvt_pk_bf16_f32 v25, v25, v29
v_mfma_f32_16x16x32_bf16 v[220:223], v[72:75], v[56:59], v[220:223]
s_add_u32 s72, s69, 129024
buffer_load_dwordx4 v4, s[4:7], s72 offen offset:2048 lds
v_mfma_f32_16x16x32_bf16 v[220:223], v[76:79], v[60:63], v[220:223]
v_cvt_pk_bf16_f32 v26, v26, v30
v_cvt_pk_bf16_f32 v27, v27, v31
v_mfma_f32_16x16x32_bf16 v[216:219], v[76:79], v[52:55], v[216:219]
s_waitcnt vmcnt(19) lgkmcnt(2)
ds_read_b128 v[116:119], v17 offset:4096
v_mfma_f32_16x16x32_bf16 v[216:219], v[72:75], v[48:51], v[216:219]
s_barrier
ds_read_b128 v[120:123], v16 offset:6144
v_mfma_f32_16x16x32_bf16 v[212:215], v[72:75], v[40:43], v[212:215]
s_add_u32 s80, s78, 1024
ds_read_b64_tr_b16 v[64:65], v8 offset:0
ds_read_b64_tr_b16 v[66:67], v8 offset:1024
v_mfma_f32_16x16x32_bf16 v[212:215], v[76:79], v[44:47], v[212:215]
ds_read_b64_tr_b16 v[68:69], v8 offset:8192
v_mfma_f32_16x16x32_bf16 v[208:211], v[76:79], v[36:39], v[208:211]
s_add_u32 s72, s69, 144384
buffer_load_dwordx4 v5, s[4:7], s72 offen offset:3072 lds
v_mfma_f32_16x16x32_bf16 v[208:211], v[72:75], v[32:35], v[208:211]
ds_read_b64_tr_b16 v[70:71], v8 offset:9216
v_mfma_f32_16x16x32_bf16 v[224:227], v[80:83], v[32:35], v[224:227]
ds_read_b64_tr_b16 v[72:73], v9 offset:0
v_mfma_f32_16x16x32_bf16 v[224:227], v[84:87], v[36:39], v[224:227]
ds_read_b64_tr_b16 v[74:75], v9 offset:1024
v_mfma_f32_16x16x32_bf16 v[228:231], v[84:87], v[44:47], v[228:231]
s_add_u32 m0, s63, 102400
buffer_store_dwordx4 v[24:27], v1, s[44:47], s80 offen sc1
v_mfma_f32_16x16x32_bf16 v[228:231], v[80:83], v[40:43], v[228:231]
s_add_u32 s72, s70, 0
buffer_load_dwordx4 v4, s[4:7], s72 offen lds
v_mfma_f32_16x16x32_bf16 v[232:235], v[80:83], v[48:51], v[232:235]
ds_read_b64_tr_b16 v[76:77], v9 offset:8192
v_accvgpr_read_b32 v20, a28
v_mfma_f32_16x16x32_bf16 v[232:235], v[84:87], v[52:55], v[232:235]
ds_read_b128 v[124:127], v17 offset:6144
v_accvgpr_read_b32 v28, a29
v_mfma_f32_16x16x32_bf16 v[236:239], v[84:87], v[60:63], v[236:239]
ds_read_b64_tr_b16 v[78:79], v9 offset:9216
v_accvgpr_read_b32 v21, a30
v_mfma_f32_16x16x32_bf16 v[236:239], v[80:83], v[56:59], v[236:239]
v_accvgpr_read_b32 v29, a31
v_accvgpr_read_b32 v22, a60
v_mfma_f32_16x16x32_bf16 v[252:255], v[88:91], v[56:59], v[252:255]
s_add_u32 s72, s70, 15360
buffer_load_dwordx4 v5, s[4:7], s72 offen offset:1024 lds
v_mfma_f32_16x16x32_bf16 v[252:255], v[92:95], v[60:63], v[252:255]
ds_read_b64_tr_b16 v[80:81], v10 offset:0
v_accvgpr_read_b32 v30, a61
v_mfma_f32_16x16x32_bf16 v[248:251], v[92:95], v[52:55], v[248:251]
ds_read_b64_tr_b16 v[82:83], v10 offset:1024
v_accvgpr_read_b32 v23, a62
v_mfma_f32_16x16x32_bf16 v[248:251], v[88:91], v[48:51], v[248:251]
v_accvgpr_read_b32 v31, a63
v_mul_f32 v20, s79, v20
v_mfma_f32_16x16x32_bf16 v[244:247], v[88:91], v[40:43], v[244:247]
ds_read_b64_tr_b16 v[84:85], v10 offset:8192
v_mul_f32 v28, s79, v28
v_mfma_f32_16x16x32_bf16 v[244:247], v[92:95], v[44:47], v[244:247]
ds_read_b64_tr_b16 v[86:87], v10 offset:9216
v_mul_f32 v21, s79, v21
v_mfma_f32_16x16x32_bf16 v[240:243], v[92:95], v[36:39], v[240:243]
s_add_u32 s72, s70, 129024
buffer_load_dwordx4 v4, s[4:7], s72 offen offset:2048 lds
v_mfma_f32_16x16x32_bf16 v[240:243], v[88:91], v[32:35], v[240:243]
s_waitcnt lgkmcnt(5)
v_mul_f32 v29, s79, v29
v_mul_f32 v22, s79, v22
v_mfma_f32_16x16x32_bf16 v[128:131], v[64:67], v[96:99], v[128:131]
ds_read_b64_tr_b16 v[88:89], v11 offset:0
v_mul_f32 v30, s79, v30
v_mfma_f32_16x16x32_bf16 v[128:131], v[68:71], v[100:103], v[128:131]
ds_read_b64_tr_b16 v[90:91], v11 offset:1024
v_mul_f32 v23, s79, v23
v_mfma_f32_16x16x32_bf16 v[132:135], v[68:71], v[108:111], v[132:135]
v_mul_f32 v31, s79, v31
v_cvt_pk_bf16_f32 v20, v20, v28
v_mfma_f32_16x16x32_bf16 v[132:135], v[64:67], v[104:107], v[132:135]
s_add_u32 s72, s70, 144384
buffer_load_dwordx4 v5, s[4:7], s72 offen offset:3072 lds
v_mfma_f32_16x16x32_bf16 v[136:139], v[64:67], v[112:115], v[136:139]
ds_read_b64_tr_b16 v[92:93], v11 offset:8192
v_cvt_pk_bf16_f32 v21, v21, v29
v_mfma_f32_16x16x32_bf16 v[136:139], v[68:71], v[116:119], v[136:139]
s_lshl_b32 s71, s73, 12
v_cvt_pk_bf16_f32 v22, v22, v30
v_cvt_pk_bf16_f32 v23, v23, v31
v_mfma_f32_16x16x32_bf16 v[140:143], v[68:71], v[124:127], v[140:143]
s_add_u32 s71, s71, s66
ds_read_b64_tr_b16 v[94:95], v11 offset:9216
v_mfma_f32_16x16x32_bf16 v[140:143], v[64:67], v[120:123], v[140:143]
s_waitcnt lgkmcnt(8)
v_mfma_f32_16x16x32_bf16 v[156:159], v[72:75], v[120:123], v[156:159]
s_add_u32 m0, s64, 32768
ds_read_b64_tr_b16 v[64:65], v12 offset:0
v_mfma_f32_16x16x32_bf16 v[156:159], v[76:79], v[124:127], v[156:159]
s_add_u32 s72, s71, 0
buffer_load_dwordx4 v6, s[12:15], s72 offen lds
v_mfma_f32_16x16x32_bf16 v[152:155], v[76:79], v[116:119], v[152:155]
s_add_u32 s73, s62, 6
ds_read_b64_tr_b16 v[66:67], v12 offset:1024
v_accvgpr_read_b32 v24, a168
v_mfma_f32_16x16x32_bf16 v[152:155], v[72:75], v[112:115], v[152:155]
s_add_u32 s70, s73, s65
v_accvgpr_read_b32 v28, a169
v_accvgpr_read_b32 v25, a170
v_mfma_f32_16x16x32_bf16 v[148:151], v[72:75], v[104:107], v[148:151]
s_and_b32 s70, s70, 3
ds_read_b64_tr_b16 v[68:69], v12 offset:8192
v_accvgpr_read_b32 v29, a171
v_mfma_f32_16x16x32_bf16 v[148:151], v[76:79], v[108:111], v[148:151]
s_and_b32 s73, s73, 12
ds_read_b64_tr_b16 v[70:71], v12 offset:9216
v_accvgpr_read_b32 v26, a172
v_mfma_f32_16x16x32_bf16 v[144:147], v[76:79], v[100:103], v[144:147]
s_add_u32 s72, s71, 31744
buffer_load_dwordx4 v6, s[12:15], s72 offen offset:1024 lds
v_mfma_f32_16x16x32_bf16 v[144:147], v[72:75], v[96:99], v[144:147]
s_waitcnt lgkmcnt(8)
v_accvgpr_read_b32 v30, a173
v_accvgpr_read_b32 v27, a174
v_mfma_f32_16x16x32_bf16 v[160:163], v[80:83], v[96:99], v[160:163]
s_or_b32 s73, s73, s70
ds_read_b64_tr_b16 v[72:73], v13 offset:0
v_accvgpr_read_b32 v31, a175
v_mfma_f32_16x16x32_bf16 v[160:163], v[84:87], v[100:103], v[160:163]
s_lshl_b32 s73, s73, 7
ds_read_b64_tr_b16 v[74:75], v13 offset:1024
v_cvt_pk_bf16_f32 v24, v24, v28
v_mfma_f32_16x16x32_bf16 v[164:167], v[84:87], v[108:111], v[164:167]
s_add_u32 s69, s73, s67
v_cvt_pk_bf16_f32 v25, v25, v29
v_cvt_pk_bf16_f32 v26, v26, v30
v_mfma_f32_16x16x32_bf16 v[164:167], v[80:83], v[104:107], v[164:167]
s_add_u32 s72, s71, 63488
buffer_load_dwordx4 v7, s[12:15], s72 offen offset:2048 lds
v_mfma_f32_16x16x32_bf16 v[168:171], v[80:83], v[112:115], v[168:171]
s_waitcnt vmcnt(17)
ds_read_b64_tr_b16 v[76:77], v13 offset:8192
v_cvt_pk_bf16_f32 v27, v27, v31
v_mfma_f32_16x16x32_bf16 v[168:171], v[84:87], v[116:119], v[168:171]
s_add_u32 s70, s73, s68
ds_read_b128 v[32:35], v18 offset:0
v_mfma_f32_16x16x32_bf16 v[172:175], v[84:87], v[124:127], v[172:175]
s_add_u32 s80, s77, 45056
ds_read_b64_tr_b16 v[78:79], v13 offset:9216
v_mfma_f32_16x16x32_bf16 v[172:175], v[80:83], v[120:123], v[172:175]
s_waitcnt lgkmcnt(9)
ds_read_b128 v[36:39], v19 offset:0
v_mfma_f32_16x16x32_bf16 v[188:191], v[88:91], v[120:123], v[188:191]
s_add_u32 s72, s71, 95232
buffer_load_dwordx4 v7, s[12:15], s72 offen offset:3072 lds
v_mfma_f32_16x16x32_bf16 v[188:191], v[92:95], v[124:127], v[188:191]
ds_read_b64_tr_b16 v[80:81], v14 offset:0
v_mfma_f32_16x16x32_bf16 v[184:187], v[92:95], v[116:119], v[184:187]
ds_read_b64_tr_b16 v[82:83], v14 offset:1024
v_mfma_f32_16x16x32_bf16 v[184:187], v[88:91], v[112:115], v[184:187]
buffer_store_dwordx4 v[20:23], v1, s[44:47], s80 offen sc1
v_mfma_f32_16x16x32_bf16 v[180:183], v[88:91], v[104:107], v[180:183]
s_add_u32 s80, s78, 9216
ds_read_b64_tr_b16 v[84:85], v14 offset:8192
v_mfma_f32_16x16x32_bf16 v[180:183], v[92:95], v[108:111], v[180:183]
s_add_u32 m0, s63, 131072
ds_read_b64_tr_b16 v[86:87], v14 offset:9216
v_mfma_f32_16x16x32_bf16 v[176:179], v[92:95], v[100:103], v[176:179]
s_add_u32 s72, s69, 0
buffer_load_dwordx4 v4, s[4:7], s72 offen lds
v_mfma_f32_16x16x32_bf16 v[176:179], v[88:91], v[96:99], v[176:179]
s_waitcnt lgkmcnt(10)
ds_read_b128 v[40:43], v18 offset:2048
v_accvgpr_read_b32 v20, a64
v_mfma_f32_16x16x32_bf16 v[192:195], v[64:67], v[96:99], v[192:195]
ds_read_b64_tr_b16 v[88:89], v15 offset:0
v_accvgpr_read_b32 v28, a65
v_mfma_f32_16x16x32_bf16 v[192:195], v[68:71], v[100:103], v[192:195]
ds_read_b64_tr_b16 v[90:91], v15 offset:1024
v_accvgpr_read_b32 v21, a66
v_mfma_f32_16x16x32_bf16 v[196:199], v[68:71], v[108:111], v[196:199]
ds_read_b64_tr_b16 v[92:93], v15 offset:8192
v_accvgpr_read_b32 v29, a67
v_mfma_f32_16x16x32_bf16 v[196:199], v[64:67], v[104:107], v[196:199]
s_add_u32 s72, s69, 15360
buffer_load_dwordx4 v5, s[4:7], s72 offen offset:1024 lds
v_mfma_f32_16x16x32_bf16 v[200:203], v[64:67], v[112:115], v[200:203]
ds_read_b64_tr_b16 v[94:95], v15 offset:9216
v_accvgpr_read_b32 v22, a96
v_mfma_f32_16x16x32_bf16 v[200:203], v[68:71], v[116:119], v[200:203]
ds_read_b128 v[44:47], v19 offset:2048
v_accvgpr_read_b32 v30, a97
v_mfma_f32_16x16x32_bf16 v[204:207], v[68:71], v[124:127], v[204:207]
buffer_store_dwordx4 v[24:27], v1, s[44:47], s80 offen sc1
v_mfma_f32_16x16x32_bf16 v[204:207], v[64:67], v[120:123], v[204:207]
s_waitcnt lgkmcnt(11)
ds_read_b128 v[48:51], v18 offset:4096
v_accvgpr_read_b32 v23, a98
v_mfma_f32_16x16x32_bf16 v[220:223], v[72:75], v[120:123], v[220:223]
s_add_u32 s72, s69, 129024
buffer_load_dwordx4 v4, s[4:7], s72 offen offset:2048 lds
v_mfma_f32_16x16x32_bf16 v[220:223], v[76:79], v[124:127], v[220:223]
v_accvgpr_read_b32 v31, a99
v_mul_f32 v20, s79, v20
v_mfma_f32_16x16x32_bf16 v[216:219], v[76:79], v[116:119], v[216:219]
s_waitcnt vmcnt(19) lgkmcnt(2)
ds_read_b128 v[52:55], v19 offset:4096
v_mul_f32 v28, s79, v28
v_mfma_f32_16x16x32_bf16 v[216:219], v[72:75], v[112:115], v[216:219]
s_barrier
ds_read_b128 v[56:59], v18 offset:6144
v_mul_f32 v21, s79, v21
v_mfma_f32_16x16x32_bf16 v[212:215], v[72:75], v[104:107], v[212:215]
ds_read_b64_tr_b16 v[64:65], v8 offset:16384
ds_read_b64_tr_b16 v[66:67], v8 offset:17408
v_mfma_f32_16x16x32_bf16 v[212:215], v[76:79], v[108:111], v[212:215]
ds_read_b64_tr_b16 v[68:69], v8 offset:24576
v_mul_f32 v29, s79, v29
v_mfma_f32_16x16x32_bf16 v[208:211], v[76:79], v[100:103], v[208:211]
s_add_u32 s72, s69, 144384
buffer_load_dwordx4 v5, s[4:7], s72 offen offset:3072 lds
v_mfma_f32_16x16x32_bf16 v[208:211], v[72:75], v[96:99], v[208:211]
ds_read_b64_tr_b16 v[70:71], v8 offset:25600
v_mul_f32 v22, s79, v22
v_mfma_f32_16x16x32_bf16 v[224:227], v[80:83], v[96:99], v[224:227]
ds_read_b64_tr_b16 v[72:73], v9 offset:16384
v_mul_f32 v30, s79, v30
v_mfma_f32_16x16x32_bf16 v[224:227], v[84:87], v[100:103], v[224:227]
ds_read_b64_tr_b16 v[74:75], v9 offset:17408
v_mul_f32 v23, s79, v23
v_mfma_f32_16x16x32_bf16 v[228:231], v[84:87], v[108:111], v[228:231]
s_add_u32 m0, s63, 135168
v_mul_f32 v31, s79, v31
v_cvt_pk_bf16_f32 v20, v20, v28
v_mfma_f32_16x16x32_bf16 v[228:231], v[80:83], v[104:107], v[228:231]
s_add_u32 s72, s70, 0
buffer_load_dwordx4 v4, s[4:7], s72 offen lds
v_mfma_f32_16x16x32_bf16 v[232:235], v[80:83], v[112:115], v[232:235]
ds_read_b64_tr_b16 v[76:77], v9 offset:24576
v_cvt_pk_bf16_f32 v21, v21, v29
v_mfma_f32_16x16x32_bf16 v[232:235], v[84:87], v[116:119], v[232:235]
ds_read_b128 v[60:63], v19 offset:6144
v_cvt_pk_bf16_f32 v22, v22, v30
v_mfma_f32_16x16x32_bf16 v[236:239], v[84:87], v[124:127], v[236:239]
ds_read_b64_tr_b16 v[78:79], v9 offset:25600
v_cvt_pk_bf16_f32 v23, v23, v31
v_mfma_f32_16x16x32_bf16 v[236:239], v[80:83], v[120:123], v[236:239]
s_add_u32 s80, s77, 1024
buffer_store_dwordx4 v[20:23], v1, s[44:47], s80 offen sc1
v_mfma_f32_16x16x32_bf16 v[252:255], v[88:91], v[120:123], v[252:255]
s_add_u32 s72, s70, 15360
buffer_load_dwordx4 v5, s[4:7], s72 offen offset:1024 lds
v_mfma_f32_16x16x32_bf16 v[252:255], v[92:95], v[124:127], v[252:255]
ds_read_b64_tr_b16 v[80:81], v10 offset:16384
v_accvgpr_read_b32 v24, a176
v_mfma_f32_16x16x32_bf16 v[248:251], v[92:95], v[116:119], v[248:251]
ds_read_b64_tr_b16 v[82:83], v10 offset:17408
v_accvgpr_read_b32 v28, a177
v_mfma_f32_16x16x32_bf16 v[248:251], v[88:91], v[112:115], v[248:251]
v_accvgpr_read_b32 v25, a178
v_accvgpr_read_b32 v29, a179
v_mfma_f32_16x16x32_bf16 v[244:247], v[88:91], v[104:107], v[244:247]
ds_read_b64_tr_b16 v[84:85], v10 offset:24576
v_accvgpr_read_b32 v26, a180
v_mfma_f32_16x16x32_bf16 v[244:247], v[92:95], v[108:111], v[244:247]
ds_read_b64_tr_b16 v[86:87], v10 offset:25600
v_accvgpr_read_b32 v30, a181
v_mfma_f32_16x16x32_bf16 v[240:243], v[92:95], v[100:103], v[240:243]
s_add_u32 s72, s70, 129024
buffer_load_dwordx4 v4, s[4:7], s72 offen offset:2048 lds
v_mfma_f32_16x16x32_bf16 v[240:243], v[88:91], v[96:99], v[240:243]
s_waitcnt lgkmcnt(5)
v_accvgpr_read_b32 v27, a182
v_accvgpr_read_b32 v31, a183
v_mfma_f32_16x16x32_bf16 v[128:131], v[64:67], v[32:35], v[128:131]
ds_read_b64_tr_b16 v[88:89], v11 offset:16384
v_cvt_pk_bf16_f32 v24, v24, v28
v_mfma_f32_16x16x32_bf16 v[128:131], v[68:71], v[36:39], v[128:131]
ds_read_b64_tr_b16 v[90:91], v11 offset:17408
v_cvt_pk_bf16_f32 v25, v25, v29
v_mfma_f32_16x16x32_bf16 v[132:135], v[68:71], v[44:47], v[132:135]
v_cvt_pk_bf16_f32 v26, v26, v30
v_cvt_pk_bf16_f32 v27, v27, v31
v_mfma_f32_16x16x32_bf16 v[132:135], v[64:67], v[40:43], v[132:135]
s_add_u32 s72, s70, 144384
buffer_load_dwordx4 v5, s[4:7], s72 offen offset:3072 lds
v_mfma_f32_16x16x32_bf16 v[136:139], v[64:67], v[48:51], v[136:139]
s_add_u32 s80, s78, 33792
ds_read_b64_tr_b16 v[92:93], v11 offset:24576
v_mfma_f32_16x16x32_bf16 v[136:139], v[68:71], v[52:55], v[136:139]
s_lshl_b32 s71, s73, 12
buffer_store_dwordx4 v[24:27], v1, s[44:47], s80 offen sc1
v_mfma_f32_16x16x32_bf16 v[140:143], v[68:71], v[60:63], v[140:143]
s_add_u32 s71, s71, s66
ds_read_b64_tr_b16 v[94:95], v11 offset:25600
v_mfma_f32_16x16x32_bf16 v[140:143], v[64:67], v[56:59], v[140:143]
s_waitcnt lgkmcnt(8)
v_mfma_f32_16x16x32_bf16 v[156:159], v[72:75], v[56:59], v[156:159]
s_add_u32 m0, s64, 0
ds_read_b64_tr_b16 v[64:65], v12 offset:16384
v_mfma_f32_16x16x32_bf16 v[156:159], v[76:79], v[60:63], v[156:159]
s_add_u32 s72, s71, 0
buffer_load_dwordx4 v6, s[12:15], s72 offen lds
v_mfma_f32_16x16x32_bf16 v[152:155], v[76:79], v[52:55], v[152:155]
s_add_u32 s73, s62, 7
ds_read_b64_tr_b16 v[66:67], v12 offset:17408
v_mfma_f32_16x16x32_bf16 v[152:155], v[72:75], v[48:51], v[152:155]
s_add_u32 s70, s73, s65
v_mfma_f32_16x16x32_bf16 v[148:151], v[72:75], v[40:43], v[148:151]
s_and_b32 s70, s70, 3
ds_read_b64_tr_b16 v[68:69], v12 offset:24576
v_accvgpr_read_b32 v20, a68
v_mfma_f32_16x16x32_bf16 v[148:151], v[76:79], v[44:47], v[148:151]
s_and_b32 s73, s73, 12
ds_read_b64_tr_b16 v[70:71], v12 offset:25600
v_accvgpr_read_b32 v28, a69
v_mfma_f32_16x16x32_bf16 v[144:147], v[76:79], v[36:39], v[144:147]
s_add_u32 s72, s71, 31744
buffer_load_dwordx4 v6, s[12:15], s72 offen offset:1024 lds
v_mfma_f32_16x16x32_bf16 v[144:147], v[72:75], v[32:35], v[144:147]
s_waitcnt lgkmcnt(8)
v_accvgpr_read_b32 v21, a70
v_accvgpr_read_b32 v29, a71
v_mfma_f32_16x16x32_bf16 v[160:163], v[80:83], v[32:35], v[160:163]
s_or_b32 s73, s73, s70
ds_read_b64_tr_b16 v[72:73], v13 offset:16384
v_accvgpr_read_b32 v22, a100
v_mfma_f32_16x16x32_bf16 v[160:163], v[84:87], v[36:39], v[160:163]
s_lshl_b32 s73, s73, 7
ds_read_b64_tr_b16 v[74:75], v13 offset:17408
v_accvgpr_read_b32 v30, a101
v_mfma_f32_16x16x32_bf16 v[164:167], v[84:87], v[44:47], v[164:167]
s_add_u32 s69, s73, s67
v_accvgpr_read_b32 v23, a102
v_accvgpr_read_b32 v31, a103
v_mfma_f32_16x16x32_bf16 v[164:167], v[80:83], v[40:43], v[164:167]
s_add_u32 s72, s71, 63488
buffer_load_dwordx4 v7, s[12:15], s72 offen offset:2048 lds
v_mfma_f32_16x16x32_bf16 v[168:171], v[80:83], v[48:51], v[168:171]
s_waitcnt vmcnt(19)
ds_read_b64_tr_b16 v[76:77], v13 offset:24576
v_mul_f32 v20, s79, v20
v_mfma_f32_16x16x32_bf16 v[168:171], v[84:87], v[52:55], v[168:171]
s_add_u32 s70, s73, s68
ds_read_b128 v[96:99], v18 offset:32768
v_mul_f32 v28, s79, v28
v_mfma_f32_16x16x32_bf16 v[172:175], v[84:87], v[60:63], v[172:175]
ds_read_b64_tr_b16 v[78:79], v13 offset:25600
v_mul_f32 v21, s79, v21
v_mfma_f32_16x16x32_bf16 v[172:175], v[80:83], v[56:59], v[172:175]
s_waitcnt lgkmcnt(9)
ds_read_b128 v[100:103], v19 offset:32768
v_mul_f32 v29, s79, v29
v_mfma_f32_16x16x32_bf16 v[188:191], v[88:91], v[56:59], v[188:191]
s_add_u32 s72, s71, 95232
buffer_load_dwordx4 v7, s[12:15], s72 offen offset:3072 lds
v_mfma_f32_16x16x32_bf16 v[188:191], v[92:95], v[60:63], v[188:191]
ds_read_b64_tr_b16 v[80:81], v14 offset:16384
v_mul_f32 v22, s79, v22
v_mfma_f32_16x16x32_bf16 v[184:187], v[92:95], v[52:55], v[184:187]
ds_read_b64_tr_b16 v[82:83], v14 offset:17408
v_mul_f32 v30, s79, v30
v_mfma_f32_16x16x32_bf16 v[184:187], v[88:91], v[48:51], v[184:187]
v_mul_f32 v23, s79, v23
v_mul_f32 v31, s79, v31
v_mfma_f32_16x16x32_bf16 v[180:183], v[88:91], v[40:43], v[180:183]
ds_read_b64_tr_b16 v[84:85], v14 offset:24576
v_cvt_pk_bf16_f32 v20, v20, v28
v_mfma_f32_16x16x32_bf16 v[180:183], v[92:95], v[44:47], v[180:183]
s_add_u32 m0, s63, 65536
ds_read_b64_tr_b16 v[86:87], v14 offset:25600
v_cvt_pk_bf16_f32 v21, v21, v29
v_mfma_f32_16x16x32_bf16 v[176:179], v[92:95], v[36:39], v[176:179]
s_add_u32 s72, s69, 0
buffer_load_dwordx4 v4, s[4:7], s72 offen lds
v_mfma_f32_16x16x32_bf16 v[176:179], v[88:91], v[32:35], v[176:179]
s_waitcnt lgkmcnt(10)
ds_read_b128 v[104:107], v18 offset:34816
v_cvt_pk_bf16_f32 v22, v22, v30
v_mfma_f32_16x16x32_bf16 v[192:195], v[64:67], v[32:35], v[192:195]
ds_read_b64_tr_b16 v[88:89], v15 offset:16384
v_cvt_pk_bf16_f32 v23, v23, v31
v_mfma_f32_16x16x32_bf16 v[192:195], v[68:71], v[36:39], v[192:195]
s_add_u32 s80, s77, 5120
ds_read_b64_tr_b16 v[90:91], v15 offset:17408
v_mfma_f32_16x16x32_bf16 v[196:199], v[68:71], v[44:47], v[196:199]
ds_read_b64_tr_b16 v[92:93], v15 offset:24576
v_accvgpr_read_b32 v24, a184
v_mfma_f32_16x16x32_bf16 v[196:199], v[64:67], v[40:43], v[196:199]
s_add_u32 s72, s69, 15360
buffer_load_dwordx4 v5, s[4:7], s72 offen offset:1024 lds
v_mfma_f32_16x16x32_bf16 v[200:203], v[64:67], v[48:51], v[200:203]
ds_read_b64_tr_b16 v[94:95], v15 offset:25600
v_accvgpr_read_b32 v28, a185
v_mfma_f32_16x16x32_bf16 v[200:203], v[68:71], v[52:55], v[200:203]
ds_read_b128 v[108:111], v19 offset:34816
v_accvgpr_read_b32 v25, a186
v_mfma_f32_16x16x32_bf16 v[204:207], v[68:71], v[60:63], v[204:207]
buffer_store_dwordx4 v[20:23], v1, s[44:47], s80 offen sc1
v_mfma_f32_16x16x32_bf16 v[204:207], v[64:67], v[56:59], v[204:207]
s_waitcnt lgkmcnt(11)
ds_read_b128 v[112:115], v18 offset:36864
v_accvgpr_read_b32 v29, a187
v_mfma_f32_16x16x32_bf16 v[220:223], v[72:75], v[56:59], v[220:223]
s_add_u32 s72, s69, 129024
buffer_load_dwordx4 v4, s[4:7], s72 offen offset:2048 lds
v_mfma_f32_16x16x32_bf16 v[220:223], v[76:79], v[60:63], v[220:223]
v_accvgpr_read_b32 v26, a188
v_accvgpr_read_b32 v30, a189
v_mfma_f32_16x16x32_bf16 v[216:219], v[76:79], v[52:55], v[216:219]
s_waitcnt vmcnt(20) lgkmcnt(2)
ds_read_b128 v[116:119], v19 offset:36864
v_accvgpr_read_b32 v27, a190
v_mfma_f32_16x16x32_bf16 v[216:219], v[72:75], v[48:51], v[216:219]
s_barrier
ds_read_b128 v[120:123], v18 offset:38912
v_accvgpr_read_b32 v31, a191
v_mfma_f32_16x16x32_bf16 v[212:215], v[72:75], v[40:43], v[212:215]
ds_read_b64_tr_b16 v[64:65], v8 offset:32768
ds_read_b64_tr_b16 v[66:67], v8 offset:33792
v_mfma_f32_16x16x32_bf16 v[212:215], v[76:79], v[44:47], v[212:215]
ds_read_b64_tr_b16 v[68:69], v8 offset:40960
v_cvt_pk_bf16_f32 v24, v24, v28
v_mfma_f32_16x16x32_bf16 v[208:211], v[76:79], v[36:39], v[208:211]
s_add_u32 s72, s69, 144384
buffer_load_dwordx4 v5, s[4:7], s72 offen offset:3072 lds
v_mfma_f32_16x16x32_bf16 v[208:211], v[72:75], v[32:35], v[208:211]
ds_read_b64_tr_b16 v[70:71], v8 offset:41984
v_cvt_pk_bf16_f32 v25, v25, v29
v_mfma_f32_16x16x32_bf16 v[224:227], v[80:83], v[32:35], v[224:227]
ds_read_b64_tr_b16 v[72:73], v9 offset:32768
v_cvt_pk_bf16_f32 v26, v26, v30
v_mfma_f32_16x16x32_bf16 v[224:227], v[84:87], v[36:39], v[224:227]
ds_read_b64_tr_b16 v[74:75], v9 offset:33792
v_cvt_pk_bf16_f32 v27, v27, v31
v_mfma_f32_16x16x32_bf16 v[228:231], v[84:87], v[44:47], v[228:231]
s_add_u32 m0, s63, 69632
v_mfma_f32_16x16x32_bf16 v[228:231], v[80:83], v[40:43], v[228:231]
s_add_u32 s72, s70, 0
buffer_load_dwordx4 v4, s[4:7], s72 offen lds
v_mfma_f32_16x16x32_bf16 v[232:235], v[80:83], v[48:51], v[232:235]
s_add_u32 s80, s78, 41984
ds_read_b64_tr_b16 v[76:77], v9 offset:40960
v_mfma_f32_16x16x32_bf16 v[232:235], v[84:87], v[52:55], v[232:235]
ds_read_b128 v[124:127], v19 offset:38912
v_mfma_f32_16x16x32_bf16 v[236:239], v[84:87], v[60:63], v[236:239]
ds_read_b64_tr_b16 v[78:79], v9 offset:41984
v_mfma_f32_16x16x32_bf16 v[236:239], v[80:83], v[56:59], v[236:239]
buffer_store_dwordx4 v[24:27], v1, s[44:47], s80 offen sc1
v_mfma_f32_16x16x32_bf16 v[252:255], v[88:91], v[56:59], v[252:255]
s_add_u32 s72, s70, 15360
buffer_load_dwordx4 v5, s[4:7], s72 offen offset:1024 lds
v_mfma_f32_16x16x32_bf16 v[252:255], v[92:95], v[60:63], v[252:255]
ds_read_b64_tr_b16 v[80:81], v10 offset:32768
v_accvgpr_read_b32 v20, a72
v_mfma_f32_16x16x32_bf16 v[248:251], v[92:95], v[52:55], v[248:251]
ds_read_b64_tr_b16 v[82:83], v10 offset:33792
v_accvgpr_read_b32 v28, a73
v_mfma_f32_16x16x32_bf16 v[248:251], v[88:91], v[48:51], v[248:251]
v_accvgpr_read_b32 v21, a74
v_accvgpr_read_b32 v29, a75
v_mfma_f32_16x16x32_bf16 v[244:247], v[88:91], v[40:43], v[244:247]
ds_read_b64_tr_b16 v[84:85], v10 offset:40960
v_accvgpr_read_b32 v22, a104
v_mfma_f32_16x16x32_bf16 v[244:247], v[92:95], v[44:47], v[244:247]
ds_read_b64_tr_b16 v[86:87], v10 offset:41984
v_accvgpr_read_b32 v30, a105
v_mfma_f32_16x16x32_bf16 v[240:243], v[92:95], v[36:39], v[240:243]
s_add_u32 s72, s70, 129024
buffer_load_dwordx4 v4, s[4:7], s72 offen offset:2048 lds
v_mfma_f32_16x16x32_bf16 v[240:243], v[88:91], v[32:35], v[240:243]
s_waitcnt lgkmcnt(5)
v_accvgpr_read_b32 v23, a106
v_accvgpr_read_b32 v31, a107
v_mfma_f32_16x16x32_bf16 v[128:131], v[64:67], v[96:99], v[128:131]
s_lshr_b32 s75, s93, 4
ds_read_b64_tr_b16 v[88:89], v11 offset:32768
v_mul_f32 v20, s79, v20
v_mfma_f32_16x16x32_bf16 v[128:131], v[68:71], v[100:103], v[128:131]
s_and_b32 s75, s75, 0x7f00
ds_read_b64_tr_b16 v[90:91], v11 offset:33792
v_mul_f32 v28, s79, v28
v_mfma_f32_16x16x32_bf16 v[132:135], v[68:71], v[108:111], v[132:135]
s_add_u32 s75, s75, LcB1-Lpc0
v_lshrrev_b32 v2, 5, v0
v_lshlrev_b32 v2, 7, v2
v_mfma_f32_16x16x32_bf16 v[132:135], v[64:67], v[104:107], v[132:135]
s_add_u32 s72, s70, 144384
buffer_load_dwordx4 v5, s[4:7], s72 offen offset:3072 lds
v_mfma_f32_16x16x32_bf16 v[136:139], v[64:67], v[112:115], v[136:139]
v_add_u32 v2, s75, v2
v_min_u32 v2, Lcode_end-Lpc0, v2
v_mfma_f32_16x16x32_bf16 v[136:139], v[68:71], v[116:119], v[136:139]
s_lshl_b32 s71, s73, 12
global_load_dword v3, v2, s[98:99]
v_mfma_f32_16x16x32_bf16 v[140:143], v[68:71], v[124:127], v[140:143]
s_add_u32 s71, s71, s66
ds_read_b64_tr_b16 v[92:93], v11 offset:40960
v_mul_f32 v21, s79, v21
v_mfma_f32_16x16x32_bf16 v[140:143], v[64:67], v[120:123], v[140:143]
s_waitcnt lgkmcnt(7)
ds_read_b64_tr_b16 v[94:95], v11 offset:41984
v_mul_f32 v29, s79, v29
v_mfma_f32_16x16x32_bf16 v[156:159], v[72:75], v[120:123], v[156:159]
s_add_u32 m0, s64, 16384
ds_read_b64_tr_b16 v[64:65], v12 offset:32768
v_mul_f32 v22, s79, v22
v_mfma_f32_16x16x32_bf16 v[156:159], v[76:79], v[124:127], v[156:159]
s_add_u32 s72, s71, 0
buffer_load_dwordx4 v6, s[12:15], s72 offen lds
v_mfma_f32_16x16x32_bf16 v[152:155], v[76:79], v[116:119], v[152:155]
s_add_u32 s73, s62, 8
ds_read_b64_tr_b16 v[66:67], v12 offset:33792
v_mul_f32 v30, s79, v30
v_mfma_f32_16x16x32_bf16 v[152:155], v[72:75], v[112:115], v[152:155]
s_add_u32 s70, s73, s65
v_mul_f32 v23, s79, v23
v_mul_f32 v31, s79, v31
v_mfma_f32_16x16x32_bf16 v[148:151], v[72:75], v[104:107], v[148:151]
s_and_b32 s70, s70, 3
ds_read_b64_tr_b16 v[68:69], v12 offset:40960
v_cvt_pk_bf16_f32 v20, v20, v28
v_mfma_f32_16x16x32_bf16 v[148:151], v[76:79], v[108:111], v[148:151]
s_and_b32 s73, s73, 12
ds_read_b64_tr_b16 v[70:71], v12 offset:41984
v_cvt_pk_bf16_f32 v21, v21, v29
v_mfma_f32_16x16x32_bf16 v[144:147], v[76:79], v[100:103], v[144:147]
s_add_u32 s72, s71, 31744
buffer_load_dwordx4 v6, s[12:15], s72 offen offset:1024 lds
v_mfma_f32_16x16x32_bf16 v[144:147], v[72:75], v[96:99], v[144:147]
s_waitcnt lgkmcnt(8)
v_cvt_pk_bf16_f32 v22, v22, v30
v_cvt_pk_bf16_f32 v23, v23, v31
v_mfma_f32_16x16x32_bf16 v[160:163], v[80:83], v[96:99], v[160:163]
s_or_b32 s73, s73, s70
ds_read_b64_tr_b16 v[72:73], v13 offset:32768
v_accvgpr_read_b32 v24, a192
v_mfma_f32_16x16x32_bf16 v[160:163], v[84:87], v[100:103], v[160:163]
s_lshl_b32 s73, s73, 7
ds_read_b64_tr_b16 v[74:75], v13 offset:33792
v_accvgpr_read_b32 v28, a193
v_mfma_f32_16x16x32_bf16 v[164:167], v[84:87], v[108:111], v[164:167]
s_add_u32 s69, s73, s67
v_accvgpr_read_b32 v25, a194
v_accvgpr_read_b32 v29, a195
v_mfma_f32_16x16x32_bf16 v[164:167], v[80:83], v[104:107], v[164:167]
s_add_u32 s72, s71, 63488
buffer_load_dwordx4 v7, s[12:15], s72 offen offset:2048 lds
v_mfma_f32_16x16x32_bf16 v[168:171], v[80:83], v[112:115], v[168:171]
s_waitcnt vmcnt(19)
ds_read_b64_tr_b16 v[76:77], v13 offset:40960
v_accvgpr_read_b32 v26, a196
v_mfma_f32_16x16x32_bf16 v[168:171], v[84:87], v[116:119], v[168:171]
s_add_u32 s70, s73, s68
ds_read_b128 v[32:35], v16 offset:0
v_accvgpr_read_b32 v30, a197
v_mfma_f32_16x16x32_bf16 v[172:175], v[84:87], v[124:127], v[172:175]
s_add_u32 s80, s77, 9216
ds_read_b64_tr_b16 v[78:79], v13 offset:41984
v_accvgpr_read_b32 v27, a198
v_mfma_f32_16x16x32_bf16 v[172:175], v[80:83], v[120:123], v[172:175]
s_waitcnt lgkmcnt(9)
ds_read_b128 v[36:39], v17 offset:0
v_accvgpr_read_b32 v31, a199
v_mfma_f32_16x16x32_bf16 v[188:191], v[88:91], v[120:123], v[188:191]
s_add_u32 s72, s71, 95232
buffer_load_dwordx4 v7, s[12:15], s72 offen offset:3072 lds
v_mfma_f32_16x16x32_bf16 v[188:191], v[92:95], v[124:127], v[188:191]
ds_read_b64_tr_b16 v[80:81], v14 offset:32768
v_cvt_pk_bf16_f32 v24, v24, v28
v_mfma_f32_16x16x32_bf16 v[184:187], v[92:95], v[116:119], v[184:187]
ds_read_b64_tr_b16 v[82:83], v14 offset:33792
v_cvt_pk_bf16_f32 v25, v25, v29
v_mfma_f32_16x16x32_bf16 v[184:187], v[88:91], v[112:115], v[184:187]
buffer_store_dwordx4 v[20:23], v1, s[44:47], s80 offen sc1
v_mfma_f32_16x16x32_bf16 v[180:183], v[88:91], v[104:107], v[180:183]
ds_read_b64_tr_b16 v[84:85], v14 offset:40960
v_cvt_pk_bf16_f32 v26, v26, v30
v_mfma_f32_16x16x32_bf16 v[180:183], v[92:95], v[108:111], v[180:183]
s_add_u32 m0, s63, 98304
ds_read_b64_tr_b16 v[86:87], v14 offset:41984
v_cvt_pk_bf16_f32 v27, v27, v31
v_mfma_f32_16x16x32_bf16 v[176:179], v[92:95], v[100:103], v[176:179]
s_add_u32 s72, s69, 0
buffer_load_dwordx4 v4, s[4:7], s72 offen lds
v_mfma_f32_16x16x32_bf16 v[176:179], v[88:91], v[96:99], v[176:179]
s_waitcnt lgkmcnt(10)
ds_read_b128 v[40:43], v16 offset:2048
v_mfma_f32_16x16x32_bf16 v[192:195], v[64:67], v[96:99], v[192:195]
s_add_u32 s80, s78, 2048
ds_read_b64_tr_b16 v[88:89], v15 offset:32768
v_mfma_f32_16x16x32_bf16 v[192:195], v[68:71], v[100:103], v[192:195]
ds_read_b64_tr_b16 v[90:91], v15 offset:33792
v_mfma_f32_16x16x32_bf16 v[196:199], v[68:71], v[108:111], v[196:199]
ds_read_b64_tr_b16 v[92:93], v15 offset:40960
v_mfma_f32_16x16x32_bf16 v[196:199], v[64:67], v[104:107], v[196:199]
s_add_u32 s72, s69, 15360
buffer_load_dwordx4 v5, s[4:7], s72 offen offset:1024 lds
v_mfma_f32_16x16x32_bf16 v[200:203], v[64:67], v[112:115], v[200:203]
ds_read_b64_tr_b16 v[94:95], v15 offset:41984
v_accvgpr_read_b32 v20, a76
v_mfma_f32_16x16x32_bf16 v[200:203], v[68:71], v[116:119], v[200:203]
ds_read_b128 v[44:47], v17 offset:2048
v_accvgpr_read_b32 v28, a77
v_mfma_f32_16x16x32_bf16 v[204:207], v[68:71], v[124:127], v[204:207]
buffer_store_dwordx4 v[24:27], v1, s[44:47], s80 offen sc1
v_mfma_f32_16x16x32_bf16 v[204:207], v[64:67], v[120:123], v[204:207]
s_waitcnt lgkmcnt(11)
ds_read_b128 v[48:51], v16 offset:4096
v_accvgpr_read_b32 v21, a78
v_mfma_f32_16x16x32_bf16 v[220:223], v[72:75], v[120:123], v[220:223]
s_add_u32 s72, s69, 129024
buffer_load_dwordx4 v4, s[4:7], s72 offen offset:2048 lds
v_mfma_f32_16x16x32_bf16 v[220:223], v[76:79], v[124:127], v[220:223]
v_accvgpr_read_b32 v29, a79
v_accvgpr_read_b32 v22, a108
v_mfma_f32_16x16x32_bf16 v[216:219], v[76:79], v[116:119], v[216:219]
s_waitcnt vmcnt(20) lgkmcnt(2)
ds_read_b128 v[52:55], v17 offset:4096
v_accvgpr_read_b32 v30, a109
v_mfma_f32_16x16x32_bf16 v[216:219], v[72:75], v[112:115], v[216:219]
s_barrier
ds_read_b128 v[56:59], v16 offset:6144
v_accvgpr_read_b32 v23, a110
v_mfma_f32_16x16x32_bf16 v[212:215], v[72:75], v[104:107], v[212:215]
ds_read_b64_tr_b16 v[64:65], v8 offset:0
ds_read_b64_tr_b16 v[66:67], v8 offset:1024
v_mfma_f32_16x16x32_bf16 v[212:215], v[76:79], v[108:111], v[212:215]
ds_read_b64_tr_b16 v[68:69], v8 offset:8192
v_accvgpr_read_b32 v31, a111
v_mfma_f32_16x16x32_bf16 v[208:211], v[76:79], v[100:103], v[208:211]
s_add_u32 s72, s69, 144384
buffer_load_dwordx4 v5, s[4:7], s72 offen offset:3072 lds
v_mfma_f32_16x16x32_bf16 v[208:211], v[72:75], v[96:99], v[208:211]
ds_read_b64_tr_b16 v[70:71], v8 offset:9216
v_mul_f32 v20, s79, v20
v_mfma_f32_16x16x32_bf16 v[224:227], v[80:83], v[96:99], v[224:227]
ds_read_b64_tr_b16 v[72:73], v9 offset:0
v_mul_f32 v28, s79, v28
v_mfma_f32_16x16x32_bf16 v[224:227], v[84:87], v[100:103], v[224:227]
ds_read_b64_tr_b16 v[74:75], v9 offset:1024
v_mul_f32 v21, s79, v21
v_mfma_f32_16x16x32_bf16 v[228:231], v[84:87], v[108:111], v[228:231]
s_add_u32 m0, s63, 102400
v_mul_f32 v29, s79, v29
v_mul_f32 v22, s79, v22
v_mfma_f32_16x16x32_bf16 v[228:231], v[80:83], v[104:107], v[228:231]
s_add_u32 s72, s70, 0
buffer_load_dwordx4 v4, s[4:7], s72 offen lds
v_mfma_f32_16x16x32_bf16 v[232:235], v[80:83], v[112:115], v[232:235]
ds_read_b64_tr_b16 v[76:77], v9 offset:8192
v_mul_f32 v30, s79, v30
v_mfma_f32_16x16x32_bf16 v[232:235], v[84:87], v[116:119], v[232:235]
ds_read_b128 v[60:63], v17 offset:6144
v_mul_f32 v23, s79, v23
v_mfma_f32_16x16x32_bf16 v[236:239], v[84:87], v[124:127], v[236:239]
ds_read_b64_tr_b16 v[78:79], v9 offset:9216
v_mul_f32 v31, s79, v31
v_mfma_f32_16x16x32_bf16 v[236:239], v[80:83], v[120:123], v[236:239]
v_cvt_pk_bf16_f32 v20, v20, v28
v_cvt_pk_bf16_f32 v21, v21, v29
v_mfma_f32_16x16x32_bf16 v[252:255], v[88:91], v[120:123], v[252:255]
s_add_u32 s72, s70, 15360
buffer_load_dwordx4 v5, s[4:7], s72 offen offset:1024 lds
v_mfma_f32_16x16x32_bf16 v[252:255], v[92:95], v[124:127], v[252:255]
ds_read_b64_tr_b16 v[80:81], v10 offset:0
v_cvt_pk_bf16_f32 v22, v22, v30
v_mfma_f32_16x16x32_bf16 v[248:251], v[92:95], v[116:119], v[248:251]
ds_read_b64_tr_b16 v[82:83], v10 offset:1024
v_cvt_pk_bf16_f32 v23, v23, v31
v_mfma_f32_16x16x32_bf16 v[248:251], v[88:91], v[112:115], v[248:251]
s_add_u32 s80, s77, 13312
buffer_store_dwordx4 v[20:23], v1, s[44:47], s80 offen sc1
v_mfma_f32_16x16x32_bf16 v[244:247], v[88:91], v[104:107], v[244:247]
ds_read_b64_tr_b16 v[84:85], v10 offset:8192
v_accvgpr_read_b32 v24, a200
v_mfma_f32_16x16x32_bf16 v[244:247], v[92:95], v[108:111], v[244:247]
ds_read_b64_tr_b16 v[86:87], v10 offset:9216
v_accvgpr_read_b32 v28, a201
v_mfma_f32_16x16x32_bf16 v[240:243], v[92:95], v[100:103], v[240:243]
s_add_u32 s72, s70, 129024
buffer_load_dwordx4 v4, s[4:7], s72 offen offset:2048 lds
v_mfma_f32_16x16x32_bf16 v[240:243], v[88:91], v[96:99], v[240:243]
s_waitcnt lgkmcnt(5)
v_accvgpr_read_b32 v25, a202
v_accvgpr_read_b32 v29, a203
v_mfma_f32_16x16x32_bf16 v[128:131], v[64:67], v[32:35], v[128:131]
ds_read_b64_tr_b16 v[88:89], v11 offset:0
v_accvgpr_read_b32 v26, a204
v_mfma_f32_16x16x32_bf16 v[128:131], v[68:71], v[36:39], v[128:131]
ds_read_b64_tr_b16 v[90:91], v11 offset:1024
v_accvgpr_read_b32 v30, a205
v_mfma_f32_16x16x32_bf16 v[132:135], v[68:71], v[44:47], v[132:135]
v_accvgpr_read_b32 v27, a206
v_accvgpr_read_b32 v31, a207
v_mfma_f32_16x16x32_bf16 v[132:135], v[64:67], v[40:43], v[132:135]
s_add_u32 s72, s70, 144384
buffer_load_dwordx4 v5, s[4:7], s72 offen offset:3072 lds
v_mfma_f32_16x16x32_bf16 v[136:139], v[64:67], v[48:51], v[136:139]
ds_read_b64_tr_b16 v[92:93], v11 offset:8192
v_cvt_pk_bf16_f32 v24, v24, v28
v_mfma_f32_16x16x32_bf16 v[136:139], v[68:71], v[52:55], v[136:139]
s_lshl_b32 s71, s73, 12
v_cvt_pk_bf16_f32 v25, v25, v29
v_cvt_pk_bf16_f32 v26, v26, v30
v_mfma_f32_16x16x32_bf16 v[140:143], v[68:71], v[60:63], v[140:143]
s_add_u32 s71, s71, s66
ds_read_b64_tr_b16 v[94:95], v11 offset:9216
v_cvt_pk_bf16_f32 v27, v27, v31
v_mfma_f32_16x16x32_bf16 v[140:143], v[64:67], v[56:59], v[140:143]
s_waitcnt lgkmcnt(8)
v_mfma_f32_16x16x32_bf16 v[156:159], v[72:75], v[56:59], v[156:159]
s_add_u32 m0, s64, 32768
ds_read_b64_tr_b16 v[64:65], v12 offset:0
v_mfma_f32_16x16x32_bf16 v[156:159], v[76:79], v[60:63], v[156:159]
s_add_u32 s72, s71, 0
buffer_load_dwordx4 v6, s[12:15], s72 offen lds
v_mfma_f32_16x16x32_bf16 v[152:155], v[76:79], v[52:55], v[152:155]
s_add_u32 s73, s62, 9
ds_read_b64_tr_b16 v[66:67], v12 offset:1024
v_mfma_f32_16x16x32_bf16 v[152:155], v[72:75], v[48:51], v[152:155]
s_add_u32 s70, s73, s65
v_mfma_f32_16x16x32_bf16 v[148:151], v[72:75], v[40:43], v[148:151]
s_and_b32 s70, s70, 3
ds_read_b64_tr_b16 v[68:69], v12 offset:8192
v_mfma_f32_16x16x32_bf16 v[148:151], v[76:79], v[44:47], v[148:151]
s_and_b32 s73, s73, 12
ds_read_b64_tr_b16 v[70:71], v12 offset:9216
v_mfma_f32_16x16x32_bf16 v[144:147], v[76:79], v[36:39], v[144:147]
s_add_u32 s72, s71, 31744
buffer_load_dwordx4 v6, s[12:15], s72 offen offset:1024 lds
v_mfma_f32_16x16x32_bf16 v[144:147], v[72:75], v[32:35], v[144:147]
s_waitcnt lgkmcnt(8)
v_mfma_f32_16x16x32_bf16 v[160:163], v[80:83], v[32:35], v[160:163]
s_or_b32 s73, s73, s70
ds_read_b64_tr_b16 v[72:73], v13 offset:0
v_accvgpr_read_b32 v20, a80
v_mfma_f32_16x16x32_bf16 v[160:163], v[84:87], v[36:39], v[160:163]
s_lshl_b32 s73, s73, 7
ds_read_b64_tr_b16 v[74:75], v13 offset:1024
v_accvgpr_read_b32 v28, a81
v_mfma_f32_16x16x32_bf16 v[164:167], v[84:87], v[44:47], v[164:167]
s_add_u32 s69, s73, s67
v_accvgpr_read_b32 v21, a82
v_accvgpr_read_b32 v29, a83
v_mfma_f32_16x16x32_bf16 v[164:167], v[80:83], v[40:43], v[164:167]
s_add_u32 s72, s71, 63488
buffer_load_dwordx4 v7, s[12:15], s72 offen offset:2048 lds
v_mfma_f32_16x16x32_bf16 v[168:171], v[80:83], v[48:51], v[168:171]
s_waitcnt vmcnt(19)
ds_read_b64_tr_b16 v[76:77], v13 offset:8192
v_accvgpr_read_b32 v22, a112
v_mfma_f32_16x16x32_bf16 v[168:171], v[84:87], v[52:55], v[168:171]
s_add_u32 s70, s73, s68
ds_read_b128 v[96:99], v18 offset:0
v_accvgpr_read_b32 v30, a113
v_mfma_f32_16x16x32_bf16 v[172:175], v[84:87], v[60:63], v[172:175]
s_add_u32 s80, s78, 10240
ds_read_b64_tr_b16 v[78:79], v13 offset:9216
v_accvgpr_read_b32 v23, a114
v_mfma_f32_16x16x32_bf16 v[172:175], v[80:83], v[56:59], v[172:175]
s_waitcnt lgkmcnt(9)
ds_read_b128 v[100:103], v19 offset:0
v_accvgpr_read_b32 v31, a115
v_mfma_f32_16x16x32_bf16 v[188:191], v[88:91], v[56:59], v[188:191]
s_add_u32 s72, s71, 95232
buffer_load_dwordx4 v7, s[12:15], s72 offen offset:3072 lds
v_mfma_f32_16x16x32_bf16 v[188:191], v[92:95], v[60:63], v[188:191]
ds_read_b64_tr_b16 v[80:81], v14 offset:0
v_mul_f32 v20, s79, v20
v_mfma_f32_16x16x32_bf16 v[184:187], v[92:95], v[52:55], v[184:187]
ds_read_b64_tr_b16 v[82:83], v14 offset:1024
v_mul_f32 v28, s79, v28
v_mfma_f32_16x16x32_bf16 v[184:187], v[88:91], v[48:51], v[184:187]
buffer_store_dwordx4 v[24:27], v1, s[44:47], s80 offen sc1
v_mfma_f32_16x16x32_bf16 v[180:183], v[88:91], v[40:43], v[180:183]
ds_read_b64_tr_b16 v[84:85], v14 offset:8192
v_mul_f32 v21, s79, v21
v_mfma_f32_16x16x32_bf16 v[180:183], v[92:95], v[44:47], v[180:183]
s_add_u32 m0, s63, 131072
ds_read_b64_tr_b16 v[86:87], v14 offset:9216
v_mul_f32 v29, s79, v29
v_mfma_f32_16x16x32_bf16 v[176:179], v[92:95], v[36:39], v[176:179]
s_add_u32 s72, s69, 0
buffer_load_dwordx4 v4, s[4:7], s72 offen lds
v_mfma_f32_16x16x32_bf16 v[176:179], v[88:91], v[32:35], v[176:179]
s_waitcnt lgkmcnt(10)
ds_read_b128 v[104:107], v18 offset:2048
v_mul_f32 v22, s79, v22
v_mfma_f32_16x16x32_bf16 v[192:195], v[64:67], v[32:35], v[192:195]
ds_read_b64_tr_b16 v[88:89], v15 offset:0
v_mul_f32 v30, s79, v30
v_mfma_f32_16x16x32_bf16 v[192:195], v[68:71], v[36:39], v[192:195]
ds_read_b64_tr_b16 v[90:91], v15 offset:1024
v_mul_f32 v23, s79, v23
v_mfma_f32_16x16x32_bf16 v[196:199], v[68:71], v[44:47], v[196:199]
ds_read_b64_tr_b16 v[92:93], v15 offset:8192
v_mul_f32 v31, s79, v31
v_mfma_f32_16x16x32_bf16 v[196:199], v[64:67], v[40:43], v[196:199]
s_add_u32 s72, s69, 15360
buffer_load_dwordx4 v5, s[4:7], s72 offen offset:1024 lds
v_mfma_f32_16x16x32_bf16 v[200:203], v[64:67], v[48:51], v[200:203]
ds_read_b64_tr_b16 v[94:95], v15 offset:9216
v_cvt_pk_bf16_f32 v20, v20, v28
v_mfma_f32_16x16x32_bf16 v[200:203], v[68:71], v[52:55], v[200:203]
ds_read_b128 v[108:111], v19 offset:2048
v_cvt_pk_bf16_f32 v21, v21, v29
v_mfma_f32_16x16x32_bf16 v[204:207], v[68:71], v[60:63], v[204:207]
v_cvt_pk_bf16_f32 v22, v22, v30
v_cvt_pk_bf16_f32 v23, v23, v31
v_mfma_f32_16x16x32_bf16 v[204:207], v[64:67], v[56:59], v[204:207]
s_waitcnt lgkmcnt(11)
ds_read_b128 v[112:115], v18 offset:4096
v_accvgpr_read_b32 v24, a208
v_mfma_f32_16x16x32_bf16 v[220:223], v[72:75], v[56:59], v[220:223]
s_add_u32 s72, s69, 129024
buffer_load_dwordx4 v4, s[4:7], s72 offen offset:2048 lds
v_mfma_f32_16x16x32_bf16 v[220:223], v[76:79], v[60:63], v[220:223]
s_add_u32 s80, s77, 33792
buffer_store_dwordx4 v[20:23], v1, s[44:47], s80 offen sc1
v_mfma_f32_16x16x32_bf16 v[216:219], v[76:79], v[52:55], v[216:219]
s_waitcnt vmcnt(20) lgkmcnt(2)
ds_read_b128 v[116:119], v19 offset:4096
v_accvgpr_read_b32 v28, a209
v_mfma_f32_16x16x32_bf16 v[216:219], v[72:75], v[48:51], v[216:219]
s_barrier
ds_read_b128 v[120:123], v18 offset:6144
v_accvgpr_read_b32 v25, a210
v_mfma_f32_16x16x32_bf16 v[212:215], v[72:75], v[40:43], v[212:215]
ds_read_b64_tr_b16 v[64:65], v8 offset:16384
ds_read_b64_tr_b16 v[66:67], v8 offset:17408
v_mfma_f32_16x16x32_bf16 v[212:215], v[76:79], v[44:47], v[212:215]
ds_read_b64_tr_b16 v[68:69], v8 offset:24576
v_accvgpr_read_b32 v29, a211
v_mfma_f32_16x16x32_bf16 v[208:211], v[76:79], v[36:39], v[208:211]
s_add_u32 s72, s69, 144384
buffer_load_dwordx4 v5, s[4:7], s72 offen offset:3072 lds
v_mfma_f32_16x16x32_bf16 v[208:211], v[72:75], v[32:35], v[208:211]
ds_read_b64_tr_b16 v[70:71], v8 offset:25600
v_accvgpr_read_b32 v26, a212
v_mfma_f32_16x16x32_bf16 v[224:227], v[80:83], v[32:35], v[224:227]
ds_read_b64_tr_b16 v[72:73], v9 offset:16384
v_accvgpr_read_b32 v30, a213
v_mfma_f32_16x16x32_bf16 v[224:227], v[84:87], v[36:39], v[224:227]
ds_read_b64_tr_b16 v[74:75], v9 offset:17408
v_accvgpr_read_b32 v27, a214
v_mfma_f32_16x16x32_bf16 v[228:231], v[84:87], v[44:47], v[228:231]
s_add_u32 m0, s63, 135168
v_accvgpr_read_b32 v31, a215
v_cvt_pk_bf16_f32 v24, v24, v28
v_mfma_f32_16x16x32_bf16 v[228:231], v[80:83], v[40:43], v[228:231]
s_add_u32 s72, s70, 0
buffer_load_dwordx4 v4, s[4:7], s72 offen lds
v_mfma_f32_16x16x32_bf16 v[232:235], v[80:83], v[48:51], v[232:235]
ds_read_b64_tr_b16 v[76:77], v9 offset:24576
v_cvt_pk_bf16_f32 v25, v25, v29
v_mfma_f32_16x16x32_bf16 v[232:235], v[84:87], v[52:55], v[232:235]
ds_read_b128 v[124:127], v19 offset:6144
v_cvt_pk_bf16_f32 v26, v26, v30
v_mfma_f32_16x16x32_bf16 v[236:239], v[84:87], v[60:63], v[236:239]
ds_read_b64_tr_b16 v[78:79], v9 offset:25600
v_cvt_pk_bf16_f32 v27, v27, v31
v_mfma_f32_16x16x32_bf16 v[236:239], v[80:83], v[56:59], v[236:239]
s_add_u32 s80, s78, 34816
buffer_store_dwordx4 v[24:27], v1, s[44:47], s80 offen sc1
v_mfma_f32_16x16x32_bf16 v[252:255], v[88:91], v[56:59], v[252:255]
s_add_u32 s72, s70, 15360
buffer_load_dwordx4 v5, s[4:7], s72 offen offset:1024 lds
v_mfma_f32_16x16x32_bf16 v[252:255], v[92:95], v[60:63], v[252:255]
ds_read_b64_tr_b16 v[80:81], v10 offset:16384
v_mfma_f32_16x16x32_bf16 v[248:251], v[92:95], v[52:55], v[248:251]
ds_read_b64_tr_b16 v[82:83], v10 offset:17408
v_mfma_f32_16x16x32_bf16 v[248:251], v[88:91], v[48:51], v[248:251]
v_mfma_f32_16x16x32_bf16 v[244:247], v[88:91], v[40:43], v[244:247]
ds_read_b64_tr_b16 v[84:85], v10 offset:24576
v_mfma_f32_16x16x32_bf16 v[244:247], v[92:95], v[44:47], v[244:247]
ds_read_b64_tr_b16 v[86:87], v10 offset:25600
v_accvgpr_read_b32 v20, a84
v_mfma_f32_16x16x32_bf16 v[240:243], v[92:95], v[36:39], v[240:243]
s_add_u32 s72, s70, 129024
buffer_load_dwordx4 v4, s[4:7], s72 offen offset:2048 lds
v_mfma_f32_16x16x32_bf16 v[240:243], v[88:91], v[32:35], v[240:243]
s_waitcnt lgkmcnt(5)
v_accvgpr_read_b32 v28, a85
v_accvgpr_read_b32 v21, a86
v_mfma_f32_16x16x32_bf16 v[128:131], v[64:67], v[96:99], v[128:131]
ds_read_b64_tr_b16 v[88:89], v11 offset:16384
v_accvgpr_read_b32 v29, a87
v_mfma_f32_16x16x32_bf16 v[128:131], v[68:71], v[100:103], v[128:131]
ds_read_b64_tr_b16 v[90:91], v11 offset:17408
v_accvgpr_read_b32 v22, a116
v_mfma_f32_16x16x32_bf16 v[132:135], v[68:71], v[108:111], v[132:135]
v_accvgpr_read_b32 v30, a117
v_accvgpr_read_b32 v23, a118
v_mfma_f32_16x16x32_bf16 v[132:135], v[64:67], v[104:107], v[132:135]
s_add_u32 s72, s70, 144384
buffer_load_dwordx4 v5, s[4:7], s72 offen offset:3072 lds
v_mfma_f32_16x16x32_bf16 v[136:139], v[64:67], v[112:115], v[136:139]
ds_read_b64_tr_b16 v[92:93], v11 offset:24576
v_accvgpr_read_b32 v31, a119
v_mfma_f32_16x16x32_bf16 v[136:139], v[68:71], v[116:119], v[136:139]
s_lshl_b32 s71, s73, 12
v_mul_f32 v20, s79, v20
v_mul_f32 v28, s79, v28
v_mfma_f32_16x16x32_bf16 v[140:143], v[68:71], v[124:127], v[140:143]
s_add_u32 s71, s71, s66
ds_read_b64_tr_b16 v[94:95], v11 offset:25600
v_mul_f32 v21, s79, v21
v_mfma_f32_16x16x32_bf16 v[140:143], v[64:67], v[120:123], v[140:143]
s_waitcnt lgkmcnt(8)
v_mul_f32 v29, s79, v29
v_mul_f32 v22, s79, v22
v_mfma_f32_16x16x32_bf16 v[156:159], v[72:75], v[120:123], v[156:159]
s_add_u32 m0, s64, 0
ds_read_b64_tr_b16 v[64:65], v12 offset:16384
v_mul_f32 v30, s79, v30
v_mfma_f32_16x16x32_bf16 v[156:159], v[76:79], v[124:127], v[156:159]
s_add_u32 s72, s71, 0
buffer_load_dwordx4 v6, s[12:15], s72 offen lds
v_mfma_f32_16x16x32_bf16 v[152:155], v[76:79], v[116:119], v[152:155]
s_add_u32 s73, s62, 10
ds_read_b64_tr_b16 v[66:67], v12 offset:17408
v_mul_f32 v23, s79, v23
v_mfma_f32_16x16x32_bf16 v[152:155], v[72:75], v[112:115], v[152:155]
s_add_u32 s70, s73, s65
v_mul_f32 v31, s79, v31
v_cvt_pk_bf16_f32 v20, v20, v28
v_mfma_f32_16x16x32_bf16 v[148:151], v[72:75], v[104:107], v[148:151]
s_and_b32 s70, s70, 3
ds_read_b64_tr_b16 v[68:69], v12 offset:24576
v_cvt_pk_bf16_f32 v21, v21, v29
v_mfma_f32_16x16x32_bf16 v[148:151], v[76:79], v[108:111], v[148:151]
s_and_b32 s73, s73, 12
ds_read_b64_tr_b16 v[70:71], v12 offset:25600
v_cvt_pk_bf16_f32 v22, v22, v30
v_mfma_f32_16x16x32_bf16 v[144:147], v[76:79], v[100:103], v[144:147]
s_add_u32 s72, s71, 31744
buffer_load_dwordx4 v6, s[12:15], s72 offen offset:1024 lds
v_mfma_f32_16x16x32_bf16 v[144:147], v[72:75], v[96:99], v[144:147]
s_waitcnt lgkmcnt(8)
v_cvt_pk_bf16_f32 v23, v23, v31
v_mfma_f32_16x16x32_bf16 v[160:163], v[80:83], v[96:99], v[160:163]
s_or_b32 s73, s73, s70
ds_read_b64_tr_b16 v[72:73], v13 offset:16384
v_mfma_f32_16x16x32_bf16 v[160:163], v[84:87], v[100:103], v[160:163]
s_lshl_b32 s73, s73, 7
ds_read_b64_tr_b16 v[74:75], v13 offset:17408
v_mfma_f32_16x16x32_bf16 v[164:167], v[84:87], v[108:111], v[164:167]
s_add_u32 s69, s73, s67
v_mfma_f32_16x16x32_bf16 v[164:167], v[80:83], v[104:107], v[164:167]
s_add_u32 s72, s71, 63488
buffer_load_dwordx4 v7, s[12:15], s72 offen offset:2048 lds
v_mfma_f32_16x16x32_bf16 v[168:171], v[80:83], v[112:115], v[168:171]
s_waitcnt vmcnt(18)
ds_read_b64_tr_b16 v[76:77], v13 offset:24576
v_accvgpr_read_b32 v24, a216
v_mfma_f32_16x16x32_bf16 v[168:171], v[84:87], v[116:119], v[168:171]
s_add_u32 s70, s73, s68
ds_read_b128 v[32:35], v18 offset:32768
v_accvgpr_read_b32 v28, a217
v_mfma_f32_16x16x32_bf16 v[172:175], v[84:87], v[124:127], v[172:175]
s_add_u32 s80, s77, 37888
ds_read_b64_tr_b16 v[78:79], v13 offset:25600
v_accvgpr_read_b32 v25, a218
v_mfma_f32_16x16x32_bf16 v[172:175], v[80:83], v[120:123], v[172:175]
s_waitcnt lgkmcnt(9)
ds_read_b128 v[36:39], v19 offset:32768
v_accvgpr_read_b32 v29, a219
v_mfma_f32_16x16x32_bf16 v[188:191], v[88:91], v[120:123], v[188:191]
s_add_u32 s72, s71, 95232
buffer_load_dwordx4 v7, s[12:15], s72 offen offset:3072 lds
v_mfma_f32_16x16x32_bf16 v[188:191], v[92:95], v[124:127], v[188:191]
ds_read_b64_tr_b16 v[80:81], v14 offset:16384
v_accvgpr_read_b32 v26, a220
v_mfma_f32_16x16x32_bf16 v[184:187], v[92:95], v[116:119], v[184:187]
ds_read_b64_tr_b16 v[82:83], v14 offset:17408
v_accvgpr_read_b32 v30, a221
v_mfma_f32_16x16x32_bf16 v[184:187], v[88:91], v[112:115], v[184:187]
buffer_store_dwordx4 v[20:23], v1, s[44:47], s80 offen sc1
v_mfma_f32_16x16x32_bf16 v[180:183], v[88:91], v[104:107], v[180:183]
ds_read_b64_tr_b16 v[84:85], v14 offset:24576
v_accvgpr_read_b32 v27, a222
v_mfma_f32_16x16x32_bf16 v[180:183], v[92:95], v[108:111], v[180:183]
s_add_u32 m0, s63, 65536
ds_read_b64_tr_b16 v[86:87], v14 offset:25600
v_accvgpr_read_b32 v31, a223
v_mfma_f32_16x16x32_bf16 v[176:179], v[92:95], v[100:103], v[176:179]
s_add_u32 s72, s69, 0
buffer_load_dwordx4 v4, s[4:7], s72 offen lds
v_mfma_f32_16x16x32_bf16 v[176:179], v[88:91], v[96:99], v[176:179]
s_waitcnt lgkmcnt(10)
ds_read_b128 v[40:43], v18 offset:34816
v_cvt_pk_bf16_f32 v24, v24, v28
v_mfma_f32_16x16x32_bf16 v[192:195], v[64:67], v[96:99], v[192:195]
ds_read_b64_tr_b16 v[88:89], v15 offset:16384
v_cvt_pk_bf16_f32 v25, v25, v29
v_mfma_f32_16x16x32_bf16 v[192:195], v[68:71], v[100:103], v[192:195]
ds_read_b64_tr_b16 v[90:91], v15 offset:17408
v_cvt_pk_bf16_f32 v26, v26, v30
v_mfma_f32_16x16x32_bf16 v[196:199], v[68:71], v[108:111], v[196:199]
ds_read_b64_tr_b16 v[92:93], v15 offset:24576
v_cvt_pk_bf16_f32 v27, v27, v31
v_mfma_f32_16x16x32_bf16 v[196:199], v[64:67], v[104:107], v[196:199]
s_add_u32 s72, s69, 15360
buffer_load_dwordx4 v5, s[4:7], s72 offen offset:1024 lds
v_mfma_f32_16x16x32_bf16 v[200:203], v[64:67], v[112:115], v[200:203]
s_add_u32 s80, s78, 43008
ds_read_b64_tr_b16 v[94:95], v15 offset:25600
v_mfma_f32_16x16x32_bf16 v[200:203], v[68:71], v[116:119], v[200:203]
ds_read_b128 v[44:47], v19 offset:34816
v_mfma_f32_16x16x32_bf16 v[204:207], v[68:71], v[124:127], v[204:207]
buffer_store_dwordx4 v[24:27], v1, s[44:47], s80 offen sc1
v_mfma_f32_16x16x32_bf16 v[204:207], v[64:67], v[120:123], v[204:207]
s_waitcnt lgkmcnt(11)
ds_read_b128 v[48:51], v18 offset:36864
v_mfma_f32_16x16x32_bf16 v[220:223], v[72:75], v[120:123], v[220:223]
s_add_u32 s72, s69, 129024
buffer_load_dwordx4 v4, s[4:7], s72 offen offset:2048 lds
v_mfma_f32_16x16x32_bf16 v[220:223], v[76:79], v[124:127], v[220:223]
v_accvgpr_read_b32 v20, a88
v_accvgpr_read_b32 v28, a89
v_mfma_f32_16x16x32_bf16 v[216:219], v[76:79], v[116:119], v[216:219]
s_waitcnt vmcnt(20) lgkmcnt(2)
ds_read_b128 v[52:55], v19 offset:36864
v_accvgpr_read_b32 v21, a90
v_mfma_f32_16x16x32_bf16 v[216:219], v[72:75], v[112:115], v[216:219]
s_barrier
ds_read_b128 v[56:59], v18 offset:38912
v_accvgpr_read_b32 v29, a91
v_mfma_f32_16x16x32_bf16 v[212:215], v[72:75], v[104:107], v[212:215]
ds_read_b64_tr_b16 v[64:65], v8 offset:32768
ds_read_b64_tr_b16 v[66:67], v8 offset:33792
v_mfma_f32_16x16x32_bf16 v[212:215], v[76:79], v[108:111], v[212:215]
ds_read_b64_tr_b16 v[68:69], v8 offset:40960
v_accvgpr_read_b32 v22, a120
v_mfma_f32_16x16x32_bf16 v[208:211], v[76:79], v[100:103], v[208:211]
s_add_u32 s72, s69, 144384
buffer_load_dwordx4 v5, s[4:7], s72 offen offset:3072 lds
v_mfma_f32_16x16x32_bf16 v[208:211], v[72:75], v[96:99], v[208:211]
ds_read_b64_tr_b16 v[70:71], v8 offset:41984
v_accvgpr_read_b32 v30, a121
v_mfma_f32_16x16x32_bf16 v[224:227], v[80:83], v[96:99], v[224:227]
ds_read_b64_tr_b16 v[72:73], v9 offset:32768
v_accvgpr_read_b32 v23, a122
v_mfma_f32_16x16x32_bf16 v[224:227], v[84:87], v[100:103], v[224:227]
ds_read_b64_tr_b16 v[74:75], v9 offset:33792
v_accvgpr_read_b32 v31, a123
v_mfma_f32_16x16x32_bf16 v[228:231], v[84:87], v[108:111], v[228:231]
s_add_u32 m0, s63, 69632
v_mul_f32 v20, s79, v20
v_mul_f32 v28, s79, v28
v_mfma_f32_16x16x32_bf16 v[228:231], v[80:83], v[104:107], v[228:231]
s_add_u32 s72, s70, 0
buffer_load_dwordx4 v4, s[4:7], s72 offen lds
v_mfma_f32_16x16x32_bf16 v[232:235], v[80:83], v[112:115], v[232:235]
ds_read_b64_tr_b16 v[76:77], v9 offset:40960
v_mul_f32 v21, s79, v21
v_mfma_f32_16x16x32_bf16 v[232:235], v[84:87], v[116:119], v[232:235]
ds_read_b128 v[60:63], v19 offset:38912
v_mul_f32 v29, s79, v29
v_mfma_f32_16x16x32_bf16 v[236:239], v[84:87], v[124:127], v[236:239]
ds_read_b64_tr_b16 v[78:79], v9 offset:41984
v_mul_f32 v22, s79, v22
v_mfma_f32_16x16x32_bf16 v[236:239], v[80:83], v[120:123], v[236:239]
v_mul_f32 v30, s79, v30
v_mul_f32 v23, s79, v23
v_mfma_f32_16x16x32_bf16 v[252:255], v[88:91], v[120:123], v[252:255]
s_add_u32 s72, s70, 15360
buffer_load_dwordx4 v5, s[4:7], s72 offen offset:1024 lds
v_mfma_f32_16x16x32_bf16 v[252:255], v[92:95], v[124:127], v[252:255]
ds_read_b64_tr_b16 v[80:81], v10 offset:32768
v_mul_f32 v31, s79, v31
v_mfma_f32_16x16x32_bf16 v[248:251], v[92:95], v[116:119], v[248:251]
ds_read_b64_tr_b16 v[82:83], v10 offset:33792
v_cvt_pk_bf16_f32 v20, v20, v28
v_mfma_f32_16x16x32_bf16 v[248:251], v[88:91], v[112:115], v[248:251]
v_cvt_pk_bf16_f32 v21, v21, v29
v_cvt_pk_bf16_f32 v22, v22, v30
v_mfma_f32_16x16x32_bf16 v[244:247], v[88:91], v[104:107], v[244:247]
ds_read_b64_tr_b16 v[84:85], v10 offset:40960
v_cvt_pk_bf16_f32 v23, v23, v31
v_mfma_f32_16x16x32_bf16 v[244:247], v[92:95], v[108:111], v[244:247]
s_add_u32 s80, s77, 41984
ds_read_b64_tr_b16 v[86:87], v10 offset:41984
v_mfma_f32_16x16x32_bf16 v[240:243], v[92:95], v[100:103], v[240:243]
s_add_u32 s72, s70, 129024
buffer_load_dwordx4 v4, s[4:7], s72 offen offset:2048 lds
v_mfma_f32_16x16x32_bf16 v[240:243], v[88:91], v[96:99], v[240:243]
s_waitcnt lgkmcnt(5)
buffer_store_dwordx4 v[20:23], v1, s[44:47], s80 offen sc1
LcB1:
v_mfma_f32_16x16x32_bf16 v[128:131], v[64:67], v[32:35], v[128:131]
ds_read_b64_tr_b16 v[88:89], v11 offset:32768
v_accvgpr_read_b32 v24, a224
v_mfma_f32_16x16x32_bf16 v[128:131], v[68:71], v[36:39], v[128:131]
ds_read_b64_tr_b16 v[90:91], v11 offset:33792
v_accvgpr_read_b32 v28, a225
v_mfma_f32_16x16x32_bf16 v[132:135], v[68:71], v[44:47], v[132:135]
v_accvgpr_read_b32 v25, a226
v_accvgpr_read_b32 v29, a227
v_mfma_f32_16x16x32_bf16 v[132:135], v[64:67], v[40:43], v[132:135]
s_add_u32 s72, s70, 144384
buffer_load_dwordx4 v5, s[4:7], s72 offen offset:3072 lds
v_mfma_f32_16x16x32_bf16 v[136:139], v[64:67], v[48:51], v[136:139]
ds_read_b64_tr_b16 v[92:93], v11 offset:40960
v_accvgpr_read_b32 v26, a228
v_mfma_f32_16x16x32_bf16 v[136:139], v[68:71], v[52:55], v[136:139]
s_lshl_b32 s71, s73, 12
v_accvgpr_read_b32 v30, a229
v_accvgpr_read_b32 v27, a230
v_mfma_f32_16x16x32_bf16 v[140:143], v[68:71], v[60:63], v[140:143]
s_add_u32 s71, s71, s66
ds_read_b64_tr_b16 v[94:95], v11 offset:41984
v_accvgpr_read_b32 v31, a231
v_mfma_f32_16x16x32_bf16 v[140:143], v[64:67], v[56:59], v[140:143]
s_waitcnt lgkmcnt(8)
v_cvt_pk_bf16_f32 v24, v24, v28
v_cvt_pk_bf16_f32 v25, v25, v29
v_mfma_f32_16x16x32_bf16 v[156:159], v[72:75], v[56:59], v[156:159]
s_add_u32 m0, s64, 16384
ds_read_b64_tr_b16 v[64:65], v12 offset:32768
v_cvt_pk_bf16_f32 v26, v26, v30
v_mfma_f32_16x16x32_bf16 v[156:159], v[76:79], v[60:63], v[156:159]
s_add_u32 s72, s71, 0
buffer_load_dwordx4 v6, s[12:15], s72 offen lds
v_mfma_f32_16x16x32_bf16 v[152:155], v[76:79], v[52:55], v[152:155]
s_add_u32 s73, s62, 11
ds_read_b64_tr_b16 v[66:67], v12 offset:33792
v_cvt_pk_bf16_f32 v27, v27, v31
v_mfma_f32_16x16x32_bf16 v[152:155], v[72:75], v[48:51], v[152:155]
s_add_u32 s70, s73, s65
v_mfma_f32_16x16x32_bf16 v[148:151], v[72:75], v[40:43], v[148:151]
s_and_b32 s70, s70, 3
ds_read_b64_tr_b16 v[68:69], v12 offset:40960
v_mfma_f32_16x16x32_bf16 v[148:151], v[76:79], v[44:47], v[148:151]
s_and_b32 s73, s73, 12
ds_read_b64_tr_b16 v[70:71], v12 offset:41984
v_mfma_f32_16x16x32_bf16 v[144:147], v[76:79], v[36:39], v[144:147]
s_add_u32 s72, s71, 31744
buffer_load_dwordx4 v6, s[12:15], s72 offen offset:1024 lds
v_mfma_f32_16x16x32_bf16 v[144:147], v[72:75], v[32:35], v[144:147]
s_waitcnt lgkmcnt(8)
v_mfma_f32_16x16x32_bf16 v[160:163], v[80:83], v[32:35], v[160:163]
s_or_b32 s73, s73, s70
ds_read_b64_tr_b16 v[72:73], v13 offset:32768
v_mfma_f32_16x16x32_bf16 v[160:163], v[84:87], v[36:39], v[160:163]
s_lshl_b32 s73, s73, 7
ds_read_b64_tr_b16 v[74:75], v13 offset:33792
v_mfma_f32_16x16x32_bf16 v[164:167], v[84:87], v[44:47], v[164:167]
s_add_u32 s69, s73, s67
v_mfma_f32_16x16x32_bf16 v[164:167], v[80:83], v[40:43], v[164:167]
s_add_u32 s72, s71, 63488
buffer_load_dwordx4 v7, s[12:15], s72 offen offset:2048 lds
v_mfma_f32_16x16x32_bf16 v[168:171], v[80:83], v[48:51], v[168:171]
s_waitcnt vmcnt(18)
ds_read_b64_tr_b16 v[76:77], v13 offset:40960
v_mfma_f32_16x16x32_bf16 v[168:171], v[84:87], v[52:55], v[168:171]
s_add_u32 s70, s73, s68
ds_read_b128 v[96:99], v16 offset:0
v_accvgpr_read_b32 v20, a92
v_mfma_f32_16x16x32_bf16 v[172:175], v[84:87], v[60:63], v[172:175]
s_add_u32 s80, s78, 3072
ds_read_b64_tr_b16 v[78:79], v13 offset:41984
v_accvgpr_read_b32 v28, a93
v_mfma_f32_16x16x32_bf16 v[172:175], v[80:83], v[56:59], v[172:175]
s_waitcnt lgkmcnt(9)
ds_read_b128 v[100:103], v17 offset:0
v_accvgpr_read_b32 v21, a94
v_mfma_f32_16x16x32_bf16 v[188:191], v[88:91], v[56:59], v[188:191]
s_add_u32 s72, s71, 95232
buffer_load_dwordx4 v7, s[12:15], s72 offen offset:3072 lds
v_mfma_f32_16x16x32_bf16 v[188:191], v[92:95], v[60:63], v[188:191]
ds_read_b64_tr_b16 v[80:81], v14 offset:32768
v_accvgpr_read_b32 v29, a95
v_mfma_f32_16x16x32_bf16 v[184:187], v[92:95], v[52:55], v[184:187]
ds_read_b64_tr_b16 v[82:83], v14 offset:33792
v_accvgpr_read_b32 v22, a124
v_mfma_f32_16x16x32_bf16 v[184:187], v[88:91], v[48:51], v[184:187]
buffer_store_dwordx4 v[24:27], v1, s[44:47], s80 offen sc1
v_mfma_f32_16x16x32_bf16 v[180:183], v[88:91], v[40:43], v[180:183]
ds_read_b64_tr_b16 v[84:85], v14 offset:40960
v_accvgpr_read_b32 v30, a125
v_mfma_f32_16x16x32_bf16 v[180:183], v[92:95], v[44:47], v[180:183]
s_add_u32 m0, s63, 98304
ds_read_b64_tr_b16 v[86:87], v14 offset:41984
v_accvgpr_read_b32 v23, a126
v_mfma_f32_16x16x32_bf16 v[176:179], v[92:95], v[36:39], v[176:179]
s_add_u32 s72, s69, 0
buffer_load_dwordx4 v4, s[4:7], s72 offen lds
v_mfma_f32_16x16x32_bf16 v[176:179], v[88:91], v[32:35], v[176:179]
s_waitcnt lgkmcnt(10)
ds_read_b128 v[104:107], v16 offset:2048
v_accvgpr_read_b32 v31, a127
v_mfma_f32_16x16x32_bf16 v[192:195], v[64:67], v[32:35], v[192:195]
ds_read_b64_tr_b16 v[88:89], v15 offset:32768
v_mul_f32 v20, s79, v20
v_mfma_f32_16x16x32_bf16 v[192:195], v[68:71], v[36:39], v[192:195]
ds_read_b64_tr_b16 v[90:91], v15 offset:33792
v_mul_f32 v28, s79, v28
v_mfma_f32_16x16x32_bf16 v[196:199], v[68:71], v[44:47], v[196:199]
ds_read_b64_tr_b16 v[92:93], v15 offset:40960
v_mul_f32 v21, s79, v21
v_mfma_f32_16x16x32_bf16 v[196:199], v[64:67], v[40:43], v[196:199]
s_add_u32 s72, s69, 15360
buffer_load_dwordx4 v5, s[4:7], s72 offen offset:1024 lds
v_mfma_f32_16x16x32_bf16 v[200:203], v[64:67], v[48:51], v[200:203]
ds_read_b64_tr_b16 v[94:95], v15 offset:41984
v_mul_f32 v29, s79, v29
v_mfma_f32_16x16x32_bf16 v[200:203], v[68:71], v[52:55], v[200:203]
ds_read_b128 v[108:111], v17 offset:2048
v_mul_f32 v22, s79, v22
v_mfma_f32_16x16x32_bf16 v[204:207], v[68:71], v[60:63], v[204:207]
v_mul_f32 v30, s79, v30
v_mul_f32 v23, s79, v23
v_mfma_f32_16x16x32_bf16 v[204:207], v[64:67], v[56:59], v[204:207]
s_waitcnt lgkmcnt(11)
ds_read_b128 v[112:115], v16 offset:4096
v_mul_f32 v31, s79, v31
v_mfma_f32_16x16x32_bf16 v[220:223], v[72:75], v[56:59], v[220:223]
s_add_u32 s72, s69, 129024
buffer_load_dwordx4 v4, s[4:7], s72 offen offset:2048 lds
v_mfma_f32_16x16x32_bf16 v[220:223], v[76:79], v[60:63], v[220:223]
v_cvt_pk_bf16_f32 v20, v20, v28
v_cvt_pk_bf16_f32 v21, v21, v29
v_mfma_f32_16x16x32_bf16 v[216:219], v[76:79], v[52:55], v[216:219]
s_waitcnt vmcnt(19) lgkmcnt(2)
ds_read_b128 v[116:119], v17 offset:4096
v_cvt_pk_bf16_f32 v22, v22, v30
v_mfma_f32_16x16x32_bf16 v[216:219], v[72:75], v[48:51], v[216:219]
s_barrier
ds_read_b128 v[120:123], v16 offset:6144
v_cvt_pk_bf16_f32 v23, v23, v31
v_mfma_f32_16x16x32_bf16 v[212:215], v[72:75], v[40:43], v[212:215]
s_add_u32 s80, s77, 46080
ds_read_b64_tr_b16 v[64:65], v8 offset:0
ds_read_b64_tr_b16 v[66:67], v8 offset:1024
v_mfma_f32_16x16x32_bf16 v[212:215], v[76:79], v[44:47], v[212:215]
ds_read_b64_tr_b16 v[68:69], v8 offset:8192
v_accvgpr_read_b32 v24, a232
v_mfma_f32_16x16x32_bf16 v[208:211], v[76:79], v[36:39], v[208:211]
s_add_u32 s72, s69, 144384
buffer_load_dwordx4 v5, s[4:7], s72 offen offset:3072 lds
v_mfma_f32_16x16x32_bf16 v[208:211], v[72:75], v[32:35], v[208:211]
ds_read_b64_tr_b16 v[70:71], v8 offset:9216
v_accvgpr_read_b32 v28, a233
v_mfma_f32_16x16x32_bf16 v[224:227], v[80:83], v[32:35], v[224:227]
ds_read_b64_tr_b16 v[72:73], v9 offset:0
v_accvgpr_read_b32 v25, a234
v_mfma_f32_16x16x32_bf16 v[224:227], v[84:87], v[36:39], v[224:227]
ds_read_b64_tr_b16 v[74:75], v9 offset:1024
v_accvgpr_read_b32 v29, a235
v_mfma_f32_16x16x32_bf16 v[228:231], v[84:87], v[44:47], v[228:231]
s_add_u32 m0, s63, 102400
buffer_store_dwordx4 v[20:23], v1, s[44:47], s80 offen sc1
v_mfma_f32_16x16x32_bf16 v[228:231], v[80:83], v[40:43], v[228:231]
s_add_u32 s72, s70, 0
buffer_load_dwordx4 v4, s[4:7], s72 offen lds
v_mfma_f32_16x16x32_bf16 v[232:235], v[80:83], v[48:51], v[232:235]
ds_read_b64_tr_b16 v[76:77], v9 offset:8192
v_accvgpr_read_b32 v26, a236
v_mfma_f32_16x16x32_bf16 v[232:235], v[84:87], v[52:55], v[232:235]
ds_read_b128 v[124:127], v17 offset:6144
v_accvgpr_read_b32 v30, a237
v_mfma_f32_16x16x32_bf16 v[236:239], v[84:87], v[60:63], v[236:239]
ds_read_b64_tr_b16 v[78:79], v9 offset:9216
v_accvgpr_read_b32 v27, a238
v_mfma_f32_16x16x32_bf16 v[236:239], v[80:83], v[56:59], v[236:239]
v_accvgpr_read_b32 v31, a239
v_cvt_pk_bf16_f32 v24, v24, v28
v_mfma_f32_16x16x32_bf16 v[252:255], v[88:91], v[56:59], v[252:255]
s_add_u32 s72, s70, 15360
buffer_load_dwordx4 v5, s[4:7], s72 offen offset:1024 lds
v_mfma_f32_16x16x32_bf16 v[252:255], v[92:95], v[60:63], v[252:255]
ds_read_b64_tr_b16 v[80:81], v10 offset:0
v_cvt_pk_bf16_f32 v25, v25, v29
v_mfma_f32_16x16x32_bf16 v[248:251], v[92:95], v[52:55], v[248:251]
ds_read_b64_tr_b16 v[82:83], v10 offset:1024
v_cvt_pk_bf16_f32 v26, v26, v30
v_mfma_f32_16x16x32_bf16 v[248:251], v[88:91], v[48:51], v[248:251]
v_cvt_pk_bf16_f32 v27, v27, v31
v_mfma_f32_16x16x32_bf16 v[244:247], v[88:91], v[40:43], v[244:247]
s_add_u32 s80, s78, 11264
ds_read_b64_tr_b16 v[84:85], v10 offset:8192
v_mfma_f32_16x16x32_bf16 v[244:247], v[92:95], v[44:47], v[244:247]
ds_read_b64_tr_b16 v[86:87], v10 offset:9216
v_mfma_f32_16x16x32_bf16 v[240:243], v[92:95], v[36:39], v[240:243]
s_add_u32 s72, s70, 129024
buffer_load_dwordx4 v4, s[4:7], s72 offen offset:2048 lds
v_mfma_f32_16x16x32_bf16 v[240:243], v[88:91], v[32:35], v[240:243]
s_waitcnt lgkmcnt(5)
buffer_store_dwordx4 v[24:27], v1, s[44:47], s80 offen sc1
v_mfma_f32_16x16x32_bf16 v[128:131], v[64:67], v[96:99], v[128:131]
ds_read_b64_tr_b16 v[88:89], v11 offset:0
v_mfma_f32_16x16x32_bf16 v[128:131], v[68:71], v[100:103], v[128:131]
ds_read_b64_tr_b16 v[90:91], v11 offset:1024
v_accvgpr_read_b32 v20, a240
v_mfma_f32_16x16x32_bf16 v[132:135], v[68:71], v[108:111], v[132:135]
v_accvgpr_read_b32 v28, a241
v_accvgpr_read_b32 v21, a242
v_mfma_f32_16x16x32_bf16 v[132:135], v[64:67], v[104:107], v[132:135]
s_add_u32 s72, s70, 144384
buffer_load_dwordx4 v5, s[4:7], s72 offen offset:3072 lds
v_mfma_f32_16x16x32_bf16 v[136:139], v[64:67], v[112:115], v[136:139]
ds_read_b64_tr_b16 v[92:93], v11 offset:8192
v_accvgpr_read_b32 v29, a243
v_mfma_f32_16x16x32_bf16 v[136:139], v[68:71], v[116:119], v[136:139]
s_lshl_b32 s71, s73, 12
v_accvgpr_read_b32 v22, a244
v_accvgpr_read_b32 v30, a245
v_mfma_f32_16x16x32_bf16 v[140:143], v[68:71], v[124:127], v[140:143]
s_add_u32 s71, s71, s66
ds_read_b64_tr_b16 v[94:95], v11 offset:9216
v_accvgpr_read_b32 v23, a246
v_mfma_f32_16x16x32_bf16 v[140:143], v[64:67], v[120:123], v[140:143]
s_waitcnt lgkmcnt(8)
v_accvgpr_read_b32 v31, a247
v_cvt_pk_bf16_f32 v20, v20, v28
v_mfma_f32_16x16x32_bf16 v[156:159], v[72:75], v[120:123], v[156:159]
s_add_u32 m0, s64, 32768
ds_read_b64_tr_b16 v[64:65], v12 offset:0
v_cvt_pk_bf16_f32 v21, v21, v29
v_mfma_f32_16x16x32_bf16 v[156:159], v[76:79], v[124:127], v[156:159]
s_add_u32 s72, s71, 0
buffer_load_dwordx4 v6, s[12:15], s72 offen lds
v_mfma_f32_16x16x32_bf16 v[152:155], v[76:79], v[116:119], v[152:155]
s_add_u32 s73, s62, 12
ds_read_b64_tr_b16 v[66:67], v12 offset:1024
v_cvt_pk_bf16_f32 v22, v22, v30
v_mfma_f32_16x16x32_bf16 v[152:155], v[72:75], v[112:115], v[152:155]
s_add_u32 s70, s73, s65
v_cvt_pk_bf16_f32 v23, v23, v31
v_mfma_f32_16x16x32_bf16 v[148:151], v[72:75], v[104:107], v[148:151]
s_and_b32 s70, s70, 3
ds_read_b64_tr_b16 v[68:69], v12 offset:8192
v_mfma_f32_16x16x32_bf16 v[148:151], v[76:79], v[108:111], v[148:151]
s_and_b32 s73, s73, 12
ds_read_b64_tr_b16 v[70:71], v12 offset:9216
v_mfma_f32_16x16x32_bf16 v[144:147], v[76:79], v[100:103], v[144:147]
s_add_u32 s72, s71, 31744
buffer_load_dwordx4 v6, s[12:15], s72 offen offset:1024 lds
v_mfma_f32_16x16x32_bf16 v[144:147], v[72:75], v[96:99], v[144:147]
s_waitcnt lgkmcnt(8)
v_mfma_f32_16x16x32_bf16 v[160:163], v[80:83], v[96:99], v[160:163]
s_or_b32 s73, s73, s70
ds_read_b64_tr_b16 v[72:73], v13 offset:0
v_mfma_f32_16x16x32_bf16 v[160:163], v[84:87], v[100:103], v[160:163]
s_lshl_b32 s73, s73, 7
ds_read_b64_tr_b16 v[74:75], v13 offset:1024
v_mfma_f32_16x16x32_bf16 v[164:167], v[84:87], v[108:111], v[164:167]
s_add_u32 s69, s73, s67
v_mfma_f32_16x16x32_bf16 v[164:167], v[80:83], v[104:107], v[164:167]
s_add_u32 s72, s71, 63488
buffer_load_dwordx4 v7, s[12:15], s72 offen offset:2048 lds
v_mfma_f32_16x16x32_bf16 v[168:171], v[80:83], v[112:115], v[168:171]
s_waitcnt vmcnt(18)
ds_read_b64_tr_b16 v[76:77], v13 offset:8192
v_mfma_f32_16x16x32_bf16 v[168:171], v[84:87], v[116:119], v[168:171]
s_add_u32 s70, s73, s68
ds_read_b128 v[32:35], v18 offset:0
v_mfma_f32_16x16x32_bf16 v[172:175], v[84:87], v[124:127], v[172:175]
s_add_u32 s80, s78, 35840
ds_read_b64_tr_b16 v[78:79], v13 offset:9216
v_mfma_f32_16x16x32_bf16 v[172:175], v[80:83], v[120:123], v[172:175]
s_waitcnt lgkmcnt(9)
ds_read_b128 v[36:39], v19 offset:0
v_accvgpr_read_b32 v24, a248
v_mfma_f32_16x16x32_bf16 v[188:191], v[88:91], v[120:123], v[188:191]
s_add_u32 s72, s71, 95232
buffer_load_dwordx4 v7, s[12:15], s72 offen offset:3072 lds
v_mfma_f32_16x16x32_bf16 v[188:191], v[92:95], v[124:127], v[188:191]
ds_read_b64_tr_b16 v[80:81], v14 offset:0
v_accvgpr_read_b32 v28, a249
v_mfma_f32_16x16x32_bf16 v[184:187], v[92:95], v[116:119], v[184:187]
ds_read_b64_tr_b16 v[82:83], v14 offset:1024
v_accvgpr_read_b32 v25, a250
v_mfma_f32_16x16x32_bf16 v[184:187], v[88:91], v[112:115], v[184:187]
buffer_store_dwordx4 v[20:23], v1, s[44:47], s80 offen sc1
v_mfma_f32_16x16x32_bf16 v[180:183], v[88:91], v[104:107], v[180:183]
ds_read_b64_tr_b16 v[84:85], v14 offset:8192
v_accvgpr_read_b32 v29, a251
v_mfma_f32_16x16x32_bf16 v[180:183], v[92:95], v[108:111], v[180:183]
s_add_u32 m0, s63, 131072
ds_read_b64_tr_b16 v[86:87], v14 offset:9216
v_accvgpr_read_b32 v26, a252
v_mfma_f32_16x16x32_bf16 v[176:179], v[92:95], v[100:103], v[176:179]
s_add_u32 s72, s69, 0
buffer_load_dwordx4 v4, s[4:7], s72 offen lds
v_mfma_f32_16x16x32_bf16 v[176:179], v[88:91], v[96:99], v[176:179]
s_waitcnt lgkmcnt(10)
ds_read_b128 v[40:43], v18 offset:2048
v_accvgpr_read_b32 v30, a253
v_mfma_f32_16x16x32_bf16 v[192:195], v[64:67], v[96:99], v[192:195]
ds_read_b64_tr_b16 v[88:89], v15 offset:0
v_accvgpr_read_b32 v27, a254
v_mfma_f32_16x16x32_bf16 v[192:195], v[68:71], v[100:103], v[192:195]
ds_read_b64_tr_b16 v[90:91], v15 offset:1024
v_accvgpr_read_b32 v31, a255
v_mfma_f32_16x16x32_bf16 v[196:199], v[68:71], v[108:111], v[196:199]
ds_read_b64_tr_b16 v[92:93], v15 offset:8192
v_cvt_pk_bf16_f32 v24, v24, v28
v_mfma_f32_16x16x32_bf16 v[196:199], v[64:67], v[104:107], v[196:199]
s_add_u32 s72, s69, 15360
buffer_load_dwordx4 v5, s[4:7], s72 offen offset:1024 lds
v_mfma_f32_16x16x32_bf16 v[200:203], v[64:67], v[112:115], v[200:203]
ds_read_b64_tr_b16 v[94:95], v15 offset:9216
v_cvt_pk_bf16_f32 v25, v25, v29
v_mfma_f32_16x16x32_bf16 v[200:203], v[68:71], v[116:119], v[200:203]
ds_read_b128 v[44:47], v19 offset:2048
v_cvt_pk_bf16_f32 v26, v26, v30
v_mfma_f32_16x16x32_bf16 v[204:207], v[68:71], v[124:127], v[204:207]
v_cvt_pk_bf16_f32 v27, v27, v31
v_mfma_f32_16x16x32_bf16 v[204:207], v[64:67], v[120:123], v[204:207]
s_waitcnt lgkmcnt(11)
ds_read_b128 v[48:51], v18 offset:4096
v_mfma_f32_16x16x32_bf16 v[220:223], v[72:75], v[120:123], v[220:223]
s_add_u32 s72, s69, 129024
buffer_load_dwordx4 v4, s[4:7], s72 offen offset:2048 lds
v_mfma_f32_16x16x32_bf16 v[220:223], v[76:79], v[124:127], v[220:223]
s_add_u32 s80, s78, 44032
ds_read_b128 v[52:55], v19 offset:4096
v_mfma_f32_16x16x32_bf16 v[216:219], v[76:79], v[116:119], v[216:219]
s_waitcnt vmcnt(19) lgkmcnt(3)
buffer_store_dwordx4 v[24:27], v1, s[44:47], s80 offen sc1
v_mfma_f32_16x16x32_bf16 v[216:219], v[72:75], v[112:115], v[216:219]
s_barrier
ds_read_b128 v[56:59], v18 offset:6144
v_mfma_f32_16x16x32_bf16 v[212:215], v[72:75], v[104:107], v[212:215]
ds_read_b64_tr_b16 v[64:65], v8 offset:16384
ds_read_b64_tr_b16 v[66:67], v8 offset:17408
v_mfma_f32_16x16x32_bf16 v[212:215], v[76:79], v[108:111], v[212:215]
ds_read_b64_tr_b16 v[68:69], v8 offset:24576
ds_read_b64_tr_b16 v[70:71], v8 offset:25600
v_mfma_f32_16x16x32_bf16 v[208:211], v[76:79], v[100:103], v[208:211]
s_add_u32 s72, s69, 144384
buffer_load_dwordx4 v5, s[4:7], s72 offen offset:3072 lds
v_mfma_f32_16x16x32_bf16 v[208:211], v[72:75], v[96:99], v[208:211]
v_and_b32 v2, 31, v0
v_lshlrev_b32 v2, 2, v2
v_mfma_f32_16x16x32_bf16 v[224:227], v[80:83], v[96:99], v[224:227]
buffer_load_dword v3, v2, s[48:51], 0 offen sc1
v_mfma_f32_16x16x32_bf16 v[224:227], v[84:87], v[100:103], v[224:227]
ds_read_b64_tr_b16 v[72:73], v9 offset:16384
v_mfma_f32_16x16x32_bf16 v[228:231], v[84:87], v[108:111], v[228:231]
s_add_u32 m0, s63, 135168
ds_read_b64_tr_b16 v[74:75], v9 offset:17408
v_mfma_f32_16x16x32_bf16 v[228:231], v[80:83], v[104:107], v[228:231]
s_add_u32 s72, s70, 0
buffer_load_dwordx4 v4, s[4:7], s72 offen lds
v_mfma_f32_16x16x32_bf16 v[232:235], v[80:83], v[112:115], v[232:235]
ds_read_b128 v[60:63], v19 offset:6144
v_mfma_f32_16x16x32_bf16 v[232:235], v[84:87], v[116:119], v[232:235]
ds_read_b64_tr_b16 v[76:77], v9 offset:24576
v_mfma_f32_16x16x32_bf16 v[236:239], v[84:87], v[124:127], v[236:239]
ds_read_b64_tr_b16 v[78:79], v9 offset:25600
v_mfma_f32_16x16x32_bf16 v[236:239], v[80:83], v[120:123], v[236:239]
v_mfma_f32_16x16x32_bf16 v[252:255], v[88:91], v[120:123], v[252:255]
s_add_u32 s72, s70, 15360
buffer_load_dwordx4 v5, s[4:7], s72 offen offset:1024 lds
v_mfma_f32_16x16x32_bf16 v[252:255], v[92:95], v[124:127], v[252:255]
ds_read_b64_tr_b16 v[80:81], v10 offset:16384
v_mfma_f32_16x16x32_bf16 v[248:251], v[92:95], v[116:119], v[248:251]
ds_read_b64_tr_b16 v[82:83], v10 offset:17408
v_mfma_f32_16x16x32_bf16 v[248:251], v[88:91], v[112:115], v[248:251]
v_mfma_f32_16x16x32_bf16 v[244:247], v[88:91], v[104:107], v[244:247]
ds_read_b64_tr_b16 v[84:85], v10 offset:24576
v_mfma_f32_16x16x32_bf16 v[244:247], v[92:95], v[108:111], v[244:247]
ds_read_b64_tr_b16 v[86:87], v10 offset:25600
v_mfma_f32_16x16x32_bf16 v[240:243], v[92:95], v[100:103], v[240:243]
s_add_u32 s72, s70, 129024
buffer_load_dwordx4 v4, s[4:7], s72 offen offset:2048 lds
v_mfma_f32_16x16x32_bf16 v[240:243], v[88:91], v[96:99], v[240:243]
s_waitcnt lgkmcnt(6)
v_mfma_f32_16x16x32_bf16 v[128:131], v[64:67], v[32:35], v[128:131]
ds_read_b64_tr_b16 v[88:89], v11 offset:16384
v_mfma_f32_16x16x32_bf16 v[128:131], v[68:71], v[36:39], v[128:131]
ds_read_b64_tr_b16 v[90:91], v11 offset:17408
v_mfma_f32_16x16x32_bf16 v[132:135], v[68:71], v[44:47], v[132:135]
v_mfma_f32_16x16x32_bf16 v[132:135], v[64:67], v[40:43], v[132:135]
s_add_u32 s72, s70, 144384
buffer_load_dwordx4 v5, s[4:7], s72 offen offset:3072 lds
v_mfma_f32_16x16x32_bf16 v[136:139], v[64:67], v[48:51], v[136:139]
ds_read_b64_tr_b16 v[92:93], v11 offset:24576
v_mfma_f32_16x16x32_bf16 v[136:139], v[68:71], v[52:55], v[136:139]
s_lshl_b32 s71, s73, 12
v_mfma_f32_16x16x32_bf16 v[140:143], v[68:71], v[60:63], v[140:143]
s_add_u32 s71, s71, s66
ds_read_b64_tr_b16 v[94:95], v11 offset:25600
v_mfma_f32_16x16x32_bf16 v[140:143], v[64:67], v[56:59], v[140:143]
s_waitcnt lgkmcnt(8)
v_mfma_f32_16x16x32_bf16 v[156:159], v[72:75], v[56:59], v[156:159]
s_add_u32 m0, s64, 0
ds_read_b64_tr_b16 v[64:65], v12 offset:16384
v_mfma_f32_16x16x32_bf16 v[156:159], v[76:79], v[60:63], v[156:159]
s_add_u32 s72, s71, 0
buffer_load_dwordx4 v6, s[12:15], s72 offen lds
v_mfma_f32_16x16x32_bf16 v[152:155], v[76:79], v[52:55], v[152:155]
s_add_u32 s73, s62, 13
ds_read_b64_tr_b16 v[66:67], v12 offset:17408
v_mfma_f32_16x16x32_bf16 v[152:155], v[72:75], v[48:51], v[152:155]
s_add_u32 s70, s73, s65
v_mfma_f32_16x16x32_bf16 v[148:151], v[72:75], v[40:43], v[148:151]
s_and_b32 s70, s70, 3
ds_read_b64_tr_b16 v[68:69], v12 offset:24576
v_mfma_f32_16x16x32_bf16 v[148:151], v[76:79], v[44:47], v[148:151]
s_and_b32 s73, s73, 12
ds_read_b64_tr_b16 v[70:71], v12 offset:25600
v_mfma_f32_16x16x32_bf16 v[144:147], v[76:79], v[36:39], v[144:147]
s_add_u32 s72, s71, 31744
buffer_load_dwordx4 v6, s[12:15], s72 offen offset:1024 lds
v_mfma_f32_16x16x32_bf16 v[144:147], v[72:75], v[32:35], v[144:147]
s_waitcnt lgkmcnt(8)
v_mfma_f32_16x16x32_bf16 v[160:163], v[80:83], v[32:35], v[160:163]
s_or_b32 s73, s73, s70
ds_read_b64_tr_b16 v[72:73], v13 offset:16384
v_mfma_f32_16x16x32_bf16 v[160:163], v[84:87], v[36:39], v[160:163]
s_lshl_b32 s73, s73, 7
ds_read_b64_tr_b16 v[74:75], v13 offset:17408
v_mfma_f32_16x16x32_bf16 v[164:167], v[84:87], v[44:47], v[164:167]
s_add_u32 s69, s73, s67
v_mfma_f32_16x16x32_bf16 v[164:167], v[80:83], v[40:43], v[164:167]
s_add_u32 s72, s71, 63488
buffer_load_dwordx4 v7, s[12:15], s72 offen offset:2048 lds
v_mfma_f32_16x16x32_bf16 v[168:171], v[80:83], v[48:51], v[168:171]
s_waitcnt vmcnt(18)
ds_read_b64_tr_b16 v[76:77], v13 offset:24576
v_mfma_f32_16x16x32_bf16 v[168:171], v[84:87], v[52:55], v[168:171]
s_add_u32 s70, s73, s68
ds_read_b128 v[96:99], v18 offset:32768
v_mfma_f32_16x16x32_bf16 v[172:175], v[84:87], v[60:63], v[172:175]
ds_read_b64_tr_b16 v[78:79], v13 offset:25600
v_mfma_f32_16x16x32_bf16 v[172:175], v[80:83], v[56:59], v[172:175]
s_waitcnt lgkmcnt(9)
ds_read_b128 v[100:103], v19 offset:32768
v_mfma_f32_16x16x32_bf16 v[188:191], v[88:91], v[56:59], v[188:191]
s_add_u32 s72, s71, 95232
buffer_load_dwordx4 v7, s[12:15], s72 offen offset:3072 lds
v_mfma_f32_16x16x32_bf16 v[188:191], v[92:95], v[60:63], v[188:191]
ds_read_b64_tr_b16 v[80:81], v14 offset:16384
v_mfma_f32_16x16x32_bf16 v[184:187], v[92:95], v[52:55], v[184:187]
ds_read_b64_tr_b16 v[82:83], v14 offset:17408
v_mfma_f32_16x16x32_bf16 v[184:187], v[88:91], v[48:51], v[184:187]
v_mfma_f32_16x16x32_bf16 v[180:183], v[88:91], v[40:43], v[180:183]
ds_read_b64_tr_b16 v[84:85], v14 offset:24576
v_mfma_f32_16x16x32_bf16 v[180:183], v[92:95], v[44:47], v[180:183]
s_add_u32 m0, s63, 65536
ds_read_b64_tr_b16 v[86:87], v14 offset:25600
v_mfma_f32_16x16x32_bf16 v[176:179], v[92:95], v[36:39], v[176:179]
s_add_u32 s72, s69, 0
buffer_load_dwordx4 v4, s[4:7], s72 offen lds
v_mfma_f32_16x16x32_bf16 v[176:179], v[88:91], v[32:35], v[176:179]
s_waitcnt lgkmcnt(10)
ds_read_b128 v[104:107], v18 offset:34816
v_mfma_f32_16x16x32_bf16 v[192:195], v[64:67], v[32:35], v[192:195]
ds_read_b64_tr_b16 v[88:89], v15 offset:16384
v_mfma_f32_16x16x32_bf16 v[192:195], v[68:71], v[36:39], v[192:195]
ds_read_b64_tr_b16 v[90:91], v15 offset:17408
v_mfma_f32_16x16x32_bf16 v[196:199], v[68:71], v[44:47], v[196:199]
ds_read_b64_tr_b16 v[92:93], v15 offset:24576
v_mfma_f32_16x16x32_bf16 v[196:199], v[64:67], v[40:43], v[196:199]
s_add_u32 s72, s69, 15360
buffer_load_dwordx4 v5, s[4:7], s72 offen offset:1024 lds
v_mfma_f32_16x16x32_bf16 v[200:203], v[64:67], v[48:51], v[200:203]
ds_read_b64_tr_b16 v[94:95], v15 offset:25600
v_mfma_f32_16x16x32_bf16 v[200:203], v[68:71], v[52:55], v[200:203]
ds_read_b128 v[108:111], v19 offset:34816
v_mfma_f32_16x16x32_bf16 v[204:207], v[68:71], v[60:63], v[204:207]
v_mfma_f32_16x16x32_bf16 v[204:207], v[64:67], v[56:59], v[204:207]
s_waitcnt lgkmcnt(11)
ds_read_b128 v[112:115], v18 offset:36864
v_mfma_f32_16x16x32_bf16 v[220:223], v[72:75], v[56:59], v[220:223]
s_add_u32 s72, s69, 129024
buffer_load_dwordx4 v4, s[4:7], s72 offen offset:2048 lds
v_mfma_f32_16x16x32_bf16 v[220:223], v[76:79], v[60:63], v[220:223]
v_mfma_f32_16x16x32_bf16 v[216:219], v[76:79], v[52:55], v[216:219]
s_waitcnt vmcnt(13) lgkmcnt(2)
ds_read_b128 v[116:119], v19 offset:36864
v_mfma_f32_16x16x32_bf16 v[216:219], v[72:75], v[48:51], v[216:219]
s_barrier
ds_read_b128 v[120:123], v18 offset:38912
v_mfma_f32_16x16x32_bf16 v[212:215], v[72:75], v[40:43], v[212:215]
ds_read_b64_tr_b16 v[64:65], v8 offset:32768
ds_read_b64_tr_b16 v[66:67], v8 offset:33792
v_mfma_f32_16x16x32_bf16 v[212:215], v[76:79], v[44:47], v[212:215]
ds_read_b64_tr_b16 v[68:69], v8 offset:40960
v_or_b32 v20, s58, v0
v_mfma_f32_16x16x32_bf16 v[208:211], v[76:79], v[36:39], v[208:211]
s_add_u32 s72, s69, 144384
buffer_load_dwordx4 v5, s[4:7], s72 offen offset:3072 lds
v_mfma_f32_16x16x32_bf16 v[208:211], v[72:75], v[32:35], v[208:211]
ds_read_b64_tr_b16 v[70:71], v8 offset:41984
v_mov_b32 v21, 1
v_mfma_f32_16x16x32_bf16 v[224:227], v[80:83], v[32:35], v[224:227]
ds_read_b64_tr_b16 v[72:73], v9 offset:32768
v_min_u32 v20, 1, v20
v_mfma_f32_16x16x32_bf16 v[224:227], v[84:87], v[36:39], v[224:227]
ds_read_b64_tr_b16 v[74:75], v9 offset:33792
v_lshlrev_b32 v20, 30, v20
v_mfma_f32_16x16x32_bf16 v[228:231], v[84:87], v[44:47], v[228:231]
s_add_u32 m0, s63, 69632
buffer_store_dword v21, v20, s[44:47], s91 offen sc1
v_mfma_f32_16x16x32_bf16 v[228:231], v[80:83], v[40:43], v[228:231]
s_add_u32 s72, s70, 0
buffer_load_dwordx4 v4, s[4:7], s72 offen lds
v_mfma_f32_16x16x32_bf16 v[232:235], v[80:83], v[48:51], v[232:235]
ds_read_b64_tr_b16 v[76:77], v9 offset:40960
v_accvgpr_write_b32 a32, 0
v_mfma_f32_16x16x32_bf16 v[232:235], v[84:87], v[52:55], v[232:235]
ds_read_b128 v[124:127], v19 offset:38912
v_accvgpr_write_b32 a33, 0
v_mfma_f32_16x16x32_bf16 v[236:239], v[84:87], v[60:63], v[236:239]
ds_read_b64_tr_b16 v[78:79], v9 offset:41984
v_accvgpr_write_b32 a34, 0
v_mfma_f32_16x16x32_bf16 v[236:239], v[80:83], v[56:59], v[236:239]
v_accvgpr_write_b32 a35, 0
v_accvgpr_write_b32 a36, 0
v_mfma_f32_16x16x32_bf16 v[252:255], v[88:91], v[56:59], v[252:255]
s_add_u32 s72, s70, 15360
buffer_load_dwordx4 v5, s[4:7], s72 offen offset:1024 lds
v_mfma_f32_16x16x32_bf16 v[252:255], v[92:95], v[60:63], v[252:255]
ds_read_b64_tr_b16 v[80:81], v10 offset:32768
v_accvgpr_write_b32 a37, 0
v_mfma_f32_16x16x32_bf16 v[248:251], v[92:95], v[52:55], v[248:251]
ds_read_b64_tr_b16 v[82:83], v10 offset:33792
v_accvgpr_write_b32 a38, 0
v_mfma_f32_16x16x32_bf16 v[248:251], v[88:91], v[48:51], v[248:251]
v_accvgpr_write_b32 a39, 0
v_accvgpr_write_b32 a40, 0
v_mfma_f32_16x16x32_bf16 v[244:247], v[88:91], v[40:43], v[244:247]
ds_read_b64_tr_b16 v[84:85], v10 offset:40960
v_accvgpr_write_b32 a41, 0
v_mfma_f32_16x16x32_bf16 v[244:247], v[92:95], v[44:47], v[244:247]
ds_read_b64_tr_b16 v[86:87], v10 offset:41984
v_accvgpr_write_b32 a42, 0
v_mfma_f32_16x16x32_bf16 v[240:243], v[92:95], v[36:39], v[240:243]
s_add_u32 s72, s70, 129024
buffer_load_dwordx4 v4, s[4:7], s72 offen offset:2048 lds
v_mfma_f32_16x16x32_bf16 v[240:243], v[88:91], v[32:35], v[240:243]
s_waitcnt lgkmcnt(5)
v_accvgpr_write_b32 a43, 0
v_accvgpr_write_b32 a44, 0
v_mfma_f32_16x16x32_bf16 v[128:131], v[64:67], v[96:99], v[128:131]
ds_read_b64_tr_b16 v[88:89], v11 offset:32768
v_accvgpr_write_b32 a45, 0
v_mfma_f32_16x16x32_bf16 v[128:131], v[68:71], v[100:103], v[128:131]
ds_read_b64_tr_b16 v[90:91], v11 offset:33792
v_accvgpr_write_b32 a46, 0
v_mfma_f32_16x16x32_bf16 v[132:135], v[68:71], v[108:111], v[132:135]
v_accvgpr_write_b32 a47, 0
v_accvgpr_write_b32 a48, 0
v_mfma_f32_16x16x32_bf16 v[132:135], v[64:67], v[104:107], v[132:135]
s_add_u32 s72, s70, 144384
buffer_load_dwordx4 v5, s[4:7], s72 offen offset:3072 lds
v_mfma_f32_16x16x32_bf16 v[136:139], v[64:67], v[112:115], v[136:139]
ds_read_b64_tr_b16 v[92:93], v11 offset:40960
v_accvgpr_write_b32 a49, 0
v_mfma_f32_16x16x32_bf16 v[136:139], v[68:71], v[116:119], v[136:139]
s_lshl_b32 s71, s73, 12
v_accvgpr_write_b32 a50, 0
v_accvgpr_write_b32 a51, 0
v_mfma_f32_16x16x32_bf16 v[140:143], v[68:71], v[124:127], v[140:143]
s_add_u32 s71, s71, s66
ds_read_b64_tr_b16 v[94:95], v11 offset:41984
v_accvgpr_write_b32 a52, 0
v_mfma_f32_16x16x32_bf16 v[140:143], v[64:67], v[120:123], v[140:143]
s_waitcnt lgkmcnt(8)
v_accvgpr_write_b32 a53, 0
v_accvgpr_write_b32 a54, 0
v_mfma_f32_16x16x32_bf16 v[156:159], v[72:75], v[120:123], v[156:159]
s_add_u32 m0, s64, 16384
ds_read_b64_tr_b16 v[64:65], v12 offset:32768
v_accvgpr_write_b32 a55, 0
v_mfma_f32_16x16x32_bf16 v[156:159], v[76:79], v[124:127], v[156:159]
s_add_u32 s72, s71, 0
buffer_load_dwordx4 v6, s[12:15], s72 offen lds
v_mfma_f32_16x16x32_bf16 v[152:155], v[76:79], v[116:119], v[152:155]
s_add_u32 s73, s62, 14
ds_read_b64_tr_b16 v[66:67], v12 offset:33792
v_accvgpr_write_b32 a56, 0
v_mfma_f32_16x16x32_bf16 v[152:155], v[72:75], v[112:115], v[152:155]
s_add_u32 s70, s73, s65
v_accvgpr_write_b32 a57, 0
v_accvgpr_write_b32 a58, 0
v_mfma_f32_16x16x32_bf16 v[148:151], v[72:75], v[104:107], v[148:151]
s_and_b32 s70, s70, 3
ds_read_b64_tr_b16 v[68:69], v12 offset:40960
v_accvgpr_write_b32 a59, 0
v_mfma_f32_16x16x32_bf16 v[148:151], v[76:79], v[108:111], v[148:151]
s_and_b32 s73, s73, 12
ds_read_b64_tr_b16 v[70:71], v12 offset:41984
v_accvgpr_write_b32 a60, 0
v_mfma_f32_16x16x32_bf16 v[144:147], v[76:79], v[100:103], v[144:147]
s_add_u32 s72, s71, 31744
buffer_load_dwordx4 v6, s[12:15], s72 offen offset:1024 lds
v_mfma_f32_16x16x32_bf16 v[144:147], v[72:75], v[96:99], v[144:147]
s_waitcnt lgkmcnt(8)
v_accvgpr_write_b32 a61, 0
v_accvgpr_write_b32 a62, 0
v_mfma_f32_16x16x32_bf16 v[160:163], v[80:83], v[96:99], v[160:163]
s_or_b32 s73, s73, s70
ds_read_b64_tr_b16 v[72:73], v13 offset:32768
v_accvgpr_write_b32 a63, 0
v_mfma_f32_16x16x32_bf16 v[160:163], v[84:87], v[100:103], v[160:163]
s_lshl_b32 s73, s73, 7
ds_read_b64_tr_b16 v[74:75], v13 offset:33792
v_accvgpr_write_b32 a96, 0
v_mfma_f32_16x16x32_bf16 v[164:167], v[84:87], v[108:111], v[164:167]
s_add_u32 s69, s73, s67
v_accvgpr_write_b32 a97, 0
v_accvgpr_write_b32 a98, 0
v_mfma_f32_16x16x32_bf16 v[164:167], v[80:83], v[104:107], v[164:167]
s_add_u32 s72, s71, 63488
buffer_load_dwordx4 v7, s[12:15], s72 offen offset:2048 lds
v_mfma_f32_16x16x32_bf16 v[168:171], v[80:83], v[112:115], v[168:171]
s_waitcnt vmcnt(16)
ds_read_b64_tr_b16 v[76:77], v13 offset:40960
v_accvgpr_write_b32 a99, 0
v_mfma_f32_16x16x32_bf16 v[168:171], v[84:87], v[116:119], v[168:171]
s_add_u32 s70, s73, s68
ds_read_b128 v[32:35], v16 offset:0
v_accvgpr_write_b32 a100, 0
v_mfma_f32_16x16x32_bf16 v[172:175], v[84:87], v[124:127], v[172:175]
ds_read_b64_tr_b16 v[78:79], v13 offset:41984
v_accvgpr_write_b32 a101, 0
v_mfma_f32_16x16x32_bf16 v[172:175], v[80:83], v[120:123], v[172:175]
s_waitcnt lgkmcnt(9)
ds_read_b128 v[36:39], v17 offset:0
v_accvgpr_write_b32 a102, 0
v_mfma_f32_16x16x32_bf16 v[188:191], v[88:91], v[120:123], v[188:191]
s_add_u32 s72, s71, 95232
buffer_load_dwordx4 v7, s[12:15], s72 offen offset:3072 lds
v_mfma_f32_16x16x32_bf16 v[188:191], v[92:95], v[124:127], v[188:191]
ds_read_b64_tr_b16 v[80:81], v14 offset:32768
v_accvgpr_write_b32 a103, 0
v_mfma_f32_16x16x32_bf16 v[184:187], v[92:95], v[116:119], v[184:187]
ds_read_b64_tr_b16 v[82:83], v14 offset:33792
v_accvgpr_write_b32 a104, 0
v_mfma_f32_16x16x32_bf16 v[184:187], v[88:91], v[112:115], v[184:187]
v_accvgpr_write_b32 a105, 0
v_accvgpr_write_b32 a106, 0
v_mfma_f32_16x16x32_bf16 v[180:183], v[88:91], v[104:107], v[180:183]
ds_read_b64_tr_b16 v[84:85], v14 offset:40960
v_accvgpr_write_b32 a107, 0
v_mfma_f32_16x16x32_bf16 v[180:183], v[92:95], v[108:111], v[180:183]
s_add_u32 m0, s63, 98304
ds_read_b64_tr_b16 v[86:87], v14 offset:41984
v_accvgpr_write_b32 a108, 0
v_mfma_f32_16x16x32_bf16 v[176:179], v[92:95], v[100:103], v[176:179]
s_add_u32 s72, s69, 0
buffer_load_dwordx4 v4, s[4:7], s72 offen lds
v_mfma_f32_16x16x32_bf16 v[176:179], v[88:91], v[96:99], v[176:179]
s_waitcnt lgkmcnt(10)
ds_read_b128 v[40:43], v16 offset:2048
v_accvgpr_write_b32 a109, 0
v_mfma_f32_16x16x32_bf16 v[192:195], v[64:67], v[96:99], v[192:195]
ds_read_b64_tr_b16 v[88:89], v15 offset:32768
v_accvgpr_write_b32 a110, 0
v_mfma_f32_16x16x32_bf16 v[192:195], v[68:71], v[100:103], v[192:195]
ds_read_b64_tr_b16 v[90:91], v15 offset:33792
v_accvgpr_write_b32 a111, 0
v_mfma_f32_16x16x32_bf16 v[196:199], v[68:71], v[108:111], v[196:199]
ds_read_b64_tr_b16 v[92:93], v15 offset:40960
v_accvgpr_write_b32 a112, 0
v_mfma_f32_16x16x32_bf16 v[196:199], v[64:67], v[104:107], v[196:199]
s_add_u32 s72, s69, 15360
buffer_load_dwordx4 v5, s[4:7], s72 offen offset:1024 lds
v_mfma_f32_16x16x32_bf16 v[200:203], v[64:67], v[112:115], v[200:203]
ds_read_b64_tr_b16 v[94:95], v15 offset:41984
v_accvgpr_write_b32 a113, 0
v_mfma_f32_16x16x32_bf16 v[200:203], v[68:71], v[116:119], v[200:203]
ds_read_b128 v[44:47], v17 offset:2048
v_accvgpr_write_b32 a114, 0
v_mfma_f32_16x16x32_bf16 v[204:207], v[68:71], v[124:127], v[204:207]
v_accvgpr_write_b32 a115, 0
v_accvgpr_write_b32 a116, 0
v_mfma_f32_16x16x32_bf16 v[204:207], v[64:67], v[120:123], v[204:207]
s_waitcnt lgkmcnt(11)
ds_read_b128 v[48:51], v16 offset:4096
v_accvgpr_write_b32 a117, 0
v_mfma_f32_16x16x32_bf16 v[220:223], v[72:75], v[120:123], v[220:223]
s_add_u32 s72, s69, 129024
buffer_load_dwordx4 v4, s[4:7], s72 offen offset:2048 lds
v_mfma_f32_16x16x32_bf16 v[220:223], v[76:79], v[124:127], v[220:223]
v_accvgpr_write_b32 a118, 0
v_accvgpr_write_b32 a119, 0
v_mfma_f32_16x16x32_bf16 v[216:219], v[76:79], v[116:119], v[216:219]
s_waitcnt vmcnt(16) lgkmcnt(2)
ds_read_b128 v[52:55], v17 offset:4096
v_accvgpr_write_b32 a120, 0
v_mfma_f32_16x16x32_bf16 v[216:219], v[72:75], v[112:115], v[216:219]
s_barrier
ds_read_b128 v[56:59], v16 offset:6144
v_accvgpr_write_b32 a121, 0
v_mfma_f32_16x16x32_bf16 v[212:215], v[72:75], v[104:107], v[212:215]
s_waitcnt vmcnt(24)
v_cmp_gt_u32 vcc, 8, v3
s_cbranch_vccnz Lspin1
Lback2:
v_mfma_f32_16x16x32_bf16 v[212:215], v[76:79], v[108:111], v[212:215]
ds_read_b64_tr_b16 v[64:65], v8 offset:0
ds_read_b64_tr_b16 v[66:67], v8 offset:1024
v_mfma_f32_16x16x32_bf16 v[208:211], v[76:79], v[100:103], v[208:211]
s_add_u32 s72, s69, 144384
buffer_load_dwordx4 v5, s[4:7], s72 offen offset:3072 lds
v_mfma_f32_16x16x32_bf16 v[208:211], v[72:75], v[96:99], v[208:211]
ds_read_b64_tr_b16 v[68:69], v8 offset:8192
ds_read_b64_tr_b16 v[70:71], v8 offset:9216
v_mfma_f32_16x16x32_bf16 v[224:227], v[80:83], v[96:99], v[224:227]
ds_read_b64_tr_b16 v[72:73], v9 offset:0
v_accvgpr_write_b32 a122, 0
v_mfma_f32_16x16x32_bf16 v[224:227], v[84:87], v[100:103], v[224:227]
ds_read_b64_tr_b16 v[74:75], v9 offset:1024
v_accvgpr_write_b32 a123, 0
v_mfma_f32_16x16x32_bf16 v[228:231], v[84:87], v[108:111], v[228:231]
s_add_u32 m0, s63, 102400
v_accvgpr_write_b32 a124, 0
v_accvgpr_write_b32 a125, 0
v_mfma_f32_16x16x32_bf16 v[228:231], v[80:83], v[104:107], v[228:231]
s_add_u32 s72, s70, 0
buffer_load_dwordx4 v4, s[4:7], s72 offen lds
v_mfma_f32_16x16x32_bf16 v[232:235], v[80:83], v[112:115], v[232:235]
ds_read_b64_tr_b16 v[76:77], v9 offset:8192
v_accvgpr_write_b32 a126, 0
v_mfma_f32_16x16x32_bf16 v[232:235], v[84:87], v[116:119], v[232:235]
ds_read_b128 v[60:63], v17 offset:6144
v_accvgpr_write_b32 a127, 0
v_mfma_f32_16x16x32_bf16 v[236:239], v[84:87], v[124:127], v[236:239]
ds_read_b64_tr_b16 v[78:79], v9 offset:9216
v_mfma_f32_16x16x32_bf16 v[236:239], v[80:83], v[120:123], v[236:239]
v_mfma_f32_16x16x32_bf16 v[252:255], v[88:91], v[120:123], v[252:255]
s_add_u32 s72, s70, 15360
buffer_load_dwordx4 v5, s[4:7], s72 offen offset:1024 lds
v_mfma_f32_16x16x32_bf16 v[252:255], v[92:95], v[124:127], v[252:255]
ds_read_b64_tr_b16 v[80:81], v10 offset:0
v_mfma_f32_16x16x32_bf16 v[248:251], v[92:95], v[116:119], v[248:251]
ds_read_b64_tr_b16 v[82:83], v10 offset:1024
v_mfma_f32_16x16x32_bf16 v[248:251], v[88:91], v[112:115], v[248:251]
v_mfma_f32_16x16x32_bf16 v[244:247], v[88:91], v[104:107], v[244:247]
ds_read_b64_tr_b16 v[84:85], v10 offset:8192
v_mfma_f32_16x16x32_bf16 v[244:247], v[92:95], v[108:111], v[244:247]
ds_read_b64_tr_b16 v[86:87], v10 offset:9216
v_mfma_f32_16x16x32_bf16 v[240:243], v[92:95], v[100:103], v[240:243]
s_add_u32 s72, s70, 129024
buffer_load_dwordx4 v4, s[4:7], s72 offen offset:2048 lds
v_mfma_f32_16x16x32_bf16 v[240:243], v[88:91], v[96:99], v[240:243]
s_waitcnt lgkmcnt(5)
v_mfma_f32_16x16x32_bf16 v[128:131], v[64:67], v[32:35], v[128:131]
ds_read_b64_tr_b16 v[88:89], v11 offset:0
v_mfma_f32_16x16x32_bf16 v[128:131], v[68:71], v[36:39], v[128:131]
ds_read_b64_tr_b16 v[90:91], v11 offset:1024
v_mfma_f32_16x16x32_bf16 v[132:135], v[68:71], v[44:47], v[132:135]
v_mfma_f32_16x16x32_bf16 v[132:135], v[64:67], v[40:43], v[132:135]
s_add_u32 s72, s70, 144384
buffer_load_dwordx4 v5, s[4:7], s72 offen offset:3072 lds
v_mfma_f32_16x16x32_bf16 v[136:139], v[64:67], v[48:51], v[136:139]
ds_read_b64_tr_b16 v[92:93], v11 offset:8192
v_mfma_f32_16x16x32_bf16 v[136:139], v[68:71], v[52:55], v[136:139]
s_lshl_b32 s71, s73, 12
v_mfma_f32_16x16x32_bf16 v[140:143], v[68:71], v[60:63], v[140:143]
s_add_u32 s71, s71, s66
ds_read_b64_tr_b16 v[94:95], v11 offset:9216
v_mfma_f32_16x16x32_bf16 v[140:143], v[64:67], v[56:59], v[140:143]
s_waitcnt lgkmcnt(8)
v_mfma_f32_16x16x32_bf16 v[156:159], v[72:75], v[56:59], v[156:159]
s_add_u32 m0, s64, 32768
ds_read_b64_tr_b16 v[64:65], v12 offset:0
v_mfma_f32_16x16x32_bf16 v[156:159], v[76:79], v[60:63], v[156:159]
s_add_u32 s72, s71, 0
buffer_load_dwordx4 v6, s[12:15], s72 offen lds
v_mfma_f32_16x16x32_bf16 v[152:155], v[76:79], v[52:55], v[152:155]
s_add_u32 s73, s62, 15
ds_read_b64_tr_b16 v[66:67], v12 offset:1024
v_mfma_f32_16x16x32_bf16 v[152:155], v[72:75], v[48:51], v[152:155]
s_add_u32 s70, s73, s65
v_mfma_f32_16x16x32_bf16 v[148:151], v[72:75], v[40:43], v[148:151]
s_and_b32 s70, s70, 3
ds_read_b64_tr_b16 v[68:69], v12 offset:8192
v_mfma_f32_16x16x32_bf16 v[148:151], v[76:79], v[44:47], v[148:151]
s_and_b32 s73, s73, 12
ds_read_b64_tr_b16 v[70:71], v12 offset:9216
v_mfma_f32_16x16x32_bf16 v[144:147], v[76:79], v[36:39], v[144:147]
s_add_u32 s72, s71, 31744
buffer_load_dwordx4 v6, s[12:15], s72 offen offset:1024 lds
v_mfma_f32_16x16x32_bf16 v[144:147], v[72:75], v[32:35], v[144:147]
s_waitcnt lgkmcnt(8)
v_mfma_f32_16x16x32_bf16 v[160:163], v[80:83], v[32:35], v[160:163]
s_or_b32 s73, s73, s70
ds_read_b64_tr_b16 v[72:73], v13 offset:0
v_mfma_f32_16x16x32_bf16 v[160:163], v[84:87], v[36:39], v[160:163]
s_lshl_b32 s73, s73, 7
ds_read_b64_tr_b16 v[74:75], v13 offset:1024
v_mfma_f32_16x16x32_bf16 v[164:167], v[84:87], v[44:47], v[164:167]
s_add_u32 s69, s73, s67
v_mfma_f32_16x16x32_bf16 v[164:167], v[80:83], v[40:43], v[164:167]
s_add_u32 s72, s71, 63488
buffer_load_dwordx4 v7, s[12:15], s72 offen offset:2048 lds
v_mfma_f32_16x16x32_bf16 v[168:171], v[80:83], v[48:51], v[168:171]
s_waitcnt vmcnt(15)
ds_read_b64_tr_b16 v[76:77], v13 offset:8192
v_mfma_f32_16x16x32_bf16 v[168:171], v[84:87], v[52:55], v[168:171]
s_add_u32 s70, s73, s68
ds_read_b128 v[96:99], v18 offset:0
v_mfma_f32_16x16x32_bf16 v[172:175], v[84:87], v[60:63], v[172:175]
ds_read_b64_tr_b16 v[78:79], v13 offset:9216
v_mfma_f32_16x16x32_bf16 v[172:175], v[80:83], v[56:59], v[172:175]
s_waitcnt lgkmcnt(9)
ds_read_b128 v[100:103], v19 offset:0
v_mfma_f32_16x16x32_bf16 v[188:191], v[88:91], v[56:59], v[188:191]
s_add_u32 s72, s71, 95232
buffer_load_dwordx4 v7, s[12:15], s72 offen offset:3072 lds
v_mfma_f32_16x16x32_bf16 v[188:191], v[92:95], v[60:63], v[188:191]
ds_read_b64_tr_b16 v[80:81], v14 offset:0
v_mfma_f32_16x16x32_bf16 v[184:187], v[92:95], v[52:55], v[184:187]
ds_read_b64_tr_b16 v[82:83], v14 offset:1024
v_mfma_f32_16x16x32_bf16 v[184:187], v[88:91], v[48:51], v[184:187]
v_mfma_f32_16x16x32_bf16 v[180:183], v[88:91], v[40:43], v[180:183]
ds_read_b64_tr_b16 v[84:85], v14 offset:8192
v_mfma_f32_16x16x32_bf16 v[180:183], v[92:95], v[44:47], v[180:183]
s_add_u32 m0, s63, 131072
ds_read_b64_tr_b16 v[86:87], v14 offset:9216
v_mfma_f32_16x16x32_bf16 v[176:179], v[92:95], v[36:39], v[176:179]
s_add_u32 s72, s69, 0
buffer_load_dwordx4 v4, s[4:7], s72 offen lds
v_mfma_f32_16x16x32_bf16 v[176:179], v[88:91], v[32:35], v[176:179]
s_waitcnt lgkmcnt(10)
ds_read_b128 v[104:107], v18 offset:2048
v_mfma_f32_16x16x32_bf16 v[192:195], v[64:67], v[32:35], v[192:195]
ds_read_b64_tr_b16 v[88:89], v15 offset:0
ds_read_b64_tr_b16 v[90:91], v15 offset:1024
v_mfma_f32_16x16x32_bf16 v[192:195], v[68:71], v[36:39], v[192:195]
ds_read_b64_tr_b16 v[92:93], v15 offset:8192
v_mfma_f32_16x16x32_bf16 v[196:199], v[68:71], v[44:47], v[196:199]
s_and_b32 s75, s91, 0xfffffc7f
v_lshrrev_b32 v2, 3, v0
v_lshlrev_b32 v2, 7, v2
v_mfma_f32_16x16x32_bf16 v[196:199], v[64:67], v[40:43], v[196:199]
s_add_u32 s72, s69, 15360
buffer_load_dwordx4 v5, s[4:7], s72 offen offset:1024 lds
v_mfma_f32_16x16x32_bf16 v[200:203], v[64:67], v[48:51], v[200:203]
buffer_load_dword v3, v2, s[44:47], s75 offen sc1
v_mfma_f32_16x16x32_bf16 v[200:203], v[68:71], v[52:55], v[200:203]
ds_read_b64_tr_b16 v[94:95], v15 offset:9216
v_mfma_f32_16x16x32_bf16 v[204:207], v[68:71], v[60:63], v[204:207]
ds_read_b128 v[108:111], v19 offset:2048
v_mfma_f32_16x16x32_bf16 v[204:207], v[64:67], v[56:59], v[204:207]
s_waitcnt lgkmcnt(11)
v_mfma_f32_16x16x32_bf16 v[220:223], v[72:75], v[56:59], v[220:223]
s_add_u32 s72, s69, 129024
buffer_load_dwordx4 v4, s[4:7], s72 offen offset:2048 lds
v_mfma_f32_16x16x32_bf16 v[220:223], v[76:79], v[60:63], v[220:223]
ds_read_b128 v[112:115], v18 offset:4096
v_mfma_f32_16x16x32_bf16 v[216:219], v[76:79], v[52:55], v[216:219]
s_waitcnt vmcnt(16) lgkmcnt(2)
ds_read_b128 v[116:119], v19 offset:4096
v_mfma_f32_16x16x32_bf16 v[216:219], v[72:75], v[48:51], v[216:219]
s_barrier
v_mfma_f32_16x16x32_bf16 v[212:215], v[72:75], v[40:43], v[212:215]
ds_read_b64_tr_b16 v[64:65], v8 offset:16384
ds_read_b64_tr_b16 v[66:67], v8 offset:17408
v_mfma_f32_16x16x32_bf16 v[212:215], v[76:79], v[44:47], v[212:215]
ds_read_b64_tr_b16 v[68:69], v8 offset:24576
v_mfma_f32_16x16x32_bf16 v[208:211], v[76:79], v[36:39], v[208:211]
s_add_u32 s72, s69, 144384
buffer_load_dwordx4 v5, s[4:7], s72 offen offset:3072 lds
v_mfma_f32_16x16x32_bf16 v[208:211], v[72:75], v[32:35], v[208:211]
ds_read_b64_tr_b16 v[70:71], v8 offset:25600
v_mfma_f32_16x16x32_bf16 v[224:227], v[80:83], v[32:35], v[224:227]
ds_read_b64_tr_b16 v[72:73], v9 offset:16384
v_mfma_f32_16x16x32_bf16 v[224:227], v[84:87], v[36:39], v[224:227]
ds_read_b64_tr_b16 v[74:75], v9 offset:17408
v_mfma_f32_16x16x32_bf16 v[228:231], v[84:87], v[44:47], v[228:231]
s_add_u32 m0, s63, 135168
ds_read_b128 v[120:123], v18 offset:6144
v_mfma_f32_16x16x32_bf16 v[228:231], v[80:83], v[40:43], v[228:231]
s_add_u32 s72, s70, 0
buffer_load_dwordx4 v4, s[4:7], s72 offen lds
v_mfma_f32_16x16x32_bf16 v[232:235], v[80:83], v[48:51], v[232:235]
ds_read_b64_tr_b16 v[76:77], v9 offset:24576
v_mfma_f32_16x16x32_bf16 v[232:235], v[84:87], v[52:55], v[232:235]
ds_read_b128 v[124:127], v19 offset:6144
v_mfma_f32_16x16x32_bf16 v[236:239], v[84:87], v[60:63], v[236:239]
ds_read_b64_tr_b16 v[78:79], v9 offset:25600
v_mfma_f32_16x16x32_bf16 v[236:239], v[80:83], v[56:59], v[236:239]
v_mfma_f32_16x16x32_bf16 v[252:255], v[88:91], v[56:59], v[252:255]
s_add_u32 s72, s70, 15360
buffer_load_dwordx4 v5, s[4:7], s72 offen offset:1024 lds
v_mfma_f32_16x16x32_bf16 v[252:255], v[92:95], v[60:63], v[252:255]
ds_read_b64_tr_b16 v[80:81], v10 offset:16384
v_mfma_f32_16x16x32_bf16 v[248:251], v[92:95], v[52:55], v[248:251]
ds_read_b64_tr_b16 v[82:83], v10 offset:17408
v_mfma_f32_16x16x32_bf16 v[248:251], v[88:91], v[48:51], v[248:251]
v_mfma_f32_16x16x32_bf16 v[244:247], v[88:91], v[40:43], v[244:247]
ds_read_b64_tr_b16 v[84:85], v10 offset:24576
v_mfma_f32_16x16x32_bf16 v[244:247], v[92:95], v[44:47], v[244:247]
ds_read_b64_tr_b16 v[86:87], v10 offset:25600
v_mfma_f32_16x16x32_bf16 v[240:243], v[92:95], v[36:39], v[240:243]
s_add_u32 s72, s70, 129024
buffer_load_dwordx4 v4, s[4:7], s72 offen offset:2048 lds
v_mfma_f32_16x16x32_bf16 v[240:243], v[88:91], v[32:35], v[240:243]
s_waitcnt lgkmcnt(5)
v_mfma_f32_16x16x32_bf16 v[128:131], v[64:67], v[96:99], v[128:131]
ds_read_b64_tr_b16 v[88:89], v11 offset:16384
v_mfma_f32_16x16x32_bf16 v[128:131], v[68:71], v[100:103], v[128:131]
ds_read_b64_tr_b16 v[90:91], v11 offset:17408
v_mfma_f32_16x16x32_bf16 v[132:135], v[68:71], v[108:111], v[132:135]
v_mfma_f32_16x16x32_bf16 v[132:135], v[64:67], v[104:107], v[132:135]
s_add_u32 s72, s70, 144384
buffer_load_dwordx4 v5, s[4:7], s72 offen offset:3072 lds
v_mfma_f32_16x16x32_bf16 v[136:139], v[64:67], v[112:115], v[136:139]
ds_read_b64_tr_b16 v[92:93], v11 offset:24576
v_mfma_f32_16x16x32_bf16 v[136:139], v[68:71], v[116:119], v[136:139]
s_lshl_b32 s71, s73, 12
v_mfma_f32_16x16x32_bf16 v[140:143], v[68:71], v[124:127], v[140:143]
s_add_u32 s71, s71, s66
ds_read_b64_tr_b16 v[94:95], v11 offset:25600
v_mfma_f32_16x16x32_bf16 v[140:143], v[64:67], v[120:123], v[140:143]
s_waitcnt lgkmcnt(8)
v_mfma_f32_16x16x32_bf16 v[156:159], v[72:75], v[120:123], v[156:159]
s_add_u32 m0, s64, 0
ds_read_b64_tr_b16 v[64:65], v12 offset:16384
v_mfma_f32_16x16x32_bf16 v[156:159], v[76:79], v[124:127], v[156:159]
s_add_u32 s72, s71, 0
buffer_load_dwordx4 v6, s[12:15], s72 offen lds
v_mfma_f32_16x16x32_bf16 v[152:155], v[76:79], v[116:119], v[152:155]
ds_read_b64_tr_b16 v[66:67], v12 offset:17408
v_mfma_f32_16x16x32_bf16 v[152:155], v[72:75], v[112:115], v[152:155]
v_mfma_f32_16x16x32_bf16 v[148:151], v[72:75], v[104:107], v[148:151]
ds_read_b64_tr_b16 v[68:69], v12 offset:24576
v_mfma_f32_16x16x32_bf16 v[148:151], v[76:79], v[108:111], v[148:151]
ds_read_b64_tr_b16 v[70:71], v12 offset:25600
v_mfma_f32_16x16x32_bf16 v[144:147], v[76:79], v[100:103], v[144:147]
s_add_u32 s72, s71, 31744
buffer_load_dwordx4 v6, s[12:15], s72 offen offset:1024 lds
v_mfma_f32_16x16x32_bf16 v[144:147], v[72:75], v[96:99], v[144:147]
s_waitcnt lgkmcnt(8)
v_mfma_f32_16x16x32_bf16 v[160:163], v[80:83], v[96:99], v[160:163]
ds_read_b64_tr_b16 v[72:73], v13 offset:16384
v_mfma_f32_16x16x32_bf16 v[160:163], v[84:87], v[100:103], v[160:163]
ds_read_b64_tr_b16 v[74:75], v13 offset:17408
v_mfma_f32_16x16x32_bf16 v[164:167], v[84:87], v[108:111], v[164:167]
v_mfma_f32_16x16x32_bf16 v[164:167], v[80:83], v[104:107], v[164:167]
s_add_u32 s72, s71, 63488
buffer_load_dwordx4 v7, s[12:15], s72 offen offset:2048 lds
v_mfma_f32_16x16x32_bf16 v[168:171], v[80:83], v[112:115], v[168:171]
s_waitcnt vmcnt(16)
ds_read_b64_tr_b16 v[76:77], v13 offset:24576
v_mfma_f32_16x16x32_bf16 v[168:171], v[84:87], v[116:119], v[168:171]
ds_read_b128 v[32:35], v18 offset:32768
v_mfma_f32_16x16x32_bf16 v[172:175], v[84:87], v[124:127], v[172:175]
ds_read_b64_tr_b16 v[78:79], v13 offset:25600
v_mfma_f32_16x16x32_bf16 v[172:175], v[80:83], v[120:123], v[172:175]
s_waitcnt lgkmcnt(9)
ds_read_b128 v[36:39], v19 offset:32768
v_mfma_f32_16x16x32_bf16 v[188:191], v[88:91], v[120:123], v[188:191]
s_add_u32 s72, s71, 95232
buffer_load_dwordx4 v7, s[12:15], s72 offen offset:3072 lds
v_mfma_f32_16x16x32_bf16 v[188:191], v[92:95], v[124:127], v[188:191]
v_accvgpr_write_b32 a0, -1
v_accvgpr_write_b32 a1, -1
v_mfma_f32_16x16x32_bf16 v[184:187], v[92:95], v[116:119], v[184:187]
v_accvgpr_write_b32 a2, -1
v_accvgpr_write_b32 a3, -1
v_mfma_f32_16x16x32_bf16 v[184:187], v[88:91], v[112:115], v[184:187]
s_add_u32 s80, s93, 0x3a00000
ds_read_b64_tr_b16 v[80:81], v14 offset:16384
v_mfma_f32_16x16x32_bf16 v[180:183], v[88:91], v[104:107], v[180:183]
ds_read_b64_tr_b16 v[82:83], v14 offset:17408
v_mfma_f32_16x16x32_bf16 v[180:183], v[92:95], v[108:111], v[180:183]
ds_read_b64_tr_b16 v[84:85], v14 offset:24576
v_mfma_f32_16x16x32_bf16 v[176:179], v[92:95], v[100:103], v[176:179]
ds_read_b64_tr_b16 v[86:87], v14 offset:25600
v_mfma_f32_16x16x32_bf16 v[176:179], v[88:91], v[96:99], v[176:179]
s_waitcnt lgkmcnt(10)
ds_read_b128 v[40:43], v18 offset:34816
v_mfma_f32_16x16x32_bf16 v[192:195], v[64:67], v[96:99], v[192:195]
s_waitcnt vmcnt(10)
v_cmp_gt_u32 vcc, 1, v3
s_cbranch_vccnz Lspin4
Lback5:
v_mfma_f32_16x16x32_bf16 v[192:195], v[68:71], v[100:103], v[192:195]
s_add_u32 m0, s64, 49152
ds_read_b64_tr_b16 v[88:89], v15 offset:16384
ds_read_b64_tr_b16 v[90:91], v15 offset:17408
v_mfma_f32_16x16x32_bf16 v[196:199], v[68:71], v[108:111], v[196:199]
s_add_u32 s72, s81, 16384
buffer_load_dwordx4 v1, s[44:47], s72 offen sc1 lds
v_mfma_f32_16x16x32_bf16 v[196:199], v[64:67], v[104:107], v[196:199]
ds_read_b64_tr_b16 v[92:93], v15 offset:24576
v_mfma_f32_16x16x32_bf16 v[200:203], v[64:67], v[112:115], v[200:203]
ds_read_b64_tr_b16 v[94:95], v15 offset:25600
v_mfma_f32_16x16x32_bf16 v[200:203], v[68:71], v[116:119], v[200:203]
buffer_load_dwordx4 v1, s[44:47], s72 offen offset:1024 sc1 lds
v_mfma_f32_16x16x32_bf16 v[204:207], v[68:71], v[124:127], v[204:207]
ds_read_b128 v[44:47], v19 offset:34816
v_mfma_f32_16x16x32_bf16 v[204:207], v[64:67], v[120:123], v[204:207]
s_waitcnt lgkmcnt(11)
v_mfma_f32_16x16x32_bf16 v[220:223], v[72:75], v[120:123], v[220:223]
ds_read_b128 v[48:51], v18 offset:36864
v_mfma_f32_16x16x32_bf16 v[220:223], v[76:79], v[124:127], v[220:223]
ds_read_b128 v[52:55], v19 offset:36864
v_mfma_f32_16x16x32_bf16 v[216:219], v[76:79], v[116:119], v[216:219]
s_waitcnt vmcnt(15) lgkmcnt(3)
buffer_load_dwordx4 v1, s[44:47], s72 offen offset:2048 sc1 lds
v_mfma_f32_16x16x32_bf16 v[216:219], v[72:75], v[112:115], v[216:219]
s_barrier
ds_read_b128 v[56:59], v18 offset:38912
v_mfma_f32_16x16x32_bf16 v[212:215], v[72:75], v[104:107], v[212:215]
ds_read_b64_tr_b16 v[64:65], v8 offset:32768
ds_read_b64_tr_b16 v[66:67], v8 offset:33792
v_mfma_f32_16x16x32_bf16 v[212:215], v[76:79], v[108:111], v[212:215]
ds_read_b64_tr_b16 v[68:69], v8 offset:40960
v_mfma_f32_16x16x32_bf16 v[208:211], v[76:79], v[100:103], v[208:211]
ds_read_b64_tr_b16 v[70:71], v8 offset:41984
v_mfma_f32_16x16x32_bf16 v[208:211], v[72:75], v[96:99], v[208:211]
buffer_load_dwordx4 v1, s[44:47], s72 offen offset:3072 sc1 lds
v_mfma_f32_16x16x32_bf16 v[224:227], v[80:83], v[96:99], v[224:227]
s_add_u32 s81, s81, 0x8000
ds_read_b64_tr_b16 v[72:73], v9 offset:32768
v_mfma_f32_16x16x32_bf16 v[224:227], v[84:87], v[100:103], v[224:227]
s_add_u32 m0, s64, 81920
ds_read_b64_tr_b16 v[74:75], v9 offset:33792
v_mfma_f32_16x16x32_bf16 v[228:231], v[84:87], v[108:111], v[228:231]
s_add_u32 s72, s81, 16384
buffer_load_dwordx4 v1, s[44:47], s72 offen sc1 lds
v_mfma_f32_16x16x32_bf16 v[228:231], v[80:83], v[104:107], v[228:231]
ds_read_b128 v[60:63], v19 offset:38912
v_mfma_f32_16x16x32_bf16 v[232:235], v[80:83], v[112:115], v[232:235]
buffer_load_dwordx4 v1, s[44:47], s72 offen offset:1024 sc1 lds
v_mfma_f32_16x16x32_bf16 v[232:235], v[84:87], v[116:119], v[232:235]
ds_read_b64_tr_b16 v[76:77], v9 offset:40960
v_mfma_f32_16x16x32_bf16 v[236:239], v[84:87], v[124:127], v[236:239]
ds_read_b64_tr_b16 v[78:79], v9 offset:41984
v_mfma_f32_16x16x32_bf16 v[236:239], v[80:83], v[120:123], v[236:239]
v_mfma_f32_16x16x32_bf16 v[252:255], v[88:91], v[120:123], v[252:255]
ds_read_b64_tr_b16 v[80:81], v10 offset:32768
v_mfma_f32_16x16x32_bf16 v[252:255], v[92:95], v[124:127], v[252:255]
buffer_load_dwordx4 v1, s[44:47], s72 offen offset:2048 sc1 lds
v_mfma_f32_16x16x32_bf16 v[248:251], v[92:95], v[116:119], v[248:251]
ds_read_b64_tr_b16 v[82:83], v10 offset:33792
v_mfma_f32_16x16x32_bf16 v[248:251], v[88:91], v[112:115], v[248:251]
v_mfma_f32_16x16x32_bf16 v[244:247], v[88:91], v[104:107], v[244:247]
ds_read_b64_tr_b16 v[84:85], v10 offset:40960
v_mfma_f32_16x16x32_bf16 v[244:247], v[92:95], v[108:111], v[244:247]
buffer_load_dwordx4 v1, s[44:47], s72 offen offset:3072 sc1 lds
v_mfma_f32_16x16x32_bf16 v[240:243], v[92:95], v[100:103], v[240:243]
ds_read_b64_tr_b16 v[86:87], v10 offset:41984
v_mfma_f32_16x16x32_bf16 v[240:243], v[88:91], v[96:99], v[240:243]
s_waitcnt lgkmcnt(6)
v_mfma_f32_16x16x32_bf16 v[128:131], v[64:67], v[32:35], v[128:131]
ds_read_b64_tr_b16 v[88:89], v11 offset:32768
v_mfma_f32_16x16x32_bf16 v[128:131], v[68:71], v[36:39], v[128:131]
ds_read_b64_tr_b16 v[90:91], v11 offset:33792
v_mfma_f32_16x16x32_bf16 v[132:135], v[68:71], v[44:47], v[132:135]
s_add_u32 m0, s64, 65536
v_mfma_f32_16x16x32_bf16 v[132:135], v[64:67], v[40:43], v[132:135]
s_add_u32 s72, s81, 0
buffer_load_dwordx4 v1, s[44:47], s72 offen sc1 lds
v_mfma_f32_16x16x32_bf16 v[136:139], v[64:67], v[48:51], v[136:139]
ds_read_b64_tr_b16 v[92:93], v11 offset:40960
v_mfma_f32_16x16x32_bf16 v[136:139], v[68:71], v[52:55], v[136:139]
ds_read_b64_tr_b16 v[94:95], v11 offset:41984
v_mfma_f32_16x16x32_bf16 v[140:143], v[68:71], v[60:63], v[140:143]
v_mfma_f32_16x16x32_bf16 v[140:143], v[64:67], v[56:59], v[140:143]
s_waitcnt lgkmcnt(8)
buffer_load_dwordx4 v1, s[44:47], s72 offen offset:1024 sc1 lds
v_mfma_f32_16x16x32_bf16 v[156:159], v[72:75], v[56:59], v[156:159]
ds_read_b64_tr_b16 v[64:65], v12 offset:32768
v_mfma_f32_16x16x32_bf16 v[156:159], v[76:79], v[60:63], v[156:159]
ds_read_b64_tr_b16 v[66:67], v12 offset:33792
v_mfma_f32_16x16x32_bf16 v[152:155], v[76:79], v[52:55], v[152:155]
v_mfma_f32_16x16x32_bf16 v[152:155], v[72:75], v[48:51], v[152:155]
buffer_load_dwordx4 v1, s[44:47], s72 offen offset:2048 sc1 lds
v_mfma_f32_16x16x32_bf16 v[148:151], v[72:75], v[40:43], v[148:151]
ds_read_b64_tr_b16 v[68:69], v12 offset:40960
v_mfma_f32_16x16x32_bf16 v[148:151], v[76:79], v[44:47], v[148:151]
v_mfma_f32_16x16x32_bf16 v[144:147], v[76:79], v[36:39], v[144:147]
ds_read_b64_tr_b16 v[70:71], v12 offset:41984
v_mfma_f32_16x16x32_bf16 v[144:147], v[72:75], v[32:35], v[144:147]
s_waitcnt lgkmcnt(8)
v_mfma_f32_16x16x32_bf16 v[160:163], v[80:83], v[32:35], v[160:163]
buffer_load_dwordx4 v1, s[44:47], s72 offen offset:3072 sc1 lds
v_mfma_f32_16x16x32_bf16 v[160:163], v[84:87], v[36:39], v[160:163]
ds_read_b64_tr_b16 v[72:73], v13 offset:32768
v_mfma_f32_16x16x32_bf16 v[164:167], v[84:87], v[44:47], v[164:167]
ds_read_b64_tr_b16 v[74:75], v13 offset:33792
v_mfma_f32_16x16x32_bf16 v[164:167], v[80:83], v[40:43], v[164:167]
v_mfma_f32_16x16x32_bf16 v[168:171], v[80:83], v[48:51], v[168:171]
s_waitcnt vmcnt(16)
ds_read_b64_tr_b16 v[76:77], v13 offset:40960
v_mfma_f32_16x16x32_bf16 v[168:171], v[84:87], v[52:55], v[168:171]
ds_read_b128 v[96:99], v16 offset:0
v_mfma_f32_16x16x32_bf16 v[172:175], v[84:87], v[60:63], v[172:175]
ds_read_b64_tr_b16 v[78:79], v13 offset:41984
v_mfma_f32_16x16x32_bf16 v[172:175], v[80:83], v[56:59], v[172:175]
s_waitcnt lgkmcnt(9)
v_mfma_f32_16x16x32_bf16 v[188:191], v[88:91], v[56:59], v[188:191]
ds_read_b64_tr_b16 v[80:81], v14 offset:32768
v_mfma_f32_16x16x32_bf16 v[188:191], v[92:95], v[60:63], v[188:191]
ds_read_b128 v[100:103], v17 offset:0
v_mfma_f32_16x16x32_bf16 v[184:187], v[92:95], v[52:55], v[184:187]
ds_read_b64_tr_b16 v[82:83], v14 offset:33792
v_mfma_f32_16x16x32_bf16 v[184:187], v[88:91], v[48:51], v[184:187]
v_mfma_f32_16x16x32_bf16 v[180:183], v[88:91], v[40:43], v[180:183]
ds_read_b64_tr_b16 v[84:85], v14 offset:40960
v_mfma_f32_16x16x32_bf16 v[180:183], v[92:95], v[44:47], v[180:183]
ds_read_b128 v[104:107], v16 offset:2048
v_mfma_f32_16x16x32_bf16 v[176:179], v[92:95], v[36:39], v[176:179]
ds_read_b64_tr_b16 v[86:87], v14 offset:41984
v_mfma_f32_16x16x32_bf16 v[176:179], v[88:91], v[32:35], v[176:179]
s_waitcnt lgkmcnt(11)
v_mfma_f32_16x16x32_bf16 v[192:195], v[64:67], v[32:35], v[192:195]
ds_read_b64_tr_b16 v[88:89], v15 offset:32768
v_mfma_f32_16x16x32_bf16 v[192:195], v[68:71], v[36:39], v[192:195]
ds_read_b64_tr_b16 v[90:91], v15 offset:33792
v_mfma_f32_16x16x32_bf16 v[196:199], v[68:71], v[44:47], v[196:199]
ds_read_b128 v[108:111], v17 offset:2048
v_mfma_f32_16x16x32_bf16 v[196:199], v[64:67], v[40:43], v[196:199]
ds_read_b64_tr_b16 v[92:93], v15 offset:40960
v_mfma_f32_16x16x32_bf16 v[200:203], v[64:67], v[48:51], v[200:203]
ds_read_b64_tr_b16 v[94:95], v15 offset:41984
v_mfma_f32_16x16x32_bf16 v[200:203], v[68:71], v[52:55], v[200:203]
v_mfma_f32_16x16x32_bf16 v[204:207], v[68:71], v[60:63], v[204:207]
ds_read_b128 v[112:115], v16 offset:4096
v_mfma_f32_16x16x32_bf16 v[204:207], v[64:67], v[56:59], v[204:207]
s_waitcnt lgkmcnt(12)
v_mfma_f32_16x16x32_bf16 v[220:223], v[72:75], v[56:59], v[220:223]
ds_read_b128 v[116:119], v17 offset:4096
v_mfma_f32_16x16x32_bf16 v[220:223], v[76:79], v[60:63], v[220:223]
v_mfma_f32_16x16x32_bf16 v[216:219], v[76:79], v[52:55], v[216:219]
s_waitcnt vmcnt(12) lgkmcnt(2)
ds_read_b128 v[120:123], v16 offset:6144
v_mfma_f32_16x16x32_bf16 v[216:219], v[72:75], v[48:51], v[216:219]
s_barrier
v_mfma_f32_16x16x32_bf16 v[212:215], v[72:75], v[40:43], v[212:215]
s_add_u32 s81, s81, 0x8000
ds_read_b64_tr_b16 v[64:65], v8 offset:0
ds_read_b64_tr_b16 v[66:67], v8 offset:1024
v_mfma_f32_16x16x32_bf16 v[212:215], v[76:79], v[44:47], v[212:215]
s_add_u32 m0, s64, 114688
ds_read_b64_tr_b16 v[68:69], v8 offset:8192
v_mfma_f32_16x16x32_bf16 v[208:211], v[76:79], v[36:39], v[208:211]
s_add_u32 s72, s81, 16384
buffer_load_dwordx4 v1, s[44:47], s72 offen sc1 lds
v_mfma_f32_16x16x32_bf16 v[208:211], v[72:75], v[32:35], v[208:211]
ds_read_b64_tr_b16 v[70:71], v8 offset:9216
v_mfma_f32_16x16x32_bf16 v[224:227], v[80:83], v[32:35], v[224:227]
buffer_load_dwordx4 v1, s[44:47], s72 offen offset:1024 sc1 lds
v_mfma_f32_16x16x32_bf16 v[224:227], v[84:87], v[36:39], v[224:227]
ds_read_b64_tr_b16 v[72:73], v9 offset:0
v_mfma_f32_16x16x32_bf16 v[228:231], v[84:87], v[44:47], v[228:231]
ds_read_b64_tr_b16 v[74:75], v9 offset:1024
v_mfma_f32_16x16x32_bf16 v[228:231], v[80:83], v[40:43], v[228:231]
ds_read_b128 v[124:127], v17 offset:6144
v_mfma_f32_16x16x32_bf16 v[232:235], v[80:83], v[48:51], v[232:235]
ds_read_b64_tr_b16 v[76:77], v9 offset:8192
v_mfma_f32_16x16x32_bf16 v[232:235], v[84:87], v[52:55], v[232:235]
buffer_store_dwordx4 a[0:3], v1, s[44:47], s80 offen sc1
v_mfma_f32_16x16x32_bf16 v[236:239], v[84:87], v[60:63], v[236:239]
ds_read_b64_tr_b16 v[78:79], v9 offset:9216
v_mfma_f32_16x16x32_bf16 v[236:239], v[80:83], v[56:59], v[236:239]
v_mfma_f32_16x16x32_bf16 v[252:255], v[88:91], v[56:59], v[252:255]
ds_read_b64_tr_b16 v[80:81], v10 offset:0
v_mfma_f32_16x16x32_bf16 v[252:255], v[92:95], v[60:63], v[252:255]
ds_read_b64_tr_b16 v[82:83], v10 offset:1024
v_mfma_f32_16x16x32_bf16 v[248:251], v[92:95], v[52:55], v[248:251]
buffer_load_dwordx4 v1, s[44:47], s72 offen offset:2048 sc1 lds
v_mfma_f32_16x16x32_bf16 v[248:251], v[88:91], v[48:51], v[248:251]
v_mfma_f32_16x16x32_bf16 v[244:247], v[88:91], v[40:43], v[244:247]
ds_read_b64_tr_b16 v[84:85], v10 offset:8192
v_mfma_f32_16x16x32_bf16 v[244:247], v[92:95], v[44:47], v[244:247]
ds_read_b64_tr_b16 v[86:87], v10 offset:9216
v_mfma_f32_16x16x32_bf16 v[240:243], v[92:95], v[36:39], v[240:243]
buffer_load_dwordx4 v1, s[44:47], s72 offen offset:3072 sc1 lds
v_mfma_f32_16x16x32_bf16 v[240:243], v[88:91], v[32:35], v[240:243]
s_waitcnt lgkmcnt(6)
v_mfma_f32_16x16x32_bf16 v[128:131], v[64:67], v[96:99], v[128:131]
ds_read_b64_tr_b16 v[88:89], v11 offset:0
v_mfma_f32_16x16x32_bf16 v[128:131], v[68:71], v[100:103], v[128:131]
ds_read_b64_tr_b16 v[90:91], v11 offset:1024
v_mfma_f32_16x16x32_bf16 v[132:135], v[68:71], v[108:111], v[132:135]
v_mfma_f32_16x16x32_bf16 v[132:135], v[64:67], v[104:107], v[132:135]
buffer_store_dwordx4 a[0:3], v1, s[44:47], s80 offen offset:1024 sc1
v_mfma_f32_16x16x32_bf16 v[136:139], v[64:67], v[112:115], v[136:139]
ds_read_b64_tr_b16 v[92:93], v11 offset:8192
v_mfma_f32_16x16x32_bf16 v[136:139], v[68:71], v[116:119], v[136:139]
v_mfma_f32_16x16x32_bf16 v[140:143], v[68:71], v[124:127], v[140:143]
ds_read_b64_tr_b16 v[94:95], v11 offset:9216
v_mfma_f32_16x16x32_bf16 v[140:143], v[64:67], v[120:123], v[140:143]
s_waitcnt lgkmcnt(8)
v_mfma_f32_16x16x32_bf16 v[156:159], v[72:75], v[120:123], v[156:159]
s_add_u32 m0, s64, 98304
ds_read_b64_tr_b16 v[64:65], v12 offset:0
v_mfma_f32_16x16x32_bf16 v[156:159], v[76:79], v[124:127], v[156:159]
s_add_u32 s72, s81, 0
buffer_load_dwordx4 v1, s[44:47], s72 offen sc1 lds
v_mfma_f32_16x16x32_bf16 v[152:155], v[76:79], v[116:119], v[152:155]
ds_read_b64_tr_b16 v[66:67], v12 offset:1024
v_mfma_f32_16x16x32_bf16 v[152:155], v[72:75], v[112:115], v[152:155]
v_mfma_f32_16x16x32_bf16 v[148:151], v[72:75], v[104:107], v[148:151]
buffer_load_dwordx4 v1, s[44:47], s72 offen offset:1024 sc1 lds
v_mfma_f32_16x16x32_bf16 v[148:151], v[76:79], v[108:111], v[148:151]
ds_read_b64_tr_b16 v[68:69], v12 offset:8192
v_mfma_f32_16x16x32_bf16 v[144:147], v[76:79], v[100:103], v[144:147]
ds_read_b64_tr_b16 v[70:71], v12 offset:9216
v_mfma_f32_16x16x32_bf16 v[144:147], v[72:75], v[96:99], v[144:147]
s_waitcnt lgkmcnt(8)
v_mfma_f32_16x16x32_bf16 v[160:163], v[80:83], v[96:99], v[160:163]
ds_read_b64_tr_b16 v[72:73], v13 offset:0
v_mfma_f32_16x16x32_bf16 v[160:163], v[84:87], v[100:103], v[160:163]
buffer_store_dwordx4 a[0:3], v1, s[44:47], s80 offen offset:2048 sc1
v_mfma_f32_16x16x32_bf16 v[164:167], v[84:87], v[108:111], v[164:167]
ds_read_b64_tr_b16 v[74:75], v13 offset:1024
v_mfma_f32_16x16x32_bf16 v[164:167], v[80:83], v[104:107], v[164:167]
v_mfma_f32_16x16x32_bf16 v[168:171], v[80:83], v[112:115], v[168:171]
ds_read_b64_tr_b16 v[76:77], v13 offset:8192
v_cvt_pk_bf16_f32 v48, v136, v137
v_mfma_f32_16x16x32_bf16 v[168:171], v[84:87], v[116:119], v[168:171]
ds_read_b64_tr_b16 v[78:79], v13 offset:9216
v_cvt_pk_bf16_f32 v49, v138, v139
v_mfma_f32_16x16x32_bf16 v[172:175], v[84:87], v[124:127], v[172:175]
buffer_load_dwordx4 v1, s[44:47], s72 offen offset:2048 sc1 lds
v_mfma_f32_16x16x32_bf16 v[172:175], v[80:83], v[120:123], v[172:175]
s_waitcnt lgkmcnt(8)
v_cvt_pk_bf16_f32 v50, v152, v153
v_cvt_pk_bf16_f32 v51, v154, v155
v_mfma_f32_16x16x32_bf16 v[188:191], v[88:91], v[120:123], v[188:191]
v_add_u32 v2, 0x8000, v1
v_cvt_pk_bf16_f32 v32, v132, v133
v_mfma_f32_16x16x32_bf16 v[188:191], v[92:95], v[124:127], v[188:191]
ds_read_b64_tr_b16 v[80:81], v14 offset:0
v_cvt_pk_bf16_f32 v33, v134, v135
v_mfma_f32_16x16x32_bf16 v[184:187], v[92:95], v[116:119], v[184:187]
buffer_load_dwordx4 v1, s[44:47], s72 offen offset:3072 sc1 lds
v_mfma_f32_16x16x32_bf16 v[184:187], v[88:91], v[112:115], v[184:187]
ds_read_b64_tr_b16 v[82:83], v14 offset:1024
v_cvt_pk_bf16_f32 v34, v148, v149
v_mfma_f32_16x16x32_bf16 v[180:183], v[88:91], v[104:107], v[180:183]
ds_read_b64_tr_b16 v[84:85], v14 offset:8192
v_cvt_pk_bf16_f32 v35, v150, v151
v_mfma_f32_16x16x32_bf16 v[180:183], v[92:95], v[108:111], v[180:183]
ds_read_b64_tr_b16 v[86:87], v14 offset:9216
v_cvt_pk_bf16_f32 v16, v128, v129
v_mfma_f32_16x16x32_bf16 v[176:179], v[92:95], v[100:103], v[176:179]
v_cvt_pk_bf16_f32 v17, v130, v131
v_cvt_pk_bf16_f32 v18, v144, v145
v_mfma_f32_16x16x32_bf16 v[176:179], v[88:91], v[96:99], v[176:179]
s_waitcnt lgkmcnt(8)
buffer_store_dwordx4 a[0:3], v1, s[44:47], s80 offen offset:3072 sc1
v_mfma_f32_16x16x32_bf16 v[192:195], v[64:67], v[96:99], v[192:195]
ds_read_b64_tr_b16 v[88:89], v15 offset:0
v_cvt_pk_bf16_f32 v19, v146, v147
v_mfma_f32_16x16x32_bf16 v[192:195], v[68:71], v[100:103], v[192:195]
ds_read_b64_tr_b16 v[90:91], v15 offset:1024
v_mfma_f32_16x16x32_bf16 v[196:199], v[68:71], v[108:111], v[196:199]
ds_read_b64_tr_b16 v[92:93], v15 offset:8192
v_mfma_f32_16x16x32_bf16 v[196:199], v[64:67], v[104:107], v[196:199]
ds_read_b64_tr_b16 v[94:95], v15 offset:9216
v_mfma_f32_16x16x32_bf16 v[200:203], v[64:67], v[112:115], v[200:203]
v_lshrrev_b32 v3, 1, v0
v_lshlrev_b32 v3, 7, v3
v_mfma_f32_16x16x32_bf16 v[200:203], v[68:71], v[116:119], v[200:203]
buffer_load_dword v4, v3, s[36:39], s93 offen
v_mfma_f32_16x16x32_bf16 v[204:207], v[68:71], v[124:127], v[204:207]
v_cvt_pk_bf16_f32 v52, v168, v169
v_cvt_pk_bf16_f32 v53, v170, v171
v_mfma_f32_16x16x32_bf16 v[204:207], v[64:67], v[120:123], v[204:207]
s_waitcnt lgkmcnt(8)
v_cvt_pk_bf16_f32 v54, v184, v185
v_cvt_pk_bf16_f32 v55, v186, v187
v_mfma_f32_16x16x32_bf16 v[220:223], v[72:75], v[120:123], v[220:223]
v_cvt_pk_bf16_f32 v36, v164, v165
v_cvt_pk_bf16_f32 v37, v166, v167
v_mfma_f32_16x16x32_bf16 v[220:223], v[76:79], v[124:127], v[220:223]
v_cvt_pk_bf16_f32 v38, v180, v181
v_cvt_pk_bf16_f32 v39, v182, v183
v_mfma_f32_16x16x32_bf16 v[216:219], v[76:79], v[116:119], v[216:219]
s_waitcnt vmcnt(21) lgkmcnt(0)
v_cvt_pk_bf16_f32 v20, v160, v161
v_cvt_pk_bf16_f32 v21, v162, v163
v_mfma_f32_16x16x32_bf16 v[216:219], v[72:75], v[112:115], v[216:219]
s_barrier
v_cvt_pk_bf16_f32 v22, v176, v177
v_cvt_pk_bf16_f32 v23, v178, v179
v_mfma_f32_16x16x32_bf16 v[212:215], v[72:75], v[104:107], v[212:215]
ds_read_b128 a[128:131], v2 offset:16384
v_cvt_pk_bf16_f32 v64, v140, v141
v_mfma_f32_16x16x32_bf16 v[212:215], v[76:79], v[108:111], v[212:215]
v_cvt_pk_bf16_f32 v65, v142, v143
v_cvt_pk_bf16_f32 v66, v156, v157
v_mfma_f32_16x16x32_bf16 v[208:211], v[76:79], v[100:103], v[208:211]
ds_read_b128 a[132:135], v2 offset:17408
v_cvt_pk_bf16_f32 v67, v158, v159
v_mfma_f32_16x16x32_bf16 v[208:211], v[72:75], v[96:99], v[208:211]
v_cvt_pk_bf16_f32 v68, v172, v173
v_cvt_pk_bf16_f32 v69, v174, v175
v_mfma_f32_16x16x32_bf16 v[224:227], v[80:83], v[96:99], v[224:227]
ds_read_b128 a[136:139], v2 offset:18432
v_cvt_pk_bf16_f32 v70, v188, v189
v_mfma_f32_16x16x32_bf16 v[224:227], v[84:87], v[100:103], v[224:227]
v_cvt_pk_bf16_f32 v71, v190, v191
v_mfma_f32_16x16x32_bf16 v[228:231], v[84:87], v[108:111], v[228:231]
ds_read_b128 a[140:143], v2 offset:19456
v_mfma_f32_16x16x32_bf16 v[228:231], v[80:83], v[104:107], v[228:231]
v_mfma_f32_16x16x32_bf16 v[232:235], v[80:83], v[112:115], v[232:235]
ds_read_b128 a[144:147], v2 offset:20480
v_cvt_pk_bf16_f32 v72, v204, v205
v_mfma_f32_16x16x32_bf16 v[232:235], v[84:87], v[116:119], v[232:235]
v_cvt_pk_bf16_f32 v73, v206, v207
v_cvt_pk_bf16_f32 v74, v220, v221
v_mfma_f32_16x16x32_bf16 v[236:239], v[84:87], v[124:127], v[236:239]
ds_read_b128 a[148:151], v2 offset:21504
v_cvt_pk_bf16_f32 v75, v222, v223
v_mfma_f32_16x16x32_bf16 v[236:239], v[80:83], v[120:123], v[236:239]
v_cvt_pk_bf16_f32 v56, v200, v201
v_cvt_pk_bf16_f32 v57, v202, v203
v_mfma_f32_16x16x32_bf16 v[252:255], v[88:91], v[120:123], v[252:255]
ds_read_b128 a[152:155], v2 offset:22528
v_cvt_pk_bf16_f32 v58, v216, v217
v_mfma_f32_16x16x32_bf16 v[252:255], v[92:95], v[124:127], v[252:255]
v_cvt_pk_bf16_f32 v59, v218, v219
v_cvt_pk_bf16_f32 v40, v196, v197
v_mfma_f32_16x16x32_bf16 v[248:251], v[92:95], v[116:119], v[248:251]
ds_read_b128 a[156:159], v2 offset:23552
v_cvt_pk_bf16_f32 v41, v198, v199
v_mfma_f32_16x16x32_bf16 v[248:251], v[88:91], v[112:115], v[248:251]
v_cvt_pk_bf16_f32 v42, v212, v213
v_cvt_pk_bf16_f32 v43, v214, v215
v_mfma_f32_16x16x32_bf16 v[244:247], v[88:91], v[104:107], v[244:247]
v_cvt_pk_bf16_f32 v24, v192, v193
v_cvt_pk_bf16_f32 v25, v194, v195
v_mfma_f32_16x16x32_bf16 v[244:247], v[92:95], v[108:111], v[244:247]
v_cvt_pk_bf16_f32 v26, v208, v209
v_cvt_pk_bf16_f32 v27, v210, v211
v_mfma_f32_16x16x32_bf16 v[240:243], v[92:95], v[100:103], v[240:243]
v_mfma_f32_16x16x32_bf16 v[240:243], v[88:91], v[96:99], v[240:243]
v_cvt_pk_bf16_f32 v76, v236, v237
v_cvt_pk_bf16_f32 v77, v238, v239
v_cvt_pk_bf16_f32 v78, v252, v253
v_cvt_pk_bf16_f32 v79, v254, v255
v_cvt_pk_bf16_f32 v60, v232, v233
v_cvt_pk_bf16_f32 v61, v234, v235
v_cvt_pk_bf16_f32 v62, v248, v249
v_cvt_pk_bf16_f32 v63, v250, v251
v_cvt_pk_bf16_f32 v44, v228, v229
v_cvt_pk_bf16_f32 v45, v230, v231
v_cvt_pk_bf16_f32 v46, v244, v245
v_cvt_pk_bf16_f32 v47, v246, v247
v_cvt_pk_bf16_f32 v28, v224, v225
v_cvt_pk_bf16_f32 v29, v226, v227
v_cvt_pk_bf16_f32 v30, v240, v241
v_cvt_pk_bf16_f32 v31, v242, v243
v_mov_b32 v124, 0xff800000
v_mov_b32 v125, 0xff800000
v_mov_b32 v126, 0xff800000
v_mov_b32 v127, 0xff800000
s_lshl_b32 s84, s60, 2
s_add_u32 s84, s84, s58
s_mov_b32 s86, 0
s_add_u32 s61, s65, s60
s_and_b32 s73, s60, 1
s_lshl_b32 s73, s73, 16
s_add_u32 s77, s73, s64
s_xor_b32 s73, s73, 0x10000
s_mov_b32 s92, s73
s_mul_i32 s62, s58, 4608
s_add_u32 s62, s62, 143104
s_add_u32 s73, s73, 49920
s_cmp_eq_u32 s58, 0
s_cselect_b32 s62, s73, s62
Lattn:
s_mov_b32 s82, 0x10000
s_waitcnt lgkmcnt(0)
v_mfma_f32_16x16x32_bf16 v[136:139], a[128:131], v[48:51], 0
ds_read_b128 a[160:163], v2 offset:24576
v_lshrrev_b32 v240, 4, v0
v_mfma_f32_16x16x32_bf16 v[136:139], a[132:135], v[52:55], v[136:139]
ds_read_b128 a[164:167], v2 offset:25600
v_and_b32 v241, 15, v0
v_mfma_f32_16x16x32_bf16 v[136:139], a[136:139], v[56:59], v[136:139]
ds_read_b128 a[168:171], v2 offset:26624
v_lshlrev_b32 v240, 2, v240
v_mfma_f32_16x16x32_bf16 v[136:139], a[140:143], v[60:63], v[136:139]
ds_read_b128 a[172:175], v2 offset:27648
v_sub_u32 v240, v241, v240
v_mfma_f32_16x16x32_bf16 v[140:143], a[140:143], v[76:79], 0
ds_read_b128 a[176:179], v2 offset:28672
v_mov_b32 v112, 0xff800000
v_mfma_f32_16x16x32_bf16 v[140:143], a[136:139], v[72:75], v[140:143]
ds_read_b128 a[180:183], v2 offset:29696
v_mov_b32 v113, 0xff800000
v_mfma_f32_16x16x32_bf16 v[140:143], a[132:135], v[68:71], v[140:143]
ds_read_b128 a[184:187], v2 offset:30720
v_mov_b32 v114, 0xff800000
v_mfma_f32_16x16x32_bf16 v[140:143], a[128:131], v[64:67], v[140:143]
ds_read_b128 a[188:191], v2 offset:31744
v_mov_b32 v115, 0xff800000
v_mfma_f32_16x16x32_bf16 v[156:159], a[144:147], v[64:67], 0
v_cmp_gt_i32 vcc, 0, v240
v_mov_b32 v120, 0x3f803f80
v_mfma_f32_16x16x32_bf16 v[156:159], a[148:151], v[68:71], v[156:159]
v_cndmask_b32 v116, 0, v112, vcc
v_cmp_gt_i32 vcc, 1, v240
v_mfma_f32_16x16x32_bf16 v[156:159], a[152:155], v[72:75], v[156:159]
v_mov_b32 v121, 0x3f803f80
v_cndmask_b32 v117, 0, v112, vcc
v_mfma_f32_16x16x32_bf16 v[156:159], a[156:159], v[76:79], v[156:159]
v_cmp_gt_i32 vcc, 2, v240
v_mov_b32 v122, 0x3f803f80
v_mfma_f32_16x16x32_bf16 v[152:155], a[156:159], v[60:63], 0
v_cndmask_b32 v118, 0, v112, vcc
v_cmp_gt_i32 vcc, 3, v240
v_mfma_f32_16x16x32_bf16 v[152:155], a[152:155], v[56:59], v[152:155]
v_mov_b32 v123, 0x3f803f80
v_cndmask_b32 v119, 0, v112, vcc
v_mfma_f32_16x16x32_bf16 v[152:155], a[148:151], v[52:55], v[152:155]
v_mov_b32 v228, 0
v_mov_b32 v229, 0
v_mfma_f32_16x16x32_bf16 v[152:155], a[144:147], v[48:51], v[152:155]
v_mov_b32 v230, 0
v_mov_b32 v231, 0
s_cmp_eq_u32 s84, 0
s_cbranch_scc1 Lta7
s_cmp_eq_u32 s84, 1
s_cbranch_scc1 Lnt8
v_mfma_f32_16x16x32_bf16 v[128:131], a[128:131], v[16:19], 0
v_mov_b32 v236, 0
v_mov_b32 v237, 0
v_mfma_f32_16x16x32_bf16 v[144:147], a[144:147], v[16:19], 0
v_mov_b32 v238, 0
v_mov_b32 v239, 0
s_branch Ljoin9
Lta7:
v_mfma_f32_16x16x32_bf16 v[128:131], a[128:131], v[16:19], v[116:119]
v_mov_b32 v236, 0
v_mov_b32 v237, 0
v_mfma_f32_16x16x32_bf16 v[144:147], a[144:147], v[16:19], v[112:115]
Lstub0:
s_cbranch_execz Lstub4
v_mov_b32 v238, 0
v_mov_b32 v239, 0
s_branch Ljoin9
Lnt8:
v_mfma_f32_16x16x32_bf16 v[128:131], a[128:131], v[16:19], 0
v_mov_b32 v236, 0
v_mov_b32 v237, 0
v_mfma_f32_16x16x32_bf16 v[144:147], a[144:147], v[16:19], v[116:119]
v_mov_b32 v238, 0
v_mov_b32 v239, 0
Ljoin9:
v_mfma_f32_16x16x32_bf16 v[128:131], a[132:135], v[20:23], v[128:131]
v_mfma_f32_16x16x32_bf16 v[128:131], a[136:139], v[24:27], v[128:131]
v_mfma_f32_16x16x32_bf16 v[128:131], a[140:143], v[28:31], v[128:131]
v_max3_f32 v240, v136, v137, v126
v_max3_f32 v242, v140, v141, v127
v_mfma_f32_16x16x32_bf16 v[132:135], a[140:143], v[44:47], 0
v_max3_f32 v240, v240, v138, v139
v_max3_f32 v242, v242, v142, v143
v_mfma_f32_16x16x32_bf16 v[132:135], a[136:139], v[40:43], v[132:135]
v_max3_f32 v240, v240, v152, v153
v_max3_f32 v242, v242, v156, v157
v_mfma_f32_16x16x32_bf16 v[132:135], a[132:135], v[36:39], v[132:135]
v_max3_f32 v240, v240, v154, v155
v_max3_f32 v242, v242, v158, v159
v_mfma_f32_16x16x32_bf16 v[132:135], a[128:131], v[32:35], v[132:135]
v_mov_b32 v241, v240
v_mov_b32 v243, v242
v_mfma_f32_16x16x32_bf16 v[148:151], a[144:147], v[32:35], 0
v_permlane16_swap_b32 v240, v241
v_permlane16_swap_b32 v242, v243
v_mfma_f32_16x16x32_bf16 v[148:151], a[148:151], v[36:39], v[148:151]
v_max_f32 v240, v240, v241
v_max_f32 v242, v242, v243
v_mfma_f32_16x16x32_bf16 v[148:151], a[152:155], v[40:43], v[148:151]
v_mov_b32 v241, v240
v_mov_b32 v243, v242
v_mfma_f32_16x16x32_bf16 v[148:151], a[156:159], v[44:47], v[148:151]
v_permlane32_swap_b32 v240, v241
v_permlane32_swap_b32 v242, v243
v_mfma_f32_16x16x32_bf16 v[144:147], a[156:159], v[28:31], v[144:147]
v_max_f32 v240, v240, v241
v_max_f32 v242, v242, v243
v_mfma_f32_16x16x32_bf16 v[144:147], a[152:155], v[24:27], v[144:147]
v_mfma_f32_16x16x32_bf16 v[144:147], a[148:151], v[20:23], v[144:147]
v_sub_f32 v88, 0, v240
v_sub_f32 v89, 0, v240
v_pk_add_f32 v[90:91], v[88:89], 0
v_pk_add_f32 v[104:105], v[116:117], v[88:89]
v_pk_add_f32 v[106:107], v[118:119], v[88:89]
v_pk_add_f32 v[136:137], v[136:137], v[88:89]
v_pk_add_f32 v[138:139], v[138:139], v[88:89]
v_pk_add_f32 v[152:153], v[152:153], v[88:89]
v_pk_add_f32 v[154:155], v[154:155], v[88:89]
v_sub_f32 v92, 0, v242
v_sub_f32 v93, 0, v242
v_pk_add_f32 v[94:95], v[92:93], 0
v_pk_add_f32 v[108:109], v[116:117], v[92:93]
v_pk_add_f32 v[110:111], v[118:119], v[92:93]
v_pk_add_f32 v[140:141], v[140:141], v[92:93]
v_pk_add_f32 v[142:143], v[142:143], v[92:93]
v_pk_add_f32 v[156:157], v[156:157], v[92:93]
v_pk_add_f32 v[158:159], v[158:159], v[92:93]
v_max3_f32 v240, v128, v129, v124
v_max3_f32 v242, v132, v133, v125
v_max3_f32 v240, v240, v130, v131
v_max3_f32 v242, v242, v134, v135
v_max3_f32 v240, v240, v144, v145
v_max3_f32 v242, v242, v148, v149
v_max3_f32 v240, v240, v146, v147
v_max3_f32 v242, v242, v150, v151
v_mov_b32 v241, v240
v_mov_b32 v243, v242
s_nop 0
v_permlane16_swap_b32 v240, v241
v_permlane16_swap_b32 v242, v243
v_max_f32 v240, v240, v241
v_max_f32 v242, v242, v243
v_mov_b32 v241, v240
v_mov_b32 v243, v242
s_nop 0
v_permlane32_swap_b32 v240, v241
v_permlane32_swap_b32 v242, v243
v_max_f32 v240, v240, v241
v_max_f32 v242, v242, v243
v_sub_f32 v80, 0, v240
v_sub_f32 v81, 0, v240
v_pk_add_f32 v[82:83], v[80:81], 0
v_pk_add_f32 v[96:97], v[116:117], v[80:81]
v_pk_add_f32 v[98:99], v[118:119], v[80:81]
v_pk_add_f32 v[128:129], v[128:129], v[80:81]
v_pk_add_f32 v[130:131], v[130:131], v[80:81]
v_pk_add_f32 v[144:145], v[144:145], v[80:81]
v_pk_add_f32 v[146:147], v[146:147], v[80:81]
v_sub_f32 v84, 0, v242
v_sub_f32 v85, 0, v242
v_pk_add_f32 v[86:87], v[84:85], 0
v_pk_add_f32 v[100:101], v[116:117], v[84:85]
v_pk_add_f32 v[102:103], v[118:119], v[84:85]
v_pk_add_f32 v[132:133], v[132:133], v[84:85]
v_pk_add_f32 v[134:135], v[134:135], v[84:85]
v_pk_add_f32 v[148:149], v[148:149], v[84:85]
v_pk_add_f32 v[150:151], v[150:151], v[84:85]
v_add_u32 v2, s82, v1
s_waitcnt vmcnt(13) lgkmcnt(0)
s_barrier
s_cmp_eq_u32 s60, 0
s_cbranch_scc1 LP0x
v_mfma_f32_16x16x32_bf16 v[164:167], a[160:163], v[32:35], v[84:87]
s_xor_b32 s74, s82, 0x10000
v_exp_f32 v128, v128
v_mfma_f32_16x16x32_bf16 v[164:167], a[164:167], v[36:39], v[164:167]
s_add_u32 s74, s74, s64
ds_read_b128 a[128:131], v2 offset:16384
ds_read_b128 a[132:135], v2 offset:17408
v_mfma_f32_16x16x32_bf16 v[164:167], a[168:171], v[40:43], v[164:167]
s_add_u32 s81, s81, 0x8000
v_exp_f32 v129, v129
v_mfma_f32_16x16x32_bf16 v[164:167], a[172:175], v[44:47], v[164:167]
s_add_u32 m0, s74, 16384
v_exp_f32 v130, v130
v_mfma_f32_16x16x32_bf16 v[172:175], a[172:175], v[76:79], v[92:95]
s_add_u32 s72, s81, 16384
v_exp_f32 v131, v131
v_mfma_f32_16x16x32_bf16 v[172:175], a[168:171], v[72:75], v[172:175]
v_exp_f32 v144, v144
v_mfma_f32_16x16x32_bf16 v[172:175], a[164:167], v[68:71], v[172:175]
ds_read_b128 a[136:139], v2 offset:18432
ds_read_b128 a[140:143], v2 offset:19456
v_mfma_f32_16x16x32_bf16 v[172:175], a[160:163], v[64:67], v[172:175]
ds_read_b128 a[144:147], v2 offset:20480
ds_read_b128 a[148:151], v2 offset:21504
v_mfma_f32_16x16x32_bf16 v[188:191], a[176:179], v[64:67], v[92:95]
ds_read_b128 a[152:155], v2 offset:22528
ds_read_b128 a[156:159], v2 offset:23552
v_mfma_f32_16x16x32_bf16 v[188:191], a[180:183], v[68:71], v[188:191]
ds_read_b128 a[192:195], v2 offset:0
ds_read_b128 a[196:199], v2 offset:1024
v_mfma_f32_16x16x32_bf16 v[188:191], a[184:187], v[72:75], v[188:191]
ds_read_b128 a[200:203], v2 offset:2048
ds_read_b128 a[204:207], v2 offset:3072
v_mfma_f32_16x16x32_bf16 v[188:191], a[188:191], v[76:79], v[188:191]
ds_read_b128 a[208:211], v2 offset:4096
ds_read_b128 a[212:215], v2 offset:5120
v_mfma_f32_16x16x32_bf16 v[180:183], a[188:191], v[44:47], v[84:87]
ds_read_b128 a[216:219], v2 offset:6144
ds_read_b128 a[220:223], v2 offset:7168
v_mfma_f32_16x16x32_bf16 v[180:183], a[184:187], v[40:43], v[180:183]
v_cvt_pk_bf16_f32 v192, v128, v129
v_cvt_pk_bf16_f32 v193, v130, v131
v_mfma_f32_16x16x32_bf16 v[180:183], a[180:183], v[36:39], v[180:183]
buffer_load_dwordx4 v1, s[44:47], s72 offen sc1 lds
v_mfma_f32_16x16x32_bf16 v[180:183], a[176:179], v[32:35], v[180:183]
v_exp_f32 v145, v145
v_mfma_f32_16x16x32_bf16 v[160:163], a[160:163], v[16:19], v[80:83]
v_exp_f32 v146, v146
v_mfma_f32_16x16x32_bf16 v[160:163], a[164:167], v[20:23], v[160:163]
v_exp_f32 v147, v147
v_mfma_f32_16x16x32_bf16 v[160:163], a[168:171], v[24:27], v[160:163]
v_exp_f32 v136, v136
v_mfma_f32_16x16x32_bf16 v[160:163], a[172:175], v[28:31], v[160:163]
v_cvt_pk_bf16_f32 v194, v144, v145
v_cvt_pk_bf16_f32 v195, v146, v147
v_mfma_f32_16x16x32_bf16 v[168:171], a[172:175], v[60:63], v[88:91]
v_exp_f32 v137, v137
v_mfma_f32_16x16x32_bf16 v[168:171], a[168:171], v[56:59], v[168:171]
v_exp_f32 v138, v138
v_mfma_f32_16x16x32_bf16 v[168:171], a[164:167], v[52:55], v[168:171]
v_exp_f32 v139, v139
v_mfma_f32_16x16x32_bf16 v[168:171], a[160:163], v[48:51], v[168:171]
v_exp_f32 v152, v152
v_mfma_f32_16x16x32_bf16 v[184:187], a[176:179], v[48:51], v[88:91]
v_cvt_pk_bf16_f32 v200, v136, v137
v_cvt_pk_bf16_f32 v201, v138, v139
v_mfma_f32_16x16x32_bf16 v[184:187], a[180:183], v[52:55], v[184:187]
buffer_load_dwordx4 v1, s[44:47], s72 offen offset:1024 sc1 lds
v_mfma_f32_16x16x32_bf16 v[184:187], a[184:187], v[56:59], v[184:187]
v_exp_f32 v153, v153
v_mfma_f32_16x16x32_bf16 v[184:187], a[188:191], v[60:63], v[184:187]
v_exp_f32 v154, v154
v_mfma_f32_16x16x32_bf16 v[176:179], a[188:191], v[28:31], v[80:83]
v_exp_f32 v155, v155
v_mfma_f32_16x16x32_bf16 v[176:179], a[184:187], v[24:27], v[176:179]
buffer_load_dwordx4 v1, s[44:47], s72 offen offset:2048 sc1 lds
v_mfma_f32_16x16x32_bf16 v[176:179], a[180:183], v[20:23], v[176:179]
buffer_load_dwordx4 v1, s[44:47], s72 offen offset:3072 sc1 lds
v_mfma_f32_16x16x32_bf16 v[176:179], a[176:179], v[16:19], v[176:179]
s_waitcnt lgkmcnt(4)
v_exp_f32 v132, v132
v_cvt_pk_bf16_f32 v202, v152, v153
v_cvt_pk_bf16_f32 v203, v154, v155
v_exp_f32 v133, v133
v_exp_f32 v134, v134
v_cvt_pk_bf16_f32 v196, v132, v133
v_exp_f32 v135, v135
v_exp_f32 v148, v148
v_cvt_pk_bf16_f32 v197, v134, v135
v_exp_f32 v149, v149
v_exp_f32 v150, v150
v_cvt_pk_bf16_f32 v198, v148, v149
v_exp_f32 v151, v151
v_exp_f32 v140, v140
v_cvt_pk_bf16_f32 v199, v150, v151
v_exp_f32 v141, v141
v_exp_f32 v142, v142
v_cvt_pk_bf16_f32 v204, v140, v141
v_exp_f32 v143, v143
v_exp_f32 v156, v156
v_cvt_pk_bf16_f32 v205, v142, v143
v_exp_f32 v157, v157
v_exp_f32 v158, v158
v_cvt_pk_bf16_f32 v206, v156, v157
v_exp_f32 v159, v159
s_nop 0
v_cvt_pk_bf16_f32 v207, v158, v159
v_mfma_f32_16x16x32_bf16 v[224:227], v[120:123], v[192:195], 0
s_add_u32 s82, s82, 0x8000
ds_read_b128 a[160:163], v2 offset:24576
ds_read_b128 a[164:167], v2 offset:25600
v_mfma_f32_16x16x32_bf16 v[232:235], v[120:123], v[200:203], 0
s_and_b32 s82, s82, 0x1ffff
v_exp_f32 v164, v164
v_mfma_f32_16x16x32_bf16 a[0:3], a[192:195], v[192:195], 0
s_add_u32 m0, s74, 0
v_exp_f32 v165, v165
v_mfma_f32_16x16x32_bf16 a[64:67], a[192:195], v[200:203], 0
s_add_u32 s72, s81, 0
v_exp_f32 v166, v166
v_mfma_f32_16x16x32_bf16 a[68:71], a[196:199], v[200:203], 0
buffer_load_dwordx4 v1, s[44:47], s72 offen sc1 lds
v_mfma_f32_16x16x32_bf16 a[4:7], a[196:199], v[192:195], 0
v_exp_f32 v167, v167
v_mfma_f32_16x16x32_bf16 a[8:11], a[200:203], v[192:195], 0
ds_read_b128 a[168:171], v2 offset:26624
v_cvt_pk_bf16_f32 v212, v164, v165
v_mfma_f32_16x16x32_bf16 a[72:75], a[200:203], v[200:203], 0
v_exp_f32 v180, v180
v_mfma_f32_16x16x32_bf16 a[76:79], a[204:207], v[200:203], 0
v_exp_f32 v181, v181
v_mfma_f32_16x16x32_bf16 a[12:15], a[204:207], v[192:195], 0
s_waitcnt lgkmcnt(3)
ds_read_b128 a[172:175], v2 offset:27648
v_cvt_pk_bf16_f32 v213, v166, v167
v_mfma_f32_16x16x32_bf16 a[16:19], a[208:211], v[192:195], 0
v_exp_f32 v182, v182
v_mfma_f32_16x16x32_bf16 a[80:83], a[208:211], v[200:203], 0
buffer_load_dwordx4 v1, s[44:47], s72 offen offset:1024 sc1 lds
v_mfma_f32_16x16x32_bf16 a[84:87], a[212:215], v[200:203], 0
v_exp_f32 v183, v183
v_mfma_f32_16x16x32_bf16 a[20:23], a[212:215], v[192:195], 0
ds_read_b128 a[176:179], v2 offset:28672
ds_read_b128 a[180:183], v2 offset:29696
v_mfma_f32_16x16x32_bf16 a[24:27], a[216:219], v[192:195], 0
v_exp_f32 v172, v172
v_mfma_f32_16x16x32_bf16 a[88:91], a[216:219], v[200:203], 0
ds_read_b128 a[184:187], v2 offset:30720
ds_read_b128 a[188:191], v2 offset:31744
v_mfma_f32_16x16x32_bf16 a[92:95], a[220:223], v[200:203], 0
ds_read_b128 a[224:227], v2 offset:8192
ds_read_b128 a[228:231], v2 offset:9216
v_mfma_f32_16x16x32_bf16 a[28:31], a[220:223], v[192:195], 0
ds_read_b128 a[232:235], v2 offset:10240
ds_read_b128 a[236:239], v2 offset:11264
v_mfma_f32_16x16x32_bf16 v[128:131], a[128:131], v[16:19], v[80:83]
ds_read_b128 a[240:243], v2 offset:12288
ds_read_b128 a[244:247], v2 offset:13312
v_mfma_f32_16x16x32_bf16 v[128:131], a[132:135], v[20:23], v[128:131]
ds_read_b128 a[248:251], v2 offset:14336
ds_read_b128 a[252:255], v2 offset:15360
v_mfma_f32_16x16x32_bf16 v[128:131], a[136:139], v[24:27], v[128:131]
v_cvt_pk_bf16_f32 v214, v180, v181
v_cvt_pk_bf16_f32 v215, v182, v183
v_mfma_f32_16x16x32_bf16 v[128:131], a[140:143], v[28:31], v[128:131]
v_exp_f32 v173, v173
v_mfma_f32_16x16x32_bf16 v[136:139], a[140:143], v[60:63], v[88:91]
v_exp_f32 v174, v174
v_mfma_f32_16x16x32_bf16 v[136:139], a[136:139], v[56:59], v[136:139]
buffer_load_dwordx4 v1, s[44:47], s72 offen offset:2048 sc1 lds
v_mfma_f32_16x16x32_bf16 v[136:139], a[132:135], v[52:55], v[136:139]
v_exp_f32 v175, v175
v_mfma_f32_16x16x32_bf16 v[136:139], a[128:131], v[48:51], v[136:139]
v_exp_f32 v188, v188
v_mfma_f32_16x16x32_bf16 v[152:155], a[144:147], v[48:51], v[88:91]
v_cvt_pk_bf16_f32 v220, v172, v173
v_cvt_pk_bf16_f32 v221, v174, v175
v_mfma_f32_16x16x32_bf16 v[152:155], a[148:151], v[52:55], v[152:155]
v_exp_f32 v189, v189
v_mfma_f32_16x16x32_bf16 v[152:155], a[152:155], v[56:59], v[152:155]
v_exp_f32 v190, v190
v_mfma_f32_16x16x32_bf16 v[152:155], a[156:159], v[60:63], v[152:155]
buffer_load_dwordx4 v1, s[44:47], s72 offen offset:3072 sc1 lds
v_mfma_f32_16x16x32_bf16 v[144:147], a[156:159], v[28:31], v[80:83]
s_add_u32 s66, s58, 1
v_exp_f32 v191, v191
v_mfma_f32_16x16x32_bf16 v[144:147], a[152:155], v[24:27], v[144:147]
s_and_b32 s66, s66, 3
v_exp_f32 v160, v160
v_mfma_f32_16x16x32_bf16 v[144:147], a[148:151], v[20:23], v[144:147]
s_mul_i32 s66, s66, 4160
v_cvt_pk_bf16_f32 v222, v188, v189
v_cvt_pk_bf16_f32 v223, v190, v191
v_mfma_f32_16x16x32_bf16 v[144:147], a[144:147], v[16:19], v[144:147]
s_add_u32 m0, s66, 131104
v_exp_f32 v161, v161
v_mfma_f32_16x16x32_bf16 v[132:135], a[128:131], v[32:35], v[84:87]
s_add_u32 s72, s93, 0x2
buffer_load_dwordx4 v1, s[36:39], s72 offen lds
v_mfma_f32_16x16x32_bf16 v[132:135], a[132:135], v[36:39], v[132:135]
v_exp_f32 v162, v162
v_mfma_f32_16x16x32_bf16 v[132:135], a[136:139], v[40:43], v[132:135]
v_exp_f32 v163, v163
v_mfma_f32_16x16x32_bf16 v[132:135], a[140:143], v[44:47], v[132:135]
v_exp_f32 v176, v176
v_mfma_f32_16x16x32_bf16 v[140:143], a[140:143], v[76:79], v[92:95]
v_cvt_pk_bf16_f32 v208, v160, v161
v_cvt_pk_bf16_f32 v209, v162, v163
v_mfma_f32_16x16x32_bf16 v[140:143], a[136:139], v[72:75], v[140:143]
v_exp_f32 v177, v177
v_mfma_f32_16x16x32_bf16 v[140:143], a[132:135], v[68:71], v[140:143]
buffer_load_dwordx4 v1, s[36:39], s72 offen offset:1024 lds
v_mfma_f32_16x16x32_bf16 v[140:143], a[128:131], v[64:67], v[140:143]
v_exp_f32 v178, v178
v_mfma_f32_16x16x32_bf16 v[156:159], a[144:147], v[64:67], v[92:95]
v_exp_f32 v179, v179
v_mfma_f32_16x16x32_bf16 v[156:159], a[148:151], v[68:71], v[156:159]
v_exp_f32 v168, v168
v_mfma_f32_16x16x32_bf16 v[156:159], a[152:155], v[72:75], v[156:159]
v_cvt_pk_bf16_f32 v210, v176, v177
v_cvt_pk_bf16_f32 v211, v178, v179
v_mfma_f32_16x16x32_bf16 v[156:159], a[156:159], v[76:79], v[156:159]
v_exp_f32 v169, v169
v_mfma_f32_16x16x32_bf16 v[148:151], a[156:159], v[44:47], v[84:87]
buffer_load_dwordx4 v1, s[36:39], s72 offen offset:2048 lds
v_mfma_f32_16x16x32_bf16 v[148:151], a[152:155], v[40:43], v[148:151]
buffer_load_dwordx4 v1, s[36:39], s72 offen offset:3072 lds
v_mfma_f32_16x16x32_bf16 v[148:151], a[148:151], v[36:39], v[148:151]
s_waitcnt vmcnt(12) lgkmcnt(4)
v_exp_f32 v170, v170
v_mfma_f32_16x16x32_bf16 v[148:151], a[144:147], v[32:35], v[148:151]
s_barrier
v_exp_f32 v171, v171
v_add_u32 v2, s82, v1
v_cvt_pk_bf16_f32 v216, v168, v169
v_exp_f32 v184, v184
v_cvt_pk_bf16_f32 v217, v170, v171
v_exp_f32 v185, v185
v_exp_f32 v186, v186
v_cvt_pk_bf16_f32 v218, v184, v185
v_exp_f32 v187, v187
s_nop 0
v_cvt_pk_bf16_f32 v219, v186, v187
s_lshl_b32 s75, s59, 4
s_and_b32 s76, s84, 15
s_add_u32 s75, s75, s76
s_lshl_b32 s75, s75, 14
s_cmp_ge_u32 s60, 4
s_cselect_b32 s75, s75, 0x40001000
s_lshl_b32 s83, s60, 1
s_sub_u32 s83, 2, s83
s_cmp_eq_u32 s83, 0
s_cbranch_scc1 LLT1
.p2align 5
s_nop 0
s_nop 0
LloopI:
v_mfma_f32_16x16x32_bf16 v[228:231], v[120:123], v[196:199], v[228:231]
s_xor_b32 s74, s82, 0x10000
v_exp_f32 v128, v128
v_mfma_f32_16x16x32_bf16 v[228:231], v[120:123], v[212:215], v[228:231]
s_add_u32 s74, s74, s64
ds_read_b128 a[128:131], v2 offset:16384
v_mfma_f32_16x16x32_bf16 v[236:239], v[120:123], v[204:207], v[236:239]
s_add_u32 s81, s81, 0x8000
v_exp_f32 v129, v129
v_mfma_f32_16x16x32_bf16 v[236:239], v[120:123], v[220:223], v[236:239]
s_add_u32 m0, s74, 16384
v_exp_f32 v130, v130
v_mfma_f32_16x16x32_bf16 a[32:35], a[192:195], v[196:199], a[32:35]
s_add_u32 s72, s81, 16384
ds_read_b128 a[132:135], v2 offset:17408
v_cvt_pk_bf16_f32 v192, v128, v129
v_mfma_f32_16x16x32_bf16 a[32:35], a[224:227], v[212:215], a[32:35]
v_exp_f32 v131, v131
v_mfma_f32_16x16x32_bf16 a[96:99], a[224:227], v[220:223], a[96:99]
v_exp_f32 v144, v144
v_mfma_f32_16x16x32_bf16 a[96:99], a[192:195], v[204:207], a[96:99]
ds_read_b128 a[136:139], v2 offset:18432
v_cvt_pk_bf16_f32 v193, v130, v131
v_mfma_f32_16x16x32_bf16 a[100:103], a[196:199], v[204:207], a[100:103]
buffer_load_dwordx4 v1, s[44:47], s72 offen sc1 lds
v_mfma_f32_16x16x32_bf16 a[100:103], a[228:231], v[220:223], a[100:103]
v_exp_f32 v145, v145
v_mfma_f32_16x16x32_bf16 a[36:39], a[228:231], v[212:215], a[36:39]
v_exp_f32 v146, v146
v_mfma_f32_16x16x32_bf16 a[36:39], a[196:199], v[196:199], a[36:39]
ds_read_b128 a[140:143], v2 offset:19456
v_cvt_pk_bf16_f32 v194, v144, v145
v_mfma_f32_16x16x32_bf16 a[40:43], a[200:203], v[196:199], a[40:43]
v_exp_f32 v147, v147
v_mfma_f32_16x16x32_bf16 a[40:43], a[232:235], v[212:215], a[40:43]
v_exp_f32 v136, v136
v_mfma_f32_16x16x32_bf16 a[104:107], a[232:235], v[220:223], a[104:107]
ds_read_b128 a[144:147], v2 offset:20480
v_cvt_pk_bf16_f32 v195, v146, v147
v_mfma_f32_16x16x32_bf16 a[104:107], a[200:203], v[204:207], a[104:107]
v_exp_f32 v137, v137
v_mfma_f32_16x16x32_bf16 a[108:111], a[204:207], v[204:207], a[108:111]
v_exp_f32 v138, v138
v_mfma_f32_16x16x32_bf16 a[108:111], a[236:239], v[220:223], a[108:111]
ds_read_b128 a[148:151], v2 offset:21504
v_cvt_pk_bf16_f32 v200, v136, v137
v_mfma_f32_16x16x32_bf16 a[44:47], a[236:239], v[212:215], a[44:47]
v_exp_f32 v139, v139
v_mfma_f32_16x16x32_bf16 a[44:47], a[204:207], v[196:199], a[44:47]
v_exp_f32 v152, v152
v_mfma_f32_16x16x32_bf16 a[48:51], a[208:211], v[196:199], a[48:51]
s_waitcnt lgkmcnt(6)
ds_read_b128 a[152:155], v2 offset:22528
v_cvt_pk_bf16_f32 v201, v138, v139
v_mfma_f32_16x16x32_bf16 a[48:51], a[240:243], v[212:215], a[48:51]
buffer_load_dwordx4 v1, s[44:47], s72 offen offset:1024 sc1 lds
v_mfma_f32_16x16x32_bf16 a[112:115], a[240:243], v[220:223], a[112:115]
v_exp_f32 v153, v153
v_mfma_f32_16x16x32_bf16 a[112:115], a[208:211], v[204:207], a[112:115]
v_exp_f32 v154, v154
v_mfma_f32_16x16x32_bf16 a[116:119], a[212:215], v[204:207], a[116:119]
ds_read_b128 a[156:159], v2 offset:23552
v_cvt_pk_bf16_f32 v202, v152, v153
v_mfma_f32_16x16x32_bf16 a[116:119], a[244:247], v[220:223], a[116:119]
v_exp_f32 v155, v155
v_mfma_f32_16x16x32_bf16 a[52:55], a[244:247], v[212:215], a[52:55]
v_exp_f32 v132, v132
v_mfma_f32_16x16x32_bf16 a[52:55], a[212:215], v[196:199], a[52:55]
ds_read_b128 a[192:195], v2 offset:0
v_cvt_pk_bf16_f32 v203, v154, v155
v_mfma_f32_16x16x32_bf16 a[56:59], a[216:219], v[196:199], a[56:59]
v_exp_f32 v133, v133
v_mfma_f32_16x16x32_bf16 a[56:59], a[248:251], v[212:215], a[56:59]
v_exp_f32 v134, v134
v_mfma_f32_16x16x32_bf16 a[120:123], a[248:251], v[220:223], a[120:123]
ds_read_b128 a[196:199], v2 offset:1024
v_add_u32 v15, s75, v3
v_mfma_f32_16x16x32_bf16 a[120:123], a[216:219], v[204:207], a[120:123]
v_exp_f32 v135, v135
v_mfma_f32_16x16x32_bf16 a[124:127], a[220:223], v[204:207], a[124:127]
v_exp_f32 v148, v148
v_mfma_f32_16x16x32_bf16 a[124:127], a[252:255], v[220:223], a[124:127]
ds_read_b128 a[200:203], v2 offset:2048
v_mfma_f32_16x16x32_bf16 a[60:63], a[252:255], v[212:215], a[60:63]
buffer_load_dwordx4 v1, s[44:47], s72 offen offset:2048 sc1 lds
v_mfma_f32_16x16x32_bf16 a[60:63], a[220:223], v[196:199], a[60:63]
ds_read_b128 a[204:207], v2 offset:3072
v_cvt_pk_bf16_f32 v196, v132, v133
v_mfma_f32_16x16x32_bf16 v[164:167], a[160:163], v[32:35], v[84:87]
v_exp_f32 v149, v149
v_mfma_f32_16x16x32_bf16 v[164:167], a[164:167], v[36:39], v[164:167]
v_exp_f32 v150, v150
v_mfma_f32_16x16x32_bf16 v[164:167], a[168:171], v[40:43], v[164:167]
ds_read_b128 a[208:211], v2 offset:4096
v_cvt_pk_bf16_f32 v197, v134, v135
v_mfma_f32_16x16x32_bf16 v[164:167], a[172:175], v[44:47], v[164:167]
v_exp_f32 v151, v151
v_mfma_f32_16x16x32_bf16 v[172:175], a[172:175], v[76:79], v[92:95]
v_exp_f32 v140, v140
v_mfma_f32_16x16x32_bf16 v[172:175], a[168:171], v[72:75], v[172:175]
ds_read_b128 a[212:215], v2 offset:5120
v_cvt_pk_bf16_f32 v198, v148, v149
v_mfma_f32_16x16x32_bf16 v[172:175], a[164:167], v[68:71], v[172:175]
v_exp_f32 v141, v141
v_mfma_f32_16x16x32_bf16 v[172:175], a[160:163], v[64:67], v[172:175]
v_exp_f32 v142, v142
v_mfma_f32_16x16x32_bf16 v[188:191], a[176:179], v[64:67], v[92:95]
ds_read_b128 a[216:219], v2 offset:6144
v_cvt_pk_bf16_f32 v199, v150, v151
v_mfma_f32_16x16x32_bf16 v[188:191], a[180:183], v[68:71], v[188:191]
v_exp_f32 v143, v143
v_mfma_f32_16x16x32_bf16 v[188:191], a[184:187], v[72:75], v[188:191]
v_exp_f32 v156, v156
v_mfma_f32_16x16x32_bf16 v[188:191], a[188:191], v[76:79], v[188:191]
ds_read_b128 a[220:223], v2 offset:7168
v_cvt_pk_bf16_f32 v204, v140, v141
v_mfma_f32_16x16x32_bf16 v[180:183], a[188:191], v[44:47], v[84:87]
buffer_load_dwordx4 v1, s[44:47], s72 offen offset:3072 sc1 lds
v_mfma_f32_16x16x32_bf16 v[180:183], a[184:187], v[40:43], v[180:183]
v_exp_f32 v157, v157
v_mfma_f32_16x16x32_bf16 v[180:183], a[180:183], v[36:39], v[180:183]
v_exp_f32 v158, v158
v_mfma_f32_16x16x32_bf16 v[180:183], a[176:179], v[32:35], v[180:183]
v_cvt_pk_bf16_f32 v205, v142, v143
v_cvt_pk_bf16_f32 v206, v156, v157
v_mfma_f32_16x16x32_bf16 v[160:163], a[160:163], v[16:19], v[80:83]
v_exp_f32 v159, v159
v_mfma_f32_16x16x32_bf16 v[160:163], a[164:167], v[20:23], v[160:163]
v_cvt_pk_bf16_f32 v207, v158, v159
v_mfma_f32_16x16x32_bf16 v[160:163], a[168:171], v[24:27], v[160:163]
v_mfma_f32_16x16x32_bf16 v[160:163], a[172:175], v[28:31], v[160:163]
v_mfma_f32_16x16x32_bf16 v[168:171], a[172:175], v[60:63], v[88:91]
v_mfma_f32_16x16x32_bf16 v[168:171], a[168:171], v[56:59], v[168:171]
v_mfma_f32_16x16x32_bf16 v[168:171], a[164:167], v[52:55], v[168:171]
v_mfma_f32_16x16x32_bf16 v[168:171], a[160:163], v[48:51], v[168:171]
v_mfma_f32_16x16x32_bf16 v[184:187], a[176:179], v[48:51], v[88:91]
v_mfma_f32_16x16x32_bf16 v[184:187], a[180:183], v[52:55], v[184:187]
v_mfma_f32_16x16x32_bf16 v[184:187], a[184:187], v[56:59], v[184:187]
v_mfma_f32_16x16x32_bf16 v[184:187], a[188:191], v[60:63], v[184:187]
v_mfma_f32_16x16x32_bf16 v[176:179], a[188:191], v[28:31], v[80:83]
v_mfma_f32_16x16x32_bf16 v[176:179], a[184:187], v[24:27], v[176:179]
v_mfma_f32_16x16x32_bf16 v[176:179], a[180:183], v[20:23], v[176:179]
v_mfma_f32_16x16x32_bf16 v[176:179], a[176:179], v[16:19], v[176:179]
s_waitcnt lgkmcnt(4)
v_mfma_f32_16x16x32_bf16 v[224:227], v[120:123], v[208:211], v[224:227]
s_add_u32 s82, s82, 0x8000
ds_read_b128 a[160:163], v2 offset:24576
v_mfma_f32_16x16x32_bf16 v[224:227], v[120:123], v[192:195], v[224:227]
s_and_b32 s82, s82, 0x1ffff
v_exp_f32 v164, v164
v_mfma_f32_16x16x32_bf16 v[232:235], v[120:123], v[216:219], v[232:235]
s_add_u32 m0, s74, 0
v_exp_f32 v165, v165
v_mfma_f32_16x16x32_bf16 v[232:235], v[120:123], v[200:203], v[232:235]
s_add_u32 s72, s81, 0
ds_read_b128 a[164:167], v2 offset:25600
v_cvt_pk_bf16_f32 v212, v164, v165
v_mfma_f32_16x16x32_bf16 a[0:3], a[224:227], v[208:211], a[0:3]
v_exp_f32 v166, v166
v_mfma_f32_16x16x32_bf16 a[0:3], a[192:195], v[192:195], a[0:3]
v_exp_f32 v167, v167
v_mfma_f32_16x16x32_bf16 a[64:67], a[192:195], v[200:203], a[64:67]
buffer_load_dwordx4 v1, s[44:47], s72 offen sc1 lds
v_mfma_f32_16x16x32_bf16 a[64:67], a[224:227], v[216:219], a[64:67]
ds_read_b128 a[168:171], v2 offset:26624
v_cvt_pk_bf16_f32 v213, v166, v167
v_mfma_f32_16x16x32_bf16 a[68:71], a[228:231], v[216:219], a[68:71]
v_exp_f32 v180, v180
v_mfma_f32_16x16x32_bf16 a[68:71], a[196:199], v[200:203], a[68:71]
v_exp_f32 v181, v181
v_mfma_f32_16x16x32_bf16 a[4:7], a[196:199], v[192:195], a[4:7]
ds_read_b128 a[172:175], v2 offset:27648
v_cvt_pk_bf16_f32 v214, v180, v181
v_mfma_f32_16x16x32_bf16 a[4:7], a[228:231], v[208:211], a[4:7]
v_exp_f32 v182, v182
v_mfma_f32_16x16x32_bf16 a[8:11], a[232:235], v[208:211], a[8:11]
v_exp_f32 v183, v183
v_mfma_f32_16x16x32_bf16 a[8:11], a[200:203], v[192:195], a[8:11]
ds_read_b128 a[176:179], v2 offset:28672
v_cvt_pk_bf16_f32 v215, v182, v183
v_mfma_f32_16x16x32_bf16 a[72:75], a[200:203], v[200:203], a[72:75]
v_exp_f32 v172, v172
v_mfma_f32_16x16x32_bf16 a[72:75], a[232:235], v[216:219], a[72:75]
v_exp_f32 v173, v173
v_mfma_f32_16x16x32_bf16 a[76:79], a[236:239], v[216:219], a[76:79]
ds_read_b128 a[180:183], v2 offset:29696
v_cvt_pk_bf16_f32 v220, v172, v173
v_mfma_f32_16x16x32_bf16 a[76:79], a[204:207], v[200:203], a[76:79]
buffer_load_dwordx4 v1, s[44:47], s72 offen offset:1024 sc1 lds
v_mfma_f32_16x16x32_bf16 a[12:15], a[204:207], v[192:195], a[12:15]
v_exp_f32 v174, v174
v_mfma_f32_16x16x32_bf16 a[12:15], a[236:239], v[208:211], a[12:15]
v_exp_f32 v175, v175
v_mfma_f32_16x16x32_bf16 a[16:19], a[240:243], v[208:211], a[16:19]
s_waitcnt lgkmcnt(6)
ds_read_b128 a[184:187], v2 offset:30720
v_cvt_pk_bf16_f32 v221, v174, v175
v_mfma_f32_16x16x32_bf16 a[16:19], a[208:211], v[192:195], a[16:19]
v_exp_f32 v188, v188
v_mfma_f32_16x16x32_bf16 a[80:83], a[208:211], v[200:203], a[80:83]
v_exp_f32 v189, v189
v_mfma_f32_16x16x32_bf16 a[80:83], a[240:243], v[216:219], a[80:83]
ds_read_b128 a[188:191], v2 offset:31744
v_cvt_pk_bf16_f32 v222, v188, v189
v_mfma_f32_16x16x32_bf16 a[84:87], a[244:247], v[216:219], a[84:87]
v_exp_f32 v190, v190
v_mfma_f32_16x16x32_bf16 a[84:87], a[212:215], v[200:203], a[84:87]
v_exp_f32 v191, v191
v_mfma_f32_16x16x32_bf16 a[20:23], a[212:215], v[192:195], a[20:23]
ds_read_b128 a[224:227], v2 offset:8192
v_cvt_pk_bf16_f32 v223, v190, v191
v_mfma_f32_16x16x32_bf16 a[20:23], a[244:247], v[208:211], a[20:23]
v_exp_f32 v160, v160
v_mfma_f32_16x16x32_bf16 a[24:27], a[248:251], v[208:211], a[24:27]
buffer_load_dwordx4 v1, s[44:47], s72 offen offset:2048 sc1 lds
v_mfma_f32_16x16x32_bf16 a[24:27], a[216:219], v[192:195], a[24:27]
v_exp_f32 v161, v161
v_mfma_f32_16x16x32_bf16 a[88:91], a[216:219], v[200:203], a[88:91]
ds_read_b128 a[228:231], v2 offset:9216
v_mfma_f32_16x16x32_bf16 a[88:91], a[248:251], v[216:219], a[88:91]
v_exp_f32 v162, v162
v_mfma_f32_16x16x32_bf16 a[92:95], a[252:255], v[216:219], a[92:95]
v_exp_f32 v163, v163
v_mfma_f32_16x16x32_bf16 a[92:95], a[220:223], v[200:203], a[92:95]
ds_read_b128 a[232:235], v2 offset:10240
v_mfma_f32_16x16x32_bf16 a[28:31], a[220:223], v[192:195], a[28:31]
v_exp_f32 v176, v176
v_mfma_f32_16x16x32_bf16 a[28:31], a[252:255], v[208:211], a[28:31]
ds_read_b128 a[236:239], v2 offset:11264
v_cvt_pk_bf16_f32 v208, v160, v161
v_mfma_f32_16x16x32_bf16 v[128:131], a[128:131], v[16:19], v[80:83]
v_exp_f32 v177, v177
v_mfma_f32_16x16x32_bf16 v[128:131], a[132:135], v[20:23], v[128:131]
v_exp_f32 v178, v178
v_mfma_f32_16x16x32_bf16 v[128:131], a[136:139], v[24:27], v[128:131]
ds_read_b128 a[240:243], v2 offset:12288
v_cvt_pk_bf16_f32 v209, v162, v163
v_mfma_f32_16x16x32_bf16 v[128:131], a[140:143], v[28:31], v[128:131]
buffer_load_dwordx4 v1, s[44:47], s72 offen offset:3072 sc1 lds
v_mfma_f32_16x16x32_bf16 v[136:139], a[140:143], v[60:63], v[88:91]
s_add_u32 s75, s75, 0x1000
v_exp_f32 v179, v179
v_mfma_f32_16x16x32_bf16 v[136:139], a[136:139], v[56:59], v[136:139]
s_and_b32 s76, s75, 0x3000
v_exp_f32 v168, v168
v_mfma_f32_16x16x32_bf16 v[136:139], a[132:135], v[52:55], v[136:139]
s_cselect_b32 s75, s75, 0x40001000
ds_read_b128 a[244:247], v2 offset:13312
v_cvt_pk_bf16_f32 v210, v176, v177
v_mfma_f32_16x16x32_bf16 v[136:139], a[128:131], v[48:51], v[136:139]
Lstub1:
s_cbranch_execz Lstub5
v_exp_f32 v169, v169
v_mfma_f32_16x16x32_bf16 v[152:155], a[144:147], v[48:51], v[88:91]
v_exp_f32 v170, v170
v_mfma_f32_16x16x32_bf16 v[152:155], a[148:151], v[52:55], v[152:155]
ds_read_b128 a[248:251], v2 offset:14336
v_cvt_pk_bf16_f32 v211, v178, v179
v_mfma_f32_16x16x32_bf16 v[152:155], a[152:155], v[56:59], v[152:155]
v_exp_f32 v171, v171
v_mfma_f32_16x16x32_bf16 v[152:155], a[156:159], v[60:63], v[152:155]
v_exp_f32 v184, v184
v_mfma_f32_16x16x32_bf16 v[144:147], a[156:159], v[28:31], v[80:83]
ds_read_b128 a[252:255], v2 offset:15360
v_cvt_pk_bf16_f32 v216, v168, v169
v_mfma_f32_16x16x32_bf16 v[144:147], a[152:155], v[24:27], v[144:147]
buffer_load_dword v4, v15, s[24:27], 0 offen
v_mfma_f32_16x16x32_bf16 v[144:147], a[148:151], v[20:23], v[144:147]
v_exp_f32 v185, v185
v_mfma_f32_16x16x32_bf16 v[144:147], a[144:147], v[16:19], v[144:147]
v_exp_f32 v186, v186
v_mfma_f32_16x16x32_bf16 v[132:135], a[128:131], v[32:35], v[84:87]
v_cvt_pk_bf16_f32 v217, v170, v171
v_cvt_pk_bf16_f32 v218, v184, v185
v_mfma_f32_16x16x32_bf16 v[132:135], a[132:135], v[36:39], v[132:135]
v_exp_f32 v187, v187
v_mfma_f32_16x16x32_bf16 v[132:135], a[136:139], v[40:43], v[132:135]
v_cvt_pk_bf16_f32 v219, v186, v187
v_add_u32 v2, s82, v1
v_mfma_f32_16x16x32_bf16 v[132:135], a[140:143], v[44:47], v[132:135]
v_mfma_f32_16x16x32_bf16 v[140:143], a[140:143], v[76:79], v[92:95]
v_mfma_f32_16x16x32_bf16 v[140:143], a[136:139], v[72:75], v[140:143]
v_mfma_f32_16x16x32_bf16 v[140:143], a[132:135], v[68:71], v[140:143]
v_mfma_f32_16x16x32_bf16 v[140:143], a[128:131], v[64:67], v[140:143]
v_mfma_f32_16x16x32_bf16 v[156:159], a[144:147], v[64:67], v[92:95]
v_mfma_f32_16x16x32_bf16 v[156:159], a[148:151], v[68:71], v[156:159]
v_mfma_f32_16x16x32_bf16 v[156:159], a[152:155], v[72:75], v[156:159]
v_mfma_f32_16x16x32_bf16 v[156:159], a[156:159], v[76:79], v[156:159]
v_mfma_f32_16x16x32_bf16 v[148:151], a[156:159], v[44:47], v[84:87]
s_waitcnt vmcnt(9) lgkmcnt(4)
v_mfma_f32_16x16x32_bf16 v[148:151], a[152:155], v[40:43], v[148:151]
s_barrier
v_mfma_f32_16x16x32_bf16 v[148:151], a[148:151], v[36:39], v[148:151]
s_add_u32 s83, s83, 1
v_mfma_f32_16x16x32_bf16 v[148:151], a[144:147], v[32:35], v[148:151]
s_cbranch_scc0 LloopI
LLT1:
Lstub2:
s_cbranch_execz Lstub6
v_mfma_f32_16x16x32_bf16 v[228:231], v[120:123], v[196:199], v[228:231]
s_xor_b32 s74, s82, 0x10000
v_exp_f32 v128, v128
v_mfma_f32_16x16x32_bf16 v[228:231], v[120:123], v[212:215], v[228:231]
s_add_u32 s74, s74, s64
ds_read_b128 a[128:131], v2 offset:16384
v_mfma_f32_16x16x32_bf16 v[236:239], v[120:123], v[204:207], v[236:239]
s_add_u32 s81, s81, 0x8000
v_exp_f32 v129, v129
v_mfma_f32_16x16x32_bf16 v[236:239], v[120:123], v[220:223], v[236:239]
s_add_u32 m0, s74, 16384
v_exp_f32 v130, v130
v_mfma_f32_16x16x32_bf16 a[32:35], a[192:195], v[196:199], a[32:35]
s_add_u32 s72, s81, 16384
ds_read_b128 a[132:135], v2 offset:17408
v_cvt_pk_bf16_f32 v192, v128, v129
v_mfma_f32_16x16x32_bf16 a[32:35], a[224:227], v[212:215], a[32:35]
v_exp_f32 v131, v131
v_mfma_f32_16x16x32_bf16 a[96:99], a[224:227], v[220:223], a[96:99]
v_exp_f32 v144, v144
v_mfma_f32_16x16x32_bf16 a[96:99], a[192:195], v[204:207], a[96:99]
ds_read_b128 a[136:139], v2 offset:18432
v_cvt_pk_bf16_f32 v193, v130, v131
v_mfma_f32_16x16x32_bf16 a[100:103], a[196:199], v[204:207], a[100:103]
buffer_load_dwordx4 v1, s[44:47], s72 offen sc1 lds
v_mfma_f32_16x16x32_bf16 a[100:103], a[228:231], v[220:223], a[100:103]
v_exp_f32 v145, v145
v_mfma_f32_16x16x32_bf16 a[36:39], a[228:231], v[212:215], a[36:39]
v_exp_f32 v146, v146
v_mfma_f32_16x16x32_bf16 a[36:39], a[196:199], v[196:199], a[36:39]
ds_read_b128 a[140:143], v2 offset:19456
v_cvt_pk_bf16_f32 v194, v144, v145
v_mfma_f32_16x16x32_bf16 a[40:43], a[200:203], v[196:199], a[40:43]
v_exp_f32 v147, v147
v_mfma_f32_16x16x32_bf16 a[40:43], a[232:235], v[212:215], a[40:43]
v_exp_f32 v136, v136
v_mfma_f32_16x16x32_bf16 a[104:107], a[232:235], v[220:223], a[104:107]
ds_read_b128 a[144:147], v2 offset:20480
v_cvt_pk_bf16_f32 v195, v146, v147
v_mfma_f32_16x16x32_bf16 a[104:107], a[200:203], v[204:207], a[104:107]
v_exp_f32 v137, v137
v_mfma_f32_16x16x32_bf16 a[108:111], a[204:207], v[204:207], a[108:111]
v_exp_f32 v138, v138
v_mfma_f32_16x16x32_bf16 a[108:111], a[236:239], v[220:223], a[108:111]
ds_read_b128 a[148:151], v2 offset:21504
v_cvt_pk_bf16_f32 v200, v136, v137
v_mfma_f32_16x16x32_bf16 a[44:47], a[236:239], v[212:215], a[44:47]
v_exp_f32 v139, v139
v_mfma_f32_16x16x32_bf16 a[44:47], a[204:207], v[196:199], a[44:47]
v_exp_f32 v152, v152
v_mfma_f32_16x16x32_bf16 a[48:51], a[208:211], v[196:199], a[48:51]
s_waitcnt lgkmcnt(6)
ds_read_b128 a[152:155], v2 offset:22528
v_cvt_pk_bf16_f32 v201, v138, v139
v_mfma_f32_16x16x32_bf16 a[48:51], a[240:243], v[212:215], a[48:51]
buffer_load_dwordx4 v1, s[44:47], s72 offen offset:1024 sc1 lds
v_mfma_f32_16x16x32_bf16 a[112:115], a[240:243], v[220:223], a[112:115]
v_exp_f32 v153, v153
v_mfma_f32_16x16x32_bf16 a[112:115], a[208:211], v[204:207], a[112:115]
v_exp_f32 v154, v154
v_mfma_f32_16x16x32_bf16 a[116:119], a[212:215], v[204:207], a[116:119]
ds_read_b128 a[156:159], v2 offset:23552
v_cvt_pk_bf16_f32 v202, v152, v153
v_mfma_f32_16x16x32_bf16 a[116:119], a[244:247], v[220:223], a[116:119]
v_exp_f32 v155, v155
v_mfma_f32_16x16x32_bf16 a[52:55], a[244:247], v[212:215], a[52:55]
v_exp_f32 v132, v132
v_mfma_f32_16x16x32_bf16 a[52:55], a[212:215], v[196:199], a[52:55]
ds_read_b128 a[192:195], v2 offset:0
v_cvt_pk_bf16_f32 v203, v154, v155
v_mfma_f32_16x16x32_bf16 a[56:59], a[216:219], v[196:199], a[56:59]
v_exp_f32 v133, v133
v_mfma_f32_16x16x32_bf16 a[56:59], a[248:251], v[212:215], a[56:59]
v_exp_f32 v134, v134
v_mfma_f32_16x16x32_bf16 a[120:123], a[248:251], v[220:223], a[120:123]
ds_read_b128 a[196:199], v2 offset:1024
v_mfma_f32_16x16x32_bf16 a[120:123], a[216:219], v[204:207], a[120:123]
v_exp_f32 v135, v135
v_mfma_f32_16x16x32_bf16 a[124:127], a[220:223], v[204:207], a[124:127]
v_exp_f32 v148, v148
v_mfma_f32_16x16x32_bf16 a[124:127], a[252:255], v[220:223], a[124:127]
ds_read_b128 a[200:203], v2 offset:2048
v_mfma_f32_16x16x32_bf16 a[60:63], a[252:255], v[212:215], a[60:63]
buffer_load_dwordx4 v1, s[44:47], s72 offen offset:2048 sc1 lds
v_mfma_f32_16x16x32_bf16 a[60:63], a[220:223], v[196:199], a[60:63]
ds_read_b128 a[204:207], v2 offset:3072
v_cvt_pk_bf16_f32 v196, v132, v133
v_mfma_f32_16x16x32_bf16 v[164:167], a[160:163], v[32:35], v[84:87]
v_exp_f32 v149, v149
v_mfma_f32_16x16x32_bf16 v[164:167], a[164:167], v[36:39], v[164:167]
v_exp_f32 v150, v150
v_mfma_f32_16x16x32_bf16 v[164:167], a[168:171], v[40:43], v[164:167]
ds_read_b128 a[208:211], v2 offset:4096
v_cvt_pk_bf16_f32 v197, v134, v135
v_mfma_f32_16x16x32_bf16 v[164:167], a[172:175], v[44:47], v[164:167]
v_exp_f32 v151, v151
v_mfma_f32_16x16x32_bf16 v[172:175], a[172:175], v[76:79], v[92:95]
v_exp_f32 v140, v140
v_mfma_f32_16x16x32_bf16 v[172:175], a[168:171], v[72:75], v[172:175]
ds_read_b128 a[212:215], v2 offset:5120
v_cvt_pk_bf16_f32 v198, v148, v149
v_mfma_f32_16x16x32_bf16 v[172:175], a[164:167], v[68:71], v[172:175]
v_exp_f32 v141, v141
v_mfma_f32_16x16x32_bf16 v[172:175], a[160:163], v[64:67], v[172:175]
v_exp_f32 v142, v142
v_mfma_f32_16x16x32_bf16 v[188:191], a[176:179], v[64:67], v[92:95]
ds_read_b128 a[216:219], v2 offset:6144
v_cvt_pk_bf16_f32 v199, v150, v151
v_mfma_f32_16x16x32_bf16 v[188:191], a[180:183], v[68:71], v[188:191]
v_exp_f32 v143, v143
v_mfma_f32_16x16x32_bf16 v[188:191], a[184:187], v[72:75], v[188:191]
v_exp_f32 v156, v156
v_mfma_f32_16x16x32_bf16 v[188:191], a[188:191], v[76:79], v[188:191]
ds_read_b128 a[220:223], v2 offset:7168
v_cvt_pk_bf16_f32 v204, v140, v141
v_mfma_f32_16x16x32_bf16 v[180:183], a[188:191], v[44:47], v[84:87]
buffer_load_dwordx4 v1, s[44:47], s72 offen offset:3072 sc1 lds
v_mfma_f32_16x16x32_bf16 v[180:183], a[184:187], v[40:43], v[180:183]
v_exp_f32 v157, v157
v_mfma_f32_16x16x32_bf16 v[180:183], a[180:183], v[36:39], v[180:183]
v_exp_f32 v158, v158
v_mfma_f32_16x16x32_bf16 v[180:183], a[176:179], v[32:35], v[180:183]
v_cvt_pk_bf16_f32 v205, v142, v143
v_cvt_pk_bf16_f32 v206, v156, v157
v_mfma_f32_16x16x32_bf16 v[160:163], a[160:163], v[16:19], v[80:83]
v_exp_f32 v159, v159
v_mfma_f32_16x16x32_bf16 v[160:163], a[164:167], v[20:23], v[160:163]
v_cvt_pk_bf16_f32 v207, v158, v159
v_mfma_f32_16x16x32_bf16 v[160:163], a[168:171], v[24:27], v[160:163]
v_mfma_f32_16x16x32_bf16 v[160:163], a[172:175], v[28:31], v[160:163]
v_mfma_f32_16x16x32_bf16 v[168:171], a[172:175], v[60:63], v[88:91]
v_mfma_f32_16x16x32_bf16 v[168:171], a[168:171], v[56:59], v[168:171]
v_mfma_f32_16x16x32_bf16 v[168:171], a[164:167], v[52:55], v[168:171]
v_mfma_f32_16x16x32_bf16 v[168:171], a[160:163], v[48:51], v[168:171]
v_mfma_f32_16x16x32_bf16 v[184:187], a[176:179], v[48:51], v[88:91]
v_mfma_f32_16x16x32_bf16 v[184:187], a[180:183], v[52:55], v[184:187]
v_mfma_f32_16x16x32_bf16 v[184:187], a[184:187], v[56:59], v[184:187]
v_mfma_f32_16x16x32_bf16 v[184:187], a[188:191], v[60:63], v[184:187]
v_mfma_f32_16x16x32_bf16 v[176:179], a[188:191], v[28:31], v[80:83]
v_mfma_f32_16x16x32_bf16 v[176:179], a[184:187], v[24:27], v[176:179]
v_mfma_f32_16x16x32_bf16 v[176:179], a[180:183], v[20:23], v[176:179]
v_mfma_f32_16x16x32_bf16 v[176:179], a[176:179], v[16:19], v[176:179]
s_waitcnt lgkmcnt(4)
v_mfma_f32_16x16x32_bf16 v[224:227], v[120:123], v[208:211], v[224:227]
s_add_u32 s82, s82, 0x8000
ds_read_b128 a[160:163], v2 offset:24576
v_mfma_f32_16x16x32_bf16 v[224:227], v[120:123], v[192:195], v[224:227]
s_and_b32 s82, s82, 0x1ffff
v_exp_f32 v164, v164
v_mfma_f32_16x16x32_bf16 v[232:235], v[120:123], v[216:219], v[232:235]
s_add_u32 m0, s74, 0
v_exp_f32 v165, v165
v_mfma_f32_16x16x32_bf16 v[232:235], v[120:123], v[200:203], v[232:235]
s_add_u32 s72, s81, 0
ds_read_b128 a[164:167], v2 offset:25600
v_cvt_pk_bf16_f32 v212, v164, v165
v_mfma_f32_16x16x32_bf16 a[0:3], a[224:227], v[208:211], a[0:3]
v_exp_f32 v166, v166
v_mfma_f32_16x16x32_bf16 a[0:3], a[192:195], v[192:195], a[0:3]
v_exp_f32 v167, v167
v_mfma_f32_16x16x32_bf16 a[64:67], a[192:195], v[200:203], a[64:67]
ds_read_b128 a[168:171], v2 offset:26624
v_cvt_pk_bf16_f32 v213, v166, v167
v_mfma_f32_16x16x32_bf16 a[64:67], a[224:227], v[216:219], a[64:67]
v_exp_f32 v180, v180
v_mfma_f32_16x16x32_bf16 a[68:71], a[228:231], v[216:219], a[68:71]
buffer_load_dwordx4 v1, s[44:47], s72 offen sc1 lds
v_mfma_f32_16x16x32_bf16 a[68:71], a[196:199], v[200:203], a[68:71]
v_exp_f32 v181, v181
v_mfma_f32_16x16x32_bf16 a[4:7], a[196:199], v[192:195], a[4:7]
ds_read_b128 a[172:175], v2 offset:27648
v_cvt_pk_bf16_f32 v214, v180, v181
v_mfma_f32_16x16x32_bf16 a[4:7], a[228:231], v[208:211], a[4:7]
v_exp_f32 v182, v182
v_mfma_f32_16x16x32_bf16 a[8:11], a[232:235], v[208:211], a[8:11]
v_exp_f32 v183, v183
v_mfma_f32_16x16x32_bf16 a[8:11], a[200:203], v[192:195], a[8:11]
ds_read_b128 a[176:179], v2 offset:28672
v_cvt_pk_bf16_f32 v215, v182, v183
v_mfma_f32_16x16x32_bf16 a[72:75], a[200:203], v[200:203], a[72:75]
v_exp_f32 v172, v172
v_mfma_f32_16x16x32_bf16 a[72:75], a[232:235], v[216:219], a[72:75]
v_exp_f32 v173, v173
v_mfma_f32_16x16x32_bf16 a[76:79], a[236:239], v[216:219], a[76:79]
ds_read_b128 a[180:183], v2 offset:29696
v_cvt_pk_bf16_f32 v220, v172, v173
v_mfma_f32_16x16x32_bf16 a[76:79], a[204:207], v[200:203], a[76:79]
v_exp_f32 v174, v174
v_mfma_f32_16x16x32_bf16 a[12:15], a[204:207], v[192:195], a[12:15]
v_exp_f32 v175, v175
v_mfma_f32_16x16x32_bf16 a[12:15], a[236:239], v[208:211], a[12:15]
ds_read_b128 a[184:187], v2 offset:30720
v_cvt_pk_bf16_f32 v221, v174, v175
v_mfma_f32_16x16x32_bf16 a[16:19], a[240:243], v[208:211], a[16:19]
s_waitcnt lgkmcnt(7)
v_exp_f32 v188, v188
v_mfma_f32_16x16x32_bf16 a[16:19], a[208:211], v[192:195], a[16:19]
buffer_load_dwordx4 v1, s[44:47], s72 offen offset:1024 sc1 lds
v_mfma_f32_16x16x32_bf16 a[80:83], a[208:211], v[200:203], a[80:83]
v_exp_f32 v189, v189
v_mfma_f32_16x16x32_bf16 a[80:83], a[240:243], v[216:219], a[80:83]
ds_read_b128 a[188:191], v2 offset:31744
v_cvt_pk_bf16_f32 v222, v188, v189
v_mfma_f32_16x16x32_bf16 a[84:87], a[244:247], v[216:219], a[84:87]
v_exp_f32 v190, v190
v_mfma_f32_16x16x32_bf16 a[84:87], a[212:215], v[200:203], a[84:87]
v_exp_f32 v191, v191
v_mfma_f32_16x16x32_bf16 a[20:23], a[212:215], v[192:195], a[20:23]
ds_read_b128 a[224:227], v2 offset:8192
v_cvt_pk_bf16_f32 v223, v190, v191
v_mfma_f32_16x16x32_bf16 a[20:23], a[244:247], v[208:211], a[20:23]
v_exp_f32 v160, v160
v_mfma_f32_16x16x32_bf16 a[24:27], a[248:251], v[208:211], a[24:27]
v_exp_f32 v161, v161
v_mfma_f32_16x16x32_bf16 a[24:27], a[216:219], v[192:195], a[24:27]
ds_read_b128 a[228:231], v2 offset:9216
v_mfma_f32_16x16x32_bf16 a[88:91], a[216:219], v[200:203], a[88:91]
v_exp_f32 v162, v162
v_mfma_f32_16x16x32_bf16 a[88:91], a[248:251], v[216:219], a[88:91]
v_exp_f32 v163, v163
v_mfma_f32_16x16x32_bf16 a[92:95], a[252:255], v[216:219], a[92:95]
ds_read_b128 a[232:235], v2 offset:10240
v_mfma_f32_16x16x32_bf16 a[92:95], a[220:223], v[200:203], a[92:95]
v_exp_f32 v176, v176
v_mfma_f32_16x16x32_bf16 a[28:31], a[220:223], v[192:195], a[28:31]
buffer_load_dwordx4 v1, s[44:47], s72 offen offset:2048 sc1 lds
v_mfma_f32_16x16x32_bf16 a[28:31], a[252:255], v[208:211], a[28:31]
ds_read_b128 a[236:239], v2 offset:11264
v_cvt_pk_bf16_f32 v208, v160, v161
s_cmp_eq_u32 s58, 0
s_cbranch_scc1 Lta16
s_cmp_eq_u32 s58, 1
s_cbranch_scc1 Lnt17
v_mfma_f32_16x16x32_bf16 v[128:131], a[128:131], v[16:19], v[80:83]
v_exp_f32 v177, v177
v_mfma_f32_16x16x32_bf16 v[144:147], a[144:147], v[16:19], v[80:83]
v_exp_f32 v178, v178
s_branch Ljoin18
Lta16:
v_mfma_f32_16x16x32_bf16 v[128:131], a[128:131], v[16:19], v[96:99]
v_exp_f32 v177, v177
v_mfma_f32_16x16x32_bf16 v[144:147], a[144:147], v[16:19], v[112:115]
v_exp_f32 v178, v178
s_branch Ljoin18
Lnt17:
v_mfma_f32_16x16x32_bf16 v[128:131], a[128:131], v[16:19], v[80:83]
v_exp_f32 v177, v177
v_mfma_f32_16x16x32_bf16 v[144:147], a[144:147], v[16:19], v[96:99]
v_exp_f32 v178, v178
Ljoin18:
v_mfma_f32_16x16x32_bf16 v[128:131], a[132:135], v[20:23], v[128:131]
ds_read_b128 a[240:243], v2 offset:12288
v_cvt_pk_bf16_f32 v209, v162, v163
v_mfma_f32_16x16x32_bf16 v[128:131], a[136:139], v[24:27], v[128:131]
v_exp_f32 v179, v179
v_mfma_f32_16x16x32_bf16 v[128:131], a[140:143], v[28:31], v[128:131]
v_exp_f32 v168, v168
v_mfma_f32_16x16x32_bf16 v[136:139], a[140:143], v[60:63], v[88:91]
ds_read_b128 a[244:247], v2 offset:13312
v_cvt_pk_bf16_f32 v210, v176, v177
v_mfma_f32_16x16x32_bf16 v[136:139], a[136:139], v[56:59], v[136:139]
v_exp_f32 v169, v169
v_mfma_f32_16x16x32_bf16 v[136:139], a[132:135], v[52:55], v[136:139]
v_exp_f32 v170, v170
v_mfma_f32_16x16x32_bf16 v[136:139], a[128:131], v[48:51], v[136:139]
ds_read_b128 a[248:251], v2 offset:14336
v_cvt_pk_bf16_f32 v211, v178, v179
v_mfma_f32_16x16x32_bf16 v[152:155], a[144:147], v[48:51], v[88:91]
v_exp_f32 v171, v171
v_mfma_f32_16x16x32_bf16 v[152:155], a[148:151], v[52:55], v[152:155]
v_exp_f32 v184, v184
v_mfma_f32_16x16x32_bf16 v[152:155], a[152:155], v[56:59], v[152:155]
ds_read_b128 a[252:255], v2 offset:15360
v_cvt_pk_bf16_f32 v216, v168, v169
v_mfma_f32_16x16x32_bf16 v[152:155], a[156:159], v[60:63], v[152:155]
buffer_load_dwordx4 v1, s[44:47], s72 offen offset:3072 sc1 lds
v_mfma_f32_16x16x32_bf16 v[144:147], a[156:159], v[28:31], v[144:147]
v_exp_f32 v185, v185
v_mfma_f32_16x16x32_bf16 v[144:147], a[152:155], v[24:27], v[144:147]
v_exp_f32 v186, v186
v_mfma_f32_16x16x32_bf16 v[144:147], a[148:151], v[20:23], v[144:147]
v_cvt_pk_bf16_f32 v217, v170, v171
v_cvt_pk_bf16_f32 v218, v184, v185
v_mfma_f32_16x16x32_bf16 v[132:135], a[128:131], v[32:35], v[84:87]
v_exp_f32 v187, v187
v_mfma_f32_16x16x32_bf16 v[132:135], a[132:135], v[36:39], v[132:135]
v_cvt_pk_bf16_f32 v219, v186, v187
v_add_u32 v2, s82, v1
v_mfma_f32_16x16x32_bf16 v[132:135], a[136:139], v[40:43], v[132:135]
v_mfma_f32_16x16x32_bf16 v[132:135], a[140:143], v[44:47], v[132:135]
v_mfma_f32_16x16x32_bf16 v[140:143], a[140:143], v[76:79], v[92:95]
v_mfma_f32_16x16x32_bf16 v[140:143], a[136:139], v[72:75], v[140:143]
v_mfma_f32_16x16x32_bf16 v[140:143], a[132:135], v[68:71], v[140:143]
v_mfma_f32_16x16x32_bf16 v[140:143], a[128:131], v[64:67], v[140:143]
v_mfma_f32_16x16x32_bf16 v[156:159], a[144:147], v[64:67], v[92:95]
v_mfma_f32_16x16x32_bf16 v[156:159], a[148:151], v[68:71], v[156:159]
v_mfma_f32_16x16x32_bf16 v[156:159], a[152:155], v[72:75], v[156:159]
v_mfma_f32_16x16x32_bf16 v[156:159], a[156:159], v[76:79], v[156:159]
v_mfma_f32_16x16x32_bf16 v[148:151], a[156:159], v[44:47], v[84:87]
v_mfma_f32_16x16x32_bf16 v[148:151], a[152:155], v[40:43], v[148:151]
v_mfma_f32_16x16x32_bf16 v[148:151], a[148:151], v[36:39], v[148:151]
s_waitcnt vmcnt(8) lgkmcnt(4)
v_mfma_f32_16x16x32_bf16 v[148:151], a[144:147], v[32:35], v[148:151]
s_barrier
v_mfma_f32_16x16x32_bf16 v[228:231], v[120:123], v[196:199], v[228:231]
s_xor_b32 s74, s82, 0x10000
v_exp_f32 v128, v128
v_mfma_f32_16x16x32_bf16 v[228:231], v[120:123], v[212:215], v[228:231]
s_add_u32 s74, s74, s64
ds_read_b128 a[128:131], v2 offset:16384
v_mfma_f32_16x16x32_bf16 v[236:239], v[120:123], v[204:207], v[236:239]
s_add_u32 s81, s81, 0x8000
v_exp_f32 v129, v129
v_mfma_f32_16x16x32_bf16 v[236:239], v[120:123], v[220:223], v[236:239]
s_add_u32 m0, s74, 16384
v_exp_f32 v130, v130
v_mfma_f32_16x16x32_bf16 a[32:35], a[192:195], v[196:199], a[32:35]
s_add_u32 s72, s81, 16384
ds_read_b128 a[132:135], v2 offset:17408
v_cvt_pk_bf16_f32 v192, v128, v129
v_mfma_f32_16x16x32_bf16 a[32:35], a[224:227], v[212:215], a[32:35]
v_exp_f32 v131, v131
v_mfma_f32_16x16x32_bf16 a[96:99], a[224:227], v[220:223], a[96:99]
v_exp_f32 v144, v144
v_mfma_f32_16x16x32_bf16 a[96:99], a[192:195], v[204:207], a[96:99]
ds_read_b128 a[136:139], v2 offset:18432
v_cvt_pk_bf16_f32 v193, v130, v131
v_mfma_f32_16x16x32_bf16 a[100:103], a[196:199], v[204:207], a[100:103]
buffer_load_dwordx4 v1, s[44:47], s72 offen sc1 lds
v_mfma_f32_16x16x32_bf16 a[100:103], a[228:231], v[220:223], a[100:103]
v_exp_f32 v145, v145
v_mfma_f32_16x16x32_bf16 a[36:39], a[228:231], v[212:215], a[36:39]
v_exp_f32 v146, v146
v_mfma_f32_16x16x32_bf16 a[36:39], a[196:199], v[196:199], a[36:39]
ds_read_b128 a[140:143], v2 offset:19456
v_cvt_pk_bf16_f32 v194, v144, v145
v_mfma_f32_16x16x32_bf16 a[40:43], a[200:203], v[196:199], a[40:43]
v_exp_f32 v147, v147
v_mfma_f32_16x16x32_bf16 a[40:43], a[232:235], v[212:215], a[40:43]
v_exp_f32 v136, v136
v_mfma_f32_16x16x32_bf16 a[104:107], a[232:235], v[220:223], a[104:107]
ds_read_b128 a[144:147], v2 offset:20480
v_cvt_pk_bf16_f32 v195, v146, v147
v_mfma_f32_16x16x32_bf16 a[104:107], a[200:203], v[204:207], a[104:107]
v_exp_f32 v137, v137
v_mfma_f32_16x16x32_bf16 a[108:111], a[204:207], v[204:207], a[108:111]
v_exp_f32 v138, v138
v_mfma_f32_16x16x32_bf16 a[108:111], a[236:239], v[220:223], a[108:111]
ds_read_b128 a[148:151], v2 offset:21504
v_cvt_pk_bf16_f32 v200, v136, v137
v_mfma_f32_16x16x32_bf16 a[44:47], a[236:239], v[212:215], a[44:47]
v_exp_f32 v139, v139
v_mfma_f32_16x16x32_bf16 a[44:47], a[204:207], v[196:199], a[44:47]
v_exp_f32 v152, v152
v_mfma_f32_16x16x32_bf16 a[48:51], a[208:211], v[196:199], a[48:51]
s_waitcnt lgkmcnt(6)
ds_read_b128 a[152:155], v2 offset:22528
v_cvt_pk_bf16_f32 v201, v138, v139
v_mfma_f32_16x16x32_bf16 a[48:51], a[240:243], v[212:215], a[48:51]
buffer_load_dwordx4 v1, s[44:47], s72 offen offset:1024 sc1 lds
v_mfma_f32_16x16x32_bf16 a[112:115], a[240:243], v[220:223], a[112:115]
v_exp_f32 v153, v153
v_mfma_f32_16x16x32_bf16 a[112:115], a[208:211], v[204:207], a[112:115]
v_exp_f32 v154, v154
v_mfma_f32_16x16x32_bf16 a[116:119], a[212:215], v[204:207], a[116:119]
ds_read_b128 a[156:159], v2 offset:23552
v_cvt_pk_bf16_f32 v202, v152, v153
v_mfma_f32_16x16x32_bf16 a[116:119], a[244:247], v[220:223], a[116:119]
v_exp_f32 v155, v155
v_mfma_f32_16x16x32_bf16 a[52:55], a[244:247], v[212:215], a[52:55]
v_exp_f32 v132, v132
v_mfma_f32_16x16x32_bf16 a[52:55], a[212:215], v[196:199], a[52:55]
ds_read_b128 a[192:195], v2 offset:0
v_cvt_pk_bf16_f32 v203, v154, v155
v_mfma_f32_16x16x32_bf16 a[56:59], a[216:219], v[196:199], a[56:59]
v_exp_f32 v133, v133
v_mfma_f32_16x16x32_bf16 a[56:59], a[248:251], v[212:215], a[56:59]
v_exp_f32 v134, v134
v_mfma_f32_16x16x32_bf16 a[120:123], a[248:251], v[220:223], a[120:123]
ds_read_b128 a[196:199], v2 offset:1024
v_mfma_f32_16x16x32_bf16 a[120:123], a[216:219], v[204:207], a[120:123]
v_exp_f32 v135, v135
v_mfma_f32_16x16x32_bf16 a[124:127], a[220:223], v[204:207], a[124:127]
v_exp_f32 v148, v148
v_mfma_f32_16x16x32_bf16 a[124:127], a[252:255], v[220:223], a[124:127]
ds_read_b128 a[200:203], v2 offset:2048
v_mfma_f32_16x16x32_bf16 a[60:63], a[252:255], v[212:215], a[60:63]
buffer_load_dwordx4 v1, s[44:47], s72 offen offset:2048 sc1 lds
v_mfma_f32_16x16x32_bf16 a[60:63], a[220:223], v[196:199], a[60:63]
ds_read_b128 a[204:207], v2 offset:3072
v_cvt_pk_bf16_f32 v196, v132, v133
s_cmp_eq_u32 s58, 2
s_cbranch_scc1 Lta19
s_cmp_eq_u32 s58, 3
s_cbranch_scc1 Lnt20
v_mfma_f32_16x16x32_bf16 v[160:163], a[160:163], v[16:19], v[112:115]
v_exp_f32 v149, v149
v_mfma_f32_16x16x32_bf16 v[176:179], a[176:179], v[16:19], v[112:115]
v_exp_f32 v150, v150
s_branch Ljoin21
Lta19:
v_mfma_f32_16x16x32_bf16 v[160:163], a[160:163], v[16:19], v[96:99]
v_exp_f32 v149, v149
v_mfma_f32_16x16x32_bf16 v[176:179], a[176:179], v[16:19], v[112:115]
v_exp_f32 v150, v150
s_branch Ljoin21
Lnt20:
v_mfma_f32_16x16x32_bf16 v[160:163], a[160:163], v[16:19], v[80:83]
v_exp_f32 v149, v149
v_mfma_f32_16x16x32_bf16 v[176:179], a[176:179], v[16:19], v[96:99]
v_exp_f32 v150, v150
Ljoin21:
v_mfma_f32_16x16x32_bf16 v[164:167], a[160:163], v[32:35], v[84:87]
ds_read_b128 a[208:211], v2 offset:4096
v_cvt_pk_bf16_f32 v197, v134, v135
v_mfma_f32_16x16x32_bf16 v[164:167], a[164:167], v[36:39], v[164:167]
v_exp_f32 v151, v151
v_mfma_f32_16x16x32_bf16 v[164:167], a[168:171], v[40:43], v[164:167]
v_exp_f32 v140, v140
v_mfma_f32_16x16x32_bf16 v[164:167], a[172:175], v[44:47], v[164:167]
ds_read_b128 a[212:215], v2 offset:5120
v_cvt_pk_bf16_f32 v198, v148, v149
v_mfma_f32_16x16x32_bf16 v[172:175], a[172:175], v[76:79], v[92:95]
v_exp_f32 v141, v141
v_mfma_f32_16x16x32_bf16 v[172:175], a[168:171], v[72:75], v[172:175]
v_exp_f32 v142, v142
v_mfma_f32_16x16x32_bf16 v[172:175], a[164:167], v[68:71], v[172:175]
ds_read_b128 a[216:219], v2 offset:6144
v_cvt_pk_bf16_f32 v199, v150, v151
v_mfma_f32_16x16x32_bf16 v[172:175], a[160:163], v[64:67], v[172:175]
v_exp_f32 v143, v143
v_mfma_f32_16x16x32_bf16 v[188:191], a[176:179], v[64:67], v[92:95]
v_exp_f32 v156, v156
v_mfma_f32_16x16x32_bf16 v[188:191], a[180:183], v[68:71], v[188:191]
ds_read_b128 a[220:223], v2 offset:7168
v_cvt_pk_bf16_f32 v204, v140, v141
v_mfma_f32_16x16x32_bf16 v[188:191], a[184:187], v[72:75], v[188:191]
buffer_load_dwordx4 v1, s[44:47], s72 offen offset:3072 sc1 lds
v_mfma_f32_16x16x32_bf16 v[188:191], a[188:191], v[76:79], v[188:191]
v_exp_f32 v157, v157
v_mfma_f32_16x16x32_bf16 v[180:183], a[188:191], v[44:47], v[84:87]
v_exp_f32 v158, v158
v_mfma_f32_16x16x32_bf16 v[180:183], a[184:187], v[40:43], v[180:183]
v_cvt_pk_bf16_f32 v205, v142, v143
v_cvt_pk_bf16_f32 v206, v156, v157
v_mfma_f32_16x16x32_bf16 v[180:183], a[180:183], v[36:39], v[180:183]
v_exp_f32 v159, v159
v_mfma_f32_16x16x32_bf16 v[180:183], a[176:179], v[32:35], v[180:183]
v_cvt_pk_bf16_f32 v207, v158, v159
v_mfma_f32_16x16x32_bf16 v[160:163], a[164:167], v[20:23], v[160:163]
v_mfma_f32_16x16x32_bf16 v[160:163], a[168:171], v[24:27], v[160:163]
v_mfma_f32_16x16x32_bf16 v[160:163], a[172:175], v[28:31], v[160:163]
v_mfma_f32_16x16x32_bf16 v[168:171], a[172:175], v[60:63], v[88:91]
v_mfma_f32_16x16x32_bf16 v[168:171], a[168:171], v[56:59], v[168:171]
v_mfma_f32_16x16x32_bf16 v[168:171], a[164:167], v[52:55], v[168:171]
v_mfma_f32_16x16x32_bf16 v[168:171], a[160:163], v[48:51], v[168:171]
v_mfma_f32_16x16x32_bf16 v[184:187], a[176:179], v[48:51], v[88:91]
v_mfma_f32_16x16x32_bf16 v[184:187], a[180:183], v[52:55], v[184:187]
v_mfma_f32_16x16x32_bf16 v[184:187], a[184:187], v[56:59], v[184:187]
v_mfma_f32_16x16x32_bf16 v[184:187], a[188:191], v[60:63], v[184:187]
v_mfma_f32_16x16x32_bf16 v[176:179], a[188:191], v[28:31], v[176:179]
v_mfma_f32_16x16x32_bf16 v[176:179], a[184:187], v[24:27], v[176:179]
v_mfma_f32_16x16x32_bf16 v[176:179], a[180:183], v[20:23], v[176:179]
s_waitcnt lgkmcnt(4)
v_mfma_f32_16x16x32_bf16 v[224:227], v[120:123], v[208:211], v[224:227]
s_add_u32 s82, s82, 0x8000
ds_read_b128 a[160:163], v2 offset:24576
v_mfma_f32_16x16x32_bf16 v[224:227], v[120:123], v[192:195], v[224:227]
s_and_b32 s82, s82, 0x1ffff
v_exp_f32 v164, v164
v_mfma_f32_16x16x32_bf16 v[232:235], v[120:123], v[216:219], v[232:235]
s_add_u32 m0, s74, 0
v_exp_f32 v165, v165
v_mfma_f32_16x16x32_bf16 v[232:235], v[120:123], v[200:203], v[232:235]
s_add_u32 s72, s81, 0
ds_read_b128 a[164:167], v2 offset:25600
v_cvt_pk_bf16_f32 v212, v164, v165
v_mfma_f32_16x16x32_bf16 a[0:3], a[224:227], v[208:211], a[0:3]
v_exp_f32 v166, v166
v_mfma_f32_16x16x32_bf16 a[0:3], a[192:195], v[192:195], a[0:3]
v_exp_f32 v167, v167
v_mfma_f32_16x16x32_bf16 a[64:67], a[192:195], v[200:203], a[64:67]
ds_read_b128 a[168:171], v2 offset:26624
v_cvt_pk_bf16_f32 v213, v166, v167
v_mfma_f32_16x16x32_bf16 a[64:67], a[224:227], v[216:219], a[64:67]
v_exp_f32 v180, v180
v_mfma_f32_16x16x32_bf16 a[68:71], a[228:231], v[216:219], a[68:71]
buffer_load_dwordx4 v1, s[44:47], s72 offen sc1 lds
v_mfma_f32_16x16x32_bf16 a[68:71], a[196:199], v[200:203], a[68:71]
v_exp_f32 v181, v181
v_mfma_f32_16x16x32_bf16 a[4:7], a[196:199], v[192:195], a[4:7]
ds_read_b128 a[172:175], v2 offset:27648
v_cvt_pk_bf16_f32 v214, v180, v181
v_mfma_f32_16x16x32_bf16 a[4:7], a[228:231], v[208:211], a[4:7]
v_exp_f32 v182, v182
v_mfma_f32_16x16x32_bf16 a[8:11], a[232:235], v[208:211], a[8:11]
v_exp_f32 v183, v183
v_mfma_f32_16x16x32_bf16 a[8:11], a[200:203], v[192:195], a[8:11]
ds_read_b128 a[176:179], v2 offset:28672
v_cvt_pk_bf16_f32 v215, v182, v183
v_mfma_f32_16x16x32_bf16 a[72:75], a[200:203], v[200:203], a[72:75]
v_exp_f32 v172, v172
v_mfma_f32_16x16x32_bf16 a[72:75], a[232:235], v[216:219], a[72:75]
v_exp_f32 v173, v173
v_mfma_f32_16x16x32_bf16 a[76:79], a[236:239], v[216:219], a[76:79]
ds_read_b128 a[180:183], v2 offset:29696
v_cvt_pk_bf16_f32 v220, v172, v173
v_mfma_f32_16x16x32_bf16 a[76:79], a[204:207], v[200:203], a[76:79]
v_exp_f32 v174, v174
v_mfma_f32_16x16x32_bf16 a[12:15], a[204:207], v[192:195], a[12:15]
v_exp_f32 v175, v175
v_mfma_f32_16x16x32_bf16 a[12:15], a[236:239], v[208:211], a[12:15]
ds_read_b128 a[184:187], v2 offset:30720
v_cvt_pk_bf16_f32 v221, v174, v175
v_mfma_f32_16x16x32_bf16 a[16:19], a[240:243], v[208:211], a[16:19]
s_waitcnt lgkmcnt(7)
v_exp_f32 v188, v188
v_mfma_f32_16x16x32_bf16 a[16:19], a[208:211], v[192:195], a[16:19]
buffer_load_dwordx4 v1, s[44:47], s72 offen offset:1024 sc1 lds
v_mfma_f32_16x16x32_bf16 a[80:83], a[208:211], v[200:203], a[80:83]
v_exp_f32 v189, v189
v_mfma_f32_16x16x32_bf16 a[80:83], a[240:243], v[216:219], a[80:83]
ds_read_b128 a[188:191], v2 offset:31744
v_cvt_pk_bf16_f32 v222, v188, v189
v_mfma_f32_16x16x32_bf16 a[84:87], a[244:247], v[216:219], a[84:87]
v_exp_f32 v190, v190
v_mfma_f32_16x16x32_bf16 a[84:87], a[212:215], v[200:203], a[84:87]
v_exp_f32 v191, v191
v_mfma_f32_16x16x32_bf16 a[20:23], a[212:215], v[192:195], a[20:23]
ds_read_b128 a[224:227], v2 offset:8192
v_cvt_pk_bf16_f32 v223, v190, v191
v_mfma_f32_16x16x32_bf16 a[20:23], a[244:247], v[208:211], a[20:23]
v_exp_f32 v160, v160
v_mfma_f32_16x16x32_bf16 a[24:27], a[248:251], v[208:211], a[24:27]
v_exp_f32 v161, v161
v_mfma_f32_16x16x32_bf16 a[24:27], a[216:219], v[192:195], a[24:27]
ds_read_b128 a[228:231], v2 offset:9216
v_mfma_f32_16x16x32_bf16 a[88:91], a[216:219], v[200:203], a[88:91]
v_exp_f32 v162, v162
v_mfma_f32_16x16x32_bf16 a[88:91], a[248:251], v[216:219], a[88:91]
v_exp_f32 v163, v163
v_mfma_f32_16x16x32_bf16 a[92:95], a[252:255], v[216:219], a[92:95]
ds_read_b128 a[232:235], v2 offset:10240
v_mfma_f32_16x16x32_bf16 a[92:95], a[220:223], v[200:203], a[92:95]
v_exp_f32 v176, v176
v_mfma_f32_16x16x32_bf16 a[28:31], a[220:223], v[192:195], a[28:31]
buffer_load_dwordx4 v1, s[44:47], s72 offen offset:2048 sc1 lds
v_mfma_f32_16x16x32_bf16 a[28:31], a[252:255], v[208:211], a[28:31]
ds_read_b128 a[236:239], v2 offset:11264
v_cvt_pk_bf16_f32 v208, v160, v161
s_cmp_eq_u32 s58, 0
s_cbranch_scc1 Lta22
s_cmp_eq_u32 s58, 1
s_cbranch_scc1 Lnt23
v_mfma_f32_16x16x32_bf16 v[132:135], a[128:131], v[32:35], v[84:87]
Lstub3:
s_cbranch_execz Lstub7
v_exp_f32 v177, v177
v_mfma_f32_16x16x32_bf16 v[148:151], a[144:147], v[32:35], v[84:87]
v_exp_f32 v178, v178
s_branch Ljoin24
Lta22:
v_mfma_f32_16x16x32_bf16 v[132:135], a[128:131], v[32:35], v[100:103]
v_exp_f32 v177, v177
v_mfma_f32_16x16x32_bf16 v[148:151], a[144:147], v[32:35], v[112:115]
v_exp_f32 v178, v178
s_branch Ljoin24
Lnt23:
v_mfma_f32_16x16x32_bf16 v[132:135], a[128:131], v[32:35], v[84:87]
v_exp_f32 v177, v177
v_mfma_f32_16x16x32_bf16 v[148:151], a[144:147], v[32:35], v[100:103]
v_exp_f32 v178, v178
Ljoin24:
v_mfma_f32_16x16x32_bf16 v[136:139], a[128:131], v[48:51], v[88:91]
ds_read_b128 a[240:243], v2 offset:12288
v_cvt_pk_bf16_f32 v209, v162, v163
v_mfma_f32_16x16x32_bf16 v[136:139], a[132:135], v[52:55], v[136:139]
v_exp_f32 v179, v179
v_mfma_f32_16x16x32_bf16 v[136:139], a[136:139], v[56:59], v[136:139]
v_exp_f32 v168, v168
v_mfma_f32_16x16x32_bf16 v[136:139], a[140:143], v[60:63], v[136:139]
ds_read_b128 a[244:247], v2 offset:13312
v_cvt_pk_bf16_f32 v210, v176, v177
v_mfma_f32_16x16x32_bf16 v[152:155], a[156:159], v[60:63], v[88:91]
v_exp_f32 v169, v169
v_mfma_f32_16x16x32_bf16 v[152:155], a[152:155], v[56:59], v[152:155]
v_exp_f32 v170, v170
v_mfma_f32_16x16x32_bf16 v[152:155], a[148:151], v[52:55], v[152:155]
ds_read_b128 a[248:251], v2 offset:14336
v_cvt_pk_bf16_f32 v211, v178, v179
v_mfma_f32_16x16x32_bf16 v[152:155], a[144:147], v[48:51], v[152:155]
v_exp_f32 v171, v171
v_mfma_f32_16x16x32_bf16 v[132:135], a[132:135], v[36:39], v[132:135]
v_exp_f32 v184, v184
v_mfma_f32_16x16x32_bf16 v[132:135], a[136:139], v[40:43], v[132:135]
ds_read_b128 a[252:255], v2 offset:15360
v_cvt_pk_bf16_f32 v216, v168, v169
v_mfma_f32_16x16x32_bf16 v[132:135], a[140:143], v[44:47], v[132:135]
buffer_load_dwordx4 v1, s[44:47], s72 offen offset:3072 sc1 lds
v_mfma_f32_16x16x32_bf16 v[140:143], a[140:143], v[76:79], v[92:95]
v_exp_f32 v185, v185
v_mfma_f32_16x16x32_bf16 v[140:143], a[136:139], v[72:75], v[140:143]
v_exp_f32 v186, v186
v_mfma_f32_16x16x32_bf16 v[140:143], a[132:135], v[68:71], v[140:143]
v_cvt_pk_bf16_f32 v217, v170, v171
v_cvt_pk_bf16_f32 v218, v184, v185
v_mfma_f32_16x16x32_bf16 v[140:143], a[128:131], v[64:67], v[140:143]
v_exp_f32 v187, v187
v_mfma_f32_16x16x32_bf16 v[156:159], a[144:147], v[64:67], v[92:95]
v_cvt_pk_bf16_f32 v219, v186, v187
v_add_u32 v2, s82, v1
v_mfma_f32_16x16x32_bf16 v[156:159], a[148:151], v[68:71], v[156:159]
v_mfma_f32_16x16x32_bf16 v[156:159], a[152:155], v[72:75], v[156:159]
v_mfma_f32_16x16x32_bf16 v[156:159], a[156:159], v[76:79], v[156:159]
v_mfma_f32_16x16x32_bf16 v[148:151], a[156:159], v[44:47], v[148:151]
v_mfma_f32_16x16x32_bf16 v[148:151], a[152:155], v[40:43], v[148:151]
s_waitcnt vmcnt(8) lgkmcnt(4)
v_mfma_f32_16x16x32_bf16 v[148:151], a[148:151], v[36:39], v[148:151]
s_barrier
s_cmp_eq_u32 s60, 7
s_cbranch_scc1 LLT3x
LLT3:
Lstub4:
s_cbranch_execz Lstub8
v_mfma_f32_16x16x32_bf16 v[228:231], v[120:123], v[196:199], v[228:231]
s_xor_b32 s74, s82, 0x10000
v_exp_f32 v136, v136
v_mfma_f32_16x16x32_bf16 v[228:231], v[120:123], v[212:215], v[228:231]
s_add_u32 s74, s74, s64
ds_read_b128 a[128:131], v2 offset:16384
v_mfma_f32_16x16x32_bf16 v[236:239], v[120:123], v[204:207], v[236:239]
s_add_u32 s81, s81, 0x8000
v_exp_f32 v137, v137
v_mfma_f32_16x16x32_bf16 v[236:239], v[120:123], v[220:223], v[236:239]
s_add_u32 m0, s74, 16384
ds_read_b128 a[132:135], v2 offset:17408
v_cvt_pk_bf16_f32 v200, v136, v137
v_mfma_f32_16x16x32_bf16 a[32:35], a[192:195], v[196:199], a[32:35]
s_add_u32 s72, s81, 16384
buffer_load_dwordx4 v1, s[44:47], s72 offen sc1 lds
v_mfma_f32_16x16x32_bf16 a[32:35], a[224:227], v[212:215], a[32:35]
s_add_u32 s69, s93, 0x3e00000
v_exp_f32 v138, v138
v_mfma_f32_16x16x32_bf16 a[96:99], a[224:227], v[220:223], a[96:99]
v_exp_f32 v139, v139
v_mfma_f32_16x16x32_bf16 a[96:99], a[192:195], v[204:207], a[96:99]
ds_read_b128 a[136:139], v2 offset:18432
v_cvt_pk_bf16_f32 v201, v138, v139
v_mfma_f32_16x16x32_bf16 a[100:103], a[196:199], v[204:207], a[100:103]
v_exp_f32 v152, v152
v_mfma_f32_16x16x32_bf16 a[100:103], a[228:231], v[220:223], a[100:103]
ds_read_b128 a[140:143], v2 offset:19456
v_and_b32 v240, 15, v0
v_mfma_f32_16x16x32_bf16 a[36:39], a[228:231], v[212:215], a[36:39]
buffer_store_dwordx4 v[112:115], v1, s[44:47], s69 offen sc1
v_mfma_f32_16x16x32_bf16 a[36:39], a[196:199], v[196:199], a[36:39]
v_exp_f32 v153, v153
v_mfma_f32_16x16x32_bf16 a[40:43], a[200:203], v[196:199], a[40:43]
v_exp_f32 v154, v154
v_mfma_f32_16x16x32_bf16 a[40:43], a[232:235], v[212:215], a[40:43]
ds_read_b128 a[144:147], v2 offset:20480
v_cvt_pk_bf16_f32 v202, v152, v153
v_mfma_f32_16x16x32_bf16 a[104:107], a[232:235], v[220:223], a[104:107]
v_exp_f32 v155, v155
v_mfma_f32_16x16x32_bf16 a[104:107], a[200:203], v[204:207], a[104:107]
ds_read_b128 a[148:151], v2 offset:21504
v_cvt_pk_bf16_f32 v203, v154, v155
v_mfma_f32_16x16x32_bf16 a[108:111], a[204:207], v[204:207], a[108:111]
buffer_load_dwordx4 v1, s[44:47], s72 offen offset:1024 sc1 lds
v_mfma_f32_16x16x32_bf16 a[108:111], a[236:239], v[220:223], a[108:111]
v_exp_f32 v132, v132
v_mfma_f32_16x16x32_bf16 a[44:47], a[236:239], v[212:215], a[44:47]
v_exp_f32 v133, v133
v_mfma_f32_16x16x32_bf16 a[44:47], a[204:207], v[196:199], a[44:47]
ds_read_b128 a[152:155], v2 offset:22528
v_lshrrev_b32 v241, 4, v0
v_mfma_f32_16x16x32_bf16 a[48:51], a[208:211], v[196:199], a[48:51]
s_waitcnt lgkmcnt(7)
v_exp_f32 v134, v134
v_mfma_f32_16x16x32_bf16 a[48:51], a[240:243], v[212:215], a[48:51]
ds_read_b128 a[156:159], v2 offset:23552
v_add_u32 v248, 1, v240
v_mfma_f32_16x16x32_bf16 a[112:115], a[240:243], v[220:223], a[112:115]
buffer_store_dwordx4 v[112:115], v1, s[44:47], s69 offen offset:1024 sc1
v_mfma_f32_16x16x32_bf16 a[112:115], a[208:211], v[204:207], a[112:115]
v_exp_f32 v135, v135
v_mfma_f32_16x16x32_bf16 a[116:119], a[212:215], v[204:207], a[116:119]
v_exp_f32 v148, v148
v_mfma_f32_16x16x32_bf16 a[116:119], a[244:247], v[220:223], a[116:119]
ds_read_b128 a[192:195], v2 offset:0
v_and_b32 v249, 3, v248
v_mfma_f32_16x16x32_bf16 a[52:55], a[244:247], v[212:215], a[52:55]
v_exp_f32 v149, v149
v_mfma_f32_16x16x32_bf16 a[52:55], a[212:215], v[196:199], a[52:55]
ds_read_b128 a[196:199], v2 offset:1024
v_lshrrev_b32 v248, 2, v248
v_mfma_f32_16x16x32_bf16 a[56:59], a[216:219], v[196:199], a[56:59]
buffer_load_dwordx4 v1, s[44:47], s72 offen offset:2048 sc1 lds
v_mfma_f32_16x16x32_bf16 a[56:59], a[248:251], v[212:215], a[56:59]
v_exp_f32 v150, v150
v_mfma_f32_16x16x32_bf16 a[120:123], a[248:251], v[220:223], a[120:123]
v_exp_f32 v151, v151
v_mfma_f32_16x16x32_bf16 a[120:123], a[216:219], v[204:207], a[120:123]
ds_read_b128 a[200:203], v2 offset:2048
v_mov_b32 v250, 0x20000
v_mfma_f32_16x16x32_bf16 a[124:127], a[220:223], v[204:207], a[124:127]
v_exp_f32 v140, v140
v_mfma_f32_16x16x32_bf16 a[124:127], a[252:255], v[220:223], a[124:127]
ds_read_b128 a[204:207], v2 offset:3072
v_mov_b32 v252, 0x20001
v_mfma_f32_16x16x32_bf16 a[60:63], a[252:255], v[212:215], a[60:63]
buffer_store_dwordx4 v[112:115], v1, s[44:47], s69 offen offset:2048 sc1
v_mfma_f32_16x16x32_bf16 a[60:63], a[220:223], v[196:199], a[60:63]
ds_read_b128 a[208:211], v2 offset:4096
v_cvt_pk_bf16_f32 v196, v132, v133
s_cmp_eq_u32 s58, 2
s_cbranch_scc1 Lta25
s_cmp_eq_u32 s58, 3
s_cbranch_scc1 Lnt26
v_mfma_f32_16x16x32_bf16 v[164:167], a[160:163], v[32:35], v[112:115]
ds_read_b128 a[212:215], v2 offset:5120
v_cvt_pk_bf16_f32 v197, v134, v135
v_mfma_f32_16x16x32_bf16 v[180:183], a[176:179], v[32:35], v[112:115]
ds_read_b128 a[216:219], v2 offset:6144
v_cvt_pk_bf16_f32 v198, v148, v149
s_branch Ljoin27
Lta25:
v_mfma_f32_16x16x32_bf16 v[164:167], a[160:163], v[32:35], v[100:103]
ds_read_b128 a[212:215], v2 offset:5120
v_cvt_pk_bf16_f32 v197, v134, v135
v_mfma_f32_16x16x32_bf16 v[180:183], a[176:179], v[32:35], v[112:115]
ds_read_b128 a[216:219], v2 offset:6144
v_cvt_pk_bf16_f32 v198, v148, v149
s_branch Ljoin27
Lnt26:
v_mfma_f32_16x16x32_bf16 v[164:167], a[160:163], v[32:35], v[84:87]
ds_read_b128 a[212:215], v2 offset:5120
v_cvt_pk_bf16_f32 v197, v134, v135
v_mfma_f32_16x16x32_bf16 v[180:183], a[176:179], v[32:35], v[100:103]
ds_read_b128 a[216:219], v2 offset:6144
v_cvt_pk_bf16_f32 v198, v148, v149
Ljoin27:
v_mfma_f32_16x16x32_bf16 v[164:167], a[164:167], v[36:39], v[164:167]
v_exp_f32 v141, v141
v_mfma_f32_16x16x32_bf16 v[164:167], a[168:171], v[40:43], v[164:167]
v_exp_f32 v142, v142
v_mfma_f32_16x16x32_bf16 v[164:167], a[172:175], v[44:47], v[164:167]
ds_read_b128 a[220:223], v2 offset:7168
v_cvt_pk_bf16_f32 v199, v150, v151
v_mfma_f32_16x16x32_bf16 v[172:175], a[172:175], v[76:79], v[92:95]
v_exp_f32 v143, v143
v_mfma_f32_16x16x32_bf16 v[172:175], a[168:171], v[72:75], v[172:175]
buffer_load_dwordx4 v1, s[44:47], s72 offen offset:3072 sc1 lds
v_mfma_f32_16x16x32_bf16 v[172:175], a[164:167], v[68:71], v[172:175]
v_exp_f32 v156, v156
v_mfma_f32_16x16x32_bf16 v[172:175], a[160:163], v[64:67], v[172:175]
v_cvt_pk_bf16_f32 v204, v140, v141
v_cvt_pk_bf16_f32 v205, v142, v143
v_mfma_f32_16x16x32_bf16 v[188:191], a[176:179], v[64:67], v[92:95]
v_exp_f32 v157, v157
v_mfma_f32_16x16x32_bf16 v[188:191], a[180:183], v[68:71], v[188:191]
v_exp_f32 v158, v158
v_mfma_f32_16x16x32_bf16 v[188:191], a[184:187], v[72:75], v[188:191]
buffer_store_dwordx4 v[112:115], v1, s[44:47], s69 offen offset:3072 sc1
v_mfma_f32_16x16x32_bf16 v[188:191], a[188:191], v[76:79], v[188:191]
v_exp_f32 v159, v159
v_mfma_f32_16x16x32_bf16 v[180:183], a[188:191], v[44:47], v[180:183]
v_cvt_pk_bf16_f32 v206, v156, v157
v_cvt_pk_bf16_f32 v207, v158, v159
v_mfma_f32_16x16x32_bf16 v[180:183], a[184:187], v[40:43], v[180:183]
v_lshlrev_b32 v6, 3, v249
v_lshrrev_b32 v6, v6, v252
v_mfma_f32_16x16x32_bf16 v[180:183], a[180:183], v[36:39], v[180:183]
v_and_b32 v6, 3, v6
v_cmp_ne_u32 vcc, 1, v249
v_mfma_f32_16x16x32_bf16 v[168:171], a[160:163], v[48:51], v[88:91]
v_mul_u32_u24 v6, 16640, v6
v_add_u32 v6, s92, v6
v_mfma_f32_16x16x32_bf16 v[168:171], a[164:167], v[52:55], v[168:171]
v_cndmask_b32 v6, v250, v6, vcc
v_add_u32 v253, s58, v249
v_mfma_f32_16x16x32_bf16 v[168:171], a[168:171], v[56:59], v[168:171]
v_and_b32 v253, 3, v253
v_mul_u32_u24 v253, 4160, v253
v_mfma_f32_16x16x32_bf16 v[168:171], a[172:175], v[60:63], v[168:171]
v_add_u32 v6, v6, v253
v_bfe_u32 v251, v0, 2, 2
v_mfma_f32_16x16x32_bf16 v[184:187], a[188:191], v[60:63], v[88:91]
v_lshl_add_u32 v6, v248, 3, v6
v_lshl_add_u32 v6, v241, 4, v6
v_mfma_f32_16x16x32_bf16 v[184:187], a[184:187], v[56:59], v[184:187]
v_lshlrev_b32 v5, 3, v251
v_lshrrev_b32 v5, v5, v252
v_mfma_f32_16x16x32_bf16 v[184:187], a[180:183], v[52:55], v[184:187]
v_and_b32 v5, 3, v5
v_cmp_ne_u32 vcc, 1, v251
v_mfma_f32_16x16x32_bf16 v[184:187], a[176:179], v[48:51], v[184:187]
s_waitcnt lgkmcnt(4)
v_mfma_f32_16x16x32_bf16 v[224:227], v[120:123], v[208:211], v[224:227]
s_add_u32 s82, s82, 0x8000
ds_read_b128 a[160:163], v2 offset:24576
ds_read_b128 a[164:167], v2 offset:25600
v_mfma_f32_16x16x32_bf16 v[232:235], v[120:123], v[216:219], v[232:235]
s_and_b32 s82, s82, 0x1ffff
v_exp_f32 v164, v164
v_mfma_f32_16x16x32_bf16 v[232:235], v[120:123], v[200:203], v[232:235]
s_add_u32 m0, s74, 0
v_exp_f32 v165, v165
v_mfma_f32_16x16x32_bf16 a[0:3], a[224:227], v[208:211], a[0:3]
s_add_u32 s72, s81, 0
v_exp_f32 v166, v166
v_mfma_f32_16x16x32_bf16 a[64:67], a[192:195], v[200:203], a[64:67]
ds_read_b128 a[168:171], v2 offset:26624
v_cvt_pk_bf16_f32 v212, v164, v165
v_mfma_f32_16x16x32_bf16 a[64:67], a[224:227], v[216:219], a[64:67]
v_exp_f32 v167, v167
v_mfma_f32_16x16x32_bf16 a[68:71], a[228:231], v[216:219], a[68:71]
buffer_load_dwordx4 v1, s[44:47], s72 offen sc1 lds
v_mfma_f32_16x16x32_bf16 a[68:71], a[196:199], v[200:203], a[68:71]
v_exp_f32 v180, v180
v_mfma_f32_16x16x32_bf16 a[4:7], a[228:231], v[208:211], a[4:7]
ds_read_b128 a[172:175], v2 offset:27648
v_cvt_pk_bf16_f32 v213, v166, v167
v_mfma_f32_16x16x32_bf16 a[8:11], a[232:235], v[208:211], a[8:11]
v_exp_f32 v181, v181
v_mfma_f32_16x16x32_bf16 a[72:75], a[200:203], v[200:203], a[72:75]
ds_read_b128 a[176:179], v2 offset:28672
v_cvt_pk_bf16_f32 v214, v180, v181
v_mfma_f32_16x16x32_bf16 a[72:75], a[232:235], v[216:219], a[72:75]
v_exp_f32 v182, v182
v_mfma_f32_16x16x32_bf16 a[76:79], a[236:239], v[216:219], a[76:79]
v_exp_f32 v183, v183
v_mfma_f32_16x16x32_bf16 a[76:79], a[204:207], v[200:203], a[76:79]
ds_read_b128 a[180:183], v2 offset:29696
v_cvt_pk_bf16_f32 v215, v182, v183
v_mfma_f32_16x16x32_bf16 a[12:15], a[236:239], v[208:211], a[12:15]
v_exp_f32 v172, v172
v_mfma_f32_16x16x32_bf16 a[16:19], a[240:243], v[208:211], a[16:19]
s_waitcnt lgkmcnt(6)
ds_read_b128 a[184:187], v2 offset:30720
ds_read_b128 a[188:191], v2 offset:31744
v_mfma_f32_16x16x32_bf16 a[80:83], a[208:211], v[200:203], a[80:83]
v_exp_f32 v173, v173
v_mfma_f32_16x16x32_bf16 a[80:83], a[240:243], v[216:219], a[80:83]
buffer_load_dwordx4 v1, s[44:47], s72 offen offset:1024 sc1 lds
v_mfma_f32_16x16x32_bf16 a[84:87], a[244:247], v[216:219], a[84:87]
v_exp_f32 v174, v174
v_mfma_f32_16x16x32_bf16 a[84:87], a[212:215], v[200:203], a[84:87]
v_exp_f32 v175, v175
v_mfma_f32_16x16x32_bf16 a[20:23], a[244:247], v[208:211], a[20:23]
ds_read_b128 a[224:227], v2 offset:8192
v_cvt_pk_bf16_f32 v220, v172, v173
v_mfma_f32_16x16x32_bf16 a[24:27], a[248:251], v[208:211], a[24:27]
v_exp_f32 v188, v188
v_mfma_f32_16x16x32_bf16 a[88:91], a[216:219], v[200:203], a[88:91]
v_exp_f32 v189, v189
v_mfma_f32_16x16x32_bf16 a[88:91], a[248:251], v[216:219], a[88:91]
ds_read_b128 a[228:231], v2 offset:9216
v_cvt_pk_bf16_f32 v221, v174, v175
v_mfma_f32_16x16x32_bf16 a[92:95], a[252:255], v[216:219], a[92:95]
v_exp_f32 v190, v190
v_mfma_f32_16x16x32_bf16 a[92:95], a[220:223], v[200:203], a[92:95]
ds_read_b128 a[232:235], v2 offset:10240
v_cvt_pk_bf16_f32 v222, v188, v189
v_mfma_f32_16x16x32_bf16 a[28:31], a[252:255], v[208:211], a[28:31]
v_exp_f32 v191, v191
v_mfma_f32_16x16x32_bf16 v[136:139], a[128:131], v[48:51], v[88:91]
buffer_load_dwordx4 v1, s[44:47], s72 offen offset:2048 sc1 lds
v_mfma_f32_16x16x32_bf16 v[136:139], a[132:135], v[52:55], v[136:139]
v_exp_f32 v168, v168
v_mfma_f32_16x16x32_bf16 v[136:139], a[136:139], v[56:59], v[136:139]
ds_read_b128 a[236:239], v2 offset:11264
v_cvt_pk_bf16_f32 v223, v190, v191
v_mfma_f32_16x16x32_bf16 v[136:139], a[140:143], v[60:63], v[136:139]
v_exp_f32 v169, v169
v_mfma_f32_16x16x32_bf16 v[152:155], a[156:159], v[60:63], v[88:91]
ds_read_b128 a[240:243], v2 offset:12288
v_cvt_pk_bf16_f32 v216, v168, v169
v_mfma_f32_16x16x32_bf16 v[152:155], a[152:155], v[56:59], v[152:155]
v_exp_f32 v170, v170
v_mfma_f32_16x16x32_bf16 v[152:155], a[148:151], v[52:55], v[152:155]
v_exp_f32 v171, v171
v_mfma_f32_16x16x32_bf16 v[152:155], a[144:147], v[48:51], v[152:155]
ds_read_b128 a[244:247], v2 offset:13312
v_cvt_pk_bf16_f32 v217, v170, v171
v_mfma_f32_16x16x32_bf16 v[140:143], a[128:131], v[64:67], v[92:95]
v_exp_f32 v184, v184
v_mfma_f32_16x16x32_bf16 v[140:143], a[132:135], v[68:71], v[140:143]
ds_read_b128 a[248:251], v2 offset:14336
v_mfma_f32_16x16x32_bf16 v[140:143], a[136:139], v[72:75], v[140:143]
v_exp_f32 v185, v185
v_mfma_f32_16x16x32_bf16 v[140:143], a[140:143], v[76:79], v[140:143]
buffer_load_dwordx4 v1, s[44:47], s72 offen offset:3072 sc1 lds
v_mfma_f32_16x16x32_bf16 v[156:159], a[156:159], v[76:79], v[92:95]
ds_read_b128 a[252:255], v2 offset:15360
v_cvt_pk_bf16_f32 v218, v184, v185
v_mfma_f32_16x16x32_bf16 v[156:159], a[152:155], v[72:75], v[156:159]
v_exp_f32 v186, v186
v_mfma_f32_16x16x32_bf16 v[156:159], a[148:151], v[68:71], v[156:159]
s_waitcnt vmcnt(12) lgkmcnt(4)
v_exp_f32 v187, v187
v_mfma_f32_16x16x32_bf16 v[156:159], a[144:147], v[64:67], v[156:159]
s_barrier
v_cvt_pk_bf16_f32 v219, v186, v187
v_add_u32 v2, s82, v1
v_mfma_f32_16x16x32_bf16 v[228:231], v[120:123], v[196:199], v[228:231]
s_xor_b32 s74, s82, 0x10000
v_exp_f32 v136, v136
v_mfma_f32_16x16x32_bf16 v[228:231], v[120:123], v[212:215], v[228:231]
s_add_u32 s74, s74, s64
ds_read_b128 a[128:131], v2 offset:16384
v_mfma_f32_16x16x32_bf16 v[236:239], v[120:123], v[204:207], v[236:239]
s_add_u32 s81, s81, 0x8000
v_exp_f32 v137, v137
v_mfma_f32_16x16x32_bf16 v[236:239], v[120:123], v[220:223], v[236:239]
s_add_u32 m0, s74, 16384
ds_read_b128 a[132:135], v2 offset:17408
v_cvt_pk_bf16_f32 v200, v136, v137
v_mfma_f32_16x16x32_bf16 a[32:35], a[192:195], v[196:199], a[32:35]
s_add_u32 s72, s81, 16384
buffer_load_dwordx4 v1, s[44:47], s72 offen sc1 lds
v_mfma_f32_16x16x32_bf16 a[32:35], a[224:227], v[212:215], a[32:35]
s_add_u32 s69, s93, 0x4200000
v_exp_f32 v138, v138
v_mfma_f32_16x16x32_bf16 a[96:99], a[224:227], v[220:223], a[96:99]
ds_read_b128 a[136:139], v2 offset:18432
v_mul_u32_u24 v5, 16640, v5
v_mfma_f32_16x16x32_bf16 a[96:99], a[192:195], v[204:207], a[96:99]
v_exp_f32 v139, v139
v_mfma_f32_16x16x32_bf16 a[100:103], a[196:199], v[204:207], a[100:103]
ds_read_b128 a[140:143], v2 offset:19456
v_cvt_pk_bf16_f32 v201, v138, v139
v_mfma_f32_16x16x32_bf16 a[100:103], a[228:231], v[220:223], a[100:103]
buffer_store_dwordx4 v[112:115], v1, s[44:47], s69 offen sc1
v_mfma_f32_16x16x32_bf16 a[36:39], a[228:231], v[212:215], a[36:39]
v_exp_f32 v152, v152
v_mfma_f32_16x16x32_bf16 a[36:39], a[196:199], v[196:199], a[36:39]
ds_read_b128 a[144:147], v2 offset:20480
v_add_u32 v5, s92, v5
v_mfma_f32_16x16x32_bf16 a[40:43], a[200:203], v[196:199], a[40:43]
v_exp_f32 v153, v153
v_mfma_f32_16x16x32_bf16 a[40:43], a[232:235], v[212:215], a[40:43]
ds_read_b128 a[148:151], v2 offset:21504
v_cvt_pk_bf16_f32 v202, v152, v153
v_mfma_f32_16x16x32_bf16 a[104:107], a[232:235], v[220:223], a[104:107]
buffer_load_dwordx4 v1, s[44:47], s72 offen offset:1024 sc1 lds
v_mfma_f32_16x16x32_bf16 a[104:107], a[200:203], v[204:207], a[104:107]
v_exp_f32 v154, v154
v_mfma_f32_16x16x32_bf16 a[108:111], a[204:207], v[204:207], a[108:111]
ds_read_b128 a[152:155], v2 offset:22528
v_cndmask_b32 v5, v250, v5, vcc
v_mfma_f32_16x16x32_bf16 a[108:111], a[236:239], v[220:223], a[108:111]
v_exp_f32 v155, v155
v_mfma_f32_16x16x32_bf16 a[44:47], a[236:239], v[212:215], a[44:47]
ds_read_b128 a[156:159], v2 offset:23552
v_cvt_pk_bf16_f32 v203, v154, v155
v_mfma_f32_16x16x32_bf16 a[44:47], a[204:207], v[196:199], a[44:47]
buffer_store_dwordx4 v[112:115], v1, s[44:47], s69 offen offset:1024 sc1
v_mfma_f32_16x16x32_bf16 a[48:51], a[208:211], v[196:199], a[48:51]
s_waitcnt lgkmcnt(8)
v_exp_f32 v140, v140
v_mfma_f32_16x16x32_bf16 a[48:51], a[240:243], v[212:215], a[48:51]
ds_read_b128 a[192:195], v2 offset:0
v_add_u32 v253, s58, v251
v_mfma_f32_16x16x32_bf16 a[112:115], a[240:243], v[220:223], a[112:115]
v_exp_f32 v141, v141
v_mfma_f32_16x16x32_bf16 a[112:115], a[208:211], v[204:207], a[112:115]
ds_read_b128 a[196:199], v2 offset:1024
v_and_b32 v253, 3, v253
v_mfma_f32_16x16x32_bf16 a[116:119], a[212:215], v[204:207], a[116:119]
buffer_load_dwordx4 v1, s[44:47], s72 offen offset:2048 sc1 lds
v_mfma_f32_16x16x32_bf16 a[116:119], a[244:247], v[220:223], a[116:119]
v_exp_f32 v142, v142
v_mfma_f32_16x16x32_bf16 a[52:55], a[244:247], v[212:215], a[52:55]
ds_read_b128 a[200:203], v2 offset:2048
v_mul_u32_u24 v253, 4160, v253
v_mfma_f32_16x16x32_bf16 a[52:55], a[212:215], v[196:199], a[52:55]
v_exp_f32 v143, v143
v_mfma_f32_16x16x32_bf16 a[56:59], a[216:219], v[196:199], a[56:59]
ds_read_b128 a[204:207], v2 offset:3072
v_add_u32 v5, v5, v253
v_mfma_f32_16x16x32_bf16 a[56:59], a[248:251], v[212:215], a[56:59]
s_add_u32 s73, s62, 480
buffer_store_dwordx4 v[112:115], v1, s[44:47], s69 offen offset:2048 sc1
v_mfma_f32_16x16x32_bf16 a[120:123], a[248:251], v[220:223], a[120:123]
v_exp_f32 v156, v156
v_mfma_f32_16x16x32_bf16 a[120:123], a[216:219], v[204:207], a[120:123]
ds_read_b128 a[208:211], v2 offset:4096
v_lshlrev_b32 v248, 5, v240
v_mfma_f32_16x16x32_bf16 a[124:127], a[220:223], v[204:207], a[124:127]
v_exp_f32 v157, v157
v_mfma_f32_16x16x32_bf16 a[124:127], a[252:255], v[220:223], a[124:127]
ds_read_b128 a[212:215], v2 offset:5120
v_sub_u32 v248, s73, v248
v_mfma_f32_16x16x32_bf16 a[60:63], a[252:255], v[212:215], a[60:63]
buffer_load_dwordx4 v1, s[44:47], s72 offen offset:3072 sc1 lds
v_mfma_f32_16x16x32_bf16 a[60:63], a[220:223], v[196:199], a[60:63]
ds_read_b128 a[216:219], v2 offset:6144
v_cvt_pk_bf16_f32 v204, v140, v141
v_mfma_f32_16x16x32_bf16 v[172:175], a[160:163], v[64:67], v[92:95]
v_exp_f32 v158, v158
v_mfma_f32_16x16x32_bf16 v[172:175], a[164:167], v[68:71], v[172:175]
ds_read_b128 a[220:223], v2 offset:7168
v_cvt_pk_bf16_f32 v205, v142, v143
v_mfma_f32_16x16x32_bf16 v[172:175], a[168:171], v[72:75], v[172:175]
v_exp_f32 v159, v159
v_mfma_f32_16x16x32_bf16 v[172:175], a[172:175], v[76:79], v[172:175]
buffer_store_dwordx4 v[112:115], v1, s[44:47], s69 offen offset:3072 sc1
v_mfma_f32_16x16x32_bf16 v[188:191], a[188:191], v[76:79], v[92:95]
v_cvt_pk_bf16_f32 v206, v156, v157
v_cvt_pk_bf16_f32 v207, v158, v159
v_mfma_f32_16x16x32_bf16 v[188:191], a[184:187], v[72:75], v[188:191]
v_lshl_add_u32 v7, v241, 4, v248
v_mfma_f32_16x16x32_bf16 v[188:191], a[180:183], v[68:71], v[188:191]
s_and_b32 s73, s58, 1
v_mfma_f32_16x16x32_bf16 v[188:191], a[176:179], v[64:67], v[188:191]
s_lshl_b32 s73, s73, 4
v_mfma_f32_16x16x32_bf16 v[168:171], a[160:163], v[48:51], v[88:91]
s_lshr_b32 s73, s90, s73
v_mfma_f32_16x16x32_bf16 v[168:171], a[164:167], v[52:55], v[168:171]
s_and_b32 s73, s73, 0xffff
v_lshl_add_u32 v248, v241, 3, v240
v_sub_u32 v248, 15, v248
v_mfma_f32_16x16x32_bf16 v[168:171], a[168:171], v[56:59], v[168:171]
v_and_b32 v249, 1, v248
v_lshlrev_b32 v249, 4, v249
v_mfma_f32_16x16x32_bf16 v[168:171], a[172:175], v[60:63], v[168:171]
v_lshlrev_b32 v249, v249, s73
v_lshrrev_b32 v248, 1, v248
v_mfma_f32_16x16x32_bf16 v[184:187], a[188:191], v[60:63], v[88:91]
v_and_b32 v241, 3, v0
v_cmp_eq_u32 vcc, 0, v248
v_mfma_f32_16x16x32_bf16 v[184:187], a[184:187], v[56:59], v[184:187]
v_lshl_add_u32 v5, v241, 3, v5
v_cndmask_b32 v8, 0, v249, vcc
v_mfma_f32_16x16x32_bf16 v[184:187], a[180:183], v[52:55], v[184:187]
v_cmp_eq_u32 vcc, 1, v248
v_lshlrev_b32 v240, 4, v251
v_mfma_f32_16x16x32_bf16 v[184:187], a[176:179], v[48:51], v[184:187]
s_waitcnt lgkmcnt(4)
v_cndmask_b32 v9, 0, v249, vcc
v_cmp_eq_u32 vcc, 2, v248
v_sub_u32 v240, 48, v240
v_lshlrev_b64 v[12:13], 16, s[88:89]
v_cndmask_b32 v10, 0, v249, vcc
v_cmp_eq_u32 vcc, 3, v248
v_lshlrev_b64 v[12:13], v240, v[12:13]
s_nop 0
v_cndmask_b32 v11, 0, v249, vcc
v_cmp_eq_u32 vcc, 3, v241
s_add_u32 s73, s62, 4096
v_lshl_add_u32 v14, v0, 3, s73
v_cndmask_b32 v12, 0, v12, vcc
v_cndmask_b32 v13, 0, v13, vcc
v_lshrrev_b32 v15, 4, v0
v_lshlrev_b32 v15, 1, v15
v_and_b32 v240, 7, v0
v_xor_b32 v15, v15, v240
v_lshlrev_b32 v15, 4, v15
v_lshrrev_b32 v240, 3, v0
v_lshl_add_u32 v15, v240, 11, v15
s_lshr_b32 s75, s59, 1
s_and_b32 s75, s75, 8
s_add_u32 s75, s75, s60
s_lshl_b32 s76, s65, 2
s_lshr_b32 s80, s59, 2
s_and_b32 s80, s80, 3
s_add_u32 s76, s76, s80
s_lshl_b32 s94, s58, 16
s_lshl_b32 s80, s76, 7
s_add_u32 s94, s94, s80
s_lshl_b32 s80, s75, 18
s_add_u32 s80, s80, s94
v_rcp_f32 v224, v224
v_rcp_f32 v228, v228
s_lshl_b32 s73, s59, 12
s_add_u32 s73, s73, 0x2000000
s_lshl_b32 s70, s67, 2
s_add_u32 s70, s70, s73
v_mov_b32 v225, v224
v_accvgpr_read_b32 v240, a0
v_accvgpr_read_b32 v241, a1
v_accvgpr_read_b32 v242, a2
v_accvgpr_read_b32 v243, a3
v_accvgpr_read_b32 v244, a4
v_accvgpr_read_b32 v245, a5
v_accvgpr_read_b32 v246, a6
v_accvgpr_read_b32 v247, a7
v_pk_mul_f32 v[240:241], v[240:241], v[224:225]
v_pk_mul_f32 v[242:243], v[242:243], v[224:225]
v_pk_mul_f32 v[244:245], v[244:245], v[224:225]
v_pk_mul_f32 v[246:247], v[246:247], v[224:225]
v_cvt_pk_bf16_f32 v128, v240, v241
v_cvt_pk_bf16_f32 v129, v242, v243
v_cvt_pk_bf16_f32 v130, v244, v245
v_cvt_pk_bf16_f32 v131, v246, v247
v_accvgpr_read_b32 v248, a8
v_accvgpr_read_b32 v249, a9
v_accvgpr_read_b32 v250, a10
v_accvgpr_read_b32 v251, a11
v_accvgpr_read_b32 v252, a12
v_accvgpr_read_b32 v253, a13
v_accvgpr_read_b32 v254, a14
v_accvgpr_read_b32 v255, a15
v_pk_mul_f32 v[248:249], v[248:249], v[224:225]
v_pk_mul_f32 v[250:251], v[250:251], v[224:225]
v_pk_mul_f32 v[252:253], v[252:253], v[224:225]
v_pk_mul_f32 v[254:255], v[254:255], v[224:225]
v_cvt_pk_bf16_f32 v144, v248, v249
v_cvt_pk_bf16_f32 v145, v250, v251
v_cvt_pk_bf16_f32 v146, v252, v253
v_cvt_pk_bf16_f32 v147, v254, v255
v_accvgpr_read_b32 v240, a16
v_accvgpr_read_b32 v241, a17
v_accvgpr_read_b32 v242, a18
v_accvgpr_read_b32 v243, a19
v_accvgpr_read_b32 v244, a20
v_accvgpr_read_b32 v245, a21
v_accvgpr_read_b32 v246, a22
v_accvgpr_read_b32 v247, a23
v_pk_mul_f32 v[240:241], v[240:241], v[224:225]
v_pk_mul_f32 v[242:243], v[242:243], v[224:225]
v_pk_mul_f32 v[244:245], v[244:245], v[224:225]
v_pk_mul_f32 v[246:247], v[246:247], v[224:225]
v_cvt_pk_bf16_f32 v160, v240, v241
v_cvt_pk_bf16_f32 v161, v242, v243
v_cvt_pk_bf16_f32 v162, v244, v245
v_cvt_pk_bf16_f32 v163, v246, v247
v_accvgpr_read_b32 v248, a24
v_accvgpr_read_b32 v249, a25
v_accvgpr_read_b32 v250, a26
v_accvgpr_read_b32 v251, a27
v_accvgpr_read_b32 v252, a28
v_accvgpr_read_b32 v253, a29
v_accvgpr_read_b32 v254, a30
v_accvgpr_read_b32 v255, a31
v_pk_mul_f32 v[248:249], v[248:249], v[224:225]
v_pk_mul_f32 v[250:251], v[250:251], v[224:225]
v_pk_mul_f32 v[252:253], v[252:253], v[224:225]
v_pk_mul_f32 v[254:255], v[254:255], v[224:225]
v_cvt_pk_bf16_f32 v176, v248, v249
v_cvt_pk_bf16_f32 v177, v250, v251
v_cvt_pk_bf16_f32 v178, v252, v253
v_cvt_pk_bf16_f32 v179, v254, v255
v_mov_b32 v229, v228
v_accvgpr_read_b32 v240, a32
v_accvgpr_read_b32 v241, a33
v_accvgpr_read_b32 v242, a34
v_accvgpr_read_b32 v243, a35
v_accvgpr_read_b32 v244, a36
v_accvgpr_read_b32 v245, a37
v_accvgpr_read_b32 v246, a38
v_accvgpr_read_b32 v247, a39
v_pk_mul_f32 v[240:241], v[240:241], v[228:229]
v_pk_mul_f32 v[242:243], v[242:243], v[228:229]
v_pk_mul_f32 v[244:245], v[244:245], v[228:229]
v_pk_mul_f32 v[246:247], v[246:247], v[228:229]
v_cvt_pk_bf16_f32 v132, v240, v241
v_cvt_pk_bf16_f32 v133, v242, v243
v_cvt_pk_bf16_f32 v134, v244, v245
v_cvt_pk_bf16_f32 v135, v246, v247
v_accvgpr_read_b32 v248, a40
v_accvgpr_read_b32 v249, a41
v_accvgpr_read_b32 v250, a42
v_accvgpr_read_b32 v251, a43
v_accvgpr_read_b32 v252, a44
v_accvgpr_read_b32 v253, a45
v_accvgpr_read_b32 v254, a46
v_accvgpr_read_b32 v255, a47
Lstub5:
s_cbranch_execz Lstub9
v_pk_mul_f32 v[248:249], v[248:249], v[228:229]
v_pk_mul_f32 v[250:251], v[250:251], v[228:229]
v_pk_mul_f32 v[252:253], v[252:253], v[228:229]
v_pk_mul_f32 v[254:255], v[254:255], v[228:229]
v_cvt_pk_bf16_f32 v148, v248, v249
v_cvt_pk_bf16_f32 v149, v250, v251
v_cvt_pk_bf16_f32 v150, v252, v253
v_cvt_pk_bf16_f32 v151, v254, v255
v_accvgpr_read_b32 v240, a48
v_accvgpr_read_b32 v241, a49
v_accvgpr_read_b32 v242, a50
v_accvgpr_read_b32 v243, a51
v_accvgpr_read_b32 v244, a52
v_accvgpr_read_b32 v245, a53
v_accvgpr_read_b32 v246, a54
v_accvgpr_read_b32 v247, a55
v_pk_mul_f32 v[240:241], v[240:241], v[228:229]
v_pk_mul_f32 v[242:243], v[242:243], v[228:229]
v_pk_mul_f32 v[244:245], v[244:245], v[228:229]
v_pk_mul_f32 v[246:247], v[246:247], v[228:229]
v_cvt_pk_bf16_f32 v164, v240, v241
v_cvt_pk_bf16_f32 v165, v242, v243
v_cvt_pk_bf16_f32 v166, v244, v245
v_cvt_pk_bf16_f32 v167, v246, v247
v_accvgpr_read_b32 v248, a56
v_accvgpr_read_b32 v249, a57
v_accvgpr_read_b32 v250, a58
v_accvgpr_read_b32 v251, a59
v_accvgpr_read_b32 v252, a60
v_accvgpr_read_b32 v253, a61
v_accvgpr_read_b32 v254, a62
v_accvgpr_read_b32 v255, a63
v_pk_mul_f32 v[248:249], v[248:249], v[228:229]
v_pk_mul_f32 v[250:251], v[250:251], v[228:229]
v_pk_mul_f32 v[252:253], v[252:253], v[228:229]
v_pk_mul_f32 v[254:255], v[254:255], v[228:229]
v_cvt_pk_bf16_f32 v180, v248, v249
v_cvt_pk_bf16_f32 v181, v250, v251
v_cvt_pk_bf16_f32 v182, v252, v253
v_cvt_pk_bf16_f32 v183, v254, v255
v_mfma_f32_16x16x32_bf16 v[232:235], v[120:123], v[216:219], v[232:235]
s_add_u32 s82, s82, 0x8000
ds_read_b128 a[160:163], v2 offset:24576
ds_read_b128 a[164:167], v2 offset:25600
v_mfma_f32_16x16x32_bf16 v[232:235], v[120:123], v[200:203], v[232:235]
s_and_b32 s82, s82, 0x1ffff
v_exp_f32 v172, v172
v_mfma_f32_16x16x32_bf16 a[64:67], a[224:227], v[216:219], a[64:67]
s_add_u32 m0, s74, 0
v_exp_f32 v173, v173
v_mfma_f32_16x16x32_bf16 a[64:67], a[192:195], v[200:203], a[64:67]
s_add_u32 s72, s81, 0
buffer_load_dwordx4 v1, s[44:47], s72 offen sc1 lds
v_mfma_f32_16x16x32_bf16 a[68:71], a[196:199], v[200:203], a[68:71]
ds_read_b128 a[168:171], v2 offset:26624
v_cvt_pk_bf16_f32 v220, v172, v173
v_mfma_f32_16x16x32_bf16 a[68:71], a[228:231], v[216:219], a[68:71]
v_exp_f32 v174, v174
v_mfma_f32_16x16x32_bf16 a[72:75], a[232:235], v[216:219], a[72:75]
ds_read_b128 a[172:175], v2 offset:27648
ds_read_b128 a[176:179], v2 offset:28672
v_mfma_f32_16x16x32_bf16 a[72:75], a[200:203], v[200:203], a[72:75]
v_exp_f32 v175, v175
v_mfma_f32_16x16x32_bf16 a[76:79], a[204:207], v[200:203], a[76:79]
v_exp_f32 v188, v188
v_mfma_f32_16x16x32_bf16 a[76:79], a[236:239], v[216:219], a[76:79]
buffer_store_dwordx4 v[128:131], v1, s[44:47], s70 offen sc1
v_mfma_f32_16x16x32_bf16 a[80:83], a[240:243], v[216:219], a[80:83]
s_waitcnt lgkmcnt(5)
ds_read_b128 a[180:183], v2 offset:29696
v_cvt_pk_bf16_f32 v221, v174, v175
v_mfma_f32_16x16x32_bf16 a[80:83], a[208:211], v[200:203], a[80:83]
v_exp_f32 v189, v189
v_mfma_f32_16x16x32_bf16 a[84:87], a[212:215], v[200:203], a[84:87]
ds_read_b128 a[184:187], v2 offset:30720
v_cvt_pk_bf16_f32 v222, v188, v189
v_mfma_f32_16x16x32_bf16 a[84:87], a[244:247], v[216:219], a[84:87]
v_exp_f32 v190, v190
v_mfma_f32_16x16x32_bf16 a[88:91], a[248:251], v[216:219], a[88:91]
buffer_load_dwordx4 v1, s[44:47], s72 offen offset:1024 sc1 lds
v_mfma_f32_16x16x32_bf16 a[88:91], a[216:219], v[200:203], a[88:91]
ds_read_b128 a[188:191], v2 offset:31744
ds_read_b128 a[224:227], v2 offset:8192
v_mfma_f32_16x16x32_bf16 a[92:95], a[220:223], v[200:203], a[92:95]
v_exp_f32 v191, v191
v_mfma_f32_16x16x32_bf16 a[92:95], a[252:255], v[216:219], a[92:95]
v_exp_f32 v168, v168
v_mfma_f32_16x16x32_bf16 v[136:139], a[128:131], v[48:51], v[88:91]
ds_read_b128 a[228:231], v2 offset:9216
v_cvt_pk_bf16_f32 v223, v190, v191
v_mfma_f32_16x16x32_bf16 v[136:139], a[132:135], v[52:55], v[136:139]
v_exp_f32 v169, v169
v_mfma_f32_16x16x32_bf16 v[136:139], a[136:139], v[56:59], v[136:139]
buffer_store_dwordx4 v[144:147], v1, s[44:47], s70 offen offset:1024 sc1
v_mfma_f32_16x16x32_bf16 v[136:139], a[140:143], v[60:63], v[136:139]
ds_read_b128 a[232:235], v2 offset:10240
v_cvt_pk_bf16_f32 v216, v168, v169
v_mfma_f32_16x16x32_bf16 v[152:155], a[156:159], v[60:63], v[88:91]
v_exp_f32 v170, v170
v_mfma_f32_16x16x32_bf16 v[152:155], a[152:155], v[56:59], v[152:155]
ds_read_b128 a[236:239], v2 offset:11264
ds_read_b128 a[240:243], v2 offset:12288
v_mfma_f32_16x16x32_bf16 v[152:155], a[148:151], v[52:55], v[152:155]
v_exp_f32 v171, v171
v_mfma_f32_16x16x32_bf16 v[152:155], a[144:147], v[48:51], v[152:155]
buffer_load_dwordx4 v1, s[44:47], s72 offen offset:2048 sc1 lds
v_mfma_f32_16x16x32_bf16 v[140:143], a[128:131], v[64:67], v[92:95]
v_exp_f32 v184, v184
v_mfma_f32_16x16x32_bf16 v[140:143], a[132:135], v[68:71], v[140:143]
ds_read_b128 a[244:247], v2 offset:13312
v_cvt_pk_bf16_f32 v217, v170, v171
v_mfma_f32_16x16x32_bf16 v[140:143], a[136:139], v[72:75], v[140:143]
v_exp_f32 v185, v185
v_mfma_f32_16x16x32_bf16 v[140:143], a[140:143], v[76:79], v[140:143]
ds_read_b128 a[248:251], v2 offset:14336
ds_read_b128 a[252:255], v2 offset:15360
v_mfma_f32_16x16x32_bf16 v[156:159], a[156:159], v[76:79], v[92:95]
v_exp_f32 v186, v186
v_mfma_f32_16x16x32_bf16 v[156:159], a[152:155], v[72:75], v[156:159]
buffer_load_dwordx4 v1, s[44:47], s72 offen offset:3072 sc1 lds
v_mfma_f32_16x16x32_bf16 v[156:159], a[148:151], v[68:71], v[156:159]
s_waitcnt vmcnt(14) lgkmcnt(4)
v_exp_f32 v187, v187
v_mfma_f32_16x16x32_bf16 v[156:159], a[144:147], v[64:67], v[156:159]
s_barrier
v_cvt_pk_bf16_f32 v218, v184, v185
v_cvt_pk_bf16_f32 v219, v186, v187
v_add_u32 v2, s82, v1
v_mfma_f32_16x16x32_bf16 v[236:239], v[120:123], v[204:207], v[236:239]
s_xor_b32 s74, s82, 0x10000
v_exp_f32 v136, v136
v_mfma_f32_16x16x32_bf16 v[236:239], v[120:123], v[220:223], v[236:239]
s_add_u32 s74, s74, s64
ds_read_b128 a[128:131], v2 offset:16384
ds_read_b128 a[132:135], v2 offset:17408
v_mfma_f32_16x16x32_bf16 a[96:99], a[192:195], v[204:207], a[96:99]
s_add_u32 s81, s81, 0x8000
v_exp_f32 v137, v137
v_mfma_f32_16x16x32_bf16 a[96:99], a[224:227], v[220:223], a[96:99]
s_add_u32 m0, s74, 16384
v_exp_f32 v138, v138
v_mfma_f32_16x16x32_bf16 a[100:103], a[228:231], v[220:223], a[100:103]
s_add_u32 s72, s81, 16384
buffer_load_dwordx4 v1, s[44:47], s72 offen sc1 lds
v_mfma_f32_16x16x32_bf16 a[100:103], a[196:199], v[204:207], a[100:103]
ds_read_b128 a[136:139], v2 offset:18432
v_cvt_pk_bf16_f32 v200, v136, v137
v_mfma_f32_16x16x32_bf16 a[104:107], a[200:203], v[204:207], a[104:107]
v_exp_f32 v139, v139
v_mfma_f32_16x16x32_bf16 a[104:107], a[232:235], v[220:223], a[104:107]
ds_read_b128 a[140:143], v2 offset:19456
v_cvt_pk_bf16_f32 v201, v138, v139
v_mfma_f32_16x16x32_bf16 a[108:111], a[236:239], v[220:223], a[108:111]
buffer_store_dwordx4 v[160:163], v1, s[44:47], s70 offen offset:2048 sc1
v_mfma_f32_16x16x32_bf16 a[108:111], a[204:207], v[204:207], a[108:111]
v_exp_f32 v152, v152
v_mfma_f32_16x16x32_bf16 a[112:115], a[208:211], v[204:207], a[112:115]
s_waitcnt lgkmcnt(4)
ds_read_b128 a[144:147], v2 offset:20480
ds_read_b128 a[148:151], v2 offset:21504
v_mfma_f32_16x16x32_bf16 a[112:115], a[240:243], v[220:223], a[112:115]
v_exp_f32 v153, v153
v_mfma_f32_16x16x32_bf16 a[116:119], a[244:247], v[220:223], a[116:119]
buffer_load_dwordx4 v1, s[44:47], s72 offen offset:1024 sc1 lds
v_mfma_f32_16x16x32_bf16 a[116:119], a[212:215], v[204:207], a[116:119]
v_exp_f32 v154, v154
v_mfma_f32_16x16x32_bf16 a[120:123], a[216:219], v[204:207], a[120:123]
ds_read_b128 a[152:155], v2 offset:22528
v_cvt_pk_bf16_f32 v202, v152, v153
v_mfma_f32_16x16x32_bf16 a[120:123], a[248:251], v[220:223], a[120:123]
v_exp_f32 v155, v155
v_mfma_f32_16x16x32_bf16 a[124:127], a[252:255], v[220:223], a[124:127]
ds_read_b128 a[156:159], v2 offset:23552
v_cvt_pk_bf16_f32 v203, v154, v155
v_mfma_f32_16x16x32_bf16 a[124:127], a[220:223], v[204:207], a[124:127]
v_exp_f32 v140, v140
v_mfma_f32_16x16x32_bf16 v[172:175], a[160:163], v[64:67], v[92:95]
ds_read_b128 a[192:195], v2 offset:0
ds_read_b128 a[196:199], v2 offset:1024
v_mfma_f32_16x16x32_bf16 v[172:175], a[164:167], v[68:71], v[172:175]
buffer_store_dwordx4 v[176:179], v1, s[44:47], s70 offen offset:3072 sc1
v_mfma_f32_16x16x32_bf16 v[172:175], a[168:171], v[72:75], v[172:175]
v_exp_f32 v141, v141
v_mfma_f32_16x16x32_bf16 v[172:175], a[172:175], v[76:79], v[172:175]
v_exp_f32 v142, v142
v_mfma_f32_16x16x32_bf16 v[188:191], a[188:191], v[76:79], v[92:95]
ds_read_b128 a[200:203], v2 offset:2048
ds_read_b128 a[204:207], v2 offset:3072
v_mfma_f32_16x16x32_bf16 v[188:191], a[184:187], v[72:75], v[188:191]
buffer_load_dwordx4 v1, s[44:47], s72 offen offset:2048 sc1 lds
v_mfma_f32_16x16x32_bf16 v[188:191], a[180:183], v[68:71], v[188:191]
s_add_u32 s70, s70, 0x80000
v_exp_f32 v143, v143
v_mfma_f32_16x16x32_bf16 v[188:191], a[176:179], v[64:67], v[188:191]
v_exp_f32 v156, v156
v_mfma_f32_16x16x32_bf16 v[168:171], a[160:163], v[48:51], v[88:91]
ds_read_b128 a[208:211], v2 offset:4096
ds_read_b128 a[212:215], v2 offset:5120
v_mfma_f32_16x16x32_bf16 v[168:171], a[164:167], v[52:55], v[168:171]
ds_read_b128 a[216:219], v2 offset:6144
ds_read_b128 a[220:223], v2 offset:7168
v_mfma_f32_16x16x32_bf16 v[168:171], a[168:171], v[56:59], v[168:171]
v_cvt_pk_bf16_f32 v204, v140, v141
v_cvt_pk_bf16_f32 v205, v142, v143
v_mfma_f32_16x16x32_bf16 v[168:171], a[172:175], v[60:63], v[168:171]
buffer_store_dwordx4 v[132:135], v1, s[44:47], s70 offen sc1
v_mfma_f32_16x16x32_bf16 v[184:187], a[188:191], v[60:63], v[88:91]
v_exp_f32 v157, v157
v_mfma_f32_16x16x32_bf16 v[184:187], a[184:187], v[56:59], v[184:187]
v_exp_f32 v158, v158
v_mfma_f32_16x16x32_bf16 v[184:187], a[180:183], v[52:55], v[184:187]
buffer_load_dwordx4 v1, s[44:47], s72 offen offset:3072 sc1 lds
v_mfma_f32_16x16x32_bf16 v[184:187], a[176:179], v[48:51], v[184:187]
s_waitcnt lgkmcnt(4)
v_exp_f32 v159, v159
v_cvt_pk_bf16_f32 v206, v156, v157
v_cvt_pk_bf16_f32 v207, v158, v159
v_mfma_f32_16x16x32_bf16 v[232:235], v[120:123], v[216:219], v[232:235]
s_add_u32 s82, s82, 0x8000
ds_read_b128 a[160:163], v2 offset:24576
ds_read_b128 a[164:167], v2 offset:25600
v_mfma_f32_16x16x32_bf16 v[232:235], v[120:123], v[200:203], v[232:235]
s_and_b32 s82, s82, 0x1ffff
v_exp_f32 v172, v172
v_mfma_f32_16x16x32_bf16 a[64:67], a[224:227], v[216:219], a[64:67]
s_add_u32 m0, s74, 0
v_exp_f32 v173, v173
v_mfma_f32_16x16x32_bf16 a[64:67], a[192:195], v[200:203], a[64:67]
s_add_u32 s72, s81, 0
buffer_load_dwordx4 v1, s[44:47], s72 offen sc1 lds
v_mfma_f32_16x16x32_bf16 a[68:71], a[196:199], v[200:203], a[68:71]
ds_read_b128 a[168:171], v2 offset:26624
v_cvt_pk_bf16_f32 v220, v172, v173
v_mfma_f32_16x16x32_bf16 a[68:71], a[228:231], v[216:219], a[68:71]
v_exp_f32 v174, v174
v_mfma_f32_16x16x32_bf16 a[72:75], a[232:235], v[216:219], a[72:75]
ds_read_b128 a[172:175], v2 offset:27648
ds_read_b128 a[176:179], v2 offset:28672
v_mfma_f32_16x16x32_bf16 a[72:75], a[200:203], v[200:203], a[72:75]
v_exp_f32 v175, v175
v_mfma_f32_16x16x32_bf16 a[76:79], a[204:207], v[200:203], a[76:79]
buffer_store_dwordx4 v[148:151], v1, s[44:47], s70 offen offset:1024 sc1
v_mfma_f32_16x16x32_bf16 a[76:79], a[236:239], v[216:219], a[76:79]
v_exp_f32 v188, v188
v_mfma_f32_16x16x32_bf16 a[80:83], a[240:243], v[216:219], a[80:83]
s_waitcnt lgkmcnt(5)
ds_read_b128 a[180:183], v2 offset:29696
v_cvt_pk_bf16_f32 v221, v174, v175
v_mfma_f32_16x16x32_bf16 a[80:83], a[208:211], v[200:203], a[80:83]
v_exp_f32 v189, v189
v_mfma_f32_16x16x32_bf16 a[84:87], a[212:215], v[200:203], a[84:87]
buffer_load_dwordx4 v1, s[44:47], s72 offen offset:1024 sc1 lds
v_mfma_f32_16x16x32_bf16 a[84:87], a[244:247], v[216:219], a[84:87]
ds_read_b128 a[184:187], v2 offset:30720
v_cvt_pk_bf16_f32 v222, v188, v189
v_mfma_f32_16x16x32_bf16 a[88:91], a[248:251], v[216:219], a[88:91]
v_exp_f32 v190, v190
v_mfma_f32_16x16x32_bf16 a[88:91], a[216:219], v[200:203], a[88:91]
ds_read_b128 a[188:191], v2 offset:31744
ds_read_b128 a[224:227], v2 offset:8192
v_mfma_f32_16x16x32_bf16 a[92:95], a[220:223], v[200:203], a[92:95]
v_exp_f32 v191, v191
v_mfma_f32_16x16x32_bf16 a[92:95], a[252:255], v[216:219], a[92:95]
buffer_store_dwordx4 v[164:167], v1, s[44:47], s70 offen offset:2048 sc1
v_mfma_f32_16x16x32_bf16 v[136:139], a[128:131], v[48:51], v[88:91]
v_exp_f32 v168, v168
v_mfma_f32_16x16x32_bf16 v[136:139], a[132:135], v[52:55], v[136:139]
ds_read_b128 a[228:231], v2 offset:9216
v_cvt_pk_bf16_f32 v223, v190, v191
v_mfma_f32_16x16x32_bf16 v[136:139], a[136:139], v[56:59], v[136:139]
v_exp_f32 v169, v169
v_mfma_f32_16x16x32_bf16 v[136:139], a[140:143], v[60:63], v[136:139]
ds_read_b128 a[232:235], v2 offset:10240
ds_read_b128 a[236:239], v2 offset:11264
v_mfma_f32_16x16x32_bf16 v[152:155], a[156:159], v[60:63], v[88:91]
v_exp_f32 v170, v170
v_mfma_f32_16x16x32_bf16 v[152:155], a[152:155], v[56:59], v[152:155]
buffer_load_dwordx4 v1, s[44:47], s72 offen offset:2048 sc1 lds
v_mfma_f32_16x16x32_bf16 v[152:155], a[148:151], v[52:55], v[152:155]
v_exp_f32 v171, v171
v_mfma_f32_16x16x32_bf16 v[152:155], a[144:147], v[48:51], v[152:155]
ds_read_b128 a[240:243], v2 offset:12288
ds_read_b128 a[244:247], v2 offset:13312
v_mfma_f32_16x16x32_bf16 v[140:143], a[128:131], v[64:67], v[92:95]
v_exp_f32 v184, v184
v_mfma_f32_16x16x32_bf16 v[140:143], a[132:135], v[68:71], v[140:143]
ds_read_b128 a[248:251], v2 offset:14336
ds_read_b128 a[252:255], v2 offset:15360
v_mfma_f32_16x16x32_bf16 v[140:143], a[136:139], v[72:75], v[140:143]
v_cvt_pk_bf16_f32 v216, v168, v169
v_cvt_pk_bf16_f32 v217, v170, v171
v_mfma_f32_16x16x32_bf16 v[140:143], a[140:143], v[76:79], v[140:143]
buffer_store_dwordx4 v[180:183], v1, s[44:47], s70 offen offset:3072 sc1
v_mfma_f32_16x16x32_bf16 v[156:159], a[156:159], v[76:79], v[92:95]
v_exp_f32 v185, v185
v_mfma_f32_16x16x32_bf16 v[156:159], a[152:155], v[72:75], v[156:159]
buffer_load_dwordx4 v1, s[44:47], s72 offen offset:3072 sc1 lds
v_mfma_f32_16x16x32_bf16 v[156:159], a[148:151], v[68:71], v[156:159]
s_waitcnt vmcnt(14) lgkmcnt(4)
v_exp_f32 v186, v186
v_mfma_f32_16x16x32_bf16 v[156:159], a[144:147], v[64:67], v[156:159]
s_barrier
v_exp_f32 v187, v187
v_add_u32 v2, s82, v1
v_cvt_pk_bf16_f32 v218, v184, v185
v_cvt_pk_bf16_f32 v219, v186, v187
s_lshl_b32 s83, s60, 2
s_sub_u32 s83, s83, 25
.p2align 5
s_nop 0
s_nop 0
LloopII:
v_mfma_f32_16x16x32_bf16 v[236:239], v[120:123], v[204:207], v[236:239]
s_xor_b32 s74, s82, 0x10000
v_exp_f32 v136, v136
v_mfma_f32_16x16x32_bf16 v[236:239], v[120:123], v[220:223], v[236:239]
s_add_u32 s74, s74, s64
ds_read_b128 a[128:131], v2 offset:16384
ds_read_b128 a[132:135], v2 offset:17408
v_mfma_f32_16x16x32_bf16 a[96:99], a[192:195], v[204:207], a[96:99]
s_add_u32 s81, s81, 0x8000
v_exp_f32 v137, v137
v_mfma_f32_16x16x32_bf16 a[96:99], a[224:227], v[220:223], a[96:99]
s_add_u32 m0, s74, 16384
v_exp_f32 v138, v138
v_mfma_f32_16x16x32_bf16 a[100:103], a[228:231], v[220:223], a[100:103]
s_add_u32 s72, s81, 16384
ds_read_b128 a[136:139], v2 offset:18432
v_cvt_pk_bf16_f32 v200, v136, v137
v_mfma_f32_16x16x32_bf16 a[100:103], a[196:199], v[204:207], a[100:103]
buffer_load_dwordx4 v1, s[44:47], s72 offen sc1 lds
v_mfma_f32_16x16x32_bf16 a[104:107], a[200:203], v[204:207], a[104:107]
v_exp_f32 v139, v139
v_mfma_f32_16x16x32_bf16 a[104:107], a[232:235], v[220:223], a[104:107]
ds_read_b128 a[140:143], v2 offset:19456
v_cvt_pk_bf16_f32 v201, v138, v139
v_mfma_f32_16x16x32_bf16 a[108:111], a[236:239], v[220:223], a[108:111]
v_exp_f32 v152, v152
v_mfma_f32_16x16x32_bf16 a[108:111], a[204:207], v[204:207], a[108:111]
ds_read_b128 a[144:147], v2 offset:20480
ds_read_b128 a[148:151], v2 offset:21504
v_mfma_f32_16x16x32_bf16 a[112:115], a[208:211], v[204:207], a[112:115]
s_waitcnt lgkmcnt(6)
v_exp_f32 v153, v153
v_mfma_f32_16x16x32_bf16 a[112:115], a[240:243], v[220:223], a[112:115]
v_exp_f32 v154, v154
v_mfma_f32_16x16x32_bf16 a[116:119], a[244:247], v[220:223], a[116:119]
ds_read_b128 a[152:155], v2 offset:22528
v_cvt_pk_bf16_f32 v202, v152, v153
v_mfma_f32_16x16x32_bf16 a[116:119], a[212:215], v[204:207], a[116:119]
buffer_load_dwordx4 v1, s[44:47], s72 offen offset:1024 sc1 lds
v_mfma_f32_16x16x32_bf16 a[120:123], a[216:219], v[204:207], a[120:123]
v_exp_f32 v155, v155
v_mfma_f32_16x16x32_bf16 a[120:123], a[248:251], v[220:223], a[120:123]
ds_read_b128 a[156:159], v2 offset:23552
v_cvt_pk_bf16_f32 v203, v154, v155
v_mfma_f32_16x16x32_bf16 a[124:127], a[252:255], v[220:223], a[124:127]
v_exp_f32 v140, v140
v_mfma_f32_16x16x32_bf16 a[124:127], a[220:223], v[204:207], a[124:127]
ds_read_b128 a[192:195], v2 offset:0
ds_read_b128 a[196:199], v2 offset:1024
v_mfma_f32_16x16x32_bf16 v[172:175], a[160:163], v[64:67], v[92:95]
v_exp_f32 v141, v141
v_mfma_f32_16x16x32_bf16 v[172:175], a[164:167], v[68:71], v[172:175]
v_exp_f32 v142, v142
v_mfma_f32_16x16x32_bf16 v[172:175], a[168:171], v[72:75], v[172:175]
ds_read_b128 a[200:203], v2 offset:2048
v_cvt_pk_bf16_f32 v204, v140, v141
v_mfma_f32_16x16x32_bf16 v[172:175], a[172:175], v[76:79], v[172:175]
buffer_load_dwordx4 v1, s[44:47], s72 offen offset:2048 sc1 lds
v_mfma_f32_16x16x32_bf16 v[188:191], a[188:191], v[76:79], v[92:95]
v_exp_f32 v143, v143
v_mfma_f32_16x16x32_bf16 v[188:191], a[184:187], v[72:75], v[188:191]
ds_read_b128 a[204:207], v2 offset:3072
v_cvt_pk_bf16_f32 v205, v142, v143
v_mfma_f32_16x16x32_bf16 v[188:191], a[180:183], v[68:71], v[188:191]
v_exp_f32 v156, v156
v_mfma_f32_16x16x32_bf16 v[188:191], a[176:179], v[64:67], v[188:191]
ds_read_b128 a[208:211], v2 offset:4096
v_mfma_f32_16x16x32_bf16 v[168:171], a[160:163], v[48:51], v[88:91]
v_exp_f32 v157, v157
v_mfma_f32_16x16x32_bf16 v[168:171], a[164:167], v[52:55], v[168:171]
ds_read_b128 a[212:215], v2 offset:5120
v_cvt_pk_bf16_f32 v206, v156, v157
v_mfma_f32_16x16x32_bf16 v[168:171], a[168:171], v[56:59], v[168:171]
v_exp_f32 v158, v158
v_mfma_f32_16x16x32_bf16 v[168:171], a[172:175], v[60:63], v[168:171]
ds_read_b128 a[216:219], v2 offset:6144
v_mfma_f32_16x16x32_bf16 v[184:187], a[188:191], v[60:63], v[88:91]
buffer_load_dwordx4 v1, s[44:47], s72 offen offset:3072 sc1 lds
v_mfma_f32_16x16x32_bf16 v[184:187], a[184:187], v[56:59], v[184:187]
v_exp_f32 v159, v159
v_mfma_f32_16x16x32_bf16 v[184:187], a[180:183], v[52:55], v[184:187]
ds_read_b128 a[220:223], v2 offset:7168
v_cvt_pk_bf16_f32 v207, v158, v159
v_mfma_f32_16x16x32_bf16 v[184:187], a[176:179], v[48:51], v[184:187]
s_waitcnt lgkmcnt(4)
v_mfma_f32_16x16x32_bf16 v[232:235], v[120:123], v[216:219], v[232:235]
s_add_u32 s82, s82, 0x8000
ds_read_b128 a[160:163], v2 offset:24576
ds_read_b128 a[164:167], v2 offset:25600
v_mfma_f32_16x16x32_bf16 v[232:235], v[120:123], v[200:203], v[232:235]
s_and_b32 s82, s82, 0x1ffff
v_exp_f32 v172, v172
v_mfma_f32_16x16x32_bf16 a[64:67], a[224:227], v[216:219], a[64:67]
s_add_u32 m0, s74, 0
v_exp_f32 v173, v173
v_mfma_f32_16x16x32_bf16 a[64:67], a[192:195], v[200:203], a[64:67]
s_add_u32 s72, s81, 0
ds_read_b128 a[168:171], v2 offset:26624
v_cvt_pk_bf16_f32 v220, v172, v173
v_mfma_f32_16x16x32_bf16 a[68:71], a[196:199], v[200:203], a[68:71]
v_exp_f32 v174, v174
v_mfma_f32_16x16x32_bf16 a[68:71], a[228:231], v[216:219], a[68:71]
buffer_load_dwordx4 v1, s[44:47], s72 offen sc1 lds
v_mfma_f32_16x16x32_bf16 a[72:75], a[232:235], v[216:219], a[72:75]
ds_read_b128 a[172:175], v2 offset:27648
ds_read_b128 a[176:179], v2 offset:28672
v_mfma_f32_16x16x32_bf16 a[72:75], a[200:203], v[200:203], a[72:75]
v_exp_f32 v175, v175
v_mfma_f32_16x16x32_bf16 a[76:79], a[204:207], v[200:203], a[76:79]
v_exp_f32 v188, v188
v_mfma_f32_16x16x32_bf16 a[76:79], a[236:239], v[216:219], a[76:79]
ds_read_b128 a[180:183], v2 offset:29696
v_cvt_pk_bf16_f32 v221, v174, v175
v_mfma_f32_16x16x32_bf16 a[80:83], a[240:243], v[216:219], a[80:83]
s_waitcnt lgkmcnt(6)
v_exp_f32 v189, v189
v_mfma_f32_16x16x32_bf16 a[80:83], a[208:211], v[200:203], a[80:83]
ds_read_b128 a[184:187], v2 offset:30720
v_cvt_pk_bf16_f32 v222, v188, v189
v_mfma_f32_16x16x32_bf16 a[84:87], a[212:215], v[200:203], a[84:87]
buffer_load_dwordx4 v1, s[44:47], s72 offen offset:1024 sc1 lds
v_mfma_f32_16x16x32_bf16 a[84:87], a[244:247], v[216:219], a[84:87]
v_exp_f32 v190, v190
v_mfma_f32_16x16x32_bf16 a[88:91], a[248:251], v[216:219], a[88:91]
ds_read_b128 a[188:191], v2 offset:31744
ds_read_b128 a[224:227], v2 offset:8192
v_mfma_f32_16x16x32_bf16 a[88:91], a[216:219], v[200:203], a[88:91]
v_exp_f32 v191, v191
v_mfma_f32_16x16x32_bf16 a[92:95], a[220:223], v[200:203], a[92:95]
v_exp_f32 v168, v168
v_mfma_f32_16x16x32_bf16 a[92:95], a[252:255], v[216:219], a[92:95]
ds_read_b128 a[228:231], v2 offset:9216
v_cvt_pk_bf16_f32 v223, v190, v191
v_mfma_f32_16x16x32_bf16 v[136:139], a[128:131], v[48:51], v[88:91]
v_exp_f32 v169, v169
v_mfma_f32_16x16x32_bf16 v[136:139], a[132:135], v[52:55], v[136:139]
ds_read_b128 a[232:235], v2 offset:10240
v_cvt_pk_bf16_f32 v216, v168, v169
v_mfma_f32_16x16x32_bf16 v[136:139], a[136:139], v[56:59], v[136:139]
buffer_load_dwordx4 v1, s[44:47], s72 offen offset:2048 sc1 lds
v_mfma_f32_16x16x32_bf16 v[136:139], a[140:143], v[60:63], v[136:139]
v_exp_f32 v170, v170
v_mfma_f32_16x16x32_bf16 v[152:155], a[156:159], v[60:63], v[88:91]
ds_read_b128 a[236:239], v2 offset:11264
ds_read_b128 a[240:243], v2 offset:12288
v_mfma_f32_16x16x32_bf16 v[152:155], a[152:155], v[56:59], v[152:155]
v_exp_f32 v171, v171
v_mfma_f32_16x16x32_bf16 v[152:155], a[148:151], v[52:55], v[152:155]
v_exp_f32 v184, v184
v_mfma_f32_16x16x32_bf16 v[152:155], a[144:147], v[48:51], v[152:155]
ds_read_b128 a[244:247], v2 offset:13312
v_cvt_pk_bf16_f32 v217, v170, v171
v_mfma_f32_16x16x32_bf16 v[140:143], a[128:131], v[64:67], v[92:95]
v_exp_f32 v185, v185
v_mfma_f32_16x16x32_bf16 v[140:143], a[132:135], v[68:71], v[140:143]
ds_read_b128 a[248:251], v2 offset:14336
v_cvt_pk_bf16_f32 v218, v184, v185
v_mfma_f32_16x16x32_bf16 v[140:143], a[136:139], v[72:75], v[140:143]
buffer_load_dwordx4 v1, s[44:47], s72 offen offset:3072 sc1 lds
v_mfma_f32_16x16x32_bf16 v[140:143], a[140:143], v[76:79], v[140:143]
ds_read_b128 a[252:255], v2 offset:15360
v_add_u32 v2, s82, v1
v_mfma_f32_16x16x32_bf16 v[156:159], a[156:159], v[76:79], v[92:95]
s_waitcnt vmcnt(8) lgkmcnt(4)
v_exp_f32 v186, v186
v_mfma_f32_16x16x32_bf16 v[156:159], a[152:155], v[72:75], v[156:159]
s_barrier
v_exp_f32 v187, v187
v_mfma_f32_16x16x32_bf16 v[156:159], a[148:151], v[68:71], v[156:159]
s_add_u32 s83, s83, 1
v_cvt_pk_bf16_f32 v219, v186, v187
v_mfma_f32_16x16x32_bf16 v[156:159], a[144:147], v[64:67], v[156:159]
s_cbranch_scc0 LloopII
v_mfma_f32_16x16x32_bf16 v[236:239], v[120:123], v[204:207], v[236:239]
s_xor_b32 s74, s82, 0x10000
ds_read_b128 a[128:131], v2 offset:16384
ds_read_b128 a[132:135], v2 offset:17408
v_mfma_f32_16x16x32_bf16 v[236:239], v[120:123], v[220:223], v[236:239]
s_add_u32 s74, s74, s64
v_exp_f32 v136, v136
v_mfma_f32_16x16x32_bf16 a[96:99], a[192:195], v[204:207], a[96:99]
s_add_u32 s81, s81, 0x8000
v_exp_f32 v137, v137
v_mfma_f32_16x16x32_bf16 a[96:99], a[224:227], v[220:223], a[96:99]
s_add_u32 m0, s74, 0
ds_read_b128 a[136:139], v2 offset:18432
v_cvt_pk_bf16_f32 v200, v136, v137
v_mfma_f32_16x16x32_bf16 a[100:103], a[228:231], v[220:223], a[100:103]
s_add_u32 s72, s81, 0
v_exp_f32 v138, v138
v_mfma_f32_16x16x32_bf16 a[100:103], a[196:199], v[204:207], a[100:103]
buffer_load_dwordx4 v1, s[44:47], s72 offen sc1 lds
v_mfma_f32_16x16x32_bf16 a[104:107], a[200:203], v[204:207], a[104:107]
ds_read_b128 a[140:143], v2 offset:19456
ds_read_b128 a[144:147], v2 offset:20480
v_mfma_f32_16x16x32_bf16 a[104:107], a[232:235], v[220:223], a[104:107]
v_exp_f32 v139, v139
v_mfma_f32_16x16x32_bf16 a[108:111], a[236:239], v[220:223], a[108:111]
v_exp_f32 v152, v152
v_mfma_f32_16x16x32_bf16 a[108:111], a[204:207], v[204:207], a[108:111]
ds_read_b128 a[148:151], v2 offset:21504
v_cvt_pk_bf16_f32 v201, v138, v139
v_mfma_f32_16x16x32_bf16 a[112:115], a[208:211], v[204:207], a[112:115]
s_waitcnt lgkmcnt(6)
v_exp_f32 v153, v153
v_mfma_f32_16x16x32_bf16 a[112:115], a[240:243], v[220:223], a[112:115]
ds_read_b128 a[152:155], v2 offset:22528
v_cvt_pk_bf16_f32 v202, v152, v153
v_mfma_f32_16x16x32_bf16 a[116:119], a[244:247], v[220:223], a[116:119]
v_exp_f32 v154, v154
v_mfma_f32_16x16x32_bf16 a[116:119], a[212:215], v[204:207], a[116:119]
buffer_load_dwordx4 v1, s[44:47], s72 offen offset:1024 sc1 lds
v_mfma_f32_16x16x32_bf16 a[120:123], a[216:219], v[204:207], a[120:123]
ds_read_b128 a[156:159], v2 offset:23552
ds_read_b128 a[192:195], v2 offset:0
v_mfma_f32_16x16x32_bf16 a[120:123], a[248:251], v[220:223], a[120:123]
v_exp_f32 v155, v155
v_mfma_f32_16x16x32_bf16 a[124:127], a[252:255], v[220:223], a[124:127]
v_exp_f32 v140, v140
v_mfma_f32_16x16x32_bf16 a[124:127], a[220:223], v[204:207], a[124:127]
ds_read_b128 a[196:199], v2 offset:1024
v_cvt_pk_bf16_f32 v203, v154, v155
v_mfma_f32_16x16x32_bf16 v[172:175], a[160:163], v[64:67], v[92:95]
v_exp_f32 v141, v141
v_mfma_f32_16x16x32_bf16 v[172:175], a[164:167], v[68:71], v[172:175]
ds_read_b128 a[200:203], v2 offset:2048
v_cvt_pk_bf16_f32 v204, v140, v141
v_mfma_f32_16x16x32_bf16 v[172:175], a[168:171], v[72:75], v[172:175]
v_exp_f32 v142, v142
v_mfma_f32_16x16x32_bf16 v[172:175], a[172:175], v[76:79], v[172:175]
buffer_load_dwordx4 v1, s[44:47], s72 offen offset:2048 sc1 lds
v_mfma_f32_16x16x32_bf16 v[188:191], a[188:191], v[76:79], v[92:95]
ds_read_b128 a[204:207], v2 offset:3072
v_mfma_f32_16x16x32_bf16 v[188:191], a[184:187], v[72:75], v[188:191]
v_exp_f32 v143, v143
v_mfma_f32_16x16x32_bf16 v[188:191], a[180:183], v[68:71], v[188:191]
ds_read_b128 a[208:211], v2 offset:4096
v_cvt_pk_bf16_f32 v205, v142, v143
v_mfma_f32_16x16x32_bf16 v[188:191], a[176:179], v[64:67], v[188:191]
v_exp_f32 v156, v156
v_mfma_f32_16x16x32_bf16 v[168:171], a[160:163], v[48:51], v[88:91]
ds_read_b128 a[212:215], v2 offset:5120
v_mfma_f32_16x16x32_bf16 v[168:171], a[164:167], v[52:55], v[168:171]
v_exp_f32 v157, v157
v_mfma_f32_16x16x32_bf16 v[168:171], a[168:171], v[56:59], v[168:171]
ds_read_b128 a[216:219], v2 offset:6144
v_cvt_pk_bf16_f32 v206, v156, v157
v_mfma_f32_16x16x32_bf16 v[168:171], a[172:175], v[60:63], v[168:171]
buffer_load_dwordx4 v1, s[44:47], s72 offen offset:3072 sc1 lds
v_mfma_f32_16x16x32_bf16 v[184:187], a[188:191], v[60:63], v[88:91]
v_exp_f32 v158, v158
v_mfma_f32_16x16x32_bf16 v[184:187], a[184:187], v[56:59], v[184:187]
ds_read_b128 a[220:223], v2 offset:7168
v_mfma_f32_16x16x32_bf16 v[184:187], a[180:183], v[52:55], v[184:187]
s_waitcnt lgkmcnt(4)
v_exp_f32 v159, v159
v_mfma_f32_16x16x32_bf16 v[184:187], a[176:179], v[48:51], v[184:187]
s_barrier
v_cvt_pk_bf16_f32 v207, v158, v159
s_lshr_b32 s69, s93, 4
s_and_b32 s69, s69, 0x7f00
s_add_u32 s69, s69, LHT4-Lpc0
v_lshrrev_b32 v3, 5, v0
v_lshlrev_b32 v3, 7, v3
v_add_u32 v3, s69, v3
v_min_u32 v3, Lcode_end-Lpc0, v3
global_load_dword v4, v3, s[98:99]
Lstub6:
s_cbranch_execz Lstub10
v_mfma_f32_16x16x32_bf16 v[232:235], v[120:123], v[216:219], v[232:235]
s_add_u32 s82, s82, 0x8000
ds_read_b128 a[160:163], v2 offset:24576
ds_read_b128 a[164:167], v2 offset:25600
v_mfma_f32_16x16x32_bf16 v[232:235], v[120:123], v[200:203], v[232:235]
s_and_b32 s82, s82, 0x1ffff
v_exp_f32 v172, v172
v_mfma_f32_16x16x32_bf16 a[64:67], a[224:227], v[216:219], a[64:67]
s_add_u32 s66, s58, 3
v_exp_f32 v173, v173
v_mfma_f32_16x16x32_bf16 a[64:67], a[192:195], v[200:203], a[64:67]
s_and_b32 s66, s66, 3
ds_read_b128 a[168:171], v2 offset:26624
v_cvt_pk_bf16_f32 v220, v172, v173
v_mfma_f32_16x16x32_bf16 a[68:71], a[196:199], v[200:203], a[68:71]
s_mul_i32 s66, s66, 4160
v_exp_f32 v174, v174
v_mfma_f32_16x16x32_bf16 a[68:71], a[228:231], v[216:219], a[68:71]
s_add_u32 s66, s66, s92
ds_read_b128 a[172:175], v2 offset:27648
ds_read_b128 a[176:179], v2 offset:28672
v_mfma_f32_16x16x32_bf16 a[72:75], a[232:235], v[216:219], a[72:75]
s_add_u32 m0, s66, 32
v_exp_f32 v175, v175
v_mfma_f32_16x16x32_bf16 a[72:75], a[200:203], v[200:203], a[72:75]
s_add_u32 s72, s93, 0x6
buffer_load_dwordx4 v1, s[36:39], s72 offen lds
v_mfma_f32_16x16x32_bf16 a[76:79], a[204:207], v[200:203], a[76:79]
v_exp_f32 v188, v188
v_mfma_f32_16x16x32_bf16 a[76:79], a[236:239], v[216:219], a[76:79]
ds_read_b128 a[180:183], v2 offset:29696
v_cvt_pk_bf16_f32 v221, v174, v175
v_mfma_f32_16x16x32_bf16 a[80:83], a[240:243], v[216:219], a[80:83]
s_waitcnt lgkmcnt(6)
v_exp_f32 v189, v189
v_mfma_f32_16x16x32_bf16 a[80:83], a[208:211], v[200:203], a[80:83]
ds_read_b128 a[184:187], v2 offset:30720
v_cvt_pk_bf16_f32 v222, v188, v189
v_mfma_f32_16x16x32_bf16 a[84:87], a[212:215], v[200:203], a[84:87]
v_exp_f32 v190, v190
v_mfma_f32_16x16x32_bf16 a[84:87], a[244:247], v[216:219], a[84:87]
buffer_load_dwordx4 v1, s[36:39], s72 offen offset:1024 lds
v_mfma_f32_16x16x32_bf16 a[88:91], a[248:251], v[216:219], a[88:91]
ds_read_b128 a[188:191], v2 offset:31744
ds_read_b128 a[224:227], v2 offset:8192
v_mfma_f32_16x16x32_bf16 a[88:91], a[216:219], v[200:203], a[88:91]
v_exp_f32 v191, v191
v_mfma_f32_16x16x32_bf16 a[92:95], a[220:223], v[200:203], a[92:95]
v_exp_f32 v168, v168
v_mfma_f32_16x16x32_bf16 a[92:95], a[252:255], v[216:219], a[92:95]
ds_read_b128 a[228:231], v2 offset:9216
v_cvt_pk_bf16_f32 v223, v190, v191
s_cmp_eq_u32 s58, 0
s_cbranch_scc1 Lta28
s_cmp_eq_u32 s58, 1
s_cbranch_scc1 Lnt29
v_mfma_f32_16x16x32_bf16 v[136:139], a[128:131], v[48:51], v[88:91]
v_exp_f32 v169, v169
v_mfma_f32_16x16x32_bf16 v[152:155], a[144:147], v[48:51], v[88:91]
ds_read_b128 a[232:235], v2 offset:10240
v_cvt_pk_bf16_f32 v216, v168, v169
s_branch Ljoin30
Lta28:
v_mfma_f32_16x16x32_bf16 v[136:139], a[128:131], v[48:51], v[104:107]
v_exp_f32 v169, v169
v_mfma_f32_16x16x32_bf16 v[152:155], a[144:147], v[48:51], v[112:115]
ds_read_b128 a[232:235], v2 offset:10240
v_cvt_pk_bf16_f32 v216, v168, v169
s_branch Ljoin30
Lnt29:
v_mfma_f32_16x16x32_bf16 v[136:139], a[128:131], v[48:51], v[88:91]
v_exp_f32 v169, v169
v_mfma_f32_16x16x32_bf16 v[152:155], a[144:147], v[48:51], v[104:107]
ds_read_b128 a[232:235], v2 offset:10240
v_cvt_pk_bf16_f32 v216, v168, v169
Ljoin30:
v_mfma_f32_16x16x32_bf16 v[136:139], a[132:135], v[52:55], v[136:139]
v_exp_f32 v170, v170
v_mfma_f32_16x16x32_bf16 v[136:139], a[136:139], v[56:59], v[136:139]
buffer_load_dwordx4 v1, s[36:39], s72 offen offset:2048 lds
v_mfma_f32_16x16x32_bf16 v[136:139], a[140:143], v[60:63], v[136:139]
ds_read_b128 a[236:239], v2 offset:11264
v_mfma_f32_16x16x32_bf16 v[152:155], a[156:159], v[60:63], v[152:155]
v_exp_f32 v171, v171
v_mfma_f32_16x16x32_bf16 v[152:155], a[152:155], v[56:59], v[152:155]
ds_read_b128 a[240:243], v2 offset:12288
v_cvt_pk_bf16_f32 v217, v170, v171
v_mfma_f32_16x16x32_bf16 v[152:155], a[148:151], v[52:55], v[152:155]
v_exp_f32 v184, v184
v_mfma_f32_16x16x32_bf16 v[140:143], a[128:131], v[64:67], v[92:95]
ds_read_b128 a[244:247], v2 offset:13312
v_mfma_f32_16x16x32_bf16 v[140:143], a[132:135], v[68:71], v[140:143]
v_exp_f32 v185, v185
v_mfma_f32_16x16x32_bf16 v[140:143], a[136:139], v[72:75], v[140:143]
ds_read_b128 a[248:251], v2 offset:14336
v_cvt_pk_bf16_f32 v218, v184, v185
v_mfma_f32_16x16x32_bf16 v[140:143], a[140:143], v[76:79], v[140:143]
buffer_load_dwordx4 v1, s[36:39], s72 offen offset:3072 lds
v_mfma_f32_16x16x32_bf16 v[156:159], a[156:159], v[76:79], v[92:95]
v_exp_f32 v186, v186
v_mfma_f32_16x16x32_bf16 v[156:159], a[152:155], v[72:75], v[156:159]
ds_read_b128 a[252:255], v2 offset:15360
v_add_u32 v2, s82, v1
v_mfma_f32_16x16x32_bf16 v[156:159], a[148:151], v[68:71], v[156:159]
s_waitcnt vmcnt(9) lgkmcnt(0)
v_exp_f32 v187, v187
v_mfma_f32_16x16x32_bf16 v[156:159], a[144:147], v[64:67], v[156:159]
s_barrier
v_cvt_pk_bf16_f32 v219, v186, v187
v_mfma_f32_16x16x32_bf16 v[236:239], v[120:123], v[204:207], v[236:239]
s_mov_b32 m0, s62
v_exp_f32 v136, v136
v_mfma_f32_16x16x32_bf16 v[236:239], v[120:123], v[220:223], v[236:239]
s_add_u32 s72, s93, 0x3000000
ds_read_b128 a[128:131], v2 offset:16384
ds_read_b128 a[132:135], v2 offset:17408
v_mfma_f32_16x16x32_bf16 a[96:99], a[192:195], v[204:207], a[96:99]
v_exp_f32 v137, v137
v_mfma_f32_16x16x32_bf16 a[96:99], a[224:227], v[220:223], a[96:99]
buffer_load_dwordx4 v1, s[44:47], s72 offen sc1 lds
v_mfma_f32_16x16x32_bf16 a[100:103], a[228:231], v[220:223], a[100:103]
s_add_u32 s78, s59, 4
v_exp_f32 v138, v138
v_mfma_f32_16x16x32_bf16 a[100:103], a[196:199], v[204:207], a[100:103]
s_and_b32 s78, s78, 12
ds_read_b128 a[136:139], v2 offset:18432
v_cvt_pk_bf16_f32 v200, v136, v137
v_mfma_f32_16x16x32_bf16 a[104:107], a[200:203], v[204:207], a[104:107]
s_and_b32 s12, s59, 16
v_exp_f32 v139, v139
v_mfma_f32_16x16x32_bf16 a[104:107], a[232:235], v[220:223], a[104:107]
s_or_b32 s78, s78, s12
ds_read_b128 a[140:143], v2 offset:19456
v_cvt_pk_bf16_f32 v201, v138, v139
v_mfma_f32_16x16x32_bf16 a[108:111], a[236:239], v[220:223], a[108:111]
s_add_u32 s12, s61, 0
v_exp_f32 v152, v152
v_mfma_f32_16x16x32_bf16 a[108:111], a[204:207], v[204:207], a[108:111]
s_and_b32 s12, s12, 3
ds_read_b128 a[144:147], v2 offset:20480
ds_read_b128 a[148:151], v2 offset:21504
v_mfma_f32_16x16x32_bf16 a[112:115], a[208:211], v[204:207], a[112:115]
s_waitcnt lgkmcnt(6)
buffer_load_dwordx4 v1, s[44:47], s72 offen offset:1024 sc1 lds
v_mfma_f32_16x16x32_bf16 a[112:115], a[240:243], v[220:223], a[112:115]
s_add_u32 s12, s12, s78
v_exp_f32 v153, v153
v_mfma_f32_16x16x32_bf16 a[116:119], a[244:247], v[220:223], a[116:119]
s_lshl_b32 s12, s12, 18
v_exp_f32 v154, v154
v_mfma_f32_16x16x32_bf16 a[116:119], a[212:215], v[204:207], a[116:119]
s_add_u32 s12, s12, s94
ds_read_b128 a[152:155], v2 offset:22528
v_cvt_pk_bf16_f32 v202, v152, v153
v_mfma_f32_16x16x32_bf16 a[120:123], a[216:219], v[204:207], a[120:123]
s_add_u32 s13, s61, 1
buffer_load_dwordx4 v1, s[44:47], s72 offen offset:2048 sc1 lds
v_mfma_f32_16x16x32_bf16 a[120:123], a[248:251], v[220:223], a[120:123]
s_and_b32 s13, s13, 3
v_exp_f32 v155, v155
v_mfma_f32_16x16x32_bf16 a[124:127], a[252:255], v[220:223], a[124:127]
s_add_u32 s13, s13, s78
ds_read_b128 a[156:159], v2 offset:23552
v_cvt_pk_bf16_f32 v203, v154, v155
v_mfma_f32_16x16x32_bf16 a[124:127], a[220:223], v[204:207], a[124:127]
s_lshl_b32 s13, s13, 18
v_exp_f32 v140, v140
s_cmp_eq_u32 s58, 2
s_cbranch_scc1 Lta31
s_cmp_eq_u32 s58, 3
s_cbranch_scc1 Lnt32
v_mfma_f32_16x16x32_bf16 v[168:171], a[160:163], v[48:51], v[112:115]
s_add_u32 s13, s13, s94
ds_read_b128 a[192:195], v2 offset:0
ds_read_b128 a[196:199], v2 offset:1024
v_mfma_f32_16x16x32_bf16 v[184:187], a[176:179], v[48:51], v[112:115]
s_add_u32 s14, s61, 2
v_exp_f32 v141, v141
s_branch Ljoin33
Lta31:
v_mfma_f32_16x16x32_bf16 v[168:171], a[160:163], v[48:51], v[104:107]
s_add_u32 s13, s13, s94
ds_read_b128 a[192:195], v2 offset:0
ds_read_b128 a[196:199], v2 offset:1024
v_mfma_f32_16x16x32_bf16 v[184:187], a[176:179], v[48:51], v[112:115]
s_add_u32 s14, s61, 2
v_exp_f32 v141, v141
s_branch Ljoin33
Lnt32:
v_mfma_f32_16x16x32_bf16 v[168:171], a[160:163], v[48:51], v[88:91]
s_add_u32 s13, s13, s94
ds_read_b128 a[192:195], v2 offset:0
ds_read_b128 a[196:199], v2 offset:1024
v_mfma_f32_16x16x32_bf16 v[184:187], a[176:179], v[48:51], v[104:107]
s_add_u32 s14, s61, 2
v_exp_f32 v141, v141
Ljoin33:
v_mfma_f32_16x16x32_bf16 v[172:175], a[160:163], v[64:67], v[92:95]
s_and_b32 s14, s14, 3
buffer_load_dwordx4 v1, s[44:47], s72 offen offset:3072 sc1 lds
v_mfma_f32_16x16x32_bf16 v[172:175], a[164:167], v[68:71], v[172:175]
s_add_u32 s66, s58, 0
v_exp_f32 v142, v142
v_mfma_f32_16x16x32_bf16 v[172:175], a[168:171], v[72:75], v[172:175]
s_and_b32 s66, s66, 3
ds_read_b128 a[200:203], v2 offset:2048
v_cvt_pk_bf16_f32 v204, v140, v141
v_mfma_f32_16x16x32_bf16 v[172:175], a[172:175], v[76:79], v[172:175]
s_mul_i32 s66, s66, 4160
v_exp_f32 v143, v143
v_mfma_f32_16x16x32_bf16 v[188:191], a[188:191], v[76:79], v[92:95]
s_add_u32 s66, s66, s92
ds_read_b128 a[204:207], v2 offset:3072
v_cvt_pk_bf16_f32 v205, v142, v143
v_mfma_f32_16x16x32_bf16 v[188:191], a[184:187], v[72:75], v[188:191]
s_add_u32 m0, s66, 16672
v_exp_f32 v156, v156
v_mfma_f32_16x16x32_bf16 v[188:191], a[180:183], v[68:71], v[188:191]
s_add_u32 s72, s93, 0x0
ds_read_b128 a[208:211], v2 offset:4096
ds_read_b128 a[212:215], v2 offset:5120
v_mfma_f32_16x16x32_bf16 v[188:191], a[176:179], v[64:67], v[188:191]
s_add_u32 s14, s14, s78
buffer_load_dwordx4 v1, s[36:39], s72 offen lds
v_mfma_f32_16x16x32_bf16 v[168:171], a[164:167], v[52:55], v[168:171]
s_lshl_b32 s14, s14, 18
v_exp_f32 v157, v157
v_mfma_f32_16x16x32_bf16 v[168:171], a[168:171], v[56:59], v[168:171]
s_add_u32 s14, s14, s94
v_exp_f32 v158, v158
v_mfma_f32_16x16x32_bf16 v[168:171], a[172:175], v[60:63], v[168:171]
s_add_u32 s15, s61, 3
ds_read_b128 a[216:219], v2 offset:6144
ds_read_b128 a[220:223], v2 offset:7168
v_mfma_f32_16x16x32_bf16 v[184:187], a[188:191], v[60:63], v[184:187]
s_and_b32 s15, s15, 3
buffer_load_dwordx4 v1, s[36:39], s72 offen offset:1024 lds
v_mfma_f32_16x16x32_bf16 v[184:187], a[184:187], v[56:59], v[184:187]
s_add_u32 s15, s15, s78
v_exp_f32 v159, v159
v_mfma_f32_16x16x32_bf16 v[184:187], a[180:183], v[52:55], v[184:187]
s_waitcnt lgkmcnt(4)
v_cvt_pk_bf16_f32 v206, v156, v157
v_cvt_pk_bf16_f32 v207, v158, v159
s_lshl_b32 s15, s15, 18
s_add_u32 s15, s15, s94
v_mfma_f32_16x16x32_bf16 v[232:235], v[120:123], v[216:219], v[232:235]
s_add_u32 s82, s82, 0x8000
ds_read_b128 a[160:163], v2 offset:24576
ds_read_b128 a[164:167], v2 offset:25600
v_mfma_f32_16x16x32_bf16 v[232:235], v[120:123], v[200:203], v[232:235]
s_and_b32 s82, s82, 0x1ffff
v_exp_f32 v172, v172
v_mfma_f32_16x16x32_bf16 a[64:67], a[224:227], v[216:219], a[64:67]
v_exp_f32 v173, v173
v_mfma_f32_16x16x32_bf16 a[64:67], a[192:195], v[200:203], a[64:67]
ds_read_b128 a[168:171], v2 offset:26624
ds_read_b128 a[172:175], v2 offset:27648
v_mfma_f32_16x16x32_bf16 a[68:71], a[196:199], v[200:203], a[68:71]
v_exp_f32 v174, v174
v_mfma_f32_16x16x32_bf16 a[68:71], a[228:231], v[216:219], a[68:71]
v_exp_f32 v175, v175
v_mfma_f32_16x16x32_bf16 a[72:75], a[232:235], v[216:219], a[72:75]
ds_read_b128 a[176:179], v2 offset:28672
ds_read_b128 a[180:183], v2 offset:29696
v_mfma_f32_16x16x32_bf16 a[72:75], a[200:203], v[200:203], a[72:75]
v_exp_f32 v188, v188
v_mfma_f32_16x16x32_bf16 a[76:79], a[204:207], v[200:203], a[76:79]
ds_read_b128 a[184:187], v2 offset:30720
ds_read_b128 a[188:191], v2 offset:31744
v_mfma_f32_16x16x32_bf16 a[76:79], a[236:239], v[216:219], a[76:79]
ds_read_b128 a[224:227], v2 offset:8192
ds_read_b128 a[228:231], v2 offset:9216
v_mfma_f32_16x16x32_bf16 a[80:83], a[240:243], v[216:219], a[80:83]
s_waitcnt lgkmcnt(10)
ds_read_b128 a[232:235], v2 offset:10240
ds_read_b128 a[236:239], v2 offset:11264
v_mfma_f32_16x16x32_bf16 a[80:83], a[208:211], v[200:203], a[80:83]
ds_read_b128 a[240:243], v2 offset:12288
v_cvt_pk_bf16_f32 v220, v172, v173
v_mfma_f32_16x16x32_bf16 a[84:87], a[212:215], v[200:203], a[84:87]
buffer_load_dwordx4 v1, s[36:39], s72 offen offset:2048 lds
v_mfma_f32_16x16x32_bf16 a[84:87], a[244:247], v[216:219], a[84:87]
v_exp_f32 v189, v189
v_mfma_f32_16x16x32_bf16 a[88:91], a[248:251], v[216:219], a[88:91]
v_exp_f32 v190, v190
v_mfma_f32_16x16x32_bf16 a[88:91], a[216:219], v[200:203], a[88:91]
ds_read_b128 a[244:247], v2 offset:13312
ds_read_b128 a[248:251], v2 offset:14336
v_mfma_f32_16x16x32_bf16 a[92:95], a[220:223], v[200:203], a[92:95]
v_cvt_pk_bf16_f32 v221, v174, v175
v_cvt_pk_bf16_f32 v222, v188, v189
v_mfma_f32_16x16x32_bf16 a[92:95], a[252:255], v[216:219], a[92:95]
v_exp_f32 v191, v191
s_cmp_eq_u32 s58, 0
s_cbranch_scc1 Lta34
s_cmp_eq_u32 s58, 1
s_cbranch_scc1 Lnt35
v_mfma_f32_16x16x32_bf16 v[140:143], a[128:131], v[64:67], v[92:95]
v_exp_f32 v168, v168
v_mfma_f32_16x16x32_bf16 v[156:159], a[144:147], v[64:67], v[92:95]
v_exp_f32 v169, v169
s_branch Ljoin36
Lta34:
v_mfma_f32_16x16x32_bf16 v[140:143], a[128:131], v[64:67], v[108:111]
v_exp_f32 v168, v168
v_mfma_f32_16x16x32_bf16 v[156:159], a[144:147], v[64:67], v[112:115]
v_exp_f32 v169, v169
s_branch Ljoin36
Lnt35:
v_mfma_f32_16x16x32_bf16 v[140:143], a[128:131], v[64:67], v[92:95]
v_exp_f32 v168, v168
v_mfma_f32_16x16x32_bf16 v[156:159], a[144:147], v[64:67], v[108:111]
v_exp_f32 v169, v169
Ljoin36:
v_mfma_f32_16x16x32_bf16 v[140:143], a[132:135], v[68:71], v[140:143]
v_exp_f32 v170, v170
v_mfma_f32_16x16x32_bf16 v[140:143], a[136:139], v[72:75], v[140:143]
ds_read_b128 a[252:255], v2 offset:15360
v_cvt_pk_bf16_f32 v223, v190, v191
v_mfma_f32_16x16x32_bf16 v[140:143], a[140:143], v[76:79], v[140:143]
v_exp_f32 v171, v171
v_mfma_f32_16x16x32_bf16 v[156:159], a[156:159], v[76:79], v[156:159]
buffer_load_dwordx4 v1, s[36:39], s72 offen offset:3072 lds
v_mfma_f32_16x16x32_bf16 v[156:159], a[152:155], v[72:75], v[156:159]
s_waitcnt vmcnt(13) lgkmcnt(4)
v_exp_f32 v184, v184
v_mfma_f32_16x16x32_bf16 v[156:159], a[148:151], v[68:71], v[156:159]
s_barrier
v_cvt_pk_bf16_f32 v216, v168, v169
v_cvt_pk_bf16_f32 v217, v170, v171
v_add_u32 v2, s82, v1
v_exp_f32 v185, v185
v_exp_f32 v186, v186
v_cvt_pk_bf16_f32 v218, v184, v185
v_exp_f32 v187, v187
s_nop 0
v_cvt_pk_bf16_f32 v219, v186, v187
v_mfma_f32_16x16x32_bf16 v[236:239], v[120:123], v[204:207], v[236:239]
s_add_u32 s66, s58, 2
v_exp_f32 v140, v140
v_mfma_f32_16x16x32_bf16 v[236:239], v[120:123], v[220:223], v[236:239]
s_and_b32 s66, s66, 3
v_exp_f32 v141, v141
v_mfma_f32_16x16x32_bf16 a[96:99], a[192:195], v[204:207], a[96:99]
s_mul_i32 s66, s66, 4160
ds_read_b128 a[192:195], v2 offset:0
v_mfma_f32_16x16x32_bf16 a[96:99], a[224:227], v[220:223], a[96:99]
s_add_u32 s66, s66, s92
v_exp_f32 v142, v142
v_mfma_f32_16x16x32_bf16 a[100:103], a[228:231], v[220:223], a[100:103]
s_add_u32 m0, s66, 33312
v_exp_f32 v143, v143
v_mfma_f32_16x16x32_bf16 a[100:103], a[196:199], v[204:207], a[100:103]
s_add_u32 s72, s93, 0x4
buffer_load_dwordx4 v1, s[36:39], s72 offen lds
v_mfma_f32_16x16x32_bf16 a[104:107], a[200:203], v[204:207], a[104:107]
ds_read_b128 a[196:199], v2 offset:1024
v_mfma_f32_16x16x32_bf16 a[104:107], a[232:235], v[220:223], a[104:107]
buffer_load_dwordx4 v1, s[36:39], s72 offen offset:1024 lds
v_mfma_f32_16x16x32_bf16 a[108:111], a[236:239], v[220:223], a[108:111]
ds_read_b128 a[200:203], v2 offset:2048
v_mfma_f32_16x16x32_bf16 a[108:111], a[204:207], v[204:207], a[108:111]
buffer_load_dwordx4 v1, s[36:39], s72 offen offset:2048 lds
v_mfma_f32_16x16x32_bf16 a[112:115], a[208:211], v[204:207], a[112:115]
s_waitcnt lgkmcnt(3)
ds_read_b128 a[204:207], v2 offset:3072
v_mfma_f32_16x16x32_bf16 a[112:115], a[240:243], v[220:223], a[112:115]
buffer_load_dwordx4 v1, s[36:39], s72 offen offset:3072 lds
v_mfma_f32_16x16x32_bf16 a[116:119], a[244:247], v[220:223], a[116:119]
v_exp_f32 v156, v156
v_mfma_f32_16x16x32_bf16 a[116:119], a[212:215], v[204:207], a[116:119]
ds_read_b128 a[208:211], v2 offset:4096
v_mfma_f32_16x16x32_bf16 a[120:123], a[216:219], v[204:207], a[120:123]
buffer_load_dwordx4 v[80:83], v15, s[4:7], s80 offen
v_mfma_f32_16x16x32_bf16 a[120:123], a[248:251], v[220:223], a[120:123]
s_add_u32 s80, s80, 0x4000
v_exp_f32 v157, v157
v_mfma_f32_16x16x32_bf16 a[124:127], a[252:255], v[220:223], a[124:127]
ds_read_b128 a[212:215], v2 offset:5120
v_mfma_f32_16x16x32_bf16 a[124:127], a[220:223], v[204:207], a[124:127]
ds_read_b128 a[216:219], v2 offset:6144
v_cvt_pk_bf16_f32 v204, v140, v141
s_cmp_eq_u32 s58, 2
s_cbranch_scc1 Lta37
s_cmp_eq_u32 s58, 3
s_cbranch_scc1 Lnt38
v_mfma_f32_16x16x32_bf16 v[172:175], a[160:163], v[64:67], v[112:115]
buffer_load_dwordx4 v[84:87], v15, s[4:7], s80 offen
v_mfma_f32_16x16x32_bf16 v[188:191], a[176:179], v[64:67], v[112:115]
s_add_u32 s80, s80, 0x4000
v_exp_f32 v158, v158
s_branch Ljoin39
Lta37:
v_mfma_f32_16x16x32_bf16 v[172:175], a[160:163], v[64:67], v[108:111]
buffer_load_dwordx4 v[84:87], v15, s[4:7], s80 offen
v_mfma_f32_16x16x32_bf16 v[188:191], a[176:179], v[64:67], v[112:115]
s_add_u32 s80, s80, 0x4000
v_exp_f32 v158, v158
s_branch Ljoin39
Lnt38:
v_mfma_f32_16x16x32_bf16 v[172:175], a[160:163], v[64:67], v[92:95]
buffer_load_dwordx4 v[84:87], v15, s[4:7], s80 offen
v_mfma_f32_16x16x32_bf16 v[188:191], a[176:179], v[64:67], v[108:111]
s_add_u32 s80, s80, 0x4000
v_exp_f32 v158, v158
Ljoin39:
v_mfma_f32_16x16x32_bf16 v[172:175], a[164:167], v[68:71], v[172:175]
ds_read_b128 a[220:223], v2 offset:7168
v_cvt_pk_bf16_f32 v205, v142, v143
v_mfma_f32_16x16x32_bf16 v[172:175], a[168:171], v[72:75], v[172:175]
buffer_load_dwordx4 v[96:99], v15, s[4:7], s80 offen
v_mfma_f32_16x16x32_bf16 v[172:175], a[172:175], v[76:79], v[172:175]
s_add_u32 s80, s80, 0x4000
v_exp_f32 v159, v159
v_mfma_f32_16x16x32_bf16 v[188:191], a[188:191], v[76:79], v[188:191]
buffer_load_dwordx4 v[100:103], v15, s[4:7], s80 offen
v_mfma_f32_16x16x32_bf16 v[188:191], a[184:187], v[72:75], v[188:191]
v_cvt_pk_bf16_f32 v206, v156, v157
v_cvt_pk_bf16_f32 v207, v158, v159
v_mfma_f32_16x16x32_bf16 v[188:191], a[180:183], v[68:71], v[188:191]
s_waitcnt lgkmcnt(4)
v_mfma_f32_16x16x32_bf16 v[232:235], v[120:123], v[216:219], v[232:235]
s_add_u32 s82, s82, 0x8000
v_exp_f32 v172, v172
v_mfma_f32_16x16x32_bf16 a[64:67], a[224:227], v[216:219], a[64:67]
s_and_b32 s82, s82, 0x1ffff
ds_read_b128 a[224:227], v2 offset:8192
v_mfma_f32_16x16x32_bf16 a[68:71], a[228:231], v[216:219], a[68:71]
ds_read_b128 a[228:231], v2 offset:9216
v_mfma_f32_16x16x32_bf16 a[72:75], a[232:235], v[216:219], a[72:75]
v_exp_f32 v173, v173
v_mfma_f32_16x16x32_bf16 a[76:79], a[236:239], v[216:219], a[76:79]
ds_read_b128 a[232:235], v2 offset:10240
ds_read_b128 a[236:239], v2 offset:11264
v_mfma_f32_16x16x32_bf16 a[80:83], a[240:243], v[216:219], a[80:83]
ds_read_b128 a[240:243], v2 offset:12288
v_cvt_pk_bf16_f32 v220, v172, v173
v_mfma_f32_16x16x32_bf16 a[84:87], a[244:247], v[216:219], a[84:87]
ds_read_b128 a[244:247], v2 offset:13312
v_mfma_f32_16x16x32_bf16 a[88:91], a[248:251], v[216:219], a[88:91]
v_exp_f32 v174, v174
v_mfma_f32_16x16x32_bf16 a[92:95], a[252:255], v[216:219], a[92:95]
v_exp_f32 v175, v175
ds_read_b128 a[248:251], v2 offset:14336
ds_read_b128 a[252:255], v2 offset:15360
v_add_u32 v2, s82, v1
v_exp_f32 v188, v188
v_cvt_pk_bf16_f32 v221, v174, v175
v_exp_f32 v189, v189
v_exp_f32 v190, v190
v_cvt_pk_bf16_f32 v222, v188, v189
v_exp_f32 v191, v191
s_nop 0
v_cvt_pk_bf16_f32 v223, v190, v191
s_waitcnt vmcnt(4) lgkmcnt(0)
s_barrier
LHT4:
Lstub7:
s_cbranch_execz Lstub11
v_mfma_f32_16x16x32_bf16 v[236:239], v[120:123], v[204:207], v[236:239]
ds_write_b64 v5, v[12:13]
v_mov_b32 v240, 0
v_mfma_f32_16x16x32_bf16 v[236:239], v[120:123], v[220:223], v[236:239]
v_mov_b32 v241, 0
v_mfma_f32_16x16x32_bf16 a[96:99], a[192:195], v[204:207], a[96:99]
ds_write_b64 v14, v[240:241]
ds_read_b64 a[128:129], v6 offset:0
v_mfma_f32_16x16x32_bf16 a[96:99], a[224:227], v[220:223], a[96:99]
ds_read_b64 a[130:131], v6 offset:8
ds_read_b128 a[192:195], v7 offset:3584
v_mfma_f32_16x16x32_bf16 a[100:103], a[228:231], v[220:223], a[100:103]
ds_read_b64 a[132:133], v6 offset:512
ds_read_b64 a[134:135], v6 offset:520
v_mfma_f32_16x16x32_bf16 a[100:103], a[196:199], v[204:207], a[100:103]
ds_read_b128 a[196:199], v7 offset:3072
ds_read_b64 a[136:137], v6 offset:1024
v_mfma_f32_16x16x32_bf16 a[104:107], a[200:203], v[204:207], a[104:107]
ds_read_b64 a[138:139], v6 offset:1032
ds_read_b128 a[200:203], v7 offset:2560
v_mfma_f32_16x16x32_bf16 a[104:107], a[232:235], v[220:223], a[104:107]
v_mfma_f32_16x16x32_bf16 a[108:111], a[236:239], v[220:223], a[108:111]
ds_read_b64 a[140:141], v6 offset:1536
ds_read_b64 a[142:143], v6 offset:1544
v_mfma_f32_16x16x32_bf16 a[108:111], a[204:207], v[204:207], a[108:111]
ds_read_b128 a[204:207], v7 offset:2048
ds_read_b64 a[144:145], v6 offset:2048
v_mfma_f32_16x16x32_bf16 a[112:115], a[208:211], v[204:207], a[112:115]
s_lshl_b32 s73, s59, 12
ds_read_b64 a[146:147], v6 offset:2056
ds_read_b128 a[208:211], v7 offset:1536
v_mfma_f32_16x16x32_bf16 a[112:115], a[240:243], v[220:223], a[112:115]
s_add_u32 s73, s73, 0x2000000
v_mfma_f32_16x16x32_bf16 a[116:119], a[244:247], v[220:223], a[116:119]
s_lshl_b32 s70, s68, 2
ds_read_b64 a[148:149], v6 offset:2560
ds_read_b64 a[150:151], v6 offset:2568
v_mfma_f32_16x16x32_bf16 a[116:119], a[212:215], v[204:207], a[116:119]
s_add_u32 s70, s70, s73
ds_read_b128 a[212:215], v7 offset:1024
ds_read_b64 a[152:153], v6 offset:3072
v_mfma_f32_16x16x32_bf16 a[120:123], a[216:219], v[204:207], a[120:123]
ds_read_b64 a[154:155], v6 offset:3080
ds_read_b128 a[216:219], v7 offset:512
v_mfma_f32_16x16x32_bf16 a[120:123], a[248:251], v[220:223], a[120:123]
v_mfma_f32_16x16x32_bf16 a[124:127], a[252:255], v[220:223], a[124:127]
s_xor_b32 s71, s12, 0x80
ds_read_b64 a[156:157], v6 offset:3584
ds_read_b64 a[158:159], v6 offset:3592
v_mfma_f32_16x16x32_bf16 a[124:127], a[220:223], v[204:207], a[124:127]
s_add_u32 m0, s77, 0
ds_read_b128 a[220:223], v7 offset:0
s_waitcnt lgkmcnt(0)
v_mfma_f32_16x16x32_bf16 v[128:131], v[8:11], a[192:195], 0
s_add_u32 s72, s71, 0
buffer_load_dwordx4 v15, s[24:27], s72 offen lds
v_mfma_f32_16x16x32_bf16 v[128:131], a[128:131], a[192:195], v[128:131]
v_mfma_f32_16x16x32_bf16 v[132:135], v[8:11], a[196:199], 0
ds_read_b128 a[224:227], v7 offset:3648
ds_read_b64 a[160:161], v6 offset:64
v_mfma_f32_16x16x32_bf16 v[132:135], a[128:131], a[196:199], v[132:135]
v_accvgpr_read_b32 v240, a64
v_accvgpr_read_b32 v241, a65
v_accvgpr_read_b32 v242, a66
v_mfma_f32_16x16x32_bf16 v[132:135], a[132:135], a[192:195], v[132:135]
s_add_u32 s72, s71, 15360
buffer_load_dwordx4 v15, s[24:27], s72 offen offset:1024 lds
v_accvgpr_read_b32 v243, a67
v_mfma_f32_16x16x32_bf16 v[136:139], v[8:11], a[200:203], 0
ds_read_b64 a[162:163], v6 offset:72
ds_read_b128 a[228:231], v7 offset:3136
v_mfma_f32_16x16x32_bf16 v[136:139], a[128:131], a[200:203], v[136:139]
s_lshl_b32 s95, s75, 20
v_rcp_f32 v232, v232
v_mfma_f32_16x16x32_bf16 v[136:139], a[132:135], a[196:199], v[136:139]
s_lshl_b32 s74, s58, 18
v_rcp_f32 v236, v236
v_accvgpr_read_b32 v244, a68
v_mfma_f32_16x16x32_bf16 v[136:139], a[136:139], a[192:195], v[136:139]
s_add_u32 s95, s95, s74
ds_read_b64 a[164:165], v6 offset:576
ds_read_b64 a[166:167], v6 offset:584
v_accvgpr_read_b32 v245, a69
v_mfma_f32_16x16x32_bf16 v[140:143], v[8:11], a[204:207], 0
s_add_u32 s72, s71, 30720
buffer_load_dwordx4 v15, s[24:27], s72 offen offset:2048 lds
v_accvgpr_read_b32 v246, a70
v_mfma_f32_16x16x32_bf16 v[140:143], a[128:131], a[204:207], v[140:143]
s_add_u32 s95, s95, 0x2000000
v_accvgpr_read_b32 v247, a71
v_mul_f32 v240, v240, v232
v_mul_f32 v241, v241, v232
v_mfma_f32_16x16x32_bf16 v[140:143], a[132:135], a[200:203], v[140:143]
s_sub_u32 s74, 15, s75
ds_read_b128 a[232:235], v7 offset:2624
ds_read_b64 a[168:169], v6 offset:1088
v_mul_f32 v242, v242, v232
v_mfma_f32_16x16x32_bf16 v[140:143], a[136:139], a[196:199], v[140:143]
s_add_u32 s72, s71, 46080
buffer_load_dwordx4 v15, s[24:27], s72 offen offset:3072 lds
v_mul_f32 v243, v243, v232
v_mfma_f32_16x16x32_bf16 v[140:143], a[140:143], a[192:195], v[140:143]
s_min_u32 s74, s74, s75
v_mul_f32 v244, v244, v232
v_mul_f32 v245, v245, v232
v_mul_f32 v246, v246, v232
v_mfma_f32_16x16x32_bf16 v[144:147], v[8:11], a[208:211], 0
s_lshl_b32 s74, s74, 7
ds_read_b64 a[170:171], v6 offset:1096
ds_read_b128 a[236:239], v7 offset:2112
v_mul_f32 v247, v247, v232
v_mfma_f32_16x16x32_bf16 v[144:147], a[128:131], a[208:211], v[144:147]
s_add_u32 s74, s74, 0x3810000
v_cvt_pk_bf16_f32 v240, v240, v241
v_cvt_pk_bf16_f32 v241, v242, v243
v_cvt_pk_bf16_f32 v242, v244, v245
v_mfma_f32_16x16x32_bf16 v[144:147], a[132:135], a[204:207], v[144:147]
s_xor_b32 s85, s77, 0x10000
v_cvt_pk_bf16_f32 v243, v246, v247
v_mfma_f32_16x16x32_bf16 v[144:147], a[136:139], a[200:203], v[144:147]
ds_read_b64 a[172:173], v6 offset:1600
ds_read_b64 a[174:175], v6 offset:1608
v_mfma_f32_16x16x32_bf16 v[144:147], a[140:143], a[196:199], v[144:147]
buffer_store_dwordx4 v[240:243], v1, s[44:47], s70 offen sc1
v_mfma_f32_16x16x32_bf16 v[144:147], a[144:147], a[192:195], v[144:147]
v_accvgpr_read_b32 v248, a72
v_accvgpr_read_b32 v249, a73
v_accvgpr_read_b32 v250, a74
v_mfma_f32_16x16x32_bf16 v[148:151], v[8:11], a[212:215], 0
ds_read_b128 a[240:243], v7 offset:1600
ds_read_b64 a[176:177], v6 offset:2112
v_accvgpr_read_b32 v251, a75
v_mfma_f32_16x16x32_bf16 v[148:151], a[128:131], a[212:215], v[148:151]
v_accvgpr_read_b32 v252, a76
v_accvgpr_read_b32 v253, a77
v_accvgpr_read_b32 v254, a78
v_mfma_f32_16x16x32_bf16 v[148:151], a[132:135], a[208:211], v[148:151]
v_accvgpr_read_b32 v255, a79
v_mul_f32 v248, v248, v232
v_mul_f32 v249, v249, v232
v_mfma_f32_16x16x32_bf16 v[148:151], a[136:139], a[204:207], v[148:151]
ds_read_b64 a[178:179], v6 offset:2120
ds_read_b128 a[244:247], v7 offset:1088
v_mul_f32 v250, v250, v232
v_mfma_f32_16x16x32_bf16 v[148:151], a[140:143], a[200:203], v[148:151]
v_mul_f32 v251, v251, v232
v_mul_f32 v252, v252, v232
v_mul_f32 v253, v253, v232
v_mfma_f32_16x16x32_bf16 v[148:151], a[144:147], a[196:199], v[148:151]
v_mul_f32 v254, v254, v232
v_mul_f32 v255, v255, v232
v_cvt_pk_bf16_f32 v248, v248, v249
v_mfma_f32_16x16x32_bf16 v[148:151], a[148:151], a[192:195], v[148:151]
ds_read_b64 a[180:181], v6 offset:2624
ds_read_b64 a[182:183], v6 offset:2632
v_cvt_pk_bf16_f32 v249, v250, v251
v_mfma_f32_16x16x32_bf16 v[152:155], v[8:11], a[216:219], 0
Lstub8:
s_cbranch_execz Lret
v_cvt_pk_bf16_f32 v250, v252, v253
v_cvt_pk_bf16_f32 v251, v254, v255
v_mfma_f32_16x16x32_bf16 v[152:155], a[128:131], a[216:219], v[152:155]
buffer_store_dwordx4 v[248:251], v1, s[44:47], s70 offen offset:1024 sc1
v_mfma_f32_16x16x32_bf16 v[152:155], a[132:135], a[212:215], v[152:155]
ds_read_b128 a[248:251], v7 offset:576
ds_read_b64 a[184:185], v6 offset:3136
v_accvgpr_read_b32 v240, a80
v_mfma_f32_16x16x32_bf16 v[152:155], a[136:139], a[208:211], v[152:155]
v_accvgpr_read_b32 v241, a81
v_accvgpr_read_b32 v242, a82
v_accvgpr_read_b32 v243, a83
v_mfma_f32_16x16x32_bf16 v[152:155], a[140:143], a[204:207], v[152:155]
v_accvgpr_read_b32 v244, a84
v_accvgpr_read_b32 v245, a85
v_accvgpr_read_b32 v246, a86
v_mfma_f32_16x16x32_bf16 v[152:155], a[144:147], a[200:203], v[152:155]
ds_read_b64 a[186:187], v6 offset:3144
ds_read_b128 a[252:255], v7 offset:64
v_accvgpr_read_b32 v247, a87
v_mfma_f32_16x16x32_bf16 v[152:155], a[148:151], a[196:199], v[152:155]
v_mul_f32 v240, v240, v232
v_mul_f32 v241, v241, v232
v_mul_f32 v242, v242, v232
v_mfma_f32_16x16x32_bf16 v[152:155], a[152:155], a[192:195], v[152:155]
v_mul_f32 v243, v243, v232
v_mul_f32 v244, v244, v232
v_mul_f32 v245, v245, v232
v_mfma_f32_16x16x32_bf16 v[156:159], v[8:11], a[220:223], 0
ds_read_b64 a[188:189], v6 offset:3648
ds_read_b64 a[190:191], v6 offset:3656
v_mul_f32 v246, v246, v232
v_mfma_f32_16x16x32_bf16 v[156:159], a[128:131], a[220:223], v[156:159]
v_mul_f32 v247, v247, v232
v_cvt_pk_bf16_f32 v240, v240, v241
v_cvt_pk_bf16_f32 v241, v242, v243
v_mfma_f32_16x16x32_bf16 v[156:159], a[132:135], a[216:219], v[156:159]
v_cvt_pk_bf16_f32 v242, v244, v245
v_cvt_pk_bf16_f32 v243, v246, v247
v_mfma_f32_16x16x32_bf16 v[156:159], a[136:139], a[212:215], v[156:159]
buffer_store_dwordx4 v[240:243], v1, s[44:47], s70 offen offset:2048 sc1
v_mfma_f32_16x16x32_bf16 v[156:159], a[140:143], a[208:211], v[156:159]
v_accvgpr_read_b32 v248, a88
v_accvgpr_read_b32 v249, a89
v_accvgpr_read_b32 v250, a90
v_mfma_f32_16x16x32_bf16 v[156:159], a[144:147], a[204:207], v[156:159]
v_accvgpr_read_b32 v251, a91
v_accvgpr_read_b32 v252, a92
v_accvgpr_read_b32 v253, a93
v_mfma_f32_16x16x32_bf16 v[156:159], a[148:151], a[200:203], v[156:159]
v_accvgpr_read_b32 v254, a94
v_accvgpr_read_b32 v255, a95
v_mul_f32 v248, v248, v232
v_mfma_f32_16x16x32_bf16 v[156:159], a[152:155], a[196:199], v[156:159]
v_mul_f32 v249, v249, v232
v_mul_f32 v250, v250, v232
v_mul_f32 v251, v251, v232
v_mfma_f32_16x16x32_bf16 v[156:159], a[156:159], a[192:195], v[156:159]
s_waitcnt lgkmcnt(0)
v_mul_f32 v252, v252, v232
v_mul_f32 v253, v253, v232
v_mul_f32 v254, v254, v232
v_mfma_f32_16x16x32_bf16 v[128:131], a[160:163], a[224:227], v[128:131]
ds_read_b128 a[192:195], v7 offset:3712
ds_read_b64 a[128:129], v6 offset:128
v_mul_f32 v255, v255, v232
v_mfma_f32_16x16x32_bf16 v[132:135], a[164:167], a[224:227], v[132:135]
v_cvt_pk_bf16_f32 v248, v248, v249
v_cvt_pk_bf16_f32 v249, v250, v251
v_cvt_pk_bf16_f32 v250, v252, v253
v_mfma_f32_16x16x32_bf16 v[132:135], a[160:163], a[228:231], v[132:135]
ds_read_b64 a[130:131], v6 offset:136
ds_read_b128 a[196:199], v7 offset:3200
v_cvt_pk_bf16_f32 v251, v254, v255
v_mfma_f32_16x16x32_bf16 v[136:139], a[160:163], a[232:235], v[136:139]
buffer_store_dwordx4 v[248:251], v1, s[44:47], s70 offen offset:3072 sc1
v_mfma_f32_16x16x32_bf16 v[136:139], a[164:167], a[228:231], v[136:139]
s_add_u32 s70, s70, 0x80000
v_accvgpr_read_b32 v240, a96
v_accvgpr_read_b32 v241, a97
v_accvgpr_read_b32 v242, a98
v_mfma_f32_16x16x32_bf16 v[136:139], a[168:171], a[224:227], v[136:139]
ds_read_b64 a[132:133], v6 offset:640
ds_read_b64 a[134:135], v6 offset:648
v_accvgpr_read_b32 v243, a99
v_mfma_f32_16x16x32_bf16 v[140:143], a[172:175], a[224:227], v[140:143]
v_accvgpr_read_b32 v244, a100
v_accvgpr_read_b32 v245, a101
v_accvgpr_read_b32 v246, a102
v_mfma_f32_16x16x32_bf16 v[140:143], a[168:171], a[228:231], v[140:143]
ds_read_b128 a[200:203], v7 offset:2688
ds_read_b64 a[136:137], v6 offset:1152
v_accvgpr_read_b32 v247, a103
v_mfma_f32_16x16x32_bf16 v[140:143], a[164:167], a[232:235], v[140:143]
v_mul_f32 v240, v240, v236
v_mul_f32 v241, v241, v236
v_mul_f32 v242, v242, v236
v_mfma_f32_16x16x32_bf16 v[140:143], a[160:163], a[236:239], v[140:143]
v_mul_f32 v243, v243, v236
v_mul_f32 v244, v244, v236
v_mul_f32 v245, v245, v236
v_mfma_f32_16x16x32_bf16 v[144:147], a[160:163], a[240:243], v[144:147]
ds_read_b64 a[138:139], v6 offset:1160
ds_read_b128 a[204:207], v7 offset:2176
v_mul_f32 v246, v246, v236
v_mfma_f32_16x16x32_bf16 v[144:147], a[164:167], a[236:239], v[144:147]
v_mul_f32 v247, v247, v236
v_cvt_pk_bf16_f32 v240, v240, v241
v_cvt_pk_bf16_f32 v241, v242, v243
v_mfma_f32_16x16x32_bf16 v[144:147], a[168:171], a[232:235], v[144:147]
ds_read_b64 a[140:141], v6 offset:1664
ds_read_b64 a[142:143], v6 offset:1672
v_cvt_pk_bf16_f32 v242, v244, v245
v_mfma_f32_16x16x32_bf16 v[144:147], a[172:175], a[228:231], v[144:147]
v_cvt_pk_bf16_f32 v243, v246, v247
v_mfma_f32_16x16x32_bf16 v[144:147], a[176:179], a[224:227], v[144:147]
buffer_store_dwordx4 v[240:243], v1, s[44:47], s70 offen sc1
v_mfma_f32_16x16x32_bf16 v[148:151], a[180:183], a[224:227], v[148:151]
ds_read_b128 a[208:211], v7 offset:1664
ds_read_b64 a[144:145], v6 offset:2176
v_accvgpr_read_b32 v248, a104
v_mfma_f32_16x16x32_bf16 v[148:151], a[176:179], a[228:231], v[148:151]
v_accvgpr_read_b32 v249, a105
v_accvgpr_read_b32 v250, a106
v_accvgpr_read_b32 v251, a107
v_mfma_f32_16x16x32_bf16 v[148:151], a[172:175], a[232:235], v[148:151]
v_accvgpr_read_b32 v252, a108
v_accvgpr_read_b32 v253, a109
v_accvgpr_read_b32 v254, a110
v_mfma_f32_16x16x32_bf16 v[148:151], a[168:171], a[236:239], v[148:151]
ds_read_b64 a[146:147], v6 offset:2184
ds_read_b128 a[212:215], v7 offset:1152
v_accvgpr_read_b32 v255, a111
v_mfma_f32_16x16x32_bf16 v[148:151], a[164:167], a[240:243], v[148:151]
v_mul_f32 v248, v248, v236
v_mul_f32 v249, v249, v236
v_mul_f32 v250, v250, v236
v_mfma_f32_16x16x32_bf16 v[148:151], a[160:163], a[244:247], v[148:151]
ds_read_b64 a[148:149], v6 offset:2688
ds_read_b64 a[150:151], v6 offset:2696
v_mul_f32 v251, v251, v236
v_mfma_f32_16x16x32_bf16 v[152:155], a[160:163], a[248:251], v[152:155]
v_mul_f32 v252, v252, v236
v_mul_f32 v253, v253, v236
v_mul_f32 v254, v254, v236
v_mfma_f32_16x16x32_bf16 v[152:155], a[164:167], a[244:247], v[152:155]
v_mul_f32 v255, v255, v236
v_cvt_pk_bf16_f32 v248, v248, v249
v_cvt_pk_bf16_f32 v249, v250, v251
v_mfma_f32_16x16x32_bf16 v[152:155], a[168:171], a[240:243], v[152:155]
ds_read_b128 a[216:219], v7 offset:640
ds_read_b64 a[152:153], v6 offset:3200
v_cvt_pk_bf16_f32 v250, v252, v253
v_mfma_f32_16x16x32_bf16 v[152:155], a[172:175], a[236:239], v[152:155]
v_cvt_pk_bf16_f32 v251, v254, v255
v_mfma_f32_16x16x32_bf16 v[152:155], a[176:179], a[232:235], v[152:155]
ds_read_b64 a[154:155], v6 offset:3208
ds_read_b128 a[220:223], v7 offset:128
v_mfma_f32_16x16x32_bf16 v[152:155], a[180:183], a[228:231], v[152:155]
buffer_store_dwordx4 v[248:251], v1, s[44:47], s70 offen offset:1024 sc1
v_mfma_f32_16x16x32_bf16 v[152:155], a[184:187], a[224:227], v[152:155]
v_accvgpr_read_b32 v240, a112
v_accvgpr_read_b32 v241, a113
v_accvgpr_read_b32 v242, a114
v_mfma_f32_16x16x32_bf16 v[156:159], a[188:191], a[224:227], v[156:159]
ds_read_b64 a[156:157], v6 offset:3712
ds_read_b64 a[158:159], v6 offset:3720
v_accvgpr_read_b32 v243, a115
v_mfma_f32_16x16x32_bf16 v[156:159], a[184:187], a[228:231], v[156:159]
v_accvgpr_read_b32 v244, a116
v_accvgpr_read_b32 v245, a117
v_accvgpr_read_b32 v246, a118
v_mfma_f32_16x16x32_bf16 v[156:159], a[180:183], a[232:235], v[156:159]
v_accvgpr_read_b32 v247, a119
v_mul_f32 v240, v240, v236
v_mul_f32 v241, v241, v236
v_mfma_f32_16x16x32_bf16 v[156:159], a[176:179], a[236:239], v[156:159]
v_mul_f32 v242, v242, v236
v_mul_f32 v243, v243, v236
v_mul_f32 v244, v244, v236
v_mfma_f32_16x16x32_bf16 v[156:159], a[172:175], a[240:243], v[156:159]
v_mul_f32 v245, v245, v236
v_mul_f32 v246, v246, v236
v_mul_f32 v247, v247, v236
v_mfma_f32_16x16x32_bf16 v[156:159], a[168:171], a[244:247], v[156:159]
v_cvt_pk_bf16_f32 v240, v240, v241
v_cvt_pk_bf16_f32 v241, v242, v243
v_cvt_pk_bf16_f32 v242, v244, v245
v_mfma_f32_16x16x32_bf16 v[156:159], a[164:167], a[248:251], v[156:159]
v_cvt_pk_bf16_f32 v243, v246, v247
v_mfma_f32_16x16x32_bf16 v[156:159], a[160:163], a[252:255], v[156:159]
s_waitcnt lgkmcnt(0)
buffer_store_dwordx4 v[240:243], v1, s[44:47], s70 offen offset:2048 sc1
v_mfma_f32_16x16x32_bf16 v[128:131], a[128:131], a[192:195], v[128:131]
ds_read_b128 a[224:227], v7 offset:3776
ds_read_b64 a[160:161], v6 offset:192
v_accvgpr_read_b32 v248, a120
v_mfma_f32_16x16x32_bf16 v[132:135], a[132:135], a[192:195], v[132:135]
v_accvgpr_read_b32 v249, a121
v_accvgpr_read_b32 v250, a122
v_accvgpr_read_b32 v251, a123
v_mfma_f32_16x16x32_bf16 v[132:135], a[128:131], a[196:199], v[132:135]
ds_read_b64 a[162:163], v6 offset:200
ds_read_b128 a[228:231], v7 offset:3264
v_accvgpr_read_b32 v252, a124
v_mfma_f32_16x16x32_bf16 v[136:139], a[128:131], a[200:203], v[136:139]
v_accvgpr_read_b32 v253, a125
v_accvgpr_read_b32 v254, a126
v_accvgpr_read_b32 v255, a127
v_mfma_f32_16x16x32_bf16 v[136:139], a[132:135], a[196:199], v[136:139]
v_mul_f32 v248, v248, v236
v_mul_f32 v249, v249, v236
v_mul_f32 v250, v250, v236
v_mfma_f32_16x16x32_bf16 v[136:139], a[136:139], a[192:195], v[136:139]
ds_read_b64 a[164:165], v6 offset:704
ds_read_b64 a[166:167], v6 offset:712
v_mul_f32 v251, v251, v236
v_mfma_f32_16x16x32_bf16 v[140:143], a[140:143], a[192:195], v[140:143]
v_mul_f32 v252, v252, v236
v_mul_f32 v253, v253, v236
v_mul_f32 v254, v254, v236
v_mfma_f32_16x16x32_bf16 v[140:143], a[136:139], a[196:199], v[140:143]
ds_read_b128 a[232:235], v7 offset:2752
ds_read_b64 a[168:169], v6 offset:1216
v_mul_f32 v255, v255, v236
v_mfma_f32_16x16x32_bf16 v[140:143], a[132:135], a[200:203], v[140:143]
v_cvt_pk_bf16_f32 v248, v248, v249
v_cvt_pk_bf16_f32 v249, v250, v251
v_cvt_pk_bf16_f32 v250, v252, v253
v_mfma_f32_16x16x32_bf16 v[140:143], a[128:131], a[204:207], v[140:143]
v_cvt_pk_bf16_f32 v251, v254, v255
v_mfma_f32_16x16x32_bf16 v[144:147], a[128:131], a[208:211], v[144:147]
ds_read_b64 a[170:171], v6 offset:1224
ds_read_b128 a[236:239], v7 offset:2240
v_mfma_f32_16x16x32_bf16 v[144:147], a[132:135], a[204:207], v[144:147]
buffer_store_dwordx4 v[248:251], v1, s[44:47], s70 offen offset:3072 sc1
v_mfma_f32_16x16x32_bf16 v[144:147], a[136:139], a[200:203], v[144:147]
s_mov_b32 s73, 0x5d800000
ds_read_b64 a[172:173], v6 offset:1728
ds_read_b64 a[174:175], v6 offset:1736
v_add_f32 v227, v226, v230
v_mfma_f32_16x16x32_bf16 v[144:147], a[140:143], a[196:199], v[144:147]
v_add_f32 v231, v234, v238
v_add_f32 v227, v227, v231
v_cmp_nlt_f32 vcc, v227, s73
v_mfma_f32_16x16x32_bf16 v[144:147], a[144:147], a[192:195], v[144:147]
s_lshl_b32 s73, s58, 2
v_mfma_f32_16x16x32_bf16 v[148:151], a[148:151], a[192:195], v[148:151]
s_add_u32 s73, s73, 163328
ds_read_b128 a[240:243], v7 offset:1728
ds_read_b64 a[176:177], v6 offset:2240
v_mov_b32 v231, s73
v_mfma_f32_16x16x32_bf16 v[148:151], a[144:147], a[196:199], v[148:151]
s_or_b32 s73, vcc_lo, vcc_hi
v_mfma_f32_16x16x32_bf16 v[148:151], a[140:143], a[200:203], v[148:151]
s_min_u32 s73, s73, 1
v_mov_b32 v227, s73
v_mfma_f32_16x16x32_bf16 v[148:151], a[136:139], a[204:207], v[148:151]
ds_read_b64 a[178:179], v6 offset:2248
ds_read_b128 a[244:247], v7 offset:1216
ds_write_b32 v231, v227
v_mfma_f32_16x16x32_bf16 v[148:151], a[132:135], a[208:211], v[148:151]
v_mfma_f32_16x16x32_bf16 v[148:151], a[128:131], a[212:215], v[148:151]
ds_read_b64 a[180:181], v6 offset:2752
ds_read_b64 a[182:183], v6 offset:2760
v_mfma_f32_16x16x32_bf16 v[152:155], a[128:131], a[216:219], v[152:155]
v_mfma_f32_16x16x32_bf16 v[152:155], a[132:135], a[212:215], v[152:155]
v_mfma_f32_16x16x32_bf16 v[152:155], a[136:139], a[208:211], v[152:155]
ds_read_b128 a[248:251], v7 offset:704
ds_read_b64 a[184:185], v6 offset:3264
v_mfma_f32_16x16x32_bf16 v[152:155], a[140:143], a[204:207], v[152:155]
v_mfma_f32_16x16x32_bf16 v[152:155], a[144:147], a[200:203], v[152:155]
s_xor_b32 s71, s12, 0x100
ds_read_b64 a[186:187], v6 offset:3272
ds_read_b128 a[252:255], v7 offset:192
v_mfma_f32_16x16x32_bf16 v[152:155], a[148:151], a[196:199], v[152:155]
s_add_u32 m0, s77, 16384
v_mfma_f32_16x16x32_bf16 v[152:155], a[152:155], a[192:195], v[152:155]
s_add_u32 s72, s71, 0
buffer_load_dwordx4 v15, s[24:27], s72 offen lds
v_mfma_f32_16x16x32_bf16 v[156:159], a[156:159], a[192:195], v[156:159]
ds_read_b64 a[188:189], v6 offset:3776
ds_read_b64 a[190:191], v6 offset:3784
v_mfma_f32_16x16x32_bf16 v[156:159], a[152:155], a[196:199], v[156:159]
v_mfma_f32_16x16x32_bf16 v[156:159], a[148:151], a[200:203], v[156:159]
s_add_u32 s72, s71, 15360
buffer_load_dwordx4 v15, s[24:27], s72 offen offset:1024 lds
v_mfma_f32_16x16x32_bf16 v[156:159], a[144:147], a[204:207], v[156:159]
v_mfma_f32_16x16x32_bf16 v[156:159], a[140:143], a[208:211], v[156:159]
v_mfma_f32_16x16x32_bf16 v[156:159], a[136:139], a[212:215], v[156:159]
v_mfma_f32_16x16x32_bf16 v[156:159], a[132:135], a[216:219], v[156:159]
v_mfma_f32_16x16x32_bf16 v[156:159], a[128:131], a[220:223], v[156:159]
s_waitcnt lgkmcnt(0)
v_mfma_f32_16x16x32_bf16 v[128:131], a[160:163], a[224:227], v[128:131]
s_add_u32 s72, s71, 30720
ds_read_b128 a[192:195], v7 offset:3840
ds_read_b64 a[128:129], v6 offset:256
s_nop 3
s_mov_b64 exec, 0
s_cmp_eq_u32 s58, 0
s_cbranch_scc1 Lstube0
s_cmp_eq_u32 s58, 1
s_cbranch_scc1 Lstube1
s_cmp_eq_u32 s58, 2
s_cbranch_scc1 Lstube2
s_branch Lstube3
Lrete:
s_mov_b64 exec, -1
s_nop 3
v_mfma_f32_16x16x32_bf16 v[132:135], a[164:167], a[224:227], v[132:135]
s_waitcnt vmcnt(2) lgkmcnt(10)
buffer_load_dwordx4 v15, s[24:27], s72 offen offset:2048 lds
v_mfma_f32_16x16x32_bf16 v[132:135], a[160:163], a[228:231], v[132:135]
s_barrier
ds_read_b64 a[130:131], v6 offset:264
ds_read_b128 a[196:199], v7 offset:3328
v_mfma_f32_16x16x32_bf16 v[136:139], a[160:163], a[232:235], v[136:139]
v_mov_b32 v244, 163328
v_mfma_f32_16x16x32_bf16 v[136:139], a[164:167], a[228:231], v[136:139]
ds_read_b128 v[240:243], v244
v_mfma_f32_16x16x32_bf16 v[136:139], a[168:171], a[224:227], v[136:139]
ds_read_b64 a[132:133], v6 offset:768
ds_read_b64 a[134:135], v6 offset:776
v_mfma_f32_16x16x32_bf16 v[140:143], a[172:175], a[224:227], v[140:143]
s_add_u32 s72, s71, 46080
buffer_load_dwordx4 v15, s[24:27], s72 offen offset:3072 lds
v_mfma_f32_16x16x32_bf16 v[140:143], a[168:171], a[228:231], v[140:143]
ds_read_b128 a[200:203], v7 offset:2816
ds_read_b64 a[136:137], v6 offset:1280
v_mfma_f32_16x16x32_bf16 v[140:143], a[164:167], a[232:235], v[140:143]
v_mfma_f32_16x16x32_bf16 v[140:143], a[160:163], a[236:239], v[140:143]
s_waitcnt lgkmcnt(4)
v_or3_b32 v240, v240, v241, v242
v_or_b32 v240, v240, v243
v_mfma_f32_16x16x32_bf16 v[144:147], a[160:163], a[240:243], v[144:147]
ds_read_b64 a[138:139], v6 offset:1288
ds_read_b128 a[204:207], v7 offset:2304
v_cmp_lt_u32 vcc, s86, v240
s_cbranch_vccnz Lslow
v_mfma_f32_16x16x32_bf16 v[144:147], a[164:167], a[236:239], v[144:147]
v_or_b32 v240, s58, v0
v_mov_b32 v241, 2
v_mfma_f32_16x16x32_bf16 v[144:147], a[168:171], a[232:235], v[144:147]
s_xor_b32 s71, s12, 0x180
ds_read_b64 a[140:141], v6 offset:1792
ds_read_b64 a[142:143], v6 offset:1800
v_mfma_f32_16x16x32_bf16 v[144:147], a[172:175], a[228:231], v[144:147]
s_add_u32 m0, s77, 32768
v_min_u32 v240, 1, v240
v_lshlrev_b32 v240, 30, v240
v_mfma_f32_16x16x32_bf16 v[144:147], a[176:179], a[224:227], v[144:147]
s_add_u32 s72, s71, 0
buffer_load_dwordx4 v15, s[24:27], s72 offen lds
v_mfma_f32_16x16x32_bf16 v[148:151], a[180:183], a[224:227], v[148:151]
ds_read_b128 a[208:211], v7 offset:1792
ds_read_b64 a[144:145], v6 offset:2304
v_mfma_f32_16x16x32_bf16 v[148:151], a[176:179], a[228:231], v[148:151]
buffer_store_dword v241, v240, s[44:47], s91 offen sc1
v_mfma_f32_16x16x32_bf16 v[148:151], a[172:175], a[232:235], v[148:151]
s_add_u32 s80, s93, 0x3400000
v_and_b32 v166, 7, v0
v_lshlrev_b32 v166, 4, v166
v_mfma_f32_16x16x32_bf16 v[148:151], a[168:171], a[236:239], v[148:151]
s_add_u32 s72, s71, 15360
ds_read_b64 a[146:147], v6 offset:2312
ds_read_b128 a[212:215], v7 offset:1280
v_mfma_f32_16x16x32_bf16 v[148:151], a[164:167], a[240:243], v[148:151]
buffer_load_dwordx4 v15, s[24:27], s72 offen offset:1024 lds
v_mfma_f32_16x16x32_bf16 v[148:151], a[160:163], a[244:247], v[148:151]
ds_read_b64 a[148:149], v6 offset:2816
ds_read_b64 a[150:151], v6 offset:2824
v_mfma_f32_16x16x32_bf16 v[152:155], a[160:163], a[248:251], v[152:155]
v_bfe_u32 v112, v0, 3, 1
v_lshl_add_u32 v166, v112, 8, v166
v_mfma_f32_16x16x32_bf16 v[152:155], a[164:167], a[244:247], v[152:155]
v_bfe_u32 v112, v0, 4, 1
v_lshl_add_u32 v166, v112, 7, v166
v_mfma_f32_16x16x32_bf16 v[152:155], a[168:171], a[240:243], v[152:155]
ds_read_b128 a[216:219], v7 offset:768
ds_read_b64 a[152:153], v6 offset:3328
v_mfma_f32_16x16x32_bf16 v[152:155], a[172:175], a[236:239], v[152:155]
s_add_u32 s72, s71, 30720
buffer_load_dwordx4 v15, s[24:27], s72 offen offset:2048 lds
v_mfma_f32_16x16x32_bf16 v[152:155], a[176:179], a[232:235], v[152:155]
ds_read_b64 a[154:155], v6 offset:3336
ds_read_b128 a[220:223], v7 offset:256
v_mfma_f32_16x16x32_bf16 v[152:155], a[180:183], a[228:231], v[152:155]
v_lshrrev_b32 v112, 5, v0
v_lshl_add_u32 v166, v112, 9, v166
v_mfma_f32_16x16x32_bf16 v[152:155], a[184:187], a[224:227], v[152:155]
v_and_b32 v112, 15, v0
v_lshrrev_b32 v113, 2, v0
v_mfma_f32_16x16x32_bf16 v[156:159], a[188:191], a[224:227], v[156:159]
ds_read_b64 a[156:157], v6 offset:3840
ds_read_b64 a[158:159], v6 offset:3848
v_mfma_f32_16x16x32_bf16 v[156:159], a[184:187], a[228:231], v[156:159]
v_bfe_u32 v114, v0, 3, 2
v_and_b32 v115, 3, v0
v_mfma_f32_16x16x32_bf16 v[156:159], a[180:183], a[232:235], v[156:159]
s_add_u32 s72, s71, 46080
buffer_load_dwordx4 v15, s[24:27], s72 offen offset:3072 lds
v_mfma_f32_16x16x32_bf16 v[156:159], a[176:179], a[236:239], v[156:159]
v_lshlrev_b32 v8, 7, v113
v_lshl_add_u32 v8, v114, 5, v8
v_mfma_f32_16x16x32_bf16 v[156:159], a[172:175], a[240:243], v[156:159]
v_lshl_add_u32 v8, v115, 3, v8
v_add_u32 v8, s77, v8
v_mfma_f32_16x16x32_bf16 v[156:159], a[168:171], a[244:247], v[156:159]
v_subrev_u32 v8, s64, v8
v_xor_b32 v9, 32, v8
v_mfma_f32_16x16x32_bf16 v[156:159], a[164:167], a[248:251], v[156:159]
v_lshrrev_b32 v2, 4, v0
v_lshlrev_b32 v2, 10, v2
v_mfma_f32_16x16x32_bf16 v[156:159], a[160:163], a[252:255], v[156:159]
s_waitcnt lgkmcnt(0)
v_xor_b32 v10, 64, v8
v_xor_b32 v11, 0x60, v8
v_mfma_f32_16x16x32_bf16 v[128:131], a[128:131], a[192:195], v[128:131]
s_xor_b32 s71, s13, 0x80
ds_read_b128 a[224:227], v7 offset:3904
ds_read_b64 a[160:161], v6 offset:320
v_mfma_f32_16x16x32_bf16 v[132:135], a[132:135], a[192:195], v[132:135]
s_add_u32 m0, s77, 49152
v_lshlrev_b32 v5, 8, v113
v_and_b32 v114, 1, v0
v_mfma_f32_16x16x32_bf16 v[132:135], a[128:131], a[196:199], v[132:135]
s_add_u32 s72, s71, 0
ds_read_b64 a[162:163], v6 offset:328
ds_read_b128 a[228:231], v7 offset:3392
v_mfma_f32_16x16x32_bf16 v[136:139], a[128:131], a[200:203], v[136:139]
s_xor_b32 s82, s78, 0
buffer_load_dwordx4 v15, s[24:27], s72 offen lds
v_mfma_f32_16x16x32_bf16 v[136:139], a[132:135], a[196:199], v[136:139]
s_lshl_b32 s82, s82, 10
v_lshl_add_u32 v5, v114, 7, v5
v_bfe_u32 v114, v0, 1, 1
v_mfma_f32_16x16x32_bf16 v[136:139], a[136:139], a[192:195], v[136:139]
s_add_u32 s82, s82, s74
ds_read_b64 a[164:165], v6 offset:832
ds_read_b64 a[166:167], v6 offset:840
v_mfma_f32_16x16x32_bf16 v[140:143], a[140:143], a[192:195], v[140:143]
s_add_u32 s72, s71, 15360
buffer_load_dwordx4 v15, s[24:27], s72 offen offset:1024 lds
v_mfma_f32_16x16x32_bf16 v[140:143], a[136:139], a[196:199], v[140:143]
ds_read_b128 a[232:235], v7 offset:2880
ds_read_b64 a[168:169], v6 offset:1344
v_mfma_f32_16x16x32_bf16 v[140:143], a[132:135], a[200:203], v[140:143]
buffer_load_dword v3, v2, s[44:47], s82 offen sc1
v_mfma_f32_16x16x32_bf16 v[140:143], a[128:131], a[204:207], v[140:143]
v_lshl_add_u32 v5, v114, 3, v5
v_lshlrev_b32 v114, 1, s58
v_mfma_f32_16x16x32_bf16 v[144:147], a[128:131], a[208:211], v[144:147]
ds_read_b64 a[170:171], v6 offset:1352
ds_read_b128 a[236:239], v7 offset:2368
v_mfma_f32_16x16x32_bf16 v[144:147], a[132:135], a[204:207], v[144:147]
v_xor_b32 v114, v114, v113
v_and_b32 v114, 7, v114
v_mfma_f32_16x16x32_bf16 v[144:147], a[136:139], a[200:203], v[144:147]
s_add_u32 s72, s71, 30720
ds_read_b64 a[172:173], v6 offset:1856
ds_read_b64 a[174:175], v6 offset:1864
v_mfma_f32_16x16x32_bf16 v[144:147], a[140:143], a[196:199], v[144:147]
buffer_load_dwordx4 v15, s[24:27], s72 offen offset:2048 lds
v_mfma_f32_16x16x32_bf16 v[144:147], a[144:147], a[192:195], v[144:147]
v_lshl_add_u32 v5, v114, 4, v5
v_add_u32 v5, 147456, v5
v_mfma_f32_16x16x32_bf16 v[148:151], a[148:151], a[192:195], v[148:151]
ds_read_b128 a[240:243], v7 offset:1856
ds_read_b64 a[176:177], v6 offset:2368
v_mfma_f32_16x16x32_bf16 v[148:151], a[144:147], a[196:199], v[148:151]
v_bfe_u32 v114, v0, 1, 2
v_lshrrev_b32 v115, 4, v0
v_mfma_f32_16x16x32_bf16 v[148:151], a[140:143], a[200:203], v[148:151]
v_lshlrev_b32 v116, 7, v112
v_lshl_add_u32 v116, v114, 5, v116
v_mfma_f32_16x16x32_bf16 v[148:151], a[136:139], a[204:207], v[148:151]
s_add_u32 s72, s71, 46080
ds_read_b64 a[178:179], v6 offset:2376
ds_read_b128 a[244:247], v7 offset:1344
v_mfma_f32_16x16x32_bf16 v[148:151], a[132:135], a[208:211], v[148:151]
buffer_load_dwordx4 v15, s[24:27], s72 offen offset:3072 lds
v_mfma_f32_16x16x32_bf16 v[148:151], a[128:131], a[212:215], v[148:151]
ds_read_b64 a[180:181], v6 offset:2880
ds_read_b64 a[182:183], v6 offset:2888
v_mfma_f32_16x16x32_bf16 v[152:155], a[128:131], a[216:219], v[152:155]
v_lshl_add_u32 v116, v115, 3, v116
v_add_u32 v116, s64, v116
v_mfma_f32_16x16x32_bf16 v[152:155], a[132:135], a[212:215], v[152:155]
v_add_u32 v116, 131072, v116
v_xor_b32 v117, 32, v116
v_mfma_f32_16x16x32_bf16 v[152:155], a[136:139], a[208:211], v[152:155]
ds_read_b128 a[248:251], v7 offset:832
ds_read_b64 a[184:185], v6 offset:3392
v_mfma_f32_16x16x32_bf16 v[152:155], a[140:143], a[204:207], v[152:155]
v_xor_b32 v118, 64, v116
v_xor_b32 v119, 0x60, v116
v_mfma_f32_16x16x32_bf16 v[152:155], a[144:147], a[200:203], v[152:155]
ds_read_b64 a[186:187], v6 offset:3400
ds_read_b128 a[252:255], v7 offset:320
v_mfma_f32_16x16x32_bf16 v[152:155], a[148:151], a[196:199], v[152:155]
v_mfma_f32_16x16x32_bf16 v[152:155], a[152:155], a[192:195], v[152:155]
v_mfma_f32_16x16x32_bf16 v[156:159], a[156:159], a[192:195], v[156:159]
ds_read_b64 a[188:189], v6 offset:3904
ds_read_b64 a[190:191], v6 offset:3912
v_mfma_f32_16x16x32_bf16 v[156:159], a[152:155], a[196:199], v[156:159]
v_mfma_f32_16x16x32_bf16 v[156:159], a[148:151], a[200:203], v[156:159]
v_mfma_f32_16x16x32_bf16 v[156:159], a[144:147], a[204:207], v[156:159]
v_mfma_f32_16x16x32_bf16 v[156:159], a[140:143], a[208:211], v[156:159]
v_mfma_f32_16x16x32_bf16 v[156:159], a[136:139], a[212:215], v[156:159]
v_mfma_f32_16x16x32_bf16 v[156:159], a[132:135], a[216:219], v[156:159]
v_mfma_f32_16x16x32_bf16 v[156:159], a[128:131], a[220:223], v[156:159]
s_waitcnt lgkmcnt(0)
v_mfma_f32_16x16x32_bf16 v[128:131], a[160:163], a[224:227], v[128:131]
ds_read_b128 a[192:195], v7 offset:3968
ds_read_b64 a[128:129], v6 offset:384
v_mfma_f32_16x16x32_bf16 v[132:135], a[164:167], a[224:227], v[132:135]
v_mfma_f32_16x16x32_bf16 v[132:135], a[160:163], a[228:231], v[132:135]
ds_read_b64 a[130:131], v6 offset:392
ds_read_b128 a[196:199], v7 offset:3456
v_mfma_f32_16x16x32_bf16 v[136:139], a[160:163], a[232:235], v[136:139]
v_mfma_f32_16x16x32_bf16 v[136:139], a[164:167], a[228:231], v[136:139]
v_mfma_f32_16x16x32_bf16 v[136:139], a[168:171], a[224:227], v[136:139]
ds_read_b64 a[132:133], v6 offset:896
ds_read_b64 a[134:135], v6 offset:904
v_mfma_f32_16x16x32_bf16 v[140:143], a[172:175], a[224:227], v[140:143]
v_mfma_f32_16x16x32_bf16 v[140:143], a[168:171], a[228:231], v[140:143]
ds_read_b128 a[200:203], v7 offset:2944
ds_read_b64 a[136:137], v6 offset:1408
v_mfma_f32_16x16x32_bf16 v[140:143], a[164:167], a[232:235], v[140:143]
v_mfma_f32_16x16x32_bf16 v[140:143], a[160:163], a[236:239], v[140:143]
v_mfma_f32_16x16x32_bf16 v[144:147], a[160:163], a[240:243], v[144:147]
ds_read_b64 a[138:139], v6 offset:1416
ds_read_b128 a[204:207], v7 offset:2432
v_mfma_f32_16x16x32_bf16 v[144:147], a[164:167], a[236:239], v[144:147]
v_mfma_f32_16x16x32_bf16 v[144:147], a[168:171], a[232:235], v[144:147]
ds_read_b64 a[140:141], v6 offset:1920
ds_read_b64 a[142:143], v6 offset:1928
v_mfma_f32_16x16x32_bf16 v[144:147], a[172:175], a[228:231], v[144:147]
v_mfma_f32_16x16x32_bf16 v[144:147], a[176:179], a[224:227], v[144:147]
v_mfma_f32_16x16x32_bf16 v[148:151], a[180:183], a[224:227], v[148:151]
ds_read_b128 a[208:211], v7 offset:1920
ds_read_b64 a[144:145], v6 offset:2432
v_mfma_f32_16x16x32_bf16 v[148:151], a[176:179], a[228:231], v[148:151]
v_mfma_f32_16x16x32_bf16 v[148:151], a[172:175], a[232:235], v[148:151]
s_waitcnt vmcnt(2)
v_cmp_gt_u32 vcc, 2, v3
s_or_b32 s81, vcc_lo, vcc_hi
s_cselect_b32 s81, 0x40000000, 0
v_or_b32 v4, s81, v1
v_mfma_f32_16x16x32_bf16 v[148:151], a[168:171], a[236:239], v[148:151]
ds_read_b64 a[146:147], v6 offset:2440
ds_read_b128 a[212:215], v7 offset:1408
v_mfma_f32_16x16x32_bf16 v[148:151], a[164:167], a[240:243], v[148:151]
v_mfma_f32_16x16x32_bf16 v[148:151], a[160:163], a[244:247], v[148:151]
ds_read_b64 a[148:149], v6 offset:2944
ds_read_b64 a[150:151], v6 offset:2952
v_mfma_f32_16x16x32_bf16 v[152:155], a[160:163], a[248:251], v[152:155]
v_mfma_f32_16x16x32_bf16 v[152:155], a[164:167], a[244:247], v[152:155]
s_lshr_b32 s69, s12, 18
v_mfma_f32_16x16x32_bf16 v[152:155], a[168:171], a[240:243], v[152:155]
s_lshl_b32 s69, s69, 12
ds_read_b128 a[216:219], v7 offset:896
ds_read_b64 a[152:153], v6 offset:3456
v_mfma_f32_16x16x32_bf16 v[152:155], a[172:175], a[236:239], v[152:155]
s_add_u32 s69, s69, s95
buffer_load_dwordx4 a[0:3], v4, s[44:47], s69 offen sc1
v_mfma_f32_16x16x32_bf16 v[152:155], a[176:179], a[232:235], v[152:155]
ds_read_b64 a[154:155], v6 offset:3464
ds_read_b128 a[220:223], v7 offset:384
v_mfma_f32_16x16x32_bf16 v[152:155], a[180:183], a[228:231], v[152:155]
Lstub9:
s_cbranch_execz Lret
v_mfma_f32_16x16x32_bf16 v[152:155], a[184:187], a[224:227], v[152:155]
v_mfma_f32_16x16x32_bf16 v[156:159], a[188:191], a[224:227], v[156:159]
ds_read_b64 a[156:157], v6 offset:3968
ds_read_b64 a[158:159], v6 offset:3976
v_mfma_f32_16x16x32_bf16 v[156:159], a[184:187], a[228:231], v[156:159]
buffer_load_dwordx4 a[4:7], v4, s[44:47], s69 offen offset:1024 sc1
v_mfma_f32_16x16x32_bf16 v[156:159], a[180:183], a[232:235], v[156:159]
v_mfma_f32_16x16x32_bf16 v[156:159], a[176:179], a[236:239], v[156:159]
v_mfma_f32_16x16x32_bf16 v[156:159], a[172:175], a[240:243], v[156:159]
v_mfma_f32_16x16x32_bf16 v[156:159], a[168:171], a[244:247], v[156:159]
buffer_load_dwordx4 a[8:11], v4, s[44:47], s69 offen offset:2048 sc1
v_mfma_f32_16x16x32_bf16 v[156:159], a[164:167], a[248:251], v[156:159]
v_mfma_f32_16x16x32_bf16 v[156:159], a[160:163], a[252:255], v[156:159]
s_waitcnt lgkmcnt(0)
v_mfma_f32_16x16x32_bf16 v[128:131], a[128:131], a[192:195], v[128:131]
ds_read_b128 a[224:227], v7 offset:4032
ds_read_b64 a[160:161], v6 offset:448
v_mfma_f32_16x16x32_bf16 v[132:135], a[132:135], a[192:195], v[132:135]
v_mfma_f32_16x16x32_bf16 v[132:135], a[128:131], a[196:199], v[132:135]
ds_read_b64 a[162:163], v6 offset:456
ds_read_b128 a[228:231], v7 offset:3520
v_mfma_f32_16x16x32_bf16 v[136:139], a[128:131], a[200:203], v[136:139]
buffer_load_dwordx4 a[12:15], v4, s[44:47], s69 offen offset:3072 sc1
v_mfma_f32_16x16x32_bf16 v[136:139], a[132:135], a[196:199], v[136:139]
v_mfma_f32_16x16x32_bf16 v[136:139], a[136:139], a[192:195], v[136:139]
ds_read_b64 a[164:165], v6 offset:960
ds_read_b64 a[166:167], v6 offset:968
v_mfma_f32_16x16x32_bf16 v[140:143], a[140:143], a[192:195], v[140:143]
v_mfma_f32_16x16x32_bf16 v[140:143], a[136:139], a[196:199], v[140:143]
ds_read_b128 a[232:235], v7 offset:3008
ds_read_b64 a[168:169], v6 offset:1472
v_mfma_f32_16x16x32_bf16 v[140:143], a[132:135], a[200:203], v[140:143]
s_add_u32 s69, s69, 0x20000
buffer_load_dwordx4 a[16:19], v4, s[44:47], s69 offen sc1
v_mfma_f32_16x16x32_bf16 v[140:143], a[128:131], a[204:207], v[140:143]
v_mfma_f32_16x16x32_bf16 v[144:147], a[128:131], a[208:211], v[144:147]
ds_read_b64 a[170:171], v6 offset:1480
ds_read_b128 a[236:239], v7 offset:2496
v_mfma_f32_16x16x32_bf16 v[144:147], a[132:135], a[204:207], v[144:147]
v_mfma_f32_16x16x32_bf16 v[144:147], a[136:139], a[200:203], v[144:147]
ds_read_b64 a[172:173], v6 offset:1984
ds_read_b64 a[174:175], v6 offset:1992
v_mfma_f32_16x16x32_bf16 v[144:147], a[140:143], a[196:199], v[144:147]
buffer_load_dwordx4 a[20:23], v4, s[44:47], s69 offen offset:1024 sc1
v_mfma_f32_16x16x32_bf16 v[144:147], a[144:147], a[192:195], v[144:147]
v_mfma_f32_16x16x32_bf16 v[148:151], a[148:151], a[192:195], v[148:151]
ds_read_b128 a[240:243], v7 offset:1984
ds_read_b64 a[176:177], v6 offset:2496
v_mfma_f32_16x16x32_bf16 v[148:151], a[144:147], a[196:199], v[148:151]
v_mfma_f32_16x16x32_bf16 v[148:151], a[140:143], a[200:203], v[148:151]
v_mfma_f32_16x16x32_bf16 v[148:151], a[136:139], a[204:207], v[148:151]
ds_read_b64 a[178:179], v6 offset:2504
ds_read_b128 a[244:247], v7 offset:1472
v_mfma_f32_16x16x32_bf16 v[148:151], a[132:135], a[208:211], v[148:151]
buffer_load_dwordx4 a[24:27], v4, s[44:47], s69 offen offset:2048 sc1
v_mfma_f32_16x16x32_bf16 v[148:151], a[128:131], a[212:215], v[148:151]
ds_read_b64 a[180:181], v6 offset:3008
ds_read_b64 a[182:183], v6 offset:3016
v_mfma_f32_16x16x32_bf16 v[152:155], a[128:131], a[216:219], v[152:155]
v_mfma_f32_16x16x32_bf16 v[152:155], a[132:135], a[212:215], v[152:155]
v_mfma_f32_16x16x32_bf16 v[152:155], a[136:139], a[208:211], v[152:155]
ds_read_b128 a[248:251], v7 offset:960
ds_read_b64 a[184:185], v6 offset:3520
v_mfma_f32_16x16x32_bf16 v[152:155], a[140:143], a[204:207], v[152:155]
buffer_load_dwordx4 a[28:31], v4, s[44:47], s69 offen offset:3072 sc1
v_mfma_f32_16x16x32_bf16 v[152:155], a[144:147], a[200:203], v[152:155]
ds_read_b64 a[186:187], v6 offset:3528
ds_read_b128 a[252:255], v7 offset:448
v_mfma_f32_16x16x32_bf16 v[152:155], a[148:151], a[196:199], v[152:155]
v_mfma_f32_16x16x32_bf16 v[152:155], a[152:155], a[192:195], v[152:155]
s_lshr_b32 s69, s13, 18
v_mfma_f32_16x16x32_bf16 v[156:159], a[156:159], a[192:195], v[156:159]
s_lshl_b32 s69, s69, 12
ds_read_b64 a[188:189], v6 offset:4032
ds_read_b64 a[190:191], v6 offset:4040
v_mfma_f32_16x16x32_bf16 v[156:159], a[152:155], a[196:199], v[156:159]
s_add_u32 s69, s69, s95
buffer_load_dwordx4 a[32:35], v4, s[44:47], s69 offen sc1
v_mfma_f32_16x16x32_bf16 v[156:159], a[148:151], a[200:203], v[156:159]
v_mfma_f32_16x16x32_bf16 v[156:159], a[144:147], a[204:207], v[156:159]
v_mfma_f32_16x16x32_bf16 v[156:159], a[140:143], a[208:211], v[156:159]
v_mfma_f32_16x16x32_bf16 v[156:159], a[136:139], a[212:215], v[156:159]
buffer_load_dwordx4 a[36:39], v4, s[44:47], s69 offen offset:1024 sc1
v_mfma_f32_16x16x32_bf16 v[156:159], a[132:135], a[216:219], v[156:159]
v_mfma_f32_16x16x32_bf16 v[156:159], a[128:131], a[220:223], v[156:159]
s_waitcnt lgkmcnt(0)
v_mfma_f32_16x16x32_bf16 v[128:131], a[160:163], a[224:227], v[128:131]
ds_read_b64_tr_b16 v[192:193], v8 offset:0
ds_read_b64_tr_b16 v[194:195], v8 offset:2048
v_mfma_f32_16x16x32_bf16 v[132:135], a[164:167], a[224:227], v[132:135]
v_mfma_f32_16x16x32_bf16 v[132:135], a[160:163], a[228:231], v[132:135]
ds_read_b64_tr_b16 v[196:197], v9 offset:0
ds_read_b64_tr_b16 v[198:199], v9 offset:2048
v_mfma_f32_16x16x32_bf16 v[136:139], a[160:163], a[232:235], v[136:139]
buffer_load_dwordx4 a[40:43], v4, s[44:47], s69 offen offset:2048 sc1
v_mfma_f32_16x16x32_bf16 v[136:139], a[164:167], a[228:231], v[136:139]
ds_read_b64_tr_b16 v[200:201], v10 offset:0
ds_read_b64_tr_b16 v[202:203], v10 offset:2048
v_mfma_f32_16x16x32_bf16 v[136:139], a[168:171], a[224:227], v[136:139]
v_mfma_f32_16x16x32_bf16 v[140:143], a[172:175], a[224:227], v[140:143]
ds_read_b64_tr_b16 v[204:205], v11 offset:0
ds_read_b64_tr_b16 v[206:207], v11 offset:2048
v_mfma_f32_16x16x32_bf16 v[140:143], a[168:171], a[228:231], v[140:143]
v_cvt_pk_bf16_f32 v128, v128, v129
v_cvt_pk_bf16_f32 v129, v130, v131
v_cvt_pk_bf16_f32 v130, v132, v133
v_mfma_f32_16x16x32_bf16 v[140:143], a[164:167], a[232:235], v[140:143]
ds_read_b64_tr_b16 v[208:209], v8 offset:4096
ds_read_b64_tr_b16 v[210:211], v8 offset:6144
v_cvt_pk_bf16_f32 v131, v134, v135
v_mfma_f32_16x16x32_bf16 v[140:143], a[160:163], a[236:239], v[140:143]
buffer_load_dwordx4 a[44:47], v4, s[44:47], s69 offen offset:3072 sc1
v_permlane32_swap_b32 v128, v130
v_mfma_f32_16x16x32_bf16 v[144:147], a[160:163], a[240:243], v[144:147]
ds_read_b64_tr_b16 v[212:213], v9 offset:4096
ds_read_b64_tr_b16 v[214:215], v9 offset:6144
v_permlane32_swap_b32 v129, v131
v_mfma_f32_16x16x32_bf16 v[144:147], a[164:167], a[236:239], v[144:147]
buffer_store_dwordx4 v[128:131], v166, s[44:47], s80 offen sc1
v_mfma_f32_16x16x32_bf16 v[144:147], a[168:171], a[232:235], v[144:147]
ds_read_b64_tr_b16 v[216:217], v10 offset:4096
ds_read_b64_tr_b16 v[218:219], v10 offset:6144
v_mfma_f32_16x16x32_bf16 v[144:147], a[172:175], a[228:231], v[144:147]
s_add_u32 s69, s69, 0x20000
buffer_load_dwordx4 a[48:51], v4, s[44:47], s69 offen sc1
v_mfma_f32_16x16x32_bf16 v[144:147], a[176:179], a[224:227], v[144:147]
ds_read_b64_tr_b16 v[220:221], v11 offset:4096
ds_read_b64_tr_b16 v[222:223], v11 offset:6144
v_cvt_pk_bf16_f32 v136, v136, v137
v_mfma_f32_16x16x32_bf16 v[148:151], a[180:183], a[224:227], v[148:151]
v_cvt_pk_bf16_f32 v137, v138, v139
v_cvt_pk_bf16_f32 v138, v140, v141
v_cvt_pk_bf16_f32 v139, v142, v143
v_mfma_f32_16x16x32_bf16 v[148:151], a[176:179], a[228:231], v[148:151]
ds_read_b64_tr_b16 v[224:225], v8 offset:8192
ds_read_b64_tr_b16 v[226:227], v8 offset:10240
v_permlane32_swap_b32 v136, v138
v_mfma_f32_16x16x32_bf16 v[148:151], a[172:175], a[232:235], v[148:151]
v_permlane32_swap_b32 v137, v139
v_mfma_f32_16x16x32_bf16 v[148:151], a[168:171], a[236:239], v[148:151]
ds_read_b64_tr_b16 v[228:229], v9 offset:8192
ds_read_b64_tr_b16 v[230:231], v9 offset:10240
v_mfma_f32_16x16x32_bf16 v[148:151], a[164:167], a[240:243], v[148:151]
buffer_load_dwordx4 a[52:55], v4, s[44:47], s69 offen offset:1024 sc1
v_mfma_f32_16x16x32_bf16 v[148:151], a[160:163], a[244:247], v[148:151]
ds_read_b64_tr_b16 v[232:233], v10 offset:8192
ds_read_b64_tr_b16 v[234:235], v10 offset:10240
v_mfma_f32_16x16x32_bf16 v[152:155], a[160:163], a[248:251], v[152:155]
buffer_store_dwordx4 v[136:139], v166, s[44:47], s80 offen offset:1024 sc1
v_mfma_f32_16x16x32_bf16 v[152:155], a[164:167], a[244:247], v[152:155]
ds_read_b64_tr_b16 v[236:237], v11 offset:8192
ds_read_b64_tr_b16 v[238:239], v11 offset:10240
v_mfma_f32_16x16x32_bf16 v[152:155], a[168:171], a[240:243], v[152:155]
buffer_load_dwordx4 a[56:59], v4, s[44:47], s69 offen offset:2048 sc1
v_mfma_f32_16x16x32_bf16 v[152:155], a[172:175], a[236:239], v[152:155]
ds_read_b64_tr_b16 v[240:241], v8 offset:12288
ds_read_b64_tr_b16 v[242:243], v8 offset:14336
v_mfma_f32_16x16x32_bf16 v[152:155], a[176:179], a[232:235], v[152:155]
v_cvt_pk_bf16_f32 v144, v144, v145
v_cvt_pk_bf16_f32 v145, v146, v147
v_cvt_pk_bf16_f32 v146, v148, v149
v_mfma_f32_16x16x32_bf16 v[152:155], a[180:183], a[228:231], v[152:155]
ds_read_b64_tr_b16 v[244:245], v9 offset:12288
ds_read_b64_tr_b16 v[246:247], v9 offset:14336
v_cvt_pk_bf16_f32 v147, v150, v151
v_mfma_f32_16x16x32_bf16 v[152:155], a[184:187], a[224:227], v[152:155]
v_permlane32_swap_b32 v144, v146
v_permlane32_swap_b32 v145, v147
v_mfma_f32_16x16x32_bf16 v[156:159], a[188:191], a[224:227], v[156:159]
ds_read_b64_tr_b16 v[248:249], v10 offset:12288
ds_read_b64_tr_b16 v[250:251], v10 offset:14336
v_mfma_f32_16x16x32_bf16 v[156:159], a[184:187], a[228:231], v[156:159]
buffer_load_dwordx4 a[60:63], v4, s[44:47], s69 offen offset:3072 sc1
v_mfma_f32_16x16x32_bf16 v[156:159], a[180:183], a[232:235], v[156:159]
ds_read_b64_tr_b16 v[252:253], v11 offset:12288
ds_read_b64_tr_b16 v[254:255], v11 offset:14336
v_mfma_f32_16x16x32_bf16 v[156:159], a[176:179], a[236:239], v[156:159]
buffer_store_dwordx4 v[144:147], v166, s[44:47], s80 offen offset:2048 sc1
v_mfma_f32_16x16x32_bf16 v[156:159], a[172:175], a[240:243], v[156:159]
v_mfma_f32_16x16x32_bf16 v[156:159], a[168:171], a[244:247], v[156:159]
v_mfma_f32_16x16x32_bf16 v[156:159], a[164:167], a[248:251], v[156:159]
v_mfma_f32_16x16x32_bf16 v[156:159], a[160:163], a[252:255], v[156:159]
v_cvt_pk_bf16_f32 v152, v152, v153
v_cvt_pk_bf16_f32 v153, v154, v155
s_nop 5
v_cvt_pk_bf16_f32 v154, v156, v157
v_cvt_pk_bf16_f32 v155, v158, v159
s_nop 0
v_permlane32_swap_b32 v152, v154
v_permlane32_swap_b32 v153, v155
buffer_store_dwordx4 v[152:155], v166, s[44:47], s80 offen offset:3072 sc1
s_waitcnt vmcnt(12) lgkmcnt(0)
s_cmp_lg_u32 s81, 0
s_cbranch_scc1 Lredo0
Lredo0b:
s_barrier
v_mfma_f32_16x16x32_bf16 v[16:19], v[192:195], a[0:3], 0
s_nop 0
ds_read_b64_tr_b16 v[128:129], v8 offset:16384
ds_read_b64_tr_b16 v[130:131], v8 offset:18432
v_mfma_f32_16x16x32_bf16 v[16:19], v[208:211], a[4:7], v[16:19]
s_xor_b32 s71, s13, 0x100
ds_read_b64_tr_b16 v[132:133], v9 offset:16384
ds_read_b64_tr_b16 v[134:135], v9 offset:18432
v_mfma_f32_16x16x32_bf16 v[16:19], v[224:227], a[8:11], v[16:19]
s_add_u32 m0, s85, 0
ds_read_b64_tr_b16 v[136:137], v10 offset:16384
ds_read_b64_tr_b16 v[138:139], v10 offset:18432
v_mfma_f32_16x16x32_bf16 v[16:19], v[240:243], a[12:15], v[16:19]
s_add_u32 s72, s71, 0
buffer_load_dwordx4 v15, s[24:27], s72 offen lds
v_mfma_f32_16x16x32_bf16 v[32:35], v[240:243], a[28:31], 0
s_lshr_b32 s69, s14, 18
ds_read_b64_tr_b16 v[140:141], v11 offset:16384
ds_read_b64_tr_b16 v[142:143], v11 offset:18432
v_mfma_f32_16x16x32_bf16 v[32:35], v[224:227], a[24:27], v[32:35]
s_lshl_b32 s69, s69, 12
v_add_u32 v4, s64, v1
v_add_u32 v4, 131072, v4
v_mfma_f32_16x16x32_bf16 v[32:35], v[208:211], a[20:23], v[32:35]
s_add_u32 s69, s69, s95
buffer_load_dwordx4 a[64:67], v1, s[44:47], s69 offen sc1
v_mfma_f32_16x16x32_bf16 v[32:35], v[192:195], a[16:19], v[32:35]
s_lshl_b32 s70, s75, 18
ds_read_b64_tr_b16 v[144:145], v8 offset:20480
ds_read_b64_tr_b16 v[146:147], v8 offset:22528
v_mfma_f32_16x16x32_bf16 v[36:39], v[196:199], a[16:19], 0
s_add_u32 s72, s71, 15360
buffer_load_dwordx4 v15, s[24:27], s72 offen offset:1024 lds
v_mfma_f32_16x16x32_bf16 v[36:39], v[212:215], a[20:23], v[36:39]
s_add_u32 s70, s70, s94
ds_read_b64_tr_b16 v[148:149], v9 offset:20480
ds_read_b64_tr_b16 v[150:151], v9 offset:22528
v_mfma_f32_16x16x32_bf16 v[36:39], v[228:231], a[24:27], v[36:39]
s_nop 0
ds_read_b64_tr_b16 v[152:153], v10 offset:20480
ds_read_b64_tr_b16 v[154:155], v10 offset:22528
v_mfma_f32_16x16x32_bf16 v[36:39], v[244:247], a[28:31], v[36:39]
s_nop 0
ds_read_b64_tr_b16 v[156:157], v11 offset:20480
ds_read_b64_tr_b16 v[158:159], v11 offset:22528
v_mfma_f32_16x16x32_bf16 v[20:23], v[244:247], a[12:15], 0
ds_write_b128 v4, v[80:83] offset:0
v_mfma_f32_16x16x32_bf16 v[20:23], v[228:231], a[8:11], v[20:23]
s_nop 0
ds_read_b64_tr_b16 v[160:161], v8 offset:24576
ds_read_b64_tr_b16 v[162:163], v8 offset:26624
v_mfma_f32_16x16x32_bf16 v[20:23], v[212:215], a[4:7], v[20:23]
s_add_u32 s72, s71, 30720
buffer_load_dwordx4 v15, s[24:27], s72 offen offset:2048 lds
v_mfma_f32_16x16x32_bf16 v[20:23], v[196:199], a[0:3], v[20:23]
buffer_load_dwordx4 a[68:71], v1, s[44:47], s69 offen offset:1024 sc1
v_mfma_f32_16x16x32_bf16 v[24:27], v[200:203], a[0:3], 0
s_nop 0
ds_read_b64_tr_b16 v[164:165], v9 offset:24576
ds_read_b64_tr_b16 v[166:167], v9 offset:26624
v_mfma_f32_16x16x32_bf16 v[24:27], v[216:219], a[4:7], v[24:27]
s_nop 0
ds_read_b64_tr_b16 v[168:169], v10 offset:24576
ds_read_b64_tr_b16 v[170:171], v10 offset:26624
v_mfma_f32_16x16x32_bf16 v[24:27], v[232:235], a[8:11], v[24:27]
s_nop 0
ds_read_b64_tr_b16 v[172:173], v11 offset:24576
ds_read_b64_tr_b16 v[174:175], v11 offset:26624
v_mfma_f32_16x16x32_bf16 v[24:27], v[248:251], a[12:15], v[24:27]
ds_write_b128 v4, v[84:87] offset:1024
v_mfma_f32_16x16x32_bf16 v[40:43], v[248:251], a[28:31], 0
s_add_u32 s72, s71, 46080
buffer_load_dwordx4 v15, s[24:27], s72 offen offset:3072 lds
v_mfma_f32_16x16x32_bf16 v[40:43], v[232:235], a[24:27], v[40:43]
s_nop 0
ds_read_b64_tr_b16 v[176:177], v8 offset:28672
ds_read_b64_tr_b16 v[178:179], v8 offset:30720
v_mfma_f32_16x16x32_bf16 v[40:43], v[216:219], a[20:23], v[40:43]
s_nop 0
ds_read_b64_tr_b16 v[180:181], v9 offset:28672
ds_read_b64_tr_b16 v[182:183], v9 offset:30720
v_mfma_f32_16x16x32_bf16 v[40:43], v[200:203], a[16:19], v[40:43]
s_nop 0
ds_read_b64_tr_b16 v[184:185], v10 offset:28672
ds_read_b64_tr_b16 v[186:187], v10 offset:30720
v_mfma_f32_16x16x32_bf16 v[44:47], v[204:207], a[16:19], 0
s_nop 0
ds_read_b64_tr_b16 v[188:189], v11 offset:28672
ds_read_b64_tr_b16 v[190:191], v11 offset:30720
v_mfma_f32_16x16x32_bf16 v[44:47], v[220:223], a[20:23], v[44:47]
buffer_load_dwordx4 a[72:75], v1, s[44:47], s69 offen offset:2048 sc1
v_mfma_f32_16x16x32_bf16 v[44:47], v[236:239], a[24:27], v[44:47]
ds_write_b128 v4, v[96:99] offset:2048
v_mfma_f32_16x16x32_bf16 v[44:47], v[252:255], a[28:31], v[44:47]
s_xor_b32 s71, s13, 0x180
v_mfma_f32_16x16x32_bf16 v[28:31], v[252:255], a[12:15], 0
s_add_u32 m0, s85, 16384
ds_write_b128 v4, v[100:103] offset:3072
v_mfma_f32_16x16x32_bf16 v[28:31], v[236:239], a[8:11], v[28:31]
s_add_u32 s72, s71, 0
v_mfma_f32_16x16x32_bf16 v[28:31], v[220:223], a[4:7], v[28:31]
s_waitcnt vmcnt(32) lgkmcnt(0)
buffer_load_dwordx4 v15, s[24:27], s72 offen lds
v_mfma_f32_16x16x32_bf16 v[28:31], v[204:207], a[0:3], v[28:31]
s_barrier
v_mfma_f32_16x16x32_bf16 v[48:51], v[128:131], a[0:3], 0
s_nop 0
ds_read_b64_tr_b16 v[192:193], v8 offset:32768
ds_read_b64_tr_b16 v[194:195], v8 offset:34816
v_mfma_f32_16x16x32_bf16 v[48:51], v[144:147], a[4:7], v[48:51]
s_nop 0
ds_read_b64_tr_b16 v[196:197], v9 offset:32768
ds_read_b64_tr_b16 v[198:199], v9 offset:34816
v_mfma_f32_16x16x32_bf16 v[48:51], v[160:163], a[8:11], v[48:51]
s_nop 0
ds_read_b64_tr_b16 v[200:201], v10 offset:32768
ds_read_b64_tr_b16 v[202:203], v10 offset:34816
v_mfma_f32_16x16x32_bf16 v[48:51], v[176:179], a[12:15], v[48:51]
s_add_u32 s72, s71, 15360
buffer_load_dwordx4 v15, s[24:27], s72 offen offset:1024 lds
v_mfma_f32_16x16x32_bf16 v[64:67], v[176:179], a[28:31], 0
buffer_load_dwordx4 a[76:79], v1, s[44:47], s69 offen offset:3072 sc1
v_mfma_f32_16x16x32_bf16 v[64:67], v[160:163], a[24:27], v[64:67]
s_nop 0
ds_read_b64_tr_b16 v[204:205], v11 offset:32768
ds_read_b64_tr_b16 v[206:207], v11 offset:34816
v_mfma_f32_16x16x32_bf16 v[64:67], v[144:147], a[20:23], v[64:67]
v_mfma_f32_16x16x32_bf16 v[64:67], v[128:131], a[16:19], v[64:67]
s_nop 0
ds_read_b64_tr_b16 v[208:209], v8 offset:36864
ds_read_b64_tr_b16 v[210:211], v8 offset:38912
v_mfma_f32_16x16x32_bf16 v[68:71], v[132:135], a[16:19], 0
s_nop 0
ds_read_b64_tr_b16 v[212:213], v9 offset:36864
ds_read_b64_tr_b16 v[214:215], v9 offset:38912
v_mfma_f32_16x16x32_bf16 v[68:71], v[148:151], a[20:23], v[68:71]
s_add_u32 s72, s71, 30720
buffer_load_dwordx4 v15, s[24:27], s72 offen offset:2048 lds
v_mfma_f32_16x16x32_bf16 v[68:71], v[164:167], a[24:27], v[68:71]
s_nop 0
ds_read_b64_tr_b16 v[216:217], v10 offset:36864
ds_read_b64_tr_b16 v[218:219], v10 offset:38912
v_mfma_f32_16x16x32_bf16 v[68:71], v[180:183], a[28:31], v[68:71]
s_nop 0
ds_read_b64_tr_b16 v[220:221], v11 offset:36864
ds_read_b64_tr_b16 v[222:223], v11 offset:38912
v_mfma_f32_16x16x32_bf16 v[52:55], v[180:183], a[12:15], 0
v_mfma_f32_16x16x32_bf16 v[52:55], v[164:167], a[8:11], v[52:55]
s_add_u32 s69, s69, 0x20000
buffer_load_dwordx4 a[80:83], v1, s[44:47], s69 offen sc1
v_mfma_f32_16x16x32_bf16 v[52:55], v[148:151], a[4:7], v[52:55]
s_nop 0
ds_read_b64_tr_b16 v[224:225], v8 offset:40960
ds_read_b64_tr_b16 v[226:227], v8 offset:43008
v_mfma_f32_16x16x32_bf16 v[52:55], v[132:135], a[0:3], v[52:55]
s_add_u32 s72, s71, 46080
buffer_load_dwordx4 v15, s[24:27], s72 offen offset:3072 lds
v_mfma_f32_16x16x32_bf16 v[56:59], v[136:139], a[0:3], 0
s_nop 0
ds_read_b64_tr_b16 v[228:229], v9 offset:40960
ds_read_b64_tr_b16 v[230:231], v9 offset:43008
v_mfma_f32_16x16x32_bf16 v[56:59], v[152:155], a[4:7], v[56:59]
s_nop 0
ds_read_b64_tr_b16 v[232:233], v10 offset:40960
ds_read_b64_tr_b16 v[234:235], v10 offset:43008
v_mfma_f32_16x16x32_bf16 v[56:59], v[168:171], a[8:11], v[56:59]
s_nop 0
ds_read_b64_tr_b16 v[236:237], v11 offset:40960
ds_read_b64_tr_b16 v[238:239], v11 offset:43008
v_mfma_f32_16x16x32_bf16 v[56:59], v[184:187], a[12:15], v[56:59]
v_mfma_f32_16x16x32_bf16 v[72:75], v[184:187], a[28:31], 0
s_nop 0
ds_read_b64_tr_b16 v[240:241], v8 offset:45056
ds_read_b64_tr_b16 v[242:243], v8 offset:47104
v_mfma_f32_16x16x32_bf16 v[72:75], v[168:171], a[24:27], v[72:75]
s_nop 0
ds_read_b64_tr_b16 v[244:245], v9 offset:45056
ds_read_b64_tr_b16 v[246:247], v9 offset:47104
v_mfma_f32_16x16x32_bf16 v[72:75], v[152:155], a[20:23], v[72:75]
s_nop 0
ds_read_b64_tr_b16 v[248:249], v10 offset:45056
ds_read_b64_tr_b16 v[250:251], v10 offset:47104
v_mfma_f32_16x16x32_bf16 v[72:75], v[136:139], a[16:19], v[72:75]
s_xor_b32 s71, s14, 0x80
buffer_load_dwordx4 a[84:87], v1, s[44:47], s69 offen offset:1024 sc1
v_mfma_f32_16x16x32_bf16 v[76:79], v[140:143], a[16:19], 0
s_add_u32 m0, s85, 32768
ds_read_b64_tr_b16 v[252:253], v11 offset:45056
ds_read_b64_tr_b16 v[254:255], v11 offset:47104
v_mfma_f32_16x16x32_bf16 v[76:79], v[156:159], a[20:23], v[76:79]
s_add_u32 s72, s71, 0
buffer_load_dwordx4 v15, s[24:27], s72 offen lds
v_mfma_f32_16x16x32_bf16 v[76:79], v[172:175], a[24:27], v[76:79]
v_mfma_f32_16x16x32_bf16 v[76:79], v[188:191], a[28:31], v[76:79]
v_mfma_f32_16x16x32_bf16 v[60:63], v[188:191], a[12:15], 0
v_mfma_f32_16x16x32_bf16 v[60:63], v[172:175], a[8:11], v[60:63]
s_add_u32 s72, s71, 15360
v_mfma_f32_16x16x32_bf16 v[60:63], v[156:159], a[4:7], v[60:63]
s_waitcnt vmcnt(35) lgkmcnt(0)
v_mfma_f32_16x16x32_bf16 v[60:63], v[140:143], a[0:3], v[60:63]
s_barrier
buffer_load_dwordx4 v15, s[24:27], s72 offen offset:1024 lds
v_mfma_f32_16x16x32_bf16 v[80:83], v[192:195], a[0:3], 0
s_nop 0
ds_read_b64_tr_b16 v[128:129], v8 offset:49152
ds_read_b64_tr_b16 v[130:131], v8 offset:51200
v_mfma_f32_16x16x32_bf16 v[80:83], v[208:211], a[4:7], v[80:83]
buffer_load_dwordx4 a[88:91], v1, s[44:47], s69 offen offset:2048 sc1
v_mfma_f32_16x16x32_bf16 v[80:83], v[224:227], a[8:11], v[80:83]
s_nop 0
ds_read_b64_tr_b16 v[132:133], v9 offset:49152
ds_read_b64_tr_b16 v[134:135], v9 offset:51200
v_mfma_f32_16x16x32_bf16 v[80:83], v[240:243], a[12:15], v[80:83]
s_nop 0
ds_read_b64_tr_b16 v[136:137], v10 offset:49152
ds_read_b64_tr_b16 v[138:139], v10 offset:51200
v_mfma_f32_16x16x32_bf16 v[96:99], v[240:243], a[28:31], 0
s_nop 0
ds_read_b64_tr_b16 v[140:141], v11 offset:49152
ds_read_b64_tr_b16 v[142:143], v11 offset:51200
v_mfma_f32_16x16x32_bf16 v[96:99], v[224:227], a[24:27], v[96:99]
s_add_u32 s72, s71, 30720
buffer_load_dwordx4 v15, s[24:27], s72 offen offset:2048 lds
v_mfma_f32_16x16x32_bf16 v[96:99], v[208:211], a[20:23], v[96:99]
v_mfma_f32_16x16x32_bf16 v[96:99], v[192:195], a[16:19], v[96:99]
s_nop 0
ds_read_b64_tr_b16 v[144:145], v8 offset:53248
ds_read_b64_tr_b16 v[146:147], v8 offset:55296
v_mfma_f32_16x16x32_bf16 v[100:103], v[196:199], a[16:19], 0
s_nop 0
ds_read_b64_tr_b16 v[148:149], v9 offset:53248
ds_read_b64_tr_b16 v[150:151], v9 offset:55296
v_mfma_f32_16x16x32_bf16 v[100:103], v[212:215], a[20:23], v[100:103]
s_nop 0
ds_read_b64_tr_b16 v[152:153], v10 offset:53248
ds_read_b64_tr_b16 v[154:155], v10 offset:55296
v_mfma_f32_16x16x32_bf16 v[100:103], v[228:231], a[24:27], v[100:103]
s_nop 0
ds_read_b64_tr_b16 v[156:157], v11 offset:53248
ds_read_b64_tr_b16 v[158:159], v11 offset:55296
v_mfma_f32_16x16x32_bf16 v[100:103], v[244:247], a[28:31], v[100:103]
s_add_u32 s72, s71, 46080
buffer_load_dwordx4 v15, s[24:27], s72 offen offset:3072 lds
v_mfma_f32_16x16x32_bf16 v[84:87], v[244:247], a[12:15], 0
buffer_load_dwordx4 a[92:95], v1, s[44:47], s69 offen offset:3072 sc1
v_mfma_f32_16x16x32_bf16 v[84:87], v[228:231], a[8:11], v[84:87]
v_mfma_f32_16x16x32_bf16 v[84:87], v[212:215], a[4:7], v[84:87]
s_nop 0
ds_read_b64_tr_b16 v[160:161], v8 offset:57344
ds_read_b64_tr_b16 v[162:163], v8 offset:59392
v_mfma_f32_16x16x32_bf16 v[84:87], v[196:199], a[0:3], v[84:87]
s_nop 0
ds_read_b64_tr_b16 v[164:165], v9 offset:57344
ds_read_b64_tr_b16 v[166:167], v9 offset:59392
v_mfma_f32_16x16x32_bf16 v[88:91], v[200:203], a[0:3], 0
s_nop 0
ds_read_b64_tr_b16 v[168:169], v10 offset:57344
ds_read_b64_tr_b16 v[170:171], v10 offset:59392
v_mfma_f32_16x16x32_bf16 v[88:91], v[216:219], a[4:7], v[88:91]
s_xor_b32 s82, s78, 16
ds_read_b64_tr_b16 v[172:173], v11 offset:57344
ds_read_b64_tr_b16 v[174:175], v11 offset:59392
v_mfma_f32_16x16x32_bf16 v[88:91], v[232:235], a[8:11], v[88:91]
s_lshl_b32 s82, s82, 10
v_mfma_f32_16x16x32_bf16 v[88:91], v[248:251], a[12:15], v[88:91]
s_xor_b32 s71, s14, 0x100
ds_read_b64_tr_b16 v[176:177], v8 offset:61440
ds_read_b64_tr_b16 v[178:179], v8 offset:63488
v_mfma_f32_16x16x32_bf16 v[104:107], v[248:251], a[28:31], 0
s_add_u32 m0, s85, 49152
ds_read_b64_tr_b16 v[180:181], v9 offset:61440
ds_read_b64_tr_b16 v[182:183], v9 offset:63488
v_mfma_f32_16x16x32_bf16 v[104:107], v[232:235], a[24:27], v[104:107]
s_add_u32 s72, s71, 0
buffer_load_dwordx4 v15, s[24:27], s72 offen lds
v_mfma_f32_16x16x32_bf16 v[104:107], v[216:219], a[20:23], v[104:107]
s_add_u32 s82, s82, s74
buffer_load_dword v3, v2, s[44:47], s82 offen sc1
v_mfma_f32_16x16x32_bf16 v[104:107], v[200:203], a[16:19], v[104:107]
s_nop 0
ds_read_b64_tr_b16 v[184:185], v10 offset:61440
ds_read_b64_tr_b16 v[186:187], v10 offset:63488
v_mfma_f32_16x16x32_bf16 v[108:111], v[204:207], a[16:19], 0
s_nop 0
ds_read_b64_tr_b16 v[188:189], v11 offset:61440
ds_read_b64_tr_b16 v[190:191], v11 offset:63488
v_mfma_f32_16x16x32_bf16 v[108:111], v[220:223], a[20:23], v[108:111]
v_mfma_f32_16x16x32_bf16 v[108:111], v[236:239], a[24:27], v[108:111]
s_add_u32 s72, s71, 15360
buffer_load_dwordx4 v15, s[24:27], s72 offen offset:1024 lds
v_mfma_f32_16x16x32_bf16 v[108:111], v[252:255], a[28:31], v[108:111]
s_lshr_b32 s69, s15, 18
v_mfma_f32_16x16x32_bf16 v[92:95], v[252:255], a[12:15], 0
s_lshl_b32 s69, s69, 12
v_xor_b32 v8, 0x10000, v8
v_mfma_f32_16x16x32_bf16 v[92:95], v[236:239], a[8:11], v[92:95]
s_add_u32 s69, s69, s95
v_xor_b32 v9, 0x10000, v9
v_mfma_f32_16x16x32_bf16 v[92:95], v[220:223], a[4:7], v[92:95]
s_waitcnt vmcnt(17) lgkmcnt(0)
v_xor_b32 v10, 0x10000, v10
v_mfma_f32_16x16x32_bf16 v[92:95], v[204:207], a[0:3], v[92:95]
s_barrier
buffer_load_dwordx4 a[96:99], v1, s[44:47], s69 offen sc1
v_xor_b32 v11, 0x10000, v11
v_mfma_f32_16x16x32_bf16 v[16:19], v[128:131], a[32:35], v[16:19]
s_add_u32 s72, s71, 30720
buffer_load_dwordx4 v15, s[24:27], s72 offen offset:2048 lds
v_mfma_f32_16x16x32_bf16 v[16:19], v[144:147], a[36:39], v[16:19]
s_nop 0
ds_read_b64_tr_b16 v[192:193], v8 offset:0
ds_read_b64_tr_b16 v[194:195], v8 offset:2048
v_mfma_f32_16x16x32_bf16 v[16:19], v[160:163], a[40:43], v[16:19]
s_nop 0
ds_read_b64_tr_b16 v[196:197], v9 offset:0
ds_read_b64_tr_b16 v[198:199], v9 offset:2048
v_mfma_f32_16x16x32_bf16 v[16:19], v[176:179], a[44:47], v[16:19]
s_nop 0
ds_read_b64_tr_b16 v[200:201], v10 offset:0
ds_read_b64_tr_b16 v[202:203], v10 offset:2048
v_mfma_f32_16x16x32_bf16 v[32:35], v[176:179], a[60:63], v[32:35]
s_nop 0
ds_read_b64_tr_b16 v[204:205], v11 offset:0
ds_read_b64_tr_b16 v[206:207], v11 offset:2048
v_mfma_f32_16x16x32_bf16 v[32:35], v[160:163], a[56:59], v[32:35]
v_or_b32 v112, s58, v0
v_mov_b32 v113, 3
v_mfma_f32_16x16x32_bf16 v[32:35], v[144:147], a[52:55], v[32:35]
s_add_u32 s72, s71, 46080
buffer_load_dwordx4 v15, s[24:27], s72 offen offset:3072 lds
v_mfma_f32_16x16x32_bf16 v[32:35], v[128:131], a[48:51], v[32:35]
s_nop 0
ds_read_b64_tr_b16 v[208:209], v8 offset:4096
ds_read_b64_tr_b16 v[210:211], v8 offset:6144
v_mfma_f32_16x16x32_bf16 v[36:39], v[132:135], a[48:51], v[36:39]
s_nop 0
ds_read_b64_tr_b16 v[212:213], v9 offset:4096
ds_read_b64_tr_b16 v[214:215], v9 offset:6144
v_mfma_f32_16x16x32_bf16 v[36:39], v[148:151], a[52:55], v[36:39]
buffer_load_dwordx4 a[100:103], v1, s[44:47], s69 offen offset:1024 sc1
v_mfma_f32_16x16x32_bf16 v[36:39], v[164:167], a[56:59], v[36:39]
s_nop 0
ds_read_b64_tr_b16 v[216:217], v10 offset:4096
ds_read_b64_tr_b16 v[218:219], v10 offset:6144
v_mfma_f32_16x16x32_bf16 v[36:39], v[180:183], a[60:63], v[36:39]
v_min_u32 v112, 1, v112
v_lshlrev_b32 v112, 30, v112
v_mfma_f32_16x16x32_bf16 v[20:23], v[180:183], a[44:47], v[20:23]
s_nop 0
ds_read_b64_tr_b16 v[220:221], v11 offset:4096
ds_read_b64_tr_b16 v[222:223], v11 offset:6144
v_mfma_f32_16x16x32_bf16 v[20:23], v[164:167], a[40:43], v[20:23]
s_nop 0
ds_read_b64_tr_b16 v[224:225], v8 offset:8192
ds_read_b64_tr_b16 v[226:227], v8 offset:10240
v_mfma_f32_16x16x32_bf16 v[20:23], v[148:151], a[36:39], v[20:23]
s_xor_b32 s71, s14, 0x180
ds_read_b64_tr_b16 v[228:229], v9 offset:8192
ds_read_b64_tr_b16 v[230:231], v9 offset:10240
v_mfma_f32_16x16x32_bf16 v[20:23], v[132:135], a[32:35], v[20:23]
s_add_u32 m0, s77, 0
buffer_store_dword v113, v112, s[44:47], s91 offen sc1
v_mfma_f32_16x16x32_bf16 v[24:27], v[136:139], a[32:35], v[24:27]
s_add_u32 s72, s71, 0
buffer_load_dwordx4 v15, s[24:27], s72 offen lds
v_mfma_f32_16x16x32_bf16 v[24:27], v[152:155], a[36:39], v[24:27]
s_nop 0
ds_read_b64_tr_b16 v[232:233], v10 offset:8192
ds_read_b64_tr_b16 v[234:235], v10 offset:10240
v_mfma_f32_16x16x32_bf16 v[24:27], v[168:171], a[40:43], v[24:27]
Lstube0:
s_cbranch_execz Lstube4
s_nop 0
ds_read_b64_tr_b16 v[236:237], v11 offset:8192
ds_read_b64_tr_b16 v[238:239], v11 offset:10240
v_mfma_f32_16x16x32_bf16 v[24:27], v[184:187], a[44:47], v[24:27]
buffer_load_dwordx4 a[104:107], v1, s[44:47], s69 offen offset:2048 sc1
v_mfma_f32_16x16x32_bf16 v[40:43], v[184:187], a[60:63], v[40:43]
s_nop 0
ds_read_b64_tr_b16 v[240:241], v8 offset:12288
ds_read_b64_tr_b16 v[242:243], v8 offset:14336
v_mfma_f32_16x16x32_bf16 v[40:43], v[168:171], a[56:59], v[40:43]
v_mfma_f32_16x16x32_bf16 v[40:43], v[152:155], a[52:55], v[40:43]
s_add_u32 s72, s71, 15360
buffer_load_dwordx4 v15, s[24:27], s72 offen offset:1024 lds
v_mfma_f32_16x16x32_bf16 v[40:43], v[136:139], a[48:51], v[40:43]
s_nop 0
ds_read_b64_tr_b16 v[244:245], v9 offset:12288
ds_read_b64_tr_b16 v[246:247], v9 offset:14336
v_mfma_f32_16x16x32_bf16 v[44:47], v[140:143], a[48:51], v[44:47]
s_nop 0
ds_read_b64_tr_b16 v[248:249], v10 offset:12288
ds_read_b64_tr_b16 v[250:251], v10 offset:14336
v_mfma_f32_16x16x32_bf16 v[44:47], v[156:159], a[52:55], v[44:47]
s_nop 0
ds_read_b64_tr_b16 v[252:253], v11 offset:12288
ds_read_b64_tr_b16 v[254:255], v11 offset:14336
v_mfma_f32_16x16x32_bf16 v[44:47], v[172:175], a[56:59], v[44:47]
v_mfma_f32_16x16x32_bf16 v[44:47], v[188:191], a[60:63], v[44:47]
v_mfma_f32_16x16x32_bf16 v[28:31], v[188:191], a[44:47], v[28:31]
s_add_u32 s72, s71, 30720
buffer_load_dwordx4 v15, s[24:27], s72 offen offset:2048 lds
v_mfma_f32_16x16x32_bf16 v[28:31], v[172:175], a[40:43], v[28:31]
buffer_load_dwordx4 a[108:111], v1, s[44:47], s69 offen offset:3072 sc1
v_mfma_f32_16x16x32_bf16 v[28:31], v[156:159], a[36:39], v[28:31]
s_waitcnt vmcnt(20) lgkmcnt(0)
v_mfma_f32_16x16x32_bf16 v[28:31], v[140:143], a[32:35], v[28:31]
s_barrier
v_mfma_f32_16x16x32_bf16 v[48:51], v[192:195], a[32:35], v[48:51]
s_nop 0
ds_read_b64_tr_b16 v[128:129], v8 offset:16384
ds_read_b64_tr_b16 v[130:131], v8 offset:18432
v_mfma_f32_16x16x32_bf16 v[48:51], v[208:211], a[36:39], v[48:51]
s_nop 0
ds_read_b64_tr_b16 v[132:133], v9 offset:16384
ds_read_b64_tr_b16 v[134:135], v9 offset:18432
v_mfma_f32_16x16x32_bf16 v[48:51], v[224:227], a[40:43], v[48:51]
s_add_u32 s72, s71, 46080
buffer_load_dwordx4 v15, s[24:27], s72 offen offset:3072 lds
v_mfma_f32_16x16x32_bf16 v[48:51], v[240:243], a[44:47], v[48:51]
s_nop 0
ds_read_b64_tr_b16 v[136:137], v10 offset:16384
ds_read_b64_tr_b16 v[138:139], v10 offset:18432
v_mfma_f32_16x16x32_bf16 v[64:67], v[240:243], a[60:63], v[64:67]
s_nop 0
ds_read_b64_tr_b16 v[140:141], v11 offset:16384
ds_read_b64_tr_b16 v[142:143], v11 offset:18432
v_mfma_f32_16x16x32_bf16 v[64:67], v[224:227], a[56:59], v[64:67]
v_and_b32 v120, 15, v0
v_lshrrev_b32 v121, 4, v0
v_mfma_f32_16x16x32_bf16 v[64:67], v[208:211], a[52:55], v[64:67]
s_nop 0
ds_read_b64_tr_b16 v[144:145], v8 offset:20480
ds_read_b64_tr_b16 v[146:147], v8 offset:22528
v_mfma_f32_16x16x32_bf16 v[64:67], v[192:195], a[48:51], v[64:67]
s_add_u32 s69, s69, 0x20000
buffer_load_dwordx4 a[112:115], v1, s[44:47], s69 offen sc1
v_mfma_f32_16x16x32_bf16 v[68:71], v[196:199], a[48:51], v[68:71]
s_nop 0
ds_read_b64_tr_b16 v[148:149], v9 offset:20480
ds_read_b64_tr_b16 v[150:151], v9 offset:22528
v_mfma_f32_16x16x32_bf16 v[68:71], v[212:215], a[52:55], v[68:71]
s_nop 0
ds_read_b64_tr_b16 v[152:153], v10 offset:20480
ds_read_b64_tr_b16 v[154:155], v10 offset:22528
v_mfma_f32_16x16x32_bf16 v[68:71], v[228:231], a[56:59], v[68:71]
s_xor_b32 s71, s15, 0x80
v_lshlrev_b32 v121, 2, v121
v_sub_u32 v120, v120, v121
v_mfma_f32_16x16x32_bf16 v[68:71], v[244:247], a[60:63], v[68:71]
s_add_u32 m0, s77, 16384
ds_read_b64_tr_b16 v[156:157], v11 offset:20480
ds_read_b64_tr_b16 v[158:159], v11 offset:22528
v_mfma_f32_16x16x32_bf16 v[52:55], v[244:247], a[44:47], v[52:55]
s_add_u32 s72, s71, 0
buffer_load_dwordx4 v15, s[24:27], s72 offen lds
v_mfma_f32_16x16x32_bf16 v[52:55], v[228:231], a[40:43], v[52:55]
s_nop 0
ds_read_b64_tr_b16 v[160:161], v8 offset:24576
ds_read_b64_tr_b16 v[162:163], v8 offset:26624
v_mfma_f32_16x16x32_bf16 v[52:55], v[212:215], a[36:39], v[52:55]
s_nop 0
ds_read_b64_tr_b16 v[164:165], v9 offset:24576
ds_read_b64_tr_b16 v[166:167], v9 offset:26624
v_mfma_f32_16x16x32_bf16 v[52:55], v[196:199], a[32:35], v[52:55]
v_min_u32 v120, 4, v120
v_lshlrev_b32 v120, 3, v120
v_mfma_f32_16x16x32_bf16 v[56:59], v[200:203], a[32:35], v[56:59]
s_nop 0
ds_read_b64_tr_b16 v[168:169], v10 offset:24576
ds_read_b64_tr_b16 v[170:171], v10 offset:26624
v_mfma_f32_16x16x32_bf16 v[56:59], v[216:219], a[36:39], v[56:59]
s_add_u32 s72, s71, 15360
buffer_load_dwordx4 v15, s[24:27], s72 offen offset:1024 lds
v_mfma_f32_16x16x32_bf16 v[56:59], v[232:235], a[40:43], v[56:59]
buffer_load_dwordx4 a[116:119], v1, s[44:47], s69 offen offset:1024 sc1
v_mfma_f32_16x16x32_bf16 v[56:59], v[248:251], a[44:47], v[56:59]
s_nop 0
ds_read_b64_tr_b16 v[172:173], v11 offset:24576
ds_read_b64_tr_b16 v[174:175], v11 offset:26624
v_mfma_f32_16x16x32_bf16 v[72:75], v[248:251], a[60:63], v[72:75]
s_nop 0
ds_read_b64_tr_b16 v[176:177], v8 offset:28672
ds_read_b64_tr_b16 v[178:179], v8 offset:30720
v_mfma_f32_16x16x32_bf16 v[72:75], v[232:235], a[56:59], v[72:75]
v_mov_b32 v122, 0x3f80
v_mov_b32 v123, 0
v_mfma_f32_16x16x32_bf16 v[72:75], v[216:219], a[52:55], v[72:75]
s_nop 0
ds_read_b64_tr_b16 v[180:181], v9 offset:28672
ds_read_b64_tr_b16 v[182:183], v9 offset:30720
v_mfma_f32_16x16x32_bf16 v[72:75], v[200:203], a[48:51], v[72:75]
s_add_u32 s72, s71, 30720
buffer_load_dwordx4 v15, s[24:27], s72 offen offset:2048 lds
v_mfma_f32_16x16x32_bf16 v[76:79], v[204:207], a[48:51], v[76:79]
s_nop 0
ds_read_b64_tr_b16 v[184:185], v10 offset:28672
ds_read_b64_tr_b16 v[186:187], v10 offset:30720
v_mfma_f32_16x16x32_bf16 v[76:79], v[220:223], a[52:55], v[76:79]
s_nop 0
ds_read_b64_tr_b16 v[188:189], v11 offset:28672
ds_read_b64_tr_b16 v[190:191], v11 offset:30720
v_mfma_f32_16x16x32_bf16 v[76:79], v[236:239], a[56:59], v[76:79]
v_lshlrev_b64 v[122:123], v120, v[122:123]
v_mov_b32 v126, 0
v_mfma_f32_16x16x32_bf16 v[76:79], v[252:255], a[60:63], v[76:79]
buffer_load_dwordx4 a[120:123], v1, s[44:47], s69 offen offset:2048 sc1
v_mfma_f32_16x16x32_bf16 v[60:63], v[252:255], a[44:47], v[60:63]
v_lshlrev_b64 v[122:123], v120, v[122:123]
v_mov_b32 v127, 0
v_mfma_f32_16x16x32_bf16 v[60:63], v[236:239], a[40:43], v[60:63]
s_add_u32 s72, s71, 46080
buffer_load_dwordx4 v15, s[24:27], s72 offen offset:3072 lds
v_mfma_f32_16x16x32_bf16 v[60:63], v[220:223], a[36:39], v[60:63]
s_waitcnt vmcnt(22) lgkmcnt(0)
v_mov_b32 v120, 0
v_mov_b32 v121, 0
v_mfma_f32_16x16x32_bf16 v[60:63], v[204:207], a[32:35], v[60:63]
s_barrier
v_mov_b32 v124, v122
v_mov_b32 v125, v123
v_mfma_f32_16x16x32_bf16 v[80:83], v[128:131], a[32:35], v[80:83]
s_nop 0
ds_read_b64_tr_b16 v[192:193], v8 offset:32768
ds_read_b64_tr_b16 v[194:195], v8 offset:34816
v_mfma_f32_16x16x32_bf16 v[80:83], v[144:147], a[36:39], v[80:83]
s_nop 0
ds_read_b64_tr_b16 v[196:197], v9 offset:32768
ds_read_b64_tr_b16 v[198:199], v9 offset:34816
v_mfma_f32_16x16x32_bf16 v[80:83], v[160:163], a[40:43], v[80:83]
s_nop 0
ds_read_b64_tr_b16 v[200:201], v10 offset:32768
ds_read_b64_tr_b16 v[202:203], v10 offset:34816
v_mfma_f32_16x16x32_bf16 v[80:83], v[176:179], a[44:47], v[80:83]
s_nop 0
ds_read_b64_tr_b16 v[204:205], v11 offset:32768
ds_read_b64_tr_b16 v[206:207], v11 offset:34816
v_mfma_f32_16x16x32_bf16 v[96:99], v[176:179], a[60:63], v[96:99]
v_mfma_f32_16x16x32_bf16 v[96:99], v[160:163], a[56:59], v[96:99]
s_xor_b32 s71, s15, 0x100
buffer_load_dwordx4 a[124:127], v1, s[44:47], s69 offen offset:3072 sc1
v_mfma_f32_16x16x32_bf16 v[96:99], v[144:147], a[52:55], v[96:99]
s_add_u32 m0, s77, 32768
ds_read_b64_tr_b16 v[208:209], v8 offset:36864
ds_read_b64_tr_b16 v[210:211], v8 offset:38912
v_mfma_f32_16x16x32_bf16 v[96:99], v[128:131], a[48:51], v[96:99]
s_add_u32 s72, s71, 0
buffer_load_dwordx4 v15, s[24:27], s72 offen lds
v_mfma_f32_16x16x32_bf16 v[100:103], v[132:135], a[48:51], v[100:103]
s_nop 0
ds_read_b64_tr_b16 v[212:213], v9 offset:36864
ds_read_b64_tr_b16 v[214:215], v9 offset:38912
v_mfma_f32_16x16x32_bf16 v[100:103], v[148:151], a[52:55], v[100:103]
s_nop 0
ds_read_b64_tr_b16 v[216:217], v10 offset:36864
ds_read_b64_tr_b16 v[218:219], v10 offset:38912
v_mfma_f32_16x16x32_bf16 v[100:103], v[164:167], a[56:59], v[100:103]
s_nop 0
ds_read_b64_tr_b16 v[220:221], v11 offset:36864
ds_read_b64_tr_b16 v[222:223], v11 offset:38912
v_mfma_f32_16x16x32_bf16 v[100:103], v[180:183], a[60:63], v[100:103]
v_mfma_f32_16x16x32_bf16 v[84:87], v[180:183], a[44:47], v[84:87]
s_nop 0
ds_read_b64_tr_b16 v[224:225], v8 offset:40960
ds_read_b64_tr_b16 v[226:227], v8 offset:43008
v_mfma_f32_16x16x32_bf16 v[84:87], v[164:167], a[40:43], v[84:87]
s_add_u32 s72, s71, 15360
buffer_load_dwordx4 v15, s[24:27], s72 offen offset:1024 lds
v_mfma_f32_16x16x32_bf16 v[84:87], v[148:151], a[36:39], v[84:87]
s_nop 0
ds_read_b64_tr_b16 v[228:229], v9 offset:40960
ds_read_b64_tr_b16 v[230:231], v9 offset:43008
v_mfma_f32_16x16x32_bf16 v[84:87], v[132:135], a[32:35], v[84:87]
s_waitcnt vmcnt(22)
v_cmp_gt_u32 vcc, 2, v3
s_cbranch_vccnz Lspin106
Lback107:
s_lshr_b32 s69, s12, 18
s_lshl_b32 s69, s69, 12
s_add_u32 s69, s69, s95
s_xor_b32 s69, s69, 0x10000
buffer_load_dwordx4 a[128:131], v1, s[44:47], s69 offen sc1
v_mfma_f32_16x16x32_bf16 v[88:91], v[136:139], a[32:35], v[88:91]
s_nop 0
ds_read_b64_tr_b16 v[232:233], v10 offset:40960
ds_read_b64_tr_b16 v[234:235], v10 offset:43008
v_mfma_f32_16x16x32_bf16 v[88:91], v[152:155], a[36:39], v[88:91]
s_nop 0
ds_read_b64_tr_b16 v[236:237], v11 offset:40960
ds_read_b64_tr_b16 v[238:239], v11 offset:43008
v_mfma_f32_16x16x32_bf16 v[88:91], v[168:171], a[40:43], v[88:91]
v_mfma_f32_16x16x32_bf16 v[88:91], v[184:187], a[44:47], v[88:91]
s_add_u32 s72, s71, 30720
buffer_load_dwordx4 v15, s[24:27], s72 offen offset:2048 lds
v_mfma_f32_16x16x32_bf16 v[104:107], v[184:187], a[60:63], v[104:107]
s_nop 0
ds_read_b64_tr_b16 v[240:241], v8 offset:45056
ds_read_b64_tr_b16 v[242:243], v8 offset:47104
v_mfma_f32_16x16x32_bf16 v[104:107], v[168:171], a[56:59], v[104:107]
s_nop 0
ds_read_b64_tr_b16 v[244:245], v9 offset:45056
ds_read_b64_tr_b16 v[246:247], v9 offset:47104
v_mfma_f32_16x16x32_bf16 v[104:107], v[152:155], a[52:55], v[104:107]
s_nop 0
ds_read_b64_tr_b16 v[248:249], v10 offset:45056
ds_read_b64_tr_b16 v[250:251], v10 offset:47104
v_mfma_f32_16x16x32_bf16 v[104:107], v[136:139], a[48:51], v[104:107]
s_nop 0
ds_read_b64_tr_b16 v[252:253], v11 offset:45056
ds_read_b64_tr_b16 v[254:255], v11 offset:47104
v_mfma_f32_16x16x32_bf16 v[108:111], v[140:143], a[48:51], v[108:111]
v_mfma_f32_16x16x32_bf16 v[108:111], v[156:159], a[52:55], v[108:111]
s_add_u32 s72, s71, 46080
buffer_load_dwordx4 v15, s[24:27], s72 offen offset:3072 lds
v_mfma_f32_16x16x32_bf16 v[108:111], v[172:175], a[56:59], v[108:111]
buffer_load_dwordx4 a[132:135], v1, s[44:47], s69 offen offset:1024 sc1
v_mfma_f32_16x16x32_bf16 v[108:111], v[188:191], a[60:63], v[108:111]
v_mfma_f32_16x16x32_bf16 v[92:95], v[188:191], a[44:47], v[92:95]
v_mfma_f32_16x16x32_bf16 v[92:95], v[172:175], a[40:43], v[92:95]
v_mfma_f32_16x16x32_bf16 v[92:95], v[156:159], a[36:39], v[92:95]
s_waitcnt vmcnt(22) lgkmcnt(0)
v_mfma_f32_16x16x32_bf16 v[92:95], v[140:143], a[32:35], v[92:95]
s_barrier
v_mfma_f32_16x16x32_bf16 v[16:19], v[192:195], a[64:67], v[16:19]
s_nop 0
ds_read_b64_tr_b16 v[128:129], v8 offset:49152
ds_read_b64_tr_b16 v[130:131], v8 offset:51200
v_mfma_f32_16x16x32_bf16 v[16:19], v[208:211], a[68:71], v[16:19]
s_xor_b32 s71, s15, 0x180
ds_read_b64_tr_b16 v[132:133], v9 offset:49152
ds_read_b64_tr_b16 v[134:135], v9 offset:51200
v_mfma_f32_16x16x32_bf16 v[16:19], v[224:227], a[72:75], v[16:19]
s_add_u32 m0, s77, 49152
ds_read_b64_tr_b16 v[136:137], v10 offset:49152
ds_read_b64_tr_b16 v[138:139], v10 offset:51200
v_mfma_f32_16x16x32_bf16 v[16:19], v[240:243], a[76:79], v[16:19]
s_add_u32 s72, s71, 0
buffer_load_dwordx4 v15, s[24:27], s72 offen lds
v_mfma_f32_16x16x32_bf16 v[32:35], v[240:243], a[92:95], v[32:35]
buffer_load_dwordx4 a[136:139], v1, s[44:47], s69 offen offset:2048 sc1
v_mfma_f32_16x16x32_bf16 v[32:35], v[224:227], a[88:91], v[32:35]
s_nop 0
ds_read_b64_tr_b16 v[140:141], v11 offset:49152
ds_read_b64_tr_b16 v[142:143], v11 offset:51200
v_mfma_f32_16x16x32_bf16 v[32:35], v[208:211], a[84:87], v[32:35]
v_mfma_f32_16x16x32_bf16 v[32:35], v[192:195], a[80:83], v[32:35]
s_nop 0
ds_read_b64_tr_b16 v[144:145], v8 offset:53248
ds_read_b64_tr_b16 v[146:147], v8 offset:55296
v_mfma_f32_16x16x32_bf16 v[36:39], v[196:199], a[80:83], v[36:39]
s_add_u32 s72, s71, 15360
buffer_load_dwordx4 v15, s[24:27], s72 offen offset:1024 lds
v_mfma_f32_16x16x32_bf16 v[36:39], v[212:215], a[84:87], v[36:39]
s_nop 0
ds_read_b64_tr_b16 v[148:149], v9 offset:53248
ds_read_b64_tr_b16 v[150:151], v9 offset:55296
v_mfma_f32_16x16x32_bf16 v[36:39], v[228:231], a[88:91], v[36:39]
s_nop 0
ds_read_b64_tr_b16 v[152:153], v10 offset:53248
ds_read_b64_tr_b16 v[154:155], v10 offset:55296
v_mfma_f32_16x16x32_bf16 v[36:39], v[244:247], a[92:95], v[36:39]
s_nop 0
ds_read_b64_tr_b16 v[156:157], v11 offset:53248
ds_read_b64_tr_b16 v[158:159], v11 offset:55296
v_mfma_f32_16x16x32_bf16 v[20:23], v[244:247], a[76:79], v[20:23]
v_mfma_f32_16x16x32_bf16 v[20:23], v[228:231], a[72:75], v[20:23]
buffer_load_dwordx4 a[140:143], v1, s[44:47], s69 offen offset:3072 sc1
v_mfma_f32_16x16x32_bf16 v[20:23], v[212:215], a[68:71], v[20:23]
s_add_u32 s72, s71, 30720
buffer_load_dwordx4 v15, s[24:27], s72 offen offset:2048 lds
v_mfma_f32_16x16x32_bf16 v[20:23], v[196:199], a[64:67], v[20:23]
s_nop 0
ds_read_b64_tr_b16 v[160:161], v8 offset:57344
ds_read_b64_tr_b16 v[162:163], v8 offset:59392
v_mfma_f32_16x16x32_bf16 v[24:27], v[200:203], a[64:67], v[24:27]
s_nop 0
ds_read_b64_tr_b16 v[164:165], v9 offset:57344
ds_read_b64_tr_b16 v[166:167], v9 offset:59392
v_mfma_f32_16x16x32_bf16 v[24:27], v[216:219], a[68:71], v[24:27]
s_nop 0
ds_read_b64_tr_b16 v[168:169], v10 offset:57344
ds_read_b64_tr_b16 v[170:171], v10 offset:59392
v_mfma_f32_16x16x32_bf16 v[24:27], v[232:235], a[72:75], v[24:27]
s_nop 0
ds_read_b64_tr_b16 v[172:173], v11 offset:57344
ds_read_b64_tr_b16 v[174:175], v11 offset:59392
v_mfma_f32_16x16x32_bf16 v[24:27], v[248:251], a[76:79], v[24:27]
v_mfma_f32_16x16x32_bf16 v[40:43], v[248:251], a[92:95], v[40:43]
s_add_u32 s72, s71, 46080
buffer_load_dwordx4 v15, s[24:27], s72 offen offset:3072 lds
v_mfma_f32_16x16x32_bf16 v[40:43], v[232:235], a[88:91], v[40:43]
s_nop 0
ds_read_b64_tr_b16 v[176:177], v8 offset:61440
ds_read_b64_tr_b16 v[178:179], v8 offset:63488
v_mfma_f32_16x16x32_bf16 v[40:43], v[216:219], a[84:87], v[40:43]
s_nop 0
ds_read_b64_tr_b16 v[180:181], v9 offset:61440
ds_read_b64_tr_b16 v[182:183], v9 offset:63488
v_mfma_f32_16x16x32_bf16 v[40:43], v[200:203], a[80:83], v[40:43]
s_add_u32 s69, s69, 0x20000
buffer_load_dwordx4 a[144:147], v1, s[44:47], s69 offen sc1
v_mfma_f32_16x16x32_bf16 v[44:47], v[204:207], a[80:83], v[44:47]
s_nop 0
ds_read_b64_tr_b16 v[184:185], v10 offset:61440
ds_read_b64_tr_b16 v[186:187], v10 offset:63488
v_mfma_f32_16x16x32_bf16 v[44:47], v[220:223], a[84:87], v[44:47]
s_nop 0
ds_read_b64_tr_b16 v[188:189], v11 offset:61440
ds_read_b64_tr_b16 v[190:191], v11 offset:63488
v_mfma_f32_16x16x32_bf16 v[44:47], v[236:239], a[88:91], v[44:47]
v_mfma_f32_16x16x32_bf16 v[44:47], v[252:255], a[92:95], v[44:47]
s_xor_b32 s71, s12, 0x400080
v_mfma_f32_16x16x32_bf16 v[28:31], v[252:255], a[76:79], v[28:31]
s_add_u32 m0, s85, 0
v_xor_b32 v8, 0x10000, v8
v_mfma_f32_16x16x32_bf16 v[28:31], v[236:239], a[72:75], v[28:31]
s_add_u32 s72, s71, 0
v_xor_b32 v9, 0x10000, v9
v_mfma_f32_16x16x32_bf16 v[28:31], v[220:223], a[68:71], v[28:31]
s_waitcnt vmcnt(21) lgkmcnt(0)
buffer_load_dwordx4 v15, s[24:27], s72 offen lds
v_xor_b32 v10, 0x10000, v10
v_mfma_f32_16x16x32_bf16 v[28:31], v[204:207], a[64:67], v[28:31]
s_barrier
v_xor_b32 v11, 0x10000, v11
v_mfma_f32_16x16x32_bf16 v[48:51], v[128:131], a[64:67], v[48:51]
s_nop 0
ds_read_b64_tr_b16 v[192:193], v8 offset:0
ds_read_b64_tr_b16 v[194:195], v8 offset:2048
v_mfma_f32_16x16x32_bf16 v[48:51], v[144:147], a[68:71], v[48:51]
buffer_load_dwordx4 a[148:151], v1, s[44:47], s69 offen offset:1024 sc1
v_mfma_f32_16x16x32_bf16 v[48:51], v[160:163], a[72:75], v[48:51]
s_nop 0
ds_read_b64_tr_b16 v[196:197], v9 offset:0
ds_read_b64_tr_b16 v[198:199], v9 offset:2048
v_mfma_f32_16x16x32_bf16 v[48:51], v[176:179], a[76:79], v[48:51]
s_add_u32 s72, s71, 15360
buffer_load_dwordx4 v15, s[24:27], s72 offen offset:1024 lds
v_mfma_f32_16x16x32_bf16 v[64:67], v[176:179], a[92:95], v[64:67]
s_nop 0
ds_read_b64_tr_b16 v[200:201], v10 offset:0
ds_read_b64_tr_b16 v[202:203], v10 offset:2048
v_mfma_f32_16x16x32_bf16 v[64:67], v[160:163], a[88:91], v[64:67]
s_nop 0
ds_read_b64_tr_b16 v[204:205], v11 offset:0
ds_read_b64_tr_b16 v[206:207], v11 offset:2048
v_mfma_f32_16x16x32_bf16 v[64:67], v[144:147], a[84:87], v[64:67]
v_mfma_f32_16x16x32_bf16 v[64:67], v[128:131], a[80:83], v[64:67]
s_nop 0
ds_read_b64_tr_b16 v[208:209], v8 offset:4096
ds_read_b64_tr_b16 v[210:211], v8 offset:6144
v_mfma_f32_16x16x32_bf16 v[68:71], v[132:135], a[80:83], v[68:71]
s_nop 0
ds_read_b64_tr_b16 v[212:213], v9 offset:4096
ds_read_b64_tr_b16 v[214:215], v9 offset:6144
v_mfma_f32_16x16x32_bf16 v[68:71], v[148:151], a[84:87], v[68:71]
s_add_u32 s72, s71, 30720
buffer_load_dwordx4 v15, s[24:27], s72 offen offset:2048 lds
v_mfma_f32_16x16x32_bf16 v[68:71], v[164:167], a[88:91], v[68:71]
s_nop 0
ds_read_b64_tr_b16 v[216:217], v10 offset:4096
ds_read_b64_tr_b16 v[218:219], v10 offset:6144
v_mfma_f32_16x16x32_bf16 v[68:71], v[180:183], a[92:95], v[68:71]
buffer_load_dwordx4 a[152:155], v1, s[44:47], s69 offen offset:2048 sc1
v_mfma_f32_16x16x32_bf16 v[52:55], v[180:183], a[76:79], v[52:55]
s_nop 0
ds_read_b64_tr_b16 v[220:221], v11 offset:4096
ds_read_b64_tr_b16 v[222:223], v11 offset:6144
v_mfma_f32_16x16x32_bf16 v[52:55], v[164:167], a[72:75], v[52:55]
v_mfma_f32_16x16x32_bf16 v[52:55], v[148:151], a[68:71], v[52:55]
s_nop 0
ds_read_b64_tr_b16 v[224:225], v8 offset:8192
ds_read_b64_tr_b16 v[226:227], v8 offset:10240
v_mfma_f32_16x16x32_bf16 v[52:55], v[132:135], a[64:67], v[52:55]
s_add_u32 s72, s71, 46080
buffer_load_dwordx4 v15, s[24:27], s72 offen offset:3072 lds
v_mfma_f32_16x16x32_bf16 v[56:59], v[136:139], a[64:67], v[56:59]
s_nop 0
ds_read_b64_tr_b16 v[228:229], v9 offset:8192
ds_read_b64_tr_b16 v[230:231], v9 offset:10240
v_mfma_f32_16x16x32_bf16 v[56:59], v[152:155], a[68:71], v[56:59]
s_nop 0
ds_read_b64_tr_b16 v[232:233], v10 offset:8192
ds_read_b64_tr_b16 v[234:235], v10 offset:10240
v_mfma_f32_16x16x32_bf16 v[56:59], v[168:171], a[72:75], v[56:59]
s_nop 0
ds_read_b64_tr_b16 v[236:237], v11 offset:8192
ds_read_b64_tr_b16 v[238:239], v11 offset:10240
v_mfma_f32_16x16x32_bf16 v[56:59], v[184:187], a[76:79], v[56:59]
v_mfma_f32_16x16x32_bf16 v[72:75], v[184:187], a[92:95], v[72:75]
s_nop 0
ds_read_b64_tr_b16 v[240:241], v8 offset:12288
ds_read_b64_tr_b16 v[242:243], v8 offset:14336
v_mfma_f32_16x16x32_bf16 v[72:75], v[168:171], a[88:91], v[72:75]
buffer_load_dwordx4 a[156:159], v1, s[44:47], s69 offen offset:3072 sc1
v_mfma_f32_16x16x32_bf16 v[72:75], v[152:155], a[84:87], v[72:75]
s_lshr_b32 s69, s13, 18
ds_read_b64_tr_b16 v[244:245], v9 offset:12288
ds_read_b64_tr_b16 v[246:247], v9 offset:14336
v_mfma_f32_16x16x32_bf16 v[72:75], v[136:139], a[80:83], v[72:75]
s_xor_b32 s71, s12, 0x400100
ds_read_b64_tr_b16 v[248:249], v10 offset:12288
ds_read_b64_tr_b16 v[250:251], v10 offset:14336
v_mfma_f32_16x16x32_bf16 v[76:79], v[140:143], a[80:83], v[76:79]
s_add_u32 m0, s85, 16384
ds_read_b64_tr_b16 v[252:253], v11 offset:12288
ds_read_b64_tr_b16 v[254:255], v11 offset:14336
v_mfma_f32_16x16x32_bf16 v[76:79], v[156:159], a[84:87], v[76:79]
s_add_u32 s72, s71, 0
buffer_load_dwordx4 v15, s[24:27], s72 offen lds
v_mfma_f32_16x16x32_bf16 v[76:79], v[172:175], a[88:91], v[76:79]
s_lshl_b32 s69, s69, 12
v_mfma_f32_16x16x32_bf16 v[76:79], v[188:191], a[92:95], v[76:79]
s_add_u32 s69, s69, s95
v_mfma_f32_16x16x32_bf16 v[60:63], v[188:191], a[76:79], v[60:63]
s_xor_b32 s69, s69, 0x10000
v_mfma_f32_16x16x32_bf16 v[60:63], v[172:175], a[72:75], v[60:63]
s_add_u32 s72, s71, 15360
v_mfma_f32_16x16x32_bf16 v[60:63], v[156:159], a[68:71], v[60:63]
s_waitcnt vmcnt(22) lgkmcnt(0)
buffer_load_dwordx4 a[160:163], v1, s[44:47], s69 offen sc1
v_mfma_f32_16x16x32_bf16 v[60:63], v[140:143], a[64:67], v[60:63]
s_barrier
buffer_load_dwordx4 v15, s[24:27], s72 offen offset:1024 lds
v_mfma_f32_16x16x32_bf16 v[80:83], v[192:195], a[64:67], v[80:83]
s_and_b32 s79, s91, 0xffffcfff
v_lshlrev_b32 v13, 2, v2
buffer_load_dword v14, v13, s[44:47], s79 offen sc1
v_mfma_f32_16x16x32_bf16 v[80:83], v[208:211], a[68:71], v[80:83]
s_nop 0
ds_read_b64_tr_b16 v[128:129], v8 offset:16384
ds_read_b64_tr_b16 v[130:131], v8 offset:18432
v_mfma_f32_16x16x32_bf16 v[80:83], v[224:227], a[72:75], v[80:83]
s_nop 0
ds_read_b64_tr_b16 v[132:133], v9 offset:16384
ds_read_b64_tr_b16 v[134:135], v9 offset:18432
v_mfma_f32_16x16x32_bf16 v[80:83], v[240:243], a[76:79], v[80:83]
s_nop 0
ds_read_b64_tr_b16 v[136:137], v10 offset:16384
ds_read_b64_tr_b16 v[138:139], v10 offset:18432
v_mfma_f32_16x16x32_bf16 v[96:99], v[240:243], a[92:95], v[96:99]
s_nop 0
ds_read_b64_tr_b16 v[140:141], v11 offset:16384
ds_read_b64_tr_b16 v[142:143], v11 offset:18432
v_mfma_f32_16x16x32_bf16 v[96:99], v[224:227], a[88:91], v[96:99]
s_add_u32 s72, s71, 30720
buffer_load_dwordx4 v15, s[24:27], s72 offen offset:2048 lds
v_mfma_f32_16x16x32_bf16 v[96:99], v[208:211], a[84:87], v[96:99]
v_mfma_f32_16x16x32_bf16 v[96:99], v[192:195], a[80:83], v[96:99]
s_nop 0
ds_read_b64_tr_b16 v[144:145], v8 offset:20480
ds_read_b64_tr_b16 v[146:147], v8 offset:22528
v_mfma_f32_16x16x32_bf16 v[100:103], v[196:199], a[80:83], v[100:103]
buffer_load_dwordx4 a[164:167], v1, s[44:47], s69 offen offset:1024 sc1
v_mfma_f32_16x16x32_bf16 v[100:103], v[212:215], a[84:87], v[100:103]
s_nop 0
ds_read_b64_tr_b16 v[148:149], v9 offset:20480
ds_read_b64_tr_b16 v[150:151], v9 offset:22528
v_mfma_f32_16x16x32_bf16 v[100:103], v[228:231], a[88:91], v[100:103]
s_nop 0
ds_read_b64_tr_b16 v[152:153], v10 offset:20480
ds_read_b64_tr_b16 v[154:155], v10 offset:22528
v_mfma_f32_16x16x32_bf16 v[100:103], v[244:247], a[92:95], v[100:103]
s_add_u32 s72, s71, 46080
buffer_load_dwordx4 v15, s[24:27], s72 offen offset:3072 lds
v_mfma_f32_16x16x32_bf16 v[84:87], v[244:247], a[76:79], v[84:87]
s_nop 0
ds_read_b64_tr_b16 v[156:157], v11 offset:20480
ds_read_b64_tr_b16 v[158:159], v11 offset:22528
v_mfma_f32_16x16x32_bf16 v[84:87], v[228:231], a[72:75], v[84:87]
v_mfma_f32_16x16x32_bf16 v[84:87], v[212:215], a[68:71], v[84:87]
s_nop 0
ds_read_b64_tr_b16 v[160:161], v8 offset:24576
ds_read_b64_tr_b16 v[162:163], v8 offset:26624
v_mfma_f32_16x16x32_bf16 v[84:87], v[196:199], a[64:67], v[84:87]
s_nop 0
ds_read_b64_tr_b16 v[164:165], v9 offset:24576
ds_read_b64_tr_b16 v[166:167], v9 offset:26624
v_mfma_f32_16x16x32_bf16 v[88:91], v[200:203], a[64:67], v[88:91]
s_nop 0
ds_read_b64_tr_b16 v[168:169], v10 offset:24576
ds_read_b64_tr_b16 v[170:171], v10 offset:26624
v_mfma_f32_16x16x32_bf16 v[88:91], v[216:219], a[68:71], v[88:91]
s_nop 0
ds_read_b64_tr_b16 v[172:173], v11 offset:24576
ds_read_b64_tr_b16 v[174:175], v11 offset:26624
v_mfma_f32_16x16x32_bf16 v[88:91], v[232:235], a[72:75], v[88:91]
buffer_load_dwordx4 a[168:171], v1, s[44:47], s69 offen offset:2048 sc1
v_mfma_f32_16x16x32_bf16 v[88:91], v[248:251], a[76:79], v[88:91]
s_xor_b32 s71, s12, 0x400180
v_mfma_f32_16x16x32_bf16 v[104:107], v[248:251], a[92:95], v[104:107]
s_add_u32 m0, s85, 32768
ds_read_b64_tr_b16 v[176:177], v8 offset:28672
ds_read_b64_tr_b16 v[178:179], v8 offset:30720
v_mfma_f32_16x16x32_bf16 v[104:107], v[232:235], a[88:91], v[104:107]
s_add_u32 s72, s71, 0
buffer_load_dwordx4 v15, s[24:27], s72 offen lds
v_mfma_f32_16x16x32_bf16 v[104:107], v[216:219], a[84:87], v[104:107]
s_nop 0
ds_read_b64_tr_b16 v[180:181], v9 offset:28672
ds_read_b64_tr_b16 v[182:183], v9 offset:30720
v_mfma_f32_16x16x32_bf16 v[104:107], v[200:203], a[80:83], v[104:107]
s_nop 0
ds_read_b64_tr_b16 v[184:185], v10 offset:28672
ds_read_b64_tr_b16 v[186:187], v10 offset:30720
v_mfma_f32_16x16x32_bf16 v[108:111], v[204:207], a[80:83], v[108:111]
s_nop 0
ds_read_b64_tr_b16 v[188:189], v11 offset:28672
ds_read_b64_tr_b16 v[190:191], v11 offset:30720
v_mfma_f32_16x16x32_bf16 v[108:111], v[220:223], a[84:87], v[108:111]
v_mfma_f32_16x16x32_bf16 v[108:111], v[236:239], a[88:91], v[108:111]
s_add_u32 s72, s71, 15360
buffer_load_dwordx4 v15, s[24:27], s72 offen offset:1024 lds
v_mfma_f32_16x16x32_bf16 v[108:111], v[252:255], a[92:95], v[108:111]
v_mfma_f32_16x16x32_bf16 v[92:95], v[252:255], a[76:79], v[92:95]
buffer_load_dwordx4 a[172:175], v1, s[44:47], s69 offen offset:3072 sc1
v_mfma_f32_16x16x32_bf16 v[92:95], v[236:239], a[72:75], v[92:95]
v_mfma_f32_16x16x32_bf16 v[92:95], v[220:223], a[68:71], v[92:95]
s_waitcnt vmcnt(26) lgkmcnt(0)
v_mfma_f32_16x16x32_bf16 v[92:95], v[204:207], a[64:67], v[92:95]
s_barrier
v_mfma_f32_16x16x32_bf16 v[16:19], v[128:131], a[96:99], v[16:19]
s_add_u32 s72, s71, 30720
buffer_load_dwordx4 v15, s[24:27], s72 offen offset:2048 lds
v_mfma_f32_16x16x32_bf16 v[16:19], v[144:147], a[100:103], v[16:19]
s_nop 0
ds_read_b64_tr_b16 v[192:193], v8 offset:32768
ds_read_b64_tr_b16 v[194:195], v8 offset:34816
v_mfma_f32_16x16x32_bf16 v[16:19], v[160:163], a[104:107], v[16:19]
s_nop 0
ds_read_b64_tr_b16 v[196:197], v9 offset:32768
ds_read_b64_tr_b16 v[198:199], v9 offset:34816
v_mfma_f32_16x16x32_bf16 v[16:19], v[176:179], a[108:111], v[16:19]
s_nop 0
ds_read_b64_tr_b16 v[200:201], v10 offset:32768
ds_read_b64_tr_b16 v[202:203], v10 offset:34816
v_mfma_f32_16x16x32_bf16 v[32:35], v[176:179], a[124:127], v[32:35]
s_nop 0
ds_read_b64_tr_b16 v[204:205], v11 offset:32768
ds_read_b64_tr_b16 v[206:207], v11 offset:34816
v_mfma_f32_16x16x32_bf16 v[32:35], v[160:163], a[120:123], v[32:35]
Lstube1:
s_cbranch_execz Lrete
v_mfma_f32_16x16x32_bf16 v[32:35], v[144:147], a[116:119], v[32:35]
s_add_u32 s72, s71, 46080
buffer_load_dwordx4 v15, s[24:27], s72 offen offset:3072 lds
v_mfma_f32_16x16x32_bf16 v[32:35], v[128:131], a[112:115], v[32:35]
s_add_u32 s69, s69, 0x20000
buffer_load_dwordx4 a[176:179], v1, s[44:47], s69 offen sc1
v_mfma_f32_16x16x32_bf16 v[36:39], v[132:135], a[112:115], v[36:39]
s_nop 0
ds_read_b64_tr_b16 v[208:209], v8 offset:36864
ds_read_b64_tr_b16 v[210:211], v8 offset:38912
v_mfma_f32_16x16x32_bf16 v[36:39], v[148:151], a[116:119], v[36:39]
s_nop 0
ds_read_b64_tr_b16 v[212:213], v9 offset:36864
ds_read_b64_tr_b16 v[214:215], v9 offset:38912
v_mfma_f32_16x16x32_bf16 v[36:39], v[164:167], a[120:123], v[36:39]
s_nop 0
ds_read_b64_tr_b16 v[216:217], v10 offset:36864
ds_read_b64_tr_b16 v[218:219], v10 offset:38912
v_mfma_f32_16x16x32_bf16 v[36:39], v[180:183], a[124:127], v[36:39]
s_nop 0
ds_read_b64_tr_b16 v[220:221], v11 offset:36864
ds_read_b64_tr_b16 v[222:223], v11 offset:38912
v_mfma_f32_16x16x32_bf16 v[20:23], v[180:183], a[108:111], v[20:23]
v_mfma_f32_16x16x32_bf16 v[20:23], v[164:167], a[104:107], v[20:23]
s_nop 0
ds_read_b64_tr_b16 v[224:225], v8 offset:40960
ds_read_b64_tr_b16 v[226:227], v8 offset:43008
v_mfma_f32_16x16x32_bf16 v[20:23], v[148:151], a[100:103], v[20:23]
s_xor_b32 s71, s13, 0x400080
ds_read_b64_tr_b16 v[228:229], v9 offset:40960
ds_read_b64_tr_b16 v[230:231], v9 offset:43008
v_mfma_f32_16x16x32_bf16 v[20:23], v[132:135], a[96:99], v[20:23]
s_add_u32 m0, s85, 49152
ds_read_b64_tr_b16 v[232:233], v10 offset:40960
ds_read_b64_tr_b16 v[234:235], v10 offset:43008
v_mfma_f32_16x16x32_bf16 v[24:27], v[136:139], a[96:99], v[24:27]
s_add_u32 s72, s71, 0
buffer_load_dwordx4 v15, s[24:27], s72 offen lds
v_mfma_f32_16x16x32_bf16 v[24:27], v[152:155], a[100:103], v[24:27]
buffer_load_dwordx4 a[180:183], v1, s[44:47], s69 offen offset:1024 sc1
v_mfma_f32_16x16x32_bf16 v[24:27], v[168:171], a[104:107], v[24:27]
s_nop 0
ds_read_b64_tr_b16 v[236:237], v11 offset:40960
ds_read_b64_tr_b16 v[238:239], v11 offset:43008
v_mfma_f32_16x16x32_bf16 v[24:27], v[184:187], a[108:111], v[24:27]
v_mfma_f32_16x16x32_bf16 v[40:43], v[184:187], a[124:127], v[40:43]
s_nop 0
ds_read_b64_tr_b16 v[240:241], v8 offset:45056
ds_read_b64_tr_b16 v[242:243], v8 offset:47104
v_mfma_f32_16x16x32_bf16 v[40:43], v[168:171], a[120:123], v[40:43]
s_nop 0
ds_read_b64_tr_b16 v[244:245], v9 offset:45056
ds_read_b64_tr_b16 v[246:247], v9 offset:47104
v_mfma_f32_16x16x32_bf16 v[40:43], v[152:155], a[116:119], v[40:43]
s_add_u32 s72, s71, 15360
buffer_load_dwordx4 v15, s[24:27], s72 offen offset:1024 lds
v_mfma_f32_16x16x32_bf16 v[40:43], v[136:139], a[112:115], v[40:43]
s_nop 0
ds_read_b64_tr_b16 v[248:249], v10 offset:45056
ds_read_b64_tr_b16 v[250:251], v10 offset:47104
v_mfma_f32_16x16x32_bf16 v[44:47], v[140:143], a[112:115], v[44:47]
s_nop 0
ds_read_b64_tr_b16 v[252:253], v11 offset:45056
ds_read_b64_tr_b16 v[254:255], v11 offset:47104
v_mfma_f32_16x16x32_bf16 v[44:47], v[156:159], a[116:119], v[44:47]
v_mfma_f32_16x16x32_bf16 v[44:47], v[172:175], a[120:123], v[44:47]
buffer_load_dwordx4 a[184:187], v1, s[44:47], s69 offen offset:2048 sc1
v_mfma_f32_16x16x32_bf16 v[44:47], v[188:191], a[124:127], v[44:47]
v_mfma_f32_16x16x32_bf16 v[28:31], v[188:191], a[108:111], v[28:31]
s_add_u32 s72, s71, 30720
buffer_load_dwordx4 v15, s[24:27], s72 offen offset:2048 lds
v_mfma_f32_16x16x32_bf16 v[28:31], v[172:175], a[104:107], v[28:31]
v_mfma_f32_16x16x32_bf16 v[28:31], v[156:159], a[100:103], v[28:31]
s_waitcnt vmcnt(27) lgkmcnt(0)
v_mfma_f32_16x16x32_bf16 v[28:31], v[140:143], a[96:99], v[28:31]
s_barrier
v_mfma_f32_16x16x32_bf16 v[48:51], v[192:195], a[96:99], v[48:51]
s_nop 0
ds_read_b64_tr_b16 v[128:129], v8 offset:49152
ds_read_b64_tr_b16 v[130:131], v8 offset:51200
v_mfma_f32_16x16x32_bf16 v[48:51], v[208:211], a[100:103], v[48:51]
s_nop 0
ds_read_b64_tr_b16 v[132:133], v9 offset:49152
ds_read_b64_tr_b16 v[134:135], v9 offset:51200
v_mfma_f32_16x16x32_bf16 v[48:51], v[224:227], a[104:107], v[48:51]
s_add_u32 s72, s71, 46080
buffer_load_dwordx4 v15, s[24:27], s72 offen offset:3072 lds
v_mfma_f32_16x16x32_bf16 v[48:51], v[240:243], a[108:111], v[48:51]
s_nop 0
ds_read_b64_tr_b16 v[136:137], v10 offset:49152
ds_read_b64_tr_b16 v[138:139], v10 offset:51200
v_mfma_f32_16x16x32_bf16 v[64:67], v[240:243], a[124:127], v[64:67]
buffer_load_dwordx4 a[188:191], v1, s[44:47], s69 offen offset:3072 sc1
v_mfma_f32_16x16x32_bf16 v[64:67], v[224:227], a[120:123], v[64:67]
s_nop 0
ds_read_b64_tr_b16 v[140:141], v11 offset:49152
ds_read_b64_tr_b16 v[142:143], v11 offset:51200
v_mfma_f32_16x16x32_bf16 v[64:67], v[208:211], a[116:119], v[64:67]
s_nop 0
ds_read_b64_tr_b16 v[144:145], v8 offset:53248
ds_read_b64_tr_b16 v[146:147], v8 offset:55296
v_mfma_f32_16x16x32_bf16 v[64:67], v[192:195], a[112:115], v[64:67]
s_nop 0
ds_read_b64_tr_b16 v[148:149], v9 offset:53248
ds_read_b64_tr_b16 v[150:151], v9 offset:55296
v_mfma_f32_16x16x32_bf16 v[68:71], v[196:199], a[112:115], v[68:71]
s_lshr_b32 s69, s14, 18
v_mfma_f32_16x16x32_bf16 v[68:71], v[212:215], a[116:119], v[68:71]
s_lshl_b32 s69, s69, 12
ds_read_b64_tr_b16 v[152:153], v10 offset:53248
ds_read_b64_tr_b16 v[154:155], v10 offset:55296
v_mfma_f32_16x16x32_bf16 v[68:71], v[228:231], a[120:123], v[68:71]
s_xor_b32 s71, s14, 0x400080
ds_read_b64_tr_b16 v[156:157], v11 offset:53248
ds_read_b64_tr_b16 v[158:159], v11 offset:55296
v_mfma_f32_16x16x32_bf16 v[68:71], v[244:247], a[124:127], v[68:71]
s_add_u32 m0, s77, 0
ds_read_b64_tr_b16 v[160:161], v8 offset:57344
ds_read_b64_tr_b16 v[162:163], v8 offset:59392
v_mfma_f32_16x16x32_bf16 v[52:55], v[244:247], a[108:111], v[52:55]
s_add_u32 s72, s71, 0
buffer_load_dwordx4 v15, s[24:27], s72 offen lds
v_mfma_f32_16x16x32_bf16 v[52:55], v[228:231], a[104:107], v[52:55]
s_add_u32 s69, s69, s95
ds_read_b64_tr_b16 v[164:165], v9 offset:57344
ds_read_b64_tr_b16 v[166:167], v9 offset:59392
v_mfma_f32_16x16x32_bf16 v[52:55], v[212:215], a[100:103], v[52:55]
s_xor_b32 s69, s69, 0x10000
buffer_load_dwordx4 a[192:195], v1, s[44:47], s69 offen sc1
v_mfma_f32_16x16x32_bf16 v[52:55], v[196:199], a[96:99], v[52:55]
s_nop 0
ds_read_b64_tr_b16 v[168:169], v10 offset:57344
ds_read_b64_tr_b16 v[170:171], v10 offset:59392
v_mfma_f32_16x16x32_bf16 v[56:59], v[200:203], a[96:99], v[56:59]
s_waitcnt vmcnt(19)
v_cmp_gt_u32 vcc, 2, v14
s_cbranch_vccnz Lspin112
Lback113:
v_mfma_f32_16x16x32_bf16 v[56:59], v[216:219], a[100:103], v[56:59]
s_add_u32 s72, s71, 15360
buffer_load_dwordx4 v15, s[24:27], s72 offen offset:1024 lds
v_mfma_f32_16x16x32_bf16 v[56:59], v[232:235], a[104:107], v[56:59]
v_mfma_f32_16x16x32_bf16 v[56:59], v[248:251], a[108:111], v[56:59]
s_nop 0
ds_read_b64_tr_b16 v[172:173], v11 offset:57344
ds_read_b64_tr_b16 v[174:175], v11 offset:59392
v_mfma_f32_16x16x32_bf16 v[72:75], v[248:251], a[124:127], v[72:75]
s_nop 0
ds_read_b64_tr_b16 v[176:177], v8 offset:61440
ds_read_b64_tr_b16 v[178:179], v8 offset:63488
v_mfma_f32_16x16x32_bf16 v[72:75], v[232:235], a[120:123], v[72:75]
s_nop 0
ds_read_b64_tr_b16 v[180:181], v9 offset:61440
ds_read_b64_tr_b16 v[182:183], v9 offset:63488
v_mfma_f32_16x16x32_bf16 v[72:75], v[216:219], a[116:119], v[72:75]
s_nop 0
ds_read_b64_tr_b16 v[184:185], v10 offset:61440
ds_read_b64_tr_b16 v[186:187], v10 offset:63488
v_mfma_f32_16x16x32_bf16 v[72:75], v[200:203], a[112:115], v[72:75]
s_add_u32 s72, s71, 30720
buffer_load_dwordx4 v15, s[24:27], s72 offen offset:2048 lds
v_mfma_f32_16x16x32_bf16 v[76:79], v[204:207], a[112:115], v[76:79]
buffer_load_dwordx4 a[196:199], v1, s[44:47], s69 offen offset:1024 sc1
v_mfma_f32_16x16x32_bf16 v[76:79], v[220:223], a[116:119], v[76:79]
s_nop 0
ds_read_b64_tr_b16 v[188:189], v11 offset:61440
ds_read_b64_tr_b16 v[190:191], v11 offset:63488
v_mfma_f32_16x16x32_bf16 v[76:79], v[236:239], a[120:123], v[76:79]
v_mfma_f32_16x16x32_bf16 v[76:79], v[252:255], a[124:127], v[76:79]
v_mfma_f32_16x16x32_bf16 v[60:63], v[252:255], a[108:111], v[60:63]
v_xor_b32 v8, 0x10000, v8
v_mfma_f32_16x16x32_bf16 v[60:63], v[236:239], a[104:107], v[60:63]
s_add_u32 s72, s71, 46080
buffer_load_dwordx4 v15, s[24:27], s72 offen offset:3072 lds
v_xor_b32 v9, 0x10000, v9
v_mfma_f32_16x16x32_bf16 v[60:63], v[220:223], a[100:103], v[60:63]
s_waitcnt vmcnt(28) lgkmcnt(0)
v_xor_b32 v10, 0x10000, v10
v_mfma_f32_16x16x32_bf16 v[60:63], v[204:207], a[96:99], v[60:63]
s_barrier
v_xor_b32 v11, 0x10000, v11
v_mfma_f32_16x16x32_bf16 v[80:83], v[128:131], a[96:99], v[80:83]
s_lshl_b32 s84, s76, 11
ds_read_b64_tr_b16 v[192:193], v8 offset:0
ds_read_b64_tr_b16 v[194:195], v8 offset:2048
v_mfma_f32_16x16x32_bf16 v[80:83], v[144:147], a[100:103], v[80:83]
s_add_u32 s84, s84, 0x3810000
ds_read_b64_tr_b16 v[196:197], v9 offset:0
ds_read_b64_tr_b16 v[198:199], v9 offset:2048
v_mfma_f32_16x16x32_bf16 v[80:83], v[160:163], a[104:107], v[80:83]
buffer_load_dwordx4 a[200:203], v1, s[44:47], s69 offen offset:2048 sc1
v_mfma_f32_16x16x32_bf16 v[80:83], v[176:179], a[108:111], v[80:83]
s_nop 0
ds_read_b64_tr_b16 v[200:201], v10 offset:0
ds_read_b64_tr_b16 v[202:203], v10 offset:2048
v_mfma_f32_16x16x32_bf16 v[96:99], v[176:179], a[124:127], v[96:99]
s_nop 0
ds_read_b64_tr_b16 v[204:205], v11 offset:0
ds_read_b64_tr_b16 v[206:207], v11 offset:2048
v_mfma_f32_16x16x32_bf16 v[96:99], v[160:163], a[120:123], v[96:99]
s_xor_b32 s71, s15, 0x400080
v_lshrrev_b32 v115, 2, v0
v_lshlrev_b32 v115, 7, v115
v_mfma_f32_16x16x32_bf16 v[96:99], v[144:147], a[116:119], v[96:99]
s_add_u32 m0, s77, 16384
ds_read_b64_tr_b16 v[208:209], v8 offset:4096
ds_read_b64_tr_b16 v[210:211], v8 offset:6144
v_mfma_f32_16x16x32_bf16 v[96:99], v[128:131], a[112:115], v[96:99]
s_add_u32 s72, s71, 0
buffer_load_dwordx4 v15, s[24:27], s72 offen lds
v_mfma_f32_16x16x32_bf16 v[100:103], v[132:135], a[112:115], v[100:103]
s_nop 0
ds_read_b64_tr_b16 v[212:213], v9 offset:4096
ds_read_b64_tr_b16 v[214:215], v9 offset:6144
v_mfma_f32_16x16x32_bf16 v[100:103], v[148:151], a[116:119], v[100:103]
s_nop 0
ds_read_b64_tr_b16 v[216:217], v10 offset:4096
ds_read_b64_tr_b16 v[218:219], v10 offset:6144
v_mfma_f32_16x16x32_bf16 v[100:103], v[164:167], a[120:123], v[100:103]
s_nop 0
ds_read_b64_tr_b16 v[220:221], v11 offset:4096
ds_read_b64_tr_b16 v[222:223], v11 offset:6144
v_mfma_f32_16x16x32_bf16 v[100:103], v[180:183], a[124:127], v[100:103]
buffer_load_dword v114, v115, s[44:47], s84 offen sc1
v_mfma_f32_16x16x32_bf16 v[84:87], v[180:183], a[108:111], v[84:87]
buffer_load_dwordx4 a[204:207], v1, s[44:47], s69 offen offset:3072 sc1
v_mfma_f32_16x16x32_bf16 v[84:87], v[164:167], a[104:107], v[84:87]
s_add_u32 s72, s71, 15360
buffer_load_dwordx4 v15, s[24:27], s72 offen offset:1024 lds
v_mfma_f32_16x16x32_bf16 v[84:87], v[148:151], a[100:103], v[84:87]
s_nop 0
ds_read_b64_tr_b16 v[224:225], v8 offset:8192
ds_read_b64_tr_b16 v[226:227], v8 offset:10240
v_mfma_f32_16x16x32_bf16 v[84:87], v[132:135], a[96:99], v[84:87]
s_nop 0
ds_read_b64_tr_b16 v[228:229], v9 offset:8192
ds_read_b64_tr_b16 v[230:231], v9 offset:10240
v_mfma_f32_16x16x32_bf16 v[88:91], v[136:139], a[96:99], v[88:91]
s_nop 0
ds_read_b64_tr_b16 v[232:233], v10 offset:8192
ds_read_b64_tr_b16 v[234:235], v10 offset:10240
v_mfma_f32_16x16x32_bf16 v[88:91], v[152:155], a[100:103], v[88:91]
s_nop 0
ds_read_b64_tr_b16 v[236:237], v11 offset:8192
ds_read_b64_tr_b16 v[238:239], v11 offset:10240
v_mfma_f32_16x16x32_bf16 v[88:91], v[168:171], a[104:107], v[88:91]
v_mfma_f32_16x16x32_bf16 v[88:91], v[184:187], a[108:111], v[88:91]
s_add_u32 s72, s71, 30720
buffer_load_dwordx4 v15, s[24:27], s72 offen offset:2048 lds
v_mfma_f32_16x16x32_bf16 v[104:107], v[184:187], a[124:127], v[104:107]
s_nop 0
ds_read_b64_tr_b16 v[240:241], v8 offset:12288
ds_read_b64_tr_b16 v[242:243], v8 offset:14336
v_mfma_f32_16x16x32_bf16 v[104:107], v[168:171], a[120:123], v[104:107]
s_nop 0
ds_read_b64_tr_b16 v[244:245], v9 offset:12288
ds_read_b64_tr_b16 v[246:247], v9 offset:14336
v_mfma_f32_16x16x32_bf16 v[104:107], v[152:155], a[116:119], v[104:107]
s_add_u32 s69, s69, 0x20000
buffer_load_dwordx4 a[208:211], v1, s[44:47], s69 offen sc1
v_mfma_f32_16x16x32_bf16 v[104:107], v[136:139], a[112:115], v[104:107]
s_nop 0
ds_read_b64_tr_b16 v[248:249], v10 offset:12288
ds_read_b64_tr_b16 v[250:251], v10 offset:14336
v_mfma_f32_16x16x32_bf16 v[108:111], v[140:143], a[112:115], v[108:111]
s_nop 0
ds_read_b64_tr_b16 v[252:253], v11 offset:12288
ds_read_b64_tr_b16 v[254:255], v11 offset:14336
v_mfma_f32_16x16x32_bf16 v[108:111], v[156:159], a[116:119], v[108:111]
s_add_u32 s72, s71, 46080
buffer_load_dwordx4 v15, s[24:27], s72 offen offset:3072 lds
v_mfma_f32_16x16x32_bf16 v[108:111], v[172:175], a[120:123], v[108:111]
v_mfma_f32_16x16x32_bf16 v[108:111], v[188:191], a[124:127], v[108:111]
v_mfma_f32_16x16x32_bf16 v[92:95], v[188:191], a[108:111], v[92:95]
v_mfma_f32_16x16x32_bf16 v[92:95], v[172:175], a[104:107], v[92:95]
v_mfma_f32_16x16x32_bf16 v[92:95], v[156:159], a[100:103], v[92:95]
s_waitcnt vmcnt(28) lgkmcnt(0)
v_mfma_f32_16x16x32_bf16 v[92:95], v[140:143], a[96:99], v[92:95]
s_barrier
v_mfma_f32_16x16x32_bf16 v[16:19], v[192:195], a[128:131], v[16:19]
buffer_load_dwordx4 a[212:215], v1, s[44:47], s69 offen offset:1024 sc1
v_mfma_f32_16x16x32_bf16 v[16:19], v[208:211], a[132:135], v[16:19]
s_xor_b32 s71, s13, 0x400100
ds_read_b64_tr_b16 v[128:129], v8 offset:16384
ds_read_b64_tr_b16 v[130:131], v8 offset:18432
v_mfma_f32_16x16x32_bf16 v[16:19], v[224:227], a[136:139], v[16:19]
s_add_u32 m0, s77, 32768
ds_read_b64_tr_b16 v[132:133], v9 offset:16384
ds_read_b64_tr_b16 v[134:135], v9 offset:18432
v_mfma_f32_16x16x32_bf16 v[16:19], v[240:243], a[140:143], v[16:19]
s_add_u32 s72, s71, 0
buffer_load_dwordx4 v15, s[24:27], s72 offen lds
v_mfma_f32_16x16x32_bf16 v[32:35], v[240:243], a[156:159], v[32:35]
s_nop 0
ds_read_b64_tr_b16 v[136:137], v10 offset:16384
ds_read_b64_tr_b16 v[138:139], v10 offset:18432
v_mfma_f32_16x16x32_bf16 v[32:35], v[224:227], a[152:155], v[32:35]
s_nop 0
ds_read_b64_tr_b16 v[140:141], v11 offset:16384
ds_read_b64_tr_b16 v[142:143], v11 offset:18432
v_mfma_f32_16x16x32_bf16 v[32:35], v[208:211], a[148:151], v[32:35]
v_mfma_f32_16x16x32_bf16 v[32:35], v[192:195], a[144:147], v[32:35]
s_nop 0
ds_read_b64_tr_b16 v[144:145], v8 offset:20480
ds_read_b64_tr_b16 v[146:147], v8 offset:22528
v_mfma_f32_16x16x32_bf16 v[36:39], v[196:199], a[144:147], v[36:39]
s_add_u32 s72, s71, 15360
buffer_load_dwordx4 v15, s[24:27], s72 offen offset:1024 lds
v_mfma_f32_16x16x32_bf16 v[36:39], v[212:215], a[148:151], v[36:39]
s_nop 0
ds_read_b64_tr_b16 v[148:149], v9 offset:20480
ds_read_b64_tr_b16 v[150:151], v9 offset:22528
v_mfma_f32_16x16x32_bf16 v[36:39], v[228:231], a[152:155], v[36:39]
buffer_load_dwordx4 a[216:219], v1, s[44:47], s69 offen offset:2048 sc1
v_mfma_f32_16x16x32_bf16 v[36:39], v[244:247], a[156:159], v[36:39]
s_nop 0
ds_read_b64_tr_b16 v[152:153], v10 offset:20480
ds_read_b64_tr_b16 v[154:155], v10 offset:22528
v_mfma_f32_16x16x32_bf16 v[20:23], v[244:247], a[140:143], v[20:23]
s_nop 0
ds_read_b64_tr_b16 v[156:157], v11 offset:20480
ds_read_b64_tr_b16 v[158:159], v11 offset:22528
v_mfma_f32_16x16x32_bf16 v[20:23], v[228:231], a[136:139], v[20:23]
v_mfma_f32_16x16x32_bf16 v[20:23], v[212:215], a[132:135], v[20:23]
s_add_u32 s72, s71, 30720
buffer_load_dwordx4 v15, s[24:27], s72 offen offset:2048 lds
v_mfma_f32_16x16x32_bf16 v[20:23], v[196:199], a[128:131], v[20:23]
s_nop 0
ds_read_b64_tr_b16 v[160:161], v8 offset:24576
ds_read_b64_tr_b16 v[162:163], v8 offset:26624
v_mfma_f32_16x16x32_bf16 v[24:27], v[200:203], a[128:131], v[24:27]
s_nop 0
ds_read_b64_tr_b16 v[164:165], v9 offset:24576
ds_read_b64_tr_b16 v[166:167], v9 offset:26624
v_mfma_f32_16x16x32_bf16 v[24:27], v[216:219], a[132:135], v[24:27]
s_nop 0
ds_read_b64_tr_b16 v[168:169], v10 offset:24576
ds_read_b64_tr_b16 v[170:171], v10 offset:26624
v_mfma_f32_16x16x32_bf16 v[24:27], v[232:235], a[136:139], v[24:27]
s_nop 0
ds_read_b64_tr_b16 v[172:173], v11 offset:24576
ds_read_b64_tr_b16 v[174:175], v11 offset:26624
v_mfma_f32_16x16x32_bf16 v[24:27], v[248:251], a[140:143], v[24:27]
v_mfma_f32_16x16x32_bf16 v[40:43], v[248:251], a[156:159], v[40:43]
s_add_u32 s72, s71, 46080
buffer_load_dwordx4 v15, s[24:27], s72 offen offset:3072 lds
v_mfma_f32_16x16x32_bf16 v[40:43], v[232:235], a[152:155], v[40:43]
buffer_load_dwordx4 a[220:223], v1, s[44:47], s69 offen offset:3072 sc1
v_mfma_f32_16x16x32_bf16 v[40:43], v[216:219], a[148:151], v[40:43]
s_nop 0
ds_read_b64_tr_b16 v[176:177], v8 offset:28672
ds_read_b64_tr_b16 v[178:179], v8 offset:30720
v_mfma_f32_16x16x32_bf16 v[40:43], v[200:203], a[144:147], v[40:43]
s_lshr_b32 s69, s15, 18
ds_read_b64_tr_b16 v[180:181], v9 offset:28672
ds_read_b64_tr_b16 v[182:183], v9 offset:30720
v_mfma_f32_16x16x32_bf16 v[44:47], v[204:207], a[144:147], v[44:47]
s_lshl_b32 s69, s69, 12
ds_read_b64_tr_b16 v[184:185], v10 offset:28672
ds_read_b64_tr_b16 v[186:187], v10 offset:30720
v_mfma_f32_16x16x32_bf16 v[44:47], v[220:223], a[148:151], v[44:47]
s_add_u32 s69, s69, s95
ds_read_b64_tr_b16 v[188:189], v11 offset:28672
ds_read_b64_tr_b16 v[190:191], v11 offset:30720
v_mfma_f32_16x16x32_bf16 v[44:47], v[236:239], a[152:155], v[44:47]
s_xor_b32 s69, s69, 0x10000
v_mfma_f32_16x16x32_bf16 v[44:47], v[252:255], a[156:159], v[44:47]
s_xor_b32 s71, s14, 0x400100
v_mfma_f32_16x16x32_bf16 v[28:31], v[252:255], a[140:143], v[28:31]
s_add_u32 m0, s77, 49152
v_mfma_f32_16x16x32_bf16 v[28:31], v[236:239], a[136:139], v[28:31]
s_add_u32 s72, s71, 0
v_mfma_f32_16x16x32_bf16 v[28:31], v[220:223], a[132:135], v[28:31]
s_waitcnt vmcnt(29) lgkmcnt(0)
buffer_load_dwordx4 v15, s[24:27], s72 offen lds
v_mfma_f32_16x16x32_bf16 v[28:31], v[204:207], a[128:131], v[28:31]
s_barrier
buffer_load_dwordx4 a[224:227], v1, s[44:47], s69 offen sc1
v_mfma_f32_16x16x32_bf16 v[48:51], v[128:131], a[128:131], v[48:51]
s_nop 0
ds_read_b64_tr_b16 v[192:193], v8 offset:32768
ds_read_b64_tr_b16 v[194:195], v8 offset:34816
v_mfma_f32_16x16x32_bf16 v[48:51], v[144:147], a[132:135], v[48:51]
s_nop 0
ds_read_b64_tr_b16 v[196:197], v9 offset:32768
ds_read_b64_tr_b16 v[198:199], v9 offset:34816
v_mfma_f32_16x16x32_bf16 v[48:51], v[160:163], a[136:139], v[48:51]
s_nop 0
ds_read_b64_tr_b16 v[200:201], v10 offset:32768
ds_read_b64_tr_b16 v[202:203], v10 offset:34816
v_mfma_f32_16x16x32_bf16 v[48:51], v[176:179], a[140:143], v[48:51]
s_add_u32 s72, s71, 15360
buffer_load_dwordx4 v15, s[24:27], s72 offen offset:1024 lds
v_mfma_f32_16x16x32_bf16 v[64:67], v[176:179], a[156:159], v[64:67]
s_nop 0
ds_read_b64_tr_b16 v[204:205], v11 offset:32768
ds_read_b64_tr_b16 v[206:207], v11 offset:34816
v_mfma_f32_16x16x32_bf16 v[64:67], v[160:163], a[152:155], v[64:67]
v_mfma_f32_16x16x32_bf16 v[64:67], v[144:147], a[148:151], v[64:67]
s_nop 0
ds_read_b64_tr_b16 v[208:209], v8 offset:36864
ds_read_b64_tr_b16 v[210:211], v8 offset:38912
v_mfma_f32_16x16x32_bf16 v[64:67], v[128:131], a[144:147], v[64:67]
s_nop 0
ds_read_b64_tr_b16 v[212:213], v9 offset:36864
ds_read_b64_tr_b16 v[214:215], v9 offset:38912
v_mfma_f32_16x16x32_bf16 v[68:71], v[132:135], a[144:147], v[68:71]
buffer_load_dwordx4 a[228:231], v1, s[44:47], s69 offen offset:1024 sc1
v_mfma_f32_16x16x32_bf16 v[68:71], v[148:151], a[148:151], v[68:71]
s_add_u32 s72, s71, 30720
buffer_load_dwordx4 v15, s[24:27], s72 offen offset:2048 lds
v_mfma_f32_16x16x32_bf16 v[68:71], v[164:167], a[152:155], v[68:71]
s_nop 0
ds_read_b64_tr_b16 v[216:217], v10 offset:36864
ds_read_b64_tr_b16 v[218:219], v10 offset:38912
v_mfma_f32_16x16x32_bf16 v[68:71], v[180:183], a[156:159], v[68:71]
v_mfma_f32_16x16x32_bf16 v[52:55], v[180:183], a[140:143], v[52:55]
s_nop 0
ds_read_b64_tr_b16 v[220:221], v11 offset:36864
ds_read_b64_tr_b16 v[222:223], v11 offset:38912
v_mfma_f32_16x16x32_bf16 v[52:55], v[164:167], a[136:139], v[52:55]
s_nop 0
ds_read_b64_tr_b16 v[224:225], v8 offset:40960
ds_read_b64_tr_b16 v[226:227], v8 offset:43008
v_mfma_f32_16x16x32_bf16 v[52:55], v[148:151], a[132:135], v[52:55]
s_nop 0
ds_read_b64_tr_b16 v[228:229], v9 offset:40960
ds_read_b64_tr_b16 v[230:231], v9 offset:43008
v_mfma_f32_16x16x32_bf16 v[52:55], v[132:135], a[128:131], v[52:55]
s_add_u32 s72, s71, 46080
buffer_load_dwordx4 v15, s[24:27], s72 offen offset:3072 lds
v_mfma_f32_16x16x32_bf16 v[56:59], v[136:139], a[128:131], v[56:59]
v_mfma_f32_16x16x32_bf16 v[56:59], v[152:155], a[132:135], v[56:59]
s_nop 0
ds_read_b64_tr_b16 v[232:233], v10 offset:40960
ds_read_b64_tr_b16 v[234:235], v10 offset:43008
v_mfma_f32_16x16x32_bf16 v[56:59], v[168:171], a[136:139], v[56:59]
buffer_load_dwordx4 a[232:235], v1, s[44:47], s69 offen offset:2048 sc1
v_mfma_f32_16x16x32_bf16 v[56:59], v[184:187], a[140:143], v[56:59]
s_nop 0
ds_read_b64_tr_b16 v[236:237], v11 offset:40960
ds_read_b64_tr_b16 v[238:239], v11 offset:43008
v_mfma_f32_16x16x32_bf16 v[72:75], v[184:187], a[156:159], v[72:75]
s_nop 0
ds_read_b64_tr_b16 v[240:241], v8 offset:45056
ds_read_b64_tr_b16 v[242:243], v8 offset:47104
v_mfma_f32_16x16x32_bf16 v[72:75], v[168:171], a[152:155], v[72:75]
v_mfma_f32_16x16x32_bf16 v[72:75], v[152:155], a[148:151], v[72:75]
s_nop 0
ds_read_b64_tr_b16 v[244:245], v9 offset:45056
ds_read_b64_tr_b16 v[246:247], v9 offset:47104
v_mfma_f32_16x16x32_bf16 v[72:75], v[136:139], a[144:147], v[72:75]
s_xor_b32 s71, s15, 0x400100
ds_read_b64_tr_b16 v[248:249], v10 offset:45056
ds_read_b64_tr_b16 v[250:251], v10 offset:47104
v_mfma_f32_16x16x32_bf16 v[76:79], v[140:143], a[144:147], v[76:79]
s_add_u32 m0, s85, 0
ds_read_b64_tr_b16 v[252:253], v11 offset:45056
ds_read_b64_tr_b16 v[254:255], v11 offset:47104
v_mfma_f32_16x16x32_bf16 v[76:79], v[156:159], a[148:151], v[76:79]
s_add_u32 s72, s71, 0
buffer_load_dwordx4 v15, s[24:27], s72 offen lds
v_mfma_f32_16x16x32_bf16 v[76:79], v[172:175], a[152:155], v[76:79]
v_mfma_f32_16x16x32_bf16 v[76:79], v[188:191], a[156:159], v[76:79]
v_mfma_f32_16x16x32_bf16 v[60:63], v[188:191], a[140:143], v[60:63]
buffer_load_dwordx4 a[236:239], v1, s[44:47], s69 offen offset:3072 sc1
v_mfma_f32_16x16x32_bf16 v[60:63], v[172:175], a[136:139], v[60:63]
s_add_u32 s72, s71, 15360
v_mfma_f32_16x16x32_bf16 v[60:63], v[156:159], a[132:135], v[60:63]
s_waitcnt vmcnt(31) lgkmcnt(0)
v_mfma_f32_16x16x32_bf16 v[60:63], v[140:143], a[128:131], v[60:63]
s_barrier
buffer_load_dwordx4 v15, s[24:27], s72 offen offset:1024 lds
v_mfma_f32_16x16x32_bf16 v[80:83], v[192:195], a[128:131], v[80:83]
s_nop 0
ds_read_b64_tr_b16 v[128:129], v8 offset:49152
ds_read_b64_tr_b16 v[130:131], v8 offset:51200
v_mfma_f32_16x16x32_bf16 v[80:83], v[208:211], a[132:135], v[80:83]
s_nop 0
ds_read_b64_tr_b16 v[132:133], v9 offset:49152
ds_read_b64_tr_b16 v[134:135], v9 offset:51200
v_mfma_f32_16x16x32_bf16 v[80:83], v[224:227], a[136:139], v[80:83]
s_nop 0
ds_read_b64_tr_b16 v[136:137], v10 offset:49152
ds_read_b64_tr_b16 v[138:139], v10 offset:51200
s_waitcnt vmcnt(22)
v_cmp_gt_u32 vcc, 3, v114
s_cbranch_vccnz Lspin109
Lback110:
v_mfma_f32_16x16x32_bf16 v[80:83], v[240:243], a[140:143], v[80:83]
s_lshl_b32 s73, s76, 18
ds_read_b64_tr_b16 v[140:141], v11 offset:49152
ds_read_b64_tr_b16 v[142:143], v11 offset:51200
v_mfma_f32_16x16x32_bf16 v[96:99], v[240:243], a[156:159], v[96:99]
s_lshl_b32 s84, s58, 16
v_mfma_f32_16x16x32_bf16 v[96:99], v[224:227], a[152:155], v[96:99]
s_add_u32 s72, s71, 30720
buffer_load_dwordx4 v15, s[24:27], s72 offen offset:2048 lds
v_mfma_f32_16x16x32_bf16 v[96:99], v[208:211], a[148:151], v[96:99]
s_add_u32 s69, s69, 0x20000
buffer_load_dwordx4 a[240:243], v1, s[44:47], s69 offen sc1
v_mfma_f32_16x16x32_bf16 v[96:99], v[192:195], a[144:147], v[96:99]
s_add_u32 s73, s73, s84
ds_read_b64_tr_b16 v[144:145], v8 offset:53248
ds_read_b64_tr_b16 v[146:147], v8 offset:55296
v_mfma_f32_16x16x32_bf16 v[100:103], v[196:199], a[144:147], v[100:103]
s_lshl_b32 s84, s75, 8
ds_read_b64_tr_b16 v[148:149], v9 offset:53248
ds_read_b64_tr_b16 v[150:151], v9 offset:55296
v_mfma_f32_16x16x32_bf16 v[100:103], v[212:215], a[148:151], v[100:103]
s_add_u32 s73, s73, s84
ds_read_b64_tr_b16 v[152:153], v10 offset:53248
ds_read_b64_tr_b16 v[154:155], v10 offset:55296
v_mfma_f32_16x16x32_bf16 v[100:103], v[228:231], a[152:155], v[100:103]
s_add_u32 s73, s73, 0x3400000
v_lshrrev_b32 v112, 4, v0
v_and_b32 v113, 15, v0
v_mfma_f32_16x16x32_bf16 v[100:103], v[244:247], a[156:159], v[100:103]
s_add_u32 s72, s71, 46080
buffer_load_dwordx4 v15, s[24:27], s72 offen offset:3072 lds
v_mfma_f32_16x16x32_bf16 v[84:87], v[244:247], a[140:143], v[84:87]
s_nop 0
ds_read_b64_tr_b16 v[156:157], v11 offset:53248
ds_read_b64_tr_b16 v[158:159], v11 offset:55296
v_mfma_f32_16x16x32_bf16 v[84:87], v[228:231], a[136:139], v[84:87]
s_nop 0
ds_read_b64_tr_b16 v[160:161], v8 offset:57344
ds_read_b64_tr_b16 v[162:163], v8 offset:59392
v_mfma_f32_16x16x32_bf16 v[84:87], v[212:215], a[132:135], v[84:87]
s_nop 0
ds_read_b64_tr_b16 v[164:165], v9 offset:57344
ds_read_b64_tr_b16 v[166:167], v9 offset:59392
v_mfma_f32_16x16x32_bf16 v[84:87], v[196:199], a[128:131], v[84:87]
v_xor_b32 v12, v113, v112
v_lshlrev_b32 v12, 4, v12
v_mfma_f32_16x16x32_bf16 v[88:91], v[200:203], a[128:131], v[88:91]
buffer_load_dwordx4 a[244:247], v1, s[44:47], s69 offen offset:1024 sc1
v_mfma_f32_16x16x32_bf16 v[88:91], v[216:219], a[132:135], v[88:91]
s_nop 0
ds_read_b64_tr_b16 v[168:169], v10 offset:57344
ds_read_b64_tr_b16 v[170:171], v10 offset:59392
v_mfma_f32_16x16x32_bf16 v[88:91], v[232:235], a[136:139], v[88:91]
s_nop 0
ds_read_b64_tr_b16 v[172:173], v11 offset:57344
ds_read_b64_tr_b16 v[174:175], v11 offset:59392
v_mfma_f32_16x16x32_bf16 v[88:91], v[248:251], a[140:143], v[88:91]
s_xor_b32 s71, s13, 0x400180
ds_read_b64_tr_b16 v[176:177], v8 offset:61440
ds_read_b64_tr_b16 v[178:179], v8 offset:63488
v_mfma_f32_16x16x32_bf16 v[104:107], v[248:251], a[156:159], v[104:107]
s_add_u32 m0, s85, 16384
v_lshl_add_u32 v112, v112, 12, v12
v_xor_b32 v12, 64, v112
v_mfma_f32_16x16x32_bf16 v[104:107], v[232:235], a[152:155], v[104:107]
s_add_u32 s72, s71, 0
buffer_load_dwordx4 v15, s[24:27], s72 offen lds
v_mfma_f32_16x16x32_bf16 v[104:107], v[216:219], a[148:151], v[104:107]
s_nop 0
ds_read_b64_tr_b16 v[180:181], v9 offset:61440
ds_read_b64_tr_b16 v[182:183], v9 offset:63488
v_mfma_f32_16x16x32_bf16 v[104:107], v[200:203], a[144:147], v[104:107]
s_nop 0
ds_read_b64_tr_b16 v[184:185], v10 offset:61440
ds_read_b64_tr_b16 v[186:187], v10 offset:63488
v_mfma_f32_16x16x32_bf16 v[108:111], v[204:207], a[144:147], v[108:111]
s_nop 0
ds_read_b64_tr_b16 v[188:189], v11 offset:61440
ds_read_b64_tr_b16 v[190:191], v11 offset:63488
v_mfma_f32_16x16x32_bf16 v[108:111], v[220:223], a[148:151], v[108:111]
v_lshlrev_b32 v113, 2, v113
v_mfma_f32_16x16x32_bf16 v[108:111], v[236:239], a[152:155], v[108:111]
s_add_u32 s72, s71, 15360
buffer_load_dwordx4 v15, s[24:27], s72 offen offset:1024 lds
v_mfma_f32_16x16x32_bf16 v[108:111], v[252:255], a[156:159], v[108:111]
Lstube2:
s_cbranch_execz Lrete
buffer_load_dwordx4 a[248:251], v1, s[44:47], s69 offen offset:2048 sc1
v_mfma_f32_16x16x32_bf16 v[92:95], v[252:255], a[140:143], v[92:95]
v_xor_b32 v8, 0x10000, v8
v_mfma_f32_16x16x32_bf16 v[92:95], v[236:239], a[136:139], v[92:95]
v_xor_b32 v9, 0x10000, v9
v_mfma_f32_16x16x32_bf16 v[92:95], v[220:223], a[132:135], v[92:95]
s_waitcnt vmcnt(32) lgkmcnt(0)
v_xor_b32 v10, 0x10000, v10
v_mfma_f32_16x16x32_bf16 v[92:95], v[204:207], a[128:131], v[92:95]
s_barrier
v_xor_b32 v11, 0x10000, v11
v_mfma_f32_16x16x32_bf16 v[16:19], v[128:131], a[160:163], v[16:19]
s_add_u32 s72, s71, 30720
buffer_load_dwordx4 v15, s[24:27], s72 offen offset:2048 lds
v_mfma_f32_16x16x32_bf16 v[16:19], v[144:147], a[164:167], v[16:19]
s_nop 0
ds_read_b64_tr_b16 v[192:193], v8 offset:0
ds_read_b64_tr_b16 v[194:195], v8 offset:2048
v_mfma_f32_16x16x32_bf16 v[16:19], v[160:163], a[168:171], v[16:19]
s_nop 0
ds_read_b64_tr_b16 v[196:197], v9 offset:0
ds_read_b64_tr_b16 v[198:199], v9 offset:2048
v_mfma_f32_16x16x32_bf16 v[16:19], v[176:179], a[172:175], v[16:19]
s_nop 0
ds_read_b64_tr_b16 v[200:201], v10 offset:0
ds_read_b64_tr_b16 v[202:203], v10 offset:2048
v_mfma_f32_16x16x32_bf16 v[32:35], v[176:179], a[188:191], v[32:35]
buffer_load_dwordx4 a[252:255], v1, s[44:47], s69 offen offset:3072 sc1
v_mfma_f32_16x16x32_bf16 v[32:35], v[160:163], a[184:187], v[32:35]
v_mfma_f32_16x16x32_bf16 v[32:35], v[144:147], a[180:183], v[32:35]
s_add_u32 s72, s71, 46080
buffer_load_dwordx4 v15, s[24:27], s72 offen offset:3072 lds
v_mfma_f32_16x16x32_bf16 v[32:35], v[128:131], a[176:179], v[32:35]
s_nop 0
ds_read_b64_tr_b16 v[204:205], v11 offset:0
ds_read_b64_tr_b16 v[206:207], v11 offset:2048
v_mfma_f32_16x16x32_bf16 v[36:39], v[132:135], a[176:179], v[36:39]
s_nop 0
ds_read_b64_tr_b16 v[208:209], v8 offset:4096
ds_read_b64_tr_b16 v[210:211], v8 offset:6144
v_mfma_f32_16x16x32_bf16 v[36:39], v[148:151], a[180:183], v[36:39]
s_nop 0
ds_read_b64_tr_b16 v[212:213], v9 offset:4096
ds_read_b64_tr_b16 v[214:215], v9 offset:6144
v_mfma_f32_16x16x32_bf16 v[36:39], v[164:167], a[184:187], v[36:39]
v_mfma_f32_16x16x32_bf16 v[36:39], v[180:183], a[188:191], v[36:39]
s_nop 0
ds_read_b64_tr_b16 v[216:217], v10 offset:4096
ds_read_b64_tr_b16 v[218:219], v10 offset:6144
v_mfma_f32_16x16x32_bf16 v[20:23], v[180:183], a[172:175], v[20:23]
s_nop 0
ds_read_b64_tr_b16 v[220:221], v11 offset:4096
ds_read_b64_tr_b16 v[222:223], v11 offset:6144
v_mfma_f32_16x16x32_bf16 v[20:23], v[164:167], a[168:171], v[20:23]
v_mfma_f32_16x16x32_bf16 v[20:23], v[148:151], a[164:167], v[20:23]
s_xor_b32 s71, s14, 0x400180
ds_read_b64_tr_b16 v[224:225], v8 offset:8192
ds_read_b64_tr_b16 v[226:227], v8 offset:10240
v_mfma_f32_16x16x32_bf16 v[20:23], v[132:135], a[160:163], v[20:23]
s_add_u32 m0, s85, 32768
ds_read_b64_tr_b16 v[228:229], v9 offset:8192
ds_read_b64_tr_b16 v[230:231], v9 offset:10240
v_mfma_f32_16x16x32_bf16 v[24:27], v[136:139], a[160:163], v[24:27]
s_add_u32 s72, s71, 0
buffer_load_dwordx4 v15, s[24:27], s72 offen lds
v_mfma_f32_16x16x32_bf16 v[24:27], v[152:155], a[164:167], v[24:27]
s_nop 0
ds_read_b64_tr_b16 v[232:233], v10 offset:8192
ds_read_b64_tr_b16 v[234:235], v10 offset:10240
v_mfma_f32_16x16x32_bf16 v[24:27], v[168:171], a[168:171], v[24:27]
v_mfma_f32_16x16x32_bf16 v[24:27], v[184:187], a[172:175], v[24:27]
s_nop 0
ds_read_b64_tr_b16 v[236:237], v11 offset:8192
ds_read_b64_tr_b16 v[238:239], v11 offset:10240
v_mfma_f32_16x16x32_bf16 v[40:43], v[184:187], a[188:191], v[40:43]
s_nop 0
ds_read_b64_tr_b16 v[240:241], v8 offset:12288
ds_read_b64_tr_b16 v[242:243], v8 offset:14336
v_mfma_f32_16x16x32_bf16 v[40:43], v[168:171], a[184:187], v[40:43]
s_nop 0
ds_read_b64_tr_b16 v[244:245], v9 offset:12288
ds_read_b64_tr_b16 v[246:247], v9 offset:14336
v_mfma_f32_16x16x32_bf16 v[40:43], v[152:155], a[180:183], v[40:43]
s_add_u32 s72, s71, 15360
buffer_load_dwordx4 v15, s[24:27], s72 offen offset:1024 lds
v_mfma_f32_16x16x32_bf16 v[40:43], v[136:139], a[176:179], v[40:43]
v_mfma_f32_16x16x32_bf16 v[44:47], v[140:143], a[176:179], v[44:47]
s_nop 0
ds_read_b64_tr_b16 v[248:249], v10 offset:12288
ds_read_b64_tr_b16 v[250:251], v10 offset:14336
v_mfma_f32_16x16x32_bf16 v[44:47], v[156:159], a[180:183], v[44:47]
s_nop 0
ds_read_b64_tr_b16 v[252:253], v11 offset:12288
ds_read_b64_tr_b16 v[254:255], v11 offset:14336
v_mfma_f32_16x16x32_bf16 v[44:47], v[172:175], a[184:187], v[44:47]
v_mfma_f32_16x16x32_bf16 v[44:47], v[188:191], a[188:191], v[44:47]
v_mfma_f32_16x16x32_bf16 v[28:31], v[188:191], a[172:175], v[28:31]
s_add_u32 s72, s71, 30720
buffer_load_dwordx4 v15, s[24:27], s72 offen offset:2048 lds
v_mfma_f32_16x16x32_bf16 v[28:31], v[172:175], a[168:171], v[28:31]
v_mfma_f32_16x16x32_bf16 v[28:31], v[156:159], a[164:167], v[28:31]
s_waitcnt vmcnt(23) lgkmcnt(0)
v_mfma_f32_16x16x32_bf16 v[28:31], v[140:143], a[160:163], v[28:31]
s_barrier
v_mfma_f32_16x16x32_bf16 v[16:19], v[192:195], a[192:195], v[16:19]
s_nop 0
ds_read_b64_tr_b16 v[128:129], v8 offset:16384
ds_read_b64_tr_b16 v[130:131], v8 offset:18432
v_mfma_f32_16x16x32_bf16 v[16:19], v[208:211], a[196:199], v[16:19]
s_nop 0
ds_read_b64_tr_b16 v[132:133], v9 offset:16384
ds_read_b64_tr_b16 v[134:135], v9 offset:18432
v_mfma_f32_16x16x32_bf16 v[16:19], v[224:227], a[200:203], v[16:19]
s_add_u32 s72, s71, 46080
buffer_load_dwordx4 v15, s[24:27], s72 offen offset:3072 lds
v_mfma_f32_16x16x32_bf16 v[16:19], v[240:243], a[204:207], v[16:19]
s_nop 0
ds_read_b64_tr_b16 v[136:137], v10 offset:16384
ds_read_b64_tr_b16 v[138:139], v10 offset:18432
v_mfma_f32_16x16x32_bf16 v[32:35], v[240:243], a[220:223], v[32:35]
s_nop 0
ds_read_b64_tr_b16 v[140:141], v11 offset:16384
ds_read_b64_tr_b16 v[142:143], v11 offset:18432
v_mfma_f32_16x16x32_bf16 v[32:35], v[224:227], a[216:219], v[32:35]
v_mfma_f32_16x16x32_bf16 v[32:35], v[208:211], a[212:215], v[32:35]
s_nop 0
ds_read_b64_tr_b16 v[144:145], v8 offset:20480
ds_read_b64_tr_b16 v[146:147], v8 offset:22528
v_mfma_f32_16x16x32_bf16 v[32:35], v[192:195], a[208:211], v[32:35]
s_nop 0
ds_read_b64_tr_b16 v[148:149], v9 offset:20480
ds_read_b64_tr_b16 v[150:151], v9 offset:22528
v_mfma_f32_16x16x32_bf16 v[36:39], v[196:199], a[208:211], v[36:39]
s_nop 0
ds_read_b64_tr_b16 v[152:153], v10 offset:20480
ds_read_b64_tr_b16 v[154:155], v10 offset:22528
v_mfma_f32_16x16x32_bf16 v[36:39], v[212:215], a[212:215], v[36:39]
s_nop 0
ds_read_b64_tr_b16 v[156:157], v11 offset:20480
ds_read_b64_tr_b16 v[158:159], v11 offset:22528
v_mfma_f32_16x16x32_bf16 v[36:39], v[228:231], a[216:219], v[36:39]
v_mfma_f32_16x16x32_bf16 v[36:39], v[244:247], a[220:223], v[36:39]
s_add_u32 m0, s64, 147456
ds_read_b64_tr_b16 v[160:161], v8 offset:24576
ds_read_b64_tr_b16 v[162:163], v8 offset:26624
v_mfma_f32_16x16x32_bf16 v[20:23], v[244:247], a[204:207], v[20:23]
s_add_u32 s72, s73, 0
buffer_load_dwordx4 v112, s[44:47], s72 offen sc1 lds
v_mfma_f32_16x16x32_bf16 v[20:23], v[228:231], a[200:203], v[20:23]
s_nop 0
ds_read_b64_tr_b16 v[164:165], v9 offset:24576
ds_read_b64_tr_b16 v[166:167], v9 offset:26624
v_mfma_f32_16x16x32_bf16 v[20:23], v[212:215], a[196:199], v[20:23]
s_add_u32 s72, s73, 15360
buffer_load_dwordx4 v12, s[44:47], s72 offen offset:1024 sc1 lds
v_mfma_f32_16x16x32_bf16 v[20:23], v[196:199], a[192:195], v[20:23]
s_nop 0
ds_read_b64_tr_b16 v[168:169], v10 offset:24576
ds_read_b64_tr_b16 v[170:171], v10 offset:26624
v_mfma_f32_16x16x32_bf16 v[24:27], v[200:203], a[192:195], v[24:27]
s_nop 0
ds_read_b64_tr_b16 v[172:173], v11 offset:24576
ds_read_b64_tr_b16 v[174:175], v11 offset:26624
v_mfma_f32_16x16x32_bf16 v[24:27], v[216:219], a[196:199], v[24:27]
s_add_u32 s72, s73, 30720
buffer_load_dwordx4 v112, s[44:47], s72 offen offset:2048 sc1 lds
v_mfma_f32_16x16x32_bf16 v[24:27], v[232:235], a[200:203], v[24:27]
v_mfma_f32_16x16x32_bf16 v[24:27], v[248:251], a[204:207], v[24:27]
s_nop 0
ds_read_b64_tr_b16 v[176:177], v8 offset:28672
ds_read_b64_tr_b16 v[178:179], v8 offset:30720
v_mfma_f32_16x16x32_bf16 v[40:43], v[248:251], a[220:223], v[40:43]
s_add_u32 s72, s73, 46080
buffer_load_dwordx4 v12, s[44:47], s72 offen offset:3072 sc1 lds
v_mfma_f32_16x16x32_bf16 v[40:43], v[232:235], a[216:219], v[40:43]
s_xor_b32 s71, s15, 0x400180
ds_read_b64_tr_b16 v[180:181], v9 offset:28672
ds_read_b64_tr_b16 v[182:183], v9 offset:30720
v_mfma_f32_16x16x32_bf16 v[40:43], v[216:219], a[212:215], v[40:43]
s_add_u32 m0, s85, 49152
ds_read_b64_tr_b16 v[184:185], v10 offset:28672
ds_read_b64_tr_b16 v[186:187], v10 offset:30720
v_mfma_f32_16x16x32_bf16 v[40:43], v[200:203], a[208:211], v[40:43]
s_add_u32 s72, s71, 0
buffer_load_dwordx4 v15, s[24:27], s72 offen lds
v_mfma_f32_16x16x32_bf16 v[44:47], v[204:207], a[208:211], v[44:47]
s_nop 0
ds_read_b64_tr_b16 v[188:189], v11 offset:28672
ds_read_b64_tr_b16 v[190:191], v11 offset:30720
v_mfma_f32_16x16x32_bf16 v[44:47], v[220:223], a[212:215], v[44:47]
v_mfma_f32_16x16x32_bf16 v[44:47], v[236:239], a[216:219], v[44:47]
s_add_u32 s72, s71, 15360
buffer_load_dwordx4 v15, s[24:27], s72 offen offset:1024 lds
v_mfma_f32_16x16x32_bf16 v[44:47], v[252:255], a[220:223], v[44:47]
v_mfma_f32_16x16x32_bf16 v[28:31], v[252:255], a[204:207], v[28:31]
v_mfma_f32_16x16x32_bf16 v[28:31], v[236:239], a[200:203], v[28:31]
s_add_u32 s72, s71, 30720
buffer_load_dwordx4 v15, s[24:27], s72 offen offset:2048 lds
v_mfma_f32_16x16x32_bf16 v[28:31], v[220:223], a[196:199], v[28:31]
s_waitcnt vmcnt(12) lgkmcnt(0)
v_mfma_f32_16x16x32_bf16 v[28:31], v[204:207], a[192:195], v[28:31]
s_barrier
v_mfma_f32_16x16x32_bf16 v[16:19], v[128:131], a[224:227], v[16:19]
s_add_u32 s72, s71, 46080
buffer_load_dwordx4 v15, s[24:27], s72 offen offset:3072 lds
v_mfma_f32_16x16x32_bf16 v[16:19], v[144:147], a[228:231], v[16:19]
s_lshl_b32 s73, s75, 9
ds_read_b64_tr_b16 v[192:193], v8 offset:32768
ds_read_b64_tr_b16 v[194:195], v8 offset:34816
v_mfma_f32_16x16x32_bf16 v[16:19], v[160:163], a[232:235], v[16:19]
s_lshl_b32 s84, s58, 7
ds_read_b64_tr_b16 v[196:197], v9 offset:32768
ds_read_b64_tr_b16 v[198:199], v9 offset:34816
v_mfma_f32_16x16x32_bf16 v[16:19], v[176:179], a[236:239], v[16:19]
s_add_u32 s73, s73, s84
ds_read_b64_tr_b16 v[200:201], v10 offset:32768
ds_read_b64_tr_b16 v[202:203], v10 offset:34816
v_mfma_f32_16x16x32_bf16 v[20:23], v[180:183], a[236:239], v[20:23]
s_add_u32 s73, s73, 0x3800000
ds_read_b64_tr_b16 v[204:205], v11 offset:32768
ds_read_b64_tr_b16 v[206:207], v11 offset:34816
v_mfma_f32_16x16x32_bf16 v[20:23], v[164:167], a[232:235], v[20:23]
s_xor_b32 s71, s12, 0x0
buffer_load_dword v6, v113, s[44:47], s73 offen sc1
v_mfma_f32_16x16x32_bf16 v[20:23], v[148:151], a[228:231], v[20:23]
s_add_u32 m0, s77, 0
ds_read_b64_tr_b16 v[208:209], v8 offset:36864
ds_read_b64_tr_b16 v[210:211], v8 offset:38912
v_mfma_f32_16x16x32_bf16 v[20:23], v[132:135], a[224:227], v[20:23]
s_add_u32 s72, s71, 0
buffer_load_dwordx4 v15, s[24:27], s72 offen lds
v_mfma_f32_16x16x32_bf16 v[24:27], v[136:139], a[224:227], v[24:27]
s_nop 0
ds_read_b64_tr_b16 v[212:213], v9 offset:36864
ds_read_b64_tr_b16 v[214:215], v9 offset:38912
v_mfma_f32_16x16x32_bf16 v[24:27], v[152:155], a[228:231], v[24:27]
s_nop 0
ds_read_b64_tr_b16 v[216:217], v10 offset:36864
ds_read_b64_tr_b16 v[218:219], v10 offset:38912
v_mfma_f32_16x16x32_bf16 v[24:27], v[168:171], a[232:235], v[24:27]
buffer_load_dword v7, v113, s[44:47], s73 offen offset:64 sc1
v_mfma_f32_16x16x32_bf16 v[24:27], v[184:187], a[236:239], v[24:27]
s_nop 0
ds_read_b64_tr_b16 v[220:221], v11 offset:36864
ds_read_b64_tr_b16 v[222:223], v11 offset:38912
v_cvt_pk_bf16_f32 v16, v16, v17
v_mfma_f32_16x16x32_bf16 v[28:31], v[188:191], a[236:239], v[28:31]
s_nop 0
ds_read_b64_tr_b16 v[224:225], v8 offset:40960
ds_read_b64_tr_b16 v[226:227], v8 offset:43008
v_cvt_pk_bf16_f32 v17, v18, v19
v_mfma_f32_16x16x32_bf16 v[28:31], v[172:175], a[232:235], v[28:31]
s_add_u32 s72, s71, 15360
buffer_load_dwordx4 v15, s[24:27], s72 offen offset:1024 lds
v_cvt_pk_bf16_f32 v18, v20, v21
v_mfma_f32_16x16x32_bf16 v[28:31], v[156:159], a[228:231], v[28:31]
s_nop 0
ds_read_b64_tr_b16 v[228:229], v9 offset:40960
ds_read_b64_tr_b16 v[230:231], v9 offset:43008
v_cvt_pk_bf16_f32 v19, v22, v23
v_mfma_f32_16x16x32_bf16 v[28:31], v[140:143], a[224:227], v[28:31]
v_mfma_f32_16x16x32_bf16 v[32:35], v[128:131], a[240:243], v[32:35]
s_xor_b32 s80, s93, 0x80000
ds_read_b64_tr_b16 v[232:233], v10 offset:40960
ds_read_b64_tr_b16 v[234:235], v10 offset:43008
v_mfma_f32_16x16x32_bf16 v[32:35], v[144:147], a[244:247], v[32:35]
s_add_u32 s80, s80, 0x3a00000
buffer_store_dwordx4 v[16:19], v1, s[44:47], s80 offen sc1
v_mfma_f32_16x16x32_bf16 v[32:35], v[160:163], a[248:251], v[32:35]
s_nop 0
ds_read_b64_tr_b16 v[236:237], v11 offset:40960
ds_read_b64_tr_b16 v[238:239], v11 offset:43008
v_mfma_f32_16x16x32_bf16 v[32:35], v[176:179], a[252:255], v[32:35]
s_add_u32 s72, s71, 30720
buffer_load_dwordx4 v15, s[24:27], s72 offen offset:2048 lds
v_cvt_pk_bf16_f32 v20, v24, v25
v_mfma_f32_16x16x32_bf16 v[36:39], v[180:183], a[252:255], v[36:39]
s_nop 0
ds_read_b64_tr_b16 v[240:241], v8 offset:45056
ds_read_b64_tr_b16 v[242:243], v8 offset:47104
v_cvt_pk_bf16_f32 v21, v26, v27
v_mfma_f32_16x16x32_bf16 v[36:39], v[164:167], a[248:251], v[36:39]
v_cvt_pk_bf16_f32 v22, v28, v29
v_cvt_pk_bf16_f32 v23, v30, v31
v_mfma_f32_16x16x32_bf16 v[36:39], v[148:151], a[244:247], v[36:39]
s_nop 0
ds_read_b64_tr_b16 v[244:245], v9 offset:45056
ds_read_b64_tr_b16 v[246:247], v9 offset:47104
v_mfma_f32_16x16x32_bf16 v[36:39], v[132:135], a[240:243], v[36:39]
s_nop 0
ds_read_b64_tr_b16 v[248:249], v10 offset:45056
ds_read_b64_tr_b16 v[250:251], v10 offset:47104
v_mfma_f32_16x16x32_bf16 v[40:43], v[136:139], a[240:243], v[40:43]
s_nop 0
ds_read_b64_tr_b16 v[252:253], v11 offset:45056
ds_read_b64_tr_b16 v[254:255], v11 offset:47104
v_mfma_f32_16x16x32_bf16 v[40:43], v[152:155], a[244:247], v[40:43]
s_add_u32 s72, s71, 46080
buffer_load_dwordx4 v15, s[24:27], s72 offen offset:3072 lds
v_mfma_f32_16x16x32_bf16 v[40:43], v[168:171], a[248:251], v[40:43]
v_mfma_f32_16x16x32_bf16 v[40:43], v[184:187], a[252:255], v[40:43]
v_cvt_pk_bf16_f32 v24, v32, v33
v_cvt_pk_bf16_f32 v25, v34, v35
v_cvt_pk_bf16_f32 v26, v36, v37
v_mfma_f32_16x16x32_bf16 v[44:47], v[188:191], a[252:255], v[44:47]
v_cvt_pk_bf16_f32 v27, v38, v39
v_mfma_f32_16x16x32_bf16 v[44:47], v[172:175], a[248:251], v[44:47]
v_mfma_f32_16x16x32_bf16 v[44:47], v[156:159], a[244:247], v[44:47]
s_waitcnt vmcnt(33) lgkmcnt(0)
v_mfma_f32_16x16x32_bf16 v[44:47], v[140:143], a[240:243], v[44:47]
s_barrier
v_mfma_f32_16x16x32_bf16 v[48:51], v[192:195], a[160:163], v[48:51]
s_nop 0
ds_read_b64_tr_b16 v[128:129], v8 offset:49152
ds_read_b64_tr_b16 v[130:131], v8 offset:51200
v_mfma_f32_16x16x32_bf16 v[48:51], v[208:211], a[164:167], v[48:51]
s_xor_b32 s71, s13, 0x0
buffer_store_dwordx4 v[20:23], v1, s[44:47], s80 offen offset:1024 sc1
v_mfma_f32_16x16x32_bf16 v[48:51], v[224:227], a[168:171], v[48:51]
s_add_u32 m0, s77, 16384
ds_read_b64_tr_b16 v[132:133], v9 offset:49152
ds_read_b64_tr_b16 v[134:135], v9 offset:51200
v_mfma_f32_16x16x32_bf16 v[48:51], v[240:243], a[172:175], v[48:51]
s_add_u32 s72, s71, 0
buffer_load_dwordx4 v15, s[24:27], s72 offen lds
v_cvt_pk_bf16_f32 v28, v40, v41
v_mfma_f32_16x16x32_bf16 v[64:67], v[240:243], a[188:191], v[64:67]
s_nop 0
ds_read_b64_tr_b16 v[136:137], v10 offset:49152
ds_read_b64_tr_b16 v[138:139], v10 offset:51200
v_cvt_pk_bf16_f32 v29, v42, v43
v_mfma_f32_16x16x32_bf16 v[64:67], v[224:227], a[184:187], v[64:67]
s_nop 0
ds_read_b64_tr_b16 v[140:141], v11 offset:49152
ds_read_b64_tr_b16 v[142:143], v11 offset:51200
v_cvt_pk_bf16_f32 v30, v44, v45
v_mfma_f32_16x16x32_bf16 v[64:67], v[208:211], a[180:183], v[64:67]
v_cvt_pk_bf16_f32 v31, v46, v47
v_mfma_f32_16x16x32_bf16 v[64:67], v[192:195], a[176:179], v[64:67]
s_nop 0
ds_read_b64_tr_b16 v[144:145], v8 offset:53248
ds_read_b64_tr_b16 v[146:147], v8 offset:55296
v_mfma_f32_16x16x32_bf16 v[68:71], v[196:199], a[176:179], v[68:71]
s_add_u32 s72, s71, 15360
buffer_load_dwordx4 v15, s[24:27], s72 offen offset:1024 lds
v_mfma_f32_16x16x32_bf16 v[68:71], v[212:215], a[180:183], v[68:71]
s_nop 0
ds_read_b64_tr_b16 v[148:149], v9 offset:53248
ds_read_b64_tr_b16 v[150:151], v9 offset:55296
v_mfma_f32_16x16x32_bf16 v[68:71], v[228:231], a[184:187], v[68:71]
s_nop 0
ds_read_b64_tr_b16 v[152:153], v10 offset:53248
ds_read_b64_tr_b16 v[154:155], v10 offset:55296
v_mfma_f32_16x16x32_bf16 v[68:71], v[244:247], a[188:191], v[68:71]
v_mfma_f32_16x16x32_bf16 v[52:55], v[244:247], a[172:175], v[52:55]
s_nop 0
ds_read_b64_tr_b16 v[156:157], v11 offset:53248
ds_read_b64_tr_b16 v[158:159], v11 offset:55296
v_mfma_f32_16x16x32_bf16 v[52:55], v[228:231], a[168:171], v[52:55]
s_nop 0
ds_read_b64_tr_b16 v[160:161], v8 offset:57344
ds_read_b64_tr_b16 v[162:163], v8 offset:59392
v_mfma_f32_16x16x32_bf16 v[52:55], v[212:215], a[164:167], v[52:55]
s_add_u32 s72, s71, 30720
buffer_load_dwordx4 v15, s[24:27], s72 offen offset:2048 lds
v_mfma_f32_16x16x32_bf16 v[52:55], v[196:199], a[160:163], v[52:55]
s_nop 0
ds_read_b64_tr_b16 v[164:165], v9 offset:57344
ds_read_b64_tr_b16 v[166:167], v9 offset:59392
v_mfma_f32_16x16x32_bf16 v[56:59], v[200:203], a[160:163], v[56:59]
v_mfma_f32_16x16x32_bf16 v[56:59], v[216:219], a[164:167], v[56:59]
buffer_store_dwordx4 v[24:27], v1, s[44:47], s80 offen offset:2048 sc1
v_mfma_f32_16x16x32_bf16 v[56:59], v[232:235], a[168:171], v[56:59]
s_nop 0
ds_read_b64_tr_b16 v[168:169], v10 offset:57344
ds_read_b64_tr_b16 v[170:171], v10 offset:59392
v_mfma_f32_16x16x32_bf16 v[56:59], v[248:251], a[172:175], v[56:59]
s_nop 0
ds_read_b64_tr_b16 v[172:173], v11 offset:57344
ds_read_b64_tr_b16 v[174:175], v11 offset:59392
v_mfma_f32_16x16x32_bf16 v[72:75], v[248:251], a[188:191], v[72:75]
s_add_u32 s72, s71, 46080
buffer_load_dwordx4 v15, s[24:27], s72 offen offset:3072 lds
v_mfma_f32_16x16x32_bf16 v[72:75], v[232:235], a[184:187], v[72:75]
s_nop 0
ds_read_b64_tr_b16 v[176:177], v8 offset:61440
ds_read_b64_tr_b16 v[178:179], v8 offset:63488
v_mfma_f32_16x16x32_bf16 v[72:75], v[216:219], a[180:183], v[72:75]
v_mfma_f32_16x16x32_bf16 v[72:75], v[200:203], a[176:179], v[72:75]
s_nop 0
ds_read_b64_tr_b16 v[180:181], v9 offset:61440
ds_read_b64_tr_b16 v[182:183], v9 offset:63488
v_mfma_f32_16x16x32_bf16 v[76:79], v[204:207], a[176:179], v[76:79]
s_nop 0
ds_read_b64_tr_b16 v[184:185], v10 offset:61440
ds_read_b64_tr_b16 v[186:187], v10 offset:63488
v_mfma_f32_16x16x32_bf16 v[76:79], v[220:223], a[180:183], v[76:79]
s_nop 0
ds_read_b64_tr_b16 v[188:189], v11 offset:61440
ds_read_b64_tr_b16 v[190:191], v11 offset:63488
v_mfma_f32_16x16x32_bf16 v[76:79], v[236:239], a[184:187], v[76:79]
v_mfma_f32_16x16x32_bf16 v[76:79], v[252:255], a[188:191], v[76:79]
s_xor_b32 s71, s14, 0x0
v_mfma_f32_16x16x32_bf16 v[60:63], v[252:255], a[172:175], v[60:63]
s_add_u32 m0, s77, 32768
v_xor_b32 v8, 0x10000, v8
v_mfma_f32_16x16x32_bf16 v[60:63], v[236:239], a[168:171], v[60:63]
s_add_u32 s72, s71, 0
v_xor_b32 v9, 0x10000, v9
v_mfma_f32_16x16x32_bf16 v[60:63], v[220:223], a[164:167], v[60:63]
s_waitcnt vmcnt(32) lgkmcnt(0)
buffer_load_dwordx4 v15, s[24:27], s72 offen lds
v_xor_b32 v10, 0x10000, v10
v_mfma_f32_16x16x32_bf16 v[60:63], v[204:207], a[160:163], v[60:63]
s_barrier
v_xor_b32 v11, 0x10000, v11
v_mfma_f32_16x16x32_bf16 v[48:51], v[128:131], a[192:195], v[48:51]
s_nop 0
ds_read_b64_tr_b16 v[192:193], v8 offset:0
ds_read_b64_tr_b16 v[194:195], v8 offset:2048
v_mfma_f32_16x16x32_bf16 v[48:51], v[144:147], a[196:199], v[48:51]
buffer_store_dwordx4 v[28:31], v1, s[44:47], s80 offen offset:3072 sc1
v_mfma_f32_16x16x32_bf16 v[48:51], v[160:163], a[200:203], v[48:51]
s_nop 0
ds_read_b64_tr_b16 v[196:197], v9 offset:0
ds_read_b64_tr_b16 v[198:199], v9 offset:2048
v_mfma_f32_16x16x32_bf16 v[48:51], v[176:179], a[204:207], v[48:51]
s_add_u32 s72, s71, 15360
buffer_load_dwordx4 v15, s[24:27], s72 offen offset:1024 lds
v_mfma_f32_16x16x32_bf16 v[64:67], v[176:179], a[220:223], v[64:67]
s_nop 0
ds_read_b64_tr_b16 v[200:201], v10 offset:0
ds_read_b64_tr_b16 v[202:203], v10 offset:2048
v_mfma_f32_16x16x32_bf16 v[64:67], v[160:163], a[216:219], v[64:67]
v_mfma_f32_16x16x32_bf16 v[64:67], v[144:147], a[212:215], v[64:67]
s_nop 0
ds_read_b64_tr_b16 v[204:205], v11 offset:0
ds_read_b64_tr_b16 v[206:207], v11 offset:2048
v_mfma_f32_16x16x32_bf16 v[64:67], v[128:131], a[208:211], v[64:67]
s_nop 0
ds_read_b64_tr_b16 v[208:209], v8 offset:4096
ds_read_b64_tr_b16 v[210:211], v8 offset:6144
v_mfma_f32_16x16x32_bf16 v[68:71], v[132:135], a[208:211], v[68:71]
s_nop 0
ds_read_b64_tr_b16 v[212:213], v9 offset:4096
ds_read_b64_tr_b16 v[214:215], v9 offset:6144
v_mfma_f32_16x16x32_bf16 v[68:71], v[148:151], a[212:215], v[68:71]
s_add_u32 s72, s71, 30720
buffer_load_dwordx4 v15, s[24:27], s72 offen offset:2048 lds
v_mfma_f32_16x16x32_bf16 v[68:71], v[164:167], a[216:219], v[68:71]
v_mfma_f32_16x16x32_bf16 v[68:71], v[180:183], a[220:223], v[68:71]
s_nop 0
ds_read_b64_tr_b16 v[216:217], v10 offset:4096
ds_read_b64_tr_b16 v[218:219], v10 offset:6144
v_mfma_f32_16x16x32_bf16 v[52:55], v[180:183], a[204:207], v[52:55]
s_nop 0
ds_read_b64_tr_b16 v[220:221], v11 offset:4096
ds_read_b64_tr_b16 v[222:223], v11 offset:6144
v_mfma_f32_16x16x32_bf16 v[52:55], v[164:167], a[200:203], v[52:55]
v_mfma_f32_16x16x32_bf16 v[52:55], v[148:151], a[196:199], v[52:55]
s_nop 0
ds_read_b64_tr_b16 v[224:225], v8 offset:8192
ds_read_b64_tr_b16 v[226:227], v8 offset:10240
v_mfma_f32_16x16x32_bf16 v[52:55], v[132:135], a[192:195], v[52:55]
s_add_u32 s72, s71, 46080
buffer_load_dwordx4 v15, s[24:27], s72 offen offset:3072 lds
v_mfma_f32_16x16x32_bf16 v[56:59], v[136:139], a[192:195], v[56:59]
s_nop 0
ds_read_b64_tr_b16 v[228:229], v9 offset:8192
ds_read_b64_tr_b16 v[230:231], v9 offset:10240
v_mfma_f32_16x16x32_bf16 v[56:59], v[152:155], a[196:199], v[56:59]
s_nop 0
ds_read_b64_tr_b16 v[232:233], v10 offset:8192
ds_read_b64_tr_b16 v[234:235], v10 offset:10240
v_mfma_f32_16x16x32_bf16 v[56:59], v[168:171], a[200:203], v[56:59]
v_mfma_f32_16x16x32_bf16 v[56:59], v[184:187], a[204:207], v[56:59]
s_nop 0
ds_read_b64_tr_b16 v[236:237], v11 offset:8192
ds_read_b64_tr_b16 v[238:239], v11 offset:10240
v_mfma_f32_16x16x32_bf16 v[72:75], v[184:187], a[220:223], v[72:75]
s_nop 0
ds_read_b64_tr_b16 v[240:241], v8 offset:12288
ds_read_b64_tr_b16 v[242:243], v8 offset:14336
v_mfma_f32_16x16x32_bf16 v[72:75], v[168:171], a[216:219], v[72:75]
s_nop 0
ds_read_b64_tr_b16 v[244:245], v9 offset:12288
ds_read_b64_tr_b16 v[246:247], v9 offset:14336
v_mfma_f32_16x16x32_bf16 v[72:75], v[152:155], a[212:215], v[72:75]
v_mfma_f32_16x16x32_bf16 v[72:75], v[136:139], a[208:211], v[72:75]
s_xor_b32 s71, s15, 0x0
ds_read_b64_tr_b16 v[248:249], v10 offset:12288
ds_read_b64_tr_b16 v[250:251], v10 offset:14336
v_mfma_f32_16x16x32_bf16 v[76:79], v[140:143], a[208:211], v[76:79]
s_add_u32 m0, s77, 49152
ds_read_b64_tr_b16 v[252:253], v11 offset:12288
ds_read_b64_tr_b16 v[254:255], v11 offset:14336
v_mfma_f32_16x16x32_bf16 v[76:79], v[156:159], a[212:215], v[76:79]
s_add_u32 s72, s71, 0
buffer_load_dwordx4 v15, s[24:27], s72 offen lds
v_mfma_f32_16x16x32_bf16 v[76:79], v[172:175], a[216:219], v[76:79]
v_mfma_f32_16x16x32_bf16 v[76:79], v[188:191], a[220:223], v[76:79]
v_mfma_f32_16x16x32_bf16 v[60:63], v[188:191], a[204:207], v[60:63]
v_mfma_f32_16x16x32_bf16 v[60:63], v[172:175], a[200:203], v[60:63]
s_add_u32 s72, s71, 15360
v_mfma_f32_16x16x32_bf16 v[60:63], v[156:159], a[196:199], v[60:63]
s_waitcnt vmcnt(31) lgkmcnt(0)
v_mfma_f32_16x16x32_bf16 v[60:63], v[140:143], a[192:195], v[60:63]
s_barrier
buffer_load_dwordx4 v15, s[24:27], s72 offen offset:1024 lds
v_mfma_f32_16x16x32_bf16 v[48:51], v[192:195], a[224:227], v[48:51]
s_nop 0
ds_read_b64_tr_b16 v[128:129], v8 offset:16384
ds_read_b64_tr_b16 v[130:131], v8 offset:18432
v_mfma_f32_16x16x32_bf16 v[48:51], v[208:211], a[228:231], v[48:51]
s_nop 0
ds_read_b64_tr_b16 v[132:133], v9 offset:16384
ds_read_b64_tr_b16 v[134:135], v9 offset:18432
v_mfma_f32_16x16x32_bf16 v[48:51], v[224:227], a[232:235], v[48:51]
s_nop 0
ds_read_b64_tr_b16 v[136:137], v10 offset:16384
ds_read_b64_tr_b16 v[138:139], v10 offset:18432
v_mfma_f32_16x16x32_bf16 v[48:51], v[240:243], a[236:239], v[48:51]
v_mfma_f32_16x16x32_bf16 v[52:55], v[244:247], a[236:239], v[52:55]
s_nop 0
ds_read_b64_tr_b16 v[140:141], v11 offset:16384
ds_read_b64_tr_b16 v[142:143], v11 offset:18432
v_mfma_f32_16x16x32_bf16 v[52:55], v[228:231], a[232:235], v[52:55]
s_add_u32 s72, s71, 30720
buffer_load_dwordx4 v15, s[24:27], s72 offen offset:2048 lds
v_mfma_f32_16x16x32_bf16 v[52:55], v[212:215], a[228:231], v[52:55]
s_nop 0
ds_read_b64_tr_b16 v[144:145], v8 offset:20480
ds_read_b64_tr_b16 v[146:147], v8 offset:22528
v_mfma_f32_16x16x32_bf16 v[52:55], v[196:199], a[224:227], v[52:55]
s_nop 0
ds_read_b64_tr_b16 v[148:149], v9 offset:20480
ds_read_b64_tr_b16 v[150:151], v9 offset:22528
v_mfma_f32_16x16x32_bf16 v[56:59], v[200:203], a[224:227], v[56:59]
v_mfma_f32_16x16x32_bf16 v[56:59], v[216:219], a[228:231], v[56:59]
s_nop 0
ds_read_b64_tr_b16 v[152:153], v10 offset:20480
ds_read_b64_tr_b16 v[154:155], v10 offset:22528
v_mfma_f32_16x16x32_bf16 v[56:59], v[232:235], a[232:235], v[56:59]
s_nop 0
ds_read_b64_tr_b16 v[156:157], v11 offset:20480
ds_read_b64_tr_b16 v[158:159], v11 offset:22528
v_mfma_f32_16x16x32_bf16 v[56:59], v[248:251], a[236:239], v[56:59]
s_add_u32 s72, s71, 46080
buffer_load_dwordx4 v15, s[24:27], s72 offen offset:3072 lds
v_cvt_pk_bf16_f32 v48, v48, v49
v_mfma_f32_16x16x32_bf16 v[60:63], v[252:255], a[236:239], v[60:63]
v_cvt_pk_bf16_f32 v49, v50, v51
v_cvt_pk_bf16_f32 v50, v52, v53
v_cvt_pk_bf16_f32 v51, v54, v55
v_mfma_f32_16x16x32_bf16 v[60:63], v[236:239], a[232:235], v[60:63]
s_nop 0
ds_read_b64_tr_b16 v[160:161], v8 offset:24576
ds_read_b64_tr_b16 v[162:163], v8 offset:26624
v_mfma_f32_16x16x32_bf16 v[60:63], v[220:223], a[228:231], v[60:63]
s_nop 0
ds_read_b64_tr_b16 v[164:165], v9 offset:24576
ds_read_b64_tr_b16 v[166:167], v9 offset:26624
v_mfma_f32_16x16x32_bf16 v[60:63], v[204:207], a[224:227], v[60:63]
s_nop 0
ds_read_b64_tr_b16 v[168:169], v10 offset:24576
ds_read_b64_tr_b16 v[170:171], v10 offset:26624
Lstube3:
s_cbranch_execz Lrete
v_mfma_f32_16x16x32_bf16 v[64:67], v[192:195], a[240:243], v[64:67]
s_xor_b32 s80, s93, 0x100000
v_mfma_f32_16x16x32_bf16 v[64:67], v[208:211], a[244:247], v[64:67]
s_add_u32 s80, s80, 0x3e00000
buffer_store_dwordx4 v[48:51], v1, s[44:47], s80 offen sc1
v_mfma_f32_16x16x32_bf16 v[64:67], v[224:227], a[248:251], v[64:67]
s_nop 0
ds_read_b64_tr_b16 v[172:173], v11 offset:24576
ds_read_b64_tr_b16 v[174:175], v11 offset:26624
v_mfma_f32_16x16x32_bf16 v[64:67], v[240:243], a[252:255], v[64:67]
s_xor_b32 s71, s12, 0x400000
ds_read_b64_tr_b16 v[176:177], v8 offset:28672
ds_read_b64_tr_b16 v[178:179], v8 offset:30720
v_cvt_pk_bf16_f32 v52, v56, v57
v_mfma_f32_16x16x32_bf16 v[68:71], v[244:247], a[252:255], v[68:71]
s_add_u32 m0, s85, 0
ds_read_b64_tr_b16 v[180:181], v9 offset:28672
ds_read_b64_tr_b16 v[182:183], v9 offset:30720
v_cvt_pk_bf16_f32 v53, v58, v59
v_mfma_f32_16x16x32_bf16 v[68:71], v[228:231], a[248:251], v[68:71]
s_add_u32 s72, s71, 0
buffer_load_dwordx4 v15, s[24:27], s72 offen lds
v_cvt_pk_bf16_f32 v54, v60, v61
v_mfma_f32_16x16x32_bf16 v[68:71], v[212:215], a[244:247], v[68:71]
v_cvt_pk_bf16_f32 v55, v62, v63
v_mfma_f32_16x16x32_bf16 v[68:71], v[196:199], a[240:243], v[68:71]
s_nop 0
ds_read_b64_tr_b16 v[184:185], v10 offset:28672
ds_read_b64_tr_b16 v[186:187], v10 offset:30720
v_mfma_f32_16x16x32_bf16 v[72:75], v[200:203], a[240:243], v[72:75]
s_nop 0
ds_read_b64_tr_b16 v[188:189], v11 offset:28672
ds_read_b64_tr_b16 v[190:191], v11 offset:30720
v_mfma_f32_16x16x32_bf16 v[72:75], v[216:219], a[244:247], v[72:75]
v_mfma_f32_16x16x32_bf16 v[72:75], v[232:235], a[248:251], v[72:75]
s_add_u32 s72, s71, 15360
buffer_load_dwordx4 v15, s[24:27], s72 offen offset:1024 lds
v_mfma_f32_16x16x32_bf16 v[72:75], v[248:251], a[252:255], v[72:75]
v_cvt_pk_bf16_f32 v56, v64, v65
v_cvt_pk_bf16_f32 v57, v66, v67
v_cvt_pk_bf16_f32 v58, v68, v69
v_mfma_f32_16x16x32_bf16 v[76:79], v[252:255], a[252:255], v[76:79]
v_cvt_pk_bf16_f32 v59, v70, v71
v_mfma_f32_16x16x32_bf16 v[76:79], v[236:239], a[248:251], v[76:79]
v_mfma_f32_16x16x32_bf16 v[76:79], v[220:223], a[244:247], v[76:79]
s_waitcnt vmcnt(29) lgkmcnt(0)
v_mfma_f32_16x16x32_bf16 v[76:79], v[204:207], a[240:243], v[76:79]
s_barrier
v_mfma_f32_16x16x32_bf16 v[80:83], v[128:131], a[160:163], v[80:83]
s_add_u32 s72, s71, 30720
buffer_load_dwordx4 v15, s[24:27], s72 offen offset:2048 lds
v_mfma_f32_16x16x32_bf16 v[80:83], v[144:147], a[164:167], v[80:83]
s_waitcnt vmcnt(23)
buffer_store_dwordx4 v[52:55], v1, s[44:47], s80 offen offset:1024 sc1
v_mfma_f32_16x16x32_bf16 v[80:83], v[160:163], a[168:171], v[80:83]
s_nop 0
ds_read_b64_tr_b16 v[192:193], v8 offset:32768
ds_read_b64_tr_b16 v[194:195], v8 offset:34816
v_mfma_f32_16x16x32_bf16 v[80:83], v[176:179], a[172:175], v[80:83]
s_nop 0
ds_read_b64_tr_b16 v[196:197], v9 offset:32768
ds_read_b64_tr_b16 v[198:199], v9 offset:34816
v_cvt_pk_bf16_f32 v60, v72, v73
v_mfma_f32_16x16x32_bf16 v[96:99], v[176:179], a[188:191], v[96:99]
s_nop 0
ds_read_b64_tr_b16 v[200:201], v10 offset:32768
ds_read_b64_tr_b16 v[202:203], v10 offset:34816
v_cvt_pk_bf16_f32 v61, v74, v75
v_mfma_f32_16x16x32_bf16 v[96:99], v[160:163], a[184:187], v[96:99]
s_nop 0
ds_read_b64_tr_b16 v[204:205], v11 offset:32768
ds_read_b64_tr_b16 v[206:207], v11 offset:34816
v_cvt_pk_bf16_f32 v62, v76, v77
v_mfma_f32_16x16x32_bf16 v[96:99], v[144:147], a[180:183], v[96:99]
s_add_u32 s72, s71, 46080
buffer_load_dwordx4 v15, s[24:27], s72 offen offset:3072 lds
v_cvt_pk_bf16_f32 v63, v78, v79
v_mfma_f32_16x16x32_bf16 v[96:99], v[128:131], a[176:179], v[96:99]
v_sub_f32 v112, 1.0, v6
v_sub_f32 v113, 1.0, v7
v_mfma_f32_16x16x32_bf16 v[100:103], v[132:135], a[176:179], v[100:103]
s_nop 0
ds_read_b64_tr_b16 v[208:209], v8 offset:36864
ds_read_b64_tr_b16 v[210:211], v8 offset:38912
v_mfma_f32_16x16x32_bf16 v[100:103], v[148:151], a[180:183], v[100:103]
s_nop 0
ds_read_b64_tr_b16 v[212:213], v9 offset:36864
ds_read_b64_tr_b16 v[214:215], v9 offset:38912
v_mfma_f32_16x16x32_bf16 v[100:103], v[164:167], a[184:187], v[100:103]
s_nop 0
ds_read_b64_tr_b16 v[216:217], v10 offset:36864
ds_read_b64_tr_b16 v[218:219], v10 offset:38912
v_mfma_f32_16x16x32_bf16 v[100:103], v[180:183], a[188:191], v[100:103]
v_mfma_f32_16x16x32_bf16 v[84:87], v[180:183], a[172:175], v[84:87]
s_nop 0
ds_read_b64_tr_b16 v[220:221], v11 offset:36864
ds_read_b64_tr_b16 v[222:223], v11 offset:38912
v_mfma_f32_16x16x32_bf16 v[84:87], v[164:167], a[168:171], v[84:87]
s_nop 0
ds_read_b64_tr_b16 v[224:225], v8 offset:40960
ds_read_b64_tr_b16 v[226:227], v8 offset:43008
v_mfma_f32_16x16x32_bf16 v[84:87], v[148:151], a[164:167], v[84:87]
s_xor_b32 s71, s13, 0x400000
ds_read_b64_tr_b16 v[228:229], v9 offset:40960
ds_read_b64_tr_b16 v[230:231], v9 offset:43008
v_mfma_f32_16x16x32_bf16 v[84:87], v[132:135], a[160:163], v[84:87]
s_add_u32 m0, s85, 16384
v_mfma_f32_16x16x32_bf16 v[88:91], v[136:139], a[160:163], v[88:91]
s_add_u32 s72, s71, 0
buffer_load_dwordx4 v15, s[24:27], s72 offen lds
v_mfma_f32_16x16x32_bf16 v[88:91], v[152:155], a[164:167], v[88:91]
buffer_store_dwordx4 v[56:59], v1, s[44:47], s80 offen offset:2048 sc1
v_mfma_f32_16x16x32_bf16 v[88:91], v[168:171], a[168:171], v[88:91]
s_nop 0
ds_read_b64_tr_b16 v[232:233], v10 offset:40960
ds_read_b64_tr_b16 v[234:235], v10 offset:43008
v_mfma_f32_16x16x32_bf16 v[88:91], v[184:187], a[172:175], v[88:91]
s_nop 0
ds_read_b64_tr_b16 v[236:237], v11 offset:40960
ds_read_b64_tr_b16 v[238:239], v11 offset:43008
v_mfma_f32_16x16x32_bf16 v[104:107], v[184:187], a[188:191], v[104:107]
s_nop 0
ds_read_b64_tr_b16 v[240:241], v8 offset:45056
ds_read_b64_tr_b16 v[242:243], v8 offset:47104
v_mfma_f32_16x16x32_bf16 v[104:107], v[168:171], a[184:187], v[104:107]
v_mfma_f32_16x16x32_bf16 v[104:107], v[152:155], a[180:183], v[104:107]
s_add_u32 s72, s71, 15360
buffer_load_dwordx4 v15, s[24:27], s72 offen offset:1024 lds
v_mfma_f32_16x16x32_bf16 v[104:107], v[136:139], a[176:179], v[104:107]
s_nop 0
ds_read_b64_tr_b16 v[244:245], v9 offset:45056
ds_read_b64_tr_b16 v[246:247], v9 offset:47104
v_mfma_f32_16x16x32_bf16 v[108:111], v[140:143], a[176:179], v[108:111]
s_nop 0
ds_read_b64_tr_b16 v[248:249], v10 offset:45056
ds_read_b64_tr_b16 v[250:251], v10 offset:47104
v_mfma_f32_16x16x32_bf16 v[108:111], v[156:159], a[180:183], v[108:111]
s_nop 0
ds_read_b64_tr_b16 v[252:253], v11 offset:45056
ds_read_b64_tr_b16 v[254:255], v11 offset:47104
v_mfma_f32_16x16x32_bf16 v[108:111], v[172:175], a[184:187], v[108:111]
v_mfma_f32_16x16x32_bf16 v[108:111], v[188:191], a[188:191], v[108:111]
v_mfma_f32_16x16x32_bf16 v[92:95], v[188:191], a[172:175], v[92:95]
s_add_u32 s72, s71, 30720
buffer_load_dwordx4 v15, s[24:27], s72 offen offset:2048 lds
v_mfma_f32_16x16x32_bf16 v[92:95], v[172:175], a[168:171], v[92:95]
v_mfma_f32_16x16x32_bf16 v[92:95], v[156:159], a[164:167], v[92:95]
s_waitcnt vmcnt(32) lgkmcnt(0)
v_mfma_f32_16x16x32_bf16 v[92:95], v[140:143], a[160:163], v[92:95]
s_barrier
v_mfma_f32_16x16x32_bf16 v[80:83], v[192:195], a[192:195], v[80:83]
s_nop 0
ds_read_b64_tr_b16 v[128:129], v8 offset:49152
ds_read_b64_tr_b16 v[130:131], v8 offset:51200
v_mfma_f32_16x16x32_bf16 v[80:83], v[208:211], a[196:199], v[80:83]
buffer_store_dwordx4 v[60:63], v1, s[44:47], s80 offen offset:3072 sc1
v_mfma_f32_16x16x32_bf16 v[80:83], v[224:227], a[200:203], v[80:83]
s_add_u32 s72, s71, 46080
buffer_load_dwordx4 v15, s[24:27], s72 offen offset:3072 lds
v_mfma_f32_16x16x32_bf16 v[80:83], v[240:243], a[204:207], v[80:83]
s_nop 0
ds_read_b64_tr_b16 v[132:133], v9 offset:49152
ds_read_b64_tr_b16 v[134:135], v9 offset:51200
v_mfma_f32_16x16x32_bf16 v[96:99], v[240:243], a[220:223], v[96:99]
s_nop 0
ds_read_b64_tr_b16 v[136:137], v10 offset:49152
ds_read_b64_tr_b16 v[138:139], v10 offset:51200
v_mfma_f32_16x16x32_bf16 v[96:99], v[224:227], a[216:219], v[96:99]
s_nop 0
ds_read_b64 v[48:49], v116 offset:0
ds_read_b64_tr_b16 v[64:65], v5 offset:0
v_mfma_f32_16x16x32_bf16 v[96:99], v[208:211], a[212:215], v[96:99]
s_nop 0
ds_read_b64_tr_b16 v[140:141], v11 offset:49152
ds_read_b64_tr_b16 v[142:143], v11 offset:51200
v_mfma_f32_16x16x32_bf16 v[96:99], v[192:195], a[208:211], v[96:99]
s_nop 0
ds_read_b64_tr_b16 v[144:145], v8 offset:53248
ds_read_b64_tr_b16 v[146:147], v8 offset:55296
v_mfma_f32_16x16x32_bf16 v[100:103], v[196:199], a[208:211], v[100:103]
s_nop 0
ds_read_b64_tr_b16 v[148:149], v9 offset:53248
ds_read_b64_tr_b16 v[150:151], v9 offset:55296
v_mfma_f32_16x16x32_bf16 v[100:103], v[212:215], a[212:215], v[100:103]
s_nop 0
ds_read_b64 v[50:51], v117 offset:0
ds_read_b64_tr_b16 v[66:67], v5 offset:4096
v_mfma_f32_16x16x32_bf16 v[100:103], v[228:231], a[216:219], v[100:103]
s_xor_b32 s71, s14, 0x400000
ds_read_b64_tr_b16 v[152:153], v10 offset:53248
ds_read_b64_tr_b16 v[154:155], v10 offset:55296
v_mfma_f32_16x16x32_bf16 v[100:103], v[244:247], a[220:223], v[100:103]
s_add_u32 m0, s85, 32768
ds_read_b64_tr_b16 v[156:157], v11 offset:53248
ds_read_b64_tr_b16 v[158:159], v11 offset:55296
v_mfma_f32_16x16x32_bf16 v[84:87], v[244:247], a[204:207], v[84:87]
s_add_u32 s72, s71, 0
buffer_load_dwordx4 v15, s[24:27], s72 offen lds
v_mfma_f32_16x16x32_bf16 v[84:87], v[228:231], a[200:203], v[84:87]
s_nop 0
ds_read_b64 v[52:53], v118 offset:0
ds_read_b64_tr_b16 v[68:69], v5 offset:8192
v_mfma_f32_16x16x32_bf16 v[84:87], v[212:215], a[196:199], v[84:87]
s_nop 0
ds_read_b64_tr_b16 v[160:161], v8 offset:57344
ds_read_b64_tr_b16 v[162:163], v8 offset:59392
v_mfma_f32_16x16x32_bf16 v[84:87], v[196:199], a[192:195], v[84:87]
s_nop 0
ds_read_b64_tr_b16 v[164:165], v9 offset:57344
ds_read_b64_tr_b16 v[166:167], v9 offset:59392
v_mfma_f32_16x16x32_bf16 v[88:91], v[200:203], a[192:195], v[88:91]
s_nop 0
ds_read_b64_tr_b16 v[168:169], v10 offset:57344
ds_read_b64_tr_b16 v[170:171], v10 offset:59392
v_mfma_f32_16x16x32_bf16 v[88:91], v[216:219], a[196:199], v[88:91]
s_add_u32 s72, s71, 15360
buffer_load_dwordx4 v15, s[24:27], s72 offen offset:1024 lds
v_mfma_f32_16x16x32_bf16 v[88:91], v[232:235], a[200:203], v[88:91]
s_nop 0
ds_read_b64 v[54:55], v119 offset:0
ds_read_b64_tr_b16 v[70:71], v5 offset:12288
v_mfma_f32_16x16x32_bf16 v[88:91], v[248:251], a[204:207], v[88:91]
s_nop 0
ds_read_b64_tr_b16 v[172:173], v11 offset:57344
ds_read_b64_tr_b16 v[174:175], v11 offset:59392
v_mfma_f32_16x16x32_bf16 v[104:107], v[248:251], a[220:223], v[104:107]
s_nop 0
ds_read_b64_tr_b16 v[176:177], v8 offset:61440
ds_read_b64_tr_b16 v[178:179], v8 offset:63488
v_mfma_f32_16x16x32_bf16 v[104:107], v[232:235], a[216:219], v[104:107]
s_nop 0
ds_read_b64_tr_b16 v[180:181], v9 offset:61440
ds_read_b64_tr_b16 v[182:183], v9 offset:63488
v_mfma_f32_16x16x32_bf16 v[104:107], v[216:219], a[212:215], v[104:107]
v_xor_b32 v5, 16, v5
v_mfma_f32_16x16x32_bf16 v[104:107], v[200:203], a[208:211], v[104:107]
s_add_u32 s72, s71, 30720
buffer_load_dwordx4 v15, s[24:27], s72 offen offset:2048 lds
v_mfma_f32_16x16x32_bf16 v[108:111], v[204:207], a[208:211], v[108:111]
s_nop 0
ds_read_b64_tr_b16 v[184:185], v10 offset:61440
ds_read_b64_tr_b16 v[186:187], v10 offset:63488
v_mfma_f32_16x16x32_bf16 v[108:111], v[220:223], a[212:215], v[108:111]
s_nop 0
ds_read_b64_tr_b16 v[188:189], v11 offset:61440
ds_read_b64_tr_b16 v[190:191], v11 offset:63488
v_mfma_f32_16x16x32_bf16 v[108:111], v[236:239], a[216:219], v[108:111]
s_nop 0
ds_read_b64 v[56:57], v116 offset:2048
ds_read_b64_tr_b16 v[72:73], v5 offset:0
v_mfma_f32_16x16x32_bf16 v[108:111], v[252:255], a[220:223], v[108:111]
s_nop 0
ds_read_b64 v[58:59], v117 offset:2048
ds_read_b64_tr_b16 v[74:75], v5 offset:4096
v_mfma_f32_16x16x32_bf16 v[92:95], v[252:255], a[204:207], v[92:95]
ds_read_b64 v[60:61], v118 offset:2048
v_xor_b32 v8, 0x10000, v8
v_mfma_f32_16x16x32_bf16 v[92:95], v[236:239], a[200:203], v[92:95]
s_add_u32 s72, s71, 46080
buffer_load_dwordx4 v15, s[24:27], s72 offen offset:3072 lds
v_xor_b32 v9, 0x10000, v9
v_mfma_f32_16x16x32_bf16 v[92:95], v[220:223], a[196:199], v[92:95]
s_waitcnt vmcnt(31) lgkmcnt(0)
ds_read_b64_tr_b16 v[76:77], v5 offset:8192
v_xor_b32 v10, 0x10000, v10
v_mfma_f32_16x16x32_bf16 v[92:95], v[204:207], a[192:195], v[92:95]
s_barrier
ds_read_b64 v[62:63], v119 offset:2048
v_xor_b32 v11, 0x10000, v11
v_mfma_f32_16x16x32_bf16 v[80:83], v[128:131], a[224:227], v[80:83]
s_nop 0
ds_read_b64_tr_b16 v[192:193], v8 offset:0
ds_read_b64_tr_b16 v[194:195], v8 offset:2048
v_mfma_f32_16x16x32_bf16 v[80:83], v[144:147], a[228:231], v[80:83]
s_nop 0
ds_read_b64_tr_b16 v[196:197], v9 offset:0
ds_read_b64_tr_b16 v[198:199], v9 offset:2048
v_mfma_f32_16x16x32_bf16 v[80:83], v[160:163], a[232:235], v[80:83]
s_nop 0
ds_read_b64_tr_b16 v[200:201], v10 offset:0
ds_read_b64_tr_b16 v[202:203], v10 offset:2048
v_mfma_f32_16x16x32_bf16 v[80:83], v[176:179], a[236:239], v[80:83]
ds_read_b64_tr_b16 v[78:79], v5 offset:12288
v_mfma_f32_16x16x32_bf16 v[84:87], v[180:183], a[236:239], v[84:87]
s_nop 0
ds_read_b64_tr_b16 v[204:205], v11 offset:0
ds_read_b64_tr_b16 v[206:207], v11 offset:2048
v_mfma_f32_16x16x32_bf16 v[84:87], v[164:167], a[232:235], v[84:87]
s_xor_b32 s71, s15, 0x400000
ds_read_b64_tr_b16 v[208:209], v8 offset:4096
ds_read_b64_tr_b16 v[210:211], v8 offset:6144
v_mfma_f32_16x16x32_bf16 v[84:87], v[148:151], a[228:231], v[84:87]
s_add_u32 m0, s85, 49152
ds_read_b64_tr_b16 v[212:213], v9 offset:4096
ds_read_b64_tr_b16 v[214:215], v9 offset:6144
v_mfma_f32_16x16x32_bf16 v[84:87], v[132:135], a[224:227], v[84:87]
s_add_u32 s72, s71, 0
buffer_load_dwordx4 v15, s[24:27], s72 offen lds
v_mfma_f32_16x16x32_bf16 v[88:91], v[136:139], a[224:227], v[88:91]
v_mfma_f32_16x16x32_bf16 v[88:91], v[152:155], a[228:231], v[88:91]
s_waitcnt lgkmcnt(6)
ds_read_b64_tr_b16 v[216:217], v10 offset:4096
ds_read_b64_tr_b16 v[218:219], v10 offset:6144
v_mfma_f32_16x16x32_bf16 v[88:91], v[168:171], a[232:235], v[88:91]
s_nop 0
ds_read_b64_tr_b16 v[220:221], v11 offset:4096
ds_read_b64_tr_b16 v[222:223], v11 offset:6144
v_mfma_f32_16x16x32_bf16 v[88:91], v[184:187], a[236:239], v[88:91]
v_cvt_pk_bf16_f32 v80, v80, v81
v_cvt_pk_bf16_f32 v81, v82, v83
v_cvt_pk_bf16_f32 v82, v84, v85
v_mfma_f32_16x16x32_bf16 v[92:95], v[188:191], a[236:239], v[92:95]
s_nop 0
ds_read_b64_tr_b16 v[224:225], v8 offset:8192
ds_read_b64_tr_b16 v[226:227], v8 offset:10240
v_cvt_pk_bf16_f32 v83, v86, v87
v_mfma_f32_16x16x32_bf16 v[92:95], v[172:175], a[232:235], v[92:95]
s_add_u32 s72, s71, 15360
buffer_load_dwordx4 v15, s[24:27], s72 offen offset:1024 lds
v_mfma_f32_16x16x32_bf16 v[92:95], v[156:159], a[228:231], v[92:95]
s_nop 0
ds_read_b64_tr_b16 v[228:229], v9 offset:8192
ds_read_b64_tr_b16 v[230:231], v9 offset:10240
v_mfma_f32_16x16x32_bf16 v[92:95], v[140:143], a[224:227], v[92:95]
s_nop 0
ds_read_b64_tr_b16 v[232:233], v10 offset:8192
ds_read_b64_tr_b16 v[234:235], v10 offset:10240
v_mfma_f32_16x16x32_bf16 v[96:99], v[128:131], a[240:243], v[96:99]
s_xor_b32 s80, s93, 0x180000
v_and_b32 v114, 0xffff0000, v48
v_lshlrev_b32 v115, 16, v64
v_mfma_f32_16x16x32_bf16 v[96:99], v[144:147], a[244:247], v[96:99]
s_add_u32 s80, s80, 0x4200000
buffer_store_dwordx4 v[80:83], v1, s[44:47], s80 offen sc1
v_mfma_f32_16x16x32_bf16 v[96:99], v[160:163], a[248:251], v[96:99]
s_nop 0
ds_read_b64_tr_b16 v[236:237], v11 offset:8192
ds_read_b64_tr_b16 v[238:239], v11 offset:10240
v_mfma_f32_16x16x32_bf16 v[96:99], v[176:179], a[252:255], v[96:99]
s_add_u32 s72, s71, 30720
buffer_load_dwordx4 v15, s[24:27], s72 offen offset:2048 lds
v_cvt_pk_bf16_f32 v84, v88, v89
v_mfma_f32_16x16x32_bf16 v[100:103], v[180:183], a[252:255], v[100:103]
s_nop 0
ds_read_b64_tr_b16 v[240:241], v8 offset:12288
ds_read_b64_tr_b16 v[242:243], v8 offset:14336
v_cvt_pk_bf16_f32 v85, v90, v91
v_mfma_f32_16x16x32_bf16 v[100:103], v[164:167], a[248:251], v[100:103]
s_nop 0
ds_read_b64_tr_b16 v[244:245], v9 offset:12288
ds_read_b64_tr_b16 v[246:247], v9 offset:14336
v_cvt_pk_bf16_f32 v86, v92, v93
v_mfma_f32_16x16x32_bf16 v[100:103], v[148:151], a[244:247], v[100:103]
v_cvt_pk_bf16_f32 v87, v94, v95
v_lshlrev_b32 v48, 16, v48
v_mfma_f32_16x16x32_bf16 v[100:103], v[132:135], a[240:243], v[100:103]
s_nop 0
ds_read_b64_tr_b16 v[248:249], v10 offset:12288
ds_read_b64_tr_b16 v[250:251], v10 offset:14336
v_mfma_f32_16x16x32_bf16 v[104:107], v[136:139], a[240:243], v[104:107]
s_nop 0
ds_read_b64_tr_b16 v[252:253], v11 offset:12288
ds_read_b64_tr_b16 v[254:255], v11 offset:14336
v_mfma_f32_16x16x32_bf16 v[104:107], v[152:155], a[244:247], v[104:107]
s_add_u32 s72, s71, 46080
buffer_load_dwordx4 v15, s[24:27], s72 offen offset:3072 lds
v_mfma_f32_16x16x32_bf16 v[104:107], v[168:171], a[248:251], v[104:107]
v_and_b32 v64, 0xffff0000, v64
v_mul_f32 v48, v48, v112
v_mfma_f32_16x16x32_bf16 v[104:107], v[184:187], a[252:255], v[104:107]
v_cvt_pk_bf16_f32 v88, v96, v97
v_cvt_pk_bf16_f32 v89, v98, v99
v_cvt_pk_bf16_f32 v90, v100, v101
v_mfma_f32_16x16x32_bf16 v[108:111], v[188:191], a[252:255], v[108:111]
v_cvt_pk_bf16_f32 v91, v102, v103
v_mul_f32 v114, v114, v112
v_mfma_f32_16x16x32_bf16 v[108:111], v[172:175], a[248:251], v[108:111]
v_mul_f32 v48, v48, v115
v_mul_f32 v64, v64, v114
v_mfma_f32_16x16x32_bf16 v[108:111], v[156:159], a[244:247], v[108:111]
s_waitcnt vmcnt(30) lgkmcnt(0)
v_and_b32 v114, 0xffff0000, v49
v_lshlrev_b32 v115, 16, v65
v_mfma_f32_16x16x32_bf16 v[108:111], v[140:143], a[240:243], v[108:111]
s_barrier
v_lshlrev_b32 v49, 16, v49
v_and_b32 v65, 0xffff0000, v65
v_mfma_f32_16x16x32_bf16 v[16:19], v[192:195], a[0:3], 0
s_nop 0
ds_read_b64_tr_b16 v[128:129], v8 offset:16384
ds_read_b64_tr_b16 v[130:131], v8 offset:18432
v_mfma_f32_16x16x32_bf16 v[16:19], v[208:211], a[4:7], v[16:19]
buffer_store_dwordx4 v[84:87], v1, s[44:47], s80 offen offset:1024 sc1
v_mfma_f32_16x16x32_bf16 v[16:19], v[224:227], a[8:11], v[16:19]
s_nop 0
ds_read_b64_tr_b16 v[132:133], v9 offset:16384
ds_read_b64_tr_b16 v[134:135], v9 offset:18432
v_mfma_f32_16x16x32_bf16 v[16:19], v[240:243], a[12:15], v[16:19]
v_cvt_pk_bf16_f32 v92, v104, v105
v_cvt_pk_bf16_f32 v93, v106, v107
v_cvt_pk_bf16_f32 v94, v108, v109
v_mfma_f32_16x16x32_bf16 v[32:35], v[240:243], a[28:31], 0
s_nop 0
ds_read_b64_tr_b16 v[136:137], v10 offset:16384
ds_read_b64_tr_b16 v[138:139], v10 offset:18432
v_cvt_pk_bf16_f32 v95, v110, v111
v_mfma_f32_16x16x32_bf16 v[32:35], v[224:227], a[24:27], v[32:35]
s_nop 0
ds_read_b64_tr_b16 v[140:141], v11 offset:16384
ds_read_b64_tr_b16 v[142:143], v11 offset:18432
v_mfma_f32_16x16x32_bf16 v[32:35], v[208:211], a[20:23], v[32:35]
v_mul_f32 v49, v49, v112
v_mul_f32 v114, v114, v112
v_mfma_f32_16x16x32_bf16 v[32:35], v[192:195], a[16:19], v[32:35]
s_nop 0
ds_read_b64_tr_b16 v[144:145], v8 offset:20480
ds_read_b64_tr_b16 v[146:147], v8 offset:22528
v_mfma_f32_16x16x32_bf16 v[36:39], v[196:199], a[16:19], 0
s_nop 0
ds_read_b64_tr_b16 v[148:149], v9 offset:20480
ds_read_b64_tr_b16 v[150:151], v9 offset:22528
v_mfma_f32_16x16x32_bf16 v[36:39], v[212:215], a[20:23], v[36:39]
v_mul_f32 v49, v49, v115
v_mul_f32 v65, v65, v114
v_mfma_f32_16x16x32_bf16 v[36:39], v[228:231], a[24:27], v[36:39]
s_nop 0
ds_read_b64_tr_b16 v[152:153], v10 offset:20480
ds_read_b64_tr_b16 v[154:155], v10 offset:22528
v_mfma_f32_16x16x32_bf16 v[36:39], v[244:247], a[28:31], v[36:39]
s_nop 0
ds_read_b64_tr_b16 v[156:157], v11 offset:20480
ds_read_b64_tr_b16 v[158:159], v11 offset:22528
v_mfma_f32_16x16x32_bf16 v[20:23], v[244:247], a[12:15], 0
v_and_b32 v114, 0xffff0000, v50
v_lshlrev_b32 v115, 16, v66
v_mfma_f32_16x16x32_bf16 v[20:23], v[228:231], a[8:11], v[20:23]
s_nop 0
ds_read_b64_tr_b16 v[160:161], v8 offset:24576
ds_read_b64_tr_b16 v[162:163], v8 offset:26624
v_mfma_f32_16x16x32_bf16 v[20:23], v[212:215], a[4:7], v[20:23]
v_lshlrev_b32 v50, 16, v50
v_and_b32 v66, 0xffff0000, v66
v_mfma_f32_16x16x32_bf16 v[20:23], v[196:199], a[0:3], v[20:23]
s_nop 0
ds_read_b64_tr_b16 v[164:165], v9 offset:24576
ds_read_b64_tr_b16 v[166:167], v9 offset:26624
v_mfma_f32_16x16x32_bf16 v[24:27], v[200:203], a[0:3], 0
s_nop 0
ds_read_b64_tr_b16 v[168:169], v10 offset:24576
ds_read_b64_tr_b16 v[170:171], v10 offset:26624
v_mfma_f32_16x16x32_bf16 v[24:27], v[216:219], a[4:7], v[24:27]
buffer_store_dwordx4 v[88:91], v1, s[44:47], s80 offen offset:2048 sc1
v_mfma_f32_16x16x32_bf16 v[24:27], v[232:235], a[8:11], v[24:27]
v_mul_f32 v50, v50, v112
v_mul_f32 v114, v114, v112
v_mfma_f32_16x16x32_bf16 v[24:27], v[248:251], a[12:15], v[24:27]
s_nop 0
ds_read_b64_tr_b16 v[172:173], v11 offset:24576
ds_read_b64_tr_b16 v[174:175], v11 offset:26624
v_mfma_f32_16x16x32_bf16 v[40:43], v[248:251], a[28:31], 0
s_nop 0
ds_read_b64_tr_b16 v[176:177], v8 offset:28672
ds_read_b64_tr_b16 v[178:179], v8 offset:30720
v_mfma_f32_16x16x32_bf16 v[40:43], v[232:235], a[24:27], v[40:43]
v_mul_f32 v50, v50, v115
v_mul_f32 v66, v66, v114
v_mfma_f32_16x16x32_bf16 v[40:43], v[216:219], a[20:23], v[40:43]
s_nop 0
ds_read_b64_tr_b16 v[180:181], v9 offset:28672
ds_read_b64_tr_b16 v[182:183], v9 offset:30720
v_mfma_f32_16x16x32_bf16 v[40:43], v[200:203], a[16:19], v[40:43]
s_nop 0
ds_read_b64_tr_b16 v[184:185], v10 offset:28672
ds_read_b64_tr_b16 v[186:187], v10 offset:30720
v_mfma_f32_16x16x32_bf16 v[44:47], v[204:207], a[16:19], 0
v_and_b32 v114, 0xffff0000, v51
v_lshlrev_b32 v115, 16, v67
v_mfma_f32_16x16x32_bf16 v[44:47], v[220:223], a[20:23], v[44:47]
s_nop 0
ds_read_b64_tr_b16 v[188:189], v11 offset:28672
ds_read_b64_tr_b16 v[190:191], v11 offset:30720
v_mfma_f32_16x16x32_bf16 v[44:47], v[236:239], a[24:27], v[44:47]
v_lshlrev_b32 v51, 16, v51
v_and_b32 v67, 0xffff0000, v67
v_mfma_f32_16x16x32_bf16 v[44:47], v[252:255], a[28:31], v[44:47]
v_mul_f32 v51, v51, v112
v_mul_f32 v114, v114, v112
v_mfma_f32_16x16x32_bf16 v[28:31], v[252:255], a[12:15], 0
v_mul_f32 v51, v51, v115
v_mul_f32 v67, v67, v114
v_mfma_f32_16x16x32_bf16 v[28:31], v[236:239], a[8:11], v[28:31]
v_and_b32 v114, 0xffff0000, v52
v_lshlrev_b32 v115, 16, v68
v_mfma_f32_16x16x32_bf16 v[28:31], v[220:223], a[4:7], v[28:31]
s_waitcnt vmcnt(27) lgkmcnt(0)
v_lshlrev_b32 v52, 16, v52
v_and_b32 v68, 0xffff0000, v68
v_mfma_f32_16x16x32_bf16 v[28:31], v[204:207], a[0:3], v[28:31]
s_barrier
v_mul_f32 v52, v52, v112
v_mul_f32 v114, v114, v112
v_mfma_f32_16x16x32_bf16 v[16:19], v[128:131], a[32:35], v[16:19]
s_nop 0
ds_read_b64_tr_b16 v[192:193], v8 offset:32768
ds_read_b64_tr_b16 v[194:195], v8 offset:34816
v_mfma_f32_16x16x32_bf16 v[16:19], v[144:147], a[36:39], v[16:19]
buffer_store_dwordx4 v[92:95], v1, s[44:47], s80 offen offset:3072 sc1
v_mfma_f32_16x16x32_bf16 v[16:19], v[160:163], a[40:43], v[16:19]
s_nop 0
ds_read_b64_tr_b16 v[196:197], v9 offset:32768
ds_read_b64_tr_b16 v[198:199], v9 offset:34816
v_mfma_f32_16x16x32_bf16 v[16:19], v[176:179], a[44:47], v[16:19]
v_mul_f32 v52, v52, v115
v_mul_f32 v68, v68, v114
v_mfma_f32_16x16x32_bf16 v[32:35], v[176:179], a[60:63], v[32:35]
s_nop 0
ds_read_b64_tr_b16 v[200:201], v10 offset:32768
ds_read_b64_tr_b16 v[202:203], v10 offset:34816
v_mfma_f32_16x16x32_bf16 v[32:35], v[160:163], a[56:59], v[32:35]
s_nop 0
ds_read_b64_tr_b16 v[204:205], v11 offset:32768
ds_read_b64_tr_b16 v[206:207], v11 offset:34816
v_mfma_f32_16x16x32_bf16 v[32:35], v[144:147], a[52:55], v[32:35]
v_and_b32 v114, 0xffff0000, v53
v_lshlrev_b32 v115, 16, v69
v_mfma_f32_16x16x32_bf16 v[32:35], v[128:131], a[48:51], v[32:35]
s_nop 0
ds_read_b64_tr_b16 v[208:209], v8 offset:36864
ds_read_b64_tr_b16 v[210:211], v8 offset:38912
v_mfma_f32_16x16x32_bf16 v[36:39], v[132:135], a[48:51], v[36:39]
v_lshlrev_b32 v53, 16, v53
v_and_b32 v69, 0xffff0000, v69
v_mfma_f32_16x16x32_bf16 v[36:39], v[148:151], a[52:55], v[36:39]
s_nop 0
ds_read_b64_tr_b16 v[212:213], v9 offset:36864
ds_read_b64_tr_b16 v[214:215], v9 offset:38912
v_mfma_f32_16x16x32_bf16 v[36:39], v[164:167], a[56:59], v[36:39]
s_nop 0
ds_read_b64_tr_b16 v[216:217], v10 offset:36864
ds_read_b64_tr_b16 v[218:219], v10 offset:38912
v_mfma_f32_16x16x32_bf16 v[36:39], v[180:183], a[60:63], v[36:39]
v_mul_f32 v53, v53, v112
v_mul_f32 v114, v114, v112
v_mfma_f32_16x16x32_bf16 v[20:23], v[180:183], a[44:47], v[20:23]
s_nop 0
ds_read_b64_tr_b16 v[220:221], v11 offset:36864
ds_read_b64_tr_b16 v[222:223], v11 offset:38912
v_mfma_f32_16x16x32_bf16 v[20:23], v[164:167], a[40:43], v[20:23]
v_mul_f32 v53, v53, v115
v_mul_f32 v69, v69, v114
v_mfma_f32_16x16x32_bf16 v[20:23], v[148:151], a[36:39], v[20:23]
s_nop 0
ds_read_b64_tr_b16 v[224:225], v8 offset:40960
ds_read_b64_tr_b16 v[226:227], v8 offset:43008
v_mfma_f32_16x16x32_bf16 v[20:23], v[132:135], a[32:35], v[20:23]
s_nop 0
ds_read_b64_tr_b16 v[228:229], v9 offset:40960
ds_read_b64_tr_b16 v[230:231], v9 offset:43008
v_mfma_f32_16x16x32_bf16 v[24:27], v[136:139], a[32:35], v[24:27]
v_and_b32 v114, 0xffff0000, v54
v_lshlrev_b32 v115, 16, v70
v_mfma_f32_16x16x32_bf16 v[24:27], v[152:155], a[36:39], v[24:27]
s_nop 0
ds_read_b64_tr_b16 v[232:233], v10 offset:40960
ds_read_b64_tr_b16 v[234:235], v10 offset:43008
v_mfma_f32_16x16x32_bf16 v[24:27], v[168:171], a[40:43], v[24:27]
s_nop 0
ds_read_b64_tr_b16 v[236:237], v11 offset:40960
ds_read_b64_tr_b16 v[238:239], v11 offset:43008
v_mfma_f32_16x16x32_bf16 v[24:27], v[184:187], a[44:47], v[24:27]
v_lshlrev_b32 v54, 16, v54
v_and_b32 v70, 0xffff0000, v70
v_mfma_f32_16x16x32_bf16 v[40:43], v[184:187], a[60:63], v[40:43]
s_nop 0
ds_read_b64_tr_b16 v[240:241], v8 offset:45056
ds_read_b64_tr_b16 v[242:243], v8 offset:47104
v_mfma_f32_16x16x32_bf16 v[40:43], v[168:171], a[56:59], v[40:43]
Lstube4:
s_cbranch_execz Lrete
v_mul_f32 v54, v54, v112
v_mul_f32 v114, v114, v112
v_mfma_f32_16x16x32_bf16 v[40:43], v[152:155], a[52:55], v[40:43]
s_nop 0
ds_read_b64_tr_b16 v[244:245], v9 offset:45056
ds_read_b64_tr_b16 v[246:247], v9 offset:47104
v_mfma_f32_16x16x32_bf16 v[40:43], v[136:139], a[48:51], v[40:43]
s_nop 0
ds_read_b64_tr_b16 v[248:249], v10 offset:45056
ds_read_b64_tr_b16 v[250:251], v10 offset:47104
v_mfma_f32_16x16x32_bf16 v[44:47], v[140:143], a[48:51], v[44:47]
v_mul_f32 v54, v54, v115
v_mul_f32 v70, v70, v114
v_mfma_f32_16x16x32_bf16 v[44:47], v[156:159], a[52:55], v[44:47]
s_nop 0
ds_read_b64_tr_b16 v[252:253], v11 offset:45056
ds_read_b64_tr_b16 v[254:255], v11 offset:47104
v_mfma_f32_16x16x32_bf16 v[44:47], v[172:175], a[56:59], v[44:47]
v_and_b32 v114, 0xffff0000, v55
v_lshlrev_b32 v115, 16, v71
v_mfma_f32_16x16x32_bf16 v[44:47], v[188:191], a[60:63], v[44:47]
v_lshlrev_b32 v55, 16, v55
v_and_b32 v71, 0xffff0000, v71
v_mfma_f32_16x16x32_bf16 v[28:31], v[188:191], a[44:47], v[28:31]
v_mul_f32 v55, v55, v112
v_mul_f32 v114, v114, v112
v_mfma_f32_16x16x32_bf16 v[28:31], v[172:175], a[40:43], v[28:31]
s_add_u32 s79, s93, 0x3a00000
v_mul_f32 v55, v55, v115
v_mul_f32 v71, v71, v114
v_mfma_f32_16x16x32_bf16 v[28:31], v[156:159], a[36:39], v[28:31]
s_waitcnt vmcnt(24) lgkmcnt(0)
buffer_load_dwordx4 v[96:99], v1, s[44:47], s79 offen sc1
v_mfma_f32_16x16x32_bf16 v[28:31], v[140:143], a[32:35], v[28:31]
s_barrier
v_and_b32 v114, 0xffff0000, v56
v_lshlrev_b32 v115, 16, v72
v_mfma_f32_16x16x32_bf16 v[16:19], v[192:195], a[64:67], v[16:19]
s_nop 0
ds_read_b64_tr_b16 v[128:129], v8 offset:49152
ds_read_b64_tr_b16 v[130:131], v8 offset:51200
v_mfma_f32_16x16x32_bf16 v[16:19], v[208:211], a[68:71], v[16:19]
s_nop 0
ds_read_b64_tr_b16 v[132:133], v9 offset:49152
ds_read_b64_tr_b16 v[134:135], v9 offset:51200
v_mfma_f32_16x16x32_bf16 v[16:19], v[224:227], a[72:75], v[16:19]
v_lshlrev_b32 v56, 16, v56
v_and_b32 v72, 0xffff0000, v72
v_mfma_f32_16x16x32_bf16 v[16:19], v[240:243], a[76:79], v[16:19]
buffer_load_dwordx4 v[100:103], v1, s[44:47], s79 offen offset:1024 sc1
v_mfma_f32_16x16x32_bf16 v[32:35], v[240:243], a[92:95], v[32:35]
s_nop 0
ds_read_b64_tr_b16 v[136:137], v10 offset:49152
ds_read_b64_tr_b16 v[138:139], v10 offset:51200
v_mfma_f32_16x16x32_bf16 v[32:35], v[224:227], a[88:91], v[32:35]
s_nop 0
ds_read_b64_tr_b16 v[140:141], v11 offset:49152
ds_read_b64_tr_b16 v[142:143], v11 offset:51200
v_mfma_f32_16x16x32_bf16 v[32:35], v[208:211], a[84:87], v[32:35]
v_mul_f32 v56, v56, v113
v_mul_f32 v114, v114, v113
v_mfma_f32_16x16x32_bf16 v[32:35], v[192:195], a[80:83], v[32:35]
s_nop 0
ds_read_b64_tr_b16 v[144:145], v8 offset:53248
ds_read_b64_tr_b16 v[146:147], v8 offset:55296
v_mfma_f32_16x16x32_bf16 v[36:39], v[196:199], a[80:83], v[36:39]
buffer_load_dwordx4 v[104:107], v1, s[44:47], s79 offen offset:2048 sc1
v_mfma_f32_16x16x32_bf16 v[36:39], v[212:215], a[84:87], v[36:39]
s_nop 0
ds_read_b64_tr_b16 v[148:149], v9 offset:53248
ds_read_b64_tr_b16 v[150:151], v9 offset:55296
v_mfma_f32_16x16x32_bf16 v[36:39], v[228:231], a[88:91], v[36:39]
v_mul_f32 v56, v56, v115
v_mul_f32 v72, v72, v114
v_mfma_f32_16x16x32_bf16 v[36:39], v[244:247], a[92:95], v[36:39]
s_nop 0
ds_read_b64_tr_b16 v[152:153], v10 offset:53248
ds_read_b64_tr_b16 v[154:155], v10 offset:55296
v_mfma_f32_16x16x32_bf16 v[20:23], v[244:247], a[76:79], v[20:23]
s_nop 0
ds_read_b64_tr_b16 v[156:157], v11 offset:53248
ds_read_b64_tr_b16 v[158:159], v11 offset:55296
v_mfma_f32_16x16x32_bf16 v[20:23], v[228:231], a[72:75], v[20:23]
buffer_load_dwordx4 v[108:111], v1, s[44:47], s79 offen offset:3072 sc1
v_mfma_f32_16x16x32_bf16 v[20:23], v[212:215], a[68:71], v[20:23]
v_and_b32 v114, 0xffff0000, v57
v_lshlrev_b32 v115, 16, v73
v_mfma_f32_16x16x32_bf16 v[20:23], v[196:199], a[64:67], v[20:23]
s_nop 0
ds_read_b64_tr_b16 v[160:161], v8 offset:57344
ds_read_b64_tr_b16 v[162:163], v8 offset:59392
v_mfma_f32_16x16x32_bf16 v[24:27], v[200:203], a[64:67], v[24:27]
s_nop 0
ds_read_b64_tr_b16 v[164:165], v9 offset:57344
ds_read_b64_tr_b16 v[166:167], v9 offset:59392
v_mfma_f32_16x16x32_bf16 v[24:27], v[216:219], a[68:71], v[24:27]
v_lshlrev_b32 v57, 16, v57
v_and_b32 v73, 0xffff0000, v73
v_mfma_f32_16x16x32_bf16 v[24:27], v[232:235], a[72:75], v[24:27]
s_nop 0
ds_read_b64_tr_b16 v[168:169], v10 offset:57344
ds_read_b64_tr_b16 v[170:171], v10 offset:59392
v_mfma_f32_16x16x32_bf16 v[24:27], v[248:251], a[76:79], v[24:27]
s_nop 0
ds_read_b64_tr_b16 v[172:173], v11 offset:57344
ds_read_b64_tr_b16 v[174:175], v11 offset:59392
v_mfma_f32_16x16x32_bf16 v[40:43], v[248:251], a[92:95], v[40:43]
v_mul_f32 v57, v57, v113
v_mul_f32 v114, v114, v113
v_mfma_f32_16x16x32_bf16 v[40:43], v[232:235], a[88:91], v[40:43]
s_nop 0
ds_read_b64_tr_b16 v[176:177], v8 offset:61440
ds_read_b64_tr_b16 v[178:179], v8 offset:63488
v_mfma_f32_16x16x32_bf16 v[40:43], v[216:219], a[84:87], v[40:43]
s_nop 0
ds_read_b64_tr_b16 v[180:181], v9 offset:61440
ds_read_b64_tr_b16 v[182:183], v9 offset:63488
v_mfma_f32_16x16x32_bf16 v[40:43], v[200:203], a[80:83], v[40:43]
v_mul_f32 v57, v57, v115
v_mul_f32 v73, v73, v114
v_mfma_f32_16x16x32_bf16 v[44:47], v[204:207], a[80:83], v[44:47]
s_nop 0
ds_read_b64_tr_b16 v[184:185], v10 offset:61440
ds_read_b64_tr_b16 v[186:187], v10 offset:63488
v_mfma_f32_16x16x32_bf16 v[44:47], v[220:223], a[84:87], v[44:47]
s_nop 0
ds_read_b64_tr_b16 v[188:189], v11 offset:61440
ds_read_b64_tr_b16 v[190:191], v11 offset:63488
v_mfma_f32_16x16x32_bf16 v[44:47], v[236:239], a[88:91], v[44:47]
v_and_b32 v114, 0xffff0000, v58
v_lshlrev_b32 v115, 16, v74
v_mfma_f32_16x16x32_bf16 v[44:47], v[252:255], a[92:95], v[44:47]
v_lshlrev_b32 v58, 16, v58
v_and_b32 v74, 0xffff0000, v74
v_mfma_f32_16x16x32_bf16 v[28:31], v[252:255], a[76:79], v[28:31]
v_xor_b32 v8, 0x10000, v8
v_mul_f32 v58, v58, v113
v_mfma_f32_16x16x32_bf16 v[28:31], v[236:239], a[72:75], v[28:31]
v_xor_b32 v9, 0x10000, v9
v_mul_f32 v114, v114, v113
v_mfma_f32_16x16x32_bf16 v[28:31], v[220:223], a[68:71], v[28:31]
s_waitcnt vmcnt(22) lgkmcnt(0)
v_xor_b32 v10, 0x10000, v10
v_mul_f32 v58, v58, v115
v_mfma_f32_16x16x32_bf16 v[28:31], v[204:207], a[64:67], v[28:31]
s_barrier
v_xor_b32 v11, 0x10000, v11
v_mul_f32 v74, v74, v114
v_mfma_f32_16x16x32_bf16 v[16:19], v[128:131], a[96:99], v[16:19]
s_nop 0
ds_read_b64_tr_b16 v[192:193], v8 offset:0
ds_read_b64_tr_b16 v[194:195], v8 offset:2048
v_mfma_f32_16x16x32_bf16 v[16:19], v[144:147], a[100:103], v[16:19]
s_nop 0
ds_read_b64_tr_b16 v[196:197], v9 offset:0
ds_read_b64_tr_b16 v[198:199], v9 offset:2048
v_mfma_f32_16x16x32_bf16 v[16:19], v[160:163], a[104:107], v[16:19]
v_and_b32 v114, 0xffff0000, v59
v_lshlrev_b32 v115, 16, v75
v_mfma_f32_16x16x32_bf16 v[16:19], v[176:179], a[108:111], v[16:19]
s_nop 0
ds_read_b64_tr_b16 v[200:201], v10 offset:0
ds_read_b64_tr_b16 v[202:203], v10 offset:2048
v_mfma_f32_16x16x32_bf16 v[32:35], v[176:179], a[124:127], v[32:35]
v_lshlrev_b32 v59, 16, v59
v_and_b32 v75, 0xffff0000, v75
v_mfma_f32_16x16x32_bf16 v[32:35], v[160:163], a[120:123], v[32:35]
s_nop 0
ds_read_b64_tr_b16 v[204:205], v11 offset:0
ds_read_b64_tr_b16 v[206:207], v11 offset:2048
v_mfma_f32_16x16x32_bf16 v[32:35], v[144:147], a[116:119], v[32:35]
s_nop 0
ds_read_b64_tr_b16 v[208:209], v8 offset:4096
ds_read_b64_tr_b16 v[210:211], v8 offset:6144
v_mfma_f32_16x16x32_bf16 v[32:35], v[128:131], a[112:115], v[32:35]
v_mul_f32 v59, v59, v113
v_mul_f32 v114, v114, v113
v_mfma_f32_16x16x32_bf16 v[36:39], v[132:135], a[112:115], v[36:39]
s_nop 0
ds_read_b64_tr_b16 v[212:213], v9 offset:4096
ds_read_b64_tr_b16 v[214:215], v9 offset:6144
v_mfma_f32_16x16x32_bf16 v[36:39], v[148:151], a[116:119], v[36:39]
v_mul_f32 v59, v59, v115
v_mul_f32 v75, v75, v114
v_mfma_f32_16x16x32_bf16 v[36:39], v[164:167], a[120:123], v[36:39]
s_nop 0
ds_read_b64_tr_b16 v[216:217], v10 offset:4096
ds_read_b64_tr_b16 v[218:219], v10 offset:6144
v_mfma_f32_16x16x32_bf16 v[36:39], v[180:183], a[124:127], v[36:39]
s_nop 0
ds_read_b64_tr_b16 v[220:221], v11 offset:4096
ds_read_b64_tr_b16 v[222:223], v11 offset:6144
v_mfma_f32_16x16x32_bf16 v[20:23], v[180:183], a[108:111], v[20:23]
v_and_b32 v114, 0xffff0000, v60
v_lshlrev_b32 v115, 16, v76
v_mfma_f32_16x16x32_bf16 v[20:23], v[164:167], a[104:107], v[20:23]
s_nop 0
ds_read_b64_tr_b16 v[224:225], v8 offset:8192
ds_read_b64_tr_b16 v[226:227], v8 offset:10240
v_mfma_f32_16x16x32_bf16 v[20:23], v[148:151], a[100:103], v[20:23]
v_lshlrev_b32 v60, 16, v60
v_and_b32 v76, 0xffff0000, v76
v_mfma_f32_16x16x32_bf16 v[20:23], v[132:135], a[96:99], v[20:23]
s_nop 0
ds_read_b64_tr_b16 v[228:229], v9 offset:8192
ds_read_b64_tr_b16 v[230:231], v9 offset:10240
v_mfma_f32_16x16x32_bf16 v[24:27], v[136:139], a[96:99], v[24:27]
s_nop 0
ds_read_b64_tr_b16 v[232:233], v10 offset:8192
ds_read_b64_tr_b16 v[234:235], v10 offset:10240
v_mfma_f32_16x16x32_bf16 v[24:27], v[152:155], a[100:103], v[24:27]
v_mul_f32 v60, v60, v113
v_mul_f32 v114, v114, v113
v_mfma_f32_16x16x32_bf16 v[24:27], v[168:171], a[104:107], v[24:27]
s_nop 0
ds_read_b64_tr_b16 v[236:237], v11 offset:8192
ds_read_b64_tr_b16 v[238:239], v11 offset:10240
v_mfma_f32_16x16x32_bf16 v[24:27], v[184:187], a[108:111], v[24:27]
v_mul_f32 v60, v60, v115
v_mul_f32 v76, v76, v114
v_mfma_f32_16x16x32_bf16 v[40:43], v[184:187], a[124:127], v[40:43]
s_nop 0
ds_read_b64_tr_b16 v[240:241], v8 offset:12288
ds_read_b64_tr_b16 v[242:243], v8 offset:14336
v_mfma_f32_16x16x32_bf16 v[40:43], v[168:171], a[120:123], v[40:43]
s_nop 0
ds_read_b64_tr_b16 v[244:245], v9 offset:12288
ds_read_b64_tr_b16 v[246:247], v9 offset:14336
v_mfma_f32_16x16x32_bf16 v[40:43], v[152:155], a[116:119], v[40:43]
v_and_b32 v114, 0xffff0000, v61
v_lshlrev_b32 v115, 16, v77
v_mfma_f32_16x16x32_bf16 v[40:43], v[136:139], a[112:115], v[40:43]
s_nop 0
ds_read_b64_tr_b16 v[248:249], v10 offset:12288
ds_read_b64_tr_b16 v[250:251], v10 offset:14336
v_mfma_f32_16x16x32_bf16 v[44:47], v[140:143], a[112:115], v[44:47]
v_lshlrev_b32 v61, 16, v61
v_and_b32 v77, 0xffff0000, v77
v_mfma_f32_16x16x32_bf16 v[44:47], v[156:159], a[116:119], v[44:47]
s_nop 0
ds_read_b64_tr_b16 v[252:253], v11 offset:12288
ds_read_b64_tr_b16 v[254:255], v11 offset:14336
v_mfma_f32_16x16x32_bf16 v[44:47], v[172:175], a[120:123], v[44:47]
v_mul_f32 v61, v61, v113
v_mul_f32 v114, v114, v113
v_mfma_f32_16x16x32_bf16 v[44:47], v[188:191], a[124:127], v[44:47]
s_waitcnt vmcnt(0)
v_max3_u32 v12, v96, v97, v98
v_max3_u32 v13, v99, v100, v101
v_mfma_f32_16x16x32_bf16 v[28:31], v[188:191], a[108:111], v[28:31]
v_max3_u32 v12, v12, v102, v103
v_max3_u32 v13, v13, v104, v105
v_mfma_f32_16x16x32_bf16 v[28:31], v[172:175], a[104:107], v[28:31]
v_max3_u32 v12, v12, v106, v107
v_max3_u32 v13, v13, v108, v109
v_mfma_f32_16x16x32_bf16 v[28:31], v[156:159], a[100:103], v[28:31]
s_waitcnt vmcnt(16) lgkmcnt(0)
v_max3_u32 v12, v12, v110, v111
v_mul_f32 v61, v61, v115
v_mfma_f32_16x16x32_bf16 v[28:31], v[140:143], a[96:99], v[28:31]
s_barrier
v_max_u32 v12, v12, v13
v_mul_f32 v77, v77, v114
v_mfma_f32_16x16x32_bf16 v[16:19], v[192:195], a[128:131], v[16:19]
v_cmp_le_u32 vcc, 0xff800000, v12
v_and_b32 v114, 0xffff0000, v62
v_mfma_f32_16x16x32_bf16 v[16:19], v[208:211], a[132:135], v[16:19]
s_nop 0
ds_read_b64_tr_b16 v[128:129], v8 offset:16384
ds_read_b64_tr_b16 v[130:131], v8 offset:18432
v_mfma_f32_16x16x32_bf16 v[16:19], v[224:227], a[136:139], v[16:19]
s_cbranch_vccnz Lxspin1
Lxback1:
ds_read_b64_tr_b16 v[132:133], v9 offset:16384
ds_read_b64_tr_b16 v[134:135], v9 offset:18432
v_mfma_f32_16x16x32_bf16 v[16:19], v[240:243], a[140:143], v[16:19]
v_lshlrev_b32 v115, 16, v78
v_lshlrev_b32 v62, 16, v62
v_mfma_f32_16x16x32_bf16 v[16:19], v[124:127], v[96:99], v[16:19]
s_nop 0
ds_read_b64_tr_b16 v[136:137], v10 offset:16384
ds_read_b64_tr_b16 v[138:139], v10 offset:18432
v_mfma_f32_16x16x32_bf16 v[32:35], v[240:243], a[156:159], v[32:35]
v_and_b32 v78, 0xffff0000, v78
v_mul_f32 v62, v62, v113
v_mfma_f32_16x16x32_bf16 v[32:35], v[224:227], a[152:155], v[32:35]
s_add_u32 s82, s93, 0x3e00000
buffer_load_dwordx4 v[80:83], v1, s[44:47], s82 offen sc1
v_mfma_f32_16x16x32_bf16 v[32:35], v[208:211], a[148:151], v[32:35]
s_nop 0
ds_read_b64_tr_b16 v[140:141], v11 offset:16384
ds_read_b64_tr_b16 v[142:143], v11 offset:18432
v_mfma_f32_16x16x32_bf16 v[32:35], v[192:195], a[144:147], v[32:35]
v_mul_f32 v114, v114, v113
v_mul_f32 v62, v62, v115
v_mfma_f32_16x16x32_bf16 v[32:35], v[124:127], v[104:107], v[32:35]
s_nop 0
ds_read_b64_tr_b16 v[144:145], v8 offset:20480
ds_read_b64_tr_b16 v[146:147], v8 offset:22528
v_mfma_f32_16x16x32_bf16 v[36:39], v[196:199], a[144:147], v[36:39]
v_mul_f32 v78, v78, v114
v_and_b32 v114, 0xffff0000, v63
v_mfma_f32_16x16x32_bf16 v[36:39], v[212:215], a[148:151], v[36:39]
buffer_load_dwordx4 v[84:87], v1, s[44:47], s82 offen offset:1024 sc1
v_mfma_f32_16x16x32_bf16 v[36:39], v[228:231], a[152:155], v[36:39]
s_nop 0
ds_read_b64_tr_b16 v[148:149], v9 offset:20480
ds_read_b64_tr_b16 v[150:151], v9 offset:22528
v_mfma_f32_16x16x32_bf16 v[36:39], v[244:247], a[156:159], v[36:39]
v_lshlrev_b32 v115, 16, v79
v_lshlrev_b32 v63, 16, v63
v_mfma_f32_16x16x32_bf16 v[36:39], v[120:123], v[104:107], v[36:39]
s_nop 0
ds_read_b64_tr_b16 v[152:153], v10 offset:20480
ds_read_b64_tr_b16 v[154:155], v10 offset:22528
v_mfma_f32_16x16x32_bf16 v[20:23], v[244:247], a[140:143], v[20:23]
v_and_b32 v79, 0xffff0000, v79
v_mul_f32 v63, v63, v113
v_mfma_f32_16x16x32_bf16 v[20:23], v[228:231], a[136:139], v[20:23]
buffer_load_dwordx4 v[88:91], v1, s[44:47], s82 offen offset:2048 sc1
v_mfma_f32_16x16x32_bf16 v[20:23], v[212:215], a[132:135], v[20:23]
s_nop 0
ds_read_b64_tr_b16 v[156:157], v11 offset:20480
ds_read_b64_tr_b16 v[158:159], v11 offset:22528
v_mfma_f32_16x16x32_bf16 v[20:23], v[196:199], a[128:131], v[20:23]
v_mul_f32 v114, v114, v113
v_mul_f32 v63, v63, v115
v_mfma_f32_16x16x32_bf16 v[20:23], v[120:123], v[96:99], v[20:23]
s_nop 0
ds_read_b64_tr_b16 v[160:161], v8 offset:24576
ds_read_b64_tr_b16 v[162:163], v8 offset:26624
v_mfma_f32_16x16x32_bf16 v[24:27], v[200:203], a[128:131], v[24:27]
s_nop 0
ds_read_b64_tr_b16 v[164:165], v9 offset:24576
ds_read_b64_tr_b16 v[166:167], v9 offset:26624
v_mfma_f32_16x16x32_bf16 v[24:27], v[216:219], a[132:135], v[24:27]
buffer_load_dwordx4 v[92:95], v1, s[44:47], s82 offen offset:3072 sc1
v_mfma_f32_16x16x32_bf16 v[24:27], v[232:235], a[136:139], v[24:27]
v_mul_f32 v79, v79, v114
v_mfma_f32_16x16x32_bf16 v[24:27], v[248:251], a[140:143], v[24:27]
s_nop 0
ds_read_b64_tr_b16 v[168:169], v10 offset:24576
ds_read_b64_tr_b16 v[170:171], v10 offset:26624
v_mfma_f32_16x16x32_bf16 v[24:27], v[124:127], v[100:103], v[24:27]
v_mfma_f32_16x16x32_bf16 v[40:43], v[248:251], a[156:159], v[40:43]
s_nop 0
ds_read_b64_tr_b16 v[172:173], v11 offset:24576
ds_read_b64_tr_b16 v[174:175], v11 offset:26624
v_mfma_f32_16x16x32_bf16 v[40:43], v[232:235], a[152:155], v[40:43]
v_mfma_f32_16x16x32_bf16 v[40:43], v[216:219], a[148:151], v[40:43]
s_nop 0
ds_read_b64_tr_b16 v[176:177], v8 offset:28672
ds_read_b64_tr_b16 v[178:179], v8 offset:30720
v_mfma_f32_16x16x32_bf16 v[40:43], v[200:203], a[144:147], v[40:43]
v_mfma_f32_16x16x32_bf16 v[40:43], v[124:127], v[108:111], v[40:43]
s_nop 0
ds_read_b64_tr_b16 v[180:181], v9 offset:28672
ds_read_b64_tr_b16 v[182:183], v9 offset:30720
v_mfma_f32_16x16x32_bf16 v[44:47], v[204:207], a[144:147], v[44:47]
v_mfma_f32_16x16x32_bf16 v[44:47], v[220:223], a[148:151], v[44:47]
s_nop 0
ds_read_b64_tr_b16 v[184:185], v10 offset:28672
ds_read_b64_tr_b16 v[186:187], v10 offset:30720
v_mfma_f32_16x16x32_bf16 v[44:47], v[236:239], a[152:155], v[44:47]
v_mfma_f32_16x16x32_bf16 v[44:47], v[252:255], a[156:159], v[44:47]
s_nop 0
ds_read_b64_tr_b16 v[188:189], v11 offset:28672
ds_read_b64_tr_b16 v[190:191], v11 offset:30720
v_mfma_f32_16x16x32_bf16 v[44:47], v[120:123], v[108:111], v[44:47]
v_mfma_f32_16x16x32_bf16 v[28:31], v[252:255], a[140:143], v[28:31]
v_mfma_f32_16x16x32_bf16 v[28:31], v[236:239], a[136:139], v[28:31]
v_mfma_f32_16x16x32_bf16 v[28:31], v[220:223], a[132:135], v[28:31]
v_mfma_f32_16x16x32_bf16 v[28:31], v[204:207], a[128:131], v[28:31]
s_waitcnt vmcnt(16) lgkmcnt(0)
v_mfma_f32_16x16x32_bf16 v[28:31], v[120:123], v[100:103], v[28:31]
s_barrier
v_mfma_f32_16x16x32_bf16 v[16:19], v[128:131], a[160:163], v[16:19]
s_nop 0
ds_read_b64_tr_b16 v[192:193], v8 offset:32768
ds_read_b64_tr_b16 v[194:195], v8 offset:34816
v_mfma_f32_16x16x32_bf16 v[16:19], v[144:147], a[164:167], v[16:19]
s_nop 0
ds_read_b64_tr_b16 v[196:197], v9 offset:32768
ds_read_b64_tr_b16 v[198:199], v9 offset:34816
v_mfma_f32_16x16x32_bf16 v[16:19], v[160:163], a[168:171], v[16:19]
s_nop 0
ds_read_b64_tr_b16 v[200:201], v10 offset:32768
ds_read_b64_tr_b16 v[202:203], v10 offset:34816
v_mfma_f32_16x16x32_bf16 v[16:19], v[176:179], a[172:175], v[16:19]
v_mfma_f32_16x16x32_bf16 v[32:35], v[176:179], a[188:191], v[32:35]
s_nop 0
ds_read_b64_tr_b16 v[204:205], v11 offset:32768
ds_read_b64_tr_b16 v[206:207], v11 offset:34816
v_mfma_f32_16x16x32_bf16 v[32:35], v[160:163], a[184:187], v[32:35]
s_nop 0
ds_read_b64_tr_b16 v[208:209], v8 offset:36864
ds_read_b64_tr_b16 v[210:211], v8 offset:38912
v_mfma_f32_16x16x32_bf16 v[32:35], v[144:147], a[180:183], v[32:35]
s_add_u32 s81, s93, 0x4200000
buffer_load_dwordx4 v[96:99], v1, s[44:47], s81 offen sc1
v_mfma_f32_16x16x32_bf16 v[32:35], v[128:131], a[176:179], v[32:35]
v_mfma_f32_16x16x32_bf16 v[36:39], v[132:135], a[176:179], v[36:39]
s_nop 0
ds_read_b64_tr_b16 v[212:213], v9 offset:36864
ds_read_b64_tr_b16 v[214:215], v9 offset:38912
v_mfma_f32_16x16x32_bf16 v[36:39], v[148:151], a[180:183], v[36:39]
s_nop 0
ds_read_b64_tr_b16 v[216:217], v10 offset:36864
ds_read_b64_tr_b16 v[218:219], v10 offset:38912
v_mfma_f32_16x16x32_bf16 v[36:39], v[164:167], a[184:187], v[36:39]
v_mfma_f32_16x16x32_bf16 v[36:39], v[180:183], a[188:191], v[36:39]
buffer_load_dwordx4 v[100:103], v1, s[44:47], s81 offen offset:1024 sc1
v_mfma_f32_16x16x32_bf16 v[20:23], v[180:183], a[172:175], v[20:23]
s_nop 0
ds_read_b64_tr_b16 v[220:221], v11 offset:36864
ds_read_b64_tr_b16 v[222:223], v11 offset:38912
v_mfma_f32_16x16x32_bf16 v[20:23], v[164:167], a[168:171], v[20:23]
s_nop 0
ds_read_b64_tr_b16 v[224:225], v8 offset:40960
ds_read_b64_tr_b16 v[226:227], v8 offset:43008
v_mfma_f32_16x16x32_bf16 v[20:23], v[148:151], a[164:167], v[20:23]
s_nop 0
ds_read_b64_tr_b16 v[228:229], v9 offset:40960
ds_read_b64_tr_b16 v[230:231], v9 offset:43008
v_mfma_f32_16x16x32_bf16 v[20:23], v[132:135], a[160:163], v[20:23]
v_mfma_f32_16x16x32_bf16 v[24:27], v[136:139], a[160:163], v[24:27]
buffer_load_dwordx4 v[104:107], v1, s[44:47], s81 offen offset:2048 sc1
v_mfma_f32_16x16x32_bf16 v[24:27], v[152:155], a[164:167], v[24:27]
s_nop 0
ds_read_b64_tr_b16 v[232:233], v10 offset:40960
ds_read_b64_tr_b16 v[234:235], v10 offset:43008
v_mfma_f32_16x16x32_bf16 v[24:27], v[168:171], a[168:171], v[24:27]
s_nop 0
ds_read_b64_tr_b16 v[236:237], v11 offset:40960
ds_read_b64_tr_b16 v[238:239], v11 offset:43008
v_mfma_f32_16x16x32_bf16 v[24:27], v[184:187], a[172:175], v[24:27]
v_mfma_f32_16x16x32_bf16 v[40:43], v[184:187], a[188:191], v[40:43]
s_nop 0
ds_read_b64_tr_b16 v[240:241], v8 offset:45056
ds_read_b64_tr_b16 v[242:243], v8 offset:47104
v_mfma_f32_16x16x32_bf16 v[40:43], v[168:171], a[184:187], v[40:43]
buffer_load_dwordx4 v[108:111], v1, s[44:47], s81 offen offset:3072 sc1
v_mfma_f32_16x16x32_bf16 v[40:43], v[152:155], a[180:183], v[40:43]
s_nop 0
ds_read_b64_tr_b16 v[244:245], v9 offset:45056
ds_read_b64_tr_b16 v[246:247], v9 offset:47104
v_mfma_f32_16x16x32_bf16 v[40:43], v[136:139], a[176:179], v[40:43]
v_mfma_f32_16x16x32_bf16 v[44:47], v[140:143], a[176:179], v[44:47]
s_nop 0
ds_read_b64_tr_b16 v[248:249], v10 offset:45056
ds_read_b64_tr_b16 v[250:251], v10 offset:47104
v_mfma_f32_16x16x32_bf16 v[44:47], v[156:159], a[180:183], v[44:47]
s_nop 0
ds_read_b64_tr_b16 v[252:253], v11 offset:45056
ds_read_b64_tr_b16 v[254:255], v11 offset:47104
v_mfma_f32_16x16x32_bf16 v[44:47], v[172:175], a[184:187], v[44:47]
v_mfma_f32_16x16x32_bf16 v[44:47], v[188:191], a[188:191], v[44:47]
s_waitcnt vmcnt(4)
v_max3_u32 v12, v80, v81, v82
v_max3_u32 v13, v83, v84, v85
v_mfma_f32_16x16x32_bf16 v[28:31], v[188:191], a[172:175], v[28:31]
v_max3_u32 v12, v12, v86, v87
v_max3_u32 v13, v13, v88, v89
v_mfma_f32_16x16x32_bf16 v[28:31], v[172:175], a[168:171], v[28:31]
v_max3_u32 v12, v12, v90, v91
v_max3_u32 v13, v13, v92, v93
v_mfma_f32_16x16x32_bf16 v[28:31], v[156:159], a[164:167], v[28:31]
s_waitcnt vmcnt(15) lgkmcnt(0)
v_max3_u32 v12, v12, v94, v95
v_mfma_f32_16x16x32_bf16 v[28:31], v[140:143], a[160:163], v[28:31]
s_barrier
v_max_u32 v12, v12, v13
v_mfma_f32_16x16x32_bf16 v[16:19], v[192:195], a[192:195], v[16:19]
v_cmp_le_u32 vcc, 0xff800000, v12
v_mfma_f32_16x16x32_bf16 v[16:19], v[208:211], a[196:199], v[16:19]
s_nop 0
ds_read_b64_tr_b16 v[128:129], v8 offset:49152
ds_read_b64_tr_b16 v[130:131], v8 offset:51200
v_mfma_f32_16x16x32_bf16 v[16:19], v[224:227], a[200:203], v[16:19]
s_cbranch_vccnz Lxspin2
Lxback2:
v_mfma_f32_16x16x32_bf16 v[16:19], v[240:243], a[204:207], v[16:19]
s_nop 0
ds_read_b64_tr_b16 v[132:133], v9 offset:49152
ds_read_b64_tr_b16 v[134:135], v9 offset:51200
v_mfma_f32_16x16x32_bf16 v[16:19], v[124:127], v[80:83], v[16:19]
v_mfma_f32_16x16x32_bf16 v[32:35], v[240:243], a[220:223], v[32:35]
s_nop 0
ds_read_b64_tr_b16 v[136:137], v10 offset:49152
ds_read_b64_tr_b16 v[138:139], v10 offset:51200
v_mfma_f32_16x16x32_bf16 v[32:35], v[224:227], a[216:219], v[32:35]
v_mfma_f32_16x16x32_bf16 v[32:35], v[208:211], a[212:215], v[32:35]
s_nop 0
ds_read_b64_tr_b16 v[140:141], v11 offset:49152
ds_read_b64_tr_b16 v[142:143], v11 offset:51200
v_mfma_f32_16x16x32_bf16 v[32:35], v[192:195], a[208:211], v[32:35]
v_mfma_f32_16x16x32_bf16 v[32:35], v[124:127], v[88:91], v[32:35]
s_nop 0
ds_read_b64_tr_b16 v[144:145], v8 offset:53248
ds_read_b64_tr_b16 v[146:147], v8 offset:55296
v_mfma_f32_16x16x32_bf16 v[36:39], v[196:199], a[208:211], v[36:39]
v_mfma_f32_16x16x32_bf16 v[36:39], v[212:215], a[212:215], v[36:39]
s_nop 0
ds_read_b64_tr_b16 v[148:149], v9 offset:53248
ds_read_b64_tr_b16 v[150:151], v9 offset:55296
v_mfma_f32_16x16x32_bf16 v[36:39], v[228:231], a[216:219], v[36:39]
v_mfma_f32_16x16x32_bf16 v[36:39], v[244:247], a[220:223], v[36:39]
s_nop 0
ds_read_b64_tr_b16 v[152:153], v10 offset:53248
ds_read_b64_tr_b16 v[154:155], v10 offset:55296
v_mfma_f32_16x16x32_bf16 v[36:39], v[120:123], v[88:91], v[36:39]
v_mfma_f32_16x16x32_bf16 v[20:23], v[244:247], a[204:207], v[20:23]
s_nop 0
ds_read_b64_tr_b16 v[156:157], v11 offset:53248
ds_read_b64_tr_b16 v[158:159], v11 offset:55296
v_mfma_f32_16x16x32_bf16 v[20:23], v[228:231], a[200:203], v[20:23]
v_mfma_f32_16x16x32_bf16 v[20:23], v[212:215], a[196:199], v[20:23]
v_mfma_f32_16x16x32_bf16 v[20:23], v[196:199], a[192:195], v[20:23]
s_nop 0
ds_read_b64_tr_b16 v[160:161], v8 offset:57344
ds_read_b64_tr_b16 v[162:163], v8 offset:59392
v_mfma_f32_16x16x32_bf16 v[20:23], v[120:123], v[80:83], v[20:23]
v_mfma_f32_16x16x32_bf16 v[24:27], v[200:203], a[192:195], v[24:27]
s_nop 0
ds_read_b64_tr_b16 v[164:165], v9 offset:57344
ds_read_b64_tr_b16 v[166:167], v9 offset:59392
v_mfma_f32_16x16x32_bf16 v[24:27], v[216:219], a[196:199], v[24:27]
v_mfma_f32_16x16x32_bf16 v[24:27], v[232:235], a[200:203], v[24:27]
s_nop 0
ds_read_b64_tr_b16 v[168:169], v10 offset:57344
ds_read_b64_tr_b16 v[170:171], v10 offset:59392
v_mfma_f32_16x16x32_bf16 v[24:27], v[248:251], a[204:207], v[24:27]
v_mfma_f32_16x16x32_bf16 v[24:27], v[124:127], v[84:87], v[24:27]
s_nop 0
ds_read_b64_tr_b16 v[172:173], v11 offset:57344
ds_read_b64_tr_b16 v[174:175], v11 offset:59392
v_mfma_f32_16x16x32_bf16 v[40:43], v[248:251], a[220:223], v[40:43]
v_mfma_f32_16x16x32_bf16 v[40:43], v[232:235], a[216:219], v[40:43]
s_nop 0
ds_read_b64_tr_b16 v[176:177], v8 offset:61440
ds_read_b64_tr_b16 v[178:179], v8 offset:63488
v_mfma_f32_16x16x32_bf16 v[40:43], v[216:219], a[212:215], v[40:43]
v_mfma_f32_16x16x32_bf16 v[40:43], v[200:203], a[208:211], v[40:43]
s_nop 0
ds_read_b64_tr_b16 v[180:181], v9 offset:61440
ds_read_b64_tr_b16 v[182:183], v9 offset:63488
v_mfma_f32_16x16x32_bf16 v[40:43], v[124:127], v[92:95], v[40:43]
v_mfma_f32_16x16x32_bf16 v[44:47], v[204:207], a[208:211], v[44:47]
s_nop 0
ds_read_b64_tr_b16 v[184:185], v10 offset:61440
ds_read_b64_tr_b16 v[186:187], v10 offset:63488
v_mfma_f32_16x16x32_bf16 v[44:47], v[220:223], a[212:215], v[44:47]
v_mfma_f32_16x16x32_bf16 v[44:47], v[236:239], a[216:219], v[44:47]
s_nop 0
ds_read_b64_tr_b16 v[188:189], v11 offset:61440
ds_read_b64_tr_b16 v[190:191], v11 offset:63488
v_mfma_f32_16x16x32_bf16 v[44:47], v[252:255], a[220:223], v[44:47]
v_mfma_f32_16x16x32_bf16 v[44:47], v[120:123], v[92:95], v[44:47]
v_mfma_f32_16x16x32_bf16 v[28:31], v[252:255], a[204:207], v[28:31]
s_waitcnt vmcnt(0)
v_max3_u32 v12, v96, v97, v98
v_max3_u32 v13, v99, v100, v101
v_mfma_f32_16x16x32_bf16 v[28:31], v[236:239], a[200:203], v[28:31]
v_max3_u32 v12, v12, v102, v103
v_max3_u32 v13, v13, v104, v105
v_mfma_f32_16x16x32_bf16 v[28:31], v[220:223], a[196:199], v[28:31]
v_max3_u32 v12, v12, v106, v107
v_max3_u32 v13, v13, v108, v109
v_mfma_f32_16x16x32_bf16 v[28:31], v[204:207], a[192:195], v[28:31]
s_waitcnt lgkmcnt(0)
v_max3_u32 v12, v12, v110, v111
v_mfma_f32_16x16x32_bf16 v[28:31], v[120:123], v[84:87], v[28:31]
v_max_u32 v12, v12, v13
v_mfma_f32_16x16x32_bf16 v[16:19], v[128:131], a[224:227], v[16:19]
v_cmp_le_u32 vcc, 0xff800000, v12
v_mfma_f32_16x16x32_bf16 v[16:19], v[144:147], a[228:231], v[16:19]
v_mfma_f32_16x16x32_bf16 v[16:19], v[160:163], a[232:235], v[16:19]
s_cbranch_vccnz Lxspin3
Lxback3:
v_mfma_f32_16x16x32_bf16 v[16:19], v[176:179], a[236:239], v[16:19]
v_mfma_f32_16x16x32_bf16 v[16:19], v[124:127], v[96:99], v[16:19]
v_mfma_f32_16x16x32_bf16 v[20:23], v[180:183], a[236:239], v[20:23]
v_mfma_f32_16x16x32_bf16 v[20:23], v[164:167], a[232:235], v[20:23]
v_mfma_f32_16x16x32_bf16 v[20:23], v[148:151], a[228:231], v[20:23]
v_mfma_f32_16x16x32_bf16 v[20:23], v[132:135], a[224:227], v[20:23]
s_nop 3
v_fma_f32 v16, v16, v6, v48
v_fma_f32 v17, v17, v6, v64
v_mfma_f32_16x16x32_bf16 v[20:23], v[120:123], v[96:99], v[20:23]
v_fma_f32 v18, v18, v6, v49
v_fma_f32 v19, v19, v6, v65
v_mfma_f32_16x16x32_bf16 v[24:27], v[136:139], a[224:227], v[24:27]
v_cvt_pk_bf16_f32 v16, v16, v17
v_cvt_pk_bf16_f32 v17, v18, v19
v_mfma_f32_16x16x32_bf16 v[24:27], v[152:155], a[228:231], v[24:27]
ds_write_b64 v116, v[16:17] offset:0
v_mfma_f32_16x16x32_bf16 v[24:27], v[168:171], a[232:235], v[24:27]
v_mfma_f32_16x16x32_bf16 v[24:27], v[184:187], a[236:239], v[24:27]
v_fma_f32 v20, v20, v6, v50
v_fma_f32 v21, v21, v6, v66
v_mfma_f32_16x16x32_bf16 v[24:27], v[124:127], v[100:103], v[24:27]
v_fma_f32 v22, v22, v6, v51
v_fma_f32 v23, v23, v6, v67
v_mfma_f32_16x16x32_bf16 v[28:31], v[188:191], a[236:239], v[28:31]
v_cvt_pk_bf16_f32 v20, v20, v21
v_cvt_pk_bf16_f32 v21, v22, v23
v_mfma_f32_16x16x32_bf16 v[28:31], v[172:175], a[232:235], v[28:31]
ds_write_b64 v117, v[20:21] offset:0
v_mfma_f32_16x16x32_bf16 v[28:31], v[156:159], a[228:231], v[28:31]
v_mfma_f32_16x16x32_bf16 v[28:31], v[140:143], a[224:227], v[28:31]
v_fma_f32 v24, v24, v6, v52
v_fma_f32 v25, v25, v6, v68
v_mfma_f32_16x16x32_bf16 v[28:31], v[120:123], v[100:103], v[28:31]
v_fma_f32 v26, v26, v6, v53
v_fma_f32 v27, v27, v6, v69
v_mfma_f32_16x16x32_bf16 v[32:35], v[128:131], a[240:243], v[32:35]
v_cvt_pk_bf16_f32 v24, v24, v25
v_cvt_pk_bf16_f32 v25, v26, v27
v_mfma_f32_16x16x32_bf16 v[32:35], v[144:147], a[244:247], v[32:35]
ds_write_b64 v118, v[24:25] offset:0
v_mfma_f32_16x16x32_bf16 v[32:35], v[160:163], a[248:251], v[32:35]
v_mfma_f32_16x16x32_bf16 v[32:35], v[176:179], a[252:255], v[32:35]
v_fma_f32 v28, v28, v6, v54
v_fma_f32 v29, v29, v6, v70
v_mfma_f32_16x16x32_bf16 v[32:35], v[124:127], v[104:107], v[32:35]
v_fma_f32 v30, v30, v6, v55
v_fma_f32 v31, v31, v6, v71
v_mfma_f32_16x16x32_bf16 v[36:39], v[180:183], a[252:255], v[36:39]
v_cvt_pk_bf16_f32 v28, v28, v29
v_cvt_pk_bf16_f32 v29, v30, v31
v_mfma_f32_16x16x32_bf16 v[36:39], v[164:167], a[248:251], v[36:39]
s_nop 0
ds_write_b64 v119, v[28:29] offset:0
ds_read_b128 v[192:195], v4 offset:0
v_mfma_f32_16x16x32_bf16 v[36:39], v[148:151], a[244:247], v[36:39]
ds_read_b128 v[196:199], v4 offset:1024
v_mfma_f32_16x16x32_bf16 v[36:39], v[132:135], a[240:243], v[36:39]
v_fma_f32 v32, v32, v7, v56
v_fma_f32 v33, v33, v7, v72
v_mfma_f32_16x16x32_bf16 v[36:39], v[120:123], v[104:107], v[36:39]
v_fma_f32 v34, v34, v7, v57
v_fma_f32 v35, v35, v7, v73
v_mfma_f32_16x16x32_bf16 v[40:43], v[136:139], a[240:243], v[40:43]
v_cvt_pk_bf16_f32 v32, v32, v33
v_cvt_pk_bf16_f32 v33, v34, v35
v_mfma_f32_16x16x32_bf16 v[40:43], v[152:155], a[244:247], v[40:43]
ds_write_b64 v116, v[32:33] offset:2048
v_mfma_f32_16x16x32_bf16 v[40:43], v[168:171], a[248:251], v[40:43]
s_waitcnt lgkmcnt(2)
buffer_store_dwordx4 v[192:195], v15, s[40:43], s70 offen sc1
v_mfma_f32_16x16x32_bf16 v[40:43], v[184:187], a[252:255], v[40:43]
s_add_u32 s70, s70, 0x4000
v_mfma_f32_16x16x32_bf16 v[40:43], v[124:127], v[108:111], v[40:43]
v_fma_f32 v36, v36, v7, v58
v_fma_f32 v37, v37, v7, v74
v_mfma_f32_16x16x32_bf16 v[44:47], v[188:191], a[252:255], v[44:47]
v_fma_f32 v38, v38, v7, v59
v_fma_f32 v39, v39, v7, v75
v_mfma_f32_16x16x32_bf16 v[44:47], v[172:175], a[248:251], v[44:47]
v_cvt_pk_bf16_f32 v36, v36, v37
v_cvt_pk_bf16_f32 v37, v38, v39
v_mfma_f32_16x16x32_bf16 v[44:47], v[156:159], a[244:247], v[44:47]
ds_write_b64 v117, v[36:37] offset:2048
v_mfma_f32_16x16x32_bf16 v[44:47], v[140:143], a[240:243], v[44:47]
v_fma_f32 v40, v40, v7, v60
v_fma_f32 v41, v41, v7, v76
v_mfma_f32_16x16x32_bf16 v[44:47], v[120:123], v[108:111], v[44:47]
v_fma_f32 v42, v42, v7, v61
v_fma_f32 v43, v43, v7, v77
v_cvt_pk_bf16_f32 v40, v40, v41
v_cvt_pk_bf16_f32 v41, v42, v43
ds_write_b64 v118, v[40:41] offset:2048
s_waitcnt lgkmcnt(3)
buffer_store_dwordx4 v[196:199], v15, s[40:43], s70 offen sc1
s_add_u32 s70, s70, 0x4000
v_fma_f32 v44, v44, v7, v62
v_fma_f32 v45, v45, v7, v78
v_fma_f32 v46, v46, v7, v63
v_fma_f32 v47, v47, v7, v79
v_cvt_pk_bf16_f32 v44, v44, v45
v_cvt_pk_bf16_f32 v45, v46, v47
ds_write_b64 v119, v[44:45] offset:2048
ds_read_b128 v[200:203], v4 offset:2048
ds_read_b128 v[204:207], v4 offset:3072
s_waitcnt lgkmcnt(1)
buffer_store_dwordx4 v[200:203], v15, s[40:43], s70 offen sc1
s_add_u32 s70, s70, 0x4000
s_waitcnt lgkmcnt(0)
buffer_store_dwordx4 v[204:207], v15, s[40:43], s70 offen sc1
s_add_u32 s70, s70, 0x4000
Lend:
s_endpgm
Lspin1:
s_mov_b32 s83, 262144
Lsl3:
s_sleep 2
buffer_load_dword v3, v2, s[48:51], 0 offen sc1
s_sub_u32 s83, s83, 1
s_cmp_eq_u32 s83, 0
s_waitcnt vmcnt(0)
s_cbranch_scc1 Lback2
v_cmp_gt_u32 vcc, 8, v3
s_cbranch_vccnz Lsl3
s_branch Lback2
Lspin4:
s_mov_b32 s83, 262144
Lsl6:
s_sleep 2
buffer_load_dword v3, v2, s[44:47], s75 offen sc1
s_sub_u32 s83, s83, 1
s_cmp_eq_u32 s83, 0
s_waitcnt vmcnt(0)
s_cbranch_scc1 Lback5
v_cmp_gt_u32 vcc, 1, v3
s_cbranch_vccnz Lsl6
s_branch Lback5
.p2align 12
s_endpgm
.p2align 7
LP0x:
Lstub10:
s_cbranch_execz Lret
s_cmp_eq_u32 s58, 2
s_cbranch_scc1 Lta10
s_cmp_eq_u32 s58, 3
s_cbranch_scc1 Lnt11
v_mfma_f32_16x16x32_bf16 v[160:163], a[160:163], v[16:19], v[112:115]
s_xor_b32 s74, s82, 0x10000
v_exp_f32 v128, v128
v_mfma_f32_16x16x32_bf16 v[176:179], a[176:179], v[16:19], v[112:115]
s_add_u32 s74, s74, s64
ds_read_b128 a[128:131], v2 offset:16384
ds_read_b128 a[132:135], v2 offset:17408
s_branch Ljoin12
Lta10:
v_mfma_f32_16x16x32_bf16 v[160:163], a[160:163], v[16:19], v[96:99]
s_xor_b32 s74, s82, 0x10000
v_exp_f32 v128, v128
v_mfma_f32_16x16x32_bf16 v[176:179], a[176:179], v[16:19], v[112:115]
s_add_u32 s74, s74, s64
ds_read_b128 a[128:131], v2 offset:16384
ds_read_b128 a[132:135], v2 offset:17408
s_branch Ljoin12
Lnt11:
v_mfma_f32_16x16x32_bf16 v[160:163], a[160:163], v[16:19], v[80:83]
s_xor_b32 s74, s82, 0x10000
v_exp_f32 v128, v128
v_mfma_f32_16x16x32_bf16 v[176:179], a[176:179], v[16:19], v[96:99]
s_add_u32 s74, s74, s64
ds_read_b128 a[128:131], v2 offset:16384
ds_read_b128 a[132:135], v2 offset:17408
Ljoin12:
v_mfma_f32_16x16x32_bf16 v[164:167], a[160:163], v[32:35], v[84:87]
s_add_u32 s81, s81, 0x8000
v_exp_f32 v129, v129
v_mfma_f32_16x16x32_bf16 v[164:167], a[164:167], v[36:39], v[164:167]
s_add_u32 m0, s74, 16384
v_exp_f32 v130, v130
v_mfma_f32_16x16x32_bf16 v[164:167], a[168:171], v[40:43], v[164:167]
s_add_u32 s72, s81, 16384
v_exp_f32 v131, v131
v_mfma_f32_16x16x32_bf16 v[164:167], a[172:175], v[44:47], v[164:167]
v_exp_f32 v144, v144
v_mfma_f32_16x16x32_bf16 v[172:175], a[172:175], v[76:79], v[92:95]
ds_read_b128 a[136:139], v2 offset:18432
ds_read_b128 a[140:143], v2 offset:19456
v_mfma_f32_16x16x32_bf16 v[172:175], a[168:171], v[72:75], v[172:175]
ds_read_b128 a[144:147], v2 offset:20480
ds_read_b128 a[148:151], v2 offset:21504
v_mfma_f32_16x16x32_bf16 v[172:175], a[164:167], v[68:71], v[172:175]
ds_read_b128 a[152:155], v2 offset:22528
ds_read_b128 a[156:159], v2 offset:23552
v_mfma_f32_16x16x32_bf16 v[172:175], a[160:163], v[64:67], v[172:175]
ds_read_b128 a[192:195], v2 offset:0
ds_read_b128 a[196:199], v2 offset:1024
v_mfma_f32_16x16x32_bf16 v[188:191], a[176:179], v[64:67], v[92:95]
ds_read_b128 a[200:203], v2 offset:2048
ds_read_b128 a[204:207], v2 offset:3072
v_mfma_f32_16x16x32_bf16 v[188:191], a[180:183], v[68:71], v[188:191]
ds_read_b128 a[208:211], v2 offset:4096
ds_read_b128 a[212:215], v2 offset:5120
v_mfma_f32_16x16x32_bf16 v[188:191], a[184:187], v[72:75], v[188:191]
ds_read_b128 a[216:219], v2 offset:6144
ds_read_b128 a[220:223], v2 offset:7168
v_mfma_f32_16x16x32_bf16 v[188:191], a[188:191], v[76:79], v[188:191]
v_cvt_pk_bf16_f32 v192, v128, v129
v_cvt_pk_bf16_f32 v193, v130, v131
v_mfma_f32_16x16x32_bf16 v[180:183], a[188:191], v[44:47], v[84:87]
buffer_load_dwordx4 v1, s[44:47], s72 offen sc1 lds
v_mfma_f32_16x16x32_bf16 v[180:183], a[184:187], v[40:43], v[180:183]
v_exp_f32 v145, v145
v_mfma_f32_16x16x32_bf16 v[180:183], a[180:183], v[36:39], v[180:183]
v_exp_f32 v146, v146
v_mfma_f32_16x16x32_bf16 v[180:183], a[176:179], v[32:35], v[180:183]
v_exp_f32 v147, v147
v_mfma_f32_16x16x32_bf16 v[160:163], a[164:167], v[20:23], v[160:163]
v_exp_f32 v136, v136
v_mfma_f32_16x16x32_bf16 v[160:163], a[168:171], v[24:27], v[160:163]
v_cvt_pk_bf16_f32 v194, v144, v145
v_cvt_pk_bf16_f32 v195, v146, v147
v_mfma_f32_16x16x32_bf16 v[160:163], a[172:175], v[28:31], v[160:163]
v_exp_f32 v137, v137
v_mfma_f32_16x16x32_bf16 v[168:171], a[172:175], v[60:63], v[88:91]
v_exp_f32 v138, v138
v_mfma_f32_16x16x32_bf16 v[168:171], a[168:171], v[56:59], v[168:171]
v_exp_f32 v139, v139
v_mfma_f32_16x16x32_bf16 v[168:171], a[164:167], v[52:55], v[168:171]
v_exp_f32 v152, v152
v_mfma_f32_16x16x32_bf16 v[168:171], a[160:163], v[48:51], v[168:171]
v_cvt_pk_bf16_f32 v200, v136, v137
v_cvt_pk_bf16_f32 v201, v138, v139
v_mfma_f32_16x16x32_bf16 v[184:187], a[176:179], v[48:51], v[88:91]
buffer_load_dwordx4 v1, s[44:47], s72 offen offset:1024 sc1 lds
v_mfma_f32_16x16x32_bf16 v[184:187], a[180:183], v[52:55], v[184:187]
v_exp_f32 v153, v153
v_mfma_f32_16x16x32_bf16 v[184:187], a[184:187], v[56:59], v[184:187]
v_exp_f32 v154, v154
v_mfma_f32_16x16x32_bf16 v[184:187], a[188:191], v[60:63], v[184:187]
v_exp_f32 v155, v155
v_mfma_f32_16x16x32_bf16 v[176:179], a[188:191], v[28:31], v[176:179]
buffer_load_dwordx4 v1, s[44:47], s72 offen offset:2048 sc1 lds
v_mfma_f32_16x16x32_bf16 v[176:179], a[184:187], v[24:27], v[176:179]
buffer_load_dwordx4 v1, s[44:47], s72 offen offset:3072 sc1 lds
v_mfma_f32_16x16x32_bf16 v[176:179], a[180:183], v[20:23], v[176:179]
s_waitcnt lgkmcnt(4)
v_exp_f32 v132, v132
v_cvt_pk_bf16_f32 v202, v152, v153
v_cvt_pk_bf16_f32 v203, v154, v155
v_exp_f32 v133, v133
v_exp_f32 v134, v134
v_cvt_pk_bf16_f32 v196, v132, v133
v_exp_f32 v135, v135
v_exp_f32 v148, v148
v_cvt_pk_bf16_f32 v197, v134, v135
v_exp_f32 v149, v149
v_exp_f32 v150, v150
v_cvt_pk_bf16_f32 v198, v148, v149
v_exp_f32 v151, v151
v_exp_f32 v140, v140
v_cvt_pk_bf16_f32 v199, v150, v151
v_exp_f32 v141, v141
v_exp_f32 v142, v142
v_cvt_pk_bf16_f32 v204, v140, v141
v_exp_f32 v143, v143
v_exp_f32 v156, v156
v_cvt_pk_bf16_f32 v205, v142, v143
v_exp_f32 v157, v157
v_exp_f32 v158, v158
v_cvt_pk_bf16_f32 v206, v156, v157
v_exp_f32 v159, v159
s_nop 0
v_cvt_pk_bf16_f32 v207, v158, v159
v_mfma_f32_16x16x32_bf16 v[224:227], v[120:123], v[192:195], 0
s_add_u32 s82, s82, 0x8000
ds_read_b128 a[160:163], v2 offset:24576
ds_read_b128 a[164:167], v2 offset:25600
v_mfma_f32_16x16x32_bf16 v[232:235], v[120:123], v[200:203], 0
s_and_b32 s82, s82, 0x1ffff
v_exp_f32 v164, v164
v_mfma_f32_16x16x32_bf16 a[0:3], a[192:195], v[192:195], 0
s_add_u32 m0, s74, 0
v_exp_f32 v165, v165
v_mfma_f32_16x16x32_bf16 a[64:67], a[192:195], v[200:203], 0
s_add_u32 s72, s81, 0
v_exp_f32 v166, v166
v_mfma_f32_16x16x32_bf16 a[68:71], a[196:199], v[200:203], 0
buffer_load_dwordx4 v1, s[44:47], s72 offen sc1 lds
v_mfma_f32_16x16x32_bf16 a[4:7], a[196:199], v[192:195], 0
v_exp_f32 v167, v167
v_mfma_f32_16x16x32_bf16 a[8:11], a[200:203], v[192:195], 0
ds_read_b128 a[168:171], v2 offset:26624
ds_read_b128 a[172:175], v2 offset:27648
v_mfma_f32_16x16x32_bf16 a[72:75], a[200:203], v[200:203], 0
v_exp_f32 v180, v180
v_mfma_f32_16x16x32_bf16 a[76:79], a[204:207], v[200:203], 0
ds_read_b128 a[176:179], v2 offset:28672
ds_read_b128 a[180:183], v2 offset:29696
v_mfma_f32_16x16x32_bf16 a[12:15], a[204:207], v[192:195], 0
s_waitcnt lgkmcnt(6)
ds_read_b128 a[184:187], v2 offset:30720
ds_read_b128 a[188:191], v2 offset:31744
v_mfma_f32_16x16x32_bf16 a[16:19], a[208:211], v[192:195], 0
ds_read_b128 a[224:227], v2 offset:8192
ds_read_b128 a[228:231], v2 offset:9216
v_mfma_f32_16x16x32_bf16 a[80:83], a[208:211], v[200:203], 0
ds_read_b128 a[232:235], v2 offset:10240
ds_read_b128 a[236:239], v2 offset:11264
v_mfma_f32_16x16x32_bf16 a[84:87], a[212:215], v[200:203], 0
ds_read_b128 a[240:243], v2 offset:12288
ds_read_b128 a[244:247], v2 offset:13312
v_mfma_f32_16x16x32_bf16 a[20:23], a[212:215], v[192:195], 0
ds_read_b128 a[248:251], v2 offset:14336
ds_read_b128 a[252:255], v2 offset:15360
v_mfma_f32_16x16x32_bf16 a[24:27], a[216:219], v[192:195], 0
v_cvt_pk_bf16_f32 v212, v164, v165
v_cvt_pk_bf16_f32 v213, v166, v167
v_mfma_f32_16x16x32_bf16 a[88:91], a[216:219], v[200:203], 0
v_exp_f32 v181, v181
v_mfma_f32_16x16x32_bf16 a[92:95], a[220:223], v[200:203], 0
v_exp_f32 v182, v182
v_mfma_f32_16x16x32_bf16 a[28:31], a[220:223], v[192:195], 0
buffer_load_dwordx4 v1, s[44:47], s72 offen offset:1024 sc1 lds
s_cmp_eq_u32 s58, 0
s_cbranch_scc1 Lta13
s_cmp_eq_u32 s58, 1
s_cbranch_scc1 Lnt14
v_mfma_f32_16x16x32_bf16 v[132:135], a[128:131], v[32:35], v[84:87]
v_exp_f32 v183, v183
v_mfma_f32_16x16x32_bf16 v[148:151], a[144:147], v[32:35], v[84:87]
v_exp_f32 v172, v172
s_branch Ljoin15
Lta13:
v_mfma_f32_16x16x32_bf16 v[132:135], a[128:131], v[32:35], v[100:103]
v_exp_f32 v183, v183
v_mfma_f32_16x16x32_bf16 v[148:151], a[144:147], v[32:35], v[112:115]
v_exp_f32 v172, v172
s_branch Ljoin15
Lnt14:
v_mfma_f32_16x16x32_bf16 v[132:135], a[128:131], v[32:35], v[84:87]
v_exp_f32 v183, v183
v_mfma_f32_16x16x32_bf16 v[148:151], a[144:147], v[32:35], v[100:103]
v_exp_f32 v172, v172
Ljoin15:
v_mfma_f32_16x16x32_bf16 v[136:139], a[128:131], v[48:51], v[88:91]
v_cvt_pk_bf16_f32 v214, v180, v181
v_cvt_pk_bf16_f32 v215, v182, v183
v_mfma_f32_16x16x32_bf16 v[136:139], a[132:135], v[52:55], v[136:139]
v_exp_f32 v173, v173
v_mfma_f32_16x16x32_bf16 v[136:139], a[136:139], v[56:59], v[136:139]
buffer_load_dwordx4 v1, s[44:47], s72 offen offset:2048 sc1 lds
v_mfma_f32_16x16x32_bf16 v[136:139], a[140:143], v[60:63], v[136:139]
v_exp_f32 v174, v174
v_mfma_f32_16x16x32_bf16 v[152:155], a[156:159], v[60:63], v[88:91]
v_exp_f32 v175, v175
v_mfma_f32_16x16x32_bf16 v[152:155], a[152:155], v[56:59], v[152:155]
v_exp_f32 v188, v188
v_mfma_f32_16x16x32_bf16 v[152:155], a[148:151], v[52:55], v[152:155]
v_cvt_pk_bf16_f32 v220, v172, v173
v_cvt_pk_bf16_f32 v221, v174, v175
v_mfma_f32_16x16x32_bf16 v[152:155], a[144:147], v[48:51], v[152:155]
v_exp_f32 v189, v189
v_mfma_f32_16x16x32_bf16 v[132:135], a[132:135], v[36:39], v[132:135]
buffer_load_dwordx4 v1, s[44:47], s72 offen offset:3072 sc1 lds
v_mfma_f32_16x16x32_bf16 v[132:135], a[136:139], v[40:43], v[132:135]
s_add_u32 s66, s58, 1
v_exp_f32 v190, v190
v_mfma_f32_16x16x32_bf16 v[132:135], a[140:143], v[44:47], v[132:135]
s_and_b32 s66, s66, 3
v_exp_f32 v191, v191
v_mfma_f32_16x16x32_bf16 v[140:143], a[140:143], v[76:79], v[92:95]
s_mul_i32 s66, s66, 4160
v_exp_f32 v160, v160
v_mfma_f32_16x16x32_bf16 v[140:143], a[136:139], v[72:75], v[140:143]
s_add_u32 m0, s66, 131104
v_cvt_pk_bf16_f32 v222, v188, v189
v_cvt_pk_bf16_f32 v223, v190, v191
v_mfma_f32_16x16x32_bf16 v[140:143], a[132:135], v[68:71], v[140:143]
s_add_u32 s72, s93, 0x2
v_exp_f32 v161, v161
v_mfma_f32_16x16x32_bf16 v[140:143], a[128:131], v[64:67], v[140:143]
buffer_load_dwordx4 v1, s[36:39], s72 offen lds
v_mfma_f32_16x16x32_bf16 v[156:159], a[144:147], v[64:67], v[92:95]
v_exp_f32 v162, v162
v_mfma_f32_16x16x32_bf16 v[156:159], a[148:151], v[68:71], v[156:159]
v_exp_f32 v163, v163
v_mfma_f32_16x16x32_bf16 v[156:159], a[152:155], v[72:75], v[156:159]
buffer_load_dwordx4 v1, s[36:39], s72 offen offset:1024 lds
v_mfma_f32_16x16x32_bf16 v[156:159], a[156:159], v[76:79], v[156:159]
buffer_load_dwordx4 v1, s[36:39], s72 offen offset:2048 lds
v_mfma_f32_16x16x32_bf16 v[148:151], a[156:159], v[44:47], v[148:151]
buffer_load_dwordx4 v1, s[36:39], s72 offen offset:3072 lds
v_mfma_f32_16x16x32_bf16 v[148:151], a[152:155], v[40:43], v[148:151]
s_waitcnt vmcnt(12) lgkmcnt(4)
v_exp_f32 v176, v176
v_mfma_f32_16x16x32_bf16 v[148:151], a[148:151], v[36:39], v[148:151]
s_barrier
v_cvt_pk_bf16_f32 v208, v160, v161
v_cvt_pk_bf16_f32 v209, v162, v163
v_add_u32 v2, s82, v1
v_exp_f32 v177, v177
v_exp_f32 v178, v178
v_cvt_pk_bf16_f32 v210, v176, v177
v_exp_f32 v179, v179
v_exp_f32 v168, v168
v_cvt_pk_bf16_f32 v211, v178, v179
v_exp_f32 v169, v169
v_exp_f32 v170, v170
v_cvt_pk_bf16_f32 v216, v168, v169
v_exp_f32 v171, v171
v_exp_f32 v184, v184
v_cvt_pk_bf16_f32 v217, v170, v171
v_exp_f32 v185, v185
v_exp_f32 v186, v186
v_cvt_pk_bf16_f32 v218, v184, v185
v_exp_f32 v187, v187
s_nop 0
v_cvt_pk_bf16_f32 v219, v186, v187
s_branch LLT3
.p2align 12
s_endpgm
.p2align 7
LLT3x:
Lstub11:
s_cbranch_execz Lret
v_mfma_f32_16x16x32_bf16 v[228:231], v[120:123], v[196:199], v[228:231]
s_xor_b32 s74, s82, 0x10000
ds_read_b128 a[128:131], v2 offset:16384
v_mfma_f32_16x16x32_bf16 v[228:231], v[120:123], v[212:215], v[228:231]
s_add_u32 s74, s74, s64
v_exp_f32 v136, v136
v_mfma_f32_16x16x32_bf16 v[236:239], v[120:123], v[204:207], v[236:239]
s_add_u32 s81, s81, 0x8000
v_exp_f32 v137, v137
v_mfma_f32_16x16x32_bf16 v[236:239], v[120:123], v[220:223], v[236:239]
s_add_u32 m0, s74, 0
ds_read_b128 a[132:135], v2 offset:17408
v_cvt_pk_bf16_f32 v200, v136, v137
v_mfma_f32_16x16x32_bf16 a[32:35], a[192:195], v[196:199], a[32:35]
s_add_u32 s72, s81, 0
buffer_load_dwordx4 v1, s[44:47], s72 offen sc1 lds
v_mfma_f32_16x16x32_bf16 a[32:35], a[224:227], v[212:215], a[32:35]
s_add_u32 s69, s93, 0x3e00000
v_exp_f32 v138, v138
v_mfma_f32_16x16x32_bf16 a[96:99], a[224:227], v[220:223], a[96:99]
ds_read_b128 a[136:139], v2 offset:18432
v_and_b32 v240, 15, v0
v_mfma_f32_16x16x32_bf16 a[96:99], a[192:195], v[204:207], a[96:99]
v_exp_f32 v139, v139
v_mfma_f32_16x16x32_bf16 a[100:103], a[196:199], v[204:207], a[100:103]
buffer_store_dwordx4 v[112:115], v1, s[44:47], s69 offen sc1
v_mfma_f32_16x16x32_bf16 a[100:103], a[228:231], v[220:223], a[100:103]
v_exp_f32 v152, v152
v_mfma_f32_16x16x32_bf16 a[36:39], a[228:231], v[212:215], a[36:39]
ds_read_b128 a[140:143], v2 offset:19456
v_cvt_pk_bf16_f32 v201, v138, v139
v_mfma_f32_16x16x32_bf16 a[36:39], a[196:199], v[196:199], a[36:39]
v_exp_f32 v153, v153
v_mfma_f32_16x16x32_bf16 a[40:43], a[200:203], v[196:199], a[40:43]
buffer_load_dwordx4 v1, s[44:47], s72 offen offset:1024 sc1 lds
v_mfma_f32_16x16x32_bf16 a[40:43], a[232:235], v[212:215], a[40:43]
ds_read_b128 a[144:147], v2 offset:20480
v_cvt_pk_bf16_f32 v202, v152, v153
v_mfma_f32_16x16x32_bf16 a[104:107], a[232:235], v[220:223], a[104:107]
v_exp_f32 v154, v154
v_mfma_f32_16x16x32_bf16 a[104:107], a[200:203], v[204:207], a[104:107]
v_exp_f32 v155, v155
v_mfma_f32_16x16x32_bf16 a[108:111], a[204:207], v[204:207], a[108:111]
buffer_store_dwordx4 v[112:115], v1, s[44:47], s69 offen offset:1024 sc1
v_mfma_f32_16x16x32_bf16 a[108:111], a[236:239], v[220:223], a[108:111]
ds_read_b128 a[148:151], v2 offset:21504
v_cvt_pk_bf16_f32 v203, v154, v155
v_mfma_f32_16x16x32_bf16 a[44:47], a[236:239], v[212:215], a[44:47]
v_exp_f32 v132, v132
v_mfma_f32_16x16x32_bf16 a[44:47], a[204:207], v[196:199], a[44:47]
ds_read_b128 a[152:155], v2 offset:22528
v_lshrrev_b32 v241, 4, v0
v_mfma_f32_16x16x32_bf16 a[48:51], a[208:211], v[196:199], a[48:51]
s_waitcnt lgkmcnt(7)
v_exp_f32 v133, v133
v_mfma_f32_16x16x32_bf16 a[48:51], a[240:243], v[212:215], a[48:51]
buffer_load_dwordx4 v1, s[44:47], s72 offen offset:2048 sc1 lds
v_mfma_f32_16x16x32_bf16 a[112:115], a[240:243], v[220:223], a[112:115]
v_exp_f32 v134, v134
v_mfma_f32_16x16x32_bf16 a[112:115], a[208:211], v[204:207], a[112:115]
ds_read_b128 a[156:159], v2 offset:23552
v_add_u32 v248, 1, v240
v_mfma_f32_16x16x32_bf16 a[116:119], a[212:215], v[204:207], a[116:119]
v_exp_f32 v135, v135
v_mfma_f32_16x16x32_bf16 a[116:119], a[244:247], v[220:223], a[116:119]
buffer_store_dwordx4 v[112:115], v1, s[44:47], s69 offen offset:2048 sc1
v_mfma_f32_16x16x32_bf16 a[52:55], a[244:247], v[212:215], a[52:55]
ds_read_b128 a[192:195], v2 offset:0
v_and_b32 v249, 3, v248
v_mfma_f32_16x16x32_bf16 a[52:55], a[212:215], v[196:199], a[52:55]
v_exp_f32 v148, v148
v_mfma_f32_16x16x32_bf16 a[56:59], a[216:219], v[196:199], a[56:59]
buffer_load_dwordx4 v1, s[44:47], s72 offen offset:3072 sc1 lds
v_mfma_f32_16x16x32_bf16 a[56:59], a[248:251], v[212:215], a[56:59]
v_exp_f32 v149, v149
v_mfma_f32_16x16x32_bf16 a[120:123], a[248:251], v[220:223], a[120:123]
ds_read_b128 a[196:199], v2 offset:1024
v_lshrrev_b32 v248, 2, v248
v_mfma_f32_16x16x32_bf16 a[120:123], a[216:219], v[204:207], a[120:123]
v_exp_f32 v150, v150
v_mfma_f32_16x16x32_bf16 a[124:127], a[220:223], v[204:207], a[124:127]
ds_read_b128 a[200:203], v2 offset:2048
v_mov_b32 v250, 0x20000
v_mfma_f32_16x16x32_bf16 a[124:127], a[252:255], v[220:223], a[124:127]
buffer_store_dwordx4 v[112:115], v1, s[44:47], s69 offen offset:3072 sc1
v_mfma_f32_16x16x32_bf16 a[60:63], a[252:255], v[212:215], a[60:63]
s_add_u32 s69, s93, 0x4200000
v_exp_f32 v151, v151
v_mfma_f32_16x16x32_bf16 a[60:63], a[220:223], v[196:199], a[60:63]
ds_read_b128 a[204:207], v2 offset:3072
v_cvt_pk_bf16_f32 v196, v132, v133
s_cmp_eq_u32 s58, 2
s_cbranch_scc1 Lta40
s_cmp_eq_u32 s58, 3
s_cbranch_scc1 Lnt41
v_mfma_f32_16x16x32_bf16 v[164:167], a[160:163], v[32:35], v[112:115]
ds_read_b128 a[208:211], v2 offset:4096
v_cvt_pk_bf16_f32 v197, v134, v135
v_mfma_f32_16x16x32_bf16 v[180:183], a[176:179], v[32:35], v[112:115]
v_exp_f32 v140, v140
s_branch Ljoin42
Lta40:
v_mfma_f32_16x16x32_bf16 v[164:167], a[160:163], v[32:35], v[100:103]
ds_read_b128 a[208:211], v2 offset:4096
v_cvt_pk_bf16_f32 v197, v134, v135
v_mfma_f32_16x16x32_bf16 v[180:183], a[176:179], v[32:35], v[112:115]
v_exp_f32 v140, v140
s_branch Ljoin42
Lnt41:
v_mfma_f32_16x16x32_bf16 v[164:167], a[160:163], v[32:35], v[84:87]
ds_read_b128 a[208:211], v2 offset:4096
v_cvt_pk_bf16_f32 v197, v134, v135
v_mfma_f32_16x16x32_bf16 v[180:183], a[176:179], v[32:35], v[100:103]
v_exp_f32 v140, v140
Ljoin42:
v_mfma_f32_16x16x32_bf16 v[164:167], a[164:167], v[36:39], v[164:167]
ds_read_b128 a[212:215], v2 offset:5120
v_cvt_pk_bf16_f32 v198, v148, v149
v_mfma_f32_16x16x32_bf16 v[164:167], a[168:171], v[40:43], v[164:167]
buffer_store_dwordx4 v[112:115], v1, s[44:47], s69 offen sc1
v_mfma_f32_16x16x32_bf16 v[164:167], a[172:175], v[44:47], v[164:167]
v_exp_f32 v141, v141
v_mfma_f32_16x16x32_bf16 v[172:175], a[172:175], v[76:79], v[92:95]
v_exp_f32 v142, v142
v_mfma_f32_16x16x32_bf16 v[172:175], a[168:171], v[72:75], v[172:175]
ds_read_b128 a[216:219], v2 offset:6144
v_cvt_pk_bf16_f32 v199, v150, v151
v_mfma_f32_16x16x32_bf16 v[172:175], a[164:167], v[68:71], v[172:175]
buffer_store_dwordx4 v[112:115], v1, s[44:47], s69 offen offset:1024 sc1
v_mfma_f32_16x16x32_bf16 v[172:175], a[160:163], v[64:67], v[172:175]
v_exp_f32 v143, v143
v_mfma_f32_16x16x32_bf16 v[188:191], a[176:179], v[64:67], v[92:95]
v_exp_f32 v156, v156
v_mfma_f32_16x16x32_bf16 v[188:191], a[180:183], v[68:71], v[188:191]
ds_read_b128 a[220:223], v2 offset:7168
v_cvt_pk_bf16_f32 v204, v140, v141
v_mfma_f32_16x16x32_bf16 v[188:191], a[184:187], v[72:75], v[188:191]
buffer_store_dwordx4 v[112:115], v1, s[44:47], s69 offen offset:2048 sc1
v_mfma_f32_16x16x32_bf16 v[188:191], a[188:191], v[76:79], v[188:191]
v_exp_f32 v157, v157
v_mfma_f32_16x16x32_bf16 v[180:183], a[188:191], v[44:47], v[180:183]
v_exp_f32 v158, v158
v_mfma_f32_16x16x32_bf16 v[180:183], a[184:187], v[40:43], v[180:183]
v_cvt_pk_bf16_f32 v205, v142, v143
v_cvt_pk_bf16_f32 v206, v156, v157
v_mfma_f32_16x16x32_bf16 v[180:183], a[180:183], v[36:39], v[180:183]
buffer_store_dwordx4 v[112:115], v1, s[44:47], s69 offen offset:3072 sc1
v_mfma_f32_16x16x32_bf16 v[168:171], a[160:163], v[48:51], v[88:91]
v_exp_f32 v159, v159
v_mfma_f32_16x16x32_bf16 v[168:171], a[164:167], v[52:55], v[168:171]
v_cvt_pk_bf16_f32 v207, v158, v159
v_mov_b32 v252, 0x20001
v_mfma_f32_16x16x32_bf16 v[168:171], a[168:171], v[56:59], v[168:171]
v_lshlrev_b32 v6, 3, v249
v_lshrrev_b32 v6, v6, v252
v_mfma_f32_16x16x32_bf16 v[168:171], a[172:175], v[60:63], v[168:171]
v_and_b32 v6, 3, v6
v_cmp_ne_u32 vcc, 1, v249
v_mfma_f32_16x16x32_bf16 v[184:187], a[188:191], v[60:63], v[88:91]
v_mul_u32_u24 v6, 16640, v6
v_add_u32 v6, s92, v6
v_mfma_f32_16x16x32_bf16 v[184:187], a[184:187], v[56:59], v[184:187]
v_cndmask_b32 v6, v250, v6, vcc
v_add_u32 v253, s58, v249
v_mfma_f32_16x16x32_bf16 v[184:187], a[180:183], v[52:55], v[184:187]
s_waitcnt lgkmcnt(4)
v_mfma_f32_16x16x32_bf16 v[184:187], a[176:179], v[48:51], v[184:187]
s_barrier
s_lshr_b32 s69, s93, 4
s_and_b32 s69, s69, 0x7f00
s_add_u32 s69, s69, LHT4-Lpc0
v_lshrrev_b32 v3, 5, v0
v_lshlrev_b32 v3, 7, v3
v_add_u32 v3, s69, v3
v_min_u32 v3, Lcode_end-Lpc0, v3
global_load_dword v4, v3, s[98:99]
v_mfma_f32_16x16x32_bf16 v[224:227], v[120:123], v[208:211], v[224:227]
s_add_u32 s82, s82, 0x8000
ds_read_b128 a[160:163], v2 offset:24576
ds_read_b128 a[164:167], v2 offset:25600
v_mfma_f32_16x16x32_bf16 v[232:235], v[120:123], v[216:219], v[232:235]
s_and_b32 s82, s82, 0x1ffff
v_exp_f32 v164, v164
v_mfma_f32_16x16x32_bf16 v[232:235], v[120:123], v[200:203], v[232:235]
s_add_u32 s66, s58, 3
v_exp_f32 v165, v165
v_mfma_f32_16x16x32_bf16 a[0:3], a[224:227], v[208:211], a[0:3]
s_and_b32 s66, s66, 3
v_exp_f32 v166, v166
v_mfma_f32_16x16x32_bf16 a[64:67], a[192:195], v[200:203], a[64:67]
s_mul_i32 s66, s66, 4160
ds_read_b128 a[168:171], v2 offset:26624
v_cvt_pk_bf16_f32 v212, v164, v165
v_mfma_f32_16x16x32_bf16 a[64:67], a[224:227], v[216:219], a[64:67]
s_add_u32 s66, s66, s92
v_exp_f32 v167, v167
v_mfma_f32_16x16x32_bf16 a[68:71], a[228:231], v[216:219], a[68:71]
s_add_u32 m0, s66, 32
v_exp_f32 v180, v180
v_mfma_f32_16x16x32_bf16 a[68:71], a[196:199], v[200:203], a[68:71]
s_add_u32 s72, s93, 0x6
buffer_load_dwordx4 v1, s[36:39], s72 offen lds
v_mfma_f32_16x16x32_bf16 a[4:7], a[228:231], v[208:211], a[4:7]
ds_read_b128 a[172:175], v2 offset:27648
v_cvt_pk_bf16_f32 v213, v166, v167
v_mfma_f32_16x16x32_bf16 a[8:11], a[232:235], v[208:211], a[8:11]
v_exp_f32 v181, v181
v_mfma_f32_16x16x32_bf16 a[72:75], a[200:203], v[200:203], a[72:75]
ds_read_b128 a[176:179], v2 offset:28672
v_cvt_pk_bf16_f32 v214, v180, v181
v_mfma_f32_16x16x32_bf16 a[72:75], a[232:235], v[216:219], a[72:75]
v_exp_f32 v182, v182
v_mfma_f32_16x16x32_bf16 a[76:79], a[236:239], v[216:219], a[76:79]
v_exp_f32 v183, v183
v_mfma_f32_16x16x32_bf16 a[76:79], a[204:207], v[200:203], a[76:79]
ds_read_b128 a[180:183], v2 offset:29696
v_cvt_pk_bf16_f32 v215, v182, v183
v_mfma_f32_16x16x32_bf16 a[12:15], a[236:239], v[208:211], a[12:15]
v_exp_f32 v172, v172
v_mfma_f32_16x16x32_bf16 a[16:19], a[240:243], v[208:211], a[16:19]
s_waitcnt lgkmcnt(6)
ds_read_b128 a[184:187], v2 offset:30720
ds_read_b128 a[188:191], v2 offset:31744
v_mfma_f32_16x16x32_bf16 a[80:83], a[208:211], v[200:203], a[80:83]
v_exp_f32 v173, v173
v_mfma_f32_16x16x32_bf16 a[80:83], a[240:243], v[216:219], a[80:83]
buffer_load_dwordx4 v1, s[36:39], s72 offen offset:1024 lds
v_mfma_f32_16x16x32_bf16 a[84:87], a[244:247], v[216:219], a[84:87]
v_exp_f32 v174, v174
v_mfma_f32_16x16x32_bf16 a[84:87], a[212:215], v[200:203], a[84:87]
v_exp_f32 v175, v175
v_mfma_f32_16x16x32_bf16 a[20:23], a[244:247], v[208:211], a[20:23]
ds_read_b128 a[224:227], v2 offset:8192
v_cvt_pk_bf16_f32 v220, v172, v173
v_mfma_f32_16x16x32_bf16 a[24:27], a[248:251], v[208:211], a[24:27]
v_exp_f32 v188, v188
v_mfma_f32_16x16x32_bf16 a[88:91], a[216:219], v[200:203], a[88:91]
v_exp_f32 v189, v189
v_mfma_f32_16x16x32_bf16 a[88:91], a[248:251], v[216:219], a[88:91]
ds_read_b128 a[228:231], v2 offset:9216
v_cvt_pk_bf16_f32 v221, v174, v175
v_mfma_f32_16x16x32_bf16 a[92:95], a[252:255], v[216:219], a[92:95]
v_exp_f32 v190, v190
v_mfma_f32_16x16x32_bf16 a[92:95], a[220:223], v[200:203], a[92:95]
ds_read_b128 a[232:235], v2 offset:10240
v_cvt_pk_bf16_f32 v222, v188, v189
v_mfma_f32_16x16x32_bf16 a[28:31], a[252:255], v[208:211], a[28:31]
v_exp_f32 v191, v191
s_cmp_eq_u32 s58, 0
s_cbranch_scc1 Lta43
s_cmp_eq_u32 s58, 1
s_cbranch_scc1 Lnt44
v_mfma_f32_16x16x32_bf16 v[136:139], a[128:131], v[48:51], v[88:91]
buffer_load_dwordx4 v1, s[36:39], s72 offen offset:2048 lds
v_mfma_f32_16x16x32_bf16 v[152:155], a[144:147], v[48:51], v[88:91]
v_exp_f32 v168, v168
s_branch Ljoin45
Lta43:
v_mfma_f32_16x16x32_bf16 v[136:139], a[128:131], v[48:51], v[104:107]
buffer_load_dwordx4 v1, s[36:39], s72 offen offset:2048 lds
v_mfma_f32_16x16x32_bf16 v[152:155], a[144:147], v[48:51], v[112:115]
v_exp_f32 v168, v168
s_branch Ljoin45
Lnt44:
v_mfma_f32_16x16x32_bf16 v[136:139], a[128:131], v[48:51], v[88:91]
buffer_load_dwordx4 v1, s[36:39], s72 offen offset:2048 lds
v_mfma_f32_16x16x32_bf16 v[152:155], a[144:147], v[48:51], v[104:107]
v_exp_f32 v168, v168
Ljoin45:
v_mfma_f32_16x16x32_bf16 v[136:139], a[132:135], v[52:55], v[136:139]
ds_read_b128 a[236:239], v2 offset:11264
v_cvt_pk_bf16_f32 v223, v190, v191
v_mfma_f32_16x16x32_bf16 v[136:139], a[136:139], v[56:59], v[136:139]
v_exp_f32 v169, v169
v_mfma_f32_16x16x32_bf16 v[136:139], a[140:143], v[60:63], v[136:139]
ds_read_b128 a[240:243], v2 offset:12288
v_cvt_pk_bf16_f32 v216, v168, v169
v_mfma_f32_16x16x32_bf16 v[152:155], a[156:159], v[60:63], v[152:155]
v_exp_f32 v170, v170
v_mfma_f32_16x16x32_bf16 v[152:155], a[152:155], v[56:59], v[152:155]
v_exp_f32 v171, v171
v_mfma_f32_16x16x32_bf16 v[152:155], a[148:151], v[52:55], v[152:155]
ds_read_b128 a[244:247], v2 offset:13312
v_cvt_pk_bf16_f32 v217, v170, v171
v_mfma_f32_16x16x32_bf16 v[140:143], a[128:131], v[64:67], v[92:95]
v_exp_f32 v184, v184
v_mfma_f32_16x16x32_bf16 v[140:143], a[132:135], v[68:71], v[140:143]
ds_read_b128 a[248:251], v2 offset:14336
v_mfma_f32_16x16x32_bf16 v[140:143], a[136:139], v[72:75], v[140:143]
v_exp_f32 v185, v185
v_mfma_f32_16x16x32_bf16 v[140:143], a[140:143], v[76:79], v[140:143]
buffer_load_dwordx4 v1, s[36:39], s72 offen offset:3072 lds
v_mfma_f32_16x16x32_bf16 v[156:159], a[156:159], v[76:79], v[92:95]
ds_read_b128 a[252:255], v2 offset:15360
v_cvt_pk_bf16_f32 v218, v184, v185
v_mfma_f32_16x16x32_bf16 v[156:159], a[152:155], v[72:75], v[156:159]
v_exp_f32 v186, v186
v_mfma_f32_16x16x32_bf16 v[156:159], a[148:151], v[68:71], v[156:159]
s_waitcnt vmcnt(17) lgkmcnt(0)
v_exp_f32 v187, v187
v_mfma_f32_16x16x32_bf16 v[156:159], a[144:147], v[64:67], v[156:159]
s_barrier
v_cvt_pk_bf16_f32 v219, v186, v187
v_add_u32 v2, s82, v1
v_mfma_f32_16x16x32_bf16 v[228:231], v[120:123], v[196:199], v[228:231]
s_mov_b32 m0, s62
v_exp_f32 v136, v136
v_mfma_f32_16x16x32_bf16 v[228:231], v[120:123], v[212:215], v[228:231]
s_add_u32 s72, s93, 0x3000000
ds_read_b128 a[128:131], v2 offset:16384
v_mfma_f32_16x16x32_bf16 v[236:239], v[120:123], v[204:207], v[236:239]
buffer_load_dwordx4 v1, s[44:47], s72 offen sc1 lds
v_mfma_f32_16x16x32_bf16 v[236:239], v[120:123], v[220:223], v[236:239]
v_exp_f32 v137, v137
v_mfma_f32_16x16x32_bf16 a[32:35], a[192:195], v[196:199], a[32:35]
ds_read_b128 a[132:135], v2 offset:17408
v_cvt_pk_bf16_f32 v200, v136, v137
v_mfma_f32_16x16x32_bf16 a[32:35], a[224:227], v[212:215], a[32:35]
v_exp_f32 v138, v138
v_mfma_f32_16x16x32_bf16 a[96:99], a[224:227], v[220:223], a[96:99]
ds_read_b128 a[136:139], v2 offset:18432
v_and_b32 v253, 3, v253
v_mfma_f32_16x16x32_bf16 a[96:99], a[192:195], v[204:207], a[96:99]
buffer_load_dwordx4 v1, s[44:47], s72 offen offset:1024 sc1 lds
v_mfma_f32_16x16x32_bf16 a[100:103], a[196:199], v[204:207], a[100:103]
v_exp_f32 v139, v139
v_mfma_f32_16x16x32_bf16 a[100:103], a[228:231], v[220:223], a[100:103]
ds_read_b128 a[140:143], v2 offset:19456
v_cvt_pk_bf16_f32 v201, v138, v139
v_mfma_f32_16x16x32_bf16 a[36:39], a[228:231], v[212:215], a[36:39]
v_exp_f32 v152, v152
v_mfma_f32_16x16x32_bf16 a[36:39], a[196:199], v[196:199], a[36:39]
ds_read_b128 a[144:147], v2 offset:20480
v_mul_u32_u24 v253, 4160, v253
v_mfma_f32_16x16x32_bf16 a[40:43], a[200:203], v[196:199], a[40:43]
buffer_load_dwordx4 v1, s[44:47], s72 offen offset:2048 sc1 lds
v_mfma_f32_16x16x32_bf16 a[40:43], a[232:235], v[212:215], a[40:43]
v_exp_f32 v153, v153
v_mfma_f32_16x16x32_bf16 a[104:107], a[232:235], v[220:223], a[104:107]
ds_read_b128 a[148:151], v2 offset:21504
v_cvt_pk_bf16_f32 v202, v152, v153
v_mfma_f32_16x16x32_bf16 a[104:107], a[200:203], v[204:207], a[104:107]
buffer_load_dwordx4 v1, s[44:47], s72 offen offset:3072 sc1 lds
v_mfma_f32_16x16x32_bf16 a[108:111], a[204:207], v[204:207], a[108:111]
s_add_u32 s66, s58, 0
v_exp_f32 v154, v154
v_mfma_f32_16x16x32_bf16 a[108:111], a[236:239], v[220:223], a[108:111]
s_and_b32 s66, s66, 3
ds_read_b128 a[152:155], v2 offset:22528
v_add_u32 v6, v6, v253
v_mfma_f32_16x16x32_bf16 a[44:47], a[236:239], v[212:215], a[44:47]
s_mul_i32 s66, s66, 4160
v_exp_f32 v155, v155
v_mfma_f32_16x16x32_bf16 a[44:47], a[204:207], v[196:199], a[44:47]
s_add_u32 s66, s66, s92
ds_read_b128 a[156:159], v2 offset:23552
v_cvt_pk_bf16_f32 v203, v154, v155
v_mfma_f32_16x16x32_bf16 a[48:51], a[208:211], v[196:199], a[48:51]
s_waitcnt lgkmcnt(8)
v_exp_f32 v140, v140
v_mfma_f32_16x16x32_bf16 a[48:51], a[240:243], v[212:215], a[48:51]
s_add_u32 m0, s66, 16672
ds_read_b128 a[192:195], v2 offset:0
v_bfe_u32 v251, v0, 2, 2
v_mfma_f32_16x16x32_bf16 a[112:115], a[240:243], v[220:223], a[112:115]
s_add_u32 s72, s93, 0x0
buffer_load_dwordx4 v1, s[36:39], s72 offen lds
v_mfma_f32_16x16x32_bf16 a[112:115], a[208:211], v[204:207], a[112:115]
buffer_load_dwordx4 v1, s[36:39], s72 offen offset:1024 lds
v_mfma_f32_16x16x32_bf16 a[116:119], a[212:215], v[204:207], a[116:119]
v_exp_f32 v141, v141
v_mfma_f32_16x16x32_bf16 a[116:119], a[244:247], v[220:223], a[116:119]
ds_read_b128 a[196:199], v2 offset:1024
v_lshl_add_u32 v6, v248, 3, v6
v_mfma_f32_16x16x32_bf16 a[52:55], a[244:247], v[212:215], a[52:55]
v_exp_f32 v142, v142
v_mfma_f32_16x16x32_bf16 a[52:55], a[212:215], v[196:199], a[52:55]
ds_read_b128 a[200:203], v2 offset:2048
v_lshl_add_u32 v6, v241, 4, v6
v_mfma_f32_16x16x32_bf16 a[56:59], a[216:219], v[196:199], a[56:59]
buffer_load_dwordx4 v1, s[36:39], s72 offen offset:2048 lds
v_mfma_f32_16x16x32_bf16 a[56:59], a[248:251], v[212:215], a[56:59]
v_exp_f32 v143, v143
v_mfma_f32_16x16x32_bf16 a[120:123], a[248:251], v[220:223], a[120:123]
ds_read_b128 a[204:207], v2 offset:3072
v_lshlrev_b32 v5, 3, v251
v_mfma_f32_16x16x32_bf16 a[120:123], a[216:219], v[204:207], a[120:123]
v_exp_f32 v156, v156
v_mfma_f32_16x16x32_bf16 a[124:127], a[220:223], v[204:207], a[124:127]
ds_read_b128 a[208:211], v2 offset:4096
v_lshrrev_b32 v5, v5, v252
v_mfma_f32_16x16x32_bf16 a[124:127], a[252:255], v[220:223], a[124:127]
buffer_load_dwordx4 v1, s[36:39], s72 offen offset:3072 lds
v_mfma_f32_16x16x32_bf16 a[60:63], a[252:255], v[212:215], a[60:63]
s_add_u32 s66, s58, 2
v_exp_f32 v157, v157
v_mfma_f32_16x16x32_bf16 a[60:63], a[220:223], v[196:199], a[60:63]
s_and_b32 s66, s66, 3
ds_read_b128 a[212:215], v2 offset:5120
v_cvt_pk_bf16_f32 v204, v140, v141
s_cmp_eq_u32 s58, 2
s_cbranch_scc1 Lta46
s_cmp_eq_u32 s58, 3
s_cbranch_scc1 Lnt47
v_mfma_f32_16x16x32_bf16 v[168:171], a[160:163], v[48:51], v[112:115]
s_mul_i32 s66, s66, 4160
v_exp_f32 v158, v158
v_mfma_f32_16x16x32_bf16 v[184:187], a[176:179], v[48:51], v[112:115]
s_add_u32 s66, s66, s92
ds_read_b128 a[216:219], v2 offset:6144
v_cvt_pk_bf16_f32 v205, v142, v143
s_branch Ljoin48
Lta46:
v_mfma_f32_16x16x32_bf16 v[168:171], a[160:163], v[48:51], v[104:107]
s_mul_i32 s66, s66, 4160
v_exp_f32 v158, v158
v_mfma_f32_16x16x32_bf16 v[184:187], a[176:179], v[48:51], v[112:115]
s_add_u32 s66, s66, s92
ds_read_b128 a[216:219], v2 offset:6144
v_cvt_pk_bf16_f32 v205, v142, v143
s_branch Ljoin48
Lnt47:
v_mfma_f32_16x16x32_bf16 v[168:171], a[160:163], v[48:51], v[88:91]
s_mul_i32 s66, s66, 4160
v_exp_f32 v158, v158
v_mfma_f32_16x16x32_bf16 v[184:187], a[176:179], v[48:51], v[104:107]
s_add_u32 s66, s66, s92
ds_read_b128 a[216:219], v2 offset:6144
v_cvt_pk_bf16_f32 v205, v142, v143
Ljoin48:
v_mfma_f32_16x16x32_bf16 v[172:175], a[160:163], v[64:67], v[92:95]
s_add_u32 m0, s66, 33312
v_exp_f32 v159, v159
v_mfma_f32_16x16x32_bf16 v[172:175], a[164:167], v[68:71], v[172:175]
s_add_u32 s72, s93, 0x4
buffer_load_dwordx4 v1, s[36:39], s72 offen lds
v_mfma_f32_16x16x32_bf16 v[172:175], a[168:171], v[72:75], v[172:175]
ds_read_b128 a[220:223], v2 offset:7168
v_cvt_pk_bf16_f32 v206, v156, v157
v_mfma_f32_16x16x32_bf16 v[172:175], a[172:175], v[76:79], v[172:175]
buffer_load_dwordx4 v1, s[36:39], s72 offen offset:1024 lds
v_mfma_f32_16x16x32_bf16 v[188:191], a[188:191], v[76:79], v[92:95]
v_cvt_pk_bf16_f32 v207, v158, v159
v_and_b32 v5, 3, v5
v_mfma_f32_16x16x32_bf16 v[188:191], a[184:187], v[72:75], v[188:191]
v_cmp_ne_u32 vcc, 1, v251
v_mul_u32_u24 v5, 16640, v5
v_mfma_f32_16x16x32_bf16 v[188:191], a[180:183], v[68:71], v[188:191]
v_add_u32 v5, s92, v5
v_cndmask_b32 v5, v250, v5, vcc
v_mfma_f32_16x16x32_bf16 v[188:191], a[176:179], v[64:67], v[188:191]
v_add_u32 v253, s58, v251
v_and_b32 v253, 3, v253
v_mfma_f32_16x16x32_bf16 v[168:171], a[164:167], v[52:55], v[168:171]
v_mul_u32_u24 v253, 4160, v253
v_add_u32 v5, v5, v253
v_mfma_f32_16x16x32_bf16 v[168:171], a[168:171], v[56:59], v[168:171]
s_add_u32 s73, s62, 480
v_lshlrev_b32 v248, 5, v240
v_sub_u32 v248, s73, v248
v_mfma_f32_16x16x32_bf16 v[168:171], a[172:175], v[60:63], v[168:171]
v_lshl_add_u32 v7, v241, 4, v248
v_mfma_f32_16x16x32_bf16 v[184:187], a[188:191], v[60:63], v[184:187]
s_and_b32 s73, s58, 1
v_mfma_f32_16x16x32_bf16 v[184:187], a[184:187], v[56:59], v[184:187]
s_lshl_b32 s73, s73, 4
v_mfma_f32_16x16x32_bf16 v[184:187], a[180:183], v[52:55], v[184:187]
s_waitcnt lgkmcnt(4)
s_lshr_b32 s73, s90, s73
s_and_b32 s73, s73, 0xffff
v_lshl_add_u32 v248, v241, 3, v240
v_sub_u32 v248, 15, v248
v_and_b32 v249, 1, v248
v_lshlrev_b32 v249, 4, v249
v_lshlrev_b32 v249, v249, s73
v_lshrrev_b32 v248, 1, v248
v_and_b32 v241, 3, v0
v_cmp_eq_u32 vcc, 0, v248
v_lshl_add_u32 v5, v241, 3, v5
s_nop 0
v_cndmask_b32 v8, 0, v249, vcc
v_cmp_eq_u32 vcc, 1, v248
v_lshlrev_b32 v240, 4, v251
s_nop 0
v_cndmask_b32 v9, 0, v249, vcc
v_cmp_eq_u32 vcc, 2, v248
v_sub_u32 v240, 48, v240
v_lshlrev_b64 v[12:13], 16, s[88:89]
v_cndmask_b32 v10, 0, v249, vcc
v_cmp_eq_u32 vcc, 3, v248
v_lshlrev_b64 v[12:13], v240, v[12:13]
s_nop 0
v_cndmask_b32 v11, 0, v249, vcc
v_cmp_eq_u32 vcc, 3, v241
s_add_u32 s73, s62, 4096
v_lshl_add_u32 v14, v0, 3, s73
v_cndmask_b32 v12, 0, v12, vcc
v_cndmask_b32 v13, 0, v13, vcc
v_lshrrev_b32 v15, 4, v0
v_lshlrev_b32 v15, 1, v15
v_and_b32 v240, 7, v0
v_xor_b32 v15, v15, v240
v_lshlrev_b32 v15, 4, v15
v_lshrrev_b32 v240, 3, v0
v_lshl_add_u32 v15, v240, 11, v15
s_lshr_b32 s75, s59, 1
s_and_b32 s75, s75, 8
s_add_u32 s75, s75, s60
s_lshl_b32 s76, s65, 2
s_lshr_b32 s80, s59, 2
s_and_b32 s80, s80, 3
s_add_u32 s76, s76, s80
s_lshl_b32 s94, s58, 16
s_lshl_b32 s80, s76, 7
s_add_u32 s94, s94, s80
s_lshl_b32 s80, s75, 18
s_add_u32 s80, s80, s94
v_rcp_f32 v224, v224
v_rcp_f32 v228, v228
s_lshl_b32 s73, s59, 12
s_add_u32 s73, s73, 0x2000000
s_lshl_b32 s70, s67, 2
s_add_u32 s70, s70, s73
v_mov_b32 v225, v224
v_accvgpr_read_b32 v240, a0
v_accvgpr_read_b32 v241, a1
v_accvgpr_read_b32 v242, a2
v_accvgpr_read_b32 v243, a3
v_accvgpr_read_b32 v244, a4
v_accvgpr_read_b32 v245, a5
v_accvgpr_read_b32 v246, a6
v_accvgpr_read_b32 v247, a7
v_pk_mul_f32 v[240:241], v[240:241], v[224:225]
v_pk_mul_f32 v[242:243], v[242:243], v[224:225]
v_pk_mul_f32 v[244:245], v[244:245], v[224:225]
v_pk_mul_f32 v[246:247], v[246:247], v[224:225]
buffer_load_dwordx4 v1, s[36:39], s72 offen offset:2048 lds
v_cvt_pk_bf16_f32 v128, v240, v241
v_cvt_pk_bf16_f32 v129, v242, v243
v_cvt_pk_bf16_f32 v130, v244, v245
v_cvt_pk_bf16_f32 v131, v246, v247
v_accvgpr_read_b32 v248, a8
v_accvgpr_read_b32 v249, a9
v_accvgpr_read_b32 v250, a10
v_accvgpr_read_b32 v251, a11
v_accvgpr_read_b32 v252, a12
v_accvgpr_read_b32 v253, a13
v_accvgpr_read_b32 v254, a14
v_accvgpr_read_b32 v255, a15
v_pk_mul_f32 v[248:249], v[248:249], v[224:225]
v_pk_mul_f32 v[250:251], v[250:251], v[224:225]
v_pk_mul_f32 v[252:253], v[252:253], v[224:225]
v_pk_mul_f32 v[254:255], v[254:255], v[224:225]
v_cvt_pk_bf16_f32 v144, v248, v249
v_cvt_pk_bf16_f32 v145, v250, v251
buffer_load_dwordx4 v1, s[36:39], s72 offen offset:3072 lds
v_cvt_pk_bf16_f32 v146, v252, v253
v_cvt_pk_bf16_f32 v147, v254, v255
v_accvgpr_read_b32 v240, a16
v_accvgpr_read_b32 v241, a17
v_accvgpr_read_b32 v242, a18
v_accvgpr_read_b32 v243, a19
v_accvgpr_read_b32 v244, a20
v_accvgpr_read_b32 v245, a21
v_accvgpr_read_b32 v246, a22
v_accvgpr_read_b32 v247, a23
v_pk_mul_f32 v[240:241], v[240:241], v[224:225]
v_pk_mul_f32 v[242:243], v[242:243], v[224:225]
v_pk_mul_f32 v[244:245], v[244:245], v[224:225]
v_pk_mul_f32 v[246:247], v[246:247], v[224:225]
v_cvt_pk_bf16_f32 v160, v240, v241
v_cvt_pk_bf16_f32 v161, v242, v243
v_cvt_pk_bf16_f32 v162, v244, v245
v_cvt_pk_bf16_f32 v163, v246, v247
buffer_load_dwordx4 v[80:83], v15, s[4:7], s80 offen
v_accvgpr_read_b32 v248, a24
v_accvgpr_read_b32 v249, a25
v_accvgpr_read_b32 v250, a26
v_accvgpr_read_b32 v251, a27
v_accvgpr_read_b32 v252, a28
v_accvgpr_read_b32 v253, a29
v_accvgpr_read_b32 v254, a30
v_accvgpr_read_b32 v255, a31
v_pk_mul_f32 v[248:249], v[248:249], v[224:225]
v_pk_mul_f32 v[250:251], v[250:251], v[224:225]
v_pk_mul_f32 v[252:253], v[252:253], v[224:225]
v_pk_mul_f32 v[254:255], v[254:255], v[224:225]
v_cvt_pk_bf16_f32 v176, v248, v249
v_cvt_pk_bf16_f32 v177, v250, v251
v_cvt_pk_bf16_f32 v178, v252, v253
v_cvt_pk_bf16_f32 v179, v254, v255
v_mov_b32 v229, v228
v_accvgpr_read_b32 v240, a32
s_add_u32 s80, s80, 0x4000
buffer_load_dwordx4 v[84:87], v15, s[4:7], s80 offen
v_accvgpr_read_b32 v241, a33
v_accvgpr_read_b32 v242, a34
v_accvgpr_read_b32 v243, a35
v_accvgpr_read_b32 v244, a36
v_accvgpr_read_b32 v245, a37
v_accvgpr_read_b32 v246, a38
v_accvgpr_read_b32 v247, a39
v_pk_mul_f32 v[240:241], v[240:241], v[228:229]
v_pk_mul_f32 v[242:243], v[242:243], v[228:229]
v_pk_mul_f32 v[244:245], v[244:245], v[228:229]
v_pk_mul_f32 v[246:247], v[246:247], v[228:229]
v_cvt_pk_bf16_f32 v132, v240, v241
v_cvt_pk_bf16_f32 v133, v242, v243
v_cvt_pk_bf16_f32 v134, v244, v245
v_cvt_pk_bf16_f32 v135, v246, v247
v_accvgpr_read_b32 v248, a40
v_accvgpr_read_b32 v249, a41
v_accvgpr_read_b32 v250, a42
s_add_u32 s80, s80, 0x4000
buffer_load_dwordx4 v[96:99], v15, s[4:7], s80 offen
v_accvgpr_read_b32 v251, a43
v_accvgpr_read_b32 v252, a44
v_accvgpr_read_b32 v253, a45
v_accvgpr_read_b32 v254, a46
v_accvgpr_read_b32 v255, a47
v_pk_mul_f32 v[248:249], v[248:249], v[228:229]
v_pk_mul_f32 v[250:251], v[250:251], v[228:229]
v_pk_mul_f32 v[252:253], v[252:253], v[228:229]
v_pk_mul_f32 v[254:255], v[254:255], v[228:229]
v_cvt_pk_bf16_f32 v148, v248, v249
v_cvt_pk_bf16_f32 v149, v250, v251
v_cvt_pk_bf16_f32 v150, v252, v253
v_cvt_pk_bf16_f32 v151, v254, v255
v_accvgpr_read_b32 v240, a48
v_accvgpr_read_b32 v241, a49
v_accvgpr_read_b32 v242, a50
v_accvgpr_read_b32 v243, a51
v_accvgpr_read_b32 v244, a52
s_add_u32 s80, s80, 0x4000
buffer_load_dwordx4 v[100:103], v15, s[4:7], s80 offen
v_accvgpr_read_b32 v245, a53
v_accvgpr_read_b32 v246, a54
v_accvgpr_read_b32 v247, a55
v_pk_mul_f32 v[240:241], v[240:241], v[228:229]
v_pk_mul_f32 v[242:243], v[242:243], v[228:229]
v_pk_mul_f32 v[244:245], v[244:245], v[228:229]
v_pk_mul_f32 v[246:247], v[246:247], v[228:229]
v_cvt_pk_bf16_f32 v164, v240, v241
v_cvt_pk_bf16_f32 v165, v242, v243
v_cvt_pk_bf16_f32 v166, v244, v245
v_cvt_pk_bf16_f32 v167, v246, v247
v_accvgpr_read_b32 v248, a56
v_accvgpr_read_b32 v249, a57
v_accvgpr_read_b32 v250, a58
v_accvgpr_read_b32 v251, a59
v_accvgpr_read_b32 v252, a60
v_accvgpr_read_b32 v253, a61
v_accvgpr_read_b32 v254, a62
v_accvgpr_read_b32 v255, a63
v_pk_mul_f32 v[248:249], v[248:249], v[228:229]
v_pk_mul_f32 v[250:251], v[250:251], v[228:229]
v_pk_mul_f32 v[252:253], v[252:253], v[228:229]
v_pk_mul_f32 v[254:255], v[254:255], v[228:229]
v_cvt_pk_bf16_f32 v180, v248, v249
v_cvt_pk_bf16_f32 v181, v250, v251
v_cvt_pk_bf16_f32 v182, v252, v253
v_cvt_pk_bf16_f32 v183, v254, v255
v_mfma_f32_16x16x32_bf16 v[232:235], v[120:123], v[216:219], v[232:235]
s_add_u32 s82, s82, 0x8000
ds_read_b128 a[160:163], v2 offset:24576
ds_read_b128 a[164:167], v2 offset:25600
v_mfma_f32_16x16x32_bf16 v[232:235], v[120:123], v[200:203], v[232:235]
s_and_b32 s82, s82, 0x1ffff
v_exp_f32 v172, v172
v_mfma_f32_16x16x32_bf16 a[64:67], a[224:227], v[216:219], a[64:67]
v_exp_f32 v173, v173
v_mfma_f32_16x16x32_bf16 a[64:67], a[192:195], v[200:203], a[64:67]
ds_read_b128 a[168:171], v2 offset:26624
ds_read_b128 a[172:175], v2 offset:27648
v_mfma_f32_16x16x32_bf16 a[68:71], a[196:199], v[200:203], a[68:71]
v_exp_f32 v174, v174
v_mfma_f32_16x16x32_bf16 a[68:71], a[228:231], v[216:219], a[68:71]
v_exp_f32 v175, v175
v_mfma_f32_16x16x32_bf16 a[72:75], a[232:235], v[216:219], a[72:75]
buffer_store_dwordx4 v[128:131], v1, s[44:47], s70 offen sc1
v_mfma_f32_16x16x32_bf16 a[72:75], a[200:203], v[200:203], a[72:75]
ds_read_b128 a[176:179], v2 offset:28672
ds_read_b128 a[180:183], v2 offset:29696
v_mfma_f32_16x16x32_bf16 a[76:79], a[204:207], v[200:203], a[76:79]
v_exp_f32 v188, v188
v_mfma_f32_16x16x32_bf16 a[76:79], a[236:239], v[216:219], a[76:79]
ds_read_b128 a[184:187], v2 offset:30720
ds_read_b128 a[188:191], v2 offset:31744
v_mfma_f32_16x16x32_bf16 a[80:83], a[240:243], v[216:219], a[80:83]
s_waitcnt lgkmcnt(8)
ds_read_b128 a[224:227], v2 offset:8192
ds_read_b128 a[228:231], v2 offset:9216
v_mfma_f32_16x16x32_bf16 a[80:83], a[208:211], v[200:203], a[80:83]
ds_read_b128 a[232:235], v2 offset:10240
ds_read_b128 a[236:239], v2 offset:11264
v_mfma_f32_16x16x32_bf16 a[84:87], a[212:215], v[200:203], a[84:87]
ds_read_b128 a[240:243], v2 offset:12288
v_cvt_pk_bf16_f32 v220, v172, v173
v_mfma_f32_16x16x32_bf16 a[84:87], a[244:247], v[216:219], a[84:87]
v_exp_f32 v189, v189
v_mfma_f32_16x16x32_bf16 a[88:91], a[248:251], v[216:219], a[88:91]
v_exp_f32 v190, v190
v_mfma_f32_16x16x32_bf16 a[88:91], a[216:219], v[200:203], a[88:91]
ds_read_b128 a[244:247], v2 offset:13312
ds_read_b128 a[248:251], v2 offset:14336
v_mfma_f32_16x16x32_bf16 a[92:95], a[220:223], v[200:203], a[92:95]
v_cvt_pk_bf16_f32 v221, v174, v175
v_cvt_pk_bf16_f32 v222, v188, v189
v_mfma_f32_16x16x32_bf16 a[92:95], a[252:255], v[216:219], a[92:95]
v_exp_f32 v191, v191
s_cmp_eq_u32 s58, 0
s_cbranch_scc1 Lta49
s_cmp_eq_u32 s58, 1
s_cbranch_scc1 Lnt50
v_mfma_f32_16x16x32_bf16 v[140:143], a[128:131], v[64:67], v[92:95]
v_exp_f32 v168, v168
v_mfma_f32_16x16x32_bf16 v[156:159], a[144:147], v[64:67], v[92:95]
buffer_store_dwordx4 v[144:147], v1, s[44:47], s70 offen offset:1024 sc1
s_branch Ljoin51
Lta49:
v_mfma_f32_16x16x32_bf16 v[140:143], a[128:131], v[64:67], v[108:111]
v_exp_f32 v168, v168
v_mfma_f32_16x16x32_bf16 v[156:159], a[144:147], v[64:67], v[112:115]
buffer_store_dwordx4 v[144:147], v1, s[44:47], s70 offen offset:1024 sc1
s_branch Ljoin51
Lnt50:
v_mfma_f32_16x16x32_bf16 v[140:143], a[128:131], v[64:67], v[92:95]
v_exp_f32 v168, v168
v_mfma_f32_16x16x32_bf16 v[156:159], a[144:147], v[64:67], v[108:111]
buffer_store_dwordx4 v[144:147], v1, s[44:47], s70 offen offset:1024 sc1
Ljoin51:
v_mfma_f32_16x16x32_bf16 v[140:143], a[132:135], v[68:71], v[140:143]
v_exp_f32 v169, v169
v_mfma_f32_16x16x32_bf16 v[140:143], a[136:139], v[72:75], v[140:143]
v_exp_f32 v170, v170
v_mfma_f32_16x16x32_bf16 v[140:143], a[140:143], v[76:79], v[140:143]
buffer_store_dwordx4 v[160:163], v1, s[44:47], s70 offen offset:2048 sc1
v_mfma_f32_16x16x32_bf16 v[156:159], a[156:159], v[76:79], v[156:159]
ds_read_b128 a[252:255], v2 offset:15360
v_cvt_pk_bf16_f32 v223, v190, v191
v_mfma_f32_16x16x32_bf16 v[156:159], a[152:155], v[72:75], v[156:159]
s_waitcnt vmcnt(24) lgkmcnt(4)
v_exp_f32 v171, v171
v_mfma_f32_16x16x32_bf16 v[156:159], a[148:151], v[68:71], v[156:159]
s_barrier
v_exp_f32 v184, v184
v_add_u32 v2, s82, v1
v_cvt_pk_bf16_f32 v216, v168, v169
v_cvt_pk_bf16_f32 v217, v170, v171
v_exp_f32 v185, v185
v_exp_f32 v186, v186
v_cvt_pk_bf16_f32 v218, v184, v185
v_exp_f32 v187, v187
s_nop 0
v_cvt_pk_bf16_f32 v219, v186, v187
v_mfma_f32_16x16x32_bf16 v[236:239], v[120:123], v[204:207], v[236:239]
v_exp_f32 v140, v140
v_mfma_f32_16x16x32_bf16 v[236:239], v[120:123], v[220:223], v[236:239]
v_exp_f32 v141, v141
v_mfma_f32_16x16x32_bf16 a[96:99], a[192:195], v[204:207], a[96:99]
ds_read_b128 a[192:195], v2 offset:0
v_mfma_f32_16x16x32_bf16 a[96:99], a[224:227], v[220:223], a[96:99]
buffer_store_dwordx4 v[176:179], v1, s[44:47], s70 offen offset:3072 sc1
v_mfma_f32_16x16x32_bf16 a[100:103], a[228:231], v[220:223], a[100:103]
s_add_u32 s70, s70, 0x80000
v_exp_f32 v142, v142
v_mfma_f32_16x16x32_bf16 a[100:103], a[196:199], v[204:207], a[100:103]
s_add_u32 s78, s59, 4
ds_read_b128 a[196:199], v2 offset:1024
v_mfma_f32_16x16x32_bf16 a[104:107], a[200:203], v[204:207], a[104:107]
s_and_b32 s78, s78, 12
ds_read_b128 a[200:203], v2 offset:2048
v_mfma_f32_16x16x32_bf16 a[104:107], a[232:235], v[220:223], a[104:107]
s_and_b32 s12, s59, 16
v_exp_f32 v143, v143
v_mfma_f32_16x16x32_bf16 a[108:111], a[236:239], v[220:223], a[108:111]
s_or_b32 s78, s78, s12
v_exp_f32 v156, v156
v_mfma_f32_16x16x32_bf16 a[108:111], a[204:207], v[204:207], a[108:111]
s_add_u32 s12, s61, 0
ds_read_b128 a[204:207], v2 offset:3072
v_mfma_f32_16x16x32_bf16 a[112:115], a[208:211], v[204:207], a[112:115]
s_waitcnt lgkmcnt(4)
ds_read_b128 a[208:211], v2 offset:4096
v_mfma_f32_16x16x32_bf16 a[112:115], a[240:243], v[220:223], a[112:115]
s_and_b32 s12, s12, 3
buffer_store_dwordx4 v[132:135], v1, s[44:47], s70 offen sc1
v_mfma_f32_16x16x32_bf16 a[116:119], a[244:247], v[220:223], a[116:119]
s_add_u32 s12, s12, s78
v_exp_f32 v157, v157
v_mfma_f32_16x16x32_bf16 a[116:119], a[212:215], v[204:207], a[116:119]
s_lshl_b32 s12, s12, 18
ds_read_b128 a[212:215], v2 offset:5120
v_mfma_f32_16x16x32_bf16 a[120:123], a[216:219], v[204:207], a[120:123]
s_add_u32 s12, s12, s94
v_exp_f32 v158, v158
v_mfma_f32_16x16x32_bf16 a[120:123], a[248:251], v[220:223], a[120:123]
s_add_u32 s13, s61, 1
ds_read_b128 a[216:219], v2 offset:6144
v_mfma_f32_16x16x32_bf16 a[124:127], a[252:255], v[220:223], a[124:127]
s_and_b32 s13, s13, 3
buffer_store_dwordx4 v[148:151], v1, s[44:47], s70 offen offset:1024 sc1
v_mfma_f32_16x16x32_bf16 a[124:127], a[220:223], v[204:207], a[124:127]
s_add_u32 s13, s13, s78
ds_read_b128 a[220:223], v2 offset:7168
v_cvt_pk_bf16_f32 v204, v140, v141
s_cmp_eq_u32 s58, 2
s_cbranch_scc1 Lta52
s_cmp_eq_u32 s58, 3
s_cbranch_scc1 Lnt53
v_mfma_f32_16x16x32_bf16 v[172:175], a[160:163], v[64:67], v[112:115]
s_lshl_b32 s13, s13, 18
v_cvt_pk_bf16_f32 v205, v142, v143
v_cvt_pk_bf16_f32 v206, v156, v157
v_mfma_f32_16x16x32_bf16 v[188:191], a[176:179], v[64:67], v[112:115]
s_add_u32 s13, s13, s94
v_exp_f32 v159, v159
s_branch Ljoin54
Lta52:
v_mfma_f32_16x16x32_bf16 v[172:175], a[160:163], v[64:67], v[108:111]
s_lshl_b32 s13, s13, 18
v_cvt_pk_bf16_f32 v205, v142, v143
v_cvt_pk_bf16_f32 v206, v156, v157
v_mfma_f32_16x16x32_bf16 v[188:191], a[176:179], v[64:67], v[112:115]
s_add_u32 s13, s13, s94
v_exp_f32 v159, v159
s_branch Ljoin54
Lnt53:
v_mfma_f32_16x16x32_bf16 v[172:175], a[160:163], v[64:67], v[92:95]
s_lshl_b32 s13, s13, 18
v_cvt_pk_bf16_f32 v205, v142, v143
v_cvt_pk_bf16_f32 v206, v156, v157
v_mfma_f32_16x16x32_bf16 v[188:191], a[176:179], v[64:67], v[108:111]
s_add_u32 s13, s13, s94
v_exp_f32 v159, v159
Ljoin54:
v_mfma_f32_16x16x32_bf16 v[172:175], a[164:167], v[68:71], v[172:175]
s_add_u32 s14, s61, 2
v_cvt_pk_bf16_f32 v207, v158, v159
v_mfma_f32_16x16x32_bf16 v[172:175], a[168:171], v[72:75], v[172:175]
s_and_b32 s14, s14, 3
v_mfma_f32_16x16x32_bf16 v[172:175], a[172:175], v[76:79], v[172:175]
s_add_u32 s14, s14, s78
v_mfma_f32_16x16x32_bf16 v[188:191], a[188:191], v[76:79], v[188:191]
s_lshl_b32 s14, s14, 18
v_mfma_f32_16x16x32_bf16 v[188:191], a[184:187], v[72:75], v[188:191]
s_add_u32 s14, s14, s94
v_mfma_f32_16x16x32_bf16 v[188:191], a[180:183], v[68:71], v[188:191]
s_waitcnt lgkmcnt(4)
s_add_u32 s15, s61, 3
s_and_b32 s15, s15, 3
s_add_u32 s15, s15, s78
s_lshl_b32 s15, s15, 18
s_add_u32 s15, s15, s94
v_mfma_f32_16x16x32_bf16 v[232:235], v[120:123], v[216:219], v[232:235]
s_add_u32 s82, s82, 0x8000
v_exp_f32 v172, v172
v_mfma_f32_16x16x32_bf16 a[64:67], a[224:227], v[216:219], a[64:67]
s_and_b32 s82, s82, 0x1ffff
ds_read_b128 a[224:227], v2 offset:8192
v_mfma_f32_16x16x32_bf16 a[68:71], a[228:231], v[216:219], a[68:71]
ds_read_b128 a[228:231], v2 offset:9216
v_mfma_f32_16x16x32_bf16 a[72:75], a[232:235], v[216:219], a[72:75]
ds_read_b128 a[232:235], v2 offset:10240
v_mfma_f32_16x16x32_bf16 a[76:79], a[236:239], v[216:219], a[76:79]
buffer_store_dwordx4 v[164:167], v1, s[44:47], s70 offen offset:2048 sc1
v_mfma_f32_16x16x32_bf16 a[80:83], a[240:243], v[216:219], a[80:83]
ds_read_b128 a[236:239], v2 offset:11264
ds_read_b128 a[240:243], v2 offset:12288
v_mfma_f32_16x16x32_bf16 a[84:87], a[244:247], v[216:219], a[84:87]
ds_read_b128 a[244:247], v2 offset:13312
v_mfma_f32_16x16x32_bf16 a[88:91], a[248:251], v[216:219], a[88:91]
v_exp_f32 v173, v173
v_mfma_f32_16x16x32_bf16 a[92:95], a[252:255], v[216:219], a[92:95]
v_exp_f32 v174, v174
ds_read_b128 a[248:251], v2 offset:14336
ds_read_b128 a[252:255], v2 offset:15360
v_add_u32 v2, s82, v1
buffer_store_dwordx4 v[180:183], v1, s[44:47], s70 offen offset:3072 sc1
v_cvt_pk_bf16_f32 v220, v172, v173
v_exp_f32 v175, v175
v_exp_f32 v188, v188
v_cvt_pk_bf16_f32 v221, v174, v175
v_exp_f32 v189, v189
v_exp_f32 v190, v190
v_cvt_pk_bf16_f32 v222, v188, v189
v_exp_f32 v191, v191
s_nop 0
v_cvt_pk_bf16_f32 v223, v190, v191
s_waitcnt vmcnt(8) lgkmcnt(0)
s_barrier
s_branch LHT4
Lslow:
s_waitcnt vmcnt(0) lgkmcnt(0)
s_barrier
s_mov_b32 s86, 1
s_lshl_b32 s81, s59, 20
s_add_u32 s81, s81, s64
s_sub_u32 s81, s81, 0x4000
s_mov_b32 s83, 0
s_lshl_b32 s75, s60, 3
s_sub_u32 s76, 128, s75
s_add_u32 s74, s75, s58
s_sub_u32 s75, s76, 8
s_add_u32 s75, s75, s58
v_mov_b32 v2, v1
v_lshrrev_b32 v240, 4, v0
v_and_b32 v241, 15, v0
v_lshlrev_b32 v240, 2, v240
v_sub_u32 v240, v241, v240
v_mov_b32 v112, 0xff800000
v_mov_b32 v113, 0xff800000
v_mov_b32 v114, 0xff800000
v_mov_b32 v115, 0xff800000
v_cmp_gt_i32 vcc, 0, v240
v_mov_b32 v120, 0x3f803f80
s_nop 0
v_cndmask_b32 v116, 0, v112, vcc
v_cmp_gt_i32 vcc, 1, v240
v_mov_b32 v121, 0x3f803f80
s_nop 0
v_cndmask_b32 v117, 0, v112, vcc
v_cmp_gt_i32 vcc, 2, v240
v_mov_b32 v122, 0x3f803f80
s_nop 0
v_cndmask_b32 v118, 0, v112, vcc
v_cmp_gt_i32 vcc, 3, v240
v_mov_b32 v123, 0x3f803f80
s_nop 0
v_cndmask_b32 v119, 0, v112, vcc
Lslow1:
s_add_u32 m0, s64, 16384
s_add_u32 s72, s81, 16384
buffer_load_dwordx4 v1, s[44:47], s72 offen sc1 lds
buffer_load_dwordx4 v1, s[44:47], s72 offen offset:1024 sc1 lds
buffer_load_dwordx4 v1, s[44:47], s72 offen offset:2048 sc1 lds
buffer_load_dwordx4 v1, s[44:47], s72 offen offset:3072 sc1 lds
s_add_u32 s81, s81, 0x8000
s_waitcnt vmcnt(0)
s_barrier
ds_read_b128 a[128:131], v2 offset:16384
ds_read_b128 a[132:135], v2 offset:17408
ds_read_b128 a[136:139], v2 offset:18432
ds_read_b128 a[140:143], v2 offset:19456
ds_read_b128 a[144:147], v2 offset:20480
ds_read_b128 a[148:151], v2 offset:21504
ds_read_b128 a[152:155], v2 offset:22528
ds_read_b128 a[156:159], v2 offset:23552
s_waitcnt lgkmcnt(0)
s_add_u32 s73, s74, 0
s_cmp_lt_u32 s73, s83
s_cbranch_scc1 Lsa55
s_cmp_eq_u32 s73, s83
s_cbranch_scc1 Lst56
v_mfma_f32_16x16x32_bf16 v[128:131], a[128:131], v[16:19], 0
s_branch Lsj57
Lst56:
v_mfma_f32_16x16x32_bf16 v[128:131], a[128:131], v[16:19], v[116:119]
Lsj57:
v_mfma_f32_16x16x32_bf16 v[128:131], a[132:135], v[20:23], v[128:131]
v_mfma_f32_16x16x32_bf16 v[128:131], a[136:139], v[24:27], v[128:131]
v_mfma_f32_16x16x32_bf16 v[128:131], a[140:143], v[28:31], v[128:131]
s_nop 7
v_max3_f32 v124, v124, v128, v129
v_max3_f32 v124, v124, v130, v131
Lsa55:
s_add_u32 s73, s74, 4
s_cmp_lt_u32 s73, s83
s_cbranch_scc1 Lsa58
s_cmp_eq_u32 s73, s83
s_cbranch_scc1 Lst59
v_mfma_f32_16x16x32_bf16 v[132:135], a[128:131], v[32:35], 0
s_branch Lsj60
Lst59:
v_mfma_f32_16x16x32_bf16 v[132:135], a[128:131], v[32:35], v[116:119]
Lsj60:
v_mfma_f32_16x16x32_bf16 v[132:135], a[132:135], v[36:39], v[132:135]
v_mfma_f32_16x16x32_bf16 v[132:135], a[136:139], v[40:43], v[132:135]
v_mfma_f32_16x16x32_bf16 v[132:135], a[140:143], v[44:47], v[132:135]
s_nop 7
v_max3_f32 v125, v125, v132, v133
v_max3_f32 v125, v125, v134, v135
Lsa58:
s_add_u32 s73, s75, 0
s_cmp_lt_u32 s73, s83
s_cbranch_scc1 Lsa61
s_cmp_eq_u32 s73, s83
s_cbranch_scc1 Lst62
v_mfma_f32_16x16x32_bf16 v[136:139], a[128:131], v[48:51], 0
s_branch Lsj63
Lst62:
v_mfma_f32_16x16x32_bf16 v[136:139], a[128:131], v[48:51], v[116:119]
Lsj63:
v_mfma_f32_16x16x32_bf16 v[136:139], a[132:135], v[52:55], v[136:139]
v_mfma_f32_16x16x32_bf16 v[136:139], a[136:139], v[56:59], v[136:139]
v_mfma_f32_16x16x32_bf16 v[136:139], a[140:143], v[60:63], v[136:139]
s_nop 7
v_max3_f32 v126, v126, v136, v137
v_max3_f32 v126, v126, v138, v139
Lsa61:
s_add_u32 s73, s75, 4
s_cmp_lt_u32 s73, s83
s_cbranch_scc1 Lsa64
s_cmp_eq_u32 s73, s83
s_cbranch_scc1 Lst65
v_mfma_f32_16x16x32_bf16 v[140:143], a[128:131], v[64:67], 0
s_branch Lsj66
Lst65:
v_mfma_f32_16x16x32_bf16 v[140:143], a[128:131], v[64:67], v[116:119]
Lsj66:
v_mfma_f32_16x16x32_bf16 v[140:143], a[132:135], v[68:71], v[140:143]
v_mfma_f32_16x16x32_bf16 v[140:143], a[136:139], v[72:75], v[140:143]
v_mfma_f32_16x16x32_bf16 v[140:143], a[140:143], v[76:79], v[140:143]
s_nop 7
v_max3_f32 v127, v127, v140, v141
v_max3_f32 v127, v127, v142, v143
Lsa64:
s_add_u32 s83, s83, 1
s_add_u32 s73, s74, 0
s_cmp_lt_u32 s73, s83
s_cbranch_scc1 Lsa67
s_cmp_eq_u32 s73, s83
s_cbranch_scc1 Lst68
v_mfma_f32_16x16x32_bf16 v[144:147], a[144:147], v[16:19], 0
s_branch Lsj69
Lst68:
v_mfma_f32_16x16x32_bf16 v[144:147], a[144:147], v[16:19], v[116:119]
Lsj69:
v_mfma_f32_16x16x32_bf16 v[144:147], a[148:151], v[20:23], v[144:147]
v_mfma_f32_16x16x32_bf16 v[144:147], a[152:155], v[24:27], v[144:147]
v_mfma_f32_16x16x32_bf16 v[144:147], a[156:159], v[28:31], v[144:147]
s_nop 7
v_max3_f32 v124, v124, v144, v145
v_max3_f32 v124, v124, v146, v147
Lsa67:
s_add_u32 s73, s74, 4
s_cmp_lt_u32 s73, s83
s_cbranch_scc1 Lsa70
s_cmp_eq_u32 s73, s83
s_cbranch_scc1 Lst71
v_mfma_f32_16x16x32_bf16 v[148:151], a[144:147], v[32:35], 0
s_branch Lsj72
Lst71:
v_mfma_f32_16x16x32_bf16 v[148:151], a[144:147], v[32:35], v[116:119]
Lsj72:
v_mfma_f32_16x16x32_bf16 v[148:151], a[148:151], v[36:39], v[148:151]
v_mfma_f32_16x16x32_bf16 v[148:151], a[152:155], v[40:43], v[148:151]
v_mfma_f32_16x16x32_bf16 v[148:151], a[156:159], v[44:47], v[148:151]
s_nop 7
v_max3_f32 v125, v125, v148, v149
v_max3_f32 v125, v125, v150, v151
Lsa70:
s_add_u32 s73, s75, 0
s_cmp_lt_u32 s73, s83
s_cbranch_scc1 Lsa73
s_cmp_eq_u32 s73, s83
s_cbranch_scc1 Lst74
v_mfma_f32_16x16x32_bf16 v[152:155], a[144:147], v[48:51], 0
s_branch Lsj75
Lst74:
v_mfma_f32_16x16x32_bf16 v[152:155], a[144:147], v[48:51], v[116:119]
Lsj75:
v_mfma_f32_16x16x32_bf16 v[152:155], a[148:151], v[52:55], v[152:155]
v_mfma_f32_16x16x32_bf16 v[152:155], a[152:155], v[56:59], v[152:155]
v_mfma_f32_16x16x32_bf16 v[152:155], a[156:159], v[60:63], v[152:155]
s_nop 7
v_max3_f32 v126, v126, v152, v153
v_max3_f32 v126, v126, v154, v155
Lsa73:
s_add_u32 s73, s75, 4
s_cmp_lt_u32 s73, s83
s_cbranch_scc1 Lsa76
s_cmp_eq_u32 s73, s83
s_cbranch_scc1 Lst77
v_mfma_f32_16x16x32_bf16 v[156:159], a[144:147], v[64:67], 0
s_branch Lsj78
Lst77:
v_mfma_f32_16x16x32_bf16 v[156:159], a[144:147], v[64:67], v[116:119]
Lsj78:
v_mfma_f32_16x16x32_bf16 v[156:159], a[148:151], v[68:71], v[156:159]
v_mfma_f32_16x16x32_bf16 v[156:159], a[152:155], v[72:75], v[156:159]
v_mfma_f32_16x16x32_bf16 v[156:159], a[156:159], v[76:79], v[156:159]
s_nop 7
v_max3_f32 v127, v127, v156, v157
v_max3_f32 v127, v127, v158, v159
Lsa76:
s_add_u32 s83, s83, 1
ds_read_b128 a[128:131], v2 offset:24576
ds_read_b128 a[132:135], v2 offset:25600
ds_read_b128 a[136:139], v2 offset:26624
ds_read_b128 a[140:143], v2 offset:27648
ds_read_b128 a[144:147], v2 offset:28672
ds_read_b128 a[148:151], v2 offset:29696
ds_read_b128 a[152:155], v2 offset:30720
ds_read_b128 a[156:159], v2 offset:31744
s_waitcnt lgkmcnt(0)
s_add_u32 s73, s74, 0
s_cmp_lt_u32 s73, s83
s_cbranch_scc1 Lsa79
s_cmp_eq_u32 s73, s83
s_cbranch_scc1 Lst80
v_mfma_f32_16x16x32_bf16 v[128:131], a[128:131], v[16:19], 0
s_branch Lsj81
Lst80:
v_mfma_f32_16x16x32_bf16 v[128:131], a[128:131], v[16:19], v[116:119]
Lsj81:
v_mfma_f32_16x16x32_bf16 v[128:131], a[132:135], v[20:23], v[128:131]
v_mfma_f32_16x16x32_bf16 v[128:131], a[136:139], v[24:27], v[128:131]
v_mfma_f32_16x16x32_bf16 v[128:131], a[140:143], v[28:31], v[128:131]
s_nop 7
v_max3_f32 v124, v124, v128, v129
v_max3_f32 v124, v124, v130, v131
Lsa79:
s_add_u32 s73, s74, 4
s_cmp_lt_u32 s73, s83
s_cbranch_scc1 Lsa82
s_cmp_eq_u32 s73, s83
s_cbranch_scc1 Lst83
v_mfma_f32_16x16x32_bf16 v[132:135], a[128:131], v[32:35], 0
s_branch Lsj84
Lst83:
v_mfma_f32_16x16x32_bf16 v[132:135], a[128:131], v[32:35], v[116:119]
Lsj84:
v_mfma_f32_16x16x32_bf16 v[132:135], a[132:135], v[36:39], v[132:135]
v_mfma_f32_16x16x32_bf16 v[132:135], a[136:139], v[40:43], v[132:135]
v_mfma_f32_16x16x32_bf16 v[132:135], a[140:143], v[44:47], v[132:135]
s_nop 7
v_max3_f32 v125, v125, v132, v133
v_max3_f32 v125, v125, v134, v135
Lsa82:
s_add_u32 s73, s75, 0
s_cmp_lt_u32 s73, s83
s_cbranch_scc1 Lsa85
s_cmp_eq_u32 s73, s83
s_cbranch_scc1 Lst86
v_mfma_f32_16x16x32_bf16 v[136:139], a[128:131], v[48:51], 0
s_branch Lsj87
Lst86:
v_mfma_f32_16x16x32_bf16 v[136:139], a[128:131], v[48:51], v[116:119]
Lsj87:
v_mfma_f32_16x16x32_bf16 v[136:139], a[132:135], v[52:55], v[136:139]
v_mfma_f32_16x16x32_bf16 v[136:139], a[136:139], v[56:59], v[136:139]
v_mfma_f32_16x16x32_bf16 v[136:139], a[140:143], v[60:63], v[136:139]
s_nop 7
v_max3_f32 v126, v126, v136, v137
v_max3_f32 v126, v126, v138, v139
Lsa85:
s_add_u32 s73, s75, 4
s_cmp_lt_u32 s73, s83
s_cbranch_scc1 Lsa88
s_cmp_eq_u32 s73, s83
s_cbranch_scc1 Lst89
v_mfma_f32_16x16x32_bf16 v[140:143], a[128:131], v[64:67], 0
s_branch Lsj90
Lst89:
v_mfma_f32_16x16x32_bf16 v[140:143], a[128:131], v[64:67], v[116:119]
Lsj90:
v_mfma_f32_16x16x32_bf16 v[140:143], a[132:135], v[68:71], v[140:143]
v_mfma_f32_16x16x32_bf16 v[140:143], a[136:139], v[72:75], v[140:143]
v_mfma_f32_16x16x32_bf16 v[140:143], a[140:143], v[76:79], v[140:143]
s_nop 7
v_max3_f32 v127, v127, v140, v141
v_max3_f32 v127, v127, v142, v143
Lsa88:
s_add_u32 s83, s83, 1
s_add_u32 s73, s74, 0
s_cmp_lt_u32 s73, s83
s_cbranch_scc1 Lsa91
s_cmp_eq_u32 s73, s83
s_cbranch_scc1 Lst92
v_mfma_f32_16x16x32_bf16 v[144:147], a[144:147], v[16:19], 0
s_branch Lsj93
Lst92:
v_mfma_f32_16x16x32_bf16 v[144:147], a[144:147], v[16:19], v[116:119]
Lsj93:
v_mfma_f32_16x16x32_bf16 v[144:147], a[148:151], v[20:23], v[144:147]
v_mfma_f32_16x16x32_bf16 v[144:147], a[152:155], v[24:27], v[144:147]
v_mfma_f32_16x16x32_bf16 v[144:147], a[156:159], v[28:31], v[144:147]
s_nop 7
v_max3_f32 v124, v124, v144, v145
v_max3_f32 v124, v124, v146, v147
Lsa91:
s_add_u32 s73, s74, 4
s_cmp_lt_u32 s73, s83
s_cbranch_scc1 Lsa94
s_cmp_eq_u32 s73, s83
s_cbranch_scc1 Lst95
v_mfma_f32_16x16x32_bf16 v[148:151], a[144:147], v[32:35], 0
s_branch Lsj96
Lst95:
v_mfma_f32_16x16x32_bf16 v[148:151], a[144:147], v[32:35], v[116:119]
Lsj96:
v_mfma_f32_16x16x32_bf16 v[148:151], a[148:151], v[36:39], v[148:151]
v_mfma_f32_16x16x32_bf16 v[148:151], a[152:155], v[40:43], v[148:151]
v_mfma_f32_16x16x32_bf16 v[148:151], a[156:159], v[44:47], v[148:151]
s_nop 7
v_max3_f32 v125, v125, v148, v149
v_max3_f32 v125, v125, v150, v151
Lsa94:
s_add_u32 s73, s75, 0
s_cmp_lt_u32 s73, s83
s_cbranch_scc1 Lsa97
s_cmp_eq_u32 s73, s83
s_cbranch_scc1 Lst98
v_mfma_f32_16x16x32_bf16 v[152:155], a[144:147], v[48:51], 0
s_branch Lsj99
Lst98:
v_mfma_f32_16x16x32_bf16 v[152:155], a[144:147], v[48:51], v[116:119]
Lsj99:
v_mfma_f32_16x16x32_bf16 v[152:155], a[148:151], v[52:55], v[152:155]
v_mfma_f32_16x16x32_bf16 v[152:155], a[152:155], v[56:59], v[152:155]
v_mfma_f32_16x16x32_bf16 v[152:155], a[156:159], v[60:63], v[152:155]
s_nop 7
v_max3_f32 v126, v126, v152, v153
v_max3_f32 v126, v126, v154, v155
Lsa97:
s_add_u32 s73, s75, 4
s_cmp_lt_u32 s73, s83
s_cbranch_scc1 Lsa100
s_cmp_eq_u32 s73, s83
s_cbranch_scc1 Lst101
v_mfma_f32_16x16x32_bf16 v[156:159], a[144:147], v[64:67], 0
s_branch Lsj102
Lst101:
v_mfma_f32_16x16x32_bf16 v[156:159], a[144:147], v[64:67], v[116:119]
Lsj102:
v_mfma_f32_16x16x32_bf16 v[156:159], a[148:151], v[68:71], v[156:159]
v_mfma_f32_16x16x32_bf16 v[156:159], a[152:155], v[72:75], v[156:159]
v_mfma_f32_16x16x32_bf16 v[156:159], a[156:159], v[76:79], v[156:159]
s_nop 7
v_max3_f32 v127, v127, v156, v157
v_max3_f32 v127, v127, v158, v159
Lsa100:
s_add_u32 s83, s83, 1
s_barrier
s_cmp_lt_u32 s83, s76
s_cbranch_scc1 Lslow1
s_lshl_b32 s81, s59, 20
s_add_u32 s81, s81, s64
s_sub_u32 s81, s81, 0x4000
s_add_u32 m0, s64, 49152
s_add_u32 s72, s81, 16384
buffer_load_dwordx4 v1, s[44:47], s72 offen sc1 lds
buffer_load_dwordx4 v1, s[44:47], s72 offen offset:1024 sc1 lds
buffer_load_dwordx4 v1, s[44:47], s72 offen offset:2048 sc1 lds
buffer_load_dwordx4 v1, s[44:47], s72 offen offset:3072 sc1 lds
s_add_u32 s81, s81, 0x8000
s_add_u32 m0, s64, 81920
s_add_u32 s72, s81, 16384
buffer_load_dwordx4 v1, s[44:47], s72 offen sc1 lds
buffer_load_dwordx4 v1, s[44:47], s72 offen offset:1024 sc1 lds
buffer_load_dwordx4 v1, s[44:47], s72 offen offset:2048 sc1 lds
buffer_load_dwordx4 v1, s[44:47], s72 offen offset:3072 sc1 lds
s_add_u32 m0, s64, 65536
s_add_u32 s72, s81, 0
buffer_load_dwordx4 v1, s[44:47], s72 offen sc1 lds
buffer_load_dwordx4 v1, s[44:47], s72 offen offset:1024 sc1 lds
buffer_load_dwordx4 v1, s[44:47], s72 offen offset:2048 sc1 lds
buffer_load_dwordx4 v1, s[44:47], s72 offen offset:3072 sc1 lds
s_add_u32 s81, s81, 0x8000
s_add_u32 m0, s64, 114688
s_add_u32 s72, s81, 16384
buffer_load_dwordx4 v1, s[44:47], s72 offen sc1 lds
buffer_load_dwordx4 v1, s[44:47], s72 offen offset:1024 sc1 lds
buffer_load_dwordx4 v1, s[44:47], s72 offen offset:2048 sc1 lds
buffer_load_dwordx4 v1, s[44:47], s72 offen offset:3072 sc1 lds
s_add_u32 m0, s64, 98304
s_add_u32 s72, s81, 0
buffer_load_dwordx4 v1, s[44:47], s72 offen sc1 lds
buffer_load_dwordx4 v1, s[44:47], s72 offen offset:1024 sc1 lds
buffer_load_dwordx4 v1, s[44:47], s72 offen offset:2048 sc1 lds
buffer_load_dwordx4 v1, s[44:47], s72 offen offset:3072 sc1 lds
v_add_u32 v2, 0x8000, v1
v_lshrrev_b32 v3, 1, v0
v_lshlrev_b32 v3, 7, v3
s_waitcnt vmcnt(0)
s_barrier
v_accvgpr_write_b32 a32, 0
v_accvgpr_write_b32 a33, 0
v_accvgpr_write_b32 a34, 0
v_accvgpr_write_b32 a35, 0
v_accvgpr_write_b32 a36, 0
v_accvgpr_write_b32 a37, 0
v_accvgpr_write_b32 a38, 0
v_accvgpr_write_b32 a39, 0
v_accvgpr_write_b32 a40, 0
v_accvgpr_write_b32 a41, 0
v_accvgpr_write_b32 a42, 0
v_accvgpr_write_b32 a43, 0
v_accvgpr_write_b32 a44, 0
v_accvgpr_write_b32 a45, 0
v_accvgpr_write_b32 a46, 0
v_accvgpr_write_b32 a47, 0
v_accvgpr_write_b32 a48, 0
v_accvgpr_write_b32 a49, 0
v_accvgpr_write_b32 a50, 0
v_accvgpr_write_b32 a51, 0
v_accvgpr_write_b32 a52, 0
v_accvgpr_write_b32 a53, 0
v_accvgpr_write_b32 a54, 0
v_accvgpr_write_b32 a55, 0
v_accvgpr_write_b32 a56, 0
v_accvgpr_write_b32 a57, 0
v_accvgpr_write_b32 a58, 0
v_accvgpr_write_b32 a59, 0
v_accvgpr_write_b32 a60, 0
v_accvgpr_write_b32 a61, 0
v_accvgpr_write_b32 a62, 0
v_accvgpr_write_b32 a63, 0
v_accvgpr_write_b32 a96, 0
v_accvgpr_write_b32 a97, 0
v_accvgpr_write_b32 a98, 0
v_accvgpr_write_b32 a99, 0
v_accvgpr_write_b32 a100, 0
v_accvgpr_write_b32 a101, 0
v_accvgpr_write_b32 a102, 0
v_accvgpr_write_b32 a103, 0
v_accvgpr_write_b32 a104, 0
v_accvgpr_write_b32 a105, 0
v_accvgpr_write_b32 a106, 0
v_accvgpr_write_b32 a107, 0
v_accvgpr_write_b32 a108, 0
v_accvgpr_write_b32 a109, 0
v_accvgpr_write_b32 a110, 0
v_accvgpr_write_b32 a111, 0
v_accvgpr_write_b32 a112, 0
v_accvgpr_write_b32 a113, 0
v_accvgpr_write_b32 a114, 0
v_accvgpr_write_b32 a115, 0
v_accvgpr_write_b32 a116, 0
v_accvgpr_write_b32 a117, 0
v_accvgpr_write_b32 a118, 0
v_accvgpr_write_b32 a119, 0
v_accvgpr_write_b32 a120, 0
v_accvgpr_write_b32 a121, 0
v_accvgpr_write_b32 a122, 0
v_accvgpr_write_b32 a123, 0
v_accvgpr_write_b32 a124, 0
v_accvgpr_write_b32 a125, 0
v_accvgpr_write_b32 a126, 0
v_accvgpr_write_b32 a127, 0
ds_read_b128 a[128:131], v2 offset:16384
ds_read_b128 a[132:135], v2 offset:17408
ds_read_b128 a[136:139], v2 offset:18432
ds_read_b128 a[140:143], v2 offset:19456
ds_read_b128 a[144:147], v2 offset:20480
ds_read_b128 a[148:151], v2 offset:21504
ds_read_b128 a[152:155], v2 offset:22528
ds_read_b128 a[156:159], v2 offset:23552
s_branch Lattn
Lspin103:
s_mov_b32 s83, 262144
Lsl105:
s_sleep 2
buffer_load_dword v3, v2, s[44:47], s82 offen sc1
s_sub_u32 s83, s83, 1
s_cmp_eq_u32 s83, 0
s_waitcnt vmcnt(0)
s_cbranch_scc1 Lback104
v_cmp_gt_u32 vcc, 2, v3
s_cbranch_vccnz Lsl105
s_branch Lback104
Lspin106:
s_mov_b32 s83, 262144
Lsl108:
s_sleep 2
buffer_load_dword v3, v2, s[44:47], s82 offen sc1
s_sub_u32 s83, s83, 1
s_cmp_eq_u32 s83, 0
s_waitcnt vmcnt(0)
s_cbranch_scc1 Lback107
v_cmp_gt_u32 vcc, 2, v3
s_cbranch_vccnz Lsl108
s_branch Lback107
Lredo0:
s_xor_b32 s82, s78, 0
s_lshl_b32 s82, s82, 10
s_add_u32 s82, s82, s74
buffer_load_dword v3, v2, s[44:47], s82 offen sc1
s_waitcnt vmcnt(0)
v_cmp_gt_u32 vcc, 2, v3
s_cbranch_vccnz Lspin103
Lback104:
s_lshr_b32 s69, s12, 18
s_lshl_b32 s69, s69, 12
s_add_u32 s69, s69, s95
buffer_load_dwordx4 a[0:3], v1, s[44:47], s69 offen sc1
buffer_load_dwordx4 a[4:7], v1, s[44:47], s69 offen offset:1024 sc1
buffer_load_dwordx4 a[8:11], v1, s[44:47], s69 offen offset:2048 sc1
buffer_load_dwordx4 a[12:15], v1, s[44:47], s69 offen offset:3072 sc1
s_add_u32 s69, s69, 0x20000
buffer_load_dwordx4 a[16:19], v1, s[44:47], s69 offen sc1
buffer_load_dwordx4 a[20:23], v1, s[44:47], s69 offen offset:1024 sc1
buffer_load_dwordx4 a[24:27], v1, s[44:47], s69 offen offset:2048 sc1
buffer_load_dwordx4 a[28:31], v1, s[44:47], s69 offen offset:3072 sc1
s_lshr_b32 s69, s13, 18
s_lshl_b32 s69, s69, 12
s_add_u32 s69, s69, s95
buffer_load_dwordx4 a[32:35], v1, s[44:47], s69 offen sc1
buffer_load_dwordx4 a[36:39], v1, s[44:47], s69 offen offset:1024 sc1
buffer_load_dwordx4 a[40:43], v1, s[44:47], s69 offen offset:2048 sc1
buffer_load_dwordx4 a[44:47], v1, s[44:47], s69 offen offset:3072 sc1
s_add_u32 s69, s69, 0x20000
buffer_load_dwordx4 a[48:51], v1, s[44:47], s69 offen sc1
buffer_load_dwordx4 a[52:55], v1, s[44:47], s69 offen offset:1024 sc1
buffer_load_dwordx4 a[56:59], v1, s[44:47], s69 offen offset:2048 sc1
buffer_load_dwordx4 a[60:63], v1, s[44:47], s69 offen offset:3072 sc1
s_waitcnt vmcnt(8)
s_branch Lredo0b
Lspin109:
s_mov_b32 s83, 262144
Lsl111:
s_sleep 2
buffer_load_dword v114, v115, s[44:47], s84 offen sc1
s_sub_u32 s83, s83, 1
s_cmp_eq_u32 s83, 0
s_waitcnt vmcnt(0)
s_cbranch_scc1 Lback110
v_cmp_gt_u32 vcc, 3, v114
s_cbranch_vccnz Lsl111
s_branch Lback110
Lspin112:
s_mov_b32 s83, 262144
Lsl114:
s_sleep 2
buffer_load_dword v14, v13, s[44:47], s79 offen sc1
s_sub_u32 s83, s83, 1
s_cmp_eq_u32 s83, 0
s_waitcnt vmcnt(0)
s_cbranch_scc1 Lback113
v_cmp_gt_u32 vcc, 2, v14
s_cbranch_vccnz Lsl114
s_branch Lback113
Lxspin1:
s_mov_b32 s83, 262144
Lxsl1:
buffer_load_dwordx4 v[96:99], v1, s[44:47], s79 offen sc1
buffer_load_dwordx4 v[100:103], v1, s[44:47], s79 offen offset:1024 sc1
buffer_load_dwordx4 v[104:107], v1, s[44:47], s79 offen offset:2048 sc1
buffer_load_dwordx4 v[108:111], v1, s[44:47], s79 offen offset:3072 sc1
s_sub_u32 s83, s83, 1
s_cmp_eq_u32 s83, 0
s_waitcnt vmcnt(0)
s_cbranch_scc1 Lxback1
v_max3_u32 v12, v96, v97, v98
v_max3_u32 v13, v99, v100, v101
v_max3_u32 v12, v12, v102, v103
v_max3_u32 v13, v13, v104, v105
v_max3_u32 v12, v12, v106, v107
v_max3_u32 v13, v13, v108, v109
v_max3_u32 v12, v12, v110, v111
v_max_u32 v12, v12, v13
v_cmp_le_u32 vcc, 0xff800000, v12
s_cbranch_vccnz Lxsl1
s_branch Lxback1
Lxspin2:
s_mov_b32 s83, 262144
Lxsl2:
buffer_load_dwordx4 v[80:83], v1, s[44:47], s82 offen sc1
buffer_load_dwordx4 v[84:87], v1, s[44:47], s82 offen offset:1024 sc1
buffer_load_dwordx4 v[88:91], v1, s[44:47], s82 offen offset:2048 sc1
buffer_load_dwordx4 v[92:95], v1, s[44:47], s82 offen offset:3072 sc1
s_sub_u32 s83, s83, 1
s_cmp_eq_u32 s83, 0
s_waitcnt vmcnt(0)
s_cbranch_scc1 Lxback2
v_max3_u32 v12, v80, v81, v82
v_max3_u32 v13, v83, v84, v85
v_max3_u32 v12, v12, v86, v87
v_max3_u32 v13, v13, v88, v89
v_max3_u32 v12, v12, v90, v91
v_max3_u32 v13, v13, v92, v93
v_max3_u32 v12, v12, v94, v95
v_max_u32 v12, v12, v13
v_cmp_le_u32 vcc, 0xff800000, v12
s_cbranch_vccnz Lxsl2
s_branch Lxback2
Lxspin3:
s_mov_b32 s83, 262144
Lxsl3:
buffer_load_dwordx4 v[96:99], v1, s[44:47], s81 offen sc1
buffer_load_dwordx4 v[100:103], v1, s[44:47], s81 offen offset:1024 sc1
buffer_load_dwordx4 v[104:107], v1, s[44:47], s81 offen offset:2048 sc1
buffer_load_dwordx4 v[108:111], v1, s[44:47], s81 offen offset:3072 sc1
s_sub_u32 s83, s83, 1
s_cmp_eq_u32 s83, 0
s_waitcnt vmcnt(0)
s_cbranch_scc1 Lxback3
v_max3_u32 v12, v96, v97, v98
v_max3_u32 v13, v99, v100, v101
v_max3_u32 v12, v12, v102, v103
v_max3_u32 v13, v13, v104, v105
v_max3_u32 v12, v12, v106, v107
v_max3_u32 v13, v13, v108, v109
v_max3_u32 v12, v12, v110, v111
v_max_u32 v12, v12, v13
v_cmp_le_u32 vcc, 0xff800000, v12
s_cbranch_vccnz Lxsl3
s_branch Lxback3
Lcode_end:
s_endpgm
.section .rodata,"a"
.p2align 6
.amdhsa_kernel gated_mix__compressed_kv_cla__ssm_conv_h3__prompt_kernel
  .amdhsa_next_free_vgpr 512
  .amdhsa_next_free_sgpr 102
  .amdhsa_accum_offset 256
  .amdhsa_group_segment_fixed_size 0
  .amdhsa_kernarg_size 128
  .amdhsa_user_sgpr_count 2
  .amdhsa_user_sgpr_kernarg_segment_ptr 1
  .amdhsa_system_sgpr_workgroup_id_x 1
  .amdhsa_float_denorm_mode_32 3
.end_amdhsa_kernel
```

```asm
; @launch grid=(256,1,1) block=(256,1,1) lds=163840
.amdgcn_target "amdgcn-amd-amdhsa--gfx950"
.text
.globl gated_mix__compressed_kv_cla__ssm_conv_h3__prompt_kernel
.p2align 8
.type gated_mix__compressed_kv_cla__ssm_conv_h3__prompt_kernel,@function
gated_mix__compressed_kv_cla__ssm_conv_h3__prompt_kernel:
s_cmp_ge_u32 s2, 256
s_cbranch_scc1 Lend
s_load_dwordx2 s[8:9], s[0:1], 8
s_load_dwordx2 s[16:17], s[0:1], 24
s_load_dwordx2 s[20:21], s[0:1], 32
s_load_dwordx2 s[4:5], s[0:1], 0
s_load_dwordx2 s[12:13], s[0:1], 16
s_load_dwordx2 s[24:25], s[0:1], 40
s_load_dwordx2 s[28:29], s[0:1], 56
s_load_dwordx2 s[32:33], s[0:1], 64
s_load_dwordx2 s[52:53], s[0:1], 72
s_load_dwordx2 s[36:37], s[0:1], 80
s_load_dwordx2 s[54:55], s[0:1], 88
s_load_dwordx2 s[56:57], s[0:1], 96
s_load_dwordx2 s[40:41], s[0:1], 104
s_load_dwordx2 s[48:49], s[0:1], 112
s_load_dwordx2 s[44:45], s[0:1], 120
s_getpc_b64 s[98:99]
Lpc0:
s_lshr_b32 s75, s2, 3
v_lshrrev_b32 v26, 3, v0
s_lshl_b32 s73, s75, 12
v_lshlrev_b32 v26, 7, v26
v_add_u32 v26, s73, v26
v_min_u32 v26, Lcode_end-Lpc0, v26
global_load_dword v31, v26, s[98:99]
v_lshrrev_b32 v26, 6, v0
v_and_b32 v0, 63, v0
s_and_b32 s73, s2, 7
v_readfirstlane_b32 s58, v26
s_lshr_b32 s65, s75, 3
s_and_b32 s60, s75, 7
s_lshl_b32 s59, s73, 2
s_add_u32 s59, s59, s65
s_lshl_b32 s61, s65, 1
s_lshl_b32 s63, s58, 13
s_lshl_b32 s64, s58, 12
s_lshl_b32 s67, s60, 18
s_lshl_b32 s76, s58, 16
s_add_u32 s84, s67, s76
s_lshl_b32 s66, s58, 17
s_lshl_b32 s73, s59, 8
s_add_u32 s66, s66, s73
v_lshrrev_b32 v26, 4, v0
v_and_b32 v27, 7, v0
v_xor_b32 v27, v27, v26
v_lshlrev_b32 v27, 4, v27
v_lshrrev_b32 v28, 3, v0
v_lshl_add_u32 v2, v28, 10, v27
v_xor_b32 v3, 64, v2
v_and_b32 v29, 15, v0
v_lshlrev_b32 v30, 1, v26
v_xor_b32 v30, v30, v29
v_lshlrev_b32 v30, 4, v30
v_lshl_add_u32 v6, v26, 13, v30
v_xor_b32 v7, 0x80, v6
s_mov_b32 s10, 0x200000
s_mov_b32 s11, 0x20000
s_mov_b32 s18, 0x400000
s_mov_b32 s19, 0x20000
s_mov_b32 s22, 0x400000
s_mov_b32 s23, 0x20000
s_lshl_b32 s73, s2, 2
s_add_u32 s73, s73, s58
s_lshl_b32 s73, s73, 11
v_lshrrev_b32 v124, 2, v0
v_lshlrev_b32 v124, 7, v124
v_add_u32 v124, s73, v124
s_lshl_b32 s73, s60, 2
s_add_u32 s73, s73, s58
s_lshl_b32 s73, s73, 13
s_lshl_b32 s74, s59, 8
s_add_u32 s73, s73, s74
v_lshrrev_b32 v125, 4, v0
v_lshlrev_b32 v125, 18, v125
v_bfe_u32 v126, v0, 3, 1
v_lshl_add_u32 v125, v126, 7, v125
v_add_u32 v125, s73, v125
s_waitcnt lgkmcnt(0)
s_mov_b32 s80, 0x0
buffer_load_dword v126, v125, s[16:19], s80 offen
buffer_load_dword v126, v125, s[20:23], s80 offen
s_and_b32 s73, s65, 1
s_xor_b32 s73, s73, 0
s_lshl_b32 s69, s73, 7
s_add_u32 s69, s69, s84
s_lshl_b32 s71, s73, 19
s_add_u32 s71, s71, s66
s_add_u32 m0, s63, 65536
s_add_u32 s72, s69, 0
buffer_load_dwordx4 v2, s[8:11], s72 offen lds
s_add_u32 s72, s69, 7168
buffer_load_dwordx4 v3, s[8:11], s72 offen offset:1024 lds
s_add_u32 s72, s69, 14336
buffer_load_dwordx4 v2, s[8:11], s72 offen offset:2048 lds
s_add_u32 s72, s69, 21504
buffer_load_dwordx4 v3, s[8:11], s72 offen offset:3072 lds
s_add_u32 m0, s64, 0
s_add_u32 s72, s71, 0
buffer_load_dwordx4 v6, s[16:19], s72 offen lds
s_add_u32 s72, s71, 31744
buffer_load_dwordx4 v6, s[16:19], s72 offen offset:1024 lds
s_add_u32 s72, s71, 63488
buffer_load_dwordx4 v7, s[16:19], s72 offen offset:2048 lds
s_add_u32 s72, s71, 95232
buffer_load_dwordx4 v7, s[16:19], s72 offen offset:3072 lds
s_add_u32 m0, s63, 69632
s_add_u32 s72, s69, 32768
buffer_load_dwordx4 v2, s[8:11], s72 offen lds
s_add_u32 s72, s69, 39936
buffer_load_dwordx4 v3, s[8:11], s72 offen offset:1024 lds
s_add_u32 s72, s69, 47104
buffer_load_dwordx4 v2, s[8:11], s72 offen offset:2048 lds
s_add_u32 s72, s69, 54272
buffer_load_dwordx4 v3, s[8:11], s72 offen offset:3072 lds
s_add_u32 m0, s64, 16384
s_add_u32 s72, s71, 0
buffer_load_dwordx4 v6, s[20:23], s72 offen lds
s_add_u32 s72, s71, 31744
buffer_load_dwordx4 v6, s[20:23], s72 offen offset:1024 lds
s_add_u32 s72, s71, 63488
buffer_load_dwordx4 v7, s[20:23], s72 offen offset:2048 lds
s_add_u32 s72, s71, 95232
buffer_load_dwordx4 v7, s[20:23], s72 offen offset:3072 lds
buffer_load_dword v126, v124, s[8:11], 0 offen
s_and_b32 s73, s65, 1
s_xor_b32 s73, s73, 1
s_lshl_b32 s69, s73, 7
s_add_u32 s69, s69, s84
s_lshl_b32 s71, s73, 19
s_add_u32 s71, s71, s66
s_add_u32 m0, s63, 98304
s_add_u32 s72, s69, 0
buffer_load_dwordx4 v2, s[8:11], s72 offen lds
s_add_u32 s72, s69, 7168
buffer_load_dwordx4 v3, s[8:11], s72 offen offset:1024 lds
s_add_u32 s72, s69, 14336
buffer_load_dwordx4 v2, s[8:11], s72 offen offset:2048 lds
s_add_u32 s72, s69, 21504
buffer_load_dwordx4 v3, s[8:11], s72 offen offset:3072 lds
s_branch Lmain
.p2align 12
Lmain:
s_mov_b32 s6, 0x400000
s_mov_b32 s7, 0x20000
s_mov_b32 s14, 0x800000
s_mov_b32 s15, 0x20000
s_mov_b32 s26, 0x800000
s_mov_b32 s27, 0x20000
s_mov_b32 s30, 0x400000
s_mov_b32 s31, 0x20000
s_mov_b32 s34, 0x400000
s_mov_b32 s35, 0x20000
s_mov_b32 s38, 0x400000
s_mov_b32 s39, 0x20000
s_mov_b32 s42, 0x400000
s_mov_b32 s43, 0x20000
s_mov_b32 s46, 0x5800000
s_mov_b32 s47, 0x20000
s_mov_b32 s50, 0x100
s_mov_b32 s51, 0x20000
v_lshl_add_u32 v4, v28, 11, v27
v_xor_b32 v5, 64, v4
v_lshlrev_b32 v1, 4, v0
s_sub_u32 s74, 15, s60
s_lshl_b32 s68, s74, 18
s_lshl_b32 s76, s58, 15
s_add_u32 s68, s68, s76
s_add_u32 s67, s67, s76
s_and_b32 s62, s60, 3
s_sub_u32 s62, 16, s62
s_lshl_b32 s91, s59, 3
s_add_u32 s91, s91, s60
s_lshl_b32 s93, s91, 2
s_add_u32 s93, s93, s58
s_lshl_b32 s91, s91, 7
s_add_u32 s91, s91, 0x3810000
s_lshl_b32 s75, s93, 1
s_and_b32 s75, s75, 0xffc
s_lshl_b32 s93, s93, 12
s_load_dwordx2 s[88:89], s[36:37], s93
s_load_dword s90, s[54:55], s75
v_or_b32 v29, s58, v0
v_mov_b32 v30, 0
v_min_u32 v29, 1, v29
v_lshlrev_b32 v29, 30, v29
buffer_store_dword v30, v29, s[44:47], s91 offen sc1
s_and_b32 s73, s2, 15
s_lshr_b32 s74, s2, 4
s_lshl_b32 s74, s74, 7
s_lshl_b32 s75, s58, 5
s_add_u32 s74, s74, s75
s_mov_b32 s75, 131072
v_lshrrev_b32 v29, 5, v0
v_lshlrev_b32 v29, 4, v29
v_add_u32 v29, s74, v29
v_and_b32 v30, 31, v0
s_lshl_b32 s73, s73, 5
v_add_u32 v30, s73, v30
v_lshlrev_b32 v26, 11, v29
v_lshl_add_u32 v26, v30, 2, v26
v_subrev_u32 v27, 0x1800, v26
s_lshl_b32 s82, s74, 11
s_lshl_b32 s73, s73, 2
s_add_u32 s82, s82, s73
v_lshrrev_b32 v26, 3, v0
v_and_b32 v32, 7, v0
v_lshlrev_b32 v32, 4, v32
v_lshl_add_u32 v26, v26, 11, v32
v_lshrrev_b32 v98, 5, v0
v_lshlrev_b32 v98, 11, v98
v_and_b32 v32, 31, v0
v_lshl_add_u32 v98, v32, 2, v98
v_add_u32 v98, s63, v98
v_add_u32 v98, s75, v98
v_and_b32 v29, 0x7f, v29
v_sub_u32 v29, 0x70, v29
v_lshlrev_b32 v29, 1, v29
v_and_b32 v32, 31, v0
v_mul_u32_u24 v32, 544, v32
v_add3_u32 v28, v32, v29, s75
v_lshlrev_b32 v30, 4, v30
s_lshl_b32 s73, s2, 14
s_lshl_b32 s74, s58, 12
s_add_u32 s76, s73, s74
v_and_b32 v29, 15, v0
v_lshrrev_b32 v32, 4, v0
v_lshrrev_b32 v24, 1, v29
v_xor_b32 v24, v24, v32
v_lshlrev_b32 v24, 4, v24
v_lshl_add_u32 v24, v29, 7, v24
s_add_u32 s73, s63, 131072
v_add_u32 v16, s73, v24
v_xor_b32 v17, 64, v16
v_subrev_u32 v18, 0x10000, v16
v_subrev_u32 v19, 0x10000, v17
s_lshr_b32 s73, s58, 1
s_lshl_b32 s74, s73, 14
s_add_u32 s74, s74, 0x10000
v_add_u32 v24, s74, v24
v_xor_b32 v25, 64, v24
v_lshrrev_b32 v8, 2, v29
v_and_b32 v9, 1, v32
v_lshl_add_u32 v9, v9, 2, v8
v_lshl_add_u32 v8, v32, 3, v8
v_lshlrev_b32 v8, 8, v8
v_lshl_add_u32 v8, v9, 5, v8
v_and_b32 v29, 3, v0
v_lshl_add_u32 v8, v29, 3, v8
s_and_b32 s74, s58, 1
s_lshl_b32 s75, s74, 7
v_xor_b32 v20, s75, v8
v_xor_b32 v9, 32, v8
v_xor_b32 v10, 64, v8
v_xor_b32 v11, 96, v8
v_xor_b32 v12, 128, v8
v_xor_b32 v13, 160, v8
v_xor_b32 v14, 192, v8
v_xor_b32 v15, 224, v8
v_xor_b32 v21, 32, v20
v_xor_b32 v22, 64, v20
v_xor_b32 v23, 96, v20
s_lshl_b32 s77, s59, 20
s_add_u32 s81, s77, s64
s_sub_u32 s81, s81, 0x4000
s_lshl_b32 s75, s60, 17
s_add_u32 s77, s77, s75
s_lshl_b32 s73, s73, 16
s_add_u32 s77, s77, s73
s_lshl_b32 s75, s74, 12
s_add_u32 s78, s77, s75
s_add_u32 s78, s78, 0x4000
s_lshl_b32 s75, s74, 11
s_add_u32 s77, s77, s75
s_mov_b32 s79, 0x3e0293ee
s_waitcnt vmcnt(6)
s_barrier
ds_read_b64_tr_b16 v[224:225], v20 offset:0
ds_read_b64_tr_b16 v[226:227], v20 offset:1024
ds_read_b64_tr_b16 v[228:229], v20 offset:8192
ds_read_b64_tr_b16 v[230:231], v20 offset:9216
ds_read_b128 v[128:131], v24 offset:0
ds_read_b128 v[132:135], v25 offset:0
ds_read_b128 v[136:139], v24 offset:2048
ds_read_b128 v[140:143], v25 offset:2048
ds_read_b128 v[144:147], v24 offset:4096
ds_read_b128 v[148:151], v25 offset:4096
ds_read_b128 v[152:155], v24 offset:6144
ds_read_b128 v[156:159], v25 offset:6144
ds_read_b128 v[160:163], v24 offset:8192
ds_read_b128 v[164:167], v25 offset:8192
ds_read_b128 v[168:171], v24 offset:10240
ds_read_b128 v[172:175], v25 offset:10240
ds_read_b128 v[176:179], v24 offset:12288
ds_read_b128 v[180:183], v25 offset:12288
ds_read_b128 v[184:187], v24 offset:14336
ds_read_b128 v[188:191], v25 offset:14336
ds_read_b64_tr_b16 v[232:233], v21 offset:0
ds_read_b64_tr_b16 v[234:235], v21 offset:1024
ds_read_b64_tr_b16 v[236:237], v21 offset:8192
ds_read_b64_tr_b16 v[238:239], v21 offset:9216
s_waitcnt lgkmcnt(0)
v_mfma_f32_16x16x32_bf16 a[0:3], v[224:227], v[128:131], 0
s_add_u32 m0, s64, 32768
ds_read_b64_tr_b16 v[240:241], v22 offset:0
v_mfma_f32_16x16x32_bf16 a[0:3], v[228:231], v[132:135], a[0:3]
s_add_u32 s72, s71, 0
buffer_load_dwordx4 v6, s[16:19], s72 offen lds
v_mfma_f32_16x16x32_bf16 a[4:7], v[228:231], v[140:143], 0
s_add_u32 s72, s71, 31744
buffer_load_dwordx4 v6, s[16:19], s72 offen offset:1024 lds
v_mfma_f32_16x16x32_bf16 a[4:7], v[224:227], v[136:139], a[4:7]
ds_read_b64_tr_b16 v[242:243], v22 offset:1024
v_mfma_f32_16x16x32_bf16 a[8:11], v[224:227], v[144:147], 0
s_add_u32 s72, s71, 63488
buffer_load_dwordx4 v7, s[16:19], s72 offen offset:2048 lds
v_mfma_f32_16x16x32_bf16 a[8:11], v[228:231], v[148:151], a[8:11]
v_mfma_f32_16x16x32_bf16 a[12:15], v[228:231], v[156:159], 0
s_add_u32 s72, s71, 95232
buffer_load_dwordx4 v7, s[16:19], s72 offen offset:3072 lds
v_mfma_f32_16x16x32_bf16 a[12:15], v[224:227], v[152:155], a[12:15]
ds_read_b64_tr_b16 v[244:245], v22 offset:8192
v_mfma_f32_16x16x32_bf16 a[16:19], v[224:227], v[160:163], 0
s_add_u32 m0, s63, 102400
v_mfma_f32_16x16x32_bf16 a[16:19], v[228:231], v[164:167], a[16:19]
s_add_u32 s72, s69, 32768
buffer_load_dwordx4 v2, s[8:11], s72 offen lds
v_mfma_f32_16x16x32_bf16 a[20:23], v[228:231], v[172:175], 0
s_add_u32 s72, s69, 39936
buffer_load_dwordx4 v3, s[8:11], s72 offen offset:1024 lds
v_mfma_f32_16x16x32_bf16 a[20:23], v[224:227], v[168:171], a[20:23]
ds_read_b64_tr_b16 v[246:247], v22 offset:9216
v_mfma_f32_16x16x32_bf16 a[24:27], v[224:227], v[176:179], 0
s_add_u32 s72, s69, 47104
buffer_load_dwordx4 v2, s[8:11], s72 offen offset:2048 lds
v_mfma_f32_16x16x32_bf16 a[24:27], v[228:231], v[180:183], a[24:27]
v_mfma_f32_16x16x32_bf16 a[28:31], v[228:231], v[188:191], 0
s_add_u32 s72, s69, 54272
buffer_load_dwordx4 v3, s[8:11], s72 offen offset:3072 lds
v_mfma_f32_16x16x32_bf16 a[28:31], v[224:227], v[184:187], a[28:31]
v_mfma_f32_16x16x32_bf16 a[60:63], v[232:235], v[184:187], 0
s_add_u32 m0, s64, 49152
ds_read_b64_tr_b16 v[248:249], v23 offset:0
v_mfma_f32_16x16x32_bf16 a[60:63], v[236:239], v[188:191], a[60:63]
s_add_u32 s72, s71, 0
buffer_load_dwordx4 v6, s[20:23], s72 offen lds
v_mfma_f32_16x16x32_bf16 a[56:59], v[236:239], v[180:183], 0
s_add_u32 s72, s71, 31744
buffer_load_dwordx4 v6, s[20:23], s72 offen offset:1024 lds
v_mfma_f32_16x16x32_bf16 a[56:59], v[232:235], v[176:179], a[56:59]
v_mfma_f32_16x16x32_bf16 a[52:55], v[232:235], v[168:171], 0
s_add_u32 s72, s71, 63488
buffer_load_dwordx4 v7, s[20:23], s72 offen offset:2048 lds
v_mfma_f32_16x16x32_bf16 a[52:55], v[236:239], v[172:175], a[52:55]
ds_read_b64_tr_b16 v[250:251], v23 offset:1024
v_mfma_f32_16x16x32_bf16 a[48:51], v[236:239], v[164:167], 0
s_add_u32 s72, s71, 95232
buffer_load_dwordx4 v7, s[20:23], s72 offen offset:3072 lds
v_mfma_f32_16x16x32_bf16 a[48:51], v[232:235], v[160:163], a[48:51]
s_mov_b32 s80, 0x100000
buffer_load_dword v126, v125, s[16:19], s80 offen
v_mfma_f32_16x16x32_bf16 a[44:47], v[232:235], v[152:155], 0
buffer_load_dword v126, v125, s[20:23], s80 offen
v_mfma_f32_16x16x32_bf16 a[44:47], v[236:239], v[156:159], a[44:47]
v_mfma_f32_16x16x32_bf16 a[40:43], v[236:239], v[148:151], 0
ds_read_b64_tr_b16 v[252:253], v23 offset:8192
v_mfma_f32_16x16x32_bf16 a[40:43], v[232:235], v[144:147], a[40:43]
v_mfma_f32_16x16x32_bf16 a[36:39], v[232:235], v[136:139], 0
ds_read_b64_tr_b16 v[254:255], v23 offset:9216
v_mfma_f32_16x16x32_bf16 a[36:39], v[236:239], v[140:143], a[36:39]
v_mfma_f32_16x16x32_bf16 a[32:35], v[236:239], v[132:135], 0
v_mfma_f32_16x16x32_bf16 a[32:35], v[232:235], v[128:131], a[32:35]
s_waitcnt lgkmcnt(4)
v_mfma_f32_16x16x32_bf16 a[64:67], v[240:243], v[128:131], 0
ds_read_b64_tr_b16 v[224:225], v20 offset:16384
v_mfma_f32_16x16x32_bf16 a[64:67], v[244:247], v[132:135], a[64:67]
v_mfma_f32_16x16x32_bf16 a[68:71], v[244:247], v[140:143], 0
v_mfma_f32_16x16x32_bf16 a[68:71], v[240:243], v[136:139], a[68:71]
ds_read_b64_tr_b16 v[226:227], v20 offset:17408
v_mfma_f32_16x16x32_bf16 a[72:75], v[240:243], v[144:147], 0
v_mfma_f32_16x16x32_bf16 a[72:75], v[244:247], v[148:151], a[72:75]
v_mfma_f32_16x16x32_bf16 a[76:79], v[244:247], v[156:159], 0
v_mfma_f32_16x16x32_bf16 a[76:79], v[240:243], v[152:155], a[76:79]
ds_read_b64_tr_b16 v[228:229], v20 offset:24576
v_mfma_f32_16x16x32_bf16 a[80:83], v[240:243], v[160:163], 0
v_mfma_f32_16x16x32_bf16 a[80:83], v[244:247], v[164:167], a[80:83]
v_mfma_f32_16x16x32_bf16 a[84:87], v[244:247], v[172:175], 0
ds_read_b64_tr_b16 v[230:231], v20 offset:25600
v_mfma_f32_16x16x32_bf16 a[84:87], v[240:243], v[168:171], a[84:87]
v_mfma_f32_16x16x32_bf16 a[88:91], v[240:243], v[176:179], 0
v_mfma_f32_16x16x32_bf16 a[88:91], v[244:247], v[180:183], a[88:91]
v_mfma_f32_16x16x32_bf16 a[92:95], v[244:247], v[188:191], 0
v_mfma_f32_16x16x32_bf16 a[92:95], v[240:243], v[184:187], a[92:95]
s_waitcnt lgkmcnt(4)
v_mfma_f32_16x16x32_bf16 a[124:127], v[248:251], v[184:187], 0
ds_read_b64_tr_b16 v[232:233], v21 offset:16384
v_mfma_f32_16x16x32_bf16 a[124:127], v[252:255], v[188:191], a[124:127]
v_mfma_f32_16x16x32_bf16 a[120:123], v[252:255], v[180:183], 0
v_mfma_f32_16x16x32_bf16 a[120:123], v[248:251], v[176:179], a[120:123]
ds_read_b64_tr_b16 v[234:235], v21 offset:17408
v_mfma_f32_16x16x32_bf16 a[116:119], v[248:251], v[168:171], 0
v_mfma_f32_16x16x32_bf16 a[116:119], v[252:255], v[172:175], a[116:119]
v_mfma_f32_16x16x32_bf16 a[112:115], v[252:255], v[164:167], 0
v_mfma_f32_16x16x32_bf16 a[112:115], v[248:251], v[160:163], a[112:115]
ds_read_b64_tr_b16 v[236:237], v21 offset:24576
v_mfma_f32_16x16x32_bf16 a[108:111], v[248:251], v[152:155], 0
v_mfma_f32_16x16x32_bf16 a[108:111], v[252:255], v[156:159], a[108:111]
v_mfma_f32_16x16x32_bf16 a[104:107], v[252:255], v[148:151], 0
ds_read_b64_tr_b16 v[238:239], v21 offset:25600
v_mfma_f32_16x16x32_bf16 a[104:107], v[248:251], v[144:147], a[104:107]
v_mfma_f32_16x16x32_bf16 a[100:103], v[248:251], v[136:139], 0
v_mfma_f32_16x16x32_bf16 a[100:103], v[252:255], v[140:143], a[100:103]
v_mfma_f32_16x16x32_bf16 a[96:99], v[252:255], v[132:135], 0
v_mfma_f32_16x16x32_bf16 a[96:99], v[248:251], v[128:131], a[96:99]
s_waitcnt lgkmcnt(4)
v_mfma_f32_16x16x32_bf16 a[128:131], v[128:131], v[224:227], 0
ds_read_b64_tr_b16 v[240:241], v22 offset:16384
v_mfma_f32_16x16x32_bf16 a[128:131], v[132:135], v[228:231], a[128:131]
v_mfma_f32_16x16x32_bf16 a[132:135], v[140:143], v[228:231], 0
v_mfma_f32_16x16x32_bf16 a[132:135], v[136:139], v[224:227], a[132:135]
ds_read_b64_tr_b16 v[242:243], v22 offset:17408
v_mfma_f32_16x16x32_bf16 a[136:139], v[144:147], v[224:227], 0
v_mfma_f32_16x16x32_bf16 a[136:139], v[148:151], v[228:231], a[136:139]
v_mfma_f32_16x16x32_bf16 a[140:143], v[156:159], v[228:231], 0
v_mfma_f32_16x16x32_bf16 a[140:143], v[152:155], v[224:227], a[140:143]
ds_read_b64_tr_b16 v[244:245], v22 offset:24576
v_mfma_f32_16x16x32_bf16 a[144:147], v[160:163], v[224:227], 0
v_mfma_f32_16x16x32_bf16 a[144:147], v[164:167], v[228:231], a[144:147]
v_mfma_f32_16x16x32_bf16 a[148:151], v[172:175], v[228:231], 0
ds_read_b64_tr_b16 v[246:247], v22 offset:25600
v_mfma_f32_16x16x32_bf16 a[148:151], v[168:171], v[224:227], a[148:151]
v_mfma_f32_16x16x32_bf16 a[152:155], v[176:179], v[224:227], 0
v_mfma_f32_16x16x32_bf16 a[152:155], v[180:183], v[228:231], a[152:155]
v_mfma_f32_16x16x32_bf16 a[156:159], v[188:191], v[228:231], 0
v_mfma_f32_16x16x32_bf16 a[156:159], v[184:187], v[224:227], a[156:159]
s_waitcnt lgkmcnt(4)
v_mfma_f32_16x16x32_bf16 a[188:191], v[184:187], v[232:235], 0
ds_read_b64_tr_b16 v[248:249], v23 offset:16384
v_mfma_f32_16x16x32_bf16 a[188:191], v[188:191], v[236:239], a[188:191]
v_mfma_f32_16x16x32_bf16 a[184:187], v[180:183], v[236:239], 0
ds_read_b64_tr_b16 v[250:251], v23 offset:17408
v_mfma_f32_16x16x32_bf16 a[184:187], v[176:179], v[232:235], a[184:187]
v_mfma_f32_16x16x32_bf16 a[180:183], v[168:171], v[232:235], 0
ds_read_b64_tr_b16 v[252:253], v23 offset:24576
v_mfma_f32_16x16x32_bf16 a[180:183], v[172:175], v[236:239], a[180:183]
v_mfma_f32_16x16x32_bf16 a[176:179], v[164:167], v[236:239], 0
ds_read_b64_tr_b16 v[254:255], v23 offset:25600
v_mfma_f32_16x16x32_bf16 a[176:179], v[160:163], v[232:235], a[176:179]
v_mfma_f32_16x16x32_bf16 a[172:175], v[152:155], v[232:235], 0
v_mfma_f32_16x16x32_bf16 a[172:175], v[156:159], v[236:239], a[172:175]
v_mfma_f32_16x16x32_bf16 a[168:171], v[148:151], v[236:239], 0
v_mfma_f32_16x16x32_bf16 a[168:171], v[144:147], v[232:235], a[168:171]
v_mfma_f32_16x16x32_bf16 a[164:167], v[136:139], v[232:235], 0
v_mfma_f32_16x16x32_bf16 a[164:167], v[140:143], v[236:239], a[164:167]
s_nop 3
s_mov_b64 exec, 0
s_cmp_eq_u32 s58, 0
s_cbranch_scc1 Lstub0
s_cmp_eq_u32 s58, 1
s_cbranch_scc1 Lstub1
s_cmp_eq_u32 s58, 2
s_cbranch_scc1 Lstub2
s_branch Lstub3
Lret:
s_mov_b64 exec, -1
s_nop 3
v_mfma_f32_16x16x32_bf16 a[160:163], v[132:135], v[236:239], 0
s_waitcnt vmcnt(2) lgkmcnt(0)
v_mfma_f32_16x16x32_bf16 a[160:163], v[128:131], v[232:235], a[160:163]
s_barrier
v_mfma_f32_16x16x32_bf16 a[192:195], v[128:131], v[240:243], 0
s_and_b32 s73, s65, 1
ds_read_b64_tr_b16 v[224:225], v20 offset:32768
v_mfma_f32_16x16x32_bf16 a[192:195], v[132:135], v[244:247], a[192:195]
s_xor_b32 s73, s73, 2
ds_read_b64_tr_b16 v[226:227], v20 offset:33792
v_mfma_f32_16x16x32_bf16 a[196:199], v[140:143], v[244:247], 0
s_lshl_b32 s69, s73, 7
ds_read_b64_tr_b16 v[228:229], v20 offset:40960
v_mfma_f32_16x16x32_bf16 a[196:199], v[136:139], v[240:243], a[196:199]
s_add_u32 s69, s69, s84
ds_read_b64_tr_b16 v[230:231], v20 offset:41984
v_mfma_f32_16x16x32_bf16 a[200:203], v[144:147], v[240:243], 0
s_lshl_b32 s71, s73, 19
ds_read_b128 v[192:195], v24 offset:32768
v_mfma_f32_16x16x32_bf16 a[200:203], v[148:151], v[244:247], a[200:203]
s_add_u32 s71, s71, s66
ds_read_b128 v[196:199], v25 offset:32768
v_mfma_f32_16x16x32_bf16 a[204:207], v[156:159], v[244:247], 0
s_add_u32 m0, s63, 65536
v_mfma_f32_16x16x32_bf16 a[204:207], v[152:155], v[240:243], a[204:207]
s_add_u32 s72, s69, 0
buffer_load_dwordx4 v2, s[8:11], s72 offen lds
v_mfma_f32_16x16x32_bf16 a[208:211], v[160:163], v[240:243], 0
s_add_u32 s72, s69, 7168
buffer_load_dwordx4 v3, s[8:11], s72 offen offset:1024 lds
v_mfma_f32_16x16x32_bf16 a[208:211], v[164:167], v[244:247], a[208:211]
s_add_u32 s72, s69, 14336
buffer_load_dwordx4 v2, s[8:11], s72 offen offset:2048 lds
v_mfma_f32_16x16x32_bf16 a[212:215], v[172:175], v[244:247], 0
ds_read_b128 v[200:203], v24 offset:34816
v_mfma_f32_16x16x32_bf16 a[212:215], v[168:171], v[240:243], a[212:215]
ds_read_b128 v[204:207], v25 offset:34816
v_mfma_f32_16x16x32_bf16 a[216:219], v[176:179], v[240:243], 0
s_add_u32 s72, s69, 21504
buffer_load_dwordx4 v3, s[8:11], s72 offen offset:3072 lds
v_mfma_f32_16x16x32_bf16 a[216:219], v[180:183], v[244:247], a[216:219]
ds_read_b128 v[208:211], v24 offset:36864
v_mfma_f32_16x16x32_bf16 a[220:223], v[188:191], v[244:247], 0
ds_read_b128 v[212:215], v25 offset:36864
v_mfma_f32_16x16x32_bf16 a[220:223], v[184:187], v[240:243], a[220:223]
ds_read_b128 v[216:219], v24 offset:38912
v_mfma_f32_16x16x32_bf16 a[252:255], v[184:187], v[248:251], 0
ds_read_b128 v[220:223], v25 offset:38912
v_mfma_f32_16x16x32_bf16 a[252:255], v[188:191], v[252:255], a[252:255]
s_add_u32 m0, s64, 0
v_mfma_f32_16x16x32_bf16 a[248:251], v[180:183], v[252:255], 0
s_add_u32 s72, s71, 0
buffer_load_dwordx4 v6, s[16:19], s72 offen lds
v_mfma_f32_16x16x32_bf16 a[248:251], v[176:179], v[248:251], a[248:251]
ds_read_b128 v[184:187], v24 offset:40960
v_mfma_f32_16x16x32_bf16 a[244:247], v[168:171], v[248:251], 0
ds_read_b128 v[188:191], v25 offset:40960
v_mfma_f32_16x16x32_bf16 a[244:247], v[172:175], v[252:255], a[244:247]
s_add_u32 s72, s71, 31744
buffer_load_dwordx4 v6, s[16:19], s72 offen offset:1024 lds
v_mfma_f32_16x16x32_bf16 a[240:243], v[164:167], v[252:255], 0
ds_read_b128 v[176:179], v24 offset:43008
v_mfma_f32_16x16x32_bf16 a[240:243], v[160:163], v[248:251], a[240:243]
ds_read_b128 v[180:183], v25 offset:43008
v_mfma_f32_16x16x32_bf16 a[236:239], v[152:155], v[248:251], 0
ds_read_b128 v[168:171], v24 offset:45056
v_mfma_f32_16x16x32_bf16 a[236:239], v[156:159], v[252:255], a[236:239]
s_add_u32 s72, s71, 63488
buffer_load_dwordx4 v7, s[16:19], s72 offen offset:2048 lds
v_mfma_f32_16x16x32_bf16 a[232:235], v[148:151], v[252:255], 0
ds_read_b128 v[172:175], v25 offset:45056
v_mfma_f32_16x16x32_bf16 a[232:235], v[144:147], v[248:251], a[232:235]
ds_read_b128 v[160:163], v24 offset:47104
v_mfma_f32_16x16x32_bf16 a[228:231], v[136:139], v[248:251], 0
ds_read_b128 v[164:167], v25 offset:47104
v_mfma_f32_16x16x32_bf16 a[228:231], v[140:143], v[252:255], a[228:231]
v_mfma_f32_16x16x32_bf16 a[224:227], v[132:135], v[252:255], 0
s_add_u32 s72, s71, 95232
buffer_load_dwordx4 v7, s[16:19], s72 offen offset:3072 lds
v_mfma_f32_16x16x32_bf16 a[224:227], v[128:131], v[248:251], a[224:227]
s_waitcnt lgkmcnt(8)
ds_read_b64_tr_b16 v[232:233], v21 offset:32768
v_mfma_f32_16x16x32_bf16 a[0:3], v[224:227], v[192:195], a[0:3]
ds_read_b64_tr_b16 v[234:235], v21 offset:33792
v_mfma_f32_16x16x32_bf16 a[0:3], v[228:231], v[196:199], a[0:3]
ds_read_b64_tr_b16 v[240:241], v22 offset:32768
v_mfma_f32_16x16x32_bf16 a[4:7], v[228:231], v[204:207], a[4:7]
s_add_u32 m0, s63, 69632
ds_read_b64_tr_b16 v[236:237], v21 offset:40960
v_mfma_f32_16x16x32_bf16 a[4:7], v[224:227], v[200:203], a[4:7]
s_add_u32 s72, s69, 32768
buffer_load_dwordx4 v2, s[8:11], s72 offen lds
v_mfma_f32_16x16x32_bf16 a[8:11], v[224:227], v[208:211], a[8:11]
ds_read_b64_tr_b16 v[238:239], v21 offset:41984
v_mfma_f32_16x16x32_bf16 a[8:11], v[228:231], v[212:215], a[8:11]
v_mfma_f32_16x16x32_bf16 a[12:15], v[228:231], v[220:223], a[12:15]
s_add_u32 s72, s69, 39936
buffer_load_dwordx4 v3, s[8:11], s72 offen offset:1024 lds
v_mfma_f32_16x16x32_bf16 a[12:15], v[224:227], v[216:219], a[12:15]
s_waitcnt lgkmcnt(5)
ds_read_b64_tr_b16 v[242:243], v22 offset:33792
v_mfma_f32_16x16x32_bf16 a[16:19], v[224:227], v[184:187], a[16:19]
v_mfma_f32_16x16x32_bf16 a[16:19], v[228:231], v[188:191], a[16:19]
ds_read_b64_tr_b16 v[244:245], v22 offset:40960
v_mfma_f32_16x16x32_bf16 a[20:23], v[228:231], v[180:183], a[20:23]
v_mfma_f32_16x16x32_bf16 a[20:23], v[224:227], v[176:179], a[20:23]
s_add_u32 s72, s69, 47104
buffer_load_dwordx4 v2, s[8:11], s72 offen offset:2048 lds
v_mfma_f32_16x16x32_bf16 a[24:27], v[224:227], v[168:171], a[24:27]
ds_read_b64_tr_b16 v[246:247], v22 offset:41984
v_mfma_f32_16x16x32_bf16 a[24:27], v[228:231], v[172:175], a[24:27]
v_mfma_f32_16x16x32_bf16 a[28:31], v[228:231], v[164:167], a[28:31]
v_mfma_f32_16x16x32_bf16 a[28:31], v[224:227], v[160:163], a[28:31]
s_waitcnt lgkmcnt(3)
v_mfma_f32_16x16x32_bf16 a[60:63], v[232:235], v[160:163], a[60:63]
s_add_u32 s72, s69, 54272
buffer_load_dwordx4 v3, s[8:11], s72 offen offset:3072 lds
v_mfma_f32_16x16x32_bf16 a[60:63], v[236:239], v[164:167], a[60:63]
ds_read_b64_tr_b16 v[248:249], v23 offset:32768
v_mfma_f32_16x16x32_bf16 a[56:59], v[236:239], v[172:175], a[56:59]
v_mfma_f32_16x16x32_bf16 a[56:59], v[232:235], v[168:171], a[56:59]
s_add_u32 m0, s64, 16384
ds_read_b64_tr_b16 v[250:251], v23 offset:33792
v_mfma_f32_16x16x32_bf16 a[52:55], v[232:235], v[176:179], a[52:55]
s_add_u32 s72, s71, 0
buffer_load_dwordx4 v6, s[20:23], s72 offen lds
v_mfma_f32_16x16x32_bf16 a[52:55], v[236:239], v[180:183], a[52:55]
v_mfma_f32_16x16x32_bf16 a[48:51], v[236:239], v[188:191], a[48:51]
v_mfma_f32_16x16x32_bf16 a[48:51], v[232:235], v[184:187], a[48:51]
ds_read_b64_tr_b16 v[252:253], v23 offset:40960
v_mfma_f32_16x16x32_bf16 a[44:47], v[232:235], v[216:219], a[44:47]
s_add_u32 s72, s71, 31744
buffer_load_dwordx4 v6, s[20:23], s72 offen offset:1024 lds
v_mfma_f32_16x16x32_bf16 a[44:47], v[236:239], v[220:223], a[44:47]
v_mfma_f32_16x16x32_bf16 a[40:43], v[236:239], v[212:215], a[40:43]
ds_read_b64_tr_b16 v[254:255], v23 offset:41984
v_mfma_f32_16x16x32_bf16 a[40:43], v[232:235], v[208:211], a[40:43]
v_mfma_f32_16x16x32_bf16 a[36:39], v[232:235], v[200:203], a[36:39]
s_add_u32 s72, s71, 63488
buffer_load_dwordx4 v7, s[20:23], s72 offen offset:2048 lds
v_mfma_f32_16x16x32_bf16 a[36:39], v[236:239], v[204:207], a[36:39]
v_mfma_f32_16x16x32_bf16 a[32:35], v[236:239], v[196:199], a[32:35]
v_mfma_f32_16x16x32_bf16 a[32:35], v[232:235], v[192:195], a[32:35]
s_waitcnt lgkmcnt(4)
v_mfma_f32_16x16x32_bf16 a[64:67], v[240:243], v[192:195], a[64:67]
s_add_u32 s72, s71, 95232
buffer_load_dwordx4 v7, s[20:23], s72 offen offset:3072 lds
v_mfma_f32_16x16x32_bf16 a[64:67], v[244:247], v[196:199], a[64:67]
s_mov_b32 s80, 0x200000
buffer_load_dword v126, v125, s[16:19], s80 offen
v_mfma_f32_16x16x32_bf16 a[68:71], v[244:247], v[204:207], a[68:71]
buffer_load_dword v126, v125, s[20:23], s80 offen
v_mfma_f32_16x16x32_bf16 a[68:71], v[240:243], v[200:203], a[68:71]
global_load_dwordx4 v[68:71], v30, s[52:53]
v_mfma_f32_16x16x32_bf16 a[72:75], v[240:243], v[208:211], a[72:75]
buffer_load_dword v33, v27, s[28:31], 0 offen nt
v_mfma_f32_16x16x32_bf16 a[72:75], v[244:247], v[212:215], a[72:75]
buffer_load_dword v34, v27, s[28:31], 0 offen offset:2048 nt
v_mfma_f32_16x16x32_bf16 a[76:79], v[244:247], v[220:223], a[76:79]
v_add_u32 v27, 0x1000, v27
v_mfma_f32_16x16x32_bf16 a[76:79], v[240:243], v[216:219], a[76:79]
buffer_load_dword v35, v27, s[28:31], 0 offen nt
v_mfma_f32_16x16x32_bf16 a[80:83], v[240:243], v[184:187], a[80:83]
s_add_u32 m0, s63, 131072
ds_read_b64_tr_b16 v[224:225], v20 offset:49152
ds_read_b64_tr_b16 v[226:227], v20 offset:50176
v_mfma_f32_16x16x32_bf16 a[80:83], v[244:247], v[188:191], a[80:83]
s_add_u32 s80, s82, 0
buffer_load_dwordx4 v26, s[28:31], s80 offen nt lds
v_mfma_f32_16x16x32_bf16 a[84:87], v[244:247], v[180:183], a[84:87]
s_add_u32 s80, s82, 15360
buffer_load_dwordx4 v26, s[28:31], s80 offen offset:1024 nt lds
v_mfma_f32_16x16x32_bf16 a[84:87], v[240:243], v[176:179], a[84:87]
s_add_u32 s80, s82, 30720
buffer_load_dwordx4 v26, s[28:31], s80 offen offset:2048 nt lds
v_mfma_f32_16x16x32_bf16 a[88:91], v[240:243], v[168:171], a[88:91]
s_add_u32 s80, s82, 46080
buffer_load_dwordx4 v26, s[28:31], s80 offen offset:3072 nt lds
v_mfma_f32_16x16x32_bf16 a[88:91], v[244:247], v[172:175], a[88:91]
ds_read_b64_tr_b16 v[228:229], v20 offset:57344
ds_read_b64_tr_b16 v[230:231], v20 offset:58368
v_mfma_f32_16x16x32_bf16 a[92:95], v[244:247], v[164:167], a[92:95]
v_mfma_f32_16x16x32_bf16 a[92:95], v[240:243], v[160:163], a[92:95]
s_waitcnt lgkmcnt(4)
v_mfma_f32_16x16x32_bf16 a[124:127], v[248:251], v[160:163], a[124:127]
ds_read_b64_tr_b16 v[232:233], v21 offset:49152
v_mfma_f32_16x16x32_bf16 a[124:127], v[252:255], v[164:167], a[124:127]
v_mfma_f32_16x16x32_bf16 a[120:123], v[252:255], v[172:175], a[120:123]
v_mfma_f32_16x16x32_bf16 a[120:123], v[248:251], v[168:171], a[120:123]
ds_read_b64_tr_b16 v[234:235], v21 offset:50176
v_mfma_f32_16x16x32_bf16 a[116:119], v[248:251], v[176:179], a[116:119]
v_mfma_f32_16x16x32_bf16 a[116:119], v[252:255], v[180:183], a[116:119]
v_mfma_f32_16x16x32_bf16 a[112:115], v[252:255], v[188:191], a[112:115]
v_mfma_f32_16x16x32_bf16 a[112:115], v[248:251], v[184:187], a[112:115]
ds_read_b64_tr_b16 v[236:237], v21 offset:57344
v_mfma_f32_16x16x32_bf16 a[108:111], v[248:251], v[216:219], a[108:111]
v_mfma_f32_16x16x32_bf16 a[108:111], v[252:255], v[220:223], a[108:111]
v_mfma_f32_16x16x32_bf16 a[104:107], v[252:255], v[212:215], a[104:107]
ds_read_b64_tr_b16 v[238:239], v21 offset:58368
v_mfma_f32_16x16x32_bf16 a[104:107], v[248:251], v[208:211], a[104:107]
v_mfma_f32_16x16x32_bf16 a[100:103], v[248:251], v[200:203], a[100:103]
v_mfma_f32_16x16x32_bf16 a[100:103], v[252:255], v[204:207], a[100:103]
v_mfma_f32_16x16x32_bf16 a[96:99], v[252:255], v[196:199], a[96:99]
v_mfma_f32_16x16x32_bf16 a[96:99], v[248:251], v[192:195], a[96:99]
s_waitcnt lgkmcnt(4)
v_mfma_f32_16x16x32_bf16 a[128:131], v[192:195], v[224:227], a[128:131]
ds_read_b64_tr_b16 v[240:241], v22 offset:49152
v_mfma_f32_16x16x32_bf16 a[128:131], v[196:199], v[228:231], a[128:131]
v_mfma_f32_16x16x32_bf16 a[132:135], v[204:207], v[228:231], a[132:135]
v_mfma_f32_16x16x32_bf16 a[132:135], v[200:203], v[224:227], a[132:135]
ds_read_b64_tr_b16 v[242:243], v22 offset:50176
v_mfma_f32_16x16x32_bf16 a[136:139], v[208:211], v[224:227], a[136:139]
v_mfma_f32_16x16x32_bf16 a[136:139], v[212:215], v[228:231], a[136:139]
v_mfma_f32_16x16x32_bf16 a[140:143], v[220:223], v[228:231], a[140:143]
v_mfma_f32_16x16x32_bf16 a[140:143], v[216:219], v[224:227], a[140:143]
ds_read_b64_tr_b16 v[244:245], v22 offset:57344
v_mfma_f32_16x16x32_bf16 a[144:147], v[184:187], v[224:227], a[144:147]
v_mfma_f32_16x16x32_bf16 a[144:147], v[188:191], v[228:231], a[144:147]
v_mfma_f32_16x16x32_bf16 a[148:151], v[180:183], v[228:231], a[148:151]
ds_read_b64_tr_b16 v[246:247], v22 offset:58368
v_mfma_f32_16x16x32_bf16 a[148:151], v[176:179], v[224:227], a[148:151]
v_mfma_f32_16x16x32_bf16 a[152:155], v[168:171], v[224:227], a[152:155]
v_mfma_f32_16x16x32_bf16 a[152:155], v[172:175], v[228:231], a[152:155]
v_mfma_f32_16x16x32_bf16 a[156:159], v[164:167], v[228:231], a[156:159]
v_mfma_f32_16x16x32_bf16 a[156:159], v[160:163], v[224:227], a[156:159]
s_waitcnt lgkmcnt(4)
v_mfma_f32_16x16x32_bf16 a[188:191], v[160:163], v[232:235], a[188:191]
ds_read_b64_tr_b16 v[248:249], v23 offset:49152
v_mfma_f32_16x16x32_bf16 a[188:191], v[164:167], v[236:239], a[188:191]
v_mfma_f32_16x16x32_bf16 a[184:187], v[172:175], v[236:239], a[184:187]
ds_read_b64_tr_b16 v[250:251], v23 offset:50176
v_mfma_f32_16x16x32_bf16 a[184:187], v[168:171], v[232:235], a[184:187]
v_mfma_f32_16x16x32_bf16 a[180:183], v[176:179], v[232:235], a[180:183]
ds_read_b64_tr_b16 v[252:253], v23 offset:57344
v_mfma_f32_16x16x32_bf16 a[180:183], v[180:183], v[236:239], a[180:183]
v_mfma_f32_16x16x32_bf16 a[176:179], v[188:191], v[236:239], a[176:179]
ds_read_b64_tr_b16 v[254:255], v23 offset:58368
v_mfma_f32_16x16x32_bf16 a[176:179], v[184:187], v[232:235], a[176:179]
v_mfma_f32_16x16x32_bf16 a[172:175], v[216:219], v[232:235], a[172:175]
v_mfma_f32_16x16x32_bf16 a[172:175], v[220:223], v[236:239], a[172:175]
v_mfma_f32_16x16x32_bf16 a[168:171], v[212:215], v[236:239], a[168:171]
v_mfma_f32_16x16x32_bf16 a[168:171], v[208:211], v[232:235], a[168:171]
v_mfma_f32_16x16x32_bf16 a[164:167], v[200:203], v[232:235], a[164:167]
v_mfma_f32_16x16x32_bf16 a[164:167], v[204:207], v[236:239], a[164:167]
v_mfma_f32_16x16x32_bf16 a[160:163], v[196:199], v[236:239], a[160:163]
s_waitcnt vmcnt(10) lgkmcnt(0)
v_mfma_f32_16x16x32_bf16 a[160:163], v[192:195], v[232:235], a[160:163]
s_barrier
v_mfma_f32_16x16x32_bf16 a[192:195], v[192:195], v[240:243], a[192:195]
s_and_b32 s73, s65, 1
ds_read_b64_tr_b16 v[224:225], v20 offset:0
v_mfma_f32_16x16x32_bf16 a[192:195], v[196:199], v[244:247], a[192:195]
s_xor_b32 s73, s73, 3
ds_read_b64_tr_b16 v[226:227], v20 offset:1024
v_mfma_f32_16x16x32_bf16 a[196:199], v[204:207], v[244:247], a[196:199]
s_lshl_b32 s69, s73, 7
ds_read_b64_tr_b16 v[228:229], v20 offset:8192
v_mfma_f32_16x16x32_bf16 a[196:199], v[200:203], v[240:243], a[196:199]
s_add_u32 s69, s69, s84
ds_read_b64_tr_b16 v[230:231], v20 offset:9216
v_mfma_f32_16x16x32_bf16 a[200:203], v[208:211], v[240:243], a[200:203]
s_lshl_b32 s71, s73, 19
ds_read_b128 v[128:131], v24 offset:0
v_mfma_f32_16x16x32_bf16 a[200:203], v[212:215], v[244:247], a[200:203]
s_add_u32 s71, s71, s66
ds_read_b128 v[132:135], v25 offset:0
v_mfma_f32_16x16x32_bf16 a[204:207], v[220:223], v[244:247], a[204:207]
s_add_u32 m0, s63, 98304
v_mfma_f32_16x16x32_bf16 a[204:207], v[216:219], v[240:243], a[204:207]
s_add_u32 s72, s69, 0
buffer_load_dwordx4 v2, s[8:11], s72 offen lds
v_mfma_f32_16x16x32_bf16 a[208:211], v[184:187], v[240:243], a[208:211]
s_add_u32 s72, s69, 7168
buffer_load_dwordx4 v3, s[8:11], s72 offen offset:1024 lds
v_mfma_f32_16x16x32_bf16 a[208:211], v[188:191], v[244:247], a[208:211]
s_add_u32 s72, s69, 14336
buffer_load_dwordx4 v2, s[8:11], s72 offen offset:2048 lds
v_mfma_f32_16x16x32_bf16 a[212:215], v[180:183], v[244:247], a[212:215]
ds_read_b128 v[136:139], v24 offset:2048
v_mfma_f32_16x16x32_bf16 a[212:215], v[176:179], v[240:243], a[212:215]
ds_read_b128 v[140:143], v25 offset:2048
v_mfma_f32_16x16x32_bf16 a[216:219], v[168:171], v[240:243], a[216:219]
s_add_u32 s72, s69, 21504
buffer_load_dwordx4 v3, s[8:11], s72 offen offset:3072 lds
v_mfma_f32_16x16x32_bf16 a[216:219], v[172:175], v[244:247], a[216:219]
ds_read_b128 v[144:147], v24 offset:4096
v_mfma_f32_16x16x32_bf16 a[220:223], v[164:167], v[244:247], a[220:223]
ds_read_b128 v[148:151], v25 offset:4096
v_mfma_f32_16x16x32_bf16 a[220:223], v[160:163], v[240:243], a[220:223]
ds_read_b128 v[152:155], v24 offset:6144
v_mfma_f32_16x16x32_bf16 a[252:255], v[160:163], v[248:251], a[252:255]
ds_read_b128 v[156:159], v25 offset:6144
v_mfma_f32_16x16x32_bf16 a[252:255], v[164:167], v[252:255], a[252:255]
s_add_u32 m0, s64, 32768
v_mfma_f32_16x16x32_bf16 a[248:251], v[172:175], v[252:255], a[248:251]
s_add_u32 s72, s71, 0
buffer_load_dwordx4 v6, s[16:19], s72 offen lds
v_mfma_f32_16x16x32_bf16 a[248:251], v[168:171], v[248:251], a[248:251]
ds_read_b128 v[160:163], v24 offset:8192
v_mfma_f32_16x16x32_bf16 a[244:247], v[176:179], v[248:251], a[244:247]
ds_read_b128 v[164:167], v25 offset:8192
v_mfma_f32_16x16x32_bf16 a[244:247], v[180:183], v[252:255], a[244:247]
s_add_u32 s72, s71, 31744
buffer_load_dwordx4 v6, s[16:19], s72 offen offset:1024 lds
v_mfma_f32_16x16x32_bf16 a[240:243], v[188:191], v[252:255], a[240:243]
ds_read_b128 v[168:171], v24 offset:10240
v_mfma_f32_16x16x32_bf16 a[240:243], v[184:187], v[248:251], a[240:243]
ds_read_b128 v[172:175], v25 offset:10240
v_mfma_f32_16x16x32_bf16 a[236:239], v[216:219], v[248:251], a[236:239]
ds_read_b128 v[176:179], v24 offset:12288
v_mfma_f32_16x16x32_bf16 a[236:239], v[220:223], v[252:255], a[236:239]
s_add_u32 s72, s71, 63488
buffer_load_dwordx4 v7, s[16:19], s72 offen offset:2048 lds
v_mfma_f32_16x16x32_bf16 a[232:235], v[212:215], v[252:255], a[232:235]
ds_read_b128 v[180:183], v25 offset:12288
v_mfma_f32_16x16x32_bf16 a[232:235], v[208:211], v[248:251], a[232:235]
ds_read_b128 v[184:187], v24 offset:14336
v_mfma_f32_16x16x32_bf16 a[228:231], v[200:203], v[248:251], a[228:231]
ds_read_b128 v[188:191], v25 offset:14336
v_mfma_f32_16x16x32_bf16 a[228:231], v[204:207], v[252:255], a[228:231]
v_mfma_f32_16x16x32_bf16 a[224:227], v[196:199], v[252:255], a[224:227]
s_add_u32 s72, s71, 95232
buffer_load_dwordx4 v7, s[16:19], s72 offen offset:3072 lds
v_mfma_f32_16x16x32_bf16 a[224:227], v[192:195], v[248:251], a[224:227]
s_waitcnt lgkmcnt(8)
ds_read_b64_tr_b16 v[232:233], v21 offset:0
v_mfma_f32_16x16x32_bf16 a[0:3], v[224:227], v[128:131], a[0:3]
ds_read_b64_tr_b16 v[234:235], v21 offset:1024
v_mfma_f32_16x16x32_bf16 a[0:3], v[228:231], v[132:135], a[0:3]
ds_read_b64_tr_b16 v[240:241], v22 offset:0
v_mfma_f32_16x16x32_bf16 a[4:7], v[228:231], v[140:143], a[4:7]
s_add_u32 m0, s63, 102400
ds_read_b64_tr_b16 v[236:237], v21 offset:8192
v_mfma_f32_16x16x32_bf16 a[4:7], v[224:227], v[136:139], a[4:7]
s_add_u32 s72, s69, 32768
buffer_load_dwordx4 v2, s[8:11], s72 offen lds
v_mfma_f32_16x16x32_bf16 a[8:11], v[224:227], v[144:147], a[8:11]
ds_read_b64_tr_b16 v[238:239], v21 offset:9216
v_mfma_f32_16x16x32_bf16 a[8:11], v[228:231], v[148:151], a[8:11]
v_mfma_f32_16x16x32_bf16 a[12:15], v[228:231], v[156:159], a[12:15]
s_add_u32 s72, s69, 39936
buffer_load_dwordx4 v3, s[8:11], s72 offen offset:1024 lds
v_mfma_f32_16x16x32_bf16 a[12:15], v[224:227], v[152:155], a[12:15]
s_waitcnt lgkmcnt(5)
ds_read_b64_tr_b16 v[242:243], v22 offset:1024
v_mfma_f32_16x16x32_bf16 a[16:19], v[224:227], v[160:163], a[16:19]
v_mfma_f32_16x16x32_bf16 a[16:19], v[228:231], v[164:167], a[16:19]
ds_read_b64_tr_b16 v[244:245], v22 offset:8192
v_mfma_f32_16x16x32_bf16 a[20:23], v[228:231], v[172:175], a[20:23]
v_mfma_f32_16x16x32_bf16 a[20:23], v[224:227], v[168:171], a[20:23]
s_add_u32 s72, s69, 47104
buffer_load_dwordx4 v2, s[8:11], s72 offen offset:2048 lds
v_mfma_f32_16x16x32_bf16 a[24:27], v[224:227], v[176:179], a[24:27]
ds_read_b64_tr_b16 v[246:247], v22 offset:9216
v_mfma_f32_16x16x32_bf16 a[24:27], v[228:231], v[180:183], a[24:27]
v_mfma_f32_16x16x32_bf16 a[28:31], v[228:231], v[188:191], a[28:31]
v_mfma_f32_16x16x32_bf16 a[28:31], v[224:227], v[184:187], a[28:31]
s_waitcnt lgkmcnt(3)
v_mfma_f32_16x16x32_bf16 a[60:63], v[232:235], v[184:187], a[60:63]
s_add_u32 s72, s69, 54272
buffer_load_dwordx4 v3, s[8:11], s72 offen offset:3072 lds
v_mfma_f32_16x16x32_bf16 a[60:63], v[236:239], v[188:191], a[60:63]
ds_read_b64_tr_b16 v[248:249], v23 offset:0
v_mfma_f32_16x16x32_bf16 a[56:59], v[236:239], v[180:183], a[56:59]
v_mfma_f32_16x16x32_bf16 a[56:59], v[232:235], v[176:179], a[56:59]
s_add_u32 m0, s64, 49152
ds_read_b64_tr_b16 v[250:251], v23 offset:1024
v_mfma_f32_16x16x32_bf16 a[52:55], v[232:235], v[168:171], a[52:55]
s_add_u32 s72, s71, 0
buffer_load_dwordx4 v6, s[20:23], s72 offen lds
v_mfma_f32_16x16x32_bf16 a[52:55], v[236:239], v[172:175], a[52:55]
v_mfma_f32_16x16x32_bf16 a[48:51], v[236:239], v[164:167], a[48:51]
v_mfma_f32_16x16x32_bf16 a[48:51], v[232:235], v[160:163], a[48:51]
ds_read_b64_tr_b16 v[252:253], v23 offset:8192
v_mfma_f32_16x16x32_bf16 a[44:47], v[232:235], v[152:155], a[44:47]
s_add_u32 s72, s71, 31744
buffer_load_dwordx4 v6, s[20:23], s72 offen offset:1024 lds
v_mfma_f32_16x16x32_bf16 a[44:47], v[236:239], v[156:159], a[44:47]
v_mfma_f32_16x16x32_bf16 a[40:43], v[236:239], v[148:151], a[40:43]
ds_read_b64_tr_b16 v[254:255], v23 offset:9216
v_mfma_f32_16x16x32_bf16 a[40:43], v[232:235], v[144:147], a[40:43]
v_mfma_f32_16x16x32_bf16 a[36:39], v[232:235], v[136:139], a[36:39]
s_add_u32 s72, s71, 63488
buffer_load_dwordx4 v7, s[20:23], s72 offen offset:2048 lds
v_mfma_f32_16x16x32_bf16 a[36:39], v[236:239], v[140:143], a[36:39]
v_mfma_f32_16x16x32_bf16 a[32:35], v[236:239], v[132:135], a[32:35]
v_mfma_f32_16x16x32_bf16 a[32:35], v[232:235], v[128:131], a[32:35]
s_waitcnt lgkmcnt(4)
v_mfma_f32_16x16x32_bf16 a[64:67], v[240:243], v[128:131], a[64:67]
s_add_u32 s72, s71, 95232
buffer_load_dwordx4 v7, s[20:23], s72 offen offset:3072 lds
v_mfma_f32_16x16x32_bf16 a[64:67], v[244:247], v[132:135], a[64:67]
s_mov_b32 s80, 0x300000
buffer_load_dword v126, v125, s[16:19], s80 offen
v_mfma_f32_16x16x32_bf16 a[68:71], v[244:247], v[140:143], a[68:71]
buffer_load_dword v126, v125, s[20:23], s80 offen
v_mfma_f32_16x16x32_bf16 a[68:71], v[240:243], v[136:139], a[68:71]
s_add_u32 m0, s63, 135168
ds_read_b64_tr_b16 v[224:225], v20 offset:16384
v_mfma_f32_16x16x32_bf16 a[72:75], v[240:243], v[144:147], a[72:75]
s_add_u32 s80, s82, 0
buffer_load_dwordx4 v26, s[32:35], s80 offen nt lds
v_mfma_f32_16x16x32_bf16 a[72:75], v[244:247], v[148:151], a[72:75]
s_add_u32 s80, s82, 15360
buffer_load_dwordx4 v26, s[32:35], s80 offen offset:1024 nt lds
v_mfma_f32_16x16x32_bf16 a[76:79], v[244:247], v[156:159], a[76:79]
s_add_u32 s80, s82, 30720
buffer_load_dwordx4 v26, s[32:35], s80 offen offset:2048 nt lds
v_mfma_f32_16x16x32_bf16 a[76:79], v[240:243], v[152:155], a[76:79]
s_add_u32 s80, s82, 46080
buffer_load_dwordx4 v26, s[32:35], s80 offen offset:3072 nt lds
v_mfma_f32_16x16x32_bf16 a[80:83], v[240:243], v[160:163], a[80:83]
ds_read_b64_tr_b16 v[226:227], v20 offset:17408
v_mfma_f32_16x16x32_bf16 a[80:83], v[244:247], v[164:167], a[80:83]
v_mfma_f32_16x16x32_bf16 a[84:87], v[244:247], v[172:175], a[84:87]
ds_read_b64_tr_b16 v[228:229], v20 offset:24576
v_mfma_f32_16x16x32_bf16 a[84:87], v[240:243], v[168:171], a[84:87]
v_mfma_f32_16x16x32_bf16 a[88:91], v[240:243], v[176:179], a[88:91]
ds_read_b64_tr_b16 v[230:231], v20 offset:25600
v_mfma_f32_16x16x32_bf16 a[88:91], v[244:247], v[180:183], a[88:91]
v_mfma_f32_16x16x32_bf16 a[92:95], v[244:247], v[188:191], a[92:95]
v_mfma_f32_16x16x32_bf16 a[92:95], v[240:243], v[184:187], a[92:95]
s_waitcnt lgkmcnt(4)
v_mfma_f32_16x16x32_bf16 a[124:127], v[248:251], v[184:187], a[124:127]
ds_read_b64_tr_b16 v[232:233], v21 offset:16384
v_mfma_f32_16x16x32_bf16 a[124:127], v[252:255], v[188:191], a[124:127]
v_mfma_f32_16x16x32_bf16 a[120:123], v[252:255], v[180:183], a[120:123]
v_mfma_f32_16x16x32_bf16 a[120:123], v[248:251], v[176:179], a[120:123]
ds_read_b64_tr_b16 v[234:235], v21 offset:17408
v_mfma_f32_16x16x32_bf16 a[116:119], v[248:251], v[168:171], a[116:119]
v_mfma_f32_16x16x32_bf16 a[116:119], v[252:255], v[172:175], a[116:119]
v_mfma_f32_16x16x32_bf16 a[112:115], v[252:255], v[164:167], a[112:115]
v_mfma_f32_16x16x32_bf16 a[112:115], v[248:251], v[160:163], a[112:115]
ds_read_b64_tr_b16 v[236:237], v21 offset:24576
v_mfma_f32_16x16x32_bf16 a[108:111], v[248:251], v[152:155], a[108:111]
v_mfma_f32_16x16x32_bf16 a[108:111], v[252:255], v[156:159], a[108:111]
v_mfma_f32_16x16x32_bf16 a[104:107], v[252:255], v[148:151], a[104:107]
ds_read_b64_tr_b16 v[238:239], v21 offset:25600
v_mfma_f32_16x16x32_bf16 a[104:107], v[248:251], v[144:147], a[104:107]
v_mfma_f32_16x16x32_bf16 a[100:103], v[248:251], v[136:139], a[100:103]
v_mfma_f32_16x16x32_bf16 a[100:103], v[252:255], v[140:143], a[100:103]
v_mfma_f32_16x16x32_bf16 a[96:99], v[252:255], v[132:135], a[96:99]
v_mfma_f32_16x16x32_bf16 a[96:99], v[248:251], v[128:131], a[96:99]
s_waitcnt lgkmcnt(4)
v_mfma_f32_16x16x32_bf16 a[128:131], v[128:131], v[224:227], a[128:131]
ds_read_b64_tr_b16 v[240:241], v22 offset:16384
v_mfma_f32_16x16x32_bf16 a[128:131], v[132:135], v[228:231], a[128:131]
v_mfma_f32_16x16x32_bf16 a[132:135], v[140:143], v[228:231], a[132:135]
v_mfma_f32_16x16x32_bf16 a[132:135], v[136:139], v[224:227], a[132:135]
ds_read_b64_tr_b16 v[242:243], v22 offset:17408
v_mfma_f32_16x16x32_bf16 a[136:139], v[144:147], v[224:227], a[136:139]
v_mfma_f32_16x16x32_bf16 a[136:139], v[148:151], v[228:231], a[136:139]
v_mfma_f32_16x16x32_bf16 a[140:143], v[156:159], v[228:231], a[140:143]
v_mfma_f32_16x16x32_bf16 a[140:143], v[152:155], v[224:227], a[140:143]
ds_read_b64_tr_b16 v[244:245], v22 offset:24576
v_mfma_f32_16x16x32_bf16 a[144:147], v[160:163], v[224:227], a[144:147]
v_mfma_f32_16x16x32_bf16 a[144:147], v[164:167], v[228:231], a[144:147]
v_mfma_f32_16x16x32_bf16 a[148:151], v[172:175], v[228:231], a[148:151]
ds_read_b64_tr_b16 v[246:247], v22 offset:25600
v_mfma_f32_16x16x32_bf16 a[148:151], v[168:171], v[224:227], a[148:151]
v_mfma_f32_16x16x32_bf16 a[152:155], v[176:179], v[224:227], a[152:155]
v_mfma_f32_16x16x32_bf16 a[152:155], v[180:183], v[228:231], a[152:155]
v_mfma_f32_16x16x32_bf16 a[156:159], v[188:191], v[228:231], a[156:159]
v_mfma_f32_16x16x32_bf16 a[156:159], v[184:187], v[224:227], a[156:159]
s_waitcnt lgkmcnt(4)
v_mfma_f32_16x16x32_bf16 a[188:191], v[184:187], v[232:235], a[188:191]
ds_read_b64_tr_b16 v[248:249], v23 offset:16384
v_mfma_f32_16x16x32_bf16 a[188:191], v[188:191], v[236:239], a[188:191]
v_mfma_f32_16x16x32_bf16 a[184:187], v[180:183], v[236:239], a[184:187]
ds_read_b64_tr_b16 v[250:251], v23 offset:17408
v_mfma_f32_16x16x32_bf16 a[184:187], v[176:179], v[232:235], a[184:187]
v_mfma_f32_16x16x32_bf16 a[180:183], v[168:171], v[232:235], a[180:183]
ds_read_b64_tr_b16 v[252:253], v23 offset:24576
v_mfma_f32_16x16x32_bf16 a[180:183], v[172:175], v[236:239], a[180:183]
v_mfma_f32_16x16x32_bf16 a[176:179], v[164:167], v[236:239], a[176:179]
ds_read_b64_tr_b16 v[254:255], v23 offset:25600
v_mfma_f32_16x16x32_bf16 a[176:179], v[160:163], v[232:235], a[176:179]
v_mfma_f32_16x16x32_bf16 a[172:175], v[152:155], v[232:235], a[172:175]
v_mfma_f32_16x16x32_bf16 a[172:175], v[156:159], v[236:239], a[172:175]
v_mfma_f32_16x16x32_bf16 a[168:171], v[148:151], v[236:239], a[168:171]
v_mfma_f32_16x16x32_bf16 a[168:171], v[144:147], v[232:235], a[168:171]
v_mfma_f32_16x16x32_bf16 a[164:167], v[136:139], v[232:235], a[164:167]
v_mfma_f32_16x16x32_bf16 a[164:167], v[140:143], v[236:239], a[164:167]
v_mfma_f32_16x16x32_bf16 a[160:163], v[132:135], v[236:239], a[160:163]
s_waitcnt vmcnt(6) lgkmcnt(0)
v_mfma_f32_16x16x32_bf16 a[160:163], v[128:131], v[232:235], a[160:163]
s_barrier
v_mfma_f32_16x16x32_bf16 a[192:195], v[128:131], v[240:243], a[192:195]
s_and_b32 s73, s65, 1
ds_read_b64_tr_b16 v[224:225], v20 offset:32768
v_mfma_f32_16x16x32_bf16 a[192:195], v[132:135], v[244:247], a[192:195]
s_xor_b32 s73, s73, 4
ds_read_b64_tr_b16 v[226:227], v20 offset:33792
v_mfma_f32_16x16x32_bf16 a[196:199], v[140:143], v[244:247], a[196:199]
s_lshl_b32 s69, s73, 7
ds_read_b64_tr_b16 v[228:229], v20 offset:40960
v_mfma_f32_16x16x32_bf16 a[196:199], v[136:139], v[240:243], a[196:199]
s_add_u32 s69, s69, s84
ds_read_b64_tr_b16 v[230:231], v20 offset:41984
v_mfma_f32_16x16x32_bf16 a[200:203], v[144:147], v[240:243], a[200:203]
s_lshl_b32 s71, s73, 19
ds_read_b128 v[192:195], v24 offset:32768
v_mfma_f32_16x16x32_bf16 a[200:203], v[148:151], v[244:247], a[200:203]
s_add_u32 s71, s71, s66
ds_read_b128 v[196:199], v25 offset:32768
v_mfma_f32_16x16x32_bf16 a[204:207], v[156:159], v[244:247], a[204:207]
s_add_u32 m0, s63, 65536
v_mfma_f32_16x16x32_bf16 a[204:207], v[152:155], v[240:243], a[204:207]
s_add_u32 s72, s69, 0
buffer_load_dwordx4 v2, s[8:11], s72 offen lds
v_mfma_f32_16x16x32_bf16 a[208:211], v[160:163], v[240:243], a[208:211]
s_add_u32 s72, s69, 7168
buffer_load_dwordx4 v3, s[8:11], s72 offen offset:1024 lds
v_mfma_f32_16x16x32_bf16 a[208:211], v[164:167], v[244:247], a[208:211]
s_add_u32 s72, s69, 14336
buffer_load_dwordx4 v2, s[8:11], s72 offen offset:2048 lds
v_mfma_f32_16x16x32_bf16 a[212:215], v[172:175], v[244:247], a[212:215]
ds_read_b128 v[200:203], v24 offset:34816
v_mfma_f32_16x16x32_bf16 a[212:215], v[168:171], v[240:243], a[212:215]
ds_read_b128 v[204:207], v25 offset:34816
v_mfma_f32_16x16x32_bf16 a[216:219], v[176:179], v[240:243], a[216:219]
s_add_u32 s72, s69, 21504
buffer_load_dwordx4 v3, s[8:11], s72 offen offset:3072 lds
v_mfma_f32_16x16x32_bf16 a[216:219], v[180:183], v[244:247], a[216:219]
ds_read_b128 v[208:211], v24 offset:36864
v_mfma_f32_16x16x32_bf16 a[220:223], v[188:191], v[244:247], a[220:223]
ds_read_b128 v[212:215], v25 offset:36864
v_mfma_f32_16x16x32_bf16 a[220:223], v[184:187], v[240:243], a[220:223]
ds_read_b128 v[216:219], v24 offset:38912
v_mfma_f32_16x16x32_bf16 a[252:255], v[184:187], v[248:251], a[252:255]
ds_read_b128 v[220:223], v25 offset:38912
v_mfma_f32_16x16x32_bf16 a[252:255], v[188:191], v[252:255], a[252:255]
s_add_u32 m0, s64, 0
v_mfma_f32_16x16x32_bf16 a[248:251], v[180:183], v[252:255], a[248:251]
s_add_u32 s72, s71, 0
buffer_load_dwordx4 v6, s[16:19], s72 offen lds
v_mfma_f32_16x16x32_bf16 a[248:251], v[176:179], v[248:251], a[248:251]
ds_read_b128 v[184:187], v24 offset:40960
v_mfma_f32_16x16x32_bf16 a[244:247], v[168:171], v[248:251], a[244:247]
ds_read_b128 v[188:191], v25 offset:40960
v_mfma_f32_16x16x32_bf16 a[244:247], v[172:175], v[252:255], a[244:247]
s_add_u32 s72, s71, 31744
buffer_load_dwordx4 v6, s[16:19], s72 offen offset:1024 lds
v_mfma_f32_16x16x32_bf16 a[240:243], v[164:167], v[252:255], a[240:243]
ds_read_b128 v[176:179], v24 offset:43008
v_mfma_f32_16x16x32_bf16 a[240:243], v[160:163], v[248:251], a[240:243]
ds_read_b128 v[180:183], v25 offset:43008
v_mfma_f32_16x16x32_bf16 a[236:239], v[152:155], v[248:251], a[236:239]
ds_read_b128 v[168:171], v24 offset:45056
v_mfma_f32_16x16x32_bf16 a[236:239], v[156:159], v[252:255], a[236:239]
s_add_u32 s72, s71, 63488
buffer_load_dwordx4 v7, s[16:19], s72 offen offset:2048 lds
v_mfma_f32_16x16x32_bf16 a[232:235], v[148:151], v[252:255], a[232:235]
ds_read_b128 v[172:175], v25 offset:45056
v_mfma_f32_16x16x32_bf16 a[232:235], v[144:147], v[248:251], a[232:235]
ds_read_b128 v[160:163], v24 offset:47104
v_mfma_f32_16x16x32_bf16 a[228:231], v[136:139], v[248:251], a[228:231]
ds_read_b128 v[164:167], v25 offset:47104
v_mfma_f32_16x16x32_bf16 a[228:231], v[140:143], v[252:255], a[228:231]
v_mfma_f32_16x16x32_bf16 a[224:227], v[132:135], v[252:255], a[224:227]
s_add_u32 s72, s71, 95232
buffer_load_dwordx4 v7, s[16:19], s72 offen offset:3072 lds
v_mfma_f32_16x16x32_bf16 a[224:227], v[128:131], v[248:251], a[224:227]
s_waitcnt lgkmcnt(8)
ds_read_b64_tr_b16 v[232:233], v21 offset:32768
v_mfma_f32_16x16x32_bf16 a[0:3], v[224:227], v[192:195], a[0:3]
ds_read_b64_tr_b16 v[234:235], v21 offset:33792
v_mfma_f32_16x16x32_bf16 a[0:3], v[228:231], v[196:199], a[0:3]
ds_read_b64_tr_b16 v[240:241], v22 offset:32768
v_mfma_f32_16x16x32_bf16 a[4:7], v[228:231], v[204:207], a[4:7]
s_add_u32 m0, s63, 69632
ds_read_b64_tr_b16 v[236:237], v21 offset:40960
v_mfma_f32_16x16x32_bf16 a[4:7], v[224:227], v[200:203], a[4:7]
s_add_u32 s72, s69, 32768
buffer_load_dwordx4 v2, s[8:11], s72 offen lds
v_mfma_f32_16x16x32_bf16 a[8:11], v[224:227], v[208:211], a[8:11]
ds_read_b64_tr_b16 v[238:239], v21 offset:41984
v_mfma_f32_16x16x32_bf16 a[8:11], v[228:231], v[212:215], a[8:11]
v_mfma_f32_16x16x32_bf16 a[12:15], v[228:231], v[220:223], a[12:15]
s_add_u32 s72, s69, 39936
buffer_load_dwordx4 v3, s[8:11], s72 offen offset:1024 lds
v_mfma_f32_16x16x32_bf16 a[12:15], v[224:227], v[216:219], a[12:15]
s_waitcnt lgkmcnt(5)
ds_read_b64_tr_b16 v[242:243], v22 offset:33792
v_mfma_f32_16x16x32_bf16 a[16:19], v[224:227], v[184:187], a[16:19]
v_mfma_f32_16x16x32_bf16 a[16:19], v[228:231], v[188:191], a[16:19]
ds_read_b64_tr_b16 v[244:245], v22 offset:40960
v_mfma_f32_16x16x32_bf16 a[20:23], v[228:231], v[180:183], a[20:23]
v_mfma_f32_16x16x32_bf16 a[20:23], v[224:227], v[176:179], a[20:23]
s_add_u32 s72, s69, 47104
buffer_load_dwordx4 v2, s[8:11], s72 offen offset:2048 lds
v_mfma_f32_16x16x32_bf16 a[24:27], v[224:227], v[168:171], a[24:27]
ds_read_b64_tr_b16 v[246:247], v22 offset:41984
v_mfma_f32_16x16x32_bf16 a[24:27], v[228:231], v[172:175], a[24:27]
v_mfma_f32_16x16x32_bf16 a[28:31], v[228:231], v[164:167], a[28:31]
v_mfma_f32_16x16x32_bf16 a[28:31], v[224:227], v[160:163], a[28:31]
s_waitcnt lgkmcnt(3)
v_mfma_f32_16x16x32_bf16 a[60:63], v[232:235], v[160:163], a[60:63]
s_add_u32 s72, s69, 54272
buffer_load_dwordx4 v3, s[8:11], s72 offen offset:3072 lds
v_mfma_f32_16x16x32_bf16 a[60:63], v[236:239], v[164:167], a[60:63]
ds_read_b64_tr_b16 v[248:249], v23 offset:32768
v_mfma_f32_16x16x32_bf16 a[56:59], v[236:239], v[172:175], a[56:59]
v_mfma_f32_16x16x32_bf16 a[56:59], v[232:235], v[168:171], a[56:59]
s_add_u32 m0, s64, 16384
ds_read_b64_tr_b16 v[250:251], v23 offset:33792
v_mfma_f32_16x16x32_bf16 a[52:55], v[232:235], v[176:179], a[52:55]
s_add_u32 s72, s71, 0
buffer_load_dwordx4 v6, s[20:23], s72 offen lds
v_mfma_f32_16x16x32_bf16 a[52:55], v[236:239], v[180:183], a[52:55]
v_mfma_f32_16x16x32_bf16 a[48:51], v[236:239], v[188:191], a[48:51]
v_mfma_f32_16x16x32_bf16 a[48:51], v[232:235], v[184:187], a[48:51]
ds_read_b64_tr_b16 v[252:253], v23 offset:40960
v_mfma_f32_16x16x32_bf16 a[44:47], v[232:235], v[216:219], a[44:47]
s_add_u32 s72, s71, 31744
buffer_load_dwordx4 v6, s[20:23], s72 offen offset:1024 lds
v_mfma_f32_16x16x32_bf16 a[44:47], v[236:239], v[220:223], a[44:47]
v_mfma_f32_16x16x32_bf16 a[40:43], v[236:239], v[212:215], a[40:43]
ds_read_b64_tr_b16 v[254:255], v23 offset:41984
v_mfma_f32_16x16x32_bf16 a[40:43], v[232:235], v[208:211], a[40:43]
v_mfma_f32_16x16x32_bf16 a[36:39], v[232:235], v[200:203], a[36:39]
s_add_u32 s72, s71, 63488
buffer_load_dwordx4 v7, s[20:23], s72 offen offset:2048 lds
v_mfma_f32_16x16x32_bf16 a[36:39], v[236:239], v[204:207], a[36:39]
v_mfma_f32_16x16x32_bf16 a[32:35], v[236:239], v[196:199], a[32:35]
v_mfma_f32_16x16x32_bf16 a[32:35], v[232:235], v[192:195], a[32:35]
s_waitcnt lgkmcnt(4)
v_mfma_f32_16x16x32_bf16 a[64:67], v[240:243], v[192:195], a[64:67]
s_add_u32 s72, s71, 95232
buffer_load_dwordx4 v7, s[20:23], s72 offen offset:3072 lds
v_mfma_f32_16x16x32_bf16 a[64:67], v[244:247], v[196:199], a[64:67]
buffer_load_dwordx4 v[108:111], v1, s[4:7], s76 offen
v_mfma_f32_16x16x32_bf16 a[68:71], v[244:247], v[204:207], a[68:71]
buffer_load_dwordx4 v[112:115], v1, s[4:7], s76 offen offset:1024
v_mfma_f32_16x16x32_bf16 a[68:71], v[240:243], v[200:203], a[68:71]
buffer_load_dwordx4 v[116:119], v1, s[4:7], s76 offen offset:2048
v_mfma_f32_16x16x32_bf16 a[72:75], v[240:243], v[208:211], a[72:75]
buffer_load_dwordx4 v[120:123], v1, s[4:7], s76 offen offset:3072
v_mfma_f32_16x16x32_bf16 a[72:75], v[244:247], v[212:215], a[72:75]
ds_read_b64_tr_b16 v[224:225], v20 offset:49152
v_mfma_f32_16x16x32_bf16 a[76:79], v[244:247], v[220:223], a[76:79]
v_mfma_f32_16x16x32_bf16 a[76:79], v[240:243], v[216:219], a[76:79]
ds_read_b64_tr_b16 v[226:227], v20 offset:50176
v_mfma_f32_16x16x32_bf16 a[80:83], v[240:243], v[184:187], a[80:83]
v_mfma_f32_16x16x32_bf16 a[80:83], v[244:247], v[188:191], a[80:83]
ds_read_b64_tr_b16 v[228:229], v20 offset:57344
v_mfma_f32_16x16x32_bf16 a[84:87], v[244:247], v[180:183], a[84:87]
v_mfma_f32_16x16x32_bf16 a[84:87], v[240:243], v[176:179], a[84:87]
ds_read_b64_tr_b16 v[230:231], v20 offset:58368
v_mfma_f32_16x16x32_bf16 a[88:91], v[240:243], v[168:171], a[88:91]
v_mfma_f32_16x16x32_bf16 a[88:91], v[244:247], v[172:175], a[88:91]
v_mfma_f32_16x16x32_bf16 a[92:95], v[244:247], v[164:167], a[92:95]
v_mfma_f32_16x16x32_bf16 a[92:95], v[240:243], v[160:163], a[92:95]
s_waitcnt lgkmcnt(4)
v_mfma_f32_16x16x32_bf16 a[124:127], v[248:251], v[160:163], a[124:127]
ds_read_b64_tr_b16 v[232:233], v21 offset:49152
v_mfma_f32_16x16x32_bf16 a[124:127], v[252:255], v[164:167], a[124:127]
v_mfma_f32_16x16x32_bf16 a[120:123], v[252:255], v[172:175], a[120:123]
v_mfma_f32_16x16x32_bf16 a[120:123], v[248:251], v[168:171], a[120:123]
ds_read_b64_tr_b16 v[234:235], v21 offset:50176
v_mfma_f32_16x16x32_bf16 a[116:119], v[248:251], v[176:179], a[116:119]
s_waitcnt vmcnt(20)
ds_read2_b32 v[36:37], v98 offset0:0 offset1:32
ds_read2_b32 v[38:39], v98 offset0:64 offset1:96
v_mfma_f32_16x16x32_bf16 a[116:119], v[252:255], v[180:183], a[116:119]
ds_read2_b32 v[40:41], v98 offset0:128 offset1:160
ds_read2_b32 v[42:43], v98 offset0:192 offset1:224
v_mfma_f32_16x16x32_bf16 a[112:115], v[252:255], v[188:191], a[112:115]
v_add_u32 v98, 1024, v98
v_mfma_f32_16x16x32_bf16 a[112:115], v[248:251], v[184:187], a[112:115]
ds_read_b64_tr_b16 v[236:237], v21 offset:57344
ds_read2_b32 v[44:45], v98 offset0:0 offset1:32
v_mfma_f32_16x16x32_bf16 a[108:111], v[248:251], v[216:219], a[108:111]
ds_read2_b32 v[46:47], v98 offset0:64 offset1:96
ds_read2_b32 v[48:49], v98 offset0:128 offset1:160
v_mfma_f32_16x16x32_bf16 a[108:111], v[252:255], v[220:223], a[108:111]
ds_read2_b32 v[50:51], v98 offset0:192 offset1:224
v_add_u32 v98, 3072, v98
v_mfma_f32_16x16x32_bf16 a[104:107], v[252:255], v[212:215], a[104:107]
ds_read_b64_tr_b16 v[238:239], v21 offset:58368
ds_read2_b32 v[52:53], v98 offset0:0 offset1:32
v_mfma_f32_16x16x32_bf16 a[104:107], v[248:251], v[208:211], a[104:107]
ds_read2_b32 v[54:55], v98 offset0:64 offset1:96
ds_read2_b32 v[56:57], v98 offset0:128 offset1:160
v_mfma_f32_16x16x32_bf16 a[100:103], v[248:251], v[200:203], a[100:103]
ds_read2_b32 v[58:59], v98 offset0:192 offset1:224
v_add_u32 v98, 1024, v98
v_mfma_f32_16x16x32_bf16 a[100:103], v[252:255], v[204:207], a[100:103]
ds_read2_b32 v[60:61], v98 offset0:0 offset1:32
ds_read2_b32 v[62:63], v98 offset0:64 offset1:96
v_mfma_f32_16x16x32_bf16 a[96:99], v[252:255], v[196:199], a[96:99]
ds_read2_b32 v[64:65], v98 offset0:128 offset1:160
ds_read2_b32 v[66:67], v98 offset0:192 offset1:224
v_mfma_f32_16x16x32_bf16 a[96:99], v[248:251], v[192:195], a[96:99]
s_waitcnt lgkmcnt(15)
v_mfma_f32_16x16x32_bf16 a[128:131], v[192:195], v[224:227], a[128:131]
ds_read_b64_tr_b16 v[240:241], v22 offset:49152
v_mfma_f32_16x16x32_bf16 a[128:131], v[196:199], v[228:231], a[128:131]
v_mfma_f32_16x16x32_bf16 a[132:135], v[204:207], v[228:231], a[132:135]
v_mfma_f32_16x16x32_bf16 a[132:135], v[200:203], v[224:227], a[132:135]
ds_read_b64_tr_b16 v[242:243], v22 offset:50176
v_mfma_f32_16x16x32_bf16 a[136:139], v[208:211], v[224:227], a[136:139]
v_mfma_f32_16x16x32_bf16 a[136:139], v[212:215], v[228:231], a[136:139]
v_mfma_f32_16x16x32_bf16 a[140:143], v[220:223], v[228:231], a[140:143]
v_mfma_f32_16x16x32_bf16 a[140:143], v[216:219], v[224:227], a[140:143]
ds_read_b64_tr_b16 v[244:245], v22 offset:57344
v_mfma_f32_16x16x32_bf16 a[144:147], v[184:187], v[224:227], a[144:147]
v_mfma_f32_16x16x32_bf16 a[144:147], v[188:191], v[228:231], a[144:147]
v_mfma_f32_16x16x32_bf16 a[148:151], v[180:183], v[228:231], a[148:151]
ds_read_b64_tr_b16 v[246:247], v22 offset:58368
v_mfma_f32_16x16x32_bf16 a[148:151], v[176:179], v[224:227], a[148:151]
v_mfma_f32_16x16x32_bf16 a[152:155], v[168:171], v[224:227], a[152:155]
v_mfma_f32_16x16x32_bf16 a[152:155], v[172:175], v[228:231], a[152:155]
v_mfma_f32_16x16x32_bf16 a[156:159], v[164:167], v[228:231], a[156:159]
v_mfma_f32_16x16x32_bf16 a[156:159], v[160:163], v[224:227], a[156:159]
s_waitcnt lgkmcnt(12)
v_mfma_f32_16x16x32_bf16 a[188:191], v[160:163], v[232:235], a[188:191]
ds_read_b64_tr_b16 v[248:249], v23 offset:49152
v_mfma_f32_16x16x32_bf16 a[188:191], v[164:167], v[236:239], a[188:191]
v_mfma_f32_16x16x32_bf16 a[184:187], v[172:175], v[236:239], a[184:187]
ds_read_b64_tr_b16 v[250:251], v23 offset:50176
v_mfma_f32_16x16x32_bf16 a[184:187], v[168:171], v[232:235], a[184:187]
v_mfma_f32_16x16x32_bf16 a[180:183], v[176:179], v[232:235], a[180:183]
ds_read_b64_tr_b16 v[252:253], v23 offset:57344
v_mfma_f32_16x16x32_bf16 a[180:183], v[180:183], v[236:239], a[180:183]
v_mfma_f32_16x16x32_bf16 a[176:179], v[188:191], v[236:239], a[176:179]
ds_read_b64_tr_b16 v[254:255], v23 offset:58368
v_mfma_f32_16x16x32_bf16 a[176:179], v[184:187], v[232:235], a[176:179]
v_mfma_f32_16x16x32_bf16 a[172:175], v[216:219], v[232:235], a[172:175]
v_mfma_f32_16x16x32_bf16 a[172:175], v[220:223], v[236:239], a[172:175]
v_mfma_f32_16x16x32_bf16 a[168:171], v[212:215], v[236:239], a[168:171]
v_mfma_f32_16x16x32_bf16 a[168:171], v[208:211], v[232:235], a[168:171]
v_mfma_f32_16x16x32_bf16 a[164:167], v[200:203], v[232:235], a[164:167]
v_mfma_f32_16x16x32_bf16 a[164:167], v[204:207], v[236:239], a[164:167]
v_mfma_f32_16x16x32_bf16 a[160:163], v[196:199], v[236:239], a[160:163]
s_waitcnt vmcnt(4) lgkmcnt(0)
v_mfma_f32_16x16x32_bf16 a[160:163], v[192:195], v[232:235], a[160:163]
s_barrier
v_mfma_f32_16x16x32_bf16 a[192:195], v[192:195], v[240:243], a[192:195]
s_and_b32 s73, s65, 1
ds_read_b64_tr_b16 v[224:225], v20 offset:0
v_lshlrev_b32 v72, 16, v68
v_mfma_f32_16x16x32_bf16 a[192:195], v[196:199], v[244:247], a[192:195]
s_xor_b32 s73, s73, 5
ds_read_b64_tr_b16 v[226:227], v20 offset:1024
v_and_b32 v73, 0xffff0000, v68
v_mfma_f32_16x16x32_bf16 a[196:199], v[204:207], v[244:247], a[196:199]
s_lshl_b32 s69, s73, 7
ds_read_b64_tr_b16 v[228:229], v20 offset:8192
v_lshlrev_b32 v74, 16, v69
v_mfma_f32_16x16x32_bf16 a[196:199], v[200:203], v[240:243], a[196:199]
s_add_u32 s69, s69, s84
ds_read_b64_tr_b16 v[230:231], v20 offset:9216
v_and_b32 v75, 0xffff0000, v69
v_mfma_f32_16x16x32_bf16 a[200:203], v[208:211], v[240:243], a[200:203]
s_lshl_b32 s71, s73, 19
ds_read_b128 v[128:131], v24 offset:0
v_lshlrev_b32 v76, 16, v33
v_mfma_f32_16x16x32_bf16 a[200:203], v[212:215], v[244:247], a[200:203]
s_add_u32 s71, s71, s66
ds_read_b128 v[132:135], v25 offset:0
v_lshlrev_b32 v77, 16, v34
v_mfma_f32_16x16x32_bf16 a[204:207], v[220:223], v[244:247], a[204:207]
s_add_u32 m0, s63, 98304
v_lshlrev_b32 v78, 16, v35
v_lshlrev_b32 v79, 16, v36
v_mfma_f32_16x16x32_bf16 a[204:207], v[216:219], v[240:243], a[204:207]
s_add_u32 s72, s69, 0
buffer_load_dwordx4 v2, s[8:11], s72 offen lds
v_mfma_f32_16x16x32_bf16 a[208:211], v[184:187], v[240:243], a[208:211]
s_add_u32 s72, s69, 7168
buffer_load_dwordx4 v3, s[8:11], s72 offen offset:1024 lds
v_mfma_f32_16x16x32_bf16 a[208:211], v[188:191], v[244:247], a[208:211]
s_add_u32 s72, s69, 14336
buffer_load_dwordx4 v2, s[8:11], s72 offen offset:2048 lds
v_mfma_f32_16x16x32_bf16 a[212:215], v[180:183], v[244:247], a[212:215]
ds_read_b128 v[136:139], v24 offset:2048
v_lshlrev_b32 v80, 16, v37
v_mfma_f32_16x16x32_bf16 a[212:215], v[176:179], v[240:243], a[212:215]
ds_read_b128 v[140:143], v25 offset:2048
v_lshlrev_b32 v81, 16, v38
v_mfma_f32_16x16x32_bf16 a[216:219], v[168:171], v[240:243], a[216:219]
s_add_u32 s72, s69, 21504
buffer_load_dwordx4 v3, s[8:11], s72 offen offset:3072 lds
v_mfma_f32_16x16x32_bf16 a[216:219], v[172:175], v[244:247], a[216:219]
ds_read_b128 v[144:147], v24 offset:4096
v_lshlrev_b32 v82, 16, v39
v_mfma_f32_16x16x32_bf16 a[220:223], v[164:167], v[244:247], a[220:223]
ds_read_b128 v[148:151], v25 offset:4096
v_lshlrev_b32 v83, 16, v40
v_mfma_f32_16x16x32_bf16 a[220:223], v[160:163], v[240:243], a[220:223]
ds_read_b128 v[152:155], v24 offset:6144
v_lshlrev_b32 v84, 16, v41
v_mfma_f32_16x16x32_bf16 a[252:255], v[160:163], v[248:251], a[252:255]
ds_read_b128 v[156:159], v25 offset:6144
v_lshlrev_b32 v85, 16, v42
v_mfma_f32_16x16x32_bf16 a[252:255], v[164:167], v[252:255], a[252:255]
s_add_u32 m0, s64, 32768
v_lshlrev_b32 v86, 16, v43
v_lshlrev_b32 v87, 16, v44
v_mfma_f32_16x16x32_bf16 a[248:251], v[172:175], v[252:255], a[248:251]
s_add_u32 s72, s71, 0
buffer_load_dwordx4 v6, s[16:19], s72 offen lds
v_mfma_f32_16x16x32_bf16 a[248:251], v[168:171], v[248:251], a[248:251]
ds_read_b128 v[160:163], v24 offset:8192
v_lshlrev_b32 v88, 16, v45
v_mfma_f32_16x16x32_bf16 a[244:247], v[176:179], v[248:251], a[244:247]
ds_read_b128 v[164:167], v25 offset:8192
v_lshlrev_b32 v89, 16, v46
v_mfma_f32_16x16x32_bf16 a[244:247], v[180:183], v[252:255], a[244:247]
s_add_u32 s72, s71, 31744
buffer_load_dwordx4 v6, s[16:19], s72 offen offset:1024 lds
v_mfma_f32_16x16x32_bf16 a[240:243], v[188:191], v[252:255], a[240:243]
ds_read_b128 v[168:171], v24 offset:10240
v_lshlrev_b32 v90, 16, v47
v_mfma_f32_16x16x32_bf16 a[240:243], v[184:187], v[248:251], a[240:243]
ds_read_b128 v[172:175], v25 offset:10240
v_lshlrev_b32 v91, 16, v48
v_mfma_f32_16x16x32_bf16 a[236:239], v[216:219], v[248:251], a[236:239]
ds_read_b128 v[176:179], v24 offset:12288
v_lshlrev_b32 v92, 16, v49
v_mfma_f32_16x16x32_bf16 a[236:239], v[220:223], v[252:255], a[236:239]
s_add_u32 s72, s71, 63488
buffer_load_dwordx4 v7, s[16:19], s72 offen offset:2048 lds
v_mfma_f32_16x16x32_bf16 a[232:235], v[212:215], v[252:255], a[232:235]
ds_read_b128 v[180:183], v25 offset:12288
v_lshlrev_b32 v93, 16, v50
v_mfma_f32_16x16x32_bf16 a[232:235], v[208:211], v[248:251], a[232:235]
ds_read_b128 v[184:187], v24 offset:14336
v_lshlrev_b32 v94, 16, v51
v_mfma_f32_16x16x32_bf16 a[228:231], v[200:203], v[248:251], a[228:231]
ds_read_b128 v[188:191], v25 offset:14336
v_mul_f32 v95, v75, v91
v_mfma_f32_16x16x32_bf16 a[228:231], v[204:207], v[252:255], a[228:231]
v_lshlrev_b32 v97, 16, v67
v_fmac_f32 v95, v74, v92
v_mfma_f32_16x16x32_bf16 a[224:227], v[196:199], v[252:255], a[224:227]
s_add_u32 s72, s71, 95232
buffer_load_dwordx4 v7, s[16:19], s72 offen offset:3072 lds
v_mfma_f32_16x16x32_bf16 a[224:227], v[192:195], v[248:251], a[224:227]
s_waitcnt lgkmcnt(8)
ds_read_b64_tr_b16 v[232:233], v21 offset:0
v_fmac_f32 v95, v73, v93
v_mfma_f32_16x16x32_bf16 a[0:3], v[224:227], v[128:131], a[0:3]
ds_read_b64_tr_b16 v[234:235], v21 offset:1024
v_fmac_f32 v95, v72, v94
v_mfma_f32_16x16x32_bf16 a[0:3], v[228:231], v[132:135], a[0:3]
ds_read_b64_tr_b16 v[240:241], v22 offset:0
v_mul_f32 v95, v95, v97
v_mfma_f32_16x16x32_bf16 a[4:7], v[228:231], v[140:143], a[4:7]
s_add_u32 m0, s63, 102400
ds_read_b64_tr_b16 v[236:237], v21 offset:8192
v_mul_f32 v96, v75, v90
v_mfma_f32_16x16x32_bf16 a[4:7], v[224:227], v[136:139], a[4:7]
s_add_u32 s72, s69, 32768
buffer_load_dwordx4 v2, s[8:11], s72 offen lds
v_mfma_f32_16x16x32_bf16 a[8:11], v[224:227], v[144:147], a[8:11]
ds_read_b64_tr_b16 v[238:239], v21 offset:9216
v_lshlrev_b32 v97, 16, v66
v_mfma_f32_16x16x32_bf16 a[8:11], v[228:231], v[148:151], a[8:11]
v_fmac_f32 v96, v74, v91
v_fmac_f32 v96, v73, v92
v_mfma_f32_16x16x32_bf16 a[12:15], v[228:231], v[156:159], a[12:15]
s_add_u32 s72, s69, 39936
buffer_load_dwordx4 v3, s[8:11], s72 offen offset:1024 lds
v_mfma_f32_16x16x32_bf16 a[12:15], v[224:227], v[152:155], a[12:15]
s_waitcnt lgkmcnt(5)
ds_read_b64_tr_b16 v[242:243], v22 offset:1024
v_fmac_f32 v96, v72, v93
v_mfma_f32_16x16x32_bf16 a[16:19], v[224:227], v[160:163], a[16:19]
v_mul_f32 v96, v96, v97
v_cvt_pk_bf16_f32 v100, v95, v96
v_mfma_f32_16x16x32_bf16 a[16:19], v[228:231], v[164:167], a[16:19]
ds_read_b64_tr_b16 v[244:245], v22 offset:8192
v_mul_f32 v95, v75, v89
v_mfma_f32_16x16x32_bf16 a[20:23], v[228:231], v[172:175], a[20:23]
v_lshlrev_b32 v97, 16, v65
v_fmac_f32 v95, v74, v90
v_mfma_f32_16x16x32_bf16 a[20:23], v[224:227], v[168:171], a[20:23]
s_add_u32 s72, s69, 47104
buffer_load_dwordx4 v2, s[8:11], s72 offen offset:2048 lds
v_mfma_f32_16x16x32_bf16 a[24:27], v[224:227], v[176:179], a[24:27]
ds_read_b64_tr_b16 v[246:247], v22 offset:9216
v_fmac_f32 v95, v73, v91
v_mfma_f32_16x16x32_bf16 a[24:27], v[228:231], v[180:183], a[24:27]
v_fmac_f32 v95, v72, v92
v_mul_f32 v95, v95, v97
v_mfma_f32_16x16x32_bf16 a[28:31], v[228:231], v[188:191], a[28:31]
v_mul_f32 v96, v75, v88
v_lshlrev_b32 v97, 16, v64
v_mfma_f32_16x16x32_bf16 a[28:31], v[224:227], v[184:187], a[28:31]
s_waitcnt lgkmcnt(3)
v_fmac_f32 v96, v74, v89
v_fmac_f32 v96, v73, v90
v_mfma_f32_16x16x32_bf16 a[60:63], v[232:235], v[184:187], a[60:63]
s_add_u32 s72, s69, 54272
buffer_load_dwordx4 v3, s[8:11], s72 offen offset:3072 lds
v_mfma_f32_16x16x32_bf16 a[60:63], v[236:239], v[188:191], a[60:63]
ds_read_b64_tr_b16 v[248:249], v23 offset:0
v_fmac_f32 v96, v72, v91
v_mfma_f32_16x16x32_bf16 a[56:59], v[236:239], v[180:183], a[56:59]
v_mul_f32 v96, v96, v97
v_cvt_pk_bf16_f32 v101, v95, v96
v_mfma_f32_16x16x32_bf16 a[56:59], v[232:235], v[176:179], a[56:59]
s_add_u32 m0, s64, 49152
ds_read_b64_tr_b16 v[250:251], v23 offset:1024
v_mul_f32 v95, v75, v87
v_mfma_f32_16x16x32_bf16 a[52:55], v[232:235], v[168:171], a[52:55]
s_add_u32 s72, s71, 0
buffer_load_dwordx4 v6, s[20:23], s72 offen lds
v_mfma_f32_16x16x32_bf16 a[52:55], v[236:239], v[172:175], a[52:55]
v_lshlrev_b32 v97, 16, v63
v_fmac_f32 v95, v74, v88
v_mfma_f32_16x16x32_bf16 a[48:51], v[236:239], v[164:167], a[48:51]
v_fmac_f32 v95, v73, v89
v_fmac_f32 v95, v72, v90
v_mfma_f32_16x16x32_bf16 a[48:51], v[232:235], v[160:163], a[48:51]
ds_read_b64_tr_b16 v[252:253], v23 offset:8192
v_mul_f32 v95, v95, v97
v_mfma_f32_16x16x32_bf16 a[44:47], v[232:235], v[152:155], a[44:47]
s_add_u32 s72, s71, 31744
buffer_load_dwordx4 v6, s[20:23], s72 offen offset:1024 lds
v_mfma_f32_16x16x32_bf16 a[44:47], v[236:239], v[156:159], a[44:47]
v_mul_f32 v96, v75, v86
v_lshlrev_b32 v97, 16, v62
v_mfma_f32_16x16x32_bf16 a[40:43], v[236:239], v[148:151], a[40:43]
ds_read_b64_tr_b16 v[254:255], v23 offset:9216
v_fmac_f32 v96, v74, v87
v_mfma_f32_16x16x32_bf16 a[40:43], v[232:235], v[144:147], a[40:43]
v_fmac_f32 v96, v73, v88
v_fmac_f32 v96, v72, v89
v_mfma_f32_16x16x32_bf16 a[36:39], v[232:235], v[136:139], a[36:39]
s_add_u32 s72, s71, 63488
buffer_load_dwordx4 v7, s[20:23], s72 offen offset:2048 lds
v_mfma_f32_16x16x32_bf16 a[36:39], v[236:239], v[140:143], a[36:39]
v_mul_f32 v96, v96, v97
v_cvt_pk_bf16_f32 v102, v95, v96
v_mfma_f32_16x16x32_bf16 a[32:35], v[236:239], v[132:135], a[32:35]
v_mul_f32 v95, v75, v85
v_lshlrev_b32 v97, 16, v61
v_mfma_f32_16x16x32_bf16 a[32:35], v[232:235], v[128:131], a[32:35]
s_waitcnt lgkmcnt(4)
v_fmac_f32 v95, v74, v86
v_fmac_f32 v95, v73, v87
v_mfma_f32_16x16x32_bf16 a[64:67], v[240:243], v[128:131], a[64:67]
s_add_u32 s72, s71, 95232
buffer_load_dwordx4 v7, s[20:23], s72 offen offset:3072 lds
v_mfma_f32_16x16x32_bf16 a[64:67], v[244:247], v[132:135], a[64:67]
s_mov_b32 s80, 0x0
buffer_load_dword v126, v125, s[12:15], s80 offen
v_mfma_f32_16x16x32_bf16 a[68:71], v[244:247], v[140:143], a[68:71]
s_mov_b32 s80, 0x100000
buffer_load_dword v126, v125, s[12:15], s80 offen
v_mfma_f32_16x16x32_bf16 a[68:71], v[240:243], v[136:139], a[68:71]
s_mov_b32 s80, 0x200000
buffer_load_dword v126, v125, s[12:15], s80 offen
v_mfma_f32_16x16x32_bf16 a[72:75], v[240:243], v[144:147], a[72:75]
s_mov_b32 s80, 0x300000
buffer_load_dword v126, v125, s[12:15], s80 offen
v_mfma_f32_16x16x32_bf16 a[72:75], v[244:247], v[148:151], a[72:75]
ds_read_b64_tr_b16 v[224:225], v20 offset:16384
v_fmac_f32 v95, v72, v88
v_mfma_f32_16x16x32_bf16 a[76:79], v[244:247], v[156:159], a[76:79]
v_mul_f32 v95, v95, v97
v_mul_f32 v96, v75, v84
v_mfma_f32_16x16x32_bf16 a[76:79], v[240:243], v[152:155], a[76:79]
ds_read_b64_tr_b16 v[226:227], v20 offset:17408
v_lshlrev_b32 v97, 16, v60
v_mfma_f32_16x16x32_bf16 a[80:83], v[240:243], v[160:163], a[80:83]
v_fmac_f32 v96, v74, v85
v_fmac_f32 v96, v73, v86
v_mfma_f32_16x16x32_bf16 a[80:83], v[244:247], v[164:167], a[80:83]
ds_read_b64_tr_b16 v[228:229], v20 offset:24576
v_fmac_f32 v96, v72, v87
v_mfma_f32_16x16x32_bf16 a[84:87], v[244:247], v[172:175], a[84:87]
v_mul_f32 v96, v96, v97
v_cvt_pk_bf16_f32 v103, v95, v96
v_mfma_f32_16x16x32_bf16 a[84:87], v[240:243], v[168:171], a[84:87]
ds_read_b64_tr_b16 v[230:231], v20 offset:25600
ds_write_b128 v28, v[100:103] offset:0
v_mfma_f32_16x16x32_bf16 a[88:91], v[240:243], v[176:179], a[88:91]
v_mul_f32 v95, v75, v83
v_lshlrev_b32 v97, 16, v59
v_mfma_f32_16x16x32_bf16 a[88:91], v[244:247], v[180:183], a[88:91]
v_fmac_f32 v95, v74, v84
v_fmac_f32 v95, v73, v85
v_mfma_f32_16x16x32_bf16 a[92:95], v[244:247], v[188:191], a[92:95]
v_fmac_f32 v95, v72, v86
v_mul_f32 v95, v95, v97
v_mfma_f32_16x16x32_bf16 a[92:95], v[240:243], v[184:187], a[92:95]
s_waitcnt lgkmcnt(5)
v_mul_f32 v96, v75, v82
v_lshlrev_b32 v97, 16, v58
v_mfma_f32_16x16x32_bf16 a[124:127], v[248:251], v[184:187], a[124:127]
ds_read_b64_tr_b16 v[232:233], v21 offset:16384
v_fmac_f32 v96, v74, v83
v_mfma_f32_16x16x32_bf16 a[124:127], v[252:255], v[188:191], a[124:127]
v_fmac_f32 v96, v73, v84
v_fmac_f32 v96, v72, v85
v_mfma_f32_16x16x32_bf16 a[120:123], v[252:255], v[180:183], a[120:123]
v_mul_f32 v96, v96, v97
v_cvt_pk_bf16_f32 v104, v95, v96
v_mfma_f32_16x16x32_bf16 a[120:123], v[248:251], v[176:179], a[120:123]
ds_read_b64_tr_b16 v[234:235], v21 offset:17408
v_mul_f32 v95, v75, v81
v_mfma_f32_16x16x32_bf16 a[116:119], v[248:251], v[168:171], a[116:119]
v_lshlrev_b32 v97, 16, v57
v_fmac_f32 v95, v74, v82
v_mfma_f32_16x16x32_bf16 a[116:119], v[252:255], v[172:175], a[116:119]
v_fmac_f32 v95, v73, v83
v_fmac_f32 v95, v72, v84
v_mfma_f32_16x16x32_bf16 a[112:115], v[252:255], v[164:167], a[112:115]
v_mul_f32 v95, v95, v97
v_mul_f32 v96, v75, v80
v_mfma_f32_16x16x32_bf16 a[112:115], v[248:251], v[160:163], a[112:115]
ds_read_b64_tr_b16 v[236:237], v21 offset:24576
v_lshlrev_b32 v97, 16, v56
v_mfma_f32_16x16x32_bf16 a[108:111], v[248:251], v[152:155], a[108:111]
v_fmac_f32 v96, v74, v81
v_fmac_f32 v96, v73, v82
v_mfma_f32_16x16x32_bf16 a[108:111], v[252:255], v[156:159], a[108:111]
v_fmac_f32 v96, v72, v83
v_mul_f32 v96, v96, v97
v_mfma_f32_16x16x32_bf16 a[104:107], v[252:255], v[148:151], a[104:107]
ds_read_b64_tr_b16 v[238:239], v21 offset:25600
v_cvt_pk_bf16_f32 v105, v95, v96
v_mfma_f32_16x16x32_bf16 a[104:107], v[248:251], v[144:147], a[104:107]
v_mul_f32 v95, v75, v79
v_lshlrev_b32 v97, 16, v55
v_mfma_f32_16x16x32_bf16 a[100:103], v[248:251], v[136:139], a[100:103]
v_fmac_f32 v95, v74, v80
v_fmac_f32 v95, v73, v81
v_mfma_f32_16x16x32_bf16 a[100:103], v[252:255], v[140:143], a[100:103]
v_fmac_f32 v95, v72, v82
v_mul_f32 v95, v95, v97
v_mfma_f32_16x16x32_bf16 a[96:99], v[252:255], v[132:135], a[96:99]
v_mul_f32 v96, v75, v78
v_lshlrev_b32 v97, 16, v54
v_mfma_f32_16x16x32_bf16 a[96:99], v[248:251], v[128:131], a[96:99]
s_waitcnt lgkmcnt(5)
v_fmac_f32 v96, v74, v79
v_fmac_f32 v96, v73, v80
v_mfma_f32_16x16x32_bf16 a[128:131], v[128:131], v[224:227], a[128:131]
ds_read_b64_tr_b16 v[240:241], v22 offset:16384
v_fmac_f32 v96, v72, v81
v_mfma_f32_16x16x32_bf16 a[128:131], v[132:135], v[228:231], a[128:131]
v_mul_f32 v96, v96, v97
v_cvt_pk_bf16_f32 v106, v95, v96
v_mfma_f32_16x16x32_bf16 a[132:135], v[140:143], v[228:231], a[132:135]
v_mul_f32 v95, v75, v77
v_lshlrev_b32 v97, 16, v53
v_mfma_f32_16x16x32_bf16 a[132:135], v[136:139], v[224:227], a[132:135]
ds_read_b64_tr_b16 v[242:243], v22 offset:17408
v_fmac_f32 v95, v74, v78
v_mfma_f32_16x16x32_bf16 a[136:139], v[144:147], v[224:227], a[136:139]
v_fmac_f32 v95, v73, v79
v_fmac_f32 v95, v72, v80
v_mfma_f32_16x16x32_bf16 a[136:139], v[148:151], v[228:231], a[136:139]
v_mul_f32 v95, v95, v97
v_mul_f32 v96, v75, v76
v_mfma_f32_16x16x32_bf16 a[140:143], v[156:159], v[228:231], a[140:143]
v_lshlrev_b32 v97, 16, v52
v_fmac_f32 v96, v74, v77
v_mfma_f32_16x16x32_bf16 a[140:143], v[152:155], v[224:227], a[140:143]
ds_read_b64_tr_b16 v[244:245], v22 offset:24576
v_fmac_f32 v96, v73, v78
v_mfma_f32_16x16x32_bf16 a[144:147], v[160:163], v[224:227], a[144:147]
v_fmac_f32 v96, v72, v79
v_mul_f32 v96, v96, v97
v_mfma_f32_16x16x32_bf16 a[144:147], v[164:167], v[228:231], a[144:147]
v_cvt_pk_bf16_f32 v107, v95, v96
v_mfma_f32_16x16x32_bf16 a[148:151], v[172:175], v[228:231], a[148:151]
ds_read_b64_tr_b16 v[246:247], v22 offset:25600
ds_write_b128 v28, v[104:107] offset:16
v_mfma_f32_16x16x32_bf16 a[148:151], v[168:171], v[224:227], a[148:151]
global_load_dwordx4 v[84:87], v1, s[56:57]
v_mfma_f32_16x16x32_bf16 a[152:155], v[176:179], v[224:227], a[152:155]
global_load_dwordx4 v[88:91], v1, s[56:57] offset:1024
v_mfma_f32_16x16x32_bf16 a[152:155], v[180:183], v[228:231], a[152:155]
v_lshlrev_b32 v72, 16, v70
v_and_b32 v73, 0xffff0000, v70
v_mfma_f32_16x16x32_bf16 a[156:159], v[188:191], v[228:231], a[156:159]
v_lshlrev_b32 v74, 16, v71
v_and_b32 v75, 0xffff0000, v71
v_mfma_f32_16x16x32_bf16 a[156:159], v[184:187], v[224:227], a[156:159]
s_waitcnt lgkmcnt(5)
v_and_b32 v33, 0xffff0000, v33
v_and_b32 v34, 0xffff0000, v34
v_mfma_f32_16x16x32_bf16 a[188:191], v[184:187], v[232:235], a[188:191]
ds_read_b64_tr_b16 v[248:249], v23 offset:16384
v_and_b32 v35, 0xffff0000, v35
v_mfma_f32_16x16x32_bf16 a[188:191], v[188:191], v[236:239], a[188:191]
v_and_b32 v36, 0xffff0000, v36
v_and_b32 v37, 0xffff0000, v37
v_mfma_f32_16x16x32_bf16 a[184:187], v[180:183], v[236:239], a[184:187]
ds_read_b64_tr_b16 v[250:251], v23 offset:17408
v_and_b32 v38, 0xffff0000, v38
v_mfma_f32_16x16x32_bf16 a[184:187], v[176:179], v[232:235], a[184:187]
v_and_b32 v39, 0xffff0000, v39
v_and_b32 v40, 0xffff0000, v40
v_mfma_f32_16x16x32_bf16 a[180:183], v[168:171], v[232:235], a[180:183]
ds_read_b64_tr_b16 v[252:253], v23 offset:24576
v_and_b32 v41, 0xffff0000, v41
v_mfma_f32_16x16x32_bf16 a[180:183], v[172:175], v[236:239], a[180:183]
v_and_b32 v42, 0xffff0000, v42
v_and_b32 v43, 0xffff0000, v43
v_mfma_f32_16x16x32_bf16 a[176:179], v[164:167], v[236:239], a[176:179]
ds_read_b64_tr_b16 v[254:255], v23 offset:25600
v_and_b32 v44, 0xffff0000, v44
v_mfma_f32_16x16x32_bf16 a[176:179], v[160:163], v[232:235], a[176:179]
v_and_b32 v45, 0xffff0000, v45
v_and_b32 v46, 0xffff0000, v46
v_mfma_f32_16x16x32_bf16 a[172:175], v[152:155], v[232:235], a[172:175]
v_and_b32 v47, 0xffff0000, v47
v_and_b32 v48, 0xffff0000, v48
v_mfma_f32_16x16x32_bf16 a[172:175], v[156:159], v[236:239], a[172:175]
v_and_b32 v49, 0xffff0000, v49
v_and_b32 v50, 0xffff0000, v50
v_mfma_f32_16x16x32_bf16 a[168:171], v[148:151], v[236:239], a[168:171]
v_and_b32 v51, 0xffff0000, v51
v_mul_f32 v95, v75, v48
v_mfma_f32_16x16x32_bf16 a[168:171], v[144:147], v[232:235], a[168:171]
v_and_b32 v97, 0xffff0000, v67
v_fmac_f32 v95, v74, v49
v_mfma_f32_16x16x32_bf16 a[164:167], v[136:139], v[232:235], a[164:167]
v_fmac_f32 v95, v73, v50
v_fmac_f32 v95, v72, v51
v_mfma_f32_16x16x32_bf16 a[164:167], v[140:143], v[236:239], a[164:167]
v_mul_f32 v95, v95, v97
v_mul_f32 v96, v75, v47
v_mfma_f32_16x16x32_bf16 a[160:163], v[132:135], v[236:239], a[160:163]
s_waitcnt vmcnt(6) lgkmcnt(0)
v_and_b32 v97, 0xffff0000, v66
v_fmac_f32 v96, v74, v48
v_mfma_f32_16x16x32_bf16 a[160:163], v[128:131], v[232:235], a[160:163]
s_barrier
v_fmac_f32 v96, v73, v49
v_fmac_f32 v96, v72, v50
v_mfma_f32_16x16x32_bf16 a[192:195], v[128:131], v[240:243], a[192:195]
s_and_b32 s73, s65, 1
ds_read_b64_tr_b16 v[224:225], v20 offset:32768
v_mul_f32 v96, v96, v97
v_mfma_f32_16x16x32_bf16 a[192:195], v[132:135], v[244:247], a[192:195]
s_xor_b32 s73, s73, 6
ds_read_b64_tr_b16 v[226:227], v20 offset:33792
v_cvt_pk_bf16_f32 v100, v95, v96
v_mfma_f32_16x16x32_bf16 a[196:199], v[140:143], v[244:247], a[196:199]
s_lshl_b32 s69, s73, 7
ds_read_b64_tr_b16 v[228:229], v20 offset:40960
v_mul_f32 v95, v75, v46
v_mfma_f32_16x16x32_bf16 a[196:199], v[136:139], v[240:243], a[196:199]
s_add_u32 s69, s69, s84
ds_read_b64_tr_b16 v[230:231], v20 offset:41984
v_and_b32 v97, 0xffff0000, v65
v_mfma_f32_16x16x32_bf16 a[200:203], v[144:147], v[240:243], a[200:203]
s_lshl_b32 s71, s73, 19
ds_read_b128 v[192:195], v24 offset:32768
v_fmac_f32 v95, v74, v47
v_mfma_f32_16x16x32_bf16 a[200:203], v[148:151], v[244:247], a[200:203]
s_add_u32 s71, s71, s66
ds_read_b128 v[196:199], v25 offset:32768
v_fmac_f32 v95, v73, v48
v_mfma_f32_16x16x32_bf16 a[204:207], v[156:159], v[244:247], a[204:207]
s_add_u32 m0, s63, 65536
v_fmac_f32 v95, v72, v49
v_mul_f32 v95, v95, v97
v_mfma_f32_16x16x32_bf16 a[204:207], v[152:155], v[240:243], a[204:207]
s_add_u32 s72, s69, 0
buffer_load_dwordx4 v2, s[8:11], s72 offen lds
v_mfma_f32_16x16x32_bf16 a[208:211], v[160:163], v[240:243], a[208:211]
s_add_u32 s72, s69, 7168
buffer_load_dwordx4 v3, s[8:11], s72 offen offset:1024 lds
v_mfma_f32_16x16x32_bf16 a[208:211], v[164:167], v[244:247], a[208:211]
s_add_u32 s72, s69, 14336
buffer_load_dwordx4 v2, s[8:11], s72 offen offset:2048 lds
v_mfma_f32_16x16x32_bf16 a[212:215], v[172:175], v[244:247], a[212:215]
ds_read_b128 v[200:203], v24 offset:34816
v_mul_f32 v96, v75, v45
v_mfma_f32_16x16x32_bf16 a[212:215], v[168:171], v[240:243], a[212:215]
ds_read_b128 v[204:207], v25 offset:34816
v_and_b32 v97, 0xffff0000, v64
v_mfma_f32_16x16x32_bf16 a[216:219], v[176:179], v[240:243], a[216:219]
s_add_u32 s72, s69, 21504
buffer_load_dwordx4 v3, s[8:11], s72 offen offset:3072 lds
v_mfma_f32_16x16x32_bf16 a[216:219], v[180:183], v[244:247], a[216:219]
ds_read_b128 v[208:211], v24 offset:36864
v_fmac_f32 v96, v74, v46
v_mfma_f32_16x16x32_bf16 a[220:223], v[188:191], v[244:247], a[220:223]
ds_read_b128 v[212:215], v25 offset:36864
v_fmac_f32 v96, v73, v47
v_mfma_f32_16x16x32_bf16 a[220:223], v[184:187], v[240:243], a[220:223]
ds_read_b128 v[216:219], v24 offset:38912
v_fmac_f32 v96, v72, v48
v_mfma_f32_16x16x32_bf16 a[252:255], v[184:187], v[248:251], a[252:255]
ds_read_b128 v[220:223], v25 offset:38912
v_mul_f32 v96, v96, v97
v_mfma_f32_16x16x32_bf16 a[252:255], v[188:191], v[252:255], a[252:255]
s_add_u32 m0, s64, 0
v_cvt_pk_bf16_f32 v101, v95, v96
v_mul_f32 v95, v75, v44
v_mfma_f32_16x16x32_bf16 a[248:251], v[180:183], v[252:255], a[248:251]
s_add_u32 s72, s71, 0
buffer_load_dwordx4 v6, s[16:19], s72 offen lds
v_mfma_f32_16x16x32_bf16 a[248:251], v[176:179], v[248:251], a[248:251]
ds_read_b128 v[184:187], v24 offset:40960
v_and_b32 v97, 0xffff0000, v63
v_mfma_f32_16x16x32_bf16 a[244:247], v[168:171], v[248:251], a[244:247]
ds_read_b128 v[188:191], v25 offset:40960
v_fmac_f32 v95, v74, v45
v_mfma_f32_16x16x32_bf16 a[244:247], v[172:175], v[252:255], a[244:247]
s_add_u32 s72, s71, 31744
buffer_load_dwordx4 v6, s[16:19], s72 offen offset:1024 lds
v_mfma_f32_16x16x32_bf16 a[240:243], v[164:167], v[252:255], a[240:243]
ds_read_b128 v[176:179], v24 offset:43008
v_fmac_f32 v95, v73, v46
v_mfma_f32_16x16x32_bf16 a[240:243], v[160:163], v[248:251], a[240:243]
ds_read_b128 v[180:183], v25 offset:43008
v_fmac_f32 v95, v72, v47
v_mfma_f32_16x16x32_bf16 a[236:239], v[152:155], v[248:251], a[236:239]
ds_read_b128 v[168:171], v24 offset:45056
v_mul_f32 v95, v95, v97
v_mfma_f32_16x16x32_bf16 a[236:239], v[156:159], v[252:255], a[236:239]
s_add_u32 s72, s71, 63488
buffer_load_dwordx4 v7, s[16:19], s72 offen offset:2048 lds
v_mfma_f32_16x16x32_bf16 a[232:235], v[148:151], v[252:255], a[232:235]
ds_read_b128 v[172:175], v25 offset:45056
v_mul_f32 v96, v75, v43
v_mfma_f32_16x16x32_bf16 a[232:235], v[144:147], v[248:251], a[232:235]
ds_read_b128 v[160:163], v24 offset:47104
v_and_b32 v97, 0xffff0000, v62
v_mfma_f32_16x16x32_bf16 a[228:231], v[136:139], v[248:251], a[228:231]
ds_read_b128 v[164:167], v25 offset:47104
v_fmac_f32 v96, v74, v44
v_mfma_f32_16x16x32_bf16 a[228:231], v[140:143], v[252:255], a[228:231]
v_fmac_f32 v96, v73, v45
v_fmac_f32 v96, v72, v46
v_mfma_f32_16x16x32_bf16 a[224:227], v[132:135], v[252:255], a[224:227]
s_add_u32 s72, s71, 95232
buffer_load_dwordx4 v7, s[16:19], s72 offen offset:3072 lds
v_mfma_f32_16x16x32_bf16 a[224:227], v[128:131], v[248:251], a[224:227]
s_waitcnt lgkmcnt(8)
ds_read_b64_tr_b16 v[232:233], v21 offset:32768
v_mul_f32 v96, v96, v97
v_mfma_f32_16x16x32_bf16 a[0:3], v[224:227], v[192:195], a[0:3]
ds_read_b64_tr_b16 v[234:235], v21 offset:33792
v_cvt_pk_bf16_f32 v102, v95, v96
v_mfma_f32_16x16x32_bf16 a[0:3], v[228:231], v[196:199], a[0:3]
ds_read_b64_tr_b16 v[240:241], v22 offset:32768
v_mul_f32 v95, v75, v42
v_mfma_f32_16x16x32_bf16 a[4:7], v[228:231], v[204:207], a[4:7]
s_add_u32 m0, s63, 69632
ds_read_b64_tr_b16 v[236:237], v21 offset:40960
v_and_b32 v97, 0xffff0000, v61
v_mfma_f32_16x16x32_bf16 a[4:7], v[224:227], v[200:203], a[4:7]
s_add_u32 s72, s69, 32768
buffer_load_dwordx4 v2, s[8:11], s72 offen lds
v_mfma_f32_16x16x32_bf16 a[8:11], v[224:227], v[208:211], a[8:11]
ds_read_b64_tr_b16 v[238:239], v21 offset:41984
v_fmac_f32 v95, v74, v43
v_mfma_f32_16x16x32_bf16 a[8:11], v[228:231], v[212:215], a[8:11]
v_fmac_f32 v95, v73, v44
v_fmac_f32 v95, v72, v45
v_mfma_f32_16x16x32_bf16 a[12:15], v[228:231], v[220:223], a[12:15]
s_add_u32 s72, s69, 39936
buffer_load_dwordx4 v3, s[8:11], s72 offen offset:1024 lds
v_mfma_f32_16x16x32_bf16 a[12:15], v[224:227], v[216:219], a[12:15]
s_waitcnt lgkmcnt(5)
ds_read_b64_tr_b16 v[242:243], v22 offset:33792
v_mul_f32 v95, v95, v97
v_mfma_f32_16x16x32_bf16 a[16:19], v[224:227], v[184:187], a[16:19]
v_mul_f32 v96, v75, v41
v_and_b32 v97, 0xffff0000, v60
v_mfma_f32_16x16x32_bf16 a[16:19], v[228:231], v[188:191], a[16:19]
ds_read_b64_tr_b16 v[244:245], v22 offset:40960
v_fmac_f32 v96, v74, v42
v_mfma_f32_16x16x32_bf16 a[20:23], v[228:231], v[180:183], a[20:23]
v_fmac_f32 v96, v73, v43
v_fmac_f32 v96, v72, v44
v_mfma_f32_16x16x32_bf16 a[20:23], v[224:227], v[176:179], a[20:23]
s_add_u32 s72, s69, 47104
buffer_load_dwordx4 v2, s[8:11], s72 offen offset:2048 lds
v_mfma_f32_16x16x32_bf16 a[24:27], v[224:227], v[168:171], a[24:27]
ds_read_b64_tr_b16 v[246:247], v22 offset:41984
v_mul_f32 v96, v96, v97
v_mfma_f32_16x16x32_bf16 a[24:27], v[228:231], v[172:175], a[24:27]
v_cvt_pk_bf16_f32 v103, v95, v96
v_mfma_f32_16x16x32_bf16 a[28:31], v[228:231], v[164:167], a[28:31]
ds_write_b128 v28, v[100:103] offset:272
v_mul_f32 v95, v75, v40
v_mfma_f32_16x16x32_bf16 a[28:31], v[224:227], v[160:163], a[28:31]
s_waitcnt lgkmcnt(4)
v_and_b32 v97, 0xffff0000, v59
v_fmac_f32 v95, v74, v41
v_mfma_f32_16x16x32_bf16 a[60:63], v[232:235], v[160:163], a[60:63]
s_add_u32 s72, s69, 54272
buffer_load_dwordx4 v3, s[8:11], s72 offen offset:3072 lds
v_mfma_f32_16x16x32_bf16 a[60:63], v[236:239], v[164:167], a[60:63]
ds_read_b64_tr_b16 v[248:249], v23 offset:32768
v_fmac_f32 v95, v73, v42
v_mfma_f32_16x16x32_bf16 a[56:59], v[236:239], v[172:175], a[56:59]
v_fmac_f32 v95, v72, v43
v_mul_f32 v95, v95, v97
v_mfma_f32_16x16x32_bf16 a[56:59], v[232:235], v[168:171], a[56:59]
s_add_u32 m0, s64, 16384
ds_read_b64_tr_b16 v[250:251], v23 offset:33792
v_mul_f32 v96, v75, v39
v_mfma_f32_16x16x32_bf16 a[52:55], v[232:235], v[176:179], a[52:55]
s_add_u32 s72, s71, 0
buffer_load_dwordx4 v6, s[20:23], s72 offen lds
v_mfma_f32_16x16x32_bf16 a[52:55], v[236:239], v[180:183], a[52:55]
v_and_b32 v97, 0xffff0000, v58
v_fmac_f32 v96, v74, v40
v_mfma_f32_16x16x32_bf16 a[48:51], v[236:239], v[188:191], a[48:51]
v_fmac_f32 v96, v73, v41
v_fmac_f32 v96, v72, v42
v_mfma_f32_16x16x32_bf16 a[48:51], v[232:235], v[184:187], a[48:51]
ds_read_b64_tr_b16 v[252:253], v23 offset:40960
v_mul_f32 v96, v96, v97
v_mfma_f32_16x16x32_bf16 a[44:47], v[232:235], v[216:219], a[44:47]
s_add_u32 s72, s71, 31744
buffer_load_dwordx4 v6, s[20:23], s72 offen offset:1024 lds
v_mfma_f32_16x16x32_bf16 a[44:47], v[236:239], v[220:223], a[44:47]
v_cvt_pk_bf16_f32 v104, v95, v96
v_mul_f32 v95, v75, v38
v_mfma_f32_16x16x32_bf16 a[40:43], v[236:239], v[212:215], a[40:43]
ds_read_b64_tr_b16 v[254:255], v23 offset:41984
v_and_b32 v97, 0xffff0000, v57
v_mfma_f32_16x16x32_bf16 a[40:43], v[232:235], v[208:211], a[40:43]
v_fmac_f32 v95, v74, v39
v_fmac_f32 v95, v73, v40
v_mfma_f32_16x16x32_bf16 a[36:39], v[232:235], v[200:203], a[36:39]
s_add_u32 s72, s71, 63488
buffer_load_dwordx4 v7, s[20:23], s72 offen offset:2048 lds
v_mfma_f32_16x16x32_bf16 a[36:39], v[236:239], v[204:207], a[36:39]
v_fmac_f32 v95, v72, v41
v_mul_f32 v95, v95, v97
v_mfma_f32_16x16x32_bf16 a[32:35], v[236:239], v[196:199], a[32:35]
v_mul_f32 v96, v75, v37
v_and_b32 v97, 0xffff0000, v56
v_mfma_f32_16x16x32_bf16 a[32:35], v[232:235], v[192:195], a[32:35]
s_waitcnt lgkmcnt(5)
v_fmac_f32 v96, v74, v38
v_fmac_f32 v96, v73, v39
v_mfma_f32_16x16x32_bf16 a[64:67], v[240:243], v[192:195], a[64:67]
s_add_u32 s72, s71, 95232
buffer_load_dwordx4 v7, s[20:23], s72 offen offset:3072 lds
v_mfma_f32_16x16x32_bf16 a[64:67], v[244:247], v[196:199], a[64:67]
s_mov_b32 s80, 0x400000
buffer_load_dword v126, v125, s[12:15], s80 offen
v_mfma_f32_16x16x32_bf16 a[68:71], v[244:247], v[204:207], a[68:71]
s_mov_b32 s80, 0x500000
buffer_load_dword v126, v125, s[12:15], s80 offen
v_mfma_f32_16x16x32_bf16 a[68:71], v[240:243], v[200:203], a[68:71]
s_mov_b32 s80, 0x600000
buffer_load_dword v126, v125, s[12:15], s80 offen
v_mfma_f32_16x16x32_bf16 a[72:75], v[240:243], v[208:211], a[72:75]
s_mov_b32 s80, 0x700000
buffer_load_dword v126, v125, s[12:15], s80 offen
v_mfma_f32_16x16x32_bf16 a[72:75], v[244:247], v[212:215], a[72:75]
ds_read_b64_tr_b16 v[224:225], v20 offset:49152
v_fmac_f32 v96, v72, v40
v_mfma_f32_16x16x32_bf16 a[76:79], v[244:247], v[220:223], a[76:79]
v_mul_f32 v96, v96, v97
v_cvt_pk_bf16_f32 v105, v95, v96
v_mfma_f32_16x16x32_bf16 a[76:79], v[240:243], v[216:219], a[76:79]
ds_read_b64_tr_b16 v[226:227], v20 offset:50176
v_mul_f32 v95, v75, v36
v_mfma_f32_16x16x32_bf16 a[80:83], v[240:243], v[184:187], a[80:83]
v_and_b32 v97, 0xffff0000, v55
v_fmac_f32 v95, v74, v37
v_mfma_f32_16x16x32_bf16 a[80:83], v[244:247], v[188:191], a[80:83]
ds_read_b64_tr_b16 v[228:229], v20 offset:57344
v_fmac_f32 v95, v73, v38
v_mfma_f32_16x16x32_bf16 a[84:87], v[244:247], v[180:183], a[84:87]
v_fmac_f32 v95, v72, v39
v_mul_f32 v95, v95, v97
v_mfma_f32_16x16x32_bf16 a[84:87], v[240:243], v[176:179], a[84:87]
ds_read_b64_tr_b16 v[230:231], v20 offset:58368
v_mul_f32 v96, v75, v35
v_mfma_f32_16x16x32_bf16 a[88:91], v[240:243], v[168:171], a[88:91]
v_and_b32 v97, 0xffff0000, v54
v_fmac_f32 v96, v74, v36
v_mfma_f32_16x16x32_bf16 a[88:91], v[244:247], v[172:175], a[88:91]
v_fmac_f32 v96, v73, v37
v_fmac_f32 v96, v72, v38
v_mfma_f32_16x16x32_bf16 a[92:95], v[244:247], v[164:167], a[92:95]
v_mul_f32 v96, v96, v97
v_cvt_pk_bf16_f32 v106, v95, v96
v_mfma_f32_16x16x32_bf16 a[92:95], v[240:243], v[160:163], a[92:95]
s_waitcnt lgkmcnt(4)
v_mul_f32 v95, v75, v34
v_and_b32 v97, 0xffff0000, v53
v_mfma_f32_16x16x32_bf16 a[124:127], v[248:251], v[160:163], a[124:127]
ds_read_b64_tr_b16 v[232:233], v21 offset:49152
v_fmac_f32 v95, v74, v35
v_mfma_f32_16x16x32_bf16 a[124:127], v[252:255], v[164:167], a[124:127]
v_fmac_f32 v95, v73, v36
v_fmac_f32 v95, v72, v37
v_mfma_f32_16x16x32_bf16 a[120:123], v[252:255], v[172:175], a[120:123]
v_mul_f32 v95, v95, v97
v_mul_f32 v96, v75, v33
v_mfma_f32_16x16x32_bf16 a[120:123], v[248:251], v[168:171], a[120:123]
ds_read_b64_tr_b16 v[234:235], v21 offset:50176
v_and_b32 v97, 0xffff0000, v52
v_mfma_f32_16x16x32_bf16 a[116:119], v[248:251], v[176:179], a[116:119]
v_fmac_f32 v96, v74, v34
v_fmac_f32 v96, v73, v35
v_mfma_f32_16x16x32_bf16 a[116:119], v[252:255], v[180:183], a[116:119]
v_fmac_f32 v96, v72, v36
v_mul_f32 v96, v96, v97
v_mfma_f32_16x16x32_bf16 a[112:115], v[252:255], v[188:191], a[112:115]
v_cvt_pk_bf16_f32 v107, v95, v96
v_mfma_f32_16x16x32_bf16 a[112:115], v[248:251], v[184:187], a[112:115]
ds_read_b64_tr_b16 v[236:237], v21 offset:57344
ds_write_b128 v28, v[104:107] offset:288
v_mfma_f32_16x16x32_bf16 a[108:111], v[248:251], v[216:219], a[108:111]
v_mfma_f32_16x16x32_bf16 a[108:111], v[252:255], v[220:223], a[108:111]
v_mfma_f32_16x16x32_bf16 a[104:107], v[252:255], v[212:215], a[104:107]
ds_read_b64_tr_b16 v[238:239], v21 offset:58368
v_mfma_f32_16x16x32_bf16 a[104:107], v[248:251], v[208:211], a[104:107]
v_mfma_f32_16x16x32_bf16 a[100:103], v[248:251], v[200:203], a[100:103]
v_mfma_f32_16x16x32_bf16 a[100:103], v[252:255], v[204:207], a[100:103]
v_mfma_f32_16x16x32_bf16 a[96:99], v[252:255], v[196:199], a[96:99]
v_mfma_f32_16x16x32_bf16 a[96:99], v[248:251], v[192:195], a[96:99]
s_waitcnt lgkmcnt(5)
v_mfma_f32_16x16x32_bf16 a[128:131], v[192:195], v[224:227], a[128:131]
ds_read_b64_tr_b16 v[240:241], v22 offset:49152
v_mfma_f32_16x16x32_bf16 a[128:131], v[196:199], v[228:231], a[128:131]
v_mfma_f32_16x16x32_bf16 a[132:135], v[204:207], v[228:231], a[132:135]
v_mfma_f32_16x16x32_bf16 a[132:135], v[200:203], v[224:227], a[132:135]
ds_read_b64_tr_b16 v[242:243], v22 offset:50176
v_mfma_f32_16x16x32_bf16 a[136:139], v[208:211], v[224:227], a[136:139]
v_mfma_f32_16x16x32_bf16 a[136:139], v[212:215], v[228:231], a[136:139]
v_mfma_f32_16x16x32_bf16 a[140:143], v[220:223], v[228:231], a[140:143]
v_mfma_f32_16x16x32_bf16 a[140:143], v[216:219], v[224:227], a[140:143]
ds_read_b64_tr_b16 v[244:245], v22 offset:57344
v_mfma_f32_16x16x32_bf16 a[144:147], v[184:187], v[224:227], a[144:147]
v_mfma_f32_16x16x32_bf16 a[144:147], v[188:191], v[228:231], a[144:147]
v_mfma_f32_16x16x32_bf16 a[148:151], v[180:183], v[228:231], a[148:151]
ds_read_b64_tr_b16 v[246:247], v22 offset:58368
v_mfma_f32_16x16x32_bf16 a[148:151], v[176:179], v[224:227], a[148:151]
v_mfma_f32_16x16x32_bf16 a[152:155], v[168:171], v[224:227], a[152:155]
v_mfma_f32_16x16x32_bf16 a[152:155], v[172:175], v[228:231], a[152:155]
v_mfma_f32_16x16x32_bf16 a[156:159], v[164:167], v[228:231], a[156:159]
v_mfma_f32_16x16x32_bf16 a[156:159], v[160:163], v[224:227], a[156:159]
s_waitcnt lgkmcnt(4)
v_mfma_f32_16x16x32_bf16 a[188:191], v[160:163], v[232:235], a[188:191]
ds_read_b64_tr_b16 v[248:249], v23 offset:49152
v_mfma_f32_16x16x32_bf16 a[188:191], v[164:167], v[236:239], a[188:191]
v_mfma_f32_16x16x32_bf16 a[184:187], v[172:175], v[236:239], a[184:187]
ds_read_b64_tr_b16 v[250:251], v23 offset:50176
v_mfma_f32_16x16x32_bf16 a[184:187], v[168:171], v[232:235], a[184:187]
v_mfma_f32_16x16x32_bf16 a[180:183], v[176:179], v[232:235], a[180:183]
ds_read_b64_tr_b16 v[252:253], v23 offset:57344
v_mfma_f32_16x16x32_bf16 a[180:183], v[180:183], v[236:239], a[180:183]
v_mfma_f32_16x16x32_bf16 a[176:179], v[188:191], v[236:239], a[176:179]
ds_read_b64_tr_b16 v[254:255], v23 offset:58368
v_mfma_f32_16x16x32_bf16 a[176:179], v[184:187], v[232:235], a[176:179]
v_mfma_f32_16x16x32_bf16 a[172:175], v[216:219], v[232:235], a[172:175]
v_mfma_f32_16x16x32_bf16 a[172:175], v[220:223], v[236:239], a[172:175]
v_mfma_f32_16x16x32_bf16 a[168:171], v[212:215], v[236:239], a[168:171]
v_mfma_f32_16x16x32_bf16 a[168:171], v[208:211], v[232:235], a[168:171]
v_mfma_f32_16x16x32_bf16 a[164:167], v[200:203], v[232:235], a[164:167]
v_mfma_f32_16x16x32_bf16 a[164:167], v[204:207], v[236:239], a[164:167]
v_mfma_f32_16x16x32_bf16 a[160:163], v[196:199], v[236:239], a[160:163]
s_waitcnt vmcnt(4) lgkmcnt(0)
v_mfma_f32_16x16x32_bf16 a[160:163], v[192:195], v[232:235], a[160:163]
s_barrier
v_mfma_f32_16x16x32_bf16 a[192:195], v[192:195], v[240:243], a[192:195]
s_and_b32 s73, s65, 1
ds_read_b64_tr_b16 v[224:225], v20 offset:0
v_mfma_f32_16x16x32_bf16 a[192:195], v[196:199], v[244:247], a[192:195]
s_xor_b32 s73, s73, 7
ds_read_b64_tr_b16 v[226:227], v20 offset:1024
v_mfma_f32_16x16x32_bf16 a[196:199], v[204:207], v[244:247], a[196:199]
s_lshl_b32 s69, s73, 7
ds_read_b64_tr_b16 v[228:229], v20 offset:8192
v_mfma_f32_16x16x32_bf16 a[196:199], v[200:203], v[240:243], a[196:199]
s_add_u32 s69, s69, s84
ds_read_b64_tr_b16 v[230:231], v20 offset:9216
v_mfma_f32_16x16x32_bf16 a[200:203], v[208:211], v[240:243], a[200:203]
s_lshl_b32 s71, s73, 19
ds_read_b128 v[128:131], v24 offset:0
v_mfma_f32_16x16x32_bf16 a[200:203], v[212:215], v[244:247], a[200:203]
s_add_u32 s71, s71, s66
ds_read_b128 v[132:135], v25 offset:0
v_mfma_f32_16x16x32_bf16 a[204:207], v[220:223], v[244:247], a[204:207]
s_add_u32 m0, s63, 98304
v_mfma_f32_16x16x32_bf16 a[204:207], v[216:219], v[240:243], a[204:207]
s_add_u32 s72, s69, 0
buffer_load_dwordx4 v2, s[8:11], s72 offen lds
v_mfma_f32_16x16x32_bf16 a[208:211], v[184:187], v[240:243], a[208:211]
s_add_u32 s72, s69, 7168
buffer_load_dwordx4 v3, s[8:11], s72 offen offset:1024 lds
v_mfma_f32_16x16x32_bf16 a[208:211], v[188:191], v[244:247], a[208:211]
s_add_u32 s72, s69, 14336
buffer_load_dwordx4 v2, s[8:11], s72 offen offset:2048 lds
v_mfma_f32_16x16x32_bf16 a[212:215], v[180:183], v[244:247], a[212:215]
s_mul_i32 s74, s58, 4352
ds_read_b128 v[136:139], v24 offset:2048
v_mfma_f32_16x16x32_bf16 a[212:215], v[176:179], v[240:243], a[212:215]
s_add_u32 s74, s74, 131072
ds_read_b128 v[140:143], v25 offset:2048
v_lshrrev_b32 v26, 4, v0
v_mfma_f32_16x16x32_bf16 a[216:219], v[168:171], v[240:243], a[216:219]
s_add_u32 s72, s69, 21504
buffer_load_dwordx4 v3, s[8:11], s72 offen offset:3072 lds
v_mfma_f32_16x16x32_bf16 a[216:219], v[172:175], v[244:247], a[216:219]
ds_read_b128 v[144:147], v24 offset:4096
v_and_b32 v27, 15, v0
v_mfma_f32_16x16x32_bf16 a[220:223], v[164:167], v[244:247], a[220:223]
ds_read_b128 v[148:151], v25 offset:4096
v_lshlrev_b32 v27, 4, v27
v_mfma_f32_16x16x32_bf16 a[220:223], v[160:163], v[240:243], a[220:223]
ds_read_b128 v[152:155], v24 offset:6144
v_mul_u32_u24 v28, 272, v26
v_mfma_f32_16x16x32_bf16 a[252:255], v[160:163], v[248:251], a[252:255]
ds_read_b128 v[156:159], v25 offset:6144
v_add3_u32 v28, v28, v27, s74
v_mfma_f32_16x16x32_bf16 a[252:255], v[164:167], v[252:255], a[252:255]
s_add_u32 m0, s64, 32768
v_lshl_add_u32 v26, v26, 12, v27
v_mfma_f32_16x16x32_bf16 a[248:251], v[172:175], v[252:255], a[248:251]
s_add_u32 s72, s71, 0
buffer_load_dwordx4 v6, s[16:19], s72 offen lds
v_mfma_f32_16x16x32_bf16 a[248:251], v[168:171], v[248:251], a[248:251]
ds_read_b128 v[160:163], v24 offset:8192
ds_read_b128 v[36:39], v28 offset:0
v_mfma_f32_16x16x32_bf16 a[244:247], v[176:179], v[248:251], a[244:247]
ds_read_b128 v[164:167], v25 offset:8192
ds_read_b128 v[40:43], v28 offset:1088
v_mfma_f32_16x16x32_bf16 a[244:247], v[180:183], v[252:255], a[244:247]
s_add_u32 s72, s71, 31744
buffer_load_dwordx4 v6, s[16:19], s72 offen offset:1024 lds
v_mfma_f32_16x16x32_bf16 a[240:243], v[188:191], v[252:255], a[240:243]
ds_read_b128 v[168:171], v24 offset:10240
ds_read_b128 v[44:47], v28 offset:2176
v_mfma_f32_16x16x32_bf16 a[240:243], v[184:187], v[248:251], a[240:243]
ds_read_b128 v[172:175], v25 offset:10240
ds_read_b128 v[48:51], v28 offset:3264
v_mfma_f32_16x16x32_bf16 a[236:239], v[216:219], v[248:251], a[236:239]
s_and_b32 s74, s2, 15
ds_read_b128 v[176:179], v24 offset:12288
v_mfma_f32_16x16x32_bf16 a[236:239], v[220:223], v[252:255], a[236:239]
s_add_u32 s72, s71, 63488
buffer_load_dwordx4 v7, s[16:19], s72 offen offset:2048 lds
v_mfma_f32_16x16x32_bf16 a[232:235], v[212:215], v[252:255], a[232:235]
s_lshl_b32 s74, s74, 2
ds_read_b128 v[180:183], v25 offset:12288
v_mfma_f32_16x16x32_bf16 a[232:235], v[208:211], v[248:251], a[232:235]
s_add_u32 s74, s74, s58
ds_read_b128 v[184:187], v24 offset:14336
v_mfma_f32_16x16x32_bf16 a[228:231], v[200:203], v[248:251], a[228:231]
s_lshl_b32 s74, s74, 16
ds_read_b128 v[188:191], v25 offset:14336
v_mfma_f32_16x16x32_bf16 a[228:231], v[204:207], v[252:255], a[228:231]
s_lshr_b32 s75, s2, 4
v_mfma_f32_16x16x32_bf16 a[224:227], v[196:199], v[252:255], a[224:227]
s_add_u32 s72, s71, 95232
buffer_load_dwordx4 v7, s[16:19], s72 offen offset:3072 lds
v_mfma_f32_16x16x32_bf16 a[224:227], v[192:195], v[248:251], a[224:227]
s_waitcnt lgkmcnt(12)
ds_read_b64_tr_b16 v[232:233], v21 offset:0
v_mfma_f32_16x16x32_bf16 a[0:3], v[224:227], v[128:131], a[0:3]
s_lshl_b32 s75, s75, 8
ds_read_b64_tr_b16 v[234:235], v21 offset:1024
v_mfma_f32_16x16x32_bf16 a[0:3], v[228:231], v[132:135], a[0:3]
s_sub_u32 s74, s74, s75
ds_read_b64_tr_b16 v[240:241], v22 offset:0
v_mfma_f32_16x16x32_bf16 a[4:7], v[228:231], v[140:143], a[4:7]
s_add_u32 m0, s63, 102400
ds_read_b64_tr_b16 v[236:237], v21 offset:8192
v_mfma_f32_16x16x32_bf16 a[4:7], v[224:227], v[136:139], a[4:7]
s_add_u32 s72, s69, 32768
buffer_load_dwordx4 v2, s[8:11], s72 offen lds
v_mfma_f32_16x16x32_bf16 a[8:11], v[224:227], v[144:147], a[8:11]
s_add_u32 s74, s74, 0x3000f00
ds_read_b64_tr_b16 v[238:239], v21 offset:9216
v_mfma_f32_16x16x32_bf16 a[8:11], v[228:231], v[148:151], a[8:11]
s_waitcnt vmcnt(29)
v_lshlrev_b32 v78, 16, v84
v_lshlrev_b32 v79, 16, v108
v_mfma_f32_16x16x32_bf16 a[12:15], v[228:231], v[156:159], a[12:15]
s_add_u32 s72, s69, 39936
buffer_load_dwordx4 v3, s[8:11], s72 offen offset:1024 lds
v_mfma_f32_16x16x32_bf16 a[12:15], v[224:227], v[152:155], a[12:15]
s_waitcnt lgkmcnt(5)
ds_read_b64_tr_b16 v[242:243], v22 offset:1024
v_mul_f32 v76, v78, v79
v_mfma_f32_16x16x32_bf16 a[16:19], v[224:227], v[160:163], a[16:19]
v_lshlrev_b32 v80, 16, v116
v_mul_f32 v77, v78, v80
v_mfma_f32_16x16x32_bf16 a[16:19], v[228:231], v[164:167], a[16:19]
ds_read_b64_tr_b16 v[244:245], v22 offset:8192
v_and_b32 v78, 0xffff0000, v84
v_mfma_f32_16x16x32_bf16 a[20:23], v[228:231], v[172:175], a[20:23]
v_and_b32 v79, 0xffff0000, v108
v_fmac_f32 v76, v78, v79
v_mfma_f32_16x16x32_bf16 a[20:23], v[224:227], v[168:171], a[20:23]
s_add_u32 s72, s69, 47104
buffer_load_dwordx4 v2, s[8:11], s72 offen offset:2048 lds
v_mfma_f32_16x16x32_bf16 a[24:27], v[224:227], v[176:179], a[24:27]
ds_read_b64_tr_b16 v[246:247], v22 offset:9216
v_and_b32 v80, 0xffff0000, v116
v_mfma_f32_16x16x32_bf16 a[24:27], v[228:231], v[180:183], a[24:27]
v_fmac_f32 v77, v78, v80
v_lshlrev_b32 v78, 16, v85
v_mfma_f32_16x16x32_bf16 a[28:31], v[228:231], v[188:191], a[28:31]
v_lshlrev_b32 v79, 16, v109
v_fmac_f32 v76, v78, v79
v_mfma_f32_16x16x32_bf16 a[28:31], v[224:227], v[184:187], a[28:31]
s_waitcnt lgkmcnt(3)
v_lshlrev_b32 v80, 16, v117
v_fmac_f32 v77, v78, v80
v_mfma_f32_16x16x32_bf16 a[60:63], v[232:235], v[184:187], a[60:63]
s_add_u32 s72, s69, 54272
buffer_load_dwordx4 v3, s[8:11], s72 offen offset:3072 lds
v_mfma_f32_16x16x32_bf16 a[60:63], v[236:239], v[188:191], a[60:63]
ds_read_b64_tr_b16 v[248:249], v23 offset:0
v_and_b32 v78, 0xffff0000, v85
v_mfma_f32_16x16x32_bf16 a[56:59], v[236:239], v[180:183], a[56:59]
v_and_b32 v79, 0xffff0000, v109
v_fmac_f32 v76, v78, v79
v_mfma_f32_16x16x32_bf16 a[56:59], v[232:235], v[176:179], a[56:59]
s_add_u32 m0, s64, 49152
ds_read_b64_tr_b16 v[250:251], v23 offset:1024
v_and_b32 v80, 0xffff0000, v117
v_mfma_f32_16x16x32_bf16 a[52:55], v[232:235], v[168:171], a[52:55]
s_add_u32 s72, s71, 0
buffer_load_dwordx4 v6, s[20:23], s72 offen lds
v_mfma_f32_16x16x32_bf16 a[52:55], v[236:239], v[172:175], a[52:55]
v_fmac_f32 v77, v78, v80
v_lshlrev_b32 v78, 16, v86
v_mfma_f32_16x16x32_bf16 a[48:51], v[236:239], v[164:167], a[48:51]
v_lshlrev_b32 v79, 16, v110
v_fmac_f32 v76, v78, v79
v_mfma_f32_16x16x32_bf16 a[48:51], v[232:235], v[160:163], a[48:51]
ds_read_b64_tr_b16 v[252:253], v23 offset:8192
v_lshlrev_b32 v80, 16, v118
v_mfma_f32_16x16x32_bf16 a[44:47], v[232:235], v[152:155], a[44:47]
s_add_u32 s72, s71, 31744
buffer_load_dwordx4 v6, s[20:23], s72 offen offset:1024 lds
v_mfma_f32_16x16x32_bf16 a[44:47], v[236:239], v[156:159], a[44:47]
v_fmac_f32 v77, v78, v80
v_and_b32 v78, 0xffff0000, v86
v_mfma_f32_16x16x32_bf16 a[40:43], v[236:239], v[148:151], a[40:43]
ds_read_b64_tr_b16 v[254:255], v23 offset:9216
v_and_b32 v79, 0xffff0000, v110
v_mfma_f32_16x16x32_bf16 a[40:43], v[232:235], v[144:147], a[40:43]
v_fmac_f32 v76, v78, v79
v_and_b32 v80, 0xffff0000, v118
v_mfma_f32_16x16x32_bf16 a[36:39], v[232:235], v[136:139], a[36:39]
s_add_u32 s72, s71, 63488
buffer_load_dwordx4 v7, s[20:23], s72 offen offset:2048 lds
v_mfma_f32_16x16x32_bf16 a[36:39], v[236:239], v[140:143], a[36:39]
v_fmac_f32 v77, v78, v80
v_lshlrev_b32 v78, 16, v87
v_mfma_f32_16x16x32_bf16 a[32:35], v[236:239], v[132:135], a[32:35]
v_lshlrev_b32 v79, 16, v111
v_fmac_f32 v76, v78, v79
v_mfma_f32_16x16x32_bf16 a[32:35], v[232:235], v[128:131], a[32:35]
s_waitcnt lgkmcnt(4)
v_lshlrev_b32 v80, 16, v119
v_fmac_f32 v77, v78, v80
v_mfma_f32_16x16x32_bf16 a[64:67], v[240:243], v[128:131], a[64:67]
s_add_u32 s72, s71, 95232
buffer_load_dwordx4 v7, s[20:23], s72 offen offset:3072 lds
v_mfma_f32_16x16x32_bf16 a[64:67], v[244:247], v[132:135], a[64:67]
ds_read_b64_tr_b16 v[224:225], v20 offset:16384
v_and_b32 v78, 0xffff0000, v87
v_mfma_f32_16x16x32_bf16 a[68:71], v[244:247], v[140:143], a[68:71]
v_and_b32 v79, 0xffff0000, v111
v_fmac_f32 v76, v78, v79
v_mfma_f32_16x16x32_bf16 a[68:71], v[240:243], v[136:139], a[68:71]
v_and_b32 v80, 0xffff0000, v119
v_fmac_f32 v77, v78, v80
v_mfma_f32_16x16x32_bf16 a[72:75], v[240:243], v[144:147], a[72:75]
ds_read_b64_tr_b16 v[226:227], v20 offset:17408
v_lshlrev_b32 v78, 16, v88
v_mfma_f32_16x16x32_bf16 a[72:75], v[244:247], v[148:151], a[72:75]
v_lshlrev_b32 v79, 16, v112
v_fmac_f32 v76, v78, v79
v_mfma_f32_16x16x32_bf16 a[76:79], v[244:247], v[156:159], a[76:79]
v_lshlrev_b32 v80, 16, v120
v_fmac_f32 v77, v78, v80
v_mfma_f32_16x16x32_bf16 a[76:79], v[240:243], v[152:155], a[76:79]
ds_read_b64_tr_b16 v[228:229], v20 offset:24576
v_and_b32 v78, 0xffff0000, v88
v_mfma_f32_16x16x32_bf16 a[80:83], v[240:243], v[160:163], a[80:83]
s_waitcnt lgkmcnt(15)
buffer_store_dwordx4 v[36:39], v26, s[44:47], s74 offen sc1
v_mfma_f32_16x16x32_bf16 a[80:83], v[244:247], v[164:167], a[80:83]
v_and_b32 v79, 0xffff0000, v112
v_fmac_f32 v76, v78, v79
v_mfma_f32_16x16x32_bf16 a[84:87], v[244:247], v[172:175], a[84:87]
v_and_b32 v80, 0xffff0000, v120
v_fmac_f32 v77, v78, v80
v_mfma_f32_16x16x32_bf16 a[84:87], v[240:243], v[168:171], a[84:87]
ds_read_b64_tr_b16 v[230:231], v20 offset:25600
v_lshlrev_b32 v78, 16, v89
v_mfma_f32_16x16x32_bf16 a[88:91], v[240:243], v[176:179], a[88:91]
v_lshlrev_b32 v79, 16, v113
v_fmac_f32 v76, v78, v79
v_mfma_f32_16x16x32_bf16 a[88:91], v[244:247], v[180:183], a[88:91]
v_lshlrev_b32 v80, 16, v121
v_fmac_f32 v77, v78, v80
v_mfma_f32_16x16x32_bf16 a[92:95], v[244:247], v[188:191], a[92:95]
v_and_b32 v78, 0xffff0000, v89
v_and_b32 v79, 0xffff0000, v113
v_mfma_f32_16x16x32_bf16 a[92:95], v[240:243], v[184:187], a[92:95]
s_waitcnt lgkmcnt(4)
v_fmac_f32 v76, v78, v79
v_and_b32 v80, 0xffff0000, v121
v_mfma_f32_16x16x32_bf16 a[124:127], v[248:251], v[184:187], a[124:127]
ds_read_b64_tr_b16 v[232:233], v21 offset:16384
v_fmac_f32 v77, v78, v80
v_mfma_f32_16x16x32_bf16 a[124:127], v[252:255], v[188:191], a[124:127]
v_lshlrev_b32 v78, 16, v90
v_lshlrev_b32 v79, 16, v114
v_mfma_f32_16x16x32_bf16 a[120:123], v[252:255], v[180:183], a[120:123]
ds_read_b64_tr_b16 v[234:235], v21 offset:17408
v_fmac_f32 v76, v78, v79
v_mfma_f32_16x16x32_bf16 a[120:123], v[248:251], v[176:179], a[120:123]
v_lshlrev_b32 v80, 16, v122
v_fmac_f32 v77, v78, v80
v_mfma_f32_16x16x32_bf16 a[116:119], v[248:251], v[168:171], a[116:119]
s_lshr_b32 s75, s93, 5
v_and_b32 v78, 0xffff0000, v90
v_and_b32 v79, 0xffff0000, v114
v_mfma_f32_16x16x32_bf16 a[116:119], v[252:255], v[172:175], a[116:119]
s_add_u32 s74, s74, 0x4000
buffer_store_dwordx4 v[40:43], v26, s[44:47], s74 offen sc1
v_mfma_f32_16x16x32_bf16 a[112:115], v[252:255], v[164:167], a[112:115]
s_and_b32 s75, s75, 0x3f80
ds_read_b64_tr_b16 v[236:237], v21 offset:24576
v_fmac_f32 v76, v78, v79
v_mfma_f32_16x16x32_bf16 a[112:115], v[248:251], v[160:163], a[112:115]
s_add_u32 s75, s75, LcB0-Lpc0
v_lshrrev_b32 v2, 6, v0
v_lshlrev_b32 v2, 7, v2
v_mfma_f32_16x16x32_bf16 a[108:111], v[248:251], v[152:155], a[108:111]
v_add_u32 v2, s75, v2
v_min_u32 v2, Lcode_end-Lpc0, v2
v_mfma_f32_16x16x32_bf16 a[108:111], v[252:255], v[156:159], a[108:111]
global_load_dword v3, v2, s[98:99]
v_mfma_f32_16x16x32_bf16 a[104:107], v[252:255], v[148:151], a[104:107]
v_and_b32 v80, 0xffff0000, v122
v_fmac_f32 v77, v78, v80
v_mfma_f32_16x16x32_bf16 a[104:107], v[248:251], v[144:147], a[104:107]
ds_read_b64_tr_b16 v[238:239], v21 offset:25600
v_lshlrev_b32 v78, 16, v91
v_mfma_f32_16x16x32_bf16 a[100:103], v[248:251], v[136:139], a[100:103]
v_lshlrev_b32 v79, 16, v115
v_fmac_f32 v76, v78, v79
v_mfma_f32_16x16x32_bf16 a[100:103], v[252:255], v[140:143], a[100:103]
v_lshlrev_b32 v80, 16, v123
v_fmac_f32 v77, v78, v80
v_mfma_f32_16x16x32_bf16 a[96:99], v[252:255], v[132:135], a[96:99]
v_and_b32 v78, 0xffff0000, v91
v_and_b32 v79, 0xffff0000, v115
v_mfma_f32_16x16x32_bf16 a[96:99], v[248:251], v[128:131], a[96:99]
s_waitcnt lgkmcnt(4)
v_fmac_f32 v76, v78, v79
v_and_b32 v80, 0xffff0000, v123
v_mfma_f32_16x16x32_bf16 a[128:131], v[128:131], v[224:227], a[128:131]
ds_read_b64_tr_b16 v[240:241], v22 offset:16384
v_fmac_f32 v77, v78, v80
v_mfma_f32_16x16x32_bf16 a[128:131], v[132:135], v[228:231], a[128:131]
v_add_f32_dpp v76, v76, v76 row_ror:8 row_mask:0xf bank_mask:0xf
v_add_f32_dpp v77, v77, v77 row_ror:8 row_mask:0xf bank_mask:0xf
v_mfma_f32_16x16x32_bf16 a[132:135], v[140:143], v[228:231], a[132:135]
s_add_u32 s74, s74, 0x4000
buffer_store_dwordx4 v[44:47], v26, s[44:47], s74 offen sc1
v_mfma_f32_16x16x32_bf16 a[132:135], v[136:139], v[224:227], a[132:135]
v_add_f32_dpp v76, v76, v76 row_ror:4 row_mask:0xf bank_mask:0xf
v_add_f32_dpp v77, v77, v77 row_ror:4 row_mask:0xf bank_mask:0xf
v_mfma_f32_16x16x32_bf16 a[136:139], v[144:147], v[224:227], a[136:139]
ds_read_b64_tr_b16 v[242:243], v22 offset:17408
v_add_f32_dpp v76, v76, v76 row_ror:2 row_mask:0xf bank_mask:0xf
v_mfma_f32_16x16x32_bf16 a[136:139], v[148:151], v[228:231], a[136:139]
v_add_f32_dpp v77, v77, v77 row_ror:2 row_mask:0xf bank_mask:0xf
v_add_f32_dpp v76, v76, v76 row_ror:1 row_mask:0xf bank_mask:0xf
v_mfma_f32_16x16x32_bf16 a[140:143], v[156:159], v[228:231], a[140:143]
v_add_f32_dpp v77, v77, v77 row_ror:1 row_mask:0xf bank_mask:0xf
v_mov_b32 v78, v76
v_mfma_f32_16x16x32_bf16 a[140:143], v[152:155], v[224:227], a[140:143]
ds_read_b64_tr_b16 v[244:245], v22 offset:24576
v_mov_b32 v79, v77
v_mfma_f32_16x16x32_bf16 a[144:147], v[160:163], v[224:227], a[144:147]
v_permlane16_swap_b32 v76, v78
v_permlane16_swap_b32 v77, v79
v_mfma_f32_16x16x32_bf16 a[144:147], v[164:167], v[228:231], a[144:147]
v_add_f32 v76, v76, v78
v_add_f32 v77, v77, v79
v_mfma_f32_16x16x32_bf16 a[148:151], v[172:175], v[228:231], a[148:151]
ds_read_b64_tr_b16 v[246:247], v22 offset:25600
v_mov_b32 v78, v76
v_mfma_f32_16x16x32_bf16 a[148:151], v[168:171], v[224:227], a[148:151]
v_mov_b32 v79, v77
v_permlane32_swap_b32 v76, v78
v_mfma_f32_16x16x32_bf16 a[152:155], v[176:179], v[224:227], a[152:155]
v_permlane32_swap_b32 v77, v79
v_add_f32 v76, v76, v78
v_mfma_f32_16x16x32_bf16 a[152:155], v[180:183], v[228:231], a[152:155]
v_add_f32 v77, v77, v79
v_mul_f32 v76, 0xbfb8aa3b, v76
v_mfma_f32_16x16x32_bf16 a[156:159], v[188:191], v[228:231], a[156:159]
v_mul_f32 v77, 0xbfb8aa3b, v77
v_mfma_f32_16x16x32_bf16 a[156:159], v[184:187], v[224:227], a[156:159]
s_waitcnt lgkmcnt(4)
v_exp_f32 v76, v76
v_mfma_f32_16x16x32_bf16 a[188:191], v[184:187], v[232:235], a[188:191]
s_add_u32 s74, s74, 0x4000
buffer_store_dwordx4 v[48:51], v26, s[44:47], s74 offen sc1
v_mfma_f32_16x16x32_bf16 a[188:191], v[188:191], v[236:239], a[188:191]
ds_read_b64_tr_b16 v[248:249], v23 offset:16384
v_mfma_f32_16x16x32_bf16 a[184:187], v[180:183], v[236:239], a[184:187]
ds_read_b64_tr_b16 v[250:251], v23 offset:17408
v_mfma_f32_16x16x32_bf16 a[184:187], v[176:179], v[232:235], a[184:187]
v_exp_f32 v77, v77
v_mfma_f32_16x16x32_bf16 a[180:183], v[168:171], v[232:235], a[180:183]
ds_read_b64_tr_b16 v[252:253], v23 offset:24576
v_add_f32 v76, 1.0, v76
v_mfma_f32_16x16x32_bf16 a[180:183], v[172:175], v[236:239], a[180:183]
v_add_f32 v77, 1.0, v77
v_mfma_f32_16x16x32_bf16 a[176:179], v[164:167], v[236:239], a[176:179]
ds_read_b64_tr_b16 v[254:255], v23 offset:25600
v_mfma_f32_16x16x32_bf16 a[176:179], v[160:163], v[232:235], a[176:179]
v_rcp_f32 v76, v76
v_mfma_f32_16x16x32_bf16 a[172:175], v[152:155], v[232:235], a[172:175]
v_rcp_f32 v77, v77
v_mfma_f32_16x16x32_bf16 a[172:175], v[156:159], v[236:239], a[172:175]
s_lshr_b32 s80, s76, 9
v_mfma_f32_16x16x32_bf16 a[168:171], v[148:151], v[236:239], a[168:171]
s_add_u32 s80, s80, 0x3800000
v_min_u32 v78, 1, v0
v_lshlrev_b32 v78, 30, v78
v_mfma_f32_16x16x32_bf16 a[168:171], v[144:147], v[232:235], a[168:171]
buffer_store_dwordx2 v[76:77], v78, s[44:47], s80 offen sc1
v_mfma_f32_16x16x32_bf16 a[164:167], v[136:139], v[232:235], a[164:167]
v_mfma_f32_16x16x32_bf16 a[164:167], v[140:143], v[236:239], a[164:167]
v_mfma_f32_16x16x32_bf16 a[160:163], v[132:135], v[236:239], a[160:163]
s_waitcnt vmcnt(6) lgkmcnt(0)
v_mfma_f32_16x16x32_bf16 a[160:163], v[128:131], v[232:235], a[160:163]
s_barrier
v_mfma_f32_16x16x32_bf16 a[192:195], v[128:131], v[240:243], a[192:195]
s_add_u32 s73, s62, 0
ds_read_b64_tr_b16 v[224:225], v20 offset:32768
v_mfma_f32_16x16x32_bf16 a[192:195], v[132:135], v[244:247], a[192:195]
s_add_u32 s70, s73, s65
ds_read_b64_tr_b16 v[226:227], v20 offset:33792
v_mfma_f32_16x16x32_bf16 a[196:199], v[140:143], v[244:247], a[196:199]
s_and_b32 s70, s70, 3
v_mov_b32 v100, v20
v_mov_b32 v101, v21
v_mfma_f32_16x16x32_bf16 a[196:199], v[136:139], v[240:243], a[196:199]
s_and_b32 s73, s73, 12
v_mov_b32 v102, v22
v_mov_b32 v103, v23
v_mfma_f32_16x16x32_bf16 a[200:203], v[144:147], v[240:243], a[200:203]
s_or_b32 s73, s73, s70
ds_read_b64_tr_b16 v[228:229], v20 offset:40960
v_mfma_f32_16x16x32_bf16 a[200:203], v[148:151], v[244:247], a[200:203]
s_lshl_b32 s73, s73, 7
ds_read_b64_tr_b16 v[230:231], v20 offset:41984
v_mfma_f32_16x16x32_bf16 a[204:207], v[156:159], v[244:247], a[204:207]
s_add_u32 s69, s73, s67
ds_read_b128 v[192:195], v24 offset:32768
v_mfma_f32_16x16x32_bf16 a[204:207], v[152:155], v[240:243], a[204:207]
s_add_u32 s70, s73, s68
ds_read_b128 v[196:199], v25 offset:32768
v_mfma_f32_16x16x32_bf16 a[208:211], v[160:163], v[240:243], a[208:211]
s_add_u32 m0, s63, 131072
ds_read_b128 v[200:203], v24 offset:34816
v_mfma_f32_16x16x32_bf16 a[208:211], v[164:167], v[244:247], a[208:211]
s_add_u32 s72, s69, 0
buffer_load_dwordx4 v4, s[4:7], s72 offen lds
v_mfma_f32_16x16x32_bf16 a[212:215], v[172:175], v[244:247], a[212:215]
s_add_u32 s72, s69, 15360
buffer_load_dwordx4 v5, s[4:7], s72 offen offset:1024 lds
v_mfma_f32_16x16x32_bf16 a[212:215], v[168:171], v[240:243], a[212:215]
s_add_u32 s72, s69, 129024
buffer_load_dwordx4 v4, s[4:7], s72 offen offset:2048 lds
v_mfma_f32_16x16x32_bf16 a[216:219], v[176:179], v[240:243], a[216:219]
ds_read_b128 v[204:207], v25 offset:34816
v_mfma_f32_16x16x32_bf16 a[216:219], v[180:183], v[244:247], a[216:219]
ds_read_b128 v[208:211], v24 offset:36864
v_mfma_f32_16x16x32_bf16 a[220:223], v[188:191], v[244:247], a[220:223]
s_add_u32 s72, s69, 144384
buffer_load_dwordx4 v5, s[4:7], s72 offen offset:3072 lds
v_mfma_f32_16x16x32_bf16 a[220:223], v[184:187], v[240:243], a[220:223]
ds_read_b128 v[212:215], v25 offset:36864
v_mfma_f32_16x16x32_bf16 a[252:255], v[184:187], v[248:251], a[252:255]
ds_read_b128 v[216:219], v24 offset:38912
v_mfma_f32_16x16x32_bf16 a[252:255], v[188:191], v[252:255], a[252:255]
ds_read_b128 v[220:223], v25 offset:38912
v_mfma_f32_16x16x32_bf16 a[248:251], v[180:183], v[252:255], a[248:251]
s_add_u32 m0, s63, 135168
ds_read_b128 v[184:187], v24 offset:40960
v_mfma_f32_16x16x32_bf16 a[248:251], v[176:179], v[248:251], a[248:251]
s_add_u32 s72, s70, 0
buffer_load_dwordx4 v4, s[4:7], s72 offen lds
v_mfma_f32_16x16x32_bf16 a[244:247], v[168:171], v[248:251], a[244:247]
ds_read_b128 v[188:191], v25 offset:40960
v_mfma_f32_16x16x32_bf16 a[244:247], v[172:175], v[252:255], a[244:247]
ds_read_b128 v[176:179], v24 offset:43008
v_mfma_f32_16x16x32_bf16 a[240:243], v[164:167], v[252:255], a[240:243]
ds_read_b128 v[180:183], v25 offset:43008
v_mfma_f32_16x16x32_bf16 a[240:243], v[160:163], v[248:251], a[240:243]
s_add_u32 s72, s70, 15360
buffer_load_dwordx4 v5, s[4:7], s72 offen offset:1024 lds
v_mfma_f32_16x16x32_bf16 a[236:239], v[152:155], v[248:251], a[236:239]
ds_read_b128 v[168:171], v24 offset:45056
v_mfma_f32_16x16x32_bf16 a[236:239], v[156:159], v[252:255], a[236:239]
ds_read_b128 v[172:175], v25 offset:45056
v_mfma_f32_16x16x32_bf16 a[232:235], v[148:151], v[252:255], a[232:235]
v_mfma_f32_16x16x32_bf16 a[232:235], v[144:147], v[248:251], a[232:235]
ds_read_b128 v[160:163], v24 offset:47104
v_mfma_f32_16x16x32_bf16 a[228:231], v[136:139], v[248:251], a[228:231]
s_add_u32 s72, s70, 129024
buffer_load_dwordx4 v4, s[4:7], s72 offen offset:2048 lds
v_mfma_f32_16x16x32_bf16 a[228:231], v[140:143], v[252:255], a[228:231]
ds_read_b128 v[164:167], v25 offset:47104
v_mfma_f32_16x16x32_bf16 a[224:227], v[132:135], v[252:255], a[224:227]
ds_read_b64_tr_b16 v[232:233], v101 offset:32768
v_mfma_f32_16x16x32_bf16 a[224:227], v[128:131], v[248:251], a[224:227]
s_waitcnt lgkmcnt(9)
ds_read_b64_tr_b16 v[234:235], v101 offset:33792
v_mfma_f32_16x16x32_bf16 a[0:3], v[224:227], v[192:195], a[0:3]
s_add_u32 s72, s70, 144384
buffer_load_dwordx4 v5, s[4:7], s72 offen offset:3072 lds
v_mfma_f32_16x16x32_bf16 a[0:3], v[228:231], v[196:199], a[0:3]
ds_read_b64_tr_b16 v[240:241], v102 offset:32768
v_mfma_f32_16x16x32_bf16 a[4:7], v[228:231], v[204:207], a[4:7]
ds_read_b64_tr_b16 v[236:237], v101 offset:40960
v_mfma_f32_16x16x32_bf16 a[4:7], v[224:227], v[200:203], a[4:7]
v_mfma_f32_16x16x32_bf16 a[8:11], v[224:227], v[208:211], a[8:11]
ds_read_b64_tr_b16 v[238:239], v101 offset:41984
v_mfma_f32_16x16x32_bf16 a[8:11], v[228:231], v[212:215], a[8:11]
s_lshl_b32 s71, s73, 12
ds_read_b64_tr_b16 v[242:243], v102 offset:33792
v_mfma_f32_16x16x32_bf16 a[12:15], v[228:231], v[220:223], a[12:15]
s_add_u32 s71, s71, s66
v_mfma_f32_16x16x32_bf16 a[12:15], v[224:227], v[216:219], a[12:15]
s_waitcnt lgkmcnt(6)
ds_read_b64_tr_b16 v[244:245], v102 offset:40960
v_mfma_f32_16x16x32_bf16 a[16:19], v[224:227], v[184:187], a[16:19]
s_add_u32 m0, s64, 0
v_mfma_f32_16x16x32_bf16 a[16:19], v[228:231], v[188:191], a[16:19]
s_add_u32 s72, s71, 0
buffer_load_dwordx4 v6, s[12:15], s72 offen lds
v_mfma_f32_16x16x32_bf16 a[20:23], v[228:231], v[180:183], a[20:23]
s_add_u32 s72, s71, 31744
buffer_load_dwordx4 v6, s[12:15], s72 offen offset:1024 lds
v_mfma_f32_16x16x32_bf16 a[20:23], v[224:227], v[176:179], a[20:23]
ds_read_b64_tr_b16 v[246:247], v102 offset:41984
v_mfma_f32_16x16x32_bf16 a[24:27], v[224:227], v[168:171], a[24:27]
v_mfma_f32_16x16x32_bf16 a[24:27], v[228:231], v[172:175], a[24:27]
v_mfma_f32_16x16x32_bf16 a[28:31], v[228:231], v[164:167], a[28:31]
v_mfma_f32_16x16x32_bf16 a[28:31], v[224:227], v[160:163], a[28:31]
s_waitcnt lgkmcnt(3)
v_mfma_f32_16x16x32_bf16 a[60:63], v[232:235], v[160:163], a[60:63]
s_add_u32 s72, s71, 63488
buffer_load_dwordx4 v7, s[12:15], s72 offen offset:2048 lds
v_mfma_f32_16x16x32_bf16 a[60:63], v[236:239], v[164:167], a[60:63]
ds_read_b64_tr_b16 v[248:249], v103 offset:32768
v_mfma_f32_16x16x32_bf16 a[56:59], v[236:239], v[172:175], a[56:59]
v_mfma_f32_16x16x32_bf16 a[56:59], v[232:235], v[168:171], a[56:59]
s_add_u32 s72, s71, 95232
buffer_load_dwordx4 v7, s[12:15], s72 offen offset:3072 lds
v_mfma_f32_16x16x32_bf16 a[52:55], v[232:235], v[176:179], a[52:55]
v_mfma_f32_16x16x32_bf16 a[52:55], v[236:239], v[180:183], a[52:55]
ds_read_b64_tr_b16 v[250:251], v103 offset:33792
v_mfma_f32_16x16x32_bf16 a[48:51], v[236:239], v[188:191], a[48:51]
v_mfma_f32_16x16x32_bf16 a[48:51], v[232:235], v[184:187], a[48:51]
v_mfma_f32_16x16x32_bf16 a[44:47], v[232:235], v[216:219], a[44:47]
s_add_u32 s73, s62, 1
ds_read_b64_tr_b16 v[252:253], v103 offset:40960
v_mfma_f32_16x16x32_bf16 a[44:47], v[236:239], v[220:223], a[44:47]
s_add_u32 s70, s73, s65
v_mfma_f32_16x16x32_bf16 a[40:43], v[236:239], v[212:215], a[40:43]
s_and_b32 s70, s70, 3
v_mfma_f32_16x16x32_bf16 a[40:43], v[232:235], v[208:211], a[40:43]
s_and_b32 s73, s73, 12
ds_read_b64_tr_b16 v[254:255], v103 offset:41984
v_mfma_f32_16x16x32_bf16 a[36:39], v[232:235], v[200:203], a[36:39]
s_or_b32 s73, s73, s70
v_mfma_f32_16x16x32_bf16 a[36:39], v[236:239], v[204:207], a[36:39]
s_lshl_b32 s73, s73, 7
v_mfma_f32_16x16x32_bf16 a[32:35], v[236:239], v[196:199], a[32:35]
s_add_u32 s69, s73, s67
v_mfma_f32_16x16x32_bf16 a[32:35], v[232:235], v[192:195], a[32:35]
s_waitcnt lgkmcnt(4)
v_mfma_f32_16x16x32_bf16 a[64:67], v[240:243], v[192:195], a[64:67]
s_add_u32 s70, s73, s68
ds_read_b64_tr_b16 v[224:225], v100 offset:49152
v_mfma_f32_16x16x32_bf16 a[64:67], v[244:247], v[196:199], a[64:67]
s_add_u32 m0, s63, 65536
v_mfma_f32_16x16x32_bf16 a[68:71], v[244:247], v[204:207], a[68:71]
s_add_u32 s72, s69, 0
buffer_load_dwordx4 v4, s[4:7], s72 offen lds
v_mfma_f32_16x16x32_bf16 a[68:71], v[240:243], v[200:203], a[68:71]
s_add_u32 s72, s69, 15360
buffer_load_dwordx4 v5, s[4:7], s72 offen offset:1024 lds
v_mfma_f32_16x16x32_bf16 a[72:75], v[240:243], v[208:211], a[72:75]
s_add_u32 s72, s69, 129024
buffer_load_dwordx4 v4, s[4:7], s72 offen offset:2048 lds
v_mfma_f32_16x16x32_bf16 a[72:75], v[244:247], v[212:215], a[72:75]
ds_read_b64_tr_b16 v[226:227], v100 offset:50176
v_mfma_f32_16x16x32_bf16 a[76:79], v[244:247], v[220:223], a[76:79]
s_add_u32 s72, s69, 144384
buffer_load_dwordx4 v5, s[4:7], s72 offen offset:3072 lds
v_mfma_f32_16x16x32_bf16 a[76:79], v[240:243], v[216:219], a[76:79]
v_mfma_f32_16x16x32_bf16 a[80:83], v[240:243], v[184:187], a[80:83]
ds_read_b64_tr_b16 v[228:229], v100 offset:57344
v_mfma_f32_16x16x32_bf16 a[80:83], v[244:247], v[188:191], a[80:83]
v_mfma_f32_16x16x32_bf16 a[84:87], v[244:247], v[180:183], a[84:87]
ds_read_b64_tr_b16 v[230:231], v100 offset:58368
v_accvgpr_read_b32 v20, a0
v_mfma_f32_16x16x32_bf16 a[84:87], v[240:243], v[176:179], a[84:87]
s_add_u32 m0, s63, 69632
v_accvgpr_read_b32 v28, a1
v_accvgpr_read_b32 v21, a2
v_mfma_f32_16x16x32_bf16 a[88:91], v[240:243], v[168:171], a[88:91]
s_add_u32 s72, s70, 0
buffer_load_dwordx4 v4, s[4:7], s72 offen lds
v_mfma_f32_16x16x32_bf16 a[88:91], v[244:247], v[172:175], a[88:91]
v_accvgpr_read_b32 v29, a3
v_accvgpr_read_b32 v22, a32
v_mfma_f32_16x16x32_bf16 a[92:95], v[244:247], v[164:167], a[92:95]
v_accvgpr_read_b32 v30, a33
v_accvgpr_read_b32 v23, a34
v_mfma_f32_16x16x32_bf16 a[92:95], v[240:243], v[160:163], a[92:95]
s_waitcnt lgkmcnt(4)
v_accvgpr_read_b32 v31, a35
v_mul_f32 v20, s79, v20
v_mfma_f32_16x16x32_bf16 a[124:127], v[248:251], v[160:163], a[124:127]
s_add_u32 s72, s70, 15360
buffer_load_dwordx4 v5, s[4:7], s72 offen offset:1024 lds
v_mfma_f32_16x16x32_bf16 a[124:127], v[252:255], v[164:167], a[124:127]
ds_read_b64_tr_b16 v[232:233], v101 offset:49152
v_mul_f32 v28, s79, v28
v_mfma_f32_16x16x32_bf16 a[120:123], v[252:255], v[172:175], a[120:123]
v_mul_f32 v21, s79, v21
v_mul_f32 v29, s79, v29
v_mfma_f32_16x16x32_bf16 a[120:123], v[248:251], v[168:171], a[120:123]
ds_read_b64_tr_b16 v[234:235], v101 offset:50176
v_mul_f32 v22, s79, v22
v_mfma_f32_16x16x32_bf16 a[116:119], v[248:251], v[176:179], a[116:119]
s_add_u32 s72, s70, 129024
buffer_load_dwordx4 v4, s[4:7], s72 offen offset:2048 lds
v_mfma_f32_16x16x32_bf16 a[116:119], v[252:255], v[180:183], a[116:119]
v_mul_f32 v30, s79, v30
v_mul_f32 v23, s79, v23
v_mfma_f32_16x16x32_bf16 a[112:115], v[252:255], v[188:191], a[112:115]
v_mul_f32 v31, s79, v31
v_cvt_pk_bf16_f32 v20, v20, v28
v_mfma_f32_16x16x32_bf16 a[112:115], v[248:251], v[184:187], a[112:115]
ds_read_b64_tr_b16 v[236:237], v101 offset:57344
v_cvt_pk_bf16_f32 v21, v21, v29
v_mfma_f32_16x16x32_bf16 a[108:111], v[248:251], v[216:219], a[108:111]
v_cvt_pk_bf16_f32 v22, v22, v30
v_cvt_pk_bf16_f32 v23, v23, v31
v_mfma_f32_16x16x32_bf16 a[108:111], v[252:255], v[220:223], a[108:111]
s_add_u32 s72, s70, 144384
buffer_load_dwordx4 v5, s[4:7], s72 offen offset:3072 lds
v_mfma_f32_16x16x32_bf16 a[104:107], v[252:255], v[212:215], a[104:107]
s_add_u32 s80, s77, 0
buffer_store_dwordx4 v[20:23], v1, s[44:47], s80 offen sc1
v_mfma_f32_16x16x32_bf16 a[104:107], v[248:251], v[208:211], a[104:107]
ds_read_b64_tr_b16 v[238:239], v101 offset:58368
v_mfma_f32_16x16x32_bf16 a[100:103], v[248:251], v[200:203], a[100:103]
v_mfma_f32_16x16x32_bf16 a[100:103], v[252:255], v[204:207], a[100:103]
v_mfma_f32_16x16x32_bf16 a[96:99], v[252:255], v[196:199], a[96:99]
s_lshl_b32 s71, s73, 12
v_mfma_f32_16x16x32_bf16 a[96:99], v[248:251], v[192:195], a[96:99]
s_waitcnt lgkmcnt(4)
LcB0:
v_mfma_f32_16x16x32_bf16 a[128:131], v[192:195], v[224:227], a[128:131]
s_add_u32 s71, s71, s66
ds_read_b64_tr_b16 v[240:241], v102 offset:49152
v_accvgpr_read_b32 v24, a4
v_mfma_f32_16x16x32_bf16 a[128:131], v[196:199], v[228:231], a[128:131]
s_add_u32 m0, s64, 16384
v_accvgpr_read_b32 v28, a5
v_accvgpr_read_b32 v25, a6
v_mfma_f32_16x16x32_bf16 a[132:135], v[204:207], v[228:231], a[132:135]
s_add_u32 s72, s71, 0
buffer_load_dwordx4 v6, s[12:15], s72 offen lds
v_mfma_f32_16x16x32_bf16 a[132:135], v[200:203], v[224:227], a[132:135]
s_add_u32 s72, s71, 31744
buffer_load_dwordx4 v6, s[12:15], s72 offen offset:1024 lds
v_mfma_f32_16x16x32_bf16 a[136:139], v[208:211], v[224:227], a[136:139]
ds_read_b64_tr_b16 v[242:243], v102 offset:50176
v_accvgpr_read_b32 v29, a7
v_mfma_f32_16x16x32_bf16 a[136:139], v[212:215], v[228:231], a[136:139]
v_accvgpr_read_b32 v26, a36
v_accvgpr_read_b32 v30, a37
v_mfma_f32_16x16x32_bf16 a[140:143], v[220:223], v[228:231], a[140:143]
v_accvgpr_read_b32 v27, a38
v_accvgpr_read_b32 v31, a39
v_mfma_f32_16x16x32_bf16 a[140:143], v[216:219], v[224:227], a[140:143]
s_add_u32 s72, s71, 63488
buffer_load_dwordx4 v7, s[12:15], s72 offen offset:2048 lds
v_mfma_f32_16x16x32_bf16 a[144:147], v[184:187], v[224:227], a[144:147]
ds_read_b64_tr_b16 v[244:245], v102 offset:57344
v_mul_f32 v24, s79, v24
v_mfma_f32_16x16x32_bf16 a[144:147], v[188:191], v[228:231], a[144:147]
v_mul_f32 v28, s79, v28
v_mul_f32 v25, s79, v25
v_mfma_f32_16x16x32_bf16 a[148:151], v[180:183], v[228:231], a[148:151]
ds_read_b64_tr_b16 v[246:247], v102 offset:58368
v_mul_f32 v29, s79, v29
v_mfma_f32_16x16x32_bf16 a[148:151], v[176:179], v[224:227], a[148:151]
v_mul_f32 v26, s79, v26
v_mul_f32 v30, s79, v30
v_mfma_f32_16x16x32_bf16 a[152:155], v[168:171], v[224:227], a[152:155]
s_add_u32 s72, s71, 95232
buffer_load_dwordx4 v7, s[12:15], s72 offen offset:3072 lds
v_mfma_f32_16x16x32_bf16 a[152:155], v[172:175], v[228:231], a[152:155]
v_mul_f32 v27, s79, v27
v_mul_f32 v31, s79, v31
v_mfma_f32_16x16x32_bf16 a[156:159], v[164:167], v[228:231], a[156:159]
v_cvt_pk_bf16_f32 v24, v24, v28
v_cvt_pk_bf16_f32 v25, v25, v29
v_mfma_f32_16x16x32_bf16 a[156:159], v[160:163], v[224:227], a[156:159]
s_waitcnt lgkmcnt(4)
v_cvt_pk_bf16_f32 v26, v26, v30
v_cvt_pk_bf16_f32 v27, v27, v31
v_mfma_f32_16x16x32_bf16 a[188:191], v[160:163], v[232:235], a[188:191]
s_add_u32 s80, s77, 4096
ds_read_b64_tr_b16 v[248:249], v103 offset:49152
v_mfma_f32_16x16x32_bf16 a[188:191], v[164:167], v[236:239], a[188:191]
buffer_store_dwordx4 v[24:27], v1, s[44:47], s80 offen sc1
v_mfma_f32_16x16x32_bf16 a[184:187], v[172:175], v[236:239], a[184:187]
ds_read_b64_tr_b16 v[250:251], v103 offset:50176
v_mfma_f32_16x16x32_bf16 a[184:187], v[168:171], v[232:235], a[184:187]
v_mfma_f32_16x16x32_bf16 a[180:183], v[176:179], v[232:235], a[180:183]
ds_read_b64_tr_b16 v[252:253], v103 offset:57344
v_mfma_f32_16x16x32_bf16 a[180:183], v[180:183], v[236:239], a[180:183]
s_add_u32 s73, s62, 2
v_mfma_f32_16x16x32_bf16 a[176:179], v[188:191], v[236:239], a[176:179]
s_add_u32 s70, s73, s65
ds_read_b64_tr_b16 v[254:255], v103 offset:58368
v_accvgpr_read_b32 v20, a8
v_mfma_f32_16x16x32_bf16 a[176:179], v[184:187], v[232:235], a[176:179]
s_and_b32 s70, s70, 3
v_accvgpr_read_b32 v28, a9
v_accvgpr_read_b32 v21, a10
v_mfma_f32_16x16x32_bf16 a[172:175], v[216:219], v[232:235], a[172:175]
s_and_b32 s73, s73, 12
v_accvgpr_read_b32 v29, a11
v_accvgpr_read_b32 v22, a40
v_mfma_f32_16x16x32_bf16 a[172:175], v[220:223], v[236:239], a[172:175]
s_or_b32 s73, s73, s70
v_accvgpr_read_b32 v30, a41
v_accvgpr_read_b32 v23, a42
v_mfma_f32_16x16x32_bf16 a[168:171], v[212:215], v[236:239], a[168:171]
s_lshl_b32 s73, s73, 7
v_accvgpr_read_b32 v31, a43
v_mul_f32 v20, s79, v20
v_mfma_f32_16x16x32_bf16 a[168:171], v[208:211], v[232:235], a[168:171]
s_add_u32 s69, s73, s67
v_mul_f32 v28, s79, v28
v_mul_f32 v21, s79, v21
v_mfma_f32_16x16x32_bf16 a[164:167], v[200:203], v[232:235], a[164:167]
s_add_u32 s70, s73, s68
v_mul_f32 v29, s79, v29
v_mul_f32 v22, s79, v22
v_mfma_f32_16x16x32_bf16 a[164:167], v[204:207], v[236:239], a[164:167]
s_add_u32 m0, s63, 98304
v_mul_f32 v30, s79, v30
v_mul_f32 v23, s79, v23
v_mfma_f32_16x16x32_bf16 a[160:163], v[196:199], v[236:239], a[160:163]
s_waitcnt vmcnt(14) lgkmcnt(0)
v_mul_f32 v31, s79, v31
v_cvt_pk_bf16_f32 v20, v20, v28
v_mfma_f32_16x16x32_bf16 a[160:163], v[192:195], v[232:235], a[160:163]
s_barrier
v_cvt_pk_bf16_f32 v21, v21, v29
v_cvt_pk_bf16_f32 v22, v22, v30
v_mfma_f32_16x16x32_bf16 a[192:195], v[192:195], v[240:243], a[192:195]
s_add_u32 s72, s69, 0
buffer_load_dwordx4 v4, s[4:7], s72 offen lds
v_mfma_f32_16x16x32_bf16 a[192:195], v[196:199], v[244:247], a[192:195]
s_lshl_b32 s74, s59, 2
ds_read_b64_tr_b16 v[64:65], v8 offset:0
v_or_b32 v106, s58, v0
v_mfma_f32_16x16x32_bf16 a[196:199], v[204:207], v[244:247], a[196:199]
ds_read_b64_tr_b16 v[66:67], v8 offset:1024
v_mov_b32 v107, 1
v_mfma_f32_16x16x32_bf16 a[196:199], v[200:203], v[240:243], a[196:199]
ds_read_b64_tr_b16 v[68:69], v8 offset:8192
v_lshlrev_b32 v106, 8, v106
v_mfma_f32_16x16x32_bf16 a[200:203], v[208:211], v[240:243], a[200:203]
ds_read_b64_tr_b16 v[70:71], v8 offset:9216
v_cvt_pk_bf16_f32 v23, v23, v31
v_mfma_f32_16x16x32_bf16 a[200:203], v[212:215], v[244:247], a[200:203]
s_add_u32 s72, s69, 15360
buffer_load_dwordx4 v5, s[4:7], s72 offen offset:1024 lds
v_mfma_f32_16x16x32_bf16 a[204:207], v[220:223], v[244:247], a[204:207]
s_add_u32 s80, s77, 8192
ds_read_b128 v[32:35], v16 offset:0
v_mfma_f32_16x16x32_bf16 a[204:207], v[216:219], v[240:243], a[204:207]
buffer_atomic_add v107, v106, s[48:51], s74 offen sc1
v_mfma_f32_16x16x32_bf16 a[208:211], v[184:187], v[240:243], a[208:211]
ds_read_b128 v[36:39], v17 offset:0
v_mfma_f32_16x16x32_bf16 a[208:211], v[188:191], v[244:247], a[208:211]
ds_read_b128 v[40:43], v16 offset:2048
v_mfma_f32_16x16x32_bf16 a[212:215], v[180:183], v[244:247], a[212:215]
s_add_u32 s72, s69, 129024
buffer_load_dwordx4 v4, s[4:7], s72 offen offset:2048 lds
v_mfma_f32_16x16x32_bf16 a[212:215], v[176:179], v[240:243], a[212:215]
ds_read_b128 v[44:47], v17 offset:2048
v_mfma_f32_16x16x32_bf16 a[216:219], v[168:171], v[240:243], a[216:219]
ds_read_b128 v[48:51], v16 offset:4096
v_accvgpr_read_b32 v24, a128
v_mfma_f32_16x16x32_bf16 a[216:219], v[172:175], v[244:247], a[216:219]
ds_read_b128 v[52:55], v17 offset:4096
v_accvgpr_read_b32 v28, a129
v_mfma_f32_16x16x32_bf16 a[220:223], v[164:167], v[244:247], a[220:223]
buffer_store_dwordx4 v[20:23], v1, s[44:47], s80 offen sc1
v_mfma_f32_16x16x32_bf16 a[220:223], v[160:163], v[240:243], a[220:223]
s_add_u32 s72, s69, 144384
buffer_load_dwordx4 v5, s[4:7], s72 offen offset:3072 lds
v_mfma_f32_16x16x32_bf16 a[252:255], v[160:163], v[248:251], a[252:255]
ds_read_b128 v[56:59], v16 offset:6144
v_accvgpr_read_b32 v25, a130
v_mfma_f32_16x16x32_bf16 a[252:255], v[164:167], v[252:255], a[252:255]
ds_read_b128 v[60:63], v17 offset:6144
v_accvgpr_read_b32 v29, a131
v_mfma_f32_16x16x32_bf16 a[248:251], v[172:175], v[252:255], a[248:251]
ds_read_b64_tr_b16 v[72:73], v9 offset:0
v_accvgpr_read_b32 v26, a132
v_mfma_f32_16x16x32_bf16 a[248:251], v[168:171], v[248:251], a[248:251]
s_add_u32 m0, s63, 102400
ds_read_b64_tr_b16 v[74:75], v9 offset:1024
v_accvgpr_read_b32 v30, a133
v_mfma_f32_16x16x32_bf16 a[244:247], v[176:179], v[248:251], a[244:247]
s_add_u32 s72, s70, 0
buffer_load_dwordx4 v4, s[4:7], s72 offen lds
v_mfma_f32_16x16x32_bf16 a[244:247], v[180:183], v[252:255], a[244:247]
ds_read_b64_tr_b16 v[76:77], v9 offset:8192
v_accvgpr_read_b32 v27, a134
v_mfma_f32_16x16x32_bf16 a[240:243], v[188:191], v[252:255], a[240:243]
v_accvgpr_read_b32 v31, a135
v_cvt_pk_bf16_f32 v24, v24, v28
v_mfma_f32_16x16x32_bf16 a[240:243], v[184:187], v[248:251], a[240:243]
ds_read_b64_tr_b16 v[78:79], v9 offset:9216
v_cvt_pk_bf16_f32 v25, v25, v29
v_mfma_f32_16x16x32_bf16 a[236:239], v[216:219], v[248:251], a[236:239]
ds_read_b64_tr_b16 v[80:81], v10 offset:0
v_cvt_pk_bf16_f32 v26, v26, v30
v_mfma_f32_16x16x32_bf16 a[236:239], v[220:223], v[252:255], a[236:239]
s_add_u32 s72, s70, 15360
buffer_load_dwordx4 v5, s[4:7], s72 offen offset:1024 lds
v_mfma_f32_16x16x32_bf16 a[232:235], v[212:215], v[252:255], a[232:235]
ds_read_b64_tr_b16 v[82:83], v10 offset:1024
v_cvt_pk_bf16_f32 v27, v27, v31
v_mfma_f32_16x16x32_bf16 a[232:235], v[208:211], v[248:251], a[232:235]
s_add_u32 s80, s78, 0
ds_read_b64_tr_b16 v[84:85], v10 offset:8192
v_mfma_f32_16x16x32_bf16 a[228:231], v[200:203], v[248:251], a[228:231]
ds_read_b64_tr_b16 v[86:87], v10 offset:9216
v_mfma_f32_16x16x32_bf16 a[228:231], v[204:207], v[252:255], a[228:231]
buffer_store_dwordx4 v[24:27], v1, s[44:47], s80 offen sc1
v_mfma_f32_16x16x32_bf16 a[224:227], v[196:199], v[252:255], a[224:227]
s_add_u32 s72, s70, 129024
buffer_load_dwordx4 v4, s[4:7], s72 offen offset:2048 lds
v_mfma_f32_16x16x32_bf16 a[224:227], v[192:195], v[248:251], a[224:227]
s_waitcnt lgkmcnt(8)
v_mfma_f32_16x16x32_bf16 v[128:131], v[64:67], v[32:35], 0
ds_read_b64_tr_b16 v[88:89], v11 offset:0
v_mfma_f32_16x16x32_bf16 v[128:131], v[68:71], v[36:39], v[128:131]
ds_read_b64_tr_b16 v[90:91], v11 offset:1024
v_mfma_f32_16x16x32_bf16 v[132:135], v[68:71], v[44:47], 0
v_accvgpr_read_b32 v20, a12
v_accvgpr_read_b32 v28, a13
v_mfma_f32_16x16x32_bf16 v[132:135], v[64:67], v[40:43], v[132:135]
s_add_u32 s72, s70, 144384
buffer_load_dwordx4 v5, s[4:7], s72 offen offset:3072 lds
v_mfma_f32_16x16x32_bf16 v[136:139], v[64:67], v[48:51], 0
s_lshl_b32 s71, s73, 12
ds_read_b64_tr_b16 v[92:93], v11 offset:8192
v_accvgpr_read_b32 v21, a14
v_mfma_f32_16x16x32_bf16 v[136:139], v[68:71], v[52:55], v[136:139]
s_add_u32 s71, s71, s66
v_accvgpr_read_b32 v29, a15
v_accvgpr_read_b32 v22, a44
v_mfma_f32_16x16x32_bf16 v[140:143], v[68:71], v[60:63], 0
s_add_u32 m0, s64, 32768
ds_read_b64_tr_b16 v[94:95], v11 offset:9216
v_accvgpr_read_b32 v30, a45
v_mfma_f32_16x16x32_bf16 v[140:143], v[64:67], v[56:59], v[140:143]
s_waitcnt lgkmcnt(8)
v_accvgpr_read_b32 v23, a46
v_accvgpr_read_b32 v31, a47
v_mfma_f32_16x16x32_bf16 v[156:159], v[72:75], v[56:59], 0
s_add_u32 s72, s71, 0
buffer_load_dwordx4 v6, s[12:15], s72 offen lds
v_mfma_f32_16x16x32_bf16 v[156:159], v[76:79], v[60:63], v[156:159]
s_add_u32 s73, s62, 3
ds_read_b64_tr_b16 v[64:65], v12 offset:0
v_mul_f32 v20, s79, v20
v_mfma_f32_16x16x32_bf16 v[152:155], v[76:79], v[52:55], 0
s_add_u32 s70, s73, s65
ds_read_b64_tr_b16 v[66:67], v12 offset:1024
v_mul_f32 v28, s79, v28
v_mfma_f32_16x16x32_bf16 v[152:155], v[72:75], v[48:51], v[152:155]
s_add_u32 s72, s71, 31744
buffer_load_dwordx4 v6, s[12:15], s72 offen offset:1024 lds
v_mfma_f32_16x16x32_bf16 v[148:151], v[72:75], v[40:43], 0
s_and_b32 s70, s70, 3
v_mul_f32 v21, s79, v21
v_mul_f32 v29, s79, v29
v_mfma_f32_16x16x32_bf16 v[148:151], v[76:79], v[44:47], v[148:151]
s_and_b32 s73, s73, 12
ds_read_b64_tr_b16 v[68:69], v12 offset:8192
v_mul_f32 v22, s79, v22
v_mfma_f32_16x16x32_bf16 v[144:147], v[76:79], v[36:39], 0
s_or_b32 s73, s73, s70
ds_read_b64_tr_b16 v[70:71], v12 offset:9216
v_mul_f32 v30, s79, v30
v_mfma_f32_16x16x32_bf16 v[144:147], v[72:75], v[32:35], v[144:147]
s_waitcnt lgkmcnt(8)
v_mul_f32 v23, s79, v23
v_mul_f32 v31, s79, v31
v_mfma_f32_16x16x32_bf16 v[160:163], v[80:83], v[32:35], 0
s_lshl_b32 s73, s73, 7
ds_read_b64_tr_b16 v[72:73], v13 offset:0
v_cvt_pk_bf16_f32 v20, v20, v28
v_mfma_f32_16x16x32_bf16 v[160:163], v[84:87], v[36:39], v[160:163]
s_add_u32 s72, s71, 63488
buffer_load_dwordx4 v7, s[12:15], s72 offen offset:2048 lds
v_mfma_f32_16x16x32_bf16 v[164:167], v[84:87], v[44:47], 0
s_add_u32 s69, s73, s67
ds_read_b64_tr_b16 v[74:75], v13 offset:1024
v_cvt_pk_bf16_f32 v21, v21, v29
v_mfma_f32_16x16x32_bf16 v[164:167], v[80:83], v[40:43], v[164:167]
s_add_u32 s70, s73, s68
v_cvt_pk_bf16_f32 v22, v22, v30
v_cvt_pk_bf16_f32 v23, v23, v31
v_mfma_f32_16x16x32_bf16 v[168:171], v[80:83], v[48:51], 0
s_waitcnt vmcnt(20)
ds_read_b64_tr_b16 v[76:77], v13 offset:8192
v_mfma_f32_16x16x32_bf16 v[168:171], v[84:87], v[52:55], v[168:171]
s_add_u32 s80, s77, 12288
ds_read_b64_tr_b16 v[78:79], v13 offset:9216
v_mfma_f32_16x16x32_bf16 v[172:175], v[84:87], v[60:63], 0
s_add_u32 s72, s71, 95232
ds_read_b128 v[96:99], v18 offset:0
v_mfma_f32_16x16x32_bf16 v[172:175], v[80:83], v[56:59], v[172:175]
s_waitcnt lgkmcnt(9)
buffer_load_dwordx4 v7, s[12:15], s72 offen offset:3072 lds
v_mfma_f32_16x16x32_bf16 v[188:191], v[88:91], v[56:59], 0
ds_read_b64_tr_b16 v[80:81], v14 offset:0
v_accvgpr_read_b32 v24, a136
v_mfma_f32_16x16x32_bf16 v[188:191], v[92:95], v[60:63], v[188:191]
ds_read_b64_tr_b16 v[82:83], v14 offset:1024
v_accvgpr_read_b32 v28, a137
v_mfma_f32_16x16x32_bf16 v[184:187], v[92:95], v[52:55], 0
ds_read_b128 v[100:103], v19 offset:0
v_accvgpr_read_b32 v25, a138
v_mfma_f32_16x16x32_bf16 v[184:187], v[88:91], v[48:51], v[184:187]
ds_read_b64_tr_b16 v[84:85], v14 offset:8192
v_accvgpr_read_b32 v29, a139
v_mfma_f32_16x16x32_bf16 v[180:183], v[88:91], v[40:43], 0
buffer_store_dwordx4 v[20:23], v1, s[44:47], s80 offen sc1
v_mfma_f32_16x16x32_bf16 v[180:183], v[92:95], v[44:47], v[180:183]
s_add_u32 m0, s63, 131072
ds_read_b64_tr_b16 v[86:87], v14 offset:9216
v_accvgpr_read_b32 v26, a140
v_mfma_f32_16x16x32_bf16 v[176:179], v[92:95], v[36:39], 0
s_add_u32 s72, s69, 0
buffer_load_dwordx4 v4, s[4:7], s72 offen lds
v_mfma_f32_16x16x32_bf16 v[176:179], v[88:91], v[32:35], v[176:179]
s_waitcnt lgkmcnt(10)
ds_read_b128 v[104:107], v18 offset:2048
v_accvgpr_read_b32 v30, a141
v_mfma_f32_16x16x32_bf16 v[192:195], v[64:67], v[32:35], 0
ds_read_b64_tr_b16 v[88:89], v15 offset:0
v_accvgpr_read_b32 v27, a142
v_mfma_f32_16x16x32_bf16 v[192:195], v[68:71], v[36:39], v[192:195]
ds_read_b64_tr_b16 v[90:91], v15 offset:1024
v_accvgpr_read_b32 v31, a143
v_mfma_f32_16x16x32_bf16 v[196:199], v[68:71], v[44:47], 0
ds_read_b64_tr_b16 v[92:93], v15 offset:8192
v_cvt_pk_bf16_f32 v24, v24, v28
v_mfma_f32_16x16x32_bf16 v[196:199], v[64:67], v[40:43], v[196:199]
s_add_u32 s72, s69, 15360
buffer_load_dwordx4 v5, s[4:7], s72 offen offset:1024 lds
v_mfma_f32_16x16x32_bf16 v[200:203], v[64:67], v[48:51], 0
ds_read_b64_tr_b16 v[94:95], v15 offset:9216
v_cvt_pk_bf16_f32 v25, v25, v29
v_mfma_f32_16x16x32_bf16 v[200:203], v[68:71], v[52:55], v[200:203]
ds_read_b128 v[108:111], v19 offset:2048
v_cvt_pk_bf16_f32 v26, v26, v30
v_mfma_f32_16x16x32_bf16 v[204:207], v[68:71], v[60:63], 0
v_cvt_pk_bf16_f32 v27, v27, v31
v_mfma_f32_16x16x32_bf16 v[204:207], v[64:67], v[56:59], v[204:207]
s_waitcnt lgkmcnt(12)
ds_read_b128 v[112:115], v18 offset:4096
v_mfma_f32_16x16x32_bf16 v[220:223], v[72:75], v[56:59], 0
s_add_u32 s72, s69, 129024
buffer_load_dwordx4 v4, s[4:7], s72 offen offset:2048 lds
v_mfma_f32_16x16x32_bf16 v[220:223], v[76:79], v[60:63], v[220:223]
s_add_u32 s80, s78, 8192
buffer_store_dwordx4 v[24:27], v1, s[44:47], s80 offen sc1
v_mfma_f32_16x16x32_bf16 v[216:219], v[76:79], v[52:55], 0
s_waitcnt vmcnt(21) lgkmcnt(2)
ds_read_b128 v[116:119], v19 offset:4096
v_mfma_f32_16x16x32_bf16 v[216:219], v[72:75], v[48:51], v[216:219]
s_barrier
ds_read_b128 v[120:123], v18 offset:6144
v_mfma_f32_16x16x32_bf16 v[212:215], v[72:75], v[40:43], 0
ds_read_b64_tr_b16 v[64:65], v8 offset:16384
ds_read_b64_tr_b16 v[66:67], v8 offset:17408
v_mfma_f32_16x16x32_bf16 v[212:215], v[76:79], v[44:47], v[212:215]
ds_read_b64_tr_b16 v[68:69], v8 offset:24576
v_mfma_f32_16x16x32_bf16 v[208:211], v[76:79], v[36:39], 0
s_add_u32 s72, s69, 144384
buffer_load_dwordx4 v5, s[4:7], s72 offen offset:3072 lds
v_mfma_f32_16x16x32_bf16 v[208:211], v[72:75], v[32:35], v[208:211]
ds_read_b64_tr_b16 v[70:71], v8 offset:25600
v_accvgpr_read_b32 v20, a16
v_mfma_f32_16x16x32_bf16 v[224:227], v[80:83], v[32:35], 0
ds_read_b64_tr_b16 v[72:73], v9 offset:16384
v_accvgpr_read_b32 v28, a17
v_mfma_f32_16x16x32_bf16 v[224:227], v[84:87], v[36:39], v[224:227]
ds_read_b64_tr_b16 v[74:75], v9 offset:17408
v_accvgpr_read_b32 v21, a18
v_mfma_f32_16x16x32_bf16 v[228:231], v[84:87], v[44:47], 0
s_add_u32 m0, s63, 135168
v_accvgpr_read_b32 v29, a19
v_accvgpr_read_b32 v22, a48
v_mfma_f32_16x16x32_bf16 v[228:231], v[80:83], v[40:43], v[228:231]
s_add_u32 s72, s70, 0
buffer_load_dwordx4 v4, s[4:7], s72 offen lds
v_mfma_f32_16x16x32_bf16 v[232:235], v[80:83], v[48:51], 0
ds_read_b64_tr_b16 v[76:77], v9 offset:24576
v_accvgpr_read_b32 v30, a49
v_mfma_f32_16x16x32_bf16 v[232:235], v[84:87], v[52:55], v[232:235]
ds_read_b128 v[124:127], v19 offset:6144
v_accvgpr_read_b32 v23, a50
v_mfma_f32_16x16x32_bf16 v[236:239], v[84:87], v[60:63], 0
ds_read_b64_tr_b16 v[78:79], v9 offset:25600
v_accvgpr_read_b32 v31, a51
v_mfma_f32_16x16x32_bf16 v[236:239], v[80:83], v[56:59], v[236:239]
v_mul_f32 v20, s79, v20
v_mul_f32 v28, s79, v28
v_mfma_f32_16x16x32_bf16 v[252:255], v[88:91], v[56:59], 0
s_add_u32 s72, s70, 15360
buffer_load_dwordx4 v5, s[4:7], s72 offen offset:1024 lds
v_mfma_f32_16x16x32_bf16 v[252:255], v[92:95], v[60:63], v[252:255]
ds_read_b64_tr_b16 v[80:81], v10 offset:16384
v_mul_f32 v21, s79, v21
v_mfma_f32_16x16x32_bf16 v[248:251], v[92:95], v[52:55], 0
ds_read_b64_tr_b16 v[82:83], v10 offset:17408
v_mul_f32 v29, s79, v29
v_mfma_f32_16x16x32_bf16 v[248:251], v[88:91], v[48:51], v[248:251]
v_mul_f32 v22, s79, v22
v_mul_f32 v30, s79, v30
v_mfma_f32_16x16x32_bf16 v[244:247], v[88:91], v[40:43], 0
ds_read_b64_tr_b16 v[84:85], v10 offset:24576
v_mul_f32 v23, s79, v23
v_mfma_f32_16x16x32_bf16 v[244:247], v[92:95], v[44:47], v[244:247]
ds_read_b64_tr_b16 v[86:87], v10 offset:25600
v_mul_f32 v31, s79, v31
v_mfma_f32_16x16x32_bf16 v[240:243], v[92:95], v[36:39], 0
s_add_u32 s72, s70, 129024
buffer_load_dwordx4 v4, s[4:7], s72 offen offset:2048 lds
v_mfma_f32_16x16x32_bf16 v[240:243], v[88:91], v[32:35], v[240:243]
s_waitcnt lgkmcnt(5)
v_cvt_pk_bf16_f32 v20, v20, v28
v_cvt_pk_bf16_f32 v21, v21, v29
v_mfma_f32_16x16x32_bf16 v[128:131], v[64:67], v[96:99], v[128:131]
ds_read_b64_tr_b16 v[88:89], v11 offset:16384
v_cvt_pk_bf16_f32 v22, v22, v30
v_mfma_f32_16x16x32_bf16 v[128:131], v[68:71], v[100:103], v[128:131]
ds_read_b64_tr_b16 v[90:91], v11 offset:17408
v_cvt_pk_bf16_f32 v23, v23, v31
v_mfma_f32_16x16x32_bf16 v[132:135], v[68:71], v[108:111], v[132:135]
s_add_u32 s80, s77, 32768
buffer_store_dwordx4 v[20:23], v1, s[44:47], s80 offen sc1
v_mfma_f32_16x16x32_bf16 v[132:135], v[64:67], v[104:107], v[132:135]
s_add_u32 s72, s70, 144384
buffer_load_dwordx4 v5, s[4:7], s72 offen offset:3072 lds
v_mfma_f32_16x16x32_bf16 v[136:139], v[64:67], v[112:115], v[136:139]
ds_read_b64_tr_b16 v[92:93], v11 offset:24576
v_accvgpr_read_b32 v24, a144
v_mfma_f32_16x16x32_bf16 v[136:139], v[68:71], v[116:119], v[136:139]
s_lshl_b32 s71, s73, 12
v_accvgpr_read_b32 v28, a145
v_accvgpr_read_b32 v25, a146
v_mfma_f32_16x16x32_bf16 v[140:143], v[68:71], v[124:127], v[140:143]
s_add_u32 s71, s71, s66
ds_read_b64_tr_b16 v[94:95], v11 offset:25600
v_accvgpr_read_b32 v29, a147
v_mfma_f32_16x16x32_bf16 v[140:143], v[64:67], v[120:123], v[140:143]
s_waitcnt lgkmcnt(8)
v_accvgpr_read_b32 v26, a148
v_accvgpr_read_b32 v30, a149
v_mfma_f32_16x16x32_bf16 v[156:159], v[72:75], v[120:123], v[156:159]
s_add_u32 m0, s64, 0
ds_read_b64_tr_b16 v[64:65], v12 offset:16384
v_accvgpr_read_b32 v27, a150
v_mfma_f32_16x16x32_bf16 v[156:159], v[76:79], v[124:127], v[156:159]
s_add_u32 s72, s71, 0
buffer_load_dwordx4 v6, s[12:15], s72 offen lds
v_mfma_f32_16x16x32_bf16 v[152:155], v[76:79], v[116:119], v[152:155]
s_add_u32 s73, s62, 4
ds_read_b64_tr_b16 v[66:67], v12 offset:17408
v_accvgpr_read_b32 v31, a151
v_mfma_f32_16x16x32_bf16 v[152:155], v[72:75], v[112:115], v[152:155]
s_add_u32 s70, s73, s65
v_cvt_pk_bf16_f32 v24, v24, v28
v_cvt_pk_bf16_f32 v25, v25, v29
v_mfma_f32_16x16x32_bf16 v[148:151], v[72:75], v[104:107], v[148:151]
s_and_b32 s70, s70, 3
ds_read_b64_tr_b16 v[68:69], v12 offset:24576
v_cvt_pk_bf16_f32 v26, v26, v30
v_mfma_f32_16x16x32_bf16 v[148:151], v[76:79], v[108:111], v[148:151]
s_and_b32 s73, s73, 12
ds_read_b64_tr_b16 v[70:71], v12 offset:25600
v_cvt_pk_bf16_f32 v27, v27, v31
v_mfma_f32_16x16x32_bf16 v[144:147], v[76:79], v[100:103], v[144:147]
s_add_u32 s72, s71, 31744
buffer_load_dwordx4 v6, s[12:15], s72 offen offset:1024 lds
v_mfma_f32_16x16x32_bf16 v[144:147], v[72:75], v[96:99], v[144:147]
s_waitcnt lgkmcnt(8)
v_mfma_f32_16x16x32_bf16 v[160:163], v[80:83], v[96:99], v[160:163]
s_or_b32 s73, s73, s70
ds_read_b64_tr_b16 v[72:73], v13 offset:16384
v_mfma_f32_16x16x32_bf16 v[160:163], v[84:87], v[100:103], v[160:163]
s_lshl_b32 s73, s73, 7
ds_read_b64_tr_b16 v[74:75], v13 offset:17408
v_mfma_f32_16x16x32_bf16 v[164:167], v[84:87], v[108:111], v[164:167]
s_add_u32 s69, s73, s67
v_mfma_f32_16x16x32_bf16 v[164:167], v[80:83], v[104:107], v[164:167]
s_add_u32 s72, s71, 63488
buffer_load_dwordx4 v7, s[12:15], s72 offen offset:2048 lds
v_mfma_f32_16x16x32_bf16 v[168:171], v[80:83], v[112:115], v[168:171]
s_waitcnt vmcnt(18)
ds_read_b64_tr_b16 v[76:77], v13 offset:24576
v_mfma_f32_16x16x32_bf16 v[168:171], v[84:87], v[116:119], v[168:171]
s_add_u32 s70, s73, s68
ds_read_b128 v[32:35], v18 offset:32768
v_mfma_f32_16x16x32_bf16 v[172:175], v[84:87], v[124:127], v[172:175]
s_add_u32 s80, s78, 32768
ds_read_b64_tr_b16 v[78:79], v13 offset:25600
v_mfma_f32_16x16x32_bf16 v[172:175], v[80:83], v[120:123], v[172:175]
s_waitcnt lgkmcnt(9)
ds_read_b128 v[36:39], v19 offset:32768
v_mfma_f32_16x16x32_bf16 v[188:191], v[88:91], v[120:123], v[188:191]
s_add_u32 s72, s71, 95232
buffer_load_dwordx4 v7, s[12:15], s72 offen offset:3072 lds
v_mfma_f32_16x16x32_bf16 v[188:191], v[92:95], v[124:127], v[188:191]
ds_read_b64_tr_b16 v[80:81], v14 offset:16384
v_mfma_f32_16x16x32_bf16 v[184:187], v[92:95], v[116:119], v[184:187]
ds_read_b64_tr_b16 v[82:83], v14 offset:17408
v_mfma_f32_16x16x32_bf16 v[184:187], v[88:91], v[112:115], v[184:187]
buffer_store_dwordx4 v[24:27], v1, s[44:47], s80 offen sc1
v_mfma_f32_16x16x32_bf16 v[180:183], v[88:91], v[104:107], v[180:183]
ds_read_b64_tr_b16 v[84:85], v14 offset:24576
v_accvgpr_read_b32 v20, a20
v_mfma_f32_16x16x32_bf16 v[180:183], v[92:95], v[108:111], v[180:183]
s_add_u32 m0, s63, 65536
ds_read_b64_tr_b16 v[86:87], v14 offset:25600
v_accvgpr_read_b32 v28, a21
v_mfma_f32_16x16x32_bf16 v[176:179], v[92:95], v[100:103], v[176:179]
s_add_u32 s72, s69, 0
buffer_load_dwordx4 v4, s[4:7], s72 offen lds
v_mfma_f32_16x16x32_bf16 v[176:179], v[88:91], v[96:99], v[176:179]
s_waitcnt lgkmcnt(10)
ds_read_b128 v[40:43], v18 offset:34816
v_accvgpr_read_b32 v21, a22
v_mfma_f32_16x16x32_bf16 v[192:195], v[64:67], v[96:99], v[192:195]
ds_read_b64_tr_b16 v[88:89], v15 offset:16384
v_accvgpr_read_b32 v29, a23
v_mfma_f32_16x16x32_bf16 v[192:195], v[68:71], v[100:103], v[192:195]
ds_read_b64_tr_b16 v[90:91], v15 offset:17408
v_accvgpr_read_b32 v22, a52
v_mfma_f32_16x16x32_bf16 v[196:199], v[68:71], v[108:111], v[196:199]
ds_read_b64_tr_b16 v[92:93], v15 offset:24576
v_accvgpr_read_b32 v30, a53
v_mfma_f32_16x16x32_bf16 v[196:199], v[64:67], v[104:107], v[196:199]
s_add_u32 s72, s69, 15360
buffer_load_dwordx4 v5, s[4:7], s72 offen offset:1024 lds
v_mfma_f32_16x16x32_bf16 v[200:203], v[64:67], v[112:115], v[200:203]
ds_read_b64_tr_b16 v[94:95], v15 offset:25600
v_accvgpr_read_b32 v23, a54
v_mfma_f32_16x16x32_bf16 v[200:203], v[68:71], v[116:119], v[200:203]
ds_read_b128 v[44:47], v19 offset:34816
v_accvgpr_read_b32 v31, a55
v_mfma_f32_16x16x32_bf16 v[204:207], v[68:71], v[124:127], v[204:207]
v_mul_f32 v20, s79, v20
v_mul_f32 v28, s79, v28
v_mfma_f32_16x16x32_bf16 v[204:207], v[64:67], v[120:123], v[204:207]
s_waitcnt lgkmcnt(11)
ds_read_b128 v[48:51], v18 offset:36864
v_mul_f32 v21, s79, v21
v_mfma_f32_16x16x32_bf16 v[220:223], v[72:75], v[120:123], v[220:223]
s_add_u32 s72, s69, 129024
buffer_load_dwordx4 v4, s[4:7], s72 offen offset:2048 lds
v_mfma_f32_16x16x32_bf16 v[220:223], v[76:79], v[124:127], v[220:223]
v_mul_f32 v29, s79, v29
v_mul_f32 v22, s79, v22
v_mfma_f32_16x16x32_bf16 v[216:219], v[76:79], v[116:119], v[216:219]
s_waitcnt vmcnt(19) lgkmcnt(2)
ds_read_b128 v[52:55], v19 offset:36864
v_mul_f32 v30, s79, v30
v_mfma_f32_16x16x32_bf16 v[216:219], v[72:75], v[112:115], v[216:219]
s_barrier
ds_read_b128 v[56:59], v18 offset:38912
v_mul_f32 v23, s79, v23
v_mfma_f32_16x16x32_bf16 v[212:215], v[72:75], v[104:107], v[212:215]
ds_read_b64_tr_b16 v[64:65], v8 offset:32768
ds_read_b64_tr_b16 v[66:67], v8 offset:33792
v_mfma_f32_16x16x32_bf16 v[212:215], v[76:79], v[108:111], v[212:215]
ds_read_b64_tr_b16 v[68:69], v8 offset:40960
v_mul_f32 v31, s79, v31
v_mfma_f32_16x16x32_bf16 v[208:211], v[76:79], v[100:103], v[208:211]
s_add_u32 s72, s69, 144384
buffer_load_dwordx4 v5, s[4:7], s72 offen offset:3072 lds
v_mfma_f32_16x16x32_bf16 v[208:211], v[72:75], v[96:99], v[208:211]
ds_read_b64_tr_b16 v[70:71], v8 offset:41984
v_cvt_pk_bf16_f32 v20, v20, v28
v_mfma_f32_16x16x32_bf16 v[224:227], v[80:83], v[96:99], v[224:227]
ds_read_b64_tr_b16 v[72:73], v9 offset:32768
v_cvt_pk_bf16_f32 v21, v21, v29
v_mfma_f32_16x16x32_bf16 v[224:227], v[84:87], v[100:103], v[224:227]
ds_read_b64_tr_b16 v[74:75], v9 offset:33792
v_cvt_pk_bf16_f32 v22, v22, v30
v_mfma_f32_16x16x32_bf16 v[228:231], v[84:87], v[108:111], v[228:231]
s_add_u32 m0, s63, 69632
v_cvt_pk_bf16_f32 v23, v23, v31
v_accvgpr_read_b32 v24, a152
v_mfma_f32_16x16x32_bf16 v[228:231], v[80:83], v[104:107], v[228:231]
s_add_u32 s72, s70, 0
buffer_load_dwordx4 v4, s[4:7], s72 offen lds
v_mfma_f32_16x16x32_bf16 v[232:235], v[80:83], v[112:115], v[232:235]
s_add_u32 s80, s77, 36864
ds_read_b64_tr_b16 v[76:77], v9 offset:40960
v_accvgpr_read_b32 v28, a153
v_mfma_f32_16x16x32_bf16 v[232:235], v[84:87], v[116:119], v[232:235]
ds_read_b128 v[60:63], v19 offset:38912
v_accvgpr_read_b32 v25, a154
v_mfma_f32_16x16x32_bf16 v[236:239], v[84:87], v[124:127], v[236:239]
ds_read_b64_tr_b16 v[78:79], v9 offset:41984
v_accvgpr_read_b32 v29, a155
v_mfma_f32_16x16x32_bf16 v[236:239], v[80:83], v[120:123], v[236:239]
buffer_store_dwordx4 v[20:23], v1, s[44:47], s80 offen sc1
v_mfma_f32_16x16x32_bf16 v[252:255], v[88:91], v[120:123], v[252:255]
s_add_u32 s72, s70, 15360
buffer_load_dwordx4 v5, s[4:7], s72 offen offset:1024 lds
v_mfma_f32_16x16x32_bf16 v[252:255], v[92:95], v[124:127], v[252:255]
ds_read_b64_tr_b16 v[80:81], v10 offset:32768
v_accvgpr_read_b32 v26, a156
v_mfma_f32_16x16x32_bf16 v[248:251], v[92:95], v[116:119], v[248:251]
ds_read_b64_tr_b16 v[82:83], v10 offset:33792
v_accvgpr_read_b32 v30, a157
v_mfma_f32_16x16x32_bf16 v[248:251], v[88:91], v[112:115], v[248:251]
v_accvgpr_read_b32 v27, a158
v_accvgpr_read_b32 v31, a159
v_mfma_f32_16x16x32_bf16 v[244:247], v[88:91], v[104:107], v[244:247]
ds_read_b64_tr_b16 v[84:85], v10 offset:40960
v_cvt_pk_bf16_f32 v24, v24, v28
v_mfma_f32_16x16x32_bf16 v[244:247], v[92:95], v[108:111], v[244:247]
ds_read_b64_tr_b16 v[86:87], v10 offset:41984
v_cvt_pk_bf16_f32 v25, v25, v29
v_mfma_f32_16x16x32_bf16 v[240:243], v[92:95], v[100:103], v[240:243]
s_add_u32 s72, s70, 129024
buffer_load_dwordx4 v4, s[4:7], s72 offen offset:2048 lds
v_mfma_f32_16x16x32_bf16 v[240:243], v[88:91], v[96:99], v[240:243]
s_waitcnt lgkmcnt(5)
v_cvt_pk_bf16_f32 v26, v26, v30
v_cvt_pk_bf16_f32 v27, v27, v31
v_mfma_f32_16x16x32_bf16 v[128:131], v[64:67], v[32:35], v[128:131]
s_add_u32 s80, s78, 40960
ds_read_b64_tr_b16 v[88:89], v11 offset:32768
v_mfma_f32_16x16x32_bf16 v[128:131], v[68:71], v[36:39], v[128:131]
ds_read_b64_tr_b16 v[90:91], v11 offset:33792
v_mfma_f32_16x16x32_bf16 v[132:135], v[68:71], v[44:47], v[132:135]
buffer_store_dwordx4 v[24:27], v1, s[44:47], s80 offen sc1
v_mfma_f32_16x16x32_bf16 v[132:135], v[64:67], v[40:43], v[132:135]
s_add_u32 s72, s70, 144384
buffer_load_dwordx4 v5, s[4:7], s72 offen offset:3072 lds
v_mfma_f32_16x16x32_bf16 v[136:139], v[64:67], v[48:51], v[136:139]
ds_read_b64_tr_b16 v[92:93], v11 offset:40960
v_mfma_f32_16x16x32_bf16 v[136:139], v[68:71], v[52:55], v[136:139]
s_lshl_b32 s71, s73, 12
v_mfma_f32_16x16x32_bf16 v[140:143], v[68:71], v[60:63], v[140:143]
s_add_u32 s71, s71, s66
ds_read_b64_tr_b16 v[94:95], v11 offset:41984
v_mfma_f32_16x16x32_bf16 v[140:143], v[64:67], v[56:59], v[140:143]
s_waitcnt lgkmcnt(8)
v_accvgpr_read_b32 v20, a24
v_accvgpr_read_b32 v28, a25
v_mfma_f32_16x16x32_bf16 v[156:159], v[72:75], v[56:59], v[156:159]
s_add_u32 m0, s64, 16384
ds_read_b64_tr_b16 v[64:65], v12 offset:32768
v_accvgpr_read_b32 v21, a26
v_mfma_f32_16x16x32_bf16 v[156:159], v[76:79], v[60:63], v[156:159]
s_add_u32 s72, s71, 0
buffer_load_dwordx4 v6, s[12:15], s72 offen lds
v_mfma_f32_16x16x32_bf16 v[152:155], v[76:79], v[52:55], v[152:155]
s_add_u32 s73, s62, 5
ds_read_b64_tr_b16 v[66:67], v12 offset:33792
v_accvgpr_read_b32 v29, a27
v_mfma_f32_16x16x32_bf16 v[152:155], v[72:75], v[48:51], v[152:155]
s_add_u32 s70, s73, s65
v_accvgpr_read_b32 v22, a56
v_accvgpr_read_b32 v30, a57
v_mfma_f32_16x16x32_bf16 v[148:151], v[72:75], v[40:43], v[148:151]
s_and_b32 s70, s70, 3
ds_read_b64_tr_b16 v[68:69], v12 offset:40960
v_accvgpr_read_b32 v23, a58
v_mfma_f32_16x16x32_bf16 v[148:151], v[76:79], v[44:47], v[148:151]
s_and_b32 s73, s73, 12
ds_read_b64_tr_b16 v[70:71], v12 offset:41984
v_accvgpr_read_b32 v31, a59
v_mfma_f32_16x16x32_bf16 v[144:147], v[76:79], v[36:39], v[144:147]
s_add_u32 s72, s71, 31744
buffer_load_dwordx4 v6, s[12:15], s72 offen offset:1024 lds
v_mfma_f32_16x16x32_bf16 v[144:147], v[72:75], v[32:35], v[144:147]
s_waitcnt lgkmcnt(8)
v_mul_f32 v20, s79, v20
v_mul_f32 v28, s79, v28
v_mfma_f32_16x16x32_bf16 v[160:163], v[80:83], v[32:35], v[160:163]
s_or_b32 s73, s73, s70
ds_read_b64_tr_b16 v[72:73], v13 offset:32768
v_mul_f32 v21, s79, v21
v_mfma_f32_16x16x32_bf16 v[160:163], v[84:87], v[36:39], v[160:163]
s_lshl_b32 s73, s73, 7
ds_read_b64_tr_b16 v[74:75], v13 offset:33792
v_mul_f32 v29, s79, v29
v_mfma_f32_16x16x32_bf16 v[164:167], v[84:87], v[44:47], v[164:167]
s_add_u32 s69, s73, s67
v_mul_f32 v22, s79, v22
v_mul_f32 v30, s79, v30
v_mfma_f32_16x16x32_bf16 v[164:167], v[80:83], v[40:43], v[164:167]
s_add_u32 s72, s71, 63488
buffer_load_dwordx4 v7, s[12:15], s72 offen offset:2048 lds
v_mfma_f32_16x16x32_bf16 v[168:171], v[80:83], v[48:51], v[168:171]
s_waitcnt vmcnt(18)
ds_read_b64_tr_b16 v[76:77], v13 offset:40960
v_mul_f32 v23, s79, v23
v_mfma_f32_16x16x32_bf16 v[168:171], v[84:87], v[52:55], v[168:171]
s_add_u32 s70, s73, s68
ds_read_b128 v[96:99], v16 offset:0
v_mul_f32 v31, s79, v31
v_mfma_f32_16x16x32_bf16 v[172:175], v[84:87], v[60:63], v[172:175]
ds_read_b64_tr_b16 v[78:79], v13 offset:41984
v_cvt_pk_bf16_f32 v20, v20, v28
v_mfma_f32_16x16x32_bf16 v[172:175], v[80:83], v[56:59], v[172:175]
s_waitcnt lgkmcnt(9)
ds_read_b128 v[100:103], v17 offset:0
v_cvt_pk_bf16_f32 v21, v21, v29
v_mfma_f32_16x16x32_bf16 v[188:191], v[88:91], v[56:59], v[188:191]
s_add_u32 s72, s71, 95232
buffer_load_dwordx4 v7, s[12:15], s72 offen offset:3072 lds
v_mfma_f32_16x16x32_bf16 v[188:191], v[92:95], v[60:63], v[188:191]
ds_read_b64_tr_b16 v[80:81], v14 offset:32768
v_cvt_pk_bf16_f32 v22, v22, v30
v_mfma_f32_16x16x32_bf16 v[184:187], v[92:95], v[52:55], v[184:187]
ds_read_b64_tr_b16 v[82:83], v14 offset:33792
v_cvt_pk_bf16_f32 v23, v23, v31
v_mfma_f32_16x16x32_bf16 v[184:187], v[88:91], v[48:51], v[184:187]
s_add_u32 s80, s77, 40960
buffer_store_dwordx4 v[20:23], v1, s[44:47], s80 offen sc1
v_mfma_f32_16x16x32_bf16 v[180:183], v[88:91], v[40:43], v[180:183]
ds_read_b64_tr_b16 v[84:85], v14 offset:40960
v_mfma_f32_16x16x32_bf16 v[180:183], v[92:95], v[44:47], v[180:183]
s_add_u32 m0, s63, 98304
ds_read_b64_tr_b16 v[86:87], v14 offset:41984
v_accvgpr_read_b32 v24, a160
v_mfma_f32_16x16x32_bf16 v[176:179], v[92:95], v[36:39], v[176:179]
s_add_u32 s72, s69, 0
buffer_load_dwordx4 v4, s[4:7], s72 offen lds
v_mfma_f32_16x16x32_bf16 v[176:179], v[88:91], v[32:35], v[176:179]
s_waitcnt lgkmcnt(10)
ds_read_b128 v[104:107], v16 offset:2048
v_accvgpr_read_b32 v28, a161
v_mfma_f32_16x16x32_bf16 v[192:195], v[64:67], v[32:35], v[192:195]
ds_read_b64_tr_b16 v[88:89], v15 offset:32768
v_accvgpr_read_b32 v25, a162
v_mfma_f32_16x16x32_bf16 v[192:195], v[68:71], v[36:39], v[192:195]
ds_read_b64_tr_b16 v[90:91], v15 offset:33792
v_accvgpr_read_b32 v29, a163
v_mfma_f32_16x16x32_bf16 v[196:199], v[68:71], v[44:47], v[196:199]
ds_read_b64_tr_b16 v[92:93], v15 offset:40960
v_accvgpr_read_b32 v26, a164
v_mfma_f32_16x16x32_bf16 v[196:199], v[64:67], v[40:43], v[196:199]
s_add_u32 s72, s69, 15360
buffer_load_dwordx4 v5, s[4:7], s72 offen offset:1024 lds
v_mfma_f32_16x16x32_bf16 v[200:203], v[64:67], v[48:51], v[200:203]
ds_read_b64_tr_b16 v[94:95], v15 offset:41984
v_accvgpr_read_b32 v30, a165
v_mfma_f32_16x16x32_bf16 v[200:203], v[68:71], v[52:55], v[200:203]
ds_read_b128 v[108:111], v17 offset:2048
v_accvgpr_read_b32 v27, a166
v_mfma_f32_16x16x32_bf16 v[204:207], v[68:71], v[60:63], v[204:207]
v_accvgpr_read_b32 v31, a167
v_cvt_pk_bf16_f32 v24, v24, v28
v_mfma_f32_16x16x32_bf16 v[204:207], v[64:67], v[56:59], v[204:207]
s_waitcnt lgkmcnt(11)
ds_read_b128 v[112:115], v16 offset:4096
v_cvt_pk_bf16_f32 v25, v25, v29
v_mfma_f32_16x16x32_bf16 v[220:223], v[72:75], v[56:59], v[220:223]
s_add_u32 s72, s69, 129024
buffer_load_dwordx4 v4, s[4:7], s72 offen offset:2048 lds
v_mfma_f32_16x16x32_bf16 v[220:223], v[76:79], v[60:63], v[220:223]
v_cvt_pk_bf16_f32 v26, v26, v30
v_cvt_pk_bf16_f32 v27, v27, v31
v_mfma_f32_16x16x32_bf16 v[216:219], v[76:79], v[52:55], v[216:219]
s_waitcnt vmcnt(19) lgkmcnt(2)
ds_read_b128 v[116:119], v17 offset:4096
v_mfma_f32_16x16x32_bf16 v[216:219], v[72:75], v[48:51], v[216:219]
s_barrier
ds_read_b128 v[120:123], v16 offset:6144
v_mfma_f32_16x16x32_bf16 v[212:215], v[72:75], v[40:43], v[212:215]
s_add_u32 s80, s78, 1024
ds_read_b64_tr_b16 v[64:65], v8 offset:0
ds_read_b64_tr_b16 v[66:67], v8 offset:1024
v_mfma_f32_16x16x32_bf16 v[212:215], v[76:79], v[44:47], v[212:215]
ds_read_b64_tr_b16 v[68:69], v8 offset:8192
v_mfma_f32_16x16x32_bf16 v[208:211], v[76:79], v[36:39], v[208:211]
s_add_u32 s72, s69, 144384
buffer_load_dwordx4 v5, s[4:7], s72 offen offset:3072 lds
v_mfma_f32_16x16x32_bf16 v[208:211], v[72:75], v[32:35], v[208:211]
ds_read_b64_tr_b16 v[70:71], v8 offset:9216
v_mfma_f32_16x16x32_bf16 v[224:227], v[80:83], v[32:35], v[224:227]
ds_read_b64_tr_b16 v[72:73], v9 offset:0
v_mfma_f32_16x16x32_bf16 v[224:227], v[84:87], v[36:39], v[224:227]
ds_read_b64_tr_b16 v[74:75], v9 offset:1024
v_mfma_f32_16x16x32_bf16 v[228:231], v[84:87], v[44:47], v[228:231]
s_add_u32 m0, s63, 102400
buffer_store_dwordx4 v[24:27], v1, s[44:47], s80 offen sc1
v_mfma_f32_16x16x32_bf16 v[228:231], v[80:83], v[40:43], v[228:231]
s_add_u32 s72, s70, 0
buffer_load_dwordx4 v4, s[4:7], s72 offen lds
v_mfma_f32_16x16x32_bf16 v[232:235], v[80:83], v[48:51], v[232:235]
ds_read_b64_tr_b16 v[76:77], v9 offset:8192
v_accvgpr_read_b32 v20, a28
v_mfma_f32_16x16x32_bf16 v[232:235], v[84:87], v[52:55], v[232:235]
ds_read_b128 v[124:127], v17 offset:6144
v_accvgpr_read_b32 v28, a29
v_mfma_f32_16x16x32_bf16 v[236:239], v[84:87], v[60:63], v[236:239]
ds_read_b64_tr_b16 v[78:79], v9 offset:9216
v_accvgpr_read_b32 v21, a30
v_mfma_f32_16x16x32_bf16 v[236:239], v[80:83], v[56:59], v[236:239]
v_accvgpr_read_b32 v29, a31
v_accvgpr_read_b32 v22, a60
v_mfma_f32_16x16x32_bf16 v[252:255], v[88:91], v[56:59], v[252:255]
s_add_u32 s72, s70, 15360
buffer_load_dwordx4 v5, s[4:7], s72 offen offset:1024 lds
v_mfma_f32_16x16x32_bf16 v[252:255], v[92:95], v[60:63], v[252:255]
ds_read_b64_tr_b16 v[80:81], v10 offset:0
v_accvgpr_read_b32 v30, a61
v_mfma_f32_16x16x32_bf16 v[248:251], v[92:95], v[52:55], v[248:251]
ds_read_b64_tr_b16 v[82:83], v10 offset:1024
v_accvgpr_read_b32 v23, a62
v_mfma_f32_16x16x32_bf16 v[248:251], v[88:91], v[48:51], v[248:251]
v_accvgpr_read_b32 v31, a63
v_mul_f32 v20, s79, v20
v_mfma_f32_16x16x32_bf16 v[244:247], v[88:91], v[40:43], v[244:247]
ds_read_b64_tr_b16 v[84:85], v10 offset:8192
v_mul_f32 v28, s79, v28
v_mfma_f32_16x16x32_bf16 v[244:247], v[92:95], v[44:47], v[244:247]
ds_read_b64_tr_b16 v[86:87], v10 offset:9216
v_mul_f32 v21, s79, v21
v_mfma_f32_16x16x32_bf16 v[240:243], v[92:95], v[36:39], v[240:243]
s_add_u32 s72, s70, 129024
buffer_load_dwordx4 v4, s[4:7], s72 offen offset:2048 lds
v_mfma_f32_16x16x32_bf16 v[240:243], v[88:91], v[32:35], v[240:243]
s_waitcnt lgkmcnt(5)
v_mul_f32 v29, s79, v29
v_mul_f32 v22, s79, v22
v_mfma_f32_16x16x32_bf16 v[128:131], v[64:67], v[96:99], v[128:131]
ds_read_b64_tr_b16 v[88:89], v11 offset:0
v_mul_f32 v30, s79, v30
v_mfma_f32_16x16x32_bf16 v[128:131], v[68:71], v[100:103], v[128:131]
ds_read_b64_tr_b16 v[90:91], v11 offset:1024
v_mul_f32 v23, s79, v23
v_mfma_f32_16x16x32_bf16 v[132:135], v[68:71], v[108:111], v[132:135]
v_mul_f32 v31, s79, v31
v_cvt_pk_bf16_f32 v20, v20, v28
v_mfma_f32_16x16x32_bf16 v[132:135], v[64:67], v[104:107], v[132:135]
s_add_u32 s72, s70, 144384
buffer_load_dwordx4 v5, s[4:7], s72 offen offset:3072 lds
v_mfma_f32_16x16x32_bf16 v[136:139], v[64:67], v[112:115], v[136:139]
ds_read_b64_tr_b16 v[92:93], v11 offset:8192
v_cvt_pk_bf16_f32 v21, v21, v29
v_mfma_f32_16x16x32_bf16 v[136:139], v[68:71], v[116:119], v[136:139]
s_lshl_b32 s71, s73, 12
v_cvt_pk_bf16_f32 v22, v22, v30
v_cvt_pk_bf16_f32 v23, v23, v31
v_mfma_f32_16x16x32_bf16 v[140:143], v[68:71], v[124:127], v[140:143]
s_add_u32 s71, s71, s66
ds_read_b64_tr_b16 v[94:95], v11 offset:9216
v_mfma_f32_16x16x32_bf16 v[140:143], v[64:67], v[120:123], v[140:143]
s_waitcnt lgkmcnt(8)
v_mfma_f32_16x16x32_bf16 v[156:159], v[72:75], v[120:123], v[156:159]
s_add_u32 m0, s64, 32768
ds_read_b64_tr_b16 v[64:65], v12 offset:0
v_mfma_f32_16x16x32_bf16 v[156:159], v[76:79], v[124:127], v[156:159]
s_add_u32 s72, s71, 0
buffer_load_dwordx4 v6, s[12:15], s72 offen lds
v_mfma_f32_16x16x32_bf16 v[152:155], v[76:79], v[116:119], v[152:155]
s_add_u32 s73, s62, 6
ds_read_b64_tr_b16 v[66:67], v12 offset:1024
v_accvgpr_read_b32 v24, a168
v_mfma_f32_16x16x32_bf16 v[152:155], v[72:75], v[112:115], v[152:155]
s_add_u32 s70, s73, s65
v_accvgpr_read_b32 v28, a169
v_accvgpr_read_b32 v25, a170
v_mfma_f32_16x16x32_bf16 v[148:151], v[72:75], v[104:107], v[148:151]
s_and_b32 s70, s70, 3
ds_read_b64_tr_b16 v[68:69], v12 offset:8192
v_accvgpr_read_b32 v29, a171
v_mfma_f32_16x16x32_bf16 v[148:151], v[76:79], v[108:111], v[148:151]
s_and_b32 s73, s73, 12
ds_read_b64_tr_b16 v[70:71], v12 offset:9216
v_accvgpr_read_b32 v26, a172
v_mfma_f32_16x16x32_bf16 v[144:147], v[76:79], v[100:103], v[144:147]
s_add_u32 s72, s71, 31744
buffer_load_dwordx4 v6, s[12:15], s72 offen offset:1024 lds
v_mfma_f32_16x16x32_bf16 v[144:147], v[72:75], v[96:99], v[144:147]
s_waitcnt lgkmcnt(8)
v_accvgpr_read_b32 v30, a173
v_accvgpr_read_b32 v27, a174
v_mfma_f32_16x16x32_bf16 v[160:163], v[80:83], v[96:99], v[160:163]
s_or_b32 s73, s73, s70
ds_read_b64_tr_b16 v[72:73], v13 offset:0
v_accvgpr_read_b32 v31, a175
v_mfma_f32_16x16x32_bf16 v[160:163], v[84:87], v[100:103], v[160:163]
s_lshl_b32 s73, s73, 7
ds_read_b64_tr_b16 v[74:75], v13 offset:1024
v_cvt_pk_bf16_f32 v24, v24, v28
v_mfma_f32_16x16x32_bf16 v[164:167], v[84:87], v[108:111], v[164:167]
s_add_u32 s69, s73, s67
v_cvt_pk_bf16_f32 v25, v25, v29
v_cvt_pk_bf16_f32 v26, v26, v30
v_mfma_f32_16x16x32_bf16 v[164:167], v[80:83], v[104:107], v[164:167]
s_add_u32 s72, s71, 63488
buffer_load_dwordx4 v7, s[12:15], s72 offen offset:2048 lds
v_mfma_f32_16x16x32_bf16 v[168:171], v[80:83], v[112:115], v[168:171]
s_waitcnt vmcnt(17)
ds_read_b64_tr_b16 v[76:77], v13 offset:8192
v_cvt_pk_bf16_f32 v27, v27, v31
v_mfma_f32_16x16x32_bf16 v[168:171], v[84:87], v[116:119], v[168:171]
s_add_u32 s70, s73, s68
ds_read_b128 v[32:35], v18 offset:0
v_mfma_f32_16x16x32_bf16 v[172:175], v[84:87], v[124:127], v[172:175]
s_add_u32 s80, s77, 45056
ds_read_b64_tr_b16 v[78:79], v13 offset:9216
v_mfma_f32_16x16x32_bf16 v[172:175], v[80:83], v[120:123], v[172:175]
s_waitcnt lgkmcnt(9)
ds_read_b128 v[36:39], v19 offset:0
v_mfma_f32_16x16x32_bf16 v[188:191], v[88:91], v[120:123], v[188:191]
s_add_u32 s72, s71, 95232
buffer_load_dwordx4 v7, s[12:15], s72 offen offset:3072 lds
v_mfma_f32_16x16x32_bf16 v[188:191], v[92:95], v[124:127], v[188:191]
ds_read_b64_tr_b16 v[80:81], v14 offset:0
v_mfma_f32_16x16x32_bf16 v[184:187], v[92:95], v[116:119], v[184:187]
ds_read_b64_tr_b16 v[82:83], v14 offset:1024
v_mfma_f32_16x16x32_bf16 v[184:187], v[88:91], v[112:115], v[184:187]
buffer_store_dwordx4 v[20:23], v1, s[44:47], s80 offen sc1
v_mfma_f32_16x16x32_bf16 v[180:183], v[88:91], v[104:107], v[180:183]
s_add_u32 s80, s78, 9216
ds_read_b64_tr_b16 v[84:85], v14 offset:8192
v_mfma_f32_16x16x32_bf16 v[180:183], v[92:95], v[108:111], v[180:183]
s_add_u32 m0, s63, 131072
ds_read_b64_tr_b16 v[86:87], v14 offset:9216
v_mfma_f32_16x16x32_bf16 v[176:179], v[92:95], v[100:103], v[176:179]
s_add_u32 s72, s69, 0
buffer_load_dwordx4 v4, s[4:7], s72 offen lds
v_mfma_f32_16x16x32_bf16 v[176:179], v[88:91], v[96:99], v[176:179]
s_waitcnt lgkmcnt(10)
ds_read_b128 v[40:43], v18 offset:2048
v_accvgpr_read_b32 v20, a64
v_mfma_f32_16x16x32_bf16 v[192:195], v[64:67], v[96:99], v[192:195]
ds_read_b64_tr_b16 v[88:89], v15 offset:0
v_accvgpr_read_b32 v28, a65
v_mfma_f32_16x16x32_bf16 v[192:195], v[68:71], v[100:103], v[192:195]
ds_read_b64_tr_b16 v[90:91], v15 offset:1024
v_accvgpr_read_b32 v21, a66
v_mfma_f32_16x16x32_bf16 v[196:199], v[68:71], v[108:111], v[196:199]
ds_read_b64_tr_b16 v[92:93], v15 offset:8192
v_accvgpr_read_b32 v29, a67
v_mfma_f32_16x16x32_bf16 v[196:199], v[64:67], v[104:107], v[196:199]
s_add_u32 s72, s69, 15360
buffer_load_dwordx4 v5, s[4:7], s72 offen offset:1024 lds
v_mfma_f32_16x16x32_bf16 v[200:203], v[64:67], v[112:115], v[200:203]
ds_read_b64_tr_b16 v[94:95], v15 offset:9216
v_accvgpr_read_b32 v22, a96
v_mfma_f32_16x16x32_bf16 v[200:203], v[68:71], v[116:119], v[200:203]
ds_read_b128 v[44:47], v19 offset:2048
v_accvgpr_read_b32 v30, a97
v_mfma_f32_16x16x32_bf16 v[204:207], v[68:71], v[124:127], v[204:207]
buffer_store_dwordx4 v[24:27], v1, s[44:47], s80 offen sc1
v_mfma_f32_16x16x32_bf16 v[204:207], v[64:67], v[120:123], v[204:207]
s_waitcnt lgkmcnt(11)
ds_read_b128 v[48:51], v18 offset:4096
v_accvgpr_read_b32 v23, a98
v_mfma_f32_16x16x32_bf16 v[220:223], v[72:75], v[120:123], v[220:223]
s_add_u32 s72, s69, 129024
buffer_load_dwordx4 v4, s[4:7], s72 offen offset:2048 lds
v_mfma_f32_16x16x32_bf16 v[220:223], v[76:79], v[124:127], v[220:223]
v_accvgpr_read_b32 v31, a99
v_mul_f32 v20, s79, v20
v_mfma_f32_16x16x32_bf16 v[216:219], v[76:79], v[116:119], v[216:219]
s_waitcnt vmcnt(19) lgkmcnt(2)
ds_read_b128 v[52:55], v19 offset:4096
v_mul_f32 v28, s79, v28
v_mfma_f32_16x16x32_bf16 v[216:219], v[72:75], v[112:115], v[216:219]
s_barrier
ds_read_b128 v[56:59], v18 offset:6144
v_mul_f32 v21, s79, v21
v_mfma_f32_16x16x32_bf16 v[212:215], v[72:75], v[104:107], v[212:215]
ds_read_b64_tr_b16 v[64:65], v8 offset:16384
ds_read_b64_tr_b16 v[66:67], v8 offset:17408
v_mfma_f32_16x16x32_bf16 v[212:215], v[76:79], v[108:111], v[212:215]
ds_read_b64_tr_b16 v[68:69], v8 offset:24576
v_mul_f32 v29, s79, v29
v_mfma_f32_16x16x32_bf16 v[208:211], v[76:79], v[100:103], v[208:211]
s_add_u32 s72, s69, 144384
buffer_load_dwordx4 v5, s[4:7], s72 offen offset:3072 lds
v_mfma_f32_16x16x32_bf16 v[208:211], v[72:75], v[96:99], v[208:211]
ds_read_b64_tr_b16 v[70:71], v8 offset:25600
v_mul_f32 v22, s79, v22
v_mfma_f32_16x16x32_bf16 v[224:227], v[80:83], v[96:99], v[224:227]
ds_read_b64_tr_b16 v[72:73], v9 offset:16384
v_mul_f32 v30, s79, v30
v_mfma_f32_16x16x32_bf16 v[224:227], v[84:87], v[100:103], v[224:227]
ds_read_b64_tr_b16 v[74:75], v9 offset:17408
v_mul_f32 v23, s79, v23
v_mfma_f32_16x16x32_bf16 v[228:231], v[84:87], v[108:111], v[228:231]
s_add_u32 m0, s63, 135168
v_mul_f32 v31, s79, v31
v_cvt_pk_bf16_f32 v20, v20, v28
v_mfma_f32_16x16x32_bf16 v[228:231], v[80:83], v[104:107], v[228:231]
s_add_u32 s72, s70, 0
buffer_load_dwordx4 v4, s[4:7], s72 offen lds
v_mfma_f32_16x16x32_bf16 v[232:235], v[80:83], v[112:115], v[232:235]
ds_read_b64_tr_b16 v[76:77], v9 offset:24576
v_cvt_pk_bf16_f32 v21, v21, v29
v_mfma_f32_16x16x32_bf16 v[232:235], v[84:87], v[116:119], v[232:235]
ds_read_b128 v[60:63], v19 offset:6144
v_cvt_pk_bf16_f32 v22, v22, v30
v_mfma_f32_16x16x32_bf16 v[236:239], v[84:87], v[124:127], v[236:239]
ds_read_b64_tr_b16 v[78:79], v9 offset:25600
v_cvt_pk_bf16_f32 v23, v23, v31
v_mfma_f32_16x16x32_bf16 v[236:239], v[80:83], v[120:123], v[236:239]
s_add_u32 s80, s77, 1024
buffer_store_dwordx4 v[20:23], v1, s[44:47], s80 offen sc1
v_mfma_f32_16x16x32_bf16 v[252:255], v[88:91], v[120:123], v[252:255]
s_add_u32 s72, s70, 15360
buffer_load_dwordx4 v5, s[4:7], s72 offen offset:1024 lds
v_mfma_f32_16x16x32_bf16 v[252:255], v[92:95], v[124:127], v[252:255]
ds_read_b64_tr_b16 v[80:81], v10 offset:16384
v_accvgpr_read_b32 v24, a176
v_mfma_f32_16x16x32_bf16 v[248:251], v[92:95], v[116:119], v[248:251]
ds_read_b64_tr_b16 v[82:83], v10 offset:17408
v_accvgpr_read_b32 v28, a177
v_mfma_f32_16x16x32_bf16 v[248:251], v[88:91], v[112:115], v[248:251]
v_accvgpr_read_b32 v25, a178
v_accvgpr_read_b32 v29, a179
v_mfma_f32_16x16x32_bf16 v[244:247], v[88:91], v[104:107], v[244:247]
ds_read_b64_tr_b16 v[84:85], v10 offset:24576
v_accvgpr_read_b32 v26, a180
v_mfma_f32_16x16x32_bf16 v[244:247], v[92:95], v[108:111], v[244:247]
ds_read_b64_tr_b16 v[86:87], v10 offset:25600
v_accvgpr_read_b32 v30, a181
v_mfma_f32_16x16x32_bf16 v[240:243], v[92:95], v[100:103], v[240:243]
s_add_u32 s72, s70, 129024
buffer_load_dwordx4 v4, s[4:7], s72 offen offset:2048 lds
v_mfma_f32_16x16x32_bf16 v[240:243], v[88:91], v[96:99], v[240:243]
s_waitcnt lgkmcnt(5)
v_accvgpr_read_b32 v27, a182
v_accvgpr_read_b32 v31, a183
v_mfma_f32_16x16x32_bf16 v[128:131], v[64:67], v[32:35], v[128:131]
ds_read_b64_tr_b16 v[88:89], v11 offset:16384
v_cvt_pk_bf16_f32 v24, v24, v28
v_mfma_f32_16x16x32_bf16 v[128:131], v[68:71], v[36:39], v[128:131]
ds_read_b64_tr_b16 v[90:91], v11 offset:17408
v_cvt_pk_bf16_f32 v25, v25, v29
v_mfma_f32_16x16x32_bf16 v[132:135], v[68:71], v[44:47], v[132:135]
v_cvt_pk_bf16_f32 v26, v26, v30
v_cvt_pk_bf16_f32 v27, v27, v31
v_mfma_f32_16x16x32_bf16 v[132:135], v[64:67], v[40:43], v[132:135]
s_add_u32 s72, s70, 144384
buffer_load_dwordx4 v5, s[4:7], s72 offen offset:3072 lds
v_mfma_f32_16x16x32_bf16 v[136:139], v[64:67], v[48:51], v[136:139]
s_add_u32 s80, s78, 33792
ds_read_b64_tr_b16 v[92:93], v11 offset:24576
v_mfma_f32_16x16x32_bf16 v[136:139], v[68:71], v[52:55], v[136:139]
s_lshl_b32 s71, s73, 12
buffer_store_dwordx4 v[24:27], v1, s[44:47], s80 offen sc1
v_mfma_f32_16x16x32_bf16 v[140:143], v[68:71], v[60:63], v[140:143]
s_add_u32 s71, s71, s66
ds_read_b64_tr_b16 v[94:95], v11 offset:25600
v_mfma_f32_16x16x32_bf16 v[140:143], v[64:67], v[56:59], v[140:143]
s_waitcnt lgkmcnt(8)
v_mfma_f32_16x16x32_bf16 v[156:159], v[72:75], v[56:59], v[156:159]
s_add_u32 m0, s64, 0
ds_read_b64_tr_b16 v[64:65], v12 offset:16384
v_mfma_f32_16x16x32_bf16 v[156:159], v[76:79], v[60:63], v[156:159]
s_add_u32 s72, s71, 0
buffer_load_dwordx4 v6, s[12:15], s72 offen lds
v_mfma_f32_16x16x32_bf16 v[152:155], v[76:79], v[52:55], v[152:155]
s_add_u32 s73, s62, 7
ds_read_b64_tr_b16 v[66:67], v12 offset:17408
v_mfma_f32_16x16x32_bf16 v[152:155], v[72:75], v[48:51], v[152:155]
s_add_u32 s70, s73, s65
v_mfma_f32_16x16x32_bf16 v[148:151], v[72:75], v[40:43], v[148:151]
s_and_b32 s70, s70, 3
ds_read_b64_tr_b16 v[68:69], v12 offset:24576
v_accvgpr_read_b32 v20, a68
v_mfma_f32_16x16x32_bf16 v[148:151], v[76:79], v[44:47], v[148:151]
s_and_b32 s73, s73, 12
ds_read_b64_tr_b16 v[70:71], v12 offset:25600
v_accvgpr_read_b32 v28, a69
v_mfma_f32_16x16x32_bf16 v[144:147], v[76:79], v[36:39], v[144:147]
s_add_u32 s72, s71, 31744
buffer_load_dwordx4 v6, s[12:15], s72 offen offset:1024 lds
v_mfma_f32_16x16x32_bf16 v[144:147], v[72:75], v[32:35], v[144:147]
s_waitcnt lgkmcnt(8)
v_accvgpr_read_b32 v21, a70
v_accvgpr_read_b32 v29, a71
v_mfma_f32_16x16x32_bf16 v[160:163], v[80:83], v[32:35], v[160:163]
s_or_b32 s73, s73, s70
ds_read_b64_tr_b16 v[72:73], v13 offset:16384
v_accvgpr_read_b32 v22, a100
v_mfma_f32_16x16x32_bf16 v[160:163], v[84:87], v[36:39], v[160:163]
s_lshl_b32 s73, s73, 7
ds_read_b64_tr_b16 v[74:75], v13 offset:17408
v_accvgpr_read_b32 v30, a101
v_mfma_f32_16x16x32_bf16 v[164:167], v[84:87], v[44:47], v[164:167]
s_add_u32 s69, s73, s67
v_accvgpr_read_b32 v23, a102
v_accvgpr_read_b32 v31, a103
v_mfma_f32_16x16x32_bf16 v[164:167], v[80:83], v[40:43], v[164:167]
s_add_u32 s72, s71, 63488
buffer_load_dwordx4 v7, s[12:15], s72 offen offset:2048 lds
v_mfma_f32_16x16x32_bf16 v[168:171], v[80:83], v[48:51], v[168:171]
s_waitcnt vmcnt(19)
ds_read_b64_tr_b16 v[76:77], v13 offset:24576
v_mul_f32 v20, s79, v20
v_mfma_f32_16x16x32_bf16 v[168:171], v[84:87], v[52:55], v[168:171]
s_add_u32 s70, s73, s68
ds_read_b128 v[96:99], v18 offset:32768
v_mul_f32 v28, s79, v28
v_mfma_f32_16x16x32_bf16 v[172:175], v[84:87], v[60:63], v[172:175]
ds_read_b64_tr_b16 v[78:79], v13 offset:25600
v_mul_f32 v21, s79, v21
v_mfma_f32_16x16x32_bf16 v[172:175], v[80:83], v[56:59], v[172:175]
s_waitcnt lgkmcnt(9)
ds_read_b128 v[100:103], v19 offset:32768
v_mul_f32 v29, s79, v29
v_mfma_f32_16x16x32_bf16 v[188:191], v[88:91], v[56:59], v[188:191]
s_add_u32 s72, s71, 95232
buffer_load_dwordx4 v7, s[12:15], s72 offen offset:3072 lds
v_mfma_f32_16x16x32_bf16 v[188:191], v[92:95], v[60:63], v[188:191]
ds_read_b64_tr_b16 v[80:81], v14 offset:16384
v_mul_f32 v22, s79, v22
v_mfma_f32_16x16x32_bf16 v[184:187], v[92:95], v[52:55], v[184:187]
ds_read_b64_tr_b16 v[82:83], v14 offset:17408
v_mul_f32 v30, s79, v30
v_mfma_f32_16x16x32_bf16 v[184:187], v[88:91], v[48:51], v[184:187]
v_mul_f32 v23, s79, v23
v_mul_f32 v31, s79, v31
v_mfma_f32_16x16x32_bf16 v[180:183], v[88:91], v[40:43], v[180:183]
ds_read_b64_tr_b16 v[84:85], v14 offset:24576
v_cvt_pk_bf16_f32 v20, v20, v28
v_mfma_f32_16x16x32_bf16 v[180:183], v[92:95], v[44:47], v[180:183]
s_add_u32 m0, s63, 65536
ds_read_b64_tr_b16 v[86:87], v14 offset:25600
v_cvt_pk_bf16_f32 v21, v21, v29
v_mfma_f32_16x16x32_bf16 v[176:179], v[92:95], v[36:39], v[176:179]
s_add_u32 s72, s69, 0
buffer_load_dwordx4 v4, s[4:7], s72 offen lds
v_mfma_f32_16x16x32_bf16 v[176:179], v[88:91], v[32:35], v[176:179]
s_waitcnt lgkmcnt(10)
ds_read_b128 v[104:107], v18 offset:34816
v_cvt_pk_bf16_f32 v22, v22, v30
v_mfma_f32_16x16x32_bf16 v[192:195], v[64:67], v[32:35], v[192:195]
ds_read_b64_tr_b16 v[88:89], v15 offset:16384
v_cvt_pk_bf16_f32 v23, v23, v31
v_mfma_f32_16x16x32_bf16 v[192:195], v[68:71], v[36:39], v[192:195]
s_add_u32 s80, s77, 5120
ds_read_b64_tr_b16 v[90:91], v15 offset:17408
v_mfma_f32_16x16x32_bf16 v[196:199], v[68:71], v[44:47], v[196:199]
ds_read_b64_tr_b16 v[92:93], v15 offset:24576
v_accvgpr_read_b32 v24, a184
v_mfma_f32_16x16x32_bf16 v[196:199], v[64:67], v[40:43], v[196:199]
s_add_u32 s72, s69, 15360
buffer_load_dwordx4 v5, s[4:7], s72 offen offset:1024 lds
v_mfma_f32_16x16x32_bf16 v[200:203], v[64:67], v[48:51], v[200:203]
ds_read_b64_tr_b16 v[94:95], v15 offset:25600
v_accvgpr_read_b32 v28, a185
v_mfma_f32_16x16x32_bf16 v[200:203], v[68:71], v[52:55], v[200:203]
ds_read_b128 v[108:111], v19 offset:34816
v_accvgpr_read_b32 v25, a186
v_mfma_f32_16x16x32_bf16 v[204:207], v[68:71], v[60:63], v[204:207]
buffer_store_dwordx4 v[20:23], v1, s[44:47], s80 offen sc1
v_mfma_f32_16x16x32_bf16 v[204:207], v[64:67], v[56:59], v[204:207]
s_waitcnt lgkmcnt(11)
ds_read_b128 v[112:115], v18 offset:36864
v_accvgpr_read_b32 v29, a187
v_mfma_f32_16x16x32_bf16 v[220:223], v[72:75], v[56:59], v[220:223]
s_add_u32 s72, s69, 129024
buffer_load_dwordx4 v4, s[4:7], s72 offen offset:2048 lds
v_mfma_f32_16x16x32_bf16 v[220:223], v[76:79], v[60:63], v[220:223]
v_accvgpr_read_b32 v26, a188
v_accvgpr_read_b32 v30, a189
v_mfma_f32_16x16x32_bf16 v[216:219], v[76:79], v[52:55], v[216:219]
s_waitcnt vmcnt(20) lgkmcnt(2)
ds_read_b128 v[116:119], v19 offset:36864
v_accvgpr_read_b32 v27, a190
v_mfma_f32_16x16x32_bf16 v[216:219], v[72:75], v[48:51], v[216:219]
s_barrier
ds_read_b128 v[120:123], v18 offset:38912
v_accvgpr_read_b32 v31, a191
v_mfma_f32_16x16x32_bf16 v[212:215], v[72:75], v[40:43], v[212:215]
ds_read_b64_tr_b16 v[64:65], v8 offset:32768
ds_read_b64_tr_b16 v[66:67], v8 offset:33792
v_mfma_f32_16x16x32_bf16 v[212:215], v[76:79], v[44:47], v[212:215]
ds_read_b64_tr_b16 v[68:69], v8 offset:40960
v_cvt_pk_bf16_f32 v24, v24, v28
v_mfma_f32_16x16x32_bf16 v[208:211], v[76:79], v[36:39], v[208:211]
s_add_u32 s72, s69, 144384
buffer_load_dwordx4 v5, s[4:7], s72 offen offset:3072 lds
v_mfma_f32_16x16x32_bf16 v[208:211], v[72:75], v[32:35], v[208:211]
ds_read_b64_tr_b16 v[70:71], v8 offset:41984
v_cvt_pk_bf16_f32 v25, v25, v29
v_mfma_f32_16x16x32_bf16 v[224:227], v[80:83], v[32:35], v[224:227]
ds_read_b64_tr_b16 v[72:73], v9 offset:32768
v_cvt_pk_bf16_f32 v26, v26, v30
v_mfma_f32_16x16x32_bf16 v[224:227], v[84:87], v[36:39], v[224:227]
ds_read_b64_tr_b16 v[74:75], v9 offset:33792
v_cvt_pk_bf16_f32 v27, v27, v31
v_mfma_f32_16x16x32_bf16 v[228:231], v[84:87], v[44:47], v[228:231]
s_add_u32 m0, s63, 69632
v_mfma_f32_16x16x32_bf16 v[228:231], v[80:83], v[40:43], v[228:231]
s_add_u32 s72, s70, 0
buffer_load_dwordx4 v4, s[4:7], s72 offen lds
v_mfma_f32_16x16x32_bf16 v[232:235], v[80:83], v[48:51], v[232:235]
s_add_u32 s80, s78, 41984
ds_read_b64_tr_b16 v[76:77], v9 offset:40960
v_mfma_f32_16x16x32_bf16 v[232:235], v[84:87], v[52:55], v[232:235]
ds_read_b128 v[124:127], v19 offset:38912
v_mfma_f32_16x16x32_bf16 v[236:239], v[84:87], v[60:63], v[236:239]
ds_read_b64_tr_b16 v[78:79], v9 offset:41984
v_mfma_f32_16x16x32_bf16 v[236:239], v[80:83], v[56:59], v[236:239]
buffer_store_dwordx4 v[24:27], v1, s[44:47], s80 offen sc1
v_mfma_f32_16x16x32_bf16 v[252:255], v[88:91], v[56:59], v[252:255]
s_add_u32 s72, s70, 15360
buffer_load_dwordx4 v5, s[4:7], s72 offen offset:1024 lds
v_mfma_f32_16x16x32_bf16 v[252:255], v[92:95], v[60:63], v[252:255]
ds_read_b64_tr_b16 v[80:81], v10 offset:32768
v_accvgpr_read_b32 v20, a72
v_mfma_f32_16x16x32_bf16 v[248:251], v[92:95], v[52:55], v[248:251]
ds_read_b64_tr_b16 v[82:83], v10 offset:33792
v_accvgpr_read_b32 v28, a73
v_mfma_f32_16x16x32_bf16 v[248:251], v[88:91], v[48:51], v[248:251]
v_accvgpr_read_b32 v21, a74
v_accvgpr_read_b32 v29, a75
v_mfma_f32_16x16x32_bf16 v[244:247], v[88:91], v[40:43], v[244:247]
ds_read_b64_tr_b16 v[84:85], v10 offset:40960
v_accvgpr_read_b32 v22, a104
v_mfma_f32_16x16x32_bf16 v[244:247], v[92:95], v[44:47], v[244:247]
ds_read_b64_tr_b16 v[86:87], v10 offset:41984
v_accvgpr_read_b32 v30, a105
v_mfma_f32_16x16x32_bf16 v[240:243], v[92:95], v[36:39], v[240:243]
s_add_u32 s72, s70, 129024
buffer_load_dwordx4 v4, s[4:7], s72 offen offset:2048 lds
v_mfma_f32_16x16x32_bf16 v[240:243], v[88:91], v[32:35], v[240:243]
s_waitcnt lgkmcnt(5)
v_accvgpr_read_b32 v23, a106
v_accvgpr_read_b32 v31, a107
v_mfma_f32_16x16x32_bf16 v[128:131], v[64:67], v[96:99], v[128:131]
s_lshr_b32 s75, s93, 4
ds_read_b64_tr_b16 v[88:89], v11 offset:32768
v_mul_f32 v20, s79, v20
v_mfma_f32_16x16x32_bf16 v[128:131], v[68:71], v[100:103], v[128:131]
s_and_b32 s75, s75, 0x7f00
ds_read_b64_tr_b16 v[90:91], v11 offset:33792
v_mul_f32 v28, s79, v28
v_mfma_f32_16x16x32_bf16 v[132:135], v[68:71], v[108:111], v[132:135]
s_add_u32 s75, s75, LcB1-Lpc0
v_lshrrev_b32 v2, 5, v0
v_lshlrev_b32 v2, 7, v2
v_mfma_f32_16x16x32_bf16 v[132:135], v[64:67], v[104:107], v[132:135]
s_add_u32 s72, s70, 144384
buffer_load_dwordx4 v5, s[4:7], s72 offen offset:3072 lds
v_mfma_f32_16x16x32_bf16 v[136:139], v[64:67], v[112:115], v[136:139]
v_add_u32 v2, s75, v2
v_min_u32 v2, Lcode_end-Lpc0, v2
v_mfma_f32_16x16x32_bf16 v[136:139], v[68:71], v[116:119], v[136:139]
s_lshl_b32 s71, s73, 12
global_load_dword v3, v2, s[98:99]
v_mfma_f32_16x16x32_bf16 v[140:143], v[68:71], v[124:127], v[140:143]
s_add_u32 s71, s71, s66
ds_read_b64_tr_b16 v[92:93], v11 offset:40960
v_mul_f32 v21, s79, v21
v_mfma_f32_16x16x32_bf16 v[140:143], v[64:67], v[120:123], v[140:143]
s_waitcnt lgkmcnt(7)
ds_read_b64_tr_b16 v[94:95], v11 offset:41984
v_mul_f32 v29, s79, v29
v_mfma_f32_16x16x32_bf16 v[156:159], v[72:75], v[120:123], v[156:159]
s_add_u32 m0, s64, 16384
ds_read_b64_tr_b16 v[64:65], v12 offset:32768
v_mul_f32 v22, s79, v22
v_mfma_f32_16x16x32_bf16 v[156:159], v[76:79], v[124:127], v[156:159]
s_add_u32 s72, s71, 0
buffer_load_dwordx4 v6, s[12:15], s72 offen lds
v_mfma_f32_16x16x32_bf16 v[152:155], v[76:79], v[116:119], v[152:155]
s_add_u32 s73, s62, 8
ds_read_b64_tr_b16 v[66:67], v12 offset:33792
v_mul_f32 v30, s79, v30
v_mfma_f32_16x16x32_bf16 v[152:155], v[72:75], v[112:115], v[152:155]
s_add_u32 s70, s73, s65
v_mul_f32 v23, s79, v23
v_mul_f32 v31, s79, v31
v_mfma_f32_16x16x32_bf16 v[148:151], v[72:75], v[104:107], v[148:151]
s_and_b32 s70, s70, 3
ds_read_b64_tr_b16 v[68:69], v12 offset:40960
v_cvt_pk_bf16_f32 v20, v20, v28
v_mfma_f32_16x16x32_bf16 v[148:151], v[76:79], v[108:111], v[148:151]
s_and_b32 s73, s73, 12
ds_read_b64_tr_b16 v[70:71], v12 offset:41984
v_cvt_pk_bf16_f32 v21, v21, v29
v_mfma_f32_16x16x32_bf16 v[144:147], v[76:79], v[100:103], v[144:147]
s_add_u32 s72, s71, 31744
buffer_load_dwordx4 v6, s[12:15], s72 offen offset:1024 lds
v_mfma_f32_16x16x32_bf16 v[144:147], v[72:75], v[96:99], v[144:147]
s_waitcnt lgkmcnt(8)
v_cvt_pk_bf16_f32 v22, v22, v30
v_cvt_pk_bf16_f32 v23, v23, v31
v_mfma_f32_16x16x32_bf16 v[160:163], v[80:83], v[96:99], v[160:163]
s_or_b32 s73, s73, s70
ds_read_b64_tr_b16 v[72:73], v13 offset:32768
v_accvgpr_read_b32 v24, a192
v_mfma_f32_16x16x32_bf16 v[160:163], v[84:87], v[100:103], v[160:163]
s_lshl_b32 s73, s73, 7
ds_read_b64_tr_b16 v[74:75], v13 offset:33792
v_accvgpr_read_b32 v28, a193
v_mfma_f32_16x16x32_bf16 v[164:167], v[84:87], v[108:111], v[164:167]
s_add_u32 s69, s73, s67
v_accvgpr_read_b32 v25, a194
v_accvgpr_read_b32 v29, a195
v_mfma_f32_16x16x32_bf16 v[164:167], v[80:83], v[104:107], v[164:167]
s_add_u32 s72, s71, 63488
buffer_load_dwordx4 v7, s[12:15], s72 offen offset:2048 lds
v_mfma_f32_16x16x32_bf16 v[168:171], v[80:83], v[112:115], v[168:171]
s_waitcnt vmcnt(19)
ds_read_b64_tr_b16 v[76:77], v13 offset:40960
v_accvgpr_read_b32 v26, a196
v_mfma_f32_16x16x32_bf16 v[168:171], v[84:87], v[116:119], v[168:171]
s_add_u32 s70, s73, s68
ds_read_b128 v[32:35], v16 offset:0
v_accvgpr_read_b32 v30, a197
v_mfma_f32_16x16x32_bf16 v[172:175], v[84:87], v[124:127], v[172:175]
s_add_u32 s80, s77, 9216
ds_read_b64_tr_b16 v[78:79], v13 offset:41984
v_accvgpr_read_b32 v27, a198
v_mfma_f32_16x16x32_bf16 v[172:175], v[80:83], v[120:123], v[172:175]
s_waitcnt lgkmcnt(9)
ds_read_b128 v[36:39], v17 offset:0
v_accvgpr_read_b32 v31, a199
v_mfma_f32_16x16x32_bf16 v[188:191], v[88:91], v[120:123], v[188:191]
s_add_u32 s72, s71, 95232
buffer_load_dwordx4 v7, s[12:15], s72 offen offset:3072 lds
v_mfma_f32_16x16x32_bf16 v[188:191], v[92:95], v[124:127], v[188:191]
ds_read_b64_tr_b16 v[80:81], v14 offset:32768
v_cvt_pk_bf16_f32 v24, v24, v28
v_mfma_f32_16x16x32_bf16 v[184:187], v[92:95], v[116:119], v[184:187]
ds_read_b64_tr_b16 v[82:83], v14 offset:33792
v_cvt_pk_bf16_f32 v25, v25, v29
v_mfma_f32_16x16x32_bf16 v[184:187], v[88:91], v[112:115], v[184:187]
buffer_store_dwordx4 v[20:23], v1, s[44:47], s80 offen sc1
v_mfma_f32_16x16x32_bf16 v[180:183], v[88:91], v[104:107], v[180:183]
ds_read_b64_tr_b16 v[84:85], v14 offset:40960
v_cvt_pk_bf16_f32 v26, v26, v30
v_mfma_f32_16x16x32_bf16 v[180:183], v[92:95], v[108:111], v[180:183]
s_add_u32 m0, s63, 98304
ds_read_b64_tr_b16 v[86:87], v14 offset:41984
v_cvt_pk_bf16_f32 v27, v27, v31
v_mfma_f32_16x16x32_bf16 v[176:179], v[92:95], v[100:103], v[176:179]
s_add_u32 s72, s69, 0
buffer_load_dwordx4 v4, s[4:7], s72 offen lds
v_mfma_f32_16x16x32_bf16 v[176:179], v[88:91], v[96:99], v[176:179]
s_waitcnt lgkmcnt(10)
ds_read_b128 v[40:43], v16 offset:2048
v_mfma_f32_16x16x32_bf16 v[192:195], v[64:67], v[96:99], v[192:195]
s_add_u32 s80, s78, 2048
ds_read_b64_tr_b16 v[88:89], v15 offset:32768
v_mfma_f32_16x16x32_bf16 v[192:195], v[68:71], v[100:103], v[192:195]
ds_read_b64_tr_b16 v[90:91], v15 offset:33792
v_mfma_f32_16x16x32_bf16 v[196:199], v[68:71], v[108:111], v[196:199]
ds_read_b64_tr_b16 v[92:93], v15 offset:40960
v_mfma_f32_16x16x32_bf16 v[196:199], v[64:67], v[104:107], v[196:199]
s_add_u32 s72, s69, 15360
buffer_load_dwordx4 v5, s[4:7], s72 offen offset:1024 lds
v_mfma_f32_16x16x32_bf16 v[200:203], v[64:67], v[112:115], v[200:203]
ds_read_b64_tr_b16 v[94:95], v15 offset:41984
v_accvgpr_read_b32 v20, a76
v_mfma_f32_16x16x32_bf16 v[200:203], v[68:71], v[116:119], v[200:203]
ds_read_b128 v[44:47], v17 offset:2048
v_accvgpr_read_b32 v28, a77
v_mfma_f32_16x16x32_bf16 v[204:207], v[68:71], v[124:127], v[204:207]
buffer_store_dwordx4 v[24:27], v1, s[44:47], s80 offen sc1
v_mfma_f32_16x16x32_bf16 v[204:207], v[64:67], v[120:123], v[204:207]
s_waitcnt lgkmcnt(11)
ds_read_b128 v[48:51], v16 offset:4096
v_accvgpr_read_b32 v21, a78
v_mfma_f32_16x16x32_bf16 v[220:223], v[72:75], v[120:123], v[220:223]
s_add_u32 s72, s69, 129024
buffer_load_dwordx4 v4, s[4:7], s72 offen offset:2048 lds
v_mfma_f32_16x16x32_bf16 v[220:223], v[76:79], v[124:127], v[220:223]
v_accvgpr_read_b32 v29, a79
v_accvgpr_read_b32 v22, a108
v_mfma_f32_16x16x32_bf16 v[216:219], v[76:79], v[116:119], v[216:219]
s_waitcnt vmcnt(20) lgkmcnt(2)
ds_read_b128 v[52:55], v17 offset:4096
v_accvgpr_read_b32 v30, a109
v_mfma_f32_16x16x32_bf16 v[216:219], v[72:75], v[112:115], v[216:219]
s_barrier
ds_read_b128 v[56:59], v16 offset:6144
v_accvgpr_read_b32 v23, a110
v_mfma_f32_16x16x32_bf16 v[212:215], v[72:75], v[104:107], v[212:215]
ds_read_b64_tr_b16 v[64:65], v8 offset:0
ds_read_b64_tr_b16 v[66:67], v8 offset:1024
v_mfma_f32_16x16x32_bf16 v[212:215], v[76:79], v[108:111], v[212:215]
ds_read_b64_tr_b16 v[68:69], v8 offset:8192
v_accvgpr_read_b32 v31, a111
v_mfma_f32_16x16x32_bf16 v[208:211], v[76:79], v[100:103], v[208:211]
s_add_u32 s72, s69, 144384
buffer_load_dwordx4 v5, s[4:7], s72 offen offset:3072 lds
v_mfma_f32_16x16x32_bf16 v[208:211], v[72:75], v[96:99], v[208:211]
ds_read_b64_tr_b16 v[70:71], v8 offset:9216
v_mul_f32 v20, s79, v20
v_mfma_f32_16x16x32_bf16 v[224:227], v[80:83], v[96:99], v[224:227]
ds_read_b64_tr_b16 v[72:73], v9 offset:0
v_mul_f32 v28, s79, v28
v_mfma_f32_16x16x32_bf16 v[224:227], v[84:87], v[100:103], v[224:227]
ds_read_b64_tr_b16 v[74:75], v9 offset:1024
v_mul_f32 v21, s79, v21
v_mfma_f32_16x16x32_bf16 v[228:231], v[84:87], v[108:111], v[228:231]
s_add_u32 m0, s63, 102400
v_mul_f32 v29, s79, v29
v_mul_f32 v22, s79, v22
v_mfma_f32_16x16x32_bf16 v[228:231], v[80:83], v[104:107], v[228:231]
s_add_u32 s72, s70, 0
buffer_load_dwordx4 v4, s[4:7], s72 offen lds
v_mfma_f32_16x16x32_bf16 v[232:235], v[80:83], v[112:115], v[232:235]
ds_read_b64_tr_b16 v[76:77], v9 offset:8192
v_mul_f32 v30, s79, v30
v_mfma_f32_16x16x32_bf16 v[232:235], v[84:87], v[116:119], v[232:235]
ds_read_b128 v[60:63], v17 offset:6144
v_mul_f32 v23, s79, v23
v_mfma_f32_16x16x32_bf16 v[236:239], v[84:87], v[124:127], v[236:239]
ds_read_b64_tr_b16 v[78:79], v9 offset:9216
v_mul_f32 v31, s79, v31
v_mfma_f32_16x16x32_bf16 v[236:239], v[80:83], v[120:123], v[236:239]
v_cvt_pk_bf16_f32 v20, v20, v28
v_cvt_pk_bf16_f32 v21, v21, v29
v_mfma_f32_16x16x32_bf16 v[252:255], v[88:91], v[120:123], v[252:255]
s_add_u32 s72, s70, 15360
buffer_load_dwordx4 v5, s[4:7], s72 offen offset:1024 lds
v_mfma_f32_16x16x32_bf16 v[252:255], v[92:95], v[124:127], v[252:255]
ds_read_b64_tr_b16 v[80:81], v10 offset:0
v_cvt_pk_bf16_f32 v22, v22, v30
v_mfma_f32_16x16x32_bf16 v[248:251], v[92:95], v[116:119], v[248:251]
ds_read_b64_tr_b16 v[82:83], v10 offset:1024
v_cvt_pk_bf16_f32 v23, v23, v31
v_mfma_f32_16x16x32_bf16 v[248:251], v[88:91], v[112:115], v[248:251]
s_add_u32 s80, s77, 13312
buffer_store_dwordx4 v[20:23], v1, s[44:47], s80 offen sc1
v_mfma_f32_16x16x32_bf16 v[244:247], v[88:91], v[104:107], v[244:247]
ds_read_b64_tr_b16 v[84:85], v10 offset:8192
v_accvgpr_read_b32 v24, a200
v_mfma_f32_16x16x32_bf16 v[244:247], v[92:95], v[108:111], v[244:247]
ds_read_b64_tr_b16 v[86:87], v10 offset:9216
v_accvgpr_read_b32 v28, a201
v_mfma_f32_16x16x32_bf16 v[240:243], v[92:95], v[100:103], v[240:243]
s_add_u32 s72, s70, 129024
buffer_load_dwordx4 v4, s[4:7], s72 offen offset:2048 lds
v_mfma_f32_16x16x32_bf16 v[240:243], v[88:91], v[96:99], v[240:243]
s_waitcnt lgkmcnt(5)
v_accvgpr_read_b32 v25, a202
v_accvgpr_read_b32 v29, a203
v_mfma_f32_16x16x32_bf16 v[128:131], v[64:67], v[32:35], v[128:131]
ds_read_b64_tr_b16 v[88:89], v11 offset:0
v_accvgpr_read_b32 v26, a204
v_mfma_f32_16x16x32_bf16 v[128:131], v[68:71], v[36:39], v[128:131]
ds_read_b64_tr_b16 v[90:91], v11 offset:1024
v_accvgpr_read_b32 v30, a205
v_mfma_f32_16x16x32_bf16 v[132:135], v[68:71], v[44:47], v[132:135]
v_accvgpr_read_b32 v27, a206
v_accvgpr_read_b32 v31, a207
v_mfma_f32_16x16x32_bf16 v[132:135], v[64:67], v[40:43], v[132:135]
s_add_u32 s72, s70, 144384
buffer_load_dwordx4 v5, s[4:7], s72 offen offset:3072 lds
v_mfma_f32_16x16x32_bf16 v[136:139], v[64:67], v[48:51], v[136:139]
ds_read_b64_tr_b16 v[92:93], v11 offset:8192
v_cvt_pk_bf16_f32 v24, v24, v28
v_mfma_f32_16x16x32_bf16 v[136:139], v[68:71], v[52:55], v[136:139]
s_lshl_b32 s71, s73, 12
v_cvt_pk_bf16_f32 v25, v25, v29
v_cvt_pk_bf16_f32 v26, v26, v30
v_mfma_f32_16x16x32_bf16 v[140:143], v[68:71], v[60:63], v[140:143]
s_add_u32 s71, s71, s66
ds_read_b64_tr_b16 v[94:95], v11 offset:9216
v_cvt_pk_bf16_f32 v27, v27, v31
v_mfma_f32_16x16x32_bf16 v[140:143], v[64:67], v[56:59], v[140:143]
s_waitcnt lgkmcnt(8)
v_mfma_f32_16x16x32_bf16 v[156:159], v[72:75], v[56:59], v[156:159]
s_add_u32 m0, s64, 32768
ds_read_b64_tr_b16 v[64:65], v12 offset:0
v_mfma_f32_16x16x32_bf16 v[156:159], v[76:79], v[60:63], v[156:159]
s_add_u32 s72, s71, 0
buffer_load_dwordx4 v6, s[12:15], s72 offen lds
v_mfma_f32_16x16x32_bf16 v[152:155], v[76:79], v[52:55], v[152:155]
s_add_u32 s73, s62, 9
ds_read_b64_tr_b16 v[66:67], v12 offset:1024
v_mfma_f32_16x16x32_bf16 v[152:155], v[72:75], v[48:51], v[152:155]
s_add_u32 s70, s73, s65
v_mfma_f32_16x16x32_bf16 v[148:151], v[72:75], v[40:43], v[148:151]
s_and_b32 s70, s70, 3
ds_read_b64_tr_b16 v[68:69], v12 offset:8192
v_mfma_f32_16x16x32_bf16 v[148:151], v[76:79], v[44:47], v[148:151]
s_and_b32 s73, s73, 12
ds_read_b64_tr_b16 v[70:71], v12 offset:9216
v_mfma_f32_16x16x32_bf16 v[144:147], v[76:79], v[36:39], v[144:147]
s_add_u32 s72, s71, 31744
buffer_load_dwordx4 v6, s[12:15], s72 offen offset:1024 lds
v_mfma_f32_16x16x32_bf16 v[144:147], v[72:75], v[32:35], v[144:147]
s_waitcnt lgkmcnt(8)
v_mfma_f32_16x16x32_bf16 v[160:163], v[80:83], v[32:35], v[160:163]
s_or_b32 s73, s73, s70
ds_read_b64_tr_b16 v[72:73], v13 offset:0
v_accvgpr_read_b32 v20, a80
v_mfma_f32_16x16x32_bf16 v[160:163], v[84:87], v[36:39], v[160:163]
s_lshl_b32 s73, s73, 7
ds_read_b64_tr_b16 v[74:75], v13 offset:1024
v_accvgpr_read_b32 v28, a81
v_mfma_f32_16x16x32_bf16 v[164:167], v[84:87], v[44:47], v[164:167]
s_add_u32 s69, s73, s67
v_accvgpr_read_b32 v21, a82
v_accvgpr_read_b32 v29, a83
v_mfma_f32_16x16x32_bf16 v[164:167], v[80:83], v[40:43], v[164:167]
s_add_u32 s72, s71, 63488
buffer_load_dwordx4 v7, s[12:15], s72 offen offset:2048 lds
v_mfma_f32_16x16x32_bf16 v[168:171], v[80:83], v[48:51], v[168:171]
s_waitcnt vmcnt(19)
ds_read_b64_tr_b16 v[76:77], v13 offset:8192
v_accvgpr_read_b32 v22, a112
v_mfma_f32_16x16x32_bf16 v[168:171], v[84:87], v[52:55], v[168:171]
s_add_u32 s70, s73, s68
ds_read_b128 v[96:99], v18 offset:0
v_accvgpr_read_b32 v30, a113
v_mfma_f32_16x16x32_bf16 v[172:175], v[84:87], v[60:63], v[172:175]
s_add_u32 s80, s78, 10240
ds_read_b64_tr_b16 v[78:79], v13 offset:9216
v_accvgpr_read_b32 v23, a114
v_mfma_f32_16x16x32_bf16 v[172:175], v[80:83], v[56:59], v[172:175]
s_waitcnt lgkmcnt(9)
ds_read_b128 v[100:103], v19 offset:0
v_accvgpr_read_b32 v31, a115
v_mfma_f32_16x16x32_bf16 v[188:191], v[88:91], v[56:59], v[188:191]
s_add_u32 s72, s71, 95232
buffer_load_dwordx4 v7, s[12:15], s72 offen offset:3072 lds
v_mfma_f32_16x16x32_bf16 v[188:191], v[92:95], v[60:63], v[188:191]
ds_read_b64_tr_b16 v[80:81], v14 offset:0
v_mul_f32 v20, s79, v20
v_mfma_f32_16x16x32_bf16 v[184:187], v[92:95], v[52:55], v[184:187]
ds_read_b64_tr_b16 v[82:83], v14 offset:1024
v_mul_f32 v28, s79, v28
v_mfma_f32_16x16x32_bf16 v[184:187], v[88:91], v[48:51], v[184:187]
buffer_store_dwordx4 v[24:27], v1, s[44:47], s80 offen sc1
v_mfma_f32_16x16x32_bf16 v[180:183], v[88:91], v[40:43], v[180:183]
ds_read_b64_tr_b16 v[84:85], v14 offset:8192
v_mul_f32 v21, s79, v21
v_mfma_f32_16x16x32_bf16 v[180:183], v[92:95], v[44:47], v[180:183]
s_add_u32 m0, s63, 131072
ds_read_b64_tr_b16 v[86:87], v14 offset:9216
v_mul_f32 v29, s79, v29
v_mfma_f32_16x16x32_bf16 v[176:179], v[92:95], v[36:39], v[176:179]
s_add_u32 s72, s69, 0
buffer_load_dwordx4 v4, s[4:7], s72 offen lds
v_mfma_f32_16x16x32_bf16 v[176:179], v[88:91], v[32:35], v[176:179]
s_waitcnt lgkmcnt(10)
ds_read_b128 v[104:107], v18 offset:2048
v_mul_f32 v22, s79, v22
v_mfma_f32_16x16x32_bf16 v[192:195], v[64:67], v[32:35], v[192:195]
ds_read_b64_tr_b16 v[88:89], v15 offset:0
v_mul_f32 v30, s79, v30
v_mfma_f32_16x16x32_bf16 v[192:195], v[68:71], v[36:39], v[192:195]
ds_read_b64_tr_b16 v[90:91], v15 offset:1024
v_mul_f32 v23, s79, v23
v_mfma_f32_16x16x32_bf16 v[196:199], v[68:71], v[44:47], v[196:199]
ds_read_b64_tr_b16 v[92:93], v15 offset:8192
v_mul_f32 v31, s79, v31
v_mfma_f32_16x16x32_bf16 v[196:199], v[64:67], v[40:43], v[196:199]
s_add_u32 s72, s69, 15360
buffer_load_dwordx4 v5, s[4:7], s72 offen offset:1024 lds
v_mfma_f32_16x16x32_bf16 v[200:203], v[64:67], v[48:51], v[200:203]
ds_read_b64_tr_b16 v[94:95], v15 offset:9216
v_cvt_pk_bf16_f32 v20, v20, v28
v_mfma_f32_16x16x32_bf16 v[200:203], v[68:71], v[52:55], v[200:203]
ds_read_b128 v[108:111], v19 offset:2048
v_cvt_pk_bf16_f32 v21, v21, v29
v_mfma_f32_16x16x32_bf16 v[204:207], v[68:71], v[60:63], v[204:207]
v_cvt_pk_bf16_f32 v22, v22, v30
v_cvt_pk_bf16_f32 v23, v23, v31
v_mfma_f32_16x16x32_bf16 v[204:207], v[64:67], v[56:59], v[204:207]
s_waitcnt lgkmcnt(11)
ds_read_b128 v[112:115], v18 offset:4096
v_accvgpr_read_b32 v24, a208
v_mfma_f32_16x16x32_bf16 v[220:223], v[72:75], v[56:59], v[220:223]
s_add_u32 s72, s69, 129024
buffer_load_dwordx4 v4, s[4:7], s72 offen offset:2048 lds
v_mfma_f32_16x16x32_bf16 v[220:223], v[76:79], v[60:63], v[220:223]
s_add_u32 s80, s77, 33792
buffer_store_dwordx4 v[20:23], v1, s[44:47], s80 offen sc1
v_mfma_f32_16x16x32_bf16 v[216:219], v[76:79], v[52:55], v[216:219]
s_waitcnt vmcnt(20) lgkmcnt(2)
ds_read_b128 v[116:119], v19 offset:4096
v_accvgpr_read_b32 v28, a209
v_mfma_f32_16x16x32_bf16 v[216:219], v[72:75], v[48:51], v[216:219]
s_barrier
ds_read_b128 v[120:123], v18 offset:6144
v_accvgpr_read_b32 v25, a210
v_mfma_f32_16x16x32_bf16 v[212:215], v[72:75], v[40:43], v[212:215]
ds_read_b64_tr_b16 v[64:65], v8 offset:16384
ds_read_b64_tr_b16 v[66:67], v8 offset:17408
v_mfma_f32_16x16x32_bf16 v[212:215], v[76:79], v[44:47], v[212:215]
ds_read_b64_tr_b16 v[68:69], v8 offset:24576
v_accvgpr_read_b32 v29, a211
v_mfma_f32_16x16x32_bf16 v[208:211], v[76:79], v[36:39], v[208:211]
s_add_u32 s72, s69, 144384
buffer_load_dwordx4 v5, s[4:7], s72 offen offset:3072 lds
v_mfma_f32_16x16x32_bf16 v[208:211], v[72:75], v[32:35], v[208:211]
ds_read_b64_tr_b16 v[70:71], v8 offset:25600
v_accvgpr_read_b32 v26, a212
v_mfma_f32_16x16x32_bf16 v[224:227], v[80:83], v[32:35], v[224:227]
ds_read_b64_tr_b16 v[72:73], v9 offset:16384
v_accvgpr_read_b32 v30, a213
v_mfma_f32_16x16x32_bf16 v[224:227], v[84:87], v[36:39], v[224:227]
ds_read_b64_tr_b16 v[74:75], v9 offset:17408
v_accvgpr_read_b32 v27, a214
v_mfma_f32_16x16x32_bf16 v[228:231], v[84:87], v[44:47], v[228:231]
s_add_u32 m0, s63, 135168
v_accvgpr_read_b32 v31, a215
v_cvt_pk_bf16_f32 v24, v24, v28
v_mfma_f32_16x16x32_bf16 v[228:231], v[80:83], v[40:43], v[228:231]
s_add_u32 s72, s70, 0
buffer_load_dwordx4 v4, s[4:7], s72 offen lds
v_mfma_f32_16x16x32_bf16 v[232:235], v[80:83], v[48:51], v[232:235]
ds_read_b64_tr_b16 v[76:77], v9 offset:24576
v_cvt_pk_bf16_f32 v25, v25, v29
v_mfma_f32_16x16x32_bf16 v[232:235], v[84:87], v[52:55], v[232:235]
ds_read_b128 v[124:127], v19 offset:6144
v_cvt_pk_bf16_f32 v26, v26, v30
v_mfma_f32_16x16x32_bf16 v[236:239], v[84:87], v[60:63], v[236:239]
ds_read_b64_tr_b16 v[78:79], v9 offset:25600
v_cvt_pk_bf16_f32 v27, v27, v31
v_mfma_f32_16x16x32_bf16 v[236:239], v[80:83], v[56:59], v[236:239]
s_add_u32 s80, s78, 34816
buffer_store_dwordx4 v[24:27], v1, s[44:47], s80 offen sc1
v_mfma_f32_16x16x32_bf16 v[252:255], v[88:91], v[56:59], v[252:255]
s_add_u32 s72, s70, 15360
buffer_load_dwordx4 v5, s[4:7], s72 offen offset:1024 lds
v_mfma_f32_16x16x32_bf16 v[252:255], v[92:95], v[60:63], v[252:255]
ds_read_b64_tr_b16 v[80:81], v10 offset:16384
v_mfma_f32_16x16x32_bf16 v[248:251], v[92:95], v[52:55], v[248:251]
ds_read_b64_tr_b16 v[82:83], v10 offset:17408
v_mfma_f32_16x16x32_bf16 v[248:251], v[88:91], v[48:51], v[248:251]
v_mfma_f32_16x16x32_bf16 v[244:247], v[88:91], v[40:43], v[244:247]
ds_read_b64_tr_b16 v[84:85], v10 offset:24576
v_mfma_f32_16x16x32_bf16 v[244:247], v[92:95], v[44:47], v[244:247]
ds_read_b64_tr_b16 v[86:87], v10 offset:25600
v_accvgpr_read_b32 v20, a84
v_mfma_f32_16x16x32_bf16 v[240:243], v[92:95], v[36:39], v[240:243]
s_add_u32 s72, s70, 129024
buffer_load_dwordx4 v4, s[4:7], s72 offen offset:2048 lds
v_mfma_f32_16x16x32_bf16 v[240:243], v[88:91], v[32:35], v[240:243]
s_waitcnt lgkmcnt(5)
v_accvgpr_read_b32 v28, a85
v_accvgpr_read_b32 v21, a86
v_mfma_f32_16x16x32_bf16 v[128:131], v[64:67], v[96:99], v[128:131]
ds_read_b64_tr_b16 v[88:89], v11 offset:16384
v_accvgpr_read_b32 v29, a87
v_mfma_f32_16x16x32_bf16 v[128:131], v[68:71], v[100:103], v[128:131]
ds_read_b64_tr_b16 v[90:91], v11 offset:17408
v_accvgpr_read_b32 v22, a116
v_mfma_f32_16x16x32_bf16 v[132:135], v[68:71], v[108:111], v[132:135]
v_accvgpr_read_b32 v30, a117
v_accvgpr_read_b32 v23, a118
v_mfma_f32_16x16x32_bf16 v[132:135], v[64:67], v[104:107], v[132:135]
s_add_u32 s72, s70, 144384
buffer_load_dwordx4 v5, s[4:7], s72 offen offset:3072 lds
v_mfma_f32_16x16x32_bf16 v[136:139], v[64:67], v[112:115], v[136:139]
ds_read_b64_tr_b16 v[92:93], v11 offset:24576
v_accvgpr_read_b32 v31, a119
v_mfma_f32_16x16x32_bf16 v[136:139], v[68:71], v[116:119], v[136:139]
s_lshl_b32 s71, s73, 12
v_mul_f32 v20, s79, v20
v_mul_f32 v28, s79, v28
v_mfma_f32_16x16x32_bf16 v[140:143], v[68:71], v[124:127], v[140:143]
s_add_u32 s71, s71, s66
ds_read_b64_tr_b16 v[94:95], v11 offset:25600
v_mul_f32 v21, s79, v21
v_mfma_f32_16x16x32_bf16 v[140:143], v[64:67], v[120:123], v[140:143]
s_waitcnt lgkmcnt(8)
v_mul_f32 v29, s79, v29
v_mul_f32 v22, s79, v22
v_mfma_f32_16x16x32_bf16 v[156:159], v[72:75], v[120:123], v[156:159]
s_add_u32 m0, s64, 0
ds_read_b64_tr_b16 v[64:65], v12 offset:16384
v_mul_f32 v30, s79, v30
v_mfma_f32_16x16x32_bf16 v[156:159], v[76:79], v[124:127], v[156:159]
s_add_u32 s72, s71, 0
buffer_load_dwordx4 v6, s[12:15], s72 offen lds
v_mfma_f32_16x16x32_bf16 v[152:155], v[76:79], v[116:119], v[152:155]
s_add_u32 s73, s62, 10
ds_read_b64_tr_b16 v[66:67], v12 offset:17408
v_mul_f32 v23, s79, v23
v_mfma_f32_16x16x32_bf16 v[152:155], v[72:75], v[112:115], v[152:155]
s_add_u32 s70, s73, s65
v_mul_f32 v31, s79, v31
v_cvt_pk_bf16_f32 v20, v20, v28
v_mfma_f32_16x16x32_bf16 v[148:151], v[72:75], v[104:107], v[148:151]
s_and_b32 s70, s70, 3
ds_read_b64_tr_b16 v[68:69], v12 offset:24576
v_cvt_pk_bf16_f32 v21, v21, v29
v_mfma_f32_16x16x32_bf16 v[148:151], v[76:79], v[108:111], v[148:151]
s_and_b32 s73, s73, 12
ds_read_b64_tr_b16 v[70:71], v12 offset:25600
v_cvt_pk_bf16_f32 v22, v22, v30
v_mfma_f32_16x16x32_bf16 v[144:147], v[76:79], v[100:103], v[144:147]
s_add_u32 s72, s71, 31744
buffer_load_dwordx4 v6, s[12:15], s72 offen offset:1024 lds
v_mfma_f32_16x16x32_bf16 v[144:147], v[72:75], v[96:99], v[144:147]
s_waitcnt lgkmcnt(8)
v_cvt_pk_bf16_f32 v23, v23, v31
v_mfma_f32_16x16x32_bf16 v[160:163], v[80:83], v[96:99], v[160:163]
s_or_b32 s73, s73, s70
ds_read_b64_tr_b16 v[72:73], v13 offset:16384
v_mfma_f32_16x16x32_bf16 v[160:163], v[84:87], v[100:103], v[160:163]
s_lshl_b32 s73, s73, 7
ds_read_b64_tr_b16 v[74:75], v13 offset:17408
v_mfma_f32_16x16x32_bf16 v[164:167], v[84:87], v[108:111], v[164:167]
s_add_u32 s69, s73, s67
v_mfma_f32_16x16x32_bf16 v[164:167], v[80:83], v[104:107], v[164:167]
s_add_u32 s72, s71, 63488
buffer_load_dwordx4 v7, s[12:15], s72 offen offset:2048 lds
v_mfma_f32_16x16x32_bf16 v[168:171], v[80:83], v[112:115], v[168:171]
s_waitcnt vmcnt(18)
ds_read_b64_tr_b16 v[76:77], v13 offset:24576
v_accvgpr_read_b32 v24, a216
v_mfma_f32_16x16x32_bf16 v[168:171], v[84:87], v[116:119], v[168:171]
s_add_u32 s70, s73, s68
ds_read_b128 v[32:35], v18 offset:32768
v_accvgpr_read_b32 v28, a217
v_mfma_f32_16x16x32_bf16 v[172:175], v[84:87], v[124:127], v[172:175]
s_add_u32 s80, s77, 37888
ds_read_b64_tr_b16 v[78:79], v13 offset:25600
v_accvgpr_read_b32 v25, a218
v_mfma_f32_16x16x32_bf16 v[172:175], v[80:83], v[120:123], v[172:175]
s_waitcnt lgkmcnt(9)
ds_read_b128 v[36:39], v19 offset:32768
v_accvgpr_read_b32 v29, a219
v_mfma_f32_16x16x32_bf16 v[188:191], v[88:91], v[120:123], v[188:191]
s_add_u32 s72, s71, 95232
buffer_load_dwordx4 v7, s[12:15], s72 offen offset:3072 lds
v_mfma_f32_16x16x32_bf16 v[188:191], v[92:95], v[124:127], v[188:191]
ds_read_b64_tr_b16 v[80:81], v14 offset:16384
v_accvgpr_read_b32 v26, a220
v_mfma_f32_16x16x32_bf16 v[184:187], v[92:95], v[116:119], v[184:187]
ds_read_b64_tr_b16 v[82:83], v14 offset:17408
v_accvgpr_read_b32 v30, a221
v_mfma_f32_16x16x32_bf16 v[184:187], v[88:91], v[112:115], v[184:187]
buffer_store_dwordx4 v[20:23], v1, s[44:47], s80 offen sc1
v_mfma_f32_16x16x32_bf16 v[180:183], v[88:91], v[104:107], v[180:183]
ds_read_b64_tr_b16 v[84:85], v14 offset:24576
v_accvgpr_read_b32 v27, a222
v_mfma_f32_16x16x32_bf16 v[180:183], v[92:95], v[108:111], v[180:183]
s_add_u32 m0, s63, 65536
ds_read_b64_tr_b16 v[86:87], v14 offset:25600
v_accvgpr_read_b32 v31, a223
v_mfma_f32_16x16x32_bf16 v[176:179], v[92:95], v[100:103], v[176:179]
s_add_u32 s72, s69, 0
buffer_load_dwordx4 v4, s[4:7], s72 offen lds
v_mfma_f32_16x16x32_bf16 v[176:179], v[88:91], v[96:99], v[176:179]
s_waitcnt lgkmcnt(10)
ds_read_b128 v[40:43], v18 offset:34816
v_cvt_pk_bf16_f32 v24, v24, v28
v_mfma_f32_16x16x32_bf16 v[192:195], v[64:67], v[96:99], v[192:195]
ds_read_b64_tr_b16 v[88:89], v15 offset:16384
v_cvt_pk_bf16_f32 v25, v25, v29
v_mfma_f32_16x16x32_bf16 v[192:195], v[68:71], v[100:103], v[192:195]
ds_read_b64_tr_b16 v[90:91], v15 offset:17408
v_cvt_pk_bf16_f32 v26, v26, v30
v_mfma_f32_16x16x32_bf16 v[196:199], v[68:71], v[108:111], v[196:199]
ds_read_b64_tr_b16 v[92:93], v15 offset:24576
v_cvt_pk_bf16_f32 v27, v27, v31
v_mfma_f32_16x16x32_bf16 v[196:199], v[64:67], v[104:107], v[196:199]
s_add_u32 s72, s69, 15360
buffer_load_dwordx4 v5, s[4:7], s72 offen offset:1024 lds
v_mfma_f32_16x16x32_bf16 v[200:203], v[64:67], v[112:115], v[200:203]
s_add_u32 s80, s78, 43008
ds_read_b64_tr_b16 v[94:95], v15 offset:25600
v_mfma_f32_16x16x32_bf16 v[200:203], v[68:71], v[116:119], v[200:203]
ds_read_b128 v[44:47], v19 offset:34816
v_mfma_f32_16x16x32_bf16 v[204:207], v[68:71], v[124:127], v[204:207]
buffer_store_dwordx4 v[24:27], v1, s[44:47], s80 offen sc1
v_mfma_f32_16x16x32_bf16 v[204:207], v[64:67], v[120:123], v[204:207]
s_waitcnt lgkmcnt(11)
ds_read_b128 v[48:51], v18 offset:36864
v_mfma_f32_16x16x32_bf16 v[220:223], v[72:75], v[120:123], v[220:223]
s_add_u32 s72, s69, 129024
buffer_load_dwordx4 v4, s[4:7], s72 offen offset:2048 lds
v_mfma_f32_16x16x32_bf16 v[220:223], v[76:79], v[124:127], v[220:223]
v_accvgpr_read_b32 v20, a88
v_accvgpr_read_b32 v28, a89
v_mfma_f32_16x16x32_bf16 v[216:219], v[76:79], v[116:119], v[216:219]
s_waitcnt vmcnt(20) lgkmcnt(2)
ds_read_b128 v[52:55], v19 offset:36864
v_accvgpr_read_b32 v21, a90
v_mfma_f32_16x16x32_bf16 v[216:219], v[72:75], v[112:115], v[216:219]
s_barrier
ds_read_b128 v[56:59], v18 offset:38912
v_accvgpr_read_b32 v29, a91
v_mfma_f32_16x16x32_bf16 v[212:215], v[72:75], v[104:107], v[212:215]
ds_read_b64_tr_b16 v[64:65], v8 offset:32768
ds_read_b64_tr_b16 v[66:67], v8 offset:33792
v_mfma_f32_16x16x32_bf16 v[212:215], v[76:79], v[108:111], v[212:215]
ds_read_b64_tr_b16 v[68:69], v8 offset:40960
v_accvgpr_read_b32 v22, a120
v_mfma_f32_16x16x32_bf16 v[208:211], v[76:79], v[100:103], v[208:211]
s_add_u32 s72, s69, 144384
buffer_load_dwordx4 v5, s[4:7], s72 offen offset:3072 lds
v_mfma_f32_16x16x32_bf16 v[208:211], v[72:75], v[96:99], v[208:211]
ds_read_b64_tr_b16 v[70:71], v8 offset:41984
v_accvgpr_read_b32 v30, a121
v_mfma_f32_16x16x32_bf16 v[224:227], v[80:83], v[96:99], v[224:227]
ds_read_b64_tr_b16 v[72:73], v9 offset:32768
v_accvgpr_read_b32 v23, a122
v_mfma_f32_16x16x32_bf16 v[224:227], v[84:87], v[100:103], v[224:227]
ds_read_b64_tr_b16 v[74:75], v9 offset:33792
v_accvgpr_read_b32 v31, a123
v_mfma_f32_16x16x32_bf16 v[228:231], v[84:87], v[108:111], v[228:231]
s_add_u32 m0, s63, 69632
v_mul_f32 v20, s79, v20
v_mul_f32 v28, s79, v28
v_mfma_f32_16x16x32_bf16 v[228:231], v[80:83], v[104:107], v[228:231]
s_add_u32 s72, s70, 0
buffer_load_dwordx4 v4, s[4:7], s72 offen lds
v_mfma_f32_16x16x32_bf16 v[232:235], v[80:83], v[112:115], v[232:235]
ds_read_b64_tr_b16 v[76:77], v9 offset:40960
v_mul_f32 v21, s79, v21
v_mfma_f32_16x16x32_bf16 v[232:235], v[84:87], v[116:119], v[232:235]
ds_read_b128 v[60:63], v19 offset:38912
v_mul_f32 v29, s79, v29
v_mfma_f32_16x16x32_bf16 v[236:239], v[84:87], v[124:127], v[236:239]
ds_read_b64_tr_b16 v[78:79], v9 offset:41984
v_mul_f32 v22, s79, v22
v_mfma_f32_16x16x32_bf16 v[236:239], v[80:83], v[120:123], v[236:239]
v_mul_f32 v30, s79, v30
v_mul_f32 v23, s79, v23
v_mfma_f32_16x16x32_bf16 v[252:255], v[88:91], v[120:123], v[252:255]
s_add_u32 s72, s70, 15360
buffer_load_dwordx4 v5, s[4:7], s72 offen offset:1024 lds
v_mfma_f32_16x16x32_bf16 v[252:255], v[92:95], v[124:127], v[252:255]
ds_read_b64_tr_b16 v[80:81], v10 offset:32768
v_mul_f32 v31, s79, v31
v_mfma_f32_16x16x32_bf16 v[248:251], v[92:95], v[116:119], v[248:251]
ds_read_b64_tr_b16 v[82:83], v10 offset:33792
v_cvt_pk_bf16_f32 v20, v20, v28
v_mfma_f32_16x16x32_bf16 v[248:251], v[88:91], v[112:115], v[248:251]
v_cvt_pk_bf16_f32 v21, v21, v29
v_cvt_pk_bf16_f32 v22, v22, v30
v_mfma_f32_16x16x32_bf16 v[244:247], v[88:91], v[104:107], v[244:247]
ds_read_b64_tr_b16 v[84:85], v10 offset:40960
v_cvt_pk_bf16_f32 v23, v23, v31
v_mfma_f32_16x16x32_bf16 v[244:247], v[92:95], v[108:111], v[244:247]
s_add_u32 s80, s77, 41984
ds_read_b64_tr_b16 v[86:87], v10 offset:41984
v_mfma_f32_16x16x32_bf16 v[240:243], v[92:95], v[100:103], v[240:243]
s_add_u32 s72, s70, 129024
buffer_load_dwordx4 v4, s[4:7], s72 offen offset:2048 lds
v_mfma_f32_16x16x32_bf16 v[240:243], v[88:91], v[96:99], v[240:243]
s_waitcnt lgkmcnt(5)
buffer_store_dwordx4 v[20:23], v1, s[44:47], s80 offen sc1
LcB1:
v_mfma_f32_16x16x32_bf16 v[128:131], v[64:67], v[32:35], v[128:131]
ds_read_b64_tr_b16 v[88:89], v11 offset:32768
v_accvgpr_read_b32 v24, a224
v_mfma_f32_16x16x32_bf16 v[128:131], v[68:71], v[36:39], v[128:131]
ds_read_b64_tr_b16 v[90:91], v11 offset:33792
v_accvgpr_read_b32 v28, a225
v_mfma_f32_16x16x32_bf16 v[132:135], v[68:71], v[44:47], v[132:135]
v_accvgpr_read_b32 v25, a226
v_accvgpr_read_b32 v29, a227
v_mfma_f32_16x16x32_bf16 v[132:135], v[64:67], v[40:43], v[132:135]
s_add_u32 s72, s70, 144384
buffer_load_dwordx4 v5, s[4:7], s72 offen offset:3072 lds
v_mfma_f32_16x16x32_bf16 v[136:139], v[64:67], v[48:51], v[136:139]
ds_read_b64_tr_b16 v[92:93], v11 offset:40960
v_accvgpr_read_b32 v26, a228
v_mfma_f32_16x16x32_bf16 v[136:139], v[68:71], v[52:55], v[136:139]
s_lshl_b32 s71, s73, 12
v_accvgpr_read_b32 v30, a229
v_accvgpr_read_b32 v27, a230
v_mfma_f32_16x16x32_bf16 v[140:143], v[68:71], v[60:63], v[140:143]
s_add_u32 s71, s71, s66
ds_read_b64_tr_b16 v[94:95], v11 offset:41984
v_accvgpr_read_b32 v31, a231
v_mfma_f32_16x16x32_bf16 v[140:143], v[64:67], v[56:59], v[140:143]
s_waitcnt lgkmcnt(8)
v_cvt_pk_bf16_f32 v24, v24, v28
v_cvt_pk_bf16_f32 v25, v25, v29
v_mfma_f32_16x16x32_bf16 v[156:159], v[72:75], v[56:59], v[156:159]
s_add_u32 m0, s64, 16384
ds_read_b64_tr_b16 v[64:65], v12 offset:32768
v_cvt_pk_bf16_f32 v26, v26, v30
v_mfma_f32_16x16x32_bf16 v[156:159], v[76:79], v[60:63], v[156:159]
s_add_u32 s72, s71, 0
buffer_load_dwordx4 v6, s[12:15], s72 offen lds
v_mfma_f32_16x16x32_bf16 v[152:155], v[76:79], v[52:55], v[152:155]
s_add_u32 s73, s62, 11
ds_read_b64_tr_b16 v[66:67], v12 offset:33792
v_cvt_pk_bf16_f32 v27, v27, v31
v_mfma_f32_16x16x32_bf16 v[152:155], v[72:75], v[48:51], v[152:155]
s_add_u32 s70, s73, s65
v_mfma_f32_16x16x32_bf16 v[148:151], v[72:75], v[40:43], v[148:151]
s_and_b32 s70, s70, 3
ds_read_b64_tr_b16 v[68:69], v12 offset:40960
v_mfma_f32_16x16x32_bf16 v[148:151], v[76:79], v[44:47], v[148:151]
s_and_b32 s73, s73, 12
ds_read_b64_tr_b16 v[70:71], v12 offset:41984
v_mfma_f32_16x16x32_bf16 v[144:147], v[76:79], v[36:39], v[144:147]
s_add_u32 s72, s71, 31744
buffer_load_dwordx4 v6, s[12:15], s72 offen offset:1024 lds
v_mfma_f32_16x16x32_bf16 v[144:147], v[72:75], v[32:35], v[144:147]
s_waitcnt lgkmcnt(8)
v_mfma_f32_16x16x32_bf16 v[160:163], v[80:83], v[32:35], v[160:163]
s_or_b32 s73, s73, s70
ds_read_b64_tr_b16 v[72:73], v13 offset:32768
v_mfma_f32_16x16x32_bf16 v[160:163], v[84:87], v[36:39], v[160:163]
s_lshl_b32 s73, s73, 7
ds_read_b64_tr_b16 v[74:75], v13 offset:33792
v_mfma_f32_16x16x32_bf16 v[164:167], v[84:87], v[44:47], v[164:167]
s_add_u32 s69, s73, s67
v_mfma_f32_16x16x32_bf16 v[164:167], v[80:83], v[40:43], v[164:167]
s_add_u32 s72, s71, 63488
buffer_load_dwordx4 v7, s[12:15], s72 offen offset:2048 lds
v_mfma_f32_16x16x32_bf16 v[168:171], v[80:83], v[48:51], v[168:171]
s_waitcnt vmcnt(18)
ds_read_b64_tr_b16 v[76:77], v13 offset:40960
v_mfma_f32_16x16x32_bf16 v[168:171], v[84:87], v[52:55], v[168:171]
s_add_u32 s70, s73, s68
ds_read_b128 v[96:99], v16 offset:0
v_accvgpr_read_b32 v20, a92
v_mfma_f32_16x16x32_bf16 v[172:175], v[84:87], v[60:63], v[172:175]
s_add_u32 s80, s78, 3072
ds_read_b64_tr_b16 v[78:79], v13 offset:41984
v_accvgpr_read_b32 v28, a93
v_mfma_f32_16x16x32_bf16 v[172:175], v[80:83], v[56:59], v[172:175]
s_waitcnt lgkmcnt(9)
ds_read_b128 v[100:103], v17 offset:0
v_accvgpr_read_b32 v21, a94
v_mfma_f32_16x16x32_bf16 v[188:191], v[88:91], v[56:59], v[188:191]
s_add_u32 s72, s71, 95232
buffer_load_dwordx4 v7, s[12:15], s72 offen offset:3072 lds
v_mfma_f32_16x16x32_bf16 v[188:191], v[92:95], v[60:63], v[188:191]
ds_read_b64_tr_b16 v[80:81], v14 offset:32768
v_accvgpr_read_b32 v29, a95
v_mfma_f32_16x16x32_bf16 v[184:187], v[92:95], v[52:55], v[184:187]
ds_read_b64_tr_b16 v[82:83], v14 offset:33792
v_accvgpr_read_b32 v22, a124
v_mfma_f32_16x16x32_bf16 v[184:187], v[88:91], v[48:51], v[184:187]
buffer_store_dwordx4 v[24:27], v1, s[44:47], s80 offen sc1
v_mfma_f32_16x16x32_bf16 v[180:183], v[88:91], v[40:43], v[180:183]
ds_read_b64_tr_b16 v[84:85], v14 offset:40960
v_accvgpr_read_b32 v30, a125
v_mfma_f32_16x16x32_bf16 v[180:183], v[92:95], v[44:47], v[180:183]
s_add_u32 m0, s63, 98304
ds_read_b64_tr_b16 v[86:87], v14 offset:41984
v_accvgpr_read_b32 v23, a126
v_mfma_f32_16x16x32_bf16 v[176:179], v[92:95], v[36:39], v[176:179]
s_add_u32 s72, s69, 0
buffer_load_dwordx4 v4, s[4:7], s72 offen lds
v_mfma_f32_16x16x32_bf16 v[176:179], v[88:91], v[32:35], v[176:179]
s_waitcnt lgkmcnt(10)
ds_read_b128 v[104:107], v16 offset:2048
v_accvgpr_read_b32 v31, a127
v_mfma_f32_16x16x32_bf16 v[192:195], v[64:67], v[32:35], v[192:195]
ds_read_b64_tr_b16 v[88:89], v15 offset:32768
v_mul_f32 v20, s79, v20
v_mfma_f32_16x16x32_bf16 v[192:195], v[68:71], v[36:39], v[192:195]
ds_read_b64_tr_b16 v[90:91], v15 offset:33792
v_mul_f32 v28, s79, v28
v_mfma_f32_16x16x32_bf16 v[196:199], v[68:71], v[44:47], v[196:199]
ds_read_b64_tr_b16 v[92:93], v15 offset:40960
v_mul_f32 v21, s79, v21
v_mfma_f32_16x16x32_bf16 v[196:199], v[64:67], v[40:43], v[196:199]
s_add_u32 s72, s69, 15360
buffer_load_dwordx4 v5, s[4:7], s72 offen offset:1024 lds
v_mfma_f32_16x16x32_bf16 v[200:203], v[64:67], v[48:51], v[200:203]
ds_read_b64_tr_b16 v[94:95], v15 offset:41984
v_mul_f32 v29, s79, v29
v_mfma_f32_16x16x32_bf16 v[200:203], v[68:71], v[52:55], v[200:203]
ds_read_b128 v[108:111], v17 offset:2048
v_mul_f32 v22, s79, v22
v_mfma_f32_16x16x32_bf16 v[204:207], v[68:71], v[60:63], v[204:207]
v_mul_f32 v30, s79, v30
v_mul_f32 v23, s79, v23
v_mfma_f32_16x16x32_bf16 v[204:207], v[64:67], v[56:59], v[204:207]
s_waitcnt lgkmcnt(11)
ds_read_b128 v[112:115], v16 offset:4096
v_mul_f32 v31, s79, v31
v_mfma_f32_16x16x32_bf16 v[220:223], v[72:75], v[56:59], v[220:223]
s_add_u32 s72, s69, 129024
buffer_load_dwordx4 v4, s[4:7], s72 offen offset:2048 lds
v_mfma_f32_16x16x32_bf16 v[220:223], v[76:79], v[60:63], v[220:223]
v_cvt_pk_bf16_f32 v20, v20, v28
v_cvt_pk_bf16_f32 v21, v21, v29
v_mfma_f32_16x16x32_bf16 v[216:219], v[76:79], v[52:55], v[216:219]
s_waitcnt vmcnt(19) lgkmcnt(2)
ds_read_b128 v[116:119], v17 offset:4096
v_cvt_pk_bf16_f32 v22, v22, v30
v_mfma_f32_16x16x32_bf16 v[216:219], v[72:75], v[48:51], v[216:219]
s_barrier
ds_read_b128 v[120:123], v16 offset:6144
v_cvt_pk_bf16_f32 v23, v23, v31
v_mfma_f32_16x16x32_bf16 v[212:215], v[72:75], v[40:43], v[212:215]
s_add_u32 s80, s77, 46080
ds_read_b64_tr_b16 v[64:65], v8 offset:0
ds_read_b64_tr_b16 v[66:67], v8 offset:1024
v_mfma_f32_16x16x32_bf16 v[212:215], v[76:79], v[44:47], v[212:215]
ds_read_b64_tr_b16 v[68:69], v8 offset:8192
v_accvgpr_read_b32 v24, a232
v_mfma_f32_16x16x32_bf16 v[208:211], v[76:79], v[36:39], v[208:211]
s_add_u32 s72, s69, 144384
buffer_load_dwordx4 v5, s[4:7], s72 offen offset:3072 lds
v_mfma_f32_16x16x32_bf16 v[208:211], v[72:75], v[32:35], v[208:211]
ds_read_b64_tr_b16 v[70:71], v8 offset:9216
v_accvgpr_read_b32 v28, a233
v_mfma_f32_16x16x32_bf16 v[224:227], v[80:83], v[32:35], v[224:227]
ds_read_b64_tr_b16 v[72:73], v9 offset:0
v_accvgpr_read_b32 v25, a234
v_mfma_f32_16x16x32_bf16 v[224:227], v[84:87], v[36:39], v[224:227]
ds_read_b64_tr_b16 v[74:75], v9 offset:1024
v_accvgpr_read_b32 v29, a235
v_mfma_f32_16x16x32_bf16 v[228:231], v[84:87], v[44:47], v[228:231]
s_add_u32 m0, s63, 102400
buffer_store_dwordx4 v[20:23], v1, s[44:47], s80 offen sc1
v_mfma_f32_16x16x32_bf16 v[228:231], v[80:83], v[40:43], v[228:231]
s_add_u32 s72, s70, 0
buffer_load_dwordx4 v4, s[4:7], s72 offen lds
v_mfma_f32_16x16x32_bf16 v[232:235], v[80:83], v[48:51], v[232:235]
ds_read_b64_tr_b16 v[76:77], v9 offset:8192
v_accvgpr_read_b32 v26, a236
v_mfma_f32_16x16x32_bf16 v[232:235], v[84:87], v[52:55], v[232:235]
ds_read_b128 v[124:127], v17 offset:6144
v_accvgpr_read_b32 v30, a237
v_mfma_f32_16x16x32_bf16 v[236:239], v[84:87], v[60:63], v[236:239]
ds_read_b64_tr_b16 v[78:79], v9 offset:9216
v_accvgpr_read_b32 v27, a238
v_mfma_f32_16x16x32_bf16 v[236:239], v[80:83], v[56:59], v[236:239]
v_accvgpr_read_b32 v31, a239
v_cvt_pk_bf16_f32 v24, v24, v28
v_mfma_f32_16x16x32_bf16 v[252:255], v[88:91], v[56:59], v[252:255]
s_add_u32 s72, s70, 15360
buffer_load_dwordx4 v5, s[4:7], s72 offen offset:1024 lds
v_mfma_f32_16x16x32_bf16 v[252:255], v[92:95], v[60:63], v[252:255]
ds_read_b64_tr_b16 v[80:81], v10 offset:0
v_cvt_pk_bf16_f32 v25, v25, v29
v_mfma_f32_16x16x32_bf16 v[248:251], v[92:95], v[52:55], v[248:251]
ds_read_b64_tr_b16 v[82:83], v10 offset:1024
v_cvt_pk_bf16_f32 v26, v26, v30
v_mfma_f32_16x16x32_bf16 v[248:251], v[88:91], v[48:51], v[248:251]
v_cvt_pk_bf16_f32 v27, v27, v31
v_mfma_f32_16x16x32_bf16 v[244:247], v[88:91], v[40:43], v[244:247]
s_add_u32 s80, s78, 11264
ds_read_b64_tr_b16 v[84:85], v10 offset:8192
v_mfma_f32_16x16x32_bf16 v[244:247], v[92:95], v[44:47], v[244:247]
ds_read_b64_tr_b16 v[86:87], v10 offset:9216
v_mfma_f32_16x16x32_bf16 v[240:243], v[92:95], v[36:39], v[240:243]
s_add_u32 s72, s70, 129024
buffer_load_dwordx4 v4, s[4:7], s72 offen offset:2048 lds
v_mfma_f32_16x16x32_bf16 v[240:243], v[88:91], v[32:35], v[240:243]
s_waitcnt lgkmcnt(5)
buffer_store_dwordx4 v[24:27], v1, s[44:47], s80 offen sc1
v_mfma_f32_16x16x32_bf16 v[128:131], v[64:67], v[96:99], v[128:131]
ds_read_b64_tr_b16 v[88:89], v11 offset:0
v_mfma_f32_16x16x32_bf16 v[128:131], v[68:71], v[100:103], v[128:131]
ds_read_b64_tr_b16 v[90:91], v11 offset:1024
v_accvgpr_read_b32 v20, a240
v_mfma_f32_16x16x32_bf16 v[132:135], v[68:71], v[108:111], v[132:135]
v_accvgpr_read_b32 v28, a241
v_accvgpr_read_b32 v21, a242
v_mfma_f32_16x16x32_bf16 v[132:135], v[64:67], v[104:107], v[132:135]
s_add_u32 s72, s70, 144384
buffer_load_dwordx4 v5, s[4:7], s72 offen offset:3072 lds
v_mfma_f32_16x16x32_bf16 v[136:139], v[64:67], v[112:115], v[136:139]
ds_read_b64_tr_b16 v[92:93], v11 offset:8192
v_accvgpr_read_b32 v29, a243
v_mfma_f32_16x16x32_bf16 v[136:139], v[68:71], v[116:119], v[136:139]
s_lshl_b32 s71, s73, 12
v_accvgpr_read_b32 v22, a244
v_accvgpr_read_b32 v30, a245
v_mfma_f32_16x16x32_bf16 v[140:143], v[68:71], v[124:127], v[140:143]
s_add_u32 s71, s71, s66
ds_read_b64_tr_b16 v[94:95], v11 offset:9216
v_accvgpr_read_b32 v23, a246
v_mfma_f32_16x16x32_bf16 v[140:143], v[64:67], v[120:123], v[140:143]
s_waitcnt lgkmcnt(8)
v_accvgpr_read_b32 v31, a247
v_cvt_pk_bf16_f32 v20, v20, v28
v_mfma_f32_16x16x32_bf16 v[156:159], v[72:75], v[120:123], v[156:159]
s_add_u32 m0, s64, 32768
ds_read_b64_tr_b16 v[64:65], v12 offset:0
v_cvt_pk_bf16_f32 v21, v21, v29
v_mfma_f32_16x16x32_bf16 v[156:159], v[76:79], v[124:127], v[156:159]
s_add_u32 s72, s71, 0
buffer_load_dwordx4 v6, s[12:15], s72 offen lds
v_mfma_f32_16x16x32_bf16 v[152:155], v[76:79], v[116:119], v[152:155]
s_add_u32 s73, s62, 12
ds_read_b64_tr_b16 v[66:67], v12 offset:1024
v_cvt_pk_bf16_f32 v22, v22, v30
v_mfma_f32_16x16x32_bf16 v[152:155], v[72:75], v[112:115], v[152:155]
s_add_u32 s70, s73, s65
v_cvt_pk_bf16_f32 v23, v23, v31
v_mfma_f32_16x16x32_bf16 v[148:151], v[72:75], v[104:107], v[148:151]
s_and_b32 s70, s70, 3
ds_read_b64_tr_b16 v[68:69], v12 offset:8192
v_mfma_f32_16x16x32_bf16 v[148:151], v[76:79], v[108:111], v[148:151]
s_and_b32 s73, s73, 12
ds_read_b64_tr_b16 v[70:71], v12 offset:9216
v_mfma_f32_16x16x32_bf16 v[144:147], v[76:79], v[100:103], v[144:147]
s_add_u32 s72, s71, 31744
buffer_load_dwordx4 v6, s[12:15], s72 offen offset:1024 lds
v_mfma_f32_16x16x32_bf16 v[144:147], v[72:75], v[96:99], v[144:147]
s_waitcnt lgkmcnt(8)
v_mfma_f32_16x16x32_bf16 v[160:163], v[80:83], v[96:99], v[160:163]
s_or_b32 s73, s73, s70
ds_read_b64_tr_b16 v[72:73], v13 offset:0
v_mfma_f32_16x16x32_bf16 v[160:163], v[84:87], v[100:103], v[160:163]
s_lshl_b32 s73, s73, 7
ds_read_b64_tr_b16 v[74:75], v13 offset:1024
v_mfma_f32_16x16x32_bf16 v[164:167], v[84:87], v[108:111], v[164:167]
s_add_u32 s69, s73, s67
v_mfma_f32_16x16x32_bf16 v[164:167], v[80:83], v[104:107], v[164:167]
s_add_u32 s72, s71, 63488
buffer_load_dwordx4 v7, s[12:15], s72 offen offset:2048 lds
v_mfma_f32_16x16x32_bf16 v[168:171], v[80:83], v[112:115], v[168:171]
s_waitcnt vmcnt(18)
ds_read_b64_tr_b16 v[76:77], v13 offset:8192
v_mfma_f32_16x16x32_bf16 v[168:171], v[84:87], v[116:119], v[168:171]
s_add_u32 s70, s73, s68
ds_read_b128 v[32:35], v18 offset:0
v_mfma_f32_16x16x32_bf16 v[172:175], v[84:87], v[124:127], v[172:175]
s_add_u32 s80, s78, 35840
ds_read_b64_tr_b16 v[78:79], v13 offset:9216
v_mfma_f32_16x16x32_bf16 v[172:175], v[80:83], v[120:123], v[172:175]
s_waitcnt lgkmcnt(9)
ds_read_b128 v[36:39], v19 offset:0
v_accvgpr_read_b32 v24, a248
v_mfma_f32_16x16x32_bf16 v[188:191], v[88:91], v[120:123], v[188:191]
s_add_u32 s72, s71, 95232
buffer_load_dwordx4 v7, s[12:15], s72 offen offset:3072 lds
v_mfma_f32_16x16x32_bf16 v[188:191], v[92:95], v[124:127], v[188:191]
ds_read_b64_tr_b16 v[80:81], v14 offset:0
v_accvgpr_read_b32 v28, a249
v_mfma_f32_16x16x32_bf16 v[184:187], v[92:95], v[116:119], v[184:187]
ds_read_b64_tr_b16 v[82:83], v14 offset:1024
v_accvgpr_read_b32 v25, a250
v_mfma_f32_16x16x32_bf16 v[184:187], v[88:91], v[112:115], v[184:187]
buffer_store_dwordx4 v[20:23], v1, s[44:47], s80 offen sc1
v_mfma_f32_16x16x32_bf16 v[180:183], v[88:91], v[104:107], v[180:183]
ds_read_b64_tr_b16 v[84:85], v14 offset:8192
v_accvgpr_read_b32 v29, a251
v_mfma_f32_16x16x32_bf16 v[180:183], v[92:95], v[108:111], v[180:183]
s_add_u32 m0, s63, 131072
ds_read_b64_tr_b16 v[86:87], v14 offset:9216
v_accvgpr_read_b32 v26, a252
v_mfma_f32_16x16x32_bf16 v[176:179], v[92:95], v[100:103], v[176:179]
s_add_u32 s72, s69, 0
buffer_load_dwordx4 v4, s[4:7], s72 offen lds
v_mfma_f32_16x16x32_bf16 v[176:179], v[88:91], v[96:99], v[176:179]
s_waitcnt lgkmcnt(10)
ds_read_b128 v[40:43], v18 offset:2048
v_accvgpr_read_b32 v30, a253
v_mfma_f32_16x16x32_bf16 v[192:195], v[64:67], v[96:99], v[192:195]
ds_read_b64_tr_b16 v[88:89], v15 offset:0
v_accvgpr_read_b32 v27, a254
v_mfma_f32_16x16x32_bf16 v[192:195], v[68:71], v[100:103], v[192:195]
ds_read_b64_tr_b16 v[90:91], v15 offset:1024
v_accvgpr_read_b32 v31, a255
v_mfma_f32_16x16x32_bf16 v[196:199], v[68:71], v[108:111], v[196:199]
ds_read_b64_tr_b16 v[92:93], v15 offset:8192
v_cvt_pk_bf16_f32 v24, v24, v28
v_mfma_f32_16x16x32_bf16 v[196:199], v[64:67], v[104:107], v[196:199]
s_add_u32 s72, s69, 15360
buffer_load_dwordx4 v5, s[4:7], s72 offen offset:1024 lds
v_mfma_f32_16x16x32_bf16 v[200:203], v[64:67], v[112:115], v[200:203]
ds_read_b64_tr_b16 v[94:95], v15 offset:9216
v_cvt_pk_bf16_f32 v25, v25, v29
v_mfma_f32_16x16x32_bf16 v[200:203], v[68:71], v[116:119], v[200:203]
ds_read_b128 v[44:47], v19 offset:2048
v_cvt_pk_bf16_f32 v26, v26, v30
v_mfma_f32_16x16x32_bf16 v[204:207], v[68:71], v[124:127], v[204:207]
v_cvt_pk_bf16_f32 v27, v27, v31
v_mfma_f32_16x16x32_bf16 v[204:207], v[64:67], v[120:123], v[204:207]
s_waitcnt lgkmcnt(11)
ds_read_b128 v[48:51], v18 offset:4096
v_mfma_f32_16x16x32_bf16 v[220:223], v[72:75], v[120:123], v[220:223]
s_add_u32 s72, s69, 129024
buffer_load_dwordx4 v4, s[4:7], s72 offen offset:2048 lds
v_mfma_f32_16x16x32_bf16 v[220:223], v[76:79], v[124:127], v[220:223]
s_add_u32 s80, s78, 44032
ds_read_b128 v[52:55], v19 offset:4096
v_mfma_f32_16x16x32_bf16 v[216:219], v[76:79], v[116:119], v[216:219]
s_waitcnt vmcnt(19) lgkmcnt(3)
buffer_store_dwordx4 v[24:27], v1, s[44:47], s80 offen sc1
v_mfma_f32_16x16x32_bf16 v[216:219], v[72:75], v[112:115], v[216:219]
s_barrier
ds_read_b128 v[56:59], v18 offset:6144
v_mfma_f32_16x16x32_bf16 v[212:215], v[72:75], v[104:107], v[212:215]
ds_read_b64_tr_b16 v[64:65], v8 offset:16384
ds_read_b64_tr_b16 v[66:67], v8 offset:17408
v_mfma_f32_16x16x32_bf16 v[212:215], v[76:79], v[108:111], v[212:215]
ds_read_b64_tr_b16 v[68:69], v8 offset:24576
ds_read_b64_tr_b16 v[70:71], v8 offset:25600
v_mfma_f32_16x16x32_bf16 v[208:211], v[76:79], v[100:103], v[208:211]
s_add_u32 s72, s69, 144384
buffer_load_dwordx4 v5, s[4:7], s72 offen offset:3072 lds
v_mfma_f32_16x16x32_bf16 v[208:211], v[72:75], v[96:99], v[208:211]
v_and_b32 v2, 31, v0
v_lshlrev_b32 v2, 2, v2
v_mfma_f32_16x16x32_bf16 v[224:227], v[80:83], v[96:99], v[224:227]
buffer_load_dword v3, v2, s[48:51], 0 offen sc1
v_mfma_f32_16x16x32_bf16 v[224:227], v[84:87], v[100:103], v[224:227]
ds_read_b64_tr_b16 v[72:73], v9 offset:16384
v_mfma_f32_16x16x32_bf16 v[228:231], v[84:87], v[108:111], v[228:231]
s_add_u32 m0, s63, 135168
ds_read_b64_tr_b16 v[74:75], v9 offset:17408
v_mfma_f32_16x16x32_bf16 v[228:231], v[80:83], v[104:107], v[228:231]
s_add_u32 s72, s70, 0
buffer_load_dwordx4 v4, s[4:7], s72 offen lds
v_mfma_f32_16x16x32_bf16 v[232:235], v[80:83], v[112:115], v[232:235]
ds_read_b128 v[60:63], v19 offset:6144
v_mfma_f32_16x16x32_bf16 v[232:235], v[84:87], v[116:119], v[232:235]
ds_read_b64_tr_b16 v[76:77], v9 offset:24576
v_mfma_f32_16x16x32_bf16 v[236:239], v[84:87], v[124:127], v[236:239]
ds_read_b64_tr_b16 v[78:79], v9 offset:25600
v_mfma_f32_16x16x32_bf16 v[236:239], v[80:83], v[120:123], v[236:239]
v_mfma_f32_16x16x32_bf16 v[252:255], v[88:91], v[120:123], v[252:255]
s_add_u32 s72, s70, 15360
buffer_load_dwordx4 v5, s[4:7], s72 offen offset:1024 lds
v_mfma_f32_16x16x32_bf16 v[252:255], v[92:95], v[124:127], v[252:255]
ds_read_b64_tr_b16 v[80:81], v10 offset:16384
v_mfma_f32_16x16x32_bf16 v[248:251], v[92:95], v[116:119], v[248:251]
ds_read_b64_tr_b16 v[82:83], v10 offset:17408
v_mfma_f32_16x16x32_bf16 v[248:251], v[88:91], v[112:115], v[248:251]
v_mfma_f32_16x16x32_bf16 v[244:247], v[88:91], v[104:107], v[244:247]
ds_read_b64_tr_b16 v[84:85], v10 offset:24576
v_mfma_f32_16x16x32_bf16 v[244:247], v[92:95], v[108:111], v[244:247]
ds_read_b64_tr_b16 v[86:87], v10 offset:25600
v_mfma_f32_16x16x32_bf16 v[240:243], v[92:95], v[100:103], v[240:243]
s_add_u32 s72, s70, 129024
buffer_load_dwordx4 v4, s[4:7], s72 offen offset:2048 lds
v_mfma_f32_16x16x32_bf16 v[240:243], v[88:91], v[96:99], v[240:243]
s_waitcnt lgkmcnt(6)
v_mfma_f32_16x16x32_bf16 v[128:131], v[64:67], v[32:35], v[128:131]
ds_read_b64_tr_b16 v[88:89], v11 offset:16384
v_mfma_f32_16x16x32_bf16 v[128:131], v[68:71], v[36:39], v[128:131]
ds_read_b64_tr_b16 v[90:91], v11 offset:17408
v_mfma_f32_16x16x32_bf16 v[132:135], v[68:71], v[44:47], v[132:135]
v_mfma_f32_16x16x32_bf16 v[132:135], v[64:67], v[40:43], v[132:135]
s_add_u32 s72, s70, 144384
buffer_load_dwordx4 v5, s[4:7], s72 offen offset:3072 lds
v_mfma_f32_16x16x32_bf16 v[136:139], v[64:67], v[48:51], v[136:139]
ds_read_b64_tr_b16 v[92:93], v11 offset:24576
v_mfma_f32_16x16x32_bf16 v[136:139], v[68:71], v[52:55], v[136:139]
s_lshl_b32 s71, s73, 12
v_mfma_f32_16x16x32_bf16 v[140:143], v[68:71], v[60:63], v[140:143]
s_add_u32 s71, s71, s66
ds_read_b64_tr_b16 v[94:95], v11 offset:25600
v_mfma_f32_16x16x32_bf16 v[140:143], v[64:67], v[56:59], v[140:143]
s_waitcnt lgkmcnt(8)
v_mfma_f32_16x16x32_bf16 v[156:159], v[72:75], v[56:59], v[156:159]
s_add_u32 m0, s64, 0
ds_read_b64_tr_b16 v[64:65], v12 offset:16384
v_mfma_f32_16x16x32_bf16 v[156:159], v[76:79], v[60:63], v[156:159]
s_add_u32 s72, s71, 0
buffer_load_dwordx4 v6, s[12:15], s72 offen lds
v_mfma_f32_16x16x32_bf16 v[152:155], v[76:79], v[52:55], v[152:155]
s_add_u32 s73, s62, 13
ds_read_b64_tr_b16 v[66:67], v12 offset:17408
v_mfma_f32_16x16x32_bf16 v[152:155], v[72:75], v[48:51], v[152:155]
s_add_u32 s70, s73, s65
v_mfma_f32_16x16x32_bf16 v[148:151], v[72:75], v[40:43], v[148:151]
s_and_b32 s70, s70, 3
ds_read_b64_tr_b16 v[68:69], v12 offset:24576
v_mfma_f32_16x16x32_bf16 v[148:151], v[76:79], v[44:47], v[148:151]
s_and_b32 s73, s73, 12
ds_read_b64_tr_b16 v[70:71], v12 offset:25600
v_mfma_f32_16x16x32_bf16 v[144:147], v[76:79], v[36:39], v[144:147]
s_add_u32 s72, s71, 31744
buffer_load_dwordx4 v6, s[12:15], s72 offen offset:1024 lds
v_mfma_f32_16x16x32_bf16 v[144:147], v[72:75], v[32:35], v[144:147]
s_waitcnt lgkmcnt(8)
v_mfma_f32_16x16x32_bf16 v[160:163], v[80:83], v[32:35], v[160:163]
s_or_b32 s73, s73, s70
ds_read_b64_tr_b16 v[72:73], v13 offset:16384
v_mfma_f32_16x16x32_bf16 v[160:163], v[84:87], v[36:39], v[160:163]
s_lshl_b32 s73, s73, 7
ds_read_b64_tr_b16 v[74:75], v13 offset:17408
v_mfma_f32_16x16x32_bf16 v[164:167], v[84:87], v[44:47], v[164:167]
s_add_u32 s69, s73, s67
v_mfma_f32_16x16x32_bf16 v[164:167], v[80:83], v[40:43], v[164:167]
s_add_u32 s72, s71, 63488
buffer_load_dwordx4 v7, s[12:15], s72 offen offset:2048 lds
v_mfma_f32_16x16x32_bf16 v[168:171], v[80:83], v[48:51], v[168:171]
s_waitcnt vmcnt(18)
ds_read_b64_tr_b16 v[76:77], v13 offset:24576
v_mfma_f32_16x16x32_bf16 v[168:171], v[84:87], v[52:55], v[168:171]
s_add_u32 s70, s73, s68
ds_read_b128 v[96:99], v18 offset:32768
v_mfma_f32_16x16x32_bf16 v[172:175], v[84:87], v[60:63], v[172:175]
ds_read_b64_tr_b16 v[78:79], v13 offset:25600
v_mfma_f32_16x16x32_bf16 v[172:175], v[80:83], v[56:59], v[172:175]
s_waitcnt lgkmcnt(9)
ds_read_b128 v[100:103], v19 offset:32768
v_mfma_f32_16x16x32_bf16 v[188:191], v[88:91], v[56:59], v[188:191]
s_add_u32 s72, s71, 95232
buffer_load_dwordx4 v7, s[12:15], s72 offen offset:3072 lds
v_mfma_f32_16x16x32_bf16 v[188:191], v[92:95], v[60:63], v[188:191]
ds_read_b64_tr_b16 v[80:81], v14 offset:16384
v_mfma_f32_16x16x32_bf16 v[184:187], v[92:95], v[52:55], v[184:187]
ds_read_b64_tr_b16 v[82:83], v14 offset:17408
v_mfma_f32_16x16x32_bf16 v[184:187], v[88:91], v[48:51], v[184:187]
v_mfma_f32_16x16x32_bf16 v[180:183], v[88:91], v[40:43], v[180:183]
ds_read_b64_tr_b16 v[84:85], v14 offset:24576
v_mfma_f32_16x16x32_bf16 v[180:183], v[92:95], v[44:47], v[180:183]
s_add_u32 m0, s63, 65536
ds_read_b64_tr_b16 v[86:87], v14 offset:25600
v_mfma_f32_16x16x32_bf16 v[176:179], v[92:95], v[36:39], v[176:179]
s_add_u32 s72, s69, 0
buffer_load_dwordx4 v4, s[4:7], s72 offen lds
v_mfma_f32_16x16x32_bf16 v[176:179], v[88:91], v[32:35], v[176:179]
s_waitcnt lgkmcnt(10)
ds_read_b128 v[104:107], v18 offset:34816
v_mfma_f32_16x16x32_bf16 v[192:195], v[64:67], v[32:35], v[192:195]
ds_read_b64_tr_b16 v[88:89], v15 offset:16384
v_mfma_f32_16x16x32_bf16 v[192:195], v[68:71], v[36:39], v[192:195]
ds_read_b64_tr_b16 v[90:91], v15 offset:17408
v_mfma_f32_16x16x32_bf16 v[196:199], v[68:71], v[44:47], v[196:199]
ds_read_b64_tr_b16 v[92:93], v15 offset:24576
v_mfma_f32_16x16x32_bf16 v[196:199], v[64:67], v[40:43], v[196:199]
s_add_u32 s72, s69, 15360
buffer_load_dwordx4 v5, s[4:7], s72 offen offset:1024 lds
v_mfma_f32_16x16x32_bf16 v[200:203], v[64:67], v[48:51], v[200:203]
ds_read_b64_tr_b16 v[94:95], v15 offset:25600
v_mfma_f32_16x16x32_bf16 v[200:203], v[68:71], v[52:55], v[200:203]
ds_read_b128 v[108:111], v19 offset:34816
v_mfma_f32_16x16x32_bf16 v[204:207], v[68:71], v[60:63], v[204:207]
v_mfma_f32_16x16x32_bf16 v[204:207], v[64:67], v[56:59], v[204:207]
s_waitcnt lgkmcnt(11)
ds_read_b128 v[112:115], v18 offset:36864
v_mfma_f32_16x16x32_bf16 v[220:223], v[72:75], v[56:59], v[220:223]
s_add_u32 s72, s69, 129024
buffer_load_dwordx4 v4, s[4:7], s72 offen offset:2048 lds
v_mfma_f32_16x16x32_bf16 v[220:223], v[76:79], v[60:63], v[220:223]
v_mfma_f32_16x16x32_bf16 v[216:219], v[76:79], v[52:55], v[216:219]
s_waitcnt vmcnt(13) lgkmcnt(2)
ds_read_b128 v[116:119], v19 offset:36864
v_mfma_f32_16x16x32_bf16 v[216:219], v[72:75], v[48:51], v[216:219]
s_barrier
ds_read_b128 v[120:123], v18 offset:38912
v_mfma_f32_16x16x32_bf16 v[212:215], v[72:75], v[40:43], v[212:215]
ds_read_b64_tr_b16 v[64:65], v8 offset:32768
ds_read_b64_tr_b16 v[66:67], v8 offset:33792
v_mfma_f32_16x16x32_bf16 v[212:215], v[76:79], v[44:47], v[212:215]
ds_read_b64_tr_b16 v[68:69], v8 offset:40960
v_or_b32 v20, s58, v0
v_mfma_f32_16x16x32_bf16 v[208:211], v[76:79], v[36:39], v[208:211]
s_add_u32 s72, s69, 144384
buffer_load_dwordx4 v5, s[4:7], s72 offen offset:3072 lds
v_mfma_f32_16x16x32_bf16 v[208:211], v[72:75], v[32:35], v[208:211]
ds_read_b64_tr_b16 v[70:71], v8 offset:41984
v_mov_b32 v21, 1
v_mfma_f32_16x16x32_bf16 v[224:227], v[80:83], v[32:35], v[224:227]
ds_read_b64_tr_b16 v[72:73], v9 offset:32768
v_min_u32 v20, 1, v20
v_mfma_f32_16x16x32_bf16 v[224:227], v[84:87], v[36:39], v[224:227]
ds_read_b64_tr_b16 v[74:75], v9 offset:33792
v_lshlrev_b32 v20, 30, v20
v_mfma_f32_16x16x32_bf16 v[228:231], v[84:87], v[44:47], v[228:231]
s_add_u32 m0, s63, 69632
buffer_store_dword v21, v20, s[44:47], s91 offen sc1
v_mfma_f32_16x16x32_bf16 v[228:231], v[80:83], v[40:43], v[228:231]
s_add_u32 s72, s70, 0
buffer_load_dwordx4 v4, s[4:7], s72 offen lds
v_mfma_f32_16x16x32_bf16 v[232:235], v[80:83], v[48:51], v[232:235]
ds_read_b64_tr_b16 v[76:77], v9 offset:40960
v_accvgpr_write_b32 a32, 0
v_mfma_f32_16x16x32_bf16 v[232:235], v[84:87], v[52:55], v[232:235]
ds_read_b128 v[124:127], v19 offset:38912
v_accvgpr_write_b32 a33, 0
v_mfma_f32_16x16x32_bf16 v[236:239], v[84:87], v[60:63], v[236:239]
ds_read_b64_tr_b16 v[78:79], v9 offset:41984
v_accvgpr_write_b32 a34, 0
v_mfma_f32_16x16x32_bf16 v[236:239], v[80:83], v[56:59], v[236:239]
v_accvgpr_write_b32 a35, 0
v_accvgpr_write_b32 a36, 0
v_mfma_f32_16x16x32_bf16 v[252:255], v[88:91], v[56:59], v[252:255]
s_add_u32 s72, s70, 15360
buffer_load_dwordx4 v5, s[4:7], s72 offen offset:1024 lds
v_mfma_f32_16x16x32_bf16 v[252:255], v[92:95], v[60:63], v[252:255]
ds_read_b64_tr_b16 v[80:81], v10 offset:32768
v_accvgpr_write_b32 a37, 0
v_mfma_f32_16x16x32_bf16 v[248:251], v[92:95], v[52:55], v[248:251]
ds_read_b64_tr_b16 v[82:83], v10 offset:33792
v_accvgpr_write_b32 a38, 0
v_mfma_f32_16x16x32_bf16 v[248:251], v[88:91], v[48:51], v[248:251]
v_accvgpr_write_b32 a39, 0
v_accvgpr_write_b32 a40, 0
v_mfma_f32_16x16x32_bf16 v[244:247], v[88:91], v[40:43], v[244:247]
ds_read_b64_tr_b16 v[84:85], v10 offset:40960
v_accvgpr_write_b32 a41, 0
v_mfma_f32_16x16x32_bf16 v[244:247], v[92:95], v[44:47], v[244:247]
ds_read_b64_tr_b16 v[86:87], v10 offset:41984
v_accvgpr_write_b32 a42, 0
v_mfma_f32_16x16x32_bf16 v[240:243], v[92:95], v[36:39], v[240:243]
s_add_u32 s72, s70, 129024
buffer_load_dwordx4 v4, s[4:7], s72 offen offset:2048 lds
v_mfma_f32_16x16x32_bf16 v[240:243], v[88:91], v[32:35], v[240:243]
s_waitcnt lgkmcnt(5)
v_accvgpr_write_b32 a43, 0
v_accvgpr_write_b32 a44, 0
v_mfma_f32_16x16x32_bf16 v[128:131], v[64:67], v[96:99], v[128:131]
ds_read_b64_tr_b16 v[88:89], v11 offset:32768
v_accvgpr_write_b32 a45, 0
v_mfma_f32_16x16x32_bf16 v[128:131], v[68:71], v[100:103], v[128:131]
ds_read_b64_tr_b16 v[90:91], v11 offset:33792
v_accvgpr_write_b32 a46, 0
v_mfma_f32_16x16x32_bf16 v[132:135], v[68:71], v[108:111], v[132:135]
v_accvgpr_write_b32 a47, 0
v_accvgpr_write_b32 a48, 0
v_mfma_f32_16x16x32_bf16 v[132:135], v[64:67], v[104:107], v[132:135]
s_add_u32 s72, s70, 144384
buffer_load_dwordx4 v5, s[4:7], s72 offen offset:3072 lds
v_mfma_f32_16x16x32_bf16 v[136:139], v[64:67], v[112:115], v[136:139]
ds_read_b64_tr_b16 v[92:93], v11 offset:40960
v_accvgpr_write_b32 a49, 0
v_mfma_f32_16x16x32_bf16 v[136:139], v[68:71], v[116:119], v[136:139]
s_lshl_b32 s71, s73, 12
v_accvgpr_write_b32 a50, 0
v_accvgpr_write_b32 a51, 0
v_mfma_f32_16x16x32_bf16 v[140:143], v[68:71], v[124:127], v[140:143]
s_add_u32 s71, s71, s66
ds_read_b64_tr_b16 v[94:95], v11 offset:41984
v_accvgpr_write_b32 a52, 0
v_mfma_f32_16x16x32_bf16 v[140:143], v[64:67], v[120:123], v[140:143]
s_waitcnt lgkmcnt(8)
v_accvgpr_write_b32 a53, 0
v_accvgpr_write_b32 a54, 0
v_mfma_f32_16x16x32_bf16 v[156:159], v[72:75], v[120:123], v[156:159]
s_add_u32 m0, s64, 16384
ds_read_b64_tr_b16 v[64:65], v12 offset:32768
v_accvgpr_write_b32 a55, 0
v_mfma_f32_16x16x32_bf16 v[156:159], v[76:79], v[124:127], v[156:159]
s_add_u32 s72, s71, 0
buffer_load_dwordx4 v6, s[12:15], s72 offen lds
v_mfma_f32_16x16x32_bf16 v[152:155], v[76:79], v[116:119], v[152:155]
s_add_u32 s73, s62, 14
ds_read_b64_tr_b16 v[66:67], v12 offset:33792
v_accvgpr_write_b32 a56, 0
v_mfma_f32_16x16x32_bf16 v[152:155], v[72:75], v[112:115], v[152:155]
s_add_u32 s70, s73, s65
v_accvgpr_write_b32 a57, 0
v_accvgpr_write_b32 a58, 0
v_mfma_f32_16x16x32_bf16 v[148:151], v[72:75], v[104:107], v[148:151]
s_and_b32 s70, s70, 3
ds_read_b64_tr_b16 v[68:69], v12 offset:40960
v_accvgpr_write_b32 a59, 0
v_mfma_f32_16x16x32_bf16 v[148:151], v[76:79], v[108:111], v[148:151]
s_and_b32 s73, s73, 12
ds_read_b64_tr_b16 v[70:71], v12 offset:41984
v_accvgpr_write_b32 a60, 0
v_mfma_f32_16x16x32_bf16 v[144:147], v[76:79], v[100:103], v[144:147]
s_add_u32 s72, s71, 31744
buffer_load_dwordx4 v6, s[12:15], s72 offen offset:1024 lds
v_mfma_f32_16x16x32_bf16 v[144:147], v[72:75], v[96:99], v[144:147]
s_waitcnt lgkmcnt(8)
v_accvgpr_write_b32 a61, 0
v_accvgpr_write_b32 a62, 0
v_mfma_f32_16x16x32_bf16 v[160:163], v[80:83], v[96:99], v[160:163]
s_or_b32 s73, s73, s70
ds_read_b64_tr_b16 v[72:73], v13 offset:32768
v_accvgpr_write_b32 a63, 0
v_mfma_f32_16x16x32_bf16 v[160:163], v[84:87], v[100:103], v[160:163]
s_lshl_b32 s73, s73, 7
ds_read_b64_tr_b16 v[74:75], v13 offset:33792
v_accvgpr_write_b32 a96, 0
v_mfma_f32_16x16x32_bf16 v[164:167], v[84:87], v[108:111], v[164:167]
s_add_u32 s69, s73, s67
v_accvgpr_write_b32 a97, 0
v_accvgpr_write_b32 a98, 0
v_mfma_f32_16x16x32_bf16 v[164:167], v[80:83], v[104:107], v[164:167]
s_add_u32 s72, s71, 63488
buffer_load_dwordx4 v7, s[12:15], s72 offen offset:2048 lds
v_mfma_f32_16x16x32_bf16 v[168:171], v[80:83], v[112:115], v[168:171]
s_waitcnt vmcnt(16)
ds_read_b64_tr_b16 v[76:77], v13 offset:40960
v_accvgpr_write_b32 a99, 0
v_mfma_f32_16x16x32_bf16 v[168:171], v[84:87], v[116:119], v[168:171]
s_add_u32 s70, s73, s68
ds_read_b128 v[32:35], v16 offset:0
v_accvgpr_write_b32 a100, 0
v_mfma_f32_16x16x32_bf16 v[172:175], v[84:87], v[124:127], v[172:175]
ds_read_b64_tr_b16 v[78:79], v13 offset:41984
v_accvgpr_write_b32 a101, 0
v_mfma_f32_16x16x32_bf16 v[172:175], v[80:83], v[120:123], v[172:175]
s_waitcnt lgkmcnt(9)
ds_read_b128 v[36:39], v17 offset:0
v_accvgpr_write_b32 a102, 0
v_mfma_f32_16x16x32_bf16 v[188:191], v[88:91], v[120:123], v[188:191]
s_add_u32 s72, s71, 95232
buffer_load_dwordx4 v7, s[12:15], s72 offen offset:3072 lds
v_mfma_f32_16x16x32_bf16 v[188:191], v[92:95], v[124:127], v[188:191]
ds_read_b64_tr_b16 v[80:81], v14 offset:32768
v_accvgpr_write_b32 a103, 0
v_mfma_f32_16x16x32_bf16 v[184:187], v[92:95], v[116:119], v[184:187]
ds_read_b64_tr_b16 v[82:83], v14 offset:33792
v_accvgpr_write_b32 a104, 0
v_mfma_f32_16x16x32_bf16 v[184:187], v[88:91], v[112:115], v[184:187]
v_accvgpr_write_b32 a105, 0
v_accvgpr_write_b32 a106, 0
v_mfma_f32_16x16x32_bf16 v[180:183], v[88:91], v[104:107], v[180:183]
ds_read_b64_tr_b16 v[84:85], v14 offset:40960
v_accvgpr_write_b32 a107, 0
v_mfma_f32_16x16x32_bf16 v[180:183], v[92:95], v[108:111], v[180:183]
s_add_u32 m0, s63, 98304
ds_read_b64_tr_b16 v[86:87], v14 offset:41984
v_accvgpr_write_b32 a108, 0
v_mfma_f32_16x16x32_bf16 v[176:179], v[92:95], v[100:103], v[176:179]
s_add_u32 s72, s69, 0
buffer_load_dwordx4 v4, s[4:7], s72 offen lds
v_mfma_f32_16x16x32_bf16 v[176:179], v[88:91], v[96:99], v[176:179]
s_waitcnt lgkmcnt(10)
ds_read_b128 v[40:43], v16 offset:2048
v_accvgpr_write_b32 a109, 0
v_mfma_f32_16x16x32_bf16 v[192:195], v[64:67], v[96:99], v[192:195]
ds_read_b64_tr_b16 v[88:89], v15 offset:32768
v_accvgpr_write_b32 a110, 0
v_mfma_f32_16x16x32_bf16 v[192:195], v[68:71], v[100:103], v[192:195]
ds_read_b64_tr_b16 v[90:91], v15 offset:33792
v_accvgpr_write_b32 a111, 0
v_mfma_f32_16x16x32_bf16 v[196:199], v[68:71], v[108:111], v[196:199]
ds_read_b64_tr_b16 v[92:93], v15 offset:40960
v_accvgpr_write_b32 a112, 0
v_mfma_f32_16x16x32_bf16 v[196:199], v[64:67], v[104:107], v[196:199]
s_add_u32 s72, s69, 15360
buffer_load_dwordx4 v5, s[4:7], s72 offen offset:1024 lds
v_mfma_f32_16x16x32_bf16 v[200:203], v[64:67], v[112:115], v[200:203]
ds_read_b64_tr_b16 v[94:95], v15 offset:41984
v_accvgpr_write_b32 a113, 0
v_mfma_f32_16x16x32_bf16 v[200:203], v[68:71], v[116:119], v[200:203]
ds_read_b128 v[44:47], v17 offset:2048
v_accvgpr_write_b32 a114, 0
v_mfma_f32_16x16x32_bf16 v[204:207], v[68:71], v[124:127], v[204:207]
v_accvgpr_write_b32 a115, 0
v_accvgpr_write_b32 a116, 0
v_mfma_f32_16x16x32_bf16 v[204:207], v[64:67], v[120:123], v[204:207]
s_waitcnt lgkmcnt(11)
ds_read_b128 v[48:51], v16 offset:4096
v_accvgpr_write_b32 a117, 0
v_mfma_f32_16x16x32_bf16 v[220:223], v[72:75], v[120:123], v[220:223]
s_add_u32 s72, s69, 129024
buffer_load_dwordx4 v4, s[4:7], s72 offen offset:2048 lds
v_mfma_f32_16x16x32_bf16 v[220:223], v[76:79], v[124:127], v[220:223]
v_accvgpr_write_b32 a118, 0
v_accvgpr_write_b32 a119, 0
v_mfma_f32_16x16x32_bf16 v[216:219], v[76:79], v[116:119], v[216:219]
s_waitcnt vmcnt(16) lgkmcnt(2)
ds_read_b128 v[52:55], v17 offset:4096
v_accvgpr_write_b32 a120, 0
v_mfma_f32_16x16x32_bf16 v[216:219], v[72:75], v[112:115], v[216:219]
s_barrier
ds_read_b128 v[56:59], v16 offset:6144
v_accvgpr_write_b32 a121, 0
v_mfma_f32_16x16x32_bf16 v[212:215], v[72:75], v[104:107], v[212:215]
s_waitcnt vmcnt(24)
v_cmp_gt_u32 vcc, 8, v3
s_cbranch_vccnz Lspin1
Lback2:
v_mfma_f32_16x16x32_bf16 v[212:215], v[76:79], v[108:111], v[212:215]
ds_read_b64_tr_b16 v[64:65], v8 offset:0
ds_read_b64_tr_b16 v[66:67], v8 offset:1024
v_mfma_f32_16x16x32_bf16 v[208:211], v[76:79], v[100:103], v[208:211]
s_add_u32 s72, s69, 144384
buffer_load_dwordx4 v5, s[4:7], s72 offen offset:3072 lds
v_mfma_f32_16x16x32_bf16 v[208:211], v[72:75], v[96:99], v[208:211]
ds_read_b64_tr_b16 v[68:69], v8 offset:8192
ds_read_b64_tr_b16 v[70:71], v8 offset:9216
v_mfma_f32_16x16x32_bf16 v[224:227], v[80:83], v[96:99], v[224:227]
ds_read_b64_tr_b16 v[72:73], v9 offset:0
v_accvgpr_write_b32 a122, 0
v_mfma_f32_16x16x32_bf16 v[224:227], v[84:87], v[100:103], v[224:227]
ds_read_b64_tr_b16 v[74:75], v9 offset:1024
v_accvgpr_write_b32 a123, 0
v_mfma_f32_16x16x32_bf16 v[228:231], v[84:87], v[108:111], v[228:231]
s_add_u32 m0, s63, 102400
v_accvgpr_write_b32 a124, 0
v_accvgpr_write_b32 a125, 0
v_mfma_f32_16x16x32_bf16 v[228:231], v[80:83], v[104:107], v[228:231]
s_add_u32 s72, s70, 0
buffer_load_dwordx4 v4, s[4:7], s72 offen lds
v_mfma_f32_16x16x32_bf16 v[232:235], v[80:83], v[112:115], v[232:235]
ds_read_b64_tr_b16 v[76:77], v9 offset:8192
v_accvgpr_write_b32 a126, 0
v_mfma_f32_16x16x32_bf16 v[232:235], v[84:87], v[116:119], v[232:235]
ds_read_b128 v[60:63], v17 offset:6144
v_accvgpr_write_b32 a127, 0
v_mfma_f32_16x16x32_bf16 v[236:239], v[84:87], v[124:127], v[236:239]
ds_read_b64_tr_b16 v[78:79], v9 offset:9216
v_mfma_f32_16x16x32_bf16 v[236:239], v[80:83], v[120:123], v[236:239]
v_mfma_f32_16x16x32_bf16 v[252:255], v[88:91], v[120:123], v[252:255]
s_add_u32 s72, s70, 15360
buffer_load_dwordx4 v5, s[4:7], s72 offen offset:1024 lds
v_mfma_f32_16x16x32_bf16 v[252:255], v[92:95], v[124:127], v[252:255]
ds_read_b64_tr_b16 v[80:81], v10 offset:0
v_mfma_f32_16x16x32_bf16 v[248:251], v[92:95], v[116:119], v[248:251]
ds_read_b64_tr_b16 v[82:83], v10 offset:1024
v_mfma_f32_16x16x32_bf16 v[248:251], v[88:91], v[112:115], v[248:251]
v_mfma_f32_16x16x32_bf16 v[244:247], v[88:91], v[104:107], v[244:247]
ds_read_b64_tr_b16 v[84:85], v10 offset:8192
v_mfma_f32_16x16x32_bf16 v[244:247], v[92:95], v[108:111], v[244:247]
ds_read_b64_tr_b16 v[86:87], v10 offset:9216
v_mfma_f32_16x16x32_bf16 v[240:243], v[92:95], v[100:103], v[240:243]
s_add_u32 s72, s70, 129024
buffer_load_dwordx4 v4, s[4:7], s72 offen offset:2048 lds
v_mfma_f32_16x16x32_bf16 v[240:243], v[88:91], v[96:99], v[240:243]
s_waitcnt lgkmcnt(5)
v_mfma_f32_16x16x32_bf16 v[128:131], v[64:67], v[32:35], v[128:131]
ds_read_b64_tr_b16 v[88:89], v11 offset:0
v_mfma_f32_16x16x32_bf16 v[128:131], v[68:71], v[36:39], v[128:131]
ds_read_b64_tr_b16 v[90:91], v11 offset:1024
v_mfma_f32_16x16x32_bf16 v[132:135], v[68:71], v[44:47], v[132:135]
v_mfma_f32_16x16x32_bf16 v[132:135], v[64:67], v[40:43], v[132:135]
s_add_u32 s72, s70, 144384
buffer_load_dwordx4 v5, s[4:7], s72 offen offset:3072 lds
v_mfma_f32_16x16x32_bf16 v[136:139], v[64:67], v[48:51], v[136:139]
ds_read_b64_tr_b16 v[92:93], v11 offset:8192
v_mfma_f32_16x16x32_bf16 v[136:139], v[68:71], v[52:55], v[136:139]
s_lshl_b32 s71, s73, 12
v_mfma_f32_16x16x32_bf16 v[140:143], v[68:71], v[60:63], v[140:143]
s_add_u32 s71, s71, s66
ds_read_b64_tr_b16 v[94:95], v11 offset:9216
v_mfma_f32_16x16x32_bf16 v[140:143], v[64:67], v[56:59], v[140:143]
s_waitcnt lgkmcnt(8)
v_mfma_f32_16x16x32_bf16 v[156:159], v[72:75], v[56:59], v[156:159]
s_add_u32 m0, s64, 32768
ds_read_b64_tr_b16 v[64:65], v12 offset:0
v_mfma_f32_16x16x32_bf16 v[156:159], v[76:79], v[60:63], v[156:159]
s_add_u32 s72, s71, 0
buffer_load_dwordx4 v6, s[12:15], s72 offen lds
v_mfma_f32_16x16x32_bf16 v[152:155], v[76:79], v[52:55], v[152:155]
s_add_u32 s73, s62, 15
ds_read_b64_tr_b16 v[66:67], v12 offset:1024
v_mfma_f32_16x16x32_bf16 v[152:155], v[72:75], v[48:51], v[152:155]
s_add_u32 s70, s73, s65
v_mfma_f32_16x16x32_bf16 v[148:151], v[72:75], v[40:43], v[148:151]
s_and_b32 s70, s70, 3
ds_read_b64_tr_b16 v[68:69], v12 offset:8192
v_mfma_f32_16x16x32_bf16 v[148:151], v[76:79], v[44:47], v[148:151]
s_and_b32 s73, s73, 12
ds_read_b64_tr_b16 v[70:71], v12 offset:9216
v_mfma_f32_16x16x32_bf16 v[144:147], v[76:79], v[36:39], v[144:147]
s_add_u32 s72, s71, 31744
buffer_load_dwordx4 v6, s[12:15], s72 offen offset:1024 lds
v_mfma_f32_16x16x32_bf16 v[144:147], v[72:75], v[32:35], v[144:147]
s_waitcnt lgkmcnt(8)
v_mfma_f32_16x16x32_bf16 v[160:163], v[80:83], v[32:35], v[160:163]
s_or_b32 s73, s73, s70
ds_read_b64_tr_b16 v[72:73], v13 offset:0
v_mfma_f32_16x16x32_bf16 v[160:163], v[84:87], v[36:39], v[160:163]
s_lshl_b32 s73, s73, 7
ds_read_b64_tr_b16 v[74:75], v13 offset:1024
v_mfma_f32_16x16x32_bf16 v[164:167], v[84:87], v[44:47], v[164:167]
s_add_u32 s69, s73, s67
v_mfma_f32_16x16x32_bf16 v[164:167], v[80:83], v[40:43], v[164:167]
s_add_u32 s72, s71, 63488
buffer_load_dwordx4 v7, s[12:15], s72 offen offset:2048 lds
v_mfma_f32_16x16x32_bf16 v[168:171], v[80:83], v[48:51], v[168:171]
s_waitcnt vmcnt(15)
ds_read_b64_tr_b16 v[76:77], v13 offset:8192
v_mfma_f32_16x16x32_bf16 v[168:171], v[84:87], v[52:55], v[168:171]
s_add_u32 s70, s73, s68
ds_read_b128 v[96:99], v18 offset:0
v_mfma_f32_16x16x32_bf16 v[172:175], v[84:87], v[60:63], v[172:175]
ds_read_b64_tr_b16 v[78:79], v13 offset:9216
v_mfma_f32_16x16x32_bf16 v[172:175], v[80:83], v[56:59], v[172:175]
s_waitcnt lgkmcnt(9)
ds_read_b128 v[100:103], v19 offset:0
v_mfma_f32_16x16x32_bf16 v[188:191], v[88:91], v[56:59], v[188:191]
s_add_u32 s72, s71, 95232
buffer_load_dwordx4 v7, s[12:15], s72 offen offset:3072 lds
v_mfma_f32_16x16x32_bf16 v[188:191], v[92:95], v[60:63], v[188:191]
ds_read_b64_tr_b16 v[80:81], v14 offset:0
v_mfma_f32_16x16x32_bf16 v[184:187], v[92:95], v[52:55], v[184:187]
ds_read_b64_tr_b16 v[82:83], v14 offset:1024
v_mfma_f32_16x16x32_bf16 v[184:187], v[88:91], v[48:51], v[184:187]
v_mfma_f32_16x16x32_bf16 v[180:183], v[88:91], v[40:43], v[180:183]
ds_read_b64_tr_b16 v[84:85], v14 offset:8192
v_mfma_f32_16x16x32_bf16 v[180:183], v[92:95], v[44:47], v[180:183]
s_add_u32 m0, s63, 131072
ds_read_b64_tr_b16 v[86:87], v14 offset:9216
v_mfma_f32_16x16x32_bf16 v[176:179], v[92:95], v[36:39], v[176:179]
s_add_u32 s72, s69, 0
buffer_load_dwordx4 v4, s[4:7], s72 offen lds
v_mfma_f32_16x16x32_bf16 v[176:179], v[88:91], v[32:35], v[176:179]
s_waitcnt lgkmcnt(10)
ds_read_b128 v[104:107], v18 offset:2048
v_mfma_f32_16x16x32_bf16 v[192:195], v[64:67], v[32:35], v[192:195]
ds_read_b64_tr_b16 v[88:89], v15 offset:0
ds_read_b64_tr_b16 v[90:91], v15 offset:1024
v_mfma_f32_16x16x32_bf16 v[192:195], v[68:71], v[36:39], v[192:195]
ds_read_b64_tr_b16 v[92:93], v15 offset:8192
v_mfma_f32_16x16x32_bf16 v[196:199], v[68:71], v[44:47], v[196:199]
s_and_b32 s75, s91, 0xfffffc7f
v_lshrrev_b32 v2, 3, v0
v_lshlrev_b32 v2, 7, v2
v_mfma_f32_16x16x32_bf16 v[196:199], v[64:67], v[40:43], v[196:199]
s_add_u32 s72, s69, 15360
buffer_load_dwordx4 v5, s[4:7], s72 offen offset:1024 lds
v_mfma_f32_16x16x32_bf16 v[200:203], v[64:67], v[48:51], v[200:203]
buffer_load_dword v3, v2, s[44:47], s75 offen sc1
v_mfma_f32_16x16x32_bf16 v[200:203], v[68:71], v[52:55], v[200:203]
ds_read_b64_tr_b16 v[94:95], v15 offset:9216
v_mfma_f32_16x16x32_bf16 v[204:207], v[68:71], v[60:63], v[204:207]
ds_read_b128 v[108:111], v19 offset:2048
v_mfma_f32_16x16x32_bf16 v[204:207], v[64:67], v[56:59], v[204:207]
s_waitcnt lgkmcnt(11)
v_mfma_f32_16x16x32_bf16 v[220:223], v[72:75], v[56:59], v[220:223]
s_add_u32 s72, s69, 129024
buffer_load_dwordx4 v4, s[4:7], s72 offen offset:2048 lds
v_mfma_f32_16x16x32_bf16 v[220:223], v[76:79], v[60:63], v[220:223]
ds_read_b128 v[112:115], v18 offset:4096
v_mfma_f32_16x16x32_bf16 v[216:219], v[76:79], v[52:55], v[216:219]
s_waitcnt vmcnt(16) lgkmcnt(2)
ds_read_b128 v[116:119], v19 offset:4096
v_mfma_f32_16x16x32_bf16 v[216:219], v[72:75], v[48:51], v[216:219]
s_barrier
v_mfma_f32_16x16x32_bf16 v[212:215], v[72:75], v[40:43], v[212:215]
ds_read_b64_tr_b16 v[64:65], v8 offset:16384
ds_read_b64_tr_b16 v[66:67], v8 offset:17408
v_mfma_f32_16x16x32_bf16 v[212:215], v[76:79], v[44:47], v[212:215]
ds_read_b64_tr_b16 v[68:69], v8 offset:24576
v_mfma_f32_16x16x32_bf16 v[208:211], v[76:79], v[36:39], v[208:211]
s_add_u32 s72, s69, 144384
buffer_load_dwordx4 v5, s[4:7], s72 offen offset:3072 lds
v_mfma_f32_16x16x32_bf16 v[208:211], v[72:75], v[32:35], v[208:211]
ds_read_b64_tr_b16 v[70:71], v8 offset:25600
v_mfma_f32_16x16x32_bf16 v[224:227], v[80:83], v[32:35], v[224:227]
ds_read_b64_tr_b16 v[72:73], v9 offset:16384
v_mfma_f32_16x16x32_bf16 v[224:227], v[84:87], v[36:39], v[224:227]
ds_read_b64_tr_b16 v[74:75], v9 offset:17408
v_mfma_f32_16x16x32_bf16 v[228:231], v[84:87], v[44:47], v[228:231]
s_add_u32 m0, s63, 135168
ds_read_b128 v[120:123], v18 offset:6144
v_mfma_f32_16x16x32_bf16 v[228:231], v[80:83], v[40:43], v[228:231]
s_add_u32 s72, s70, 0
buffer_load_dwordx4 v4, s[4:7], s72 offen lds
v_mfma_f32_16x16x32_bf16 v[232:235], v[80:83], v[48:51], v[232:235]
ds_read_b64_tr_b16 v[76:77], v9 offset:24576
v_mfma_f32_16x16x32_bf16 v[232:235], v[84:87], v[52:55], v[232:235]
ds_read_b128 v[124:127], v19 offset:6144
v_mfma_f32_16x16x32_bf16 v[236:239], v[84:87], v[60:63], v[236:239]
ds_read_b64_tr_b16 v[78:79], v9 offset:25600
v_mfma_f32_16x16x32_bf16 v[236:239], v[80:83], v[56:59], v[236:239]
v_mfma_f32_16x16x32_bf16 v[252:255], v[88:91], v[56:59], v[252:255]
s_add_u32 s72, s70, 15360
buffer_load_dwordx4 v5, s[4:7], s72 offen offset:1024 lds
v_mfma_f32_16x16x32_bf16 v[252:255], v[92:95], v[60:63], v[252:255]
ds_read_b64_tr_b16 v[80:81], v10 offset:16384
v_mfma_f32_16x16x32_bf16 v[248:251], v[92:95], v[52:55], v[248:251]
ds_read_b64_tr_b16 v[82:83], v10 offset:17408
v_mfma_f32_16x16x32_bf16 v[248:251], v[88:91], v[48:51], v[248:251]
v_mfma_f32_16x16x32_bf16 v[244:247], v[88:91], v[40:43], v[244:247]
ds_read_b64_tr_b16 v[84:85], v10 offset:24576
v_mfma_f32_16x16x32_bf16 v[244:247], v[92:95], v[44:47], v[244:247]
ds_read_b64_tr_b16 v[86:87], v10 offset:25600
v_mfma_f32_16x16x32_bf16 v[240:243], v[92:95], v[36:39], v[240:243]
s_add_u32 s72, s70, 129024
buffer_load_dwordx4 v4, s[4:7], s72 offen offset:2048 lds
v_mfma_f32_16x16x32_bf16 v[240:243], v[88:91], v[32:35], v[240:243]
s_waitcnt lgkmcnt(5)
v_mfma_f32_16x16x32_bf16 v[128:131], v[64:67], v[96:99], v[128:131]
ds_read_b64_tr_b16 v[88:89], v11 offset:16384
v_mfma_f32_16x16x32_bf16 v[128:131], v[68:71], v[100:103], v[128:131]
ds_read_b64_tr_b16 v[90:91], v11 offset:17408
v_mfma_f32_16x16x32_bf16 v[132:135], v[68:71], v[108:111], v[132:135]
v_mfma_f32_16x16x32_bf16 v[132:135], v[64:67], v[104:107], v[132:135]
s_add_u32 s72, s70, 144384
buffer_load_dwordx4 v5, s[4:7], s72 offen offset:3072 lds
v_mfma_f32_16x16x32_bf16 v[136:139], v[64:67], v[112:115], v[136:139]
ds_read_b64_tr_b16 v[92:93], v11 offset:24576
v_mfma_f32_16x16x32_bf16 v[136:139], v[68:71], v[116:119], v[136:139]
s_lshl_b32 s71, s73, 12
v_mfma_f32_16x16x32_bf16 v[140:143], v[68:71], v[124:127], v[140:143]
s_add_u32 s71, s71, s66
ds_read_b64_tr_b16 v[94:95], v11 offset:25600
v_mfma_f32_16x16x32_bf16 v[140:143], v[64:67], v[120:123], v[140:143]
s_waitcnt lgkmcnt(8)
v_mfma_f32_16x16x32_bf16 v[156:159], v[72:75], v[120:123], v[156:159]
s_add_u32 m0, s64, 0
ds_read_b64_tr_b16 v[64:65], v12 offset:16384
v_mfma_f32_16x16x32_bf16 v[156:159], v[76:79], v[124:127], v[156:159]
s_add_u32 s72, s71, 0
buffer_load_dwordx4 v6, s[12:15], s72 offen lds
v_mfma_f32_16x16x32_bf16 v[152:155], v[76:79], v[116:119], v[152:155]
ds_read_b64_tr_b16 v[66:67], v12 offset:17408
v_mfma_f32_16x16x32_bf16 v[152:155], v[72:75], v[112:115], v[152:155]
v_mfma_f32_16x16x32_bf16 v[148:151], v[72:75], v[104:107], v[148:151]
ds_read_b64_tr_b16 v[68:69], v12 offset:24576
v_mfma_f32_16x16x32_bf16 v[148:151], v[76:79], v[108:111], v[148:151]
ds_read_b64_tr_b16 v[70:71], v12 offset:25600
v_mfma_f32_16x16x32_bf16 v[144:147], v[76:79], v[100:103], v[144:147]
s_add_u32 s72, s71, 31744
buffer_load_dwordx4 v6, s[12:15], s72 offen offset:1024 lds
v_mfma_f32_16x16x32_bf16 v[144:147], v[72:75], v[96:99], v[144:147]
s_waitcnt lgkmcnt(8)
v_mfma_f32_16x16x32_bf16 v[160:163], v[80:83], v[96:99], v[160:163]
ds_read_b64_tr_b16 v[72:73], v13 offset:16384
v_mfma_f32_16x16x32_bf16 v[160:163], v[84:87], v[100:103], v[160:163]
ds_read_b64_tr_b16 v[74:75], v13 offset:17408
v_mfma_f32_16x16x32_bf16 v[164:167], v[84:87], v[108:111], v[164:167]
v_mfma_f32_16x16x32_bf16 v[164:167], v[80:83], v[104:107], v[164:167]
s_add_u32 s72, s71, 63488
buffer_load_dwordx4 v7, s[12:15], s72 offen offset:2048 lds
v_mfma_f32_16x16x32_bf16 v[168:171], v[80:83], v[112:115], v[168:171]
s_waitcnt vmcnt(16)
ds_read_b64_tr_b16 v[76:77], v13 offset:24576
v_mfma_f32_16x16x32_bf16 v[168:171], v[84:87], v[116:119], v[168:171]
ds_read_b128 v[32:35], v18 offset:32768
v_mfma_f32_16x16x32_bf16 v[172:175], v[84:87], v[124:127], v[172:175]
ds_read_b64_tr_b16 v[78:79], v13 offset:25600
v_mfma_f32_16x16x32_bf16 v[172:175], v[80:83], v[120:123], v[172:175]
s_waitcnt lgkmcnt(9)
ds_read_b128 v[36:39], v19 offset:32768
v_mfma_f32_16x16x32_bf16 v[188:191], v[88:91], v[120:123], v[188:191]
s_add_u32 s72, s71, 95232
buffer_load_dwordx4 v7, s[12:15], s72 offen offset:3072 lds
v_mfma_f32_16x16x32_bf16 v[188:191], v[92:95], v[124:127], v[188:191]
v_accvgpr_write_b32 a0, -1
v_accvgpr_write_b32 a1, -1
v_mfma_f32_16x16x32_bf16 v[184:187], v[92:95], v[116:119], v[184:187]
v_accvgpr_write_b32 a2, -1
v_accvgpr_write_b32 a3, -1
v_mfma_f32_16x16x32_bf16 v[184:187], v[88:91], v[112:115], v[184:187]
s_add_u32 s80, s93, 0x3a00000
ds_read_b64_tr_b16 v[80:81], v14 offset:16384
v_mfma_f32_16x16x32_bf16 v[180:183], v[88:91], v[104:107], v[180:183]
ds_read_b64_tr_b16 v[82:83], v14 offset:17408
v_mfma_f32_16x16x32_bf16 v[180:183], v[92:95], v[108:111], v[180:183]
ds_read_b64_tr_b16 v[84:85], v14 offset:24576
v_mfma_f32_16x16x32_bf16 v[176:179], v[92:95], v[100:103], v[176:179]
ds_read_b64_tr_b16 v[86:87], v14 offset:25600
v_mfma_f32_16x16x32_bf16 v[176:179], v[88:91], v[96:99], v[176:179]
s_waitcnt lgkmcnt(10)
ds_read_b128 v[40:43], v18 offset:34816
v_mfma_f32_16x16x32_bf16 v[192:195], v[64:67], v[96:99], v[192:195]
s_waitcnt vmcnt(10)
v_cmp_gt_u32 vcc, 1, v3
s_cbranch_vccnz Lspin4
Lback5:
v_mfma_f32_16x16x32_bf16 v[192:195], v[68:71], v[100:103], v[192:195]
s_add_u32 m0, s64, 49152
ds_read_b64_tr_b16 v[88:89], v15 offset:16384
ds_read_b64_tr_b16 v[90:91], v15 offset:17408
v_mfma_f32_16x16x32_bf16 v[196:199], v[68:71], v[108:111], v[196:199]
s_add_u32 s72, s81, 16384
buffer_load_dwordx4 v1, s[44:47], s72 offen sc1 lds
v_mfma_f32_16x16x32_bf16 v[196:199], v[64:67], v[104:107], v[196:199]
ds_read_b64_tr_b16 v[92:93], v15 offset:24576
v_mfma_f32_16x16x32_bf16 v[200:203], v[64:67], v[112:115], v[200:203]
ds_read_b64_tr_b16 v[94:95], v15 offset:25600
v_mfma_f32_16x16x32_bf16 v[200:203], v[68:71], v[116:119], v[200:203]
buffer_load_dwordx4 v1, s[44:47], s72 offen offset:1024 sc1 lds
v_mfma_f32_16x16x32_bf16 v[204:207], v[68:71], v[124:127], v[204:207]
ds_read_b128 v[44:47], v19 offset:34816
v_mfma_f32_16x16x32_bf16 v[204:207], v[64:67], v[120:123], v[204:207]
s_waitcnt lgkmcnt(11)
v_mfma_f32_16x16x32_bf16 v[220:223], v[72:75], v[120:123], v[220:223]
ds_read_b128 v[48:51], v18 offset:36864
v_mfma_f32_16x16x32_bf16 v[220:223], v[76:79], v[124:127], v[220:223]
ds_read_b128 v[52:55], v19 offset:36864
v_mfma_f32_16x16x32_bf16 v[216:219], v[76:79], v[116:119], v[216:219]
s_waitcnt vmcnt(15) lgkmcnt(3)
buffer_load_dwordx4 v1, s[44:47], s72 offen offset:2048 sc1 lds
v_mfma_f32_16x16x32_bf16 v[216:219], v[72:75], v[112:115], v[216:219]
s_barrier
ds_read_b128 v[56:59], v18 offset:38912
v_mfma_f32_16x16x32_bf16 v[212:215], v[72:75], v[104:107], v[212:215]
ds_read_b64_tr_b16 v[64:65], v8 offset:32768
ds_read_b64_tr_b16 v[66:67], v8 offset:33792
v_mfma_f32_16x16x32_bf16 v[212:215], v[76:79], v[108:111], v[212:215]
ds_read_b64_tr_b16 v[68:69], v8 offset:40960
v_mfma_f32_16x16x32_bf16 v[208:211], v[76:79], v[100:103], v[208:211]
ds_read_b64_tr_b16 v[70:71], v8 offset:41984
v_mfma_f32_16x16x32_bf16 v[208:211], v[72:75], v[96:99], v[208:211]
buffer_load_dwordx4 v1, s[44:47], s72 offen offset:3072 sc1 lds
v_mfma_f32_16x16x32_bf16 v[224:227], v[80:83], v[96:99], v[224:227]
s_add_u32 s81, s81, 0x8000
ds_read_b64_tr_b16 v[72:73], v9 offset:32768
v_mfma_f32_16x16x32_bf16 v[224:227], v[84:87], v[100:103], v[224:227]
s_add_u32 m0, s64, 81920
ds_read_b64_tr_b16 v[74:75], v9 offset:33792
v_mfma_f32_16x16x32_bf16 v[228:231], v[84:87], v[108:111], v[228:231]
s_add_u32 s72, s81, 16384
buffer_load_dwordx4 v1, s[44:47], s72 offen sc1 lds
v_mfma_f32_16x16x32_bf16 v[228:231], v[80:83], v[104:107], v[228:231]
ds_read_b128 v[60:63], v19 offset:38912
v_mfma_f32_16x16x32_bf16 v[232:235], v[80:83], v[112:115], v[232:235]
buffer_load_dwordx4 v1, s[44:47], s72 offen offset:1024 sc1 lds
v_mfma_f32_16x16x32_bf16 v[232:235], v[84:87], v[116:119], v[232:235]
ds_read_b64_tr_b16 v[76:77], v9 offset:40960
v_mfma_f32_16x16x32_bf16 v[236:239], v[84:87], v[124:127], v[236:239]
ds_read_b64_tr_b16 v[78:79], v9 offset:41984
v_mfma_f32_16x16x32_bf16 v[236:239], v[80:83], v[120:123], v[236:239]
v_mfma_f32_16x16x32_bf16 v[252:255], v[88:91], v[120:123], v[252:255]
ds_read_b64_tr_b16 v[80:81], v10 offset:32768
v_mfma_f32_16x16x32_bf16 v[252:255], v[92:95], v[124:127], v[252:255]
buffer_load_dwordx4 v1, s[44:47], s72 offen offset:2048 sc1 lds
v_mfma_f32_16x16x32_bf16 v[248:251], v[92:95], v[116:119], v[248:251]
ds_read_b64_tr_b16 v[82:83], v10 offset:33792
v_mfma_f32_16x16x32_bf16 v[248:251], v[88:91], v[112:115], v[248:251]
v_mfma_f32_16x16x32_bf16 v[244:247], v[88:91], v[104:107], v[244:247]
ds_read_b64_tr_b16 v[84:85], v10 offset:40960
v_mfma_f32_16x16x32_bf16 v[244:247], v[92:95], v[108:111], v[244:247]
buffer_load_dwordx4 v1, s[44:47], s72 offen offset:3072 sc1 lds
v_mfma_f32_16x16x32_bf16 v[240:243], v[92:95], v[100:103], v[240:243]
ds_read_b64_tr_b16 v[86:87], v10 offset:41984
v_mfma_f32_16x16x32_bf16 v[240:243], v[88:91], v[96:99], v[240:243]
s_waitcnt lgkmcnt(6)
v_mfma_f32_16x16x32_bf16 v[128:131], v[64:67], v[32:35], v[128:131]
ds_read_b64_tr_b16 v[88:89], v11 offset:32768
v_mfma_f32_16x16x32_bf16 v[128:131], v[68:71], v[36:39], v[128:131]
ds_read_b64_tr_b16 v[90:91], v11 offset:33792
v_mfma_f32_16x16x32_bf16 v[132:135], v[68:71], v[44:47], v[132:135]
s_add_u32 m0, s64, 65536
v_mfma_f32_16x16x32_bf16 v[132:135], v[64:67], v[40:43], v[132:135]
s_add_u32 s72, s81, 0
buffer_load_dwordx4 v1, s[44:47], s72 offen sc1 lds
v_mfma_f32_16x16x32_bf16 v[136:139], v[64:67], v[48:51], v[136:139]
ds_read_b64_tr_b16 v[92:93], v11 offset:40960
v_mfma_f32_16x16x32_bf16 v[136:139], v[68:71], v[52:55], v[136:139]
ds_read_b64_tr_b16 v[94:95], v11 offset:41984
v_mfma_f32_16x16x32_bf16 v[140:143], v[68:71], v[60:63], v[140:143]
v_mfma_f32_16x16x32_bf16 v[140:143], v[64:67], v[56:59], v[140:143]
s_waitcnt lgkmcnt(8)
buffer_load_dwordx4 v1, s[44:47], s72 offen offset:1024 sc1 lds
v_mfma_f32_16x16x32_bf16 v[156:159], v[72:75], v[56:59], v[156:159]
ds_read_b64_tr_b16 v[64:65], v12 offset:32768
v_mfma_f32_16x16x32_bf16 v[156:159], v[76:79], v[60:63], v[156:159]
ds_read_b64_tr_b16 v[66:67], v12 offset:33792
v_mfma_f32_16x16x32_bf16 v[152:155], v[76:79], v[52:55], v[152:155]
v_mfma_f32_16x16x32_bf16 v[152:155], v[72:75], v[48:51], v[152:155]
buffer_load_dwordx4 v1, s[44:47], s72 offen offset:2048 sc1 lds
v_mfma_f32_16x16x32_bf16 v[148:151], v[72:75], v[40:43], v[148:151]
ds_read_b64_tr_b16 v[68:69], v12 offset:40960
v_mfma_f32_16x16x32_bf16 v[148:151], v[76:79], v[44:47], v[148:151]
v_mfma_f32_16x16x32_bf16 v[144:147], v[76:79], v[36:39], v[144:147]
ds_read_b64_tr_b16 v[70:71], v12 offset:41984
v_mfma_f32_16x16x32_bf16 v[144:147], v[72:75], v[32:35], v[144:147]
s_waitcnt lgkmcnt(8)
v_mfma_f32_16x16x32_bf16 v[160:163], v[80:83], v[32:35], v[160:163]
buffer_load_dwordx4 v1, s[44:47], s72 offen offset:3072 sc1 lds
v_mfma_f32_16x16x32_bf16 v[160:163], v[84:87], v[36:39], v[160:163]
ds_read_b64_tr_b16 v[72:73], v13 offset:32768
v_mfma_f32_16x16x32_bf16 v[164:167], v[84:87], v[44:47], v[164:167]
ds_read_b64_tr_b16 v[74:75], v13 offset:33792
v_mfma_f32_16x16x32_bf16 v[164:167], v[80:83], v[40:43], v[164:167]
v_mfma_f32_16x16x32_bf16 v[168:171], v[80:83], v[48:51], v[168:171]
s_waitcnt vmcnt(16)
ds_read_b64_tr_b16 v[76:77], v13 offset:40960
v_mfma_f32_16x16x32_bf16 v[168:171], v[84:87], v[52:55], v[168:171]
ds_read_b128 v[96:99], v16 offset:0
v_mfma_f32_16x16x32_bf16 v[172:175], v[84:87], v[60:63], v[172:175]
ds_read_b64_tr_b16 v[78:79], v13 offset:41984
v_mfma_f32_16x16x32_bf16 v[172:175], v[80:83], v[56:59], v[172:175]
s_waitcnt lgkmcnt(9)
v_mfma_f32_16x16x32_bf16 v[188:191], v[88:91], v[56:59], v[188:191]
ds_read_b64_tr_b16 v[80:81], v14 offset:32768
v_mfma_f32_16x16x32_bf16 v[188:191], v[92:95], v[60:63], v[188:191]
ds_read_b128 v[100:103], v17 offset:0
v_mfma_f32_16x16x32_bf16 v[184:187], v[92:95], v[52:55], v[184:187]
ds_read_b64_tr_b16 v[82:83], v14 offset:33792
v_mfma_f32_16x16x32_bf16 v[184:187], v[88:91], v[48:51], v[184:187]
v_mfma_f32_16x16x32_bf16 v[180:183], v[88:91], v[40:43], v[180:183]
ds_read_b64_tr_b16 v[84:85], v14 offset:40960
v_mfma_f32_16x16x32_bf16 v[180:183], v[92:95], v[44:47], v[180:183]
ds_read_b128 v[104:107], v16 offset:2048
v_mfma_f32_16x16x32_bf16 v[176:179], v[92:95], v[36:39], v[176:179]
ds_read_b64_tr_b16 v[86:87], v14 offset:41984
v_mfma_f32_16x16x32_bf16 v[176:179], v[88:91], v[32:35], v[176:179]
s_waitcnt lgkmcnt(11)
v_mfma_f32_16x16x32_bf16 v[192:195], v[64:67], v[32:35], v[192:195]
ds_read_b64_tr_b16 v[88:89], v15 offset:32768
v_mfma_f32_16x16x32_bf16 v[192:195], v[68:71], v[36:39], v[192:195]
ds_read_b64_tr_b16 v[90:91], v15 offset:33792
v_mfma_f32_16x16x32_bf16 v[196:199], v[68:71], v[44:47], v[196:199]
ds_read_b128 v[108:111], v17 offset:2048
v_mfma_f32_16x16x32_bf16 v[196:199], v[64:67], v[40:43], v[196:199]
ds_read_b64_tr_b16 v[92:93], v15 offset:40960
v_mfma_f32_16x16x32_bf16 v[200:203], v[64:67], v[48:51], v[200:203]
ds_read_b64_tr_b16 v[94:95], v15 offset:41984
v_mfma_f32_16x16x32_bf16 v[200:203], v[68:71], v[52:55], v[200:203]
v_mfma_f32_16x16x32_bf16 v[204:207], v[68:71], v[60:63], v[204:207]
ds_read_b128 v[112:115], v16 offset:4096
v_mfma_f32_16x16x32_bf16 v[204:207], v[64:67], v[56:59], v[204:207]
s_waitcnt lgkmcnt(12)
v_mfma_f32_16x16x32_bf16 v[220:223], v[72:75], v[56:59], v[220:223]
ds_read_b128 v[116:119], v17 offset:4096
v_mfma_f32_16x16x32_bf16 v[220:223], v[76:79], v[60:63], v[220:223]
v_mfma_f32_16x16x32_bf16 v[216:219], v[76:79], v[52:55], v[216:219]
s_waitcnt vmcnt(12) lgkmcnt(2)
ds_read_b128 v[120:123], v16 offset:6144
v_mfma_f32_16x16x32_bf16 v[216:219], v[72:75], v[48:51], v[216:219]
s_barrier
v_mfma_f32_16x16x32_bf16 v[212:215], v[72:75], v[40:43], v[212:215]
s_add_u32 s81, s81, 0x8000
ds_read_b64_tr_b16 v[64:65], v8 offset:0
ds_read_b64_tr_b16 v[66:67], v8 offset:1024
v_mfma_f32_16x16x32_bf16 v[212:215], v[76:79], v[44:47], v[212:215]
s_add_u32 m0, s64, 114688
ds_read_b64_tr_b16 v[68:69], v8 offset:8192
v_mfma_f32_16x16x32_bf16 v[208:211], v[76:79], v[36:39], v[208:211]
s_add_u32 s72, s81, 16384
buffer_load_dwordx4 v1, s[44:47], s72 offen sc1 lds
v_mfma_f32_16x16x32_bf16 v[208:211], v[72:75], v[32:35], v[208:211]
ds_read_b64_tr_b16 v[70:71], v8 offset:9216
v_mfma_f32_16x16x32_bf16 v[224:227], v[80:83], v[32:35], v[224:227]
buffer_load_dwordx4 v1, s[44:47], s72 offen offset:1024 sc1 lds
v_mfma_f32_16x16x32_bf16 v[224:227], v[84:87], v[36:39], v[224:227]
ds_read_b64_tr_b16 v[72:73], v9 offset:0
v_mfma_f32_16x16x32_bf16 v[228:231], v[84:87], v[44:47], v[228:231]
ds_read_b64_tr_b16 v[74:75], v9 offset:1024
v_mfma_f32_16x16x32_bf16 v[228:231], v[80:83], v[40:43], v[228:231]
ds_read_b128 v[124:127], v17 offset:6144
v_mfma_f32_16x16x32_bf16 v[232:235], v[80:83], v[48:51], v[232:235]
ds_read_b64_tr_b16 v[76:77], v9 offset:8192
v_mfma_f32_16x16x32_bf16 v[232:235], v[84:87], v[52:55], v[232:235]
buffer_store_dwordx4 a[0:3], v1, s[44:47], s80 offen sc1
v_mfma_f32_16x16x32_bf16 v[236:239], v[84:87], v[60:63], v[236:239]
ds_read_b64_tr_b16 v[78:79], v9 offset:9216
v_mfma_f32_16x16x32_bf16 v[236:239], v[80:83], v[56:59], v[236:239]
v_mfma_f32_16x16x32_bf16 v[252:255], v[88:91], v[56:59], v[252:255]
ds_read_b64_tr_b16 v[80:81], v10 offset:0
v_mfma_f32_16x16x32_bf16 v[252:255], v[92:95], v[60:63], v[252:255]
ds_read_b64_tr_b16 v[82:83], v10 offset:1024
v_mfma_f32_16x16x32_bf16 v[248:251], v[92:95], v[52:55], v[248:251]
buffer_load_dwordx4 v1, s[44:47], s72 offen offset:2048 sc1 lds
v_mfma_f32_16x16x32_bf16 v[248:251], v[88:91], v[48:51], v[248:251]
v_mfma_f32_16x16x32_bf16 v[244:247], v[88:91], v[40:43], v[244:247]
ds_read_b64_tr_b16 v[84:85], v10 offset:8192
v_mfma_f32_16x16x32_bf16 v[244:247], v[92:95], v[44:47], v[244:247]
ds_read_b64_tr_b16 v[86:87], v10 offset:9216
v_mfma_f32_16x16x32_bf16 v[240:243], v[92:95], v[36:39], v[240:243]
buffer_load_dwordx4 v1, s[44:47], s72 offen offset:3072 sc1 lds
v_mfma_f32_16x16x32_bf16 v[240:243], v[88:91], v[32:35], v[240:243]
s_waitcnt lgkmcnt(6)
v_mfma_f32_16x16x32_bf16 v[128:131], v[64:67], v[96:99], v[128:131]
ds_read_b64_tr_b16 v[88:89], v11 offset:0
v_mfma_f32_16x16x32_bf16 v[128:131], v[68:71], v[100:103], v[128:131]
ds_read_b64_tr_b16 v[90:91], v11 offset:1024
v_mfma_f32_16x16x32_bf16 v[132:135], v[68:71], v[108:111], v[132:135]
v_mfma_f32_16x16x32_bf16 v[132:135], v[64:67], v[104:107], v[132:135]
buffer_store_dwordx4 a[0:3], v1, s[44:47], s80 offen offset:1024 sc1
v_mfma_f32_16x16x32_bf16 v[136:139], v[64:67], v[112:115], v[136:139]
ds_read_b64_tr_b16 v[92:93], v11 offset:8192
v_mfma_f32_16x16x32_bf16 v[136:139], v[68:71], v[116:119], v[136:139]
v_mfma_f32_16x16x32_bf16 v[140:143], v[68:71], v[124:127], v[140:143]
ds_read_b64_tr_b16 v[94:95], v11 offset:9216
v_mfma_f32_16x16x32_bf16 v[140:143], v[64:67], v[120:123], v[140:143]
s_waitcnt lgkmcnt(8)
v_mfma_f32_16x16x32_bf16 v[156:159], v[72:75], v[120:123], v[156:159]
s_add_u32 m0, s64, 98304
ds_read_b64_tr_b16 v[64:65], v12 offset:0
v_mfma_f32_16x16x32_bf16 v[156:159], v[76:79], v[124:127], v[156:159]
s_add_u32 s72, s81, 0
buffer_load_dwordx4 v1, s[44:47], s72 offen sc1 lds
v_mfma_f32_16x16x32_bf16 v[152:155], v[76:79], v[116:119], v[152:155]
ds_read_b64_tr_b16 v[66:67], v12 offset:1024
v_mfma_f32_16x16x32_bf16 v[152:155], v[72:75], v[112:115], v[152:155]
v_mfma_f32_16x16x32_bf16 v[148:151], v[72:75], v[104:107], v[148:151]
buffer_load_dwordx4 v1, s[44:47], s72 offen offset:1024 sc1 lds
v_mfma_f32_16x16x32_bf16 v[148:151], v[76:79], v[108:111], v[148:151]
ds_read_b64_tr_b16 v[68:69], v12 offset:8192
v_mfma_f32_16x16x32_bf16 v[144:147], v[76:79], v[100:103], v[144:147]
ds_read_b64_tr_b16 v[70:71], v12 offset:9216
v_mfma_f32_16x16x32_bf16 v[144:147], v[72:75], v[96:99], v[144:147]
s_waitcnt lgkmcnt(8)
v_mfma_f32_16x16x32_bf16 v[160:163], v[80:83], v[96:99], v[160:163]
ds_read_b64_tr_b16 v[72:73], v13 offset:0
v_mfma_f32_16x16x32_bf16 v[160:163], v[84:87], v[100:103], v[160:163]
buffer_store_dwordx4 a[0:3], v1, s[44:47], s80 offen offset:2048 sc1
v_mfma_f32_16x16x32_bf16 v[164:167], v[84:87], v[108:111], v[164:167]
ds_read_b64_tr_b16 v[74:75], v13 offset:1024
v_mfma_f32_16x16x32_bf16 v[164:167], v[80:83], v[104:107], v[164:167]
v_mfma_f32_16x16x32_bf16 v[168:171], v[80:83], v[112:115], v[168:171]
ds_read_b64_tr_b16 v[76:77], v13 offset:8192
v_cvt_pk_bf16_f32 v48, v136, v137
v_mfma_f32_16x16x32_bf16 v[168:171], v[84:87], v[116:119], v[168:171]
ds_read_b64_tr_b16 v[78:79], v13 offset:9216
v_cvt_pk_bf16_f32 v49, v138, v139
v_mfma_f32_16x16x32_bf16 v[172:175], v[84:87], v[124:127], v[172:175]
buffer_load_dwordx4 v1, s[44:47], s72 offen offset:2048 sc1 lds
v_mfma_f32_16x16x32_bf16 v[172:175], v[80:83], v[120:123], v[172:175]
s_waitcnt lgkmcnt(8)
v_cvt_pk_bf16_f32 v50, v152, v153
v_cvt_pk_bf16_f32 v51, v154, v155
v_mfma_f32_16x16x32_bf16 v[188:191], v[88:91], v[120:123], v[188:191]
v_add_u32 v2, 0x8000, v1
v_cvt_pk_bf16_f32 v32, v132, v133
v_mfma_f32_16x16x32_bf16 v[188:191], v[92:95], v[124:127], v[188:191]
ds_read_b64_tr_b16 v[80:81], v14 offset:0
v_cvt_pk_bf16_f32 v33, v134, v135
v_mfma_f32_16x16x32_bf16 v[184:187], v[92:95], v[116:119], v[184:187]
buffer_load_dwordx4 v1, s[44:47], s72 offen offset:3072 sc1 lds
v_mfma_f32_16x16x32_bf16 v[184:187], v[88:91], v[112:115], v[184:187]
ds_read_b64_tr_b16 v[82:83], v14 offset:1024
v_cvt_pk_bf16_f32 v34, v148, v149
v_mfma_f32_16x16x32_bf16 v[180:183], v[88:91], v[104:107], v[180:183]
ds_read_b64_tr_b16 v[84:85], v14 offset:8192
v_cvt_pk_bf16_f32 v35, v150, v151
v_mfma_f32_16x16x32_bf16 v[180:183], v[92:95], v[108:111], v[180:183]
ds_read_b64_tr_b16 v[86:87], v14 offset:9216
v_cvt_pk_bf16_f32 v16, v128, v129
v_mfma_f32_16x16x32_bf16 v[176:179], v[92:95], v[100:103], v[176:179]
v_cvt_pk_bf16_f32 v17, v130, v131
v_cvt_pk_bf16_f32 v18, v144, v145
v_mfma_f32_16x16x32_bf16 v[176:179], v[88:91], v[96:99], v[176:179]
s_waitcnt lgkmcnt(8)
buffer_store_dwordx4 a[0:3], v1, s[44:47], s80 offen offset:3072 sc1
v_mfma_f32_16x16x32_bf16 v[192:195], v[64:67], v[96:99], v[192:195]
ds_read_b64_tr_b16 v[88:89], v15 offset:0
v_cvt_pk_bf16_f32 v19, v146, v147
v_mfma_f32_16x16x32_bf16 v[192:195], v[68:71], v[100:103], v[192:195]
ds_read_b64_tr_b16 v[90:91], v15 offset:1024
v_mfma_f32_16x16x32_bf16 v[196:199], v[68:71], v[108:111], v[196:199]
ds_read_b64_tr_b16 v[92:93], v15 offset:8192
v_mfma_f32_16x16x32_bf16 v[196:199], v[64:67], v[104:107], v[196:199]
ds_read_b64_tr_b16 v[94:95], v15 offset:9216
v_mfma_f32_16x16x32_bf16 v[200:203], v[64:67], v[112:115], v[200:203]
v_lshrrev_b32 v3, 1, v0
v_lshlrev_b32 v3, 7, v3
v_mfma_f32_16x16x32_bf16 v[200:203], v[68:71], v[116:119], v[200:203]
buffer_load_dword v4, v3, s[36:39], s93 offen
v_mfma_f32_16x16x32_bf16 v[204:207], v[68:71], v[124:127], v[204:207]
v_cvt_pk_bf16_f32 v52, v168, v169
v_cvt_pk_bf16_f32 v53, v170, v171
v_mfma_f32_16x16x32_bf16 v[204:207], v[64:67], v[120:123], v[204:207]
s_waitcnt lgkmcnt(8)
v_cvt_pk_bf16_f32 v54, v184, v185
v_cvt_pk_bf16_f32 v55, v186, v187
v_mfma_f32_16x16x32_bf16 v[220:223], v[72:75], v[120:123], v[220:223]
v_cvt_pk_bf16_f32 v36, v164, v165
v_cvt_pk_bf16_f32 v37, v166, v167
v_mfma_f32_16x16x32_bf16 v[220:223], v[76:79], v[124:127], v[220:223]
v_cvt_pk_bf16_f32 v38, v180, v181
v_cvt_pk_bf16_f32 v39, v182, v183
v_mfma_f32_16x16x32_bf16 v[216:219], v[76:79], v[116:119], v[216:219]
s_waitcnt vmcnt(21) lgkmcnt(0)
v_cvt_pk_bf16_f32 v20, v160, v161
v_cvt_pk_bf16_f32 v21, v162, v163
v_mfma_f32_16x16x32_bf16 v[216:219], v[72:75], v[112:115], v[216:219]
s_barrier
v_cvt_pk_bf16_f32 v22, v176, v177
v_cvt_pk_bf16_f32 v23, v178, v179
v_mfma_f32_16x16x32_bf16 v[212:215], v[72:75], v[104:107], v[212:215]
ds_read_b128 a[128:131], v2 offset:16384
v_cvt_pk_bf16_f32 v64, v140, v141
v_mfma_f32_16x16x32_bf16 v[212:215], v[76:79], v[108:111], v[212:215]
v_cvt_pk_bf16_f32 v65, v142, v143
v_cvt_pk_bf16_f32 v66, v156, v157
v_mfma_f32_16x16x32_bf16 v[208:211], v[76:79], v[100:103], v[208:211]
ds_read_b128 a[132:135], v2 offset:17408
v_cvt_pk_bf16_f32 v67, v158, v159
v_mfma_f32_16x16x32_bf16 v[208:211], v[72:75], v[96:99], v[208:211]
v_cvt_pk_bf16_f32 v68, v172, v173
v_cvt_pk_bf16_f32 v69, v174, v175
v_mfma_f32_16x16x32_bf16 v[224:227], v[80:83], v[96:99], v[224:227]
ds_read_b128 a[136:139], v2 offset:18432
v_cvt_pk_bf16_f32 v70, v188, v189
v_mfma_f32_16x16x32_bf16 v[224:227], v[84:87], v[100:103], v[224:227]
v_cvt_pk_bf16_f32 v71, v190, v191
v_mfma_f32_16x16x32_bf16 v[228:231], v[84:87], v[108:111], v[228:231]
ds_read_b128 a[140:143], v2 offset:19456
v_mfma_f32_16x16x32_bf16 v[228:231], v[80:83], v[104:107], v[228:231]
v_mfma_f32_16x16x32_bf16 v[232:235], v[80:83], v[112:115], v[232:235]
ds_read_b128 a[144:147], v2 offset:20480
v_cvt_pk_bf16_f32 v72, v204, v205
v_mfma_f32_16x16x32_bf16 v[232:235], v[84:87], v[116:119], v[232:235]
v_cvt_pk_bf16_f32 v73, v206, v207
v_cvt_pk_bf16_f32 v74, v220, v221
v_mfma_f32_16x16x32_bf16 v[236:239], v[84:87], v[124:127], v[236:239]
ds_read_b128 a[148:151], v2 offset:21504
v_cvt_pk_bf16_f32 v75, v222, v223
v_mfma_f32_16x16x32_bf16 v[236:239], v[80:83], v[120:123], v[236:239]
v_cvt_pk_bf16_f32 v56, v200, v201
v_cvt_pk_bf16_f32 v57, v202, v203
v_mfma_f32_16x16x32_bf16 v[252:255], v[88:91], v[120:123], v[252:255]
ds_read_b128 a[152:155], v2 offset:22528
v_cvt_pk_bf16_f32 v58, v216, v217
v_mfma_f32_16x16x32_bf16 v[252:255], v[92:95], v[124:127], v[252:255]
v_cvt_pk_bf16_f32 v59, v218, v219
v_cvt_pk_bf16_f32 v40, v196, v197
v_mfma_f32_16x16x32_bf16 v[248:251], v[92:95], v[116:119], v[248:251]
ds_read_b128 a[156:159], v2 offset:23552
v_cvt_pk_bf16_f32 v41, v198, v199
v_mfma_f32_16x16x32_bf16 v[248:251], v[88:91], v[112:115], v[248:251]
v_cvt_pk_bf16_f32 v42, v212, v213
v_cvt_pk_bf16_f32 v43, v214, v215
v_mfma_f32_16x16x32_bf16 v[244:247], v[88:91], v[104:107], v[244:247]
v_cvt_pk_bf16_f32 v24, v192, v193
v_cvt_pk_bf16_f32 v25, v194, v195
v_mfma_f32_16x16x32_bf16 v[244:247], v[92:95], v[108:111], v[244:247]
v_cvt_pk_bf16_f32 v26, v208, v209
v_cvt_pk_bf16_f32 v27, v210, v211
v_mfma_f32_16x16x32_bf16 v[240:243], v[92:95], v[100:103], v[240:243]
v_mfma_f32_16x16x32_bf16 v[240:243], v[88:91], v[96:99], v[240:243]
v_cvt_pk_bf16_f32 v76, v236, v237
v_cvt_pk_bf16_f32 v77, v238, v239
v_cvt_pk_bf16_f32 v78, v252, v253
v_cvt_pk_bf16_f32 v79, v254, v255
v_cvt_pk_bf16_f32 v60, v232, v233
v_cvt_pk_bf16_f32 v61, v234, v235
v_cvt_pk_bf16_f32 v62, v248, v249
v_cvt_pk_bf16_f32 v63, v250, v251
v_cvt_pk_bf16_f32 v44, v228, v229
v_cvt_pk_bf16_f32 v45, v230, v231
v_cvt_pk_bf16_f32 v46, v244, v245
v_cvt_pk_bf16_f32 v47, v246, v247
v_cvt_pk_bf16_f32 v28, v224, v225
v_cvt_pk_bf16_f32 v29, v226, v227
v_cvt_pk_bf16_f32 v30, v240, v241
v_cvt_pk_bf16_f32 v31, v242, v243
v_mov_b32 v124, 0xff800000
v_mov_b32 v125, 0xff800000
v_mov_b32 v126, 0xff800000
v_mov_b32 v127, 0xff800000
s_lshl_b32 s84, s60, 2
s_add_u32 s84, s84, s58
s_mov_b32 s86, 0
s_add_u32 s61, s65, s60
s_and_b32 s73, s60, 1
s_lshl_b32 s73, s73, 16
s_add_u32 s77, s73, s64
s_xor_b32 s73, s73, 0x10000
s_mov_b32 s92, s73
s_mul_i32 s62, s58, 4608
s_add_u32 s62, s62, 143104
s_add_u32 s73, s73, 49920
s_cmp_eq_u32 s58, 0
s_cselect_b32 s62, s73, s62
Lattn:
s_mov_b32 s82, 0x10000
s_waitcnt lgkmcnt(0)
v_mfma_f32_16x16x32_bf16 v[136:139], a[128:131], v[48:51], 0
ds_read_b128 a[160:163], v2 offset:24576
v_lshrrev_b32 v240, 4, v0
v_mfma_f32_16x16x32_bf16 v[136:139], a[132:135], v[52:55], v[136:139]
ds_read_b128 a[164:167], v2 offset:25600
v_and_b32 v241, 15, v0
v_mfma_f32_16x16x32_bf16 v[136:139], a[136:139], v[56:59], v[136:139]
ds_read_b128 a[168:171], v2 offset:26624
v_lshlrev_b32 v240, 2, v240
v_mfma_f32_16x16x32_bf16 v[136:139], a[140:143], v[60:63], v[136:139]
ds_read_b128 a[172:175], v2 offset:27648
v_sub_u32 v240, v241, v240
v_mfma_f32_16x16x32_bf16 v[140:143], a[140:143], v[76:79], 0
ds_read_b128 a[176:179], v2 offset:28672
v_mov_b32 v112, 0xff800000
v_mfma_f32_16x16x32_bf16 v[140:143], a[136:139], v[72:75], v[140:143]
ds_read_b128 a[180:183], v2 offset:29696
v_mov_b32 v113, 0xff800000
v_mfma_f32_16x16x32_bf16 v[140:143], a[132:135], v[68:71], v[140:143]
ds_read_b128 a[184:187], v2 offset:30720
v_mov_b32 v114, 0xff800000
v_mfma_f32_16x16x32_bf16 v[140:143], a[128:131], v[64:67], v[140:143]
ds_read_b128 a[188:191], v2 offset:31744
v_mov_b32 v115, 0xff800000
v_mfma_f32_16x16x32_bf16 v[156:159], a[144:147], v[64:67], 0
v_cmp_gt_i32 vcc, 0, v240
v_mov_b32 v120, 0x3f803f80
v_mfma_f32_16x16x32_bf16 v[156:159], a[148:151], v[68:71], v[156:159]
v_cndmask_b32 v116, 0, v112, vcc
v_cmp_gt_i32 vcc, 1, v240
v_mfma_f32_16x16x32_bf16 v[156:159], a[152:155], v[72:75], v[156:159]
v_mov_b32 v121, 0x3f803f80
v_cndmask_b32 v117, 0, v112, vcc
v_mfma_f32_16x16x32_bf16 v[156:159], a[156:159], v[76:79], v[156:159]
v_cmp_gt_i32 vcc, 2, v240
v_mov_b32 v122, 0x3f803f80
v_mfma_f32_16x16x32_bf16 v[152:155], a[156:159], v[60:63], 0
v_cndmask_b32 v118, 0, v112, vcc
v_cmp_gt_i32 vcc, 3, v240
v_mfma_f32_16x16x32_bf16 v[152:155], a[152:155], v[56:59], v[152:155]
v_mov_b32 v123, 0x3f803f80
v_cndmask_b32 v119, 0, v112, vcc
v_mfma_f32_16x16x32_bf16 v[152:155], a[148:151], v[52:55], v[152:155]
v_mov_b32 v228, 0
v_mov_b32 v229, 0
v_mfma_f32_16x16x32_bf16 v[152:155], a[144:147], v[48:51], v[152:155]
v_mov_b32 v230, 0
v_mov_b32 v231, 0
s_cmp_eq_u32 s84, 0
s_cbranch_scc1 Lta7
s_cmp_eq_u32 s84, 1
s_cbranch_scc1 Lnt8
v_mfma_f32_16x16x32_bf16 v[128:131], a[128:131], v[16:19], 0
v_mov_b32 v236, 0
v_mov_b32 v237, 0
v_mfma_f32_16x16x32_bf16 v[144:147], a[144:147], v[16:19], 0
v_mov_b32 v238, 0
v_mov_b32 v239, 0
s_branch Ljoin9
Lta7:
v_mfma_f32_16x16x32_bf16 v[128:131], a[128:131], v[16:19], v[116:119]
v_mov_b32 v236, 0
v_mov_b32 v237, 0
v_mfma_f32_16x16x32_bf16 v[144:147], a[144:147], v[16:19], v[112:115]
Lstub0:
s_cbranch_execz Lstub4
v_mov_b32 v238, 0
v_mov_b32 v239, 0
s_branch Ljoin9
Lnt8:
v_mfma_f32_16x16x32_bf16 v[128:131], a[128:131], v[16:19], 0
v_mov_b32 v236, 0
v_mov_b32 v237, 0
v_mfma_f32_16x16x32_bf16 v[144:147], a[144:147], v[16:19], v[116:119]
v_mov_b32 v238, 0
v_mov_b32 v239, 0
Ljoin9:
v_mfma_f32_16x16x32_bf16 v[128:131], a[132:135], v[20:23], v[128:131]
v_mfma_f32_16x16x32_bf16 v[128:131], a[136:139], v[24:27], v[128:131]
v_mfma_f32_16x16x32_bf16 v[128:131], a[140:143], v[28:31], v[128:131]
v_max3_f32 v240, v136, v137, v126
v_max3_f32 v242, v140, v141, v127
v_mfma_f32_16x16x32_bf16 v[132:135], a[140:143], v[44:47], 0
v_max3_f32 v240, v240, v138, v139
v_max3_f32 v242, v242, v142, v143
v_mfma_f32_16x16x32_bf16 v[132:135], a[136:139], v[40:43], v[132:135]
v_max3_f32 v240, v240, v152, v153
v_max3_f32 v242, v242, v156, v157
v_mfma_f32_16x16x32_bf16 v[132:135], a[132:135], v[36:39], v[132:135]
v_max3_f32 v240, v240, v154, v155
v_max3_f32 v242, v242, v158, v159
v_mfma_f32_16x16x32_bf16 v[132:135], a[128:131], v[32:35], v[132:135]
v_mov_b32 v241, v240
v_mov_b32 v243, v242
v_mfma_f32_16x16x32_bf16 v[148:151], a[144:147], v[32:35], 0
v_permlane16_swap_b32 v240, v241
v_permlane16_swap_b32 v242, v243
v_mfma_f32_16x16x32_bf16 v[148:151], a[148:151], v[36:39], v[148:151]
v_max_f32 v240, v240, v241
v_max_f32 v242, v242, v243
v_mfma_f32_16x16x32_bf16 v[148:151], a[152:155], v[40:43], v[148:151]
v_mov_b32 v241, v240
v_mov_b32 v243, v242
v_mfma_f32_16x16x32_bf16 v[148:151], a[156:159], v[44:47], v[148:151]
v_permlane32_swap_b32 v240, v241
v_permlane32_swap_b32 v242, v243
v_mfma_f32_16x16x32_bf16 v[144:147], a[156:159], v[28:31], v[144:147]
v_max_f32 v240, v240, v241
v_max_f32 v242, v242, v243
v_mfma_f32_16x16x32_bf16 v[144:147], a[152:155], v[24:27], v[144:147]
v_mfma_f32_16x16x32_bf16 v[144:147], a[148:151], v[20:23], v[144:147]
v_sub_f32 v88, 0, v240
v_sub_f32 v89, 0, v240
v_pk_add_f32 v[90:91], v[88:89], 0
v_pk_add_f32 v[104:105], v[116:117], v[88:89]
v_pk_add_f32 v[106:107], v[118:119], v[88:89]
v_pk_add_f32 v[136:137], v[136:137], v[88:89]
v_pk_add_f32 v[138:139], v[138:139], v[88:89]
v_pk_add_f32 v[152:153], v[152:153], v[88:89]
v_pk_add_f32 v[154:155], v[154:155], v[88:89]
v_sub_f32 v92, 0, v242
v_sub_f32 v93, 0, v242
v_pk_add_f32 v[94:95], v[92:93], 0
v_pk_add_f32 v[108:109], v[116:117], v[92:93]
v_pk_add_f32 v[110:111], v[118:119], v[92:93]
v_pk_add_f32 v[140:141], v[140:141], v[92:93]
v_pk_add_f32 v[142:143], v[142:143], v[92:93]
v_pk_add_f32 v[156:157], v[156:157], v[92:93]
v_pk_add_f32 v[158:159], v[158:159], v[92:93]
v_max3_f32 v240, v128, v129, v124
v_max3_f32 v242, v132, v133, v125
v_max3_f32 v240, v240, v130, v131
v_max3_f32 v242, v242, v134, v135
v_max3_f32 v240, v240, v144, v145
v_max3_f32 v242, v242, v148, v149
v_max3_f32 v240, v240, v146, v147
v_max3_f32 v242, v242, v150, v151
v_mov_b32 v241, v240
v_mov_b32 v243, v242
s_nop 0
v_permlane16_swap_b32 v240, v241
v_permlane16_swap_b32 v242, v243
v_max_f32 v240, v240, v241
v_max_f32 v242, v242, v243
v_mov_b32 v241, v240
v_mov_b32 v243, v242
s_nop 0
v_permlane32_swap_b32 v240, v241
v_permlane32_swap_b32 v242, v243
v_max_f32 v240, v240, v241
v_max_f32 v242, v242, v243
v_sub_f32 v80, 0, v240
v_sub_f32 v81, 0, v240
v_pk_add_f32 v[82:83], v[80:81], 0
v_pk_add_f32 v[96:97], v[116:117], v[80:81]
v_pk_add_f32 v[98:99], v[118:119], v[80:81]
v_pk_add_f32 v[128:129], v[128:129], v[80:81]
v_pk_add_f32 v[130:131], v[130:131], v[80:81]
v_pk_add_f32 v[144:145], v[144:145], v[80:81]
v_pk_add_f32 v[146:147], v[146:147], v[80:81]
v_sub_f32 v84, 0, v242
v_sub_f32 v85, 0, v242
v_pk_add_f32 v[86:87], v[84:85], 0
v_pk_add_f32 v[100:101], v[116:117], v[84:85]
v_pk_add_f32 v[102:103], v[118:119], v[84:85]
v_pk_add_f32 v[132:133], v[132:133], v[84:85]
v_pk_add_f32 v[134:135], v[134:135], v[84:85]
v_pk_add_f32 v[148:149], v[148:149], v[84:85]
v_pk_add_f32 v[150:151], v[150:151], v[84:85]
v_add_u32 v2, s82, v1
s_waitcnt vmcnt(13) lgkmcnt(0)
s_barrier
s_cmp_eq_u32 s60, 0
s_cbranch_scc1 LP0x
v_mfma_f32_16x16x32_bf16 v[164:167], a[160:163], v[32:35], v[84:87]
s_xor_b32 s74, s82, 0x10000
v_exp_f32 v128, v128
v_mfma_f32_16x16x32_bf16 v[164:167], a[164:167], v[36:39], v[164:167]
s_add_u32 s74, s74, s64
ds_read_b128 a[128:131], v2 offset:16384
ds_read_b128 a[132:135], v2 offset:17408
v_mfma_f32_16x16x32_bf16 v[164:167], a[168:171], v[40:43], v[164:167]
s_add_u32 s81, s81, 0x8000
v_exp_f32 v129, v129
v_mfma_f32_16x16x32_bf16 v[164:167], a[172:175], v[44:47], v[164:167]
s_add_u32 m0, s74, 16384
v_exp_f32 v130, v130
v_mfma_f32_16x16x32_bf16 v[172:175], a[172:175], v[76:79], v[92:95]
s_add_u32 s72, s81, 16384
v_exp_f32 v131, v131
v_mfma_f32_16x16x32_bf16 v[172:175], a[168:171], v[72:75], v[172:175]
v_exp_f32 v144, v144
v_mfma_f32_16x16x32_bf16 v[172:175], a[164:167], v[68:71], v[172:175]
s_nop 0
ds_read_b128 a[136:139], v2 offset:18432
ds_read_b128 a[140:143], v2 offset:19456
v_mfma_f32_16x16x32_bf16 v[172:175], a[160:163], v[64:67], v[172:175]
s_nop 0
ds_read_b128 a[144:147], v2 offset:20480
ds_read_b128 a[148:151], v2 offset:21504
v_mfma_f32_16x16x32_bf16 v[188:191], a[176:179], v[64:67], v[92:95]
s_nop 0
ds_read_b128 a[152:155], v2 offset:22528
ds_read_b128 a[156:159], v2 offset:23552
v_mfma_f32_16x16x32_bf16 v[188:191], a[180:183], v[68:71], v[188:191]
s_nop 0
ds_read_b128 a[192:195], v2 offset:0
ds_read_b128 a[196:199], v2 offset:1024
v_mfma_f32_16x16x32_bf16 v[188:191], a[184:187], v[72:75], v[188:191]
s_nop 0
ds_read_b128 a[200:203], v2 offset:2048
ds_read_b128 a[204:207], v2 offset:3072
v_mfma_f32_16x16x32_bf16 v[188:191], a[188:191], v[76:79], v[188:191]
s_nop 0
ds_read_b128 a[208:211], v2 offset:4096
ds_read_b128 a[212:215], v2 offset:5120
v_mfma_f32_16x16x32_bf16 v[180:183], a[188:191], v[44:47], v[84:87]
s_nop 0
ds_read_b128 a[216:219], v2 offset:6144
ds_read_b128 a[220:223], v2 offset:7168
v_mfma_f32_16x16x32_bf16 v[180:183], a[184:187], v[40:43], v[180:183]
v_cvt_pk_bf16_f32 v192, v128, v129
v_cvt_pk_bf16_f32 v193, v130, v131
v_mfma_f32_16x16x32_bf16 v[180:183], a[180:183], v[36:39], v[180:183]
buffer_load_dwordx4 v1, s[44:47], s72 offen sc1 lds
v_mfma_f32_16x16x32_bf16 v[180:183], a[176:179], v[32:35], v[180:183]
v_exp_f32 v145, v145
v_mfma_f32_16x16x32_bf16 v[160:163], a[160:163], v[16:19], v[80:83]
v_exp_f32 v146, v146
v_mfma_f32_16x16x32_bf16 v[160:163], a[164:167], v[20:23], v[160:163]
v_exp_f32 v147, v147
v_mfma_f32_16x16x32_bf16 v[160:163], a[168:171], v[24:27], v[160:163]
v_exp_f32 v136, v136
v_mfma_f32_16x16x32_bf16 v[160:163], a[172:175], v[28:31], v[160:163]
v_cvt_pk_bf16_f32 v194, v144, v145
v_cvt_pk_bf16_f32 v195, v146, v147
v_mfma_f32_16x16x32_bf16 v[168:171], a[172:175], v[60:63], v[88:91]
v_exp_f32 v137, v137
v_mfma_f32_16x16x32_bf16 v[168:171], a[168:171], v[56:59], v[168:171]
v_exp_f32 v138, v138
v_mfma_f32_16x16x32_bf16 v[168:171], a[164:167], v[52:55], v[168:171]
v_exp_f32 v139, v139
v_mfma_f32_16x16x32_bf16 v[168:171], a[160:163], v[48:51], v[168:171]
v_exp_f32 v152, v152
v_mfma_f32_16x16x32_bf16 v[184:187], a[176:179], v[48:51], v[88:91]
v_cvt_pk_bf16_f32 v200, v136, v137
v_cvt_pk_bf16_f32 v201, v138, v139
v_mfma_f32_16x16x32_bf16 v[184:187], a[180:183], v[52:55], v[184:187]
buffer_load_dwordx4 v1, s[44:47], s72 offen offset:1024 sc1 lds
v_mfma_f32_16x16x32_bf16 v[184:187], a[184:187], v[56:59], v[184:187]
v_exp_f32 v153, v153
v_mfma_f32_16x16x32_bf16 v[184:187], a[188:191], v[60:63], v[184:187]
v_exp_f32 v154, v154
v_mfma_f32_16x16x32_bf16 v[176:179], a[188:191], v[28:31], v[80:83]
v_exp_f32 v155, v155
v_mfma_f32_16x16x32_bf16 v[176:179], a[184:187], v[24:27], v[176:179]
buffer_load_dwordx4 v1, s[44:47], s72 offen offset:2048 sc1 lds
v_mfma_f32_16x16x32_bf16 v[176:179], a[180:183], v[20:23], v[176:179]
buffer_load_dwordx4 v1, s[44:47], s72 offen offset:3072 sc1 lds
v_mfma_f32_16x16x32_bf16 v[176:179], a[176:179], v[16:19], v[176:179]
s_waitcnt lgkmcnt(4)
v_exp_f32 v132, v132
v_cvt_pk_bf16_f32 v202, v152, v153
v_cvt_pk_bf16_f32 v203, v154, v155
v_exp_f32 v133, v133
v_exp_f32 v134, v134
v_cvt_pk_bf16_f32 v196, v132, v133
v_exp_f32 v135, v135
v_exp_f32 v148, v148
v_cvt_pk_bf16_f32 v197, v134, v135
v_exp_f32 v149, v149
v_exp_f32 v150, v150
v_cvt_pk_bf16_f32 v198, v148, v149
v_exp_f32 v151, v151
v_exp_f32 v140, v140
v_cvt_pk_bf16_f32 v199, v150, v151
v_exp_f32 v141, v141
v_exp_f32 v142, v142
v_cvt_pk_bf16_f32 v204, v140, v141
v_exp_f32 v143, v143
v_exp_f32 v156, v156
v_cvt_pk_bf16_f32 v205, v142, v143
v_exp_f32 v157, v157
v_exp_f32 v158, v158
v_cvt_pk_bf16_f32 v206, v156, v157
v_exp_f32 v159, v159
s_nop 0
v_cvt_pk_bf16_f32 v207, v158, v159
v_mfma_f32_16x16x32_bf16 v[224:227], v[120:123], v[192:195], 0
s_add_u32 s82, s82, 0x8000
ds_read_b128 a[160:163], v2 offset:24576
ds_read_b128 a[164:167], v2 offset:25600
v_mfma_f32_16x16x32_bf16 v[232:235], v[120:123], v[200:203], 0
s_and_b32 s82, s82, 0x1ffff
v_exp_f32 v164, v164
v_mfma_f32_16x16x32_bf16 a[0:3], a[192:195], v[192:195], 0
s_add_u32 m0, s74, 0
v_exp_f32 v165, v165
v_mfma_f32_16x16x32_bf16 a[64:67], a[192:195], v[200:203], 0
s_add_u32 s72, s81, 0
v_exp_f32 v166, v166
v_mfma_f32_16x16x32_bf16 a[68:71], a[196:199], v[200:203], 0
buffer_load_dwordx4 v1, s[44:47], s72 offen sc1 lds
v_mfma_f32_16x16x32_bf16 a[4:7], a[196:199], v[192:195], 0
v_exp_f32 v167, v167
v_mfma_f32_16x16x32_bf16 a[8:11], a[200:203], v[192:195], 0
ds_read_b128 a[168:171], v2 offset:26624
v_cvt_pk_bf16_f32 v212, v164, v165
v_mfma_f32_16x16x32_bf16 a[72:75], a[200:203], v[200:203], 0
v_exp_f32 v180, v180
v_mfma_f32_16x16x32_bf16 a[76:79], a[204:207], v[200:203], 0
v_exp_f32 v181, v181
v_mfma_f32_16x16x32_bf16 a[12:15], a[204:207], v[192:195], 0
s_waitcnt lgkmcnt(3)
ds_read_b128 a[172:175], v2 offset:27648
v_cvt_pk_bf16_f32 v213, v166, v167
v_mfma_f32_16x16x32_bf16 a[16:19], a[208:211], v[192:195], 0
v_exp_f32 v182, v182
v_mfma_f32_16x16x32_bf16 a[80:83], a[208:211], v[200:203], 0
buffer_load_dwordx4 v1, s[44:47], s72 offen offset:1024 sc1 lds
v_mfma_f32_16x16x32_bf16 a[84:87], a[212:215], v[200:203], 0
v_exp_f32 v183, v183
v_mfma_f32_16x16x32_bf16 a[20:23], a[212:215], v[192:195], 0
s_nop 0
ds_read_b128 a[176:179], v2 offset:28672
ds_read_b128 a[180:183], v2 offset:29696
v_mfma_f32_16x16x32_bf16 a[24:27], a[216:219], v[192:195], 0
v_exp_f32 v172, v172
v_mfma_f32_16x16x32_bf16 a[88:91], a[216:219], v[200:203], 0
s_nop 0
ds_read_b128 a[184:187], v2 offset:30720
ds_read_b128 a[188:191], v2 offset:31744
v_mfma_f32_16x16x32_bf16 a[92:95], a[220:223], v[200:203], 0
s_nop 0
ds_read_b128 a[224:227], v2 offset:8192
ds_read_b128 a[228:231], v2 offset:9216
v_mfma_f32_16x16x32_bf16 a[28:31], a[220:223], v[192:195], 0
s_nop 0
ds_read_b128 a[232:235], v2 offset:10240
ds_read_b128 a[236:239], v2 offset:11264
v_mfma_f32_16x16x32_bf16 v[128:131], a[128:131], v[16:19], v[80:83]
s_nop 0
ds_read_b128 a[240:243], v2 offset:12288
ds_read_b128 a[244:247], v2 offset:13312
v_mfma_f32_16x16x32_bf16 v[128:131], a[132:135], v[20:23], v[128:131]
s_nop 0
ds_read_b128 a[248:251], v2 offset:14336
ds_read_b128 a[252:255], v2 offset:15360
v_mfma_f32_16x16x32_bf16 v[128:131], a[136:139], v[24:27], v[128:131]
v_cvt_pk_bf16_f32 v214, v180, v181
v_cvt_pk_bf16_f32 v215, v182, v183
v_mfma_f32_16x16x32_bf16 v[128:131], a[140:143], v[28:31], v[128:131]
v_exp_f32 v173, v173
v_mfma_f32_16x16x32_bf16 v[136:139], a[140:143], v[60:63], v[88:91]
v_exp_f32 v174, v174
v_mfma_f32_16x16x32_bf16 v[136:139], a[136:139], v[56:59], v[136:139]
buffer_load_dwordx4 v1, s[44:47], s72 offen offset:2048 sc1 lds
v_mfma_f32_16x16x32_bf16 v[136:139], a[132:135], v[52:55], v[136:139]
v_exp_f32 v175, v175
v_mfma_f32_16x16x32_bf16 v[136:139], a[128:131], v[48:51], v[136:139]
v_exp_f32 v188, v188
v_mfma_f32_16x16x32_bf16 v[152:155], a[144:147], v[48:51], v[88:91]
v_cvt_pk_bf16_f32 v220, v172, v173
v_cvt_pk_bf16_f32 v221, v174, v175
v_mfma_f32_16x16x32_bf16 v[152:155], a[148:151], v[52:55], v[152:155]
v_exp_f32 v189, v189
v_mfma_f32_16x16x32_bf16 v[152:155], a[152:155], v[56:59], v[152:155]
v_exp_f32 v190, v190
v_mfma_f32_16x16x32_bf16 v[152:155], a[156:159], v[60:63], v[152:155]
buffer_load_dwordx4 v1, s[44:47], s72 offen offset:3072 sc1 lds
v_mfma_f32_16x16x32_bf16 v[144:147], a[156:159], v[28:31], v[80:83]
s_add_u32 s66, s58, 1
v_exp_f32 v191, v191
v_mfma_f32_16x16x32_bf16 v[144:147], a[152:155], v[24:27], v[144:147]
s_and_b32 s66, s66, 3
v_exp_f32 v160, v160
v_mfma_f32_16x16x32_bf16 v[144:147], a[148:151], v[20:23], v[144:147]
s_mul_i32 s66, s66, 4160
v_cvt_pk_bf16_f32 v222, v188, v189
v_cvt_pk_bf16_f32 v223, v190, v191
v_mfma_f32_16x16x32_bf16 v[144:147], a[144:147], v[16:19], v[144:147]
s_add_u32 m0, s66, 131104
v_exp_f32 v161, v161
v_mfma_f32_16x16x32_bf16 v[132:135], a[128:131], v[32:35], v[84:87]
s_add_u32 s72, s93, 0x2
buffer_load_dwordx4 v1, s[36:39], s72 offen lds
v_mfma_f32_16x16x32_bf16 v[132:135], a[132:135], v[36:39], v[132:135]
v_exp_f32 v162, v162
v_mfma_f32_16x16x32_bf16 v[132:135], a[136:139], v[40:43], v[132:135]
v_exp_f32 v163, v163
v_mfma_f32_16x16x32_bf16 v[132:135], a[140:143], v[44:47], v[132:135]
v_exp_f32 v176, v176
v_mfma_f32_16x16x32_bf16 v[140:143], a[140:143], v[76:79], v[92:95]
v_cvt_pk_bf16_f32 v208, v160, v161
v_cvt_pk_bf16_f32 v209, v162, v163
v_mfma_f32_16x16x32_bf16 v[140:143], a[136:139], v[72:75], v[140:143]
v_exp_f32 v177, v177
v_mfma_f32_16x16x32_bf16 v[140:143], a[132:135], v[68:71], v[140:143]
buffer_load_dwordx4 v1, s[36:39], s72 offen offset:1024 lds
v_mfma_f32_16x16x32_bf16 v[140:143], a[128:131], v[64:67], v[140:143]
v_exp_f32 v178, v178
v_mfma_f32_16x16x32_bf16 v[156:159], a[144:147], v[64:67], v[92:95]
v_exp_f32 v179, v179
v_mfma_f32_16x16x32_bf16 v[156:159], a[148:151], v[68:71], v[156:159]
v_exp_f32 v168, v168
v_mfma_f32_16x16x32_bf16 v[156:159], a[152:155], v[72:75], v[156:159]
v_cvt_pk_bf16_f32 v210, v176, v177
v_cvt_pk_bf16_f32 v211, v178, v179
v_mfma_f32_16x16x32_bf16 v[156:159], a[156:159], v[76:79], v[156:159]
v_exp_f32 v169, v169
v_mfma_f32_16x16x32_bf16 v[148:151], a[156:159], v[44:47], v[84:87]
buffer_load_dwordx4 v1, s[36:39], s72 offen offset:2048 lds
v_mfma_f32_16x16x32_bf16 v[148:151], a[152:155], v[40:43], v[148:151]
buffer_load_dwordx4 v1, s[36:39], s72 offen offset:3072 lds
v_mfma_f32_16x16x32_bf16 v[148:151], a[148:151], v[36:39], v[148:151]
s_waitcnt vmcnt(12) lgkmcnt(4)
v_exp_f32 v170, v170
v_mfma_f32_16x16x32_bf16 v[148:151], a[144:147], v[32:35], v[148:151]
s_barrier
v_exp_f32 v171, v171
v_add_u32 v2, s82, v1
v_cvt_pk_bf16_f32 v216, v168, v169
v_exp_f32 v184, v184
v_cvt_pk_bf16_f32 v217, v170, v171
v_exp_f32 v185, v185
v_exp_f32 v186, v186
v_cvt_pk_bf16_f32 v218, v184, v185
v_exp_f32 v187, v187
s_nop 0
v_cvt_pk_bf16_f32 v219, v186, v187
s_lshl_b32 s75, s59, 4
s_and_b32 s76, s84, 15
s_add_u32 s75, s75, s76
s_lshl_b32 s75, s75, 14
s_cmp_ge_u32 s60, 4
s_cselect_b32 s75, s75, 0x40001000
s_lshl_b32 s83, s60, 1
s_sub_u32 s83, 2, s83
s_cmp_eq_u32 s83, 0
s_cbranch_scc1 LLT1
.p2align 5
s_nop 0
s_nop 0
LloopI:
v_mfma_f32_16x16x32_bf16 v[228:231], v[120:123], v[196:199], v[228:231]
s_xor_b32 s74, s82, 0x10000
v_exp_f32 v128, v128
v_mfma_f32_16x16x32_bf16 v[228:231], v[120:123], v[212:215], v[228:231]
s_add_u32 s74, s74, s64
ds_read_b128 a[128:131], v2 offset:16384
v_add_u32 v15, s75, v3
v_mfma_f32_16x16x32_bf16 v[236:239], v[120:123], v[204:207], v[236:239]
s_add_u32 s81, s81, 0x8000
v_exp_f32 v129, v129
v_mfma_f32_16x16x32_bf16 v[236:239], v[120:123], v[220:223], v[236:239]
s_add_u32 m0, s74, 16384
v_exp_f32 v130, v130
v_mfma_f32_16x16x32_bf16 a[32:35], a[192:195], v[196:199], a[32:35]
s_add_u32 s72, s81, 16384
ds_read_b128 a[132:135], v2 offset:17408
v_cvt_pk_bf16_f32 v192, v128, v129
v_mfma_f32_16x16x32_bf16 a[32:35], a[224:227], v[212:215], a[32:35]
v_exp_f32 v131, v131
v_mfma_f32_16x16x32_bf16 a[96:99], a[224:227], v[220:223], a[96:99]
v_exp_f32 v144, v144
v_mfma_f32_16x16x32_bf16 a[96:99], a[192:195], v[204:207], a[96:99]
ds_read_b128 a[136:139], v2 offset:18432
v_cvt_pk_bf16_f32 v193, v130, v131
v_mfma_f32_16x16x32_bf16 a[100:103], a[196:199], v[204:207], a[100:103]
buffer_load_dwordx4 v1, s[44:47], s72 offen sc1 lds
v_mfma_f32_16x16x32_bf16 a[100:103], a[228:231], v[220:223], a[100:103]
v_exp_f32 v145, v145
v_mfma_f32_16x16x32_bf16 a[36:39], a[228:231], v[212:215], a[36:39]
v_exp_f32 v146, v146
v_mfma_f32_16x16x32_bf16 a[36:39], a[196:199], v[196:199], a[36:39]
ds_read_b128 a[140:143], v2 offset:19456
v_cvt_pk_bf16_f32 v194, v144, v145
v_mfma_f32_16x16x32_bf16 a[40:43], a[200:203], v[196:199], a[40:43]
v_exp_f32 v147, v147
v_mfma_f32_16x16x32_bf16 a[40:43], a[232:235], v[212:215], a[40:43]
v_exp_f32 v136, v136
v_mfma_f32_16x16x32_bf16 a[104:107], a[232:235], v[220:223], a[104:107]
ds_read_b128 a[144:147], v2 offset:20480
v_cvt_pk_bf16_f32 v195, v146, v147
v_mfma_f32_16x16x32_bf16 a[104:107], a[200:203], v[204:207], a[104:107]
v_exp_f32 v137, v137
v_mfma_f32_16x16x32_bf16 a[108:111], a[204:207], v[204:207], a[108:111]
v_exp_f32 v138, v138
v_mfma_f32_16x16x32_bf16 a[108:111], a[236:239], v[220:223], a[108:111]
ds_read_b128 a[148:151], v2 offset:21504
v_cvt_pk_bf16_f32 v200, v136, v137
v_mfma_f32_16x16x32_bf16 a[44:47], a[236:239], v[212:215], a[44:47]
v_exp_f32 v139, v139
v_mfma_f32_16x16x32_bf16 a[44:47], a[204:207], v[196:199], a[44:47]
v_exp_f32 v152, v152
v_mfma_f32_16x16x32_bf16 a[48:51], a[208:211], v[196:199], a[48:51]
s_waitcnt lgkmcnt(6)
ds_read_b128 a[152:155], v2 offset:22528
v_cvt_pk_bf16_f32 v201, v138, v139
v_mfma_f32_16x16x32_bf16 a[48:51], a[240:243], v[212:215], a[48:51]
buffer_load_dwordx4 v1, s[44:47], s72 offen offset:1024 sc1 lds
v_mfma_f32_16x16x32_bf16 a[112:115], a[240:243], v[220:223], a[112:115]
v_exp_f32 v153, v153
v_mfma_f32_16x16x32_bf16 a[112:115], a[208:211], v[204:207], a[112:115]
v_exp_f32 v154, v154
v_mfma_f32_16x16x32_bf16 a[116:119], a[212:215], v[204:207], a[116:119]
ds_read_b128 a[156:159], v2 offset:23552
v_cvt_pk_bf16_f32 v202, v152, v153
v_mfma_f32_16x16x32_bf16 a[116:119], a[244:247], v[220:223], a[116:119]
v_exp_f32 v155, v155
v_mfma_f32_16x16x32_bf16 a[52:55], a[244:247], v[212:215], a[52:55]
v_exp_f32 v132, v132
v_mfma_f32_16x16x32_bf16 a[52:55], a[212:215], v[196:199], a[52:55]
ds_read_b128 a[192:195], v2 offset:0
v_cvt_pk_bf16_f32 v203, v154, v155
v_mfma_f32_16x16x32_bf16 a[56:59], a[216:219], v[196:199], a[56:59]
v_exp_f32 v133, v133
v_mfma_f32_16x16x32_bf16 a[56:59], a[248:251], v[212:215], a[56:59]
v_exp_f32 v134, v134
v_mfma_f32_16x16x32_bf16 a[120:123], a[248:251], v[220:223], a[120:123]
ds_read_b128 a[196:199], v2 offset:1024
v_mfma_f32_16x16x32_bf16 a[120:123], a[216:219], v[204:207], a[120:123]
v_exp_f32 v135, v135
v_mfma_f32_16x16x32_bf16 a[124:127], a[220:223], v[204:207], a[124:127]
v_exp_f32 v148, v148
v_mfma_f32_16x16x32_bf16 a[124:127], a[252:255], v[220:223], a[124:127]
ds_read_b128 a[200:203], v2 offset:2048
v_mfma_f32_16x16x32_bf16 a[60:63], a[252:255], v[212:215], a[60:63]
buffer_load_dwordx4 v1, s[44:47], s72 offen offset:2048 sc1 lds
v_mfma_f32_16x16x32_bf16 a[60:63], a[220:223], v[196:199], a[60:63]
ds_read_b128 a[204:207], v2 offset:3072
v_cvt_pk_bf16_f32 v196, v132, v133
v_mfma_f32_16x16x32_bf16 v[164:167], a[160:163], v[32:35], v[84:87]
v_exp_f32 v149, v149
v_mfma_f32_16x16x32_bf16 v[164:167], a[164:167], v[36:39], v[164:167]
v_exp_f32 v150, v150
v_mfma_f32_16x16x32_bf16 v[164:167], a[168:171], v[40:43], v[164:167]
ds_read_b128 a[208:211], v2 offset:4096
v_cvt_pk_bf16_f32 v197, v134, v135
v_mfma_f32_16x16x32_bf16 v[164:167], a[172:175], v[44:47], v[164:167]
v_exp_f32 v151, v151
v_mfma_f32_16x16x32_bf16 v[172:175], a[172:175], v[76:79], v[92:95]
v_exp_f32 v140, v140
v_mfma_f32_16x16x32_bf16 v[172:175], a[168:171], v[72:75], v[172:175]
ds_read_b128 a[212:215], v2 offset:5120
v_cvt_pk_bf16_f32 v198, v148, v149
v_mfma_f32_16x16x32_bf16 v[172:175], a[164:167], v[68:71], v[172:175]
v_exp_f32 v141, v141
v_mfma_f32_16x16x32_bf16 v[172:175], a[160:163], v[64:67], v[172:175]
v_exp_f32 v142, v142
v_mfma_f32_16x16x32_bf16 v[188:191], a[176:179], v[64:67], v[92:95]
ds_read_b128 a[216:219], v2 offset:6144
v_cvt_pk_bf16_f32 v199, v150, v151
v_mfma_f32_16x16x32_bf16 v[188:191], a[180:183], v[68:71], v[188:191]
v_exp_f32 v143, v143
v_mfma_f32_16x16x32_bf16 v[188:191], a[184:187], v[72:75], v[188:191]
v_exp_f32 v156, v156
v_mfma_f32_16x16x32_bf16 v[188:191], a[188:191], v[76:79], v[188:191]
ds_read_b128 a[220:223], v2 offset:7168
v_cvt_pk_bf16_f32 v204, v140, v141
v_mfma_f32_16x16x32_bf16 v[180:183], a[188:191], v[44:47], v[84:87]
buffer_load_dwordx4 v1, s[44:47], s72 offen offset:3072 sc1 lds
v_mfma_f32_16x16x32_bf16 v[180:183], a[184:187], v[40:43], v[180:183]
v_exp_f32 v157, v157
v_mfma_f32_16x16x32_bf16 v[180:183], a[180:183], v[36:39], v[180:183]
v_exp_f32 v158, v158
v_mfma_f32_16x16x32_bf16 v[180:183], a[176:179], v[32:35], v[180:183]
v_cvt_pk_bf16_f32 v205, v142, v143
v_cvt_pk_bf16_f32 v206, v156, v157
v_mfma_f32_16x16x32_bf16 v[160:163], a[160:163], v[16:19], v[80:83]
v_exp_f32 v159, v159
v_mfma_f32_16x16x32_bf16 v[160:163], a[164:167], v[20:23], v[160:163]
v_cvt_pk_bf16_f32 v207, v158, v159
v_mfma_f32_16x16x32_bf16 v[160:163], a[168:171], v[24:27], v[160:163]
v_mfma_f32_16x16x32_bf16 v[160:163], a[172:175], v[28:31], v[160:163]
v_mfma_f32_16x16x32_bf16 v[168:171], a[172:175], v[60:63], v[88:91]
v_mfma_f32_16x16x32_bf16 v[168:171], a[168:171], v[56:59], v[168:171]
v_mfma_f32_16x16x32_bf16 v[168:171], a[164:167], v[52:55], v[168:171]
v_mfma_f32_16x16x32_bf16 v[168:171], a[160:163], v[48:51], v[168:171]
v_mfma_f32_16x16x32_bf16 v[184:187], a[176:179], v[48:51], v[88:91]
v_mfma_f32_16x16x32_bf16 v[184:187], a[180:183], v[52:55], v[184:187]
v_mfma_f32_16x16x32_bf16 v[184:187], a[184:187], v[56:59], v[184:187]
v_mfma_f32_16x16x32_bf16 v[184:187], a[188:191], v[60:63], v[184:187]
v_mfma_f32_16x16x32_bf16 v[176:179], a[188:191], v[28:31], v[80:83]
v_mfma_f32_16x16x32_bf16 v[176:179], a[184:187], v[24:27], v[176:179]
v_mfma_f32_16x16x32_bf16 v[176:179], a[180:183], v[20:23], v[176:179]
v_mfma_f32_16x16x32_bf16 v[176:179], a[176:179], v[16:19], v[176:179]
s_waitcnt lgkmcnt(4)
v_mfma_f32_16x16x32_bf16 v[224:227], v[120:123], v[208:211], v[224:227]
s_add_u32 s82, s82, 0x8000
ds_read_b128 a[160:163], v2 offset:24576
v_mfma_f32_16x16x32_bf16 v[224:227], v[120:123], v[192:195], v[224:227]
s_and_b32 s82, s82, 0x1ffff
v_exp_f32 v164, v164
v_mfma_f32_16x16x32_bf16 v[232:235], v[120:123], v[216:219], v[232:235]
s_add_u32 m0, s74, 0
v_exp_f32 v165, v165
v_mfma_f32_16x16x32_bf16 v[232:235], v[120:123], v[200:203], v[232:235]
s_add_u32 s72, s81, 0
ds_read_b128 a[164:167], v2 offset:25600
v_cvt_pk_bf16_f32 v212, v164, v165
v_mfma_f32_16x16x32_bf16 a[0:3], a[224:227], v[208:211], a[0:3]
v_exp_f32 v166, v166
v_mfma_f32_16x16x32_bf16 a[0:3], a[192:195], v[192:195], a[0:3]
v_exp_f32 v167, v167
v_mfma_f32_16x16x32_bf16 a[64:67], a[192:195], v[200:203], a[64:67]
buffer_load_dwordx4 v1, s[44:47], s72 offen sc1 lds
v_mfma_f32_16x16x32_bf16 a[64:67], a[224:227], v[216:219], a[64:67]
ds_read_b128 a[168:171], v2 offset:26624
v_cvt_pk_bf16_f32 v213, v166, v167
v_mfma_f32_16x16x32_bf16 a[68:71], a[228:231], v[216:219], a[68:71]
v_exp_f32 v180, v180
v_mfma_f32_16x16x32_bf16 a[68:71], a[196:199], v[200:203], a[68:71]
v_exp_f32 v181, v181
v_mfma_f32_16x16x32_bf16 a[4:7], a[196:199], v[192:195], a[4:7]
ds_read_b128 a[172:175], v2 offset:27648
v_cvt_pk_bf16_f32 v214, v180, v181
v_mfma_f32_16x16x32_bf16 a[4:7], a[228:231], v[208:211], a[4:7]
v_exp_f32 v182, v182
v_mfma_f32_16x16x32_bf16 a[8:11], a[232:235], v[208:211], a[8:11]
v_exp_f32 v183, v183
v_mfma_f32_16x16x32_bf16 a[8:11], a[200:203], v[192:195], a[8:11]
ds_read_b128 a[176:179], v2 offset:28672
v_cvt_pk_bf16_f32 v215, v182, v183
v_mfma_f32_16x16x32_bf16 a[72:75], a[200:203], v[200:203], a[72:75]
v_exp_f32 v172, v172
v_mfma_f32_16x16x32_bf16 a[72:75], a[232:235], v[216:219], a[72:75]
v_exp_f32 v173, v173
v_mfma_f32_16x16x32_bf16 a[76:79], a[236:239], v[216:219], a[76:79]
ds_read_b128 a[180:183], v2 offset:29696
v_cvt_pk_bf16_f32 v220, v172, v173
v_mfma_f32_16x16x32_bf16 a[76:79], a[204:207], v[200:203], a[76:79]
buffer_load_dwordx4 v1, s[44:47], s72 offen offset:1024 sc1 lds
v_mfma_f32_16x16x32_bf16 a[12:15], a[204:207], v[192:195], a[12:15]
v_exp_f32 v174, v174
v_mfma_f32_16x16x32_bf16 a[12:15], a[236:239], v[208:211], a[12:15]
v_exp_f32 v175, v175
v_mfma_f32_16x16x32_bf16 a[16:19], a[240:243], v[208:211], a[16:19]
s_waitcnt lgkmcnt(6)
ds_read_b128 a[184:187], v2 offset:30720
v_cvt_pk_bf16_f32 v221, v174, v175
v_mfma_f32_16x16x32_bf16 a[16:19], a[208:211], v[192:195], a[16:19]
v_exp_f32 v188, v188
v_mfma_f32_16x16x32_bf16 a[80:83], a[208:211], v[200:203], a[80:83]
v_exp_f32 v189, v189
v_mfma_f32_16x16x32_bf16 a[80:83], a[240:243], v[216:219], a[80:83]
ds_read_b128 a[188:191], v2 offset:31744
v_cvt_pk_bf16_f32 v222, v188, v189
v_mfma_f32_16x16x32_bf16 a[84:87], a[244:247], v[216:219], a[84:87]
v_exp_f32 v190, v190
v_mfma_f32_16x16x32_bf16 a[84:87], a[212:215], v[200:203], a[84:87]
v_exp_f32 v191, v191
v_mfma_f32_16x16x32_bf16 a[20:23], a[212:215], v[192:195], a[20:23]
ds_read_b128 a[224:227], v2 offset:8192
v_cvt_pk_bf16_f32 v223, v190, v191
v_mfma_f32_16x16x32_bf16 a[20:23], a[244:247], v[208:211], a[20:23]
v_exp_f32 v160, v160
v_mfma_f32_16x16x32_bf16 a[24:27], a[248:251], v[208:211], a[24:27]
buffer_load_dwordx4 v1, s[44:47], s72 offen offset:2048 sc1 lds
v_mfma_f32_16x16x32_bf16 a[24:27], a[216:219], v[192:195], a[24:27]
v_exp_f32 v161, v161
v_mfma_f32_16x16x32_bf16 a[88:91], a[216:219], v[200:203], a[88:91]
ds_read_b128 a[228:231], v2 offset:9216
v_mfma_f32_16x16x32_bf16 a[88:91], a[248:251], v[216:219], a[88:91]
v_exp_f32 v162, v162
v_mfma_f32_16x16x32_bf16 a[92:95], a[252:255], v[216:219], a[92:95]
v_exp_f32 v163, v163
v_mfma_f32_16x16x32_bf16 a[92:95], a[220:223], v[200:203], a[92:95]
ds_read_b128 a[232:235], v2 offset:10240
v_mfma_f32_16x16x32_bf16 a[28:31], a[220:223], v[192:195], a[28:31]
v_exp_f32 v176, v176
v_mfma_f32_16x16x32_bf16 a[28:31], a[252:255], v[208:211], a[28:31]
ds_read_b128 a[236:239], v2 offset:11264
v_cvt_pk_bf16_f32 v208, v160, v161
v_mfma_f32_16x16x32_bf16 v[128:131], a[128:131], v[16:19], v[80:83]
v_exp_f32 v177, v177
v_mfma_f32_16x16x32_bf16 v[128:131], a[132:135], v[20:23], v[128:131]
v_exp_f32 v178, v178
v_mfma_f32_16x16x32_bf16 v[128:131], a[136:139], v[24:27], v[128:131]
ds_read_b128 a[240:243], v2 offset:12288
v_cvt_pk_bf16_f32 v209, v162, v163
v_mfma_f32_16x16x32_bf16 v[128:131], a[140:143], v[28:31], v[128:131]
Lstub1:
s_cbranch_execz Lstub5
buffer_load_dwordx4 v1, s[44:47], s72 offen offset:3072 sc1 lds
v_mfma_f32_16x16x32_bf16 v[136:139], a[140:143], v[60:63], v[88:91]
s_add_u32 s75, s75, 0x1000
v_exp_f32 v179, v179
v_mfma_f32_16x16x32_bf16 v[136:139], a[136:139], v[56:59], v[136:139]
s_and_b32 s76, s75, 0x3000
v_exp_f32 v168, v168
v_mfma_f32_16x16x32_bf16 v[136:139], a[132:135], v[52:55], v[136:139]
s_cselect_b32 s75, s75, 0x40001000
ds_read_b128 a[244:247], v2 offset:13312
v_cvt_pk_bf16_f32 v210, v176, v177
v_mfma_f32_16x16x32_bf16 v[136:139], a[128:131], v[48:51], v[136:139]
v_exp_f32 v169, v169
v_mfma_f32_16x16x32_bf16 v[152:155], a[144:147], v[48:51], v[88:91]
v_exp_f32 v170, v170
v_mfma_f32_16x16x32_bf16 v[152:155], a[148:151], v[52:55], v[152:155]
ds_read_b128 a[248:251], v2 offset:14336
v_cvt_pk_bf16_f32 v211, v178, v179
v_mfma_f32_16x16x32_bf16 v[152:155], a[152:155], v[56:59], v[152:155]
v_exp_f32 v171, v171
v_mfma_f32_16x16x32_bf16 v[152:155], a[156:159], v[60:63], v[152:155]
v_exp_f32 v184, v184
v_mfma_f32_16x16x32_bf16 v[144:147], a[156:159], v[28:31], v[80:83]
ds_read_b128 a[252:255], v2 offset:15360
v_cvt_pk_bf16_f32 v216, v168, v169
v_mfma_f32_16x16x32_bf16 v[144:147], a[152:155], v[24:27], v[144:147]
buffer_load_dword v4, v15, s[24:27], 0 offen
v_mfma_f32_16x16x32_bf16 v[144:147], a[148:151], v[20:23], v[144:147]
v_exp_f32 v185, v185
v_mfma_f32_16x16x32_bf16 v[144:147], a[144:147], v[16:19], v[144:147]
v_exp_f32 v186, v186
v_mfma_f32_16x16x32_bf16 v[132:135], a[128:131], v[32:35], v[84:87]
v_cvt_pk_bf16_f32 v217, v170, v171
v_cvt_pk_bf16_f32 v218, v184, v185
v_mfma_f32_16x16x32_bf16 v[132:135], a[132:135], v[36:39], v[132:135]
v_exp_f32 v187, v187
v_mfma_f32_16x16x32_bf16 v[132:135], a[136:139], v[40:43], v[132:135]
v_cvt_pk_bf16_f32 v219, v186, v187
v_add_u32 v2, s82, v1
v_mfma_f32_16x16x32_bf16 v[132:135], a[140:143], v[44:47], v[132:135]
v_mfma_f32_16x16x32_bf16 v[140:143], a[140:143], v[76:79], v[92:95]
v_mfma_f32_16x16x32_bf16 v[140:143], a[136:139], v[72:75], v[140:143]
v_mfma_f32_16x16x32_bf16 v[140:143], a[132:135], v[68:71], v[140:143]
v_mfma_f32_16x16x32_bf16 v[140:143], a[128:131], v[64:67], v[140:143]
v_mfma_f32_16x16x32_bf16 v[156:159], a[144:147], v[64:67], v[92:95]
v_mfma_f32_16x16x32_bf16 v[156:159], a[148:151], v[68:71], v[156:159]
v_mfma_f32_16x16x32_bf16 v[156:159], a[152:155], v[72:75], v[156:159]
v_mfma_f32_16x16x32_bf16 v[156:159], a[156:159], v[76:79], v[156:159]
v_mfma_f32_16x16x32_bf16 v[148:151], a[156:159], v[44:47], v[84:87]
s_waitcnt vmcnt(9) lgkmcnt(4)
v_mfma_f32_16x16x32_bf16 v[148:151], a[152:155], v[40:43], v[148:151]
s_barrier
v_mfma_f32_16x16x32_bf16 v[148:151], a[148:151], v[36:39], v[148:151]
s_add_u32 s83, s83, 1
v_mfma_f32_16x16x32_bf16 v[148:151], a[144:147], v[32:35], v[148:151]
s_cbranch_scc0 LloopI
LLT1:
Lstub2:
s_cbranch_execz Lstub6
v_mfma_f32_16x16x32_bf16 v[228:231], v[120:123], v[196:199], v[228:231]
s_xor_b32 s74, s82, 0x10000
v_exp_f32 v128, v128
v_mfma_f32_16x16x32_bf16 v[228:231], v[120:123], v[212:215], v[228:231]
s_add_u32 s74, s74, s64
ds_read_b128 a[128:131], v2 offset:16384
v_mfma_f32_16x16x32_bf16 v[236:239], v[120:123], v[204:207], v[236:239]
s_add_u32 s81, s81, 0x8000
v_exp_f32 v129, v129
v_mfma_f32_16x16x32_bf16 v[236:239], v[120:123], v[220:223], v[236:239]
s_add_u32 m0, s74, 16384
v_exp_f32 v130, v130
v_mfma_f32_16x16x32_bf16 a[32:35], a[192:195], v[196:199], a[32:35]
s_add_u32 s72, s81, 16384
ds_read_b128 a[132:135], v2 offset:17408
v_cvt_pk_bf16_f32 v192, v128, v129
v_mfma_f32_16x16x32_bf16 a[32:35], a[224:227], v[212:215], a[32:35]
v_exp_f32 v131, v131
v_mfma_f32_16x16x32_bf16 a[96:99], a[224:227], v[220:223], a[96:99]
v_exp_f32 v144, v144
v_mfma_f32_16x16x32_bf16 a[96:99], a[192:195], v[204:207], a[96:99]
ds_read_b128 a[136:139], v2 offset:18432
v_cvt_pk_bf16_f32 v193, v130, v131
v_mfma_f32_16x16x32_bf16 a[100:103], a[196:199], v[204:207], a[100:103]
buffer_load_dwordx4 v1, s[44:47], s72 offen sc1 lds
v_mfma_f32_16x16x32_bf16 a[100:103], a[228:231], v[220:223], a[100:103]
v_exp_f32 v145, v145
v_mfma_f32_16x16x32_bf16 a[36:39], a[228:231], v[212:215], a[36:39]
v_exp_f32 v146, v146
v_mfma_f32_16x16x32_bf16 a[36:39], a[196:199], v[196:199], a[36:39]
ds_read_b128 a[140:143], v2 offset:19456
v_cvt_pk_bf16_f32 v194, v144, v145
v_mfma_f32_16x16x32_bf16 a[40:43], a[200:203], v[196:199], a[40:43]
v_exp_f32 v147, v147
v_mfma_f32_16x16x32_bf16 a[40:43], a[232:235], v[212:215], a[40:43]
v_exp_f32 v136, v136
v_mfma_f32_16x16x32_bf16 a[104:107], a[232:235], v[220:223], a[104:107]
ds_read_b128 a[144:147], v2 offset:20480
v_cvt_pk_bf16_f32 v195, v146, v147
v_mfma_f32_16x16x32_bf16 a[104:107], a[200:203], v[204:207], a[104:107]
v_exp_f32 v137, v137
v_mfma_f32_16x16x32_bf16 a[108:111], a[204:207], v[204:207], a[108:111]
v_exp_f32 v138, v138
v_mfma_f32_16x16x32_bf16 a[108:111], a[236:239], v[220:223], a[108:111]
ds_read_b128 a[148:151], v2 offset:21504
v_cvt_pk_bf16_f32 v200, v136, v137
v_mfma_f32_16x16x32_bf16 a[44:47], a[236:239], v[212:215], a[44:47]
v_exp_f32 v139, v139
v_mfma_f32_16x16x32_bf16 a[44:47], a[204:207], v[196:199], a[44:47]
v_exp_f32 v152, v152
v_mfma_f32_16x16x32_bf16 a[48:51], a[208:211], v[196:199], a[48:51]
s_waitcnt lgkmcnt(6)
ds_read_b128 a[152:155], v2 offset:22528
v_cvt_pk_bf16_f32 v201, v138, v139
v_mfma_f32_16x16x32_bf16 a[48:51], a[240:243], v[212:215], a[48:51]
buffer_load_dwordx4 v1, s[44:47], s72 offen offset:1024 sc1 lds
v_mfma_f32_16x16x32_bf16 a[112:115], a[240:243], v[220:223], a[112:115]
v_exp_f32 v153, v153
v_mfma_f32_16x16x32_bf16 a[112:115], a[208:211], v[204:207], a[112:115]
v_exp_f32 v154, v154
v_mfma_f32_16x16x32_bf16 a[116:119], a[212:215], v[204:207], a[116:119]
ds_read_b128 a[156:159], v2 offset:23552
v_cvt_pk_bf16_f32 v202, v152, v153
v_mfma_f32_16x16x32_bf16 a[116:119], a[244:247], v[220:223], a[116:119]
v_exp_f32 v155, v155
v_mfma_f32_16x16x32_bf16 a[52:55], a[244:247], v[212:215], a[52:55]
v_exp_f32 v132, v132
v_mfma_f32_16x16x32_bf16 a[52:55], a[212:215], v[196:199], a[52:55]
ds_read_b128 a[192:195], v2 offset:0
v_cvt_pk_bf16_f32 v203, v154, v155
v_mfma_f32_16x16x32_bf16 a[56:59], a[216:219], v[196:199], a[56:59]
v_exp_f32 v133, v133
v_mfma_f32_16x16x32_bf16 a[56:59], a[248:251], v[212:215], a[56:59]
v_exp_f32 v134, v134
v_mfma_f32_16x16x32_bf16 a[120:123], a[248:251], v[220:223], a[120:123]
ds_read_b128 a[196:199], v2 offset:1024
v_mfma_f32_16x16x32_bf16 a[120:123], a[216:219], v[204:207], a[120:123]
v_exp_f32 v135, v135
v_mfma_f32_16x16x32_bf16 a[124:127], a[220:223], v[204:207], a[124:127]
v_exp_f32 v148, v148
v_mfma_f32_16x16x32_bf16 a[124:127], a[252:255], v[220:223], a[124:127]
ds_read_b128 a[200:203], v2 offset:2048
v_mfma_f32_16x16x32_bf16 a[60:63], a[252:255], v[212:215], a[60:63]
buffer_load_dwordx4 v1, s[44:47], s72 offen offset:2048 sc1 lds
v_mfma_f32_16x16x32_bf16 a[60:63], a[220:223], v[196:199], a[60:63]
ds_read_b128 a[204:207], v2 offset:3072
v_cvt_pk_bf16_f32 v196, v132, v133
v_mfma_f32_16x16x32_bf16 v[164:167], a[160:163], v[32:35], v[84:87]
v_exp_f32 v149, v149
v_mfma_f32_16x16x32_bf16 v[164:167], a[164:167], v[36:39], v[164:167]
v_exp_f32 v150, v150
v_mfma_f32_16x16x32_bf16 v[164:167], a[168:171], v[40:43], v[164:167]
ds_read_b128 a[208:211], v2 offset:4096
v_cvt_pk_bf16_f32 v197, v134, v135
v_mfma_f32_16x16x32_bf16 v[164:167], a[172:175], v[44:47], v[164:167]
v_exp_f32 v151, v151
v_mfma_f32_16x16x32_bf16 v[172:175], a[172:175], v[76:79], v[92:95]
v_exp_f32 v140, v140
v_mfma_f32_16x16x32_bf16 v[172:175], a[168:171], v[72:75], v[172:175]
ds_read_b128 a[212:215], v2 offset:5120
v_cvt_pk_bf16_f32 v198, v148, v149
v_mfma_f32_16x16x32_bf16 v[172:175], a[164:167], v[68:71], v[172:175]
v_exp_f32 v141, v141
v_mfma_f32_16x16x32_bf16 v[172:175], a[160:163], v[64:67], v[172:175]
v_exp_f32 v142, v142
v_mfma_f32_16x16x32_bf16 v[188:191], a[176:179], v[64:67], v[92:95]
ds_read_b128 a[216:219], v2 offset:6144
v_cvt_pk_bf16_f32 v199, v150, v151
v_mfma_f32_16x16x32_bf16 v[188:191], a[180:183], v[68:71], v[188:191]
v_exp_f32 v143, v143
v_mfma_f32_16x16x32_bf16 v[188:191], a[184:187], v[72:75], v[188:191]
v_exp_f32 v156, v156
v_mfma_f32_16x16x32_bf16 v[188:191], a[188:191], v[76:79], v[188:191]
ds_read_b128 a[220:223], v2 offset:7168
v_cvt_pk_bf16_f32 v204, v140, v141
v_mfma_f32_16x16x32_bf16 v[180:183], a[188:191], v[44:47], v[84:87]
buffer_load_dwordx4 v1, s[44:47], s72 offen offset:3072 sc1 lds
v_mfma_f32_16x16x32_bf16 v[180:183], a[184:187], v[40:43], v[180:183]
v_exp_f32 v157, v157
v_mfma_f32_16x16x32_bf16 v[180:183], a[180:183], v[36:39], v[180:183]
v_exp_f32 v158, v158
v_mfma_f32_16x16x32_bf16 v[180:183], a[176:179], v[32:35], v[180:183]
v_cvt_pk_bf16_f32 v205, v142, v143
v_cvt_pk_bf16_f32 v206, v156, v157
v_mfma_f32_16x16x32_bf16 v[160:163], a[160:163], v[16:19], v[80:83]
v_exp_f32 v159, v159
v_mfma_f32_16x16x32_bf16 v[160:163], a[164:167], v[20:23], v[160:163]
v_cvt_pk_bf16_f32 v207, v158, v159
v_mfma_f32_16x16x32_bf16 v[160:163], a[168:171], v[24:27], v[160:163]
v_mfma_f32_16x16x32_bf16 v[160:163], a[172:175], v[28:31], v[160:163]
v_mfma_f32_16x16x32_bf16 v[168:171], a[172:175], v[60:63], v[88:91]
v_mfma_f32_16x16x32_bf16 v[168:171], a[168:171], v[56:59], v[168:171]
v_mfma_f32_16x16x32_bf16 v[168:171], a[164:167], v[52:55], v[168:171]
v_mfma_f32_16x16x32_bf16 v[168:171], a[160:163], v[48:51], v[168:171]
v_mfma_f32_16x16x32_bf16 v[184:187], a[176:179], v[48:51], v[88:91]
v_mfma_f32_16x16x32_bf16 v[184:187], a[180:183], v[52:55], v[184:187]
v_mfma_f32_16x16x32_bf16 v[184:187], a[184:187], v[56:59], v[184:187]
v_mfma_f32_16x16x32_bf16 v[184:187], a[188:191], v[60:63], v[184:187]
v_mfma_f32_16x16x32_bf16 v[176:179], a[188:191], v[28:31], v[80:83]
v_mfma_f32_16x16x32_bf16 v[176:179], a[184:187], v[24:27], v[176:179]
v_mfma_f32_16x16x32_bf16 v[176:179], a[180:183], v[20:23], v[176:179]
v_mfma_f32_16x16x32_bf16 v[176:179], a[176:179], v[16:19], v[176:179]
s_waitcnt lgkmcnt(4)
v_mfma_f32_16x16x32_bf16 v[224:227], v[120:123], v[208:211], v[224:227]
s_add_u32 s82, s82, 0x8000
ds_read_b128 a[160:163], v2 offset:24576
v_mfma_f32_16x16x32_bf16 v[224:227], v[120:123], v[192:195], v[224:227]
s_and_b32 s82, s82, 0x1ffff
v_exp_f32 v164, v164
v_mfma_f32_16x16x32_bf16 v[232:235], v[120:123], v[216:219], v[232:235]
s_add_u32 m0, s74, 0
v_exp_f32 v165, v165
v_mfma_f32_16x16x32_bf16 v[232:235], v[120:123], v[200:203], v[232:235]
s_add_u32 s72, s81, 0
ds_read_b128 a[164:167], v2 offset:25600
v_cvt_pk_bf16_f32 v212, v164, v165
v_mfma_f32_16x16x32_bf16 a[0:3], a[224:227], v[208:211], a[0:3]
v_exp_f32 v166, v166
v_mfma_f32_16x16x32_bf16 a[0:3], a[192:195], v[192:195], a[0:3]
v_exp_f32 v167, v167
v_mfma_f32_16x16x32_bf16 a[64:67], a[192:195], v[200:203], a[64:67]
ds_read_b128 a[168:171], v2 offset:26624
v_cvt_pk_bf16_f32 v213, v166, v167
v_mfma_f32_16x16x32_bf16 a[64:67], a[224:227], v[216:219], a[64:67]
v_exp_f32 v180, v180
v_mfma_f32_16x16x32_bf16 a[68:71], a[228:231], v[216:219], a[68:71]
buffer_load_dwordx4 v1, s[44:47], s72 offen sc1 lds
v_mfma_f32_16x16x32_bf16 a[68:71], a[196:199], v[200:203], a[68:71]
v_exp_f32 v181, v181
v_mfma_f32_16x16x32_bf16 a[4:7], a[196:199], v[192:195], a[4:7]
ds_read_b128 a[172:175], v2 offset:27648
v_cvt_pk_bf16_f32 v214, v180, v181
v_mfma_f32_16x16x32_bf16 a[4:7], a[228:231], v[208:211], a[4:7]
v_exp_f32 v182, v182
v_mfma_f32_16x16x32_bf16 a[8:11], a[232:235], v[208:211], a[8:11]
v_exp_f32 v183, v183
v_mfma_f32_16x16x32_bf16 a[8:11], a[200:203], v[192:195], a[8:11]
ds_read_b128 a[176:179], v2 offset:28672
v_cvt_pk_bf16_f32 v215, v182, v183
v_mfma_f32_16x16x32_bf16 a[72:75], a[200:203], v[200:203], a[72:75]
v_exp_f32 v172, v172
v_mfma_f32_16x16x32_bf16 a[72:75], a[232:235], v[216:219], a[72:75]
v_exp_f32 v173, v173
v_mfma_f32_16x16x32_bf16 a[76:79], a[236:239], v[216:219], a[76:79]
ds_read_b128 a[180:183], v2 offset:29696
v_cvt_pk_bf16_f32 v220, v172, v173
v_mfma_f32_16x16x32_bf16 a[76:79], a[204:207], v[200:203], a[76:79]
v_exp_f32 v174, v174
v_mfma_f32_16x16x32_bf16 a[12:15], a[204:207], v[192:195], a[12:15]
v_exp_f32 v175, v175
v_mfma_f32_16x16x32_bf16 a[12:15], a[236:239], v[208:211], a[12:15]
ds_read_b128 a[184:187], v2 offset:30720
v_cvt_pk_bf16_f32 v221, v174, v175
v_mfma_f32_16x16x32_bf16 a[16:19], a[240:243], v[208:211], a[16:19]
s_waitcnt lgkmcnt(7)
v_exp_f32 v188, v188
v_mfma_f32_16x16x32_bf16 a[16:19], a[208:211], v[192:195], a[16:19]
buffer_load_dwordx4 v1, s[44:47], s72 offen offset:1024 sc1 lds
v_mfma_f32_16x16x32_bf16 a[80:83], a[208:211], v[200:203], a[80:83]
v_exp_f32 v189, v189
v_mfma_f32_16x16x32_bf16 a[80:83], a[240:243], v[216:219], a[80:83]
ds_read_b128 a[188:191], v2 offset:31744
v_cvt_pk_bf16_f32 v222, v188, v189
v_mfma_f32_16x16x32_bf16 a[84:87], a[244:247], v[216:219], a[84:87]
v_exp_f32 v190, v190
v_mfma_f32_16x16x32_bf16 a[84:87], a[212:215], v[200:203], a[84:87]
v_exp_f32 v191, v191
v_mfma_f32_16x16x32_bf16 a[20:23], a[212:215], v[192:195], a[20:23]
ds_read_b128 a[224:227], v2 offset:8192
v_cvt_pk_bf16_f32 v223, v190, v191
v_mfma_f32_16x16x32_bf16 a[20:23], a[244:247], v[208:211], a[20:23]
v_exp_f32 v160, v160
v_mfma_f32_16x16x32_bf16 a[24:27], a[248:251], v[208:211], a[24:27]
v_exp_f32 v161, v161
v_mfma_f32_16x16x32_bf16 a[24:27], a[216:219], v[192:195], a[24:27]
ds_read_b128 a[228:231], v2 offset:9216
v_mfma_f32_16x16x32_bf16 a[88:91], a[216:219], v[200:203], a[88:91]
v_exp_f32 v162, v162
v_mfma_f32_16x16x32_bf16 a[88:91], a[248:251], v[216:219], a[88:91]
v_exp_f32 v163, v163
v_mfma_f32_16x16x32_bf16 a[92:95], a[252:255], v[216:219], a[92:95]
ds_read_b128 a[232:235], v2 offset:10240
v_mfma_f32_16x16x32_bf16 a[92:95], a[220:223], v[200:203], a[92:95]
v_exp_f32 v176, v176
v_mfma_f32_16x16x32_bf16 a[28:31], a[220:223], v[192:195], a[28:31]
buffer_load_dwordx4 v1, s[44:47], s72 offen offset:2048 sc1 lds
v_mfma_f32_16x16x32_bf16 a[28:31], a[252:255], v[208:211], a[28:31]
ds_read_b128 a[236:239], v2 offset:11264
v_cvt_pk_bf16_f32 v208, v160, v161
s_cmp_eq_u32 s58, 0
s_cbranch_scc1 Lta16
s_cmp_eq_u32 s58, 1
s_cbranch_scc1 Lnt17
v_mfma_f32_16x16x32_bf16 v[128:131], a[128:131], v[16:19], v[80:83]
v_exp_f32 v177, v177
v_mfma_f32_16x16x32_bf16 v[144:147], a[144:147], v[16:19], v[80:83]
v_exp_f32 v178, v178
s_branch Ljoin18
Lta16:
v_mfma_f32_16x16x32_bf16 v[128:131], a[128:131], v[16:19], v[96:99]
v_exp_f32 v177, v177
v_mfma_f32_16x16x32_bf16 v[144:147], a[144:147], v[16:19], v[112:115]
v_exp_f32 v178, v178
s_branch Ljoin18
Lnt17:
v_mfma_f32_16x16x32_bf16 v[128:131], a[128:131], v[16:19], v[80:83]
v_exp_f32 v177, v177
v_mfma_f32_16x16x32_bf16 v[144:147], a[144:147], v[16:19], v[96:99]
v_exp_f32 v178, v178
Ljoin18:
v_mfma_f32_16x16x32_bf16 v[128:131], a[132:135], v[20:23], v[128:131]
ds_read_b128 a[240:243], v2 offset:12288
v_cvt_pk_bf16_f32 v209, v162, v163
v_mfma_f32_16x16x32_bf16 v[128:131], a[136:139], v[24:27], v[128:131]
v_exp_f32 v179, v179
v_mfma_f32_16x16x32_bf16 v[128:131], a[140:143], v[28:31], v[128:131]
v_exp_f32 v168, v168
v_mfma_f32_16x16x32_bf16 v[136:139], a[140:143], v[60:63], v[88:91]
ds_read_b128 a[244:247], v2 offset:13312
v_cvt_pk_bf16_f32 v210, v176, v177
v_mfma_f32_16x16x32_bf16 v[136:139], a[136:139], v[56:59], v[136:139]
v_exp_f32 v169, v169
v_mfma_f32_16x16x32_bf16 v[136:139], a[132:135], v[52:55], v[136:139]
v_exp_f32 v170, v170
v_mfma_f32_16x16x32_bf16 v[136:139], a[128:131], v[48:51], v[136:139]
ds_read_b128 a[248:251], v2 offset:14336
v_cvt_pk_bf16_f32 v211, v178, v179
v_mfma_f32_16x16x32_bf16 v[152:155], a[144:147], v[48:51], v[88:91]
v_exp_f32 v171, v171
v_mfma_f32_16x16x32_bf16 v[152:155], a[148:151], v[52:55], v[152:155]
v_exp_f32 v184, v184
v_mfma_f32_16x16x32_bf16 v[152:155], a[152:155], v[56:59], v[152:155]
ds_read_b128 a[252:255], v2 offset:15360
v_cvt_pk_bf16_f32 v216, v168, v169
v_mfma_f32_16x16x32_bf16 v[152:155], a[156:159], v[60:63], v[152:155]
buffer_load_dwordx4 v1, s[44:47], s72 offen offset:3072 sc1 lds
v_mfma_f32_16x16x32_bf16 v[144:147], a[156:159], v[28:31], v[144:147]
v_exp_f32 v185, v185
v_mfma_f32_16x16x32_bf16 v[144:147], a[152:155], v[24:27], v[144:147]
v_exp_f32 v186, v186
v_mfma_f32_16x16x32_bf16 v[144:147], a[148:151], v[20:23], v[144:147]
v_cvt_pk_bf16_f32 v217, v170, v171
v_cvt_pk_bf16_f32 v218, v184, v185
v_mfma_f32_16x16x32_bf16 v[132:135], a[128:131], v[32:35], v[84:87]
v_exp_f32 v187, v187
v_mfma_f32_16x16x32_bf16 v[132:135], a[132:135], v[36:39], v[132:135]
v_cvt_pk_bf16_f32 v219, v186, v187
v_add_u32 v2, s82, v1
v_mfma_f32_16x16x32_bf16 v[132:135], a[136:139], v[40:43], v[132:135]
v_mfma_f32_16x16x32_bf16 v[132:135], a[140:143], v[44:47], v[132:135]
v_mfma_f32_16x16x32_bf16 v[140:143], a[140:143], v[76:79], v[92:95]
v_mfma_f32_16x16x32_bf16 v[140:143], a[136:139], v[72:75], v[140:143]
v_mfma_f32_16x16x32_bf16 v[140:143], a[132:135], v[68:71], v[140:143]
v_mfma_f32_16x16x32_bf16 v[140:143], a[128:131], v[64:67], v[140:143]
v_mfma_f32_16x16x32_bf16 v[156:159], a[144:147], v[64:67], v[92:95]
v_mfma_f32_16x16x32_bf16 v[156:159], a[148:151], v[68:71], v[156:159]
v_mfma_f32_16x16x32_bf16 v[156:159], a[152:155], v[72:75], v[156:159]
v_mfma_f32_16x16x32_bf16 v[156:159], a[156:159], v[76:79], v[156:159]
v_mfma_f32_16x16x32_bf16 v[148:151], a[156:159], v[44:47], v[84:87]
v_mfma_f32_16x16x32_bf16 v[148:151], a[152:155], v[40:43], v[148:151]
v_mfma_f32_16x16x32_bf16 v[148:151], a[148:151], v[36:39], v[148:151]
s_waitcnt vmcnt(8) lgkmcnt(4)
v_mfma_f32_16x16x32_bf16 v[148:151], a[144:147], v[32:35], v[148:151]
s_barrier
v_mfma_f32_16x16x32_bf16 v[228:231], v[120:123], v[196:199], v[228:231]
s_xor_b32 s74, s82, 0x10000
v_exp_f32 v128, v128
v_mfma_f32_16x16x32_bf16 v[228:231], v[120:123], v[212:215], v[228:231]
s_add_u32 s74, s74, s64
ds_read_b128 a[128:131], v2 offset:16384
v_mfma_f32_16x16x32_bf16 v[236:239], v[120:123], v[204:207], v[236:239]
s_add_u32 s81, s81, 0x8000
v_exp_f32 v129, v129
v_mfma_f32_16x16x32_bf16 v[236:239], v[120:123], v[220:223], v[236:239]
s_add_u32 m0, s74, 16384
v_exp_f32 v130, v130
v_mfma_f32_16x16x32_bf16 a[32:35], a[192:195], v[196:199], a[32:35]
s_add_u32 s72, s81, 16384
ds_read_b128 a[132:135], v2 offset:17408
v_cvt_pk_bf16_f32 v192, v128, v129
v_mfma_f32_16x16x32_bf16 a[32:35], a[224:227], v[212:215], a[32:35]
v_exp_f32 v131, v131
v_mfma_f32_16x16x32_bf16 a[96:99], a[224:227], v[220:223], a[96:99]
v_exp_f32 v144, v144
v_mfma_f32_16x16x32_bf16 a[96:99], a[192:195], v[204:207], a[96:99]
ds_read_b128 a[136:139], v2 offset:18432
v_cvt_pk_bf16_f32 v193, v130, v131
v_mfma_f32_16x16x32_bf16 a[100:103], a[196:199], v[204:207], a[100:103]
buffer_load_dwordx4 v1, s[44:47], s72 offen sc1 lds
v_mfma_f32_16x16x32_bf16 a[100:103], a[228:231], v[220:223], a[100:103]
v_exp_f32 v145, v145
v_mfma_f32_16x16x32_bf16 a[36:39], a[228:231], v[212:215], a[36:39]
v_exp_f32 v146, v146
v_mfma_f32_16x16x32_bf16 a[36:39], a[196:199], v[196:199], a[36:39]
ds_read_b128 a[140:143], v2 offset:19456
v_cvt_pk_bf16_f32 v194, v144, v145
v_mfma_f32_16x16x32_bf16 a[40:43], a[200:203], v[196:199], a[40:43]
v_exp_f32 v147, v147
v_mfma_f32_16x16x32_bf16 a[40:43], a[232:235], v[212:215], a[40:43]
v_exp_f32 v136, v136
v_mfma_f32_16x16x32_bf16 a[104:107], a[232:235], v[220:223], a[104:107]
ds_read_b128 a[144:147], v2 offset:20480
v_cvt_pk_bf16_f32 v195, v146, v147
v_mfma_f32_16x16x32_bf16 a[104:107], a[200:203], v[204:207], a[104:107]
v_exp_f32 v137, v137
v_mfma_f32_16x16x32_bf16 a[108:111], a[204:207], v[204:207], a[108:111]
v_exp_f32 v138, v138
v_mfma_f32_16x16x32_bf16 a[108:111], a[236:239], v[220:223], a[108:111]
ds_read_b128 a[148:151], v2 offset:21504
v_cvt_pk_bf16_f32 v200, v136, v137
v_mfma_f32_16x16x32_bf16 a[44:47], a[236:239], v[212:215], a[44:47]
v_exp_f32 v139, v139
v_mfma_f32_16x16x32_bf16 a[44:47], a[204:207], v[196:199], a[44:47]
v_exp_f32 v152, v152
v_mfma_f32_16x16x32_bf16 a[48:51], a[208:211], v[196:199], a[48:51]
s_waitcnt lgkmcnt(6)
ds_read_b128 a[152:155], v2 offset:22528
v_cvt_pk_bf16_f32 v201, v138, v139
v_mfma_f32_16x16x32_bf16 a[48:51], a[240:243], v[212:215], a[48:51]
buffer_load_dwordx4 v1, s[44:47], s72 offen offset:1024 sc1 lds
v_mfma_f32_16x16x32_bf16 a[112:115], a[240:243], v[220:223], a[112:115]
v_exp_f32 v153, v153
v_mfma_f32_16x16x32_bf16 a[112:115], a[208:211], v[204:207], a[112:115]
v_exp_f32 v154, v154
v_mfma_f32_16x16x32_bf16 a[116:119], a[212:215], v[204:207], a[116:119]
ds_read_b128 a[156:159], v2 offset:23552
v_cvt_pk_bf16_f32 v202, v152, v153
v_mfma_f32_16x16x32_bf16 a[116:119], a[244:247], v[220:223], a[116:119]
v_exp_f32 v155, v155
v_mfma_f32_16x16x32_bf16 a[52:55], a[244:247], v[212:215], a[52:55]
v_exp_f32 v132, v132
v_mfma_f32_16x16x32_bf16 a[52:55], a[212:215], v[196:199], a[52:55]
ds_read_b128 a[192:195], v2 offset:0
v_cvt_pk_bf16_f32 v203, v154, v155
v_mfma_f32_16x16x32_bf16 a[56:59], a[216:219], v[196:199], a[56:59]
v_exp_f32 v133, v133
v_mfma_f32_16x16x32_bf16 a[56:59], a[248:251], v[212:215], a[56:59]
v_exp_f32 v134, v134
v_mfma_f32_16x16x32_bf16 a[120:123], a[248:251], v[220:223], a[120:123]
ds_read_b128 a[196:199], v2 offset:1024
v_mfma_f32_16x16x32_bf16 a[120:123], a[216:219], v[204:207], a[120:123]
v_exp_f32 v135, v135
v_mfma_f32_16x16x32_bf16 a[124:127], a[220:223], v[204:207], a[124:127]
v_exp_f32 v148, v148
v_mfma_f32_16x16x32_bf16 a[124:127], a[252:255], v[220:223], a[124:127]
ds_read_b128 a[200:203], v2 offset:2048
v_mfma_f32_16x16x32_bf16 a[60:63], a[252:255], v[212:215], a[60:63]
buffer_load_dwordx4 v1, s[44:47], s72 offen offset:2048 sc1 lds
v_mfma_f32_16x16x32_bf16 a[60:63], a[220:223], v[196:199], a[60:63]
ds_read_b128 a[204:207], v2 offset:3072
v_cvt_pk_bf16_f32 v196, v132, v133
s_cmp_eq_u32 s58, 2
s_cbranch_scc1 Lta19
s_cmp_eq_u32 s58, 3
s_cbranch_scc1 Lnt20
v_mfma_f32_16x16x32_bf16 v[160:163], a[160:163], v[16:19], v[112:115]
v_exp_f32 v149, v149
v_mfma_f32_16x16x32_bf16 v[176:179], a[176:179], v[16:19], v[112:115]
v_exp_f32 v150, v150
s_branch Ljoin21
Lta19:
v_mfma_f32_16x16x32_bf16 v[160:163], a[160:163], v[16:19], v[96:99]
v_exp_f32 v149, v149
v_mfma_f32_16x16x32_bf16 v[176:179], a[176:179], v[16:19], v[112:115]
v_exp_f32 v150, v150
s_branch Ljoin21
Lnt20:
v_mfma_f32_16x16x32_bf16 v[160:163], a[160:163], v[16:19], v[80:83]
v_exp_f32 v149, v149
v_mfma_f32_16x16x32_bf16 v[176:179], a[176:179], v[16:19], v[96:99]
v_exp_f32 v150, v150
Ljoin21:
v_mfma_f32_16x16x32_bf16 v[164:167], a[160:163], v[32:35], v[84:87]
ds_read_b128 a[208:211], v2 offset:4096
v_cvt_pk_bf16_f32 v197, v134, v135
v_mfma_f32_16x16x32_bf16 v[164:167], a[164:167], v[36:39], v[164:167]
v_exp_f32 v151, v151
v_mfma_f32_16x16x32_bf16 v[164:167], a[168:171], v[40:43], v[164:167]
v_exp_f32 v140, v140
v_mfma_f32_16x16x32_bf16 v[164:167], a[172:175], v[44:47], v[164:167]
ds_read_b128 a[212:215], v2 offset:5120
v_cvt_pk_bf16_f32 v198, v148, v149
v_mfma_f32_16x16x32_bf16 v[172:175], a[172:175], v[76:79], v[92:95]
v_exp_f32 v141, v141
v_mfma_f32_16x16x32_bf16 v[172:175], a[168:171], v[72:75], v[172:175]
v_exp_f32 v142, v142
v_mfma_f32_16x16x32_bf16 v[172:175], a[164:167], v[68:71], v[172:175]
ds_read_b128 a[216:219], v2 offset:6144
v_cvt_pk_bf16_f32 v199, v150, v151
v_mfma_f32_16x16x32_bf16 v[172:175], a[160:163], v[64:67], v[172:175]
v_exp_f32 v143, v143
v_mfma_f32_16x16x32_bf16 v[188:191], a[176:179], v[64:67], v[92:95]
v_exp_f32 v156, v156
v_mfma_f32_16x16x32_bf16 v[188:191], a[180:183], v[68:71], v[188:191]
ds_read_b128 a[220:223], v2 offset:7168
v_cvt_pk_bf16_f32 v204, v140, v141
v_mfma_f32_16x16x32_bf16 v[188:191], a[184:187], v[72:75], v[188:191]
buffer_load_dwordx4 v1, s[44:47], s72 offen offset:3072 sc1 lds
v_mfma_f32_16x16x32_bf16 v[188:191], a[188:191], v[76:79], v[188:191]
v_exp_f32 v157, v157
v_mfma_f32_16x16x32_bf16 v[180:183], a[188:191], v[44:47], v[84:87]
v_exp_f32 v158, v158
v_mfma_f32_16x16x32_bf16 v[180:183], a[184:187], v[40:43], v[180:183]
v_cvt_pk_bf16_f32 v205, v142, v143
v_cvt_pk_bf16_f32 v206, v156, v157
v_mfma_f32_16x16x32_bf16 v[180:183], a[180:183], v[36:39], v[180:183]
v_exp_f32 v159, v159
v_mfma_f32_16x16x32_bf16 v[180:183], a[176:179], v[32:35], v[180:183]
v_cvt_pk_bf16_f32 v207, v158, v159
v_mfma_f32_16x16x32_bf16 v[160:163], a[164:167], v[20:23], v[160:163]
v_mfma_f32_16x16x32_bf16 v[160:163], a[168:171], v[24:27], v[160:163]
v_mfma_f32_16x16x32_bf16 v[160:163], a[172:175], v[28:31], v[160:163]
v_mfma_f32_16x16x32_bf16 v[168:171], a[172:175], v[60:63], v[88:91]
v_mfma_f32_16x16x32_bf16 v[168:171], a[168:171], v[56:59], v[168:171]
v_mfma_f32_16x16x32_bf16 v[168:171], a[164:167], v[52:55], v[168:171]
v_mfma_f32_16x16x32_bf16 v[168:171], a[160:163], v[48:51], v[168:171]
v_mfma_f32_16x16x32_bf16 v[184:187], a[176:179], v[48:51], v[88:91]
v_mfma_f32_16x16x32_bf16 v[184:187], a[180:183], v[52:55], v[184:187]
v_mfma_f32_16x16x32_bf16 v[184:187], a[184:187], v[56:59], v[184:187]
v_mfma_f32_16x16x32_bf16 v[184:187], a[188:191], v[60:63], v[184:187]
v_mfma_f32_16x16x32_bf16 v[176:179], a[188:191], v[28:31], v[176:179]
v_mfma_f32_16x16x32_bf16 v[176:179], a[184:187], v[24:27], v[176:179]
v_mfma_f32_16x16x32_bf16 v[176:179], a[180:183], v[20:23], v[176:179]
s_waitcnt lgkmcnt(4)
v_mfma_f32_16x16x32_bf16 v[224:227], v[120:123], v[208:211], v[224:227]
s_add_u32 s82, s82, 0x8000
ds_read_b128 a[160:163], v2 offset:24576
v_mfma_f32_16x16x32_bf16 v[224:227], v[120:123], v[192:195], v[224:227]
s_and_b32 s82, s82, 0x1ffff
v_exp_f32 v164, v164
v_mfma_f32_16x16x32_bf16 v[232:235], v[120:123], v[216:219], v[232:235]
s_add_u32 m0, s74, 0
v_exp_f32 v165, v165
v_mfma_f32_16x16x32_bf16 v[232:235], v[120:123], v[200:203], v[232:235]
s_add_u32 s72, s81, 0
ds_read_b128 a[164:167], v2 offset:25600
v_cvt_pk_bf16_f32 v212, v164, v165
v_mfma_f32_16x16x32_bf16 a[0:3], a[224:227], v[208:211], a[0:3]
v_exp_f32 v166, v166
v_mfma_f32_16x16x32_bf16 a[0:3], a[192:195], v[192:195], a[0:3]
v_exp_f32 v167, v167
v_mfma_f32_16x16x32_bf16 a[64:67], a[192:195], v[200:203], a[64:67]
ds_read_b128 a[168:171], v2 offset:26624
v_cvt_pk_bf16_f32 v213, v166, v167
v_mfma_f32_16x16x32_bf16 a[64:67], a[224:227], v[216:219], a[64:67]
v_exp_f32 v180, v180
v_mfma_f32_16x16x32_bf16 a[68:71], a[228:231], v[216:219], a[68:71]
buffer_load_dwordx4 v1, s[44:47], s72 offen sc1 lds
v_mfma_f32_16x16x32_bf16 a[68:71], a[196:199], v[200:203], a[68:71]
v_exp_f32 v181, v181
v_mfma_f32_16x16x32_bf16 a[4:7], a[196:199], v[192:195], a[4:7]
ds_read_b128 a[172:175], v2 offset:27648
v_cvt_pk_bf16_f32 v214, v180, v181
v_mfma_f32_16x16x32_bf16 a[4:7], a[228:231], v[208:211], a[4:7]
v_exp_f32 v182, v182
v_mfma_f32_16x16x32_bf16 a[8:11], a[232:235], v[208:211], a[8:11]
v_exp_f32 v183, v183
v_mfma_f32_16x16x32_bf16 a[8:11], a[200:203], v[192:195], a[8:11]
ds_read_b128 a[176:179], v2 offset:28672
v_cvt_pk_bf16_f32 v215, v182, v183
v_mfma_f32_16x16x32_bf16 a[72:75], a[200:203], v[200:203], a[72:75]
v_exp_f32 v172, v172
v_mfma_f32_16x16x32_bf16 a[72:75], a[232:235], v[216:219], a[72:75]
v_exp_f32 v173, v173
v_mfma_f32_16x16x32_bf16 a[76:79], a[236:239], v[216:219], a[76:79]
ds_read_b128 a[180:183], v2 offset:29696
v_cvt_pk_bf16_f32 v220, v172, v173
v_mfma_f32_16x16x32_bf16 a[76:79], a[204:207], v[200:203], a[76:79]
v_exp_f32 v174, v174
v_mfma_f32_16x16x32_bf16 a[12:15], a[204:207], v[192:195], a[12:15]
v_exp_f32 v175, v175
v_mfma_f32_16x16x32_bf16 a[12:15], a[236:239], v[208:211], a[12:15]
ds_read_b128 a[184:187], v2 offset:30720
v_cvt_pk_bf16_f32 v221, v174, v175
v_mfma_f32_16x16x32_bf16 a[16:19], a[240:243], v[208:211], a[16:19]
s_waitcnt lgkmcnt(7)
v_exp_f32 v188, v188
v_mfma_f32_16x16x32_bf16 a[16:19], a[208:211], v[192:195], a[16:19]
buffer_load_dwordx4 v1, s[44:47], s72 offen offset:1024 sc1 lds
v_mfma_f32_16x16x32_bf16 a[80:83], a[208:211], v[200:203], a[80:83]
v_exp_f32 v189, v189
v_mfma_f32_16x16x32_bf16 a[80:83], a[240:243], v[216:219], a[80:83]
ds_read_b128 a[188:191], v2 offset:31744
v_cvt_pk_bf16_f32 v222, v188, v189
v_mfma_f32_16x16x32_bf16 a[84:87], a[244:247], v[216:219], a[84:87]
v_exp_f32 v190, v190
v_mfma_f32_16x16x32_bf16 a[84:87], a[212:215], v[200:203], a[84:87]
v_exp_f32 v191, v191
v_mfma_f32_16x16x32_bf16 a[20:23], a[212:215], v[192:195], a[20:23]
ds_read_b128 a[224:227], v2 offset:8192
v_cvt_pk_bf16_f32 v223, v190, v191
v_mfma_f32_16x16x32_bf16 a[20:23], a[244:247], v[208:211], a[20:23]
v_exp_f32 v160, v160
v_mfma_f32_16x16x32_bf16 a[24:27], a[248:251], v[208:211], a[24:27]
v_exp_f32 v161, v161
v_mfma_f32_16x16x32_bf16 a[24:27], a[216:219], v[192:195], a[24:27]
ds_read_b128 a[228:231], v2 offset:9216
v_mfma_f32_16x16x32_bf16 a[88:91], a[216:219], v[200:203], a[88:91]
v_exp_f32 v162, v162
v_mfma_f32_16x16x32_bf16 a[88:91], a[248:251], v[216:219], a[88:91]
v_exp_f32 v163, v163
v_mfma_f32_16x16x32_bf16 a[92:95], a[252:255], v[216:219], a[92:95]
ds_read_b128 a[232:235], v2 offset:10240
v_mfma_f32_16x16x32_bf16 a[92:95], a[220:223], v[200:203], a[92:95]
Lstub3:
s_cbranch_execz Lstub7
v_exp_f32 v176, v176
v_mfma_f32_16x16x32_bf16 a[28:31], a[220:223], v[192:195], a[28:31]
buffer_load_dwordx4 v1, s[44:47], s72 offen offset:2048 sc1 lds
v_mfma_f32_16x16x32_bf16 a[28:31], a[252:255], v[208:211], a[28:31]
ds_read_b128 a[236:239], v2 offset:11264
v_cvt_pk_bf16_f32 v208, v160, v161
s_cmp_eq_u32 s58, 0
s_cbranch_scc1 Lta22
s_cmp_eq_u32 s58, 1
s_cbranch_scc1 Lnt23
v_mfma_f32_16x16x32_bf16 v[132:135], a[128:131], v[32:35], v[84:87]
v_exp_f32 v177, v177
v_mfma_f32_16x16x32_bf16 v[148:151], a[144:147], v[32:35], v[84:87]
v_exp_f32 v178, v178
s_branch Ljoin24
Lta22:
v_mfma_f32_16x16x32_bf16 v[132:135], a[128:131], v[32:35], v[100:103]
v_exp_f32 v177, v177
v_mfma_f32_16x16x32_bf16 v[148:151], a[144:147], v[32:35], v[112:115]
v_exp_f32 v178, v178
s_branch Ljoin24
Lnt23:
v_mfma_f32_16x16x32_bf16 v[132:135], a[128:131], v[32:35], v[84:87]
v_exp_f32 v177, v177
v_mfma_f32_16x16x32_bf16 v[148:151], a[144:147], v[32:35], v[100:103]
v_exp_f32 v178, v178
Ljoin24:
v_mfma_f32_16x16x32_bf16 v[136:139], a[128:131], v[48:51], v[88:91]
ds_read_b128 a[240:243], v2 offset:12288
v_cvt_pk_bf16_f32 v209, v162, v163
v_mfma_f32_16x16x32_bf16 v[136:139], a[132:135], v[52:55], v[136:139]
v_exp_f32 v179, v179
v_mfma_f32_16x16x32_bf16 v[136:139], a[136:139], v[56:59], v[136:139]
v_exp_f32 v168, v168
v_mfma_f32_16x16x32_bf16 v[136:139], a[140:143], v[60:63], v[136:139]
ds_read_b128 a[244:247], v2 offset:13312
v_cvt_pk_bf16_f32 v210, v176, v177
v_mfma_f32_16x16x32_bf16 v[152:155], a[156:159], v[60:63], v[88:91]
v_exp_f32 v169, v169
v_mfma_f32_16x16x32_bf16 v[152:155], a[152:155], v[56:59], v[152:155]
v_exp_f32 v170, v170
v_mfma_f32_16x16x32_bf16 v[152:155], a[148:151], v[52:55], v[152:155]
ds_read_b128 a[248:251], v2 offset:14336
v_cvt_pk_bf16_f32 v211, v178, v179
v_mfma_f32_16x16x32_bf16 v[152:155], a[144:147], v[48:51], v[152:155]
v_exp_f32 v171, v171
v_mfma_f32_16x16x32_bf16 v[132:135], a[132:135], v[36:39], v[132:135]
v_exp_f32 v184, v184
v_mfma_f32_16x16x32_bf16 v[132:135], a[136:139], v[40:43], v[132:135]
ds_read_b128 a[252:255], v2 offset:15360
v_cvt_pk_bf16_f32 v216, v168, v169
v_mfma_f32_16x16x32_bf16 v[132:135], a[140:143], v[44:47], v[132:135]
buffer_load_dwordx4 v1, s[44:47], s72 offen offset:3072 sc1 lds
v_mfma_f32_16x16x32_bf16 v[140:143], a[140:143], v[76:79], v[92:95]
v_exp_f32 v185, v185
v_mfma_f32_16x16x32_bf16 v[140:143], a[136:139], v[72:75], v[140:143]
v_exp_f32 v186, v186
v_mfma_f32_16x16x32_bf16 v[140:143], a[132:135], v[68:71], v[140:143]
v_cvt_pk_bf16_f32 v217, v170, v171
v_cvt_pk_bf16_f32 v218, v184, v185
v_mfma_f32_16x16x32_bf16 v[140:143], a[128:131], v[64:67], v[140:143]
v_exp_f32 v187, v187
v_mfma_f32_16x16x32_bf16 v[156:159], a[144:147], v[64:67], v[92:95]
v_cvt_pk_bf16_f32 v219, v186, v187
v_add_u32 v2, s82, v1
v_mfma_f32_16x16x32_bf16 v[156:159], a[148:151], v[68:71], v[156:159]
v_mfma_f32_16x16x32_bf16 v[156:159], a[152:155], v[72:75], v[156:159]
v_mfma_f32_16x16x32_bf16 v[156:159], a[156:159], v[76:79], v[156:159]
v_mfma_f32_16x16x32_bf16 v[148:151], a[156:159], v[44:47], v[148:151]
v_mfma_f32_16x16x32_bf16 v[148:151], a[152:155], v[40:43], v[148:151]
s_waitcnt vmcnt(8) lgkmcnt(4)
v_mfma_f32_16x16x32_bf16 v[148:151], a[148:151], v[36:39], v[148:151]
s_barrier
s_cmp_eq_u32 s60, 7
s_cbranch_scc1 LLT3x
LLT3:
Lstub4:
s_cbranch_execz Lstub8
v_mfma_f32_16x16x32_bf16 v[228:231], v[120:123], v[196:199], v[228:231]
s_xor_b32 s74, s82, 0x10000
v_exp_f32 v136, v136
v_mfma_f32_16x16x32_bf16 v[228:231], v[120:123], v[212:215], v[228:231]
s_add_u32 s74, s74, s64
ds_read_b128 a[128:131], v2 offset:16384
v_and_b32 v240, 15, v0
v_mfma_f32_16x16x32_bf16 v[236:239], v[120:123], v[204:207], v[236:239]
s_add_u32 s81, s81, 0x8000
v_exp_f32 v137, v137
v_mfma_f32_16x16x32_bf16 v[236:239], v[120:123], v[220:223], v[236:239]
s_add_u32 m0, s74, 16384
ds_read_b128 a[132:135], v2 offset:17408
v_cvt_pk_bf16_f32 v200, v136, v137
v_mfma_f32_16x16x32_bf16 a[32:35], a[192:195], v[196:199], a[32:35]
s_add_u32 s72, s81, 16384
buffer_load_dwordx4 v1, s[44:47], s72 offen sc1 lds
v_mfma_f32_16x16x32_bf16 a[32:35], a[224:227], v[212:215], a[32:35]
s_add_u32 s69, s93, 0x3e00000
v_exp_f32 v138, v138
v_mfma_f32_16x16x32_bf16 a[96:99], a[224:227], v[220:223], a[96:99]
v_exp_f32 v139, v139
v_mfma_f32_16x16x32_bf16 a[96:99], a[192:195], v[204:207], a[96:99]
ds_read_b128 a[136:139], v2 offset:18432
v_cvt_pk_bf16_f32 v201, v138, v139
v_mfma_f32_16x16x32_bf16 a[100:103], a[196:199], v[204:207], a[100:103]
v_exp_f32 v152, v152
v_mfma_f32_16x16x32_bf16 a[100:103], a[228:231], v[220:223], a[100:103]
ds_read_b128 a[140:143], v2 offset:19456
v_lshrrev_b32 v241, 4, v0
v_mfma_f32_16x16x32_bf16 a[36:39], a[228:231], v[212:215], a[36:39]
buffer_store_dwordx4 v[112:115], v1, s[44:47], s69 offen sc1
v_mfma_f32_16x16x32_bf16 a[36:39], a[196:199], v[196:199], a[36:39]
v_exp_f32 v153, v153
v_mfma_f32_16x16x32_bf16 a[40:43], a[200:203], v[196:199], a[40:43]
v_exp_f32 v154, v154
v_mfma_f32_16x16x32_bf16 a[40:43], a[232:235], v[212:215], a[40:43]
ds_read_b128 a[144:147], v2 offset:20480
v_cvt_pk_bf16_f32 v202, v152, v153
v_mfma_f32_16x16x32_bf16 a[104:107], a[232:235], v[220:223], a[104:107]
v_exp_f32 v155, v155
v_mfma_f32_16x16x32_bf16 a[104:107], a[200:203], v[204:207], a[104:107]
ds_read_b128 a[148:151], v2 offset:21504
v_cvt_pk_bf16_f32 v203, v154, v155
v_mfma_f32_16x16x32_bf16 a[108:111], a[204:207], v[204:207], a[108:111]
buffer_load_dwordx4 v1, s[44:47], s72 offen offset:1024 sc1 lds
v_mfma_f32_16x16x32_bf16 a[108:111], a[236:239], v[220:223], a[108:111]
v_exp_f32 v132, v132
v_mfma_f32_16x16x32_bf16 a[44:47], a[236:239], v[212:215], a[44:47]
v_exp_f32 v133, v133
v_mfma_f32_16x16x32_bf16 a[44:47], a[204:207], v[196:199], a[44:47]
ds_read_b128 a[152:155], v2 offset:22528
v_add_u32 v248, 1, v240
v_mfma_f32_16x16x32_bf16 a[48:51], a[208:211], v[196:199], a[48:51]
s_waitcnt lgkmcnt(7)
v_exp_f32 v134, v134
v_mfma_f32_16x16x32_bf16 a[48:51], a[240:243], v[212:215], a[48:51]
ds_read_b128 a[156:159], v2 offset:23552
v_and_b32 v249, 3, v248
v_mfma_f32_16x16x32_bf16 a[112:115], a[240:243], v[220:223], a[112:115]
buffer_store_dwordx4 v[112:115], v1, s[44:47], s69 offen offset:1024 sc1
v_mfma_f32_16x16x32_bf16 a[112:115], a[208:211], v[204:207], a[112:115]
v_exp_f32 v135, v135
v_mfma_f32_16x16x32_bf16 a[116:119], a[212:215], v[204:207], a[116:119]
v_exp_f32 v148, v148
v_mfma_f32_16x16x32_bf16 a[116:119], a[244:247], v[220:223], a[116:119]
ds_read_b128 a[192:195], v2 offset:0
v_lshrrev_b32 v248, 2, v248
v_mfma_f32_16x16x32_bf16 a[52:55], a[244:247], v[212:215], a[52:55]
v_exp_f32 v149, v149
v_mfma_f32_16x16x32_bf16 a[52:55], a[212:215], v[196:199], a[52:55]
ds_read_b128 a[196:199], v2 offset:1024
v_mov_b32 v250, 0x20000
v_mfma_f32_16x16x32_bf16 a[56:59], a[216:219], v[196:199], a[56:59]
buffer_load_dwordx4 v1, s[44:47], s72 offen offset:2048 sc1 lds
v_mfma_f32_16x16x32_bf16 a[56:59], a[248:251], v[212:215], a[56:59]
v_exp_f32 v150, v150
v_mfma_f32_16x16x32_bf16 a[120:123], a[248:251], v[220:223], a[120:123]
v_exp_f32 v151, v151
v_mfma_f32_16x16x32_bf16 a[120:123], a[216:219], v[204:207], a[120:123]
ds_read_b128 a[200:203], v2 offset:2048
v_mov_b32 v252, 0x20001
v_mfma_f32_16x16x32_bf16 a[124:127], a[220:223], v[204:207], a[124:127]
v_exp_f32 v140, v140
v_mfma_f32_16x16x32_bf16 a[124:127], a[252:255], v[220:223], a[124:127]
ds_read_b128 a[204:207], v2 offset:3072
v_lshlrev_b32 v6, 3, v249
v_mfma_f32_16x16x32_bf16 a[60:63], a[252:255], v[212:215], a[60:63]
buffer_store_dwordx4 v[112:115], v1, s[44:47], s69 offen offset:2048 sc1
v_mfma_f32_16x16x32_bf16 a[60:63], a[220:223], v[196:199], a[60:63]
ds_read_b128 a[208:211], v2 offset:4096
v_cvt_pk_bf16_f32 v196, v132, v133
s_cmp_eq_u32 s58, 2
s_cbranch_scc1 Lta25
s_cmp_eq_u32 s58, 3
s_cbranch_scc1 Lnt26
v_mfma_f32_16x16x32_bf16 v[164:167], a[160:163], v[32:35], v[112:115]
ds_read_b128 a[212:215], v2 offset:5120
v_cvt_pk_bf16_f32 v197, v134, v135
v_mfma_f32_16x16x32_bf16 v[180:183], a[176:179], v[32:35], v[112:115]
ds_read_b128 a[216:219], v2 offset:6144
v_cvt_pk_bf16_f32 v198, v148, v149
s_branch Ljoin27
Lta25:
v_mfma_f32_16x16x32_bf16 v[164:167], a[160:163], v[32:35], v[100:103]
ds_read_b128 a[212:215], v2 offset:5120
v_cvt_pk_bf16_f32 v197, v134, v135
v_mfma_f32_16x16x32_bf16 v[180:183], a[176:179], v[32:35], v[112:115]
ds_read_b128 a[216:219], v2 offset:6144
v_cvt_pk_bf16_f32 v198, v148, v149
s_branch Ljoin27
Lnt26:
v_mfma_f32_16x16x32_bf16 v[164:167], a[160:163], v[32:35], v[84:87]
ds_read_b128 a[212:215], v2 offset:5120
v_cvt_pk_bf16_f32 v197, v134, v135
v_mfma_f32_16x16x32_bf16 v[180:183], a[176:179], v[32:35], v[100:103]
ds_read_b128 a[216:219], v2 offset:6144
v_cvt_pk_bf16_f32 v198, v148, v149
Ljoin27:
v_mfma_f32_16x16x32_bf16 v[164:167], a[164:167], v[36:39], v[164:167]
v_exp_f32 v141, v141
v_mfma_f32_16x16x32_bf16 v[164:167], a[168:171], v[40:43], v[164:167]
v_exp_f32 v142, v142
v_mfma_f32_16x16x32_bf16 v[164:167], a[172:175], v[44:47], v[164:167]
ds_read_b128 a[220:223], v2 offset:7168
v_cvt_pk_bf16_f32 v199, v150, v151
v_mfma_f32_16x16x32_bf16 v[172:175], a[172:175], v[76:79], v[92:95]
v_exp_f32 v143, v143
v_mfma_f32_16x16x32_bf16 v[172:175], a[168:171], v[72:75], v[172:175]
buffer_load_dwordx4 v1, s[44:47], s72 offen offset:3072 sc1 lds
v_mfma_f32_16x16x32_bf16 v[172:175], a[164:167], v[68:71], v[172:175]
v_exp_f32 v156, v156
v_mfma_f32_16x16x32_bf16 v[172:175], a[160:163], v[64:67], v[172:175]
v_cvt_pk_bf16_f32 v204, v140, v141
v_cvt_pk_bf16_f32 v205, v142, v143
v_mfma_f32_16x16x32_bf16 v[188:191], a[176:179], v[64:67], v[92:95]
v_exp_f32 v157, v157
v_mfma_f32_16x16x32_bf16 v[188:191], a[180:183], v[68:71], v[188:191]
v_exp_f32 v158, v158
v_mfma_f32_16x16x32_bf16 v[188:191], a[184:187], v[72:75], v[188:191]
buffer_store_dwordx4 v[112:115], v1, s[44:47], s69 offen offset:3072 sc1
v_mfma_f32_16x16x32_bf16 v[188:191], a[188:191], v[76:79], v[188:191]
v_exp_f32 v159, v159
v_mfma_f32_16x16x32_bf16 v[180:183], a[188:191], v[44:47], v[180:183]
v_cvt_pk_bf16_f32 v206, v156, v157
v_cvt_pk_bf16_f32 v207, v158, v159
v_mfma_f32_16x16x32_bf16 v[180:183], a[184:187], v[40:43], v[180:183]
v_lshrrev_b32 v6, v6, v252
v_and_b32 v6, 3, v6
v_mfma_f32_16x16x32_bf16 v[180:183], a[180:183], v[36:39], v[180:183]
v_cmp_ne_u32 vcc, 1, v249
v_mul_u32_u24 v6, 16640, v6
v_mfma_f32_16x16x32_bf16 v[168:171], a[160:163], v[48:51], v[88:91]
v_add_u32 v6, s92, v6
v_cndmask_b32 v6, v250, v6, vcc
v_mfma_f32_16x16x32_bf16 v[168:171], a[164:167], v[52:55], v[168:171]
v_add_u32 v253, s58, v249
v_and_b32 v253, 3, v253
v_mfma_f32_16x16x32_bf16 v[168:171], a[168:171], v[56:59], v[168:171]
v_mul_u32_u24 v253, 4160, v253
v_add_u32 v6, v6, v253
v_mfma_f32_16x16x32_bf16 v[168:171], a[172:175], v[60:63], v[168:171]
v_bfe_u32 v251, v0, 2, 2
v_lshl_add_u32 v6, v248, 3, v6
v_mfma_f32_16x16x32_bf16 v[184:187], a[188:191], v[60:63], v[88:91]
v_lshl_add_u32 v6, v241, 4, v6
v_lshlrev_b32 v5, 3, v251
v_mfma_f32_16x16x32_bf16 v[184:187], a[184:187], v[56:59], v[184:187]
v_lshrrev_b32 v5, v5, v252
v_and_b32 v5, 3, v5
v_mfma_f32_16x16x32_bf16 v[184:187], a[180:183], v[52:55], v[184:187]
v_cmp_ne_u32 vcc, 1, v251
v_mul_u32_u24 v5, 16640, v5
v_mfma_f32_16x16x32_bf16 v[184:187], a[176:179], v[48:51], v[184:187]
s_waitcnt lgkmcnt(4)
v_mfma_f32_16x16x32_bf16 v[224:227], v[120:123], v[208:211], v[224:227]
s_add_u32 s82, s82, 0x8000
ds_read_b128 a[160:163], v2 offset:24576
ds_read_b128 a[164:167], v2 offset:25600
v_mfma_f32_16x16x32_bf16 v[232:235], v[120:123], v[216:219], v[232:235]
s_and_b32 s82, s82, 0x1ffff
v_exp_f32 v164, v164
v_mfma_f32_16x16x32_bf16 v[232:235], v[120:123], v[200:203], v[232:235]
s_add_u32 m0, s74, 0
v_exp_f32 v165, v165
v_mfma_f32_16x16x32_bf16 a[0:3], a[224:227], v[208:211], a[0:3]
s_add_u32 s72, s81, 0
v_exp_f32 v166, v166
v_mfma_f32_16x16x32_bf16 a[64:67], a[192:195], v[200:203], a[64:67]
ds_read_b128 a[168:171], v2 offset:26624
v_cvt_pk_bf16_f32 v212, v164, v165
v_mfma_f32_16x16x32_bf16 a[64:67], a[224:227], v[216:219], a[64:67]
v_exp_f32 v167, v167
v_mfma_f32_16x16x32_bf16 a[68:71], a[228:231], v[216:219], a[68:71]
buffer_load_dwordx4 v1, s[44:47], s72 offen sc1 lds
v_mfma_f32_16x16x32_bf16 a[68:71], a[196:199], v[200:203], a[68:71]
v_exp_f32 v180, v180
v_mfma_f32_16x16x32_bf16 a[4:7], a[228:231], v[208:211], a[4:7]
ds_read_b128 a[172:175], v2 offset:27648
v_cvt_pk_bf16_f32 v213, v166, v167
v_mfma_f32_16x16x32_bf16 a[8:11], a[232:235], v[208:211], a[8:11]
v_exp_f32 v181, v181
v_mfma_f32_16x16x32_bf16 a[72:75], a[200:203], v[200:203], a[72:75]
ds_read_b128 a[176:179], v2 offset:28672
v_cvt_pk_bf16_f32 v214, v180, v181
v_mfma_f32_16x16x32_bf16 a[72:75], a[232:235], v[216:219], a[72:75]
v_exp_f32 v182, v182
v_mfma_f32_16x16x32_bf16 a[76:79], a[236:239], v[216:219], a[76:79]
v_exp_f32 v183, v183
v_mfma_f32_16x16x32_bf16 a[76:79], a[204:207], v[200:203], a[76:79]
ds_read_b128 a[180:183], v2 offset:29696
v_cvt_pk_bf16_f32 v215, v182, v183
v_mfma_f32_16x16x32_bf16 a[12:15], a[236:239], v[208:211], a[12:15]
v_exp_f32 v172, v172
v_mfma_f32_16x16x32_bf16 a[16:19], a[240:243], v[208:211], a[16:19]
s_waitcnt lgkmcnt(6)
ds_read_b128 a[184:187], v2 offset:30720
ds_read_b128 a[188:191], v2 offset:31744
v_mfma_f32_16x16x32_bf16 a[80:83], a[208:211], v[200:203], a[80:83]
v_exp_f32 v173, v173
v_mfma_f32_16x16x32_bf16 a[80:83], a[240:243], v[216:219], a[80:83]
buffer_load_dwordx4 v1, s[44:47], s72 offen offset:1024 sc1 lds
v_mfma_f32_16x16x32_bf16 a[84:87], a[244:247], v[216:219], a[84:87]
v_exp_f32 v174, v174
v_mfma_f32_16x16x32_bf16 a[84:87], a[212:215], v[200:203], a[84:87]
v_exp_f32 v175, v175
v_mfma_f32_16x16x32_bf16 a[20:23], a[244:247], v[208:211], a[20:23]
ds_read_b128 a[224:227], v2 offset:8192
v_cvt_pk_bf16_f32 v220, v172, v173
v_mfma_f32_16x16x32_bf16 a[24:27], a[248:251], v[208:211], a[24:27]
v_exp_f32 v188, v188
v_mfma_f32_16x16x32_bf16 a[88:91], a[216:219], v[200:203], a[88:91]
v_exp_f32 v189, v189
v_mfma_f32_16x16x32_bf16 a[88:91], a[248:251], v[216:219], a[88:91]
ds_read_b128 a[228:231], v2 offset:9216
v_cvt_pk_bf16_f32 v221, v174, v175
v_mfma_f32_16x16x32_bf16 a[92:95], a[252:255], v[216:219], a[92:95]
v_exp_f32 v190, v190
v_mfma_f32_16x16x32_bf16 a[92:95], a[220:223], v[200:203], a[92:95]
ds_read_b128 a[232:235], v2 offset:10240
v_cvt_pk_bf16_f32 v222, v188, v189
v_mfma_f32_16x16x32_bf16 a[28:31], a[252:255], v[208:211], a[28:31]
v_exp_f32 v191, v191
v_mfma_f32_16x16x32_bf16 v[136:139], a[128:131], v[48:51], v[88:91]
buffer_load_dwordx4 v1, s[44:47], s72 offen offset:2048 sc1 lds
v_mfma_f32_16x16x32_bf16 v[136:139], a[132:135], v[52:55], v[136:139]
v_exp_f32 v168, v168
v_mfma_f32_16x16x32_bf16 v[136:139], a[136:139], v[56:59], v[136:139]
ds_read_b128 a[236:239], v2 offset:11264
v_cvt_pk_bf16_f32 v223, v190, v191
v_mfma_f32_16x16x32_bf16 v[136:139], a[140:143], v[60:63], v[136:139]
v_exp_f32 v169, v169
v_mfma_f32_16x16x32_bf16 v[152:155], a[156:159], v[60:63], v[88:91]
ds_read_b128 a[240:243], v2 offset:12288
v_cvt_pk_bf16_f32 v216, v168, v169
v_mfma_f32_16x16x32_bf16 v[152:155], a[152:155], v[56:59], v[152:155]
v_exp_f32 v170, v170
v_mfma_f32_16x16x32_bf16 v[152:155], a[148:151], v[52:55], v[152:155]
v_exp_f32 v171, v171
v_mfma_f32_16x16x32_bf16 v[152:155], a[144:147], v[48:51], v[152:155]
ds_read_b128 a[244:247], v2 offset:13312
v_cvt_pk_bf16_f32 v217, v170, v171
v_mfma_f32_16x16x32_bf16 v[140:143], a[128:131], v[64:67], v[92:95]
v_exp_f32 v184, v184
v_mfma_f32_16x16x32_bf16 v[140:143], a[132:135], v[68:71], v[140:143]
ds_read_b128 a[248:251], v2 offset:14336
v_mfma_f32_16x16x32_bf16 v[140:143], a[136:139], v[72:75], v[140:143]
v_exp_f32 v185, v185
v_mfma_f32_16x16x32_bf16 v[140:143], a[140:143], v[76:79], v[140:143]
buffer_load_dwordx4 v1, s[44:47], s72 offen offset:3072 sc1 lds
v_mfma_f32_16x16x32_bf16 v[156:159], a[156:159], v[76:79], v[92:95]
ds_read_b128 a[252:255], v2 offset:15360
v_cvt_pk_bf16_f32 v218, v184, v185
v_mfma_f32_16x16x32_bf16 v[156:159], a[152:155], v[72:75], v[156:159]
v_exp_f32 v186, v186
v_mfma_f32_16x16x32_bf16 v[156:159], a[148:151], v[68:71], v[156:159]
s_waitcnt vmcnt(12) lgkmcnt(4)
v_exp_f32 v187, v187
v_mfma_f32_16x16x32_bf16 v[156:159], a[144:147], v[64:67], v[156:159]
s_barrier
v_cvt_pk_bf16_f32 v219, v186, v187
v_add_u32 v2, s82, v1
v_mfma_f32_16x16x32_bf16 v[228:231], v[120:123], v[196:199], v[228:231]
s_xor_b32 s74, s82, 0x10000
v_exp_f32 v136, v136
v_mfma_f32_16x16x32_bf16 v[228:231], v[120:123], v[212:215], v[228:231]
s_add_u32 s74, s74, s64
ds_read_b128 a[128:131], v2 offset:16384
v_add_u32 v5, s92, v5
v_mfma_f32_16x16x32_bf16 v[236:239], v[120:123], v[204:207], v[236:239]
s_add_u32 s81, s81, 0x8000
v_exp_f32 v137, v137
v_mfma_f32_16x16x32_bf16 v[236:239], v[120:123], v[220:223], v[236:239]
s_add_u32 m0, s74, 16384
ds_read_b128 a[132:135], v2 offset:17408
v_cvt_pk_bf16_f32 v200, v136, v137
v_mfma_f32_16x16x32_bf16 a[32:35], a[192:195], v[196:199], a[32:35]
s_add_u32 s72, s81, 16384
buffer_load_dwordx4 v1, s[44:47], s72 offen sc1 lds
v_mfma_f32_16x16x32_bf16 a[32:35], a[224:227], v[212:215], a[32:35]
s_add_u32 s69, s93, 0x4200000
v_exp_f32 v138, v138
v_mfma_f32_16x16x32_bf16 a[96:99], a[224:227], v[220:223], a[96:99]
ds_read_b128 a[136:139], v2 offset:18432
v_cndmask_b32 v5, v250, v5, vcc
v_mfma_f32_16x16x32_bf16 a[96:99], a[192:195], v[204:207], a[96:99]
v_exp_f32 v139, v139
v_mfma_f32_16x16x32_bf16 a[100:103], a[196:199], v[204:207], a[100:103]
ds_read_b128 a[140:143], v2 offset:19456
v_cvt_pk_bf16_f32 v201, v138, v139
v_mfma_f32_16x16x32_bf16 a[100:103], a[228:231], v[220:223], a[100:103]
buffer_store_dwordx4 v[112:115], v1, s[44:47], s69 offen sc1
v_mfma_f32_16x16x32_bf16 a[36:39], a[228:231], v[212:215], a[36:39]
v_exp_f32 v152, v152
v_mfma_f32_16x16x32_bf16 a[36:39], a[196:199], v[196:199], a[36:39]
ds_read_b128 a[144:147], v2 offset:20480
v_add_u32 v253, s58, v251
v_mfma_f32_16x16x32_bf16 a[40:43], a[200:203], v[196:199], a[40:43]
v_exp_f32 v153, v153
v_mfma_f32_16x16x32_bf16 a[40:43], a[232:235], v[212:215], a[40:43]
ds_read_b128 a[148:151], v2 offset:21504
v_cvt_pk_bf16_f32 v202, v152, v153
v_mfma_f32_16x16x32_bf16 a[104:107], a[232:235], v[220:223], a[104:107]
buffer_load_dwordx4 v1, s[44:47], s72 offen offset:1024 sc1 lds
v_mfma_f32_16x16x32_bf16 a[104:107], a[200:203], v[204:207], a[104:107]
v_exp_f32 v154, v154
v_mfma_f32_16x16x32_bf16 a[108:111], a[204:207], v[204:207], a[108:111]
ds_read_b128 a[152:155], v2 offset:22528
v_and_b32 v253, 3, v253
v_mfma_f32_16x16x32_bf16 a[108:111], a[236:239], v[220:223], a[108:111]
v_exp_f32 v155, v155
v_mfma_f32_16x16x32_bf16 a[44:47], a[236:239], v[212:215], a[44:47]
ds_read_b128 a[156:159], v2 offset:23552
v_cvt_pk_bf16_f32 v203, v154, v155
v_mfma_f32_16x16x32_bf16 a[44:47], a[204:207], v[196:199], a[44:47]
buffer_store_dwordx4 v[112:115], v1, s[44:47], s69 offen offset:1024 sc1
v_mfma_f32_16x16x32_bf16 a[48:51], a[208:211], v[196:199], a[48:51]
s_waitcnt lgkmcnt(8)
v_exp_f32 v140, v140
v_mfma_f32_16x16x32_bf16 a[48:51], a[240:243], v[212:215], a[48:51]
ds_read_b128 a[192:195], v2 offset:0
v_mul_u32_u24 v253, 4160, v253
v_mfma_f32_16x16x32_bf16 a[112:115], a[240:243], v[220:223], a[112:115]
v_exp_f32 v141, v141
v_mfma_f32_16x16x32_bf16 a[112:115], a[208:211], v[204:207], a[112:115]
ds_read_b128 a[196:199], v2 offset:1024
v_add_u32 v5, v5, v253
v_mfma_f32_16x16x32_bf16 a[116:119], a[212:215], v[204:207], a[116:119]
s_add_u32 s73, s62, 480
buffer_load_dwordx4 v1, s[44:47], s72 offen offset:2048 sc1 lds
v_mfma_f32_16x16x32_bf16 a[116:119], a[244:247], v[220:223], a[116:119]
v_exp_f32 v142, v142
v_mfma_f32_16x16x32_bf16 a[52:55], a[244:247], v[212:215], a[52:55]
ds_read_b128 a[200:203], v2 offset:2048
v_lshlrev_b32 v248, 5, v240
v_mfma_f32_16x16x32_bf16 a[52:55], a[212:215], v[196:199], a[52:55]
v_exp_f32 v143, v143
v_mfma_f32_16x16x32_bf16 a[56:59], a[216:219], v[196:199], a[56:59]
ds_read_b128 a[204:207], v2 offset:3072
v_sub_u32 v248, s73, v248
v_mfma_f32_16x16x32_bf16 a[56:59], a[248:251], v[212:215], a[56:59]
buffer_store_dwordx4 v[112:115], v1, s[44:47], s69 offen offset:2048 sc1
v_mfma_f32_16x16x32_bf16 a[120:123], a[248:251], v[220:223], a[120:123]
v_exp_f32 v156, v156
v_mfma_f32_16x16x32_bf16 a[120:123], a[216:219], v[204:207], a[120:123]
ds_read_b128 a[208:211], v2 offset:4096
v_lshl_add_u32 v7, v241, 4, v248
v_mfma_f32_16x16x32_bf16 a[124:127], a[220:223], v[204:207], a[124:127]
s_and_b32 s73, s58, 1
v_exp_f32 v157, v157
v_mfma_f32_16x16x32_bf16 a[124:127], a[252:255], v[220:223], a[124:127]
s_lshl_b32 s73, s73, 4
ds_read_b128 a[212:215], v2 offset:5120
v_mfma_f32_16x16x32_bf16 a[60:63], a[252:255], v[212:215], a[60:63]
s_lshr_b32 s73, s90, s73
buffer_load_dwordx4 v1, s[44:47], s72 offen offset:3072 sc1 lds
v_mfma_f32_16x16x32_bf16 a[60:63], a[220:223], v[196:199], a[60:63]
s_and_b32 s73, s73, 0xffff
ds_read_b128 a[216:219], v2 offset:6144
v_cvt_pk_bf16_f32 v204, v140, v141
v_mfma_f32_16x16x32_bf16 v[172:175], a[160:163], v[64:67], v[92:95]
v_exp_f32 v158, v158
v_mfma_f32_16x16x32_bf16 v[172:175], a[164:167], v[68:71], v[172:175]
ds_read_b128 a[220:223], v2 offset:7168
v_cvt_pk_bf16_f32 v205, v142, v143
v_mfma_f32_16x16x32_bf16 v[172:175], a[168:171], v[72:75], v[172:175]
v_exp_f32 v159, v159
v_mfma_f32_16x16x32_bf16 v[172:175], a[172:175], v[76:79], v[172:175]
buffer_store_dwordx4 v[112:115], v1, s[44:47], s69 offen offset:3072 sc1
v_mfma_f32_16x16x32_bf16 v[188:191], a[188:191], v[76:79], v[92:95]
v_cvt_pk_bf16_f32 v206, v156, v157
v_cvt_pk_bf16_f32 v207, v158, v159
v_mfma_f32_16x16x32_bf16 v[188:191], a[184:187], v[72:75], v[188:191]
v_lshl_add_u32 v248, v241, 3, v240
v_sub_u32 v248, 15, v248
v_mfma_f32_16x16x32_bf16 v[188:191], a[180:183], v[68:71], v[188:191]
v_and_b32 v249, 1, v248
v_lshlrev_b32 v249, 4, v249
v_mfma_f32_16x16x32_bf16 v[188:191], a[176:179], v[64:67], v[188:191]
v_lshlrev_b32 v249, v249, s73
v_lshrrev_b32 v248, 1, v248
v_mfma_f32_16x16x32_bf16 v[168:171], a[160:163], v[48:51], v[88:91]
v_and_b32 v241, 3, v0
v_cmp_eq_u32 vcc, 0, v248
v_mfma_f32_16x16x32_bf16 v[168:171], a[164:167], v[52:55], v[168:171]
v_lshl_add_u32 v5, v241, 3, v5
v_cndmask_b32 v8, 0, v249, vcc
v_mfma_f32_16x16x32_bf16 v[168:171], a[168:171], v[56:59], v[168:171]
v_cmp_eq_u32 vcc, 1, v248
v_lshlrev_b32 v240, 4, v251
v_mfma_f32_16x16x32_bf16 v[168:171], a[172:175], v[60:63], v[168:171]
v_cndmask_b32 v9, 0, v249, vcc
v_cmp_eq_u32 vcc, 2, v248
v_mfma_f32_16x16x32_bf16 v[184:187], a[188:191], v[60:63], v[88:91]
v_sub_u32 v240, 48, v240
v_lshlrev_b64 v[12:13], 16, s[88:89]
v_mfma_f32_16x16x32_bf16 v[184:187], a[184:187], v[56:59], v[184:187]
v_cndmask_b32 v10, 0, v249, vcc
v_cmp_eq_u32 vcc, 3, v248
v_mfma_f32_16x16x32_bf16 v[184:187], a[180:183], v[52:55], v[184:187]
v_lshlrev_b64 v[12:13], v240, v[12:13]
v_cndmask_b32 v11, 0, v249, vcc
v_mfma_f32_16x16x32_bf16 v[184:187], a[176:179], v[48:51], v[184:187]
s_waitcnt lgkmcnt(4)
v_cmp_eq_u32 vcc, 3, v241
s_add_u32 s73, s62, 4096
v_lshl_add_u32 v14, v0, 3, s73
v_cndmask_b32 v12, 0, v12, vcc
v_cndmask_b32 v13, 0, v13, vcc
v_lshrrev_b32 v15, 4, v0
v_lshlrev_b32 v15, 1, v15
v_and_b32 v240, 7, v0
v_xor_b32 v15, v15, v240
v_lshlrev_b32 v15, 4, v15
v_lshrrev_b32 v240, 3, v0
v_lshl_add_u32 v15, v240, 11, v15
s_lshr_b32 s75, s59, 1
s_and_b32 s75, s75, 8
s_add_u32 s75, s75, s60
s_lshl_b32 s76, s65, 2
s_lshr_b32 s80, s59, 2
s_and_b32 s80, s80, 3
s_add_u32 s76, s76, s80
s_lshl_b32 s94, s58, 16
s_lshl_b32 s80, s76, 7
s_add_u32 s94, s94, s80
s_lshl_b32 s80, s75, 18
s_add_u32 s80, s80, s94
v_rcp_f32 v224, v224
v_rcp_f32 v228, v228
s_lshl_b32 s73, s59, 12
s_add_u32 s73, s73, 0x2000000
s_lshl_b32 s70, s67, 2
s_add_u32 s70, s70, s73
v_mov_b32 v225, v224
v_accvgpr_read_b32 v240, a0
v_accvgpr_read_b32 v241, a1
v_accvgpr_read_b32 v242, a2
v_accvgpr_read_b32 v243, a3
v_accvgpr_read_b32 v244, a4
v_accvgpr_read_b32 v245, a5
v_accvgpr_read_b32 v246, a6
v_accvgpr_read_b32 v247, a7
v_pk_mul_f32 v[240:241], v[240:241], v[224:225]
v_pk_mul_f32 v[242:243], v[242:243], v[224:225]
v_pk_mul_f32 v[244:245], v[244:245], v[224:225]
v_pk_mul_f32 v[246:247], v[246:247], v[224:225]
v_cvt_pk_bf16_f32 v128, v240, v241
v_cvt_pk_bf16_f32 v129, v242, v243
v_cvt_pk_bf16_f32 v130, v244, v245
v_cvt_pk_bf16_f32 v131, v246, v247
v_accvgpr_read_b32 v248, a8
v_accvgpr_read_b32 v249, a9
v_accvgpr_read_b32 v250, a10
v_accvgpr_read_b32 v251, a11
v_accvgpr_read_b32 v252, a12
v_accvgpr_read_b32 v253, a13
v_accvgpr_read_b32 v254, a14
v_accvgpr_read_b32 v255, a15
v_pk_mul_f32 v[248:249], v[248:249], v[224:225]
v_pk_mul_f32 v[250:251], v[250:251], v[224:225]
v_pk_mul_f32 v[252:253], v[252:253], v[224:225]
v_pk_mul_f32 v[254:255], v[254:255], v[224:225]
v_cvt_pk_bf16_f32 v144, v248, v249
v_cvt_pk_bf16_f32 v145, v250, v251
v_cvt_pk_bf16_f32 v146, v252, v253
v_cvt_pk_bf16_f32 v147, v254, v255
v_accvgpr_read_b32 v240, a16
v_accvgpr_read_b32 v241, a17
v_accvgpr_read_b32 v242, a18
v_accvgpr_read_b32 v243, a19
v_accvgpr_read_b32 v244, a20
v_accvgpr_read_b32 v245, a21
v_accvgpr_read_b32 v246, a22
v_accvgpr_read_b32 v247, a23
v_pk_mul_f32 v[240:241], v[240:241], v[224:225]
v_pk_mul_f32 v[242:243], v[242:243], v[224:225]
v_pk_mul_f32 v[244:245], v[244:245], v[224:225]
v_pk_mul_f32 v[246:247], v[246:247], v[224:225]
v_cvt_pk_bf16_f32 v160, v240, v241
v_cvt_pk_bf16_f32 v161, v242, v243
v_cvt_pk_bf16_f32 v162, v244, v245
v_cvt_pk_bf16_f32 v163, v246, v247
v_accvgpr_read_b32 v248, a24
v_accvgpr_read_b32 v249, a25
v_accvgpr_read_b32 v250, a26
v_accvgpr_read_b32 v251, a27
v_accvgpr_read_b32 v252, a28
v_accvgpr_read_b32 v253, a29
v_accvgpr_read_b32 v254, a30
v_accvgpr_read_b32 v255, a31
v_pk_mul_f32 v[248:249], v[248:249], v[224:225]
v_pk_mul_f32 v[250:251], v[250:251], v[224:225]
v_pk_mul_f32 v[252:253], v[252:253], v[224:225]
v_pk_mul_f32 v[254:255], v[254:255], v[224:225]
v_cvt_pk_bf16_f32 v176, v248, v249
v_cvt_pk_bf16_f32 v177, v250, v251
v_cvt_pk_bf16_f32 v178, v252, v253
v_cvt_pk_bf16_f32 v179, v254, v255
v_mov_b32 v229, v228
v_accvgpr_read_b32 v240, a32
v_accvgpr_read_b32 v241, a33
v_accvgpr_read_b32 v242, a34
v_accvgpr_read_b32 v243, a35
v_accvgpr_read_b32 v244, a36
v_accvgpr_read_b32 v245, a37
v_accvgpr_read_b32 v246, a38
v_accvgpr_read_b32 v247, a39
v_pk_mul_f32 v[240:241], v[240:241], v[228:229]
v_pk_mul_f32 v[242:243], v[242:243], v[228:229]
v_pk_mul_f32 v[244:245], v[244:245], v[228:229]
v_pk_mul_f32 v[246:247], v[246:247], v[228:229]
v_cvt_pk_bf16_f32 v132, v240, v241
v_cvt_pk_bf16_f32 v133, v242, v243
v_cvt_pk_bf16_f32 v134, v244, v245
v_cvt_pk_bf16_f32 v135, v246, v247
v_accvgpr_read_b32 v248, a40
Lstub5:
s_cbranch_execz Lstub9
v_accvgpr_read_b32 v249, a41
v_accvgpr_read_b32 v250, a42
v_accvgpr_read_b32 v251, a43
v_accvgpr_read_b32 v252, a44
v_accvgpr_read_b32 v253, a45
v_accvgpr_read_b32 v254, a46
v_accvgpr_read_b32 v255, a47
v_pk_mul_f32 v[248:249], v[248:249], v[228:229]
v_pk_mul_f32 v[250:251], v[250:251], v[228:229]
v_pk_mul_f32 v[252:253], v[252:253], v[228:229]
v_pk_mul_f32 v[254:255], v[254:255], v[228:229]
v_cvt_pk_bf16_f32 v148, v248, v249
v_cvt_pk_bf16_f32 v149, v250, v251
v_cvt_pk_bf16_f32 v150, v252, v253
v_cvt_pk_bf16_f32 v151, v254, v255
v_accvgpr_read_b32 v240, a48
v_accvgpr_read_b32 v241, a49
v_accvgpr_read_b32 v242, a50
v_accvgpr_read_b32 v243, a51
v_accvgpr_read_b32 v244, a52
v_accvgpr_read_b32 v245, a53
v_accvgpr_read_b32 v246, a54
v_accvgpr_read_b32 v247, a55
v_pk_mul_f32 v[240:241], v[240:241], v[228:229]
v_pk_mul_f32 v[242:243], v[242:243], v[228:229]
v_pk_mul_f32 v[244:245], v[244:245], v[228:229]
v_pk_mul_f32 v[246:247], v[246:247], v[228:229]
v_cvt_pk_bf16_f32 v164, v240, v241
v_cvt_pk_bf16_f32 v165, v242, v243
v_cvt_pk_bf16_f32 v166, v244, v245
v_cvt_pk_bf16_f32 v167, v246, v247
v_accvgpr_read_b32 v248, a56
v_accvgpr_read_b32 v249, a57
v_accvgpr_read_b32 v250, a58
v_accvgpr_read_b32 v251, a59
v_accvgpr_read_b32 v252, a60
v_accvgpr_read_b32 v253, a61
v_accvgpr_read_b32 v254, a62
v_accvgpr_read_b32 v255, a63
v_pk_mul_f32 v[248:249], v[248:249], v[228:229]
v_pk_mul_f32 v[250:251], v[250:251], v[228:229]
v_pk_mul_f32 v[252:253], v[252:253], v[228:229]
v_pk_mul_f32 v[254:255], v[254:255], v[228:229]
v_cvt_pk_bf16_f32 v180, v248, v249
v_cvt_pk_bf16_f32 v181, v250, v251
v_cvt_pk_bf16_f32 v182, v252, v253
v_cvt_pk_bf16_f32 v183, v254, v255
v_mfma_f32_16x16x32_bf16 v[232:235], v[120:123], v[216:219], v[232:235]
s_add_u32 s82, s82, 0x8000
ds_read_b128 a[160:163], v2 offset:24576
ds_read_b128 a[164:167], v2 offset:25600
v_mfma_f32_16x16x32_bf16 v[232:235], v[120:123], v[200:203], v[232:235]
s_and_b32 s82, s82, 0x1ffff
v_exp_f32 v172, v172
v_mfma_f32_16x16x32_bf16 a[64:67], a[224:227], v[216:219], a[64:67]
s_add_u32 m0, s74, 0
v_exp_f32 v173, v173
v_mfma_f32_16x16x32_bf16 a[64:67], a[192:195], v[200:203], a[64:67]
s_add_u32 s72, s81, 0
buffer_load_dwordx4 v1, s[44:47], s72 offen sc1 lds
v_mfma_f32_16x16x32_bf16 a[68:71], a[196:199], v[200:203], a[68:71]
ds_read_b128 a[168:171], v2 offset:26624
v_cvt_pk_bf16_f32 v220, v172, v173
v_mfma_f32_16x16x32_bf16 a[68:71], a[228:231], v[216:219], a[68:71]
v_exp_f32 v174, v174
v_mfma_f32_16x16x32_bf16 a[72:75], a[232:235], v[216:219], a[72:75]
s_nop 0
ds_read_b128 a[172:175], v2 offset:27648
ds_read_b128 a[176:179], v2 offset:28672
v_mfma_f32_16x16x32_bf16 a[72:75], a[200:203], v[200:203], a[72:75]
v_exp_f32 v175, v175
v_mfma_f32_16x16x32_bf16 a[76:79], a[204:207], v[200:203], a[76:79]
v_exp_f32 v188, v188
v_mfma_f32_16x16x32_bf16 a[76:79], a[236:239], v[216:219], a[76:79]
buffer_store_dwordx4 v[128:131], v1, s[44:47], s70 offen sc1
v_mfma_f32_16x16x32_bf16 a[80:83], a[240:243], v[216:219], a[80:83]
s_waitcnt lgkmcnt(5)
ds_read_b128 a[180:183], v2 offset:29696
v_cvt_pk_bf16_f32 v221, v174, v175
v_mfma_f32_16x16x32_bf16 a[80:83], a[208:211], v[200:203], a[80:83]
v_exp_f32 v189, v189
v_mfma_f32_16x16x32_bf16 a[84:87], a[212:215], v[200:203], a[84:87]
ds_read_b128 a[184:187], v2 offset:30720
v_cvt_pk_bf16_f32 v222, v188, v189
v_mfma_f32_16x16x32_bf16 a[84:87], a[244:247], v[216:219], a[84:87]
v_exp_f32 v190, v190
v_mfma_f32_16x16x32_bf16 a[88:91], a[248:251], v[216:219], a[88:91]
buffer_load_dwordx4 v1, s[44:47], s72 offen offset:1024 sc1 lds
v_mfma_f32_16x16x32_bf16 a[88:91], a[216:219], v[200:203], a[88:91]
s_nop 0
ds_read_b128 a[188:191], v2 offset:31744
ds_read_b128 a[224:227], v2 offset:8192
v_mfma_f32_16x16x32_bf16 a[92:95], a[220:223], v[200:203], a[92:95]
v_exp_f32 v191, v191
v_mfma_f32_16x16x32_bf16 a[92:95], a[252:255], v[216:219], a[92:95]
v_exp_f32 v168, v168
v_mfma_f32_16x16x32_bf16 v[136:139], a[128:131], v[48:51], v[88:91]
ds_read_b128 a[228:231], v2 offset:9216
v_cvt_pk_bf16_f32 v223, v190, v191
v_mfma_f32_16x16x32_bf16 v[136:139], a[132:135], v[52:55], v[136:139]
v_exp_f32 v169, v169
v_mfma_f32_16x16x32_bf16 v[136:139], a[136:139], v[56:59], v[136:139]
buffer_store_dwordx4 v[144:147], v1, s[44:47], s70 offen offset:1024 sc1
v_mfma_f32_16x16x32_bf16 v[136:139], a[140:143], v[60:63], v[136:139]
ds_read_b128 a[232:235], v2 offset:10240
v_cvt_pk_bf16_f32 v216, v168, v169
v_mfma_f32_16x16x32_bf16 v[152:155], a[156:159], v[60:63], v[88:91]
v_exp_f32 v170, v170
v_mfma_f32_16x16x32_bf16 v[152:155], a[152:155], v[56:59], v[152:155]
s_nop 0
ds_read_b128 a[236:239], v2 offset:11264
ds_read_b128 a[240:243], v2 offset:12288
v_mfma_f32_16x16x32_bf16 v[152:155], a[148:151], v[52:55], v[152:155]
v_exp_f32 v171, v171
v_mfma_f32_16x16x32_bf16 v[152:155], a[144:147], v[48:51], v[152:155]
buffer_load_dwordx4 v1, s[44:47], s72 offen offset:2048 sc1 lds
v_mfma_f32_16x16x32_bf16 v[140:143], a[128:131], v[64:67], v[92:95]
v_exp_f32 v184, v184
v_mfma_f32_16x16x32_bf16 v[140:143], a[132:135], v[68:71], v[140:143]
ds_read_b128 a[244:247], v2 offset:13312
v_cvt_pk_bf16_f32 v217, v170, v171
v_mfma_f32_16x16x32_bf16 v[140:143], a[136:139], v[72:75], v[140:143]
v_exp_f32 v185, v185
v_mfma_f32_16x16x32_bf16 v[140:143], a[140:143], v[76:79], v[140:143]
s_nop 0
ds_read_b128 a[248:251], v2 offset:14336
ds_read_b128 a[252:255], v2 offset:15360
v_mfma_f32_16x16x32_bf16 v[156:159], a[156:159], v[76:79], v[92:95]
v_exp_f32 v186, v186
v_mfma_f32_16x16x32_bf16 v[156:159], a[152:155], v[72:75], v[156:159]
buffer_load_dwordx4 v1, s[44:47], s72 offen offset:3072 sc1 lds
v_mfma_f32_16x16x32_bf16 v[156:159], a[148:151], v[68:71], v[156:159]
s_waitcnt vmcnt(14) lgkmcnt(4)
v_exp_f32 v187, v187
v_mfma_f32_16x16x32_bf16 v[156:159], a[144:147], v[64:67], v[156:159]
s_barrier
v_cvt_pk_bf16_f32 v218, v184, v185
v_cvt_pk_bf16_f32 v219, v186, v187
v_add_u32 v2, s82, v1
v_mfma_f32_16x16x32_bf16 v[236:239], v[120:123], v[204:207], v[236:239]
s_xor_b32 s74, s82, 0x10000
v_exp_f32 v136, v136
v_mfma_f32_16x16x32_bf16 v[236:239], v[120:123], v[220:223], v[236:239]
s_add_u32 s74, s74, s64
ds_read_b128 a[128:131], v2 offset:16384
ds_read_b128 a[132:135], v2 offset:17408
v_mfma_f32_16x16x32_bf16 a[96:99], a[192:195], v[204:207], a[96:99]
s_add_u32 s81, s81, 0x8000
v_exp_f32 v137, v137
v_mfma_f32_16x16x32_bf16 a[96:99], a[224:227], v[220:223], a[96:99]
s_add_u32 m0, s74, 16384
v_exp_f32 v138, v138
v_mfma_f32_16x16x32_bf16 a[100:103], a[228:231], v[220:223], a[100:103]
s_add_u32 s72, s81, 16384
buffer_load_dwordx4 v1, s[44:47], s72 offen sc1 lds
v_mfma_f32_16x16x32_bf16 a[100:103], a[196:199], v[204:207], a[100:103]
ds_read_b128 a[136:139], v2 offset:18432
v_cvt_pk_bf16_f32 v200, v136, v137
v_mfma_f32_16x16x32_bf16 a[104:107], a[200:203], v[204:207], a[104:107]
v_exp_f32 v139, v139
v_mfma_f32_16x16x32_bf16 a[104:107], a[232:235], v[220:223], a[104:107]
ds_read_b128 a[140:143], v2 offset:19456
v_cvt_pk_bf16_f32 v201, v138, v139
v_mfma_f32_16x16x32_bf16 a[108:111], a[236:239], v[220:223], a[108:111]
buffer_store_dwordx4 v[160:163], v1, s[44:47], s70 offen offset:2048 sc1
v_mfma_f32_16x16x32_bf16 a[108:111], a[204:207], v[204:207], a[108:111]
v_exp_f32 v152, v152
v_mfma_f32_16x16x32_bf16 a[112:115], a[208:211], v[204:207], a[112:115]
s_waitcnt lgkmcnt(4)
ds_read_b128 a[144:147], v2 offset:20480
ds_read_b128 a[148:151], v2 offset:21504
v_mfma_f32_16x16x32_bf16 a[112:115], a[240:243], v[220:223], a[112:115]
v_exp_f32 v153, v153
v_mfma_f32_16x16x32_bf16 a[116:119], a[244:247], v[220:223], a[116:119]
buffer_load_dwordx4 v1, s[44:47], s72 offen offset:1024 sc1 lds
v_mfma_f32_16x16x32_bf16 a[116:119], a[212:215], v[204:207], a[116:119]
v_exp_f32 v154, v154
v_mfma_f32_16x16x32_bf16 a[120:123], a[216:219], v[204:207], a[120:123]
ds_read_b128 a[152:155], v2 offset:22528
v_cvt_pk_bf16_f32 v202, v152, v153
v_mfma_f32_16x16x32_bf16 a[120:123], a[248:251], v[220:223], a[120:123]
v_exp_f32 v155, v155
v_mfma_f32_16x16x32_bf16 a[124:127], a[252:255], v[220:223], a[124:127]
ds_read_b128 a[156:159], v2 offset:23552
v_cvt_pk_bf16_f32 v203, v154, v155
v_mfma_f32_16x16x32_bf16 a[124:127], a[220:223], v[204:207], a[124:127]
v_exp_f32 v140, v140
v_mfma_f32_16x16x32_bf16 v[172:175], a[160:163], v[64:67], v[92:95]
s_nop 0
ds_read_b128 a[192:195], v2 offset:0
ds_read_b128 a[196:199], v2 offset:1024
v_mfma_f32_16x16x32_bf16 v[172:175], a[164:167], v[68:71], v[172:175]
buffer_store_dwordx4 v[176:179], v1, s[44:47], s70 offen offset:3072 sc1
v_mfma_f32_16x16x32_bf16 v[172:175], a[168:171], v[72:75], v[172:175]
v_exp_f32 v141, v141
v_mfma_f32_16x16x32_bf16 v[172:175], a[172:175], v[76:79], v[172:175]
v_exp_f32 v142, v142
v_mfma_f32_16x16x32_bf16 v[188:191], a[188:191], v[76:79], v[92:95]
s_nop 0
ds_read_b128 a[200:203], v2 offset:2048
ds_read_b128 a[204:207], v2 offset:3072
v_mfma_f32_16x16x32_bf16 v[188:191], a[184:187], v[72:75], v[188:191]
buffer_load_dwordx4 v1, s[44:47], s72 offen offset:2048 sc1 lds
v_mfma_f32_16x16x32_bf16 v[188:191], a[180:183], v[68:71], v[188:191]
s_add_u32 s70, s70, 0x80000
v_exp_f32 v143, v143
v_mfma_f32_16x16x32_bf16 v[188:191], a[176:179], v[64:67], v[188:191]
v_exp_f32 v156, v156
v_mfma_f32_16x16x32_bf16 v[168:171], a[160:163], v[48:51], v[88:91]
s_nop 0
ds_read_b128 a[208:211], v2 offset:4096
ds_read_b128 a[212:215], v2 offset:5120
v_mfma_f32_16x16x32_bf16 v[168:171], a[164:167], v[52:55], v[168:171]
s_nop 0
ds_read_b128 a[216:219], v2 offset:6144
ds_read_b128 a[220:223], v2 offset:7168
v_mfma_f32_16x16x32_bf16 v[168:171], a[168:171], v[56:59], v[168:171]
v_cvt_pk_bf16_f32 v204, v140, v141
v_cvt_pk_bf16_f32 v205, v142, v143
v_mfma_f32_16x16x32_bf16 v[168:171], a[172:175], v[60:63], v[168:171]
buffer_store_dwordx4 v[132:135], v1, s[44:47], s70 offen sc1
v_mfma_f32_16x16x32_bf16 v[184:187], a[188:191], v[60:63], v[88:91]
v_exp_f32 v157, v157
v_mfma_f32_16x16x32_bf16 v[184:187], a[184:187], v[56:59], v[184:187]
v_exp_f32 v158, v158
v_mfma_f32_16x16x32_bf16 v[184:187], a[180:183], v[52:55], v[184:187]
buffer_load_dwordx4 v1, s[44:47], s72 offen offset:3072 sc1 lds
v_mfma_f32_16x16x32_bf16 v[184:187], a[176:179], v[48:51], v[184:187]
s_waitcnt lgkmcnt(4)
v_exp_f32 v159, v159
v_cvt_pk_bf16_f32 v206, v156, v157
v_cvt_pk_bf16_f32 v207, v158, v159
v_mfma_f32_16x16x32_bf16 v[232:235], v[120:123], v[216:219], v[232:235]
s_add_u32 s82, s82, 0x8000
ds_read_b128 a[160:163], v2 offset:24576
ds_read_b128 a[164:167], v2 offset:25600
v_mfma_f32_16x16x32_bf16 v[232:235], v[120:123], v[200:203], v[232:235]
s_and_b32 s82, s82, 0x1ffff
v_exp_f32 v172, v172
v_mfma_f32_16x16x32_bf16 a[64:67], a[224:227], v[216:219], a[64:67]
s_add_u32 m0, s74, 0
v_exp_f32 v173, v173
v_mfma_f32_16x16x32_bf16 a[64:67], a[192:195], v[200:203], a[64:67]
s_add_u32 s72, s81, 0
buffer_load_dwordx4 v1, s[44:47], s72 offen sc1 lds
v_mfma_f32_16x16x32_bf16 a[68:71], a[196:199], v[200:203], a[68:71]
ds_read_b128 a[168:171], v2 offset:26624
v_cvt_pk_bf16_f32 v220, v172, v173
v_mfma_f32_16x16x32_bf16 a[68:71], a[228:231], v[216:219], a[68:71]
v_exp_f32 v174, v174
v_mfma_f32_16x16x32_bf16 a[72:75], a[232:235], v[216:219], a[72:75]
s_nop 0
ds_read_b128 a[172:175], v2 offset:27648
ds_read_b128 a[176:179], v2 offset:28672
v_mfma_f32_16x16x32_bf16 a[72:75], a[200:203], v[200:203], a[72:75]
v_exp_f32 v175, v175
v_mfma_f32_16x16x32_bf16 a[76:79], a[204:207], v[200:203], a[76:79]
buffer_store_dwordx4 v[148:151], v1, s[44:47], s70 offen offset:1024 sc1
v_mfma_f32_16x16x32_bf16 a[76:79], a[236:239], v[216:219], a[76:79]
v_exp_f32 v188, v188
v_mfma_f32_16x16x32_bf16 a[80:83], a[240:243], v[216:219], a[80:83]
s_waitcnt lgkmcnt(5)
ds_read_b128 a[180:183], v2 offset:29696
v_cvt_pk_bf16_f32 v221, v174, v175
v_mfma_f32_16x16x32_bf16 a[80:83], a[208:211], v[200:203], a[80:83]
v_exp_f32 v189, v189
v_mfma_f32_16x16x32_bf16 a[84:87], a[212:215], v[200:203], a[84:87]
buffer_load_dwordx4 v1, s[44:47], s72 offen offset:1024 sc1 lds
v_mfma_f32_16x16x32_bf16 a[84:87], a[244:247], v[216:219], a[84:87]
ds_read_b128 a[184:187], v2 offset:30720
v_cvt_pk_bf16_f32 v222, v188, v189
v_mfma_f32_16x16x32_bf16 a[88:91], a[248:251], v[216:219], a[88:91]
v_exp_f32 v190, v190
v_mfma_f32_16x16x32_bf16 a[88:91], a[216:219], v[200:203], a[88:91]
s_nop 0
ds_read_b128 a[188:191], v2 offset:31744
ds_read_b128 a[224:227], v2 offset:8192
v_mfma_f32_16x16x32_bf16 a[92:95], a[220:223], v[200:203], a[92:95]
v_exp_f32 v191, v191
v_mfma_f32_16x16x32_bf16 a[92:95], a[252:255], v[216:219], a[92:95]
buffer_store_dwordx4 v[164:167], v1, s[44:47], s70 offen offset:2048 sc1
v_mfma_f32_16x16x32_bf16 v[136:139], a[128:131], v[48:51], v[88:91]
v_exp_f32 v168, v168
v_mfma_f32_16x16x32_bf16 v[136:139], a[132:135], v[52:55], v[136:139]
ds_read_b128 a[228:231], v2 offset:9216
v_cvt_pk_bf16_f32 v223, v190, v191
v_mfma_f32_16x16x32_bf16 v[136:139], a[136:139], v[56:59], v[136:139]
v_exp_f32 v169, v169
v_mfma_f32_16x16x32_bf16 v[136:139], a[140:143], v[60:63], v[136:139]
s_nop 0
ds_read_b128 a[232:235], v2 offset:10240
ds_read_b128 a[236:239], v2 offset:11264
v_mfma_f32_16x16x32_bf16 v[152:155], a[156:159], v[60:63], v[88:91]
v_exp_f32 v170, v170
v_mfma_f32_16x16x32_bf16 v[152:155], a[152:155], v[56:59], v[152:155]
buffer_load_dwordx4 v1, s[44:47], s72 offen offset:2048 sc1 lds
v_mfma_f32_16x16x32_bf16 v[152:155], a[148:151], v[52:55], v[152:155]
v_exp_f32 v171, v171
v_mfma_f32_16x16x32_bf16 v[152:155], a[144:147], v[48:51], v[152:155]
s_nop 0
ds_read_b128 a[240:243], v2 offset:12288
ds_read_b128 a[244:247], v2 offset:13312
v_mfma_f32_16x16x32_bf16 v[140:143], a[128:131], v[64:67], v[92:95]
v_exp_f32 v184, v184
v_mfma_f32_16x16x32_bf16 v[140:143], a[132:135], v[68:71], v[140:143]
s_nop 0
ds_read_b128 a[248:251], v2 offset:14336
ds_read_b128 a[252:255], v2 offset:15360
v_mfma_f32_16x16x32_bf16 v[140:143], a[136:139], v[72:75], v[140:143]
v_cvt_pk_bf16_f32 v216, v168, v169
v_cvt_pk_bf16_f32 v217, v170, v171
v_mfma_f32_16x16x32_bf16 v[140:143], a[140:143], v[76:79], v[140:143]
buffer_store_dwordx4 v[180:183], v1, s[44:47], s70 offen offset:3072 sc1
v_mfma_f32_16x16x32_bf16 v[156:159], a[156:159], v[76:79], v[92:95]
v_exp_f32 v185, v185
v_mfma_f32_16x16x32_bf16 v[156:159], a[152:155], v[72:75], v[156:159]
buffer_load_dwordx4 v1, s[44:47], s72 offen offset:3072 sc1 lds
v_mfma_f32_16x16x32_bf16 v[156:159], a[148:151], v[68:71], v[156:159]
s_waitcnt vmcnt(14) lgkmcnt(4)
v_exp_f32 v186, v186
v_mfma_f32_16x16x32_bf16 v[156:159], a[144:147], v[64:67], v[156:159]
s_barrier
v_exp_f32 v187, v187
v_add_u32 v2, s82, v1
v_cvt_pk_bf16_f32 v218, v184, v185
v_cvt_pk_bf16_f32 v219, v186, v187
s_lshl_b32 s83, s60, 2
s_sub_u32 s83, s83, 25
.p2align 5
s_nop 0
s_nop 0
LloopII:
v_mfma_f32_16x16x32_bf16 v[236:239], v[120:123], v[204:207], v[236:239]
s_xor_b32 s74, s82, 0x10000
v_exp_f32 v136, v136
v_mfma_f32_16x16x32_bf16 v[236:239], v[120:123], v[220:223], v[236:239]
s_add_u32 s74, s74, s64
ds_read_b128 a[128:131], v2 offset:16384
ds_read_b128 a[132:135], v2 offset:17408
v_mfma_f32_16x16x32_bf16 a[96:99], a[192:195], v[204:207], a[96:99]
s_add_u32 s81, s81, 0x8000
v_exp_f32 v137, v137
v_mfma_f32_16x16x32_bf16 a[96:99], a[224:227], v[220:223], a[96:99]
s_add_u32 m0, s74, 16384
v_exp_f32 v138, v138
v_mfma_f32_16x16x32_bf16 a[100:103], a[228:231], v[220:223], a[100:103]
s_add_u32 s72, s81, 16384
ds_read_b128 a[136:139], v2 offset:18432
v_cvt_pk_bf16_f32 v200, v136, v137
v_mfma_f32_16x16x32_bf16 a[100:103], a[196:199], v[204:207], a[100:103]
buffer_load_dwordx4 v1, s[44:47], s72 offen sc1 lds
v_mfma_f32_16x16x32_bf16 a[104:107], a[200:203], v[204:207], a[104:107]
v_exp_f32 v139, v139
v_mfma_f32_16x16x32_bf16 a[104:107], a[232:235], v[220:223], a[104:107]
ds_read_b128 a[140:143], v2 offset:19456
v_cvt_pk_bf16_f32 v201, v138, v139
v_mfma_f32_16x16x32_bf16 a[108:111], a[236:239], v[220:223], a[108:111]
v_exp_f32 v152, v152
v_mfma_f32_16x16x32_bf16 a[108:111], a[204:207], v[204:207], a[108:111]
s_nop 0
ds_read_b128 a[144:147], v2 offset:20480
ds_read_b128 a[148:151], v2 offset:21504
v_mfma_f32_16x16x32_bf16 a[112:115], a[208:211], v[204:207], a[112:115]
s_waitcnt lgkmcnt(6)
v_exp_f32 v153, v153
v_mfma_f32_16x16x32_bf16 a[112:115], a[240:243], v[220:223], a[112:115]
v_exp_f32 v154, v154
v_mfma_f32_16x16x32_bf16 a[116:119], a[244:247], v[220:223], a[116:119]
ds_read_b128 a[152:155], v2 offset:22528
v_cvt_pk_bf16_f32 v202, v152, v153
v_mfma_f32_16x16x32_bf16 a[116:119], a[212:215], v[204:207], a[116:119]
buffer_load_dwordx4 v1, s[44:47], s72 offen offset:1024 sc1 lds
v_mfma_f32_16x16x32_bf16 a[120:123], a[216:219], v[204:207], a[120:123]
v_exp_f32 v155, v155
v_mfma_f32_16x16x32_bf16 a[120:123], a[248:251], v[220:223], a[120:123]
ds_read_b128 a[156:159], v2 offset:23552
v_cvt_pk_bf16_f32 v203, v154, v155
v_mfma_f32_16x16x32_bf16 a[124:127], a[252:255], v[220:223], a[124:127]
v_exp_f32 v140, v140
v_mfma_f32_16x16x32_bf16 a[124:127], a[220:223], v[204:207], a[124:127]
s_nop 0
ds_read_b128 a[192:195], v2 offset:0
ds_read_b128 a[196:199], v2 offset:1024
v_mfma_f32_16x16x32_bf16 v[172:175], a[160:163], v[64:67], v[92:95]
v_exp_f32 v141, v141
v_mfma_f32_16x16x32_bf16 v[172:175], a[164:167], v[68:71], v[172:175]
v_exp_f32 v142, v142
v_mfma_f32_16x16x32_bf16 v[172:175], a[168:171], v[72:75], v[172:175]
ds_read_b128 a[200:203], v2 offset:2048
v_cvt_pk_bf16_f32 v204, v140, v141
v_mfma_f32_16x16x32_bf16 v[172:175], a[172:175], v[76:79], v[172:175]
buffer_load_dwordx4 v1, s[44:47], s72 offen offset:2048 sc1 lds
v_mfma_f32_16x16x32_bf16 v[188:191], a[188:191], v[76:79], v[92:95]
v_exp_f32 v143, v143
v_mfma_f32_16x16x32_bf16 v[188:191], a[184:187], v[72:75], v[188:191]
ds_read_b128 a[204:207], v2 offset:3072
v_cvt_pk_bf16_f32 v205, v142, v143
v_mfma_f32_16x16x32_bf16 v[188:191], a[180:183], v[68:71], v[188:191]
v_exp_f32 v156, v156
v_mfma_f32_16x16x32_bf16 v[188:191], a[176:179], v[64:67], v[188:191]
ds_read_b128 a[208:211], v2 offset:4096
v_mfma_f32_16x16x32_bf16 v[168:171], a[160:163], v[48:51], v[88:91]
v_exp_f32 v157, v157
v_mfma_f32_16x16x32_bf16 v[168:171], a[164:167], v[52:55], v[168:171]
ds_read_b128 a[212:215], v2 offset:5120
v_cvt_pk_bf16_f32 v206, v156, v157
v_mfma_f32_16x16x32_bf16 v[168:171], a[168:171], v[56:59], v[168:171]
v_exp_f32 v158, v158
v_mfma_f32_16x16x32_bf16 v[168:171], a[172:175], v[60:63], v[168:171]
ds_read_b128 a[216:219], v2 offset:6144
v_mfma_f32_16x16x32_bf16 v[184:187], a[188:191], v[60:63], v[88:91]
buffer_load_dwordx4 v1, s[44:47], s72 offen offset:3072 sc1 lds
v_mfma_f32_16x16x32_bf16 v[184:187], a[184:187], v[56:59], v[184:187]
v_exp_f32 v159, v159
v_mfma_f32_16x16x32_bf16 v[184:187], a[180:183], v[52:55], v[184:187]
ds_read_b128 a[220:223], v2 offset:7168
v_cvt_pk_bf16_f32 v207, v158, v159
v_mfma_f32_16x16x32_bf16 v[184:187], a[176:179], v[48:51], v[184:187]
s_waitcnt lgkmcnt(4)
v_mfma_f32_16x16x32_bf16 v[232:235], v[120:123], v[216:219], v[232:235]
s_add_u32 s82, s82, 0x8000
ds_read_b128 a[160:163], v2 offset:24576
ds_read_b128 a[164:167], v2 offset:25600
v_mfma_f32_16x16x32_bf16 v[232:235], v[120:123], v[200:203], v[232:235]
s_and_b32 s82, s82, 0x1ffff
v_exp_f32 v172, v172
v_mfma_f32_16x16x32_bf16 a[64:67], a[224:227], v[216:219], a[64:67]
s_add_u32 m0, s74, 0
v_exp_f32 v173, v173
v_mfma_f32_16x16x32_bf16 a[64:67], a[192:195], v[200:203], a[64:67]
s_add_u32 s72, s81, 0
ds_read_b128 a[168:171], v2 offset:26624
v_cvt_pk_bf16_f32 v220, v172, v173
v_mfma_f32_16x16x32_bf16 a[68:71], a[196:199], v[200:203], a[68:71]
v_exp_f32 v174, v174
v_mfma_f32_16x16x32_bf16 a[68:71], a[228:231], v[216:219], a[68:71]
buffer_load_dwordx4 v1, s[44:47], s72 offen sc1 lds
v_mfma_f32_16x16x32_bf16 a[72:75], a[232:235], v[216:219], a[72:75]
s_nop 0
ds_read_b128 a[172:175], v2 offset:27648
ds_read_b128 a[176:179], v2 offset:28672
v_mfma_f32_16x16x32_bf16 a[72:75], a[200:203], v[200:203], a[72:75]
v_exp_f32 v175, v175
v_mfma_f32_16x16x32_bf16 a[76:79], a[204:207], v[200:203], a[76:79]
v_exp_f32 v188, v188
v_mfma_f32_16x16x32_bf16 a[76:79], a[236:239], v[216:219], a[76:79]
ds_read_b128 a[180:183], v2 offset:29696
v_cvt_pk_bf16_f32 v221, v174, v175
v_mfma_f32_16x16x32_bf16 a[80:83], a[240:243], v[216:219], a[80:83]
s_waitcnt lgkmcnt(6)
v_exp_f32 v189, v189
v_mfma_f32_16x16x32_bf16 a[80:83], a[208:211], v[200:203], a[80:83]
ds_read_b128 a[184:187], v2 offset:30720
v_cvt_pk_bf16_f32 v222, v188, v189
v_mfma_f32_16x16x32_bf16 a[84:87], a[212:215], v[200:203], a[84:87]
buffer_load_dwordx4 v1, s[44:47], s72 offen offset:1024 sc1 lds
v_mfma_f32_16x16x32_bf16 a[84:87], a[244:247], v[216:219], a[84:87]
v_exp_f32 v190, v190
v_mfma_f32_16x16x32_bf16 a[88:91], a[248:251], v[216:219], a[88:91]
s_nop 0
ds_read_b128 a[188:191], v2 offset:31744
ds_read_b128 a[224:227], v2 offset:8192
v_mfma_f32_16x16x32_bf16 a[88:91], a[216:219], v[200:203], a[88:91]
v_exp_f32 v191, v191
v_mfma_f32_16x16x32_bf16 a[92:95], a[220:223], v[200:203], a[92:95]
v_exp_f32 v168, v168
v_mfma_f32_16x16x32_bf16 a[92:95], a[252:255], v[216:219], a[92:95]
ds_read_b128 a[228:231], v2 offset:9216
v_cvt_pk_bf16_f32 v223, v190, v191
v_mfma_f32_16x16x32_bf16 v[136:139], a[128:131], v[48:51], v[88:91]
v_exp_f32 v169, v169
v_mfma_f32_16x16x32_bf16 v[136:139], a[132:135], v[52:55], v[136:139]
ds_read_b128 a[232:235], v2 offset:10240
v_cvt_pk_bf16_f32 v216, v168, v169
v_mfma_f32_16x16x32_bf16 v[136:139], a[136:139], v[56:59], v[136:139]
buffer_load_dwordx4 v1, s[44:47], s72 offen offset:2048 sc1 lds
v_mfma_f32_16x16x32_bf16 v[136:139], a[140:143], v[60:63], v[136:139]
v_exp_f32 v170, v170
v_mfma_f32_16x16x32_bf16 v[152:155], a[156:159], v[60:63], v[88:91]
s_nop 0
ds_read_b128 a[236:239], v2 offset:11264
ds_read_b128 a[240:243], v2 offset:12288
v_mfma_f32_16x16x32_bf16 v[152:155], a[152:155], v[56:59], v[152:155]
v_exp_f32 v171, v171
v_mfma_f32_16x16x32_bf16 v[152:155], a[148:151], v[52:55], v[152:155]
v_exp_f32 v184, v184
v_mfma_f32_16x16x32_bf16 v[152:155], a[144:147], v[48:51], v[152:155]
ds_read_b128 a[244:247], v2 offset:13312
v_cvt_pk_bf16_f32 v217, v170, v171
v_mfma_f32_16x16x32_bf16 v[140:143], a[128:131], v[64:67], v[92:95]
v_exp_f32 v185, v185
v_mfma_f32_16x16x32_bf16 v[140:143], a[132:135], v[68:71], v[140:143]
ds_read_b128 a[248:251], v2 offset:14336
v_cvt_pk_bf16_f32 v218, v184, v185
v_mfma_f32_16x16x32_bf16 v[140:143], a[136:139], v[72:75], v[140:143]
buffer_load_dwordx4 v1, s[44:47], s72 offen offset:3072 sc1 lds
v_mfma_f32_16x16x32_bf16 v[140:143], a[140:143], v[76:79], v[140:143]
ds_read_b128 a[252:255], v2 offset:15360
v_add_u32 v2, s82, v1
v_mfma_f32_16x16x32_bf16 v[156:159], a[156:159], v[76:79], v[92:95]
s_waitcnt vmcnt(8) lgkmcnt(4)
v_exp_f32 v186, v186
v_mfma_f32_16x16x32_bf16 v[156:159], a[152:155], v[72:75], v[156:159]
s_barrier
v_exp_f32 v187, v187
v_mfma_f32_16x16x32_bf16 v[156:159], a[148:151], v[68:71], v[156:159]
s_add_u32 s83, s83, 1
v_cvt_pk_bf16_f32 v219, v186, v187
v_mfma_f32_16x16x32_bf16 v[156:159], a[144:147], v[64:67], v[156:159]
s_cbranch_scc0 LloopII
v_mfma_f32_16x16x32_bf16 v[236:239], v[120:123], v[204:207], v[236:239]
s_xor_b32 s74, s82, 0x10000
ds_read_b128 a[128:131], v2 offset:16384
ds_read_b128 a[132:135], v2 offset:17408
v_mfma_f32_16x16x32_bf16 v[236:239], v[120:123], v[220:223], v[236:239]
s_add_u32 s74, s74, s64
v_exp_f32 v136, v136
v_mfma_f32_16x16x32_bf16 a[96:99], a[192:195], v[204:207], a[96:99]
s_add_u32 s81, s81, 0x8000
v_exp_f32 v137, v137
v_mfma_f32_16x16x32_bf16 a[96:99], a[224:227], v[220:223], a[96:99]
s_add_u32 m0, s74, 0
ds_read_b128 a[136:139], v2 offset:18432
v_cvt_pk_bf16_f32 v200, v136, v137
v_mfma_f32_16x16x32_bf16 a[100:103], a[228:231], v[220:223], a[100:103]
s_add_u32 s72, s81, 0
v_exp_f32 v138, v138
v_mfma_f32_16x16x32_bf16 a[100:103], a[196:199], v[204:207], a[100:103]
buffer_load_dwordx4 v1, s[44:47], s72 offen sc1 lds
v_mfma_f32_16x16x32_bf16 a[104:107], a[200:203], v[204:207], a[104:107]
s_nop 0
ds_read_b128 a[140:143], v2 offset:19456
ds_read_b128 a[144:147], v2 offset:20480
v_mfma_f32_16x16x32_bf16 a[104:107], a[232:235], v[220:223], a[104:107]
v_exp_f32 v139, v139
v_mfma_f32_16x16x32_bf16 a[108:111], a[236:239], v[220:223], a[108:111]
v_exp_f32 v152, v152
v_mfma_f32_16x16x32_bf16 a[108:111], a[204:207], v[204:207], a[108:111]
ds_read_b128 a[148:151], v2 offset:21504
v_cvt_pk_bf16_f32 v201, v138, v139
v_mfma_f32_16x16x32_bf16 a[112:115], a[208:211], v[204:207], a[112:115]
s_waitcnt lgkmcnt(6)
v_exp_f32 v153, v153
v_mfma_f32_16x16x32_bf16 a[112:115], a[240:243], v[220:223], a[112:115]
ds_read_b128 a[152:155], v2 offset:22528
v_cvt_pk_bf16_f32 v202, v152, v153
v_mfma_f32_16x16x32_bf16 a[116:119], a[244:247], v[220:223], a[116:119]
v_exp_f32 v154, v154
v_mfma_f32_16x16x32_bf16 a[116:119], a[212:215], v[204:207], a[116:119]
buffer_load_dwordx4 v1, s[44:47], s72 offen offset:1024 sc1 lds
v_mfma_f32_16x16x32_bf16 a[120:123], a[216:219], v[204:207], a[120:123]
s_nop 0
ds_read_b128 a[156:159], v2 offset:23552
ds_read_b128 a[192:195], v2 offset:0
v_mfma_f32_16x16x32_bf16 a[120:123], a[248:251], v[220:223], a[120:123]
v_exp_f32 v155, v155
v_mfma_f32_16x16x32_bf16 a[124:127], a[252:255], v[220:223], a[124:127]
v_exp_f32 v140, v140
v_mfma_f32_16x16x32_bf16 a[124:127], a[220:223], v[204:207], a[124:127]
ds_read_b128 a[196:199], v2 offset:1024
v_cvt_pk_bf16_f32 v203, v154, v155
v_mfma_f32_16x16x32_bf16 v[172:175], a[160:163], v[64:67], v[92:95]
v_exp_f32 v141, v141
v_mfma_f32_16x16x32_bf16 v[172:175], a[164:167], v[68:71], v[172:175]
ds_read_b128 a[200:203], v2 offset:2048
v_cvt_pk_bf16_f32 v204, v140, v141
v_mfma_f32_16x16x32_bf16 v[172:175], a[168:171], v[72:75], v[172:175]
v_exp_f32 v142, v142
v_mfma_f32_16x16x32_bf16 v[172:175], a[172:175], v[76:79], v[172:175]
buffer_load_dwordx4 v1, s[44:47], s72 offen offset:2048 sc1 lds
v_mfma_f32_16x16x32_bf16 v[188:191], a[188:191], v[76:79], v[92:95]
ds_read_b128 a[204:207], v2 offset:3072
v_mfma_f32_16x16x32_bf16 v[188:191], a[184:187], v[72:75], v[188:191]
v_exp_f32 v143, v143
v_mfma_f32_16x16x32_bf16 v[188:191], a[180:183], v[68:71], v[188:191]
ds_read_b128 a[208:211], v2 offset:4096
v_cvt_pk_bf16_f32 v205, v142, v143
v_mfma_f32_16x16x32_bf16 v[188:191], a[176:179], v[64:67], v[188:191]
v_exp_f32 v156, v156
v_mfma_f32_16x16x32_bf16 v[168:171], a[160:163], v[48:51], v[88:91]
ds_read_b128 a[212:215], v2 offset:5120
v_mfma_f32_16x16x32_bf16 v[168:171], a[164:167], v[52:55], v[168:171]
Lstub6:
s_cbranch_execz Lstub10
v_exp_f32 v157, v157
v_mfma_f32_16x16x32_bf16 v[168:171], a[168:171], v[56:59], v[168:171]
ds_read_b128 a[216:219], v2 offset:6144
v_cvt_pk_bf16_f32 v206, v156, v157
v_mfma_f32_16x16x32_bf16 v[168:171], a[172:175], v[60:63], v[168:171]
buffer_load_dwordx4 v1, s[44:47], s72 offen offset:3072 sc1 lds
v_mfma_f32_16x16x32_bf16 v[184:187], a[188:191], v[60:63], v[88:91]
v_exp_f32 v158, v158
v_mfma_f32_16x16x32_bf16 v[184:187], a[184:187], v[56:59], v[184:187]
ds_read_b128 a[220:223], v2 offset:7168
v_mfma_f32_16x16x32_bf16 v[184:187], a[180:183], v[52:55], v[184:187]
s_waitcnt lgkmcnt(4)
v_exp_f32 v159, v159
v_mfma_f32_16x16x32_bf16 v[184:187], a[176:179], v[48:51], v[184:187]
s_barrier
v_cvt_pk_bf16_f32 v207, v158, v159
s_lshr_b32 s69, s93, 4
s_and_b32 s69, s69, 0x7f00
s_add_u32 s69, s69, LHT4-Lpc0
v_lshrrev_b32 v3, 5, v0
v_lshlrev_b32 v3, 7, v3
v_add_u32 v3, s69, v3
v_min_u32 v3, Lcode_end-Lpc0, v3
global_load_dword v4, v3, s[98:99]
v_mfma_f32_16x16x32_bf16 v[232:235], v[120:123], v[216:219], v[232:235]
s_add_u32 s82, s82, 0x8000
ds_read_b128 a[160:163], v2 offset:24576
ds_read_b128 a[164:167], v2 offset:25600
v_mfma_f32_16x16x32_bf16 v[232:235], v[120:123], v[200:203], v[232:235]
s_and_b32 s82, s82, 0x1ffff
v_exp_f32 v172, v172
v_mfma_f32_16x16x32_bf16 a[64:67], a[224:227], v[216:219], a[64:67]
s_add_u32 s66, s58, 3
v_exp_f32 v173, v173
v_mfma_f32_16x16x32_bf16 a[64:67], a[192:195], v[200:203], a[64:67]
s_and_b32 s66, s66, 3
ds_read_b128 a[168:171], v2 offset:26624
v_cvt_pk_bf16_f32 v220, v172, v173
v_mfma_f32_16x16x32_bf16 a[68:71], a[196:199], v[200:203], a[68:71]
s_mul_i32 s66, s66, 4160
v_exp_f32 v174, v174
v_mfma_f32_16x16x32_bf16 a[68:71], a[228:231], v[216:219], a[68:71]
s_add_u32 s66, s66, s92
ds_read_b128 a[172:175], v2 offset:27648
ds_read_b128 a[176:179], v2 offset:28672
v_mfma_f32_16x16x32_bf16 a[72:75], a[232:235], v[216:219], a[72:75]
s_add_u32 m0, s66, 32
v_exp_f32 v175, v175
v_mfma_f32_16x16x32_bf16 a[72:75], a[200:203], v[200:203], a[72:75]
s_add_u32 s72, s93, 0x6
buffer_load_dwordx4 v1, s[36:39], s72 offen lds
v_mfma_f32_16x16x32_bf16 a[76:79], a[204:207], v[200:203], a[76:79]
v_exp_f32 v188, v188
v_mfma_f32_16x16x32_bf16 a[76:79], a[236:239], v[216:219], a[76:79]
ds_read_b128 a[180:183], v2 offset:29696
v_cvt_pk_bf16_f32 v221, v174, v175
v_mfma_f32_16x16x32_bf16 a[80:83], a[240:243], v[216:219], a[80:83]
s_waitcnt lgkmcnt(6)
v_exp_f32 v189, v189
v_mfma_f32_16x16x32_bf16 a[80:83], a[208:211], v[200:203], a[80:83]
ds_read_b128 a[184:187], v2 offset:30720
v_cvt_pk_bf16_f32 v222, v188, v189
v_mfma_f32_16x16x32_bf16 a[84:87], a[212:215], v[200:203], a[84:87]
v_exp_f32 v190, v190
v_mfma_f32_16x16x32_bf16 a[84:87], a[244:247], v[216:219], a[84:87]
buffer_load_dwordx4 v1, s[36:39], s72 offen offset:1024 lds
v_mfma_f32_16x16x32_bf16 a[88:91], a[248:251], v[216:219], a[88:91]
s_nop 0
ds_read_b128 a[188:191], v2 offset:31744
ds_read_b128 a[224:227], v2 offset:8192
v_mfma_f32_16x16x32_bf16 a[88:91], a[216:219], v[200:203], a[88:91]
v_exp_f32 v191, v191
v_mfma_f32_16x16x32_bf16 a[92:95], a[220:223], v[200:203], a[92:95]
v_exp_f32 v168, v168
v_mfma_f32_16x16x32_bf16 a[92:95], a[252:255], v[216:219], a[92:95]
ds_read_b128 a[228:231], v2 offset:9216
v_cvt_pk_bf16_f32 v223, v190, v191
s_cmp_eq_u32 s58, 0
s_cbranch_scc1 Lta28
s_cmp_eq_u32 s58, 1
s_cbranch_scc1 Lnt29
v_mfma_f32_16x16x32_bf16 v[136:139], a[128:131], v[48:51], v[88:91]
v_exp_f32 v169, v169
v_mfma_f32_16x16x32_bf16 v[152:155], a[144:147], v[48:51], v[88:91]
ds_read_b128 a[232:235], v2 offset:10240
v_cvt_pk_bf16_f32 v216, v168, v169
s_branch Ljoin30
Lta28:
v_mfma_f32_16x16x32_bf16 v[136:139], a[128:131], v[48:51], v[104:107]
v_exp_f32 v169, v169
v_mfma_f32_16x16x32_bf16 v[152:155], a[144:147], v[48:51], v[112:115]
ds_read_b128 a[232:235], v2 offset:10240
v_cvt_pk_bf16_f32 v216, v168, v169
s_branch Ljoin30
Lnt29:
v_mfma_f32_16x16x32_bf16 v[136:139], a[128:131], v[48:51], v[88:91]
v_exp_f32 v169, v169
v_mfma_f32_16x16x32_bf16 v[152:155], a[144:147], v[48:51], v[104:107]
ds_read_b128 a[232:235], v2 offset:10240
v_cvt_pk_bf16_f32 v216, v168, v169
Ljoin30:
v_mfma_f32_16x16x32_bf16 v[136:139], a[132:135], v[52:55], v[136:139]
v_exp_f32 v170, v170
v_mfma_f32_16x16x32_bf16 v[136:139], a[136:139], v[56:59], v[136:139]
buffer_load_dwordx4 v1, s[36:39], s72 offen offset:2048 lds
v_mfma_f32_16x16x32_bf16 v[136:139], a[140:143], v[60:63], v[136:139]
ds_read_b128 a[236:239], v2 offset:11264
v_mfma_f32_16x16x32_bf16 v[152:155], a[156:159], v[60:63], v[152:155]
v_exp_f32 v171, v171
v_mfma_f32_16x16x32_bf16 v[152:155], a[152:155], v[56:59], v[152:155]
ds_read_b128 a[240:243], v2 offset:12288
v_cvt_pk_bf16_f32 v217, v170, v171
v_mfma_f32_16x16x32_bf16 v[152:155], a[148:151], v[52:55], v[152:155]
v_exp_f32 v184, v184
v_mfma_f32_16x16x32_bf16 v[140:143], a[128:131], v[64:67], v[92:95]
ds_read_b128 a[244:247], v2 offset:13312
v_mfma_f32_16x16x32_bf16 v[140:143], a[132:135], v[68:71], v[140:143]
v_exp_f32 v185, v185
v_mfma_f32_16x16x32_bf16 v[140:143], a[136:139], v[72:75], v[140:143]
ds_read_b128 a[248:251], v2 offset:14336
v_cvt_pk_bf16_f32 v218, v184, v185
v_mfma_f32_16x16x32_bf16 v[140:143], a[140:143], v[76:79], v[140:143]
buffer_load_dwordx4 v1, s[36:39], s72 offen offset:3072 lds
v_mfma_f32_16x16x32_bf16 v[156:159], a[156:159], v[76:79], v[92:95]
v_exp_f32 v186, v186
v_mfma_f32_16x16x32_bf16 v[156:159], a[152:155], v[72:75], v[156:159]
ds_read_b128 a[252:255], v2 offset:15360
v_add_u32 v2, s82, v1
v_mfma_f32_16x16x32_bf16 v[156:159], a[148:151], v[68:71], v[156:159]
s_waitcnt vmcnt(9) lgkmcnt(0)
v_exp_f32 v187, v187
v_mfma_f32_16x16x32_bf16 v[156:159], a[144:147], v[64:67], v[156:159]
s_barrier
v_cvt_pk_bf16_f32 v219, v186, v187
v_mfma_f32_16x16x32_bf16 v[236:239], v[120:123], v[204:207], v[236:239]
s_mov_b32 m0, s62
v_exp_f32 v136, v136
v_mfma_f32_16x16x32_bf16 v[236:239], v[120:123], v[220:223], v[236:239]
s_add_u32 s72, s93, 0x3000000
ds_read_b128 a[128:131], v2 offset:16384
ds_read_b128 a[132:135], v2 offset:17408
v_mfma_f32_16x16x32_bf16 a[96:99], a[192:195], v[204:207], a[96:99]
s_add_u32 s78, s59, 4
v_exp_f32 v137, v137
v_mfma_f32_16x16x32_bf16 a[96:99], a[224:227], v[220:223], a[96:99]
s_and_b32 s78, s78, 12
buffer_load_dwordx4 v1, s[44:47], s72 offen sc1 lds
v_mfma_f32_16x16x32_bf16 a[100:103], a[228:231], v[220:223], a[100:103]
s_and_b32 s12, s59, 16
v_exp_f32 v138, v138
v_mfma_f32_16x16x32_bf16 a[100:103], a[196:199], v[204:207], a[100:103]
s_or_b32 s78, s78, s12
ds_read_b128 a[136:139], v2 offset:18432
v_cvt_pk_bf16_f32 v200, v136, v137
v_mfma_f32_16x16x32_bf16 a[104:107], a[200:203], v[204:207], a[104:107]
s_add_u32 s12, s61, 0
v_exp_f32 v139, v139
v_mfma_f32_16x16x32_bf16 a[104:107], a[232:235], v[220:223], a[104:107]
s_and_b32 s12, s12, 3
ds_read_b128 a[140:143], v2 offset:19456
v_cvt_pk_bf16_f32 v201, v138, v139
v_mfma_f32_16x16x32_bf16 a[108:111], a[236:239], v[220:223], a[108:111]
s_add_u32 s12, s12, s78
v_exp_f32 v152, v152
v_mfma_f32_16x16x32_bf16 a[108:111], a[204:207], v[204:207], a[108:111]
s_lshl_b32 s12, s12, 18
ds_read_b128 a[144:147], v2 offset:20480
ds_read_b128 a[148:151], v2 offset:21504
v_mfma_f32_16x16x32_bf16 a[112:115], a[208:211], v[204:207], a[112:115]
s_waitcnt lgkmcnt(6)
buffer_load_dwordx4 v1, s[44:47], s72 offen offset:1024 sc1 lds
v_mfma_f32_16x16x32_bf16 a[112:115], a[240:243], v[220:223], a[112:115]
s_add_u32 s12, s12, s94
v_exp_f32 v153, v153
v_mfma_f32_16x16x32_bf16 a[116:119], a[244:247], v[220:223], a[116:119]
s_add_u32 s13, s61, 1
v_exp_f32 v154, v154
v_mfma_f32_16x16x32_bf16 a[116:119], a[212:215], v[204:207], a[116:119]
s_and_b32 s13, s13, 3
ds_read_b128 a[152:155], v2 offset:22528
v_cvt_pk_bf16_f32 v202, v152, v153
v_mfma_f32_16x16x32_bf16 a[120:123], a[216:219], v[204:207], a[120:123]
s_add_u32 s13, s13, s78
buffer_load_dwordx4 v1, s[44:47], s72 offen offset:2048 sc1 lds
v_mfma_f32_16x16x32_bf16 a[120:123], a[248:251], v[220:223], a[120:123]
s_lshl_b32 s13, s13, 18
v_exp_f32 v155, v155
v_mfma_f32_16x16x32_bf16 a[124:127], a[252:255], v[220:223], a[124:127]
s_add_u32 s13, s13, s94
ds_read_b128 a[156:159], v2 offset:23552
v_cvt_pk_bf16_f32 v203, v154, v155
v_mfma_f32_16x16x32_bf16 a[124:127], a[220:223], v[204:207], a[124:127]
s_add_u32 s14, s61, 2
v_exp_f32 v140, v140
s_cmp_eq_u32 s58, 2
s_cbranch_scc1 Lta31
s_cmp_eq_u32 s58, 3
s_cbranch_scc1 Lnt32
v_mfma_f32_16x16x32_bf16 v[168:171], a[160:163], v[48:51], v[112:115]
s_and_b32 s14, s14, 3
ds_read_b128 a[192:195], v2 offset:0
ds_read_b128 a[196:199], v2 offset:1024
v_mfma_f32_16x16x32_bf16 v[184:187], a[176:179], v[48:51], v[112:115]
s_add_u32 s14, s14, s78
v_exp_f32 v141, v141
s_branch Ljoin33
Lta31:
v_mfma_f32_16x16x32_bf16 v[168:171], a[160:163], v[48:51], v[104:107]
s_and_b32 s14, s14, 3
ds_read_b128 a[192:195], v2 offset:0
ds_read_b128 a[196:199], v2 offset:1024
v_mfma_f32_16x16x32_bf16 v[184:187], a[176:179], v[48:51], v[112:115]
s_add_u32 s14, s14, s78
v_exp_f32 v141, v141
s_branch Ljoin33
Lnt32:
v_mfma_f32_16x16x32_bf16 v[168:171], a[160:163], v[48:51], v[88:91]
s_and_b32 s14, s14, 3
ds_read_b128 a[192:195], v2 offset:0
ds_read_b128 a[196:199], v2 offset:1024
v_mfma_f32_16x16x32_bf16 v[184:187], a[176:179], v[48:51], v[104:107]
s_add_u32 s14, s14, s78
v_exp_f32 v141, v141
Ljoin33:
v_mfma_f32_16x16x32_bf16 v[172:175], a[160:163], v[64:67], v[92:95]
s_lshl_b32 s14, s14, 18
buffer_load_dwordx4 v1, s[44:47], s72 offen offset:3072 sc1 lds
v_mfma_f32_16x16x32_bf16 v[172:175], a[164:167], v[68:71], v[172:175]
s_add_u32 s66, s58, 0
v_exp_f32 v142, v142
v_mfma_f32_16x16x32_bf16 v[172:175], a[168:171], v[72:75], v[172:175]
s_and_b32 s66, s66, 3
ds_read_b128 a[200:203], v2 offset:2048
v_cvt_pk_bf16_f32 v204, v140, v141
v_mfma_f32_16x16x32_bf16 v[172:175], a[172:175], v[76:79], v[172:175]
s_mul_i32 s66, s66, 4160
v_exp_f32 v143, v143
v_mfma_f32_16x16x32_bf16 v[188:191], a[188:191], v[76:79], v[92:95]
s_add_u32 s66, s66, s92
ds_read_b128 a[204:207], v2 offset:3072
v_cvt_pk_bf16_f32 v205, v142, v143
v_mfma_f32_16x16x32_bf16 v[188:191], a[184:187], v[72:75], v[188:191]
s_add_u32 m0, s66, 16672
v_exp_f32 v156, v156
v_mfma_f32_16x16x32_bf16 v[188:191], a[180:183], v[68:71], v[188:191]
s_add_u32 s72, s93, 0x0
ds_read_b128 a[208:211], v2 offset:4096
ds_read_b128 a[212:215], v2 offset:5120
v_mfma_f32_16x16x32_bf16 v[188:191], a[176:179], v[64:67], v[188:191]
s_add_u32 s14, s14, s94
buffer_load_dwordx4 v1, s[36:39], s72 offen lds
v_mfma_f32_16x16x32_bf16 v[168:171], a[164:167], v[52:55], v[168:171]
s_add_u32 s15, s61, 3
v_exp_f32 v157, v157
v_mfma_f32_16x16x32_bf16 v[168:171], a[168:171], v[56:59], v[168:171]
s_and_b32 s15, s15, 3
v_exp_f32 v158, v158
v_mfma_f32_16x16x32_bf16 v[168:171], a[172:175], v[60:63], v[168:171]
s_add_u32 s15, s15, s78
ds_read_b128 a[216:219], v2 offset:6144
ds_read_b128 a[220:223], v2 offset:7168
v_mfma_f32_16x16x32_bf16 v[184:187], a[188:191], v[60:63], v[184:187]
s_lshl_b32 s15, s15, 18
buffer_load_dwordx4 v1, s[36:39], s72 offen offset:1024 lds
v_mfma_f32_16x16x32_bf16 v[184:187], a[184:187], v[56:59], v[184:187]
s_add_u32 s15, s15, s94
v_exp_f32 v159, v159
v_mfma_f32_16x16x32_bf16 v[184:187], a[180:183], v[52:55], v[184:187]
s_waitcnt lgkmcnt(4)
v_cvt_pk_bf16_f32 v206, v156, v157
v_cvt_pk_bf16_f32 v207, v158, v159
v_mfma_f32_16x16x32_bf16 v[232:235], v[120:123], v[216:219], v[232:235]
s_add_u32 s82, s82, 0x8000
ds_read_b128 a[160:163], v2 offset:24576
ds_read_b128 a[164:167], v2 offset:25600
v_mfma_f32_16x16x32_bf16 v[232:235], v[120:123], v[200:203], v[232:235]
s_and_b32 s82, s82, 0x1ffff
v_exp_f32 v172, v172
v_mfma_f32_16x16x32_bf16 a[64:67], a[224:227], v[216:219], a[64:67]
v_exp_f32 v173, v173
v_mfma_f32_16x16x32_bf16 a[64:67], a[192:195], v[200:203], a[64:67]
s_nop 0
ds_read_b128 a[168:171], v2 offset:26624
ds_read_b128 a[172:175], v2 offset:27648
v_mfma_f32_16x16x32_bf16 a[68:71], a[196:199], v[200:203], a[68:71]
v_exp_f32 v174, v174
v_mfma_f32_16x16x32_bf16 a[68:71], a[228:231], v[216:219], a[68:71]
v_exp_f32 v175, v175
v_mfma_f32_16x16x32_bf16 a[72:75], a[232:235], v[216:219], a[72:75]
s_nop 0
ds_read_b128 a[176:179], v2 offset:28672
ds_read_b128 a[180:183], v2 offset:29696
v_mfma_f32_16x16x32_bf16 a[72:75], a[200:203], v[200:203], a[72:75]
v_exp_f32 v188, v188
v_mfma_f32_16x16x32_bf16 a[76:79], a[204:207], v[200:203], a[76:79]
s_nop 0
ds_read_b128 a[184:187], v2 offset:30720
ds_read_b128 a[188:191], v2 offset:31744
v_mfma_f32_16x16x32_bf16 a[76:79], a[236:239], v[216:219], a[76:79]
s_nop 0
ds_read_b128 a[224:227], v2 offset:8192
ds_read_b128 a[228:231], v2 offset:9216
v_mfma_f32_16x16x32_bf16 a[80:83], a[240:243], v[216:219], a[80:83]
s_waitcnt lgkmcnt(10)
ds_read_b128 a[232:235], v2 offset:10240
ds_read_b128 a[236:239], v2 offset:11264
v_mfma_f32_16x16x32_bf16 a[80:83], a[208:211], v[200:203], a[80:83]
ds_read_b128 a[240:243], v2 offset:12288
v_cvt_pk_bf16_f32 v220, v172, v173
v_mfma_f32_16x16x32_bf16 a[84:87], a[212:215], v[200:203], a[84:87]
buffer_load_dwordx4 v1, s[36:39], s72 offen offset:2048 lds
v_mfma_f32_16x16x32_bf16 a[84:87], a[244:247], v[216:219], a[84:87]
v_exp_f32 v189, v189
v_mfma_f32_16x16x32_bf16 a[88:91], a[248:251], v[216:219], a[88:91]
v_exp_f32 v190, v190
v_mfma_f32_16x16x32_bf16 a[88:91], a[216:219], v[200:203], a[88:91]
s_nop 0
ds_read_b128 a[244:247], v2 offset:13312
ds_read_b128 a[248:251], v2 offset:14336
v_mfma_f32_16x16x32_bf16 a[92:95], a[220:223], v[200:203], a[92:95]
v_cvt_pk_bf16_f32 v221, v174, v175
v_cvt_pk_bf16_f32 v222, v188, v189
v_mfma_f32_16x16x32_bf16 a[92:95], a[252:255], v[216:219], a[92:95]
v_exp_f32 v191, v191
s_cmp_eq_u32 s58, 0
s_cbranch_scc1 Lta34
s_cmp_eq_u32 s58, 1
s_cbranch_scc1 Lnt35
v_mfma_f32_16x16x32_bf16 v[140:143], a[128:131], v[64:67], v[92:95]
v_exp_f32 v168, v168
v_mfma_f32_16x16x32_bf16 v[156:159], a[144:147], v[64:67], v[92:95]
v_exp_f32 v169, v169
s_branch Ljoin36
Lta34:
v_mfma_f32_16x16x32_bf16 v[140:143], a[128:131], v[64:67], v[108:111]
v_exp_f32 v168, v168
v_mfma_f32_16x16x32_bf16 v[156:159], a[144:147], v[64:67], v[112:115]
v_exp_f32 v169, v169
s_branch Ljoin36
Lnt35:
v_mfma_f32_16x16x32_bf16 v[140:143], a[128:131], v[64:67], v[92:95]
v_exp_f32 v168, v168
v_mfma_f32_16x16x32_bf16 v[156:159], a[144:147], v[64:67], v[108:111]
v_exp_f32 v169, v169
Ljoin36:
v_mfma_f32_16x16x32_bf16 v[140:143], a[132:135], v[68:71], v[140:143]
v_exp_f32 v170, v170
v_mfma_f32_16x16x32_bf16 v[140:143], a[136:139], v[72:75], v[140:143]
ds_read_b128 a[252:255], v2 offset:15360
v_cvt_pk_bf16_f32 v223, v190, v191
v_mfma_f32_16x16x32_bf16 v[140:143], a[140:143], v[76:79], v[140:143]
v_exp_f32 v171, v171
v_mfma_f32_16x16x32_bf16 v[156:159], a[156:159], v[76:79], v[156:159]
buffer_load_dwordx4 v1, s[36:39], s72 offen offset:3072 lds
v_mfma_f32_16x16x32_bf16 v[156:159], a[152:155], v[72:75], v[156:159]
s_waitcnt vmcnt(13) lgkmcnt(4)
v_exp_f32 v184, v184
v_mfma_f32_16x16x32_bf16 v[156:159], a[148:151], v[68:71], v[156:159]
s_barrier
v_cvt_pk_bf16_f32 v216, v168, v169
v_cvt_pk_bf16_f32 v217, v170, v171
v_add_u32 v2, s82, v1
v_exp_f32 v185, v185
v_exp_f32 v186, v186
v_cvt_pk_bf16_f32 v218, v184, v185
v_exp_f32 v187, v187
s_nop 0
v_cvt_pk_bf16_f32 v219, v186, v187
v_mfma_f32_16x16x32_bf16 v[236:239], v[120:123], v[204:207], v[236:239]
s_add_u32 s66, s58, 2
v_exp_f32 v140, v140
v_mfma_f32_16x16x32_bf16 v[236:239], v[120:123], v[220:223], v[236:239]
s_and_b32 s66, s66, 3
v_exp_f32 v141, v141
v_mfma_f32_16x16x32_bf16 a[96:99], a[192:195], v[204:207], a[96:99]
s_mul_i32 s66, s66, 4160
ds_read_b128 a[192:195], v2 offset:0
v_mfma_f32_16x16x32_bf16 a[96:99], a[224:227], v[220:223], a[96:99]
s_add_u32 s66, s66, s92
v_exp_f32 v142, v142
v_mfma_f32_16x16x32_bf16 a[100:103], a[228:231], v[220:223], a[100:103]
s_add_u32 m0, s66, 33312
v_exp_f32 v143, v143
v_mfma_f32_16x16x32_bf16 a[100:103], a[196:199], v[204:207], a[100:103]
s_add_u32 s72, s93, 0x4
buffer_load_dwordx4 v1, s[36:39], s72 offen lds
v_mfma_f32_16x16x32_bf16 a[104:107], a[200:203], v[204:207], a[104:107]
ds_read_b128 a[196:199], v2 offset:1024
v_mfma_f32_16x16x32_bf16 a[104:107], a[232:235], v[220:223], a[104:107]
buffer_load_dwordx4 v1, s[36:39], s72 offen offset:1024 lds
v_mfma_f32_16x16x32_bf16 a[108:111], a[236:239], v[220:223], a[108:111]
ds_read_b128 a[200:203], v2 offset:2048
v_mfma_f32_16x16x32_bf16 a[108:111], a[204:207], v[204:207], a[108:111]
buffer_load_dwordx4 v1, s[36:39], s72 offen offset:2048 lds
v_mfma_f32_16x16x32_bf16 a[112:115], a[208:211], v[204:207], a[112:115]
s_waitcnt lgkmcnt(3)
ds_read_b128 a[204:207], v2 offset:3072
v_mfma_f32_16x16x32_bf16 a[112:115], a[240:243], v[220:223], a[112:115]
buffer_load_dwordx4 v1, s[36:39], s72 offen offset:3072 lds
v_mfma_f32_16x16x32_bf16 a[116:119], a[244:247], v[220:223], a[116:119]
v_exp_f32 v156, v156
v_mfma_f32_16x16x32_bf16 a[116:119], a[212:215], v[204:207], a[116:119]
ds_read_b128 a[208:211], v2 offset:4096
v_mfma_f32_16x16x32_bf16 a[120:123], a[216:219], v[204:207], a[120:123]
buffer_load_dwordx4 v[80:83], v15, s[4:7], s80 offen
v_mfma_f32_16x16x32_bf16 a[120:123], a[248:251], v[220:223], a[120:123]
s_add_u32 s80, s80, 0x4000
v_exp_f32 v157, v157
v_mfma_f32_16x16x32_bf16 a[124:127], a[252:255], v[220:223], a[124:127]
ds_read_b128 a[212:215], v2 offset:5120
v_mfma_f32_16x16x32_bf16 a[124:127], a[220:223], v[204:207], a[124:127]
ds_read_b128 a[216:219], v2 offset:6144
v_cvt_pk_bf16_f32 v204, v140, v141
s_cmp_eq_u32 s58, 2
s_cbranch_scc1 Lta37
s_cmp_eq_u32 s58, 3
s_cbranch_scc1 Lnt38
v_mfma_f32_16x16x32_bf16 v[172:175], a[160:163], v[64:67], v[112:115]
buffer_load_dwordx4 v[84:87], v15, s[4:7], s80 offen
v_mfma_f32_16x16x32_bf16 v[188:191], a[176:179], v[64:67], v[112:115]
s_add_u32 s80, s80, 0x4000
v_exp_f32 v158, v158
s_branch Ljoin39
Lta37:
v_mfma_f32_16x16x32_bf16 v[172:175], a[160:163], v[64:67], v[108:111]
buffer_load_dwordx4 v[84:87], v15, s[4:7], s80 offen
v_mfma_f32_16x16x32_bf16 v[188:191], a[176:179], v[64:67], v[112:115]
s_add_u32 s80, s80, 0x4000
v_exp_f32 v158, v158
s_branch Ljoin39
Lnt38:
v_mfma_f32_16x16x32_bf16 v[172:175], a[160:163], v[64:67], v[92:95]
buffer_load_dwordx4 v[84:87], v15, s[4:7], s80 offen
v_mfma_f32_16x16x32_bf16 v[188:191], a[176:179], v[64:67], v[108:111]
s_add_u32 s80, s80, 0x4000
v_exp_f32 v158, v158
Ljoin39:
v_mfma_f32_16x16x32_bf16 v[172:175], a[164:167], v[68:71], v[172:175]
ds_read_b128 a[220:223], v2 offset:7168
v_cvt_pk_bf16_f32 v205, v142, v143
v_mfma_f32_16x16x32_bf16 v[172:175], a[168:171], v[72:75], v[172:175]
buffer_load_dwordx4 v[96:99], v15, s[4:7], s80 offen
v_mfma_f32_16x16x32_bf16 v[172:175], a[172:175], v[76:79], v[172:175]
s_add_u32 s80, s80, 0x4000
v_exp_f32 v159, v159
v_mfma_f32_16x16x32_bf16 v[188:191], a[188:191], v[76:79], v[188:191]
buffer_load_dwordx4 v[100:103], v15, s[4:7], s80 offen
v_mfma_f32_16x16x32_bf16 v[188:191], a[184:187], v[72:75], v[188:191]
v_cvt_pk_bf16_f32 v206, v156, v157
v_cvt_pk_bf16_f32 v207, v158, v159
v_mfma_f32_16x16x32_bf16 v[188:191], a[180:183], v[68:71], v[188:191]
s_waitcnt lgkmcnt(4)
v_mfma_f32_16x16x32_bf16 v[232:235], v[120:123], v[216:219], v[232:235]
s_add_u32 s82, s82, 0x8000
v_exp_f32 v172, v172
v_mfma_f32_16x16x32_bf16 a[64:67], a[224:227], v[216:219], a[64:67]
s_and_b32 s82, s82, 0x1ffff
ds_read_b128 a[224:227], v2 offset:8192
v_mfma_f32_16x16x32_bf16 a[68:71], a[228:231], v[216:219], a[68:71]
ds_read_b128 a[228:231], v2 offset:9216
v_mfma_f32_16x16x32_bf16 a[72:75], a[232:235], v[216:219], a[72:75]
v_exp_f32 v173, v173
v_mfma_f32_16x16x32_bf16 a[76:79], a[236:239], v[216:219], a[76:79]
s_nop 0
ds_read_b128 a[232:235], v2 offset:10240
ds_read_b128 a[236:239], v2 offset:11264
v_mfma_f32_16x16x32_bf16 a[80:83], a[240:243], v[216:219], a[80:83]
ds_read_b128 a[240:243], v2 offset:12288
v_cvt_pk_bf16_f32 v220, v172, v173
v_mfma_f32_16x16x32_bf16 a[84:87], a[244:247], v[216:219], a[84:87]
ds_read_b128 a[244:247], v2 offset:13312
v_mfma_f32_16x16x32_bf16 a[88:91], a[248:251], v[216:219], a[88:91]
v_exp_f32 v174, v174
v_mfma_f32_16x16x32_bf16 a[92:95], a[252:255], v[216:219], a[92:95]
v_exp_f32 v175, v175
ds_read_b128 a[248:251], v2 offset:14336
ds_read_b128 a[252:255], v2 offset:15360
v_add_u32 v2, s82, v1
v_exp_f32 v188, v188
v_cvt_pk_bf16_f32 v221, v174, v175
v_exp_f32 v189, v189
v_exp_f32 v190, v190
v_cvt_pk_bf16_f32 v222, v188, v189
v_exp_f32 v191, v191
s_nop 0
v_cvt_pk_bf16_f32 v223, v190, v191
s_waitcnt vmcnt(4) lgkmcnt(0)
s_barrier
LHT4:
Lstub7:
s_cbranch_execz Lstub11
v_mfma_f32_16x16x32_bf16 v[236:239], v[120:123], v[204:207], v[236:239]
ds_write_b64 v5, v[12:13]
v_mov_b32 v240, 0
v_mfma_f32_16x16x32_bf16 v[236:239], v[120:123], v[220:223], v[236:239]
v_mov_b32 v241, 0
v_mfma_f32_16x16x32_bf16 a[96:99], a[192:195], v[204:207], a[96:99]
s_nop 0
ds_write_b64 v14, v[240:241]
ds_read_b64 a[128:129], v6 offset:0
v_mfma_f32_16x16x32_bf16 a[96:99], a[224:227], v[220:223], a[96:99]
s_nop 0
ds_read_b64 a[130:131], v6 offset:8
ds_read_b128 a[192:195], v7 offset:3584
v_mfma_f32_16x16x32_bf16 a[100:103], a[228:231], v[220:223], a[100:103]
s_nop 0
ds_read_b64 a[132:133], v6 offset:512
ds_read_b64 a[134:135], v6 offset:520
v_mfma_f32_16x16x32_bf16 a[100:103], a[196:199], v[204:207], a[100:103]
s_nop 0
ds_read_b128 a[196:199], v7 offset:3072
ds_read_b64 a[136:137], v6 offset:1024
v_mfma_f32_16x16x32_bf16 a[104:107], a[200:203], v[204:207], a[104:107]
s_nop 0
ds_read_b64 a[138:139], v6 offset:1032
ds_read_b128 a[200:203], v7 offset:2560
v_mfma_f32_16x16x32_bf16 a[104:107], a[232:235], v[220:223], a[104:107]
v_mfma_f32_16x16x32_bf16 a[108:111], a[236:239], v[220:223], a[108:111]
s_nop 0
ds_read_b64 a[140:141], v6 offset:1536
ds_read_b64 a[142:143], v6 offset:1544
v_mfma_f32_16x16x32_bf16 a[108:111], a[204:207], v[204:207], a[108:111]
s_nop 0
ds_read_b128 a[204:207], v7 offset:2048
ds_read_b64 a[144:145], v6 offset:2048
v_mfma_f32_16x16x32_bf16 a[112:115], a[208:211], v[204:207], a[112:115]
s_lshl_b32 s73, s59, 12
ds_read_b64 a[146:147], v6 offset:2056
ds_read_b128 a[208:211], v7 offset:1536
v_mfma_f32_16x16x32_bf16 a[112:115], a[240:243], v[220:223], a[112:115]
s_add_u32 s73, s73, 0x2000000
v_mfma_f32_16x16x32_bf16 a[116:119], a[244:247], v[220:223], a[116:119]
s_lshl_b32 s70, s68, 2
ds_read_b64 a[148:149], v6 offset:2560
ds_read_b64 a[150:151], v6 offset:2568
v_mfma_f32_16x16x32_bf16 a[116:119], a[212:215], v[204:207], a[116:119]
s_add_u32 s70, s70, s73
ds_read_b128 a[212:215], v7 offset:1024
ds_read_b64 a[152:153], v6 offset:3072
v_mfma_f32_16x16x32_bf16 a[120:123], a[216:219], v[204:207], a[120:123]
s_nop 0
ds_read_b64 a[154:155], v6 offset:3080
ds_read_b128 a[216:219], v7 offset:512
v_mfma_f32_16x16x32_bf16 a[120:123], a[248:251], v[220:223], a[120:123]
v_mfma_f32_16x16x32_bf16 a[124:127], a[252:255], v[220:223], a[124:127]
s_xor_b32 s71, s12, 0x80
ds_read_b64 a[156:157], v6 offset:3584
ds_read_b64 a[158:159], v6 offset:3592
v_mfma_f32_16x16x32_bf16 a[124:127], a[220:223], v[204:207], a[124:127]
s_add_u32 m0, s77, 0
ds_read_b128 a[220:223], v7 offset:0
s_waitcnt lgkmcnt(0)
v_mfma_f32_16x16x32_bf16 v[128:131], v[8:11], a[192:195], 0
s_add_u32 s72, s71, 0
buffer_load_dwordx4 v15, s[24:27], s72 offen lds
v_mfma_f32_16x16x32_bf16 v[128:131], a[128:131], a[192:195], v[128:131]
v_mfma_f32_16x16x32_bf16 v[132:135], v[8:11], a[196:199], 0
s_nop 0
ds_read_b128 a[224:227], v7 offset:3648
ds_read_b64 a[160:161], v6 offset:64
v_mfma_f32_16x16x32_bf16 v[132:135], a[128:131], a[196:199], v[132:135]
v_accvgpr_read_b32 v240, a64
v_accvgpr_read_b32 v241, a65
v_accvgpr_read_b32 v242, a66
v_mfma_f32_16x16x32_bf16 v[132:135], a[132:135], a[192:195], v[132:135]
s_add_u32 s72, s71, 15360
buffer_load_dwordx4 v15, s[24:27], s72 offen offset:1024 lds
v_accvgpr_read_b32 v243, a67
v_mfma_f32_16x16x32_bf16 v[136:139], v[8:11], a[200:203], 0
s_nop 0
ds_read_b64 a[162:163], v6 offset:72
ds_read_b128 a[228:231], v7 offset:3136
v_mfma_f32_16x16x32_bf16 v[136:139], a[128:131], a[200:203], v[136:139]
s_lshl_b32 s95, s75, 20
v_rcp_f32 v232, v232
v_mfma_f32_16x16x32_bf16 v[136:139], a[132:135], a[196:199], v[136:139]
s_lshl_b32 s74, s58, 18
v_rcp_f32 v236, v236
v_accvgpr_read_b32 v244, a68
v_mfma_f32_16x16x32_bf16 v[136:139], a[136:139], a[192:195], v[136:139]
s_add_u32 s95, s95, s74
ds_read_b64 a[164:165], v6 offset:576
ds_read_b64 a[166:167], v6 offset:584
v_accvgpr_read_b32 v245, a69
v_mfma_f32_16x16x32_bf16 v[140:143], v[8:11], a[204:207], 0
s_add_u32 s72, s71, 30720
buffer_load_dwordx4 v15, s[24:27], s72 offen offset:2048 lds
v_accvgpr_read_b32 v246, a70
v_mfma_f32_16x16x32_bf16 v[140:143], a[128:131], a[204:207], v[140:143]
s_add_u32 s95, s95, 0x2000000
v_accvgpr_read_b32 v247, a71
v_mul_f32 v240, v240, v232
v_mul_f32 v241, v241, v232
v_mfma_f32_16x16x32_bf16 v[140:143], a[132:135], a[200:203], v[140:143]
s_sub_u32 s74, 15, s75
ds_read_b128 a[232:235], v7 offset:2624
ds_read_b64 a[168:169], v6 offset:1088
v_mul_f32 v242, v242, v232
v_mfma_f32_16x16x32_bf16 v[140:143], a[136:139], a[196:199], v[140:143]
s_add_u32 s72, s71, 46080
buffer_load_dwordx4 v15, s[24:27], s72 offen offset:3072 lds
v_mul_f32 v243, v243, v232
v_mfma_f32_16x16x32_bf16 v[140:143], a[140:143], a[192:195], v[140:143]
s_min_u32 s74, s74, s75
v_mul_f32 v244, v244, v232
v_mul_f32 v245, v245, v232
v_mul_f32 v246, v246, v232
v_mfma_f32_16x16x32_bf16 v[144:147], v[8:11], a[208:211], 0
s_lshl_b32 s74, s74, 7
ds_read_b64 a[170:171], v6 offset:1096
ds_read_b128 a[236:239], v7 offset:2112
v_mul_f32 v247, v247, v232
v_mfma_f32_16x16x32_bf16 v[144:147], a[128:131], a[208:211], v[144:147]
s_add_u32 s74, s74, 0x3810000
v_cvt_pk_bf16_f32 v240, v240, v241
v_cvt_pk_bf16_f32 v241, v242, v243
v_cvt_pk_bf16_f32 v242, v244, v245
v_mfma_f32_16x16x32_bf16 v[144:147], a[132:135], a[204:207], v[144:147]
s_xor_b32 s85, s77, 0x10000
v_cvt_pk_bf16_f32 v243, v246, v247
v_mfma_f32_16x16x32_bf16 v[144:147], a[136:139], a[200:203], v[144:147]
s_nop 0
ds_read_b64 a[172:173], v6 offset:1600
ds_read_b64 a[174:175], v6 offset:1608
v_mfma_f32_16x16x32_bf16 v[144:147], a[140:143], a[196:199], v[144:147]
buffer_store_dwordx4 v[240:243], v1, s[44:47], s70 offen sc1
v_mfma_f32_16x16x32_bf16 v[144:147], a[144:147], a[192:195], v[144:147]
v_accvgpr_read_b32 v248, a72
v_accvgpr_read_b32 v249, a73
v_accvgpr_read_b32 v250, a74
v_mfma_f32_16x16x32_bf16 v[148:151], v[8:11], a[212:215], 0
s_nop 0
ds_read_b128 a[240:243], v7 offset:1600
ds_read_b64 a[176:177], v6 offset:2112
Lstub8:
s_cbranch_execz Lret
v_accvgpr_read_b32 v251, a75
v_mfma_f32_16x16x32_bf16 v[148:151], a[128:131], a[212:215], v[148:151]
v_accvgpr_read_b32 v252, a76
v_accvgpr_read_b32 v253, a77
v_accvgpr_read_b32 v254, a78
v_mfma_f32_16x16x32_bf16 v[148:151], a[132:135], a[208:211], v[148:151]
v_accvgpr_read_b32 v255, a79
v_mul_f32 v248, v248, v232
v_mul_f32 v249, v249, v232
v_mfma_f32_16x16x32_bf16 v[148:151], a[136:139], a[204:207], v[148:151]
s_nop 0
ds_read_b64 a[178:179], v6 offset:2120
ds_read_b128 a[244:247], v7 offset:1088
v_mul_f32 v250, v250, v232
v_mfma_f32_16x16x32_bf16 v[148:151], a[140:143], a[200:203], v[148:151]
v_mul_f32 v251, v251, v232
v_mul_f32 v252, v252, v232
v_mul_f32 v253, v253, v232
v_mfma_f32_16x16x32_bf16 v[148:151], a[144:147], a[196:199], v[148:151]
v_mul_f32 v254, v254, v232
v_mul_f32 v255, v255, v232
v_cvt_pk_bf16_f32 v248, v248, v249
v_mfma_f32_16x16x32_bf16 v[148:151], a[148:151], a[192:195], v[148:151]
s_nop 0
ds_read_b64 a[180:181], v6 offset:2624
ds_read_b64 a[182:183], v6 offset:2632
v_cvt_pk_bf16_f32 v249, v250, v251
v_mfma_f32_16x16x32_bf16 v[152:155], v[8:11], a[216:219], 0
v_cvt_pk_bf16_f32 v250, v252, v253
v_cvt_pk_bf16_f32 v251, v254, v255
v_mfma_f32_16x16x32_bf16 v[152:155], a[128:131], a[216:219], v[152:155]
buffer_store_dwordx4 v[248:251], v1, s[44:47], s70 offen offset:1024 sc1
v_mfma_f32_16x16x32_bf16 v[152:155], a[132:135], a[212:215], v[152:155]
s_nop 0
ds_read_b128 a[248:251], v7 offset:576
ds_read_b64 a[184:185], v6 offset:3136
v_accvgpr_read_b32 v240, a80
v_mfma_f32_16x16x32_bf16 v[152:155], a[136:139], a[208:211], v[152:155]
v_accvgpr_read_b32 v241, a81
v_accvgpr_read_b32 v242, a82
v_accvgpr_read_b32 v243, a83
v_mfma_f32_16x16x32_bf16 v[152:155], a[140:143], a[204:207], v[152:155]
v_accvgpr_read_b32 v244, a84
v_accvgpr_read_b32 v245, a85
v_accvgpr_read_b32 v246, a86
v_mfma_f32_16x16x32_bf16 v[152:155], a[144:147], a[200:203], v[152:155]
s_nop 0
ds_read_b64 a[186:187], v6 offset:3144
ds_read_b128 a[252:255], v7 offset:64
v_accvgpr_read_b32 v247, a87
v_mfma_f32_16x16x32_bf16 v[152:155], a[148:151], a[196:199], v[152:155]
v_mul_f32 v240, v240, v232
v_mul_f32 v241, v241, v232
v_mul_f32 v242, v242, v232
v_mfma_f32_16x16x32_bf16 v[152:155], a[152:155], a[192:195], v[152:155]
v_mul_f32 v243, v243, v232
v_mul_f32 v244, v244, v232
v_mul_f32 v245, v245, v232
v_mfma_f32_16x16x32_bf16 v[156:159], v[8:11], a[220:223], 0
s_nop 0
ds_read_b64 a[188:189], v6 offset:3648
ds_read_b64 a[190:191], v6 offset:3656
v_mul_f32 v246, v246, v232
v_mfma_f32_16x16x32_bf16 v[156:159], a[128:131], a[220:223], v[156:159]
v_mul_f32 v247, v247, v232
v_cvt_pk_bf16_f32 v240, v240, v241
v_cvt_pk_bf16_f32 v241, v242, v243
v_mfma_f32_16x16x32_bf16 v[156:159], a[132:135], a[216:219], v[156:159]
v_cvt_pk_bf16_f32 v242, v244, v245
v_cvt_pk_bf16_f32 v243, v246, v247
v_mfma_f32_16x16x32_bf16 v[156:159], a[136:139], a[212:215], v[156:159]
buffer_store_dwordx4 v[240:243], v1, s[44:47], s70 offen offset:2048 sc1
v_mfma_f32_16x16x32_bf16 v[156:159], a[140:143], a[208:211], v[156:159]
v_accvgpr_read_b32 v248, a88
v_accvgpr_read_b32 v249, a89
v_accvgpr_read_b32 v250, a90
v_mfma_f32_16x16x32_bf16 v[156:159], a[144:147], a[204:207], v[156:159]
v_accvgpr_read_b32 v251, a91
v_accvgpr_read_b32 v252, a92
v_accvgpr_read_b32 v253, a93
v_mfma_f32_16x16x32_bf16 v[156:159], a[148:151], a[200:203], v[156:159]
v_accvgpr_read_b32 v254, a94
v_accvgpr_read_b32 v255, a95
v_mul_f32 v248, v248, v232
v_mfma_f32_16x16x32_bf16 v[156:159], a[152:155], a[196:199], v[156:159]
v_mul_f32 v249, v249, v232
v_mul_f32 v250, v250, v232
v_mul_f32 v251, v251, v232
v_mfma_f32_16x16x32_bf16 v[156:159], a[156:159], a[192:195], v[156:159]
s_waitcnt lgkmcnt(0)
v_mul_f32 v252, v252, v232
v_mul_f32 v253, v253, v232
v_mul_f32 v254, v254, v232
v_mfma_f32_16x16x32_bf16 v[128:131], a[160:163], a[224:227], v[128:131]
s_nop 0
ds_read_b128 a[192:195], v7 offset:3712
ds_read_b64 a[128:129], v6 offset:128
v_mul_f32 v255, v255, v232
v_mfma_f32_16x16x32_bf16 v[132:135], a[164:167], a[224:227], v[132:135]
v_cvt_pk_bf16_f32 v248, v248, v249
v_cvt_pk_bf16_f32 v249, v250, v251
v_cvt_pk_bf16_f32 v250, v252, v253
v_mfma_f32_16x16x32_bf16 v[132:135], a[160:163], a[228:231], v[132:135]
s_nop 0
ds_read_b64 a[130:131], v6 offset:136
ds_read_b128 a[196:199], v7 offset:3200
v_cvt_pk_bf16_f32 v251, v254, v255
v_mfma_f32_16x16x32_bf16 v[136:139], a[160:163], a[232:235], v[136:139]
buffer_store_dwordx4 v[248:251], v1, s[44:47], s70 offen offset:3072 sc1
v_mfma_f32_16x16x32_bf16 v[136:139], a[164:167], a[228:231], v[136:139]
s_add_u32 s70, s70, 0x80000
v_accvgpr_read_b32 v240, a96
v_accvgpr_read_b32 v241, a97
v_accvgpr_read_b32 v242, a98
v_mfma_f32_16x16x32_bf16 v[136:139], a[168:171], a[224:227], v[136:139]
s_nop 0
ds_read_b64 a[132:133], v6 offset:640
ds_read_b64 a[134:135], v6 offset:648
v_accvgpr_read_b32 v243, a99
v_mfma_f32_16x16x32_bf16 v[140:143], a[172:175], a[224:227], v[140:143]
v_accvgpr_read_b32 v244, a100
v_accvgpr_read_b32 v245, a101
v_accvgpr_read_b32 v246, a102
v_mfma_f32_16x16x32_bf16 v[140:143], a[168:171], a[228:231], v[140:143]
s_nop 0
ds_read_b128 a[200:203], v7 offset:2688
ds_read_b64 a[136:137], v6 offset:1152
v_accvgpr_read_b32 v247, a103
v_mfma_f32_16x16x32_bf16 v[140:143], a[164:167], a[232:235], v[140:143]
v_mul_f32 v240, v240, v236
v_mul_f32 v241, v241, v236
v_mul_f32 v242, v242, v236
v_mfma_f32_16x16x32_bf16 v[140:143], a[160:163], a[236:239], v[140:143]
v_mul_f32 v243, v243, v236
v_mul_f32 v244, v244, v236
v_mul_f32 v245, v245, v236
v_mfma_f32_16x16x32_bf16 v[144:147], a[160:163], a[240:243], v[144:147]
s_nop 0
ds_read_b64 a[138:139], v6 offset:1160
ds_read_b128 a[204:207], v7 offset:2176
v_mul_f32 v246, v246, v236
v_mfma_f32_16x16x32_bf16 v[144:147], a[164:167], a[236:239], v[144:147]
v_mul_f32 v247, v247, v236
v_cvt_pk_bf16_f32 v240, v240, v241
v_cvt_pk_bf16_f32 v241, v242, v243
v_mfma_f32_16x16x32_bf16 v[144:147], a[168:171], a[232:235], v[144:147]
s_nop 0
ds_read_b64 a[140:141], v6 offset:1664
ds_read_b64 a[142:143], v6 offset:1672
v_cvt_pk_bf16_f32 v242, v244, v245
v_mfma_f32_16x16x32_bf16 v[144:147], a[172:175], a[228:231], v[144:147]
v_cvt_pk_bf16_f32 v243, v246, v247
v_mfma_f32_16x16x32_bf16 v[144:147], a[176:179], a[224:227], v[144:147]
buffer_store_dwordx4 v[240:243], v1, s[44:47], s70 offen sc1
v_mfma_f32_16x16x32_bf16 v[148:151], a[180:183], a[224:227], v[148:151]
s_nop 0
ds_read_b128 a[208:211], v7 offset:1664
ds_read_b64 a[144:145], v6 offset:2176
v_accvgpr_read_b32 v248, a104
v_mfma_f32_16x16x32_bf16 v[148:151], a[176:179], a[228:231], v[148:151]
v_accvgpr_read_b32 v249, a105
v_accvgpr_read_b32 v250, a106
v_accvgpr_read_b32 v251, a107
v_mfma_f32_16x16x32_bf16 v[148:151], a[172:175], a[232:235], v[148:151]
v_accvgpr_read_b32 v252, a108
v_accvgpr_read_b32 v253, a109
v_accvgpr_read_b32 v254, a110
v_mfma_f32_16x16x32_bf16 v[148:151], a[168:171], a[236:239], v[148:151]
s_nop 0
ds_read_b64 a[146:147], v6 offset:2184
ds_read_b128 a[212:215], v7 offset:1152
v_accvgpr_read_b32 v255, a111
v_mfma_f32_16x16x32_bf16 v[148:151], a[164:167], a[240:243], v[148:151]
v_mul_f32 v248, v248, v236
v_mul_f32 v249, v249, v236
v_mul_f32 v250, v250, v236
v_mfma_f32_16x16x32_bf16 v[148:151], a[160:163], a[244:247], v[148:151]
s_nop 0
ds_read_b64 a[148:149], v6 offset:2688
ds_read_b64 a[150:151], v6 offset:2696
v_mul_f32 v251, v251, v236
v_mfma_f32_16x16x32_bf16 v[152:155], a[160:163], a[248:251], v[152:155]
v_mul_f32 v252, v252, v236
v_mul_f32 v253, v253, v236
v_mul_f32 v254, v254, v236
v_mfma_f32_16x16x32_bf16 v[152:155], a[164:167], a[244:247], v[152:155]
v_mul_f32 v255, v255, v236
v_cvt_pk_bf16_f32 v248, v248, v249
v_cvt_pk_bf16_f32 v249, v250, v251
v_mfma_f32_16x16x32_bf16 v[152:155], a[168:171], a[240:243], v[152:155]
s_nop 0
ds_read_b128 a[216:219], v7 offset:640
ds_read_b64 a[152:153], v6 offset:3200
v_cvt_pk_bf16_f32 v250, v252, v253
v_mfma_f32_16x16x32_bf16 v[152:155], a[172:175], a[236:239], v[152:155]
v_cvt_pk_bf16_f32 v251, v254, v255
v_mfma_f32_16x16x32_bf16 v[152:155], a[176:179], a[232:235], v[152:155]
s_nop 0
ds_read_b64 a[154:155], v6 offset:3208
ds_read_b128 a[220:223], v7 offset:128
v_mfma_f32_16x16x32_bf16 v[152:155], a[180:183], a[228:231], v[152:155]
buffer_store_dwordx4 v[248:251], v1, s[44:47], s70 offen offset:1024 sc1
v_mfma_f32_16x16x32_bf16 v[152:155], a[184:187], a[224:227], v[152:155]
v_accvgpr_read_b32 v240, a112
v_accvgpr_read_b32 v241, a113
v_accvgpr_read_b32 v242, a114
v_mfma_f32_16x16x32_bf16 v[156:159], a[188:191], a[224:227], v[156:159]
s_nop 0
ds_read_b64 a[156:157], v6 offset:3712
ds_read_b64 a[158:159], v6 offset:3720
v_accvgpr_read_b32 v243, a115
v_mfma_f32_16x16x32_bf16 v[156:159], a[184:187], a[228:231], v[156:159]
v_accvgpr_read_b32 v244, a116
v_accvgpr_read_b32 v245, a117
v_accvgpr_read_b32 v246, a118
v_mfma_f32_16x16x32_bf16 v[156:159], a[180:183], a[232:235], v[156:159]
v_accvgpr_read_b32 v247, a119
v_mul_f32 v240, v240, v236
v_mul_f32 v241, v241, v236
v_mfma_f32_16x16x32_bf16 v[156:159], a[176:179], a[236:239], v[156:159]
v_mul_f32 v242, v242, v236
v_mul_f32 v243, v243, v236
v_mul_f32 v244, v244, v236
v_mfma_f32_16x16x32_bf16 v[156:159], a[172:175], a[240:243], v[156:159]
v_mul_f32 v245, v245, v236
v_mul_f32 v246, v246, v236
v_mul_f32 v247, v247, v236
v_mfma_f32_16x16x32_bf16 v[156:159], a[168:171], a[244:247], v[156:159]
v_cvt_pk_bf16_f32 v240, v240, v241
v_cvt_pk_bf16_f32 v241, v242, v243
v_cvt_pk_bf16_f32 v242, v244, v245
v_mfma_f32_16x16x32_bf16 v[156:159], a[164:167], a[248:251], v[156:159]
v_cvt_pk_bf16_f32 v243, v246, v247
v_mfma_f32_16x16x32_bf16 v[156:159], a[160:163], a[252:255], v[156:159]
s_waitcnt lgkmcnt(0)
buffer_store_dwordx4 v[240:243], v1, s[44:47], s70 offen offset:2048 sc1
v_mfma_f32_16x16x32_bf16 v[128:131], a[128:131], a[192:195], v[128:131]
s_nop 0
ds_read_b128 a[224:227], v7 offset:3776
ds_read_b64 a[160:161], v6 offset:192
v_accvgpr_read_b32 v248, a120
v_mfma_f32_16x16x32_bf16 v[132:135], a[132:135], a[192:195], v[132:135]
v_accvgpr_read_b32 v249, a121
v_accvgpr_read_b32 v250, a122
v_accvgpr_read_b32 v251, a123
v_mfma_f32_16x16x32_bf16 v[132:135], a[128:131], a[196:199], v[132:135]
s_nop 0
ds_read_b64 a[162:163], v6 offset:200
ds_read_b128 a[228:231], v7 offset:3264
v_accvgpr_read_b32 v252, a124
v_mfma_f32_16x16x32_bf16 v[136:139], a[128:131], a[200:203], v[136:139]
v_accvgpr_read_b32 v253, a125
v_accvgpr_read_b32 v254, a126
v_accvgpr_read_b32 v255, a127
v_mfma_f32_16x16x32_bf16 v[136:139], a[132:135], a[196:199], v[136:139]
v_mul_f32 v248, v248, v236
v_mul_f32 v249, v249, v236
v_mul_f32 v250, v250, v236
v_mfma_f32_16x16x32_bf16 v[136:139], a[136:139], a[192:195], v[136:139]
s_nop 0
ds_read_b64 a[164:165], v6 offset:704
ds_read_b64 a[166:167], v6 offset:712
v_mul_f32 v251, v251, v236
v_mfma_f32_16x16x32_bf16 v[140:143], a[140:143], a[192:195], v[140:143]
v_mul_f32 v252, v252, v236
v_mul_f32 v253, v253, v236
v_mul_f32 v254, v254, v236
v_mfma_f32_16x16x32_bf16 v[140:143], a[136:139], a[196:199], v[140:143]
s_nop 0
ds_read_b128 a[232:235], v7 offset:2752
ds_read_b64 a[168:169], v6 offset:1216
v_mul_f32 v255, v255, v236
v_mfma_f32_16x16x32_bf16 v[140:143], a[132:135], a[200:203], v[140:143]
v_cvt_pk_bf16_f32 v248, v248, v249
v_cvt_pk_bf16_f32 v249, v250, v251
v_cvt_pk_bf16_f32 v250, v252, v253
v_mfma_f32_16x16x32_bf16 v[140:143], a[128:131], a[204:207], v[140:143]
v_cvt_pk_bf16_f32 v251, v254, v255
v_mfma_f32_16x16x32_bf16 v[144:147], a[128:131], a[208:211], v[144:147]
s_nop 0
ds_read_b64 a[170:171], v6 offset:1224
ds_read_b128 a[236:239], v7 offset:2240
v_mfma_f32_16x16x32_bf16 v[144:147], a[132:135], a[204:207], v[144:147]
buffer_store_dwordx4 v[248:251], v1, s[44:47], s70 offen offset:3072 sc1
v_mfma_f32_16x16x32_bf16 v[144:147], a[136:139], a[200:203], v[144:147]
s_mov_b32 s73, 0x5d800000
ds_read_b64 a[172:173], v6 offset:1728
ds_read_b64 a[174:175], v6 offset:1736
v_add_f32 v227, v226, v230
v_mfma_f32_16x16x32_bf16 v[144:147], a[140:143], a[196:199], v[144:147]
v_add_f32 v231, v234, v238
v_add_f32 v227, v227, v231
v_cmp_nlt_f32 vcc, v227, s73
v_mfma_f32_16x16x32_bf16 v[144:147], a[144:147], a[192:195], v[144:147]
s_lshl_b32 s73, s58, 2
v_mfma_f32_16x16x32_bf16 v[148:151], a[148:151], a[192:195], v[148:151]
s_add_u32 s73, s73, 163328
ds_read_b128 a[240:243], v7 offset:1728
ds_read_b64 a[176:177], v6 offset:2240
v_mov_b32 v231, s73
v_mfma_f32_16x16x32_bf16 v[148:151], a[144:147], a[196:199], v[148:151]
s_or_b32 s73, vcc_lo, vcc_hi
v_mfma_f32_16x16x32_bf16 v[148:151], a[140:143], a[200:203], v[148:151]
s_min_u32 s73, s73, 1
v_mov_b32 v227, s73
v_mfma_f32_16x16x32_bf16 v[148:151], a[136:139], a[204:207], v[148:151]
s_nop 0
ds_read_b64 a[178:179], v6 offset:2248
ds_read_b128 a[244:247], v7 offset:1216
ds_write_b32 v231, v227
v_mfma_f32_16x16x32_bf16 v[148:151], a[132:135], a[208:211], v[148:151]
v_mfma_f32_16x16x32_bf16 v[148:151], a[128:131], a[212:215], v[148:151]
s_nop 0
ds_read_b64 a[180:181], v6 offset:2752
ds_read_b64 a[182:183], v6 offset:2760
v_mfma_f32_16x16x32_bf16 v[152:155], a[128:131], a[216:219], v[152:155]
v_mfma_f32_16x16x32_bf16 v[152:155], a[132:135], a[212:215], v[152:155]
v_mfma_f32_16x16x32_bf16 v[152:155], a[136:139], a[208:211], v[152:155]
s_nop 0
ds_read_b128 a[248:251], v7 offset:704
ds_read_b64 a[184:185], v6 offset:3264
v_mfma_f32_16x16x32_bf16 v[152:155], a[140:143], a[204:207], v[152:155]
v_mfma_f32_16x16x32_bf16 v[152:155], a[144:147], a[200:203], v[152:155]
s_nop 0
ds_read_b64 a[186:187], v6 offset:3272
ds_read_b128 a[252:255], v7 offset:192
v_mfma_f32_16x16x32_bf16 v[152:155], a[148:151], a[196:199], v[152:155]
v_mfma_f32_16x16x32_bf16 v[152:155], a[152:155], a[192:195], v[152:155]
v_mfma_f32_16x16x32_bf16 v[156:159], a[156:159], a[192:195], v[156:159]
s_nop 0
ds_read_b64 a[188:189], v6 offset:3776
ds_read_b64 a[190:191], v6 offset:3784
v_mfma_f32_16x16x32_bf16 v[156:159], a[152:155], a[196:199], v[156:159]
v_mfma_f32_16x16x32_bf16 v[156:159], a[148:151], a[200:203], v[156:159]
v_mfma_f32_16x16x32_bf16 v[156:159], a[144:147], a[204:207], v[156:159]
v_mfma_f32_16x16x32_bf16 v[156:159], a[140:143], a[208:211], v[156:159]
v_mfma_f32_16x16x32_bf16 v[156:159], a[136:139], a[212:215], v[156:159]
v_mfma_f32_16x16x32_bf16 v[156:159], a[132:135], a[216:219], v[156:159]
v_mfma_f32_16x16x32_bf16 v[156:159], a[128:131], a[220:223], v[156:159]
s_waitcnt lgkmcnt(0)
v_mfma_f32_16x16x32_bf16 v[128:131], a[160:163], a[224:227], v[128:131]
s_nop 0
ds_read_b128 a[192:195], v7 offset:3840
ds_read_b64 a[128:129], v6 offset:256
v_mfma_f32_16x16x32_bf16 v[132:135], a[164:167], a[224:227], v[132:135]
v_mfma_f32_16x16x32_bf16 v[132:135], a[160:163], a[228:231], v[132:135]
s_nop 0
ds_read_b64 a[130:131], v6 offset:264
ds_read_b128 a[196:199], v7 offset:3328
v_mfma_f32_16x16x32_bf16 v[136:139], a[160:163], a[232:235], v[136:139]
v_mfma_f32_16x16x32_bf16 v[136:139], a[164:167], a[228:231], v[136:139]
v_mfma_f32_16x16x32_bf16 v[136:139], a[168:171], a[224:227], v[136:139]
s_nop 0
ds_read_b64 a[132:133], v6 offset:768
ds_read_b64 a[134:135], v6 offset:776
v_mfma_f32_16x16x32_bf16 v[140:143], a[172:175], a[224:227], v[140:143]
v_mfma_f32_16x16x32_bf16 v[140:143], a[168:171], a[228:231], v[140:143]
s_nop 0
ds_read_b128 a[200:203], v7 offset:2816
ds_read_b64 a[136:137], v6 offset:1280
v_mfma_f32_16x16x32_bf16 v[140:143], a[164:167], a[232:235], v[140:143]
v_mfma_f32_16x16x32_bf16 v[140:143], a[160:163], a[236:239], v[140:143]
v_mfma_f32_16x16x32_bf16 v[144:147], a[160:163], a[240:243], v[144:147]
s_nop 0
ds_read_b64 a[138:139], v6 offset:1288
ds_read_b128 a[204:207], v7 offset:2304
v_mfma_f32_16x16x32_bf16 v[144:147], a[164:167], a[236:239], v[144:147]
s_nop 3
s_mov_b64 exec, 0
s_cmp_eq_u32 s58, 0
s_cbranch_scc1 Lstube0
s_cmp_eq_u32 s58, 1
s_cbranch_scc1 Lstube1
s_cmp_eq_u32 s58, 2
s_cbranch_scc1 Lstube2
s_branch Lstube3
Lrete:
s_mov_b64 exec, -1
s_nop 3
v_mfma_f32_16x16x32_bf16 v[144:147], a[168:171], a[232:235], v[144:147]
s_waitcnt vmcnt(0) lgkmcnt(15)
ds_read_b64 a[140:141], v6 offset:1792
ds_read_b64 a[142:143], v6 offset:1800
v_mfma_f32_16x16x32_bf16 v[144:147], a[172:175], a[228:231], v[144:147]
s_barrier
v_mov_b32 v244, 163328
v_mfma_f32_16x16x32_bf16 v[144:147], a[176:179], a[224:227], v[144:147]
s_xor_b32 s71, s12, 0x100
ds_read_b128 v[240:243], v244
v_mfma_f32_16x16x32_bf16 v[148:151], a[180:183], a[224:227], v[148:151]
s_add_u32 m0, s77, 16384
ds_read_b128 a[208:211], v7 offset:1792
ds_read_b64 a[144:145], v6 offset:2304
v_mfma_f32_16x16x32_bf16 v[148:151], a[176:179], a[228:231], v[148:151]
s_add_u32 s72, s71, 0
buffer_load_dwordx4 v15, s[24:27], s72 offen lds
v_mfma_f32_16x16x32_bf16 v[148:151], a[172:175], a[232:235], v[148:151]
v_mfma_f32_16x16x32_bf16 v[148:151], a[168:171], a[236:239], v[148:151]
s_nop 0
ds_read_b64 a[146:147], v6 offset:2312
ds_read_b128 a[212:215], v7 offset:1280
v_mfma_f32_16x16x32_bf16 v[148:151], a[164:167], a[240:243], v[148:151]
s_add_u32 s72, s71, 15360
buffer_load_dwordx4 v15, s[24:27], s72 offen offset:1024 lds
v_mfma_f32_16x16x32_bf16 v[148:151], a[160:163], a[244:247], v[148:151]
s_waitcnt lgkmcnt(4)
ds_read_b64 a[148:149], v6 offset:2816
ds_read_b64 a[150:151], v6 offset:2824
v_mfma_f32_16x16x32_bf16 v[152:155], a[160:163], a[248:251], v[152:155]
v_or3_b32 v240, v240, v241, v242
v_or_b32 v240, v240, v243
v_mfma_f32_16x16x32_bf16 v[152:155], a[164:167], a[244:247], v[152:155]
v_cmp_lt_u32 vcc, s86, v240
s_cbranch_vccnz Lslow
v_mfma_f32_16x16x32_bf16 v[152:155], a[168:171], a[240:243], v[152:155]
s_nop 0
ds_read_b128 a[216:219], v7 offset:768
ds_read_b64 a[152:153], v6 offset:3328
v_mfma_f32_16x16x32_bf16 v[152:155], a[172:175], a[236:239], v[152:155]
v_or_b32 v240, s58, v0
v_mov_b32 v241, 2
v_mfma_f32_16x16x32_bf16 v[152:155], a[176:179], a[232:235], v[152:155]
s_add_u32 s72, s71, 30720
ds_read_b64 a[154:155], v6 offset:3336
ds_read_b128 a[220:223], v7 offset:256
v_mfma_f32_16x16x32_bf16 v[152:155], a[180:183], a[228:231], v[152:155]
buffer_load_dwordx4 v15, s[24:27], s72 offen offset:2048 lds
v_mfma_f32_16x16x32_bf16 v[152:155], a[184:187], a[224:227], v[152:155]
v_min_u32 v240, 1, v240
v_lshlrev_b32 v240, 30, v240
v_mfma_f32_16x16x32_bf16 v[156:159], a[188:191], a[224:227], v[156:159]
s_nop 0
ds_read_b64 a[156:157], v6 offset:3840
ds_read_b64 a[158:159], v6 offset:3848
v_mfma_f32_16x16x32_bf16 v[156:159], a[184:187], a[228:231], v[156:159]
buffer_store_dword v241, v240, s[44:47], s91 offen sc1
v_mfma_f32_16x16x32_bf16 v[156:159], a[180:183], a[232:235], v[156:159]
s_add_u32 s80, s93, 0x3400000
v_and_b32 v166, 7, v0
v_lshlrev_b32 v166, 4, v166
v_mfma_f32_16x16x32_bf16 v[156:159], a[176:179], a[236:239], v[156:159]
s_add_u32 s72, s71, 46080
buffer_load_dwordx4 v15, s[24:27], s72 offen offset:3072 lds
v_mfma_f32_16x16x32_bf16 v[156:159], a[172:175], a[240:243], v[156:159]
v_bfe_u32 v112, v0, 3, 1
v_lshl_add_u32 v166, v112, 8, v166
v_mfma_f32_16x16x32_bf16 v[156:159], a[168:171], a[244:247], v[156:159]
v_bfe_u32 v112, v0, 4, 1
v_lshl_add_u32 v166, v112, 7, v166
v_mfma_f32_16x16x32_bf16 v[156:159], a[164:167], a[248:251], v[156:159]
v_lshrrev_b32 v2, 4, v0
v_lshlrev_b32 v2, 10, v2
v_mfma_f32_16x16x32_bf16 v[156:159], a[160:163], a[252:255], v[156:159]
s_waitcnt lgkmcnt(0)
v_lshrrev_b32 v112, 5, v0
v_lshl_add_u32 v166, v112, 9, v166
v_mfma_f32_16x16x32_bf16 v[128:131], a[128:131], a[192:195], v[128:131]
s_xor_b32 s82, s78, 0
ds_read_b128 a[224:227], v7 offset:3904
ds_read_b64 a[160:161], v6 offset:320
v_mfma_f32_16x16x32_bf16 v[132:135], a[132:135], a[192:195], v[132:135]
s_xor_b32 s71, s12, 0x180
v_and_b32 v112, 15, v0
v_lshrrev_b32 v113, 2, v0
v_mfma_f32_16x16x32_bf16 v[132:135], a[128:131], a[196:199], v[132:135]
s_add_u32 m0, s77, 32768
ds_read_b64 a[162:163], v6 offset:328
ds_read_b128 a[228:231], v7 offset:3392
v_mfma_f32_16x16x32_bf16 v[136:139], a[128:131], a[200:203], v[136:139]
s_add_u32 s72, s71, 0
buffer_load_dwordx4 v15, s[24:27], s72 offen lds
v_mfma_f32_16x16x32_bf16 v[136:139], a[132:135], a[196:199], v[136:139]
s_lshl_b32 s82, s82, 10
v_bfe_u32 v114, v0, 3, 2
v_and_b32 v115, 3, v0
v_mfma_f32_16x16x32_bf16 v[136:139], a[136:139], a[192:195], v[136:139]
s_add_u32 s82, s82, s74
ds_read_b64 a[164:165], v6 offset:832
ds_read_b64 a[166:167], v6 offset:840
v_mfma_f32_16x16x32_bf16 v[140:143], a[140:143], a[192:195], v[140:143]
buffer_load_dword v3, v2, s[44:47], s82 offen sc1
v_mfma_f32_16x16x32_bf16 v[140:143], a[136:139], a[196:199], v[140:143]
s_add_u32 s72, s71, 15360
ds_read_b128 a[232:235], v7 offset:2880
ds_read_b64 a[168:169], v6 offset:1344
v_mfma_f32_16x16x32_bf16 v[140:143], a[132:135], a[200:203], v[140:143]
buffer_load_dwordx4 v15, s[24:27], s72 offen offset:1024 lds
v_mfma_f32_16x16x32_bf16 v[140:143], a[128:131], a[204:207], v[140:143]
v_lshlrev_b32 v8, 7, v113
v_lshl_add_u32 v8, v114, 5, v8
v_mfma_f32_16x16x32_bf16 v[144:147], a[128:131], a[208:211], v[144:147]
s_nop 0
ds_read_b64 a[170:171], v6 offset:1352
ds_read_b128 a[236:239], v7 offset:2368
v_mfma_f32_16x16x32_bf16 v[144:147], a[132:135], a[204:207], v[144:147]
v_lshl_add_u32 v8, v115, 3, v8
v_add_u32 v8, s77, v8
v_mfma_f32_16x16x32_bf16 v[144:147], a[136:139], a[200:203], v[144:147]
s_nop 0
ds_read_b64 a[172:173], v6 offset:1856
ds_read_b64 a[174:175], v6 offset:1864
v_mfma_f32_16x16x32_bf16 v[144:147], a[140:143], a[196:199], v[144:147]
s_add_u32 s72, s71, 30720
buffer_load_dwordx4 v15, s[24:27], s72 offen offset:2048 lds
v_mfma_f32_16x16x32_bf16 v[144:147], a[144:147], a[192:195], v[144:147]
v_subrev_u32 v8, s64, v8
v_xor_b32 v9, 32, v8
v_mfma_f32_16x16x32_bf16 v[148:151], a[148:151], a[192:195], v[148:151]
s_nop 0
ds_read_b128 a[240:243], v7 offset:1856
ds_read_b64 a[176:177], v6 offset:2368
v_mfma_f32_16x16x32_bf16 v[148:151], a[144:147], a[196:199], v[148:151]
v_xor_b32 v10, 64, v8
v_xor_b32 v11, 0x60, v8
v_mfma_f32_16x16x32_bf16 v[148:151], a[140:143], a[200:203], v[148:151]
v_lshlrev_b32 v5, 8, v113
v_and_b32 v114, 1, v0
v_mfma_f32_16x16x32_bf16 v[148:151], a[136:139], a[204:207], v[148:151]
s_nop 0
ds_read_b64 a[178:179], v6 offset:2376
ds_read_b128 a[244:247], v7 offset:1344
v_mfma_f32_16x16x32_bf16 v[148:151], a[132:135], a[208:211], v[148:151]
s_add_u32 s72, s71, 46080
buffer_load_dwordx4 v15, s[24:27], s72 offen offset:3072 lds
v_mfma_f32_16x16x32_bf16 v[148:151], a[128:131], a[212:215], v[148:151]
s_nop 0
ds_read_b64 a[180:181], v6 offset:2880
ds_read_b64 a[182:183], v6 offset:2888
v_mfma_f32_16x16x32_bf16 v[152:155], a[128:131], a[216:219], v[152:155]
v_lshl_add_u32 v5, v114, 7, v5
v_bfe_u32 v114, v0, 1, 1
v_mfma_f32_16x16x32_bf16 v[152:155], a[132:135], a[212:215], v[152:155]
v_lshl_add_u32 v5, v114, 3, v5
v_lshlrev_b32 v114, 1, s58
v_mfma_f32_16x16x32_bf16 v[152:155], a[136:139], a[208:211], v[152:155]
s_nop 0
ds_read_b128 a[248:251], v7 offset:832
ds_read_b64 a[184:185], v6 offset:3392
v_mfma_f32_16x16x32_bf16 v[152:155], a[140:143], a[204:207], v[152:155]
v_xor_b32 v114, v114, v113
v_and_b32 v114, 7, v114
v_mfma_f32_16x16x32_bf16 v[152:155], a[144:147], a[200:203], v[152:155]
s_xor_b32 s71, s13, 0x80
ds_read_b64 a[186:187], v6 offset:3400
ds_read_b128 a[252:255], v7 offset:320
v_mfma_f32_16x16x32_bf16 v[152:155], a[148:151], a[196:199], v[152:155]
s_add_u32 m0, s77, 49152
v_lshl_add_u32 v5, v114, 4, v5
v_add_u32 v5, 147456, v5
v_mfma_f32_16x16x32_bf16 v[152:155], a[152:155], a[192:195], v[152:155]
s_add_u32 s72, s71, 0
buffer_load_dwordx4 v15, s[24:27], s72 offen lds
v_mfma_f32_16x16x32_bf16 v[156:159], a[156:159], a[192:195], v[156:159]
s_nop 0
ds_read_b64 a[188:189], v6 offset:3904
ds_read_b64 a[190:191], v6 offset:3912
v_mfma_f32_16x16x32_bf16 v[156:159], a[152:155], a[196:199], v[156:159]
v_bfe_u32 v114, v0, 1, 2
v_lshrrev_b32 v115, 4, v0
v_mfma_f32_16x16x32_bf16 v[156:159], a[148:151], a[200:203], v[156:159]
v_lshlrev_b32 v116, 7, v112
v_lshl_add_u32 v116, v114, 5, v116
v_mfma_f32_16x16x32_bf16 v[156:159], a[144:147], a[204:207], v[156:159]
s_add_u32 s72, s71, 15360
buffer_load_dwordx4 v15, s[24:27], s72 offen offset:1024 lds
v_mfma_f32_16x16x32_bf16 v[156:159], a[140:143], a[208:211], v[156:159]
v_lshl_add_u32 v116, v115, 3, v116
v_add_u32 v116, s64, v116
v_mfma_f32_16x16x32_bf16 v[156:159], a[136:139], a[212:215], v[156:159]
v_add_u32 v116, 131072, v116
v_xor_b32 v117, 32, v116
v_mfma_f32_16x16x32_bf16 v[156:159], a[132:135], a[216:219], v[156:159]
v_xor_b32 v118, 64, v116
v_xor_b32 v119, 0x60, v116
v_mfma_f32_16x16x32_bf16 v[156:159], a[128:131], a[220:223], v[156:159]
s_waitcnt lgkmcnt(0)
v_mfma_f32_16x16x32_bf16 v[128:131], a[160:163], a[224:227], v[128:131]
s_nop 0
ds_read_b128 a[192:195], v7 offset:3968
ds_read_b64 a[128:129], v6 offset:384
v_mfma_f32_16x16x32_bf16 v[132:135], a[164:167], a[224:227], v[132:135]
s_add_u32 s72, s71, 30720
buffer_load_dwordx4 v15, s[24:27], s72 offen offset:2048 lds
v_mfma_f32_16x16x32_bf16 v[132:135], a[160:163], a[228:231], v[132:135]
s_nop 0
ds_read_b64 a[130:131], v6 offset:392
ds_read_b128 a[196:199], v7 offset:3456
v_mfma_f32_16x16x32_bf16 v[136:139], a[160:163], a[232:235], v[136:139]
v_mfma_f32_16x16x32_bf16 v[136:139], a[164:167], a[228:231], v[136:139]
Lstub9:
s_cbranch_execz Lret
v_mfma_f32_16x16x32_bf16 v[136:139], a[168:171], a[224:227], v[136:139]
s_nop 0
ds_read_b64 a[132:133], v6 offset:896
ds_read_b64 a[134:135], v6 offset:904
v_mfma_f32_16x16x32_bf16 v[140:143], a[172:175], a[224:227], v[140:143]
v_mfma_f32_16x16x32_bf16 v[140:143], a[168:171], a[228:231], v[140:143]
s_add_u32 s72, s71, 46080
ds_read_b128 a[200:203], v7 offset:2944
ds_read_b64 a[136:137], v6 offset:1408
v_mfma_f32_16x16x32_bf16 v[140:143], a[164:167], a[232:235], v[140:143]
buffer_load_dwordx4 v15, s[24:27], s72 offen offset:3072 lds
v_mfma_f32_16x16x32_bf16 v[140:143], a[160:163], a[236:239], v[140:143]
v_mfma_f32_16x16x32_bf16 v[144:147], a[160:163], a[240:243], v[144:147]
s_nop 0
ds_read_b64 a[138:139], v6 offset:1416
ds_read_b128 a[204:207], v7 offset:2432
v_mfma_f32_16x16x32_bf16 v[144:147], a[164:167], a[236:239], v[144:147]
v_mfma_f32_16x16x32_bf16 v[144:147], a[168:171], a[232:235], v[144:147]
s_nop 0
ds_read_b64 a[140:141], v6 offset:1920
ds_read_b64 a[142:143], v6 offset:1928
v_mfma_f32_16x16x32_bf16 v[144:147], a[172:175], a[228:231], v[144:147]
v_mfma_f32_16x16x32_bf16 v[144:147], a[176:179], a[224:227], v[144:147]
v_mfma_f32_16x16x32_bf16 v[148:151], a[180:183], a[224:227], v[148:151]
s_nop 0
ds_read_b128 a[208:211], v7 offset:1920
ds_read_b64 a[144:145], v6 offset:2432
v_mfma_f32_16x16x32_bf16 v[148:151], a[176:179], a[228:231], v[148:151]
v_mfma_f32_16x16x32_bf16 v[148:151], a[172:175], a[232:235], v[148:151]
s_waitcnt vmcnt(7)
v_cmp_gt_u32 vcc, 2, v3
s_or_b32 s81, vcc_lo, vcc_hi
s_cselect_b32 s81, 0x40000000, 0
v_or_b32 v4, s81, v1
v_mfma_f32_16x16x32_bf16 v[148:151], a[168:171], a[236:239], v[148:151]
s_nop 0
ds_read_b64 a[146:147], v6 offset:2440
ds_read_b128 a[212:215], v7 offset:1408
v_mfma_f32_16x16x32_bf16 v[148:151], a[164:167], a[240:243], v[148:151]
v_mfma_f32_16x16x32_bf16 v[148:151], a[160:163], a[244:247], v[148:151]
s_nop 0
ds_read_b64 a[148:149], v6 offset:2944
ds_read_b64 a[150:151], v6 offset:2952
v_mfma_f32_16x16x32_bf16 v[152:155], a[160:163], a[248:251], v[152:155]
v_mfma_f32_16x16x32_bf16 v[152:155], a[164:167], a[244:247], v[152:155]
s_lshr_b32 s69, s12, 18
v_mfma_f32_16x16x32_bf16 v[152:155], a[168:171], a[240:243], v[152:155]
s_lshl_b32 s69, s69, 12
ds_read_b128 a[216:219], v7 offset:896
ds_read_b64 a[152:153], v6 offset:3456
v_mfma_f32_16x16x32_bf16 v[152:155], a[172:175], a[236:239], v[152:155]
s_add_u32 s69, s69, s95
buffer_load_dwordx4 a[0:3], v4, s[44:47], s69 offen sc1
v_mfma_f32_16x16x32_bf16 v[152:155], a[176:179], a[232:235], v[152:155]
s_nop 0
ds_read_b64 a[154:155], v6 offset:3464
ds_read_b128 a[220:223], v7 offset:384
v_mfma_f32_16x16x32_bf16 v[152:155], a[180:183], a[228:231], v[152:155]
v_mfma_f32_16x16x32_bf16 v[152:155], a[184:187], a[224:227], v[152:155]
v_mfma_f32_16x16x32_bf16 v[156:159], a[188:191], a[224:227], v[156:159]
s_nop 0
ds_read_b64 a[156:157], v6 offset:3968
ds_read_b64 a[158:159], v6 offset:3976
v_mfma_f32_16x16x32_bf16 v[156:159], a[184:187], a[228:231], v[156:159]
buffer_load_dwordx4 a[4:7], v4, s[44:47], s69 offen offset:1024 sc1
v_mfma_f32_16x16x32_bf16 v[156:159], a[180:183], a[232:235], v[156:159]
v_mfma_f32_16x16x32_bf16 v[156:159], a[176:179], a[236:239], v[156:159]
v_mfma_f32_16x16x32_bf16 v[156:159], a[172:175], a[240:243], v[156:159]
v_mfma_f32_16x16x32_bf16 v[156:159], a[168:171], a[244:247], v[156:159]
buffer_load_dwordx4 a[8:11], v4, s[44:47], s69 offen offset:2048 sc1
v_mfma_f32_16x16x32_bf16 v[156:159], a[164:167], a[248:251], v[156:159]
v_mfma_f32_16x16x32_bf16 v[156:159], a[160:163], a[252:255], v[156:159]
s_waitcnt lgkmcnt(0)
v_mfma_f32_16x16x32_bf16 v[128:131], a[128:131], a[192:195], v[128:131]
s_nop 0
ds_read_b128 a[224:227], v7 offset:4032
ds_read_b64 a[160:161], v6 offset:448
v_mfma_f32_16x16x32_bf16 v[132:135], a[132:135], a[192:195], v[132:135]
v_mfma_f32_16x16x32_bf16 v[132:135], a[128:131], a[196:199], v[132:135]
s_nop 0
ds_read_b64 a[162:163], v6 offset:456
ds_read_b128 a[228:231], v7 offset:3520
v_mfma_f32_16x16x32_bf16 v[136:139], a[128:131], a[200:203], v[136:139]
buffer_load_dwordx4 a[12:15], v4, s[44:47], s69 offen offset:3072 sc1
v_mfma_f32_16x16x32_bf16 v[136:139], a[132:135], a[196:199], v[136:139]
v_mfma_f32_16x16x32_bf16 v[136:139], a[136:139], a[192:195], v[136:139]
s_nop 0
ds_read_b64 a[164:165], v6 offset:960
ds_read_b64 a[166:167], v6 offset:968
v_mfma_f32_16x16x32_bf16 v[140:143], a[140:143], a[192:195], v[140:143]
v_mfma_f32_16x16x32_bf16 v[140:143], a[136:139], a[196:199], v[140:143]
s_nop 0
ds_read_b128 a[232:235], v7 offset:3008
ds_read_b64 a[168:169], v6 offset:1472
v_mfma_f32_16x16x32_bf16 v[140:143], a[132:135], a[200:203], v[140:143]
s_add_u32 s69, s69, 0x20000
buffer_load_dwordx4 a[16:19], v4, s[44:47], s69 offen sc1
v_mfma_f32_16x16x32_bf16 v[140:143], a[128:131], a[204:207], v[140:143]
v_mfma_f32_16x16x32_bf16 v[144:147], a[128:131], a[208:211], v[144:147]
s_nop 0
ds_read_b64 a[170:171], v6 offset:1480
ds_read_b128 a[236:239], v7 offset:2496
v_mfma_f32_16x16x32_bf16 v[144:147], a[132:135], a[204:207], v[144:147]
v_mfma_f32_16x16x32_bf16 v[144:147], a[136:139], a[200:203], v[144:147]
s_nop 0
ds_read_b64 a[172:173], v6 offset:1984
ds_read_b64 a[174:175], v6 offset:1992
v_mfma_f32_16x16x32_bf16 v[144:147], a[140:143], a[196:199], v[144:147]
buffer_load_dwordx4 a[20:23], v4, s[44:47], s69 offen offset:1024 sc1
v_mfma_f32_16x16x32_bf16 v[144:147], a[144:147], a[192:195], v[144:147]
v_mfma_f32_16x16x32_bf16 v[148:151], a[148:151], a[192:195], v[148:151]
s_nop 0
ds_read_b128 a[240:243], v7 offset:1984
ds_read_b64 a[176:177], v6 offset:2496
v_mfma_f32_16x16x32_bf16 v[148:151], a[144:147], a[196:199], v[148:151]
v_mfma_f32_16x16x32_bf16 v[148:151], a[140:143], a[200:203], v[148:151]
v_mfma_f32_16x16x32_bf16 v[148:151], a[136:139], a[204:207], v[148:151]
s_nop 0
ds_read_b64 a[178:179], v6 offset:2504
ds_read_b128 a[244:247], v7 offset:1472
v_mfma_f32_16x16x32_bf16 v[148:151], a[132:135], a[208:211], v[148:151]
buffer_load_dwordx4 a[24:27], v4, s[44:47], s69 offen offset:2048 sc1
v_mfma_f32_16x16x32_bf16 v[148:151], a[128:131], a[212:215], v[148:151]
s_nop 0
ds_read_b64 a[180:181], v6 offset:3008
ds_read_b64 a[182:183], v6 offset:3016
v_mfma_f32_16x16x32_bf16 v[152:155], a[128:131], a[216:219], v[152:155]
v_mfma_f32_16x16x32_bf16 v[152:155], a[132:135], a[212:215], v[152:155]
v_mfma_f32_16x16x32_bf16 v[152:155], a[136:139], a[208:211], v[152:155]
s_nop 0
ds_read_b128 a[248:251], v7 offset:960
ds_read_b64 a[184:185], v6 offset:3520
v_mfma_f32_16x16x32_bf16 v[152:155], a[140:143], a[204:207], v[152:155]
buffer_load_dwordx4 a[28:31], v4, s[44:47], s69 offen offset:3072 sc1
v_mfma_f32_16x16x32_bf16 v[152:155], a[144:147], a[200:203], v[152:155]
s_nop 0
ds_read_b64 a[186:187], v6 offset:3528
ds_read_b128 a[252:255], v7 offset:448
v_mfma_f32_16x16x32_bf16 v[152:155], a[148:151], a[196:199], v[152:155]
v_mfma_f32_16x16x32_bf16 v[152:155], a[152:155], a[192:195], v[152:155]
s_lshr_b32 s69, s13, 18
v_mfma_f32_16x16x32_bf16 v[156:159], a[156:159], a[192:195], v[156:159]
s_lshl_b32 s69, s69, 12
ds_read_b64 a[188:189], v6 offset:4032
ds_read_b64 a[190:191], v6 offset:4040
v_mfma_f32_16x16x32_bf16 v[156:159], a[152:155], a[196:199], v[156:159]
s_add_u32 s69, s69, s95
buffer_load_dwordx4 a[32:35], v4, s[44:47], s69 offen sc1
v_mfma_f32_16x16x32_bf16 v[156:159], a[148:151], a[200:203], v[156:159]
v_mfma_f32_16x16x32_bf16 v[156:159], a[144:147], a[204:207], v[156:159]
v_mfma_f32_16x16x32_bf16 v[156:159], a[140:143], a[208:211], v[156:159]
v_mfma_f32_16x16x32_bf16 v[156:159], a[136:139], a[212:215], v[156:159]
buffer_load_dwordx4 a[36:39], v4, s[44:47], s69 offen offset:1024 sc1
v_mfma_f32_16x16x32_bf16 v[156:159], a[132:135], a[216:219], v[156:159]
v_mfma_f32_16x16x32_bf16 v[156:159], a[128:131], a[220:223], v[156:159]
s_waitcnt lgkmcnt(0)
v_mfma_f32_16x16x32_bf16 v[128:131], a[160:163], a[224:227], v[128:131]
s_nop 0
ds_read_b64_tr_b16 v[192:193], v8 offset:0
ds_read_b64_tr_b16 v[194:195], v8 offset:2048
v_mfma_f32_16x16x32_bf16 v[132:135], a[164:167], a[224:227], v[132:135]
v_mfma_f32_16x16x32_bf16 v[132:135], a[160:163], a[228:231], v[132:135]
s_nop 0
ds_read_b64_tr_b16 v[196:197], v9 offset:0
ds_read_b64_tr_b16 v[198:199], v9 offset:2048
v_mfma_f32_16x16x32_bf16 v[136:139], a[160:163], a[232:235], v[136:139]
buffer_load_dwordx4 a[40:43], v4, s[44:47], s69 offen offset:2048 sc1
v_mfma_f32_16x16x32_bf16 v[136:139], a[164:167], a[228:231], v[136:139]
s_nop 0
ds_read_b64_tr_b16 v[200:201], v10 offset:0
ds_read_b64_tr_b16 v[202:203], v10 offset:2048
v_mfma_f32_16x16x32_bf16 v[136:139], a[168:171], a[224:227], v[136:139]
v_mfma_f32_16x16x32_bf16 v[140:143], a[172:175], a[224:227], v[140:143]
s_nop 0
ds_read_b64_tr_b16 v[204:205], v11 offset:0
ds_read_b64_tr_b16 v[206:207], v11 offset:2048
v_mfma_f32_16x16x32_bf16 v[140:143], a[168:171], a[228:231], v[140:143]
v_cvt_pk_bf16_f32 v128, v128, v129
v_cvt_pk_bf16_f32 v129, v130, v131
v_cvt_pk_bf16_f32 v130, v132, v133
v_mfma_f32_16x16x32_bf16 v[140:143], a[164:167], a[232:235], v[140:143]
s_nop 0
ds_read_b64_tr_b16 v[208:209], v8 offset:4096
ds_read_b64_tr_b16 v[210:211], v8 offset:6144
v_cvt_pk_bf16_f32 v131, v134, v135
v_mfma_f32_16x16x32_bf16 v[140:143], a[160:163], a[236:239], v[140:143]
s_nop 0
buffer_load_dwordx4 a[44:47], v4, s[44:47], s69 offen offset:3072 sc1
v_permlane32_swap_b32 v128, v130
v_mfma_f32_16x16x32_bf16 v[144:147], a[160:163], a[240:243], v[144:147]
s_nop 0
ds_read_b64_tr_b16 v[212:213], v9 offset:4096
ds_read_b64_tr_b16 v[214:215], v9 offset:6144
v_permlane32_swap_b32 v129, v131
v_mfma_f32_16x16x32_bf16 v[144:147], a[164:167], a[236:239], v[144:147]
buffer_store_dwordx4 v[128:131], v166, s[44:47], s80 offen sc1
v_mfma_f32_16x16x32_bf16 v[144:147], a[168:171], a[232:235], v[144:147]
s_nop 0
ds_read_b64_tr_b16 v[216:217], v10 offset:4096
ds_read_b64_tr_b16 v[218:219], v10 offset:6144
v_mfma_f32_16x16x32_bf16 v[144:147], a[172:175], a[228:231], v[144:147]
s_add_u32 s69, s69, 0x20000
buffer_load_dwordx4 a[48:51], v4, s[44:47], s69 offen sc1
v_mfma_f32_16x16x32_bf16 v[144:147], a[176:179], a[224:227], v[144:147]
s_nop 0
ds_read_b64_tr_b16 v[220:221], v11 offset:4096
ds_read_b64_tr_b16 v[222:223], v11 offset:6144
v_cvt_pk_bf16_f32 v136, v136, v137
v_mfma_f32_16x16x32_bf16 v[148:151], a[180:183], a[224:227], v[148:151]
v_cvt_pk_bf16_f32 v137, v138, v139
v_cvt_pk_bf16_f32 v138, v140, v141
v_cvt_pk_bf16_f32 v139, v142, v143
v_mfma_f32_16x16x32_bf16 v[148:151], a[176:179], a[228:231], v[148:151]
s_nop 0
ds_read_b64_tr_b16 v[224:225], v8 offset:8192
ds_read_b64_tr_b16 v[226:227], v8 offset:10240
v_permlane32_swap_b32 v136, v138
v_mfma_f32_16x16x32_bf16 v[148:151], a[172:175], a[232:235], v[148:151]
v_permlane32_swap_b32 v137, v139
v_mfma_f32_16x16x32_bf16 v[148:151], a[168:171], a[236:239], v[148:151]
s_nop 0
ds_read_b64_tr_b16 v[228:229], v9 offset:8192
ds_read_b64_tr_b16 v[230:231], v9 offset:10240
v_mfma_f32_16x16x32_bf16 v[148:151], a[164:167], a[240:243], v[148:151]
buffer_load_dwordx4 a[52:55], v4, s[44:47], s69 offen offset:1024 sc1
v_mfma_f32_16x16x32_bf16 v[148:151], a[160:163], a[244:247], v[148:151]
s_nop 0
ds_read_b64_tr_b16 v[232:233], v10 offset:8192
ds_read_b64_tr_b16 v[234:235], v10 offset:10240
v_mfma_f32_16x16x32_bf16 v[152:155], a[160:163], a[248:251], v[152:155]
buffer_store_dwordx4 v[136:139], v166, s[44:47], s80 offen offset:1024 sc1
v_mfma_f32_16x16x32_bf16 v[152:155], a[164:167], a[244:247], v[152:155]
s_nop 0
ds_read_b64_tr_b16 v[236:237], v11 offset:8192
ds_read_b64_tr_b16 v[238:239], v11 offset:10240
v_mfma_f32_16x16x32_bf16 v[152:155], a[168:171], a[240:243], v[152:155]
buffer_load_dwordx4 a[56:59], v4, s[44:47], s69 offen offset:2048 sc1
v_mfma_f32_16x16x32_bf16 v[152:155], a[172:175], a[236:239], v[152:155]
s_nop 0
ds_read_b64_tr_b16 v[240:241], v8 offset:12288
ds_read_b64_tr_b16 v[242:243], v8 offset:14336
v_mfma_f32_16x16x32_bf16 v[152:155], a[176:179], a[232:235], v[152:155]
v_cvt_pk_bf16_f32 v144, v144, v145
v_cvt_pk_bf16_f32 v145, v146, v147
v_cvt_pk_bf16_f32 v146, v148, v149
v_mfma_f32_16x16x32_bf16 v[152:155], a[180:183], a[228:231], v[152:155]
s_nop 0
ds_read_b64_tr_b16 v[244:245], v9 offset:12288
ds_read_b64_tr_b16 v[246:247], v9 offset:14336
v_cvt_pk_bf16_f32 v147, v150, v151
v_mfma_f32_16x16x32_bf16 v[152:155], a[184:187], a[224:227], v[152:155]
v_permlane32_swap_b32 v144, v146
v_permlane32_swap_b32 v145, v147
v_mfma_f32_16x16x32_bf16 v[156:159], a[188:191], a[224:227], v[156:159]
s_nop 0
ds_read_b64_tr_b16 v[248:249], v10 offset:12288
ds_read_b64_tr_b16 v[250:251], v10 offset:14336
v_mfma_f32_16x16x32_bf16 v[156:159], a[184:187], a[228:231], v[156:159]
buffer_load_dwordx4 a[60:63], v4, s[44:47], s69 offen offset:3072 sc1
v_mfma_f32_16x16x32_bf16 v[156:159], a[180:183], a[232:235], v[156:159]
s_nop 0
ds_read_b64_tr_b16 v[252:253], v11 offset:12288
ds_read_b64_tr_b16 v[254:255], v11 offset:14336
v_mfma_f32_16x16x32_bf16 v[156:159], a[176:179], a[236:239], v[156:159]
buffer_store_dwordx4 v[144:147], v166, s[44:47], s80 offen offset:2048 sc1
v_mfma_f32_16x16x32_bf16 v[156:159], a[172:175], a[240:243], v[156:159]
v_mfma_f32_16x16x32_bf16 v[156:159], a[168:171], a[244:247], v[156:159]
v_mfma_f32_16x16x32_bf16 v[156:159], a[164:167], a[248:251], v[156:159]
v_mfma_f32_16x16x32_bf16 v[156:159], a[160:163], a[252:255], v[156:159]
v_cvt_pk_bf16_f32 v152, v152, v153
v_cvt_pk_bf16_f32 v153, v154, v155
s_nop 5
v_cvt_pk_bf16_f32 v154, v156, v157
v_cvt_pk_bf16_f32 v155, v158, v159
s_nop 0
v_permlane32_swap_b32 v152, v154
v_permlane32_swap_b32 v153, v155
buffer_store_dwordx4 v[152:155], v166, s[44:47], s80 offen offset:3072 sc1
s_waitcnt vmcnt(12) lgkmcnt(0)
s_cmp_lg_u32 s81, 0
s_cbranch_scc1 Lredo0
Lredo0b:
s_barrier
v_mfma_f32_16x16x32_bf16 v[16:19], v[192:195], a[0:3], 0
s_nop 0
ds_read_b64_tr_b16 v[128:129], v8 offset:16384
ds_read_b64_tr_b16 v[130:131], v8 offset:18432
v_mfma_f32_16x16x32_bf16 v[16:19], v[208:211], a[4:7], v[16:19]
s_xor_b32 s71, s13, 0x100
ds_read_b64_tr_b16 v[132:133], v9 offset:16384
ds_read_b64_tr_b16 v[134:135], v9 offset:18432
v_mfma_f32_16x16x32_bf16 v[16:19], v[224:227], a[8:11], v[16:19]
s_add_u32 m0, s85, 0
ds_read_b64_tr_b16 v[136:137], v10 offset:16384
ds_read_b64_tr_b16 v[138:139], v10 offset:18432
v_mfma_f32_16x16x32_bf16 v[16:19], v[240:243], a[12:15], v[16:19]
s_add_u32 s72, s71, 0
buffer_load_dwordx4 v15, s[24:27], s72 offen lds
v_mfma_f32_16x16x32_bf16 v[32:35], v[240:243], a[28:31], 0
s_lshr_b32 s69, s14, 18
ds_read_b64_tr_b16 v[140:141], v11 offset:16384
ds_read_b64_tr_b16 v[142:143], v11 offset:18432
v_mfma_f32_16x16x32_bf16 v[32:35], v[224:227], a[24:27], v[32:35]
s_lshl_b32 s69, s69, 12
v_add_u32 v4, s64, v1
v_add_u32 v4, 131072, v4
v_mfma_f32_16x16x32_bf16 v[32:35], v[208:211], a[20:23], v[32:35]
s_add_u32 s69, s69, s95
buffer_load_dwordx4 a[64:67], v1, s[44:47], s69 offen sc1
v_mfma_f32_16x16x32_bf16 v[32:35], v[192:195], a[16:19], v[32:35]
s_lshl_b32 s70, s75, 18
ds_read_b64_tr_b16 v[144:145], v8 offset:20480
ds_read_b64_tr_b16 v[146:147], v8 offset:22528
v_mfma_f32_16x16x32_bf16 v[36:39], v[196:199], a[16:19], 0
s_add_u32 s72, s71, 15360
buffer_load_dwordx4 v15, s[24:27], s72 offen offset:1024 lds
v_mfma_f32_16x16x32_bf16 v[36:39], v[212:215], a[20:23], v[36:39]
s_add_u32 s70, s70, s94
ds_read_b64_tr_b16 v[148:149], v9 offset:20480
ds_read_b64_tr_b16 v[150:151], v9 offset:22528
v_mfma_f32_16x16x32_bf16 v[36:39], v[228:231], a[24:27], v[36:39]
s_nop 0
ds_read_b64_tr_b16 v[152:153], v10 offset:20480
ds_read_b64_tr_b16 v[154:155], v10 offset:22528
v_mfma_f32_16x16x32_bf16 v[36:39], v[244:247], a[28:31], v[36:39]
s_nop 0
ds_read_b64_tr_b16 v[156:157], v11 offset:20480
ds_read_b64_tr_b16 v[158:159], v11 offset:22528
v_mfma_f32_16x16x32_bf16 v[20:23], v[244:247], a[12:15], 0
ds_write_b128 v4, v[80:83] offset:0
v_mfma_f32_16x16x32_bf16 v[20:23], v[228:231], a[8:11], v[20:23]
s_nop 0
ds_read_b64_tr_b16 v[160:161], v8 offset:24576
ds_read_b64_tr_b16 v[162:163], v8 offset:26624
v_mfma_f32_16x16x32_bf16 v[20:23], v[212:215], a[4:7], v[20:23]
s_add_u32 s72, s71, 30720
buffer_load_dwordx4 v15, s[24:27], s72 offen offset:2048 lds
v_mfma_f32_16x16x32_bf16 v[20:23], v[196:199], a[0:3], v[20:23]
buffer_load_dwordx4 a[68:71], v1, s[44:47], s69 offen offset:1024 sc1
v_mfma_f32_16x16x32_bf16 v[24:27], v[200:203], a[0:3], 0
s_nop 0
ds_read_b64_tr_b16 v[164:165], v9 offset:24576
ds_read_b64_tr_b16 v[166:167], v9 offset:26624
v_mfma_f32_16x16x32_bf16 v[24:27], v[216:219], a[4:7], v[24:27]
s_nop 0
ds_read_b64_tr_b16 v[168:169], v10 offset:24576
ds_read_b64_tr_b16 v[170:171], v10 offset:26624
v_mfma_f32_16x16x32_bf16 v[24:27], v[232:235], a[8:11], v[24:27]
s_nop 0
ds_read_b64_tr_b16 v[172:173], v11 offset:24576
ds_read_b64_tr_b16 v[174:175], v11 offset:26624
v_mfma_f32_16x16x32_bf16 v[24:27], v[248:251], a[12:15], v[24:27]
ds_write_b128 v4, v[84:87] offset:1024
v_mfma_f32_16x16x32_bf16 v[40:43], v[248:251], a[28:31], 0
s_add_u32 s72, s71, 46080
buffer_load_dwordx4 v15, s[24:27], s72 offen offset:3072 lds
v_mfma_f32_16x16x32_bf16 v[40:43], v[232:235], a[24:27], v[40:43]
s_nop 0
ds_read_b64_tr_b16 v[176:177], v8 offset:28672
ds_read_b64_tr_b16 v[178:179], v8 offset:30720
v_mfma_f32_16x16x32_bf16 v[40:43], v[216:219], a[20:23], v[40:43]
s_nop 0
ds_read_b64_tr_b16 v[180:181], v9 offset:28672
ds_read_b64_tr_b16 v[182:183], v9 offset:30720
v_mfma_f32_16x16x32_bf16 v[40:43], v[200:203], a[16:19], v[40:43]
s_nop 0
ds_read_b64_tr_b16 v[184:185], v10 offset:28672
ds_read_b64_tr_b16 v[186:187], v10 offset:30720
v_mfma_f32_16x16x32_bf16 v[44:47], v[204:207], a[16:19], 0
s_nop 0
ds_read_b64_tr_b16 v[188:189], v11 offset:28672
ds_read_b64_tr_b16 v[190:191], v11 offset:30720
v_mfma_f32_16x16x32_bf16 v[44:47], v[220:223], a[20:23], v[44:47]
buffer_load_dwordx4 a[72:75], v1, s[44:47], s69 offen offset:2048 sc1
v_mfma_f32_16x16x32_bf16 v[44:47], v[236:239], a[24:27], v[44:47]
ds_write_b128 v4, v[96:99] offset:2048
v_mfma_f32_16x16x32_bf16 v[44:47], v[252:255], a[28:31], v[44:47]
s_xor_b32 s71, s13, 0x180
v_mfma_f32_16x16x32_bf16 v[28:31], v[252:255], a[12:15], 0
s_add_u32 m0, s85, 16384
ds_write_b128 v4, v[100:103] offset:3072
v_mfma_f32_16x16x32_bf16 v[28:31], v[236:239], a[8:11], v[28:31]
s_add_u32 s72, s71, 0
v_mfma_f32_16x16x32_bf16 v[28:31], v[220:223], a[4:7], v[28:31]
s_waitcnt vmcnt(31) lgkmcnt(0)
buffer_load_dwordx4 v15, s[24:27], s72 offen lds
v_mfma_f32_16x16x32_bf16 v[28:31], v[204:207], a[0:3], v[28:31]
s_barrier
v_mfma_f32_16x16x32_bf16 v[48:51], v[128:131], a[0:3], 0
s_nop 0
ds_read_b64_tr_b16 v[192:193], v8 offset:32768
ds_read_b64_tr_b16 v[194:195], v8 offset:34816
v_mfma_f32_16x16x32_bf16 v[48:51], v[144:147], a[4:7], v[48:51]
s_nop 0
ds_read_b64_tr_b16 v[196:197], v9 offset:32768
ds_read_b64_tr_b16 v[198:199], v9 offset:34816
v_mfma_f32_16x16x32_bf16 v[48:51], v[160:163], a[8:11], v[48:51]
s_nop 0
ds_read_b64_tr_b16 v[200:201], v10 offset:32768
ds_read_b64_tr_b16 v[202:203], v10 offset:34816
v_mfma_f32_16x16x32_bf16 v[48:51], v[176:179], a[12:15], v[48:51]
s_add_u32 s72, s71, 15360
buffer_load_dwordx4 v15, s[24:27], s72 offen offset:1024 lds
v_mfma_f32_16x16x32_bf16 v[64:67], v[176:179], a[28:31], 0
buffer_load_dwordx4 a[76:79], v1, s[44:47], s69 offen offset:3072 sc1
v_mfma_f32_16x16x32_bf16 v[64:67], v[160:163], a[24:27], v[64:67]
s_nop 0
ds_read_b64_tr_b16 v[204:205], v11 offset:32768
ds_read_b64_tr_b16 v[206:207], v11 offset:34816
v_mfma_f32_16x16x32_bf16 v[64:67], v[144:147], a[20:23], v[64:67]
v_mfma_f32_16x16x32_bf16 v[64:67], v[128:131], a[16:19], v[64:67]
s_nop 0
ds_read_b64_tr_b16 v[208:209], v8 offset:36864
ds_read_b64_tr_b16 v[210:211], v8 offset:38912
v_mfma_f32_16x16x32_bf16 v[68:71], v[132:135], a[16:19], 0
s_nop 0
ds_read_b64_tr_b16 v[212:213], v9 offset:36864
ds_read_b64_tr_b16 v[214:215], v9 offset:38912
v_mfma_f32_16x16x32_bf16 v[68:71], v[148:151], a[20:23], v[68:71]
s_add_u32 s72, s71, 30720
buffer_load_dwordx4 v15, s[24:27], s72 offen offset:2048 lds
v_mfma_f32_16x16x32_bf16 v[68:71], v[164:167], a[24:27], v[68:71]
s_nop 0
ds_read_b64_tr_b16 v[216:217], v10 offset:36864
ds_read_b64_tr_b16 v[218:219], v10 offset:38912
v_mfma_f32_16x16x32_bf16 v[68:71], v[180:183], a[28:31], v[68:71]
s_nop 0
ds_read_b64_tr_b16 v[220:221], v11 offset:36864
ds_read_b64_tr_b16 v[222:223], v11 offset:38912
v_mfma_f32_16x16x32_bf16 v[52:55], v[180:183], a[12:15], 0
v_mfma_f32_16x16x32_bf16 v[52:55], v[164:167], a[8:11], v[52:55]
s_add_u32 s69, s69, 0x20000
buffer_load_dwordx4 a[80:83], v1, s[44:47], s69 offen sc1
v_mfma_f32_16x16x32_bf16 v[52:55], v[148:151], a[4:7], v[52:55]
s_nop 0
ds_read_b64_tr_b16 v[224:225], v8 offset:40960
ds_read_b64_tr_b16 v[226:227], v8 offset:43008
v_mfma_f32_16x16x32_bf16 v[52:55], v[132:135], a[0:3], v[52:55]
s_add_u32 s72, s71, 46080
buffer_load_dwordx4 v15, s[24:27], s72 offen offset:3072 lds
v_mfma_f32_16x16x32_bf16 v[56:59], v[136:139], a[0:3], 0
s_nop 0
ds_read_b64_tr_b16 v[228:229], v9 offset:40960
ds_read_b64_tr_b16 v[230:231], v9 offset:43008
v_mfma_f32_16x16x32_bf16 v[56:59], v[152:155], a[4:7], v[56:59]
s_nop 0
ds_read_b64_tr_b16 v[232:233], v10 offset:40960
ds_read_b64_tr_b16 v[234:235], v10 offset:43008
v_mfma_f32_16x16x32_bf16 v[56:59], v[168:171], a[8:11], v[56:59]
s_nop 0
ds_read_b64_tr_b16 v[236:237], v11 offset:40960
ds_read_b64_tr_b16 v[238:239], v11 offset:43008
v_mfma_f32_16x16x32_bf16 v[56:59], v[184:187], a[12:15], v[56:59]
v_mfma_f32_16x16x32_bf16 v[72:75], v[184:187], a[28:31], 0
s_nop 0
ds_read_b64_tr_b16 v[240:241], v8 offset:45056
ds_read_b64_tr_b16 v[242:243], v8 offset:47104
v_mfma_f32_16x16x32_bf16 v[72:75], v[168:171], a[24:27], v[72:75]
s_nop 0
ds_read_b64_tr_b16 v[244:245], v9 offset:45056
ds_read_b64_tr_b16 v[246:247], v9 offset:47104
v_mfma_f32_16x16x32_bf16 v[72:75], v[152:155], a[20:23], v[72:75]
s_nop 0
ds_read_b64_tr_b16 v[248:249], v10 offset:45056
ds_read_b64_tr_b16 v[250:251], v10 offset:47104
v_mfma_f32_16x16x32_bf16 v[72:75], v[136:139], a[16:19], v[72:75]
s_xor_b32 s71, s14, 0x80
buffer_load_dwordx4 a[84:87], v1, s[44:47], s69 offen offset:1024 sc1
v_mfma_f32_16x16x32_bf16 v[76:79], v[140:143], a[16:19], 0
s_add_u32 m0, s85, 32768
ds_read_b64_tr_b16 v[252:253], v11 offset:45056
ds_read_b64_tr_b16 v[254:255], v11 offset:47104
v_mfma_f32_16x16x32_bf16 v[76:79], v[156:159], a[20:23], v[76:79]
s_add_u32 s72, s71, 0
buffer_load_dwordx4 v15, s[24:27], s72 offen lds
v_mfma_f32_16x16x32_bf16 v[76:79], v[172:175], a[24:27], v[76:79]
v_mfma_f32_16x16x32_bf16 v[76:79], v[188:191], a[28:31], v[76:79]
v_mfma_f32_16x16x32_bf16 v[60:63], v[188:191], a[12:15], 0
v_mfma_f32_16x16x32_bf16 v[60:63], v[172:175], a[8:11], v[60:63]
s_add_u32 s72, s71, 15360
v_mfma_f32_16x16x32_bf16 v[60:63], v[156:159], a[4:7], v[60:63]
s_waitcnt vmcnt(35) lgkmcnt(0)
v_mfma_f32_16x16x32_bf16 v[60:63], v[140:143], a[0:3], v[60:63]
s_barrier
buffer_load_dwordx4 v15, s[24:27], s72 offen offset:1024 lds
v_mfma_f32_16x16x32_bf16 v[80:83], v[192:195], a[0:3], 0
s_nop 0
ds_read_b64_tr_b16 v[128:129], v8 offset:49152
ds_read_b64_tr_b16 v[130:131], v8 offset:51200
v_mfma_f32_16x16x32_bf16 v[80:83], v[208:211], a[4:7], v[80:83]
buffer_load_dwordx4 a[88:91], v1, s[44:47], s69 offen offset:2048 sc1
v_mfma_f32_16x16x32_bf16 v[80:83], v[224:227], a[8:11], v[80:83]
s_nop 0
ds_read_b64_tr_b16 v[132:133], v9 offset:49152
ds_read_b64_tr_b16 v[134:135], v9 offset:51200
v_mfma_f32_16x16x32_bf16 v[80:83], v[240:243], a[12:15], v[80:83]
s_nop 0
ds_read_b64_tr_b16 v[136:137], v10 offset:49152
ds_read_b64_tr_b16 v[138:139], v10 offset:51200
v_mfma_f32_16x16x32_bf16 v[96:99], v[240:243], a[28:31], 0
s_nop 0
ds_read_b64_tr_b16 v[140:141], v11 offset:49152
ds_read_b64_tr_b16 v[142:143], v11 offset:51200
v_mfma_f32_16x16x32_bf16 v[96:99], v[224:227], a[24:27], v[96:99]
s_add_u32 s72, s71, 30720
buffer_load_dwordx4 v15, s[24:27], s72 offen offset:2048 lds
v_mfma_f32_16x16x32_bf16 v[96:99], v[208:211], a[20:23], v[96:99]
v_mfma_f32_16x16x32_bf16 v[96:99], v[192:195], a[16:19], v[96:99]
s_nop 0
ds_read_b64_tr_b16 v[144:145], v8 offset:53248
ds_read_b64_tr_b16 v[146:147], v8 offset:55296
v_mfma_f32_16x16x32_bf16 v[100:103], v[196:199], a[16:19], 0
s_nop 0
ds_read_b64_tr_b16 v[148:149], v9 offset:53248
ds_read_b64_tr_b16 v[150:151], v9 offset:55296
v_mfma_f32_16x16x32_bf16 v[100:103], v[212:215], a[20:23], v[100:103]
s_nop 0
ds_read_b64_tr_b16 v[152:153], v10 offset:53248
ds_read_b64_tr_b16 v[154:155], v10 offset:55296
v_mfma_f32_16x16x32_bf16 v[100:103], v[228:231], a[24:27], v[100:103]
s_nop 0
ds_read_b64_tr_b16 v[156:157], v11 offset:53248
ds_read_b64_tr_b16 v[158:159], v11 offset:55296
v_mfma_f32_16x16x32_bf16 v[100:103], v[244:247], a[28:31], v[100:103]
s_add_u32 s72, s71, 46080
buffer_load_dwordx4 v15, s[24:27], s72 offen offset:3072 lds
v_mfma_f32_16x16x32_bf16 v[84:87], v[244:247], a[12:15], 0
buffer_load_dwordx4 a[92:95], v1, s[44:47], s69 offen offset:3072 sc1
v_mfma_f32_16x16x32_bf16 v[84:87], v[228:231], a[8:11], v[84:87]
v_mfma_f32_16x16x32_bf16 v[84:87], v[212:215], a[4:7], v[84:87]
s_nop 0
ds_read_b64_tr_b16 v[160:161], v8 offset:57344
ds_read_b64_tr_b16 v[162:163], v8 offset:59392
v_mfma_f32_16x16x32_bf16 v[84:87], v[196:199], a[0:3], v[84:87]
s_nop 0
ds_read_b64_tr_b16 v[164:165], v9 offset:57344
ds_read_b64_tr_b16 v[166:167], v9 offset:59392
v_mfma_f32_16x16x32_bf16 v[88:91], v[200:203], a[0:3], 0
s_nop 0
ds_read_b64_tr_b16 v[168:169], v10 offset:57344
ds_read_b64_tr_b16 v[170:171], v10 offset:59392
v_mfma_f32_16x16x32_bf16 v[88:91], v[216:219], a[4:7], v[88:91]
s_xor_b32 s82, s78, 16
ds_read_b64_tr_b16 v[172:173], v11 offset:57344
ds_read_b64_tr_b16 v[174:175], v11 offset:59392
v_mfma_f32_16x16x32_bf16 v[88:91], v[232:235], a[8:11], v[88:91]
s_lshl_b32 s82, s82, 10
v_mfma_f32_16x16x32_bf16 v[88:91], v[248:251], a[12:15], v[88:91]
s_xor_b32 s71, s14, 0x100
ds_read_b64_tr_b16 v[176:177], v8 offset:61440
ds_read_b64_tr_b16 v[178:179], v8 offset:63488
v_mfma_f32_16x16x32_bf16 v[104:107], v[248:251], a[28:31], 0
s_add_u32 m0, s85, 49152
ds_read_b64_tr_b16 v[180:181], v9 offset:61440
ds_read_b64_tr_b16 v[182:183], v9 offset:63488
v_mfma_f32_16x16x32_bf16 v[104:107], v[232:235], a[24:27], v[104:107]
s_add_u32 s72, s71, 0
buffer_load_dwordx4 v15, s[24:27], s72 offen lds
v_mfma_f32_16x16x32_bf16 v[104:107], v[216:219], a[20:23], v[104:107]
s_add_u32 s82, s82, s74
buffer_load_dword v3, v2, s[44:47], s82 offen sc1
v_mfma_f32_16x16x32_bf16 v[104:107], v[200:203], a[16:19], v[104:107]
s_nop 0
ds_read_b64_tr_b16 v[184:185], v10 offset:61440
ds_read_b64_tr_b16 v[186:187], v10 offset:63488
v_mfma_f32_16x16x32_bf16 v[108:111], v[204:207], a[16:19], 0
s_nop 0
ds_read_b64_tr_b16 v[188:189], v11 offset:61440
ds_read_b64_tr_b16 v[190:191], v11 offset:63488
v_mfma_f32_16x16x32_bf16 v[108:111], v[220:223], a[20:23], v[108:111]
v_mfma_f32_16x16x32_bf16 v[108:111], v[236:239], a[24:27], v[108:111]
s_add_u32 s72, s71, 15360
buffer_load_dwordx4 v15, s[24:27], s72 offen offset:1024 lds
v_mfma_f32_16x16x32_bf16 v[108:111], v[252:255], a[28:31], v[108:111]
s_lshr_b32 s69, s15, 18
v_mfma_f32_16x16x32_bf16 v[92:95], v[252:255], a[12:15], 0
s_lshl_b32 s69, s69, 12
v_xor_b32 v8, 0x10000, v8
Lstube0:
s_cbranch_execz Lstube4
v_mfma_f32_16x16x32_bf16 v[92:95], v[236:239], a[8:11], v[92:95]
s_add_u32 s69, s69, s95
v_xor_b32 v9, 0x10000, v9
v_mfma_f32_16x16x32_bf16 v[92:95], v[220:223], a[4:7], v[92:95]
s_waitcnt vmcnt(17) lgkmcnt(0)
v_xor_b32 v10, 0x10000, v10
v_mfma_f32_16x16x32_bf16 v[92:95], v[204:207], a[0:3], v[92:95]
s_barrier
buffer_load_dwordx4 a[96:99], v1, s[44:47], s69 offen sc1
v_xor_b32 v11, 0x10000, v11
v_mfma_f32_16x16x32_bf16 v[16:19], v[128:131], a[32:35], v[16:19]
s_add_u32 s72, s71, 30720
buffer_load_dwordx4 v15, s[24:27], s72 offen offset:2048 lds
v_mfma_f32_16x16x32_bf16 v[16:19], v[144:147], a[36:39], v[16:19]
s_nop 0
ds_read_b64_tr_b16 v[192:193], v8 offset:0
ds_read_b64_tr_b16 v[194:195], v8 offset:2048
v_mfma_f32_16x16x32_bf16 v[16:19], v[160:163], a[40:43], v[16:19]
s_nop 0
ds_read_b64_tr_b16 v[196:197], v9 offset:0
ds_read_b64_tr_b16 v[198:199], v9 offset:2048
v_mfma_f32_16x16x32_bf16 v[16:19], v[176:179], a[44:47], v[16:19]
s_nop 0
ds_read_b64_tr_b16 v[200:201], v10 offset:0
ds_read_b64_tr_b16 v[202:203], v10 offset:2048
v_mfma_f32_16x16x32_bf16 v[32:35], v[176:179], a[60:63], v[32:35]
s_nop 0
ds_read_b64_tr_b16 v[204:205], v11 offset:0
ds_read_b64_tr_b16 v[206:207], v11 offset:2048
v_mfma_f32_16x16x32_bf16 v[32:35], v[160:163], a[56:59], v[32:35]
v_or_b32 v112, s58, v0
v_mov_b32 v113, 3
v_mfma_f32_16x16x32_bf16 v[32:35], v[144:147], a[52:55], v[32:35]
s_add_u32 s72, s71, 46080
buffer_load_dwordx4 v15, s[24:27], s72 offen offset:3072 lds
v_mfma_f32_16x16x32_bf16 v[32:35], v[128:131], a[48:51], v[32:35]
s_nop 0
ds_read_b64_tr_b16 v[208:209], v8 offset:4096
ds_read_b64_tr_b16 v[210:211], v8 offset:6144
v_mfma_f32_16x16x32_bf16 v[36:39], v[132:135], a[48:51], v[36:39]
s_nop 0
ds_read_b64_tr_b16 v[212:213], v9 offset:4096
ds_read_b64_tr_b16 v[214:215], v9 offset:6144
v_mfma_f32_16x16x32_bf16 v[36:39], v[148:151], a[52:55], v[36:39]
buffer_load_dwordx4 a[100:103], v1, s[44:47], s69 offen offset:1024 sc1
v_mfma_f32_16x16x32_bf16 v[36:39], v[164:167], a[56:59], v[36:39]
s_nop 0
ds_read_b64_tr_b16 v[216:217], v10 offset:4096
ds_read_b64_tr_b16 v[218:219], v10 offset:6144
v_mfma_f32_16x16x32_bf16 v[36:39], v[180:183], a[60:63], v[36:39]
v_min_u32 v112, 1, v112
v_lshlrev_b32 v112, 30, v112
v_mfma_f32_16x16x32_bf16 v[20:23], v[180:183], a[44:47], v[20:23]
s_nop 0
ds_read_b64_tr_b16 v[220:221], v11 offset:4096
ds_read_b64_tr_b16 v[222:223], v11 offset:6144
v_mfma_f32_16x16x32_bf16 v[20:23], v[164:167], a[40:43], v[20:23]
s_nop 0
ds_read_b64_tr_b16 v[224:225], v8 offset:8192
ds_read_b64_tr_b16 v[226:227], v8 offset:10240
v_mfma_f32_16x16x32_bf16 v[20:23], v[148:151], a[36:39], v[20:23]
s_xor_b32 s71, s14, 0x180
ds_read_b64_tr_b16 v[228:229], v9 offset:8192
ds_read_b64_tr_b16 v[230:231], v9 offset:10240
v_mfma_f32_16x16x32_bf16 v[20:23], v[132:135], a[32:35], v[20:23]
s_add_u32 m0, s77, 0
buffer_store_dword v113, v112, s[44:47], s91 offen sc1
v_mfma_f32_16x16x32_bf16 v[24:27], v[136:139], a[32:35], v[24:27]
s_add_u32 s72, s71, 0
buffer_load_dwordx4 v15, s[24:27], s72 offen lds
v_mfma_f32_16x16x32_bf16 v[24:27], v[152:155], a[36:39], v[24:27]
s_nop 0
ds_read_b64_tr_b16 v[232:233], v10 offset:8192
ds_read_b64_tr_b16 v[234:235], v10 offset:10240
v_mfma_f32_16x16x32_bf16 v[24:27], v[168:171], a[40:43], v[24:27]
s_nop 0
ds_read_b64_tr_b16 v[236:237], v11 offset:8192
ds_read_b64_tr_b16 v[238:239], v11 offset:10240
v_mfma_f32_16x16x32_bf16 v[24:27], v[184:187], a[44:47], v[24:27]
buffer_load_dwordx4 a[104:107], v1, s[44:47], s69 offen offset:2048 sc1
v_mfma_f32_16x16x32_bf16 v[40:43], v[184:187], a[60:63], v[40:43]
s_nop 0
ds_read_b64_tr_b16 v[240:241], v8 offset:12288
ds_read_b64_tr_b16 v[242:243], v8 offset:14336
v_mfma_f32_16x16x32_bf16 v[40:43], v[168:171], a[56:59], v[40:43]
v_mfma_f32_16x16x32_bf16 v[40:43], v[152:155], a[52:55], v[40:43]
s_add_u32 s72, s71, 15360
buffer_load_dwordx4 v15, s[24:27], s72 offen offset:1024 lds
v_mfma_f32_16x16x32_bf16 v[40:43], v[136:139], a[48:51], v[40:43]
s_nop 0
ds_read_b64_tr_b16 v[244:245], v9 offset:12288
ds_read_b64_tr_b16 v[246:247], v9 offset:14336
v_mfma_f32_16x16x32_bf16 v[44:47], v[140:143], a[48:51], v[44:47]
s_nop 0
ds_read_b64_tr_b16 v[248:249], v10 offset:12288
ds_read_b64_tr_b16 v[250:251], v10 offset:14336
v_mfma_f32_16x16x32_bf16 v[44:47], v[156:159], a[52:55], v[44:47]
s_nop 0
ds_read_b64_tr_b16 v[252:253], v11 offset:12288
ds_read_b64_tr_b16 v[254:255], v11 offset:14336
v_mfma_f32_16x16x32_bf16 v[44:47], v[172:175], a[56:59], v[44:47]
v_mfma_f32_16x16x32_bf16 v[44:47], v[188:191], a[60:63], v[44:47]
v_mfma_f32_16x16x32_bf16 v[28:31], v[188:191], a[44:47], v[28:31]
s_add_u32 s72, s71, 30720
buffer_load_dwordx4 v15, s[24:27], s72 offen offset:2048 lds
v_mfma_f32_16x16x32_bf16 v[28:31], v[172:175], a[40:43], v[28:31]
buffer_load_dwordx4 a[108:111], v1, s[44:47], s69 offen offset:3072 sc1
v_mfma_f32_16x16x32_bf16 v[28:31], v[156:159], a[36:39], v[28:31]
s_waitcnt vmcnt(20) lgkmcnt(0)
v_mfma_f32_16x16x32_bf16 v[28:31], v[140:143], a[32:35], v[28:31]
s_barrier
v_mfma_f32_16x16x32_bf16 v[48:51], v[192:195], a[32:35], v[48:51]
s_nop 0
ds_read_b64_tr_b16 v[128:129], v8 offset:16384
ds_read_b64_tr_b16 v[130:131], v8 offset:18432
v_mfma_f32_16x16x32_bf16 v[48:51], v[208:211], a[36:39], v[48:51]
s_nop 0
ds_read_b64_tr_b16 v[132:133], v9 offset:16384
ds_read_b64_tr_b16 v[134:135], v9 offset:18432
v_mfma_f32_16x16x32_bf16 v[48:51], v[224:227], a[40:43], v[48:51]
s_add_u32 s72, s71, 46080
buffer_load_dwordx4 v15, s[24:27], s72 offen offset:3072 lds
v_mfma_f32_16x16x32_bf16 v[48:51], v[240:243], a[44:47], v[48:51]
s_nop 0
ds_read_b64_tr_b16 v[136:137], v10 offset:16384
ds_read_b64_tr_b16 v[138:139], v10 offset:18432
v_mfma_f32_16x16x32_bf16 v[64:67], v[240:243], a[60:63], v[64:67]
s_nop 0
ds_read_b64_tr_b16 v[140:141], v11 offset:16384
ds_read_b64_tr_b16 v[142:143], v11 offset:18432
v_mfma_f32_16x16x32_bf16 v[64:67], v[224:227], a[56:59], v[64:67]
v_and_b32 v120, 15, v0
v_lshrrev_b32 v121, 4, v0
v_mfma_f32_16x16x32_bf16 v[64:67], v[208:211], a[52:55], v[64:67]
s_nop 0
ds_read_b64_tr_b16 v[144:145], v8 offset:20480
ds_read_b64_tr_b16 v[146:147], v8 offset:22528
v_mfma_f32_16x16x32_bf16 v[64:67], v[192:195], a[48:51], v[64:67]
s_add_u32 s69, s69, 0x20000
buffer_load_dwordx4 a[112:115], v1, s[44:47], s69 offen sc1
v_mfma_f32_16x16x32_bf16 v[68:71], v[196:199], a[48:51], v[68:71]
s_nop 0
ds_read_b64_tr_b16 v[148:149], v9 offset:20480
ds_read_b64_tr_b16 v[150:151], v9 offset:22528
v_mfma_f32_16x16x32_bf16 v[68:71], v[212:215], a[52:55], v[68:71]
s_nop 0
ds_read_b64_tr_b16 v[152:153], v10 offset:20480
ds_read_b64_tr_b16 v[154:155], v10 offset:22528
v_mfma_f32_16x16x32_bf16 v[68:71], v[228:231], a[56:59], v[68:71]
s_xor_b32 s71, s15, 0x80
v_lshlrev_b32 v121, 2, v121
v_sub_u32 v120, v120, v121
v_mfma_f32_16x16x32_bf16 v[68:71], v[244:247], a[60:63], v[68:71]
s_add_u32 m0, s77, 16384
ds_read_b64_tr_b16 v[156:157], v11 offset:20480
ds_read_b64_tr_b16 v[158:159], v11 offset:22528
v_mfma_f32_16x16x32_bf16 v[52:55], v[244:247], a[44:47], v[52:55]
s_add_u32 s72, s71, 0
buffer_load_dwordx4 v15, s[24:27], s72 offen lds
v_mfma_f32_16x16x32_bf16 v[52:55], v[228:231], a[40:43], v[52:55]
s_nop 0
ds_read_b64_tr_b16 v[160:161], v8 offset:24576
ds_read_b64_tr_b16 v[162:163], v8 offset:26624
v_mfma_f32_16x16x32_bf16 v[52:55], v[212:215], a[36:39], v[52:55]
s_nop 0
ds_read_b64_tr_b16 v[164:165], v9 offset:24576
ds_read_b64_tr_b16 v[166:167], v9 offset:26624
v_mfma_f32_16x16x32_bf16 v[52:55], v[196:199], a[32:35], v[52:55]
v_min_u32 v120, 4, v120
v_lshlrev_b32 v120, 3, v120
v_mfma_f32_16x16x32_bf16 v[56:59], v[200:203], a[32:35], v[56:59]
s_nop 0
ds_read_b64_tr_b16 v[168:169], v10 offset:24576
ds_read_b64_tr_b16 v[170:171], v10 offset:26624
v_mfma_f32_16x16x32_bf16 v[56:59], v[216:219], a[36:39], v[56:59]
s_add_u32 s72, s71, 15360
buffer_load_dwordx4 v15, s[24:27], s72 offen offset:1024 lds
v_mfma_f32_16x16x32_bf16 v[56:59], v[232:235], a[40:43], v[56:59]
buffer_load_dwordx4 a[116:119], v1, s[44:47], s69 offen offset:1024 sc1
v_mfma_f32_16x16x32_bf16 v[56:59], v[248:251], a[44:47], v[56:59]
s_nop 0
ds_read_b64_tr_b16 v[172:173], v11 offset:24576
ds_read_b64_tr_b16 v[174:175], v11 offset:26624
v_mfma_f32_16x16x32_bf16 v[72:75], v[248:251], a[60:63], v[72:75]
s_nop 0
ds_read_b64_tr_b16 v[176:177], v8 offset:28672
ds_read_b64_tr_b16 v[178:179], v8 offset:30720
v_mfma_f32_16x16x32_bf16 v[72:75], v[232:235], a[56:59], v[72:75]
v_mov_b32 v122, 0x3f80
v_mov_b32 v123, 0
v_mfma_f32_16x16x32_bf16 v[72:75], v[216:219], a[52:55], v[72:75]
s_nop 0
ds_read_b64_tr_b16 v[180:181], v9 offset:28672
ds_read_b64_tr_b16 v[182:183], v9 offset:30720
v_mfma_f32_16x16x32_bf16 v[72:75], v[200:203], a[48:51], v[72:75]
s_add_u32 s72, s71, 30720
buffer_load_dwordx4 v15, s[24:27], s72 offen offset:2048 lds
v_mfma_f32_16x16x32_bf16 v[76:79], v[204:207], a[48:51], v[76:79]
s_nop 0
ds_read_b64_tr_b16 v[184:185], v10 offset:28672
ds_read_b64_tr_b16 v[186:187], v10 offset:30720
v_mfma_f32_16x16x32_bf16 v[76:79], v[220:223], a[52:55], v[76:79]
s_nop 0
ds_read_b64_tr_b16 v[188:189], v11 offset:28672
ds_read_b64_tr_b16 v[190:191], v11 offset:30720
v_mfma_f32_16x16x32_bf16 v[76:79], v[236:239], a[56:59], v[76:79]
v_lshlrev_b64 v[122:123], v120, v[122:123]
v_mov_b32 v126, 0
v_mfma_f32_16x16x32_bf16 v[76:79], v[252:255], a[60:63], v[76:79]
buffer_load_dwordx4 a[120:123], v1, s[44:47], s69 offen offset:2048 sc1
v_mfma_f32_16x16x32_bf16 v[60:63], v[252:255], a[44:47], v[60:63]
v_lshlrev_b64 v[122:123], v120, v[122:123]
v_mov_b32 v127, 0
v_mfma_f32_16x16x32_bf16 v[60:63], v[236:239], a[40:43], v[60:63]
s_add_u32 s72, s71, 46080
buffer_load_dwordx4 v15, s[24:27], s72 offen offset:3072 lds
v_mfma_f32_16x16x32_bf16 v[60:63], v[220:223], a[36:39], v[60:63]
s_waitcnt vmcnt(22) lgkmcnt(0)
v_mov_b32 v120, 0
v_mov_b32 v121, 0
v_mfma_f32_16x16x32_bf16 v[60:63], v[204:207], a[32:35], v[60:63]
s_barrier
v_mov_b32 v124, v122
v_mov_b32 v125, v123
v_mfma_f32_16x16x32_bf16 v[80:83], v[128:131], a[32:35], v[80:83]
s_nop 0
ds_read_b64_tr_b16 v[192:193], v8 offset:32768
ds_read_b64_tr_b16 v[194:195], v8 offset:34816
v_mfma_f32_16x16x32_bf16 v[80:83], v[144:147], a[36:39], v[80:83]
s_nop 0
ds_read_b64_tr_b16 v[196:197], v9 offset:32768
ds_read_b64_tr_b16 v[198:199], v9 offset:34816
v_mfma_f32_16x16x32_bf16 v[80:83], v[160:163], a[40:43], v[80:83]
s_nop 0
ds_read_b64_tr_b16 v[200:201], v10 offset:32768
ds_read_b64_tr_b16 v[202:203], v10 offset:34816
v_mfma_f32_16x16x32_bf16 v[80:83], v[176:179], a[44:47], v[80:83]
s_nop 0
ds_read_b64_tr_b16 v[204:205], v11 offset:32768
ds_read_b64_tr_b16 v[206:207], v11 offset:34816
v_mfma_f32_16x16x32_bf16 v[96:99], v[176:179], a[60:63], v[96:99]
v_mfma_f32_16x16x32_bf16 v[96:99], v[160:163], a[56:59], v[96:99]
s_xor_b32 s71, s15, 0x100
buffer_load_dwordx4 a[124:127], v1, s[44:47], s69 offen offset:3072 sc1
v_mfma_f32_16x16x32_bf16 v[96:99], v[144:147], a[52:55], v[96:99]
s_add_u32 m0, s77, 32768
ds_read_b64_tr_b16 v[208:209], v8 offset:36864
ds_read_b64_tr_b16 v[210:211], v8 offset:38912
v_mfma_f32_16x16x32_bf16 v[96:99], v[128:131], a[48:51], v[96:99]
s_add_u32 s72, s71, 0
buffer_load_dwordx4 v15, s[24:27], s72 offen lds
v_mfma_f32_16x16x32_bf16 v[100:103], v[132:135], a[48:51], v[100:103]
s_nop 0
ds_read_b64_tr_b16 v[212:213], v9 offset:36864
ds_read_b64_tr_b16 v[214:215], v9 offset:38912
v_mfma_f32_16x16x32_bf16 v[100:103], v[148:151], a[52:55], v[100:103]
s_nop 0
ds_read_b64_tr_b16 v[216:217], v10 offset:36864
ds_read_b64_tr_b16 v[218:219], v10 offset:38912
v_mfma_f32_16x16x32_bf16 v[100:103], v[164:167], a[56:59], v[100:103]
s_nop 0
ds_read_b64_tr_b16 v[220:221], v11 offset:36864
ds_read_b64_tr_b16 v[222:223], v11 offset:38912
v_mfma_f32_16x16x32_bf16 v[100:103], v[180:183], a[60:63], v[100:103]
v_mfma_f32_16x16x32_bf16 v[84:87], v[180:183], a[44:47], v[84:87]
s_nop 0
ds_read_b64_tr_b16 v[224:225], v8 offset:40960
ds_read_b64_tr_b16 v[226:227], v8 offset:43008
v_mfma_f32_16x16x32_bf16 v[84:87], v[164:167], a[40:43], v[84:87]
s_add_u32 s72, s71, 15360
buffer_load_dwordx4 v15, s[24:27], s72 offen offset:1024 lds
v_mfma_f32_16x16x32_bf16 v[84:87], v[148:151], a[36:39], v[84:87]
s_nop 0
ds_read_b64_tr_b16 v[228:229], v9 offset:40960
ds_read_b64_tr_b16 v[230:231], v9 offset:43008
v_mfma_f32_16x16x32_bf16 v[84:87], v[132:135], a[32:35], v[84:87]
s_waitcnt vmcnt(22)
v_cmp_gt_u32 vcc, 2, v3
s_cbranch_vccnz Lspin106
Lback107:
s_lshr_b32 s69, s12, 18
s_lshl_b32 s69, s69, 12
s_add_u32 s69, s69, s95
s_xor_b32 s69, s69, 0x10000
buffer_load_dwordx4 a[128:131], v1, s[44:47], s69 offen sc1
v_mfma_f32_16x16x32_bf16 v[88:91], v[136:139], a[32:35], v[88:91]
s_nop 0
ds_read_b64_tr_b16 v[232:233], v10 offset:40960
ds_read_b64_tr_b16 v[234:235], v10 offset:43008
v_mfma_f32_16x16x32_bf16 v[88:91], v[152:155], a[36:39], v[88:91]
s_nop 0
ds_read_b64_tr_b16 v[236:237], v11 offset:40960
ds_read_b64_tr_b16 v[238:239], v11 offset:43008
v_mfma_f32_16x16x32_bf16 v[88:91], v[168:171], a[40:43], v[88:91]
v_mfma_f32_16x16x32_bf16 v[88:91], v[184:187], a[44:47], v[88:91]
s_add_u32 s72, s71, 30720
buffer_load_dwordx4 v15, s[24:27], s72 offen offset:2048 lds
v_mfma_f32_16x16x32_bf16 v[104:107], v[184:187], a[60:63], v[104:107]
s_nop 0
ds_read_b64_tr_b16 v[240:241], v8 offset:45056
ds_read_b64_tr_b16 v[242:243], v8 offset:47104
v_mfma_f32_16x16x32_bf16 v[104:107], v[168:171], a[56:59], v[104:107]
s_nop 0
ds_read_b64_tr_b16 v[244:245], v9 offset:45056
ds_read_b64_tr_b16 v[246:247], v9 offset:47104
v_mfma_f32_16x16x32_bf16 v[104:107], v[152:155], a[52:55], v[104:107]
s_nop 0
ds_read_b64_tr_b16 v[248:249], v10 offset:45056
ds_read_b64_tr_b16 v[250:251], v10 offset:47104
v_mfma_f32_16x16x32_bf16 v[104:107], v[136:139], a[48:51], v[104:107]
s_nop 0
ds_read_b64_tr_b16 v[252:253], v11 offset:45056
ds_read_b64_tr_b16 v[254:255], v11 offset:47104
v_mfma_f32_16x16x32_bf16 v[108:111], v[140:143], a[48:51], v[108:111]
v_mfma_f32_16x16x32_bf16 v[108:111], v[156:159], a[52:55], v[108:111]
s_add_u32 s72, s71, 46080
buffer_load_dwordx4 v15, s[24:27], s72 offen offset:3072 lds
v_mfma_f32_16x16x32_bf16 v[108:111], v[172:175], a[56:59], v[108:111]
buffer_load_dwordx4 a[132:135], v1, s[44:47], s69 offen offset:1024 sc1
v_mfma_f32_16x16x32_bf16 v[108:111], v[188:191], a[60:63], v[108:111]
v_mfma_f32_16x16x32_bf16 v[92:95], v[188:191], a[44:47], v[92:95]
v_mfma_f32_16x16x32_bf16 v[92:95], v[172:175], a[40:43], v[92:95]
v_mfma_f32_16x16x32_bf16 v[92:95], v[156:159], a[36:39], v[92:95]
s_waitcnt vmcnt(22) lgkmcnt(0)
v_mfma_f32_16x16x32_bf16 v[92:95], v[140:143], a[32:35], v[92:95]
s_barrier
v_mfma_f32_16x16x32_bf16 v[16:19], v[192:195], a[64:67], v[16:19]
s_nop 0
ds_read_b64_tr_b16 v[128:129], v8 offset:49152
ds_read_b64_tr_b16 v[130:131], v8 offset:51200
v_mfma_f32_16x16x32_bf16 v[16:19], v[208:211], a[68:71], v[16:19]
s_xor_b32 s71, s15, 0x180
ds_read_b64_tr_b16 v[132:133], v9 offset:49152
ds_read_b64_tr_b16 v[134:135], v9 offset:51200
v_mfma_f32_16x16x32_bf16 v[16:19], v[224:227], a[72:75], v[16:19]
s_add_u32 m0, s77, 49152
ds_read_b64_tr_b16 v[136:137], v10 offset:49152
ds_read_b64_tr_b16 v[138:139], v10 offset:51200
v_mfma_f32_16x16x32_bf16 v[16:19], v[240:243], a[76:79], v[16:19]
s_add_u32 s72, s71, 0
buffer_load_dwordx4 v15, s[24:27], s72 offen lds
v_mfma_f32_16x16x32_bf16 v[32:35], v[240:243], a[92:95], v[32:35]
buffer_load_dwordx4 a[136:139], v1, s[44:47], s69 offen offset:2048 sc1
v_mfma_f32_16x16x32_bf16 v[32:35], v[224:227], a[88:91], v[32:35]
s_nop 0
ds_read_b64_tr_b16 v[140:141], v11 offset:49152
ds_read_b64_tr_b16 v[142:143], v11 offset:51200
v_mfma_f32_16x16x32_bf16 v[32:35], v[208:211], a[84:87], v[32:35]
v_mfma_f32_16x16x32_bf16 v[32:35], v[192:195], a[80:83], v[32:35]
s_nop 0
ds_read_b64_tr_b16 v[144:145], v8 offset:53248
ds_read_b64_tr_b16 v[146:147], v8 offset:55296
v_mfma_f32_16x16x32_bf16 v[36:39], v[196:199], a[80:83], v[36:39]
s_add_u32 s72, s71, 15360
buffer_load_dwordx4 v15, s[24:27], s72 offen offset:1024 lds
v_mfma_f32_16x16x32_bf16 v[36:39], v[212:215], a[84:87], v[36:39]
s_nop 0
ds_read_b64_tr_b16 v[148:149], v9 offset:53248
ds_read_b64_tr_b16 v[150:151], v9 offset:55296
v_mfma_f32_16x16x32_bf16 v[36:39], v[228:231], a[88:91], v[36:39]
s_nop 0
ds_read_b64_tr_b16 v[152:153], v10 offset:53248
ds_read_b64_tr_b16 v[154:155], v10 offset:55296
v_mfma_f32_16x16x32_bf16 v[36:39], v[244:247], a[92:95], v[36:39]
s_nop 0
ds_read_b64_tr_b16 v[156:157], v11 offset:53248
ds_read_b64_tr_b16 v[158:159], v11 offset:55296
v_mfma_f32_16x16x32_bf16 v[20:23], v[244:247], a[76:79], v[20:23]
v_mfma_f32_16x16x32_bf16 v[20:23], v[228:231], a[72:75], v[20:23]
buffer_load_dwordx4 a[140:143], v1, s[44:47], s69 offen offset:3072 sc1
v_mfma_f32_16x16x32_bf16 v[20:23], v[212:215], a[68:71], v[20:23]
s_add_u32 s72, s71, 30720
buffer_load_dwordx4 v15, s[24:27], s72 offen offset:2048 lds
v_mfma_f32_16x16x32_bf16 v[20:23], v[196:199], a[64:67], v[20:23]
s_nop 0
ds_read_b64_tr_b16 v[160:161], v8 offset:57344
ds_read_b64_tr_b16 v[162:163], v8 offset:59392
v_mfma_f32_16x16x32_bf16 v[24:27], v[200:203], a[64:67], v[24:27]
s_nop 0
ds_read_b64_tr_b16 v[164:165], v9 offset:57344
ds_read_b64_tr_b16 v[166:167], v9 offset:59392
v_mfma_f32_16x16x32_bf16 v[24:27], v[216:219], a[68:71], v[24:27]
s_nop 0
ds_read_b64_tr_b16 v[168:169], v10 offset:57344
ds_read_b64_tr_b16 v[170:171], v10 offset:59392
v_mfma_f32_16x16x32_bf16 v[24:27], v[232:235], a[72:75], v[24:27]
s_nop 0
ds_read_b64_tr_b16 v[172:173], v11 offset:57344
ds_read_b64_tr_b16 v[174:175], v11 offset:59392
v_mfma_f32_16x16x32_bf16 v[24:27], v[248:251], a[76:79], v[24:27]
v_mfma_f32_16x16x32_bf16 v[40:43], v[248:251], a[92:95], v[40:43]
s_add_u32 s72, s71, 46080
buffer_load_dwordx4 v15, s[24:27], s72 offen offset:3072 lds
v_mfma_f32_16x16x32_bf16 v[40:43], v[232:235], a[88:91], v[40:43]
s_nop 0
ds_read_b64_tr_b16 v[176:177], v8 offset:61440
ds_read_b64_tr_b16 v[178:179], v8 offset:63488
v_mfma_f32_16x16x32_bf16 v[40:43], v[216:219], a[84:87], v[40:43]
s_nop 0
ds_read_b64_tr_b16 v[180:181], v9 offset:61440
ds_read_b64_tr_b16 v[182:183], v9 offset:63488
v_mfma_f32_16x16x32_bf16 v[40:43], v[200:203], a[80:83], v[40:43]
s_add_u32 s69, s69, 0x20000
buffer_load_dwordx4 a[144:147], v1, s[44:47], s69 offen sc1
v_mfma_f32_16x16x32_bf16 v[44:47], v[204:207], a[80:83], v[44:47]
s_nop 0
ds_read_b64_tr_b16 v[184:185], v10 offset:61440
ds_read_b64_tr_b16 v[186:187], v10 offset:63488
v_mfma_f32_16x16x32_bf16 v[44:47], v[220:223], a[84:87], v[44:47]
s_nop 0
ds_read_b64_tr_b16 v[188:189], v11 offset:61440
ds_read_b64_tr_b16 v[190:191], v11 offset:63488
v_mfma_f32_16x16x32_bf16 v[44:47], v[236:239], a[88:91], v[44:47]
v_mfma_f32_16x16x32_bf16 v[44:47], v[252:255], a[92:95], v[44:47]
s_xor_b32 s71, s12, 0x400080
v_mfma_f32_16x16x32_bf16 v[28:31], v[252:255], a[76:79], v[28:31]
s_add_u32 m0, s85, 0
v_xor_b32 v8, 0x10000, v8
v_mfma_f32_16x16x32_bf16 v[28:31], v[236:239], a[72:75], v[28:31]
s_add_u32 s72, s71, 0
v_xor_b32 v9, 0x10000, v9
v_mfma_f32_16x16x32_bf16 v[28:31], v[220:223], a[68:71], v[28:31]
s_waitcnt vmcnt(21) lgkmcnt(0)
buffer_load_dwordx4 v15, s[24:27], s72 offen lds
v_xor_b32 v10, 0x10000, v10
v_mfma_f32_16x16x32_bf16 v[28:31], v[204:207], a[64:67], v[28:31]
s_barrier
v_xor_b32 v11, 0x10000, v11
v_mfma_f32_16x16x32_bf16 v[48:51], v[128:131], a[64:67], v[48:51]
s_nop 0
ds_read_b64_tr_b16 v[192:193], v8 offset:0
ds_read_b64_tr_b16 v[194:195], v8 offset:2048
v_mfma_f32_16x16x32_bf16 v[48:51], v[144:147], a[68:71], v[48:51]
buffer_load_dwordx4 a[148:151], v1, s[44:47], s69 offen offset:1024 sc1
v_mfma_f32_16x16x32_bf16 v[48:51], v[160:163], a[72:75], v[48:51]
s_nop 0
ds_read_b64_tr_b16 v[196:197], v9 offset:0
ds_read_b64_tr_b16 v[198:199], v9 offset:2048
v_mfma_f32_16x16x32_bf16 v[48:51], v[176:179], a[76:79], v[48:51]
s_add_u32 s72, s71, 15360
buffer_load_dwordx4 v15, s[24:27], s72 offen offset:1024 lds
v_mfma_f32_16x16x32_bf16 v[64:67], v[176:179], a[92:95], v[64:67]
s_nop 0
ds_read_b64_tr_b16 v[200:201], v10 offset:0
ds_read_b64_tr_b16 v[202:203], v10 offset:2048
v_mfma_f32_16x16x32_bf16 v[64:67], v[160:163], a[88:91], v[64:67]
s_nop 0
ds_read_b64_tr_b16 v[204:205], v11 offset:0
ds_read_b64_tr_b16 v[206:207], v11 offset:2048
v_mfma_f32_16x16x32_bf16 v[64:67], v[144:147], a[84:87], v[64:67]
v_mfma_f32_16x16x32_bf16 v[64:67], v[128:131], a[80:83], v[64:67]
s_nop 0
ds_read_b64_tr_b16 v[208:209], v8 offset:4096
ds_read_b64_tr_b16 v[210:211], v8 offset:6144
v_mfma_f32_16x16x32_bf16 v[68:71], v[132:135], a[80:83], v[68:71]
s_nop 0
ds_read_b64_tr_b16 v[212:213], v9 offset:4096
ds_read_b64_tr_b16 v[214:215], v9 offset:6144
v_mfma_f32_16x16x32_bf16 v[68:71], v[148:151], a[84:87], v[68:71]
s_add_u32 s72, s71, 30720
buffer_load_dwordx4 v15, s[24:27], s72 offen offset:2048 lds
v_mfma_f32_16x16x32_bf16 v[68:71], v[164:167], a[88:91], v[68:71]
s_nop 0
ds_read_b64_tr_b16 v[216:217], v10 offset:4096
ds_read_b64_tr_b16 v[218:219], v10 offset:6144
v_mfma_f32_16x16x32_bf16 v[68:71], v[180:183], a[92:95], v[68:71]
buffer_load_dwordx4 a[152:155], v1, s[44:47], s69 offen offset:2048 sc1
v_mfma_f32_16x16x32_bf16 v[52:55], v[180:183], a[76:79], v[52:55]
s_nop 0
ds_read_b64_tr_b16 v[220:221], v11 offset:4096
ds_read_b64_tr_b16 v[222:223], v11 offset:6144
v_mfma_f32_16x16x32_bf16 v[52:55], v[164:167], a[72:75], v[52:55]
v_mfma_f32_16x16x32_bf16 v[52:55], v[148:151], a[68:71], v[52:55]
s_nop 0
ds_read_b64_tr_b16 v[224:225], v8 offset:8192
ds_read_b64_tr_b16 v[226:227], v8 offset:10240
v_mfma_f32_16x16x32_bf16 v[52:55], v[132:135], a[64:67], v[52:55]
s_add_u32 s72, s71, 46080
buffer_load_dwordx4 v15, s[24:27], s72 offen offset:3072 lds
v_mfma_f32_16x16x32_bf16 v[56:59], v[136:139], a[64:67], v[56:59]
s_nop 0
ds_read_b64_tr_b16 v[228:229], v9 offset:8192
ds_read_b64_tr_b16 v[230:231], v9 offset:10240
v_mfma_f32_16x16x32_bf16 v[56:59], v[152:155], a[68:71], v[56:59]
s_nop 0
ds_read_b64_tr_b16 v[232:233], v10 offset:8192
ds_read_b64_tr_b16 v[234:235], v10 offset:10240
v_mfma_f32_16x16x32_bf16 v[56:59], v[168:171], a[72:75], v[56:59]
s_nop 0
ds_read_b64_tr_b16 v[236:237], v11 offset:8192
ds_read_b64_tr_b16 v[238:239], v11 offset:10240
v_mfma_f32_16x16x32_bf16 v[56:59], v[184:187], a[76:79], v[56:59]
v_mfma_f32_16x16x32_bf16 v[72:75], v[184:187], a[92:95], v[72:75]
s_nop 0
ds_read_b64_tr_b16 v[240:241], v8 offset:12288
ds_read_b64_tr_b16 v[242:243], v8 offset:14336
v_mfma_f32_16x16x32_bf16 v[72:75], v[168:171], a[88:91], v[72:75]
buffer_load_dwordx4 a[156:159], v1, s[44:47], s69 offen offset:3072 sc1
v_mfma_f32_16x16x32_bf16 v[72:75], v[152:155], a[84:87], v[72:75]
s_lshr_b32 s69, s13, 18
ds_read_b64_tr_b16 v[244:245], v9 offset:12288
ds_read_b64_tr_b16 v[246:247], v9 offset:14336
v_mfma_f32_16x16x32_bf16 v[72:75], v[136:139], a[80:83], v[72:75]
s_xor_b32 s71, s12, 0x400100
ds_read_b64_tr_b16 v[248:249], v10 offset:12288
ds_read_b64_tr_b16 v[250:251], v10 offset:14336
v_mfma_f32_16x16x32_bf16 v[76:79], v[140:143], a[80:83], v[76:79]
s_add_u32 m0, s85, 16384
ds_read_b64_tr_b16 v[252:253], v11 offset:12288
ds_read_b64_tr_b16 v[254:255], v11 offset:14336
v_mfma_f32_16x16x32_bf16 v[76:79], v[156:159], a[84:87], v[76:79]
s_add_u32 s72, s71, 0
buffer_load_dwordx4 v15, s[24:27], s72 offen lds
v_mfma_f32_16x16x32_bf16 v[76:79], v[172:175], a[88:91], v[76:79]
s_lshl_b32 s69, s69, 12
v_mfma_f32_16x16x32_bf16 v[76:79], v[188:191], a[92:95], v[76:79]
s_add_u32 s69, s69, s95
v_mfma_f32_16x16x32_bf16 v[60:63], v[188:191], a[76:79], v[60:63]
s_xor_b32 s69, s69, 0x10000
v_mfma_f32_16x16x32_bf16 v[60:63], v[172:175], a[72:75], v[60:63]
s_add_u32 s72, s71, 15360
v_mfma_f32_16x16x32_bf16 v[60:63], v[156:159], a[68:71], v[60:63]
s_waitcnt vmcnt(22) lgkmcnt(0)
buffer_load_dwordx4 a[160:163], v1, s[44:47], s69 offen sc1
v_mfma_f32_16x16x32_bf16 v[60:63], v[140:143], a[64:67], v[60:63]
s_barrier
buffer_load_dwordx4 v15, s[24:27], s72 offen offset:1024 lds
v_mfma_f32_16x16x32_bf16 v[80:83], v[192:195], a[64:67], v[80:83]
s_and_b32 s79, s91, 0xffffcfff
v_lshlrev_b32 v13, 2, v2
buffer_load_dword v14, v13, s[44:47], s79 offen sc1
v_mfma_f32_16x16x32_bf16 v[80:83], v[208:211], a[68:71], v[80:83]
s_nop 0
ds_read_b64_tr_b16 v[128:129], v8 offset:16384
ds_read_b64_tr_b16 v[130:131], v8 offset:18432
v_mfma_f32_16x16x32_bf16 v[80:83], v[224:227], a[72:75], v[80:83]
s_nop 0
ds_read_b64_tr_b16 v[132:133], v9 offset:16384
ds_read_b64_tr_b16 v[134:135], v9 offset:18432
v_mfma_f32_16x16x32_bf16 v[80:83], v[240:243], a[76:79], v[80:83]
s_nop 0
ds_read_b64_tr_b16 v[136:137], v10 offset:16384
ds_read_b64_tr_b16 v[138:139], v10 offset:18432
v_mfma_f32_16x16x32_bf16 v[96:99], v[240:243], a[92:95], v[96:99]
s_nop 0
ds_read_b64_tr_b16 v[140:141], v11 offset:16384
ds_read_b64_tr_b16 v[142:143], v11 offset:18432
v_mfma_f32_16x16x32_bf16 v[96:99], v[224:227], a[88:91], v[96:99]
s_add_u32 s72, s71, 30720
buffer_load_dwordx4 v15, s[24:27], s72 offen offset:2048 lds
v_mfma_f32_16x16x32_bf16 v[96:99], v[208:211], a[84:87], v[96:99]
v_mfma_f32_16x16x32_bf16 v[96:99], v[192:195], a[80:83], v[96:99]
s_nop 0
ds_read_b64_tr_b16 v[144:145], v8 offset:20480
ds_read_b64_tr_b16 v[146:147], v8 offset:22528
v_mfma_f32_16x16x32_bf16 v[100:103], v[196:199], a[80:83], v[100:103]
buffer_load_dwordx4 a[164:167], v1, s[44:47], s69 offen offset:1024 sc1
v_mfma_f32_16x16x32_bf16 v[100:103], v[212:215], a[84:87], v[100:103]
s_nop 0
ds_read_b64_tr_b16 v[148:149], v9 offset:20480
ds_read_b64_tr_b16 v[150:151], v9 offset:22528
v_mfma_f32_16x16x32_bf16 v[100:103], v[228:231], a[88:91], v[100:103]
s_nop 0
ds_read_b64_tr_b16 v[152:153], v10 offset:20480
ds_read_b64_tr_b16 v[154:155], v10 offset:22528
v_mfma_f32_16x16x32_bf16 v[100:103], v[244:247], a[92:95], v[100:103]
s_add_u32 s72, s71, 46080
buffer_load_dwordx4 v15, s[24:27], s72 offen offset:3072 lds
v_mfma_f32_16x16x32_bf16 v[84:87], v[244:247], a[76:79], v[84:87]
s_nop 0
ds_read_b64_tr_b16 v[156:157], v11 offset:20480
ds_read_b64_tr_b16 v[158:159], v11 offset:22528
v_mfma_f32_16x16x32_bf16 v[84:87], v[228:231], a[72:75], v[84:87]
Lstube1:
s_cbranch_execz Lrete
v_mfma_f32_16x16x32_bf16 v[84:87], v[212:215], a[68:71], v[84:87]
s_nop 0
ds_read_b64_tr_b16 v[160:161], v8 offset:24576
ds_read_b64_tr_b16 v[162:163], v8 offset:26624
v_mfma_f32_16x16x32_bf16 v[84:87], v[196:199], a[64:67], v[84:87]
s_nop 0
ds_read_b64_tr_b16 v[164:165], v9 offset:24576
ds_read_b64_tr_b16 v[166:167], v9 offset:26624
v_mfma_f32_16x16x32_bf16 v[88:91], v[200:203], a[64:67], v[88:91]
s_nop 0
ds_read_b64_tr_b16 v[168:169], v10 offset:24576
ds_read_b64_tr_b16 v[170:171], v10 offset:26624
v_mfma_f32_16x16x32_bf16 v[88:91], v[216:219], a[68:71], v[88:91]
s_nop 0
ds_read_b64_tr_b16 v[172:173], v11 offset:24576
ds_read_b64_tr_b16 v[174:175], v11 offset:26624
v_mfma_f32_16x16x32_bf16 v[88:91], v[232:235], a[72:75], v[88:91]
buffer_load_dwordx4 a[168:171], v1, s[44:47], s69 offen offset:2048 sc1
v_mfma_f32_16x16x32_bf16 v[88:91], v[248:251], a[76:79], v[88:91]
s_xor_b32 s71, s12, 0x400180
v_mfma_f32_16x16x32_bf16 v[104:107], v[248:251], a[92:95], v[104:107]
s_add_u32 m0, s85, 32768
ds_read_b64_tr_b16 v[176:177], v8 offset:28672
ds_read_b64_tr_b16 v[178:179], v8 offset:30720
v_mfma_f32_16x16x32_bf16 v[104:107], v[232:235], a[88:91], v[104:107]
s_add_u32 s72, s71, 0
buffer_load_dwordx4 v15, s[24:27], s72 offen lds
v_mfma_f32_16x16x32_bf16 v[104:107], v[216:219], a[84:87], v[104:107]
s_nop 0
ds_read_b64_tr_b16 v[180:181], v9 offset:28672
ds_read_b64_tr_b16 v[182:183], v9 offset:30720
v_mfma_f32_16x16x32_bf16 v[104:107], v[200:203], a[80:83], v[104:107]
s_nop 0
ds_read_b64_tr_b16 v[184:185], v10 offset:28672
ds_read_b64_tr_b16 v[186:187], v10 offset:30720
v_mfma_f32_16x16x32_bf16 v[108:111], v[204:207], a[80:83], v[108:111]
s_nop 0
ds_read_b64_tr_b16 v[188:189], v11 offset:28672
ds_read_b64_tr_b16 v[190:191], v11 offset:30720
v_mfma_f32_16x16x32_bf16 v[108:111], v[220:223], a[84:87], v[108:111]
v_mfma_f32_16x16x32_bf16 v[108:111], v[236:239], a[88:91], v[108:111]
s_add_u32 s72, s71, 15360
buffer_load_dwordx4 v15, s[24:27], s72 offen offset:1024 lds
v_mfma_f32_16x16x32_bf16 v[108:111], v[252:255], a[92:95], v[108:111]
v_mfma_f32_16x16x32_bf16 v[92:95], v[252:255], a[76:79], v[92:95]
buffer_load_dwordx4 a[172:175], v1, s[44:47], s69 offen offset:3072 sc1
v_mfma_f32_16x16x32_bf16 v[92:95], v[236:239], a[72:75], v[92:95]
v_mfma_f32_16x16x32_bf16 v[92:95], v[220:223], a[68:71], v[92:95]
s_waitcnt vmcnt(26) lgkmcnt(0)
v_mfma_f32_16x16x32_bf16 v[92:95], v[204:207], a[64:67], v[92:95]
s_barrier
v_mfma_f32_16x16x32_bf16 v[16:19], v[128:131], a[96:99], v[16:19]
s_add_u32 s72, s71, 30720
buffer_load_dwordx4 v15, s[24:27], s72 offen offset:2048 lds
v_mfma_f32_16x16x32_bf16 v[16:19], v[144:147], a[100:103], v[16:19]
s_nop 0
ds_read_b64_tr_b16 v[192:193], v8 offset:32768
ds_read_b64_tr_b16 v[194:195], v8 offset:34816
v_mfma_f32_16x16x32_bf16 v[16:19], v[160:163], a[104:107], v[16:19]
s_nop 0
ds_read_b64_tr_b16 v[196:197], v9 offset:32768
ds_read_b64_tr_b16 v[198:199], v9 offset:34816
v_mfma_f32_16x16x32_bf16 v[16:19], v[176:179], a[108:111], v[16:19]
s_nop 0
ds_read_b64_tr_b16 v[200:201], v10 offset:32768
ds_read_b64_tr_b16 v[202:203], v10 offset:34816
v_mfma_f32_16x16x32_bf16 v[32:35], v[176:179], a[124:127], v[32:35]
s_nop 0
ds_read_b64_tr_b16 v[204:205], v11 offset:32768
ds_read_b64_tr_b16 v[206:207], v11 offset:34816
v_mfma_f32_16x16x32_bf16 v[32:35], v[160:163], a[120:123], v[32:35]
v_mfma_f32_16x16x32_bf16 v[32:35], v[144:147], a[116:119], v[32:35]
s_add_u32 s72, s71, 46080
buffer_load_dwordx4 v15, s[24:27], s72 offen offset:3072 lds
v_mfma_f32_16x16x32_bf16 v[32:35], v[128:131], a[112:115], v[32:35]
s_add_u32 s69, s69, 0x20000
buffer_load_dwordx4 a[176:179], v1, s[44:47], s69 offen sc1
v_mfma_f32_16x16x32_bf16 v[36:39], v[132:135], a[112:115], v[36:39]
s_nop 0
ds_read_b64_tr_b16 v[208:209], v8 offset:36864
ds_read_b64_tr_b16 v[210:211], v8 offset:38912
v_mfma_f32_16x16x32_bf16 v[36:39], v[148:151], a[116:119], v[36:39]
s_nop 0
ds_read_b64_tr_b16 v[212:213], v9 offset:36864
ds_read_b64_tr_b16 v[214:215], v9 offset:38912
v_mfma_f32_16x16x32_bf16 v[36:39], v[164:167], a[120:123], v[36:39]
s_nop 0
ds_read_b64_tr_b16 v[216:217], v10 offset:36864
ds_read_b64_tr_b16 v[218:219], v10 offset:38912
v_mfma_f32_16x16x32_bf16 v[36:39], v[180:183], a[124:127], v[36:39]
s_nop 0
ds_read_b64_tr_b16 v[220:221], v11 offset:36864
ds_read_b64_tr_b16 v[222:223], v11 offset:38912
v_mfma_f32_16x16x32_bf16 v[20:23], v[180:183], a[108:111], v[20:23]
v_mfma_f32_16x16x32_bf16 v[20:23], v[164:167], a[104:107], v[20:23]
s_nop 0
ds_read_b64_tr_b16 v[224:225], v8 offset:40960
ds_read_b64_tr_b16 v[226:227], v8 offset:43008
v_mfma_f32_16x16x32_bf16 v[20:23], v[148:151], a[100:103], v[20:23]
s_xor_b32 s71, s13, 0x400080
ds_read_b64_tr_b16 v[228:229], v9 offset:40960
ds_read_b64_tr_b16 v[230:231], v9 offset:43008
v_mfma_f32_16x16x32_bf16 v[20:23], v[132:135], a[96:99], v[20:23]
s_add_u32 m0, s85, 49152
ds_read_b64_tr_b16 v[232:233], v10 offset:40960
ds_read_b64_tr_b16 v[234:235], v10 offset:43008
v_mfma_f32_16x16x32_bf16 v[24:27], v[136:139], a[96:99], v[24:27]
s_add_u32 s72, s71, 0
buffer_load_dwordx4 v15, s[24:27], s72 offen lds
v_mfma_f32_16x16x32_bf16 v[24:27], v[152:155], a[100:103], v[24:27]
buffer_load_dwordx4 a[180:183], v1, s[44:47], s69 offen offset:1024 sc1
v_mfma_f32_16x16x32_bf16 v[24:27], v[168:171], a[104:107], v[24:27]
s_nop 0
ds_read_b64_tr_b16 v[236:237], v11 offset:40960
ds_read_b64_tr_b16 v[238:239], v11 offset:43008
v_mfma_f32_16x16x32_bf16 v[24:27], v[184:187], a[108:111], v[24:27]
v_mfma_f32_16x16x32_bf16 v[40:43], v[184:187], a[124:127], v[40:43]
s_nop 0
ds_read_b64_tr_b16 v[240:241], v8 offset:45056
ds_read_b64_tr_b16 v[242:243], v8 offset:47104
v_mfma_f32_16x16x32_bf16 v[40:43], v[168:171], a[120:123], v[40:43]
s_nop 0
ds_read_b64_tr_b16 v[244:245], v9 offset:45056
ds_read_b64_tr_b16 v[246:247], v9 offset:47104
v_mfma_f32_16x16x32_bf16 v[40:43], v[152:155], a[116:119], v[40:43]
s_add_u32 s72, s71, 15360
buffer_load_dwordx4 v15, s[24:27], s72 offen offset:1024 lds
v_mfma_f32_16x16x32_bf16 v[40:43], v[136:139], a[112:115], v[40:43]
s_nop 0
ds_read_b64_tr_b16 v[248:249], v10 offset:45056
ds_read_b64_tr_b16 v[250:251], v10 offset:47104
v_mfma_f32_16x16x32_bf16 v[44:47], v[140:143], a[112:115], v[44:47]
s_nop 0
ds_read_b64_tr_b16 v[252:253], v11 offset:45056
ds_read_b64_tr_b16 v[254:255], v11 offset:47104
v_mfma_f32_16x16x32_bf16 v[44:47], v[156:159], a[116:119], v[44:47]
v_mfma_f32_16x16x32_bf16 v[44:47], v[172:175], a[120:123], v[44:47]
buffer_load_dwordx4 a[184:187], v1, s[44:47], s69 offen offset:2048 sc1
v_mfma_f32_16x16x32_bf16 v[44:47], v[188:191], a[124:127], v[44:47]
v_mfma_f32_16x16x32_bf16 v[28:31], v[188:191], a[108:111], v[28:31]
s_add_u32 s72, s71, 30720
buffer_load_dwordx4 v15, s[24:27], s72 offen offset:2048 lds
v_mfma_f32_16x16x32_bf16 v[28:31], v[172:175], a[104:107], v[28:31]
v_mfma_f32_16x16x32_bf16 v[28:31], v[156:159], a[100:103], v[28:31]
s_waitcnt vmcnt(27) lgkmcnt(0)
v_mfma_f32_16x16x32_bf16 v[28:31], v[140:143], a[96:99], v[28:31]
s_barrier
v_mfma_f32_16x16x32_bf16 v[48:51], v[192:195], a[96:99], v[48:51]
s_nop 0
ds_read_b64_tr_b16 v[128:129], v8 offset:49152
ds_read_b64_tr_b16 v[130:131], v8 offset:51200
v_mfma_f32_16x16x32_bf16 v[48:51], v[208:211], a[100:103], v[48:51]
s_nop 0
ds_read_b64_tr_b16 v[132:133], v9 offset:49152
ds_read_b64_tr_b16 v[134:135], v9 offset:51200
v_mfma_f32_16x16x32_bf16 v[48:51], v[224:227], a[104:107], v[48:51]
s_add_u32 s72, s71, 46080
buffer_load_dwordx4 v15, s[24:27], s72 offen offset:3072 lds
v_mfma_f32_16x16x32_bf16 v[48:51], v[240:243], a[108:111], v[48:51]
s_nop 0
ds_read_b64_tr_b16 v[136:137], v10 offset:49152
ds_read_b64_tr_b16 v[138:139], v10 offset:51200
v_mfma_f32_16x16x32_bf16 v[64:67], v[240:243], a[124:127], v[64:67]
buffer_load_dwordx4 a[188:191], v1, s[44:47], s69 offen offset:3072 sc1
v_mfma_f32_16x16x32_bf16 v[64:67], v[224:227], a[120:123], v[64:67]
s_nop 0
ds_read_b64_tr_b16 v[140:141], v11 offset:49152
ds_read_b64_tr_b16 v[142:143], v11 offset:51200
v_mfma_f32_16x16x32_bf16 v[64:67], v[208:211], a[116:119], v[64:67]
s_nop 0
ds_read_b64_tr_b16 v[144:145], v8 offset:53248
ds_read_b64_tr_b16 v[146:147], v8 offset:55296
v_mfma_f32_16x16x32_bf16 v[64:67], v[192:195], a[112:115], v[64:67]
s_nop 0
ds_read_b64_tr_b16 v[148:149], v9 offset:53248
ds_read_b64_tr_b16 v[150:151], v9 offset:55296
v_mfma_f32_16x16x32_bf16 v[68:71], v[196:199], a[112:115], v[68:71]
s_lshr_b32 s69, s14, 18
v_mfma_f32_16x16x32_bf16 v[68:71], v[212:215], a[116:119], v[68:71]
s_lshl_b32 s69, s69, 12
ds_read_b64_tr_b16 v[152:153], v10 offset:53248
ds_read_b64_tr_b16 v[154:155], v10 offset:55296
v_mfma_f32_16x16x32_bf16 v[68:71], v[228:231], a[120:123], v[68:71]
s_xor_b32 s71, s14, 0x400080
ds_read_b64_tr_b16 v[156:157], v11 offset:53248
ds_read_b64_tr_b16 v[158:159], v11 offset:55296
v_mfma_f32_16x16x32_bf16 v[68:71], v[244:247], a[124:127], v[68:71]
s_add_u32 m0, s77, 0
ds_read_b64_tr_b16 v[160:161], v8 offset:57344
ds_read_b64_tr_b16 v[162:163], v8 offset:59392
v_mfma_f32_16x16x32_bf16 v[52:55], v[244:247], a[108:111], v[52:55]
s_add_u32 s72, s71, 0
buffer_load_dwordx4 v15, s[24:27], s72 offen lds
v_mfma_f32_16x16x32_bf16 v[52:55], v[228:231], a[104:107], v[52:55]
s_add_u32 s69, s69, s95
ds_read_b64_tr_b16 v[164:165], v9 offset:57344
ds_read_b64_tr_b16 v[166:167], v9 offset:59392
v_mfma_f32_16x16x32_bf16 v[52:55], v[212:215], a[100:103], v[52:55]
s_xor_b32 s69, s69, 0x10000
buffer_load_dwordx4 a[192:195], v1, s[44:47], s69 offen sc1
v_mfma_f32_16x16x32_bf16 v[52:55], v[196:199], a[96:99], v[52:55]
s_nop 0
ds_read_b64_tr_b16 v[168:169], v10 offset:57344
ds_read_b64_tr_b16 v[170:171], v10 offset:59392
v_mfma_f32_16x16x32_bf16 v[56:59], v[200:203], a[96:99], v[56:59]
s_waitcnt vmcnt(19)
v_cmp_gt_u32 vcc, 2, v14
s_cbranch_vccnz Lspin112
Lback113:
v_mfma_f32_16x16x32_bf16 v[56:59], v[216:219], a[100:103], v[56:59]
s_add_u32 s72, s71, 15360
buffer_load_dwordx4 v15, s[24:27], s72 offen offset:1024 lds
v_mfma_f32_16x16x32_bf16 v[56:59], v[232:235], a[104:107], v[56:59]
v_mfma_f32_16x16x32_bf16 v[56:59], v[248:251], a[108:111], v[56:59]
s_nop 0
ds_read_b64_tr_b16 v[172:173], v11 offset:57344
ds_read_b64_tr_b16 v[174:175], v11 offset:59392
v_mfma_f32_16x16x32_bf16 v[72:75], v[248:251], a[124:127], v[72:75]
s_nop 0
ds_read_b64_tr_b16 v[176:177], v8 offset:61440
ds_read_b64_tr_b16 v[178:179], v8 offset:63488
v_mfma_f32_16x16x32_bf16 v[72:75], v[232:235], a[120:123], v[72:75]
s_nop 0
ds_read_b64_tr_b16 v[180:181], v9 offset:61440
ds_read_b64_tr_b16 v[182:183], v9 offset:63488
v_mfma_f32_16x16x32_bf16 v[72:75], v[216:219], a[116:119], v[72:75]
s_nop 0
ds_read_b64_tr_b16 v[184:185], v10 offset:61440
ds_read_b64_tr_b16 v[186:187], v10 offset:63488
v_mfma_f32_16x16x32_bf16 v[72:75], v[200:203], a[112:115], v[72:75]
s_add_u32 s72, s71, 30720
buffer_load_dwordx4 v15, s[24:27], s72 offen offset:2048 lds
v_mfma_f32_16x16x32_bf16 v[76:79], v[204:207], a[112:115], v[76:79]
buffer_load_dwordx4 a[196:199], v1, s[44:47], s69 offen offset:1024 sc1
v_mfma_f32_16x16x32_bf16 v[76:79], v[220:223], a[116:119], v[76:79]
s_nop 0
ds_read_b64_tr_b16 v[188:189], v11 offset:61440
ds_read_b64_tr_b16 v[190:191], v11 offset:63488
v_mfma_f32_16x16x32_bf16 v[76:79], v[236:239], a[120:123], v[76:79]
v_mfma_f32_16x16x32_bf16 v[76:79], v[252:255], a[124:127], v[76:79]
v_mfma_f32_16x16x32_bf16 v[60:63], v[252:255], a[108:111], v[60:63]
v_xor_b32 v8, 0x10000, v8
v_mfma_f32_16x16x32_bf16 v[60:63], v[236:239], a[104:107], v[60:63]
s_add_u32 s72, s71, 46080
buffer_load_dwordx4 v15, s[24:27], s72 offen offset:3072 lds
v_xor_b32 v9, 0x10000, v9
v_mfma_f32_16x16x32_bf16 v[60:63], v[220:223], a[100:103], v[60:63]
s_waitcnt vmcnt(28) lgkmcnt(0)
v_xor_b32 v10, 0x10000, v10
v_mfma_f32_16x16x32_bf16 v[60:63], v[204:207], a[96:99], v[60:63]
s_barrier
v_xor_b32 v11, 0x10000, v11
v_mfma_f32_16x16x32_bf16 v[80:83], v[128:131], a[96:99], v[80:83]
s_lshl_b32 s84, s76, 11
ds_read_b64_tr_b16 v[192:193], v8 offset:0
ds_read_b64_tr_b16 v[194:195], v8 offset:2048
v_mfma_f32_16x16x32_bf16 v[80:83], v[144:147], a[100:103], v[80:83]
s_add_u32 s84, s84, 0x3810000
ds_read_b64_tr_b16 v[196:197], v9 offset:0
ds_read_b64_tr_b16 v[198:199], v9 offset:2048
v_mfma_f32_16x16x32_bf16 v[80:83], v[160:163], a[104:107], v[80:83]
buffer_load_dwordx4 a[200:203], v1, s[44:47], s69 offen offset:2048 sc1
v_mfma_f32_16x16x32_bf16 v[80:83], v[176:179], a[108:111], v[80:83]
s_nop 0
ds_read_b64_tr_b16 v[200:201], v10 offset:0
ds_read_b64_tr_b16 v[202:203], v10 offset:2048
v_mfma_f32_16x16x32_bf16 v[96:99], v[176:179], a[124:127], v[96:99]
s_nop 0
ds_read_b64_tr_b16 v[204:205], v11 offset:0
ds_read_b64_tr_b16 v[206:207], v11 offset:2048
v_mfma_f32_16x16x32_bf16 v[96:99], v[160:163], a[120:123], v[96:99]
s_xor_b32 s71, s15, 0x400080
v_lshrrev_b32 v115, 2, v0
v_lshlrev_b32 v115, 7, v115
v_mfma_f32_16x16x32_bf16 v[96:99], v[144:147], a[116:119], v[96:99]
s_add_u32 m0, s77, 16384
ds_read_b64_tr_b16 v[208:209], v8 offset:4096
ds_read_b64_tr_b16 v[210:211], v8 offset:6144
v_mfma_f32_16x16x32_bf16 v[96:99], v[128:131], a[112:115], v[96:99]
s_add_u32 s72, s71, 0
buffer_load_dwordx4 v15, s[24:27], s72 offen lds
v_mfma_f32_16x16x32_bf16 v[100:103], v[132:135], a[112:115], v[100:103]
s_nop 0
ds_read_b64_tr_b16 v[212:213], v9 offset:4096
ds_read_b64_tr_b16 v[214:215], v9 offset:6144
v_mfma_f32_16x16x32_bf16 v[100:103], v[148:151], a[116:119], v[100:103]
s_nop 0
ds_read_b64_tr_b16 v[216:217], v10 offset:4096
ds_read_b64_tr_b16 v[218:219], v10 offset:6144
v_mfma_f32_16x16x32_bf16 v[100:103], v[164:167], a[120:123], v[100:103]
s_nop 0
ds_read_b64_tr_b16 v[220:221], v11 offset:4096
ds_read_b64_tr_b16 v[222:223], v11 offset:6144
v_mfma_f32_16x16x32_bf16 v[100:103], v[180:183], a[124:127], v[100:103]
buffer_load_dword v114, v115, s[44:47], s84 offen sc1
v_mfma_f32_16x16x32_bf16 v[84:87], v[180:183], a[108:111], v[84:87]
buffer_load_dwordx4 a[204:207], v1, s[44:47], s69 offen offset:3072 sc1
v_mfma_f32_16x16x32_bf16 v[84:87], v[164:167], a[104:107], v[84:87]
s_add_u32 s72, s71, 15360
buffer_load_dwordx4 v15, s[24:27], s72 offen offset:1024 lds
v_mfma_f32_16x16x32_bf16 v[84:87], v[148:151], a[100:103], v[84:87]
s_nop 0
ds_read_b64_tr_b16 v[224:225], v8 offset:8192
ds_read_b64_tr_b16 v[226:227], v8 offset:10240
v_mfma_f32_16x16x32_bf16 v[84:87], v[132:135], a[96:99], v[84:87]
s_nop 0
ds_read_b64_tr_b16 v[228:229], v9 offset:8192
ds_read_b64_tr_b16 v[230:231], v9 offset:10240
v_mfma_f32_16x16x32_bf16 v[88:91], v[136:139], a[96:99], v[88:91]
s_nop 0
ds_read_b64_tr_b16 v[232:233], v10 offset:8192
ds_read_b64_tr_b16 v[234:235], v10 offset:10240
v_mfma_f32_16x16x32_bf16 v[88:91], v[152:155], a[100:103], v[88:91]
s_nop 0
ds_read_b64_tr_b16 v[236:237], v11 offset:8192
ds_read_b64_tr_b16 v[238:239], v11 offset:10240
v_mfma_f32_16x16x32_bf16 v[88:91], v[168:171], a[104:107], v[88:91]
v_mfma_f32_16x16x32_bf16 v[88:91], v[184:187], a[108:111], v[88:91]
s_add_u32 s72, s71, 30720
buffer_load_dwordx4 v15, s[24:27], s72 offen offset:2048 lds
v_mfma_f32_16x16x32_bf16 v[104:107], v[184:187], a[124:127], v[104:107]
s_nop 0
ds_read_b64_tr_b16 v[240:241], v8 offset:12288
ds_read_b64_tr_b16 v[242:243], v8 offset:14336
v_mfma_f32_16x16x32_bf16 v[104:107], v[168:171], a[120:123], v[104:107]
s_nop 0
ds_read_b64_tr_b16 v[244:245], v9 offset:12288
ds_read_b64_tr_b16 v[246:247], v9 offset:14336
v_mfma_f32_16x16x32_bf16 v[104:107], v[152:155], a[116:119], v[104:107]
s_add_u32 s69, s69, 0x20000
buffer_load_dwordx4 a[208:211], v1, s[44:47], s69 offen sc1
v_mfma_f32_16x16x32_bf16 v[104:107], v[136:139], a[112:115], v[104:107]
s_nop 0
ds_read_b64_tr_b16 v[248:249], v10 offset:12288
ds_read_b64_tr_b16 v[250:251], v10 offset:14336
v_mfma_f32_16x16x32_bf16 v[108:111], v[140:143], a[112:115], v[108:111]
s_nop 0
ds_read_b64_tr_b16 v[252:253], v11 offset:12288
ds_read_b64_tr_b16 v[254:255], v11 offset:14336
v_mfma_f32_16x16x32_bf16 v[108:111], v[156:159], a[116:119], v[108:111]
s_add_u32 s72, s71, 46080
buffer_load_dwordx4 v15, s[24:27], s72 offen offset:3072 lds
v_mfma_f32_16x16x32_bf16 v[108:111], v[172:175], a[120:123], v[108:111]
v_mfma_f32_16x16x32_bf16 v[108:111], v[188:191], a[124:127], v[108:111]
v_mfma_f32_16x16x32_bf16 v[92:95], v[188:191], a[108:111], v[92:95]
v_mfma_f32_16x16x32_bf16 v[92:95], v[172:175], a[104:107], v[92:95]
v_mfma_f32_16x16x32_bf16 v[92:95], v[156:159], a[100:103], v[92:95]
s_waitcnt vmcnt(28) lgkmcnt(0)
v_mfma_f32_16x16x32_bf16 v[92:95], v[140:143], a[96:99], v[92:95]
s_barrier
v_mfma_f32_16x16x32_bf16 v[16:19], v[192:195], a[128:131], v[16:19]
buffer_load_dwordx4 a[212:215], v1, s[44:47], s69 offen offset:1024 sc1
v_mfma_f32_16x16x32_bf16 v[16:19], v[208:211], a[132:135], v[16:19]
s_xor_b32 s71, s13, 0x400100
ds_read_b64_tr_b16 v[128:129], v8 offset:16384
ds_read_b64_tr_b16 v[130:131], v8 offset:18432
v_mfma_f32_16x16x32_bf16 v[16:19], v[224:227], a[136:139], v[16:19]
s_add_u32 m0, s77, 32768
ds_read_b64_tr_b16 v[132:133], v9 offset:16384
ds_read_b64_tr_b16 v[134:135], v9 offset:18432
v_mfma_f32_16x16x32_bf16 v[16:19], v[240:243], a[140:143], v[16:19]
s_add_u32 s72, s71, 0
buffer_load_dwordx4 v15, s[24:27], s72 offen lds
v_mfma_f32_16x16x32_bf16 v[32:35], v[240:243], a[156:159], v[32:35]
s_nop 0
ds_read_b64_tr_b16 v[136:137], v10 offset:16384
ds_read_b64_tr_b16 v[138:139], v10 offset:18432
v_mfma_f32_16x16x32_bf16 v[32:35], v[224:227], a[152:155], v[32:35]
s_nop 0
ds_read_b64_tr_b16 v[140:141], v11 offset:16384
ds_read_b64_tr_b16 v[142:143], v11 offset:18432
v_mfma_f32_16x16x32_bf16 v[32:35], v[208:211], a[148:151], v[32:35]
v_mfma_f32_16x16x32_bf16 v[32:35], v[192:195], a[144:147], v[32:35]
s_nop 0
ds_read_b64_tr_b16 v[144:145], v8 offset:20480
ds_read_b64_tr_b16 v[146:147], v8 offset:22528
v_mfma_f32_16x16x32_bf16 v[36:39], v[196:199], a[144:147], v[36:39]
s_add_u32 s72, s71, 15360
buffer_load_dwordx4 v15, s[24:27], s72 offen offset:1024 lds
v_mfma_f32_16x16x32_bf16 v[36:39], v[212:215], a[148:151], v[36:39]
s_nop 0
ds_read_b64_tr_b16 v[148:149], v9 offset:20480
ds_read_b64_tr_b16 v[150:151], v9 offset:22528
v_mfma_f32_16x16x32_bf16 v[36:39], v[228:231], a[152:155], v[36:39]
buffer_load_dwordx4 a[216:219], v1, s[44:47], s69 offen offset:2048 sc1
v_mfma_f32_16x16x32_bf16 v[36:39], v[244:247], a[156:159], v[36:39]
s_nop 0
ds_read_b64_tr_b16 v[152:153], v10 offset:20480
ds_read_b64_tr_b16 v[154:155], v10 offset:22528
v_mfma_f32_16x16x32_bf16 v[20:23], v[244:247], a[140:143], v[20:23]
s_nop 0
ds_read_b64_tr_b16 v[156:157], v11 offset:20480
ds_read_b64_tr_b16 v[158:159], v11 offset:22528
v_mfma_f32_16x16x32_bf16 v[20:23], v[228:231], a[136:139], v[20:23]
v_mfma_f32_16x16x32_bf16 v[20:23], v[212:215], a[132:135], v[20:23]
s_add_u32 s72, s71, 30720
buffer_load_dwordx4 v15, s[24:27], s72 offen offset:2048 lds
v_mfma_f32_16x16x32_bf16 v[20:23], v[196:199], a[128:131], v[20:23]
s_nop 0
ds_read_b64_tr_b16 v[160:161], v8 offset:24576
ds_read_b64_tr_b16 v[162:163], v8 offset:26624
v_mfma_f32_16x16x32_bf16 v[24:27], v[200:203], a[128:131], v[24:27]
s_nop 0
ds_read_b64_tr_b16 v[164:165], v9 offset:24576
ds_read_b64_tr_b16 v[166:167], v9 offset:26624
v_mfma_f32_16x16x32_bf16 v[24:27], v[216:219], a[132:135], v[24:27]
s_nop 0
ds_read_b64_tr_b16 v[168:169], v10 offset:24576
ds_read_b64_tr_b16 v[170:171], v10 offset:26624
v_mfma_f32_16x16x32_bf16 v[24:27], v[232:235], a[136:139], v[24:27]
s_nop 0
ds_read_b64_tr_b16 v[172:173], v11 offset:24576
ds_read_b64_tr_b16 v[174:175], v11 offset:26624
v_mfma_f32_16x16x32_bf16 v[24:27], v[248:251], a[140:143], v[24:27]
v_mfma_f32_16x16x32_bf16 v[40:43], v[248:251], a[156:159], v[40:43]
s_add_u32 s72, s71, 46080
buffer_load_dwordx4 v15, s[24:27], s72 offen offset:3072 lds
v_mfma_f32_16x16x32_bf16 v[40:43], v[232:235], a[152:155], v[40:43]
buffer_load_dwordx4 a[220:223], v1, s[44:47], s69 offen offset:3072 sc1
v_mfma_f32_16x16x32_bf16 v[40:43], v[216:219], a[148:151], v[40:43]
s_nop 0
ds_read_b64_tr_b16 v[176:177], v8 offset:28672
ds_read_b64_tr_b16 v[178:179], v8 offset:30720
v_mfma_f32_16x16x32_bf16 v[40:43], v[200:203], a[144:147], v[40:43]
s_lshr_b32 s69, s15, 18
ds_read_b64_tr_b16 v[180:181], v9 offset:28672
ds_read_b64_tr_b16 v[182:183], v9 offset:30720
v_mfma_f32_16x16x32_bf16 v[44:47], v[204:207], a[144:147], v[44:47]
s_lshl_b32 s69, s69, 12
ds_read_b64_tr_b16 v[184:185], v10 offset:28672
ds_read_b64_tr_b16 v[186:187], v10 offset:30720
v_mfma_f32_16x16x32_bf16 v[44:47], v[220:223], a[148:151], v[44:47]
s_add_u32 s69, s69, s95
ds_read_b64_tr_b16 v[188:189], v11 offset:28672
ds_read_b64_tr_b16 v[190:191], v11 offset:30720
v_mfma_f32_16x16x32_bf16 v[44:47], v[236:239], a[152:155], v[44:47]
s_xor_b32 s69, s69, 0x10000
v_mfma_f32_16x16x32_bf16 v[44:47], v[252:255], a[156:159], v[44:47]
s_xor_b32 s71, s14, 0x400100
v_mfma_f32_16x16x32_bf16 v[28:31], v[252:255], a[140:143], v[28:31]
s_add_u32 m0, s77, 49152
v_mfma_f32_16x16x32_bf16 v[28:31], v[236:239], a[136:139], v[28:31]
s_add_u32 s72, s71, 0
v_mfma_f32_16x16x32_bf16 v[28:31], v[220:223], a[132:135], v[28:31]
s_waitcnt vmcnt(29) lgkmcnt(0)
buffer_load_dwordx4 v15, s[24:27], s72 offen lds
v_mfma_f32_16x16x32_bf16 v[28:31], v[204:207], a[128:131], v[28:31]
s_barrier
buffer_load_dwordx4 a[224:227], v1, s[44:47], s69 offen sc1
v_mfma_f32_16x16x32_bf16 v[48:51], v[128:131], a[128:131], v[48:51]
s_nop 0
ds_read_b64_tr_b16 v[192:193], v8 offset:32768
ds_read_b64_tr_b16 v[194:195], v8 offset:34816
v_mfma_f32_16x16x32_bf16 v[48:51], v[144:147], a[132:135], v[48:51]
s_nop 0
ds_read_b64_tr_b16 v[196:197], v9 offset:32768
ds_read_b64_tr_b16 v[198:199], v9 offset:34816
v_mfma_f32_16x16x32_bf16 v[48:51], v[160:163], a[136:139], v[48:51]
s_nop 0
ds_read_b64_tr_b16 v[200:201], v10 offset:32768
ds_read_b64_tr_b16 v[202:203], v10 offset:34816
v_mfma_f32_16x16x32_bf16 v[48:51], v[176:179], a[140:143], v[48:51]
s_add_u32 s72, s71, 15360
buffer_load_dwordx4 v15, s[24:27], s72 offen offset:1024 lds
v_mfma_f32_16x16x32_bf16 v[64:67], v[176:179], a[156:159], v[64:67]
s_nop 0
ds_read_b64_tr_b16 v[204:205], v11 offset:32768
ds_read_b64_tr_b16 v[206:207], v11 offset:34816
v_mfma_f32_16x16x32_bf16 v[64:67], v[160:163], a[152:155], v[64:67]
v_mfma_f32_16x16x32_bf16 v[64:67], v[144:147], a[148:151], v[64:67]
s_nop 0
ds_read_b64_tr_b16 v[208:209], v8 offset:36864
ds_read_b64_tr_b16 v[210:211], v8 offset:38912
v_mfma_f32_16x16x32_bf16 v[64:67], v[128:131], a[144:147], v[64:67]
s_nop 0
ds_read_b64_tr_b16 v[212:213], v9 offset:36864
ds_read_b64_tr_b16 v[214:215], v9 offset:38912
v_mfma_f32_16x16x32_bf16 v[68:71], v[132:135], a[144:147], v[68:71]
buffer_load_dwordx4 a[228:231], v1, s[44:47], s69 offen offset:1024 sc1
v_mfma_f32_16x16x32_bf16 v[68:71], v[148:151], a[148:151], v[68:71]
s_add_u32 s72, s71, 30720
buffer_load_dwordx4 v15, s[24:27], s72 offen offset:2048 lds
v_mfma_f32_16x16x32_bf16 v[68:71], v[164:167], a[152:155], v[68:71]
s_nop 0
ds_read_b64_tr_b16 v[216:217], v10 offset:36864
ds_read_b64_tr_b16 v[218:219], v10 offset:38912
v_mfma_f32_16x16x32_bf16 v[68:71], v[180:183], a[156:159], v[68:71]
v_mfma_f32_16x16x32_bf16 v[52:55], v[180:183], a[140:143], v[52:55]
s_nop 0
ds_read_b64_tr_b16 v[220:221], v11 offset:36864
ds_read_b64_tr_b16 v[222:223], v11 offset:38912
v_mfma_f32_16x16x32_bf16 v[52:55], v[164:167], a[136:139], v[52:55]
s_nop 0
ds_read_b64_tr_b16 v[224:225], v8 offset:40960
ds_read_b64_tr_b16 v[226:227], v8 offset:43008
v_mfma_f32_16x16x32_bf16 v[52:55], v[148:151], a[132:135], v[52:55]
s_nop 0
ds_read_b64_tr_b16 v[228:229], v9 offset:40960
ds_read_b64_tr_b16 v[230:231], v9 offset:43008
v_mfma_f32_16x16x32_bf16 v[52:55], v[132:135], a[128:131], v[52:55]
s_add_u32 s72, s71, 46080
buffer_load_dwordx4 v15, s[24:27], s72 offen offset:3072 lds
v_mfma_f32_16x16x32_bf16 v[56:59], v[136:139], a[128:131], v[56:59]
v_mfma_f32_16x16x32_bf16 v[56:59], v[152:155], a[132:135], v[56:59]
s_nop 0
ds_read_b64_tr_b16 v[232:233], v10 offset:40960
ds_read_b64_tr_b16 v[234:235], v10 offset:43008
v_mfma_f32_16x16x32_bf16 v[56:59], v[168:171], a[136:139], v[56:59]
buffer_load_dwordx4 a[232:235], v1, s[44:47], s69 offen offset:2048 sc1
v_mfma_f32_16x16x32_bf16 v[56:59], v[184:187], a[140:143], v[56:59]
s_nop 0
ds_read_b64_tr_b16 v[236:237], v11 offset:40960
ds_read_b64_tr_b16 v[238:239], v11 offset:43008
v_mfma_f32_16x16x32_bf16 v[72:75], v[184:187], a[156:159], v[72:75]
s_nop 0
ds_read_b64_tr_b16 v[240:241], v8 offset:45056
ds_read_b64_tr_b16 v[242:243], v8 offset:47104
v_mfma_f32_16x16x32_bf16 v[72:75], v[168:171], a[152:155], v[72:75]
v_mfma_f32_16x16x32_bf16 v[72:75], v[152:155], a[148:151], v[72:75]
s_nop 0
ds_read_b64_tr_b16 v[244:245], v9 offset:45056
ds_read_b64_tr_b16 v[246:247], v9 offset:47104
v_mfma_f32_16x16x32_bf16 v[72:75], v[136:139], a[144:147], v[72:75]
s_xor_b32 s71, s15, 0x400100
ds_read_b64_tr_b16 v[248:249], v10 offset:45056
ds_read_b64_tr_b16 v[250:251], v10 offset:47104
v_mfma_f32_16x16x32_bf16 v[76:79], v[140:143], a[144:147], v[76:79]
s_add_u32 m0, s85, 0
ds_read_b64_tr_b16 v[252:253], v11 offset:45056
ds_read_b64_tr_b16 v[254:255], v11 offset:47104
v_mfma_f32_16x16x32_bf16 v[76:79], v[156:159], a[148:151], v[76:79]
s_add_u32 s72, s71, 0
buffer_load_dwordx4 v15, s[24:27], s72 offen lds
v_mfma_f32_16x16x32_bf16 v[76:79], v[172:175], a[152:155], v[76:79]
v_mfma_f32_16x16x32_bf16 v[76:79], v[188:191], a[156:159], v[76:79]
v_mfma_f32_16x16x32_bf16 v[60:63], v[188:191], a[140:143], v[60:63]
buffer_load_dwordx4 a[236:239], v1, s[44:47], s69 offen offset:3072 sc1
v_mfma_f32_16x16x32_bf16 v[60:63], v[172:175], a[136:139], v[60:63]
s_add_u32 s72, s71, 15360
v_mfma_f32_16x16x32_bf16 v[60:63], v[156:159], a[132:135], v[60:63]
s_waitcnt vmcnt(31) lgkmcnt(0)
v_mfma_f32_16x16x32_bf16 v[60:63], v[140:143], a[128:131], v[60:63]
s_barrier
buffer_load_dwordx4 v15, s[24:27], s72 offen offset:1024 lds
v_mfma_f32_16x16x32_bf16 v[80:83], v[192:195], a[128:131], v[80:83]
s_nop 0
ds_read_b64_tr_b16 v[128:129], v8 offset:49152
ds_read_b64_tr_b16 v[130:131], v8 offset:51200
v_mfma_f32_16x16x32_bf16 v[80:83], v[208:211], a[132:135], v[80:83]
s_nop 0
ds_read_b64_tr_b16 v[132:133], v9 offset:49152
ds_read_b64_tr_b16 v[134:135], v9 offset:51200
v_mfma_f32_16x16x32_bf16 v[80:83], v[224:227], a[136:139], v[80:83]
s_nop 0
ds_read_b64_tr_b16 v[136:137], v10 offset:49152
ds_read_b64_tr_b16 v[138:139], v10 offset:51200
s_waitcnt vmcnt(22)
v_cmp_gt_u32 vcc, 3, v114
s_cbranch_vccnz Lspin109
Lback110:
v_mfma_f32_16x16x32_bf16 v[80:83], v[240:243], a[140:143], v[80:83]
s_lshl_b32 s73, s76, 18
ds_read_b64_tr_b16 v[140:141], v11 offset:49152
ds_read_b64_tr_b16 v[142:143], v11 offset:51200
v_mfma_f32_16x16x32_bf16 v[96:99], v[240:243], a[156:159], v[96:99]
s_lshl_b32 s84, s58, 16
v_mfma_f32_16x16x32_bf16 v[96:99], v[224:227], a[152:155], v[96:99]
s_add_u32 s72, s71, 30720
buffer_load_dwordx4 v15, s[24:27], s72 offen offset:2048 lds
v_mfma_f32_16x16x32_bf16 v[96:99], v[208:211], a[148:151], v[96:99]
s_add_u32 s69, s69, 0x20000
buffer_load_dwordx4 a[240:243], v1, s[44:47], s69 offen sc1
v_mfma_f32_16x16x32_bf16 v[96:99], v[192:195], a[144:147], v[96:99]
Lstube2:
s_cbranch_execz Lrete
s_add_u32 s73, s73, s84
ds_read_b64_tr_b16 v[144:145], v8 offset:53248
ds_read_b64_tr_b16 v[146:147], v8 offset:55296
v_mfma_f32_16x16x32_bf16 v[100:103], v[196:199], a[144:147], v[100:103]
s_lshl_b32 s84, s75, 8
ds_read_b64_tr_b16 v[148:149], v9 offset:53248
ds_read_b64_tr_b16 v[150:151], v9 offset:55296
v_mfma_f32_16x16x32_bf16 v[100:103], v[212:215], a[148:151], v[100:103]
s_add_u32 s73, s73, s84
ds_read_b64_tr_b16 v[152:153], v10 offset:53248
ds_read_b64_tr_b16 v[154:155], v10 offset:55296
v_mfma_f32_16x16x32_bf16 v[100:103], v[228:231], a[152:155], v[100:103]
s_add_u32 s73, s73, 0x3400000
v_lshrrev_b32 v112, 4, v0
v_and_b32 v113, 15, v0
v_mfma_f32_16x16x32_bf16 v[100:103], v[244:247], a[156:159], v[100:103]
s_add_u32 s72, s71, 46080
buffer_load_dwordx4 v15, s[24:27], s72 offen offset:3072 lds
v_mfma_f32_16x16x32_bf16 v[84:87], v[244:247], a[140:143], v[84:87]
s_nop 0
ds_read_b64_tr_b16 v[156:157], v11 offset:53248
ds_read_b64_tr_b16 v[158:159], v11 offset:55296
v_mfma_f32_16x16x32_bf16 v[84:87], v[228:231], a[136:139], v[84:87]
s_nop 0
ds_read_b64_tr_b16 v[160:161], v8 offset:57344
ds_read_b64_tr_b16 v[162:163], v8 offset:59392
v_mfma_f32_16x16x32_bf16 v[84:87], v[212:215], a[132:135], v[84:87]
s_nop 0
ds_read_b64_tr_b16 v[164:165], v9 offset:57344
ds_read_b64_tr_b16 v[166:167], v9 offset:59392
v_mfma_f32_16x16x32_bf16 v[84:87], v[196:199], a[128:131], v[84:87]
v_xor_b32 v12, v113, v112
v_lshlrev_b32 v12, 4, v12
v_mfma_f32_16x16x32_bf16 v[88:91], v[200:203], a[128:131], v[88:91]
buffer_load_dwordx4 a[244:247], v1, s[44:47], s69 offen offset:1024 sc1
v_mfma_f32_16x16x32_bf16 v[88:91], v[216:219], a[132:135], v[88:91]
s_nop 0
ds_read_b64_tr_b16 v[168:169], v10 offset:57344
ds_read_b64_tr_b16 v[170:171], v10 offset:59392
v_mfma_f32_16x16x32_bf16 v[88:91], v[232:235], a[136:139], v[88:91]
s_nop 0
ds_read_b64_tr_b16 v[172:173], v11 offset:57344
ds_read_b64_tr_b16 v[174:175], v11 offset:59392
v_mfma_f32_16x16x32_bf16 v[88:91], v[248:251], a[140:143], v[88:91]
s_xor_b32 s71, s13, 0x400180
ds_read_b64_tr_b16 v[176:177], v8 offset:61440
ds_read_b64_tr_b16 v[178:179], v8 offset:63488
v_mfma_f32_16x16x32_bf16 v[104:107], v[248:251], a[156:159], v[104:107]
s_add_u32 m0, s85, 16384
v_lshl_add_u32 v112, v112, 12, v12
v_xor_b32 v12, 64, v112
v_mfma_f32_16x16x32_bf16 v[104:107], v[232:235], a[152:155], v[104:107]
s_add_u32 s72, s71, 0
buffer_load_dwordx4 v15, s[24:27], s72 offen lds
v_mfma_f32_16x16x32_bf16 v[104:107], v[216:219], a[148:151], v[104:107]
s_nop 0
ds_read_b64_tr_b16 v[180:181], v9 offset:61440
ds_read_b64_tr_b16 v[182:183], v9 offset:63488
v_mfma_f32_16x16x32_bf16 v[104:107], v[200:203], a[144:147], v[104:107]
s_nop 0
ds_read_b64_tr_b16 v[184:185], v10 offset:61440
ds_read_b64_tr_b16 v[186:187], v10 offset:63488
v_mfma_f32_16x16x32_bf16 v[108:111], v[204:207], a[144:147], v[108:111]
s_nop 0
ds_read_b64_tr_b16 v[188:189], v11 offset:61440
ds_read_b64_tr_b16 v[190:191], v11 offset:63488
v_mfma_f32_16x16x32_bf16 v[108:111], v[220:223], a[148:151], v[108:111]
v_lshlrev_b32 v113, 2, v113
v_mfma_f32_16x16x32_bf16 v[108:111], v[236:239], a[152:155], v[108:111]
s_add_u32 s72, s71, 15360
buffer_load_dwordx4 v15, s[24:27], s72 offen offset:1024 lds
v_mfma_f32_16x16x32_bf16 v[108:111], v[252:255], a[156:159], v[108:111]
buffer_load_dwordx4 a[248:251], v1, s[44:47], s69 offen offset:2048 sc1
v_mfma_f32_16x16x32_bf16 v[92:95], v[252:255], a[140:143], v[92:95]
v_xor_b32 v8, 0x10000, v8
v_mfma_f32_16x16x32_bf16 v[92:95], v[236:239], a[136:139], v[92:95]
v_xor_b32 v9, 0x10000, v9
v_mfma_f32_16x16x32_bf16 v[92:95], v[220:223], a[132:135], v[92:95]
s_waitcnt vmcnt(32) lgkmcnt(0)
v_xor_b32 v10, 0x10000, v10
v_mfma_f32_16x16x32_bf16 v[92:95], v[204:207], a[128:131], v[92:95]
s_barrier
v_xor_b32 v11, 0x10000, v11
v_mfma_f32_16x16x32_bf16 v[16:19], v[128:131], a[160:163], v[16:19]
s_add_u32 s72, s71, 30720
buffer_load_dwordx4 v15, s[24:27], s72 offen offset:2048 lds
v_mfma_f32_16x16x32_bf16 v[16:19], v[144:147], a[164:167], v[16:19]
s_nop 0
ds_read_b64_tr_b16 v[192:193], v8 offset:0
ds_read_b64_tr_b16 v[194:195], v8 offset:2048
v_mfma_f32_16x16x32_bf16 v[16:19], v[160:163], a[168:171], v[16:19]
s_nop 0
ds_read_b64_tr_b16 v[196:197], v9 offset:0
ds_read_b64_tr_b16 v[198:199], v9 offset:2048
v_mfma_f32_16x16x32_bf16 v[16:19], v[176:179], a[172:175], v[16:19]
s_nop 0
ds_read_b64_tr_b16 v[200:201], v10 offset:0
ds_read_b64_tr_b16 v[202:203], v10 offset:2048
v_mfma_f32_16x16x32_bf16 v[32:35], v[176:179], a[188:191], v[32:35]
buffer_load_dwordx4 a[252:255], v1, s[44:47], s69 offen offset:3072 sc1
v_mfma_f32_16x16x32_bf16 v[32:35], v[160:163], a[184:187], v[32:35]
v_mfma_f32_16x16x32_bf16 v[32:35], v[144:147], a[180:183], v[32:35]
s_add_u32 s72, s71, 46080
buffer_load_dwordx4 v15, s[24:27], s72 offen offset:3072 lds
v_mfma_f32_16x16x32_bf16 v[32:35], v[128:131], a[176:179], v[32:35]
s_nop 0
ds_read_b64_tr_b16 v[204:205], v11 offset:0
ds_read_b64_tr_b16 v[206:207], v11 offset:2048
v_mfma_f32_16x16x32_bf16 v[36:39], v[132:135], a[176:179], v[36:39]
s_nop 0
ds_read_b64_tr_b16 v[208:209], v8 offset:4096
ds_read_b64_tr_b16 v[210:211], v8 offset:6144
v_mfma_f32_16x16x32_bf16 v[36:39], v[148:151], a[180:183], v[36:39]
s_nop 0
ds_read_b64_tr_b16 v[212:213], v9 offset:4096
ds_read_b64_tr_b16 v[214:215], v9 offset:6144
v_mfma_f32_16x16x32_bf16 v[36:39], v[164:167], a[184:187], v[36:39]
v_mfma_f32_16x16x32_bf16 v[36:39], v[180:183], a[188:191], v[36:39]
s_nop 0
ds_read_b64_tr_b16 v[216:217], v10 offset:4096
ds_read_b64_tr_b16 v[218:219], v10 offset:6144
v_mfma_f32_16x16x32_bf16 v[20:23], v[180:183], a[172:175], v[20:23]
s_nop 0
ds_read_b64_tr_b16 v[220:221], v11 offset:4096
ds_read_b64_tr_b16 v[222:223], v11 offset:6144
v_mfma_f32_16x16x32_bf16 v[20:23], v[164:167], a[168:171], v[20:23]
v_mfma_f32_16x16x32_bf16 v[20:23], v[148:151], a[164:167], v[20:23]
s_xor_b32 s71, s14, 0x400180
ds_read_b64_tr_b16 v[224:225], v8 offset:8192
ds_read_b64_tr_b16 v[226:227], v8 offset:10240
v_mfma_f32_16x16x32_bf16 v[20:23], v[132:135], a[160:163], v[20:23]
s_add_u32 m0, s85, 32768
ds_read_b64_tr_b16 v[228:229], v9 offset:8192
ds_read_b64_tr_b16 v[230:231], v9 offset:10240
v_mfma_f32_16x16x32_bf16 v[24:27], v[136:139], a[160:163], v[24:27]
s_add_u32 s72, s71, 0
buffer_load_dwordx4 v15, s[24:27], s72 offen lds
v_mfma_f32_16x16x32_bf16 v[24:27], v[152:155], a[164:167], v[24:27]
s_nop 0
ds_read_b64_tr_b16 v[232:233], v10 offset:8192
ds_read_b64_tr_b16 v[234:235], v10 offset:10240
v_mfma_f32_16x16x32_bf16 v[24:27], v[168:171], a[168:171], v[24:27]
v_mfma_f32_16x16x32_bf16 v[24:27], v[184:187], a[172:175], v[24:27]
s_nop 0
ds_read_b64_tr_b16 v[236:237], v11 offset:8192
ds_read_b64_tr_b16 v[238:239], v11 offset:10240
v_mfma_f32_16x16x32_bf16 v[40:43], v[184:187], a[188:191], v[40:43]
s_nop 0
ds_read_b64_tr_b16 v[240:241], v8 offset:12288
ds_read_b64_tr_b16 v[242:243], v8 offset:14336
v_mfma_f32_16x16x32_bf16 v[40:43], v[168:171], a[184:187], v[40:43]
s_nop 0
ds_read_b64_tr_b16 v[244:245], v9 offset:12288
ds_read_b64_tr_b16 v[246:247], v9 offset:14336
v_mfma_f32_16x16x32_bf16 v[40:43], v[152:155], a[180:183], v[40:43]
s_add_u32 s72, s71, 15360
buffer_load_dwordx4 v15, s[24:27], s72 offen offset:1024 lds
v_mfma_f32_16x16x32_bf16 v[40:43], v[136:139], a[176:179], v[40:43]
v_mfma_f32_16x16x32_bf16 v[44:47], v[140:143], a[176:179], v[44:47]
s_nop 0
ds_read_b64_tr_b16 v[248:249], v10 offset:12288
ds_read_b64_tr_b16 v[250:251], v10 offset:14336
v_mfma_f32_16x16x32_bf16 v[44:47], v[156:159], a[180:183], v[44:47]
s_nop 0
ds_read_b64_tr_b16 v[252:253], v11 offset:12288
ds_read_b64_tr_b16 v[254:255], v11 offset:14336
v_mfma_f32_16x16x32_bf16 v[44:47], v[172:175], a[184:187], v[44:47]
v_mfma_f32_16x16x32_bf16 v[44:47], v[188:191], a[188:191], v[44:47]
v_mfma_f32_16x16x32_bf16 v[28:31], v[188:191], a[172:175], v[28:31]
s_add_u32 s72, s71, 30720
buffer_load_dwordx4 v15, s[24:27], s72 offen offset:2048 lds
v_mfma_f32_16x16x32_bf16 v[28:31], v[172:175], a[168:171], v[28:31]
v_mfma_f32_16x16x32_bf16 v[28:31], v[156:159], a[164:167], v[28:31]
s_waitcnt vmcnt(23) lgkmcnt(0)
v_mfma_f32_16x16x32_bf16 v[28:31], v[140:143], a[160:163], v[28:31]
s_barrier
v_mfma_f32_16x16x32_bf16 v[16:19], v[192:195], a[192:195], v[16:19]
s_nop 0
ds_read_b64_tr_b16 v[128:129], v8 offset:16384
ds_read_b64_tr_b16 v[130:131], v8 offset:18432
v_mfma_f32_16x16x32_bf16 v[16:19], v[208:211], a[196:199], v[16:19]
s_nop 0
ds_read_b64_tr_b16 v[132:133], v9 offset:16384
ds_read_b64_tr_b16 v[134:135], v9 offset:18432
v_mfma_f32_16x16x32_bf16 v[16:19], v[224:227], a[200:203], v[16:19]
s_add_u32 s72, s71, 46080
buffer_load_dwordx4 v15, s[24:27], s72 offen offset:3072 lds
v_mfma_f32_16x16x32_bf16 v[16:19], v[240:243], a[204:207], v[16:19]
s_nop 0
ds_read_b64_tr_b16 v[136:137], v10 offset:16384
ds_read_b64_tr_b16 v[138:139], v10 offset:18432
v_mfma_f32_16x16x32_bf16 v[32:35], v[240:243], a[220:223], v[32:35]
s_nop 0
ds_read_b64_tr_b16 v[140:141], v11 offset:16384
ds_read_b64_tr_b16 v[142:143], v11 offset:18432
v_mfma_f32_16x16x32_bf16 v[32:35], v[224:227], a[216:219], v[32:35]
v_mfma_f32_16x16x32_bf16 v[32:35], v[208:211], a[212:215], v[32:35]
s_nop 0
ds_read_b64_tr_b16 v[144:145], v8 offset:20480
ds_read_b64_tr_b16 v[146:147], v8 offset:22528
v_mfma_f32_16x16x32_bf16 v[32:35], v[192:195], a[208:211], v[32:35]
s_nop 0
ds_read_b64_tr_b16 v[148:149], v9 offset:20480
ds_read_b64_tr_b16 v[150:151], v9 offset:22528
v_mfma_f32_16x16x32_bf16 v[36:39], v[196:199], a[208:211], v[36:39]
s_nop 0
ds_read_b64_tr_b16 v[152:153], v10 offset:20480
ds_read_b64_tr_b16 v[154:155], v10 offset:22528
v_mfma_f32_16x16x32_bf16 v[36:39], v[212:215], a[212:215], v[36:39]
s_nop 0
ds_read_b64_tr_b16 v[156:157], v11 offset:20480
ds_read_b64_tr_b16 v[158:159], v11 offset:22528
v_mfma_f32_16x16x32_bf16 v[36:39], v[228:231], a[216:219], v[36:39]
v_mfma_f32_16x16x32_bf16 v[36:39], v[244:247], a[220:223], v[36:39]
s_add_u32 m0, s64, 147456
ds_read_b64_tr_b16 v[160:161], v8 offset:24576
ds_read_b64_tr_b16 v[162:163], v8 offset:26624
v_mfma_f32_16x16x32_bf16 v[20:23], v[244:247], a[204:207], v[20:23]
s_add_u32 s72, s73, 0
buffer_load_dwordx4 v112, s[44:47], s72 offen sc1 lds
v_mfma_f32_16x16x32_bf16 v[20:23], v[228:231], a[200:203], v[20:23]
s_nop 0
ds_read_b64_tr_b16 v[164:165], v9 offset:24576
ds_read_b64_tr_b16 v[166:167], v9 offset:26624
v_mfma_f32_16x16x32_bf16 v[20:23], v[212:215], a[196:199], v[20:23]
s_add_u32 s72, s73, 15360
buffer_load_dwordx4 v12, s[44:47], s72 offen offset:1024 sc1 lds
v_mfma_f32_16x16x32_bf16 v[20:23], v[196:199], a[192:195], v[20:23]
s_nop 0
ds_read_b64_tr_b16 v[168:169], v10 offset:24576
ds_read_b64_tr_b16 v[170:171], v10 offset:26624
v_mfma_f32_16x16x32_bf16 v[24:27], v[200:203], a[192:195], v[24:27]
s_nop 0
ds_read_b64_tr_b16 v[172:173], v11 offset:24576
ds_read_b64_tr_b16 v[174:175], v11 offset:26624
v_mfma_f32_16x16x32_bf16 v[24:27], v[216:219], a[196:199], v[24:27]
s_add_u32 s72, s73, 30720
buffer_load_dwordx4 v112, s[44:47], s72 offen offset:2048 sc1 lds
v_mfma_f32_16x16x32_bf16 v[24:27], v[232:235], a[200:203], v[24:27]
v_mfma_f32_16x16x32_bf16 v[24:27], v[248:251], a[204:207], v[24:27]
s_nop 0
ds_read_b64_tr_b16 v[176:177], v8 offset:28672
ds_read_b64_tr_b16 v[178:179], v8 offset:30720
v_mfma_f32_16x16x32_bf16 v[40:43], v[248:251], a[220:223], v[40:43]
s_add_u32 s72, s73, 46080
buffer_load_dwordx4 v12, s[44:47], s72 offen offset:3072 sc1 lds
v_mfma_f32_16x16x32_bf16 v[40:43], v[232:235], a[216:219], v[40:43]
s_xor_b32 s71, s15, 0x400180
ds_read_b64_tr_b16 v[180:181], v9 offset:28672
ds_read_b64_tr_b16 v[182:183], v9 offset:30720
v_mfma_f32_16x16x32_bf16 v[40:43], v[216:219], a[212:215], v[40:43]
s_add_u32 m0, s85, 49152
ds_read_b64_tr_b16 v[184:185], v10 offset:28672
ds_read_b64_tr_b16 v[186:187], v10 offset:30720
v_mfma_f32_16x16x32_bf16 v[40:43], v[200:203], a[208:211], v[40:43]
s_add_u32 s72, s71, 0
buffer_load_dwordx4 v15, s[24:27], s72 offen lds
v_mfma_f32_16x16x32_bf16 v[44:47], v[204:207], a[208:211], v[44:47]
s_nop 0
ds_read_b64_tr_b16 v[188:189], v11 offset:28672
ds_read_b64_tr_b16 v[190:191], v11 offset:30720
v_mfma_f32_16x16x32_bf16 v[44:47], v[220:223], a[212:215], v[44:47]
v_mfma_f32_16x16x32_bf16 v[44:47], v[236:239], a[216:219], v[44:47]
s_add_u32 s72, s71, 15360
buffer_load_dwordx4 v15, s[24:27], s72 offen offset:1024 lds
v_mfma_f32_16x16x32_bf16 v[44:47], v[252:255], a[220:223], v[44:47]
v_mfma_f32_16x16x32_bf16 v[28:31], v[252:255], a[204:207], v[28:31]
v_mfma_f32_16x16x32_bf16 v[28:31], v[236:239], a[200:203], v[28:31]
s_add_u32 s72, s71, 30720
buffer_load_dwordx4 v15, s[24:27], s72 offen offset:2048 lds
v_mfma_f32_16x16x32_bf16 v[28:31], v[220:223], a[196:199], v[28:31]
s_waitcnt vmcnt(12) lgkmcnt(0)
v_mfma_f32_16x16x32_bf16 v[28:31], v[204:207], a[192:195], v[28:31]
s_barrier
v_mfma_f32_16x16x32_bf16 v[16:19], v[128:131], a[224:227], v[16:19]
s_add_u32 s72, s71, 46080
buffer_load_dwordx4 v15, s[24:27], s72 offen offset:3072 lds
v_mfma_f32_16x16x32_bf16 v[16:19], v[144:147], a[228:231], v[16:19]
s_lshl_b32 s73, s75, 9
ds_read_b64_tr_b16 v[192:193], v8 offset:32768
ds_read_b64_tr_b16 v[194:195], v8 offset:34816
v_mfma_f32_16x16x32_bf16 v[16:19], v[160:163], a[232:235], v[16:19]
s_lshl_b32 s84, s58, 7
ds_read_b64_tr_b16 v[196:197], v9 offset:32768
ds_read_b64_tr_b16 v[198:199], v9 offset:34816
v_mfma_f32_16x16x32_bf16 v[16:19], v[176:179], a[236:239], v[16:19]
s_add_u32 s73, s73, s84
ds_read_b64_tr_b16 v[200:201], v10 offset:32768
ds_read_b64_tr_b16 v[202:203], v10 offset:34816
v_mfma_f32_16x16x32_bf16 v[20:23], v[180:183], a[236:239], v[20:23]
s_add_u32 s73, s73, 0x3800000
ds_read_b64_tr_b16 v[204:205], v11 offset:32768
ds_read_b64_tr_b16 v[206:207], v11 offset:34816
v_mfma_f32_16x16x32_bf16 v[20:23], v[164:167], a[232:235], v[20:23]
s_xor_b32 s71, s12, 0x0
buffer_load_dword v6, v113, s[44:47], s73 offen sc1
v_mfma_f32_16x16x32_bf16 v[20:23], v[148:151], a[228:231], v[20:23]
s_add_u32 m0, s77, 0
ds_read_b64_tr_b16 v[208:209], v8 offset:36864
ds_read_b64_tr_b16 v[210:211], v8 offset:38912
v_mfma_f32_16x16x32_bf16 v[20:23], v[132:135], a[224:227], v[20:23]
s_add_u32 s72, s71, 0
buffer_load_dwordx4 v15, s[24:27], s72 offen lds
v_mfma_f32_16x16x32_bf16 v[24:27], v[136:139], a[224:227], v[24:27]
s_nop 0
ds_read_b64_tr_b16 v[212:213], v9 offset:36864
ds_read_b64_tr_b16 v[214:215], v9 offset:38912
v_mfma_f32_16x16x32_bf16 v[24:27], v[152:155], a[228:231], v[24:27]
s_nop 0
ds_read_b64_tr_b16 v[216:217], v10 offset:36864
ds_read_b64_tr_b16 v[218:219], v10 offset:38912
v_mfma_f32_16x16x32_bf16 v[24:27], v[168:171], a[232:235], v[24:27]
buffer_load_dword v7, v113, s[44:47], s73 offen offset:64 sc1
v_mfma_f32_16x16x32_bf16 v[24:27], v[184:187], a[236:239], v[24:27]
s_nop 0
ds_read_b64_tr_b16 v[220:221], v11 offset:36864
ds_read_b64_tr_b16 v[222:223], v11 offset:38912
v_cvt_pk_bf16_f32 v16, v16, v17
v_mfma_f32_16x16x32_bf16 v[28:31], v[188:191], a[236:239], v[28:31]
s_nop 0
ds_read_b64_tr_b16 v[224:225], v8 offset:40960
ds_read_b64_tr_b16 v[226:227], v8 offset:43008
v_cvt_pk_bf16_f32 v17, v18, v19
v_mfma_f32_16x16x32_bf16 v[28:31], v[172:175], a[232:235], v[28:31]
s_add_u32 s72, s71, 15360
buffer_load_dwordx4 v15, s[24:27], s72 offen offset:1024 lds
v_cvt_pk_bf16_f32 v18, v20, v21
v_mfma_f32_16x16x32_bf16 v[28:31], v[156:159], a[228:231], v[28:31]
s_nop 0
ds_read_b64_tr_b16 v[228:229], v9 offset:40960
ds_read_b64_tr_b16 v[230:231], v9 offset:43008
v_cvt_pk_bf16_f32 v19, v22, v23
v_mfma_f32_16x16x32_bf16 v[28:31], v[140:143], a[224:227], v[28:31]
v_mfma_f32_16x16x32_bf16 v[32:35], v[128:131], a[240:243], v[32:35]
s_xor_b32 s80, s93, 0x80000
ds_read_b64_tr_b16 v[232:233], v10 offset:40960
ds_read_b64_tr_b16 v[234:235], v10 offset:43008
v_mfma_f32_16x16x32_bf16 v[32:35], v[144:147], a[244:247], v[32:35]
s_add_u32 s80, s80, 0x3a00000
buffer_store_dwordx4 v[16:19], v1, s[44:47], s80 offen sc1
v_mfma_f32_16x16x32_bf16 v[32:35], v[160:163], a[248:251], v[32:35]
s_nop 0
ds_read_b64_tr_b16 v[236:237], v11 offset:40960
ds_read_b64_tr_b16 v[238:239], v11 offset:43008
v_mfma_f32_16x16x32_bf16 v[32:35], v[176:179], a[252:255], v[32:35]
s_add_u32 s72, s71, 30720
buffer_load_dwordx4 v15, s[24:27], s72 offen offset:2048 lds
v_cvt_pk_bf16_f32 v20, v24, v25
v_mfma_f32_16x16x32_bf16 v[36:39], v[180:183], a[252:255], v[36:39]
s_nop 0
ds_read_b64_tr_b16 v[240:241], v8 offset:45056
ds_read_b64_tr_b16 v[242:243], v8 offset:47104
v_cvt_pk_bf16_f32 v21, v26, v27
v_mfma_f32_16x16x32_bf16 v[36:39], v[164:167], a[248:251], v[36:39]
v_cvt_pk_bf16_f32 v22, v28, v29
v_cvt_pk_bf16_f32 v23, v30, v31
v_mfma_f32_16x16x32_bf16 v[36:39], v[148:151], a[244:247], v[36:39]
s_nop 0
ds_read_b64_tr_b16 v[244:245], v9 offset:45056
ds_read_b64_tr_b16 v[246:247], v9 offset:47104
v_mfma_f32_16x16x32_bf16 v[36:39], v[132:135], a[240:243], v[36:39]
s_nop 0
ds_read_b64_tr_b16 v[248:249], v10 offset:45056
ds_read_b64_tr_b16 v[250:251], v10 offset:47104
v_mfma_f32_16x16x32_bf16 v[40:43], v[136:139], a[240:243], v[40:43]
s_nop 0
ds_read_b64_tr_b16 v[252:253], v11 offset:45056
ds_read_b64_tr_b16 v[254:255], v11 offset:47104
v_mfma_f32_16x16x32_bf16 v[40:43], v[152:155], a[244:247], v[40:43]
s_add_u32 s72, s71, 46080
buffer_load_dwordx4 v15, s[24:27], s72 offen offset:3072 lds
v_mfma_f32_16x16x32_bf16 v[40:43], v[168:171], a[248:251], v[40:43]
v_mfma_f32_16x16x32_bf16 v[40:43], v[184:187], a[252:255], v[40:43]
v_cvt_pk_bf16_f32 v24, v32, v33
v_cvt_pk_bf16_f32 v25, v34, v35
v_cvt_pk_bf16_f32 v26, v36, v37
v_mfma_f32_16x16x32_bf16 v[44:47], v[188:191], a[252:255], v[44:47]
v_cvt_pk_bf16_f32 v27, v38, v39
v_mfma_f32_16x16x32_bf16 v[44:47], v[172:175], a[248:251], v[44:47]
v_mfma_f32_16x16x32_bf16 v[44:47], v[156:159], a[244:247], v[44:47]
s_waitcnt vmcnt(33) lgkmcnt(0)
v_mfma_f32_16x16x32_bf16 v[44:47], v[140:143], a[240:243], v[44:47]
s_barrier
v_mfma_f32_16x16x32_bf16 v[48:51], v[192:195], a[160:163], v[48:51]
s_nop 0
ds_read_b64_tr_b16 v[128:129], v8 offset:49152
ds_read_b64_tr_b16 v[130:131], v8 offset:51200
v_mfma_f32_16x16x32_bf16 v[48:51], v[208:211], a[164:167], v[48:51]
s_xor_b32 s71, s13, 0x0
buffer_store_dwordx4 v[20:23], v1, s[44:47], s80 offen offset:1024 sc1
v_mfma_f32_16x16x32_bf16 v[48:51], v[224:227], a[168:171], v[48:51]
s_add_u32 m0, s77, 16384
ds_read_b64_tr_b16 v[132:133], v9 offset:49152
ds_read_b64_tr_b16 v[134:135], v9 offset:51200
v_mfma_f32_16x16x32_bf16 v[48:51], v[240:243], a[172:175], v[48:51]
s_add_u32 s72, s71, 0
buffer_load_dwordx4 v15, s[24:27], s72 offen lds
v_cvt_pk_bf16_f32 v28, v40, v41
v_mfma_f32_16x16x32_bf16 v[64:67], v[240:243], a[188:191], v[64:67]
s_nop 0
ds_read_b64_tr_b16 v[136:137], v10 offset:49152
ds_read_b64_tr_b16 v[138:139], v10 offset:51200
v_cvt_pk_bf16_f32 v29, v42, v43
v_mfma_f32_16x16x32_bf16 v[64:67], v[224:227], a[184:187], v[64:67]
s_nop 0
ds_read_b64_tr_b16 v[140:141], v11 offset:49152
ds_read_b64_tr_b16 v[142:143], v11 offset:51200
v_cvt_pk_bf16_f32 v30, v44, v45
v_mfma_f32_16x16x32_bf16 v[64:67], v[208:211], a[180:183], v[64:67]
v_cvt_pk_bf16_f32 v31, v46, v47
v_mfma_f32_16x16x32_bf16 v[64:67], v[192:195], a[176:179], v[64:67]
s_nop 0
ds_read_b64_tr_b16 v[144:145], v8 offset:53248
ds_read_b64_tr_b16 v[146:147], v8 offset:55296
v_mfma_f32_16x16x32_bf16 v[68:71], v[196:199], a[176:179], v[68:71]
s_add_u32 s72, s71, 15360
buffer_load_dwordx4 v15, s[24:27], s72 offen offset:1024 lds
v_mfma_f32_16x16x32_bf16 v[68:71], v[212:215], a[180:183], v[68:71]
s_nop 0
ds_read_b64_tr_b16 v[148:149], v9 offset:53248
ds_read_b64_tr_b16 v[150:151], v9 offset:55296
v_mfma_f32_16x16x32_bf16 v[68:71], v[228:231], a[184:187], v[68:71]
s_nop 0
ds_read_b64_tr_b16 v[152:153], v10 offset:53248
ds_read_b64_tr_b16 v[154:155], v10 offset:55296
v_mfma_f32_16x16x32_bf16 v[68:71], v[244:247], a[188:191], v[68:71]
v_mfma_f32_16x16x32_bf16 v[52:55], v[244:247], a[172:175], v[52:55]
s_nop 0
ds_read_b64_tr_b16 v[156:157], v11 offset:53248
ds_read_b64_tr_b16 v[158:159], v11 offset:55296
v_mfma_f32_16x16x32_bf16 v[52:55], v[228:231], a[168:171], v[52:55]
s_nop 0
ds_read_b64_tr_b16 v[160:161], v8 offset:57344
ds_read_b64_tr_b16 v[162:163], v8 offset:59392
v_mfma_f32_16x16x32_bf16 v[52:55], v[212:215], a[164:167], v[52:55]
s_add_u32 s72, s71, 30720
buffer_load_dwordx4 v15, s[24:27], s72 offen offset:2048 lds
v_mfma_f32_16x16x32_bf16 v[52:55], v[196:199], a[160:163], v[52:55]
s_nop 0
ds_read_b64_tr_b16 v[164:165], v9 offset:57344
ds_read_b64_tr_b16 v[166:167], v9 offset:59392
v_mfma_f32_16x16x32_bf16 v[56:59], v[200:203], a[160:163], v[56:59]
v_mfma_f32_16x16x32_bf16 v[56:59], v[216:219], a[164:167], v[56:59]
buffer_store_dwordx4 v[24:27], v1, s[44:47], s80 offen offset:2048 sc1
v_mfma_f32_16x16x32_bf16 v[56:59], v[232:235], a[168:171], v[56:59]
s_nop 0
ds_read_b64_tr_b16 v[168:169], v10 offset:57344
ds_read_b64_tr_b16 v[170:171], v10 offset:59392
v_mfma_f32_16x16x32_bf16 v[56:59], v[248:251], a[172:175], v[56:59]
s_nop 0
ds_read_b64_tr_b16 v[172:173], v11 offset:57344
ds_read_b64_tr_b16 v[174:175], v11 offset:59392
v_mfma_f32_16x16x32_bf16 v[72:75], v[248:251], a[188:191], v[72:75]
s_add_u32 s72, s71, 46080
buffer_load_dwordx4 v15, s[24:27], s72 offen offset:3072 lds
v_mfma_f32_16x16x32_bf16 v[72:75], v[232:235], a[184:187], v[72:75]
s_nop 0
ds_read_b64_tr_b16 v[176:177], v8 offset:61440
ds_read_b64_tr_b16 v[178:179], v8 offset:63488
v_mfma_f32_16x16x32_bf16 v[72:75], v[216:219], a[180:183], v[72:75]
v_mfma_f32_16x16x32_bf16 v[72:75], v[200:203], a[176:179], v[72:75]
s_nop 0
ds_read_b64_tr_b16 v[180:181], v9 offset:61440
ds_read_b64_tr_b16 v[182:183], v9 offset:63488
v_mfma_f32_16x16x32_bf16 v[76:79], v[204:207], a[176:179], v[76:79]
s_nop 0
ds_read_b64_tr_b16 v[184:185], v10 offset:61440
ds_read_b64_tr_b16 v[186:187], v10 offset:63488
v_mfma_f32_16x16x32_bf16 v[76:79], v[220:223], a[180:183], v[76:79]
s_nop 0
ds_read_b64_tr_b16 v[188:189], v11 offset:61440
ds_read_b64_tr_b16 v[190:191], v11 offset:63488
v_mfma_f32_16x16x32_bf16 v[76:79], v[236:239], a[184:187], v[76:79]
v_mfma_f32_16x16x32_bf16 v[76:79], v[252:255], a[188:191], v[76:79]
s_xor_b32 s71, s14, 0x0
v_mfma_f32_16x16x32_bf16 v[60:63], v[252:255], a[172:175], v[60:63]
s_add_u32 m0, s77, 32768
v_xor_b32 v8, 0x10000, v8
v_mfma_f32_16x16x32_bf16 v[60:63], v[236:239], a[168:171], v[60:63]
s_add_u32 s72, s71, 0
v_xor_b32 v9, 0x10000, v9
v_mfma_f32_16x16x32_bf16 v[60:63], v[220:223], a[164:167], v[60:63]
s_waitcnt vmcnt(32) lgkmcnt(0)
buffer_load_dwordx4 v15, s[24:27], s72 offen lds
v_xor_b32 v10, 0x10000, v10
v_mfma_f32_16x16x32_bf16 v[60:63], v[204:207], a[160:163], v[60:63]
s_barrier
v_xor_b32 v11, 0x10000, v11
v_mfma_f32_16x16x32_bf16 v[48:51], v[128:131], a[192:195], v[48:51]
s_nop 0
ds_read_b64_tr_b16 v[192:193], v8 offset:0
ds_read_b64_tr_b16 v[194:195], v8 offset:2048
v_mfma_f32_16x16x32_bf16 v[48:51], v[144:147], a[196:199], v[48:51]
buffer_store_dwordx4 v[28:31], v1, s[44:47], s80 offen offset:3072 sc1
v_mfma_f32_16x16x32_bf16 v[48:51], v[160:163], a[200:203], v[48:51]
s_nop 0
ds_read_b64_tr_b16 v[196:197], v9 offset:0
ds_read_b64_tr_b16 v[198:199], v9 offset:2048
v_mfma_f32_16x16x32_bf16 v[48:51], v[176:179], a[204:207], v[48:51]
s_add_u32 s72, s71, 15360
buffer_load_dwordx4 v15, s[24:27], s72 offen offset:1024 lds
v_mfma_f32_16x16x32_bf16 v[64:67], v[176:179], a[220:223], v[64:67]
s_nop 0
ds_read_b64_tr_b16 v[200:201], v10 offset:0
ds_read_b64_tr_b16 v[202:203], v10 offset:2048
v_mfma_f32_16x16x32_bf16 v[64:67], v[160:163], a[216:219], v[64:67]
v_mfma_f32_16x16x32_bf16 v[64:67], v[144:147], a[212:215], v[64:67]
s_nop 0
ds_read_b64_tr_b16 v[204:205], v11 offset:0
ds_read_b64_tr_b16 v[206:207], v11 offset:2048
v_mfma_f32_16x16x32_bf16 v[64:67], v[128:131], a[208:211], v[64:67]
s_nop 0
ds_read_b64_tr_b16 v[208:209], v8 offset:4096
ds_read_b64_tr_b16 v[210:211], v8 offset:6144
v_mfma_f32_16x16x32_bf16 v[68:71], v[132:135], a[208:211], v[68:71]
s_nop 0
ds_read_b64_tr_b16 v[212:213], v9 offset:4096
ds_read_b64_tr_b16 v[214:215], v9 offset:6144
v_mfma_f32_16x16x32_bf16 v[68:71], v[148:151], a[212:215], v[68:71]
s_add_u32 s72, s71, 30720
buffer_load_dwordx4 v15, s[24:27], s72 offen offset:2048 lds
v_mfma_f32_16x16x32_bf16 v[68:71], v[164:167], a[216:219], v[68:71]
v_mfma_f32_16x16x32_bf16 v[68:71], v[180:183], a[220:223], v[68:71]
s_nop 0
ds_read_b64_tr_b16 v[216:217], v10 offset:4096
ds_read_b64_tr_b16 v[218:219], v10 offset:6144
v_mfma_f32_16x16x32_bf16 v[52:55], v[180:183], a[204:207], v[52:55]
s_nop 0
ds_read_b64_tr_b16 v[220:221], v11 offset:4096
ds_read_b64_tr_b16 v[222:223], v11 offset:6144
v_mfma_f32_16x16x32_bf16 v[52:55], v[164:167], a[200:203], v[52:55]
v_mfma_f32_16x16x32_bf16 v[52:55], v[148:151], a[196:199], v[52:55]
s_nop 0
ds_read_b64_tr_b16 v[224:225], v8 offset:8192
ds_read_b64_tr_b16 v[226:227], v8 offset:10240
v_mfma_f32_16x16x32_bf16 v[52:55], v[132:135], a[192:195], v[52:55]
s_add_u32 s72, s71, 46080
buffer_load_dwordx4 v15, s[24:27], s72 offen offset:3072 lds
v_mfma_f32_16x16x32_bf16 v[56:59], v[136:139], a[192:195], v[56:59]
s_nop 0
ds_read_b64_tr_b16 v[228:229], v9 offset:8192
ds_read_b64_tr_b16 v[230:231], v9 offset:10240
v_mfma_f32_16x16x32_bf16 v[56:59], v[152:155], a[196:199], v[56:59]
s_nop 0
ds_read_b64_tr_b16 v[232:233], v10 offset:8192
ds_read_b64_tr_b16 v[234:235], v10 offset:10240
v_mfma_f32_16x16x32_bf16 v[56:59], v[168:171], a[200:203], v[56:59]
v_mfma_f32_16x16x32_bf16 v[56:59], v[184:187], a[204:207], v[56:59]
s_nop 0
ds_read_b64_tr_b16 v[236:237], v11 offset:8192
ds_read_b64_tr_b16 v[238:239], v11 offset:10240
v_mfma_f32_16x16x32_bf16 v[72:75], v[184:187], a[220:223], v[72:75]
s_nop 0
ds_read_b64_tr_b16 v[240:241], v8 offset:12288
ds_read_b64_tr_b16 v[242:243], v8 offset:14336
v_mfma_f32_16x16x32_bf16 v[72:75], v[168:171], a[216:219], v[72:75]
s_nop 0
ds_read_b64_tr_b16 v[244:245], v9 offset:12288
ds_read_b64_tr_b16 v[246:247], v9 offset:14336
v_mfma_f32_16x16x32_bf16 v[72:75], v[152:155], a[212:215], v[72:75]
Lstube3:
s_cbranch_execz Lrete
v_mfma_f32_16x16x32_bf16 v[72:75], v[136:139], a[208:211], v[72:75]
s_xor_b32 s71, s15, 0x0
ds_read_b64_tr_b16 v[248:249], v10 offset:12288
ds_read_b64_tr_b16 v[250:251], v10 offset:14336
v_mfma_f32_16x16x32_bf16 v[76:79], v[140:143], a[208:211], v[76:79]
s_add_u32 m0, s77, 49152
ds_read_b64_tr_b16 v[252:253], v11 offset:12288
ds_read_b64_tr_b16 v[254:255], v11 offset:14336
v_mfma_f32_16x16x32_bf16 v[76:79], v[156:159], a[212:215], v[76:79]
s_add_u32 s72, s71, 0
buffer_load_dwordx4 v15, s[24:27], s72 offen lds
v_mfma_f32_16x16x32_bf16 v[76:79], v[172:175], a[216:219], v[76:79]
v_mfma_f32_16x16x32_bf16 v[76:79], v[188:191], a[220:223], v[76:79]
v_mfma_f32_16x16x32_bf16 v[60:63], v[188:191], a[204:207], v[60:63]
v_mfma_f32_16x16x32_bf16 v[60:63], v[172:175], a[200:203], v[60:63]
s_add_u32 s72, s71, 15360
v_mfma_f32_16x16x32_bf16 v[60:63], v[156:159], a[196:199], v[60:63]
s_waitcnt vmcnt(31) lgkmcnt(0)
v_mfma_f32_16x16x32_bf16 v[60:63], v[140:143], a[192:195], v[60:63]
s_barrier
buffer_load_dwordx4 v15, s[24:27], s72 offen offset:1024 lds
v_mfma_f32_16x16x32_bf16 v[48:51], v[192:195], a[224:227], v[48:51]
s_nop 0
ds_read_b64_tr_b16 v[128:129], v8 offset:16384
ds_read_b64_tr_b16 v[130:131], v8 offset:18432
v_mfma_f32_16x16x32_bf16 v[48:51], v[208:211], a[228:231], v[48:51]
s_nop 0
ds_read_b64_tr_b16 v[132:133], v9 offset:16384
ds_read_b64_tr_b16 v[134:135], v9 offset:18432
v_mfma_f32_16x16x32_bf16 v[48:51], v[224:227], a[232:235], v[48:51]
s_nop 0
ds_read_b64_tr_b16 v[136:137], v10 offset:16384
ds_read_b64_tr_b16 v[138:139], v10 offset:18432
v_mfma_f32_16x16x32_bf16 v[48:51], v[240:243], a[236:239], v[48:51]
v_mfma_f32_16x16x32_bf16 v[52:55], v[244:247], a[236:239], v[52:55]
s_nop 0
ds_read_b64_tr_b16 v[140:141], v11 offset:16384
ds_read_b64_tr_b16 v[142:143], v11 offset:18432
v_mfma_f32_16x16x32_bf16 v[52:55], v[228:231], a[232:235], v[52:55]
s_add_u32 s72, s71, 30720
buffer_load_dwordx4 v15, s[24:27], s72 offen offset:2048 lds
v_mfma_f32_16x16x32_bf16 v[52:55], v[212:215], a[228:231], v[52:55]
s_nop 0
ds_read_b64_tr_b16 v[144:145], v8 offset:20480
ds_read_b64_tr_b16 v[146:147], v8 offset:22528
v_mfma_f32_16x16x32_bf16 v[52:55], v[196:199], a[224:227], v[52:55]
s_nop 0
ds_read_b64_tr_b16 v[148:149], v9 offset:20480
ds_read_b64_tr_b16 v[150:151], v9 offset:22528
v_mfma_f32_16x16x32_bf16 v[56:59], v[200:203], a[224:227], v[56:59]
v_mfma_f32_16x16x32_bf16 v[56:59], v[216:219], a[228:231], v[56:59]
s_nop 0
ds_read_b64_tr_b16 v[152:153], v10 offset:20480
ds_read_b64_tr_b16 v[154:155], v10 offset:22528
v_mfma_f32_16x16x32_bf16 v[56:59], v[232:235], a[232:235], v[56:59]
s_nop 0
ds_read_b64_tr_b16 v[156:157], v11 offset:20480
ds_read_b64_tr_b16 v[158:159], v11 offset:22528
v_mfma_f32_16x16x32_bf16 v[56:59], v[248:251], a[236:239], v[56:59]
s_add_u32 s72, s71, 46080
buffer_load_dwordx4 v15, s[24:27], s72 offen offset:3072 lds
v_cvt_pk_bf16_f32 v48, v48, v49
v_mfma_f32_16x16x32_bf16 v[60:63], v[252:255], a[236:239], v[60:63]
v_cvt_pk_bf16_f32 v49, v50, v51
v_cvt_pk_bf16_f32 v50, v52, v53
v_cvt_pk_bf16_f32 v51, v54, v55
v_mfma_f32_16x16x32_bf16 v[60:63], v[236:239], a[232:235], v[60:63]
s_nop 0
ds_read_b64_tr_b16 v[160:161], v8 offset:24576
ds_read_b64_tr_b16 v[162:163], v8 offset:26624
v_mfma_f32_16x16x32_bf16 v[60:63], v[220:223], a[228:231], v[60:63]
s_nop 0
ds_read_b64_tr_b16 v[164:165], v9 offset:24576
ds_read_b64_tr_b16 v[166:167], v9 offset:26624
v_mfma_f32_16x16x32_bf16 v[60:63], v[204:207], a[224:227], v[60:63]
s_nop 0
ds_read_b64_tr_b16 v[168:169], v10 offset:24576
ds_read_b64_tr_b16 v[170:171], v10 offset:26624
v_mfma_f32_16x16x32_bf16 v[64:67], v[192:195], a[240:243], v[64:67]
s_xor_b32 s80, s93, 0x100000
v_mfma_f32_16x16x32_bf16 v[64:67], v[208:211], a[244:247], v[64:67]
s_add_u32 s80, s80, 0x3e00000
buffer_store_dwordx4 v[48:51], v1, s[44:47], s80 offen sc1
v_mfma_f32_16x16x32_bf16 v[64:67], v[224:227], a[248:251], v[64:67]
s_nop 0
ds_read_b64_tr_b16 v[172:173], v11 offset:24576
ds_read_b64_tr_b16 v[174:175], v11 offset:26624
v_mfma_f32_16x16x32_bf16 v[64:67], v[240:243], a[252:255], v[64:67]
s_xor_b32 s71, s12, 0x400000
ds_read_b64_tr_b16 v[176:177], v8 offset:28672
ds_read_b64_tr_b16 v[178:179], v8 offset:30720
v_cvt_pk_bf16_f32 v52, v56, v57
v_mfma_f32_16x16x32_bf16 v[68:71], v[244:247], a[252:255], v[68:71]
s_add_u32 m0, s85, 0
ds_read_b64_tr_b16 v[180:181], v9 offset:28672
ds_read_b64_tr_b16 v[182:183], v9 offset:30720
v_cvt_pk_bf16_f32 v53, v58, v59
v_mfma_f32_16x16x32_bf16 v[68:71], v[228:231], a[248:251], v[68:71]
s_add_u32 s72, s71, 0
buffer_load_dwordx4 v15, s[24:27], s72 offen lds
v_cvt_pk_bf16_f32 v54, v60, v61
v_mfma_f32_16x16x32_bf16 v[68:71], v[212:215], a[244:247], v[68:71]
v_cvt_pk_bf16_f32 v55, v62, v63
v_mfma_f32_16x16x32_bf16 v[68:71], v[196:199], a[240:243], v[68:71]
s_nop 0
ds_read_b64_tr_b16 v[184:185], v10 offset:28672
ds_read_b64_tr_b16 v[186:187], v10 offset:30720
v_mfma_f32_16x16x32_bf16 v[72:75], v[200:203], a[240:243], v[72:75]
s_nop 0
ds_read_b64_tr_b16 v[188:189], v11 offset:28672
ds_read_b64_tr_b16 v[190:191], v11 offset:30720
v_mfma_f32_16x16x32_bf16 v[72:75], v[216:219], a[244:247], v[72:75]
v_mfma_f32_16x16x32_bf16 v[72:75], v[232:235], a[248:251], v[72:75]
s_add_u32 s72, s71, 15360
buffer_load_dwordx4 v15, s[24:27], s72 offen offset:1024 lds
v_mfma_f32_16x16x32_bf16 v[72:75], v[248:251], a[252:255], v[72:75]
v_cvt_pk_bf16_f32 v56, v64, v65
v_cvt_pk_bf16_f32 v57, v66, v67
v_cvt_pk_bf16_f32 v58, v68, v69
v_mfma_f32_16x16x32_bf16 v[76:79], v[252:255], a[252:255], v[76:79]
v_cvt_pk_bf16_f32 v59, v70, v71
v_mfma_f32_16x16x32_bf16 v[76:79], v[236:239], a[248:251], v[76:79]
v_mfma_f32_16x16x32_bf16 v[76:79], v[220:223], a[244:247], v[76:79]
s_waitcnt vmcnt(29) lgkmcnt(0)
v_mfma_f32_16x16x32_bf16 v[76:79], v[204:207], a[240:243], v[76:79]
s_barrier
v_mfma_f32_16x16x32_bf16 v[80:83], v[128:131], a[160:163], v[80:83]
s_add_u32 s72, s71, 30720
buffer_load_dwordx4 v15, s[24:27], s72 offen offset:2048 lds
v_mfma_f32_16x16x32_bf16 v[80:83], v[144:147], a[164:167], v[80:83]
s_waitcnt vmcnt(23)
buffer_store_dwordx4 v[52:55], v1, s[44:47], s80 offen offset:1024 sc1
v_mfma_f32_16x16x32_bf16 v[80:83], v[160:163], a[168:171], v[80:83]
s_nop 0
ds_read_b64_tr_b16 v[192:193], v8 offset:32768
ds_read_b64_tr_b16 v[194:195], v8 offset:34816
v_mfma_f32_16x16x32_bf16 v[80:83], v[176:179], a[172:175], v[80:83]
s_nop 0
ds_read_b64_tr_b16 v[196:197], v9 offset:32768
ds_read_b64_tr_b16 v[198:199], v9 offset:34816
v_cvt_pk_bf16_f32 v60, v72, v73
v_mfma_f32_16x16x32_bf16 v[96:99], v[176:179], a[188:191], v[96:99]
s_nop 0
ds_read_b64_tr_b16 v[200:201], v10 offset:32768
ds_read_b64_tr_b16 v[202:203], v10 offset:34816
v_cvt_pk_bf16_f32 v61, v74, v75
v_mfma_f32_16x16x32_bf16 v[96:99], v[160:163], a[184:187], v[96:99]
s_nop 0
ds_read_b64_tr_b16 v[204:205], v11 offset:32768
ds_read_b64_tr_b16 v[206:207], v11 offset:34816
v_cvt_pk_bf16_f32 v62, v76, v77
v_mfma_f32_16x16x32_bf16 v[96:99], v[144:147], a[180:183], v[96:99]
s_add_u32 s72, s71, 46080
buffer_load_dwordx4 v15, s[24:27], s72 offen offset:3072 lds
v_cvt_pk_bf16_f32 v63, v78, v79
v_mfma_f32_16x16x32_bf16 v[96:99], v[128:131], a[176:179], v[96:99]
v_sub_f32 v112, 1.0, v6
v_sub_f32 v113, 1.0, v7
v_mfma_f32_16x16x32_bf16 v[100:103], v[132:135], a[176:179], v[100:103]
s_nop 0
ds_read_b64_tr_b16 v[208:209], v8 offset:36864
ds_read_b64_tr_b16 v[210:211], v8 offset:38912
v_mfma_f32_16x16x32_bf16 v[100:103], v[148:151], a[180:183], v[100:103]
s_nop 0
ds_read_b64_tr_b16 v[212:213], v9 offset:36864
ds_read_b64_tr_b16 v[214:215], v9 offset:38912
v_mfma_f32_16x16x32_bf16 v[100:103], v[164:167], a[184:187], v[100:103]
s_nop 0
ds_read_b64_tr_b16 v[216:217], v10 offset:36864
ds_read_b64_tr_b16 v[218:219], v10 offset:38912
v_mfma_f32_16x16x32_bf16 v[100:103], v[180:183], a[188:191], v[100:103]
v_mfma_f32_16x16x32_bf16 v[84:87], v[180:183], a[172:175], v[84:87]
s_nop 0
ds_read_b64_tr_b16 v[220:221], v11 offset:36864
ds_read_b64_tr_b16 v[222:223], v11 offset:38912
v_mfma_f32_16x16x32_bf16 v[84:87], v[164:167], a[168:171], v[84:87]
s_nop 0
ds_read_b64_tr_b16 v[224:225], v8 offset:40960
ds_read_b64_tr_b16 v[226:227], v8 offset:43008
v_mfma_f32_16x16x32_bf16 v[84:87], v[148:151], a[164:167], v[84:87]
s_xor_b32 s71, s13, 0x400000
ds_read_b64_tr_b16 v[228:229], v9 offset:40960
ds_read_b64_tr_b16 v[230:231], v9 offset:43008
v_mfma_f32_16x16x32_bf16 v[84:87], v[132:135], a[160:163], v[84:87]
s_add_u32 m0, s85, 16384
v_mfma_f32_16x16x32_bf16 v[88:91], v[136:139], a[160:163], v[88:91]
s_add_u32 s72, s71, 0
buffer_load_dwordx4 v15, s[24:27], s72 offen lds
v_mfma_f32_16x16x32_bf16 v[88:91], v[152:155], a[164:167], v[88:91]
buffer_store_dwordx4 v[56:59], v1, s[44:47], s80 offen offset:2048 sc1
v_mfma_f32_16x16x32_bf16 v[88:91], v[168:171], a[168:171], v[88:91]
s_nop 0
ds_read_b64_tr_b16 v[232:233], v10 offset:40960
ds_read_b64_tr_b16 v[234:235], v10 offset:43008
v_mfma_f32_16x16x32_bf16 v[88:91], v[184:187], a[172:175], v[88:91]
s_nop 0
ds_read_b64_tr_b16 v[236:237], v11 offset:40960
ds_read_b64_tr_b16 v[238:239], v11 offset:43008
v_mfma_f32_16x16x32_bf16 v[104:107], v[184:187], a[188:191], v[104:107]
s_nop 0
ds_read_b64_tr_b16 v[240:241], v8 offset:45056
ds_read_b64_tr_b16 v[242:243], v8 offset:47104
v_mfma_f32_16x16x32_bf16 v[104:107], v[168:171], a[184:187], v[104:107]
v_mfma_f32_16x16x32_bf16 v[104:107], v[152:155], a[180:183], v[104:107]
s_add_u32 s72, s71, 15360
buffer_load_dwordx4 v15, s[24:27], s72 offen offset:1024 lds
v_mfma_f32_16x16x32_bf16 v[104:107], v[136:139], a[176:179], v[104:107]
s_nop 0
ds_read_b64_tr_b16 v[244:245], v9 offset:45056
ds_read_b64_tr_b16 v[246:247], v9 offset:47104
v_mfma_f32_16x16x32_bf16 v[108:111], v[140:143], a[176:179], v[108:111]
s_nop 0
ds_read_b64_tr_b16 v[248:249], v10 offset:45056
ds_read_b64_tr_b16 v[250:251], v10 offset:47104
v_mfma_f32_16x16x32_bf16 v[108:111], v[156:159], a[180:183], v[108:111]
s_nop 0
ds_read_b64_tr_b16 v[252:253], v11 offset:45056
ds_read_b64_tr_b16 v[254:255], v11 offset:47104
v_mfma_f32_16x16x32_bf16 v[108:111], v[172:175], a[184:187], v[108:111]
v_mfma_f32_16x16x32_bf16 v[108:111], v[188:191], a[188:191], v[108:111]
v_mfma_f32_16x16x32_bf16 v[92:95], v[188:191], a[172:175], v[92:95]
s_add_u32 s72, s71, 30720
buffer_load_dwordx4 v15, s[24:27], s72 offen offset:2048 lds
v_mfma_f32_16x16x32_bf16 v[92:95], v[172:175], a[168:171], v[92:95]
v_mfma_f32_16x16x32_bf16 v[92:95], v[156:159], a[164:167], v[92:95]
s_waitcnt vmcnt(32) lgkmcnt(0)
v_mfma_f32_16x16x32_bf16 v[92:95], v[140:143], a[160:163], v[92:95]
s_barrier
v_mfma_f32_16x16x32_bf16 v[80:83], v[192:195], a[192:195], v[80:83]
s_nop 0
ds_read_b64_tr_b16 v[128:129], v8 offset:49152
ds_read_b64_tr_b16 v[130:131], v8 offset:51200
v_mfma_f32_16x16x32_bf16 v[80:83], v[208:211], a[196:199], v[80:83]
buffer_store_dwordx4 v[60:63], v1, s[44:47], s80 offen offset:3072 sc1
v_mfma_f32_16x16x32_bf16 v[80:83], v[224:227], a[200:203], v[80:83]
s_add_u32 s72, s71, 46080
buffer_load_dwordx4 v15, s[24:27], s72 offen offset:3072 lds
v_mfma_f32_16x16x32_bf16 v[80:83], v[240:243], a[204:207], v[80:83]
s_nop 0
ds_read_b64_tr_b16 v[132:133], v9 offset:49152
ds_read_b64_tr_b16 v[134:135], v9 offset:51200
v_mfma_f32_16x16x32_bf16 v[96:99], v[240:243], a[220:223], v[96:99]
s_nop 0
ds_read_b64_tr_b16 v[136:137], v10 offset:49152
ds_read_b64_tr_b16 v[138:139], v10 offset:51200
v_mfma_f32_16x16x32_bf16 v[96:99], v[224:227], a[216:219], v[96:99]
s_nop 0
ds_read_b64 v[48:49], v116 offset:0
ds_read_b64_tr_b16 v[64:65], v5 offset:0
v_mfma_f32_16x16x32_bf16 v[96:99], v[208:211], a[212:215], v[96:99]
s_nop 0
ds_read_b64_tr_b16 v[140:141], v11 offset:49152
ds_read_b64_tr_b16 v[142:143], v11 offset:51200
v_mfma_f32_16x16x32_bf16 v[96:99], v[192:195], a[208:211], v[96:99]
s_nop 0
ds_read_b64_tr_b16 v[144:145], v8 offset:53248
ds_read_b64_tr_b16 v[146:147], v8 offset:55296
v_mfma_f32_16x16x32_bf16 v[100:103], v[196:199], a[208:211], v[100:103]
s_nop 0
ds_read_b64_tr_b16 v[148:149], v9 offset:53248
ds_read_b64_tr_b16 v[150:151], v9 offset:55296
v_mfma_f32_16x16x32_bf16 v[100:103], v[212:215], a[212:215], v[100:103]
s_nop 0
ds_read_b64 v[50:51], v117 offset:0
ds_read_b64_tr_b16 v[66:67], v5 offset:4096
v_mfma_f32_16x16x32_bf16 v[100:103], v[228:231], a[216:219], v[100:103]
s_xor_b32 s71, s14, 0x400000
ds_read_b64_tr_b16 v[152:153], v10 offset:53248
ds_read_b64_tr_b16 v[154:155], v10 offset:55296
v_mfma_f32_16x16x32_bf16 v[100:103], v[244:247], a[220:223], v[100:103]
s_add_u32 m0, s85, 32768
ds_read_b64_tr_b16 v[156:157], v11 offset:53248
ds_read_b64_tr_b16 v[158:159], v11 offset:55296
v_mfma_f32_16x16x32_bf16 v[84:87], v[244:247], a[204:207], v[84:87]
s_add_u32 s72, s71, 0
buffer_load_dwordx4 v15, s[24:27], s72 offen lds
v_mfma_f32_16x16x32_bf16 v[84:87], v[228:231], a[200:203], v[84:87]
s_nop 0
ds_read_b64 v[52:53], v118 offset:0
ds_read_b64_tr_b16 v[68:69], v5 offset:8192
v_mfma_f32_16x16x32_bf16 v[84:87], v[212:215], a[196:199], v[84:87]
s_nop 0
ds_read_b64_tr_b16 v[160:161], v8 offset:57344
ds_read_b64_tr_b16 v[162:163], v8 offset:59392
v_mfma_f32_16x16x32_bf16 v[84:87], v[196:199], a[192:195], v[84:87]
s_nop 0
ds_read_b64_tr_b16 v[164:165], v9 offset:57344
ds_read_b64_tr_b16 v[166:167], v9 offset:59392
v_mfma_f32_16x16x32_bf16 v[88:91], v[200:203], a[192:195], v[88:91]
s_nop 0
ds_read_b64_tr_b16 v[168:169], v10 offset:57344
ds_read_b64_tr_b16 v[170:171], v10 offset:59392
v_mfma_f32_16x16x32_bf16 v[88:91], v[216:219], a[196:199], v[88:91]
s_add_u32 s72, s71, 15360
buffer_load_dwordx4 v15, s[24:27], s72 offen offset:1024 lds
v_mfma_f32_16x16x32_bf16 v[88:91], v[232:235], a[200:203], v[88:91]
s_nop 0
ds_read_b64 v[54:55], v119 offset:0
ds_read_b64_tr_b16 v[70:71], v5 offset:12288
v_mfma_f32_16x16x32_bf16 v[88:91], v[248:251], a[204:207], v[88:91]
s_nop 0
ds_read_b64_tr_b16 v[172:173], v11 offset:57344
ds_read_b64_tr_b16 v[174:175], v11 offset:59392
v_mfma_f32_16x16x32_bf16 v[104:107], v[248:251], a[220:223], v[104:107]
s_nop 0
ds_read_b64_tr_b16 v[176:177], v8 offset:61440
ds_read_b64_tr_b16 v[178:179], v8 offset:63488
v_mfma_f32_16x16x32_bf16 v[104:107], v[232:235], a[216:219], v[104:107]
s_nop 0
ds_read_b64_tr_b16 v[180:181], v9 offset:61440
ds_read_b64_tr_b16 v[182:183], v9 offset:63488
v_mfma_f32_16x16x32_bf16 v[104:107], v[216:219], a[212:215], v[104:107]
v_xor_b32 v5, 16, v5
v_mfma_f32_16x16x32_bf16 v[104:107], v[200:203], a[208:211], v[104:107]
s_add_u32 s72, s71, 30720
buffer_load_dwordx4 v15, s[24:27], s72 offen offset:2048 lds
v_mfma_f32_16x16x32_bf16 v[108:111], v[204:207], a[208:211], v[108:111]
s_nop 0
ds_read_b64_tr_b16 v[184:185], v10 offset:61440
ds_read_b64_tr_b16 v[186:187], v10 offset:63488
v_mfma_f32_16x16x32_bf16 v[108:111], v[220:223], a[212:215], v[108:111]
s_nop 0
ds_read_b64_tr_b16 v[188:189], v11 offset:61440
ds_read_b64_tr_b16 v[190:191], v11 offset:63488
v_mfma_f32_16x16x32_bf16 v[108:111], v[236:239], a[216:219], v[108:111]
s_nop 0
ds_read_b64 v[56:57], v116 offset:2048
ds_read_b64_tr_b16 v[72:73], v5 offset:0
v_mfma_f32_16x16x32_bf16 v[108:111], v[252:255], a[220:223], v[108:111]
s_nop 0
ds_read_b64 v[58:59], v117 offset:2048
ds_read_b64_tr_b16 v[74:75], v5 offset:4096
v_mfma_f32_16x16x32_bf16 v[92:95], v[252:255], a[204:207], v[92:95]
ds_read_b64 v[60:61], v118 offset:2048
v_xor_b32 v8, 0x10000, v8
v_mfma_f32_16x16x32_bf16 v[92:95], v[236:239], a[200:203], v[92:95]
s_add_u32 s72, s71, 46080
buffer_load_dwordx4 v15, s[24:27], s72 offen offset:3072 lds
v_xor_b32 v9, 0x10000, v9
v_mfma_f32_16x16x32_bf16 v[92:95], v[220:223], a[196:199], v[92:95]
s_waitcnt vmcnt(31) lgkmcnt(0)
ds_read_b64_tr_b16 v[76:77], v5 offset:8192
v_xor_b32 v10, 0x10000, v10
v_mfma_f32_16x16x32_bf16 v[92:95], v[204:207], a[192:195], v[92:95]
s_barrier
ds_read_b64 v[62:63], v119 offset:2048
v_xor_b32 v11, 0x10000, v11
v_mfma_f32_16x16x32_bf16 v[80:83], v[128:131], a[224:227], v[80:83]
s_nop 0
ds_read_b64_tr_b16 v[192:193], v8 offset:0
ds_read_b64_tr_b16 v[194:195], v8 offset:2048
v_mfma_f32_16x16x32_bf16 v[80:83], v[144:147], a[228:231], v[80:83]
s_nop 0
ds_read_b64_tr_b16 v[196:197], v9 offset:0
ds_read_b64_tr_b16 v[198:199], v9 offset:2048
v_mfma_f32_16x16x32_bf16 v[80:83], v[160:163], a[232:235], v[80:83]
s_nop 0
ds_read_b64_tr_b16 v[200:201], v10 offset:0
ds_read_b64_tr_b16 v[202:203], v10 offset:2048
v_mfma_f32_16x16x32_bf16 v[80:83], v[176:179], a[236:239], v[80:83]
ds_read_b64_tr_b16 v[78:79], v5 offset:12288
v_mfma_f32_16x16x32_bf16 v[84:87], v[180:183], a[236:239], v[84:87]
s_nop 0
ds_read_b64_tr_b16 v[204:205], v11 offset:0
ds_read_b64_tr_b16 v[206:207], v11 offset:2048
v_mfma_f32_16x16x32_bf16 v[84:87], v[164:167], a[232:235], v[84:87]
s_xor_b32 s71, s15, 0x400000
ds_read_b64_tr_b16 v[208:209], v8 offset:4096
ds_read_b64_tr_b16 v[210:211], v8 offset:6144
v_mfma_f32_16x16x32_bf16 v[84:87], v[148:151], a[228:231], v[84:87]
s_add_u32 m0, s85, 49152
ds_read_b64_tr_b16 v[212:213], v9 offset:4096
ds_read_b64_tr_b16 v[214:215], v9 offset:6144
v_mfma_f32_16x16x32_bf16 v[84:87], v[132:135], a[224:227], v[84:87]
s_add_u32 s72, s71, 0
buffer_load_dwordx4 v15, s[24:27], s72 offen lds
v_mfma_f32_16x16x32_bf16 v[88:91], v[136:139], a[224:227], v[88:91]
v_mfma_f32_16x16x32_bf16 v[88:91], v[152:155], a[228:231], v[88:91]
s_waitcnt lgkmcnt(6)
ds_read_b64_tr_b16 v[216:217], v10 offset:4096
ds_read_b64_tr_b16 v[218:219], v10 offset:6144
v_mfma_f32_16x16x32_bf16 v[88:91], v[168:171], a[232:235], v[88:91]
s_nop 0
ds_read_b64_tr_b16 v[220:221], v11 offset:4096
ds_read_b64_tr_b16 v[222:223], v11 offset:6144
v_mfma_f32_16x16x32_bf16 v[88:91], v[184:187], a[236:239], v[88:91]
v_cvt_pk_bf16_f32 v80, v80, v81
v_cvt_pk_bf16_f32 v81, v82, v83
v_cvt_pk_bf16_f32 v82, v84, v85
v_mfma_f32_16x16x32_bf16 v[92:95], v[188:191], a[236:239], v[92:95]
s_nop 0
ds_read_b64_tr_b16 v[224:225], v8 offset:8192
ds_read_b64_tr_b16 v[226:227], v8 offset:10240
v_cvt_pk_bf16_f32 v83, v86, v87
v_mfma_f32_16x16x32_bf16 v[92:95], v[172:175], a[232:235], v[92:95]
s_add_u32 s72, s71, 15360
buffer_load_dwordx4 v15, s[24:27], s72 offen offset:1024 lds
v_mfma_f32_16x16x32_bf16 v[92:95], v[156:159], a[228:231], v[92:95]
s_nop 0
ds_read_b64_tr_b16 v[228:229], v9 offset:8192
ds_read_b64_tr_b16 v[230:231], v9 offset:10240
v_mfma_f32_16x16x32_bf16 v[92:95], v[140:143], a[224:227], v[92:95]
s_nop 0
ds_read_b64_tr_b16 v[232:233], v10 offset:8192
ds_read_b64_tr_b16 v[234:235], v10 offset:10240
v_mfma_f32_16x16x32_bf16 v[96:99], v[128:131], a[240:243], v[96:99]
s_xor_b32 s80, s93, 0x180000
v_and_b32 v114, 0xffff0000, v48
v_lshlrev_b32 v115, 16, v64
v_mfma_f32_16x16x32_bf16 v[96:99], v[144:147], a[244:247], v[96:99]
s_add_u32 s80, s80, 0x4200000
buffer_store_dwordx4 v[80:83], v1, s[44:47], s80 offen sc1
v_mfma_f32_16x16x32_bf16 v[96:99], v[160:163], a[248:251], v[96:99]
s_nop 0
ds_read_b64_tr_b16 v[236:237], v11 offset:8192
ds_read_b64_tr_b16 v[238:239], v11 offset:10240
v_mfma_f32_16x16x32_bf16 v[96:99], v[176:179], a[252:255], v[96:99]
s_add_u32 s72, s71, 30720
buffer_load_dwordx4 v15, s[24:27], s72 offen offset:2048 lds
v_cvt_pk_bf16_f32 v84, v88, v89
v_mfma_f32_16x16x32_bf16 v[100:103], v[180:183], a[252:255], v[100:103]
s_nop 0
ds_read_b64_tr_b16 v[240:241], v8 offset:12288
ds_read_b64_tr_b16 v[242:243], v8 offset:14336
v_cvt_pk_bf16_f32 v85, v90, v91
v_mfma_f32_16x16x32_bf16 v[100:103], v[164:167], a[248:251], v[100:103]
s_nop 0
ds_read_b64_tr_b16 v[244:245], v9 offset:12288
ds_read_b64_tr_b16 v[246:247], v9 offset:14336
v_cvt_pk_bf16_f32 v86, v92, v93
v_mfma_f32_16x16x32_bf16 v[100:103], v[148:151], a[244:247], v[100:103]
v_cvt_pk_bf16_f32 v87, v94, v95
v_lshlrev_b32 v48, 16, v48
v_mfma_f32_16x16x32_bf16 v[100:103], v[132:135], a[240:243], v[100:103]
s_nop 0
ds_read_b64_tr_b16 v[248:249], v10 offset:12288
ds_read_b64_tr_b16 v[250:251], v10 offset:14336
v_mfma_f32_16x16x32_bf16 v[104:107], v[136:139], a[240:243], v[104:107]
s_nop 0
ds_read_b64_tr_b16 v[252:253], v11 offset:12288
ds_read_b64_tr_b16 v[254:255], v11 offset:14336
v_mfma_f32_16x16x32_bf16 v[104:107], v[152:155], a[244:247], v[104:107]
s_add_u32 s72, s71, 46080
buffer_load_dwordx4 v15, s[24:27], s72 offen offset:3072 lds
v_mfma_f32_16x16x32_bf16 v[104:107], v[168:171], a[248:251], v[104:107]
v_and_b32 v64, 0xffff0000, v64
v_mul_f32 v48, v48, v112
v_mfma_f32_16x16x32_bf16 v[104:107], v[184:187], a[252:255], v[104:107]
v_cvt_pk_bf16_f32 v88, v96, v97
v_cvt_pk_bf16_f32 v89, v98, v99
v_cvt_pk_bf16_f32 v90, v100, v101
v_mfma_f32_16x16x32_bf16 v[108:111], v[188:191], a[252:255], v[108:111]
v_cvt_pk_bf16_f32 v91, v102, v103
v_mul_f32 v114, v114, v112
v_mfma_f32_16x16x32_bf16 v[108:111], v[172:175], a[248:251], v[108:111]
v_mul_f32 v48, v48, v115
v_mul_f32 v64, v64, v114
v_mfma_f32_16x16x32_bf16 v[108:111], v[156:159], a[244:247], v[108:111]
s_waitcnt vmcnt(30) lgkmcnt(0)
v_and_b32 v114, 0xffff0000, v49
v_lshlrev_b32 v115, 16, v65
v_mfma_f32_16x16x32_bf16 v[108:111], v[140:143], a[240:243], v[108:111]
s_barrier
v_lshlrev_b32 v49, 16, v49
v_and_b32 v65, 0xffff0000, v65
v_mfma_f32_16x16x32_bf16 v[16:19], v[192:195], a[0:3], 0
s_nop 0
ds_read_b64_tr_b16 v[128:129], v8 offset:16384
ds_read_b64_tr_b16 v[130:131], v8 offset:18432
v_mfma_f32_16x16x32_bf16 v[16:19], v[208:211], a[4:7], v[16:19]
buffer_store_dwordx4 v[84:87], v1, s[44:47], s80 offen offset:1024 sc1
v_mfma_f32_16x16x32_bf16 v[16:19], v[224:227], a[8:11], v[16:19]
s_nop 0
ds_read_b64_tr_b16 v[132:133], v9 offset:16384
ds_read_b64_tr_b16 v[134:135], v9 offset:18432
v_mfma_f32_16x16x32_bf16 v[16:19], v[240:243], a[12:15], v[16:19]
v_cvt_pk_bf16_f32 v92, v104, v105
v_cvt_pk_bf16_f32 v93, v106, v107
v_cvt_pk_bf16_f32 v94, v108, v109
v_mfma_f32_16x16x32_bf16 v[32:35], v[240:243], a[28:31], 0
s_nop 0
ds_read_b64_tr_b16 v[136:137], v10 offset:16384
ds_read_b64_tr_b16 v[138:139], v10 offset:18432
v_cvt_pk_bf16_f32 v95, v110, v111
v_mfma_f32_16x16x32_bf16 v[32:35], v[224:227], a[24:27], v[32:35]
s_nop 0
ds_read_b64_tr_b16 v[140:141], v11 offset:16384
ds_read_b64_tr_b16 v[142:143], v11 offset:18432
v_mfma_f32_16x16x32_bf16 v[32:35], v[208:211], a[20:23], v[32:35]
v_mul_f32 v49, v49, v112
v_mul_f32 v114, v114, v112
v_mfma_f32_16x16x32_bf16 v[32:35], v[192:195], a[16:19], v[32:35]
s_nop 0
ds_read_b64_tr_b16 v[144:145], v8 offset:20480
ds_read_b64_tr_b16 v[146:147], v8 offset:22528
v_mfma_f32_16x16x32_bf16 v[36:39], v[196:199], a[16:19], 0
s_nop 0
ds_read_b64_tr_b16 v[148:149], v9 offset:20480
ds_read_b64_tr_b16 v[150:151], v9 offset:22528
v_mfma_f32_16x16x32_bf16 v[36:39], v[212:215], a[20:23], v[36:39]
v_mul_f32 v49, v49, v115
v_mul_f32 v65, v65, v114
v_mfma_f32_16x16x32_bf16 v[36:39], v[228:231], a[24:27], v[36:39]
s_nop 0
ds_read_b64_tr_b16 v[152:153], v10 offset:20480
ds_read_b64_tr_b16 v[154:155], v10 offset:22528
v_mfma_f32_16x16x32_bf16 v[36:39], v[244:247], a[28:31], v[36:39]
s_nop 0
ds_read_b64_tr_b16 v[156:157], v11 offset:20480
ds_read_b64_tr_b16 v[158:159], v11 offset:22528
v_mfma_f32_16x16x32_bf16 v[20:23], v[244:247], a[12:15], 0
v_and_b32 v114, 0xffff0000, v50
v_lshlrev_b32 v115, 16, v66
v_mfma_f32_16x16x32_bf16 v[20:23], v[228:231], a[8:11], v[20:23]
s_nop 0
ds_read_b64_tr_b16 v[160:161], v8 offset:24576
ds_read_b64_tr_b16 v[162:163], v8 offset:26624
v_mfma_f32_16x16x32_bf16 v[20:23], v[212:215], a[4:7], v[20:23]
v_lshlrev_b32 v50, 16, v50
v_and_b32 v66, 0xffff0000, v66
v_mfma_f32_16x16x32_bf16 v[20:23], v[196:199], a[0:3], v[20:23]
s_nop 0
ds_read_b64_tr_b16 v[164:165], v9 offset:24576
ds_read_b64_tr_b16 v[166:167], v9 offset:26624
v_mfma_f32_16x16x32_bf16 v[24:27], v[200:203], a[0:3], 0
s_nop 0
ds_read_b64_tr_b16 v[168:169], v10 offset:24576
ds_read_b64_tr_b16 v[170:171], v10 offset:26624
v_mfma_f32_16x16x32_bf16 v[24:27], v[216:219], a[4:7], v[24:27]
buffer_store_dwordx4 v[88:91], v1, s[44:47], s80 offen offset:2048 sc1
v_mfma_f32_16x16x32_bf16 v[24:27], v[232:235], a[8:11], v[24:27]
v_mul_f32 v50, v50, v112
v_mul_f32 v114, v114, v112
v_mfma_f32_16x16x32_bf16 v[24:27], v[248:251], a[12:15], v[24:27]
s_nop 0
ds_read_b64_tr_b16 v[172:173], v11 offset:24576
ds_read_b64_tr_b16 v[174:175], v11 offset:26624
v_mfma_f32_16x16x32_bf16 v[40:43], v[248:251], a[28:31], 0
s_nop 0
ds_read_b64_tr_b16 v[176:177], v8 offset:28672
ds_read_b64_tr_b16 v[178:179], v8 offset:30720
v_mfma_f32_16x16x32_bf16 v[40:43], v[232:235], a[24:27], v[40:43]
v_mul_f32 v50, v50, v115
v_mul_f32 v66, v66, v114
v_mfma_f32_16x16x32_bf16 v[40:43], v[216:219], a[20:23], v[40:43]
s_nop 0
ds_read_b64_tr_b16 v[180:181], v9 offset:28672
ds_read_b64_tr_b16 v[182:183], v9 offset:30720
v_mfma_f32_16x16x32_bf16 v[40:43], v[200:203], a[16:19], v[40:43]
s_nop 0
ds_read_b64_tr_b16 v[184:185], v10 offset:28672
ds_read_b64_tr_b16 v[186:187], v10 offset:30720
v_mfma_f32_16x16x32_bf16 v[44:47], v[204:207], a[16:19], 0
v_and_b32 v114, 0xffff0000, v51
v_lshlrev_b32 v115, 16, v67
v_mfma_f32_16x16x32_bf16 v[44:47], v[220:223], a[20:23], v[44:47]
s_nop 0
ds_read_b64_tr_b16 v[188:189], v11 offset:28672
ds_read_b64_tr_b16 v[190:191], v11 offset:30720
v_mfma_f32_16x16x32_bf16 v[44:47], v[236:239], a[24:27], v[44:47]
v_lshlrev_b32 v51, 16, v51
v_and_b32 v67, 0xffff0000, v67
v_mfma_f32_16x16x32_bf16 v[44:47], v[252:255], a[28:31], v[44:47]
v_mul_f32 v51, v51, v112
v_mul_f32 v114, v114, v112
v_mfma_f32_16x16x32_bf16 v[28:31], v[252:255], a[12:15], 0
v_mul_f32 v51, v51, v115
v_mul_f32 v67, v67, v114
v_mfma_f32_16x16x32_bf16 v[28:31], v[236:239], a[8:11], v[28:31]
v_and_b32 v114, 0xffff0000, v52
v_lshlrev_b32 v115, 16, v68
v_mfma_f32_16x16x32_bf16 v[28:31], v[220:223], a[4:7], v[28:31]
s_waitcnt vmcnt(27) lgkmcnt(0)
v_lshlrev_b32 v52, 16, v52
v_and_b32 v68, 0xffff0000, v68
v_mfma_f32_16x16x32_bf16 v[28:31], v[204:207], a[0:3], v[28:31]
s_barrier
v_mul_f32 v52, v52, v112
v_mul_f32 v114, v114, v112
v_mfma_f32_16x16x32_bf16 v[16:19], v[128:131], a[32:35], v[16:19]
s_nop 0
ds_read_b64_tr_b16 v[192:193], v8 offset:32768
Lstube4:
s_cbranch_execz Lrete
ds_read_b64_tr_b16 v[194:195], v8 offset:34816
v_mfma_f32_16x16x32_bf16 v[16:19], v[144:147], a[36:39], v[16:19]
buffer_store_dwordx4 v[92:95], v1, s[44:47], s80 offen offset:3072 sc1
v_mfma_f32_16x16x32_bf16 v[16:19], v[160:163], a[40:43], v[16:19]
s_nop 0
ds_read_b64_tr_b16 v[196:197], v9 offset:32768
ds_read_b64_tr_b16 v[198:199], v9 offset:34816
v_mfma_f32_16x16x32_bf16 v[16:19], v[176:179], a[44:47], v[16:19]
v_mul_f32 v52, v52, v115
v_mul_f32 v68, v68, v114
v_mfma_f32_16x16x32_bf16 v[32:35], v[176:179], a[60:63], v[32:35]
s_nop 0
ds_read_b64_tr_b16 v[200:201], v10 offset:32768
ds_read_b64_tr_b16 v[202:203], v10 offset:34816
v_mfma_f32_16x16x32_bf16 v[32:35], v[160:163], a[56:59], v[32:35]
s_nop 0
ds_read_b64_tr_b16 v[204:205], v11 offset:32768
ds_read_b64_tr_b16 v[206:207], v11 offset:34816
v_mfma_f32_16x16x32_bf16 v[32:35], v[144:147], a[52:55], v[32:35]
v_and_b32 v114, 0xffff0000, v53
v_lshlrev_b32 v115, 16, v69
v_mfma_f32_16x16x32_bf16 v[32:35], v[128:131], a[48:51], v[32:35]
s_nop 0
ds_read_b64_tr_b16 v[208:209], v8 offset:36864
ds_read_b64_tr_b16 v[210:211], v8 offset:38912
v_mfma_f32_16x16x32_bf16 v[36:39], v[132:135], a[48:51], v[36:39]
v_lshlrev_b32 v53, 16, v53
v_and_b32 v69, 0xffff0000, v69
v_mfma_f32_16x16x32_bf16 v[36:39], v[148:151], a[52:55], v[36:39]
s_nop 0
ds_read_b64_tr_b16 v[212:213], v9 offset:36864
ds_read_b64_tr_b16 v[214:215], v9 offset:38912
v_mfma_f32_16x16x32_bf16 v[36:39], v[164:167], a[56:59], v[36:39]
s_nop 0
ds_read_b64_tr_b16 v[216:217], v10 offset:36864
ds_read_b64_tr_b16 v[218:219], v10 offset:38912
v_mfma_f32_16x16x32_bf16 v[36:39], v[180:183], a[60:63], v[36:39]
v_mul_f32 v53, v53, v112
v_mul_f32 v114, v114, v112
v_mfma_f32_16x16x32_bf16 v[20:23], v[180:183], a[44:47], v[20:23]
s_nop 0
ds_read_b64_tr_b16 v[220:221], v11 offset:36864
ds_read_b64_tr_b16 v[222:223], v11 offset:38912
v_mfma_f32_16x16x32_bf16 v[20:23], v[164:167], a[40:43], v[20:23]
v_mul_f32 v53, v53, v115
v_mul_f32 v69, v69, v114
v_mfma_f32_16x16x32_bf16 v[20:23], v[148:151], a[36:39], v[20:23]
s_nop 0
ds_read_b64_tr_b16 v[224:225], v8 offset:40960
ds_read_b64_tr_b16 v[226:227], v8 offset:43008
v_mfma_f32_16x16x32_bf16 v[20:23], v[132:135], a[32:35], v[20:23]
s_nop 0
ds_read_b64_tr_b16 v[228:229], v9 offset:40960
ds_read_b64_tr_b16 v[230:231], v9 offset:43008
v_mfma_f32_16x16x32_bf16 v[24:27], v[136:139], a[32:35], v[24:27]
v_and_b32 v114, 0xffff0000, v54
v_lshlrev_b32 v115, 16, v70
v_mfma_f32_16x16x32_bf16 v[24:27], v[152:155], a[36:39], v[24:27]
s_nop 0
ds_read_b64_tr_b16 v[232:233], v10 offset:40960
ds_read_b64_tr_b16 v[234:235], v10 offset:43008
v_mfma_f32_16x16x32_bf16 v[24:27], v[168:171], a[40:43], v[24:27]
s_nop 0
ds_read_b64_tr_b16 v[236:237], v11 offset:40960
ds_read_b64_tr_b16 v[238:239], v11 offset:43008
v_mfma_f32_16x16x32_bf16 v[24:27], v[184:187], a[44:47], v[24:27]
v_lshlrev_b32 v54, 16, v54
v_and_b32 v70, 0xffff0000, v70
v_mfma_f32_16x16x32_bf16 v[40:43], v[184:187], a[60:63], v[40:43]
s_nop 0
ds_read_b64_tr_b16 v[240:241], v8 offset:45056
ds_read_b64_tr_b16 v[242:243], v8 offset:47104
v_mfma_f32_16x16x32_bf16 v[40:43], v[168:171], a[56:59], v[40:43]
v_mul_f32 v54, v54, v112
v_mul_f32 v114, v114, v112
v_mfma_f32_16x16x32_bf16 v[40:43], v[152:155], a[52:55], v[40:43]
s_nop 0
ds_read_b64_tr_b16 v[244:245], v9 offset:45056
ds_read_b64_tr_b16 v[246:247], v9 offset:47104
v_mfma_f32_16x16x32_bf16 v[40:43], v[136:139], a[48:51], v[40:43]
s_nop 0
ds_read_b64_tr_b16 v[248:249], v10 offset:45056
ds_read_b64_tr_b16 v[250:251], v10 offset:47104
v_mfma_f32_16x16x32_bf16 v[44:47], v[140:143], a[48:51], v[44:47]
v_mul_f32 v54, v54, v115
v_mul_f32 v70, v70, v114
v_mfma_f32_16x16x32_bf16 v[44:47], v[156:159], a[52:55], v[44:47]
s_nop 0
ds_read_b64_tr_b16 v[252:253], v11 offset:45056
ds_read_b64_tr_b16 v[254:255], v11 offset:47104
v_mfma_f32_16x16x32_bf16 v[44:47], v[172:175], a[56:59], v[44:47]
v_and_b32 v114, 0xffff0000, v55
v_lshlrev_b32 v115, 16, v71
v_mfma_f32_16x16x32_bf16 v[44:47], v[188:191], a[60:63], v[44:47]
v_lshlrev_b32 v55, 16, v55
v_and_b32 v71, 0xffff0000, v71
v_mfma_f32_16x16x32_bf16 v[28:31], v[188:191], a[44:47], v[28:31]
v_mul_f32 v55, v55, v112
v_mul_f32 v114, v114, v112
v_mfma_f32_16x16x32_bf16 v[28:31], v[172:175], a[40:43], v[28:31]
s_add_u32 s79, s93, 0x3a00000
v_mul_f32 v55, v55, v115
v_mul_f32 v71, v71, v114
v_mfma_f32_16x16x32_bf16 v[28:31], v[156:159], a[36:39], v[28:31]
s_waitcnt vmcnt(24) lgkmcnt(0)
buffer_load_dwordx4 v[96:99], v1, s[44:47], s79 offen sc1
v_mfma_f32_16x16x32_bf16 v[28:31], v[140:143], a[32:35], v[28:31]
s_barrier
v_and_b32 v114, 0xffff0000, v56
v_lshlrev_b32 v115, 16, v72
v_mfma_f32_16x16x32_bf16 v[16:19], v[192:195], a[64:67], v[16:19]
s_nop 0
ds_read_b64_tr_b16 v[128:129], v8 offset:49152
ds_read_b64_tr_b16 v[130:131], v8 offset:51200
v_mfma_f32_16x16x32_bf16 v[16:19], v[208:211], a[68:71], v[16:19]
s_nop 0
ds_read_b64_tr_b16 v[132:133], v9 offset:49152
ds_read_b64_tr_b16 v[134:135], v9 offset:51200
v_mfma_f32_16x16x32_bf16 v[16:19], v[224:227], a[72:75], v[16:19]
v_lshlrev_b32 v56, 16, v56
v_and_b32 v72, 0xffff0000, v72
v_mfma_f32_16x16x32_bf16 v[16:19], v[240:243], a[76:79], v[16:19]
buffer_load_dwordx4 v[100:103], v1, s[44:47], s79 offen offset:1024 sc1
v_mfma_f32_16x16x32_bf16 v[32:35], v[240:243], a[92:95], v[32:35]
s_nop 0
ds_read_b64_tr_b16 v[136:137], v10 offset:49152
ds_read_b64_tr_b16 v[138:139], v10 offset:51200
v_mfma_f32_16x16x32_bf16 v[32:35], v[224:227], a[88:91], v[32:35]
s_nop 0
ds_read_b64_tr_b16 v[140:141], v11 offset:49152
ds_read_b64_tr_b16 v[142:143], v11 offset:51200
v_mfma_f32_16x16x32_bf16 v[32:35], v[208:211], a[84:87], v[32:35]
v_mul_f32 v56, v56, v113
v_mul_f32 v114, v114, v113
v_mfma_f32_16x16x32_bf16 v[32:35], v[192:195], a[80:83], v[32:35]
s_nop 0
ds_read_b64_tr_b16 v[144:145], v8 offset:53248
ds_read_b64_tr_b16 v[146:147], v8 offset:55296
v_mfma_f32_16x16x32_bf16 v[36:39], v[196:199], a[80:83], v[36:39]
buffer_load_dwordx4 v[104:107], v1, s[44:47], s79 offen offset:2048 sc1
v_mfma_f32_16x16x32_bf16 v[36:39], v[212:215], a[84:87], v[36:39]
s_nop 0
ds_read_b64_tr_b16 v[148:149], v9 offset:53248
ds_read_b64_tr_b16 v[150:151], v9 offset:55296
v_mfma_f32_16x16x32_bf16 v[36:39], v[228:231], a[88:91], v[36:39]
v_mul_f32 v56, v56, v115
v_mul_f32 v72, v72, v114
v_mfma_f32_16x16x32_bf16 v[36:39], v[244:247], a[92:95], v[36:39]
s_nop 0
ds_read_b64_tr_b16 v[152:153], v10 offset:53248
ds_read_b64_tr_b16 v[154:155], v10 offset:55296
v_mfma_f32_16x16x32_bf16 v[20:23], v[244:247], a[76:79], v[20:23]
s_nop 0
ds_read_b64_tr_b16 v[156:157], v11 offset:53248
ds_read_b64_tr_b16 v[158:159], v11 offset:55296
v_mfma_f32_16x16x32_bf16 v[20:23], v[228:231], a[72:75], v[20:23]
buffer_load_dwordx4 v[108:111], v1, s[44:47], s79 offen offset:3072 sc1
v_mfma_f32_16x16x32_bf16 v[20:23], v[212:215], a[68:71], v[20:23]
v_and_b32 v114, 0xffff0000, v57
v_lshlrev_b32 v115, 16, v73
v_mfma_f32_16x16x32_bf16 v[20:23], v[196:199], a[64:67], v[20:23]
s_nop 0
ds_read_b64_tr_b16 v[160:161], v8 offset:57344
ds_read_b64_tr_b16 v[162:163], v8 offset:59392
v_mfma_f32_16x16x32_bf16 v[24:27], v[200:203], a[64:67], v[24:27]
s_nop 0
ds_read_b64_tr_b16 v[164:165], v9 offset:57344
ds_read_b64_tr_b16 v[166:167], v9 offset:59392
v_mfma_f32_16x16x32_bf16 v[24:27], v[216:219], a[68:71], v[24:27]
v_lshlrev_b32 v57, 16, v57
v_and_b32 v73, 0xffff0000, v73
v_mfma_f32_16x16x32_bf16 v[24:27], v[232:235], a[72:75], v[24:27]
s_nop 0
ds_read_b64_tr_b16 v[168:169], v10 offset:57344
ds_read_b64_tr_b16 v[170:171], v10 offset:59392
v_mfma_f32_16x16x32_bf16 v[24:27], v[248:251], a[76:79], v[24:27]
s_nop 0
ds_read_b64_tr_b16 v[172:173], v11 offset:57344
ds_read_b64_tr_b16 v[174:175], v11 offset:59392
v_mfma_f32_16x16x32_bf16 v[40:43], v[248:251], a[92:95], v[40:43]
v_mul_f32 v57, v57, v113
v_mul_f32 v114, v114, v113
v_mfma_f32_16x16x32_bf16 v[40:43], v[232:235], a[88:91], v[40:43]
s_nop 0
ds_read_b64_tr_b16 v[176:177], v8 offset:61440
ds_read_b64_tr_b16 v[178:179], v8 offset:63488
v_mfma_f32_16x16x32_bf16 v[40:43], v[216:219], a[84:87], v[40:43]
s_nop 0
ds_read_b64_tr_b16 v[180:181], v9 offset:61440
ds_read_b64_tr_b16 v[182:183], v9 offset:63488
v_mfma_f32_16x16x32_bf16 v[40:43], v[200:203], a[80:83], v[40:43]
v_mul_f32 v57, v57, v115
v_mul_f32 v73, v73, v114
v_mfma_f32_16x16x32_bf16 v[44:47], v[204:207], a[80:83], v[44:47]
s_nop 0
ds_read_b64_tr_b16 v[184:185], v10 offset:61440
ds_read_b64_tr_b16 v[186:187], v10 offset:63488
v_mfma_f32_16x16x32_bf16 v[44:47], v[220:223], a[84:87], v[44:47]
s_nop 0
ds_read_b64_tr_b16 v[188:189], v11 offset:61440
ds_read_b64_tr_b16 v[190:191], v11 offset:63488
v_mfma_f32_16x16x32_bf16 v[44:47], v[236:239], a[88:91], v[44:47]
v_and_b32 v114, 0xffff0000, v58
v_lshlrev_b32 v115, 16, v74
v_mfma_f32_16x16x32_bf16 v[44:47], v[252:255], a[92:95], v[44:47]
v_lshlrev_b32 v58, 16, v58
v_and_b32 v74, 0xffff0000, v74
v_mfma_f32_16x16x32_bf16 v[28:31], v[252:255], a[76:79], v[28:31]
v_xor_b32 v8, 0x10000, v8
v_mul_f32 v58, v58, v113
v_mfma_f32_16x16x32_bf16 v[28:31], v[236:239], a[72:75], v[28:31]
v_xor_b32 v9, 0x10000, v9
v_mul_f32 v114, v114, v113
v_mfma_f32_16x16x32_bf16 v[28:31], v[220:223], a[68:71], v[28:31]
s_waitcnt vmcnt(22) lgkmcnt(0)
v_xor_b32 v10, 0x10000, v10
v_mul_f32 v58, v58, v115
v_mfma_f32_16x16x32_bf16 v[28:31], v[204:207], a[64:67], v[28:31]
s_barrier
v_xor_b32 v11, 0x10000, v11
v_mul_f32 v74, v74, v114
v_mfma_f32_16x16x32_bf16 v[16:19], v[128:131], a[96:99], v[16:19]
s_nop 0
ds_read_b64_tr_b16 v[192:193], v8 offset:0
ds_read_b64_tr_b16 v[194:195], v8 offset:2048
v_mfma_f32_16x16x32_bf16 v[16:19], v[144:147], a[100:103], v[16:19]
s_nop 0
ds_read_b64_tr_b16 v[196:197], v9 offset:0
ds_read_b64_tr_b16 v[198:199], v9 offset:2048
v_mfma_f32_16x16x32_bf16 v[16:19], v[160:163], a[104:107], v[16:19]
v_and_b32 v114, 0xffff0000, v59
v_lshlrev_b32 v115, 16, v75
v_mfma_f32_16x16x32_bf16 v[16:19], v[176:179], a[108:111], v[16:19]
s_nop 0
ds_read_b64_tr_b16 v[200:201], v10 offset:0
ds_read_b64_tr_b16 v[202:203], v10 offset:2048
v_mfma_f32_16x16x32_bf16 v[32:35], v[176:179], a[124:127], v[32:35]
v_lshlrev_b32 v59, 16, v59
v_and_b32 v75, 0xffff0000, v75
v_mfma_f32_16x16x32_bf16 v[32:35], v[160:163], a[120:123], v[32:35]
s_nop 0
ds_read_b64_tr_b16 v[204:205], v11 offset:0
ds_read_b64_tr_b16 v[206:207], v11 offset:2048
v_mfma_f32_16x16x32_bf16 v[32:35], v[144:147], a[116:119], v[32:35]
s_nop 0
ds_read_b64_tr_b16 v[208:209], v8 offset:4096
ds_read_b64_tr_b16 v[210:211], v8 offset:6144
v_mfma_f32_16x16x32_bf16 v[32:35], v[128:131], a[112:115], v[32:35]
v_mul_f32 v59, v59, v113
v_mul_f32 v114, v114, v113
v_mfma_f32_16x16x32_bf16 v[36:39], v[132:135], a[112:115], v[36:39]
s_nop 0
ds_read_b64_tr_b16 v[212:213], v9 offset:4096
ds_read_b64_tr_b16 v[214:215], v9 offset:6144
v_mfma_f32_16x16x32_bf16 v[36:39], v[148:151], a[116:119], v[36:39]
v_mul_f32 v59, v59, v115
v_mul_f32 v75, v75, v114
v_mfma_f32_16x16x32_bf16 v[36:39], v[164:167], a[120:123], v[36:39]
s_nop 0
ds_read_b64_tr_b16 v[216:217], v10 offset:4096
ds_read_b64_tr_b16 v[218:219], v10 offset:6144
v_mfma_f32_16x16x32_bf16 v[36:39], v[180:183], a[124:127], v[36:39]
s_nop 0
ds_read_b64_tr_b16 v[220:221], v11 offset:4096
ds_read_b64_tr_b16 v[222:223], v11 offset:6144
v_mfma_f32_16x16x32_bf16 v[20:23], v[180:183], a[108:111], v[20:23]
v_and_b32 v114, 0xffff0000, v60
v_lshlrev_b32 v115, 16, v76
v_mfma_f32_16x16x32_bf16 v[20:23], v[164:167], a[104:107], v[20:23]
s_nop 0
ds_read_b64_tr_b16 v[224:225], v8 offset:8192
ds_read_b64_tr_b16 v[226:227], v8 offset:10240
v_mfma_f32_16x16x32_bf16 v[20:23], v[148:151], a[100:103], v[20:23]
v_lshlrev_b32 v60, 16, v60
v_and_b32 v76, 0xffff0000, v76
v_mfma_f32_16x16x32_bf16 v[20:23], v[132:135], a[96:99], v[20:23]
s_nop 0
ds_read_b64_tr_b16 v[228:229], v9 offset:8192
ds_read_b64_tr_b16 v[230:231], v9 offset:10240
v_mfma_f32_16x16x32_bf16 v[24:27], v[136:139], a[96:99], v[24:27]
s_nop 0
ds_read_b64_tr_b16 v[232:233], v10 offset:8192
ds_read_b64_tr_b16 v[234:235], v10 offset:10240
v_mfma_f32_16x16x32_bf16 v[24:27], v[152:155], a[100:103], v[24:27]
v_mul_f32 v60, v60, v113
v_mul_f32 v114, v114, v113
v_mfma_f32_16x16x32_bf16 v[24:27], v[168:171], a[104:107], v[24:27]
s_nop 0
ds_read_b64_tr_b16 v[236:237], v11 offset:8192
ds_read_b64_tr_b16 v[238:239], v11 offset:10240
v_mfma_f32_16x16x32_bf16 v[24:27], v[184:187], a[108:111], v[24:27]
v_mul_f32 v60, v60, v115
v_mul_f32 v76, v76, v114
v_mfma_f32_16x16x32_bf16 v[40:43], v[184:187], a[124:127], v[40:43]
s_nop 0
ds_read_b64_tr_b16 v[240:241], v8 offset:12288
ds_read_b64_tr_b16 v[242:243], v8 offset:14336
v_mfma_f32_16x16x32_bf16 v[40:43], v[168:171], a[120:123], v[40:43]
s_nop 0
ds_read_b64_tr_b16 v[244:245], v9 offset:12288
ds_read_b64_tr_b16 v[246:247], v9 offset:14336
v_mfma_f32_16x16x32_bf16 v[40:43], v[152:155], a[116:119], v[40:43]
v_and_b32 v114, 0xffff0000, v61
v_lshlrev_b32 v115, 16, v77
v_mfma_f32_16x16x32_bf16 v[40:43], v[136:139], a[112:115], v[40:43]
s_nop 0
ds_read_b64_tr_b16 v[248:249], v10 offset:12288
ds_read_b64_tr_b16 v[250:251], v10 offset:14336
v_mfma_f32_16x16x32_bf16 v[44:47], v[140:143], a[112:115], v[44:47]
v_lshlrev_b32 v61, 16, v61
v_and_b32 v77, 0xffff0000, v77
v_mfma_f32_16x16x32_bf16 v[44:47], v[156:159], a[116:119], v[44:47]
s_nop 0
ds_read_b64_tr_b16 v[252:253], v11 offset:12288
ds_read_b64_tr_b16 v[254:255], v11 offset:14336
v_mfma_f32_16x16x32_bf16 v[44:47], v[172:175], a[120:123], v[44:47]
v_mul_f32 v61, v61, v113
v_mul_f32 v114, v114, v113
v_mfma_f32_16x16x32_bf16 v[44:47], v[188:191], a[124:127], v[44:47]
s_waitcnt vmcnt(0)
v_max3_u32 v12, v96, v97, v98
v_max3_u32 v13, v99, v100, v101
v_mfma_f32_16x16x32_bf16 v[28:31], v[188:191], a[108:111], v[28:31]
v_max3_u32 v12, v12, v102, v103
v_max3_u32 v13, v13, v104, v105
v_mfma_f32_16x16x32_bf16 v[28:31], v[172:175], a[104:107], v[28:31]
v_max3_u32 v12, v12, v106, v107
v_max3_u32 v13, v13, v108, v109
v_mfma_f32_16x16x32_bf16 v[28:31], v[156:159], a[100:103], v[28:31]
s_waitcnt vmcnt(16) lgkmcnt(0)
v_max3_u32 v12, v12, v110, v111
v_mul_f32 v61, v61, v115
v_mfma_f32_16x16x32_bf16 v[28:31], v[140:143], a[96:99], v[28:31]
s_barrier
v_max_u32 v12, v12, v13
v_mul_f32 v77, v77, v114
v_mfma_f32_16x16x32_bf16 v[16:19], v[192:195], a[128:131], v[16:19]
v_cmp_le_u32 vcc, 0xff800000, v12
v_and_b32 v114, 0xffff0000, v62
v_mfma_f32_16x16x32_bf16 v[16:19], v[208:211], a[132:135], v[16:19]
s_nop 0
ds_read_b64_tr_b16 v[128:129], v8 offset:16384
ds_read_b64_tr_b16 v[130:131], v8 offset:18432
v_mfma_f32_16x16x32_bf16 v[16:19], v[224:227], a[136:139], v[16:19]
s_cbranch_vccnz Lxspin1
Lxback1:
ds_read_b64_tr_b16 v[132:133], v9 offset:16384
ds_read_b64_tr_b16 v[134:135], v9 offset:18432
v_mfma_f32_16x16x32_bf16 v[16:19], v[240:243], a[140:143], v[16:19]
v_lshlrev_b32 v115, 16, v78
v_lshlrev_b32 v62, 16, v62
v_mfma_f32_16x16x32_bf16 v[16:19], v[124:127], v[96:99], v[16:19]
s_nop 0
ds_read_b64_tr_b16 v[136:137], v10 offset:16384
ds_read_b64_tr_b16 v[138:139], v10 offset:18432
v_mfma_f32_16x16x32_bf16 v[32:35], v[240:243], a[156:159], v[32:35]
v_and_b32 v78, 0xffff0000, v78
v_mul_f32 v62, v62, v113
v_mfma_f32_16x16x32_bf16 v[32:35], v[224:227], a[152:155], v[32:35]
s_add_u32 s82, s93, 0x3e00000
buffer_load_dwordx4 v[80:83], v1, s[44:47], s82 offen sc1
v_mfma_f32_16x16x32_bf16 v[32:35], v[208:211], a[148:151], v[32:35]
s_nop 0
ds_read_b64_tr_b16 v[140:141], v11 offset:16384
ds_read_b64_tr_b16 v[142:143], v11 offset:18432
v_mfma_f32_16x16x32_bf16 v[32:35], v[192:195], a[144:147], v[32:35]
v_mul_f32 v114, v114, v113
v_mul_f32 v62, v62, v115
v_mfma_f32_16x16x32_bf16 v[32:35], v[124:127], v[104:107], v[32:35]
s_nop 0
ds_read_b64_tr_b16 v[144:145], v8 offset:20480
ds_read_b64_tr_b16 v[146:147], v8 offset:22528
v_mfma_f32_16x16x32_bf16 v[36:39], v[196:199], a[144:147], v[36:39]
v_mul_f32 v78, v78, v114
v_and_b32 v114, 0xffff0000, v63
v_mfma_f32_16x16x32_bf16 v[36:39], v[212:215], a[148:151], v[36:39]
buffer_load_dwordx4 v[84:87], v1, s[44:47], s82 offen offset:1024 sc1
v_mfma_f32_16x16x32_bf16 v[36:39], v[228:231], a[152:155], v[36:39]
s_nop 0
ds_read_b64_tr_b16 v[148:149], v9 offset:20480
ds_read_b64_tr_b16 v[150:151], v9 offset:22528
v_mfma_f32_16x16x32_bf16 v[36:39], v[244:247], a[156:159], v[36:39]
v_lshlrev_b32 v115, 16, v79
v_lshlrev_b32 v63, 16, v63
v_mfma_f32_16x16x32_bf16 v[36:39], v[120:123], v[104:107], v[36:39]
s_nop 0
ds_read_b64_tr_b16 v[152:153], v10 offset:20480
ds_read_b64_tr_b16 v[154:155], v10 offset:22528
v_mfma_f32_16x16x32_bf16 v[20:23], v[244:247], a[140:143], v[20:23]
v_and_b32 v79, 0xffff0000, v79
v_mul_f32 v63, v63, v113
v_mfma_f32_16x16x32_bf16 v[20:23], v[228:231], a[136:139], v[20:23]
buffer_load_dwordx4 v[88:91], v1, s[44:47], s82 offen offset:2048 sc1
v_mfma_f32_16x16x32_bf16 v[20:23], v[212:215], a[132:135], v[20:23]
s_nop 0
ds_read_b64_tr_b16 v[156:157], v11 offset:20480
ds_read_b64_tr_b16 v[158:159], v11 offset:22528
v_mfma_f32_16x16x32_bf16 v[20:23], v[196:199], a[128:131], v[20:23]
v_mul_f32 v114, v114, v113
v_mul_f32 v63, v63, v115
v_mfma_f32_16x16x32_bf16 v[20:23], v[120:123], v[96:99], v[20:23]
s_nop 0
ds_read_b64_tr_b16 v[160:161], v8 offset:24576
ds_read_b64_tr_b16 v[162:163], v8 offset:26624
v_mfma_f32_16x16x32_bf16 v[24:27], v[200:203], a[128:131], v[24:27]
s_nop 0
ds_read_b64_tr_b16 v[164:165], v9 offset:24576
ds_read_b64_tr_b16 v[166:167], v9 offset:26624
v_mfma_f32_16x16x32_bf16 v[24:27], v[216:219], a[132:135], v[24:27]
buffer_load_dwordx4 v[92:95], v1, s[44:47], s82 offen offset:3072 sc1
v_mfma_f32_16x16x32_bf16 v[24:27], v[232:235], a[136:139], v[24:27]
v_mul_f32 v79, v79, v114
v_mfma_f32_16x16x32_bf16 v[24:27], v[248:251], a[140:143], v[24:27]
s_nop 0
ds_read_b64_tr_b16 v[168:169], v10 offset:24576
ds_read_b64_tr_b16 v[170:171], v10 offset:26624
v_mfma_f32_16x16x32_bf16 v[24:27], v[124:127], v[100:103], v[24:27]
v_mfma_f32_16x16x32_bf16 v[40:43], v[248:251], a[156:159], v[40:43]
s_nop 0
ds_read_b64_tr_b16 v[172:173], v11 offset:24576
ds_read_b64_tr_b16 v[174:175], v11 offset:26624
v_mfma_f32_16x16x32_bf16 v[40:43], v[232:235], a[152:155], v[40:43]
v_mfma_f32_16x16x32_bf16 v[40:43], v[216:219], a[148:151], v[40:43]
s_nop 0
ds_read_b64_tr_b16 v[176:177], v8 offset:28672
ds_read_b64_tr_b16 v[178:179], v8 offset:30720
v_mfma_f32_16x16x32_bf16 v[40:43], v[200:203], a[144:147], v[40:43]
v_mfma_f32_16x16x32_bf16 v[40:43], v[124:127], v[108:111], v[40:43]
s_nop 0
ds_read_b64_tr_b16 v[180:181], v9 offset:28672
ds_read_b64_tr_b16 v[182:183], v9 offset:30720
v_mfma_f32_16x16x32_bf16 v[44:47], v[204:207], a[144:147], v[44:47]
v_mfma_f32_16x16x32_bf16 v[44:47], v[220:223], a[148:151], v[44:47]
s_nop 0
ds_read_b64_tr_b16 v[184:185], v10 offset:28672
ds_read_b64_tr_b16 v[186:187], v10 offset:30720
v_mfma_f32_16x16x32_bf16 v[44:47], v[236:239], a[152:155], v[44:47]
v_mfma_f32_16x16x32_bf16 v[44:47], v[252:255], a[156:159], v[44:47]
s_nop 0
ds_read_b64_tr_b16 v[188:189], v11 offset:28672
ds_read_b64_tr_b16 v[190:191], v11 offset:30720
v_mfma_f32_16x16x32_bf16 v[44:47], v[120:123], v[108:111], v[44:47]
v_mfma_f32_16x16x32_bf16 v[28:31], v[252:255], a[140:143], v[28:31]
v_mfma_f32_16x16x32_bf16 v[28:31], v[236:239], a[136:139], v[28:31]
v_mfma_f32_16x16x32_bf16 v[28:31], v[220:223], a[132:135], v[28:31]
v_mfma_f32_16x16x32_bf16 v[28:31], v[204:207], a[128:131], v[28:31]
s_waitcnt vmcnt(16) lgkmcnt(0)
v_mfma_f32_16x16x32_bf16 v[28:31], v[120:123], v[100:103], v[28:31]
s_barrier
v_mfma_f32_16x16x32_bf16 v[16:19], v[128:131], a[160:163], v[16:19]
s_nop 0
ds_read_b64_tr_b16 v[192:193], v8 offset:32768
ds_read_b64_tr_b16 v[194:195], v8 offset:34816
v_mfma_f32_16x16x32_bf16 v[16:19], v[144:147], a[164:167], v[16:19]
s_nop 0
ds_read_b64_tr_b16 v[196:197], v9 offset:32768
ds_read_b64_tr_b16 v[198:199], v9 offset:34816
v_mfma_f32_16x16x32_bf16 v[16:19], v[160:163], a[168:171], v[16:19]
s_nop 0
ds_read_b64_tr_b16 v[200:201], v10 offset:32768
ds_read_b64_tr_b16 v[202:203], v10 offset:34816
v_mfma_f32_16x16x32_bf16 v[16:19], v[176:179], a[172:175], v[16:19]
v_mfma_f32_16x16x32_bf16 v[32:35], v[176:179], a[188:191], v[32:35]
s_nop 0
ds_read_b64_tr_b16 v[204:205], v11 offset:32768
ds_read_b64_tr_b16 v[206:207], v11 offset:34816
v_mfma_f32_16x16x32_bf16 v[32:35], v[160:163], a[184:187], v[32:35]
s_nop 0
ds_read_b64_tr_b16 v[208:209], v8 offset:36864
ds_read_b64_tr_b16 v[210:211], v8 offset:38912
v_mfma_f32_16x16x32_bf16 v[32:35], v[144:147], a[180:183], v[32:35]
s_add_u32 s81, s93, 0x4200000
buffer_load_dwordx4 v[96:99], v1, s[44:47], s81 offen sc1
v_mfma_f32_16x16x32_bf16 v[32:35], v[128:131], a[176:179], v[32:35]
v_mfma_f32_16x16x32_bf16 v[36:39], v[132:135], a[176:179], v[36:39]
s_nop 0
ds_read_b64_tr_b16 v[212:213], v9 offset:36864
ds_read_b64_tr_b16 v[214:215], v9 offset:38912
v_mfma_f32_16x16x32_bf16 v[36:39], v[148:151], a[180:183], v[36:39]
s_nop 0
ds_read_b64_tr_b16 v[216:217], v10 offset:36864
ds_read_b64_tr_b16 v[218:219], v10 offset:38912
v_mfma_f32_16x16x32_bf16 v[36:39], v[164:167], a[184:187], v[36:39]
v_mfma_f32_16x16x32_bf16 v[36:39], v[180:183], a[188:191], v[36:39]
buffer_load_dwordx4 v[100:103], v1, s[44:47], s81 offen offset:1024 sc1
v_mfma_f32_16x16x32_bf16 v[20:23], v[180:183], a[172:175], v[20:23]
s_nop 0
ds_read_b64_tr_b16 v[220:221], v11 offset:36864
ds_read_b64_tr_b16 v[222:223], v11 offset:38912
v_mfma_f32_16x16x32_bf16 v[20:23], v[164:167], a[168:171], v[20:23]
s_nop 0
ds_read_b64_tr_b16 v[224:225], v8 offset:40960
ds_read_b64_tr_b16 v[226:227], v8 offset:43008
v_mfma_f32_16x16x32_bf16 v[20:23], v[148:151], a[164:167], v[20:23]
s_nop 0
ds_read_b64_tr_b16 v[228:229], v9 offset:40960
ds_read_b64_tr_b16 v[230:231], v9 offset:43008
v_mfma_f32_16x16x32_bf16 v[20:23], v[132:135], a[160:163], v[20:23]
v_mfma_f32_16x16x32_bf16 v[24:27], v[136:139], a[160:163], v[24:27]
buffer_load_dwordx4 v[104:107], v1, s[44:47], s81 offen offset:2048 sc1
v_mfma_f32_16x16x32_bf16 v[24:27], v[152:155], a[164:167], v[24:27]
s_nop 0
ds_read_b64_tr_b16 v[232:233], v10 offset:40960
ds_read_b64_tr_b16 v[234:235], v10 offset:43008
v_mfma_f32_16x16x32_bf16 v[24:27], v[168:171], a[168:171], v[24:27]
s_nop 0
ds_read_b64_tr_b16 v[236:237], v11 offset:40960
ds_read_b64_tr_b16 v[238:239], v11 offset:43008
v_mfma_f32_16x16x32_bf16 v[24:27], v[184:187], a[172:175], v[24:27]
v_mfma_f32_16x16x32_bf16 v[40:43], v[184:187], a[188:191], v[40:43]
s_nop 0
ds_read_b64_tr_b16 v[240:241], v8 offset:45056
ds_read_b64_tr_b16 v[242:243], v8 offset:47104
v_mfma_f32_16x16x32_bf16 v[40:43], v[168:171], a[184:187], v[40:43]
buffer_load_dwordx4 v[108:111], v1, s[44:47], s81 offen offset:3072 sc1
v_mfma_f32_16x16x32_bf16 v[40:43], v[152:155], a[180:183], v[40:43]
s_nop 0
ds_read_b64_tr_b16 v[244:245], v9 offset:45056
ds_read_b64_tr_b16 v[246:247], v9 offset:47104
v_mfma_f32_16x16x32_bf16 v[40:43], v[136:139], a[176:179], v[40:43]
v_mfma_f32_16x16x32_bf16 v[44:47], v[140:143], a[176:179], v[44:47]
s_nop 0
ds_read_b64_tr_b16 v[248:249], v10 offset:45056
ds_read_b64_tr_b16 v[250:251], v10 offset:47104
v_mfma_f32_16x16x32_bf16 v[44:47], v[156:159], a[180:183], v[44:47]
s_nop 0
ds_read_b64_tr_b16 v[252:253], v11 offset:45056
ds_read_b64_tr_b16 v[254:255], v11 offset:47104
v_mfma_f32_16x16x32_bf16 v[44:47], v[172:175], a[184:187], v[44:47]
v_mfma_f32_16x16x32_bf16 v[44:47], v[188:191], a[188:191], v[44:47]
s_waitcnt vmcnt(4)
v_max3_u32 v12, v80, v81, v82
v_max3_u32 v13, v83, v84, v85
v_mfma_f32_16x16x32_bf16 v[28:31], v[188:191], a[172:175], v[28:31]
v_max3_u32 v12, v12, v86, v87
v_max3_u32 v13, v13, v88, v89
v_mfma_f32_16x16x32_bf16 v[28:31], v[172:175], a[168:171], v[28:31]
v_max3_u32 v12, v12, v90, v91
v_max3_u32 v13, v13, v92, v93
v_mfma_f32_16x16x32_bf16 v[28:31], v[156:159], a[164:167], v[28:31]
s_waitcnt vmcnt(15) lgkmcnt(0)
v_max3_u32 v12, v12, v94, v95
v_mfma_f32_16x16x32_bf16 v[28:31], v[140:143], a[160:163], v[28:31]
s_barrier
v_max_u32 v12, v12, v13
v_mfma_f32_16x16x32_bf16 v[16:19], v[192:195], a[192:195], v[16:19]
v_cmp_le_u32 vcc, 0xff800000, v12
v_mfma_f32_16x16x32_bf16 v[16:19], v[208:211], a[196:199], v[16:19]
s_nop 0
ds_read_b64_tr_b16 v[128:129], v8 offset:49152
ds_read_b64_tr_b16 v[130:131], v8 offset:51200
v_mfma_f32_16x16x32_bf16 v[16:19], v[224:227], a[200:203], v[16:19]
s_cbranch_vccnz Lxspin2
Lxback2:
v_mfma_f32_16x16x32_bf16 v[16:19], v[240:243], a[204:207], v[16:19]
s_nop 0
ds_read_b64_tr_b16 v[132:133], v9 offset:49152
ds_read_b64_tr_b16 v[134:135], v9 offset:51200
v_mfma_f32_16x16x32_bf16 v[16:19], v[124:127], v[80:83], v[16:19]
v_mfma_f32_16x16x32_bf16 v[32:35], v[240:243], a[220:223], v[32:35]
s_nop 0
ds_read_b64_tr_b16 v[136:137], v10 offset:49152
ds_read_b64_tr_b16 v[138:139], v10 offset:51200
v_mfma_f32_16x16x32_bf16 v[32:35], v[224:227], a[216:219], v[32:35]
v_mfma_f32_16x16x32_bf16 v[32:35], v[208:211], a[212:215], v[32:35]
s_nop 0
ds_read_b64_tr_b16 v[140:141], v11 offset:49152
ds_read_b64_tr_b16 v[142:143], v11 offset:51200
v_mfma_f32_16x16x32_bf16 v[32:35], v[192:195], a[208:211], v[32:35]
v_mfma_f32_16x16x32_bf16 v[32:35], v[124:127], v[88:91], v[32:35]
s_nop 0
ds_read_b64_tr_b16 v[144:145], v8 offset:53248
ds_read_b64_tr_b16 v[146:147], v8 offset:55296
v_mfma_f32_16x16x32_bf16 v[36:39], v[196:199], a[208:211], v[36:39]
v_mfma_f32_16x16x32_bf16 v[36:39], v[212:215], a[212:215], v[36:39]
s_nop 0
ds_read_b64_tr_b16 v[148:149], v9 offset:53248
ds_read_b64_tr_b16 v[150:151], v9 offset:55296
v_mfma_f32_16x16x32_bf16 v[36:39], v[228:231], a[216:219], v[36:39]
v_mfma_f32_16x16x32_bf16 v[36:39], v[244:247], a[220:223], v[36:39]
s_nop 0
ds_read_b64_tr_b16 v[152:153], v10 offset:53248
ds_read_b64_tr_b16 v[154:155], v10 offset:55296
v_mfma_f32_16x16x32_bf16 v[36:39], v[120:123], v[88:91], v[36:39]
v_mfma_f32_16x16x32_bf16 v[20:23], v[244:247], a[204:207], v[20:23]
s_nop 0
ds_read_b64_tr_b16 v[156:157], v11 offset:53248
ds_read_b64_tr_b16 v[158:159], v11 offset:55296
v_mfma_f32_16x16x32_bf16 v[20:23], v[228:231], a[200:203], v[20:23]
v_mfma_f32_16x16x32_bf16 v[20:23], v[212:215], a[196:199], v[20:23]
v_mfma_f32_16x16x32_bf16 v[20:23], v[196:199], a[192:195], v[20:23]
s_nop 0
ds_read_b64_tr_b16 v[160:161], v8 offset:57344
ds_read_b64_tr_b16 v[162:163], v8 offset:59392
v_mfma_f32_16x16x32_bf16 v[20:23], v[120:123], v[80:83], v[20:23]
v_mfma_f32_16x16x32_bf16 v[24:27], v[200:203], a[192:195], v[24:27]
s_nop 0
ds_read_b64_tr_b16 v[164:165], v9 offset:57344
ds_read_b64_tr_b16 v[166:167], v9 offset:59392
v_mfma_f32_16x16x32_bf16 v[24:27], v[216:219], a[196:199], v[24:27]
v_mfma_f32_16x16x32_bf16 v[24:27], v[232:235], a[200:203], v[24:27]
s_nop 0
ds_read_b64_tr_b16 v[168:169], v10 offset:57344
ds_read_b64_tr_b16 v[170:171], v10 offset:59392
v_mfma_f32_16x16x32_bf16 v[24:27], v[248:251], a[204:207], v[24:27]
v_mfma_f32_16x16x32_bf16 v[24:27], v[124:127], v[84:87], v[24:27]
s_nop 0
ds_read_b64_tr_b16 v[172:173], v11 offset:57344
ds_read_b64_tr_b16 v[174:175], v11 offset:59392
v_mfma_f32_16x16x32_bf16 v[40:43], v[248:251], a[220:223], v[40:43]
v_mfma_f32_16x16x32_bf16 v[40:43], v[232:235], a[216:219], v[40:43]
s_nop 0
ds_read_b64_tr_b16 v[176:177], v8 offset:61440
ds_read_b64_tr_b16 v[178:179], v8 offset:63488
v_mfma_f32_16x16x32_bf16 v[40:43], v[216:219], a[212:215], v[40:43]
v_mfma_f32_16x16x32_bf16 v[40:43], v[200:203], a[208:211], v[40:43]
s_nop 0
ds_read_b64_tr_b16 v[180:181], v9 offset:61440
ds_read_b64_tr_b16 v[182:183], v9 offset:63488
v_mfma_f32_16x16x32_bf16 v[40:43], v[124:127], v[92:95], v[40:43]
v_mfma_f32_16x16x32_bf16 v[44:47], v[204:207], a[208:211], v[44:47]
s_nop 0
ds_read_b64_tr_b16 v[184:185], v10 offset:61440
ds_read_b64_tr_b16 v[186:187], v10 offset:63488
v_mfma_f32_16x16x32_bf16 v[44:47], v[220:223], a[212:215], v[44:47]
v_mfma_f32_16x16x32_bf16 v[44:47], v[236:239], a[216:219], v[44:47]
s_nop 0
ds_read_b64_tr_b16 v[188:189], v11 offset:61440
ds_read_b64_tr_b16 v[190:191], v11 offset:63488
v_mfma_f32_16x16x32_bf16 v[44:47], v[252:255], a[220:223], v[44:47]
v_mfma_f32_16x16x32_bf16 v[44:47], v[120:123], v[92:95], v[44:47]
v_mfma_f32_16x16x32_bf16 v[28:31], v[252:255], a[204:207], v[28:31]
s_waitcnt vmcnt(0)
v_max3_u32 v12, v96, v97, v98
v_max3_u32 v13, v99, v100, v101
v_mfma_f32_16x16x32_bf16 v[28:31], v[236:239], a[200:203], v[28:31]
v_max3_u32 v12, v12, v102, v103
v_max3_u32 v13, v13, v104, v105
v_mfma_f32_16x16x32_bf16 v[28:31], v[220:223], a[196:199], v[28:31]
v_max3_u32 v12, v12, v106, v107
v_max3_u32 v13, v13, v108, v109
v_mfma_f32_16x16x32_bf16 v[28:31], v[204:207], a[192:195], v[28:31]
s_waitcnt lgkmcnt(0)
v_max3_u32 v12, v12, v110, v111
v_mfma_f32_16x16x32_bf16 v[28:31], v[120:123], v[84:87], v[28:31]
v_max_u32 v12, v12, v13
v_mfma_f32_16x16x32_bf16 v[16:19], v[128:131], a[224:227], v[16:19]
v_cmp_le_u32 vcc, 0xff800000, v12
v_mfma_f32_16x16x32_bf16 v[16:19], v[144:147], a[228:231], v[16:19]
v_mfma_f32_16x16x32_bf16 v[16:19], v[160:163], a[232:235], v[16:19]
s_cbranch_vccnz Lxspin3
Lxback3:
v_mfma_f32_16x16x32_bf16 v[16:19], v[176:179], a[236:239], v[16:19]
v_mfma_f32_16x16x32_bf16 v[16:19], v[124:127], v[96:99], v[16:19]
v_mfma_f32_16x16x32_bf16 v[20:23], v[180:183], a[236:239], v[20:23]
v_mfma_f32_16x16x32_bf16 v[20:23], v[164:167], a[232:235], v[20:23]
v_mfma_f32_16x16x32_bf16 v[20:23], v[148:151], a[228:231], v[20:23]
v_mfma_f32_16x16x32_bf16 v[20:23], v[132:135], a[224:227], v[20:23]
s_nop 3
v_fma_f32 v16, v16, v6, v48
v_fma_f32 v17, v17, v6, v64
v_mfma_f32_16x16x32_bf16 v[20:23], v[120:123], v[96:99], v[20:23]
v_fma_f32 v18, v18, v6, v49
v_fma_f32 v19, v19, v6, v65
v_mfma_f32_16x16x32_bf16 v[24:27], v[136:139], a[224:227], v[24:27]
v_cvt_pk_bf16_f32 v16, v16, v17
v_cvt_pk_bf16_f32 v17, v18, v19
v_mfma_f32_16x16x32_bf16 v[24:27], v[152:155], a[228:231], v[24:27]
ds_write_b64 v116, v[16:17] offset:0
v_mfma_f32_16x16x32_bf16 v[24:27], v[168:171], a[232:235], v[24:27]
v_mfma_f32_16x16x32_bf16 v[24:27], v[184:187], a[236:239], v[24:27]
v_fma_f32 v20, v20, v6, v50
v_fma_f32 v21, v21, v6, v66
v_mfma_f32_16x16x32_bf16 v[24:27], v[124:127], v[100:103], v[24:27]
v_fma_f32 v22, v22, v6, v51
v_fma_f32 v23, v23, v6, v67
v_mfma_f32_16x16x32_bf16 v[28:31], v[188:191], a[236:239], v[28:31]
v_cvt_pk_bf16_f32 v20, v20, v21
v_cvt_pk_bf16_f32 v21, v22, v23
v_mfma_f32_16x16x32_bf16 v[28:31], v[172:175], a[232:235], v[28:31]
ds_write_b64 v117, v[20:21] offset:0
v_mfma_f32_16x16x32_bf16 v[28:31], v[156:159], a[228:231], v[28:31]
v_mfma_f32_16x16x32_bf16 v[28:31], v[140:143], a[224:227], v[28:31]
v_fma_f32 v24, v24, v6, v52
v_fma_f32 v25, v25, v6, v68
v_mfma_f32_16x16x32_bf16 v[28:31], v[120:123], v[100:103], v[28:31]
v_fma_f32 v26, v26, v6, v53
v_fma_f32 v27, v27, v6, v69
v_mfma_f32_16x16x32_bf16 v[32:35], v[128:131], a[240:243], v[32:35]
v_cvt_pk_bf16_f32 v24, v24, v25
v_cvt_pk_bf16_f32 v25, v26, v27
v_mfma_f32_16x16x32_bf16 v[32:35], v[144:147], a[244:247], v[32:35]
ds_write_b64 v118, v[24:25] offset:0
v_mfma_f32_16x16x32_bf16 v[32:35], v[160:163], a[248:251], v[32:35]
v_mfma_f32_16x16x32_bf16 v[32:35], v[176:179], a[252:255], v[32:35]
v_fma_f32 v28, v28, v6, v54
v_fma_f32 v29, v29, v6, v70
v_mfma_f32_16x16x32_bf16 v[32:35], v[124:127], v[104:107], v[32:35]
v_fma_f32 v30, v30, v6, v55
v_fma_f32 v31, v31, v6, v71
v_mfma_f32_16x16x32_bf16 v[36:39], v[180:183], a[252:255], v[36:39]
v_cvt_pk_bf16_f32 v28, v28, v29
v_cvt_pk_bf16_f32 v29, v30, v31
v_mfma_f32_16x16x32_bf16 v[36:39], v[164:167], a[248:251], v[36:39]
s_nop 0
ds_write_b64 v119, v[28:29] offset:0
ds_read_b128 v[192:195], v4 offset:0
v_mfma_f32_16x16x32_bf16 v[36:39], v[148:151], a[244:247], v[36:39]
ds_read_b128 v[196:199], v4 offset:1024
v_mfma_f32_16x16x32_bf16 v[36:39], v[132:135], a[240:243], v[36:39]
v_fma_f32 v32, v32, v7, v56
v_fma_f32 v33, v33, v7, v72
v_mfma_f32_16x16x32_bf16 v[36:39], v[120:123], v[104:107], v[36:39]
v_fma_f32 v34, v34, v7, v57
v_fma_f32 v35, v35, v7, v73
v_mfma_f32_16x16x32_bf16 v[40:43], v[136:139], a[240:243], v[40:43]
v_cvt_pk_bf16_f32 v32, v32, v33
v_cvt_pk_bf16_f32 v33, v34, v35
v_mfma_f32_16x16x32_bf16 v[40:43], v[152:155], a[244:247], v[40:43]
ds_write_b64 v116, v[32:33] offset:2048
v_mfma_f32_16x16x32_bf16 v[40:43], v[168:171], a[248:251], v[40:43]
s_waitcnt lgkmcnt(2)
buffer_store_dwordx4 v[192:195], v15, s[40:43], s70 offen sc1
v_mfma_f32_16x16x32_bf16 v[40:43], v[184:187], a[252:255], v[40:43]
s_add_u32 s70, s70, 0x4000
v_mfma_f32_16x16x32_bf16 v[40:43], v[124:127], v[108:111], v[40:43]
v_fma_f32 v36, v36, v7, v58
v_fma_f32 v37, v37, v7, v74
v_mfma_f32_16x16x32_bf16 v[44:47], v[188:191], a[252:255], v[44:47]
v_fma_f32 v38, v38, v7, v59
v_fma_f32 v39, v39, v7, v75
v_mfma_f32_16x16x32_bf16 v[44:47], v[172:175], a[248:251], v[44:47]
v_cvt_pk_bf16_f32 v36, v36, v37
v_cvt_pk_bf16_f32 v37, v38, v39
v_mfma_f32_16x16x32_bf16 v[44:47], v[156:159], a[244:247], v[44:47]
ds_write_b64 v117, v[36:37] offset:2048
v_mfma_f32_16x16x32_bf16 v[44:47], v[140:143], a[240:243], v[44:47]
v_fma_f32 v40, v40, v7, v60
v_fma_f32 v41, v41, v7, v76
v_mfma_f32_16x16x32_bf16 v[44:47], v[120:123], v[108:111], v[44:47]
v_fma_f32 v42, v42, v7, v61
v_fma_f32 v43, v43, v7, v77
v_cvt_pk_bf16_f32 v40, v40, v41
v_cvt_pk_bf16_f32 v41, v42, v43
ds_write_b64 v118, v[40:41] offset:2048
s_waitcnt lgkmcnt(3)
buffer_store_dwordx4 v[196:199], v15, s[40:43], s70 offen sc1
s_add_u32 s70, s70, 0x4000
v_fma_f32 v44, v44, v7, v62
v_fma_f32 v45, v45, v7, v78
v_fma_f32 v46, v46, v7, v63
v_fma_f32 v47, v47, v7, v79
v_cvt_pk_bf16_f32 v44, v44, v45
v_cvt_pk_bf16_f32 v45, v46, v47
ds_write_b64 v119, v[44:45] offset:2048
ds_read_b128 v[200:203], v4 offset:2048
ds_read_b128 v[204:207], v4 offset:3072
s_waitcnt lgkmcnt(1)
buffer_store_dwordx4 v[200:203], v15, s[40:43], s70 offen sc1
s_add_u32 s70, s70, 0x4000
s_waitcnt lgkmcnt(0)
buffer_store_dwordx4 v[204:207], v15, s[40:43], s70 offen sc1
s_add_u32 s70, s70, 0x4000
Lend:
s_endpgm
Lspin1:
s_mov_b32 s83, 262144
Lsl3:
s_sleep 2
buffer_load_dword v3, v2, s[48:51], 0 offen sc1
s_sub_u32 s83, s83, 1
s_cmp_eq_u32 s83, 0
s_waitcnt vmcnt(0)
s_cbranch_scc1 Lback2
v_cmp_gt_u32 vcc, 8, v3
s_cbranch_vccnz Lsl3
s_branch Lback2
Lspin4:
s_mov_b32 s83, 262144
Lsl6:
s_sleep 2
buffer_load_dword v3, v2, s[44:47], s75 offen sc1
s_sub_u32 s83, s83, 1
s_cmp_eq_u32 s83, 0
s_waitcnt vmcnt(0)
s_cbranch_scc1 Lback5
v_cmp_gt_u32 vcc, 1, v3
s_cbranch_vccnz Lsl6
s_branch Lback5
.p2align 12
s_endpgm
.p2align 7
LP0x:
Lstub10:
s_cbranch_execz Lret
s_cmp_eq_u32 s58, 2
s_cbranch_scc1 Lta10
s_cmp_eq_u32 s58, 3
s_cbranch_scc1 Lnt11
v_mfma_f32_16x16x32_bf16 v[160:163], a[160:163], v[16:19], v[112:115]
s_xor_b32 s74, s82, 0x10000
v_exp_f32 v128, v128
v_mfma_f32_16x16x32_bf16 v[176:179], a[176:179], v[16:19], v[112:115]
s_add_u32 s74, s74, s64
ds_read_b128 a[128:131], v2 offset:16384
ds_read_b128 a[132:135], v2 offset:17408
s_branch Ljoin12
Lta10:
v_mfma_f32_16x16x32_bf16 v[160:163], a[160:163], v[16:19], v[96:99]
s_xor_b32 s74, s82, 0x10000
v_exp_f32 v128, v128
v_mfma_f32_16x16x32_bf16 v[176:179], a[176:179], v[16:19], v[112:115]
s_add_u32 s74, s74, s64
ds_read_b128 a[128:131], v2 offset:16384
ds_read_b128 a[132:135], v2 offset:17408
s_branch Ljoin12
Lnt11:
v_mfma_f32_16x16x32_bf16 v[160:163], a[160:163], v[16:19], v[80:83]
s_xor_b32 s74, s82, 0x10000
v_exp_f32 v128, v128
v_mfma_f32_16x16x32_bf16 v[176:179], a[176:179], v[16:19], v[96:99]
s_add_u32 s74, s74, s64
ds_read_b128 a[128:131], v2 offset:16384
ds_read_b128 a[132:135], v2 offset:17408
Ljoin12:
v_mfma_f32_16x16x32_bf16 v[164:167], a[160:163], v[32:35], v[84:87]
s_add_u32 s81, s81, 0x8000
v_exp_f32 v129, v129
v_mfma_f32_16x16x32_bf16 v[164:167], a[164:167], v[36:39], v[164:167]
s_add_u32 m0, s74, 16384
v_exp_f32 v130, v130
v_mfma_f32_16x16x32_bf16 v[164:167], a[168:171], v[40:43], v[164:167]
s_add_u32 s72, s81, 16384
v_exp_f32 v131, v131
v_mfma_f32_16x16x32_bf16 v[164:167], a[172:175], v[44:47], v[164:167]
v_exp_f32 v144, v144
v_mfma_f32_16x16x32_bf16 v[172:175], a[172:175], v[76:79], v[92:95]
s_nop 0
ds_read_b128 a[136:139], v2 offset:18432
ds_read_b128 a[140:143], v2 offset:19456
v_mfma_f32_16x16x32_bf16 v[172:175], a[168:171], v[72:75], v[172:175]
s_nop 0
ds_read_b128 a[144:147], v2 offset:20480
ds_read_b128 a[148:151], v2 offset:21504
v_mfma_f32_16x16x32_bf16 v[172:175], a[164:167], v[68:71], v[172:175]
s_nop 0
ds_read_b128 a[152:155], v2 offset:22528
ds_read_b128 a[156:159], v2 offset:23552
v_mfma_f32_16x16x32_bf16 v[172:175], a[160:163], v[64:67], v[172:175]
s_nop 0
ds_read_b128 a[192:195], v2 offset:0
ds_read_b128 a[196:199], v2 offset:1024
v_mfma_f32_16x16x32_bf16 v[188:191], a[176:179], v[64:67], v[92:95]
s_nop 0
ds_read_b128 a[200:203], v2 offset:2048
ds_read_b128 a[204:207], v2 offset:3072
v_mfma_f32_16x16x32_bf16 v[188:191], a[180:183], v[68:71], v[188:191]
s_nop 0
ds_read_b128 a[208:211], v2 offset:4096
ds_read_b128 a[212:215], v2 offset:5120
v_mfma_f32_16x16x32_bf16 v[188:191], a[184:187], v[72:75], v[188:191]
s_nop 0
ds_read_b128 a[216:219], v2 offset:6144
ds_read_b128 a[220:223], v2 offset:7168
v_mfma_f32_16x16x32_bf16 v[188:191], a[188:191], v[76:79], v[188:191]
v_cvt_pk_bf16_f32 v192, v128, v129
v_cvt_pk_bf16_f32 v193, v130, v131
v_mfma_f32_16x16x32_bf16 v[180:183], a[188:191], v[44:47], v[84:87]
buffer_load_dwordx4 v1, s[44:47], s72 offen sc1 lds
v_mfma_f32_16x16x32_bf16 v[180:183], a[184:187], v[40:43], v[180:183]
v_exp_f32 v145, v145
v_mfma_f32_16x16x32_bf16 v[180:183], a[180:183], v[36:39], v[180:183]
v_exp_f32 v146, v146
v_mfma_f32_16x16x32_bf16 v[180:183], a[176:179], v[32:35], v[180:183]
v_exp_f32 v147, v147
v_mfma_f32_16x16x32_bf16 v[160:163], a[164:167], v[20:23], v[160:163]
v_exp_f32 v136, v136
v_mfma_f32_16x16x32_bf16 v[160:163], a[168:171], v[24:27], v[160:163]
v_cvt_pk_bf16_f32 v194, v144, v145
v_cvt_pk_bf16_f32 v195, v146, v147
v_mfma_f32_16x16x32_bf16 v[160:163], a[172:175], v[28:31], v[160:163]
v_exp_f32 v137, v137
v_mfma_f32_16x16x32_bf16 v[168:171], a[172:175], v[60:63], v[88:91]
v_exp_f32 v138, v138
v_mfma_f32_16x16x32_bf16 v[168:171], a[168:171], v[56:59], v[168:171]
v_exp_f32 v139, v139
v_mfma_f32_16x16x32_bf16 v[168:171], a[164:167], v[52:55], v[168:171]
v_exp_f32 v152, v152
v_mfma_f32_16x16x32_bf16 v[168:171], a[160:163], v[48:51], v[168:171]
v_cvt_pk_bf16_f32 v200, v136, v137
v_cvt_pk_bf16_f32 v201, v138, v139
v_mfma_f32_16x16x32_bf16 v[184:187], a[176:179], v[48:51], v[88:91]
buffer_load_dwordx4 v1, s[44:47], s72 offen offset:1024 sc1 lds
v_mfma_f32_16x16x32_bf16 v[184:187], a[180:183], v[52:55], v[184:187]
v_exp_f32 v153, v153
v_mfma_f32_16x16x32_bf16 v[184:187], a[184:187], v[56:59], v[184:187]
v_exp_f32 v154, v154
v_mfma_f32_16x16x32_bf16 v[184:187], a[188:191], v[60:63], v[184:187]
v_exp_f32 v155, v155
v_mfma_f32_16x16x32_bf16 v[176:179], a[188:191], v[28:31], v[176:179]
buffer_load_dwordx4 v1, s[44:47], s72 offen offset:2048 sc1 lds
v_mfma_f32_16x16x32_bf16 v[176:179], a[184:187], v[24:27], v[176:179]
buffer_load_dwordx4 v1, s[44:47], s72 offen offset:3072 sc1 lds
v_mfma_f32_16x16x32_bf16 v[176:179], a[180:183], v[20:23], v[176:179]
s_waitcnt lgkmcnt(4)
v_exp_f32 v132, v132
v_cvt_pk_bf16_f32 v202, v152, v153
v_cvt_pk_bf16_f32 v203, v154, v155
v_exp_f32 v133, v133
v_exp_f32 v134, v134
v_cvt_pk_bf16_f32 v196, v132, v133
v_exp_f32 v135, v135
v_exp_f32 v148, v148
v_cvt_pk_bf16_f32 v197, v134, v135
v_exp_f32 v149, v149
v_exp_f32 v150, v150
v_cvt_pk_bf16_f32 v198, v148, v149
v_exp_f32 v151, v151
v_exp_f32 v140, v140
v_cvt_pk_bf16_f32 v199, v150, v151
v_exp_f32 v141, v141
v_exp_f32 v142, v142
v_cvt_pk_bf16_f32 v204, v140, v141
v_exp_f32 v143, v143
v_exp_f32 v156, v156
v_cvt_pk_bf16_f32 v205, v142, v143
v_exp_f32 v157, v157
v_exp_f32 v158, v158
v_cvt_pk_bf16_f32 v206, v156, v157
v_exp_f32 v159, v159
s_nop 0
v_cvt_pk_bf16_f32 v207, v158, v159
v_mfma_f32_16x16x32_bf16 v[224:227], v[120:123], v[192:195], 0
s_add_u32 s82, s82, 0x8000
ds_read_b128 a[160:163], v2 offset:24576
ds_read_b128 a[164:167], v2 offset:25600
v_mfma_f32_16x16x32_bf16 v[232:235], v[120:123], v[200:203], 0
s_and_b32 s82, s82, 0x1ffff
v_exp_f32 v164, v164
v_mfma_f32_16x16x32_bf16 a[0:3], a[192:195], v[192:195], 0
s_add_u32 m0, s74, 0
v_exp_f32 v165, v165
v_mfma_f32_16x16x32_bf16 a[64:67], a[192:195], v[200:203], 0
s_add_u32 s72, s81, 0
v_exp_f32 v166, v166
v_mfma_f32_16x16x32_bf16 a[68:71], a[196:199], v[200:203], 0
buffer_load_dwordx4 v1, s[44:47], s72 offen sc1 lds
v_mfma_f32_16x16x32_bf16 a[4:7], a[196:199], v[192:195], 0
v_exp_f32 v167, v167
v_mfma_f32_16x16x32_bf16 a[8:11], a[200:203], v[192:195], 0
s_nop 0
ds_read_b128 a[168:171], v2 offset:26624
ds_read_b128 a[172:175], v2 offset:27648
v_mfma_f32_16x16x32_bf16 a[72:75], a[200:203], v[200:203], 0
v_exp_f32 v180, v180
v_mfma_f32_16x16x32_bf16 a[76:79], a[204:207], v[200:203], 0
s_nop 0
ds_read_b128 a[176:179], v2 offset:28672
ds_read_b128 a[180:183], v2 offset:29696
v_mfma_f32_16x16x32_bf16 a[12:15], a[204:207], v[192:195], 0
s_waitcnt lgkmcnt(6)
ds_read_b128 a[184:187], v2 offset:30720
ds_read_b128 a[188:191], v2 offset:31744
v_mfma_f32_16x16x32_bf16 a[16:19], a[208:211], v[192:195], 0
s_nop 0
ds_read_b128 a[224:227], v2 offset:8192
ds_read_b128 a[228:231], v2 offset:9216
v_mfma_f32_16x16x32_bf16 a[80:83], a[208:211], v[200:203], 0
s_nop 0
ds_read_b128 a[232:235], v2 offset:10240
ds_read_b128 a[236:239], v2 offset:11264
v_mfma_f32_16x16x32_bf16 a[84:87], a[212:215], v[200:203], 0
s_nop 0
ds_read_b128 a[240:243], v2 offset:12288
ds_read_b128 a[244:247], v2 offset:13312
v_mfma_f32_16x16x32_bf16 a[20:23], a[212:215], v[192:195], 0
s_nop 0
ds_read_b128 a[248:251], v2 offset:14336
ds_read_b128 a[252:255], v2 offset:15360
v_mfma_f32_16x16x32_bf16 a[24:27], a[216:219], v[192:195], 0
v_cvt_pk_bf16_f32 v212, v164, v165
v_cvt_pk_bf16_f32 v213, v166, v167
v_mfma_f32_16x16x32_bf16 a[88:91], a[216:219], v[200:203], 0
v_exp_f32 v181, v181
v_mfma_f32_16x16x32_bf16 a[92:95], a[220:223], v[200:203], 0
v_exp_f32 v182, v182
v_mfma_f32_16x16x32_bf16 a[28:31], a[220:223], v[192:195], 0
buffer_load_dwordx4 v1, s[44:47], s72 offen offset:1024 sc1 lds
s_cmp_eq_u32 s58, 0
s_cbranch_scc1 Lta13
s_cmp_eq_u32 s58, 1
s_cbranch_scc1 Lnt14
v_mfma_f32_16x16x32_bf16 v[132:135], a[128:131], v[32:35], v[84:87]
v_exp_f32 v183, v183
v_mfma_f32_16x16x32_bf16 v[148:151], a[144:147], v[32:35], v[84:87]
v_exp_f32 v172, v172
s_branch Ljoin15
Lta13:
v_mfma_f32_16x16x32_bf16 v[132:135], a[128:131], v[32:35], v[100:103]
v_exp_f32 v183, v183
v_mfma_f32_16x16x32_bf16 v[148:151], a[144:147], v[32:35], v[112:115]
v_exp_f32 v172, v172
s_branch Ljoin15
Lnt14:
v_mfma_f32_16x16x32_bf16 v[132:135], a[128:131], v[32:35], v[84:87]
v_exp_f32 v183, v183
v_mfma_f32_16x16x32_bf16 v[148:151], a[144:147], v[32:35], v[100:103]
v_exp_f32 v172, v172
Ljoin15:
v_mfma_f32_16x16x32_bf16 v[136:139], a[128:131], v[48:51], v[88:91]
v_cvt_pk_bf16_f32 v214, v180, v181
v_cvt_pk_bf16_f32 v215, v182, v183
v_mfma_f32_16x16x32_bf16 v[136:139], a[132:135], v[52:55], v[136:139]
v_exp_f32 v173, v173
v_mfma_f32_16x16x32_bf16 v[136:139], a[136:139], v[56:59], v[136:139]
buffer_load_dwordx4 v1, s[44:47], s72 offen offset:2048 sc1 lds
v_mfma_f32_16x16x32_bf16 v[136:139], a[140:143], v[60:63], v[136:139]
v_exp_f32 v174, v174
v_mfma_f32_16x16x32_bf16 v[152:155], a[156:159], v[60:63], v[88:91]
v_exp_f32 v175, v175
v_mfma_f32_16x16x32_bf16 v[152:155], a[152:155], v[56:59], v[152:155]
v_exp_f32 v188, v188
v_mfma_f32_16x16x32_bf16 v[152:155], a[148:151], v[52:55], v[152:155]
v_cvt_pk_bf16_f32 v220, v172, v173
v_cvt_pk_bf16_f32 v221, v174, v175
v_mfma_f32_16x16x32_bf16 v[152:155], a[144:147], v[48:51], v[152:155]
v_exp_f32 v189, v189
v_mfma_f32_16x16x32_bf16 v[132:135], a[132:135], v[36:39], v[132:135]
buffer_load_dwordx4 v1, s[44:47], s72 offen offset:3072 sc1 lds
v_mfma_f32_16x16x32_bf16 v[132:135], a[136:139], v[40:43], v[132:135]
s_add_u32 s66, s58, 1
v_exp_f32 v190, v190
v_mfma_f32_16x16x32_bf16 v[132:135], a[140:143], v[44:47], v[132:135]
s_and_b32 s66, s66, 3
v_exp_f32 v191, v191
v_mfma_f32_16x16x32_bf16 v[140:143], a[140:143], v[76:79], v[92:95]
s_mul_i32 s66, s66, 4160
v_exp_f32 v160, v160
v_mfma_f32_16x16x32_bf16 v[140:143], a[136:139], v[72:75], v[140:143]
s_add_u32 m0, s66, 131104
v_cvt_pk_bf16_f32 v222, v188, v189
v_cvt_pk_bf16_f32 v223, v190, v191
v_mfma_f32_16x16x32_bf16 v[140:143], a[132:135], v[68:71], v[140:143]
s_add_u32 s72, s93, 0x2
v_exp_f32 v161, v161
v_mfma_f32_16x16x32_bf16 v[140:143], a[128:131], v[64:67], v[140:143]
buffer_load_dwordx4 v1, s[36:39], s72 offen lds
v_mfma_f32_16x16x32_bf16 v[156:159], a[144:147], v[64:67], v[92:95]
v_exp_f32 v162, v162
v_mfma_f32_16x16x32_bf16 v[156:159], a[148:151], v[68:71], v[156:159]
v_exp_f32 v163, v163
v_mfma_f32_16x16x32_bf16 v[156:159], a[152:155], v[72:75], v[156:159]
buffer_load_dwordx4 v1, s[36:39], s72 offen offset:1024 lds
v_mfma_f32_16x16x32_bf16 v[156:159], a[156:159], v[76:79], v[156:159]
buffer_load_dwordx4 v1, s[36:39], s72 offen offset:2048 lds
v_mfma_f32_16x16x32_bf16 v[148:151], a[156:159], v[44:47], v[148:151]
buffer_load_dwordx4 v1, s[36:39], s72 offen offset:3072 lds
v_mfma_f32_16x16x32_bf16 v[148:151], a[152:155], v[40:43], v[148:151]
s_waitcnt vmcnt(12) lgkmcnt(4)
v_exp_f32 v176, v176
v_mfma_f32_16x16x32_bf16 v[148:151], a[148:151], v[36:39], v[148:151]
s_barrier
v_cvt_pk_bf16_f32 v208, v160, v161
v_cvt_pk_bf16_f32 v209, v162, v163
v_add_u32 v2, s82, v1
v_exp_f32 v177, v177
v_exp_f32 v178, v178
v_cvt_pk_bf16_f32 v210, v176, v177
v_exp_f32 v179, v179
v_exp_f32 v168, v168
v_cvt_pk_bf16_f32 v211, v178, v179
v_exp_f32 v169, v169
v_exp_f32 v170, v170
v_cvt_pk_bf16_f32 v216, v168, v169
v_exp_f32 v171, v171
v_exp_f32 v184, v184
v_cvt_pk_bf16_f32 v217, v170, v171
v_exp_f32 v185, v185
v_exp_f32 v186, v186
v_cvt_pk_bf16_f32 v218, v184, v185
v_exp_f32 v187, v187
s_nop 0
v_cvt_pk_bf16_f32 v219, v186, v187
s_branch LLT3
.p2align 12
s_endpgm
.p2align 7
LLT3x:
Lstub11:
s_cbranch_execz Lret
v_mfma_f32_16x16x32_bf16 v[228:231], v[120:123], v[196:199], v[228:231]
s_xor_b32 s74, s82, 0x10000
ds_read_b128 a[128:131], v2 offset:16384
v_and_b32 v240, 15, v0
v_mfma_f32_16x16x32_bf16 v[228:231], v[120:123], v[212:215], v[228:231]
s_add_u32 s74, s74, s64
v_exp_f32 v136, v136
v_mfma_f32_16x16x32_bf16 v[236:239], v[120:123], v[204:207], v[236:239]
s_add_u32 s81, s81, 0x8000
v_exp_f32 v137, v137
v_mfma_f32_16x16x32_bf16 v[236:239], v[120:123], v[220:223], v[236:239]
s_add_u32 m0, s74, 0
ds_read_b128 a[132:135], v2 offset:17408
v_cvt_pk_bf16_f32 v200, v136, v137
v_mfma_f32_16x16x32_bf16 a[32:35], a[192:195], v[196:199], a[32:35]
s_add_u32 s72, s81, 0
buffer_load_dwordx4 v1, s[44:47], s72 offen sc1 lds
v_mfma_f32_16x16x32_bf16 a[32:35], a[224:227], v[212:215], a[32:35]
s_add_u32 s69, s93, 0x3e00000
v_exp_f32 v138, v138
v_mfma_f32_16x16x32_bf16 a[96:99], a[224:227], v[220:223], a[96:99]
ds_read_b128 a[136:139], v2 offset:18432
v_lshrrev_b32 v241, 4, v0
v_mfma_f32_16x16x32_bf16 a[96:99], a[192:195], v[204:207], a[96:99]
v_exp_f32 v139, v139
v_mfma_f32_16x16x32_bf16 a[100:103], a[196:199], v[204:207], a[100:103]
buffer_store_dwordx4 v[112:115], v1, s[44:47], s69 offen sc1
v_mfma_f32_16x16x32_bf16 a[100:103], a[228:231], v[220:223], a[100:103]
v_exp_f32 v152, v152
v_mfma_f32_16x16x32_bf16 a[36:39], a[228:231], v[212:215], a[36:39]
ds_read_b128 a[140:143], v2 offset:19456
v_cvt_pk_bf16_f32 v201, v138, v139
v_mfma_f32_16x16x32_bf16 a[36:39], a[196:199], v[196:199], a[36:39]
v_exp_f32 v153, v153
v_mfma_f32_16x16x32_bf16 a[40:43], a[200:203], v[196:199], a[40:43]
buffer_load_dwordx4 v1, s[44:47], s72 offen offset:1024 sc1 lds
v_mfma_f32_16x16x32_bf16 a[40:43], a[232:235], v[212:215], a[40:43]
ds_read_b128 a[144:147], v2 offset:20480
v_cvt_pk_bf16_f32 v202, v152, v153
v_mfma_f32_16x16x32_bf16 a[104:107], a[232:235], v[220:223], a[104:107]
v_exp_f32 v154, v154
v_mfma_f32_16x16x32_bf16 a[104:107], a[200:203], v[204:207], a[104:107]
v_exp_f32 v155, v155
v_mfma_f32_16x16x32_bf16 a[108:111], a[204:207], v[204:207], a[108:111]
buffer_store_dwordx4 v[112:115], v1, s[44:47], s69 offen offset:1024 sc1
v_mfma_f32_16x16x32_bf16 a[108:111], a[236:239], v[220:223], a[108:111]
ds_read_b128 a[148:151], v2 offset:21504
v_cvt_pk_bf16_f32 v203, v154, v155
v_mfma_f32_16x16x32_bf16 a[44:47], a[236:239], v[212:215], a[44:47]
v_exp_f32 v132, v132
v_mfma_f32_16x16x32_bf16 a[44:47], a[204:207], v[196:199], a[44:47]
ds_read_b128 a[152:155], v2 offset:22528
v_add_u32 v248, 1, v240
v_mfma_f32_16x16x32_bf16 a[48:51], a[208:211], v[196:199], a[48:51]
s_waitcnt lgkmcnt(7)
v_exp_f32 v133, v133
v_mfma_f32_16x16x32_bf16 a[48:51], a[240:243], v[212:215], a[48:51]
buffer_load_dwordx4 v1, s[44:47], s72 offen offset:2048 sc1 lds
v_mfma_f32_16x16x32_bf16 a[112:115], a[240:243], v[220:223], a[112:115]
v_exp_f32 v134, v134
v_mfma_f32_16x16x32_bf16 a[112:115], a[208:211], v[204:207], a[112:115]
ds_read_b128 a[156:159], v2 offset:23552
v_and_b32 v249, 3, v248
v_mfma_f32_16x16x32_bf16 a[116:119], a[212:215], v[204:207], a[116:119]
v_exp_f32 v135, v135
v_mfma_f32_16x16x32_bf16 a[116:119], a[244:247], v[220:223], a[116:119]
buffer_store_dwordx4 v[112:115], v1, s[44:47], s69 offen offset:2048 sc1
v_mfma_f32_16x16x32_bf16 a[52:55], a[244:247], v[212:215], a[52:55]
ds_read_b128 a[192:195], v2 offset:0
v_lshrrev_b32 v248, 2, v248
v_mfma_f32_16x16x32_bf16 a[52:55], a[212:215], v[196:199], a[52:55]
v_exp_f32 v148, v148
v_mfma_f32_16x16x32_bf16 a[56:59], a[216:219], v[196:199], a[56:59]
buffer_load_dwordx4 v1, s[44:47], s72 offen offset:3072 sc1 lds
v_mfma_f32_16x16x32_bf16 a[56:59], a[248:251], v[212:215], a[56:59]
v_exp_f32 v149, v149
v_mfma_f32_16x16x32_bf16 a[120:123], a[248:251], v[220:223], a[120:123]
ds_read_b128 a[196:199], v2 offset:1024
v_mov_b32 v250, 0x20000
v_mfma_f32_16x16x32_bf16 a[120:123], a[216:219], v[204:207], a[120:123]
v_exp_f32 v150, v150
v_mfma_f32_16x16x32_bf16 a[124:127], a[220:223], v[204:207], a[124:127]
ds_read_b128 a[200:203], v2 offset:2048
v_mov_b32 v252, 0x20001
v_mfma_f32_16x16x32_bf16 a[124:127], a[252:255], v[220:223], a[124:127]
buffer_store_dwordx4 v[112:115], v1, s[44:47], s69 offen offset:3072 sc1
v_mfma_f32_16x16x32_bf16 a[60:63], a[252:255], v[212:215], a[60:63]
s_add_u32 s69, s93, 0x4200000
v_exp_f32 v151, v151
v_mfma_f32_16x16x32_bf16 a[60:63], a[220:223], v[196:199], a[60:63]
ds_read_b128 a[204:207], v2 offset:3072
v_cvt_pk_bf16_f32 v196, v132, v133
s_cmp_eq_u32 s58, 2
s_cbranch_scc1 Lta40
s_cmp_eq_u32 s58, 3
s_cbranch_scc1 Lnt41
v_mfma_f32_16x16x32_bf16 v[164:167], a[160:163], v[32:35], v[112:115]
ds_read_b128 a[208:211], v2 offset:4096
v_cvt_pk_bf16_f32 v197, v134, v135
v_mfma_f32_16x16x32_bf16 v[180:183], a[176:179], v[32:35], v[112:115]
v_exp_f32 v140, v140
s_branch Ljoin42
Lta40:
v_mfma_f32_16x16x32_bf16 v[164:167], a[160:163], v[32:35], v[100:103]
ds_read_b128 a[208:211], v2 offset:4096
v_cvt_pk_bf16_f32 v197, v134, v135
v_mfma_f32_16x16x32_bf16 v[180:183], a[176:179], v[32:35], v[112:115]
v_exp_f32 v140, v140
s_branch Ljoin42
Lnt41:
v_mfma_f32_16x16x32_bf16 v[164:167], a[160:163], v[32:35], v[84:87]
ds_read_b128 a[208:211], v2 offset:4096
v_cvt_pk_bf16_f32 v197, v134, v135
v_mfma_f32_16x16x32_bf16 v[180:183], a[176:179], v[32:35], v[100:103]
v_exp_f32 v140, v140
Ljoin42:
v_mfma_f32_16x16x32_bf16 v[164:167], a[164:167], v[36:39], v[164:167]
ds_read_b128 a[212:215], v2 offset:5120
v_cvt_pk_bf16_f32 v198, v148, v149
v_mfma_f32_16x16x32_bf16 v[164:167], a[168:171], v[40:43], v[164:167]
buffer_store_dwordx4 v[112:115], v1, s[44:47], s69 offen sc1
v_mfma_f32_16x16x32_bf16 v[164:167], a[172:175], v[44:47], v[164:167]
v_exp_f32 v141, v141
v_mfma_f32_16x16x32_bf16 v[172:175], a[172:175], v[76:79], v[92:95]
v_exp_f32 v142, v142
v_mfma_f32_16x16x32_bf16 v[172:175], a[168:171], v[72:75], v[172:175]
ds_read_b128 a[216:219], v2 offset:6144
v_cvt_pk_bf16_f32 v199, v150, v151
v_mfma_f32_16x16x32_bf16 v[172:175], a[164:167], v[68:71], v[172:175]
buffer_store_dwordx4 v[112:115], v1, s[44:47], s69 offen offset:1024 sc1
v_mfma_f32_16x16x32_bf16 v[172:175], a[160:163], v[64:67], v[172:175]
v_exp_f32 v143, v143
v_mfma_f32_16x16x32_bf16 v[188:191], a[176:179], v[64:67], v[92:95]
v_exp_f32 v156, v156
v_mfma_f32_16x16x32_bf16 v[188:191], a[180:183], v[68:71], v[188:191]
ds_read_b128 a[220:223], v2 offset:7168
v_cvt_pk_bf16_f32 v204, v140, v141
v_mfma_f32_16x16x32_bf16 v[188:191], a[184:187], v[72:75], v[188:191]
buffer_store_dwordx4 v[112:115], v1, s[44:47], s69 offen offset:2048 sc1
v_mfma_f32_16x16x32_bf16 v[188:191], a[188:191], v[76:79], v[188:191]
v_exp_f32 v157, v157
v_mfma_f32_16x16x32_bf16 v[180:183], a[188:191], v[44:47], v[180:183]
v_exp_f32 v158, v158
v_mfma_f32_16x16x32_bf16 v[180:183], a[184:187], v[40:43], v[180:183]
v_cvt_pk_bf16_f32 v205, v142, v143
v_cvt_pk_bf16_f32 v206, v156, v157
v_mfma_f32_16x16x32_bf16 v[180:183], a[180:183], v[36:39], v[180:183]
buffer_store_dwordx4 v[112:115], v1, s[44:47], s69 offen offset:3072 sc1
v_mfma_f32_16x16x32_bf16 v[168:171], a[160:163], v[48:51], v[88:91]
v_exp_f32 v159, v159
v_mfma_f32_16x16x32_bf16 v[168:171], a[164:167], v[52:55], v[168:171]
v_cvt_pk_bf16_f32 v207, v158, v159
v_lshlrev_b32 v6, 3, v249
v_mfma_f32_16x16x32_bf16 v[168:171], a[168:171], v[56:59], v[168:171]
v_lshrrev_b32 v6, v6, v252
v_and_b32 v6, 3, v6
v_mfma_f32_16x16x32_bf16 v[168:171], a[172:175], v[60:63], v[168:171]
v_cmp_ne_u32 vcc, 1, v249
v_mul_u32_u24 v6, 16640, v6
v_mfma_f32_16x16x32_bf16 v[184:187], a[188:191], v[60:63], v[88:91]
v_add_u32 v6, s92, v6
v_cndmask_b32 v6, v250, v6, vcc
v_mfma_f32_16x16x32_bf16 v[184:187], a[184:187], v[56:59], v[184:187]
v_add_u32 v253, s58, v249
v_and_b32 v253, 3, v253
v_mfma_f32_16x16x32_bf16 v[184:187], a[180:183], v[52:55], v[184:187]
s_waitcnt lgkmcnt(4)
v_mfma_f32_16x16x32_bf16 v[184:187], a[176:179], v[48:51], v[184:187]
s_barrier
s_lshr_b32 s69, s93, 4
s_and_b32 s69, s69, 0x7f00
s_add_u32 s69, s69, LHT4-Lpc0
v_lshrrev_b32 v3, 5, v0
v_lshlrev_b32 v3, 7, v3
v_add_u32 v3, s69, v3
v_min_u32 v3, Lcode_end-Lpc0, v3
global_load_dword v4, v3, s[98:99]
v_mfma_f32_16x16x32_bf16 v[224:227], v[120:123], v[208:211], v[224:227]
s_add_u32 s82, s82, 0x8000
ds_read_b128 a[160:163], v2 offset:24576
ds_read_b128 a[164:167], v2 offset:25600
v_mfma_f32_16x16x32_bf16 v[232:235], v[120:123], v[216:219], v[232:235]
s_and_b32 s82, s82, 0x1ffff
v_exp_f32 v164, v164
v_mfma_f32_16x16x32_bf16 v[232:235], v[120:123], v[200:203], v[232:235]
s_add_u32 s66, s58, 3
v_exp_f32 v165, v165
v_mfma_f32_16x16x32_bf16 a[0:3], a[224:227], v[208:211], a[0:3]
s_and_b32 s66, s66, 3
v_exp_f32 v166, v166
v_mfma_f32_16x16x32_bf16 a[64:67], a[192:195], v[200:203], a[64:67]
s_mul_i32 s66, s66, 4160
ds_read_b128 a[168:171], v2 offset:26624
v_cvt_pk_bf16_f32 v212, v164, v165
v_mfma_f32_16x16x32_bf16 a[64:67], a[224:227], v[216:219], a[64:67]
s_add_u32 s66, s66, s92
v_exp_f32 v167, v167
v_mfma_f32_16x16x32_bf16 a[68:71], a[228:231], v[216:219], a[68:71]
s_add_u32 m0, s66, 32
v_exp_f32 v180, v180
v_mfma_f32_16x16x32_bf16 a[68:71], a[196:199], v[200:203], a[68:71]
s_add_u32 s72, s93, 0x6
buffer_load_dwordx4 v1, s[36:39], s72 offen lds
v_mfma_f32_16x16x32_bf16 a[4:7], a[228:231], v[208:211], a[4:7]
ds_read_b128 a[172:175], v2 offset:27648
v_cvt_pk_bf16_f32 v213, v166, v167
v_mfma_f32_16x16x32_bf16 a[8:11], a[232:235], v[208:211], a[8:11]
v_exp_f32 v181, v181
v_mfma_f32_16x16x32_bf16 a[72:75], a[200:203], v[200:203], a[72:75]
ds_read_b128 a[176:179], v2 offset:28672
v_cvt_pk_bf16_f32 v214, v180, v181
v_mfma_f32_16x16x32_bf16 a[72:75], a[232:235], v[216:219], a[72:75]
v_exp_f32 v182, v182
v_mfma_f32_16x16x32_bf16 a[76:79], a[236:239], v[216:219], a[76:79]
v_exp_f32 v183, v183
v_mfma_f32_16x16x32_bf16 a[76:79], a[204:207], v[200:203], a[76:79]
ds_read_b128 a[180:183], v2 offset:29696
v_cvt_pk_bf16_f32 v215, v182, v183
v_mfma_f32_16x16x32_bf16 a[12:15], a[236:239], v[208:211], a[12:15]
v_exp_f32 v172, v172
v_mfma_f32_16x16x32_bf16 a[16:19], a[240:243], v[208:211], a[16:19]
s_waitcnt lgkmcnt(6)
ds_read_b128 a[184:187], v2 offset:30720
ds_read_b128 a[188:191], v2 offset:31744
v_mfma_f32_16x16x32_bf16 a[80:83], a[208:211], v[200:203], a[80:83]
v_exp_f32 v173, v173
v_mfma_f32_16x16x32_bf16 a[80:83], a[240:243], v[216:219], a[80:83]
buffer_load_dwordx4 v1, s[36:39], s72 offen offset:1024 lds
v_mfma_f32_16x16x32_bf16 a[84:87], a[244:247], v[216:219], a[84:87]
v_exp_f32 v174, v174
v_mfma_f32_16x16x32_bf16 a[84:87], a[212:215], v[200:203], a[84:87]
v_exp_f32 v175, v175
v_mfma_f32_16x16x32_bf16 a[20:23], a[244:247], v[208:211], a[20:23]
ds_read_b128 a[224:227], v2 offset:8192
v_cvt_pk_bf16_f32 v220, v172, v173
v_mfma_f32_16x16x32_bf16 a[24:27], a[248:251], v[208:211], a[24:27]
v_exp_f32 v188, v188
v_mfma_f32_16x16x32_bf16 a[88:91], a[216:219], v[200:203], a[88:91]
v_exp_f32 v189, v189
v_mfma_f32_16x16x32_bf16 a[88:91], a[248:251], v[216:219], a[88:91]
ds_read_b128 a[228:231], v2 offset:9216
v_cvt_pk_bf16_f32 v221, v174, v175
v_mfma_f32_16x16x32_bf16 a[92:95], a[252:255], v[216:219], a[92:95]
v_exp_f32 v190, v190
v_mfma_f32_16x16x32_bf16 a[92:95], a[220:223], v[200:203], a[92:95]
ds_read_b128 a[232:235], v2 offset:10240
v_cvt_pk_bf16_f32 v222, v188, v189
v_mfma_f32_16x16x32_bf16 a[28:31], a[252:255], v[208:211], a[28:31]
v_exp_f32 v191, v191
s_cmp_eq_u32 s58, 0
s_cbranch_scc1 Lta43
s_cmp_eq_u32 s58, 1
s_cbranch_scc1 Lnt44
v_mfma_f32_16x16x32_bf16 v[136:139], a[128:131], v[48:51], v[88:91]
buffer_load_dwordx4 v1, s[36:39], s72 offen offset:2048 lds
v_mfma_f32_16x16x32_bf16 v[152:155], a[144:147], v[48:51], v[88:91]
v_exp_f32 v168, v168
s_branch Ljoin45
Lta43:
v_mfma_f32_16x16x32_bf16 v[136:139], a[128:131], v[48:51], v[104:107]
buffer_load_dwordx4 v1, s[36:39], s72 offen offset:2048 lds
v_mfma_f32_16x16x32_bf16 v[152:155], a[144:147], v[48:51], v[112:115]
v_exp_f32 v168, v168
s_branch Ljoin45
Lnt44:
v_mfma_f32_16x16x32_bf16 v[136:139], a[128:131], v[48:51], v[88:91]
buffer_load_dwordx4 v1, s[36:39], s72 offen offset:2048 lds
v_mfma_f32_16x16x32_bf16 v[152:155], a[144:147], v[48:51], v[104:107]
v_exp_f32 v168, v168
Ljoin45:
v_mfma_f32_16x16x32_bf16 v[136:139], a[132:135], v[52:55], v[136:139]
ds_read_b128 a[236:239], v2 offset:11264
v_cvt_pk_bf16_f32 v223, v190, v191
v_mfma_f32_16x16x32_bf16 v[136:139], a[136:139], v[56:59], v[136:139]
v_exp_f32 v169, v169
v_mfma_f32_16x16x32_bf16 v[136:139], a[140:143], v[60:63], v[136:139]
ds_read_b128 a[240:243], v2 offset:12288
v_cvt_pk_bf16_f32 v216, v168, v169
v_mfma_f32_16x16x32_bf16 v[152:155], a[156:159], v[60:63], v[152:155]
v_exp_f32 v170, v170
v_mfma_f32_16x16x32_bf16 v[152:155], a[152:155], v[56:59], v[152:155]
v_exp_f32 v171, v171
v_mfma_f32_16x16x32_bf16 v[152:155], a[148:151], v[52:55], v[152:155]
ds_read_b128 a[244:247], v2 offset:13312
v_cvt_pk_bf16_f32 v217, v170, v171
v_mfma_f32_16x16x32_bf16 v[140:143], a[128:131], v[64:67], v[92:95]
v_exp_f32 v184, v184
v_mfma_f32_16x16x32_bf16 v[140:143], a[132:135], v[68:71], v[140:143]
ds_read_b128 a[248:251], v2 offset:14336
v_mfma_f32_16x16x32_bf16 v[140:143], a[136:139], v[72:75], v[140:143]
v_exp_f32 v185, v185
v_mfma_f32_16x16x32_bf16 v[140:143], a[140:143], v[76:79], v[140:143]
buffer_load_dwordx4 v1, s[36:39], s72 offen offset:3072 lds
v_mfma_f32_16x16x32_bf16 v[156:159], a[156:159], v[76:79], v[92:95]
ds_read_b128 a[252:255], v2 offset:15360
v_cvt_pk_bf16_f32 v218, v184, v185
v_mfma_f32_16x16x32_bf16 v[156:159], a[152:155], v[72:75], v[156:159]
v_exp_f32 v186, v186
v_mfma_f32_16x16x32_bf16 v[156:159], a[148:151], v[68:71], v[156:159]
s_waitcnt vmcnt(17) lgkmcnt(0)
v_exp_f32 v187, v187
v_mfma_f32_16x16x32_bf16 v[156:159], a[144:147], v[64:67], v[156:159]
s_barrier
v_cvt_pk_bf16_f32 v219, v186, v187
v_add_u32 v2, s82, v1
v_mfma_f32_16x16x32_bf16 v[228:231], v[120:123], v[196:199], v[228:231]
s_mov_b32 m0, s62
v_exp_f32 v136, v136
v_mfma_f32_16x16x32_bf16 v[228:231], v[120:123], v[212:215], v[228:231]
s_add_u32 s72, s93, 0x3000000
ds_read_b128 a[128:131], v2 offset:16384
v_mul_u32_u24 v253, 4160, v253
v_mfma_f32_16x16x32_bf16 v[236:239], v[120:123], v[204:207], v[236:239]
buffer_load_dwordx4 v1, s[44:47], s72 offen sc1 lds
v_mfma_f32_16x16x32_bf16 v[236:239], v[120:123], v[220:223], v[236:239]
v_exp_f32 v137, v137
v_mfma_f32_16x16x32_bf16 a[32:35], a[192:195], v[196:199], a[32:35]
ds_read_b128 a[132:135], v2 offset:17408
v_cvt_pk_bf16_f32 v200, v136, v137
v_mfma_f32_16x16x32_bf16 a[32:35], a[224:227], v[212:215], a[32:35]
v_exp_f32 v138, v138
v_mfma_f32_16x16x32_bf16 a[96:99], a[224:227], v[220:223], a[96:99]
ds_read_b128 a[136:139], v2 offset:18432
v_add_u32 v6, v6, v253
v_mfma_f32_16x16x32_bf16 a[96:99], a[192:195], v[204:207], a[96:99]
buffer_load_dwordx4 v1, s[44:47], s72 offen offset:1024 sc1 lds
v_mfma_f32_16x16x32_bf16 a[100:103], a[196:199], v[204:207], a[100:103]
v_exp_f32 v139, v139
v_mfma_f32_16x16x32_bf16 a[100:103], a[228:231], v[220:223], a[100:103]
ds_read_b128 a[140:143], v2 offset:19456
v_cvt_pk_bf16_f32 v201, v138, v139
v_mfma_f32_16x16x32_bf16 a[36:39], a[228:231], v[212:215], a[36:39]
v_exp_f32 v152, v152
v_mfma_f32_16x16x32_bf16 a[36:39], a[196:199], v[196:199], a[36:39]
ds_read_b128 a[144:147], v2 offset:20480
v_bfe_u32 v251, v0, 2, 2
v_mfma_f32_16x16x32_bf16 a[40:43], a[200:203], v[196:199], a[40:43]
buffer_load_dwordx4 v1, s[44:47], s72 offen offset:2048 sc1 lds
v_mfma_f32_16x16x32_bf16 a[40:43], a[232:235], v[212:215], a[40:43]
v_exp_f32 v153, v153
v_mfma_f32_16x16x32_bf16 a[104:107], a[232:235], v[220:223], a[104:107]
ds_read_b128 a[148:151], v2 offset:21504
v_cvt_pk_bf16_f32 v202, v152, v153
v_mfma_f32_16x16x32_bf16 a[104:107], a[200:203], v[204:207], a[104:107]
buffer_load_dwordx4 v1, s[44:47], s72 offen offset:3072 sc1 lds
v_mfma_f32_16x16x32_bf16 a[108:111], a[204:207], v[204:207], a[108:111]
s_add_u32 s66, s58, 0
v_exp_f32 v154, v154
v_mfma_f32_16x16x32_bf16 a[108:111], a[236:239], v[220:223], a[108:111]
s_and_b32 s66, s66, 3
ds_read_b128 a[152:155], v2 offset:22528
v_lshl_add_u32 v6, v248, 3, v6
v_mfma_f32_16x16x32_bf16 a[44:47], a[236:239], v[212:215], a[44:47]
s_mul_i32 s66, s66, 4160
v_exp_f32 v155, v155
v_mfma_f32_16x16x32_bf16 a[44:47], a[204:207], v[196:199], a[44:47]
s_add_u32 s66, s66, s92
ds_read_b128 a[156:159], v2 offset:23552
v_cvt_pk_bf16_f32 v203, v154, v155
v_mfma_f32_16x16x32_bf16 a[48:51], a[208:211], v[196:199], a[48:51]
s_waitcnt lgkmcnt(8)
v_exp_f32 v140, v140
v_mfma_f32_16x16x32_bf16 a[48:51], a[240:243], v[212:215], a[48:51]
s_add_u32 m0, s66, 16672
ds_read_b128 a[192:195], v2 offset:0
v_lshl_add_u32 v6, v241, 4, v6
v_mfma_f32_16x16x32_bf16 a[112:115], a[240:243], v[220:223], a[112:115]
s_add_u32 s72, s93, 0x0
buffer_load_dwordx4 v1, s[36:39], s72 offen lds
v_mfma_f32_16x16x32_bf16 a[112:115], a[208:211], v[204:207], a[112:115]
buffer_load_dwordx4 v1, s[36:39], s72 offen offset:1024 lds
v_mfma_f32_16x16x32_bf16 a[116:119], a[212:215], v[204:207], a[116:119]
v_exp_f32 v141, v141
v_mfma_f32_16x16x32_bf16 a[116:119], a[244:247], v[220:223], a[116:119]
ds_read_b128 a[196:199], v2 offset:1024
v_lshlrev_b32 v5, 3, v251
v_mfma_f32_16x16x32_bf16 a[52:55], a[244:247], v[212:215], a[52:55]
v_exp_f32 v142, v142
v_mfma_f32_16x16x32_bf16 a[52:55], a[212:215], v[196:199], a[52:55]
ds_read_b128 a[200:203], v2 offset:2048
v_lshrrev_b32 v5, v5, v252
v_mfma_f32_16x16x32_bf16 a[56:59], a[216:219], v[196:199], a[56:59]
buffer_load_dwordx4 v1, s[36:39], s72 offen offset:2048 lds
v_mfma_f32_16x16x32_bf16 a[56:59], a[248:251], v[212:215], a[56:59]
v_exp_f32 v143, v143
v_mfma_f32_16x16x32_bf16 a[120:123], a[248:251], v[220:223], a[120:123]
ds_read_b128 a[204:207], v2 offset:3072
v_and_b32 v5, 3, v5
v_mfma_f32_16x16x32_bf16 a[120:123], a[216:219], v[204:207], a[120:123]
v_exp_f32 v156, v156
v_mfma_f32_16x16x32_bf16 a[124:127], a[220:223], v[204:207], a[124:127]
ds_read_b128 a[208:211], v2 offset:4096
v_cmp_ne_u32 vcc, 1, v251
v_mfma_f32_16x16x32_bf16 a[124:127], a[252:255], v[220:223], a[124:127]
buffer_load_dwordx4 v1, s[36:39], s72 offen offset:3072 lds
v_mfma_f32_16x16x32_bf16 a[60:63], a[252:255], v[212:215], a[60:63]
s_add_u32 s66, s58, 2
v_exp_f32 v157, v157
v_mfma_f32_16x16x32_bf16 a[60:63], a[220:223], v[196:199], a[60:63]
s_and_b32 s66, s66, 3
ds_read_b128 a[212:215], v2 offset:5120
v_cvt_pk_bf16_f32 v204, v140, v141
s_cmp_eq_u32 s58, 2
s_cbranch_scc1 Lta46
s_cmp_eq_u32 s58, 3
s_cbranch_scc1 Lnt47
v_mfma_f32_16x16x32_bf16 v[168:171], a[160:163], v[48:51], v[112:115]
s_mul_i32 s66, s66, 4160
v_exp_f32 v158, v158
v_mfma_f32_16x16x32_bf16 v[184:187], a[176:179], v[48:51], v[112:115]
s_add_u32 s66, s66, s92
ds_read_b128 a[216:219], v2 offset:6144
v_cvt_pk_bf16_f32 v205, v142, v143
s_branch Ljoin48
Lta46:
v_mfma_f32_16x16x32_bf16 v[168:171], a[160:163], v[48:51], v[104:107]
s_mul_i32 s66, s66, 4160
v_exp_f32 v158, v158
v_mfma_f32_16x16x32_bf16 v[184:187], a[176:179], v[48:51], v[112:115]
s_add_u32 s66, s66, s92
ds_read_b128 a[216:219], v2 offset:6144
v_cvt_pk_bf16_f32 v205, v142, v143
s_branch Ljoin48
Lnt47:
v_mfma_f32_16x16x32_bf16 v[168:171], a[160:163], v[48:51], v[88:91]
s_mul_i32 s66, s66, 4160
v_exp_f32 v158, v158
v_mfma_f32_16x16x32_bf16 v[184:187], a[176:179], v[48:51], v[104:107]
s_add_u32 s66, s66, s92
ds_read_b128 a[216:219], v2 offset:6144
v_cvt_pk_bf16_f32 v205, v142, v143
Ljoin48:
v_mfma_f32_16x16x32_bf16 v[172:175], a[160:163], v[64:67], v[92:95]
s_add_u32 m0, s66, 33312
v_exp_f32 v159, v159
v_mfma_f32_16x16x32_bf16 v[172:175], a[164:167], v[68:71], v[172:175]
s_add_u32 s72, s93, 0x4
buffer_load_dwordx4 v1, s[36:39], s72 offen lds
v_mfma_f32_16x16x32_bf16 v[172:175], a[168:171], v[72:75], v[172:175]
ds_read_b128 a[220:223], v2 offset:7168
v_cvt_pk_bf16_f32 v206, v156, v157
v_mfma_f32_16x16x32_bf16 v[172:175], a[172:175], v[76:79], v[172:175]
buffer_load_dwordx4 v1, s[36:39], s72 offen offset:1024 lds
v_mfma_f32_16x16x32_bf16 v[188:191], a[188:191], v[76:79], v[92:95]
v_cvt_pk_bf16_f32 v207, v158, v159
v_mul_u32_u24 v5, 16640, v5
v_mfma_f32_16x16x32_bf16 v[188:191], a[184:187], v[72:75], v[188:191]
v_add_u32 v5, s92, v5
v_cndmask_b32 v5, v250, v5, vcc
v_mfma_f32_16x16x32_bf16 v[188:191], a[180:183], v[68:71], v[188:191]
v_add_u32 v253, s58, v251
v_and_b32 v253, 3, v253
v_mfma_f32_16x16x32_bf16 v[188:191], a[176:179], v[64:67], v[188:191]
v_mul_u32_u24 v253, 4160, v253
v_add_u32 v5, v5, v253
v_mfma_f32_16x16x32_bf16 v[168:171], a[164:167], v[52:55], v[168:171]
s_add_u32 s73, s62, 480
v_lshlrev_b32 v248, 5, v240
v_sub_u32 v248, s73, v248
v_mfma_f32_16x16x32_bf16 v[168:171], a[168:171], v[56:59], v[168:171]
v_lshl_add_u32 v7, v241, 4, v248
v_mfma_f32_16x16x32_bf16 v[168:171], a[172:175], v[60:63], v[168:171]
s_and_b32 s73, s58, 1
v_mfma_f32_16x16x32_bf16 v[184:187], a[188:191], v[60:63], v[184:187]
s_lshl_b32 s73, s73, 4
v_mfma_f32_16x16x32_bf16 v[184:187], a[184:187], v[56:59], v[184:187]
s_lshr_b32 s73, s90, s73
v_mfma_f32_16x16x32_bf16 v[184:187], a[180:183], v[52:55], v[184:187]
s_waitcnt lgkmcnt(4)
s_and_b32 s73, s73, 0xffff
v_lshl_add_u32 v248, v241, 3, v240
v_sub_u32 v248, 15, v248
v_and_b32 v249, 1, v248
v_lshlrev_b32 v249, 4, v249
v_lshlrev_b32 v249, v249, s73
v_lshrrev_b32 v248, 1, v248
v_and_b32 v241, 3, v0
v_cmp_eq_u32 vcc, 0, v248
v_lshl_add_u32 v5, v241, 3, v5
s_nop 0
v_cndmask_b32 v8, 0, v249, vcc
v_cmp_eq_u32 vcc, 1, v248
v_lshlrev_b32 v240, 4, v251
s_nop 0
v_cndmask_b32 v9, 0, v249, vcc
v_cmp_eq_u32 vcc, 2, v248
v_sub_u32 v240, 48, v240
v_lshlrev_b64 v[12:13], 16, s[88:89]
v_cndmask_b32 v10, 0, v249, vcc
v_cmp_eq_u32 vcc, 3, v248
v_lshlrev_b64 v[12:13], v240, v[12:13]
s_nop 0
v_cndmask_b32 v11, 0, v249, vcc
v_cmp_eq_u32 vcc, 3, v241
s_add_u32 s73, s62, 4096
v_lshl_add_u32 v14, v0, 3, s73
v_cndmask_b32 v12, 0, v12, vcc
v_cndmask_b32 v13, 0, v13, vcc
v_lshrrev_b32 v15, 4, v0
v_lshlrev_b32 v15, 1, v15
v_and_b32 v240, 7, v0
v_xor_b32 v15, v15, v240
v_lshlrev_b32 v15, 4, v15
v_lshrrev_b32 v240, 3, v0
v_lshl_add_u32 v15, v240, 11, v15
s_lshr_b32 s75, s59, 1
s_and_b32 s75, s75, 8
s_add_u32 s75, s75, s60
s_lshl_b32 s76, s65, 2
s_lshr_b32 s80, s59, 2
s_and_b32 s80, s80, 3
s_add_u32 s76, s76, s80
s_lshl_b32 s94, s58, 16
s_lshl_b32 s80, s76, 7
s_add_u32 s94, s94, s80
s_lshl_b32 s80, s75, 18
s_add_u32 s80, s80, s94
v_rcp_f32 v224, v224
v_rcp_f32 v228, v228
s_lshl_b32 s73, s59, 12
s_add_u32 s73, s73, 0x2000000
s_lshl_b32 s70, s67, 2
s_add_u32 s70, s70, s73
v_mov_b32 v225, v224
v_accvgpr_read_b32 v240, a0
v_accvgpr_read_b32 v241, a1
v_accvgpr_read_b32 v242, a2
v_accvgpr_read_b32 v243, a3
v_accvgpr_read_b32 v244, a4
v_accvgpr_read_b32 v245, a5
v_accvgpr_read_b32 v246, a6
v_accvgpr_read_b32 v247, a7
v_pk_mul_f32 v[240:241], v[240:241], v[224:225]
v_pk_mul_f32 v[242:243], v[242:243], v[224:225]
v_pk_mul_f32 v[244:245], v[244:245], v[224:225]
v_pk_mul_f32 v[246:247], v[246:247], v[224:225]
buffer_load_dwordx4 v1, s[36:39], s72 offen offset:2048 lds
v_cvt_pk_bf16_f32 v128, v240, v241
v_cvt_pk_bf16_f32 v129, v242, v243
v_cvt_pk_bf16_f32 v130, v244, v245
v_cvt_pk_bf16_f32 v131, v246, v247
v_accvgpr_read_b32 v248, a8
v_accvgpr_read_b32 v249, a9
v_accvgpr_read_b32 v250, a10
v_accvgpr_read_b32 v251, a11
v_accvgpr_read_b32 v252, a12
v_accvgpr_read_b32 v253, a13
v_accvgpr_read_b32 v254, a14
v_accvgpr_read_b32 v255, a15
v_pk_mul_f32 v[248:249], v[248:249], v[224:225]
v_pk_mul_f32 v[250:251], v[250:251], v[224:225]
v_pk_mul_f32 v[252:253], v[252:253], v[224:225]
v_pk_mul_f32 v[254:255], v[254:255], v[224:225]
v_cvt_pk_bf16_f32 v144, v248, v249
v_cvt_pk_bf16_f32 v145, v250, v251
buffer_load_dwordx4 v1, s[36:39], s72 offen offset:3072 lds
v_cvt_pk_bf16_f32 v146, v252, v253
v_cvt_pk_bf16_f32 v147, v254, v255
v_accvgpr_read_b32 v240, a16
v_accvgpr_read_b32 v241, a17
v_accvgpr_read_b32 v242, a18
v_accvgpr_read_b32 v243, a19
v_accvgpr_read_b32 v244, a20
v_accvgpr_read_b32 v245, a21
v_accvgpr_read_b32 v246, a22
v_accvgpr_read_b32 v247, a23
v_pk_mul_f32 v[240:241], v[240:241], v[224:225]
v_pk_mul_f32 v[242:243], v[242:243], v[224:225]
v_pk_mul_f32 v[244:245], v[244:245], v[224:225]
v_pk_mul_f32 v[246:247], v[246:247], v[224:225]
v_cvt_pk_bf16_f32 v160, v240, v241
v_cvt_pk_bf16_f32 v161, v242, v243
v_cvt_pk_bf16_f32 v162, v244, v245
v_cvt_pk_bf16_f32 v163, v246, v247
buffer_load_dwordx4 v[80:83], v15, s[4:7], s80 offen
v_accvgpr_read_b32 v248, a24
v_accvgpr_read_b32 v249, a25
v_accvgpr_read_b32 v250, a26
v_accvgpr_read_b32 v251, a27
v_accvgpr_read_b32 v252, a28
v_accvgpr_read_b32 v253, a29
v_accvgpr_read_b32 v254, a30
v_accvgpr_read_b32 v255, a31
v_pk_mul_f32 v[248:249], v[248:249], v[224:225]
v_pk_mul_f32 v[250:251], v[250:251], v[224:225]
v_pk_mul_f32 v[252:253], v[252:253], v[224:225]
v_pk_mul_f32 v[254:255], v[254:255], v[224:225]
v_cvt_pk_bf16_f32 v176, v248, v249
v_cvt_pk_bf16_f32 v177, v250, v251
v_cvt_pk_bf16_f32 v178, v252, v253
v_cvt_pk_bf16_f32 v179, v254, v255
v_mov_b32 v229, v228
v_accvgpr_read_b32 v240, a32
s_add_u32 s80, s80, 0x4000
buffer_load_dwordx4 v[84:87], v15, s[4:7], s80 offen
v_accvgpr_read_b32 v241, a33
v_accvgpr_read_b32 v242, a34
v_accvgpr_read_b32 v243, a35
v_accvgpr_read_b32 v244, a36
v_accvgpr_read_b32 v245, a37
v_accvgpr_read_b32 v246, a38
v_accvgpr_read_b32 v247, a39
v_pk_mul_f32 v[240:241], v[240:241], v[228:229]
v_pk_mul_f32 v[242:243], v[242:243], v[228:229]
v_pk_mul_f32 v[244:245], v[244:245], v[228:229]
v_pk_mul_f32 v[246:247], v[246:247], v[228:229]
v_cvt_pk_bf16_f32 v132, v240, v241
v_cvt_pk_bf16_f32 v133, v242, v243
v_cvt_pk_bf16_f32 v134, v244, v245
v_cvt_pk_bf16_f32 v135, v246, v247
v_accvgpr_read_b32 v248, a40
v_accvgpr_read_b32 v249, a41
v_accvgpr_read_b32 v250, a42
s_add_u32 s80, s80, 0x4000
buffer_load_dwordx4 v[96:99], v15, s[4:7], s80 offen
v_accvgpr_read_b32 v251, a43
v_accvgpr_read_b32 v252, a44
v_accvgpr_read_b32 v253, a45
v_accvgpr_read_b32 v254, a46
v_accvgpr_read_b32 v255, a47
v_pk_mul_f32 v[248:249], v[248:249], v[228:229]
v_pk_mul_f32 v[250:251], v[250:251], v[228:229]
v_pk_mul_f32 v[252:253], v[252:253], v[228:229]
v_pk_mul_f32 v[254:255], v[254:255], v[228:229]
v_cvt_pk_bf16_f32 v148, v248, v249
v_cvt_pk_bf16_f32 v149, v250, v251
v_cvt_pk_bf16_f32 v150, v252, v253
v_cvt_pk_bf16_f32 v151, v254, v255
v_accvgpr_read_b32 v240, a48
v_accvgpr_read_b32 v241, a49
v_accvgpr_read_b32 v242, a50
v_accvgpr_read_b32 v243, a51
v_accvgpr_read_b32 v244, a52
s_add_u32 s80, s80, 0x4000
buffer_load_dwordx4 v[100:103], v15, s[4:7], s80 offen
v_accvgpr_read_b32 v245, a53
v_accvgpr_read_b32 v246, a54
v_accvgpr_read_b32 v247, a55
v_pk_mul_f32 v[240:241], v[240:241], v[228:229]
v_pk_mul_f32 v[242:243], v[242:243], v[228:229]
v_pk_mul_f32 v[244:245], v[244:245], v[228:229]
v_pk_mul_f32 v[246:247], v[246:247], v[228:229]
v_cvt_pk_bf16_f32 v164, v240, v241
v_cvt_pk_bf16_f32 v165, v242, v243
v_cvt_pk_bf16_f32 v166, v244, v245
v_cvt_pk_bf16_f32 v167, v246, v247
v_accvgpr_read_b32 v248, a56
v_accvgpr_read_b32 v249, a57
v_accvgpr_read_b32 v250, a58
v_accvgpr_read_b32 v251, a59
v_accvgpr_read_b32 v252, a60
v_accvgpr_read_b32 v253, a61
v_accvgpr_read_b32 v254, a62
v_accvgpr_read_b32 v255, a63
v_pk_mul_f32 v[248:249], v[248:249], v[228:229]
v_pk_mul_f32 v[250:251], v[250:251], v[228:229]
v_pk_mul_f32 v[252:253], v[252:253], v[228:229]
v_pk_mul_f32 v[254:255], v[254:255], v[228:229]
v_cvt_pk_bf16_f32 v180, v248, v249
v_cvt_pk_bf16_f32 v181, v250, v251
v_cvt_pk_bf16_f32 v182, v252, v253
v_cvt_pk_bf16_f32 v183, v254, v255
v_mfma_f32_16x16x32_bf16 v[232:235], v[120:123], v[216:219], v[232:235]
s_add_u32 s82, s82, 0x8000
ds_read_b128 a[160:163], v2 offset:24576
ds_read_b128 a[164:167], v2 offset:25600
v_mfma_f32_16x16x32_bf16 v[232:235], v[120:123], v[200:203], v[232:235]
s_and_b32 s82, s82, 0x1ffff
v_exp_f32 v172, v172
v_mfma_f32_16x16x32_bf16 a[64:67], a[224:227], v[216:219], a[64:67]
v_exp_f32 v173, v173
v_mfma_f32_16x16x32_bf16 a[64:67], a[192:195], v[200:203], a[64:67]
s_nop 0
ds_read_b128 a[168:171], v2 offset:26624
ds_read_b128 a[172:175], v2 offset:27648
v_mfma_f32_16x16x32_bf16 a[68:71], a[196:199], v[200:203], a[68:71]
v_exp_f32 v174, v174
v_mfma_f32_16x16x32_bf16 a[68:71], a[228:231], v[216:219], a[68:71]
v_exp_f32 v175, v175
v_mfma_f32_16x16x32_bf16 a[72:75], a[232:235], v[216:219], a[72:75]
buffer_store_dwordx4 v[128:131], v1, s[44:47], s70 offen sc1
v_mfma_f32_16x16x32_bf16 a[72:75], a[200:203], v[200:203], a[72:75]
s_nop 0
ds_read_b128 a[176:179], v2 offset:28672
ds_read_b128 a[180:183], v2 offset:29696
v_mfma_f32_16x16x32_bf16 a[76:79], a[204:207], v[200:203], a[76:79]
v_exp_f32 v188, v188
v_mfma_f32_16x16x32_bf16 a[76:79], a[236:239], v[216:219], a[76:79]
s_nop 0
ds_read_b128 a[184:187], v2 offset:30720
ds_read_b128 a[188:191], v2 offset:31744
v_mfma_f32_16x16x32_bf16 a[80:83], a[240:243], v[216:219], a[80:83]
s_waitcnt lgkmcnt(8)
ds_read_b128 a[224:227], v2 offset:8192
ds_read_b128 a[228:231], v2 offset:9216
v_mfma_f32_16x16x32_bf16 a[80:83], a[208:211], v[200:203], a[80:83]
s_nop 0
ds_read_b128 a[232:235], v2 offset:10240
ds_read_b128 a[236:239], v2 offset:11264
v_mfma_f32_16x16x32_bf16 a[84:87], a[212:215], v[200:203], a[84:87]
ds_read_b128 a[240:243], v2 offset:12288
v_cvt_pk_bf16_f32 v220, v172, v173
v_mfma_f32_16x16x32_bf16 a[84:87], a[244:247], v[216:219], a[84:87]
v_exp_f32 v189, v189
v_mfma_f32_16x16x32_bf16 a[88:91], a[248:251], v[216:219], a[88:91]
v_exp_f32 v190, v190
v_mfma_f32_16x16x32_bf16 a[88:91], a[216:219], v[200:203], a[88:91]
s_nop 0
ds_read_b128 a[244:247], v2 offset:13312
ds_read_b128 a[248:251], v2 offset:14336
v_mfma_f32_16x16x32_bf16 a[92:95], a[220:223], v[200:203], a[92:95]
v_cvt_pk_bf16_f32 v221, v174, v175
v_cvt_pk_bf16_f32 v222, v188, v189
v_mfma_f32_16x16x32_bf16 a[92:95], a[252:255], v[216:219], a[92:95]
v_exp_f32 v191, v191
s_cmp_eq_u32 s58, 0
s_cbranch_scc1 Lta49
s_cmp_eq_u32 s58, 1
s_cbranch_scc1 Lnt50
v_mfma_f32_16x16x32_bf16 v[140:143], a[128:131], v[64:67], v[92:95]
v_exp_f32 v168, v168
v_mfma_f32_16x16x32_bf16 v[156:159], a[144:147], v[64:67], v[92:95]
buffer_store_dwordx4 v[144:147], v1, s[44:47], s70 offen offset:1024 sc1
s_branch Ljoin51
Lta49:
v_mfma_f32_16x16x32_bf16 v[140:143], a[128:131], v[64:67], v[108:111]
v_exp_f32 v168, v168
v_mfma_f32_16x16x32_bf16 v[156:159], a[144:147], v[64:67], v[112:115]
buffer_store_dwordx4 v[144:147], v1, s[44:47], s70 offen offset:1024 sc1
s_branch Ljoin51
Lnt50:
v_mfma_f32_16x16x32_bf16 v[140:143], a[128:131], v[64:67], v[92:95]
v_exp_f32 v168, v168
v_mfma_f32_16x16x32_bf16 v[156:159], a[144:147], v[64:67], v[108:111]
buffer_store_dwordx4 v[144:147], v1, s[44:47], s70 offen offset:1024 sc1
Ljoin51:
v_mfma_f32_16x16x32_bf16 v[140:143], a[132:135], v[68:71], v[140:143]
v_exp_f32 v169, v169
v_mfma_f32_16x16x32_bf16 v[140:143], a[136:139], v[72:75], v[140:143]
v_exp_f32 v170, v170
v_mfma_f32_16x16x32_bf16 v[140:143], a[140:143], v[76:79], v[140:143]
buffer_store_dwordx4 v[160:163], v1, s[44:47], s70 offen offset:2048 sc1
v_mfma_f32_16x16x32_bf16 v[156:159], a[156:159], v[76:79], v[156:159]
ds_read_b128 a[252:255], v2 offset:15360
v_cvt_pk_bf16_f32 v223, v190, v191
v_mfma_f32_16x16x32_bf16 v[156:159], a[152:155], v[72:75], v[156:159]
s_waitcnt vmcnt(24) lgkmcnt(4)
v_exp_f32 v171, v171
v_mfma_f32_16x16x32_bf16 v[156:159], a[148:151], v[68:71], v[156:159]
s_barrier
v_exp_f32 v184, v184
v_add_u32 v2, s82, v1
v_cvt_pk_bf16_f32 v216, v168, v169
v_cvt_pk_bf16_f32 v217, v170, v171
v_exp_f32 v185, v185
v_exp_f32 v186, v186
v_cvt_pk_bf16_f32 v218, v184, v185
v_exp_f32 v187, v187
s_nop 0
v_cvt_pk_bf16_f32 v219, v186, v187
v_mfma_f32_16x16x32_bf16 v[236:239], v[120:123], v[204:207], v[236:239]
s_add_u32 s78, s59, 4
v_exp_f32 v140, v140
v_mfma_f32_16x16x32_bf16 v[236:239], v[120:123], v[220:223], v[236:239]
s_and_b32 s78, s78, 12
v_exp_f32 v141, v141
v_mfma_f32_16x16x32_bf16 a[96:99], a[192:195], v[204:207], a[96:99]
s_and_b32 s12, s59, 16
ds_read_b128 a[192:195], v2 offset:0
v_mfma_f32_16x16x32_bf16 a[96:99], a[224:227], v[220:223], a[96:99]
s_or_b32 s78, s78, s12
buffer_store_dwordx4 v[176:179], v1, s[44:47], s70 offen offset:3072 sc1
v_mfma_f32_16x16x32_bf16 a[100:103], a[228:231], v[220:223], a[100:103]
s_add_u32 s70, s70, 0x80000
v_exp_f32 v142, v142
v_mfma_f32_16x16x32_bf16 a[100:103], a[196:199], v[204:207], a[100:103]
s_add_u32 s12, s61, 0
ds_read_b128 a[196:199], v2 offset:1024
v_mfma_f32_16x16x32_bf16 a[104:107], a[200:203], v[204:207], a[104:107]
s_and_b32 s12, s12, 3
ds_read_b128 a[200:203], v2 offset:2048
v_mfma_f32_16x16x32_bf16 a[104:107], a[232:235], v[220:223], a[104:107]
s_add_u32 s12, s12, s78
v_exp_f32 v143, v143
v_mfma_f32_16x16x32_bf16 a[108:111], a[236:239], v[220:223], a[108:111]
s_lshl_b32 s12, s12, 18
v_exp_f32 v156, v156
v_mfma_f32_16x16x32_bf16 a[108:111], a[204:207], v[204:207], a[108:111]
s_add_u32 s12, s12, s94
ds_read_b128 a[204:207], v2 offset:3072
v_mfma_f32_16x16x32_bf16 a[112:115], a[208:211], v[204:207], a[112:115]
s_waitcnt lgkmcnt(4)
ds_read_b128 a[208:211], v2 offset:4096
v_mfma_f32_16x16x32_bf16 a[112:115], a[240:243], v[220:223], a[112:115]
s_add_u32 s13, s61, 1
buffer_store_dwordx4 v[132:135], v1, s[44:47], s70 offen sc1
v_mfma_f32_16x16x32_bf16 a[116:119], a[244:247], v[220:223], a[116:119]
s_and_b32 s13, s13, 3
v_exp_f32 v157, v157
v_mfma_f32_16x16x32_bf16 a[116:119], a[212:215], v[204:207], a[116:119]
s_add_u32 s13, s13, s78
ds_read_b128 a[212:215], v2 offset:5120
v_mfma_f32_16x16x32_bf16 a[120:123], a[216:219], v[204:207], a[120:123]
s_lshl_b32 s13, s13, 18
v_exp_f32 v158, v158
v_mfma_f32_16x16x32_bf16 a[120:123], a[248:251], v[220:223], a[120:123]
s_add_u32 s13, s13, s94
ds_read_b128 a[216:219], v2 offset:6144
v_mfma_f32_16x16x32_bf16 a[124:127], a[252:255], v[220:223], a[124:127]
s_add_u32 s14, s61, 2
buffer_store_dwordx4 v[148:151], v1, s[44:47], s70 offen offset:1024 sc1
v_mfma_f32_16x16x32_bf16 a[124:127], a[220:223], v[204:207], a[124:127]
s_and_b32 s14, s14, 3
ds_read_b128 a[220:223], v2 offset:7168
v_cvt_pk_bf16_f32 v204, v140, v141
s_cmp_eq_u32 s58, 2
s_cbranch_scc1 Lta52
s_cmp_eq_u32 s58, 3
s_cbranch_scc1 Lnt53
v_mfma_f32_16x16x32_bf16 v[172:175], a[160:163], v[64:67], v[112:115]
s_add_u32 s14, s14, s78
v_cvt_pk_bf16_f32 v205, v142, v143
v_cvt_pk_bf16_f32 v206, v156, v157
v_mfma_f32_16x16x32_bf16 v[188:191], a[176:179], v[64:67], v[112:115]
s_lshl_b32 s14, s14, 18
v_exp_f32 v159, v159
s_branch Ljoin54
Lta52:
v_mfma_f32_16x16x32_bf16 v[172:175], a[160:163], v[64:67], v[108:111]
s_add_u32 s14, s14, s78
v_cvt_pk_bf16_f32 v205, v142, v143
v_cvt_pk_bf16_f32 v206, v156, v157
v_mfma_f32_16x16x32_bf16 v[188:191], a[176:179], v[64:67], v[112:115]
s_lshl_b32 s14, s14, 18
v_exp_f32 v159, v159
s_branch Ljoin54
Lnt53:
v_mfma_f32_16x16x32_bf16 v[172:175], a[160:163], v[64:67], v[92:95]
s_add_u32 s14, s14, s78
v_cvt_pk_bf16_f32 v205, v142, v143
v_cvt_pk_bf16_f32 v206, v156, v157
v_mfma_f32_16x16x32_bf16 v[188:191], a[176:179], v[64:67], v[108:111]
s_lshl_b32 s14, s14, 18
v_exp_f32 v159, v159
Ljoin54:
v_mfma_f32_16x16x32_bf16 v[172:175], a[164:167], v[68:71], v[172:175]
s_add_u32 s14, s14, s94
v_cvt_pk_bf16_f32 v207, v158, v159
v_mfma_f32_16x16x32_bf16 v[172:175], a[168:171], v[72:75], v[172:175]
s_add_u32 s15, s61, 3
v_mfma_f32_16x16x32_bf16 v[172:175], a[172:175], v[76:79], v[172:175]
s_and_b32 s15, s15, 3
v_mfma_f32_16x16x32_bf16 v[188:191], a[188:191], v[76:79], v[188:191]
s_add_u32 s15, s15, s78
v_mfma_f32_16x16x32_bf16 v[188:191], a[184:187], v[72:75], v[188:191]
s_lshl_b32 s15, s15, 18
v_mfma_f32_16x16x32_bf16 v[188:191], a[180:183], v[68:71], v[188:191]
s_waitcnt lgkmcnt(4)
s_add_u32 s15, s15, s94
v_mfma_f32_16x16x32_bf16 v[232:235], v[120:123], v[216:219], v[232:235]
s_add_u32 s82, s82, 0x8000
v_exp_f32 v172, v172
v_mfma_f32_16x16x32_bf16 a[64:67], a[224:227], v[216:219], a[64:67]
s_and_b32 s82, s82, 0x1ffff
ds_read_b128 a[224:227], v2 offset:8192
v_mfma_f32_16x16x32_bf16 a[68:71], a[228:231], v[216:219], a[68:71]
ds_read_b128 a[228:231], v2 offset:9216
v_mfma_f32_16x16x32_bf16 a[72:75], a[232:235], v[216:219], a[72:75]
ds_read_b128 a[232:235], v2 offset:10240
v_mfma_f32_16x16x32_bf16 a[76:79], a[236:239], v[216:219], a[76:79]
buffer_store_dwordx4 v[164:167], v1, s[44:47], s70 offen offset:2048 sc1
v_mfma_f32_16x16x32_bf16 a[80:83], a[240:243], v[216:219], a[80:83]
s_nop 0
ds_read_b128 a[236:239], v2 offset:11264
ds_read_b128 a[240:243], v2 offset:12288
v_mfma_f32_16x16x32_bf16 a[84:87], a[244:247], v[216:219], a[84:87]
ds_read_b128 a[244:247], v2 offset:13312
v_mfma_f32_16x16x32_bf16 a[88:91], a[248:251], v[216:219], a[88:91]
v_exp_f32 v173, v173
v_mfma_f32_16x16x32_bf16 a[92:95], a[252:255], v[216:219], a[92:95]
v_exp_f32 v174, v174
ds_read_b128 a[248:251], v2 offset:14336
ds_read_b128 a[252:255], v2 offset:15360
v_add_u32 v2, s82, v1
buffer_store_dwordx4 v[180:183], v1, s[44:47], s70 offen offset:3072 sc1
v_cvt_pk_bf16_f32 v220, v172, v173
v_exp_f32 v175, v175
v_exp_f32 v188, v188
v_cvt_pk_bf16_f32 v221, v174, v175
v_exp_f32 v189, v189
v_exp_f32 v190, v190
v_cvt_pk_bf16_f32 v222, v188, v189
v_exp_f32 v191, v191
s_nop 0
v_cvt_pk_bf16_f32 v223, v190, v191
s_waitcnt vmcnt(8) lgkmcnt(0)
s_barrier
s_branch LHT4
Lslow:
s_waitcnt vmcnt(0) lgkmcnt(0)
s_barrier
s_mov_b32 s86, 1
s_lshl_b32 s81, s59, 20
s_add_u32 s81, s81, s64
s_sub_u32 s81, s81, 0x4000
s_mov_b32 s83, 0
s_lshl_b32 s75, s60, 3
s_sub_u32 s76, 128, s75
s_add_u32 s74, s75, s58
s_sub_u32 s75, s76, 8
s_add_u32 s75, s75, s58
v_mov_b32 v2, v1
v_lshrrev_b32 v240, 4, v0
v_and_b32 v241, 15, v0
v_lshlrev_b32 v240, 2, v240
v_sub_u32 v240, v241, v240
v_mov_b32 v112, 0xff800000
v_mov_b32 v113, 0xff800000
v_mov_b32 v114, 0xff800000
v_mov_b32 v115, 0xff800000
v_cmp_gt_i32 vcc, 0, v240
v_mov_b32 v120, 0x3f803f80
s_nop 0
v_cndmask_b32 v116, 0, v112, vcc
v_cmp_gt_i32 vcc, 1, v240
v_mov_b32 v121, 0x3f803f80
s_nop 0
v_cndmask_b32 v117, 0, v112, vcc
v_cmp_gt_i32 vcc, 2, v240
v_mov_b32 v122, 0x3f803f80
s_nop 0
v_cndmask_b32 v118, 0, v112, vcc
v_cmp_gt_i32 vcc, 3, v240
v_mov_b32 v123, 0x3f803f80
s_nop 0
v_cndmask_b32 v119, 0, v112, vcc
Lslow1:
s_add_u32 m0, s64, 16384
s_add_u32 s72, s81, 16384
buffer_load_dwordx4 v1, s[44:47], s72 offen sc1 lds
buffer_load_dwordx4 v1, s[44:47], s72 offen offset:1024 sc1 lds
buffer_load_dwordx4 v1, s[44:47], s72 offen offset:2048 sc1 lds
buffer_load_dwordx4 v1, s[44:47], s72 offen offset:3072 sc1 lds
s_add_u32 s81, s81, 0x8000
s_waitcnt vmcnt(0)
s_barrier
ds_read_b128 a[128:131], v2 offset:16384
ds_read_b128 a[132:135], v2 offset:17408
ds_read_b128 a[136:139], v2 offset:18432
ds_read_b128 a[140:143], v2 offset:19456
ds_read_b128 a[144:147], v2 offset:20480
ds_read_b128 a[148:151], v2 offset:21504
ds_read_b128 a[152:155], v2 offset:22528
ds_read_b128 a[156:159], v2 offset:23552
s_waitcnt lgkmcnt(0)
s_add_u32 s73, s74, 0
s_cmp_lt_u32 s73, s83
s_cbranch_scc1 Lsa55
s_cmp_eq_u32 s73, s83
s_cbranch_scc1 Lst56
v_mfma_f32_16x16x32_bf16 v[128:131], a[128:131], v[16:19], 0
s_branch Lsj57
Lst56:
v_mfma_f32_16x16x32_bf16 v[128:131], a[128:131], v[16:19], v[116:119]
Lsj57:
v_mfma_f32_16x16x32_bf16 v[128:131], a[132:135], v[20:23], v[128:131]
v_mfma_f32_16x16x32_bf16 v[128:131], a[136:139], v[24:27], v[128:131]
v_mfma_f32_16x16x32_bf16 v[128:131], a[140:143], v[28:31], v[128:131]
s_nop 7
v_max3_f32 v124, v124, v128, v129
v_max3_f32 v124, v124, v130, v131
Lsa55:
s_add_u32 s73, s74, 4
s_cmp_lt_u32 s73, s83
s_cbranch_scc1 Lsa58
s_cmp_eq_u32 s73, s83
s_cbranch_scc1 Lst59
v_mfma_f32_16x16x32_bf16 v[132:135], a[128:131], v[32:35], 0
s_branch Lsj60
Lst59:
v_mfma_f32_16x16x32_bf16 v[132:135], a[128:131], v[32:35], v[116:119]
Lsj60:
v_mfma_f32_16x16x32_bf16 v[132:135], a[132:135], v[36:39], v[132:135]
v_mfma_f32_16x16x32_bf16 v[132:135], a[136:139], v[40:43], v[132:135]
v_mfma_f32_16x16x32_bf16 v[132:135], a[140:143], v[44:47], v[132:135]
s_nop 7
v_max3_f32 v125, v125, v132, v133
v_max3_f32 v125, v125, v134, v135
Lsa58:
s_add_u32 s73, s75, 0
s_cmp_lt_u32 s73, s83
s_cbranch_scc1 Lsa61
s_cmp_eq_u32 s73, s83
s_cbranch_scc1 Lst62
v_mfma_f32_16x16x32_bf16 v[136:139], a[128:131], v[48:51], 0
s_branch Lsj63
Lst62:
v_mfma_f32_16x16x32_bf16 v[136:139], a[128:131], v[48:51], v[116:119]
Lsj63:
v_mfma_f32_16x16x32_bf16 v[136:139], a[132:135], v[52:55], v[136:139]
v_mfma_f32_16x16x32_bf16 v[136:139], a[136:139], v[56:59], v[136:139]
v_mfma_f32_16x16x32_bf16 v[136:139], a[140:143], v[60:63], v[136:139]
s_nop 7
v_max3_f32 v126, v126, v136, v137
v_max3_f32 v126, v126, v138, v139
Lsa61:
s_add_u32 s73, s75, 4
s_cmp_lt_u32 s73, s83
s_cbranch_scc1 Lsa64
s_cmp_eq_u32 s73, s83
s_cbranch_scc1 Lst65
v_mfma_f32_16x16x32_bf16 v[140:143], a[128:131], v[64:67], 0
s_branch Lsj66
Lst65:
v_mfma_f32_16x16x32_bf16 v[140:143], a[128:131], v[64:67], v[116:119]
Lsj66:
v_mfma_f32_16x16x32_bf16 v[140:143], a[132:135], v[68:71], v[140:143]
v_mfma_f32_16x16x32_bf16 v[140:143], a[136:139], v[72:75], v[140:143]
v_mfma_f32_16x16x32_bf16 v[140:143], a[140:143], v[76:79], v[140:143]
s_nop 7
v_max3_f32 v127, v127, v140, v141
v_max3_f32 v127, v127, v142, v143
Lsa64:
s_add_u32 s83, s83, 1
s_add_u32 s73, s74, 0
s_cmp_lt_u32 s73, s83
s_cbranch_scc1 Lsa67
s_cmp_eq_u32 s73, s83
s_cbranch_scc1 Lst68
v_mfma_f32_16x16x32_bf16 v[144:147], a[144:147], v[16:19], 0
s_branch Lsj69
Lst68:
v_mfma_f32_16x16x32_bf16 v[144:147], a[144:147], v[16:19], v[116:119]
Lsj69:
v_mfma_f32_16x16x32_bf16 v[144:147], a[148:151], v[20:23], v[144:147]
v_mfma_f32_16x16x32_bf16 v[144:147], a[152:155], v[24:27], v[144:147]
v_mfma_f32_16x16x32_bf16 v[144:147], a[156:159], v[28:31], v[144:147]
s_nop 7
v_max3_f32 v124, v124, v144, v145
v_max3_f32 v124, v124, v146, v147
Lsa67:
s_add_u32 s73, s74, 4
s_cmp_lt_u32 s73, s83
s_cbranch_scc1 Lsa70
s_cmp_eq_u32 s73, s83
s_cbranch_scc1 Lst71
v_mfma_f32_16x16x32_bf16 v[148:151], a[144:147], v[32:35], 0
s_branch Lsj72
Lst71:
v_mfma_f32_16x16x32_bf16 v[148:151], a[144:147], v[32:35], v[116:119]
Lsj72:
v_mfma_f32_16x16x32_bf16 v[148:151], a[148:151], v[36:39], v[148:151]
v_mfma_f32_16x16x32_bf16 v[148:151], a[152:155], v[40:43], v[148:151]
v_mfma_f32_16x16x32_bf16 v[148:151], a[156:159], v[44:47], v[148:151]
s_nop 7
v_max3_f32 v125, v125, v148, v149
v_max3_f32 v125, v125, v150, v151
Lsa70:
s_add_u32 s73, s75, 0
s_cmp_lt_u32 s73, s83
s_cbranch_scc1 Lsa73
s_cmp_eq_u32 s73, s83
s_cbranch_scc1 Lst74
v_mfma_f32_16x16x32_bf16 v[152:155], a[144:147], v[48:51], 0
s_branch Lsj75
Lst74:
v_mfma_f32_16x16x32_bf16 v[152:155], a[144:147], v[48:51], v[116:119]
Lsj75:
v_mfma_f32_16x16x32_bf16 v[152:155], a[148:151], v[52:55], v[152:155]
v_mfma_f32_16x16x32_bf16 v[152:155], a[152:155], v[56:59], v[152:155]
v_mfma_f32_16x16x32_bf16 v[152:155], a[156:159], v[60:63], v[152:155]
s_nop 7
v_max3_f32 v126, v126, v152, v153
v_max3_f32 v126, v126, v154, v155
Lsa73:
s_add_u32 s73, s75, 4
s_cmp_lt_u32 s73, s83
s_cbranch_scc1 Lsa76
s_cmp_eq_u32 s73, s83
s_cbranch_scc1 Lst77
v_mfma_f32_16x16x32_bf16 v[156:159], a[144:147], v[64:67], 0
s_branch Lsj78
Lst77:
v_mfma_f32_16x16x32_bf16 v[156:159], a[144:147], v[64:67], v[116:119]
Lsj78:
v_mfma_f32_16x16x32_bf16 v[156:159], a[148:151], v[68:71], v[156:159]
v_mfma_f32_16x16x32_bf16 v[156:159], a[152:155], v[72:75], v[156:159]
v_mfma_f32_16x16x32_bf16 v[156:159], a[156:159], v[76:79], v[156:159]
s_nop 7
v_max3_f32 v127, v127, v156, v157
v_max3_f32 v127, v127, v158, v159
Lsa76:
s_add_u32 s83, s83, 1
ds_read_b128 a[128:131], v2 offset:24576
ds_read_b128 a[132:135], v2 offset:25600
ds_read_b128 a[136:139], v2 offset:26624
ds_read_b128 a[140:143], v2 offset:27648
ds_read_b128 a[144:147], v2 offset:28672
ds_read_b128 a[148:151], v2 offset:29696
ds_read_b128 a[152:155], v2 offset:30720
ds_read_b128 a[156:159], v2 offset:31744
s_waitcnt lgkmcnt(0)
s_add_u32 s73, s74, 0
s_cmp_lt_u32 s73, s83
s_cbranch_scc1 Lsa79
s_cmp_eq_u32 s73, s83
s_cbranch_scc1 Lst80
v_mfma_f32_16x16x32_bf16 v[128:131], a[128:131], v[16:19], 0
s_branch Lsj81
Lst80:
v_mfma_f32_16x16x32_bf16 v[128:131], a[128:131], v[16:19], v[116:119]
Lsj81:
v_mfma_f32_16x16x32_bf16 v[128:131], a[132:135], v[20:23], v[128:131]
v_mfma_f32_16x16x32_bf16 v[128:131], a[136:139], v[24:27], v[128:131]
v_mfma_f32_16x16x32_bf16 v[128:131], a[140:143], v[28:31], v[128:131]
s_nop 7
v_max3_f32 v124, v124, v128, v129
v_max3_f32 v124, v124, v130, v131
Lsa79:
s_add_u32 s73, s74, 4
s_cmp_lt_u32 s73, s83
s_cbranch_scc1 Lsa82
s_cmp_eq_u32 s73, s83
s_cbranch_scc1 Lst83
v_mfma_f32_16x16x32_bf16 v[132:135], a[128:131], v[32:35], 0
s_branch Lsj84
Lst83:
v_mfma_f32_16x16x32_bf16 v[132:135], a[128:131], v[32:35], v[116:119]
Lsj84:
v_mfma_f32_16x16x32_bf16 v[132:135], a[132:135], v[36:39], v[132:135]
v_mfma_f32_16x16x32_bf16 v[132:135], a[136:139], v[40:43], v[132:135]
v_mfma_f32_16x16x32_bf16 v[132:135], a[140:143], v[44:47], v[132:135]
s_nop 7
v_max3_f32 v125, v125, v132, v133
v_max3_f32 v125, v125, v134, v135
Lsa82:
s_add_u32 s73, s75, 0
s_cmp_lt_u32 s73, s83
s_cbranch_scc1 Lsa85
s_cmp_eq_u32 s73, s83
s_cbranch_scc1 Lst86
v_mfma_f32_16x16x32_bf16 v[136:139], a[128:131], v[48:51], 0
s_branch Lsj87
Lst86:
v_mfma_f32_16x16x32_bf16 v[136:139], a[128:131], v[48:51], v[116:119]
Lsj87:
v_mfma_f32_16x16x32_bf16 v[136:139], a[132:135], v[52:55], v[136:139]
v_mfma_f32_16x16x32_bf16 v[136:139], a[136:139], v[56:59], v[136:139]
v_mfma_f32_16x16x32_bf16 v[136:139], a[140:143], v[60:63], v[136:139]
s_nop 7
v_max3_f32 v126, v126, v136, v137
v_max3_f32 v126, v126, v138, v139
Lsa85:
s_add_u32 s73, s75, 4
s_cmp_lt_u32 s73, s83
s_cbranch_scc1 Lsa88
s_cmp_eq_u32 s73, s83
s_cbranch_scc1 Lst89
v_mfma_f32_16x16x32_bf16 v[140:143], a[128:131], v[64:67], 0
s_branch Lsj90
Lst89:
v_mfma_f32_16x16x32_bf16 v[140:143], a[128:131], v[64:67], v[116:119]
Lsj90:
v_mfma_f32_16x16x32_bf16 v[140:143], a[132:135], v[68:71], v[140:143]
v_mfma_f32_16x16x32_bf16 v[140:143], a[136:139], v[72:75], v[140:143]
v_mfma_f32_16x16x32_bf16 v[140:143], a[140:143], v[76:79], v[140:143]
s_nop 7
v_max3_f32 v127, v127, v140, v141
v_max3_f32 v127, v127, v142, v143
Lsa88:
s_add_u32 s83, s83, 1
s_add_u32 s73, s74, 0
s_cmp_lt_u32 s73, s83
s_cbranch_scc1 Lsa91
s_cmp_eq_u32 s73, s83
s_cbranch_scc1 Lst92
v_mfma_f32_16x16x32_bf16 v[144:147], a[144:147], v[16:19], 0
s_branch Lsj93
Lst92:
v_mfma_f32_16x16x32_bf16 v[144:147], a[144:147], v[16:19], v[116:119]
Lsj93:
v_mfma_f32_16x16x32_bf16 v[144:147], a[148:151], v[20:23], v[144:147]
v_mfma_f32_16x16x32_bf16 v[144:147], a[152:155], v[24:27], v[144:147]
v_mfma_f32_16x16x32_bf16 v[144:147], a[156:159], v[28:31], v[144:147]
s_nop 7
v_max3_f32 v124, v124, v144, v145
v_max3_f32 v124, v124, v146, v147
Lsa91:
s_add_u32 s73, s74, 4
s_cmp_lt_u32 s73, s83
s_cbranch_scc1 Lsa94
s_cmp_eq_u32 s73, s83
s_cbranch_scc1 Lst95
v_mfma_f32_16x16x32_bf16 v[148:151], a[144:147], v[32:35], 0
s_branch Lsj96
Lst95:
v_mfma_f32_16x16x32_bf16 v[148:151], a[144:147], v[32:35], v[116:119]
Lsj96:
v_mfma_f32_16x16x32_bf16 v[148:151], a[148:151], v[36:39], v[148:151]
v_mfma_f32_16x16x32_bf16 v[148:151], a[152:155], v[40:43], v[148:151]
v_mfma_f32_16x16x32_bf16 v[148:151], a[156:159], v[44:47], v[148:151]
s_nop 7
v_max3_f32 v125, v125, v148, v149
v_max3_f32 v125, v125, v150, v151
Lsa94:
s_add_u32 s73, s75, 0
s_cmp_lt_u32 s73, s83
s_cbranch_scc1 Lsa97
s_cmp_eq_u32 s73, s83
s_cbranch_scc1 Lst98
v_mfma_f32_16x16x32_bf16 v[152:155], a[144:147], v[48:51], 0
s_branch Lsj99
Lst98:
v_mfma_f32_16x16x32_bf16 v[152:155], a[144:147], v[48:51], v[116:119]
Lsj99:
v_mfma_f32_16x16x32_bf16 v[152:155], a[148:151], v[52:55], v[152:155]
v_mfma_f32_16x16x32_bf16 v[152:155], a[152:155], v[56:59], v[152:155]
v_mfma_f32_16x16x32_bf16 v[152:155], a[156:159], v[60:63], v[152:155]
s_nop 7
v_max3_f32 v126, v126, v152, v153
v_max3_f32 v126, v126, v154, v155
Lsa97:
s_add_u32 s73, s75, 4
s_cmp_lt_u32 s73, s83
s_cbranch_scc1 Lsa100
s_cmp_eq_u32 s73, s83
s_cbranch_scc1 Lst101
v_mfma_f32_16x16x32_bf16 v[156:159], a[144:147], v[64:67], 0
s_branch Lsj102
Lst101:
v_mfma_f32_16x16x32_bf16 v[156:159], a[144:147], v[64:67], v[116:119]
Lsj102:
v_mfma_f32_16x16x32_bf16 v[156:159], a[148:151], v[68:71], v[156:159]
v_mfma_f32_16x16x32_bf16 v[156:159], a[152:155], v[72:75], v[156:159]
v_mfma_f32_16x16x32_bf16 v[156:159], a[156:159], v[76:79], v[156:159]
s_nop 7
v_max3_f32 v127, v127, v156, v157
v_max3_f32 v127, v127, v158, v159
Lsa100:
s_add_u32 s83, s83, 1
s_barrier
s_cmp_lt_u32 s83, s76
s_cbranch_scc1 Lslow1
s_lshl_b32 s81, s59, 20
s_add_u32 s81, s81, s64
s_sub_u32 s81, s81, 0x4000
s_add_u32 m0, s64, 49152
s_add_u32 s72, s81, 16384
buffer_load_dwordx4 v1, s[44:47], s72 offen sc1 lds
buffer_load_dwordx4 v1, s[44:47], s72 offen offset:1024 sc1 lds
buffer_load_dwordx4 v1, s[44:47], s72 offen offset:2048 sc1 lds
buffer_load_dwordx4 v1, s[44:47], s72 offen offset:3072 sc1 lds
s_add_u32 s81, s81, 0x8000
s_add_u32 m0, s64, 81920
s_add_u32 s72, s81, 16384
buffer_load_dwordx4 v1, s[44:47], s72 offen sc1 lds
buffer_load_dwordx4 v1, s[44:47], s72 offen offset:1024 sc1 lds
buffer_load_dwordx4 v1, s[44:47], s72 offen offset:2048 sc1 lds
buffer_load_dwordx4 v1, s[44:47], s72 offen offset:3072 sc1 lds
s_add_u32 m0, s64, 65536
s_add_u32 s72, s81, 0
buffer_load_dwordx4 v1, s[44:47], s72 offen sc1 lds
buffer_load_dwordx4 v1, s[44:47], s72 offen offset:1024 sc1 lds
buffer_load_dwordx4 v1, s[44:47], s72 offen offset:2048 sc1 lds
buffer_load_dwordx4 v1, s[44:47], s72 offen offset:3072 sc1 lds
s_add_u32 s81, s81, 0x8000
s_add_u32 m0, s64, 114688
s_add_u32 s72, s81, 16384
buffer_load_dwordx4 v1, s[44:47], s72 offen sc1 lds
buffer_load_dwordx4 v1, s[44:47], s72 offen offset:1024 sc1 lds
buffer_load_dwordx4 v1, s[44:47], s72 offen offset:2048 sc1 lds
buffer_load_dwordx4 v1, s[44:47], s72 offen offset:3072 sc1 lds
s_add_u32 m0, s64, 98304
s_add_u32 s72, s81, 0
buffer_load_dwordx4 v1, s[44:47], s72 offen sc1 lds
buffer_load_dwordx4 v1, s[44:47], s72 offen offset:1024 sc1 lds
buffer_load_dwordx4 v1, s[44:47], s72 offen offset:2048 sc1 lds
buffer_load_dwordx4 v1, s[44:47], s72 offen offset:3072 sc1 lds
v_add_u32 v2, 0x8000, v1
v_lshrrev_b32 v3, 1, v0
v_lshlrev_b32 v3, 7, v3
s_waitcnt vmcnt(0)
s_barrier
v_accvgpr_write_b32 a32, 0
v_accvgpr_write_b32 a33, 0
v_accvgpr_write_b32 a34, 0
v_accvgpr_write_b32 a35, 0
v_accvgpr_write_b32 a36, 0
v_accvgpr_write_b32 a37, 0
v_accvgpr_write_b32 a38, 0
v_accvgpr_write_b32 a39, 0
v_accvgpr_write_b32 a40, 0
v_accvgpr_write_b32 a41, 0
v_accvgpr_write_b32 a42, 0
v_accvgpr_write_b32 a43, 0
v_accvgpr_write_b32 a44, 0
v_accvgpr_write_b32 a45, 0
v_accvgpr_write_b32 a46, 0
v_accvgpr_write_b32 a47, 0
v_accvgpr_write_b32 a48, 0
v_accvgpr_write_b32 a49, 0
v_accvgpr_write_b32 a50, 0
v_accvgpr_write_b32 a51, 0
v_accvgpr_write_b32 a52, 0
v_accvgpr_write_b32 a53, 0
v_accvgpr_write_b32 a54, 0
v_accvgpr_write_b32 a55, 0
v_accvgpr_write_b32 a56, 0
v_accvgpr_write_b32 a57, 0
v_accvgpr_write_b32 a58, 0
v_accvgpr_write_b32 a59, 0
v_accvgpr_write_b32 a60, 0
v_accvgpr_write_b32 a61, 0
v_accvgpr_write_b32 a62, 0
v_accvgpr_write_b32 a63, 0
v_accvgpr_write_b32 a96, 0
v_accvgpr_write_b32 a97, 0
v_accvgpr_write_b32 a98, 0
v_accvgpr_write_b32 a99, 0
v_accvgpr_write_b32 a100, 0
v_accvgpr_write_b32 a101, 0
v_accvgpr_write_b32 a102, 0
v_accvgpr_write_b32 a103, 0
v_accvgpr_write_b32 a104, 0
v_accvgpr_write_b32 a105, 0
v_accvgpr_write_b32 a106, 0
v_accvgpr_write_b32 a107, 0
v_accvgpr_write_b32 a108, 0
v_accvgpr_write_b32 a109, 0
v_accvgpr_write_b32 a110, 0
v_accvgpr_write_b32 a111, 0
v_accvgpr_write_b32 a112, 0
v_accvgpr_write_b32 a113, 0
v_accvgpr_write_b32 a114, 0
v_accvgpr_write_b32 a115, 0
v_accvgpr_write_b32 a116, 0
v_accvgpr_write_b32 a117, 0
v_accvgpr_write_b32 a118, 0
v_accvgpr_write_b32 a119, 0
v_accvgpr_write_b32 a120, 0
v_accvgpr_write_b32 a121, 0
v_accvgpr_write_b32 a122, 0
v_accvgpr_write_b32 a123, 0
v_accvgpr_write_b32 a124, 0
v_accvgpr_write_b32 a125, 0
v_accvgpr_write_b32 a126, 0
v_accvgpr_write_b32 a127, 0
ds_read_b128 a[128:131], v2 offset:16384
ds_read_b128 a[132:135], v2 offset:17408
ds_read_b128 a[136:139], v2 offset:18432
ds_read_b128 a[140:143], v2 offset:19456
ds_read_b128 a[144:147], v2 offset:20480
ds_read_b128 a[148:151], v2 offset:21504
ds_read_b128 a[152:155], v2 offset:22528
ds_read_b128 a[156:159], v2 offset:23552
s_branch Lattn
Lspin103:
s_mov_b32 s83, 262144
Lsl105:
s_sleep 2
buffer_load_dword v3, v2, s[44:47], s82 offen sc1
s_sub_u32 s83, s83, 1
s_cmp_eq_u32 s83, 0
s_waitcnt vmcnt(0)
s_cbranch_scc1 Lback104
v_cmp_gt_u32 vcc, 2, v3
s_cbranch_vccnz Lsl105
s_branch Lback104
Lspin106:
s_mov_b32 s83, 262144
Lsl108:
s_sleep 2
buffer_load_dword v3, v2, s[44:47], s82 offen sc1
s_sub_u32 s83, s83, 1
s_cmp_eq_u32 s83, 0
s_waitcnt vmcnt(0)
s_cbranch_scc1 Lback107
v_cmp_gt_u32 vcc, 2, v3
s_cbranch_vccnz Lsl108
s_branch Lback107
Lredo0:
s_xor_b32 s82, s78, 0
s_lshl_b32 s82, s82, 10
s_add_u32 s82, s82, s74
buffer_load_dword v3, v2, s[44:47], s82 offen sc1
s_waitcnt vmcnt(0)
v_cmp_gt_u32 vcc, 2, v3
s_cbranch_vccnz Lspin103
Lback104:
s_lshr_b32 s69, s12, 18
s_lshl_b32 s69, s69, 12
s_add_u32 s69, s69, s95
buffer_load_dwordx4 a[0:3], v1, s[44:47], s69 offen sc1
buffer_load_dwordx4 a[4:7], v1, s[44:47], s69 offen offset:1024 sc1
buffer_load_dwordx4 a[8:11], v1, s[44:47], s69 offen offset:2048 sc1
buffer_load_dwordx4 a[12:15], v1, s[44:47], s69 offen offset:3072 sc1
s_add_u32 s69, s69, 0x20000
buffer_load_dwordx4 a[16:19], v1, s[44:47], s69 offen sc1
buffer_load_dwordx4 a[20:23], v1, s[44:47], s69 offen offset:1024 sc1
buffer_load_dwordx4 a[24:27], v1, s[44:47], s69 offen offset:2048 sc1
buffer_load_dwordx4 a[28:31], v1, s[44:47], s69 offen offset:3072 sc1
s_lshr_b32 s69, s13, 18
s_lshl_b32 s69, s69, 12
s_add_u32 s69, s69, s95
buffer_load_dwordx4 a[32:35], v1, s[44:47], s69 offen sc1
buffer_load_dwordx4 a[36:39], v1, s[44:47], s69 offen offset:1024 sc1
buffer_load_dwordx4 a[40:43], v1, s[44:47], s69 offen offset:2048 sc1
buffer_load_dwordx4 a[44:47], v1, s[44:47], s69 offen offset:3072 sc1
s_add_u32 s69, s69, 0x20000
buffer_load_dwordx4 a[48:51], v1, s[44:47], s69 offen sc1
buffer_load_dwordx4 a[52:55], v1, s[44:47], s69 offen offset:1024 sc1
buffer_load_dwordx4 a[56:59], v1, s[44:47], s69 offen offset:2048 sc1
buffer_load_dwordx4 a[60:63], v1, s[44:47], s69 offen offset:3072 sc1
s_waitcnt vmcnt(8)
s_branch Lredo0b
Lspin109:
s_mov_b32 s83, 262144
Lsl111:
s_sleep 2
buffer_load_dword v114, v115, s[44:47], s84 offen sc1
s_sub_u32 s83, s83, 1
s_cmp_eq_u32 s83, 0
s_waitcnt vmcnt(0)
s_cbranch_scc1 Lback110
v_cmp_gt_u32 vcc, 3, v114
s_cbranch_vccnz Lsl111
s_branch Lback110
Lspin112:
s_mov_b32 s83, 262144
Lsl114:
s_sleep 2
buffer_load_dword v14, v13, s[44:47], s79 offen sc1
s_sub_u32 s83, s83, 1
s_cmp_eq_u32 s83, 0
s_waitcnt vmcnt(0)
s_cbranch_scc1 Lback113
v_cmp_gt_u32 vcc, 2, v14
s_cbranch_vccnz Lsl114
s_branch Lback113
Lxspin1:
s_mov_b32 s83, 262144
Lxsl1:
buffer_load_dwordx4 v[96:99], v1, s[44:47], s79 offen sc1
buffer_load_dwordx4 v[100:103], v1, s[44:47], s79 offen offset:1024 sc1
buffer_load_dwordx4 v[104:107], v1, s[44:47], s79 offen offset:2048 sc1
buffer_load_dwordx4 v[108:111], v1, s[44:47], s79 offen offset:3072 sc1
s_sub_u32 s83, s83, 1
s_cmp_eq_u32 s83, 0
s_waitcnt vmcnt(0)
s_cbranch_scc1 Lxback1
v_max3_u32 v12, v96, v97, v98
v_max3_u32 v13, v99, v100, v101
v_max3_u32 v12, v12, v102, v103
v_max3_u32 v13, v13, v104, v105
v_max3_u32 v12, v12, v106, v107
v_max3_u32 v13, v13, v108, v109
v_max3_u32 v12, v12, v110, v111
v_max_u32 v12, v12, v13
v_cmp_le_u32 vcc, 0xff800000, v12
s_cbranch_vccnz Lxsl1
s_branch Lxback1
Lxspin2:
s_mov_b32 s83, 262144
Lxsl2:
buffer_load_dwordx4 v[80:83], v1, s[44:47], s82 offen sc1
buffer_load_dwordx4 v[84:87], v1, s[44:47], s82 offen offset:1024 sc1
buffer_load_dwordx4 v[88:91], v1, s[44:47], s82 offen offset:2048 sc1
buffer_load_dwordx4 v[92:95], v1, s[44:47], s82 offen offset:3072 sc1
s_sub_u32 s83, s83, 1
s_cmp_eq_u32 s83, 0
s_waitcnt vmcnt(0)
s_cbranch_scc1 Lxback2
v_max3_u32 v12, v80, v81, v82
v_max3_u32 v13, v83, v84, v85
v_max3_u32 v12, v12, v86, v87
v_max3_u32 v13, v13, v88, v89
v_max3_u32 v12, v12, v90, v91
v_max3_u32 v13, v13, v92, v93
v_max3_u32 v12, v12, v94, v95
v_max_u32 v12, v12, v13
v_cmp_le_u32 vcc, 0xff800000, v12
s_cbranch_vccnz Lxsl2
s_branch Lxback2
Lxspin3:
s_mov_b32 s83, 262144
Lxsl3:
buffer_load_dwordx4 v[96:99], v1, s[44:47], s81 offen sc1
buffer_load_dwordx4 v[100:103], v1, s[44:47], s81 offen offset:1024 sc1
buffer_load_dwordx4 v[104:107], v1, s[44:47], s81 offen offset:2048 sc1
buffer_load_dwordx4 v[108:111], v1, s[44:47], s81 offen offset:3072 sc1
s_sub_u32 s83, s83, 1
s_cmp_eq_u32 s83, 0
s_waitcnt vmcnt(0)
s_cbranch_scc1 Lxback3
v_max3_u32 v12, v96, v97, v98
v_max3_u32 v13, v99, v100, v101
v_max3_u32 v12, v12, v102, v103
v_max3_u32 v13, v13, v104, v105
v_max3_u32 v12, v12, v106, v107
v_max3_u32 v13, v13, v108, v109
v_max3_u32 v12, v12, v110, v111
v_max_u32 v12, v12, v13
v_cmp_le_u32 vcc, 0xff800000, v12
s_cbranch_vccnz Lxsl3
s_branch Lxback3
Lcode_end:
s_endpgm
.section .rodata,"a"
.p2align 6
.amdhsa_kernel gated_mix__compressed_kv_cla__ssm_conv_h3__prompt_kernel
  .amdhsa_next_free_vgpr 512
  .amdhsa_next_free_sgpr 102
  .amdhsa_accum_offset 256
  .amdhsa_group_segment_fixed_size 0
  .amdhsa_kernarg_size 128
  .amdhsa_user_sgpr_count 2
  .amdhsa_user_sgpr_kernarg_segment_ptr 1
  .amdhsa_system_sgpr_workgroup_id_x 1
  .amdhsa_float_denorm_mode_32 3
.end_amdhsa_kernel
```

```asm
; @launch grid=(256,1,1) block=(256,1,1) lds=163840
.amdgcn_target "amdgcn-amd-amdhsa--gfx950"
.text
.globl gated_mix__compressed_kv_cla__ssm_conv_h3__prompt_kernel
.p2align 8
.type gated_mix__compressed_kv_cla__ssm_conv_h3__prompt_kernel,@function
gated_mix__compressed_kv_cla__ssm_conv_h3__prompt_kernel:
s_cmp_ge_u32 s2, 256
s_cbranch_scc1 Lend
s_load_dwordx2 s[8:9], s[0:1], 8
s_load_dwordx2 s[16:17], s[0:1], 24
s_load_dwordx2 s[20:21], s[0:1], 32
s_load_dwordx2 s[4:5], s[0:1], 0
s_load_dwordx2 s[12:13], s[0:1], 16
s_load_dwordx2 s[24:25], s[0:1], 40
s_load_dwordx2 s[28:29], s[0:1], 56
s_load_dwordx2 s[32:33], s[0:1], 64
s_load_dwordx2 s[52:53], s[0:1], 72
s_load_dwordx2 s[36:37], s[0:1], 80
s_load_dwordx2 s[54:55], s[0:1], 88
s_load_dwordx2 s[56:57], s[0:1], 96
s_load_dwordx2 s[40:41], s[0:1], 104
s_load_dwordx2 s[48:49], s[0:1], 112
s_load_dwordx2 s[44:45], s[0:1], 120
s_getpc_b64 s[98:99]
Lpc0:
s_lshr_b32 s75, s2, 3
v_lshrrev_b32 v26, 3, v0
s_lshl_b32 s73, s75, 12
v_lshlrev_b32 v26, 7, v26
v_add_u32 v26, s73, v26
v_min_u32 v26, Lcode_end-Lpc0, v26
global_load_dword v31, v26, s[98:99]
v_lshrrev_b32 v26, 6, v0
v_and_b32 v0, 63, v0
s_and_b32 s73, s2, 7
v_readfirstlane_b32 s58, v26
s_lshr_b32 s65, s75, 3
s_and_b32 s60, s75, 7
s_lshl_b32 s59, s73, 2
s_add_u32 s59, s59, s65
s_lshl_b32 s61, s65, 1
s_lshl_b32 s63, s58, 13
s_lshl_b32 s64, s58, 12
s_lshl_b32 s67, s60, 18
s_lshl_b32 s76, s58, 16
s_add_u32 s84, s67, s76
s_lshl_b32 s66, s58, 17
s_lshl_b32 s73, s59, 8
s_add_u32 s66, s66, s73
v_lshrrev_b32 v26, 4, v0
v_and_b32 v27, 7, v0
v_xor_b32 v27, v27, v26
v_lshlrev_b32 v27, 4, v27
v_lshrrev_b32 v28, 3, v0
v_lshl_add_u32 v2, v28, 10, v27
v_xor_b32 v3, 64, v2
v_and_b32 v29, 15, v0
v_lshlrev_b32 v30, 1, v26
v_xor_b32 v30, v30, v29
v_lshlrev_b32 v30, 4, v30
v_lshl_add_u32 v6, v26, 13, v30
v_xor_b32 v7, 0x80, v6
s_mov_b32 s10, 0x200000
s_mov_b32 s11, 0x20000
s_mov_b32 s18, 0x400000
s_mov_b32 s19, 0x20000
s_mov_b32 s22, 0x400000
s_mov_b32 s23, 0x20000
s_lshl_b32 s73, s2, 2
s_add_u32 s73, s73, s58
s_lshl_b32 s73, s73, 11
v_lshrrev_b32 v124, 2, v0
v_lshlrev_b32 v124, 7, v124
v_add_u32 v124, s73, v124
s_lshl_b32 s73, s60, 2
s_add_u32 s73, s73, s58
s_lshl_b32 s73, s73, 13
s_lshl_b32 s74, s59, 8
s_add_u32 s73, s73, s74
v_lshrrev_b32 v125, 4, v0
v_lshlrev_b32 v125, 18, v125
v_bfe_u32 v126, v0, 3, 1
v_lshl_add_u32 v125, v126, 7, v125
v_add_u32 v125, s73, v125
s_waitcnt lgkmcnt(0)
s_mov_b32 s80, 0x0
buffer_load_dword v126, v125, s[16:19], s80 offen nt
buffer_load_dword v126, v125, s[16:19], s80 offen sc1
buffer_load_dword v126, v125, s[20:23], s80 offen nt
buffer_load_dword v126, v125, s[20:23], s80 offen sc1
s_and_b32 s73, s65, 1
s_xor_b32 s73, s73, 0
s_lshl_b32 s69, s73, 7
s_add_u32 s69, s69, s84
s_lshl_b32 s71, s73, 19
s_add_u32 s71, s71, s66
s_add_u32 m0, s63, 65536
s_add_u32 s72, s69, 0
buffer_load_dwordx4 v2, s[8:11], s72 offen lds
s_add_u32 s72, s69, 7168
buffer_load_dwordx4 v3, s[8:11], s72 offen offset:1024 lds
s_add_u32 s72, s69, 14336
buffer_load_dwordx4 v2, s[8:11], s72 offen offset:2048 lds
s_add_u32 s72, s69, 21504
buffer_load_dwordx4 v3, s[8:11], s72 offen offset:3072 lds
s_add_u32 m0, s64, 0
s_add_u32 s72, s71, 0
buffer_load_dwordx4 v6, s[16:19], s72 offen nt lds
s_add_u32 s72, s71, 31744
buffer_load_dwordx4 v6, s[16:19], s72 offen offset:1024 nt lds
s_add_u32 s72, s71, 63488
buffer_load_dwordx4 v7, s[16:19], s72 offen offset:2048 nt lds
s_add_u32 s72, s71, 95232
buffer_load_dwordx4 v7, s[16:19], s72 offen offset:3072 nt lds
s_add_u32 m0, s63, 69632
s_add_u32 s72, s69, 32768
buffer_load_dwordx4 v2, s[8:11], s72 offen lds
s_add_u32 s72, s69, 39936
buffer_load_dwordx4 v3, s[8:11], s72 offen offset:1024 lds
s_add_u32 s72, s69, 47104
buffer_load_dwordx4 v2, s[8:11], s72 offen offset:2048 lds
s_add_u32 s72, s69, 54272
buffer_load_dwordx4 v3, s[8:11], s72 offen offset:3072 lds
s_add_u32 m0, s64, 16384
s_add_u32 s72, s71, 0
buffer_load_dwordx4 v6, s[20:23], s72 offen nt lds
s_add_u32 s72, s71, 31744
buffer_load_dwordx4 v6, s[20:23], s72 offen offset:1024 nt lds
s_add_u32 s72, s71, 63488
buffer_load_dwordx4 v7, s[20:23], s72 offen offset:2048 nt lds
s_add_u32 s72, s71, 95232
buffer_load_dwordx4 v7, s[20:23], s72 offen offset:3072 nt lds
buffer_load_dword v126, v124, s[8:11], 0 offen
s_and_b32 s73, s65, 1
s_xor_b32 s73, s73, 1
s_lshl_b32 s69, s73, 7
s_add_u32 s69, s69, s84
s_lshl_b32 s71, s73, 19
s_add_u32 s71, s71, s66
s_add_u32 m0, s63, 98304
s_add_u32 s72, s69, 0
buffer_load_dwordx4 v2, s[8:11], s72 offen lds
s_add_u32 s72, s69, 7168
buffer_load_dwordx4 v3, s[8:11], s72 offen offset:1024 lds
s_add_u32 s72, s69, 14336
buffer_load_dwordx4 v2, s[8:11], s72 offen offset:2048 lds
s_add_u32 s72, s69, 21504
buffer_load_dwordx4 v3, s[8:11], s72 offen offset:3072 lds
s_branch Lmain
.p2align 12
Lmain:
s_mov_b32 s6, 0x400000
s_mov_b32 s7, 0x20000
s_mov_b32 s14, 0x800000
s_mov_b32 s15, 0x20000
s_mov_b32 s26, 0x800000
s_mov_b32 s27, 0x20000
s_mov_b32 s30, 0x400000
s_mov_b32 s31, 0x20000
s_mov_b32 s34, 0x400000
s_mov_b32 s35, 0x20000
s_mov_b32 s38, 0x400000
s_mov_b32 s39, 0x20000
s_mov_b32 s42, 0x400000
s_mov_b32 s43, 0x20000
s_mov_b32 s46, 0x5800000
s_mov_b32 s47, 0x20000
s_mov_b32 s50, 0x100
s_mov_b32 s51, 0x20000
v_lshl_add_u32 v4, v28, 11, v27
v_xor_b32 v5, 64, v4
v_lshlrev_b32 v1, 4, v0
s_sub_u32 s74, 15, s60
s_lshl_b32 s68, s74, 18
s_lshl_b32 s76, s58, 15
s_add_u32 s68, s68, s76
s_add_u32 s67, s67, s76
s_and_b32 s62, s60, 3
s_sub_u32 s62, 16, s62
s_lshl_b32 s91, s59, 3
s_add_u32 s91, s91, s60
s_lshl_b32 s93, s91, 2
s_add_u32 s93, s93, s58
s_lshl_b32 s91, s91, 7
s_add_u32 s91, s91, 0x3810000
s_lshl_b32 s75, s93, 1
s_and_b32 s75, s75, 0xffc
s_lshl_b32 s93, s93, 12
s_load_dwordx2 s[88:89], s[36:37], s93
s_load_dword s90, s[54:55], s75
v_or_b32 v29, s58, v0
v_mov_b32 v30, 0
v_min_u32 v29, 1, v29
v_lshlrev_b32 v29, 30, v29
buffer_store_dword v30, v29, s[44:47], s91 offen sc1
s_and_b32 s73, s2, 15
s_lshr_b32 s74, s2, 4
s_lshl_b32 s74, s74, 7
s_lshl_b32 s75, s58, 5
s_add_u32 s74, s74, s75
s_mov_b32 s75, 131072
v_lshrrev_b32 v29, 5, v0
v_lshlrev_b32 v29, 4, v29
v_add_u32 v29, s74, v29
v_and_b32 v30, 31, v0
s_lshl_b32 s73, s73, 5
v_add_u32 v30, s73, v30
v_lshlrev_b32 v26, 11, v29
v_lshl_add_u32 v26, v30, 2, v26
v_subrev_u32 v27, 0x1800, v26
s_lshl_b32 s82, s74, 11
s_lshl_b32 s73, s73, 2
s_add_u32 s82, s82, s73
v_lshrrev_b32 v26, 3, v0
v_and_b32 v32, 7, v0
v_lshlrev_b32 v32, 4, v32
v_lshl_add_u32 v26, v26, 11, v32
v_lshrrev_b32 v98, 5, v0
v_lshlrev_b32 v98, 11, v98
v_and_b32 v32, 31, v0
v_lshl_add_u32 v98, v32, 2, v98
v_add_u32 v98, s63, v98
v_add_u32 v98, s75, v98
v_and_b32 v29, 0x7f, v29
v_sub_u32 v29, 0x70, v29
v_lshlrev_b32 v29, 1, v29
v_and_b32 v32, 31, v0
v_mul_u32_u24 v32, 544, v32
v_add3_u32 v28, v32, v29, s75
v_lshlrev_b32 v30, 4, v30
s_lshl_b32 s73, s2, 14
s_lshl_b32 s74, s58, 12
s_add_u32 s76, s73, s74
v_and_b32 v29, 15, v0
v_lshrrev_b32 v32, 4, v0
v_lshrrev_b32 v24, 1, v29
v_xor_b32 v24, v24, v32
v_lshlrev_b32 v24, 4, v24
v_lshl_add_u32 v24, v29, 7, v24
s_add_u32 s73, s63, 131072
v_add_u32 v16, s73, v24
v_xor_b32 v17, 64, v16
v_subrev_u32 v18, 0x10000, v16
v_subrev_u32 v19, 0x10000, v17
s_lshr_b32 s73, s58, 1
s_lshl_b32 s74, s73, 14
s_add_u32 s74, s74, 0x10000
v_add_u32 v24, s74, v24
v_xor_b32 v25, 64, v24
v_lshrrev_b32 v8, 2, v29
v_and_b32 v9, 1, v32
v_lshl_add_u32 v9, v9, 2, v8
v_lshl_add_u32 v8, v32, 3, v8
v_lshlrev_b32 v8, 8, v8
v_lshl_add_u32 v8, v9, 5, v8
v_and_b32 v29, 3, v0
v_lshl_add_u32 v8, v29, 3, v8
s_and_b32 s74, s58, 1
s_lshl_b32 s75, s74, 7
v_xor_b32 v20, s75, v8
v_xor_b32 v9, 32, v8
v_xor_b32 v10, 64, v8
v_xor_b32 v11, 96, v8
v_xor_b32 v12, 128, v8
v_xor_b32 v13, 160, v8
v_xor_b32 v14, 192, v8
v_xor_b32 v15, 224, v8
v_xor_b32 v21, 32, v20
v_xor_b32 v22, 64, v20
v_xor_b32 v23, 96, v20
s_lshl_b32 s77, s59, 20
s_add_u32 s81, s77, s64
s_sub_u32 s81, s81, 0x4000
s_lshl_b32 s75, s60, 17
s_add_u32 s77, s77, s75
s_lshl_b32 s73, s73, 16
s_add_u32 s77, s77, s73
s_lshl_b32 s75, s74, 12
s_add_u32 s78, s77, s75
s_add_u32 s78, s78, 0x4000
s_lshl_b32 s75, s74, 11
s_add_u32 s77, s77, s75
s_mov_b32 s79, 0x3e0293ee
s_waitcnt vmcnt(6)
s_barrier
ds_read_b64_tr_b16 v[224:225], v20 offset:0
ds_read_b64_tr_b16 v[226:227], v20 offset:1024
ds_read_b64_tr_b16 v[228:229], v20 offset:8192
ds_read_b64_tr_b16 v[230:231], v20 offset:9216
ds_read_b128 v[128:131], v24 offset:0
ds_read_b128 v[132:135], v25 offset:0
ds_read_b128 v[136:139], v24 offset:2048
ds_read_b128 v[140:143], v25 offset:2048
ds_read_b128 v[144:147], v24 offset:4096
ds_read_b128 v[148:151], v25 offset:4096
ds_read_b128 v[152:155], v24 offset:6144
ds_read_b128 v[156:159], v25 offset:6144
ds_read_b128 v[160:163], v24 offset:8192
ds_read_b128 v[164:167], v25 offset:8192
ds_read_b128 v[168:171], v24 offset:10240
ds_read_b128 v[172:175], v25 offset:10240
ds_read_b128 v[176:179], v24 offset:12288
ds_read_b128 v[180:183], v25 offset:12288
ds_read_b128 v[184:187], v24 offset:14336
ds_read_b128 v[188:191], v25 offset:14336
ds_read_b64_tr_b16 v[232:233], v21 offset:0
ds_read_b64_tr_b16 v[234:235], v21 offset:1024
ds_read_b64_tr_b16 v[236:237], v21 offset:8192
ds_read_b64_tr_b16 v[238:239], v21 offset:9216
s_waitcnt lgkmcnt(0)
v_mfma_f32_16x16x32_bf16 a[0:3], v[224:227], v[128:131], 0
s_add_u32 m0, s64, 32768
ds_read_b64_tr_b16 v[240:241], v22 offset:0
v_mfma_f32_16x16x32_bf16 a[0:3], v[228:231], v[132:135], a[0:3]
s_add_u32 s72, s71, 0
buffer_load_dwordx4 v6, s[16:19], s72 offen lds
v_mfma_f32_16x16x32_bf16 a[4:7], v[228:231], v[140:143], 0
s_add_u32 s72, s71, 31744
buffer_load_dwordx4 v6, s[16:19], s72 offen offset:1024 lds
v_mfma_f32_16x16x32_bf16 a[4:7], v[224:227], v[136:139], a[4:7]
ds_read_b64_tr_b16 v[242:243], v22 offset:1024
v_mfma_f32_16x16x32_bf16 a[8:11], v[224:227], v[144:147], 0
s_add_u32 s72, s71, 63488
buffer_load_dwordx4 v7, s[16:19], s72 offen offset:2048 lds
v_mfma_f32_16x16x32_bf16 a[8:11], v[228:231], v[148:151], a[8:11]
v_mfma_f32_16x16x32_bf16 a[12:15], v[228:231], v[156:159], 0
s_add_u32 s72, s71, 95232
buffer_load_dwordx4 v7, s[16:19], s72 offen offset:3072 lds
v_mfma_f32_16x16x32_bf16 a[12:15], v[224:227], v[152:155], a[12:15]
ds_read_b64_tr_b16 v[244:245], v22 offset:8192
v_mfma_f32_16x16x32_bf16 a[16:19], v[224:227], v[160:163], 0
s_add_u32 m0, s63, 102400
v_mfma_f32_16x16x32_bf16 a[16:19], v[228:231], v[164:167], a[16:19]
s_add_u32 s72, s69, 32768
buffer_load_dwordx4 v2, s[8:11], s72 offen lds
v_mfma_f32_16x16x32_bf16 a[20:23], v[228:231], v[172:175], 0
s_add_u32 s72, s69, 39936
buffer_load_dwordx4 v3, s[8:11], s72 offen offset:1024 lds
v_mfma_f32_16x16x32_bf16 a[20:23], v[224:227], v[168:171], a[20:23]
ds_read_b64_tr_b16 v[246:247], v22 offset:9216
v_mfma_f32_16x16x32_bf16 a[24:27], v[224:227], v[176:179], 0
s_add_u32 s72, s69, 47104
buffer_load_dwordx4 v2, s[8:11], s72 offen offset:2048 lds
v_mfma_f32_16x16x32_bf16 a[24:27], v[228:231], v[180:183], a[24:27]
v_mfma_f32_16x16x32_bf16 a[28:31], v[228:231], v[188:191], 0
s_add_u32 s72, s69, 54272
buffer_load_dwordx4 v3, s[8:11], s72 offen offset:3072 lds
v_mfma_f32_16x16x32_bf16 a[28:31], v[224:227], v[184:187], a[28:31]
v_mfma_f32_16x16x32_bf16 a[60:63], v[232:235], v[184:187], 0
s_add_u32 m0, s64, 49152
ds_read_b64_tr_b16 v[248:249], v23 offset:0
v_mfma_f32_16x16x32_bf16 a[60:63], v[236:239], v[188:191], a[60:63]
s_add_u32 s72, s71, 0
buffer_load_dwordx4 v6, s[20:23], s72 offen lds
v_mfma_f32_16x16x32_bf16 a[56:59], v[236:239], v[180:183], 0
s_add_u32 s72, s71, 31744
buffer_load_dwordx4 v6, s[20:23], s72 offen offset:1024 lds
v_mfma_f32_16x16x32_bf16 a[56:59], v[232:235], v[176:179], a[56:59]
ds_read_b64_tr_b16 v[250:251], v23 offset:1024
v_mfma_f32_16x16x32_bf16 a[52:55], v[232:235], v[168:171], 0
s_add_u32 s72, s71, 63488
buffer_load_dwordx4 v7, s[20:23], s72 offen offset:2048 lds
v_mfma_f32_16x16x32_bf16 a[52:55], v[236:239], v[172:175], a[52:55]
v_mfma_f32_16x16x32_bf16 a[48:51], v[236:239], v[164:167], 0
s_add_u32 s72, s71, 95232
buffer_load_dwordx4 v7, s[20:23], s72 offen offset:3072 lds
v_mfma_f32_16x16x32_bf16 a[48:51], v[232:235], v[160:163], a[48:51]
s_mov_b32 s80, 0x100000
buffer_load_dword v126, v125, s[16:19], s80 offen nt
v_mfma_f32_16x16x32_bf16 a[44:47], v[232:235], v[152:155], 0
buffer_load_dword v126, v125, s[16:19], s80 offen sc1
v_mfma_f32_16x16x32_bf16 a[44:47], v[236:239], v[156:159], a[44:47]
buffer_load_dword v126, v125, s[20:23], s80 offen nt
v_mfma_f32_16x16x32_bf16 a[40:43], v[236:239], v[148:151], 0
buffer_load_dword v126, v125, s[20:23], s80 offen sc1
v_mfma_f32_16x16x32_bf16 a[40:43], v[232:235], v[144:147], a[40:43]
ds_read_b64_tr_b16 v[252:253], v23 offset:8192
v_mfma_f32_16x16x32_bf16 a[36:39], v[232:235], v[136:139], 0
ds_read_b64_tr_b16 v[254:255], v23 offset:9216
v_mfma_f32_16x16x32_bf16 a[36:39], v[236:239], v[140:143], a[36:39]
v_mfma_f32_16x16x32_bf16 a[32:35], v[236:239], v[132:135], 0
v_mfma_f32_16x16x32_bf16 a[32:35], v[232:235], v[128:131], a[32:35]
s_waitcnt lgkmcnt(4)
v_mfma_f32_16x16x32_bf16 a[64:67], v[240:243], v[128:131], 0
ds_read_b64_tr_b16 v[224:225], v20 offset:16384
v_mfma_f32_16x16x32_bf16 a[64:67], v[244:247], v[132:135], a[64:67]
v_mfma_f32_16x16x32_bf16 a[68:71], v[244:247], v[140:143], 0
v_mfma_f32_16x16x32_bf16 a[68:71], v[240:243], v[136:139], a[68:71]
ds_read_b64_tr_b16 v[226:227], v20 offset:17408
v_mfma_f32_16x16x32_bf16 a[72:75], v[240:243], v[144:147], 0
v_mfma_f32_16x16x32_bf16 a[72:75], v[244:247], v[148:151], a[72:75]
v_mfma_f32_16x16x32_bf16 a[76:79], v[244:247], v[156:159], 0
v_mfma_f32_16x16x32_bf16 a[76:79], v[240:243], v[152:155], a[76:79]
ds_read_b64_tr_b16 v[228:229], v20 offset:24576
v_mfma_f32_16x16x32_bf16 a[80:83], v[240:243], v[160:163], 0
v_mfma_f32_16x16x32_bf16 a[80:83], v[244:247], v[164:167], a[80:83]
v_mfma_f32_16x16x32_bf16 a[84:87], v[244:247], v[172:175], 0
ds_read_b64_tr_b16 v[230:231], v20 offset:25600
v_mfma_f32_16x16x32_bf16 a[84:87], v[240:243], v[168:171], a[84:87]
v_mfma_f32_16x16x32_bf16 a[88:91], v[240:243], v[176:179], 0
v_mfma_f32_16x16x32_bf16 a[88:91], v[244:247], v[180:183], a[88:91]
v_mfma_f32_16x16x32_bf16 a[92:95], v[244:247], v[188:191], 0
v_mfma_f32_16x16x32_bf16 a[92:95], v[240:243], v[184:187], a[92:95]
s_waitcnt lgkmcnt(4)
v_mfma_f32_16x16x32_bf16 a[124:127], v[248:251], v[184:187], 0
ds_read_b64_tr_b16 v[232:233], v21 offset:16384
v_mfma_f32_16x16x32_bf16 a[124:127], v[252:255], v[188:191], a[124:127]
v_mfma_f32_16x16x32_bf16 a[120:123], v[252:255], v[180:183], 0
v_mfma_f32_16x16x32_bf16 a[120:123], v[248:251], v[176:179], a[120:123]
ds_read_b64_tr_b16 v[234:235], v21 offset:17408
v_mfma_f32_16x16x32_bf16 a[116:119], v[248:251], v[168:171], 0
v_mfma_f32_16x16x32_bf16 a[116:119], v[252:255], v[172:175], a[116:119]
v_mfma_f32_16x16x32_bf16 a[112:115], v[252:255], v[164:167], 0
v_mfma_f32_16x16x32_bf16 a[112:115], v[248:251], v[160:163], a[112:115]
ds_read_b64_tr_b16 v[236:237], v21 offset:24576
v_mfma_f32_16x16x32_bf16 a[108:111], v[248:251], v[152:155], 0
v_mfma_f32_16x16x32_bf16 a[108:111], v[252:255], v[156:159], a[108:111]
v_mfma_f32_16x16x32_bf16 a[104:107], v[252:255], v[148:151], 0
ds_read_b64_tr_b16 v[238:239], v21 offset:25600
v_mfma_f32_16x16x32_bf16 a[104:107], v[248:251], v[144:147], a[104:107]
v_mfma_f32_16x16x32_bf16 a[100:103], v[248:251], v[136:139], 0
v_mfma_f32_16x16x32_bf16 a[100:103], v[252:255], v[140:143], a[100:103]
v_mfma_f32_16x16x32_bf16 a[96:99], v[252:255], v[132:135], 0
v_mfma_f32_16x16x32_bf16 a[96:99], v[248:251], v[128:131], a[96:99]
s_waitcnt lgkmcnt(4)
v_mfma_f32_16x16x32_bf16 a[128:131], v[128:131], v[224:227], 0
ds_read_b64_tr_b16 v[240:241], v22 offset:16384
v_mfma_f32_16x16x32_bf16 a[128:131], v[132:135], v[228:231], a[128:131]
v_mfma_f32_16x16x32_bf16 a[132:135], v[140:143], v[228:231], 0
v_mfma_f32_16x16x32_bf16 a[132:135], v[136:139], v[224:227], a[132:135]
ds_read_b64_tr_b16 v[242:243], v22 offset:17408
v_mfma_f32_16x16x32_bf16 a[136:139], v[144:147], v[224:227], 0
v_mfma_f32_16x16x32_bf16 a[136:139], v[148:151], v[228:231], a[136:139]
v_mfma_f32_16x16x32_bf16 a[140:143], v[156:159], v[228:231], 0
v_mfma_f32_16x16x32_bf16 a[140:143], v[152:155], v[224:227], a[140:143]
ds_read_b64_tr_b16 v[244:245], v22 offset:24576
v_mfma_f32_16x16x32_bf16 a[144:147], v[160:163], v[224:227], 0
v_mfma_f32_16x16x32_bf16 a[144:147], v[164:167], v[228:231], a[144:147]
v_mfma_f32_16x16x32_bf16 a[148:151], v[172:175], v[228:231], 0
ds_read_b64_tr_b16 v[246:247], v22 offset:25600
v_mfma_f32_16x16x32_bf16 a[148:151], v[168:171], v[224:227], a[148:151]
v_mfma_f32_16x16x32_bf16 a[152:155], v[176:179], v[224:227], 0
v_mfma_f32_16x16x32_bf16 a[152:155], v[180:183], v[228:231], a[152:155]
v_mfma_f32_16x16x32_bf16 a[156:159], v[188:191], v[228:231], 0
v_mfma_f32_16x16x32_bf16 a[156:159], v[184:187], v[224:227], a[156:159]
s_waitcnt lgkmcnt(4)
v_mfma_f32_16x16x32_bf16 a[188:191], v[184:187], v[232:235], 0
ds_read_b64_tr_b16 v[248:249], v23 offset:16384
v_mfma_f32_16x16x32_bf16 a[188:191], v[188:191], v[236:239], a[188:191]
v_mfma_f32_16x16x32_bf16 a[184:187], v[180:183], v[236:239], 0
ds_read_b64_tr_b16 v[250:251], v23 offset:17408
v_mfma_f32_16x16x32_bf16 a[184:187], v[176:179], v[232:235], a[184:187]
v_mfma_f32_16x16x32_bf16 a[180:183], v[168:171], v[232:235], 0
ds_read_b64_tr_b16 v[252:253], v23 offset:24576
v_mfma_f32_16x16x32_bf16 a[180:183], v[172:175], v[236:239], a[180:183]
v_mfma_f32_16x16x32_bf16 a[176:179], v[164:167], v[236:239], 0
ds_read_b64_tr_b16 v[254:255], v23 offset:25600
v_mfma_f32_16x16x32_bf16 a[176:179], v[160:163], v[232:235], a[176:179]
v_mfma_f32_16x16x32_bf16 a[172:175], v[152:155], v[232:235], 0
v_mfma_f32_16x16x32_bf16 a[172:175], v[156:159], v[236:239], a[172:175]
v_mfma_f32_16x16x32_bf16 a[168:171], v[148:151], v[236:239], 0
v_mfma_f32_16x16x32_bf16 a[168:171], v[144:147], v[232:235], a[168:171]
v_mfma_f32_16x16x32_bf16 a[164:167], v[136:139], v[232:235], 0
v_mfma_f32_16x16x32_bf16 a[164:167], v[140:143], v[236:239], a[164:167]
s_nop 3
s_mov_b64 exec, 0
s_cmp_eq_u32 s58, 0
s_cbranch_scc1 Lstub0
s_cmp_eq_u32 s58, 1
s_cbranch_scc1 Lstub1
s_cmp_eq_u32 s58, 2
s_cbranch_scc1 Lstub2
s_branch Lstub3
Lret:
s_mov_b64 exec, -1
s_nop 3
v_mfma_f32_16x16x32_bf16 a[160:163], v[132:135], v[236:239], 0
s_waitcnt vmcnt(4) lgkmcnt(0)
v_mfma_f32_16x16x32_bf16 a[160:163], v[128:131], v[232:235], a[160:163]
s_barrier
v_mfma_f32_16x16x32_bf16 a[192:195], v[128:131], v[240:243], 0
s_and_b32 s73, s65, 1
ds_read_b64_tr_b16 v[224:225], v20 offset:32768
v_mfma_f32_16x16x32_bf16 a[192:195], v[132:135], v[244:247], a[192:195]
s_xor_b32 s73, s73, 2
ds_read_b64_tr_b16 v[226:227], v20 offset:33792
v_mfma_f32_16x16x32_bf16 a[196:199], v[140:143], v[244:247], 0
s_lshl_b32 s69, s73, 7
ds_read_b64_tr_b16 v[228:229], v20 offset:40960
v_mfma_f32_16x16x32_bf16 a[196:199], v[136:139], v[240:243], a[196:199]
s_add_u32 s69, s69, s84
ds_read_b64_tr_b16 v[230:231], v20 offset:41984
v_mfma_f32_16x16x32_bf16 a[200:203], v[144:147], v[240:243], 0
s_lshl_b32 s71, s73, 19
ds_read_b128 v[192:195], v24 offset:32768
v_mfma_f32_16x16x32_bf16 a[200:203], v[148:151], v[244:247], a[200:203]
s_add_u32 s71, s71, s66
ds_read_b128 v[196:199], v25 offset:32768
v_mfma_f32_16x16x32_bf16 a[204:207], v[156:159], v[244:247], 0
s_add_u32 m0, s63, 65536
v_mfma_f32_16x16x32_bf16 a[204:207], v[152:155], v[240:243], a[204:207]
s_add_u32 s72, s69, 0
buffer_load_dwordx4 v2, s[8:11], s72 offen lds
v_mfma_f32_16x16x32_bf16 a[208:211], v[160:163], v[240:243], 0
s_add_u32 s72, s69, 7168
buffer_load_dwordx4 v3, s[8:11], s72 offen offset:1024 lds
v_mfma_f32_16x16x32_bf16 a[208:211], v[164:167], v[244:247], a[208:211]
s_add_u32 s72, s69, 14336
buffer_load_dwordx4 v2, s[8:11], s72 offen offset:2048 lds
v_mfma_f32_16x16x32_bf16 a[212:215], v[172:175], v[244:247], 0
ds_read_b128 v[200:203], v24 offset:34816
v_mfma_f32_16x16x32_bf16 a[212:215], v[168:171], v[240:243], a[212:215]
ds_read_b128 v[204:207], v25 offset:34816
v_mfma_f32_16x16x32_bf16 a[216:219], v[176:179], v[240:243], 0
s_add_u32 s72, s69, 21504
buffer_load_dwordx4 v3, s[8:11], s72 offen offset:3072 lds
v_mfma_f32_16x16x32_bf16 a[216:219], v[180:183], v[244:247], a[216:219]
ds_read_b128 v[208:211], v24 offset:36864
v_mfma_f32_16x16x32_bf16 a[220:223], v[188:191], v[244:247], 0
ds_read_b128 v[212:215], v25 offset:36864
v_mfma_f32_16x16x32_bf16 a[220:223], v[184:187], v[240:243], a[220:223]
ds_read_b128 v[216:219], v24 offset:38912
v_mfma_f32_16x16x32_bf16 a[252:255], v[184:187], v[248:251], 0
ds_read_b128 v[220:223], v25 offset:38912
v_mfma_f32_16x16x32_bf16 a[252:255], v[188:191], v[252:255], a[252:255]
s_add_u32 m0, s64, 0
v_mfma_f32_16x16x32_bf16 a[248:251], v[180:183], v[252:255], 0
s_add_u32 s72, s71, 0
buffer_load_dwordx4 v6, s[16:19], s72 offen lds
v_mfma_f32_16x16x32_bf16 a[248:251], v[176:179], v[248:251], a[248:251]
ds_read_b128 v[184:187], v24 offset:40960
v_mfma_f32_16x16x32_bf16 a[244:247], v[168:171], v[248:251], 0
ds_read_b128 v[188:191], v25 offset:40960
v_mfma_f32_16x16x32_bf16 a[244:247], v[172:175], v[252:255], a[244:247]
s_add_u32 s72, s71, 31744
buffer_load_dwordx4 v6, s[16:19], s72 offen offset:1024 lds
v_mfma_f32_16x16x32_bf16 a[240:243], v[164:167], v[252:255], 0
ds_read_b128 v[176:179], v24 offset:43008
v_mfma_f32_16x16x32_bf16 a[240:243], v[160:163], v[248:251], a[240:243]
ds_read_b128 v[180:183], v25 offset:43008
v_mfma_f32_16x16x32_bf16 a[236:239], v[152:155], v[248:251], 0
ds_read_b128 v[168:171], v24 offset:45056
v_mfma_f32_16x16x32_bf16 a[236:239], v[156:159], v[252:255], a[236:239]
s_add_u32 s72, s71, 63488
buffer_load_dwordx4 v7, s[16:19], s72 offen offset:2048 lds
v_mfma_f32_16x16x32_bf16 a[232:235], v[148:151], v[252:255], 0
ds_read_b128 v[172:175], v25 offset:45056
v_mfma_f32_16x16x32_bf16 a[232:235], v[144:147], v[248:251], a[232:235]
ds_read_b128 v[160:163], v24 offset:47104
v_mfma_f32_16x16x32_bf16 a[228:231], v[136:139], v[248:251], 0
ds_read_b128 v[164:167], v25 offset:47104
v_mfma_f32_16x16x32_bf16 a[228:231], v[140:143], v[252:255], a[228:231]
v_mfma_f32_16x16x32_bf16 a[224:227], v[132:135], v[252:255], 0
s_add_u32 s72, s71, 95232
buffer_load_dwordx4 v7, s[16:19], s72 offen offset:3072 lds
v_mfma_f32_16x16x32_bf16 a[224:227], v[128:131], v[248:251], a[224:227]
s_waitcnt lgkmcnt(8)
ds_read_b64_tr_b16 v[232:233], v21 offset:32768
v_mfma_f32_16x16x32_bf16 a[0:3], v[224:227], v[192:195], a[0:3]
ds_read_b64_tr_b16 v[234:235], v21 offset:33792
v_mfma_f32_16x16x32_bf16 a[0:3], v[228:231], v[196:199], a[0:3]
ds_read_b64_tr_b16 v[240:241], v22 offset:32768
v_mfma_f32_16x16x32_bf16 a[4:7], v[228:231], v[204:207], a[4:7]
s_add_u32 m0, s63, 69632
ds_read_b64_tr_b16 v[236:237], v21 offset:40960
v_mfma_f32_16x16x32_bf16 a[4:7], v[224:227], v[200:203], a[4:7]
s_add_u32 s72, s69, 32768
buffer_load_dwordx4 v2, s[8:11], s72 offen lds
v_mfma_f32_16x16x32_bf16 a[8:11], v[224:227], v[208:211], a[8:11]
ds_read_b64_tr_b16 v[238:239], v21 offset:41984
v_mfma_f32_16x16x32_bf16 a[8:11], v[228:231], v[212:215], a[8:11]
v_mfma_f32_16x16x32_bf16 a[12:15], v[228:231], v[220:223], a[12:15]
s_add_u32 s72, s69, 39936
buffer_load_dwordx4 v3, s[8:11], s72 offen offset:1024 lds
v_mfma_f32_16x16x32_bf16 a[12:15], v[224:227], v[216:219], a[12:15]
s_waitcnt lgkmcnt(5)
ds_read_b64_tr_b16 v[242:243], v22 offset:33792
v_mfma_f32_16x16x32_bf16 a[16:19], v[224:227], v[184:187], a[16:19]
v_mfma_f32_16x16x32_bf16 a[16:19], v[228:231], v[188:191], a[16:19]
ds_read_b64_tr_b16 v[244:245], v22 offset:40960
v_mfma_f32_16x16x32_bf16 a[20:23], v[228:231], v[180:183], a[20:23]
v_mfma_f32_16x16x32_bf16 a[20:23], v[224:227], v[176:179], a[20:23]
s_add_u32 s72, s69, 47104
buffer_load_dwordx4 v2, s[8:11], s72 offen offset:2048 lds
v_mfma_f32_16x16x32_bf16 a[24:27], v[224:227], v[168:171], a[24:27]
ds_read_b64_tr_b16 v[246:247], v22 offset:41984
v_mfma_f32_16x16x32_bf16 a[24:27], v[228:231], v[172:175], a[24:27]
v_mfma_f32_16x16x32_bf16 a[28:31], v[228:231], v[164:167], a[28:31]
v_mfma_f32_16x16x32_bf16 a[28:31], v[224:227], v[160:163], a[28:31]
s_waitcnt lgkmcnt(3)
v_mfma_f32_16x16x32_bf16 a[60:63], v[232:235], v[160:163], a[60:63]
s_add_u32 s72, s69, 54272
buffer_load_dwordx4 v3, s[8:11], s72 offen offset:3072 lds
v_mfma_f32_16x16x32_bf16 a[60:63], v[236:239], v[164:167], a[60:63]
ds_read_b64_tr_b16 v[248:249], v23 offset:32768
v_mfma_f32_16x16x32_bf16 a[56:59], v[236:239], v[172:175], a[56:59]
v_mfma_f32_16x16x32_bf16 a[56:59], v[232:235], v[168:171], a[56:59]
s_add_u32 m0, s64, 16384
ds_read_b64_tr_b16 v[250:251], v23 offset:33792
v_mfma_f32_16x16x32_bf16 a[52:55], v[232:235], v[176:179], a[52:55]
s_add_u32 s72, s71, 0
buffer_load_dwordx4 v6, s[20:23], s72 offen lds
v_mfma_f32_16x16x32_bf16 a[52:55], v[236:239], v[180:183], a[52:55]
v_mfma_f32_16x16x32_bf16 a[48:51], v[236:239], v[188:191], a[48:51]
v_mfma_f32_16x16x32_bf16 a[48:51], v[232:235], v[184:187], a[48:51]
ds_read_b64_tr_b16 v[252:253], v23 offset:40960
v_mfma_f32_16x16x32_bf16 a[44:47], v[232:235], v[216:219], a[44:47]
s_add_u32 s72, s71, 31744
buffer_load_dwordx4 v6, s[20:23], s72 offen offset:1024 lds
v_mfma_f32_16x16x32_bf16 a[44:47], v[236:239], v[220:223], a[44:47]
v_mfma_f32_16x16x32_bf16 a[40:43], v[236:239], v[212:215], a[40:43]
ds_read_b64_tr_b16 v[254:255], v23 offset:41984
v_mfma_f32_16x16x32_bf16 a[40:43], v[232:235], v[208:211], a[40:43]
v_mfma_f32_16x16x32_bf16 a[36:39], v[232:235], v[200:203], a[36:39]
s_add_u32 s72, s71, 63488
buffer_load_dwordx4 v7, s[20:23], s72 offen offset:2048 lds
v_mfma_f32_16x16x32_bf16 a[36:39], v[236:239], v[204:207], a[36:39]
v_mfma_f32_16x16x32_bf16 a[32:35], v[236:239], v[196:199], a[32:35]
v_mfma_f32_16x16x32_bf16 a[32:35], v[232:235], v[192:195], a[32:35]
s_waitcnt lgkmcnt(4)
v_mfma_f32_16x16x32_bf16 a[64:67], v[240:243], v[192:195], a[64:67]
s_add_u32 s72, s71, 95232
buffer_load_dwordx4 v7, s[20:23], s72 offen offset:3072 lds
ds_read_b64_tr_b16 v[224:225], v20 offset:49152
v_mfma_f32_16x16x32_bf16 a[64:67], v[244:247], v[196:199], a[64:67]
s_mov_b32 s80, 0x200000
buffer_load_dword v126, v125, s[16:19], s80 offen nt
v_mfma_f32_16x16x32_bf16 a[68:71], v[244:247], v[204:207], a[68:71]
buffer_load_dword v126, v125, s[16:19], s80 offen sc1
v_mfma_f32_16x16x32_bf16 a[68:71], v[240:243], v[200:203], a[68:71]
buffer_load_dword v126, v125, s[20:23], s80 offen nt
ds_read_b64_tr_b16 v[226:227], v20 offset:50176
v_mfma_f32_16x16x32_bf16 a[72:75], v[240:243], v[208:211], a[72:75]
buffer_load_dword v126, v125, s[20:23], s80 offen sc1
v_mfma_f32_16x16x32_bf16 a[72:75], v[244:247], v[212:215], a[72:75]
global_load_dwordx4 v[68:71], v30, s[52:53]
v_mfma_f32_16x16x32_bf16 a[76:79], v[244:247], v[220:223], a[76:79]
buffer_load_dword v33, v27, s[28:31], 0 offen nt
ds_read_b64_tr_b16 v[228:229], v20 offset:57344
v_mfma_f32_16x16x32_bf16 a[76:79], v[240:243], v[216:219], a[76:79]
buffer_load_dword v34, v27, s[28:31], 0 offen offset:2048 nt
v_mfma_f32_16x16x32_bf16 a[80:83], v[240:243], v[184:187], a[80:83]
v_add_u32 v27, 0x1000, v27
v_mfma_f32_16x16x32_bf16 a[80:83], v[244:247], v[188:191], a[80:83]
buffer_load_dword v35, v27, s[28:31], 0 offen nt
v_mfma_f32_16x16x32_bf16 a[84:87], v[244:247], v[180:183], a[84:87]
s_add_u32 m0, s63, 131072
ds_read_b64_tr_b16 v[230:231], v20 offset:58368
v_mfma_f32_16x16x32_bf16 a[84:87], v[240:243], v[176:179], a[84:87]
s_add_u32 s80, s82, 0
buffer_load_dwordx4 v26, s[28:31], s80 offen nt lds
v_mfma_f32_16x16x32_bf16 a[88:91], v[240:243], v[168:171], a[88:91]
s_add_u32 s80, s82, 15360
buffer_load_dwordx4 v26, s[28:31], s80 offen offset:1024 nt lds
v_mfma_f32_16x16x32_bf16 a[88:91], v[244:247], v[172:175], a[88:91]
s_add_u32 s80, s82, 30720
buffer_load_dwordx4 v26, s[28:31], s80 offen offset:2048 nt lds
v_mfma_f32_16x16x32_bf16 a[92:95], v[244:247], v[164:167], a[92:95]
s_add_u32 s80, s82, 46080
buffer_load_dwordx4 v26, s[28:31], s80 offen offset:3072 nt lds
v_mfma_f32_16x16x32_bf16 a[92:95], v[240:243], v[160:163], a[92:95]
s_waitcnt lgkmcnt(4)
v_mfma_f32_16x16x32_bf16 a[124:127], v[248:251], v[160:163], a[124:127]
ds_read_b64_tr_b16 v[232:233], v21 offset:49152
v_mfma_f32_16x16x32_bf16 a[124:127], v[252:255], v[164:167], a[124:127]
v_mfma_f32_16x16x32_bf16 a[120:123], v[252:255], v[172:175], a[120:123]
v_mfma_f32_16x16x32_bf16 a[120:123], v[248:251], v[168:171], a[120:123]
ds_read_b64_tr_b16 v[234:235], v21 offset:50176
v_mfma_f32_16x16x32_bf16 a[116:119], v[248:251], v[176:179], a[116:119]
v_mfma_f32_16x16x32_bf16 a[116:119], v[252:255], v[180:183], a[116:119]
v_mfma_f32_16x16x32_bf16 a[112:115], v[252:255], v[188:191], a[112:115]
v_mfma_f32_16x16x32_bf16 a[112:115], v[248:251], v[184:187], a[112:115]
ds_read_b64_tr_b16 v[236:237], v21 offset:57344
v_mfma_f32_16x16x32_bf16 a[108:111], v[248:251], v[216:219], a[108:111]
v_mfma_f32_16x16x32_bf16 a[108:111], v[252:255], v[220:223], a[108:111]
v_mfma_f32_16x16x32_bf16 a[104:107], v[252:255], v[212:215], a[104:107]
ds_read_b64_tr_b16 v[238:239], v21 offset:58368
v_mfma_f32_16x16x32_bf16 a[104:107], v[248:251], v[208:211], a[104:107]
v_mfma_f32_16x16x32_bf16 a[100:103], v[248:251], v[200:203], a[100:103]
v_mfma_f32_16x16x32_bf16 a[100:103], v[252:255], v[204:207], a[100:103]
v_mfma_f32_16x16x32_bf16 a[96:99], v[252:255], v[196:199], a[96:99]
v_mfma_f32_16x16x32_bf16 a[96:99], v[248:251], v[192:195], a[96:99]
s_waitcnt lgkmcnt(4)
v_mfma_f32_16x16x32_bf16 a[128:131], v[192:195], v[224:227], a[128:131]
ds_read_b64_tr_b16 v[240:241], v22 offset:49152
v_mfma_f32_16x16x32_bf16 a[128:131], v[196:199], v[228:231], a[128:131]
v_mfma_f32_16x16x32_bf16 a[132:135], v[204:207], v[228:231], a[132:135]
v_mfma_f32_16x16x32_bf16 a[132:135], v[200:203], v[224:227], a[132:135]
ds_read_b64_tr_b16 v[242:243], v22 offset:50176
v_mfma_f32_16x16x32_bf16 a[136:139], v[208:211], v[224:227], a[136:139]
v_mfma_f32_16x16x32_bf16 a[136:139], v[212:215], v[228:231], a[136:139]
v_mfma_f32_16x16x32_bf16 a[140:143], v[220:223], v[228:231], a[140:143]
v_mfma_f32_16x16x32_bf16 a[140:143], v[216:219], v[224:227], a[140:143]
ds_read_b64_tr_b16 v[244:245], v22 offset:57344
v_mfma_f32_16x16x32_bf16 a[144:147], v[184:187], v[224:227], a[144:147]
v_mfma_f32_16x16x32_bf16 a[144:147], v[188:191], v[228:231], a[144:147]
v_mfma_f32_16x16x32_bf16 a[148:151], v[180:183], v[228:231], a[148:151]
ds_read_b64_tr_b16 v[246:247], v22 offset:58368
v_mfma_f32_16x16x32_bf16 a[148:151], v[176:179], v[224:227], a[148:151]
v_mfma_f32_16x16x32_bf16 a[152:155], v[168:171], v[224:227], a[152:155]
v_mfma_f32_16x16x32_bf16 a[152:155], v[172:175], v[228:231], a[152:155]
v_mfma_f32_16x16x32_bf16 a[156:159], v[164:167], v[228:231], a[156:159]
v_mfma_f32_16x16x32_bf16 a[156:159], v[160:163], v[224:227], a[156:159]
s_waitcnt lgkmcnt(4)
v_mfma_f32_16x16x32_bf16 a[188:191], v[160:163], v[232:235], a[188:191]
ds_read_b64_tr_b16 v[248:249], v23 offset:49152
v_mfma_f32_16x16x32_bf16 a[188:191], v[164:167], v[236:239], a[188:191]
v_mfma_f32_16x16x32_bf16 a[184:187], v[172:175], v[236:239], a[184:187]
ds_read_b64_tr_b16 v[250:251], v23 offset:50176
v_mfma_f32_16x16x32_bf16 a[184:187], v[168:171], v[232:235], a[184:187]
v_mfma_f32_16x16x32_bf16 a[180:183], v[176:179], v[232:235], a[180:183]
ds_read_b64_tr_b16 v[252:253], v23 offset:57344
v_mfma_f32_16x16x32_bf16 a[180:183], v[180:183], v[236:239], a[180:183]
v_mfma_f32_16x16x32_bf16 a[176:179], v[188:191], v[236:239], a[176:179]
ds_read_b64_tr_b16 v[254:255], v23 offset:58368
v_mfma_f32_16x16x32_bf16 a[176:179], v[184:187], v[232:235], a[176:179]
v_mfma_f32_16x16x32_bf16 a[172:175], v[216:219], v[232:235], a[172:175]
v_mfma_f32_16x16x32_bf16 a[172:175], v[220:223], v[236:239], a[172:175]
v_mfma_f32_16x16x32_bf16 a[168:171], v[212:215], v[236:239], a[168:171]
v_mfma_f32_16x16x32_bf16 a[168:171], v[208:211], v[232:235], a[168:171]
v_mfma_f32_16x16x32_bf16 a[164:167], v[200:203], v[232:235], a[164:167]
v_mfma_f32_16x16x32_bf16 a[164:167], v[204:207], v[236:239], a[164:167]
v_mfma_f32_16x16x32_bf16 a[160:163], v[196:199], v[236:239], a[160:163]
s_waitcnt vmcnt(12) lgkmcnt(0)
v_mfma_f32_16x16x32_bf16 a[160:163], v[192:195], v[232:235], a[160:163]
s_barrier
v_mfma_f32_16x16x32_bf16 a[192:195], v[192:195], v[240:243], a[192:195]
s_and_b32 s73, s65, 1
ds_read_b64_tr_b16 v[224:225], v20 offset:0
v_mfma_f32_16x16x32_bf16 a[192:195], v[196:199], v[244:247], a[192:195]
s_xor_b32 s73, s73, 3
ds_read_b64_tr_b16 v[226:227], v20 offset:1024
v_mfma_f32_16x16x32_bf16 a[196:199], v[204:207], v[244:247], a[196:199]
s_lshl_b32 s69, s73, 7
ds_read_b64_tr_b16 v[228:229], v20 offset:8192
v_mfma_f32_16x16x32_bf16 a[196:199], v[200:203], v[240:243], a[196:199]
s_add_u32 s69, s69, s84
ds_read_b64_tr_b16 v[230:231], v20 offset:9216
v_mfma_f32_16x16x32_bf16 a[200:203], v[208:211], v[240:243], a[200:203]
s_lshl_b32 s71, s73, 19
ds_read_b128 v[128:131], v24 offset:0
v_mfma_f32_16x16x32_bf16 a[200:203], v[212:215], v[244:247], a[200:203]
s_add_u32 s71, s71, s66
ds_read_b128 v[132:135], v25 offset:0
v_mfma_f32_16x16x32_bf16 a[204:207], v[220:223], v[244:247], a[204:207]
s_add_u32 m0, s63, 98304
v_mfma_f32_16x16x32_bf16 a[204:207], v[216:219], v[240:243], a[204:207]
s_add_u32 s72, s69, 0
buffer_load_dwordx4 v2, s[8:11], s72 offen lds
v_mfma_f32_16x16x32_bf16 a[208:211], v[184:187], v[240:243], a[208:211]
s_add_u32 s72, s69, 7168
buffer_load_dwordx4 v3, s[8:11], s72 offen offset:1024 lds
v_mfma_f32_16x16x32_bf16 a[208:211], v[188:191], v[244:247], a[208:211]
s_add_u32 s72, s69, 14336
buffer_load_dwordx4 v2, s[8:11], s72 offen offset:2048 lds
v_mfma_f32_16x16x32_bf16 a[212:215], v[180:183], v[244:247], a[212:215]
ds_read_b128 v[136:139], v24 offset:2048
v_mfma_f32_16x16x32_bf16 a[212:215], v[176:179], v[240:243], a[212:215]
ds_read_b128 v[140:143], v25 offset:2048
v_mfma_f32_16x16x32_bf16 a[216:219], v[168:171], v[240:243], a[216:219]
s_add_u32 s72, s69, 21504
buffer_load_dwordx4 v3, s[8:11], s72 offen offset:3072 lds
v_mfma_f32_16x16x32_bf16 a[216:219], v[172:175], v[244:247], a[216:219]
ds_read_b128 v[144:147], v24 offset:4096
v_mfma_f32_16x16x32_bf16 a[220:223], v[164:167], v[244:247], a[220:223]
ds_read_b128 v[148:151], v25 offset:4096
v_mfma_f32_16x16x32_bf16 a[220:223], v[160:163], v[240:243], a[220:223]
ds_read_b128 v[152:155], v24 offset:6144
v_mfma_f32_16x16x32_bf16 a[252:255], v[160:163], v[248:251], a[252:255]
ds_read_b128 v[156:159], v25 offset:6144
v_mfma_f32_16x16x32_bf16 a[252:255], v[164:167], v[252:255], a[252:255]
s_add_u32 m0, s64, 32768
v_mfma_f32_16x16x32_bf16 a[248:251], v[172:175], v[252:255], a[248:251]
s_add_u32 s72, s71, 0
buffer_load_dwordx4 v6, s[16:19], s72 offen lds
v_mfma_f32_16x16x32_bf16 a[248:251], v[168:171], v[248:251], a[248:251]
ds_read_b128 v[160:163], v24 offset:8192
v_mfma_f32_16x16x32_bf16 a[244:247], v[176:179], v[248:251], a[244:247]
ds_read_b128 v[164:167], v25 offset:8192
v_mfma_f32_16x16x32_bf16 a[244:247], v[180:183], v[252:255], a[244:247]
s_add_u32 s72, s71, 31744
buffer_load_dwordx4 v6, s[16:19], s72 offen offset:1024 lds
v_mfma_f32_16x16x32_bf16 a[240:243], v[188:191], v[252:255], a[240:243]
ds_read_b128 v[168:171], v24 offset:10240
v_mfma_f32_16x16x32_bf16 a[240:243], v[184:187], v[248:251], a[240:243]
ds_read_b128 v[172:175], v25 offset:10240
v_mfma_f32_16x16x32_bf16 a[236:239], v[216:219], v[248:251], a[236:239]
ds_read_b128 v[176:179], v24 offset:12288
v_mfma_f32_16x16x32_bf16 a[236:239], v[220:223], v[252:255], a[236:239]
s_add_u32 s72, s71, 63488
buffer_load_dwordx4 v7, s[16:19], s72 offen offset:2048 lds
v_mfma_f32_16x16x32_bf16 a[232:235], v[212:215], v[252:255], a[232:235]
ds_read_b128 v[180:183], v25 offset:12288
v_mfma_f32_16x16x32_bf16 a[232:235], v[208:211], v[248:251], a[232:235]
ds_read_b128 v[184:187], v24 offset:14336
v_mfma_f32_16x16x32_bf16 a[228:231], v[200:203], v[248:251], a[228:231]
ds_read_b128 v[188:191], v25 offset:14336
v_mfma_f32_16x16x32_bf16 a[228:231], v[204:207], v[252:255], a[228:231]
v_mfma_f32_16x16x32_bf16 a[224:227], v[196:199], v[252:255], a[224:227]
s_add_u32 s72, s71, 95232
buffer_load_dwordx4 v7, s[16:19], s72 offen offset:3072 lds
v_mfma_f32_16x16x32_bf16 a[224:227], v[192:195], v[248:251], a[224:227]
s_waitcnt lgkmcnt(8)
ds_read_b64_tr_b16 v[232:233], v21 offset:0
v_mfma_f32_16x16x32_bf16 a[0:3], v[224:227], v[128:131], a[0:3]
ds_read_b64_tr_b16 v[234:235], v21 offset:1024
v_mfma_f32_16x16x32_bf16 a[0:3], v[228:231], v[132:135], a[0:3]
ds_read_b64_tr_b16 v[240:241], v22 offset:0
v_mfma_f32_16x16x32_bf16 a[4:7], v[228:231], v[140:143], a[4:7]
s_add_u32 m0, s63, 102400
ds_read_b64_tr_b16 v[236:237], v21 offset:8192
v_mfma_f32_16x16x32_bf16 a[4:7], v[224:227], v[136:139], a[4:7]
s_add_u32 s72, s69, 32768
buffer_load_dwordx4 v2, s[8:11], s72 offen lds
v_mfma_f32_16x16x32_bf16 a[8:11], v[224:227], v[144:147], a[8:11]
ds_read_b64_tr_b16 v[238:239], v21 offset:9216
v_mfma_f32_16x16x32_bf16 a[8:11], v[228:231], v[148:151], a[8:11]
v_mfma_f32_16x16x32_bf16 a[12:15], v[228:231], v[156:159], a[12:15]
s_add_u32 s72, s69, 39936
buffer_load_dwordx4 v3, s[8:11], s72 offen offset:1024 lds
v_mfma_f32_16x16x32_bf16 a[12:15], v[224:227], v[152:155], a[12:15]
s_waitcnt lgkmcnt(5)
ds_read_b64_tr_b16 v[242:243], v22 offset:1024
v_mfma_f32_16x16x32_bf16 a[16:19], v[224:227], v[160:163], a[16:19]
v_mfma_f32_16x16x32_bf16 a[16:19], v[228:231], v[164:167], a[16:19]
ds_read_b64_tr_b16 v[244:245], v22 offset:8192
v_mfma_f32_16x16x32_bf16 a[20:23], v[228:231], v[172:175], a[20:23]
v_mfma_f32_16x16x32_bf16 a[20:23], v[224:227], v[168:171], a[20:23]
s_add_u32 s72, s69, 47104
buffer_load_dwordx4 v2, s[8:11], s72 offen offset:2048 lds
v_mfma_f32_16x16x32_bf16 a[24:27], v[224:227], v[176:179], a[24:27]
ds_read_b64_tr_b16 v[246:247], v22 offset:9216
v_mfma_f32_16x16x32_bf16 a[24:27], v[228:231], v[180:183], a[24:27]
v_mfma_f32_16x16x32_bf16 a[28:31], v[228:231], v[188:191], a[28:31]
v_mfma_f32_16x16x32_bf16 a[28:31], v[224:227], v[184:187], a[28:31]
s_waitcnt lgkmcnt(3)
v_mfma_f32_16x16x32_bf16 a[60:63], v[232:235], v[184:187], a[60:63]
s_add_u32 s72, s69, 54272
buffer_load_dwordx4 v3, s[8:11], s72 offen offset:3072 lds
v_mfma_f32_16x16x32_bf16 a[60:63], v[236:239], v[188:191], a[60:63]
ds_read_b64_tr_b16 v[248:249], v23 offset:0
v_mfma_f32_16x16x32_bf16 a[56:59], v[236:239], v[180:183], a[56:59]
v_mfma_f32_16x16x32_bf16 a[56:59], v[232:235], v[176:179], a[56:59]
s_add_u32 m0, s64, 49152
ds_read_b64_tr_b16 v[250:251], v23 offset:1024
v_mfma_f32_16x16x32_bf16 a[52:55], v[232:235], v[168:171], a[52:55]
s_add_u32 s72, s71, 0
buffer_load_dwordx4 v6, s[20:23], s72 offen lds
v_mfma_f32_16x16x32_bf16 a[52:55], v[236:239], v[172:175], a[52:55]
v_mfma_f32_16x16x32_bf16 a[48:51], v[236:239], v[164:167], a[48:51]
v_mfma_f32_16x16x32_bf16 a[48:51], v[232:235], v[160:163], a[48:51]
ds_read_b64_tr_b16 v[252:253], v23 offset:8192
v_mfma_f32_16x16x32_bf16 a[44:47], v[232:235], v[152:155], a[44:47]
s_add_u32 s72, s71, 31744
buffer_load_dwordx4 v6, s[20:23], s72 offen offset:1024 lds
v_mfma_f32_16x16x32_bf16 a[44:47], v[236:239], v[156:159], a[44:47]
v_mfma_f32_16x16x32_bf16 a[40:43], v[236:239], v[148:151], a[40:43]
ds_read_b64_tr_b16 v[254:255], v23 offset:9216
v_mfma_f32_16x16x32_bf16 a[40:43], v[232:235], v[144:147], a[40:43]
v_mfma_f32_16x16x32_bf16 a[36:39], v[232:235], v[136:139], a[36:39]
s_add_u32 s72, s71, 63488
buffer_load_dwordx4 v7, s[20:23], s72 offen offset:2048 lds
v_mfma_f32_16x16x32_bf16 a[36:39], v[236:239], v[140:143], a[36:39]
v_mfma_f32_16x16x32_bf16 a[32:35], v[236:239], v[132:135], a[32:35]
v_mfma_f32_16x16x32_bf16 a[32:35], v[232:235], v[128:131], a[32:35]
s_waitcnt lgkmcnt(4)
v_mfma_f32_16x16x32_bf16 a[64:67], v[240:243], v[128:131], a[64:67]
s_add_u32 s72, s71, 95232
buffer_load_dwordx4 v7, s[20:23], s72 offen offset:3072 lds
v_mfma_f32_16x16x32_bf16 a[64:67], v[244:247], v[132:135], a[64:67]
s_mov_b32 s80, 0x300000
buffer_load_dword v126, v125, s[16:19], s80 offen nt
v_mfma_f32_16x16x32_bf16 a[68:71], v[244:247], v[140:143], a[68:71]
buffer_load_dword v126, v125, s[16:19], s80 offen sc1
v_mfma_f32_16x16x32_bf16 a[68:71], v[240:243], v[136:139], a[68:71]
buffer_load_dword v126, v125, s[20:23], s80 offen nt
v_mfma_f32_16x16x32_bf16 a[72:75], v[240:243], v[144:147], a[72:75]
buffer_load_dword v126, v125, s[20:23], s80 offen sc1
v_mfma_f32_16x16x32_bf16 a[72:75], v[244:247], v[148:151], a[72:75]
s_add_u32 m0, s63, 135168
ds_read_b64_tr_b16 v[224:225], v20 offset:16384
v_mfma_f32_16x16x32_bf16 a[76:79], v[244:247], v[156:159], a[76:79]
s_add_u32 s80, s82, 0
buffer_load_dwordx4 v26, s[32:35], s80 offen nt lds
v_mfma_f32_16x16x32_bf16 a[76:79], v[240:243], v[152:155], a[76:79]
s_add_u32 s80, s82, 15360
buffer_load_dwordx4 v26, s[32:35], s80 offen offset:1024 nt lds
v_mfma_f32_16x16x32_bf16 a[80:83], v[240:243], v[160:163], a[80:83]
s_add_u32 s80, s82, 30720
buffer_load_dwordx4 v26, s[32:35], s80 offen offset:2048 nt lds
v_mfma_f32_16x16x32_bf16 a[80:83], v[244:247], v[164:167], a[80:83]
s_add_u32 s80, s82, 46080
buffer_load_dwordx4 v26, s[32:35], s80 offen offset:3072 nt lds
v_mfma_f32_16x16x32_bf16 a[84:87], v[244:247], v[172:175], a[84:87]
ds_read_b64_tr_b16 v[226:227], v20 offset:17408
v_mfma_f32_16x16x32_bf16 a[84:87], v[240:243], v[168:171], a[84:87]
ds_read_b64_tr_b16 v[228:229], v20 offset:24576
v_mfma_f32_16x16x32_bf16 a[88:91], v[240:243], v[176:179], a[88:91]
ds_read_b64_tr_b16 v[230:231], v20 offset:25600
v_mfma_f32_16x16x32_bf16 a[88:91], v[244:247], v[180:183], a[88:91]
v_mfma_f32_16x16x32_bf16 a[92:95], v[244:247], v[188:191], a[92:95]
v_mfma_f32_16x16x32_bf16 a[92:95], v[240:243], v[184:187], a[92:95]
s_waitcnt lgkmcnt(4)
v_mfma_f32_16x16x32_bf16 a[124:127], v[248:251], v[184:187], a[124:127]
ds_read_b64_tr_b16 v[232:233], v21 offset:16384
v_mfma_f32_16x16x32_bf16 a[124:127], v[252:255], v[188:191], a[124:127]
v_mfma_f32_16x16x32_bf16 a[120:123], v[252:255], v[180:183], a[120:123]
v_mfma_f32_16x16x32_bf16 a[120:123], v[248:251], v[176:179], a[120:123]
ds_read_b64_tr_b16 v[234:235], v21 offset:17408
v_mfma_f32_16x16x32_bf16 a[116:119], v[248:251], v[168:171], a[116:119]
v_mfma_f32_16x16x32_bf16 a[116:119], v[252:255], v[172:175], a[116:119]
v_mfma_f32_16x16x32_bf16 a[112:115], v[252:255], v[164:167], a[112:115]
v_mfma_f32_16x16x32_bf16 a[112:115], v[248:251], v[160:163], a[112:115]
ds_read_b64_tr_b16 v[236:237], v21 offset:24576
v_mfma_f32_16x16x32_bf16 a[108:111], v[248:251], v[152:155], a[108:111]
v_mfma_f32_16x16x32_bf16 a[108:111], v[252:255], v[156:159], a[108:111]
v_mfma_f32_16x16x32_bf16 a[104:107], v[252:255], v[148:151], a[104:107]
ds_read_b64_tr_b16 v[238:239], v21 offset:25600
v_mfma_f32_16x16x32_bf16 a[104:107], v[248:251], v[144:147], a[104:107]
v_mfma_f32_16x16x32_bf16 a[100:103], v[248:251], v[136:139], a[100:103]
v_mfma_f32_16x16x32_bf16 a[100:103], v[252:255], v[140:143], a[100:103]
v_mfma_f32_16x16x32_bf16 a[96:99], v[252:255], v[132:135], a[96:99]
v_mfma_f32_16x16x32_bf16 a[96:99], v[248:251], v[128:131], a[96:99]
s_waitcnt lgkmcnt(4)
v_mfma_f32_16x16x32_bf16 a[128:131], v[128:131], v[224:227], a[128:131]
ds_read_b64_tr_b16 v[240:241], v22 offset:16384
v_mfma_f32_16x16x32_bf16 a[128:131], v[132:135], v[228:231], a[128:131]
v_mfma_f32_16x16x32_bf16 a[132:135], v[140:143], v[228:231], a[132:135]
v_mfma_f32_16x16x32_bf16 a[132:135], v[136:139], v[224:227], a[132:135]
ds_read_b64_tr_b16 v[242:243], v22 offset:17408
v_mfma_f32_16x16x32_bf16 a[136:139], v[144:147], v[224:227], a[136:139]
v_mfma_f32_16x16x32_bf16 a[136:139], v[148:151], v[228:231], a[136:139]
v_mfma_f32_16x16x32_bf16 a[140:143], v[156:159], v[228:231], a[140:143]
v_mfma_f32_16x16x32_bf16 a[140:143], v[152:155], v[224:227], a[140:143]
ds_read_b64_tr_b16 v[244:245], v22 offset:24576
v_mfma_f32_16x16x32_bf16 a[144:147], v[160:163], v[224:227], a[144:147]
v_mfma_f32_16x16x32_bf16 a[144:147], v[164:167], v[228:231], a[144:147]
v_mfma_f32_16x16x32_bf16 a[148:151], v[172:175], v[228:231], a[148:151]
ds_read_b64_tr_b16 v[246:247], v22 offset:25600
v_mfma_f32_16x16x32_bf16 a[148:151], v[168:171], v[224:227], a[148:151]
v_mfma_f32_16x16x32_bf16 a[152:155], v[176:179], v[224:227], a[152:155]
v_mfma_f32_16x16x32_bf16 a[152:155], v[180:183], v[228:231], a[152:155]
v_mfma_f32_16x16x32_bf16 a[156:159], v[188:191], v[228:231], a[156:159]
v_mfma_f32_16x16x32_bf16 a[156:159], v[184:187], v[224:227], a[156:159]
s_waitcnt lgkmcnt(4)
v_mfma_f32_16x16x32_bf16 a[188:191], v[184:187], v[232:235], a[188:191]
ds_read_b64_tr_b16 v[248:249], v23 offset:16384
v_mfma_f32_16x16x32_bf16 a[188:191], v[188:191], v[236:239], a[188:191]
v_mfma_f32_16x16x32_bf16 a[184:187], v[180:183], v[236:239], a[184:187]
ds_read_b64_tr_b16 v[250:251], v23 offset:17408
v_mfma_f32_16x16x32_bf16 a[184:187], v[176:179], v[232:235], a[184:187]
v_mfma_f32_16x16x32_bf16 a[180:183], v[168:171], v[232:235], a[180:183]
ds_read_b64_tr_b16 v[252:253], v23 offset:24576
v_mfma_f32_16x16x32_bf16 a[180:183], v[172:175], v[236:239], a[180:183]
v_mfma_f32_16x16x32_bf16 a[176:179], v[164:167], v[236:239], a[176:179]
ds_read_b64_tr_b16 v[254:255], v23 offset:25600
v_mfma_f32_16x16x32_bf16 a[176:179], v[160:163], v[232:235], a[176:179]
v_mfma_f32_16x16x32_bf16 a[172:175], v[152:155], v[232:235], a[172:175]
v_mfma_f32_16x16x32_bf16 a[172:175], v[156:159], v[236:239], a[172:175]
v_mfma_f32_16x16x32_bf16 a[168:171], v[148:151], v[236:239], a[168:171]
v_mfma_f32_16x16x32_bf16 a[168:171], v[144:147], v[232:235], a[168:171]
v_mfma_f32_16x16x32_bf16 a[164:167], v[136:139], v[232:235], a[164:167]
v_mfma_f32_16x16x32_bf16 a[164:167], v[140:143], v[236:239], a[164:167]
v_mfma_f32_16x16x32_bf16 a[160:163], v[132:135], v[236:239], a[160:163]
s_waitcnt vmcnt(8) lgkmcnt(0)
v_mfma_f32_16x16x32_bf16 a[160:163], v[128:131], v[232:235], a[160:163]
s_barrier
v_mfma_f32_16x16x32_bf16 a[192:195], v[128:131], v[240:243], a[192:195]
s_and_b32 s73, s65, 1
ds_read_b64_tr_b16 v[224:225], v20 offset:32768
v_mfma_f32_16x16x32_bf16 a[192:195], v[132:135], v[244:247], a[192:195]
s_xor_b32 s73, s73, 4
ds_read_b64_tr_b16 v[226:227], v20 offset:33792
v_mfma_f32_16x16x32_bf16 a[196:199], v[140:143], v[244:247], a[196:199]
s_lshl_b32 s69, s73, 7
ds_read_b64_tr_b16 v[228:229], v20 offset:40960
v_mfma_f32_16x16x32_bf16 a[196:199], v[136:139], v[240:243], a[196:199]
s_add_u32 s69, s69, s84
ds_read_b64_tr_b16 v[230:231], v20 offset:41984
v_mfma_f32_16x16x32_bf16 a[200:203], v[144:147], v[240:243], a[200:203]
s_lshl_b32 s71, s73, 19
ds_read_b128 v[192:195], v24 offset:32768
v_mfma_f32_16x16x32_bf16 a[200:203], v[148:151], v[244:247], a[200:203]
s_add_u32 s71, s71, s66
ds_read_b128 v[196:199], v25 offset:32768
v_mfma_f32_16x16x32_bf16 a[204:207], v[156:159], v[244:247], a[204:207]
s_add_u32 m0, s63, 65536
v_mfma_f32_16x16x32_bf16 a[204:207], v[152:155], v[240:243], a[204:207]
s_add_u32 s72, s69, 0
buffer_load_dwordx4 v2, s[8:11], s72 offen lds
v_mfma_f32_16x16x32_bf16 a[208:211], v[160:163], v[240:243], a[208:211]
s_add_u32 s72, s69, 7168
buffer_load_dwordx4 v3, s[8:11], s72 offen offset:1024 lds
v_mfma_f32_16x16x32_bf16 a[208:211], v[164:167], v[244:247], a[208:211]
s_add_u32 s72, s69, 14336
buffer_load_dwordx4 v2, s[8:11], s72 offen offset:2048 lds
v_mfma_f32_16x16x32_bf16 a[212:215], v[172:175], v[244:247], a[212:215]
ds_read_b128 v[200:203], v24 offset:34816
v_mfma_f32_16x16x32_bf16 a[212:215], v[168:171], v[240:243], a[212:215]
ds_read_b128 v[204:207], v25 offset:34816
v_mfma_f32_16x16x32_bf16 a[216:219], v[176:179], v[240:243], a[216:219]
s_add_u32 s72, s69, 21504
buffer_load_dwordx4 v3, s[8:11], s72 offen offset:3072 lds
v_mfma_f32_16x16x32_bf16 a[216:219], v[180:183], v[244:247], a[216:219]
ds_read_b128 v[208:211], v24 offset:36864
v_mfma_f32_16x16x32_bf16 a[220:223], v[188:191], v[244:247], a[220:223]
ds_read_b128 v[212:215], v25 offset:36864
v_mfma_f32_16x16x32_bf16 a[220:223], v[184:187], v[240:243], a[220:223]
ds_read_b128 v[216:219], v24 offset:38912
v_mfma_f32_16x16x32_bf16 a[252:255], v[184:187], v[248:251], a[252:255]
ds_read_b128 v[220:223], v25 offset:38912
v_mfma_f32_16x16x32_bf16 a[252:255], v[188:191], v[252:255], a[252:255]
s_add_u32 m0, s64, 0
v_mfma_f32_16x16x32_bf16 a[248:251], v[180:183], v[252:255], a[248:251]
s_add_u32 s72, s71, 0
buffer_load_dwordx4 v6, s[16:19], s72 offen lds
v_mfma_f32_16x16x32_bf16 a[248:251], v[176:179], v[248:251], a[248:251]
ds_read_b128 v[184:187], v24 offset:40960
v_mfma_f32_16x16x32_bf16 a[244:247], v[168:171], v[248:251], a[244:247]
ds_read_b128 v[188:191], v25 offset:40960
v_mfma_f32_16x16x32_bf16 a[244:247], v[172:175], v[252:255], a[244:247]
s_add_u32 s72, s71, 31744
buffer_load_dwordx4 v6, s[16:19], s72 offen offset:1024 lds
v_mfma_f32_16x16x32_bf16 a[240:243], v[164:167], v[252:255], a[240:243]
ds_read_b128 v[176:179], v24 offset:43008
v_mfma_f32_16x16x32_bf16 a[240:243], v[160:163], v[248:251], a[240:243]
ds_read_b128 v[180:183], v25 offset:43008
v_mfma_f32_16x16x32_bf16 a[236:239], v[152:155], v[248:251], a[236:239]
ds_read_b128 v[168:171], v24 offset:45056
v_mfma_f32_16x16x32_bf16 a[236:239], v[156:159], v[252:255], a[236:239]
s_add_u32 s72, s71, 63488
buffer_load_dwordx4 v7, s[16:19], s72 offen offset:2048 lds
v_mfma_f32_16x16x32_bf16 a[232:235], v[148:151], v[252:255], a[232:235]
ds_read_b128 v[172:175], v25 offset:45056
v_mfma_f32_16x16x32_bf16 a[232:235], v[144:147], v[248:251], a[232:235]
ds_read_b128 v[160:163], v24 offset:47104
v_mfma_f32_16x16x32_bf16 a[228:231], v[136:139], v[248:251], a[228:231]
ds_read_b128 v[164:167], v25 offset:47104
v_mfma_f32_16x16x32_bf16 a[228:231], v[140:143], v[252:255], a[228:231]
v_mfma_f32_16x16x32_bf16 a[224:227], v[132:135], v[252:255], a[224:227]
s_add_u32 s72, s71, 95232
buffer_load_dwordx4 v7, s[16:19], s72 offen offset:3072 lds
v_mfma_f32_16x16x32_bf16 a[224:227], v[128:131], v[248:251], a[224:227]
s_waitcnt lgkmcnt(8)
ds_read_b64_tr_b16 v[232:233], v21 offset:32768
v_mfma_f32_16x16x32_bf16 a[0:3], v[224:227], v[192:195], a[0:3]
ds_read_b64_tr_b16 v[234:235], v21 offset:33792
v_mfma_f32_16x16x32_bf16 a[0:3], v[228:231], v[196:199], a[0:3]
ds_read_b64_tr_b16 v[240:241], v22 offset:32768
v_mfma_f32_16x16x32_bf16 a[4:7], v[228:231], v[204:207], a[4:7]
s_add_u32 m0, s63, 69632
ds_read_b64_tr_b16 v[236:237], v21 offset:40960
v_mfma_f32_16x16x32_bf16 a[4:7], v[224:227], v[200:203], a[4:7]
s_add_u32 s72, s69, 32768
buffer_load_dwordx4 v2, s[8:11], s72 offen lds
v_mfma_f32_16x16x32_bf16 a[8:11], v[224:227], v[208:211], a[8:11]
ds_read_b64_tr_b16 v[238:239], v21 offset:41984
v_mfma_f32_16x16x32_bf16 a[8:11], v[228:231], v[212:215], a[8:11]
v_mfma_f32_16x16x32_bf16 a[12:15], v[228:231], v[220:223], a[12:15]
s_add_u32 s72, s69, 39936
buffer_load_dwordx4 v3, s[8:11], s72 offen offset:1024 lds
v_mfma_f32_16x16x32_bf16 a[12:15], v[224:227], v[216:219], a[12:15]
s_waitcnt lgkmcnt(5)
ds_read_b64_tr_b16 v[242:243], v22 offset:33792
v_mfma_f32_16x16x32_bf16 a[16:19], v[224:227], v[184:187], a[16:19]
v_mfma_f32_16x16x32_bf16 a[16:19], v[228:231], v[188:191], a[16:19]
ds_read_b64_tr_b16 v[244:245], v22 offset:40960
v_mfma_f32_16x16x32_bf16 a[20:23], v[228:231], v[180:183], a[20:23]
v_mfma_f32_16x16x32_bf16 a[20:23], v[224:227], v[176:179], a[20:23]
s_add_u32 s72, s69, 47104
buffer_load_dwordx4 v2, s[8:11], s72 offen offset:2048 lds
v_mfma_f32_16x16x32_bf16 a[24:27], v[224:227], v[168:171], a[24:27]
ds_read_b64_tr_b16 v[246:247], v22 offset:41984
v_mfma_f32_16x16x32_bf16 a[24:27], v[228:231], v[172:175], a[24:27]
v_mfma_f32_16x16x32_bf16 a[28:31], v[228:231], v[164:167], a[28:31]
v_mfma_f32_16x16x32_bf16 a[28:31], v[224:227], v[160:163], a[28:31]
s_waitcnt lgkmcnt(3)
v_mfma_f32_16x16x32_bf16 a[60:63], v[232:235], v[160:163], a[60:63]
s_add_u32 s72, s69, 54272
buffer_load_dwordx4 v3, s[8:11], s72 offen offset:3072 lds
v_mfma_f32_16x16x32_bf16 a[60:63], v[236:239], v[164:167], a[60:63]
ds_read_b64_tr_b16 v[248:249], v23 offset:32768
v_mfma_f32_16x16x32_bf16 a[56:59], v[236:239], v[172:175], a[56:59]
v_mfma_f32_16x16x32_bf16 a[56:59], v[232:235], v[168:171], a[56:59]
s_add_u32 m0, s64, 16384
ds_read_b64_tr_b16 v[250:251], v23 offset:33792
v_mfma_f32_16x16x32_bf16 a[52:55], v[232:235], v[176:179], a[52:55]
s_add_u32 s72, s71, 0
buffer_load_dwordx4 v6, s[20:23], s72 offen lds
v_mfma_f32_16x16x32_bf16 a[52:55], v[236:239], v[180:183], a[52:55]
v_mfma_f32_16x16x32_bf16 a[48:51], v[236:239], v[188:191], a[48:51]
v_mfma_f32_16x16x32_bf16 a[48:51], v[232:235], v[184:187], a[48:51]
ds_read_b64_tr_b16 v[252:253], v23 offset:40960
v_mfma_f32_16x16x32_bf16 a[44:47], v[232:235], v[216:219], a[44:47]
s_add_u32 s72, s71, 31744
buffer_load_dwordx4 v6, s[20:23], s72 offen offset:1024 lds
v_mfma_f32_16x16x32_bf16 a[44:47], v[236:239], v[220:223], a[44:47]
v_mfma_f32_16x16x32_bf16 a[40:43], v[236:239], v[212:215], a[40:43]
ds_read_b64_tr_b16 v[254:255], v23 offset:41984
v_mfma_f32_16x16x32_bf16 a[40:43], v[232:235], v[208:211], a[40:43]
v_mfma_f32_16x16x32_bf16 a[36:39], v[232:235], v[200:203], a[36:39]
s_add_u32 s72, s71, 63488
buffer_load_dwordx4 v7, s[20:23], s72 offen offset:2048 lds
v_mfma_f32_16x16x32_bf16 a[36:39], v[236:239], v[204:207], a[36:39]
v_mfma_f32_16x16x32_bf16 a[32:35], v[236:239], v[196:199], a[32:35]
v_mfma_f32_16x16x32_bf16 a[32:35], v[232:235], v[192:195], a[32:35]
s_waitcnt lgkmcnt(4)
v_mfma_f32_16x16x32_bf16 a[64:67], v[240:243], v[192:195], a[64:67]
s_add_u32 s72, s71, 95232
buffer_load_dwordx4 v7, s[20:23], s72 offen offset:3072 lds
v_mfma_f32_16x16x32_bf16 a[64:67], v[244:247], v[196:199], a[64:67]
buffer_load_dwordx4 v[108:111], v1, s[4:7], s76 offen
v_mfma_f32_16x16x32_bf16 a[68:71], v[244:247], v[204:207], a[68:71]
buffer_load_dwordx4 v[112:115], v1, s[4:7], s76 offen offset:1024
v_mfma_f32_16x16x32_bf16 a[68:71], v[240:243], v[200:203], a[68:71]
buffer_load_dwordx4 v[116:119], v1, s[4:7], s76 offen offset:2048
v_mfma_f32_16x16x32_bf16 a[72:75], v[240:243], v[208:211], a[72:75]
buffer_load_dwordx4 v[120:123], v1, s[4:7], s76 offen offset:3072
v_mfma_f32_16x16x32_bf16 a[72:75], v[244:247], v[212:215], a[72:75]
ds_read_b64_tr_b16 v[224:225], v20 offset:49152
v_mfma_f32_16x16x32_bf16 a[76:79], v[244:247], v[220:223], a[76:79]
v_mfma_f32_16x16x32_bf16 a[76:79], v[240:243], v[216:219], a[76:79]
ds_read_b64_tr_b16 v[226:227], v20 offset:50176
v_mfma_f32_16x16x32_bf16 a[80:83], v[240:243], v[184:187], a[80:83]
v_mfma_f32_16x16x32_bf16 a[80:83], v[244:247], v[188:191], a[80:83]
ds_read_b64_tr_b16 v[228:229], v20 offset:57344
v_mfma_f32_16x16x32_bf16 a[84:87], v[244:247], v[180:183], a[84:87]
v_mfma_f32_16x16x32_bf16 a[84:87], v[240:243], v[176:179], a[84:87]
ds_read_b64_tr_b16 v[230:231], v20 offset:58368
v_mfma_f32_16x16x32_bf16 a[88:91], v[240:243], v[168:171], a[88:91]
v_mfma_f32_16x16x32_bf16 a[88:91], v[244:247], v[172:175], a[88:91]
v_mfma_f32_16x16x32_bf16 a[92:95], v[244:247], v[164:167], a[92:95]
v_mfma_f32_16x16x32_bf16 a[92:95], v[240:243], v[160:163], a[92:95]
s_waitcnt lgkmcnt(4)
v_mfma_f32_16x16x32_bf16 a[124:127], v[248:251], v[160:163], a[124:127]
ds_read_b64_tr_b16 v[232:233], v21 offset:49152
v_mfma_f32_16x16x32_bf16 a[124:127], v[252:255], v[164:167], a[124:127]
v_mfma_f32_16x16x32_bf16 a[120:123], v[252:255], v[172:175], a[120:123]
v_mfma_f32_16x16x32_bf16 a[120:123], v[248:251], v[168:171], a[120:123]
ds_read_b64_tr_b16 v[234:235], v21 offset:50176
v_mfma_f32_16x16x32_bf16 a[116:119], v[248:251], v[176:179], a[116:119]
s_waitcnt vmcnt(20)
ds_read2_b32 v[36:37], v98 offset0:0 offset1:32
ds_read2_b32 v[38:39], v98 offset0:64 offset1:96
v_mfma_f32_16x16x32_bf16 a[116:119], v[252:255], v[180:183], a[116:119]
ds_read2_b32 v[40:41], v98 offset0:128 offset1:160
ds_read2_b32 v[42:43], v98 offset0:192 offset1:224
v_mfma_f32_16x16x32_bf16 a[112:115], v[252:255], v[188:191], a[112:115]
v_add_u32 v98, 1024, v98
v_mfma_f32_16x16x32_bf16 a[112:115], v[248:251], v[184:187], a[112:115]
ds_read_b64_tr_b16 v[236:237], v21 offset:57344
ds_read2_b32 v[44:45], v98 offset0:0 offset1:32
v_mfma_f32_16x16x32_bf16 a[108:111], v[248:251], v[216:219], a[108:111]
ds_read2_b32 v[46:47], v98 offset0:64 offset1:96
ds_read2_b32 v[48:49], v98 offset0:128 offset1:160
v_mfma_f32_16x16x32_bf16 a[108:111], v[252:255], v[220:223], a[108:111]
ds_read2_b32 v[50:51], v98 offset0:192 offset1:224
v_add_u32 v98, 3072, v98
v_mfma_f32_16x16x32_bf16 a[104:107], v[252:255], v[212:215], a[104:107]
ds_read_b64_tr_b16 v[238:239], v21 offset:58368
ds_read2_b32 v[52:53], v98 offset0:0 offset1:32
v_mfma_f32_16x16x32_bf16 a[104:107], v[248:251], v[208:211], a[104:107]
ds_read2_b32 v[54:55], v98 offset0:64 offset1:96
ds_read2_b32 v[56:57], v98 offset0:128 offset1:160
v_mfma_f32_16x16x32_bf16 a[100:103], v[248:251], v[200:203], a[100:103]
ds_read2_b32 v[58:59], v98 offset0:192 offset1:224
v_add_u32 v98, 1024, v98
v_mfma_f32_16x16x32_bf16 a[100:103], v[252:255], v[204:207], a[100:103]
ds_read2_b32 v[60:61], v98 offset0:0 offset1:32
ds_read2_b32 v[62:63], v98 offset0:64 offset1:96
v_mfma_f32_16x16x32_bf16 a[96:99], v[252:255], v[196:199], a[96:99]
ds_read2_b32 v[64:65], v98 offset0:128 offset1:160
ds_read2_b32 v[66:67], v98 offset0:192 offset1:224
v_mfma_f32_16x16x32_bf16 a[96:99], v[248:251], v[192:195], a[96:99]
s_waitcnt lgkmcnt(15)
v_mfma_f32_16x16x32_bf16 a[128:131], v[192:195], v[224:227], a[128:131]
ds_read_b64_tr_b16 v[240:241], v22 offset:49152
v_mfma_f32_16x16x32_bf16 a[128:131], v[196:199], v[228:231], a[128:131]
v_mfma_f32_16x16x32_bf16 a[132:135], v[204:207], v[228:231], a[132:135]
v_mfma_f32_16x16x32_bf16 a[132:135], v[200:203], v[224:227], a[132:135]
ds_read_b64_tr_b16 v[242:243], v22 offset:50176
v_mfma_f32_16x16x32_bf16 a[136:139], v[208:211], v[224:227], a[136:139]
v_mfma_f32_16x16x32_bf16 a[136:139], v[212:215], v[228:231], a[136:139]
v_mfma_f32_16x16x32_bf16 a[140:143], v[220:223], v[228:231], a[140:143]
v_mfma_f32_16x16x32_bf16 a[140:143], v[216:219], v[224:227], a[140:143]
ds_read_b64_tr_b16 v[244:245], v22 offset:57344
v_mfma_f32_16x16x32_bf16 a[144:147], v[184:187], v[224:227], a[144:147]
v_mfma_f32_16x16x32_bf16 a[144:147], v[188:191], v[228:231], a[144:147]
v_mfma_f32_16x16x32_bf16 a[148:151], v[180:183], v[228:231], a[148:151]
ds_read_b64_tr_b16 v[246:247], v22 offset:58368
v_mfma_f32_16x16x32_bf16 a[148:151], v[176:179], v[224:227], a[148:151]
v_mfma_f32_16x16x32_bf16 a[152:155], v[168:171], v[224:227], a[152:155]
v_mfma_f32_16x16x32_bf16 a[152:155], v[172:175], v[228:231], a[152:155]
v_mfma_f32_16x16x32_bf16 a[156:159], v[164:167], v[228:231], a[156:159]
v_mfma_f32_16x16x32_bf16 a[156:159], v[160:163], v[224:227], a[156:159]
s_waitcnt lgkmcnt(12)
v_mfma_f32_16x16x32_bf16 a[188:191], v[160:163], v[232:235], a[188:191]
ds_read_b64_tr_b16 v[248:249], v23 offset:49152
v_mfma_f32_16x16x32_bf16 a[188:191], v[164:167], v[236:239], a[188:191]
v_mfma_f32_16x16x32_bf16 a[184:187], v[172:175], v[236:239], a[184:187]
ds_read_b64_tr_b16 v[250:251], v23 offset:50176
v_mfma_f32_16x16x32_bf16 a[184:187], v[168:171], v[232:235], a[184:187]
v_mfma_f32_16x16x32_bf16 a[180:183], v[176:179], v[232:235], a[180:183]
ds_read_b64_tr_b16 v[252:253], v23 offset:57344
v_mfma_f32_16x16x32_bf16 a[180:183], v[180:183], v[236:239], a[180:183]
v_mfma_f32_16x16x32_bf16 a[176:179], v[188:191], v[236:239], a[176:179]
ds_read_b64_tr_b16 v[254:255], v23 offset:58368
v_mfma_f32_16x16x32_bf16 a[176:179], v[184:187], v[232:235], a[176:179]
v_mfma_f32_16x16x32_bf16 a[172:175], v[216:219], v[232:235], a[172:175]
v_mfma_f32_16x16x32_bf16 a[172:175], v[220:223], v[236:239], a[172:175]
v_mfma_f32_16x16x32_bf16 a[168:171], v[212:215], v[236:239], a[168:171]
v_mfma_f32_16x16x32_bf16 a[168:171], v[208:211], v[232:235], a[168:171]
v_mfma_f32_16x16x32_bf16 a[164:167], v[200:203], v[232:235], a[164:167]
v_mfma_f32_16x16x32_bf16 a[164:167], v[204:207], v[236:239], a[164:167]
v_mfma_f32_16x16x32_bf16 a[160:163], v[196:199], v[236:239], a[160:163]
s_waitcnt vmcnt(4) lgkmcnt(0)
v_mfma_f32_16x16x32_bf16 a[160:163], v[192:195], v[232:235], a[160:163]
s_barrier
v_mfma_f32_16x16x32_bf16 a[192:195], v[192:195], v[240:243], a[192:195]
s_and_b32 s73, s65, 1
ds_read_b64_tr_b16 v[224:225], v20 offset:0
v_lshlrev_b32 v72, 16, v68
v_mfma_f32_16x16x32_bf16 a[192:195], v[196:199], v[244:247], a[192:195]
s_xor_b32 s73, s73, 5
ds_read_b64_tr_b16 v[226:227], v20 offset:1024
v_and_b32 v73, 0xffff0000, v68
v_mfma_f32_16x16x32_bf16 a[196:199], v[204:207], v[244:247], a[196:199]
s_lshl_b32 s69, s73, 7
ds_read_b64_tr_b16 v[228:229], v20 offset:8192
v_lshlrev_b32 v74, 16, v69
v_mfma_f32_16x16x32_bf16 a[196:199], v[200:203], v[240:243], a[196:199]
s_add_u32 s69, s69, s84
ds_read_b64_tr_b16 v[230:231], v20 offset:9216
v_and_b32 v75, 0xffff0000, v69
v_mfma_f32_16x16x32_bf16 a[200:203], v[208:211], v[240:243], a[200:203]
s_lshl_b32 s71, s73, 19
ds_read_b128 v[128:131], v24 offset:0
v_lshlrev_b32 v76, 16, v33
v_mfma_f32_16x16x32_bf16 a[200:203], v[212:215], v[244:247], a[200:203]
s_add_u32 s71, s71, s66
ds_read_b128 v[132:135], v25 offset:0
v_lshlrev_b32 v77, 16, v34
v_mfma_f32_16x16x32_bf16 a[204:207], v[220:223], v[244:247], a[204:207]
s_add_u32 m0, s63, 98304
v_lshlrev_b32 v78, 16, v35
v_lshlrev_b32 v79, 16, v36
v_mfma_f32_16x16x32_bf16 a[204:207], v[216:219], v[240:243], a[204:207]
s_add_u32 s72, s69, 0
buffer_load_dwordx4 v2, s[8:11], s72 offen lds
v_mfma_f32_16x16x32_bf16 a[208:211], v[184:187], v[240:243], a[208:211]
s_add_u32 s72, s69, 7168
buffer_load_dwordx4 v3, s[8:11], s72 offen offset:1024 lds
v_mfma_f32_16x16x32_bf16 a[208:211], v[188:191], v[244:247], a[208:211]
s_add_u32 s72, s69, 14336
buffer_load_dwordx4 v2, s[8:11], s72 offen offset:2048 lds
v_mfma_f32_16x16x32_bf16 a[212:215], v[180:183], v[244:247], a[212:215]
ds_read_b128 v[136:139], v24 offset:2048
v_lshlrev_b32 v80, 16, v37
v_mfma_f32_16x16x32_bf16 a[212:215], v[176:179], v[240:243], a[212:215]
ds_read_b128 v[140:143], v25 offset:2048
v_lshlrev_b32 v81, 16, v38
v_mfma_f32_16x16x32_bf16 a[216:219], v[168:171], v[240:243], a[216:219]
s_add_u32 s72, s69, 21504
buffer_load_dwordx4 v3, s[8:11], s72 offen offset:3072 lds
v_mfma_f32_16x16x32_bf16 a[216:219], v[172:175], v[244:247], a[216:219]
ds_read_b128 v[144:147], v24 offset:4096
v_lshlrev_b32 v82, 16, v39
v_mfma_f32_16x16x32_bf16 a[220:223], v[164:167], v[244:247], a[220:223]
ds_read_b128 v[148:151], v25 offset:4096
v_lshlrev_b32 v83, 16, v40
v_mfma_f32_16x16x32_bf16 a[220:223], v[160:163], v[240:243], a[220:223]
ds_read_b128 v[152:155], v24 offset:6144
v_lshlrev_b32 v84, 16, v41
v_mfma_f32_16x16x32_bf16 a[252:255], v[160:163], v[248:251], a[252:255]
ds_read_b128 v[156:159], v25 offset:6144
v_lshlrev_b32 v85, 16, v42
v_mfma_f32_16x16x32_bf16 a[252:255], v[164:167], v[252:255], a[252:255]
s_add_u32 m0, s64, 32768
v_lshlrev_b32 v86, 16, v43
v_lshlrev_b32 v87, 16, v44
v_mfma_f32_16x16x32_bf16 a[248:251], v[172:175], v[252:255], a[248:251]
s_add_u32 s72, s71, 0
buffer_load_dwordx4 v6, s[16:19], s72 offen lds
v_mfma_f32_16x16x32_bf16 a[248:251], v[168:171], v[248:251], a[248:251]
ds_read_b128 v[160:163], v24 offset:8192
v_lshlrev_b32 v88, 16, v45
v_mfma_f32_16x16x32_bf16 a[244:247], v[176:179], v[248:251], a[244:247]
ds_read_b128 v[164:167], v25 offset:8192
v_lshlrev_b32 v89, 16, v46
v_mfma_f32_16x16x32_bf16 a[244:247], v[180:183], v[252:255], a[244:247]
s_add_u32 s72, s71, 31744
buffer_load_dwordx4 v6, s[16:19], s72 offen offset:1024 lds
v_mfma_f32_16x16x32_bf16 a[240:243], v[188:191], v[252:255], a[240:243]
ds_read_b128 v[168:171], v24 offset:10240
v_lshlrev_b32 v90, 16, v47
v_mfma_f32_16x16x32_bf16 a[240:243], v[184:187], v[248:251], a[240:243]
ds_read_b128 v[172:175], v25 offset:10240
v_lshlrev_b32 v91, 16, v48
v_mfma_f32_16x16x32_bf16 a[236:239], v[216:219], v[248:251], a[236:239]
ds_read_b128 v[176:179], v24 offset:12288
v_lshlrev_b32 v92, 16, v49
v_mfma_f32_16x16x32_bf16 a[236:239], v[220:223], v[252:255], a[236:239]
s_add_u32 s72, s71, 63488
buffer_load_dwordx4 v7, s[16:19], s72 offen offset:2048 lds
v_mfma_f32_16x16x32_bf16 a[232:235], v[212:215], v[252:255], a[232:235]
ds_read_b128 v[180:183], v25 offset:12288
v_lshlrev_b32 v93, 16, v50
v_mfma_f32_16x16x32_bf16 a[232:235], v[208:211], v[248:251], a[232:235]
ds_read_b128 v[184:187], v24 offset:14336
v_lshlrev_b32 v94, 16, v51
v_mfma_f32_16x16x32_bf16 a[228:231], v[200:203], v[248:251], a[228:231]
ds_read_b128 v[188:191], v25 offset:14336
v_mul_f32 v95, v75, v91
v_mfma_f32_16x16x32_bf16 a[228:231], v[204:207], v[252:255], a[228:231]
v_lshlrev_b32 v97, 16, v67
v_fmac_f32 v95, v74, v92
v_mfma_f32_16x16x32_bf16 a[224:227], v[196:199], v[252:255], a[224:227]
s_add_u32 s72, s71, 95232
buffer_load_dwordx4 v7, s[16:19], s72 offen offset:3072 lds
v_mfma_f32_16x16x32_bf16 a[224:227], v[192:195], v[248:251], a[224:227]
s_waitcnt lgkmcnt(8)
ds_read_b64_tr_b16 v[232:233], v21 offset:0
v_fmac_f32 v95, v73, v93
v_mfma_f32_16x16x32_bf16 a[0:3], v[224:227], v[128:131], a[0:3]
ds_read_b64_tr_b16 v[234:235], v21 offset:1024
v_fmac_f32 v95, v72, v94
v_mfma_f32_16x16x32_bf16 a[0:3], v[228:231], v[132:135], a[0:3]
ds_read_b64_tr_b16 v[240:241], v22 offset:0
v_mul_f32 v95, v95, v97
v_mfma_f32_16x16x32_bf16 a[4:7], v[228:231], v[140:143], a[4:7]
s_add_u32 m0, s63, 102400
ds_read_b64_tr_b16 v[236:237], v21 offset:8192
v_mul_f32 v96, v75, v90
v_mfma_f32_16x16x32_bf16 a[4:7], v[224:227], v[136:139], a[4:7]
s_add_u32 s72, s69, 32768
buffer_load_dwordx4 v2, s[8:11], s72 offen lds
v_mfma_f32_16x16x32_bf16 a[8:11], v[224:227], v[144:147], a[8:11]
ds_read_b64_tr_b16 v[238:239], v21 offset:9216
v_lshlrev_b32 v97, 16, v66
v_mfma_f32_16x16x32_bf16 a[8:11], v[228:231], v[148:151], a[8:11]
v_fmac_f32 v96, v74, v91
v_fmac_f32 v96, v73, v92
v_mfma_f32_16x16x32_bf16 a[12:15], v[228:231], v[156:159], a[12:15]
s_add_u32 s72, s69, 39936
buffer_load_dwordx4 v3, s[8:11], s72 offen offset:1024 lds
v_mfma_f32_16x16x32_bf16 a[12:15], v[224:227], v[152:155], a[12:15]
s_waitcnt lgkmcnt(5)
ds_read_b64_tr_b16 v[242:243], v22 offset:1024
v_fmac_f32 v96, v72, v93
v_mfma_f32_16x16x32_bf16 a[16:19], v[224:227], v[160:163], a[16:19]
v_mul_f32 v96, v96, v97
v_cvt_pk_bf16_f32 v100, v95, v96
v_mfma_f32_16x16x32_bf16 a[16:19], v[228:231], v[164:167], a[16:19]
ds_read_b64_tr_b16 v[244:245], v22 offset:8192
v_mul_f32 v95, v75, v89
v_mfma_f32_16x16x32_bf16 a[20:23], v[228:231], v[172:175], a[20:23]
v_lshlrev_b32 v97, 16, v65
v_fmac_f32 v95, v74, v90
v_mfma_f32_16x16x32_bf16 a[20:23], v[224:227], v[168:171], a[20:23]
s_add_u32 s72, s69, 47104
buffer_load_dwordx4 v2, s[8:11], s72 offen offset:2048 lds
v_mfma_f32_16x16x32_bf16 a[24:27], v[224:227], v[176:179], a[24:27]
ds_read_b64_tr_b16 v[246:247], v22 offset:9216
v_fmac_f32 v95, v73, v91
v_mfma_f32_16x16x32_bf16 a[24:27], v[228:231], v[180:183], a[24:27]
v_fmac_f32 v95, v72, v92
v_mul_f32 v95, v95, v97
v_mfma_f32_16x16x32_bf16 a[28:31], v[228:231], v[188:191], a[28:31]
v_mul_f32 v96, v75, v88
v_lshlrev_b32 v97, 16, v64
v_mfma_f32_16x16x32_bf16 a[28:31], v[224:227], v[184:187], a[28:31]
s_waitcnt lgkmcnt(3)
v_fmac_f32 v96, v74, v89
v_fmac_f32 v96, v73, v90
v_mfma_f32_16x16x32_bf16 a[60:63], v[232:235], v[184:187], a[60:63]
s_add_u32 s72, s69, 54272
buffer_load_dwordx4 v3, s[8:11], s72 offen offset:3072 lds
v_mfma_f32_16x16x32_bf16 a[60:63], v[236:239], v[188:191], a[60:63]
ds_read_b64_tr_b16 v[248:249], v23 offset:0
v_fmac_f32 v96, v72, v91
v_mfma_f32_16x16x32_bf16 a[56:59], v[236:239], v[180:183], a[56:59]
v_mul_f32 v96, v96, v97
v_cvt_pk_bf16_f32 v101, v95, v96
v_mfma_f32_16x16x32_bf16 a[56:59], v[232:235], v[176:179], a[56:59]
s_add_u32 m0, s64, 49152
ds_read_b64_tr_b16 v[250:251], v23 offset:1024
v_mul_f32 v95, v75, v87
v_mfma_f32_16x16x32_bf16 a[52:55], v[232:235], v[168:171], a[52:55]
s_add_u32 s72, s71, 0
buffer_load_dwordx4 v6, s[20:23], s72 offen lds
v_mfma_f32_16x16x32_bf16 a[52:55], v[236:239], v[172:175], a[52:55]
v_lshlrev_b32 v97, 16, v63
v_fmac_f32 v95, v74, v88
v_mfma_f32_16x16x32_bf16 a[48:51], v[236:239], v[164:167], a[48:51]
v_fmac_f32 v95, v73, v89
v_fmac_f32 v95, v72, v90
v_mfma_f32_16x16x32_bf16 a[48:51], v[232:235], v[160:163], a[48:51]
ds_read_b64_tr_b16 v[252:253], v23 offset:8192
v_mul_f32 v95, v95, v97
v_mfma_f32_16x16x32_bf16 a[44:47], v[232:235], v[152:155], a[44:47]
s_add_u32 s72, s71, 31744
buffer_load_dwordx4 v6, s[20:23], s72 offen offset:1024 lds
v_mfma_f32_16x16x32_bf16 a[44:47], v[236:239], v[156:159], a[44:47]
v_mul_f32 v96, v75, v86
v_lshlrev_b32 v97, 16, v62
v_mfma_f32_16x16x32_bf16 a[40:43], v[236:239], v[148:151], a[40:43]
ds_read_b64_tr_b16 v[254:255], v23 offset:9216
v_fmac_f32 v96, v74, v87
v_mfma_f32_16x16x32_bf16 a[40:43], v[232:235], v[144:147], a[40:43]
v_fmac_f32 v96, v73, v88
v_fmac_f32 v96, v72, v89
v_mfma_f32_16x16x32_bf16 a[36:39], v[232:235], v[136:139], a[36:39]
s_add_u32 s72, s71, 63488
buffer_load_dwordx4 v7, s[20:23], s72 offen offset:2048 lds
v_mfma_f32_16x16x32_bf16 a[36:39], v[236:239], v[140:143], a[36:39]
v_mul_f32 v96, v96, v97
v_cvt_pk_bf16_f32 v102, v95, v96
v_mfma_f32_16x16x32_bf16 a[32:35], v[236:239], v[132:135], a[32:35]
v_mul_f32 v95, v75, v85
v_lshlrev_b32 v97, 16, v61
v_mfma_f32_16x16x32_bf16 a[32:35], v[232:235], v[128:131], a[32:35]
s_waitcnt lgkmcnt(4)
v_fmac_f32 v95, v74, v86
v_fmac_f32 v95, v73, v87
v_mfma_f32_16x16x32_bf16 a[64:67], v[240:243], v[128:131], a[64:67]
s_add_u32 s72, s71, 95232
buffer_load_dwordx4 v7, s[20:23], s72 offen offset:3072 lds
v_mfma_f32_16x16x32_bf16 a[64:67], v[244:247], v[132:135], a[64:67]
s_mov_b32 s80, 0x0
buffer_load_dword v126, v125, s[12:15], s80 offen
v_mfma_f32_16x16x32_bf16 a[68:71], v[244:247], v[140:143], a[68:71]
s_mov_b32 s80, 0x100000
buffer_load_dword v126, v125, s[12:15], s80 offen
v_mfma_f32_16x16x32_bf16 a[68:71], v[240:243], v[136:139], a[68:71]
s_mov_b32 s80, 0x200000
buffer_load_dword v126, v125, s[12:15], s80 offen
v_mfma_f32_16x16x32_bf16 a[72:75], v[240:243], v[144:147], a[72:75]
s_mov_b32 s80, 0x300000
buffer_load_dword v126, v125, s[12:15], s80 offen
v_mfma_f32_16x16x32_bf16 a[72:75], v[244:247], v[148:151], a[72:75]
ds_read_b64_tr_b16 v[224:225], v20 offset:16384
v_fmac_f32 v95, v72, v88
v_mfma_f32_16x16x32_bf16 a[76:79], v[244:247], v[156:159], a[76:79]
v_mul_f32 v95, v95, v97
v_mul_f32 v96, v75, v84
v_mfma_f32_16x16x32_bf16 a[76:79], v[240:243], v[152:155], a[76:79]
ds_read_b64_tr_b16 v[226:227], v20 offset:17408
v_lshlrev_b32 v97, 16, v60
v_mfma_f32_16x16x32_bf16 a[80:83], v[240:243], v[160:163], a[80:83]
v_fmac_f32 v96, v74, v85
v_fmac_f32 v96, v73, v86
v_mfma_f32_16x16x32_bf16 a[80:83], v[244:247], v[164:167], a[80:83]
ds_read_b64_tr_b16 v[228:229], v20 offset:24576
v_fmac_f32 v96, v72, v87
v_mfma_f32_16x16x32_bf16 a[84:87], v[244:247], v[172:175], a[84:87]
v_mul_f32 v96, v96, v97
v_cvt_pk_bf16_f32 v103, v95, v96
v_mfma_f32_16x16x32_bf16 a[84:87], v[240:243], v[168:171], a[84:87]
ds_read_b64_tr_b16 v[230:231], v20 offset:25600
ds_write_b128 v28, v[100:103] offset:0
v_mfma_f32_16x16x32_bf16 a[88:91], v[240:243], v[176:179], a[88:91]
v_mul_f32 v95, v75, v83
v_lshlrev_b32 v97, 16, v59
v_mfma_f32_16x16x32_bf16 a[88:91], v[244:247], v[180:183], a[88:91]
v_fmac_f32 v95, v74, v84
v_fmac_f32 v95, v73, v85
v_mfma_f32_16x16x32_bf16 a[92:95], v[244:247], v[188:191], a[92:95]
v_fmac_f32 v95, v72, v86
v_mul_f32 v95, v95, v97
v_mfma_f32_16x16x32_bf16 a[92:95], v[240:243], v[184:187], a[92:95]
s_waitcnt lgkmcnt(5)
v_mul_f32 v96, v75, v82
v_lshlrev_b32 v97, 16, v58
v_mfma_f32_16x16x32_bf16 a[124:127], v[248:251], v[184:187], a[124:127]
ds_read_b64_tr_b16 v[232:233], v21 offset:16384
v_fmac_f32 v96, v74, v83
v_mfma_f32_16x16x32_bf16 a[124:127], v[252:255], v[188:191], a[124:127]
v_fmac_f32 v96, v73, v84
v_fmac_f32 v96, v72, v85
v_mfma_f32_16x16x32_bf16 a[120:123], v[252:255], v[180:183], a[120:123]
v_mul_f32 v96, v96, v97
v_cvt_pk_bf16_f32 v104, v95, v96
v_mfma_f32_16x16x32_bf16 a[120:123], v[248:251], v[176:179], a[120:123]
ds_read_b64_tr_b16 v[234:235], v21 offset:17408
v_mul_f32 v95, v75, v81
v_mfma_f32_16x16x32_bf16 a[116:119], v[248:251], v[168:171], a[116:119]
v_lshlrev_b32 v97, 16, v57
v_fmac_f32 v95, v74, v82
v_mfma_f32_16x16x32_bf16 a[116:119], v[252:255], v[172:175], a[116:119]
v_fmac_f32 v95, v73, v83
v_fmac_f32 v95, v72, v84
v_mfma_f32_16x16x32_bf16 a[112:115], v[252:255], v[164:167], a[112:115]
v_mul_f32 v95, v95, v97
v_mul_f32 v96, v75, v80
v_mfma_f32_16x16x32_bf16 a[112:115], v[248:251], v[160:163], a[112:115]
ds_read_b64_tr_b16 v[236:237], v21 offset:24576
v_lshlrev_b32 v97, 16, v56
v_mfma_f32_16x16x32_bf16 a[108:111], v[248:251], v[152:155], a[108:111]
v_fmac_f32 v96, v74, v81
v_fmac_f32 v96, v73, v82
v_mfma_f32_16x16x32_bf16 a[108:111], v[252:255], v[156:159], a[108:111]
v_fmac_f32 v96, v72, v83
v_mul_f32 v96, v96, v97
v_mfma_f32_16x16x32_bf16 a[104:107], v[252:255], v[148:151], a[104:107]
ds_read_b64_tr_b16 v[238:239], v21 offset:25600
v_cvt_pk_bf16_f32 v105, v95, v96
v_mfma_f32_16x16x32_bf16 a[104:107], v[248:251], v[144:147], a[104:107]
v_mul_f32 v95, v75, v79
v_lshlrev_b32 v97, 16, v55
v_mfma_f32_16x16x32_bf16 a[100:103], v[248:251], v[136:139], a[100:103]
v_fmac_f32 v95, v74, v80
v_fmac_f32 v95, v73, v81
v_mfma_f32_16x16x32_bf16 a[100:103], v[252:255], v[140:143], a[100:103]
v_fmac_f32 v95, v72, v82
v_mul_f32 v95, v95, v97
v_mfma_f32_16x16x32_bf16 a[96:99], v[252:255], v[132:135], a[96:99]
v_mul_f32 v96, v75, v78
v_lshlrev_b32 v97, 16, v54
v_mfma_f32_16x16x32_bf16 a[96:99], v[248:251], v[128:131], a[96:99]
s_waitcnt lgkmcnt(5)
v_fmac_f32 v96, v74, v79
v_fmac_f32 v96, v73, v80
v_mfma_f32_16x16x32_bf16 a[128:131], v[128:131], v[224:227], a[128:131]
ds_read_b64_tr_b16 v[240:241], v22 offset:16384
v_fmac_f32 v96, v72, v81
v_mfma_f32_16x16x32_bf16 a[128:131], v[132:135], v[228:231], a[128:131]
v_mul_f32 v96, v96, v97
v_cvt_pk_bf16_f32 v106, v95, v96
v_mfma_f32_16x16x32_bf16 a[132:135], v[140:143], v[228:231], a[132:135]
v_mul_f32 v95, v75, v77
v_lshlrev_b32 v97, 16, v53
v_mfma_f32_16x16x32_bf16 a[132:135], v[136:139], v[224:227], a[132:135]
ds_read_b64_tr_b16 v[242:243], v22 offset:17408
v_fmac_f32 v95, v74, v78
v_mfma_f32_16x16x32_bf16 a[136:139], v[144:147], v[224:227], a[136:139]
v_fmac_f32 v95, v73, v79
v_fmac_f32 v95, v72, v80
v_mfma_f32_16x16x32_bf16 a[136:139], v[148:151], v[228:231], a[136:139]
v_mul_f32 v95, v95, v97
v_mul_f32 v96, v75, v76
v_mfma_f32_16x16x32_bf16 a[140:143], v[156:159], v[228:231], a[140:143]
v_lshlrev_b32 v97, 16, v52
v_fmac_f32 v96, v74, v77
v_mfma_f32_16x16x32_bf16 a[140:143], v[152:155], v[224:227], a[140:143]
ds_read_b64_tr_b16 v[244:245], v22 offset:24576
v_fmac_f32 v96, v73, v78
v_mfma_f32_16x16x32_bf16 a[144:147], v[160:163], v[224:227], a[144:147]
v_fmac_f32 v96, v72, v79
v_mul_f32 v96, v96, v97
v_mfma_f32_16x16x32_bf16 a[144:147], v[164:167], v[228:231], a[144:147]
v_cvt_pk_bf16_f32 v107, v95, v96
v_mfma_f32_16x16x32_bf16 a[148:151], v[172:175], v[228:231], a[148:151]
ds_read_b64_tr_b16 v[246:247], v22 offset:25600
ds_write_b128 v28, v[104:107] offset:16
v_mfma_f32_16x16x32_bf16 a[148:151], v[168:171], v[224:227], a[148:151]
global_load_dwordx4 v[84:87], v1, s[56:57]
v_mfma_f32_16x16x32_bf16 a[152:155], v[176:179], v[224:227], a[152:155]
global_load_dwordx4 v[88:91], v1, s[56:57] offset:1024
v_mfma_f32_16x16x32_bf16 a[152:155], v[180:183], v[228:231], a[152:155]
v_lshlrev_b32 v72, 16, v70
v_and_b32 v73, 0xffff0000, v70
v_mfma_f32_16x16x32_bf16 a[156:159], v[188:191], v[228:231], a[156:159]
v_lshlrev_b32 v74, 16, v71
v_and_b32 v75, 0xffff0000, v71
v_mfma_f32_16x16x32_bf16 a[156:159], v[184:187], v[224:227], a[156:159]
s_waitcnt lgkmcnt(5)
v_and_b32 v33, 0xffff0000, v33
v_and_b32 v34, 0xffff0000, v34
v_mfma_f32_16x16x32_bf16 a[188:191], v[184:187], v[232:235], a[188:191]
ds_read_b64_tr_b16 v[248:249], v23 offset:16384
v_and_b32 v35, 0xffff0000, v35
v_mfma_f32_16x16x32_bf16 a[188:191], v[188:191], v[236:239], a[188:191]
v_and_b32 v36, 0xffff0000, v36
v_and_b32 v37, 0xffff0000, v37
v_mfma_f32_16x16x32_bf16 a[184:187], v[180:183], v[236:239], a[184:187]
ds_read_b64_tr_b16 v[250:251], v23 offset:17408
v_and_b32 v38, 0xffff0000, v38
v_mfma_f32_16x16x32_bf16 a[184:187], v[176:179], v[232:235], a[184:187]
v_and_b32 v39, 0xffff0000, v39
v_and_b32 v40, 0xffff0000, v40
v_mfma_f32_16x16x32_bf16 a[180:183], v[168:171], v[232:235], a[180:183]
ds_read_b64_tr_b16 v[252:253], v23 offset:24576
v_and_b32 v41, 0xffff0000, v41
v_mfma_f32_16x16x32_bf16 a[180:183], v[172:175], v[236:239], a[180:183]
v_and_b32 v42, 0xffff0000, v42
v_and_b32 v43, 0xffff0000, v43
v_mfma_f32_16x16x32_bf16 a[176:179], v[164:167], v[236:239], a[176:179]
ds_read_b64_tr_b16 v[254:255], v23 offset:25600
v_and_b32 v44, 0xffff0000, v44
v_mfma_f32_16x16x32_bf16 a[176:179], v[160:163], v[232:235], a[176:179]
v_and_b32 v45, 0xffff0000, v45
v_and_b32 v46, 0xffff0000, v46
v_mfma_f32_16x16x32_bf16 a[172:175], v[152:155], v[232:235], a[172:175]
v_and_b32 v47, 0xffff0000, v47
v_and_b32 v48, 0xffff0000, v48
v_mfma_f32_16x16x32_bf16 a[172:175], v[156:159], v[236:239], a[172:175]
v_and_b32 v49, 0xffff0000, v49
v_and_b32 v50, 0xffff0000, v50
v_mfma_f32_16x16x32_bf16 a[168:171], v[148:151], v[236:239], a[168:171]
v_and_b32 v51, 0xffff0000, v51
v_mul_f32 v95, v75, v48
v_mfma_f32_16x16x32_bf16 a[168:171], v[144:147], v[232:235], a[168:171]
v_and_b32 v97, 0xffff0000, v67
v_fmac_f32 v95, v74, v49
v_mfma_f32_16x16x32_bf16 a[164:167], v[136:139], v[232:235], a[164:167]
v_fmac_f32 v95, v73, v50
v_fmac_f32 v95, v72, v51
v_mfma_f32_16x16x32_bf16 a[164:167], v[140:143], v[236:239], a[164:167]
v_mul_f32 v95, v95, v97
v_mul_f32 v96, v75, v47
v_mfma_f32_16x16x32_bf16 a[160:163], v[132:135], v[236:239], a[160:163]
s_waitcnt vmcnt(6) lgkmcnt(0)
v_and_b32 v97, 0xffff0000, v66
v_fmac_f32 v96, v74, v48
v_mfma_f32_16x16x32_bf16 a[160:163], v[128:131], v[232:235], a[160:163]
s_barrier
v_fmac_f32 v96, v73, v49
v_fmac_f32 v96, v72, v50
v_mfma_f32_16x16x32_bf16 a[192:195], v[128:131], v[240:243], a[192:195]
s_and_b32 s73, s65, 1
ds_read_b64_tr_b16 v[224:225], v20 offset:32768
v_mul_f32 v96, v96, v97
v_mfma_f32_16x16x32_bf16 a[192:195], v[132:135], v[244:247], a[192:195]
s_xor_b32 s73, s73, 6
ds_read_b64_tr_b16 v[226:227], v20 offset:33792
v_cvt_pk_bf16_f32 v100, v95, v96
v_mfma_f32_16x16x32_bf16 a[196:199], v[140:143], v[244:247], a[196:199]
s_lshl_b32 s69, s73, 7
ds_read_b64_tr_b16 v[228:229], v20 offset:40960
v_mul_f32 v95, v75, v46
v_mfma_f32_16x16x32_bf16 a[196:199], v[136:139], v[240:243], a[196:199]
s_add_u32 s69, s69, s84
ds_read_b64_tr_b16 v[230:231], v20 offset:41984
v_and_b32 v97, 0xffff0000, v65
v_mfma_f32_16x16x32_bf16 a[200:203], v[144:147], v[240:243], a[200:203]
s_lshl_b32 s71, s73, 19
ds_read_b128 v[192:195], v24 offset:32768
v_fmac_f32 v95, v74, v47
v_mfma_f32_16x16x32_bf16 a[200:203], v[148:151], v[244:247], a[200:203]
s_add_u32 s71, s71, s66
ds_read_b128 v[196:199], v25 offset:32768
v_fmac_f32 v95, v73, v48
v_mfma_f32_16x16x32_bf16 a[204:207], v[156:159], v[244:247], a[204:207]
s_add_u32 m0, s63, 65536
v_fmac_f32 v95, v72, v49
v_mul_f32 v95, v95, v97
v_mfma_f32_16x16x32_bf16 a[204:207], v[152:155], v[240:243], a[204:207]
s_add_u32 s72, s69, 0
buffer_load_dwordx4 v2, s[8:11], s72 offen lds
v_mfma_f32_16x16x32_bf16 a[208:211], v[160:163], v[240:243], a[208:211]
s_add_u32 s72, s69, 7168
buffer_load_dwordx4 v3, s[8:11], s72 offen offset:1024 lds
v_mfma_f32_16x16x32_bf16 a[208:211], v[164:167], v[244:247], a[208:211]
s_add_u32 s72, s69, 14336
buffer_load_dwordx4 v2, s[8:11], s72 offen offset:2048 lds
v_mfma_f32_16x16x32_bf16 a[212:215], v[172:175], v[244:247], a[212:215]
ds_read_b128 v[200:203], v24 offset:34816
v_mul_f32 v96, v75, v45
v_mfma_f32_16x16x32_bf16 a[212:215], v[168:171], v[240:243], a[212:215]
ds_read_b128 v[204:207], v25 offset:34816
v_and_b32 v97, 0xffff0000, v64
v_mfma_f32_16x16x32_bf16 a[216:219], v[176:179], v[240:243], a[216:219]
s_add_u32 s72, s69, 21504
buffer_load_dwordx4 v3, s[8:11], s72 offen offset:3072 lds
v_mfma_f32_16x16x32_bf16 a[216:219], v[180:183], v[244:247], a[216:219]
ds_read_b128 v[208:211], v24 offset:36864
v_fmac_f32 v96, v74, v46
v_mfma_f32_16x16x32_bf16 a[220:223], v[188:191], v[244:247], a[220:223]
ds_read_b128 v[212:215], v25 offset:36864
v_fmac_f32 v96, v73, v47
v_mfma_f32_16x16x32_bf16 a[220:223], v[184:187], v[240:243], a[220:223]
ds_read_b128 v[216:219], v24 offset:38912
v_fmac_f32 v96, v72, v48
v_mfma_f32_16x16x32_bf16 a[252:255], v[184:187], v[248:251], a[252:255]
ds_read_b128 v[220:223], v25 offset:38912
v_mul_f32 v96, v96, v97
v_mfma_f32_16x16x32_bf16 a[252:255], v[188:191], v[252:255], a[252:255]
s_add_u32 m0, s64, 0
v_cvt_pk_bf16_f32 v101, v95, v96
v_mul_f32 v95, v75, v44
v_mfma_f32_16x16x32_bf16 a[248:251], v[180:183], v[252:255], a[248:251]
s_add_u32 s72, s71, 0
buffer_load_dwordx4 v6, s[16:19], s72 offen lds
v_mfma_f32_16x16x32_bf16 a[248:251], v[176:179], v[248:251], a[248:251]
ds_read_b128 v[184:187], v24 offset:40960
v_and_b32 v97, 0xffff0000, v63
v_mfma_f32_16x16x32_bf16 a[244:247], v[168:171], v[248:251], a[244:247]
ds_read_b128 v[188:191], v25 offset:40960
v_fmac_f32 v95, v74, v45
v_mfma_f32_16x16x32_bf16 a[244:247], v[172:175], v[252:255], a[244:247]
s_add_u32 s72, s71, 31744
buffer_load_dwordx4 v6, s[16:19], s72 offen offset:1024 lds
v_mfma_f32_16x16x32_bf16 a[240:243], v[164:167], v[252:255], a[240:243]
ds_read_b128 v[176:179], v24 offset:43008
v_fmac_f32 v95, v73, v46
v_mfma_f32_16x16x32_bf16 a[240:243], v[160:163], v[248:251], a[240:243]
ds_read_b128 v[180:183], v25 offset:43008
v_fmac_f32 v95, v72, v47
v_mfma_f32_16x16x32_bf16 a[236:239], v[152:155], v[248:251], a[236:239]
ds_read_b128 v[168:171], v24 offset:45056
v_mul_f32 v95, v95, v97
v_mfma_f32_16x16x32_bf16 a[236:239], v[156:159], v[252:255], a[236:239]
s_add_u32 s72, s71, 63488
buffer_load_dwordx4 v7, s[16:19], s72 offen offset:2048 lds
v_mfma_f32_16x16x32_bf16 a[232:235], v[148:151], v[252:255], a[232:235]
ds_read_b128 v[172:175], v25 offset:45056
v_mul_f32 v96, v75, v43
v_mfma_f32_16x16x32_bf16 a[232:235], v[144:147], v[248:251], a[232:235]
ds_read_b128 v[160:163], v24 offset:47104
v_and_b32 v97, 0xffff0000, v62
v_mfma_f32_16x16x32_bf16 a[228:231], v[136:139], v[248:251], a[228:231]
ds_read_b128 v[164:167], v25 offset:47104
v_fmac_f32 v96, v74, v44
v_mfma_f32_16x16x32_bf16 a[228:231], v[140:143], v[252:255], a[228:231]
v_fmac_f32 v96, v73, v45
v_fmac_f32 v96, v72, v46
v_mfma_f32_16x16x32_bf16 a[224:227], v[132:135], v[252:255], a[224:227]
s_add_u32 s72, s71, 95232
buffer_load_dwordx4 v7, s[16:19], s72 offen offset:3072 lds
v_mfma_f32_16x16x32_bf16 a[224:227], v[128:131], v[248:251], a[224:227]
s_waitcnt lgkmcnt(8)
ds_read_b64_tr_b16 v[232:233], v21 offset:32768
v_mul_f32 v96, v96, v97
v_mfma_f32_16x16x32_bf16 a[0:3], v[224:227], v[192:195], a[0:3]
ds_read_b64_tr_b16 v[234:235], v21 offset:33792
v_cvt_pk_bf16_f32 v102, v95, v96
v_mfma_f32_16x16x32_bf16 a[0:3], v[228:231], v[196:199], a[0:3]
ds_read_b64_tr_b16 v[240:241], v22 offset:32768
v_mul_f32 v95, v75, v42
v_mfma_f32_16x16x32_bf16 a[4:7], v[228:231], v[204:207], a[4:7]
s_add_u32 m0, s63, 69632
ds_read_b64_tr_b16 v[236:237], v21 offset:40960
v_and_b32 v97, 0xffff0000, v61
v_mfma_f32_16x16x32_bf16 a[4:7], v[224:227], v[200:203], a[4:7]
s_add_u32 s72, s69, 32768
buffer_load_dwordx4 v2, s[8:11], s72 offen lds
v_mfma_f32_16x16x32_bf16 a[8:11], v[224:227], v[208:211], a[8:11]
ds_read_b64_tr_b16 v[238:239], v21 offset:41984
v_fmac_f32 v95, v74, v43
v_mfma_f32_16x16x32_bf16 a[8:11], v[228:231], v[212:215], a[8:11]
v_fmac_f32 v95, v73, v44
v_fmac_f32 v95, v72, v45
v_mfma_f32_16x16x32_bf16 a[12:15], v[228:231], v[220:223], a[12:15]
s_add_u32 s72, s69, 39936
buffer_load_dwordx4 v3, s[8:11], s72 offen offset:1024 lds
v_mfma_f32_16x16x32_bf16 a[12:15], v[224:227], v[216:219], a[12:15]
s_waitcnt lgkmcnt(5)
ds_read_b64_tr_b16 v[242:243], v22 offset:33792
v_mul_f32 v95, v95, v97
v_mfma_f32_16x16x32_bf16 a[16:19], v[224:227], v[184:187], a[16:19]
v_mul_f32 v96, v75, v41
v_and_b32 v97, 0xffff0000, v60
v_mfma_f32_16x16x32_bf16 a[16:19], v[228:231], v[188:191], a[16:19]
ds_read_b64_tr_b16 v[244:245], v22 offset:40960
v_fmac_f32 v96, v74, v42
v_mfma_f32_16x16x32_bf16 a[20:23], v[228:231], v[180:183], a[20:23]
v_fmac_f32 v96, v73, v43
v_fmac_f32 v96, v72, v44
v_mfma_f32_16x16x32_bf16 a[20:23], v[224:227], v[176:179], a[20:23]
s_add_u32 s72, s69, 47104
buffer_load_dwordx4 v2, s[8:11], s72 offen offset:2048 lds
v_mfma_f32_16x16x32_bf16 a[24:27], v[224:227], v[168:171], a[24:27]
ds_read_b64_tr_b16 v[246:247], v22 offset:41984
v_mul_f32 v96, v96, v97
v_mfma_f32_16x16x32_bf16 a[24:27], v[228:231], v[172:175], a[24:27]
v_cvt_pk_bf16_f32 v103, v95, v96
v_mfma_f32_16x16x32_bf16 a[28:31], v[228:231], v[164:167], a[28:31]
ds_write_b128 v28, v[100:103] offset:272
v_mul_f32 v95, v75, v40
v_mfma_f32_16x16x32_bf16 a[28:31], v[224:227], v[160:163], a[28:31]
s_waitcnt lgkmcnt(4)
v_and_b32 v97, 0xffff0000, v59
v_fmac_f32 v95, v74, v41
v_mfma_f32_16x16x32_bf16 a[60:63], v[232:235], v[160:163], a[60:63]
s_add_u32 s72, s69, 54272
buffer_load_dwordx4 v3, s[8:11], s72 offen offset:3072 lds
v_mfma_f32_16x16x32_bf16 a[60:63], v[236:239], v[164:167], a[60:63]
ds_read_b64_tr_b16 v[248:249], v23 offset:32768
v_fmac_f32 v95, v73, v42
v_mfma_f32_16x16x32_bf16 a[56:59], v[236:239], v[172:175], a[56:59]
v_fmac_f32 v95, v72, v43
v_mul_f32 v95, v95, v97
v_mfma_f32_16x16x32_bf16 a[56:59], v[232:235], v[168:171], a[56:59]
s_add_u32 m0, s64, 16384
ds_read_b64_tr_b16 v[250:251], v23 offset:33792
v_mul_f32 v96, v75, v39
v_mfma_f32_16x16x32_bf16 a[52:55], v[232:235], v[176:179], a[52:55]
s_add_u32 s72, s71, 0
buffer_load_dwordx4 v6, s[20:23], s72 offen lds
v_mfma_f32_16x16x32_bf16 a[52:55], v[236:239], v[180:183], a[52:55]
v_and_b32 v97, 0xffff0000, v58
v_fmac_f32 v96, v74, v40
v_mfma_f32_16x16x32_bf16 a[48:51], v[236:239], v[188:191], a[48:51]
v_fmac_f32 v96, v73, v41
v_fmac_f32 v96, v72, v42
v_mfma_f32_16x16x32_bf16 a[48:51], v[232:235], v[184:187], a[48:51]
ds_read_b64_tr_b16 v[252:253], v23 offset:40960
v_mul_f32 v96, v96, v97
v_mfma_f32_16x16x32_bf16 a[44:47], v[232:235], v[216:219], a[44:47]
s_add_u32 s72, s71, 31744
buffer_load_dwordx4 v6, s[20:23], s72 offen offset:1024 lds
v_mfma_f32_16x16x32_bf16 a[44:47], v[236:239], v[220:223], a[44:47]
v_cvt_pk_bf16_f32 v104, v95, v96
v_mul_f32 v95, v75, v38
v_mfma_f32_16x16x32_bf16 a[40:43], v[236:239], v[212:215], a[40:43]
ds_read_b64_tr_b16 v[254:255], v23 offset:41984
v_and_b32 v97, 0xffff0000, v57
v_mfma_f32_16x16x32_bf16 a[40:43], v[232:235], v[208:211], a[40:43]
v_fmac_f32 v95, v74, v39
v_fmac_f32 v95, v73, v40
v_mfma_f32_16x16x32_bf16 a[36:39], v[232:235], v[200:203], a[36:39]
s_add_u32 s72, s71, 63488
buffer_load_dwordx4 v7, s[20:23], s72 offen offset:2048 lds
v_mfma_f32_16x16x32_bf16 a[36:39], v[236:239], v[204:207], a[36:39]
v_fmac_f32 v95, v72, v41
v_mul_f32 v95, v95, v97
v_mfma_f32_16x16x32_bf16 a[32:35], v[236:239], v[196:199], a[32:35]
v_mul_f32 v96, v75, v37
v_and_b32 v97, 0xffff0000, v56
v_mfma_f32_16x16x32_bf16 a[32:35], v[232:235], v[192:195], a[32:35]
s_waitcnt lgkmcnt(5)
v_fmac_f32 v96, v74, v38
v_fmac_f32 v96, v73, v39
v_mfma_f32_16x16x32_bf16 a[64:67], v[240:243], v[192:195], a[64:67]
s_add_u32 s72, s71, 95232
buffer_load_dwordx4 v7, s[20:23], s72 offen offset:3072 lds
v_mfma_f32_16x16x32_bf16 a[64:67], v[244:247], v[196:199], a[64:67]
s_mov_b32 s80, 0x400000
buffer_load_dword v126, v125, s[12:15], s80 offen
v_mfma_f32_16x16x32_bf16 a[68:71], v[244:247], v[204:207], a[68:71]
s_mov_b32 s80, 0x500000
buffer_load_dword v126, v125, s[12:15], s80 offen
v_mfma_f32_16x16x32_bf16 a[68:71], v[240:243], v[200:203], a[68:71]
s_mov_b32 s80, 0x600000
buffer_load_dword v126, v125, s[12:15], s80 offen
v_mfma_f32_16x16x32_bf16 a[72:75], v[240:243], v[208:211], a[72:75]
s_mov_b32 s80, 0x700000
buffer_load_dword v126, v125, s[12:15], s80 offen
v_mfma_f32_16x16x32_bf16 a[72:75], v[244:247], v[212:215], a[72:75]
ds_read_b64_tr_b16 v[224:225], v20 offset:49152
v_fmac_f32 v96, v72, v40
v_mfma_f32_16x16x32_bf16 a[76:79], v[244:247], v[220:223], a[76:79]
v_mul_f32 v96, v96, v97
v_cvt_pk_bf16_f32 v105, v95, v96
v_mfma_f32_16x16x32_bf16 a[76:79], v[240:243], v[216:219], a[76:79]
ds_read_b64_tr_b16 v[226:227], v20 offset:50176
v_mul_f32 v95, v75, v36
v_mfma_f32_16x16x32_bf16 a[80:83], v[240:243], v[184:187], a[80:83]
v_and_b32 v97, 0xffff0000, v55
v_fmac_f32 v95, v74, v37
v_mfma_f32_16x16x32_bf16 a[80:83], v[244:247], v[188:191], a[80:83]
ds_read_b64_tr_b16 v[228:229], v20 offset:57344
v_fmac_f32 v95, v73, v38
v_mfma_f32_16x16x32_bf16 a[84:87], v[244:247], v[180:183], a[84:87]
v_fmac_f32 v95, v72, v39
v_mul_f32 v95, v95, v97
v_mfma_f32_16x16x32_bf16 a[84:87], v[240:243], v[176:179], a[84:87]
ds_read_b64_tr_b16 v[230:231], v20 offset:58368
v_mul_f32 v96, v75, v35
v_mfma_f32_16x16x32_bf16 a[88:91], v[240:243], v[168:171], a[88:91]
v_and_b32 v97, 0xffff0000, v54
v_fmac_f32 v96, v74, v36
v_mfma_f32_16x16x32_bf16 a[88:91], v[244:247], v[172:175], a[88:91]
v_fmac_f32 v96, v73, v37
v_fmac_f32 v96, v72, v38
v_mfma_f32_16x16x32_bf16 a[92:95], v[244:247], v[164:167], a[92:95]
v_mul_f32 v96, v96, v97
v_cvt_pk_bf16_f32 v106, v95, v96
v_mfma_f32_16x16x32_bf16 a[92:95], v[240:243], v[160:163], a[92:95]
s_waitcnt lgkmcnt(4)
v_mul_f32 v95, v75, v34
v_and_b32 v97, 0xffff0000, v53
v_mfma_f32_16x16x32_bf16 a[124:127], v[248:251], v[160:163], a[124:127]
ds_read_b64_tr_b16 v[232:233], v21 offset:49152
v_fmac_f32 v95, v74, v35
v_mfma_f32_16x16x32_bf16 a[124:127], v[252:255], v[164:167], a[124:127]
v_fmac_f32 v95, v73, v36
v_fmac_f32 v95, v72, v37
v_mfma_f32_16x16x32_bf16 a[120:123], v[252:255], v[172:175], a[120:123]
v_mul_f32 v95, v95, v97
v_mul_f32 v96, v75, v33
v_mfma_f32_16x16x32_bf16 a[120:123], v[248:251], v[168:171], a[120:123]
ds_read_b64_tr_b16 v[234:235], v21 offset:50176
v_and_b32 v97, 0xffff0000, v52
v_mfma_f32_16x16x32_bf16 a[116:119], v[248:251], v[176:179], a[116:119]
v_fmac_f32 v96, v74, v34
v_fmac_f32 v96, v73, v35
v_mfma_f32_16x16x32_bf16 a[116:119], v[252:255], v[180:183], a[116:119]
v_fmac_f32 v96, v72, v36
v_mul_f32 v96, v96, v97
v_mfma_f32_16x16x32_bf16 a[112:115], v[252:255], v[188:191], a[112:115]
v_cvt_pk_bf16_f32 v107, v95, v96
v_mfma_f32_16x16x32_bf16 a[112:115], v[248:251], v[184:187], a[112:115]
ds_read_b64_tr_b16 v[236:237], v21 offset:57344
ds_write_b128 v28, v[104:107] offset:288
v_mfma_f32_16x16x32_bf16 a[108:111], v[248:251], v[216:219], a[108:111]
v_mfma_f32_16x16x32_bf16 a[108:111], v[252:255], v[220:223], a[108:111]
v_mfma_f32_16x16x32_bf16 a[104:107], v[252:255], v[212:215], a[104:107]
ds_read_b64_tr_b16 v[238:239], v21 offset:58368
v_mfma_f32_16x16x32_bf16 a[104:107], v[248:251], v[208:211], a[104:107]
v_mfma_f32_16x16x32_bf16 a[100:103], v[248:251], v[200:203], a[100:103]
v_mfma_f32_16x16x32_bf16 a[100:103], v[252:255], v[204:207], a[100:103]
v_mfma_f32_16x16x32_bf16 a[96:99], v[252:255], v[196:199], a[96:99]
v_mfma_f32_16x16x32_bf16 a[96:99], v[248:251], v[192:195], a[96:99]
s_waitcnt lgkmcnt(5)
v_mfma_f32_16x16x32_bf16 a[128:131], v[192:195], v[224:227], a[128:131]
ds_read_b64_tr_b16 v[240:241], v22 offset:49152
v_mfma_f32_16x16x32_bf16 a[128:131], v[196:199], v[228:231], a[128:131]
v_mfma_f32_16x16x32_bf16 a[132:135], v[204:207], v[228:231], a[132:135]
v_mfma_f32_16x16x32_bf16 a[132:135], v[200:203], v[224:227], a[132:135]
ds_read_b64_tr_b16 v[242:243], v22 offset:50176
v_mfma_f32_16x16x32_bf16 a[136:139], v[208:211], v[224:227], a[136:139]
v_mfma_f32_16x16x32_bf16 a[136:139], v[212:215], v[228:231], a[136:139]
v_mfma_f32_16x16x32_bf16 a[140:143], v[220:223], v[228:231], a[140:143]
v_mfma_f32_16x16x32_bf16 a[140:143], v[216:219], v[224:227], a[140:143]
ds_read_b64_tr_b16 v[244:245], v22 offset:57344
v_mfma_f32_16x16x32_bf16 a[144:147], v[184:187], v[224:227], a[144:147]
v_mfma_f32_16x16x32_bf16 a[144:147], v[188:191], v[228:231], a[144:147]
v_mfma_f32_16x16x32_bf16 a[148:151], v[180:183], v[228:231], a[148:151]
ds_read_b64_tr_b16 v[246:247], v22 offset:58368
v_mfma_f32_16x16x32_bf16 a[148:151], v[176:179], v[224:227], a[148:151]
v_mfma_f32_16x16x32_bf16 a[152:155], v[168:171], v[224:227], a[152:155]
v_mfma_f32_16x16x32_bf16 a[152:155], v[172:175], v[228:231], a[152:155]
v_mfma_f32_16x16x32_bf16 a[156:159], v[164:167], v[228:231], a[156:159]
v_mfma_f32_16x16x32_bf16 a[156:159], v[160:163], v[224:227], a[156:159]
s_waitcnt lgkmcnt(4)
v_mfma_f32_16x16x32_bf16 a[188:191], v[160:163], v[232:235], a[188:191]
ds_read_b64_tr_b16 v[248:249], v23 offset:49152
v_mfma_f32_16x16x32_bf16 a[188:191], v[164:167], v[236:239], a[188:191]
v_mfma_f32_16x16x32_bf16 a[184:187], v[172:175], v[236:239], a[184:187]
ds_read_b64_tr_b16 v[250:251], v23 offset:50176
v_mfma_f32_16x16x32_bf16 a[184:187], v[168:171], v[232:235], a[184:187]
v_mfma_f32_16x16x32_bf16 a[180:183], v[176:179], v[232:235], a[180:183]
ds_read_b64_tr_b16 v[252:253], v23 offset:57344
v_mfma_f32_16x16x32_bf16 a[180:183], v[180:183], v[236:239], a[180:183]
v_mfma_f32_16x16x32_bf16 a[176:179], v[188:191], v[236:239], a[176:179]
ds_read_b64_tr_b16 v[254:255], v23 offset:58368
v_mfma_f32_16x16x32_bf16 a[176:179], v[184:187], v[232:235], a[176:179]
v_mfma_f32_16x16x32_bf16 a[172:175], v[216:219], v[232:235], a[172:175]
v_mfma_f32_16x16x32_bf16 a[172:175], v[220:223], v[236:239], a[172:175]
v_mfma_f32_16x16x32_bf16 a[168:171], v[212:215], v[236:239], a[168:171]
v_mfma_f32_16x16x32_bf16 a[168:171], v[208:211], v[232:235], a[168:171]
v_mfma_f32_16x16x32_bf16 a[164:167], v[200:203], v[232:235], a[164:167]
v_mfma_f32_16x16x32_bf16 a[164:167], v[204:207], v[236:239], a[164:167]
v_mfma_f32_16x16x32_bf16 a[160:163], v[196:199], v[236:239], a[160:163]
s_waitcnt vmcnt(4) lgkmcnt(0)
v_mfma_f32_16x16x32_bf16 a[160:163], v[192:195], v[232:235], a[160:163]
s_barrier
v_mfma_f32_16x16x32_bf16 a[192:195], v[192:195], v[240:243], a[192:195]
s_and_b32 s73, s65, 1
ds_read_b64_tr_b16 v[224:225], v20 offset:0
v_mfma_f32_16x16x32_bf16 a[192:195], v[196:199], v[244:247], a[192:195]
s_xor_b32 s73, s73, 7
ds_read_b64_tr_b16 v[226:227], v20 offset:1024
v_mfma_f32_16x16x32_bf16 a[196:199], v[204:207], v[244:247], a[196:199]
s_lshl_b32 s69, s73, 7
ds_read_b64_tr_b16 v[228:229], v20 offset:8192
v_mfma_f32_16x16x32_bf16 a[196:199], v[200:203], v[240:243], a[196:199]
s_add_u32 s69, s69, s84
ds_read_b64_tr_b16 v[230:231], v20 offset:9216
v_mfma_f32_16x16x32_bf16 a[200:203], v[208:211], v[240:243], a[200:203]
s_lshl_b32 s71, s73, 19
ds_read_b128 v[128:131], v24 offset:0
v_mfma_f32_16x16x32_bf16 a[200:203], v[212:215], v[244:247], a[200:203]
s_add_u32 s71, s71, s66
ds_read_b128 v[132:135], v25 offset:0
v_mfma_f32_16x16x32_bf16 a[204:207], v[220:223], v[244:247], a[204:207]
s_add_u32 m0, s63, 98304
v_mfma_f32_16x16x32_bf16 a[204:207], v[216:219], v[240:243], a[204:207]
s_add_u32 s72, s69, 0
buffer_load_dwordx4 v2, s[8:11], s72 offen lds
v_mfma_f32_16x16x32_bf16 a[208:211], v[184:187], v[240:243], a[208:211]
s_add_u32 s72, s69, 7168
buffer_load_dwordx4 v3, s[8:11], s72 offen offset:1024 lds
v_mfma_f32_16x16x32_bf16 a[208:211], v[188:191], v[244:247], a[208:211]
s_add_u32 s72, s69, 14336
buffer_load_dwordx4 v2, s[8:11], s72 offen offset:2048 lds
v_mfma_f32_16x16x32_bf16 a[212:215], v[180:183], v[244:247], a[212:215]
s_mul_i32 s74, s58, 4352
ds_read_b128 v[136:139], v24 offset:2048
v_mfma_f32_16x16x32_bf16 a[212:215], v[176:179], v[240:243], a[212:215]
s_add_u32 s74, s74, 131072
ds_read_b128 v[140:143], v25 offset:2048
v_lshrrev_b32 v26, 4, v0
v_mfma_f32_16x16x32_bf16 a[216:219], v[168:171], v[240:243], a[216:219]
s_add_u32 s72, s69, 21504
buffer_load_dwordx4 v3, s[8:11], s72 offen offset:3072 lds
v_mfma_f32_16x16x32_bf16 a[216:219], v[172:175], v[244:247], a[216:219]
ds_read_b128 v[144:147], v24 offset:4096
v_and_b32 v27, 15, v0
v_mfma_f32_16x16x32_bf16 a[220:223], v[164:167], v[244:247], a[220:223]
ds_read_b128 v[148:151], v25 offset:4096
v_lshlrev_b32 v27, 4, v27
v_mfma_f32_16x16x32_bf16 a[220:223], v[160:163], v[240:243], a[220:223]
ds_read_b128 v[152:155], v24 offset:6144
v_mul_u32_u24 v28, 272, v26
v_mfma_f32_16x16x32_bf16 a[252:255], v[160:163], v[248:251], a[252:255]
ds_read_b128 v[156:159], v25 offset:6144
v_add3_u32 v28, v28, v27, s74
v_mfma_f32_16x16x32_bf16 a[252:255], v[164:167], v[252:255], a[252:255]
s_add_u32 m0, s64, 32768
v_lshl_add_u32 v26, v26, 12, v27
v_mfma_f32_16x16x32_bf16 a[248:251], v[172:175], v[252:255], a[248:251]
s_add_u32 s72, s71, 0
buffer_load_dwordx4 v6, s[16:19], s72 offen lds
v_mfma_f32_16x16x32_bf16 a[248:251], v[168:171], v[248:251], a[248:251]
ds_read_b128 v[160:163], v24 offset:8192
ds_read_b128 v[36:39], v28 offset:0
v_mfma_f32_16x16x32_bf16 a[244:247], v[176:179], v[248:251], a[244:247]
ds_read_b128 v[164:167], v25 offset:8192
ds_read_b128 v[40:43], v28 offset:1088
v_mfma_f32_16x16x32_bf16 a[244:247], v[180:183], v[252:255], a[244:247]
s_add_u32 s72, s71, 31744
buffer_load_dwordx4 v6, s[16:19], s72 offen offset:1024 lds
v_mfma_f32_16x16x32_bf16 a[240:243], v[188:191], v[252:255], a[240:243]
ds_read_b128 v[168:171], v24 offset:10240
ds_read_b128 v[44:47], v28 offset:2176
v_mfma_f32_16x16x32_bf16 a[240:243], v[184:187], v[248:251], a[240:243]
ds_read_b128 v[172:175], v25 offset:10240
ds_read_b128 v[48:51], v28 offset:3264
v_mfma_f32_16x16x32_bf16 a[236:239], v[216:219], v[248:251], a[236:239]
s_and_b32 s74, s2, 15
ds_read_b128 v[176:179], v24 offset:12288
v_mfma_f32_16x16x32_bf16 a[236:239], v[220:223], v[252:255], a[236:239]
s_add_u32 s72, s71, 63488
buffer_load_dwordx4 v7, s[16:19], s72 offen offset:2048 lds
v_mfma_f32_16x16x32_bf16 a[232:235], v[212:215], v[252:255], a[232:235]
s_lshl_b32 s74, s74, 2
ds_read_b128 v[180:183], v25 offset:12288
v_mfma_f32_16x16x32_bf16 a[232:235], v[208:211], v[248:251], a[232:235]
s_add_u32 s74, s74, s58
ds_read_b128 v[184:187], v24 offset:14336
v_mfma_f32_16x16x32_bf16 a[228:231], v[200:203], v[248:251], a[228:231]
s_lshl_b32 s74, s74, 16
ds_read_b128 v[188:191], v25 offset:14336
v_mfma_f32_16x16x32_bf16 a[228:231], v[204:207], v[252:255], a[228:231]
s_lshr_b32 s75, s2, 4
v_mfma_f32_16x16x32_bf16 a[224:227], v[196:199], v[252:255], a[224:227]
s_add_u32 s72, s71, 95232
buffer_load_dwordx4 v7, s[16:19], s72 offen offset:3072 lds
v_mfma_f32_16x16x32_bf16 a[224:227], v[192:195], v[248:251], a[224:227]
s_waitcnt lgkmcnt(12)
ds_read_b64_tr_b16 v[232:233], v21 offset:0
v_mfma_f32_16x16x32_bf16 a[0:3], v[224:227], v[128:131], a[0:3]
s_lshl_b32 s75, s75, 8
ds_read_b64_tr_b16 v[234:235], v21 offset:1024
v_mfma_f32_16x16x32_bf16 a[0:3], v[228:231], v[132:135], a[0:3]
s_sub_u32 s74, s74, s75
ds_read_b64_tr_b16 v[240:241], v22 offset:0
v_mfma_f32_16x16x32_bf16 a[4:7], v[228:231], v[140:143], a[4:7]
s_add_u32 m0, s63, 102400
ds_read_b64_tr_b16 v[236:237], v21 offset:8192
v_mfma_f32_16x16x32_bf16 a[4:7], v[224:227], v[136:139], a[4:7]
s_add_u32 s72, s69, 32768
buffer_load_dwordx4 v2, s[8:11], s72 offen lds
v_mfma_f32_16x16x32_bf16 a[8:11], v[224:227], v[144:147], a[8:11]
s_add_u32 s74, s74, 0x3000f00
ds_read_b64_tr_b16 v[238:239], v21 offset:9216
v_mfma_f32_16x16x32_bf16 a[8:11], v[228:231], v[148:151], a[8:11]
s_waitcnt vmcnt(29)
v_lshlrev_b32 v78, 16, v84
v_lshlrev_b32 v79, 16, v108
v_mfma_f32_16x16x32_bf16 a[12:15], v[228:231], v[156:159], a[12:15]
s_add_u32 s72, s69, 39936
buffer_load_dwordx4 v3, s[8:11], s72 offen offset:1024 lds
v_mfma_f32_16x16x32_bf16 a[12:15], v[224:227], v[152:155], a[12:15]
s_waitcnt lgkmcnt(5)
ds_read_b64_tr_b16 v[242:243], v22 offset:1024
v_mul_f32 v76, v78, v79
v_mfma_f32_16x16x32_bf16 a[16:19], v[224:227], v[160:163], a[16:19]
v_lshlrev_b32 v80, 16, v116
v_mul_f32 v77, v78, v80
v_mfma_f32_16x16x32_bf16 a[16:19], v[228:231], v[164:167], a[16:19]
ds_read_b64_tr_b16 v[244:245], v22 offset:8192
v_and_b32 v78, 0xffff0000, v84
v_mfma_f32_16x16x32_bf16 a[20:23], v[228:231], v[172:175], a[20:23]
v_and_b32 v79, 0xffff0000, v108
v_fmac_f32 v76, v78, v79
v_mfma_f32_16x16x32_bf16 a[20:23], v[224:227], v[168:171], a[20:23]
s_add_u32 s72, s69, 47104
buffer_load_dwordx4 v2, s[8:11], s72 offen offset:2048 lds
v_mfma_f32_16x16x32_bf16 a[24:27], v[224:227], v[176:179], a[24:27]
ds_read_b64_tr_b16 v[246:247], v22 offset:9216
v_and_b32 v80, 0xffff0000, v116
v_mfma_f32_16x16x32_bf16 a[24:27], v[228:231], v[180:183], a[24:27]
v_fmac_f32 v77, v78, v80
v_lshlrev_b32 v78, 16, v85
v_mfma_f32_16x16x32_bf16 a[28:31], v[228:231], v[188:191], a[28:31]
v_lshlrev_b32 v79, 16, v109
v_fmac_f32 v76, v78, v79
v_mfma_f32_16x16x32_bf16 a[28:31], v[224:227], v[184:187], a[28:31]
s_waitcnt lgkmcnt(3)
v_lshlrev_b32 v80, 16, v117
v_fmac_f32 v77, v78, v80
v_mfma_f32_16x16x32_bf16 a[60:63], v[232:235], v[184:187], a[60:63]
s_add_u32 s72, s69, 54272
buffer_load_dwordx4 v3, s[8:11], s72 offen offset:3072 lds
v_mfma_f32_16x16x32_bf16 a[60:63], v[236:239], v[188:191], a[60:63]
ds_read_b64_tr_b16 v[248:249], v23 offset:0
v_and_b32 v78, 0xffff0000, v85
v_mfma_f32_16x16x32_bf16 a[56:59], v[236:239], v[180:183], a[56:59]
v_and_b32 v79, 0xffff0000, v109
v_fmac_f32 v76, v78, v79
v_mfma_f32_16x16x32_bf16 a[56:59], v[232:235], v[176:179], a[56:59]
s_add_u32 m0, s64, 49152
ds_read_b64_tr_b16 v[250:251], v23 offset:1024
v_and_b32 v80, 0xffff0000, v117
v_mfma_f32_16x16x32_bf16 a[52:55], v[232:235], v[168:171], a[52:55]
s_add_u32 s72, s71, 0
buffer_load_dwordx4 v6, s[20:23], s72 offen lds
v_mfma_f32_16x16x32_bf16 a[52:55], v[236:239], v[172:175], a[52:55]
v_fmac_f32 v77, v78, v80
v_lshlrev_b32 v78, 16, v86
v_mfma_f32_16x16x32_bf16 a[48:51], v[236:239], v[164:167], a[48:51]
v_lshlrev_b32 v79, 16, v110
v_fmac_f32 v76, v78, v79
v_mfma_f32_16x16x32_bf16 a[48:51], v[232:235], v[160:163], a[48:51]
ds_read_b64_tr_b16 v[252:253], v23 offset:8192
v_lshlrev_b32 v80, 16, v118
v_mfma_f32_16x16x32_bf16 a[44:47], v[232:235], v[152:155], a[44:47]
s_add_u32 s72, s71, 31744
buffer_load_dwordx4 v6, s[20:23], s72 offen offset:1024 lds
v_mfma_f32_16x16x32_bf16 a[44:47], v[236:239], v[156:159], a[44:47]
v_fmac_f32 v77, v78, v80
v_and_b32 v78, 0xffff0000, v86
v_mfma_f32_16x16x32_bf16 a[40:43], v[236:239], v[148:151], a[40:43]
ds_read_b64_tr_b16 v[254:255], v23 offset:9216
v_and_b32 v79, 0xffff0000, v110
v_mfma_f32_16x16x32_bf16 a[40:43], v[232:235], v[144:147], a[40:43]
v_fmac_f32 v76, v78, v79
v_and_b32 v80, 0xffff0000, v118
v_mfma_f32_16x16x32_bf16 a[36:39], v[232:235], v[136:139], a[36:39]
s_add_u32 s72, s71, 63488
buffer_load_dwordx4 v7, s[20:23], s72 offen offset:2048 lds
v_mfma_f32_16x16x32_bf16 a[36:39], v[236:239], v[140:143], a[36:39]
v_fmac_f32 v77, v78, v80
v_lshlrev_b32 v78, 16, v87
v_mfma_f32_16x16x32_bf16 a[32:35], v[236:239], v[132:135], a[32:35]
v_lshlrev_b32 v79, 16, v111
v_fmac_f32 v76, v78, v79
v_mfma_f32_16x16x32_bf16 a[32:35], v[232:235], v[128:131], a[32:35]
s_waitcnt lgkmcnt(4)
v_lshlrev_b32 v80, 16, v119
v_fmac_f32 v77, v78, v80
v_mfma_f32_16x16x32_bf16 a[64:67], v[240:243], v[128:131], a[64:67]
s_add_u32 s72, s71, 95232
buffer_load_dwordx4 v7, s[20:23], s72 offen offset:3072 lds
v_mfma_f32_16x16x32_bf16 a[64:67], v[244:247], v[132:135], a[64:67]
ds_read_b64_tr_b16 v[224:225], v20 offset:16384
v_and_b32 v78, 0xffff0000, v87
v_mfma_f32_16x16x32_bf16 a[68:71], v[244:247], v[140:143], a[68:71]
v_and_b32 v79, 0xffff0000, v111
v_fmac_f32 v76, v78, v79
v_mfma_f32_16x16x32_bf16 a[68:71], v[240:243], v[136:139], a[68:71]
v_and_b32 v80, 0xffff0000, v119
v_fmac_f32 v77, v78, v80
v_mfma_f32_16x16x32_bf16 a[72:75], v[240:243], v[144:147], a[72:75]
ds_read_b64_tr_b16 v[226:227], v20 offset:17408
v_lshlrev_b32 v78, 16, v88
v_mfma_f32_16x16x32_bf16 a[72:75], v[244:247], v[148:151], a[72:75]
v_lshlrev_b32 v79, 16, v112
v_fmac_f32 v76, v78, v79
v_mfma_f32_16x16x32_bf16 a[76:79], v[244:247], v[156:159], a[76:79]
v_lshlrev_b32 v80, 16, v120
v_fmac_f32 v77, v78, v80
v_mfma_f32_16x16x32_bf16 a[76:79], v[240:243], v[152:155], a[76:79]
ds_read_b64_tr_b16 v[228:229], v20 offset:24576
v_and_b32 v78, 0xffff0000, v88
v_mfma_f32_16x16x32_bf16 a[80:83], v[240:243], v[160:163], a[80:83]
s_waitcnt lgkmcnt(15)
buffer_store_dwordx4 v[36:39], v26, s[44:47], s74 offen sc1
v_mfma_f32_16x16x32_bf16 a[80:83], v[244:247], v[164:167], a[80:83]
v_and_b32 v79, 0xffff0000, v112
v_fmac_f32 v76, v78, v79
v_mfma_f32_16x16x32_bf16 a[84:87], v[244:247], v[172:175], a[84:87]
v_and_b32 v80, 0xffff0000, v120
v_fmac_f32 v77, v78, v80
v_mfma_f32_16x16x32_bf16 a[84:87], v[240:243], v[168:171], a[84:87]
ds_read_b64_tr_b16 v[230:231], v20 offset:25600
v_lshlrev_b32 v78, 16, v89
v_mfma_f32_16x16x32_bf16 a[88:91], v[240:243], v[176:179], a[88:91]
v_lshlrev_b32 v79, 16, v113
v_fmac_f32 v76, v78, v79
v_mfma_f32_16x16x32_bf16 a[88:91], v[244:247], v[180:183], a[88:91]
v_lshlrev_b32 v80, 16, v121
v_fmac_f32 v77, v78, v80
v_mfma_f32_16x16x32_bf16 a[92:95], v[244:247], v[188:191], a[92:95]
v_and_b32 v78, 0xffff0000, v89
v_and_b32 v79, 0xffff0000, v113
v_mfma_f32_16x16x32_bf16 a[92:95], v[240:243], v[184:187], a[92:95]
s_waitcnt lgkmcnt(4)
v_fmac_f32 v76, v78, v79
v_and_b32 v80, 0xffff0000, v121
v_mfma_f32_16x16x32_bf16 a[124:127], v[248:251], v[184:187], a[124:127]
ds_read_b64_tr_b16 v[232:233], v21 offset:16384
v_fmac_f32 v77, v78, v80
v_mfma_f32_16x16x32_bf16 a[124:127], v[252:255], v[188:191], a[124:127]
v_lshlrev_b32 v78, 16, v90
v_lshlrev_b32 v79, 16, v114
v_mfma_f32_16x16x32_bf16 a[120:123], v[252:255], v[180:183], a[120:123]
ds_read_b64_tr_b16 v[234:235], v21 offset:17408
v_fmac_f32 v76, v78, v79
v_mfma_f32_16x16x32_bf16 a[120:123], v[248:251], v[176:179], a[120:123]
v_lshlrev_b32 v80, 16, v122
v_fmac_f32 v77, v78, v80
v_mfma_f32_16x16x32_bf16 a[116:119], v[248:251], v[168:171], a[116:119]
s_lshr_b32 s75, s93, 5
v_and_b32 v78, 0xffff0000, v90
v_and_b32 v79, 0xffff0000, v114
v_mfma_f32_16x16x32_bf16 a[116:119], v[252:255], v[172:175], a[116:119]
s_add_u32 s74, s74, 0x4000
buffer_store_dwordx4 v[40:43], v26, s[44:47], s74 offen sc1
v_mfma_f32_16x16x32_bf16 a[112:115], v[252:255], v[164:167], a[112:115]
s_and_b32 s75, s75, 0x3f80
ds_read_b64_tr_b16 v[236:237], v21 offset:24576
v_fmac_f32 v76, v78, v79
v_mfma_f32_16x16x32_bf16 a[112:115], v[248:251], v[160:163], a[112:115]
s_add_u32 s75, s75, LcB0-Lpc0
v_lshrrev_b32 v2, 6, v0
v_lshlrev_b32 v2, 7, v2
v_mfma_f32_16x16x32_bf16 a[108:111], v[248:251], v[152:155], a[108:111]
v_add_u32 v2, s75, v2
v_min_u32 v2, Lcode_end-Lpc0, v2
v_mfma_f32_16x16x32_bf16 a[108:111], v[252:255], v[156:159], a[108:111]
global_load_dword v3, v2, s[98:99]
v_mfma_f32_16x16x32_bf16 a[104:107], v[252:255], v[148:151], a[104:107]
v_and_b32 v80, 0xffff0000, v122
v_fmac_f32 v77, v78, v80
v_mfma_f32_16x16x32_bf16 a[104:107], v[248:251], v[144:147], a[104:107]
ds_read_b64_tr_b16 v[238:239], v21 offset:25600
v_lshlrev_b32 v78, 16, v91
v_mfma_f32_16x16x32_bf16 a[100:103], v[248:251], v[136:139], a[100:103]
v_lshlrev_b32 v79, 16, v115
v_fmac_f32 v76, v78, v79
v_mfma_f32_16x16x32_bf16 a[100:103], v[252:255], v[140:143], a[100:103]
v_lshlrev_b32 v80, 16, v123
v_fmac_f32 v77, v78, v80
v_mfma_f32_16x16x32_bf16 a[96:99], v[252:255], v[132:135], a[96:99]
v_and_b32 v78, 0xffff0000, v91
v_and_b32 v79, 0xffff0000, v115
v_mfma_f32_16x16x32_bf16 a[96:99], v[248:251], v[128:131], a[96:99]
s_waitcnt lgkmcnt(4)
v_fmac_f32 v76, v78, v79
v_and_b32 v80, 0xffff0000, v123
v_mfma_f32_16x16x32_bf16 a[128:131], v[128:131], v[224:227], a[128:131]
ds_read_b64_tr_b16 v[240:241], v22 offset:16384
v_fmac_f32 v77, v78, v80
v_mfma_f32_16x16x32_bf16 a[128:131], v[132:135], v[228:231], a[128:131]
v_add_f32_dpp v76, v76, v76 row_ror:8 row_mask:0xf bank_mask:0xf
v_add_f32_dpp v77, v77, v77 row_ror:8 row_mask:0xf bank_mask:0xf
v_mfma_f32_16x16x32_bf16 a[132:135], v[140:143], v[228:231], a[132:135]
s_add_u32 s74, s74, 0x4000
buffer_store_dwordx4 v[44:47], v26, s[44:47], s74 offen sc1
v_mfma_f32_16x16x32_bf16 a[132:135], v[136:139], v[224:227], a[132:135]
v_add_f32_dpp v76, v76, v76 row_ror:4 row_mask:0xf bank_mask:0xf
v_add_f32_dpp v77, v77, v77 row_ror:4 row_mask:0xf bank_mask:0xf
v_mfma_f32_16x16x32_bf16 a[136:139], v[144:147], v[224:227], a[136:139]
ds_read_b64_tr_b16 v[242:243], v22 offset:17408
v_add_f32_dpp v76, v76, v76 row_ror:2 row_mask:0xf bank_mask:0xf
v_mfma_f32_16x16x32_bf16 a[136:139], v[148:151], v[228:231], a[136:139]
v_add_f32_dpp v77, v77, v77 row_ror:2 row_mask:0xf bank_mask:0xf
v_add_f32_dpp v76, v76, v76 row_ror:1 row_mask:0xf bank_mask:0xf
v_mfma_f32_16x16x32_bf16 a[140:143], v[156:159], v[228:231], a[140:143]
v_add_f32_dpp v77, v77, v77 row_ror:1 row_mask:0xf bank_mask:0xf
v_mov_b32 v78, v76
v_mfma_f32_16x16x32_bf16 a[140:143], v[152:155], v[224:227], a[140:143]
ds_read_b64_tr_b16 v[244:245], v22 offset:24576
v_mov_b32 v79, v77
v_mfma_f32_16x16x32_bf16 a[144:147], v[160:163], v[224:227], a[144:147]
v_permlane16_swap_b32 v76, v78
v_permlane16_swap_b32 v77, v79
v_mfma_f32_16x16x32_bf16 a[144:147], v[164:167], v[228:231], a[144:147]
v_add_f32 v76, v76, v78
v_add_f32 v77, v77, v79
v_mfma_f32_16x16x32_bf16 a[148:151], v[172:175], v[228:231], a[148:151]
ds_read_b64_tr_b16 v[246:247], v22 offset:25600
v_mov_b32 v78, v76
v_mfma_f32_16x16x32_bf16 a[148:151], v[168:171], v[224:227], a[148:151]
v_mov_b32 v79, v77
v_permlane32_swap_b32 v76, v78
v_mfma_f32_16x16x32_bf16 a[152:155], v[176:179], v[224:227], a[152:155]
v_permlane32_swap_b32 v77, v79
v_add_f32 v76, v76, v78
v_mfma_f32_16x16x32_bf16 a[152:155], v[180:183], v[228:231], a[152:155]
v_add_f32 v77, v77, v79
v_mul_f32 v76, 0xbfb8aa3b, v76
v_mfma_f32_16x16x32_bf16 a[156:159], v[188:191], v[228:231], a[156:159]
v_mul_f32 v77, 0xbfb8aa3b, v77
v_mfma_f32_16x16x32_bf16 a[156:159], v[184:187], v[224:227], a[156:159]
s_waitcnt lgkmcnt(4)
v_exp_f32 v76, v76
v_mfma_f32_16x16x32_bf16 a[188:191], v[184:187], v[232:235], a[188:191]
s_add_u32 s74, s74, 0x4000
buffer_store_dwordx4 v[48:51], v26, s[44:47], s74 offen sc1
v_mfma_f32_16x16x32_bf16 a[188:191], v[188:191], v[236:239], a[188:191]
ds_read_b64_tr_b16 v[248:249], v23 offset:16384
v_mfma_f32_16x16x32_bf16 a[184:187], v[180:183], v[236:239], a[184:187]
ds_read_b64_tr_b16 v[250:251], v23 offset:17408
v_mfma_f32_16x16x32_bf16 a[184:187], v[176:179], v[232:235], a[184:187]
v_exp_f32 v77, v77
v_mfma_f32_16x16x32_bf16 a[180:183], v[168:171], v[232:235], a[180:183]
ds_read_b64_tr_b16 v[252:253], v23 offset:24576
v_add_f32 v76, 1.0, v76
v_mfma_f32_16x16x32_bf16 a[180:183], v[172:175], v[236:239], a[180:183]
v_add_f32 v77, 1.0, v77
v_mfma_f32_16x16x32_bf16 a[176:179], v[164:167], v[236:239], a[176:179]
ds_read_b64_tr_b16 v[254:255], v23 offset:25600
v_mfma_f32_16x16x32_bf16 a[176:179], v[160:163], v[232:235], a[176:179]
v_rcp_f32 v76, v76
v_mfma_f32_16x16x32_bf16 a[172:175], v[152:155], v[232:235], a[172:175]
v_rcp_f32 v77, v77
v_mfma_f32_16x16x32_bf16 a[172:175], v[156:159], v[236:239], a[172:175]
s_lshr_b32 s80, s76, 9
v_mfma_f32_16x16x32_bf16 a[168:171], v[148:151], v[236:239], a[168:171]
s_add_u32 s80, s80, 0x3800000
v_min_u32 v78, 1, v0
v_lshlrev_b32 v78, 30, v78
v_mfma_f32_16x16x32_bf16 a[168:171], v[144:147], v[232:235], a[168:171]
buffer_store_dwordx2 v[76:77], v78, s[44:47], s80 offen sc1
v_mfma_f32_16x16x32_bf16 a[164:167], v[136:139], v[232:235], a[164:167]
v_mfma_f32_16x16x32_bf16 a[164:167], v[140:143], v[236:239], a[164:167]
v_mfma_f32_16x16x32_bf16 a[160:163], v[132:135], v[236:239], a[160:163]
s_waitcnt vmcnt(6) lgkmcnt(0)
v_mfma_f32_16x16x32_bf16 a[160:163], v[128:131], v[232:235], a[160:163]
s_barrier
v_mfma_f32_16x16x32_bf16 a[192:195], v[128:131], v[240:243], a[192:195]
s_add_u32 s73, s62, 0
ds_read_b64_tr_b16 v[224:225], v20 offset:32768
v_mfma_f32_16x16x32_bf16 a[192:195], v[132:135], v[244:247], a[192:195]
s_add_u32 s70, s73, s65
ds_read_b64_tr_b16 v[226:227], v20 offset:33792
v_mfma_f32_16x16x32_bf16 a[196:199], v[140:143], v[244:247], a[196:199]
s_and_b32 s70, s70, 3
v_mov_b32 v100, v20
v_mov_b32 v101, v21
v_mfma_f32_16x16x32_bf16 a[196:199], v[136:139], v[240:243], a[196:199]
s_and_b32 s73, s73, 12
v_mov_b32 v102, v22
v_mov_b32 v103, v23
v_mfma_f32_16x16x32_bf16 a[200:203], v[144:147], v[240:243], a[200:203]
s_or_b32 s73, s73, s70
ds_read_b64_tr_b16 v[228:229], v20 offset:40960
v_mfma_f32_16x16x32_bf16 a[200:203], v[148:151], v[244:247], a[200:203]
s_lshl_b32 s73, s73, 7
ds_read_b64_tr_b16 v[230:231], v20 offset:41984
v_mfma_f32_16x16x32_bf16 a[204:207], v[156:159], v[244:247], a[204:207]
s_add_u32 s69, s73, s67
ds_read_b128 v[192:195], v24 offset:32768
v_mfma_f32_16x16x32_bf16 a[204:207], v[152:155], v[240:243], a[204:207]
s_add_u32 s70, s73, s68
ds_read_b128 v[196:199], v25 offset:32768
v_mfma_f32_16x16x32_bf16 a[208:211], v[160:163], v[240:243], a[208:211]
s_add_u32 m0, s63, 131072
ds_read_b128 v[200:203], v24 offset:34816
v_mfma_f32_16x16x32_bf16 a[208:211], v[164:167], v[244:247], a[208:211]
s_add_u32 s72, s69, 0
buffer_load_dwordx4 v4, s[4:7], s72 offen lds
v_mfma_f32_16x16x32_bf16 a[212:215], v[172:175], v[244:247], a[212:215]
s_add_u32 s72, s69, 15360
buffer_load_dwordx4 v5, s[4:7], s72 offen offset:1024 lds
v_mfma_f32_16x16x32_bf16 a[212:215], v[168:171], v[240:243], a[212:215]
s_add_u32 s72, s69, 129024
buffer_load_dwordx4 v4, s[4:7], s72 offen offset:2048 lds
v_mfma_f32_16x16x32_bf16 a[216:219], v[176:179], v[240:243], a[216:219]
ds_read_b128 v[204:207], v25 offset:34816
v_mfma_f32_16x16x32_bf16 a[216:219], v[180:183], v[244:247], a[216:219]
ds_read_b128 v[208:211], v24 offset:36864
v_mfma_f32_16x16x32_bf16 a[220:223], v[188:191], v[244:247], a[220:223]
s_add_u32 s72, s69, 144384
buffer_load_dwordx4 v5, s[4:7], s72 offen offset:3072 lds
v_mfma_f32_16x16x32_bf16 a[220:223], v[184:187], v[240:243], a[220:223]
ds_read_b128 v[212:215], v25 offset:36864
v_mfma_f32_16x16x32_bf16 a[252:255], v[184:187], v[248:251], a[252:255]
ds_read_b128 v[216:219], v24 offset:38912
v_mfma_f32_16x16x32_bf16 a[252:255], v[188:191], v[252:255], a[252:255]
ds_read_b128 v[220:223], v25 offset:38912
v_mfma_f32_16x16x32_bf16 a[248:251], v[180:183], v[252:255], a[248:251]
s_add_u32 m0, s63, 135168
ds_read_b128 v[184:187], v24 offset:40960
v_mfma_f32_16x16x32_bf16 a[248:251], v[176:179], v[248:251], a[248:251]
s_add_u32 s72, s70, 0
buffer_load_dwordx4 v4, s[4:7], s72 offen lds
v_mfma_f32_16x16x32_bf16 a[244:247], v[168:171], v[248:251], a[244:247]
ds_read_b128 v[188:191], v25 offset:40960
v_mfma_f32_16x16x32_bf16 a[244:247], v[172:175], v[252:255], a[244:247]
ds_read_b128 v[176:179], v24 offset:43008
v_mfma_f32_16x16x32_bf16 a[240:243], v[164:167], v[252:255], a[240:243]
ds_read_b128 v[180:183], v25 offset:43008
v_mfma_f32_16x16x32_bf16 a[240:243], v[160:163], v[248:251], a[240:243]
s_add_u32 s72, s70, 15360
buffer_load_dwordx4 v5, s[4:7], s72 offen offset:1024 lds
v_mfma_f32_16x16x32_bf16 a[236:239], v[152:155], v[248:251], a[236:239]
ds_read_b128 v[168:171], v24 offset:45056
v_mfma_f32_16x16x32_bf16 a[236:239], v[156:159], v[252:255], a[236:239]
ds_read_b128 v[172:175], v25 offset:45056
v_mfma_f32_16x16x32_bf16 a[232:235], v[148:151], v[252:255], a[232:235]
v_mfma_f32_16x16x32_bf16 a[232:235], v[144:147], v[248:251], a[232:235]
ds_read_b128 v[160:163], v24 offset:47104
v_mfma_f32_16x16x32_bf16 a[228:231], v[136:139], v[248:251], a[228:231]
s_add_u32 s72, s70, 129024
buffer_load_dwordx4 v4, s[4:7], s72 offen offset:2048 lds
v_mfma_f32_16x16x32_bf16 a[228:231], v[140:143], v[252:255], a[228:231]
ds_read_b128 v[164:167], v25 offset:47104
v_mfma_f32_16x16x32_bf16 a[224:227], v[132:135], v[252:255], a[224:227]
ds_read_b64_tr_b16 v[232:233], v101 offset:32768
v_mfma_f32_16x16x32_bf16 a[224:227], v[128:131], v[248:251], a[224:227]
s_waitcnt lgkmcnt(9)
ds_read_b64_tr_b16 v[234:235], v101 offset:33792
v_mfma_f32_16x16x32_bf16 a[0:3], v[224:227], v[192:195], a[0:3]
s_add_u32 s72, s70, 144384
buffer_load_dwordx4 v5, s[4:7], s72 offen offset:3072 lds
v_mfma_f32_16x16x32_bf16 a[0:3], v[228:231], v[196:199], a[0:3]
ds_read_b64_tr_b16 v[240:241], v102 offset:32768
v_mfma_f32_16x16x32_bf16 a[4:7], v[228:231], v[204:207], a[4:7]
ds_read_b64_tr_b16 v[236:237], v101 offset:40960
v_mfma_f32_16x16x32_bf16 a[4:7], v[224:227], v[200:203], a[4:7]
v_mfma_f32_16x16x32_bf16 a[8:11], v[224:227], v[208:211], a[8:11]
ds_read_b64_tr_b16 v[238:239], v101 offset:41984
v_mfma_f32_16x16x32_bf16 a[8:11], v[228:231], v[212:215], a[8:11]
s_lshl_b32 s71, s73, 12
ds_read_b64_tr_b16 v[242:243], v102 offset:33792
v_mfma_f32_16x16x32_bf16 a[12:15], v[228:231], v[220:223], a[12:15]
s_add_u32 s71, s71, s66
v_mfma_f32_16x16x32_bf16 a[12:15], v[224:227], v[216:219], a[12:15]
s_waitcnt lgkmcnt(6)
ds_read_b64_tr_b16 v[244:245], v102 offset:40960
v_mfma_f32_16x16x32_bf16 a[16:19], v[224:227], v[184:187], a[16:19]
s_add_u32 m0, s64, 0
v_mfma_f32_16x16x32_bf16 a[16:19], v[228:231], v[188:191], a[16:19]
s_add_u32 s72, s71, 0
buffer_load_dwordx4 v6, s[12:15], s72 offen lds
v_mfma_f32_16x16x32_bf16 a[20:23], v[228:231], v[180:183], a[20:23]
s_add_u32 s72, s71, 31744
buffer_load_dwordx4 v6, s[12:15], s72 offen offset:1024 lds
v_mfma_f32_16x16x32_bf16 a[20:23], v[224:227], v[176:179], a[20:23]
ds_read_b64_tr_b16 v[246:247], v102 offset:41984
v_mfma_f32_16x16x32_bf16 a[24:27], v[224:227], v[168:171], a[24:27]
v_mfma_f32_16x16x32_bf16 a[24:27], v[228:231], v[172:175], a[24:27]
v_mfma_f32_16x16x32_bf16 a[28:31], v[228:231], v[164:167], a[28:31]
v_mfma_f32_16x16x32_bf16 a[28:31], v[224:227], v[160:163], a[28:31]
s_waitcnt lgkmcnt(3)
v_mfma_f32_16x16x32_bf16 a[60:63], v[232:235], v[160:163], a[60:63]
s_add_u32 s72, s71, 63488
buffer_load_dwordx4 v7, s[12:15], s72 offen offset:2048 lds
v_mfma_f32_16x16x32_bf16 a[60:63], v[236:239], v[164:167], a[60:63]
ds_read_b64_tr_b16 v[248:249], v103 offset:32768
v_mfma_f32_16x16x32_bf16 a[56:59], v[236:239], v[172:175], a[56:59]
v_mfma_f32_16x16x32_bf16 a[56:59], v[232:235], v[168:171], a[56:59]
s_add_u32 s72, s71, 95232
buffer_load_dwordx4 v7, s[12:15], s72 offen offset:3072 lds
v_mfma_f32_16x16x32_bf16 a[52:55], v[232:235], v[176:179], a[52:55]
v_mfma_f32_16x16x32_bf16 a[52:55], v[236:239], v[180:183], a[52:55]
ds_read_b64_tr_b16 v[250:251], v103 offset:33792
v_mfma_f32_16x16x32_bf16 a[48:51], v[236:239], v[188:191], a[48:51]
v_mfma_f32_16x16x32_bf16 a[48:51], v[232:235], v[184:187], a[48:51]
v_mfma_f32_16x16x32_bf16 a[44:47], v[232:235], v[216:219], a[44:47]
s_add_u32 s73, s62, 1
ds_read_b64_tr_b16 v[252:253], v103 offset:40960
v_mfma_f32_16x16x32_bf16 a[44:47], v[236:239], v[220:223], a[44:47]
s_add_u32 s70, s73, s65
v_mfma_f32_16x16x32_bf16 a[40:43], v[236:239], v[212:215], a[40:43]
s_and_b32 s70, s70, 3
v_mfma_f32_16x16x32_bf16 a[40:43], v[232:235], v[208:211], a[40:43]
s_and_b32 s73, s73, 12
ds_read_b64_tr_b16 v[254:255], v103 offset:41984
v_mfma_f32_16x16x32_bf16 a[36:39], v[232:235], v[200:203], a[36:39]
s_or_b32 s73, s73, s70
v_mfma_f32_16x16x32_bf16 a[36:39], v[236:239], v[204:207], a[36:39]
s_lshl_b32 s73, s73, 7
v_mfma_f32_16x16x32_bf16 a[32:35], v[236:239], v[196:199], a[32:35]
s_add_u32 s69, s73, s67
v_mfma_f32_16x16x32_bf16 a[32:35], v[232:235], v[192:195], a[32:35]
s_waitcnt lgkmcnt(4)
v_mfma_f32_16x16x32_bf16 a[64:67], v[240:243], v[192:195], a[64:67]
s_add_u32 s70, s73, s68
ds_read_b64_tr_b16 v[224:225], v100 offset:49152
v_mfma_f32_16x16x32_bf16 a[64:67], v[244:247], v[196:199], a[64:67]
s_add_u32 m0, s63, 65536
v_mfma_f32_16x16x32_bf16 a[68:71], v[244:247], v[204:207], a[68:71]
s_add_u32 s72, s69, 0
buffer_load_dwordx4 v4, s[4:7], s72 offen lds
v_mfma_f32_16x16x32_bf16 a[68:71], v[240:243], v[200:203], a[68:71]
s_add_u32 s72, s69, 15360
buffer_load_dwordx4 v5, s[4:7], s72 offen offset:1024 lds
v_mfma_f32_16x16x32_bf16 a[72:75], v[240:243], v[208:211], a[72:75]
s_add_u32 s72, s69, 129024
buffer_load_dwordx4 v4, s[4:7], s72 offen offset:2048 lds
v_mfma_f32_16x16x32_bf16 a[72:75], v[244:247], v[212:215], a[72:75]
ds_read_b64_tr_b16 v[226:227], v100 offset:50176
v_mfma_f32_16x16x32_bf16 a[76:79], v[244:247], v[220:223], a[76:79]
s_add_u32 s72, s69, 144384
buffer_load_dwordx4 v5, s[4:7], s72 offen offset:3072 lds
v_mfma_f32_16x16x32_bf16 a[76:79], v[240:243], v[216:219], a[76:79]
v_mfma_f32_16x16x32_bf16 a[80:83], v[240:243], v[184:187], a[80:83]
ds_read_b64_tr_b16 v[228:229], v100 offset:57344
v_mfma_f32_16x16x32_bf16 a[80:83], v[244:247], v[188:191], a[80:83]
v_mfma_f32_16x16x32_bf16 a[84:87], v[244:247], v[180:183], a[84:87]
ds_read_b64_tr_b16 v[230:231], v100 offset:58368
v_accvgpr_read_b32 v20, a0
v_mfma_f32_16x16x32_bf16 a[84:87], v[240:243], v[176:179], a[84:87]
s_add_u32 m0, s63, 69632
v_accvgpr_read_b32 v28, a1
v_accvgpr_read_b32 v21, a2
v_mfma_f32_16x16x32_bf16 a[88:91], v[240:243], v[168:171], a[88:91]
s_add_u32 s72, s70, 0
buffer_load_dwordx4 v4, s[4:7], s72 offen lds
v_mfma_f32_16x16x32_bf16 a[88:91], v[244:247], v[172:175], a[88:91]
v_accvgpr_read_b32 v29, a3
v_accvgpr_read_b32 v22, a32
v_mfma_f32_16x16x32_bf16 a[92:95], v[244:247], v[164:167], a[92:95]
v_accvgpr_read_b32 v30, a33
v_accvgpr_read_b32 v23, a34
v_mfma_f32_16x16x32_bf16 a[92:95], v[240:243], v[160:163], a[92:95]
s_waitcnt lgkmcnt(4)
v_accvgpr_read_b32 v31, a35
v_mul_f32 v20, s79, v20
v_mfma_f32_16x16x32_bf16 a[124:127], v[248:251], v[160:163], a[124:127]
s_add_u32 s72, s70, 15360
buffer_load_dwordx4 v5, s[4:7], s72 offen offset:1024 lds
v_mfma_f32_16x16x32_bf16 a[124:127], v[252:255], v[164:167], a[124:127]
ds_read_b64_tr_b16 v[232:233], v101 offset:49152
v_mul_f32 v28, s79, v28
v_mfma_f32_16x16x32_bf16 a[120:123], v[252:255], v[172:175], a[120:123]
v_mul_f32 v21, s79, v21
v_mul_f32 v29, s79, v29
v_mfma_f32_16x16x32_bf16 a[120:123], v[248:251], v[168:171], a[120:123]
ds_read_b64_tr_b16 v[234:235], v101 offset:50176
v_mul_f32 v22, s79, v22
v_mfma_f32_16x16x32_bf16 a[116:119], v[248:251], v[176:179], a[116:119]
s_add_u32 s72, s70, 129024
buffer_load_dwordx4 v4, s[4:7], s72 offen offset:2048 lds
v_mfma_f32_16x16x32_bf16 a[116:119], v[252:255], v[180:183], a[116:119]
v_mul_f32 v30, s79, v30
v_mul_f32 v23, s79, v23
v_mfma_f32_16x16x32_bf16 a[112:115], v[252:255], v[188:191], a[112:115]
v_mul_f32 v31, s79, v31
v_cvt_pk_bf16_f32 v20, v20, v28
v_mfma_f32_16x16x32_bf16 a[112:115], v[248:251], v[184:187], a[112:115]
ds_read_b64_tr_b16 v[236:237], v101 offset:57344
v_cvt_pk_bf16_f32 v21, v21, v29
v_mfma_f32_16x16x32_bf16 a[108:111], v[248:251], v[216:219], a[108:111]
v_cvt_pk_bf16_f32 v22, v22, v30
v_cvt_pk_bf16_f32 v23, v23, v31
v_mfma_f32_16x16x32_bf16 a[108:111], v[252:255], v[220:223], a[108:111]
s_add_u32 s72, s70, 144384
buffer_load_dwordx4 v5, s[4:7], s72 offen offset:3072 lds
v_mfma_f32_16x16x32_bf16 a[104:107], v[252:255], v[212:215], a[104:107]
s_add_u32 s80, s77, 0
buffer_store_dwordx4 v[20:23], v1, s[44:47], s80 offen sc1
v_mfma_f32_16x16x32_bf16 a[104:107], v[248:251], v[208:211], a[104:107]
ds_read_b64_tr_b16 v[238:239], v101 offset:58368
v_mfma_f32_16x16x32_bf16 a[100:103], v[248:251], v[200:203], a[100:103]
v_mfma_f32_16x16x32_bf16 a[100:103], v[252:255], v[204:207], a[100:103]
v_mfma_f32_16x16x32_bf16 a[96:99], v[252:255], v[196:199], a[96:99]
s_lshl_b32 s71, s73, 12
v_mfma_f32_16x16x32_bf16 a[96:99], v[248:251], v[192:195], a[96:99]
s_waitcnt lgkmcnt(4)
LcB0:
v_mfma_f32_16x16x32_bf16 a[128:131], v[192:195], v[224:227], a[128:131]
s_add_u32 s71, s71, s66
ds_read_b64_tr_b16 v[240:241], v102 offset:49152
v_accvgpr_read_b32 v24, a4
v_mfma_f32_16x16x32_bf16 a[128:131], v[196:199], v[228:231], a[128:131]
s_add_u32 m0, s64, 16384
v_accvgpr_read_b32 v28, a5
v_accvgpr_read_b32 v25, a6
v_mfma_f32_16x16x32_bf16 a[132:135], v[204:207], v[228:231], a[132:135]
s_add_u32 s72, s71, 0
buffer_load_dwordx4 v6, s[12:15], s72 offen lds
v_mfma_f32_16x16x32_bf16 a[132:135], v[200:203], v[224:227], a[132:135]
s_add_u32 s72, s71, 31744
buffer_load_dwordx4 v6, s[12:15], s72 offen offset:1024 lds
v_mfma_f32_16x16x32_bf16 a[136:139], v[208:211], v[224:227], a[136:139]
ds_read_b64_tr_b16 v[242:243], v102 offset:50176
v_accvgpr_read_b32 v29, a7
v_mfma_f32_16x16x32_bf16 a[136:139], v[212:215], v[228:231], a[136:139]
v_accvgpr_read_b32 v26, a36
v_accvgpr_read_b32 v30, a37
v_mfma_f32_16x16x32_bf16 a[140:143], v[220:223], v[228:231], a[140:143]
v_accvgpr_read_b32 v27, a38
v_accvgpr_read_b32 v31, a39
v_mfma_f32_16x16x32_bf16 a[140:143], v[216:219], v[224:227], a[140:143]
s_add_u32 s72, s71, 63488
buffer_load_dwordx4 v7, s[12:15], s72 offen offset:2048 lds
v_mfma_f32_16x16x32_bf16 a[144:147], v[184:187], v[224:227], a[144:147]
ds_read_b64_tr_b16 v[244:245], v102 offset:57344
v_mul_f32 v24, s79, v24
v_mfma_f32_16x16x32_bf16 a[144:147], v[188:191], v[228:231], a[144:147]
v_mul_f32 v28, s79, v28
v_mul_f32 v25, s79, v25
v_mfma_f32_16x16x32_bf16 a[148:151], v[180:183], v[228:231], a[148:151]
ds_read_b64_tr_b16 v[246:247], v102 offset:58368
v_mul_f32 v29, s79, v29
v_mfma_f32_16x16x32_bf16 a[148:151], v[176:179], v[224:227], a[148:151]
v_mul_f32 v26, s79, v26
v_mul_f32 v30, s79, v30
v_mfma_f32_16x16x32_bf16 a[152:155], v[168:171], v[224:227], a[152:155]
s_add_u32 s72, s71, 95232
buffer_load_dwordx4 v7, s[12:15], s72 offen offset:3072 lds
v_mfma_f32_16x16x32_bf16 a[152:155], v[172:175], v[228:231], a[152:155]
v_mul_f32 v27, s79, v27
v_mul_f32 v31, s79, v31
v_mfma_f32_16x16x32_bf16 a[156:159], v[164:167], v[228:231], a[156:159]
v_cvt_pk_bf16_f32 v24, v24, v28
v_cvt_pk_bf16_f32 v25, v25, v29
v_mfma_f32_16x16x32_bf16 a[156:159], v[160:163], v[224:227], a[156:159]
s_waitcnt lgkmcnt(4)
v_cvt_pk_bf16_f32 v26, v26, v30
v_cvt_pk_bf16_f32 v27, v27, v31
v_mfma_f32_16x16x32_bf16 a[188:191], v[160:163], v[232:235], a[188:191]
s_add_u32 s80, s77, 4096
ds_read_b64_tr_b16 v[248:249], v103 offset:49152
v_mfma_f32_16x16x32_bf16 a[188:191], v[164:167], v[236:239], a[188:191]
buffer_store_dwordx4 v[24:27], v1, s[44:47], s80 offen sc1
v_mfma_f32_16x16x32_bf16 a[184:187], v[172:175], v[236:239], a[184:187]
ds_read_b64_tr_b16 v[250:251], v103 offset:50176
v_mfma_f32_16x16x32_bf16 a[184:187], v[168:171], v[232:235], a[184:187]
v_mfma_f32_16x16x32_bf16 a[180:183], v[176:179], v[232:235], a[180:183]
ds_read_b64_tr_b16 v[252:253], v103 offset:57344
v_mfma_f32_16x16x32_bf16 a[180:183], v[180:183], v[236:239], a[180:183]
s_add_u32 s73, s62, 2
v_mfma_f32_16x16x32_bf16 a[176:179], v[188:191], v[236:239], a[176:179]
s_add_u32 s70, s73, s65
ds_read_b64_tr_b16 v[254:255], v103 offset:58368
v_accvgpr_read_b32 v20, a8
v_mfma_f32_16x16x32_bf16 a[176:179], v[184:187], v[232:235], a[176:179]
s_and_b32 s70, s70, 3
v_accvgpr_read_b32 v28, a9
v_accvgpr_read_b32 v21, a10
v_mfma_f32_16x16x32_bf16 a[172:175], v[216:219], v[232:235], a[172:175]
s_and_b32 s73, s73, 12
v_accvgpr_read_b32 v29, a11
v_accvgpr_read_b32 v22, a40
v_mfma_f32_16x16x32_bf16 a[172:175], v[220:223], v[236:239], a[172:175]
s_or_b32 s73, s73, s70
v_accvgpr_read_b32 v30, a41
v_accvgpr_read_b32 v23, a42
v_mfma_f32_16x16x32_bf16 a[168:171], v[212:215], v[236:239], a[168:171]
s_lshl_b32 s73, s73, 7
v_accvgpr_read_b32 v31, a43
v_mul_f32 v20, s79, v20
v_mfma_f32_16x16x32_bf16 a[168:171], v[208:211], v[232:235], a[168:171]
s_add_u32 s69, s73, s67
v_mul_f32 v28, s79, v28
v_mul_f32 v21, s79, v21
v_mfma_f32_16x16x32_bf16 a[164:167], v[200:203], v[232:235], a[164:167]
s_add_u32 s70, s73, s68
v_mul_f32 v29, s79, v29
v_mul_f32 v22, s79, v22
v_mfma_f32_16x16x32_bf16 a[164:167], v[204:207], v[236:239], a[164:167]
s_add_u32 m0, s63, 98304
v_mul_f32 v30, s79, v30
v_mul_f32 v23, s79, v23
v_mfma_f32_16x16x32_bf16 a[160:163], v[196:199], v[236:239], a[160:163]
s_waitcnt vmcnt(14) lgkmcnt(0)
v_mul_f32 v31, s79, v31
v_cvt_pk_bf16_f32 v20, v20, v28
v_mfma_f32_16x16x32_bf16 a[160:163], v[192:195], v[232:235], a[160:163]
s_barrier
v_cvt_pk_bf16_f32 v21, v21, v29
v_cvt_pk_bf16_f32 v22, v22, v30
v_mfma_f32_16x16x32_bf16 a[192:195], v[192:195], v[240:243], a[192:195]
s_add_u32 s72, s69, 0
buffer_load_dwordx4 v4, s[4:7], s72 offen lds
v_mfma_f32_16x16x32_bf16 a[192:195], v[196:199], v[244:247], a[192:195]
s_lshl_b32 s74, s59, 2
ds_read_b64_tr_b16 v[64:65], v8 offset:0
v_or_b32 v106, s58, v0
v_mfma_f32_16x16x32_bf16 a[196:199], v[204:207], v[244:247], a[196:199]
ds_read_b64_tr_b16 v[66:67], v8 offset:1024
v_mov_b32 v107, 1
v_mfma_f32_16x16x32_bf16 a[196:199], v[200:203], v[240:243], a[196:199]
ds_read_b64_tr_b16 v[68:69], v8 offset:8192
v_lshlrev_b32 v106, 8, v106
v_mfma_f32_16x16x32_bf16 a[200:203], v[208:211], v[240:243], a[200:203]
ds_read_b64_tr_b16 v[70:71], v8 offset:9216
v_cvt_pk_bf16_f32 v23, v23, v31
v_mfma_f32_16x16x32_bf16 a[200:203], v[212:215], v[244:247], a[200:203]
s_add_u32 s72, s69, 15360
buffer_load_dwordx4 v5, s[4:7], s72 offen offset:1024 lds
v_mfma_f32_16x16x32_bf16 a[204:207], v[220:223], v[244:247], a[204:207]
s_add_u32 s80, s77, 8192
ds_read_b128 v[32:35], v16 offset:0
v_mfma_f32_16x16x32_bf16 a[204:207], v[216:219], v[240:243], a[204:207]
buffer_atomic_add v107, v106, s[48:51], s74 offen sc1
v_mfma_f32_16x16x32_bf16 a[208:211], v[184:187], v[240:243], a[208:211]
ds_read_b128 v[36:39], v17 offset:0
v_mfma_f32_16x16x32_bf16 a[208:211], v[188:191], v[244:247], a[208:211]
ds_read_b128 v[40:43], v16 offset:2048
v_mfma_f32_16x16x32_bf16 a[212:215], v[180:183], v[244:247], a[212:215]
s_add_u32 s72, s69, 129024
buffer_load_dwordx4 v4, s[4:7], s72 offen offset:2048 lds
v_mfma_f32_16x16x32_bf16 a[212:215], v[176:179], v[240:243], a[212:215]
ds_read_b128 v[44:47], v17 offset:2048
v_mfma_f32_16x16x32_bf16 a[216:219], v[168:171], v[240:243], a[216:219]
ds_read_b128 v[48:51], v16 offset:4096
v_accvgpr_read_b32 v24, a128
v_mfma_f32_16x16x32_bf16 a[216:219], v[172:175], v[244:247], a[216:219]
ds_read_b128 v[52:55], v17 offset:4096
v_accvgpr_read_b32 v28, a129
v_mfma_f32_16x16x32_bf16 a[220:223], v[164:167], v[244:247], a[220:223]
buffer_store_dwordx4 v[20:23], v1, s[44:47], s80 offen sc1
v_mfma_f32_16x16x32_bf16 a[220:223], v[160:163], v[240:243], a[220:223]
s_add_u32 s72, s69, 144384
buffer_load_dwordx4 v5, s[4:7], s72 offen offset:3072 lds
v_mfma_f32_16x16x32_bf16 a[252:255], v[160:163], v[248:251], a[252:255]
ds_read_b128 v[56:59], v16 offset:6144
v_accvgpr_read_b32 v25, a130
v_mfma_f32_16x16x32_bf16 a[252:255], v[164:167], v[252:255], a[252:255]
ds_read_b128 v[60:63], v17 offset:6144
v_accvgpr_read_b32 v29, a131
v_mfma_f32_16x16x32_bf16 a[248:251], v[172:175], v[252:255], a[248:251]
ds_read_b64_tr_b16 v[72:73], v9 offset:0
v_accvgpr_read_b32 v26, a132
v_mfma_f32_16x16x32_bf16 a[248:251], v[168:171], v[248:251], a[248:251]
s_add_u32 m0, s63, 102400
ds_read_b64_tr_b16 v[74:75], v9 offset:1024
v_accvgpr_read_b32 v30, a133
v_mfma_f32_16x16x32_bf16 a[244:247], v[176:179], v[248:251], a[244:247]
s_add_u32 s72, s70, 0
buffer_load_dwordx4 v4, s[4:7], s72 offen lds
v_mfma_f32_16x16x32_bf16 a[244:247], v[180:183], v[252:255], a[244:247]
ds_read_b64_tr_b16 v[76:77], v9 offset:8192
v_accvgpr_read_b32 v27, a134
v_mfma_f32_16x16x32_bf16 a[240:243], v[188:191], v[252:255], a[240:243]
v_accvgpr_read_b32 v31, a135
v_cvt_pk_bf16_f32 v24, v24, v28
v_mfma_f32_16x16x32_bf16 a[240:243], v[184:187], v[248:251], a[240:243]
ds_read_b64_tr_b16 v[78:79], v9 offset:9216
v_cvt_pk_bf16_f32 v25, v25, v29
v_mfma_f32_16x16x32_bf16 a[236:239], v[216:219], v[248:251], a[236:239]
ds_read_b64_tr_b16 v[80:81], v10 offset:0
v_cvt_pk_bf16_f32 v26, v26, v30
v_mfma_f32_16x16x32_bf16 a[236:239], v[220:223], v[252:255], a[236:239]
s_add_u32 s72, s70, 15360
buffer_load_dwordx4 v5, s[4:7], s72 offen offset:1024 lds
v_mfma_f32_16x16x32_bf16 a[232:235], v[212:215], v[252:255], a[232:235]
ds_read_b64_tr_b16 v[82:83], v10 offset:1024
v_cvt_pk_bf16_f32 v27, v27, v31
v_mfma_f32_16x16x32_bf16 a[232:235], v[208:211], v[248:251], a[232:235]
s_add_u32 s80, s78, 0
ds_read_b64_tr_b16 v[84:85], v10 offset:8192
v_mfma_f32_16x16x32_bf16 a[228:231], v[200:203], v[248:251], a[228:231]
ds_read_b64_tr_b16 v[86:87], v10 offset:9216
v_mfma_f32_16x16x32_bf16 a[228:231], v[204:207], v[252:255], a[228:231]
buffer_store_dwordx4 v[24:27], v1, s[44:47], s80 offen sc1
v_mfma_f32_16x16x32_bf16 a[224:227], v[196:199], v[252:255], a[224:227]
s_add_u32 s72, s70, 129024
buffer_load_dwordx4 v4, s[4:7], s72 offen offset:2048 lds
v_mfma_f32_16x16x32_bf16 a[224:227], v[192:195], v[248:251], a[224:227]
s_waitcnt lgkmcnt(8)
v_mfma_f32_16x16x32_bf16 v[128:131], v[64:67], v[32:35], 0
ds_read_b64_tr_b16 v[88:89], v11 offset:0
v_mfma_f32_16x16x32_bf16 v[128:131], v[68:71], v[36:39], v[128:131]
ds_read_b64_tr_b16 v[90:91], v11 offset:1024
v_mfma_f32_16x16x32_bf16 v[132:135], v[68:71], v[44:47], 0
v_accvgpr_read_b32 v20, a12
v_accvgpr_read_b32 v28, a13
v_mfma_f32_16x16x32_bf16 v[132:135], v[64:67], v[40:43], v[132:135]
s_add_u32 s72, s70, 144384
buffer_load_dwordx4 v5, s[4:7], s72 offen offset:3072 lds
v_mfma_f32_16x16x32_bf16 v[136:139], v[64:67], v[48:51], 0
s_lshl_b32 s71, s73, 12
ds_read_b64_tr_b16 v[92:93], v11 offset:8192
v_accvgpr_read_b32 v21, a14
v_mfma_f32_16x16x32_bf16 v[136:139], v[68:71], v[52:55], v[136:139]
s_add_u32 s71, s71, s66
v_accvgpr_read_b32 v29, a15
v_accvgpr_read_b32 v22, a44
v_mfma_f32_16x16x32_bf16 v[140:143], v[68:71], v[60:63], 0
s_add_u32 m0, s64, 32768
ds_read_b64_tr_b16 v[94:95], v11 offset:9216
v_accvgpr_read_b32 v30, a45
v_mfma_f32_16x16x32_bf16 v[140:143], v[64:67], v[56:59], v[140:143]
s_waitcnt lgkmcnt(8)
v_accvgpr_read_b32 v23, a46
v_accvgpr_read_b32 v31, a47
v_mfma_f32_16x16x32_bf16 v[156:159], v[72:75], v[56:59], 0
s_add_u32 s72, s71, 0
buffer_load_dwordx4 v6, s[12:15], s72 offen lds
v_mfma_f32_16x16x32_bf16 v[156:159], v[76:79], v[60:63], v[156:159]
s_add_u32 s73, s62, 3
ds_read_b64_tr_b16 v[64:65], v12 offset:0
v_mul_f32 v20, s79, v20
v_mfma_f32_16x16x32_bf16 v[152:155], v[76:79], v[52:55], 0
s_add_u32 s70, s73, s65
ds_read_b64_tr_b16 v[66:67], v12 offset:1024
v_mul_f32 v28, s79, v28
v_mfma_f32_16x16x32_bf16 v[152:155], v[72:75], v[48:51], v[152:155]
s_add_u32 s72, s71, 31744
buffer_load_dwordx4 v6, s[12:15], s72 offen offset:1024 lds
v_mfma_f32_16x16x32_bf16 v[148:151], v[72:75], v[40:43], 0
s_and_b32 s70, s70, 3
v_mul_f32 v21, s79, v21
v_mul_f32 v29, s79, v29
v_mfma_f32_16x16x32_bf16 v[148:151], v[76:79], v[44:47], v[148:151]
s_and_b32 s73, s73, 12
ds_read_b64_tr_b16 v[68:69], v12 offset:8192
v_mul_f32 v22, s79, v22
v_mfma_f32_16x16x32_bf16 v[144:147], v[76:79], v[36:39], 0
s_or_b32 s73, s73, s70
ds_read_b64_tr_b16 v[70:71], v12 offset:9216
v_mul_f32 v30, s79, v30
v_mfma_f32_16x16x32_bf16 v[144:147], v[72:75], v[32:35], v[144:147]
s_waitcnt lgkmcnt(8)
v_mul_f32 v23, s79, v23
v_mul_f32 v31, s79, v31
v_mfma_f32_16x16x32_bf16 v[160:163], v[80:83], v[32:35], 0
s_lshl_b32 s73, s73, 7
ds_read_b64_tr_b16 v[72:73], v13 offset:0
v_cvt_pk_bf16_f32 v20, v20, v28
v_mfma_f32_16x16x32_bf16 v[160:163], v[84:87], v[36:39], v[160:163]
s_add_u32 s72, s71, 63488
buffer_load_dwordx4 v7, s[12:15], s72 offen offset:2048 lds
v_mfma_f32_16x16x32_bf16 v[164:167], v[84:87], v[44:47], 0
s_add_u32 s69, s73, s67
ds_read_b64_tr_b16 v[74:75], v13 offset:1024
v_cvt_pk_bf16_f32 v21, v21, v29
v_mfma_f32_16x16x32_bf16 v[164:167], v[80:83], v[40:43], v[164:167]
s_add_u32 s70, s73, s68
v_cvt_pk_bf16_f32 v22, v22, v30
v_cvt_pk_bf16_f32 v23, v23, v31
v_mfma_f32_16x16x32_bf16 v[168:171], v[80:83], v[48:51], 0
s_waitcnt vmcnt(20)
ds_read_b64_tr_b16 v[76:77], v13 offset:8192
v_mfma_f32_16x16x32_bf16 v[168:171], v[84:87], v[52:55], v[168:171]
s_add_u32 s80, s77, 12288
ds_read_b64_tr_b16 v[78:79], v13 offset:9216
v_mfma_f32_16x16x32_bf16 v[172:175], v[84:87], v[60:63], 0
s_add_u32 s72, s71, 95232
ds_read_b128 v[96:99], v18 offset:0
v_mfma_f32_16x16x32_bf16 v[172:175], v[80:83], v[56:59], v[172:175]
s_waitcnt lgkmcnt(9)
buffer_load_dwordx4 v7, s[12:15], s72 offen offset:3072 lds
v_mfma_f32_16x16x32_bf16 v[188:191], v[88:91], v[56:59], 0
ds_read_b64_tr_b16 v[80:81], v14 offset:0
v_accvgpr_read_b32 v24, a136
v_mfma_f32_16x16x32_bf16 v[188:191], v[92:95], v[60:63], v[188:191]
ds_read_b64_tr_b16 v[82:83], v14 offset:1024
v_accvgpr_read_b32 v28, a137
v_mfma_f32_16x16x32_bf16 v[184:187], v[92:95], v[52:55], 0
ds_read_b128 v[100:103], v19 offset:0
v_accvgpr_read_b32 v25, a138
v_mfma_f32_16x16x32_bf16 v[184:187], v[88:91], v[48:51], v[184:187]
ds_read_b64_tr_b16 v[84:85], v14 offset:8192
v_accvgpr_read_b32 v29, a139
v_mfma_f32_16x16x32_bf16 v[180:183], v[88:91], v[40:43], 0
buffer_store_dwordx4 v[20:23], v1, s[44:47], s80 offen sc1
v_mfma_f32_16x16x32_bf16 v[180:183], v[92:95], v[44:47], v[180:183]
s_add_u32 m0, s63, 131072
ds_read_b64_tr_b16 v[86:87], v14 offset:9216
v_accvgpr_read_b32 v26, a140
v_mfma_f32_16x16x32_bf16 v[176:179], v[92:95], v[36:39], 0
s_add_u32 s72, s69, 0
buffer_load_dwordx4 v4, s[4:7], s72 offen lds
v_mfma_f32_16x16x32_bf16 v[176:179], v[88:91], v[32:35], v[176:179]
s_waitcnt lgkmcnt(10)
ds_read_b128 v[104:107], v18 offset:2048
v_accvgpr_read_b32 v30, a141
v_mfma_f32_16x16x32_bf16 v[192:195], v[64:67], v[32:35], 0
ds_read_b64_tr_b16 v[88:89], v15 offset:0
v_accvgpr_read_b32 v27, a142
v_mfma_f32_16x16x32_bf16 v[192:195], v[68:71], v[36:39], v[192:195]
ds_read_b64_tr_b16 v[90:91], v15 offset:1024
v_accvgpr_read_b32 v31, a143
v_mfma_f32_16x16x32_bf16 v[196:199], v[68:71], v[44:47], 0
ds_read_b64_tr_b16 v[92:93], v15 offset:8192
v_cvt_pk_bf16_f32 v24, v24, v28
v_mfma_f32_16x16x32_bf16 v[196:199], v[64:67], v[40:43], v[196:199]
s_add_u32 s72, s69, 15360
buffer_load_dwordx4 v5, s[4:7], s72 offen offset:1024 lds
v_mfma_f32_16x16x32_bf16 v[200:203], v[64:67], v[48:51], 0
ds_read_b64_tr_b16 v[94:95], v15 offset:9216
v_cvt_pk_bf16_f32 v25, v25, v29
v_mfma_f32_16x16x32_bf16 v[200:203], v[68:71], v[52:55], v[200:203]
ds_read_b128 v[108:111], v19 offset:2048
v_cvt_pk_bf16_f32 v26, v26, v30
v_mfma_f32_16x16x32_bf16 v[204:207], v[68:71], v[60:63], 0
v_cvt_pk_bf16_f32 v27, v27, v31
v_mfma_f32_16x16x32_bf16 v[204:207], v[64:67], v[56:59], v[204:207]
s_waitcnt lgkmcnt(12)
ds_read_b128 v[112:115], v18 offset:4096
v_mfma_f32_16x16x32_bf16 v[220:223], v[72:75], v[56:59], 0
s_add_u32 s72, s69, 129024
buffer_load_dwordx4 v4, s[4:7], s72 offen offset:2048 lds
v_mfma_f32_16x16x32_bf16 v[220:223], v[76:79], v[60:63], v[220:223]
s_add_u32 s80, s78, 8192
buffer_store_dwordx4 v[24:27], v1, s[44:47], s80 offen sc1
v_mfma_f32_16x16x32_bf16 v[216:219], v[76:79], v[52:55], 0
s_waitcnt vmcnt(21) lgkmcnt(2)
ds_read_b128 v[116:119], v19 offset:4096
v_mfma_f32_16x16x32_bf16 v[216:219], v[72:75], v[48:51], v[216:219]
s_barrier
ds_read_b128 v[120:123], v18 offset:6144
v_mfma_f32_16x16x32_bf16 v[212:215], v[72:75], v[40:43], 0
ds_read_b64_tr_b16 v[64:65], v8 offset:16384
ds_read_b64_tr_b16 v[66:67], v8 offset:17408
v_mfma_f32_16x16x32_bf16 v[212:215], v[76:79], v[44:47], v[212:215]
ds_read_b64_tr_b16 v[68:69], v8 offset:24576
v_mfma_f32_16x16x32_bf16 v[208:211], v[76:79], v[36:39], 0
s_add_u32 s72, s69, 144384
buffer_load_dwordx4 v5, s[4:7], s72 offen offset:3072 lds
v_mfma_f32_16x16x32_bf16 v[208:211], v[72:75], v[32:35], v[208:211]
ds_read_b64_tr_b16 v[70:71], v8 offset:25600
v_accvgpr_read_b32 v20, a16
v_mfma_f32_16x16x32_bf16 v[224:227], v[80:83], v[32:35], 0
ds_read_b64_tr_b16 v[72:73], v9 offset:16384
v_accvgpr_read_b32 v28, a17
v_mfma_f32_16x16x32_bf16 v[224:227], v[84:87], v[36:39], v[224:227]
ds_read_b64_tr_b16 v[74:75], v9 offset:17408
v_accvgpr_read_b32 v21, a18
v_mfma_f32_16x16x32_bf16 v[228:231], v[84:87], v[44:47], 0
s_add_u32 m0, s63, 135168
v_accvgpr_read_b32 v29, a19
v_accvgpr_read_b32 v22, a48
v_mfma_f32_16x16x32_bf16 v[228:231], v[80:83], v[40:43], v[228:231]
s_add_u32 s72, s70, 0
buffer_load_dwordx4 v4, s[4:7], s72 offen lds
v_mfma_f32_16x16x32_bf16 v[232:235], v[80:83], v[48:51], 0
ds_read_b64_tr_b16 v[76:77], v9 offset:24576
v_accvgpr_read_b32 v30, a49
v_mfma_f32_16x16x32_bf16 v[232:235], v[84:87], v[52:55], v[232:235]
ds_read_b128 v[124:127], v19 offset:6144
v_accvgpr_read_b32 v23, a50
v_mfma_f32_16x16x32_bf16 v[236:239], v[84:87], v[60:63], 0
ds_read_b64_tr_b16 v[78:79], v9 offset:25600
v_accvgpr_read_b32 v31, a51
v_mfma_f32_16x16x32_bf16 v[236:239], v[80:83], v[56:59], v[236:239]
v_mul_f32 v20, s79, v20
v_mul_f32 v28, s79, v28
v_mfma_f32_16x16x32_bf16 v[252:255], v[88:91], v[56:59], 0
s_add_u32 s72, s70, 15360
buffer_load_dwordx4 v5, s[4:7], s72 offen offset:1024 lds
v_mfma_f32_16x16x32_bf16 v[252:255], v[92:95], v[60:63], v[252:255]
ds_read_b64_tr_b16 v[80:81], v10 offset:16384
v_mul_f32 v21, s79, v21
v_mfma_f32_16x16x32_bf16 v[248:251], v[92:95], v[52:55], 0
ds_read_b64_tr_b16 v[82:83], v10 offset:17408
v_mul_f32 v29, s79, v29
v_mfma_f32_16x16x32_bf16 v[248:251], v[88:91], v[48:51], v[248:251]
v_mul_f32 v22, s79, v22
v_mul_f32 v30, s79, v30
v_mfma_f32_16x16x32_bf16 v[244:247], v[88:91], v[40:43], 0
ds_read_b64_tr_b16 v[84:85], v10 offset:24576
v_mul_f32 v23, s79, v23
v_mfma_f32_16x16x32_bf16 v[244:247], v[92:95], v[44:47], v[244:247]
ds_read_b64_tr_b16 v[86:87], v10 offset:25600
v_mul_f32 v31, s79, v31
v_mfma_f32_16x16x32_bf16 v[240:243], v[92:95], v[36:39], 0
s_add_u32 s72, s70, 129024
buffer_load_dwordx4 v4, s[4:7], s72 offen offset:2048 lds
v_mfma_f32_16x16x32_bf16 v[240:243], v[88:91], v[32:35], v[240:243]
s_waitcnt lgkmcnt(5)
v_cvt_pk_bf16_f32 v20, v20, v28
v_cvt_pk_bf16_f32 v21, v21, v29
v_mfma_f32_16x16x32_bf16 v[128:131], v[64:67], v[96:99], v[128:131]
ds_read_b64_tr_b16 v[88:89], v11 offset:16384
v_cvt_pk_bf16_f32 v22, v22, v30
v_mfma_f32_16x16x32_bf16 v[128:131], v[68:71], v[100:103], v[128:131]
ds_read_b64_tr_b16 v[90:91], v11 offset:17408
v_cvt_pk_bf16_f32 v23, v23, v31
v_mfma_f32_16x16x32_bf16 v[132:135], v[68:71], v[108:111], v[132:135]
s_add_u32 s80, s77, 32768
buffer_store_dwordx4 v[20:23], v1, s[44:47], s80 offen sc1
v_mfma_f32_16x16x32_bf16 v[132:135], v[64:67], v[104:107], v[132:135]
s_add_u32 s72, s70, 144384
buffer_load_dwordx4 v5, s[4:7], s72 offen offset:3072 lds
v_mfma_f32_16x16x32_bf16 v[136:139], v[64:67], v[112:115], v[136:139]
ds_read_b64_tr_b16 v[92:93], v11 offset:24576
v_accvgpr_read_b32 v24, a144
v_mfma_f32_16x16x32_bf16 v[136:139], v[68:71], v[116:119], v[136:139]
s_lshl_b32 s71, s73, 12
v_accvgpr_read_b32 v28, a145
v_accvgpr_read_b32 v25, a146
v_mfma_f32_16x16x32_bf16 v[140:143], v[68:71], v[124:127], v[140:143]
s_add_u32 s71, s71, s66
ds_read_b64_tr_b16 v[94:95], v11 offset:25600
v_accvgpr_read_b32 v29, a147
v_mfma_f32_16x16x32_bf16 v[140:143], v[64:67], v[120:123], v[140:143]
s_waitcnt lgkmcnt(8)
v_accvgpr_read_b32 v26, a148
v_accvgpr_read_b32 v30, a149
v_mfma_f32_16x16x32_bf16 v[156:159], v[72:75], v[120:123], v[156:159]
s_add_u32 m0, s64, 0
ds_read_b64_tr_b16 v[64:65], v12 offset:16384
v_accvgpr_read_b32 v27, a150
v_mfma_f32_16x16x32_bf16 v[156:159], v[76:79], v[124:127], v[156:159]
s_add_u32 s72, s71, 0
buffer_load_dwordx4 v6, s[12:15], s72 offen lds
v_mfma_f32_16x16x32_bf16 v[152:155], v[76:79], v[116:119], v[152:155]
s_add_u32 s73, s62, 4
ds_read_b64_tr_b16 v[66:67], v12 offset:17408
v_accvgpr_read_b32 v31, a151
v_mfma_f32_16x16x32_bf16 v[152:155], v[72:75], v[112:115], v[152:155]
s_add_u32 s70, s73, s65
v_cvt_pk_bf16_f32 v24, v24, v28
v_cvt_pk_bf16_f32 v25, v25, v29
v_mfma_f32_16x16x32_bf16 v[148:151], v[72:75], v[104:107], v[148:151]
s_and_b32 s70, s70, 3
ds_read_b64_tr_b16 v[68:69], v12 offset:24576
v_cvt_pk_bf16_f32 v26, v26, v30
v_mfma_f32_16x16x32_bf16 v[148:151], v[76:79], v[108:111], v[148:151]
s_and_b32 s73, s73, 12
ds_read_b64_tr_b16 v[70:71], v12 offset:25600
v_cvt_pk_bf16_f32 v27, v27, v31
v_mfma_f32_16x16x32_bf16 v[144:147], v[76:79], v[100:103], v[144:147]
s_add_u32 s72, s71, 31744
buffer_load_dwordx4 v6, s[12:15], s72 offen offset:1024 lds
v_mfma_f32_16x16x32_bf16 v[144:147], v[72:75], v[96:99], v[144:147]
s_waitcnt lgkmcnt(8)
v_mfma_f32_16x16x32_bf16 v[160:163], v[80:83], v[96:99], v[160:163]
s_or_b32 s73, s73, s70
ds_read_b64_tr_b16 v[72:73], v13 offset:16384
v_mfma_f32_16x16x32_bf16 v[160:163], v[84:87], v[100:103], v[160:163]
s_lshl_b32 s73, s73, 7
ds_read_b64_tr_b16 v[74:75], v13 offset:17408
v_mfma_f32_16x16x32_bf16 v[164:167], v[84:87], v[108:111], v[164:167]
s_add_u32 s69, s73, s67
v_mfma_f32_16x16x32_bf16 v[164:167], v[80:83], v[104:107], v[164:167]
s_add_u32 s72, s71, 63488
buffer_load_dwordx4 v7, s[12:15], s72 offen offset:2048 lds
v_mfma_f32_16x16x32_bf16 v[168:171], v[80:83], v[112:115], v[168:171]
s_waitcnt vmcnt(18)
ds_read_b64_tr_b16 v[76:77], v13 offset:24576
v_mfma_f32_16x16x32_bf16 v[168:171], v[84:87], v[116:119], v[168:171]
s_add_u32 s70, s73, s68
ds_read_b128 v[32:35], v18 offset:32768
v_mfma_f32_16x16x32_bf16 v[172:175], v[84:87], v[124:127], v[172:175]
s_add_u32 s80, s78, 32768
ds_read_b64_tr_b16 v[78:79], v13 offset:25600
v_mfma_f32_16x16x32_bf16 v[172:175], v[80:83], v[120:123], v[172:175]
s_waitcnt lgkmcnt(9)
ds_read_b128 v[36:39], v19 offset:32768
v_mfma_f32_16x16x32_bf16 v[188:191], v[88:91], v[120:123], v[188:191]
s_add_u32 s72, s71, 95232
buffer_load_dwordx4 v7, s[12:15], s72 offen offset:3072 lds
v_mfma_f32_16x16x32_bf16 v[188:191], v[92:95], v[124:127], v[188:191]
ds_read_b64_tr_b16 v[80:81], v14 offset:16384
v_mfma_f32_16x16x32_bf16 v[184:187], v[92:95], v[116:119], v[184:187]
ds_read_b64_tr_b16 v[82:83], v14 offset:17408
v_mfma_f32_16x16x32_bf16 v[184:187], v[88:91], v[112:115], v[184:187]
buffer_store_dwordx4 v[24:27], v1, s[44:47], s80 offen sc1
v_mfma_f32_16x16x32_bf16 v[180:183], v[88:91], v[104:107], v[180:183]
ds_read_b64_tr_b16 v[84:85], v14 offset:24576
v_accvgpr_read_b32 v20, a20
v_mfma_f32_16x16x32_bf16 v[180:183], v[92:95], v[108:111], v[180:183]
s_add_u32 m0, s63, 65536
ds_read_b64_tr_b16 v[86:87], v14 offset:25600
v_accvgpr_read_b32 v28, a21
v_mfma_f32_16x16x32_bf16 v[176:179], v[92:95], v[100:103], v[176:179]
s_add_u32 s72, s69, 0
buffer_load_dwordx4 v4, s[4:7], s72 offen lds
v_mfma_f32_16x16x32_bf16 v[176:179], v[88:91], v[96:99], v[176:179]
s_waitcnt lgkmcnt(10)
ds_read_b128 v[40:43], v18 offset:34816
v_accvgpr_read_b32 v21, a22
v_mfma_f32_16x16x32_bf16 v[192:195], v[64:67], v[96:99], v[192:195]
ds_read_b64_tr_b16 v[88:89], v15 offset:16384
v_accvgpr_read_b32 v29, a23
v_mfma_f32_16x16x32_bf16 v[192:195], v[68:71], v[100:103], v[192:195]
ds_read_b64_tr_b16 v[90:91], v15 offset:17408
v_accvgpr_read_b32 v22, a52
v_mfma_f32_16x16x32_bf16 v[196:199], v[68:71], v[108:111], v[196:199]
ds_read_b64_tr_b16 v[92:93], v15 offset:24576
v_accvgpr_read_b32 v30, a53
v_mfma_f32_16x16x32_bf16 v[196:199], v[64:67], v[104:107], v[196:199]
s_add_u32 s72, s69, 15360
buffer_load_dwordx4 v5, s[4:7], s72 offen offset:1024 lds
v_mfma_f32_16x16x32_bf16 v[200:203], v[64:67], v[112:115], v[200:203]
ds_read_b64_tr_b16 v[94:95], v15 offset:25600
v_accvgpr_read_b32 v23, a54
v_mfma_f32_16x16x32_bf16 v[200:203], v[68:71], v[116:119], v[200:203]
ds_read_b128 v[44:47], v19 offset:34816
v_accvgpr_read_b32 v31, a55
v_mfma_f32_16x16x32_bf16 v[204:207], v[68:71], v[124:127], v[204:207]
v_mul_f32 v20, s79, v20
v_mul_f32 v28, s79, v28
v_mfma_f32_16x16x32_bf16 v[204:207], v[64:67], v[120:123], v[204:207]
s_waitcnt lgkmcnt(11)
ds_read_b128 v[48:51], v18 offset:36864
v_mul_f32 v21, s79, v21
v_mfma_f32_16x16x32_bf16 v[220:223], v[72:75], v[120:123], v[220:223]
s_add_u32 s72, s69, 129024
buffer_load_dwordx4 v4, s[4:7], s72 offen offset:2048 lds
v_mfma_f32_16x16x32_bf16 v[220:223], v[76:79], v[124:127], v[220:223]
v_mul_f32 v29, s79, v29
v_mul_f32 v22, s79, v22
v_mfma_f32_16x16x32_bf16 v[216:219], v[76:79], v[116:119], v[216:219]
s_waitcnt vmcnt(19) lgkmcnt(2)
ds_read_b128 v[52:55], v19 offset:36864
v_mul_f32 v30, s79, v30
v_mfma_f32_16x16x32_bf16 v[216:219], v[72:75], v[112:115], v[216:219]
s_barrier
ds_read_b128 v[56:59], v18 offset:38912
v_mul_f32 v23, s79, v23
v_mfma_f32_16x16x32_bf16 v[212:215], v[72:75], v[104:107], v[212:215]
ds_read_b64_tr_b16 v[64:65], v8 offset:32768
ds_read_b64_tr_b16 v[66:67], v8 offset:33792
v_mfma_f32_16x16x32_bf16 v[212:215], v[76:79], v[108:111], v[212:215]
ds_read_b64_tr_b16 v[68:69], v8 offset:40960
v_mul_f32 v31, s79, v31
v_mfma_f32_16x16x32_bf16 v[208:211], v[76:79], v[100:103], v[208:211]
s_add_u32 s72, s69, 144384
buffer_load_dwordx4 v5, s[4:7], s72 offen offset:3072 lds
v_mfma_f32_16x16x32_bf16 v[208:211], v[72:75], v[96:99], v[208:211]
ds_read_b64_tr_b16 v[70:71], v8 offset:41984
v_cvt_pk_bf16_f32 v20, v20, v28
v_mfma_f32_16x16x32_bf16 v[224:227], v[80:83], v[96:99], v[224:227]
ds_read_b64_tr_b16 v[72:73], v9 offset:32768
v_cvt_pk_bf16_f32 v21, v21, v29
v_mfma_f32_16x16x32_bf16 v[224:227], v[84:87], v[100:103], v[224:227]
ds_read_b64_tr_b16 v[74:75], v9 offset:33792
v_cvt_pk_bf16_f32 v22, v22, v30
v_mfma_f32_16x16x32_bf16 v[228:231], v[84:87], v[108:111], v[228:231]
s_add_u32 m0, s63, 69632
v_cvt_pk_bf16_f32 v23, v23, v31
v_accvgpr_read_b32 v24, a152
v_mfma_f32_16x16x32_bf16 v[228:231], v[80:83], v[104:107], v[228:231]
s_add_u32 s72, s70, 0
buffer_load_dwordx4 v4, s[4:7], s72 offen lds
v_mfma_f32_16x16x32_bf16 v[232:235], v[80:83], v[112:115], v[232:235]
s_add_u32 s80, s77, 36864
ds_read_b64_tr_b16 v[76:77], v9 offset:40960
v_accvgpr_read_b32 v28, a153
v_mfma_f32_16x16x32_bf16 v[232:235], v[84:87], v[116:119], v[232:235]
ds_read_b128 v[60:63], v19 offset:38912
v_accvgpr_read_b32 v25, a154
v_mfma_f32_16x16x32_bf16 v[236:239], v[84:87], v[124:127], v[236:239]
ds_read_b64_tr_b16 v[78:79], v9 offset:41984
v_accvgpr_read_b32 v29, a155
v_mfma_f32_16x16x32_bf16 v[236:239], v[80:83], v[120:123], v[236:239]
buffer_store_dwordx4 v[20:23], v1, s[44:47], s80 offen sc1
v_mfma_f32_16x16x32_bf16 v[252:255], v[88:91], v[120:123], v[252:255]
s_add_u32 s72, s70, 15360
buffer_load_dwordx4 v5, s[4:7], s72 offen offset:1024 lds
v_mfma_f32_16x16x32_bf16 v[252:255], v[92:95], v[124:127], v[252:255]
ds_read_b64_tr_b16 v[80:81], v10 offset:32768
v_accvgpr_read_b32 v26, a156
v_mfma_f32_16x16x32_bf16 v[248:251], v[92:95], v[116:119], v[248:251]
ds_read_b64_tr_b16 v[82:83], v10 offset:33792
v_accvgpr_read_b32 v30, a157
v_mfma_f32_16x16x32_bf16 v[248:251], v[88:91], v[112:115], v[248:251]
v_accvgpr_read_b32 v27, a158
v_accvgpr_read_b32 v31, a159
v_mfma_f32_16x16x32_bf16 v[244:247], v[88:91], v[104:107], v[244:247]
ds_read_b64_tr_b16 v[84:85], v10 offset:40960
v_cvt_pk_bf16_f32 v24, v24, v28
v_mfma_f32_16x16x32_bf16 v[244:247], v[92:95], v[108:111], v[244:247]
ds_read_b64_tr_b16 v[86:87], v10 offset:41984
v_cvt_pk_bf16_f32 v25, v25, v29
v_mfma_f32_16x16x32_bf16 v[240:243], v[92:95], v[100:103], v[240:243]
s_add_u32 s72, s70, 129024
buffer_load_dwordx4 v4, s[4:7], s72 offen offset:2048 lds
v_mfma_f32_16x16x32_bf16 v[240:243], v[88:91], v[96:99], v[240:243]
s_waitcnt lgkmcnt(5)
v_cvt_pk_bf16_f32 v26, v26, v30
v_cvt_pk_bf16_f32 v27, v27, v31
v_mfma_f32_16x16x32_bf16 v[128:131], v[64:67], v[32:35], v[128:131]
s_add_u32 s80, s78, 40960
ds_read_b64_tr_b16 v[88:89], v11 offset:32768
v_mfma_f32_16x16x32_bf16 v[128:131], v[68:71], v[36:39], v[128:131]
ds_read_b64_tr_b16 v[90:91], v11 offset:33792
v_mfma_f32_16x16x32_bf16 v[132:135], v[68:71], v[44:47], v[132:135]
buffer_store_dwordx4 v[24:27], v1, s[44:47], s80 offen sc1
v_mfma_f32_16x16x32_bf16 v[132:135], v[64:67], v[40:43], v[132:135]
s_add_u32 s72, s70, 144384
buffer_load_dwordx4 v5, s[4:7], s72 offen offset:3072 lds
v_mfma_f32_16x16x32_bf16 v[136:139], v[64:67], v[48:51], v[136:139]
ds_read_b64_tr_b16 v[92:93], v11 offset:40960
v_mfma_f32_16x16x32_bf16 v[136:139], v[68:71], v[52:55], v[136:139]
s_lshl_b32 s71, s73, 12
v_mfma_f32_16x16x32_bf16 v[140:143], v[68:71], v[60:63], v[140:143]
s_add_u32 s71, s71, s66
ds_read_b64_tr_b16 v[94:95], v11 offset:41984
v_mfma_f32_16x16x32_bf16 v[140:143], v[64:67], v[56:59], v[140:143]
s_waitcnt lgkmcnt(8)
v_accvgpr_read_b32 v20, a24
v_accvgpr_read_b32 v28, a25
v_mfma_f32_16x16x32_bf16 v[156:159], v[72:75], v[56:59], v[156:159]
s_add_u32 m0, s64, 16384
ds_read_b64_tr_b16 v[64:65], v12 offset:32768
v_accvgpr_read_b32 v21, a26
v_mfma_f32_16x16x32_bf16 v[156:159], v[76:79], v[60:63], v[156:159]
s_add_u32 s72, s71, 0
buffer_load_dwordx4 v6, s[12:15], s72 offen lds
v_mfma_f32_16x16x32_bf16 v[152:155], v[76:79], v[52:55], v[152:155]
s_add_u32 s73, s62, 5
ds_read_b64_tr_b16 v[66:67], v12 offset:33792
v_accvgpr_read_b32 v29, a27
v_mfma_f32_16x16x32_bf16 v[152:155], v[72:75], v[48:51], v[152:155]
s_add_u32 s70, s73, s65
v_accvgpr_read_b32 v22, a56
v_accvgpr_read_b32 v30, a57
v_mfma_f32_16x16x32_bf16 v[148:151], v[72:75], v[40:43], v[148:151]
s_and_b32 s70, s70, 3
ds_read_b64_tr_b16 v[68:69], v12 offset:40960
v_accvgpr_read_b32 v23, a58
v_mfma_f32_16x16x32_bf16 v[148:151], v[76:79], v[44:47], v[148:151]
s_and_b32 s73, s73, 12
ds_read_b64_tr_b16 v[70:71], v12 offset:41984
v_accvgpr_read_b32 v31, a59
v_mfma_f32_16x16x32_bf16 v[144:147], v[76:79], v[36:39], v[144:147]
s_add_u32 s72, s71, 31744
buffer_load_dwordx4 v6, s[12:15], s72 offen offset:1024 lds
v_mfma_f32_16x16x32_bf16 v[144:147], v[72:75], v[32:35], v[144:147]
s_waitcnt lgkmcnt(8)
v_mul_f32 v20, s79, v20
v_mul_f32 v28, s79, v28
v_mfma_f32_16x16x32_bf16 v[160:163], v[80:83], v[32:35], v[160:163]
s_or_b32 s73, s73, s70
ds_read_b64_tr_b16 v[72:73], v13 offset:32768
v_mul_f32 v21, s79, v21
v_mfma_f32_16x16x32_bf16 v[160:163], v[84:87], v[36:39], v[160:163]
s_lshl_b32 s73, s73, 7
ds_read_b64_tr_b16 v[74:75], v13 offset:33792
v_mul_f32 v29, s79, v29
v_mfma_f32_16x16x32_bf16 v[164:167], v[84:87], v[44:47], v[164:167]
s_add_u32 s69, s73, s67
v_mul_f32 v22, s79, v22
v_mul_f32 v30, s79, v30
v_mfma_f32_16x16x32_bf16 v[164:167], v[80:83], v[40:43], v[164:167]
s_add_u32 s72, s71, 63488
buffer_load_dwordx4 v7, s[12:15], s72 offen offset:2048 lds
v_mfma_f32_16x16x32_bf16 v[168:171], v[80:83], v[48:51], v[168:171]
s_waitcnt vmcnt(18)
ds_read_b64_tr_b16 v[76:77], v13 offset:40960
v_mul_f32 v23, s79, v23
v_mfma_f32_16x16x32_bf16 v[168:171], v[84:87], v[52:55], v[168:171]
s_add_u32 s70, s73, s68
ds_read_b128 v[96:99], v16 offset:0
v_mul_f32 v31, s79, v31
v_mfma_f32_16x16x32_bf16 v[172:175], v[84:87], v[60:63], v[172:175]
ds_read_b64_tr_b16 v[78:79], v13 offset:41984
v_cvt_pk_bf16_f32 v20, v20, v28
v_mfma_f32_16x16x32_bf16 v[172:175], v[80:83], v[56:59], v[172:175]
s_waitcnt lgkmcnt(9)
ds_read_b128 v[100:103], v17 offset:0
v_cvt_pk_bf16_f32 v21, v21, v29
v_mfma_f32_16x16x32_bf16 v[188:191], v[88:91], v[56:59], v[188:191]
s_add_u32 s72, s71, 95232
buffer_load_dwordx4 v7, s[12:15], s72 offen offset:3072 lds
v_mfma_f32_16x16x32_bf16 v[188:191], v[92:95], v[60:63], v[188:191]
ds_read_b64_tr_b16 v[80:81], v14 offset:32768
v_cvt_pk_bf16_f32 v22, v22, v30
v_mfma_f32_16x16x32_bf16 v[184:187], v[92:95], v[52:55], v[184:187]
ds_read_b64_tr_b16 v[82:83], v14 offset:33792
v_cvt_pk_bf16_f32 v23, v23, v31
v_mfma_f32_16x16x32_bf16 v[184:187], v[88:91], v[48:51], v[184:187]
s_add_u32 s80, s77, 40960
buffer_store_dwordx4 v[20:23], v1, s[44:47], s80 offen sc1
v_mfma_f32_16x16x32_bf16 v[180:183], v[88:91], v[40:43], v[180:183]
ds_read_b64_tr_b16 v[84:85], v14 offset:40960
v_mfma_f32_16x16x32_bf16 v[180:183], v[92:95], v[44:47], v[180:183]
s_add_u32 m0, s63, 98304
ds_read_b64_tr_b16 v[86:87], v14 offset:41984
v_accvgpr_read_b32 v24, a160
v_mfma_f32_16x16x32_bf16 v[176:179], v[92:95], v[36:39], v[176:179]
s_add_u32 s72, s69, 0
buffer_load_dwordx4 v4, s[4:7], s72 offen lds
v_mfma_f32_16x16x32_bf16 v[176:179], v[88:91], v[32:35], v[176:179]
s_waitcnt lgkmcnt(10)
ds_read_b128 v[104:107], v16 offset:2048
v_accvgpr_read_b32 v28, a161
v_mfma_f32_16x16x32_bf16 v[192:195], v[64:67], v[32:35], v[192:195]
ds_read_b64_tr_b16 v[88:89], v15 offset:32768
v_accvgpr_read_b32 v25, a162
v_mfma_f32_16x16x32_bf16 v[192:195], v[68:71], v[36:39], v[192:195]
ds_read_b64_tr_b16 v[90:91], v15 offset:33792
v_accvgpr_read_b32 v29, a163
v_mfma_f32_16x16x32_bf16 v[196:199], v[68:71], v[44:47], v[196:199]
ds_read_b64_tr_b16 v[92:93], v15 offset:40960
v_accvgpr_read_b32 v26, a164
v_mfma_f32_16x16x32_bf16 v[196:199], v[64:67], v[40:43], v[196:199]
s_add_u32 s72, s69, 15360
buffer_load_dwordx4 v5, s[4:7], s72 offen offset:1024 lds
v_mfma_f32_16x16x32_bf16 v[200:203], v[64:67], v[48:51], v[200:203]
ds_read_b64_tr_b16 v[94:95], v15 offset:41984
v_accvgpr_read_b32 v30, a165
v_mfma_f32_16x16x32_bf16 v[200:203], v[68:71], v[52:55], v[200:203]
ds_read_b128 v[108:111], v17 offset:2048
v_accvgpr_read_b32 v27, a166
v_mfma_f32_16x16x32_bf16 v[204:207], v[68:71], v[60:63], v[204:207]
v_accvgpr_read_b32 v31, a167
v_cvt_pk_bf16_f32 v24, v24, v28
v_mfma_f32_16x16x32_bf16 v[204:207], v[64:67], v[56:59], v[204:207]
s_waitcnt lgkmcnt(11)
ds_read_b128 v[112:115], v16 offset:4096
v_cvt_pk_bf16_f32 v25, v25, v29
v_mfma_f32_16x16x32_bf16 v[220:223], v[72:75], v[56:59], v[220:223]
s_add_u32 s72, s69, 129024
buffer_load_dwordx4 v4, s[4:7], s72 offen offset:2048 lds
v_mfma_f32_16x16x32_bf16 v[220:223], v[76:79], v[60:63], v[220:223]
v_cvt_pk_bf16_f32 v26, v26, v30
v_cvt_pk_bf16_f32 v27, v27, v31
v_mfma_f32_16x16x32_bf16 v[216:219], v[76:79], v[52:55], v[216:219]
s_waitcnt vmcnt(19) lgkmcnt(2)
ds_read_b128 v[116:119], v17 offset:4096
v_mfma_f32_16x16x32_bf16 v[216:219], v[72:75], v[48:51], v[216:219]
s_barrier
ds_read_b128 v[120:123], v16 offset:6144
v_mfma_f32_16x16x32_bf16 v[212:215], v[72:75], v[40:43], v[212:215]
s_add_u32 s80, s78, 1024
ds_read_b64_tr_b16 v[64:65], v8 offset:0
ds_read_b64_tr_b16 v[66:67], v8 offset:1024
v_mfma_f32_16x16x32_bf16 v[212:215], v[76:79], v[44:47], v[212:215]
ds_read_b64_tr_b16 v[68:69], v8 offset:8192
v_mfma_f32_16x16x32_bf16 v[208:211], v[76:79], v[36:39], v[208:211]
s_add_u32 s72, s69, 144384
buffer_load_dwordx4 v5, s[4:7], s72 offen offset:3072 lds
v_mfma_f32_16x16x32_bf16 v[208:211], v[72:75], v[32:35], v[208:211]
ds_read_b64_tr_b16 v[70:71], v8 offset:9216
v_mfma_f32_16x16x32_bf16 v[224:227], v[80:83], v[32:35], v[224:227]
ds_read_b64_tr_b16 v[72:73], v9 offset:0
v_mfma_f32_16x16x32_bf16 v[224:227], v[84:87], v[36:39], v[224:227]
ds_read_b64_tr_b16 v[74:75], v9 offset:1024
v_mfma_f32_16x16x32_bf16 v[228:231], v[84:87], v[44:47], v[228:231]
s_add_u32 m0, s63, 102400
buffer_store_dwordx4 v[24:27], v1, s[44:47], s80 offen sc1
v_mfma_f32_16x16x32_bf16 v[228:231], v[80:83], v[40:43], v[228:231]
s_add_u32 s72, s70, 0
buffer_load_dwordx4 v4, s[4:7], s72 offen lds
v_mfma_f32_16x16x32_bf16 v[232:235], v[80:83], v[48:51], v[232:235]
ds_read_b64_tr_b16 v[76:77], v9 offset:8192
v_accvgpr_read_b32 v20, a28
v_mfma_f32_16x16x32_bf16 v[232:235], v[84:87], v[52:55], v[232:235]
ds_read_b128 v[124:127], v17 offset:6144
v_accvgpr_read_b32 v28, a29
v_mfma_f32_16x16x32_bf16 v[236:239], v[84:87], v[60:63], v[236:239]
ds_read_b64_tr_b16 v[78:79], v9 offset:9216
v_accvgpr_read_b32 v21, a30
v_mfma_f32_16x16x32_bf16 v[236:239], v[80:83], v[56:59], v[236:239]
v_accvgpr_read_b32 v29, a31
v_accvgpr_read_b32 v22, a60
v_mfma_f32_16x16x32_bf16 v[252:255], v[88:91], v[56:59], v[252:255]
s_add_u32 s72, s70, 15360
buffer_load_dwordx4 v5, s[4:7], s72 offen offset:1024 lds
v_mfma_f32_16x16x32_bf16 v[252:255], v[92:95], v[60:63], v[252:255]
ds_read_b64_tr_b16 v[80:81], v10 offset:0
v_accvgpr_read_b32 v30, a61
v_mfma_f32_16x16x32_bf16 v[248:251], v[92:95], v[52:55], v[248:251]
ds_read_b64_tr_b16 v[82:83], v10 offset:1024
v_accvgpr_read_b32 v23, a62
v_mfma_f32_16x16x32_bf16 v[248:251], v[88:91], v[48:51], v[248:251]
v_accvgpr_read_b32 v31, a63
v_mul_f32 v20, s79, v20
v_mfma_f32_16x16x32_bf16 v[244:247], v[88:91], v[40:43], v[244:247]
ds_read_b64_tr_b16 v[84:85], v10 offset:8192
v_mul_f32 v28, s79, v28
v_mfma_f32_16x16x32_bf16 v[244:247], v[92:95], v[44:47], v[244:247]
ds_read_b64_tr_b16 v[86:87], v10 offset:9216
v_mul_f32 v21, s79, v21
v_mfma_f32_16x16x32_bf16 v[240:243], v[92:95], v[36:39], v[240:243]
s_add_u32 s72, s70, 129024
buffer_load_dwordx4 v4, s[4:7], s72 offen offset:2048 lds
v_mfma_f32_16x16x32_bf16 v[240:243], v[88:91], v[32:35], v[240:243]
s_waitcnt lgkmcnt(5)
v_mul_f32 v29, s79, v29
v_mul_f32 v22, s79, v22
v_mfma_f32_16x16x32_bf16 v[128:131], v[64:67], v[96:99], v[128:131]
ds_read_b64_tr_b16 v[88:89], v11 offset:0
v_mul_f32 v30, s79, v30
v_mfma_f32_16x16x32_bf16 v[128:131], v[68:71], v[100:103], v[128:131]
ds_read_b64_tr_b16 v[90:91], v11 offset:1024
v_mul_f32 v23, s79, v23
v_mfma_f32_16x16x32_bf16 v[132:135], v[68:71], v[108:111], v[132:135]
v_mul_f32 v31, s79, v31
v_cvt_pk_bf16_f32 v20, v20, v28
v_mfma_f32_16x16x32_bf16 v[132:135], v[64:67], v[104:107], v[132:135]
s_add_u32 s72, s70, 144384
buffer_load_dwordx4 v5, s[4:7], s72 offen offset:3072 lds
v_mfma_f32_16x16x32_bf16 v[136:139], v[64:67], v[112:115], v[136:139]
ds_read_b64_tr_b16 v[92:93], v11 offset:8192
v_cvt_pk_bf16_f32 v21, v21, v29
v_mfma_f32_16x16x32_bf16 v[136:139], v[68:71], v[116:119], v[136:139]
s_lshl_b32 s71, s73, 12
v_cvt_pk_bf16_f32 v22, v22, v30
v_cvt_pk_bf16_f32 v23, v23, v31
v_mfma_f32_16x16x32_bf16 v[140:143], v[68:71], v[124:127], v[140:143]
s_add_u32 s71, s71, s66
ds_read_b64_tr_b16 v[94:95], v11 offset:9216
v_mfma_f32_16x16x32_bf16 v[140:143], v[64:67], v[120:123], v[140:143]
s_waitcnt lgkmcnt(8)
v_mfma_f32_16x16x32_bf16 v[156:159], v[72:75], v[120:123], v[156:159]
s_add_u32 m0, s64, 32768
ds_read_b64_tr_b16 v[64:65], v12 offset:0
v_mfma_f32_16x16x32_bf16 v[156:159], v[76:79], v[124:127], v[156:159]
s_add_u32 s72, s71, 0
buffer_load_dwordx4 v6, s[12:15], s72 offen lds
v_mfma_f32_16x16x32_bf16 v[152:155], v[76:79], v[116:119], v[152:155]
s_add_u32 s73, s62, 6
ds_read_b64_tr_b16 v[66:67], v12 offset:1024
v_accvgpr_read_b32 v24, a168
v_mfma_f32_16x16x32_bf16 v[152:155], v[72:75], v[112:115], v[152:155]
s_add_u32 s70, s73, s65
v_accvgpr_read_b32 v28, a169
v_accvgpr_read_b32 v25, a170
v_mfma_f32_16x16x32_bf16 v[148:151], v[72:75], v[104:107], v[148:151]
s_and_b32 s70, s70, 3
ds_read_b64_tr_b16 v[68:69], v12 offset:8192
v_accvgpr_read_b32 v29, a171
v_mfma_f32_16x16x32_bf16 v[148:151], v[76:79], v[108:111], v[148:151]
s_and_b32 s73, s73, 12
ds_read_b64_tr_b16 v[70:71], v12 offset:9216
v_accvgpr_read_b32 v26, a172
v_mfma_f32_16x16x32_bf16 v[144:147], v[76:79], v[100:103], v[144:147]
s_add_u32 s72, s71, 31744
buffer_load_dwordx4 v6, s[12:15], s72 offen offset:1024 lds
v_mfma_f32_16x16x32_bf16 v[144:147], v[72:75], v[96:99], v[144:147]
s_waitcnt lgkmcnt(8)
v_accvgpr_read_b32 v30, a173
v_accvgpr_read_b32 v27, a174
v_mfma_f32_16x16x32_bf16 v[160:163], v[80:83], v[96:99], v[160:163]
s_or_b32 s73, s73, s70
ds_read_b64_tr_b16 v[72:73], v13 offset:0
v_accvgpr_read_b32 v31, a175
v_mfma_f32_16x16x32_bf16 v[160:163], v[84:87], v[100:103], v[160:163]
s_lshl_b32 s73, s73, 7
ds_read_b64_tr_b16 v[74:75], v13 offset:1024
v_cvt_pk_bf16_f32 v24, v24, v28
v_mfma_f32_16x16x32_bf16 v[164:167], v[84:87], v[108:111], v[164:167]
s_add_u32 s69, s73, s67
v_cvt_pk_bf16_f32 v25, v25, v29
v_cvt_pk_bf16_f32 v26, v26, v30
v_mfma_f32_16x16x32_bf16 v[164:167], v[80:83], v[104:107], v[164:167]
s_add_u32 s72, s71, 63488
buffer_load_dwordx4 v7, s[12:15], s72 offen offset:2048 lds
v_mfma_f32_16x16x32_bf16 v[168:171], v[80:83], v[112:115], v[168:171]
s_waitcnt vmcnt(17)
ds_read_b64_tr_b16 v[76:77], v13 offset:8192
v_cvt_pk_bf16_f32 v27, v27, v31
v_mfma_f32_16x16x32_bf16 v[168:171], v[84:87], v[116:119], v[168:171]
s_add_u32 s70, s73, s68
ds_read_b128 v[32:35], v18 offset:0
v_mfma_f32_16x16x32_bf16 v[172:175], v[84:87], v[124:127], v[172:175]
s_add_u32 s80, s77, 45056
ds_read_b64_tr_b16 v[78:79], v13 offset:9216
v_mfma_f32_16x16x32_bf16 v[172:175], v[80:83], v[120:123], v[172:175]
s_waitcnt lgkmcnt(9)
ds_read_b128 v[36:39], v19 offset:0
v_mfma_f32_16x16x32_bf16 v[188:191], v[88:91], v[120:123], v[188:191]
s_add_u32 s72, s71, 95232
buffer_load_dwordx4 v7, s[12:15], s72 offen offset:3072 lds
v_mfma_f32_16x16x32_bf16 v[188:191], v[92:95], v[124:127], v[188:191]
ds_read_b64_tr_b16 v[80:81], v14 offset:0
v_mfma_f32_16x16x32_bf16 v[184:187], v[92:95], v[116:119], v[184:187]
ds_read_b64_tr_b16 v[82:83], v14 offset:1024
v_mfma_f32_16x16x32_bf16 v[184:187], v[88:91], v[112:115], v[184:187]
buffer_store_dwordx4 v[20:23], v1, s[44:47], s80 offen sc1
v_mfma_f32_16x16x32_bf16 v[180:183], v[88:91], v[104:107], v[180:183]
s_add_u32 s80, s78, 9216
ds_read_b64_tr_b16 v[84:85], v14 offset:8192
v_mfma_f32_16x16x32_bf16 v[180:183], v[92:95], v[108:111], v[180:183]
s_add_u32 m0, s63, 131072
ds_read_b64_tr_b16 v[86:87], v14 offset:9216
v_mfma_f32_16x16x32_bf16 v[176:179], v[92:95], v[100:103], v[176:179]
s_add_u32 s72, s69, 0
buffer_load_dwordx4 v4, s[4:7], s72 offen lds
v_mfma_f32_16x16x32_bf16 v[176:179], v[88:91], v[96:99], v[176:179]
s_waitcnt lgkmcnt(10)
ds_read_b128 v[40:43], v18 offset:2048
v_accvgpr_read_b32 v20, a64
v_mfma_f32_16x16x32_bf16 v[192:195], v[64:67], v[96:99], v[192:195]
ds_read_b64_tr_b16 v[88:89], v15 offset:0
v_accvgpr_read_b32 v28, a65
v_mfma_f32_16x16x32_bf16 v[192:195], v[68:71], v[100:103], v[192:195]
ds_read_b64_tr_b16 v[90:91], v15 offset:1024
v_accvgpr_read_b32 v21, a66
v_mfma_f32_16x16x32_bf16 v[196:199], v[68:71], v[108:111], v[196:199]
ds_read_b64_tr_b16 v[92:93], v15 offset:8192
v_accvgpr_read_b32 v29, a67
v_mfma_f32_16x16x32_bf16 v[196:199], v[64:67], v[104:107], v[196:199]
s_add_u32 s72, s69, 15360
buffer_load_dwordx4 v5, s[4:7], s72 offen offset:1024 lds
v_mfma_f32_16x16x32_bf16 v[200:203], v[64:67], v[112:115], v[200:203]
ds_read_b64_tr_b16 v[94:95], v15 offset:9216
v_accvgpr_read_b32 v22, a96
v_mfma_f32_16x16x32_bf16 v[200:203], v[68:71], v[116:119], v[200:203]
ds_read_b128 v[44:47], v19 offset:2048
v_accvgpr_read_b32 v30, a97
v_mfma_f32_16x16x32_bf16 v[204:207], v[68:71], v[124:127], v[204:207]
buffer_store_dwordx4 v[24:27], v1, s[44:47], s80 offen sc1
v_mfma_f32_16x16x32_bf16 v[204:207], v[64:67], v[120:123], v[204:207]
s_waitcnt lgkmcnt(11)
ds_read_b128 v[48:51], v18 offset:4096
v_accvgpr_read_b32 v23, a98
v_mfma_f32_16x16x32_bf16 v[220:223], v[72:75], v[120:123], v[220:223]
s_add_u32 s72, s69, 129024
buffer_load_dwordx4 v4, s[4:7], s72 offen offset:2048 lds
v_mfma_f32_16x16x32_bf16 v[220:223], v[76:79], v[124:127], v[220:223]
v_accvgpr_read_b32 v31, a99
v_mul_f32 v20, s79, v20
v_mfma_f32_16x16x32_bf16 v[216:219], v[76:79], v[116:119], v[216:219]
s_waitcnt vmcnt(19) lgkmcnt(2)
ds_read_b128 v[52:55], v19 offset:4096
v_mul_f32 v28, s79, v28
v_mfma_f32_16x16x32_bf16 v[216:219], v[72:75], v[112:115], v[216:219]
s_barrier
ds_read_b128 v[56:59], v18 offset:6144
v_mul_f32 v21, s79, v21
v_mfma_f32_16x16x32_bf16 v[212:215], v[72:75], v[104:107], v[212:215]
ds_read_b64_tr_b16 v[64:65], v8 offset:16384
ds_read_b64_tr_b16 v[66:67], v8 offset:17408
v_mfma_f32_16x16x32_bf16 v[212:215], v[76:79], v[108:111], v[212:215]
ds_read_b64_tr_b16 v[68:69], v8 offset:24576
v_mul_f32 v29, s79, v29
v_mfma_f32_16x16x32_bf16 v[208:211], v[76:79], v[100:103], v[208:211]
s_add_u32 s72, s69, 144384
buffer_load_dwordx4 v5, s[4:7], s72 offen offset:3072 lds
v_mfma_f32_16x16x32_bf16 v[208:211], v[72:75], v[96:99], v[208:211]
ds_read_b64_tr_b16 v[70:71], v8 offset:25600
v_mul_f32 v22, s79, v22
v_mfma_f32_16x16x32_bf16 v[224:227], v[80:83], v[96:99], v[224:227]
ds_read_b64_tr_b16 v[72:73], v9 offset:16384
v_mul_f32 v30, s79, v30
v_mfma_f32_16x16x32_bf16 v[224:227], v[84:87], v[100:103], v[224:227]
ds_read_b64_tr_b16 v[74:75], v9 offset:17408
v_mul_f32 v23, s79, v23
v_mfma_f32_16x16x32_bf16 v[228:231], v[84:87], v[108:111], v[228:231]
s_add_u32 m0, s63, 135168
v_mul_f32 v31, s79, v31
v_cvt_pk_bf16_f32 v20, v20, v28
v_mfma_f32_16x16x32_bf16 v[228:231], v[80:83], v[104:107], v[228:231]
s_add_u32 s72, s70, 0
buffer_load_dwordx4 v4, s[4:7], s72 offen lds
v_mfma_f32_16x16x32_bf16 v[232:235], v[80:83], v[112:115], v[232:235]
ds_read_b64_tr_b16 v[76:77], v9 offset:24576
v_cvt_pk_bf16_f32 v21, v21, v29
v_mfma_f32_16x16x32_bf16 v[232:235], v[84:87], v[116:119], v[232:235]
ds_read_b128 v[60:63], v19 offset:6144
v_cvt_pk_bf16_f32 v22, v22, v30
v_mfma_f32_16x16x32_bf16 v[236:239], v[84:87], v[124:127], v[236:239]
ds_read_b64_tr_b16 v[78:79], v9 offset:25600
v_cvt_pk_bf16_f32 v23, v23, v31
v_mfma_f32_16x16x32_bf16 v[236:239], v[80:83], v[120:123], v[236:239]
s_add_u32 s80, s77, 1024
buffer_store_dwordx4 v[20:23], v1, s[44:47], s80 offen sc1
v_mfma_f32_16x16x32_bf16 v[252:255], v[88:91], v[120:123], v[252:255]
s_add_u32 s72, s70, 15360
buffer_load_dwordx4 v5, s[4:7], s72 offen offset:1024 lds
v_mfma_f32_16x16x32_bf16 v[252:255], v[92:95], v[124:127], v[252:255]
ds_read_b64_tr_b16 v[80:81], v10 offset:16384
v_accvgpr_read_b32 v24, a176
v_mfma_f32_16x16x32_bf16 v[248:251], v[92:95], v[116:119], v[248:251]
ds_read_b64_tr_b16 v[82:83], v10 offset:17408
v_accvgpr_read_b32 v28, a177
v_mfma_f32_16x16x32_bf16 v[248:251], v[88:91], v[112:115], v[248:251]
v_accvgpr_read_b32 v25, a178
v_accvgpr_read_b32 v29, a179
v_mfma_f32_16x16x32_bf16 v[244:247], v[88:91], v[104:107], v[244:247]
ds_read_b64_tr_b16 v[84:85], v10 offset:24576
v_accvgpr_read_b32 v26, a180
v_mfma_f32_16x16x32_bf16 v[244:247], v[92:95], v[108:111], v[244:247]
ds_read_b64_tr_b16 v[86:87], v10 offset:25600
v_accvgpr_read_b32 v30, a181
v_mfma_f32_16x16x32_bf16 v[240:243], v[92:95], v[100:103], v[240:243]
s_add_u32 s72, s70, 129024
buffer_load_dwordx4 v4, s[4:7], s72 offen offset:2048 lds
v_mfma_f32_16x16x32_bf16 v[240:243], v[88:91], v[96:99], v[240:243]
s_waitcnt lgkmcnt(5)
v_accvgpr_read_b32 v27, a182
v_accvgpr_read_b32 v31, a183
v_mfma_f32_16x16x32_bf16 v[128:131], v[64:67], v[32:35], v[128:131]
ds_read_b64_tr_b16 v[88:89], v11 offset:16384
v_cvt_pk_bf16_f32 v24, v24, v28
v_mfma_f32_16x16x32_bf16 v[128:131], v[68:71], v[36:39], v[128:131]
ds_read_b64_tr_b16 v[90:91], v11 offset:17408
v_cvt_pk_bf16_f32 v25, v25, v29
v_mfma_f32_16x16x32_bf16 v[132:135], v[68:71], v[44:47], v[132:135]
v_cvt_pk_bf16_f32 v26, v26, v30
v_cvt_pk_bf16_f32 v27, v27, v31
v_mfma_f32_16x16x32_bf16 v[132:135], v[64:67], v[40:43], v[132:135]
s_add_u32 s72, s70, 144384
buffer_load_dwordx4 v5, s[4:7], s72 offen offset:3072 lds
v_mfma_f32_16x16x32_bf16 v[136:139], v[64:67], v[48:51], v[136:139]
s_add_u32 s80, s78, 33792
ds_read_b64_tr_b16 v[92:93], v11 offset:24576
v_mfma_f32_16x16x32_bf16 v[136:139], v[68:71], v[52:55], v[136:139]
s_lshl_b32 s71, s73, 12
buffer_store_dwordx4 v[24:27], v1, s[44:47], s80 offen sc1
v_mfma_f32_16x16x32_bf16 v[140:143], v[68:71], v[60:63], v[140:143]
s_add_u32 s71, s71, s66
ds_read_b64_tr_b16 v[94:95], v11 offset:25600
v_mfma_f32_16x16x32_bf16 v[140:143], v[64:67], v[56:59], v[140:143]
s_waitcnt lgkmcnt(8)
v_mfma_f32_16x16x32_bf16 v[156:159], v[72:75], v[56:59], v[156:159]
s_add_u32 m0, s64, 0
ds_read_b64_tr_b16 v[64:65], v12 offset:16384
v_mfma_f32_16x16x32_bf16 v[156:159], v[76:79], v[60:63], v[156:159]
s_add_u32 s72, s71, 0
buffer_load_dwordx4 v6, s[12:15], s72 offen lds
v_mfma_f32_16x16x32_bf16 v[152:155], v[76:79], v[52:55], v[152:155]
s_add_u32 s73, s62, 7
ds_read_b64_tr_b16 v[66:67], v12 offset:17408
v_mfma_f32_16x16x32_bf16 v[152:155], v[72:75], v[48:51], v[152:155]
s_add_u32 s70, s73, s65
v_mfma_f32_16x16x32_bf16 v[148:151], v[72:75], v[40:43], v[148:151]
s_and_b32 s70, s70, 3
ds_read_b64_tr_b16 v[68:69], v12 offset:24576
v_accvgpr_read_b32 v20, a68
v_mfma_f32_16x16x32_bf16 v[148:151], v[76:79], v[44:47], v[148:151]
s_and_b32 s73, s73, 12
ds_read_b64_tr_b16 v[70:71], v12 offset:25600
v_accvgpr_read_b32 v28, a69
v_mfma_f32_16x16x32_bf16 v[144:147], v[76:79], v[36:39], v[144:147]
s_add_u32 s72, s71, 31744
buffer_load_dwordx4 v6, s[12:15], s72 offen offset:1024 lds
v_mfma_f32_16x16x32_bf16 v[144:147], v[72:75], v[32:35], v[144:147]
s_waitcnt lgkmcnt(8)
v_accvgpr_read_b32 v21, a70
v_accvgpr_read_b32 v29, a71
v_mfma_f32_16x16x32_bf16 v[160:163], v[80:83], v[32:35], v[160:163]
s_or_b32 s73, s73, s70
ds_read_b64_tr_b16 v[72:73], v13 offset:16384
v_accvgpr_read_b32 v22, a100
v_mfma_f32_16x16x32_bf16 v[160:163], v[84:87], v[36:39], v[160:163]
s_lshl_b32 s73, s73, 7
ds_read_b64_tr_b16 v[74:75], v13 offset:17408
v_accvgpr_read_b32 v30, a101
v_mfma_f32_16x16x32_bf16 v[164:167], v[84:87], v[44:47], v[164:167]
s_add_u32 s69, s73, s67
v_accvgpr_read_b32 v23, a102
v_accvgpr_read_b32 v31, a103
v_mfma_f32_16x16x32_bf16 v[164:167], v[80:83], v[40:43], v[164:167]
s_add_u32 s72, s71, 63488
buffer_load_dwordx4 v7, s[12:15], s72 offen offset:2048 lds
v_mfma_f32_16x16x32_bf16 v[168:171], v[80:83], v[48:51], v[168:171]
s_waitcnt vmcnt(19)
ds_read_b64_tr_b16 v[76:77], v13 offset:24576
v_mul_f32 v20, s79, v20
v_mfma_f32_16x16x32_bf16 v[168:171], v[84:87], v[52:55], v[168:171]
s_add_u32 s70, s73, s68
ds_read_b128 v[96:99], v18 offset:32768
v_mul_f32 v28, s79, v28
v_mfma_f32_16x16x32_bf16 v[172:175], v[84:87], v[60:63], v[172:175]
ds_read_b64_tr_b16 v[78:79], v13 offset:25600
v_mul_f32 v21, s79, v21
v_mfma_f32_16x16x32_bf16 v[172:175], v[80:83], v[56:59], v[172:175]
s_waitcnt lgkmcnt(9)
ds_read_b128 v[100:103], v19 offset:32768
v_mul_f32 v29, s79, v29
v_mfma_f32_16x16x32_bf16 v[188:191], v[88:91], v[56:59], v[188:191]
s_add_u32 s72, s71, 95232
buffer_load_dwordx4 v7, s[12:15], s72 offen offset:3072 lds
v_mfma_f32_16x16x32_bf16 v[188:191], v[92:95], v[60:63], v[188:191]
ds_read_b64_tr_b16 v[80:81], v14 offset:16384
v_mul_f32 v22, s79, v22
v_mfma_f32_16x16x32_bf16 v[184:187], v[92:95], v[52:55], v[184:187]
ds_read_b64_tr_b16 v[82:83], v14 offset:17408
v_mul_f32 v30, s79, v30
v_mfma_f32_16x16x32_bf16 v[184:187], v[88:91], v[48:51], v[184:187]
v_mul_f32 v23, s79, v23
v_mul_f32 v31, s79, v31
v_mfma_f32_16x16x32_bf16 v[180:183], v[88:91], v[40:43], v[180:183]
ds_read_b64_tr_b16 v[84:85], v14 offset:24576
v_cvt_pk_bf16_f32 v20, v20, v28
v_mfma_f32_16x16x32_bf16 v[180:183], v[92:95], v[44:47], v[180:183]
s_add_u32 m0, s63, 65536
ds_read_b64_tr_b16 v[86:87], v14 offset:25600
v_cvt_pk_bf16_f32 v21, v21, v29
v_mfma_f32_16x16x32_bf16 v[176:179], v[92:95], v[36:39], v[176:179]
s_add_u32 s72, s69, 0
buffer_load_dwordx4 v4, s[4:7], s72 offen lds
v_mfma_f32_16x16x32_bf16 v[176:179], v[88:91], v[32:35], v[176:179]
s_waitcnt lgkmcnt(10)
ds_read_b128 v[104:107], v18 offset:34816
v_cvt_pk_bf16_f32 v22, v22, v30
v_mfma_f32_16x16x32_bf16 v[192:195], v[64:67], v[32:35], v[192:195]
ds_read_b64_tr_b16 v[88:89], v15 offset:16384
v_cvt_pk_bf16_f32 v23, v23, v31
v_mfma_f32_16x16x32_bf16 v[192:195], v[68:71], v[36:39], v[192:195]
s_add_u32 s80, s77, 5120
ds_read_b64_tr_b16 v[90:91], v15 offset:17408
v_mfma_f32_16x16x32_bf16 v[196:199], v[68:71], v[44:47], v[196:199]
ds_read_b64_tr_b16 v[92:93], v15 offset:24576
v_accvgpr_read_b32 v24, a184
v_mfma_f32_16x16x32_bf16 v[196:199], v[64:67], v[40:43], v[196:199]
s_add_u32 s72, s69, 15360
buffer_load_dwordx4 v5, s[4:7], s72 offen offset:1024 lds
v_mfma_f32_16x16x32_bf16 v[200:203], v[64:67], v[48:51], v[200:203]
ds_read_b64_tr_b16 v[94:95], v15 offset:25600
v_accvgpr_read_b32 v28, a185
v_mfma_f32_16x16x32_bf16 v[200:203], v[68:71], v[52:55], v[200:203]
ds_read_b128 v[108:111], v19 offset:34816
v_accvgpr_read_b32 v25, a186
v_mfma_f32_16x16x32_bf16 v[204:207], v[68:71], v[60:63], v[204:207]
buffer_store_dwordx4 v[20:23], v1, s[44:47], s80 offen sc1
v_mfma_f32_16x16x32_bf16 v[204:207], v[64:67], v[56:59], v[204:207]
s_waitcnt lgkmcnt(11)
ds_read_b128 v[112:115], v18 offset:36864
v_accvgpr_read_b32 v29, a187
v_mfma_f32_16x16x32_bf16 v[220:223], v[72:75], v[56:59], v[220:223]
s_add_u32 s72, s69, 129024
buffer_load_dwordx4 v4, s[4:7], s72 offen offset:2048 lds
v_mfma_f32_16x16x32_bf16 v[220:223], v[76:79], v[60:63], v[220:223]
v_accvgpr_read_b32 v26, a188
v_accvgpr_read_b32 v30, a189
v_mfma_f32_16x16x32_bf16 v[216:219], v[76:79], v[52:55], v[216:219]
s_waitcnt vmcnt(20) lgkmcnt(2)
ds_read_b128 v[116:119], v19 offset:36864
v_accvgpr_read_b32 v27, a190
v_mfma_f32_16x16x32_bf16 v[216:219], v[72:75], v[48:51], v[216:219]
s_barrier
ds_read_b128 v[120:123], v18 offset:38912
v_accvgpr_read_b32 v31, a191
v_mfma_f32_16x16x32_bf16 v[212:215], v[72:75], v[40:43], v[212:215]
ds_read_b64_tr_b16 v[64:65], v8 offset:32768
ds_read_b64_tr_b16 v[66:67], v8 offset:33792
v_mfma_f32_16x16x32_bf16 v[212:215], v[76:79], v[44:47], v[212:215]
ds_read_b64_tr_b16 v[68:69], v8 offset:40960
v_cvt_pk_bf16_f32 v24, v24, v28
v_mfma_f32_16x16x32_bf16 v[208:211], v[76:79], v[36:39], v[208:211]
s_add_u32 s72, s69, 144384
buffer_load_dwordx4 v5, s[4:7], s72 offen offset:3072 lds
v_mfma_f32_16x16x32_bf16 v[208:211], v[72:75], v[32:35], v[208:211]
ds_read_b64_tr_b16 v[70:71], v8 offset:41984
v_cvt_pk_bf16_f32 v25, v25, v29
v_mfma_f32_16x16x32_bf16 v[224:227], v[80:83], v[32:35], v[224:227]
ds_read_b64_tr_b16 v[72:73], v9 offset:32768
v_cvt_pk_bf16_f32 v26, v26, v30
v_mfma_f32_16x16x32_bf16 v[224:227], v[84:87], v[36:39], v[224:227]
ds_read_b64_tr_b16 v[74:75], v9 offset:33792
v_cvt_pk_bf16_f32 v27, v27, v31
v_mfma_f32_16x16x32_bf16 v[228:231], v[84:87], v[44:47], v[228:231]
s_add_u32 m0, s63, 69632
v_mfma_f32_16x16x32_bf16 v[228:231], v[80:83], v[40:43], v[228:231]
s_add_u32 s72, s70, 0
buffer_load_dwordx4 v4, s[4:7], s72 offen lds
v_mfma_f32_16x16x32_bf16 v[232:235], v[80:83], v[48:51], v[232:235]
s_add_u32 s80, s78, 41984
ds_read_b64_tr_b16 v[76:77], v9 offset:40960
v_mfma_f32_16x16x32_bf16 v[232:235], v[84:87], v[52:55], v[232:235]
ds_read_b128 v[124:127], v19 offset:38912
v_mfma_f32_16x16x32_bf16 v[236:239], v[84:87], v[60:63], v[236:239]
ds_read_b64_tr_b16 v[78:79], v9 offset:41984
v_mfma_f32_16x16x32_bf16 v[236:239], v[80:83], v[56:59], v[236:239]
buffer_store_dwordx4 v[24:27], v1, s[44:47], s80 offen sc1
v_mfma_f32_16x16x32_bf16 v[252:255], v[88:91], v[56:59], v[252:255]
s_add_u32 s72, s70, 15360
buffer_load_dwordx4 v5, s[4:7], s72 offen offset:1024 lds
v_mfma_f32_16x16x32_bf16 v[252:255], v[92:95], v[60:63], v[252:255]
ds_read_b64_tr_b16 v[80:81], v10 offset:32768
v_accvgpr_read_b32 v20, a72
v_mfma_f32_16x16x32_bf16 v[248:251], v[92:95], v[52:55], v[248:251]
ds_read_b64_tr_b16 v[82:83], v10 offset:33792
v_accvgpr_read_b32 v28, a73
v_mfma_f32_16x16x32_bf16 v[248:251], v[88:91], v[48:51], v[248:251]
v_accvgpr_read_b32 v21, a74
v_accvgpr_read_b32 v29, a75
v_mfma_f32_16x16x32_bf16 v[244:247], v[88:91], v[40:43], v[244:247]
ds_read_b64_tr_b16 v[84:85], v10 offset:40960
v_accvgpr_read_b32 v22, a104
v_mfma_f32_16x16x32_bf16 v[244:247], v[92:95], v[44:47], v[244:247]
ds_read_b64_tr_b16 v[86:87], v10 offset:41984
v_accvgpr_read_b32 v30, a105
v_mfma_f32_16x16x32_bf16 v[240:243], v[92:95], v[36:39], v[240:243]
s_add_u32 s72, s70, 129024
buffer_load_dwordx4 v4, s[4:7], s72 offen offset:2048 lds
v_mfma_f32_16x16x32_bf16 v[240:243], v[88:91], v[32:35], v[240:243]
s_waitcnt lgkmcnt(5)
v_accvgpr_read_b32 v23, a106
v_accvgpr_read_b32 v31, a107
v_mfma_f32_16x16x32_bf16 v[128:131], v[64:67], v[96:99], v[128:131]
s_lshr_b32 s75, s93, 4
ds_read_b64_tr_b16 v[88:89], v11 offset:32768
v_mul_f32 v20, s79, v20
v_mfma_f32_16x16x32_bf16 v[128:131], v[68:71], v[100:103], v[128:131]
s_and_b32 s75, s75, 0x7f00
ds_read_b64_tr_b16 v[90:91], v11 offset:33792
v_mul_f32 v28, s79, v28
v_mfma_f32_16x16x32_bf16 v[132:135], v[68:71], v[108:111], v[132:135]
s_add_u32 s75, s75, LcB1-Lpc0
v_lshrrev_b32 v2, 5, v0
v_lshlrev_b32 v2, 7, v2
v_mfma_f32_16x16x32_bf16 v[132:135], v[64:67], v[104:107], v[132:135]
s_add_u32 s72, s70, 144384
buffer_load_dwordx4 v5, s[4:7], s72 offen offset:3072 lds
v_mfma_f32_16x16x32_bf16 v[136:139], v[64:67], v[112:115], v[136:139]
v_add_u32 v2, s75, v2
v_min_u32 v2, Lcode_end-Lpc0, v2
v_mfma_f32_16x16x32_bf16 v[136:139], v[68:71], v[116:119], v[136:139]
s_lshl_b32 s71, s73, 12
global_load_dword v3, v2, s[98:99]
v_mfma_f32_16x16x32_bf16 v[140:143], v[68:71], v[124:127], v[140:143]
s_add_u32 s71, s71, s66
ds_read_b64_tr_b16 v[92:93], v11 offset:40960
v_mul_f32 v21, s79, v21
v_mfma_f32_16x16x32_bf16 v[140:143], v[64:67], v[120:123], v[140:143]
s_waitcnt lgkmcnt(7)
ds_read_b64_tr_b16 v[94:95], v11 offset:41984
v_mul_f32 v29, s79, v29
v_mfma_f32_16x16x32_bf16 v[156:159], v[72:75], v[120:123], v[156:159]
s_add_u32 m0, s64, 16384
ds_read_b64_tr_b16 v[64:65], v12 offset:32768
v_mul_f32 v22, s79, v22
v_mfma_f32_16x16x32_bf16 v[156:159], v[76:79], v[124:127], v[156:159]
s_add_u32 s72, s71, 0
buffer_load_dwordx4 v6, s[12:15], s72 offen lds
v_mfma_f32_16x16x32_bf16 v[152:155], v[76:79], v[116:119], v[152:155]
s_add_u32 s73, s62, 8
ds_read_b64_tr_b16 v[66:67], v12 offset:33792
v_mul_f32 v30, s79, v30
v_mfma_f32_16x16x32_bf16 v[152:155], v[72:75], v[112:115], v[152:155]
s_add_u32 s70, s73, s65
v_mul_f32 v23, s79, v23
v_mul_f32 v31, s79, v31
v_mfma_f32_16x16x32_bf16 v[148:151], v[72:75], v[104:107], v[148:151]
s_and_b32 s70, s70, 3
ds_read_b64_tr_b16 v[68:69], v12 offset:40960
v_cvt_pk_bf16_f32 v20, v20, v28
v_mfma_f32_16x16x32_bf16 v[148:151], v[76:79], v[108:111], v[148:151]
s_and_b32 s73, s73, 12
ds_read_b64_tr_b16 v[70:71], v12 offset:41984
v_cvt_pk_bf16_f32 v21, v21, v29
v_mfma_f32_16x16x32_bf16 v[144:147], v[76:79], v[100:103], v[144:147]
s_add_u32 s72, s71, 31744
buffer_load_dwordx4 v6, s[12:15], s72 offen offset:1024 lds
v_mfma_f32_16x16x32_bf16 v[144:147], v[72:75], v[96:99], v[144:147]
s_waitcnt lgkmcnt(8)
v_cvt_pk_bf16_f32 v22, v22, v30
v_cvt_pk_bf16_f32 v23, v23, v31
v_mfma_f32_16x16x32_bf16 v[160:163], v[80:83], v[96:99], v[160:163]
s_or_b32 s73, s73, s70
ds_read_b64_tr_b16 v[72:73], v13 offset:32768
v_accvgpr_read_b32 v24, a192
v_mfma_f32_16x16x32_bf16 v[160:163], v[84:87], v[100:103], v[160:163]
s_lshl_b32 s73, s73, 7
ds_read_b64_tr_b16 v[74:75], v13 offset:33792
v_accvgpr_read_b32 v28, a193
v_mfma_f32_16x16x32_bf16 v[164:167], v[84:87], v[108:111], v[164:167]
s_add_u32 s69, s73, s67
v_accvgpr_read_b32 v25, a194
v_accvgpr_read_b32 v29, a195
v_mfma_f32_16x16x32_bf16 v[164:167], v[80:83], v[104:107], v[164:167]
s_add_u32 s72, s71, 63488
buffer_load_dwordx4 v7, s[12:15], s72 offen offset:2048 lds
v_mfma_f32_16x16x32_bf16 v[168:171], v[80:83], v[112:115], v[168:171]
s_waitcnt vmcnt(19)
ds_read_b64_tr_b16 v[76:77], v13 offset:40960
v_accvgpr_read_b32 v26, a196
v_mfma_f32_16x16x32_bf16 v[168:171], v[84:87], v[116:119], v[168:171]
s_add_u32 s70, s73, s68
ds_read_b128 v[32:35], v16 offset:0
v_accvgpr_read_b32 v30, a197
v_mfma_f32_16x16x32_bf16 v[172:175], v[84:87], v[124:127], v[172:175]
s_add_u32 s80, s77, 9216
ds_read_b64_tr_b16 v[78:79], v13 offset:41984
v_accvgpr_read_b32 v27, a198
v_mfma_f32_16x16x32_bf16 v[172:175], v[80:83], v[120:123], v[172:175]
s_waitcnt lgkmcnt(9)
ds_read_b128 v[36:39], v17 offset:0
v_accvgpr_read_b32 v31, a199
v_mfma_f32_16x16x32_bf16 v[188:191], v[88:91], v[120:123], v[188:191]
s_add_u32 s72, s71, 95232
buffer_load_dwordx4 v7, s[12:15], s72 offen offset:3072 lds
v_mfma_f32_16x16x32_bf16 v[188:191], v[92:95], v[124:127], v[188:191]
ds_read_b64_tr_b16 v[80:81], v14 offset:32768
v_cvt_pk_bf16_f32 v24, v24, v28
v_mfma_f32_16x16x32_bf16 v[184:187], v[92:95], v[116:119], v[184:187]
ds_read_b64_tr_b16 v[82:83], v14 offset:33792
v_cvt_pk_bf16_f32 v25, v25, v29
v_mfma_f32_16x16x32_bf16 v[184:187], v[88:91], v[112:115], v[184:187]
buffer_store_dwordx4 v[20:23], v1, s[44:47], s80 offen sc1
v_mfma_f32_16x16x32_bf16 v[180:183], v[88:91], v[104:107], v[180:183]
ds_read_b64_tr_b16 v[84:85], v14 offset:40960
v_cvt_pk_bf16_f32 v26, v26, v30
v_mfma_f32_16x16x32_bf16 v[180:183], v[92:95], v[108:111], v[180:183]
s_add_u32 m0, s63, 98304
ds_read_b64_tr_b16 v[86:87], v14 offset:41984
v_cvt_pk_bf16_f32 v27, v27, v31
v_mfma_f32_16x16x32_bf16 v[176:179], v[92:95], v[100:103], v[176:179]
s_add_u32 s72, s69, 0
buffer_load_dwordx4 v4, s[4:7], s72 offen lds
v_mfma_f32_16x16x32_bf16 v[176:179], v[88:91], v[96:99], v[176:179]
s_waitcnt lgkmcnt(10)
ds_read_b128 v[40:43], v16 offset:2048
v_mfma_f32_16x16x32_bf16 v[192:195], v[64:67], v[96:99], v[192:195]
s_add_u32 s80, s78, 2048
ds_read_b64_tr_b16 v[88:89], v15 offset:32768
v_mfma_f32_16x16x32_bf16 v[192:195], v[68:71], v[100:103], v[192:195]
ds_read_b64_tr_b16 v[90:91], v15 offset:33792
v_mfma_f32_16x16x32_bf16 v[196:199], v[68:71], v[108:111], v[196:199]
ds_read_b64_tr_b16 v[92:93], v15 offset:40960
v_mfma_f32_16x16x32_bf16 v[196:199], v[64:67], v[104:107], v[196:199]
s_add_u32 s72, s69, 15360
buffer_load_dwordx4 v5, s[4:7], s72 offen offset:1024 lds
v_mfma_f32_16x16x32_bf16 v[200:203], v[64:67], v[112:115], v[200:203]
ds_read_b64_tr_b16 v[94:95], v15 offset:41984
v_accvgpr_read_b32 v20, a76
v_mfma_f32_16x16x32_bf16 v[200:203], v[68:71], v[116:119], v[200:203]
ds_read_b128 v[44:47], v17 offset:2048
v_accvgpr_read_b32 v28, a77
v_mfma_f32_16x16x32_bf16 v[204:207], v[68:71], v[124:127], v[204:207]
buffer_store_dwordx4 v[24:27], v1, s[44:47], s80 offen sc1
v_mfma_f32_16x16x32_bf16 v[204:207], v[64:67], v[120:123], v[204:207]
s_waitcnt lgkmcnt(11)
ds_read_b128 v[48:51], v16 offset:4096
v_accvgpr_read_b32 v21, a78
v_mfma_f32_16x16x32_bf16 v[220:223], v[72:75], v[120:123], v[220:223]
s_add_u32 s72, s69, 129024
buffer_load_dwordx4 v4, s[4:7], s72 offen offset:2048 lds
v_mfma_f32_16x16x32_bf16 v[220:223], v[76:79], v[124:127], v[220:223]
v_accvgpr_read_b32 v29, a79
v_accvgpr_read_b32 v22, a108
v_mfma_f32_16x16x32_bf16 v[216:219], v[76:79], v[116:119], v[216:219]
s_waitcnt vmcnt(20) lgkmcnt(2)
ds_read_b128 v[52:55], v17 offset:4096
v_accvgpr_read_b32 v30, a109
v_mfma_f32_16x16x32_bf16 v[216:219], v[72:75], v[112:115], v[216:219]
s_barrier
ds_read_b128 v[56:59], v16 offset:6144
v_accvgpr_read_b32 v23, a110
v_mfma_f32_16x16x32_bf16 v[212:215], v[72:75], v[104:107], v[212:215]
ds_read_b64_tr_b16 v[64:65], v8 offset:0
ds_read_b64_tr_b16 v[66:67], v8 offset:1024
v_mfma_f32_16x16x32_bf16 v[212:215], v[76:79], v[108:111], v[212:215]
ds_read_b64_tr_b16 v[68:69], v8 offset:8192
v_accvgpr_read_b32 v31, a111
v_mfma_f32_16x16x32_bf16 v[208:211], v[76:79], v[100:103], v[208:211]
s_add_u32 s72, s69, 144384
buffer_load_dwordx4 v5, s[4:7], s72 offen offset:3072 lds
v_mfma_f32_16x16x32_bf16 v[208:211], v[72:75], v[96:99], v[208:211]
ds_read_b64_tr_b16 v[70:71], v8 offset:9216
v_mul_f32 v20, s79, v20
v_mfma_f32_16x16x32_bf16 v[224:227], v[80:83], v[96:99], v[224:227]
ds_read_b64_tr_b16 v[72:73], v9 offset:0
v_mul_f32 v28, s79, v28
v_mfma_f32_16x16x32_bf16 v[224:227], v[84:87], v[100:103], v[224:227]
ds_read_b64_tr_b16 v[74:75], v9 offset:1024
v_mul_f32 v21, s79, v21
v_mfma_f32_16x16x32_bf16 v[228:231], v[84:87], v[108:111], v[228:231]
s_add_u32 m0, s63, 102400
v_mul_f32 v29, s79, v29
v_mul_f32 v22, s79, v22
v_mfma_f32_16x16x32_bf16 v[228:231], v[80:83], v[104:107], v[228:231]
s_add_u32 s72, s70, 0
buffer_load_dwordx4 v4, s[4:7], s72 offen lds
v_mfma_f32_16x16x32_bf16 v[232:235], v[80:83], v[112:115], v[232:235]
ds_read_b64_tr_b16 v[76:77], v9 offset:8192
v_mul_f32 v30, s79, v30
v_mfma_f32_16x16x32_bf16 v[232:235], v[84:87], v[116:119], v[232:235]
ds_read_b128 v[60:63], v17 offset:6144
v_mul_f32 v23, s79, v23
v_mfma_f32_16x16x32_bf16 v[236:239], v[84:87], v[124:127], v[236:239]
ds_read_b64_tr_b16 v[78:79], v9 offset:9216
v_mul_f32 v31, s79, v31
v_mfma_f32_16x16x32_bf16 v[236:239], v[80:83], v[120:123], v[236:239]
v_cvt_pk_bf16_f32 v20, v20, v28
v_cvt_pk_bf16_f32 v21, v21, v29
v_mfma_f32_16x16x32_bf16 v[252:255], v[88:91], v[120:123], v[252:255]
s_add_u32 s72, s70, 15360
buffer_load_dwordx4 v5, s[4:7], s72 offen offset:1024 lds
v_mfma_f32_16x16x32_bf16 v[252:255], v[92:95], v[124:127], v[252:255]
ds_read_b64_tr_b16 v[80:81], v10 offset:0
v_cvt_pk_bf16_f32 v22, v22, v30
v_mfma_f32_16x16x32_bf16 v[248:251], v[92:95], v[116:119], v[248:251]
ds_read_b64_tr_b16 v[82:83], v10 offset:1024
v_cvt_pk_bf16_f32 v23, v23, v31
v_mfma_f32_16x16x32_bf16 v[248:251], v[88:91], v[112:115], v[248:251]
s_add_u32 s80, s77, 13312
buffer_store_dwordx4 v[20:23], v1, s[44:47], s80 offen sc1
v_mfma_f32_16x16x32_bf16 v[244:247], v[88:91], v[104:107], v[244:247]
ds_read_b64_tr_b16 v[84:85], v10 offset:8192
v_accvgpr_read_b32 v24, a200
v_mfma_f32_16x16x32_bf16 v[244:247], v[92:95], v[108:111], v[244:247]
ds_read_b64_tr_b16 v[86:87], v10 offset:9216
v_accvgpr_read_b32 v28, a201
v_mfma_f32_16x16x32_bf16 v[240:243], v[92:95], v[100:103], v[240:243]
s_add_u32 s72, s70, 129024
buffer_load_dwordx4 v4, s[4:7], s72 offen offset:2048 lds
v_mfma_f32_16x16x32_bf16 v[240:243], v[88:91], v[96:99], v[240:243]
s_waitcnt lgkmcnt(5)
v_accvgpr_read_b32 v25, a202
v_accvgpr_read_b32 v29, a203
v_mfma_f32_16x16x32_bf16 v[128:131], v[64:67], v[32:35], v[128:131]
ds_read_b64_tr_b16 v[88:89], v11 offset:0
v_accvgpr_read_b32 v26, a204
v_mfma_f32_16x16x32_bf16 v[128:131], v[68:71], v[36:39], v[128:131]
ds_read_b64_tr_b16 v[90:91], v11 offset:1024
v_accvgpr_read_b32 v30, a205
v_mfma_f32_16x16x32_bf16 v[132:135], v[68:71], v[44:47], v[132:135]
v_accvgpr_read_b32 v27, a206
v_accvgpr_read_b32 v31, a207
v_mfma_f32_16x16x32_bf16 v[132:135], v[64:67], v[40:43], v[132:135]
s_add_u32 s72, s70, 144384
buffer_load_dwordx4 v5, s[4:7], s72 offen offset:3072 lds
v_mfma_f32_16x16x32_bf16 v[136:139], v[64:67], v[48:51], v[136:139]
ds_read_b64_tr_b16 v[92:93], v11 offset:8192
v_cvt_pk_bf16_f32 v24, v24, v28
v_mfma_f32_16x16x32_bf16 v[136:139], v[68:71], v[52:55], v[136:139]
s_lshl_b32 s71, s73, 12
v_cvt_pk_bf16_f32 v25, v25, v29
v_cvt_pk_bf16_f32 v26, v26, v30
v_mfma_f32_16x16x32_bf16 v[140:143], v[68:71], v[60:63], v[140:143]
s_add_u32 s71, s71, s66
ds_read_b64_tr_b16 v[94:95], v11 offset:9216
v_cvt_pk_bf16_f32 v27, v27, v31
v_mfma_f32_16x16x32_bf16 v[140:143], v[64:67], v[56:59], v[140:143]
s_waitcnt lgkmcnt(8)
v_mfma_f32_16x16x32_bf16 v[156:159], v[72:75], v[56:59], v[156:159]
s_add_u32 m0, s64, 32768
ds_read_b64_tr_b16 v[64:65], v12 offset:0
v_mfma_f32_16x16x32_bf16 v[156:159], v[76:79], v[60:63], v[156:159]
s_add_u32 s72, s71, 0
buffer_load_dwordx4 v6, s[12:15], s72 offen lds
v_mfma_f32_16x16x32_bf16 v[152:155], v[76:79], v[52:55], v[152:155]
s_add_u32 s73, s62, 9
ds_read_b64_tr_b16 v[66:67], v12 offset:1024
v_mfma_f32_16x16x32_bf16 v[152:155], v[72:75], v[48:51], v[152:155]
s_add_u32 s70, s73, s65
v_mfma_f32_16x16x32_bf16 v[148:151], v[72:75], v[40:43], v[148:151]
s_and_b32 s70, s70, 3
ds_read_b64_tr_b16 v[68:69], v12 offset:8192
v_mfma_f32_16x16x32_bf16 v[148:151], v[76:79], v[44:47], v[148:151]
s_and_b32 s73, s73, 12
ds_read_b64_tr_b16 v[70:71], v12 offset:9216
v_mfma_f32_16x16x32_bf16 v[144:147], v[76:79], v[36:39], v[144:147]
s_add_u32 s72, s71, 31744
buffer_load_dwordx4 v6, s[12:15], s72 offen offset:1024 lds
v_mfma_f32_16x16x32_bf16 v[144:147], v[72:75], v[32:35], v[144:147]
s_waitcnt lgkmcnt(8)
v_mfma_f32_16x16x32_bf16 v[160:163], v[80:83], v[32:35], v[160:163]
s_or_b32 s73, s73, s70
ds_read_b64_tr_b16 v[72:73], v13 offset:0
v_accvgpr_read_b32 v20, a80
v_mfma_f32_16x16x32_bf16 v[160:163], v[84:87], v[36:39], v[160:163]
s_lshl_b32 s73, s73, 7
ds_read_b64_tr_b16 v[74:75], v13 offset:1024
v_accvgpr_read_b32 v28, a81
v_mfma_f32_16x16x32_bf16 v[164:167], v[84:87], v[44:47], v[164:167]
s_add_u32 s69, s73, s67
v_accvgpr_read_b32 v21, a82
v_accvgpr_read_b32 v29, a83
v_mfma_f32_16x16x32_bf16 v[164:167], v[80:83], v[40:43], v[164:167]
s_add_u32 s72, s71, 63488
buffer_load_dwordx4 v7, s[12:15], s72 offen offset:2048 lds
v_mfma_f32_16x16x32_bf16 v[168:171], v[80:83], v[48:51], v[168:171]
s_waitcnt vmcnt(19)
ds_read_b64_tr_b16 v[76:77], v13 offset:8192
v_accvgpr_read_b32 v22, a112
v_mfma_f32_16x16x32_bf16 v[168:171], v[84:87], v[52:55], v[168:171]
s_add_u32 s70, s73, s68
ds_read_b128 v[96:99], v18 offset:0
v_accvgpr_read_b32 v30, a113
v_mfma_f32_16x16x32_bf16 v[172:175], v[84:87], v[60:63], v[172:175]
s_add_u32 s80, s78, 10240
ds_read_b64_tr_b16 v[78:79], v13 offset:9216
v_accvgpr_read_b32 v23, a114
v_mfma_f32_16x16x32_bf16 v[172:175], v[80:83], v[56:59], v[172:175]
s_waitcnt lgkmcnt(9)
ds_read_b128 v[100:103], v19 offset:0
v_accvgpr_read_b32 v31, a115
v_mfma_f32_16x16x32_bf16 v[188:191], v[88:91], v[56:59], v[188:191]
s_add_u32 s72, s71, 95232
buffer_load_dwordx4 v7, s[12:15], s72 offen offset:3072 lds
v_mfma_f32_16x16x32_bf16 v[188:191], v[92:95], v[60:63], v[188:191]
ds_read_b64_tr_b16 v[80:81], v14 offset:0
v_mul_f32 v20, s79, v20
v_mfma_f32_16x16x32_bf16 v[184:187], v[92:95], v[52:55], v[184:187]
ds_read_b64_tr_b16 v[82:83], v14 offset:1024
v_mul_f32 v28, s79, v28
v_mfma_f32_16x16x32_bf16 v[184:187], v[88:91], v[48:51], v[184:187]
buffer_store_dwordx4 v[24:27], v1, s[44:47], s80 offen sc1
v_mfma_f32_16x16x32_bf16 v[180:183], v[88:91], v[40:43], v[180:183]
ds_read_b64_tr_b16 v[84:85], v14 offset:8192
v_mul_f32 v21, s79, v21
v_mfma_f32_16x16x32_bf16 v[180:183], v[92:95], v[44:47], v[180:183]
s_add_u32 m0, s63, 131072
ds_read_b64_tr_b16 v[86:87], v14 offset:9216
v_mul_f32 v29, s79, v29
v_mfma_f32_16x16x32_bf16 v[176:179], v[92:95], v[36:39], v[176:179]
s_add_u32 s72, s69, 0
buffer_load_dwordx4 v4, s[4:7], s72 offen lds
v_mfma_f32_16x16x32_bf16 v[176:179], v[88:91], v[32:35], v[176:179]
s_waitcnt lgkmcnt(10)
ds_read_b128 v[104:107], v18 offset:2048
v_mul_f32 v22, s79, v22
v_mfma_f32_16x16x32_bf16 v[192:195], v[64:67], v[32:35], v[192:195]
ds_read_b64_tr_b16 v[88:89], v15 offset:0
v_mul_f32 v30, s79, v30
v_mfma_f32_16x16x32_bf16 v[192:195], v[68:71], v[36:39], v[192:195]
ds_read_b64_tr_b16 v[90:91], v15 offset:1024
v_mul_f32 v23, s79, v23
v_mfma_f32_16x16x32_bf16 v[196:199], v[68:71], v[44:47], v[196:199]
ds_read_b64_tr_b16 v[92:93], v15 offset:8192
v_mul_f32 v31, s79, v31
v_mfma_f32_16x16x32_bf16 v[196:199], v[64:67], v[40:43], v[196:199]
s_add_u32 s72, s69, 15360
buffer_load_dwordx4 v5, s[4:7], s72 offen offset:1024 lds
v_mfma_f32_16x16x32_bf16 v[200:203], v[64:67], v[48:51], v[200:203]
ds_read_b64_tr_b16 v[94:95], v15 offset:9216
v_cvt_pk_bf16_f32 v20, v20, v28
v_mfma_f32_16x16x32_bf16 v[200:203], v[68:71], v[52:55], v[200:203]
ds_read_b128 v[108:111], v19 offset:2048
v_cvt_pk_bf16_f32 v21, v21, v29
v_mfma_f32_16x16x32_bf16 v[204:207], v[68:71], v[60:63], v[204:207]
v_cvt_pk_bf16_f32 v22, v22, v30
v_cvt_pk_bf16_f32 v23, v23, v31
v_mfma_f32_16x16x32_bf16 v[204:207], v[64:67], v[56:59], v[204:207]
s_waitcnt lgkmcnt(11)
ds_read_b128 v[112:115], v18 offset:4096
v_accvgpr_read_b32 v24, a208
v_mfma_f32_16x16x32_bf16 v[220:223], v[72:75], v[56:59], v[220:223]
s_add_u32 s72, s69, 129024
buffer_load_dwordx4 v4, s[4:7], s72 offen offset:2048 lds
v_mfma_f32_16x16x32_bf16 v[220:223], v[76:79], v[60:63], v[220:223]
s_add_u32 s80, s77, 33792
buffer_store_dwordx4 v[20:23], v1, s[44:47], s80 offen sc1
v_mfma_f32_16x16x32_bf16 v[216:219], v[76:79], v[52:55], v[216:219]
s_waitcnt vmcnt(20) lgkmcnt(2)
ds_read_b128 v[116:119], v19 offset:4096
v_accvgpr_read_b32 v28, a209
v_mfma_f32_16x16x32_bf16 v[216:219], v[72:75], v[48:51], v[216:219]
s_barrier
ds_read_b128 v[120:123], v18 offset:6144
v_accvgpr_read_b32 v25, a210
v_mfma_f32_16x16x32_bf16 v[212:215], v[72:75], v[40:43], v[212:215]
ds_read_b64_tr_b16 v[64:65], v8 offset:16384
ds_read_b64_tr_b16 v[66:67], v8 offset:17408
v_mfma_f32_16x16x32_bf16 v[212:215], v[76:79], v[44:47], v[212:215]
ds_read_b64_tr_b16 v[68:69], v8 offset:24576
v_accvgpr_read_b32 v29, a211
v_mfma_f32_16x16x32_bf16 v[208:211], v[76:79], v[36:39], v[208:211]
s_add_u32 s72, s69, 144384
buffer_load_dwordx4 v5, s[4:7], s72 offen offset:3072 lds
v_mfma_f32_16x16x32_bf16 v[208:211], v[72:75], v[32:35], v[208:211]
ds_read_b64_tr_b16 v[70:71], v8 offset:25600
v_accvgpr_read_b32 v26, a212
v_mfma_f32_16x16x32_bf16 v[224:227], v[80:83], v[32:35], v[224:227]
ds_read_b64_tr_b16 v[72:73], v9 offset:16384
v_accvgpr_read_b32 v30, a213
v_mfma_f32_16x16x32_bf16 v[224:227], v[84:87], v[36:39], v[224:227]
ds_read_b64_tr_b16 v[74:75], v9 offset:17408
v_accvgpr_read_b32 v27, a214
v_mfma_f32_16x16x32_bf16 v[228:231], v[84:87], v[44:47], v[228:231]
s_add_u32 m0, s63, 135168
v_accvgpr_read_b32 v31, a215
v_cvt_pk_bf16_f32 v24, v24, v28
v_mfma_f32_16x16x32_bf16 v[228:231], v[80:83], v[40:43], v[228:231]
s_add_u32 s72, s70, 0
buffer_load_dwordx4 v4, s[4:7], s72 offen lds
v_mfma_f32_16x16x32_bf16 v[232:235], v[80:83], v[48:51], v[232:235]
ds_read_b64_tr_b16 v[76:77], v9 offset:24576
v_cvt_pk_bf16_f32 v25, v25, v29
v_mfma_f32_16x16x32_bf16 v[232:235], v[84:87], v[52:55], v[232:235]
ds_read_b128 v[124:127], v19 offset:6144
v_cvt_pk_bf16_f32 v26, v26, v30
v_mfma_f32_16x16x32_bf16 v[236:239], v[84:87], v[60:63], v[236:239]
ds_read_b64_tr_b16 v[78:79], v9 offset:25600
v_cvt_pk_bf16_f32 v27, v27, v31
v_mfma_f32_16x16x32_bf16 v[236:239], v[80:83], v[56:59], v[236:239]
s_add_u32 s80, s78, 34816
buffer_store_dwordx4 v[24:27], v1, s[44:47], s80 offen sc1
v_mfma_f32_16x16x32_bf16 v[252:255], v[88:91], v[56:59], v[252:255]
s_add_u32 s72, s70, 15360
buffer_load_dwordx4 v5, s[4:7], s72 offen offset:1024 lds
v_mfma_f32_16x16x32_bf16 v[252:255], v[92:95], v[60:63], v[252:255]
ds_read_b64_tr_b16 v[80:81], v10 offset:16384
v_mfma_f32_16x16x32_bf16 v[248:251], v[92:95], v[52:55], v[248:251]
ds_read_b64_tr_b16 v[82:83], v10 offset:17408
v_mfma_f32_16x16x32_bf16 v[248:251], v[88:91], v[48:51], v[248:251]
v_mfma_f32_16x16x32_bf16 v[244:247], v[88:91], v[40:43], v[244:247]
ds_read_b64_tr_b16 v[84:85], v10 offset:24576
v_mfma_f32_16x16x32_bf16 v[244:247], v[92:95], v[44:47], v[244:247]
ds_read_b64_tr_b16 v[86:87], v10 offset:25600
v_accvgpr_read_b32 v20, a84
v_mfma_f32_16x16x32_bf16 v[240:243], v[92:95], v[36:39], v[240:243]
s_add_u32 s72, s70, 129024
buffer_load_dwordx4 v4, s[4:7], s72 offen offset:2048 lds
v_mfma_f32_16x16x32_bf16 v[240:243], v[88:91], v[32:35], v[240:243]
s_waitcnt lgkmcnt(5)
v_accvgpr_read_b32 v28, a85
v_accvgpr_read_b32 v21, a86
v_mfma_f32_16x16x32_bf16 v[128:131], v[64:67], v[96:99], v[128:131]
ds_read_b64_tr_b16 v[88:89], v11 offset:16384
v_accvgpr_read_b32 v29, a87
v_mfma_f32_16x16x32_bf16 v[128:131], v[68:71], v[100:103], v[128:131]
ds_read_b64_tr_b16 v[90:91], v11 offset:17408
v_accvgpr_read_b32 v22, a116
v_mfma_f32_16x16x32_bf16 v[132:135], v[68:71], v[108:111], v[132:135]
v_accvgpr_read_b32 v30, a117
v_accvgpr_read_b32 v23, a118
v_mfma_f32_16x16x32_bf16 v[132:135], v[64:67], v[104:107], v[132:135]
s_add_u32 s72, s70, 144384
buffer_load_dwordx4 v5, s[4:7], s72 offen offset:3072 lds
v_mfma_f32_16x16x32_bf16 v[136:139], v[64:67], v[112:115], v[136:139]
ds_read_b64_tr_b16 v[92:93], v11 offset:24576
v_accvgpr_read_b32 v31, a119
v_mfma_f32_16x16x32_bf16 v[136:139], v[68:71], v[116:119], v[136:139]
s_lshl_b32 s71, s73, 12
v_mul_f32 v20, s79, v20
v_mul_f32 v28, s79, v28
v_mfma_f32_16x16x32_bf16 v[140:143], v[68:71], v[124:127], v[140:143]
s_add_u32 s71, s71, s66
ds_read_b64_tr_b16 v[94:95], v11 offset:25600
v_mul_f32 v21, s79, v21
v_mfma_f32_16x16x32_bf16 v[140:143], v[64:67], v[120:123], v[140:143]
s_waitcnt lgkmcnt(8)
v_mul_f32 v29, s79, v29
v_mul_f32 v22, s79, v22
v_mfma_f32_16x16x32_bf16 v[156:159], v[72:75], v[120:123], v[156:159]
s_add_u32 m0, s64, 0
ds_read_b64_tr_b16 v[64:65], v12 offset:16384
v_mul_f32 v30, s79, v30
v_mfma_f32_16x16x32_bf16 v[156:159], v[76:79], v[124:127], v[156:159]
s_add_u32 s72, s71, 0
buffer_load_dwordx4 v6, s[12:15], s72 offen lds
v_mfma_f32_16x16x32_bf16 v[152:155], v[76:79], v[116:119], v[152:155]
s_add_u32 s73, s62, 10
ds_read_b64_tr_b16 v[66:67], v12 offset:17408
v_mul_f32 v23, s79, v23
v_mfma_f32_16x16x32_bf16 v[152:155], v[72:75], v[112:115], v[152:155]
s_add_u32 s70, s73, s65
v_mul_f32 v31, s79, v31
v_cvt_pk_bf16_f32 v20, v20, v28
v_mfma_f32_16x16x32_bf16 v[148:151], v[72:75], v[104:107], v[148:151]
s_and_b32 s70, s70, 3
ds_read_b64_tr_b16 v[68:69], v12 offset:24576
v_cvt_pk_bf16_f32 v21, v21, v29
v_mfma_f32_16x16x32_bf16 v[148:151], v[76:79], v[108:111], v[148:151]
s_and_b32 s73, s73, 12
ds_read_b64_tr_b16 v[70:71], v12 offset:25600
v_cvt_pk_bf16_f32 v22, v22, v30
v_mfma_f32_16x16x32_bf16 v[144:147], v[76:79], v[100:103], v[144:147]
s_add_u32 s72, s71, 31744
buffer_load_dwordx4 v6, s[12:15], s72 offen offset:1024 lds
v_mfma_f32_16x16x32_bf16 v[144:147], v[72:75], v[96:99], v[144:147]
s_waitcnt lgkmcnt(8)
v_cvt_pk_bf16_f32 v23, v23, v31
v_mfma_f32_16x16x32_bf16 v[160:163], v[80:83], v[96:99], v[160:163]
s_or_b32 s73, s73, s70
ds_read_b64_tr_b16 v[72:73], v13 offset:16384
v_mfma_f32_16x16x32_bf16 v[160:163], v[84:87], v[100:103], v[160:163]
s_lshl_b32 s73, s73, 7
ds_read_b64_tr_b16 v[74:75], v13 offset:17408
v_mfma_f32_16x16x32_bf16 v[164:167], v[84:87], v[108:111], v[164:167]
s_add_u32 s69, s73, s67
v_mfma_f32_16x16x32_bf16 v[164:167], v[80:83], v[104:107], v[164:167]
s_add_u32 s72, s71, 63488
buffer_load_dwordx4 v7, s[12:15], s72 offen offset:2048 lds
v_mfma_f32_16x16x32_bf16 v[168:171], v[80:83], v[112:115], v[168:171]
s_waitcnt vmcnt(18)
ds_read_b64_tr_b16 v[76:77], v13 offset:24576
v_accvgpr_read_b32 v24, a216
v_mfma_f32_16x16x32_bf16 v[168:171], v[84:87], v[116:119], v[168:171]
s_add_u32 s70, s73, s68
ds_read_b128 v[32:35], v18 offset:32768
v_accvgpr_read_b32 v28, a217
v_mfma_f32_16x16x32_bf16 v[172:175], v[84:87], v[124:127], v[172:175]
s_add_u32 s80, s77, 37888
ds_read_b64_tr_b16 v[78:79], v13 offset:25600
v_accvgpr_read_b32 v25, a218
v_mfma_f32_16x16x32_bf16 v[172:175], v[80:83], v[120:123], v[172:175]
s_waitcnt lgkmcnt(9)
ds_read_b128 v[36:39], v19 offset:32768
v_accvgpr_read_b32 v29, a219
v_mfma_f32_16x16x32_bf16 v[188:191], v[88:91], v[120:123], v[188:191]
s_add_u32 s72, s71, 95232
buffer_load_dwordx4 v7, s[12:15], s72 offen offset:3072 lds
v_mfma_f32_16x16x32_bf16 v[188:191], v[92:95], v[124:127], v[188:191]
ds_read_b64_tr_b16 v[80:81], v14 offset:16384
v_accvgpr_read_b32 v26, a220
v_mfma_f32_16x16x32_bf16 v[184:187], v[92:95], v[116:119], v[184:187]
ds_read_b64_tr_b16 v[82:83], v14 offset:17408
v_accvgpr_read_b32 v30, a221
v_mfma_f32_16x16x32_bf16 v[184:187], v[88:91], v[112:115], v[184:187]
buffer_store_dwordx4 v[20:23], v1, s[44:47], s80 offen sc1
v_mfma_f32_16x16x32_bf16 v[180:183], v[88:91], v[104:107], v[180:183]
ds_read_b64_tr_b16 v[84:85], v14 offset:24576
v_accvgpr_read_b32 v27, a222
v_mfma_f32_16x16x32_bf16 v[180:183], v[92:95], v[108:111], v[180:183]
s_add_u32 m0, s63, 65536
ds_read_b64_tr_b16 v[86:87], v14 offset:25600
v_accvgpr_read_b32 v31, a223
v_mfma_f32_16x16x32_bf16 v[176:179], v[92:95], v[100:103], v[176:179]
s_add_u32 s72, s69, 0
buffer_load_dwordx4 v4, s[4:7], s72 offen lds
v_mfma_f32_16x16x32_bf16 v[176:179], v[88:91], v[96:99], v[176:179]
s_waitcnt lgkmcnt(10)
ds_read_b128 v[40:43], v18 offset:34816
v_cvt_pk_bf16_f32 v24, v24, v28
v_mfma_f32_16x16x32_bf16 v[192:195], v[64:67], v[96:99], v[192:195]
ds_read_b64_tr_b16 v[88:89], v15 offset:16384
v_cvt_pk_bf16_f32 v25, v25, v29
v_mfma_f32_16x16x32_bf16 v[192:195], v[68:71], v[100:103], v[192:195]
ds_read_b64_tr_b16 v[90:91], v15 offset:17408
v_cvt_pk_bf16_f32 v26, v26, v30
v_mfma_f32_16x16x32_bf16 v[196:199], v[68:71], v[108:111], v[196:199]
ds_read_b64_tr_b16 v[92:93], v15 offset:24576
v_cvt_pk_bf16_f32 v27, v27, v31
v_mfma_f32_16x16x32_bf16 v[196:199], v[64:67], v[104:107], v[196:199]
s_add_u32 s72, s69, 15360
buffer_load_dwordx4 v5, s[4:7], s72 offen offset:1024 lds
v_mfma_f32_16x16x32_bf16 v[200:203], v[64:67], v[112:115], v[200:203]
s_add_u32 s80, s78, 43008
ds_read_b64_tr_b16 v[94:95], v15 offset:25600
v_mfma_f32_16x16x32_bf16 v[200:203], v[68:71], v[116:119], v[200:203]
ds_read_b128 v[44:47], v19 offset:34816
v_mfma_f32_16x16x32_bf16 v[204:207], v[68:71], v[124:127], v[204:207]
buffer_store_dwordx4 v[24:27], v1, s[44:47], s80 offen sc1
v_mfma_f32_16x16x32_bf16 v[204:207], v[64:67], v[120:123], v[204:207]
s_waitcnt lgkmcnt(11)
ds_read_b128 v[48:51], v18 offset:36864
v_mfma_f32_16x16x32_bf16 v[220:223], v[72:75], v[120:123], v[220:223]
s_add_u32 s72, s69, 129024
buffer_load_dwordx4 v4, s[4:7], s72 offen offset:2048 lds
v_mfma_f32_16x16x32_bf16 v[220:223], v[76:79], v[124:127], v[220:223]
v_accvgpr_read_b32 v20, a88
v_accvgpr_read_b32 v28, a89
v_mfma_f32_16x16x32_bf16 v[216:219], v[76:79], v[116:119], v[216:219]
s_waitcnt vmcnt(20) lgkmcnt(2)
ds_read_b128 v[52:55], v19 offset:36864
v_accvgpr_read_b32 v21, a90
v_mfma_f32_16x16x32_bf16 v[216:219], v[72:75], v[112:115], v[216:219]
s_barrier
ds_read_b128 v[56:59], v18 offset:38912
v_accvgpr_read_b32 v29, a91
v_mfma_f32_16x16x32_bf16 v[212:215], v[72:75], v[104:107], v[212:215]
ds_read_b64_tr_b16 v[64:65], v8 offset:32768
ds_read_b64_tr_b16 v[66:67], v8 offset:33792
v_mfma_f32_16x16x32_bf16 v[212:215], v[76:79], v[108:111], v[212:215]
ds_read_b64_tr_b16 v[68:69], v8 offset:40960
v_accvgpr_read_b32 v22, a120
v_mfma_f32_16x16x32_bf16 v[208:211], v[76:79], v[100:103], v[208:211]
s_add_u32 s72, s69, 144384
buffer_load_dwordx4 v5, s[4:7], s72 offen offset:3072 lds
v_mfma_f32_16x16x32_bf16 v[208:211], v[72:75], v[96:99], v[208:211]
ds_read_b64_tr_b16 v[70:71], v8 offset:41984
v_accvgpr_read_b32 v30, a121
v_mfma_f32_16x16x32_bf16 v[224:227], v[80:83], v[96:99], v[224:227]
ds_read_b64_tr_b16 v[72:73], v9 offset:32768
v_accvgpr_read_b32 v23, a122
v_mfma_f32_16x16x32_bf16 v[224:227], v[84:87], v[100:103], v[224:227]
ds_read_b64_tr_b16 v[74:75], v9 offset:33792
v_accvgpr_read_b32 v31, a123
v_mfma_f32_16x16x32_bf16 v[228:231], v[84:87], v[108:111], v[228:231]
s_add_u32 m0, s63, 69632
v_mul_f32 v20, s79, v20
v_mul_f32 v28, s79, v28
v_mfma_f32_16x16x32_bf16 v[228:231], v[80:83], v[104:107], v[228:231]
s_add_u32 s72, s70, 0
buffer_load_dwordx4 v4, s[4:7], s72 offen lds
v_mfma_f32_16x16x32_bf16 v[232:235], v[80:83], v[112:115], v[232:235]
ds_read_b64_tr_b16 v[76:77], v9 offset:40960
v_mul_f32 v21, s79, v21
v_mfma_f32_16x16x32_bf16 v[232:235], v[84:87], v[116:119], v[232:235]
ds_read_b128 v[60:63], v19 offset:38912
v_mul_f32 v29, s79, v29
v_mfma_f32_16x16x32_bf16 v[236:239], v[84:87], v[124:127], v[236:239]
ds_read_b64_tr_b16 v[78:79], v9 offset:41984
v_mul_f32 v22, s79, v22
v_mfma_f32_16x16x32_bf16 v[236:239], v[80:83], v[120:123], v[236:239]
v_mul_f32 v30, s79, v30
v_mul_f32 v23, s79, v23
v_mfma_f32_16x16x32_bf16 v[252:255], v[88:91], v[120:123], v[252:255]
s_add_u32 s72, s70, 15360
buffer_load_dwordx4 v5, s[4:7], s72 offen offset:1024 lds
v_mfma_f32_16x16x32_bf16 v[252:255], v[92:95], v[124:127], v[252:255]
ds_read_b64_tr_b16 v[80:81], v10 offset:32768
v_mul_f32 v31, s79, v31
v_mfma_f32_16x16x32_bf16 v[248:251], v[92:95], v[116:119], v[248:251]
ds_read_b64_tr_b16 v[82:83], v10 offset:33792
v_cvt_pk_bf16_f32 v20, v20, v28
v_mfma_f32_16x16x32_bf16 v[248:251], v[88:91], v[112:115], v[248:251]
v_cvt_pk_bf16_f32 v21, v21, v29
v_cvt_pk_bf16_f32 v22, v22, v30
v_mfma_f32_16x16x32_bf16 v[244:247], v[88:91], v[104:107], v[244:247]
ds_read_b64_tr_b16 v[84:85], v10 offset:40960
v_cvt_pk_bf16_f32 v23, v23, v31
v_mfma_f32_16x16x32_bf16 v[244:247], v[92:95], v[108:111], v[244:247]
s_add_u32 s80, s77, 41984
ds_read_b64_tr_b16 v[86:87], v10 offset:41984
v_mfma_f32_16x16x32_bf16 v[240:243], v[92:95], v[100:103], v[240:243]
s_add_u32 s72, s70, 129024
buffer_load_dwordx4 v4, s[4:7], s72 offen offset:2048 lds
v_mfma_f32_16x16x32_bf16 v[240:243], v[88:91], v[96:99], v[240:243]
s_waitcnt lgkmcnt(5)
buffer_store_dwordx4 v[20:23], v1, s[44:47], s80 offen sc1
LcB1:
v_mfma_f32_16x16x32_bf16 v[128:131], v[64:67], v[32:35], v[128:131]
ds_read_b64_tr_b16 v[88:89], v11 offset:32768
v_accvgpr_read_b32 v24, a224
v_mfma_f32_16x16x32_bf16 v[128:131], v[68:71], v[36:39], v[128:131]
ds_read_b64_tr_b16 v[90:91], v11 offset:33792
v_accvgpr_read_b32 v28, a225
v_mfma_f32_16x16x32_bf16 v[132:135], v[68:71], v[44:47], v[132:135]
v_accvgpr_read_b32 v25, a226
v_accvgpr_read_b32 v29, a227
v_mfma_f32_16x16x32_bf16 v[132:135], v[64:67], v[40:43], v[132:135]
s_add_u32 s72, s70, 144384
buffer_load_dwordx4 v5, s[4:7], s72 offen offset:3072 lds
v_mfma_f32_16x16x32_bf16 v[136:139], v[64:67], v[48:51], v[136:139]
ds_read_b64_tr_b16 v[92:93], v11 offset:40960
v_accvgpr_read_b32 v26, a228
v_mfma_f32_16x16x32_bf16 v[136:139], v[68:71], v[52:55], v[136:139]
s_lshl_b32 s71, s73, 12
v_accvgpr_read_b32 v30, a229
v_accvgpr_read_b32 v27, a230
v_mfma_f32_16x16x32_bf16 v[140:143], v[68:71], v[60:63], v[140:143]
s_add_u32 s71, s71, s66
ds_read_b64_tr_b16 v[94:95], v11 offset:41984
v_accvgpr_read_b32 v31, a231
v_mfma_f32_16x16x32_bf16 v[140:143], v[64:67], v[56:59], v[140:143]
s_waitcnt lgkmcnt(8)
v_cvt_pk_bf16_f32 v24, v24, v28
v_cvt_pk_bf16_f32 v25, v25, v29
v_mfma_f32_16x16x32_bf16 v[156:159], v[72:75], v[56:59], v[156:159]
s_add_u32 m0, s64, 16384
ds_read_b64_tr_b16 v[64:65], v12 offset:32768
v_cvt_pk_bf16_f32 v26, v26, v30
v_mfma_f32_16x16x32_bf16 v[156:159], v[76:79], v[60:63], v[156:159]
s_add_u32 s72, s71, 0
buffer_load_dwordx4 v6, s[12:15], s72 offen lds
v_mfma_f32_16x16x32_bf16 v[152:155], v[76:79], v[52:55], v[152:155]
s_add_u32 s73, s62, 11
ds_read_b64_tr_b16 v[66:67], v12 offset:33792
v_cvt_pk_bf16_f32 v27, v27, v31
v_mfma_f32_16x16x32_bf16 v[152:155], v[72:75], v[48:51], v[152:155]
s_add_u32 s70, s73, s65
v_mfma_f32_16x16x32_bf16 v[148:151], v[72:75], v[40:43], v[148:151]
s_and_b32 s70, s70, 3
ds_read_b64_tr_b16 v[68:69], v12 offset:40960
v_mfma_f32_16x16x32_bf16 v[148:151], v[76:79], v[44:47], v[148:151]
s_and_b32 s73, s73, 12
ds_read_b64_tr_b16 v[70:71], v12 offset:41984
v_mfma_f32_16x16x32_bf16 v[144:147], v[76:79], v[36:39], v[144:147]
s_add_u32 s72, s71, 31744
buffer_load_dwordx4 v6, s[12:15], s72 offen offset:1024 lds
v_mfma_f32_16x16x32_bf16 v[144:147], v[72:75], v[32:35], v[144:147]
s_waitcnt lgkmcnt(8)
v_mfma_f32_16x16x32_bf16 v[160:163], v[80:83], v[32:35], v[160:163]
s_or_b32 s73, s73, s70
ds_read_b64_tr_b16 v[72:73], v13 offset:32768
v_mfma_f32_16x16x32_bf16 v[160:163], v[84:87], v[36:39], v[160:163]
s_lshl_b32 s73, s73, 7
ds_read_b64_tr_b16 v[74:75], v13 offset:33792
v_mfma_f32_16x16x32_bf16 v[164:167], v[84:87], v[44:47], v[164:167]
s_add_u32 s69, s73, s67
v_mfma_f32_16x16x32_bf16 v[164:167], v[80:83], v[40:43], v[164:167]
s_add_u32 s72, s71, 63488
buffer_load_dwordx4 v7, s[12:15], s72 offen offset:2048 lds
v_mfma_f32_16x16x32_bf16 v[168:171], v[80:83], v[48:51], v[168:171]
s_waitcnt vmcnt(18)
ds_read_b64_tr_b16 v[76:77], v13 offset:40960
v_mfma_f32_16x16x32_bf16 v[168:171], v[84:87], v[52:55], v[168:171]
s_add_u32 s70, s73, s68
ds_read_b128 v[96:99], v16 offset:0
v_accvgpr_read_b32 v20, a92
v_mfma_f32_16x16x32_bf16 v[172:175], v[84:87], v[60:63], v[172:175]
s_add_u32 s80, s78, 3072
ds_read_b64_tr_b16 v[78:79], v13 offset:41984
v_accvgpr_read_b32 v28, a93
v_mfma_f32_16x16x32_bf16 v[172:175], v[80:83], v[56:59], v[172:175]
s_waitcnt lgkmcnt(9)
ds_read_b128 v[100:103], v17 offset:0
v_accvgpr_read_b32 v21, a94
v_mfma_f32_16x16x32_bf16 v[188:191], v[88:91], v[56:59], v[188:191]
s_add_u32 s72, s71, 95232
buffer_load_dwordx4 v7, s[12:15], s72 offen offset:3072 lds
v_mfma_f32_16x16x32_bf16 v[188:191], v[92:95], v[60:63], v[188:191]
ds_read_b64_tr_b16 v[80:81], v14 offset:32768
v_accvgpr_read_b32 v29, a95
v_mfma_f32_16x16x32_bf16 v[184:187], v[92:95], v[52:55], v[184:187]
ds_read_b64_tr_b16 v[82:83], v14 offset:33792
v_accvgpr_read_b32 v22, a124
v_mfma_f32_16x16x32_bf16 v[184:187], v[88:91], v[48:51], v[184:187]
buffer_store_dwordx4 v[24:27], v1, s[44:47], s80 offen sc1
v_mfma_f32_16x16x32_bf16 v[180:183], v[88:91], v[40:43], v[180:183]
ds_read_b64_tr_b16 v[84:85], v14 offset:40960
v_accvgpr_read_b32 v30, a125
v_mfma_f32_16x16x32_bf16 v[180:183], v[92:95], v[44:47], v[180:183]
s_add_u32 m0, s63, 98304
ds_read_b64_tr_b16 v[86:87], v14 offset:41984
v_accvgpr_read_b32 v23, a126
v_mfma_f32_16x16x32_bf16 v[176:179], v[92:95], v[36:39], v[176:179]
s_add_u32 s72, s69, 0
buffer_load_dwordx4 v4, s[4:7], s72 offen lds
v_mfma_f32_16x16x32_bf16 v[176:179], v[88:91], v[32:35], v[176:179]
s_waitcnt lgkmcnt(10)
ds_read_b128 v[104:107], v16 offset:2048
v_accvgpr_read_b32 v31, a127
v_mfma_f32_16x16x32_bf16 v[192:195], v[64:67], v[32:35], v[192:195]
ds_read_b64_tr_b16 v[88:89], v15 offset:32768
v_mul_f32 v20, s79, v20
v_mfma_f32_16x16x32_bf16 v[192:195], v[68:71], v[36:39], v[192:195]
ds_read_b64_tr_b16 v[90:91], v15 offset:33792
v_mul_f32 v28, s79, v28
v_mfma_f32_16x16x32_bf16 v[196:199], v[68:71], v[44:47], v[196:199]
ds_read_b64_tr_b16 v[92:93], v15 offset:40960
v_mul_f32 v21, s79, v21
v_mfma_f32_16x16x32_bf16 v[196:199], v[64:67], v[40:43], v[196:199]
s_add_u32 s72, s69, 15360
buffer_load_dwordx4 v5, s[4:7], s72 offen offset:1024 lds
v_mfma_f32_16x16x32_bf16 v[200:203], v[64:67], v[48:51], v[200:203]
ds_read_b64_tr_b16 v[94:95], v15 offset:41984
v_mul_f32 v29, s79, v29
v_mfma_f32_16x16x32_bf16 v[200:203], v[68:71], v[52:55], v[200:203]
ds_read_b128 v[108:111], v17 offset:2048
v_mul_f32 v22, s79, v22
v_mfma_f32_16x16x32_bf16 v[204:207], v[68:71], v[60:63], v[204:207]
v_mul_f32 v30, s79, v30
v_mul_f32 v23, s79, v23
v_mfma_f32_16x16x32_bf16 v[204:207], v[64:67], v[56:59], v[204:207]
s_waitcnt lgkmcnt(11)
ds_read_b128 v[112:115], v16 offset:4096
v_mul_f32 v31, s79, v31
v_mfma_f32_16x16x32_bf16 v[220:223], v[72:75], v[56:59], v[220:223]
s_add_u32 s72, s69, 129024
buffer_load_dwordx4 v4, s[4:7], s72 offen offset:2048 lds
v_mfma_f32_16x16x32_bf16 v[220:223], v[76:79], v[60:63], v[220:223]
v_cvt_pk_bf16_f32 v20, v20, v28
v_cvt_pk_bf16_f32 v21, v21, v29
v_mfma_f32_16x16x32_bf16 v[216:219], v[76:79], v[52:55], v[216:219]
s_waitcnt vmcnt(19) lgkmcnt(2)
ds_read_b128 v[116:119], v17 offset:4096
v_cvt_pk_bf16_f32 v22, v22, v30
v_mfma_f32_16x16x32_bf16 v[216:219], v[72:75], v[48:51], v[216:219]
s_barrier
ds_read_b128 v[120:123], v16 offset:6144
v_cvt_pk_bf16_f32 v23, v23, v31
v_mfma_f32_16x16x32_bf16 v[212:215], v[72:75], v[40:43], v[212:215]
s_add_u32 s80, s77, 46080
ds_read_b64_tr_b16 v[64:65], v8 offset:0
ds_read_b64_tr_b16 v[66:67], v8 offset:1024
v_mfma_f32_16x16x32_bf16 v[212:215], v[76:79], v[44:47], v[212:215]
ds_read_b64_tr_b16 v[68:69], v8 offset:8192
v_accvgpr_read_b32 v24, a232
v_mfma_f32_16x16x32_bf16 v[208:211], v[76:79], v[36:39], v[208:211]
s_add_u32 s72, s69, 144384
buffer_load_dwordx4 v5, s[4:7], s72 offen offset:3072 lds
v_mfma_f32_16x16x32_bf16 v[208:211], v[72:75], v[32:35], v[208:211]
ds_read_b64_tr_b16 v[70:71], v8 offset:9216
v_accvgpr_read_b32 v28, a233
v_mfma_f32_16x16x32_bf16 v[224:227], v[80:83], v[32:35], v[224:227]
ds_read_b64_tr_b16 v[72:73], v9 offset:0
v_accvgpr_read_b32 v25, a234
v_mfma_f32_16x16x32_bf16 v[224:227], v[84:87], v[36:39], v[224:227]
ds_read_b64_tr_b16 v[74:75], v9 offset:1024
v_accvgpr_read_b32 v29, a235
v_mfma_f32_16x16x32_bf16 v[228:231], v[84:87], v[44:47], v[228:231]
s_add_u32 m0, s63, 102400
buffer_store_dwordx4 v[20:23], v1, s[44:47], s80 offen sc1
v_mfma_f32_16x16x32_bf16 v[228:231], v[80:83], v[40:43], v[228:231]
s_add_u32 s72, s70, 0
buffer_load_dwordx4 v4, s[4:7], s72 offen lds
v_mfma_f32_16x16x32_bf16 v[232:235], v[80:83], v[48:51], v[232:235]
ds_read_b64_tr_b16 v[76:77], v9 offset:8192
v_accvgpr_read_b32 v26, a236
v_mfma_f32_16x16x32_bf16 v[232:235], v[84:87], v[52:55], v[232:235]
ds_read_b128 v[124:127], v17 offset:6144
v_accvgpr_read_b32 v30, a237
v_mfma_f32_16x16x32_bf16 v[236:239], v[84:87], v[60:63], v[236:239]
ds_read_b64_tr_b16 v[78:79], v9 offset:9216
v_accvgpr_read_b32 v27, a238
v_mfma_f32_16x16x32_bf16 v[236:239], v[80:83], v[56:59], v[236:239]
v_accvgpr_read_b32 v31, a239
v_cvt_pk_bf16_f32 v24, v24, v28
v_mfma_f32_16x16x32_bf16 v[252:255], v[88:91], v[56:59], v[252:255]
s_add_u32 s72, s70, 15360
buffer_load_dwordx4 v5, s[4:7], s72 offen offset:1024 lds
v_mfma_f32_16x16x32_bf16 v[252:255], v[92:95], v[60:63], v[252:255]
ds_read_b64_tr_b16 v[80:81], v10 offset:0
v_cvt_pk_bf16_f32 v25, v25, v29
v_mfma_f32_16x16x32_bf16 v[248:251], v[92:95], v[52:55], v[248:251]
ds_read_b64_tr_b16 v[82:83], v10 offset:1024
v_cvt_pk_bf16_f32 v26, v26, v30
v_mfma_f32_16x16x32_bf16 v[248:251], v[88:91], v[48:51], v[248:251]
v_cvt_pk_bf16_f32 v27, v27, v31
v_mfma_f32_16x16x32_bf16 v[244:247], v[88:91], v[40:43], v[244:247]
s_add_u32 s80, s78, 11264
ds_read_b64_tr_b16 v[84:85], v10 offset:8192
v_mfma_f32_16x16x32_bf16 v[244:247], v[92:95], v[44:47], v[244:247]
ds_read_b64_tr_b16 v[86:87], v10 offset:9216
v_mfma_f32_16x16x32_bf16 v[240:243], v[92:95], v[36:39], v[240:243]
s_add_u32 s72, s70, 129024
buffer_load_dwordx4 v4, s[4:7], s72 offen offset:2048 lds
v_mfma_f32_16x16x32_bf16 v[240:243], v[88:91], v[32:35], v[240:243]
s_waitcnt lgkmcnt(5)
buffer_store_dwordx4 v[24:27], v1, s[44:47], s80 offen sc1
v_mfma_f32_16x16x32_bf16 v[128:131], v[64:67], v[96:99], v[128:131]
ds_read_b64_tr_b16 v[88:89], v11 offset:0
v_mfma_f32_16x16x32_bf16 v[128:131], v[68:71], v[100:103], v[128:131]
ds_read_b64_tr_b16 v[90:91], v11 offset:1024
v_accvgpr_read_b32 v20, a240
v_mfma_f32_16x16x32_bf16 v[132:135], v[68:71], v[108:111], v[132:135]
v_accvgpr_read_b32 v28, a241
v_accvgpr_read_b32 v21, a242
v_mfma_f32_16x16x32_bf16 v[132:135], v[64:67], v[104:107], v[132:135]
s_add_u32 s72, s70, 144384
buffer_load_dwordx4 v5, s[4:7], s72 offen offset:3072 lds
v_mfma_f32_16x16x32_bf16 v[136:139], v[64:67], v[112:115], v[136:139]
ds_read_b64_tr_b16 v[92:93], v11 offset:8192
v_accvgpr_read_b32 v29, a243
v_mfma_f32_16x16x32_bf16 v[136:139], v[68:71], v[116:119], v[136:139]
s_lshl_b32 s71, s73, 12
v_accvgpr_read_b32 v22, a244
v_accvgpr_read_b32 v30, a245
v_mfma_f32_16x16x32_bf16 v[140:143], v[68:71], v[124:127], v[140:143]
s_add_u32 s71, s71, s66
ds_read_b64_tr_b16 v[94:95], v11 offset:9216
v_accvgpr_read_b32 v23, a246
v_mfma_f32_16x16x32_bf16 v[140:143], v[64:67], v[120:123], v[140:143]
s_waitcnt lgkmcnt(8)
v_accvgpr_read_b32 v31, a247
v_cvt_pk_bf16_f32 v20, v20, v28
v_mfma_f32_16x16x32_bf16 v[156:159], v[72:75], v[120:123], v[156:159]
s_add_u32 m0, s64, 32768
ds_read_b64_tr_b16 v[64:65], v12 offset:0
v_cvt_pk_bf16_f32 v21, v21, v29
v_mfma_f32_16x16x32_bf16 v[156:159], v[76:79], v[124:127], v[156:159]
s_add_u32 s72, s71, 0
buffer_load_dwordx4 v6, s[12:15], s72 offen lds
v_mfma_f32_16x16x32_bf16 v[152:155], v[76:79], v[116:119], v[152:155]
s_add_u32 s73, s62, 12
ds_read_b64_tr_b16 v[66:67], v12 offset:1024
v_cvt_pk_bf16_f32 v22, v22, v30
v_mfma_f32_16x16x32_bf16 v[152:155], v[72:75], v[112:115], v[152:155]
s_add_u32 s70, s73, s65
v_cvt_pk_bf16_f32 v23, v23, v31
v_mfma_f32_16x16x32_bf16 v[148:151], v[72:75], v[104:107], v[148:151]
s_and_b32 s70, s70, 3
ds_read_b64_tr_b16 v[68:69], v12 offset:8192
v_mfma_f32_16x16x32_bf16 v[148:151], v[76:79], v[108:111], v[148:151]
s_and_b32 s73, s73, 12
ds_read_b64_tr_b16 v[70:71], v12 offset:9216
v_mfma_f32_16x16x32_bf16 v[144:147], v[76:79], v[100:103], v[144:147]
s_add_u32 s72, s71, 31744
buffer_load_dwordx4 v6, s[12:15], s72 offen offset:1024 lds
v_mfma_f32_16x16x32_bf16 v[144:147], v[72:75], v[96:99], v[144:147]
s_waitcnt lgkmcnt(8)
v_mfma_f32_16x16x32_bf16 v[160:163], v[80:83], v[96:99], v[160:163]
s_or_b32 s73, s73, s70
ds_read_b64_tr_b16 v[72:73], v13 offset:0
v_mfma_f32_16x16x32_bf16 v[160:163], v[84:87], v[100:103], v[160:163]
s_lshl_b32 s73, s73, 7
ds_read_b64_tr_b16 v[74:75], v13 offset:1024
v_mfma_f32_16x16x32_bf16 v[164:167], v[84:87], v[108:111], v[164:167]
s_add_u32 s69, s73, s67
v_mfma_f32_16x16x32_bf16 v[164:167], v[80:83], v[104:107], v[164:167]
s_add_u32 s72, s71, 63488
buffer_load_dwordx4 v7, s[12:15], s72 offen offset:2048 lds
v_mfma_f32_16x16x32_bf16 v[168:171], v[80:83], v[112:115], v[168:171]
s_waitcnt vmcnt(18)
ds_read_b64_tr_b16 v[76:77], v13 offset:8192
v_mfma_f32_16x16x32_bf16 v[168:171], v[84:87], v[116:119], v[168:171]
s_add_u32 s70, s73, s68
ds_read_b128 v[32:35], v18 offset:0
v_mfma_f32_16x16x32_bf16 v[172:175], v[84:87], v[124:127], v[172:175]
s_add_u32 s80, s78, 35840
ds_read_b64_tr_b16 v[78:79], v13 offset:9216
v_mfma_f32_16x16x32_bf16 v[172:175], v[80:83], v[120:123], v[172:175]
s_waitcnt lgkmcnt(9)
ds_read_b128 v[36:39], v19 offset:0
v_accvgpr_read_b32 v24, a248
v_mfma_f32_16x16x32_bf16 v[188:191], v[88:91], v[120:123], v[188:191]
s_add_u32 s72, s71, 95232
buffer_load_dwordx4 v7, s[12:15], s72 offen offset:3072 lds
v_mfma_f32_16x16x32_bf16 v[188:191], v[92:95], v[124:127], v[188:191]
ds_read_b64_tr_b16 v[80:81], v14 offset:0
v_accvgpr_read_b32 v28, a249
v_mfma_f32_16x16x32_bf16 v[184:187], v[92:95], v[116:119], v[184:187]
ds_read_b64_tr_b16 v[82:83], v14 offset:1024
v_accvgpr_read_b32 v25, a250
v_mfma_f32_16x16x32_bf16 v[184:187], v[88:91], v[112:115], v[184:187]
buffer_store_dwordx4 v[20:23], v1, s[44:47], s80 offen sc1
v_mfma_f32_16x16x32_bf16 v[180:183], v[88:91], v[104:107], v[180:183]
ds_read_b64_tr_b16 v[84:85], v14 offset:8192
v_accvgpr_read_b32 v29, a251
v_mfma_f32_16x16x32_bf16 v[180:183], v[92:95], v[108:111], v[180:183]
s_add_u32 m0, s63, 131072
ds_read_b64_tr_b16 v[86:87], v14 offset:9216
v_accvgpr_read_b32 v26, a252
v_mfma_f32_16x16x32_bf16 v[176:179], v[92:95], v[100:103], v[176:179]
s_add_u32 s72, s69, 0
buffer_load_dwordx4 v4, s[4:7], s72 offen lds
v_mfma_f32_16x16x32_bf16 v[176:179], v[88:91], v[96:99], v[176:179]
s_waitcnt lgkmcnt(10)
ds_read_b128 v[40:43], v18 offset:2048
v_accvgpr_read_b32 v30, a253
v_mfma_f32_16x16x32_bf16 v[192:195], v[64:67], v[96:99], v[192:195]
ds_read_b64_tr_b16 v[88:89], v15 offset:0
v_accvgpr_read_b32 v27, a254
v_mfma_f32_16x16x32_bf16 v[192:195], v[68:71], v[100:103], v[192:195]
ds_read_b64_tr_b16 v[90:91], v15 offset:1024
v_accvgpr_read_b32 v31, a255
v_mfma_f32_16x16x32_bf16 v[196:199], v[68:71], v[108:111], v[196:199]
ds_read_b64_tr_b16 v[92:93], v15 offset:8192
v_cvt_pk_bf16_f32 v24, v24, v28
v_mfma_f32_16x16x32_bf16 v[196:199], v[64:67], v[104:107], v[196:199]
s_add_u32 s72, s69, 15360
buffer_load_dwordx4 v5, s[4:7], s72 offen offset:1024 lds
v_mfma_f32_16x16x32_bf16 v[200:203], v[64:67], v[112:115], v[200:203]
ds_read_b64_tr_b16 v[94:95], v15 offset:9216
v_cvt_pk_bf16_f32 v25, v25, v29
v_mfma_f32_16x16x32_bf16 v[200:203], v[68:71], v[116:119], v[200:203]
ds_read_b128 v[44:47], v19 offset:2048
v_cvt_pk_bf16_f32 v26, v26, v30
v_mfma_f32_16x16x32_bf16 v[204:207], v[68:71], v[124:127], v[204:207]
v_cvt_pk_bf16_f32 v27, v27, v31
v_mfma_f32_16x16x32_bf16 v[204:207], v[64:67], v[120:123], v[204:207]
s_waitcnt lgkmcnt(11)
ds_read_b128 v[48:51], v18 offset:4096
v_mfma_f32_16x16x32_bf16 v[220:223], v[72:75], v[120:123], v[220:223]
s_add_u32 s72, s69, 129024
buffer_load_dwordx4 v4, s[4:7], s72 offen offset:2048 lds
v_mfma_f32_16x16x32_bf16 v[220:223], v[76:79], v[124:127], v[220:223]
s_add_u32 s80, s78, 44032
ds_read_b128 v[52:55], v19 offset:4096
v_mfma_f32_16x16x32_bf16 v[216:219], v[76:79], v[116:119], v[216:219]
s_waitcnt vmcnt(19) lgkmcnt(3)
buffer_store_dwordx4 v[24:27], v1, s[44:47], s80 offen sc1
v_mfma_f32_16x16x32_bf16 v[216:219], v[72:75], v[112:115], v[216:219]
s_barrier
ds_read_b128 v[56:59], v18 offset:6144
v_mfma_f32_16x16x32_bf16 v[212:215], v[72:75], v[104:107], v[212:215]
ds_read_b64_tr_b16 v[64:65], v8 offset:16384
ds_read_b64_tr_b16 v[66:67], v8 offset:17408
v_mfma_f32_16x16x32_bf16 v[212:215], v[76:79], v[108:111], v[212:215]
ds_read_b64_tr_b16 v[68:69], v8 offset:24576
ds_read_b64_tr_b16 v[70:71], v8 offset:25600
v_mfma_f32_16x16x32_bf16 v[208:211], v[76:79], v[100:103], v[208:211]
s_add_u32 s72, s69, 144384
buffer_load_dwordx4 v5, s[4:7], s72 offen offset:3072 lds
v_mfma_f32_16x16x32_bf16 v[208:211], v[72:75], v[96:99], v[208:211]
v_and_b32 v2, 31, v0
v_lshlrev_b32 v2, 2, v2
v_mfma_f32_16x16x32_bf16 v[224:227], v[80:83], v[96:99], v[224:227]
buffer_load_dword v3, v2, s[48:51], 0 offen sc1
v_mfma_f32_16x16x32_bf16 v[224:227], v[84:87], v[100:103], v[224:227]
ds_read_b64_tr_b16 v[72:73], v9 offset:16384
v_mfma_f32_16x16x32_bf16 v[228:231], v[84:87], v[108:111], v[228:231]
s_add_u32 m0, s63, 135168
ds_read_b64_tr_b16 v[74:75], v9 offset:17408
v_mfma_f32_16x16x32_bf16 v[228:231], v[80:83], v[104:107], v[228:231]
s_add_u32 s72, s70, 0
buffer_load_dwordx4 v4, s[4:7], s72 offen lds
v_mfma_f32_16x16x32_bf16 v[232:235], v[80:83], v[112:115], v[232:235]
ds_read_b128 v[60:63], v19 offset:6144
v_mfma_f32_16x16x32_bf16 v[232:235], v[84:87], v[116:119], v[232:235]
ds_read_b64_tr_b16 v[76:77], v9 offset:24576
v_mfma_f32_16x16x32_bf16 v[236:239], v[84:87], v[124:127], v[236:239]
ds_read_b64_tr_b16 v[78:79], v9 offset:25600
v_mfma_f32_16x16x32_bf16 v[236:239], v[80:83], v[120:123], v[236:239]
v_mfma_f32_16x16x32_bf16 v[252:255], v[88:91], v[120:123], v[252:255]
s_add_u32 s72, s70, 15360
buffer_load_dwordx4 v5, s[4:7], s72 offen offset:1024 lds
v_mfma_f32_16x16x32_bf16 v[252:255], v[92:95], v[124:127], v[252:255]
ds_read_b64_tr_b16 v[80:81], v10 offset:16384
v_mfma_f32_16x16x32_bf16 v[248:251], v[92:95], v[116:119], v[248:251]
ds_read_b64_tr_b16 v[82:83], v10 offset:17408
v_mfma_f32_16x16x32_bf16 v[248:251], v[88:91], v[112:115], v[248:251]
v_mfma_f32_16x16x32_bf16 v[244:247], v[88:91], v[104:107], v[244:247]
ds_read_b64_tr_b16 v[84:85], v10 offset:24576
v_mfma_f32_16x16x32_bf16 v[244:247], v[92:95], v[108:111], v[244:247]
ds_read_b64_tr_b16 v[86:87], v10 offset:25600
v_mfma_f32_16x16x32_bf16 v[240:243], v[92:95], v[100:103], v[240:243]
s_add_u32 s72, s70, 129024
buffer_load_dwordx4 v4, s[4:7], s72 offen offset:2048 lds
v_mfma_f32_16x16x32_bf16 v[240:243], v[88:91], v[96:99], v[240:243]
s_waitcnt lgkmcnt(6)
v_mfma_f32_16x16x32_bf16 v[128:131], v[64:67], v[32:35], v[128:131]
ds_read_b64_tr_b16 v[88:89], v11 offset:16384
v_mfma_f32_16x16x32_bf16 v[128:131], v[68:71], v[36:39], v[128:131]
ds_read_b64_tr_b16 v[90:91], v11 offset:17408
v_mfma_f32_16x16x32_bf16 v[132:135], v[68:71], v[44:47], v[132:135]
v_mfma_f32_16x16x32_bf16 v[132:135], v[64:67], v[40:43], v[132:135]
s_add_u32 s72, s70, 144384
buffer_load_dwordx4 v5, s[4:7], s72 offen offset:3072 lds
v_mfma_f32_16x16x32_bf16 v[136:139], v[64:67], v[48:51], v[136:139]
ds_read_b64_tr_b16 v[92:93], v11 offset:24576
v_mfma_f32_16x16x32_bf16 v[136:139], v[68:71], v[52:55], v[136:139]
s_lshl_b32 s71, s73, 12
v_mfma_f32_16x16x32_bf16 v[140:143], v[68:71], v[60:63], v[140:143]
s_add_u32 s71, s71, s66
ds_read_b64_tr_b16 v[94:95], v11 offset:25600
v_mfma_f32_16x16x32_bf16 v[140:143], v[64:67], v[56:59], v[140:143]
s_waitcnt lgkmcnt(8)
v_mfma_f32_16x16x32_bf16 v[156:159], v[72:75], v[56:59], v[156:159]
s_add_u32 m0, s64, 0
ds_read_b64_tr_b16 v[64:65], v12 offset:16384
v_mfma_f32_16x16x32_bf16 v[156:159], v[76:79], v[60:63], v[156:159]
s_add_u32 s72, s71, 0
buffer_load_dwordx4 v6, s[12:15], s72 offen lds
v_mfma_f32_16x16x32_bf16 v[152:155], v[76:79], v[52:55], v[152:155]
s_add_u32 s73, s62, 13
ds_read_b64_tr_b16 v[66:67], v12 offset:17408
v_mfma_f32_16x16x32_bf16 v[152:155], v[72:75], v[48:51], v[152:155]
s_add_u32 s70, s73, s65
v_mfma_f32_16x16x32_bf16 v[148:151], v[72:75], v[40:43], v[148:151]
s_and_b32 s70, s70, 3
ds_read_b64_tr_b16 v[68:69], v12 offset:24576
v_mfma_f32_16x16x32_bf16 v[148:151], v[76:79], v[44:47], v[148:151]
s_and_b32 s73, s73, 12
ds_read_b64_tr_b16 v[70:71], v12 offset:25600
v_mfma_f32_16x16x32_bf16 v[144:147], v[76:79], v[36:39], v[144:147]
s_add_u32 s72, s71, 31744
buffer_load_dwordx4 v6, s[12:15], s72 offen offset:1024 lds
v_mfma_f32_16x16x32_bf16 v[144:147], v[72:75], v[32:35], v[144:147]
s_waitcnt lgkmcnt(8)
v_mfma_f32_16x16x32_bf16 v[160:163], v[80:83], v[32:35], v[160:163]
s_or_b32 s73, s73, s70
ds_read_b64_tr_b16 v[72:73], v13 offset:16384
v_mfma_f32_16x16x32_bf16 v[160:163], v[84:87], v[36:39], v[160:163]
s_lshl_b32 s73, s73, 7
ds_read_b64_tr_b16 v[74:75], v13 offset:17408
v_mfma_f32_16x16x32_bf16 v[164:167], v[84:87], v[44:47], v[164:167]
s_add_u32 s69, s73, s67
v_mfma_f32_16x16x32_bf16 v[164:167], v[80:83], v[40:43], v[164:167]
s_add_u32 s72, s71, 63488
buffer_load_dwordx4 v7, s[12:15], s72 offen offset:2048 lds
v_mfma_f32_16x16x32_bf16 v[168:171], v[80:83], v[48:51], v[168:171]
s_waitcnt vmcnt(18)
ds_read_b64_tr_b16 v[76:77], v13 offset:24576
v_mfma_f32_16x16x32_bf16 v[168:171], v[84:87], v[52:55], v[168:171]
s_add_u32 s70, s73, s68
ds_read_b128 v[96:99], v18 offset:32768
v_mfma_f32_16x16x32_bf16 v[172:175], v[84:87], v[60:63], v[172:175]
ds_read_b64_tr_b16 v[78:79], v13 offset:25600
v_mfma_f32_16x16x32_bf16 v[172:175], v[80:83], v[56:59], v[172:175]
s_waitcnt lgkmcnt(9)
ds_read_b128 v[100:103], v19 offset:32768
v_mfma_f32_16x16x32_bf16 v[188:191], v[88:91], v[56:59], v[188:191]
s_add_u32 s72, s71, 95232
buffer_load_dwordx4 v7, s[12:15], s72 offen offset:3072 lds
v_mfma_f32_16x16x32_bf16 v[188:191], v[92:95], v[60:63], v[188:191]
ds_read_b64_tr_b16 v[80:81], v14 offset:16384
v_mfma_f32_16x16x32_bf16 v[184:187], v[92:95], v[52:55], v[184:187]
ds_read_b64_tr_b16 v[82:83], v14 offset:17408
v_mfma_f32_16x16x32_bf16 v[184:187], v[88:91], v[48:51], v[184:187]
v_mfma_f32_16x16x32_bf16 v[180:183], v[88:91], v[40:43], v[180:183]
ds_read_b64_tr_b16 v[84:85], v14 offset:24576
v_mfma_f32_16x16x32_bf16 v[180:183], v[92:95], v[44:47], v[180:183]
s_add_u32 m0, s63, 65536
ds_read_b64_tr_b16 v[86:87], v14 offset:25600
v_mfma_f32_16x16x32_bf16 v[176:179], v[92:95], v[36:39], v[176:179]
s_add_u32 s72, s69, 0
buffer_load_dwordx4 v4, s[4:7], s72 offen lds
v_mfma_f32_16x16x32_bf16 v[176:179], v[88:91], v[32:35], v[176:179]
s_waitcnt lgkmcnt(10)
ds_read_b128 v[104:107], v18 offset:34816
v_mfma_f32_16x16x32_bf16 v[192:195], v[64:67], v[32:35], v[192:195]
ds_read_b64_tr_b16 v[88:89], v15 offset:16384
v_mfma_f32_16x16x32_bf16 v[192:195], v[68:71], v[36:39], v[192:195]
ds_read_b64_tr_b16 v[90:91], v15 offset:17408
v_mfma_f32_16x16x32_bf16 v[196:199], v[68:71], v[44:47], v[196:199]
ds_read_b64_tr_b16 v[92:93], v15 offset:24576
v_mfma_f32_16x16x32_bf16 v[196:199], v[64:67], v[40:43], v[196:199]
s_add_u32 s72, s69, 15360
buffer_load_dwordx4 v5, s[4:7], s72 offen offset:1024 lds
v_mfma_f32_16x16x32_bf16 v[200:203], v[64:67], v[48:51], v[200:203]
ds_read_b64_tr_b16 v[94:95], v15 offset:25600
v_mfma_f32_16x16x32_bf16 v[200:203], v[68:71], v[52:55], v[200:203]
ds_read_b128 v[108:111], v19 offset:34816
v_mfma_f32_16x16x32_bf16 v[204:207], v[68:71], v[60:63], v[204:207]
v_mfma_f32_16x16x32_bf16 v[204:207], v[64:67], v[56:59], v[204:207]
s_waitcnt lgkmcnt(11)
ds_read_b128 v[112:115], v18 offset:36864
v_mfma_f32_16x16x32_bf16 v[220:223], v[72:75], v[56:59], v[220:223]
s_add_u32 s72, s69, 129024
buffer_load_dwordx4 v4, s[4:7], s72 offen offset:2048 lds
v_mfma_f32_16x16x32_bf16 v[220:223], v[76:79], v[60:63], v[220:223]
v_mfma_f32_16x16x32_bf16 v[216:219], v[76:79], v[52:55], v[216:219]
s_waitcnt vmcnt(13) lgkmcnt(2)
ds_read_b128 v[116:119], v19 offset:36864
v_mfma_f32_16x16x32_bf16 v[216:219], v[72:75], v[48:51], v[216:219]
s_barrier
ds_read_b128 v[120:123], v18 offset:38912
v_mfma_f32_16x16x32_bf16 v[212:215], v[72:75], v[40:43], v[212:215]
ds_read_b64_tr_b16 v[64:65], v8 offset:32768
ds_read_b64_tr_b16 v[66:67], v8 offset:33792
v_mfma_f32_16x16x32_bf16 v[212:215], v[76:79], v[44:47], v[212:215]
ds_read_b64_tr_b16 v[68:69], v8 offset:40960
v_or_b32 v20, s58, v0
v_mfma_f32_16x16x32_bf16 v[208:211], v[76:79], v[36:39], v[208:211]
s_add_u32 s72, s69, 144384
buffer_load_dwordx4 v5, s[4:7], s72 offen offset:3072 lds
v_mfma_f32_16x16x32_bf16 v[208:211], v[72:75], v[32:35], v[208:211]
ds_read_b64_tr_b16 v[70:71], v8 offset:41984
v_mov_b32 v21, 1
v_mfma_f32_16x16x32_bf16 v[224:227], v[80:83], v[32:35], v[224:227]
ds_read_b64_tr_b16 v[72:73], v9 offset:32768
v_min_u32 v20, 1, v20
v_mfma_f32_16x16x32_bf16 v[224:227], v[84:87], v[36:39], v[224:227]
ds_read_b64_tr_b16 v[74:75], v9 offset:33792
v_lshlrev_b32 v20, 30, v20
v_mfma_f32_16x16x32_bf16 v[228:231], v[84:87], v[44:47], v[228:231]
s_add_u32 m0, s63, 69632
buffer_store_dword v21, v20, s[44:47], s91 offen sc1
v_mfma_f32_16x16x32_bf16 v[228:231], v[80:83], v[40:43], v[228:231]
s_add_u32 s72, s70, 0
buffer_load_dwordx4 v4, s[4:7], s72 offen lds
v_mfma_f32_16x16x32_bf16 v[232:235], v[80:83], v[48:51], v[232:235]
ds_read_b64_tr_b16 v[76:77], v9 offset:40960
v_accvgpr_write_b32 a32, 0
v_mfma_f32_16x16x32_bf16 v[232:235], v[84:87], v[52:55], v[232:235]
ds_read_b128 v[124:127], v19 offset:38912
v_accvgpr_write_b32 a33, 0
v_mfma_f32_16x16x32_bf16 v[236:239], v[84:87], v[60:63], v[236:239]
ds_read_b64_tr_b16 v[78:79], v9 offset:41984
v_accvgpr_write_b32 a34, 0
v_mfma_f32_16x16x32_bf16 v[236:239], v[80:83], v[56:59], v[236:239]
v_accvgpr_write_b32 a35, 0
v_accvgpr_write_b32 a36, 0
v_mfma_f32_16x16x32_bf16 v[252:255], v[88:91], v[56:59], v[252:255]
s_add_u32 s72, s70, 15360
buffer_load_dwordx4 v5, s[4:7], s72 offen offset:1024 lds
v_mfma_f32_16x16x32_bf16 v[252:255], v[92:95], v[60:63], v[252:255]
ds_read_b64_tr_b16 v[80:81], v10 offset:32768
v_accvgpr_write_b32 a37, 0
v_mfma_f32_16x16x32_bf16 v[248:251], v[92:95], v[52:55], v[248:251]
ds_read_b64_tr_b16 v[82:83], v10 offset:33792
v_accvgpr_write_b32 a38, 0
v_mfma_f32_16x16x32_bf16 v[248:251], v[88:91], v[48:51], v[248:251]
v_accvgpr_write_b32 a39, 0
v_accvgpr_write_b32 a40, 0
v_mfma_f32_16x16x32_bf16 v[244:247], v[88:91], v[40:43], v[244:247]
ds_read_b64_tr_b16 v[84:85], v10 offset:40960
v_accvgpr_write_b32 a41, 0
v_mfma_f32_16x16x32_bf16 v[244:247], v[92:95], v[44:47], v[244:247]
ds_read_b64_tr_b16 v[86:87], v10 offset:41984
v_accvgpr_write_b32 a42, 0
v_mfma_f32_16x16x32_bf16 v[240:243], v[92:95], v[36:39], v[240:243]
s_add_u32 s72, s70, 129024
buffer_load_dwordx4 v4, s[4:7], s72 offen offset:2048 lds
v_mfma_f32_16x16x32_bf16 v[240:243], v[88:91], v[32:35], v[240:243]
s_waitcnt lgkmcnt(5)
v_accvgpr_write_b32 a43, 0
v_accvgpr_write_b32 a44, 0
v_mfma_f32_16x16x32_bf16 v[128:131], v[64:67], v[96:99], v[128:131]
ds_read_b64_tr_b16 v[88:89], v11 offset:32768
v_accvgpr_write_b32 a45, 0
v_mfma_f32_16x16x32_bf16 v[128:131], v[68:71], v[100:103], v[128:131]
ds_read_b64_tr_b16 v[90:91], v11 offset:33792
v_accvgpr_write_b32 a46, 0
v_mfma_f32_16x16x32_bf16 v[132:135], v[68:71], v[108:111], v[132:135]
v_accvgpr_write_b32 a47, 0
v_accvgpr_write_b32 a48, 0
v_mfma_f32_16x16x32_bf16 v[132:135], v[64:67], v[104:107], v[132:135]
s_add_u32 s72, s70, 144384
buffer_load_dwordx4 v5, s[4:7], s72 offen offset:3072 lds
v_mfma_f32_16x16x32_bf16 v[136:139], v[64:67], v[112:115], v[136:139]
ds_read_b64_tr_b16 v[92:93], v11 offset:40960
v_accvgpr_write_b32 a49, 0
v_mfma_f32_16x16x32_bf16 v[136:139], v[68:71], v[116:119], v[136:139]
s_lshl_b32 s71, s73, 12
v_accvgpr_write_b32 a50, 0
v_accvgpr_write_b32 a51, 0
v_mfma_f32_16x16x32_bf16 v[140:143], v[68:71], v[124:127], v[140:143]
s_add_u32 s71, s71, s66
ds_read_b64_tr_b16 v[94:95], v11 offset:41984
v_accvgpr_write_b32 a52, 0
v_mfma_f32_16x16x32_bf16 v[140:143], v[64:67], v[120:123], v[140:143]
s_waitcnt lgkmcnt(8)
v_accvgpr_write_b32 a53, 0
v_accvgpr_write_b32 a54, 0
v_mfma_f32_16x16x32_bf16 v[156:159], v[72:75], v[120:123], v[156:159]
s_add_u32 m0, s64, 16384
ds_read_b64_tr_b16 v[64:65], v12 offset:32768
v_accvgpr_write_b32 a55, 0
v_mfma_f32_16x16x32_bf16 v[156:159], v[76:79], v[124:127], v[156:159]
s_add_u32 s72, s71, 0
buffer_load_dwordx4 v6, s[12:15], s72 offen lds
v_mfma_f32_16x16x32_bf16 v[152:155], v[76:79], v[116:119], v[152:155]
s_add_u32 s73, s62, 14
ds_read_b64_tr_b16 v[66:67], v12 offset:33792
v_accvgpr_write_b32 a56, 0
v_mfma_f32_16x16x32_bf16 v[152:155], v[72:75], v[112:115], v[152:155]
s_add_u32 s70, s73, s65
v_accvgpr_write_b32 a57, 0
v_accvgpr_write_b32 a58, 0
v_mfma_f32_16x16x32_bf16 v[148:151], v[72:75], v[104:107], v[148:151]
s_and_b32 s70, s70, 3
ds_read_b64_tr_b16 v[68:69], v12 offset:40960
v_accvgpr_write_b32 a59, 0
v_mfma_f32_16x16x32_bf16 v[148:151], v[76:79], v[108:111], v[148:151]
s_and_b32 s73, s73, 12
ds_read_b64_tr_b16 v[70:71], v12 offset:41984
v_accvgpr_write_b32 a60, 0
v_mfma_f32_16x16x32_bf16 v[144:147], v[76:79], v[100:103], v[144:147]
s_add_u32 s72, s71, 31744
buffer_load_dwordx4 v6, s[12:15], s72 offen offset:1024 lds
v_mfma_f32_16x16x32_bf16 v[144:147], v[72:75], v[96:99], v[144:147]
s_waitcnt lgkmcnt(8)
v_accvgpr_write_b32 a61, 0
v_accvgpr_write_b32 a62, 0
v_mfma_f32_16x16x32_bf16 v[160:163], v[80:83], v[96:99], v[160:163]
s_or_b32 s73, s73, s70
ds_read_b64_tr_b16 v[72:73], v13 offset:32768
v_accvgpr_write_b32 a63, 0
v_mfma_f32_16x16x32_bf16 v[160:163], v[84:87], v[100:103], v[160:163]
s_lshl_b32 s73, s73, 7
ds_read_b64_tr_b16 v[74:75], v13 offset:33792
v_accvgpr_write_b32 a96, 0
v_mfma_f32_16x16x32_bf16 v[164:167], v[84:87], v[108:111], v[164:167]
s_add_u32 s69, s73, s67
v_accvgpr_write_b32 a97, 0
v_accvgpr_write_b32 a98, 0
v_mfma_f32_16x16x32_bf16 v[164:167], v[80:83], v[104:107], v[164:167]
s_add_u32 s72, s71, 63488
buffer_load_dwordx4 v7, s[12:15], s72 offen offset:2048 lds
v_mfma_f32_16x16x32_bf16 v[168:171], v[80:83], v[112:115], v[168:171]
s_waitcnt vmcnt(16)
ds_read_b64_tr_b16 v[76:77], v13 offset:40960
v_accvgpr_write_b32 a99, 0
v_mfma_f32_16x16x32_bf16 v[168:171], v[84:87], v[116:119], v[168:171]
s_add_u32 s70, s73, s68
ds_read_b128 v[32:35], v16 offset:0
v_accvgpr_write_b32 a100, 0
v_mfma_f32_16x16x32_bf16 v[172:175], v[84:87], v[124:127], v[172:175]
ds_read_b64_tr_b16 v[78:79], v13 offset:41984
v_accvgpr_write_b32 a101, 0
v_mfma_f32_16x16x32_bf16 v[172:175], v[80:83], v[120:123], v[172:175]
s_waitcnt lgkmcnt(9)
ds_read_b128 v[36:39], v17 offset:0
v_accvgpr_write_b32 a102, 0
v_mfma_f32_16x16x32_bf16 v[188:191], v[88:91], v[120:123], v[188:191]
s_add_u32 s72, s71, 95232
buffer_load_dwordx4 v7, s[12:15], s72 offen offset:3072 lds
v_mfma_f32_16x16x32_bf16 v[188:191], v[92:95], v[124:127], v[188:191]
ds_read_b64_tr_b16 v[80:81], v14 offset:32768
v_accvgpr_write_b32 a103, 0
v_mfma_f32_16x16x32_bf16 v[184:187], v[92:95], v[116:119], v[184:187]
ds_read_b64_tr_b16 v[82:83], v14 offset:33792
v_accvgpr_write_b32 a104, 0
v_mfma_f32_16x16x32_bf16 v[184:187], v[88:91], v[112:115], v[184:187]
v_accvgpr_write_b32 a105, 0
v_accvgpr_write_b32 a106, 0
v_mfma_f32_16x16x32_bf16 v[180:183], v[88:91], v[104:107], v[180:183]
ds_read_b64_tr_b16 v[84:85], v14 offset:40960
v_accvgpr_write_b32 a107, 0
v_mfma_f32_16x16x32_bf16 v[180:183], v[92:95], v[108:111], v[180:183]
s_add_u32 m0, s63, 98304
ds_read_b64_tr_b16 v[86:87], v14 offset:41984
v_accvgpr_write_b32 a108, 0
v_mfma_f32_16x16x32_bf16 v[176:179], v[92:95], v[100:103], v[176:179]
s_add_u32 s72, s69, 0
buffer_load_dwordx4 v4, s[4:7], s72 offen lds
v_mfma_f32_16x16x32_bf16 v[176:179], v[88:91], v[96:99], v[176:179]
s_waitcnt lgkmcnt(10)
ds_read_b128 v[40:43], v16 offset:2048
v_accvgpr_write_b32 a109, 0
v_mfma_f32_16x16x32_bf16 v[192:195], v[64:67], v[96:99], v[192:195]
ds_read_b64_tr_b16 v[88:89], v15 offset:32768
v_accvgpr_write_b32 a110, 0
v_mfma_f32_16x16x32_bf16 v[192:195], v[68:71], v[100:103], v[192:195]
ds_read_b64_tr_b16 v[90:91], v15 offset:33792
v_accvgpr_write_b32 a111, 0
v_mfma_f32_16x16x32_bf16 v[196:199], v[68:71], v[108:111], v[196:199]
ds_read_b64_tr_b16 v[92:93], v15 offset:40960
v_accvgpr_write_b32 a112, 0
v_mfma_f32_16x16x32_bf16 v[196:199], v[64:67], v[104:107], v[196:199]
s_add_u32 s72, s69, 15360
buffer_load_dwordx4 v5, s[4:7], s72 offen offset:1024 lds
v_mfma_f32_16x16x32_bf16 v[200:203], v[64:67], v[112:115], v[200:203]
ds_read_b64_tr_b16 v[94:95], v15 offset:41984
v_accvgpr_write_b32 a113, 0
v_mfma_f32_16x16x32_bf16 v[200:203], v[68:71], v[116:119], v[200:203]
ds_read_b128 v[44:47], v17 offset:2048
v_accvgpr_write_b32 a114, 0
v_mfma_f32_16x16x32_bf16 v[204:207], v[68:71], v[124:127], v[204:207]
v_accvgpr_write_b32 a115, 0
v_accvgpr_write_b32 a116, 0
v_mfma_f32_16x16x32_bf16 v[204:207], v[64:67], v[120:123], v[204:207]
s_waitcnt lgkmcnt(11)
ds_read_b128 v[48:51], v16 offset:4096
v_accvgpr_write_b32 a117, 0
v_mfma_f32_16x16x32_bf16 v[220:223], v[72:75], v[120:123], v[220:223]
s_add_u32 s72, s69, 129024
buffer_load_dwordx4 v4, s[4:7], s72 offen offset:2048 lds
v_mfma_f32_16x16x32_bf16 v[220:223], v[76:79], v[124:127], v[220:223]
v_accvgpr_write_b32 a118, 0
v_accvgpr_write_b32 a119, 0
v_mfma_f32_16x16x32_bf16 v[216:219], v[76:79], v[116:119], v[216:219]
s_waitcnt vmcnt(16) lgkmcnt(2)
ds_read_b128 v[52:55], v17 offset:4096
v_accvgpr_write_b32 a120, 0
v_mfma_f32_16x16x32_bf16 v[216:219], v[72:75], v[112:115], v[216:219]
s_barrier
ds_read_b128 v[56:59], v16 offset:6144
v_accvgpr_write_b32 a121, 0
v_mfma_f32_16x16x32_bf16 v[212:215], v[72:75], v[104:107], v[212:215]
s_waitcnt vmcnt(24)
v_cmp_gt_u32 vcc, 8, v3
s_cbranch_vccnz Lspin1
Lback2:
v_mfma_f32_16x16x32_bf16 v[212:215], v[76:79], v[108:111], v[212:215]
ds_read_b64_tr_b16 v[64:65], v8 offset:0
ds_read_b64_tr_b16 v[66:67], v8 offset:1024
v_mfma_f32_16x16x32_bf16 v[208:211], v[76:79], v[100:103], v[208:211]
s_add_u32 s72, s69, 144384
buffer_load_dwordx4 v5, s[4:7], s72 offen offset:3072 lds
v_mfma_f32_16x16x32_bf16 v[208:211], v[72:75], v[96:99], v[208:211]
ds_read_b64_tr_b16 v[68:69], v8 offset:8192
ds_read_b64_tr_b16 v[70:71], v8 offset:9216
v_mfma_f32_16x16x32_bf16 v[224:227], v[80:83], v[96:99], v[224:227]
ds_read_b64_tr_b16 v[72:73], v9 offset:0
v_accvgpr_write_b32 a122, 0
v_mfma_f32_16x16x32_bf16 v[224:227], v[84:87], v[100:103], v[224:227]
ds_read_b64_tr_b16 v[74:75], v9 offset:1024
v_accvgpr_write_b32 a123, 0
v_mfma_f32_16x16x32_bf16 v[228:231], v[84:87], v[108:111], v[228:231]
s_add_u32 m0, s63, 102400
v_accvgpr_write_b32 a124, 0
v_accvgpr_write_b32 a125, 0
v_mfma_f32_16x16x32_bf16 v[228:231], v[80:83], v[104:107], v[228:231]
s_add_u32 s72, s70, 0
buffer_load_dwordx4 v4, s[4:7], s72 offen lds
v_mfma_f32_16x16x32_bf16 v[232:235], v[80:83], v[112:115], v[232:235]
ds_read_b64_tr_b16 v[76:77], v9 offset:8192
v_accvgpr_write_b32 a126, 0
v_mfma_f32_16x16x32_bf16 v[232:235], v[84:87], v[116:119], v[232:235]
ds_read_b128 v[60:63], v17 offset:6144
v_accvgpr_write_b32 a127, 0
v_mfma_f32_16x16x32_bf16 v[236:239], v[84:87], v[124:127], v[236:239]
ds_read_b64_tr_b16 v[78:79], v9 offset:9216
v_mfma_f32_16x16x32_bf16 v[236:239], v[80:83], v[120:123], v[236:239]
v_mfma_f32_16x16x32_bf16 v[252:255], v[88:91], v[120:123], v[252:255]
s_add_u32 s72, s70, 15360
buffer_load_dwordx4 v5, s[4:7], s72 offen offset:1024 lds
v_mfma_f32_16x16x32_bf16 v[252:255], v[92:95], v[124:127], v[252:255]
ds_read_b64_tr_b16 v[80:81], v10 offset:0
v_mfma_f32_16x16x32_bf16 v[248:251], v[92:95], v[116:119], v[248:251]
ds_read_b64_tr_b16 v[82:83], v10 offset:1024
v_mfma_f32_16x16x32_bf16 v[248:251], v[88:91], v[112:115], v[248:251]
v_mfma_f32_16x16x32_bf16 v[244:247], v[88:91], v[104:107], v[244:247]
ds_read_b64_tr_b16 v[84:85], v10 offset:8192
v_mfma_f32_16x16x32_bf16 v[244:247], v[92:95], v[108:111], v[244:247]
ds_read_b64_tr_b16 v[86:87], v10 offset:9216
v_mfma_f32_16x16x32_bf16 v[240:243], v[92:95], v[100:103], v[240:243]
s_add_u32 s72, s70, 129024
buffer_load_dwordx4 v4, s[4:7], s72 offen offset:2048 lds
v_mfma_f32_16x16x32_bf16 v[240:243], v[88:91], v[96:99], v[240:243]
s_waitcnt lgkmcnt(5)
v_mfma_f32_16x16x32_bf16 v[128:131], v[64:67], v[32:35], v[128:131]
ds_read_b64_tr_b16 v[88:89], v11 offset:0
v_mfma_f32_16x16x32_bf16 v[128:131], v[68:71], v[36:39], v[128:131]
ds_read_b64_tr_b16 v[90:91], v11 offset:1024
v_mfma_f32_16x16x32_bf16 v[132:135], v[68:71], v[44:47], v[132:135]
v_mfma_f32_16x16x32_bf16 v[132:135], v[64:67], v[40:43], v[132:135]
s_add_u32 s72, s70, 144384
buffer_load_dwordx4 v5, s[4:7], s72 offen offset:3072 lds
v_mfma_f32_16x16x32_bf16 v[136:139], v[64:67], v[48:51], v[136:139]
ds_read_b64_tr_b16 v[92:93], v11 offset:8192
v_mfma_f32_16x16x32_bf16 v[136:139], v[68:71], v[52:55], v[136:139]
s_lshl_b32 s71, s73, 12
v_mfma_f32_16x16x32_bf16 v[140:143], v[68:71], v[60:63], v[140:143]
s_add_u32 s71, s71, s66
ds_read_b64_tr_b16 v[94:95], v11 offset:9216
v_mfma_f32_16x16x32_bf16 v[140:143], v[64:67], v[56:59], v[140:143]
s_waitcnt lgkmcnt(8)
v_mfma_f32_16x16x32_bf16 v[156:159], v[72:75], v[56:59], v[156:159]
s_add_u32 m0, s64, 32768
ds_read_b64_tr_b16 v[64:65], v12 offset:0
v_mfma_f32_16x16x32_bf16 v[156:159], v[76:79], v[60:63], v[156:159]
s_add_u32 s72, s71, 0
buffer_load_dwordx4 v6, s[12:15], s72 offen lds
v_mfma_f32_16x16x32_bf16 v[152:155], v[76:79], v[52:55], v[152:155]
s_add_u32 s73, s62, 15
ds_read_b64_tr_b16 v[66:67], v12 offset:1024
v_mfma_f32_16x16x32_bf16 v[152:155], v[72:75], v[48:51], v[152:155]
s_add_u32 s70, s73, s65
v_mfma_f32_16x16x32_bf16 v[148:151], v[72:75], v[40:43], v[148:151]
s_and_b32 s70, s70, 3
ds_read_b64_tr_b16 v[68:69], v12 offset:8192
v_mfma_f32_16x16x32_bf16 v[148:151], v[76:79], v[44:47], v[148:151]
s_and_b32 s73, s73, 12
ds_read_b64_tr_b16 v[70:71], v12 offset:9216
v_mfma_f32_16x16x32_bf16 v[144:147], v[76:79], v[36:39], v[144:147]
s_add_u32 s72, s71, 31744
buffer_load_dwordx4 v6, s[12:15], s72 offen offset:1024 lds
v_mfma_f32_16x16x32_bf16 v[144:147], v[72:75], v[32:35], v[144:147]
s_waitcnt lgkmcnt(8)
v_mfma_f32_16x16x32_bf16 v[160:163], v[80:83], v[32:35], v[160:163]
s_or_b32 s73, s73, s70
ds_read_b64_tr_b16 v[72:73], v13 offset:0
v_mfma_f32_16x16x32_bf16 v[160:163], v[84:87], v[36:39], v[160:163]
s_lshl_b32 s73, s73, 7
ds_read_b64_tr_b16 v[74:75], v13 offset:1024
v_mfma_f32_16x16x32_bf16 v[164:167], v[84:87], v[44:47], v[164:167]
s_add_u32 s69, s73, s67
v_mfma_f32_16x16x32_bf16 v[164:167], v[80:83], v[40:43], v[164:167]
s_add_u32 s72, s71, 63488
buffer_load_dwordx4 v7, s[12:15], s72 offen offset:2048 lds
v_mfma_f32_16x16x32_bf16 v[168:171], v[80:83], v[48:51], v[168:171]
s_waitcnt vmcnt(15)
ds_read_b64_tr_b16 v[76:77], v13 offset:8192
v_mfma_f32_16x16x32_bf16 v[168:171], v[84:87], v[52:55], v[168:171]
s_add_u32 s70, s73, s68
ds_read_b128 v[96:99], v18 offset:0
v_mfma_f32_16x16x32_bf16 v[172:175], v[84:87], v[60:63], v[172:175]
ds_read_b64_tr_b16 v[78:79], v13 offset:9216
v_mfma_f32_16x16x32_bf16 v[172:175], v[80:83], v[56:59], v[172:175]
s_waitcnt lgkmcnt(9)
ds_read_b128 v[100:103], v19 offset:0
v_mfma_f32_16x16x32_bf16 v[188:191], v[88:91], v[56:59], v[188:191]
s_add_u32 s72, s71, 95232
buffer_load_dwordx4 v7, s[12:15], s72 offen offset:3072 lds
v_mfma_f32_16x16x32_bf16 v[188:191], v[92:95], v[60:63], v[188:191]
ds_read_b64_tr_b16 v[80:81], v14 offset:0
v_mfma_f32_16x16x32_bf16 v[184:187], v[92:95], v[52:55], v[184:187]
ds_read_b64_tr_b16 v[82:83], v14 offset:1024
v_mfma_f32_16x16x32_bf16 v[184:187], v[88:91], v[48:51], v[184:187]
v_mfma_f32_16x16x32_bf16 v[180:183], v[88:91], v[40:43], v[180:183]
ds_read_b64_tr_b16 v[84:85], v14 offset:8192
v_mfma_f32_16x16x32_bf16 v[180:183], v[92:95], v[44:47], v[180:183]
s_add_u32 m0, s63, 131072
ds_read_b64_tr_b16 v[86:87], v14 offset:9216
v_mfma_f32_16x16x32_bf16 v[176:179], v[92:95], v[36:39], v[176:179]
s_add_u32 s72, s69, 0
buffer_load_dwordx4 v4, s[4:7], s72 offen lds
v_mfma_f32_16x16x32_bf16 v[176:179], v[88:91], v[32:35], v[176:179]
s_waitcnt lgkmcnt(10)
ds_read_b128 v[104:107], v18 offset:2048
v_mfma_f32_16x16x32_bf16 v[192:195], v[64:67], v[32:35], v[192:195]
ds_read_b64_tr_b16 v[88:89], v15 offset:0
ds_read_b64_tr_b16 v[90:91], v15 offset:1024
v_mfma_f32_16x16x32_bf16 v[192:195], v[68:71], v[36:39], v[192:195]
ds_read_b64_tr_b16 v[92:93], v15 offset:8192
v_mfma_f32_16x16x32_bf16 v[196:199], v[68:71], v[44:47], v[196:199]
s_and_b32 s75, s91, 0xfffffc7f
v_lshrrev_b32 v2, 3, v0
v_lshlrev_b32 v2, 7, v2
v_mfma_f32_16x16x32_bf16 v[196:199], v[64:67], v[40:43], v[196:199]
s_add_u32 s72, s69, 15360
buffer_load_dwordx4 v5, s[4:7], s72 offen offset:1024 lds
v_mfma_f32_16x16x32_bf16 v[200:203], v[64:67], v[48:51], v[200:203]
buffer_load_dword v3, v2, s[44:47], s75 offen sc1
v_mfma_f32_16x16x32_bf16 v[200:203], v[68:71], v[52:55], v[200:203]
ds_read_b64_tr_b16 v[94:95], v15 offset:9216
v_mfma_f32_16x16x32_bf16 v[204:207], v[68:71], v[60:63], v[204:207]
ds_read_b128 v[108:111], v19 offset:2048
v_mfma_f32_16x16x32_bf16 v[204:207], v[64:67], v[56:59], v[204:207]
s_waitcnt lgkmcnt(11)
v_mfma_f32_16x16x32_bf16 v[220:223], v[72:75], v[56:59], v[220:223]
s_add_u32 s72, s69, 129024
buffer_load_dwordx4 v4, s[4:7], s72 offen offset:2048 lds
v_mfma_f32_16x16x32_bf16 v[220:223], v[76:79], v[60:63], v[220:223]
ds_read_b128 v[112:115], v18 offset:4096
v_mfma_f32_16x16x32_bf16 v[216:219], v[76:79], v[52:55], v[216:219]
s_waitcnt vmcnt(16) lgkmcnt(2)
ds_read_b128 v[116:119], v19 offset:4096
v_mfma_f32_16x16x32_bf16 v[216:219], v[72:75], v[48:51], v[216:219]
s_barrier
v_mfma_f32_16x16x32_bf16 v[212:215], v[72:75], v[40:43], v[212:215]
ds_read_b64_tr_b16 v[64:65], v8 offset:16384
ds_read_b64_tr_b16 v[66:67], v8 offset:17408
v_mfma_f32_16x16x32_bf16 v[212:215], v[76:79], v[44:47], v[212:215]
ds_read_b64_tr_b16 v[68:69], v8 offset:24576
v_mfma_f32_16x16x32_bf16 v[208:211], v[76:79], v[36:39], v[208:211]
s_add_u32 s72, s69, 144384
buffer_load_dwordx4 v5, s[4:7], s72 offen offset:3072 lds
v_mfma_f32_16x16x32_bf16 v[208:211], v[72:75], v[32:35], v[208:211]
ds_read_b64_tr_b16 v[70:71], v8 offset:25600
v_mfma_f32_16x16x32_bf16 v[224:227], v[80:83], v[32:35], v[224:227]
ds_read_b64_tr_b16 v[72:73], v9 offset:16384
v_mfma_f32_16x16x32_bf16 v[224:227], v[84:87], v[36:39], v[224:227]
ds_read_b64_tr_b16 v[74:75], v9 offset:17408
v_mfma_f32_16x16x32_bf16 v[228:231], v[84:87], v[44:47], v[228:231]
s_add_u32 m0, s63, 135168
ds_read_b128 v[120:123], v18 offset:6144
v_mfma_f32_16x16x32_bf16 v[228:231], v[80:83], v[40:43], v[228:231]
s_add_u32 s72, s70, 0
buffer_load_dwordx4 v4, s[4:7], s72 offen lds
v_mfma_f32_16x16x32_bf16 v[232:235], v[80:83], v[48:51], v[232:235]
ds_read_b64_tr_b16 v[76:77], v9 offset:24576
v_mfma_f32_16x16x32_bf16 v[232:235], v[84:87], v[52:55], v[232:235]
ds_read_b128 v[124:127], v19 offset:6144
v_mfma_f32_16x16x32_bf16 v[236:239], v[84:87], v[60:63], v[236:239]
ds_read_b64_tr_b16 v[78:79], v9 offset:25600
v_mfma_f32_16x16x32_bf16 v[236:239], v[80:83], v[56:59], v[236:239]
v_mfma_f32_16x16x32_bf16 v[252:255], v[88:91], v[56:59], v[252:255]
s_add_u32 s72, s70, 15360
buffer_load_dwordx4 v5, s[4:7], s72 offen offset:1024 lds
v_mfma_f32_16x16x32_bf16 v[252:255], v[92:95], v[60:63], v[252:255]
ds_read_b64_tr_b16 v[80:81], v10 offset:16384
v_mfma_f32_16x16x32_bf16 v[248:251], v[92:95], v[52:55], v[248:251]
ds_read_b64_tr_b16 v[82:83], v10 offset:17408
v_mfma_f32_16x16x32_bf16 v[248:251], v[88:91], v[48:51], v[248:251]
v_mfma_f32_16x16x32_bf16 v[244:247], v[88:91], v[40:43], v[244:247]
ds_read_b64_tr_b16 v[84:85], v10 offset:24576
v_mfma_f32_16x16x32_bf16 v[244:247], v[92:95], v[44:47], v[244:247]
ds_read_b64_tr_b16 v[86:87], v10 offset:25600
v_mfma_f32_16x16x32_bf16 v[240:243], v[92:95], v[36:39], v[240:243]
s_add_u32 s72, s70, 129024
buffer_load_dwordx4 v4, s[4:7], s72 offen offset:2048 lds
v_mfma_f32_16x16x32_bf16 v[240:243], v[88:91], v[32:35], v[240:243]
s_waitcnt lgkmcnt(5)
v_mfma_f32_16x16x32_bf16 v[128:131], v[64:67], v[96:99], v[128:131]
ds_read_b64_tr_b16 v[88:89], v11 offset:16384
v_mfma_f32_16x16x32_bf16 v[128:131], v[68:71], v[100:103], v[128:131]
ds_read_b64_tr_b16 v[90:91], v11 offset:17408
v_mfma_f32_16x16x32_bf16 v[132:135], v[68:71], v[108:111], v[132:135]
v_mfma_f32_16x16x32_bf16 v[132:135], v[64:67], v[104:107], v[132:135]
s_add_u32 s72, s70, 144384
buffer_load_dwordx4 v5, s[4:7], s72 offen offset:3072 lds
v_mfma_f32_16x16x32_bf16 v[136:139], v[64:67], v[112:115], v[136:139]
ds_read_b64_tr_b16 v[92:93], v11 offset:24576
v_mfma_f32_16x16x32_bf16 v[136:139], v[68:71], v[116:119], v[136:139]
s_lshl_b32 s71, s73, 12
v_mfma_f32_16x16x32_bf16 v[140:143], v[68:71], v[124:127], v[140:143]
s_add_u32 s71, s71, s66
ds_read_b64_tr_b16 v[94:95], v11 offset:25600
v_mfma_f32_16x16x32_bf16 v[140:143], v[64:67], v[120:123], v[140:143]
s_waitcnt lgkmcnt(8)
v_mfma_f32_16x16x32_bf16 v[156:159], v[72:75], v[120:123], v[156:159]
s_add_u32 m0, s64, 0
ds_read_b64_tr_b16 v[64:65], v12 offset:16384
v_mfma_f32_16x16x32_bf16 v[156:159], v[76:79], v[124:127], v[156:159]
s_add_u32 s72, s71, 0
buffer_load_dwordx4 v6, s[12:15], s72 offen lds
v_mfma_f32_16x16x32_bf16 v[152:155], v[76:79], v[116:119], v[152:155]
ds_read_b64_tr_b16 v[66:67], v12 offset:17408
v_mfma_f32_16x16x32_bf16 v[152:155], v[72:75], v[112:115], v[152:155]
v_mfma_f32_16x16x32_bf16 v[148:151], v[72:75], v[104:107], v[148:151]
ds_read_b64_tr_b16 v[68:69], v12 offset:24576
v_mfma_f32_16x16x32_bf16 v[148:151], v[76:79], v[108:111], v[148:151]
ds_read_b64_tr_b16 v[70:71], v12 offset:25600
v_mfma_f32_16x16x32_bf16 v[144:147], v[76:79], v[100:103], v[144:147]
s_add_u32 s72, s71, 31744
buffer_load_dwordx4 v6, s[12:15], s72 offen offset:1024 lds
v_mfma_f32_16x16x32_bf16 v[144:147], v[72:75], v[96:99], v[144:147]
s_waitcnt lgkmcnt(8)
v_mfma_f32_16x16x32_bf16 v[160:163], v[80:83], v[96:99], v[160:163]
ds_read_b64_tr_b16 v[72:73], v13 offset:16384
v_mfma_f32_16x16x32_bf16 v[160:163], v[84:87], v[100:103], v[160:163]
ds_read_b64_tr_b16 v[74:75], v13 offset:17408
v_mfma_f32_16x16x32_bf16 v[164:167], v[84:87], v[108:111], v[164:167]
v_mfma_f32_16x16x32_bf16 v[164:167], v[80:83], v[104:107], v[164:167]
s_add_u32 s72, s71, 63488
buffer_load_dwordx4 v7, s[12:15], s72 offen offset:2048 lds
v_mfma_f32_16x16x32_bf16 v[168:171], v[80:83], v[112:115], v[168:171]
s_waitcnt vmcnt(16)
ds_read_b64_tr_b16 v[76:77], v13 offset:24576
v_mfma_f32_16x16x32_bf16 v[168:171], v[84:87], v[116:119], v[168:171]
ds_read_b128 v[32:35], v18 offset:32768
v_mfma_f32_16x16x32_bf16 v[172:175], v[84:87], v[124:127], v[172:175]
ds_read_b64_tr_b16 v[78:79], v13 offset:25600
v_mfma_f32_16x16x32_bf16 v[172:175], v[80:83], v[120:123], v[172:175]
s_waitcnt lgkmcnt(9)
ds_read_b128 v[36:39], v19 offset:32768
v_mfma_f32_16x16x32_bf16 v[188:191], v[88:91], v[120:123], v[188:191]
s_add_u32 s72, s71, 95232
buffer_load_dwordx4 v7, s[12:15], s72 offen offset:3072 lds
v_mfma_f32_16x16x32_bf16 v[188:191], v[92:95], v[124:127], v[188:191]
v_accvgpr_write_b32 a0, -1
v_accvgpr_write_b32 a1, -1
v_mfma_f32_16x16x32_bf16 v[184:187], v[92:95], v[116:119], v[184:187]
v_accvgpr_write_b32 a2, -1
v_accvgpr_write_b32 a3, -1
v_mfma_f32_16x16x32_bf16 v[184:187], v[88:91], v[112:115], v[184:187]
s_add_u32 s80, s93, 0x3a00000
ds_read_b64_tr_b16 v[80:81], v14 offset:16384
v_mfma_f32_16x16x32_bf16 v[180:183], v[88:91], v[104:107], v[180:183]
ds_read_b64_tr_b16 v[82:83], v14 offset:17408
v_mfma_f32_16x16x32_bf16 v[180:183], v[92:95], v[108:111], v[180:183]
ds_read_b64_tr_b16 v[84:85], v14 offset:24576
v_mfma_f32_16x16x32_bf16 v[176:179], v[92:95], v[100:103], v[176:179]
ds_read_b64_tr_b16 v[86:87], v14 offset:25600
v_mfma_f32_16x16x32_bf16 v[176:179], v[88:91], v[96:99], v[176:179]
s_waitcnt lgkmcnt(10)
ds_read_b128 v[40:43], v18 offset:34816
v_mfma_f32_16x16x32_bf16 v[192:195], v[64:67], v[96:99], v[192:195]
s_waitcnt vmcnt(10)
v_cmp_gt_u32 vcc, 1, v3
s_cbranch_vccnz Lspin4
Lback5:
v_mfma_f32_16x16x32_bf16 v[192:195], v[68:71], v[100:103], v[192:195]
s_add_u32 m0, s64, 49152
ds_read_b64_tr_b16 v[88:89], v15 offset:16384
ds_read_b64_tr_b16 v[90:91], v15 offset:17408
v_mfma_f32_16x16x32_bf16 v[196:199], v[68:71], v[108:111], v[196:199]
s_add_u32 s72, s81, 16384
buffer_load_dwordx4 v1, s[44:47], s72 offen sc1 lds
v_mfma_f32_16x16x32_bf16 v[196:199], v[64:67], v[104:107], v[196:199]
ds_read_b64_tr_b16 v[92:93], v15 offset:24576
v_mfma_f32_16x16x32_bf16 v[200:203], v[64:67], v[112:115], v[200:203]
ds_read_b64_tr_b16 v[94:95], v15 offset:25600
v_mfma_f32_16x16x32_bf16 v[200:203], v[68:71], v[116:119], v[200:203]
buffer_load_dwordx4 v1, s[44:47], s72 offen offset:1024 sc1 lds
v_mfma_f32_16x16x32_bf16 v[204:207], v[68:71], v[124:127], v[204:207]
ds_read_b128 v[44:47], v19 offset:34816
v_mfma_f32_16x16x32_bf16 v[204:207], v[64:67], v[120:123], v[204:207]
s_waitcnt lgkmcnt(11)
v_mfma_f32_16x16x32_bf16 v[220:223], v[72:75], v[120:123], v[220:223]
ds_read_b128 v[48:51], v18 offset:36864
v_mfma_f32_16x16x32_bf16 v[220:223], v[76:79], v[124:127], v[220:223]
ds_read_b128 v[52:55], v19 offset:36864
v_mfma_f32_16x16x32_bf16 v[216:219], v[76:79], v[116:119], v[216:219]
s_waitcnt vmcnt(15) lgkmcnt(3)
buffer_load_dwordx4 v1, s[44:47], s72 offen offset:2048 sc1 lds
v_mfma_f32_16x16x32_bf16 v[216:219], v[72:75], v[112:115], v[216:219]
s_barrier
ds_read_b128 v[56:59], v18 offset:38912
v_mfma_f32_16x16x32_bf16 v[212:215], v[72:75], v[104:107], v[212:215]
ds_read_b64_tr_b16 v[64:65], v8 offset:32768
ds_read_b64_tr_b16 v[66:67], v8 offset:33792
v_mfma_f32_16x16x32_bf16 v[212:215], v[76:79], v[108:111], v[212:215]
ds_read_b64_tr_b16 v[68:69], v8 offset:40960
v_mfma_f32_16x16x32_bf16 v[208:211], v[76:79], v[100:103], v[208:211]
ds_read_b64_tr_b16 v[70:71], v8 offset:41984
v_mfma_f32_16x16x32_bf16 v[208:211], v[72:75], v[96:99], v[208:211]
buffer_load_dwordx4 v1, s[44:47], s72 offen offset:3072 sc1 lds
v_mfma_f32_16x16x32_bf16 v[224:227], v[80:83], v[96:99], v[224:227]
s_add_u32 s81, s81, 0x8000
ds_read_b64_tr_b16 v[72:73], v9 offset:32768
v_mfma_f32_16x16x32_bf16 v[224:227], v[84:87], v[100:103], v[224:227]
s_add_u32 m0, s64, 81920
ds_read_b64_tr_b16 v[74:75], v9 offset:33792
v_mfma_f32_16x16x32_bf16 v[228:231], v[84:87], v[108:111], v[228:231]
s_add_u32 s72, s81, 16384
buffer_load_dwordx4 v1, s[44:47], s72 offen sc1 lds
v_mfma_f32_16x16x32_bf16 v[228:231], v[80:83], v[104:107], v[228:231]
ds_read_b128 v[60:63], v19 offset:38912
v_mfma_f32_16x16x32_bf16 v[232:235], v[80:83], v[112:115], v[232:235]
buffer_load_dwordx4 v1, s[44:47], s72 offen offset:1024 sc1 lds
v_mfma_f32_16x16x32_bf16 v[232:235], v[84:87], v[116:119], v[232:235]
ds_read_b64_tr_b16 v[76:77], v9 offset:40960
v_mfma_f32_16x16x32_bf16 v[236:239], v[84:87], v[124:127], v[236:239]
ds_read_b64_tr_b16 v[78:79], v9 offset:41984
v_mfma_f32_16x16x32_bf16 v[236:239], v[80:83], v[120:123], v[236:239]
v_mfma_f32_16x16x32_bf16 v[252:255], v[88:91], v[120:123], v[252:255]
ds_read_b64_tr_b16 v[80:81], v10 offset:32768
v_mfma_f32_16x16x32_bf16 v[252:255], v[92:95], v[124:127], v[252:255]
buffer_load_dwordx4 v1, s[44:47], s72 offen offset:2048 sc1 lds
v_mfma_f32_16x16x32_bf16 v[248:251], v[92:95], v[116:119], v[248:251]
ds_read_b64_tr_b16 v[82:83], v10 offset:33792
v_mfma_f32_16x16x32_bf16 v[248:251], v[88:91], v[112:115], v[248:251]
v_mfma_f32_16x16x32_bf16 v[244:247], v[88:91], v[104:107], v[244:247]
ds_read_b64_tr_b16 v[84:85], v10 offset:40960
v_mfma_f32_16x16x32_bf16 v[244:247], v[92:95], v[108:111], v[244:247]
buffer_load_dwordx4 v1, s[44:47], s72 offen offset:3072 sc1 lds
v_mfma_f32_16x16x32_bf16 v[240:243], v[92:95], v[100:103], v[240:243]
ds_read_b64_tr_b16 v[86:87], v10 offset:41984
v_mfma_f32_16x16x32_bf16 v[240:243], v[88:91], v[96:99], v[240:243]
s_waitcnt lgkmcnt(6)
v_mfma_f32_16x16x32_bf16 v[128:131], v[64:67], v[32:35], v[128:131]
ds_read_b64_tr_b16 v[88:89], v11 offset:32768
v_mfma_f32_16x16x32_bf16 v[128:131], v[68:71], v[36:39], v[128:131]
ds_read_b64_tr_b16 v[90:91], v11 offset:33792
v_mfma_f32_16x16x32_bf16 v[132:135], v[68:71], v[44:47], v[132:135]
s_add_u32 m0, s64, 65536
v_mfma_f32_16x16x32_bf16 v[132:135], v[64:67], v[40:43], v[132:135]
s_add_u32 s72, s81, 0
buffer_load_dwordx4 v1, s[44:47], s72 offen sc1 lds
v_mfma_f32_16x16x32_bf16 v[136:139], v[64:67], v[48:51], v[136:139]
ds_read_b64_tr_b16 v[92:93], v11 offset:40960
v_mfma_f32_16x16x32_bf16 v[136:139], v[68:71], v[52:55], v[136:139]
ds_read_b64_tr_b16 v[94:95], v11 offset:41984
v_mfma_f32_16x16x32_bf16 v[140:143], v[68:71], v[60:63], v[140:143]
v_mfma_f32_16x16x32_bf16 v[140:143], v[64:67], v[56:59], v[140:143]
s_waitcnt lgkmcnt(8)
buffer_load_dwordx4 v1, s[44:47], s72 offen offset:1024 sc1 lds
v_mfma_f32_16x16x32_bf16 v[156:159], v[72:75], v[56:59], v[156:159]
ds_read_b64_tr_b16 v[64:65], v12 offset:32768
v_mfma_f32_16x16x32_bf16 v[156:159], v[76:79], v[60:63], v[156:159]
ds_read_b64_tr_b16 v[66:67], v12 offset:33792
v_mfma_f32_16x16x32_bf16 v[152:155], v[76:79], v[52:55], v[152:155]
v_mfma_f32_16x16x32_bf16 v[152:155], v[72:75], v[48:51], v[152:155]
buffer_load_dwordx4 v1, s[44:47], s72 offen offset:2048 sc1 lds
v_mfma_f32_16x16x32_bf16 v[148:151], v[72:75], v[40:43], v[148:151]
ds_read_b64_tr_b16 v[68:69], v12 offset:40960
v_mfma_f32_16x16x32_bf16 v[148:151], v[76:79], v[44:47], v[148:151]
v_mfma_f32_16x16x32_bf16 v[144:147], v[76:79], v[36:39], v[144:147]
ds_read_b64_tr_b16 v[70:71], v12 offset:41984
v_mfma_f32_16x16x32_bf16 v[144:147], v[72:75], v[32:35], v[144:147]
s_waitcnt lgkmcnt(8)
v_mfma_f32_16x16x32_bf16 v[160:163], v[80:83], v[32:35], v[160:163]
buffer_load_dwordx4 v1, s[44:47], s72 offen offset:3072 sc1 lds
v_mfma_f32_16x16x32_bf16 v[160:163], v[84:87], v[36:39], v[160:163]
ds_read_b64_tr_b16 v[72:73], v13 offset:32768
v_mfma_f32_16x16x32_bf16 v[164:167], v[84:87], v[44:47], v[164:167]
ds_read_b64_tr_b16 v[74:75], v13 offset:33792
v_mfma_f32_16x16x32_bf16 v[164:167], v[80:83], v[40:43], v[164:167]
v_mfma_f32_16x16x32_bf16 v[168:171], v[80:83], v[48:51], v[168:171]
s_waitcnt vmcnt(16)
ds_read_b64_tr_b16 v[76:77], v13 offset:40960
v_mfma_f32_16x16x32_bf16 v[168:171], v[84:87], v[52:55], v[168:171]
ds_read_b128 v[96:99], v16 offset:0
v_mfma_f32_16x16x32_bf16 v[172:175], v[84:87], v[60:63], v[172:175]
ds_read_b64_tr_b16 v[78:79], v13 offset:41984
v_mfma_f32_16x16x32_bf16 v[172:175], v[80:83], v[56:59], v[172:175]
s_waitcnt lgkmcnt(9)
v_mfma_f32_16x16x32_bf16 v[188:191], v[88:91], v[56:59], v[188:191]
ds_read_b64_tr_b16 v[80:81], v14 offset:32768
v_mfma_f32_16x16x32_bf16 v[188:191], v[92:95], v[60:63], v[188:191]
ds_read_b128 v[100:103], v17 offset:0
v_mfma_f32_16x16x32_bf16 v[184:187], v[92:95], v[52:55], v[184:187]
ds_read_b64_tr_b16 v[82:83], v14 offset:33792
v_mfma_f32_16x16x32_bf16 v[184:187], v[88:91], v[48:51], v[184:187]
v_mfma_f32_16x16x32_bf16 v[180:183], v[88:91], v[40:43], v[180:183]
ds_read_b64_tr_b16 v[84:85], v14 offset:40960
v_mfma_f32_16x16x32_bf16 v[180:183], v[92:95], v[44:47], v[180:183]
ds_read_b128 v[104:107], v16 offset:2048
v_mfma_f32_16x16x32_bf16 v[176:179], v[92:95], v[36:39], v[176:179]
ds_read_b64_tr_b16 v[86:87], v14 offset:41984
v_mfma_f32_16x16x32_bf16 v[176:179], v[88:91], v[32:35], v[176:179]
s_waitcnt lgkmcnt(11)
v_mfma_f32_16x16x32_bf16 v[192:195], v[64:67], v[32:35], v[192:195]
ds_read_b64_tr_b16 v[88:89], v15 offset:32768
v_mfma_f32_16x16x32_bf16 v[192:195], v[68:71], v[36:39], v[192:195]
ds_read_b64_tr_b16 v[90:91], v15 offset:33792
v_mfma_f32_16x16x32_bf16 v[196:199], v[68:71], v[44:47], v[196:199]
ds_read_b128 v[108:111], v17 offset:2048
v_mfma_f32_16x16x32_bf16 v[196:199], v[64:67], v[40:43], v[196:199]
ds_read_b64_tr_b16 v[92:93], v15 offset:40960
v_mfma_f32_16x16x32_bf16 v[200:203], v[64:67], v[48:51], v[200:203]
ds_read_b64_tr_b16 v[94:95], v15 offset:41984
v_mfma_f32_16x16x32_bf16 v[200:203], v[68:71], v[52:55], v[200:203]
v_mfma_f32_16x16x32_bf16 v[204:207], v[68:71], v[60:63], v[204:207]
ds_read_b128 v[112:115], v16 offset:4096
v_mfma_f32_16x16x32_bf16 v[204:207], v[64:67], v[56:59], v[204:207]
s_waitcnt lgkmcnt(12)
v_mfma_f32_16x16x32_bf16 v[220:223], v[72:75], v[56:59], v[220:223]
ds_read_b128 v[116:119], v17 offset:4096
v_mfma_f32_16x16x32_bf16 v[220:223], v[76:79], v[60:63], v[220:223]
v_mfma_f32_16x16x32_bf16 v[216:219], v[76:79], v[52:55], v[216:219]
s_waitcnt vmcnt(12) lgkmcnt(2)
ds_read_b128 v[120:123], v16 offset:6144
v_mfma_f32_16x16x32_bf16 v[216:219], v[72:75], v[48:51], v[216:219]
s_barrier
v_mfma_f32_16x16x32_bf16 v[212:215], v[72:75], v[40:43], v[212:215]
s_add_u32 s81, s81, 0x8000
ds_read_b64_tr_b16 v[64:65], v8 offset:0
ds_read_b64_tr_b16 v[66:67], v8 offset:1024
v_mfma_f32_16x16x32_bf16 v[212:215], v[76:79], v[44:47], v[212:215]
s_add_u32 m0, s64, 114688
ds_read_b64_tr_b16 v[68:69], v8 offset:8192
v_mfma_f32_16x16x32_bf16 v[208:211], v[76:79], v[36:39], v[208:211]
s_add_u32 s72, s81, 16384
buffer_load_dwordx4 v1, s[44:47], s72 offen sc1 lds
v_mfma_f32_16x16x32_bf16 v[208:211], v[72:75], v[32:35], v[208:211]
ds_read_b64_tr_b16 v[70:71], v8 offset:9216
v_mfma_f32_16x16x32_bf16 v[224:227], v[80:83], v[32:35], v[224:227]
buffer_load_dwordx4 v1, s[44:47], s72 offen offset:1024 sc1 lds
v_mfma_f32_16x16x32_bf16 v[224:227], v[84:87], v[36:39], v[224:227]
ds_read_b64_tr_b16 v[72:73], v9 offset:0
v_mfma_f32_16x16x32_bf16 v[228:231], v[84:87], v[44:47], v[228:231]
ds_read_b64_tr_b16 v[74:75], v9 offset:1024
v_mfma_f32_16x16x32_bf16 v[228:231], v[80:83], v[40:43], v[228:231]
ds_read_b128 v[124:127], v17 offset:6144
v_mfma_f32_16x16x32_bf16 v[232:235], v[80:83], v[48:51], v[232:235]
ds_read_b64_tr_b16 v[76:77], v9 offset:8192
v_mfma_f32_16x16x32_bf16 v[232:235], v[84:87], v[52:55], v[232:235]
buffer_store_dwordx4 a[0:3], v1, s[44:47], s80 offen sc1
v_mfma_f32_16x16x32_bf16 v[236:239], v[84:87], v[60:63], v[236:239]
ds_read_b64_tr_b16 v[78:79], v9 offset:9216
v_mfma_f32_16x16x32_bf16 v[236:239], v[80:83], v[56:59], v[236:239]
v_mfma_f32_16x16x32_bf16 v[252:255], v[88:91], v[56:59], v[252:255]
ds_read_b64_tr_b16 v[80:81], v10 offset:0
v_mfma_f32_16x16x32_bf16 v[252:255], v[92:95], v[60:63], v[252:255]
ds_read_b64_tr_b16 v[82:83], v10 offset:1024
v_mfma_f32_16x16x32_bf16 v[248:251], v[92:95], v[52:55], v[248:251]
buffer_load_dwordx4 v1, s[44:47], s72 offen offset:2048 sc1 lds
v_mfma_f32_16x16x32_bf16 v[248:251], v[88:91], v[48:51], v[248:251]
v_mfma_f32_16x16x32_bf16 v[244:247], v[88:91], v[40:43], v[244:247]
ds_read_b64_tr_b16 v[84:85], v10 offset:8192
v_mfma_f32_16x16x32_bf16 v[244:247], v[92:95], v[44:47], v[244:247]
ds_read_b64_tr_b16 v[86:87], v10 offset:9216
v_mfma_f32_16x16x32_bf16 v[240:243], v[92:95], v[36:39], v[240:243]
buffer_load_dwordx4 v1, s[44:47], s72 offen offset:3072 sc1 lds
v_mfma_f32_16x16x32_bf16 v[240:243], v[88:91], v[32:35], v[240:243]
s_waitcnt lgkmcnt(6)
v_mfma_f32_16x16x32_bf16 v[128:131], v[64:67], v[96:99], v[128:131]
ds_read_b64_tr_b16 v[88:89], v11 offset:0
v_mfma_f32_16x16x32_bf16 v[128:131], v[68:71], v[100:103], v[128:131]
ds_read_b64_tr_b16 v[90:91], v11 offset:1024
v_mfma_f32_16x16x32_bf16 v[132:135], v[68:71], v[108:111], v[132:135]
v_mfma_f32_16x16x32_bf16 v[132:135], v[64:67], v[104:107], v[132:135]
buffer_store_dwordx4 a[0:3], v1, s[44:47], s80 offen offset:1024 sc1
v_mfma_f32_16x16x32_bf16 v[136:139], v[64:67], v[112:115], v[136:139]
ds_read_b64_tr_b16 v[92:93], v11 offset:8192
v_mfma_f32_16x16x32_bf16 v[136:139], v[68:71], v[116:119], v[136:139]
v_mfma_f32_16x16x32_bf16 v[140:143], v[68:71], v[124:127], v[140:143]
ds_read_b64_tr_b16 v[94:95], v11 offset:9216
v_mfma_f32_16x16x32_bf16 v[140:143], v[64:67], v[120:123], v[140:143]
s_waitcnt lgkmcnt(8)
v_mfma_f32_16x16x32_bf16 v[156:159], v[72:75], v[120:123], v[156:159]
s_add_u32 m0, s64, 98304
ds_read_b64_tr_b16 v[64:65], v12 offset:0
v_mfma_f32_16x16x32_bf16 v[156:159], v[76:79], v[124:127], v[156:159]
s_add_u32 s72, s81, 0
buffer_load_dwordx4 v1, s[44:47], s72 offen sc1 lds
v_mfma_f32_16x16x32_bf16 v[152:155], v[76:79], v[116:119], v[152:155]
ds_read_b64_tr_b16 v[66:67], v12 offset:1024
v_mfma_f32_16x16x32_bf16 v[152:155], v[72:75], v[112:115], v[152:155]
v_mfma_f32_16x16x32_bf16 v[148:151], v[72:75], v[104:107], v[148:151]
buffer_load_dwordx4 v1, s[44:47], s72 offen offset:1024 sc1 lds
v_mfma_f32_16x16x32_bf16 v[148:151], v[76:79], v[108:111], v[148:151]
ds_read_b64_tr_b16 v[68:69], v12 offset:8192
v_mfma_f32_16x16x32_bf16 v[144:147], v[76:79], v[100:103], v[144:147]
ds_read_b64_tr_b16 v[70:71], v12 offset:9216
v_mfma_f32_16x16x32_bf16 v[144:147], v[72:75], v[96:99], v[144:147]
s_waitcnt lgkmcnt(8)
v_mfma_f32_16x16x32_bf16 v[160:163], v[80:83], v[96:99], v[160:163]
ds_read_b64_tr_b16 v[72:73], v13 offset:0
v_mfma_f32_16x16x32_bf16 v[160:163], v[84:87], v[100:103], v[160:163]
buffer_store_dwordx4 a[0:3], v1, s[44:47], s80 offen offset:2048 sc1
v_mfma_f32_16x16x32_bf16 v[164:167], v[84:87], v[108:111], v[164:167]
ds_read_b64_tr_b16 v[74:75], v13 offset:1024
v_mfma_f32_16x16x32_bf16 v[164:167], v[80:83], v[104:107], v[164:167]
v_mfma_f32_16x16x32_bf16 v[168:171], v[80:83], v[112:115], v[168:171]
ds_read_b64_tr_b16 v[76:77], v13 offset:8192
v_cvt_pk_bf16_f32 v48, v136, v137
v_mfma_f32_16x16x32_bf16 v[168:171], v[84:87], v[116:119], v[168:171]
ds_read_b64_tr_b16 v[78:79], v13 offset:9216
v_cvt_pk_bf16_f32 v49, v138, v139
v_mfma_f32_16x16x32_bf16 v[172:175], v[84:87], v[124:127], v[172:175]
buffer_load_dwordx4 v1, s[44:47], s72 offen offset:2048 sc1 lds
v_mfma_f32_16x16x32_bf16 v[172:175], v[80:83], v[120:123], v[172:175]
s_waitcnt lgkmcnt(8)
v_cvt_pk_bf16_f32 v50, v152, v153
v_cvt_pk_bf16_f32 v51, v154, v155
v_mfma_f32_16x16x32_bf16 v[188:191], v[88:91], v[120:123], v[188:191]
v_add_u32 v2, 0x8000, v1
v_cvt_pk_bf16_f32 v32, v132, v133
v_mfma_f32_16x16x32_bf16 v[188:191], v[92:95], v[124:127], v[188:191]
ds_read_b64_tr_b16 v[80:81], v14 offset:0
v_cvt_pk_bf16_f32 v33, v134, v135
v_mfma_f32_16x16x32_bf16 v[184:187], v[92:95], v[116:119], v[184:187]
buffer_load_dwordx4 v1, s[44:47], s72 offen offset:3072 sc1 lds
v_mfma_f32_16x16x32_bf16 v[184:187], v[88:91], v[112:115], v[184:187]
ds_read_b64_tr_b16 v[82:83], v14 offset:1024
v_cvt_pk_bf16_f32 v34, v148, v149
v_mfma_f32_16x16x32_bf16 v[180:183], v[88:91], v[104:107], v[180:183]
ds_read_b64_tr_b16 v[84:85], v14 offset:8192
v_cvt_pk_bf16_f32 v35, v150, v151
v_mfma_f32_16x16x32_bf16 v[180:183], v[92:95], v[108:111], v[180:183]
ds_read_b64_tr_b16 v[86:87], v14 offset:9216
v_cvt_pk_bf16_f32 v16, v128, v129
v_mfma_f32_16x16x32_bf16 v[176:179], v[92:95], v[100:103], v[176:179]
v_cvt_pk_bf16_f32 v17, v130, v131
v_cvt_pk_bf16_f32 v18, v144, v145
v_mfma_f32_16x16x32_bf16 v[176:179], v[88:91], v[96:99], v[176:179]
s_waitcnt lgkmcnt(8)
buffer_store_dwordx4 a[0:3], v1, s[44:47], s80 offen offset:3072 sc1
v_mfma_f32_16x16x32_bf16 v[192:195], v[64:67], v[96:99], v[192:195]
ds_read_b64_tr_b16 v[88:89], v15 offset:0
v_cvt_pk_bf16_f32 v19, v146, v147
v_mfma_f32_16x16x32_bf16 v[192:195], v[68:71], v[100:103], v[192:195]
ds_read_b64_tr_b16 v[90:91], v15 offset:1024
v_mfma_f32_16x16x32_bf16 v[196:199], v[68:71], v[108:111], v[196:199]
ds_read_b64_tr_b16 v[92:93], v15 offset:8192
v_mfma_f32_16x16x32_bf16 v[196:199], v[64:67], v[104:107], v[196:199]
ds_read_b64_tr_b16 v[94:95], v15 offset:9216
v_mfma_f32_16x16x32_bf16 v[200:203], v[64:67], v[112:115], v[200:203]
v_lshrrev_b32 v3, 1, v0
v_lshlrev_b32 v3, 7, v3
v_mfma_f32_16x16x32_bf16 v[200:203], v[68:71], v[116:119], v[200:203]
buffer_load_dword v4, v3, s[36:39], s93 offen
v_mfma_f32_16x16x32_bf16 v[204:207], v[68:71], v[124:127], v[204:207]
v_cvt_pk_bf16_f32 v52, v168, v169
v_cvt_pk_bf16_f32 v53, v170, v171
v_mfma_f32_16x16x32_bf16 v[204:207], v[64:67], v[120:123], v[204:207]
s_waitcnt lgkmcnt(8)
v_cvt_pk_bf16_f32 v54, v184, v185
v_cvt_pk_bf16_f32 v55, v186, v187
v_mfma_f32_16x16x32_bf16 v[220:223], v[72:75], v[120:123], v[220:223]
v_cvt_pk_bf16_f32 v36, v164, v165
v_cvt_pk_bf16_f32 v37, v166, v167
v_mfma_f32_16x16x32_bf16 v[220:223], v[76:79], v[124:127], v[220:223]
v_cvt_pk_bf16_f32 v38, v180, v181
v_cvt_pk_bf16_f32 v39, v182, v183
v_mfma_f32_16x16x32_bf16 v[216:219], v[76:79], v[116:119], v[216:219]
s_waitcnt vmcnt(21) lgkmcnt(0)
v_cvt_pk_bf16_f32 v20, v160, v161
v_cvt_pk_bf16_f32 v21, v162, v163
v_mfma_f32_16x16x32_bf16 v[216:219], v[72:75], v[112:115], v[216:219]
s_barrier
v_cvt_pk_bf16_f32 v22, v176, v177
v_cvt_pk_bf16_f32 v23, v178, v179
v_mfma_f32_16x16x32_bf16 v[212:215], v[72:75], v[104:107], v[212:215]
ds_read_b128 a[128:131], v2 offset:16384
v_cvt_pk_bf16_f32 v64, v140, v141
v_mfma_f32_16x16x32_bf16 v[212:215], v[76:79], v[108:111], v[212:215]
v_cvt_pk_bf16_f32 v65, v142, v143
v_cvt_pk_bf16_f32 v66, v156, v157
v_mfma_f32_16x16x32_bf16 v[208:211], v[76:79], v[100:103], v[208:211]
ds_read_b128 a[132:135], v2 offset:17408
v_cvt_pk_bf16_f32 v67, v158, v159
v_mfma_f32_16x16x32_bf16 v[208:211], v[72:75], v[96:99], v[208:211]
v_cvt_pk_bf16_f32 v68, v172, v173
v_cvt_pk_bf16_f32 v69, v174, v175
v_mfma_f32_16x16x32_bf16 v[224:227], v[80:83], v[96:99], v[224:227]
ds_read_b128 a[136:139], v2 offset:18432
v_cvt_pk_bf16_f32 v70, v188, v189
v_mfma_f32_16x16x32_bf16 v[224:227], v[84:87], v[100:103], v[224:227]
v_cvt_pk_bf16_f32 v71, v190, v191
v_mfma_f32_16x16x32_bf16 v[228:231], v[84:87], v[108:111], v[228:231]
ds_read_b128 a[140:143], v2 offset:19456
v_mfma_f32_16x16x32_bf16 v[228:231], v[80:83], v[104:107], v[228:231]
v_mfma_f32_16x16x32_bf16 v[232:235], v[80:83], v[112:115], v[232:235]
ds_read_b128 a[144:147], v2 offset:20480
v_cvt_pk_bf16_f32 v72, v204, v205
v_mfma_f32_16x16x32_bf16 v[232:235], v[84:87], v[116:119], v[232:235]
v_cvt_pk_bf16_f32 v73, v206, v207
v_cvt_pk_bf16_f32 v74, v220, v221
v_mfma_f32_16x16x32_bf16 v[236:239], v[84:87], v[124:127], v[236:239]
ds_read_b128 a[148:151], v2 offset:21504
v_cvt_pk_bf16_f32 v75, v222, v223
v_mfma_f32_16x16x32_bf16 v[236:239], v[80:83], v[120:123], v[236:239]
v_cvt_pk_bf16_f32 v56, v200, v201
v_cvt_pk_bf16_f32 v57, v202, v203
v_mfma_f32_16x16x32_bf16 v[252:255], v[88:91], v[120:123], v[252:255]
ds_read_b128 a[152:155], v2 offset:22528
v_cvt_pk_bf16_f32 v58, v216, v217
v_mfma_f32_16x16x32_bf16 v[252:255], v[92:95], v[124:127], v[252:255]
v_cvt_pk_bf16_f32 v59, v218, v219
v_cvt_pk_bf16_f32 v40, v196, v197
v_mfma_f32_16x16x32_bf16 v[248:251], v[92:95], v[116:119], v[248:251]
ds_read_b128 a[156:159], v2 offset:23552
v_cvt_pk_bf16_f32 v41, v198, v199
v_mfma_f32_16x16x32_bf16 v[248:251], v[88:91], v[112:115], v[248:251]
v_cvt_pk_bf16_f32 v42, v212, v213
v_cvt_pk_bf16_f32 v43, v214, v215
v_mfma_f32_16x16x32_bf16 v[244:247], v[88:91], v[104:107], v[244:247]
v_cvt_pk_bf16_f32 v24, v192, v193
v_cvt_pk_bf16_f32 v25, v194, v195
v_mfma_f32_16x16x32_bf16 v[244:247], v[92:95], v[108:111], v[244:247]
v_cvt_pk_bf16_f32 v26, v208, v209
v_cvt_pk_bf16_f32 v27, v210, v211
v_mfma_f32_16x16x32_bf16 v[240:243], v[92:95], v[100:103], v[240:243]
v_mfma_f32_16x16x32_bf16 v[240:243], v[88:91], v[96:99], v[240:243]
v_cvt_pk_bf16_f32 v76, v236, v237
v_cvt_pk_bf16_f32 v77, v238, v239
v_cvt_pk_bf16_f32 v78, v252, v253
v_cvt_pk_bf16_f32 v79, v254, v255
v_cvt_pk_bf16_f32 v60, v232, v233
v_cvt_pk_bf16_f32 v61, v234, v235
v_cvt_pk_bf16_f32 v62, v248, v249
v_cvt_pk_bf16_f32 v63, v250, v251
v_cvt_pk_bf16_f32 v44, v228, v229
v_cvt_pk_bf16_f32 v45, v230, v231
v_cvt_pk_bf16_f32 v46, v244, v245
v_cvt_pk_bf16_f32 v47, v246, v247
v_cvt_pk_bf16_f32 v28, v224, v225
v_cvt_pk_bf16_f32 v29, v226, v227
v_cvt_pk_bf16_f32 v30, v240, v241
v_cvt_pk_bf16_f32 v31, v242, v243
v_mov_b32 v124, 0xff800000
v_mov_b32 v125, 0xff800000
v_mov_b32 v126, 0xff800000
v_mov_b32 v127, 0xff800000
s_lshl_b32 s84, s60, 2
s_add_u32 s84, s84, s58
s_mov_b32 s86, 0
s_add_u32 s61, s65, s60
s_and_b32 s73, s60, 1
s_lshl_b32 s73, s73, 16
s_add_u32 s77, s73, s64
s_xor_b32 s73, s73, 0x10000
s_mov_b32 s92, s73
s_mul_i32 s62, s58, 4608
s_add_u32 s62, s62, 143104
s_add_u32 s73, s73, 49920
s_cmp_eq_u32 s58, 0
s_cselect_b32 s62, s73, s62
Lattn:
s_mov_b32 s82, 0x10000
s_waitcnt lgkmcnt(0)
v_mfma_f32_16x16x32_bf16 v[136:139], a[128:131], v[48:51], 0
ds_read_b128 a[160:163], v2 offset:24576
v_lshrrev_b32 v240, 4, v0
v_mfma_f32_16x16x32_bf16 v[136:139], a[132:135], v[52:55], v[136:139]
ds_read_b128 a[164:167], v2 offset:25600
v_and_b32 v241, 15, v0
v_mfma_f32_16x16x32_bf16 v[136:139], a[136:139], v[56:59], v[136:139]
ds_read_b128 a[168:171], v2 offset:26624
v_lshlrev_b32 v240, 2, v240
v_mfma_f32_16x16x32_bf16 v[136:139], a[140:143], v[60:63], v[136:139]
ds_read_b128 a[172:175], v2 offset:27648
v_sub_u32 v240, v241, v240
v_mfma_f32_16x16x32_bf16 v[140:143], a[140:143], v[76:79], 0
ds_read_b128 a[176:179], v2 offset:28672
v_mov_b32 v112, 0xff800000
v_mfma_f32_16x16x32_bf16 v[140:143], a[136:139], v[72:75], v[140:143]
ds_read_b128 a[180:183], v2 offset:29696
v_mov_b32 v113, 0xff800000
v_mfma_f32_16x16x32_bf16 v[140:143], a[132:135], v[68:71], v[140:143]
ds_read_b128 a[184:187], v2 offset:30720
v_mov_b32 v114, 0xff800000
v_mfma_f32_16x16x32_bf16 v[140:143], a[128:131], v[64:67], v[140:143]
ds_read_b128 a[188:191], v2 offset:31744
v_mov_b32 v115, 0xff800000
v_mfma_f32_16x16x32_bf16 v[156:159], a[144:147], v[64:67], 0
v_cmp_gt_i32 vcc, 0, v240
v_mov_b32 v120, 0x3f803f80
v_mfma_f32_16x16x32_bf16 v[156:159], a[148:151], v[68:71], v[156:159]
v_cndmask_b32 v116, 0, v112, vcc
v_cmp_gt_i32 vcc, 1, v240
v_mfma_f32_16x16x32_bf16 v[156:159], a[152:155], v[72:75], v[156:159]
v_mov_b32 v121, 0x3f803f80
v_cndmask_b32 v117, 0, v112, vcc
v_mfma_f32_16x16x32_bf16 v[156:159], a[156:159], v[76:79], v[156:159]
v_cmp_gt_i32 vcc, 2, v240
v_mov_b32 v122, 0x3f803f80
v_mfma_f32_16x16x32_bf16 v[152:155], a[156:159], v[60:63], 0
v_cndmask_b32 v118, 0, v112, vcc
v_cmp_gt_i32 vcc, 3, v240
v_mfma_f32_16x16x32_bf16 v[152:155], a[152:155], v[56:59], v[152:155]
v_mov_b32 v123, 0x3f803f80
v_cndmask_b32 v119, 0, v112, vcc
v_mfma_f32_16x16x32_bf16 v[152:155], a[148:151], v[52:55], v[152:155]
v_mov_b32 v228, 0
v_mov_b32 v229, 0
v_mfma_f32_16x16x32_bf16 v[152:155], a[144:147], v[48:51], v[152:155]
v_mov_b32 v230, 0
v_mov_b32 v231, 0
s_cmp_eq_u32 s84, 0
s_cbranch_scc1 Lta7
s_cmp_eq_u32 s84, 1
s_cbranch_scc1 Lnt8
v_mfma_f32_16x16x32_bf16 v[128:131], a[128:131], v[16:19], 0
Lstub0:
s_cbranch_execz Lstub4
v_mov_b32 v236, 0
v_mov_b32 v237, 0
v_mfma_f32_16x16x32_bf16 v[144:147], a[144:147], v[16:19], 0
v_mov_b32 v238, 0
v_mov_b32 v239, 0
s_branch Ljoin9
Lta7:
v_mfma_f32_16x16x32_bf16 v[128:131], a[128:131], v[16:19], v[116:119]
v_mov_b32 v236, 0
v_mov_b32 v237, 0
v_mfma_f32_16x16x32_bf16 v[144:147], a[144:147], v[16:19], v[112:115]
v_mov_b32 v238, 0
v_mov_b32 v239, 0
s_branch Ljoin9
Lnt8:
v_mfma_f32_16x16x32_bf16 v[128:131], a[128:131], v[16:19], 0
v_mov_b32 v236, 0
v_mov_b32 v237, 0
v_mfma_f32_16x16x32_bf16 v[144:147], a[144:147], v[16:19], v[116:119]
v_mov_b32 v238, 0
v_mov_b32 v239, 0
Ljoin9:
v_mfma_f32_16x16x32_bf16 v[128:131], a[132:135], v[20:23], v[128:131]
v_mfma_f32_16x16x32_bf16 v[128:131], a[136:139], v[24:27], v[128:131]
v_mfma_f32_16x16x32_bf16 v[128:131], a[140:143], v[28:31], v[128:131]
v_max3_f32 v240, v136, v137, v126
v_max3_f32 v242, v140, v141, v127
v_mfma_f32_16x16x32_bf16 v[132:135], a[140:143], v[44:47], 0
v_max3_f32 v240, v240, v138, v139
v_max3_f32 v242, v242, v142, v143
v_mfma_f32_16x16x32_bf16 v[132:135], a[136:139], v[40:43], v[132:135]
v_max3_f32 v240, v240, v152, v153
v_max3_f32 v242, v242, v156, v157
v_mfma_f32_16x16x32_bf16 v[132:135], a[132:135], v[36:39], v[132:135]
v_max3_f32 v240, v240, v154, v155
v_max3_f32 v242, v242, v158, v159
v_mfma_f32_16x16x32_bf16 v[132:135], a[128:131], v[32:35], v[132:135]
v_mov_b32 v241, v240
v_mov_b32 v243, v242
v_mfma_f32_16x16x32_bf16 v[148:151], a[144:147], v[32:35], 0
v_permlane16_swap_b32 v240, v241
v_permlane16_swap_b32 v242, v243
v_mfma_f32_16x16x32_bf16 v[148:151], a[148:151], v[36:39], v[148:151]
v_max_f32 v240, v240, v241
v_max_f32 v242, v242, v243
v_mfma_f32_16x16x32_bf16 v[148:151], a[152:155], v[40:43], v[148:151]
v_mov_b32 v241, v240
v_mov_b32 v243, v242
v_mfma_f32_16x16x32_bf16 v[148:151], a[156:159], v[44:47], v[148:151]
v_permlane32_swap_b32 v240, v241
v_permlane32_swap_b32 v242, v243
v_mfma_f32_16x16x32_bf16 v[144:147], a[156:159], v[28:31], v[144:147]
v_max_f32 v240, v240, v241
v_max_f32 v242, v242, v243
v_mfma_f32_16x16x32_bf16 v[144:147], a[152:155], v[24:27], v[144:147]
v_mfma_f32_16x16x32_bf16 v[144:147], a[148:151], v[20:23], v[144:147]
v_sub_f32 v88, 0, v240
v_sub_f32 v89, 0, v240
v_pk_add_f32 v[90:91], v[88:89], 0
v_pk_add_f32 v[104:105], v[116:117], v[88:89]
v_pk_add_f32 v[106:107], v[118:119], v[88:89]
v_pk_add_f32 v[136:137], v[136:137], v[88:89]
v_pk_add_f32 v[138:139], v[138:139], v[88:89]
v_pk_add_f32 v[152:153], v[152:153], v[88:89]
v_pk_add_f32 v[154:155], v[154:155], v[88:89]
v_sub_f32 v92, 0, v242
v_sub_f32 v93, 0, v242
v_pk_add_f32 v[94:95], v[92:93], 0
v_pk_add_f32 v[108:109], v[116:117], v[92:93]
v_pk_add_f32 v[110:111], v[118:119], v[92:93]
v_pk_add_f32 v[140:141], v[140:141], v[92:93]
v_pk_add_f32 v[142:143], v[142:143], v[92:93]
v_pk_add_f32 v[156:157], v[156:157], v[92:93]
v_pk_add_f32 v[158:159], v[158:159], v[92:93]
v_max3_f32 v240, v128, v129, v124
v_max3_f32 v242, v132, v133, v125
v_max3_f32 v240, v240, v130, v131
v_max3_f32 v242, v242, v134, v135
v_max3_f32 v240, v240, v144, v145
v_max3_f32 v242, v242, v148, v149
v_max3_f32 v240, v240, v146, v147
v_max3_f32 v242, v242, v150, v151
v_mov_b32 v241, v240
v_mov_b32 v243, v242
s_nop 0
v_permlane16_swap_b32 v240, v241
v_permlane16_swap_b32 v242, v243
v_max_f32 v240, v240, v241
v_max_f32 v242, v242, v243
v_mov_b32 v241, v240
v_mov_b32 v243, v242
s_nop 0
v_permlane32_swap_b32 v240, v241
v_permlane32_swap_b32 v242, v243
v_max_f32 v240, v240, v241
v_max_f32 v242, v242, v243
v_sub_f32 v80, 0, v240
v_sub_f32 v81, 0, v240
v_pk_add_f32 v[82:83], v[80:81], 0
v_pk_add_f32 v[96:97], v[116:117], v[80:81]
v_pk_add_f32 v[98:99], v[118:119], v[80:81]
v_pk_add_f32 v[128:129], v[128:129], v[80:81]
v_pk_add_f32 v[130:131], v[130:131], v[80:81]
v_pk_add_f32 v[144:145], v[144:145], v[80:81]
v_pk_add_f32 v[146:147], v[146:147], v[80:81]
v_sub_f32 v84, 0, v242
v_sub_f32 v85, 0, v242
v_pk_add_f32 v[86:87], v[84:85], 0
v_pk_add_f32 v[100:101], v[116:117], v[84:85]
v_pk_add_f32 v[102:103], v[118:119], v[84:85]
v_pk_add_f32 v[132:133], v[132:133], v[84:85]
v_pk_add_f32 v[134:135], v[134:135], v[84:85]
v_pk_add_f32 v[148:149], v[148:149], v[84:85]
v_pk_add_f32 v[150:151], v[150:151], v[84:85]
v_add_u32 v2, s82, v1
s_waitcnt vmcnt(13) lgkmcnt(0)
s_barrier
s_cmp_eq_u32 s60, 0
s_cbranch_scc1 LP0x
v_mfma_f32_16x16x32_bf16 v[164:167], a[160:163], v[32:35], v[84:87]
s_xor_b32 s74, s82, 0x10000
v_exp_f32 v128, v128
v_mfma_f32_16x16x32_bf16 v[164:167], a[164:167], v[36:39], v[164:167]
s_add_u32 s74, s74, s64
ds_read_b128 a[128:131], v2 offset:16384
ds_read_b128 a[132:135], v2 offset:17408
v_mfma_f32_16x16x32_bf16 v[164:167], a[168:171], v[40:43], v[164:167]
s_add_u32 s81, s81, 0x8000
v_exp_f32 v129, v129
v_mfma_f32_16x16x32_bf16 v[164:167], a[172:175], v[44:47], v[164:167]
s_add_u32 m0, s74, 16384
v_exp_f32 v130, v130
v_mfma_f32_16x16x32_bf16 v[172:175], a[172:175], v[76:79], v[92:95]
s_add_u32 s72, s81, 16384
v_exp_f32 v131, v131
v_mfma_f32_16x16x32_bf16 v[172:175], a[168:171], v[72:75], v[172:175]
v_exp_f32 v144, v144
v_mfma_f32_16x16x32_bf16 v[172:175], a[164:167], v[68:71], v[172:175]
s_nop 0
ds_read_b128 a[136:139], v2 offset:18432
ds_read_b128 a[140:143], v2 offset:19456
v_mfma_f32_16x16x32_bf16 v[172:175], a[160:163], v[64:67], v[172:175]
s_nop 0
ds_read_b128 a[144:147], v2 offset:20480
ds_read_b128 a[148:151], v2 offset:21504
v_mfma_f32_16x16x32_bf16 v[188:191], a[176:179], v[64:67], v[92:95]
s_nop 0
ds_read_b128 a[152:155], v2 offset:22528
ds_read_b128 a[156:159], v2 offset:23552
v_mfma_f32_16x16x32_bf16 v[188:191], a[180:183], v[68:71], v[188:191]
s_nop 0
ds_read_b128 a[192:195], v2 offset:0
ds_read_b128 a[196:199], v2 offset:1024
v_mfma_f32_16x16x32_bf16 v[188:191], a[184:187], v[72:75], v[188:191]
s_nop 0
ds_read_b128 a[200:203], v2 offset:2048
ds_read_b128 a[204:207], v2 offset:3072
v_mfma_f32_16x16x32_bf16 v[188:191], a[188:191], v[76:79], v[188:191]
s_nop 0
ds_read_b128 a[208:211], v2 offset:4096
ds_read_b128 a[212:215], v2 offset:5120
v_mfma_f32_16x16x32_bf16 v[180:183], a[188:191], v[44:47], v[84:87]
s_nop 0
ds_read_b128 a[216:219], v2 offset:6144
ds_read_b128 a[220:223], v2 offset:7168
v_mfma_f32_16x16x32_bf16 v[180:183], a[184:187], v[40:43], v[180:183]
v_cvt_pk_bf16_f32 v192, v128, v129
v_cvt_pk_bf16_f32 v193, v130, v131
v_mfma_f32_16x16x32_bf16 v[180:183], a[180:183], v[36:39], v[180:183]
buffer_load_dwordx4 v1, s[44:47], s72 offen sc1 lds
v_mfma_f32_16x16x32_bf16 v[180:183], a[176:179], v[32:35], v[180:183]
v_exp_f32 v145, v145
v_mfma_f32_16x16x32_bf16 v[160:163], a[160:163], v[16:19], v[80:83]
v_exp_f32 v146, v146
v_mfma_f32_16x16x32_bf16 v[160:163], a[164:167], v[20:23], v[160:163]
v_exp_f32 v147, v147
v_mfma_f32_16x16x32_bf16 v[160:163], a[168:171], v[24:27], v[160:163]
v_exp_f32 v136, v136
v_mfma_f32_16x16x32_bf16 v[160:163], a[172:175], v[28:31], v[160:163]
v_cvt_pk_bf16_f32 v194, v144, v145
v_cvt_pk_bf16_f32 v195, v146, v147
v_mfma_f32_16x16x32_bf16 v[168:171], a[172:175], v[60:63], v[88:91]
v_exp_f32 v137, v137
v_mfma_f32_16x16x32_bf16 v[168:171], a[168:171], v[56:59], v[168:171]
v_exp_f32 v138, v138
v_mfma_f32_16x16x32_bf16 v[168:171], a[164:167], v[52:55], v[168:171]
v_exp_f32 v139, v139
v_mfma_f32_16x16x32_bf16 v[168:171], a[160:163], v[48:51], v[168:171]
v_exp_f32 v152, v152
v_mfma_f32_16x16x32_bf16 v[184:187], a[176:179], v[48:51], v[88:91]
v_cvt_pk_bf16_f32 v200, v136, v137
v_cvt_pk_bf16_f32 v201, v138, v139
v_mfma_f32_16x16x32_bf16 v[184:187], a[180:183], v[52:55], v[184:187]
buffer_load_dwordx4 v1, s[44:47], s72 offen offset:1024 sc1 lds
v_mfma_f32_16x16x32_bf16 v[184:187], a[184:187], v[56:59], v[184:187]
v_exp_f32 v153, v153
v_mfma_f32_16x16x32_bf16 v[184:187], a[188:191], v[60:63], v[184:187]
v_exp_f32 v154, v154
v_mfma_f32_16x16x32_bf16 v[176:179], a[188:191], v[28:31], v[80:83]
v_exp_f32 v155, v155
v_mfma_f32_16x16x32_bf16 v[176:179], a[184:187], v[24:27], v[176:179]
buffer_load_dwordx4 v1, s[44:47], s72 offen offset:2048 sc1 lds
v_mfma_f32_16x16x32_bf16 v[176:179], a[180:183], v[20:23], v[176:179]
buffer_load_dwordx4 v1, s[44:47], s72 offen offset:3072 sc1 lds
v_mfma_f32_16x16x32_bf16 v[176:179], a[176:179], v[16:19], v[176:179]
s_waitcnt lgkmcnt(4)
v_exp_f32 v132, v132
v_cvt_pk_bf16_f32 v202, v152, v153
v_cvt_pk_bf16_f32 v203, v154, v155
v_exp_f32 v133, v133
v_exp_f32 v134, v134
v_cvt_pk_bf16_f32 v196, v132, v133
v_exp_f32 v135, v135
v_exp_f32 v148, v148
v_cvt_pk_bf16_f32 v197, v134, v135
v_exp_f32 v149, v149
v_exp_f32 v150, v150
v_cvt_pk_bf16_f32 v198, v148, v149
v_exp_f32 v151, v151
v_exp_f32 v140, v140
v_cvt_pk_bf16_f32 v199, v150, v151
v_exp_f32 v141, v141
v_exp_f32 v142, v142
v_cvt_pk_bf16_f32 v204, v140, v141
v_exp_f32 v143, v143
v_exp_f32 v156, v156
v_cvt_pk_bf16_f32 v205, v142, v143
v_exp_f32 v157, v157
v_exp_f32 v158, v158
v_cvt_pk_bf16_f32 v206, v156, v157
v_exp_f32 v159, v159
s_nop 0
v_cvt_pk_bf16_f32 v207, v158, v159
v_mfma_f32_16x16x32_bf16 v[224:227], v[120:123], v[192:195], 0
s_add_u32 s82, s82, 0x8000
ds_read_b128 a[160:163], v2 offset:24576
ds_read_b128 a[164:167], v2 offset:25600
v_mfma_f32_16x16x32_bf16 v[232:235], v[120:123], v[200:203], 0
s_and_b32 s82, s82, 0x1ffff
v_exp_f32 v164, v164
v_mfma_f32_16x16x32_bf16 a[0:3], a[192:195], v[192:195], 0
s_add_u32 m0, s74, 0
v_exp_f32 v165, v165
v_mfma_f32_16x16x32_bf16 a[64:67], a[192:195], v[200:203], 0
s_add_u32 s72, s81, 0
v_exp_f32 v166, v166
v_mfma_f32_16x16x32_bf16 a[68:71], a[196:199], v[200:203], 0
buffer_load_dwordx4 v1, s[44:47], s72 offen sc1 lds
v_mfma_f32_16x16x32_bf16 a[4:7], a[196:199], v[192:195], 0
v_exp_f32 v167, v167
v_mfma_f32_16x16x32_bf16 a[8:11], a[200:203], v[192:195], 0
ds_read_b128 a[168:171], v2 offset:26624
v_cvt_pk_bf16_f32 v212, v164, v165
v_mfma_f32_16x16x32_bf16 a[72:75], a[200:203], v[200:203], 0
v_exp_f32 v180, v180
v_mfma_f32_16x16x32_bf16 a[76:79], a[204:207], v[200:203], 0
v_exp_f32 v181, v181
v_mfma_f32_16x16x32_bf16 a[12:15], a[204:207], v[192:195], 0
s_waitcnt lgkmcnt(3)
ds_read_b128 a[172:175], v2 offset:27648
v_cvt_pk_bf16_f32 v213, v166, v167
v_mfma_f32_16x16x32_bf16 a[16:19], a[208:211], v[192:195], 0
v_exp_f32 v182, v182
v_mfma_f32_16x16x32_bf16 a[80:83], a[208:211], v[200:203], 0
buffer_load_dwordx4 v1, s[44:47], s72 offen offset:1024 sc1 lds
v_mfma_f32_16x16x32_bf16 a[84:87], a[212:215], v[200:203], 0
v_exp_f32 v183, v183
v_mfma_f32_16x16x32_bf16 a[20:23], a[212:215], v[192:195], 0
s_nop 0
ds_read_b128 a[176:179], v2 offset:28672
ds_read_b128 a[180:183], v2 offset:29696
v_mfma_f32_16x16x32_bf16 a[24:27], a[216:219], v[192:195], 0
v_exp_f32 v172, v172
v_mfma_f32_16x16x32_bf16 a[88:91], a[216:219], v[200:203], 0
s_nop 0
ds_read_b128 a[184:187], v2 offset:30720
ds_read_b128 a[188:191], v2 offset:31744
v_mfma_f32_16x16x32_bf16 a[92:95], a[220:223], v[200:203], 0
s_nop 0
ds_read_b128 a[224:227], v2 offset:8192
ds_read_b128 a[228:231], v2 offset:9216
v_mfma_f32_16x16x32_bf16 a[28:31], a[220:223], v[192:195], 0
s_nop 0
ds_read_b128 a[232:235], v2 offset:10240
ds_read_b128 a[236:239], v2 offset:11264
v_mfma_f32_16x16x32_bf16 v[128:131], a[128:131], v[16:19], v[80:83]
s_nop 0
ds_read_b128 a[240:243], v2 offset:12288
ds_read_b128 a[244:247], v2 offset:13312
v_mfma_f32_16x16x32_bf16 v[128:131], a[132:135], v[20:23], v[128:131]
s_nop 0
ds_read_b128 a[248:251], v2 offset:14336
ds_read_b128 a[252:255], v2 offset:15360
v_mfma_f32_16x16x32_bf16 v[128:131], a[136:139], v[24:27], v[128:131]
v_cvt_pk_bf16_f32 v214, v180, v181
v_cvt_pk_bf16_f32 v215, v182, v183
v_mfma_f32_16x16x32_bf16 v[128:131], a[140:143], v[28:31], v[128:131]
v_exp_f32 v173, v173
v_mfma_f32_16x16x32_bf16 v[136:139], a[140:143], v[60:63], v[88:91]
v_exp_f32 v174, v174
v_mfma_f32_16x16x32_bf16 v[136:139], a[136:139], v[56:59], v[136:139]
buffer_load_dwordx4 v1, s[44:47], s72 offen offset:2048 sc1 lds
v_mfma_f32_16x16x32_bf16 v[136:139], a[132:135], v[52:55], v[136:139]
v_exp_f32 v175, v175
v_mfma_f32_16x16x32_bf16 v[136:139], a[128:131], v[48:51], v[136:139]
v_exp_f32 v188, v188
v_mfma_f32_16x16x32_bf16 v[152:155], a[144:147], v[48:51], v[88:91]
v_cvt_pk_bf16_f32 v220, v172, v173
v_cvt_pk_bf16_f32 v221, v174, v175
v_mfma_f32_16x16x32_bf16 v[152:155], a[148:151], v[52:55], v[152:155]
v_exp_f32 v189, v189
v_mfma_f32_16x16x32_bf16 v[152:155], a[152:155], v[56:59], v[152:155]
v_exp_f32 v190, v190
v_mfma_f32_16x16x32_bf16 v[152:155], a[156:159], v[60:63], v[152:155]
buffer_load_dwordx4 v1, s[44:47], s72 offen offset:3072 sc1 lds
v_mfma_f32_16x16x32_bf16 v[144:147], a[156:159], v[28:31], v[80:83]
s_add_u32 s66, s58, 1
v_exp_f32 v191, v191
v_mfma_f32_16x16x32_bf16 v[144:147], a[152:155], v[24:27], v[144:147]
s_and_b32 s66, s66, 3
v_exp_f32 v160, v160
v_mfma_f32_16x16x32_bf16 v[144:147], a[148:151], v[20:23], v[144:147]
s_mul_i32 s66, s66, 4160
v_cvt_pk_bf16_f32 v222, v188, v189
v_cvt_pk_bf16_f32 v223, v190, v191
v_mfma_f32_16x16x32_bf16 v[144:147], a[144:147], v[16:19], v[144:147]
s_add_u32 m0, s66, 131104
v_exp_f32 v161, v161
v_mfma_f32_16x16x32_bf16 v[132:135], a[128:131], v[32:35], v[84:87]
s_add_u32 s72, s93, 0x2
buffer_load_dwordx4 v1, s[36:39], s72 offen lds
v_mfma_f32_16x16x32_bf16 v[132:135], a[132:135], v[36:39], v[132:135]
v_exp_f32 v162, v162
v_mfma_f32_16x16x32_bf16 v[132:135], a[136:139], v[40:43], v[132:135]
v_exp_f32 v163, v163
v_mfma_f32_16x16x32_bf16 v[132:135], a[140:143], v[44:47], v[132:135]
v_exp_f32 v176, v176
v_mfma_f32_16x16x32_bf16 v[140:143], a[140:143], v[76:79], v[92:95]
v_cvt_pk_bf16_f32 v208, v160, v161
v_cvt_pk_bf16_f32 v209, v162, v163
v_mfma_f32_16x16x32_bf16 v[140:143], a[136:139], v[72:75], v[140:143]
v_exp_f32 v177, v177
v_mfma_f32_16x16x32_bf16 v[140:143], a[132:135], v[68:71], v[140:143]
buffer_load_dwordx4 v1, s[36:39], s72 offen offset:1024 lds
v_mfma_f32_16x16x32_bf16 v[140:143], a[128:131], v[64:67], v[140:143]
v_exp_f32 v178, v178
v_mfma_f32_16x16x32_bf16 v[156:159], a[144:147], v[64:67], v[92:95]
v_exp_f32 v179, v179
v_mfma_f32_16x16x32_bf16 v[156:159], a[148:151], v[68:71], v[156:159]
v_exp_f32 v168, v168
v_mfma_f32_16x16x32_bf16 v[156:159], a[152:155], v[72:75], v[156:159]
v_cvt_pk_bf16_f32 v210, v176, v177
v_cvt_pk_bf16_f32 v211, v178, v179
v_mfma_f32_16x16x32_bf16 v[156:159], a[156:159], v[76:79], v[156:159]
v_exp_f32 v169, v169
v_mfma_f32_16x16x32_bf16 v[148:151], a[156:159], v[44:47], v[84:87]
buffer_load_dwordx4 v1, s[36:39], s72 offen offset:2048 lds
v_mfma_f32_16x16x32_bf16 v[148:151], a[152:155], v[40:43], v[148:151]
buffer_load_dwordx4 v1, s[36:39], s72 offen offset:3072 lds
v_mfma_f32_16x16x32_bf16 v[148:151], a[148:151], v[36:39], v[148:151]
s_waitcnt vmcnt(12) lgkmcnt(4)
v_exp_f32 v170, v170
v_mfma_f32_16x16x32_bf16 v[148:151], a[144:147], v[32:35], v[148:151]
s_barrier
v_exp_f32 v171, v171
v_add_u32 v2, s82, v1
v_cvt_pk_bf16_f32 v216, v168, v169
v_exp_f32 v184, v184
v_cvt_pk_bf16_f32 v217, v170, v171
v_exp_f32 v185, v185
v_exp_f32 v186, v186
v_cvt_pk_bf16_f32 v218, v184, v185
v_exp_f32 v187, v187
s_nop 0
v_cvt_pk_bf16_f32 v219, v186, v187
s_lshl_b32 s75, s59, 4
s_and_b32 s76, s84, 15
s_add_u32 s75, s75, s76
s_lshl_b32 s75, s75, 14
s_cmp_ge_u32 s60, 4
s_cselect_b32 s75, s75, 0x40001000
s_lshl_b32 s83, s60, 1
s_sub_u32 s83, 2, s83
s_cmp_eq_u32 s83, 0
s_cbranch_scc1 LLT1
.p2align 5
s_nop 0
s_nop 0
LloopI:
v_mfma_f32_16x16x32_bf16 v[228:231], v[120:123], v[196:199], v[228:231]
s_xor_b32 s74, s82, 0x10000
v_exp_f32 v128, v128
v_mfma_f32_16x16x32_bf16 v[228:231], v[120:123], v[212:215], v[228:231]
s_add_u32 s74, s74, s64
ds_read_b128 a[128:131], v2 offset:16384
v_add_u32 v15, s75, v3
v_mfma_f32_16x16x32_bf16 v[236:239], v[120:123], v[204:207], v[236:239]
s_add_u32 s81, s81, 0x8000
v_exp_f32 v129, v129
v_mfma_f32_16x16x32_bf16 v[236:239], v[120:123], v[220:223], v[236:239]
s_add_u32 m0, s74, 16384
v_exp_f32 v130, v130
v_mfma_f32_16x16x32_bf16 a[32:35], a[192:195], v[196:199], a[32:35]
s_add_u32 s72, s81, 16384
ds_read_b128 a[132:135], v2 offset:17408
v_cvt_pk_bf16_f32 v192, v128, v129
v_mfma_f32_16x16x32_bf16 a[32:35], a[224:227], v[212:215], a[32:35]
v_exp_f32 v131, v131
v_mfma_f32_16x16x32_bf16 a[96:99], a[224:227], v[220:223], a[96:99]
v_exp_f32 v144, v144
v_mfma_f32_16x16x32_bf16 a[96:99], a[192:195], v[204:207], a[96:99]
ds_read_b128 a[136:139], v2 offset:18432
v_cvt_pk_bf16_f32 v193, v130, v131
v_mfma_f32_16x16x32_bf16 a[100:103], a[196:199], v[204:207], a[100:103]
buffer_load_dwordx4 v1, s[44:47], s72 offen sc1 lds
v_mfma_f32_16x16x32_bf16 a[100:103], a[228:231], v[220:223], a[100:103]
v_exp_f32 v145, v145
v_mfma_f32_16x16x32_bf16 a[36:39], a[228:231], v[212:215], a[36:39]
v_exp_f32 v146, v146
v_mfma_f32_16x16x32_bf16 a[36:39], a[196:199], v[196:199], a[36:39]
ds_read_b128 a[140:143], v2 offset:19456
v_cvt_pk_bf16_f32 v194, v144, v145
v_mfma_f32_16x16x32_bf16 a[40:43], a[200:203], v[196:199], a[40:43]
v_exp_f32 v147, v147
v_mfma_f32_16x16x32_bf16 a[40:43], a[232:235], v[212:215], a[40:43]
v_exp_f32 v136, v136
v_mfma_f32_16x16x32_bf16 a[104:107], a[232:235], v[220:223], a[104:107]
ds_read_b128 a[144:147], v2 offset:20480
v_cvt_pk_bf16_f32 v195, v146, v147
v_mfma_f32_16x16x32_bf16 a[104:107], a[200:203], v[204:207], a[104:107]
v_exp_f32 v137, v137
v_mfma_f32_16x16x32_bf16 a[108:111], a[204:207], v[204:207], a[108:111]
v_exp_f32 v138, v138
v_mfma_f32_16x16x32_bf16 a[108:111], a[236:239], v[220:223], a[108:111]
ds_read_b128 a[148:151], v2 offset:21504
v_cvt_pk_bf16_f32 v200, v136, v137
v_mfma_f32_16x16x32_bf16 a[44:47], a[236:239], v[212:215], a[44:47]
v_exp_f32 v139, v139
v_mfma_f32_16x16x32_bf16 a[44:47], a[204:207], v[196:199], a[44:47]
v_exp_f32 v152, v152
v_mfma_f32_16x16x32_bf16 a[48:51], a[208:211], v[196:199], a[48:51]
s_waitcnt lgkmcnt(6)
ds_read_b128 a[152:155], v2 offset:22528
v_cvt_pk_bf16_f32 v201, v138, v139
v_mfma_f32_16x16x32_bf16 a[48:51], a[240:243], v[212:215], a[48:51]
buffer_load_dwordx4 v1, s[44:47], s72 offen offset:1024 sc1 lds
v_mfma_f32_16x16x32_bf16 a[112:115], a[240:243], v[220:223], a[112:115]
v_exp_f32 v153, v153
v_mfma_f32_16x16x32_bf16 a[112:115], a[208:211], v[204:207], a[112:115]
v_exp_f32 v154, v154
v_mfma_f32_16x16x32_bf16 a[116:119], a[212:215], v[204:207], a[116:119]
ds_read_b128 a[156:159], v2 offset:23552
v_cvt_pk_bf16_f32 v202, v152, v153
v_mfma_f32_16x16x32_bf16 a[116:119], a[244:247], v[220:223], a[116:119]
v_exp_f32 v155, v155
v_mfma_f32_16x16x32_bf16 a[52:55], a[244:247], v[212:215], a[52:55]
v_exp_f32 v132, v132
v_mfma_f32_16x16x32_bf16 a[52:55], a[212:215], v[196:199], a[52:55]
ds_read_b128 a[192:195], v2 offset:0
v_cvt_pk_bf16_f32 v203, v154, v155
v_mfma_f32_16x16x32_bf16 a[56:59], a[216:219], v[196:199], a[56:59]
v_exp_f32 v133, v133
v_mfma_f32_16x16x32_bf16 a[56:59], a[248:251], v[212:215], a[56:59]
v_exp_f32 v134, v134
v_mfma_f32_16x16x32_bf16 a[120:123], a[248:251], v[220:223], a[120:123]
ds_read_b128 a[196:199], v2 offset:1024
v_mfma_f32_16x16x32_bf16 a[120:123], a[216:219], v[204:207], a[120:123]
v_exp_f32 v135, v135
v_mfma_f32_16x16x32_bf16 a[124:127], a[220:223], v[204:207], a[124:127]
v_exp_f32 v148, v148
v_mfma_f32_16x16x32_bf16 a[124:127], a[252:255], v[220:223], a[124:127]
ds_read_b128 a[200:203], v2 offset:2048
v_mfma_f32_16x16x32_bf16 a[60:63], a[252:255], v[212:215], a[60:63]
buffer_load_dwordx4 v1, s[44:47], s72 offen offset:2048 sc1 lds
v_mfma_f32_16x16x32_bf16 a[60:63], a[220:223], v[196:199], a[60:63]
ds_read_b128 a[204:207], v2 offset:3072
v_cvt_pk_bf16_f32 v196, v132, v133
v_mfma_f32_16x16x32_bf16 v[164:167], a[160:163], v[32:35], v[84:87]
v_exp_f32 v149, v149
v_mfma_f32_16x16x32_bf16 v[164:167], a[164:167], v[36:39], v[164:167]
v_exp_f32 v150, v150
v_mfma_f32_16x16x32_bf16 v[164:167], a[168:171], v[40:43], v[164:167]
ds_read_b128 a[208:211], v2 offset:4096
v_cvt_pk_bf16_f32 v197, v134, v135
v_mfma_f32_16x16x32_bf16 v[164:167], a[172:175], v[44:47], v[164:167]
v_exp_f32 v151, v151
v_mfma_f32_16x16x32_bf16 v[172:175], a[172:175], v[76:79], v[92:95]
v_exp_f32 v140, v140
v_mfma_f32_16x16x32_bf16 v[172:175], a[168:171], v[72:75], v[172:175]
ds_read_b128 a[212:215], v2 offset:5120
v_cvt_pk_bf16_f32 v198, v148, v149
v_mfma_f32_16x16x32_bf16 v[172:175], a[164:167], v[68:71], v[172:175]
v_exp_f32 v141, v141
v_mfma_f32_16x16x32_bf16 v[172:175], a[160:163], v[64:67], v[172:175]
v_exp_f32 v142, v142
v_mfma_f32_16x16x32_bf16 v[188:191], a[176:179], v[64:67], v[92:95]
ds_read_b128 a[216:219], v2 offset:6144
v_cvt_pk_bf16_f32 v199, v150, v151
v_mfma_f32_16x16x32_bf16 v[188:191], a[180:183], v[68:71], v[188:191]
v_exp_f32 v143, v143
v_mfma_f32_16x16x32_bf16 v[188:191], a[184:187], v[72:75], v[188:191]
v_exp_f32 v156, v156
v_mfma_f32_16x16x32_bf16 v[188:191], a[188:191], v[76:79], v[188:191]
ds_read_b128 a[220:223], v2 offset:7168
v_cvt_pk_bf16_f32 v204, v140, v141
v_mfma_f32_16x16x32_bf16 v[180:183], a[188:191], v[44:47], v[84:87]
buffer_load_dwordx4 v1, s[44:47], s72 offen offset:3072 sc1 lds
v_mfma_f32_16x16x32_bf16 v[180:183], a[184:187], v[40:43], v[180:183]
v_exp_f32 v157, v157
v_mfma_f32_16x16x32_bf16 v[180:183], a[180:183], v[36:39], v[180:183]
v_exp_f32 v158, v158
v_mfma_f32_16x16x32_bf16 v[180:183], a[176:179], v[32:35], v[180:183]
v_cvt_pk_bf16_f32 v205, v142, v143
v_cvt_pk_bf16_f32 v206, v156, v157
v_mfma_f32_16x16x32_bf16 v[160:163], a[160:163], v[16:19], v[80:83]
v_exp_f32 v159, v159
v_mfma_f32_16x16x32_bf16 v[160:163], a[164:167], v[20:23], v[160:163]
v_cvt_pk_bf16_f32 v207, v158, v159
v_mfma_f32_16x16x32_bf16 v[160:163], a[168:171], v[24:27], v[160:163]
v_mfma_f32_16x16x32_bf16 v[160:163], a[172:175], v[28:31], v[160:163]
v_mfma_f32_16x16x32_bf16 v[168:171], a[172:175], v[60:63], v[88:91]
v_mfma_f32_16x16x32_bf16 v[168:171], a[168:171], v[56:59], v[168:171]
v_mfma_f32_16x16x32_bf16 v[168:171], a[164:167], v[52:55], v[168:171]
v_mfma_f32_16x16x32_bf16 v[168:171], a[160:163], v[48:51], v[168:171]
v_mfma_f32_16x16x32_bf16 v[184:187], a[176:179], v[48:51], v[88:91]
v_mfma_f32_16x16x32_bf16 v[184:187], a[180:183], v[52:55], v[184:187]
v_mfma_f32_16x16x32_bf16 v[184:187], a[184:187], v[56:59], v[184:187]
v_mfma_f32_16x16x32_bf16 v[184:187], a[188:191], v[60:63], v[184:187]
v_mfma_f32_16x16x32_bf16 v[176:179], a[188:191], v[28:31], v[80:83]
v_mfma_f32_16x16x32_bf16 v[176:179], a[184:187], v[24:27], v[176:179]
v_mfma_f32_16x16x32_bf16 v[176:179], a[180:183], v[20:23], v[176:179]
v_mfma_f32_16x16x32_bf16 v[176:179], a[176:179], v[16:19], v[176:179]
s_waitcnt lgkmcnt(4)
v_mfma_f32_16x16x32_bf16 v[224:227], v[120:123], v[208:211], v[224:227]
s_add_u32 s82, s82, 0x8000
ds_read_b128 a[160:163], v2 offset:24576
v_mfma_f32_16x16x32_bf16 v[224:227], v[120:123], v[192:195], v[224:227]
s_and_b32 s82, s82, 0x1ffff
v_exp_f32 v164, v164
v_mfma_f32_16x16x32_bf16 v[232:235], v[120:123], v[216:219], v[232:235]
s_add_u32 m0, s74, 0
v_exp_f32 v165, v165
v_mfma_f32_16x16x32_bf16 v[232:235], v[120:123], v[200:203], v[232:235]
s_add_u32 s72, s81, 0
ds_read_b128 a[164:167], v2 offset:25600
v_cvt_pk_bf16_f32 v212, v164, v165
v_mfma_f32_16x16x32_bf16 a[0:3], a[224:227], v[208:211], a[0:3]
v_exp_f32 v166, v166
v_mfma_f32_16x16x32_bf16 a[0:3], a[192:195], v[192:195], a[0:3]
v_exp_f32 v167, v167
v_mfma_f32_16x16x32_bf16 a[64:67], a[192:195], v[200:203], a[64:67]
buffer_load_dwordx4 v1, s[44:47], s72 offen sc1 lds
v_mfma_f32_16x16x32_bf16 a[64:67], a[224:227], v[216:219], a[64:67]
ds_read_b128 a[168:171], v2 offset:26624
v_cvt_pk_bf16_f32 v213, v166, v167
v_mfma_f32_16x16x32_bf16 a[68:71], a[228:231], v[216:219], a[68:71]
v_exp_f32 v180, v180
v_mfma_f32_16x16x32_bf16 a[68:71], a[196:199], v[200:203], a[68:71]
v_exp_f32 v181, v181
v_mfma_f32_16x16x32_bf16 a[4:7], a[196:199], v[192:195], a[4:7]
ds_read_b128 a[172:175], v2 offset:27648
v_cvt_pk_bf16_f32 v214, v180, v181
v_mfma_f32_16x16x32_bf16 a[4:7], a[228:231], v[208:211], a[4:7]
v_exp_f32 v182, v182
v_mfma_f32_16x16x32_bf16 a[8:11], a[232:235], v[208:211], a[8:11]
v_exp_f32 v183, v183
v_mfma_f32_16x16x32_bf16 a[8:11], a[200:203], v[192:195], a[8:11]
ds_read_b128 a[176:179], v2 offset:28672
v_cvt_pk_bf16_f32 v215, v182, v183
v_mfma_f32_16x16x32_bf16 a[72:75], a[200:203], v[200:203], a[72:75]
v_exp_f32 v172, v172
v_mfma_f32_16x16x32_bf16 a[72:75], a[232:235], v[216:219], a[72:75]
v_exp_f32 v173, v173
v_mfma_f32_16x16x32_bf16 a[76:79], a[236:239], v[216:219], a[76:79]
ds_read_b128 a[180:183], v2 offset:29696
v_cvt_pk_bf16_f32 v220, v172, v173
v_mfma_f32_16x16x32_bf16 a[76:79], a[204:207], v[200:203], a[76:79]
buffer_load_dwordx4 v1, s[44:47], s72 offen offset:1024 sc1 lds
v_mfma_f32_16x16x32_bf16 a[12:15], a[204:207], v[192:195], a[12:15]
v_exp_f32 v174, v174
v_mfma_f32_16x16x32_bf16 a[12:15], a[236:239], v[208:211], a[12:15]
v_exp_f32 v175, v175
v_mfma_f32_16x16x32_bf16 a[16:19], a[240:243], v[208:211], a[16:19]
s_waitcnt lgkmcnt(6)
ds_read_b128 a[184:187], v2 offset:30720
v_cvt_pk_bf16_f32 v221, v174, v175
v_mfma_f32_16x16x32_bf16 a[16:19], a[208:211], v[192:195], a[16:19]
v_exp_f32 v188, v188
v_mfma_f32_16x16x32_bf16 a[80:83], a[208:211], v[200:203], a[80:83]
v_exp_f32 v189, v189
v_mfma_f32_16x16x32_bf16 a[80:83], a[240:243], v[216:219], a[80:83]
ds_read_b128 a[188:191], v2 offset:31744
v_cvt_pk_bf16_f32 v222, v188, v189
v_mfma_f32_16x16x32_bf16 a[84:87], a[244:247], v[216:219], a[84:87]
v_exp_f32 v190, v190
v_mfma_f32_16x16x32_bf16 a[84:87], a[212:215], v[200:203], a[84:87]
v_exp_f32 v191, v191
v_mfma_f32_16x16x32_bf16 a[20:23], a[212:215], v[192:195], a[20:23]
ds_read_b128 a[224:227], v2 offset:8192
v_cvt_pk_bf16_f32 v223, v190, v191
v_mfma_f32_16x16x32_bf16 a[20:23], a[244:247], v[208:211], a[20:23]
v_exp_f32 v160, v160
v_mfma_f32_16x16x32_bf16 a[24:27], a[248:251], v[208:211], a[24:27]
buffer_load_dwordx4 v1, s[44:47], s72 offen offset:2048 sc1 lds
v_mfma_f32_16x16x32_bf16 a[24:27], a[216:219], v[192:195], a[24:27]
v_exp_f32 v161, v161
v_mfma_f32_16x16x32_bf16 a[88:91], a[216:219], v[200:203], a[88:91]
ds_read_b128 a[228:231], v2 offset:9216
v_mfma_f32_16x16x32_bf16 a[88:91], a[248:251], v[216:219], a[88:91]
v_exp_f32 v162, v162
v_mfma_f32_16x16x32_bf16 a[92:95], a[252:255], v[216:219], a[92:95]
v_exp_f32 v163, v163
v_mfma_f32_16x16x32_bf16 a[92:95], a[220:223], v[200:203], a[92:95]
ds_read_b128 a[232:235], v2 offset:10240
v_mfma_f32_16x16x32_bf16 a[28:31], a[220:223], v[192:195], a[28:31]
v_exp_f32 v176, v176
v_mfma_f32_16x16x32_bf16 a[28:31], a[252:255], v[208:211], a[28:31]
ds_read_b128 a[236:239], v2 offset:11264
v_cvt_pk_bf16_f32 v208, v160, v161
v_mfma_f32_16x16x32_bf16 v[128:131], a[128:131], v[16:19], v[80:83]
v_exp_f32 v177, v177
v_mfma_f32_16x16x32_bf16 v[128:131], a[132:135], v[20:23], v[128:131]
v_exp_f32 v178, v178
v_mfma_f32_16x16x32_bf16 v[128:131], a[136:139], v[24:27], v[128:131]
Lstub1:
s_cbranch_execz Lstub5
ds_read_b128 a[240:243], v2 offset:12288
v_cvt_pk_bf16_f32 v209, v162, v163
v_mfma_f32_16x16x32_bf16 v[128:131], a[140:143], v[28:31], v[128:131]
buffer_load_dwordx4 v1, s[44:47], s72 offen offset:3072 sc1 lds
v_mfma_f32_16x16x32_bf16 v[136:139], a[140:143], v[60:63], v[88:91]
s_add_u32 s75, s75, 0x1000
v_exp_f32 v179, v179
v_mfma_f32_16x16x32_bf16 v[136:139], a[136:139], v[56:59], v[136:139]
s_and_b32 s76, s75, 0x3000
v_exp_f32 v168, v168
v_mfma_f32_16x16x32_bf16 v[136:139], a[132:135], v[52:55], v[136:139]
s_cselect_b32 s75, s75, 0x40001000
ds_read_b128 a[244:247], v2 offset:13312
v_cvt_pk_bf16_f32 v210, v176, v177
v_mfma_f32_16x16x32_bf16 v[136:139], a[128:131], v[48:51], v[136:139]
v_exp_f32 v169, v169
v_mfma_f32_16x16x32_bf16 v[152:155], a[144:147], v[48:51], v[88:91]
v_exp_f32 v170, v170
v_mfma_f32_16x16x32_bf16 v[152:155], a[148:151], v[52:55], v[152:155]
ds_read_b128 a[248:251], v2 offset:14336
v_cvt_pk_bf16_f32 v211, v178, v179
v_mfma_f32_16x16x32_bf16 v[152:155], a[152:155], v[56:59], v[152:155]
v_exp_f32 v171, v171
v_mfma_f32_16x16x32_bf16 v[152:155], a[156:159], v[60:63], v[152:155]
v_exp_f32 v184, v184
v_mfma_f32_16x16x32_bf16 v[144:147], a[156:159], v[28:31], v[80:83]
ds_read_b128 a[252:255], v2 offset:15360
v_cvt_pk_bf16_f32 v216, v168, v169
v_mfma_f32_16x16x32_bf16 v[144:147], a[152:155], v[24:27], v[144:147]
buffer_load_dword v4, v15, s[24:27], 0 offen
v_mfma_f32_16x16x32_bf16 v[144:147], a[148:151], v[20:23], v[144:147]
v_exp_f32 v185, v185
v_mfma_f32_16x16x32_bf16 v[144:147], a[144:147], v[16:19], v[144:147]
v_exp_f32 v186, v186
v_mfma_f32_16x16x32_bf16 v[132:135], a[128:131], v[32:35], v[84:87]
v_cvt_pk_bf16_f32 v217, v170, v171
v_cvt_pk_bf16_f32 v218, v184, v185
v_mfma_f32_16x16x32_bf16 v[132:135], a[132:135], v[36:39], v[132:135]
v_exp_f32 v187, v187
v_mfma_f32_16x16x32_bf16 v[132:135], a[136:139], v[40:43], v[132:135]
v_cvt_pk_bf16_f32 v219, v186, v187
v_add_u32 v2, s82, v1
v_mfma_f32_16x16x32_bf16 v[132:135], a[140:143], v[44:47], v[132:135]
v_mfma_f32_16x16x32_bf16 v[140:143], a[140:143], v[76:79], v[92:95]
v_mfma_f32_16x16x32_bf16 v[140:143], a[136:139], v[72:75], v[140:143]
v_mfma_f32_16x16x32_bf16 v[140:143], a[132:135], v[68:71], v[140:143]
v_mfma_f32_16x16x32_bf16 v[140:143], a[128:131], v[64:67], v[140:143]
v_mfma_f32_16x16x32_bf16 v[156:159], a[144:147], v[64:67], v[92:95]
v_mfma_f32_16x16x32_bf16 v[156:159], a[148:151], v[68:71], v[156:159]
v_mfma_f32_16x16x32_bf16 v[156:159], a[152:155], v[72:75], v[156:159]
v_mfma_f32_16x16x32_bf16 v[156:159], a[156:159], v[76:79], v[156:159]
v_mfma_f32_16x16x32_bf16 v[148:151], a[156:159], v[44:47], v[84:87]
s_waitcnt vmcnt(9) lgkmcnt(4)
v_mfma_f32_16x16x32_bf16 v[148:151], a[152:155], v[40:43], v[148:151]
s_barrier
v_mfma_f32_16x16x32_bf16 v[148:151], a[148:151], v[36:39], v[148:151]
s_add_u32 s83, s83, 1
v_mfma_f32_16x16x32_bf16 v[148:151], a[144:147], v[32:35], v[148:151]
s_cbranch_scc0 LloopI
LLT1:
Lstub2:
s_cbranch_execz Lstub6
v_mfma_f32_16x16x32_bf16 v[228:231], v[120:123], v[196:199], v[228:231]
s_xor_b32 s74, s82, 0x10000
v_exp_f32 v128, v128
v_mfma_f32_16x16x32_bf16 v[228:231], v[120:123], v[212:215], v[228:231]
s_add_u32 s74, s74, s64
ds_read_b128 a[128:131], v2 offset:16384
v_mfma_f32_16x16x32_bf16 v[236:239], v[120:123], v[204:207], v[236:239]
s_add_u32 s81, s81, 0x8000
v_exp_f32 v129, v129
v_mfma_f32_16x16x32_bf16 v[236:239], v[120:123], v[220:223], v[236:239]
s_add_u32 m0, s74, 16384
v_exp_f32 v130, v130
v_mfma_f32_16x16x32_bf16 a[32:35], a[192:195], v[196:199], a[32:35]
s_add_u32 s72, s81, 16384
ds_read_b128 a[132:135], v2 offset:17408
v_cvt_pk_bf16_f32 v192, v128, v129
v_mfma_f32_16x16x32_bf16 a[32:35], a[224:227], v[212:215], a[32:35]
v_exp_f32 v131, v131
v_mfma_f32_16x16x32_bf16 a[96:99], a[224:227], v[220:223], a[96:99]
v_exp_f32 v144, v144
v_mfma_f32_16x16x32_bf16 a[96:99], a[192:195], v[204:207], a[96:99]
ds_read_b128 a[136:139], v2 offset:18432
v_cvt_pk_bf16_f32 v193, v130, v131
v_mfma_f32_16x16x32_bf16 a[100:103], a[196:199], v[204:207], a[100:103]
buffer_load_dwordx4 v1, s[44:47], s72 offen sc1 lds
v_mfma_f32_16x16x32_bf16 a[100:103], a[228:231], v[220:223], a[100:103]
v_exp_f32 v145, v145
v_mfma_f32_16x16x32_bf16 a[36:39], a[228:231], v[212:215], a[36:39]
v_exp_f32 v146, v146
v_mfma_f32_16x16x32_bf16 a[36:39], a[196:199], v[196:199], a[36:39]
ds_read_b128 a[140:143], v2 offset:19456
v_cvt_pk_bf16_f32 v194, v144, v145
v_mfma_f32_16x16x32_bf16 a[40:43], a[200:203], v[196:199], a[40:43]
v_exp_f32 v147, v147
v_mfma_f32_16x16x32_bf16 a[40:43], a[232:235], v[212:215], a[40:43]
v_exp_f32 v136, v136
v_mfma_f32_16x16x32_bf16 a[104:107], a[232:235], v[220:223], a[104:107]
ds_read_b128 a[144:147], v2 offset:20480
v_cvt_pk_bf16_f32 v195, v146, v147
v_mfma_f32_16x16x32_bf16 a[104:107], a[200:203], v[204:207], a[104:107]
v_exp_f32 v137, v137
v_mfma_f32_16x16x32_bf16 a[108:111], a[204:207], v[204:207], a[108:111]
v_exp_f32 v138, v138
v_mfma_f32_16x16x32_bf16 a[108:111], a[236:239], v[220:223], a[108:111]
ds_read_b128 a[148:151], v2 offset:21504
v_cvt_pk_bf16_f32 v200, v136, v137
v_mfma_f32_16x16x32_bf16 a[44:47], a[236:239], v[212:215], a[44:47]
v_exp_f32 v139, v139
v_mfma_f32_16x16x32_bf16 a[44:47], a[204:207], v[196:199], a[44:47]
v_exp_f32 v152, v152
v_mfma_f32_16x16x32_bf16 a[48:51], a[208:211], v[196:199], a[48:51]
s_waitcnt lgkmcnt(6)
ds_read_b128 a[152:155], v2 offset:22528
v_cvt_pk_bf16_f32 v201, v138, v139
v_mfma_f32_16x16x32_bf16 a[48:51], a[240:243], v[212:215], a[48:51]
buffer_load_dwordx4 v1, s[44:47], s72 offen offset:1024 sc1 lds
v_mfma_f32_16x16x32_bf16 a[112:115], a[240:243], v[220:223], a[112:115]
v_exp_f32 v153, v153
v_mfma_f32_16x16x32_bf16 a[112:115], a[208:211], v[204:207], a[112:115]
v_exp_f32 v154, v154
v_mfma_f32_16x16x32_bf16 a[116:119], a[212:215], v[204:207], a[116:119]
ds_read_b128 a[156:159], v2 offset:23552
v_cvt_pk_bf16_f32 v202, v152, v153
v_mfma_f32_16x16x32_bf16 a[116:119], a[244:247], v[220:223], a[116:119]
v_exp_f32 v155, v155
v_mfma_f32_16x16x32_bf16 a[52:55], a[244:247], v[212:215], a[52:55]
v_exp_f32 v132, v132
v_mfma_f32_16x16x32_bf16 a[52:55], a[212:215], v[196:199], a[52:55]
ds_read_b128 a[192:195], v2 offset:0
v_cvt_pk_bf16_f32 v203, v154, v155
v_mfma_f32_16x16x32_bf16 a[56:59], a[216:219], v[196:199], a[56:59]
v_exp_f32 v133, v133
v_mfma_f32_16x16x32_bf16 a[56:59], a[248:251], v[212:215], a[56:59]
v_exp_f32 v134, v134
v_mfma_f32_16x16x32_bf16 a[120:123], a[248:251], v[220:223], a[120:123]
ds_read_b128 a[196:199], v2 offset:1024
v_mfma_f32_16x16x32_bf16 a[120:123], a[216:219], v[204:207], a[120:123]
v_exp_f32 v135, v135
v_mfma_f32_16x16x32_bf16 a[124:127], a[220:223], v[204:207], a[124:127]
v_exp_f32 v148, v148
v_mfma_f32_16x16x32_bf16 a[124:127], a[252:255], v[220:223], a[124:127]
ds_read_b128 a[200:203], v2 offset:2048
v_mfma_f32_16x16x32_bf16 a[60:63], a[252:255], v[212:215], a[60:63]
buffer_load_dwordx4 v1, s[44:47], s72 offen offset:2048 sc1 lds
v_mfma_f32_16x16x32_bf16 a[60:63], a[220:223], v[196:199], a[60:63]
ds_read_b128 a[204:207], v2 offset:3072
v_cvt_pk_bf16_f32 v196, v132, v133
v_mfma_f32_16x16x32_bf16 v[164:167], a[160:163], v[32:35], v[84:87]
v_exp_f32 v149, v149
v_mfma_f32_16x16x32_bf16 v[164:167], a[164:167], v[36:39], v[164:167]
v_exp_f32 v150, v150
v_mfma_f32_16x16x32_bf16 v[164:167], a[168:171], v[40:43], v[164:167]
ds_read_b128 a[208:211], v2 offset:4096
v_cvt_pk_bf16_f32 v197, v134, v135
v_mfma_f32_16x16x32_bf16 v[164:167], a[172:175], v[44:47], v[164:167]
v_exp_f32 v151, v151
v_mfma_f32_16x16x32_bf16 v[172:175], a[172:175], v[76:79], v[92:95]
v_exp_f32 v140, v140
v_mfma_f32_16x16x32_bf16 v[172:175], a[168:171], v[72:75], v[172:175]
ds_read_b128 a[212:215], v2 offset:5120
v_cvt_pk_bf16_f32 v198, v148, v149
v_mfma_f32_16x16x32_bf16 v[172:175], a[164:167], v[68:71], v[172:175]
v_exp_f32 v141, v141
v_mfma_f32_16x16x32_bf16 v[172:175], a[160:163], v[64:67], v[172:175]
v_exp_f32 v142, v142
v_mfma_f32_16x16x32_bf16 v[188:191], a[176:179], v[64:67], v[92:95]
ds_read_b128 a[216:219], v2 offset:6144
v_cvt_pk_bf16_f32 v199, v150, v151
v_mfma_f32_16x16x32_bf16 v[188:191], a[180:183], v[68:71], v[188:191]
v_exp_f32 v143, v143
v_mfma_f32_16x16x32_bf16 v[188:191], a[184:187], v[72:75], v[188:191]
v_exp_f32 v156, v156
v_mfma_f32_16x16x32_bf16 v[188:191], a[188:191], v[76:79], v[188:191]
ds_read_b128 a[220:223], v2 offset:7168
v_cvt_pk_bf16_f32 v204, v140, v141
v_mfma_f32_16x16x32_bf16 v[180:183], a[188:191], v[44:47], v[84:87]
buffer_load_dwordx4 v1, s[44:47], s72 offen offset:3072 sc1 lds
v_mfma_f32_16x16x32_bf16 v[180:183], a[184:187], v[40:43], v[180:183]
v_exp_f32 v157, v157
v_mfma_f32_16x16x32_bf16 v[180:183], a[180:183], v[36:39], v[180:183]
v_exp_f32 v158, v158
v_mfma_f32_16x16x32_bf16 v[180:183], a[176:179], v[32:35], v[180:183]
v_cvt_pk_bf16_f32 v205, v142, v143
v_cvt_pk_bf16_f32 v206, v156, v157
v_mfma_f32_16x16x32_bf16 v[160:163], a[160:163], v[16:19], v[80:83]
v_exp_f32 v159, v159
v_mfma_f32_16x16x32_bf16 v[160:163], a[164:167], v[20:23], v[160:163]
v_cvt_pk_bf16_f32 v207, v158, v159
v_mfma_f32_16x16x32_bf16 v[160:163], a[168:171], v[24:27], v[160:163]
v_mfma_f32_16x16x32_bf16 v[160:163], a[172:175], v[28:31], v[160:163]
v_mfma_f32_16x16x32_bf16 v[168:171], a[172:175], v[60:63], v[88:91]
v_mfma_f32_16x16x32_bf16 v[168:171], a[168:171], v[56:59], v[168:171]
v_mfma_f32_16x16x32_bf16 v[168:171], a[164:167], v[52:55], v[168:171]
v_mfma_f32_16x16x32_bf16 v[168:171], a[160:163], v[48:51], v[168:171]
v_mfma_f32_16x16x32_bf16 v[184:187], a[176:179], v[48:51], v[88:91]
v_mfma_f32_16x16x32_bf16 v[184:187], a[180:183], v[52:55], v[184:187]
v_mfma_f32_16x16x32_bf16 v[184:187], a[184:187], v[56:59], v[184:187]
v_mfma_f32_16x16x32_bf16 v[184:187], a[188:191], v[60:63], v[184:187]
v_mfma_f32_16x16x32_bf16 v[176:179], a[188:191], v[28:31], v[80:83]
v_mfma_f32_16x16x32_bf16 v[176:179], a[184:187], v[24:27], v[176:179]
v_mfma_f32_16x16x32_bf16 v[176:179], a[180:183], v[20:23], v[176:179]
v_mfma_f32_16x16x32_bf16 v[176:179], a[176:179], v[16:19], v[176:179]
s_waitcnt lgkmcnt(4)
v_mfma_f32_16x16x32_bf16 v[224:227], v[120:123], v[208:211], v[224:227]
s_add_u32 s82, s82, 0x8000
ds_read_b128 a[160:163], v2 offset:24576
v_mfma_f32_16x16x32_bf16 v[224:227], v[120:123], v[192:195], v[224:227]
s_and_b32 s82, s82, 0x1ffff
v_exp_f32 v164, v164
v_mfma_f32_16x16x32_bf16 v[232:235], v[120:123], v[216:219], v[232:235]
s_add_u32 m0, s74, 0
v_exp_f32 v165, v165
v_mfma_f32_16x16x32_bf16 v[232:235], v[120:123], v[200:203], v[232:235]
s_add_u32 s72, s81, 0
ds_read_b128 a[164:167], v2 offset:25600
v_cvt_pk_bf16_f32 v212, v164, v165
v_mfma_f32_16x16x32_bf16 a[0:3], a[224:227], v[208:211], a[0:3]
v_exp_f32 v166, v166
v_mfma_f32_16x16x32_bf16 a[0:3], a[192:195], v[192:195], a[0:3]
v_exp_f32 v167, v167
v_mfma_f32_16x16x32_bf16 a[64:67], a[192:195], v[200:203], a[64:67]
ds_read_b128 a[168:171], v2 offset:26624
v_cvt_pk_bf16_f32 v213, v166, v167
v_mfma_f32_16x16x32_bf16 a[64:67], a[224:227], v[216:219], a[64:67]
v_exp_f32 v180, v180
v_mfma_f32_16x16x32_bf16 a[68:71], a[228:231], v[216:219], a[68:71]
buffer_load_dwordx4 v1, s[44:47], s72 offen sc1 lds
v_mfma_f32_16x16x32_bf16 a[68:71], a[196:199], v[200:203], a[68:71]
v_exp_f32 v181, v181
v_mfma_f32_16x16x32_bf16 a[4:7], a[196:199], v[192:195], a[4:7]
ds_read_b128 a[172:175], v2 offset:27648
v_cvt_pk_bf16_f32 v214, v180, v181
v_mfma_f32_16x16x32_bf16 a[4:7], a[228:231], v[208:211], a[4:7]
v_exp_f32 v182, v182
v_mfma_f32_16x16x32_bf16 a[8:11], a[232:235], v[208:211], a[8:11]
v_exp_f32 v183, v183
v_mfma_f32_16x16x32_bf16 a[8:11], a[200:203], v[192:195], a[8:11]
ds_read_b128 a[176:179], v2 offset:28672
v_cvt_pk_bf16_f32 v215, v182, v183
v_mfma_f32_16x16x32_bf16 a[72:75], a[200:203], v[200:203], a[72:75]
v_exp_f32 v172, v172
v_mfma_f32_16x16x32_bf16 a[72:75], a[232:235], v[216:219], a[72:75]
v_exp_f32 v173, v173
v_mfma_f32_16x16x32_bf16 a[76:79], a[236:239], v[216:219], a[76:79]
ds_read_b128 a[180:183], v2 offset:29696
v_cvt_pk_bf16_f32 v220, v172, v173
v_mfma_f32_16x16x32_bf16 a[76:79], a[204:207], v[200:203], a[76:79]
v_exp_f32 v174, v174
v_mfma_f32_16x16x32_bf16 a[12:15], a[204:207], v[192:195], a[12:15]
v_exp_f32 v175, v175
v_mfma_f32_16x16x32_bf16 a[12:15], a[236:239], v[208:211], a[12:15]
ds_read_b128 a[184:187], v2 offset:30720
v_cvt_pk_bf16_f32 v221, v174, v175
v_mfma_f32_16x16x32_bf16 a[16:19], a[240:243], v[208:211], a[16:19]
s_waitcnt lgkmcnt(7)
v_exp_f32 v188, v188
v_mfma_f32_16x16x32_bf16 a[16:19], a[208:211], v[192:195], a[16:19]
buffer_load_dwordx4 v1, s[44:47], s72 offen offset:1024 sc1 lds
v_mfma_f32_16x16x32_bf16 a[80:83], a[208:211], v[200:203], a[80:83]
v_exp_f32 v189, v189
v_mfma_f32_16x16x32_bf16 a[80:83], a[240:243], v[216:219], a[80:83]
ds_read_b128 a[188:191], v2 offset:31744
v_cvt_pk_bf16_f32 v222, v188, v189
v_mfma_f32_16x16x32_bf16 a[84:87], a[244:247], v[216:219], a[84:87]
v_exp_f32 v190, v190
v_mfma_f32_16x16x32_bf16 a[84:87], a[212:215], v[200:203], a[84:87]
v_exp_f32 v191, v191
v_mfma_f32_16x16x32_bf16 a[20:23], a[212:215], v[192:195], a[20:23]
ds_read_b128 a[224:227], v2 offset:8192
v_cvt_pk_bf16_f32 v223, v190, v191
v_mfma_f32_16x16x32_bf16 a[20:23], a[244:247], v[208:211], a[20:23]
v_exp_f32 v160, v160
v_mfma_f32_16x16x32_bf16 a[24:27], a[248:251], v[208:211], a[24:27]
v_exp_f32 v161, v161
v_mfma_f32_16x16x32_bf16 a[24:27], a[216:219], v[192:195], a[24:27]
ds_read_b128 a[228:231], v2 offset:9216
v_mfma_f32_16x16x32_bf16 a[88:91], a[216:219], v[200:203], a[88:91]
v_exp_f32 v162, v162
v_mfma_f32_16x16x32_bf16 a[88:91], a[248:251], v[216:219], a[88:91]
v_exp_f32 v163, v163
v_mfma_f32_16x16x32_bf16 a[92:95], a[252:255], v[216:219], a[92:95]
ds_read_b128 a[232:235], v2 offset:10240
v_mfma_f32_16x16x32_bf16 a[92:95], a[220:223], v[200:203], a[92:95]
v_exp_f32 v176, v176
v_mfma_f32_16x16x32_bf16 a[28:31], a[220:223], v[192:195], a[28:31]
buffer_load_dwordx4 v1, s[44:47], s72 offen offset:2048 sc1 lds
v_mfma_f32_16x16x32_bf16 a[28:31], a[252:255], v[208:211], a[28:31]
ds_read_b128 a[236:239], v2 offset:11264
v_cvt_pk_bf16_f32 v208, v160, v161
s_cmp_eq_u32 s58, 0
s_cbranch_scc1 Lta16
s_cmp_eq_u32 s58, 1
s_cbranch_scc1 Lnt17
v_mfma_f32_16x16x32_bf16 v[128:131], a[128:131], v[16:19], v[80:83]
v_exp_f32 v177, v177
v_mfma_f32_16x16x32_bf16 v[144:147], a[144:147], v[16:19], v[80:83]
v_exp_f32 v178, v178
s_branch Ljoin18
Lta16:
v_mfma_f32_16x16x32_bf16 v[128:131], a[128:131], v[16:19], v[96:99]
v_exp_f32 v177, v177
v_mfma_f32_16x16x32_bf16 v[144:147], a[144:147], v[16:19], v[112:115]
v_exp_f32 v178, v178
s_branch Ljoin18
Lnt17:
v_mfma_f32_16x16x32_bf16 v[128:131], a[128:131], v[16:19], v[80:83]
v_exp_f32 v177, v177
v_mfma_f32_16x16x32_bf16 v[144:147], a[144:147], v[16:19], v[96:99]
v_exp_f32 v178, v178
Ljoin18:
v_mfma_f32_16x16x32_bf16 v[128:131], a[132:135], v[20:23], v[128:131]
ds_read_b128 a[240:243], v2 offset:12288
v_cvt_pk_bf16_f32 v209, v162, v163
v_mfma_f32_16x16x32_bf16 v[128:131], a[136:139], v[24:27], v[128:131]
v_exp_f32 v179, v179
v_mfma_f32_16x16x32_bf16 v[128:131], a[140:143], v[28:31], v[128:131]
v_exp_f32 v168, v168
v_mfma_f32_16x16x32_bf16 v[136:139], a[140:143], v[60:63], v[88:91]
ds_read_b128 a[244:247], v2 offset:13312
v_cvt_pk_bf16_f32 v210, v176, v177
v_mfma_f32_16x16x32_bf16 v[136:139], a[136:139], v[56:59], v[136:139]
v_exp_f32 v169, v169
v_mfma_f32_16x16x32_bf16 v[136:139], a[132:135], v[52:55], v[136:139]
v_exp_f32 v170, v170
v_mfma_f32_16x16x32_bf16 v[136:139], a[128:131], v[48:51], v[136:139]
ds_read_b128 a[248:251], v2 offset:14336
v_cvt_pk_bf16_f32 v211, v178, v179
v_mfma_f32_16x16x32_bf16 v[152:155], a[144:147], v[48:51], v[88:91]
v_exp_f32 v171, v171
v_mfma_f32_16x16x32_bf16 v[152:155], a[148:151], v[52:55], v[152:155]
v_exp_f32 v184, v184
v_mfma_f32_16x16x32_bf16 v[152:155], a[152:155], v[56:59], v[152:155]
ds_read_b128 a[252:255], v2 offset:15360
v_cvt_pk_bf16_f32 v216, v168, v169
v_mfma_f32_16x16x32_bf16 v[152:155], a[156:159], v[60:63], v[152:155]
buffer_load_dwordx4 v1, s[44:47], s72 offen offset:3072 sc1 lds
v_mfma_f32_16x16x32_bf16 v[144:147], a[156:159], v[28:31], v[144:147]
v_exp_f32 v185, v185
v_mfma_f32_16x16x32_bf16 v[144:147], a[152:155], v[24:27], v[144:147]
v_exp_f32 v186, v186
v_mfma_f32_16x16x32_bf16 v[144:147], a[148:151], v[20:23], v[144:147]
v_cvt_pk_bf16_f32 v217, v170, v171
v_cvt_pk_bf16_f32 v218, v184, v185
v_mfma_f32_16x16x32_bf16 v[132:135], a[128:131], v[32:35], v[84:87]
v_exp_f32 v187, v187
v_mfma_f32_16x16x32_bf16 v[132:135], a[132:135], v[36:39], v[132:135]
v_cvt_pk_bf16_f32 v219, v186, v187
v_add_u32 v2, s82, v1
v_mfma_f32_16x16x32_bf16 v[132:135], a[136:139], v[40:43], v[132:135]
v_mfma_f32_16x16x32_bf16 v[132:135], a[140:143], v[44:47], v[132:135]
v_mfma_f32_16x16x32_bf16 v[140:143], a[140:143], v[76:79], v[92:95]
v_mfma_f32_16x16x32_bf16 v[140:143], a[136:139], v[72:75], v[140:143]
v_mfma_f32_16x16x32_bf16 v[140:143], a[132:135], v[68:71], v[140:143]
v_mfma_f32_16x16x32_bf16 v[140:143], a[128:131], v[64:67], v[140:143]
v_mfma_f32_16x16x32_bf16 v[156:159], a[144:147], v[64:67], v[92:95]
v_mfma_f32_16x16x32_bf16 v[156:159], a[148:151], v[68:71], v[156:159]
v_mfma_f32_16x16x32_bf16 v[156:159], a[152:155], v[72:75], v[156:159]
v_mfma_f32_16x16x32_bf16 v[156:159], a[156:159], v[76:79], v[156:159]
v_mfma_f32_16x16x32_bf16 v[148:151], a[156:159], v[44:47], v[84:87]
v_mfma_f32_16x16x32_bf16 v[148:151], a[152:155], v[40:43], v[148:151]
v_mfma_f32_16x16x32_bf16 v[148:151], a[148:151], v[36:39], v[148:151]
s_waitcnt vmcnt(8) lgkmcnt(4)
v_mfma_f32_16x16x32_bf16 v[148:151], a[144:147], v[32:35], v[148:151]
s_barrier
v_mfma_f32_16x16x32_bf16 v[228:231], v[120:123], v[196:199], v[228:231]
s_xor_b32 s74, s82, 0x10000
v_exp_f32 v128, v128
v_mfma_f32_16x16x32_bf16 v[228:231], v[120:123], v[212:215], v[228:231]
s_add_u32 s74, s74, s64
ds_read_b128 a[128:131], v2 offset:16384
v_mfma_f32_16x16x32_bf16 v[236:239], v[120:123], v[204:207], v[236:239]
s_add_u32 s81, s81, 0x8000
v_exp_f32 v129, v129
v_mfma_f32_16x16x32_bf16 v[236:239], v[120:123], v[220:223], v[236:239]
s_add_u32 m0, s74, 16384
v_exp_f32 v130, v130
v_mfma_f32_16x16x32_bf16 a[32:35], a[192:195], v[196:199], a[32:35]
s_add_u32 s72, s81, 16384
ds_read_b128 a[132:135], v2 offset:17408
v_cvt_pk_bf16_f32 v192, v128, v129
v_mfma_f32_16x16x32_bf16 a[32:35], a[224:227], v[212:215], a[32:35]
v_exp_f32 v131, v131
v_mfma_f32_16x16x32_bf16 a[96:99], a[224:227], v[220:223], a[96:99]
v_exp_f32 v144, v144
v_mfma_f32_16x16x32_bf16 a[96:99], a[192:195], v[204:207], a[96:99]
ds_read_b128 a[136:139], v2 offset:18432
v_cvt_pk_bf16_f32 v193, v130, v131
v_mfma_f32_16x16x32_bf16 a[100:103], a[196:199], v[204:207], a[100:103]
buffer_load_dwordx4 v1, s[44:47], s72 offen sc1 lds
v_mfma_f32_16x16x32_bf16 a[100:103], a[228:231], v[220:223], a[100:103]
v_exp_f32 v145, v145
v_mfma_f32_16x16x32_bf16 a[36:39], a[228:231], v[212:215], a[36:39]
v_exp_f32 v146, v146
v_mfma_f32_16x16x32_bf16 a[36:39], a[196:199], v[196:199], a[36:39]
ds_read_b128 a[140:143], v2 offset:19456
v_cvt_pk_bf16_f32 v194, v144, v145
v_mfma_f32_16x16x32_bf16 a[40:43], a[200:203], v[196:199], a[40:43]
v_exp_f32 v147, v147
v_mfma_f32_16x16x32_bf16 a[40:43], a[232:235], v[212:215], a[40:43]
v_exp_f32 v136, v136
v_mfma_f32_16x16x32_bf16 a[104:107], a[232:235], v[220:223], a[104:107]
ds_read_b128 a[144:147], v2 offset:20480
v_cvt_pk_bf16_f32 v195, v146, v147
v_mfma_f32_16x16x32_bf16 a[104:107], a[200:203], v[204:207], a[104:107]
v_exp_f32 v137, v137
v_mfma_f32_16x16x32_bf16 a[108:111], a[204:207], v[204:207], a[108:111]
v_exp_f32 v138, v138
v_mfma_f32_16x16x32_bf16 a[108:111], a[236:239], v[220:223], a[108:111]
ds_read_b128 a[148:151], v2 offset:21504
v_cvt_pk_bf16_f32 v200, v136, v137
v_mfma_f32_16x16x32_bf16 a[44:47], a[236:239], v[212:215], a[44:47]
v_exp_f32 v139, v139
v_mfma_f32_16x16x32_bf16 a[44:47], a[204:207], v[196:199], a[44:47]
v_exp_f32 v152, v152
v_mfma_f32_16x16x32_bf16 a[48:51], a[208:211], v[196:199], a[48:51]
s_waitcnt lgkmcnt(6)
ds_read_b128 a[152:155], v2 offset:22528
v_cvt_pk_bf16_f32 v201, v138, v139
v_mfma_f32_16x16x32_bf16 a[48:51], a[240:243], v[212:215], a[48:51]
buffer_load_dwordx4 v1, s[44:47], s72 offen offset:1024 sc1 lds
v_mfma_f32_16x16x32_bf16 a[112:115], a[240:243], v[220:223], a[112:115]
v_exp_f32 v153, v153
v_mfma_f32_16x16x32_bf16 a[112:115], a[208:211], v[204:207], a[112:115]
v_exp_f32 v154, v154
v_mfma_f32_16x16x32_bf16 a[116:119], a[212:215], v[204:207], a[116:119]
ds_read_b128 a[156:159], v2 offset:23552
v_cvt_pk_bf16_f32 v202, v152, v153
v_mfma_f32_16x16x32_bf16 a[116:119], a[244:247], v[220:223], a[116:119]
v_exp_f32 v155, v155
v_mfma_f32_16x16x32_bf16 a[52:55], a[244:247], v[212:215], a[52:55]
v_exp_f32 v132, v132
v_mfma_f32_16x16x32_bf16 a[52:55], a[212:215], v[196:199], a[52:55]
ds_read_b128 a[192:195], v2 offset:0
v_cvt_pk_bf16_f32 v203, v154, v155
v_mfma_f32_16x16x32_bf16 a[56:59], a[216:219], v[196:199], a[56:59]
v_exp_f32 v133, v133
v_mfma_f32_16x16x32_bf16 a[56:59], a[248:251], v[212:215], a[56:59]
v_exp_f32 v134, v134
v_mfma_f32_16x16x32_bf16 a[120:123], a[248:251], v[220:223], a[120:123]
ds_read_b128 a[196:199], v2 offset:1024
v_mfma_f32_16x16x32_bf16 a[120:123], a[216:219], v[204:207], a[120:123]
v_exp_f32 v135, v135
v_mfma_f32_16x16x32_bf16 a[124:127], a[220:223], v[204:207], a[124:127]
v_exp_f32 v148, v148
v_mfma_f32_16x16x32_bf16 a[124:127], a[252:255], v[220:223], a[124:127]
ds_read_b128 a[200:203], v2 offset:2048
v_mfma_f32_16x16x32_bf16 a[60:63], a[252:255], v[212:215], a[60:63]
buffer_load_dwordx4 v1, s[44:47], s72 offen offset:2048 sc1 lds
v_mfma_f32_16x16x32_bf16 a[60:63], a[220:223], v[196:199], a[60:63]
ds_read_b128 a[204:207], v2 offset:3072
v_cvt_pk_bf16_f32 v196, v132, v133
s_cmp_eq_u32 s58, 2
s_cbranch_scc1 Lta19
s_cmp_eq_u32 s58, 3
s_cbranch_scc1 Lnt20
v_mfma_f32_16x16x32_bf16 v[160:163], a[160:163], v[16:19], v[112:115]
v_exp_f32 v149, v149
v_mfma_f32_16x16x32_bf16 v[176:179], a[176:179], v[16:19], v[112:115]
v_exp_f32 v150, v150
s_branch Ljoin21
Lta19:
v_mfma_f32_16x16x32_bf16 v[160:163], a[160:163], v[16:19], v[96:99]
v_exp_f32 v149, v149
v_mfma_f32_16x16x32_bf16 v[176:179], a[176:179], v[16:19], v[112:115]
v_exp_f32 v150, v150
s_branch Ljoin21
Lnt20:
v_mfma_f32_16x16x32_bf16 v[160:163], a[160:163], v[16:19], v[80:83]
v_exp_f32 v149, v149
v_mfma_f32_16x16x32_bf16 v[176:179], a[176:179], v[16:19], v[96:99]
v_exp_f32 v150, v150
Ljoin21:
v_mfma_f32_16x16x32_bf16 v[164:167], a[160:163], v[32:35], v[84:87]
ds_read_b128 a[208:211], v2 offset:4096
v_cvt_pk_bf16_f32 v197, v134, v135
v_mfma_f32_16x16x32_bf16 v[164:167], a[164:167], v[36:39], v[164:167]
v_exp_f32 v151, v151
v_mfma_f32_16x16x32_bf16 v[164:167], a[168:171], v[40:43], v[164:167]
v_exp_f32 v140, v140
v_mfma_f32_16x16x32_bf16 v[164:167], a[172:175], v[44:47], v[164:167]
ds_read_b128 a[212:215], v2 offset:5120
v_cvt_pk_bf16_f32 v198, v148, v149
v_mfma_f32_16x16x32_bf16 v[172:175], a[172:175], v[76:79], v[92:95]
v_exp_f32 v141, v141
v_mfma_f32_16x16x32_bf16 v[172:175], a[168:171], v[72:75], v[172:175]
v_exp_f32 v142, v142
v_mfma_f32_16x16x32_bf16 v[172:175], a[164:167], v[68:71], v[172:175]
ds_read_b128 a[216:219], v2 offset:6144
v_cvt_pk_bf16_f32 v199, v150, v151
v_mfma_f32_16x16x32_bf16 v[172:175], a[160:163], v[64:67], v[172:175]
v_exp_f32 v143, v143
v_mfma_f32_16x16x32_bf16 v[188:191], a[176:179], v[64:67], v[92:95]
v_exp_f32 v156, v156
v_mfma_f32_16x16x32_bf16 v[188:191], a[180:183], v[68:71], v[188:191]
ds_read_b128 a[220:223], v2 offset:7168
v_cvt_pk_bf16_f32 v204, v140, v141
v_mfma_f32_16x16x32_bf16 v[188:191], a[184:187], v[72:75], v[188:191]
buffer_load_dwordx4 v1, s[44:47], s72 offen offset:3072 sc1 lds
v_mfma_f32_16x16x32_bf16 v[188:191], a[188:191], v[76:79], v[188:191]
v_exp_f32 v157, v157
v_mfma_f32_16x16x32_bf16 v[180:183], a[188:191], v[44:47], v[84:87]
v_exp_f32 v158, v158
v_mfma_f32_16x16x32_bf16 v[180:183], a[184:187], v[40:43], v[180:183]
v_cvt_pk_bf16_f32 v205, v142, v143
v_cvt_pk_bf16_f32 v206, v156, v157
v_mfma_f32_16x16x32_bf16 v[180:183], a[180:183], v[36:39], v[180:183]
v_exp_f32 v159, v159
v_mfma_f32_16x16x32_bf16 v[180:183], a[176:179], v[32:35], v[180:183]
v_cvt_pk_bf16_f32 v207, v158, v159
v_mfma_f32_16x16x32_bf16 v[160:163], a[164:167], v[20:23], v[160:163]
v_mfma_f32_16x16x32_bf16 v[160:163], a[168:171], v[24:27], v[160:163]
v_mfma_f32_16x16x32_bf16 v[160:163], a[172:175], v[28:31], v[160:163]
v_mfma_f32_16x16x32_bf16 v[168:171], a[172:175], v[60:63], v[88:91]
v_mfma_f32_16x16x32_bf16 v[168:171], a[168:171], v[56:59], v[168:171]
v_mfma_f32_16x16x32_bf16 v[168:171], a[164:167], v[52:55], v[168:171]
v_mfma_f32_16x16x32_bf16 v[168:171], a[160:163], v[48:51], v[168:171]
v_mfma_f32_16x16x32_bf16 v[184:187], a[176:179], v[48:51], v[88:91]
v_mfma_f32_16x16x32_bf16 v[184:187], a[180:183], v[52:55], v[184:187]
v_mfma_f32_16x16x32_bf16 v[184:187], a[184:187], v[56:59], v[184:187]
v_mfma_f32_16x16x32_bf16 v[184:187], a[188:191], v[60:63], v[184:187]
v_mfma_f32_16x16x32_bf16 v[176:179], a[188:191], v[28:31], v[176:179]
v_mfma_f32_16x16x32_bf16 v[176:179], a[184:187], v[24:27], v[176:179]
v_mfma_f32_16x16x32_bf16 v[176:179], a[180:183], v[20:23], v[176:179]
s_waitcnt lgkmcnt(4)
v_mfma_f32_16x16x32_bf16 v[224:227], v[120:123], v[208:211], v[224:227]
s_add_u32 s82, s82, 0x8000
ds_read_b128 a[160:163], v2 offset:24576
v_mfma_f32_16x16x32_bf16 v[224:227], v[120:123], v[192:195], v[224:227]
s_and_b32 s82, s82, 0x1ffff
v_exp_f32 v164, v164
v_mfma_f32_16x16x32_bf16 v[232:235], v[120:123], v[216:219], v[232:235]
s_add_u32 m0, s74, 0
v_exp_f32 v165, v165
v_mfma_f32_16x16x32_bf16 v[232:235], v[120:123], v[200:203], v[232:235]
s_add_u32 s72, s81, 0
ds_read_b128 a[164:167], v2 offset:25600
v_cvt_pk_bf16_f32 v212, v164, v165
v_mfma_f32_16x16x32_bf16 a[0:3], a[224:227], v[208:211], a[0:3]
v_exp_f32 v166, v166
v_mfma_f32_16x16x32_bf16 a[0:3], a[192:195], v[192:195], a[0:3]
v_exp_f32 v167, v167
v_mfma_f32_16x16x32_bf16 a[64:67], a[192:195], v[200:203], a[64:67]
ds_read_b128 a[168:171], v2 offset:26624
v_cvt_pk_bf16_f32 v213, v166, v167
v_mfma_f32_16x16x32_bf16 a[64:67], a[224:227], v[216:219], a[64:67]
v_exp_f32 v180, v180
v_mfma_f32_16x16x32_bf16 a[68:71], a[228:231], v[216:219], a[68:71]
buffer_load_dwordx4 v1, s[44:47], s72 offen sc1 lds
v_mfma_f32_16x16x32_bf16 a[68:71], a[196:199], v[200:203], a[68:71]
v_exp_f32 v181, v181
v_mfma_f32_16x16x32_bf16 a[4:7], a[196:199], v[192:195], a[4:7]
ds_read_b128 a[172:175], v2 offset:27648
v_cvt_pk_bf16_f32 v214, v180, v181
v_mfma_f32_16x16x32_bf16 a[4:7], a[228:231], v[208:211], a[4:7]
v_exp_f32 v182, v182
v_mfma_f32_16x16x32_bf16 a[8:11], a[232:235], v[208:211], a[8:11]
v_exp_f32 v183, v183
v_mfma_f32_16x16x32_bf16 a[8:11], a[200:203], v[192:195], a[8:11]
ds_read_b128 a[176:179], v2 offset:28672
v_cvt_pk_bf16_f32 v215, v182, v183
v_mfma_f32_16x16x32_bf16 a[72:75], a[200:203], v[200:203], a[72:75]
v_exp_f32 v172, v172
v_mfma_f32_16x16x32_bf16 a[72:75], a[232:235], v[216:219], a[72:75]
v_exp_f32 v173, v173
v_mfma_f32_16x16x32_bf16 a[76:79], a[236:239], v[216:219], a[76:79]
ds_read_b128 a[180:183], v2 offset:29696
v_cvt_pk_bf16_f32 v220, v172, v173
v_mfma_f32_16x16x32_bf16 a[76:79], a[204:207], v[200:203], a[76:79]
v_exp_f32 v174, v174
v_mfma_f32_16x16x32_bf16 a[12:15], a[204:207], v[192:195], a[12:15]
v_exp_f32 v175, v175
v_mfma_f32_16x16x32_bf16 a[12:15], a[236:239], v[208:211], a[12:15]
ds_read_b128 a[184:187], v2 offset:30720
v_cvt_pk_bf16_f32 v221, v174, v175
v_mfma_f32_16x16x32_bf16 a[16:19], a[240:243], v[208:211], a[16:19]
s_waitcnt lgkmcnt(7)
v_exp_f32 v188, v188
v_mfma_f32_16x16x32_bf16 a[16:19], a[208:211], v[192:195], a[16:19]
buffer_load_dwordx4 v1, s[44:47], s72 offen offset:1024 sc1 lds
v_mfma_f32_16x16x32_bf16 a[80:83], a[208:211], v[200:203], a[80:83]
v_exp_f32 v189, v189
v_mfma_f32_16x16x32_bf16 a[80:83], a[240:243], v[216:219], a[80:83]
ds_read_b128 a[188:191], v2 offset:31744
v_cvt_pk_bf16_f32 v222, v188, v189
v_mfma_f32_16x16x32_bf16 a[84:87], a[244:247], v[216:219], a[84:87]
v_exp_f32 v190, v190
v_mfma_f32_16x16x32_bf16 a[84:87], a[212:215], v[200:203], a[84:87]
v_exp_f32 v191, v191
v_mfma_f32_16x16x32_bf16 a[20:23], a[212:215], v[192:195], a[20:23]
ds_read_b128 a[224:227], v2 offset:8192
v_cvt_pk_bf16_f32 v223, v190, v191
v_mfma_f32_16x16x32_bf16 a[20:23], a[244:247], v[208:211], a[20:23]
v_exp_f32 v160, v160
v_mfma_f32_16x16x32_bf16 a[24:27], a[248:251], v[208:211], a[24:27]
v_exp_f32 v161, v161
v_mfma_f32_16x16x32_bf16 a[24:27], a[216:219], v[192:195], a[24:27]
ds_read_b128 a[228:231], v2 offset:9216
v_mfma_f32_16x16x32_bf16 a[88:91], a[216:219], v[200:203], a[88:91]
v_exp_f32 v162, v162
v_mfma_f32_16x16x32_bf16 a[88:91], a[248:251], v[216:219], a[88:91]
Lstub3:
s_cbranch_execz Lstub7
v_exp_f32 v163, v163
v_mfma_f32_16x16x32_bf16 a[92:95], a[252:255], v[216:219], a[92:95]
ds_read_b128 a[232:235], v2 offset:10240
v_mfma_f32_16x16x32_bf16 a[92:95], a[220:223], v[200:203], a[92:95]
v_exp_f32 v176, v176
v_mfma_f32_16x16x32_bf16 a[28:31], a[220:223], v[192:195], a[28:31]
buffer_load_dwordx4 v1, s[44:47], s72 offen offset:2048 sc1 lds
v_mfma_f32_16x16x32_bf16 a[28:31], a[252:255], v[208:211], a[28:31]
ds_read_b128 a[236:239], v2 offset:11264
v_cvt_pk_bf16_f32 v208, v160, v161
s_cmp_eq_u32 s58, 0
s_cbranch_scc1 Lta22
s_cmp_eq_u32 s58, 1
s_cbranch_scc1 Lnt23
v_mfma_f32_16x16x32_bf16 v[132:135], a[128:131], v[32:35], v[84:87]
v_exp_f32 v177, v177
v_mfma_f32_16x16x32_bf16 v[148:151], a[144:147], v[32:35], v[84:87]
v_exp_f32 v178, v178
s_branch Ljoin24
Lta22:
v_mfma_f32_16x16x32_bf16 v[132:135], a[128:131], v[32:35], v[100:103]
v_exp_f32 v177, v177
v_mfma_f32_16x16x32_bf16 v[148:151], a[144:147], v[32:35], v[112:115]
v_exp_f32 v178, v178
s_branch Ljoin24
Lnt23:
v_mfma_f32_16x16x32_bf16 v[132:135], a[128:131], v[32:35], v[84:87]
v_exp_f32 v177, v177
v_mfma_f32_16x16x32_bf16 v[148:151], a[144:147], v[32:35], v[100:103]
v_exp_f32 v178, v178
Ljoin24:
v_mfma_f32_16x16x32_bf16 v[136:139], a[128:131], v[48:51], v[88:91]
ds_read_b128 a[240:243], v2 offset:12288
v_cvt_pk_bf16_f32 v209, v162, v163
v_mfma_f32_16x16x32_bf16 v[136:139], a[132:135], v[52:55], v[136:139]
v_exp_f32 v179, v179
v_mfma_f32_16x16x32_bf16 v[136:139], a[136:139], v[56:59], v[136:139]
v_exp_f32 v168, v168
v_mfma_f32_16x16x32_bf16 v[136:139], a[140:143], v[60:63], v[136:139]
ds_read_b128 a[244:247], v2 offset:13312
v_cvt_pk_bf16_f32 v210, v176, v177
v_mfma_f32_16x16x32_bf16 v[152:155], a[156:159], v[60:63], v[88:91]
v_exp_f32 v169, v169
v_mfma_f32_16x16x32_bf16 v[152:155], a[152:155], v[56:59], v[152:155]
v_exp_f32 v170, v170
v_mfma_f32_16x16x32_bf16 v[152:155], a[148:151], v[52:55], v[152:155]
ds_read_b128 a[248:251], v2 offset:14336
v_cvt_pk_bf16_f32 v211, v178, v179
v_mfma_f32_16x16x32_bf16 v[152:155], a[144:147], v[48:51], v[152:155]
v_exp_f32 v171, v171
v_mfma_f32_16x16x32_bf16 v[132:135], a[132:135], v[36:39], v[132:135]
v_exp_f32 v184, v184
v_mfma_f32_16x16x32_bf16 v[132:135], a[136:139], v[40:43], v[132:135]
ds_read_b128 a[252:255], v2 offset:15360
v_cvt_pk_bf16_f32 v216, v168, v169
v_mfma_f32_16x16x32_bf16 v[132:135], a[140:143], v[44:47], v[132:135]
buffer_load_dwordx4 v1, s[44:47], s72 offen offset:3072 sc1 lds
v_mfma_f32_16x16x32_bf16 v[140:143], a[140:143], v[76:79], v[92:95]
v_exp_f32 v185, v185
v_mfma_f32_16x16x32_bf16 v[140:143], a[136:139], v[72:75], v[140:143]
v_exp_f32 v186, v186
v_mfma_f32_16x16x32_bf16 v[140:143], a[132:135], v[68:71], v[140:143]
v_cvt_pk_bf16_f32 v217, v170, v171
v_cvt_pk_bf16_f32 v218, v184, v185
v_mfma_f32_16x16x32_bf16 v[140:143], a[128:131], v[64:67], v[140:143]
v_exp_f32 v187, v187
v_mfma_f32_16x16x32_bf16 v[156:159], a[144:147], v[64:67], v[92:95]
v_cvt_pk_bf16_f32 v219, v186, v187
v_add_u32 v2, s82, v1
v_mfma_f32_16x16x32_bf16 v[156:159], a[148:151], v[68:71], v[156:159]
v_mfma_f32_16x16x32_bf16 v[156:159], a[152:155], v[72:75], v[156:159]
v_mfma_f32_16x16x32_bf16 v[156:159], a[156:159], v[76:79], v[156:159]
v_mfma_f32_16x16x32_bf16 v[148:151], a[156:159], v[44:47], v[148:151]
v_mfma_f32_16x16x32_bf16 v[148:151], a[152:155], v[40:43], v[148:151]
s_waitcnt vmcnt(8) lgkmcnt(4)
v_mfma_f32_16x16x32_bf16 v[148:151], a[148:151], v[36:39], v[148:151]
s_barrier
s_cmp_eq_u32 s60, 7
s_cbranch_scc1 LLT3x
LLT3:
Lstub4:
s_cbranch_execz Lstub8
v_mfma_f32_16x16x32_bf16 v[228:231], v[120:123], v[196:199], v[228:231]
s_xor_b32 s74, s82, 0x10000
v_exp_f32 v136, v136
v_mfma_f32_16x16x32_bf16 v[228:231], v[120:123], v[212:215], v[228:231]
s_add_u32 s74, s74, s64
ds_read_b128 a[128:131], v2 offset:16384
v_and_b32 v240, 15, v0
v_mfma_f32_16x16x32_bf16 v[236:239], v[120:123], v[204:207], v[236:239]
s_add_u32 s81, s81, 0x8000
v_exp_f32 v137, v137
v_mfma_f32_16x16x32_bf16 v[236:239], v[120:123], v[220:223], v[236:239]
s_add_u32 m0, s74, 16384
ds_read_b128 a[132:135], v2 offset:17408
v_cvt_pk_bf16_f32 v200, v136, v137
v_mfma_f32_16x16x32_bf16 a[32:35], a[192:195], v[196:199], a[32:35]
s_add_u32 s72, s81, 16384
buffer_load_dwordx4 v1, s[44:47], s72 offen sc1 lds
v_mfma_f32_16x16x32_bf16 a[32:35], a[224:227], v[212:215], a[32:35]
s_add_u32 s69, s93, 0x3e00000
v_exp_f32 v138, v138
v_mfma_f32_16x16x32_bf16 a[96:99], a[224:227], v[220:223], a[96:99]
v_exp_f32 v139, v139
v_mfma_f32_16x16x32_bf16 a[96:99], a[192:195], v[204:207], a[96:99]
ds_read_b128 a[136:139], v2 offset:18432
v_cvt_pk_bf16_f32 v201, v138, v139
v_mfma_f32_16x16x32_bf16 a[100:103], a[196:199], v[204:207], a[100:103]
v_exp_f32 v152, v152
v_mfma_f32_16x16x32_bf16 a[100:103], a[228:231], v[220:223], a[100:103]
ds_read_b128 a[140:143], v2 offset:19456
v_lshrrev_b32 v241, 4, v0
v_mfma_f32_16x16x32_bf16 a[36:39], a[228:231], v[212:215], a[36:39]
buffer_store_dwordx4 v[112:115], v1, s[44:47], s69 offen sc1
v_mfma_f32_16x16x32_bf16 a[36:39], a[196:199], v[196:199], a[36:39]
v_exp_f32 v153, v153
v_mfma_f32_16x16x32_bf16 a[40:43], a[200:203], v[196:199], a[40:43]
v_exp_f32 v154, v154
v_mfma_f32_16x16x32_bf16 a[40:43], a[232:235], v[212:215], a[40:43]
ds_read_b128 a[144:147], v2 offset:20480
v_cvt_pk_bf16_f32 v202, v152, v153
v_mfma_f32_16x16x32_bf16 a[104:107], a[232:235], v[220:223], a[104:107]
v_exp_f32 v155, v155
v_mfma_f32_16x16x32_bf16 a[104:107], a[200:203], v[204:207], a[104:107]
ds_read_b128 a[148:151], v2 offset:21504
v_cvt_pk_bf16_f32 v203, v154, v155
v_mfma_f32_16x16x32_bf16 a[108:111], a[204:207], v[204:207], a[108:111]
buffer_load_dwordx4 v1, s[44:47], s72 offen offset:1024 sc1 lds
v_mfma_f32_16x16x32_bf16 a[108:111], a[236:239], v[220:223], a[108:111]
v_exp_f32 v132, v132
v_mfma_f32_16x16x32_bf16 a[44:47], a[236:239], v[212:215], a[44:47]
v_exp_f32 v133, v133
v_mfma_f32_16x16x32_bf16 a[44:47], a[204:207], v[196:199], a[44:47]
ds_read_b128 a[152:155], v2 offset:22528
v_add_u32 v248, 1, v240
v_mfma_f32_16x16x32_bf16 a[48:51], a[208:211], v[196:199], a[48:51]
s_waitcnt lgkmcnt(7)
v_exp_f32 v134, v134
v_mfma_f32_16x16x32_bf16 a[48:51], a[240:243], v[212:215], a[48:51]
ds_read_b128 a[156:159], v2 offset:23552
v_and_b32 v249, 3, v248
v_mfma_f32_16x16x32_bf16 a[112:115], a[240:243], v[220:223], a[112:115]
buffer_store_dwordx4 v[112:115], v1, s[44:47], s69 offen offset:1024 sc1
v_mfma_f32_16x16x32_bf16 a[112:115], a[208:211], v[204:207], a[112:115]
v_exp_f32 v135, v135
v_mfma_f32_16x16x32_bf16 a[116:119], a[212:215], v[204:207], a[116:119]
v_exp_f32 v148, v148
v_mfma_f32_16x16x32_bf16 a[116:119], a[244:247], v[220:223], a[116:119]
ds_read_b128 a[192:195], v2 offset:0
v_lshrrev_b32 v248, 2, v248
v_mfma_f32_16x16x32_bf16 a[52:55], a[244:247], v[212:215], a[52:55]
v_exp_f32 v149, v149
v_mfma_f32_16x16x32_bf16 a[52:55], a[212:215], v[196:199], a[52:55]
ds_read_b128 a[196:199], v2 offset:1024
v_mov_b32 v250, 0x20000
v_mfma_f32_16x16x32_bf16 a[56:59], a[216:219], v[196:199], a[56:59]
buffer_load_dwordx4 v1, s[44:47], s72 offen offset:2048 sc1 lds
v_mfma_f32_16x16x32_bf16 a[56:59], a[248:251], v[212:215], a[56:59]
v_exp_f32 v150, v150
v_mfma_f32_16x16x32_bf16 a[120:123], a[248:251], v[220:223], a[120:123]
v_exp_f32 v151, v151
v_mfma_f32_16x16x32_bf16 a[120:123], a[216:219], v[204:207], a[120:123]
ds_read_b128 a[200:203], v2 offset:2048
v_mov_b32 v252, 0x20001
v_mfma_f32_16x16x32_bf16 a[124:127], a[220:223], v[204:207], a[124:127]
v_exp_f32 v140, v140
v_mfma_f32_16x16x32_bf16 a[124:127], a[252:255], v[220:223], a[124:127]
ds_read_b128 a[204:207], v2 offset:3072
v_lshlrev_b32 v6, 3, v249
v_mfma_f32_16x16x32_bf16 a[60:63], a[252:255], v[212:215], a[60:63]
buffer_store_dwordx4 v[112:115], v1, s[44:47], s69 offen offset:2048 sc1
v_mfma_f32_16x16x32_bf16 a[60:63], a[220:223], v[196:199], a[60:63]
ds_read_b128 a[208:211], v2 offset:4096
v_cvt_pk_bf16_f32 v196, v132, v133
s_cmp_eq_u32 s58, 2
s_cbranch_scc1 Lta25
s_cmp_eq_u32 s58, 3
s_cbranch_scc1 Lnt26
v_mfma_f32_16x16x32_bf16 v[164:167], a[160:163], v[32:35], v[112:115]
ds_read_b128 a[212:215], v2 offset:5120
v_cvt_pk_bf16_f32 v197, v134, v135
v_mfma_f32_16x16x32_bf16 v[180:183], a[176:179], v[32:35], v[112:115]
ds_read_b128 a[216:219], v2 offset:6144
v_cvt_pk_bf16_f32 v198, v148, v149
s_branch Ljoin27
Lta25:
v_mfma_f32_16x16x32_bf16 v[164:167], a[160:163], v[32:35], v[100:103]
ds_read_b128 a[212:215], v2 offset:5120
v_cvt_pk_bf16_f32 v197, v134, v135
v_mfma_f32_16x16x32_bf16 v[180:183], a[176:179], v[32:35], v[112:115]
ds_read_b128 a[216:219], v2 offset:6144
v_cvt_pk_bf16_f32 v198, v148, v149
s_branch Ljoin27
Lnt26:
v_mfma_f32_16x16x32_bf16 v[164:167], a[160:163], v[32:35], v[84:87]
ds_read_b128 a[212:215], v2 offset:5120
v_cvt_pk_bf16_f32 v197, v134, v135
v_mfma_f32_16x16x32_bf16 v[180:183], a[176:179], v[32:35], v[100:103]
ds_read_b128 a[216:219], v2 offset:6144
v_cvt_pk_bf16_f32 v198, v148, v149
Ljoin27:
v_mfma_f32_16x16x32_bf16 v[164:167], a[164:167], v[36:39], v[164:167]
v_exp_f32 v141, v141
v_mfma_f32_16x16x32_bf16 v[164:167], a[168:171], v[40:43], v[164:167]
v_exp_f32 v142, v142
v_mfma_f32_16x16x32_bf16 v[164:167], a[172:175], v[44:47], v[164:167]
ds_read_b128 a[220:223], v2 offset:7168
v_cvt_pk_bf16_f32 v199, v150, v151
v_mfma_f32_16x16x32_bf16 v[172:175], a[172:175], v[76:79], v[92:95]
v_exp_f32 v143, v143
v_mfma_f32_16x16x32_bf16 v[172:175], a[168:171], v[72:75], v[172:175]
buffer_load_dwordx4 v1, s[44:47], s72 offen offset:3072 sc1 lds
v_mfma_f32_16x16x32_bf16 v[172:175], a[164:167], v[68:71], v[172:175]
v_exp_f32 v156, v156
v_mfma_f32_16x16x32_bf16 v[172:175], a[160:163], v[64:67], v[172:175]
v_cvt_pk_bf16_f32 v204, v140, v141
v_cvt_pk_bf16_f32 v205, v142, v143
v_mfma_f32_16x16x32_bf16 v[188:191], a[176:179], v[64:67], v[92:95]
v_exp_f32 v157, v157
v_mfma_f32_16x16x32_bf16 v[188:191], a[180:183], v[68:71], v[188:191]
v_exp_f32 v158, v158
v_mfma_f32_16x16x32_bf16 v[188:191], a[184:187], v[72:75], v[188:191]
buffer_store_dwordx4 v[112:115], v1, s[44:47], s69 offen offset:3072 sc1
v_mfma_f32_16x16x32_bf16 v[188:191], a[188:191], v[76:79], v[188:191]
v_exp_f32 v159, v159
v_mfma_f32_16x16x32_bf16 v[180:183], a[188:191], v[44:47], v[180:183]
v_cvt_pk_bf16_f32 v206, v156, v157
v_cvt_pk_bf16_f32 v207, v158, v159
v_mfma_f32_16x16x32_bf16 v[180:183], a[184:187], v[40:43], v[180:183]
v_lshrrev_b32 v6, v6, v252
v_and_b32 v6, 3, v6
v_mfma_f32_16x16x32_bf16 v[180:183], a[180:183], v[36:39], v[180:183]
v_cmp_ne_u32 vcc, 1, v249
v_mul_u32_u24 v6, 16640, v6
v_mfma_f32_16x16x32_bf16 v[168:171], a[160:163], v[48:51], v[88:91]
v_add_u32 v6, s92, v6
v_cndmask_b32 v6, v250, v6, vcc
v_mfma_f32_16x16x32_bf16 v[168:171], a[164:167], v[52:55], v[168:171]
v_add_u32 v253, s58, v249
v_and_b32 v253, 3, v253
v_mfma_f32_16x16x32_bf16 v[168:171], a[168:171], v[56:59], v[168:171]
v_mul_u32_u24 v253, 4160, v253
v_add_u32 v6, v6, v253
v_mfma_f32_16x16x32_bf16 v[168:171], a[172:175], v[60:63], v[168:171]
v_bfe_u32 v251, v0, 2, 2
v_lshl_add_u32 v6, v248, 3, v6
v_mfma_f32_16x16x32_bf16 v[184:187], a[188:191], v[60:63], v[88:91]
v_lshl_add_u32 v6, v241, 4, v6
v_lshlrev_b32 v5, 3, v251
v_mfma_f32_16x16x32_bf16 v[184:187], a[184:187], v[56:59], v[184:187]
v_lshrrev_b32 v5, v5, v252
v_and_b32 v5, 3, v5
v_mfma_f32_16x16x32_bf16 v[184:187], a[180:183], v[52:55], v[184:187]
v_cmp_ne_u32 vcc, 1, v251
v_mul_u32_u24 v5, 16640, v5
v_mfma_f32_16x16x32_bf16 v[184:187], a[176:179], v[48:51], v[184:187]
s_waitcnt lgkmcnt(4)
v_mfma_f32_16x16x32_bf16 v[224:227], v[120:123], v[208:211], v[224:227]
s_add_u32 s82, s82, 0x8000
ds_read_b128 a[160:163], v2 offset:24576
ds_read_b128 a[164:167], v2 offset:25600
v_mfma_f32_16x16x32_bf16 v[232:235], v[120:123], v[216:219], v[232:235]
s_and_b32 s82, s82, 0x1ffff
v_exp_f32 v164, v164
v_mfma_f32_16x16x32_bf16 v[232:235], v[120:123], v[200:203], v[232:235]
s_add_u32 m0, s74, 0
v_exp_f32 v165, v165
v_mfma_f32_16x16x32_bf16 a[0:3], a[224:227], v[208:211], a[0:3]
s_add_u32 s72, s81, 0
v_exp_f32 v166, v166
v_mfma_f32_16x16x32_bf16 a[64:67], a[192:195], v[200:203], a[64:67]
ds_read_b128 a[168:171], v2 offset:26624
v_cvt_pk_bf16_f32 v212, v164, v165
v_mfma_f32_16x16x32_bf16 a[64:67], a[224:227], v[216:219], a[64:67]
v_exp_f32 v167, v167
v_mfma_f32_16x16x32_bf16 a[68:71], a[228:231], v[216:219], a[68:71]
buffer_load_dwordx4 v1, s[44:47], s72 offen sc1 lds
v_mfma_f32_16x16x32_bf16 a[68:71], a[196:199], v[200:203], a[68:71]
v_exp_f32 v180, v180
v_mfma_f32_16x16x32_bf16 a[4:7], a[228:231], v[208:211], a[4:7]
ds_read_b128 a[172:175], v2 offset:27648
v_cvt_pk_bf16_f32 v213, v166, v167
v_mfma_f32_16x16x32_bf16 a[8:11], a[232:235], v[208:211], a[8:11]
v_exp_f32 v181, v181
v_mfma_f32_16x16x32_bf16 a[72:75], a[200:203], v[200:203], a[72:75]
ds_read_b128 a[176:179], v2 offset:28672
v_cvt_pk_bf16_f32 v214, v180, v181
v_mfma_f32_16x16x32_bf16 a[72:75], a[232:235], v[216:219], a[72:75]
v_exp_f32 v182, v182
v_mfma_f32_16x16x32_bf16 a[76:79], a[236:239], v[216:219], a[76:79]
v_exp_f32 v183, v183
v_mfma_f32_16x16x32_bf16 a[76:79], a[204:207], v[200:203], a[76:79]
ds_read_b128 a[180:183], v2 offset:29696
v_cvt_pk_bf16_f32 v215, v182, v183
v_mfma_f32_16x16x32_bf16 a[12:15], a[236:239], v[208:211], a[12:15]
v_exp_f32 v172, v172
v_mfma_f32_16x16x32_bf16 a[16:19], a[240:243], v[208:211], a[16:19]
s_waitcnt lgkmcnt(6)
ds_read_b128 a[184:187], v2 offset:30720
ds_read_b128 a[188:191], v2 offset:31744
v_mfma_f32_16x16x32_bf16 a[80:83], a[208:211], v[200:203], a[80:83]
v_exp_f32 v173, v173
v_mfma_f32_16x16x32_bf16 a[80:83], a[240:243], v[216:219], a[80:83]
buffer_load_dwordx4 v1, s[44:47], s72 offen offset:1024 sc1 lds
v_mfma_f32_16x16x32_bf16 a[84:87], a[244:247], v[216:219], a[84:87]
v_exp_f32 v174, v174
v_mfma_f32_16x16x32_bf16 a[84:87], a[212:215], v[200:203], a[84:87]
v_exp_f32 v175, v175
v_mfma_f32_16x16x32_bf16 a[20:23], a[244:247], v[208:211], a[20:23]
ds_read_b128 a[224:227], v2 offset:8192
v_cvt_pk_bf16_f32 v220, v172, v173
v_mfma_f32_16x16x32_bf16 a[24:27], a[248:251], v[208:211], a[24:27]
v_exp_f32 v188, v188
v_mfma_f32_16x16x32_bf16 a[88:91], a[216:219], v[200:203], a[88:91]
v_exp_f32 v189, v189
v_mfma_f32_16x16x32_bf16 a[88:91], a[248:251], v[216:219], a[88:91]
ds_read_b128 a[228:231], v2 offset:9216
v_cvt_pk_bf16_f32 v221, v174, v175
v_mfma_f32_16x16x32_bf16 a[92:95], a[252:255], v[216:219], a[92:95]
v_exp_f32 v190, v190
v_mfma_f32_16x16x32_bf16 a[92:95], a[220:223], v[200:203], a[92:95]
ds_read_b128 a[232:235], v2 offset:10240
v_cvt_pk_bf16_f32 v222, v188, v189
v_mfma_f32_16x16x32_bf16 a[28:31], a[252:255], v[208:211], a[28:31]
v_exp_f32 v191, v191
v_mfma_f32_16x16x32_bf16 v[136:139], a[128:131], v[48:51], v[88:91]
buffer_load_dwordx4 v1, s[44:47], s72 offen offset:2048 sc1 lds
v_mfma_f32_16x16x32_bf16 v[136:139], a[132:135], v[52:55], v[136:139]
v_exp_f32 v168, v168
v_mfma_f32_16x16x32_bf16 v[136:139], a[136:139], v[56:59], v[136:139]
ds_read_b128 a[236:239], v2 offset:11264
v_cvt_pk_bf16_f32 v223, v190, v191
v_mfma_f32_16x16x32_bf16 v[136:139], a[140:143], v[60:63], v[136:139]
v_exp_f32 v169, v169
v_mfma_f32_16x16x32_bf16 v[152:155], a[156:159], v[60:63], v[88:91]
ds_read_b128 a[240:243], v2 offset:12288
v_cvt_pk_bf16_f32 v216, v168, v169
v_mfma_f32_16x16x32_bf16 v[152:155], a[152:155], v[56:59], v[152:155]
v_exp_f32 v170, v170
v_mfma_f32_16x16x32_bf16 v[152:155], a[148:151], v[52:55], v[152:155]
v_exp_f32 v171, v171
v_mfma_f32_16x16x32_bf16 v[152:155], a[144:147], v[48:51], v[152:155]
ds_read_b128 a[244:247], v2 offset:13312
v_cvt_pk_bf16_f32 v217, v170, v171
v_mfma_f32_16x16x32_bf16 v[140:143], a[128:131], v[64:67], v[92:95]
v_exp_f32 v184, v184
v_mfma_f32_16x16x32_bf16 v[140:143], a[132:135], v[68:71], v[140:143]
ds_read_b128 a[248:251], v2 offset:14336
v_mfma_f32_16x16x32_bf16 v[140:143], a[136:139], v[72:75], v[140:143]
v_exp_f32 v185, v185
v_mfma_f32_16x16x32_bf16 v[140:143], a[140:143], v[76:79], v[140:143]
buffer_load_dwordx4 v1, s[44:47], s72 offen offset:3072 sc1 lds
v_mfma_f32_16x16x32_bf16 v[156:159], a[156:159], v[76:79], v[92:95]
ds_read_b128 a[252:255], v2 offset:15360
v_cvt_pk_bf16_f32 v218, v184, v185
v_mfma_f32_16x16x32_bf16 v[156:159], a[152:155], v[72:75], v[156:159]
v_exp_f32 v186, v186
v_mfma_f32_16x16x32_bf16 v[156:159], a[148:151], v[68:71], v[156:159]
s_waitcnt vmcnt(12) lgkmcnt(4)
v_exp_f32 v187, v187
v_mfma_f32_16x16x32_bf16 v[156:159], a[144:147], v[64:67], v[156:159]
s_barrier
v_cvt_pk_bf16_f32 v219, v186, v187
v_add_u32 v2, s82, v1
v_mfma_f32_16x16x32_bf16 v[228:231], v[120:123], v[196:199], v[228:231]
s_xor_b32 s74, s82, 0x10000
v_exp_f32 v136, v136
v_mfma_f32_16x16x32_bf16 v[228:231], v[120:123], v[212:215], v[228:231]
s_add_u32 s74, s74, s64
ds_read_b128 a[128:131], v2 offset:16384
v_add_u32 v5, s92, v5
v_mfma_f32_16x16x32_bf16 v[236:239], v[120:123], v[204:207], v[236:239]
s_add_u32 s81, s81, 0x8000
v_exp_f32 v137, v137
v_mfma_f32_16x16x32_bf16 v[236:239], v[120:123], v[220:223], v[236:239]
s_add_u32 m0, s74, 16384
ds_read_b128 a[132:135], v2 offset:17408
v_cvt_pk_bf16_f32 v200, v136, v137
v_mfma_f32_16x16x32_bf16 a[32:35], a[192:195], v[196:199], a[32:35]
s_add_u32 s72, s81, 16384
buffer_load_dwordx4 v1, s[44:47], s72 offen sc1 lds
v_mfma_f32_16x16x32_bf16 a[32:35], a[224:227], v[212:215], a[32:35]
s_add_u32 s69, s93, 0x4200000
v_exp_f32 v138, v138
v_mfma_f32_16x16x32_bf16 a[96:99], a[224:227], v[220:223], a[96:99]
ds_read_b128 a[136:139], v2 offset:18432
v_cndmask_b32 v5, v250, v5, vcc
v_mfma_f32_16x16x32_bf16 a[96:99], a[192:195], v[204:207], a[96:99]
v_exp_f32 v139, v139
v_mfma_f32_16x16x32_bf16 a[100:103], a[196:199], v[204:207], a[100:103]
ds_read_b128 a[140:143], v2 offset:19456
v_cvt_pk_bf16_f32 v201, v138, v139
v_mfma_f32_16x16x32_bf16 a[100:103], a[228:231], v[220:223], a[100:103]
buffer_store_dwordx4 v[112:115], v1, s[44:47], s69 offen sc1
v_mfma_f32_16x16x32_bf16 a[36:39], a[228:231], v[212:215], a[36:39]
v_exp_f32 v152, v152
v_mfma_f32_16x16x32_bf16 a[36:39], a[196:199], v[196:199], a[36:39]
ds_read_b128 a[144:147], v2 offset:20480
v_add_u32 v253, s58, v251
v_mfma_f32_16x16x32_bf16 a[40:43], a[200:203], v[196:199], a[40:43]
v_exp_f32 v153, v153
v_mfma_f32_16x16x32_bf16 a[40:43], a[232:235], v[212:215], a[40:43]
ds_read_b128 a[148:151], v2 offset:21504
v_cvt_pk_bf16_f32 v202, v152, v153
v_mfma_f32_16x16x32_bf16 a[104:107], a[232:235], v[220:223], a[104:107]
buffer_load_dwordx4 v1, s[44:47], s72 offen offset:1024 sc1 lds
v_mfma_f32_16x16x32_bf16 a[104:107], a[200:203], v[204:207], a[104:107]
v_exp_f32 v154, v154
v_mfma_f32_16x16x32_bf16 a[108:111], a[204:207], v[204:207], a[108:111]
ds_read_b128 a[152:155], v2 offset:22528
v_and_b32 v253, 3, v253
v_mfma_f32_16x16x32_bf16 a[108:111], a[236:239], v[220:223], a[108:111]
v_exp_f32 v155, v155
v_mfma_f32_16x16x32_bf16 a[44:47], a[236:239], v[212:215], a[44:47]
ds_read_b128 a[156:159], v2 offset:23552
v_cvt_pk_bf16_f32 v203, v154, v155
v_mfma_f32_16x16x32_bf16 a[44:47], a[204:207], v[196:199], a[44:47]
buffer_store_dwordx4 v[112:115], v1, s[44:47], s69 offen offset:1024 sc1
v_mfma_f32_16x16x32_bf16 a[48:51], a[208:211], v[196:199], a[48:51]
s_waitcnt lgkmcnt(8)
v_exp_f32 v140, v140
v_mfma_f32_16x16x32_bf16 a[48:51], a[240:243], v[212:215], a[48:51]
ds_read_b128 a[192:195], v2 offset:0
v_mul_u32_u24 v253, 4160, v253
v_mfma_f32_16x16x32_bf16 a[112:115], a[240:243], v[220:223], a[112:115]
v_exp_f32 v141, v141
v_mfma_f32_16x16x32_bf16 a[112:115], a[208:211], v[204:207], a[112:115]
ds_read_b128 a[196:199], v2 offset:1024
v_add_u32 v5, v5, v253
v_mfma_f32_16x16x32_bf16 a[116:119], a[212:215], v[204:207], a[116:119]
s_add_u32 s73, s62, 480
buffer_load_dwordx4 v1, s[44:47], s72 offen offset:2048 sc1 lds
v_mfma_f32_16x16x32_bf16 a[116:119], a[244:247], v[220:223], a[116:119]
v_exp_f32 v142, v142
v_mfma_f32_16x16x32_bf16 a[52:55], a[244:247], v[212:215], a[52:55]
ds_read_b128 a[200:203], v2 offset:2048
v_lshlrev_b32 v248, 5, v240
v_mfma_f32_16x16x32_bf16 a[52:55], a[212:215], v[196:199], a[52:55]
v_exp_f32 v143, v143
v_mfma_f32_16x16x32_bf16 a[56:59], a[216:219], v[196:199], a[56:59]
ds_read_b128 a[204:207], v2 offset:3072
v_sub_u32 v248, s73, v248
v_mfma_f32_16x16x32_bf16 a[56:59], a[248:251], v[212:215], a[56:59]
buffer_store_dwordx4 v[112:115], v1, s[44:47], s69 offen offset:2048 sc1
v_mfma_f32_16x16x32_bf16 a[120:123], a[248:251], v[220:223], a[120:123]
v_exp_f32 v156, v156
v_mfma_f32_16x16x32_bf16 a[120:123], a[216:219], v[204:207], a[120:123]
ds_read_b128 a[208:211], v2 offset:4096
v_lshl_add_u32 v7, v241, 4, v248
v_mfma_f32_16x16x32_bf16 a[124:127], a[220:223], v[204:207], a[124:127]
s_and_b32 s73, s58, 1
v_exp_f32 v157, v157
v_mfma_f32_16x16x32_bf16 a[124:127], a[252:255], v[220:223], a[124:127]
s_lshl_b32 s73, s73, 4
ds_read_b128 a[212:215], v2 offset:5120
v_mfma_f32_16x16x32_bf16 a[60:63], a[252:255], v[212:215], a[60:63]
s_lshr_b32 s73, s90, s73
buffer_load_dwordx4 v1, s[44:47], s72 offen offset:3072 sc1 lds
v_mfma_f32_16x16x32_bf16 a[60:63], a[220:223], v[196:199], a[60:63]
s_and_b32 s73, s73, 0xffff
ds_read_b128 a[216:219], v2 offset:6144
v_cvt_pk_bf16_f32 v204, v140, v141
v_mfma_f32_16x16x32_bf16 v[172:175], a[160:163], v[64:67], v[92:95]
v_exp_f32 v158, v158
v_mfma_f32_16x16x32_bf16 v[172:175], a[164:167], v[68:71], v[172:175]
ds_read_b128 a[220:223], v2 offset:7168
v_cvt_pk_bf16_f32 v205, v142, v143
v_mfma_f32_16x16x32_bf16 v[172:175], a[168:171], v[72:75], v[172:175]
v_exp_f32 v159, v159
v_mfma_f32_16x16x32_bf16 v[172:175], a[172:175], v[76:79], v[172:175]
buffer_store_dwordx4 v[112:115], v1, s[44:47], s69 offen offset:3072 sc1
v_mfma_f32_16x16x32_bf16 v[188:191], a[188:191], v[76:79], v[92:95]
v_cvt_pk_bf16_f32 v206, v156, v157
v_cvt_pk_bf16_f32 v207, v158, v159
v_mfma_f32_16x16x32_bf16 v[188:191], a[184:187], v[72:75], v[188:191]
v_lshl_add_u32 v248, v241, 3, v240
v_sub_u32 v248, 15, v248
v_mfma_f32_16x16x32_bf16 v[188:191], a[180:183], v[68:71], v[188:191]
v_and_b32 v249, 1, v248
v_lshlrev_b32 v249, 4, v249
v_mfma_f32_16x16x32_bf16 v[188:191], a[176:179], v[64:67], v[188:191]
v_lshlrev_b32 v249, v249, s73
v_lshrrev_b32 v248, 1, v248
v_mfma_f32_16x16x32_bf16 v[168:171], a[160:163], v[48:51], v[88:91]
v_and_b32 v241, 3, v0
v_cmp_eq_u32 vcc, 0, v248
v_mfma_f32_16x16x32_bf16 v[168:171], a[164:167], v[52:55], v[168:171]
v_lshl_add_u32 v5, v241, 3, v5
v_cndmask_b32 v8, 0, v249, vcc
v_mfma_f32_16x16x32_bf16 v[168:171], a[168:171], v[56:59], v[168:171]
v_cmp_eq_u32 vcc, 1, v248
v_lshlrev_b32 v240, 4, v251
v_mfma_f32_16x16x32_bf16 v[168:171], a[172:175], v[60:63], v[168:171]
v_cndmask_b32 v9, 0, v249, vcc
v_cmp_eq_u32 vcc, 2, v248
v_mfma_f32_16x16x32_bf16 v[184:187], a[188:191], v[60:63], v[88:91]
v_sub_u32 v240, 48, v240
v_lshlrev_b64 v[12:13], 16, s[88:89]
v_mfma_f32_16x16x32_bf16 v[184:187], a[184:187], v[56:59], v[184:187]
v_cndmask_b32 v10, 0, v249, vcc
v_cmp_eq_u32 vcc, 3, v248
v_mfma_f32_16x16x32_bf16 v[184:187], a[180:183], v[52:55], v[184:187]
v_lshlrev_b64 v[12:13], v240, v[12:13]
v_cndmask_b32 v11, 0, v249, vcc
v_mfma_f32_16x16x32_bf16 v[184:187], a[176:179], v[48:51], v[184:187]
s_waitcnt lgkmcnt(4)
v_cmp_eq_u32 vcc, 3, v241
s_add_u32 s73, s62, 4096
v_lshl_add_u32 v14, v0, 3, s73
v_cndmask_b32 v12, 0, v12, vcc
v_cndmask_b32 v13, 0, v13, vcc
v_lshrrev_b32 v15, 4, v0
v_lshlrev_b32 v15, 1, v15
v_and_b32 v240, 7, v0
v_xor_b32 v15, v15, v240
v_lshlrev_b32 v15, 4, v15
v_lshrrev_b32 v240, 3, v0
v_lshl_add_u32 v15, v240, 11, v15
s_lshr_b32 s75, s59, 1
s_and_b32 s75, s75, 8
s_add_u32 s75, s75, s60
s_lshl_b32 s76, s65, 2
s_lshr_b32 s80, s59, 2
s_and_b32 s80, s80, 3
s_add_u32 s76, s76, s80
s_lshl_b32 s94, s58, 16
s_lshl_b32 s80, s76, 7
s_add_u32 s94, s94, s80
s_lshl_b32 s80, s75, 18
s_add_u32 s80, s80, s94
v_rcp_f32 v224, v224
v_rcp_f32 v228, v228
s_lshl_b32 s73, s59, 12
s_add_u32 s73, s73, 0x2000000
s_lshl_b32 s70, s67, 2
s_add_u32 s70, s70, s73
v_mov_b32 v225, v224
v_accvgpr_read_b32 v240, a0
v_accvgpr_read_b32 v241, a1
v_accvgpr_read_b32 v242, a2
v_accvgpr_read_b32 v243, a3
v_accvgpr_read_b32 v244, a4
v_accvgpr_read_b32 v245, a5
v_accvgpr_read_b32 v246, a6
v_accvgpr_read_b32 v247, a7
v_pk_mul_f32 v[240:241], v[240:241], v[224:225]
v_pk_mul_f32 v[242:243], v[242:243], v[224:225]
v_pk_mul_f32 v[244:245], v[244:245], v[224:225]
v_pk_mul_f32 v[246:247], v[246:247], v[224:225]
v_cvt_pk_bf16_f32 v128, v240, v241
v_cvt_pk_bf16_f32 v129, v242, v243
v_cvt_pk_bf16_f32 v130, v244, v245
v_cvt_pk_bf16_f32 v131, v246, v247
v_accvgpr_read_b32 v248, a8
v_accvgpr_read_b32 v249, a9
v_accvgpr_read_b32 v250, a10
v_accvgpr_read_b32 v251, a11
v_accvgpr_read_b32 v252, a12
v_accvgpr_read_b32 v253, a13
v_accvgpr_read_b32 v254, a14
v_accvgpr_read_b32 v255, a15
v_pk_mul_f32 v[248:249], v[248:249], v[224:225]
v_pk_mul_f32 v[250:251], v[250:251], v[224:225]
v_pk_mul_f32 v[252:253], v[252:253], v[224:225]
v_pk_mul_f32 v[254:255], v[254:255], v[224:225]
v_cvt_pk_bf16_f32 v144, v248, v249
v_cvt_pk_bf16_f32 v145, v250, v251
v_cvt_pk_bf16_f32 v146, v252, v253
v_cvt_pk_bf16_f32 v147, v254, v255
v_accvgpr_read_b32 v240, a16
v_accvgpr_read_b32 v241, a17
v_accvgpr_read_b32 v242, a18
v_accvgpr_read_b32 v243, a19
v_accvgpr_read_b32 v244, a20
v_accvgpr_read_b32 v245, a21
v_accvgpr_read_b32 v246, a22
v_accvgpr_read_b32 v247, a23
v_pk_mul_f32 v[240:241], v[240:241], v[224:225]
v_pk_mul_f32 v[242:243], v[242:243], v[224:225]
v_pk_mul_f32 v[244:245], v[244:245], v[224:225]
v_pk_mul_f32 v[246:247], v[246:247], v[224:225]
v_cvt_pk_bf16_f32 v160, v240, v241
v_cvt_pk_bf16_f32 v161, v242, v243
v_cvt_pk_bf16_f32 v162, v244, v245
v_cvt_pk_bf16_f32 v163, v246, v247
v_accvgpr_read_b32 v248, a24
v_accvgpr_read_b32 v249, a25
v_accvgpr_read_b32 v250, a26
v_accvgpr_read_b32 v251, a27
v_accvgpr_read_b32 v252, a28
v_accvgpr_read_b32 v253, a29
v_accvgpr_read_b32 v254, a30
v_accvgpr_read_b32 v255, a31
v_pk_mul_f32 v[248:249], v[248:249], v[224:225]
v_pk_mul_f32 v[250:251], v[250:251], v[224:225]
v_pk_mul_f32 v[252:253], v[252:253], v[224:225]
v_pk_mul_f32 v[254:255], v[254:255], v[224:225]
v_cvt_pk_bf16_f32 v176, v248, v249
v_cvt_pk_bf16_f32 v177, v250, v251
v_cvt_pk_bf16_f32 v178, v252, v253
v_cvt_pk_bf16_f32 v179, v254, v255
v_mov_b32 v229, v228
v_accvgpr_read_b32 v240, a32
v_accvgpr_read_b32 v241, a33
v_accvgpr_read_b32 v242, a34
v_accvgpr_read_b32 v243, a35
v_accvgpr_read_b32 v244, a36
v_accvgpr_read_b32 v245, a37
v_accvgpr_read_b32 v246, a38
v_accvgpr_read_b32 v247, a39
v_pk_mul_f32 v[240:241], v[240:241], v[228:229]
v_pk_mul_f32 v[242:243], v[242:243], v[228:229]
v_pk_mul_f32 v[244:245], v[244:245], v[228:229]
v_pk_mul_f32 v[246:247], v[246:247], v[228:229]
v_cvt_pk_bf16_f32 v132, v240, v241
Lstub5:
s_cbranch_execz Lstub9
v_cvt_pk_bf16_f32 v133, v242, v243
v_cvt_pk_bf16_f32 v134, v244, v245
v_cvt_pk_bf16_f32 v135, v246, v247
v_accvgpr_read_b32 v248, a40
v_accvgpr_read_b32 v249, a41
v_accvgpr_read_b32 v250, a42
v_accvgpr_read_b32 v251, a43
v_accvgpr_read_b32 v252, a44
v_accvgpr_read_b32 v253, a45
v_accvgpr_read_b32 v254, a46
v_accvgpr_read_b32 v255, a47
v_pk_mul_f32 v[248:249], v[248:249], v[228:229]
v_pk_mul_f32 v[250:251], v[250:251], v[228:229]
v_pk_mul_f32 v[252:253], v[252:253], v[228:229]
v_pk_mul_f32 v[254:255], v[254:255], v[228:229]
v_cvt_pk_bf16_f32 v148, v248, v249
v_cvt_pk_bf16_f32 v149, v250, v251
v_cvt_pk_bf16_f32 v150, v252, v253
v_cvt_pk_bf16_f32 v151, v254, v255
v_accvgpr_read_b32 v240, a48
v_accvgpr_read_b32 v241, a49
v_accvgpr_read_b32 v242, a50
v_accvgpr_read_b32 v243, a51
v_accvgpr_read_b32 v244, a52
v_accvgpr_read_b32 v245, a53
v_accvgpr_read_b32 v246, a54
v_accvgpr_read_b32 v247, a55
v_pk_mul_f32 v[240:241], v[240:241], v[228:229]
v_pk_mul_f32 v[242:243], v[242:243], v[228:229]
v_pk_mul_f32 v[244:245], v[244:245], v[228:229]
v_pk_mul_f32 v[246:247], v[246:247], v[228:229]
v_cvt_pk_bf16_f32 v164, v240, v241
v_cvt_pk_bf16_f32 v165, v242, v243
v_cvt_pk_bf16_f32 v166, v244, v245
v_cvt_pk_bf16_f32 v167, v246, v247
v_accvgpr_read_b32 v248, a56
v_accvgpr_read_b32 v249, a57
v_accvgpr_read_b32 v250, a58
v_accvgpr_read_b32 v251, a59
v_accvgpr_read_b32 v252, a60
v_accvgpr_read_b32 v253, a61
v_accvgpr_read_b32 v254, a62
v_accvgpr_read_b32 v255, a63
v_pk_mul_f32 v[248:249], v[248:249], v[228:229]
v_pk_mul_f32 v[250:251], v[250:251], v[228:229]
v_pk_mul_f32 v[252:253], v[252:253], v[228:229]
v_pk_mul_f32 v[254:255], v[254:255], v[228:229]
v_cvt_pk_bf16_f32 v180, v248, v249
v_cvt_pk_bf16_f32 v181, v250, v251
v_cvt_pk_bf16_f32 v182, v252, v253
v_cvt_pk_bf16_f32 v183, v254, v255
v_mfma_f32_16x16x32_bf16 v[232:235], v[120:123], v[216:219], v[232:235]
s_add_u32 s82, s82, 0x8000
ds_read_b128 a[160:163], v2 offset:24576
ds_read_b128 a[164:167], v2 offset:25600
v_mfma_f32_16x16x32_bf16 v[232:235], v[120:123], v[200:203], v[232:235]
s_and_b32 s82, s82, 0x1ffff
v_exp_f32 v172, v172
v_mfma_f32_16x16x32_bf16 a[64:67], a[224:227], v[216:219], a[64:67]
s_add_u32 m0, s74, 0
v_exp_f32 v173, v173
v_mfma_f32_16x16x32_bf16 a[64:67], a[192:195], v[200:203], a[64:67]
s_add_u32 s72, s81, 0
buffer_load_dwordx4 v1, s[44:47], s72 offen sc1 lds
v_mfma_f32_16x16x32_bf16 a[68:71], a[196:199], v[200:203], a[68:71]
ds_read_b128 a[168:171], v2 offset:26624
v_cvt_pk_bf16_f32 v220, v172, v173
v_mfma_f32_16x16x32_bf16 a[68:71], a[228:231], v[216:219], a[68:71]
v_exp_f32 v174, v174
v_mfma_f32_16x16x32_bf16 a[72:75], a[232:235], v[216:219], a[72:75]
s_nop 0
ds_read_b128 a[172:175], v2 offset:27648
ds_read_b128 a[176:179], v2 offset:28672
v_mfma_f32_16x16x32_bf16 a[72:75], a[200:203], v[200:203], a[72:75]
v_exp_f32 v175, v175
v_mfma_f32_16x16x32_bf16 a[76:79], a[204:207], v[200:203], a[76:79]
v_exp_f32 v188, v188
v_mfma_f32_16x16x32_bf16 a[76:79], a[236:239], v[216:219], a[76:79]
buffer_store_dwordx4 v[128:131], v1, s[44:47], s70 offen sc1
v_mfma_f32_16x16x32_bf16 a[80:83], a[240:243], v[216:219], a[80:83]
s_waitcnt lgkmcnt(5)
ds_read_b128 a[180:183], v2 offset:29696
v_cvt_pk_bf16_f32 v221, v174, v175
v_mfma_f32_16x16x32_bf16 a[80:83], a[208:211], v[200:203], a[80:83]
v_exp_f32 v189, v189
v_mfma_f32_16x16x32_bf16 a[84:87], a[212:215], v[200:203], a[84:87]
ds_read_b128 a[184:187], v2 offset:30720
v_cvt_pk_bf16_f32 v222, v188, v189
v_mfma_f32_16x16x32_bf16 a[84:87], a[244:247], v[216:219], a[84:87]
v_exp_f32 v190, v190
v_mfma_f32_16x16x32_bf16 a[88:91], a[248:251], v[216:219], a[88:91]
buffer_load_dwordx4 v1, s[44:47], s72 offen offset:1024 sc1 lds
v_mfma_f32_16x16x32_bf16 a[88:91], a[216:219], v[200:203], a[88:91]
s_nop 0
ds_read_b128 a[188:191], v2 offset:31744
ds_read_b128 a[224:227], v2 offset:8192
v_mfma_f32_16x16x32_bf16 a[92:95], a[220:223], v[200:203], a[92:95]
v_exp_f32 v191, v191
v_mfma_f32_16x16x32_bf16 a[92:95], a[252:255], v[216:219], a[92:95]
v_exp_f32 v168, v168
v_mfma_f32_16x16x32_bf16 v[136:139], a[128:131], v[48:51], v[88:91]
ds_read_b128 a[228:231], v2 offset:9216
v_cvt_pk_bf16_f32 v223, v190, v191
v_mfma_f32_16x16x32_bf16 v[136:139], a[132:135], v[52:55], v[136:139]
v_exp_f32 v169, v169
v_mfma_f32_16x16x32_bf16 v[136:139], a[136:139], v[56:59], v[136:139]
buffer_store_dwordx4 v[144:147], v1, s[44:47], s70 offen offset:1024 sc1
v_mfma_f32_16x16x32_bf16 v[136:139], a[140:143], v[60:63], v[136:139]
ds_read_b128 a[232:235], v2 offset:10240
v_cvt_pk_bf16_f32 v216, v168, v169
v_mfma_f32_16x16x32_bf16 v[152:155], a[156:159], v[60:63], v[88:91]
v_exp_f32 v170, v170
v_mfma_f32_16x16x32_bf16 v[152:155], a[152:155], v[56:59], v[152:155]
s_nop 0
ds_read_b128 a[236:239], v2 offset:11264
ds_read_b128 a[240:243], v2 offset:12288
v_mfma_f32_16x16x32_bf16 v[152:155], a[148:151], v[52:55], v[152:155]
v_exp_f32 v171, v171
v_mfma_f32_16x16x32_bf16 v[152:155], a[144:147], v[48:51], v[152:155]
buffer_load_dwordx4 v1, s[44:47], s72 offen offset:2048 sc1 lds
v_mfma_f32_16x16x32_bf16 v[140:143], a[128:131], v[64:67], v[92:95]
v_exp_f32 v184, v184
v_mfma_f32_16x16x32_bf16 v[140:143], a[132:135], v[68:71], v[140:143]
ds_read_b128 a[244:247], v2 offset:13312
v_cvt_pk_bf16_f32 v217, v170, v171
v_mfma_f32_16x16x32_bf16 v[140:143], a[136:139], v[72:75], v[140:143]
v_exp_f32 v185, v185
v_mfma_f32_16x16x32_bf16 v[140:143], a[140:143], v[76:79], v[140:143]
s_nop 0
ds_read_b128 a[248:251], v2 offset:14336
ds_read_b128 a[252:255], v2 offset:15360
v_mfma_f32_16x16x32_bf16 v[156:159], a[156:159], v[76:79], v[92:95]
v_exp_f32 v186, v186
v_mfma_f32_16x16x32_bf16 v[156:159], a[152:155], v[72:75], v[156:159]
buffer_load_dwordx4 v1, s[44:47], s72 offen offset:3072 sc1 lds
v_mfma_f32_16x16x32_bf16 v[156:159], a[148:151], v[68:71], v[156:159]
s_waitcnt vmcnt(14) lgkmcnt(4)
v_exp_f32 v187, v187
v_mfma_f32_16x16x32_bf16 v[156:159], a[144:147], v[64:67], v[156:159]
s_barrier
v_cvt_pk_bf16_f32 v218, v184, v185
v_cvt_pk_bf16_f32 v219, v186, v187
v_add_u32 v2, s82, v1
v_mfma_f32_16x16x32_bf16 v[236:239], v[120:123], v[204:207], v[236:239]
s_xor_b32 s74, s82, 0x10000
v_exp_f32 v136, v136
v_mfma_f32_16x16x32_bf16 v[236:239], v[120:123], v[220:223], v[236:239]
s_add_u32 s74, s74, s64
ds_read_b128 a[128:131], v2 offset:16384
ds_read_b128 a[132:135], v2 offset:17408
v_mfma_f32_16x16x32_bf16 a[96:99], a[192:195], v[204:207], a[96:99]
s_add_u32 s81, s81, 0x8000
v_exp_f32 v137, v137
v_mfma_f32_16x16x32_bf16 a[96:99], a[224:227], v[220:223], a[96:99]
s_add_u32 m0, s74, 16384
v_exp_f32 v138, v138
v_mfma_f32_16x16x32_bf16 a[100:103], a[228:231], v[220:223], a[100:103]
s_add_u32 s72, s81, 16384
buffer_load_dwordx4 v1, s[44:47], s72 offen sc1 lds
v_mfma_f32_16x16x32_bf16 a[100:103], a[196:199], v[204:207], a[100:103]
ds_read_b128 a[136:139], v2 offset:18432
v_cvt_pk_bf16_f32 v200, v136, v137
v_mfma_f32_16x16x32_bf16 a[104:107], a[200:203], v[204:207], a[104:107]
v_exp_f32 v139, v139
v_mfma_f32_16x16x32_bf16 a[104:107], a[232:235], v[220:223], a[104:107]
ds_read_b128 a[140:143], v2 offset:19456
v_cvt_pk_bf16_f32 v201, v138, v139
v_mfma_f32_16x16x32_bf16 a[108:111], a[236:239], v[220:223], a[108:111]
buffer_store_dwordx4 v[160:163], v1, s[44:47], s70 offen offset:2048 sc1
v_mfma_f32_16x16x32_bf16 a[108:111], a[204:207], v[204:207], a[108:111]
v_exp_f32 v152, v152
v_mfma_f32_16x16x32_bf16 a[112:115], a[208:211], v[204:207], a[112:115]
s_waitcnt lgkmcnt(4)
ds_read_b128 a[144:147], v2 offset:20480
ds_read_b128 a[148:151], v2 offset:21504
v_mfma_f32_16x16x32_bf16 a[112:115], a[240:243], v[220:223], a[112:115]
v_exp_f32 v153, v153
v_mfma_f32_16x16x32_bf16 a[116:119], a[244:247], v[220:223], a[116:119]
buffer_load_dwordx4 v1, s[44:47], s72 offen offset:1024 sc1 lds
v_mfma_f32_16x16x32_bf16 a[116:119], a[212:215], v[204:207], a[116:119]
v_exp_f32 v154, v154
v_mfma_f32_16x16x32_bf16 a[120:123], a[216:219], v[204:207], a[120:123]
ds_read_b128 a[152:155], v2 offset:22528
v_cvt_pk_bf16_f32 v202, v152, v153
v_mfma_f32_16x16x32_bf16 a[120:123], a[248:251], v[220:223], a[120:123]
v_exp_f32 v155, v155
v_mfma_f32_16x16x32_bf16 a[124:127], a[252:255], v[220:223], a[124:127]
ds_read_b128 a[156:159], v2 offset:23552
v_cvt_pk_bf16_f32 v203, v154, v155
v_mfma_f32_16x16x32_bf16 a[124:127], a[220:223], v[204:207], a[124:127]
v_exp_f32 v140, v140
v_mfma_f32_16x16x32_bf16 v[172:175], a[160:163], v[64:67], v[92:95]
s_nop 0
ds_read_b128 a[192:195], v2 offset:0
ds_read_b128 a[196:199], v2 offset:1024
v_mfma_f32_16x16x32_bf16 v[172:175], a[164:167], v[68:71], v[172:175]
buffer_store_dwordx4 v[176:179], v1, s[44:47], s70 offen offset:3072 sc1
v_mfma_f32_16x16x32_bf16 v[172:175], a[168:171], v[72:75], v[172:175]
v_exp_f32 v141, v141
v_mfma_f32_16x16x32_bf16 v[172:175], a[172:175], v[76:79], v[172:175]
v_exp_f32 v142, v142
v_mfma_f32_16x16x32_bf16 v[188:191], a[188:191], v[76:79], v[92:95]
s_nop 0
ds_read_b128 a[200:203], v2 offset:2048
ds_read_b128 a[204:207], v2 offset:3072
v_mfma_f32_16x16x32_bf16 v[188:191], a[184:187], v[72:75], v[188:191]
buffer_load_dwordx4 v1, s[44:47], s72 offen offset:2048 sc1 lds
v_mfma_f32_16x16x32_bf16 v[188:191], a[180:183], v[68:71], v[188:191]
s_add_u32 s70, s70, 0x80000
v_exp_f32 v143, v143
v_mfma_f32_16x16x32_bf16 v[188:191], a[176:179], v[64:67], v[188:191]
v_exp_f32 v156, v156
v_mfma_f32_16x16x32_bf16 v[168:171], a[160:163], v[48:51], v[88:91]
s_nop 0
ds_read_b128 a[208:211], v2 offset:4096
ds_read_b128 a[212:215], v2 offset:5120
v_mfma_f32_16x16x32_bf16 v[168:171], a[164:167], v[52:55], v[168:171]
s_nop 0
ds_read_b128 a[216:219], v2 offset:6144
ds_read_b128 a[220:223], v2 offset:7168
v_mfma_f32_16x16x32_bf16 v[168:171], a[168:171], v[56:59], v[168:171]
v_cvt_pk_bf16_f32 v204, v140, v141
v_cvt_pk_bf16_f32 v205, v142, v143
v_mfma_f32_16x16x32_bf16 v[168:171], a[172:175], v[60:63], v[168:171]
buffer_store_dwordx4 v[132:135], v1, s[44:47], s70 offen sc1
v_mfma_f32_16x16x32_bf16 v[184:187], a[188:191], v[60:63], v[88:91]
v_exp_f32 v157, v157
v_mfma_f32_16x16x32_bf16 v[184:187], a[184:187], v[56:59], v[184:187]
v_exp_f32 v158, v158
v_mfma_f32_16x16x32_bf16 v[184:187], a[180:183], v[52:55], v[184:187]
buffer_load_dwordx4 v1, s[44:47], s72 offen offset:3072 sc1 lds
v_mfma_f32_16x16x32_bf16 v[184:187], a[176:179], v[48:51], v[184:187]
s_waitcnt lgkmcnt(4)
v_exp_f32 v159, v159
v_cvt_pk_bf16_f32 v206, v156, v157
v_cvt_pk_bf16_f32 v207, v158, v159
v_mfma_f32_16x16x32_bf16 v[232:235], v[120:123], v[216:219], v[232:235]
s_add_u32 s82, s82, 0x8000
ds_read_b128 a[160:163], v2 offset:24576
ds_read_b128 a[164:167], v2 offset:25600
v_mfma_f32_16x16x32_bf16 v[232:235], v[120:123], v[200:203], v[232:235]
s_and_b32 s82, s82, 0x1ffff
v_exp_f32 v172, v172
v_mfma_f32_16x16x32_bf16 a[64:67], a[224:227], v[216:219], a[64:67]
s_add_u32 m0, s74, 0
v_exp_f32 v173, v173
v_mfma_f32_16x16x32_bf16 a[64:67], a[192:195], v[200:203], a[64:67]
s_add_u32 s72, s81, 0
buffer_load_dwordx4 v1, s[44:47], s72 offen sc1 lds
v_mfma_f32_16x16x32_bf16 a[68:71], a[196:199], v[200:203], a[68:71]
ds_read_b128 a[168:171], v2 offset:26624
v_cvt_pk_bf16_f32 v220, v172, v173
v_mfma_f32_16x16x32_bf16 a[68:71], a[228:231], v[216:219], a[68:71]
v_exp_f32 v174, v174
v_mfma_f32_16x16x32_bf16 a[72:75], a[232:235], v[216:219], a[72:75]
s_nop 0
ds_read_b128 a[172:175], v2 offset:27648
ds_read_b128 a[176:179], v2 offset:28672
v_mfma_f32_16x16x32_bf16 a[72:75], a[200:203], v[200:203], a[72:75]
v_exp_f32 v175, v175
v_mfma_f32_16x16x32_bf16 a[76:79], a[204:207], v[200:203], a[76:79]
buffer_store_dwordx4 v[148:151], v1, s[44:47], s70 offen offset:1024 sc1
v_mfma_f32_16x16x32_bf16 a[76:79], a[236:239], v[216:219], a[76:79]
v_exp_f32 v188, v188
v_mfma_f32_16x16x32_bf16 a[80:83], a[240:243], v[216:219], a[80:83]
s_waitcnt lgkmcnt(5)
ds_read_b128 a[180:183], v2 offset:29696
v_cvt_pk_bf16_f32 v221, v174, v175
v_mfma_f32_16x16x32_bf16 a[80:83], a[208:211], v[200:203], a[80:83]
v_exp_f32 v189, v189
v_mfma_f32_16x16x32_bf16 a[84:87], a[212:215], v[200:203], a[84:87]
buffer_load_dwordx4 v1, s[44:47], s72 offen offset:1024 sc1 lds
v_mfma_f32_16x16x32_bf16 a[84:87], a[244:247], v[216:219], a[84:87]
ds_read_b128 a[184:187], v2 offset:30720
v_cvt_pk_bf16_f32 v222, v188, v189
v_mfma_f32_16x16x32_bf16 a[88:91], a[248:251], v[216:219], a[88:91]
v_exp_f32 v190, v190
v_mfma_f32_16x16x32_bf16 a[88:91], a[216:219], v[200:203], a[88:91]
s_nop 0
ds_read_b128 a[188:191], v2 offset:31744
ds_read_b128 a[224:227], v2 offset:8192
v_mfma_f32_16x16x32_bf16 a[92:95], a[220:223], v[200:203], a[92:95]
v_exp_f32 v191, v191
v_mfma_f32_16x16x32_bf16 a[92:95], a[252:255], v[216:219], a[92:95]
buffer_store_dwordx4 v[164:167], v1, s[44:47], s70 offen offset:2048 sc1
v_mfma_f32_16x16x32_bf16 v[136:139], a[128:131], v[48:51], v[88:91]
v_exp_f32 v168, v168
v_mfma_f32_16x16x32_bf16 v[136:139], a[132:135], v[52:55], v[136:139]
ds_read_b128 a[228:231], v2 offset:9216
v_cvt_pk_bf16_f32 v223, v190, v191
v_mfma_f32_16x16x32_bf16 v[136:139], a[136:139], v[56:59], v[136:139]
v_exp_f32 v169, v169
v_mfma_f32_16x16x32_bf16 v[136:139], a[140:143], v[60:63], v[136:139]
s_nop 0
ds_read_b128 a[232:235], v2 offset:10240
ds_read_b128 a[236:239], v2 offset:11264
v_mfma_f32_16x16x32_bf16 v[152:155], a[156:159], v[60:63], v[88:91]
v_exp_f32 v170, v170
v_mfma_f32_16x16x32_bf16 v[152:155], a[152:155], v[56:59], v[152:155]
buffer_load_dwordx4 v1, s[44:47], s72 offen offset:2048 sc1 lds
v_mfma_f32_16x16x32_bf16 v[152:155], a[148:151], v[52:55], v[152:155]
v_exp_f32 v171, v171
v_mfma_f32_16x16x32_bf16 v[152:155], a[144:147], v[48:51], v[152:155]
s_nop 0
ds_read_b128 a[240:243], v2 offset:12288
ds_read_b128 a[244:247], v2 offset:13312
v_mfma_f32_16x16x32_bf16 v[140:143], a[128:131], v[64:67], v[92:95]
v_exp_f32 v184, v184
v_mfma_f32_16x16x32_bf16 v[140:143], a[132:135], v[68:71], v[140:143]
s_nop 0
ds_read_b128 a[248:251], v2 offset:14336
ds_read_b128 a[252:255], v2 offset:15360
v_mfma_f32_16x16x32_bf16 v[140:143], a[136:139], v[72:75], v[140:143]
v_cvt_pk_bf16_f32 v216, v168, v169
v_cvt_pk_bf16_f32 v217, v170, v171
v_mfma_f32_16x16x32_bf16 v[140:143], a[140:143], v[76:79], v[140:143]
buffer_store_dwordx4 v[180:183], v1, s[44:47], s70 offen offset:3072 sc1
v_mfma_f32_16x16x32_bf16 v[156:159], a[156:159], v[76:79], v[92:95]
v_exp_f32 v185, v185
v_mfma_f32_16x16x32_bf16 v[156:159], a[152:155], v[72:75], v[156:159]
buffer_load_dwordx4 v1, s[44:47], s72 offen offset:3072 sc1 lds
v_mfma_f32_16x16x32_bf16 v[156:159], a[148:151], v[68:71], v[156:159]
s_waitcnt vmcnt(14) lgkmcnt(4)
v_exp_f32 v186, v186
v_mfma_f32_16x16x32_bf16 v[156:159], a[144:147], v[64:67], v[156:159]
s_barrier
v_exp_f32 v187, v187
v_add_u32 v2, s82, v1
v_cvt_pk_bf16_f32 v218, v184, v185
v_cvt_pk_bf16_f32 v219, v186, v187
s_lshl_b32 s83, s60, 2
s_sub_u32 s83, s83, 25
.p2align 5
s_nop 0
s_nop 0
LloopII:
v_mfma_f32_16x16x32_bf16 v[236:239], v[120:123], v[204:207], v[236:239]
s_xor_b32 s74, s82, 0x10000
v_exp_f32 v136, v136
v_mfma_f32_16x16x32_bf16 v[236:239], v[120:123], v[220:223], v[236:239]
s_add_u32 s74, s74, s64
ds_read_b128 a[128:131], v2 offset:16384
ds_read_b128 a[132:135], v2 offset:17408
v_mfma_f32_16x16x32_bf16 a[96:99], a[192:195], v[204:207], a[96:99]
s_add_u32 s81, s81, 0x8000
v_exp_f32 v137, v137
v_mfma_f32_16x16x32_bf16 a[96:99], a[224:227], v[220:223], a[96:99]
s_add_u32 m0, s74, 16384
v_exp_f32 v138, v138
v_mfma_f32_16x16x32_bf16 a[100:103], a[228:231], v[220:223], a[100:103]
s_add_u32 s72, s81, 16384
ds_read_b128 a[136:139], v2 offset:18432
v_cvt_pk_bf16_f32 v200, v136, v137
v_mfma_f32_16x16x32_bf16 a[100:103], a[196:199], v[204:207], a[100:103]
buffer_load_dwordx4 v1, s[44:47], s72 offen sc1 lds
v_mfma_f32_16x16x32_bf16 a[104:107], a[200:203], v[204:207], a[104:107]
v_exp_f32 v139, v139
v_mfma_f32_16x16x32_bf16 a[104:107], a[232:235], v[220:223], a[104:107]
ds_read_b128 a[140:143], v2 offset:19456
v_cvt_pk_bf16_f32 v201, v138, v139
v_mfma_f32_16x16x32_bf16 a[108:111], a[236:239], v[220:223], a[108:111]
v_exp_f32 v152, v152
v_mfma_f32_16x16x32_bf16 a[108:111], a[204:207], v[204:207], a[108:111]
s_nop 0
ds_read_b128 a[144:147], v2 offset:20480
ds_read_b128 a[148:151], v2 offset:21504
v_mfma_f32_16x16x32_bf16 a[112:115], a[208:211], v[204:207], a[112:115]
s_waitcnt lgkmcnt(6)
v_exp_f32 v153, v153
v_mfma_f32_16x16x32_bf16 a[112:115], a[240:243], v[220:223], a[112:115]
v_exp_f32 v154, v154
v_mfma_f32_16x16x32_bf16 a[116:119], a[244:247], v[220:223], a[116:119]
ds_read_b128 a[152:155], v2 offset:22528
v_cvt_pk_bf16_f32 v202, v152, v153
v_mfma_f32_16x16x32_bf16 a[116:119], a[212:215], v[204:207], a[116:119]
buffer_load_dwordx4 v1, s[44:47], s72 offen offset:1024 sc1 lds
v_mfma_f32_16x16x32_bf16 a[120:123], a[216:219], v[204:207], a[120:123]
v_exp_f32 v155, v155
v_mfma_f32_16x16x32_bf16 a[120:123], a[248:251], v[220:223], a[120:123]
ds_read_b128 a[156:159], v2 offset:23552
v_cvt_pk_bf16_f32 v203, v154, v155
v_mfma_f32_16x16x32_bf16 a[124:127], a[252:255], v[220:223], a[124:127]
v_exp_f32 v140, v140
v_mfma_f32_16x16x32_bf16 a[124:127], a[220:223], v[204:207], a[124:127]
s_nop 0
ds_read_b128 a[192:195], v2 offset:0
ds_read_b128 a[196:199], v2 offset:1024
v_mfma_f32_16x16x32_bf16 v[172:175], a[160:163], v[64:67], v[92:95]
v_exp_f32 v141, v141
v_mfma_f32_16x16x32_bf16 v[172:175], a[164:167], v[68:71], v[172:175]
v_exp_f32 v142, v142
v_mfma_f32_16x16x32_bf16 v[172:175], a[168:171], v[72:75], v[172:175]
ds_read_b128 a[200:203], v2 offset:2048
v_cvt_pk_bf16_f32 v204, v140, v141
v_mfma_f32_16x16x32_bf16 v[172:175], a[172:175], v[76:79], v[172:175]
buffer_load_dwordx4 v1, s[44:47], s72 offen offset:2048 sc1 lds
v_mfma_f32_16x16x32_bf16 v[188:191], a[188:191], v[76:79], v[92:95]
v_exp_f32 v143, v143
v_mfma_f32_16x16x32_bf16 v[188:191], a[184:187], v[72:75], v[188:191]
ds_read_b128 a[204:207], v2 offset:3072
v_cvt_pk_bf16_f32 v205, v142, v143
v_mfma_f32_16x16x32_bf16 v[188:191], a[180:183], v[68:71], v[188:191]
v_exp_f32 v156, v156
v_mfma_f32_16x16x32_bf16 v[188:191], a[176:179], v[64:67], v[188:191]
ds_read_b128 a[208:211], v2 offset:4096
v_mfma_f32_16x16x32_bf16 v[168:171], a[160:163], v[48:51], v[88:91]
v_exp_f32 v157, v157
v_mfma_f32_16x16x32_bf16 v[168:171], a[164:167], v[52:55], v[168:171]
ds_read_b128 a[212:215], v2 offset:5120
v_cvt_pk_bf16_f32 v206, v156, v157
v_mfma_f32_16x16x32_bf16 v[168:171], a[168:171], v[56:59], v[168:171]
v_exp_f32 v158, v158
v_mfma_f32_16x16x32_bf16 v[168:171], a[172:175], v[60:63], v[168:171]
ds_read_b128 a[216:219], v2 offset:6144
v_mfma_f32_16x16x32_bf16 v[184:187], a[188:191], v[60:63], v[88:91]
buffer_load_dwordx4 v1, s[44:47], s72 offen offset:3072 sc1 lds
v_mfma_f32_16x16x32_bf16 v[184:187], a[184:187], v[56:59], v[184:187]
v_exp_f32 v159, v159
v_mfma_f32_16x16x32_bf16 v[184:187], a[180:183], v[52:55], v[184:187]
ds_read_b128 a[220:223], v2 offset:7168
v_cvt_pk_bf16_f32 v207, v158, v159
v_mfma_f32_16x16x32_bf16 v[184:187], a[176:179], v[48:51], v[184:187]
s_waitcnt lgkmcnt(4)
v_mfma_f32_16x16x32_bf16 v[232:235], v[120:123], v[216:219], v[232:235]
s_add_u32 s82, s82, 0x8000
ds_read_b128 a[160:163], v2 offset:24576
ds_read_b128 a[164:167], v2 offset:25600
v_mfma_f32_16x16x32_bf16 v[232:235], v[120:123], v[200:203], v[232:235]
s_and_b32 s82, s82, 0x1ffff
v_exp_f32 v172, v172
v_mfma_f32_16x16x32_bf16 a[64:67], a[224:227], v[216:219], a[64:67]
s_add_u32 m0, s74, 0
v_exp_f32 v173, v173
v_mfma_f32_16x16x32_bf16 a[64:67], a[192:195], v[200:203], a[64:67]
s_add_u32 s72, s81, 0
ds_read_b128 a[168:171], v2 offset:26624
v_cvt_pk_bf16_f32 v220, v172, v173
v_mfma_f32_16x16x32_bf16 a[68:71], a[196:199], v[200:203], a[68:71]
v_exp_f32 v174, v174
v_mfma_f32_16x16x32_bf16 a[68:71], a[228:231], v[216:219], a[68:71]
buffer_load_dwordx4 v1, s[44:47], s72 offen sc1 lds
v_mfma_f32_16x16x32_bf16 a[72:75], a[232:235], v[216:219], a[72:75]
s_nop 0
ds_read_b128 a[172:175], v2 offset:27648
ds_read_b128 a[176:179], v2 offset:28672
v_mfma_f32_16x16x32_bf16 a[72:75], a[200:203], v[200:203], a[72:75]
v_exp_f32 v175, v175
v_mfma_f32_16x16x32_bf16 a[76:79], a[204:207], v[200:203], a[76:79]
v_exp_f32 v188, v188
v_mfma_f32_16x16x32_bf16 a[76:79], a[236:239], v[216:219], a[76:79]
ds_read_b128 a[180:183], v2 offset:29696
v_cvt_pk_bf16_f32 v221, v174, v175
v_mfma_f32_16x16x32_bf16 a[80:83], a[240:243], v[216:219], a[80:83]
s_waitcnt lgkmcnt(6)
v_exp_f32 v189, v189
v_mfma_f32_16x16x32_bf16 a[80:83], a[208:211], v[200:203], a[80:83]
ds_read_b128 a[184:187], v2 offset:30720
v_cvt_pk_bf16_f32 v222, v188, v189
v_mfma_f32_16x16x32_bf16 a[84:87], a[212:215], v[200:203], a[84:87]
buffer_load_dwordx4 v1, s[44:47], s72 offen offset:1024 sc1 lds
v_mfma_f32_16x16x32_bf16 a[84:87], a[244:247], v[216:219], a[84:87]
v_exp_f32 v190, v190
v_mfma_f32_16x16x32_bf16 a[88:91], a[248:251], v[216:219], a[88:91]
s_nop 0
ds_read_b128 a[188:191], v2 offset:31744
ds_read_b128 a[224:227], v2 offset:8192
v_mfma_f32_16x16x32_bf16 a[88:91], a[216:219], v[200:203], a[88:91]
v_exp_f32 v191, v191
v_mfma_f32_16x16x32_bf16 a[92:95], a[220:223], v[200:203], a[92:95]
v_exp_f32 v168, v168
v_mfma_f32_16x16x32_bf16 a[92:95], a[252:255], v[216:219], a[92:95]
ds_read_b128 a[228:231], v2 offset:9216
v_cvt_pk_bf16_f32 v223, v190, v191
v_mfma_f32_16x16x32_bf16 v[136:139], a[128:131], v[48:51], v[88:91]
v_exp_f32 v169, v169
v_mfma_f32_16x16x32_bf16 v[136:139], a[132:135], v[52:55], v[136:139]
ds_read_b128 a[232:235], v2 offset:10240
v_cvt_pk_bf16_f32 v216, v168, v169
v_mfma_f32_16x16x32_bf16 v[136:139], a[136:139], v[56:59], v[136:139]
buffer_load_dwordx4 v1, s[44:47], s72 offen offset:2048 sc1 lds
v_mfma_f32_16x16x32_bf16 v[136:139], a[140:143], v[60:63], v[136:139]
v_exp_f32 v170, v170
v_mfma_f32_16x16x32_bf16 v[152:155], a[156:159], v[60:63], v[88:91]
s_nop 0
ds_read_b128 a[236:239], v2 offset:11264
ds_read_b128 a[240:243], v2 offset:12288
v_mfma_f32_16x16x32_bf16 v[152:155], a[152:155], v[56:59], v[152:155]
v_exp_f32 v171, v171
v_mfma_f32_16x16x32_bf16 v[152:155], a[148:151], v[52:55], v[152:155]
v_exp_f32 v184, v184
v_mfma_f32_16x16x32_bf16 v[152:155], a[144:147], v[48:51], v[152:155]
ds_read_b128 a[244:247], v2 offset:13312
v_cvt_pk_bf16_f32 v217, v170, v171
v_mfma_f32_16x16x32_bf16 v[140:143], a[128:131], v[64:67], v[92:95]
v_exp_f32 v185, v185
v_mfma_f32_16x16x32_bf16 v[140:143], a[132:135], v[68:71], v[140:143]
ds_read_b128 a[248:251], v2 offset:14336
v_cvt_pk_bf16_f32 v218, v184, v185
v_mfma_f32_16x16x32_bf16 v[140:143], a[136:139], v[72:75], v[140:143]
buffer_load_dwordx4 v1, s[44:47], s72 offen offset:3072 sc1 lds
v_mfma_f32_16x16x32_bf16 v[140:143], a[140:143], v[76:79], v[140:143]
ds_read_b128 a[252:255], v2 offset:15360
v_add_u32 v2, s82, v1
v_mfma_f32_16x16x32_bf16 v[156:159], a[156:159], v[76:79], v[92:95]
s_waitcnt vmcnt(8) lgkmcnt(4)
v_exp_f32 v186, v186
v_mfma_f32_16x16x32_bf16 v[156:159], a[152:155], v[72:75], v[156:159]
s_barrier
v_exp_f32 v187, v187
v_mfma_f32_16x16x32_bf16 v[156:159], a[148:151], v[68:71], v[156:159]
s_add_u32 s83, s83, 1
v_cvt_pk_bf16_f32 v219, v186, v187
v_mfma_f32_16x16x32_bf16 v[156:159], a[144:147], v[64:67], v[156:159]
s_cbranch_scc0 LloopII
v_mfma_f32_16x16x32_bf16 v[236:239], v[120:123], v[204:207], v[236:239]
s_xor_b32 s74, s82, 0x10000
ds_read_b128 a[128:131], v2 offset:16384
ds_read_b128 a[132:135], v2 offset:17408
v_mfma_f32_16x16x32_bf16 v[236:239], v[120:123], v[220:223], v[236:239]
s_add_u32 s74, s74, s64
v_exp_f32 v136, v136
v_mfma_f32_16x16x32_bf16 a[96:99], a[192:195], v[204:207], a[96:99]
s_add_u32 s81, s81, 0x8000
v_exp_f32 v137, v137
v_mfma_f32_16x16x32_bf16 a[96:99], a[224:227], v[220:223], a[96:99]
s_add_u32 m0, s74, 0
ds_read_b128 a[136:139], v2 offset:18432
v_cvt_pk_bf16_f32 v200, v136, v137
v_mfma_f32_16x16x32_bf16 a[100:103], a[228:231], v[220:223], a[100:103]
s_add_u32 s72, s81, 0
v_exp_f32 v138, v138
v_mfma_f32_16x16x32_bf16 a[100:103], a[196:199], v[204:207], a[100:103]
buffer_load_dwordx4 v1, s[44:47], s72 offen sc1 lds
v_mfma_f32_16x16x32_bf16 a[104:107], a[200:203], v[204:207], a[104:107]
s_nop 0
ds_read_b128 a[140:143], v2 offset:19456
ds_read_b128 a[144:147], v2 offset:20480
v_mfma_f32_16x16x32_bf16 a[104:107], a[232:235], v[220:223], a[104:107]
v_exp_f32 v139, v139
v_mfma_f32_16x16x32_bf16 a[108:111], a[236:239], v[220:223], a[108:111]
v_exp_f32 v152, v152
v_mfma_f32_16x16x32_bf16 a[108:111], a[204:207], v[204:207], a[108:111]
ds_read_b128 a[148:151], v2 offset:21504
v_cvt_pk_bf16_f32 v201, v138, v139
v_mfma_f32_16x16x32_bf16 a[112:115], a[208:211], v[204:207], a[112:115]
s_waitcnt lgkmcnt(6)
v_exp_f32 v153, v153
v_mfma_f32_16x16x32_bf16 a[112:115], a[240:243], v[220:223], a[112:115]
ds_read_b128 a[152:155], v2 offset:22528
v_cvt_pk_bf16_f32 v202, v152, v153
v_mfma_f32_16x16x32_bf16 a[116:119], a[244:247], v[220:223], a[116:119]
v_exp_f32 v154, v154
v_mfma_f32_16x16x32_bf16 a[116:119], a[212:215], v[204:207], a[116:119]
buffer_load_dwordx4 v1, s[44:47], s72 offen offset:1024 sc1 lds
v_mfma_f32_16x16x32_bf16 a[120:123], a[216:219], v[204:207], a[120:123]
s_nop 0
ds_read_b128 a[156:159], v2 offset:23552
ds_read_b128 a[192:195], v2 offset:0
v_mfma_f32_16x16x32_bf16 a[120:123], a[248:251], v[220:223], a[120:123]
v_exp_f32 v155, v155
v_mfma_f32_16x16x32_bf16 a[124:127], a[252:255], v[220:223], a[124:127]
v_exp_f32 v140, v140
v_mfma_f32_16x16x32_bf16 a[124:127], a[220:223], v[204:207], a[124:127]
ds_read_b128 a[196:199], v2 offset:1024
v_cvt_pk_bf16_f32 v203, v154, v155
v_mfma_f32_16x16x32_bf16 v[172:175], a[160:163], v[64:67], v[92:95]
v_exp_f32 v141, v141
v_mfma_f32_16x16x32_bf16 v[172:175], a[164:167], v[68:71], v[172:175]
ds_read_b128 a[200:203], v2 offset:2048
v_cvt_pk_bf16_f32 v204, v140, v141
v_mfma_f32_16x16x32_bf16 v[172:175], a[168:171], v[72:75], v[172:175]
v_exp_f32 v142, v142
v_mfma_f32_16x16x32_bf16 v[172:175], a[172:175], v[76:79], v[172:175]
buffer_load_dwordx4 v1, s[44:47], s72 offen offset:2048 sc1 lds
v_mfma_f32_16x16x32_bf16 v[188:191], a[188:191], v[76:79], v[92:95]
ds_read_b128 a[204:207], v2 offset:3072
v_mfma_f32_16x16x32_bf16 v[188:191], a[184:187], v[72:75], v[188:191]
v_exp_f32 v143, v143
v_mfma_f32_16x16x32_bf16 v[188:191], a[180:183], v[68:71], v[188:191]
ds_read_b128 a[208:211], v2 offset:4096
v_cvt_pk_bf16_f32 v205, v142, v143
v_mfma_f32_16x16x32_bf16 v[188:191], a[176:179], v[64:67], v[188:191]
Lstub6:
s_cbranch_execz Lstub10
v_exp_f32 v156, v156
v_mfma_f32_16x16x32_bf16 v[168:171], a[160:163], v[48:51], v[88:91]
ds_read_b128 a[212:215], v2 offset:5120
v_mfma_f32_16x16x32_bf16 v[168:171], a[164:167], v[52:55], v[168:171]
v_exp_f32 v157, v157
v_mfma_f32_16x16x32_bf16 v[168:171], a[168:171], v[56:59], v[168:171]
ds_read_b128 a[216:219], v2 offset:6144
v_cvt_pk_bf16_f32 v206, v156, v157
v_mfma_f32_16x16x32_bf16 v[168:171], a[172:175], v[60:63], v[168:171]
buffer_load_dwordx4 v1, s[44:47], s72 offen offset:3072 sc1 lds
v_mfma_f32_16x16x32_bf16 v[184:187], a[188:191], v[60:63], v[88:91]
v_exp_f32 v158, v158
v_mfma_f32_16x16x32_bf16 v[184:187], a[184:187], v[56:59], v[184:187]
ds_read_b128 a[220:223], v2 offset:7168
v_mfma_f32_16x16x32_bf16 v[184:187], a[180:183], v[52:55], v[184:187]
s_waitcnt lgkmcnt(4)
v_exp_f32 v159, v159
v_mfma_f32_16x16x32_bf16 v[184:187], a[176:179], v[48:51], v[184:187]
s_barrier
v_cvt_pk_bf16_f32 v207, v158, v159
s_lshr_b32 s69, s93, 4
s_and_b32 s69, s69, 0x7f00
s_add_u32 s69, s69, LHT4-Lpc0
v_lshrrev_b32 v3, 5, v0
v_lshlrev_b32 v3, 7, v3
v_add_u32 v3, s69, v3
v_min_u32 v3, Lcode_end-Lpc0, v3
global_load_dword v4, v3, s[98:99]
v_mfma_f32_16x16x32_bf16 v[232:235], v[120:123], v[216:219], v[232:235]
s_add_u32 s82, s82, 0x8000
ds_read_b128 a[160:163], v2 offset:24576
ds_read_b128 a[164:167], v2 offset:25600
v_mfma_f32_16x16x32_bf16 v[232:235], v[120:123], v[200:203], v[232:235]
s_and_b32 s82, s82, 0x1ffff
v_exp_f32 v172, v172
v_mfma_f32_16x16x32_bf16 a[64:67], a[224:227], v[216:219], a[64:67]
s_add_u32 s66, s58, 3
v_exp_f32 v173, v173
v_mfma_f32_16x16x32_bf16 a[64:67], a[192:195], v[200:203], a[64:67]
s_and_b32 s66, s66, 3
ds_read_b128 a[168:171], v2 offset:26624
v_cvt_pk_bf16_f32 v220, v172, v173
v_mfma_f32_16x16x32_bf16 a[68:71], a[196:199], v[200:203], a[68:71]
s_mul_i32 s66, s66, 4160
v_exp_f32 v174, v174
v_mfma_f32_16x16x32_bf16 a[68:71], a[228:231], v[216:219], a[68:71]
s_add_u32 s66, s66, s92
ds_read_b128 a[172:175], v2 offset:27648
ds_read_b128 a[176:179], v2 offset:28672
v_mfma_f32_16x16x32_bf16 a[72:75], a[232:235], v[216:219], a[72:75]
s_add_u32 m0, s66, 32
v_exp_f32 v175, v175
v_mfma_f32_16x16x32_bf16 a[72:75], a[200:203], v[200:203], a[72:75]
s_add_u32 s72, s93, 0x6
buffer_load_dwordx4 v1, s[36:39], s72 offen lds
v_mfma_f32_16x16x32_bf16 a[76:79], a[204:207], v[200:203], a[76:79]
v_exp_f32 v188, v188
v_mfma_f32_16x16x32_bf16 a[76:79], a[236:239], v[216:219], a[76:79]
ds_read_b128 a[180:183], v2 offset:29696
v_cvt_pk_bf16_f32 v221, v174, v175
v_mfma_f32_16x16x32_bf16 a[80:83], a[240:243], v[216:219], a[80:83]
s_waitcnt lgkmcnt(6)
v_exp_f32 v189, v189
v_mfma_f32_16x16x32_bf16 a[80:83], a[208:211], v[200:203], a[80:83]
ds_read_b128 a[184:187], v2 offset:30720
v_cvt_pk_bf16_f32 v222, v188, v189
v_mfma_f32_16x16x32_bf16 a[84:87], a[212:215], v[200:203], a[84:87]
v_exp_f32 v190, v190
v_mfma_f32_16x16x32_bf16 a[84:87], a[244:247], v[216:219], a[84:87]
buffer_load_dwordx4 v1, s[36:39], s72 offen offset:1024 lds
v_mfma_f32_16x16x32_bf16 a[88:91], a[248:251], v[216:219], a[88:91]
s_nop 0
ds_read_b128 a[188:191], v2 offset:31744
ds_read_b128 a[224:227], v2 offset:8192
v_mfma_f32_16x16x32_bf16 a[88:91], a[216:219], v[200:203], a[88:91]
v_exp_f32 v191, v191
v_mfma_f32_16x16x32_bf16 a[92:95], a[220:223], v[200:203], a[92:95]
v_exp_f32 v168, v168
v_mfma_f32_16x16x32_bf16 a[92:95], a[252:255], v[216:219], a[92:95]
ds_read_b128 a[228:231], v2 offset:9216
v_cvt_pk_bf16_f32 v223, v190, v191
s_cmp_eq_u32 s58, 0
s_cbranch_scc1 Lta28
s_cmp_eq_u32 s58, 1
s_cbranch_scc1 Lnt29
v_mfma_f32_16x16x32_bf16 v[136:139], a[128:131], v[48:51], v[88:91]
v_exp_f32 v169, v169
v_mfma_f32_16x16x32_bf16 v[152:155], a[144:147], v[48:51], v[88:91]
ds_read_b128 a[232:235], v2 offset:10240
v_cvt_pk_bf16_f32 v216, v168, v169
s_branch Ljoin30
Lta28:
v_mfma_f32_16x16x32_bf16 v[136:139], a[128:131], v[48:51], v[104:107]
v_exp_f32 v169, v169
v_mfma_f32_16x16x32_bf16 v[152:155], a[144:147], v[48:51], v[112:115]
ds_read_b128 a[232:235], v2 offset:10240
v_cvt_pk_bf16_f32 v216, v168, v169
s_branch Ljoin30
Lnt29:
v_mfma_f32_16x16x32_bf16 v[136:139], a[128:131], v[48:51], v[88:91]
v_exp_f32 v169, v169
v_mfma_f32_16x16x32_bf16 v[152:155], a[144:147], v[48:51], v[104:107]
ds_read_b128 a[232:235], v2 offset:10240
v_cvt_pk_bf16_f32 v216, v168, v169
Ljoin30:
v_mfma_f32_16x16x32_bf16 v[136:139], a[132:135], v[52:55], v[136:139]
v_exp_f32 v170, v170
v_mfma_f32_16x16x32_bf16 v[136:139], a[136:139], v[56:59], v[136:139]
buffer_load_dwordx4 v1, s[36:39], s72 offen offset:2048 lds
v_mfma_f32_16x16x32_bf16 v[136:139], a[140:143], v[60:63], v[136:139]
ds_read_b128 a[236:239], v2 offset:11264
v_mfma_f32_16x16x32_bf16 v[152:155], a[156:159], v[60:63], v[152:155]
v_exp_f32 v171, v171
v_mfma_f32_16x16x32_bf16 v[152:155], a[152:155], v[56:59], v[152:155]
ds_read_b128 a[240:243], v2 offset:12288
v_cvt_pk_bf16_f32 v217, v170, v171
v_mfma_f32_16x16x32_bf16 v[152:155], a[148:151], v[52:55], v[152:155]
v_exp_f32 v184, v184
v_mfma_f32_16x16x32_bf16 v[140:143], a[128:131], v[64:67], v[92:95]
ds_read_b128 a[244:247], v2 offset:13312
v_mfma_f32_16x16x32_bf16 v[140:143], a[132:135], v[68:71], v[140:143]
v_exp_f32 v185, v185
v_mfma_f32_16x16x32_bf16 v[140:143], a[136:139], v[72:75], v[140:143]
ds_read_b128 a[248:251], v2 offset:14336
v_cvt_pk_bf16_f32 v218, v184, v185
v_mfma_f32_16x16x32_bf16 v[140:143], a[140:143], v[76:79], v[140:143]
buffer_load_dwordx4 v1, s[36:39], s72 offen offset:3072 lds
v_mfma_f32_16x16x32_bf16 v[156:159], a[156:159], v[76:79], v[92:95]
v_exp_f32 v186, v186
v_mfma_f32_16x16x32_bf16 v[156:159], a[152:155], v[72:75], v[156:159]
ds_read_b128 a[252:255], v2 offset:15360
v_add_u32 v2, s82, v1
v_mfma_f32_16x16x32_bf16 v[156:159], a[148:151], v[68:71], v[156:159]
s_waitcnt vmcnt(9) lgkmcnt(0)
v_exp_f32 v187, v187
v_mfma_f32_16x16x32_bf16 v[156:159], a[144:147], v[64:67], v[156:159]
s_barrier
v_cvt_pk_bf16_f32 v219, v186, v187
v_mfma_f32_16x16x32_bf16 v[236:239], v[120:123], v[204:207], v[236:239]
s_mov_b32 m0, s62
v_exp_f32 v136, v136
v_mfma_f32_16x16x32_bf16 v[236:239], v[120:123], v[220:223], v[236:239]
s_add_u32 s72, s93, 0x3000000
ds_read_b128 a[128:131], v2 offset:16384
ds_read_b128 a[132:135], v2 offset:17408
v_mfma_f32_16x16x32_bf16 a[96:99], a[192:195], v[204:207], a[96:99]
s_add_u32 s78, s59, 4
v_exp_f32 v137, v137
v_mfma_f32_16x16x32_bf16 a[96:99], a[224:227], v[220:223], a[96:99]
s_and_b32 s78, s78, 12
buffer_load_dwordx4 v1, s[44:47], s72 offen sc1 lds
v_mfma_f32_16x16x32_bf16 a[100:103], a[228:231], v[220:223], a[100:103]
s_and_b32 s12, s59, 16
v_exp_f32 v138, v138
v_mfma_f32_16x16x32_bf16 a[100:103], a[196:199], v[204:207], a[100:103]
s_or_b32 s78, s78, s12
ds_read_b128 a[136:139], v2 offset:18432
v_cvt_pk_bf16_f32 v200, v136, v137
v_mfma_f32_16x16x32_bf16 a[104:107], a[200:203], v[204:207], a[104:107]
s_add_u32 s12, s61, 0
v_exp_f32 v139, v139
v_mfma_f32_16x16x32_bf16 a[104:107], a[232:235], v[220:223], a[104:107]
s_and_b32 s12, s12, 3
ds_read_b128 a[140:143], v2 offset:19456
v_cvt_pk_bf16_f32 v201, v138, v139
v_mfma_f32_16x16x32_bf16 a[108:111], a[236:239], v[220:223], a[108:111]
s_add_u32 s12, s12, s78
v_exp_f32 v152, v152
v_mfma_f32_16x16x32_bf16 a[108:111], a[204:207], v[204:207], a[108:111]
s_lshl_b32 s12, s12, 18
ds_read_b128 a[144:147], v2 offset:20480
ds_read_b128 a[148:151], v2 offset:21504
v_mfma_f32_16x16x32_bf16 a[112:115], a[208:211], v[204:207], a[112:115]
s_waitcnt lgkmcnt(6)
buffer_load_dwordx4 v1, s[44:47], s72 offen offset:1024 sc1 lds
v_mfma_f32_16x16x32_bf16 a[112:115], a[240:243], v[220:223], a[112:115]
s_add_u32 s12, s12, s94
v_exp_f32 v153, v153
v_mfma_f32_16x16x32_bf16 a[116:119], a[244:247], v[220:223], a[116:119]
s_add_u32 s13, s61, 1
v_exp_f32 v154, v154
v_mfma_f32_16x16x32_bf16 a[116:119], a[212:215], v[204:207], a[116:119]
s_and_b32 s13, s13, 3
ds_read_b128 a[152:155], v2 offset:22528
v_cvt_pk_bf16_f32 v202, v152, v153
v_mfma_f32_16x16x32_bf16 a[120:123], a[216:219], v[204:207], a[120:123]
s_add_u32 s13, s13, s78
buffer_load_dwordx4 v1, s[44:47], s72 offen offset:2048 sc1 lds
v_mfma_f32_16x16x32_bf16 a[120:123], a[248:251], v[220:223], a[120:123]
s_lshl_b32 s13, s13, 18
v_exp_f32 v155, v155
v_mfma_f32_16x16x32_bf16 a[124:127], a[252:255], v[220:223], a[124:127]
s_add_u32 s13, s13, s94
ds_read_b128 a[156:159], v2 offset:23552
v_cvt_pk_bf16_f32 v203, v154, v155
v_mfma_f32_16x16x32_bf16 a[124:127], a[220:223], v[204:207], a[124:127]
s_add_u32 s14, s61, 2
v_exp_f32 v140, v140
s_cmp_eq_u32 s58, 2
s_cbranch_scc1 Lta31
s_cmp_eq_u32 s58, 3
s_cbranch_scc1 Lnt32
v_mfma_f32_16x16x32_bf16 v[168:171], a[160:163], v[48:51], v[112:115]
s_and_b32 s14, s14, 3
ds_read_b128 a[192:195], v2 offset:0
ds_read_b128 a[196:199], v2 offset:1024
v_mfma_f32_16x16x32_bf16 v[184:187], a[176:179], v[48:51], v[112:115]
s_add_u32 s14, s14, s78
v_exp_f32 v141, v141
s_branch Ljoin33
Lta31:
v_mfma_f32_16x16x32_bf16 v[168:171], a[160:163], v[48:51], v[104:107]
s_and_b32 s14, s14, 3
ds_read_b128 a[192:195], v2 offset:0
ds_read_b128 a[196:199], v2 offset:1024
v_mfma_f32_16x16x32_bf16 v[184:187], a[176:179], v[48:51], v[112:115]
s_add_u32 s14, s14, s78
v_exp_f32 v141, v141
s_branch Ljoin33
Lnt32:
v_mfma_f32_16x16x32_bf16 v[168:171], a[160:163], v[48:51], v[88:91]
s_and_b32 s14, s14, 3
ds_read_b128 a[192:195], v2 offset:0
ds_read_b128 a[196:199], v2 offset:1024
v_mfma_f32_16x16x32_bf16 v[184:187], a[176:179], v[48:51], v[104:107]
s_add_u32 s14, s14, s78
v_exp_f32 v141, v141
Ljoin33:
v_mfma_f32_16x16x32_bf16 v[172:175], a[160:163], v[64:67], v[92:95]
s_lshl_b32 s14, s14, 18
buffer_load_dwordx4 v1, s[44:47], s72 offen offset:3072 sc1 lds
v_mfma_f32_16x16x32_bf16 v[172:175], a[164:167], v[68:71], v[172:175]
s_add_u32 s66, s58, 0
v_exp_f32 v142, v142
v_mfma_f32_16x16x32_bf16 v[172:175], a[168:171], v[72:75], v[172:175]
s_and_b32 s66, s66, 3
ds_read_b128 a[200:203], v2 offset:2048
v_cvt_pk_bf16_f32 v204, v140, v141
v_mfma_f32_16x16x32_bf16 v[172:175], a[172:175], v[76:79], v[172:175]
s_mul_i32 s66, s66, 4160
v_exp_f32 v143, v143
v_mfma_f32_16x16x32_bf16 v[188:191], a[188:191], v[76:79], v[92:95]
s_add_u32 s66, s66, s92
ds_read_b128 a[204:207], v2 offset:3072
v_cvt_pk_bf16_f32 v205, v142, v143
v_mfma_f32_16x16x32_bf16 v[188:191], a[184:187], v[72:75], v[188:191]
s_add_u32 m0, s66, 16672
v_exp_f32 v156, v156
v_mfma_f32_16x16x32_bf16 v[188:191], a[180:183], v[68:71], v[188:191]
s_add_u32 s72, s93, 0x0
ds_read_b128 a[208:211], v2 offset:4096
ds_read_b128 a[212:215], v2 offset:5120
v_mfma_f32_16x16x32_bf16 v[188:191], a[176:179], v[64:67], v[188:191]
s_add_u32 s14, s14, s94
buffer_load_dwordx4 v1, s[36:39], s72 offen lds
v_mfma_f32_16x16x32_bf16 v[168:171], a[164:167], v[52:55], v[168:171]
s_add_u32 s15, s61, 3
v_exp_f32 v157, v157
v_mfma_f32_16x16x32_bf16 v[168:171], a[168:171], v[56:59], v[168:171]
s_and_b32 s15, s15, 3
v_exp_f32 v158, v158
v_mfma_f32_16x16x32_bf16 v[168:171], a[172:175], v[60:63], v[168:171]
s_add_u32 s15, s15, s78
ds_read_b128 a[216:219], v2 offset:6144
ds_read_b128 a[220:223], v2 offset:7168
v_mfma_f32_16x16x32_bf16 v[184:187], a[188:191], v[60:63], v[184:187]
s_lshl_b32 s15, s15, 18
buffer_load_dwordx4 v1, s[36:39], s72 offen offset:1024 lds
v_mfma_f32_16x16x32_bf16 v[184:187], a[184:187], v[56:59], v[184:187]
s_add_u32 s15, s15, s94
v_exp_f32 v159, v159
v_mfma_f32_16x16x32_bf16 v[184:187], a[180:183], v[52:55], v[184:187]
s_waitcnt lgkmcnt(4)
v_cvt_pk_bf16_f32 v206, v156, v157
v_cvt_pk_bf16_f32 v207, v158, v159
v_mfma_f32_16x16x32_bf16 v[232:235], v[120:123], v[216:219], v[232:235]
s_add_u32 s82, s82, 0x8000
ds_read_b128 a[160:163], v2 offset:24576
ds_read_b128 a[164:167], v2 offset:25600
v_mfma_f32_16x16x32_bf16 v[232:235], v[120:123], v[200:203], v[232:235]
s_and_b32 s82, s82, 0x1ffff
v_exp_f32 v172, v172
v_mfma_f32_16x16x32_bf16 a[64:67], a[224:227], v[216:219], a[64:67]
v_exp_f32 v173, v173
v_mfma_f32_16x16x32_bf16 a[64:67], a[192:195], v[200:203], a[64:67]
s_nop 0
ds_read_b128 a[168:171], v2 offset:26624
ds_read_b128 a[172:175], v2 offset:27648
v_mfma_f32_16x16x32_bf16 a[68:71], a[196:199], v[200:203], a[68:71]
v_exp_f32 v174, v174
v_mfma_f32_16x16x32_bf16 a[68:71], a[228:231], v[216:219], a[68:71]
v_exp_f32 v175, v175
v_mfma_f32_16x16x32_bf16 a[72:75], a[232:235], v[216:219], a[72:75]
s_nop 0
ds_read_b128 a[176:179], v2 offset:28672
ds_read_b128 a[180:183], v2 offset:29696
v_mfma_f32_16x16x32_bf16 a[72:75], a[200:203], v[200:203], a[72:75]
v_exp_f32 v188, v188
v_mfma_f32_16x16x32_bf16 a[76:79], a[204:207], v[200:203], a[76:79]
s_nop 0
ds_read_b128 a[184:187], v2 offset:30720
ds_read_b128 a[188:191], v2 offset:31744
v_mfma_f32_16x16x32_bf16 a[76:79], a[236:239], v[216:219], a[76:79]
s_nop 0
ds_read_b128 a[224:227], v2 offset:8192
ds_read_b128 a[228:231], v2 offset:9216
v_mfma_f32_16x16x32_bf16 a[80:83], a[240:243], v[216:219], a[80:83]
s_waitcnt lgkmcnt(10)
ds_read_b128 a[232:235], v2 offset:10240
ds_read_b128 a[236:239], v2 offset:11264
v_mfma_f32_16x16x32_bf16 a[80:83], a[208:211], v[200:203], a[80:83]
ds_read_b128 a[240:243], v2 offset:12288
v_cvt_pk_bf16_f32 v220, v172, v173
v_mfma_f32_16x16x32_bf16 a[84:87], a[212:215], v[200:203], a[84:87]
buffer_load_dwordx4 v1, s[36:39], s72 offen offset:2048 lds
v_mfma_f32_16x16x32_bf16 a[84:87], a[244:247], v[216:219], a[84:87]
v_exp_f32 v189, v189
v_mfma_f32_16x16x32_bf16 a[88:91], a[248:251], v[216:219], a[88:91]
v_exp_f32 v190, v190
v_mfma_f32_16x16x32_bf16 a[88:91], a[216:219], v[200:203], a[88:91]
s_nop 0
ds_read_b128 a[244:247], v2 offset:13312
ds_read_b128 a[248:251], v2 offset:14336
v_mfma_f32_16x16x32_bf16 a[92:95], a[220:223], v[200:203], a[92:95]
v_cvt_pk_bf16_f32 v221, v174, v175
v_cvt_pk_bf16_f32 v222, v188, v189
v_mfma_f32_16x16x32_bf16 a[92:95], a[252:255], v[216:219], a[92:95]
v_exp_f32 v191, v191
s_cmp_eq_u32 s58, 0
s_cbranch_scc1 Lta34
s_cmp_eq_u32 s58, 1
s_cbranch_scc1 Lnt35
v_mfma_f32_16x16x32_bf16 v[140:143], a[128:131], v[64:67], v[92:95]
v_exp_f32 v168, v168
v_mfma_f32_16x16x32_bf16 v[156:159], a[144:147], v[64:67], v[92:95]
v_exp_f32 v169, v169
s_branch Ljoin36
Lta34:
v_mfma_f32_16x16x32_bf16 v[140:143], a[128:131], v[64:67], v[108:111]
v_exp_f32 v168, v168
v_mfma_f32_16x16x32_bf16 v[156:159], a[144:147], v[64:67], v[112:115]
v_exp_f32 v169, v169
s_branch Ljoin36
Lnt35:
v_mfma_f32_16x16x32_bf16 v[140:143], a[128:131], v[64:67], v[92:95]
v_exp_f32 v168, v168
v_mfma_f32_16x16x32_bf16 v[156:159], a[144:147], v[64:67], v[108:111]
v_exp_f32 v169, v169
Ljoin36:
v_mfma_f32_16x16x32_bf16 v[140:143], a[132:135], v[68:71], v[140:143]
v_exp_f32 v170, v170
v_mfma_f32_16x16x32_bf16 v[140:143], a[136:139], v[72:75], v[140:143]
ds_read_b128 a[252:255], v2 offset:15360
v_cvt_pk_bf16_f32 v223, v190, v191
v_mfma_f32_16x16x32_bf16 v[140:143], a[140:143], v[76:79], v[140:143]
v_exp_f32 v171, v171
v_mfma_f32_16x16x32_bf16 v[156:159], a[156:159], v[76:79], v[156:159]
buffer_load_dwordx4 v1, s[36:39], s72 offen offset:3072 lds
v_mfma_f32_16x16x32_bf16 v[156:159], a[152:155], v[72:75], v[156:159]
s_waitcnt vmcnt(13) lgkmcnt(4)
v_exp_f32 v184, v184
v_mfma_f32_16x16x32_bf16 v[156:159], a[148:151], v[68:71], v[156:159]
s_barrier
v_cvt_pk_bf16_f32 v216, v168, v169
v_cvt_pk_bf16_f32 v217, v170, v171
v_add_u32 v2, s82, v1
v_exp_f32 v185, v185
v_exp_f32 v186, v186
v_cvt_pk_bf16_f32 v218, v184, v185
v_exp_f32 v187, v187
s_nop 0
v_cvt_pk_bf16_f32 v219, v186, v187
v_mfma_f32_16x16x32_bf16 v[236:239], v[120:123], v[204:207], v[236:239]
s_add_u32 s66, s58, 2
v_exp_f32 v140, v140
v_mfma_f32_16x16x32_bf16 v[236:239], v[120:123], v[220:223], v[236:239]
s_and_b32 s66, s66, 3
v_exp_f32 v141, v141
v_mfma_f32_16x16x32_bf16 a[96:99], a[192:195], v[204:207], a[96:99]
s_mul_i32 s66, s66, 4160
ds_read_b128 a[192:195], v2 offset:0
v_mfma_f32_16x16x32_bf16 a[96:99], a[224:227], v[220:223], a[96:99]
s_add_u32 s66, s66, s92
v_exp_f32 v142, v142
v_mfma_f32_16x16x32_bf16 a[100:103], a[228:231], v[220:223], a[100:103]
s_add_u32 m0, s66, 33312
v_exp_f32 v143, v143
v_mfma_f32_16x16x32_bf16 a[100:103], a[196:199], v[204:207], a[100:103]
s_add_u32 s72, s93, 0x4
buffer_load_dwordx4 v1, s[36:39], s72 offen lds
v_mfma_f32_16x16x32_bf16 a[104:107], a[200:203], v[204:207], a[104:107]
ds_read_b128 a[196:199], v2 offset:1024
v_mfma_f32_16x16x32_bf16 a[104:107], a[232:235], v[220:223], a[104:107]
buffer_load_dwordx4 v1, s[36:39], s72 offen offset:1024 lds
v_mfma_f32_16x16x32_bf16 a[108:111], a[236:239], v[220:223], a[108:111]
ds_read_b128 a[200:203], v2 offset:2048
v_mfma_f32_16x16x32_bf16 a[108:111], a[204:207], v[204:207], a[108:111]
buffer_load_dwordx4 v1, s[36:39], s72 offen offset:2048 lds
v_mfma_f32_16x16x32_bf16 a[112:115], a[208:211], v[204:207], a[112:115]
s_waitcnt lgkmcnt(3)
ds_read_b128 a[204:207], v2 offset:3072
v_mfma_f32_16x16x32_bf16 a[112:115], a[240:243], v[220:223], a[112:115]
buffer_load_dwordx4 v1, s[36:39], s72 offen offset:3072 lds
v_mfma_f32_16x16x32_bf16 a[116:119], a[244:247], v[220:223], a[116:119]
v_exp_f32 v156, v156
v_mfma_f32_16x16x32_bf16 a[116:119], a[212:215], v[204:207], a[116:119]
ds_read_b128 a[208:211], v2 offset:4096
v_mfma_f32_16x16x32_bf16 a[120:123], a[216:219], v[204:207], a[120:123]
buffer_load_dwordx4 v[80:83], v15, s[4:7], s80 offen
v_mfma_f32_16x16x32_bf16 a[120:123], a[248:251], v[220:223], a[120:123]
s_add_u32 s80, s80, 0x4000
v_exp_f32 v157, v157
v_mfma_f32_16x16x32_bf16 a[124:127], a[252:255], v[220:223], a[124:127]
ds_read_b128 a[212:215], v2 offset:5120
v_mfma_f32_16x16x32_bf16 a[124:127], a[220:223], v[204:207], a[124:127]
ds_read_b128 a[216:219], v2 offset:6144
v_cvt_pk_bf16_f32 v204, v140, v141
s_cmp_eq_u32 s58, 2
s_cbranch_scc1 Lta37
s_cmp_eq_u32 s58, 3
s_cbranch_scc1 Lnt38
v_mfma_f32_16x16x32_bf16 v[172:175], a[160:163], v[64:67], v[112:115]
buffer_load_dwordx4 v[84:87], v15, s[4:7], s80 offen
v_mfma_f32_16x16x32_bf16 v[188:191], a[176:179], v[64:67], v[112:115]
s_add_u32 s80, s80, 0x4000
v_exp_f32 v158, v158
s_branch Ljoin39
Lta37:
v_mfma_f32_16x16x32_bf16 v[172:175], a[160:163], v[64:67], v[108:111]
buffer_load_dwordx4 v[84:87], v15, s[4:7], s80 offen
v_mfma_f32_16x16x32_bf16 v[188:191], a[176:179], v[64:67], v[112:115]
s_add_u32 s80, s80, 0x4000
v_exp_f32 v158, v158
s_branch Ljoin39
Lnt38:
v_mfma_f32_16x16x32_bf16 v[172:175], a[160:163], v[64:67], v[92:95]
buffer_load_dwordx4 v[84:87], v15, s[4:7], s80 offen
v_mfma_f32_16x16x32_bf16 v[188:191], a[176:179], v[64:67], v[108:111]
s_add_u32 s80, s80, 0x4000
v_exp_f32 v158, v158
Ljoin39:
v_mfma_f32_16x16x32_bf16 v[172:175], a[164:167], v[68:71], v[172:175]
ds_read_b128 a[220:223], v2 offset:7168
v_cvt_pk_bf16_f32 v205, v142, v143
v_mfma_f32_16x16x32_bf16 v[172:175], a[168:171], v[72:75], v[172:175]
buffer_load_dwordx4 v[96:99], v15, s[4:7], s80 offen
v_mfma_f32_16x16x32_bf16 v[172:175], a[172:175], v[76:79], v[172:175]
s_add_u32 s80, s80, 0x4000
v_exp_f32 v159, v159
v_mfma_f32_16x16x32_bf16 v[188:191], a[188:191], v[76:79], v[188:191]
buffer_load_dwordx4 v[100:103], v15, s[4:7], s80 offen
v_mfma_f32_16x16x32_bf16 v[188:191], a[184:187], v[72:75], v[188:191]
v_cvt_pk_bf16_f32 v206, v156, v157
v_cvt_pk_bf16_f32 v207, v158, v159
v_mfma_f32_16x16x32_bf16 v[188:191], a[180:183], v[68:71], v[188:191]
s_waitcnt lgkmcnt(4)
v_mfma_f32_16x16x32_bf16 v[232:235], v[120:123], v[216:219], v[232:235]
s_add_u32 s82, s82, 0x8000
v_exp_f32 v172, v172
v_mfma_f32_16x16x32_bf16 a[64:67], a[224:227], v[216:219], a[64:67]
s_and_b32 s82, s82, 0x1ffff
ds_read_b128 a[224:227], v2 offset:8192
v_mfma_f32_16x16x32_bf16 a[68:71], a[228:231], v[216:219], a[68:71]
ds_read_b128 a[228:231], v2 offset:9216
v_mfma_f32_16x16x32_bf16 a[72:75], a[232:235], v[216:219], a[72:75]
v_exp_f32 v173, v173
v_mfma_f32_16x16x32_bf16 a[76:79], a[236:239], v[216:219], a[76:79]
s_nop 0
ds_read_b128 a[232:235], v2 offset:10240
ds_read_b128 a[236:239], v2 offset:11264
v_mfma_f32_16x16x32_bf16 a[80:83], a[240:243], v[216:219], a[80:83]
ds_read_b128 a[240:243], v2 offset:12288
v_cvt_pk_bf16_f32 v220, v172, v173
v_mfma_f32_16x16x32_bf16 a[84:87], a[244:247], v[216:219], a[84:87]
ds_read_b128 a[244:247], v2 offset:13312
v_mfma_f32_16x16x32_bf16 a[88:91], a[248:251], v[216:219], a[88:91]
v_exp_f32 v174, v174
v_mfma_f32_16x16x32_bf16 a[92:95], a[252:255], v[216:219], a[92:95]
v_exp_f32 v175, v175
ds_read_b128 a[248:251], v2 offset:14336
ds_read_b128 a[252:255], v2 offset:15360
v_add_u32 v2, s82, v1
v_exp_f32 v188, v188
v_cvt_pk_bf16_f32 v221, v174, v175
v_exp_f32 v189, v189
v_exp_f32 v190, v190
v_cvt_pk_bf16_f32 v222, v188, v189
v_exp_f32 v191, v191
s_nop 0
v_cvt_pk_bf16_f32 v223, v190, v191
s_waitcnt vmcnt(4) lgkmcnt(0)
s_barrier
LHT4:
Lstub7:
s_cbranch_execz Lstub11
v_mfma_f32_16x16x32_bf16 v[236:239], v[120:123], v[204:207], v[236:239]
ds_write_b64 v5, v[12:13]
v_mov_b32 v240, 0
v_mfma_f32_16x16x32_bf16 v[236:239], v[120:123], v[220:223], v[236:239]
v_mov_b32 v241, 0
v_mfma_f32_16x16x32_bf16 a[96:99], a[192:195], v[204:207], a[96:99]
s_nop 0
ds_write_b64 v14, v[240:241]
ds_read_b64 a[128:129], v6 offset:0
v_mfma_f32_16x16x32_bf16 a[96:99], a[224:227], v[220:223], a[96:99]
s_nop 0
ds_read_b64 a[130:131], v6 offset:8
ds_read_b128 a[192:195], v7 offset:3584
v_mfma_f32_16x16x32_bf16 a[100:103], a[228:231], v[220:223], a[100:103]
s_nop 0
ds_read_b64 a[132:133], v6 offset:512
ds_read_b64 a[134:135], v6 offset:520
v_mfma_f32_16x16x32_bf16 a[100:103], a[196:199], v[204:207], a[100:103]
s_nop 0
ds_read_b128 a[196:199], v7 offset:3072
ds_read_b64 a[136:137], v6 offset:1024
v_mfma_f32_16x16x32_bf16 a[104:107], a[200:203], v[204:207], a[104:107]
s_nop 0
ds_read_b64 a[138:139], v6 offset:1032
ds_read_b128 a[200:203], v7 offset:2560
v_mfma_f32_16x16x32_bf16 a[104:107], a[232:235], v[220:223], a[104:107]
v_mfma_f32_16x16x32_bf16 a[108:111], a[236:239], v[220:223], a[108:111]
s_nop 0
ds_read_b64 a[140:141], v6 offset:1536
ds_read_b64 a[142:143], v6 offset:1544
v_mfma_f32_16x16x32_bf16 a[108:111], a[204:207], v[204:207], a[108:111]
s_nop 0
ds_read_b128 a[204:207], v7 offset:2048
ds_read_b64 a[144:145], v6 offset:2048
v_mfma_f32_16x16x32_bf16 a[112:115], a[208:211], v[204:207], a[112:115]
s_lshl_b32 s73, s59, 12
ds_read_b64 a[146:147], v6 offset:2056
ds_read_b128 a[208:211], v7 offset:1536
v_mfma_f32_16x16x32_bf16 a[112:115], a[240:243], v[220:223], a[112:115]
s_add_u32 s73, s73, 0x2000000
v_mfma_f32_16x16x32_bf16 a[116:119], a[244:247], v[220:223], a[116:119]
s_lshl_b32 s70, s68, 2
ds_read_b64 a[148:149], v6 offset:2560
ds_read_b64 a[150:151], v6 offset:2568
v_mfma_f32_16x16x32_bf16 a[116:119], a[212:215], v[204:207], a[116:119]
s_add_u32 s70, s70, s73
ds_read_b128 a[212:215], v7 offset:1024
ds_read_b64 a[152:153], v6 offset:3072
v_mfma_f32_16x16x32_bf16 a[120:123], a[216:219], v[204:207], a[120:123]
s_nop 0
ds_read_b64 a[154:155], v6 offset:3080
ds_read_b128 a[216:219], v7 offset:512
v_mfma_f32_16x16x32_bf16 a[120:123], a[248:251], v[220:223], a[120:123]
v_mfma_f32_16x16x32_bf16 a[124:127], a[252:255], v[220:223], a[124:127]
s_xor_b32 s71, s12, 0x80
ds_read_b64 a[156:157], v6 offset:3584
ds_read_b64 a[158:159], v6 offset:3592
v_mfma_f32_16x16x32_bf16 a[124:127], a[220:223], v[204:207], a[124:127]
s_add_u32 m0, s77, 0
ds_read_b128 a[220:223], v7 offset:0
s_waitcnt lgkmcnt(0)
v_mfma_f32_16x16x32_bf16 v[128:131], v[8:11], a[192:195], 0
s_add_u32 s72, s71, 0
buffer_load_dwordx4 v15, s[24:27], s72 offen lds
v_mfma_f32_16x16x32_bf16 v[128:131], a[128:131], a[192:195], v[128:131]
v_mfma_f32_16x16x32_bf16 v[132:135], v[8:11], a[196:199], 0
s_nop 0
ds_read_b128 a[224:227], v7 offset:3648
ds_read_b64 a[160:161], v6 offset:64
v_mfma_f32_16x16x32_bf16 v[132:135], a[128:131], a[196:199], v[132:135]
v_accvgpr_read_b32 v240, a64
v_accvgpr_read_b32 v241, a65
v_accvgpr_read_b32 v242, a66
v_mfma_f32_16x16x32_bf16 v[132:135], a[132:135], a[192:195], v[132:135]
s_add_u32 s72, s71, 15360
buffer_load_dwordx4 v15, s[24:27], s72 offen offset:1024 lds
v_accvgpr_read_b32 v243, a67
v_mfma_f32_16x16x32_bf16 v[136:139], v[8:11], a[200:203], 0
s_nop 0
ds_read_b64 a[162:163], v6 offset:72
ds_read_b128 a[228:231], v7 offset:3136
v_mfma_f32_16x16x32_bf16 v[136:139], a[128:131], a[200:203], v[136:139]
s_lshl_b32 s95, s75, 20
v_rcp_f32 v232, v232
v_mfma_f32_16x16x32_bf16 v[136:139], a[132:135], a[196:199], v[136:139]
s_lshl_b32 s74, s58, 18
v_rcp_f32 v236, v236
v_accvgpr_read_b32 v244, a68
v_mfma_f32_16x16x32_bf16 v[136:139], a[136:139], a[192:195], v[136:139]
s_add_u32 s95, s95, s74
ds_read_b64 a[164:165], v6 offset:576
ds_read_b64 a[166:167], v6 offset:584
v_accvgpr_read_b32 v245, a69
v_mfma_f32_16x16x32_bf16 v[140:143], v[8:11], a[204:207], 0
s_add_u32 s72, s71, 30720
buffer_load_dwordx4 v15, s[24:27], s72 offen offset:2048 lds
v_accvgpr_read_b32 v246, a70
v_mfma_f32_16x16x32_bf16 v[140:143], a[128:131], a[204:207], v[140:143]
s_add_u32 s95, s95, 0x2000000
v_accvgpr_read_b32 v247, a71
v_mul_f32 v240, v240, v232
v_mul_f32 v241, v241, v232
v_mfma_f32_16x16x32_bf16 v[140:143], a[132:135], a[200:203], v[140:143]
s_sub_u32 s74, 15, s75
ds_read_b128 a[232:235], v7 offset:2624
ds_read_b64 a[168:169], v6 offset:1088
v_mul_f32 v242, v242, v232
v_mfma_f32_16x16x32_bf16 v[140:143], a[136:139], a[196:199], v[140:143]
s_add_u32 s72, s71, 46080
buffer_load_dwordx4 v15, s[24:27], s72 offen offset:3072 lds
v_mul_f32 v243, v243, v232
v_mfma_f32_16x16x32_bf16 v[140:143], a[140:143], a[192:195], v[140:143]
s_min_u32 s74, s74, s75
v_mul_f32 v244, v244, v232
v_mul_f32 v245, v245, v232
v_mul_f32 v246, v246, v232
v_mfma_f32_16x16x32_bf16 v[144:147], v[8:11], a[208:211], 0
s_lshl_b32 s74, s74, 7
ds_read_b64 a[170:171], v6 offset:1096
ds_read_b128 a[236:239], v7 offset:2112
v_mul_f32 v247, v247, v232
v_mfma_f32_16x16x32_bf16 v[144:147], a[128:131], a[208:211], v[144:147]
s_add_u32 s74, s74, 0x3810000
v_cvt_pk_bf16_f32 v240, v240, v241
v_cvt_pk_bf16_f32 v241, v242, v243
v_cvt_pk_bf16_f32 v242, v244, v245
v_mfma_f32_16x16x32_bf16 v[144:147], a[132:135], a[204:207], v[144:147]
s_xor_b32 s85, s77, 0x10000
v_cvt_pk_bf16_f32 v243, v246, v247
v_mfma_f32_16x16x32_bf16 v[144:147], a[136:139], a[200:203], v[144:147]
s_nop 0
ds_read_b64 a[172:173], v6 offset:1600
ds_read_b64 a[174:175], v6 offset:1608
v_mfma_f32_16x16x32_bf16 v[144:147], a[140:143], a[196:199], v[144:147]
Lstub8:
s_cbranch_execz Lret
buffer_store_dwordx4 v[240:243], v1, s[44:47], s70 offen sc1
v_mfma_f32_16x16x32_bf16 v[144:147], a[144:147], a[192:195], v[144:147]
v_accvgpr_read_b32 v248, a72
v_accvgpr_read_b32 v249, a73
v_accvgpr_read_b32 v250, a74
v_mfma_f32_16x16x32_bf16 v[148:151], v[8:11], a[212:215], 0
s_nop 0
ds_read_b128 a[240:243], v7 offset:1600
ds_read_b64 a[176:177], v6 offset:2112
v_accvgpr_read_b32 v251, a75
v_mfma_f32_16x16x32_bf16 v[148:151], a[128:131], a[212:215], v[148:151]
v_accvgpr_read_b32 v252, a76
v_accvgpr_read_b32 v253, a77
v_accvgpr_read_b32 v254, a78
v_mfma_f32_16x16x32_bf16 v[148:151], a[132:135], a[208:211], v[148:151]
v_accvgpr_read_b32 v255, a79
v_mul_f32 v248, v248, v232
v_mul_f32 v249, v249, v232
v_mfma_f32_16x16x32_bf16 v[148:151], a[136:139], a[204:207], v[148:151]
s_nop 0
ds_read_b64 a[178:179], v6 offset:2120
ds_read_b128 a[244:247], v7 offset:1088
v_mul_f32 v250, v250, v232
v_mfma_f32_16x16x32_bf16 v[148:151], a[140:143], a[200:203], v[148:151]
v_mul_f32 v251, v251, v232
v_mul_f32 v252, v252, v232
v_mul_f32 v253, v253, v232
v_mfma_f32_16x16x32_bf16 v[148:151], a[144:147], a[196:199], v[148:151]
v_mul_f32 v254, v254, v232
v_mul_f32 v255, v255, v232
v_cvt_pk_bf16_f32 v248, v248, v249
v_mfma_f32_16x16x32_bf16 v[148:151], a[148:151], a[192:195], v[148:151]
s_nop 0
ds_read_b64 a[180:181], v6 offset:2624
ds_read_b64 a[182:183], v6 offset:2632
v_cvt_pk_bf16_f32 v249, v250, v251
v_mfma_f32_16x16x32_bf16 v[152:155], v[8:11], a[216:219], 0
v_cvt_pk_bf16_f32 v250, v252, v253
v_cvt_pk_bf16_f32 v251, v254, v255
v_mfma_f32_16x16x32_bf16 v[152:155], a[128:131], a[216:219], v[152:155]
buffer_store_dwordx4 v[248:251], v1, s[44:47], s70 offen offset:1024 sc1
v_mfma_f32_16x16x32_bf16 v[152:155], a[132:135], a[212:215], v[152:155]
s_nop 0
ds_read_b128 a[248:251], v7 offset:576
ds_read_b64 a[184:185], v6 offset:3136
v_accvgpr_read_b32 v240, a80
v_mfma_f32_16x16x32_bf16 v[152:155], a[136:139], a[208:211], v[152:155]
v_accvgpr_read_b32 v241, a81
v_accvgpr_read_b32 v242, a82
v_accvgpr_read_b32 v243, a83
v_mfma_f32_16x16x32_bf16 v[152:155], a[140:143], a[204:207], v[152:155]
v_accvgpr_read_b32 v244, a84
v_accvgpr_read_b32 v245, a85
v_accvgpr_read_b32 v246, a86
v_mfma_f32_16x16x32_bf16 v[152:155], a[144:147], a[200:203], v[152:155]
s_nop 0
ds_read_b64 a[186:187], v6 offset:3144
ds_read_b128 a[252:255], v7 offset:64
v_accvgpr_read_b32 v247, a87
v_mfma_f32_16x16x32_bf16 v[152:155], a[148:151], a[196:199], v[152:155]
v_mul_f32 v240, v240, v232
v_mul_f32 v241, v241, v232
v_mul_f32 v242, v242, v232
v_mfma_f32_16x16x32_bf16 v[152:155], a[152:155], a[192:195], v[152:155]
v_mul_f32 v243, v243, v232
v_mul_f32 v244, v244, v232
v_mul_f32 v245, v245, v232
v_mfma_f32_16x16x32_bf16 v[156:159], v[8:11], a[220:223], 0
s_nop 0
ds_read_b64 a[188:189], v6 offset:3648
ds_read_b64 a[190:191], v6 offset:3656
v_mul_f32 v246, v246, v232
v_mfma_f32_16x16x32_bf16 v[156:159], a[128:131], a[220:223], v[156:159]
v_mul_f32 v247, v247, v232
v_cvt_pk_bf16_f32 v240, v240, v241
v_cvt_pk_bf16_f32 v241, v242, v243
v_mfma_f32_16x16x32_bf16 v[156:159], a[132:135], a[216:219], v[156:159]
v_cvt_pk_bf16_f32 v242, v244, v245
v_cvt_pk_bf16_f32 v243, v246, v247
v_mfma_f32_16x16x32_bf16 v[156:159], a[136:139], a[212:215], v[156:159]
buffer_store_dwordx4 v[240:243], v1, s[44:47], s70 offen offset:2048 sc1
v_mfma_f32_16x16x32_bf16 v[156:159], a[140:143], a[208:211], v[156:159]
v_accvgpr_read_b32 v248, a88
v_accvgpr_read_b32 v249, a89
v_accvgpr_read_b32 v250, a90
v_mfma_f32_16x16x32_bf16 v[156:159], a[144:147], a[204:207], v[156:159]
v_accvgpr_read_b32 v251, a91
v_accvgpr_read_b32 v252, a92
v_accvgpr_read_b32 v253, a93
v_mfma_f32_16x16x32_bf16 v[156:159], a[148:151], a[200:203], v[156:159]
v_accvgpr_read_b32 v254, a94
v_accvgpr_read_b32 v255, a95
v_mul_f32 v248, v248, v232
v_mfma_f32_16x16x32_bf16 v[156:159], a[152:155], a[196:199], v[156:159]
v_mul_f32 v249, v249, v232
v_mul_f32 v250, v250, v232
v_mul_f32 v251, v251, v232
v_mfma_f32_16x16x32_bf16 v[156:159], a[156:159], a[192:195], v[156:159]
s_waitcnt lgkmcnt(0)
v_mul_f32 v252, v252, v232
v_mul_f32 v253, v253, v232
v_mul_f32 v254, v254, v232
v_mfma_f32_16x16x32_bf16 v[128:131], a[160:163], a[224:227], v[128:131]
s_nop 0
ds_read_b128 a[192:195], v7 offset:3712
ds_read_b64 a[128:129], v6 offset:128
v_mul_f32 v255, v255, v232
v_mfma_f32_16x16x32_bf16 v[132:135], a[164:167], a[224:227], v[132:135]
v_cvt_pk_bf16_f32 v248, v248, v249
v_cvt_pk_bf16_f32 v249, v250, v251
v_cvt_pk_bf16_f32 v250, v252, v253
v_mfma_f32_16x16x32_bf16 v[132:135], a[160:163], a[228:231], v[132:135]
s_nop 0
ds_read_b64 a[130:131], v6 offset:136
ds_read_b128 a[196:199], v7 offset:3200
v_cvt_pk_bf16_f32 v251, v254, v255
v_mfma_f32_16x16x32_bf16 v[136:139], a[160:163], a[232:235], v[136:139]
buffer_store_dwordx4 v[248:251], v1, s[44:47], s70 offen offset:3072 sc1
v_mfma_f32_16x16x32_bf16 v[136:139], a[164:167], a[228:231], v[136:139]
s_add_u32 s70, s70, 0x80000
v_accvgpr_read_b32 v240, a96
v_accvgpr_read_b32 v241, a97
v_accvgpr_read_b32 v242, a98
v_mfma_f32_16x16x32_bf16 v[136:139], a[168:171], a[224:227], v[136:139]
s_nop 0
ds_read_b64 a[132:133], v6 offset:640
ds_read_b64 a[134:135], v6 offset:648
v_accvgpr_read_b32 v243, a99
v_mfma_f32_16x16x32_bf16 v[140:143], a[172:175], a[224:227], v[140:143]
v_accvgpr_read_b32 v244, a100
v_accvgpr_read_b32 v245, a101
v_accvgpr_read_b32 v246, a102
v_mfma_f32_16x16x32_bf16 v[140:143], a[168:171], a[228:231], v[140:143]
s_nop 0
ds_read_b128 a[200:203], v7 offset:2688
ds_read_b64 a[136:137], v6 offset:1152
v_accvgpr_read_b32 v247, a103
v_mfma_f32_16x16x32_bf16 v[140:143], a[164:167], a[232:235], v[140:143]
v_mul_f32 v240, v240, v236
v_mul_f32 v241, v241, v236
v_mul_f32 v242, v242, v236
v_mfma_f32_16x16x32_bf16 v[140:143], a[160:163], a[236:239], v[140:143]
v_mul_f32 v243, v243, v236
v_mul_f32 v244, v244, v236
v_mul_f32 v245, v245, v236
v_mfma_f32_16x16x32_bf16 v[144:147], a[160:163], a[240:243], v[144:147]
s_nop 0
ds_read_b64 a[138:139], v6 offset:1160
ds_read_b128 a[204:207], v7 offset:2176
v_mul_f32 v246, v246, v236
v_mfma_f32_16x16x32_bf16 v[144:147], a[164:167], a[236:239], v[144:147]
v_mul_f32 v247, v247, v236
v_cvt_pk_bf16_f32 v240, v240, v241
v_cvt_pk_bf16_f32 v241, v242, v243
v_mfma_f32_16x16x32_bf16 v[144:147], a[168:171], a[232:235], v[144:147]
s_nop 0
ds_read_b64 a[140:141], v6 offset:1664
ds_read_b64 a[142:143], v6 offset:1672
v_cvt_pk_bf16_f32 v242, v244, v245
v_mfma_f32_16x16x32_bf16 v[144:147], a[172:175], a[228:231], v[144:147]
v_cvt_pk_bf16_f32 v243, v246, v247
v_mfma_f32_16x16x32_bf16 v[144:147], a[176:179], a[224:227], v[144:147]
buffer_store_dwordx4 v[240:243], v1, s[44:47], s70 offen sc1
v_mfma_f32_16x16x32_bf16 v[148:151], a[180:183], a[224:227], v[148:151]
s_nop 0
ds_read_b128 a[208:211], v7 offset:1664
ds_read_b64 a[144:145], v6 offset:2176
v_accvgpr_read_b32 v248, a104
v_mfma_f32_16x16x32_bf16 v[148:151], a[176:179], a[228:231], v[148:151]
v_accvgpr_read_b32 v249, a105
v_accvgpr_read_b32 v250, a106
v_accvgpr_read_b32 v251, a107
v_mfma_f32_16x16x32_bf16 v[148:151], a[172:175], a[232:235], v[148:151]
v_accvgpr_read_b32 v252, a108
v_accvgpr_read_b32 v253, a109
v_accvgpr_read_b32 v254, a110
v_mfma_f32_16x16x32_bf16 v[148:151], a[168:171], a[236:239], v[148:151]
s_nop 0
ds_read_b64 a[146:147], v6 offset:2184
ds_read_b128 a[212:215], v7 offset:1152
v_accvgpr_read_b32 v255, a111
v_mfma_f32_16x16x32_bf16 v[148:151], a[164:167], a[240:243], v[148:151]
v_mul_f32 v248, v248, v236
v_mul_f32 v249, v249, v236
v_mul_f32 v250, v250, v236
v_mfma_f32_16x16x32_bf16 v[148:151], a[160:163], a[244:247], v[148:151]
s_nop 0
ds_read_b64 a[148:149], v6 offset:2688
ds_read_b64 a[150:151], v6 offset:2696
v_mul_f32 v251, v251, v236
v_mfma_f32_16x16x32_bf16 v[152:155], a[160:163], a[248:251], v[152:155]
v_mul_f32 v252, v252, v236
v_mul_f32 v253, v253, v236
v_mul_f32 v254, v254, v236
v_mfma_f32_16x16x32_bf16 v[152:155], a[164:167], a[244:247], v[152:155]
v_mul_f32 v255, v255, v236
v_cvt_pk_bf16_f32 v248, v248, v249
v_cvt_pk_bf16_f32 v249, v250, v251
v_mfma_f32_16x16x32_bf16 v[152:155], a[168:171], a[240:243], v[152:155]
s_nop 0
ds_read_b128 a[216:219], v7 offset:640
ds_read_b64 a[152:153], v6 offset:3200
v_cvt_pk_bf16_f32 v250, v252, v253
v_mfma_f32_16x16x32_bf16 v[152:155], a[172:175], a[236:239], v[152:155]
v_cvt_pk_bf16_f32 v251, v254, v255
v_mfma_f32_16x16x32_bf16 v[152:155], a[176:179], a[232:235], v[152:155]
s_nop 0
ds_read_b64 a[154:155], v6 offset:3208
ds_read_b128 a[220:223], v7 offset:128
v_mfma_f32_16x16x32_bf16 v[152:155], a[180:183], a[228:231], v[152:155]
buffer_store_dwordx4 v[248:251], v1, s[44:47], s70 offen offset:1024 sc1
v_mfma_f32_16x16x32_bf16 v[152:155], a[184:187], a[224:227], v[152:155]
v_accvgpr_read_b32 v240, a112
v_accvgpr_read_b32 v241, a113
v_accvgpr_read_b32 v242, a114
v_mfma_f32_16x16x32_bf16 v[156:159], a[188:191], a[224:227], v[156:159]
s_nop 0
ds_read_b64 a[156:157], v6 offset:3712
ds_read_b64 a[158:159], v6 offset:3720
v_accvgpr_read_b32 v243, a115
v_mfma_f32_16x16x32_bf16 v[156:159], a[184:187], a[228:231], v[156:159]
v_accvgpr_read_b32 v244, a116
v_accvgpr_read_b32 v245, a117
v_accvgpr_read_b32 v246, a118
v_mfma_f32_16x16x32_bf16 v[156:159], a[180:183], a[232:235], v[156:159]
v_accvgpr_read_b32 v247, a119
v_mul_f32 v240, v240, v236
v_mul_f32 v241, v241, v236
v_mfma_f32_16x16x32_bf16 v[156:159], a[176:179], a[236:239], v[156:159]
v_mul_f32 v242, v242, v236
v_mul_f32 v243, v243, v236
v_mul_f32 v244, v244, v236
v_mfma_f32_16x16x32_bf16 v[156:159], a[172:175], a[240:243], v[156:159]
v_mul_f32 v245, v245, v236
v_mul_f32 v246, v246, v236
v_mul_f32 v247, v247, v236
v_mfma_f32_16x16x32_bf16 v[156:159], a[168:171], a[244:247], v[156:159]
v_cvt_pk_bf16_f32 v240, v240, v241
v_cvt_pk_bf16_f32 v241, v242, v243
v_cvt_pk_bf16_f32 v242, v244, v245
v_mfma_f32_16x16x32_bf16 v[156:159], a[164:167], a[248:251], v[156:159]
v_cvt_pk_bf16_f32 v243, v246, v247
v_mfma_f32_16x16x32_bf16 v[156:159], a[160:163], a[252:255], v[156:159]
s_waitcnt lgkmcnt(0)
buffer_store_dwordx4 v[240:243], v1, s[44:47], s70 offen offset:2048 sc1
v_mfma_f32_16x16x32_bf16 v[128:131], a[128:131], a[192:195], v[128:131]
s_nop 0
ds_read_b128 a[224:227], v7 offset:3776
ds_read_b64 a[160:161], v6 offset:192
v_accvgpr_read_b32 v248, a120
v_mfma_f32_16x16x32_bf16 v[132:135], a[132:135], a[192:195], v[132:135]
v_accvgpr_read_b32 v249, a121
v_accvgpr_read_b32 v250, a122
v_accvgpr_read_b32 v251, a123
v_mfma_f32_16x16x32_bf16 v[132:135], a[128:131], a[196:199], v[132:135]
s_nop 0
ds_read_b64 a[162:163], v6 offset:200
ds_read_b128 a[228:231], v7 offset:3264
v_accvgpr_read_b32 v252, a124
v_mfma_f32_16x16x32_bf16 v[136:139], a[128:131], a[200:203], v[136:139]
v_accvgpr_read_b32 v253, a125
v_accvgpr_read_b32 v254, a126
v_accvgpr_read_b32 v255, a127
v_mfma_f32_16x16x32_bf16 v[136:139], a[132:135], a[196:199], v[136:139]
v_mul_f32 v248, v248, v236
v_mul_f32 v249, v249, v236
v_mul_f32 v250, v250, v236
v_mfma_f32_16x16x32_bf16 v[136:139], a[136:139], a[192:195], v[136:139]
s_nop 0
ds_read_b64 a[164:165], v6 offset:704
ds_read_b64 a[166:167], v6 offset:712
v_mul_f32 v251, v251, v236
v_mfma_f32_16x16x32_bf16 v[140:143], a[140:143], a[192:195], v[140:143]
v_mul_f32 v252, v252, v236
v_mul_f32 v253, v253, v236
v_mul_f32 v254, v254, v236
v_mfma_f32_16x16x32_bf16 v[140:143], a[136:139], a[196:199], v[140:143]
s_nop 0
ds_read_b128 a[232:235], v7 offset:2752
ds_read_b64 a[168:169], v6 offset:1216
v_mul_f32 v255, v255, v236
v_mfma_f32_16x16x32_bf16 v[140:143], a[132:135], a[200:203], v[140:143]
v_cvt_pk_bf16_f32 v248, v248, v249
v_cvt_pk_bf16_f32 v249, v250, v251
v_cvt_pk_bf16_f32 v250, v252, v253
v_mfma_f32_16x16x32_bf16 v[140:143], a[128:131], a[204:207], v[140:143]
v_cvt_pk_bf16_f32 v251, v254, v255
v_mfma_f32_16x16x32_bf16 v[144:147], a[128:131], a[208:211], v[144:147]
s_nop 0
ds_read_b64 a[170:171], v6 offset:1224
ds_read_b128 a[236:239], v7 offset:2240
v_mfma_f32_16x16x32_bf16 v[144:147], a[132:135], a[204:207], v[144:147]
buffer_store_dwordx4 v[248:251], v1, s[44:47], s70 offen offset:3072 sc1
v_mfma_f32_16x16x32_bf16 v[144:147], a[136:139], a[200:203], v[144:147]
s_mov_b32 s73, 0x5d800000
ds_read_b64 a[172:173], v6 offset:1728
ds_read_b64 a[174:175], v6 offset:1736
v_add_f32 v227, v226, v230
v_mfma_f32_16x16x32_bf16 v[144:147], a[140:143], a[196:199], v[144:147]
v_add_f32 v231, v234, v238
v_add_f32 v227, v227, v231
v_cmp_nlt_f32 vcc, v227, s73
v_mfma_f32_16x16x32_bf16 v[144:147], a[144:147], a[192:195], v[144:147]
s_lshl_b32 s73, s58, 2
v_mfma_f32_16x16x32_bf16 v[148:151], a[148:151], a[192:195], v[148:151]
s_add_u32 s73, s73, 163328
ds_read_b128 a[240:243], v7 offset:1728
ds_read_b64 a[176:177], v6 offset:2240
v_mov_b32 v231, s73
v_mfma_f32_16x16x32_bf16 v[148:151], a[144:147], a[196:199], v[148:151]
s_or_b32 s73, vcc_lo, vcc_hi
v_mfma_f32_16x16x32_bf16 v[148:151], a[140:143], a[200:203], v[148:151]
s_min_u32 s73, s73, 1
v_mov_b32 v227, s73
v_mfma_f32_16x16x32_bf16 v[148:151], a[136:139], a[204:207], v[148:151]
s_nop 0
ds_read_b64 a[178:179], v6 offset:2248
ds_read_b128 a[244:247], v7 offset:1216
ds_write_b32 v231, v227
v_mfma_f32_16x16x32_bf16 v[148:151], a[132:135], a[208:211], v[148:151]
v_mfma_f32_16x16x32_bf16 v[148:151], a[128:131], a[212:215], v[148:151]
s_nop 0
ds_read_b64 a[180:181], v6 offset:2752
ds_read_b64 a[182:183], v6 offset:2760
v_mfma_f32_16x16x32_bf16 v[152:155], a[128:131], a[216:219], v[152:155]
v_mfma_f32_16x16x32_bf16 v[152:155], a[132:135], a[212:215], v[152:155]
v_mfma_f32_16x16x32_bf16 v[152:155], a[136:139], a[208:211], v[152:155]
s_nop 0
ds_read_b128 a[248:251], v7 offset:704
ds_read_b64 a[184:185], v6 offset:3264
v_mfma_f32_16x16x32_bf16 v[152:155], a[140:143], a[204:207], v[152:155]
v_mfma_f32_16x16x32_bf16 v[152:155], a[144:147], a[200:203], v[152:155]
s_nop 0
ds_read_b64 a[186:187], v6 offset:3272
ds_read_b128 a[252:255], v7 offset:192
v_mfma_f32_16x16x32_bf16 v[152:155], a[148:151], a[196:199], v[152:155]
v_mfma_f32_16x16x32_bf16 v[152:155], a[152:155], a[192:195], v[152:155]
v_mfma_f32_16x16x32_bf16 v[156:159], a[156:159], a[192:195], v[156:159]
s_nop 0
ds_read_b64 a[188:189], v6 offset:3776
ds_read_b64 a[190:191], v6 offset:3784
v_mfma_f32_16x16x32_bf16 v[156:159], a[152:155], a[196:199], v[156:159]
v_mfma_f32_16x16x32_bf16 v[156:159], a[148:151], a[200:203], v[156:159]
v_mfma_f32_16x16x32_bf16 v[156:159], a[144:147], a[204:207], v[156:159]
v_mfma_f32_16x16x32_bf16 v[156:159], a[140:143], a[208:211], v[156:159]
v_mfma_f32_16x16x32_bf16 v[156:159], a[136:139], a[212:215], v[156:159]
v_mfma_f32_16x16x32_bf16 v[156:159], a[132:135], a[216:219], v[156:159]
v_mfma_f32_16x16x32_bf16 v[156:159], a[128:131], a[220:223], v[156:159]
s_waitcnt lgkmcnt(0)
v_mfma_f32_16x16x32_bf16 v[128:131], a[160:163], a[224:227], v[128:131]
s_nop 0
ds_read_b128 a[192:195], v7 offset:3840
ds_read_b64 a[128:129], v6 offset:256
v_mfma_f32_16x16x32_bf16 v[132:135], a[164:167], a[224:227], v[132:135]
v_mfma_f32_16x16x32_bf16 v[132:135], a[160:163], a[228:231], v[132:135]
s_nop 0
ds_read_b64 a[130:131], v6 offset:264
ds_read_b128 a[196:199], v7 offset:3328
v_mfma_f32_16x16x32_bf16 v[136:139], a[160:163], a[232:235], v[136:139]
v_mfma_f32_16x16x32_bf16 v[136:139], a[164:167], a[228:231], v[136:139]
v_mfma_f32_16x16x32_bf16 v[136:139], a[168:171], a[224:227], v[136:139]
s_nop 0
ds_read_b64 a[132:133], v6 offset:768
ds_read_b64 a[134:135], v6 offset:776
v_mfma_f32_16x16x32_bf16 v[140:143], a[172:175], a[224:227], v[140:143]
v_mfma_f32_16x16x32_bf16 v[140:143], a[168:171], a[228:231], v[140:143]
s_nop 0
ds_read_b128 a[200:203], v7 offset:2816
ds_read_b64 a[136:137], v6 offset:1280
v_mfma_f32_16x16x32_bf16 v[140:143], a[164:167], a[232:235], v[140:143]
v_mfma_f32_16x16x32_bf16 v[140:143], a[160:163], a[236:239], v[140:143]
v_mfma_f32_16x16x32_bf16 v[144:147], a[160:163], a[240:243], v[144:147]
s_nop 0
ds_read_b64 a[138:139], v6 offset:1288
ds_read_b128 a[204:207], v7 offset:2304
v_mfma_f32_16x16x32_bf16 v[144:147], a[164:167], a[236:239], v[144:147]
s_nop 3
s_mov_b64 exec, 0
s_cmp_eq_u32 s58, 0
s_cbranch_scc1 Lstube0
s_cmp_eq_u32 s58, 1
s_cbranch_scc1 Lstube1
s_cmp_eq_u32 s58, 2
s_cbranch_scc1 Lstube2
s_branch Lstube3
Lrete:
s_mov_b64 exec, -1
s_nop 3
v_mfma_f32_16x16x32_bf16 v[144:147], a[168:171], a[232:235], v[144:147]
s_waitcnt vmcnt(0) lgkmcnt(15)
ds_read_b64 a[140:141], v6 offset:1792
ds_read_b64 a[142:143], v6 offset:1800
v_mfma_f32_16x16x32_bf16 v[144:147], a[172:175], a[228:231], v[144:147]
s_barrier
v_mov_b32 v244, 163328
v_mfma_f32_16x16x32_bf16 v[144:147], a[176:179], a[224:227], v[144:147]
s_xor_b32 s71, s12, 0x100
ds_read_b128 v[240:243], v244
v_mfma_f32_16x16x32_bf16 v[148:151], a[180:183], a[224:227], v[148:151]
s_add_u32 m0, s77, 16384
ds_read_b128 a[208:211], v7 offset:1792
ds_read_b64 a[144:145], v6 offset:2304
v_mfma_f32_16x16x32_bf16 v[148:151], a[176:179], a[228:231], v[148:151]
s_add_u32 s72, s71, 0
buffer_load_dwordx4 v15, s[24:27], s72 offen lds
v_mfma_f32_16x16x32_bf16 v[148:151], a[172:175], a[232:235], v[148:151]
v_mfma_f32_16x16x32_bf16 v[148:151], a[168:171], a[236:239], v[148:151]
s_nop 0
ds_read_b64 a[146:147], v6 offset:2312
ds_read_b128 a[212:215], v7 offset:1280
v_mfma_f32_16x16x32_bf16 v[148:151], a[164:167], a[240:243], v[148:151]
s_add_u32 s72, s71, 15360
buffer_load_dwordx4 v15, s[24:27], s72 offen offset:1024 lds
v_mfma_f32_16x16x32_bf16 v[148:151], a[160:163], a[244:247], v[148:151]
s_waitcnt lgkmcnt(4)
ds_read_b64 a[148:149], v6 offset:2816
ds_read_b64 a[150:151], v6 offset:2824
v_mfma_f32_16x16x32_bf16 v[152:155], a[160:163], a[248:251], v[152:155]
v_or3_b32 v240, v240, v241, v242
v_or_b32 v240, v240, v243
v_mfma_f32_16x16x32_bf16 v[152:155], a[164:167], a[244:247], v[152:155]
v_cmp_lt_u32 vcc, s86, v240
s_cbranch_vccnz Lslow
v_mfma_f32_16x16x32_bf16 v[152:155], a[168:171], a[240:243], v[152:155]
s_nop 0
ds_read_b128 a[216:219], v7 offset:768
ds_read_b64 a[152:153], v6 offset:3328
v_mfma_f32_16x16x32_bf16 v[152:155], a[172:175], a[236:239], v[152:155]
v_or_b32 v240, s58, v0
v_mov_b32 v241, 2
v_mfma_f32_16x16x32_bf16 v[152:155], a[176:179], a[232:235], v[152:155]
s_add_u32 s72, s71, 30720
ds_read_b64 a[154:155], v6 offset:3336
ds_read_b128 a[220:223], v7 offset:256
v_mfma_f32_16x16x32_bf16 v[152:155], a[180:183], a[228:231], v[152:155]
buffer_load_dwordx4 v15, s[24:27], s72 offen offset:2048 lds
v_mfma_f32_16x16x32_bf16 v[152:155], a[184:187], a[224:227], v[152:155]
v_min_u32 v240, 1, v240
v_lshlrev_b32 v240, 30, v240
v_mfma_f32_16x16x32_bf16 v[156:159], a[188:191], a[224:227], v[156:159]
s_nop 0
ds_read_b64 a[156:157], v6 offset:3840
ds_read_b64 a[158:159], v6 offset:3848
v_mfma_f32_16x16x32_bf16 v[156:159], a[184:187], a[228:231], v[156:159]
buffer_store_dword v241, v240, s[44:47], s91 offen sc1
v_mfma_f32_16x16x32_bf16 v[156:159], a[180:183], a[232:235], v[156:159]
s_add_u32 s80, s93, 0x3400000
v_and_b32 v166, 7, v0
v_lshlrev_b32 v166, 4, v166
v_mfma_f32_16x16x32_bf16 v[156:159], a[176:179], a[236:239], v[156:159]
s_add_u32 s72, s71, 46080
buffer_load_dwordx4 v15, s[24:27], s72 offen offset:3072 lds
v_mfma_f32_16x16x32_bf16 v[156:159], a[172:175], a[240:243], v[156:159]
v_bfe_u32 v112, v0, 3, 1
v_lshl_add_u32 v166, v112, 8, v166
v_mfma_f32_16x16x32_bf16 v[156:159], a[168:171], a[244:247], v[156:159]
v_bfe_u32 v112, v0, 4, 1
v_lshl_add_u32 v166, v112, 7, v166
v_mfma_f32_16x16x32_bf16 v[156:159], a[164:167], a[248:251], v[156:159]
v_lshrrev_b32 v2, 4, v0
v_lshlrev_b32 v2, 10, v2
v_mfma_f32_16x16x32_bf16 v[156:159], a[160:163], a[252:255], v[156:159]
s_waitcnt lgkmcnt(0)
v_lshrrev_b32 v112, 5, v0
v_lshl_add_u32 v166, v112, 9, v166
v_mfma_f32_16x16x32_bf16 v[128:131], a[128:131], a[192:195], v[128:131]
s_xor_b32 s82, s78, 0
ds_read_b128 a[224:227], v7 offset:3904
ds_read_b64 a[160:161], v6 offset:320
v_mfma_f32_16x16x32_bf16 v[132:135], a[132:135], a[192:195], v[132:135]
s_xor_b32 s71, s12, 0x180
v_and_b32 v112, 15, v0
v_lshrrev_b32 v113, 2, v0
v_mfma_f32_16x16x32_bf16 v[132:135], a[128:131], a[196:199], v[132:135]
s_add_u32 m0, s77, 32768
ds_read_b64 a[162:163], v6 offset:328
ds_read_b128 a[228:231], v7 offset:3392
v_mfma_f32_16x16x32_bf16 v[136:139], a[128:131], a[200:203], v[136:139]
s_add_u32 s72, s71, 0
buffer_load_dwordx4 v15, s[24:27], s72 offen lds
v_mfma_f32_16x16x32_bf16 v[136:139], a[132:135], a[196:199], v[136:139]
s_lshl_b32 s82, s82, 10
v_bfe_u32 v114, v0, 3, 2
v_and_b32 v115, 3, v0
v_mfma_f32_16x16x32_bf16 v[136:139], a[136:139], a[192:195], v[136:139]
s_add_u32 s82, s82, s74
ds_read_b64 a[164:165], v6 offset:832
ds_read_b64 a[166:167], v6 offset:840
v_mfma_f32_16x16x32_bf16 v[140:143], a[140:143], a[192:195], v[140:143]
buffer_load_dword v3, v2, s[44:47], s82 offen sc1
v_mfma_f32_16x16x32_bf16 v[140:143], a[136:139], a[196:199], v[140:143]
s_add_u32 s72, s71, 15360
ds_read_b128 a[232:235], v7 offset:2880
ds_read_b64 a[168:169], v6 offset:1344
v_mfma_f32_16x16x32_bf16 v[140:143], a[132:135], a[200:203], v[140:143]
buffer_load_dwordx4 v15, s[24:27], s72 offen offset:1024 lds
v_mfma_f32_16x16x32_bf16 v[140:143], a[128:131], a[204:207], v[140:143]
v_lshlrev_b32 v8, 7, v113
v_lshl_add_u32 v8, v114, 5, v8
v_mfma_f32_16x16x32_bf16 v[144:147], a[128:131], a[208:211], v[144:147]
s_nop 0
ds_read_b64 a[170:171], v6 offset:1352
ds_read_b128 a[236:239], v7 offset:2368
v_mfma_f32_16x16x32_bf16 v[144:147], a[132:135], a[204:207], v[144:147]
v_lshl_add_u32 v8, v115, 3, v8
v_add_u32 v8, s77, v8
v_mfma_f32_16x16x32_bf16 v[144:147], a[136:139], a[200:203], v[144:147]
s_nop 0
ds_read_b64 a[172:173], v6 offset:1856
ds_read_b64 a[174:175], v6 offset:1864
v_mfma_f32_16x16x32_bf16 v[144:147], a[140:143], a[196:199], v[144:147]
s_add_u32 s72, s71, 30720
buffer_load_dwordx4 v15, s[24:27], s72 offen offset:2048 lds
v_mfma_f32_16x16x32_bf16 v[144:147], a[144:147], a[192:195], v[144:147]
v_subrev_u32 v8, s64, v8
v_xor_b32 v9, 32, v8
v_mfma_f32_16x16x32_bf16 v[148:151], a[148:151], a[192:195], v[148:151]
s_nop 0
ds_read_b128 a[240:243], v7 offset:1856
ds_read_b64 a[176:177], v6 offset:2368
v_mfma_f32_16x16x32_bf16 v[148:151], a[144:147], a[196:199], v[148:151]
v_xor_b32 v10, 64, v8
v_xor_b32 v11, 0x60, v8
v_mfma_f32_16x16x32_bf16 v[148:151], a[140:143], a[200:203], v[148:151]
v_lshlrev_b32 v5, 8, v113
v_and_b32 v114, 1, v0
v_mfma_f32_16x16x32_bf16 v[148:151], a[136:139], a[204:207], v[148:151]
s_nop 0
ds_read_b64 a[178:179], v6 offset:2376
ds_read_b128 a[244:247], v7 offset:1344
v_mfma_f32_16x16x32_bf16 v[148:151], a[132:135], a[208:211], v[148:151]
s_add_u32 s72, s71, 46080
buffer_load_dwordx4 v15, s[24:27], s72 offen offset:3072 lds
v_mfma_f32_16x16x32_bf16 v[148:151], a[128:131], a[212:215], v[148:151]
s_nop 0
ds_read_b64 a[180:181], v6 offset:2880
ds_read_b64 a[182:183], v6 offset:2888
v_mfma_f32_16x16x32_bf16 v[152:155], a[128:131], a[216:219], v[152:155]
v_lshl_add_u32 v5, v114, 7, v5
v_bfe_u32 v114, v0, 1, 1
v_mfma_f32_16x16x32_bf16 v[152:155], a[132:135], a[212:215], v[152:155]
v_lshl_add_u32 v5, v114, 3, v5
v_lshlrev_b32 v114, 1, s58
v_mfma_f32_16x16x32_bf16 v[152:155], a[136:139], a[208:211], v[152:155]
s_nop 0
ds_read_b128 a[248:251], v7 offset:832
ds_read_b64 a[184:185], v6 offset:3392
v_mfma_f32_16x16x32_bf16 v[152:155], a[140:143], a[204:207], v[152:155]
v_xor_b32 v114, v114, v113
v_and_b32 v114, 7, v114
v_mfma_f32_16x16x32_bf16 v[152:155], a[144:147], a[200:203], v[152:155]
s_xor_b32 s71, s13, 0x80
ds_read_b64 a[186:187], v6 offset:3400
ds_read_b128 a[252:255], v7 offset:320
v_mfma_f32_16x16x32_bf16 v[152:155], a[148:151], a[196:199], v[152:155]
s_add_u32 m0, s77, 49152
v_lshl_add_u32 v5, v114, 4, v5
v_add_u32 v5, 147456, v5
v_mfma_f32_16x16x32_bf16 v[152:155], a[152:155], a[192:195], v[152:155]
s_add_u32 s72, s71, 0
buffer_load_dwordx4 v15, s[24:27], s72 offen lds
v_mfma_f32_16x16x32_bf16 v[156:159], a[156:159], a[192:195], v[156:159]
s_nop 0
ds_read_b64 a[188:189], v6 offset:3904
ds_read_b64 a[190:191], v6 offset:3912
v_mfma_f32_16x16x32_bf16 v[156:159], a[152:155], a[196:199], v[156:159]
v_bfe_u32 v114, v0, 1, 2
v_lshrrev_b32 v115, 4, v0
v_mfma_f32_16x16x32_bf16 v[156:159], a[148:151], a[200:203], v[156:159]
v_lshlrev_b32 v116, 7, v112
v_lshl_add_u32 v116, v114, 5, v116
v_mfma_f32_16x16x32_bf16 v[156:159], a[144:147], a[204:207], v[156:159]
s_add_u32 s72, s71, 15360
buffer_load_dwordx4 v15, s[24:27], s72 offen offset:1024 lds
v_mfma_f32_16x16x32_bf16 v[156:159], a[140:143], a[208:211], v[156:159]
v_lshl_add_u32 v116, v115, 3, v116
v_add_u32 v116, s64, v116
v_mfma_f32_16x16x32_bf16 v[156:159], a[136:139], a[212:215], v[156:159]
v_add_u32 v116, 131072, v116
v_xor_b32 v117, 32, v116
v_mfma_f32_16x16x32_bf16 v[156:159], a[132:135], a[216:219], v[156:159]
v_xor_b32 v118, 64, v116
v_xor_b32 v119, 0x60, v116
v_mfma_f32_16x16x32_bf16 v[156:159], a[128:131], a[220:223], v[156:159]
s_waitcnt lgkmcnt(0)
v_mfma_f32_16x16x32_bf16 v[128:131], a[160:163], a[224:227], v[128:131]
s_nop 0
ds_read_b128 a[192:195], v7 offset:3968
ds_read_b64 a[128:129], v6 offset:384
v_mfma_f32_16x16x32_bf16 v[132:135], a[164:167], a[224:227], v[132:135]
s_add_u32 s72, s71, 30720
buffer_load_dwordx4 v15, s[24:27], s72 offen offset:2048 lds
v_mfma_f32_16x16x32_bf16 v[132:135], a[160:163], a[228:231], v[132:135]
s_nop 0
ds_read_b64 a[130:131], v6 offset:392
ds_read_b128 a[196:199], v7 offset:3456
v_mfma_f32_16x16x32_bf16 v[136:139], a[160:163], a[232:235], v[136:139]
Lstub9:
s_cbranch_execz Lret
v_mfma_f32_16x16x32_bf16 v[136:139], a[164:167], a[228:231], v[136:139]
v_mfma_f32_16x16x32_bf16 v[136:139], a[168:171], a[224:227], v[136:139]
s_nop 0
ds_read_b64 a[132:133], v6 offset:896
ds_read_b64 a[134:135], v6 offset:904
v_mfma_f32_16x16x32_bf16 v[140:143], a[172:175], a[224:227], v[140:143]
v_mfma_f32_16x16x32_bf16 v[140:143], a[168:171], a[228:231], v[140:143]
s_add_u32 s72, s71, 46080
ds_read_b128 a[200:203], v7 offset:2944
ds_read_b64 a[136:137], v6 offset:1408
v_mfma_f32_16x16x32_bf16 v[140:143], a[164:167], a[232:235], v[140:143]
buffer_load_dwordx4 v15, s[24:27], s72 offen offset:3072 lds
v_mfma_f32_16x16x32_bf16 v[140:143], a[160:163], a[236:239], v[140:143]
v_mfma_f32_16x16x32_bf16 v[144:147], a[160:163], a[240:243], v[144:147]
s_nop 0
ds_read_b64 a[138:139], v6 offset:1416
ds_read_b128 a[204:207], v7 offset:2432
v_mfma_f32_16x16x32_bf16 v[144:147], a[164:167], a[236:239], v[144:147]
v_mfma_f32_16x16x32_bf16 v[144:147], a[168:171], a[232:235], v[144:147]
s_nop 0
ds_read_b64 a[140:141], v6 offset:1920
ds_read_b64 a[142:143], v6 offset:1928
v_mfma_f32_16x16x32_bf16 v[144:147], a[172:175], a[228:231], v[144:147]
v_mfma_f32_16x16x32_bf16 v[144:147], a[176:179], a[224:227], v[144:147]
v_mfma_f32_16x16x32_bf16 v[148:151], a[180:183], a[224:227], v[148:151]
s_nop 0
ds_read_b128 a[208:211], v7 offset:1920
ds_read_b64 a[144:145], v6 offset:2432
v_mfma_f32_16x16x32_bf16 v[148:151], a[176:179], a[228:231], v[148:151]
v_mfma_f32_16x16x32_bf16 v[148:151], a[172:175], a[232:235], v[148:151]
s_waitcnt vmcnt(7)
v_cmp_gt_u32 vcc, 2, v3
s_or_b32 s81, vcc_lo, vcc_hi
s_cselect_b32 s81, 0x40000000, 0
v_or_b32 v4, s81, v1
v_mfma_f32_16x16x32_bf16 v[148:151], a[168:171], a[236:239], v[148:151]
s_nop 0
ds_read_b64 a[146:147], v6 offset:2440
ds_read_b128 a[212:215], v7 offset:1408
v_mfma_f32_16x16x32_bf16 v[148:151], a[164:167], a[240:243], v[148:151]
v_mfma_f32_16x16x32_bf16 v[148:151], a[160:163], a[244:247], v[148:151]
s_nop 0
ds_read_b64 a[148:149], v6 offset:2944
ds_read_b64 a[150:151], v6 offset:2952
v_mfma_f32_16x16x32_bf16 v[152:155], a[160:163], a[248:251], v[152:155]
v_mfma_f32_16x16x32_bf16 v[152:155], a[164:167], a[244:247], v[152:155]
s_lshr_b32 s69, s12, 18
v_mfma_f32_16x16x32_bf16 v[152:155], a[168:171], a[240:243], v[152:155]
s_lshl_b32 s69, s69, 12
ds_read_b128 a[216:219], v7 offset:896
ds_read_b64 a[152:153], v6 offset:3456
v_mfma_f32_16x16x32_bf16 v[152:155], a[172:175], a[236:239], v[152:155]
s_add_u32 s69, s69, s95
buffer_load_dwordx4 a[0:3], v4, s[44:47], s69 offen sc1
v_mfma_f32_16x16x32_bf16 v[152:155], a[176:179], a[232:235], v[152:155]
s_nop 0
ds_read_b64 a[154:155], v6 offset:3464
ds_read_b128 a[220:223], v7 offset:384
v_mfma_f32_16x16x32_bf16 v[152:155], a[180:183], a[228:231], v[152:155]
v_mfma_f32_16x16x32_bf16 v[152:155], a[184:187], a[224:227], v[152:155]
v_mfma_f32_16x16x32_bf16 v[156:159], a[188:191], a[224:227], v[156:159]
s_nop 0
ds_read_b64 a[156:157], v6 offset:3968
ds_read_b64 a[158:159], v6 offset:3976
v_mfma_f32_16x16x32_bf16 v[156:159], a[184:187], a[228:231], v[156:159]
buffer_load_dwordx4 a[4:7], v4, s[44:47], s69 offen offset:1024 sc1
v_mfma_f32_16x16x32_bf16 v[156:159], a[180:183], a[232:235], v[156:159]
v_mfma_f32_16x16x32_bf16 v[156:159], a[176:179], a[236:239], v[156:159]
v_mfma_f32_16x16x32_bf16 v[156:159], a[172:175], a[240:243], v[156:159]
v_mfma_f32_16x16x32_bf16 v[156:159], a[168:171], a[244:247], v[156:159]
buffer_load_dwordx4 a[8:11], v4, s[44:47], s69 offen offset:2048 sc1
v_mfma_f32_16x16x32_bf16 v[156:159], a[164:167], a[248:251], v[156:159]
v_mfma_f32_16x16x32_bf16 v[156:159], a[160:163], a[252:255], v[156:159]
s_waitcnt lgkmcnt(0)
v_mfma_f32_16x16x32_bf16 v[128:131], a[128:131], a[192:195], v[128:131]
s_nop 0
ds_read_b128 a[224:227], v7 offset:4032
ds_read_b64 a[160:161], v6 offset:448
v_mfma_f32_16x16x32_bf16 v[132:135], a[132:135], a[192:195], v[132:135]
v_mfma_f32_16x16x32_bf16 v[132:135], a[128:131], a[196:199], v[132:135]
s_nop 0
ds_read_b64 a[162:163], v6 offset:456
ds_read_b128 a[228:231], v7 offset:3520
v_mfma_f32_16x16x32_bf16 v[136:139], a[128:131], a[200:203], v[136:139]
buffer_load_dwordx4 a[12:15], v4, s[44:47], s69 offen offset:3072 sc1
v_mfma_f32_16x16x32_bf16 v[136:139], a[132:135], a[196:199], v[136:139]
v_mfma_f32_16x16x32_bf16 v[136:139], a[136:139], a[192:195], v[136:139]
s_nop 0
ds_read_b64 a[164:165], v6 offset:960
ds_read_b64 a[166:167], v6 offset:968
v_mfma_f32_16x16x32_bf16 v[140:143], a[140:143], a[192:195], v[140:143]
v_mfma_f32_16x16x32_bf16 v[140:143], a[136:139], a[196:199], v[140:143]
s_nop 0
ds_read_b128 a[232:235], v7 offset:3008
ds_read_b64 a[168:169], v6 offset:1472
v_mfma_f32_16x16x32_bf16 v[140:143], a[132:135], a[200:203], v[140:143]
s_add_u32 s69, s69, 0x20000
buffer_load_dwordx4 a[16:19], v4, s[44:47], s69 offen sc1
v_mfma_f32_16x16x32_bf16 v[140:143], a[128:131], a[204:207], v[140:143]
v_mfma_f32_16x16x32_bf16 v[144:147], a[128:131], a[208:211], v[144:147]
s_nop 0
ds_read_b64 a[170:171], v6 offset:1480
ds_read_b128 a[236:239], v7 offset:2496
v_mfma_f32_16x16x32_bf16 v[144:147], a[132:135], a[204:207], v[144:147]
v_mfma_f32_16x16x32_bf16 v[144:147], a[136:139], a[200:203], v[144:147]
s_nop 0
ds_read_b64 a[172:173], v6 offset:1984
ds_read_b64 a[174:175], v6 offset:1992
v_mfma_f32_16x16x32_bf16 v[144:147], a[140:143], a[196:199], v[144:147]
buffer_load_dwordx4 a[20:23], v4, s[44:47], s69 offen offset:1024 sc1
v_mfma_f32_16x16x32_bf16 v[144:147], a[144:147], a[192:195], v[144:147]
v_mfma_f32_16x16x32_bf16 v[148:151], a[148:151], a[192:195], v[148:151]
s_nop 0
ds_read_b128 a[240:243], v7 offset:1984
ds_read_b64 a[176:177], v6 offset:2496
v_mfma_f32_16x16x32_bf16 v[148:151], a[144:147], a[196:199], v[148:151]
v_mfma_f32_16x16x32_bf16 v[148:151], a[140:143], a[200:203], v[148:151]
v_mfma_f32_16x16x32_bf16 v[148:151], a[136:139], a[204:207], v[148:151]
s_nop 0
ds_read_b64 a[178:179], v6 offset:2504
ds_read_b128 a[244:247], v7 offset:1472
v_mfma_f32_16x16x32_bf16 v[148:151], a[132:135], a[208:211], v[148:151]
buffer_load_dwordx4 a[24:27], v4, s[44:47], s69 offen offset:2048 sc1
v_mfma_f32_16x16x32_bf16 v[148:151], a[128:131], a[212:215], v[148:151]
s_nop 0
ds_read_b64 a[180:181], v6 offset:3008
ds_read_b64 a[182:183], v6 offset:3016
v_mfma_f32_16x16x32_bf16 v[152:155], a[128:131], a[216:219], v[152:155]
v_mfma_f32_16x16x32_bf16 v[152:155], a[132:135], a[212:215], v[152:155]
v_mfma_f32_16x16x32_bf16 v[152:155], a[136:139], a[208:211], v[152:155]
s_nop 0
ds_read_b128 a[248:251], v7 offset:960
ds_read_b64 a[184:185], v6 offset:3520
v_mfma_f32_16x16x32_bf16 v[152:155], a[140:143], a[204:207], v[152:155]
buffer_load_dwordx4 a[28:31], v4, s[44:47], s69 offen offset:3072 sc1
v_mfma_f32_16x16x32_bf16 v[152:155], a[144:147], a[200:203], v[152:155]
s_nop 0
ds_read_b64 a[186:187], v6 offset:3528
ds_read_b128 a[252:255], v7 offset:448
v_mfma_f32_16x16x32_bf16 v[152:155], a[148:151], a[196:199], v[152:155]
v_mfma_f32_16x16x32_bf16 v[152:155], a[152:155], a[192:195], v[152:155]
s_lshr_b32 s69, s13, 18
v_mfma_f32_16x16x32_bf16 v[156:159], a[156:159], a[192:195], v[156:159]
s_lshl_b32 s69, s69, 12
ds_read_b64 a[188:189], v6 offset:4032
ds_read_b64 a[190:191], v6 offset:4040
v_mfma_f32_16x16x32_bf16 v[156:159], a[152:155], a[196:199], v[156:159]
s_add_u32 s69, s69, s95
buffer_load_dwordx4 a[32:35], v4, s[44:47], s69 offen sc1
v_mfma_f32_16x16x32_bf16 v[156:159], a[148:151], a[200:203], v[156:159]
v_mfma_f32_16x16x32_bf16 v[156:159], a[144:147], a[204:207], v[156:159]
v_mfma_f32_16x16x32_bf16 v[156:159], a[140:143], a[208:211], v[156:159]
v_mfma_f32_16x16x32_bf16 v[156:159], a[136:139], a[212:215], v[156:159]
buffer_load_dwordx4 a[36:39], v4, s[44:47], s69 offen offset:1024 sc1
v_mfma_f32_16x16x32_bf16 v[156:159], a[132:135], a[216:219], v[156:159]
v_mfma_f32_16x16x32_bf16 v[156:159], a[128:131], a[220:223], v[156:159]
s_waitcnt lgkmcnt(0)
v_mfma_f32_16x16x32_bf16 v[128:131], a[160:163], a[224:227], v[128:131]
s_nop 0
ds_read_b64_tr_b16 v[192:193], v8 offset:0
ds_read_b64_tr_b16 v[194:195], v8 offset:2048
v_mfma_f32_16x16x32_bf16 v[132:135], a[164:167], a[224:227], v[132:135]
v_mfma_f32_16x16x32_bf16 v[132:135], a[160:163], a[228:231], v[132:135]
s_nop 0
ds_read_b64_tr_b16 v[196:197], v9 offset:0
ds_read_b64_tr_b16 v[198:199], v9 offset:2048
v_mfma_f32_16x16x32_bf16 v[136:139], a[160:163], a[232:235], v[136:139]
buffer_load_dwordx4 a[40:43], v4, s[44:47], s69 offen offset:2048 sc1
v_mfma_f32_16x16x32_bf16 v[136:139], a[164:167], a[228:231], v[136:139]
s_nop 0
ds_read_b64_tr_b16 v[200:201], v10 offset:0
ds_read_b64_tr_b16 v[202:203], v10 offset:2048
v_mfma_f32_16x16x32_bf16 v[136:139], a[168:171], a[224:227], v[136:139]
v_mfma_f32_16x16x32_bf16 v[140:143], a[172:175], a[224:227], v[140:143]
s_nop 0
ds_read_b64_tr_b16 v[204:205], v11 offset:0
ds_read_b64_tr_b16 v[206:207], v11 offset:2048
v_mfma_f32_16x16x32_bf16 v[140:143], a[168:171], a[228:231], v[140:143]
v_cvt_pk_bf16_f32 v128, v128, v129
v_cvt_pk_bf16_f32 v129, v130, v131
v_cvt_pk_bf16_f32 v130, v132, v133
v_mfma_f32_16x16x32_bf16 v[140:143], a[164:167], a[232:235], v[140:143]
s_nop 0
ds_read_b64_tr_b16 v[208:209], v8 offset:4096
ds_read_b64_tr_b16 v[210:211], v8 offset:6144
v_cvt_pk_bf16_f32 v131, v134, v135
v_mfma_f32_16x16x32_bf16 v[140:143], a[160:163], a[236:239], v[140:143]
s_nop 0
buffer_load_dwordx4 a[44:47], v4, s[44:47], s69 offen offset:3072 sc1
v_permlane32_swap_b32 v128, v130
v_mfma_f32_16x16x32_bf16 v[144:147], a[160:163], a[240:243], v[144:147]
s_nop 0
ds_read_b64_tr_b16 v[212:213], v9 offset:4096
ds_read_b64_tr_b16 v[214:215], v9 offset:6144
v_permlane32_swap_b32 v129, v131
v_mfma_f32_16x16x32_bf16 v[144:147], a[164:167], a[236:239], v[144:147]
buffer_store_dwordx4 v[128:131], v166, s[44:47], s80 offen sc1
v_mfma_f32_16x16x32_bf16 v[144:147], a[168:171], a[232:235], v[144:147]
s_nop 0
ds_read_b64_tr_b16 v[216:217], v10 offset:4096
ds_read_b64_tr_b16 v[218:219], v10 offset:6144
v_mfma_f32_16x16x32_bf16 v[144:147], a[172:175], a[228:231], v[144:147]
s_add_u32 s69, s69, 0x20000
buffer_load_dwordx4 a[48:51], v4, s[44:47], s69 offen sc1
v_mfma_f32_16x16x32_bf16 v[144:147], a[176:179], a[224:227], v[144:147]
s_nop 0
ds_read_b64_tr_b16 v[220:221], v11 offset:4096
ds_read_b64_tr_b16 v[222:223], v11 offset:6144
v_cvt_pk_bf16_f32 v136, v136, v137
v_mfma_f32_16x16x32_bf16 v[148:151], a[180:183], a[224:227], v[148:151]
v_cvt_pk_bf16_f32 v137, v138, v139
v_cvt_pk_bf16_f32 v138, v140, v141
v_cvt_pk_bf16_f32 v139, v142, v143
v_mfma_f32_16x16x32_bf16 v[148:151], a[176:179], a[228:231], v[148:151]
s_nop 0
ds_read_b64_tr_b16 v[224:225], v8 offset:8192
ds_read_b64_tr_b16 v[226:227], v8 offset:10240
v_permlane32_swap_b32 v136, v138
v_mfma_f32_16x16x32_bf16 v[148:151], a[172:175], a[232:235], v[148:151]
v_permlane32_swap_b32 v137, v139
v_mfma_f32_16x16x32_bf16 v[148:151], a[168:171], a[236:239], v[148:151]
s_nop 0
ds_read_b64_tr_b16 v[228:229], v9 offset:8192
ds_read_b64_tr_b16 v[230:231], v9 offset:10240
v_mfma_f32_16x16x32_bf16 v[148:151], a[164:167], a[240:243], v[148:151]
buffer_load_dwordx4 a[52:55], v4, s[44:47], s69 offen offset:1024 sc1
v_mfma_f32_16x16x32_bf16 v[148:151], a[160:163], a[244:247], v[148:151]
s_nop 0
ds_read_b64_tr_b16 v[232:233], v10 offset:8192
ds_read_b64_tr_b16 v[234:235], v10 offset:10240
v_mfma_f32_16x16x32_bf16 v[152:155], a[160:163], a[248:251], v[152:155]
buffer_store_dwordx4 v[136:139], v166, s[44:47], s80 offen offset:1024 sc1
v_mfma_f32_16x16x32_bf16 v[152:155], a[164:167], a[244:247], v[152:155]
s_nop 0
ds_read_b64_tr_b16 v[236:237], v11 offset:8192
ds_read_b64_tr_b16 v[238:239], v11 offset:10240
v_mfma_f32_16x16x32_bf16 v[152:155], a[168:171], a[240:243], v[152:155]
buffer_load_dwordx4 a[56:59], v4, s[44:47], s69 offen offset:2048 sc1
v_mfma_f32_16x16x32_bf16 v[152:155], a[172:175], a[236:239], v[152:155]
s_nop 0
ds_read_b64_tr_b16 v[240:241], v8 offset:12288
ds_read_b64_tr_b16 v[242:243], v8 offset:14336
v_mfma_f32_16x16x32_bf16 v[152:155], a[176:179], a[232:235], v[152:155]
v_cvt_pk_bf16_f32 v144, v144, v145
v_cvt_pk_bf16_f32 v145, v146, v147
v_cvt_pk_bf16_f32 v146, v148, v149
v_mfma_f32_16x16x32_bf16 v[152:155], a[180:183], a[228:231], v[152:155]
s_nop 0
ds_read_b64_tr_b16 v[244:245], v9 offset:12288
ds_read_b64_tr_b16 v[246:247], v9 offset:14336
v_cvt_pk_bf16_f32 v147, v150, v151
v_mfma_f32_16x16x32_bf16 v[152:155], a[184:187], a[224:227], v[152:155]
v_permlane32_swap_b32 v144, v146
v_permlane32_swap_b32 v145, v147
v_mfma_f32_16x16x32_bf16 v[156:159], a[188:191], a[224:227], v[156:159]
s_nop 0
ds_read_b64_tr_b16 v[248:249], v10 offset:12288
ds_read_b64_tr_b16 v[250:251], v10 offset:14336
v_mfma_f32_16x16x32_bf16 v[156:159], a[184:187], a[228:231], v[156:159]
buffer_load_dwordx4 a[60:63], v4, s[44:47], s69 offen offset:3072 sc1
v_mfma_f32_16x16x32_bf16 v[156:159], a[180:183], a[232:235], v[156:159]
s_nop 0
ds_read_b64_tr_b16 v[252:253], v11 offset:12288
ds_read_b64_tr_b16 v[254:255], v11 offset:14336
v_mfma_f32_16x16x32_bf16 v[156:159], a[176:179], a[236:239], v[156:159]
buffer_store_dwordx4 v[144:147], v166, s[44:47], s80 offen offset:2048 sc1
v_mfma_f32_16x16x32_bf16 v[156:159], a[172:175], a[240:243], v[156:159]
v_mfma_f32_16x16x32_bf16 v[156:159], a[168:171], a[244:247], v[156:159]
v_mfma_f32_16x16x32_bf16 v[156:159], a[164:167], a[248:251], v[156:159]
v_mfma_f32_16x16x32_bf16 v[156:159], a[160:163], a[252:255], v[156:159]
v_cvt_pk_bf16_f32 v152, v152, v153
v_cvt_pk_bf16_f32 v153, v154, v155
s_nop 5
v_cvt_pk_bf16_f32 v154, v156, v157
v_cvt_pk_bf16_f32 v155, v158, v159
s_nop 0
v_permlane32_swap_b32 v152, v154
v_permlane32_swap_b32 v153, v155
buffer_store_dwordx4 v[152:155], v166, s[44:47], s80 offen offset:3072 sc1
s_waitcnt vmcnt(12) lgkmcnt(0)
s_cmp_lg_u32 s81, 0
s_cbranch_scc1 Lredo0
Lredo0b:
s_barrier
v_mfma_f32_16x16x32_bf16 v[16:19], v[192:195], a[0:3], 0
s_nop 0
ds_read_b64_tr_b16 v[128:129], v8 offset:16384
ds_read_b64_tr_b16 v[130:131], v8 offset:18432
v_mfma_f32_16x16x32_bf16 v[16:19], v[208:211], a[4:7], v[16:19]
s_xor_b32 s71, s13, 0x100
ds_read_b64_tr_b16 v[132:133], v9 offset:16384
ds_read_b64_tr_b16 v[134:135], v9 offset:18432
v_mfma_f32_16x16x32_bf16 v[16:19], v[224:227], a[8:11], v[16:19]
s_add_u32 m0, s85, 0
ds_read_b64_tr_b16 v[136:137], v10 offset:16384
ds_read_b64_tr_b16 v[138:139], v10 offset:18432
v_mfma_f32_16x16x32_bf16 v[16:19], v[240:243], a[12:15], v[16:19]
s_add_u32 s72, s71, 0
buffer_load_dwordx4 v15, s[24:27], s72 offen lds
v_mfma_f32_16x16x32_bf16 v[32:35], v[240:243], a[28:31], 0
s_lshr_b32 s69, s14, 18
ds_read_b64_tr_b16 v[140:141], v11 offset:16384
ds_read_b64_tr_b16 v[142:143], v11 offset:18432
v_mfma_f32_16x16x32_bf16 v[32:35], v[224:227], a[24:27], v[32:35]
s_lshl_b32 s69, s69, 12
v_add_u32 v4, s64, v1
v_add_u32 v4, 131072, v4
v_mfma_f32_16x16x32_bf16 v[32:35], v[208:211], a[20:23], v[32:35]
s_add_u32 s69, s69, s95
buffer_load_dwordx4 a[64:67], v1, s[44:47], s69 offen sc1
v_mfma_f32_16x16x32_bf16 v[32:35], v[192:195], a[16:19], v[32:35]
s_lshl_b32 s70, s75, 18
ds_read_b64_tr_b16 v[144:145], v8 offset:20480
ds_read_b64_tr_b16 v[146:147], v8 offset:22528
v_mfma_f32_16x16x32_bf16 v[36:39], v[196:199], a[16:19], 0
s_add_u32 s72, s71, 15360
buffer_load_dwordx4 v15, s[24:27], s72 offen offset:1024 lds
v_mfma_f32_16x16x32_bf16 v[36:39], v[212:215], a[20:23], v[36:39]
s_add_u32 s70, s70, s94
ds_read_b64_tr_b16 v[148:149], v9 offset:20480
ds_read_b64_tr_b16 v[150:151], v9 offset:22528
v_mfma_f32_16x16x32_bf16 v[36:39], v[228:231], a[24:27], v[36:39]
s_nop 0
ds_read_b64_tr_b16 v[152:153], v10 offset:20480
ds_read_b64_tr_b16 v[154:155], v10 offset:22528
v_mfma_f32_16x16x32_bf16 v[36:39], v[244:247], a[28:31], v[36:39]
s_nop 0
ds_read_b64_tr_b16 v[156:157], v11 offset:20480
ds_read_b64_tr_b16 v[158:159], v11 offset:22528
v_mfma_f32_16x16x32_bf16 v[20:23], v[244:247], a[12:15], 0
ds_write_b128 v4, v[80:83] offset:0
v_mfma_f32_16x16x32_bf16 v[20:23], v[228:231], a[8:11], v[20:23]
s_nop 0
ds_read_b64_tr_b16 v[160:161], v8 offset:24576
ds_read_b64_tr_b16 v[162:163], v8 offset:26624
v_mfma_f32_16x16x32_bf16 v[20:23], v[212:215], a[4:7], v[20:23]
s_add_u32 s72, s71, 30720
buffer_load_dwordx4 v15, s[24:27], s72 offen offset:2048 lds
v_mfma_f32_16x16x32_bf16 v[20:23], v[196:199], a[0:3], v[20:23]
buffer_load_dwordx4 a[68:71], v1, s[44:47], s69 offen offset:1024 sc1
v_mfma_f32_16x16x32_bf16 v[24:27], v[200:203], a[0:3], 0
s_nop 0
ds_read_b64_tr_b16 v[164:165], v9 offset:24576
ds_read_b64_tr_b16 v[166:167], v9 offset:26624
v_mfma_f32_16x16x32_bf16 v[24:27], v[216:219], a[4:7], v[24:27]
s_nop 0
ds_read_b64_tr_b16 v[168:169], v10 offset:24576
ds_read_b64_tr_b16 v[170:171], v10 offset:26624
v_mfma_f32_16x16x32_bf16 v[24:27], v[232:235], a[8:11], v[24:27]
s_nop 0
ds_read_b64_tr_b16 v[172:173], v11 offset:24576
ds_read_b64_tr_b16 v[174:175], v11 offset:26624
v_mfma_f32_16x16x32_bf16 v[24:27], v[248:251], a[12:15], v[24:27]
ds_write_b128 v4, v[84:87] offset:1024
v_mfma_f32_16x16x32_bf16 v[40:43], v[248:251], a[28:31], 0
s_add_u32 s72, s71, 46080
buffer_load_dwordx4 v15, s[24:27], s72 offen offset:3072 lds
v_mfma_f32_16x16x32_bf16 v[40:43], v[232:235], a[24:27], v[40:43]
s_nop 0
ds_read_b64_tr_b16 v[176:177], v8 offset:28672
ds_read_b64_tr_b16 v[178:179], v8 offset:30720
v_mfma_f32_16x16x32_bf16 v[40:43], v[216:219], a[20:23], v[40:43]
s_nop 0
ds_read_b64_tr_b16 v[180:181], v9 offset:28672
ds_read_b64_tr_b16 v[182:183], v9 offset:30720
v_mfma_f32_16x16x32_bf16 v[40:43], v[200:203], a[16:19], v[40:43]
s_nop 0
ds_read_b64_tr_b16 v[184:185], v10 offset:28672
ds_read_b64_tr_b16 v[186:187], v10 offset:30720
v_mfma_f32_16x16x32_bf16 v[44:47], v[204:207], a[16:19], 0
s_nop 0
ds_read_b64_tr_b16 v[188:189], v11 offset:28672
ds_read_b64_tr_b16 v[190:191], v11 offset:30720
v_mfma_f32_16x16x32_bf16 v[44:47], v[220:223], a[20:23], v[44:47]
buffer_load_dwordx4 a[72:75], v1, s[44:47], s69 offen offset:2048 sc1
v_mfma_f32_16x16x32_bf16 v[44:47], v[236:239], a[24:27], v[44:47]
ds_write_b128 v4, v[96:99] offset:2048
v_mfma_f32_16x16x32_bf16 v[44:47], v[252:255], a[28:31], v[44:47]
s_xor_b32 s71, s13, 0x180
v_mfma_f32_16x16x32_bf16 v[28:31], v[252:255], a[12:15], 0
s_add_u32 m0, s85, 16384
ds_write_b128 v4, v[100:103] offset:3072
v_mfma_f32_16x16x32_bf16 v[28:31], v[236:239], a[8:11], v[28:31]
s_add_u32 s72, s71, 0
v_mfma_f32_16x16x32_bf16 v[28:31], v[220:223], a[4:7], v[28:31]
s_waitcnt vmcnt(31) lgkmcnt(0)
buffer_load_dwordx4 v15, s[24:27], s72 offen lds
v_mfma_f32_16x16x32_bf16 v[28:31], v[204:207], a[0:3], v[28:31]
s_barrier
v_mfma_f32_16x16x32_bf16 v[48:51], v[128:131], a[0:3], 0
s_nop 0
ds_read_b64_tr_b16 v[192:193], v8 offset:32768
ds_read_b64_tr_b16 v[194:195], v8 offset:34816
v_mfma_f32_16x16x32_bf16 v[48:51], v[144:147], a[4:7], v[48:51]
s_nop 0
ds_read_b64_tr_b16 v[196:197], v9 offset:32768
ds_read_b64_tr_b16 v[198:199], v9 offset:34816
v_mfma_f32_16x16x32_bf16 v[48:51], v[160:163], a[8:11], v[48:51]
s_nop 0
ds_read_b64_tr_b16 v[200:201], v10 offset:32768
ds_read_b64_tr_b16 v[202:203], v10 offset:34816
v_mfma_f32_16x16x32_bf16 v[48:51], v[176:179], a[12:15], v[48:51]
s_add_u32 s72, s71, 15360
buffer_load_dwordx4 v15, s[24:27], s72 offen offset:1024 lds
v_mfma_f32_16x16x32_bf16 v[64:67], v[176:179], a[28:31], 0
buffer_load_dwordx4 a[76:79], v1, s[44:47], s69 offen offset:3072 sc1
v_mfma_f32_16x16x32_bf16 v[64:67], v[160:163], a[24:27], v[64:67]
s_nop 0
ds_read_b64_tr_b16 v[204:205], v11 offset:32768
ds_read_b64_tr_b16 v[206:207], v11 offset:34816
v_mfma_f32_16x16x32_bf16 v[64:67], v[144:147], a[20:23], v[64:67]
v_mfma_f32_16x16x32_bf16 v[64:67], v[128:131], a[16:19], v[64:67]
s_nop 0
ds_read_b64_tr_b16 v[208:209], v8 offset:36864
ds_read_b64_tr_b16 v[210:211], v8 offset:38912
v_mfma_f32_16x16x32_bf16 v[68:71], v[132:135], a[16:19], 0
s_nop 0
ds_read_b64_tr_b16 v[212:213], v9 offset:36864
ds_read_b64_tr_b16 v[214:215], v9 offset:38912
v_mfma_f32_16x16x32_bf16 v[68:71], v[148:151], a[20:23], v[68:71]
s_add_u32 s72, s71, 30720
buffer_load_dwordx4 v15, s[24:27], s72 offen offset:2048 lds
v_mfma_f32_16x16x32_bf16 v[68:71], v[164:167], a[24:27], v[68:71]
s_nop 0
ds_read_b64_tr_b16 v[216:217], v10 offset:36864
ds_read_b64_tr_b16 v[218:219], v10 offset:38912
v_mfma_f32_16x16x32_bf16 v[68:71], v[180:183], a[28:31], v[68:71]
s_nop 0
ds_read_b64_tr_b16 v[220:221], v11 offset:36864
ds_read_b64_tr_b16 v[222:223], v11 offset:38912
v_mfma_f32_16x16x32_bf16 v[52:55], v[180:183], a[12:15], 0
v_mfma_f32_16x16x32_bf16 v[52:55], v[164:167], a[8:11], v[52:55]
s_add_u32 s69, s69, 0x20000
buffer_load_dwordx4 a[80:83], v1, s[44:47], s69 offen sc1
v_mfma_f32_16x16x32_bf16 v[52:55], v[148:151], a[4:7], v[52:55]
s_nop 0
ds_read_b64_tr_b16 v[224:225], v8 offset:40960
ds_read_b64_tr_b16 v[226:227], v8 offset:43008
v_mfma_f32_16x16x32_bf16 v[52:55], v[132:135], a[0:3], v[52:55]
s_add_u32 s72, s71, 46080
buffer_load_dwordx4 v15, s[24:27], s72 offen offset:3072 lds
v_mfma_f32_16x16x32_bf16 v[56:59], v[136:139], a[0:3], 0
s_nop 0
ds_read_b64_tr_b16 v[228:229], v9 offset:40960
ds_read_b64_tr_b16 v[230:231], v9 offset:43008
v_mfma_f32_16x16x32_bf16 v[56:59], v[152:155], a[4:7], v[56:59]
s_nop 0
ds_read_b64_tr_b16 v[232:233], v10 offset:40960
ds_read_b64_tr_b16 v[234:235], v10 offset:43008
v_mfma_f32_16x16x32_bf16 v[56:59], v[168:171], a[8:11], v[56:59]
s_nop 0
ds_read_b64_tr_b16 v[236:237], v11 offset:40960
ds_read_b64_tr_b16 v[238:239], v11 offset:43008
v_mfma_f32_16x16x32_bf16 v[56:59], v[184:187], a[12:15], v[56:59]
v_mfma_f32_16x16x32_bf16 v[72:75], v[184:187], a[28:31], 0
s_nop 0
ds_read_b64_tr_b16 v[240:241], v8 offset:45056
ds_read_b64_tr_b16 v[242:243], v8 offset:47104
v_mfma_f32_16x16x32_bf16 v[72:75], v[168:171], a[24:27], v[72:75]
s_nop 0
ds_read_b64_tr_b16 v[244:245], v9 offset:45056
ds_read_b64_tr_b16 v[246:247], v9 offset:47104
v_mfma_f32_16x16x32_bf16 v[72:75], v[152:155], a[20:23], v[72:75]
s_nop 0
ds_read_b64_tr_b16 v[248:249], v10 offset:45056
ds_read_b64_tr_b16 v[250:251], v10 offset:47104
v_mfma_f32_16x16x32_bf16 v[72:75], v[136:139], a[16:19], v[72:75]
s_xor_b32 s71, s14, 0x80
buffer_load_dwordx4 a[84:87], v1, s[44:47], s69 offen offset:1024 sc1
v_mfma_f32_16x16x32_bf16 v[76:79], v[140:143], a[16:19], 0
s_add_u32 m0, s85, 32768
ds_read_b64_tr_b16 v[252:253], v11 offset:45056
ds_read_b64_tr_b16 v[254:255], v11 offset:47104
v_mfma_f32_16x16x32_bf16 v[76:79], v[156:159], a[20:23], v[76:79]
s_add_u32 s72, s71, 0
buffer_load_dwordx4 v15, s[24:27], s72 offen lds
v_mfma_f32_16x16x32_bf16 v[76:79], v[172:175], a[24:27], v[76:79]
v_mfma_f32_16x16x32_bf16 v[76:79], v[188:191], a[28:31], v[76:79]
v_mfma_f32_16x16x32_bf16 v[60:63], v[188:191], a[12:15], 0
v_mfma_f32_16x16x32_bf16 v[60:63], v[172:175], a[8:11], v[60:63]
s_add_u32 s72, s71, 15360
v_mfma_f32_16x16x32_bf16 v[60:63], v[156:159], a[4:7], v[60:63]
s_waitcnt vmcnt(35) lgkmcnt(0)
v_mfma_f32_16x16x32_bf16 v[60:63], v[140:143], a[0:3], v[60:63]
s_barrier
buffer_load_dwordx4 v15, s[24:27], s72 offen offset:1024 lds
v_mfma_f32_16x16x32_bf16 v[80:83], v[192:195], a[0:3], 0
s_nop 0
ds_read_b64_tr_b16 v[128:129], v8 offset:49152
ds_read_b64_tr_b16 v[130:131], v8 offset:51200
v_mfma_f32_16x16x32_bf16 v[80:83], v[208:211], a[4:7], v[80:83]
buffer_load_dwordx4 a[88:91], v1, s[44:47], s69 offen offset:2048 sc1
v_mfma_f32_16x16x32_bf16 v[80:83], v[224:227], a[8:11], v[80:83]
s_nop 0
ds_read_b64_tr_b16 v[132:133], v9 offset:49152
ds_read_b64_tr_b16 v[134:135], v9 offset:51200
v_mfma_f32_16x16x32_bf16 v[80:83], v[240:243], a[12:15], v[80:83]
s_nop 0
ds_read_b64_tr_b16 v[136:137], v10 offset:49152
ds_read_b64_tr_b16 v[138:139], v10 offset:51200
v_mfma_f32_16x16x32_bf16 v[96:99], v[240:243], a[28:31], 0
s_nop 0
ds_read_b64_tr_b16 v[140:141], v11 offset:49152
ds_read_b64_tr_b16 v[142:143], v11 offset:51200
v_mfma_f32_16x16x32_bf16 v[96:99], v[224:227], a[24:27], v[96:99]
s_add_u32 s72, s71, 30720
buffer_load_dwordx4 v15, s[24:27], s72 offen offset:2048 lds
v_mfma_f32_16x16x32_bf16 v[96:99], v[208:211], a[20:23], v[96:99]
v_mfma_f32_16x16x32_bf16 v[96:99], v[192:195], a[16:19], v[96:99]
s_nop 0
ds_read_b64_tr_b16 v[144:145], v8 offset:53248
ds_read_b64_tr_b16 v[146:147], v8 offset:55296
v_mfma_f32_16x16x32_bf16 v[100:103], v[196:199], a[16:19], 0
s_nop 0
ds_read_b64_tr_b16 v[148:149], v9 offset:53248
ds_read_b64_tr_b16 v[150:151], v9 offset:55296
v_mfma_f32_16x16x32_bf16 v[100:103], v[212:215], a[20:23], v[100:103]
s_nop 0
ds_read_b64_tr_b16 v[152:153], v10 offset:53248
ds_read_b64_tr_b16 v[154:155], v10 offset:55296
v_mfma_f32_16x16x32_bf16 v[100:103], v[228:231], a[24:27], v[100:103]
s_nop 0
ds_read_b64_tr_b16 v[156:157], v11 offset:53248
ds_read_b64_tr_b16 v[158:159], v11 offset:55296
v_mfma_f32_16x16x32_bf16 v[100:103], v[244:247], a[28:31], v[100:103]
s_add_u32 s72, s71, 46080
buffer_load_dwordx4 v15, s[24:27], s72 offen offset:3072 lds
v_mfma_f32_16x16x32_bf16 v[84:87], v[244:247], a[12:15], 0
buffer_load_dwordx4 a[92:95], v1, s[44:47], s69 offen offset:3072 sc1
v_mfma_f32_16x16x32_bf16 v[84:87], v[228:231], a[8:11], v[84:87]
v_mfma_f32_16x16x32_bf16 v[84:87], v[212:215], a[4:7], v[84:87]
s_nop 0
ds_read_b64_tr_b16 v[160:161], v8 offset:57344
ds_read_b64_tr_b16 v[162:163], v8 offset:59392
v_mfma_f32_16x16x32_bf16 v[84:87], v[196:199], a[0:3], v[84:87]
s_nop 0
ds_read_b64_tr_b16 v[164:165], v9 offset:57344
ds_read_b64_tr_b16 v[166:167], v9 offset:59392
v_mfma_f32_16x16x32_bf16 v[88:91], v[200:203], a[0:3], 0
s_nop 0
ds_read_b64_tr_b16 v[168:169], v10 offset:57344
ds_read_b64_tr_b16 v[170:171], v10 offset:59392
v_mfma_f32_16x16x32_bf16 v[88:91], v[216:219], a[4:7], v[88:91]
s_xor_b32 s82, s78, 16
ds_read_b64_tr_b16 v[172:173], v11 offset:57344
ds_read_b64_tr_b16 v[174:175], v11 offset:59392
v_mfma_f32_16x16x32_bf16 v[88:91], v[232:235], a[8:11], v[88:91]
s_lshl_b32 s82, s82, 10
v_mfma_f32_16x16x32_bf16 v[88:91], v[248:251], a[12:15], v[88:91]
s_xor_b32 s71, s14, 0x100
ds_read_b64_tr_b16 v[176:177], v8 offset:61440
ds_read_b64_tr_b16 v[178:179], v8 offset:63488
v_mfma_f32_16x16x32_bf16 v[104:107], v[248:251], a[28:31], 0
s_add_u32 m0, s85, 49152
ds_read_b64_tr_b16 v[180:181], v9 offset:61440
ds_read_b64_tr_b16 v[182:183], v9 offset:63488
v_mfma_f32_16x16x32_bf16 v[104:107], v[232:235], a[24:27], v[104:107]
s_add_u32 s72, s71, 0
buffer_load_dwordx4 v15, s[24:27], s72 offen lds
v_mfma_f32_16x16x32_bf16 v[104:107], v[216:219], a[20:23], v[104:107]
s_add_u32 s82, s82, s74
buffer_load_dword v3, v2, s[44:47], s82 offen sc1
v_mfma_f32_16x16x32_bf16 v[104:107], v[200:203], a[16:19], v[104:107]
s_nop 0
ds_read_b64_tr_b16 v[184:185], v10 offset:61440
ds_read_b64_tr_b16 v[186:187], v10 offset:63488
v_mfma_f32_16x16x32_bf16 v[108:111], v[204:207], a[16:19], 0
s_nop 0
ds_read_b64_tr_b16 v[188:189], v11 offset:61440
ds_read_b64_tr_b16 v[190:191], v11 offset:63488
v_mfma_f32_16x16x32_bf16 v[108:111], v[220:223], a[20:23], v[108:111]
Lstube0:
s_cbranch_execz Lstube4
v_mfma_f32_16x16x32_bf16 v[108:111], v[236:239], a[24:27], v[108:111]
s_add_u32 s72, s71, 15360
buffer_load_dwordx4 v15, s[24:27], s72 offen offset:1024 lds
v_mfma_f32_16x16x32_bf16 v[108:111], v[252:255], a[28:31], v[108:111]
s_lshr_b32 s69, s15, 18
v_mfma_f32_16x16x32_bf16 v[92:95], v[252:255], a[12:15], 0
s_lshl_b32 s69, s69, 12
v_xor_b32 v8, 0x10000, v8
v_mfma_f32_16x16x32_bf16 v[92:95], v[236:239], a[8:11], v[92:95]
s_add_u32 s69, s69, s95
v_xor_b32 v9, 0x10000, v9
v_mfma_f32_16x16x32_bf16 v[92:95], v[220:223], a[4:7], v[92:95]
s_waitcnt vmcnt(17) lgkmcnt(0)
v_xor_b32 v10, 0x10000, v10
v_mfma_f32_16x16x32_bf16 v[92:95], v[204:207], a[0:3], v[92:95]
s_barrier
buffer_load_dwordx4 a[96:99], v1, s[44:47], s69 offen sc1
v_xor_b32 v11, 0x10000, v11
v_mfma_f32_16x16x32_bf16 v[16:19], v[128:131], a[32:35], v[16:19]
s_add_u32 s72, s71, 30720
buffer_load_dwordx4 v15, s[24:27], s72 offen offset:2048 lds
v_mfma_f32_16x16x32_bf16 v[16:19], v[144:147], a[36:39], v[16:19]
s_nop 0
ds_read_b64_tr_b16 v[192:193], v8 offset:0
ds_read_b64_tr_b16 v[194:195], v8 offset:2048
v_mfma_f32_16x16x32_bf16 v[16:19], v[160:163], a[40:43], v[16:19]
s_nop 0
ds_read_b64_tr_b16 v[196:197], v9 offset:0
ds_read_b64_tr_b16 v[198:199], v9 offset:2048
v_mfma_f32_16x16x32_bf16 v[16:19], v[176:179], a[44:47], v[16:19]
s_nop 0
ds_read_b64_tr_b16 v[200:201], v10 offset:0
ds_read_b64_tr_b16 v[202:203], v10 offset:2048
v_mfma_f32_16x16x32_bf16 v[32:35], v[176:179], a[60:63], v[32:35]
s_nop 0
ds_read_b64_tr_b16 v[204:205], v11 offset:0
ds_read_b64_tr_b16 v[206:207], v11 offset:2048
v_mfma_f32_16x16x32_bf16 v[32:35], v[160:163], a[56:59], v[32:35]
v_or_b32 v112, s58, v0
v_mov_b32 v113, 3
v_mfma_f32_16x16x32_bf16 v[32:35], v[144:147], a[52:55], v[32:35]
s_add_u32 s72, s71, 46080
buffer_load_dwordx4 v15, s[24:27], s72 offen offset:3072 lds
v_mfma_f32_16x16x32_bf16 v[32:35], v[128:131], a[48:51], v[32:35]
s_nop 0
ds_read_b64_tr_b16 v[208:209], v8 offset:4096
ds_read_b64_tr_b16 v[210:211], v8 offset:6144
v_mfma_f32_16x16x32_bf16 v[36:39], v[132:135], a[48:51], v[36:39]
s_nop 0
ds_read_b64_tr_b16 v[212:213], v9 offset:4096
ds_read_b64_tr_b16 v[214:215], v9 offset:6144
v_mfma_f32_16x16x32_bf16 v[36:39], v[148:151], a[52:55], v[36:39]
buffer_load_dwordx4 a[100:103], v1, s[44:47], s69 offen offset:1024 sc1
v_mfma_f32_16x16x32_bf16 v[36:39], v[164:167], a[56:59], v[36:39]
s_nop 0
ds_read_b64_tr_b16 v[216:217], v10 offset:4096
ds_read_b64_tr_b16 v[218:219], v10 offset:6144
v_mfma_f32_16x16x32_bf16 v[36:39], v[180:183], a[60:63], v[36:39]
v_min_u32 v112, 1, v112
v_lshlrev_b32 v112, 30, v112
v_mfma_f32_16x16x32_bf16 v[20:23], v[180:183], a[44:47], v[20:23]
s_nop 0
ds_read_b64_tr_b16 v[220:221], v11 offset:4096
ds_read_b64_tr_b16 v[222:223], v11 offset:6144
v_mfma_f32_16x16x32_bf16 v[20:23], v[164:167], a[40:43], v[20:23]
s_nop 0
ds_read_b64_tr_b16 v[224:225], v8 offset:8192
ds_read_b64_tr_b16 v[226:227], v8 offset:10240
v_mfma_f32_16x16x32_bf16 v[20:23], v[148:151], a[36:39], v[20:23]
s_xor_b32 s71, s14, 0x180
ds_read_b64_tr_b16 v[228:229], v9 offset:8192
ds_read_b64_tr_b16 v[230:231], v9 offset:10240
v_mfma_f32_16x16x32_bf16 v[20:23], v[132:135], a[32:35], v[20:23]
s_add_u32 m0, s77, 0
buffer_store_dword v113, v112, s[44:47], s91 offen sc1
v_mfma_f32_16x16x32_bf16 v[24:27], v[136:139], a[32:35], v[24:27]
s_add_u32 s72, s71, 0
buffer_load_dwordx4 v15, s[24:27], s72 offen lds
v_mfma_f32_16x16x32_bf16 v[24:27], v[152:155], a[36:39], v[24:27]
s_nop 0
ds_read_b64_tr_b16 v[232:233], v10 offset:8192
ds_read_b64_tr_b16 v[234:235], v10 offset:10240
v_mfma_f32_16x16x32_bf16 v[24:27], v[168:171], a[40:43], v[24:27]
s_nop 0
ds_read_b64_tr_b16 v[236:237], v11 offset:8192
ds_read_b64_tr_b16 v[238:239], v11 offset:10240
v_mfma_f32_16x16x32_bf16 v[24:27], v[184:187], a[44:47], v[24:27]
buffer_load_dwordx4 a[104:107], v1, s[44:47], s69 offen offset:2048 sc1
v_mfma_f32_16x16x32_bf16 v[40:43], v[184:187], a[60:63], v[40:43]
s_nop 0
ds_read_b64_tr_b16 v[240:241], v8 offset:12288
ds_read_b64_tr_b16 v[242:243], v8 offset:14336
v_mfma_f32_16x16x32_bf16 v[40:43], v[168:171], a[56:59], v[40:43]
v_mfma_f32_16x16x32_bf16 v[40:43], v[152:155], a[52:55], v[40:43]
s_add_u32 s72, s71, 15360
buffer_load_dwordx4 v15, s[24:27], s72 offen offset:1024 lds
v_mfma_f32_16x16x32_bf16 v[40:43], v[136:139], a[48:51], v[40:43]
s_nop 0
ds_read_b64_tr_b16 v[244:245], v9 offset:12288
ds_read_b64_tr_b16 v[246:247], v9 offset:14336
v_mfma_f32_16x16x32_bf16 v[44:47], v[140:143], a[48:51], v[44:47]
s_nop 0
ds_read_b64_tr_b16 v[248:249], v10 offset:12288
ds_read_b64_tr_b16 v[250:251], v10 offset:14336
v_mfma_f32_16x16x32_bf16 v[44:47], v[156:159], a[52:55], v[44:47]
s_nop 0
ds_read_b64_tr_b16 v[252:253], v11 offset:12288
ds_read_b64_tr_b16 v[254:255], v11 offset:14336
v_mfma_f32_16x16x32_bf16 v[44:47], v[172:175], a[56:59], v[44:47]
v_mfma_f32_16x16x32_bf16 v[44:47], v[188:191], a[60:63], v[44:47]
v_mfma_f32_16x16x32_bf16 v[28:31], v[188:191], a[44:47], v[28:31]
s_add_u32 s72, s71, 30720
buffer_load_dwordx4 v15, s[24:27], s72 offen offset:2048 lds
v_mfma_f32_16x16x32_bf16 v[28:31], v[172:175], a[40:43], v[28:31]
buffer_load_dwordx4 a[108:111], v1, s[44:47], s69 offen offset:3072 sc1
v_mfma_f32_16x16x32_bf16 v[28:31], v[156:159], a[36:39], v[28:31]
s_waitcnt vmcnt(20) lgkmcnt(0)
v_mfma_f32_16x16x32_bf16 v[28:31], v[140:143], a[32:35], v[28:31]
s_barrier
v_mfma_f32_16x16x32_bf16 v[48:51], v[192:195], a[32:35], v[48:51]
s_nop 0
ds_read_b64_tr_b16 v[128:129], v8 offset:16384
ds_read_b64_tr_b16 v[130:131], v8 offset:18432
v_mfma_f32_16x16x32_bf16 v[48:51], v[208:211], a[36:39], v[48:51]
s_nop 0
ds_read_b64_tr_b16 v[132:133], v9 offset:16384
ds_read_b64_tr_b16 v[134:135], v9 offset:18432
v_mfma_f32_16x16x32_bf16 v[48:51], v[224:227], a[40:43], v[48:51]
s_add_u32 s72, s71, 46080
buffer_load_dwordx4 v15, s[24:27], s72 offen offset:3072 lds
v_mfma_f32_16x16x32_bf16 v[48:51], v[240:243], a[44:47], v[48:51]
s_nop 0
ds_read_b64_tr_b16 v[136:137], v10 offset:16384
ds_read_b64_tr_b16 v[138:139], v10 offset:18432
v_mfma_f32_16x16x32_bf16 v[64:67], v[240:243], a[60:63], v[64:67]
s_nop 0
ds_read_b64_tr_b16 v[140:141], v11 offset:16384
ds_read_b64_tr_b16 v[142:143], v11 offset:18432
v_mfma_f32_16x16x32_bf16 v[64:67], v[224:227], a[56:59], v[64:67]
v_and_b32 v120, 15, v0
v_lshrrev_b32 v121, 4, v0
v_mfma_f32_16x16x32_bf16 v[64:67], v[208:211], a[52:55], v[64:67]
s_nop 0
ds_read_b64_tr_b16 v[144:145], v8 offset:20480
ds_read_b64_tr_b16 v[146:147], v8 offset:22528
v_mfma_f32_16x16x32_bf16 v[64:67], v[192:195], a[48:51], v[64:67]
s_add_u32 s69, s69, 0x20000
buffer_load_dwordx4 a[112:115], v1, s[44:47], s69 offen sc1
v_mfma_f32_16x16x32_bf16 v[68:71], v[196:199], a[48:51], v[68:71]
s_nop 0
ds_read_b64_tr_b16 v[148:149], v9 offset:20480
ds_read_b64_tr_b16 v[150:151], v9 offset:22528
v_mfma_f32_16x16x32_bf16 v[68:71], v[212:215], a[52:55], v[68:71]
s_nop 0
ds_read_b64_tr_b16 v[152:153], v10 offset:20480
ds_read_b64_tr_b16 v[154:155], v10 offset:22528
v_mfma_f32_16x16x32_bf16 v[68:71], v[228:231], a[56:59], v[68:71]
s_xor_b32 s71, s15, 0x80
v_lshlrev_b32 v121, 2, v121
v_sub_u32 v120, v120, v121
v_mfma_f32_16x16x32_bf16 v[68:71], v[244:247], a[60:63], v[68:71]
s_add_u32 m0, s77, 16384
ds_read_b64_tr_b16 v[156:157], v11 offset:20480
ds_read_b64_tr_b16 v[158:159], v11 offset:22528
v_mfma_f32_16x16x32_bf16 v[52:55], v[244:247], a[44:47], v[52:55]
s_add_u32 s72, s71, 0
buffer_load_dwordx4 v15, s[24:27], s72 offen lds
v_mfma_f32_16x16x32_bf16 v[52:55], v[228:231], a[40:43], v[52:55]
s_nop 0
ds_read_b64_tr_b16 v[160:161], v8 offset:24576
ds_read_b64_tr_b16 v[162:163], v8 offset:26624
v_mfma_f32_16x16x32_bf16 v[52:55], v[212:215], a[36:39], v[52:55]
s_nop 0
ds_read_b64_tr_b16 v[164:165], v9 offset:24576
ds_read_b64_tr_b16 v[166:167], v9 offset:26624
v_mfma_f32_16x16x32_bf16 v[52:55], v[196:199], a[32:35], v[52:55]
v_min_u32 v120, 4, v120
v_lshlrev_b32 v120, 3, v120
v_mfma_f32_16x16x32_bf16 v[56:59], v[200:203], a[32:35], v[56:59]
s_nop 0
ds_read_b64_tr_b16 v[168:169], v10 offset:24576
ds_read_b64_tr_b16 v[170:171], v10 offset:26624
v_mfma_f32_16x16x32_bf16 v[56:59], v[216:219], a[36:39], v[56:59]
s_add_u32 s72, s71, 15360
buffer_load_dwordx4 v15, s[24:27], s72 offen offset:1024 lds
v_mfma_f32_16x16x32_bf16 v[56:59], v[232:235], a[40:43], v[56:59]
buffer_load_dwordx4 a[116:119], v1, s[44:47], s69 offen offset:1024 sc1
v_mfma_f32_16x16x32_bf16 v[56:59], v[248:251], a[44:47], v[56:59]
s_nop 0
ds_read_b64_tr_b16 v[172:173], v11 offset:24576
ds_read_b64_tr_b16 v[174:175], v11 offset:26624
v_mfma_f32_16x16x32_bf16 v[72:75], v[248:251], a[60:63], v[72:75]
s_nop 0
ds_read_b64_tr_b16 v[176:177], v8 offset:28672
ds_read_b64_tr_b16 v[178:179], v8 offset:30720
v_mfma_f32_16x16x32_bf16 v[72:75], v[232:235], a[56:59], v[72:75]
v_mov_b32 v122, 0x3f80
v_mov_b32 v123, 0
v_mfma_f32_16x16x32_bf16 v[72:75], v[216:219], a[52:55], v[72:75]
s_nop 0
ds_read_b64_tr_b16 v[180:181], v9 offset:28672
ds_read_b64_tr_b16 v[182:183], v9 offset:30720
v_mfma_f32_16x16x32_bf16 v[72:75], v[200:203], a[48:51], v[72:75]
s_add_u32 s72, s71, 30720
buffer_load_dwordx4 v15, s[24:27], s72 offen offset:2048 lds
v_mfma_f32_16x16x32_bf16 v[76:79], v[204:207], a[48:51], v[76:79]
s_nop 0
ds_read_b64_tr_b16 v[184:185], v10 offset:28672
ds_read_b64_tr_b16 v[186:187], v10 offset:30720
v_mfma_f32_16x16x32_bf16 v[76:79], v[220:223], a[52:55], v[76:79]
s_nop 0
ds_read_b64_tr_b16 v[188:189], v11 offset:28672
ds_read_b64_tr_b16 v[190:191], v11 offset:30720
v_mfma_f32_16x16x32_bf16 v[76:79], v[236:239], a[56:59], v[76:79]
v_lshlrev_b64 v[122:123], v120, v[122:123]
v_mov_b32 v126, 0
v_mfma_f32_16x16x32_bf16 v[76:79], v[252:255], a[60:63], v[76:79]
buffer_load_dwordx4 a[120:123], v1, s[44:47], s69 offen offset:2048 sc1
v_mfma_f32_16x16x32_bf16 v[60:63], v[252:255], a[44:47], v[60:63]
v_lshlrev_b64 v[122:123], v120, v[122:123]
v_mov_b32 v127, 0
v_mfma_f32_16x16x32_bf16 v[60:63], v[236:239], a[40:43], v[60:63]
s_add_u32 s72, s71, 46080
buffer_load_dwordx4 v15, s[24:27], s72 offen offset:3072 lds
v_mfma_f32_16x16x32_bf16 v[60:63], v[220:223], a[36:39], v[60:63]
s_waitcnt vmcnt(22) lgkmcnt(0)
v_mov_b32 v120, 0
v_mov_b32 v121, 0
v_mfma_f32_16x16x32_bf16 v[60:63], v[204:207], a[32:35], v[60:63]
s_barrier
v_mov_b32 v124, v122
v_mov_b32 v125, v123
v_mfma_f32_16x16x32_bf16 v[80:83], v[128:131], a[32:35], v[80:83]
s_nop 0
ds_read_b64_tr_b16 v[192:193], v8 offset:32768
ds_read_b64_tr_b16 v[194:195], v8 offset:34816
v_mfma_f32_16x16x32_bf16 v[80:83], v[144:147], a[36:39], v[80:83]
s_nop 0
ds_read_b64_tr_b16 v[196:197], v9 offset:32768
ds_read_b64_tr_b16 v[198:199], v9 offset:34816
v_mfma_f32_16x16x32_bf16 v[80:83], v[160:163], a[40:43], v[80:83]
s_nop 0
ds_read_b64_tr_b16 v[200:201], v10 offset:32768
ds_read_b64_tr_b16 v[202:203], v10 offset:34816
v_mfma_f32_16x16x32_bf16 v[80:83], v[176:179], a[44:47], v[80:83]
s_nop 0
ds_read_b64_tr_b16 v[204:205], v11 offset:32768
ds_read_b64_tr_b16 v[206:207], v11 offset:34816
v_mfma_f32_16x16x32_bf16 v[96:99], v[176:179], a[60:63], v[96:99]
v_mfma_f32_16x16x32_bf16 v[96:99], v[160:163], a[56:59], v[96:99]
s_xor_b32 s71, s15, 0x100
buffer_load_dwordx4 a[124:127], v1, s[44:47], s69 offen offset:3072 sc1
v_mfma_f32_16x16x32_bf16 v[96:99], v[144:147], a[52:55], v[96:99]
s_add_u32 m0, s77, 32768
ds_read_b64_tr_b16 v[208:209], v8 offset:36864
ds_read_b64_tr_b16 v[210:211], v8 offset:38912
v_mfma_f32_16x16x32_bf16 v[96:99], v[128:131], a[48:51], v[96:99]
s_add_u32 s72, s71, 0
buffer_load_dwordx4 v15, s[24:27], s72 offen lds
v_mfma_f32_16x16x32_bf16 v[100:103], v[132:135], a[48:51], v[100:103]
s_nop 0
ds_read_b64_tr_b16 v[212:213], v9 offset:36864
ds_read_b64_tr_b16 v[214:215], v9 offset:38912
v_mfma_f32_16x16x32_bf16 v[100:103], v[148:151], a[52:55], v[100:103]
s_nop 0
ds_read_b64_tr_b16 v[216:217], v10 offset:36864
ds_read_b64_tr_b16 v[218:219], v10 offset:38912
v_mfma_f32_16x16x32_bf16 v[100:103], v[164:167], a[56:59], v[100:103]
s_nop 0
ds_read_b64_tr_b16 v[220:221], v11 offset:36864
ds_read_b64_tr_b16 v[222:223], v11 offset:38912
v_mfma_f32_16x16x32_bf16 v[100:103], v[180:183], a[60:63], v[100:103]
v_mfma_f32_16x16x32_bf16 v[84:87], v[180:183], a[44:47], v[84:87]
s_nop 0
ds_read_b64_tr_b16 v[224:225], v8 offset:40960
ds_read_b64_tr_b16 v[226:227], v8 offset:43008
v_mfma_f32_16x16x32_bf16 v[84:87], v[164:167], a[40:43], v[84:87]
s_add_u32 s72, s71, 15360
buffer_load_dwordx4 v15, s[24:27], s72 offen offset:1024 lds
v_mfma_f32_16x16x32_bf16 v[84:87], v[148:151], a[36:39], v[84:87]
s_nop 0
ds_read_b64_tr_b16 v[228:229], v9 offset:40960
ds_read_b64_tr_b16 v[230:231], v9 offset:43008
v_mfma_f32_16x16x32_bf16 v[84:87], v[132:135], a[32:35], v[84:87]
s_waitcnt vmcnt(22)
v_cmp_gt_u32 vcc, 2, v3
s_cbranch_vccnz Lspin106
Lback107:
s_lshr_b32 s69, s12, 18
s_lshl_b32 s69, s69, 12
s_add_u32 s69, s69, s95
s_xor_b32 s69, s69, 0x10000
buffer_load_dwordx4 a[128:131], v1, s[44:47], s69 offen sc1
v_mfma_f32_16x16x32_bf16 v[88:91], v[136:139], a[32:35], v[88:91]
s_nop 0
ds_read_b64_tr_b16 v[232:233], v10 offset:40960
ds_read_b64_tr_b16 v[234:235], v10 offset:43008
v_mfma_f32_16x16x32_bf16 v[88:91], v[152:155], a[36:39], v[88:91]
s_nop 0
ds_read_b64_tr_b16 v[236:237], v11 offset:40960
ds_read_b64_tr_b16 v[238:239], v11 offset:43008
v_mfma_f32_16x16x32_bf16 v[88:91], v[168:171], a[40:43], v[88:91]
v_mfma_f32_16x16x32_bf16 v[88:91], v[184:187], a[44:47], v[88:91]
s_add_u32 s72, s71, 30720
buffer_load_dwordx4 v15, s[24:27], s72 offen offset:2048 lds
v_mfma_f32_16x16x32_bf16 v[104:107], v[184:187], a[60:63], v[104:107]
s_nop 0
ds_read_b64_tr_b16 v[240:241], v8 offset:45056
ds_read_b64_tr_b16 v[242:243], v8 offset:47104
v_mfma_f32_16x16x32_bf16 v[104:107], v[168:171], a[56:59], v[104:107]
s_nop 0
ds_read_b64_tr_b16 v[244:245], v9 offset:45056
ds_read_b64_tr_b16 v[246:247], v9 offset:47104
v_mfma_f32_16x16x32_bf16 v[104:107], v[152:155], a[52:55], v[104:107]
s_nop 0
ds_read_b64_tr_b16 v[248:249], v10 offset:45056
ds_read_b64_tr_b16 v[250:251], v10 offset:47104
v_mfma_f32_16x16x32_bf16 v[104:107], v[136:139], a[48:51], v[104:107]
s_nop 0
ds_read_b64_tr_b16 v[252:253], v11 offset:45056
ds_read_b64_tr_b16 v[254:255], v11 offset:47104
v_mfma_f32_16x16x32_bf16 v[108:111], v[140:143], a[48:51], v[108:111]
v_mfma_f32_16x16x32_bf16 v[108:111], v[156:159], a[52:55], v[108:111]
s_add_u32 s72, s71, 46080
buffer_load_dwordx4 v15, s[24:27], s72 offen offset:3072 lds
v_mfma_f32_16x16x32_bf16 v[108:111], v[172:175], a[56:59], v[108:111]
buffer_load_dwordx4 a[132:135], v1, s[44:47], s69 offen offset:1024 sc1
v_mfma_f32_16x16x32_bf16 v[108:111], v[188:191], a[60:63], v[108:111]
v_mfma_f32_16x16x32_bf16 v[92:95], v[188:191], a[44:47], v[92:95]
v_mfma_f32_16x16x32_bf16 v[92:95], v[172:175], a[40:43], v[92:95]
v_mfma_f32_16x16x32_bf16 v[92:95], v[156:159], a[36:39], v[92:95]
s_waitcnt vmcnt(22) lgkmcnt(0)
v_mfma_f32_16x16x32_bf16 v[92:95], v[140:143], a[32:35], v[92:95]
s_barrier
v_mfma_f32_16x16x32_bf16 v[16:19], v[192:195], a[64:67], v[16:19]
s_nop 0
ds_read_b64_tr_b16 v[128:129], v8 offset:49152
ds_read_b64_tr_b16 v[130:131], v8 offset:51200
v_mfma_f32_16x16x32_bf16 v[16:19], v[208:211], a[68:71], v[16:19]
s_xor_b32 s71, s15, 0x180
ds_read_b64_tr_b16 v[132:133], v9 offset:49152
ds_read_b64_tr_b16 v[134:135], v9 offset:51200
v_mfma_f32_16x16x32_bf16 v[16:19], v[224:227], a[72:75], v[16:19]
s_add_u32 m0, s77, 49152
ds_read_b64_tr_b16 v[136:137], v10 offset:49152
ds_read_b64_tr_b16 v[138:139], v10 offset:51200
v_mfma_f32_16x16x32_bf16 v[16:19], v[240:243], a[76:79], v[16:19]
s_add_u32 s72, s71, 0
buffer_load_dwordx4 v15, s[24:27], s72 offen lds
v_mfma_f32_16x16x32_bf16 v[32:35], v[240:243], a[92:95], v[32:35]
buffer_load_dwordx4 a[136:139], v1, s[44:47], s69 offen offset:2048 sc1
v_mfma_f32_16x16x32_bf16 v[32:35], v[224:227], a[88:91], v[32:35]
s_nop 0
ds_read_b64_tr_b16 v[140:141], v11 offset:49152
ds_read_b64_tr_b16 v[142:143], v11 offset:51200
v_mfma_f32_16x16x32_bf16 v[32:35], v[208:211], a[84:87], v[32:35]
v_mfma_f32_16x16x32_bf16 v[32:35], v[192:195], a[80:83], v[32:35]
s_nop 0
ds_read_b64_tr_b16 v[144:145], v8 offset:53248
ds_read_b64_tr_b16 v[146:147], v8 offset:55296
v_mfma_f32_16x16x32_bf16 v[36:39], v[196:199], a[80:83], v[36:39]
s_add_u32 s72, s71, 15360
buffer_load_dwordx4 v15, s[24:27], s72 offen offset:1024 lds
v_mfma_f32_16x16x32_bf16 v[36:39], v[212:215], a[84:87], v[36:39]
s_nop 0
ds_read_b64_tr_b16 v[148:149], v9 offset:53248
ds_read_b64_tr_b16 v[150:151], v9 offset:55296
v_mfma_f32_16x16x32_bf16 v[36:39], v[228:231], a[88:91], v[36:39]
s_nop 0
ds_read_b64_tr_b16 v[152:153], v10 offset:53248
ds_read_b64_tr_b16 v[154:155], v10 offset:55296
v_mfma_f32_16x16x32_bf16 v[36:39], v[244:247], a[92:95], v[36:39]
s_nop 0
ds_read_b64_tr_b16 v[156:157], v11 offset:53248
ds_read_b64_tr_b16 v[158:159], v11 offset:55296
v_mfma_f32_16x16x32_bf16 v[20:23], v[244:247], a[76:79], v[20:23]
v_mfma_f32_16x16x32_bf16 v[20:23], v[228:231], a[72:75], v[20:23]
buffer_load_dwordx4 a[140:143], v1, s[44:47], s69 offen offset:3072 sc1
v_mfma_f32_16x16x32_bf16 v[20:23], v[212:215], a[68:71], v[20:23]
s_add_u32 s72, s71, 30720
buffer_load_dwordx4 v15, s[24:27], s72 offen offset:2048 lds
v_mfma_f32_16x16x32_bf16 v[20:23], v[196:199], a[64:67], v[20:23]
s_nop 0
ds_read_b64_tr_b16 v[160:161], v8 offset:57344
ds_read_b64_tr_b16 v[162:163], v8 offset:59392
v_mfma_f32_16x16x32_bf16 v[24:27], v[200:203], a[64:67], v[24:27]
s_nop 0
ds_read_b64_tr_b16 v[164:165], v9 offset:57344
ds_read_b64_tr_b16 v[166:167], v9 offset:59392
v_mfma_f32_16x16x32_bf16 v[24:27], v[216:219], a[68:71], v[24:27]
s_nop 0
ds_read_b64_tr_b16 v[168:169], v10 offset:57344
ds_read_b64_tr_b16 v[170:171], v10 offset:59392
v_mfma_f32_16x16x32_bf16 v[24:27], v[232:235], a[72:75], v[24:27]
s_nop 0
ds_read_b64_tr_b16 v[172:173], v11 offset:57344
ds_read_b64_tr_b16 v[174:175], v11 offset:59392
v_mfma_f32_16x16x32_bf16 v[24:27], v[248:251], a[76:79], v[24:27]
v_mfma_f32_16x16x32_bf16 v[40:43], v[248:251], a[92:95], v[40:43]
s_add_u32 s72, s71, 46080
buffer_load_dwordx4 v15, s[24:27], s72 offen offset:3072 lds
v_mfma_f32_16x16x32_bf16 v[40:43], v[232:235], a[88:91], v[40:43]
s_nop 0
ds_read_b64_tr_b16 v[176:177], v8 offset:61440
ds_read_b64_tr_b16 v[178:179], v8 offset:63488
v_mfma_f32_16x16x32_bf16 v[40:43], v[216:219], a[84:87], v[40:43]
s_nop 0
ds_read_b64_tr_b16 v[180:181], v9 offset:61440
ds_read_b64_tr_b16 v[182:183], v9 offset:63488
v_mfma_f32_16x16x32_bf16 v[40:43], v[200:203], a[80:83], v[40:43]
s_add_u32 s69, s69, 0x20000
buffer_load_dwordx4 a[144:147], v1, s[44:47], s69 offen sc1
v_mfma_f32_16x16x32_bf16 v[44:47], v[204:207], a[80:83], v[44:47]
s_nop 0
ds_read_b64_tr_b16 v[184:185], v10 offset:61440
ds_read_b64_tr_b16 v[186:187], v10 offset:63488
v_mfma_f32_16x16x32_bf16 v[44:47], v[220:223], a[84:87], v[44:47]
s_nop 0
ds_read_b64_tr_b16 v[188:189], v11 offset:61440
ds_read_b64_tr_b16 v[190:191], v11 offset:63488
v_mfma_f32_16x16x32_bf16 v[44:47], v[236:239], a[88:91], v[44:47]
v_mfma_f32_16x16x32_bf16 v[44:47], v[252:255], a[92:95], v[44:47]
s_xor_b32 s71, s12, 0x400080
v_mfma_f32_16x16x32_bf16 v[28:31], v[252:255], a[76:79], v[28:31]
s_add_u32 m0, s85, 0
v_xor_b32 v8, 0x10000, v8
v_mfma_f32_16x16x32_bf16 v[28:31], v[236:239], a[72:75], v[28:31]
s_add_u32 s72, s71, 0
v_xor_b32 v9, 0x10000, v9
v_mfma_f32_16x16x32_bf16 v[28:31], v[220:223], a[68:71], v[28:31]
s_waitcnt vmcnt(21) lgkmcnt(0)
buffer_load_dwordx4 v15, s[24:27], s72 offen lds
v_xor_b32 v10, 0x10000, v10
v_mfma_f32_16x16x32_bf16 v[28:31], v[204:207], a[64:67], v[28:31]
s_barrier
v_xor_b32 v11, 0x10000, v11
v_mfma_f32_16x16x32_bf16 v[48:51], v[128:131], a[64:67], v[48:51]
s_nop 0
ds_read_b64_tr_b16 v[192:193], v8 offset:0
ds_read_b64_tr_b16 v[194:195], v8 offset:2048
v_mfma_f32_16x16x32_bf16 v[48:51], v[144:147], a[68:71], v[48:51]
buffer_load_dwordx4 a[148:151], v1, s[44:47], s69 offen offset:1024 sc1
v_mfma_f32_16x16x32_bf16 v[48:51], v[160:163], a[72:75], v[48:51]
s_nop 0
ds_read_b64_tr_b16 v[196:197], v9 offset:0
ds_read_b64_tr_b16 v[198:199], v9 offset:2048
v_mfma_f32_16x16x32_bf16 v[48:51], v[176:179], a[76:79], v[48:51]
s_add_u32 s72, s71, 15360
buffer_load_dwordx4 v15, s[24:27], s72 offen offset:1024 lds
v_mfma_f32_16x16x32_bf16 v[64:67], v[176:179], a[92:95], v[64:67]
s_nop 0
ds_read_b64_tr_b16 v[200:201], v10 offset:0
ds_read_b64_tr_b16 v[202:203], v10 offset:2048
v_mfma_f32_16x16x32_bf16 v[64:67], v[160:163], a[88:91], v[64:67]
s_nop 0
ds_read_b64_tr_b16 v[204:205], v11 offset:0
ds_read_b64_tr_b16 v[206:207], v11 offset:2048
v_mfma_f32_16x16x32_bf16 v[64:67], v[144:147], a[84:87], v[64:67]
v_mfma_f32_16x16x32_bf16 v[64:67], v[128:131], a[80:83], v[64:67]
s_nop 0
ds_read_b64_tr_b16 v[208:209], v8 offset:4096
ds_read_b64_tr_b16 v[210:211], v8 offset:6144
v_mfma_f32_16x16x32_bf16 v[68:71], v[132:135], a[80:83], v[68:71]
s_nop 0
ds_read_b64_tr_b16 v[212:213], v9 offset:4096
ds_read_b64_tr_b16 v[214:215], v9 offset:6144
v_mfma_f32_16x16x32_bf16 v[68:71], v[148:151], a[84:87], v[68:71]
s_add_u32 s72, s71, 30720
buffer_load_dwordx4 v15, s[24:27], s72 offen offset:2048 lds
v_mfma_f32_16x16x32_bf16 v[68:71], v[164:167], a[88:91], v[68:71]
s_nop 0
ds_read_b64_tr_b16 v[216:217], v10 offset:4096
ds_read_b64_tr_b16 v[218:219], v10 offset:6144
v_mfma_f32_16x16x32_bf16 v[68:71], v[180:183], a[92:95], v[68:71]
buffer_load_dwordx4 a[152:155], v1, s[44:47], s69 offen offset:2048 sc1
v_mfma_f32_16x16x32_bf16 v[52:55], v[180:183], a[76:79], v[52:55]
s_nop 0
ds_read_b64_tr_b16 v[220:221], v11 offset:4096
ds_read_b64_tr_b16 v[222:223], v11 offset:6144
v_mfma_f32_16x16x32_bf16 v[52:55], v[164:167], a[72:75], v[52:55]
v_mfma_f32_16x16x32_bf16 v[52:55], v[148:151], a[68:71], v[52:55]
s_nop 0
ds_read_b64_tr_b16 v[224:225], v8 offset:8192
ds_read_b64_tr_b16 v[226:227], v8 offset:10240
v_mfma_f32_16x16x32_bf16 v[52:55], v[132:135], a[64:67], v[52:55]
s_add_u32 s72, s71, 46080
buffer_load_dwordx4 v15, s[24:27], s72 offen offset:3072 lds
v_mfma_f32_16x16x32_bf16 v[56:59], v[136:139], a[64:67], v[56:59]
s_nop 0
ds_read_b64_tr_b16 v[228:229], v9 offset:8192
ds_read_b64_tr_b16 v[230:231], v9 offset:10240
v_mfma_f32_16x16x32_bf16 v[56:59], v[152:155], a[68:71], v[56:59]
s_nop 0
ds_read_b64_tr_b16 v[232:233], v10 offset:8192
ds_read_b64_tr_b16 v[234:235], v10 offset:10240
v_mfma_f32_16x16x32_bf16 v[56:59], v[168:171], a[72:75], v[56:59]
s_nop 0
ds_read_b64_tr_b16 v[236:237], v11 offset:8192
ds_read_b64_tr_b16 v[238:239], v11 offset:10240
v_mfma_f32_16x16x32_bf16 v[56:59], v[184:187], a[76:79], v[56:59]
v_mfma_f32_16x16x32_bf16 v[72:75], v[184:187], a[92:95], v[72:75]
s_nop 0
ds_read_b64_tr_b16 v[240:241], v8 offset:12288
ds_read_b64_tr_b16 v[242:243], v8 offset:14336
v_mfma_f32_16x16x32_bf16 v[72:75], v[168:171], a[88:91], v[72:75]
buffer_load_dwordx4 a[156:159], v1, s[44:47], s69 offen offset:3072 sc1
v_mfma_f32_16x16x32_bf16 v[72:75], v[152:155], a[84:87], v[72:75]
s_lshr_b32 s69, s13, 18
ds_read_b64_tr_b16 v[244:245], v9 offset:12288
ds_read_b64_tr_b16 v[246:247], v9 offset:14336
v_mfma_f32_16x16x32_bf16 v[72:75], v[136:139], a[80:83], v[72:75]
s_xor_b32 s71, s12, 0x400100
ds_read_b64_tr_b16 v[248:249], v10 offset:12288
ds_read_b64_tr_b16 v[250:251], v10 offset:14336
v_mfma_f32_16x16x32_bf16 v[76:79], v[140:143], a[80:83], v[76:79]
s_add_u32 m0, s85, 16384
ds_read_b64_tr_b16 v[252:253], v11 offset:12288
ds_read_b64_tr_b16 v[254:255], v11 offset:14336
v_mfma_f32_16x16x32_bf16 v[76:79], v[156:159], a[84:87], v[76:79]
s_add_u32 s72, s71, 0
buffer_load_dwordx4 v15, s[24:27], s72 offen lds
v_mfma_f32_16x16x32_bf16 v[76:79], v[172:175], a[88:91], v[76:79]
s_lshl_b32 s69, s69, 12
v_mfma_f32_16x16x32_bf16 v[76:79], v[188:191], a[92:95], v[76:79]
s_add_u32 s69, s69, s95
v_mfma_f32_16x16x32_bf16 v[60:63], v[188:191], a[76:79], v[60:63]
s_xor_b32 s69, s69, 0x10000
v_mfma_f32_16x16x32_bf16 v[60:63], v[172:175], a[72:75], v[60:63]
s_add_u32 s72, s71, 15360
v_mfma_f32_16x16x32_bf16 v[60:63], v[156:159], a[68:71], v[60:63]
s_waitcnt vmcnt(22) lgkmcnt(0)
buffer_load_dwordx4 a[160:163], v1, s[44:47], s69 offen sc1
v_mfma_f32_16x16x32_bf16 v[60:63], v[140:143], a[64:67], v[60:63]
s_barrier
buffer_load_dwordx4 v15, s[24:27], s72 offen offset:1024 lds
v_mfma_f32_16x16x32_bf16 v[80:83], v[192:195], a[64:67], v[80:83]
s_and_b32 s79, s91, 0xffffcfff
v_lshlrev_b32 v13, 2, v2
buffer_load_dword v14, v13, s[44:47], s79 offen sc1
v_mfma_f32_16x16x32_bf16 v[80:83], v[208:211], a[68:71], v[80:83]
s_nop 0
ds_read_b64_tr_b16 v[128:129], v8 offset:16384
ds_read_b64_tr_b16 v[130:131], v8 offset:18432
v_mfma_f32_16x16x32_bf16 v[80:83], v[224:227], a[72:75], v[80:83]
s_nop 0
ds_read_b64_tr_b16 v[132:133], v9 offset:16384
ds_read_b64_tr_b16 v[134:135], v9 offset:18432
v_mfma_f32_16x16x32_bf16 v[80:83], v[240:243], a[76:79], v[80:83]
s_nop 0
ds_read_b64_tr_b16 v[136:137], v10 offset:16384
ds_read_b64_tr_b16 v[138:139], v10 offset:18432
v_mfma_f32_16x16x32_bf16 v[96:99], v[240:243], a[92:95], v[96:99]
s_nop 0
ds_read_b64_tr_b16 v[140:141], v11 offset:16384
ds_read_b64_tr_b16 v[142:143], v11 offset:18432
v_mfma_f32_16x16x32_bf16 v[96:99], v[224:227], a[88:91], v[96:99]
s_add_u32 s72, s71, 30720
buffer_load_dwordx4 v15, s[24:27], s72 offen offset:2048 lds
v_mfma_f32_16x16x32_bf16 v[96:99], v[208:211], a[84:87], v[96:99]
v_mfma_f32_16x16x32_bf16 v[96:99], v[192:195], a[80:83], v[96:99]
s_nop 0
ds_read_b64_tr_b16 v[144:145], v8 offset:20480
ds_read_b64_tr_b16 v[146:147], v8 offset:22528
v_mfma_f32_16x16x32_bf16 v[100:103], v[196:199], a[80:83], v[100:103]
buffer_load_dwordx4 a[164:167], v1, s[44:47], s69 offen offset:1024 sc1
v_mfma_f32_16x16x32_bf16 v[100:103], v[212:215], a[84:87], v[100:103]
s_nop 0
ds_read_b64_tr_b16 v[148:149], v9 offset:20480
ds_read_b64_tr_b16 v[150:151], v9 offset:22528
v_mfma_f32_16x16x32_bf16 v[100:103], v[228:231], a[88:91], v[100:103]
s_nop 0
ds_read_b64_tr_b16 v[152:153], v10 offset:20480
ds_read_b64_tr_b16 v[154:155], v10 offset:22528
v_mfma_f32_16x16x32_bf16 v[100:103], v[244:247], a[92:95], v[100:103]
s_add_u32 s72, s71, 46080
buffer_load_dwordx4 v15, s[24:27], s72 offen offset:3072 lds
v_mfma_f32_16x16x32_bf16 v[84:87], v[244:247], a[76:79], v[84:87]
s_nop 0
ds_read_b64_tr_b16 v[156:157], v11 offset:20480
ds_read_b64_tr_b16 v[158:159], v11 offset:22528
v_mfma_f32_16x16x32_bf16 v[84:87], v[228:231], a[72:75], v[84:87]
Lstube1:
s_cbranch_execz Lrete
v_mfma_f32_16x16x32_bf16 v[84:87], v[212:215], a[68:71], v[84:87]
s_nop 0
ds_read_b64_tr_b16 v[160:161], v8 offset:24576
ds_read_b64_tr_b16 v[162:163], v8 offset:26624
v_mfma_f32_16x16x32_bf16 v[84:87], v[196:199], a[64:67], v[84:87]
s_nop 0
ds_read_b64_tr_b16 v[164:165], v9 offset:24576
ds_read_b64_tr_b16 v[166:167], v9 offset:26624
v_mfma_f32_16x16x32_bf16 v[88:91], v[200:203], a[64:67], v[88:91]
s_nop 0
ds_read_b64_tr_b16 v[168:169], v10 offset:24576
ds_read_b64_tr_b16 v[170:171], v10 offset:26624
v_mfma_f32_16x16x32_bf16 v[88:91], v[216:219], a[68:71], v[88:91]
s_nop 0
ds_read_b64_tr_b16 v[172:173], v11 offset:24576
ds_read_b64_tr_b16 v[174:175], v11 offset:26624
v_mfma_f32_16x16x32_bf16 v[88:91], v[232:235], a[72:75], v[88:91]
buffer_load_dwordx4 a[168:171], v1, s[44:47], s69 offen offset:2048 sc1
v_mfma_f32_16x16x32_bf16 v[88:91], v[248:251], a[76:79], v[88:91]
s_xor_b32 s71, s12, 0x400180
v_mfma_f32_16x16x32_bf16 v[104:107], v[248:251], a[92:95], v[104:107]
s_add_u32 m0, s85, 32768
ds_read_b64_tr_b16 v[176:177], v8 offset:28672
ds_read_b64_tr_b16 v[178:179], v8 offset:30720
v_mfma_f32_16x16x32_bf16 v[104:107], v[232:235], a[88:91], v[104:107]
s_add_u32 s72, s71, 0
buffer_load_dwordx4 v15, s[24:27], s72 offen lds
v_mfma_f32_16x16x32_bf16 v[104:107], v[216:219], a[84:87], v[104:107]
s_nop 0
ds_read_b64_tr_b16 v[180:181], v9 offset:28672
ds_read_b64_tr_b16 v[182:183], v9 offset:30720
v_mfma_f32_16x16x32_bf16 v[104:107], v[200:203], a[80:83], v[104:107]
s_nop 0
ds_read_b64_tr_b16 v[184:185], v10 offset:28672
ds_read_b64_tr_b16 v[186:187], v10 offset:30720
v_mfma_f32_16x16x32_bf16 v[108:111], v[204:207], a[80:83], v[108:111]
s_nop 0
ds_read_b64_tr_b16 v[188:189], v11 offset:28672
ds_read_b64_tr_b16 v[190:191], v11 offset:30720
v_mfma_f32_16x16x32_bf16 v[108:111], v[220:223], a[84:87], v[108:111]
v_mfma_f32_16x16x32_bf16 v[108:111], v[236:239], a[88:91], v[108:111]
s_add_u32 s72, s71, 15360
buffer_load_dwordx4 v15, s[24:27], s72 offen offset:1024 lds
v_mfma_f32_16x16x32_bf16 v[108:111], v[252:255], a[92:95], v[108:111]
v_mfma_f32_16x16x32_bf16 v[92:95], v[252:255], a[76:79], v[92:95]
buffer_load_dwordx4 a[172:175], v1, s[44:47], s69 offen offset:3072 sc1
v_mfma_f32_16x16x32_bf16 v[92:95], v[236:239], a[72:75], v[92:95]
v_mfma_f32_16x16x32_bf16 v[92:95], v[220:223], a[68:71], v[92:95]
s_waitcnt vmcnt(26) lgkmcnt(0)
v_mfma_f32_16x16x32_bf16 v[92:95], v[204:207], a[64:67], v[92:95]
s_barrier
v_mfma_f32_16x16x32_bf16 v[16:19], v[128:131], a[96:99], v[16:19]
s_add_u32 s72, s71, 30720
buffer_load_dwordx4 v15, s[24:27], s72 offen offset:2048 lds
v_mfma_f32_16x16x32_bf16 v[16:19], v[144:147], a[100:103], v[16:19]
s_nop 0
ds_read_b64_tr_b16 v[192:193], v8 offset:32768
ds_read_b64_tr_b16 v[194:195], v8 offset:34816
v_mfma_f32_16x16x32_bf16 v[16:19], v[160:163], a[104:107], v[16:19]
s_nop 0
ds_read_b64_tr_b16 v[196:197], v9 offset:32768
ds_read_b64_tr_b16 v[198:199], v9 offset:34816
v_mfma_f32_16x16x32_bf16 v[16:19], v[176:179], a[108:111], v[16:19]
s_nop 0
ds_read_b64_tr_b16 v[200:201], v10 offset:32768
ds_read_b64_tr_b16 v[202:203], v10 offset:34816
v_mfma_f32_16x16x32_bf16 v[32:35], v[176:179], a[124:127], v[32:35]
s_nop 0
ds_read_b64_tr_b16 v[204:205], v11 offset:32768
ds_read_b64_tr_b16 v[206:207], v11 offset:34816
v_mfma_f32_16x16x32_bf16 v[32:35], v[160:163], a[120:123], v[32:35]
v_mfma_f32_16x16x32_bf16 v[32:35], v[144:147], a[116:119], v[32:35]
s_add_u32 s72, s71, 46080
buffer_load_dwordx4 v15, s[24:27], s72 offen offset:3072 lds
v_mfma_f32_16x16x32_bf16 v[32:35], v[128:131], a[112:115], v[32:35]
s_add_u32 s69, s69, 0x20000
buffer_load_dwordx4 a[176:179], v1, s[44:47], s69 offen sc1
v_mfma_f32_16x16x32_bf16 v[36:39], v[132:135], a[112:115], v[36:39]
s_nop 0
ds_read_b64_tr_b16 v[208:209], v8 offset:36864
ds_read_b64_tr_b16 v[210:211], v8 offset:38912
v_mfma_f32_16x16x32_bf16 v[36:39], v[148:151], a[116:119], v[36:39]
s_nop 0
ds_read_b64_tr_b16 v[212:213], v9 offset:36864
ds_read_b64_tr_b16 v[214:215], v9 offset:38912
v_mfma_f32_16x16x32_bf16 v[36:39], v[164:167], a[120:123], v[36:39]
s_nop 0
ds_read_b64_tr_b16 v[216:217], v10 offset:36864
ds_read_b64_tr_b16 v[218:219], v10 offset:38912
v_mfma_f32_16x16x32_bf16 v[36:39], v[180:183], a[124:127], v[36:39]
s_nop 0
ds_read_b64_tr_b16 v[220:221], v11 offset:36864
ds_read_b64_tr_b16 v[222:223], v11 offset:38912
v_mfma_f32_16x16x32_bf16 v[20:23], v[180:183], a[108:111], v[20:23]
v_mfma_f32_16x16x32_bf16 v[20:23], v[164:167], a[104:107], v[20:23]
s_nop 0
ds_read_b64_tr_b16 v[224:225], v8 offset:40960
ds_read_b64_tr_b16 v[226:227], v8 offset:43008
v_mfma_f32_16x16x32_bf16 v[20:23], v[148:151], a[100:103], v[20:23]
s_xor_b32 s71, s13, 0x400080
ds_read_b64_tr_b16 v[228:229], v9 offset:40960
ds_read_b64_tr_b16 v[230:231], v9 offset:43008
v_mfma_f32_16x16x32_bf16 v[20:23], v[132:135], a[96:99], v[20:23]
s_add_u32 m0, s85, 49152
ds_read_b64_tr_b16 v[232:233], v10 offset:40960
ds_read_b64_tr_b16 v[234:235], v10 offset:43008
v_mfma_f32_16x16x32_bf16 v[24:27], v[136:139], a[96:99], v[24:27]
s_add_u32 s72, s71, 0
buffer_load_dwordx4 v15, s[24:27], s72 offen lds
v_mfma_f32_16x16x32_bf16 v[24:27], v[152:155], a[100:103], v[24:27]
buffer_load_dwordx4 a[180:183], v1, s[44:47], s69 offen offset:1024 sc1
v_mfma_f32_16x16x32_bf16 v[24:27], v[168:171], a[104:107], v[24:27]
s_nop 0
ds_read_b64_tr_b16 v[236:237], v11 offset:40960
ds_read_b64_tr_b16 v[238:239], v11 offset:43008
v_mfma_f32_16x16x32_bf16 v[24:27], v[184:187], a[108:111], v[24:27]
v_mfma_f32_16x16x32_bf16 v[40:43], v[184:187], a[124:127], v[40:43]
s_nop 0
ds_read_b64_tr_b16 v[240:241], v8 offset:45056
ds_read_b64_tr_b16 v[242:243], v8 offset:47104
v_mfma_f32_16x16x32_bf16 v[40:43], v[168:171], a[120:123], v[40:43]
s_nop 0
ds_read_b64_tr_b16 v[244:245], v9 offset:45056
ds_read_b64_tr_b16 v[246:247], v9 offset:47104
v_mfma_f32_16x16x32_bf16 v[40:43], v[152:155], a[116:119], v[40:43]
s_add_u32 s72, s71, 15360
buffer_load_dwordx4 v15, s[24:27], s72 offen offset:1024 lds
v_mfma_f32_16x16x32_bf16 v[40:43], v[136:139], a[112:115], v[40:43]
s_nop 0
ds_read_b64_tr_b16 v[248:249], v10 offset:45056
ds_read_b64_tr_b16 v[250:251], v10 offset:47104
v_mfma_f32_16x16x32_bf16 v[44:47], v[140:143], a[112:115], v[44:47]
s_nop 0
ds_read_b64_tr_b16 v[252:253], v11 offset:45056
ds_read_b64_tr_b16 v[254:255], v11 offset:47104
v_mfma_f32_16x16x32_bf16 v[44:47], v[156:159], a[116:119], v[44:47]
v_mfma_f32_16x16x32_bf16 v[44:47], v[172:175], a[120:123], v[44:47]
buffer_load_dwordx4 a[184:187], v1, s[44:47], s69 offen offset:2048 sc1
v_mfma_f32_16x16x32_bf16 v[44:47], v[188:191], a[124:127], v[44:47]
v_mfma_f32_16x16x32_bf16 v[28:31], v[188:191], a[108:111], v[28:31]
s_add_u32 s72, s71, 30720
buffer_load_dwordx4 v15, s[24:27], s72 offen offset:2048 lds
v_mfma_f32_16x16x32_bf16 v[28:31], v[172:175], a[104:107], v[28:31]
v_mfma_f32_16x16x32_bf16 v[28:31], v[156:159], a[100:103], v[28:31]
s_waitcnt vmcnt(27) lgkmcnt(0)
v_mfma_f32_16x16x32_bf16 v[28:31], v[140:143], a[96:99], v[28:31]
s_barrier
v_mfma_f32_16x16x32_bf16 v[48:51], v[192:195], a[96:99], v[48:51]
s_nop 0
ds_read_b64_tr_b16 v[128:129], v8 offset:49152
ds_read_b64_tr_b16 v[130:131], v8 offset:51200
v_mfma_f32_16x16x32_bf16 v[48:51], v[208:211], a[100:103], v[48:51]
s_nop 0
ds_read_b64_tr_b16 v[132:133], v9 offset:49152
ds_read_b64_tr_b16 v[134:135], v9 offset:51200
v_mfma_f32_16x16x32_bf16 v[48:51], v[224:227], a[104:107], v[48:51]
s_add_u32 s72, s71, 46080
buffer_load_dwordx4 v15, s[24:27], s72 offen offset:3072 lds
v_mfma_f32_16x16x32_bf16 v[48:51], v[240:243], a[108:111], v[48:51]
s_nop 0
ds_read_b64_tr_b16 v[136:137], v10 offset:49152
ds_read_b64_tr_b16 v[138:139], v10 offset:51200
v_mfma_f32_16x16x32_bf16 v[64:67], v[240:243], a[124:127], v[64:67]
buffer_load_dwordx4 a[188:191], v1, s[44:47], s69 offen offset:3072 sc1
v_mfma_f32_16x16x32_bf16 v[64:67], v[224:227], a[120:123], v[64:67]
s_nop 0
ds_read_b64_tr_b16 v[140:141], v11 offset:49152
ds_read_b64_tr_b16 v[142:143], v11 offset:51200
v_mfma_f32_16x16x32_bf16 v[64:67], v[208:211], a[116:119], v[64:67]
s_nop 0
ds_read_b64_tr_b16 v[144:145], v8 offset:53248
ds_read_b64_tr_b16 v[146:147], v8 offset:55296
v_mfma_f32_16x16x32_bf16 v[64:67], v[192:195], a[112:115], v[64:67]
s_nop 0
ds_read_b64_tr_b16 v[148:149], v9 offset:53248
ds_read_b64_tr_b16 v[150:151], v9 offset:55296
v_mfma_f32_16x16x32_bf16 v[68:71], v[196:199], a[112:115], v[68:71]
s_lshr_b32 s69, s14, 18
v_mfma_f32_16x16x32_bf16 v[68:71], v[212:215], a[116:119], v[68:71]
s_lshl_b32 s69, s69, 12
ds_read_b64_tr_b16 v[152:153], v10 offset:53248
ds_read_b64_tr_b16 v[154:155], v10 offset:55296
v_mfma_f32_16x16x32_bf16 v[68:71], v[228:231], a[120:123], v[68:71]
s_xor_b32 s71, s14, 0x400080
ds_read_b64_tr_b16 v[156:157], v11 offset:53248
ds_read_b64_tr_b16 v[158:159], v11 offset:55296
v_mfma_f32_16x16x32_bf16 v[68:71], v[244:247], a[124:127], v[68:71]
s_add_u32 m0, s77, 0
ds_read_b64_tr_b16 v[160:161], v8 offset:57344
ds_read_b64_tr_b16 v[162:163], v8 offset:59392
v_mfma_f32_16x16x32_bf16 v[52:55], v[244:247], a[108:111], v[52:55]
s_add_u32 s72, s71, 0
buffer_load_dwordx4 v15, s[24:27], s72 offen lds
v_mfma_f32_16x16x32_bf16 v[52:55], v[228:231], a[104:107], v[52:55]
s_add_u32 s69, s69, s95
ds_read_b64_tr_b16 v[164:165], v9 offset:57344
ds_read_b64_tr_b16 v[166:167], v9 offset:59392
v_mfma_f32_16x16x32_bf16 v[52:55], v[212:215], a[100:103], v[52:55]
s_xor_b32 s69, s69, 0x10000
buffer_load_dwordx4 a[192:195], v1, s[44:47], s69 offen sc1
v_mfma_f32_16x16x32_bf16 v[52:55], v[196:199], a[96:99], v[52:55]
s_nop 0
ds_read_b64_tr_b16 v[168:169], v10 offset:57344
ds_read_b64_tr_b16 v[170:171], v10 offset:59392
v_mfma_f32_16x16x32_bf16 v[56:59], v[200:203], a[96:99], v[56:59]
s_waitcnt vmcnt(19)
v_cmp_gt_u32 vcc, 2, v14
s_cbranch_vccnz Lspin112
Lback113:
v_mfma_f32_16x16x32_bf16 v[56:59], v[216:219], a[100:103], v[56:59]
s_add_u32 s72, s71, 15360
buffer_load_dwordx4 v15, s[24:27], s72 offen offset:1024 lds
v_mfma_f32_16x16x32_bf16 v[56:59], v[232:235], a[104:107], v[56:59]
v_mfma_f32_16x16x32_bf16 v[56:59], v[248:251], a[108:111], v[56:59]
s_nop 0
ds_read_b64_tr_b16 v[172:173], v11 offset:57344
ds_read_b64_tr_b16 v[174:175], v11 offset:59392
v_mfma_f32_16x16x32_bf16 v[72:75], v[248:251], a[124:127], v[72:75]
s_nop 0
ds_read_b64_tr_b16 v[176:177], v8 offset:61440
ds_read_b64_tr_b16 v[178:179], v8 offset:63488
v_mfma_f32_16x16x32_bf16 v[72:75], v[232:235], a[120:123], v[72:75]
s_nop 0
ds_read_b64_tr_b16 v[180:181], v9 offset:61440
ds_read_b64_tr_b16 v[182:183], v9 offset:63488
v_mfma_f32_16x16x32_bf16 v[72:75], v[216:219], a[116:119], v[72:75]
s_nop 0
ds_read_b64_tr_b16 v[184:185], v10 offset:61440
ds_read_b64_tr_b16 v[186:187], v10 offset:63488
v_mfma_f32_16x16x32_bf16 v[72:75], v[200:203], a[112:115], v[72:75]
s_add_u32 s72, s71, 30720
buffer_load_dwordx4 v15, s[24:27], s72 offen offset:2048 lds
v_mfma_f32_16x16x32_bf16 v[76:79], v[204:207], a[112:115], v[76:79]
buffer_load_dwordx4 a[196:199], v1, s[44:47], s69 offen offset:1024 sc1
v_mfma_f32_16x16x32_bf16 v[76:79], v[220:223], a[116:119], v[76:79]
s_nop 0
ds_read_b64_tr_b16 v[188:189], v11 offset:61440
ds_read_b64_tr_b16 v[190:191], v11 offset:63488
v_mfma_f32_16x16x32_bf16 v[76:79], v[236:239], a[120:123], v[76:79]
v_mfma_f32_16x16x32_bf16 v[76:79], v[252:255], a[124:127], v[76:79]
v_mfma_f32_16x16x32_bf16 v[60:63], v[252:255], a[108:111], v[60:63]
v_xor_b32 v8, 0x10000, v8
v_mfma_f32_16x16x32_bf16 v[60:63], v[236:239], a[104:107], v[60:63]
s_add_u32 s72, s71, 46080
buffer_load_dwordx4 v15, s[24:27], s72 offen offset:3072 lds
v_xor_b32 v9, 0x10000, v9
v_mfma_f32_16x16x32_bf16 v[60:63], v[220:223], a[100:103], v[60:63]
s_waitcnt vmcnt(28) lgkmcnt(0)
v_xor_b32 v10, 0x10000, v10
v_mfma_f32_16x16x32_bf16 v[60:63], v[204:207], a[96:99], v[60:63]
s_barrier
v_xor_b32 v11, 0x10000, v11
v_mfma_f32_16x16x32_bf16 v[80:83], v[128:131], a[96:99], v[80:83]
s_lshl_b32 s84, s76, 11
ds_read_b64_tr_b16 v[192:193], v8 offset:0
ds_read_b64_tr_b16 v[194:195], v8 offset:2048
v_mfma_f32_16x16x32_bf16 v[80:83], v[144:147], a[100:103], v[80:83]
s_add_u32 s84, s84, 0x3810000
ds_read_b64_tr_b16 v[196:197], v9 offset:0
ds_read_b64_tr_b16 v[198:199], v9 offset:2048
v_mfma_f32_16x16x32_bf16 v[80:83], v[160:163], a[104:107], v[80:83]
buffer_load_dwordx4 a[200:203], v1, s[44:47], s69 offen offset:2048 sc1
v_mfma_f32_16x16x32_bf16 v[80:83], v[176:179], a[108:111], v[80:83]
s_nop 0
ds_read_b64_tr_b16 v[200:201], v10 offset:0
ds_read_b64_tr_b16 v[202:203], v10 offset:2048
v_mfma_f32_16x16x32_bf16 v[96:99], v[176:179], a[124:127], v[96:99]
s_nop 0
ds_read_b64_tr_b16 v[204:205], v11 offset:0
ds_read_b64_tr_b16 v[206:207], v11 offset:2048
v_mfma_f32_16x16x32_bf16 v[96:99], v[160:163], a[120:123], v[96:99]
s_xor_b32 s71, s15, 0x400080
v_lshrrev_b32 v115, 2, v0
v_lshlrev_b32 v115, 7, v115
v_mfma_f32_16x16x32_bf16 v[96:99], v[144:147], a[116:119], v[96:99]
s_add_u32 m0, s77, 16384
ds_read_b64_tr_b16 v[208:209], v8 offset:4096
ds_read_b64_tr_b16 v[210:211], v8 offset:6144
v_mfma_f32_16x16x32_bf16 v[96:99], v[128:131], a[112:115], v[96:99]
s_add_u32 s72, s71, 0
buffer_load_dwordx4 v15, s[24:27], s72 offen lds
v_mfma_f32_16x16x32_bf16 v[100:103], v[132:135], a[112:115], v[100:103]
s_nop 0
ds_read_b64_tr_b16 v[212:213], v9 offset:4096
ds_read_b64_tr_b16 v[214:215], v9 offset:6144
v_mfma_f32_16x16x32_bf16 v[100:103], v[148:151], a[116:119], v[100:103]
s_nop 0
ds_read_b64_tr_b16 v[216:217], v10 offset:4096
ds_read_b64_tr_b16 v[218:219], v10 offset:6144
v_mfma_f32_16x16x32_bf16 v[100:103], v[164:167], a[120:123], v[100:103]
s_nop 0
ds_read_b64_tr_b16 v[220:221], v11 offset:4096
ds_read_b64_tr_b16 v[222:223], v11 offset:6144
v_mfma_f32_16x16x32_bf16 v[100:103], v[180:183], a[124:127], v[100:103]
buffer_load_dword v114, v115, s[44:47], s84 offen sc1
v_mfma_f32_16x16x32_bf16 v[84:87], v[180:183], a[108:111], v[84:87]
buffer_load_dwordx4 a[204:207], v1, s[44:47], s69 offen offset:3072 sc1
v_mfma_f32_16x16x32_bf16 v[84:87], v[164:167], a[104:107], v[84:87]
s_add_u32 s72, s71, 15360
buffer_load_dwordx4 v15, s[24:27], s72 offen offset:1024 lds
v_mfma_f32_16x16x32_bf16 v[84:87], v[148:151], a[100:103], v[84:87]
s_nop 0
ds_read_b64_tr_b16 v[224:225], v8 offset:8192
ds_read_b64_tr_b16 v[226:227], v8 offset:10240
v_mfma_f32_16x16x32_bf16 v[84:87], v[132:135], a[96:99], v[84:87]
s_nop 0
ds_read_b64_tr_b16 v[228:229], v9 offset:8192
ds_read_b64_tr_b16 v[230:231], v9 offset:10240
v_mfma_f32_16x16x32_bf16 v[88:91], v[136:139], a[96:99], v[88:91]
s_nop 0
ds_read_b64_tr_b16 v[232:233], v10 offset:8192
ds_read_b64_tr_b16 v[234:235], v10 offset:10240
v_mfma_f32_16x16x32_bf16 v[88:91], v[152:155], a[100:103], v[88:91]
s_nop 0
ds_read_b64_tr_b16 v[236:237], v11 offset:8192
ds_read_b64_tr_b16 v[238:239], v11 offset:10240
v_mfma_f32_16x16x32_bf16 v[88:91], v[168:171], a[104:107], v[88:91]
v_mfma_f32_16x16x32_bf16 v[88:91], v[184:187], a[108:111], v[88:91]
s_add_u32 s72, s71, 30720
buffer_load_dwordx4 v15, s[24:27], s72 offen offset:2048 lds
v_mfma_f32_16x16x32_bf16 v[104:107], v[184:187], a[124:127], v[104:107]
s_nop 0
ds_read_b64_tr_b16 v[240:241], v8 offset:12288
ds_read_b64_tr_b16 v[242:243], v8 offset:14336
v_mfma_f32_16x16x32_bf16 v[104:107], v[168:171], a[120:123], v[104:107]
s_nop 0
ds_read_b64_tr_b16 v[244:245], v9 offset:12288
ds_read_b64_tr_b16 v[246:247], v9 offset:14336
v_mfma_f32_16x16x32_bf16 v[104:107], v[152:155], a[116:119], v[104:107]
s_add_u32 s69, s69, 0x20000
buffer_load_dwordx4 a[208:211], v1, s[44:47], s69 offen sc1
v_mfma_f32_16x16x32_bf16 v[104:107], v[136:139], a[112:115], v[104:107]
s_nop 0
ds_read_b64_tr_b16 v[248:249], v10 offset:12288
ds_read_b64_tr_b16 v[250:251], v10 offset:14336
v_mfma_f32_16x16x32_bf16 v[108:111], v[140:143], a[112:115], v[108:111]
s_nop 0
ds_read_b64_tr_b16 v[252:253], v11 offset:12288
ds_read_b64_tr_b16 v[254:255], v11 offset:14336
v_mfma_f32_16x16x32_bf16 v[108:111], v[156:159], a[116:119], v[108:111]
s_add_u32 s72, s71, 46080
buffer_load_dwordx4 v15, s[24:27], s72 offen offset:3072 lds
v_mfma_f32_16x16x32_bf16 v[108:111], v[172:175], a[120:123], v[108:111]
v_mfma_f32_16x16x32_bf16 v[108:111], v[188:191], a[124:127], v[108:111]
v_mfma_f32_16x16x32_bf16 v[92:95], v[188:191], a[108:111], v[92:95]
v_mfma_f32_16x16x32_bf16 v[92:95], v[172:175], a[104:107], v[92:95]
v_mfma_f32_16x16x32_bf16 v[92:95], v[156:159], a[100:103], v[92:95]
s_waitcnt vmcnt(28) lgkmcnt(0)
v_mfma_f32_16x16x32_bf16 v[92:95], v[140:143], a[96:99], v[92:95]
s_barrier
v_mfma_f32_16x16x32_bf16 v[16:19], v[192:195], a[128:131], v[16:19]
buffer_load_dwordx4 a[212:215], v1, s[44:47], s69 offen offset:1024 sc1
v_mfma_f32_16x16x32_bf16 v[16:19], v[208:211], a[132:135], v[16:19]
s_xor_b32 s71, s13, 0x400100
ds_read_b64_tr_b16 v[128:129], v8 offset:16384
ds_read_b64_tr_b16 v[130:131], v8 offset:18432
v_mfma_f32_16x16x32_bf16 v[16:19], v[224:227], a[136:139], v[16:19]
s_add_u32 m0, s77, 32768
ds_read_b64_tr_b16 v[132:133], v9 offset:16384
ds_read_b64_tr_b16 v[134:135], v9 offset:18432
v_mfma_f32_16x16x32_bf16 v[16:19], v[240:243], a[140:143], v[16:19]
s_add_u32 s72, s71, 0
buffer_load_dwordx4 v15, s[24:27], s72 offen lds
v_mfma_f32_16x16x32_bf16 v[32:35], v[240:243], a[156:159], v[32:35]
s_nop 0
ds_read_b64_tr_b16 v[136:137], v10 offset:16384
ds_read_b64_tr_b16 v[138:139], v10 offset:18432
v_mfma_f32_16x16x32_bf16 v[32:35], v[224:227], a[152:155], v[32:35]
s_nop 0
ds_read_b64_tr_b16 v[140:141], v11 offset:16384
ds_read_b64_tr_b16 v[142:143], v11 offset:18432
v_mfma_f32_16x16x32_bf16 v[32:35], v[208:211], a[148:151], v[32:35]
v_mfma_f32_16x16x32_bf16 v[32:35], v[192:195], a[144:147], v[32:35]
s_nop 0
ds_read_b64_tr_b16 v[144:145], v8 offset:20480
ds_read_b64_tr_b16 v[146:147], v8 offset:22528
v_mfma_f32_16x16x32_bf16 v[36:39], v[196:199], a[144:147], v[36:39]
s_add_u32 s72, s71, 15360
buffer_load_dwordx4 v15, s[24:27], s72 offen offset:1024 lds
v_mfma_f32_16x16x32_bf16 v[36:39], v[212:215], a[148:151], v[36:39]
s_nop 0
ds_read_b64_tr_b16 v[148:149], v9 offset:20480
ds_read_b64_tr_b16 v[150:151], v9 offset:22528
v_mfma_f32_16x16x32_bf16 v[36:39], v[228:231], a[152:155], v[36:39]
buffer_load_dwordx4 a[216:219], v1, s[44:47], s69 offen offset:2048 sc1
v_mfma_f32_16x16x32_bf16 v[36:39], v[244:247], a[156:159], v[36:39]
s_nop 0
ds_read_b64_tr_b16 v[152:153], v10 offset:20480
ds_read_b64_tr_b16 v[154:155], v10 offset:22528
v_mfma_f32_16x16x32_bf16 v[20:23], v[244:247], a[140:143], v[20:23]
s_nop 0
ds_read_b64_tr_b16 v[156:157], v11 offset:20480
ds_read_b64_tr_b16 v[158:159], v11 offset:22528
v_mfma_f32_16x16x32_bf16 v[20:23], v[228:231], a[136:139], v[20:23]
v_mfma_f32_16x16x32_bf16 v[20:23], v[212:215], a[132:135], v[20:23]
s_add_u32 s72, s71, 30720
buffer_load_dwordx4 v15, s[24:27], s72 offen offset:2048 lds
v_mfma_f32_16x16x32_bf16 v[20:23], v[196:199], a[128:131], v[20:23]
s_nop 0
ds_read_b64_tr_b16 v[160:161], v8 offset:24576
ds_read_b64_tr_b16 v[162:163], v8 offset:26624
v_mfma_f32_16x16x32_bf16 v[24:27], v[200:203], a[128:131], v[24:27]
s_nop 0
ds_read_b64_tr_b16 v[164:165], v9 offset:24576
ds_read_b64_tr_b16 v[166:167], v9 offset:26624
v_mfma_f32_16x16x32_bf16 v[24:27], v[216:219], a[132:135], v[24:27]
s_nop 0
ds_read_b64_tr_b16 v[168:169], v10 offset:24576
ds_read_b64_tr_b16 v[170:171], v10 offset:26624
v_mfma_f32_16x16x32_bf16 v[24:27], v[232:235], a[136:139], v[24:27]
s_nop 0
ds_read_b64_tr_b16 v[172:173], v11 offset:24576
ds_read_b64_tr_b16 v[174:175], v11 offset:26624
v_mfma_f32_16x16x32_bf16 v[24:27], v[248:251], a[140:143], v[24:27]
v_mfma_f32_16x16x32_bf16 v[40:43], v[248:251], a[156:159], v[40:43]
s_add_u32 s72, s71, 46080
buffer_load_dwordx4 v15, s[24:27], s72 offen offset:3072 lds
v_mfma_f32_16x16x32_bf16 v[40:43], v[232:235], a[152:155], v[40:43]
buffer_load_dwordx4 a[220:223], v1, s[44:47], s69 offen offset:3072 sc1
v_mfma_f32_16x16x32_bf16 v[40:43], v[216:219], a[148:151], v[40:43]
s_nop 0
ds_read_b64_tr_b16 v[176:177], v8 offset:28672
ds_read_b64_tr_b16 v[178:179], v8 offset:30720
v_mfma_f32_16x16x32_bf16 v[40:43], v[200:203], a[144:147], v[40:43]
s_lshr_b32 s69, s15, 18
ds_read_b64_tr_b16 v[180:181], v9 offset:28672
ds_read_b64_tr_b16 v[182:183], v9 offset:30720
v_mfma_f32_16x16x32_bf16 v[44:47], v[204:207], a[144:147], v[44:47]
s_lshl_b32 s69, s69, 12
ds_read_b64_tr_b16 v[184:185], v10 offset:28672
ds_read_b64_tr_b16 v[186:187], v10 offset:30720
v_mfma_f32_16x16x32_bf16 v[44:47], v[220:223], a[148:151], v[44:47]
s_add_u32 s69, s69, s95
ds_read_b64_tr_b16 v[188:189], v11 offset:28672
ds_read_b64_tr_b16 v[190:191], v11 offset:30720
v_mfma_f32_16x16x32_bf16 v[44:47], v[236:239], a[152:155], v[44:47]
s_xor_b32 s69, s69, 0x10000
v_mfma_f32_16x16x32_bf16 v[44:47], v[252:255], a[156:159], v[44:47]
s_xor_b32 s71, s14, 0x400100
v_mfma_f32_16x16x32_bf16 v[28:31], v[252:255], a[140:143], v[28:31]
s_add_u32 m0, s77, 49152
v_mfma_f32_16x16x32_bf16 v[28:31], v[236:239], a[136:139], v[28:31]
s_add_u32 s72, s71, 0
v_mfma_f32_16x16x32_bf16 v[28:31], v[220:223], a[132:135], v[28:31]
s_waitcnt vmcnt(29) lgkmcnt(0)
buffer_load_dwordx4 v15, s[24:27], s72 offen lds
v_mfma_f32_16x16x32_bf16 v[28:31], v[204:207], a[128:131], v[28:31]
s_barrier
buffer_load_dwordx4 a[224:227], v1, s[44:47], s69 offen sc1
v_mfma_f32_16x16x32_bf16 v[48:51], v[128:131], a[128:131], v[48:51]
s_nop 0
ds_read_b64_tr_b16 v[192:193], v8 offset:32768
ds_read_b64_tr_b16 v[194:195], v8 offset:34816
v_mfma_f32_16x16x32_bf16 v[48:51], v[144:147], a[132:135], v[48:51]
s_nop 0
ds_read_b64_tr_b16 v[196:197], v9 offset:32768
ds_read_b64_tr_b16 v[198:199], v9 offset:34816
v_mfma_f32_16x16x32_bf16 v[48:51], v[160:163], a[136:139], v[48:51]
s_nop 0
ds_read_b64_tr_b16 v[200:201], v10 offset:32768
ds_read_b64_tr_b16 v[202:203], v10 offset:34816
v_mfma_f32_16x16x32_bf16 v[48:51], v[176:179], a[140:143], v[48:51]
s_add_u32 s72, s71, 15360
buffer_load_dwordx4 v15, s[24:27], s72 offen offset:1024 lds
v_mfma_f32_16x16x32_bf16 v[64:67], v[176:179], a[156:159], v[64:67]
s_nop 0
ds_read_b64_tr_b16 v[204:205], v11 offset:32768
ds_read_b64_tr_b16 v[206:207], v11 offset:34816
v_mfma_f32_16x16x32_bf16 v[64:67], v[160:163], a[152:155], v[64:67]
v_mfma_f32_16x16x32_bf16 v[64:67], v[144:147], a[148:151], v[64:67]
s_nop 0
ds_read_b64_tr_b16 v[208:209], v8 offset:36864
ds_read_b64_tr_b16 v[210:211], v8 offset:38912
v_mfma_f32_16x16x32_bf16 v[64:67], v[128:131], a[144:147], v[64:67]
s_nop 0
ds_read_b64_tr_b16 v[212:213], v9 offset:36864
ds_read_b64_tr_b16 v[214:215], v9 offset:38912
v_mfma_f32_16x16x32_bf16 v[68:71], v[132:135], a[144:147], v[68:71]
buffer_load_dwordx4 a[228:231], v1, s[44:47], s69 offen offset:1024 sc1
v_mfma_f32_16x16x32_bf16 v[68:71], v[148:151], a[148:151], v[68:71]
s_add_u32 s72, s71, 30720
buffer_load_dwordx4 v15, s[24:27], s72 offen offset:2048 lds
v_mfma_f32_16x16x32_bf16 v[68:71], v[164:167], a[152:155], v[68:71]
s_nop 0
ds_read_b64_tr_b16 v[216:217], v10 offset:36864
ds_read_b64_tr_b16 v[218:219], v10 offset:38912
v_mfma_f32_16x16x32_bf16 v[68:71], v[180:183], a[156:159], v[68:71]
v_mfma_f32_16x16x32_bf16 v[52:55], v[180:183], a[140:143], v[52:55]
s_nop 0
ds_read_b64_tr_b16 v[220:221], v11 offset:36864
ds_read_b64_tr_b16 v[222:223], v11 offset:38912
v_mfma_f32_16x16x32_bf16 v[52:55], v[164:167], a[136:139], v[52:55]
s_nop 0
ds_read_b64_tr_b16 v[224:225], v8 offset:40960
ds_read_b64_tr_b16 v[226:227], v8 offset:43008
v_mfma_f32_16x16x32_bf16 v[52:55], v[148:151], a[132:135], v[52:55]
s_nop 0
ds_read_b64_tr_b16 v[228:229], v9 offset:40960
ds_read_b64_tr_b16 v[230:231], v9 offset:43008
v_mfma_f32_16x16x32_bf16 v[52:55], v[132:135], a[128:131], v[52:55]
s_add_u32 s72, s71, 46080
buffer_load_dwordx4 v15, s[24:27], s72 offen offset:3072 lds
v_mfma_f32_16x16x32_bf16 v[56:59], v[136:139], a[128:131], v[56:59]
v_mfma_f32_16x16x32_bf16 v[56:59], v[152:155], a[132:135], v[56:59]
s_nop 0
ds_read_b64_tr_b16 v[232:233], v10 offset:40960
ds_read_b64_tr_b16 v[234:235], v10 offset:43008
v_mfma_f32_16x16x32_bf16 v[56:59], v[168:171], a[136:139], v[56:59]
buffer_load_dwordx4 a[232:235], v1, s[44:47], s69 offen offset:2048 sc1
v_mfma_f32_16x16x32_bf16 v[56:59], v[184:187], a[140:143], v[56:59]
s_nop 0
ds_read_b64_tr_b16 v[236:237], v11 offset:40960
ds_read_b64_tr_b16 v[238:239], v11 offset:43008
v_mfma_f32_16x16x32_bf16 v[72:75], v[184:187], a[156:159], v[72:75]
s_nop 0
ds_read_b64_tr_b16 v[240:241], v8 offset:45056
ds_read_b64_tr_b16 v[242:243], v8 offset:47104
v_mfma_f32_16x16x32_bf16 v[72:75], v[168:171], a[152:155], v[72:75]
v_mfma_f32_16x16x32_bf16 v[72:75], v[152:155], a[148:151], v[72:75]
s_nop 0
ds_read_b64_tr_b16 v[244:245], v9 offset:45056
ds_read_b64_tr_b16 v[246:247], v9 offset:47104
v_mfma_f32_16x16x32_bf16 v[72:75], v[136:139], a[144:147], v[72:75]
s_xor_b32 s71, s15, 0x400100
ds_read_b64_tr_b16 v[248:249], v10 offset:45056
ds_read_b64_tr_b16 v[250:251], v10 offset:47104
v_mfma_f32_16x16x32_bf16 v[76:79], v[140:143], a[144:147], v[76:79]
s_add_u32 m0, s85, 0
ds_read_b64_tr_b16 v[252:253], v11 offset:45056
ds_read_b64_tr_b16 v[254:255], v11 offset:47104
v_mfma_f32_16x16x32_bf16 v[76:79], v[156:159], a[148:151], v[76:79]
s_add_u32 s72, s71, 0
buffer_load_dwordx4 v15, s[24:27], s72 offen lds
v_mfma_f32_16x16x32_bf16 v[76:79], v[172:175], a[152:155], v[76:79]
v_mfma_f32_16x16x32_bf16 v[76:79], v[188:191], a[156:159], v[76:79]
v_mfma_f32_16x16x32_bf16 v[60:63], v[188:191], a[140:143], v[60:63]
buffer_load_dwordx4 a[236:239], v1, s[44:47], s69 offen offset:3072 sc1
v_mfma_f32_16x16x32_bf16 v[60:63], v[172:175], a[136:139], v[60:63]
s_add_u32 s72, s71, 15360
v_mfma_f32_16x16x32_bf16 v[60:63], v[156:159], a[132:135], v[60:63]
s_waitcnt vmcnt(31) lgkmcnt(0)
v_mfma_f32_16x16x32_bf16 v[60:63], v[140:143], a[128:131], v[60:63]
s_barrier
buffer_load_dwordx4 v15, s[24:27], s72 offen offset:1024 lds
v_mfma_f32_16x16x32_bf16 v[80:83], v[192:195], a[128:131], v[80:83]
s_nop 0
ds_read_b64_tr_b16 v[128:129], v8 offset:49152
ds_read_b64_tr_b16 v[130:131], v8 offset:51200
v_mfma_f32_16x16x32_bf16 v[80:83], v[208:211], a[132:135], v[80:83]
s_nop 0
ds_read_b64_tr_b16 v[132:133], v9 offset:49152
ds_read_b64_tr_b16 v[134:135], v9 offset:51200
v_mfma_f32_16x16x32_bf16 v[80:83], v[224:227], a[136:139], v[80:83]
s_nop 0
ds_read_b64_tr_b16 v[136:137], v10 offset:49152
ds_read_b64_tr_b16 v[138:139], v10 offset:51200
s_waitcnt vmcnt(22)
v_cmp_gt_u32 vcc, 3, v114
s_cbranch_vccnz Lspin109
Lback110:
v_mfma_f32_16x16x32_bf16 v[80:83], v[240:243], a[140:143], v[80:83]
s_lshl_b32 s73, s76, 18
ds_read_b64_tr_b16 v[140:141], v11 offset:49152
ds_read_b64_tr_b16 v[142:143], v11 offset:51200
v_mfma_f32_16x16x32_bf16 v[96:99], v[240:243], a[156:159], v[96:99]
s_lshl_b32 s84, s58, 16
v_mfma_f32_16x16x32_bf16 v[96:99], v[224:227], a[152:155], v[96:99]
s_add_u32 s72, s71, 30720
buffer_load_dwordx4 v15, s[24:27], s72 offen offset:2048 lds
Lstube2:
s_cbranch_execz Lrete
v_mfma_f32_16x16x32_bf16 v[96:99], v[208:211], a[148:151], v[96:99]
s_add_u32 s69, s69, 0x20000
buffer_load_dwordx4 a[240:243], v1, s[44:47], s69 offen sc1
v_mfma_f32_16x16x32_bf16 v[96:99], v[192:195], a[144:147], v[96:99]
s_add_u32 s73, s73, s84
ds_read_b64_tr_b16 v[144:145], v8 offset:53248
ds_read_b64_tr_b16 v[146:147], v8 offset:55296
v_mfma_f32_16x16x32_bf16 v[100:103], v[196:199], a[144:147], v[100:103]
s_lshl_b32 s84, s75, 8
ds_read_b64_tr_b16 v[148:149], v9 offset:53248
ds_read_b64_tr_b16 v[150:151], v9 offset:55296
v_mfma_f32_16x16x32_bf16 v[100:103], v[212:215], a[148:151], v[100:103]
s_add_u32 s73, s73, s84
ds_read_b64_tr_b16 v[152:153], v10 offset:53248
ds_read_b64_tr_b16 v[154:155], v10 offset:55296
v_mfma_f32_16x16x32_bf16 v[100:103], v[228:231], a[152:155], v[100:103]
s_add_u32 s73, s73, 0x3400000
v_lshrrev_b32 v112, 4, v0
v_and_b32 v113, 15, v0
v_mfma_f32_16x16x32_bf16 v[100:103], v[244:247], a[156:159], v[100:103]
s_add_u32 s72, s71, 46080
buffer_load_dwordx4 v15, s[24:27], s72 offen offset:3072 lds
v_mfma_f32_16x16x32_bf16 v[84:87], v[244:247], a[140:143], v[84:87]
s_nop 0
ds_read_b64_tr_b16 v[156:157], v11 offset:53248
ds_read_b64_tr_b16 v[158:159], v11 offset:55296
v_mfma_f32_16x16x32_bf16 v[84:87], v[228:231], a[136:139], v[84:87]
s_nop 0
ds_read_b64_tr_b16 v[160:161], v8 offset:57344
ds_read_b64_tr_b16 v[162:163], v8 offset:59392
v_mfma_f32_16x16x32_bf16 v[84:87], v[212:215], a[132:135], v[84:87]
s_nop 0
ds_read_b64_tr_b16 v[164:165], v9 offset:57344
ds_read_b64_tr_b16 v[166:167], v9 offset:59392
v_mfma_f32_16x16x32_bf16 v[84:87], v[196:199], a[128:131], v[84:87]
v_xor_b32 v12, v113, v112
v_lshlrev_b32 v12, 4, v12
v_mfma_f32_16x16x32_bf16 v[88:91], v[200:203], a[128:131], v[88:91]
buffer_load_dwordx4 a[244:247], v1, s[44:47], s69 offen offset:1024 sc1
v_mfma_f32_16x16x32_bf16 v[88:91], v[216:219], a[132:135], v[88:91]
s_nop 0
ds_read_b64_tr_b16 v[168:169], v10 offset:57344
ds_read_b64_tr_b16 v[170:171], v10 offset:59392
v_mfma_f32_16x16x32_bf16 v[88:91], v[232:235], a[136:139], v[88:91]
s_nop 0
ds_read_b64_tr_b16 v[172:173], v11 offset:57344
ds_read_b64_tr_b16 v[174:175], v11 offset:59392
v_mfma_f32_16x16x32_bf16 v[88:91], v[248:251], a[140:143], v[88:91]
s_xor_b32 s71, s13, 0x400180
ds_read_b64_tr_b16 v[176:177], v8 offset:61440
ds_read_b64_tr_b16 v[178:179], v8 offset:63488
v_mfma_f32_16x16x32_bf16 v[104:107], v[248:251], a[156:159], v[104:107]
s_add_u32 m0, s85, 16384
v_lshl_add_u32 v112, v112, 12, v12
v_xor_b32 v12, 64, v112
v_mfma_f32_16x16x32_bf16 v[104:107], v[232:235], a[152:155], v[104:107]
s_add_u32 s72, s71, 0
buffer_load_dwordx4 v15, s[24:27], s72 offen lds
v_mfma_f32_16x16x32_bf16 v[104:107], v[216:219], a[148:151], v[104:107]
s_nop 0
ds_read_b64_tr_b16 v[180:181], v9 offset:61440
ds_read_b64_tr_b16 v[182:183], v9 offset:63488
v_mfma_f32_16x16x32_bf16 v[104:107], v[200:203], a[144:147], v[104:107]
s_nop 0
ds_read_b64_tr_b16 v[184:185], v10 offset:61440
ds_read_b64_tr_b16 v[186:187], v10 offset:63488
v_mfma_f32_16x16x32_bf16 v[108:111], v[204:207], a[144:147], v[108:111]
s_nop 0
ds_read_b64_tr_b16 v[188:189], v11 offset:61440
ds_read_b64_tr_b16 v[190:191], v11 offset:63488
v_mfma_f32_16x16x32_bf16 v[108:111], v[220:223], a[148:151], v[108:111]
v_lshlrev_b32 v113, 2, v113
v_mfma_f32_16x16x32_bf16 v[108:111], v[236:239], a[152:155], v[108:111]
s_add_u32 s72, s71, 15360
buffer_load_dwordx4 v15, s[24:27], s72 offen offset:1024 lds
v_mfma_f32_16x16x32_bf16 v[108:111], v[252:255], a[156:159], v[108:111]
buffer_load_dwordx4 a[248:251], v1, s[44:47], s69 offen offset:2048 sc1
v_mfma_f32_16x16x32_bf16 v[92:95], v[252:255], a[140:143], v[92:95]
v_xor_b32 v8, 0x10000, v8
v_mfma_f32_16x16x32_bf16 v[92:95], v[236:239], a[136:139], v[92:95]
v_xor_b32 v9, 0x10000, v9
v_mfma_f32_16x16x32_bf16 v[92:95], v[220:223], a[132:135], v[92:95]
s_waitcnt vmcnt(32) lgkmcnt(0)
v_xor_b32 v10, 0x10000, v10
v_mfma_f32_16x16x32_bf16 v[92:95], v[204:207], a[128:131], v[92:95]
s_barrier
v_xor_b32 v11, 0x10000, v11
v_mfma_f32_16x16x32_bf16 v[16:19], v[128:131], a[160:163], v[16:19]
s_add_u32 s72, s71, 30720
buffer_load_dwordx4 v15, s[24:27], s72 offen offset:2048 lds
v_mfma_f32_16x16x32_bf16 v[16:19], v[144:147], a[164:167], v[16:19]
s_nop 0
ds_read_b64_tr_b16 v[192:193], v8 offset:0
ds_read_b64_tr_b16 v[194:195], v8 offset:2048
v_mfma_f32_16x16x32_bf16 v[16:19], v[160:163], a[168:171], v[16:19]
s_nop 0
ds_read_b64_tr_b16 v[196:197], v9 offset:0
ds_read_b64_tr_b16 v[198:199], v9 offset:2048
v_mfma_f32_16x16x32_bf16 v[16:19], v[176:179], a[172:175], v[16:19]
s_nop 0
ds_read_b64_tr_b16 v[200:201], v10 offset:0
ds_read_b64_tr_b16 v[202:203], v10 offset:2048
v_mfma_f32_16x16x32_bf16 v[32:35], v[176:179], a[188:191], v[32:35]
buffer_load_dwordx4 a[252:255], v1, s[44:47], s69 offen offset:3072 sc1
v_mfma_f32_16x16x32_bf16 v[32:35], v[160:163], a[184:187], v[32:35]
v_mfma_f32_16x16x32_bf16 v[32:35], v[144:147], a[180:183], v[32:35]
s_add_u32 s72, s71, 46080
buffer_load_dwordx4 v15, s[24:27], s72 offen offset:3072 lds
v_mfma_f32_16x16x32_bf16 v[32:35], v[128:131], a[176:179], v[32:35]
s_nop 0
ds_read_b64_tr_b16 v[204:205], v11 offset:0
ds_read_b64_tr_b16 v[206:207], v11 offset:2048
v_mfma_f32_16x16x32_bf16 v[36:39], v[132:135], a[176:179], v[36:39]
s_nop 0
ds_read_b64_tr_b16 v[208:209], v8 offset:4096
ds_read_b64_tr_b16 v[210:211], v8 offset:6144
v_mfma_f32_16x16x32_bf16 v[36:39], v[148:151], a[180:183], v[36:39]
s_nop 0
ds_read_b64_tr_b16 v[212:213], v9 offset:4096
ds_read_b64_tr_b16 v[214:215], v9 offset:6144
v_mfma_f32_16x16x32_bf16 v[36:39], v[164:167], a[184:187], v[36:39]
v_mfma_f32_16x16x32_bf16 v[36:39], v[180:183], a[188:191], v[36:39]
s_nop 0
ds_read_b64_tr_b16 v[216:217], v10 offset:4096
ds_read_b64_tr_b16 v[218:219], v10 offset:6144
v_mfma_f32_16x16x32_bf16 v[20:23], v[180:183], a[172:175], v[20:23]
s_nop 0
ds_read_b64_tr_b16 v[220:221], v11 offset:4096
ds_read_b64_tr_b16 v[222:223], v11 offset:6144
v_mfma_f32_16x16x32_bf16 v[20:23], v[164:167], a[168:171], v[20:23]
v_mfma_f32_16x16x32_bf16 v[20:23], v[148:151], a[164:167], v[20:23]
s_xor_b32 s71, s14, 0x400180
ds_read_b64_tr_b16 v[224:225], v8 offset:8192
ds_read_b64_tr_b16 v[226:227], v8 offset:10240
v_mfma_f32_16x16x32_bf16 v[20:23], v[132:135], a[160:163], v[20:23]
s_add_u32 m0, s85, 32768
ds_read_b64_tr_b16 v[228:229], v9 offset:8192
ds_read_b64_tr_b16 v[230:231], v9 offset:10240
v_mfma_f32_16x16x32_bf16 v[24:27], v[136:139], a[160:163], v[24:27]
s_add_u32 s72, s71, 0
buffer_load_dwordx4 v15, s[24:27], s72 offen lds
v_mfma_f32_16x16x32_bf16 v[24:27], v[152:155], a[164:167], v[24:27]
s_nop 0
ds_read_b64_tr_b16 v[232:233], v10 offset:8192
ds_read_b64_tr_b16 v[234:235], v10 offset:10240
v_mfma_f32_16x16x32_bf16 v[24:27], v[168:171], a[168:171], v[24:27]
v_mfma_f32_16x16x32_bf16 v[24:27], v[184:187], a[172:175], v[24:27]
s_nop 0
ds_read_b64_tr_b16 v[236:237], v11 offset:8192
ds_read_b64_tr_b16 v[238:239], v11 offset:10240
v_mfma_f32_16x16x32_bf16 v[40:43], v[184:187], a[188:191], v[40:43]
s_nop 0
ds_read_b64_tr_b16 v[240:241], v8 offset:12288
ds_read_b64_tr_b16 v[242:243], v8 offset:14336
v_mfma_f32_16x16x32_bf16 v[40:43], v[168:171], a[184:187], v[40:43]
s_nop 0
ds_read_b64_tr_b16 v[244:245], v9 offset:12288
ds_read_b64_tr_b16 v[246:247], v9 offset:14336
v_mfma_f32_16x16x32_bf16 v[40:43], v[152:155], a[180:183], v[40:43]
s_add_u32 s72, s71, 15360
buffer_load_dwordx4 v15, s[24:27], s72 offen offset:1024 lds
v_mfma_f32_16x16x32_bf16 v[40:43], v[136:139], a[176:179], v[40:43]
v_mfma_f32_16x16x32_bf16 v[44:47], v[140:143], a[176:179], v[44:47]
s_nop 0
ds_read_b64_tr_b16 v[248:249], v10 offset:12288
ds_read_b64_tr_b16 v[250:251], v10 offset:14336
v_mfma_f32_16x16x32_bf16 v[44:47], v[156:159], a[180:183], v[44:47]
s_nop 0
ds_read_b64_tr_b16 v[252:253], v11 offset:12288
ds_read_b64_tr_b16 v[254:255], v11 offset:14336
v_mfma_f32_16x16x32_bf16 v[44:47], v[172:175], a[184:187], v[44:47]
v_mfma_f32_16x16x32_bf16 v[44:47], v[188:191], a[188:191], v[44:47]
v_mfma_f32_16x16x32_bf16 v[28:31], v[188:191], a[172:175], v[28:31]
s_add_u32 s72, s71, 30720
buffer_load_dwordx4 v15, s[24:27], s72 offen offset:2048 lds
v_mfma_f32_16x16x32_bf16 v[28:31], v[172:175], a[168:171], v[28:31]
v_mfma_f32_16x16x32_bf16 v[28:31], v[156:159], a[164:167], v[28:31]
s_waitcnt vmcnt(23) lgkmcnt(0)
v_mfma_f32_16x16x32_bf16 v[28:31], v[140:143], a[160:163], v[28:31]
s_barrier
v_mfma_f32_16x16x32_bf16 v[16:19], v[192:195], a[192:195], v[16:19]
s_nop 0
ds_read_b64_tr_b16 v[128:129], v8 offset:16384
ds_read_b64_tr_b16 v[130:131], v8 offset:18432
v_mfma_f32_16x16x32_bf16 v[16:19], v[208:211], a[196:199], v[16:19]
s_nop 0
ds_read_b64_tr_b16 v[132:133], v9 offset:16384
ds_read_b64_tr_b16 v[134:135], v9 offset:18432
v_mfma_f32_16x16x32_bf16 v[16:19], v[224:227], a[200:203], v[16:19]
s_add_u32 s72, s71, 46080
buffer_load_dwordx4 v15, s[24:27], s72 offen offset:3072 lds
v_mfma_f32_16x16x32_bf16 v[16:19], v[240:243], a[204:207], v[16:19]
s_nop 0
ds_read_b64_tr_b16 v[136:137], v10 offset:16384
ds_read_b64_tr_b16 v[138:139], v10 offset:18432
v_mfma_f32_16x16x32_bf16 v[32:35], v[240:243], a[220:223], v[32:35]
s_nop 0
ds_read_b64_tr_b16 v[140:141], v11 offset:16384
ds_read_b64_tr_b16 v[142:143], v11 offset:18432
v_mfma_f32_16x16x32_bf16 v[32:35], v[224:227], a[216:219], v[32:35]
v_mfma_f32_16x16x32_bf16 v[32:35], v[208:211], a[212:215], v[32:35]
s_nop 0
ds_read_b64_tr_b16 v[144:145], v8 offset:20480
ds_read_b64_tr_b16 v[146:147], v8 offset:22528
v_mfma_f32_16x16x32_bf16 v[32:35], v[192:195], a[208:211], v[32:35]
s_nop 0
ds_read_b64_tr_b16 v[148:149], v9 offset:20480
ds_read_b64_tr_b16 v[150:151], v9 offset:22528
v_mfma_f32_16x16x32_bf16 v[36:39], v[196:199], a[208:211], v[36:39]
s_nop 0
ds_read_b64_tr_b16 v[152:153], v10 offset:20480
ds_read_b64_tr_b16 v[154:155], v10 offset:22528
v_mfma_f32_16x16x32_bf16 v[36:39], v[212:215], a[212:215], v[36:39]
s_nop 0
ds_read_b64_tr_b16 v[156:157], v11 offset:20480
ds_read_b64_tr_b16 v[158:159], v11 offset:22528
v_mfma_f32_16x16x32_bf16 v[36:39], v[228:231], a[216:219], v[36:39]
v_mfma_f32_16x16x32_bf16 v[36:39], v[244:247], a[220:223], v[36:39]
s_add_u32 m0, s64, 147456
ds_read_b64_tr_b16 v[160:161], v8 offset:24576
ds_read_b64_tr_b16 v[162:163], v8 offset:26624
v_mfma_f32_16x16x32_bf16 v[20:23], v[244:247], a[204:207], v[20:23]
s_add_u32 s72, s73, 0
buffer_load_dwordx4 v112, s[44:47], s72 offen sc1 lds
v_mfma_f32_16x16x32_bf16 v[20:23], v[228:231], a[200:203], v[20:23]
s_nop 0
ds_read_b64_tr_b16 v[164:165], v9 offset:24576
ds_read_b64_tr_b16 v[166:167], v9 offset:26624
v_mfma_f32_16x16x32_bf16 v[20:23], v[212:215], a[196:199], v[20:23]
s_add_u32 s72, s73, 15360
buffer_load_dwordx4 v12, s[44:47], s72 offen offset:1024 sc1 lds
v_mfma_f32_16x16x32_bf16 v[20:23], v[196:199], a[192:195], v[20:23]
s_nop 0
ds_read_b64_tr_b16 v[168:169], v10 offset:24576
ds_read_b64_tr_b16 v[170:171], v10 offset:26624
v_mfma_f32_16x16x32_bf16 v[24:27], v[200:203], a[192:195], v[24:27]
s_nop 0
ds_read_b64_tr_b16 v[172:173], v11 offset:24576
ds_read_b64_tr_b16 v[174:175], v11 offset:26624
v_mfma_f32_16x16x32_bf16 v[24:27], v[216:219], a[196:199], v[24:27]
s_add_u32 s72, s73, 30720
buffer_load_dwordx4 v112, s[44:47], s72 offen offset:2048 sc1 lds
v_mfma_f32_16x16x32_bf16 v[24:27], v[232:235], a[200:203], v[24:27]
v_mfma_f32_16x16x32_bf16 v[24:27], v[248:251], a[204:207], v[24:27]
s_nop 0
ds_read_b64_tr_b16 v[176:177], v8 offset:28672
ds_read_b64_tr_b16 v[178:179], v8 offset:30720
v_mfma_f32_16x16x32_bf16 v[40:43], v[248:251], a[220:223], v[40:43]
s_add_u32 s72, s73, 46080
buffer_load_dwordx4 v12, s[44:47], s72 offen offset:3072 sc1 lds
v_mfma_f32_16x16x32_bf16 v[40:43], v[232:235], a[216:219], v[40:43]
s_xor_b32 s71, s15, 0x400180
ds_read_b64_tr_b16 v[180:181], v9 offset:28672
ds_read_b64_tr_b16 v[182:183], v9 offset:30720
v_mfma_f32_16x16x32_bf16 v[40:43], v[216:219], a[212:215], v[40:43]
s_add_u32 m0, s85, 49152
ds_read_b64_tr_b16 v[184:185], v10 offset:28672
ds_read_b64_tr_b16 v[186:187], v10 offset:30720
v_mfma_f32_16x16x32_bf16 v[40:43], v[200:203], a[208:211], v[40:43]
s_add_u32 s72, s71, 0
buffer_load_dwordx4 v15, s[24:27], s72 offen lds
v_mfma_f32_16x16x32_bf16 v[44:47], v[204:207], a[208:211], v[44:47]
s_nop 0
ds_read_b64_tr_b16 v[188:189], v11 offset:28672
ds_read_b64_tr_b16 v[190:191], v11 offset:30720
v_mfma_f32_16x16x32_bf16 v[44:47], v[220:223], a[212:215], v[44:47]
v_mfma_f32_16x16x32_bf16 v[44:47], v[236:239], a[216:219], v[44:47]
s_add_u32 s72, s71, 15360
buffer_load_dwordx4 v15, s[24:27], s72 offen offset:1024 lds
v_mfma_f32_16x16x32_bf16 v[44:47], v[252:255], a[220:223], v[44:47]
v_mfma_f32_16x16x32_bf16 v[28:31], v[252:255], a[204:207], v[28:31]
v_mfma_f32_16x16x32_bf16 v[28:31], v[236:239], a[200:203], v[28:31]
s_add_u32 s72, s71, 30720
buffer_load_dwordx4 v15, s[24:27], s72 offen offset:2048 lds
v_mfma_f32_16x16x32_bf16 v[28:31], v[220:223], a[196:199], v[28:31]
s_waitcnt vmcnt(12) lgkmcnt(0)
v_mfma_f32_16x16x32_bf16 v[28:31], v[204:207], a[192:195], v[28:31]
s_barrier
v_mfma_f32_16x16x32_bf16 v[16:19], v[128:131], a[224:227], v[16:19]
s_add_u32 s72, s71, 46080
buffer_load_dwordx4 v15, s[24:27], s72 offen offset:3072 lds
v_mfma_f32_16x16x32_bf16 v[16:19], v[144:147], a[228:231], v[16:19]
s_lshl_b32 s73, s75, 9
ds_read_b64_tr_b16 v[192:193], v8 offset:32768
ds_read_b64_tr_b16 v[194:195], v8 offset:34816
v_mfma_f32_16x16x32_bf16 v[16:19], v[160:163], a[232:235], v[16:19]
s_lshl_b32 s84, s58, 7
ds_read_b64_tr_b16 v[196:197], v9 offset:32768
ds_read_b64_tr_b16 v[198:199], v9 offset:34816
v_mfma_f32_16x16x32_bf16 v[16:19], v[176:179], a[236:239], v[16:19]
s_add_u32 s73, s73, s84
ds_read_b64_tr_b16 v[200:201], v10 offset:32768
ds_read_b64_tr_b16 v[202:203], v10 offset:34816
v_mfma_f32_16x16x32_bf16 v[20:23], v[180:183], a[236:239], v[20:23]
s_add_u32 s73, s73, 0x3800000
ds_read_b64_tr_b16 v[204:205], v11 offset:32768
ds_read_b64_tr_b16 v[206:207], v11 offset:34816
v_mfma_f32_16x16x32_bf16 v[20:23], v[164:167], a[232:235], v[20:23]
s_xor_b32 s71, s12, 0x0
buffer_load_dword v6, v113, s[44:47], s73 offen sc1
v_mfma_f32_16x16x32_bf16 v[20:23], v[148:151], a[228:231], v[20:23]
s_add_u32 m0, s77, 0
ds_read_b64_tr_b16 v[208:209], v8 offset:36864
ds_read_b64_tr_b16 v[210:211], v8 offset:38912
v_mfma_f32_16x16x32_bf16 v[20:23], v[132:135], a[224:227], v[20:23]
s_add_u32 s72, s71, 0
buffer_load_dwordx4 v15, s[24:27], s72 offen lds
v_mfma_f32_16x16x32_bf16 v[24:27], v[136:139], a[224:227], v[24:27]
s_nop 0
ds_read_b64_tr_b16 v[212:213], v9 offset:36864
ds_read_b64_tr_b16 v[214:215], v9 offset:38912
v_mfma_f32_16x16x32_bf16 v[24:27], v[152:155], a[228:231], v[24:27]
s_nop 0
ds_read_b64_tr_b16 v[216:217], v10 offset:36864
ds_read_b64_tr_b16 v[218:219], v10 offset:38912
v_mfma_f32_16x16x32_bf16 v[24:27], v[168:171], a[232:235], v[24:27]
buffer_load_dword v7, v113, s[44:47], s73 offen offset:64 sc1
v_mfma_f32_16x16x32_bf16 v[24:27], v[184:187], a[236:239], v[24:27]
s_nop 0
ds_read_b64_tr_b16 v[220:221], v11 offset:36864
ds_read_b64_tr_b16 v[222:223], v11 offset:38912
v_cvt_pk_bf16_f32 v16, v16, v17
v_mfma_f32_16x16x32_bf16 v[28:31], v[188:191], a[236:239], v[28:31]
s_nop 0
ds_read_b64_tr_b16 v[224:225], v8 offset:40960
ds_read_b64_tr_b16 v[226:227], v8 offset:43008
v_cvt_pk_bf16_f32 v17, v18, v19
v_mfma_f32_16x16x32_bf16 v[28:31], v[172:175], a[232:235], v[28:31]
s_add_u32 s72, s71, 15360
buffer_load_dwordx4 v15, s[24:27], s72 offen offset:1024 lds
v_cvt_pk_bf16_f32 v18, v20, v21
v_mfma_f32_16x16x32_bf16 v[28:31], v[156:159], a[228:231], v[28:31]
s_nop 0
ds_read_b64_tr_b16 v[228:229], v9 offset:40960
ds_read_b64_tr_b16 v[230:231], v9 offset:43008
v_cvt_pk_bf16_f32 v19, v22, v23
v_mfma_f32_16x16x32_bf16 v[28:31], v[140:143], a[224:227], v[28:31]
v_mfma_f32_16x16x32_bf16 v[32:35], v[128:131], a[240:243], v[32:35]
s_xor_b32 s80, s93, 0x80000
ds_read_b64_tr_b16 v[232:233], v10 offset:40960
ds_read_b64_tr_b16 v[234:235], v10 offset:43008
v_mfma_f32_16x16x32_bf16 v[32:35], v[144:147], a[244:247], v[32:35]
s_add_u32 s80, s80, 0x3a00000
buffer_store_dwordx4 v[16:19], v1, s[44:47], s80 offen sc1
v_mfma_f32_16x16x32_bf16 v[32:35], v[160:163], a[248:251], v[32:35]
s_nop 0
ds_read_b64_tr_b16 v[236:237], v11 offset:40960
ds_read_b64_tr_b16 v[238:239], v11 offset:43008
v_mfma_f32_16x16x32_bf16 v[32:35], v[176:179], a[252:255], v[32:35]
s_add_u32 s72, s71, 30720
buffer_load_dwordx4 v15, s[24:27], s72 offen offset:2048 lds
v_cvt_pk_bf16_f32 v20, v24, v25
v_mfma_f32_16x16x32_bf16 v[36:39], v[180:183], a[252:255], v[36:39]
s_nop 0
ds_read_b64_tr_b16 v[240:241], v8 offset:45056
ds_read_b64_tr_b16 v[242:243], v8 offset:47104
v_cvt_pk_bf16_f32 v21, v26, v27
v_mfma_f32_16x16x32_bf16 v[36:39], v[164:167], a[248:251], v[36:39]
v_cvt_pk_bf16_f32 v22, v28, v29
v_cvt_pk_bf16_f32 v23, v30, v31
v_mfma_f32_16x16x32_bf16 v[36:39], v[148:151], a[244:247], v[36:39]
s_nop 0
ds_read_b64_tr_b16 v[244:245], v9 offset:45056
ds_read_b64_tr_b16 v[246:247], v9 offset:47104
v_mfma_f32_16x16x32_bf16 v[36:39], v[132:135], a[240:243], v[36:39]
s_nop 0
ds_read_b64_tr_b16 v[248:249], v10 offset:45056
ds_read_b64_tr_b16 v[250:251], v10 offset:47104
v_mfma_f32_16x16x32_bf16 v[40:43], v[136:139], a[240:243], v[40:43]
s_nop 0
ds_read_b64_tr_b16 v[252:253], v11 offset:45056
ds_read_b64_tr_b16 v[254:255], v11 offset:47104
v_mfma_f32_16x16x32_bf16 v[40:43], v[152:155], a[244:247], v[40:43]
s_add_u32 s72, s71, 46080
buffer_load_dwordx4 v15, s[24:27], s72 offen offset:3072 lds
v_mfma_f32_16x16x32_bf16 v[40:43], v[168:171], a[248:251], v[40:43]
v_mfma_f32_16x16x32_bf16 v[40:43], v[184:187], a[252:255], v[40:43]
v_cvt_pk_bf16_f32 v24, v32, v33
v_cvt_pk_bf16_f32 v25, v34, v35
v_cvt_pk_bf16_f32 v26, v36, v37
v_mfma_f32_16x16x32_bf16 v[44:47], v[188:191], a[252:255], v[44:47]
v_cvt_pk_bf16_f32 v27, v38, v39
v_mfma_f32_16x16x32_bf16 v[44:47], v[172:175], a[248:251], v[44:47]
v_mfma_f32_16x16x32_bf16 v[44:47], v[156:159], a[244:247], v[44:47]
s_waitcnt vmcnt(33) lgkmcnt(0)
v_mfma_f32_16x16x32_bf16 v[44:47], v[140:143], a[240:243], v[44:47]
s_barrier
v_mfma_f32_16x16x32_bf16 v[48:51], v[192:195], a[160:163], v[48:51]
s_nop 0
ds_read_b64_tr_b16 v[128:129], v8 offset:49152
ds_read_b64_tr_b16 v[130:131], v8 offset:51200
v_mfma_f32_16x16x32_bf16 v[48:51], v[208:211], a[164:167], v[48:51]
s_xor_b32 s71, s13, 0x0
buffer_store_dwordx4 v[20:23], v1, s[44:47], s80 offen offset:1024 sc1
v_mfma_f32_16x16x32_bf16 v[48:51], v[224:227], a[168:171], v[48:51]
s_add_u32 m0, s77, 16384
ds_read_b64_tr_b16 v[132:133], v9 offset:49152
ds_read_b64_tr_b16 v[134:135], v9 offset:51200
v_mfma_f32_16x16x32_bf16 v[48:51], v[240:243], a[172:175], v[48:51]
s_add_u32 s72, s71, 0
buffer_load_dwordx4 v15, s[24:27], s72 offen lds
v_cvt_pk_bf16_f32 v28, v40, v41
v_mfma_f32_16x16x32_bf16 v[64:67], v[240:243], a[188:191], v[64:67]
s_nop 0
ds_read_b64_tr_b16 v[136:137], v10 offset:49152
ds_read_b64_tr_b16 v[138:139], v10 offset:51200
v_cvt_pk_bf16_f32 v29, v42, v43
v_mfma_f32_16x16x32_bf16 v[64:67], v[224:227], a[184:187], v[64:67]
s_nop 0
ds_read_b64_tr_b16 v[140:141], v11 offset:49152
ds_read_b64_tr_b16 v[142:143], v11 offset:51200
v_cvt_pk_bf16_f32 v30, v44, v45
v_mfma_f32_16x16x32_bf16 v[64:67], v[208:211], a[180:183], v[64:67]
v_cvt_pk_bf16_f32 v31, v46, v47
v_mfma_f32_16x16x32_bf16 v[64:67], v[192:195], a[176:179], v[64:67]
s_nop 0
ds_read_b64_tr_b16 v[144:145], v8 offset:53248
ds_read_b64_tr_b16 v[146:147], v8 offset:55296
v_mfma_f32_16x16x32_bf16 v[68:71], v[196:199], a[176:179], v[68:71]
s_add_u32 s72, s71, 15360
buffer_load_dwordx4 v15, s[24:27], s72 offen offset:1024 lds
v_mfma_f32_16x16x32_bf16 v[68:71], v[212:215], a[180:183], v[68:71]
s_nop 0
ds_read_b64_tr_b16 v[148:149], v9 offset:53248
ds_read_b64_tr_b16 v[150:151], v9 offset:55296
v_mfma_f32_16x16x32_bf16 v[68:71], v[228:231], a[184:187], v[68:71]
s_nop 0
ds_read_b64_tr_b16 v[152:153], v10 offset:53248
ds_read_b64_tr_b16 v[154:155], v10 offset:55296
v_mfma_f32_16x16x32_bf16 v[68:71], v[244:247], a[188:191], v[68:71]
v_mfma_f32_16x16x32_bf16 v[52:55], v[244:247], a[172:175], v[52:55]
s_nop 0
ds_read_b64_tr_b16 v[156:157], v11 offset:53248
ds_read_b64_tr_b16 v[158:159], v11 offset:55296
v_mfma_f32_16x16x32_bf16 v[52:55], v[228:231], a[168:171], v[52:55]
s_nop 0
ds_read_b64_tr_b16 v[160:161], v8 offset:57344
ds_read_b64_tr_b16 v[162:163], v8 offset:59392
v_mfma_f32_16x16x32_bf16 v[52:55], v[212:215], a[164:167], v[52:55]
s_add_u32 s72, s71, 30720
buffer_load_dwordx4 v15, s[24:27], s72 offen offset:2048 lds
v_mfma_f32_16x16x32_bf16 v[52:55], v[196:199], a[160:163], v[52:55]
s_nop 0
ds_read_b64_tr_b16 v[164:165], v9 offset:57344
ds_read_b64_tr_b16 v[166:167], v9 offset:59392
v_mfma_f32_16x16x32_bf16 v[56:59], v[200:203], a[160:163], v[56:59]
v_mfma_f32_16x16x32_bf16 v[56:59], v[216:219], a[164:167], v[56:59]
buffer_store_dwordx4 v[24:27], v1, s[44:47], s80 offen offset:2048 sc1
v_mfma_f32_16x16x32_bf16 v[56:59], v[232:235], a[168:171], v[56:59]
s_nop 0
ds_read_b64_tr_b16 v[168:169], v10 offset:57344
ds_read_b64_tr_b16 v[170:171], v10 offset:59392
v_mfma_f32_16x16x32_bf16 v[56:59], v[248:251], a[172:175], v[56:59]
s_nop 0
ds_read_b64_tr_b16 v[172:173], v11 offset:57344
ds_read_b64_tr_b16 v[174:175], v11 offset:59392
v_mfma_f32_16x16x32_bf16 v[72:75], v[248:251], a[188:191], v[72:75]
s_add_u32 s72, s71, 46080
buffer_load_dwordx4 v15, s[24:27], s72 offen offset:3072 lds
v_mfma_f32_16x16x32_bf16 v[72:75], v[232:235], a[184:187], v[72:75]
s_nop 0
ds_read_b64_tr_b16 v[176:177], v8 offset:61440
ds_read_b64_tr_b16 v[178:179], v8 offset:63488
v_mfma_f32_16x16x32_bf16 v[72:75], v[216:219], a[180:183], v[72:75]
v_mfma_f32_16x16x32_bf16 v[72:75], v[200:203], a[176:179], v[72:75]
s_nop 0
ds_read_b64_tr_b16 v[180:181], v9 offset:61440
ds_read_b64_tr_b16 v[182:183], v9 offset:63488
v_mfma_f32_16x16x32_bf16 v[76:79], v[204:207], a[176:179], v[76:79]
s_nop 0
ds_read_b64_tr_b16 v[184:185], v10 offset:61440
ds_read_b64_tr_b16 v[186:187], v10 offset:63488
v_mfma_f32_16x16x32_bf16 v[76:79], v[220:223], a[180:183], v[76:79]
s_nop 0
ds_read_b64_tr_b16 v[188:189], v11 offset:61440
ds_read_b64_tr_b16 v[190:191], v11 offset:63488
v_mfma_f32_16x16x32_bf16 v[76:79], v[236:239], a[184:187], v[76:79]
v_mfma_f32_16x16x32_bf16 v[76:79], v[252:255], a[188:191], v[76:79]
s_xor_b32 s71, s14, 0x0
v_mfma_f32_16x16x32_bf16 v[60:63], v[252:255], a[172:175], v[60:63]
s_add_u32 m0, s77, 32768
v_xor_b32 v8, 0x10000, v8
v_mfma_f32_16x16x32_bf16 v[60:63], v[236:239], a[168:171], v[60:63]
s_add_u32 s72, s71, 0
v_xor_b32 v9, 0x10000, v9
v_mfma_f32_16x16x32_bf16 v[60:63], v[220:223], a[164:167], v[60:63]
s_waitcnt vmcnt(32) lgkmcnt(0)
buffer_load_dwordx4 v15, s[24:27], s72 offen lds
v_xor_b32 v10, 0x10000, v10
v_mfma_f32_16x16x32_bf16 v[60:63], v[204:207], a[160:163], v[60:63]
s_barrier
v_xor_b32 v11, 0x10000, v11
v_mfma_f32_16x16x32_bf16 v[48:51], v[128:131], a[192:195], v[48:51]
s_nop 0
ds_read_b64_tr_b16 v[192:193], v8 offset:0
ds_read_b64_tr_b16 v[194:195], v8 offset:2048
v_mfma_f32_16x16x32_bf16 v[48:51], v[144:147], a[196:199], v[48:51]
buffer_store_dwordx4 v[28:31], v1, s[44:47], s80 offen offset:3072 sc1
v_mfma_f32_16x16x32_bf16 v[48:51], v[160:163], a[200:203], v[48:51]
s_nop 0
ds_read_b64_tr_b16 v[196:197], v9 offset:0
ds_read_b64_tr_b16 v[198:199], v9 offset:2048
v_mfma_f32_16x16x32_bf16 v[48:51], v[176:179], a[204:207], v[48:51]
s_add_u32 s72, s71, 15360
buffer_load_dwordx4 v15, s[24:27], s72 offen offset:1024 lds
v_mfma_f32_16x16x32_bf16 v[64:67], v[176:179], a[220:223], v[64:67]
s_nop 0
ds_read_b64_tr_b16 v[200:201], v10 offset:0
ds_read_b64_tr_b16 v[202:203], v10 offset:2048
v_mfma_f32_16x16x32_bf16 v[64:67], v[160:163], a[216:219], v[64:67]
v_mfma_f32_16x16x32_bf16 v[64:67], v[144:147], a[212:215], v[64:67]
s_nop 0
ds_read_b64_tr_b16 v[204:205], v11 offset:0
ds_read_b64_tr_b16 v[206:207], v11 offset:2048
v_mfma_f32_16x16x32_bf16 v[64:67], v[128:131], a[208:211], v[64:67]
s_nop 0
ds_read_b64_tr_b16 v[208:209], v8 offset:4096
ds_read_b64_tr_b16 v[210:211], v8 offset:6144
v_mfma_f32_16x16x32_bf16 v[68:71], v[132:135], a[208:211], v[68:71]
s_nop 0
ds_read_b64_tr_b16 v[212:213], v9 offset:4096
ds_read_b64_tr_b16 v[214:215], v9 offset:6144
v_mfma_f32_16x16x32_bf16 v[68:71], v[148:151], a[212:215], v[68:71]
s_add_u32 s72, s71, 30720
buffer_load_dwordx4 v15, s[24:27], s72 offen offset:2048 lds
v_mfma_f32_16x16x32_bf16 v[68:71], v[164:167], a[216:219], v[68:71]
v_mfma_f32_16x16x32_bf16 v[68:71], v[180:183], a[220:223], v[68:71]
s_nop 0
ds_read_b64_tr_b16 v[216:217], v10 offset:4096
ds_read_b64_tr_b16 v[218:219], v10 offset:6144
v_mfma_f32_16x16x32_bf16 v[52:55], v[180:183], a[204:207], v[52:55]
s_nop 0
ds_read_b64_tr_b16 v[220:221], v11 offset:4096
ds_read_b64_tr_b16 v[222:223], v11 offset:6144
v_mfma_f32_16x16x32_bf16 v[52:55], v[164:167], a[200:203], v[52:55]
v_mfma_f32_16x16x32_bf16 v[52:55], v[148:151], a[196:199], v[52:55]
s_nop 0
ds_read_b64_tr_b16 v[224:225], v8 offset:8192
ds_read_b64_tr_b16 v[226:227], v8 offset:10240
v_mfma_f32_16x16x32_bf16 v[52:55], v[132:135], a[192:195], v[52:55]
s_add_u32 s72, s71, 46080
buffer_load_dwordx4 v15, s[24:27], s72 offen offset:3072 lds
v_mfma_f32_16x16x32_bf16 v[56:59], v[136:139], a[192:195], v[56:59]
s_nop 0
ds_read_b64_tr_b16 v[228:229], v9 offset:8192
ds_read_b64_tr_b16 v[230:231], v9 offset:10240
v_mfma_f32_16x16x32_bf16 v[56:59], v[152:155], a[196:199], v[56:59]
s_nop 0
ds_read_b64_tr_b16 v[232:233], v10 offset:8192
ds_read_b64_tr_b16 v[234:235], v10 offset:10240
v_mfma_f32_16x16x32_bf16 v[56:59], v[168:171], a[200:203], v[56:59]
v_mfma_f32_16x16x32_bf16 v[56:59], v[184:187], a[204:207], v[56:59]
s_nop 0
ds_read_b64_tr_b16 v[236:237], v11 offset:8192
ds_read_b64_tr_b16 v[238:239], v11 offset:10240
v_mfma_f32_16x16x32_bf16 v[72:75], v[184:187], a[220:223], v[72:75]
s_nop 0
ds_read_b64_tr_b16 v[240:241], v8 offset:12288
ds_read_b64_tr_b16 v[242:243], v8 offset:14336
v_mfma_f32_16x16x32_bf16 v[72:75], v[168:171], a[216:219], v[72:75]
s_nop 0
ds_read_b64_tr_b16 v[244:245], v9 offset:12288
ds_read_b64_tr_b16 v[246:247], v9 offset:14336
v_mfma_f32_16x16x32_bf16 v[72:75], v[152:155], a[212:215], v[72:75]
Lstube3:
s_cbranch_execz Lrete
v_mfma_f32_16x16x32_bf16 v[72:75], v[136:139], a[208:211], v[72:75]
s_xor_b32 s71, s15, 0x0
ds_read_b64_tr_b16 v[248:249], v10 offset:12288
ds_read_b64_tr_b16 v[250:251], v10 offset:14336
v_mfma_f32_16x16x32_bf16 v[76:79], v[140:143], a[208:211], v[76:79]
s_add_u32 m0, s77, 49152
ds_read_b64_tr_b16 v[252:253], v11 offset:12288
ds_read_b64_tr_b16 v[254:255], v11 offset:14336
v_mfma_f32_16x16x32_bf16 v[76:79], v[156:159], a[212:215], v[76:79]
s_add_u32 s72, s71, 0
buffer_load_dwordx4 v15, s[24:27], s72 offen lds
v_mfma_f32_16x16x32_bf16 v[76:79], v[172:175], a[216:219], v[76:79]
v_mfma_f32_16x16x32_bf16 v[76:79], v[188:191], a[220:223], v[76:79]
v_mfma_f32_16x16x32_bf16 v[60:63], v[188:191], a[204:207], v[60:63]
v_mfma_f32_16x16x32_bf16 v[60:63], v[172:175], a[200:203], v[60:63]
s_add_u32 s72, s71, 15360
v_mfma_f32_16x16x32_bf16 v[60:63], v[156:159], a[196:199], v[60:63]
s_waitcnt vmcnt(31) lgkmcnt(0)
v_mfma_f32_16x16x32_bf16 v[60:63], v[140:143], a[192:195], v[60:63]
s_barrier
buffer_load_dwordx4 v15, s[24:27], s72 offen offset:1024 lds
v_mfma_f32_16x16x32_bf16 v[48:51], v[192:195], a[224:227], v[48:51]
s_nop 0
ds_read_b64_tr_b16 v[128:129], v8 offset:16384
ds_read_b64_tr_b16 v[130:131], v8 offset:18432
v_mfma_f32_16x16x32_bf16 v[48:51], v[208:211], a[228:231], v[48:51]
s_nop 0
ds_read_b64_tr_b16 v[132:133], v9 offset:16384
ds_read_b64_tr_b16 v[134:135], v9 offset:18432
v_mfma_f32_16x16x32_bf16 v[48:51], v[224:227], a[232:235], v[48:51]
s_nop 0
ds_read_b64_tr_b16 v[136:137], v10 offset:16384
ds_read_b64_tr_b16 v[138:139], v10 offset:18432
v_mfma_f32_16x16x32_bf16 v[48:51], v[240:243], a[236:239], v[48:51]
v_mfma_f32_16x16x32_bf16 v[52:55], v[244:247], a[236:239], v[52:55]
s_nop 0
ds_read_b64_tr_b16 v[140:141], v11 offset:16384
ds_read_b64_tr_b16 v[142:143], v11 offset:18432
v_mfma_f32_16x16x32_bf16 v[52:55], v[228:231], a[232:235], v[52:55]
s_add_u32 s72, s71, 30720
buffer_load_dwordx4 v15, s[24:27], s72 offen offset:2048 lds
v_mfma_f32_16x16x32_bf16 v[52:55], v[212:215], a[228:231], v[52:55]
s_nop 0
ds_read_b64_tr_b16 v[144:145], v8 offset:20480
ds_read_b64_tr_b16 v[146:147], v8 offset:22528
v_mfma_f32_16x16x32_bf16 v[52:55], v[196:199], a[224:227], v[52:55]
s_nop 0
ds_read_b64_tr_b16 v[148:149], v9 offset:20480
ds_read_b64_tr_b16 v[150:151], v9 offset:22528
v_mfma_f32_16x16x32_bf16 v[56:59], v[200:203], a[224:227], v[56:59]
v_mfma_f32_16x16x32_bf16 v[56:59], v[216:219], a[228:231], v[56:59]
s_nop 0
ds_read_b64_tr_b16 v[152:153], v10 offset:20480
ds_read_b64_tr_b16 v[154:155], v10 offset:22528
v_mfma_f32_16x16x32_bf16 v[56:59], v[232:235], a[232:235], v[56:59]
s_nop 0
ds_read_b64_tr_b16 v[156:157], v11 offset:20480
ds_read_b64_tr_b16 v[158:159], v11 offset:22528
v_mfma_f32_16x16x32_bf16 v[56:59], v[248:251], a[236:239], v[56:59]
s_add_u32 s72, s71, 46080
buffer_load_dwordx4 v15, s[24:27], s72 offen offset:3072 lds
v_cvt_pk_bf16_f32 v48, v48, v49
v_mfma_f32_16x16x32_bf16 v[60:63], v[252:255], a[236:239], v[60:63]
v_cvt_pk_bf16_f32 v49, v50, v51
v_cvt_pk_bf16_f32 v50, v52, v53
v_cvt_pk_bf16_f32 v51, v54, v55
v_mfma_f32_16x16x32_bf16 v[60:63], v[236:239], a[232:235], v[60:63]
s_nop 0
ds_read_b64_tr_b16 v[160:161], v8 offset:24576
ds_read_b64_tr_b16 v[162:163], v8 offset:26624
v_mfma_f32_16x16x32_bf16 v[60:63], v[220:223], a[228:231], v[60:63]
s_nop 0
ds_read_b64_tr_b16 v[164:165], v9 offset:24576
ds_read_b64_tr_b16 v[166:167], v9 offset:26624
v_mfma_f32_16x16x32_bf16 v[60:63], v[204:207], a[224:227], v[60:63]
s_nop 0
ds_read_b64_tr_b16 v[168:169], v10 offset:24576
ds_read_b64_tr_b16 v[170:171], v10 offset:26624
v_mfma_f32_16x16x32_bf16 v[64:67], v[192:195], a[240:243], v[64:67]
s_xor_b32 s80, s93, 0x100000
v_mfma_f32_16x16x32_bf16 v[64:67], v[208:211], a[244:247], v[64:67]
s_add_u32 s80, s80, 0x3e00000
buffer_store_dwordx4 v[48:51], v1, s[44:47], s80 offen sc1
v_mfma_f32_16x16x32_bf16 v[64:67], v[224:227], a[248:251], v[64:67]
s_nop 0
ds_read_b64_tr_b16 v[172:173], v11 offset:24576
ds_read_b64_tr_b16 v[174:175], v11 offset:26624
v_mfma_f32_16x16x32_bf16 v[64:67], v[240:243], a[252:255], v[64:67]
s_xor_b32 s71, s12, 0x400000
ds_read_b64_tr_b16 v[176:177], v8 offset:28672
ds_read_b64_tr_b16 v[178:179], v8 offset:30720
v_cvt_pk_bf16_f32 v52, v56, v57
v_mfma_f32_16x16x32_bf16 v[68:71], v[244:247], a[252:255], v[68:71]
s_add_u32 m0, s85, 0
ds_read_b64_tr_b16 v[180:181], v9 offset:28672
ds_read_b64_tr_b16 v[182:183], v9 offset:30720
v_cvt_pk_bf16_f32 v53, v58, v59
v_mfma_f32_16x16x32_bf16 v[68:71], v[228:231], a[248:251], v[68:71]
s_add_u32 s72, s71, 0
buffer_load_dwordx4 v15, s[24:27], s72 offen lds
v_cvt_pk_bf16_f32 v54, v60, v61
v_mfma_f32_16x16x32_bf16 v[68:71], v[212:215], a[244:247], v[68:71]
v_cvt_pk_bf16_f32 v55, v62, v63
v_mfma_f32_16x16x32_bf16 v[68:71], v[196:199], a[240:243], v[68:71]
s_nop 0
ds_read_b64_tr_b16 v[184:185], v10 offset:28672
ds_read_b64_tr_b16 v[186:187], v10 offset:30720
v_mfma_f32_16x16x32_bf16 v[72:75], v[200:203], a[240:243], v[72:75]
s_nop 0
ds_read_b64_tr_b16 v[188:189], v11 offset:28672
ds_read_b64_tr_b16 v[190:191], v11 offset:30720
v_mfma_f32_16x16x32_bf16 v[72:75], v[216:219], a[244:247], v[72:75]
v_mfma_f32_16x16x32_bf16 v[72:75], v[232:235], a[248:251], v[72:75]
s_add_u32 s72, s71, 15360
buffer_load_dwordx4 v15, s[24:27], s72 offen offset:1024 lds
v_mfma_f32_16x16x32_bf16 v[72:75], v[248:251], a[252:255], v[72:75]
v_cvt_pk_bf16_f32 v56, v64, v65
v_cvt_pk_bf16_f32 v57, v66, v67
v_cvt_pk_bf16_f32 v58, v68, v69
v_mfma_f32_16x16x32_bf16 v[76:79], v[252:255], a[252:255], v[76:79]
v_cvt_pk_bf16_f32 v59, v70, v71
v_mfma_f32_16x16x32_bf16 v[76:79], v[236:239], a[248:251], v[76:79]
v_mfma_f32_16x16x32_bf16 v[76:79], v[220:223], a[244:247], v[76:79]
s_waitcnt vmcnt(29) lgkmcnt(0)
v_mfma_f32_16x16x32_bf16 v[76:79], v[204:207], a[240:243], v[76:79]
s_barrier
v_mfma_f32_16x16x32_bf16 v[80:83], v[128:131], a[160:163], v[80:83]
s_add_u32 s72, s71, 30720
buffer_load_dwordx4 v15, s[24:27], s72 offen offset:2048 lds
v_mfma_f32_16x16x32_bf16 v[80:83], v[144:147], a[164:167], v[80:83]
s_waitcnt vmcnt(23)
buffer_store_dwordx4 v[52:55], v1, s[44:47], s80 offen offset:1024 sc1
v_mfma_f32_16x16x32_bf16 v[80:83], v[160:163], a[168:171], v[80:83]
s_nop 0
ds_read_b64_tr_b16 v[192:193], v8 offset:32768
ds_read_b64_tr_b16 v[194:195], v8 offset:34816
v_mfma_f32_16x16x32_bf16 v[80:83], v[176:179], a[172:175], v[80:83]
s_nop 0
ds_read_b64_tr_b16 v[196:197], v9 offset:32768
ds_read_b64_tr_b16 v[198:199], v9 offset:34816
v_cvt_pk_bf16_f32 v60, v72, v73
v_mfma_f32_16x16x32_bf16 v[96:99], v[176:179], a[188:191], v[96:99]
s_nop 0
ds_read_b64_tr_b16 v[200:201], v10 offset:32768
ds_read_b64_tr_b16 v[202:203], v10 offset:34816
v_cvt_pk_bf16_f32 v61, v74, v75
v_mfma_f32_16x16x32_bf16 v[96:99], v[160:163], a[184:187], v[96:99]
s_nop 0
ds_read_b64_tr_b16 v[204:205], v11 offset:32768
ds_read_b64_tr_b16 v[206:207], v11 offset:34816
v_cvt_pk_bf16_f32 v62, v76, v77
v_mfma_f32_16x16x32_bf16 v[96:99], v[144:147], a[180:183], v[96:99]
s_add_u32 s72, s71, 46080
buffer_load_dwordx4 v15, s[24:27], s72 offen offset:3072 lds
v_cvt_pk_bf16_f32 v63, v78, v79
v_mfma_f32_16x16x32_bf16 v[96:99], v[128:131], a[176:179], v[96:99]
v_sub_f32 v112, 1.0, v6
v_sub_f32 v113, 1.0, v7
v_mfma_f32_16x16x32_bf16 v[100:103], v[132:135], a[176:179], v[100:103]
s_nop 0
ds_read_b64_tr_b16 v[208:209], v8 offset:36864
ds_read_b64_tr_b16 v[210:211], v8 offset:38912
v_mfma_f32_16x16x32_bf16 v[100:103], v[148:151], a[180:183], v[100:103]
s_nop 0
ds_read_b64_tr_b16 v[212:213], v9 offset:36864
ds_read_b64_tr_b16 v[214:215], v9 offset:38912
v_mfma_f32_16x16x32_bf16 v[100:103], v[164:167], a[184:187], v[100:103]
s_nop 0
ds_read_b64_tr_b16 v[216:217], v10 offset:36864
ds_read_b64_tr_b16 v[218:219], v10 offset:38912
v_mfma_f32_16x16x32_bf16 v[100:103], v[180:183], a[188:191], v[100:103]
v_mfma_f32_16x16x32_bf16 v[84:87], v[180:183], a[172:175], v[84:87]
s_nop 0
ds_read_b64_tr_b16 v[220:221], v11 offset:36864
ds_read_b64_tr_b16 v[222:223], v11 offset:38912
v_mfma_f32_16x16x32_bf16 v[84:87], v[164:167], a[168:171], v[84:87]
s_nop 0
ds_read_b64_tr_b16 v[224:225], v8 offset:40960
ds_read_b64_tr_b16 v[226:227], v8 offset:43008
v_mfma_f32_16x16x32_bf16 v[84:87], v[148:151], a[164:167], v[84:87]
s_xor_b32 s71, s13, 0x400000
ds_read_b64_tr_b16 v[228:229], v9 offset:40960
ds_read_b64_tr_b16 v[230:231], v9 offset:43008
v_mfma_f32_16x16x32_bf16 v[84:87], v[132:135], a[160:163], v[84:87]
s_add_u32 m0, s85, 16384
v_mfma_f32_16x16x32_bf16 v[88:91], v[136:139], a[160:163], v[88:91]
s_add_u32 s72, s71, 0
buffer_load_dwordx4 v15, s[24:27], s72 offen lds
v_mfma_f32_16x16x32_bf16 v[88:91], v[152:155], a[164:167], v[88:91]
buffer_store_dwordx4 v[56:59], v1, s[44:47], s80 offen offset:2048 sc1
v_mfma_f32_16x16x32_bf16 v[88:91], v[168:171], a[168:171], v[88:91]
s_nop 0
ds_read_b64_tr_b16 v[232:233], v10 offset:40960
ds_read_b64_tr_b16 v[234:235], v10 offset:43008
v_mfma_f32_16x16x32_bf16 v[88:91], v[184:187], a[172:175], v[88:91]
s_nop 0
ds_read_b64_tr_b16 v[236:237], v11 offset:40960
ds_read_b64_tr_b16 v[238:239], v11 offset:43008
v_mfma_f32_16x16x32_bf16 v[104:107], v[184:187], a[188:191], v[104:107]
s_nop 0
ds_read_b64_tr_b16 v[240:241], v8 offset:45056
ds_read_b64_tr_b16 v[242:243], v8 offset:47104
v_mfma_f32_16x16x32_bf16 v[104:107], v[168:171], a[184:187], v[104:107]
v_mfma_f32_16x16x32_bf16 v[104:107], v[152:155], a[180:183], v[104:107]
s_add_u32 s72, s71, 15360
buffer_load_dwordx4 v15, s[24:27], s72 offen offset:1024 lds
v_mfma_f32_16x16x32_bf16 v[104:107], v[136:139], a[176:179], v[104:107]
s_nop 0
ds_read_b64_tr_b16 v[244:245], v9 offset:45056
ds_read_b64_tr_b16 v[246:247], v9 offset:47104
v_mfma_f32_16x16x32_bf16 v[108:111], v[140:143], a[176:179], v[108:111]
s_nop 0
ds_read_b64_tr_b16 v[248:249], v10 offset:45056
ds_read_b64_tr_b16 v[250:251], v10 offset:47104
v_mfma_f32_16x16x32_bf16 v[108:111], v[156:159], a[180:183], v[108:111]
s_nop 0
ds_read_b64_tr_b16 v[252:253], v11 offset:45056
ds_read_b64_tr_b16 v[254:255], v11 offset:47104
v_mfma_f32_16x16x32_bf16 v[108:111], v[172:175], a[184:187], v[108:111]
v_mfma_f32_16x16x32_bf16 v[108:111], v[188:191], a[188:191], v[108:111]
v_mfma_f32_16x16x32_bf16 v[92:95], v[188:191], a[172:175], v[92:95]
s_add_u32 s72, s71, 30720
buffer_load_dwordx4 v15, s[24:27], s72 offen offset:2048 lds
v_mfma_f32_16x16x32_bf16 v[92:95], v[172:175], a[168:171], v[92:95]
v_mfma_f32_16x16x32_bf16 v[92:95], v[156:159], a[164:167], v[92:95]
s_waitcnt vmcnt(32) lgkmcnt(0)
v_mfma_f32_16x16x32_bf16 v[92:95], v[140:143], a[160:163], v[92:95]
s_barrier
v_mfma_f32_16x16x32_bf16 v[80:83], v[192:195], a[192:195], v[80:83]
s_nop 0
ds_read_b64_tr_b16 v[128:129], v8 offset:49152
ds_read_b64_tr_b16 v[130:131], v8 offset:51200
v_mfma_f32_16x16x32_bf16 v[80:83], v[208:211], a[196:199], v[80:83]
buffer_store_dwordx4 v[60:63], v1, s[44:47], s80 offen offset:3072 sc1
v_mfma_f32_16x16x32_bf16 v[80:83], v[224:227], a[200:203], v[80:83]
s_add_u32 s72, s71, 46080
buffer_load_dwordx4 v15, s[24:27], s72 offen offset:3072 lds
v_mfma_f32_16x16x32_bf16 v[80:83], v[240:243], a[204:207], v[80:83]
s_nop 0
ds_read_b64_tr_b16 v[132:133], v9 offset:49152
ds_read_b64_tr_b16 v[134:135], v9 offset:51200
v_mfma_f32_16x16x32_bf16 v[96:99], v[240:243], a[220:223], v[96:99]
s_nop 0
ds_read_b64_tr_b16 v[136:137], v10 offset:49152
ds_read_b64_tr_b16 v[138:139], v10 offset:51200
v_mfma_f32_16x16x32_bf16 v[96:99], v[224:227], a[216:219], v[96:99]
s_nop 0
ds_read_b64 v[48:49], v116 offset:0
ds_read_b64_tr_b16 v[64:65], v5 offset:0
v_mfma_f32_16x16x32_bf16 v[96:99], v[208:211], a[212:215], v[96:99]
s_nop 0
ds_read_b64_tr_b16 v[140:141], v11 offset:49152
ds_read_b64_tr_b16 v[142:143], v11 offset:51200
v_mfma_f32_16x16x32_bf16 v[96:99], v[192:195], a[208:211], v[96:99]
s_nop 0
ds_read_b64_tr_b16 v[144:145], v8 offset:53248
ds_read_b64_tr_b16 v[146:147], v8 offset:55296
v_mfma_f32_16x16x32_bf16 v[100:103], v[196:199], a[208:211], v[100:103]
s_nop 0
ds_read_b64_tr_b16 v[148:149], v9 offset:53248
ds_read_b64_tr_b16 v[150:151], v9 offset:55296
v_mfma_f32_16x16x32_bf16 v[100:103], v[212:215], a[212:215], v[100:103]
s_nop 0
ds_read_b64 v[50:51], v117 offset:0
ds_read_b64_tr_b16 v[66:67], v5 offset:4096
v_mfma_f32_16x16x32_bf16 v[100:103], v[228:231], a[216:219], v[100:103]
s_xor_b32 s71, s14, 0x400000
ds_read_b64_tr_b16 v[152:153], v10 offset:53248
ds_read_b64_tr_b16 v[154:155], v10 offset:55296
v_mfma_f32_16x16x32_bf16 v[100:103], v[244:247], a[220:223], v[100:103]
s_add_u32 m0, s85, 32768
ds_read_b64_tr_b16 v[156:157], v11 offset:53248
ds_read_b64_tr_b16 v[158:159], v11 offset:55296
v_mfma_f32_16x16x32_bf16 v[84:87], v[244:247], a[204:207], v[84:87]
s_add_u32 s72, s71, 0
buffer_load_dwordx4 v15, s[24:27], s72 offen lds
v_mfma_f32_16x16x32_bf16 v[84:87], v[228:231], a[200:203], v[84:87]
s_nop 0
ds_read_b64 v[52:53], v118 offset:0
ds_read_b64_tr_b16 v[68:69], v5 offset:8192
v_mfma_f32_16x16x32_bf16 v[84:87], v[212:215], a[196:199], v[84:87]
s_nop 0
ds_read_b64_tr_b16 v[160:161], v8 offset:57344
ds_read_b64_tr_b16 v[162:163], v8 offset:59392
v_mfma_f32_16x16x32_bf16 v[84:87], v[196:199], a[192:195], v[84:87]
s_nop 0
ds_read_b64_tr_b16 v[164:165], v9 offset:57344
ds_read_b64_tr_b16 v[166:167], v9 offset:59392
v_mfma_f32_16x16x32_bf16 v[88:91], v[200:203], a[192:195], v[88:91]
s_nop 0
ds_read_b64_tr_b16 v[168:169], v10 offset:57344
ds_read_b64_tr_b16 v[170:171], v10 offset:59392
v_mfma_f32_16x16x32_bf16 v[88:91], v[216:219], a[196:199], v[88:91]
s_add_u32 s72, s71, 15360
buffer_load_dwordx4 v15, s[24:27], s72 offen offset:1024 lds
v_mfma_f32_16x16x32_bf16 v[88:91], v[232:235], a[200:203], v[88:91]
s_nop 0
ds_read_b64 v[54:55], v119 offset:0
ds_read_b64_tr_b16 v[70:71], v5 offset:12288
v_mfma_f32_16x16x32_bf16 v[88:91], v[248:251], a[204:207], v[88:91]
s_nop 0
ds_read_b64_tr_b16 v[172:173], v11 offset:57344
ds_read_b64_tr_b16 v[174:175], v11 offset:59392
v_mfma_f32_16x16x32_bf16 v[104:107], v[248:251], a[220:223], v[104:107]
s_nop 0
ds_read_b64_tr_b16 v[176:177], v8 offset:61440
ds_read_b64_tr_b16 v[178:179], v8 offset:63488
v_mfma_f32_16x16x32_bf16 v[104:107], v[232:235], a[216:219], v[104:107]
s_nop 0
ds_read_b64_tr_b16 v[180:181], v9 offset:61440
ds_read_b64_tr_b16 v[182:183], v9 offset:63488
v_mfma_f32_16x16x32_bf16 v[104:107], v[216:219], a[212:215], v[104:107]
v_xor_b32 v5, 16, v5
v_mfma_f32_16x16x32_bf16 v[104:107], v[200:203], a[208:211], v[104:107]
s_add_u32 s72, s71, 30720
buffer_load_dwordx4 v15, s[24:27], s72 offen offset:2048 lds
v_mfma_f32_16x16x32_bf16 v[108:111], v[204:207], a[208:211], v[108:111]
s_nop 0
ds_read_b64_tr_b16 v[184:185], v10 offset:61440
ds_read_b64_tr_b16 v[186:187], v10 offset:63488
v_mfma_f32_16x16x32_bf16 v[108:111], v[220:223], a[212:215], v[108:111]
s_nop 0
ds_read_b64_tr_b16 v[188:189], v11 offset:61440
ds_read_b64_tr_b16 v[190:191], v11 offset:63488
v_mfma_f32_16x16x32_bf16 v[108:111], v[236:239], a[216:219], v[108:111]
s_nop 0
ds_read_b64 v[56:57], v116 offset:2048
ds_read_b64_tr_b16 v[72:73], v5 offset:0
v_mfma_f32_16x16x32_bf16 v[108:111], v[252:255], a[220:223], v[108:111]
s_nop 0
ds_read_b64 v[58:59], v117 offset:2048
ds_read_b64_tr_b16 v[74:75], v5 offset:4096
v_mfma_f32_16x16x32_bf16 v[92:95], v[252:255], a[204:207], v[92:95]
ds_read_b64 v[60:61], v118 offset:2048
v_xor_b32 v8, 0x10000, v8
v_mfma_f32_16x16x32_bf16 v[92:95], v[236:239], a[200:203], v[92:95]
s_add_u32 s72, s71, 46080
buffer_load_dwordx4 v15, s[24:27], s72 offen offset:3072 lds
v_xor_b32 v9, 0x10000, v9
v_mfma_f32_16x16x32_bf16 v[92:95], v[220:223], a[196:199], v[92:95]
s_waitcnt vmcnt(31) lgkmcnt(0)
ds_read_b64_tr_b16 v[76:77], v5 offset:8192
v_xor_b32 v10, 0x10000, v10
v_mfma_f32_16x16x32_bf16 v[92:95], v[204:207], a[192:195], v[92:95]
s_barrier
ds_read_b64 v[62:63], v119 offset:2048
v_xor_b32 v11, 0x10000, v11
v_mfma_f32_16x16x32_bf16 v[80:83], v[128:131], a[224:227], v[80:83]
s_nop 0
ds_read_b64_tr_b16 v[192:193], v8 offset:0
ds_read_b64_tr_b16 v[194:195], v8 offset:2048
v_mfma_f32_16x16x32_bf16 v[80:83], v[144:147], a[228:231], v[80:83]
s_nop 0
ds_read_b64_tr_b16 v[196:197], v9 offset:0
ds_read_b64_tr_b16 v[198:199], v9 offset:2048
v_mfma_f32_16x16x32_bf16 v[80:83], v[160:163], a[232:235], v[80:83]
s_nop 0
ds_read_b64_tr_b16 v[200:201], v10 offset:0
ds_read_b64_tr_b16 v[202:203], v10 offset:2048
v_mfma_f32_16x16x32_bf16 v[80:83], v[176:179], a[236:239], v[80:83]
ds_read_b64_tr_b16 v[78:79], v5 offset:12288
v_mfma_f32_16x16x32_bf16 v[84:87], v[180:183], a[236:239], v[84:87]
s_nop 0
ds_read_b64_tr_b16 v[204:205], v11 offset:0
ds_read_b64_tr_b16 v[206:207], v11 offset:2048
v_mfma_f32_16x16x32_bf16 v[84:87], v[164:167], a[232:235], v[84:87]
s_xor_b32 s71, s15, 0x400000
ds_read_b64_tr_b16 v[208:209], v8 offset:4096
ds_read_b64_tr_b16 v[210:211], v8 offset:6144
v_mfma_f32_16x16x32_bf16 v[84:87], v[148:151], a[228:231], v[84:87]
s_add_u32 m0, s85, 49152
ds_read_b64_tr_b16 v[212:213], v9 offset:4096
ds_read_b64_tr_b16 v[214:215], v9 offset:6144
v_mfma_f32_16x16x32_bf16 v[84:87], v[132:135], a[224:227], v[84:87]
s_add_u32 s72, s71, 0
buffer_load_dwordx4 v15, s[24:27], s72 offen lds
v_mfma_f32_16x16x32_bf16 v[88:91], v[136:139], a[224:227], v[88:91]
v_mfma_f32_16x16x32_bf16 v[88:91], v[152:155], a[228:231], v[88:91]
s_waitcnt lgkmcnt(6)
ds_read_b64_tr_b16 v[216:217], v10 offset:4096
ds_read_b64_tr_b16 v[218:219], v10 offset:6144
v_mfma_f32_16x16x32_bf16 v[88:91], v[168:171], a[232:235], v[88:91]
s_nop 0
ds_read_b64_tr_b16 v[220:221], v11 offset:4096
ds_read_b64_tr_b16 v[222:223], v11 offset:6144
v_mfma_f32_16x16x32_bf16 v[88:91], v[184:187], a[236:239], v[88:91]
v_cvt_pk_bf16_f32 v80, v80, v81
v_cvt_pk_bf16_f32 v81, v82, v83
v_cvt_pk_bf16_f32 v82, v84, v85
v_mfma_f32_16x16x32_bf16 v[92:95], v[188:191], a[236:239], v[92:95]
s_nop 0
ds_read_b64_tr_b16 v[224:225], v8 offset:8192
ds_read_b64_tr_b16 v[226:227], v8 offset:10240
v_cvt_pk_bf16_f32 v83, v86, v87
v_mfma_f32_16x16x32_bf16 v[92:95], v[172:175], a[232:235], v[92:95]
s_add_u32 s72, s71, 15360
buffer_load_dwordx4 v15, s[24:27], s72 offen offset:1024 lds
v_mfma_f32_16x16x32_bf16 v[92:95], v[156:159], a[228:231], v[92:95]
s_nop 0
ds_read_b64_tr_b16 v[228:229], v9 offset:8192
ds_read_b64_tr_b16 v[230:231], v9 offset:10240
v_mfma_f32_16x16x32_bf16 v[92:95], v[140:143], a[224:227], v[92:95]
s_nop 0
ds_read_b64_tr_b16 v[232:233], v10 offset:8192
ds_read_b64_tr_b16 v[234:235], v10 offset:10240
v_mfma_f32_16x16x32_bf16 v[96:99], v[128:131], a[240:243], v[96:99]
s_xor_b32 s80, s93, 0x180000
v_and_b32 v114, 0xffff0000, v48
v_lshlrev_b32 v115, 16, v64
v_mfma_f32_16x16x32_bf16 v[96:99], v[144:147], a[244:247], v[96:99]
s_add_u32 s80, s80, 0x4200000
buffer_store_dwordx4 v[80:83], v1, s[44:47], s80 offen sc1
v_mfma_f32_16x16x32_bf16 v[96:99], v[160:163], a[248:251], v[96:99]
s_nop 0
ds_read_b64_tr_b16 v[236:237], v11 offset:8192
ds_read_b64_tr_b16 v[238:239], v11 offset:10240
v_mfma_f32_16x16x32_bf16 v[96:99], v[176:179], a[252:255], v[96:99]
s_add_u32 s72, s71, 30720
buffer_load_dwordx4 v15, s[24:27], s72 offen offset:2048 lds
v_cvt_pk_bf16_f32 v84, v88, v89
v_mfma_f32_16x16x32_bf16 v[100:103], v[180:183], a[252:255], v[100:103]
s_nop 0
ds_read_b64_tr_b16 v[240:241], v8 offset:12288
ds_read_b64_tr_b16 v[242:243], v8 offset:14336
v_cvt_pk_bf16_f32 v85, v90, v91
v_mfma_f32_16x16x32_bf16 v[100:103], v[164:167], a[248:251], v[100:103]
s_nop 0
ds_read_b64_tr_b16 v[244:245], v9 offset:12288
ds_read_b64_tr_b16 v[246:247], v9 offset:14336
v_cvt_pk_bf16_f32 v86, v92, v93
v_mfma_f32_16x16x32_bf16 v[100:103], v[148:151], a[244:247], v[100:103]
v_cvt_pk_bf16_f32 v87, v94, v95
v_lshlrev_b32 v48, 16, v48
v_mfma_f32_16x16x32_bf16 v[100:103], v[132:135], a[240:243], v[100:103]
s_nop 0
ds_read_b64_tr_b16 v[248:249], v10 offset:12288
ds_read_b64_tr_b16 v[250:251], v10 offset:14336
v_mfma_f32_16x16x32_bf16 v[104:107], v[136:139], a[240:243], v[104:107]
s_nop 0
ds_read_b64_tr_b16 v[252:253], v11 offset:12288
ds_read_b64_tr_b16 v[254:255], v11 offset:14336
v_mfma_f32_16x16x32_bf16 v[104:107], v[152:155], a[244:247], v[104:107]
s_add_u32 s72, s71, 46080
buffer_load_dwordx4 v15, s[24:27], s72 offen offset:3072 lds
v_mfma_f32_16x16x32_bf16 v[104:107], v[168:171], a[248:251], v[104:107]
v_and_b32 v64, 0xffff0000, v64
v_mul_f32 v48, v48, v112
v_mfma_f32_16x16x32_bf16 v[104:107], v[184:187], a[252:255], v[104:107]
v_cvt_pk_bf16_f32 v88, v96, v97
v_cvt_pk_bf16_f32 v89, v98, v99
v_cvt_pk_bf16_f32 v90, v100, v101
v_mfma_f32_16x16x32_bf16 v[108:111], v[188:191], a[252:255], v[108:111]
v_cvt_pk_bf16_f32 v91, v102, v103
v_mul_f32 v114, v114, v112
v_mfma_f32_16x16x32_bf16 v[108:111], v[172:175], a[248:251], v[108:111]
v_mul_f32 v48, v48, v115
v_mul_f32 v64, v64, v114
v_mfma_f32_16x16x32_bf16 v[108:111], v[156:159], a[244:247], v[108:111]
s_waitcnt vmcnt(30) lgkmcnt(0)
v_and_b32 v114, 0xffff0000, v49
v_lshlrev_b32 v115, 16, v65
v_mfma_f32_16x16x32_bf16 v[108:111], v[140:143], a[240:243], v[108:111]
s_barrier
v_lshlrev_b32 v49, 16, v49
v_and_b32 v65, 0xffff0000, v65
v_mfma_f32_16x16x32_bf16 v[16:19], v[192:195], a[0:3], 0
s_nop 0
ds_read_b64_tr_b16 v[128:129], v8 offset:16384
ds_read_b64_tr_b16 v[130:131], v8 offset:18432
v_mfma_f32_16x16x32_bf16 v[16:19], v[208:211], a[4:7], v[16:19]
buffer_store_dwordx4 v[84:87], v1, s[44:47], s80 offen offset:1024 sc1
v_mfma_f32_16x16x32_bf16 v[16:19], v[224:227], a[8:11], v[16:19]
s_nop 0
ds_read_b64_tr_b16 v[132:133], v9 offset:16384
ds_read_b64_tr_b16 v[134:135], v9 offset:18432
v_mfma_f32_16x16x32_bf16 v[16:19], v[240:243], a[12:15], v[16:19]
v_cvt_pk_bf16_f32 v92, v104, v105
v_cvt_pk_bf16_f32 v93, v106, v107
v_cvt_pk_bf16_f32 v94, v108, v109
v_mfma_f32_16x16x32_bf16 v[32:35], v[240:243], a[28:31], 0
s_nop 0
ds_read_b64_tr_b16 v[136:137], v10 offset:16384
ds_read_b64_tr_b16 v[138:139], v10 offset:18432
v_cvt_pk_bf16_f32 v95, v110, v111
v_mfma_f32_16x16x32_bf16 v[32:35], v[224:227], a[24:27], v[32:35]
s_nop 0
ds_read_b64_tr_b16 v[140:141], v11 offset:16384
ds_read_b64_tr_b16 v[142:143], v11 offset:18432
v_mfma_f32_16x16x32_bf16 v[32:35], v[208:211], a[20:23], v[32:35]
v_mul_f32 v49, v49, v112
v_mul_f32 v114, v114, v112
v_mfma_f32_16x16x32_bf16 v[32:35], v[192:195], a[16:19], v[32:35]
s_nop 0
ds_read_b64_tr_b16 v[144:145], v8 offset:20480
ds_read_b64_tr_b16 v[146:147], v8 offset:22528
v_mfma_f32_16x16x32_bf16 v[36:39], v[196:199], a[16:19], 0
s_nop 0
ds_read_b64_tr_b16 v[148:149], v9 offset:20480
ds_read_b64_tr_b16 v[150:151], v9 offset:22528
v_mfma_f32_16x16x32_bf16 v[36:39], v[212:215], a[20:23], v[36:39]
v_mul_f32 v49, v49, v115
v_mul_f32 v65, v65, v114
v_mfma_f32_16x16x32_bf16 v[36:39], v[228:231], a[24:27], v[36:39]
s_nop 0
ds_read_b64_tr_b16 v[152:153], v10 offset:20480
ds_read_b64_tr_b16 v[154:155], v10 offset:22528
v_mfma_f32_16x16x32_bf16 v[36:39], v[244:247], a[28:31], v[36:39]
s_nop 0
ds_read_b64_tr_b16 v[156:157], v11 offset:20480
ds_read_b64_tr_b16 v[158:159], v11 offset:22528
v_mfma_f32_16x16x32_bf16 v[20:23], v[244:247], a[12:15], 0
v_and_b32 v114, 0xffff0000, v50
v_lshlrev_b32 v115, 16, v66
v_mfma_f32_16x16x32_bf16 v[20:23], v[228:231], a[8:11], v[20:23]
s_nop 0
ds_read_b64_tr_b16 v[160:161], v8 offset:24576
ds_read_b64_tr_b16 v[162:163], v8 offset:26624
v_mfma_f32_16x16x32_bf16 v[20:23], v[212:215], a[4:7], v[20:23]
v_lshlrev_b32 v50, 16, v50
v_and_b32 v66, 0xffff0000, v66
v_mfma_f32_16x16x32_bf16 v[20:23], v[196:199], a[0:3], v[20:23]
s_nop 0
ds_read_b64_tr_b16 v[164:165], v9 offset:24576
ds_read_b64_tr_b16 v[166:167], v9 offset:26624
v_mfma_f32_16x16x32_bf16 v[24:27], v[200:203], a[0:3], 0
s_nop 0
ds_read_b64_tr_b16 v[168:169], v10 offset:24576
ds_read_b64_tr_b16 v[170:171], v10 offset:26624
v_mfma_f32_16x16x32_bf16 v[24:27], v[216:219], a[4:7], v[24:27]
buffer_store_dwordx4 v[88:91], v1, s[44:47], s80 offen offset:2048 sc1
v_mfma_f32_16x16x32_bf16 v[24:27], v[232:235], a[8:11], v[24:27]
v_mul_f32 v50, v50, v112
v_mul_f32 v114, v114, v112
v_mfma_f32_16x16x32_bf16 v[24:27], v[248:251], a[12:15], v[24:27]
s_nop 0
ds_read_b64_tr_b16 v[172:173], v11 offset:24576
ds_read_b64_tr_b16 v[174:175], v11 offset:26624
v_mfma_f32_16x16x32_bf16 v[40:43], v[248:251], a[28:31], 0
s_nop 0
ds_read_b64_tr_b16 v[176:177], v8 offset:28672
ds_read_b64_tr_b16 v[178:179], v8 offset:30720
v_mfma_f32_16x16x32_bf16 v[40:43], v[232:235], a[24:27], v[40:43]
v_mul_f32 v50, v50, v115
v_mul_f32 v66, v66, v114
v_mfma_f32_16x16x32_bf16 v[40:43], v[216:219], a[20:23], v[40:43]
s_nop 0
ds_read_b64_tr_b16 v[180:181], v9 offset:28672
ds_read_b64_tr_b16 v[182:183], v9 offset:30720
v_mfma_f32_16x16x32_bf16 v[40:43], v[200:203], a[16:19], v[40:43]
s_nop 0
ds_read_b64_tr_b16 v[184:185], v10 offset:28672
ds_read_b64_tr_b16 v[186:187], v10 offset:30720
v_mfma_f32_16x16x32_bf16 v[44:47], v[204:207], a[16:19], 0
v_and_b32 v114, 0xffff0000, v51
v_lshlrev_b32 v115, 16, v67
v_mfma_f32_16x16x32_bf16 v[44:47], v[220:223], a[20:23], v[44:47]
s_nop 0
ds_read_b64_tr_b16 v[188:189], v11 offset:28672
ds_read_b64_tr_b16 v[190:191], v11 offset:30720
v_mfma_f32_16x16x32_bf16 v[44:47], v[236:239], a[24:27], v[44:47]
v_lshlrev_b32 v51, 16, v51
v_and_b32 v67, 0xffff0000, v67
v_mfma_f32_16x16x32_bf16 v[44:47], v[252:255], a[28:31], v[44:47]
v_mul_f32 v51, v51, v112
v_mul_f32 v114, v114, v112
v_mfma_f32_16x16x32_bf16 v[28:31], v[252:255], a[12:15], 0
v_mul_f32 v51, v51, v115
v_mul_f32 v67, v67, v114
v_mfma_f32_16x16x32_bf16 v[28:31], v[236:239], a[8:11], v[28:31]
v_and_b32 v114, 0xffff0000, v52
v_lshlrev_b32 v115, 16, v68
v_mfma_f32_16x16x32_bf16 v[28:31], v[220:223], a[4:7], v[28:31]
s_waitcnt vmcnt(27) lgkmcnt(0)
v_lshlrev_b32 v52, 16, v52
v_and_b32 v68, 0xffff0000, v68
v_mfma_f32_16x16x32_bf16 v[28:31], v[204:207], a[0:3], v[28:31]
Lstube4:
s_cbranch_execz Lrete
s_barrier
v_mul_f32 v52, v52, v112
v_mul_f32 v114, v114, v112
v_mfma_f32_16x16x32_bf16 v[16:19], v[128:131], a[32:35], v[16:19]
s_nop 0
ds_read_b64_tr_b16 v[192:193], v8 offset:32768
ds_read_b64_tr_b16 v[194:195], v8 offset:34816
v_mfma_f32_16x16x32_bf16 v[16:19], v[144:147], a[36:39], v[16:19]
buffer_store_dwordx4 v[92:95], v1, s[44:47], s80 offen offset:3072 sc1
v_mfma_f32_16x16x32_bf16 v[16:19], v[160:163], a[40:43], v[16:19]
s_nop 0
ds_read_b64_tr_b16 v[196:197], v9 offset:32768
ds_read_b64_tr_b16 v[198:199], v9 offset:34816
v_mfma_f32_16x16x32_bf16 v[16:19], v[176:179], a[44:47], v[16:19]
v_mul_f32 v52, v52, v115
v_mul_f32 v68, v68, v114
v_mfma_f32_16x16x32_bf16 v[32:35], v[176:179], a[60:63], v[32:35]
s_nop 0
ds_read_b64_tr_b16 v[200:201], v10 offset:32768
ds_read_b64_tr_b16 v[202:203], v10 offset:34816
v_mfma_f32_16x16x32_bf16 v[32:35], v[160:163], a[56:59], v[32:35]
s_nop 0
ds_read_b64_tr_b16 v[204:205], v11 offset:32768
ds_read_b64_tr_b16 v[206:207], v11 offset:34816
v_mfma_f32_16x16x32_bf16 v[32:35], v[144:147], a[52:55], v[32:35]
v_and_b32 v114, 0xffff0000, v53
v_lshlrev_b32 v115, 16, v69
v_mfma_f32_16x16x32_bf16 v[32:35], v[128:131], a[48:51], v[32:35]
s_nop 0
ds_read_b64_tr_b16 v[208:209], v8 offset:36864
ds_read_b64_tr_b16 v[210:211], v8 offset:38912
v_mfma_f32_16x16x32_bf16 v[36:39], v[132:135], a[48:51], v[36:39]
v_lshlrev_b32 v53, 16, v53
v_and_b32 v69, 0xffff0000, v69
v_mfma_f32_16x16x32_bf16 v[36:39], v[148:151], a[52:55], v[36:39]
s_nop 0
ds_read_b64_tr_b16 v[212:213], v9 offset:36864
ds_read_b64_tr_b16 v[214:215], v9 offset:38912
v_mfma_f32_16x16x32_bf16 v[36:39], v[164:167], a[56:59], v[36:39]
s_nop 0
ds_read_b64_tr_b16 v[216:217], v10 offset:36864
ds_read_b64_tr_b16 v[218:219], v10 offset:38912
v_mfma_f32_16x16x32_bf16 v[36:39], v[180:183], a[60:63], v[36:39]
v_mul_f32 v53, v53, v112
v_mul_f32 v114, v114, v112
v_mfma_f32_16x16x32_bf16 v[20:23], v[180:183], a[44:47], v[20:23]
s_nop 0
ds_read_b64_tr_b16 v[220:221], v11 offset:36864
ds_read_b64_tr_b16 v[222:223], v11 offset:38912
v_mfma_f32_16x16x32_bf16 v[20:23], v[164:167], a[40:43], v[20:23]
v_mul_f32 v53, v53, v115
v_mul_f32 v69, v69, v114
v_mfma_f32_16x16x32_bf16 v[20:23], v[148:151], a[36:39], v[20:23]
s_nop 0
ds_read_b64_tr_b16 v[224:225], v8 offset:40960
ds_read_b64_tr_b16 v[226:227], v8 offset:43008
v_mfma_f32_16x16x32_bf16 v[20:23], v[132:135], a[32:35], v[20:23]
s_nop 0
ds_read_b64_tr_b16 v[228:229], v9 offset:40960
ds_read_b64_tr_b16 v[230:231], v9 offset:43008
v_mfma_f32_16x16x32_bf16 v[24:27], v[136:139], a[32:35], v[24:27]
v_and_b32 v114, 0xffff0000, v54
v_lshlrev_b32 v115, 16, v70
v_mfma_f32_16x16x32_bf16 v[24:27], v[152:155], a[36:39], v[24:27]
s_nop 0
ds_read_b64_tr_b16 v[232:233], v10 offset:40960
ds_read_b64_tr_b16 v[234:235], v10 offset:43008
v_mfma_f32_16x16x32_bf16 v[24:27], v[168:171], a[40:43], v[24:27]
s_nop 0
ds_read_b64_tr_b16 v[236:237], v11 offset:40960
ds_read_b64_tr_b16 v[238:239], v11 offset:43008
v_mfma_f32_16x16x32_bf16 v[24:27], v[184:187], a[44:47], v[24:27]
v_lshlrev_b32 v54, 16, v54
v_and_b32 v70, 0xffff0000, v70
v_mfma_f32_16x16x32_bf16 v[40:43], v[184:187], a[60:63], v[40:43]
s_nop 0
ds_read_b64_tr_b16 v[240:241], v8 offset:45056
ds_read_b64_tr_b16 v[242:243], v8 offset:47104
v_mfma_f32_16x16x32_bf16 v[40:43], v[168:171], a[56:59], v[40:43]
v_mul_f32 v54, v54, v112
v_mul_f32 v114, v114, v112
v_mfma_f32_16x16x32_bf16 v[40:43], v[152:155], a[52:55], v[40:43]
s_nop 0
ds_read_b64_tr_b16 v[244:245], v9 offset:45056
ds_read_b64_tr_b16 v[246:247], v9 offset:47104
v_mfma_f32_16x16x32_bf16 v[40:43], v[136:139], a[48:51], v[40:43]
s_nop 0
ds_read_b64_tr_b16 v[248:249], v10 offset:45056
ds_read_b64_tr_b16 v[250:251], v10 offset:47104
v_mfma_f32_16x16x32_bf16 v[44:47], v[140:143], a[48:51], v[44:47]
v_mul_f32 v54, v54, v115
v_mul_f32 v70, v70, v114
v_mfma_f32_16x16x32_bf16 v[44:47], v[156:159], a[52:55], v[44:47]
s_nop 0
ds_read_b64_tr_b16 v[252:253], v11 offset:45056
ds_read_b64_tr_b16 v[254:255], v11 offset:47104
v_mfma_f32_16x16x32_bf16 v[44:47], v[172:175], a[56:59], v[44:47]
v_and_b32 v114, 0xffff0000, v55
v_lshlrev_b32 v115, 16, v71
v_mfma_f32_16x16x32_bf16 v[44:47], v[188:191], a[60:63], v[44:47]
v_lshlrev_b32 v55, 16, v55
v_and_b32 v71, 0xffff0000, v71
v_mfma_f32_16x16x32_bf16 v[28:31], v[188:191], a[44:47], v[28:31]
v_mul_f32 v55, v55, v112
v_mul_f32 v114, v114, v112
v_mfma_f32_16x16x32_bf16 v[28:31], v[172:175], a[40:43], v[28:31]
s_add_u32 s79, s93, 0x3a00000
v_mul_f32 v55, v55, v115
v_mul_f32 v71, v71, v114
v_mfma_f32_16x16x32_bf16 v[28:31], v[156:159], a[36:39], v[28:31]
s_waitcnt vmcnt(24) lgkmcnt(0)
buffer_load_dwordx4 v[96:99], v1, s[44:47], s79 offen sc1
v_mfma_f32_16x16x32_bf16 v[28:31], v[140:143], a[32:35], v[28:31]
s_barrier
v_and_b32 v114, 0xffff0000, v56
v_lshlrev_b32 v115, 16, v72
v_mfma_f32_16x16x32_bf16 v[16:19], v[192:195], a[64:67], v[16:19]
s_nop 0
ds_read_b64_tr_b16 v[128:129], v8 offset:49152
ds_read_b64_tr_b16 v[130:131], v8 offset:51200
v_mfma_f32_16x16x32_bf16 v[16:19], v[208:211], a[68:71], v[16:19]
s_nop 0
ds_read_b64_tr_b16 v[132:133], v9 offset:49152
ds_read_b64_tr_b16 v[134:135], v9 offset:51200
v_mfma_f32_16x16x32_bf16 v[16:19], v[224:227], a[72:75], v[16:19]
v_lshlrev_b32 v56, 16, v56
v_and_b32 v72, 0xffff0000, v72
v_mfma_f32_16x16x32_bf16 v[16:19], v[240:243], a[76:79], v[16:19]
buffer_load_dwordx4 v[100:103], v1, s[44:47], s79 offen offset:1024 sc1
v_mfma_f32_16x16x32_bf16 v[32:35], v[240:243], a[92:95], v[32:35]
s_nop 0
ds_read_b64_tr_b16 v[136:137], v10 offset:49152
ds_read_b64_tr_b16 v[138:139], v10 offset:51200
v_mfma_f32_16x16x32_bf16 v[32:35], v[224:227], a[88:91], v[32:35]
s_nop 0
ds_read_b64_tr_b16 v[140:141], v11 offset:49152
ds_read_b64_tr_b16 v[142:143], v11 offset:51200
v_mfma_f32_16x16x32_bf16 v[32:35], v[208:211], a[84:87], v[32:35]
v_mul_f32 v56, v56, v113
v_mul_f32 v114, v114, v113
v_mfma_f32_16x16x32_bf16 v[32:35], v[192:195], a[80:83], v[32:35]
s_nop 0
ds_read_b64_tr_b16 v[144:145], v8 offset:53248
ds_read_b64_tr_b16 v[146:147], v8 offset:55296
v_mfma_f32_16x16x32_bf16 v[36:39], v[196:199], a[80:83], v[36:39]
buffer_load_dwordx4 v[104:107], v1, s[44:47], s79 offen offset:2048 sc1
v_mfma_f32_16x16x32_bf16 v[36:39], v[212:215], a[84:87], v[36:39]
s_nop 0
ds_read_b64_tr_b16 v[148:149], v9 offset:53248
ds_read_b64_tr_b16 v[150:151], v9 offset:55296
v_mfma_f32_16x16x32_bf16 v[36:39], v[228:231], a[88:91], v[36:39]
v_mul_f32 v56, v56, v115
v_mul_f32 v72, v72, v114
v_mfma_f32_16x16x32_bf16 v[36:39], v[244:247], a[92:95], v[36:39]
s_nop 0
ds_read_b64_tr_b16 v[152:153], v10 offset:53248
ds_read_b64_tr_b16 v[154:155], v10 offset:55296
v_mfma_f32_16x16x32_bf16 v[20:23], v[244:247], a[76:79], v[20:23]
s_nop 0
ds_read_b64_tr_b16 v[156:157], v11 offset:53248
ds_read_b64_tr_b16 v[158:159], v11 offset:55296
v_mfma_f32_16x16x32_bf16 v[20:23], v[228:231], a[72:75], v[20:23]
buffer_load_dwordx4 v[108:111], v1, s[44:47], s79 offen offset:3072 sc1
v_mfma_f32_16x16x32_bf16 v[20:23], v[212:215], a[68:71], v[20:23]
v_and_b32 v114, 0xffff0000, v57
v_lshlrev_b32 v115, 16, v73
v_mfma_f32_16x16x32_bf16 v[20:23], v[196:199], a[64:67], v[20:23]
s_nop 0
ds_read_b64_tr_b16 v[160:161], v8 offset:57344
ds_read_b64_tr_b16 v[162:163], v8 offset:59392
v_mfma_f32_16x16x32_bf16 v[24:27], v[200:203], a[64:67], v[24:27]
s_nop 0
ds_read_b64_tr_b16 v[164:165], v9 offset:57344
ds_read_b64_tr_b16 v[166:167], v9 offset:59392
v_mfma_f32_16x16x32_bf16 v[24:27], v[216:219], a[68:71], v[24:27]
v_lshlrev_b32 v57, 16, v57
v_and_b32 v73, 0xffff0000, v73
v_mfma_f32_16x16x32_bf16 v[24:27], v[232:235], a[72:75], v[24:27]
s_nop 0
ds_read_b64_tr_b16 v[168:169], v10 offset:57344
ds_read_b64_tr_b16 v[170:171], v10 offset:59392
v_mfma_f32_16x16x32_bf16 v[24:27], v[248:251], a[76:79], v[24:27]
s_nop 0
ds_read_b64_tr_b16 v[172:173], v11 offset:57344
ds_read_b64_tr_b16 v[174:175], v11 offset:59392
v_mfma_f32_16x16x32_bf16 v[40:43], v[248:251], a[92:95], v[40:43]
v_mul_f32 v57, v57, v113
v_mul_f32 v114, v114, v113
v_mfma_f32_16x16x32_bf16 v[40:43], v[232:235], a[88:91], v[40:43]
s_nop 0
ds_read_b64_tr_b16 v[176:177], v8 offset:61440
ds_read_b64_tr_b16 v[178:179], v8 offset:63488
v_mfma_f32_16x16x32_bf16 v[40:43], v[216:219], a[84:87], v[40:43]
s_nop 0
ds_read_b64_tr_b16 v[180:181], v9 offset:61440
ds_read_b64_tr_b16 v[182:183], v9 offset:63488
v_mfma_f32_16x16x32_bf16 v[40:43], v[200:203], a[80:83], v[40:43]
v_mul_f32 v57, v57, v115
v_mul_f32 v73, v73, v114
v_mfma_f32_16x16x32_bf16 v[44:47], v[204:207], a[80:83], v[44:47]
s_nop 0
ds_read_b64_tr_b16 v[184:185], v10 offset:61440
ds_read_b64_tr_b16 v[186:187], v10 offset:63488
v_mfma_f32_16x16x32_bf16 v[44:47], v[220:223], a[84:87], v[44:47]
s_nop 0
ds_read_b64_tr_b16 v[188:189], v11 offset:61440
ds_read_b64_tr_b16 v[190:191], v11 offset:63488
v_mfma_f32_16x16x32_bf16 v[44:47], v[236:239], a[88:91], v[44:47]
v_and_b32 v114, 0xffff0000, v58
v_lshlrev_b32 v115, 16, v74
v_mfma_f32_16x16x32_bf16 v[44:47], v[252:255], a[92:95], v[44:47]
v_lshlrev_b32 v58, 16, v58
v_and_b32 v74, 0xffff0000, v74
v_mfma_f32_16x16x32_bf16 v[28:31], v[252:255], a[76:79], v[28:31]
v_xor_b32 v8, 0x10000, v8
v_mul_f32 v58, v58, v113
v_mfma_f32_16x16x32_bf16 v[28:31], v[236:239], a[72:75], v[28:31]
v_xor_b32 v9, 0x10000, v9
v_mul_f32 v114, v114, v113
v_mfma_f32_16x16x32_bf16 v[28:31], v[220:223], a[68:71], v[28:31]
s_waitcnt vmcnt(22) lgkmcnt(0)
v_xor_b32 v10, 0x10000, v10
v_mul_f32 v58, v58, v115
v_mfma_f32_16x16x32_bf16 v[28:31], v[204:207], a[64:67], v[28:31]
s_barrier
v_xor_b32 v11, 0x10000, v11
v_mul_f32 v74, v74, v114
v_mfma_f32_16x16x32_bf16 v[16:19], v[128:131], a[96:99], v[16:19]
s_nop 0
ds_read_b64_tr_b16 v[192:193], v8 offset:0
ds_read_b64_tr_b16 v[194:195], v8 offset:2048
v_mfma_f32_16x16x32_bf16 v[16:19], v[144:147], a[100:103], v[16:19]
s_nop 0
ds_read_b64_tr_b16 v[196:197], v9 offset:0
ds_read_b64_tr_b16 v[198:199], v9 offset:2048
v_mfma_f32_16x16x32_bf16 v[16:19], v[160:163], a[104:107], v[16:19]
v_and_b32 v114, 0xffff0000, v59
v_lshlrev_b32 v115, 16, v75
v_mfma_f32_16x16x32_bf16 v[16:19], v[176:179], a[108:111], v[16:19]
s_nop 0
ds_read_b64_tr_b16 v[200:201], v10 offset:0
ds_read_b64_tr_b16 v[202:203], v10 offset:2048
v_mfma_f32_16x16x32_bf16 v[32:35], v[176:179], a[124:127], v[32:35]
v_lshlrev_b32 v59, 16, v59
v_and_b32 v75, 0xffff0000, v75
v_mfma_f32_16x16x32_bf16 v[32:35], v[160:163], a[120:123], v[32:35]
s_nop 0
ds_read_b64_tr_b16 v[204:205], v11 offset:0
ds_read_b64_tr_b16 v[206:207], v11 offset:2048
v_mfma_f32_16x16x32_bf16 v[32:35], v[144:147], a[116:119], v[32:35]
s_nop 0
ds_read_b64_tr_b16 v[208:209], v8 offset:4096
ds_read_b64_tr_b16 v[210:211], v8 offset:6144
v_mfma_f32_16x16x32_bf16 v[32:35], v[128:131], a[112:115], v[32:35]
v_mul_f32 v59, v59, v113
v_mul_f32 v114, v114, v113
v_mfma_f32_16x16x32_bf16 v[36:39], v[132:135], a[112:115], v[36:39]
s_nop 0
ds_read_b64_tr_b16 v[212:213], v9 offset:4096
ds_read_b64_tr_b16 v[214:215], v9 offset:6144
v_mfma_f32_16x16x32_bf16 v[36:39], v[148:151], a[116:119], v[36:39]
v_mul_f32 v59, v59, v115
v_mul_f32 v75, v75, v114
v_mfma_f32_16x16x32_bf16 v[36:39], v[164:167], a[120:123], v[36:39]
s_nop 0
ds_read_b64_tr_b16 v[216:217], v10 offset:4096
ds_read_b64_tr_b16 v[218:219], v10 offset:6144
v_mfma_f32_16x16x32_bf16 v[36:39], v[180:183], a[124:127], v[36:39]
s_nop 0
ds_read_b64_tr_b16 v[220:221], v11 offset:4096
ds_read_b64_tr_b16 v[222:223], v11 offset:6144
v_mfma_f32_16x16x32_bf16 v[20:23], v[180:183], a[108:111], v[20:23]
v_and_b32 v114, 0xffff0000, v60
v_lshlrev_b32 v115, 16, v76
v_mfma_f32_16x16x32_bf16 v[20:23], v[164:167], a[104:107], v[20:23]
s_nop 0
ds_read_b64_tr_b16 v[224:225], v8 offset:8192
ds_read_b64_tr_b16 v[226:227], v8 offset:10240
v_mfma_f32_16x16x32_bf16 v[20:23], v[148:151], a[100:103], v[20:23]
v_lshlrev_b32 v60, 16, v60
v_and_b32 v76, 0xffff0000, v76
v_mfma_f32_16x16x32_bf16 v[20:23], v[132:135], a[96:99], v[20:23]
s_nop 0
ds_read_b64_tr_b16 v[228:229], v9 offset:8192
ds_read_b64_tr_b16 v[230:231], v9 offset:10240
v_mfma_f32_16x16x32_bf16 v[24:27], v[136:139], a[96:99], v[24:27]
s_nop 0
ds_read_b64_tr_b16 v[232:233], v10 offset:8192
ds_read_b64_tr_b16 v[234:235], v10 offset:10240
v_mfma_f32_16x16x32_bf16 v[24:27], v[152:155], a[100:103], v[24:27]
v_mul_f32 v60, v60, v113
v_mul_f32 v114, v114, v113
v_mfma_f32_16x16x32_bf16 v[24:27], v[168:171], a[104:107], v[24:27]
s_nop 0
ds_read_b64_tr_b16 v[236:237], v11 offset:8192
ds_read_b64_tr_b16 v[238:239], v11 offset:10240
v_mfma_f32_16x16x32_bf16 v[24:27], v[184:187], a[108:111], v[24:27]
v_mul_f32 v60, v60, v115
v_mul_f32 v76, v76, v114
v_mfma_f32_16x16x32_bf16 v[40:43], v[184:187], a[124:127], v[40:43]
s_nop 0
ds_read_b64_tr_b16 v[240:241], v8 offset:12288
ds_read_b64_tr_b16 v[242:243], v8 offset:14336
v_mfma_f32_16x16x32_bf16 v[40:43], v[168:171], a[120:123], v[40:43]
s_nop 0
ds_read_b64_tr_b16 v[244:245], v9 offset:12288
ds_read_b64_tr_b16 v[246:247], v9 offset:14336
v_mfma_f32_16x16x32_bf16 v[40:43], v[152:155], a[116:119], v[40:43]
v_and_b32 v114, 0xffff0000, v61
v_lshlrev_b32 v115, 16, v77
v_mfma_f32_16x16x32_bf16 v[40:43], v[136:139], a[112:115], v[40:43]
s_nop 0
ds_read_b64_tr_b16 v[248:249], v10 offset:12288
ds_read_b64_tr_b16 v[250:251], v10 offset:14336
v_mfma_f32_16x16x32_bf16 v[44:47], v[140:143], a[112:115], v[44:47]
v_lshlrev_b32 v61, 16, v61
v_and_b32 v77, 0xffff0000, v77
v_mfma_f32_16x16x32_bf16 v[44:47], v[156:159], a[116:119], v[44:47]
s_nop 0
ds_read_b64_tr_b16 v[252:253], v11 offset:12288
ds_read_b64_tr_b16 v[254:255], v11 offset:14336
v_mfma_f32_16x16x32_bf16 v[44:47], v[172:175], a[120:123], v[44:47]
v_mul_f32 v61, v61, v113
v_mul_f32 v114, v114, v113
v_mfma_f32_16x16x32_bf16 v[44:47], v[188:191], a[124:127], v[44:47]
s_waitcnt vmcnt(0)
v_max3_u32 v12, v96, v97, v98
v_max3_u32 v13, v99, v100, v101
v_mfma_f32_16x16x32_bf16 v[28:31], v[188:191], a[108:111], v[28:31]
v_max3_u32 v12, v12, v102, v103
v_max3_u32 v13, v13, v104, v105
v_mfma_f32_16x16x32_bf16 v[28:31], v[172:175], a[104:107], v[28:31]
v_max3_u32 v12, v12, v106, v107
v_max3_u32 v13, v13, v108, v109
v_mfma_f32_16x16x32_bf16 v[28:31], v[156:159], a[100:103], v[28:31]
s_waitcnt vmcnt(16) lgkmcnt(0)
v_max3_u32 v12, v12, v110, v111
v_mul_f32 v61, v61, v115
v_mfma_f32_16x16x32_bf16 v[28:31], v[140:143], a[96:99], v[28:31]
s_barrier
v_max_u32 v12, v12, v13
v_mul_f32 v77, v77, v114
v_mfma_f32_16x16x32_bf16 v[16:19], v[192:195], a[128:131], v[16:19]
v_cmp_le_u32 vcc, 0xff800000, v12
v_and_b32 v114, 0xffff0000, v62
v_mfma_f32_16x16x32_bf16 v[16:19], v[208:211], a[132:135], v[16:19]
s_nop 0
ds_read_b64_tr_b16 v[128:129], v8 offset:16384
ds_read_b64_tr_b16 v[130:131], v8 offset:18432
v_mfma_f32_16x16x32_bf16 v[16:19], v[224:227], a[136:139], v[16:19]
s_cbranch_vccnz Lxspin1
Lxback1:
ds_read_b64_tr_b16 v[132:133], v9 offset:16384
ds_read_b64_tr_b16 v[134:135], v9 offset:18432
v_mfma_f32_16x16x32_bf16 v[16:19], v[240:243], a[140:143], v[16:19]
v_lshlrev_b32 v115, 16, v78
v_lshlrev_b32 v62, 16, v62
v_mfma_f32_16x16x32_bf16 v[16:19], v[124:127], v[96:99], v[16:19]
s_nop 0
ds_read_b64_tr_b16 v[136:137], v10 offset:16384
ds_read_b64_tr_b16 v[138:139], v10 offset:18432
v_mfma_f32_16x16x32_bf16 v[32:35], v[240:243], a[156:159], v[32:35]
v_and_b32 v78, 0xffff0000, v78
v_mul_f32 v62, v62, v113
v_mfma_f32_16x16x32_bf16 v[32:35], v[224:227], a[152:155], v[32:35]
s_add_u32 s82, s93, 0x3e00000
buffer_load_dwordx4 v[80:83], v1, s[44:47], s82 offen sc1
v_mfma_f32_16x16x32_bf16 v[32:35], v[208:211], a[148:151], v[32:35]
s_nop 0
ds_read_b64_tr_b16 v[140:141], v11 offset:16384
ds_read_b64_tr_b16 v[142:143], v11 offset:18432
v_mfma_f32_16x16x32_bf16 v[32:35], v[192:195], a[144:147], v[32:35]
v_mul_f32 v114, v114, v113
v_mul_f32 v62, v62, v115
v_mfma_f32_16x16x32_bf16 v[32:35], v[124:127], v[104:107], v[32:35]
s_nop 0
ds_read_b64_tr_b16 v[144:145], v8 offset:20480
ds_read_b64_tr_b16 v[146:147], v8 offset:22528
v_mfma_f32_16x16x32_bf16 v[36:39], v[196:199], a[144:147], v[36:39]
v_mul_f32 v78, v78, v114
v_and_b32 v114, 0xffff0000, v63
v_mfma_f32_16x16x32_bf16 v[36:39], v[212:215], a[148:151], v[36:39]
buffer_load_dwordx4 v[84:87], v1, s[44:47], s82 offen offset:1024 sc1
v_mfma_f32_16x16x32_bf16 v[36:39], v[228:231], a[152:155], v[36:39]
s_nop 0
ds_read_b64_tr_b16 v[148:149], v9 offset:20480
ds_read_b64_tr_b16 v[150:151], v9 offset:22528
v_mfma_f32_16x16x32_bf16 v[36:39], v[244:247], a[156:159], v[36:39]
v_lshlrev_b32 v115, 16, v79
v_lshlrev_b32 v63, 16, v63
v_mfma_f32_16x16x32_bf16 v[36:39], v[120:123], v[104:107], v[36:39]
s_nop 0
ds_read_b64_tr_b16 v[152:153], v10 offset:20480
ds_read_b64_tr_b16 v[154:155], v10 offset:22528
v_mfma_f32_16x16x32_bf16 v[20:23], v[244:247], a[140:143], v[20:23]
v_and_b32 v79, 0xffff0000, v79
v_mul_f32 v63, v63, v113
v_mfma_f32_16x16x32_bf16 v[20:23], v[228:231], a[136:139], v[20:23]
buffer_load_dwordx4 v[88:91], v1, s[44:47], s82 offen offset:2048 sc1
v_mfma_f32_16x16x32_bf16 v[20:23], v[212:215], a[132:135], v[20:23]
s_nop 0
ds_read_b64_tr_b16 v[156:157], v11 offset:20480
ds_read_b64_tr_b16 v[158:159], v11 offset:22528
v_mfma_f32_16x16x32_bf16 v[20:23], v[196:199], a[128:131], v[20:23]
v_mul_f32 v114, v114, v113
v_mul_f32 v63, v63, v115
v_mfma_f32_16x16x32_bf16 v[20:23], v[120:123], v[96:99], v[20:23]
s_nop 0
ds_read_b64_tr_b16 v[160:161], v8 offset:24576
ds_read_b64_tr_b16 v[162:163], v8 offset:26624
v_mfma_f32_16x16x32_bf16 v[24:27], v[200:203], a[128:131], v[24:27]
s_nop 0
ds_read_b64_tr_b16 v[164:165], v9 offset:24576
ds_read_b64_tr_b16 v[166:167], v9 offset:26624
v_mfma_f32_16x16x32_bf16 v[24:27], v[216:219], a[132:135], v[24:27]
buffer_load_dwordx4 v[92:95], v1, s[44:47], s82 offen offset:3072 sc1
v_mfma_f32_16x16x32_bf16 v[24:27], v[232:235], a[136:139], v[24:27]
v_mul_f32 v79, v79, v114
v_mfma_f32_16x16x32_bf16 v[24:27], v[248:251], a[140:143], v[24:27]
s_nop 0
ds_read_b64_tr_b16 v[168:169], v10 offset:24576
ds_read_b64_tr_b16 v[170:171], v10 offset:26624
v_mfma_f32_16x16x32_bf16 v[24:27], v[124:127], v[100:103], v[24:27]
v_mfma_f32_16x16x32_bf16 v[40:43], v[248:251], a[156:159], v[40:43]
s_nop 0
ds_read_b64_tr_b16 v[172:173], v11 offset:24576
ds_read_b64_tr_b16 v[174:175], v11 offset:26624
v_mfma_f32_16x16x32_bf16 v[40:43], v[232:235], a[152:155], v[40:43]
v_mfma_f32_16x16x32_bf16 v[40:43], v[216:219], a[148:151], v[40:43]
s_nop 0
ds_read_b64_tr_b16 v[176:177], v8 offset:28672
ds_read_b64_tr_b16 v[178:179], v8 offset:30720
v_mfma_f32_16x16x32_bf16 v[40:43], v[200:203], a[144:147], v[40:43]
v_mfma_f32_16x16x32_bf16 v[40:43], v[124:127], v[108:111], v[40:43]
s_nop 0
ds_read_b64_tr_b16 v[180:181], v9 offset:28672
ds_read_b64_tr_b16 v[182:183], v9 offset:30720
v_mfma_f32_16x16x32_bf16 v[44:47], v[204:207], a[144:147], v[44:47]
v_mfma_f32_16x16x32_bf16 v[44:47], v[220:223], a[148:151], v[44:47]
s_nop 0
ds_read_b64_tr_b16 v[184:185], v10 offset:28672
ds_read_b64_tr_b16 v[186:187], v10 offset:30720
v_mfma_f32_16x16x32_bf16 v[44:47], v[236:239], a[152:155], v[44:47]
v_mfma_f32_16x16x32_bf16 v[44:47], v[252:255], a[156:159], v[44:47]
s_nop 0
ds_read_b64_tr_b16 v[188:189], v11 offset:28672
ds_read_b64_tr_b16 v[190:191], v11 offset:30720
v_mfma_f32_16x16x32_bf16 v[44:47], v[120:123], v[108:111], v[44:47]
v_mfma_f32_16x16x32_bf16 v[28:31], v[252:255], a[140:143], v[28:31]
v_mfma_f32_16x16x32_bf16 v[28:31], v[236:239], a[136:139], v[28:31]
v_mfma_f32_16x16x32_bf16 v[28:31], v[220:223], a[132:135], v[28:31]
v_mfma_f32_16x16x32_bf16 v[28:31], v[204:207], a[128:131], v[28:31]
s_waitcnt vmcnt(16) lgkmcnt(0)
v_mfma_f32_16x16x32_bf16 v[28:31], v[120:123], v[100:103], v[28:31]
s_barrier
v_mfma_f32_16x16x32_bf16 v[16:19], v[128:131], a[160:163], v[16:19]
s_nop 0
ds_read_b64_tr_b16 v[192:193], v8 offset:32768
ds_read_b64_tr_b16 v[194:195], v8 offset:34816
v_mfma_f32_16x16x32_bf16 v[16:19], v[144:147], a[164:167], v[16:19]
s_nop 0
ds_read_b64_tr_b16 v[196:197], v9 offset:32768
ds_read_b64_tr_b16 v[198:199], v9 offset:34816
v_mfma_f32_16x16x32_bf16 v[16:19], v[160:163], a[168:171], v[16:19]
s_nop 0
ds_read_b64_tr_b16 v[200:201], v10 offset:32768
ds_read_b64_tr_b16 v[202:203], v10 offset:34816
v_mfma_f32_16x16x32_bf16 v[16:19], v[176:179], a[172:175], v[16:19]
v_mfma_f32_16x16x32_bf16 v[32:35], v[176:179], a[188:191], v[32:35]
s_nop 0
ds_read_b64_tr_b16 v[204:205], v11 offset:32768
ds_read_b64_tr_b16 v[206:207], v11 offset:34816
v_mfma_f32_16x16x32_bf16 v[32:35], v[160:163], a[184:187], v[32:35]
s_nop 0
ds_read_b64_tr_b16 v[208:209], v8 offset:36864
ds_read_b64_tr_b16 v[210:211], v8 offset:38912
v_mfma_f32_16x16x32_bf16 v[32:35], v[144:147], a[180:183], v[32:35]
s_add_u32 s81, s93, 0x4200000
buffer_load_dwordx4 v[96:99], v1, s[44:47], s81 offen sc1
v_mfma_f32_16x16x32_bf16 v[32:35], v[128:131], a[176:179], v[32:35]
v_mfma_f32_16x16x32_bf16 v[36:39], v[132:135], a[176:179], v[36:39]
s_nop 0
ds_read_b64_tr_b16 v[212:213], v9 offset:36864
ds_read_b64_tr_b16 v[214:215], v9 offset:38912
v_mfma_f32_16x16x32_bf16 v[36:39], v[148:151], a[180:183], v[36:39]
s_nop 0
ds_read_b64_tr_b16 v[216:217], v10 offset:36864
ds_read_b64_tr_b16 v[218:219], v10 offset:38912
v_mfma_f32_16x16x32_bf16 v[36:39], v[164:167], a[184:187], v[36:39]
v_mfma_f32_16x16x32_bf16 v[36:39], v[180:183], a[188:191], v[36:39]
buffer_load_dwordx4 v[100:103], v1, s[44:47], s81 offen offset:1024 sc1
v_mfma_f32_16x16x32_bf16 v[20:23], v[180:183], a[172:175], v[20:23]
s_nop 0
ds_read_b64_tr_b16 v[220:221], v11 offset:36864
ds_read_b64_tr_b16 v[222:223], v11 offset:38912
v_mfma_f32_16x16x32_bf16 v[20:23], v[164:167], a[168:171], v[20:23]
s_nop 0
ds_read_b64_tr_b16 v[224:225], v8 offset:40960
ds_read_b64_tr_b16 v[226:227], v8 offset:43008
v_mfma_f32_16x16x32_bf16 v[20:23], v[148:151], a[164:167], v[20:23]
s_nop 0
ds_read_b64_tr_b16 v[228:229], v9 offset:40960
ds_read_b64_tr_b16 v[230:231], v9 offset:43008
v_mfma_f32_16x16x32_bf16 v[20:23], v[132:135], a[160:163], v[20:23]
v_mfma_f32_16x16x32_bf16 v[24:27], v[136:139], a[160:163], v[24:27]
buffer_load_dwordx4 v[104:107], v1, s[44:47], s81 offen offset:2048 sc1
v_mfma_f32_16x16x32_bf16 v[24:27], v[152:155], a[164:167], v[24:27]
s_nop 0
ds_read_b64_tr_b16 v[232:233], v10 offset:40960
ds_read_b64_tr_b16 v[234:235], v10 offset:43008
v_mfma_f32_16x16x32_bf16 v[24:27], v[168:171], a[168:171], v[24:27]
s_nop 0
ds_read_b64_tr_b16 v[236:237], v11 offset:40960
ds_read_b64_tr_b16 v[238:239], v11 offset:43008
v_mfma_f32_16x16x32_bf16 v[24:27], v[184:187], a[172:175], v[24:27]
v_mfma_f32_16x16x32_bf16 v[40:43], v[184:187], a[188:191], v[40:43]
s_nop 0
ds_read_b64_tr_b16 v[240:241], v8 offset:45056
ds_read_b64_tr_b16 v[242:243], v8 offset:47104
v_mfma_f32_16x16x32_bf16 v[40:43], v[168:171], a[184:187], v[40:43]
buffer_load_dwordx4 v[108:111], v1, s[44:47], s81 offen offset:3072 sc1
v_mfma_f32_16x16x32_bf16 v[40:43], v[152:155], a[180:183], v[40:43]
s_nop 0
ds_read_b64_tr_b16 v[244:245], v9 offset:45056
ds_read_b64_tr_b16 v[246:247], v9 offset:47104
v_mfma_f32_16x16x32_bf16 v[40:43], v[136:139], a[176:179], v[40:43]
v_mfma_f32_16x16x32_bf16 v[44:47], v[140:143], a[176:179], v[44:47]
s_nop 0
ds_read_b64_tr_b16 v[248:249], v10 offset:45056
ds_read_b64_tr_b16 v[250:251], v10 offset:47104
v_mfma_f32_16x16x32_bf16 v[44:47], v[156:159], a[180:183], v[44:47]
s_nop 0
ds_read_b64_tr_b16 v[252:253], v11 offset:45056
ds_read_b64_tr_b16 v[254:255], v11 offset:47104
v_mfma_f32_16x16x32_bf16 v[44:47], v[172:175], a[184:187], v[44:47]
v_mfma_f32_16x16x32_bf16 v[44:47], v[188:191], a[188:191], v[44:47]
s_waitcnt vmcnt(4)
v_max3_u32 v12, v80, v81, v82
v_max3_u32 v13, v83, v84, v85
v_mfma_f32_16x16x32_bf16 v[28:31], v[188:191], a[172:175], v[28:31]
v_max3_u32 v12, v12, v86, v87
v_max3_u32 v13, v13, v88, v89
v_mfma_f32_16x16x32_bf16 v[28:31], v[172:175], a[168:171], v[28:31]
v_max3_u32 v12, v12, v90, v91
v_max3_u32 v13, v13, v92, v93
v_mfma_f32_16x16x32_bf16 v[28:31], v[156:159], a[164:167], v[28:31]
s_waitcnt vmcnt(15) lgkmcnt(0)
v_max3_u32 v12, v12, v94, v95
v_mfma_f32_16x16x32_bf16 v[28:31], v[140:143], a[160:163], v[28:31]
s_barrier
v_max_u32 v12, v12, v13
v_mfma_f32_16x16x32_bf16 v[16:19], v[192:195], a[192:195], v[16:19]
v_cmp_le_u32 vcc, 0xff800000, v12
v_mfma_f32_16x16x32_bf16 v[16:19], v[208:211], a[196:199], v[16:19]
s_nop 0
ds_read_b64_tr_b16 v[128:129], v8 offset:49152
ds_read_b64_tr_b16 v[130:131], v8 offset:51200
v_mfma_f32_16x16x32_bf16 v[16:19], v[224:227], a[200:203], v[16:19]
s_cbranch_vccnz Lxspin2
Lxback2:
v_mfma_f32_16x16x32_bf16 v[16:19], v[240:243], a[204:207], v[16:19]
s_nop 0
ds_read_b64_tr_b16 v[132:133], v9 offset:49152
ds_read_b64_tr_b16 v[134:135], v9 offset:51200
v_mfma_f32_16x16x32_bf16 v[16:19], v[124:127], v[80:83], v[16:19]
v_mfma_f32_16x16x32_bf16 v[32:35], v[240:243], a[220:223], v[32:35]
s_nop 0
ds_read_b64_tr_b16 v[136:137], v10 offset:49152
ds_read_b64_tr_b16 v[138:139], v10 offset:51200
v_mfma_f32_16x16x32_bf16 v[32:35], v[224:227], a[216:219], v[32:35]
v_mfma_f32_16x16x32_bf16 v[32:35], v[208:211], a[212:215], v[32:35]
s_nop 0
ds_read_b64_tr_b16 v[140:141], v11 offset:49152
ds_read_b64_tr_b16 v[142:143], v11 offset:51200
v_mfma_f32_16x16x32_bf16 v[32:35], v[192:195], a[208:211], v[32:35]
v_mfma_f32_16x16x32_bf16 v[32:35], v[124:127], v[88:91], v[32:35]
s_nop 0
ds_read_b64_tr_b16 v[144:145], v8 offset:53248
ds_read_b64_tr_b16 v[146:147], v8 offset:55296
v_mfma_f32_16x16x32_bf16 v[36:39], v[196:199], a[208:211], v[36:39]
v_mfma_f32_16x16x32_bf16 v[36:39], v[212:215], a[212:215], v[36:39]
s_nop 0
ds_read_b64_tr_b16 v[148:149], v9 offset:53248
ds_read_b64_tr_b16 v[150:151], v9 offset:55296
v_mfma_f32_16x16x32_bf16 v[36:39], v[228:231], a[216:219], v[36:39]
v_mfma_f32_16x16x32_bf16 v[36:39], v[244:247], a[220:223], v[36:39]
s_nop 0
ds_read_b64_tr_b16 v[152:153], v10 offset:53248
ds_read_b64_tr_b16 v[154:155], v10 offset:55296
v_mfma_f32_16x16x32_bf16 v[36:39], v[120:123], v[88:91], v[36:39]
v_mfma_f32_16x16x32_bf16 v[20:23], v[244:247], a[204:207], v[20:23]
s_nop 0
ds_read_b64_tr_b16 v[156:157], v11 offset:53248
ds_read_b64_tr_b16 v[158:159], v11 offset:55296
v_mfma_f32_16x16x32_bf16 v[20:23], v[228:231], a[200:203], v[20:23]
v_mfma_f32_16x16x32_bf16 v[20:23], v[212:215], a[196:199], v[20:23]
v_mfma_f32_16x16x32_bf16 v[20:23], v[196:199], a[192:195], v[20:23]
s_nop 0
ds_read_b64_tr_b16 v[160:161], v8 offset:57344
ds_read_b64_tr_b16 v[162:163], v8 offset:59392
v_mfma_f32_16x16x32_bf16 v[20:23], v[120:123], v[80:83], v[20:23]
v_mfma_f32_16x16x32_bf16 v[24:27], v[200:203], a[192:195], v[24:27]
s_nop 0
ds_read_b64_tr_b16 v[164:165], v9 offset:57344
ds_read_b64_tr_b16 v[166:167], v9 offset:59392
v_mfma_f32_16x16x32_bf16 v[24:27], v[216:219], a[196:199], v[24:27]
v_mfma_f32_16x16x32_bf16 v[24:27], v[232:235], a[200:203], v[24:27]
s_nop 0
ds_read_b64_tr_b16 v[168:169], v10 offset:57344
ds_read_b64_tr_b16 v[170:171], v10 offset:59392
v_mfma_f32_16x16x32_bf16 v[24:27], v[248:251], a[204:207], v[24:27]
v_mfma_f32_16x16x32_bf16 v[24:27], v[124:127], v[84:87], v[24:27]
s_nop 0
ds_read_b64_tr_b16 v[172:173], v11 offset:57344
ds_read_b64_tr_b16 v[174:175], v11 offset:59392
v_mfma_f32_16x16x32_bf16 v[40:43], v[248:251], a[220:223], v[40:43]
v_mfma_f32_16x16x32_bf16 v[40:43], v[232:235], a[216:219], v[40:43]
s_nop 0
ds_read_b64_tr_b16 v[176:177], v8 offset:61440
ds_read_b64_tr_b16 v[178:179], v8 offset:63488
v_mfma_f32_16x16x32_bf16 v[40:43], v[216:219], a[212:215], v[40:43]
v_mfma_f32_16x16x32_bf16 v[40:43], v[200:203], a[208:211], v[40:43]
s_nop 0
ds_read_b64_tr_b16 v[180:181], v9 offset:61440
ds_read_b64_tr_b16 v[182:183], v9 offset:63488
v_mfma_f32_16x16x32_bf16 v[40:43], v[124:127], v[92:95], v[40:43]
v_mfma_f32_16x16x32_bf16 v[44:47], v[204:207], a[208:211], v[44:47]
s_nop 0
ds_read_b64_tr_b16 v[184:185], v10 offset:61440
ds_read_b64_tr_b16 v[186:187], v10 offset:63488
v_mfma_f32_16x16x32_bf16 v[44:47], v[220:223], a[212:215], v[44:47]
v_mfma_f32_16x16x32_bf16 v[44:47], v[236:239], a[216:219], v[44:47]
s_nop 0
ds_read_b64_tr_b16 v[188:189], v11 offset:61440
ds_read_b64_tr_b16 v[190:191], v11 offset:63488
v_mfma_f32_16x16x32_bf16 v[44:47], v[252:255], a[220:223], v[44:47]
v_mfma_f32_16x16x32_bf16 v[44:47], v[120:123], v[92:95], v[44:47]
v_mfma_f32_16x16x32_bf16 v[28:31], v[252:255], a[204:207], v[28:31]
s_waitcnt vmcnt(0)
v_max3_u32 v12, v96, v97, v98
v_max3_u32 v13, v99, v100, v101
v_mfma_f32_16x16x32_bf16 v[28:31], v[236:239], a[200:203], v[28:31]
v_max3_u32 v12, v12, v102, v103
v_max3_u32 v13, v13, v104, v105
v_mfma_f32_16x16x32_bf16 v[28:31], v[220:223], a[196:199], v[28:31]
v_max3_u32 v12, v12, v106, v107
v_max3_u32 v13, v13, v108, v109
v_mfma_f32_16x16x32_bf16 v[28:31], v[204:207], a[192:195], v[28:31]
s_waitcnt lgkmcnt(0)
v_max3_u32 v12, v12, v110, v111
v_mfma_f32_16x16x32_bf16 v[28:31], v[120:123], v[84:87], v[28:31]
v_max_u32 v12, v12, v13
v_mfma_f32_16x16x32_bf16 v[16:19], v[128:131], a[224:227], v[16:19]
v_cmp_le_u32 vcc, 0xff800000, v12
v_mfma_f32_16x16x32_bf16 v[16:19], v[144:147], a[228:231], v[16:19]
v_mfma_f32_16x16x32_bf16 v[16:19], v[160:163], a[232:235], v[16:19]
s_cbranch_vccnz Lxspin3
Lxback3:
v_mfma_f32_16x16x32_bf16 v[16:19], v[176:179], a[236:239], v[16:19]
v_mfma_f32_16x16x32_bf16 v[16:19], v[124:127], v[96:99], v[16:19]
v_mfma_f32_16x16x32_bf16 v[20:23], v[180:183], a[236:239], v[20:23]
v_mfma_f32_16x16x32_bf16 v[20:23], v[164:167], a[232:235], v[20:23]
v_mfma_f32_16x16x32_bf16 v[20:23], v[148:151], a[228:231], v[20:23]
v_mfma_f32_16x16x32_bf16 v[20:23], v[132:135], a[224:227], v[20:23]
s_nop 3
v_fma_f32 v16, v16, v6, v48
v_fma_f32 v17, v17, v6, v64
v_mfma_f32_16x16x32_bf16 v[20:23], v[120:123], v[96:99], v[20:23]
v_fma_f32 v18, v18, v6, v49
v_fma_f32 v19, v19, v6, v65
v_mfma_f32_16x16x32_bf16 v[24:27], v[136:139], a[224:227], v[24:27]
v_cvt_pk_bf16_f32 v16, v16, v17
v_cvt_pk_bf16_f32 v17, v18, v19
v_mfma_f32_16x16x32_bf16 v[24:27], v[152:155], a[228:231], v[24:27]
ds_write_b64 v116, v[16:17] offset:0
v_mfma_f32_16x16x32_bf16 v[24:27], v[168:171], a[232:235], v[24:27]
v_mfma_f32_16x16x32_bf16 v[24:27], v[184:187], a[236:239], v[24:27]
v_fma_f32 v20, v20, v6, v50
v_fma_f32 v21, v21, v6, v66
v_mfma_f32_16x16x32_bf16 v[24:27], v[124:127], v[100:103], v[24:27]
v_fma_f32 v22, v22, v6, v51
v_fma_f32 v23, v23, v6, v67
v_mfma_f32_16x16x32_bf16 v[28:31], v[188:191], a[236:239], v[28:31]
v_cvt_pk_bf16_f32 v20, v20, v21
v_cvt_pk_bf16_f32 v21, v22, v23
v_mfma_f32_16x16x32_bf16 v[28:31], v[172:175], a[232:235], v[28:31]
ds_write_b64 v117, v[20:21] offset:0
v_mfma_f32_16x16x32_bf16 v[28:31], v[156:159], a[228:231], v[28:31]
v_mfma_f32_16x16x32_bf16 v[28:31], v[140:143], a[224:227], v[28:31]
v_fma_f32 v24, v24, v6, v52
v_fma_f32 v25, v25, v6, v68
v_mfma_f32_16x16x32_bf16 v[28:31], v[120:123], v[100:103], v[28:31]
v_fma_f32 v26, v26, v6, v53
v_fma_f32 v27, v27, v6, v69
v_mfma_f32_16x16x32_bf16 v[32:35], v[128:131], a[240:243], v[32:35]
v_cvt_pk_bf16_f32 v24, v24, v25
v_cvt_pk_bf16_f32 v25, v26, v27
v_mfma_f32_16x16x32_bf16 v[32:35], v[144:147], a[244:247], v[32:35]
ds_write_b64 v118, v[24:25] offset:0
v_mfma_f32_16x16x32_bf16 v[32:35], v[160:163], a[248:251], v[32:35]
v_mfma_f32_16x16x32_bf16 v[32:35], v[176:179], a[252:255], v[32:35]
v_fma_f32 v28, v28, v6, v54
v_fma_f32 v29, v29, v6, v70
v_mfma_f32_16x16x32_bf16 v[32:35], v[124:127], v[104:107], v[32:35]
v_fma_f32 v30, v30, v6, v55
v_fma_f32 v31, v31, v6, v71
v_mfma_f32_16x16x32_bf16 v[36:39], v[180:183], a[252:255], v[36:39]
v_cvt_pk_bf16_f32 v28, v28, v29
v_cvt_pk_bf16_f32 v29, v30, v31
v_mfma_f32_16x16x32_bf16 v[36:39], v[164:167], a[248:251], v[36:39]
s_nop 0
ds_write_b64 v119, v[28:29] offset:0
ds_read_b128 v[192:195], v4 offset:0
v_mfma_f32_16x16x32_bf16 v[36:39], v[148:151], a[244:247], v[36:39]
ds_read_b128 v[196:199], v4 offset:1024
v_mfma_f32_16x16x32_bf16 v[36:39], v[132:135], a[240:243], v[36:39]
v_fma_f32 v32, v32, v7, v56
v_fma_f32 v33, v33, v7, v72
v_mfma_f32_16x16x32_bf16 v[36:39], v[120:123], v[104:107], v[36:39]
v_fma_f32 v34, v34, v7, v57
v_fma_f32 v35, v35, v7, v73
v_mfma_f32_16x16x32_bf16 v[40:43], v[136:139], a[240:243], v[40:43]
v_cvt_pk_bf16_f32 v32, v32, v33
v_cvt_pk_bf16_f32 v33, v34, v35
v_mfma_f32_16x16x32_bf16 v[40:43], v[152:155], a[244:247], v[40:43]
ds_write_b64 v116, v[32:33] offset:2048
v_mfma_f32_16x16x32_bf16 v[40:43], v[168:171], a[248:251], v[40:43]
s_waitcnt lgkmcnt(2)
buffer_store_dwordx4 v[192:195], v15, s[40:43], s70 offen sc1
v_mfma_f32_16x16x32_bf16 v[40:43], v[184:187], a[252:255], v[40:43]
s_add_u32 s70, s70, 0x4000
v_mfma_f32_16x16x32_bf16 v[40:43], v[124:127], v[108:111], v[40:43]
v_fma_f32 v36, v36, v7, v58
v_fma_f32 v37, v37, v7, v74
v_mfma_f32_16x16x32_bf16 v[44:47], v[188:191], a[252:255], v[44:47]
v_fma_f32 v38, v38, v7, v59
v_fma_f32 v39, v39, v7, v75
v_mfma_f32_16x16x32_bf16 v[44:47], v[172:175], a[248:251], v[44:47]
v_cvt_pk_bf16_f32 v36, v36, v37
v_cvt_pk_bf16_f32 v37, v38, v39
v_mfma_f32_16x16x32_bf16 v[44:47], v[156:159], a[244:247], v[44:47]
ds_write_b64 v117, v[36:37] offset:2048
v_mfma_f32_16x16x32_bf16 v[44:47], v[140:143], a[240:243], v[44:47]
v_fma_f32 v40, v40, v7, v60
v_fma_f32 v41, v41, v7, v76
v_mfma_f32_16x16x32_bf16 v[44:47], v[120:123], v[108:111], v[44:47]
v_fma_f32 v42, v42, v7, v61
v_fma_f32 v43, v43, v7, v77
v_cvt_pk_bf16_f32 v40, v40, v41
v_cvt_pk_bf16_f32 v41, v42, v43
ds_write_b64 v118, v[40:41] offset:2048
s_waitcnt lgkmcnt(3)
buffer_store_dwordx4 v[196:199], v15, s[40:43], s70 offen sc1
s_add_u32 s70, s70, 0x4000
v_fma_f32 v44, v44, v7, v62
v_fma_f32 v45, v45, v7, v78
v_fma_f32 v46, v46, v7, v63
v_fma_f32 v47, v47, v7, v79
v_cvt_pk_bf16_f32 v44, v44, v45
v_cvt_pk_bf16_f32 v45, v46, v47
ds_write_b64 v119, v[44:45] offset:2048
ds_read_b128 v[200:203], v4 offset:2048
ds_read_b128 v[204:207], v4 offset:3072
s_waitcnt lgkmcnt(1)
buffer_store_dwordx4 v[200:203], v15, s[40:43], s70 offen sc1
s_add_u32 s70, s70, 0x4000
s_waitcnt lgkmcnt(0)
buffer_store_dwordx4 v[204:207], v15, s[40:43], s70 offen sc1
s_add_u32 s70, s70, 0x4000
Lend:
s_endpgm
Lspin1:
s_mov_b32 s83, 262144
Lsl3:
s_sleep 2
buffer_load_dword v3, v2, s[48:51], 0 offen sc1
s_sub_u32 s83, s83, 1
s_cmp_eq_u32 s83, 0
s_waitcnt vmcnt(0)
s_cbranch_scc1 Lback2
v_cmp_gt_u32 vcc, 8, v3
s_cbranch_vccnz Lsl3
s_branch Lback2
Lspin4:
s_mov_b32 s83, 262144
Lsl6:
s_sleep 2
buffer_load_dword v3, v2, s[44:47], s75 offen sc1
s_sub_u32 s83, s83, 1
s_cmp_eq_u32 s83, 0
s_waitcnt vmcnt(0)
s_cbranch_scc1 Lback5
v_cmp_gt_u32 vcc, 1, v3
s_cbranch_vccnz Lsl6
s_branch Lback5
.p2align 12
s_endpgm
.p2align 7
LP0x:
Lstub10:
s_cbranch_execz Lret
s_cmp_eq_u32 s58, 2
s_cbranch_scc1 Lta10
s_cmp_eq_u32 s58, 3
s_cbranch_scc1 Lnt11
v_mfma_f32_16x16x32_bf16 v[160:163], a[160:163], v[16:19], v[112:115]
s_xor_b32 s74, s82, 0x10000
v_exp_f32 v128, v128
v_mfma_f32_16x16x32_bf16 v[176:179], a[176:179], v[16:19], v[112:115]
s_add_u32 s74, s74, s64
ds_read_b128 a[128:131], v2 offset:16384
ds_read_b128 a[132:135], v2 offset:17408
s_branch Ljoin12
Lta10:
v_mfma_f32_16x16x32_bf16 v[160:163], a[160:163], v[16:19], v[96:99]
s_xor_b32 s74, s82, 0x10000
v_exp_f32 v128, v128
v_mfma_f32_16x16x32_bf16 v[176:179], a[176:179], v[16:19], v[112:115]
s_add_u32 s74, s74, s64
ds_read_b128 a[128:131], v2 offset:16384
ds_read_b128 a[132:135], v2 offset:17408
s_branch Ljoin12
Lnt11:
v_mfma_f32_16x16x32_bf16 v[160:163], a[160:163], v[16:19], v[80:83]
s_xor_b32 s74, s82, 0x10000
v_exp_f32 v128, v128
v_mfma_f32_16x16x32_bf16 v[176:179], a[176:179], v[16:19], v[96:99]
s_add_u32 s74, s74, s64
ds_read_b128 a[128:131], v2 offset:16384
ds_read_b128 a[132:135], v2 offset:17408
Ljoin12:
v_mfma_f32_16x16x32_bf16 v[164:167], a[160:163], v[32:35], v[84:87]
s_add_u32 s81, s81, 0x8000
v_exp_f32 v129, v129
v_mfma_f32_16x16x32_bf16 v[164:167], a[164:167], v[36:39], v[164:167]
s_add_u32 m0, s74, 16384
v_exp_f32 v130, v130
v_mfma_f32_16x16x32_bf16 v[164:167], a[168:171], v[40:43], v[164:167]
s_add_u32 s72, s81, 16384
v_exp_f32 v131, v131
v_mfma_f32_16x16x32_bf16 v[164:167], a[172:175], v[44:47], v[164:167]
v_exp_f32 v144, v144
v_mfma_f32_16x16x32_bf16 v[172:175], a[172:175], v[76:79], v[92:95]
s_nop 0
ds_read_b128 a[136:139], v2 offset:18432
ds_read_b128 a[140:143], v2 offset:19456
v_mfma_f32_16x16x32_bf16 v[172:175], a[168:171], v[72:75], v[172:175]
s_nop 0
ds_read_b128 a[144:147], v2 offset:20480
ds_read_b128 a[148:151], v2 offset:21504
v_mfma_f32_16x16x32_bf16 v[172:175], a[164:167], v[68:71], v[172:175]
s_nop 0
ds_read_b128 a[152:155], v2 offset:22528
ds_read_b128 a[156:159], v2 offset:23552
v_mfma_f32_16x16x32_bf16 v[172:175], a[160:163], v[64:67], v[172:175]
s_nop 0
ds_read_b128 a[192:195], v2 offset:0
ds_read_b128 a[196:199], v2 offset:1024
v_mfma_f32_16x16x32_bf16 v[188:191], a[176:179], v[64:67], v[92:95]
s_nop 0
ds_read_b128 a[200:203], v2 offset:2048
ds_read_b128 a[204:207], v2 offset:3072
v_mfma_f32_16x16x32_bf16 v[188:191], a[180:183], v[68:71], v[188:191]
s_nop 0
ds_read_b128 a[208:211], v2 offset:4096
ds_read_b128 a[212:215], v2 offset:5120
v_mfma_f32_16x16x32_bf16 v[188:191], a[184:187], v[72:75], v[188:191]
s_nop 0
ds_read_b128 a[216:219], v2 offset:6144
ds_read_b128 a[220:223], v2 offset:7168
v_mfma_f32_16x16x32_bf16 v[188:191], a[188:191], v[76:79], v[188:191]
v_cvt_pk_bf16_f32 v192, v128, v129
v_cvt_pk_bf16_f32 v193, v130, v131
v_mfma_f32_16x16x32_bf16 v[180:183], a[188:191], v[44:47], v[84:87]
buffer_load_dwordx4 v1, s[44:47], s72 offen sc1 lds
v_mfma_f32_16x16x32_bf16 v[180:183], a[184:187], v[40:43], v[180:183]
v_exp_f32 v145, v145
v_mfma_f32_16x16x32_bf16 v[180:183], a[180:183], v[36:39], v[180:183]
v_exp_f32 v146, v146
v_mfma_f32_16x16x32_bf16 v[180:183], a[176:179], v[32:35], v[180:183]
v_exp_f32 v147, v147
v_mfma_f32_16x16x32_bf16 v[160:163], a[164:167], v[20:23], v[160:163]
v_exp_f32 v136, v136
v_mfma_f32_16x16x32_bf16 v[160:163], a[168:171], v[24:27], v[160:163]
v_cvt_pk_bf16_f32 v194, v144, v145
v_cvt_pk_bf16_f32 v195, v146, v147
v_mfma_f32_16x16x32_bf16 v[160:163], a[172:175], v[28:31], v[160:163]
v_exp_f32 v137, v137
v_mfma_f32_16x16x32_bf16 v[168:171], a[172:175], v[60:63], v[88:91]
v_exp_f32 v138, v138
v_mfma_f32_16x16x32_bf16 v[168:171], a[168:171], v[56:59], v[168:171]
v_exp_f32 v139, v139
v_mfma_f32_16x16x32_bf16 v[168:171], a[164:167], v[52:55], v[168:171]
v_exp_f32 v152, v152
v_mfma_f32_16x16x32_bf16 v[168:171], a[160:163], v[48:51], v[168:171]
v_cvt_pk_bf16_f32 v200, v136, v137
v_cvt_pk_bf16_f32 v201, v138, v139
v_mfma_f32_16x16x32_bf16 v[184:187], a[176:179], v[48:51], v[88:91]
buffer_load_dwordx4 v1, s[44:47], s72 offen offset:1024 sc1 lds
v_mfma_f32_16x16x32_bf16 v[184:187], a[180:183], v[52:55], v[184:187]
v_exp_f32 v153, v153
v_mfma_f32_16x16x32_bf16 v[184:187], a[184:187], v[56:59], v[184:187]
v_exp_f32 v154, v154
v_mfma_f32_16x16x32_bf16 v[184:187], a[188:191], v[60:63], v[184:187]
v_exp_f32 v155, v155
v_mfma_f32_16x16x32_bf16 v[176:179], a[188:191], v[28:31], v[176:179]
buffer_load_dwordx4 v1, s[44:47], s72 offen offset:2048 sc1 lds
v_mfma_f32_16x16x32_bf16 v[176:179], a[184:187], v[24:27], v[176:179]
buffer_load_dwordx4 v1, s[44:47], s72 offen offset:3072 sc1 lds
v_mfma_f32_16x16x32_bf16 v[176:179], a[180:183], v[20:23], v[176:179]
s_waitcnt lgkmcnt(4)
v_exp_f32 v132, v132
v_cvt_pk_bf16_f32 v202, v152, v153
v_cvt_pk_bf16_f32 v203, v154, v155
v_exp_f32 v133, v133
v_exp_f32 v134, v134
v_cvt_pk_bf16_f32 v196, v132, v133
v_exp_f32 v135, v135
v_exp_f32 v148, v148
v_cvt_pk_bf16_f32 v197, v134, v135
v_exp_f32 v149, v149
v_exp_f32 v150, v150
v_cvt_pk_bf16_f32 v198, v148, v149
v_exp_f32 v151, v151
v_exp_f32 v140, v140
v_cvt_pk_bf16_f32 v199, v150, v151
v_exp_f32 v141, v141
v_exp_f32 v142, v142
v_cvt_pk_bf16_f32 v204, v140, v141
v_exp_f32 v143, v143
v_exp_f32 v156, v156
v_cvt_pk_bf16_f32 v205, v142, v143
v_exp_f32 v157, v157
v_exp_f32 v158, v158
v_cvt_pk_bf16_f32 v206, v156, v157
v_exp_f32 v159, v159
s_nop 0
v_cvt_pk_bf16_f32 v207, v158, v159
v_mfma_f32_16x16x32_bf16 v[224:227], v[120:123], v[192:195], 0
s_add_u32 s82, s82, 0x8000
ds_read_b128 a[160:163], v2 offset:24576
ds_read_b128 a[164:167], v2 offset:25600
v_mfma_f32_16x16x32_bf16 v[232:235], v[120:123], v[200:203], 0
s_and_b32 s82, s82, 0x1ffff
v_exp_f32 v164, v164
v_mfma_f32_16x16x32_bf16 a[0:3], a[192:195], v[192:195], 0
s_add_u32 m0, s74, 0
v_exp_f32 v165, v165
v_mfma_f32_16x16x32_bf16 a[64:67], a[192:195], v[200:203], 0
s_add_u32 s72, s81, 0
v_exp_f32 v166, v166
v_mfma_f32_16x16x32_bf16 a[68:71], a[196:199], v[200:203], 0
buffer_load_dwordx4 v1, s[44:47], s72 offen sc1 lds
v_mfma_f32_16x16x32_bf16 a[4:7], a[196:199], v[192:195], 0
v_exp_f32 v167, v167
v_mfma_f32_16x16x32_bf16 a[8:11], a[200:203], v[192:195], 0
s_nop 0
ds_read_b128 a[168:171], v2 offset:26624
ds_read_b128 a[172:175], v2 offset:27648
v_mfma_f32_16x16x32_bf16 a[72:75], a[200:203], v[200:203], 0
v_exp_f32 v180, v180
v_mfma_f32_16x16x32_bf16 a[76:79], a[204:207], v[200:203], 0
s_nop 0
ds_read_b128 a[176:179], v2 offset:28672
ds_read_b128 a[180:183], v2 offset:29696
v_mfma_f32_16x16x32_bf16 a[12:15], a[204:207], v[192:195], 0
s_waitcnt lgkmcnt(6)
ds_read_b128 a[184:187], v2 offset:30720
ds_read_b128 a[188:191], v2 offset:31744
v_mfma_f32_16x16x32_bf16 a[16:19], a[208:211], v[192:195], 0
s_nop 0
ds_read_b128 a[224:227], v2 offset:8192
ds_read_b128 a[228:231], v2 offset:9216
v_mfma_f32_16x16x32_bf16 a[80:83], a[208:211], v[200:203], 0
s_nop 0
ds_read_b128 a[232:235], v2 offset:10240
ds_read_b128 a[236:239], v2 offset:11264
v_mfma_f32_16x16x32_bf16 a[84:87], a[212:215], v[200:203], 0
s_nop 0
ds_read_b128 a[240:243], v2 offset:12288
ds_read_b128 a[244:247], v2 offset:13312
v_mfma_f32_16x16x32_bf16 a[20:23], a[212:215], v[192:195], 0
s_nop 0
ds_read_b128 a[248:251], v2 offset:14336
ds_read_b128 a[252:255], v2 offset:15360
v_mfma_f32_16x16x32_bf16 a[24:27], a[216:219], v[192:195], 0
v_cvt_pk_bf16_f32 v212, v164, v165
v_cvt_pk_bf16_f32 v213, v166, v167
v_mfma_f32_16x16x32_bf16 a[88:91], a[216:219], v[200:203], 0
v_exp_f32 v181, v181
v_mfma_f32_16x16x32_bf16 a[92:95], a[220:223], v[200:203], 0
v_exp_f32 v182, v182
v_mfma_f32_16x16x32_bf16 a[28:31], a[220:223], v[192:195], 0
buffer_load_dwordx4 v1, s[44:47], s72 offen offset:1024 sc1 lds
s_cmp_eq_u32 s58, 0
s_cbranch_scc1 Lta13
s_cmp_eq_u32 s58, 1
s_cbranch_scc1 Lnt14
v_mfma_f32_16x16x32_bf16 v[132:135], a[128:131], v[32:35], v[84:87]
v_exp_f32 v183, v183
v_mfma_f32_16x16x32_bf16 v[148:151], a[144:147], v[32:35], v[84:87]
v_exp_f32 v172, v172
s_branch Ljoin15
Lta13:
v_mfma_f32_16x16x32_bf16 v[132:135], a[128:131], v[32:35], v[100:103]
v_exp_f32 v183, v183
v_mfma_f32_16x16x32_bf16 v[148:151], a[144:147], v[32:35], v[112:115]
v_exp_f32 v172, v172
s_branch Ljoin15
Lnt14:
v_mfma_f32_16x16x32_bf16 v[132:135], a[128:131], v[32:35], v[84:87]
v_exp_f32 v183, v183
v_mfma_f32_16x16x32_bf16 v[148:151], a[144:147], v[32:35], v[100:103]
v_exp_f32 v172, v172
Ljoin15:
v_mfma_f32_16x16x32_bf16 v[136:139], a[128:131], v[48:51], v[88:91]
v_cvt_pk_bf16_f32 v214, v180, v181
v_cvt_pk_bf16_f32 v215, v182, v183
v_mfma_f32_16x16x32_bf16 v[136:139], a[132:135], v[52:55], v[136:139]
v_exp_f32 v173, v173
v_mfma_f32_16x16x32_bf16 v[136:139], a[136:139], v[56:59], v[136:139]
buffer_load_dwordx4 v1, s[44:47], s72 offen offset:2048 sc1 lds
v_mfma_f32_16x16x32_bf16 v[136:139], a[140:143], v[60:63], v[136:139]
v_exp_f32 v174, v174
v_mfma_f32_16x16x32_bf16 v[152:155], a[156:159], v[60:63], v[88:91]
v_exp_f32 v175, v175
v_mfma_f32_16x16x32_bf16 v[152:155], a[152:155], v[56:59], v[152:155]
v_exp_f32 v188, v188
v_mfma_f32_16x16x32_bf16 v[152:155], a[148:151], v[52:55], v[152:155]
v_cvt_pk_bf16_f32 v220, v172, v173
v_cvt_pk_bf16_f32 v221, v174, v175
v_mfma_f32_16x16x32_bf16 v[152:155], a[144:147], v[48:51], v[152:155]
v_exp_f32 v189, v189
v_mfma_f32_16x16x32_bf16 v[132:135], a[132:135], v[36:39], v[132:135]
buffer_load_dwordx4 v1, s[44:47], s72 offen offset:3072 sc1 lds
v_mfma_f32_16x16x32_bf16 v[132:135], a[136:139], v[40:43], v[132:135]
s_add_u32 s66, s58, 1
v_exp_f32 v190, v190
v_mfma_f32_16x16x32_bf16 v[132:135], a[140:143], v[44:47], v[132:135]
s_and_b32 s66, s66, 3
v_exp_f32 v191, v191
v_mfma_f32_16x16x32_bf16 v[140:143], a[140:143], v[76:79], v[92:95]
s_mul_i32 s66, s66, 4160
v_exp_f32 v160, v160
v_mfma_f32_16x16x32_bf16 v[140:143], a[136:139], v[72:75], v[140:143]
s_add_u32 m0, s66, 131104
v_cvt_pk_bf16_f32 v222, v188, v189
v_cvt_pk_bf16_f32 v223, v190, v191
v_mfma_f32_16x16x32_bf16 v[140:143], a[132:135], v[68:71], v[140:143]
s_add_u32 s72, s93, 0x2
v_exp_f32 v161, v161
v_mfma_f32_16x16x32_bf16 v[140:143], a[128:131], v[64:67], v[140:143]
buffer_load_dwordx4 v1, s[36:39], s72 offen lds
v_mfma_f32_16x16x32_bf16 v[156:159], a[144:147], v[64:67], v[92:95]
v_exp_f32 v162, v162
v_mfma_f32_16x16x32_bf16 v[156:159], a[148:151], v[68:71], v[156:159]
v_exp_f32 v163, v163
v_mfma_f32_16x16x32_bf16 v[156:159], a[152:155], v[72:75], v[156:159]
buffer_load_dwordx4 v1, s[36:39], s72 offen offset:1024 lds
v_mfma_f32_16x16x32_bf16 v[156:159], a[156:159], v[76:79], v[156:159]
buffer_load_dwordx4 v1, s[36:39], s72 offen offset:2048 lds
v_mfma_f32_16x16x32_bf16 v[148:151], a[156:159], v[44:47], v[148:151]
buffer_load_dwordx4 v1, s[36:39], s72 offen offset:3072 lds
v_mfma_f32_16x16x32_bf16 v[148:151], a[152:155], v[40:43], v[148:151]
s_waitcnt vmcnt(12) lgkmcnt(4)
v_exp_f32 v176, v176
v_mfma_f32_16x16x32_bf16 v[148:151], a[148:151], v[36:39], v[148:151]
s_barrier
v_cvt_pk_bf16_f32 v208, v160, v161
v_cvt_pk_bf16_f32 v209, v162, v163
v_add_u32 v2, s82, v1
v_exp_f32 v177, v177
v_exp_f32 v178, v178
v_cvt_pk_bf16_f32 v210, v176, v177
v_exp_f32 v179, v179
v_exp_f32 v168, v168
v_cvt_pk_bf16_f32 v211, v178, v179
v_exp_f32 v169, v169
v_exp_f32 v170, v170
v_cvt_pk_bf16_f32 v216, v168, v169
v_exp_f32 v171, v171
v_exp_f32 v184, v184
v_cvt_pk_bf16_f32 v217, v170, v171
v_exp_f32 v185, v185
v_exp_f32 v186, v186
v_cvt_pk_bf16_f32 v218, v184, v185
v_exp_f32 v187, v187
s_nop 0
v_cvt_pk_bf16_f32 v219, v186, v187
s_branch LLT3
.p2align 12
s_endpgm
.p2align 7
LLT3x:
Lstub11:
s_cbranch_execz Lret
v_mfma_f32_16x16x32_bf16 v[228:231], v[120:123], v[196:199], v[228:231]
s_xor_b32 s74, s82, 0x10000
ds_read_b128 a[128:131], v2 offset:16384
v_and_b32 v240, 15, v0
v_mfma_f32_16x16x32_bf16 v[228:231], v[120:123], v[212:215], v[228:231]
s_add_u32 s74, s74, s64
v_exp_f32 v136, v136
v_mfma_f32_16x16x32_bf16 v[236:239], v[120:123], v[204:207], v[236:239]
s_add_u32 s81, s81, 0x8000
v_exp_f32 v137, v137
v_mfma_f32_16x16x32_bf16 v[236:239], v[120:123], v[220:223], v[236:239]
s_add_u32 m0, s74, 0
ds_read_b128 a[132:135], v2 offset:17408
v_cvt_pk_bf16_f32 v200, v136, v137
v_mfma_f32_16x16x32_bf16 a[32:35], a[192:195], v[196:199], a[32:35]
s_add_u32 s72, s81, 0
buffer_load_dwordx4 v1, s[44:47], s72 offen sc1 lds
v_mfma_f32_16x16x32_bf16 a[32:35], a[224:227], v[212:215], a[32:35]
s_add_u32 s69, s93, 0x3e00000
v_exp_f32 v138, v138
v_mfma_f32_16x16x32_bf16 a[96:99], a[224:227], v[220:223], a[96:99]
ds_read_b128 a[136:139], v2 offset:18432
v_lshrrev_b32 v241, 4, v0
v_mfma_f32_16x16x32_bf16 a[96:99], a[192:195], v[204:207], a[96:99]
v_exp_f32 v139, v139
v_mfma_f32_16x16x32_bf16 a[100:103], a[196:199], v[204:207], a[100:103]
buffer_store_dwordx4 v[112:115], v1, s[44:47], s69 offen sc1
v_mfma_f32_16x16x32_bf16 a[100:103], a[228:231], v[220:223], a[100:103]
v_exp_f32 v152, v152
v_mfma_f32_16x16x32_bf16 a[36:39], a[228:231], v[212:215], a[36:39]
ds_read_b128 a[140:143], v2 offset:19456
v_cvt_pk_bf16_f32 v201, v138, v139
v_mfma_f32_16x16x32_bf16 a[36:39], a[196:199], v[196:199], a[36:39]
v_exp_f32 v153, v153
v_mfma_f32_16x16x32_bf16 a[40:43], a[200:203], v[196:199], a[40:43]
buffer_load_dwordx4 v1, s[44:47], s72 offen offset:1024 sc1 lds
v_mfma_f32_16x16x32_bf16 a[40:43], a[232:235], v[212:215], a[40:43]
ds_read_b128 a[144:147], v2 offset:20480
v_cvt_pk_bf16_f32 v202, v152, v153
v_mfma_f32_16x16x32_bf16 a[104:107], a[232:235], v[220:223], a[104:107]
v_exp_f32 v154, v154
v_mfma_f32_16x16x32_bf16 a[104:107], a[200:203], v[204:207], a[104:107]
v_exp_f32 v155, v155
v_mfma_f32_16x16x32_bf16 a[108:111], a[204:207], v[204:207], a[108:111]
buffer_store_dwordx4 v[112:115], v1, s[44:47], s69 offen offset:1024 sc1
v_mfma_f32_16x16x32_bf16 a[108:111], a[236:239], v[220:223], a[108:111]
ds_read_b128 a[148:151], v2 offset:21504
v_cvt_pk_bf16_f32 v203, v154, v155
v_mfma_f32_16x16x32_bf16 a[44:47], a[236:239], v[212:215], a[44:47]
v_exp_f32 v132, v132
v_mfma_f32_16x16x32_bf16 a[44:47], a[204:207], v[196:199], a[44:47]
ds_read_b128 a[152:155], v2 offset:22528
v_add_u32 v248, 1, v240
v_mfma_f32_16x16x32_bf16 a[48:51], a[208:211], v[196:199], a[48:51]
s_waitcnt lgkmcnt(7)
v_exp_f32 v133, v133
v_mfma_f32_16x16x32_bf16 a[48:51], a[240:243], v[212:215], a[48:51]
buffer_load_dwordx4 v1, s[44:47], s72 offen offset:2048 sc1 lds
v_mfma_f32_16x16x32_bf16 a[112:115], a[240:243], v[220:223], a[112:115]
v_exp_f32 v134, v134
v_mfma_f32_16x16x32_bf16 a[112:115], a[208:211], v[204:207], a[112:115]
ds_read_b128 a[156:159], v2 offset:23552
v_and_b32 v249, 3, v248
v_mfma_f32_16x16x32_bf16 a[116:119], a[212:215], v[204:207], a[116:119]
v_exp_f32 v135, v135
v_mfma_f32_16x16x32_bf16 a[116:119], a[244:247], v[220:223], a[116:119]
buffer_store_dwordx4 v[112:115], v1, s[44:47], s69 offen offset:2048 sc1
v_mfma_f32_16x16x32_bf16 a[52:55], a[244:247], v[212:215], a[52:55]
ds_read_b128 a[192:195], v2 offset:0
v_lshrrev_b32 v248, 2, v248
v_mfma_f32_16x16x32_bf16 a[52:55], a[212:215], v[196:199], a[52:55]
v_exp_f32 v148, v148
v_mfma_f32_16x16x32_bf16 a[56:59], a[216:219], v[196:199], a[56:59]
buffer_load_dwordx4 v1, s[44:47], s72 offen offset:3072 sc1 lds
v_mfma_f32_16x16x32_bf16 a[56:59], a[248:251], v[212:215], a[56:59]
v_exp_f32 v149, v149
v_mfma_f32_16x16x32_bf16 a[120:123], a[248:251], v[220:223], a[120:123]
ds_read_b128 a[196:199], v2 offset:1024
v_mov_b32 v250, 0x20000
v_mfma_f32_16x16x32_bf16 a[120:123], a[216:219], v[204:207], a[120:123]
v_exp_f32 v150, v150
v_mfma_f32_16x16x32_bf16 a[124:127], a[220:223], v[204:207], a[124:127]
ds_read_b128 a[200:203], v2 offset:2048
v_mov_b32 v252, 0x20001
v_mfma_f32_16x16x32_bf16 a[124:127], a[252:255], v[220:223], a[124:127]
buffer_store_dwordx4 v[112:115], v1, s[44:47], s69 offen offset:3072 sc1
v_mfma_f32_16x16x32_bf16 a[60:63], a[252:255], v[212:215], a[60:63]
s_add_u32 s69, s93, 0x4200000
v_exp_f32 v151, v151
v_mfma_f32_16x16x32_bf16 a[60:63], a[220:223], v[196:199], a[60:63]
ds_read_b128 a[204:207], v2 offset:3072
v_cvt_pk_bf16_f32 v196, v132, v133
s_cmp_eq_u32 s58, 2
s_cbranch_scc1 Lta40
s_cmp_eq_u32 s58, 3
s_cbranch_scc1 Lnt41
v_mfma_f32_16x16x32_bf16 v[164:167], a[160:163], v[32:35], v[112:115]
ds_read_b128 a[208:211], v2 offset:4096
v_cvt_pk_bf16_f32 v197, v134, v135
v_mfma_f32_16x16x32_bf16 v[180:183], a[176:179], v[32:35], v[112:115]
v_exp_f32 v140, v140
s_branch Ljoin42
Lta40:
v_mfma_f32_16x16x32_bf16 v[164:167], a[160:163], v[32:35], v[100:103]
ds_read_b128 a[208:211], v2 offset:4096
v_cvt_pk_bf16_f32 v197, v134, v135
v_mfma_f32_16x16x32_bf16 v[180:183], a[176:179], v[32:35], v[112:115]
v_exp_f32 v140, v140
s_branch Ljoin42
Lnt41:
v_mfma_f32_16x16x32_bf16 v[164:167], a[160:163], v[32:35], v[84:87]
ds_read_b128 a[208:211], v2 offset:4096
v_cvt_pk_bf16_f32 v197, v134, v135
v_mfma_f32_16x16x32_bf16 v[180:183], a[176:179], v[32:35], v[100:103]
v_exp_f32 v140, v140
Ljoin42:
v_mfma_f32_16x16x32_bf16 v[164:167], a[164:167], v[36:39], v[164:167]
ds_read_b128 a[212:215], v2 offset:5120
v_cvt_pk_bf16_f32 v198, v148, v149
v_mfma_f32_16x16x32_bf16 v[164:167], a[168:171], v[40:43], v[164:167]
buffer_store_dwordx4 v[112:115], v1, s[44:47], s69 offen sc1
v_mfma_f32_16x16x32_bf16 v[164:167], a[172:175], v[44:47], v[164:167]
v_exp_f32 v141, v141
v_mfma_f32_16x16x32_bf16 v[172:175], a[172:175], v[76:79], v[92:95]
v_exp_f32 v142, v142
v_mfma_f32_16x16x32_bf16 v[172:175], a[168:171], v[72:75], v[172:175]
ds_read_b128 a[216:219], v2 offset:6144
v_cvt_pk_bf16_f32 v199, v150, v151
v_mfma_f32_16x16x32_bf16 v[172:175], a[164:167], v[68:71], v[172:175]
buffer_store_dwordx4 v[112:115], v1, s[44:47], s69 offen offset:1024 sc1
v_mfma_f32_16x16x32_bf16 v[172:175], a[160:163], v[64:67], v[172:175]
v_exp_f32 v143, v143
v_mfma_f32_16x16x32_bf16 v[188:191], a[176:179], v[64:67], v[92:95]
v_exp_f32 v156, v156
v_mfma_f32_16x16x32_bf16 v[188:191], a[180:183], v[68:71], v[188:191]
ds_read_b128 a[220:223], v2 offset:7168
v_cvt_pk_bf16_f32 v204, v140, v141
v_mfma_f32_16x16x32_bf16 v[188:191], a[184:187], v[72:75], v[188:191]
buffer_store_dwordx4 v[112:115], v1, s[44:47], s69 offen offset:2048 sc1
v_mfma_f32_16x16x32_bf16 v[188:191], a[188:191], v[76:79], v[188:191]
v_exp_f32 v157, v157
v_mfma_f32_16x16x32_bf16 v[180:183], a[188:191], v[44:47], v[180:183]
v_exp_f32 v158, v158
v_mfma_f32_16x16x32_bf16 v[180:183], a[184:187], v[40:43], v[180:183]
v_cvt_pk_bf16_f32 v205, v142, v143
v_cvt_pk_bf16_f32 v206, v156, v157
v_mfma_f32_16x16x32_bf16 v[180:183], a[180:183], v[36:39], v[180:183]
buffer_store_dwordx4 v[112:115], v1, s[44:47], s69 offen offset:3072 sc1
v_mfma_f32_16x16x32_bf16 v[168:171], a[160:163], v[48:51], v[88:91]
v_exp_f32 v159, v159
v_mfma_f32_16x16x32_bf16 v[168:171], a[164:167], v[52:55], v[168:171]
v_cvt_pk_bf16_f32 v207, v158, v159
v_lshlrev_b32 v6, 3, v249
v_mfma_f32_16x16x32_bf16 v[168:171], a[168:171], v[56:59], v[168:171]
v_lshrrev_b32 v6, v6, v252
v_and_b32 v6, 3, v6
v_mfma_f32_16x16x32_bf16 v[168:171], a[172:175], v[60:63], v[168:171]
v_cmp_ne_u32 vcc, 1, v249
v_mul_u32_u24 v6, 16640, v6
v_mfma_f32_16x16x32_bf16 v[184:187], a[188:191], v[60:63], v[88:91]
v_add_u32 v6, s92, v6
v_cndmask_b32 v6, v250, v6, vcc
v_mfma_f32_16x16x32_bf16 v[184:187], a[184:187], v[56:59], v[184:187]
v_add_u32 v253, s58, v249
v_and_b32 v253, 3, v253
v_mfma_f32_16x16x32_bf16 v[184:187], a[180:183], v[52:55], v[184:187]
s_waitcnt lgkmcnt(4)
v_mfma_f32_16x16x32_bf16 v[184:187], a[176:179], v[48:51], v[184:187]
s_barrier
s_lshr_b32 s69, s93, 4
s_and_b32 s69, s69, 0x7f00
s_add_u32 s69, s69, LHT4-Lpc0
v_lshrrev_b32 v3, 5, v0
v_lshlrev_b32 v3, 7, v3
v_add_u32 v3, s69, v3
v_min_u32 v3, Lcode_end-Lpc0, v3
global_load_dword v4, v3, s[98:99]
v_mfma_f32_16x16x32_bf16 v[224:227], v[120:123], v[208:211], v[224:227]
s_add_u32 s82, s82, 0x8000
ds_read_b128 a[160:163], v2 offset:24576
ds_read_b128 a[164:167], v2 offset:25600
v_mfma_f32_16x16x32_bf16 v[232:235], v[120:123], v[216:219], v[232:235]
s_and_b32 s82, s82, 0x1ffff
v_exp_f32 v164, v164
v_mfma_f32_16x16x32_bf16 v[232:235], v[120:123], v[200:203], v[232:235]
s_add_u32 s66, s58, 3
v_exp_f32 v165, v165
v_mfma_f32_16x16x32_bf16 a[0:3], a[224:227], v[208:211], a[0:3]
s_and_b32 s66, s66, 3
v_exp_f32 v166, v166
v_mfma_f32_16x16x32_bf16 a[64:67], a[192:195], v[200:203], a[64:67]
s_mul_i32 s66, s66, 4160
ds_read_b128 a[168:171], v2 offset:26624
v_cvt_pk_bf16_f32 v212, v164, v165
v_mfma_f32_16x16x32_bf16 a[64:67], a[224:227], v[216:219], a[64:67]
s_add_u32 s66, s66, s92
v_exp_f32 v167, v167
v_mfma_f32_16x16x32_bf16 a[68:71], a[228:231], v[216:219], a[68:71]
s_add_u32 m0, s66, 32
v_exp_f32 v180, v180
v_mfma_f32_16x16x32_bf16 a[68:71], a[196:199], v[200:203], a[68:71]
s_add_u32 s72, s93, 0x6
buffer_load_dwordx4 v1, s[36:39], s72 offen lds
v_mfma_f32_16x16x32_bf16 a[4:7], a[228:231], v[208:211], a[4:7]
ds_read_b128 a[172:175], v2 offset:27648
v_cvt_pk_bf16_f32 v213, v166, v167
v_mfma_f32_16x16x32_bf16 a[8:11], a[232:235], v[208:211], a[8:11]
v_exp_f32 v181, v181
v_mfma_f32_16x16x32_bf16 a[72:75], a[200:203], v[200:203], a[72:75]
ds_read_b128 a[176:179], v2 offset:28672
v_cvt_pk_bf16_f32 v214, v180, v181
v_mfma_f32_16x16x32_bf16 a[72:75], a[232:235], v[216:219], a[72:75]
v_exp_f32 v182, v182
v_mfma_f32_16x16x32_bf16 a[76:79], a[236:239], v[216:219], a[76:79]
v_exp_f32 v183, v183
v_mfma_f32_16x16x32_bf16 a[76:79], a[204:207], v[200:203], a[76:79]
ds_read_b128 a[180:183], v2 offset:29696
v_cvt_pk_bf16_f32 v215, v182, v183
v_mfma_f32_16x16x32_bf16 a[12:15], a[236:239], v[208:211], a[12:15]
v_exp_f32 v172, v172
v_mfma_f32_16x16x32_bf16 a[16:19], a[240:243], v[208:211], a[16:19]
s_waitcnt lgkmcnt(6)
ds_read_b128 a[184:187], v2 offset:30720
ds_read_b128 a[188:191], v2 offset:31744
v_mfma_f32_16x16x32_bf16 a[80:83], a[208:211], v[200:203], a[80:83]
v_exp_f32 v173, v173
v_mfma_f32_16x16x32_bf16 a[80:83], a[240:243], v[216:219], a[80:83]
buffer_load_dwordx4 v1, s[36:39], s72 offen offset:1024 lds
v_mfma_f32_16x16x32_bf16 a[84:87], a[244:247], v[216:219], a[84:87]
v_exp_f32 v174, v174
v_mfma_f32_16x16x32_bf16 a[84:87], a[212:215], v[200:203], a[84:87]
v_exp_f32 v175, v175
v_mfma_f32_16x16x32_bf16 a[20:23], a[244:247], v[208:211], a[20:23]
ds_read_b128 a[224:227], v2 offset:8192
v_cvt_pk_bf16_f32 v220, v172, v173
v_mfma_f32_16x16x32_bf16 a[24:27], a[248:251], v[208:211], a[24:27]
v_exp_f32 v188, v188
v_mfma_f32_16x16x32_bf16 a[88:91], a[216:219], v[200:203], a[88:91]
v_exp_f32 v189, v189
v_mfma_f32_16x16x32_bf16 a[88:91], a[248:251], v[216:219], a[88:91]
ds_read_b128 a[228:231], v2 offset:9216
v_cvt_pk_bf16_f32 v221, v174, v175
v_mfma_f32_16x16x32_bf16 a[92:95], a[252:255], v[216:219], a[92:95]
v_exp_f32 v190, v190
v_mfma_f32_16x16x32_bf16 a[92:95], a[220:223], v[200:203], a[92:95]
ds_read_b128 a[232:235], v2 offset:10240
v_cvt_pk_bf16_f32 v222, v188, v189
v_mfma_f32_16x16x32_bf16 a[28:31], a[252:255], v[208:211], a[28:31]
v_exp_f32 v191, v191
s_cmp_eq_u32 s58, 0
s_cbranch_scc1 Lta43
s_cmp_eq_u32 s58, 1
s_cbranch_scc1 Lnt44
v_mfma_f32_16x16x32_bf16 v[136:139], a[128:131], v[48:51], v[88:91]
buffer_load_dwordx4 v1, s[36:39], s72 offen offset:2048 lds
v_mfma_f32_16x16x32_bf16 v[152:155], a[144:147], v[48:51], v[88:91]
v_exp_f32 v168, v168
s_branch Ljoin45
Lta43:
v_mfma_f32_16x16x32_bf16 v[136:139], a[128:131], v[48:51], v[104:107]
buffer_load_dwordx4 v1, s[36:39], s72 offen offset:2048 lds
v_mfma_f32_16x16x32_bf16 v[152:155], a[144:147], v[48:51], v[112:115]
v_exp_f32 v168, v168
s_branch Ljoin45
Lnt44:
v_mfma_f32_16x16x32_bf16 v[136:139], a[128:131], v[48:51], v[88:91]
buffer_load_dwordx4 v1, s[36:39], s72 offen offset:2048 lds
v_mfma_f32_16x16x32_bf16 v[152:155], a[144:147], v[48:51], v[104:107]
v_exp_f32 v168, v168
Ljoin45:
v_mfma_f32_16x16x32_bf16 v[136:139], a[132:135], v[52:55], v[136:139]
ds_read_b128 a[236:239], v2 offset:11264
v_cvt_pk_bf16_f32 v223, v190, v191
v_mfma_f32_16x16x32_bf16 v[136:139], a[136:139], v[56:59], v[136:139]
v_exp_f32 v169, v169
v_mfma_f32_16x16x32_bf16 v[136:139], a[140:143], v[60:63], v[136:139]
ds_read_b128 a[240:243], v2 offset:12288
v_cvt_pk_bf16_f32 v216, v168, v169
v_mfma_f32_16x16x32_bf16 v[152:155], a[156:159], v[60:63], v[152:155]
v_exp_f32 v170, v170
v_mfma_f32_16x16x32_bf16 v[152:155], a[152:155], v[56:59], v[152:155]
v_exp_f32 v171, v171
v_mfma_f32_16x16x32_bf16 v[152:155], a[148:151], v[52:55], v[152:155]
ds_read_b128 a[244:247], v2 offset:13312
v_cvt_pk_bf16_f32 v217, v170, v171
v_mfma_f32_16x16x32_bf16 v[140:143], a[128:131], v[64:67], v[92:95]
v_exp_f32 v184, v184
v_mfma_f32_16x16x32_bf16 v[140:143], a[132:135], v[68:71], v[140:143]
ds_read_b128 a[248:251], v2 offset:14336
v_mfma_f32_16x16x32_bf16 v[140:143], a[136:139], v[72:75], v[140:143]
v_exp_f32 v185, v185
v_mfma_f32_16x16x32_bf16 v[140:143], a[140:143], v[76:79], v[140:143]
buffer_load_dwordx4 v1, s[36:39], s72 offen offset:3072 lds
v_mfma_f32_16x16x32_bf16 v[156:159], a[156:159], v[76:79], v[92:95]
ds_read_b128 a[252:255], v2 offset:15360
v_cvt_pk_bf16_f32 v218, v184, v185
v_mfma_f32_16x16x32_bf16 v[156:159], a[152:155], v[72:75], v[156:159]
v_exp_f32 v186, v186
v_mfma_f32_16x16x32_bf16 v[156:159], a[148:151], v[68:71], v[156:159]
s_waitcnt vmcnt(17) lgkmcnt(0)
v_exp_f32 v187, v187
v_mfma_f32_16x16x32_bf16 v[156:159], a[144:147], v[64:67], v[156:159]
s_barrier
v_cvt_pk_bf16_f32 v219, v186, v187
v_add_u32 v2, s82, v1
v_mfma_f32_16x16x32_bf16 v[228:231], v[120:123], v[196:199], v[228:231]
s_mov_b32 m0, s62
v_exp_f32 v136, v136
v_mfma_f32_16x16x32_bf16 v[228:231], v[120:123], v[212:215], v[228:231]
s_add_u32 s72, s93, 0x3000000
ds_read_b128 a[128:131], v2 offset:16384
v_mul_u32_u24 v253, 4160, v253
v_mfma_f32_16x16x32_bf16 v[236:239], v[120:123], v[204:207], v[236:239]
buffer_load_dwordx4 v1, s[44:47], s72 offen sc1 lds
v_mfma_f32_16x16x32_bf16 v[236:239], v[120:123], v[220:223], v[236:239]
v_exp_f32 v137, v137
v_mfma_f32_16x16x32_bf16 a[32:35], a[192:195], v[196:199], a[32:35]
ds_read_b128 a[132:135], v2 offset:17408
v_cvt_pk_bf16_f32 v200, v136, v137
v_mfma_f32_16x16x32_bf16 a[32:35], a[224:227], v[212:215], a[32:35]
v_exp_f32 v138, v138
v_mfma_f32_16x16x32_bf16 a[96:99], a[224:227], v[220:223], a[96:99]
ds_read_b128 a[136:139], v2 offset:18432
v_add_u32 v6, v6, v253
v_mfma_f32_16x16x32_bf16 a[96:99], a[192:195], v[204:207], a[96:99]
buffer_load_dwordx4 v1, s[44:47], s72 offen offset:1024 sc1 lds
v_mfma_f32_16x16x32_bf16 a[100:103], a[196:199], v[204:207], a[100:103]
v_exp_f32 v139, v139
v_mfma_f32_16x16x32_bf16 a[100:103], a[228:231], v[220:223], a[100:103]
ds_read_b128 a[140:143], v2 offset:19456
v_cvt_pk_bf16_f32 v201, v138, v139
v_mfma_f32_16x16x32_bf16 a[36:39], a[228:231], v[212:215], a[36:39]
v_exp_f32 v152, v152
v_mfma_f32_16x16x32_bf16 a[36:39], a[196:199], v[196:199], a[36:39]
ds_read_b128 a[144:147], v2 offset:20480
v_bfe_u32 v251, v0, 2, 2
v_mfma_f32_16x16x32_bf16 a[40:43], a[200:203], v[196:199], a[40:43]
buffer_load_dwordx4 v1, s[44:47], s72 offen offset:2048 sc1 lds
v_mfma_f32_16x16x32_bf16 a[40:43], a[232:235], v[212:215], a[40:43]
v_exp_f32 v153, v153
v_mfma_f32_16x16x32_bf16 a[104:107], a[232:235], v[220:223], a[104:107]
ds_read_b128 a[148:151], v2 offset:21504
v_cvt_pk_bf16_f32 v202, v152, v153
v_mfma_f32_16x16x32_bf16 a[104:107], a[200:203], v[204:207], a[104:107]
buffer_load_dwordx4 v1, s[44:47], s72 offen offset:3072 sc1 lds
v_mfma_f32_16x16x32_bf16 a[108:111], a[204:207], v[204:207], a[108:111]
s_add_u32 s66, s58, 0
v_exp_f32 v154, v154
v_mfma_f32_16x16x32_bf16 a[108:111], a[236:239], v[220:223], a[108:111]
s_and_b32 s66, s66, 3
ds_read_b128 a[152:155], v2 offset:22528
v_lshl_add_u32 v6, v248, 3, v6
v_mfma_f32_16x16x32_bf16 a[44:47], a[236:239], v[212:215], a[44:47]
s_mul_i32 s66, s66, 4160
v_exp_f32 v155, v155
v_mfma_f32_16x16x32_bf16 a[44:47], a[204:207], v[196:199], a[44:47]
s_add_u32 s66, s66, s92
ds_read_b128 a[156:159], v2 offset:23552
v_cvt_pk_bf16_f32 v203, v154, v155
v_mfma_f32_16x16x32_bf16 a[48:51], a[208:211], v[196:199], a[48:51]
s_waitcnt lgkmcnt(8)
v_exp_f32 v140, v140
v_mfma_f32_16x16x32_bf16 a[48:51], a[240:243], v[212:215], a[48:51]
s_add_u32 m0, s66, 16672
ds_read_b128 a[192:195], v2 offset:0
v_lshl_add_u32 v6, v241, 4, v6
v_mfma_f32_16x16x32_bf16 a[112:115], a[240:243], v[220:223], a[112:115]
s_add_u32 s72, s93, 0x0
buffer_load_dwordx4 v1, s[36:39], s72 offen lds
v_mfma_f32_16x16x32_bf16 a[112:115], a[208:211], v[204:207], a[112:115]
buffer_load_dwordx4 v1, s[36:39], s72 offen offset:1024 lds
v_mfma_f32_16x16x32_bf16 a[116:119], a[212:215], v[204:207], a[116:119]
v_exp_f32 v141, v141
v_mfma_f32_16x16x32_bf16 a[116:119], a[244:247], v[220:223], a[116:119]
ds_read_b128 a[196:199], v2 offset:1024
v_lshlrev_b32 v5, 3, v251
v_mfma_f32_16x16x32_bf16 a[52:55], a[244:247], v[212:215], a[52:55]
v_exp_f32 v142, v142
v_mfma_f32_16x16x32_bf16 a[52:55], a[212:215], v[196:199], a[52:55]
ds_read_b128 a[200:203], v2 offset:2048
v_lshrrev_b32 v5, v5, v252
v_mfma_f32_16x16x32_bf16 a[56:59], a[216:219], v[196:199], a[56:59]
buffer_load_dwordx4 v1, s[36:39], s72 offen offset:2048 lds
v_mfma_f32_16x16x32_bf16 a[56:59], a[248:251], v[212:215], a[56:59]
v_exp_f32 v143, v143
v_mfma_f32_16x16x32_bf16 a[120:123], a[248:251], v[220:223], a[120:123]
ds_read_b128 a[204:207], v2 offset:3072
v_and_b32 v5, 3, v5
v_mfma_f32_16x16x32_bf16 a[120:123], a[216:219], v[204:207], a[120:123]
v_exp_f32 v156, v156
v_mfma_f32_16x16x32_bf16 a[124:127], a[220:223], v[204:207], a[124:127]
ds_read_b128 a[208:211], v2 offset:4096
v_cmp_ne_u32 vcc, 1, v251
v_mfma_f32_16x16x32_bf16 a[124:127], a[252:255], v[220:223], a[124:127]
buffer_load_dwordx4 v1, s[36:39], s72 offen offset:3072 lds
v_mfma_f32_16x16x32_bf16 a[60:63], a[252:255], v[212:215], a[60:63]
s_add_u32 s66, s58, 2
v_exp_f32 v157, v157
v_mfma_f32_16x16x32_bf16 a[60:63], a[220:223], v[196:199], a[60:63]
s_and_b32 s66, s66, 3
ds_read_b128 a[212:215], v2 offset:5120
v_cvt_pk_bf16_f32 v204, v140, v141
s_cmp_eq_u32 s58, 2
s_cbranch_scc1 Lta46
s_cmp_eq_u32 s58, 3
s_cbranch_scc1 Lnt47
v_mfma_f32_16x16x32_bf16 v[168:171], a[160:163], v[48:51], v[112:115]
s_mul_i32 s66, s66, 4160
v_exp_f32 v158, v158
v_mfma_f32_16x16x32_bf16 v[184:187], a[176:179], v[48:51], v[112:115]
s_add_u32 s66, s66, s92
ds_read_b128 a[216:219], v2 offset:6144
v_cvt_pk_bf16_f32 v205, v142, v143
s_branch Ljoin48
Lta46:
v_mfma_f32_16x16x32_bf16 v[168:171], a[160:163], v[48:51], v[104:107]
s_mul_i32 s66, s66, 4160
v_exp_f32 v158, v158
v_mfma_f32_16x16x32_bf16 v[184:187], a[176:179], v[48:51], v[112:115]
s_add_u32 s66, s66, s92
ds_read_b128 a[216:219], v2 offset:6144
v_cvt_pk_bf16_f32 v205, v142, v143
s_branch Ljoin48
Lnt47:
v_mfma_f32_16x16x32_bf16 v[168:171], a[160:163], v[48:51], v[88:91]
s_mul_i32 s66, s66, 4160
v_exp_f32 v158, v158
v_mfma_f32_16x16x32_bf16 v[184:187], a[176:179], v[48:51], v[104:107]
s_add_u32 s66, s66, s92
ds_read_b128 a[216:219], v2 offset:6144
v_cvt_pk_bf16_f32 v205, v142, v143
Ljoin48:
v_mfma_f32_16x16x32_bf16 v[172:175], a[160:163], v[64:67], v[92:95]
s_add_u32 m0, s66, 33312
v_exp_f32 v159, v159
v_mfma_f32_16x16x32_bf16 v[172:175], a[164:167], v[68:71], v[172:175]
s_add_u32 s72, s93, 0x4
buffer_load_dwordx4 v1, s[36:39], s72 offen lds
v_mfma_f32_16x16x32_bf16 v[172:175], a[168:171], v[72:75], v[172:175]
ds_read_b128 a[220:223], v2 offset:7168
v_cvt_pk_bf16_f32 v206, v156, v157
v_mfma_f32_16x16x32_bf16 v[172:175], a[172:175], v[76:79], v[172:175]
buffer_load_dwordx4 v1, s[36:39], s72 offen offset:1024 lds
v_mfma_f32_16x16x32_bf16 v[188:191], a[188:191], v[76:79], v[92:95]
v_cvt_pk_bf16_f32 v207, v158, v159
v_mul_u32_u24 v5, 16640, v5
v_mfma_f32_16x16x32_bf16 v[188:191], a[184:187], v[72:75], v[188:191]
v_add_u32 v5, s92, v5
v_cndmask_b32 v5, v250, v5, vcc
v_mfma_f32_16x16x32_bf16 v[188:191], a[180:183], v[68:71], v[188:191]
v_add_u32 v253, s58, v251
v_and_b32 v253, 3, v253
v_mfma_f32_16x16x32_bf16 v[188:191], a[176:179], v[64:67], v[188:191]
v_mul_u32_u24 v253, 4160, v253
v_add_u32 v5, v5, v253
v_mfma_f32_16x16x32_bf16 v[168:171], a[164:167], v[52:55], v[168:171]
s_add_u32 s73, s62, 480
v_lshlrev_b32 v248, 5, v240
v_sub_u32 v248, s73, v248
v_mfma_f32_16x16x32_bf16 v[168:171], a[168:171], v[56:59], v[168:171]
v_lshl_add_u32 v7, v241, 4, v248
v_mfma_f32_16x16x32_bf16 v[168:171], a[172:175], v[60:63], v[168:171]
s_and_b32 s73, s58, 1
v_mfma_f32_16x16x32_bf16 v[184:187], a[188:191], v[60:63], v[184:187]
s_lshl_b32 s73, s73, 4
v_mfma_f32_16x16x32_bf16 v[184:187], a[184:187], v[56:59], v[184:187]
s_lshr_b32 s73, s90, s73
v_mfma_f32_16x16x32_bf16 v[184:187], a[180:183], v[52:55], v[184:187]
s_waitcnt lgkmcnt(4)
s_and_b32 s73, s73, 0xffff
v_lshl_add_u32 v248, v241, 3, v240
v_sub_u32 v248, 15, v248
v_and_b32 v249, 1, v248
v_lshlrev_b32 v249, 4, v249
v_lshlrev_b32 v249, v249, s73
v_lshrrev_b32 v248, 1, v248
v_and_b32 v241, 3, v0
v_cmp_eq_u32 vcc, 0, v248
v_lshl_add_u32 v5, v241, 3, v5
s_nop 0
v_cndmask_b32 v8, 0, v249, vcc
v_cmp_eq_u32 vcc, 1, v248
v_lshlrev_b32 v240, 4, v251
s_nop 0
v_cndmask_b32 v9, 0, v249, vcc
v_cmp_eq_u32 vcc, 2, v248
v_sub_u32 v240, 48, v240
v_lshlrev_b64 v[12:13], 16, s[88:89]
v_cndmask_b32 v10, 0, v249, vcc
v_cmp_eq_u32 vcc, 3, v248
v_lshlrev_b64 v[12:13], v240, v[12:13]
s_nop 0
v_cndmask_b32 v11, 0, v249, vcc
v_cmp_eq_u32 vcc, 3, v241
s_add_u32 s73, s62, 4096
v_lshl_add_u32 v14, v0, 3, s73
v_cndmask_b32 v12, 0, v12, vcc
v_cndmask_b32 v13, 0, v13, vcc
v_lshrrev_b32 v15, 4, v0
v_lshlrev_b32 v15, 1, v15
v_and_b32 v240, 7, v0
v_xor_b32 v15, v15, v240
v_lshlrev_b32 v15, 4, v15
v_lshrrev_b32 v240, 3, v0
v_lshl_add_u32 v15, v240, 11, v15
s_lshr_b32 s75, s59, 1
s_and_b32 s75, s75, 8
s_add_u32 s75, s75, s60
s_lshl_b32 s76, s65, 2
s_lshr_b32 s80, s59, 2
s_and_b32 s80, s80, 3
s_add_u32 s76, s76, s80
s_lshl_b32 s94, s58, 16
s_lshl_b32 s80, s76, 7
s_add_u32 s94, s94, s80
s_lshl_b32 s80, s75, 18
s_add_u32 s80, s80, s94
v_rcp_f32 v224, v224
v_rcp_f32 v228, v228
s_lshl_b32 s73, s59, 12
s_add_u32 s73, s73, 0x2000000
s_lshl_b32 s70, s67, 2
s_add_u32 s70, s70, s73
v_mov_b32 v225, v224
v_accvgpr_read_b32 v240, a0
v_accvgpr_read_b32 v241, a1
v_accvgpr_read_b32 v242, a2
v_accvgpr_read_b32 v243, a3
v_accvgpr_read_b32 v244, a4
v_accvgpr_read_b32 v245, a5
v_accvgpr_read_b32 v246, a6
v_accvgpr_read_b32 v247, a7
v_pk_mul_f32 v[240:241], v[240:241], v[224:225]
v_pk_mul_f32 v[242:243], v[242:243], v[224:225]
v_pk_mul_f32 v[244:245], v[244:245], v[224:225]
v_pk_mul_f32 v[246:247], v[246:247], v[224:225]
buffer_load_dwordx4 v1, s[36:39], s72 offen offset:2048 lds
v_cvt_pk_bf16_f32 v128, v240, v241
v_cvt_pk_bf16_f32 v129, v242, v243
v_cvt_pk_bf16_f32 v130, v244, v245
v_cvt_pk_bf16_f32 v131, v246, v247
v_accvgpr_read_b32 v248, a8
v_accvgpr_read_b32 v249, a9
v_accvgpr_read_b32 v250, a10
v_accvgpr_read_b32 v251, a11
v_accvgpr_read_b32 v252, a12
v_accvgpr_read_b32 v253, a13
v_accvgpr_read_b32 v254, a14
v_accvgpr_read_b32 v255, a15
v_pk_mul_f32 v[248:249], v[248:249], v[224:225]
v_pk_mul_f32 v[250:251], v[250:251], v[224:225]
v_pk_mul_f32 v[252:253], v[252:253], v[224:225]
v_pk_mul_f32 v[254:255], v[254:255], v[224:225]
v_cvt_pk_bf16_f32 v144, v248, v249
v_cvt_pk_bf16_f32 v145, v250, v251
buffer_load_dwordx4 v1, s[36:39], s72 offen offset:3072 lds
v_cvt_pk_bf16_f32 v146, v252, v253
v_cvt_pk_bf16_f32 v147, v254, v255
v_accvgpr_read_b32 v240, a16
v_accvgpr_read_b32 v241, a17
v_accvgpr_read_b32 v242, a18
v_accvgpr_read_b32 v243, a19
v_accvgpr_read_b32 v244, a20
v_accvgpr_read_b32 v245, a21
v_accvgpr_read_b32 v246, a22
v_accvgpr_read_b32 v247, a23
v_pk_mul_f32 v[240:241], v[240:241], v[224:225]
v_pk_mul_f32 v[242:243], v[242:243], v[224:225]
v_pk_mul_f32 v[244:245], v[244:245], v[224:225]
v_pk_mul_f32 v[246:247], v[246:247], v[224:225]
v_cvt_pk_bf16_f32 v160, v240, v241
v_cvt_pk_bf16_f32 v161, v242, v243
v_cvt_pk_bf16_f32 v162, v244, v245
v_cvt_pk_bf16_f32 v163, v246, v247
buffer_load_dwordx4 v[80:83], v15, s[4:7], s80 offen
v_accvgpr_read_b32 v248, a24
v_accvgpr_read_b32 v249, a25
v_accvgpr_read_b32 v250, a26
v_accvgpr_read_b32 v251, a27
v_accvgpr_read_b32 v252, a28
v_accvgpr_read_b32 v253, a29
v_accvgpr_read_b32 v254, a30
v_accvgpr_read_b32 v255, a31
v_pk_mul_f32 v[248:249], v[248:249], v[224:225]
v_pk_mul_f32 v[250:251], v[250:251], v[224:225]
v_pk_mul_f32 v[252:253], v[252:253], v[224:225]
v_pk_mul_f32 v[254:255], v[254:255], v[224:225]
v_cvt_pk_bf16_f32 v176, v248, v249
v_cvt_pk_bf16_f32 v177, v250, v251
v_cvt_pk_bf16_f32 v178, v252, v253
v_cvt_pk_bf16_f32 v179, v254, v255
v_mov_b32 v229, v228
v_accvgpr_read_b32 v240, a32
s_add_u32 s80, s80, 0x4000
buffer_load_dwordx4 v[84:87], v15, s[4:7], s80 offen
v_accvgpr_read_b32 v241, a33
v_accvgpr_read_b32 v242, a34
v_accvgpr_read_b32 v243, a35
v_accvgpr_read_b32 v244, a36
v_accvgpr_read_b32 v245, a37
v_accvgpr_read_b32 v246, a38
v_accvgpr_read_b32 v247, a39
v_pk_mul_f32 v[240:241], v[240:241], v[228:229]
v_pk_mul_f32 v[242:243], v[242:243], v[228:229]
v_pk_mul_f32 v[244:245], v[244:245], v[228:229]
v_pk_mul_f32 v[246:247], v[246:247], v[228:229]
v_cvt_pk_bf16_f32 v132, v240, v241
v_cvt_pk_bf16_f32 v133, v242, v243
v_cvt_pk_bf16_f32 v134, v244, v245
v_cvt_pk_bf16_f32 v135, v246, v247
v_accvgpr_read_b32 v248, a40
v_accvgpr_read_b32 v249, a41
v_accvgpr_read_b32 v250, a42
s_add_u32 s80, s80, 0x4000
buffer_load_dwordx4 v[96:99], v15, s[4:7], s80 offen
v_accvgpr_read_b32 v251, a43
v_accvgpr_read_b32 v252, a44
v_accvgpr_read_b32 v253, a45
v_accvgpr_read_b32 v254, a46
v_accvgpr_read_b32 v255, a47
v_pk_mul_f32 v[248:249], v[248:249], v[228:229]
v_pk_mul_f32 v[250:251], v[250:251], v[228:229]
v_pk_mul_f32 v[252:253], v[252:253], v[228:229]
v_pk_mul_f32 v[254:255], v[254:255], v[228:229]
v_cvt_pk_bf16_f32 v148, v248, v249
v_cvt_pk_bf16_f32 v149, v250, v251
v_cvt_pk_bf16_f32 v150, v252, v253
v_cvt_pk_bf16_f32 v151, v254, v255
v_accvgpr_read_b32 v240, a48
v_accvgpr_read_b32 v241, a49
v_accvgpr_read_b32 v242, a50
v_accvgpr_read_b32 v243, a51
v_accvgpr_read_b32 v244, a52
s_add_u32 s80, s80, 0x4000
buffer_load_dwordx4 v[100:103], v15, s[4:7], s80 offen
v_accvgpr_read_b32 v245, a53
v_accvgpr_read_b32 v246, a54
v_accvgpr_read_b32 v247, a55
v_pk_mul_f32 v[240:241], v[240:241], v[228:229]
v_pk_mul_f32 v[242:243], v[242:243], v[228:229]
v_pk_mul_f32 v[244:245], v[244:245], v[228:229]
v_pk_mul_f32 v[246:247], v[246:247], v[228:229]
v_cvt_pk_bf16_f32 v164, v240, v241
v_cvt_pk_bf16_f32 v165, v242, v243
v_cvt_pk_bf16_f32 v166, v244, v245
v_cvt_pk_bf16_f32 v167, v246, v247
v_accvgpr_read_b32 v248, a56
v_accvgpr_read_b32 v249, a57
v_accvgpr_read_b32 v250, a58
v_accvgpr_read_b32 v251, a59
v_accvgpr_read_b32 v252, a60
v_accvgpr_read_b32 v253, a61
v_accvgpr_read_b32 v254, a62
v_accvgpr_read_b32 v255, a63
v_pk_mul_f32 v[248:249], v[248:249], v[228:229]
v_pk_mul_f32 v[250:251], v[250:251], v[228:229]
v_pk_mul_f32 v[252:253], v[252:253], v[228:229]
v_pk_mul_f32 v[254:255], v[254:255], v[228:229]
v_cvt_pk_bf16_f32 v180, v248, v249
v_cvt_pk_bf16_f32 v181, v250, v251
v_cvt_pk_bf16_f32 v182, v252, v253
v_cvt_pk_bf16_f32 v183, v254, v255
v_mfma_f32_16x16x32_bf16 v[232:235], v[120:123], v[216:219], v[232:235]
s_add_u32 s82, s82, 0x8000
ds_read_b128 a[160:163], v2 offset:24576
ds_read_b128 a[164:167], v2 offset:25600
v_mfma_f32_16x16x32_bf16 v[232:235], v[120:123], v[200:203], v[232:235]
s_and_b32 s82, s82, 0x1ffff
v_exp_f32 v172, v172
v_mfma_f32_16x16x32_bf16 a[64:67], a[224:227], v[216:219], a[64:67]
v_exp_f32 v173, v173
v_mfma_f32_16x16x32_bf16 a[64:67], a[192:195], v[200:203], a[64:67]
s_nop 0
ds_read_b128 a[168:171], v2 offset:26624
ds_read_b128 a[172:175], v2 offset:27648
v_mfma_f32_16x16x32_bf16 a[68:71], a[196:199], v[200:203], a[68:71]
v_exp_f32 v174, v174
v_mfma_f32_16x16x32_bf16 a[68:71], a[228:231], v[216:219], a[68:71]
v_exp_f32 v175, v175
v_mfma_f32_16x16x32_bf16 a[72:75], a[232:235], v[216:219], a[72:75]
buffer_store_dwordx4 v[128:131], v1, s[44:47], s70 offen sc1
v_mfma_f32_16x16x32_bf16 a[72:75], a[200:203], v[200:203], a[72:75]
s_nop 0
ds_read_b128 a[176:179], v2 offset:28672
ds_read_b128 a[180:183], v2 offset:29696
v_mfma_f32_16x16x32_bf16 a[76:79], a[204:207], v[200:203], a[76:79]
v_exp_f32 v188, v188
v_mfma_f32_16x16x32_bf16 a[76:79], a[236:239], v[216:219], a[76:79]
s_nop 0
ds_read_b128 a[184:187], v2 offset:30720
ds_read_b128 a[188:191], v2 offset:31744
v_mfma_f32_16x16x32_bf16 a[80:83], a[240:243], v[216:219], a[80:83]
s_waitcnt lgkmcnt(8)
ds_read_b128 a[224:227], v2 offset:8192
ds_read_b128 a[228:231], v2 offset:9216
v_mfma_f32_16x16x32_bf16 a[80:83], a[208:211], v[200:203], a[80:83]
s_nop 0
ds_read_b128 a[232:235], v2 offset:10240
ds_read_b128 a[236:239], v2 offset:11264
v_mfma_f32_16x16x32_bf16 a[84:87], a[212:215], v[200:203], a[84:87]
ds_read_b128 a[240:243], v2 offset:12288
v_cvt_pk_bf16_f32 v220, v172, v173
v_mfma_f32_16x16x32_bf16 a[84:87], a[244:247], v[216:219], a[84:87]
v_exp_f32 v189, v189
v_mfma_f32_16x16x32_bf16 a[88:91], a[248:251], v[216:219], a[88:91]
v_exp_f32 v190, v190
v_mfma_f32_16x16x32_bf16 a[88:91], a[216:219], v[200:203], a[88:91]
s_nop 0
ds_read_b128 a[244:247], v2 offset:13312
ds_read_b128 a[248:251], v2 offset:14336
v_mfma_f32_16x16x32_bf16 a[92:95], a[220:223], v[200:203], a[92:95]
v_cvt_pk_bf16_f32 v221, v174, v175
v_cvt_pk_bf16_f32 v222, v188, v189
v_mfma_f32_16x16x32_bf16 a[92:95], a[252:255], v[216:219], a[92:95]
v_exp_f32 v191, v191
s_cmp_eq_u32 s58, 0
s_cbranch_scc1 Lta49
s_cmp_eq_u32 s58, 1
s_cbranch_scc1 Lnt50
v_mfma_f32_16x16x32_bf16 v[140:143], a[128:131], v[64:67], v[92:95]
v_exp_f32 v168, v168
v_mfma_f32_16x16x32_bf16 v[156:159], a[144:147], v[64:67], v[92:95]
buffer_store_dwordx4 v[144:147], v1, s[44:47], s70 offen offset:1024 sc1
s_branch Ljoin51
Lta49:
v_mfma_f32_16x16x32_bf16 v[140:143], a[128:131], v[64:67], v[108:111]
v_exp_f32 v168, v168
v_mfma_f32_16x16x32_bf16 v[156:159], a[144:147], v[64:67], v[112:115]
buffer_store_dwordx4 v[144:147], v1, s[44:47], s70 offen offset:1024 sc1
s_branch Ljoin51
Lnt50:
v_mfma_f32_16x16x32_bf16 v[140:143], a[128:131], v[64:67], v[92:95]
v_exp_f32 v168, v168
v_mfma_f32_16x16x32_bf16 v[156:159], a[144:147], v[64:67], v[108:111]
buffer_store_dwordx4 v[144:147], v1, s[44:47], s70 offen offset:1024 sc1
Ljoin51:
v_mfma_f32_16x16x32_bf16 v[140:143], a[132:135], v[68:71], v[140:143]
v_exp_f32 v169, v169
v_mfma_f32_16x16x32_bf16 v[140:143], a[136:139], v[72:75], v[140:143]
v_exp_f32 v170, v170
v_mfma_f32_16x16x32_bf16 v[140:143], a[140:143], v[76:79], v[140:143]
buffer_store_dwordx4 v[160:163], v1, s[44:47], s70 offen offset:2048 sc1
v_mfma_f32_16x16x32_bf16 v[156:159], a[156:159], v[76:79], v[156:159]
ds_read_b128 a[252:255], v2 offset:15360
v_cvt_pk_bf16_f32 v223, v190, v191
v_mfma_f32_16x16x32_bf16 v[156:159], a[152:155], v[72:75], v[156:159]
s_waitcnt vmcnt(24) lgkmcnt(4)
v_exp_f32 v171, v171
v_mfma_f32_16x16x32_bf16 v[156:159], a[148:151], v[68:71], v[156:159]
s_barrier
v_exp_f32 v184, v184
v_add_u32 v2, s82, v1
v_cvt_pk_bf16_f32 v216, v168, v169
v_cvt_pk_bf16_f32 v217, v170, v171
v_exp_f32 v185, v185
v_exp_f32 v186, v186
v_cvt_pk_bf16_f32 v218, v184, v185
v_exp_f32 v187, v187
s_nop 0
v_cvt_pk_bf16_f32 v219, v186, v187
v_mfma_f32_16x16x32_bf16 v[236:239], v[120:123], v[204:207], v[236:239]
s_add_u32 s78, s59, 4
v_exp_f32 v140, v140
v_mfma_f32_16x16x32_bf16 v[236:239], v[120:123], v[220:223], v[236:239]
s_and_b32 s78, s78, 12
v_exp_f32 v141, v141
v_mfma_f32_16x16x32_bf16 a[96:99], a[192:195], v[204:207], a[96:99]
s_and_b32 s12, s59, 16
ds_read_b128 a[192:195], v2 offset:0
v_mfma_f32_16x16x32_bf16 a[96:99], a[224:227], v[220:223], a[96:99]
s_or_b32 s78, s78, s12
buffer_store_dwordx4 v[176:179], v1, s[44:47], s70 offen offset:3072 sc1
v_mfma_f32_16x16x32_bf16 a[100:103], a[228:231], v[220:223], a[100:103]
s_add_u32 s70, s70, 0x80000
v_exp_f32 v142, v142
v_mfma_f32_16x16x32_bf16 a[100:103], a[196:199], v[204:207], a[100:103]
s_add_u32 s12, s61, 0
ds_read_b128 a[196:199], v2 offset:1024
v_mfma_f32_16x16x32_bf16 a[104:107], a[200:203], v[204:207], a[104:107]
s_and_b32 s12, s12, 3
ds_read_b128 a[200:203], v2 offset:2048
v_mfma_f32_16x16x32_bf16 a[104:107], a[232:235], v[220:223], a[104:107]
s_add_u32 s12, s12, s78
v_exp_f32 v143, v143
v_mfma_f32_16x16x32_bf16 a[108:111], a[236:239], v[220:223], a[108:111]
s_lshl_b32 s12, s12, 18
v_exp_f32 v156, v156
v_mfma_f32_16x16x32_bf16 a[108:111], a[204:207], v[204:207], a[108:111]
s_add_u32 s12, s12, s94
ds_read_b128 a[204:207], v2 offset:3072
v_mfma_f32_16x16x32_bf16 a[112:115], a[208:211], v[204:207], a[112:115]
s_waitcnt lgkmcnt(4)
ds_read_b128 a[208:211], v2 offset:4096
v_mfma_f32_16x16x32_bf16 a[112:115], a[240:243], v[220:223], a[112:115]
s_add_u32 s13, s61, 1
buffer_store_dwordx4 v[132:135], v1, s[44:47], s70 offen sc1
v_mfma_f32_16x16x32_bf16 a[116:119], a[244:247], v[220:223], a[116:119]
s_and_b32 s13, s13, 3
v_exp_f32 v157, v157
v_mfma_f32_16x16x32_bf16 a[116:119], a[212:215], v[204:207], a[116:119]
s_add_u32 s13, s13, s78
ds_read_b128 a[212:215], v2 offset:5120
v_mfma_f32_16x16x32_bf16 a[120:123], a[216:219], v[204:207], a[120:123]
s_lshl_b32 s13, s13, 18
v_exp_f32 v158, v158
v_mfma_f32_16x16x32_bf16 a[120:123], a[248:251], v[220:223], a[120:123]
s_add_u32 s13, s13, s94
ds_read_b128 a[216:219], v2 offset:6144
v_mfma_f32_16x16x32_bf16 a[124:127], a[252:255], v[220:223], a[124:127]
s_add_u32 s14, s61, 2
buffer_store_dwordx4 v[148:151], v1, s[44:47], s70 offen offset:1024 sc1
v_mfma_f32_16x16x32_bf16 a[124:127], a[220:223], v[204:207], a[124:127]
s_and_b32 s14, s14, 3
ds_read_b128 a[220:223], v2 offset:7168
v_cvt_pk_bf16_f32 v204, v140, v141
s_cmp_eq_u32 s58, 2
s_cbranch_scc1 Lta52
s_cmp_eq_u32 s58, 3
s_cbranch_scc1 Lnt53
v_mfma_f32_16x16x32_bf16 v[172:175], a[160:163], v[64:67], v[112:115]
s_add_u32 s14, s14, s78
v_cvt_pk_bf16_f32 v205, v142, v143
v_cvt_pk_bf16_f32 v206, v156, v157
v_mfma_f32_16x16x32_bf16 v[188:191], a[176:179], v[64:67], v[112:115]
s_lshl_b32 s14, s14, 18
v_exp_f32 v159, v159
s_branch Ljoin54
Lta52:
v_mfma_f32_16x16x32_bf16 v[172:175], a[160:163], v[64:67], v[108:111]
s_add_u32 s14, s14, s78
v_cvt_pk_bf16_f32 v205, v142, v143
v_cvt_pk_bf16_f32 v206, v156, v157
v_mfma_f32_16x16x32_bf16 v[188:191], a[176:179], v[64:67], v[112:115]
s_lshl_b32 s14, s14, 18
v_exp_f32 v159, v159
s_branch Ljoin54
Lnt53:
v_mfma_f32_16x16x32_bf16 v[172:175], a[160:163], v[64:67], v[92:95]
s_add_u32 s14, s14, s78
v_cvt_pk_bf16_f32 v205, v142, v143
v_cvt_pk_bf16_f32 v206, v156, v157
v_mfma_f32_16x16x32_bf16 v[188:191], a[176:179], v[64:67], v[108:111]
s_lshl_b32 s14, s14, 18
v_exp_f32 v159, v159
Ljoin54:
v_mfma_f32_16x16x32_bf16 v[172:175], a[164:167], v[68:71], v[172:175]
s_add_u32 s14, s14, s94
v_cvt_pk_bf16_f32 v207, v158, v159
v_mfma_f32_16x16x32_bf16 v[172:175], a[168:171], v[72:75], v[172:175]
s_add_u32 s15, s61, 3
v_mfma_f32_16x16x32_bf16 v[172:175], a[172:175], v[76:79], v[172:175]
s_and_b32 s15, s15, 3
v_mfma_f32_16x16x32_bf16 v[188:191], a[188:191], v[76:79], v[188:191]
s_add_u32 s15, s15, s78
v_mfma_f32_16x16x32_bf16 v[188:191], a[184:187], v[72:75], v[188:191]
s_lshl_b32 s15, s15, 18
v_mfma_f32_16x16x32_bf16 v[188:191], a[180:183], v[68:71], v[188:191]
s_waitcnt lgkmcnt(4)
s_add_u32 s15, s15, s94
v_mfma_f32_16x16x32_bf16 v[232:235], v[120:123], v[216:219], v[232:235]
s_add_u32 s82, s82, 0x8000
v_exp_f32 v172, v172
v_mfma_f32_16x16x32_bf16 a[64:67], a[224:227], v[216:219], a[64:67]
s_and_b32 s82, s82, 0x1ffff
ds_read_b128 a[224:227], v2 offset:8192
v_mfma_f32_16x16x32_bf16 a[68:71], a[228:231], v[216:219], a[68:71]
ds_read_b128 a[228:231], v2 offset:9216
v_mfma_f32_16x16x32_bf16 a[72:75], a[232:235], v[216:219], a[72:75]
ds_read_b128 a[232:235], v2 offset:10240
v_mfma_f32_16x16x32_bf16 a[76:79], a[236:239], v[216:219], a[76:79]
buffer_store_dwordx4 v[164:167], v1, s[44:47], s70 offen offset:2048 sc1
v_mfma_f32_16x16x32_bf16 a[80:83], a[240:243], v[216:219], a[80:83]
s_nop 0
ds_read_b128 a[236:239], v2 offset:11264
ds_read_b128 a[240:243], v2 offset:12288
v_mfma_f32_16x16x32_bf16 a[84:87], a[244:247], v[216:219], a[84:87]
ds_read_b128 a[244:247], v2 offset:13312
v_mfma_f32_16x16x32_bf16 a[88:91], a[248:251], v[216:219], a[88:91]
v_exp_f32 v173, v173
v_mfma_f32_16x16x32_bf16 a[92:95], a[252:255], v[216:219], a[92:95]
v_exp_f32 v174, v174
ds_read_b128 a[248:251], v2 offset:14336
ds_read_b128 a[252:255], v2 offset:15360
v_add_u32 v2, s82, v1
buffer_store_dwordx4 v[180:183], v1, s[44:47], s70 offen offset:3072 sc1
v_cvt_pk_bf16_f32 v220, v172, v173
v_exp_f32 v175, v175
v_exp_f32 v188, v188
v_cvt_pk_bf16_f32 v221, v174, v175
v_exp_f32 v189, v189
v_exp_f32 v190, v190
v_cvt_pk_bf16_f32 v222, v188, v189
v_exp_f32 v191, v191
s_nop 0
v_cvt_pk_bf16_f32 v223, v190, v191
s_waitcnt vmcnt(8) lgkmcnt(0)
s_barrier
s_branch LHT4
Lslow:
s_waitcnt vmcnt(0) lgkmcnt(0)
s_barrier
s_mov_b32 s86, 1
s_lshl_b32 s81, s59, 20
s_add_u32 s81, s81, s64
s_sub_u32 s81, s81, 0x4000
s_mov_b32 s83, 0
s_lshl_b32 s75, s60, 3
s_sub_u32 s76, 128, s75
s_add_u32 s74, s75, s58
s_sub_u32 s75, s76, 8
s_add_u32 s75, s75, s58
v_mov_b32 v2, v1
v_lshrrev_b32 v240, 4, v0
v_and_b32 v241, 15, v0
v_lshlrev_b32 v240, 2, v240
v_sub_u32 v240, v241, v240
v_mov_b32 v112, 0xff800000
v_mov_b32 v113, 0xff800000
v_mov_b32 v114, 0xff800000
v_mov_b32 v115, 0xff800000
v_cmp_gt_i32 vcc, 0, v240
v_mov_b32 v120, 0x3f803f80
s_nop 0
v_cndmask_b32 v116, 0, v112, vcc
v_cmp_gt_i32 vcc, 1, v240
v_mov_b32 v121, 0x3f803f80
s_nop 0
v_cndmask_b32 v117, 0, v112, vcc
v_cmp_gt_i32 vcc, 2, v240
v_mov_b32 v122, 0x3f803f80
s_nop 0
v_cndmask_b32 v118, 0, v112, vcc
v_cmp_gt_i32 vcc, 3, v240
v_mov_b32 v123, 0x3f803f80
s_nop 0
v_cndmask_b32 v119, 0, v112, vcc
Lslow1:
s_add_u32 m0, s64, 16384
s_add_u32 s72, s81, 16384
buffer_load_dwordx4 v1, s[44:47], s72 offen sc1 lds
buffer_load_dwordx4 v1, s[44:47], s72 offen offset:1024 sc1 lds
buffer_load_dwordx4 v1, s[44:47], s72 offen offset:2048 sc1 lds
buffer_load_dwordx4 v1, s[44:47], s72 offen offset:3072 sc1 lds
s_add_u32 s81, s81, 0x8000
s_waitcnt vmcnt(0)
s_barrier
ds_read_b128 a[128:131], v2 offset:16384
ds_read_b128 a[132:135], v2 offset:17408
ds_read_b128 a[136:139], v2 offset:18432
ds_read_b128 a[140:143], v2 offset:19456
ds_read_b128 a[144:147], v2 offset:20480
ds_read_b128 a[148:151], v2 offset:21504
ds_read_b128 a[152:155], v2 offset:22528
ds_read_b128 a[156:159], v2 offset:23552
s_waitcnt lgkmcnt(0)
s_add_u32 s73, s74, 0
s_cmp_lt_u32 s73, s83
s_cbranch_scc1 Lsa55
s_cmp_eq_u32 s73, s83
s_cbranch_scc1 Lst56
v_mfma_f32_16x16x32_bf16 v[128:131], a[128:131], v[16:19], 0
s_branch Lsj57
Lst56:
v_mfma_f32_16x16x32_bf16 v[128:131], a[128:131], v[16:19], v[116:119]
Lsj57:
v_mfma_f32_16x16x32_bf16 v[128:131], a[132:135], v[20:23], v[128:131]
v_mfma_f32_16x16x32_bf16 v[128:131], a[136:139], v[24:27], v[128:131]
v_mfma_f32_16x16x32_bf16 v[128:131], a[140:143], v[28:31], v[128:131]
s_nop 7
v_max3_f32 v124, v124, v128, v129
v_max3_f32 v124, v124, v130, v131
Lsa55:
s_add_u32 s73, s74, 4
s_cmp_lt_u32 s73, s83
s_cbranch_scc1 Lsa58
s_cmp_eq_u32 s73, s83
s_cbranch_scc1 Lst59
v_mfma_f32_16x16x32_bf16 v[132:135], a[128:131], v[32:35], 0
s_branch Lsj60
Lst59:
v_mfma_f32_16x16x32_bf16 v[132:135], a[128:131], v[32:35], v[116:119]
Lsj60:
v_mfma_f32_16x16x32_bf16 v[132:135], a[132:135], v[36:39], v[132:135]
v_mfma_f32_16x16x32_bf16 v[132:135], a[136:139], v[40:43], v[132:135]
v_mfma_f32_16x16x32_bf16 v[132:135], a[140:143], v[44:47], v[132:135]
s_nop 7
v_max3_f32 v125, v125, v132, v133
v_max3_f32 v125, v125, v134, v135
Lsa58:
s_add_u32 s73, s75, 0
s_cmp_lt_u32 s73, s83
s_cbranch_scc1 Lsa61
s_cmp_eq_u32 s73, s83
s_cbranch_scc1 Lst62
v_mfma_f32_16x16x32_bf16 v[136:139], a[128:131], v[48:51], 0
s_branch Lsj63
Lst62:
v_mfma_f32_16x16x32_bf16 v[136:139], a[128:131], v[48:51], v[116:119]
Lsj63:
v_mfma_f32_16x16x32_bf16 v[136:139], a[132:135], v[52:55], v[136:139]
v_mfma_f32_16x16x32_bf16 v[136:139], a[136:139], v[56:59], v[136:139]
v_mfma_f32_16x16x32_bf16 v[136:139], a[140:143], v[60:63], v[136:139]
s_nop 7
v_max3_f32 v126, v126, v136, v137
v_max3_f32 v126, v126, v138, v139
Lsa61:
s_add_u32 s73, s75, 4
s_cmp_lt_u32 s73, s83
s_cbranch_scc1 Lsa64
s_cmp_eq_u32 s73, s83
s_cbranch_scc1 Lst65
v_mfma_f32_16x16x32_bf16 v[140:143], a[128:131], v[64:67], 0
s_branch Lsj66
Lst65:
v_mfma_f32_16x16x32_bf16 v[140:143], a[128:131], v[64:67], v[116:119]
Lsj66:
v_mfma_f32_16x16x32_bf16 v[140:143], a[132:135], v[68:71], v[140:143]
v_mfma_f32_16x16x32_bf16 v[140:143], a[136:139], v[72:75], v[140:143]
v_mfma_f32_16x16x32_bf16 v[140:143], a[140:143], v[76:79], v[140:143]
s_nop 7
v_max3_f32 v127, v127, v140, v141
v_max3_f32 v127, v127, v142, v143
Lsa64:
s_add_u32 s83, s83, 1
s_add_u32 s73, s74, 0
s_cmp_lt_u32 s73, s83
s_cbranch_scc1 Lsa67
s_cmp_eq_u32 s73, s83
s_cbranch_scc1 Lst68
v_mfma_f32_16x16x32_bf16 v[144:147], a[144:147], v[16:19], 0
s_branch Lsj69
Lst68:
v_mfma_f32_16x16x32_bf16 v[144:147], a[144:147], v[16:19], v[116:119]
Lsj69:
v_mfma_f32_16x16x32_bf16 v[144:147], a[148:151], v[20:23], v[144:147]
v_mfma_f32_16x16x32_bf16 v[144:147], a[152:155], v[24:27], v[144:147]
v_mfma_f32_16x16x32_bf16 v[144:147], a[156:159], v[28:31], v[144:147]
s_nop 7
v_max3_f32 v124, v124, v144, v145
v_max3_f32 v124, v124, v146, v147
Lsa67:
s_add_u32 s73, s74, 4
s_cmp_lt_u32 s73, s83
s_cbranch_scc1 Lsa70
s_cmp_eq_u32 s73, s83
s_cbranch_scc1 Lst71
v_mfma_f32_16x16x32_bf16 v[148:151], a[144:147], v[32:35], 0
s_branch Lsj72
Lst71:
v_mfma_f32_16x16x32_bf16 v[148:151], a[144:147], v[32:35], v[116:119]
Lsj72:
v_mfma_f32_16x16x32_bf16 v[148:151], a[148:151], v[36:39], v[148:151]
v_mfma_f32_16x16x32_bf16 v[148:151], a[152:155], v[40:43], v[148:151]
v_mfma_f32_16x16x32_bf16 v[148:151], a[156:159], v[44:47], v[148:151]
s_nop 7
v_max3_f32 v125, v125, v148, v149
v_max3_f32 v125, v125, v150, v151
Lsa70:
s_add_u32 s73, s75, 0
s_cmp_lt_u32 s73, s83
s_cbranch_scc1 Lsa73
s_cmp_eq_u32 s73, s83
s_cbranch_scc1 Lst74
v_mfma_f32_16x16x32_bf16 v[152:155], a[144:147], v[48:51], 0
s_branch Lsj75
Lst74:
v_mfma_f32_16x16x32_bf16 v[152:155], a[144:147], v[48:51], v[116:119]
Lsj75:
v_mfma_f32_16x16x32_bf16 v[152:155], a[148:151], v[52:55], v[152:155]
v_mfma_f32_16x16x32_bf16 v[152:155], a[152:155], v[56:59], v[152:155]
v_mfma_f32_16x16x32_bf16 v[152:155], a[156:159], v[60:63], v[152:155]
s_nop 7
v_max3_f32 v126, v126, v152, v153
v_max3_f32 v126, v126, v154, v155
Lsa73:
s_add_u32 s73, s75, 4
s_cmp_lt_u32 s73, s83
s_cbranch_scc1 Lsa76
s_cmp_eq_u32 s73, s83
s_cbranch_scc1 Lst77
v_mfma_f32_16x16x32_bf16 v[156:159], a[144:147], v[64:67], 0
s_branch Lsj78
Lst77:
v_mfma_f32_16x16x32_bf16 v[156:159], a[144:147], v[64:67], v[116:119]
Lsj78:
v_mfma_f32_16x16x32_bf16 v[156:159], a[148:151], v[68:71], v[156:159]
v_mfma_f32_16x16x32_bf16 v[156:159], a[152:155], v[72:75], v[156:159]
v_mfma_f32_16x16x32_bf16 v[156:159], a[156:159], v[76:79], v[156:159]
s_nop 7
v_max3_f32 v127, v127, v156, v157
v_max3_f32 v127, v127, v158, v159
Lsa76:
s_add_u32 s83, s83, 1
ds_read_b128 a[128:131], v2 offset:24576
ds_read_b128 a[132:135], v2 offset:25600
ds_read_b128 a[136:139], v2 offset:26624
ds_read_b128 a[140:143], v2 offset:27648
ds_read_b128 a[144:147], v2 offset:28672
ds_read_b128 a[148:151], v2 offset:29696
ds_read_b128 a[152:155], v2 offset:30720
ds_read_b128 a[156:159], v2 offset:31744
s_waitcnt lgkmcnt(0)
s_add_u32 s73, s74, 0
s_cmp_lt_u32 s73, s83
s_cbranch_scc1 Lsa79
s_cmp_eq_u32 s73, s83
s_cbranch_scc1 Lst80
v_mfma_f32_16x16x32_bf16 v[128:131], a[128:131], v[16:19], 0
s_branch Lsj81
Lst80:
v_mfma_f32_16x16x32_bf16 v[128:131], a[128:131], v[16:19], v[116:119]
Lsj81:
v_mfma_f32_16x16x32_bf16 v[128:131], a[132:135], v[20:23], v[128:131]
v_mfma_f32_16x16x32_bf16 v[128:131], a[136:139], v[24:27], v[128:131]
v_mfma_f32_16x16x32_bf16 v[128:131], a[140:143], v[28:31], v[128:131]
s_nop 7
v_max3_f32 v124, v124, v128, v129
v_max3_f32 v124, v124, v130, v131
Lsa79:
s_add_u32 s73, s74, 4
s_cmp_lt_u32 s73, s83
s_cbranch_scc1 Lsa82
s_cmp_eq_u32 s73, s83
s_cbranch_scc1 Lst83
v_mfma_f32_16x16x32_bf16 v[132:135], a[128:131], v[32:35], 0
s_branch Lsj84
Lst83:
v_mfma_f32_16x16x32_bf16 v[132:135], a[128:131], v[32:35], v[116:119]
Lsj84:
v_mfma_f32_16x16x32_bf16 v[132:135], a[132:135], v[36:39], v[132:135]
v_mfma_f32_16x16x32_bf16 v[132:135], a[136:139], v[40:43], v[132:135]
v_mfma_f32_16x16x32_bf16 v[132:135], a[140:143], v[44:47], v[132:135]
s_nop 7
v_max3_f32 v125, v125, v132, v133
v_max3_f32 v125, v125, v134, v135
Lsa82:
s_add_u32 s73, s75, 0
s_cmp_lt_u32 s73, s83
s_cbranch_scc1 Lsa85
s_cmp_eq_u32 s73, s83
s_cbranch_scc1 Lst86
v_mfma_f32_16x16x32_bf16 v[136:139], a[128:131], v[48:51], 0
s_branch Lsj87
Lst86:
v_mfma_f32_16x16x32_bf16 v[136:139], a[128:131], v[48:51], v[116:119]
Lsj87:
v_mfma_f32_16x16x32_bf16 v[136:139], a[132:135], v[52:55], v[136:139]
v_mfma_f32_16x16x32_bf16 v[136:139], a[136:139], v[56:59], v[136:139]
v_mfma_f32_16x16x32_bf16 v[136:139], a[140:143], v[60:63], v[136:139]
s_nop 7
v_max3_f32 v126, v126, v136, v137
v_max3_f32 v126, v126, v138, v139
Lsa85:
s_add_u32 s73, s75, 4
s_cmp_lt_u32 s73, s83
s_cbranch_scc1 Lsa88
s_cmp_eq_u32 s73, s83
s_cbranch_scc1 Lst89
v_mfma_f32_16x16x32_bf16 v[140:143], a[128:131], v[64:67], 0
s_branch Lsj90
Lst89:
v_mfma_f32_16x16x32_bf16 v[140:143], a[128:131], v[64:67], v[116:119]
Lsj90:
v_mfma_f32_16x16x32_bf16 v[140:143], a[132:135], v[68:71], v[140:143]
v_mfma_f32_16x16x32_bf16 v[140:143], a[136:139], v[72:75], v[140:143]
v_mfma_f32_16x16x32_bf16 v[140:143], a[140:143], v[76:79], v[140:143]
s_nop 7
v_max3_f32 v127, v127, v140, v141
v_max3_f32 v127, v127, v142, v143
Lsa88:
s_add_u32 s83, s83, 1
s_add_u32 s73, s74, 0
s_cmp_lt_u32 s73, s83
s_cbranch_scc1 Lsa91
s_cmp_eq_u32 s73, s83
s_cbranch_scc1 Lst92
v_mfma_f32_16x16x32_bf16 v[144:147], a[144:147], v[16:19], 0
s_branch Lsj93
Lst92:
v_mfma_f32_16x16x32_bf16 v[144:147], a[144:147], v[16:19], v[116:119]
Lsj93:
v_mfma_f32_16x16x32_bf16 v[144:147], a[148:151], v[20:23], v[144:147]
v_mfma_f32_16x16x32_bf16 v[144:147], a[152:155], v[24:27], v[144:147]
v_mfma_f32_16x16x32_bf16 v[144:147], a[156:159], v[28:31], v[144:147]
s_nop 7
v_max3_f32 v124, v124, v144, v145
v_max3_f32 v124, v124, v146, v147
Lsa91:
s_add_u32 s73, s74, 4
s_cmp_lt_u32 s73, s83
s_cbranch_scc1 Lsa94
s_cmp_eq_u32 s73, s83
s_cbranch_scc1 Lst95
v_mfma_f32_16x16x32_bf16 v[148:151], a[144:147], v[32:35], 0
s_branch Lsj96
Lst95:
v_mfma_f32_16x16x32_bf16 v[148:151], a[144:147], v[32:35], v[116:119]
Lsj96:
v_mfma_f32_16x16x32_bf16 v[148:151], a[148:151], v[36:39], v[148:151]
v_mfma_f32_16x16x32_bf16 v[148:151], a[152:155], v[40:43], v[148:151]
v_mfma_f32_16x16x32_bf16 v[148:151], a[156:159], v[44:47], v[148:151]
s_nop 7
v_max3_f32 v125, v125, v148, v149
v_max3_f32 v125, v125, v150, v151
Lsa94:
s_add_u32 s73, s75, 0
s_cmp_lt_u32 s73, s83
s_cbranch_scc1 Lsa97
s_cmp_eq_u32 s73, s83
s_cbranch_scc1 Lst98
v_mfma_f32_16x16x32_bf16 v[152:155], a[144:147], v[48:51], 0
s_branch Lsj99
Lst98:
v_mfma_f32_16x16x32_bf16 v[152:155], a[144:147], v[48:51], v[116:119]
Lsj99:
v_mfma_f32_16x16x32_bf16 v[152:155], a[148:151], v[52:55], v[152:155]
v_mfma_f32_16x16x32_bf16 v[152:155], a[152:155], v[56:59], v[152:155]
v_mfma_f32_16x16x32_bf16 v[152:155], a[156:159], v[60:63], v[152:155]
s_nop 7
v_max3_f32 v126, v126, v152, v153
v_max3_f32 v126, v126, v154, v155
Lsa97:
s_add_u32 s73, s75, 4
s_cmp_lt_u32 s73, s83
s_cbranch_scc1 Lsa100
s_cmp_eq_u32 s73, s83
s_cbranch_scc1 Lst101
v_mfma_f32_16x16x32_bf16 v[156:159], a[144:147], v[64:67], 0
s_branch Lsj102
Lst101:
v_mfma_f32_16x16x32_bf16 v[156:159], a[144:147], v[64:67], v[116:119]
Lsj102:
v_mfma_f32_16x16x32_bf16 v[156:159], a[148:151], v[68:71], v[156:159]
v_mfma_f32_16x16x32_bf16 v[156:159], a[152:155], v[72:75], v[156:159]
v_mfma_f32_16x16x32_bf16 v[156:159], a[156:159], v[76:79], v[156:159]
s_nop 7
v_max3_f32 v127, v127, v156, v157
v_max3_f32 v127, v127, v158, v159
Lsa100:
s_add_u32 s83, s83, 1
s_barrier
s_cmp_lt_u32 s83, s76
s_cbranch_scc1 Lslow1
s_lshl_b32 s81, s59, 20
s_add_u32 s81, s81, s64
s_sub_u32 s81, s81, 0x4000
s_add_u32 m0, s64, 49152
s_add_u32 s72, s81, 16384
buffer_load_dwordx4 v1, s[44:47], s72 offen sc1 lds
buffer_load_dwordx4 v1, s[44:47], s72 offen offset:1024 sc1 lds
buffer_load_dwordx4 v1, s[44:47], s72 offen offset:2048 sc1 lds
buffer_load_dwordx4 v1, s[44:47], s72 offen offset:3072 sc1 lds
s_add_u32 s81, s81, 0x8000
s_add_u32 m0, s64, 81920
s_add_u32 s72, s81, 16384
buffer_load_dwordx4 v1, s[44:47], s72 offen sc1 lds
buffer_load_dwordx4 v1, s[44:47], s72 offen offset:1024 sc1 lds
buffer_load_dwordx4 v1, s[44:47], s72 offen offset:2048 sc1 lds
buffer_load_dwordx4 v1, s[44:47], s72 offen offset:3072 sc1 lds
s_add_u32 m0, s64, 65536
s_add_u32 s72, s81, 0
buffer_load_dwordx4 v1, s[44:47], s72 offen sc1 lds
buffer_load_dwordx4 v1, s[44:47], s72 offen offset:1024 sc1 lds
buffer_load_dwordx4 v1, s[44:47], s72 offen offset:2048 sc1 lds
buffer_load_dwordx4 v1, s[44:47], s72 offen offset:3072 sc1 lds
s_add_u32 s81, s81, 0x8000
s_add_u32 m0, s64, 114688
s_add_u32 s72, s81, 16384
buffer_load_dwordx4 v1, s[44:47], s72 offen sc1 lds
buffer_load_dwordx4 v1, s[44:47], s72 offen offset:1024 sc1 lds
buffer_load_dwordx4 v1, s[44:47], s72 offen offset:2048 sc1 lds
buffer_load_dwordx4 v1, s[44:47], s72 offen offset:3072 sc1 lds
s_add_u32 m0, s64, 98304
s_add_u32 s72, s81, 0
buffer_load_dwordx4 v1, s[44:47], s72 offen sc1 lds
buffer_load_dwordx4 v1, s[44:47], s72 offen offset:1024 sc1 lds
buffer_load_dwordx4 v1, s[44:47], s72 offen offset:2048 sc1 lds
buffer_load_dwordx4 v1, s[44:47], s72 offen offset:3072 sc1 lds
v_add_u32 v2, 0x8000, v1
v_lshrrev_b32 v3, 1, v0
v_lshlrev_b32 v3, 7, v3
s_waitcnt vmcnt(0)
s_barrier
v_accvgpr_write_b32 a32, 0
v_accvgpr_write_b32 a33, 0
v_accvgpr_write_b32 a34, 0
v_accvgpr_write_b32 a35, 0
v_accvgpr_write_b32 a36, 0
v_accvgpr_write_b32 a37, 0
v_accvgpr_write_b32 a38, 0
v_accvgpr_write_b32 a39, 0
v_accvgpr_write_b32 a40, 0
v_accvgpr_write_b32 a41, 0
v_accvgpr_write_b32 a42, 0
v_accvgpr_write_b32 a43, 0
v_accvgpr_write_b32 a44, 0
v_accvgpr_write_b32 a45, 0
v_accvgpr_write_b32 a46, 0
v_accvgpr_write_b32 a47, 0
v_accvgpr_write_b32 a48, 0
v_accvgpr_write_b32 a49, 0
v_accvgpr_write_b32 a50, 0
v_accvgpr_write_b32 a51, 0
v_accvgpr_write_b32 a52, 0
v_accvgpr_write_b32 a53, 0
v_accvgpr_write_b32 a54, 0
v_accvgpr_write_b32 a55, 0
v_accvgpr_write_b32 a56, 0
v_accvgpr_write_b32 a57, 0
v_accvgpr_write_b32 a58, 0
v_accvgpr_write_b32 a59, 0
v_accvgpr_write_b32 a60, 0
v_accvgpr_write_b32 a61, 0
v_accvgpr_write_b32 a62, 0
v_accvgpr_write_b32 a63, 0
v_accvgpr_write_b32 a96, 0
v_accvgpr_write_b32 a97, 0
v_accvgpr_write_b32 a98, 0
v_accvgpr_write_b32 a99, 0
v_accvgpr_write_b32 a100, 0
v_accvgpr_write_b32 a101, 0
v_accvgpr_write_b32 a102, 0
v_accvgpr_write_b32 a103, 0
v_accvgpr_write_b32 a104, 0
v_accvgpr_write_b32 a105, 0
v_accvgpr_write_b32 a106, 0
v_accvgpr_write_b32 a107, 0
v_accvgpr_write_b32 a108, 0
v_accvgpr_write_b32 a109, 0
v_accvgpr_write_b32 a110, 0
v_accvgpr_write_b32 a111, 0
v_accvgpr_write_b32 a112, 0
v_accvgpr_write_b32 a113, 0
v_accvgpr_write_b32 a114, 0
v_accvgpr_write_b32 a115, 0
v_accvgpr_write_b32 a116, 0
v_accvgpr_write_b32 a117, 0
v_accvgpr_write_b32 a118, 0
v_accvgpr_write_b32 a119, 0
v_accvgpr_write_b32 a120, 0
v_accvgpr_write_b32 a121, 0
v_accvgpr_write_b32 a122, 0
v_accvgpr_write_b32 a123, 0
v_accvgpr_write_b32 a124, 0
v_accvgpr_write_b32 a125, 0
v_accvgpr_write_b32 a126, 0
v_accvgpr_write_b32 a127, 0
ds_read_b128 a[128:131], v2 offset:16384
ds_read_b128 a[132:135], v2 offset:17408
ds_read_b128 a[136:139], v2 offset:18432
ds_read_b128 a[140:143], v2 offset:19456
ds_read_b128 a[144:147], v2 offset:20480
ds_read_b128 a[148:151], v2 offset:21504
ds_read_b128 a[152:155], v2 offset:22528
ds_read_b128 a[156:159], v2 offset:23552
s_branch Lattn
Lspin103:
s_mov_b32 s83, 262144
Lsl105:
s_sleep 2
buffer_load_dword v3, v2, s[44:47], s82 offen sc1
s_sub_u32 s83, s83, 1
s_cmp_eq_u32 s83, 0
s_waitcnt vmcnt(0)
s_cbranch_scc1 Lback104
v_cmp_gt_u32 vcc, 2, v3
s_cbranch_vccnz Lsl105
s_branch Lback104
Lspin106:
s_mov_b32 s83, 262144
Lsl108:
s_sleep 2
buffer_load_dword v3, v2, s[44:47], s82 offen sc1
s_sub_u32 s83, s83, 1
s_cmp_eq_u32 s83, 0
s_waitcnt vmcnt(0)
s_cbranch_scc1 Lback107
v_cmp_gt_u32 vcc, 2, v3
s_cbranch_vccnz Lsl108
s_branch Lback107
Lredo0:
s_xor_b32 s82, s78, 0
s_lshl_b32 s82, s82, 10
s_add_u32 s82, s82, s74
buffer_load_dword v3, v2, s[44:47], s82 offen sc1
s_waitcnt vmcnt(0)
v_cmp_gt_u32 vcc, 2, v3
s_cbranch_vccnz Lspin103
Lback104:
s_lshr_b32 s69, s12, 18
s_lshl_b32 s69, s69, 12
s_add_u32 s69, s69, s95
buffer_load_dwordx4 a[0:3], v1, s[44:47], s69 offen sc1
buffer_load_dwordx4 a[4:7], v1, s[44:47], s69 offen offset:1024 sc1
buffer_load_dwordx4 a[8:11], v1, s[44:47], s69 offen offset:2048 sc1
buffer_load_dwordx4 a[12:15], v1, s[44:47], s69 offen offset:3072 sc1
s_add_u32 s69, s69, 0x20000
buffer_load_dwordx4 a[16:19], v1, s[44:47], s69 offen sc1
buffer_load_dwordx4 a[20:23], v1, s[44:47], s69 offen offset:1024 sc1
buffer_load_dwordx4 a[24:27], v1, s[44:47], s69 offen offset:2048 sc1
buffer_load_dwordx4 a[28:31], v1, s[44:47], s69 offen offset:3072 sc1
s_lshr_b32 s69, s13, 18
s_lshl_b32 s69, s69, 12
s_add_u32 s69, s69, s95
buffer_load_dwordx4 a[32:35], v1, s[44:47], s69 offen sc1
buffer_load_dwordx4 a[36:39], v1, s[44:47], s69 offen offset:1024 sc1
buffer_load_dwordx4 a[40:43], v1, s[44:47], s69 offen offset:2048 sc1
buffer_load_dwordx4 a[44:47], v1, s[44:47], s69 offen offset:3072 sc1
s_add_u32 s69, s69, 0x20000
buffer_load_dwordx4 a[48:51], v1, s[44:47], s69 offen sc1
buffer_load_dwordx4 a[52:55], v1, s[44:47], s69 offen offset:1024 sc1
buffer_load_dwordx4 a[56:59], v1, s[44:47], s69 offen offset:2048 sc1
buffer_load_dwordx4 a[60:63], v1, s[44:47], s69 offen offset:3072 sc1
s_waitcnt vmcnt(8)
s_branch Lredo0b
Lspin109:
s_mov_b32 s83, 262144
Lsl111:
s_sleep 2
buffer_load_dword v114, v115, s[44:47], s84 offen sc1
s_sub_u32 s83, s83, 1
s_cmp_eq_u32 s83, 0
s_waitcnt vmcnt(0)
s_cbranch_scc1 Lback110
v_cmp_gt_u32 vcc, 3, v114
s_cbranch_vccnz Lsl111
s_branch Lback110
Lspin112:
s_mov_b32 s83, 262144
Lsl114:
s_sleep 2
buffer_load_dword v14, v13, s[44:47], s79 offen sc1
s_sub_u32 s83, s83, 1
s_cmp_eq_u32 s83, 0
s_waitcnt vmcnt(0)
s_cbranch_scc1 Lback113
v_cmp_gt_u32 vcc, 2, v14
s_cbranch_vccnz Lsl114
s_branch Lback113
Lxspin1:
s_mov_b32 s83, 262144
Lxsl1:
buffer_load_dwordx4 v[96:99], v1, s[44:47], s79 offen sc1
buffer_load_dwordx4 v[100:103], v1, s[44:47], s79 offen offset:1024 sc1
buffer_load_dwordx4 v[104:107], v1, s[44:47], s79 offen offset:2048 sc1
buffer_load_dwordx4 v[108:111], v1, s[44:47], s79 offen offset:3072 sc1
s_sub_u32 s83, s83, 1
s_cmp_eq_u32 s83, 0
s_waitcnt vmcnt(0)
s_cbranch_scc1 Lxback1
v_max3_u32 v12, v96, v97, v98
v_max3_u32 v13, v99, v100, v101
v_max3_u32 v12, v12, v102, v103
v_max3_u32 v13, v13, v104, v105
v_max3_u32 v12, v12, v106, v107
v_max3_u32 v13, v13, v108, v109
v_max3_u32 v12, v12, v110, v111
v_max_u32 v12, v12, v13
v_cmp_le_u32 vcc, 0xff800000, v12
s_cbranch_vccnz Lxsl1
s_branch Lxback1
Lxspin2:
s_mov_b32 s83, 262144
Lxsl2:
buffer_load_dwordx4 v[80:83], v1, s[44:47], s82 offen sc1
buffer_load_dwordx4 v[84:87], v1, s[44:47], s82 offen offset:1024 sc1
buffer_load_dwordx4 v[88:91], v1, s[44:47], s82 offen offset:2048 sc1
buffer_load_dwordx4 v[92:95], v1, s[44:47], s82 offen offset:3072 sc1
s_sub_u32 s83, s83, 1
s_cmp_eq_u32 s83, 0
s_waitcnt vmcnt(0)
s_cbranch_scc1 Lxback2
v_max3_u32 v12, v80, v81, v82
v_max3_u32 v13, v83, v84, v85
v_max3_u32 v12, v12, v86, v87
v_max3_u32 v13, v13, v88, v89
v_max3_u32 v12, v12, v90, v91
v_max3_u32 v13, v13, v92, v93
v_max3_u32 v12, v12, v94, v95
v_max_u32 v12, v12, v13
v_cmp_le_u32 vcc, 0xff800000, v12
s_cbranch_vccnz Lxsl2
s_branch Lxback2
Lxspin3:
s_mov_b32 s83, 262144
Lxsl3:
buffer_load_dwordx4 v[96:99], v1, s[44:47], s81 offen sc1
buffer_load_dwordx4 v[100:103], v1, s[44:47], s81 offen offset:1024 sc1
buffer_load_dwordx4 v[104:107], v1, s[44:47], s81 offen offset:2048 sc1
buffer_load_dwordx4 v[108:111], v1, s[44:47], s81 offen offset:3072 sc1
s_sub_u32 s83, s83, 1
s_cmp_eq_u32 s83, 0
s_waitcnt vmcnt(0)
s_cbranch_scc1 Lxback3
v_max3_u32 v12, v96, v97, v98
v_max3_u32 v13, v99, v100, v101
v_max3_u32 v12, v12, v102, v103
v_max3_u32 v13, v13, v104, v105
v_max3_u32 v12, v12, v106, v107
v_max3_u32 v13, v13, v108, v109
v_max3_u32 v12, v12, v110, v111
v_max_u32 v12, v12, v13
v_cmp_le_u32 vcc, 0xff800000, v12
s_cbranch_vccnz Lxsl3
s_branch Lxback3
Lcode_end:
s_endpgm
.section .rodata,"a"
.p2align 6
.amdhsa_kernel gated_mix__compressed_kv_cla__ssm_conv_h3__prompt_kernel
  .amdhsa_next_free_vgpr 512
  .amdhsa_next_free_sgpr 102
  .amdhsa_accum_offset 256
  .amdhsa_group_segment_fixed_size 0
  .amdhsa_kernarg_size 128
  .amdhsa_user_sgpr_count 2
  .amdhsa_user_sgpr_kernarg_segment_ptr 1
  .amdhsa_system_sgpr_workgroup_id_x 1
  .amdhsa_float_denorm_mode_32 3
.end_amdhsa_kernel
```

```asm
; @launch grid=(256,1,1) block=(256,1,1) lds=163840
.amdgcn_target "amdgcn-amd-amdhsa--gfx950"
.text
.globl gated_mix__compressed_kv_cla__ssm_conv_h3__prompt_kernel
.p2align 8
.type gated_mix__compressed_kv_cla__ssm_conv_h3__prompt_kernel,@function
gated_mix__compressed_kv_cla__ssm_conv_h3__prompt_kernel:
s_cmp_ge_u32 s2, 256
s_cbranch_scc1 Lend
s_load_dwordx2 s[8:9], s[0:1], 8
s_load_dwordx2 s[16:17], s[0:1], 24
s_load_dwordx2 s[20:21], s[0:1], 32
s_load_dwordx2 s[4:5], s[0:1], 0
s_load_dwordx2 s[12:13], s[0:1], 16
s_load_dwordx2 s[24:25], s[0:1], 40
s_load_dwordx2 s[28:29], s[0:1], 56
s_load_dwordx2 s[32:33], s[0:1], 64
s_load_dwordx2 s[52:53], s[0:1], 72
s_load_dwordx2 s[36:37], s[0:1], 80
s_load_dwordx2 s[54:55], s[0:1], 88
s_load_dwordx2 s[56:57], s[0:1], 96
s_load_dwordx2 s[40:41], s[0:1], 104
s_load_dwordx2 s[48:49], s[0:1], 112
s_load_dwordx2 s[44:45], s[0:1], 120
s_getpc_b64 s[98:99]
Lpc0:
s_lshr_b32 s75, s2, 3
v_lshrrev_b32 v26, 3, v0
s_lshl_b32 s73, s75, 12
v_lshlrev_b32 v26, 7, v26
v_add_u32 v26, s73, v26
v_min_u32 v26, Lcode_end-Lpc0, v26
global_load_dword v31, v26, s[98:99]
v_lshrrev_b32 v26, 6, v0
v_and_b32 v0, 63, v0
s_and_b32 s73, s2, 7
v_readfirstlane_b32 s58, v26
s_lshr_b32 s65, s75, 3
s_and_b32 s60, s75, 7
s_lshl_b32 s59, s73, 2
s_add_u32 s59, s59, s65
s_lshl_b32 s61, s65, 1
s_lshl_b32 s63, s58, 13
s_lshl_b32 s64, s58, 12
s_lshl_b32 s67, s60, 18
s_lshl_b32 s76, s58, 16
s_add_u32 s84, s67, s76
s_lshl_b32 s66, s58, 17
s_lshl_b32 s73, s59, 8
s_add_u32 s66, s66, s73
v_lshrrev_b32 v26, 4, v0
v_and_b32 v27, 7, v0
v_xor_b32 v27, v27, v26
v_lshlrev_b32 v27, 4, v27
v_lshrrev_b32 v28, 3, v0
v_lshl_add_u32 v2, v28, 10, v27
v_xor_b32 v3, 64, v2
v_and_b32 v29, 15, v0
v_lshlrev_b32 v30, 1, v26
v_xor_b32 v30, v30, v29
v_lshlrev_b32 v30, 4, v30
v_lshl_add_u32 v6, v26, 13, v30
v_xor_b32 v7, 0x80, v6
s_mov_b32 s10, 0x200000
s_mov_b32 s11, 0x20000
s_mov_b32 s18, 0x400000
s_mov_b32 s19, 0x20000
s_mov_b32 s22, 0x400000
s_mov_b32 s23, 0x20000
s_lshl_b32 s73, s2, 2
s_add_u32 s73, s73, s58
s_lshl_b32 s73, s73, 11
v_lshrrev_b32 v124, 2, v0
v_lshlrev_b32 v124, 7, v124
v_add_u32 v124, s73, v124
s_lshl_b32 s73, s60, 2
s_add_u32 s73, s73, s58
s_lshl_b32 s73, s73, 13
s_lshl_b32 s74, s59, 8
s_add_u32 s73, s73, s74
v_lshrrev_b32 v125, 4, v0
v_lshlrev_b32 v125, 18, v125
v_bfe_u32 v126, v0, 3, 1
v_lshl_add_u32 v125, v126, 7, v125
v_add_u32 v125, s73, v125
s_waitcnt lgkmcnt(0)
s_mov_b32 s80, 0x0
buffer_load_dword v126, v125, s[16:19], s80 offen nt
buffer_load_dword v126, v125, s[16:19], s80 offen sc1
buffer_load_dword v126, v125, s[20:23], s80 offen nt
buffer_load_dword v126, v125, s[20:23], s80 offen sc1
s_and_b32 s73, s65, 1
s_xor_b32 s73, s73, 0
s_lshl_b32 s69, s73, 7
s_add_u32 s69, s69, s84
s_lshl_b32 s71, s73, 19
s_add_u32 s71, s71, s66
s_add_u32 m0, s63, 65536
s_add_u32 s72, s69, 0
buffer_load_dwordx4 v2, s[8:11], s72 offen lds
s_add_u32 s72, s69, 7168
buffer_load_dwordx4 v3, s[8:11], s72 offen offset:1024 lds
s_add_u32 s72, s69, 14336
buffer_load_dwordx4 v2, s[8:11], s72 offen offset:2048 lds
s_add_u32 s72, s69, 21504
buffer_load_dwordx4 v3, s[8:11], s72 offen offset:3072 lds
s_add_u32 m0, s64, 0
s_add_u32 s72, s71, 0
buffer_load_dwordx4 v6, s[16:19], s72 offen nt lds
s_add_u32 s72, s71, 31744
buffer_load_dwordx4 v6, s[16:19], s72 offen offset:1024 nt lds
s_add_u32 s72, s71, 63488
buffer_load_dwordx4 v7, s[16:19], s72 offen offset:2048 nt lds
s_add_u32 s72, s71, 95232
buffer_load_dwordx4 v7, s[16:19], s72 offen offset:3072 nt lds
s_add_u32 m0, s63, 69632
s_add_u32 s72, s69, 32768
buffer_load_dwordx4 v2, s[8:11], s72 offen lds
s_add_u32 s72, s69, 39936
buffer_load_dwordx4 v3, s[8:11], s72 offen offset:1024 lds
s_add_u32 s72, s69, 47104
buffer_load_dwordx4 v2, s[8:11], s72 offen offset:2048 lds
s_add_u32 s72, s69, 54272
buffer_load_dwordx4 v3, s[8:11], s72 offen offset:3072 lds
s_add_u32 m0, s64, 16384
s_add_u32 s72, s71, 0
buffer_load_dwordx4 v6, s[20:23], s72 offen nt lds
s_add_u32 s72, s71, 31744
buffer_load_dwordx4 v6, s[20:23], s72 offen offset:1024 nt lds
s_add_u32 s72, s71, 63488
buffer_load_dwordx4 v7, s[20:23], s72 offen offset:2048 nt lds
s_add_u32 s72, s71, 95232
buffer_load_dwordx4 v7, s[20:23], s72 offen offset:3072 nt lds
buffer_load_dword v126, v124, s[8:11], 0 offen
s_and_b32 s73, s65, 1
s_xor_b32 s73, s73, 1
s_lshl_b32 s69, s73, 7
s_add_u32 s69, s69, s84
s_lshl_b32 s71, s73, 19
s_add_u32 s71, s71, s66
s_add_u32 m0, s63, 98304
s_add_u32 s72, s69, 0
buffer_load_dwordx4 v2, s[8:11], s72 offen lds
s_add_u32 s72, s69, 7168
buffer_load_dwordx4 v3, s[8:11], s72 offen offset:1024 lds
s_add_u32 s72, s69, 14336
buffer_load_dwordx4 v2, s[8:11], s72 offen offset:2048 lds
s_add_u32 s72, s69, 21504
buffer_load_dwordx4 v3, s[8:11], s72 offen offset:3072 lds
s_branch Lmain
.p2align 12
Lmain:
s_mov_b32 s6, 0x400000
s_mov_b32 s7, 0x20000
s_mov_b32 s14, 0x800000
s_mov_b32 s15, 0x20000
s_mov_b32 s26, 0x800000
s_mov_b32 s27, 0x20000
s_mov_b32 s30, 0x400000
s_mov_b32 s31, 0x20000
s_mov_b32 s34, 0x400000
s_mov_b32 s35, 0x20000
s_mov_b32 s38, 0x400000
s_mov_b32 s39, 0x20000
s_mov_b32 s42, 0x400000
s_mov_b32 s43, 0x20000
s_mov_b32 s46, 0x5800000
s_mov_b32 s47, 0x20000
s_mov_b32 s50, 0x100
s_mov_b32 s51, 0x20000
v_lshl_add_u32 v4, v28, 11, v27
v_xor_b32 v5, 64, v4
v_lshlrev_b32 v1, 4, v0
s_sub_u32 s74, 15, s60
s_lshl_b32 s68, s74, 18
s_lshl_b32 s76, s58, 15
s_add_u32 s68, s68, s76
s_add_u32 s67, s67, s76
s_and_b32 s62, s60, 3
s_sub_u32 s62, 16, s62
s_lshl_b32 s91, s59, 3
s_add_u32 s91, s91, s60
s_lshl_b32 s93, s91, 2
s_add_u32 s93, s93, s58
s_lshl_b32 s91, s91, 7
s_add_u32 s91, s91, 0x3810000
s_lshl_b32 s75, s93, 1
s_and_b32 s75, s75, 0xffc
s_lshl_b32 s93, s93, 12
s_load_dwordx2 s[88:89], s[36:37], s93
s_load_dword s90, s[54:55], s75
v_or_b32 v29, s58, v0
v_mov_b32 v30, 0
v_min_u32 v29, 1, v29
v_lshlrev_b32 v29, 30, v29
buffer_store_dword v30, v29, s[44:47], s91 offen sc1
s_and_b32 s73, s2, 15
s_lshr_b32 s74, s2, 4
s_lshl_b32 s74, s74, 7
s_lshl_b32 s75, s58, 5
s_add_u32 s74, s74, s75
s_mov_b32 s75, 131072
v_lshrrev_b32 v29, 5, v0
v_lshlrev_b32 v29, 4, v29
v_add_u32 v29, s74, v29
v_and_b32 v30, 31, v0
s_lshl_b32 s73, s73, 5
v_add_u32 v30, s73, v30
v_lshlrev_b32 v26, 11, v29
v_lshl_add_u32 v26, v30, 2, v26
v_subrev_u32 v27, 0x1800, v26
s_lshl_b32 s82, s74, 11
s_lshl_b32 s73, s73, 2
s_add_u32 s82, s82, s73
v_lshrrev_b32 v26, 3, v0
v_and_b32 v32, 7, v0
v_lshlrev_b32 v32, 4, v32
v_lshl_add_u32 v26, v26, 11, v32
v_lshrrev_b32 v98, 5, v0
v_lshlrev_b32 v98, 11, v98
v_and_b32 v32, 31, v0
v_lshl_add_u32 v98, v32, 2, v98
v_add_u32 v98, s63, v98
v_add_u32 v98, s75, v98
v_and_b32 v29, 0x7f, v29
v_sub_u32 v29, 0x70, v29
v_lshlrev_b32 v29, 1, v29
v_and_b32 v32, 31, v0
v_mul_u32_u24 v32, 544, v32
v_add3_u32 v28, v32, v29, s75
v_lshlrev_b32 v30, 4, v30
s_lshl_b32 s73, s2, 14
s_lshl_b32 s74, s58, 12
s_add_u32 s76, s73, s74
v_and_b32 v29, 15, v0
v_lshrrev_b32 v32, 4, v0
v_lshrrev_b32 v24, 1, v29
v_xor_b32 v24, v24, v32
v_lshlrev_b32 v24, 4, v24
v_lshl_add_u32 v24, v29, 7, v24
s_add_u32 s73, s63, 131072
v_add_u32 v16, s73, v24
v_xor_b32 v17, 64, v16
v_subrev_u32 v18, 0x10000, v16
v_subrev_u32 v19, 0x10000, v17
s_lshr_b32 s73, s58, 1
s_lshl_b32 s74, s73, 14
s_add_u32 s74, s74, 0x10000
v_add_u32 v24, s74, v24
v_xor_b32 v25, 64, v24
v_lshrrev_b32 v8, 2, v29
v_and_b32 v9, 1, v32
v_lshl_add_u32 v9, v9, 2, v8
v_lshl_add_u32 v8, v32, 3, v8
v_lshlrev_b32 v8, 8, v8
v_lshl_add_u32 v8, v9, 5, v8
v_and_b32 v29, 3, v0
v_lshl_add_u32 v8, v29, 3, v8
s_and_b32 s74, s58, 1
s_lshl_b32 s75, s74, 7
v_xor_b32 v20, s75, v8
v_xor_b32 v9, 32, v8
v_xor_b32 v10, 64, v8
v_xor_b32 v11, 96, v8
v_xor_b32 v12, 128, v8
v_xor_b32 v13, 160, v8
v_xor_b32 v14, 192, v8
v_xor_b32 v15, 224, v8
v_xor_b32 v21, 32, v20
v_xor_b32 v22, 64, v20
v_xor_b32 v23, 96, v20
s_lshl_b32 s77, s59, 20
s_add_u32 s81, s77, s64
s_sub_u32 s81, s81, 0x4000
s_lshl_b32 s75, s60, 17
s_add_u32 s77, s77, s75
s_lshl_b32 s73, s73, 16
s_add_u32 s77, s77, s73
s_lshl_b32 s75, s74, 12
s_add_u32 s78, s77, s75
s_add_u32 s78, s78, 0x4000
s_lshl_b32 s75, s74, 11
s_add_u32 s77, s77, s75
s_mov_b32 s79, 0x3e0293ee
s_waitcnt vmcnt(6)
s_barrier
ds_read_b64_tr_b16 v[224:225], v20 offset:0
ds_read_b64_tr_b16 v[226:227], v20 offset:1024
ds_read_b64_tr_b16 v[228:229], v20 offset:8192
ds_read_b64_tr_b16 v[230:231], v20 offset:9216
ds_read_b128 v[128:131], v24 offset:0
ds_read_b128 v[132:135], v25 offset:0
ds_read_b128 v[136:139], v24 offset:2048
ds_read_b128 v[140:143], v25 offset:2048
ds_read_b128 v[144:147], v24 offset:4096
ds_read_b128 v[148:151], v25 offset:4096
ds_read_b128 v[152:155], v24 offset:6144
ds_read_b128 v[156:159], v25 offset:6144
ds_read_b128 v[160:163], v24 offset:8192
ds_read_b128 v[164:167], v25 offset:8192
ds_read_b128 v[168:171], v24 offset:10240
ds_read_b128 v[172:175], v25 offset:10240
ds_read_b128 v[176:179], v24 offset:12288
ds_read_b128 v[180:183], v25 offset:12288
ds_read_b128 v[184:187], v24 offset:14336
ds_read_b128 v[188:191], v25 offset:14336
ds_read_b64_tr_b16 v[232:233], v21 offset:0
ds_read_b64_tr_b16 v[234:235], v21 offset:1024
ds_read_b64_tr_b16 v[236:237], v21 offset:8192
ds_read_b64_tr_b16 v[238:239], v21 offset:9216
s_waitcnt lgkmcnt(0)
v_mfma_f32_16x16x32_bf16 a[0:3], v[224:227], v[128:131], 0
s_add_u32 m0, s64, 32768
ds_read_b64_tr_b16 v[240:241], v22 offset:0
v_mfma_f32_16x16x32_bf16 a[0:3], v[228:231], v[132:135], a[0:3]
s_add_u32 s72, s71, 0
buffer_load_dwordx4 v6, s[16:19], s72 offen lds
v_mfma_f32_16x16x32_bf16 a[4:7], v[228:231], v[140:143], 0
s_add_u32 s72, s71, 31744
buffer_load_dwordx4 v6, s[16:19], s72 offen offset:1024 lds
v_mfma_f32_16x16x32_bf16 a[4:7], v[224:227], v[136:139], a[4:7]
ds_read_b64_tr_b16 v[242:243], v22 offset:1024
v_mfma_f32_16x16x32_bf16 a[8:11], v[224:227], v[144:147], 0
s_add_u32 s72, s71, 63488
buffer_load_dwordx4 v7, s[16:19], s72 offen offset:2048 lds
v_mfma_f32_16x16x32_bf16 a[8:11], v[228:231], v[148:151], a[8:11]
v_mfma_f32_16x16x32_bf16 a[12:15], v[228:231], v[156:159], 0
s_add_u32 s72, s71, 95232
buffer_load_dwordx4 v7, s[16:19], s72 offen offset:3072 lds
v_mfma_f32_16x16x32_bf16 a[12:15], v[224:227], v[152:155], a[12:15]
ds_read_b64_tr_b16 v[244:245], v22 offset:8192
v_mfma_f32_16x16x32_bf16 a[16:19], v[224:227], v[160:163], 0
s_add_u32 m0, s63, 102400
v_mfma_f32_16x16x32_bf16 a[16:19], v[228:231], v[164:167], a[16:19]
s_add_u32 s72, s69, 32768
buffer_load_dwordx4 v2, s[8:11], s72 offen lds
v_mfma_f32_16x16x32_bf16 a[20:23], v[228:231], v[172:175], 0
s_add_u32 s72, s69, 39936
buffer_load_dwordx4 v3, s[8:11], s72 offen offset:1024 lds
v_mfma_f32_16x16x32_bf16 a[20:23], v[224:227], v[168:171], a[20:23]
ds_read_b64_tr_b16 v[246:247], v22 offset:9216
v_mfma_f32_16x16x32_bf16 a[24:27], v[224:227], v[176:179], 0
s_add_u32 s72, s69, 47104
buffer_load_dwordx4 v2, s[8:11], s72 offen offset:2048 lds
v_mfma_f32_16x16x32_bf16 a[24:27], v[228:231], v[180:183], a[24:27]
v_mfma_f32_16x16x32_bf16 a[28:31], v[228:231], v[188:191], 0
s_add_u32 s72, s69, 54272
buffer_load_dwordx4 v3, s[8:11], s72 offen offset:3072 lds
v_mfma_f32_16x16x32_bf16 a[28:31], v[224:227], v[184:187], a[28:31]
v_mfma_f32_16x16x32_bf16 a[60:63], v[232:235], v[184:187], 0
s_add_u32 m0, s64, 49152
ds_read_b64_tr_b16 v[248:249], v23 offset:0
v_mfma_f32_16x16x32_bf16 a[60:63], v[236:239], v[188:191], a[60:63]
s_add_u32 s72, s71, 0
buffer_load_dwordx4 v6, s[20:23], s72 offen lds
v_mfma_f32_16x16x32_bf16 a[56:59], v[236:239], v[180:183], 0
s_add_u32 s72, s71, 31744
buffer_load_dwordx4 v6, s[20:23], s72 offen offset:1024 lds
v_mfma_f32_16x16x32_bf16 a[56:59], v[232:235], v[176:179], a[56:59]
ds_read_b64_tr_b16 v[250:251], v23 offset:1024
v_mfma_f32_16x16x32_bf16 a[52:55], v[232:235], v[168:171], 0
s_add_u32 s72, s71, 63488
buffer_load_dwordx4 v7, s[20:23], s72 offen offset:2048 lds
v_mfma_f32_16x16x32_bf16 a[52:55], v[236:239], v[172:175], a[52:55]
v_mfma_f32_16x16x32_bf16 a[48:51], v[236:239], v[164:167], 0
s_add_u32 s72, s71, 95232
buffer_load_dwordx4 v7, s[20:23], s72 offen offset:3072 lds
v_mfma_f32_16x16x32_bf16 a[48:51], v[232:235], v[160:163], a[48:51]
s_mov_b32 s80, 0x100000
buffer_load_dword v126, v125, s[16:19], s80 offen nt
v_mfma_f32_16x16x32_bf16 a[44:47], v[232:235], v[152:155], 0
buffer_load_dword v126, v125, s[16:19], s80 offen sc1
v_mfma_f32_16x16x32_bf16 a[44:47], v[236:239], v[156:159], a[44:47]
buffer_load_dword v126, v125, s[20:23], s80 offen nt
v_mfma_f32_16x16x32_bf16 a[40:43], v[236:239], v[148:151], 0
buffer_load_dword v126, v125, s[20:23], s80 offen sc1
v_mfma_f32_16x16x32_bf16 a[40:43], v[232:235], v[144:147], a[40:43]
ds_read_b64_tr_b16 v[252:253], v23 offset:8192
v_mfma_f32_16x16x32_bf16 a[36:39], v[232:235], v[136:139], 0
ds_read_b64_tr_b16 v[254:255], v23 offset:9216
v_mfma_f32_16x16x32_bf16 a[36:39], v[236:239], v[140:143], a[36:39]
v_mfma_f32_16x16x32_bf16 a[32:35], v[236:239], v[132:135], 0
v_mfma_f32_16x16x32_bf16 a[32:35], v[232:235], v[128:131], a[32:35]
s_waitcnt lgkmcnt(4)
v_mfma_f32_16x16x32_bf16 a[64:67], v[240:243], v[128:131], 0
ds_read_b64_tr_b16 v[224:225], v20 offset:16384
v_mfma_f32_16x16x32_bf16 a[64:67], v[244:247], v[132:135], a[64:67]
v_mfma_f32_16x16x32_bf16 a[68:71], v[244:247], v[140:143], 0
v_mfma_f32_16x16x32_bf16 a[68:71], v[240:243], v[136:139], a[68:71]
ds_read_b64_tr_b16 v[226:227], v20 offset:17408
v_mfma_f32_16x16x32_bf16 a[72:75], v[240:243], v[144:147], 0
v_mfma_f32_16x16x32_bf16 a[72:75], v[244:247], v[148:151], a[72:75]
v_mfma_f32_16x16x32_bf16 a[76:79], v[244:247], v[156:159], 0
v_mfma_f32_16x16x32_bf16 a[76:79], v[240:243], v[152:155], a[76:79]
ds_read_b64_tr_b16 v[228:229], v20 offset:24576
v_mfma_f32_16x16x32_bf16 a[80:83], v[240:243], v[160:163], 0
v_mfma_f32_16x16x32_bf16 a[80:83], v[244:247], v[164:167], a[80:83]
v_mfma_f32_16x16x32_bf16 a[84:87], v[244:247], v[172:175], 0
ds_read_b64_tr_b16 v[230:231], v20 offset:25600
v_mfma_f32_16x16x32_bf16 a[84:87], v[240:243], v[168:171], a[84:87]
v_mfma_f32_16x16x32_bf16 a[88:91], v[240:243], v[176:179], 0
v_mfma_f32_16x16x32_bf16 a[88:91], v[244:247], v[180:183], a[88:91]
v_mfma_f32_16x16x32_bf16 a[92:95], v[244:247], v[188:191], 0
v_mfma_f32_16x16x32_bf16 a[92:95], v[240:243], v[184:187], a[92:95]
s_waitcnt lgkmcnt(4)
v_mfma_f32_16x16x32_bf16 a[124:127], v[248:251], v[184:187], 0
ds_read_b64_tr_b16 v[232:233], v21 offset:16384
v_mfma_f32_16x16x32_bf16 a[124:127], v[252:255], v[188:191], a[124:127]
v_mfma_f32_16x16x32_bf16 a[120:123], v[252:255], v[180:183], 0
v_mfma_f32_16x16x32_bf16 a[120:123], v[248:251], v[176:179], a[120:123]
ds_read_b64_tr_b16 v[234:235], v21 offset:17408
v_mfma_f32_16x16x32_bf16 a[116:119], v[248:251], v[168:171], 0
v_mfma_f32_16x16x32_bf16 a[116:119], v[252:255], v[172:175], a[116:119]
v_mfma_f32_16x16x32_bf16 a[112:115], v[252:255], v[164:167], 0
v_mfma_f32_16x16x32_bf16 a[112:115], v[248:251], v[160:163], a[112:115]
ds_read_b64_tr_b16 v[236:237], v21 offset:24576
v_mfma_f32_16x16x32_bf16 a[108:111], v[248:251], v[152:155], 0
v_mfma_f32_16x16x32_bf16 a[108:111], v[252:255], v[156:159], a[108:111]
v_mfma_f32_16x16x32_bf16 a[104:107], v[252:255], v[148:151], 0
ds_read_b64_tr_b16 v[238:239], v21 offset:25600
v_mfma_f32_16x16x32_bf16 a[104:107], v[248:251], v[144:147], a[104:107]
v_mfma_f32_16x16x32_bf16 a[100:103], v[248:251], v[136:139], 0
v_mfma_f32_16x16x32_bf16 a[100:103], v[252:255], v[140:143], a[100:103]
v_mfma_f32_16x16x32_bf16 a[96:99], v[252:255], v[132:135], 0
v_mfma_f32_16x16x32_bf16 a[96:99], v[248:251], v[128:131], a[96:99]
s_waitcnt lgkmcnt(4)
v_mfma_f32_16x16x32_bf16 a[128:131], v[128:131], v[224:227], 0
ds_read_b64_tr_b16 v[240:241], v22 offset:16384
v_mfma_f32_16x16x32_bf16 a[128:131], v[132:135], v[228:231], a[128:131]
v_mfma_f32_16x16x32_bf16 a[132:135], v[140:143], v[228:231], 0
v_mfma_f32_16x16x32_bf16 a[132:135], v[136:139], v[224:227], a[132:135]
ds_read_b64_tr_b16 v[242:243], v22 offset:17408
v_mfma_f32_16x16x32_bf16 a[136:139], v[144:147], v[224:227], 0
v_mfma_f32_16x16x32_bf16 a[136:139], v[148:151], v[228:231], a[136:139]
v_mfma_f32_16x16x32_bf16 a[140:143], v[156:159], v[228:231], 0
v_mfma_f32_16x16x32_bf16 a[140:143], v[152:155], v[224:227], a[140:143]
ds_read_b64_tr_b16 v[244:245], v22 offset:24576
v_mfma_f32_16x16x32_bf16 a[144:147], v[160:163], v[224:227], 0
v_mfma_f32_16x16x32_bf16 a[144:147], v[164:167], v[228:231], a[144:147]
v_mfma_f32_16x16x32_bf16 a[148:151], v[172:175], v[228:231], 0
ds_read_b64_tr_b16 v[246:247], v22 offset:25600
v_mfma_f32_16x16x32_bf16 a[148:151], v[168:171], v[224:227], a[148:151]
v_mfma_f32_16x16x32_bf16 a[152:155], v[176:179], v[224:227], 0
v_mfma_f32_16x16x32_bf16 a[152:155], v[180:183], v[228:231], a[152:155]
v_mfma_f32_16x16x32_bf16 a[156:159], v[188:191], v[228:231], 0
v_mfma_f32_16x16x32_bf16 a[156:159], v[184:187], v[224:227], a[156:159]
s_waitcnt lgkmcnt(4)
v_mfma_f32_16x16x32_bf16 a[188:191], v[184:187], v[232:235], 0
ds_read_b64_tr_b16 v[248:249], v23 offset:16384
v_mfma_f32_16x16x32_bf16 a[188:191], v[188:191], v[236:239], a[188:191]
v_mfma_f32_16x16x32_bf16 a[184:187], v[180:183], v[236:239], 0
ds_read_b64_tr_b16 v[250:251], v23 offset:17408
v_mfma_f32_16x16x32_bf16 a[184:187], v[176:179], v[232:235], a[184:187]
v_mfma_f32_16x16x32_bf16 a[180:183], v[168:171], v[232:235], 0
ds_read_b64_tr_b16 v[252:253], v23 offset:24576
v_mfma_f32_16x16x32_bf16 a[180:183], v[172:175], v[236:239], a[180:183]
v_mfma_f32_16x16x32_bf16 a[176:179], v[164:167], v[236:239], 0
ds_read_b64_tr_b16 v[254:255], v23 offset:25600
v_mfma_f32_16x16x32_bf16 a[176:179], v[160:163], v[232:235], a[176:179]
v_mfma_f32_16x16x32_bf16 a[172:175], v[152:155], v[232:235], 0
v_mfma_f32_16x16x32_bf16 a[172:175], v[156:159], v[236:239], a[172:175]
v_mfma_f32_16x16x32_bf16 a[168:171], v[148:151], v[236:239], 0
v_mfma_f32_16x16x32_bf16 a[168:171], v[144:147], v[232:235], a[168:171]
v_mfma_f32_16x16x32_bf16 a[164:167], v[136:139], v[232:235], 0
v_mfma_f32_16x16x32_bf16 a[164:167], v[140:143], v[236:239], a[164:167]
v_mfma_f32_16x16x32_bf16 a[160:163], v[132:135], v[236:239], 0
s_waitcnt vmcnt(4) lgkmcnt(0)
v_mfma_f32_16x16x32_bf16 a[160:163], v[128:131], v[232:235], a[160:163]
s_barrier
v_mfma_f32_16x16x32_bf16 a[192:195], v[128:131], v[240:243], 0
s_and_b32 s73, s65, 1
ds_read_b64_tr_b16 v[224:225], v20 offset:32768
v_mfma_f32_16x16x32_bf16 a[192:195], v[132:135], v[244:247], a[192:195]
s_xor_b32 s73, s73, 2
ds_read_b64_tr_b16 v[226:227], v20 offset:33792
v_mfma_f32_16x16x32_bf16 a[196:199], v[140:143], v[244:247], 0
s_lshl_b32 s69, s73, 7
ds_read_b64_tr_b16 v[228:229], v20 offset:40960
v_mfma_f32_16x16x32_bf16 a[196:199], v[136:139], v[240:243], a[196:199]
s_add_u32 s69, s69, s84
ds_read_b64_tr_b16 v[230:231], v20 offset:41984
v_mfma_f32_16x16x32_bf16 a[200:203], v[144:147], v[240:243], 0
s_lshl_b32 s71, s73, 19
ds_read_b128 v[192:195], v24 offset:32768
v_mfma_f32_16x16x32_bf16 a[200:203], v[148:151], v[244:247], a[200:203]
s_add_u32 s71, s71, s66
ds_read_b128 v[196:199], v25 offset:32768
v_mfma_f32_16x16x32_bf16 a[204:207], v[156:159], v[244:247], 0
s_add_u32 m0, s63, 65536
v_mfma_f32_16x16x32_bf16 a[204:207], v[152:155], v[240:243], a[204:207]
s_add_u32 s72, s69, 0
buffer_load_dwordx4 v2, s[8:11], s72 offen lds
v_mfma_f32_16x16x32_bf16 a[208:211], v[160:163], v[240:243], 0
s_add_u32 s72, s69, 7168
buffer_load_dwordx4 v3, s[8:11], s72 offen offset:1024 lds
v_mfma_f32_16x16x32_bf16 a[208:211], v[164:167], v[244:247], a[208:211]
s_add_u32 s72, s69, 14336
buffer_load_dwordx4 v2, s[8:11], s72 offen offset:2048 lds
v_mfma_f32_16x16x32_bf16 a[212:215], v[172:175], v[244:247], 0
ds_read_b128 v[200:203], v24 offset:34816
v_mfma_f32_16x16x32_bf16 a[212:215], v[168:171], v[240:243], a[212:215]
ds_read_b128 v[204:207], v25 offset:34816
v_mfma_f32_16x16x32_bf16 a[216:219], v[176:179], v[240:243], 0
s_add_u32 s72, s69, 21504
buffer_load_dwordx4 v3, s[8:11], s72 offen offset:3072 lds
v_mfma_f32_16x16x32_bf16 a[216:219], v[180:183], v[244:247], a[216:219]
ds_read_b128 v[208:211], v24 offset:36864
v_mfma_f32_16x16x32_bf16 a[220:223], v[188:191], v[244:247], 0
ds_read_b128 v[212:215], v25 offset:36864
v_mfma_f32_16x16x32_bf16 a[220:223], v[184:187], v[240:243], a[220:223]
ds_read_b128 v[216:219], v24 offset:38912
v_mfma_f32_16x16x32_bf16 a[252:255], v[184:187], v[248:251], 0
ds_read_b128 v[220:223], v25 offset:38912
v_mfma_f32_16x16x32_bf16 a[252:255], v[188:191], v[252:255], a[252:255]
s_add_u32 m0, s64, 0
v_mfma_f32_16x16x32_bf16 a[248:251], v[180:183], v[252:255], 0
s_add_u32 s72, s71, 0
buffer_load_dwordx4 v6, s[16:19], s72 offen lds
v_mfma_f32_16x16x32_bf16 a[248:251], v[176:179], v[248:251], a[248:251]
ds_read_b128 v[184:187], v24 offset:40960
v_mfma_f32_16x16x32_bf16 a[244:247], v[168:171], v[248:251], 0
ds_read_b128 v[188:191], v25 offset:40960
v_mfma_f32_16x16x32_bf16 a[244:247], v[172:175], v[252:255], a[244:247]
s_add_u32 s72, s71, 31744
buffer_load_dwordx4 v6, s[16:19], s72 offen offset:1024 lds
v_mfma_f32_16x16x32_bf16 a[240:243], v[164:167], v[252:255], 0
ds_read_b128 v[176:179], v24 offset:43008
v_mfma_f32_16x16x32_bf16 a[240:243], v[160:163], v[248:251], a[240:243]
ds_read_b128 v[180:183], v25 offset:43008
v_mfma_f32_16x16x32_bf16 a[236:239], v[152:155], v[248:251], 0
ds_read_b128 v[168:171], v24 offset:45056
v_mfma_f32_16x16x32_bf16 a[236:239], v[156:159], v[252:255], a[236:239]
s_add_u32 s72, s71, 63488
buffer_load_dwordx4 v7, s[16:19], s72 offen offset:2048 lds
v_mfma_f32_16x16x32_bf16 a[232:235], v[148:151], v[252:255], 0
ds_read_b128 v[172:175], v25 offset:45056
v_mfma_f32_16x16x32_bf16 a[232:235], v[144:147], v[248:251], a[232:235]
ds_read_b128 v[160:163], v24 offset:47104
v_mfma_f32_16x16x32_bf16 a[228:231], v[136:139], v[248:251], 0
ds_read_b128 v[164:167], v25 offset:47104
v_mfma_f32_16x16x32_bf16 a[228:231], v[140:143], v[252:255], a[228:231]
v_mfma_f32_16x16x32_bf16 a[224:227], v[132:135], v[252:255], 0
s_add_u32 s72, s71, 95232
buffer_load_dwordx4 v7, s[16:19], s72 offen offset:3072 lds
v_mfma_f32_16x16x32_bf16 a[224:227], v[128:131], v[248:251], a[224:227]
s_waitcnt lgkmcnt(8)
ds_read_b64_tr_b16 v[232:233], v21 offset:32768
v_mfma_f32_16x16x32_bf16 a[0:3], v[224:227], v[192:195], a[0:3]
ds_read_b64_tr_b16 v[234:235], v21 offset:33792
v_mfma_f32_16x16x32_bf16 a[0:3], v[228:231], v[196:199], a[0:3]
ds_read_b64_tr_b16 v[240:241], v22 offset:32768
v_mfma_f32_16x16x32_bf16 a[4:7], v[228:231], v[204:207], a[4:7]
s_add_u32 m0, s63, 69632
ds_read_b64_tr_b16 v[236:237], v21 offset:40960
v_mfma_f32_16x16x32_bf16 a[4:7], v[224:227], v[200:203], a[4:7]
s_add_u32 s72, s69, 32768
buffer_load_dwordx4 v2, s[8:11], s72 offen lds
v_mfma_f32_16x16x32_bf16 a[8:11], v[224:227], v[208:211], a[8:11]
ds_read_b64_tr_b16 v[238:239], v21 offset:41984
v_mfma_f32_16x16x32_bf16 a[8:11], v[228:231], v[212:215], a[8:11]
v_mfma_f32_16x16x32_bf16 a[12:15], v[228:231], v[220:223], a[12:15]
s_add_u32 s72, s69, 39936
buffer_load_dwordx4 v3, s[8:11], s72 offen offset:1024 lds
v_mfma_f32_16x16x32_bf16 a[12:15], v[224:227], v[216:219], a[12:15]
s_waitcnt lgkmcnt(5)
ds_read_b64_tr_b16 v[242:243], v22 offset:33792
v_mfma_f32_16x16x32_bf16 a[16:19], v[224:227], v[184:187], a[16:19]
v_mfma_f32_16x16x32_bf16 a[16:19], v[228:231], v[188:191], a[16:19]
ds_read_b64_tr_b16 v[244:245], v22 offset:40960
v_mfma_f32_16x16x32_bf16 a[20:23], v[228:231], v[180:183], a[20:23]
v_mfma_f32_16x16x32_bf16 a[20:23], v[224:227], v[176:179], a[20:23]
s_add_u32 s72, s69, 47104
buffer_load_dwordx4 v2, s[8:11], s72 offen offset:2048 lds
v_mfma_f32_16x16x32_bf16 a[24:27], v[224:227], v[168:171], a[24:27]
ds_read_b64_tr_b16 v[246:247], v22 offset:41984
v_mfma_f32_16x16x32_bf16 a[24:27], v[228:231], v[172:175], a[24:27]
v_mfma_f32_16x16x32_bf16 a[28:31], v[228:231], v[164:167], a[28:31]
v_mfma_f32_16x16x32_bf16 a[28:31], v[224:227], v[160:163], a[28:31]
s_waitcnt lgkmcnt(3)
v_mfma_f32_16x16x32_bf16 a[60:63], v[232:235], v[160:163], a[60:63]
s_add_u32 s72, s69, 54272
buffer_load_dwordx4 v3, s[8:11], s72 offen offset:3072 lds
v_mfma_f32_16x16x32_bf16 a[60:63], v[236:239], v[164:167], a[60:63]
ds_read_b64_tr_b16 v[248:249], v23 offset:32768
v_mfma_f32_16x16x32_bf16 a[56:59], v[236:239], v[172:175], a[56:59]
v_mfma_f32_16x16x32_bf16 a[56:59], v[232:235], v[168:171], a[56:59]
s_add_u32 m0, s64, 16384
ds_read_b64_tr_b16 v[250:251], v23 offset:33792
v_mfma_f32_16x16x32_bf16 a[52:55], v[232:235], v[176:179], a[52:55]
s_add_u32 s72, s71, 0
buffer_load_dwordx4 v6, s[20:23], s72 offen lds
v_mfma_f32_16x16x32_bf16 a[52:55], v[236:239], v[180:183], a[52:55]
v_mfma_f32_16x16x32_bf16 a[48:51], v[236:239], v[188:191], a[48:51]
v_mfma_f32_16x16x32_bf16 a[48:51], v[232:235], v[184:187], a[48:51]
ds_read_b64_tr_b16 v[252:253], v23 offset:40960
v_mfma_f32_16x16x32_bf16 a[44:47], v[232:235], v[216:219], a[44:47]
s_add_u32 s72, s71, 31744
buffer_load_dwordx4 v6, s[20:23], s72 offen offset:1024 lds
v_mfma_f32_16x16x32_bf16 a[44:47], v[236:239], v[220:223], a[44:47]
v_mfma_f32_16x16x32_bf16 a[40:43], v[236:239], v[212:215], a[40:43]
ds_read_b64_tr_b16 v[254:255], v23 offset:41984
v_mfma_f32_16x16x32_bf16 a[40:43], v[232:235], v[208:211], a[40:43]
v_mfma_f32_16x16x32_bf16 a[36:39], v[232:235], v[200:203], a[36:39]
s_add_u32 s72, s71, 63488
buffer_load_dwordx4 v7, s[20:23], s72 offen offset:2048 lds
v_mfma_f32_16x16x32_bf16 a[36:39], v[236:239], v[204:207], a[36:39]
v_mfma_f32_16x16x32_bf16 a[32:35], v[236:239], v[196:199], a[32:35]
v_mfma_f32_16x16x32_bf16 a[32:35], v[232:235], v[192:195], a[32:35]
s_waitcnt lgkmcnt(4)
v_mfma_f32_16x16x32_bf16 a[64:67], v[240:243], v[192:195], a[64:67]
s_add_u32 s72, s71, 95232
buffer_load_dwordx4 v7, s[20:23], s72 offen offset:3072 lds
ds_read_b64_tr_b16 v[224:225], v20 offset:49152
v_mfma_f32_16x16x32_bf16 a[64:67], v[244:247], v[196:199], a[64:67]
s_mov_b32 s80, 0x200000
buffer_load_dword v126, v125, s[16:19], s80 offen nt
v_mfma_f32_16x16x32_bf16 a[68:71], v[244:247], v[204:207], a[68:71]
buffer_load_dword v126, v125, s[16:19], s80 offen sc1
v_mfma_f32_16x16x32_bf16 a[68:71], v[240:243], v[200:203], a[68:71]
buffer_load_dword v126, v125, s[20:23], s80 offen nt
ds_read_b64_tr_b16 v[226:227], v20 offset:50176
v_mfma_f32_16x16x32_bf16 a[72:75], v[240:243], v[208:211], a[72:75]
buffer_load_dword v126, v125, s[20:23], s80 offen sc1
v_mfma_f32_16x16x32_bf16 a[72:75], v[244:247], v[212:215], a[72:75]
global_load_dwordx4 v[68:71], v30, s[52:53]
v_mfma_f32_16x16x32_bf16 a[76:79], v[244:247], v[220:223], a[76:79]
buffer_load_dword v33, v27, s[28:31], 0 offen nt
ds_read_b64_tr_b16 v[228:229], v20 offset:57344
v_mfma_f32_16x16x32_bf16 a[76:79], v[240:243], v[216:219], a[76:79]
buffer_load_dword v34, v27, s[28:31], 0 offen offset:2048 nt
v_mfma_f32_16x16x32_bf16 a[80:83], v[240:243], v[184:187], a[80:83]
v_add_u32 v27, 0x1000, v27
v_mfma_f32_16x16x32_bf16 a[80:83], v[244:247], v[188:191], a[80:83]
buffer_load_dword v35, v27, s[28:31], 0 offen nt
v_mfma_f32_16x16x32_bf16 a[84:87], v[244:247], v[180:183], a[84:87]
s_add_u32 m0, s63, 131072
ds_read_b64_tr_b16 v[230:231], v20 offset:58368
v_mfma_f32_16x16x32_bf16 a[84:87], v[240:243], v[176:179], a[84:87]
s_add_u32 s80, s82, 0
buffer_load_dwordx4 v26, s[28:31], s80 offen nt lds
v_mfma_f32_16x16x32_bf16 a[88:91], v[240:243], v[168:171], a[88:91]
s_add_u32 s80, s82, 15360
buffer_load_dwordx4 v26, s[28:31], s80 offen offset:1024 nt lds
v_mfma_f32_16x16x32_bf16 a[88:91], v[244:247], v[172:175], a[88:91]
s_add_u32 s80, s82, 30720
buffer_load_dwordx4 v26, s[28:31], s80 offen offset:2048 nt lds
v_mfma_f32_16x16x32_bf16 a[92:95], v[244:247], v[164:167], a[92:95]
s_add_u32 s80, s82, 46080
buffer_load_dwordx4 v26, s[28:31], s80 offen offset:3072 nt lds
v_mfma_f32_16x16x32_bf16 a[92:95], v[240:243], v[160:163], a[92:95]
s_waitcnt lgkmcnt(4)
v_mfma_f32_16x16x32_bf16 a[124:127], v[248:251], v[160:163], a[124:127]
ds_read_b64_tr_b16 v[232:233], v21 offset:49152
v_mfma_f32_16x16x32_bf16 a[124:127], v[252:255], v[164:167], a[124:127]
v_mfma_f32_16x16x32_bf16 a[120:123], v[252:255], v[172:175], a[120:123]
v_mfma_f32_16x16x32_bf16 a[120:123], v[248:251], v[168:171], a[120:123]
ds_read_b64_tr_b16 v[234:235], v21 offset:50176
v_mfma_f32_16x16x32_bf16 a[116:119], v[248:251], v[176:179], a[116:119]
v_mfma_f32_16x16x32_bf16 a[116:119], v[252:255], v[180:183], a[116:119]
v_mfma_f32_16x16x32_bf16 a[112:115], v[252:255], v[188:191], a[112:115]
v_mfma_f32_16x16x32_bf16 a[112:115], v[248:251], v[184:187], a[112:115]
ds_read_b64_tr_b16 v[236:237], v21 offset:57344
v_mfma_f32_16x16x32_bf16 a[108:111], v[248:251], v[216:219], a[108:111]
v_mfma_f32_16x16x32_bf16 a[108:111], v[252:255], v[220:223], a[108:111]
v_mfma_f32_16x16x32_bf16 a[104:107], v[252:255], v[212:215], a[104:107]
ds_read_b64_tr_b16 v[238:239], v21 offset:58368
v_mfma_f32_16x16x32_bf16 a[104:107], v[248:251], v[208:211], a[104:107]
v_mfma_f32_16x16x32_bf16 a[100:103], v[248:251], v[200:203], a[100:103]
v_mfma_f32_16x16x32_bf16 a[100:103], v[252:255], v[204:207], a[100:103]
v_mfma_f32_16x16x32_bf16 a[96:99], v[252:255], v[196:199], a[96:99]
v_mfma_f32_16x16x32_bf16 a[96:99], v[248:251], v[192:195], a[96:99]
s_waitcnt lgkmcnt(4)
v_mfma_f32_16x16x32_bf16 a[128:131], v[192:195], v[224:227], a[128:131]
ds_read_b64_tr_b16 v[240:241], v22 offset:49152
v_mfma_f32_16x16x32_bf16 a[128:131], v[196:199], v[228:231], a[128:131]
v_mfma_f32_16x16x32_bf16 a[132:135], v[204:207], v[228:231], a[132:135]
v_mfma_f32_16x16x32_bf16 a[132:135], v[200:203], v[224:227], a[132:135]
ds_read_b64_tr_b16 v[242:243], v22 offset:50176
v_mfma_f32_16x16x32_bf16 a[136:139], v[208:211], v[224:227], a[136:139]
v_mfma_f32_16x16x32_bf16 a[136:139], v[212:215], v[228:231], a[136:139]
v_mfma_f32_16x16x32_bf16 a[140:143], v[220:223], v[228:231], a[140:143]
v_mfma_f32_16x16x32_bf16 a[140:143], v[216:219], v[224:227], a[140:143]
ds_read_b64_tr_b16 v[244:245], v22 offset:57344
v_mfma_f32_16x16x32_bf16 a[144:147], v[184:187], v[224:227], a[144:147]
v_mfma_f32_16x16x32_bf16 a[144:147], v[188:191], v[228:231], a[144:147]
v_mfma_f32_16x16x32_bf16 a[148:151], v[180:183], v[228:231], a[148:151]
ds_read_b64_tr_b16 v[246:247], v22 offset:58368
v_mfma_f32_16x16x32_bf16 a[148:151], v[176:179], v[224:227], a[148:151]
v_mfma_f32_16x16x32_bf16 a[152:155], v[168:171], v[224:227], a[152:155]
v_mfma_f32_16x16x32_bf16 a[152:155], v[172:175], v[228:231], a[152:155]
v_mfma_f32_16x16x32_bf16 a[156:159], v[164:167], v[228:231], a[156:159]
v_mfma_f32_16x16x32_bf16 a[156:159], v[160:163], v[224:227], a[156:159]
s_waitcnt lgkmcnt(4)
v_mfma_f32_16x16x32_bf16 a[188:191], v[160:163], v[232:235], a[188:191]
ds_read_b64_tr_b16 v[248:249], v23 offset:49152
v_mfma_f32_16x16x32_bf16 a[188:191], v[164:167], v[236:239], a[188:191]
v_mfma_f32_16x16x32_bf16 a[184:187], v[172:175], v[236:239], a[184:187]
ds_read_b64_tr_b16 v[250:251], v23 offset:50176
v_mfma_f32_16x16x32_bf16 a[184:187], v[168:171], v[232:235], a[184:187]
v_mfma_f32_16x16x32_bf16 a[180:183], v[176:179], v[232:235], a[180:183]
ds_read_b64_tr_b16 v[252:253], v23 offset:57344
v_mfma_f32_16x16x32_bf16 a[180:183], v[180:183], v[236:239], a[180:183]
v_mfma_f32_16x16x32_bf16 a[176:179], v[188:191], v[236:239], a[176:179]
ds_read_b64_tr_b16 v[254:255], v23 offset:58368
v_mfma_f32_16x16x32_bf16 a[176:179], v[184:187], v[232:235], a[176:179]
v_mfma_f32_16x16x32_bf16 a[172:175], v[216:219], v[232:235], a[172:175]
v_mfma_f32_16x16x32_bf16 a[172:175], v[220:223], v[236:239], a[172:175]
v_mfma_f32_16x16x32_bf16 a[168:171], v[212:215], v[236:239], a[168:171]
v_mfma_f32_16x16x32_bf16 a[168:171], v[208:211], v[232:235], a[168:171]
v_mfma_f32_16x16x32_bf16 a[164:167], v[200:203], v[232:235], a[164:167]
v_mfma_f32_16x16x32_bf16 a[164:167], v[204:207], v[236:239], a[164:167]
v_mfma_f32_16x16x32_bf16 a[160:163], v[196:199], v[236:239], a[160:163]
s_waitcnt vmcnt(12) lgkmcnt(0)
v_mfma_f32_16x16x32_bf16 a[160:163], v[192:195], v[232:235], a[160:163]
s_barrier
v_mfma_f32_16x16x32_bf16 a[192:195], v[192:195], v[240:243], a[192:195]
s_and_b32 s73, s65, 1
ds_read_b64_tr_b16 v[224:225], v20 offset:0
v_mfma_f32_16x16x32_bf16 a[192:195], v[196:199], v[244:247], a[192:195]
s_xor_b32 s73, s73, 3
ds_read_b64_tr_b16 v[226:227], v20 offset:1024
v_mfma_f32_16x16x32_bf16 a[196:199], v[204:207], v[244:247], a[196:199]
s_lshl_b32 s69, s73, 7
ds_read_b64_tr_b16 v[228:229], v20 offset:8192
v_mfma_f32_16x16x32_bf16 a[196:199], v[200:203], v[240:243], a[196:199]
s_add_u32 s69, s69, s84
ds_read_b64_tr_b16 v[230:231], v20 offset:9216
v_mfma_f32_16x16x32_bf16 a[200:203], v[208:211], v[240:243], a[200:203]
s_lshl_b32 s71, s73, 19
ds_read_b128 v[128:131], v24 offset:0
v_mfma_f32_16x16x32_bf16 a[200:203], v[212:215], v[244:247], a[200:203]
s_add_u32 s71, s71, s66
ds_read_b128 v[132:135], v25 offset:0
v_mfma_f32_16x16x32_bf16 a[204:207], v[220:223], v[244:247], a[204:207]
s_add_u32 m0, s63, 98304
v_mfma_f32_16x16x32_bf16 a[204:207], v[216:219], v[240:243], a[204:207]
s_add_u32 s72, s69, 0
buffer_load_dwordx4 v2, s[8:11], s72 offen lds
v_mfma_f32_16x16x32_bf16 a[208:211], v[184:187], v[240:243], a[208:211]
s_add_u32 s72, s69, 7168
buffer_load_dwordx4 v3, s[8:11], s72 offen offset:1024 lds
v_mfma_f32_16x16x32_bf16 a[208:211], v[188:191], v[244:247], a[208:211]
s_add_u32 s72, s69, 14336
buffer_load_dwordx4 v2, s[8:11], s72 offen offset:2048 lds
v_mfma_f32_16x16x32_bf16 a[212:215], v[180:183], v[244:247], a[212:215]
ds_read_b128 v[136:139], v24 offset:2048
v_mfma_f32_16x16x32_bf16 a[212:215], v[176:179], v[240:243], a[212:215]
ds_read_b128 v[140:143], v25 offset:2048
v_mfma_f32_16x16x32_bf16 a[216:219], v[168:171], v[240:243], a[216:219]
s_add_u32 s72, s69, 21504
buffer_load_dwordx4 v3, s[8:11], s72 offen offset:3072 lds
v_mfma_f32_16x16x32_bf16 a[216:219], v[172:175], v[244:247], a[216:219]
ds_read_b128 v[144:147], v24 offset:4096
v_mfma_f32_16x16x32_bf16 a[220:223], v[164:167], v[244:247], a[220:223]
ds_read_b128 v[148:151], v25 offset:4096
v_mfma_f32_16x16x32_bf16 a[220:223], v[160:163], v[240:243], a[220:223]
ds_read_b128 v[152:155], v24 offset:6144
v_mfma_f32_16x16x32_bf16 a[252:255], v[160:163], v[248:251], a[252:255]
ds_read_b128 v[156:159], v25 offset:6144
v_mfma_f32_16x16x32_bf16 a[252:255], v[164:167], v[252:255], a[252:255]
s_add_u32 m0, s64, 32768
v_mfma_f32_16x16x32_bf16 a[248:251], v[172:175], v[252:255], a[248:251]
s_add_u32 s72, s71, 0
buffer_load_dwordx4 v6, s[16:19], s72 offen lds
v_mfma_f32_16x16x32_bf16 a[248:251], v[168:171], v[248:251], a[248:251]
ds_read_b128 v[160:163], v24 offset:8192
v_mfma_f32_16x16x32_bf16 a[244:247], v[176:179], v[248:251], a[244:247]
ds_read_b128 v[164:167], v25 offset:8192
v_mfma_f32_16x16x32_bf16 a[244:247], v[180:183], v[252:255], a[244:247]
s_add_u32 s72, s71, 31744
buffer_load_dwordx4 v6, s[16:19], s72 offen offset:1024 lds
v_mfma_f32_16x16x32_bf16 a[240:243], v[188:191], v[252:255], a[240:243]
ds_read_b128 v[168:171], v24 offset:10240
v_mfma_f32_16x16x32_bf16 a[240:243], v[184:187], v[248:251], a[240:243]
ds_read_b128 v[172:175], v25 offset:10240
v_mfma_f32_16x16x32_bf16 a[236:239], v[216:219], v[248:251], a[236:239]
ds_read_b128 v[176:179], v24 offset:12288
v_mfma_f32_16x16x32_bf16 a[236:239], v[220:223], v[252:255], a[236:239]
s_add_u32 s72, s71, 63488
buffer_load_dwordx4 v7, s[16:19], s72 offen offset:2048 lds
v_mfma_f32_16x16x32_bf16 a[232:235], v[212:215], v[252:255], a[232:235]
ds_read_b128 v[180:183], v25 offset:12288
v_mfma_f32_16x16x32_bf16 a[232:235], v[208:211], v[248:251], a[232:235]
ds_read_b128 v[184:187], v24 offset:14336
v_mfma_f32_16x16x32_bf16 a[228:231], v[200:203], v[248:251], a[228:231]
ds_read_b128 v[188:191], v25 offset:14336
v_mfma_f32_16x16x32_bf16 a[228:231], v[204:207], v[252:255], a[228:231]
v_mfma_f32_16x16x32_bf16 a[224:227], v[196:199], v[252:255], a[224:227]
s_add_u32 s72, s71, 95232
buffer_load_dwordx4 v7, s[16:19], s72 offen offset:3072 lds
v_mfma_f32_16x16x32_bf16 a[224:227], v[192:195], v[248:251], a[224:227]
s_waitcnt lgkmcnt(8)
ds_read_b64_tr_b16 v[232:233], v21 offset:0
v_mfma_f32_16x16x32_bf16 a[0:3], v[224:227], v[128:131], a[0:3]
ds_read_b64_tr_b16 v[234:235], v21 offset:1024
v_mfma_f32_16x16x32_bf16 a[0:3], v[228:231], v[132:135], a[0:3]
ds_read_b64_tr_b16 v[240:241], v22 offset:0
v_mfma_f32_16x16x32_bf16 a[4:7], v[228:231], v[140:143], a[4:7]
s_add_u32 m0, s63, 102400
ds_read_b64_tr_b16 v[236:237], v21 offset:8192
v_mfma_f32_16x16x32_bf16 a[4:7], v[224:227], v[136:139], a[4:7]
s_add_u32 s72, s69, 32768
buffer_load_dwordx4 v2, s[8:11], s72 offen lds
v_mfma_f32_16x16x32_bf16 a[8:11], v[224:227], v[144:147], a[8:11]
ds_read_b64_tr_b16 v[238:239], v21 offset:9216
v_mfma_f32_16x16x32_bf16 a[8:11], v[228:231], v[148:151], a[8:11]
v_mfma_f32_16x16x32_bf16 a[12:15], v[228:231], v[156:159], a[12:15]
s_add_u32 s72, s69, 39936
buffer_load_dwordx4 v3, s[8:11], s72 offen offset:1024 lds
v_mfma_f32_16x16x32_bf16 a[12:15], v[224:227], v[152:155], a[12:15]
s_waitcnt lgkmcnt(5)
ds_read_b64_tr_b16 v[242:243], v22 offset:1024
v_mfma_f32_16x16x32_bf16 a[16:19], v[224:227], v[160:163], a[16:19]
v_mfma_f32_16x16x32_bf16 a[16:19], v[228:231], v[164:167], a[16:19]
ds_read_b64_tr_b16 v[244:245], v22 offset:8192
v_mfma_f32_16x16x32_bf16 a[20:23], v[228:231], v[172:175], a[20:23]
v_mfma_f32_16x16x32_bf16 a[20:23], v[224:227], v[168:171], a[20:23]
s_add_u32 s72, s69, 47104
buffer_load_dwordx4 v2, s[8:11], s72 offen offset:2048 lds
v_mfma_f32_16x16x32_bf16 a[24:27], v[224:227], v[176:179], a[24:27]
ds_read_b64_tr_b16 v[246:247], v22 offset:9216
v_mfma_f32_16x16x32_bf16 a[24:27], v[228:231], v[180:183], a[24:27]
v_mfma_f32_16x16x32_bf16 a[28:31], v[228:231], v[188:191], a[28:31]
v_mfma_f32_16x16x32_bf16 a[28:31], v[224:227], v[184:187], a[28:31]
s_waitcnt lgkmcnt(3)
v_mfma_f32_16x16x32_bf16 a[60:63], v[232:235], v[184:187], a[60:63]
s_add_u32 s72, s69, 54272
buffer_load_dwordx4 v3, s[8:11], s72 offen offset:3072 lds
v_mfma_f32_16x16x32_bf16 a[60:63], v[236:239], v[188:191], a[60:63]
ds_read_b64_tr_b16 v[248:249], v23 offset:0
v_mfma_f32_16x16x32_bf16 a[56:59], v[236:239], v[180:183], a[56:59]
v_mfma_f32_16x16x32_bf16 a[56:59], v[232:235], v[176:179], a[56:59]
s_add_u32 m0, s64, 49152
ds_read_b64_tr_b16 v[250:251], v23 offset:1024
v_mfma_f32_16x16x32_bf16 a[52:55], v[232:235], v[168:171], a[52:55]
s_add_u32 s72, s71, 0
buffer_load_dwordx4 v6, s[20:23], s72 offen lds
v_mfma_f32_16x16x32_bf16 a[52:55], v[236:239], v[172:175], a[52:55]
v_mfma_f32_16x16x32_bf16 a[48:51], v[236:239], v[164:167], a[48:51]
v_mfma_f32_16x16x32_bf16 a[48:51], v[232:235], v[160:163], a[48:51]
ds_read_b64_tr_b16 v[252:253], v23 offset:8192
v_mfma_f32_16x16x32_bf16 a[44:47], v[232:235], v[152:155], a[44:47]
s_add_u32 s72, s71, 31744
buffer_load_dwordx4 v6, s[20:23], s72 offen offset:1024 lds
v_mfma_f32_16x16x32_bf16 a[44:47], v[236:239], v[156:159], a[44:47]
v_mfma_f32_16x16x32_bf16 a[40:43], v[236:239], v[148:151], a[40:43]
ds_read_b64_tr_b16 v[254:255], v23 offset:9216
v_mfma_f32_16x16x32_bf16 a[40:43], v[232:235], v[144:147], a[40:43]
v_mfma_f32_16x16x32_bf16 a[36:39], v[232:235], v[136:139], a[36:39]
s_add_u32 s72, s71, 63488
buffer_load_dwordx4 v7, s[20:23], s72 offen offset:2048 lds
v_mfma_f32_16x16x32_bf16 a[36:39], v[236:239], v[140:143], a[36:39]
v_mfma_f32_16x16x32_bf16 a[32:35], v[236:239], v[132:135], a[32:35]
v_mfma_f32_16x16x32_bf16 a[32:35], v[232:235], v[128:131], a[32:35]
s_waitcnt lgkmcnt(4)
v_mfma_f32_16x16x32_bf16 a[64:67], v[240:243], v[128:131], a[64:67]
s_add_u32 s72, s71, 95232
buffer_load_dwordx4 v7, s[20:23], s72 offen offset:3072 lds
v_mfma_f32_16x16x32_bf16 a[64:67], v[244:247], v[132:135], a[64:67]
s_mov_b32 s80, 0x300000
buffer_load_dword v126, v125, s[16:19], s80 offen nt
v_mfma_f32_16x16x32_bf16 a[68:71], v[244:247], v[140:143], a[68:71]
buffer_load_dword v126, v125, s[16:19], s80 offen sc1
v_mfma_f32_16x16x32_bf16 a[68:71], v[240:243], v[136:139], a[68:71]
buffer_load_dword v126, v125, s[20:23], s80 offen nt
v_mfma_f32_16x16x32_bf16 a[72:75], v[240:243], v[144:147], a[72:75]
buffer_load_dword v126, v125, s[20:23], s80 offen sc1
v_mfma_f32_16x16x32_bf16 a[72:75], v[244:247], v[148:151], a[72:75]
s_add_u32 m0, s63, 135168
ds_read_b64_tr_b16 v[224:225], v20 offset:16384
v_mfma_f32_16x16x32_bf16 a[76:79], v[244:247], v[156:159], a[76:79]
s_add_u32 s80, s82, 0
buffer_load_dwordx4 v26, s[32:35], s80 offen nt lds
v_mfma_f32_16x16x32_bf16 a[76:79], v[240:243], v[152:155], a[76:79]
s_add_u32 s80, s82, 15360
buffer_load_dwordx4 v26, s[32:35], s80 offen offset:1024 nt lds
v_mfma_f32_16x16x32_bf16 a[80:83], v[240:243], v[160:163], a[80:83]
s_add_u32 s80, s82, 30720
buffer_load_dwordx4 v26, s[32:35], s80 offen offset:2048 nt lds
v_mfma_f32_16x16x32_bf16 a[80:83], v[244:247], v[164:167], a[80:83]
s_add_u32 s80, s82, 46080
buffer_load_dwordx4 v26, s[32:35], s80 offen offset:3072 nt lds
v_mfma_f32_16x16x32_bf16 a[84:87], v[244:247], v[172:175], a[84:87]
ds_read_b64_tr_b16 v[226:227], v20 offset:17408
v_mfma_f32_16x16x32_bf16 a[84:87], v[240:243], v[168:171], a[84:87]
ds_read_b64_tr_b16 v[228:229], v20 offset:24576
v_mfma_f32_16x16x32_bf16 a[88:91], v[240:243], v[176:179], a[88:91]
ds_read_b64_tr_b16 v[230:231], v20 offset:25600
v_mfma_f32_16x16x32_bf16 a[88:91], v[244:247], v[180:183], a[88:91]
v_mfma_f32_16x16x32_bf16 a[92:95], v[244:247], v[188:191], a[92:95]
v_mfma_f32_16x16x32_bf16 a[92:95], v[240:243], v[184:187], a[92:95]
s_waitcnt lgkmcnt(4)
v_mfma_f32_16x16x32_bf16 a[124:127], v[248:251], v[184:187], a[124:127]
ds_read_b64_tr_b16 v[232:233], v21 offset:16384
v_mfma_f32_16x16x32_bf16 a[124:127], v[252:255], v[188:191], a[124:127]
v_mfma_f32_16x16x32_bf16 a[120:123], v[252:255], v[180:183], a[120:123]
v_mfma_f32_16x16x32_bf16 a[120:123], v[248:251], v[176:179], a[120:123]
ds_read_b64_tr_b16 v[234:235], v21 offset:17408
v_mfma_f32_16x16x32_bf16 a[116:119], v[248:251], v[168:171], a[116:119]
v_mfma_f32_16x16x32_bf16 a[116:119], v[252:255], v[172:175], a[116:119]
v_mfma_f32_16x16x32_bf16 a[112:115], v[252:255], v[164:167], a[112:115]
v_mfma_f32_16x16x32_bf16 a[112:115], v[248:251], v[160:163], a[112:115]
ds_read_b64_tr_b16 v[236:237], v21 offset:24576
v_mfma_f32_16x16x32_bf16 a[108:111], v[248:251], v[152:155], a[108:111]
v_mfma_f32_16x16x32_bf16 a[108:111], v[252:255], v[156:159], a[108:111]
v_mfma_f32_16x16x32_bf16 a[104:107], v[252:255], v[148:151], a[104:107]
ds_read_b64_tr_b16 v[238:239], v21 offset:25600
v_mfma_f32_16x16x32_bf16 a[104:107], v[248:251], v[144:147], a[104:107]
v_mfma_f32_16x16x32_bf16 a[100:103], v[248:251], v[136:139], a[100:103]
v_mfma_f32_16x16x32_bf16 a[100:103], v[252:255], v[140:143], a[100:103]
v_mfma_f32_16x16x32_bf16 a[96:99], v[252:255], v[132:135], a[96:99]
v_mfma_f32_16x16x32_bf16 a[96:99], v[248:251], v[128:131], a[96:99]
s_waitcnt lgkmcnt(4)
v_mfma_f32_16x16x32_bf16 a[128:131], v[128:131], v[224:227], a[128:131]
ds_read_b64_tr_b16 v[240:241], v22 offset:16384
v_mfma_f32_16x16x32_bf16 a[128:131], v[132:135], v[228:231], a[128:131]
v_mfma_f32_16x16x32_bf16 a[132:135], v[140:143], v[228:231], a[132:135]
v_mfma_f32_16x16x32_bf16 a[132:135], v[136:139], v[224:227], a[132:135]
ds_read_b64_tr_b16 v[242:243], v22 offset:17408
v_mfma_f32_16x16x32_bf16 a[136:139], v[144:147], v[224:227], a[136:139]
v_mfma_f32_16x16x32_bf16 a[136:139], v[148:151], v[228:231], a[136:139]
v_mfma_f32_16x16x32_bf16 a[140:143], v[156:159], v[228:231], a[140:143]
v_mfma_f32_16x16x32_bf16 a[140:143], v[152:155], v[224:227], a[140:143]
ds_read_b64_tr_b16 v[244:245], v22 offset:24576
v_mfma_f32_16x16x32_bf16 a[144:147], v[160:163], v[224:227], a[144:147]
v_mfma_f32_16x16x32_bf16 a[144:147], v[164:167], v[228:231], a[144:147]
v_mfma_f32_16x16x32_bf16 a[148:151], v[172:175], v[228:231], a[148:151]
ds_read_b64_tr_b16 v[246:247], v22 offset:25600
v_mfma_f32_16x16x32_bf16 a[148:151], v[168:171], v[224:227], a[148:151]
v_mfma_f32_16x16x32_bf16 a[152:155], v[176:179], v[224:227], a[152:155]
v_mfma_f32_16x16x32_bf16 a[152:155], v[180:183], v[228:231], a[152:155]
v_mfma_f32_16x16x32_bf16 a[156:159], v[188:191], v[228:231], a[156:159]
v_mfma_f32_16x16x32_bf16 a[156:159], v[184:187], v[224:227], a[156:159]
s_waitcnt lgkmcnt(4)
v_mfma_f32_16x16x32_bf16 a[188:191], v[184:187], v[232:235], a[188:191]
ds_read_b64_tr_b16 v[248:249], v23 offset:16384
v_mfma_f32_16x16x32_bf16 a[188:191], v[188:191], v[236:239], a[188:191]
v_mfma_f32_16x16x32_bf16 a[184:187], v[180:183], v[236:239], a[184:187]
ds_read_b64_tr_b16 v[250:251], v23 offset:17408
v_mfma_f32_16x16x32_bf16 a[184:187], v[176:179], v[232:235], a[184:187]
v_mfma_f32_16x16x32_bf16 a[180:183], v[168:171], v[232:235], a[180:183]
ds_read_b64_tr_b16 v[252:253], v23 offset:24576
v_mfma_f32_16x16x32_bf16 a[180:183], v[172:175], v[236:239], a[180:183]
v_mfma_f32_16x16x32_bf16 a[176:179], v[164:167], v[236:239], a[176:179]
ds_read_b64_tr_b16 v[254:255], v23 offset:25600
v_mfma_f32_16x16x32_bf16 a[176:179], v[160:163], v[232:235], a[176:179]
v_mfma_f32_16x16x32_bf16 a[172:175], v[152:155], v[232:235], a[172:175]
v_mfma_f32_16x16x32_bf16 a[172:175], v[156:159], v[236:239], a[172:175]
v_mfma_f32_16x16x32_bf16 a[168:171], v[148:151], v[236:239], a[168:171]
v_mfma_f32_16x16x32_bf16 a[168:171], v[144:147], v[232:235], a[168:171]
v_mfma_f32_16x16x32_bf16 a[164:167], v[136:139], v[232:235], a[164:167]
v_mfma_f32_16x16x32_bf16 a[164:167], v[140:143], v[236:239], a[164:167]
v_mfma_f32_16x16x32_bf16 a[160:163], v[132:135], v[236:239], a[160:163]
s_waitcnt vmcnt(8) lgkmcnt(0)
v_mfma_f32_16x16x32_bf16 a[160:163], v[128:131], v[232:235], a[160:163]
s_barrier
v_mfma_f32_16x16x32_bf16 a[192:195], v[128:131], v[240:243], a[192:195]
s_and_b32 s73, s65, 1
ds_read_b64_tr_b16 v[224:225], v20 offset:32768
v_mfma_f32_16x16x32_bf16 a[192:195], v[132:135], v[244:247], a[192:195]
s_xor_b32 s73, s73, 4
ds_read_b64_tr_b16 v[226:227], v20 offset:33792
v_mfma_f32_16x16x32_bf16 a[196:199], v[140:143], v[244:247], a[196:199]
s_lshl_b32 s69, s73, 7
ds_read_b64_tr_b16 v[228:229], v20 offset:40960
v_mfma_f32_16x16x32_bf16 a[196:199], v[136:139], v[240:243], a[196:199]
s_add_u32 s69, s69, s84
ds_read_b64_tr_b16 v[230:231], v20 offset:41984
v_mfma_f32_16x16x32_bf16 a[200:203], v[144:147], v[240:243], a[200:203]
s_lshl_b32 s71, s73, 19
ds_read_b128 v[192:195], v24 offset:32768
v_mfma_f32_16x16x32_bf16 a[200:203], v[148:151], v[244:247], a[200:203]
s_add_u32 s71, s71, s66
ds_read_b128 v[196:199], v25 offset:32768
v_mfma_f32_16x16x32_bf16 a[204:207], v[156:159], v[244:247], a[204:207]
s_add_u32 m0, s63, 65536
v_mfma_f32_16x16x32_bf16 a[204:207], v[152:155], v[240:243], a[204:207]
s_add_u32 s72, s69, 0
buffer_load_dwordx4 v2, s[8:11], s72 offen lds
v_mfma_f32_16x16x32_bf16 a[208:211], v[160:163], v[240:243], a[208:211]
s_add_u32 s72, s69, 7168
buffer_load_dwordx4 v3, s[8:11], s72 offen offset:1024 lds
v_mfma_f32_16x16x32_bf16 a[208:211], v[164:167], v[244:247], a[208:211]
s_add_u32 s72, s69, 14336
buffer_load_dwordx4 v2, s[8:11], s72 offen offset:2048 lds
v_mfma_f32_16x16x32_bf16 a[212:215], v[172:175], v[244:247], a[212:215]
ds_read_b128 v[200:203], v24 offset:34816
v_mfma_f32_16x16x32_bf16 a[212:215], v[168:171], v[240:243], a[212:215]
ds_read_b128 v[204:207], v25 offset:34816
v_mfma_f32_16x16x32_bf16 a[216:219], v[176:179], v[240:243], a[216:219]
s_add_u32 s72, s69, 21504
buffer_load_dwordx4 v3, s[8:11], s72 offen offset:3072 lds
v_mfma_f32_16x16x32_bf16 a[216:219], v[180:183], v[244:247], a[216:219]
ds_read_b128 v[208:211], v24 offset:36864
v_mfma_f32_16x16x32_bf16 a[220:223], v[188:191], v[244:247], a[220:223]
ds_read_b128 v[212:215], v25 offset:36864
v_mfma_f32_16x16x32_bf16 a[220:223], v[184:187], v[240:243], a[220:223]
ds_read_b128 v[216:219], v24 offset:38912
v_mfma_f32_16x16x32_bf16 a[252:255], v[184:187], v[248:251], a[252:255]
ds_read_b128 v[220:223], v25 offset:38912
v_mfma_f32_16x16x32_bf16 a[252:255], v[188:191], v[252:255], a[252:255]
s_add_u32 m0, s64, 0
v_mfma_f32_16x16x32_bf16 a[248:251], v[180:183], v[252:255], a[248:251]
s_add_u32 s72, s71, 0
buffer_load_dwordx4 v6, s[16:19], s72 offen lds
v_mfma_f32_16x16x32_bf16 a[248:251], v[176:179], v[248:251], a[248:251]
ds_read_b128 v[184:187], v24 offset:40960
v_mfma_f32_16x16x32_bf16 a[244:247], v[168:171], v[248:251], a[244:247]
ds_read_b128 v[188:191], v25 offset:40960
v_mfma_f32_16x16x32_bf16 a[244:247], v[172:175], v[252:255], a[244:247]
s_add_u32 s72, s71, 31744
buffer_load_dwordx4 v6, s[16:19], s72 offen offset:1024 lds
v_mfma_f32_16x16x32_bf16 a[240:243], v[164:167], v[252:255], a[240:243]
ds_read_b128 v[176:179], v24 offset:43008
v_mfma_f32_16x16x32_bf16 a[240:243], v[160:163], v[248:251], a[240:243]
ds_read_b128 v[180:183], v25 offset:43008
v_mfma_f32_16x16x32_bf16 a[236:239], v[152:155], v[248:251], a[236:239]
ds_read_b128 v[168:171], v24 offset:45056
v_mfma_f32_16x16x32_bf16 a[236:239], v[156:159], v[252:255], a[236:239]
s_add_u32 s72, s71, 63488
buffer_load_dwordx4 v7, s[16:19], s72 offen offset:2048 lds
v_mfma_f32_16x16x32_bf16 a[232:235], v[148:151], v[252:255], a[232:235]
ds_read_b128 v[172:175], v25 offset:45056
v_mfma_f32_16x16x32_bf16 a[232:235], v[144:147], v[248:251], a[232:235]
ds_read_b128 v[160:163], v24 offset:47104
v_mfma_f32_16x16x32_bf16 a[228:231], v[136:139], v[248:251], a[228:231]
ds_read_b128 v[164:167], v25 offset:47104
v_mfma_f32_16x16x32_bf16 a[228:231], v[140:143], v[252:255], a[228:231]
v_mfma_f32_16x16x32_bf16 a[224:227], v[132:135], v[252:255], a[224:227]
s_add_u32 s72, s71, 95232
buffer_load_dwordx4 v7, s[16:19], s72 offen offset:3072 lds
v_mfma_f32_16x16x32_bf16 a[224:227], v[128:131], v[248:251], a[224:227]
s_waitcnt lgkmcnt(8)
ds_read_b64_tr_b16 v[232:233], v21 offset:32768
v_mfma_f32_16x16x32_bf16 a[0:3], v[224:227], v[192:195], a[0:3]
ds_read_b64_tr_b16 v[234:235], v21 offset:33792
v_mfma_f32_16x16x32_bf16 a[0:3], v[228:231], v[196:199], a[0:3]
ds_read_b64_tr_b16 v[240:241], v22 offset:32768
v_mfma_f32_16x16x32_bf16 a[4:7], v[228:231], v[204:207], a[4:7]
s_add_u32 m0, s63, 69632
ds_read_b64_tr_b16 v[236:237], v21 offset:40960
v_mfma_f32_16x16x32_bf16 a[4:7], v[224:227], v[200:203], a[4:7]
s_add_u32 s72, s69, 32768
buffer_load_dwordx4 v2, s[8:11], s72 offen lds
v_mfma_f32_16x16x32_bf16 a[8:11], v[224:227], v[208:211], a[8:11]
ds_read_b64_tr_b16 v[238:239], v21 offset:41984
v_mfma_f32_16x16x32_bf16 a[8:11], v[228:231], v[212:215], a[8:11]
v_mfma_f32_16x16x32_bf16 a[12:15], v[228:231], v[220:223], a[12:15]
s_add_u32 s72, s69, 39936
buffer_load_dwordx4 v3, s[8:11], s72 offen offset:1024 lds
v_mfma_f32_16x16x32_bf16 a[12:15], v[224:227], v[216:219], a[12:15]
s_waitcnt lgkmcnt(5)
ds_read_b64_tr_b16 v[242:243], v22 offset:33792
v_mfma_f32_16x16x32_bf16 a[16:19], v[224:227], v[184:187], a[16:19]
v_mfma_f32_16x16x32_bf16 a[16:19], v[228:231], v[188:191], a[16:19]
ds_read_b64_tr_b16 v[244:245], v22 offset:40960
v_mfma_f32_16x16x32_bf16 a[20:23], v[228:231], v[180:183], a[20:23]
v_mfma_f32_16x16x32_bf16 a[20:23], v[224:227], v[176:179], a[20:23]
s_add_u32 s72, s69, 47104
buffer_load_dwordx4 v2, s[8:11], s72 offen offset:2048 lds
v_mfma_f32_16x16x32_bf16 a[24:27], v[224:227], v[168:171], a[24:27]
ds_read_b64_tr_b16 v[246:247], v22 offset:41984
v_mfma_f32_16x16x32_bf16 a[24:27], v[228:231], v[172:175], a[24:27]
v_mfma_f32_16x16x32_bf16 a[28:31], v[228:231], v[164:167], a[28:31]
v_mfma_f32_16x16x32_bf16 a[28:31], v[224:227], v[160:163], a[28:31]
s_waitcnt lgkmcnt(3)
v_mfma_f32_16x16x32_bf16 a[60:63], v[232:235], v[160:163], a[60:63]
s_add_u32 s72, s69, 54272
buffer_load_dwordx4 v3, s[8:11], s72 offen offset:3072 lds
v_mfma_f32_16x16x32_bf16 a[60:63], v[236:239], v[164:167], a[60:63]
ds_read_b64_tr_b16 v[248:249], v23 offset:32768
v_mfma_f32_16x16x32_bf16 a[56:59], v[236:239], v[172:175], a[56:59]
v_mfma_f32_16x16x32_bf16 a[56:59], v[232:235], v[168:171], a[56:59]
s_add_u32 m0, s64, 16384
ds_read_b64_tr_b16 v[250:251], v23 offset:33792
v_mfma_f32_16x16x32_bf16 a[52:55], v[232:235], v[176:179], a[52:55]
s_add_u32 s72, s71, 0
buffer_load_dwordx4 v6, s[20:23], s72 offen lds
v_mfma_f32_16x16x32_bf16 a[52:55], v[236:239], v[180:183], a[52:55]
v_mfma_f32_16x16x32_bf16 a[48:51], v[236:239], v[188:191], a[48:51]
v_mfma_f32_16x16x32_bf16 a[48:51], v[232:235], v[184:187], a[48:51]
ds_read_b64_tr_b16 v[252:253], v23 offset:40960
v_mfma_f32_16x16x32_bf16 a[44:47], v[232:235], v[216:219], a[44:47]
s_add_u32 s72, s71, 31744
buffer_load_dwordx4 v6, s[20:23], s72 offen offset:1024 lds
v_mfma_f32_16x16x32_bf16 a[44:47], v[236:239], v[220:223], a[44:47]
v_mfma_f32_16x16x32_bf16 a[40:43], v[236:239], v[212:215], a[40:43]
ds_read_b64_tr_b16 v[254:255], v23 offset:41984
v_mfma_f32_16x16x32_bf16 a[40:43], v[232:235], v[208:211], a[40:43]
v_mfma_f32_16x16x32_bf16 a[36:39], v[232:235], v[200:203], a[36:39]
s_add_u32 s72, s71, 63488
buffer_load_dwordx4 v7, s[20:23], s72 offen offset:2048 lds
v_mfma_f32_16x16x32_bf16 a[36:39], v[236:239], v[204:207], a[36:39]
v_mfma_f32_16x16x32_bf16 a[32:35], v[236:239], v[196:199], a[32:35]
v_mfma_f32_16x16x32_bf16 a[32:35], v[232:235], v[192:195], a[32:35]
s_waitcnt lgkmcnt(4)
v_mfma_f32_16x16x32_bf16 a[64:67], v[240:243], v[192:195], a[64:67]
s_add_u32 s72, s71, 95232
buffer_load_dwordx4 v7, s[20:23], s72 offen offset:3072 lds
v_mfma_f32_16x16x32_bf16 a[64:67], v[244:247], v[196:199], a[64:67]
buffer_load_dwordx4 v[108:111], v1, s[4:7], s76 offen
v_mfma_f32_16x16x32_bf16 a[68:71], v[244:247], v[204:207], a[68:71]
buffer_load_dwordx4 v[112:115], v1, s[4:7], s76 offen offset:1024
v_mfma_f32_16x16x32_bf16 a[68:71], v[240:243], v[200:203], a[68:71]
buffer_load_dwordx4 v[116:119], v1, s[4:7], s76 offen offset:2048
v_mfma_f32_16x16x32_bf16 a[72:75], v[240:243], v[208:211], a[72:75]
buffer_load_dwordx4 v[120:123], v1, s[4:7], s76 offen offset:3072
v_mfma_f32_16x16x32_bf16 a[72:75], v[244:247], v[212:215], a[72:75]
ds_read_b64_tr_b16 v[224:225], v20 offset:49152
v_mfma_f32_16x16x32_bf16 a[76:79], v[244:247], v[220:223], a[76:79]
v_mfma_f32_16x16x32_bf16 a[76:79], v[240:243], v[216:219], a[76:79]
ds_read_b64_tr_b16 v[226:227], v20 offset:50176
v_mfma_f32_16x16x32_bf16 a[80:83], v[240:243], v[184:187], a[80:83]
v_mfma_f32_16x16x32_bf16 a[80:83], v[244:247], v[188:191], a[80:83]
ds_read_b64_tr_b16 v[228:229], v20 offset:57344
v_mfma_f32_16x16x32_bf16 a[84:87], v[244:247], v[180:183], a[84:87]
v_mfma_f32_16x16x32_bf16 a[84:87], v[240:243], v[176:179], a[84:87]
ds_read_b64_tr_b16 v[230:231], v20 offset:58368
v_mfma_f32_16x16x32_bf16 a[88:91], v[240:243], v[168:171], a[88:91]
v_mfma_f32_16x16x32_bf16 a[88:91], v[244:247], v[172:175], a[88:91]
v_mfma_f32_16x16x32_bf16 a[92:95], v[244:247], v[164:167], a[92:95]
v_mfma_f32_16x16x32_bf16 a[92:95], v[240:243], v[160:163], a[92:95]
s_waitcnt lgkmcnt(4)
v_mfma_f32_16x16x32_bf16 a[124:127], v[248:251], v[160:163], a[124:127]
ds_read_b64_tr_b16 v[232:233], v21 offset:49152
v_mfma_f32_16x16x32_bf16 a[124:127], v[252:255], v[164:167], a[124:127]
v_mfma_f32_16x16x32_bf16 a[120:123], v[252:255], v[172:175], a[120:123]
v_mfma_f32_16x16x32_bf16 a[120:123], v[248:251], v[168:171], a[120:123]
ds_read_b64_tr_b16 v[234:235], v21 offset:50176
v_mfma_f32_16x16x32_bf16 a[116:119], v[248:251], v[176:179], a[116:119]
s_waitcnt vmcnt(20)
ds_read2_b32 v[36:37], v98 offset0:0 offset1:32
ds_read2_b32 v[38:39], v98 offset0:64 offset1:96
v_mfma_f32_16x16x32_bf16 a[116:119], v[252:255], v[180:183], a[116:119]
ds_read2_b32 v[40:41], v98 offset0:128 offset1:160
ds_read2_b32 v[42:43], v98 offset0:192 offset1:224
v_mfma_f32_16x16x32_bf16 a[112:115], v[252:255], v[188:191], a[112:115]
v_add_u32 v98, 1024, v98
v_mfma_f32_16x16x32_bf16 a[112:115], v[248:251], v[184:187], a[112:115]
ds_read_b64_tr_b16 v[236:237], v21 offset:57344
ds_read2_b32 v[44:45], v98 offset0:0 offset1:32
v_mfma_f32_16x16x32_bf16 a[108:111], v[248:251], v[216:219], a[108:111]
ds_read2_b32 v[46:47], v98 offset0:64 offset1:96
ds_read2_b32 v[48:49], v98 offset0:128 offset1:160
v_mfma_f32_16x16x32_bf16 a[108:111], v[252:255], v[220:223], a[108:111]
ds_read2_b32 v[50:51], v98 offset0:192 offset1:224
v_add_u32 v98, 3072, v98
v_mfma_f32_16x16x32_bf16 a[104:107], v[252:255], v[212:215], a[104:107]
ds_read_b64_tr_b16 v[238:239], v21 offset:58368
ds_read2_b32 v[52:53], v98 offset0:0 offset1:32
v_mfma_f32_16x16x32_bf16 a[104:107], v[248:251], v[208:211], a[104:107]
ds_read2_b32 v[54:55], v98 offset0:64 offset1:96
ds_read2_b32 v[56:57], v98 offset0:128 offset1:160
v_mfma_f32_16x16x32_bf16 a[100:103], v[248:251], v[200:203], a[100:103]
ds_read2_b32 v[58:59], v98 offset0:192 offset1:224
v_add_u32 v98, 1024, v98
v_mfma_f32_16x16x32_bf16 a[100:103], v[252:255], v[204:207], a[100:103]
ds_read2_b32 v[60:61], v98 offset0:0 offset1:32
ds_read2_b32 v[62:63], v98 offset0:64 offset1:96
v_mfma_f32_16x16x32_bf16 a[96:99], v[252:255], v[196:199], a[96:99]
ds_read2_b32 v[64:65], v98 offset0:128 offset1:160
ds_read2_b32 v[66:67], v98 offset0:192 offset1:224
v_mfma_f32_16x16x32_bf16 a[96:99], v[248:251], v[192:195], a[96:99]
s_waitcnt lgkmcnt(15)
v_mfma_f32_16x16x32_bf16 a[128:131], v[192:195], v[224:227], a[128:131]
ds_read_b64_tr_b16 v[240:241], v22 offset:49152
v_mfma_f32_16x16x32_bf16 a[128:131], v[196:199], v[228:231], a[128:131]
v_mfma_f32_16x16x32_bf16 a[132:135], v[204:207], v[228:231], a[132:135]
v_mfma_f32_16x16x32_bf16 a[132:135], v[200:203], v[224:227], a[132:135]
ds_read_b64_tr_b16 v[242:243], v22 offset:50176
v_mfma_f32_16x16x32_bf16 a[136:139], v[208:211], v[224:227], a[136:139]
v_mfma_f32_16x16x32_bf16 a[136:139], v[212:215], v[228:231], a[136:139]
v_mfma_f32_16x16x32_bf16 a[140:143], v[220:223], v[228:231], a[140:143]
v_mfma_f32_16x16x32_bf16 a[140:143], v[216:219], v[224:227], a[140:143]
ds_read_b64_tr_b16 v[244:245], v22 offset:57344
v_mfma_f32_16x16x32_bf16 a[144:147], v[184:187], v[224:227], a[144:147]
v_mfma_f32_16x16x32_bf16 a[144:147], v[188:191], v[228:231], a[144:147]
v_mfma_f32_16x16x32_bf16 a[148:151], v[180:183], v[228:231], a[148:151]
ds_read_b64_tr_b16 v[246:247], v22 offset:58368
v_mfma_f32_16x16x32_bf16 a[148:151], v[176:179], v[224:227], a[148:151]
v_mfma_f32_16x16x32_bf16 a[152:155], v[168:171], v[224:227], a[152:155]
v_mfma_f32_16x16x32_bf16 a[152:155], v[172:175], v[228:231], a[152:155]
v_mfma_f32_16x16x32_bf16 a[156:159], v[164:167], v[228:231], a[156:159]
v_mfma_f32_16x16x32_bf16 a[156:159], v[160:163], v[224:227], a[156:159]
s_waitcnt lgkmcnt(12)
v_mfma_f32_16x16x32_bf16 a[188:191], v[160:163], v[232:235], a[188:191]
ds_read_b64_tr_b16 v[248:249], v23 offset:49152
v_mfma_f32_16x16x32_bf16 a[188:191], v[164:167], v[236:239], a[188:191]
v_mfma_f32_16x16x32_bf16 a[184:187], v[172:175], v[236:239], a[184:187]
ds_read_b64_tr_b16 v[250:251], v23 offset:50176
v_mfma_f32_16x16x32_bf16 a[184:187], v[168:171], v[232:235], a[184:187]
v_mfma_f32_16x16x32_bf16 a[180:183], v[176:179], v[232:235], a[180:183]
ds_read_b64_tr_b16 v[252:253], v23 offset:57344
v_mfma_f32_16x16x32_bf16 a[180:183], v[180:183], v[236:239], a[180:183]
v_mfma_f32_16x16x32_bf16 a[176:179], v[188:191], v[236:239], a[176:179]
ds_read_b64_tr_b16 v[254:255], v23 offset:58368
v_mfma_f32_16x16x32_bf16 a[176:179], v[184:187], v[232:235], a[176:179]
v_mfma_f32_16x16x32_bf16 a[172:175], v[216:219], v[232:235], a[172:175]
v_mfma_f32_16x16x32_bf16 a[172:175], v[220:223], v[236:239], a[172:175]
v_mfma_f32_16x16x32_bf16 a[168:171], v[212:215], v[236:239], a[168:171]
v_mfma_f32_16x16x32_bf16 a[168:171], v[208:211], v[232:235], a[168:171]
v_mfma_f32_16x16x32_bf16 a[164:167], v[200:203], v[232:235], a[164:167]
v_mfma_f32_16x16x32_bf16 a[164:167], v[204:207], v[236:239], a[164:167]
v_mfma_f32_16x16x32_bf16 a[160:163], v[196:199], v[236:239], a[160:163]
s_waitcnt vmcnt(4) lgkmcnt(0)
v_mfma_f32_16x16x32_bf16 a[160:163], v[192:195], v[232:235], a[160:163]
s_barrier
v_mfma_f32_16x16x32_bf16 a[192:195], v[192:195], v[240:243], a[192:195]
s_and_b32 s73, s65, 1
ds_read_b64_tr_b16 v[224:225], v20 offset:0
v_lshlrev_b32 v72, 16, v68
v_mfma_f32_16x16x32_bf16 a[192:195], v[196:199], v[244:247], a[192:195]
s_xor_b32 s73, s73, 5
ds_read_b64_tr_b16 v[226:227], v20 offset:1024
v_and_b32 v73, 0xffff0000, v68
v_mfma_f32_16x16x32_bf16 a[196:199], v[204:207], v[244:247], a[196:199]
s_lshl_b32 s69, s73, 7
ds_read_b64_tr_b16 v[228:229], v20 offset:8192
v_lshlrev_b32 v74, 16, v69
v_mfma_f32_16x16x32_bf16 a[196:199], v[200:203], v[240:243], a[196:199]
s_add_u32 s69, s69, s84
ds_read_b64_tr_b16 v[230:231], v20 offset:9216
v_and_b32 v75, 0xffff0000, v69
v_mfma_f32_16x16x32_bf16 a[200:203], v[208:211], v[240:243], a[200:203]
s_lshl_b32 s71, s73, 19
ds_read_b128 v[128:131], v24 offset:0
v_lshlrev_b32 v76, 16, v33
v_mfma_f32_16x16x32_bf16 a[200:203], v[212:215], v[244:247], a[200:203]
s_add_u32 s71, s71, s66
ds_read_b128 v[132:135], v25 offset:0
v_lshlrev_b32 v77, 16, v34
v_mfma_f32_16x16x32_bf16 a[204:207], v[220:223], v[244:247], a[204:207]
s_add_u32 m0, s63, 98304
v_lshlrev_b32 v78, 16, v35
v_lshlrev_b32 v79, 16, v36
v_mfma_f32_16x16x32_bf16 a[204:207], v[216:219], v[240:243], a[204:207]
s_add_u32 s72, s69, 0
buffer_load_dwordx4 v2, s[8:11], s72 offen lds
v_mfma_f32_16x16x32_bf16 a[208:211], v[184:187], v[240:243], a[208:211]
s_add_u32 s72, s69, 7168
buffer_load_dwordx4 v3, s[8:11], s72 offen offset:1024 lds
v_mfma_f32_16x16x32_bf16 a[208:211], v[188:191], v[244:247], a[208:211]
s_add_u32 s72, s69, 14336
buffer_load_dwordx4 v2, s[8:11], s72 offen offset:2048 lds
v_mfma_f32_16x16x32_bf16 a[212:215], v[180:183], v[244:247], a[212:215]
ds_read_b128 v[136:139], v24 offset:2048
v_lshlrev_b32 v80, 16, v37
v_mfma_f32_16x16x32_bf16 a[212:215], v[176:179], v[240:243], a[212:215]
ds_read_b128 v[140:143], v25 offset:2048
v_lshlrev_b32 v81, 16, v38
v_mfma_f32_16x16x32_bf16 a[216:219], v[168:171], v[240:243], a[216:219]
s_add_u32 s72, s69, 21504
buffer_load_dwordx4 v3, s[8:11], s72 offen offset:3072 lds
v_mfma_f32_16x16x32_bf16 a[216:219], v[172:175], v[244:247], a[216:219]
ds_read_b128 v[144:147], v24 offset:4096
v_lshlrev_b32 v82, 16, v39
v_mfma_f32_16x16x32_bf16 a[220:223], v[164:167], v[244:247], a[220:223]
ds_read_b128 v[148:151], v25 offset:4096
v_lshlrev_b32 v83, 16, v40
v_mfma_f32_16x16x32_bf16 a[220:223], v[160:163], v[240:243], a[220:223]
ds_read_b128 v[152:155], v24 offset:6144
v_lshlrev_b32 v84, 16, v41
v_mfma_f32_16x16x32_bf16 a[252:255], v[160:163], v[248:251], a[252:255]
ds_read_b128 v[156:159], v25 offset:6144
v_lshlrev_b32 v85, 16, v42
v_mfma_f32_16x16x32_bf16 a[252:255], v[164:167], v[252:255], a[252:255]
s_add_u32 m0, s64, 32768
v_lshlrev_b32 v86, 16, v43
v_lshlrev_b32 v87, 16, v44
v_mfma_f32_16x16x32_bf16 a[248:251], v[172:175], v[252:255], a[248:251]
s_add_u32 s72, s71, 0
buffer_load_dwordx4 v6, s[16:19], s72 offen lds
v_mfma_f32_16x16x32_bf16 a[248:251], v[168:171], v[248:251], a[248:251]
ds_read_b128 v[160:163], v24 offset:8192
v_lshlrev_b32 v88, 16, v45
v_mfma_f32_16x16x32_bf16 a[244:247], v[176:179], v[248:251], a[244:247]
ds_read_b128 v[164:167], v25 offset:8192
v_lshlrev_b32 v89, 16, v46
v_mfma_f32_16x16x32_bf16 a[244:247], v[180:183], v[252:255], a[244:247]
s_add_u32 s72, s71, 31744
buffer_load_dwordx4 v6, s[16:19], s72 offen offset:1024 lds
v_mfma_f32_16x16x32_bf16 a[240:243], v[188:191], v[252:255], a[240:243]
ds_read_b128 v[168:171], v24 offset:10240
v_lshlrev_b32 v90, 16, v47
v_mfma_f32_16x16x32_bf16 a[240:243], v[184:187], v[248:251], a[240:243]
ds_read_b128 v[172:175], v25 offset:10240
v_lshlrev_b32 v91, 16, v48
v_mfma_f32_16x16x32_bf16 a[236:239], v[216:219], v[248:251], a[236:239]
ds_read_b128 v[176:179], v24 offset:12288
v_lshlrev_b32 v92, 16, v49
v_mfma_f32_16x16x32_bf16 a[236:239], v[220:223], v[252:255], a[236:239]
s_add_u32 s72, s71, 63488
buffer_load_dwordx4 v7, s[16:19], s72 offen offset:2048 lds
v_mfma_f32_16x16x32_bf16 a[232:235], v[212:215], v[252:255], a[232:235]
ds_read_b128 v[180:183], v25 offset:12288
v_lshlrev_b32 v93, 16, v50
v_mfma_f32_16x16x32_bf16 a[232:235], v[208:211], v[248:251], a[232:235]
ds_read_b128 v[184:187], v24 offset:14336
v_lshlrev_b32 v94, 16, v51
v_mfma_f32_16x16x32_bf16 a[228:231], v[200:203], v[248:251], a[228:231]
ds_read_b128 v[188:191], v25 offset:14336
v_mul_f32 v95, v75, v91
v_mfma_f32_16x16x32_bf16 a[228:231], v[204:207], v[252:255], a[228:231]
v_lshlrev_b32 v97, 16, v67
v_fmac_f32 v95, v74, v92
v_mfma_f32_16x16x32_bf16 a[224:227], v[196:199], v[252:255], a[224:227]
s_add_u32 s72, s71, 95232
buffer_load_dwordx4 v7, s[16:19], s72 offen offset:3072 lds
v_mfma_f32_16x16x32_bf16 a[224:227], v[192:195], v[248:251], a[224:227]
s_waitcnt lgkmcnt(8)
ds_read_b64_tr_b16 v[232:233], v21 offset:0
v_fmac_f32 v95, v73, v93
v_mfma_f32_16x16x32_bf16 a[0:3], v[224:227], v[128:131], a[0:3]
ds_read_b64_tr_b16 v[234:235], v21 offset:1024
v_fmac_f32 v95, v72, v94
v_mfma_f32_16x16x32_bf16 a[0:3], v[228:231], v[132:135], a[0:3]
ds_read_b64_tr_b16 v[240:241], v22 offset:0
v_mul_f32 v95, v95, v97
v_mfma_f32_16x16x32_bf16 a[4:7], v[228:231], v[140:143], a[4:7]
s_add_u32 m0, s63, 102400
ds_read_b64_tr_b16 v[236:237], v21 offset:8192
v_mul_f32 v96, v75, v90
v_mfma_f32_16x16x32_bf16 a[4:7], v[224:227], v[136:139], a[4:7]
s_add_u32 s72, s69, 32768
buffer_load_dwordx4 v2, s[8:11], s72 offen lds
v_mfma_f32_16x16x32_bf16 a[8:11], v[224:227], v[144:147], a[8:11]
ds_read_b64_tr_b16 v[238:239], v21 offset:9216
v_lshlrev_b32 v97, 16, v66
v_mfma_f32_16x16x32_bf16 a[8:11], v[228:231], v[148:151], a[8:11]
v_fmac_f32 v96, v74, v91
v_fmac_f32 v96, v73, v92
v_mfma_f32_16x16x32_bf16 a[12:15], v[228:231], v[156:159], a[12:15]
s_add_u32 s72, s69, 39936
buffer_load_dwordx4 v3, s[8:11], s72 offen offset:1024 lds
v_mfma_f32_16x16x32_bf16 a[12:15], v[224:227], v[152:155], a[12:15]
s_waitcnt lgkmcnt(5)
ds_read_b64_tr_b16 v[242:243], v22 offset:1024
v_fmac_f32 v96, v72, v93
v_mfma_f32_16x16x32_bf16 a[16:19], v[224:227], v[160:163], a[16:19]
v_mul_f32 v96, v96, v97
v_cvt_pk_bf16_f32 v100, v95, v96
v_mfma_f32_16x16x32_bf16 a[16:19], v[228:231], v[164:167], a[16:19]
ds_read_b64_tr_b16 v[244:245], v22 offset:8192
v_mul_f32 v95, v75, v89
v_mfma_f32_16x16x32_bf16 a[20:23], v[228:231], v[172:175], a[20:23]
v_lshlrev_b32 v97, 16, v65
v_fmac_f32 v95, v74, v90
v_mfma_f32_16x16x32_bf16 a[20:23], v[224:227], v[168:171], a[20:23]
s_add_u32 s72, s69, 47104
buffer_load_dwordx4 v2, s[8:11], s72 offen offset:2048 lds
v_mfma_f32_16x16x32_bf16 a[24:27], v[224:227], v[176:179], a[24:27]
ds_read_b64_tr_b16 v[246:247], v22 offset:9216
v_fmac_f32 v95, v73, v91
v_mfma_f32_16x16x32_bf16 a[24:27], v[228:231], v[180:183], a[24:27]
v_fmac_f32 v95, v72, v92
v_mul_f32 v95, v95, v97
v_mfma_f32_16x16x32_bf16 a[28:31], v[228:231], v[188:191], a[28:31]
v_mul_f32 v96, v75, v88
v_lshlrev_b32 v97, 16, v64
v_mfma_f32_16x16x32_bf16 a[28:31], v[224:227], v[184:187], a[28:31]
s_waitcnt lgkmcnt(3)
v_fmac_f32 v96, v74, v89
v_fmac_f32 v96, v73, v90
v_mfma_f32_16x16x32_bf16 a[60:63], v[232:235], v[184:187], a[60:63]
s_add_u32 s72, s69, 54272
buffer_load_dwordx4 v3, s[8:11], s72 offen offset:3072 lds
v_mfma_f32_16x16x32_bf16 a[60:63], v[236:239], v[188:191], a[60:63]
ds_read_b64_tr_b16 v[248:249], v23 offset:0
v_fmac_f32 v96, v72, v91
v_mfma_f32_16x16x32_bf16 a[56:59], v[236:239], v[180:183], a[56:59]
v_mul_f32 v96, v96, v97
v_cvt_pk_bf16_f32 v101, v95, v96
v_mfma_f32_16x16x32_bf16 a[56:59], v[232:235], v[176:179], a[56:59]
s_add_u32 m0, s64, 49152
ds_read_b64_tr_b16 v[250:251], v23 offset:1024
v_mul_f32 v95, v75, v87
v_mfma_f32_16x16x32_bf16 a[52:55], v[232:235], v[168:171], a[52:55]
s_add_u32 s72, s71, 0
buffer_load_dwordx4 v6, s[20:23], s72 offen lds
v_mfma_f32_16x16x32_bf16 a[52:55], v[236:239], v[172:175], a[52:55]
v_lshlrev_b32 v97, 16, v63
v_fmac_f32 v95, v74, v88
v_mfma_f32_16x16x32_bf16 a[48:51], v[236:239], v[164:167], a[48:51]
v_fmac_f32 v95, v73, v89
v_fmac_f32 v95, v72, v90
v_mfma_f32_16x16x32_bf16 a[48:51], v[232:235], v[160:163], a[48:51]
ds_read_b64_tr_b16 v[252:253], v23 offset:8192
v_mul_f32 v95, v95, v97
v_mfma_f32_16x16x32_bf16 a[44:47], v[232:235], v[152:155], a[44:47]
s_add_u32 s72, s71, 31744
buffer_load_dwordx4 v6, s[20:23], s72 offen offset:1024 lds
v_mfma_f32_16x16x32_bf16 a[44:47], v[236:239], v[156:159], a[44:47]
v_mul_f32 v96, v75, v86
v_lshlrev_b32 v97, 16, v62
v_mfma_f32_16x16x32_bf16 a[40:43], v[236:239], v[148:151], a[40:43]
ds_read_b64_tr_b16 v[254:255], v23 offset:9216
v_fmac_f32 v96, v74, v87
v_mfma_f32_16x16x32_bf16 a[40:43], v[232:235], v[144:147], a[40:43]
v_fmac_f32 v96, v73, v88
v_fmac_f32 v96, v72, v89
v_mfma_f32_16x16x32_bf16 a[36:39], v[232:235], v[136:139], a[36:39]
s_add_u32 s72, s71, 63488
buffer_load_dwordx4 v7, s[20:23], s72 offen offset:2048 lds
v_mfma_f32_16x16x32_bf16 a[36:39], v[236:239], v[140:143], a[36:39]
v_mul_f32 v96, v96, v97
v_cvt_pk_bf16_f32 v102, v95, v96
v_mfma_f32_16x16x32_bf16 a[32:35], v[236:239], v[132:135], a[32:35]
v_mul_f32 v95, v75, v85
v_lshlrev_b32 v97, 16, v61
v_mfma_f32_16x16x32_bf16 a[32:35], v[232:235], v[128:131], a[32:35]
s_waitcnt lgkmcnt(4)
v_fmac_f32 v95, v74, v86
v_fmac_f32 v95, v73, v87
v_mfma_f32_16x16x32_bf16 a[64:67], v[240:243], v[128:131], a[64:67]
s_add_u32 s72, s71, 95232
buffer_load_dwordx4 v7, s[20:23], s72 offen offset:3072 lds
v_mfma_f32_16x16x32_bf16 a[64:67], v[244:247], v[132:135], a[64:67]
s_mov_b32 s80, 0x0
buffer_load_dword v126, v125, s[12:15], s80 offen
v_mfma_f32_16x16x32_bf16 a[68:71], v[244:247], v[140:143], a[68:71]
s_mov_b32 s80, 0x100000
buffer_load_dword v126, v125, s[12:15], s80 offen
v_mfma_f32_16x16x32_bf16 a[68:71], v[240:243], v[136:139], a[68:71]
s_mov_b32 s80, 0x200000
buffer_load_dword v126, v125, s[12:15], s80 offen
v_mfma_f32_16x16x32_bf16 a[72:75], v[240:243], v[144:147], a[72:75]
s_mov_b32 s80, 0x300000
buffer_load_dword v126, v125, s[12:15], s80 offen
v_mfma_f32_16x16x32_bf16 a[72:75], v[244:247], v[148:151], a[72:75]
ds_read_b64_tr_b16 v[224:225], v20 offset:16384
v_fmac_f32 v95, v72, v88
v_mfma_f32_16x16x32_bf16 a[76:79], v[244:247], v[156:159], a[76:79]
v_mul_f32 v95, v95, v97
v_mul_f32 v96, v75, v84
v_mfma_f32_16x16x32_bf16 a[76:79], v[240:243], v[152:155], a[76:79]
ds_read_b64_tr_b16 v[226:227], v20 offset:17408
v_lshlrev_b32 v97, 16, v60
v_mfma_f32_16x16x32_bf16 a[80:83], v[240:243], v[160:163], a[80:83]
v_fmac_f32 v96, v74, v85
v_fmac_f32 v96, v73, v86
v_mfma_f32_16x16x32_bf16 a[80:83], v[244:247], v[164:167], a[80:83]
ds_read_b64_tr_b16 v[228:229], v20 offset:24576
v_fmac_f32 v96, v72, v87
v_mfma_f32_16x16x32_bf16 a[84:87], v[244:247], v[172:175], a[84:87]
v_mul_f32 v96, v96, v97
v_cvt_pk_bf16_f32 v103, v95, v96
v_mfma_f32_16x16x32_bf16 a[84:87], v[240:243], v[168:171], a[84:87]
ds_read_b64_tr_b16 v[230:231], v20 offset:25600
ds_write_b128 v28, v[100:103] offset:0
v_mfma_f32_16x16x32_bf16 a[88:91], v[240:243], v[176:179], a[88:91]
v_mul_f32 v95, v75, v83
v_lshlrev_b32 v97, 16, v59
v_mfma_f32_16x16x32_bf16 a[88:91], v[244:247], v[180:183], a[88:91]
v_fmac_f32 v95, v74, v84
v_fmac_f32 v95, v73, v85
v_mfma_f32_16x16x32_bf16 a[92:95], v[244:247], v[188:191], a[92:95]
v_fmac_f32 v95, v72, v86
v_mul_f32 v95, v95, v97
v_mfma_f32_16x16x32_bf16 a[92:95], v[240:243], v[184:187], a[92:95]
s_waitcnt lgkmcnt(5)
v_mul_f32 v96, v75, v82
v_lshlrev_b32 v97, 16, v58
v_mfma_f32_16x16x32_bf16 a[124:127], v[248:251], v[184:187], a[124:127]
ds_read_b64_tr_b16 v[232:233], v21 offset:16384
v_fmac_f32 v96, v74, v83
v_mfma_f32_16x16x32_bf16 a[124:127], v[252:255], v[188:191], a[124:127]
v_fmac_f32 v96, v73, v84
v_fmac_f32 v96, v72, v85
v_mfma_f32_16x16x32_bf16 a[120:123], v[252:255], v[180:183], a[120:123]
v_mul_f32 v96, v96, v97
v_cvt_pk_bf16_f32 v104, v95, v96
v_mfma_f32_16x16x32_bf16 a[120:123], v[248:251], v[176:179], a[120:123]
ds_read_b64_tr_b16 v[234:235], v21 offset:17408
v_mul_f32 v95, v75, v81
v_mfma_f32_16x16x32_bf16 a[116:119], v[248:251], v[168:171], a[116:119]
v_lshlrev_b32 v97, 16, v57
v_fmac_f32 v95, v74, v82
v_mfma_f32_16x16x32_bf16 a[116:119], v[252:255], v[172:175], a[116:119]
v_fmac_f32 v95, v73, v83
v_fmac_f32 v95, v72, v84
v_mfma_f32_16x16x32_bf16 a[112:115], v[252:255], v[164:167], a[112:115]
v_mul_f32 v95, v95, v97
v_mul_f32 v96, v75, v80
v_mfma_f32_16x16x32_bf16 a[112:115], v[248:251], v[160:163], a[112:115]
ds_read_b64_tr_b16 v[236:237], v21 offset:24576
v_lshlrev_b32 v97, 16, v56
v_mfma_f32_16x16x32_bf16 a[108:111], v[248:251], v[152:155], a[108:111]
v_fmac_f32 v96, v74, v81
v_fmac_f32 v96, v73, v82
v_mfma_f32_16x16x32_bf16 a[108:111], v[252:255], v[156:159], a[108:111]
v_fmac_f32 v96, v72, v83
v_mul_f32 v96, v96, v97
v_mfma_f32_16x16x32_bf16 a[104:107], v[252:255], v[148:151], a[104:107]
ds_read_b64_tr_b16 v[238:239], v21 offset:25600
v_cvt_pk_bf16_f32 v105, v95, v96
v_mfma_f32_16x16x32_bf16 a[104:107], v[248:251], v[144:147], a[104:107]
v_mul_f32 v95, v75, v79
v_lshlrev_b32 v97, 16, v55
v_mfma_f32_16x16x32_bf16 a[100:103], v[248:251], v[136:139], a[100:103]
v_fmac_f32 v95, v74, v80
v_fmac_f32 v95, v73, v81
v_mfma_f32_16x16x32_bf16 a[100:103], v[252:255], v[140:143], a[100:103]
v_fmac_f32 v95, v72, v82
v_mul_f32 v95, v95, v97
v_mfma_f32_16x16x32_bf16 a[96:99], v[252:255], v[132:135], a[96:99]
v_mul_f32 v96, v75, v78
v_lshlrev_b32 v97, 16, v54
v_mfma_f32_16x16x32_bf16 a[96:99], v[248:251], v[128:131], a[96:99]
s_waitcnt lgkmcnt(5)
v_fmac_f32 v96, v74, v79
v_fmac_f32 v96, v73, v80
v_mfma_f32_16x16x32_bf16 a[128:131], v[128:131], v[224:227], a[128:131]
ds_read_b64_tr_b16 v[240:241], v22 offset:16384
v_fmac_f32 v96, v72, v81
v_mfma_f32_16x16x32_bf16 a[128:131], v[132:135], v[228:231], a[128:131]
v_mul_f32 v96, v96, v97
v_cvt_pk_bf16_f32 v106, v95, v96
v_mfma_f32_16x16x32_bf16 a[132:135], v[140:143], v[228:231], a[132:135]
v_mul_f32 v95, v75, v77
v_lshlrev_b32 v97, 16, v53
v_mfma_f32_16x16x32_bf16 a[132:135], v[136:139], v[224:227], a[132:135]
ds_read_b64_tr_b16 v[242:243], v22 offset:17408
v_fmac_f32 v95, v74, v78
v_mfma_f32_16x16x32_bf16 a[136:139], v[144:147], v[224:227], a[136:139]
v_fmac_f32 v95, v73, v79
v_fmac_f32 v95, v72, v80
v_mfma_f32_16x16x32_bf16 a[136:139], v[148:151], v[228:231], a[136:139]
v_mul_f32 v95, v95, v97
v_mul_f32 v96, v75, v76
v_mfma_f32_16x16x32_bf16 a[140:143], v[156:159], v[228:231], a[140:143]
v_lshlrev_b32 v97, 16, v52
v_fmac_f32 v96, v74, v77
v_mfma_f32_16x16x32_bf16 a[140:143], v[152:155], v[224:227], a[140:143]
ds_read_b64_tr_b16 v[244:245], v22 offset:24576
v_fmac_f32 v96, v73, v78
v_mfma_f32_16x16x32_bf16 a[144:147], v[160:163], v[224:227], a[144:147]
v_fmac_f32 v96, v72, v79
v_mul_f32 v96, v96, v97
v_mfma_f32_16x16x32_bf16 a[144:147], v[164:167], v[228:231], a[144:147]
v_cvt_pk_bf16_f32 v107, v95, v96
v_mfma_f32_16x16x32_bf16 a[148:151], v[172:175], v[228:231], a[148:151]
ds_read_b64_tr_b16 v[246:247], v22 offset:25600
ds_write_b128 v28, v[104:107] offset:16
v_mfma_f32_16x16x32_bf16 a[148:151], v[168:171], v[224:227], a[148:151]
global_load_dwordx4 v[84:87], v1, s[56:57]
v_mfma_f32_16x16x32_bf16 a[152:155], v[176:179], v[224:227], a[152:155]
global_load_dwordx4 v[88:91], v1, s[56:57] offset:1024
v_mfma_f32_16x16x32_bf16 a[152:155], v[180:183], v[228:231], a[152:155]
v_lshlrev_b32 v72, 16, v70
v_and_b32 v73, 0xffff0000, v70
v_mfma_f32_16x16x32_bf16 a[156:159], v[188:191], v[228:231], a[156:159]
v_lshlrev_b32 v74, 16, v71
v_and_b32 v75, 0xffff0000, v71
v_mfma_f32_16x16x32_bf16 a[156:159], v[184:187], v[224:227], a[156:159]
s_waitcnt lgkmcnt(5)
v_and_b32 v33, 0xffff0000, v33
v_and_b32 v34, 0xffff0000, v34
v_mfma_f32_16x16x32_bf16 a[188:191], v[184:187], v[232:235], a[188:191]
ds_read_b64_tr_b16 v[248:249], v23 offset:16384
v_and_b32 v35, 0xffff0000, v35
v_mfma_f32_16x16x32_bf16 a[188:191], v[188:191], v[236:239], a[188:191]
v_and_b32 v36, 0xffff0000, v36
v_and_b32 v37, 0xffff0000, v37
v_mfma_f32_16x16x32_bf16 a[184:187], v[180:183], v[236:239], a[184:187]
ds_read_b64_tr_b16 v[250:251], v23 offset:17408
v_and_b32 v38, 0xffff0000, v38
v_mfma_f32_16x16x32_bf16 a[184:187], v[176:179], v[232:235], a[184:187]
v_and_b32 v39, 0xffff0000, v39
v_and_b32 v40, 0xffff0000, v40
v_mfma_f32_16x16x32_bf16 a[180:183], v[168:171], v[232:235], a[180:183]
ds_read_b64_tr_b16 v[252:253], v23 offset:24576
v_and_b32 v41, 0xffff0000, v41
v_mfma_f32_16x16x32_bf16 a[180:183], v[172:175], v[236:239], a[180:183]
v_and_b32 v42, 0xffff0000, v42
v_and_b32 v43, 0xffff0000, v43
v_mfma_f32_16x16x32_bf16 a[176:179], v[164:167], v[236:239], a[176:179]
ds_read_b64_tr_b16 v[254:255], v23 offset:25600
v_and_b32 v44, 0xffff0000, v44
v_mfma_f32_16x16x32_bf16 a[176:179], v[160:163], v[232:235], a[176:179]
v_and_b32 v45, 0xffff0000, v45
v_and_b32 v46, 0xffff0000, v46
v_mfma_f32_16x16x32_bf16 a[172:175], v[152:155], v[232:235], a[172:175]
v_and_b32 v47, 0xffff0000, v47
v_and_b32 v48, 0xffff0000, v48
v_mfma_f32_16x16x32_bf16 a[172:175], v[156:159], v[236:239], a[172:175]
v_and_b32 v49, 0xffff0000, v49
v_and_b32 v50, 0xffff0000, v50
v_mfma_f32_16x16x32_bf16 a[168:171], v[148:151], v[236:239], a[168:171]
v_and_b32 v51, 0xffff0000, v51
v_mul_f32 v95, v75, v48
v_mfma_f32_16x16x32_bf16 a[168:171], v[144:147], v[232:235], a[168:171]
v_and_b32 v97, 0xffff0000, v67
v_fmac_f32 v95, v74, v49
v_mfma_f32_16x16x32_bf16 a[164:167], v[136:139], v[232:235], a[164:167]
v_fmac_f32 v95, v73, v50
v_fmac_f32 v95, v72, v51
v_mfma_f32_16x16x32_bf16 a[164:167], v[140:143], v[236:239], a[164:167]
v_mul_f32 v95, v95, v97
v_mul_f32 v96, v75, v47
v_mfma_f32_16x16x32_bf16 a[160:163], v[132:135], v[236:239], a[160:163]
s_waitcnt vmcnt(6) lgkmcnt(0)
v_and_b32 v97, 0xffff0000, v66
v_fmac_f32 v96, v74, v48
v_mfma_f32_16x16x32_bf16 a[160:163], v[128:131], v[232:235], a[160:163]
s_barrier
v_fmac_f32 v96, v73, v49
v_fmac_f32 v96, v72, v50
v_mfma_f32_16x16x32_bf16 a[192:195], v[128:131], v[240:243], a[192:195]
s_and_b32 s73, s65, 1
ds_read_b64_tr_b16 v[224:225], v20 offset:32768
v_mul_f32 v96, v96, v97
v_mfma_f32_16x16x32_bf16 a[192:195], v[132:135], v[244:247], a[192:195]
s_xor_b32 s73, s73, 6
ds_read_b64_tr_b16 v[226:227], v20 offset:33792
v_cvt_pk_bf16_f32 v100, v95, v96
v_mfma_f32_16x16x32_bf16 a[196:199], v[140:143], v[244:247], a[196:199]
s_lshl_b32 s69, s73, 7
ds_read_b64_tr_b16 v[228:229], v20 offset:40960
v_mul_f32 v95, v75, v46
v_mfma_f32_16x16x32_bf16 a[196:199], v[136:139], v[240:243], a[196:199]
s_add_u32 s69, s69, s84
ds_read_b64_tr_b16 v[230:231], v20 offset:41984
v_and_b32 v97, 0xffff0000, v65
v_mfma_f32_16x16x32_bf16 a[200:203], v[144:147], v[240:243], a[200:203]
s_lshl_b32 s71, s73, 19
ds_read_b128 v[192:195], v24 offset:32768
v_fmac_f32 v95, v74, v47
v_mfma_f32_16x16x32_bf16 a[200:203], v[148:151], v[244:247], a[200:203]
s_add_u32 s71, s71, s66
ds_read_b128 v[196:199], v25 offset:32768
v_fmac_f32 v95, v73, v48
v_mfma_f32_16x16x32_bf16 a[204:207], v[156:159], v[244:247], a[204:207]
s_add_u32 m0, s63, 65536
v_fmac_f32 v95, v72, v49
v_mul_f32 v95, v95, v97
v_mfma_f32_16x16x32_bf16 a[204:207], v[152:155], v[240:243], a[204:207]
s_add_u32 s72, s69, 0
buffer_load_dwordx4 v2, s[8:11], s72 offen lds
v_mfma_f32_16x16x32_bf16 a[208:211], v[160:163], v[240:243], a[208:211]
s_add_u32 s72, s69, 7168
buffer_load_dwordx4 v3, s[8:11], s72 offen offset:1024 lds
v_mfma_f32_16x16x32_bf16 a[208:211], v[164:167], v[244:247], a[208:211]
s_add_u32 s72, s69, 14336
buffer_load_dwordx4 v2, s[8:11], s72 offen offset:2048 lds
v_mfma_f32_16x16x32_bf16 a[212:215], v[172:175], v[244:247], a[212:215]
ds_read_b128 v[200:203], v24 offset:34816
v_mul_f32 v96, v75, v45
v_mfma_f32_16x16x32_bf16 a[212:215], v[168:171], v[240:243], a[212:215]
ds_read_b128 v[204:207], v25 offset:34816
v_and_b32 v97, 0xffff0000, v64
v_mfma_f32_16x16x32_bf16 a[216:219], v[176:179], v[240:243], a[216:219]
s_add_u32 s72, s69, 21504
buffer_load_dwordx4 v3, s[8:11], s72 offen offset:3072 lds
v_mfma_f32_16x16x32_bf16 a[216:219], v[180:183], v[244:247], a[216:219]
ds_read_b128 v[208:211], v24 offset:36864
v_fmac_f32 v96, v74, v46
v_mfma_f32_16x16x32_bf16 a[220:223], v[188:191], v[244:247], a[220:223]
ds_read_b128 v[212:215], v25 offset:36864
v_fmac_f32 v96, v73, v47
v_mfma_f32_16x16x32_bf16 a[220:223], v[184:187], v[240:243], a[220:223]
ds_read_b128 v[216:219], v24 offset:38912
v_fmac_f32 v96, v72, v48
v_mfma_f32_16x16x32_bf16 a[252:255], v[184:187], v[248:251], a[252:255]
ds_read_b128 v[220:223], v25 offset:38912
v_mul_f32 v96, v96, v97
v_mfma_f32_16x16x32_bf16 a[252:255], v[188:191], v[252:255], a[252:255]
s_add_u32 m0, s64, 0
v_cvt_pk_bf16_f32 v101, v95, v96
v_mul_f32 v95, v75, v44
v_mfma_f32_16x16x32_bf16 a[248:251], v[180:183], v[252:255], a[248:251]
s_add_u32 s72, s71, 0
buffer_load_dwordx4 v6, s[16:19], s72 offen lds
v_mfma_f32_16x16x32_bf16 a[248:251], v[176:179], v[248:251], a[248:251]
ds_read_b128 v[184:187], v24 offset:40960
v_and_b32 v97, 0xffff0000, v63
v_mfma_f32_16x16x32_bf16 a[244:247], v[168:171], v[248:251], a[244:247]
ds_read_b128 v[188:191], v25 offset:40960
v_fmac_f32 v95, v74, v45
v_mfma_f32_16x16x32_bf16 a[244:247], v[172:175], v[252:255], a[244:247]
s_add_u32 s72, s71, 31744
buffer_load_dwordx4 v6, s[16:19], s72 offen offset:1024 lds
v_mfma_f32_16x16x32_bf16 a[240:243], v[164:167], v[252:255], a[240:243]
ds_read_b128 v[176:179], v24 offset:43008
v_fmac_f32 v95, v73, v46
v_mfma_f32_16x16x32_bf16 a[240:243], v[160:163], v[248:251], a[240:243]
ds_read_b128 v[180:183], v25 offset:43008
v_fmac_f32 v95, v72, v47
v_mfma_f32_16x16x32_bf16 a[236:239], v[152:155], v[248:251], a[236:239]
ds_read_b128 v[168:171], v24 offset:45056
v_mul_f32 v95, v95, v97
v_mfma_f32_16x16x32_bf16 a[236:239], v[156:159], v[252:255], a[236:239]
s_add_u32 s72, s71, 63488
buffer_load_dwordx4 v7, s[16:19], s72 offen offset:2048 lds
v_mfma_f32_16x16x32_bf16 a[232:235], v[148:151], v[252:255], a[232:235]
ds_read_b128 v[172:175], v25 offset:45056
v_mul_f32 v96, v75, v43
v_mfma_f32_16x16x32_bf16 a[232:235], v[144:147], v[248:251], a[232:235]
ds_read_b128 v[160:163], v24 offset:47104
v_and_b32 v97, 0xffff0000, v62
v_mfma_f32_16x16x32_bf16 a[228:231], v[136:139], v[248:251], a[228:231]
ds_read_b128 v[164:167], v25 offset:47104
v_fmac_f32 v96, v74, v44
v_mfma_f32_16x16x32_bf16 a[228:231], v[140:143], v[252:255], a[228:231]
v_fmac_f32 v96, v73, v45
v_fmac_f32 v96, v72, v46
v_mfma_f32_16x16x32_bf16 a[224:227], v[132:135], v[252:255], a[224:227]
s_add_u32 s72, s71, 95232
buffer_load_dwordx4 v7, s[16:19], s72 offen offset:3072 lds
v_mfma_f32_16x16x32_bf16 a[224:227], v[128:131], v[248:251], a[224:227]
s_waitcnt lgkmcnt(8)
ds_read_b64_tr_b16 v[232:233], v21 offset:32768
v_mul_f32 v96, v96, v97
v_mfma_f32_16x16x32_bf16 a[0:3], v[224:227], v[192:195], a[0:3]
ds_read_b64_tr_b16 v[234:235], v21 offset:33792
v_cvt_pk_bf16_f32 v102, v95, v96
v_mfma_f32_16x16x32_bf16 a[0:3], v[228:231], v[196:199], a[0:3]
ds_read_b64_tr_b16 v[240:241], v22 offset:32768
v_mul_f32 v95, v75, v42
v_mfma_f32_16x16x32_bf16 a[4:7], v[228:231], v[204:207], a[4:7]
s_add_u32 m0, s63, 69632
ds_read_b64_tr_b16 v[236:237], v21 offset:40960
v_and_b32 v97, 0xffff0000, v61
v_mfma_f32_16x16x32_bf16 a[4:7], v[224:227], v[200:203], a[4:7]
s_add_u32 s72, s69, 32768
buffer_load_dwordx4 v2, s[8:11], s72 offen lds
v_mfma_f32_16x16x32_bf16 a[8:11], v[224:227], v[208:211], a[8:11]
ds_read_b64_tr_b16 v[238:239], v21 offset:41984
v_fmac_f32 v95, v74, v43
v_mfma_f32_16x16x32_bf16 a[8:11], v[228:231], v[212:215], a[8:11]
v_fmac_f32 v95, v73, v44
v_fmac_f32 v95, v72, v45
v_mfma_f32_16x16x32_bf16 a[12:15], v[228:231], v[220:223], a[12:15]
s_add_u32 s72, s69, 39936
buffer_load_dwordx4 v3, s[8:11], s72 offen offset:1024 lds
v_mfma_f32_16x16x32_bf16 a[12:15], v[224:227], v[216:219], a[12:15]
s_waitcnt lgkmcnt(5)
ds_read_b64_tr_b16 v[242:243], v22 offset:33792
v_mul_f32 v95, v95, v97
v_mfma_f32_16x16x32_bf16 a[16:19], v[224:227], v[184:187], a[16:19]
v_mul_f32 v96, v75, v41
v_and_b32 v97, 0xffff0000, v60
v_mfma_f32_16x16x32_bf16 a[16:19], v[228:231], v[188:191], a[16:19]
ds_read_b64_tr_b16 v[244:245], v22 offset:40960
v_fmac_f32 v96, v74, v42
v_mfma_f32_16x16x32_bf16 a[20:23], v[228:231], v[180:183], a[20:23]
v_fmac_f32 v96, v73, v43
v_fmac_f32 v96, v72, v44
v_mfma_f32_16x16x32_bf16 a[20:23], v[224:227], v[176:179], a[20:23]
s_add_u32 s72, s69, 47104
buffer_load_dwordx4 v2, s[8:11], s72 offen offset:2048 lds
v_mfma_f32_16x16x32_bf16 a[24:27], v[224:227], v[168:171], a[24:27]
ds_read_b64_tr_b16 v[246:247], v22 offset:41984
v_mul_f32 v96, v96, v97
v_mfma_f32_16x16x32_bf16 a[24:27], v[228:231], v[172:175], a[24:27]
v_cvt_pk_bf16_f32 v103, v95, v96
v_mfma_f32_16x16x32_bf16 a[28:31], v[228:231], v[164:167], a[28:31]
ds_write_b128 v28, v[100:103] offset:272
v_mul_f32 v95, v75, v40
v_mfma_f32_16x16x32_bf16 a[28:31], v[224:227], v[160:163], a[28:31]
s_waitcnt lgkmcnt(4)
v_and_b32 v97, 0xffff0000, v59
v_fmac_f32 v95, v74, v41
v_mfma_f32_16x16x32_bf16 a[60:63], v[232:235], v[160:163], a[60:63]
s_add_u32 s72, s69, 54272
buffer_load_dwordx4 v3, s[8:11], s72 offen offset:3072 lds
v_mfma_f32_16x16x32_bf16 a[60:63], v[236:239], v[164:167], a[60:63]
ds_read_b64_tr_b16 v[248:249], v23 offset:32768
v_fmac_f32 v95, v73, v42
v_mfma_f32_16x16x32_bf16 a[56:59], v[236:239], v[172:175], a[56:59]
v_fmac_f32 v95, v72, v43
v_mul_f32 v95, v95, v97
v_mfma_f32_16x16x32_bf16 a[56:59], v[232:235], v[168:171], a[56:59]
s_add_u32 m0, s64, 16384
ds_read_b64_tr_b16 v[250:251], v23 offset:33792
v_mul_f32 v96, v75, v39
v_mfma_f32_16x16x32_bf16 a[52:55], v[232:235], v[176:179], a[52:55]
s_add_u32 s72, s71, 0
buffer_load_dwordx4 v6, s[20:23], s72 offen lds
v_mfma_f32_16x16x32_bf16 a[52:55], v[236:239], v[180:183], a[52:55]
v_and_b32 v97, 0xffff0000, v58
v_fmac_f32 v96, v74, v40
v_mfma_f32_16x16x32_bf16 a[48:51], v[236:239], v[188:191], a[48:51]
v_fmac_f32 v96, v73, v41
v_fmac_f32 v96, v72, v42
v_mfma_f32_16x16x32_bf16 a[48:51], v[232:235], v[184:187], a[48:51]
ds_read_b64_tr_b16 v[252:253], v23 offset:40960
v_mul_f32 v96, v96, v97
v_mfma_f32_16x16x32_bf16 a[44:47], v[232:235], v[216:219], a[44:47]
s_add_u32 s72, s71, 31744
buffer_load_dwordx4 v6, s[20:23], s72 offen offset:1024 lds
v_mfma_f32_16x16x32_bf16 a[44:47], v[236:239], v[220:223], a[44:47]
v_cvt_pk_bf16_f32 v104, v95, v96
v_mul_f32 v95, v75, v38
v_mfma_f32_16x16x32_bf16 a[40:43], v[236:239], v[212:215], a[40:43]
ds_read_b64_tr_b16 v[254:255], v23 offset:41984
v_and_b32 v97, 0xffff0000, v57
v_mfma_f32_16x16x32_bf16 a[40:43], v[232:235], v[208:211], a[40:43]
v_fmac_f32 v95, v74, v39
v_fmac_f32 v95, v73, v40
v_mfma_f32_16x16x32_bf16 a[36:39], v[232:235], v[200:203], a[36:39]
s_add_u32 s72, s71, 63488
buffer_load_dwordx4 v7, s[20:23], s72 offen offset:2048 lds
v_mfma_f32_16x16x32_bf16 a[36:39], v[236:239], v[204:207], a[36:39]
v_fmac_f32 v95, v72, v41
v_mul_f32 v95, v95, v97
v_mfma_f32_16x16x32_bf16 a[32:35], v[236:239], v[196:199], a[32:35]
v_mul_f32 v96, v75, v37
v_and_b32 v97, 0xffff0000, v56
v_mfma_f32_16x16x32_bf16 a[32:35], v[232:235], v[192:195], a[32:35]
s_waitcnt lgkmcnt(5)
v_fmac_f32 v96, v74, v38
v_fmac_f32 v96, v73, v39
v_mfma_f32_16x16x32_bf16 a[64:67], v[240:243], v[192:195], a[64:67]
s_add_u32 s72, s71, 95232
buffer_load_dwordx4 v7, s[20:23], s72 offen offset:3072 lds
v_mfma_f32_16x16x32_bf16 a[64:67], v[244:247], v[196:199], a[64:67]
s_mov_b32 s80, 0x400000
buffer_load_dword v126, v125, s[12:15], s80 offen
v_mfma_f32_16x16x32_bf16 a[68:71], v[244:247], v[204:207], a[68:71]
s_mov_b32 s80, 0x500000
buffer_load_dword v126, v125, s[12:15], s80 offen
v_mfma_f32_16x16x32_bf16 a[68:71], v[240:243], v[200:203], a[68:71]
s_mov_b32 s80, 0x600000
buffer_load_dword v126, v125, s[12:15], s80 offen
v_mfma_f32_16x16x32_bf16 a[72:75], v[240:243], v[208:211], a[72:75]
s_mov_b32 s80, 0x700000
buffer_load_dword v126, v125, s[12:15], s80 offen
v_mfma_f32_16x16x32_bf16 a[72:75], v[244:247], v[212:215], a[72:75]
ds_read_b64_tr_b16 v[224:225], v20 offset:49152
v_fmac_f32 v96, v72, v40
v_mfma_f32_16x16x32_bf16 a[76:79], v[244:247], v[220:223], a[76:79]
v_mul_f32 v96, v96, v97
v_cvt_pk_bf16_f32 v105, v95, v96
v_mfma_f32_16x16x32_bf16 a[76:79], v[240:243], v[216:219], a[76:79]
ds_read_b64_tr_b16 v[226:227], v20 offset:50176
v_mul_f32 v95, v75, v36
v_mfma_f32_16x16x32_bf16 a[80:83], v[240:243], v[184:187], a[80:83]
v_and_b32 v97, 0xffff0000, v55
v_fmac_f32 v95, v74, v37
v_mfma_f32_16x16x32_bf16 a[80:83], v[244:247], v[188:191], a[80:83]
ds_read_b64_tr_b16 v[228:229], v20 offset:57344
v_fmac_f32 v95, v73, v38
v_mfma_f32_16x16x32_bf16 a[84:87], v[244:247], v[180:183], a[84:87]
v_fmac_f32 v95, v72, v39
v_mul_f32 v95, v95, v97
v_mfma_f32_16x16x32_bf16 a[84:87], v[240:243], v[176:179], a[84:87]
ds_read_b64_tr_b16 v[230:231], v20 offset:58368
v_mul_f32 v96, v75, v35
v_mfma_f32_16x16x32_bf16 a[88:91], v[240:243], v[168:171], a[88:91]
v_and_b32 v97, 0xffff0000, v54
v_fmac_f32 v96, v74, v36
v_mfma_f32_16x16x32_bf16 a[88:91], v[244:247], v[172:175], a[88:91]
v_fmac_f32 v96, v73, v37
v_fmac_f32 v96, v72, v38
v_mfma_f32_16x16x32_bf16 a[92:95], v[244:247], v[164:167], a[92:95]
v_mul_f32 v96, v96, v97
v_cvt_pk_bf16_f32 v106, v95, v96
v_mfma_f32_16x16x32_bf16 a[92:95], v[240:243], v[160:163], a[92:95]
s_waitcnt lgkmcnt(4)
v_mul_f32 v95, v75, v34
v_and_b32 v97, 0xffff0000, v53
v_mfma_f32_16x16x32_bf16 a[124:127], v[248:251], v[160:163], a[124:127]
ds_read_b64_tr_b16 v[232:233], v21 offset:49152
v_fmac_f32 v95, v74, v35
v_mfma_f32_16x16x32_bf16 a[124:127], v[252:255], v[164:167], a[124:127]
v_fmac_f32 v95, v73, v36
v_fmac_f32 v95, v72, v37
v_mfma_f32_16x16x32_bf16 a[120:123], v[252:255], v[172:175], a[120:123]
v_mul_f32 v95, v95, v97
v_mul_f32 v96, v75, v33
v_mfma_f32_16x16x32_bf16 a[120:123], v[248:251], v[168:171], a[120:123]
ds_read_b64_tr_b16 v[234:235], v21 offset:50176
v_and_b32 v97, 0xffff0000, v52
v_mfma_f32_16x16x32_bf16 a[116:119], v[248:251], v[176:179], a[116:119]
v_fmac_f32 v96, v74, v34
v_fmac_f32 v96, v73, v35
v_mfma_f32_16x16x32_bf16 a[116:119], v[252:255], v[180:183], a[116:119]
v_fmac_f32 v96, v72, v36
v_mul_f32 v96, v96, v97
v_mfma_f32_16x16x32_bf16 a[112:115], v[252:255], v[188:191], a[112:115]
v_cvt_pk_bf16_f32 v107, v95, v96
v_mfma_f32_16x16x32_bf16 a[112:115], v[248:251], v[184:187], a[112:115]
ds_read_b64_tr_b16 v[236:237], v21 offset:57344
ds_write_b128 v28, v[104:107] offset:288
v_mfma_f32_16x16x32_bf16 a[108:111], v[248:251], v[216:219], a[108:111]
v_mfma_f32_16x16x32_bf16 a[108:111], v[252:255], v[220:223], a[108:111]
v_mfma_f32_16x16x32_bf16 a[104:107], v[252:255], v[212:215], a[104:107]
ds_read_b64_tr_b16 v[238:239], v21 offset:58368
v_mfma_f32_16x16x32_bf16 a[104:107], v[248:251], v[208:211], a[104:107]
v_mfma_f32_16x16x32_bf16 a[100:103], v[248:251], v[200:203], a[100:103]
v_mfma_f32_16x16x32_bf16 a[100:103], v[252:255], v[204:207], a[100:103]
v_mfma_f32_16x16x32_bf16 a[96:99], v[252:255], v[196:199], a[96:99]
v_mfma_f32_16x16x32_bf16 a[96:99], v[248:251], v[192:195], a[96:99]
s_waitcnt lgkmcnt(5)
v_mfma_f32_16x16x32_bf16 a[128:131], v[192:195], v[224:227], a[128:131]
ds_read_b64_tr_b16 v[240:241], v22 offset:49152
v_mfma_f32_16x16x32_bf16 a[128:131], v[196:199], v[228:231], a[128:131]
v_mfma_f32_16x16x32_bf16 a[132:135], v[204:207], v[228:231], a[132:135]
v_mfma_f32_16x16x32_bf16 a[132:135], v[200:203], v[224:227], a[132:135]
ds_read_b64_tr_b16 v[242:243], v22 offset:50176
v_mfma_f32_16x16x32_bf16 a[136:139], v[208:211], v[224:227], a[136:139]
v_mfma_f32_16x16x32_bf16 a[136:139], v[212:215], v[228:231], a[136:139]
v_mfma_f32_16x16x32_bf16 a[140:143], v[220:223], v[228:231], a[140:143]
v_mfma_f32_16x16x32_bf16 a[140:143], v[216:219], v[224:227], a[140:143]
ds_read_b64_tr_b16 v[244:245], v22 offset:57344
v_mfma_f32_16x16x32_bf16 a[144:147], v[184:187], v[224:227], a[144:147]
v_mfma_f32_16x16x32_bf16 a[144:147], v[188:191], v[228:231], a[144:147]
v_mfma_f32_16x16x32_bf16 a[148:151], v[180:183], v[228:231], a[148:151]
ds_read_b64_tr_b16 v[246:247], v22 offset:58368
v_mfma_f32_16x16x32_bf16 a[148:151], v[176:179], v[224:227], a[148:151]
v_mfma_f32_16x16x32_bf16 a[152:155], v[168:171], v[224:227], a[152:155]
v_mfma_f32_16x16x32_bf16 a[152:155], v[172:175], v[228:231], a[152:155]
v_mfma_f32_16x16x32_bf16 a[156:159], v[164:167], v[228:231], a[156:159]
v_mfma_f32_16x16x32_bf16 a[156:159], v[160:163], v[224:227], a[156:159]
s_waitcnt lgkmcnt(4)
v_mfma_f32_16x16x32_bf16 a[188:191], v[160:163], v[232:235], a[188:191]
ds_read_b64_tr_b16 v[248:249], v23 offset:49152
v_mfma_f32_16x16x32_bf16 a[188:191], v[164:167], v[236:239], a[188:191]
v_mfma_f32_16x16x32_bf16 a[184:187], v[172:175], v[236:239], a[184:187]
ds_read_b64_tr_b16 v[250:251], v23 offset:50176
v_mfma_f32_16x16x32_bf16 a[184:187], v[168:171], v[232:235], a[184:187]
v_mfma_f32_16x16x32_bf16 a[180:183], v[176:179], v[232:235], a[180:183]
ds_read_b64_tr_b16 v[252:253], v23 offset:57344
v_mfma_f32_16x16x32_bf16 a[180:183], v[180:183], v[236:239], a[180:183]
v_mfma_f32_16x16x32_bf16 a[176:179], v[188:191], v[236:239], a[176:179]
ds_read_b64_tr_b16 v[254:255], v23 offset:58368
v_mfma_f32_16x16x32_bf16 a[176:179], v[184:187], v[232:235], a[176:179]
v_mfma_f32_16x16x32_bf16 a[172:175], v[216:219], v[232:235], a[172:175]
v_mfma_f32_16x16x32_bf16 a[172:175], v[220:223], v[236:239], a[172:175]
v_mfma_f32_16x16x32_bf16 a[168:171], v[212:215], v[236:239], a[168:171]
v_mfma_f32_16x16x32_bf16 a[168:171], v[208:211], v[232:235], a[168:171]
v_mfma_f32_16x16x32_bf16 a[164:167], v[200:203], v[232:235], a[164:167]
v_mfma_f32_16x16x32_bf16 a[164:167], v[204:207], v[236:239], a[164:167]
v_mfma_f32_16x16x32_bf16 a[160:163], v[196:199], v[236:239], a[160:163]
s_waitcnt vmcnt(4) lgkmcnt(0)
v_mfma_f32_16x16x32_bf16 a[160:163], v[192:195], v[232:235], a[160:163]
s_barrier
v_mfma_f32_16x16x32_bf16 a[192:195], v[192:195], v[240:243], a[192:195]
s_and_b32 s73, s65, 1
ds_read_b64_tr_b16 v[224:225], v20 offset:0
v_mfma_f32_16x16x32_bf16 a[192:195], v[196:199], v[244:247], a[192:195]
s_xor_b32 s73, s73, 7
ds_read_b64_tr_b16 v[226:227], v20 offset:1024
v_mfma_f32_16x16x32_bf16 a[196:199], v[204:207], v[244:247], a[196:199]
s_lshl_b32 s69, s73, 7
ds_read_b64_tr_b16 v[228:229], v20 offset:8192
v_mfma_f32_16x16x32_bf16 a[196:199], v[200:203], v[240:243], a[196:199]
s_add_u32 s69, s69, s84
ds_read_b64_tr_b16 v[230:231], v20 offset:9216
v_mfma_f32_16x16x32_bf16 a[200:203], v[208:211], v[240:243], a[200:203]
s_lshl_b32 s71, s73, 19
ds_read_b128 v[128:131], v24 offset:0
v_mfma_f32_16x16x32_bf16 a[200:203], v[212:215], v[244:247], a[200:203]
s_add_u32 s71, s71, s66
ds_read_b128 v[132:135], v25 offset:0
v_mfma_f32_16x16x32_bf16 a[204:207], v[220:223], v[244:247], a[204:207]
s_add_u32 m0, s63, 98304
v_mfma_f32_16x16x32_bf16 a[204:207], v[216:219], v[240:243], a[204:207]
s_add_u32 s72, s69, 0
buffer_load_dwordx4 v2, s[8:11], s72 offen lds
v_mfma_f32_16x16x32_bf16 a[208:211], v[184:187], v[240:243], a[208:211]
s_add_u32 s72, s69, 7168
buffer_load_dwordx4 v3, s[8:11], s72 offen offset:1024 lds
v_mfma_f32_16x16x32_bf16 a[208:211], v[188:191], v[244:247], a[208:211]
s_add_u32 s72, s69, 14336
buffer_load_dwordx4 v2, s[8:11], s72 offen offset:2048 lds
v_mfma_f32_16x16x32_bf16 a[212:215], v[180:183], v[244:247], a[212:215]
s_mul_i32 s74, s58, 4352
ds_read_b128 v[136:139], v24 offset:2048
v_mfma_f32_16x16x32_bf16 a[212:215], v[176:179], v[240:243], a[212:215]
s_add_u32 s74, s74, 131072
ds_read_b128 v[140:143], v25 offset:2048
v_lshrrev_b32 v26, 4, v0
v_mfma_f32_16x16x32_bf16 a[216:219], v[168:171], v[240:243], a[216:219]
s_add_u32 s72, s69, 21504
buffer_load_dwordx4 v3, s[8:11], s72 offen offset:3072 lds
v_mfma_f32_16x16x32_bf16 a[216:219], v[172:175], v[244:247], a[216:219]
ds_read_b128 v[144:147], v24 offset:4096
v_and_b32 v27, 15, v0
v_mfma_f32_16x16x32_bf16 a[220:223], v[164:167], v[244:247], a[220:223]
ds_read_b128 v[148:151], v25 offset:4096
v_lshlrev_b32 v27, 4, v27
v_mfma_f32_16x16x32_bf16 a[220:223], v[160:163], v[240:243], a[220:223]
ds_read_b128 v[152:155], v24 offset:6144
v_mul_u32_u24 v28, 272, v26
v_mfma_f32_16x16x32_bf16 a[252:255], v[160:163], v[248:251], a[252:255]
ds_read_b128 v[156:159], v25 offset:6144
v_add3_u32 v28, v28, v27, s74
v_mfma_f32_16x16x32_bf16 a[252:255], v[164:167], v[252:255], a[252:255]
s_add_u32 m0, s64, 32768
v_lshl_add_u32 v26, v26, 12, v27
v_mfma_f32_16x16x32_bf16 a[248:251], v[172:175], v[252:255], a[248:251]
s_add_u32 s72, s71, 0
buffer_load_dwordx4 v6, s[16:19], s72 offen lds
v_mfma_f32_16x16x32_bf16 a[248:251], v[168:171], v[248:251], a[248:251]
ds_read_b128 v[160:163], v24 offset:8192
ds_read_b128 v[36:39], v28 offset:0
v_mfma_f32_16x16x32_bf16 a[244:247], v[176:179], v[248:251], a[244:247]
ds_read_b128 v[164:167], v25 offset:8192
ds_read_b128 v[40:43], v28 offset:1088
v_mfma_f32_16x16x32_bf16 a[244:247], v[180:183], v[252:255], a[244:247]
s_add_u32 s72, s71, 31744
buffer_load_dwordx4 v6, s[16:19], s72 offen offset:1024 lds
v_mfma_f32_16x16x32_bf16 a[240:243], v[188:191], v[252:255], a[240:243]
ds_read_b128 v[168:171], v24 offset:10240
ds_read_b128 v[44:47], v28 offset:2176
v_mfma_f32_16x16x32_bf16 a[240:243], v[184:187], v[248:251], a[240:243]
ds_read_b128 v[172:175], v25 offset:10240
ds_read_b128 v[48:51], v28 offset:3264
v_mfma_f32_16x16x32_bf16 a[236:239], v[216:219], v[248:251], a[236:239]
s_and_b32 s74, s2, 15
ds_read_b128 v[176:179], v24 offset:12288
v_mfma_f32_16x16x32_bf16 a[236:239], v[220:223], v[252:255], a[236:239]
s_add_u32 s72, s71, 63488
buffer_load_dwordx4 v7, s[16:19], s72 offen offset:2048 lds
v_mfma_f32_16x16x32_bf16 a[232:235], v[212:215], v[252:255], a[232:235]
s_lshl_b32 s74, s74, 2
ds_read_b128 v[180:183], v25 offset:12288
v_mfma_f32_16x16x32_bf16 a[232:235], v[208:211], v[248:251], a[232:235]
s_add_u32 s74, s74, s58
ds_read_b128 v[184:187], v24 offset:14336
v_mfma_f32_16x16x32_bf16 a[228:231], v[200:203], v[248:251], a[228:231]
s_lshl_b32 s74, s74, 16
ds_read_b128 v[188:191], v25 offset:14336
v_mfma_f32_16x16x32_bf16 a[228:231], v[204:207], v[252:255], a[228:231]
s_lshr_b32 s75, s2, 4
v_mfma_f32_16x16x32_bf16 a[224:227], v[196:199], v[252:255], a[224:227]
s_add_u32 s72, s71, 95232
buffer_load_dwordx4 v7, s[16:19], s72 offen offset:3072 lds
v_mfma_f32_16x16x32_bf16 a[224:227], v[192:195], v[248:251], a[224:227]
s_waitcnt lgkmcnt(12)
ds_read_b64_tr_b16 v[232:233], v21 offset:0
v_mfma_f32_16x16x32_bf16 a[0:3], v[224:227], v[128:131], a[0:3]
s_lshl_b32 s75, s75, 8
ds_read_b64_tr_b16 v[234:235], v21 offset:1024
v_mfma_f32_16x16x32_bf16 a[0:3], v[228:231], v[132:135], a[0:3]
s_sub_u32 s74, s74, s75
ds_read_b64_tr_b16 v[240:241], v22 offset:0
v_mfma_f32_16x16x32_bf16 a[4:7], v[228:231], v[140:143], a[4:7]
s_add_u32 m0, s63, 102400
ds_read_b64_tr_b16 v[236:237], v21 offset:8192
v_mfma_f32_16x16x32_bf16 a[4:7], v[224:227], v[136:139], a[4:7]
s_add_u32 s72, s69, 32768
buffer_load_dwordx4 v2, s[8:11], s72 offen lds
v_mfma_f32_16x16x32_bf16 a[8:11], v[224:227], v[144:147], a[8:11]
s_add_u32 s74, s74, 0x3000f00
ds_read_b64_tr_b16 v[238:239], v21 offset:9216
v_mfma_f32_16x16x32_bf16 a[8:11], v[228:231], v[148:151], a[8:11]
s_waitcnt vmcnt(29)
v_lshlrev_b32 v78, 16, v84
v_lshlrev_b32 v79, 16, v108
v_mfma_f32_16x16x32_bf16 a[12:15], v[228:231], v[156:159], a[12:15]
s_add_u32 s72, s69, 39936
buffer_load_dwordx4 v3, s[8:11], s72 offen offset:1024 lds
v_mfma_f32_16x16x32_bf16 a[12:15], v[224:227], v[152:155], a[12:15]
s_waitcnt lgkmcnt(5)
ds_read_b64_tr_b16 v[242:243], v22 offset:1024
v_mul_f32 v76, v78, v79
v_mfma_f32_16x16x32_bf16 a[16:19], v[224:227], v[160:163], a[16:19]
v_lshlrev_b32 v80, 16, v116
v_mul_f32 v77, v78, v80
v_mfma_f32_16x16x32_bf16 a[16:19], v[228:231], v[164:167], a[16:19]
ds_read_b64_tr_b16 v[244:245], v22 offset:8192
v_and_b32 v78, 0xffff0000, v84
v_mfma_f32_16x16x32_bf16 a[20:23], v[228:231], v[172:175], a[20:23]
v_and_b32 v79, 0xffff0000, v108
v_fmac_f32 v76, v78, v79
v_mfma_f32_16x16x32_bf16 a[20:23], v[224:227], v[168:171], a[20:23]
s_add_u32 s72, s69, 47104
buffer_load_dwordx4 v2, s[8:11], s72 offen offset:2048 lds
v_mfma_f32_16x16x32_bf16 a[24:27], v[224:227], v[176:179], a[24:27]
ds_read_b64_tr_b16 v[246:247], v22 offset:9216
v_and_b32 v80, 0xffff0000, v116
v_mfma_f32_16x16x32_bf16 a[24:27], v[228:231], v[180:183], a[24:27]
v_fmac_f32 v77, v78, v80
v_lshlrev_b32 v78, 16, v85
v_mfma_f32_16x16x32_bf16 a[28:31], v[228:231], v[188:191], a[28:31]
v_lshlrev_b32 v79, 16, v109
v_fmac_f32 v76, v78, v79
v_mfma_f32_16x16x32_bf16 a[28:31], v[224:227], v[184:187], a[28:31]
s_waitcnt lgkmcnt(3)
v_lshlrev_b32 v80, 16, v117
v_fmac_f32 v77, v78, v80
v_mfma_f32_16x16x32_bf16 a[60:63], v[232:235], v[184:187], a[60:63]
s_add_u32 s72, s69, 54272
buffer_load_dwordx4 v3, s[8:11], s72 offen offset:3072 lds
v_mfma_f32_16x16x32_bf16 a[60:63], v[236:239], v[188:191], a[60:63]
ds_read_b64_tr_b16 v[248:249], v23 offset:0
v_and_b32 v78, 0xffff0000, v85
v_mfma_f32_16x16x32_bf16 a[56:59], v[236:239], v[180:183], a[56:59]
v_and_b32 v79, 0xffff0000, v109
v_fmac_f32 v76, v78, v79
v_mfma_f32_16x16x32_bf16 a[56:59], v[232:235], v[176:179], a[56:59]
s_add_u32 m0, s64, 49152
ds_read_b64_tr_b16 v[250:251], v23 offset:1024
v_and_b32 v80, 0xffff0000, v117
v_mfma_f32_16x16x32_bf16 a[52:55], v[232:235], v[168:171], a[52:55]
s_add_u32 s72, s71, 0
buffer_load_dwordx4 v6, s[20:23], s72 offen lds
v_mfma_f32_16x16x32_bf16 a[52:55], v[236:239], v[172:175], a[52:55]
v_fmac_f32 v77, v78, v80
v_lshlrev_b32 v78, 16, v86
v_mfma_f32_16x16x32_bf16 a[48:51], v[236:239], v[164:167], a[48:51]
v_lshlrev_b32 v79, 16, v110
v_fmac_f32 v76, v78, v79
v_mfma_f32_16x16x32_bf16 a[48:51], v[232:235], v[160:163], a[48:51]
ds_read_b64_tr_b16 v[252:253], v23 offset:8192
v_lshlrev_b32 v80, 16, v118
v_mfma_f32_16x16x32_bf16 a[44:47], v[232:235], v[152:155], a[44:47]
s_add_u32 s72, s71, 31744
buffer_load_dwordx4 v6, s[20:23], s72 offen offset:1024 lds
v_mfma_f32_16x16x32_bf16 a[44:47], v[236:239], v[156:159], a[44:47]
v_fmac_f32 v77, v78, v80
v_and_b32 v78, 0xffff0000, v86
v_mfma_f32_16x16x32_bf16 a[40:43], v[236:239], v[148:151], a[40:43]
ds_read_b64_tr_b16 v[254:255], v23 offset:9216
v_and_b32 v79, 0xffff0000, v110
v_mfma_f32_16x16x32_bf16 a[40:43], v[232:235], v[144:147], a[40:43]
v_fmac_f32 v76, v78, v79
v_and_b32 v80, 0xffff0000, v118
v_mfma_f32_16x16x32_bf16 a[36:39], v[232:235], v[136:139], a[36:39]
s_add_u32 s72, s71, 63488
buffer_load_dwordx4 v7, s[20:23], s72 offen offset:2048 lds
v_mfma_f32_16x16x32_bf16 a[36:39], v[236:239], v[140:143], a[36:39]
v_fmac_f32 v77, v78, v80
v_lshlrev_b32 v78, 16, v87
v_mfma_f32_16x16x32_bf16 a[32:35], v[236:239], v[132:135], a[32:35]
v_lshlrev_b32 v79, 16, v111
v_fmac_f32 v76, v78, v79
v_mfma_f32_16x16x32_bf16 a[32:35], v[232:235], v[128:131], a[32:35]
s_waitcnt lgkmcnt(4)
v_lshlrev_b32 v80, 16, v119
v_fmac_f32 v77, v78, v80
v_mfma_f32_16x16x32_bf16 a[64:67], v[240:243], v[128:131], a[64:67]
s_add_u32 s72, s71, 95232
buffer_load_dwordx4 v7, s[20:23], s72 offen offset:3072 lds
v_mfma_f32_16x16x32_bf16 a[64:67], v[244:247], v[132:135], a[64:67]
ds_read_b64_tr_b16 v[224:225], v20 offset:16384
v_and_b32 v78, 0xffff0000, v87
v_mfma_f32_16x16x32_bf16 a[68:71], v[244:247], v[140:143], a[68:71]
v_and_b32 v79, 0xffff0000, v111
v_fmac_f32 v76, v78, v79
v_mfma_f32_16x16x32_bf16 a[68:71], v[240:243], v[136:139], a[68:71]
v_and_b32 v80, 0xffff0000, v119
v_fmac_f32 v77, v78, v80
v_mfma_f32_16x16x32_bf16 a[72:75], v[240:243], v[144:147], a[72:75]
ds_read_b64_tr_b16 v[226:227], v20 offset:17408
v_lshlrev_b32 v78, 16, v88
v_mfma_f32_16x16x32_bf16 a[72:75], v[244:247], v[148:151], a[72:75]
v_lshlrev_b32 v79, 16, v112
v_fmac_f32 v76, v78, v79
v_mfma_f32_16x16x32_bf16 a[76:79], v[244:247], v[156:159], a[76:79]
v_lshlrev_b32 v80, 16, v120
v_fmac_f32 v77, v78, v80
v_mfma_f32_16x16x32_bf16 a[76:79], v[240:243], v[152:155], a[76:79]
ds_read_b64_tr_b16 v[228:229], v20 offset:24576
v_and_b32 v78, 0xffff0000, v88
v_mfma_f32_16x16x32_bf16 a[80:83], v[240:243], v[160:163], a[80:83]
s_waitcnt lgkmcnt(15)
buffer_store_dwordx4 v[36:39], v26, s[44:47], s74 offen sc1
v_mfma_f32_16x16x32_bf16 a[80:83], v[244:247], v[164:167], a[80:83]
v_and_b32 v79, 0xffff0000, v112
v_fmac_f32 v76, v78, v79
v_mfma_f32_16x16x32_bf16 a[84:87], v[244:247], v[172:175], a[84:87]
v_and_b32 v80, 0xffff0000, v120
v_fmac_f32 v77, v78, v80
v_mfma_f32_16x16x32_bf16 a[84:87], v[240:243], v[168:171], a[84:87]
ds_read_b64_tr_b16 v[230:231], v20 offset:25600
v_lshlrev_b32 v78, 16, v89
v_mfma_f32_16x16x32_bf16 a[88:91], v[240:243], v[176:179], a[88:91]
v_lshlrev_b32 v79, 16, v113
v_fmac_f32 v76, v78, v79
v_mfma_f32_16x16x32_bf16 a[88:91], v[244:247], v[180:183], a[88:91]
v_lshlrev_b32 v80, 16, v121
v_fmac_f32 v77, v78, v80
v_mfma_f32_16x16x32_bf16 a[92:95], v[244:247], v[188:191], a[92:95]
v_and_b32 v78, 0xffff0000, v89
v_and_b32 v79, 0xffff0000, v113
v_mfma_f32_16x16x32_bf16 a[92:95], v[240:243], v[184:187], a[92:95]
s_waitcnt lgkmcnt(4)
v_fmac_f32 v76, v78, v79
v_and_b32 v80, 0xffff0000, v121
v_mfma_f32_16x16x32_bf16 a[124:127], v[248:251], v[184:187], a[124:127]
ds_read_b64_tr_b16 v[232:233], v21 offset:16384
v_fmac_f32 v77, v78, v80
v_mfma_f32_16x16x32_bf16 a[124:127], v[252:255], v[188:191], a[124:127]
v_lshlrev_b32 v78, 16, v90
v_lshlrev_b32 v79, 16, v114
v_mfma_f32_16x16x32_bf16 a[120:123], v[252:255], v[180:183], a[120:123]
ds_read_b64_tr_b16 v[234:235], v21 offset:17408
v_fmac_f32 v76, v78, v79
v_mfma_f32_16x16x32_bf16 a[120:123], v[248:251], v[176:179], a[120:123]
v_lshlrev_b32 v80, 16, v122
v_fmac_f32 v77, v78, v80
v_mfma_f32_16x16x32_bf16 a[116:119], v[248:251], v[168:171], a[116:119]
s_lshr_b32 s75, s93, 5
v_and_b32 v78, 0xffff0000, v90
v_and_b32 v79, 0xffff0000, v114
v_mfma_f32_16x16x32_bf16 a[116:119], v[252:255], v[172:175], a[116:119]
s_add_u32 s74, s74, 0x4000
buffer_store_dwordx4 v[40:43], v26, s[44:47], s74 offen sc1
v_mfma_f32_16x16x32_bf16 a[112:115], v[252:255], v[164:167], a[112:115]
s_and_b32 s75, s75, 0x3f80
ds_read_b64_tr_b16 v[236:237], v21 offset:24576
v_fmac_f32 v76, v78, v79
v_mfma_f32_16x16x32_bf16 a[112:115], v[248:251], v[160:163], a[112:115]
s_add_u32 s75, s75, LcB0-Lpc0
v_lshrrev_b32 v2, 6, v0
v_lshlrev_b32 v2, 7, v2
v_mfma_f32_16x16x32_bf16 a[108:111], v[248:251], v[152:155], a[108:111]
v_add_u32 v2, s75, v2
v_min_u32 v2, Lcode_end-Lpc0, v2
v_mfma_f32_16x16x32_bf16 a[108:111], v[252:255], v[156:159], a[108:111]
global_load_dword v3, v2, s[98:99]
v_mfma_f32_16x16x32_bf16 a[104:107], v[252:255], v[148:151], a[104:107]
v_and_b32 v80, 0xffff0000, v122
v_fmac_f32 v77, v78, v80
v_mfma_f32_16x16x32_bf16 a[104:107], v[248:251], v[144:147], a[104:107]
ds_read_b64_tr_b16 v[238:239], v21 offset:25600
v_lshlrev_b32 v78, 16, v91
v_mfma_f32_16x16x32_bf16 a[100:103], v[248:251], v[136:139], a[100:103]
v_lshlrev_b32 v79, 16, v115
v_fmac_f32 v76, v78, v79
v_mfma_f32_16x16x32_bf16 a[100:103], v[252:255], v[140:143], a[100:103]
v_lshlrev_b32 v80, 16, v123
v_fmac_f32 v77, v78, v80
v_mfma_f32_16x16x32_bf16 a[96:99], v[252:255], v[132:135], a[96:99]
v_and_b32 v78, 0xffff0000, v91
v_and_b32 v79, 0xffff0000, v115
v_mfma_f32_16x16x32_bf16 a[96:99], v[248:251], v[128:131], a[96:99]
s_waitcnt lgkmcnt(4)
v_fmac_f32 v76, v78, v79
v_and_b32 v80, 0xffff0000, v123
v_mfma_f32_16x16x32_bf16 a[128:131], v[128:131], v[224:227], a[128:131]
ds_read_b64_tr_b16 v[240:241], v22 offset:16384
v_fmac_f32 v77, v78, v80
v_mfma_f32_16x16x32_bf16 a[128:131], v[132:135], v[228:231], a[128:131]
v_add_f32_dpp v76, v76, v76 row_ror:8 row_mask:0xf bank_mask:0xf
v_add_f32_dpp v77, v77, v77 row_ror:8 row_mask:0xf bank_mask:0xf
v_mfma_f32_16x16x32_bf16 a[132:135], v[140:143], v[228:231], a[132:135]
s_add_u32 s74, s74, 0x4000
buffer_store_dwordx4 v[44:47], v26, s[44:47], s74 offen sc1
v_mfma_f32_16x16x32_bf16 a[132:135], v[136:139], v[224:227], a[132:135]
v_add_f32_dpp v76, v76, v76 row_ror:4 row_mask:0xf bank_mask:0xf
v_add_f32_dpp v77, v77, v77 row_ror:4 row_mask:0xf bank_mask:0xf
v_mfma_f32_16x16x32_bf16 a[136:139], v[144:147], v[224:227], a[136:139]
ds_read_b64_tr_b16 v[242:243], v22 offset:17408
v_add_f32_dpp v76, v76, v76 row_ror:2 row_mask:0xf bank_mask:0xf
v_mfma_f32_16x16x32_bf16 a[136:139], v[148:151], v[228:231], a[136:139]
v_add_f32_dpp v77, v77, v77 row_ror:2 row_mask:0xf bank_mask:0xf
v_add_f32_dpp v76, v76, v76 row_ror:1 row_mask:0xf bank_mask:0xf
v_mfma_f32_16x16x32_bf16 a[140:143], v[156:159], v[228:231], a[140:143]
v_add_f32_dpp v77, v77, v77 row_ror:1 row_mask:0xf bank_mask:0xf
v_mov_b32 v78, v76
v_mfma_f32_16x16x32_bf16 a[140:143], v[152:155], v[224:227], a[140:143]
ds_read_b64_tr_b16 v[244:245], v22 offset:24576
v_mov_b32 v79, v77
v_mfma_f32_16x16x32_bf16 a[144:147], v[160:163], v[224:227], a[144:147]
v_permlane16_swap_b32 v76, v78
v_permlane16_swap_b32 v77, v79
v_mfma_f32_16x16x32_bf16 a[144:147], v[164:167], v[228:231], a[144:147]
v_add_f32 v76, v76, v78
v_add_f32 v77, v77, v79
v_mfma_f32_16x16x32_bf16 a[148:151], v[172:175], v[228:231], a[148:151]
ds_read_b64_tr_b16 v[246:247], v22 offset:25600
v_mov_b32 v78, v76
v_mfma_f32_16x16x32_bf16 a[148:151], v[168:171], v[224:227], a[148:151]
v_mov_b32 v79, v77
v_permlane32_swap_b32 v76, v78
v_mfma_f32_16x16x32_bf16 a[152:155], v[176:179], v[224:227], a[152:155]
v_permlane32_swap_b32 v77, v79
v_add_f32 v76, v76, v78
v_mfma_f32_16x16x32_bf16 a[152:155], v[180:183], v[228:231], a[152:155]
v_add_f32 v77, v77, v79
v_mul_f32 v76, 0xbfb8aa3b, v76
v_mfma_f32_16x16x32_bf16 a[156:159], v[188:191], v[228:231], a[156:159]
v_mul_f32 v77, 0xbfb8aa3b, v77
v_mfma_f32_16x16x32_bf16 a[156:159], v[184:187], v[224:227], a[156:159]
s_waitcnt lgkmcnt(4)
v_exp_f32 v76, v76
v_mfma_f32_16x16x32_bf16 a[188:191], v[184:187], v[232:235], a[188:191]
s_add_u32 s74, s74, 0x4000
buffer_store_dwordx4 v[48:51], v26, s[44:47], s74 offen sc1
v_mfma_f32_16x16x32_bf16 a[188:191], v[188:191], v[236:239], a[188:191]
ds_read_b64_tr_b16 v[248:249], v23 offset:16384
v_mfma_f32_16x16x32_bf16 a[184:187], v[180:183], v[236:239], a[184:187]
ds_read_b64_tr_b16 v[250:251], v23 offset:17408
v_mfma_f32_16x16x32_bf16 a[184:187], v[176:179], v[232:235], a[184:187]
v_exp_f32 v77, v77
v_mfma_f32_16x16x32_bf16 a[180:183], v[168:171], v[232:235], a[180:183]
ds_read_b64_tr_b16 v[252:253], v23 offset:24576
v_add_f32 v76, 1.0, v76
v_mfma_f32_16x16x32_bf16 a[180:183], v[172:175], v[236:239], a[180:183]
v_add_f32 v77, 1.0, v77
v_mfma_f32_16x16x32_bf16 a[176:179], v[164:167], v[236:239], a[176:179]
ds_read_b64_tr_b16 v[254:255], v23 offset:25600
v_mfma_f32_16x16x32_bf16 a[176:179], v[160:163], v[232:235], a[176:179]
v_rcp_f32 v76, v76
v_mfma_f32_16x16x32_bf16 a[172:175], v[152:155], v[232:235], a[172:175]
v_rcp_f32 v77, v77
v_mfma_f32_16x16x32_bf16 a[172:175], v[156:159], v[236:239], a[172:175]
s_lshr_b32 s80, s76, 9
v_mfma_f32_16x16x32_bf16 a[168:171], v[148:151], v[236:239], a[168:171]
s_add_u32 s80, s80, 0x3800000
v_min_u32 v78, 1, v0
v_lshlrev_b32 v78, 30, v78
v_mfma_f32_16x16x32_bf16 a[168:171], v[144:147], v[232:235], a[168:171]
buffer_store_dwordx2 v[76:77], v78, s[44:47], s80 offen sc1
v_mfma_f32_16x16x32_bf16 a[164:167], v[136:139], v[232:235], a[164:167]
v_mfma_f32_16x16x32_bf16 a[164:167], v[140:143], v[236:239], a[164:167]
v_mfma_f32_16x16x32_bf16 a[160:163], v[132:135], v[236:239], a[160:163]
s_waitcnt vmcnt(6) lgkmcnt(0)
v_mfma_f32_16x16x32_bf16 a[160:163], v[128:131], v[232:235], a[160:163]
s_barrier
v_mfma_f32_16x16x32_bf16 a[192:195], v[128:131], v[240:243], a[192:195]
s_add_u32 s73, s62, 0
ds_read_b64_tr_b16 v[224:225], v20 offset:32768
v_mfma_f32_16x16x32_bf16 a[192:195], v[132:135], v[244:247], a[192:195]
s_add_u32 s70, s73, s65
ds_read_b64_tr_b16 v[226:227], v20 offset:33792
v_mfma_f32_16x16x32_bf16 a[196:199], v[140:143], v[244:247], a[196:199]
s_and_b32 s70, s70, 3
v_mov_b32 v100, v20
v_mov_b32 v101, v21
v_mfma_f32_16x16x32_bf16 a[196:199], v[136:139], v[240:243], a[196:199]
s_and_b32 s73, s73, 12
v_mov_b32 v102, v22
v_mov_b32 v103, v23
v_mfma_f32_16x16x32_bf16 a[200:203], v[144:147], v[240:243], a[200:203]
s_or_b32 s73, s73, s70
ds_read_b64_tr_b16 v[228:229], v20 offset:40960
v_mfma_f32_16x16x32_bf16 a[200:203], v[148:151], v[244:247], a[200:203]
s_lshl_b32 s73, s73, 7
ds_read_b64_tr_b16 v[230:231], v20 offset:41984
v_mfma_f32_16x16x32_bf16 a[204:207], v[156:159], v[244:247], a[204:207]
s_add_u32 s69, s73, s67
ds_read_b128 v[192:195], v24 offset:32768
v_mfma_f32_16x16x32_bf16 a[204:207], v[152:155], v[240:243], a[204:207]
s_add_u32 s70, s73, s68
ds_read_b128 v[196:199], v25 offset:32768
v_mfma_f32_16x16x32_bf16 a[208:211], v[160:163], v[240:243], a[208:211]
s_add_u32 m0, s63, 131072
ds_read_b128 v[200:203], v24 offset:34816
v_mfma_f32_16x16x32_bf16 a[208:211], v[164:167], v[244:247], a[208:211]
s_add_u32 s72, s69, 0
buffer_load_dwordx4 v4, s[4:7], s72 offen lds
v_mfma_f32_16x16x32_bf16 a[212:215], v[172:175], v[244:247], a[212:215]
s_add_u32 s72, s69, 15360
buffer_load_dwordx4 v5, s[4:7], s72 offen offset:1024 lds
v_mfma_f32_16x16x32_bf16 a[212:215], v[168:171], v[240:243], a[212:215]
s_add_u32 s72, s69, 129024
buffer_load_dwordx4 v4, s[4:7], s72 offen offset:2048 lds
v_mfma_f32_16x16x32_bf16 a[216:219], v[176:179], v[240:243], a[216:219]
ds_read_b128 v[204:207], v25 offset:34816
v_mfma_f32_16x16x32_bf16 a[216:219], v[180:183], v[244:247], a[216:219]
ds_read_b128 v[208:211], v24 offset:36864
v_mfma_f32_16x16x32_bf16 a[220:223], v[188:191], v[244:247], a[220:223]
s_add_u32 s72, s69, 144384
buffer_load_dwordx4 v5, s[4:7], s72 offen offset:3072 lds
v_mfma_f32_16x16x32_bf16 a[220:223], v[184:187], v[240:243], a[220:223]
ds_read_b128 v[212:215], v25 offset:36864
v_mfma_f32_16x16x32_bf16 a[252:255], v[184:187], v[248:251], a[252:255]
ds_read_b128 v[216:219], v24 offset:38912
v_mfma_f32_16x16x32_bf16 a[252:255], v[188:191], v[252:255], a[252:255]
ds_read_b128 v[220:223], v25 offset:38912
v_mfma_f32_16x16x32_bf16 a[248:251], v[180:183], v[252:255], a[248:251]
s_add_u32 m0, s63, 135168
ds_read_b128 v[184:187], v24 offset:40960
v_mfma_f32_16x16x32_bf16 a[248:251], v[176:179], v[248:251], a[248:251]
s_add_u32 s72, s70, 0
buffer_load_dwordx4 v4, s[4:7], s72 offen lds
v_mfma_f32_16x16x32_bf16 a[244:247], v[168:171], v[248:251], a[244:247]
ds_read_b128 v[188:191], v25 offset:40960
v_mfma_f32_16x16x32_bf16 a[244:247], v[172:175], v[252:255], a[244:247]
ds_read_b128 v[176:179], v24 offset:43008
v_mfma_f32_16x16x32_bf16 a[240:243], v[164:167], v[252:255], a[240:243]
ds_read_b128 v[180:183], v25 offset:43008
v_mfma_f32_16x16x32_bf16 a[240:243], v[160:163], v[248:251], a[240:243]
s_add_u32 s72, s70, 15360
buffer_load_dwordx4 v5, s[4:7], s72 offen offset:1024 lds
v_mfma_f32_16x16x32_bf16 a[236:239], v[152:155], v[248:251], a[236:239]
ds_read_b128 v[168:171], v24 offset:45056
v_mfma_f32_16x16x32_bf16 a[236:239], v[156:159], v[252:255], a[236:239]
ds_read_b128 v[172:175], v25 offset:45056
v_mfma_f32_16x16x32_bf16 a[232:235], v[148:151], v[252:255], a[232:235]
v_mfma_f32_16x16x32_bf16 a[232:235], v[144:147], v[248:251], a[232:235]
ds_read_b128 v[160:163], v24 offset:47104
v_mfma_f32_16x16x32_bf16 a[228:231], v[136:139], v[248:251], a[228:231]
s_add_u32 s72, s70, 129024
buffer_load_dwordx4 v4, s[4:7], s72 offen offset:2048 lds
v_mfma_f32_16x16x32_bf16 a[228:231], v[140:143], v[252:255], a[228:231]
ds_read_b128 v[164:167], v25 offset:47104
v_mfma_f32_16x16x32_bf16 a[224:227], v[132:135], v[252:255], a[224:227]
ds_read_b64_tr_b16 v[232:233], v101 offset:32768
v_mfma_f32_16x16x32_bf16 a[224:227], v[128:131], v[248:251], a[224:227]
s_waitcnt lgkmcnt(9)
ds_read_b64_tr_b16 v[234:235], v101 offset:33792
v_mfma_f32_16x16x32_bf16 a[0:3], v[224:227], v[192:195], a[0:3]
s_add_u32 s72, s70, 144384
buffer_load_dwordx4 v5, s[4:7], s72 offen offset:3072 lds
v_mfma_f32_16x16x32_bf16 a[0:3], v[228:231], v[196:199], a[0:3]
ds_read_b64_tr_b16 v[240:241], v102 offset:32768
v_mfma_f32_16x16x32_bf16 a[4:7], v[228:231], v[204:207], a[4:7]
ds_read_b64_tr_b16 v[236:237], v101 offset:40960
v_mfma_f32_16x16x32_bf16 a[4:7], v[224:227], v[200:203], a[4:7]
v_mfma_f32_16x16x32_bf16 a[8:11], v[224:227], v[208:211], a[8:11]
ds_read_b64_tr_b16 v[238:239], v101 offset:41984
v_mfma_f32_16x16x32_bf16 a[8:11], v[228:231], v[212:215], a[8:11]
s_lshl_b32 s71, s73, 12
ds_read_b64_tr_b16 v[242:243], v102 offset:33792
v_mfma_f32_16x16x32_bf16 a[12:15], v[228:231], v[220:223], a[12:15]
s_add_u32 s71, s71, s66
v_mfma_f32_16x16x32_bf16 a[12:15], v[224:227], v[216:219], a[12:15]
s_waitcnt lgkmcnt(6)
ds_read_b64_tr_b16 v[244:245], v102 offset:40960
v_mfma_f32_16x16x32_bf16 a[16:19], v[224:227], v[184:187], a[16:19]
s_add_u32 m0, s64, 0
v_mfma_f32_16x16x32_bf16 a[16:19], v[228:231], v[188:191], a[16:19]
s_add_u32 s72, s71, 0
buffer_load_dwordx4 v6, s[12:15], s72 offen lds
v_mfma_f32_16x16x32_bf16 a[20:23], v[228:231], v[180:183], a[20:23]
s_add_u32 s72, s71, 31744
buffer_load_dwordx4 v6, s[12:15], s72 offen offset:1024 lds
v_mfma_f32_16x16x32_bf16 a[20:23], v[224:227], v[176:179], a[20:23]
ds_read_b64_tr_b16 v[246:247], v102 offset:41984
v_mfma_f32_16x16x32_bf16 a[24:27], v[224:227], v[168:171], a[24:27]
v_mfma_f32_16x16x32_bf16 a[24:27], v[228:231], v[172:175], a[24:27]
v_mfma_f32_16x16x32_bf16 a[28:31], v[228:231], v[164:167], a[28:31]
v_mfma_f32_16x16x32_bf16 a[28:31], v[224:227], v[160:163], a[28:31]
s_waitcnt lgkmcnt(3)
v_mfma_f32_16x16x32_bf16 a[60:63], v[232:235], v[160:163], a[60:63]
s_add_u32 s72, s71, 63488
buffer_load_dwordx4 v7, s[12:15], s72 offen offset:2048 lds
v_mfma_f32_16x16x32_bf16 a[60:63], v[236:239], v[164:167], a[60:63]
ds_read_b64_tr_b16 v[248:249], v103 offset:32768
v_mfma_f32_16x16x32_bf16 a[56:59], v[236:239], v[172:175], a[56:59]
v_mfma_f32_16x16x32_bf16 a[56:59], v[232:235], v[168:171], a[56:59]
s_add_u32 s72, s71, 95232
buffer_load_dwordx4 v7, s[12:15], s72 offen offset:3072 lds
v_mfma_f32_16x16x32_bf16 a[52:55], v[232:235], v[176:179], a[52:55]
v_mfma_f32_16x16x32_bf16 a[52:55], v[236:239], v[180:183], a[52:55]
ds_read_b64_tr_b16 v[250:251], v103 offset:33792
v_mfma_f32_16x16x32_bf16 a[48:51], v[236:239], v[188:191], a[48:51]
v_mfma_f32_16x16x32_bf16 a[48:51], v[232:235], v[184:187], a[48:51]
v_mfma_f32_16x16x32_bf16 a[44:47], v[232:235], v[216:219], a[44:47]
s_add_u32 s73, s62, 1
ds_read_b64_tr_b16 v[252:253], v103 offset:40960
v_mfma_f32_16x16x32_bf16 a[44:47], v[236:239], v[220:223], a[44:47]
s_add_u32 s70, s73, s65
v_mfma_f32_16x16x32_bf16 a[40:43], v[236:239], v[212:215], a[40:43]
s_and_b32 s70, s70, 3
v_mfma_f32_16x16x32_bf16 a[40:43], v[232:235], v[208:211], a[40:43]
s_and_b32 s73, s73, 12
ds_read_b64_tr_b16 v[254:255], v103 offset:41984
v_mfma_f32_16x16x32_bf16 a[36:39], v[232:235], v[200:203], a[36:39]
s_or_b32 s73, s73, s70
v_mfma_f32_16x16x32_bf16 a[36:39], v[236:239], v[204:207], a[36:39]
s_lshl_b32 s73, s73, 7
v_mfma_f32_16x16x32_bf16 a[32:35], v[236:239], v[196:199], a[32:35]
s_add_u32 s69, s73, s67
v_mfma_f32_16x16x32_bf16 a[32:35], v[232:235], v[192:195], a[32:35]
s_waitcnt lgkmcnt(4)
v_mfma_f32_16x16x32_bf16 a[64:67], v[240:243], v[192:195], a[64:67]
s_add_u32 s70, s73, s68
ds_read_b64_tr_b16 v[224:225], v100 offset:49152
v_mfma_f32_16x16x32_bf16 a[64:67], v[244:247], v[196:199], a[64:67]
s_add_u32 m0, s63, 65536
v_mfma_f32_16x16x32_bf16 a[68:71], v[244:247], v[204:207], a[68:71]
s_add_u32 s72, s69, 0
buffer_load_dwordx4 v4, s[4:7], s72 offen lds
v_mfma_f32_16x16x32_bf16 a[68:71], v[240:243], v[200:203], a[68:71]
s_add_u32 s72, s69, 15360
buffer_load_dwordx4 v5, s[4:7], s72 offen offset:1024 lds
v_mfma_f32_16x16x32_bf16 a[72:75], v[240:243], v[208:211], a[72:75]
s_add_u32 s72, s69, 129024
buffer_load_dwordx4 v4, s[4:7], s72 offen offset:2048 lds
v_mfma_f32_16x16x32_bf16 a[72:75], v[244:247], v[212:215], a[72:75]
ds_read_b64_tr_b16 v[226:227], v100 offset:50176
v_mfma_f32_16x16x32_bf16 a[76:79], v[244:247], v[220:223], a[76:79]
s_add_u32 s72, s69, 144384
buffer_load_dwordx4 v5, s[4:7], s72 offen offset:3072 lds
v_mfma_f32_16x16x32_bf16 a[76:79], v[240:243], v[216:219], a[76:79]
v_mfma_f32_16x16x32_bf16 a[80:83], v[240:243], v[184:187], a[80:83]
ds_read_b64_tr_b16 v[228:229], v100 offset:57344
v_mfma_f32_16x16x32_bf16 a[80:83], v[244:247], v[188:191], a[80:83]
v_mfma_f32_16x16x32_bf16 a[84:87], v[244:247], v[180:183], a[84:87]
ds_read_b64_tr_b16 v[230:231], v100 offset:58368
v_accvgpr_read_b32 v20, a0
v_mfma_f32_16x16x32_bf16 a[84:87], v[240:243], v[176:179], a[84:87]
s_add_u32 m0, s63, 69632
v_accvgpr_read_b32 v28, a1
v_accvgpr_read_b32 v21, a2
v_mfma_f32_16x16x32_bf16 a[88:91], v[240:243], v[168:171], a[88:91]
s_add_u32 s72, s70, 0
buffer_load_dwordx4 v4, s[4:7], s72 offen lds
v_mfma_f32_16x16x32_bf16 a[88:91], v[244:247], v[172:175], a[88:91]
v_accvgpr_read_b32 v29, a3
v_accvgpr_read_b32 v22, a32
v_mfma_f32_16x16x32_bf16 a[92:95], v[244:247], v[164:167], a[92:95]
v_accvgpr_read_b32 v30, a33
v_accvgpr_read_b32 v23, a34
v_mfma_f32_16x16x32_bf16 a[92:95], v[240:243], v[160:163], a[92:95]
s_waitcnt lgkmcnt(4)
v_accvgpr_read_b32 v31, a35
v_mul_f32 v20, s79, v20
v_mfma_f32_16x16x32_bf16 a[124:127], v[248:251], v[160:163], a[124:127]
s_add_u32 s72, s70, 15360
buffer_load_dwordx4 v5, s[4:7], s72 offen offset:1024 lds
v_mfma_f32_16x16x32_bf16 a[124:127], v[252:255], v[164:167], a[124:127]
ds_read_b64_tr_b16 v[232:233], v101 offset:49152
v_mul_f32 v28, s79, v28
v_mfma_f32_16x16x32_bf16 a[120:123], v[252:255], v[172:175], a[120:123]
v_mul_f32 v21, s79, v21
v_mul_f32 v29, s79, v29
v_mfma_f32_16x16x32_bf16 a[120:123], v[248:251], v[168:171], a[120:123]
ds_read_b64_tr_b16 v[234:235], v101 offset:50176
v_mul_f32 v22, s79, v22
v_mfma_f32_16x16x32_bf16 a[116:119], v[248:251], v[176:179], a[116:119]
s_add_u32 s72, s70, 129024
buffer_load_dwordx4 v4, s[4:7], s72 offen offset:2048 lds
v_mfma_f32_16x16x32_bf16 a[116:119], v[252:255], v[180:183], a[116:119]
v_mul_f32 v30, s79, v30
v_mul_f32 v23, s79, v23
v_mfma_f32_16x16x32_bf16 a[112:115], v[252:255], v[188:191], a[112:115]
v_mul_f32 v31, s79, v31
v_cvt_pk_bf16_f32 v20, v20, v28
v_mfma_f32_16x16x32_bf16 a[112:115], v[248:251], v[184:187], a[112:115]
ds_read_b64_tr_b16 v[236:237], v101 offset:57344
v_cvt_pk_bf16_f32 v21, v21, v29
v_mfma_f32_16x16x32_bf16 a[108:111], v[248:251], v[216:219], a[108:111]
v_cvt_pk_bf16_f32 v22, v22, v30
v_cvt_pk_bf16_f32 v23, v23, v31
v_mfma_f32_16x16x32_bf16 a[108:111], v[252:255], v[220:223], a[108:111]
s_add_u32 s72, s70, 144384
buffer_load_dwordx4 v5, s[4:7], s72 offen offset:3072 lds
v_mfma_f32_16x16x32_bf16 a[104:107], v[252:255], v[212:215], a[104:107]
s_add_u32 s80, s77, 0
buffer_store_dwordx4 v[20:23], v1, s[44:47], s80 offen sc1
v_mfma_f32_16x16x32_bf16 a[104:107], v[248:251], v[208:211], a[104:107]
ds_read_b64_tr_b16 v[238:239], v101 offset:58368
v_mfma_f32_16x16x32_bf16 a[100:103], v[248:251], v[200:203], a[100:103]
v_mfma_f32_16x16x32_bf16 a[100:103], v[252:255], v[204:207], a[100:103]
v_mfma_f32_16x16x32_bf16 a[96:99], v[252:255], v[196:199], a[96:99]
s_lshl_b32 s71, s73, 12
v_mfma_f32_16x16x32_bf16 a[96:99], v[248:251], v[192:195], a[96:99]
s_waitcnt lgkmcnt(4)
LcB0:
v_mfma_f32_16x16x32_bf16 a[128:131], v[192:195], v[224:227], a[128:131]
s_add_u32 s71, s71, s66
ds_read_b64_tr_b16 v[240:241], v102 offset:49152
v_accvgpr_read_b32 v24, a4
v_mfma_f32_16x16x32_bf16 a[128:131], v[196:199], v[228:231], a[128:131]
s_add_u32 m0, s64, 16384
v_accvgpr_read_b32 v28, a5
v_accvgpr_read_b32 v25, a6
v_mfma_f32_16x16x32_bf16 a[132:135], v[204:207], v[228:231], a[132:135]
s_add_u32 s72, s71, 0
buffer_load_dwordx4 v6, s[12:15], s72 offen lds
v_mfma_f32_16x16x32_bf16 a[132:135], v[200:203], v[224:227], a[132:135]
s_add_u32 s72, s71, 31744
buffer_load_dwordx4 v6, s[12:15], s72 offen offset:1024 lds
v_mfma_f32_16x16x32_bf16 a[136:139], v[208:211], v[224:227], a[136:139]
ds_read_b64_tr_b16 v[242:243], v102 offset:50176
v_accvgpr_read_b32 v29, a7
v_mfma_f32_16x16x32_bf16 a[136:139], v[212:215], v[228:231], a[136:139]
v_accvgpr_read_b32 v26, a36
v_accvgpr_read_b32 v30, a37
v_mfma_f32_16x16x32_bf16 a[140:143], v[220:223], v[228:231], a[140:143]
v_accvgpr_read_b32 v27, a38
v_accvgpr_read_b32 v31, a39
v_mfma_f32_16x16x32_bf16 a[140:143], v[216:219], v[224:227], a[140:143]
s_add_u32 s72, s71, 63488
buffer_load_dwordx4 v7, s[12:15], s72 offen offset:2048 lds
v_mfma_f32_16x16x32_bf16 a[144:147], v[184:187], v[224:227], a[144:147]
ds_read_b64_tr_b16 v[244:245], v102 offset:57344
v_mul_f32 v24, s79, v24
v_mfma_f32_16x16x32_bf16 a[144:147], v[188:191], v[228:231], a[144:147]
v_mul_f32 v28, s79, v28
v_mul_f32 v25, s79, v25
v_mfma_f32_16x16x32_bf16 a[148:151], v[180:183], v[228:231], a[148:151]
ds_read_b64_tr_b16 v[246:247], v102 offset:58368
v_mul_f32 v29, s79, v29
v_mfma_f32_16x16x32_bf16 a[148:151], v[176:179], v[224:227], a[148:151]
v_mul_f32 v26, s79, v26
v_mul_f32 v30, s79, v30
v_mfma_f32_16x16x32_bf16 a[152:155], v[168:171], v[224:227], a[152:155]
s_add_u32 s72, s71, 95232
buffer_load_dwordx4 v7, s[12:15], s72 offen offset:3072 lds
v_mfma_f32_16x16x32_bf16 a[152:155], v[172:175], v[228:231], a[152:155]
v_mul_f32 v27, s79, v27
v_mul_f32 v31, s79, v31
v_mfma_f32_16x16x32_bf16 a[156:159], v[164:167], v[228:231], a[156:159]
v_cvt_pk_bf16_f32 v24, v24, v28
v_cvt_pk_bf16_f32 v25, v25, v29
v_mfma_f32_16x16x32_bf16 a[156:159], v[160:163], v[224:227], a[156:159]
s_waitcnt lgkmcnt(4)
v_cvt_pk_bf16_f32 v26, v26, v30
v_cvt_pk_bf16_f32 v27, v27, v31
v_mfma_f32_16x16x32_bf16 a[188:191], v[160:163], v[232:235], a[188:191]
s_add_u32 s80, s77, 4096
ds_read_b64_tr_b16 v[248:249], v103 offset:49152
v_mfma_f32_16x16x32_bf16 a[188:191], v[164:167], v[236:239], a[188:191]
buffer_store_dwordx4 v[24:27], v1, s[44:47], s80 offen sc1
v_mfma_f32_16x16x32_bf16 a[184:187], v[172:175], v[236:239], a[184:187]
ds_read_b64_tr_b16 v[250:251], v103 offset:50176
v_mfma_f32_16x16x32_bf16 a[184:187], v[168:171], v[232:235], a[184:187]
v_mfma_f32_16x16x32_bf16 a[180:183], v[176:179], v[232:235], a[180:183]
ds_read_b64_tr_b16 v[252:253], v103 offset:57344
v_mfma_f32_16x16x32_bf16 a[180:183], v[180:183], v[236:239], a[180:183]
s_add_u32 s73, s62, 2
v_mfma_f32_16x16x32_bf16 a[176:179], v[188:191], v[236:239], a[176:179]
s_add_u32 s70, s73, s65
ds_read_b64_tr_b16 v[254:255], v103 offset:58368
v_accvgpr_read_b32 v20, a8
v_mfma_f32_16x16x32_bf16 a[176:179], v[184:187], v[232:235], a[176:179]
s_and_b32 s70, s70, 3
v_accvgpr_read_b32 v28, a9
v_accvgpr_read_b32 v21, a10
v_mfma_f32_16x16x32_bf16 a[172:175], v[216:219], v[232:235], a[172:175]
s_and_b32 s73, s73, 12
v_accvgpr_read_b32 v29, a11
v_accvgpr_read_b32 v22, a40
v_mfma_f32_16x16x32_bf16 a[172:175], v[220:223], v[236:239], a[172:175]
s_or_b32 s73, s73, s70
v_accvgpr_read_b32 v30, a41
v_accvgpr_read_b32 v23, a42
v_mfma_f32_16x16x32_bf16 a[168:171], v[212:215], v[236:239], a[168:171]
s_lshl_b32 s73, s73, 7
v_accvgpr_read_b32 v31, a43
v_mul_f32 v20, s79, v20
v_mfma_f32_16x16x32_bf16 a[168:171], v[208:211], v[232:235], a[168:171]
s_add_u32 s69, s73, s67
v_mul_f32 v28, s79, v28
v_mul_f32 v21, s79, v21
v_mfma_f32_16x16x32_bf16 a[164:167], v[200:203], v[232:235], a[164:167]
s_add_u32 s70, s73, s68
v_mul_f32 v29, s79, v29
v_mul_f32 v22, s79, v22
v_mfma_f32_16x16x32_bf16 a[164:167], v[204:207], v[236:239], a[164:167]
s_add_u32 m0, s63, 98304
v_mul_f32 v30, s79, v30
v_mul_f32 v23, s79, v23
v_mfma_f32_16x16x32_bf16 a[160:163], v[196:199], v[236:239], a[160:163]
s_waitcnt vmcnt(14) lgkmcnt(0)
v_mul_f32 v31, s79, v31
v_cvt_pk_bf16_f32 v20, v20, v28
v_mfma_f32_16x16x32_bf16 a[160:163], v[192:195], v[232:235], a[160:163]
s_barrier
v_cvt_pk_bf16_f32 v21, v21, v29
v_cvt_pk_bf16_f32 v22, v22, v30
v_mfma_f32_16x16x32_bf16 a[192:195], v[192:195], v[240:243], a[192:195]
s_add_u32 s72, s69, 0
buffer_load_dwordx4 v4, s[4:7], s72 offen lds
v_mfma_f32_16x16x32_bf16 a[192:195], v[196:199], v[244:247], a[192:195]
s_lshl_b32 s74, s59, 2
ds_read_b64_tr_b16 v[64:65], v8 offset:0
v_or_b32 v106, s58, v0
v_mfma_f32_16x16x32_bf16 a[196:199], v[204:207], v[244:247], a[196:199]
ds_read_b64_tr_b16 v[66:67], v8 offset:1024
v_mov_b32 v107, 1
v_mfma_f32_16x16x32_bf16 a[196:199], v[200:203], v[240:243], a[196:199]
ds_read_b64_tr_b16 v[68:69], v8 offset:8192
v_lshlrev_b32 v106, 8, v106
v_mfma_f32_16x16x32_bf16 a[200:203], v[208:211], v[240:243], a[200:203]
ds_read_b64_tr_b16 v[70:71], v8 offset:9216
v_cvt_pk_bf16_f32 v23, v23, v31
v_mfma_f32_16x16x32_bf16 a[200:203], v[212:215], v[244:247], a[200:203]
s_add_u32 s72, s69, 15360
buffer_load_dwordx4 v5, s[4:7], s72 offen offset:1024 lds
v_mfma_f32_16x16x32_bf16 a[204:207], v[220:223], v[244:247], a[204:207]
s_add_u32 s80, s77, 8192
ds_read_b128 v[32:35], v16 offset:0
v_mfma_f32_16x16x32_bf16 a[204:207], v[216:219], v[240:243], a[204:207]
buffer_atomic_add v107, v106, s[48:51], s74 offen sc1
v_mfma_f32_16x16x32_bf16 a[208:211], v[184:187], v[240:243], a[208:211]
ds_read_b128 v[36:39], v17 offset:0
v_mfma_f32_16x16x32_bf16 a[208:211], v[188:191], v[244:247], a[208:211]
ds_read_b128 v[40:43], v16 offset:2048
v_mfma_f32_16x16x32_bf16 a[212:215], v[180:183], v[244:247], a[212:215]
s_add_u32 s72, s69, 129024
buffer_load_dwordx4 v4, s[4:7], s72 offen offset:2048 lds
v_mfma_f32_16x16x32_bf16 a[212:215], v[176:179], v[240:243], a[212:215]
ds_read_b128 v[44:47], v17 offset:2048
v_mfma_f32_16x16x32_bf16 a[216:219], v[168:171], v[240:243], a[216:219]
ds_read_b128 v[48:51], v16 offset:4096
v_accvgpr_read_b32 v24, a128
v_mfma_f32_16x16x32_bf16 a[216:219], v[172:175], v[244:247], a[216:219]
ds_read_b128 v[52:55], v17 offset:4096
v_accvgpr_read_b32 v28, a129
v_mfma_f32_16x16x32_bf16 a[220:223], v[164:167], v[244:247], a[220:223]
buffer_store_dwordx4 v[20:23], v1, s[44:47], s80 offen sc1
v_mfma_f32_16x16x32_bf16 a[220:223], v[160:163], v[240:243], a[220:223]
s_add_u32 s72, s69, 144384
buffer_load_dwordx4 v5, s[4:7], s72 offen offset:3072 lds
v_mfma_f32_16x16x32_bf16 a[252:255], v[160:163], v[248:251], a[252:255]
ds_read_b128 v[56:59], v16 offset:6144
v_accvgpr_read_b32 v25, a130
v_mfma_f32_16x16x32_bf16 a[252:255], v[164:167], v[252:255], a[252:255]
ds_read_b128 v[60:63], v17 offset:6144
v_accvgpr_read_b32 v29, a131
v_mfma_f32_16x16x32_bf16 a[248:251], v[172:175], v[252:255], a[248:251]
ds_read_b64_tr_b16 v[72:73], v9 offset:0
v_accvgpr_read_b32 v26, a132
v_mfma_f32_16x16x32_bf16 a[248:251], v[168:171], v[248:251], a[248:251]
s_add_u32 m0, s63, 102400
ds_read_b64_tr_b16 v[74:75], v9 offset:1024
v_accvgpr_read_b32 v30, a133
v_mfma_f32_16x16x32_bf16 a[244:247], v[176:179], v[248:251], a[244:247]
s_add_u32 s72, s70, 0
buffer_load_dwordx4 v4, s[4:7], s72 offen lds
v_mfma_f32_16x16x32_bf16 a[244:247], v[180:183], v[252:255], a[244:247]
ds_read_b64_tr_b16 v[76:77], v9 offset:8192
v_accvgpr_read_b32 v27, a134
v_mfma_f32_16x16x32_bf16 a[240:243], v[188:191], v[252:255], a[240:243]
v_accvgpr_read_b32 v31, a135
v_cvt_pk_bf16_f32 v24, v24, v28
v_mfma_f32_16x16x32_bf16 a[240:243], v[184:187], v[248:251], a[240:243]
ds_read_b64_tr_b16 v[78:79], v9 offset:9216
v_cvt_pk_bf16_f32 v25, v25, v29
v_mfma_f32_16x16x32_bf16 a[236:239], v[216:219], v[248:251], a[236:239]
ds_read_b64_tr_b16 v[80:81], v10 offset:0
v_cvt_pk_bf16_f32 v26, v26, v30
v_mfma_f32_16x16x32_bf16 a[236:239], v[220:223], v[252:255], a[236:239]
s_add_u32 s72, s70, 15360
buffer_load_dwordx4 v5, s[4:7], s72 offen offset:1024 lds
v_mfma_f32_16x16x32_bf16 a[232:235], v[212:215], v[252:255], a[232:235]
ds_read_b64_tr_b16 v[82:83], v10 offset:1024
v_cvt_pk_bf16_f32 v27, v27, v31
v_mfma_f32_16x16x32_bf16 a[232:235], v[208:211], v[248:251], a[232:235]
s_add_u32 s80, s78, 0
ds_read_b64_tr_b16 v[84:85], v10 offset:8192
v_mfma_f32_16x16x32_bf16 a[228:231], v[200:203], v[248:251], a[228:231]
ds_read_b64_tr_b16 v[86:87], v10 offset:9216
v_mfma_f32_16x16x32_bf16 a[228:231], v[204:207], v[252:255], a[228:231]
buffer_store_dwordx4 v[24:27], v1, s[44:47], s80 offen sc1
v_mfma_f32_16x16x32_bf16 a[224:227], v[196:199], v[252:255], a[224:227]
s_add_u32 s72, s70, 129024
buffer_load_dwordx4 v4, s[4:7], s72 offen offset:2048 lds
v_mfma_f32_16x16x32_bf16 a[224:227], v[192:195], v[248:251], a[224:227]
s_waitcnt lgkmcnt(8)
v_mfma_f32_16x16x32_bf16 v[128:131], v[64:67], v[32:35], 0
ds_read_b64_tr_b16 v[88:89], v11 offset:0
v_mfma_f32_16x16x32_bf16 v[128:131], v[68:71], v[36:39], v[128:131]
ds_read_b64_tr_b16 v[90:91], v11 offset:1024
v_mfma_f32_16x16x32_bf16 v[132:135], v[68:71], v[44:47], 0
v_accvgpr_read_b32 v20, a12
v_accvgpr_read_b32 v28, a13
v_mfma_f32_16x16x32_bf16 v[132:135], v[64:67], v[40:43], v[132:135]
s_add_u32 s72, s70, 144384
buffer_load_dwordx4 v5, s[4:7], s72 offen offset:3072 lds
v_mfma_f32_16x16x32_bf16 v[136:139], v[64:67], v[48:51], 0
s_lshl_b32 s71, s73, 12
ds_read_b64_tr_b16 v[92:93], v11 offset:8192
v_accvgpr_read_b32 v21, a14
v_mfma_f32_16x16x32_bf16 v[136:139], v[68:71], v[52:55], v[136:139]
s_add_u32 s71, s71, s66
v_accvgpr_read_b32 v29, a15
v_accvgpr_read_b32 v22, a44
v_mfma_f32_16x16x32_bf16 v[140:143], v[68:71], v[60:63], 0
s_add_u32 m0, s64, 32768
ds_read_b64_tr_b16 v[94:95], v11 offset:9216
v_accvgpr_read_b32 v30, a45
v_mfma_f32_16x16x32_bf16 v[140:143], v[64:67], v[56:59], v[140:143]
s_waitcnt lgkmcnt(8)
v_accvgpr_read_b32 v23, a46
v_accvgpr_read_b32 v31, a47
v_mfma_f32_16x16x32_bf16 v[156:159], v[72:75], v[56:59], 0
s_add_u32 s72, s71, 0
buffer_load_dwordx4 v6, s[12:15], s72 offen lds
v_mfma_f32_16x16x32_bf16 v[156:159], v[76:79], v[60:63], v[156:159]
s_add_u32 s73, s62, 3
ds_read_b64_tr_b16 v[64:65], v12 offset:0
v_mul_f32 v20, s79, v20
v_mfma_f32_16x16x32_bf16 v[152:155], v[76:79], v[52:55], 0
s_add_u32 s70, s73, s65
ds_read_b64_tr_b16 v[66:67], v12 offset:1024
v_mul_f32 v28, s79, v28
v_mfma_f32_16x16x32_bf16 v[152:155], v[72:75], v[48:51], v[152:155]
s_add_u32 s72, s71, 31744
buffer_load_dwordx4 v6, s[12:15], s72 offen offset:1024 lds
v_mfma_f32_16x16x32_bf16 v[148:151], v[72:75], v[40:43], 0
s_and_b32 s70, s70, 3
v_mul_f32 v21, s79, v21
v_mul_f32 v29, s79, v29
v_mfma_f32_16x16x32_bf16 v[148:151], v[76:79], v[44:47], v[148:151]
s_and_b32 s73, s73, 12
ds_read_b64_tr_b16 v[68:69], v12 offset:8192
v_mul_f32 v22, s79, v22
v_mfma_f32_16x16x32_bf16 v[144:147], v[76:79], v[36:39], 0
s_or_b32 s73, s73, s70
ds_read_b64_tr_b16 v[70:71], v12 offset:9216
v_mul_f32 v30, s79, v30
v_mfma_f32_16x16x32_bf16 v[144:147], v[72:75], v[32:35], v[144:147]
s_waitcnt lgkmcnt(8)
v_mul_f32 v23, s79, v23
v_mul_f32 v31, s79, v31
v_mfma_f32_16x16x32_bf16 v[160:163], v[80:83], v[32:35], 0
s_lshl_b32 s73, s73, 7
ds_read_b64_tr_b16 v[72:73], v13 offset:0
v_cvt_pk_bf16_f32 v20, v20, v28
v_mfma_f32_16x16x32_bf16 v[160:163], v[84:87], v[36:39], v[160:163]
s_add_u32 s72, s71, 63488
buffer_load_dwordx4 v7, s[12:15], s72 offen offset:2048 lds
v_mfma_f32_16x16x32_bf16 v[164:167], v[84:87], v[44:47], 0
s_add_u32 s69, s73, s67
ds_read_b64_tr_b16 v[74:75], v13 offset:1024
v_cvt_pk_bf16_f32 v21, v21, v29
v_mfma_f32_16x16x32_bf16 v[164:167], v[80:83], v[40:43], v[164:167]
s_add_u32 s70, s73, s68
v_cvt_pk_bf16_f32 v22, v22, v30
v_cvt_pk_bf16_f32 v23, v23, v31
v_mfma_f32_16x16x32_bf16 v[168:171], v[80:83], v[48:51], 0
s_waitcnt vmcnt(20)
ds_read_b64_tr_b16 v[76:77], v13 offset:8192
v_mfma_f32_16x16x32_bf16 v[168:171], v[84:87], v[52:55], v[168:171]
s_add_u32 s80, s77, 12288
ds_read_b64_tr_b16 v[78:79], v13 offset:9216
v_mfma_f32_16x16x32_bf16 v[172:175], v[84:87], v[60:63], 0
s_add_u32 s72, s71, 95232
ds_read_b128 v[96:99], v18 offset:0
v_mfma_f32_16x16x32_bf16 v[172:175], v[80:83], v[56:59], v[172:175]
s_waitcnt lgkmcnt(9)
buffer_load_dwordx4 v7, s[12:15], s72 offen offset:3072 lds
v_mfma_f32_16x16x32_bf16 v[188:191], v[88:91], v[56:59], 0
ds_read_b64_tr_b16 v[80:81], v14 offset:0
v_accvgpr_read_b32 v24, a136
v_mfma_f32_16x16x32_bf16 v[188:191], v[92:95], v[60:63], v[188:191]
ds_read_b64_tr_b16 v[82:83], v14 offset:1024
v_accvgpr_read_b32 v28, a137
v_mfma_f32_16x16x32_bf16 v[184:187], v[92:95], v[52:55], 0
ds_read_b128 v[100:103], v19 offset:0
v_accvgpr_read_b32 v25, a138
v_mfma_f32_16x16x32_bf16 v[184:187], v[88:91], v[48:51], v[184:187]
ds_read_b64_tr_b16 v[84:85], v14 offset:8192
v_accvgpr_read_b32 v29, a139
v_mfma_f32_16x16x32_bf16 v[180:183], v[88:91], v[40:43], 0
buffer_store_dwordx4 v[20:23], v1, s[44:47], s80 offen sc1
v_mfma_f32_16x16x32_bf16 v[180:183], v[92:95], v[44:47], v[180:183]
s_add_u32 m0, s63, 131072
ds_read_b64_tr_b16 v[86:87], v14 offset:9216
v_accvgpr_read_b32 v26, a140
v_mfma_f32_16x16x32_bf16 v[176:179], v[92:95], v[36:39], 0
s_add_u32 s72, s69, 0
buffer_load_dwordx4 v4, s[4:7], s72 offen lds
v_mfma_f32_16x16x32_bf16 v[176:179], v[88:91], v[32:35], v[176:179]
s_waitcnt lgkmcnt(10)
ds_read_b128 v[104:107], v18 offset:2048
v_accvgpr_read_b32 v30, a141
v_mfma_f32_16x16x32_bf16 v[192:195], v[64:67], v[32:35], 0
ds_read_b64_tr_b16 v[88:89], v15 offset:0
v_accvgpr_read_b32 v27, a142
v_mfma_f32_16x16x32_bf16 v[192:195], v[68:71], v[36:39], v[192:195]
ds_read_b64_tr_b16 v[90:91], v15 offset:1024
v_accvgpr_read_b32 v31, a143
v_mfma_f32_16x16x32_bf16 v[196:199], v[68:71], v[44:47], 0
ds_read_b64_tr_b16 v[92:93], v15 offset:8192
v_cvt_pk_bf16_f32 v24, v24, v28
v_mfma_f32_16x16x32_bf16 v[196:199], v[64:67], v[40:43], v[196:199]
s_add_u32 s72, s69, 15360
buffer_load_dwordx4 v5, s[4:7], s72 offen offset:1024 lds
v_mfma_f32_16x16x32_bf16 v[200:203], v[64:67], v[48:51], 0
ds_read_b64_tr_b16 v[94:95], v15 offset:9216
v_cvt_pk_bf16_f32 v25, v25, v29
v_mfma_f32_16x16x32_bf16 v[200:203], v[68:71], v[52:55], v[200:203]
ds_read_b128 v[108:111], v19 offset:2048
v_cvt_pk_bf16_f32 v26, v26, v30
v_mfma_f32_16x16x32_bf16 v[204:207], v[68:71], v[60:63], 0
v_cvt_pk_bf16_f32 v27, v27, v31
v_mfma_f32_16x16x32_bf16 v[204:207], v[64:67], v[56:59], v[204:207]
s_waitcnt lgkmcnt(12)
ds_read_b128 v[112:115], v18 offset:4096
v_mfma_f32_16x16x32_bf16 v[220:223], v[72:75], v[56:59], 0
s_add_u32 s72, s69, 129024
buffer_load_dwordx4 v4, s[4:7], s72 offen offset:2048 lds
v_mfma_f32_16x16x32_bf16 v[220:223], v[76:79], v[60:63], v[220:223]
s_add_u32 s80, s78, 8192
buffer_store_dwordx4 v[24:27], v1, s[44:47], s80 offen sc1
v_mfma_f32_16x16x32_bf16 v[216:219], v[76:79], v[52:55], 0
s_waitcnt vmcnt(21) lgkmcnt(2)
ds_read_b128 v[116:119], v19 offset:4096
v_mfma_f32_16x16x32_bf16 v[216:219], v[72:75], v[48:51], v[216:219]
s_barrier
ds_read_b128 v[120:123], v18 offset:6144
v_mfma_f32_16x16x32_bf16 v[212:215], v[72:75], v[40:43], 0
ds_read_b64_tr_b16 v[64:65], v8 offset:16384
ds_read_b64_tr_b16 v[66:67], v8 offset:17408
v_mfma_f32_16x16x32_bf16 v[212:215], v[76:79], v[44:47], v[212:215]
ds_read_b64_tr_b16 v[68:69], v8 offset:24576
v_mfma_f32_16x16x32_bf16 v[208:211], v[76:79], v[36:39], 0
s_add_u32 s72, s69, 144384
buffer_load_dwordx4 v5, s[4:7], s72 offen offset:3072 lds
v_mfma_f32_16x16x32_bf16 v[208:211], v[72:75], v[32:35], v[208:211]
ds_read_b64_tr_b16 v[70:71], v8 offset:25600
v_accvgpr_read_b32 v20, a16
v_mfma_f32_16x16x32_bf16 v[224:227], v[80:83], v[32:35], 0
ds_read_b64_tr_b16 v[72:73], v9 offset:16384
v_accvgpr_read_b32 v28, a17
v_mfma_f32_16x16x32_bf16 v[224:227], v[84:87], v[36:39], v[224:227]
ds_read_b64_tr_b16 v[74:75], v9 offset:17408
v_accvgpr_read_b32 v21, a18
v_mfma_f32_16x16x32_bf16 v[228:231], v[84:87], v[44:47], 0
s_add_u32 m0, s63, 135168
v_accvgpr_read_b32 v29, a19
v_accvgpr_read_b32 v22, a48
v_mfma_f32_16x16x32_bf16 v[228:231], v[80:83], v[40:43], v[228:231]
s_add_u32 s72, s70, 0
buffer_load_dwordx4 v4, s[4:7], s72 offen lds
v_mfma_f32_16x16x32_bf16 v[232:235], v[80:83], v[48:51], 0
ds_read_b64_tr_b16 v[76:77], v9 offset:24576
v_accvgpr_read_b32 v30, a49
v_mfma_f32_16x16x32_bf16 v[232:235], v[84:87], v[52:55], v[232:235]
ds_read_b128 v[124:127], v19 offset:6144
v_accvgpr_read_b32 v23, a50
v_mfma_f32_16x16x32_bf16 v[236:239], v[84:87], v[60:63], 0
ds_read_b64_tr_b16 v[78:79], v9 offset:25600
v_accvgpr_read_b32 v31, a51
v_mfma_f32_16x16x32_bf16 v[236:239], v[80:83], v[56:59], v[236:239]
v_mul_f32 v20, s79, v20
v_mul_f32 v28, s79, v28
v_mfma_f32_16x16x32_bf16 v[252:255], v[88:91], v[56:59], 0
s_add_u32 s72, s70, 15360
buffer_load_dwordx4 v5, s[4:7], s72 offen offset:1024 lds
v_mfma_f32_16x16x32_bf16 v[252:255], v[92:95], v[60:63], v[252:255]
ds_read_b64_tr_b16 v[80:81], v10 offset:16384
v_mul_f32 v21, s79, v21
v_mfma_f32_16x16x32_bf16 v[248:251], v[92:95], v[52:55], 0
ds_read_b64_tr_b16 v[82:83], v10 offset:17408
v_mul_f32 v29, s79, v29
v_mfma_f32_16x16x32_bf16 v[248:251], v[88:91], v[48:51], v[248:251]
v_mul_f32 v22, s79, v22
v_mul_f32 v30, s79, v30
v_mfma_f32_16x16x32_bf16 v[244:247], v[88:91], v[40:43], 0
ds_read_b64_tr_b16 v[84:85], v10 offset:24576
v_mul_f32 v23, s79, v23
v_mfma_f32_16x16x32_bf16 v[244:247], v[92:95], v[44:47], v[244:247]
ds_read_b64_tr_b16 v[86:87], v10 offset:25600
v_mul_f32 v31, s79, v31
v_mfma_f32_16x16x32_bf16 v[240:243], v[92:95], v[36:39], 0
s_add_u32 s72, s70, 129024
buffer_load_dwordx4 v4, s[4:7], s72 offen offset:2048 lds
v_mfma_f32_16x16x32_bf16 v[240:243], v[88:91], v[32:35], v[240:243]
s_waitcnt lgkmcnt(5)
v_cvt_pk_bf16_f32 v20, v20, v28
v_cvt_pk_bf16_f32 v21, v21, v29
v_mfma_f32_16x16x32_bf16 v[128:131], v[64:67], v[96:99], v[128:131]
ds_read_b64_tr_b16 v[88:89], v11 offset:16384
v_cvt_pk_bf16_f32 v22, v22, v30
v_mfma_f32_16x16x32_bf16 v[128:131], v[68:71], v[100:103], v[128:131]
ds_read_b64_tr_b16 v[90:91], v11 offset:17408
v_cvt_pk_bf16_f32 v23, v23, v31
v_mfma_f32_16x16x32_bf16 v[132:135], v[68:71], v[108:111], v[132:135]
s_add_u32 s80, s77, 32768
buffer_store_dwordx4 v[20:23], v1, s[44:47], s80 offen sc1
v_mfma_f32_16x16x32_bf16 v[132:135], v[64:67], v[104:107], v[132:135]
s_add_u32 s72, s70, 144384
buffer_load_dwordx4 v5, s[4:7], s72 offen offset:3072 lds
v_mfma_f32_16x16x32_bf16 v[136:139], v[64:67], v[112:115], v[136:139]
ds_read_b64_tr_b16 v[92:93], v11 offset:24576
v_accvgpr_read_b32 v24, a144
v_mfma_f32_16x16x32_bf16 v[136:139], v[68:71], v[116:119], v[136:139]
s_lshl_b32 s71, s73, 12
v_accvgpr_read_b32 v28, a145
v_accvgpr_read_b32 v25, a146
v_mfma_f32_16x16x32_bf16 v[140:143], v[68:71], v[124:127], v[140:143]
s_add_u32 s71, s71, s66
ds_read_b64_tr_b16 v[94:95], v11 offset:25600
v_accvgpr_read_b32 v29, a147
v_mfma_f32_16x16x32_bf16 v[140:143], v[64:67], v[120:123], v[140:143]
s_waitcnt lgkmcnt(8)
v_accvgpr_read_b32 v26, a148
v_accvgpr_read_b32 v30, a149
v_mfma_f32_16x16x32_bf16 v[156:159], v[72:75], v[120:123], v[156:159]
s_add_u32 m0, s64, 0
ds_read_b64_tr_b16 v[64:65], v12 offset:16384
v_accvgpr_read_b32 v27, a150
v_mfma_f32_16x16x32_bf16 v[156:159], v[76:79], v[124:127], v[156:159]
s_add_u32 s72, s71, 0
buffer_load_dwordx4 v6, s[12:15], s72 offen lds
v_mfma_f32_16x16x32_bf16 v[152:155], v[76:79], v[116:119], v[152:155]
s_add_u32 s73, s62, 4
ds_read_b64_tr_b16 v[66:67], v12 offset:17408
v_accvgpr_read_b32 v31, a151
v_mfma_f32_16x16x32_bf16 v[152:155], v[72:75], v[112:115], v[152:155]
s_add_u32 s70, s73, s65
v_cvt_pk_bf16_f32 v24, v24, v28
v_cvt_pk_bf16_f32 v25, v25, v29
v_mfma_f32_16x16x32_bf16 v[148:151], v[72:75], v[104:107], v[148:151]
s_and_b32 s70, s70, 3
ds_read_b64_tr_b16 v[68:69], v12 offset:24576
v_cvt_pk_bf16_f32 v26, v26, v30
v_mfma_f32_16x16x32_bf16 v[148:151], v[76:79], v[108:111], v[148:151]
s_and_b32 s73, s73, 12
ds_read_b64_tr_b16 v[70:71], v12 offset:25600
v_cvt_pk_bf16_f32 v27, v27, v31
v_mfma_f32_16x16x32_bf16 v[144:147], v[76:79], v[100:103], v[144:147]
s_add_u32 s72, s71, 31744
buffer_load_dwordx4 v6, s[12:15], s72 offen offset:1024 lds
v_mfma_f32_16x16x32_bf16 v[144:147], v[72:75], v[96:99], v[144:147]
s_waitcnt lgkmcnt(8)
v_mfma_f32_16x16x32_bf16 v[160:163], v[80:83], v[96:99], v[160:163]
s_or_b32 s73, s73, s70
ds_read_b64_tr_b16 v[72:73], v13 offset:16384
v_mfma_f32_16x16x32_bf16 v[160:163], v[84:87], v[100:103], v[160:163]
s_lshl_b32 s73, s73, 7
ds_read_b64_tr_b16 v[74:75], v13 offset:17408
v_mfma_f32_16x16x32_bf16 v[164:167], v[84:87], v[108:111], v[164:167]
s_add_u32 s69, s73, s67
v_mfma_f32_16x16x32_bf16 v[164:167], v[80:83], v[104:107], v[164:167]
s_add_u32 s72, s71, 63488
buffer_load_dwordx4 v7, s[12:15], s72 offen offset:2048 lds
v_mfma_f32_16x16x32_bf16 v[168:171], v[80:83], v[112:115], v[168:171]
s_waitcnt vmcnt(18)
ds_read_b64_tr_b16 v[76:77], v13 offset:24576
v_mfma_f32_16x16x32_bf16 v[168:171], v[84:87], v[116:119], v[168:171]
s_add_u32 s70, s73, s68
ds_read_b128 v[32:35], v18 offset:32768
v_mfma_f32_16x16x32_bf16 v[172:175], v[84:87], v[124:127], v[172:175]
s_add_u32 s80, s78, 32768
ds_read_b64_tr_b16 v[78:79], v13 offset:25600
v_mfma_f32_16x16x32_bf16 v[172:175], v[80:83], v[120:123], v[172:175]
s_waitcnt lgkmcnt(9)
ds_read_b128 v[36:39], v19 offset:32768
v_mfma_f32_16x16x32_bf16 v[188:191], v[88:91], v[120:123], v[188:191]
s_add_u32 s72, s71, 95232
buffer_load_dwordx4 v7, s[12:15], s72 offen offset:3072 lds
v_mfma_f32_16x16x32_bf16 v[188:191], v[92:95], v[124:127], v[188:191]
ds_read_b64_tr_b16 v[80:81], v14 offset:16384
v_mfma_f32_16x16x32_bf16 v[184:187], v[92:95], v[116:119], v[184:187]
ds_read_b64_tr_b16 v[82:83], v14 offset:17408
v_mfma_f32_16x16x32_bf16 v[184:187], v[88:91], v[112:115], v[184:187]
buffer_store_dwordx4 v[24:27], v1, s[44:47], s80 offen sc1
v_mfma_f32_16x16x32_bf16 v[180:183], v[88:91], v[104:107], v[180:183]
ds_read_b64_tr_b16 v[84:85], v14 offset:24576
v_accvgpr_read_b32 v20, a20
v_mfma_f32_16x16x32_bf16 v[180:183], v[92:95], v[108:111], v[180:183]
s_add_u32 m0, s63, 65536
ds_read_b64_tr_b16 v[86:87], v14 offset:25600
v_accvgpr_read_b32 v28, a21
v_mfma_f32_16x16x32_bf16 v[176:179], v[92:95], v[100:103], v[176:179]
s_add_u32 s72, s69, 0
buffer_load_dwordx4 v4, s[4:7], s72 offen lds
v_mfma_f32_16x16x32_bf16 v[176:179], v[88:91], v[96:99], v[176:179]
s_waitcnt lgkmcnt(10)
ds_read_b128 v[40:43], v18 offset:34816
v_accvgpr_read_b32 v21, a22
v_mfma_f32_16x16x32_bf16 v[192:195], v[64:67], v[96:99], v[192:195]
ds_read_b64_tr_b16 v[88:89], v15 offset:16384
v_accvgpr_read_b32 v29, a23
v_mfma_f32_16x16x32_bf16 v[192:195], v[68:71], v[100:103], v[192:195]
ds_read_b64_tr_b16 v[90:91], v15 offset:17408
v_accvgpr_read_b32 v22, a52
v_mfma_f32_16x16x32_bf16 v[196:199], v[68:71], v[108:111], v[196:199]
ds_read_b64_tr_b16 v[92:93], v15 offset:24576
v_accvgpr_read_b32 v30, a53
v_mfma_f32_16x16x32_bf16 v[196:199], v[64:67], v[104:107], v[196:199]
s_add_u32 s72, s69, 15360
buffer_load_dwordx4 v5, s[4:7], s72 offen offset:1024 lds
v_mfma_f32_16x16x32_bf16 v[200:203], v[64:67], v[112:115], v[200:203]
ds_read_b64_tr_b16 v[94:95], v15 offset:25600
v_accvgpr_read_b32 v23, a54
v_mfma_f32_16x16x32_bf16 v[200:203], v[68:71], v[116:119], v[200:203]
ds_read_b128 v[44:47], v19 offset:34816
v_accvgpr_read_b32 v31, a55
v_mfma_f32_16x16x32_bf16 v[204:207], v[68:71], v[124:127], v[204:207]
v_mul_f32 v20, s79, v20
v_mul_f32 v28, s79, v28
v_mfma_f32_16x16x32_bf16 v[204:207], v[64:67], v[120:123], v[204:207]
s_waitcnt lgkmcnt(11)
ds_read_b128 v[48:51], v18 offset:36864
v_mul_f32 v21, s79, v21
v_mfma_f32_16x16x32_bf16 v[220:223], v[72:75], v[120:123], v[220:223]
s_add_u32 s72, s69, 129024
buffer_load_dwordx4 v4, s[4:7], s72 offen offset:2048 lds
v_mfma_f32_16x16x32_bf16 v[220:223], v[76:79], v[124:127], v[220:223]
v_mul_f32 v29, s79, v29
v_mul_f32 v22, s79, v22
v_mfma_f32_16x16x32_bf16 v[216:219], v[76:79], v[116:119], v[216:219]
s_waitcnt vmcnt(19) lgkmcnt(2)
ds_read_b128 v[52:55], v19 offset:36864
v_mul_f32 v30, s79, v30
v_mfma_f32_16x16x32_bf16 v[216:219], v[72:75], v[112:115], v[216:219]
s_barrier
ds_read_b128 v[56:59], v18 offset:38912
v_mul_f32 v23, s79, v23
v_mfma_f32_16x16x32_bf16 v[212:215], v[72:75], v[104:107], v[212:215]
ds_read_b64_tr_b16 v[64:65], v8 offset:32768
ds_read_b64_tr_b16 v[66:67], v8 offset:33792
v_mfma_f32_16x16x32_bf16 v[212:215], v[76:79], v[108:111], v[212:215]
ds_read_b64_tr_b16 v[68:69], v8 offset:40960
v_mul_f32 v31, s79, v31
v_mfma_f32_16x16x32_bf16 v[208:211], v[76:79], v[100:103], v[208:211]
s_add_u32 s72, s69, 144384
buffer_load_dwordx4 v5, s[4:7], s72 offen offset:3072 lds
v_mfma_f32_16x16x32_bf16 v[208:211], v[72:75], v[96:99], v[208:211]
ds_read_b64_tr_b16 v[70:71], v8 offset:41984
v_cvt_pk_bf16_f32 v20, v20, v28
v_mfma_f32_16x16x32_bf16 v[224:227], v[80:83], v[96:99], v[224:227]
ds_read_b64_tr_b16 v[72:73], v9 offset:32768
v_cvt_pk_bf16_f32 v21, v21, v29
v_mfma_f32_16x16x32_bf16 v[224:227], v[84:87], v[100:103], v[224:227]
ds_read_b64_tr_b16 v[74:75], v9 offset:33792
v_cvt_pk_bf16_f32 v22, v22, v30
v_mfma_f32_16x16x32_bf16 v[228:231], v[84:87], v[108:111], v[228:231]
s_add_u32 m0, s63, 69632
v_cvt_pk_bf16_f32 v23, v23, v31
v_accvgpr_read_b32 v24, a152
v_mfma_f32_16x16x32_bf16 v[228:231], v[80:83], v[104:107], v[228:231]
s_add_u32 s72, s70, 0
buffer_load_dwordx4 v4, s[4:7], s72 offen lds
v_mfma_f32_16x16x32_bf16 v[232:235], v[80:83], v[112:115], v[232:235]
s_add_u32 s80, s77, 36864
ds_read_b64_tr_b16 v[76:77], v9 offset:40960
v_accvgpr_read_b32 v28, a153
v_mfma_f32_16x16x32_bf16 v[232:235], v[84:87], v[116:119], v[232:235]
ds_read_b128 v[60:63], v19 offset:38912
v_accvgpr_read_b32 v25, a154
v_mfma_f32_16x16x32_bf16 v[236:239], v[84:87], v[124:127], v[236:239]
ds_read_b64_tr_b16 v[78:79], v9 offset:41984
v_accvgpr_read_b32 v29, a155
v_mfma_f32_16x16x32_bf16 v[236:239], v[80:83], v[120:123], v[236:239]
buffer_store_dwordx4 v[20:23], v1, s[44:47], s80 offen sc1
v_mfma_f32_16x16x32_bf16 v[252:255], v[88:91], v[120:123], v[252:255]
s_add_u32 s72, s70, 15360
buffer_load_dwordx4 v5, s[4:7], s72 offen offset:1024 lds
v_mfma_f32_16x16x32_bf16 v[252:255], v[92:95], v[124:127], v[252:255]
ds_read_b64_tr_b16 v[80:81], v10 offset:32768
v_accvgpr_read_b32 v26, a156
v_mfma_f32_16x16x32_bf16 v[248:251], v[92:95], v[116:119], v[248:251]
ds_read_b64_tr_b16 v[82:83], v10 offset:33792
v_accvgpr_read_b32 v30, a157
v_mfma_f32_16x16x32_bf16 v[248:251], v[88:91], v[112:115], v[248:251]
v_accvgpr_read_b32 v27, a158
v_accvgpr_read_b32 v31, a159
v_mfma_f32_16x16x32_bf16 v[244:247], v[88:91], v[104:107], v[244:247]
ds_read_b64_tr_b16 v[84:85], v10 offset:40960
v_cvt_pk_bf16_f32 v24, v24, v28
v_mfma_f32_16x16x32_bf16 v[244:247], v[92:95], v[108:111], v[244:247]
ds_read_b64_tr_b16 v[86:87], v10 offset:41984
v_cvt_pk_bf16_f32 v25, v25, v29
v_mfma_f32_16x16x32_bf16 v[240:243], v[92:95], v[100:103], v[240:243]
s_add_u32 s72, s70, 129024
buffer_load_dwordx4 v4, s[4:7], s72 offen offset:2048 lds
v_mfma_f32_16x16x32_bf16 v[240:243], v[88:91], v[96:99], v[240:243]
s_waitcnt lgkmcnt(5)
v_cvt_pk_bf16_f32 v26, v26, v30
v_cvt_pk_bf16_f32 v27, v27, v31
v_mfma_f32_16x16x32_bf16 v[128:131], v[64:67], v[32:35], v[128:131]
s_add_u32 s80, s78, 40960
ds_read_b64_tr_b16 v[88:89], v11 offset:32768
v_mfma_f32_16x16x32_bf16 v[128:131], v[68:71], v[36:39], v[128:131]
ds_read_b64_tr_b16 v[90:91], v11 offset:33792
v_mfma_f32_16x16x32_bf16 v[132:135], v[68:71], v[44:47], v[132:135]
buffer_store_dwordx4 v[24:27], v1, s[44:47], s80 offen sc1
v_mfma_f32_16x16x32_bf16 v[132:135], v[64:67], v[40:43], v[132:135]
s_add_u32 s72, s70, 144384
buffer_load_dwordx4 v5, s[4:7], s72 offen offset:3072 lds
v_mfma_f32_16x16x32_bf16 v[136:139], v[64:67], v[48:51], v[136:139]
ds_read_b64_tr_b16 v[92:93], v11 offset:40960
v_mfma_f32_16x16x32_bf16 v[136:139], v[68:71], v[52:55], v[136:139]
s_lshl_b32 s71, s73, 12
v_mfma_f32_16x16x32_bf16 v[140:143], v[68:71], v[60:63], v[140:143]
s_add_u32 s71, s71, s66
ds_read_b64_tr_b16 v[94:95], v11 offset:41984
v_mfma_f32_16x16x32_bf16 v[140:143], v[64:67], v[56:59], v[140:143]
s_waitcnt lgkmcnt(8)
v_accvgpr_read_b32 v20, a24
v_accvgpr_read_b32 v28, a25
v_mfma_f32_16x16x32_bf16 v[156:159], v[72:75], v[56:59], v[156:159]
s_add_u32 m0, s64, 16384
ds_read_b64_tr_b16 v[64:65], v12 offset:32768
v_accvgpr_read_b32 v21, a26
v_mfma_f32_16x16x32_bf16 v[156:159], v[76:79], v[60:63], v[156:159]
s_add_u32 s72, s71, 0
buffer_load_dwordx4 v6, s[12:15], s72 offen lds
v_mfma_f32_16x16x32_bf16 v[152:155], v[76:79], v[52:55], v[152:155]
s_add_u32 s73, s62, 5
ds_read_b64_tr_b16 v[66:67], v12 offset:33792
v_accvgpr_read_b32 v29, a27
v_mfma_f32_16x16x32_bf16 v[152:155], v[72:75], v[48:51], v[152:155]
s_add_u32 s70, s73, s65
v_accvgpr_read_b32 v22, a56
v_accvgpr_read_b32 v30, a57
v_mfma_f32_16x16x32_bf16 v[148:151], v[72:75], v[40:43], v[148:151]
s_and_b32 s70, s70, 3
ds_read_b64_tr_b16 v[68:69], v12 offset:40960
v_accvgpr_read_b32 v23, a58
v_mfma_f32_16x16x32_bf16 v[148:151], v[76:79], v[44:47], v[148:151]
s_and_b32 s73, s73, 12
ds_read_b64_tr_b16 v[70:71], v12 offset:41984
v_accvgpr_read_b32 v31, a59
v_mfma_f32_16x16x32_bf16 v[144:147], v[76:79], v[36:39], v[144:147]
s_add_u32 s72, s71, 31744
buffer_load_dwordx4 v6, s[12:15], s72 offen offset:1024 lds
v_mfma_f32_16x16x32_bf16 v[144:147], v[72:75], v[32:35], v[144:147]
s_waitcnt lgkmcnt(8)
v_mul_f32 v20, s79, v20
v_mul_f32 v28, s79, v28
v_mfma_f32_16x16x32_bf16 v[160:163], v[80:83], v[32:35], v[160:163]
s_or_b32 s73, s73, s70
ds_read_b64_tr_b16 v[72:73], v13 offset:32768
v_mul_f32 v21, s79, v21
v_mfma_f32_16x16x32_bf16 v[160:163], v[84:87], v[36:39], v[160:163]
s_lshl_b32 s73, s73, 7
ds_read_b64_tr_b16 v[74:75], v13 offset:33792
v_mul_f32 v29, s79, v29
v_mfma_f32_16x16x32_bf16 v[164:167], v[84:87], v[44:47], v[164:167]
s_add_u32 s69, s73, s67
v_mul_f32 v22, s79, v22
v_mul_f32 v30, s79, v30
v_mfma_f32_16x16x32_bf16 v[164:167], v[80:83], v[40:43], v[164:167]
s_add_u32 s72, s71, 63488
buffer_load_dwordx4 v7, s[12:15], s72 offen offset:2048 lds
v_mfma_f32_16x16x32_bf16 v[168:171], v[80:83], v[48:51], v[168:171]
s_waitcnt vmcnt(18)
ds_read_b64_tr_b16 v[76:77], v13 offset:40960
v_mul_f32 v23, s79, v23
v_mfma_f32_16x16x32_bf16 v[168:171], v[84:87], v[52:55], v[168:171]
s_add_u32 s70, s73, s68
ds_read_b128 v[96:99], v16 offset:0
v_mul_f32 v31, s79, v31
v_mfma_f32_16x16x32_bf16 v[172:175], v[84:87], v[60:63], v[172:175]
ds_read_b64_tr_b16 v[78:79], v13 offset:41984
v_cvt_pk_bf16_f32 v20, v20, v28
v_mfma_f32_16x16x32_bf16 v[172:175], v[80:83], v[56:59], v[172:175]
s_waitcnt lgkmcnt(9)
ds_read_b128 v[100:103], v17 offset:0
v_cvt_pk_bf16_f32 v21, v21, v29
v_mfma_f32_16x16x32_bf16 v[188:191], v[88:91], v[56:59], v[188:191]
s_add_u32 s72, s71, 95232
buffer_load_dwordx4 v7, s[12:15], s72 offen offset:3072 lds
v_mfma_f32_16x16x32_bf16 v[188:191], v[92:95], v[60:63], v[188:191]
ds_read_b64_tr_b16 v[80:81], v14 offset:32768
v_cvt_pk_bf16_f32 v22, v22, v30
v_mfma_f32_16x16x32_bf16 v[184:187], v[92:95], v[52:55], v[184:187]
ds_read_b64_tr_b16 v[82:83], v14 offset:33792
v_cvt_pk_bf16_f32 v23, v23, v31
v_mfma_f32_16x16x32_bf16 v[184:187], v[88:91], v[48:51], v[184:187]
s_add_u32 s80, s77, 40960
buffer_store_dwordx4 v[20:23], v1, s[44:47], s80 offen sc1
v_mfma_f32_16x16x32_bf16 v[180:183], v[88:91], v[40:43], v[180:183]
ds_read_b64_tr_b16 v[84:85], v14 offset:40960
v_mfma_f32_16x16x32_bf16 v[180:183], v[92:95], v[44:47], v[180:183]
s_add_u32 m0, s63, 98304
ds_read_b64_tr_b16 v[86:87], v14 offset:41984
v_accvgpr_read_b32 v24, a160
v_mfma_f32_16x16x32_bf16 v[176:179], v[92:95], v[36:39], v[176:179]
s_add_u32 s72, s69, 0
buffer_load_dwordx4 v4, s[4:7], s72 offen lds
v_mfma_f32_16x16x32_bf16 v[176:179], v[88:91], v[32:35], v[176:179]
s_waitcnt lgkmcnt(10)
ds_read_b128 v[104:107], v16 offset:2048
v_accvgpr_read_b32 v28, a161
v_mfma_f32_16x16x32_bf16 v[192:195], v[64:67], v[32:35], v[192:195]
ds_read_b64_tr_b16 v[88:89], v15 offset:32768
v_accvgpr_read_b32 v25, a162
v_mfma_f32_16x16x32_bf16 v[192:195], v[68:71], v[36:39], v[192:195]
ds_read_b64_tr_b16 v[90:91], v15 offset:33792
v_accvgpr_read_b32 v29, a163
v_mfma_f32_16x16x32_bf16 v[196:199], v[68:71], v[44:47], v[196:199]
ds_read_b64_tr_b16 v[92:93], v15 offset:40960
v_accvgpr_read_b32 v26, a164
v_mfma_f32_16x16x32_bf16 v[196:199], v[64:67], v[40:43], v[196:199]
s_add_u32 s72, s69, 15360
buffer_load_dwordx4 v5, s[4:7], s72 offen offset:1024 lds
v_mfma_f32_16x16x32_bf16 v[200:203], v[64:67], v[48:51], v[200:203]
ds_read_b64_tr_b16 v[94:95], v15 offset:41984
v_accvgpr_read_b32 v30, a165
v_mfma_f32_16x16x32_bf16 v[200:203], v[68:71], v[52:55], v[200:203]
ds_read_b128 v[108:111], v17 offset:2048
v_accvgpr_read_b32 v27, a166
v_mfma_f32_16x16x32_bf16 v[204:207], v[68:71], v[60:63], v[204:207]
v_accvgpr_read_b32 v31, a167
v_cvt_pk_bf16_f32 v24, v24, v28
v_mfma_f32_16x16x32_bf16 v[204:207], v[64:67], v[56:59], v[204:207]
s_waitcnt lgkmcnt(11)
ds_read_b128 v[112:115], v16 offset:4096
v_cvt_pk_bf16_f32 v25, v25, v29
v_mfma_f32_16x16x32_bf16 v[220:223], v[72:75], v[56:59], v[220:223]
s_add_u32 s72, s69, 129024
buffer_load_dwordx4 v4, s[4:7], s72 offen offset:2048 lds
v_mfma_f32_16x16x32_bf16 v[220:223], v[76:79], v[60:63], v[220:223]
v_cvt_pk_bf16_f32 v26, v26, v30
v_cvt_pk_bf16_f32 v27, v27, v31
v_mfma_f32_16x16x32_bf16 v[216:219], v[76:79], v[52:55], v[216:219]
s_waitcnt vmcnt(19) lgkmcnt(2)
ds_read_b128 v[116:119], v17 offset:4096
v_mfma_f32_16x16x32_bf16 v[216:219], v[72:75], v[48:51], v[216:219]
s_barrier
ds_read_b128 v[120:123], v16 offset:6144
v_mfma_f32_16x16x32_bf16 v[212:215], v[72:75], v[40:43], v[212:215]
s_add_u32 s80, s78, 1024
ds_read_b64_tr_b16 v[64:65], v8 offset:0
ds_read_b64_tr_b16 v[66:67], v8 offset:1024
v_mfma_f32_16x16x32_bf16 v[212:215], v[76:79], v[44:47], v[212:215]
ds_read_b64_tr_b16 v[68:69], v8 offset:8192
v_mfma_f32_16x16x32_bf16 v[208:211], v[76:79], v[36:39], v[208:211]
s_add_u32 s72, s69, 144384
buffer_load_dwordx4 v5, s[4:7], s72 offen offset:3072 lds
v_mfma_f32_16x16x32_bf16 v[208:211], v[72:75], v[32:35], v[208:211]
ds_read_b64_tr_b16 v[70:71], v8 offset:9216
v_mfma_f32_16x16x32_bf16 v[224:227], v[80:83], v[32:35], v[224:227]
ds_read_b64_tr_b16 v[72:73], v9 offset:0
v_mfma_f32_16x16x32_bf16 v[224:227], v[84:87], v[36:39], v[224:227]
ds_read_b64_tr_b16 v[74:75], v9 offset:1024
v_mfma_f32_16x16x32_bf16 v[228:231], v[84:87], v[44:47], v[228:231]
s_add_u32 m0, s63, 102400
buffer_store_dwordx4 v[24:27], v1, s[44:47], s80 offen sc1
v_mfma_f32_16x16x32_bf16 v[228:231], v[80:83], v[40:43], v[228:231]
s_add_u32 s72, s70, 0
buffer_load_dwordx4 v4, s[4:7], s72 offen lds
v_mfma_f32_16x16x32_bf16 v[232:235], v[80:83], v[48:51], v[232:235]
ds_read_b64_tr_b16 v[76:77], v9 offset:8192
v_accvgpr_read_b32 v20, a28
v_mfma_f32_16x16x32_bf16 v[232:235], v[84:87], v[52:55], v[232:235]
ds_read_b128 v[124:127], v17 offset:6144
v_accvgpr_read_b32 v28, a29
v_mfma_f32_16x16x32_bf16 v[236:239], v[84:87], v[60:63], v[236:239]
ds_read_b64_tr_b16 v[78:79], v9 offset:9216
v_accvgpr_read_b32 v21, a30
v_mfma_f32_16x16x32_bf16 v[236:239], v[80:83], v[56:59], v[236:239]
v_accvgpr_read_b32 v29, a31
v_accvgpr_read_b32 v22, a60
v_mfma_f32_16x16x32_bf16 v[252:255], v[88:91], v[56:59], v[252:255]
s_add_u32 s72, s70, 15360
buffer_load_dwordx4 v5, s[4:7], s72 offen offset:1024 lds
v_mfma_f32_16x16x32_bf16 v[252:255], v[92:95], v[60:63], v[252:255]
ds_read_b64_tr_b16 v[80:81], v10 offset:0
v_accvgpr_read_b32 v30, a61
v_mfma_f32_16x16x32_bf16 v[248:251], v[92:95], v[52:55], v[248:251]
ds_read_b64_tr_b16 v[82:83], v10 offset:1024
v_accvgpr_read_b32 v23, a62
v_mfma_f32_16x16x32_bf16 v[248:251], v[88:91], v[48:51], v[248:251]
v_accvgpr_read_b32 v31, a63
v_mul_f32 v20, s79, v20
v_mfma_f32_16x16x32_bf16 v[244:247], v[88:91], v[40:43], v[244:247]
ds_read_b64_tr_b16 v[84:85], v10 offset:8192
v_mul_f32 v28, s79, v28
v_mfma_f32_16x16x32_bf16 v[244:247], v[92:95], v[44:47], v[244:247]
ds_read_b64_tr_b16 v[86:87], v10 offset:9216
v_mul_f32 v21, s79, v21
v_mfma_f32_16x16x32_bf16 v[240:243], v[92:95], v[36:39], v[240:243]
s_add_u32 s72, s70, 129024
buffer_load_dwordx4 v4, s[4:7], s72 offen offset:2048 lds
v_mfma_f32_16x16x32_bf16 v[240:243], v[88:91], v[32:35], v[240:243]
s_waitcnt lgkmcnt(5)
v_mul_f32 v29, s79, v29
v_mul_f32 v22, s79, v22
v_mfma_f32_16x16x32_bf16 v[128:131], v[64:67], v[96:99], v[128:131]
ds_read_b64_tr_b16 v[88:89], v11 offset:0
v_mul_f32 v30, s79, v30
v_mfma_f32_16x16x32_bf16 v[128:131], v[68:71], v[100:103], v[128:131]
ds_read_b64_tr_b16 v[90:91], v11 offset:1024
v_mul_f32 v23, s79, v23
v_mfma_f32_16x16x32_bf16 v[132:135], v[68:71], v[108:111], v[132:135]
v_mul_f32 v31, s79, v31
v_cvt_pk_bf16_f32 v20, v20, v28
v_mfma_f32_16x16x32_bf16 v[132:135], v[64:67], v[104:107], v[132:135]
s_add_u32 s72, s70, 144384
buffer_load_dwordx4 v5, s[4:7], s72 offen offset:3072 lds
v_mfma_f32_16x16x32_bf16 v[136:139], v[64:67], v[112:115], v[136:139]
ds_read_b64_tr_b16 v[92:93], v11 offset:8192
v_cvt_pk_bf16_f32 v21, v21, v29
v_mfma_f32_16x16x32_bf16 v[136:139], v[68:71], v[116:119], v[136:139]
s_lshl_b32 s71, s73, 12
v_cvt_pk_bf16_f32 v22, v22, v30
v_cvt_pk_bf16_f32 v23, v23, v31
v_mfma_f32_16x16x32_bf16 v[140:143], v[68:71], v[124:127], v[140:143]
s_add_u32 s71, s71, s66
ds_read_b64_tr_b16 v[94:95], v11 offset:9216
v_mfma_f32_16x16x32_bf16 v[140:143], v[64:67], v[120:123], v[140:143]
s_waitcnt lgkmcnt(8)
v_mfma_f32_16x16x32_bf16 v[156:159], v[72:75], v[120:123], v[156:159]
s_add_u32 m0, s64, 32768
ds_read_b64_tr_b16 v[64:65], v12 offset:0
v_mfma_f32_16x16x32_bf16 v[156:159], v[76:79], v[124:127], v[156:159]
s_add_u32 s72, s71, 0
buffer_load_dwordx4 v6, s[12:15], s72 offen lds
v_mfma_f32_16x16x32_bf16 v[152:155], v[76:79], v[116:119], v[152:155]
s_add_u32 s73, s62, 6
ds_read_b64_tr_b16 v[66:67], v12 offset:1024
v_accvgpr_read_b32 v24, a168
v_mfma_f32_16x16x32_bf16 v[152:155], v[72:75], v[112:115], v[152:155]
s_add_u32 s70, s73, s65
v_accvgpr_read_b32 v28, a169
v_accvgpr_read_b32 v25, a170
v_mfma_f32_16x16x32_bf16 v[148:151], v[72:75], v[104:107], v[148:151]
s_and_b32 s70, s70, 3
ds_read_b64_tr_b16 v[68:69], v12 offset:8192
v_accvgpr_read_b32 v29, a171
v_mfma_f32_16x16x32_bf16 v[148:151], v[76:79], v[108:111], v[148:151]
s_and_b32 s73, s73, 12
ds_read_b64_tr_b16 v[70:71], v12 offset:9216
v_accvgpr_read_b32 v26, a172
v_mfma_f32_16x16x32_bf16 v[144:147], v[76:79], v[100:103], v[144:147]
s_add_u32 s72, s71, 31744
buffer_load_dwordx4 v6, s[12:15], s72 offen offset:1024 lds
v_mfma_f32_16x16x32_bf16 v[144:147], v[72:75], v[96:99], v[144:147]
s_waitcnt lgkmcnt(8)
v_accvgpr_read_b32 v30, a173
v_accvgpr_read_b32 v27, a174
v_mfma_f32_16x16x32_bf16 v[160:163], v[80:83], v[96:99], v[160:163]
s_or_b32 s73, s73, s70
ds_read_b64_tr_b16 v[72:73], v13 offset:0
v_accvgpr_read_b32 v31, a175
v_mfma_f32_16x16x32_bf16 v[160:163], v[84:87], v[100:103], v[160:163]
s_lshl_b32 s73, s73, 7
ds_read_b64_tr_b16 v[74:75], v13 offset:1024
v_cvt_pk_bf16_f32 v24, v24, v28
v_mfma_f32_16x16x32_bf16 v[164:167], v[84:87], v[108:111], v[164:167]
s_add_u32 s69, s73, s67
v_cvt_pk_bf16_f32 v25, v25, v29
v_cvt_pk_bf16_f32 v26, v26, v30
v_mfma_f32_16x16x32_bf16 v[164:167], v[80:83], v[104:107], v[164:167]
s_add_u32 s72, s71, 63488
buffer_load_dwordx4 v7, s[12:15], s72 offen offset:2048 lds
v_mfma_f32_16x16x32_bf16 v[168:171], v[80:83], v[112:115], v[168:171]
s_waitcnt vmcnt(17)
ds_read_b64_tr_b16 v[76:77], v13 offset:8192
v_cvt_pk_bf16_f32 v27, v27, v31
v_mfma_f32_16x16x32_bf16 v[168:171], v[84:87], v[116:119], v[168:171]
s_add_u32 s70, s73, s68
ds_read_b128 v[32:35], v18 offset:0
v_mfma_f32_16x16x32_bf16 v[172:175], v[84:87], v[124:127], v[172:175]
s_add_u32 s80, s77, 45056
ds_read_b64_tr_b16 v[78:79], v13 offset:9216
v_mfma_f32_16x16x32_bf16 v[172:175], v[80:83], v[120:123], v[172:175]
s_waitcnt lgkmcnt(9)
ds_read_b128 v[36:39], v19 offset:0
v_mfma_f32_16x16x32_bf16 v[188:191], v[88:91], v[120:123], v[188:191]
s_add_u32 s72, s71, 95232
buffer_load_dwordx4 v7, s[12:15], s72 offen offset:3072 lds
v_mfma_f32_16x16x32_bf16 v[188:191], v[92:95], v[124:127], v[188:191]
ds_read_b64_tr_b16 v[80:81], v14 offset:0
v_mfma_f32_16x16x32_bf16 v[184:187], v[92:95], v[116:119], v[184:187]
ds_read_b64_tr_b16 v[82:83], v14 offset:1024
v_mfma_f32_16x16x32_bf16 v[184:187], v[88:91], v[112:115], v[184:187]
buffer_store_dwordx4 v[20:23], v1, s[44:47], s80 offen sc1
v_mfma_f32_16x16x32_bf16 v[180:183], v[88:91], v[104:107], v[180:183]
s_add_u32 s80, s78, 9216
ds_read_b64_tr_b16 v[84:85], v14 offset:8192
v_mfma_f32_16x16x32_bf16 v[180:183], v[92:95], v[108:111], v[180:183]
s_add_u32 m0, s63, 131072
ds_read_b64_tr_b16 v[86:87], v14 offset:9216
v_mfma_f32_16x16x32_bf16 v[176:179], v[92:95], v[100:103], v[176:179]
s_add_u32 s72, s69, 0
buffer_load_dwordx4 v4, s[4:7], s72 offen lds
v_mfma_f32_16x16x32_bf16 v[176:179], v[88:91], v[96:99], v[176:179]
s_waitcnt lgkmcnt(10)
ds_read_b128 v[40:43], v18 offset:2048
v_accvgpr_read_b32 v20, a64
v_mfma_f32_16x16x32_bf16 v[192:195], v[64:67], v[96:99], v[192:195]
ds_read_b64_tr_b16 v[88:89], v15 offset:0
v_accvgpr_read_b32 v28, a65
v_mfma_f32_16x16x32_bf16 v[192:195], v[68:71], v[100:103], v[192:195]
ds_read_b64_tr_b16 v[90:91], v15 offset:1024
v_accvgpr_read_b32 v21, a66
v_mfma_f32_16x16x32_bf16 v[196:199], v[68:71], v[108:111], v[196:199]
ds_read_b64_tr_b16 v[92:93], v15 offset:8192
v_accvgpr_read_b32 v29, a67
v_mfma_f32_16x16x32_bf16 v[196:199], v[64:67], v[104:107], v[196:199]
s_add_u32 s72, s69, 15360
buffer_load_dwordx4 v5, s[4:7], s72 offen offset:1024 lds
v_mfma_f32_16x16x32_bf16 v[200:203], v[64:67], v[112:115], v[200:203]
ds_read_b64_tr_b16 v[94:95], v15 offset:9216
v_accvgpr_read_b32 v22, a96
v_mfma_f32_16x16x32_bf16 v[200:203], v[68:71], v[116:119], v[200:203]
ds_read_b128 v[44:47], v19 offset:2048
v_accvgpr_read_b32 v30, a97
v_mfma_f32_16x16x32_bf16 v[204:207], v[68:71], v[124:127], v[204:207]
buffer_store_dwordx4 v[24:27], v1, s[44:47], s80 offen sc1
v_mfma_f32_16x16x32_bf16 v[204:207], v[64:67], v[120:123], v[204:207]
s_waitcnt lgkmcnt(11)
ds_read_b128 v[48:51], v18 offset:4096
v_accvgpr_read_b32 v23, a98
v_mfma_f32_16x16x32_bf16 v[220:223], v[72:75], v[120:123], v[220:223]
s_add_u32 s72, s69, 129024
buffer_load_dwordx4 v4, s[4:7], s72 offen offset:2048 lds
v_mfma_f32_16x16x32_bf16 v[220:223], v[76:79], v[124:127], v[220:223]
v_accvgpr_read_b32 v31, a99
v_mul_f32 v20, s79, v20
v_mfma_f32_16x16x32_bf16 v[216:219], v[76:79], v[116:119], v[216:219]
s_waitcnt vmcnt(19) lgkmcnt(2)
ds_read_b128 v[52:55], v19 offset:4096
v_mul_f32 v28, s79, v28
v_mfma_f32_16x16x32_bf16 v[216:219], v[72:75], v[112:115], v[216:219]
s_barrier
ds_read_b128 v[56:59], v18 offset:6144
v_mul_f32 v21, s79, v21
v_mfma_f32_16x16x32_bf16 v[212:215], v[72:75], v[104:107], v[212:215]
ds_read_b64_tr_b16 v[64:65], v8 offset:16384
ds_read_b64_tr_b16 v[66:67], v8 offset:17408
v_mfma_f32_16x16x32_bf16 v[212:215], v[76:79], v[108:111], v[212:215]
ds_read_b64_tr_b16 v[68:69], v8 offset:24576
v_mul_f32 v29, s79, v29
v_mfma_f32_16x16x32_bf16 v[208:211], v[76:79], v[100:103], v[208:211]
s_add_u32 s72, s69, 144384
buffer_load_dwordx4 v5, s[4:7], s72 offen offset:3072 lds
v_mfma_f32_16x16x32_bf16 v[208:211], v[72:75], v[96:99], v[208:211]
ds_read_b64_tr_b16 v[70:71], v8 offset:25600
v_mul_f32 v22, s79, v22
v_mfma_f32_16x16x32_bf16 v[224:227], v[80:83], v[96:99], v[224:227]
ds_read_b64_tr_b16 v[72:73], v9 offset:16384
v_mul_f32 v30, s79, v30
v_mfma_f32_16x16x32_bf16 v[224:227], v[84:87], v[100:103], v[224:227]
ds_read_b64_tr_b16 v[74:75], v9 offset:17408
v_mul_f32 v23, s79, v23
v_mfma_f32_16x16x32_bf16 v[228:231], v[84:87], v[108:111], v[228:231]
s_add_u32 m0, s63, 135168
v_mul_f32 v31, s79, v31
v_cvt_pk_bf16_f32 v20, v20, v28
v_mfma_f32_16x16x32_bf16 v[228:231], v[80:83], v[104:107], v[228:231]
s_add_u32 s72, s70, 0
buffer_load_dwordx4 v4, s[4:7], s72 offen lds
v_mfma_f32_16x16x32_bf16 v[232:235], v[80:83], v[112:115], v[232:235]
ds_read_b64_tr_b16 v[76:77], v9 offset:24576
v_cvt_pk_bf16_f32 v21, v21, v29
v_mfma_f32_16x16x32_bf16 v[232:235], v[84:87], v[116:119], v[232:235]
ds_read_b128 v[60:63], v19 offset:6144
v_cvt_pk_bf16_f32 v22, v22, v30
v_mfma_f32_16x16x32_bf16 v[236:239], v[84:87], v[124:127], v[236:239]
ds_read_b64_tr_b16 v[78:79], v9 offset:25600
v_cvt_pk_bf16_f32 v23, v23, v31
v_mfma_f32_16x16x32_bf16 v[236:239], v[80:83], v[120:123], v[236:239]
s_add_u32 s80, s77, 1024
buffer_store_dwordx4 v[20:23], v1, s[44:47], s80 offen sc1
v_mfma_f32_16x16x32_bf16 v[252:255], v[88:91], v[120:123], v[252:255]
s_add_u32 s72, s70, 15360
buffer_load_dwordx4 v5, s[4:7], s72 offen offset:1024 lds
v_mfma_f32_16x16x32_bf16 v[252:255], v[92:95], v[124:127], v[252:255]
ds_read_b64_tr_b16 v[80:81], v10 offset:16384
v_accvgpr_read_b32 v24, a176
v_mfma_f32_16x16x32_bf16 v[248:251], v[92:95], v[116:119], v[248:251]
ds_read_b64_tr_b16 v[82:83], v10 offset:17408
v_accvgpr_read_b32 v28, a177
v_mfma_f32_16x16x32_bf16 v[248:251], v[88:91], v[112:115], v[248:251]
v_accvgpr_read_b32 v25, a178
v_accvgpr_read_b32 v29, a179
v_mfma_f32_16x16x32_bf16 v[244:247], v[88:91], v[104:107], v[244:247]
ds_read_b64_tr_b16 v[84:85], v10 offset:24576
v_accvgpr_read_b32 v26, a180
v_mfma_f32_16x16x32_bf16 v[244:247], v[92:95], v[108:111], v[244:247]
ds_read_b64_tr_b16 v[86:87], v10 offset:25600
v_accvgpr_read_b32 v30, a181
v_mfma_f32_16x16x32_bf16 v[240:243], v[92:95], v[100:103], v[240:243]
s_add_u32 s72, s70, 129024
buffer_load_dwordx4 v4, s[4:7], s72 offen offset:2048 lds
v_mfma_f32_16x16x32_bf16 v[240:243], v[88:91], v[96:99], v[240:243]
s_waitcnt lgkmcnt(5)
v_accvgpr_read_b32 v27, a182
v_accvgpr_read_b32 v31, a183
v_mfma_f32_16x16x32_bf16 v[128:131], v[64:67], v[32:35], v[128:131]
ds_read_b64_tr_b16 v[88:89], v11 offset:16384
v_cvt_pk_bf16_f32 v24, v24, v28
v_mfma_f32_16x16x32_bf16 v[128:131], v[68:71], v[36:39], v[128:131]
ds_read_b64_tr_b16 v[90:91], v11 offset:17408
v_cvt_pk_bf16_f32 v25, v25, v29
v_mfma_f32_16x16x32_bf16 v[132:135], v[68:71], v[44:47], v[132:135]
v_cvt_pk_bf16_f32 v26, v26, v30
v_cvt_pk_bf16_f32 v27, v27, v31
v_mfma_f32_16x16x32_bf16 v[132:135], v[64:67], v[40:43], v[132:135]
s_add_u32 s72, s70, 144384
buffer_load_dwordx4 v5, s[4:7], s72 offen offset:3072 lds
v_mfma_f32_16x16x32_bf16 v[136:139], v[64:67], v[48:51], v[136:139]
s_add_u32 s80, s78, 33792
ds_read_b64_tr_b16 v[92:93], v11 offset:24576
v_mfma_f32_16x16x32_bf16 v[136:139], v[68:71], v[52:55], v[136:139]
s_lshl_b32 s71, s73, 12
buffer_store_dwordx4 v[24:27], v1, s[44:47], s80 offen sc1
v_mfma_f32_16x16x32_bf16 v[140:143], v[68:71], v[60:63], v[140:143]
s_add_u32 s71, s71, s66
ds_read_b64_tr_b16 v[94:95], v11 offset:25600
v_mfma_f32_16x16x32_bf16 v[140:143], v[64:67], v[56:59], v[140:143]
s_waitcnt lgkmcnt(8)
v_mfma_f32_16x16x32_bf16 v[156:159], v[72:75], v[56:59], v[156:159]
s_add_u32 m0, s64, 0
ds_read_b64_tr_b16 v[64:65], v12 offset:16384
v_mfma_f32_16x16x32_bf16 v[156:159], v[76:79], v[60:63], v[156:159]
s_add_u32 s72, s71, 0
buffer_load_dwordx4 v6, s[12:15], s72 offen lds
v_mfma_f32_16x16x32_bf16 v[152:155], v[76:79], v[52:55], v[152:155]
s_add_u32 s73, s62, 7
ds_read_b64_tr_b16 v[66:67], v12 offset:17408
v_mfma_f32_16x16x32_bf16 v[152:155], v[72:75], v[48:51], v[152:155]
s_add_u32 s70, s73, s65
v_mfma_f32_16x16x32_bf16 v[148:151], v[72:75], v[40:43], v[148:151]
s_and_b32 s70, s70, 3
ds_read_b64_tr_b16 v[68:69], v12 offset:24576
v_accvgpr_read_b32 v20, a68
v_mfma_f32_16x16x32_bf16 v[148:151], v[76:79], v[44:47], v[148:151]
s_and_b32 s73, s73, 12
ds_read_b64_tr_b16 v[70:71], v12 offset:25600
v_accvgpr_read_b32 v28, a69
v_mfma_f32_16x16x32_bf16 v[144:147], v[76:79], v[36:39], v[144:147]
s_add_u32 s72, s71, 31744
buffer_load_dwordx4 v6, s[12:15], s72 offen offset:1024 lds
v_mfma_f32_16x16x32_bf16 v[144:147], v[72:75], v[32:35], v[144:147]
s_waitcnt lgkmcnt(8)
v_accvgpr_read_b32 v21, a70
v_accvgpr_read_b32 v29, a71
v_mfma_f32_16x16x32_bf16 v[160:163], v[80:83], v[32:35], v[160:163]
s_or_b32 s73, s73, s70
ds_read_b64_tr_b16 v[72:73], v13 offset:16384
v_accvgpr_read_b32 v22, a100
v_mfma_f32_16x16x32_bf16 v[160:163], v[84:87], v[36:39], v[160:163]
s_lshl_b32 s73, s73, 7
ds_read_b64_tr_b16 v[74:75], v13 offset:17408
v_accvgpr_read_b32 v30, a101
v_mfma_f32_16x16x32_bf16 v[164:167], v[84:87], v[44:47], v[164:167]
s_add_u32 s69, s73, s67
v_accvgpr_read_b32 v23, a102
v_accvgpr_read_b32 v31, a103
v_mfma_f32_16x16x32_bf16 v[164:167], v[80:83], v[40:43], v[164:167]
s_add_u32 s72, s71, 63488
buffer_load_dwordx4 v7, s[12:15], s72 offen offset:2048 lds
v_mfma_f32_16x16x32_bf16 v[168:171], v[80:83], v[48:51], v[168:171]
s_waitcnt vmcnt(19)
ds_read_b64_tr_b16 v[76:77], v13 offset:24576
v_mul_f32 v20, s79, v20
v_mfma_f32_16x16x32_bf16 v[168:171], v[84:87], v[52:55], v[168:171]
s_add_u32 s70, s73, s68
ds_read_b128 v[96:99], v18 offset:32768
v_mul_f32 v28, s79, v28
v_mfma_f32_16x16x32_bf16 v[172:175], v[84:87], v[60:63], v[172:175]
ds_read_b64_tr_b16 v[78:79], v13 offset:25600
v_mul_f32 v21, s79, v21
v_mfma_f32_16x16x32_bf16 v[172:175], v[80:83], v[56:59], v[172:175]
s_waitcnt lgkmcnt(9)
ds_read_b128 v[100:103], v19 offset:32768
v_mul_f32 v29, s79, v29
v_mfma_f32_16x16x32_bf16 v[188:191], v[88:91], v[56:59], v[188:191]
s_add_u32 s72, s71, 95232
buffer_load_dwordx4 v7, s[12:15], s72 offen offset:3072 lds
v_mfma_f32_16x16x32_bf16 v[188:191], v[92:95], v[60:63], v[188:191]
ds_read_b64_tr_b16 v[80:81], v14 offset:16384
v_mul_f32 v22, s79, v22
v_mfma_f32_16x16x32_bf16 v[184:187], v[92:95], v[52:55], v[184:187]
ds_read_b64_tr_b16 v[82:83], v14 offset:17408
v_mul_f32 v30, s79, v30
v_mfma_f32_16x16x32_bf16 v[184:187], v[88:91], v[48:51], v[184:187]
v_mul_f32 v23, s79, v23
v_mul_f32 v31, s79, v31
v_mfma_f32_16x16x32_bf16 v[180:183], v[88:91], v[40:43], v[180:183]
ds_read_b64_tr_b16 v[84:85], v14 offset:24576
v_cvt_pk_bf16_f32 v20, v20, v28
v_mfma_f32_16x16x32_bf16 v[180:183], v[92:95], v[44:47], v[180:183]
s_add_u32 m0, s63, 65536
ds_read_b64_tr_b16 v[86:87], v14 offset:25600
v_cvt_pk_bf16_f32 v21, v21, v29
v_mfma_f32_16x16x32_bf16 v[176:179], v[92:95], v[36:39], v[176:179]
s_add_u32 s72, s69, 0
buffer_load_dwordx4 v4, s[4:7], s72 offen lds
v_mfma_f32_16x16x32_bf16 v[176:179], v[88:91], v[32:35], v[176:179]
s_waitcnt lgkmcnt(10)
ds_read_b128 v[104:107], v18 offset:34816
v_cvt_pk_bf16_f32 v22, v22, v30
v_mfma_f32_16x16x32_bf16 v[192:195], v[64:67], v[32:35], v[192:195]
ds_read_b64_tr_b16 v[88:89], v15 offset:16384
v_cvt_pk_bf16_f32 v23, v23, v31
v_mfma_f32_16x16x32_bf16 v[192:195], v[68:71], v[36:39], v[192:195]
s_add_u32 s80, s77, 5120
ds_read_b64_tr_b16 v[90:91], v15 offset:17408
v_mfma_f32_16x16x32_bf16 v[196:199], v[68:71], v[44:47], v[196:199]
ds_read_b64_tr_b16 v[92:93], v15 offset:24576
v_accvgpr_read_b32 v24, a184
v_mfma_f32_16x16x32_bf16 v[196:199], v[64:67], v[40:43], v[196:199]
s_add_u32 s72, s69, 15360
buffer_load_dwordx4 v5, s[4:7], s72 offen offset:1024 lds
v_mfma_f32_16x16x32_bf16 v[200:203], v[64:67], v[48:51], v[200:203]
ds_read_b64_tr_b16 v[94:95], v15 offset:25600
v_accvgpr_read_b32 v28, a185
v_mfma_f32_16x16x32_bf16 v[200:203], v[68:71], v[52:55], v[200:203]
ds_read_b128 v[108:111], v19 offset:34816
v_accvgpr_read_b32 v25, a186
v_mfma_f32_16x16x32_bf16 v[204:207], v[68:71], v[60:63], v[204:207]
buffer_store_dwordx4 v[20:23], v1, s[44:47], s80 offen sc1
v_mfma_f32_16x16x32_bf16 v[204:207], v[64:67], v[56:59], v[204:207]
s_waitcnt lgkmcnt(11)
ds_read_b128 v[112:115], v18 offset:36864
v_accvgpr_read_b32 v29, a187
v_mfma_f32_16x16x32_bf16 v[220:223], v[72:75], v[56:59], v[220:223]
s_add_u32 s72, s69, 129024
buffer_load_dwordx4 v4, s[4:7], s72 offen offset:2048 lds
v_mfma_f32_16x16x32_bf16 v[220:223], v[76:79], v[60:63], v[220:223]
v_accvgpr_read_b32 v26, a188
v_accvgpr_read_b32 v30, a189
v_mfma_f32_16x16x32_bf16 v[216:219], v[76:79], v[52:55], v[216:219]
s_waitcnt vmcnt(20) lgkmcnt(2)
ds_read_b128 v[116:119], v19 offset:36864
v_accvgpr_read_b32 v27, a190
v_mfma_f32_16x16x32_bf16 v[216:219], v[72:75], v[48:51], v[216:219]
s_barrier
ds_read_b128 v[120:123], v18 offset:38912
v_accvgpr_read_b32 v31, a191
v_mfma_f32_16x16x32_bf16 v[212:215], v[72:75], v[40:43], v[212:215]
ds_read_b64_tr_b16 v[64:65], v8 offset:32768
ds_read_b64_tr_b16 v[66:67], v8 offset:33792
v_mfma_f32_16x16x32_bf16 v[212:215], v[76:79], v[44:47], v[212:215]
ds_read_b64_tr_b16 v[68:69], v8 offset:40960
v_cvt_pk_bf16_f32 v24, v24, v28
v_mfma_f32_16x16x32_bf16 v[208:211], v[76:79], v[36:39], v[208:211]
s_add_u32 s72, s69, 144384
buffer_load_dwordx4 v5, s[4:7], s72 offen offset:3072 lds
v_mfma_f32_16x16x32_bf16 v[208:211], v[72:75], v[32:35], v[208:211]
ds_read_b64_tr_b16 v[70:71], v8 offset:41984
v_cvt_pk_bf16_f32 v25, v25, v29
v_mfma_f32_16x16x32_bf16 v[224:227], v[80:83], v[32:35], v[224:227]
ds_read_b64_tr_b16 v[72:73], v9 offset:32768
v_cvt_pk_bf16_f32 v26, v26, v30
v_mfma_f32_16x16x32_bf16 v[224:227], v[84:87], v[36:39], v[224:227]
ds_read_b64_tr_b16 v[74:75], v9 offset:33792
v_cvt_pk_bf16_f32 v27, v27, v31
v_mfma_f32_16x16x32_bf16 v[228:231], v[84:87], v[44:47], v[228:231]
s_add_u32 m0, s63, 69632
v_mfma_f32_16x16x32_bf16 v[228:231], v[80:83], v[40:43], v[228:231]
s_add_u32 s72, s70, 0
buffer_load_dwordx4 v4, s[4:7], s72 offen lds
v_mfma_f32_16x16x32_bf16 v[232:235], v[80:83], v[48:51], v[232:235]
s_add_u32 s80, s78, 41984
ds_read_b64_tr_b16 v[76:77], v9 offset:40960
v_mfma_f32_16x16x32_bf16 v[232:235], v[84:87], v[52:55], v[232:235]
ds_read_b128 v[124:127], v19 offset:38912
v_mfma_f32_16x16x32_bf16 v[236:239], v[84:87], v[60:63], v[236:239]
ds_read_b64_tr_b16 v[78:79], v9 offset:41984
v_mfma_f32_16x16x32_bf16 v[236:239], v[80:83], v[56:59], v[236:239]
buffer_store_dwordx4 v[24:27], v1, s[44:47], s80 offen sc1
v_mfma_f32_16x16x32_bf16 v[252:255], v[88:91], v[56:59], v[252:255]
s_add_u32 s72, s70, 15360
buffer_load_dwordx4 v5, s[4:7], s72 offen offset:1024 lds
v_mfma_f32_16x16x32_bf16 v[252:255], v[92:95], v[60:63], v[252:255]
ds_read_b64_tr_b16 v[80:81], v10 offset:32768
v_accvgpr_read_b32 v20, a72
v_mfma_f32_16x16x32_bf16 v[248:251], v[92:95], v[52:55], v[248:251]
ds_read_b64_tr_b16 v[82:83], v10 offset:33792
v_accvgpr_read_b32 v28, a73
v_mfma_f32_16x16x32_bf16 v[248:251], v[88:91], v[48:51], v[248:251]
v_accvgpr_read_b32 v21, a74
v_accvgpr_read_b32 v29, a75
v_mfma_f32_16x16x32_bf16 v[244:247], v[88:91], v[40:43], v[244:247]
ds_read_b64_tr_b16 v[84:85], v10 offset:40960
v_accvgpr_read_b32 v22, a104
v_mfma_f32_16x16x32_bf16 v[244:247], v[92:95], v[44:47], v[244:247]
ds_read_b64_tr_b16 v[86:87], v10 offset:41984
v_accvgpr_read_b32 v30, a105
v_mfma_f32_16x16x32_bf16 v[240:243], v[92:95], v[36:39], v[240:243]
s_add_u32 s72, s70, 129024
buffer_load_dwordx4 v4, s[4:7], s72 offen offset:2048 lds
v_mfma_f32_16x16x32_bf16 v[240:243], v[88:91], v[32:35], v[240:243]
s_waitcnt lgkmcnt(5)
v_accvgpr_read_b32 v23, a106
v_accvgpr_read_b32 v31, a107
v_mfma_f32_16x16x32_bf16 v[128:131], v[64:67], v[96:99], v[128:131]
s_lshr_b32 s75, s93, 4
ds_read_b64_tr_b16 v[88:89], v11 offset:32768
v_mul_f32 v20, s79, v20
v_mfma_f32_16x16x32_bf16 v[128:131], v[68:71], v[100:103], v[128:131]
s_and_b32 s75, s75, 0x7f00
ds_read_b64_tr_b16 v[90:91], v11 offset:33792
v_mul_f32 v28, s79, v28
v_mfma_f32_16x16x32_bf16 v[132:135], v[68:71], v[108:111], v[132:135]
s_add_u32 s75, s75, LcB1-Lpc0
v_lshrrev_b32 v2, 5, v0
v_lshlrev_b32 v2, 7, v2
v_mfma_f32_16x16x32_bf16 v[132:135], v[64:67], v[104:107], v[132:135]
s_add_u32 s72, s70, 144384
buffer_load_dwordx4 v5, s[4:7], s72 offen offset:3072 lds
v_mfma_f32_16x16x32_bf16 v[136:139], v[64:67], v[112:115], v[136:139]
v_add_u32 v2, s75, v2
v_min_u32 v2, Lcode_end-Lpc0, v2
v_mfma_f32_16x16x32_bf16 v[136:139], v[68:71], v[116:119], v[136:139]
s_lshl_b32 s71, s73, 12
global_load_dword v3, v2, s[98:99]
v_mfma_f32_16x16x32_bf16 v[140:143], v[68:71], v[124:127], v[140:143]
s_add_u32 s71, s71, s66
ds_read_b64_tr_b16 v[92:93], v11 offset:40960
v_mul_f32 v21, s79, v21
v_mfma_f32_16x16x32_bf16 v[140:143], v[64:67], v[120:123], v[140:143]
s_waitcnt lgkmcnt(7)
ds_read_b64_tr_b16 v[94:95], v11 offset:41984
v_mul_f32 v29, s79, v29
v_mfma_f32_16x16x32_bf16 v[156:159], v[72:75], v[120:123], v[156:159]
s_add_u32 m0, s64, 16384
ds_read_b64_tr_b16 v[64:65], v12 offset:32768
v_mul_f32 v22, s79, v22
v_mfma_f32_16x16x32_bf16 v[156:159], v[76:79], v[124:127], v[156:159]
s_add_u32 s72, s71, 0
buffer_load_dwordx4 v6, s[12:15], s72 offen lds
v_mfma_f32_16x16x32_bf16 v[152:155], v[76:79], v[116:119], v[152:155]
s_add_u32 s73, s62, 8
ds_read_b64_tr_b16 v[66:67], v12 offset:33792
v_mul_f32 v30, s79, v30
v_mfma_f32_16x16x32_bf16 v[152:155], v[72:75], v[112:115], v[152:155]
s_add_u32 s70, s73, s65
v_mul_f32 v23, s79, v23
v_mul_f32 v31, s79, v31
v_mfma_f32_16x16x32_bf16 v[148:151], v[72:75], v[104:107], v[148:151]
s_and_b32 s70, s70, 3
ds_read_b64_tr_b16 v[68:69], v12 offset:40960
v_cvt_pk_bf16_f32 v20, v20, v28
v_mfma_f32_16x16x32_bf16 v[148:151], v[76:79], v[108:111], v[148:151]
s_and_b32 s73, s73, 12
ds_read_b64_tr_b16 v[70:71], v12 offset:41984
v_cvt_pk_bf16_f32 v21, v21, v29
v_mfma_f32_16x16x32_bf16 v[144:147], v[76:79], v[100:103], v[144:147]
s_add_u32 s72, s71, 31744
buffer_load_dwordx4 v6, s[12:15], s72 offen offset:1024 lds
v_mfma_f32_16x16x32_bf16 v[144:147], v[72:75], v[96:99], v[144:147]
s_waitcnt lgkmcnt(8)
v_cvt_pk_bf16_f32 v22, v22, v30
v_cvt_pk_bf16_f32 v23, v23, v31
v_mfma_f32_16x16x32_bf16 v[160:163], v[80:83], v[96:99], v[160:163]
s_or_b32 s73, s73, s70
ds_read_b64_tr_b16 v[72:73], v13 offset:32768
v_accvgpr_read_b32 v24, a192
v_mfma_f32_16x16x32_bf16 v[160:163], v[84:87], v[100:103], v[160:163]
s_lshl_b32 s73, s73, 7
ds_read_b64_tr_b16 v[74:75], v13 offset:33792
v_accvgpr_read_b32 v28, a193
v_mfma_f32_16x16x32_bf16 v[164:167], v[84:87], v[108:111], v[164:167]
s_add_u32 s69, s73, s67
v_accvgpr_read_b32 v25, a194
v_accvgpr_read_b32 v29, a195
v_mfma_f32_16x16x32_bf16 v[164:167], v[80:83], v[104:107], v[164:167]
s_add_u32 s72, s71, 63488
buffer_load_dwordx4 v7, s[12:15], s72 offen offset:2048 lds
v_mfma_f32_16x16x32_bf16 v[168:171], v[80:83], v[112:115], v[168:171]
s_waitcnt vmcnt(19)
ds_read_b64_tr_b16 v[76:77], v13 offset:40960
v_accvgpr_read_b32 v26, a196
v_mfma_f32_16x16x32_bf16 v[168:171], v[84:87], v[116:119], v[168:171]
s_add_u32 s70, s73, s68
ds_read_b128 v[32:35], v16 offset:0
v_accvgpr_read_b32 v30, a197
v_mfma_f32_16x16x32_bf16 v[172:175], v[84:87], v[124:127], v[172:175]
s_add_u32 s80, s77, 9216
ds_read_b64_tr_b16 v[78:79], v13 offset:41984
v_accvgpr_read_b32 v27, a198
v_mfma_f32_16x16x32_bf16 v[172:175], v[80:83], v[120:123], v[172:175]
s_waitcnt lgkmcnt(9)
ds_read_b128 v[36:39], v17 offset:0
v_accvgpr_read_b32 v31, a199
v_mfma_f32_16x16x32_bf16 v[188:191], v[88:91], v[120:123], v[188:191]
s_add_u32 s72, s71, 95232
buffer_load_dwordx4 v7, s[12:15], s72 offen offset:3072 lds
v_mfma_f32_16x16x32_bf16 v[188:191], v[92:95], v[124:127], v[188:191]
ds_read_b64_tr_b16 v[80:81], v14 offset:32768
v_cvt_pk_bf16_f32 v24, v24, v28
v_mfma_f32_16x16x32_bf16 v[184:187], v[92:95], v[116:119], v[184:187]
ds_read_b64_tr_b16 v[82:83], v14 offset:33792
v_cvt_pk_bf16_f32 v25, v25, v29
v_mfma_f32_16x16x32_bf16 v[184:187], v[88:91], v[112:115], v[184:187]
buffer_store_dwordx4 v[20:23], v1, s[44:47], s80 offen sc1
v_mfma_f32_16x16x32_bf16 v[180:183], v[88:91], v[104:107], v[180:183]
ds_read_b64_tr_b16 v[84:85], v14 offset:40960
v_cvt_pk_bf16_f32 v26, v26, v30
v_mfma_f32_16x16x32_bf16 v[180:183], v[92:95], v[108:111], v[180:183]
s_add_u32 m0, s63, 98304
ds_read_b64_tr_b16 v[86:87], v14 offset:41984
v_cvt_pk_bf16_f32 v27, v27, v31
v_mfma_f32_16x16x32_bf16 v[176:179], v[92:95], v[100:103], v[176:179]
s_add_u32 s72, s69, 0
buffer_load_dwordx4 v4, s[4:7], s72 offen lds
v_mfma_f32_16x16x32_bf16 v[176:179], v[88:91], v[96:99], v[176:179]
s_waitcnt lgkmcnt(10)
ds_read_b128 v[40:43], v16 offset:2048
v_mfma_f32_16x16x32_bf16 v[192:195], v[64:67], v[96:99], v[192:195]
s_add_u32 s80, s78, 2048
ds_read_b64_tr_b16 v[88:89], v15 offset:32768
v_mfma_f32_16x16x32_bf16 v[192:195], v[68:71], v[100:103], v[192:195]
ds_read_b64_tr_b16 v[90:91], v15 offset:33792
v_mfma_f32_16x16x32_bf16 v[196:199], v[68:71], v[108:111], v[196:199]
ds_read_b64_tr_b16 v[92:93], v15 offset:40960
v_mfma_f32_16x16x32_bf16 v[196:199], v[64:67], v[104:107], v[196:199]
s_add_u32 s72, s69, 15360
buffer_load_dwordx4 v5, s[4:7], s72 offen offset:1024 lds
v_mfma_f32_16x16x32_bf16 v[200:203], v[64:67], v[112:115], v[200:203]
ds_read_b64_tr_b16 v[94:95], v15 offset:41984
v_accvgpr_read_b32 v20, a76
v_mfma_f32_16x16x32_bf16 v[200:203], v[68:71], v[116:119], v[200:203]
ds_read_b128 v[44:47], v17 offset:2048
v_accvgpr_read_b32 v28, a77
v_mfma_f32_16x16x32_bf16 v[204:207], v[68:71], v[124:127], v[204:207]
buffer_store_dwordx4 v[24:27], v1, s[44:47], s80 offen sc1
v_mfma_f32_16x16x32_bf16 v[204:207], v[64:67], v[120:123], v[204:207]
s_waitcnt lgkmcnt(11)
ds_read_b128 v[48:51], v16 offset:4096
v_accvgpr_read_b32 v21, a78
v_mfma_f32_16x16x32_bf16 v[220:223], v[72:75], v[120:123], v[220:223]
s_add_u32 s72, s69, 129024
buffer_load_dwordx4 v4, s[4:7], s72 offen offset:2048 lds
v_mfma_f32_16x16x32_bf16 v[220:223], v[76:79], v[124:127], v[220:223]
v_accvgpr_read_b32 v29, a79
v_accvgpr_read_b32 v22, a108
v_mfma_f32_16x16x32_bf16 v[216:219], v[76:79], v[116:119], v[216:219]
s_waitcnt vmcnt(20) lgkmcnt(2)
ds_read_b128 v[52:55], v17 offset:4096
v_accvgpr_read_b32 v30, a109
v_mfma_f32_16x16x32_bf16 v[216:219], v[72:75], v[112:115], v[216:219]
s_barrier
ds_read_b128 v[56:59], v16 offset:6144
v_accvgpr_read_b32 v23, a110
v_mfma_f32_16x16x32_bf16 v[212:215], v[72:75], v[104:107], v[212:215]
ds_read_b64_tr_b16 v[64:65], v8 offset:0
ds_read_b64_tr_b16 v[66:67], v8 offset:1024
v_mfma_f32_16x16x32_bf16 v[212:215], v[76:79], v[108:111], v[212:215]
ds_read_b64_tr_b16 v[68:69], v8 offset:8192
v_accvgpr_read_b32 v31, a111
v_mfma_f32_16x16x32_bf16 v[208:211], v[76:79], v[100:103], v[208:211]
s_add_u32 s72, s69, 144384
buffer_load_dwordx4 v5, s[4:7], s72 offen offset:3072 lds
v_mfma_f32_16x16x32_bf16 v[208:211], v[72:75], v[96:99], v[208:211]
ds_read_b64_tr_b16 v[70:71], v8 offset:9216
v_mul_f32 v20, s79, v20
v_mfma_f32_16x16x32_bf16 v[224:227], v[80:83], v[96:99], v[224:227]
ds_read_b64_tr_b16 v[72:73], v9 offset:0
v_mul_f32 v28, s79, v28
v_mfma_f32_16x16x32_bf16 v[224:227], v[84:87], v[100:103], v[224:227]
ds_read_b64_tr_b16 v[74:75], v9 offset:1024
v_mul_f32 v21, s79, v21
v_mfma_f32_16x16x32_bf16 v[228:231], v[84:87], v[108:111], v[228:231]
s_add_u32 m0, s63, 102400
v_mul_f32 v29, s79, v29
v_mul_f32 v22, s79, v22
v_mfma_f32_16x16x32_bf16 v[228:231], v[80:83], v[104:107], v[228:231]
s_add_u32 s72, s70, 0
buffer_load_dwordx4 v4, s[4:7], s72 offen lds
v_mfma_f32_16x16x32_bf16 v[232:235], v[80:83], v[112:115], v[232:235]
ds_read_b64_tr_b16 v[76:77], v9 offset:8192
v_mul_f32 v30, s79, v30
v_mfma_f32_16x16x32_bf16 v[232:235], v[84:87], v[116:119], v[232:235]
ds_read_b128 v[60:63], v17 offset:6144
v_mul_f32 v23, s79, v23
v_mfma_f32_16x16x32_bf16 v[236:239], v[84:87], v[124:127], v[236:239]
ds_read_b64_tr_b16 v[78:79], v9 offset:9216
v_mul_f32 v31, s79, v31
v_mfma_f32_16x16x32_bf16 v[236:239], v[80:83], v[120:123], v[236:239]
v_cvt_pk_bf16_f32 v20, v20, v28
v_cvt_pk_bf16_f32 v21, v21, v29
v_mfma_f32_16x16x32_bf16 v[252:255], v[88:91], v[120:123], v[252:255]
s_add_u32 s72, s70, 15360
buffer_load_dwordx4 v5, s[4:7], s72 offen offset:1024 lds
v_mfma_f32_16x16x32_bf16 v[252:255], v[92:95], v[124:127], v[252:255]
ds_read_b64_tr_b16 v[80:81], v10 offset:0
v_cvt_pk_bf16_f32 v22, v22, v30
v_mfma_f32_16x16x32_bf16 v[248:251], v[92:95], v[116:119], v[248:251]
ds_read_b64_tr_b16 v[82:83], v10 offset:1024
v_cvt_pk_bf16_f32 v23, v23, v31
v_mfma_f32_16x16x32_bf16 v[248:251], v[88:91], v[112:115], v[248:251]
s_add_u32 s80, s77, 13312
buffer_store_dwordx4 v[20:23], v1, s[44:47], s80 offen sc1
v_mfma_f32_16x16x32_bf16 v[244:247], v[88:91], v[104:107], v[244:247]
ds_read_b64_tr_b16 v[84:85], v10 offset:8192
v_accvgpr_read_b32 v24, a200
v_mfma_f32_16x16x32_bf16 v[244:247], v[92:95], v[108:111], v[244:247]
ds_read_b64_tr_b16 v[86:87], v10 offset:9216
v_accvgpr_read_b32 v28, a201
v_mfma_f32_16x16x32_bf16 v[240:243], v[92:95], v[100:103], v[240:243]
s_add_u32 s72, s70, 129024
buffer_load_dwordx4 v4, s[4:7], s72 offen offset:2048 lds
v_mfma_f32_16x16x32_bf16 v[240:243], v[88:91], v[96:99], v[240:243]
s_waitcnt lgkmcnt(5)
v_accvgpr_read_b32 v25, a202
v_accvgpr_read_b32 v29, a203
v_mfma_f32_16x16x32_bf16 v[128:131], v[64:67], v[32:35], v[128:131]
ds_read_b64_tr_b16 v[88:89], v11 offset:0
v_accvgpr_read_b32 v26, a204
v_mfma_f32_16x16x32_bf16 v[128:131], v[68:71], v[36:39], v[128:131]
ds_read_b64_tr_b16 v[90:91], v11 offset:1024
v_accvgpr_read_b32 v30, a205
v_mfma_f32_16x16x32_bf16 v[132:135], v[68:71], v[44:47], v[132:135]
v_accvgpr_read_b32 v27, a206
v_accvgpr_read_b32 v31, a207
v_mfma_f32_16x16x32_bf16 v[132:135], v[64:67], v[40:43], v[132:135]
s_add_u32 s72, s70, 144384
buffer_load_dwordx4 v5, s[4:7], s72 offen offset:3072 lds
v_mfma_f32_16x16x32_bf16 v[136:139], v[64:67], v[48:51], v[136:139]
ds_read_b64_tr_b16 v[92:93], v11 offset:8192
v_cvt_pk_bf16_f32 v24, v24, v28
v_mfma_f32_16x16x32_bf16 v[136:139], v[68:71], v[52:55], v[136:139]
s_lshl_b32 s71, s73, 12
v_cvt_pk_bf16_f32 v25, v25, v29
v_cvt_pk_bf16_f32 v26, v26, v30
v_mfma_f32_16x16x32_bf16 v[140:143], v[68:71], v[60:63], v[140:143]
s_add_u32 s71, s71, s66
ds_read_b64_tr_b16 v[94:95], v11 offset:9216
v_cvt_pk_bf16_f32 v27, v27, v31
v_mfma_f32_16x16x32_bf16 v[140:143], v[64:67], v[56:59], v[140:143]
s_waitcnt lgkmcnt(8)
v_mfma_f32_16x16x32_bf16 v[156:159], v[72:75], v[56:59], v[156:159]
s_add_u32 m0, s64, 32768
ds_read_b64_tr_b16 v[64:65], v12 offset:0
v_mfma_f32_16x16x32_bf16 v[156:159], v[76:79], v[60:63], v[156:159]
s_add_u32 s72, s71, 0
buffer_load_dwordx4 v6, s[12:15], s72 offen lds
v_mfma_f32_16x16x32_bf16 v[152:155], v[76:79], v[52:55], v[152:155]
s_add_u32 s73, s62, 9
ds_read_b64_tr_b16 v[66:67], v12 offset:1024
v_mfma_f32_16x16x32_bf16 v[152:155], v[72:75], v[48:51], v[152:155]
s_add_u32 s70, s73, s65
v_mfma_f32_16x16x32_bf16 v[148:151], v[72:75], v[40:43], v[148:151]
s_and_b32 s70, s70, 3
ds_read_b64_tr_b16 v[68:69], v12 offset:8192
v_mfma_f32_16x16x32_bf16 v[148:151], v[76:79], v[44:47], v[148:151]
s_and_b32 s73, s73, 12
ds_read_b64_tr_b16 v[70:71], v12 offset:9216
v_mfma_f32_16x16x32_bf16 v[144:147], v[76:79], v[36:39], v[144:147]
s_add_u32 s72, s71, 31744
buffer_load_dwordx4 v6, s[12:15], s72 offen offset:1024 lds
v_mfma_f32_16x16x32_bf16 v[144:147], v[72:75], v[32:35], v[144:147]
s_waitcnt lgkmcnt(8)
v_mfma_f32_16x16x32_bf16 v[160:163], v[80:83], v[32:35], v[160:163]
s_or_b32 s73, s73, s70
ds_read_b64_tr_b16 v[72:73], v13 offset:0
v_accvgpr_read_b32 v20, a80
v_mfma_f32_16x16x32_bf16 v[160:163], v[84:87], v[36:39], v[160:163]
s_lshl_b32 s73, s73, 7
ds_read_b64_tr_b16 v[74:75], v13 offset:1024
v_accvgpr_read_b32 v28, a81
v_mfma_f32_16x16x32_bf16 v[164:167], v[84:87], v[44:47], v[164:167]
s_add_u32 s69, s73, s67
v_accvgpr_read_b32 v21, a82
v_accvgpr_read_b32 v29, a83
v_mfma_f32_16x16x32_bf16 v[164:167], v[80:83], v[40:43], v[164:167]
s_add_u32 s72, s71, 63488
buffer_load_dwordx4 v7, s[12:15], s72 offen offset:2048 lds
v_mfma_f32_16x16x32_bf16 v[168:171], v[80:83], v[48:51], v[168:171]
s_waitcnt vmcnt(19)
ds_read_b64_tr_b16 v[76:77], v13 offset:8192
v_accvgpr_read_b32 v22, a112
v_mfma_f32_16x16x32_bf16 v[168:171], v[84:87], v[52:55], v[168:171]
s_add_u32 s70, s73, s68
ds_read_b128 v[96:99], v18 offset:0
v_accvgpr_read_b32 v30, a113
v_mfma_f32_16x16x32_bf16 v[172:175], v[84:87], v[60:63], v[172:175]
s_add_u32 s80, s78, 10240
ds_read_b64_tr_b16 v[78:79], v13 offset:9216
v_accvgpr_read_b32 v23, a114
v_mfma_f32_16x16x32_bf16 v[172:175], v[80:83], v[56:59], v[172:175]
s_waitcnt lgkmcnt(9)
ds_read_b128 v[100:103], v19 offset:0
v_accvgpr_read_b32 v31, a115
v_mfma_f32_16x16x32_bf16 v[188:191], v[88:91], v[56:59], v[188:191]
s_add_u32 s72, s71, 95232
buffer_load_dwordx4 v7, s[12:15], s72 offen offset:3072 lds
v_mfma_f32_16x16x32_bf16 v[188:191], v[92:95], v[60:63], v[188:191]
ds_read_b64_tr_b16 v[80:81], v14 offset:0
v_mul_f32 v20, s79, v20
v_mfma_f32_16x16x32_bf16 v[184:187], v[92:95], v[52:55], v[184:187]
ds_read_b64_tr_b16 v[82:83], v14 offset:1024
v_mul_f32 v28, s79, v28
v_mfma_f32_16x16x32_bf16 v[184:187], v[88:91], v[48:51], v[184:187]
buffer_store_dwordx4 v[24:27], v1, s[44:47], s80 offen sc1
v_mfma_f32_16x16x32_bf16 v[180:183], v[88:91], v[40:43], v[180:183]
ds_read_b64_tr_b16 v[84:85], v14 offset:8192
v_mul_f32 v21, s79, v21
v_mfma_f32_16x16x32_bf16 v[180:183], v[92:95], v[44:47], v[180:183]
s_add_u32 m0, s63, 131072
ds_read_b64_tr_b16 v[86:87], v14 offset:9216
v_mul_f32 v29, s79, v29
v_mfma_f32_16x16x32_bf16 v[176:179], v[92:95], v[36:39], v[176:179]
s_add_u32 s72, s69, 0
buffer_load_dwordx4 v4, s[4:7], s72 offen lds
v_mfma_f32_16x16x32_bf16 v[176:179], v[88:91], v[32:35], v[176:179]
s_waitcnt lgkmcnt(10)
ds_read_b128 v[104:107], v18 offset:2048
v_mul_f32 v22, s79, v22
v_mfma_f32_16x16x32_bf16 v[192:195], v[64:67], v[32:35], v[192:195]
ds_read_b64_tr_b16 v[88:89], v15 offset:0
v_mul_f32 v30, s79, v30
v_mfma_f32_16x16x32_bf16 v[192:195], v[68:71], v[36:39], v[192:195]
ds_read_b64_tr_b16 v[90:91], v15 offset:1024
v_mul_f32 v23, s79, v23
v_mfma_f32_16x16x32_bf16 v[196:199], v[68:71], v[44:47], v[196:199]
ds_read_b64_tr_b16 v[92:93], v15 offset:8192
v_mul_f32 v31, s79, v31
v_mfma_f32_16x16x32_bf16 v[196:199], v[64:67], v[40:43], v[196:199]
s_add_u32 s72, s69, 15360
buffer_load_dwordx4 v5, s[4:7], s72 offen offset:1024 lds
v_mfma_f32_16x16x32_bf16 v[200:203], v[64:67], v[48:51], v[200:203]
ds_read_b64_tr_b16 v[94:95], v15 offset:9216
v_cvt_pk_bf16_f32 v20, v20, v28
v_mfma_f32_16x16x32_bf16 v[200:203], v[68:71], v[52:55], v[200:203]
ds_read_b128 v[108:111], v19 offset:2048
v_cvt_pk_bf16_f32 v21, v21, v29
v_mfma_f32_16x16x32_bf16 v[204:207], v[68:71], v[60:63], v[204:207]
v_cvt_pk_bf16_f32 v22, v22, v30
v_cvt_pk_bf16_f32 v23, v23, v31
v_mfma_f32_16x16x32_bf16 v[204:207], v[64:67], v[56:59], v[204:207]
s_waitcnt lgkmcnt(11)
ds_read_b128 v[112:115], v18 offset:4096
v_accvgpr_read_b32 v24, a208
v_mfma_f32_16x16x32_bf16 v[220:223], v[72:75], v[56:59], v[220:223]
s_add_u32 s72, s69, 129024
buffer_load_dwordx4 v4, s[4:7], s72 offen offset:2048 lds
v_mfma_f32_16x16x32_bf16 v[220:223], v[76:79], v[60:63], v[220:223]
s_add_u32 s80, s77, 33792
s_nop 3
s_mov_b64 exec, 0
s_cmp_eq_u32 s58, 0
s_cbranch_scc1 Lstub0
s_cmp_eq_u32 s58, 1
s_cbranch_scc1 Lstub1
s_cmp_eq_u32 s58, 2
s_cbranch_scc1 Lstub2
s_branch Lstub3
Lret:
s_mov_b64 exec, -1
s_nop 3
v_mfma_f32_16x16x32_bf16 v[216:219], v[76:79], v[52:55], v[216:219]
s_waitcnt vmcnt(19) lgkmcnt(2)
ds_read_b128 v[116:119], v19 offset:4096
v_accvgpr_read_b32 v28, a209
v_mfma_f32_16x16x32_bf16 v[216:219], v[72:75], v[48:51], v[216:219]
s_barrier
buffer_store_dwordx4 v[20:23], v1, s[44:47], s80 offen sc1
v_mfma_f32_16x16x32_bf16 v[212:215], v[72:75], v[40:43], v[212:215]
ds_read_b64_tr_b16 v[64:65], v8 offset:16384
ds_read_b64_tr_b16 v[66:67], v8 offset:17408
v_mfma_f32_16x16x32_bf16 v[212:215], v[76:79], v[44:47], v[212:215]
ds_read_b64_tr_b16 v[68:69], v8 offset:24576
v_accvgpr_read_b32 v25, a210
v_mfma_f32_16x16x32_bf16 v[208:211], v[76:79], v[36:39], v[208:211]
s_add_u32 s72, s69, 144384
buffer_load_dwordx4 v5, s[4:7], s72 offen offset:3072 lds
v_mfma_f32_16x16x32_bf16 v[208:211], v[72:75], v[32:35], v[208:211]
ds_read_b64_tr_b16 v[70:71], v8 offset:25600
v_accvgpr_read_b32 v29, a211
v_mfma_f32_16x16x32_bf16 v[224:227], v[80:83], v[32:35], v[224:227]
ds_read_b64_tr_b16 v[72:73], v9 offset:16384
v_accvgpr_read_b32 v26, a212
v_mfma_f32_16x16x32_bf16 v[224:227], v[84:87], v[36:39], v[224:227]
ds_read_b64_tr_b16 v[74:75], v9 offset:17408
v_accvgpr_read_b32 v30, a213
v_mfma_f32_16x16x32_bf16 v[228:231], v[84:87], v[44:47], v[228:231]
s_add_u32 m0, s63, 135168
ds_read_b128 v[120:123], v18 offset:6144
v_accvgpr_read_b32 v27, a214
v_mfma_f32_16x16x32_bf16 v[228:231], v[80:83], v[40:43], v[228:231]
s_add_u32 s72, s70, 0
buffer_load_dwordx4 v4, s[4:7], s72 offen lds
v_mfma_f32_16x16x32_bf16 v[232:235], v[80:83], v[48:51], v[232:235]
ds_read_b64_tr_b16 v[76:77], v9 offset:24576
v_accvgpr_read_b32 v31, a215
v_mfma_f32_16x16x32_bf16 v[232:235], v[84:87], v[52:55], v[232:235]
ds_read_b128 v[124:127], v19 offset:6144
v_cvt_pk_bf16_f32 v24, v24, v28
v_mfma_f32_16x16x32_bf16 v[236:239], v[84:87], v[60:63], v[236:239]
ds_read_b64_tr_b16 v[78:79], v9 offset:25600
v_cvt_pk_bf16_f32 v25, v25, v29
v_mfma_f32_16x16x32_bf16 v[236:239], v[80:83], v[56:59], v[236:239]
v_cvt_pk_bf16_f32 v26, v26, v30
v_cvt_pk_bf16_f32 v27, v27, v31
v_mfma_f32_16x16x32_bf16 v[252:255], v[88:91], v[56:59], v[252:255]
s_add_u32 s72, s70, 15360
buffer_load_dwordx4 v5, s[4:7], s72 offen offset:1024 lds
v_mfma_f32_16x16x32_bf16 v[252:255], v[92:95], v[60:63], v[252:255]
s_add_u32 s80, s78, 34816
ds_read_b64_tr_b16 v[80:81], v10 offset:16384
v_mfma_f32_16x16x32_bf16 v[248:251], v[92:95], v[52:55], v[248:251]
ds_read_b64_tr_b16 v[82:83], v10 offset:17408
v_mfma_f32_16x16x32_bf16 v[248:251], v[88:91], v[48:51], v[248:251]
buffer_store_dwordx4 v[24:27], v1, s[44:47], s80 offen sc1
v_mfma_f32_16x16x32_bf16 v[244:247], v[88:91], v[40:43], v[244:247]
ds_read_b64_tr_b16 v[84:85], v10 offset:24576
v_mfma_f32_16x16x32_bf16 v[244:247], v[92:95], v[44:47], v[244:247]
ds_read_b64_tr_b16 v[86:87], v10 offset:25600
v_accvgpr_read_b32 v20, a84
v_mfma_f32_16x16x32_bf16 v[240:243], v[92:95], v[36:39], v[240:243]
s_add_u32 s72, s70, 129024
buffer_load_dwordx4 v4, s[4:7], s72 offen offset:2048 lds
v_mfma_f32_16x16x32_bf16 v[240:243], v[88:91], v[32:35], v[240:243]
s_waitcnt lgkmcnt(5)
v_accvgpr_read_b32 v28, a85
v_accvgpr_read_b32 v21, a86
v_mfma_f32_16x16x32_bf16 v[128:131], v[64:67], v[96:99], v[128:131]
ds_read_b64_tr_b16 v[88:89], v11 offset:16384
v_accvgpr_read_b32 v29, a87
v_mfma_f32_16x16x32_bf16 v[128:131], v[68:71], v[100:103], v[128:131]
ds_read_b64_tr_b16 v[90:91], v11 offset:17408
v_accvgpr_read_b32 v22, a116
v_mfma_f32_16x16x32_bf16 v[132:135], v[68:71], v[108:111], v[132:135]
v_accvgpr_read_b32 v30, a117
v_accvgpr_read_b32 v23, a118
v_mfma_f32_16x16x32_bf16 v[132:135], v[64:67], v[104:107], v[132:135]
s_add_u32 s72, s70, 144384
buffer_load_dwordx4 v5, s[4:7], s72 offen offset:3072 lds
v_mfma_f32_16x16x32_bf16 v[136:139], v[64:67], v[112:115], v[136:139]
ds_read_b64_tr_b16 v[92:93], v11 offset:24576
v_accvgpr_read_b32 v31, a119
v_mfma_f32_16x16x32_bf16 v[136:139], v[68:71], v[116:119], v[136:139]
s_lshl_b32 s71, s73, 12
v_mul_f32 v20, s79, v20
v_mul_f32 v28, s79, v28
v_mfma_f32_16x16x32_bf16 v[140:143], v[68:71], v[124:127], v[140:143]
s_add_u32 s71, s71, s66
ds_read_b64_tr_b16 v[94:95], v11 offset:25600
v_mul_f32 v21, s79, v21
v_mfma_f32_16x16x32_bf16 v[140:143], v[64:67], v[120:123], v[140:143]
s_waitcnt lgkmcnt(8)
v_mul_f32 v29, s79, v29
v_mul_f32 v22, s79, v22
v_mfma_f32_16x16x32_bf16 v[156:159], v[72:75], v[120:123], v[156:159]
s_add_u32 m0, s64, 0
ds_read_b64_tr_b16 v[64:65], v12 offset:16384
v_mul_f32 v30, s79, v30
v_mfma_f32_16x16x32_bf16 v[156:159], v[76:79], v[124:127], v[156:159]
s_add_u32 s72, s71, 0
buffer_load_dwordx4 v6, s[12:15], s72 offen lds
v_mfma_f32_16x16x32_bf16 v[152:155], v[76:79], v[116:119], v[152:155]
s_add_u32 s73, s62, 10
ds_read_b64_tr_b16 v[66:67], v12 offset:17408
v_mul_f32 v23, s79, v23
v_mfma_f32_16x16x32_bf16 v[152:155], v[72:75], v[112:115], v[152:155]
s_add_u32 s70, s73, s65
v_mul_f32 v31, s79, v31
v_cvt_pk_bf16_f32 v20, v20, v28
v_mfma_f32_16x16x32_bf16 v[148:151], v[72:75], v[104:107], v[148:151]
s_and_b32 s70, s70, 3
ds_read_b64_tr_b16 v[68:69], v12 offset:24576
v_cvt_pk_bf16_f32 v21, v21, v29
v_mfma_f32_16x16x32_bf16 v[148:151], v[76:79], v[108:111], v[148:151]
s_and_b32 s73, s73, 12
ds_read_b64_tr_b16 v[70:71], v12 offset:25600
v_cvt_pk_bf16_f32 v22, v22, v30
v_mfma_f32_16x16x32_bf16 v[144:147], v[76:79], v[100:103], v[144:147]
s_add_u32 s72, s71, 31744
buffer_load_dwordx4 v6, s[12:15], s72 offen offset:1024 lds
v_mfma_f32_16x16x32_bf16 v[144:147], v[72:75], v[96:99], v[144:147]
s_waitcnt lgkmcnt(8)
v_cvt_pk_bf16_f32 v23, v23, v31
v_mfma_f32_16x16x32_bf16 v[160:163], v[80:83], v[96:99], v[160:163]
s_or_b32 s73, s73, s70
ds_read_b64_tr_b16 v[72:73], v13 offset:16384
v_mfma_f32_16x16x32_bf16 v[160:163], v[84:87], v[100:103], v[160:163]
s_lshl_b32 s73, s73, 7
ds_read_b64_tr_b16 v[74:75], v13 offset:17408
v_mfma_f32_16x16x32_bf16 v[164:167], v[84:87], v[108:111], v[164:167]
s_add_u32 s69, s73, s67
v_mfma_f32_16x16x32_bf16 v[164:167], v[80:83], v[104:107], v[164:167]
s_add_u32 s72, s71, 63488
buffer_load_dwordx4 v7, s[12:15], s72 offen offset:2048 lds
v_mfma_f32_16x16x32_bf16 v[168:171], v[80:83], v[112:115], v[168:171]
s_waitcnt vmcnt(18)
ds_read_b64_tr_b16 v[76:77], v13 offset:24576
v_accvgpr_read_b32 v24, a216
v_mfma_f32_16x16x32_bf16 v[168:171], v[84:87], v[116:119], v[168:171]
s_add_u32 s70, s73, s68
ds_read_b128 v[32:35], v18 offset:32768
v_accvgpr_read_b32 v28, a217
v_mfma_f32_16x16x32_bf16 v[172:175], v[84:87], v[124:127], v[172:175]
s_add_u32 s80, s77, 37888
ds_read_b64_tr_b16 v[78:79], v13 offset:25600
v_accvgpr_read_b32 v25, a218
v_mfma_f32_16x16x32_bf16 v[172:175], v[80:83], v[120:123], v[172:175]
s_waitcnt lgkmcnt(9)
ds_read_b128 v[36:39], v19 offset:32768
v_accvgpr_read_b32 v29, a219
v_mfma_f32_16x16x32_bf16 v[188:191], v[88:91], v[120:123], v[188:191]
s_add_u32 s72, s71, 95232
buffer_load_dwordx4 v7, s[12:15], s72 offen offset:3072 lds
v_mfma_f32_16x16x32_bf16 v[188:191], v[92:95], v[124:127], v[188:191]
ds_read_b64_tr_b16 v[80:81], v14 offset:16384
v_accvgpr_read_b32 v26, a220
v_mfma_f32_16x16x32_bf16 v[184:187], v[92:95], v[116:119], v[184:187]
ds_read_b64_tr_b16 v[82:83], v14 offset:17408
v_accvgpr_read_b32 v30, a221
v_mfma_f32_16x16x32_bf16 v[184:187], v[88:91], v[112:115], v[184:187]
buffer_store_dwordx4 v[20:23], v1, s[44:47], s80 offen sc1
v_mfma_f32_16x16x32_bf16 v[180:183], v[88:91], v[104:107], v[180:183]
ds_read_b64_tr_b16 v[84:85], v14 offset:24576
v_accvgpr_read_b32 v27, a222
v_mfma_f32_16x16x32_bf16 v[180:183], v[92:95], v[108:111], v[180:183]
s_add_u32 m0, s63, 65536
ds_read_b64_tr_b16 v[86:87], v14 offset:25600
v_accvgpr_read_b32 v31, a223
v_mfma_f32_16x16x32_bf16 v[176:179], v[92:95], v[100:103], v[176:179]
s_add_u32 s72, s69, 0
buffer_load_dwordx4 v4, s[4:7], s72 offen lds
v_mfma_f32_16x16x32_bf16 v[176:179], v[88:91], v[96:99], v[176:179]
s_waitcnt lgkmcnt(10)
ds_read_b128 v[40:43], v18 offset:34816
v_cvt_pk_bf16_f32 v24, v24, v28
v_mfma_f32_16x16x32_bf16 v[192:195], v[64:67], v[96:99], v[192:195]
ds_read_b64_tr_b16 v[88:89], v15 offset:16384
v_cvt_pk_bf16_f32 v25, v25, v29
v_mfma_f32_16x16x32_bf16 v[192:195], v[68:71], v[100:103], v[192:195]
ds_read_b64_tr_b16 v[90:91], v15 offset:17408
v_cvt_pk_bf16_f32 v26, v26, v30
v_mfma_f32_16x16x32_bf16 v[196:199], v[68:71], v[108:111], v[196:199]
ds_read_b64_tr_b16 v[92:93], v15 offset:24576
v_cvt_pk_bf16_f32 v27, v27, v31
v_mfma_f32_16x16x32_bf16 v[196:199], v[64:67], v[104:107], v[196:199]
s_add_u32 s72, s69, 15360
buffer_load_dwordx4 v5, s[4:7], s72 offen offset:1024 lds
v_mfma_f32_16x16x32_bf16 v[200:203], v[64:67], v[112:115], v[200:203]
s_add_u32 s80, s78, 43008
ds_read_b64_tr_b16 v[94:95], v15 offset:25600
v_mfma_f32_16x16x32_bf16 v[200:203], v[68:71], v[116:119], v[200:203]
ds_read_b128 v[44:47], v19 offset:34816
v_mfma_f32_16x16x32_bf16 v[204:207], v[68:71], v[124:127], v[204:207]
buffer_store_dwordx4 v[24:27], v1, s[44:47], s80 offen sc1
v_mfma_f32_16x16x32_bf16 v[204:207], v[64:67], v[120:123], v[204:207]
s_waitcnt lgkmcnt(11)
ds_read_b128 v[48:51], v18 offset:36864
v_mfma_f32_16x16x32_bf16 v[220:223], v[72:75], v[120:123], v[220:223]
s_add_u32 s72, s69, 129024
buffer_load_dwordx4 v4, s[4:7], s72 offen offset:2048 lds
v_mfma_f32_16x16x32_bf16 v[220:223], v[76:79], v[124:127], v[220:223]
v_accvgpr_read_b32 v20, a88
v_accvgpr_read_b32 v28, a89
v_mfma_f32_16x16x32_bf16 v[216:219], v[76:79], v[116:119], v[216:219]
s_waitcnt vmcnt(20) lgkmcnt(2)
ds_read_b128 v[52:55], v19 offset:36864
v_accvgpr_read_b32 v21, a90
v_mfma_f32_16x16x32_bf16 v[216:219], v[72:75], v[112:115], v[216:219]
s_barrier
ds_read_b128 v[56:59], v18 offset:38912
v_accvgpr_read_b32 v29, a91
v_mfma_f32_16x16x32_bf16 v[212:215], v[72:75], v[104:107], v[212:215]
ds_read_b64_tr_b16 v[64:65], v8 offset:32768
ds_read_b64_tr_b16 v[66:67], v8 offset:33792
v_mfma_f32_16x16x32_bf16 v[212:215], v[76:79], v[108:111], v[212:215]
ds_read_b64_tr_b16 v[68:69], v8 offset:40960
v_accvgpr_read_b32 v22, a120
v_mfma_f32_16x16x32_bf16 v[208:211], v[76:79], v[100:103], v[208:211]
s_add_u32 s72, s69, 144384
buffer_load_dwordx4 v5, s[4:7], s72 offen offset:3072 lds
v_mfma_f32_16x16x32_bf16 v[208:211], v[72:75], v[96:99], v[208:211]
ds_read_b64_tr_b16 v[70:71], v8 offset:41984
v_accvgpr_read_b32 v30, a121
v_mfma_f32_16x16x32_bf16 v[224:227], v[80:83], v[96:99], v[224:227]
ds_read_b64_tr_b16 v[72:73], v9 offset:32768
v_accvgpr_read_b32 v23, a122
v_mfma_f32_16x16x32_bf16 v[224:227], v[84:87], v[100:103], v[224:227]
ds_read_b64_tr_b16 v[74:75], v9 offset:33792
v_accvgpr_read_b32 v31, a123
v_mfma_f32_16x16x32_bf16 v[228:231], v[84:87], v[108:111], v[228:231]
s_add_u32 m0, s63, 69632
v_mul_f32 v20, s79, v20
v_mul_f32 v28, s79, v28
v_mfma_f32_16x16x32_bf16 v[228:231], v[80:83], v[104:107], v[228:231]
s_add_u32 s72, s70, 0
buffer_load_dwordx4 v4, s[4:7], s72 offen lds
v_mfma_f32_16x16x32_bf16 v[232:235], v[80:83], v[112:115], v[232:235]
ds_read_b64_tr_b16 v[76:77], v9 offset:40960
v_mul_f32 v21, s79, v21
v_mfma_f32_16x16x32_bf16 v[232:235], v[84:87], v[116:119], v[232:235]
ds_read_b128 v[60:63], v19 offset:38912
v_mul_f32 v29, s79, v29
v_mfma_f32_16x16x32_bf16 v[236:239], v[84:87], v[124:127], v[236:239]
ds_read_b64_tr_b16 v[78:79], v9 offset:41984
v_mul_f32 v22, s79, v22
v_mfma_f32_16x16x32_bf16 v[236:239], v[80:83], v[120:123], v[236:239]
v_mul_f32 v30, s79, v30
v_mul_f32 v23, s79, v23
v_mfma_f32_16x16x32_bf16 v[252:255], v[88:91], v[120:123], v[252:255]
s_add_u32 s72, s70, 15360
buffer_load_dwordx4 v5, s[4:7], s72 offen offset:1024 lds
v_mfma_f32_16x16x32_bf16 v[252:255], v[92:95], v[124:127], v[252:255]
ds_read_b64_tr_b16 v[80:81], v10 offset:32768
v_mul_f32 v31, s79, v31
v_mfma_f32_16x16x32_bf16 v[248:251], v[92:95], v[116:119], v[248:251]
ds_read_b64_tr_b16 v[82:83], v10 offset:33792
v_cvt_pk_bf16_f32 v20, v20, v28
v_mfma_f32_16x16x32_bf16 v[248:251], v[88:91], v[112:115], v[248:251]
v_cvt_pk_bf16_f32 v21, v21, v29
v_cvt_pk_bf16_f32 v22, v22, v30
v_mfma_f32_16x16x32_bf16 v[244:247], v[88:91], v[104:107], v[244:247]
ds_read_b64_tr_b16 v[84:85], v10 offset:40960
v_cvt_pk_bf16_f32 v23, v23, v31
v_mfma_f32_16x16x32_bf16 v[244:247], v[92:95], v[108:111], v[244:247]
s_add_u32 s80, s77, 41984
ds_read_b64_tr_b16 v[86:87], v10 offset:41984
v_mfma_f32_16x16x32_bf16 v[240:243], v[92:95], v[100:103], v[240:243]
s_add_u32 s72, s70, 129024
buffer_load_dwordx4 v4, s[4:7], s72 offen offset:2048 lds
v_mfma_f32_16x16x32_bf16 v[240:243], v[88:91], v[96:99], v[240:243]
s_waitcnt lgkmcnt(5)
buffer_store_dwordx4 v[20:23], v1, s[44:47], s80 offen sc1
LcB1:
v_mfma_f32_16x16x32_bf16 v[128:131], v[64:67], v[32:35], v[128:131]
ds_read_b64_tr_b16 v[88:89], v11 offset:32768
v_accvgpr_read_b32 v24, a224
v_mfma_f32_16x16x32_bf16 v[128:131], v[68:71], v[36:39], v[128:131]
ds_read_b64_tr_b16 v[90:91], v11 offset:33792
v_accvgpr_read_b32 v28, a225
v_mfma_f32_16x16x32_bf16 v[132:135], v[68:71], v[44:47], v[132:135]
v_accvgpr_read_b32 v25, a226
v_accvgpr_read_b32 v29, a227
v_mfma_f32_16x16x32_bf16 v[132:135], v[64:67], v[40:43], v[132:135]
s_add_u32 s72, s70, 144384
buffer_load_dwordx4 v5, s[4:7], s72 offen offset:3072 lds
v_mfma_f32_16x16x32_bf16 v[136:139], v[64:67], v[48:51], v[136:139]
ds_read_b64_tr_b16 v[92:93], v11 offset:40960
v_accvgpr_read_b32 v26, a228
v_mfma_f32_16x16x32_bf16 v[136:139], v[68:71], v[52:55], v[136:139]
s_lshl_b32 s71, s73, 12
v_accvgpr_read_b32 v30, a229
v_accvgpr_read_b32 v27, a230
v_mfma_f32_16x16x32_bf16 v[140:143], v[68:71], v[60:63], v[140:143]
s_add_u32 s71, s71, s66
ds_read_b64_tr_b16 v[94:95], v11 offset:41984
v_accvgpr_read_b32 v31, a231
v_mfma_f32_16x16x32_bf16 v[140:143], v[64:67], v[56:59], v[140:143]
s_waitcnt lgkmcnt(8)
v_cvt_pk_bf16_f32 v24, v24, v28
v_cvt_pk_bf16_f32 v25, v25, v29
v_mfma_f32_16x16x32_bf16 v[156:159], v[72:75], v[56:59], v[156:159]
s_add_u32 m0, s64, 16384
ds_read_b64_tr_b16 v[64:65], v12 offset:32768
v_cvt_pk_bf16_f32 v26, v26, v30
v_mfma_f32_16x16x32_bf16 v[156:159], v[76:79], v[60:63], v[156:159]
s_add_u32 s72, s71, 0
buffer_load_dwordx4 v6, s[12:15], s72 offen lds
v_mfma_f32_16x16x32_bf16 v[152:155], v[76:79], v[52:55], v[152:155]
s_add_u32 s73, s62, 11
ds_read_b64_tr_b16 v[66:67], v12 offset:33792
v_cvt_pk_bf16_f32 v27, v27, v31
v_mfma_f32_16x16x32_bf16 v[152:155], v[72:75], v[48:51], v[152:155]
s_add_u32 s70, s73, s65
v_mfma_f32_16x16x32_bf16 v[148:151], v[72:75], v[40:43], v[148:151]
s_and_b32 s70, s70, 3
ds_read_b64_tr_b16 v[68:69], v12 offset:40960
v_mfma_f32_16x16x32_bf16 v[148:151], v[76:79], v[44:47], v[148:151]
s_and_b32 s73, s73, 12
ds_read_b64_tr_b16 v[70:71], v12 offset:41984
v_mfma_f32_16x16x32_bf16 v[144:147], v[76:79], v[36:39], v[144:147]
s_add_u32 s72, s71, 31744
buffer_load_dwordx4 v6, s[12:15], s72 offen offset:1024 lds
v_mfma_f32_16x16x32_bf16 v[144:147], v[72:75], v[32:35], v[144:147]
s_waitcnt lgkmcnt(8)
v_mfma_f32_16x16x32_bf16 v[160:163], v[80:83], v[32:35], v[160:163]
s_or_b32 s73, s73, s70
ds_read_b64_tr_b16 v[72:73], v13 offset:32768
v_mfma_f32_16x16x32_bf16 v[160:163], v[84:87], v[36:39], v[160:163]
s_lshl_b32 s73, s73, 7
ds_read_b64_tr_b16 v[74:75], v13 offset:33792
v_mfma_f32_16x16x32_bf16 v[164:167], v[84:87], v[44:47], v[164:167]
s_add_u32 s69, s73, s67
v_mfma_f32_16x16x32_bf16 v[164:167], v[80:83], v[40:43], v[164:167]
s_add_u32 s72, s71, 63488
buffer_load_dwordx4 v7, s[12:15], s72 offen offset:2048 lds
v_mfma_f32_16x16x32_bf16 v[168:171], v[80:83], v[48:51], v[168:171]
s_waitcnt vmcnt(18)
ds_read_b64_tr_b16 v[76:77], v13 offset:40960
v_mfma_f32_16x16x32_bf16 v[168:171], v[84:87], v[52:55], v[168:171]
s_add_u32 s70, s73, s68
ds_read_b128 v[96:99], v16 offset:0
v_accvgpr_read_b32 v20, a92
v_mfma_f32_16x16x32_bf16 v[172:175], v[84:87], v[60:63], v[172:175]
s_add_u32 s80, s78, 3072
ds_read_b64_tr_b16 v[78:79], v13 offset:41984
v_accvgpr_read_b32 v28, a93
v_mfma_f32_16x16x32_bf16 v[172:175], v[80:83], v[56:59], v[172:175]
s_waitcnt lgkmcnt(9)
ds_read_b128 v[100:103], v17 offset:0
v_accvgpr_read_b32 v21, a94
v_mfma_f32_16x16x32_bf16 v[188:191], v[88:91], v[56:59], v[188:191]
s_add_u32 s72, s71, 95232
buffer_load_dwordx4 v7, s[12:15], s72 offen offset:3072 lds
v_mfma_f32_16x16x32_bf16 v[188:191], v[92:95], v[60:63], v[188:191]
ds_read_b64_tr_b16 v[80:81], v14 offset:32768
v_accvgpr_read_b32 v29, a95
v_mfma_f32_16x16x32_bf16 v[184:187], v[92:95], v[52:55], v[184:187]
ds_read_b64_tr_b16 v[82:83], v14 offset:33792
v_accvgpr_read_b32 v22, a124
v_mfma_f32_16x16x32_bf16 v[184:187], v[88:91], v[48:51], v[184:187]
buffer_store_dwordx4 v[24:27], v1, s[44:47], s80 offen sc1
v_mfma_f32_16x16x32_bf16 v[180:183], v[88:91], v[40:43], v[180:183]
ds_read_b64_tr_b16 v[84:85], v14 offset:40960
v_accvgpr_read_b32 v30, a125
v_mfma_f32_16x16x32_bf16 v[180:183], v[92:95], v[44:47], v[180:183]
s_add_u32 m0, s63, 98304
ds_read_b64_tr_b16 v[86:87], v14 offset:41984
v_accvgpr_read_b32 v23, a126
v_mfma_f32_16x16x32_bf16 v[176:179], v[92:95], v[36:39], v[176:179]
s_add_u32 s72, s69, 0
buffer_load_dwordx4 v4, s[4:7], s72 offen lds
v_mfma_f32_16x16x32_bf16 v[176:179], v[88:91], v[32:35], v[176:179]
s_waitcnt lgkmcnt(10)
ds_read_b128 v[104:107], v16 offset:2048
v_accvgpr_read_b32 v31, a127
v_mfma_f32_16x16x32_bf16 v[192:195], v[64:67], v[32:35], v[192:195]
ds_read_b64_tr_b16 v[88:89], v15 offset:32768
v_mul_f32 v20, s79, v20
v_mfma_f32_16x16x32_bf16 v[192:195], v[68:71], v[36:39], v[192:195]
ds_read_b64_tr_b16 v[90:91], v15 offset:33792
v_mul_f32 v28, s79, v28
v_mfma_f32_16x16x32_bf16 v[196:199], v[68:71], v[44:47], v[196:199]
ds_read_b64_tr_b16 v[92:93], v15 offset:40960
v_mul_f32 v21, s79, v21
v_mfma_f32_16x16x32_bf16 v[196:199], v[64:67], v[40:43], v[196:199]
s_add_u32 s72, s69, 15360
buffer_load_dwordx4 v5, s[4:7], s72 offen offset:1024 lds
v_mfma_f32_16x16x32_bf16 v[200:203], v[64:67], v[48:51], v[200:203]
ds_read_b64_tr_b16 v[94:95], v15 offset:41984
v_mul_f32 v29, s79, v29
v_mfma_f32_16x16x32_bf16 v[200:203], v[68:71], v[52:55], v[200:203]
ds_read_b128 v[108:111], v17 offset:2048
v_mul_f32 v22, s79, v22
v_mfma_f32_16x16x32_bf16 v[204:207], v[68:71], v[60:63], v[204:207]
v_mul_f32 v30, s79, v30
v_mul_f32 v23, s79, v23
v_mfma_f32_16x16x32_bf16 v[204:207], v[64:67], v[56:59], v[204:207]
s_waitcnt lgkmcnt(11)
ds_read_b128 v[112:115], v16 offset:4096
v_mul_f32 v31, s79, v31
v_mfma_f32_16x16x32_bf16 v[220:223], v[72:75], v[56:59], v[220:223]
s_add_u32 s72, s69, 129024
buffer_load_dwordx4 v4, s[4:7], s72 offen offset:2048 lds
v_mfma_f32_16x16x32_bf16 v[220:223], v[76:79], v[60:63], v[220:223]
v_cvt_pk_bf16_f32 v20, v20, v28
v_cvt_pk_bf16_f32 v21, v21, v29
v_mfma_f32_16x16x32_bf16 v[216:219], v[76:79], v[52:55], v[216:219]
s_waitcnt vmcnt(19) lgkmcnt(2)
ds_read_b128 v[116:119], v17 offset:4096
v_cvt_pk_bf16_f32 v22, v22, v30
v_mfma_f32_16x16x32_bf16 v[216:219], v[72:75], v[48:51], v[216:219]
s_barrier
ds_read_b128 v[120:123], v16 offset:6144
v_cvt_pk_bf16_f32 v23, v23, v31
v_mfma_f32_16x16x32_bf16 v[212:215], v[72:75], v[40:43], v[212:215]
s_add_u32 s80, s77, 46080
ds_read_b64_tr_b16 v[64:65], v8 offset:0
ds_read_b64_tr_b16 v[66:67], v8 offset:1024
v_mfma_f32_16x16x32_bf16 v[212:215], v[76:79], v[44:47], v[212:215]
ds_read_b64_tr_b16 v[68:69], v8 offset:8192
v_accvgpr_read_b32 v24, a232
v_mfma_f32_16x16x32_bf16 v[208:211], v[76:79], v[36:39], v[208:211]
s_add_u32 s72, s69, 144384
buffer_load_dwordx4 v5, s[4:7], s72 offen offset:3072 lds
v_mfma_f32_16x16x32_bf16 v[208:211], v[72:75], v[32:35], v[208:211]
ds_read_b64_tr_b16 v[70:71], v8 offset:9216
v_accvgpr_read_b32 v28, a233
v_mfma_f32_16x16x32_bf16 v[224:227], v[80:83], v[32:35], v[224:227]
ds_read_b64_tr_b16 v[72:73], v9 offset:0
v_accvgpr_read_b32 v25, a234
v_mfma_f32_16x16x32_bf16 v[224:227], v[84:87], v[36:39], v[224:227]
ds_read_b64_tr_b16 v[74:75], v9 offset:1024
v_accvgpr_read_b32 v29, a235
v_mfma_f32_16x16x32_bf16 v[228:231], v[84:87], v[44:47], v[228:231]
s_add_u32 m0, s63, 102400
buffer_store_dwordx4 v[20:23], v1, s[44:47], s80 offen sc1
v_mfma_f32_16x16x32_bf16 v[228:231], v[80:83], v[40:43], v[228:231]
s_add_u32 s72, s70, 0
buffer_load_dwordx4 v4, s[4:7], s72 offen lds
v_mfma_f32_16x16x32_bf16 v[232:235], v[80:83], v[48:51], v[232:235]
ds_read_b64_tr_b16 v[76:77], v9 offset:8192
v_accvgpr_read_b32 v26, a236
v_mfma_f32_16x16x32_bf16 v[232:235], v[84:87], v[52:55], v[232:235]
ds_read_b128 v[124:127], v17 offset:6144
v_accvgpr_read_b32 v30, a237
v_mfma_f32_16x16x32_bf16 v[236:239], v[84:87], v[60:63], v[236:239]
ds_read_b64_tr_b16 v[78:79], v9 offset:9216
v_accvgpr_read_b32 v27, a238
v_mfma_f32_16x16x32_bf16 v[236:239], v[80:83], v[56:59], v[236:239]
v_accvgpr_read_b32 v31, a239
v_cvt_pk_bf16_f32 v24, v24, v28
v_mfma_f32_16x16x32_bf16 v[252:255], v[88:91], v[56:59], v[252:255]
s_add_u32 s72, s70, 15360
buffer_load_dwordx4 v5, s[4:7], s72 offen offset:1024 lds
v_mfma_f32_16x16x32_bf16 v[252:255], v[92:95], v[60:63], v[252:255]
ds_read_b64_tr_b16 v[80:81], v10 offset:0
v_cvt_pk_bf16_f32 v25, v25, v29
v_mfma_f32_16x16x32_bf16 v[248:251], v[92:95], v[52:55], v[248:251]
ds_read_b64_tr_b16 v[82:83], v10 offset:1024
v_cvt_pk_bf16_f32 v26, v26, v30
v_mfma_f32_16x16x32_bf16 v[248:251], v[88:91], v[48:51], v[248:251]
v_cvt_pk_bf16_f32 v27, v27, v31
v_mfma_f32_16x16x32_bf16 v[244:247], v[88:91], v[40:43], v[244:247]
s_add_u32 s80, s78, 11264
ds_read_b64_tr_b16 v[84:85], v10 offset:8192
v_mfma_f32_16x16x32_bf16 v[244:247], v[92:95], v[44:47], v[244:247]
ds_read_b64_tr_b16 v[86:87], v10 offset:9216
v_mfma_f32_16x16x32_bf16 v[240:243], v[92:95], v[36:39], v[240:243]
s_add_u32 s72, s70, 129024
buffer_load_dwordx4 v4, s[4:7], s72 offen offset:2048 lds
v_mfma_f32_16x16x32_bf16 v[240:243], v[88:91], v[32:35], v[240:243]
s_waitcnt lgkmcnt(5)
buffer_store_dwordx4 v[24:27], v1, s[44:47], s80 offen sc1
v_mfma_f32_16x16x32_bf16 v[128:131], v[64:67], v[96:99], v[128:131]
ds_read_b64_tr_b16 v[88:89], v11 offset:0
v_mfma_f32_16x16x32_bf16 v[128:131], v[68:71], v[100:103], v[128:131]
ds_read_b64_tr_b16 v[90:91], v11 offset:1024
v_accvgpr_read_b32 v20, a240
v_mfma_f32_16x16x32_bf16 v[132:135], v[68:71], v[108:111], v[132:135]
v_accvgpr_read_b32 v28, a241
v_accvgpr_read_b32 v21, a242
v_mfma_f32_16x16x32_bf16 v[132:135], v[64:67], v[104:107], v[132:135]
s_add_u32 s72, s70, 144384
buffer_load_dwordx4 v5, s[4:7], s72 offen offset:3072 lds
v_mfma_f32_16x16x32_bf16 v[136:139], v[64:67], v[112:115], v[136:139]
ds_read_b64_tr_b16 v[92:93], v11 offset:8192
v_accvgpr_read_b32 v29, a243
v_mfma_f32_16x16x32_bf16 v[136:139], v[68:71], v[116:119], v[136:139]
s_lshl_b32 s71, s73, 12
v_accvgpr_read_b32 v22, a244
v_accvgpr_read_b32 v30, a245
v_mfma_f32_16x16x32_bf16 v[140:143], v[68:71], v[124:127], v[140:143]
s_add_u32 s71, s71, s66
ds_read_b64_tr_b16 v[94:95], v11 offset:9216
v_accvgpr_read_b32 v23, a246
v_mfma_f32_16x16x32_bf16 v[140:143], v[64:67], v[120:123], v[140:143]
s_waitcnt lgkmcnt(8)
v_accvgpr_read_b32 v31, a247
v_cvt_pk_bf16_f32 v20, v20, v28
v_mfma_f32_16x16x32_bf16 v[156:159], v[72:75], v[120:123], v[156:159]
s_add_u32 m0, s64, 32768
ds_read_b64_tr_b16 v[64:65], v12 offset:0
v_cvt_pk_bf16_f32 v21, v21, v29
v_mfma_f32_16x16x32_bf16 v[156:159], v[76:79], v[124:127], v[156:159]
s_add_u32 s72, s71, 0
buffer_load_dwordx4 v6, s[12:15], s72 offen lds
v_mfma_f32_16x16x32_bf16 v[152:155], v[76:79], v[116:119], v[152:155]
s_add_u32 s73, s62, 12
ds_read_b64_tr_b16 v[66:67], v12 offset:1024
v_cvt_pk_bf16_f32 v22, v22, v30
v_mfma_f32_16x16x32_bf16 v[152:155], v[72:75], v[112:115], v[152:155]
s_add_u32 s70, s73, s65
v_cvt_pk_bf16_f32 v23, v23, v31
v_mfma_f32_16x16x32_bf16 v[148:151], v[72:75], v[104:107], v[148:151]
s_and_b32 s70, s70, 3
ds_read_b64_tr_b16 v[68:69], v12 offset:8192
v_mfma_f32_16x16x32_bf16 v[148:151], v[76:79], v[108:111], v[148:151]
s_and_b32 s73, s73, 12
ds_read_b64_tr_b16 v[70:71], v12 offset:9216
v_mfma_f32_16x16x32_bf16 v[144:147], v[76:79], v[100:103], v[144:147]
s_add_u32 s72, s71, 31744
buffer_load_dwordx4 v6, s[12:15], s72 offen offset:1024 lds
v_mfma_f32_16x16x32_bf16 v[144:147], v[72:75], v[96:99], v[144:147]
s_waitcnt lgkmcnt(8)
v_mfma_f32_16x16x32_bf16 v[160:163], v[80:83], v[96:99], v[160:163]
s_or_b32 s73, s73, s70
ds_read_b64_tr_b16 v[72:73], v13 offset:0
v_mfma_f32_16x16x32_bf16 v[160:163], v[84:87], v[100:103], v[160:163]
s_lshl_b32 s73, s73, 7
ds_read_b64_tr_b16 v[74:75], v13 offset:1024
v_mfma_f32_16x16x32_bf16 v[164:167], v[84:87], v[108:111], v[164:167]
s_add_u32 s69, s73, s67
v_mfma_f32_16x16x32_bf16 v[164:167], v[80:83], v[104:107], v[164:167]
s_add_u32 s72, s71, 63488
buffer_load_dwordx4 v7, s[12:15], s72 offen offset:2048 lds
v_mfma_f32_16x16x32_bf16 v[168:171], v[80:83], v[112:115], v[168:171]
s_waitcnt vmcnt(18)
ds_read_b64_tr_b16 v[76:77], v13 offset:8192
v_mfma_f32_16x16x32_bf16 v[168:171], v[84:87], v[116:119], v[168:171]
s_add_u32 s70, s73, s68
ds_read_b128 v[32:35], v18 offset:0
v_mfma_f32_16x16x32_bf16 v[172:175], v[84:87], v[124:127], v[172:175]
s_add_u32 s80, s78, 35840
ds_read_b64_tr_b16 v[78:79], v13 offset:9216
v_mfma_f32_16x16x32_bf16 v[172:175], v[80:83], v[120:123], v[172:175]
s_waitcnt lgkmcnt(9)
ds_read_b128 v[36:39], v19 offset:0
v_accvgpr_read_b32 v24, a248
v_mfma_f32_16x16x32_bf16 v[188:191], v[88:91], v[120:123], v[188:191]
s_add_u32 s72, s71, 95232
buffer_load_dwordx4 v7, s[12:15], s72 offen offset:3072 lds
v_mfma_f32_16x16x32_bf16 v[188:191], v[92:95], v[124:127], v[188:191]
ds_read_b64_tr_b16 v[80:81], v14 offset:0
v_accvgpr_read_b32 v28, a249
v_mfma_f32_16x16x32_bf16 v[184:187], v[92:95], v[116:119], v[184:187]
ds_read_b64_tr_b16 v[82:83], v14 offset:1024
v_accvgpr_read_b32 v25, a250
v_mfma_f32_16x16x32_bf16 v[184:187], v[88:91], v[112:115], v[184:187]
buffer_store_dwordx4 v[20:23], v1, s[44:47], s80 offen sc1
v_mfma_f32_16x16x32_bf16 v[180:183], v[88:91], v[104:107], v[180:183]
ds_read_b64_tr_b16 v[84:85], v14 offset:8192
v_accvgpr_read_b32 v29, a251
v_mfma_f32_16x16x32_bf16 v[180:183], v[92:95], v[108:111], v[180:183]
s_add_u32 m0, s63, 131072
ds_read_b64_tr_b16 v[86:87], v14 offset:9216
v_accvgpr_read_b32 v26, a252
v_mfma_f32_16x16x32_bf16 v[176:179], v[92:95], v[100:103], v[176:179]
s_add_u32 s72, s69, 0
buffer_load_dwordx4 v4, s[4:7], s72 offen lds
v_mfma_f32_16x16x32_bf16 v[176:179], v[88:91], v[96:99], v[176:179]
s_waitcnt lgkmcnt(10)
ds_read_b128 v[40:43], v18 offset:2048
v_accvgpr_read_b32 v30, a253
v_mfma_f32_16x16x32_bf16 v[192:195], v[64:67], v[96:99], v[192:195]
ds_read_b64_tr_b16 v[88:89], v15 offset:0
v_accvgpr_read_b32 v27, a254
v_mfma_f32_16x16x32_bf16 v[192:195], v[68:71], v[100:103], v[192:195]
ds_read_b64_tr_b16 v[90:91], v15 offset:1024
v_accvgpr_read_b32 v31, a255
v_mfma_f32_16x16x32_bf16 v[196:199], v[68:71], v[108:111], v[196:199]
ds_read_b64_tr_b16 v[92:93], v15 offset:8192
v_cvt_pk_bf16_f32 v24, v24, v28
v_mfma_f32_16x16x32_bf16 v[196:199], v[64:67], v[104:107], v[196:199]
s_add_u32 s72, s69, 15360
buffer_load_dwordx4 v5, s[4:7], s72 offen offset:1024 lds
v_mfma_f32_16x16x32_bf16 v[200:203], v[64:67], v[112:115], v[200:203]
ds_read_b64_tr_b16 v[94:95], v15 offset:9216
v_cvt_pk_bf16_f32 v25, v25, v29
v_mfma_f32_16x16x32_bf16 v[200:203], v[68:71], v[116:119], v[200:203]
ds_read_b128 v[44:47], v19 offset:2048
v_cvt_pk_bf16_f32 v26, v26, v30
v_mfma_f32_16x16x32_bf16 v[204:207], v[68:71], v[124:127], v[204:207]
v_cvt_pk_bf16_f32 v27, v27, v31
v_mfma_f32_16x16x32_bf16 v[204:207], v[64:67], v[120:123], v[204:207]
s_waitcnt lgkmcnt(11)
ds_read_b128 v[48:51], v18 offset:4096
v_mfma_f32_16x16x32_bf16 v[220:223], v[72:75], v[120:123], v[220:223]
s_add_u32 s72, s69, 129024
buffer_load_dwordx4 v4, s[4:7], s72 offen offset:2048 lds
v_mfma_f32_16x16x32_bf16 v[220:223], v[76:79], v[124:127], v[220:223]
s_add_u32 s80, s78, 44032
ds_read_b128 v[52:55], v19 offset:4096
v_mfma_f32_16x16x32_bf16 v[216:219], v[76:79], v[116:119], v[216:219]
s_waitcnt vmcnt(19) lgkmcnt(3)
buffer_store_dwordx4 v[24:27], v1, s[44:47], s80 offen sc1
v_mfma_f32_16x16x32_bf16 v[216:219], v[72:75], v[112:115], v[216:219]
s_barrier
ds_read_b128 v[56:59], v18 offset:6144
v_mfma_f32_16x16x32_bf16 v[212:215], v[72:75], v[104:107], v[212:215]
ds_read_b64_tr_b16 v[64:65], v8 offset:16384
ds_read_b64_tr_b16 v[66:67], v8 offset:17408
v_mfma_f32_16x16x32_bf16 v[212:215], v[76:79], v[108:111], v[212:215]
ds_read_b64_tr_b16 v[68:69], v8 offset:24576
ds_read_b64_tr_b16 v[70:71], v8 offset:25600
v_mfma_f32_16x16x32_bf16 v[208:211], v[76:79], v[100:103], v[208:211]
s_add_u32 s72, s69, 144384
buffer_load_dwordx4 v5, s[4:7], s72 offen offset:3072 lds
v_mfma_f32_16x16x32_bf16 v[208:211], v[72:75], v[96:99], v[208:211]
v_and_b32 v2, 31, v0
v_lshlrev_b32 v2, 2, v2
v_mfma_f32_16x16x32_bf16 v[224:227], v[80:83], v[96:99], v[224:227]
buffer_load_dword v3, v2, s[48:51], 0 offen sc1
v_mfma_f32_16x16x32_bf16 v[224:227], v[84:87], v[100:103], v[224:227]
ds_read_b64_tr_b16 v[72:73], v9 offset:16384
v_mfma_f32_16x16x32_bf16 v[228:231], v[84:87], v[108:111], v[228:231]
s_add_u32 m0, s63, 135168
ds_read_b64_tr_b16 v[74:75], v9 offset:17408
v_mfma_f32_16x16x32_bf16 v[228:231], v[80:83], v[104:107], v[228:231]
s_add_u32 s72, s70, 0
buffer_load_dwordx4 v4, s[4:7], s72 offen lds
v_mfma_f32_16x16x32_bf16 v[232:235], v[80:83], v[112:115], v[232:235]
ds_read_b128 v[60:63], v19 offset:6144
v_mfma_f32_16x16x32_bf16 v[232:235], v[84:87], v[116:119], v[232:235]
ds_read_b64_tr_b16 v[76:77], v9 offset:24576
v_mfma_f32_16x16x32_bf16 v[236:239], v[84:87], v[124:127], v[236:239]
ds_read_b64_tr_b16 v[78:79], v9 offset:25600
v_mfma_f32_16x16x32_bf16 v[236:239], v[80:83], v[120:123], v[236:239]
v_mfma_f32_16x16x32_bf16 v[252:255], v[88:91], v[120:123], v[252:255]
s_add_u32 s72, s70, 15360
buffer_load_dwordx4 v5, s[4:7], s72 offen offset:1024 lds
v_mfma_f32_16x16x32_bf16 v[252:255], v[92:95], v[124:127], v[252:255]
ds_read_b64_tr_b16 v[80:81], v10 offset:16384
v_mfma_f32_16x16x32_bf16 v[248:251], v[92:95], v[116:119], v[248:251]
ds_read_b64_tr_b16 v[82:83], v10 offset:17408
v_mfma_f32_16x16x32_bf16 v[248:251], v[88:91], v[112:115], v[248:251]
v_mfma_f32_16x16x32_bf16 v[244:247], v[88:91], v[104:107], v[244:247]
ds_read_b64_tr_b16 v[84:85], v10 offset:24576
v_mfma_f32_16x16x32_bf16 v[244:247], v[92:95], v[108:111], v[244:247]
ds_read_b64_tr_b16 v[86:87], v10 offset:25600
v_mfma_f32_16x16x32_bf16 v[240:243], v[92:95], v[100:103], v[240:243]
s_add_u32 s72, s70, 129024
buffer_load_dwordx4 v4, s[4:7], s72 offen offset:2048 lds
v_mfma_f32_16x16x32_bf16 v[240:243], v[88:91], v[96:99], v[240:243]
s_waitcnt lgkmcnt(6)
v_mfma_f32_16x16x32_bf16 v[128:131], v[64:67], v[32:35], v[128:131]
ds_read_b64_tr_b16 v[88:89], v11 offset:16384
v_mfma_f32_16x16x32_bf16 v[128:131], v[68:71], v[36:39], v[128:131]
ds_read_b64_tr_b16 v[90:91], v11 offset:17408
v_mfma_f32_16x16x32_bf16 v[132:135], v[68:71], v[44:47], v[132:135]
v_mfma_f32_16x16x32_bf16 v[132:135], v[64:67], v[40:43], v[132:135]
s_add_u32 s72, s70, 144384
buffer_load_dwordx4 v5, s[4:7], s72 offen offset:3072 lds
v_mfma_f32_16x16x32_bf16 v[136:139], v[64:67], v[48:51], v[136:139]
ds_read_b64_tr_b16 v[92:93], v11 offset:24576
v_mfma_f32_16x16x32_bf16 v[136:139], v[68:71], v[52:55], v[136:139]
s_lshl_b32 s71, s73, 12
v_mfma_f32_16x16x32_bf16 v[140:143], v[68:71], v[60:63], v[140:143]
s_add_u32 s71, s71, s66
ds_read_b64_tr_b16 v[94:95], v11 offset:25600
v_mfma_f32_16x16x32_bf16 v[140:143], v[64:67], v[56:59], v[140:143]
s_waitcnt lgkmcnt(8)
v_mfma_f32_16x16x32_bf16 v[156:159], v[72:75], v[56:59], v[156:159]
s_add_u32 m0, s64, 0
ds_read_b64_tr_b16 v[64:65], v12 offset:16384
v_mfma_f32_16x16x32_bf16 v[156:159], v[76:79], v[60:63], v[156:159]
s_add_u32 s72, s71, 0
buffer_load_dwordx4 v6, s[12:15], s72 offen lds
v_mfma_f32_16x16x32_bf16 v[152:155], v[76:79], v[52:55], v[152:155]
s_add_u32 s73, s62, 13
ds_read_b64_tr_b16 v[66:67], v12 offset:17408
v_mfma_f32_16x16x32_bf16 v[152:155], v[72:75], v[48:51], v[152:155]
s_add_u32 s70, s73, s65
v_mfma_f32_16x16x32_bf16 v[148:151], v[72:75], v[40:43], v[148:151]
s_and_b32 s70, s70, 3
ds_read_b64_tr_b16 v[68:69], v12 offset:24576
v_mfma_f32_16x16x32_bf16 v[148:151], v[76:79], v[44:47], v[148:151]
s_and_b32 s73, s73, 12
ds_read_b64_tr_b16 v[70:71], v12 offset:25600
v_mfma_f32_16x16x32_bf16 v[144:147], v[76:79], v[36:39], v[144:147]
s_add_u32 s72, s71, 31744
buffer_load_dwordx4 v6, s[12:15], s72 offen offset:1024 lds
v_mfma_f32_16x16x32_bf16 v[144:147], v[72:75], v[32:35], v[144:147]
s_waitcnt lgkmcnt(8)
v_mfma_f32_16x16x32_bf16 v[160:163], v[80:83], v[32:35], v[160:163]
s_or_b32 s73, s73, s70
ds_read_b64_tr_b16 v[72:73], v13 offset:16384
v_mfma_f32_16x16x32_bf16 v[160:163], v[84:87], v[36:39], v[160:163]
s_lshl_b32 s73, s73, 7
ds_read_b64_tr_b16 v[74:75], v13 offset:17408
v_mfma_f32_16x16x32_bf16 v[164:167], v[84:87], v[44:47], v[164:167]
s_add_u32 s69, s73, s67
v_mfma_f32_16x16x32_bf16 v[164:167], v[80:83], v[40:43], v[164:167]
s_add_u32 s72, s71, 63488
buffer_load_dwordx4 v7, s[12:15], s72 offen offset:2048 lds
v_mfma_f32_16x16x32_bf16 v[168:171], v[80:83], v[48:51], v[168:171]
s_waitcnt vmcnt(18)
ds_read_b64_tr_b16 v[76:77], v13 offset:24576
v_mfma_f32_16x16x32_bf16 v[168:171], v[84:87], v[52:55], v[168:171]
s_add_u32 s70, s73, s68
ds_read_b128 v[96:99], v18 offset:32768
v_mfma_f32_16x16x32_bf16 v[172:175], v[84:87], v[60:63], v[172:175]
ds_read_b64_tr_b16 v[78:79], v13 offset:25600
v_mfma_f32_16x16x32_bf16 v[172:175], v[80:83], v[56:59], v[172:175]
s_waitcnt lgkmcnt(9)
ds_read_b128 v[100:103], v19 offset:32768
v_mfma_f32_16x16x32_bf16 v[188:191], v[88:91], v[56:59], v[188:191]
s_add_u32 s72, s71, 95232
buffer_load_dwordx4 v7, s[12:15], s72 offen offset:3072 lds
v_mfma_f32_16x16x32_bf16 v[188:191], v[92:95], v[60:63], v[188:191]
ds_read_b64_tr_b16 v[80:81], v14 offset:16384
v_mfma_f32_16x16x32_bf16 v[184:187], v[92:95], v[52:55], v[184:187]
ds_read_b64_tr_b16 v[82:83], v14 offset:17408
v_mfma_f32_16x16x32_bf16 v[184:187], v[88:91], v[48:51], v[184:187]
v_mfma_f32_16x16x32_bf16 v[180:183], v[88:91], v[40:43], v[180:183]
ds_read_b64_tr_b16 v[84:85], v14 offset:24576
v_mfma_f32_16x16x32_bf16 v[180:183], v[92:95], v[44:47], v[180:183]
s_add_u32 m0, s63, 65536
ds_read_b64_tr_b16 v[86:87], v14 offset:25600
v_mfma_f32_16x16x32_bf16 v[176:179], v[92:95], v[36:39], v[176:179]
s_add_u32 s72, s69, 0
buffer_load_dwordx4 v4, s[4:7], s72 offen lds
v_mfma_f32_16x16x32_bf16 v[176:179], v[88:91], v[32:35], v[176:179]
s_waitcnt lgkmcnt(10)
ds_read_b128 v[104:107], v18 offset:34816
v_mfma_f32_16x16x32_bf16 v[192:195], v[64:67], v[32:35], v[192:195]
ds_read_b64_tr_b16 v[88:89], v15 offset:16384
v_mfma_f32_16x16x32_bf16 v[192:195], v[68:71], v[36:39], v[192:195]
ds_read_b64_tr_b16 v[90:91], v15 offset:17408
v_mfma_f32_16x16x32_bf16 v[196:199], v[68:71], v[44:47], v[196:199]
ds_read_b64_tr_b16 v[92:93], v15 offset:24576
v_mfma_f32_16x16x32_bf16 v[196:199], v[64:67], v[40:43], v[196:199]
s_add_u32 s72, s69, 15360
buffer_load_dwordx4 v5, s[4:7], s72 offen offset:1024 lds
v_mfma_f32_16x16x32_bf16 v[200:203], v[64:67], v[48:51], v[200:203]
ds_read_b64_tr_b16 v[94:95], v15 offset:25600
v_mfma_f32_16x16x32_bf16 v[200:203], v[68:71], v[52:55], v[200:203]
ds_read_b128 v[108:111], v19 offset:34816
v_mfma_f32_16x16x32_bf16 v[204:207], v[68:71], v[60:63], v[204:207]
v_mfma_f32_16x16x32_bf16 v[204:207], v[64:67], v[56:59], v[204:207]
s_waitcnt lgkmcnt(11)
ds_read_b128 v[112:115], v18 offset:36864
v_mfma_f32_16x16x32_bf16 v[220:223], v[72:75], v[56:59], v[220:223]
s_add_u32 s72, s69, 129024
buffer_load_dwordx4 v4, s[4:7], s72 offen offset:2048 lds
v_mfma_f32_16x16x32_bf16 v[220:223], v[76:79], v[60:63], v[220:223]
v_mfma_f32_16x16x32_bf16 v[216:219], v[76:79], v[52:55], v[216:219]
s_waitcnt vmcnt(13) lgkmcnt(2)
ds_read_b128 v[116:119], v19 offset:36864
v_mfma_f32_16x16x32_bf16 v[216:219], v[72:75], v[48:51], v[216:219]
s_barrier
ds_read_b128 v[120:123], v18 offset:38912
v_mfma_f32_16x16x32_bf16 v[212:215], v[72:75], v[40:43], v[212:215]
ds_read_b64_tr_b16 v[64:65], v8 offset:32768
ds_read_b64_tr_b16 v[66:67], v8 offset:33792
v_mfma_f32_16x16x32_bf16 v[212:215], v[76:79], v[44:47], v[212:215]
ds_read_b64_tr_b16 v[68:69], v8 offset:40960
v_or_b32 v20, s58, v0
v_mfma_f32_16x16x32_bf16 v[208:211], v[76:79], v[36:39], v[208:211]
s_add_u32 s72, s69, 144384
buffer_load_dwordx4 v5, s[4:7], s72 offen offset:3072 lds
v_mfma_f32_16x16x32_bf16 v[208:211], v[72:75], v[32:35], v[208:211]
ds_read_b64_tr_b16 v[70:71], v8 offset:41984
v_mov_b32 v21, 1
v_mfma_f32_16x16x32_bf16 v[224:227], v[80:83], v[32:35], v[224:227]
ds_read_b64_tr_b16 v[72:73], v9 offset:32768
v_min_u32 v20, 1, v20
v_mfma_f32_16x16x32_bf16 v[224:227], v[84:87], v[36:39], v[224:227]
ds_read_b64_tr_b16 v[74:75], v9 offset:33792
v_lshlrev_b32 v20, 30, v20
v_mfma_f32_16x16x32_bf16 v[228:231], v[84:87], v[44:47], v[228:231]
s_add_u32 m0, s63, 69632
buffer_store_dword v21, v20, s[44:47], s91 offen sc1
v_mfma_f32_16x16x32_bf16 v[228:231], v[80:83], v[40:43], v[228:231]
s_add_u32 s72, s70, 0
buffer_load_dwordx4 v4, s[4:7], s72 offen lds
v_mfma_f32_16x16x32_bf16 v[232:235], v[80:83], v[48:51], v[232:235]
ds_read_b64_tr_b16 v[76:77], v9 offset:40960
v_accvgpr_write_b32 a32, 0
v_mfma_f32_16x16x32_bf16 v[232:235], v[84:87], v[52:55], v[232:235]
ds_read_b128 v[124:127], v19 offset:38912
v_accvgpr_write_b32 a33, 0
v_mfma_f32_16x16x32_bf16 v[236:239], v[84:87], v[60:63], v[236:239]
ds_read_b64_tr_b16 v[78:79], v9 offset:41984
v_accvgpr_write_b32 a34, 0
v_mfma_f32_16x16x32_bf16 v[236:239], v[80:83], v[56:59], v[236:239]
v_accvgpr_write_b32 a35, 0
v_accvgpr_write_b32 a36, 0
v_mfma_f32_16x16x32_bf16 v[252:255], v[88:91], v[56:59], v[252:255]
s_add_u32 s72, s70, 15360
buffer_load_dwordx4 v5, s[4:7], s72 offen offset:1024 lds
v_mfma_f32_16x16x32_bf16 v[252:255], v[92:95], v[60:63], v[252:255]
ds_read_b64_tr_b16 v[80:81], v10 offset:32768
v_accvgpr_write_b32 a37, 0
v_mfma_f32_16x16x32_bf16 v[248:251], v[92:95], v[52:55], v[248:251]
ds_read_b64_tr_b16 v[82:83], v10 offset:33792
v_accvgpr_write_b32 a38, 0
v_mfma_f32_16x16x32_bf16 v[248:251], v[88:91], v[48:51], v[248:251]
v_accvgpr_write_b32 a39, 0
v_accvgpr_write_b32 a40, 0
v_mfma_f32_16x16x32_bf16 v[244:247], v[88:91], v[40:43], v[244:247]
ds_read_b64_tr_b16 v[84:85], v10 offset:40960
v_accvgpr_write_b32 a41, 0
v_mfma_f32_16x16x32_bf16 v[244:247], v[92:95], v[44:47], v[244:247]
ds_read_b64_tr_b16 v[86:87], v10 offset:41984
v_accvgpr_write_b32 a42, 0
v_mfma_f32_16x16x32_bf16 v[240:243], v[92:95], v[36:39], v[240:243]
s_add_u32 s72, s70, 129024
buffer_load_dwordx4 v4, s[4:7], s72 offen offset:2048 lds
v_mfma_f32_16x16x32_bf16 v[240:243], v[88:91], v[32:35], v[240:243]
s_waitcnt lgkmcnt(5)
v_accvgpr_write_b32 a43, 0
v_accvgpr_write_b32 a44, 0
v_mfma_f32_16x16x32_bf16 v[128:131], v[64:67], v[96:99], v[128:131]
ds_read_b64_tr_b16 v[88:89], v11 offset:32768
v_accvgpr_write_b32 a45, 0
v_mfma_f32_16x16x32_bf16 v[128:131], v[68:71], v[100:103], v[128:131]
ds_read_b64_tr_b16 v[90:91], v11 offset:33792
v_accvgpr_write_b32 a46, 0
v_mfma_f32_16x16x32_bf16 v[132:135], v[68:71], v[108:111], v[132:135]
v_accvgpr_write_b32 a47, 0
v_accvgpr_write_b32 a48, 0
v_mfma_f32_16x16x32_bf16 v[132:135], v[64:67], v[104:107], v[132:135]
s_add_u32 s72, s70, 144384
buffer_load_dwordx4 v5, s[4:7], s72 offen offset:3072 lds
v_mfma_f32_16x16x32_bf16 v[136:139], v[64:67], v[112:115], v[136:139]
ds_read_b64_tr_b16 v[92:93], v11 offset:40960
v_accvgpr_write_b32 a49, 0
v_mfma_f32_16x16x32_bf16 v[136:139], v[68:71], v[116:119], v[136:139]
s_lshl_b32 s71, s73, 12
v_accvgpr_write_b32 a50, 0
v_accvgpr_write_b32 a51, 0
v_mfma_f32_16x16x32_bf16 v[140:143], v[68:71], v[124:127], v[140:143]
s_add_u32 s71, s71, s66
ds_read_b64_tr_b16 v[94:95], v11 offset:41984
v_accvgpr_write_b32 a52, 0
v_mfma_f32_16x16x32_bf16 v[140:143], v[64:67], v[120:123], v[140:143]
s_waitcnt lgkmcnt(8)
v_accvgpr_write_b32 a53, 0
v_accvgpr_write_b32 a54, 0
v_mfma_f32_16x16x32_bf16 v[156:159], v[72:75], v[120:123], v[156:159]
s_add_u32 m0, s64, 16384
ds_read_b64_tr_b16 v[64:65], v12 offset:32768
v_accvgpr_write_b32 a55, 0
v_mfma_f32_16x16x32_bf16 v[156:159], v[76:79], v[124:127], v[156:159]
s_add_u32 s72, s71, 0
buffer_load_dwordx4 v6, s[12:15], s72 offen lds
v_mfma_f32_16x16x32_bf16 v[152:155], v[76:79], v[116:119], v[152:155]
s_add_u32 s73, s62, 14
ds_read_b64_tr_b16 v[66:67], v12 offset:33792
v_accvgpr_write_b32 a56, 0
v_mfma_f32_16x16x32_bf16 v[152:155], v[72:75], v[112:115], v[152:155]
s_add_u32 s70, s73, s65
v_accvgpr_write_b32 a57, 0
v_accvgpr_write_b32 a58, 0
v_mfma_f32_16x16x32_bf16 v[148:151], v[72:75], v[104:107], v[148:151]
s_and_b32 s70, s70, 3
ds_read_b64_tr_b16 v[68:69], v12 offset:40960
v_accvgpr_write_b32 a59, 0
v_mfma_f32_16x16x32_bf16 v[148:151], v[76:79], v[108:111], v[148:151]
s_and_b32 s73, s73, 12
ds_read_b64_tr_b16 v[70:71], v12 offset:41984
v_accvgpr_write_b32 a60, 0
v_mfma_f32_16x16x32_bf16 v[144:147], v[76:79], v[100:103], v[144:147]
s_add_u32 s72, s71, 31744
buffer_load_dwordx4 v6, s[12:15], s72 offen offset:1024 lds
v_mfma_f32_16x16x32_bf16 v[144:147], v[72:75], v[96:99], v[144:147]
s_waitcnt lgkmcnt(8)
v_accvgpr_write_b32 a61, 0
v_accvgpr_write_b32 a62, 0
v_mfma_f32_16x16x32_bf16 v[160:163], v[80:83], v[96:99], v[160:163]
s_or_b32 s73, s73, s70
ds_read_b64_tr_b16 v[72:73], v13 offset:32768
v_accvgpr_write_b32 a63, 0
v_mfma_f32_16x16x32_bf16 v[160:163], v[84:87], v[100:103], v[160:163]
s_lshl_b32 s73, s73, 7
ds_read_b64_tr_b16 v[74:75], v13 offset:33792
v_accvgpr_write_b32 a96, 0
v_mfma_f32_16x16x32_bf16 v[164:167], v[84:87], v[108:111], v[164:167]
s_add_u32 s69, s73, s67
v_accvgpr_write_b32 a97, 0
v_accvgpr_write_b32 a98, 0
v_mfma_f32_16x16x32_bf16 v[164:167], v[80:83], v[104:107], v[164:167]
s_add_u32 s72, s71, 63488
buffer_load_dwordx4 v7, s[12:15], s72 offen offset:2048 lds
v_mfma_f32_16x16x32_bf16 v[168:171], v[80:83], v[112:115], v[168:171]
s_waitcnt vmcnt(16)
ds_read_b64_tr_b16 v[76:77], v13 offset:40960
v_accvgpr_write_b32 a99, 0
v_mfma_f32_16x16x32_bf16 v[168:171], v[84:87], v[116:119], v[168:171]
s_add_u32 s70, s73, s68
ds_read_b128 v[32:35], v16 offset:0
v_accvgpr_write_b32 a100, 0
v_mfma_f32_16x16x32_bf16 v[172:175], v[84:87], v[124:127], v[172:175]
ds_read_b64_tr_b16 v[78:79], v13 offset:41984
v_accvgpr_write_b32 a101, 0
v_mfma_f32_16x16x32_bf16 v[172:175], v[80:83], v[120:123], v[172:175]
s_waitcnt lgkmcnt(9)
ds_read_b128 v[36:39], v17 offset:0
v_accvgpr_write_b32 a102, 0
v_mfma_f32_16x16x32_bf16 v[188:191], v[88:91], v[120:123], v[188:191]
s_add_u32 s72, s71, 95232
buffer_load_dwordx4 v7, s[12:15], s72 offen offset:3072 lds
v_mfma_f32_16x16x32_bf16 v[188:191], v[92:95], v[124:127], v[188:191]
ds_read_b64_tr_b16 v[80:81], v14 offset:32768
v_accvgpr_write_b32 a103, 0
v_mfma_f32_16x16x32_bf16 v[184:187], v[92:95], v[116:119], v[184:187]
ds_read_b64_tr_b16 v[82:83], v14 offset:33792
v_accvgpr_write_b32 a104, 0
v_mfma_f32_16x16x32_bf16 v[184:187], v[88:91], v[112:115], v[184:187]
v_accvgpr_write_b32 a105, 0
v_accvgpr_write_b32 a106, 0
v_mfma_f32_16x16x32_bf16 v[180:183], v[88:91], v[104:107], v[180:183]
ds_read_b64_tr_b16 v[84:85], v14 offset:40960
v_accvgpr_write_b32 a107, 0
v_mfma_f32_16x16x32_bf16 v[180:183], v[92:95], v[108:111], v[180:183]
s_add_u32 m0, s63, 98304
ds_read_b64_tr_b16 v[86:87], v14 offset:41984
v_accvgpr_write_b32 a108, 0
v_mfma_f32_16x16x32_bf16 v[176:179], v[92:95], v[100:103], v[176:179]
s_add_u32 s72, s69, 0
buffer_load_dwordx4 v4, s[4:7], s72 offen lds
v_mfma_f32_16x16x32_bf16 v[176:179], v[88:91], v[96:99], v[176:179]
s_waitcnt lgkmcnt(10)
ds_read_b128 v[40:43], v16 offset:2048
v_accvgpr_write_b32 a109, 0
v_mfma_f32_16x16x32_bf16 v[192:195], v[64:67], v[96:99], v[192:195]
ds_read_b64_tr_b16 v[88:89], v15 offset:32768
v_accvgpr_write_b32 a110, 0
v_mfma_f32_16x16x32_bf16 v[192:195], v[68:71], v[100:103], v[192:195]
ds_read_b64_tr_b16 v[90:91], v15 offset:33792
v_accvgpr_write_b32 a111, 0
v_mfma_f32_16x16x32_bf16 v[196:199], v[68:71], v[108:111], v[196:199]
ds_read_b64_tr_b16 v[92:93], v15 offset:40960
v_accvgpr_write_b32 a112, 0
v_mfma_f32_16x16x32_bf16 v[196:199], v[64:67], v[104:107], v[196:199]
s_add_u32 s72, s69, 15360
buffer_load_dwordx4 v5, s[4:7], s72 offen offset:1024 lds
v_mfma_f32_16x16x32_bf16 v[200:203], v[64:67], v[112:115], v[200:203]
ds_read_b64_tr_b16 v[94:95], v15 offset:41984
v_accvgpr_write_b32 a113, 0
v_mfma_f32_16x16x32_bf16 v[200:203], v[68:71], v[116:119], v[200:203]
ds_read_b128 v[44:47], v17 offset:2048
v_accvgpr_write_b32 a114, 0
v_mfma_f32_16x16x32_bf16 v[204:207], v[68:71], v[124:127], v[204:207]
v_accvgpr_write_b32 a115, 0
v_accvgpr_write_b32 a116, 0
v_mfma_f32_16x16x32_bf16 v[204:207], v[64:67], v[120:123], v[204:207]
s_waitcnt lgkmcnt(11)
ds_read_b128 v[48:51], v16 offset:4096
v_accvgpr_write_b32 a117, 0
v_mfma_f32_16x16x32_bf16 v[220:223], v[72:75], v[120:123], v[220:223]
s_add_u32 s72, s69, 129024
buffer_load_dwordx4 v4, s[4:7], s72 offen offset:2048 lds
v_mfma_f32_16x16x32_bf16 v[220:223], v[76:79], v[124:127], v[220:223]
v_accvgpr_write_b32 a118, 0
v_accvgpr_write_b32 a119, 0
v_mfma_f32_16x16x32_bf16 v[216:219], v[76:79], v[116:119], v[216:219]
s_waitcnt vmcnt(16) lgkmcnt(2)
ds_read_b128 v[52:55], v17 offset:4096
v_accvgpr_write_b32 a120, 0
v_mfma_f32_16x16x32_bf16 v[216:219], v[72:75], v[112:115], v[216:219]
s_barrier
ds_read_b128 v[56:59], v16 offset:6144
v_accvgpr_write_b32 a121, 0
v_mfma_f32_16x16x32_bf16 v[212:215], v[72:75], v[104:107], v[212:215]
s_waitcnt vmcnt(24)
v_cmp_gt_u32 vcc, 8, v3
s_cbranch_vccnz Lspin1
Lback2:
v_mfma_f32_16x16x32_bf16 v[212:215], v[76:79], v[108:111], v[212:215]
ds_read_b64_tr_b16 v[64:65], v8 offset:0
ds_read_b64_tr_b16 v[66:67], v8 offset:1024
v_mfma_f32_16x16x32_bf16 v[208:211], v[76:79], v[100:103], v[208:211]
s_add_u32 s72, s69, 144384
buffer_load_dwordx4 v5, s[4:7], s72 offen offset:3072 lds
v_mfma_f32_16x16x32_bf16 v[208:211], v[72:75], v[96:99], v[208:211]
ds_read_b64_tr_b16 v[68:69], v8 offset:8192
ds_read_b64_tr_b16 v[70:71], v8 offset:9216
v_mfma_f32_16x16x32_bf16 v[224:227], v[80:83], v[96:99], v[224:227]
ds_read_b64_tr_b16 v[72:73], v9 offset:0
v_accvgpr_write_b32 a122, 0
v_mfma_f32_16x16x32_bf16 v[224:227], v[84:87], v[100:103], v[224:227]
ds_read_b64_tr_b16 v[74:75], v9 offset:1024
v_accvgpr_write_b32 a123, 0
v_mfma_f32_16x16x32_bf16 v[228:231], v[84:87], v[108:111], v[228:231]
s_add_u32 m0, s63, 102400
v_accvgpr_write_b32 a124, 0
v_accvgpr_write_b32 a125, 0
v_mfma_f32_16x16x32_bf16 v[228:231], v[80:83], v[104:107], v[228:231]
s_add_u32 s72, s70, 0
buffer_load_dwordx4 v4, s[4:7], s72 offen lds
v_mfma_f32_16x16x32_bf16 v[232:235], v[80:83], v[112:115], v[232:235]
ds_read_b64_tr_b16 v[76:77], v9 offset:8192
v_accvgpr_write_b32 a126, 0
v_mfma_f32_16x16x32_bf16 v[232:235], v[84:87], v[116:119], v[232:235]
ds_read_b128 v[60:63], v17 offset:6144
v_accvgpr_write_b32 a127, 0
v_mfma_f32_16x16x32_bf16 v[236:239], v[84:87], v[124:127], v[236:239]
ds_read_b64_tr_b16 v[78:79], v9 offset:9216
v_mfma_f32_16x16x32_bf16 v[236:239], v[80:83], v[120:123], v[236:239]
v_mfma_f32_16x16x32_bf16 v[252:255], v[88:91], v[120:123], v[252:255]
s_add_u32 s72, s70, 15360
buffer_load_dwordx4 v5, s[4:7], s72 offen offset:1024 lds
v_mfma_f32_16x16x32_bf16 v[252:255], v[92:95], v[124:127], v[252:255]
ds_read_b64_tr_b16 v[80:81], v10 offset:0
v_mfma_f32_16x16x32_bf16 v[248:251], v[92:95], v[116:119], v[248:251]
ds_read_b64_tr_b16 v[82:83], v10 offset:1024
v_mfma_f32_16x16x32_bf16 v[248:251], v[88:91], v[112:115], v[248:251]
v_mfma_f32_16x16x32_bf16 v[244:247], v[88:91], v[104:107], v[244:247]
ds_read_b64_tr_b16 v[84:85], v10 offset:8192
v_mfma_f32_16x16x32_bf16 v[244:247], v[92:95], v[108:111], v[244:247]
ds_read_b64_tr_b16 v[86:87], v10 offset:9216
v_mfma_f32_16x16x32_bf16 v[240:243], v[92:95], v[100:103], v[240:243]
s_add_u32 s72, s70, 129024
buffer_load_dwordx4 v4, s[4:7], s72 offen offset:2048 lds
v_mfma_f32_16x16x32_bf16 v[240:243], v[88:91], v[96:99], v[240:243]
s_waitcnt lgkmcnt(5)
v_mfma_f32_16x16x32_bf16 v[128:131], v[64:67], v[32:35], v[128:131]
ds_read_b64_tr_b16 v[88:89], v11 offset:0
v_mfma_f32_16x16x32_bf16 v[128:131], v[68:71], v[36:39], v[128:131]
ds_read_b64_tr_b16 v[90:91], v11 offset:1024
v_mfma_f32_16x16x32_bf16 v[132:135], v[68:71], v[44:47], v[132:135]
v_mfma_f32_16x16x32_bf16 v[132:135], v[64:67], v[40:43], v[132:135]
s_add_u32 s72, s70, 144384
buffer_load_dwordx4 v5, s[4:7], s72 offen offset:3072 lds
v_mfma_f32_16x16x32_bf16 v[136:139], v[64:67], v[48:51], v[136:139]
ds_read_b64_tr_b16 v[92:93], v11 offset:8192
v_mfma_f32_16x16x32_bf16 v[136:139], v[68:71], v[52:55], v[136:139]
s_lshl_b32 s71, s73, 12
v_mfma_f32_16x16x32_bf16 v[140:143], v[68:71], v[60:63], v[140:143]
s_add_u32 s71, s71, s66
ds_read_b64_tr_b16 v[94:95], v11 offset:9216
v_mfma_f32_16x16x32_bf16 v[140:143], v[64:67], v[56:59], v[140:143]
s_waitcnt lgkmcnt(8)
v_mfma_f32_16x16x32_bf16 v[156:159], v[72:75], v[56:59], v[156:159]
s_add_u32 m0, s64, 32768
ds_read_b64_tr_b16 v[64:65], v12 offset:0
v_mfma_f32_16x16x32_bf16 v[156:159], v[76:79], v[60:63], v[156:159]
s_add_u32 s72, s71, 0
buffer_load_dwordx4 v6, s[12:15], s72 offen lds
v_mfma_f32_16x16x32_bf16 v[152:155], v[76:79], v[52:55], v[152:155]
s_add_u32 s73, s62, 15
ds_read_b64_tr_b16 v[66:67], v12 offset:1024
v_mfma_f32_16x16x32_bf16 v[152:155], v[72:75], v[48:51], v[152:155]
s_add_u32 s70, s73, s65
v_mfma_f32_16x16x32_bf16 v[148:151], v[72:75], v[40:43], v[148:151]
s_and_b32 s70, s70, 3
ds_read_b64_tr_b16 v[68:69], v12 offset:8192
v_mfma_f32_16x16x32_bf16 v[148:151], v[76:79], v[44:47], v[148:151]
s_and_b32 s73, s73, 12
ds_read_b64_tr_b16 v[70:71], v12 offset:9216
v_mfma_f32_16x16x32_bf16 v[144:147], v[76:79], v[36:39], v[144:147]
s_add_u32 s72, s71, 31744
buffer_load_dwordx4 v6, s[12:15], s72 offen offset:1024 lds
v_mfma_f32_16x16x32_bf16 v[144:147], v[72:75], v[32:35], v[144:147]
s_waitcnt lgkmcnt(8)
v_mfma_f32_16x16x32_bf16 v[160:163], v[80:83], v[32:35], v[160:163]
s_or_b32 s73, s73, s70
ds_read_b64_tr_b16 v[72:73], v13 offset:0
v_mfma_f32_16x16x32_bf16 v[160:163], v[84:87], v[36:39], v[160:163]
s_lshl_b32 s73, s73, 7
ds_read_b64_tr_b16 v[74:75], v13 offset:1024
v_mfma_f32_16x16x32_bf16 v[164:167], v[84:87], v[44:47], v[164:167]
s_add_u32 s69, s73, s67
v_mfma_f32_16x16x32_bf16 v[164:167], v[80:83], v[40:43], v[164:167]
s_add_u32 s72, s71, 63488
buffer_load_dwordx4 v7, s[12:15], s72 offen offset:2048 lds
v_mfma_f32_16x16x32_bf16 v[168:171], v[80:83], v[48:51], v[168:171]
s_waitcnt vmcnt(15)
ds_read_b64_tr_b16 v[76:77], v13 offset:8192
v_mfma_f32_16x16x32_bf16 v[168:171], v[84:87], v[52:55], v[168:171]
s_add_u32 s70, s73, s68
ds_read_b128 v[96:99], v18 offset:0
v_mfma_f32_16x16x32_bf16 v[172:175], v[84:87], v[60:63], v[172:175]
ds_read_b64_tr_b16 v[78:79], v13 offset:9216
v_mfma_f32_16x16x32_bf16 v[172:175], v[80:83], v[56:59], v[172:175]
s_waitcnt lgkmcnt(9)
ds_read_b128 v[100:103], v19 offset:0
v_mfma_f32_16x16x32_bf16 v[188:191], v[88:91], v[56:59], v[188:191]
s_add_u32 s72, s71, 95232
buffer_load_dwordx4 v7, s[12:15], s72 offen offset:3072 lds
v_mfma_f32_16x16x32_bf16 v[188:191], v[92:95], v[60:63], v[188:191]
ds_read_b64_tr_b16 v[80:81], v14 offset:0
v_mfma_f32_16x16x32_bf16 v[184:187], v[92:95], v[52:55], v[184:187]
ds_read_b64_tr_b16 v[82:83], v14 offset:1024
v_mfma_f32_16x16x32_bf16 v[184:187], v[88:91], v[48:51], v[184:187]
v_mfma_f32_16x16x32_bf16 v[180:183], v[88:91], v[40:43], v[180:183]
ds_read_b64_tr_b16 v[84:85], v14 offset:8192
v_mfma_f32_16x16x32_bf16 v[180:183], v[92:95], v[44:47], v[180:183]
s_add_u32 m0, s63, 131072
ds_read_b64_tr_b16 v[86:87], v14 offset:9216
v_mfma_f32_16x16x32_bf16 v[176:179], v[92:95], v[36:39], v[176:179]
s_add_u32 s72, s69, 0
buffer_load_dwordx4 v4, s[4:7], s72 offen lds
v_mfma_f32_16x16x32_bf16 v[176:179], v[88:91], v[32:35], v[176:179]
s_waitcnt lgkmcnt(10)
ds_read_b128 v[104:107], v18 offset:2048
v_mfma_f32_16x16x32_bf16 v[192:195], v[64:67], v[32:35], v[192:195]
ds_read_b64_tr_b16 v[88:89], v15 offset:0
ds_read_b64_tr_b16 v[90:91], v15 offset:1024
v_mfma_f32_16x16x32_bf16 v[192:195], v[68:71], v[36:39], v[192:195]
ds_read_b64_tr_b16 v[92:93], v15 offset:8192
v_mfma_f32_16x16x32_bf16 v[196:199], v[68:71], v[44:47], v[196:199]
s_and_b32 s75, s91, 0xfffffc7f
v_lshrrev_b32 v2, 3, v0
v_lshlrev_b32 v2, 7, v2
v_mfma_f32_16x16x32_bf16 v[196:199], v[64:67], v[40:43], v[196:199]
s_add_u32 s72, s69, 15360
buffer_load_dwordx4 v5, s[4:7], s72 offen offset:1024 lds
v_mfma_f32_16x16x32_bf16 v[200:203], v[64:67], v[48:51], v[200:203]
buffer_load_dword v3, v2, s[44:47], s75 offen sc1
v_mfma_f32_16x16x32_bf16 v[200:203], v[68:71], v[52:55], v[200:203]
ds_read_b64_tr_b16 v[94:95], v15 offset:9216
v_mfma_f32_16x16x32_bf16 v[204:207], v[68:71], v[60:63], v[204:207]
ds_read_b128 v[108:111], v19 offset:2048
v_mfma_f32_16x16x32_bf16 v[204:207], v[64:67], v[56:59], v[204:207]
s_waitcnt lgkmcnt(11)
v_mfma_f32_16x16x32_bf16 v[220:223], v[72:75], v[56:59], v[220:223]
s_add_u32 s72, s69, 129024
buffer_load_dwordx4 v4, s[4:7], s72 offen offset:2048 lds
v_mfma_f32_16x16x32_bf16 v[220:223], v[76:79], v[60:63], v[220:223]
ds_read_b128 v[112:115], v18 offset:4096
v_mfma_f32_16x16x32_bf16 v[216:219], v[76:79], v[52:55], v[216:219]
s_waitcnt vmcnt(16) lgkmcnt(2)
ds_read_b128 v[116:119], v19 offset:4096
v_mfma_f32_16x16x32_bf16 v[216:219], v[72:75], v[48:51], v[216:219]
s_barrier
v_mfma_f32_16x16x32_bf16 v[212:215], v[72:75], v[40:43], v[212:215]
ds_read_b64_tr_b16 v[64:65], v8 offset:16384
ds_read_b64_tr_b16 v[66:67], v8 offset:17408
v_mfma_f32_16x16x32_bf16 v[212:215], v[76:79], v[44:47], v[212:215]
ds_read_b64_tr_b16 v[68:69], v8 offset:24576
v_mfma_f32_16x16x32_bf16 v[208:211], v[76:79], v[36:39], v[208:211]
s_add_u32 s72, s69, 144384
buffer_load_dwordx4 v5, s[4:7], s72 offen offset:3072 lds
v_mfma_f32_16x16x32_bf16 v[208:211], v[72:75], v[32:35], v[208:211]
ds_read_b64_tr_b16 v[70:71], v8 offset:25600
v_mfma_f32_16x16x32_bf16 v[224:227], v[80:83], v[32:35], v[224:227]
ds_read_b64_tr_b16 v[72:73], v9 offset:16384
v_mfma_f32_16x16x32_bf16 v[224:227], v[84:87], v[36:39], v[224:227]
ds_read_b64_tr_b16 v[74:75], v9 offset:17408
v_mfma_f32_16x16x32_bf16 v[228:231], v[84:87], v[44:47], v[228:231]
s_add_u32 m0, s63, 135168
ds_read_b128 v[120:123], v18 offset:6144
v_mfma_f32_16x16x32_bf16 v[228:231], v[80:83], v[40:43], v[228:231]
s_add_u32 s72, s70, 0
buffer_load_dwordx4 v4, s[4:7], s72 offen lds
v_mfma_f32_16x16x32_bf16 v[232:235], v[80:83], v[48:51], v[232:235]
ds_read_b64_tr_b16 v[76:77], v9 offset:24576
v_mfma_f32_16x16x32_bf16 v[232:235], v[84:87], v[52:55], v[232:235]
ds_read_b128 v[124:127], v19 offset:6144
v_mfma_f32_16x16x32_bf16 v[236:239], v[84:87], v[60:63], v[236:239]
ds_read_b64_tr_b16 v[78:79], v9 offset:25600
v_mfma_f32_16x16x32_bf16 v[236:239], v[80:83], v[56:59], v[236:239]
v_mfma_f32_16x16x32_bf16 v[252:255], v[88:91], v[56:59], v[252:255]
s_add_u32 s72, s70, 15360
buffer_load_dwordx4 v5, s[4:7], s72 offen offset:1024 lds
v_mfma_f32_16x16x32_bf16 v[252:255], v[92:95], v[60:63], v[252:255]
ds_read_b64_tr_b16 v[80:81], v10 offset:16384
v_mfma_f32_16x16x32_bf16 v[248:251], v[92:95], v[52:55], v[248:251]
ds_read_b64_tr_b16 v[82:83], v10 offset:17408
v_mfma_f32_16x16x32_bf16 v[248:251], v[88:91], v[48:51], v[248:251]
v_mfma_f32_16x16x32_bf16 v[244:247], v[88:91], v[40:43], v[244:247]
ds_read_b64_tr_b16 v[84:85], v10 offset:24576
v_mfma_f32_16x16x32_bf16 v[244:247], v[92:95], v[44:47], v[244:247]
ds_read_b64_tr_b16 v[86:87], v10 offset:25600
v_mfma_f32_16x16x32_bf16 v[240:243], v[92:95], v[36:39], v[240:243]
s_add_u32 s72, s70, 129024
buffer_load_dwordx4 v4, s[4:7], s72 offen offset:2048 lds
v_mfma_f32_16x16x32_bf16 v[240:243], v[88:91], v[32:35], v[240:243]
s_waitcnt lgkmcnt(5)
v_mfma_f32_16x16x32_bf16 v[128:131], v[64:67], v[96:99], v[128:131]
ds_read_b64_tr_b16 v[88:89], v11 offset:16384
v_mfma_f32_16x16x32_bf16 v[128:131], v[68:71], v[100:103], v[128:131]
ds_read_b64_tr_b16 v[90:91], v11 offset:17408
v_mfma_f32_16x16x32_bf16 v[132:135], v[68:71], v[108:111], v[132:135]
v_mfma_f32_16x16x32_bf16 v[132:135], v[64:67], v[104:107], v[132:135]
s_add_u32 s72, s70, 144384
buffer_load_dwordx4 v5, s[4:7], s72 offen offset:3072 lds
v_mfma_f32_16x16x32_bf16 v[136:139], v[64:67], v[112:115], v[136:139]
ds_read_b64_tr_b16 v[92:93], v11 offset:24576
v_mfma_f32_16x16x32_bf16 v[136:139], v[68:71], v[116:119], v[136:139]
s_lshl_b32 s71, s73, 12
v_mfma_f32_16x16x32_bf16 v[140:143], v[68:71], v[124:127], v[140:143]
s_add_u32 s71, s71, s66
ds_read_b64_tr_b16 v[94:95], v11 offset:25600
v_mfma_f32_16x16x32_bf16 v[140:143], v[64:67], v[120:123], v[140:143]
s_waitcnt lgkmcnt(8)
v_mfma_f32_16x16x32_bf16 v[156:159], v[72:75], v[120:123], v[156:159]
s_add_u32 m0, s64, 0
ds_read_b64_tr_b16 v[64:65], v12 offset:16384
v_mfma_f32_16x16x32_bf16 v[156:159], v[76:79], v[124:127], v[156:159]
s_add_u32 s72, s71, 0
buffer_load_dwordx4 v6, s[12:15], s72 offen lds
v_mfma_f32_16x16x32_bf16 v[152:155], v[76:79], v[116:119], v[152:155]
ds_read_b64_tr_b16 v[66:67], v12 offset:17408
v_mfma_f32_16x16x32_bf16 v[152:155], v[72:75], v[112:115], v[152:155]
v_mfma_f32_16x16x32_bf16 v[148:151], v[72:75], v[104:107], v[148:151]
ds_read_b64_tr_b16 v[68:69], v12 offset:24576
v_mfma_f32_16x16x32_bf16 v[148:151], v[76:79], v[108:111], v[148:151]
ds_read_b64_tr_b16 v[70:71], v12 offset:25600
v_mfma_f32_16x16x32_bf16 v[144:147], v[76:79], v[100:103], v[144:147]
s_add_u32 s72, s71, 31744
buffer_load_dwordx4 v6, s[12:15], s72 offen offset:1024 lds
v_mfma_f32_16x16x32_bf16 v[144:147], v[72:75], v[96:99], v[144:147]
s_waitcnt lgkmcnt(8)
v_mfma_f32_16x16x32_bf16 v[160:163], v[80:83], v[96:99], v[160:163]
ds_read_b64_tr_b16 v[72:73], v13 offset:16384
v_mfma_f32_16x16x32_bf16 v[160:163], v[84:87], v[100:103], v[160:163]
ds_read_b64_tr_b16 v[74:75], v13 offset:17408
v_mfma_f32_16x16x32_bf16 v[164:167], v[84:87], v[108:111], v[164:167]
v_mfma_f32_16x16x32_bf16 v[164:167], v[80:83], v[104:107], v[164:167]
s_add_u32 s72, s71, 63488
buffer_load_dwordx4 v7, s[12:15], s72 offen offset:2048 lds
v_mfma_f32_16x16x32_bf16 v[168:171], v[80:83], v[112:115], v[168:171]
s_waitcnt vmcnt(16)
ds_read_b64_tr_b16 v[76:77], v13 offset:24576
v_mfma_f32_16x16x32_bf16 v[168:171], v[84:87], v[116:119], v[168:171]
ds_read_b128 v[32:35], v18 offset:32768
v_mfma_f32_16x16x32_bf16 v[172:175], v[84:87], v[124:127], v[172:175]
ds_read_b64_tr_b16 v[78:79], v13 offset:25600
v_mfma_f32_16x16x32_bf16 v[172:175], v[80:83], v[120:123], v[172:175]
s_waitcnt lgkmcnt(9)
ds_read_b128 v[36:39], v19 offset:32768
v_mfma_f32_16x16x32_bf16 v[188:191], v[88:91], v[120:123], v[188:191]
s_add_u32 s72, s71, 95232
buffer_load_dwordx4 v7, s[12:15], s72 offen offset:3072 lds
v_mfma_f32_16x16x32_bf16 v[188:191], v[92:95], v[124:127], v[188:191]
v_accvgpr_write_b32 a0, -1
v_accvgpr_write_b32 a1, -1
v_mfma_f32_16x16x32_bf16 v[184:187], v[92:95], v[116:119], v[184:187]
v_accvgpr_write_b32 a2, -1
v_accvgpr_write_b32 a3, -1
v_mfma_f32_16x16x32_bf16 v[184:187], v[88:91], v[112:115], v[184:187]
s_add_u32 s80, s93, 0x3a00000
ds_read_b64_tr_b16 v[80:81], v14 offset:16384
v_mfma_f32_16x16x32_bf16 v[180:183], v[88:91], v[104:107], v[180:183]
ds_read_b64_tr_b16 v[82:83], v14 offset:17408
v_mfma_f32_16x16x32_bf16 v[180:183], v[92:95], v[108:111], v[180:183]
ds_read_b64_tr_b16 v[84:85], v14 offset:24576
v_mfma_f32_16x16x32_bf16 v[176:179], v[92:95], v[100:103], v[176:179]
ds_read_b64_tr_b16 v[86:87], v14 offset:25600
v_mfma_f32_16x16x32_bf16 v[176:179], v[88:91], v[96:99], v[176:179]
s_waitcnt lgkmcnt(10)
ds_read_b128 v[40:43], v18 offset:34816
v_mfma_f32_16x16x32_bf16 v[192:195], v[64:67], v[96:99], v[192:195]
s_waitcnt vmcnt(10)
v_cmp_gt_u32 vcc, 1, v3
s_cbranch_vccnz Lspin4
Lback5:
v_mfma_f32_16x16x32_bf16 v[192:195], v[68:71], v[100:103], v[192:195]
s_add_u32 m0, s64, 49152
ds_read_b64_tr_b16 v[88:89], v15 offset:16384
ds_read_b64_tr_b16 v[90:91], v15 offset:17408
v_mfma_f32_16x16x32_bf16 v[196:199], v[68:71], v[108:111], v[196:199]
s_add_u32 s72, s81, 16384
buffer_load_dwordx4 v1, s[44:47], s72 offen sc1 lds
v_mfma_f32_16x16x32_bf16 v[196:199], v[64:67], v[104:107], v[196:199]
ds_read_b64_tr_b16 v[92:93], v15 offset:24576
v_mfma_f32_16x16x32_bf16 v[200:203], v[64:67], v[112:115], v[200:203]
ds_read_b64_tr_b16 v[94:95], v15 offset:25600
v_mfma_f32_16x16x32_bf16 v[200:203], v[68:71], v[116:119], v[200:203]
buffer_load_dwordx4 v1, s[44:47], s72 offen offset:1024 sc1 lds
v_mfma_f32_16x16x32_bf16 v[204:207], v[68:71], v[124:127], v[204:207]
ds_read_b128 v[44:47], v19 offset:34816
v_mfma_f32_16x16x32_bf16 v[204:207], v[64:67], v[120:123], v[204:207]
s_waitcnt lgkmcnt(11)
v_mfma_f32_16x16x32_bf16 v[220:223], v[72:75], v[120:123], v[220:223]
ds_read_b128 v[48:51], v18 offset:36864
v_mfma_f32_16x16x32_bf16 v[220:223], v[76:79], v[124:127], v[220:223]
ds_read_b128 v[52:55], v19 offset:36864
v_mfma_f32_16x16x32_bf16 v[216:219], v[76:79], v[116:119], v[216:219]
s_waitcnt vmcnt(15) lgkmcnt(3)
buffer_load_dwordx4 v1, s[44:47], s72 offen offset:2048 sc1 lds
v_mfma_f32_16x16x32_bf16 v[216:219], v[72:75], v[112:115], v[216:219]
s_barrier
ds_read_b128 v[56:59], v18 offset:38912
v_mfma_f32_16x16x32_bf16 v[212:215], v[72:75], v[104:107], v[212:215]
ds_read_b64_tr_b16 v[64:65], v8 offset:32768
ds_read_b64_tr_b16 v[66:67], v8 offset:33792
v_mfma_f32_16x16x32_bf16 v[212:215], v[76:79], v[108:111], v[212:215]
ds_read_b64_tr_b16 v[68:69], v8 offset:40960
v_mfma_f32_16x16x32_bf16 v[208:211], v[76:79], v[100:103], v[208:211]
ds_read_b64_tr_b16 v[70:71], v8 offset:41984
v_mfma_f32_16x16x32_bf16 v[208:211], v[72:75], v[96:99], v[208:211]
buffer_load_dwordx4 v1, s[44:47], s72 offen offset:3072 sc1 lds
v_mfma_f32_16x16x32_bf16 v[224:227], v[80:83], v[96:99], v[224:227]
s_add_u32 s81, s81, 0x8000
ds_read_b64_tr_b16 v[72:73], v9 offset:32768
v_mfma_f32_16x16x32_bf16 v[224:227], v[84:87], v[100:103], v[224:227]
s_add_u32 m0, s64, 81920
ds_read_b64_tr_b16 v[74:75], v9 offset:33792
v_mfma_f32_16x16x32_bf16 v[228:231], v[84:87], v[108:111], v[228:231]
s_add_u32 s72, s81, 16384
buffer_load_dwordx4 v1, s[44:47], s72 offen sc1 lds
v_mfma_f32_16x16x32_bf16 v[228:231], v[80:83], v[104:107], v[228:231]
ds_read_b128 v[60:63], v19 offset:38912
v_mfma_f32_16x16x32_bf16 v[232:235], v[80:83], v[112:115], v[232:235]
buffer_load_dwordx4 v1, s[44:47], s72 offen offset:1024 sc1 lds
v_mfma_f32_16x16x32_bf16 v[232:235], v[84:87], v[116:119], v[232:235]
ds_read_b64_tr_b16 v[76:77], v9 offset:40960
v_mfma_f32_16x16x32_bf16 v[236:239], v[84:87], v[124:127], v[236:239]
ds_read_b64_tr_b16 v[78:79], v9 offset:41984
v_mfma_f32_16x16x32_bf16 v[236:239], v[80:83], v[120:123], v[236:239]
v_mfma_f32_16x16x32_bf16 v[252:255], v[88:91], v[120:123], v[252:255]
ds_read_b64_tr_b16 v[80:81], v10 offset:32768
v_mfma_f32_16x16x32_bf16 v[252:255], v[92:95], v[124:127], v[252:255]
buffer_load_dwordx4 v1, s[44:47], s72 offen offset:2048 sc1 lds
v_mfma_f32_16x16x32_bf16 v[248:251], v[92:95], v[116:119], v[248:251]
ds_read_b64_tr_b16 v[82:83], v10 offset:33792
v_mfma_f32_16x16x32_bf16 v[248:251], v[88:91], v[112:115], v[248:251]
v_mfma_f32_16x16x32_bf16 v[244:247], v[88:91], v[104:107], v[244:247]
ds_read_b64_tr_b16 v[84:85], v10 offset:40960
v_mfma_f32_16x16x32_bf16 v[244:247], v[92:95], v[108:111], v[244:247]
buffer_load_dwordx4 v1, s[44:47], s72 offen offset:3072 sc1 lds
v_mfma_f32_16x16x32_bf16 v[240:243], v[92:95], v[100:103], v[240:243]
ds_read_b64_tr_b16 v[86:87], v10 offset:41984
v_mfma_f32_16x16x32_bf16 v[240:243], v[88:91], v[96:99], v[240:243]
s_waitcnt lgkmcnt(6)
v_mfma_f32_16x16x32_bf16 v[128:131], v[64:67], v[32:35], v[128:131]
ds_read_b64_tr_b16 v[88:89], v11 offset:32768
v_mfma_f32_16x16x32_bf16 v[128:131], v[68:71], v[36:39], v[128:131]
ds_read_b64_tr_b16 v[90:91], v11 offset:33792
v_mfma_f32_16x16x32_bf16 v[132:135], v[68:71], v[44:47], v[132:135]
s_add_u32 m0, s64, 65536
v_mfma_f32_16x16x32_bf16 v[132:135], v[64:67], v[40:43], v[132:135]
s_add_u32 s72, s81, 0
buffer_load_dwordx4 v1, s[44:47], s72 offen sc1 lds
v_mfma_f32_16x16x32_bf16 v[136:139], v[64:67], v[48:51], v[136:139]
ds_read_b64_tr_b16 v[92:93], v11 offset:40960
v_mfma_f32_16x16x32_bf16 v[136:139], v[68:71], v[52:55], v[136:139]
ds_read_b64_tr_b16 v[94:95], v11 offset:41984
v_mfma_f32_16x16x32_bf16 v[140:143], v[68:71], v[60:63], v[140:143]
v_mfma_f32_16x16x32_bf16 v[140:143], v[64:67], v[56:59], v[140:143]
s_waitcnt lgkmcnt(8)
buffer_load_dwordx4 v1, s[44:47], s72 offen offset:1024 sc1 lds
v_mfma_f32_16x16x32_bf16 v[156:159], v[72:75], v[56:59], v[156:159]
ds_read_b64_tr_b16 v[64:65], v12 offset:32768
v_mfma_f32_16x16x32_bf16 v[156:159], v[76:79], v[60:63], v[156:159]
ds_read_b64_tr_b16 v[66:67], v12 offset:33792
v_mfma_f32_16x16x32_bf16 v[152:155], v[76:79], v[52:55], v[152:155]
v_mfma_f32_16x16x32_bf16 v[152:155], v[72:75], v[48:51], v[152:155]
buffer_load_dwordx4 v1, s[44:47], s72 offen offset:2048 sc1 lds
v_mfma_f32_16x16x32_bf16 v[148:151], v[72:75], v[40:43], v[148:151]
ds_read_b64_tr_b16 v[68:69], v12 offset:40960
v_mfma_f32_16x16x32_bf16 v[148:151], v[76:79], v[44:47], v[148:151]
v_mfma_f32_16x16x32_bf16 v[144:147], v[76:79], v[36:39], v[144:147]
ds_read_b64_tr_b16 v[70:71], v12 offset:41984
v_mfma_f32_16x16x32_bf16 v[144:147], v[72:75], v[32:35], v[144:147]
s_waitcnt lgkmcnt(8)
v_mfma_f32_16x16x32_bf16 v[160:163], v[80:83], v[32:35], v[160:163]
buffer_load_dwordx4 v1, s[44:47], s72 offen offset:3072 sc1 lds
v_mfma_f32_16x16x32_bf16 v[160:163], v[84:87], v[36:39], v[160:163]
ds_read_b64_tr_b16 v[72:73], v13 offset:32768
v_mfma_f32_16x16x32_bf16 v[164:167], v[84:87], v[44:47], v[164:167]
ds_read_b64_tr_b16 v[74:75], v13 offset:33792
v_mfma_f32_16x16x32_bf16 v[164:167], v[80:83], v[40:43], v[164:167]
v_mfma_f32_16x16x32_bf16 v[168:171], v[80:83], v[48:51], v[168:171]
s_waitcnt vmcnt(16)
ds_read_b64_tr_b16 v[76:77], v13 offset:40960
v_mfma_f32_16x16x32_bf16 v[168:171], v[84:87], v[52:55], v[168:171]
ds_read_b128 v[96:99], v16 offset:0
v_mfma_f32_16x16x32_bf16 v[172:175], v[84:87], v[60:63], v[172:175]
ds_read_b64_tr_b16 v[78:79], v13 offset:41984
v_mfma_f32_16x16x32_bf16 v[172:175], v[80:83], v[56:59], v[172:175]
s_waitcnt lgkmcnt(9)
v_mfma_f32_16x16x32_bf16 v[188:191], v[88:91], v[56:59], v[188:191]
ds_read_b64_tr_b16 v[80:81], v14 offset:32768
v_mfma_f32_16x16x32_bf16 v[188:191], v[92:95], v[60:63], v[188:191]
ds_read_b128 v[100:103], v17 offset:0
v_mfma_f32_16x16x32_bf16 v[184:187], v[92:95], v[52:55], v[184:187]
ds_read_b64_tr_b16 v[82:83], v14 offset:33792
v_mfma_f32_16x16x32_bf16 v[184:187], v[88:91], v[48:51], v[184:187]
v_mfma_f32_16x16x32_bf16 v[180:183], v[88:91], v[40:43], v[180:183]
ds_read_b64_tr_b16 v[84:85], v14 offset:40960
v_mfma_f32_16x16x32_bf16 v[180:183], v[92:95], v[44:47], v[180:183]
ds_read_b128 v[104:107], v16 offset:2048
v_mfma_f32_16x16x32_bf16 v[176:179], v[92:95], v[36:39], v[176:179]
ds_read_b64_tr_b16 v[86:87], v14 offset:41984
v_mfma_f32_16x16x32_bf16 v[176:179], v[88:91], v[32:35], v[176:179]
s_waitcnt lgkmcnt(11)
v_mfma_f32_16x16x32_bf16 v[192:195], v[64:67], v[32:35], v[192:195]
ds_read_b64_tr_b16 v[88:89], v15 offset:32768
v_mfma_f32_16x16x32_bf16 v[192:195], v[68:71], v[36:39], v[192:195]
ds_read_b64_tr_b16 v[90:91], v15 offset:33792
v_mfma_f32_16x16x32_bf16 v[196:199], v[68:71], v[44:47], v[196:199]
ds_read_b128 v[108:111], v17 offset:2048
v_mfma_f32_16x16x32_bf16 v[196:199], v[64:67], v[40:43], v[196:199]
ds_read_b64_tr_b16 v[92:93], v15 offset:40960
v_mfma_f32_16x16x32_bf16 v[200:203], v[64:67], v[48:51], v[200:203]
ds_read_b64_tr_b16 v[94:95], v15 offset:41984
v_mfma_f32_16x16x32_bf16 v[200:203], v[68:71], v[52:55], v[200:203]
v_mfma_f32_16x16x32_bf16 v[204:207], v[68:71], v[60:63], v[204:207]
ds_read_b128 v[112:115], v16 offset:4096
v_mfma_f32_16x16x32_bf16 v[204:207], v[64:67], v[56:59], v[204:207]
s_waitcnt lgkmcnt(12)
v_mfma_f32_16x16x32_bf16 v[220:223], v[72:75], v[56:59], v[220:223]
ds_read_b128 v[116:119], v17 offset:4096
v_mfma_f32_16x16x32_bf16 v[220:223], v[76:79], v[60:63], v[220:223]
v_mfma_f32_16x16x32_bf16 v[216:219], v[76:79], v[52:55], v[216:219]
s_waitcnt vmcnt(12) lgkmcnt(2)
ds_read_b128 v[120:123], v16 offset:6144
v_mfma_f32_16x16x32_bf16 v[216:219], v[72:75], v[48:51], v[216:219]
s_barrier
v_mfma_f32_16x16x32_bf16 v[212:215], v[72:75], v[40:43], v[212:215]
s_add_u32 s81, s81, 0x8000
ds_read_b64_tr_b16 v[64:65], v8 offset:0
ds_read_b64_tr_b16 v[66:67], v8 offset:1024
v_mfma_f32_16x16x32_bf16 v[212:215], v[76:79], v[44:47], v[212:215]
s_add_u32 m0, s64, 114688
ds_read_b64_tr_b16 v[68:69], v8 offset:8192
v_mfma_f32_16x16x32_bf16 v[208:211], v[76:79], v[36:39], v[208:211]
s_add_u32 s72, s81, 16384
buffer_load_dwordx4 v1, s[44:47], s72 offen sc1 lds
v_mfma_f32_16x16x32_bf16 v[208:211], v[72:75], v[32:35], v[208:211]
ds_read_b64_tr_b16 v[70:71], v8 offset:9216
v_mfma_f32_16x16x32_bf16 v[224:227], v[80:83], v[32:35], v[224:227]
buffer_load_dwordx4 v1, s[44:47], s72 offen offset:1024 sc1 lds
v_mfma_f32_16x16x32_bf16 v[224:227], v[84:87], v[36:39], v[224:227]
ds_read_b64_tr_b16 v[72:73], v9 offset:0
v_mfma_f32_16x16x32_bf16 v[228:231], v[84:87], v[44:47], v[228:231]
ds_read_b64_tr_b16 v[74:75], v9 offset:1024
v_mfma_f32_16x16x32_bf16 v[228:231], v[80:83], v[40:43], v[228:231]
ds_read_b128 v[124:127], v17 offset:6144
v_mfma_f32_16x16x32_bf16 v[232:235], v[80:83], v[48:51], v[232:235]
ds_read_b64_tr_b16 v[76:77], v9 offset:8192
v_mfma_f32_16x16x32_bf16 v[232:235], v[84:87], v[52:55], v[232:235]
buffer_store_dwordx4 a[0:3], v1, s[44:47], s80 offen sc1
v_mfma_f32_16x16x32_bf16 v[236:239], v[84:87], v[60:63], v[236:239]
ds_read_b64_tr_b16 v[78:79], v9 offset:9216
v_mfma_f32_16x16x32_bf16 v[236:239], v[80:83], v[56:59], v[236:239]
v_mfma_f32_16x16x32_bf16 v[252:255], v[88:91], v[56:59], v[252:255]
ds_read_b64_tr_b16 v[80:81], v10 offset:0
v_mfma_f32_16x16x32_bf16 v[252:255], v[92:95], v[60:63], v[252:255]
ds_read_b64_tr_b16 v[82:83], v10 offset:1024
v_mfma_f32_16x16x32_bf16 v[248:251], v[92:95], v[52:55], v[248:251]
buffer_load_dwordx4 v1, s[44:47], s72 offen offset:2048 sc1 lds
v_mfma_f32_16x16x32_bf16 v[248:251], v[88:91], v[48:51], v[248:251]
v_mfma_f32_16x16x32_bf16 v[244:247], v[88:91], v[40:43], v[244:247]
ds_read_b64_tr_b16 v[84:85], v10 offset:8192
v_mfma_f32_16x16x32_bf16 v[244:247], v[92:95], v[44:47], v[244:247]
ds_read_b64_tr_b16 v[86:87], v10 offset:9216
v_mfma_f32_16x16x32_bf16 v[240:243], v[92:95], v[36:39], v[240:243]
buffer_load_dwordx4 v1, s[44:47], s72 offen offset:3072 sc1 lds
v_mfma_f32_16x16x32_bf16 v[240:243], v[88:91], v[32:35], v[240:243]
s_waitcnt lgkmcnt(6)
v_mfma_f32_16x16x32_bf16 v[128:131], v[64:67], v[96:99], v[128:131]
ds_read_b64_tr_b16 v[88:89], v11 offset:0
v_mfma_f32_16x16x32_bf16 v[128:131], v[68:71], v[100:103], v[128:131]
ds_read_b64_tr_b16 v[90:91], v11 offset:1024
v_mfma_f32_16x16x32_bf16 v[132:135], v[68:71], v[108:111], v[132:135]
v_mfma_f32_16x16x32_bf16 v[132:135], v[64:67], v[104:107], v[132:135]
buffer_store_dwordx4 a[0:3], v1, s[44:47], s80 offen offset:1024 sc1
v_mfma_f32_16x16x32_bf16 v[136:139], v[64:67], v[112:115], v[136:139]
ds_read_b64_tr_b16 v[92:93], v11 offset:8192
v_mfma_f32_16x16x32_bf16 v[136:139], v[68:71], v[116:119], v[136:139]
v_mfma_f32_16x16x32_bf16 v[140:143], v[68:71], v[124:127], v[140:143]
ds_read_b64_tr_b16 v[94:95], v11 offset:9216
v_mfma_f32_16x16x32_bf16 v[140:143], v[64:67], v[120:123], v[140:143]
s_waitcnt lgkmcnt(8)
v_mfma_f32_16x16x32_bf16 v[156:159], v[72:75], v[120:123], v[156:159]
s_add_u32 m0, s64, 98304
ds_read_b64_tr_b16 v[64:65], v12 offset:0
v_mfma_f32_16x16x32_bf16 v[156:159], v[76:79], v[124:127], v[156:159]
s_add_u32 s72, s81, 0
buffer_load_dwordx4 v1, s[44:47], s72 offen sc1 lds
v_mfma_f32_16x16x32_bf16 v[152:155], v[76:79], v[116:119], v[152:155]
ds_read_b64_tr_b16 v[66:67], v12 offset:1024
v_mfma_f32_16x16x32_bf16 v[152:155], v[72:75], v[112:115], v[152:155]
v_mfma_f32_16x16x32_bf16 v[148:151], v[72:75], v[104:107], v[148:151]
buffer_load_dwordx4 v1, s[44:47], s72 offen offset:1024 sc1 lds
v_mfma_f32_16x16x32_bf16 v[148:151], v[76:79], v[108:111], v[148:151]
ds_read_b64_tr_b16 v[68:69], v12 offset:8192
v_mfma_f32_16x16x32_bf16 v[144:147], v[76:79], v[100:103], v[144:147]
ds_read_b64_tr_b16 v[70:71], v12 offset:9216
v_mfma_f32_16x16x32_bf16 v[144:147], v[72:75], v[96:99], v[144:147]
s_waitcnt lgkmcnt(8)
v_mfma_f32_16x16x32_bf16 v[160:163], v[80:83], v[96:99], v[160:163]
ds_read_b64_tr_b16 v[72:73], v13 offset:0
v_mfma_f32_16x16x32_bf16 v[160:163], v[84:87], v[100:103], v[160:163]
buffer_store_dwordx4 a[0:3], v1, s[44:47], s80 offen offset:2048 sc1
v_mfma_f32_16x16x32_bf16 v[164:167], v[84:87], v[108:111], v[164:167]
ds_read_b64_tr_b16 v[74:75], v13 offset:1024
v_mfma_f32_16x16x32_bf16 v[164:167], v[80:83], v[104:107], v[164:167]
v_mfma_f32_16x16x32_bf16 v[168:171], v[80:83], v[112:115], v[168:171]
ds_read_b64_tr_b16 v[76:77], v13 offset:8192
v_cvt_pk_bf16_f32 v48, v136, v137
v_mfma_f32_16x16x32_bf16 v[168:171], v[84:87], v[116:119], v[168:171]
ds_read_b64_tr_b16 v[78:79], v13 offset:9216
v_cvt_pk_bf16_f32 v49, v138, v139
v_mfma_f32_16x16x32_bf16 v[172:175], v[84:87], v[124:127], v[172:175]
buffer_load_dwordx4 v1, s[44:47], s72 offen offset:2048 sc1 lds
v_mfma_f32_16x16x32_bf16 v[172:175], v[80:83], v[120:123], v[172:175]
s_waitcnt lgkmcnt(8)
v_cvt_pk_bf16_f32 v50, v152, v153
v_cvt_pk_bf16_f32 v51, v154, v155
v_mfma_f32_16x16x32_bf16 v[188:191], v[88:91], v[120:123], v[188:191]
v_add_u32 v2, 0x8000, v1
v_cvt_pk_bf16_f32 v32, v132, v133
v_mfma_f32_16x16x32_bf16 v[188:191], v[92:95], v[124:127], v[188:191]
ds_read_b64_tr_b16 v[80:81], v14 offset:0
v_cvt_pk_bf16_f32 v33, v134, v135
v_mfma_f32_16x16x32_bf16 v[184:187], v[92:95], v[116:119], v[184:187]
buffer_load_dwordx4 v1, s[44:47], s72 offen offset:3072 sc1 lds
v_mfma_f32_16x16x32_bf16 v[184:187], v[88:91], v[112:115], v[184:187]
ds_read_b64_tr_b16 v[82:83], v14 offset:1024
v_cvt_pk_bf16_f32 v34, v148, v149
v_mfma_f32_16x16x32_bf16 v[180:183], v[88:91], v[104:107], v[180:183]
ds_read_b64_tr_b16 v[84:85], v14 offset:8192
v_cvt_pk_bf16_f32 v35, v150, v151
v_mfma_f32_16x16x32_bf16 v[180:183], v[92:95], v[108:111], v[180:183]
ds_read_b64_tr_b16 v[86:87], v14 offset:9216
v_cvt_pk_bf16_f32 v16, v128, v129
v_mfma_f32_16x16x32_bf16 v[176:179], v[92:95], v[100:103], v[176:179]
v_cvt_pk_bf16_f32 v17, v130, v131
v_cvt_pk_bf16_f32 v18, v144, v145
v_mfma_f32_16x16x32_bf16 v[176:179], v[88:91], v[96:99], v[176:179]
s_waitcnt lgkmcnt(8)
buffer_store_dwordx4 a[0:3], v1, s[44:47], s80 offen offset:3072 sc1
v_mfma_f32_16x16x32_bf16 v[192:195], v[64:67], v[96:99], v[192:195]
ds_read_b64_tr_b16 v[88:89], v15 offset:0
v_cvt_pk_bf16_f32 v19, v146, v147
v_mfma_f32_16x16x32_bf16 v[192:195], v[68:71], v[100:103], v[192:195]
ds_read_b64_tr_b16 v[90:91], v15 offset:1024
v_mfma_f32_16x16x32_bf16 v[196:199], v[68:71], v[108:111], v[196:199]
ds_read_b64_tr_b16 v[92:93], v15 offset:8192
v_mfma_f32_16x16x32_bf16 v[196:199], v[64:67], v[104:107], v[196:199]
ds_read_b64_tr_b16 v[94:95], v15 offset:9216
v_mfma_f32_16x16x32_bf16 v[200:203], v[64:67], v[112:115], v[200:203]
v_lshrrev_b32 v3, 1, v0
v_lshlrev_b32 v3, 7, v3
v_mfma_f32_16x16x32_bf16 v[200:203], v[68:71], v[116:119], v[200:203]
buffer_load_dword v4, v3, s[36:39], s93 offen
v_mfma_f32_16x16x32_bf16 v[204:207], v[68:71], v[124:127], v[204:207]
v_cvt_pk_bf16_f32 v52, v168, v169
v_cvt_pk_bf16_f32 v53, v170, v171
v_mfma_f32_16x16x32_bf16 v[204:207], v[64:67], v[120:123], v[204:207]
s_waitcnt lgkmcnt(8)
v_cvt_pk_bf16_f32 v54, v184, v185
v_cvt_pk_bf16_f32 v55, v186, v187
v_mfma_f32_16x16x32_bf16 v[220:223], v[72:75], v[120:123], v[220:223]
v_cvt_pk_bf16_f32 v36, v164, v165
v_cvt_pk_bf16_f32 v37, v166, v167
v_mfma_f32_16x16x32_bf16 v[220:223], v[76:79], v[124:127], v[220:223]
v_cvt_pk_bf16_f32 v38, v180, v181
v_cvt_pk_bf16_f32 v39, v182, v183
v_mfma_f32_16x16x32_bf16 v[216:219], v[76:79], v[116:119], v[216:219]
s_waitcnt vmcnt(21) lgkmcnt(0)
v_cvt_pk_bf16_f32 v20, v160, v161
v_cvt_pk_bf16_f32 v21, v162, v163
v_mfma_f32_16x16x32_bf16 v[216:219], v[72:75], v[112:115], v[216:219]
s_barrier
v_cvt_pk_bf16_f32 v22, v176, v177
v_cvt_pk_bf16_f32 v23, v178, v179
v_mfma_f32_16x16x32_bf16 v[212:215], v[72:75], v[104:107], v[212:215]
ds_read_b128 a[128:131], v2 offset:16384
v_cvt_pk_bf16_f32 v64, v140, v141
v_mfma_f32_16x16x32_bf16 v[212:215], v[76:79], v[108:111], v[212:215]
v_cvt_pk_bf16_f32 v65, v142, v143
v_cvt_pk_bf16_f32 v66, v156, v157
v_mfma_f32_16x16x32_bf16 v[208:211], v[76:79], v[100:103], v[208:211]
ds_read_b128 a[132:135], v2 offset:17408
v_cvt_pk_bf16_f32 v67, v158, v159
v_mfma_f32_16x16x32_bf16 v[208:211], v[72:75], v[96:99], v[208:211]
v_cvt_pk_bf16_f32 v68, v172, v173
v_cvt_pk_bf16_f32 v69, v174, v175
v_mfma_f32_16x16x32_bf16 v[224:227], v[80:83], v[96:99], v[224:227]
ds_read_b128 a[136:139], v2 offset:18432
v_cvt_pk_bf16_f32 v70, v188, v189
v_mfma_f32_16x16x32_bf16 v[224:227], v[84:87], v[100:103], v[224:227]
v_cvt_pk_bf16_f32 v71, v190, v191
v_mfma_f32_16x16x32_bf16 v[228:231], v[84:87], v[108:111], v[228:231]
ds_read_b128 a[140:143], v2 offset:19456
v_mfma_f32_16x16x32_bf16 v[228:231], v[80:83], v[104:107], v[228:231]
v_mfma_f32_16x16x32_bf16 v[232:235], v[80:83], v[112:115], v[232:235]
ds_read_b128 a[144:147], v2 offset:20480
v_cvt_pk_bf16_f32 v72, v204, v205
v_mfma_f32_16x16x32_bf16 v[232:235], v[84:87], v[116:119], v[232:235]
v_cvt_pk_bf16_f32 v73, v206, v207
v_cvt_pk_bf16_f32 v74, v220, v221
v_mfma_f32_16x16x32_bf16 v[236:239], v[84:87], v[124:127], v[236:239]
ds_read_b128 a[148:151], v2 offset:21504
v_cvt_pk_bf16_f32 v75, v222, v223
v_mfma_f32_16x16x32_bf16 v[236:239], v[80:83], v[120:123], v[236:239]
v_cvt_pk_bf16_f32 v56, v200, v201
v_cvt_pk_bf16_f32 v57, v202, v203
v_mfma_f32_16x16x32_bf16 v[252:255], v[88:91], v[120:123], v[252:255]
ds_read_b128 a[152:155], v2 offset:22528
v_cvt_pk_bf16_f32 v58, v216, v217
v_mfma_f32_16x16x32_bf16 v[252:255], v[92:95], v[124:127], v[252:255]
v_cvt_pk_bf16_f32 v59, v218, v219
v_cvt_pk_bf16_f32 v40, v196, v197
v_mfma_f32_16x16x32_bf16 v[248:251], v[92:95], v[116:119], v[248:251]
ds_read_b128 a[156:159], v2 offset:23552
v_cvt_pk_bf16_f32 v41, v198, v199
v_mfma_f32_16x16x32_bf16 v[248:251], v[88:91], v[112:115], v[248:251]
v_cvt_pk_bf16_f32 v42, v212, v213
v_cvt_pk_bf16_f32 v43, v214, v215
v_mfma_f32_16x16x32_bf16 v[244:247], v[88:91], v[104:107], v[244:247]
v_cvt_pk_bf16_f32 v24, v192, v193
v_cvt_pk_bf16_f32 v25, v194, v195
v_mfma_f32_16x16x32_bf16 v[244:247], v[92:95], v[108:111], v[244:247]
v_cvt_pk_bf16_f32 v26, v208, v209
v_cvt_pk_bf16_f32 v27, v210, v211
v_mfma_f32_16x16x32_bf16 v[240:243], v[92:95], v[100:103], v[240:243]
v_mfma_f32_16x16x32_bf16 v[240:243], v[88:91], v[96:99], v[240:243]
v_cvt_pk_bf16_f32 v76, v236, v237
v_cvt_pk_bf16_f32 v77, v238, v239
v_cvt_pk_bf16_f32 v78, v252, v253
v_cvt_pk_bf16_f32 v79, v254, v255
v_cvt_pk_bf16_f32 v60, v232, v233
v_cvt_pk_bf16_f32 v61, v234, v235
v_cvt_pk_bf16_f32 v62, v248, v249
v_cvt_pk_bf16_f32 v63, v250, v251
v_cvt_pk_bf16_f32 v44, v228, v229
v_cvt_pk_bf16_f32 v45, v230, v231
v_cvt_pk_bf16_f32 v46, v244, v245
v_cvt_pk_bf16_f32 v47, v246, v247
v_cvt_pk_bf16_f32 v28, v224, v225
v_cvt_pk_bf16_f32 v29, v226, v227
v_cvt_pk_bf16_f32 v30, v240, v241
v_cvt_pk_bf16_f32 v31, v242, v243
v_mov_b32 v124, 0xff800000
v_mov_b32 v125, 0xff800000
v_mov_b32 v126, 0xff800000
v_mov_b32 v127, 0xff800000
s_lshl_b32 s84, s60, 2
s_add_u32 s84, s84, s58
s_mov_b32 s86, 0
s_add_u32 s61, s65, s60
s_and_b32 s73, s60, 1
s_lshl_b32 s73, s73, 16
s_add_u32 s77, s73, s64
s_xor_b32 s73, s73, 0x10000
s_mov_b32 s92, s73
s_mul_i32 s62, s58, 4608
s_add_u32 s62, s62, 143104
s_add_u32 s73, s73, 49920
s_cmp_eq_u32 s58, 0
s_cselect_b32 s62, s73, s62
Lattn:
s_mov_b32 s82, 0x10000
s_waitcnt lgkmcnt(0)
v_mfma_f32_16x16x32_bf16 v[136:139], a[128:131], v[48:51], 0
ds_read_b128 a[160:163], v2 offset:24576
v_lshrrev_b32 v240, 4, v0
v_mfma_f32_16x16x32_bf16 v[136:139], a[132:135], v[52:55], v[136:139]
ds_read_b128 a[164:167], v2 offset:25600
v_and_b32 v241, 15, v0
v_mfma_f32_16x16x32_bf16 v[136:139], a[136:139], v[56:59], v[136:139]
ds_read_b128 a[168:171], v2 offset:26624
v_lshlrev_b32 v240, 2, v240
v_mfma_f32_16x16x32_bf16 v[136:139], a[140:143], v[60:63], v[136:139]
ds_read_b128 a[172:175], v2 offset:27648
v_sub_u32 v240, v241, v240
v_mfma_f32_16x16x32_bf16 v[140:143], a[140:143], v[76:79], 0
ds_read_b128 a[176:179], v2 offset:28672
v_mov_b32 v112, 0xff800000
v_mfma_f32_16x16x32_bf16 v[140:143], a[136:139], v[72:75], v[140:143]
ds_read_b128 a[180:183], v2 offset:29696
v_mov_b32 v113, 0xff800000
v_mfma_f32_16x16x32_bf16 v[140:143], a[132:135], v[68:71], v[140:143]
ds_read_b128 a[184:187], v2 offset:30720
v_mov_b32 v114, 0xff800000
v_mfma_f32_16x16x32_bf16 v[140:143], a[128:131], v[64:67], v[140:143]
ds_read_b128 a[188:191], v2 offset:31744
v_mov_b32 v115, 0xff800000
v_mfma_f32_16x16x32_bf16 v[156:159], a[144:147], v[64:67], 0
v_cmp_gt_i32 vcc, 0, v240
v_mov_b32 v120, 0x3f803f80
v_mfma_f32_16x16x32_bf16 v[156:159], a[148:151], v[68:71], v[156:159]
v_cndmask_b32 v116, 0, v112, vcc
v_cmp_gt_i32 vcc, 1, v240
v_mfma_f32_16x16x32_bf16 v[156:159], a[152:155], v[72:75], v[156:159]
v_mov_b32 v121, 0x3f803f80
v_cndmask_b32 v117, 0, v112, vcc
v_mfma_f32_16x16x32_bf16 v[156:159], a[156:159], v[76:79], v[156:159]
v_cmp_gt_i32 vcc, 2, v240
v_mov_b32 v122, 0x3f803f80
v_mfma_f32_16x16x32_bf16 v[152:155], a[156:159], v[60:63], 0
v_cndmask_b32 v118, 0, v112, vcc
v_cmp_gt_i32 vcc, 3, v240
v_mfma_f32_16x16x32_bf16 v[152:155], a[152:155], v[56:59], v[152:155]
v_mov_b32 v123, 0x3f803f80
v_cndmask_b32 v119, 0, v112, vcc
v_mfma_f32_16x16x32_bf16 v[152:155], a[148:151], v[52:55], v[152:155]
v_mov_b32 v228, 0
v_mov_b32 v229, 0
v_mfma_f32_16x16x32_bf16 v[152:155], a[144:147], v[48:51], v[152:155]
v_mov_b32 v230, 0
v_mov_b32 v231, 0
s_cmp_eq_u32 s84, 0
s_cbranch_scc1 Lta7
s_cmp_eq_u32 s84, 1
s_cbranch_scc1 Lnt8
v_mfma_f32_16x16x32_bf16 v[128:131], a[128:131], v[16:19], 0
Lstub0:
s_cbranch_execz Lstub4
v_mov_b32 v236, 0
v_mov_b32 v237, 0
v_mfma_f32_16x16x32_bf16 v[144:147], a[144:147], v[16:19], 0
v_mov_b32 v238, 0
v_mov_b32 v239, 0
s_branch Ljoin9
Lta7:
v_mfma_f32_16x16x32_bf16 v[128:131], a[128:131], v[16:19], v[116:119]
v_mov_b32 v236, 0
v_mov_b32 v237, 0
v_mfma_f32_16x16x32_bf16 v[144:147], a[144:147], v[16:19], v[112:115]
v_mov_b32 v238, 0
v_mov_b32 v239, 0
s_branch Ljoin9
Lnt8:
v_mfma_f32_16x16x32_bf16 v[128:131], a[128:131], v[16:19], 0
v_mov_b32 v236, 0
v_mov_b32 v237, 0
v_mfma_f32_16x16x32_bf16 v[144:147], a[144:147], v[16:19], v[116:119]
v_mov_b32 v238, 0
v_mov_b32 v239, 0
Ljoin9:
v_mfma_f32_16x16x32_bf16 v[128:131], a[132:135], v[20:23], v[128:131]
v_mfma_f32_16x16x32_bf16 v[128:131], a[136:139], v[24:27], v[128:131]
v_mfma_f32_16x16x32_bf16 v[128:131], a[140:143], v[28:31], v[128:131]
v_max3_f32 v240, v136, v137, v126
v_max3_f32 v242, v140, v141, v127
v_mfma_f32_16x16x32_bf16 v[132:135], a[140:143], v[44:47], 0
v_max3_f32 v240, v240, v138, v139
v_max3_f32 v242, v242, v142, v143
v_mfma_f32_16x16x32_bf16 v[132:135], a[136:139], v[40:43], v[132:135]
v_max3_f32 v240, v240, v152, v153
v_max3_f32 v242, v242, v156, v157
v_mfma_f32_16x16x32_bf16 v[132:135], a[132:135], v[36:39], v[132:135]
v_max3_f32 v240, v240, v154, v155
v_max3_f32 v242, v242, v158, v159
v_mfma_f32_16x16x32_bf16 v[132:135], a[128:131], v[32:35], v[132:135]
v_mov_b32 v241, v240
v_mov_b32 v243, v242
v_mfma_f32_16x16x32_bf16 v[148:151], a[144:147], v[32:35], 0
v_permlane16_swap_b32 v240, v241
v_permlane16_swap_b32 v242, v243
v_mfma_f32_16x16x32_bf16 v[148:151], a[148:151], v[36:39], v[148:151]
v_max_f32 v240, v240, v241
v_max_f32 v242, v242, v243
v_mfma_f32_16x16x32_bf16 v[148:151], a[152:155], v[40:43], v[148:151]
v_mov_b32 v241, v240
v_mov_b32 v243, v242
v_mfma_f32_16x16x32_bf16 v[148:151], a[156:159], v[44:47], v[148:151]
v_permlane32_swap_b32 v240, v241
v_permlane32_swap_b32 v242, v243
v_mfma_f32_16x16x32_bf16 v[144:147], a[156:159], v[28:31], v[144:147]
v_max_f32 v240, v240, v241
v_max_f32 v242, v242, v243
v_mfma_f32_16x16x32_bf16 v[144:147], a[152:155], v[24:27], v[144:147]
v_mfma_f32_16x16x32_bf16 v[144:147], a[148:151], v[20:23], v[144:147]
v_sub_f32 v88, 0, v240
v_sub_f32 v89, 0, v240
v_pk_add_f32 v[90:91], v[88:89], 0
v_pk_add_f32 v[104:105], v[116:117], v[88:89]
v_pk_add_f32 v[106:107], v[118:119], v[88:89]
v_pk_add_f32 v[136:137], v[136:137], v[88:89]
v_pk_add_f32 v[138:139], v[138:139], v[88:89]
v_pk_add_f32 v[152:153], v[152:153], v[88:89]
v_pk_add_f32 v[154:155], v[154:155], v[88:89]
v_sub_f32 v92, 0, v242
v_sub_f32 v93, 0, v242
v_pk_add_f32 v[94:95], v[92:93], 0
v_pk_add_f32 v[108:109], v[116:117], v[92:93]
v_pk_add_f32 v[110:111], v[118:119], v[92:93]
v_pk_add_f32 v[140:141], v[140:141], v[92:93]
v_pk_add_f32 v[142:143], v[142:143], v[92:93]
v_pk_add_f32 v[156:157], v[156:157], v[92:93]
v_pk_add_f32 v[158:159], v[158:159], v[92:93]
v_max3_f32 v240, v128, v129, v124
v_max3_f32 v242, v132, v133, v125
v_max3_f32 v240, v240, v130, v131
v_max3_f32 v242, v242, v134, v135
v_max3_f32 v240, v240, v144, v145
v_max3_f32 v242, v242, v148, v149
v_max3_f32 v240, v240, v146, v147
v_max3_f32 v242, v242, v150, v151
v_mov_b32 v241, v240
v_mov_b32 v243, v242
s_nop 0
v_permlane16_swap_b32 v240, v241
v_permlane16_swap_b32 v242, v243
v_max_f32 v240, v240, v241
v_max_f32 v242, v242, v243
v_mov_b32 v241, v240
v_mov_b32 v243, v242
s_nop 0
v_permlane32_swap_b32 v240, v241
v_permlane32_swap_b32 v242, v243
v_max_f32 v240, v240, v241
v_max_f32 v242, v242, v243
v_sub_f32 v80, 0, v240
v_sub_f32 v81, 0, v240
v_pk_add_f32 v[82:83], v[80:81], 0
v_pk_add_f32 v[96:97], v[116:117], v[80:81]
v_pk_add_f32 v[98:99], v[118:119], v[80:81]
v_pk_add_f32 v[128:129], v[128:129], v[80:81]
v_pk_add_f32 v[130:131], v[130:131], v[80:81]
v_pk_add_f32 v[144:145], v[144:145], v[80:81]
v_pk_add_f32 v[146:147], v[146:147], v[80:81]
v_sub_f32 v84, 0, v242
v_sub_f32 v85, 0, v242
v_pk_add_f32 v[86:87], v[84:85], 0
v_pk_add_f32 v[100:101], v[116:117], v[84:85]
v_pk_add_f32 v[102:103], v[118:119], v[84:85]
v_pk_add_f32 v[132:133], v[132:133], v[84:85]
v_pk_add_f32 v[134:135], v[134:135], v[84:85]
v_pk_add_f32 v[148:149], v[148:149], v[84:85]
v_pk_add_f32 v[150:151], v[150:151], v[84:85]
v_add_u32 v2, s82, v1
s_waitcnt vmcnt(13) lgkmcnt(0)
s_barrier
s_cmp_eq_u32 s60, 0
s_cbranch_scc1 LP0x
v_mfma_f32_16x16x32_bf16 v[164:167], a[160:163], v[32:35], v[84:87]
s_xor_b32 s74, s82, 0x10000
v_exp_f32 v128, v128
v_mfma_f32_16x16x32_bf16 v[164:167], a[164:167], v[36:39], v[164:167]
s_add_u32 s74, s74, s64
ds_read_b128 a[128:131], v2 offset:16384
ds_read_b128 a[132:135], v2 offset:17408
v_mfma_f32_16x16x32_bf16 v[164:167], a[168:171], v[40:43], v[164:167]
s_add_u32 s81, s81, 0x8000
v_exp_f32 v129, v129
v_mfma_f32_16x16x32_bf16 v[164:167], a[172:175], v[44:47], v[164:167]
s_add_u32 m0, s74, 16384
v_exp_f32 v130, v130
v_mfma_f32_16x16x32_bf16 v[172:175], a[172:175], v[76:79], v[92:95]
s_add_u32 s72, s81, 16384
v_exp_f32 v131, v131
v_mfma_f32_16x16x32_bf16 v[172:175], a[168:171], v[72:75], v[172:175]
v_exp_f32 v144, v144
v_mfma_f32_16x16x32_bf16 v[172:175], a[164:167], v[68:71], v[172:175]
s_nop 0
ds_read_b128 a[136:139], v2 offset:18432
ds_read_b128 a[140:143], v2 offset:19456
v_mfma_f32_16x16x32_bf16 v[172:175], a[160:163], v[64:67], v[172:175]
s_nop 0
ds_read_b128 a[144:147], v2 offset:20480
ds_read_b128 a[148:151], v2 offset:21504
v_mfma_f32_16x16x32_bf16 v[188:191], a[176:179], v[64:67], v[92:95]
s_nop 0
ds_read_b128 a[152:155], v2 offset:22528
ds_read_b128 a[156:159], v2 offset:23552
v_mfma_f32_16x16x32_bf16 v[188:191], a[180:183], v[68:71], v[188:191]
s_nop 0
ds_read_b128 a[192:195], v2 offset:0
ds_read_b128 a[196:199], v2 offset:1024
v_mfma_f32_16x16x32_bf16 v[188:191], a[184:187], v[72:75], v[188:191]
s_nop 0
ds_read_b128 a[200:203], v2 offset:2048
ds_read_b128 a[204:207], v2 offset:3072
v_mfma_f32_16x16x32_bf16 v[188:191], a[188:191], v[76:79], v[188:191]
s_nop 0
ds_read_b128 a[208:211], v2 offset:4096
ds_read_b128 a[212:215], v2 offset:5120
v_mfma_f32_16x16x32_bf16 v[180:183], a[188:191], v[44:47], v[84:87]
s_nop 0
ds_read_b128 a[216:219], v2 offset:6144
ds_read_b128 a[220:223], v2 offset:7168
v_mfma_f32_16x16x32_bf16 v[180:183], a[184:187], v[40:43], v[180:183]
v_cvt_pk_bf16_f32 v192, v128, v129
v_cvt_pk_bf16_f32 v193, v130, v131
v_mfma_f32_16x16x32_bf16 v[180:183], a[180:183], v[36:39], v[180:183]
buffer_load_dwordx4 v1, s[44:47], s72 offen sc1 lds
v_mfma_f32_16x16x32_bf16 v[180:183], a[176:179], v[32:35], v[180:183]
v_exp_f32 v145, v145
v_mfma_f32_16x16x32_bf16 v[160:163], a[160:163], v[16:19], v[80:83]
v_exp_f32 v146, v146
v_mfma_f32_16x16x32_bf16 v[160:163], a[164:167], v[20:23], v[160:163]
v_exp_f32 v147, v147
v_mfma_f32_16x16x32_bf16 v[160:163], a[168:171], v[24:27], v[160:163]
v_exp_f32 v136, v136
v_mfma_f32_16x16x32_bf16 v[160:163], a[172:175], v[28:31], v[160:163]
v_cvt_pk_bf16_f32 v194, v144, v145
v_cvt_pk_bf16_f32 v195, v146, v147
v_mfma_f32_16x16x32_bf16 v[168:171], a[172:175], v[60:63], v[88:91]
v_exp_f32 v137, v137
v_mfma_f32_16x16x32_bf16 v[168:171], a[168:171], v[56:59], v[168:171]
v_exp_f32 v138, v138
v_mfma_f32_16x16x32_bf16 v[168:171], a[164:167], v[52:55], v[168:171]
v_exp_f32 v139, v139
v_mfma_f32_16x16x32_bf16 v[168:171], a[160:163], v[48:51], v[168:171]
v_exp_f32 v152, v152
v_mfma_f32_16x16x32_bf16 v[184:187], a[176:179], v[48:51], v[88:91]
v_cvt_pk_bf16_f32 v200, v136, v137
v_cvt_pk_bf16_f32 v201, v138, v139
v_mfma_f32_16x16x32_bf16 v[184:187], a[180:183], v[52:55], v[184:187]
buffer_load_dwordx4 v1, s[44:47], s72 offen offset:1024 sc1 lds
v_mfma_f32_16x16x32_bf16 v[184:187], a[184:187], v[56:59], v[184:187]
v_exp_f32 v153, v153
v_mfma_f32_16x16x32_bf16 v[184:187], a[188:191], v[60:63], v[184:187]
v_exp_f32 v154, v154
v_mfma_f32_16x16x32_bf16 v[176:179], a[188:191], v[28:31], v[80:83]
v_exp_f32 v155, v155
v_mfma_f32_16x16x32_bf16 v[176:179], a[184:187], v[24:27], v[176:179]
buffer_load_dwordx4 v1, s[44:47], s72 offen offset:2048 sc1 lds
v_mfma_f32_16x16x32_bf16 v[176:179], a[180:183], v[20:23], v[176:179]
buffer_load_dwordx4 v1, s[44:47], s72 offen offset:3072 sc1 lds
v_mfma_f32_16x16x32_bf16 v[176:179], a[176:179], v[16:19], v[176:179]
s_waitcnt lgkmcnt(4)
v_exp_f32 v132, v132
v_cvt_pk_bf16_f32 v202, v152, v153
v_cvt_pk_bf16_f32 v203, v154, v155
v_exp_f32 v133, v133
v_exp_f32 v134, v134
v_cvt_pk_bf16_f32 v196, v132, v133
v_exp_f32 v135, v135
v_exp_f32 v148, v148
v_cvt_pk_bf16_f32 v197, v134, v135
v_exp_f32 v149, v149
v_exp_f32 v150, v150
v_cvt_pk_bf16_f32 v198, v148, v149
v_exp_f32 v151, v151
v_exp_f32 v140, v140
v_cvt_pk_bf16_f32 v199, v150, v151
v_exp_f32 v141, v141
v_exp_f32 v142, v142
v_cvt_pk_bf16_f32 v204, v140, v141
v_exp_f32 v143, v143
v_exp_f32 v156, v156
v_cvt_pk_bf16_f32 v205, v142, v143
v_exp_f32 v157, v157
v_exp_f32 v158, v158
v_cvt_pk_bf16_f32 v206, v156, v157
v_exp_f32 v159, v159
s_nop 0
v_cvt_pk_bf16_f32 v207, v158, v159
v_mfma_f32_16x16x32_bf16 v[224:227], v[120:123], v[192:195], 0
s_add_u32 s82, s82, 0x8000
ds_read_b128 a[160:163], v2 offset:24576
ds_read_b128 a[164:167], v2 offset:25600
v_mfma_f32_16x16x32_bf16 v[232:235], v[120:123], v[200:203], 0
s_and_b32 s82, s82, 0x1ffff
v_exp_f32 v164, v164
v_mfma_f32_16x16x32_bf16 a[0:3], a[192:195], v[192:195], 0
s_add_u32 m0, s74, 0
v_exp_f32 v165, v165
v_mfma_f32_16x16x32_bf16 a[64:67], a[192:195], v[200:203], 0
s_add_u32 s72, s81, 0
v_exp_f32 v166, v166
v_mfma_f32_16x16x32_bf16 a[68:71], a[196:199], v[200:203], 0
buffer_load_dwordx4 v1, s[44:47], s72 offen sc1 lds
v_mfma_f32_16x16x32_bf16 a[4:7], a[196:199], v[192:195], 0
v_exp_f32 v167, v167
v_mfma_f32_16x16x32_bf16 a[8:11], a[200:203], v[192:195], 0
ds_read_b128 a[168:171], v2 offset:26624
v_cvt_pk_bf16_f32 v212, v164, v165
v_mfma_f32_16x16x32_bf16 a[72:75], a[200:203], v[200:203], 0
v_exp_f32 v180, v180
v_mfma_f32_16x16x32_bf16 a[76:79], a[204:207], v[200:203], 0
v_exp_f32 v181, v181
v_mfma_f32_16x16x32_bf16 a[12:15], a[204:207], v[192:195], 0
s_waitcnt lgkmcnt(3)
ds_read_b128 a[172:175], v2 offset:27648
v_cvt_pk_bf16_f32 v213, v166, v167
v_mfma_f32_16x16x32_bf16 a[16:19], a[208:211], v[192:195], 0
v_exp_f32 v182, v182
v_mfma_f32_16x16x32_bf16 a[80:83], a[208:211], v[200:203], 0
buffer_load_dwordx4 v1, s[44:47], s72 offen offset:1024 sc1 lds
v_mfma_f32_16x16x32_bf16 a[84:87], a[212:215], v[200:203], 0
v_exp_f32 v183, v183
v_mfma_f32_16x16x32_bf16 a[20:23], a[212:215], v[192:195], 0
s_nop 0
ds_read_b128 a[176:179], v2 offset:28672
ds_read_b128 a[180:183], v2 offset:29696
v_mfma_f32_16x16x32_bf16 a[24:27], a[216:219], v[192:195], 0
v_exp_f32 v172, v172
v_mfma_f32_16x16x32_bf16 a[88:91], a[216:219], v[200:203], 0
s_nop 0
ds_read_b128 a[184:187], v2 offset:30720
ds_read_b128 a[188:191], v2 offset:31744
v_mfma_f32_16x16x32_bf16 a[92:95], a[220:223], v[200:203], 0
s_nop 0
ds_read_b128 a[224:227], v2 offset:8192
ds_read_b128 a[228:231], v2 offset:9216
v_mfma_f32_16x16x32_bf16 a[28:31], a[220:223], v[192:195], 0
s_nop 0
ds_read_b128 a[232:235], v2 offset:10240
ds_read_b128 a[236:239], v2 offset:11264
v_mfma_f32_16x16x32_bf16 v[128:131], a[128:131], v[16:19], v[80:83]
s_nop 0
ds_read_b128 a[240:243], v2 offset:12288
ds_read_b128 a[244:247], v2 offset:13312
v_mfma_f32_16x16x32_bf16 v[128:131], a[132:135], v[20:23], v[128:131]
s_nop 0
ds_read_b128 a[248:251], v2 offset:14336
ds_read_b128 a[252:255], v2 offset:15360
v_mfma_f32_16x16x32_bf16 v[128:131], a[136:139], v[24:27], v[128:131]
v_cvt_pk_bf16_f32 v214, v180, v181
v_cvt_pk_bf16_f32 v215, v182, v183
v_mfma_f32_16x16x32_bf16 v[128:131], a[140:143], v[28:31], v[128:131]
v_exp_f32 v173, v173
v_mfma_f32_16x16x32_bf16 v[136:139], a[140:143], v[60:63], v[88:91]
v_exp_f32 v174, v174
v_mfma_f32_16x16x32_bf16 v[136:139], a[136:139], v[56:59], v[136:139]
buffer_load_dwordx4 v1, s[44:47], s72 offen offset:2048 sc1 lds
v_mfma_f32_16x16x32_bf16 v[136:139], a[132:135], v[52:55], v[136:139]
v_exp_f32 v175, v175
v_mfma_f32_16x16x32_bf16 v[136:139], a[128:131], v[48:51], v[136:139]
v_exp_f32 v188, v188
v_mfma_f32_16x16x32_bf16 v[152:155], a[144:147], v[48:51], v[88:91]
v_cvt_pk_bf16_f32 v220, v172, v173
v_cvt_pk_bf16_f32 v221, v174, v175
v_mfma_f32_16x16x32_bf16 v[152:155], a[148:151], v[52:55], v[152:155]
v_exp_f32 v189, v189
v_mfma_f32_16x16x32_bf16 v[152:155], a[152:155], v[56:59], v[152:155]
v_exp_f32 v190, v190
v_mfma_f32_16x16x32_bf16 v[152:155], a[156:159], v[60:63], v[152:155]
buffer_load_dwordx4 v1, s[44:47], s72 offen offset:3072 sc1 lds
v_mfma_f32_16x16x32_bf16 v[144:147], a[156:159], v[28:31], v[80:83]
s_add_u32 s66, s58, 1
v_exp_f32 v191, v191
v_mfma_f32_16x16x32_bf16 v[144:147], a[152:155], v[24:27], v[144:147]
s_and_b32 s66, s66, 3
v_exp_f32 v160, v160
v_mfma_f32_16x16x32_bf16 v[144:147], a[148:151], v[20:23], v[144:147]
s_mul_i32 s66, s66, 4160
v_cvt_pk_bf16_f32 v222, v188, v189
v_cvt_pk_bf16_f32 v223, v190, v191
v_mfma_f32_16x16x32_bf16 v[144:147], a[144:147], v[16:19], v[144:147]
s_add_u32 m0, s66, 131104
v_exp_f32 v161, v161
v_mfma_f32_16x16x32_bf16 v[132:135], a[128:131], v[32:35], v[84:87]
s_add_u32 s72, s93, 0x2
buffer_load_dwordx4 v1, s[36:39], s72 offen lds
v_mfma_f32_16x16x32_bf16 v[132:135], a[132:135], v[36:39], v[132:135]
v_exp_f32 v162, v162
v_mfma_f32_16x16x32_bf16 v[132:135], a[136:139], v[40:43], v[132:135]
v_exp_f32 v163, v163
v_mfma_f32_16x16x32_bf16 v[132:135], a[140:143], v[44:47], v[132:135]
v_exp_f32 v176, v176
v_mfma_f32_16x16x32_bf16 v[140:143], a[140:143], v[76:79], v[92:95]
v_cvt_pk_bf16_f32 v208, v160, v161
v_cvt_pk_bf16_f32 v209, v162, v163
v_mfma_f32_16x16x32_bf16 v[140:143], a[136:139], v[72:75], v[140:143]
v_exp_f32 v177, v177
v_mfma_f32_16x16x32_bf16 v[140:143], a[132:135], v[68:71], v[140:143]
buffer_load_dwordx4 v1, s[36:39], s72 offen offset:1024 lds
v_mfma_f32_16x16x32_bf16 v[140:143], a[128:131], v[64:67], v[140:143]
v_exp_f32 v178, v178
v_mfma_f32_16x16x32_bf16 v[156:159], a[144:147], v[64:67], v[92:95]
v_exp_f32 v179, v179
v_mfma_f32_16x16x32_bf16 v[156:159], a[148:151], v[68:71], v[156:159]
v_exp_f32 v168, v168
v_mfma_f32_16x16x32_bf16 v[156:159], a[152:155], v[72:75], v[156:159]
v_cvt_pk_bf16_f32 v210, v176, v177
v_cvt_pk_bf16_f32 v211, v178, v179
v_mfma_f32_16x16x32_bf16 v[156:159], a[156:159], v[76:79], v[156:159]
v_exp_f32 v169, v169
v_mfma_f32_16x16x32_bf16 v[148:151], a[156:159], v[44:47], v[84:87]
buffer_load_dwordx4 v1, s[36:39], s72 offen offset:2048 lds
v_mfma_f32_16x16x32_bf16 v[148:151], a[152:155], v[40:43], v[148:151]
buffer_load_dwordx4 v1, s[36:39], s72 offen offset:3072 lds
v_mfma_f32_16x16x32_bf16 v[148:151], a[148:151], v[36:39], v[148:151]
s_waitcnt vmcnt(12) lgkmcnt(4)
v_exp_f32 v170, v170
v_mfma_f32_16x16x32_bf16 v[148:151], a[144:147], v[32:35], v[148:151]
s_barrier
v_exp_f32 v171, v171
v_add_u32 v2, s82, v1
v_cvt_pk_bf16_f32 v216, v168, v169
v_exp_f32 v184, v184
v_cvt_pk_bf16_f32 v217, v170, v171
v_exp_f32 v185, v185
v_exp_f32 v186, v186
v_cvt_pk_bf16_f32 v218, v184, v185
v_exp_f32 v187, v187
s_nop 0
v_cvt_pk_bf16_f32 v219, v186, v187
s_lshl_b32 s75, s59, 4
s_and_b32 s76, s84, 15
s_add_u32 s75, s75, s76
s_lshl_b32 s75, s75, 14
s_cmp_ge_u32 s60, 4
s_cselect_b32 s75, s75, 0x40001000
s_lshl_b32 s83, s60, 1
s_sub_u32 s83, 2, s83
s_cmp_eq_u32 s83, 0
s_cbranch_scc1 LLT1
.p2align 5
s_nop 0
s_nop 0
LloopI:
v_mfma_f32_16x16x32_bf16 v[228:231], v[120:123], v[196:199], v[228:231]
s_xor_b32 s74, s82, 0x10000
v_exp_f32 v128, v128
v_mfma_f32_16x16x32_bf16 v[228:231], v[120:123], v[212:215], v[228:231]
s_add_u32 s74, s74, s64
ds_read_b128 a[128:131], v2 offset:16384
v_add_u32 v15, s75, v3
v_mfma_f32_16x16x32_bf16 v[236:239], v[120:123], v[204:207], v[236:239]
s_add_u32 s81, s81, 0x8000
v_exp_f32 v129, v129
v_mfma_f32_16x16x32_bf16 v[236:239], v[120:123], v[220:223], v[236:239]
s_add_u32 m0, s74, 16384
v_exp_f32 v130, v130
v_mfma_f32_16x16x32_bf16 a[32:35], a[192:195], v[196:199], a[32:35]
s_add_u32 s72, s81, 16384
ds_read_b128 a[132:135], v2 offset:17408
v_cvt_pk_bf16_f32 v192, v128, v129
v_mfma_f32_16x16x32_bf16 a[32:35], a[224:227], v[212:215], a[32:35]
v_exp_f32 v131, v131
v_mfma_f32_16x16x32_bf16 a[96:99], a[224:227], v[220:223], a[96:99]
v_exp_f32 v144, v144
v_mfma_f32_16x16x32_bf16 a[96:99], a[192:195], v[204:207], a[96:99]
ds_read_b128 a[136:139], v2 offset:18432
v_cvt_pk_bf16_f32 v193, v130, v131
v_mfma_f32_16x16x32_bf16 a[100:103], a[196:199], v[204:207], a[100:103]
buffer_load_dwordx4 v1, s[44:47], s72 offen sc1 lds
v_mfma_f32_16x16x32_bf16 a[100:103], a[228:231], v[220:223], a[100:103]
v_exp_f32 v145, v145
v_mfma_f32_16x16x32_bf16 a[36:39], a[228:231], v[212:215], a[36:39]
v_exp_f32 v146, v146
v_mfma_f32_16x16x32_bf16 a[36:39], a[196:199], v[196:199], a[36:39]
ds_read_b128 a[140:143], v2 offset:19456
v_cvt_pk_bf16_f32 v194, v144, v145
v_mfma_f32_16x16x32_bf16 a[40:43], a[200:203], v[196:199], a[40:43]
v_exp_f32 v147, v147
v_mfma_f32_16x16x32_bf16 a[40:43], a[232:235], v[212:215], a[40:43]
v_exp_f32 v136, v136
v_mfma_f32_16x16x32_bf16 a[104:107], a[232:235], v[220:223], a[104:107]
ds_read_b128 a[144:147], v2 offset:20480
v_cvt_pk_bf16_f32 v195, v146, v147
v_mfma_f32_16x16x32_bf16 a[104:107], a[200:203], v[204:207], a[104:107]
v_exp_f32 v137, v137
v_mfma_f32_16x16x32_bf16 a[108:111], a[204:207], v[204:207], a[108:111]
v_exp_f32 v138, v138
v_mfma_f32_16x16x32_bf16 a[108:111], a[236:239], v[220:223], a[108:111]
ds_read_b128 a[148:151], v2 offset:21504
v_cvt_pk_bf16_f32 v200, v136, v137
v_mfma_f32_16x16x32_bf16 a[44:47], a[236:239], v[212:215], a[44:47]
v_exp_f32 v139, v139
v_mfma_f32_16x16x32_bf16 a[44:47], a[204:207], v[196:199], a[44:47]
v_exp_f32 v152, v152
v_mfma_f32_16x16x32_bf16 a[48:51], a[208:211], v[196:199], a[48:51]
s_waitcnt lgkmcnt(6)
ds_read_b128 a[152:155], v2 offset:22528
v_cvt_pk_bf16_f32 v201, v138, v139
v_mfma_f32_16x16x32_bf16 a[48:51], a[240:243], v[212:215], a[48:51]
buffer_load_dwordx4 v1, s[44:47], s72 offen offset:1024 sc1 lds
v_mfma_f32_16x16x32_bf16 a[112:115], a[240:243], v[220:223], a[112:115]
v_exp_f32 v153, v153
v_mfma_f32_16x16x32_bf16 a[112:115], a[208:211], v[204:207], a[112:115]
v_exp_f32 v154, v154
v_mfma_f32_16x16x32_bf16 a[116:119], a[212:215], v[204:207], a[116:119]
ds_read_b128 a[156:159], v2 offset:23552
v_cvt_pk_bf16_f32 v202, v152, v153
v_mfma_f32_16x16x32_bf16 a[116:119], a[244:247], v[220:223], a[116:119]
v_exp_f32 v155, v155
v_mfma_f32_16x16x32_bf16 a[52:55], a[244:247], v[212:215], a[52:55]
v_exp_f32 v132, v132
v_mfma_f32_16x16x32_bf16 a[52:55], a[212:215], v[196:199], a[52:55]
ds_read_b128 a[192:195], v2 offset:0
v_cvt_pk_bf16_f32 v203, v154, v155
v_mfma_f32_16x16x32_bf16 a[56:59], a[216:219], v[196:199], a[56:59]
v_exp_f32 v133, v133
v_mfma_f32_16x16x32_bf16 a[56:59], a[248:251], v[212:215], a[56:59]
v_exp_f32 v134, v134
v_mfma_f32_16x16x32_bf16 a[120:123], a[248:251], v[220:223], a[120:123]
ds_read_b128 a[196:199], v2 offset:1024
v_mfma_f32_16x16x32_bf16 a[120:123], a[216:219], v[204:207], a[120:123]
v_exp_f32 v135, v135
v_mfma_f32_16x16x32_bf16 a[124:127], a[220:223], v[204:207], a[124:127]
v_exp_f32 v148, v148
v_mfma_f32_16x16x32_bf16 a[124:127], a[252:255], v[220:223], a[124:127]
ds_read_b128 a[200:203], v2 offset:2048
v_mfma_f32_16x16x32_bf16 a[60:63], a[252:255], v[212:215], a[60:63]
buffer_load_dwordx4 v1, s[44:47], s72 offen offset:2048 sc1 lds
v_mfma_f32_16x16x32_bf16 a[60:63], a[220:223], v[196:199], a[60:63]
ds_read_b128 a[204:207], v2 offset:3072
v_cvt_pk_bf16_f32 v196, v132, v133
v_mfma_f32_16x16x32_bf16 v[164:167], a[160:163], v[32:35], v[84:87]
v_exp_f32 v149, v149
v_mfma_f32_16x16x32_bf16 v[164:167], a[164:167], v[36:39], v[164:167]
v_exp_f32 v150, v150
v_mfma_f32_16x16x32_bf16 v[164:167], a[168:171], v[40:43], v[164:167]
ds_read_b128 a[208:211], v2 offset:4096
v_cvt_pk_bf16_f32 v197, v134, v135
v_mfma_f32_16x16x32_bf16 v[164:167], a[172:175], v[44:47], v[164:167]
v_exp_f32 v151, v151
v_mfma_f32_16x16x32_bf16 v[172:175], a[172:175], v[76:79], v[92:95]
v_exp_f32 v140, v140
v_mfma_f32_16x16x32_bf16 v[172:175], a[168:171], v[72:75], v[172:175]
ds_read_b128 a[212:215], v2 offset:5120
v_cvt_pk_bf16_f32 v198, v148, v149
v_mfma_f32_16x16x32_bf16 v[172:175], a[164:167], v[68:71], v[172:175]
v_exp_f32 v141, v141
v_mfma_f32_16x16x32_bf16 v[172:175], a[160:163], v[64:67], v[172:175]
v_exp_f32 v142, v142
v_mfma_f32_16x16x32_bf16 v[188:191], a[176:179], v[64:67], v[92:95]
ds_read_b128 a[216:219], v2 offset:6144
v_cvt_pk_bf16_f32 v199, v150, v151
v_mfma_f32_16x16x32_bf16 v[188:191], a[180:183], v[68:71], v[188:191]
v_exp_f32 v143, v143
v_mfma_f32_16x16x32_bf16 v[188:191], a[184:187], v[72:75], v[188:191]
v_exp_f32 v156, v156
v_mfma_f32_16x16x32_bf16 v[188:191], a[188:191], v[76:79], v[188:191]
ds_read_b128 a[220:223], v2 offset:7168
v_cvt_pk_bf16_f32 v204, v140, v141
v_mfma_f32_16x16x32_bf16 v[180:183], a[188:191], v[44:47], v[84:87]
buffer_load_dwordx4 v1, s[44:47], s72 offen offset:3072 sc1 lds
v_mfma_f32_16x16x32_bf16 v[180:183], a[184:187], v[40:43], v[180:183]
v_exp_f32 v157, v157
v_mfma_f32_16x16x32_bf16 v[180:183], a[180:183], v[36:39], v[180:183]
v_exp_f32 v158, v158
v_mfma_f32_16x16x32_bf16 v[180:183], a[176:179], v[32:35], v[180:183]
v_cvt_pk_bf16_f32 v205, v142, v143
v_cvt_pk_bf16_f32 v206, v156, v157
v_mfma_f32_16x16x32_bf16 v[160:163], a[160:163], v[16:19], v[80:83]
v_exp_f32 v159, v159
v_mfma_f32_16x16x32_bf16 v[160:163], a[164:167], v[20:23], v[160:163]
v_cvt_pk_bf16_f32 v207, v158, v159
v_mfma_f32_16x16x32_bf16 v[160:163], a[168:171], v[24:27], v[160:163]
v_mfma_f32_16x16x32_bf16 v[160:163], a[172:175], v[28:31], v[160:163]
v_mfma_f32_16x16x32_bf16 v[168:171], a[172:175], v[60:63], v[88:91]
v_mfma_f32_16x16x32_bf16 v[168:171], a[168:171], v[56:59], v[168:171]
v_mfma_f32_16x16x32_bf16 v[168:171], a[164:167], v[52:55], v[168:171]
v_mfma_f32_16x16x32_bf16 v[168:171], a[160:163], v[48:51], v[168:171]
v_mfma_f32_16x16x32_bf16 v[184:187], a[176:179], v[48:51], v[88:91]
v_mfma_f32_16x16x32_bf16 v[184:187], a[180:183], v[52:55], v[184:187]
v_mfma_f32_16x16x32_bf16 v[184:187], a[184:187], v[56:59], v[184:187]
v_mfma_f32_16x16x32_bf16 v[184:187], a[188:191], v[60:63], v[184:187]
v_mfma_f32_16x16x32_bf16 v[176:179], a[188:191], v[28:31], v[80:83]
v_mfma_f32_16x16x32_bf16 v[176:179], a[184:187], v[24:27], v[176:179]
v_mfma_f32_16x16x32_bf16 v[176:179], a[180:183], v[20:23], v[176:179]
v_mfma_f32_16x16x32_bf16 v[176:179], a[176:179], v[16:19], v[176:179]
s_waitcnt lgkmcnt(4)
v_mfma_f32_16x16x32_bf16 v[224:227], v[120:123], v[208:211], v[224:227]
s_add_u32 s82, s82, 0x8000
ds_read_b128 a[160:163], v2 offset:24576
v_mfma_f32_16x16x32_bf16 v[224:227], v[120:123], v[192:195], v[224:227]
s_and_b32 s82, s82, 0x1ffff
v_exp_f32 v164, v164
v_mfma_f32_16x16x32_bf16 v[232:235], v[120:123], v[216:219], v[232:235]
s_add_u32 m0, s74, 0
v_exp_f32 v165, v165
v_mfma_f32_16x16x32_bf16 v[232:235], v[120:123], v[200:203], v[232:235]
s_add_u32 s72, s81, 0
ds_read_b128 a[164:167], v2 offset:25600
v_cvt_pk_bf16_f32 v212, v164, v165
v_mfma_f32_16x16x32_bf16 a[0:3], a[224:227], v[208:211], a[0:3]
v_exp_f32 v166, v166
v_mfma_f32_16x16x32_bf16 a[0:3], a[192:195], v[192:195], a[0:3]
v_exp_f32 v167, v167
v_mfma_f32_16x16x32_bf16 a[64:67], a[192:195], v[200:203], a[64:67]
buffer_load_dwordx4 v1, s[44:47], s72 offen sc1 lds
v_mfma_f32_16x16x32_bf16 a[64:67], a[224:227], v[216:219], a[64:67]
ds_read_b128 a[168:171], v2 offset:26624
v_cvt_pk_bf16_f32 v213, v166, v167
v_mfma_f32_16x16x32_bf16 a[68:71], a[228:231], v[216:219], a[68:71]
v_exp_f32 v180, v180
v_mfma_f32_16x16x32_bf16 a[68:71], a[196:199], v[200:203], a[68:71]
v_exp_f32 v181, v181
v_mfma_f32_16x16x32_bf16 a[4:7], a[196:199], v[192:195], a[4:7]
ds_read_b128 a[172:175], v2 offset:27648
v_cvt_pk_bf16_f32 v214, v180, v181
v_mfma_f32_16x16x32_bf16 a[4:7], a[228:231], v[208:211], a[4:7]
v_exp_f32 v182, v182
v_mfma_f32_16x16x32_bf16 a[8:11], a[232:235], v[208:211], a[8:11]
v_exp_f32 v183, v183
v_mfma_f32_16x16x32_bf16 a[8:11], a[200:203], v[192:195], a[8:11]
ds_read_b128 a[176:179], v2 offset:28672
v_cvt_pk_bf16_f32 v215, v182, v183
v_mfma_f32_16x16x32_bf16 a[72:75], a[200:203], v[200:203], a[72:75]
v_exp_f32 v172, v172
v_mfma_f32_16x16x32_bf16 a[72:75], a[232:235], v[216:219], a[72:75]
v_exp_f32 v173, v173
v_mfma_f32_16x16x32_bf16 a[76:79], a[236:239], v[216:219], a[76:79]
ds_read_b128 a[180:183], v2 offset:29696
v_cvt_pk_bf16_f32 v220, v172, v173
v_mfma_f32_16x16x32_bf16 a[76:79], a[204:207], v[200:203], a[76:79]
buffer_load_dwordx4 v1, s[44:47], s72 offen offset:1024 sc1 lds
v_mfma_f32_16x16x32_bf16 a[12:15], a[204:207], v[192:195], a[12:15]
v_exp_f32 v174, v174
v_mfma_f32_16x16x32_bf16 a[12:15], a[236:239], v[208:211], a[12:15]
v_exp_f32 v175, v175
v_mfma_f32_16x16x32_bf16 a[16:19], a[240:243], v[208:211], a[16:19]
s_waitcnt lgkmcnt(6)
ds_read_b128 a[184:187], v2 offset:30720
v_cvt_pk_bf16_f32 v221, v174, v175
v_mfma_f32_16x16x32_bf16 a[16:19], a[208:211], v[192:195], a[16:19]
v_exp_f32 v188, v188
v_mfma_f32_16x16x32_bf16 a[80:83], a[208:211], v[200:203], a[80:83]
v_exp_f32 v189, v189
v_mfma_f32_16x16x32_bf16 a[80:83], a[240:243], v[216:219], a[80:83]
ds_read_b128 a[188:191], v2 offset:31744
v_cvt_pk_bf16_f32 v222, v188, v189
v_mfma_f32_16x16x32_bf16 a[84:87], a[244:247], v[216:219], a[84:87]
v_exp_f32 v190, v190
v_mfma_f32_16x16x32_bf16 a[84:87], a[212:215], v[200:203], a[84:87]
v_exp_f32 v191, v191
v_mfma_f32_16x16x32_bf16 a[20:23], a[212:215], v[192:195], a[20:23]
ds_read_b128 a[224:227], v2 offset:8192
v_cvt_pk_bf16_f32 v223, v190, v191
v_mfma_f32_16x16x32_bf16 a[20:23], a[244:247], v[208:211], a[20:23]
v_exp_f32 v160, v160
v_mfma_f32_16x16x32_bf16 a[24:27], a[248:251], v[208:211], a[24:27]
buffer_load_dwordx4 v1, s[44:47], s72 offen offset:2048 sc1 lds
v_mfma_f32_16x16x32_bf16 a[24:27], a[216:219], v[192:195], a[24:27]
v_exp_f32 v161, v161
v_mfma_f32_16x16x32_bf16 a[88:91], a[216:219], v[200:203], a[88:91]
ds_read_b128 a[228:231], v2 offset:9216
v_mfma_f32_16x16x32_bf16 a[88:91], a[248:251], v[216:219], a[88:91]
v_exp_f32 v162, v162
v_mfma_f32_16x16x32_bf16 a[92:95], a[252:255], v[216:219], a[92:95]
v_exp_f32 v163, v163
v_mfma_f32_16x16x32_bf16 a[92:95], a[220:223], v[200:203], a[92:95]
ds_read_b128 a[232:235], v2 offset:10240
v_mfma_f32_16x16x32_bf16 a[28:31], a[220:223], v[192:195], a[28:31]
v_exp_f32 v176, v176
v_mfma_f32_16x16x32_bf16 a[28:31], a[252:255], v[208:211], a[28:31]
ds_read_b128 a[236:239], v2 offset:11264
v_cvt_pk_bf16_f32 v208, v160, v161
v_mfma_f32_16x16x32_bf16 v[128:131], a[128:131], v[16:19], v[80:83]
v_exp_f32 v177, v177
v_mfma_f32_16x16x32_bf16 v[128:131], a[132:135], v[20:23], v[128:131]
v_exp_f32 v178, v178
v_mfma_f32_16x16x32_bf16 v[128:131], a[136:139], v[24:27], v[128:131]
Lstub1:
s_cbranch_execz Lstub5
ds_read_b128 a[240:243], v2 offset:12288
v_cvt_pk_bf16_f32 v209, v162, v163
v_mfma_f32_16x16x32_bf16 v[128:131], a[140:143], v[28:31], v[128:131]
buffer_load_dwordx4 v1, s[44:47], s72 offen offset:3072 sc1 lds
v_mfma_f32_16x16x32_bf16 v[136:139], a[140:143], v[60:63], v[88:91]
s_add_u32 s75, s75, 0x1000
v_exp_f32 v179, v179
v_mfma_f32_16x16x32_bf16 v[136:139], a[136:139], v[56:59], v[136:139]
s_and_b32 s76, s75, 0x3000
v_exp_f32 v168, v168
v_mfma_f32_16x16x32_bf16 v[136:139], a[132:135], v[52:55], v[136:139]
s_cselect_b32 s75, s75, 0x40001000
ds_read_b128 a[244:247], v2 offset:13312
v_cvt_pk_bf16_f32 v210, v176, v177
v_mfma_f32_16x16x32_bf16 v[136:139], a[128:131], v[48:51], v[136:139]
v_exp_f32 v169, v169
v_mfma_f32_16x16x32_bf16 v[152:155], a[144:147], v[48:51], v[88:91]
v_exp_f32 v170, v170
v_mfma_f32_16x16x32_bf16 v[152:155], a[148:151], v[52:55], v[152:155]
ds_read_b128 a[248:251], v2 offset:14336
v_cvt_pk_bf16_f32 v211, v178, v179
v_mfma_f32_16x16x32_bf16 v[152:155], a[152:155], v[56:59], v[152:155]
v_exp_f32 v171, v171
v_mfma_f32_16x16x32_bf16 v[152:155], a[156:159], v[60:63], v[152:155]
v_exp_f32 v184, v184
v_mfma_f32_16x16x32_bf16 v[144:147], a[156:159], v[28:31], v[80:83]
ds_read_b128 a[252:255], v2 offset:15360
v_cvt_pk_bf16_f32 v216, v168, v169
v_mfma_f32_16x16x32_bf16 v[144:147], a[152:155], v[24:27], v[144:147]
buffer_load_dword v4, v15, s[24:27], 0 offen
v_mfma_f32_16x16x32_bf16 v[144:147], a[148:151], v[20:23], v[144:147]
v_exp_f32 v185, v185
v_mfma_f32_16x16x32_bf16 v[144:147], a[144:147], v[16:19], v[144:147]
v_exp_f32 v186, v186
v_mfma_f32_16x16x32_bf16 v[132:135], a[128:131], v[32:35], v[84:87]
v_cvt_pk_bf16_f32 v217, v170, v171
v_cvt_pk_bf16_f32 v218, v184, v185
v_mfma_f32_16x16x32_bf16 v[132:135], a[132:135], v[36:39], v[132:135]
v_exp_f32 v187, v187
v_mfma_f32_16x16x32_bf16 v[132:135], a[136:139], v[40:43], v[132:135]
v_cvt_pk_bf16_f32 v219, v186, v187
v_add_u32 v2, s82, v1
v_mfma_f32_16x16x32_bf16 v[132:135], a[140:143], v[44:47], v[132:135]
v_mfma_f32_16x16x32_bf16 v[140:143], a[140:143], v[76:79], v[92:95]
v_mfma_f32_16x16x32_bf16 v[140:143], a[136:139], v[72:75], v[140:143]
v_mfma_f32_16x16x32_bf16 v[140:143], a[132:135], v[68:71], v[140:143]
v_mfma_f32_16x16x32_bf16 v[140:143], a[128:131], v[64:67], v[140:143]
v_mfma_f32_16x16x32_bf16 v[156:159], a[144:147], v[64:67], v[92:95]
v_mfma_f32_16x16x32_bf16 v[156:159], a[148:151], v[68:71], v[156:159]
v_mfma_f32_16x16x32_bf16 v[156:159], a[152:155], v[72:75], v[156:159]
v_mfma_f32_16x16x32_bf16 v[156:159], a[156:159], v[76:79], v[156:159]
v_mfma_f32_16x16x32_bf16 v[148:151], a[156:159], v[44:47], v[84:87]
s_waitcnt vmcnt(9) lgkmcnt(4)
v_mfma_f32_16x16x32_bf16 v[148:151], a[152:155], v[40:43], v[148:151]
s_barrier
v_mfma_f32_16x16x32_bf16 v[148:151], a[148:151], v[36:39], v[148:151]
s_add_u32 s83, s83, 1
v_mfma_f32_16x16x32_bf16 v[148:151], a[144:147], v[32:35], v[148:151]
s_cbranch_scc0 LloopI
LLT1:
Lstub2:
s_cbranch_execz Lstub6
v_mfma_f32_16x16x32_bf16 v[228:231], v[120:123], v[196:199], v[228:231]
s_xor_b32 s74, s82, 0x10000
v_exp_f32 v128, v128
v_mfma_f32_16x16x32_bf16 v[228:231], v[120:123], v[212:215], v[228:231]
s_add_u32 s74, s74, s64
ds_read_b128 a[128:131], v2 offset:16384
v_mfma_f32_16x16x32_bf16 v[236:239], v[120:123], v[204:207], v[236:239]
s_add_u32 s81, s81, 0x8000
v_exp_f32 v129, v129
v_mfma_f32_16x16x32_bf16 v[236:239], v[120:123], v[220:223], v[236:239]
s_add_u32 m0, s74, 16384
v_exp_f32 v130, v130
v_mfma_f32_16x16x32_bf16 a[32:35], a[192:195], v[196:199], a[32:35]
s_add_u32 s72, s81, 16384
ds_read_b128 a[132:135], v2 offset:17408
v_cvt_pk_bf16_f32 v192, v128, v129
v_mfma_f32_16x16x32_bf16 a[32:35], a[224:227], v[212:215], a[32:35]
v_exp_f32 v131, v131
v_mfma_f32_16x16x32_bf16 a[96:99], a[224:227], v[220:223], a[96:99]
v_exp_f32 v144, v144
v_mfma_f32_16x16x32_bf16 a[96:99], a[192:195], v[204:207], a[96:99]
ds_read_b128 a[136:139], v2 offset:18432
v_cvt_pk_bf16_f32 v193, v130, v131
v_mfma_f32_16x16x32_bf16 a[100:103], a[196:199], v[204:207], a[100:103]
buffer_load_dwordx4 v1, s[44:47], s72 offen sc1 lds
v_mfma_f32_16x16x32_bf16 a[100:103], a[228:231], v[220:223], a[100:103]
v_exp_f32 v145, v145
v_mfma_f32_16x16x32_bf16 a[36:39], a[228:231], v[212:215], a[36:39]
v_exp_f32 v146, v146
v_mfma_f32_16x16x32_bf16 a[36:39], a[196:199], v[196:199], a[36:39]
ds_read_b128 a[140:143], v2 offset:19456
v_cvt_pk_bf16_f32 v194, v144, v145
v_mfma_f32_16x16x32_bf16 a[40:43], a[200:203], v[196:199], a[40:43]
v_exp_f32 v147, v147
v_mfma_f32_16x16x32_bf16 a[40:43], a[232:235], v[212:215], a[40:43]
v_exp_f32 v136, v136
v_mfma_f32_16x16x32_bf16 a[104:107], a[232:235], v[220:223], a[104:107]
ds_read_b128 a[144:147], v2 offset:20480
v_cvt_pk_bf16_f32 v195, v146, v147
v_mfma_f32_16x16x32_bf16 a[104:107], a[200:203], v[204:207], a[104:107]
v_exp_f32 v137, v137
v_mfma_f32_16x16x32_bf16 a[108:111], a[204:207], v[204:207], a[108:111]
v_exp_f32 v138, v138
v_mfma_f32_16x16x32_bf16 a[108:111], a[236:239], v[220:223], a[108:111]
ds_read_b128 a[148:151], v2 offset:21504
v_cvt_pk_bf16_f32 v200, v136, v137
v_mfma_f32_16x16x32_bf16 a[44:47], a[236:239], v[212:215], a[44:47]
v_exp_f32 v139, v139
v_mfma_f32_16x16x32_bf16 a[44:47], a[204:207], v[196:199], a[44:47]
v_exp_f32 v152, v152
v_mfma_f32_16x16x32_bf16 a[48:51], a[208:211], v[196:199], a[48:51]
s_waitcnt lgkmcnt(6)
ds_read_b128 a[152:155], v2 offset:22528
v_cvt_pk_bf16_f32 v201, v138, v139
v_mfma_f32_16x16x32_bf16 a[48:51], a[240:243], v[212:215], a[48:51]
buffer_load_dwordx4 v1, s[44:47], s72 offen offset:1024 sc1 lds
v_mfma_f32_16x16x32_bf16 a[112:115], a[240:243], v[220:223], a[112:115]
v_exp_f32 v153, v153
v_mfma_f32_16x16x32_bf16 a[112:115], a[208:211], v[204:207], a[112:115]
v_exp_f32 v154, v154
v_mfma_f32_16x16x32_bf16 a[116:119], a[212:215], v[204:207], a[116:119]
ds_read_b128 a[156:159], v2 offset:23552
v_cvt_pk_bf16_f32 v202, v152, v153
v_mfma_f32_16x16x32_bf16 a[116:119], a[244:247], v[220:223], a[116:119]
v_exp_f32 v155, v155
v_mfma_f32_16x16x32_bf16 a[52:55], a[244:247], v[212:215], a[52:55]
v_exp_f32 v132, v132
v_mfma_f32_16x16x32_bf16 a[52:55], a[212:215], v[196:199], a[52:55]
ds_read_b128 a[192:195], v2 offset:0
v_cvt_pk_bf16_f32 v203, v154, v155
v_mfma_f32_16x16x32_bf16 a[56:59], a[216:219], v[196:199], a[56:59]
v_exp_f32 v133, v133
v_mfma_f32_16x16x32_bf16 a[56:59], a[248:251], v[212:215], a[56:59]
v_exp_f32 v134, v134
v_mfma_f32_16x16x32_bf16 a[120:123], a[248:251], v[220:223], a[120:123]
ds_read_b128 a[196:199], v2 offset:1024
v_mfma_f32_16x16x32_bf16 a[120:123], a[216:219], v[204:207], a[120:123]
v_exp_f32 v135, v135
v_mfma_f32_16x16x32_bf16 a[124:127], a[220:223], v[204:207], a[124:127]
v_exp_f32 v148, v148
v_mfma_f32_16x16x32_bf16 a[124:127], a[252:255], v[220:223], a[124:127]
ds_read_b128 a[200:203], v2 offset:2048
v_mfma_f32_16x16x32_bf16 a[60:63], a[252:255], v[212:215], a[60:63]
buffer_load_dwordx4 v1, s[44:47], s72 offen offset:2048 sc1 lds
v_mfma_f32_16x16x32_bf16 a[60:63], a[220:223], v[196:199], a[60:63]
ds_read_b128 a[204:207], v2 offset:3072
v_cvt_pk_bf16_f32 v196, v132, v133
v_mfma_f32_16x16x32_bf16 v[164:167], a[160:163], v[32:35], v[84:87]
v_exp_f32 v149, v149
v_mfma_f32_16x16x32_bf16 v[164:167], a[164:167], v[36:39], v[164:167]
v_exp_f32 v150, v150
v_mfma_f32_16x16x32_bf16 v[164:167], a[168:171], v[40:43], v[164:167]
ds_read_b128 a[208:211], v2 offset:4096
v_cvt_pk_bf16_f32 v197, v134, v135
v_mfma_f32_16x16x32_bf16 v[164:167], a[172:175], v[44:47], v[164:167]
v_exp_f32 v151, v151
v_mfma_f32_16x16x32_bf16 v[172:175], a[172:175], v[76:79], v[92:95]
v_exp_f32 v140, v140
v_mfma_f32_16x16x32_bf16 v[172:175], a[168:171], v[72:75], v[172:175]
ds_read_b128 a[212:215], v2 offset:5120
v_cvt_pk_bf16_f32 v198, v148, v149
v_mfma_f32_16x16x32_bf16 v[172:175], a[164:167], v[68:71], v[172:175]
v_exp_f32 v141, v141
v_mfma_f32_16x16x32_bf16 v[172:175], a[160:163], v[64:67], v[172:175]
v_exp_f32 v142, v142
v_mfma_f32_16x16x32_bf16 v[188:191], a[176:179], v[64:67], v[92:95]
ds_read_b128 a[216:219], v2 offset:6144
v_cvt_pk_bf16_f32 v199, v150, v151
v_mfma_f32_16x16x32_bf16 v[188:191], a[180:183], v[68:71], v[188:191]
v_exp_f32 v143, v143
v_mfma_f32_16x16x32_bf16 v[188:191], a[184:187], v[72:75], v[188:191]
v_exp_f32 v156, v156
v_mfma_f32_16x16x32_bf16 v[188:191], a[188:191], v[76:79], v[188:191]
ds_read_b128 a[220:223], v2 offset:7168
v_cvt_pk_bf16_f32 v204, v140, v141
v_mfma_f32_16x16x32_bf16 v[180:183], a[188:191], v[44:47], v[84:87]
buffer_load_dwordx4 v1, s[44:47], s72 offen offset:3072 sc1 lds
v_mfma_f32_16x16x32_bf16 v[180:183], a[184:187], v[40:43], v[180:183]
v_exp_f32 v157, v157
v_mfma_f32_16x16x32_bf16 v[180:183], a[180:183], v[36:39], v[180:183]
v_exp_f32 v158, v158
v_mfma_f32_16x16x32_bf16 v[180:183], a[176:179], v[32:35], v[180:183]
v_cvt_pk_bf16_f32 v205, v142, v143
v_cvt_pk_bf16_f32 v206, v156, v157
v_mfma_f32_16x16x32_bf16 v[160:163], a[160:163], v[16:19], v[80:83]
v_exp_f32 v159, v159
v_mfma_f32_16x16x32_bf16 v[160:163], a[164:167], v[20:23], v[160:163]
v_cvt_pk_bf16_f32 v207, v158, v159
v_mfma_f32_16x16x32_bf16 v[160:163], a[168:171], v[24:27], v[160:163]
v_mfma_f32_16x16x32_bf16 v[160:163], a[172:175], v[28:31], v[160:163]
v_mfma_f32_16x16x32_bf16 v[168:171], a[172:175], v[60:63], v[88:91]
v_mfma_f32_16x16x32_bf16 v[168:171], a[168:171], v[56:59], v[168:171]
v_mfma_f32_16x16x32_bf16 v[168:171], a[164:167], v[52:55], v[168:171]
v_mfma_f32_16x16x32_bf16 v[168:171], a[160:163], v[48:51], v[168:171]
v_mfma_f32_16x16x32_bf16 v[184:187], a[176:179], v[48:51], v[88:91]
v_mfma_f32_16x16x32_bf16 v[184:187], a[180:183], v[52:55], v[184:187]
v_mfma_f32_16x16x32_bf16 v[184:187], a[184:187], v[56:59], v[184:187]
v_mfma_f32_16x16x32_bf16 v[184:187], a[188:191], v[60:63], v[184:187]
v_mfma_f32_16x16x32_bf16 v[176:179], a[188:191], v[28:31], v[80:83]
v_mfma_f32_16x16x32_bf16 v[176:179], a[184:187], v[24:27], v[176:179]
v_mfma_f32_16x16x32_bf16 v[176:179], a[180:183], v[20:23], v[176:179]
v_mfma_f32_16x16x32_bf16 v[176:179], a[176:179], v[16:19], v[176:179]
s_waitcnt lgkmcnt(4)
v_mfma_f32_16x16x32_bf16 v[224:227], v[120:123], v[208:211], v[224:227]
s_add_u32 s82, s82, 0x8000
ds_read_b128 a[160:163], v2 offset:24576
v_mfma_f32_16x16x32_bf16 v[224:227], v[120:123], v[192:195], v[224:227]
s_and_b32 s82, s82, 0x1ffff
v_exp_f32 v164, v164
v_mfma_f32_16x16x32_bf16 v[232:235], v[120:123], v[216:219], v[232:235]
s_add_u32 m0, s74, 0
v_exp_f32 v165, v165
v_mfma_f32_16x16x32_bf16 v[232:235], v[120:123], v[200:203], v[232:235]
s_add_u32 s72, s81, 0
ds_read_b128 a[164:167], v2 offset:25600
v_cvt_pk_bf16_f32 v212, v164, v165
v_mfma_f32_16x16x32_bf16 a[0:3], a[224:227], v[208:211], a[0:3]
v_exp_f32 v166, v166
v_mfma_f32_16x16x32_bf16 a[0:3], a[192:195], v[192:195], a[0:3]
v_exp_f32 v167, v167
v_mfma_f32_16x16x32_bf16 a[64:67], a[192:195], v[200:203], a[64:67]
ds_read_b128 a[168:171], v2 offset:26624
v_cvt_pk_bf16_f32 v213, v166, v167
v_mfma_f32_16x16x32_bf16 a[64:67], a[224:227], v[216:219], a[64:67]
v_exp_f32 v180, v180
v_mfma_f32_16x16x32_bf16 a[68:71], a[228:231], v[216:219], a[68:71]
buffer_load_dwordx4 v1, s[44:47], s72 offen sc1 lds
v_mfma_f32_16x16x32_bf16 a[68:71], a[196:199], v[200:203], a[68:71]
v_exp_f32 v181, v181
v_mfma_f32_16x16x32_bf16 a[4:7], a[196:199], v[192:195], a[4:7]
ds_read_b128 a[172:175], v2 offset:27648
v_cvt_pk_bf16_f32 v214, v180, v181
v_mfma_f32_16x16x32_bf16 a[4:7], a[228:231], v[208:211], a[4:7]
v_exp_f32 v182, v182
v_mfma_f32_16x16x32_bf16 a[8:11], a[232:235], v[208:211], a[8:11]
v_exp_f32 v183, v183
v_mfma_f32_16x16x32_bf16 a[8:11], a[200:203], v[192:195], a[8:11]
ds_read_b128 a[176:179], v2 offset:28672
v_cvt_pk_bf16_f32 v215, v182, v183
v_mfma_f32_16x16x32_bf16 a[72:75], a[200:203], v[200:203], a[72:75]
v_exp_f32 v172, v172
v_mfma_f32_16x16x32_bf16 a[72:75], a[232:235], v[216:219], a[72:75]
v_exp_f32 v173, v173
v_mfma_f32_16x16x32_bf16 a[76:79], a[236:239], v[216:219], a[76:79]
ds_read_b128 a[180:183], v2 offset:29696
v_cvt_pk_bf16_f32 v220, v172, v173
v_mfma_f32_16x16x32_bf16 a[76:79], a[204:207], v[200:203], a[76:79]
v_exp_f32 v174, v174
v_mfma_f32_16x16x32_bf16 a[12:15], a[204:207], v[192:195], a[12:15]
v_exp_f32 v175, v175
v_mfma_f32_16x16x32_bf16 a[12:15], a[236:239], v[208:211], a[12:15]
ds_read_b128 a[184:187], v2 offset:30720
v_cvt_pk_bf16_f32 v221, v174, v175
v_mfma_f32_16x16x32_bf16 a[16:19], a[240:243], v[208:211], a[16:19]
s_waitcnt lgkmcnt(7)
v_exp_f32 v188, v188
v_mfma_f32_16x16x32_bf16 a[16:19], a[208:211], v[192:195], a[16:19]
buffer_load_dwordx4 v1, s[44:47], s72 offen offset:1024 sc1 lds
v_mfma_f32_16x16x32_bf16 a[80:83], a[208:211], v[200:203], a[80:83]
v_exp_f32 v189, v189
v_mfma_f32_16x16x32_bf16 a[80:83], a[240:243], v[216:219], a[80:83]
ds_read_b128 a[188:191], v2 offset:31744
v_cvt_pk_bf16_f32 v222, v188, v189
v_mfma_f32_16x16x32_bf16 a[84:87], a[244:247], v[216:219], a[84:87]
v_exp_f32 v190, v190
v_mfma_f32_16x16x32_bf16 a[84:87], a[212:215], v[200:203], a[84:87]
v_exp_f32 v191, v191
v_mfma_f32_16x16x32_bf16 a[20:23], a[212:215], v[192:195], a[20:23]
ds_read_b128 a[224:227], v2 offset:8192
v_cvt_pk_bf16_f32 v223, v190, v191
v_mfma_f32_16x16x32_bf16 a[20:23], a[244:247], v[208:211], a[20:23]
v_exp_f32 v160, v160
v_mfma_f32_16x16x32_bf16 a[24:27], a[248:251], v[208:211], a[24:27]
v_exp_f32 v161, v161
v_mfma_f32_16x16x32_bf16 a[24:27], a[216:219], v[192:195], a[24:27]
ds_read_b128 a[228:231], v2 offset:9216
v_mfma_f32_16x16x32_bf16 a[88:91], a[216:219], v[200:203], a[88:91]
v_exp_f32 v162, v162
v_mfma_f32_16x16x32_bf16 a[88:91], a[248:251], v[216:219], a[88:91]
v_exp_f32 v163, v163
v_mfma_f32_16x16x32_bf16 a[92:95], a[252:255], v[216:219], a[92:95]
ds_read_b128 a[232:235], v2 offset:10240
v_mfma_f32_16x16x32_bf16 a[92:95], a[220:223], v[200:203], a[92:95]
v_exp_f32 v176, v176
v_mfma_f32_16x16x32_bf16 a[28:31], a[220:223], v[192:195], a[28:31]
buffer_load_dwordx4 v1, s[44:47], s72 offen offset:2048 sc1 lds
v_mfma_f32_16x16x32_bf16 a[28:31], a[252:255], v[208:211], a[28:31]
ds_read_b128 a[236:239], v2 offset:11264
v_cvt_pk_bf16_f32 v208, v160, v161
s_cmp_eq_u32 s58, 0
s_cbranch_scc1 Lta16
s_cmp_eq_u32 s58, 1
s_cbranch_scc1 Lnt17
v_mfma_f32_16x16x32_bf16 v[128:131], a[128:131], v[16:19], v[80:83]
v_exp_f32 v177, v177
v_mfma_f32_16x16x32_bf16 v[144:147], a[144:147], v[16:19], v[80:83]
v_exp_f32 v178, v178
s_branch Ljoin18
Lta16:
v_mfma_f32_16x16x32_bf16 v[128:131], a[128:131], v[16:19], v[96:99]
v_exp_f32 v177, v177
v_mfma_f32_16x16x32_bf16 v[144:147], a[144:147], v[16:19], v[112:115]
v_exp_f32 v178, v178
s_branch Ljoin18
Lnt17:
v_mfma_f32_16x16x32_bf16 v[128:131], a[128:131], v[16:19], v[80:83]
v_exp_f32 v177, v177
v_mfma_f32_16x16x32_bf16 v[144:147], a[144:147], v[16:19], v[96:99]
v_exp_f32 v178, v178
Ljoin18:
v_mfma_f32_16x16x32_bf16 v[128:131], a[132:135], v[20:23], v[128:131]
ds_read_b128 a[240:243], v2 offset:12288
v_cvt_pk_bf16_f32 v209, v162, v163
v_mfma_f32_16x16x32_bf16 v[128:131], a[136:139], v[24:27], v[128:131]
v_exp_f32 v179, v179
v_mfma_f32_16x16x32_bf16 v[128:131], a[140:143], v[28:31], v[128:131]
v_exp_f32 v168, v168
v_mfma_f32_16x16x32_bf16 v[136:139], a[140:143], v[60:63], v[88:91]
ds_read_b128 a[244:247], v2 offset:13312
v_cvt_pk_bf16_f32 v210, v176, v177
v_mfma_f32_16x16x32_bf16 v[136:139], a[136:139], v[56:59], v[136:139]
v_exp_f32 v169, v169
v_mfma_f32_16x16x32_bf16 v[136:139], a[132:135], v[52:55], v[136:139]
v_exp_f32 v170, v170
v_mfma_f32_16x16x32_bf16 v[136:139], a[128:131], v[48:51], v[136:139]
ds_read_b128 a[248:251], v2 offset:14336
v_cvt_pk_bf16_f32 v211, v178, v179
v_mfma_f32_16x16x32_bf16 v[152:155], a[144:147], v[48:51], v[88:91]
v_exp_f32 v171, v171
v_mfma_f32_16x16x32_bf16 v[152:155], a[148:151], v[52:55], v[152:155]
v_exp_f32 v184, v184
v_mfma_f32_16x16x32_bf16 v[152:155], a[152:155], v[56:59], v[152:155]
ds_read_b128 a[252:255], v2 offset:15360
v_cvt_pk_bf16_f32 v216, v168, v169
v_mfma_f32_16x16x32_bf16 v[152:155], a[156:159], v[60:63], v[152:155]
buffer_load_dwordx4 v1, s[44:47], s72 offen offset:3072 sc1 lds
v_mfma_f32_16x16x32_bf16 v[144:147], a[156:159], v[28:31], v[144:147]
v_exp_f32 v185, v185
v_mfma_f32_16x16x32_bf16 v[144:147], a[152:155], v[24:27], v[144:147]
v_exp_f32 v186, v186
v_mfma_f32_16x16x32_bf16 v[144:147], a[148:151], v[20:23], v[144:147]
v_cvt_pk_bf16_f32 v217, v170, v171
v_cvt_pk_bf16_f32 v218, v184, v185
v_mfma_f32_16x16x32_bf16 v[132:135], a[128:131], v[32:35], v[84:87]
v_exp_f32 v187, v187
v_mfma_f32_16x16x32_bf16 v[132:135], a[132:135], v[36:39], v[132:135]
v_cvt_pk_bf16_f32 v219, v186, v187
v_add_u32 v2, s82, v1
v_mfma_f32_16x16x32_bf16 v[132:135], a[136:139], v[40:43], v[132:135]
v_mfma_f32_16x16x32_bf16 v[132:135], a[140:143], v[44:47], v[132:135]
v_mfma_f32_16x16x32_bf16 v[140:143], a[140:143], v[76:79], v[92:95]
v_mfma_f32_16x16x32_bf16 v[140:143], a[136:139], v[72:75], v[140:143]
v_mfma_f32_16x16x32_bf16 v[140:143], a[132:135], v[68:71], v[140:143]
v_mfma_f32_16x16x32_bf16 v[140:143], a[128:131], v[64:67], v[140:143]
v_mfma_f32_16x16x32_bf16 v[156:159], a[144:147], v[64:67], v[92:95]
v_mfma_f32_16x16x32_bf16 v[156:159], a[148:151], v[68:71], v[156:159]
v_mfma_f32_16x16x32_bf16 v[156:159], a[152:155], v[72:75], v[156:159]
v_mfma_f32_16x16x32_bf16 v[156:159], a[156:159], v[76:79], v[156:159]
v_mfma_f32_16x16x32_bf16 v[148:151], a[156:159], v[44:47], v[84:87]
v_mfma_f32_16x16x32_bf16 v[148:151], a[152:155], v[40:43], v[148:151]
v_mfma_f32_16x16x32_bf16 v[148:151], a[148:151], v[36:39], v[148:151]
s_waitcnt vmcnt(8) lgkmcnt(4)
v_mfma_f32_16x16x32_bf16 v[148:151], a[144:147], v[32:35], v[148:151]
s_barrier
v_mfma_f32_16x16x32_bf16 v[228:231], v[120:123], v[196:199], v[228:231]
s_xor_b32 s74, s82, 0x10000
v_exp_f32 v128, v128
v_mfma_f32_16x16x32_bf16 v[228:231], v[120:123], v[212:215], v[228:231]
s_add_u32 s74, s74, s64
ds_read_b128 a[128:131], v2 offset:16384
v_mfma_f32_16x16x32_bf16 v[236:239], v[120:123], v[204:207], v[236:239]
s_add_u32 s81, s81, 0x8000
v_exp_f32 v129, v129
v_mfma_f32_16x16x32_bf16 v[236:239], v[120:123], v[220:223], v[236:239]
s_add_u32 m0, s74, 16384
v_exp_f32 v130, v130
v_mfma_f32_16x16x32_bf16 a[32:35], a[192:195], v[196:199], a[32:35]
s_add_u32 s72, s81, 16384
ds_read_b128 a[132:135], v2 offset:17408
v_cvt_pk_bf16_f32 v192, v128, v129
v_mfma_f32_16x16x32_bf16 a[32:35], a[224:227], v[212:215], a[32:35]
v_exp_f32 v131, v131
v_mfma_f32_16x16x32_bf16 a[96:99], a[224:227], v[220:223], a[96:99]
v_exp_f32 v144, v144
v_mfma_f32_16x16x32_bf16 a[96:99], a[192:195], v[204:207], a[96:99]
ds_read_b128 a[136:139], v2 offset:18432
v_cvt_pk_bf16_f32 v193, v130, v131
v_mfma_f32_16x16x32_bf16 a[100:103], a[196:199], v[204:207], a[100:103]
buffer_load_dwordx4 v1, s[44:47], s72 offen sc1 lds
v_mfma_f32_16x16x32_bf16 a[100:103], a[228:231], v[220:223], a[100:103]
v_exp_f32 v145, v145
v_mfma_f32_16x16x32_bf16 a[36:39], a[228:231], v[212:215], a[36:39]
v_exp_f32 v146, v146
v_mfma_f32_16x16x32_bf16 a[36:39], a[196:199], v[196:199], a[36:39]
ds_read_b128 a[140:143], v2 offset:19456
v_cvt_pk_bf16_f32 v194, v144, v145
v_mfma_f32_16x16x32_bf16 a[40:43], a[200:203], v[196:199], a[40:43]
v_exp_f32 v147, v147
v_mfma_f32_16x16x32_bf16 a[40:43], a[232:235], v[212:215], a[40:43]
v_exp_f32 v136, v136
v_mfma_f32_16x16x32_bf16 a[104:107], a[232:235], v[220:223], a[104:107]
ds_read_b128 a[144:147], v2 offset:20480
v_cvt_pk_bf16_f32 v195, v146, v147
v_mfma_f32_16x16x32_bf16 a[104:107], a[200:203], v[204:207], a[104:107]
v_exp_f32 v137, v137
v_mfma_f32_16x16x32_bf16 a[108:111], a[204:207], v[204:207], a[108:111]
v_exp_f32 v138, v138
v_mfma_f32_16x16x32_bf16 a[108:111], a[236:239], v[220:223], a[108:111]
ds_read_b128 a[148:151], v2 offset:21504
v_cvt_pk_bf16_f32 v200, v136, v137
v_mfma_f32_16x16x32_bf16 a[44:47], a[236:239], v[212:215], a[44:47]
v_exp_f32 v139, v139
v_mfma_f32_16x16x32_bf16 a[44:47], a[204:207], v[196:199], a[44:47]
v_exp_f32 v152, v152
v_mfma_f32_16x16x32_bf16 a[48:51], a[208:211], v[196:199], a[48:51]
s_waitcnt lgkmcnt(6)
ds_read_b128 a[152:155], v2 offset:22528
v_cvt_pk_bf16_f32 v201, v138, v139
v_mfma_f32_16x16x32_bf16 a[48:51], a[240:243], v[212:215], a[48:51]
buffer_load_dwordx4 v1, s[44:47], s72 offen offset:1024 sc1 lds
v_mfma_f32_16x16x32_bf16 a[112:115], a[240:243], v[220:223], a[112:115]
v_exp_f32 v153, v153
v_mfma_f32_16x16x32_bf16 a[112:115], a[208:211], v[204:207], a[112:115]
v_exp_f32 v154, v154
v_mfma_f32_16x16x32_bf16 a[116:119], a[212:215], v[204:207], a[116:119]
ds_read_b128 a[156:159], v2 offset:23552
v_cvt_pk_bf16_f32 v202, v152, v153
v_mfma_f32_16x16x32_bf16 a[116:119], a[244:247], v[220:223], a[116:119]
v_exp_f32 v155, v155
v_mfma_f32_16x16x32_bf16 a[52:55], a[244:247], v[212:215], a[52:55]
v_exp_f32 v132, v132
v_mfma_f32_16x16x32_bf16 a[52:55], a[212:215], v[196:199], a[52:55]
ds_read_b128 a[192:195], v2 offset:0
v_cvt_pk_bf16_f32 v203, v154, v155
v_mfma_f32_16x16x32_bf16 a[56:59], a[216:219], v[196:199], a[56:59]
v_exp_f32 v133, v133
v_mfma_f32_16x16x32_bf16 a[56:59], a[248:251], v[212:215], a[56:59]
v_exp_f32 v134, v134
v_mfma_f32_16x16x32_bf16 a[120:123], a[248:251], v[220:223], a[120:123]
ds_read_b128 a[196:199], v2 offset:1024
v_mfma_f32_16x16x32_bf16 a[120:123], a[216:219], v[204:207], a[120:123]
v_exp_f32 v135, v135
v_mfma_f32_16x16x32_bf16 a[124:127], a[220:223], v[204:207], a[124:127]
v_exp_f32 v148, v148
v_mfma_f32_16x16x32_bf16 a[124:127], a[252:255], v[220:223], a[124:127]
ds_read_b128 a[200:203], v2 offset:2048
v_mfma_f32_16x16x32_bf16 a[60:63], a[252:255], v[212:215], a[60:63]
buffer_load_dwordx4 v1, s[44:47], s72 offen offset:2048 sc1 lds
v_mfma_f32_16x16x32_bf16 a[60:63], a[220:223], v[196:199], a[60:63]
ds_read_b128 a[204:207], v2 offset:3072
v_cvt_pk_bf16_f32 v196, v132, v133
s_cmp_eq_u32 s58, 2
s_cbranch_scc1 Lta19
s_cmp_eq_u32 s58, 3
s_cbranch_scc1 Lnt20
v_mfma_f32_16x16x32_bf16 v[160:163], a[160:163], v[16:19], v[112:115]
v_exp_f32 v149, v149
v_mfma_f32_16x16x32_bf16 v[176:179], a[176:179], v[16:19], v[112:115]
v_exp_f32 v150, v150
s_branch Ljoin21
Lta19:
v_mfma_f32_16x16x32_bf16 v[160:163], a[160:163], v[16:19], v[96:99]
v_exp_f32 v149, v149
v_mfma_f32_16x16x32_bf16 v[176:179], a[176:179], v[16:19], v[112:115]
v_exp_f32 v150, v150
s_branch Ljoin21
Lnt20:
v_mfma_f32_16x16x32_bf16 v[160:163], a[160:163], v[16:19], v[80:83]
v_exp_f32 v149, v149
v_mfma_f32_16x16x32_bf16 v[176:179], a[176:179], v[16:19], v[96:99]
v_exp_f32 v150, v150
Ljoin21:
v_mfma_f32_16x16x32_bf16 v[164:167], a[160:163], v[32:35], v[84:87]
ds_read_b128 a[208:211], v2 offset:4096
v_cvt_pk_bf16_f32 v197, v134, v135
v_mfma_f32_16x16x32_bf16 v[164:167], a[164:167], v[36:39], v[164:167]
v_exp_f32 v151, v151
v_mfma_f32_16x16x32_bf16 v[164:167], a[168:171], v[40:43], v[164:167]
v_exp_f32 v140, v140
v_mfma_f32_16x16x32_bf16 v[164:167], a[172:175], v[44:47], v[164:167]
ds_read_b128 a[212:215], v2 offset:5120
v_cvt_pk_bf16_f32 v198, v148, v149
v_mfma_f32_16x16x32_bf16 v[172:175], a[172:175], v[76:79], v[92:95]
v_exp_f32 v141, v141
v_mfma_f32_16x16x32_bf16 v[172:175], a[168:171], v[72:75], v[172:175]
v_exp_f32 v142, v142
v_mfma_f32_16x16x32_bf16 v[172:175], a[164:167], v[68:71], v[172:175]
ds_read_b128 a[216:219], v2 offset:6144
v_cvt_pk_bf16_f32 v199, v150, v151
v_mfma_f32_16x16x32_bf16 v[172:175], a[160:163], v[64:67], v[172:175]
v_exp_f32 v143, v143
v_mfma_f32_16x16x32_bf16 v[188:191], a[176:179], v[64:67], v[92:95]
v_exp_f32 v156, v156
v_mfma_f32_16x16x32_bf16 v[188:191], a[180:183], v[68:71], v[188:191]
ds_read_b128 a[220:223], v2 offset:7168
v_cvt_pk_bf16_f32 v204, v140, v141
v_mfma_f32_16x16x32_bf16 v[188:191], a[184:187], v[72:75], v[188:191]
buffer_load_dwordx4 v1, s[44:47], s72 offen offset:3072 sc1 lds
v_mfma_f32_16x16x32_bf16 v[188:191], a[188:191], v[76:79], v[188:191]
v_exp_f32 v157, v157
v_mfma_f32_16x16x32_bf16 v[180:183], a[188:191], v[44:47], v[84:87]
v_exp_f32 v158, v158
v_mfma_f32_16x16x32_bf16 v[180:183], a[184:187], v[40:43], v[180:183]
v_cvt_pk_bf16_f32 v205, v142, v143
v_cvt_pk_bf16_f32 v206, v156, v157
v_mfma_f32_16x16x32_bf16 v[180:183], a[180:183], v[36:39], v[180:183]
v_exp_f32 v159, v159
v_mfma_f32_16x16x32_bf16 v[180:183], a[176:179], v[32:35], v[180:183]
v_cvt_pk_bf16_f32 v207, v158, v159
v_mfma_f32_16x16x32_bf16 v[160:163], a[164:167], v[20:23], v[160:163]
v_mfma_f32_16x16x32_bf16 v[160:163], a[168:171], v[24:27], v[160:163]
v_mfma_f32_16x16x32_bf16 v[160:163], a[172:175], v[28:31], v[160:163]
v_mfma_f32_16x16x32_bf16 v[168:171], a[172:175], v[60:63], v[88:91]
v_mfma_f32_16x16x32_bf16 v[168:171], a[168:171], v[56:59], v[168:171]
v_mfma_f32_16x16x32_bf16 v[168:171], a[164:167], v[52:55], v[168:171]
v_mfma_f32_16x16x32_bf16 v[168:171], a[160:163], v[48:51], v[168:171]
v_mfma_f32_16x16x32_bf16 v[184:187], a[176:179], v[48:51], v[88:91]
v_mfma_f32_16x16x32_bf16 v[184:187], a[180:183], v[52:55], v[184:187]
v_mfma_f32_16x16x32_bf16 v[184:187], a[184:187], v[56:59], v[184:187]
v_mfma_f32_16x16x32_bf16 v[184:187], a[188:191], v[60:63], v[184:187]
v_mfma_f32_16x16x32_bf16 v[176:179], a[188:191], v[28:31], v[176:179]
v_mfma_f32_16x16x32_bf16 v[176:179], a[184:187], v[24:27], v[176:179]
v_mfma_f32_16x16x32_bf16 v[176:179], a[180:183], v[20:23], v[176:179]
s_waitcnt lgkmcnt(4)
v_mfma_f32_16x16x32_bf16 v[224:227], v[120:123], v[208:211], v[224:227]
s_add_u32 s82, s82, 0x8000
ds_read_b128 a[160:163], v2 offset:24576
v_mfma_f32_16x16x32_bf16 v[224:227], v[120:123], v[192:195], v[224:227]
s_and_b32 s82, s82, 0x1ffff
v_exp_f32 v164, v164
v_mfma_f32_16x16x32_bf16 v[232:235], v[120:123], v[216:219], v[232:235]
s_add_u32 m0, s74, 0
v_exp_f32 v165, v165
v_mfma_f32_16x16x32_bf16 v[232:235], v[120:123], v[200:203], v[232:235]
s_add_u32 s72, s81, 0
ds_read_b128 a[164:167], v2 offset:25600
v_cvt_pk_bf16_f32 v212, v164, v165
v_mfma_f32_16x16x32_bf16 a[0:3], a[224:227], v[208:211], a[0:3]
v_exp_f32 v166, v166
v_mfma_f32_16x16x32_bf16 a[0:3], a[192:195], v[192:195], a[0:3]
v_exp_f32 v167, v167
v_mfma_f32_16x16x32_bf16 a[64:67], a[192:195], v[200:203], a[64:67]
ds_read_b128 a[168:171], v2 offset:26624
v_cvt_pk_bf16_f32 v213, v166, v167
v_mfma_f32_16x16x32_bf16 a[64:67], a[224:227], v[216:219], a[64:67]
v_exp_f32 v180, v180
v_mfma_f32_16x16x32_bf16 a[68:71], a[228:231], v[216:219], a[68:71]
buffer_load_dwordx4 v1, s[44:47], s72 offen sc1 lds
v_mfma_f32_16x16x32_bf16 a[68:71], a[196:199], v[200:203], a[68:71]
v_exp_f32 v181, v181
v_mfma_f32_16x16x32_bf16 a[4:7], a[196:199], v[192:195], a[4:7]
ds_read_b128 a[172:175], v2 offset:27648
v_cvt_pk_bf16_f32 v214, v180, v181
v_mfma_f32_16x16x32_bf16 a[4:7], a[228:231], v[208:211], a[4:7]
v_exp_f32 v182, v182
v_mfma_f32_16x16x32_bf16 a[8:11], a[232:235], v[208:211], a[8:11]
v_exp_f32 v183, v183
v_mfma_f32_16x16x32_bf16 a[8:11], a[200:203], v[192:195], a[8:11]
ds_read_b128 a[176:179], v2 offset:28672
v_cvt_pk_bf16_f32 v215, v182, v183
v_mfma_f32_16x16x32_bf16 a[72:75], a[200:203], v[200:203], a[72:75]
v_exp_f32 v172, v172
v_mfma_f32_16x16x32_bf16 a[72:75], a[232:235], v[216:219], a[72:75]
v_exp_f32 v173, v173
v_mfma_f32_16x16x32_bf16 a[76:79], a[236:239], v[216:219], a[76:79]
ds_read_b128 a[180:183], v2 offset:29696
v_cvt_pk_bf16_f32 v220, v172, v173
v_mfma_f32_16x16x32_bf16 a[76:79], a[204:207], v[200:203], a[76:79]
v_exp_f32 v174, v174
v_mfma_f32_16x16x32_bf16 a[12:15], a[204:207], v[192:195], a[12:15]
v_exp_f32 v175, v175
v_mfma_f32_16x16x32_bf16 a[12:15], a[236:239], v[208:211], a[12:15]
ds_read_b128 a[184:187], v2 offset:30720
v_cvt_pk_bf16_f32 v221, v174, v175
v_mfma_f32_16x16x32_bf16 a[16:19], a[240:243], v[208:211], a[16:19]
s_waitcnt lgkmcnt(7)
v_exp_f32 v188, v188
v_mfma_f32_16x16x32_bf16 a[16:19], a[208:211], v[192:195], a[16:19]
buffer_load_dwordx4 v1, s[44:47], s72 offen offset:1024 sc1 lds
v_mfma_f32_16x16x32_bf16 a[80:83], a[208:211], v[200:203], a[80:83]
v_exp_f32 v189, v189
v_mfma_f32_16x16x32_bf16 a[80:83], a[240:243], v[216:219], a[80:83]
ds_read_b128 a[188:191], v2 offset:31744
v_cvt_pk_bf16_f32 v222, v188, v189
v_mfma_f32_16x16x32_bf16 a[84:87], a[244:247], v[216:219], a[84:87]
v_exp_f32 v190, v190
v_mfma_f32_16x16x32_bf16 a[84:87], a[212:215], v[200:203], a[84:87]
v_exp_f32 v191, v191
v_mfma_f32_16x16x32_bf16 a[20:23], a[212:215], v[192:195], a[20:23]
ds_read_b128 a[224:227], v2 offset:8192
v_cvt_pk_bf16_f32 v223, v190, v191
v_mfma_f32_16x16x32_bf16 a[20:23], a[244:247], v[208:211], a[20:23]
v_exp_f32 v160, v160
v_mfma_f32_16x16x32_bf16 a[24:27], a[248:251], v[208:211], a[24:27]
v_exp_f32 v161, v161
v_mfma_f32_16x16x32_bf16 a[24:27], a[216:219], v[192:195], a[24:27]
ds_read_b128 a[228:231], v2 offset:9216
v_mfma_f32_16x16x32_bf16 a[88:91], a[216:219], v[200:203], a[88:91]
v_exp_f32 v162, v162
v_mfma_f32_16x16x32_bf16 a[88:91], a[248:251], v[216:219], a[88:91]
Lstub3:
s_cbranch_execz Lstub7
v_exp_f32 v163, v163
v_mfma_f32_16x16x32_bf16 a[92:95], a[252:255], v[216:219], a[92:95]
ds_read_b128 a[232:235], v2 offset:10240
v_mfma_f32_16x16x32_bf16 a[92:95], a[220:223], v[200:203], a[92:95]
v_exp_f32 v176, v176
v_mfma_f32_16x16x32_bf16 a[28:31], a[220:223], v[192:195], a[28:31]
buffer_load_dwordx4 v1, s[44:47], s72 offen offset:2048 sc1 lds
v_mfma_f32_16x16x32_bf16 a[28:31], a[252:255], v[208:211], a[28:31]
ds_read_b128 a[236:239], v2 offset:11264
v_cvt_pk_bf16_f32 v208, v160, v161
s_cmp_eq_u32 s58, 0
s_cbranch_scc1 Lta22
s_cmp_eq_u32 s58, 1
s_cbranch_scc1 Lnt23
v_mfma_f32_16x16x32_bf16 v[132:135], a[128:131], v[32:35], v[84:87]
v_exp_f32 v177, v177
v_mfma_f32_16x16x32_bf16 v[148:151], a[144:147], v[32:35], v[84:87]
v_exp_f32 v178, v178
s_branch Ljoin24
Lta22:
v_mfma_f32_16x16x32_bf16 v[132:135], a[128:131], v[32:35], v[100:103]
v_exp_f32 v177, v177
v_mfma_f32_16x16x32_bf16 v[148:151], a[144:147], v[32:35], v[112:115]
v_exp_f32 v178, v178
s_branch Ljoin24
Lnt23:
v_mfma_f32_16x16x32_bf16 v[132:135], a[128:131], v[32:35], v[84:87]
v_exp_f32 v177, v177
v_mfma_f32_16x16x32_bf16 v[148:151], a[144:147], v[32:35], v[100:103]
v_exp_f32 v178, v178
Ljoin24:
v_mfma_f32_16x16x32_bf16 v[136:139], a[128:131], v[48:51], v[88:91]
ds_read_b128 a[240:243], v2 offset:12288
v_cvt_pk_bf16_f32 v209, v162, v163
v_mfma_f32_16x16x32_bf16 v[136:139], a[132:135], v[52:55], v[136:139]
v_exp_f32 v179, v179
v_mfma_f32_16x16x32_bf16 v[136:139], a[136:139], v[56:59], v[136:139]
v_exp_f32 v168, v168
v_mfma_f32_16x16x32_bf16 v[136:139], a[140:143], v[60:63], v[136:139]
ds_read_b128 a[244:247], v2 offset:13312
v_cvt_pk_bf16_f32 v210, v176, v177
v_mfma_f32_16x16x32_bf16 v[152:155], a[156:159], v[60:63], v[88:91]
v_exp_f32 v169, v169
v_mfma_f32_16x16x32_bf16 v[152:155], a[152:155], v[56:59], v[152:155]
v_exp_f32 v170, v170
v_mfma_f32_16x16x32_bf16 v[152:155], a[148:151], v[52:55], v[152:155]
ds_read_b128 a[248:251], v2 offset:14336
v_cvt_pk_bf16_f32 v211, v178, v179
v_mfma_f32_16x16x32_bf16 v[152:155], a[144:147], v[48:51], v[152:155]
v_exp_f32 v171, v171
v_mfma_f32_16x16x32_bf16 v[132:135], a[132:135], v[36:39], v[132:135]
v_exp_f32 v184, v184
v_mfma_f32_16x16x32_bf16 v[132:135], a[136:139], v[40:43], v[132:135]
ds_read_b128 a[252:255], v2 offset:15360
v_cvt_pk_bf16_f32 v216, v168, v169
v_mfma_f32_16x16x32_bf16 v[132:135], a[140:143], v[44:47], v[132:135]
buffer_load_dwordx4 v1, s[44:47], s72 offen offset:3072 sc1 lds
v_mfma_f32_16x16x32_bf16 v[140:143], a[140:143], v[76:79], v[92:95]
v_exp_f32 v185, v185
v_mfma_f32_16x16x32_bf16 v[140:143], a[136:139], v[72:75], v[140:143]
v_exp_f32 v186, v186
v_mfma_f32_16x16x32_bf16 v[140:143], a[132:135], v[68:71], v[140:143]
v_cvt_pk_bf16_f32 v217, v170, v171
v_cvt_pk_bf16_f32 v218, v184, v185
v_mfma_f32_16x16x32_bf16 v[140:143], a[128:131], v[64:67], v[140:143]
v_exp_f32 v187, v187
v_mfma_f32_16x16x32_bf16 v[156:159], a[144:147], v[64:67], v[92:95]
v_cvt_pk_bf16_f32 v219, v186, v187
v_add_u32 v2, s82, v1
v_mfma_f32_16x16x32_bf16 v[156:159], a[148:151], v[68:71], v[156:159]
v_mfma_f32_16x16x32_bf16 v[156:159], a[152:155], v[72:75], v[156:159]
v_mfma_f32_16x16x32_bf16 v[156:159], a[156:159], v[76:79], v[156:159]
v_mfma_f32_16x16x32_bf16 v[148:151], a[156:159], v[44:47], v[148:151]
v_mfma_f32_16x16x32_bf16 v[148:151], a[152:155], v[40:43], v[148:151]
s_waitcnt vmcnt(8) lgkmcnt(4)
v_mfma_f32_16x16x32_bf16 v[148:151], a[148:151], v[36:39], v[148:151]
s_barrier
s_cmp_eq_u32 s60, 7
s_cbranch_scc1 LLT3x
LLT3:
Lstub4:
s_cbranch_execz Lstub8
v_mfma_f32_16x16x32_bf16 v[228:231], v[120:123], v[196:199], v[228:231]
s_xor_b32 s74, s82, 0x10000
v_exp_f32 v136, v136
v_mfma_f32_16x16x32_bf16 v[228:231], v[120:123], v[212:215], v[228:231]
s_add_u32 s74, s74, s64
ds_read_b128 a[128:131], v2 offset:16384
v_and_b32 v240, 15, v0
v_mfma_f32_16x16x32_bf16 v[236:239], v[120:123], v[204:207], v[236:239]
s_add_u32 s81, s81, 0x8000
v_exp_f32 v137, v137
v_mfma_f32_16x16x32_bf16 v[236:239], v[120:123], v[220:223], v[236:239]
s_add_u32 m0, s74, 16384
ds_read_b128 a[132:135], v2 offset:17408
v_cvt_pk_bf16_f32 v200, v136, v137
v_mfma_f32_16x16x32_bf16 a[32:35], a[192:195], v[196:199], a[32:35]
s_add_u32 s72, s81, 16384
buffer_load_dwordx4 v1, s[44:47], s72 offen sc1 lds
v_mfma_f32_16x16x32_bf16 a[32:35], a[224:227], v[212:215], a[32:35]
s_add_u32 s69, s93, 0x3e00000
v_exp_f32 v138, v138
v_mfma_f32_16x16x32_bf16 a[96:99], a[224:227], v[220:223], a[96:99]
v_exp_f32 v139, v139
v_mfma_f32_16x16x32_bf16 a[96:99], a[192:195], v[204:207], a[96:99]
ds_read_b128 a[136:139], v2 offset:18432
v_cvt_pk_bf16_f32 v201, v138, v139
v_mfma_f32_16x16x32_bf16 a[100:103], a[196:199], v[204:207], a[100:103]
v_exp_f32 v152, v152
v_mfma_f32_16x16x32_bf16 a[100:103], a[228:231], v[220:223], a[100:103]
ds_read_b128 a[140:143], v2 offset:19456
v_lshrrev_b32 v241, 4, v0
v_mfma_f32_16x16x32_bf16 a[36:39], a[228:231], v[212:215], a[36:39]
buffer_store_dwordx4 v[112:115], v1, s[44:47], s69 offen sc1
v_mfma_f32_16x16x32_bf16 a[36:39], a[196:199], v[196:199], a[36:39]
v_exp_f32 v153, v153
v_mfma_f32_16x16x32_bf16 a[40:43], a[200:203], v[196:199], a[40:43]
v_exp_f32 v154, v154
v_mfma_f32_16x16x32_bf16 a[40:43], a[232:235], v[212:215], a[40:43]
ds_read_b128 a[144:147], v2 offset:20480
v_cvt_pk_bf16_f32 v202, v152, v153
v_mfma_f32_16x16x32_bf16 a[104:107], a[232:235], v[220:223], a[104:107]
v_exp_f32 v155, v155
v_mfma_f32_16x16x32_bf16 a[104:107], a[200:203], v[204:207], a[104:107]
ds_read_b128 a[148:151], v2 offset:21504
v_cvt_pk_bf16_f32 v203, v154, v155
v_mfma_f32_16x16x32_bf16 a[108:111], a[204:207], v[204:207], a[108:111]
buffer_load_dwordx4 v1, s[44:47], s72 offen offset:1024 sc1 lds
v_mfma_f32_16x16x32_bf16 a[108:111], a[236:239], v[220:223], a[108:111]
v_exp_f32 v132, v132
v_mfma_f32_16x16x32_bf16 a[44:47], a[236:239], v[212:215], a[44:47]
v_exp_f32 v133, v133
v_mfma_f32_16x16x32_bf16 a[44:47], a[204:207], v[196:199], a[44:47]
ds_read_b128 a[152:155], v2 offset:22528
v_add_u32 v248, 1, v240
v_mfma_f32_16x16x32_bf16 a[48:51], a[208:211], v[196:199], a[48:51]
s_waitcnt lgkmcnt(7)
v_exp_f32 v134, v134
v_mfma_f32_16x16x32_bf16 a[48:51], a[240:243], v[212:215], a[48:51]
ds_read_b128 a[156:159], v2 offset:23552
v_and_b32 v249, 3, v248
v_mfma_f32_16x16x32_bf16 a[112:115], a[240:243], v[220:223], a[112:115]
buffer_store_dwordx4 v[112:115], v1, s[44:47], s69 offen offset:1024 sc1
v_mfma_f32_16x16x32_bf16 a[112:115], a[208:211], v[204:207], a[112:115]
v_exp_f32 v135, v135
v_mfma_f32_16x16x32_bf16 a[116:119], a[212:215], v[204:207], a[116:119]
v_exp_f32 v148, v148
v_mfma_f32_16x16x32_bf16 a[116:119], a[244:247], v[220:223], a[116:119]
ds_read_b128 a[192:195], v2 offset:0
v_lshrrev_b32 v248, 2, v248
v_mfma_f32_16x16x32_bf16 a[52:55], a[244:247], v[212:215], a[52:55]
v_exp_f32 v149, v149
v_mfma_f32_16x16x32_bf16 a[52:55], a[212:215], v[196:199], a[52:55]
ds_read_b128 a[196:199], v2 offset:1024
v_mov_b32 v250, 0x20000
v_mfma_f32_16x16x32_bf16 a[56:59], a[216:219], v[196:199], a[56:59]
buffer_load_dwordx4 v1, s[44:47], s72 offen offset:2048 sc1 lds
v_mfma_f32_16x16x32_bf16 a[56:59], a[248:251], v[212:215], a[56:59]
v_exp_f32 v150, v150
v_mfma_f32_16x16x32_bf16 a[120:123], a[248:251], v[220:223], a[120:123]
v_exp_f32 v151, v151
v_mfma_f32_16x16x32_bf16 a[120:123], a[216:219], v[204:207], a[120:123]
ds_read_b128 a[200:203], v2 offset:2048
v_mov_b32 v252, 0x20001
v_mfma_f32_16x16x32_bf16 a[124:127], a[220:223], v[204:207], a[124:127]
v_exp_f32 v140, v140
v_mfma_f32_16x16x32_bf16 a[124:127], a[252:255], v[220:223], a[124:127]
ds_read_b128 a[204:207], v2 offset:3072
v_lshlrev_b32 v6, 3, v249
v_mfma_f32_16x16x32_bf16 a[60:63], a[252:255], v[212:215], a[60:63]
buffer_store_dwordx4 v[112:115], v1, s[44:47], s69 offen offset:2048 sc1
v_mfma_f32_16x16x32_bf16 a[60:63], a[220:223], v[196:199], a[60:63]
ds_read_b128 a[208:211], v2 offset:4096
v_cvt_pk_bf16_f32 v196, v132, v133
s_cmp_eq_u32 s58, 2
s_cbranch_scc1 Lta25
s_cmp_eq_u32 s58, 3
s_cbranch_scc1 Lnt26
v_mfma_f32_16x16x32_bf16 v[164:167], a[160:163], v[32:35], v[112:115]
ds_read_b128 a[212:215], v2 offset:5120
v_cvt_pk_bf16_f32 v197, v134, v135
v_mfma_f32_16x16x32_bf16 v[180:183], a[176:179], v[32:35], v[112:115]
ds_read_b128 a[216:219], v2 offset:6144
v_cvt_pk_bf16_f32 v198, v148, v149
s_branch Ljoin27
Lta25:
v_mfma_f32_16x16x32_bf16 v[164:167], a[160:163], v[32:35], v[100:103]
ds_read_b128 a[212:215], v2 offset:5120
v_cvt_pk_bf16_f32 v197, v134, v135
v_mfma_f32_16x16x32_bf16 v[180:183], a[176:179], v[32:35], v[112:115]
ds_read_b128 a[216:219], v2 offset:6144
v_cvt_pk_bf16_f32 v198, v148, v149
s_branch Ljoin27
Lnt26:
v_mfma_f32_16x16x32_bf16 v[164:167], a[160:163], v[32:35], v[84:87]
ds_read_b128 a[212:215], v2 offset:5120
v_cvt_pk_bf16_f32 v197, v134, v135
v_mfma_f32_16x16x32_bf16 v[180:183], a[176:179], v[32:35], v[100:103]
ds_read_b128 a[216:219], v2 offset:6144
v_cvt_pk_bf16_f32 v198, v148, v149
Ljoin27:
v_mfma_f32_16x16x32_bf16 v[164:167], a[164:167], v[36:39], v[164:167]
v_exp_f32 v141, v141
v_mfma_f32_16x16x32_bf16 v[164:167], a[168:171], v[40:43], v[164:167]
v_exp_f32 v142, v142
v_mfma_f32_16x16x32_bf16 v[164:167], a[172:175], v[44:47], v[164:167]
ds_read_b128 a[220:223], v2 offset:7168
v_cvt_pk_bf16_f32 v199, v150, v151
v_mfma_f32_16x16x32_bf16 v[172:175], a[172:175], v[76:79], v[92:95]
v_exp_f32 v143, v143
v_mfma_f32_16x16x32_bf16 v[172:175], a[168:171], v[72:75], v[172:175]
buffer_load_dwordx4 v1, s[44:47], s72 offen offset:3072 sc1 lds
v_mfma_f32_16x16x32_bf16 v[172:175], a[164:167], v[68:71], v[172:175]
v_exp_f32 v156, v156
v_mfma_f32_16x16x32_bf16 v[172:175], a[160:163], v[64:67], v[172:175]
v_cvt_pk_bf16_f32 v204, v140, v141
v_cvt_pk_bf16_f32 v205, v142, v143
v_mfma_f32_16x16x32_bf16 v[188:191], a[176:179], v[64:67], v[92:95]
v_exp_f32 v157, v157
v_mfma_f32_16x16x32_bf16 v[188:191], a[180:183], v[68:71], v[188:191]
v_exp_f32 v158, v158
v_mfma_f32_16x16x32_bf16 v[188:191], a[184:187], v[72:75], v[188:191]
buffer_store_dwordx4 v[112:115], v1, s[44:47], s69 offen offset:3072 sc1
v_mfma_f32_16x16x32_bf16 v[188:191], a[188:191], v[76:79], v[188:191]
v_exp_f32 v159, v159
v_mfma_f32_16x16x32_bf16 v[180:183], a[188:191], v[44:47], v[180:183]
v_cvt_pk_bf16_f32 v206, v156, v157
v_cvt_pk_bf16_f32 v207, v158, v159
v_mfma_f32_16x16x32_bf16 v[180:183], a[184:187], v[40:43], v[180:183]
v_lshrrev_b32 v6, v6, v252
v_and_b32 v6, 3, v6
v_mfma_f32_16x16x32_bf16 v[180:183], a[180:183], v[36:39], v[180:183]
v_cmp_ne_u32 vcc, 1, v249
v_mul_u32_u24 v6, 16640, v6
v_mfma_f32_16x16x32_bf16 v[168:171], a[160:163], v[48:51], v[88:91]
v_add_u32 v6, s92, v6
v_cndmask_b32 v6, v250, v6, vcc
v_mfma_f32_16x16x32_bf16 v[168:171], a[164:167], v[52:55], v[168:171]
v_add_u32 v253, s58, v249
v_and_b32 v253, 3, v253
v_mfma_f32_16x16x32_bf16 v[168:171], a[168:171], v[56:59], v[168:171]
v_mul_u32_u24 v253, 4160, v253
v_add_u32 v6, v6, v253
v_mfma_f32_16x16x32_bf16 v[168:171], a[172:175], v[60:63], v[168:171]
v_bfe_u32 v251, v0, 2, 2
v_lshl_add_u32 v6, v248, 3, v6
v_mfma_f32_16x16x32_bf16 v[184:187], a[188:191], v[60:63], v[88:91]
v_lshl_add_u32 v6, v241, 4, v6
v_lshlrev_b32 v5, 3, v251
v_mfma_f32_16x16x32_bf16 v[184:187], a[184:187], v[56:59], v[184:187]
v_lshrrev_b32 v5, v5, v252
v_and_b32 v5, 3, v5
v_mfma_f32_16x16x32_bf16 v[184:187], a[180:183], v[52:55], v[184:187]
v_cmp_ne_u32 vcc, 1, v251
v_mul_u32_u24 v5, 16640, v5
v_mfma_f32_16x16x32_bf16 v[184:187], a[176:179], v[48:51], v[184:187]
s_waitcnt lgkmcnt(4)
v_mfma_f32_16x16x32_bf16 v[224:227], v[120:123], v[208:211], v[224:227]
s_add_u32 s82, s82, 0x8000
ds_read_b128 a[160:163], v2 offset:24576
ds_read_b128 a[164:167], v2 offset:25600
v_mfma_f32_16x16x32_bf16 v[232:235], v[120:123], v[216:219], v[232:235]
s_and_b32 s82, s82, 0x1ffff
v_exp_f32 v164, v164
v_mfma_f32_16x16x32_bf16 v[232:235], v[120:123], v[200:203], v[232:235]
s_add_u32 m0, s74, 0
v_exp_f32 v165, v165
v_mfma_f32_16x16x32_bf16 a[0:3], a[224:227], v[208:211], a[0:3]
s_add_u32 s72, s81, 0
v_exp_f32 v166, v166
v_mfma_f32_16x16x32_bf16 a[64:67], a[192:195], v[200:203], a[64:67]
ds_read_b128 a[168:171], v2 offset:26624
v_cvt_pk_bf16_f32 v212, v164, v165
v_mfma_f32_16x16x32_bf16 a[64:67], a[224:227], v[216:219], a[64:67]
v_exp_f32 v167, v167
v_mfma_f32_16x16x32_bf16 a[68:71], a[228:231], v[216:219], a[68:71]
buffer_load_dwordx4 v1, s[44:47], s72 offen sc1 lds
v_mfma_f32_16x16x32_bf16 a[68:71], a[196:199], v[200:203], a[68:71]
v_exp_f32 v180, v180
v_mfma_f32_16x16x32_bf16 a[4:7], a[228:231], v[208:211], a[4:7]
ds_read_b128 a[172:175], v2 offset:27648
v_cvt_pk_bf16_f32 v213, v166, v167
v_mfma_f32_16x16x32_bf16 a[8:11], a[232:235], v[208:211], a[8:11]
v_exp_f32 v181, v181
v_mfma_f32_16x16x32_bf16 a[72:75], a[200:203], v[200:203], a[72:75]
ds_read_b128 a[176:179], v2 offset:28672
v_cvt_pk_bf16_f32 v214, v180, v181
v_mfma_f32_16x16x32_bf16 a[72:75], a[232:235], v[216:219], a[72:75]
v_exp_f32 v182, v182
v_mfma_f32_16x16x32_bf16 a[76:79], a[236:239], v[216:219], a[76:79]
v_exp_f32 v183, v183
v_mfma_f32_16x16x32_bf16 a[76:79], a[204:207], v[200:203], a[76:79]
ds_read_b128 a[180:183], v2 offset:29696
v_cvt_pk_bf16_f32 v215, v182, v183
v_mfma_f32_16x16x32_bf16 a[12:15], a[236:239], v[208:211], a[12:15]
v_exp_f32 v172, v172
v_mfma_f32_16x16x32_bf16 a[16:19], a[240:243], v[208:211], a[16:19]
s_waitcnt lgkmcnt(6)
ds_read_b128 a[184:187], v2 offset:30720
ds_read_b128 a[188:191], v2 offset:31744
v_mfma_f32_16x16x32_bf16 a[80:83], a[208:211], v[200:203], a[80:83]
v_exp_f32 v173, v173
v_mfma_f32_16x16x32_bf16 a[80:83], a[240:243], v[216:219], a[80:83]
buffer_load_dwordx4 v1, s[44:47], s72 offen offset:1024 sc1 lds
v_mfma_f32_16x16x32_bf16 a[84:87], a[244:247], v[216:219], a[84:87]
v_exp_f32 v174, v174
v_mfma_f32_16x16x32_bf16 a[84:87], a[212:215], v[200:203], a[84:87]
v_exp_f32 v175, v175
v_mfma_f32_16x16x32_bf16 a[20:23], a[244:247], v[208:211], a[20:23]
ds_read_b128 a[224:227], v2 offset:8192
v_cvt_pk_bf16_f32 v220, v172, v173
v_mfma_f32_16x16x32_bf16 a[24:27], a[248:251], v[208:211], a[24:27]
v_exp_f32 v188, v188
v_mfma_f32_16x16x32_bf16 a[88:91], a[216:219], v[200:203], a[88:91]
v_exp_f32 v189, v189
v_mfma_f32_16x16x32_bf16 a[88:91], a[248:251], v[216:219], a[88:91]
ds_read_b128 a[228:231], v2 offset:9216
v_cvt_pk_bf16_f32 v221, v174, v175
v_mfma_f32_16x16x32_bf16 a[92:95], a[252:255], v[216:219], a[92:95]
v_exp_f32 v190, v190
v_mfma_f32_16x16x32_bf16 a[92:95], a[220:223], v[200:203], a[92:95]
ds_read_b128 a[232:235], v2 offset:10240
v_cvt_pk_bf16_f32 v222, v188, v189
v_mfma_f32_16x16x32_bf16 a[28:31], a[252:255], v[208:211], a[28:31]
v_exp_f32 v191, v191
v_mfma_f32_16x16x32_bf16 v[136:139], a[128:131], v[48:51], v[88:91]
buffer_load_dwordx4 v1, s[44:47], s72 offen offset:2048 sc1 lds
v_mfma_f32_16x16x32_bf16 v[136:139], a[132:135], v[52:55], v[136:139]
v_exp_f32 v168, v168
v_mfma_f32_16x16x32_bf16 v[136:139], a[136:139], v[56:59], v[136:139]
ds_read_b128 a[236:239], v2 offset:11264
v_cvt_pk_bf16_f32 v223, v190, v191
v_mfma_f32_16x16x32_bf16 v[136:139], a[140:143], v[60:63], v[136:139]
v_exp_f32 v169, v169
v_mfma_f32_16x16x32_bf16 v[152:155], a[156:159], v[60:63], v[88:91]
ds_read_b128 a[240:243], v2 offset:12288
v_cvt_pk_bf16_f32 v216, v168, v169
v_mfma_f32_16x16x32_bf16 v[152:155], a[152:155], v[56:59], v[152:155]
v_exp_f32 v170, v170
v_mfma_f32_16x16x32_bf16 v[152:155], a[148:151], v[52:55], v[152:155]
v_exp_f32 v171, v171
v_mfma_f32_16x16x32_bf16 v[152:155], a[144:147], v[48:51], v[152:155]
ds_read_b128 a[244:247], v2 offset:13312
v_cvt_pk_bf16_f32 v217, v170, v171
v_mfma_f32_16x16x32_bf16 v[140:143], a[128:131], v[64:67], v[92:95]
v_exp_f32 v184, v184
v_mfma_f32_16x16x32_bf16 v[140:143], a[132:135], v[68:71], v[140:143]
ds_read_b128 a[248:251], v2 offset:14336
v_mfma_f32_16x16x32_bf16 v[140:143], a[136:139], v[72:75], v[140:143]
v_exp_f32 v185, v185
v_mfma_f32_16x16x32_bf16 v[140:143], a[140:143], v[76:79], v[140:143]
buffer_load_dwordx4 v1, s[44:47], s72 offen offset:3072 sc1 lds
v_mfma_f32_16x16x32_bf16 v[156:159], a[156:159], v[76:79], v[92:95]
ds_read_b128 a[252:255], v2 offset:15360
v_cvt_pk_bf16_f32 v218, v184, v185
v_mfma_f32_16x16x32_bf16 v[156:159], a[152:155], v[72:75], v[156:159]
v_exp_f32 v186, v186
v_mfma_f32_16x16x32_bf16 v[156:159], a[148:151], v[68:71], v[156:159]
s_waitcnt vmcnt(12) lgkmcnt(4)
v_exp_f32 v187, v187
v_mfma_f32_16x16x32_bf16 v[156:159], a[144:147], v[64:67], v[156:159]
s_barrier
v_cvt_pk_bf16_f32 v219, v186, v187
v_add_u32 v2, s82, v1
v_mfma_f32_16x16x32_bf16 v[228:231], v[120:123], v[196:199], v[228:231]
s_xor_b32 s74, s82, 0x10000
v_exp_f32 v136, v136
v_mfma_f32_16x16x32_bf16 v[228:231], v[120:123], v[212:215], v[228:231]
s_add_u32 s74, s74, s64
ds_read_b128 a[128:131], v2 offset:16384
v_add_u32 v5, s92, v5
v_mfma_f32_16x16x32_bf16 v[236:239], v[120:123], v[204:207], v[236:239]
s_add_u32 s81, s81, 0x8000
v_exp_f32 v137, v137
v_mfma_f32_16x16x32_bf16 v[236:239], v[120:123], v[220:223], v[236:239]
s_add_u32 m0, s74, 16384
ds_read_b128 a[132:135], v2 offset:17408
v_cvt_pk_bf16_f32 v200, v136, v137
v_mfma_f32_16x16x32_bf16 a[32:35], a[192:195], v[196:199], a[32:35]
s_add_u32 s72, s81, 16384
buffer_load_dwordx4 v1, s[44:47], s72 offen sc1 lds
v_mfma_f32_16x16x32_bf16 a[32:35], a[224:227], v[212:215], a[32:35]
s_add_u32 s69, s93, 0x4200000
v_exp_f32 v138, v138
v_mfma_f32_16x16x32_bf16 a[96:99], a[224:227], v[220:223], a[96:99]
ds_read_b128 a[136:139], v2 offset:18432
v_cndmask_b32 v5, v250, v5, vcc
v_mfma_f32_16x16x32_bf16 a[96:99], a[192:195], v[204:207], a[96:99]
v_exp_f32 v139, v139
v_mfma_f32_16x16x32_bf16 a[100:103], a[196:199], v[204:207], a[100:103]
ds_read_b128 a[140:143], v2 offset:19456
v_cvt_pk_bf16_f32 v201, v138, v139
v_mfma_f32_16x16x32_bf16 a[100:103], a[228:231], v[220:223], a[100:103]
buffer_store_dwordx4 v[112:115], v1, s[44:47], s69 offen sc1
v_mfma_f32_16x16x32_bf16 a[36:39], a[228:231], v[212:215], a[36:39]
v_exp_f32 v152, v152
v_mfma_f32_16x16x32_bf16 a[36:39], a[196:199], v[196:199], a[36:39]
ds_read_b128 a[144:147], v2 offset:20480
v_add_u32 v253, s58, v251
v_mfma_f32_16x16x32_bf16 a[40:43], a[200:203], v[196:199], a[40:43]
v_exp_f32 v153, v153
v_mfma_f32_16x16x32_bf16 a[40:43], a[232:235], v[212:215], a[40:43]
ds_read_b128 a[148:151], v2 offset:21504
v_cvt_pk_bf16_f32 v202, v152, v153
v_mfma_f32_16x16x32_bf16 a[104:107], a[232:235], v[220:223], a[104:107]
buffer_load_dwordx4 v1, s[44:47], s72 offen offset:1024 sc1 lds
v_mfma_f32_16x16x32_bf16 a[104:107], a[200:203], v[204:207], a[104:107]
v_exp_f32 v154, v154
v_mfma_f32_16x16x32_bf16 a[108:111], a[204:207], v[204:207], a[108:111]
ds_read_b128 a[152:155], v2 offset:22528
v_and_b32 v253, 3, v253
v_mfma_f32_16x16x32_bf16 a[108:111], a[236:239], v[220:223], a[108:111]
v_exp_f32 v155, v155
v_mfma_f32_16x16x32_bf16 a[44:47], a[236:239], v[212:215], a[44:47]
ds_read_b128 a[156:159], v2 offset:23552
v_cvt_pk_bf16_f32 v203, v154, v155
v_mfma_f32_16x16x32_bf16 a[44:47], a[204:207], v[196:199], a[44:47]
buffer_store_dwordx4 v[112:115], v1, s[44:47], s69 offen offset:1024 sc1
v_mfma_f32_16x16x32_bf16 a[48:51], a[208:211], v[196:199], a[48:51]
s_waitcnt lgkmcnt(8)
v_exp_f32 v140, v140
v_mfma_f32_16x16x32_bf16 a[48:51], a[240:243], v[212:215], a[48:51]
ds_read_b128 a[192:195], v2 offset:0
v_mul_u32_u24 v253, 4160, v253
v_mfma_f32_16x16x32_bf16 a[112:115], a[240:243], v[220:223], a[112:115]
v_exp_f32 v141, v141
v_mfma_f32_16x16x32_bf16 a[112:115], a[208:211], v[204:207], a[112:115]
ds_read_b128 a[196:199], v2 offset:1024
v_add_u32 v5, v5, v253
v_mfma_f32_16x16x32_bf16 a[116:119], a[212:215], v[204:207], a[116:119]
s_add_u32 s73, s62, 480
buffer_load_dwordx4 v1, s[44:47], s72 offen offset:2048 sc1 lds
v_mfma_f32_16x16x32_bf16 a[116:119], a[244:247], v[220:223], a[116:119]
v_exp_f32 v142, v142
v_mfma_f32_16x16x32_bf16 a[52:55], a[244:247], v[212:215], a[52:55]
ds_read_b128 a[200:203], v2 offset:2048
v_lshlrev_b32 v248, 5, v240
v_mfma_f32_16x16x32_bf16 a[52:55], a[212:215], v[196:199], a[52:55]
v_exp_f32 v143, v143
v_mfma_f32_16x16x32_bf16 a[56:59], a[216:219], v[196:199], a[56:59]
ds_read_b128 a[204:207], v2 offset:3072
v_sub_u32 v248, s73, v248
v_mfma_f32_16x16x32_bf16 a[56:59], a[248:251], v[212:215], a[56:59]
buffer_store_dwordx4 v[112:115], v1, s[44:47], s69 offen offset:2048 sc1
v_mfma_f32_16x16x32_bf16 a[120:123], a[248:251], v[220:223], a[120:123]
v_exp_f32 v156, v156
v_mfma_f32_16x16x32_bf16 a[120:123], a[216:219], v[204:207], a[120:123]
ds_read_b128 a[208:211], v2 offset:4096
v_lshl_add_u32 v7, v241, 4, v248
v_mfma_f32_16x16x32_bf16 a[124:127], a[220:223], v[204:207], a[124:127]
s_and_b32 s73, s58, 1
v_exp_f32 v157, v157
v_mfma_f32_16x16x32_bf16 a[124:127], a[252:255], v[220:223], a[124:127]
s_lshl_b32 s73, s73, 4
ds_read_b128 a[212:215], v2 offset:5120
v_mfma_f32_16x16x32_bf16 a[60:63], a[252:255], v[212:215], a[60:63]
s_lshr_b32 s73, s90, s73
buffer_load_dwordx4 v1, s[44:47], s72 offen offset:3072 sc1 lds
v_mfma_f32_16x16x32_bf16 a[60:63], a[220:223], v[196:199], a[60:63]
s_and_b32 s73, s73, 0xffff
ds_read_b128 a[216:219], v2 offset:6144
v_cvt_pk_bf16_f32 v204, v140, v141
v_mfma_f32_16x16x32_bf16 v[172:175], a[160:163], v[64:67], v[92:95]
v_exp_f32 v158, v158
v_mfma_f32_16x16x32_bf16 v[172:175], a[164:167], v[68:71], v[172:175]
ds_read_b128 a[220:223], v2 offset:7168
v_cvt_pk_bf16_f32 v205, v142, v143
v_mfma_f32_16x16x32_bf16 v[172:175], a[168:171], v[72:75], v[172:175]
v_exp_f32 v159, v159
v_mfma_f32_16x16x32_bf16 v[172:175], a[172:175], v[76:79], v[172:175]
buffer_store_dwordx4 v[112:115], v1, s[44:47], s69 offen offset:3072 sc1
v_mfma_f32_16x16x32_bf16 v[188:191], a[188:191], v[76:79], v[92:95]
v_cvt_pk_bf16_f32 v206, v156, v157
v_cvt_pk_bf16_f32 v207, v158, v159
v_mfma_f32_16x16x32_bf16 v[188:191], a[184:187], v[72:75], v[188:191]
v_lshl_add_u32 v248, v241, 3, v240
v_sub_u32 v248, 15, v248
v_mfma_f32_16x16x32_bf16 v[188:191], a[180:183], v[68:71], v[188:191]
v_and_b32 v249, 1, v248
v_lshlrev_b32 v249, 4, v249
v_mfma_f32_16x16x32_bf16 v[188:191], a[176:179], v[64:67], v[188:191]
v_lshlrev_b32 v249, v249, s73
v_lshrrev_b32 v248, 1, v248
v_mfma_f32_16x16x32_bf16 v[168:171], a[160:163], v[48:51], v[88:91]
v_and_b32 v241, 3, v0
v_cmp_eq_u32 vcc, 0, v248
v_mfma_f32_16x16x32_bf16 v[168:171], a[164:167], v[52:55], v[168:171]
v_lshl_add_u32 v5, v241, 3, v5
v_cndmask_b32 v8, 0, v249, vcc
v_mfma_f32_16x16x32_bf16 v[168:171], a[168:171], v[56:59], v[168:171]
v_cmp_eq_u32 vcc, 1, v248
v_lshlrev_b32 v240, 4, v251
v_mfma_f32_16x16x32_bf16 v[168:171], a[172:175], v[60:63], v[168:171]
v_cndmask_b32 v9, 0, v249, vcc
v_cmp_eq_u32 vcc, 2, v248
v_mfma_f32_16x16x32_bf16 v[184:187], a[188:191], v[60:63], v[88:91]
v_sub_u32 v240, 48, v240
v_lshlrev_b64 v[12:13], 16, s[88:89]
v_mfma_f32_16x16x32_bf16 v[184:187], a[184:187], v[56:59], v[184:187]
v_cndmask_b32 v10, 0, v249, vcc
v_cmp_eq_u32 vcc, 3, v248
v_mfma_f32_16x16x32_bf16 v[184:187], a[180:183], v[52:55], v[184:187]
v_lshlrev_b64 v[12:13], v240, v[12:13]
v_cndmask_b32 v11, 0, v249, vcc
v_mfma_f32_16x16x32_bf16 v[184:187], a[176:179], v[48:51], v[184:187]
s_waitcnt lgkmcnt(4)
v_cmp_eq_u32 vcc, 3, v241
s_add_u32 s73, s62, 4096
v_lshl_add_u32 v14, v0, 3, s73
v_cndmask_b32 v12, 0, v12, vcc
v_cndmask_b32 v13, 0, v13, vcc
v_lshrrev_b32 v15, 4, v0
v_lshlrev_b32 v15, 1, v15
v_and_b32 v240, 7, v0
v_xor_b32 v15, v15, v240
v_lshlrev_b32 v15, 4, v15
v_lshrrev_b32 v240, 3, v0
v_lshl_add_u32 v15, v240, 11, v15
s_lshr_b32 s75, s59, 1
s_and_b32 s75, s75, 8
s_add_u32 s75, s75, s60
s_lshl_b32 s76, s65, 2
s_lshr_b32 s80, s59, 2
s_and_b32 s80, s80, 3
s_add_u32 s76, s76, s80
s_lshl_b32 s94, s58, 16
s_lshl_b32 s80, s76, 7
s_add_u32 s94, s94, s80
s_lshl_b32 s80, s75, 18
s_add_u32 s80, s80, s94
v_rcp_f32 v224, v224
v_rcp_f32 v228, v228
s_lshl_b32 s73, s59, 12
s_add_u32 s73, s73, 0x2000000
s_lshl_b32 s70, s67, 2
s_add_u32 s70, s70, s73
v_mov_b32 v225, v224
v_accvgpr_read_b32 v240, a0
v_accvgpr_read_b32 v241, a1
v_accvgpr_read_b32 v242, a2
v_accvgpr_read_b32 v243, a3
v_accvgpr_read_b32 v244, a4
v_accvgpr_read_b32 v245, a5
v_accvgpr_read_b32 v246, a6
v_accvgpr_read_b32 v247, a7
v_pk_mul_f32 v[240:241], v[240:241], v[224:225]
v_pk_mul_f32 v[242:243], v[242:243], v[224:225]
v_pk_mul_f32 v[244:245], v[244:245], v[224:225]
v_pk_mul_f32 v[246:247], v[246:247], v[224:225]
v_cvt_pk_bf16_f32 v128, v240, v241
v_cvt_pk_bf16_f32 v129, v242, v243
v_cvt_pk_bf16_f32 v130, v244, v245
v_cvt_pk_bf16_f32 v131, v246, v247
v_accvgpr_read_b32 v248, a8
v_accvgpr_read_b32 v249, a9
v_accvgpr_read_b32 v250, a10
v_accvgpr_read_b32 v251, a11
v_accvgpr_read_b32 v252, a12
v_accvgpr_read_b32 v253, a13
v_accvgpr_read_b32 v254, a14
v_accvgpr_read_b32 v255, a15
v_pk_mul_f32 v[248:249], v[248:249], v[224:225]
v_pk_mul_f32 v[250:251], v[250:251], v[224:225]
v_pk_mul_f32 v[252:253], v[252:253], v[224:225]
v_pk_mul_f32 v[254:255], v[254:255], v[224:225]
v_cvt_pk_bf16_f32 v144, v248, v249
v_cvt_pk_bf16_f32 v145, v250, v251
v_cvt_pk_bf16_f32 v146, v252, v253
v_cvt_pk_bf16_f32 v147, v254, v255
v_accvgpr_read_b32 v240, a16
v_accvgpr_read_b32 v241, a17
v_accvgpr_read_b32 v242, a18
v_accvgpr_read_b32 v243, a19
v_accvgpr_read_b32 v244, a20
v_accvgpr_read_b32 v245, a21
v_accvgpr_read_b32 v246, a22
v_accvgpr_read_b32 v247, a23
v_pk_mul_f32 v[240:241], v[240:241], v[224:225]
v_pk_mul_f32 v[242:243], v[242:243], v[224:225]
v_pk_mul_f32 v[244:245], v[244:245], v[224:225]
v_pk_mul_f32 v[246:247], v[246:247], v[224:225]
v_cvt_pk_bf16_f32 v160, v240, v241
v_cvt_pk_bf16_f32 v161, v242, v243
v_cvt_pk_bf16_f32 v162, v244, v245
v_cvt_pk_bf16_f32 v163, v246, v247
v_accvgpr_read_b32 v248, a24
v_accvgpr_read_b32 v249, a25
v_accvgpr_read_b32 v250, a26
v_accvgpr_read_b32 v251, a27
v_accvgpr_read_b32 v252, a28
v_accvgpr_read_b32 v253, a29
v_accvgpr_read_b32 v254, a30
v_accvgpr_read_b32 v255, a31
v_pk_mul_f32 v[248:249], v[248:249], v[224:225]
v_pk_mul_f32 v[250:251], v[250:251], v[224:225]
v_pk_mul_f32 v[252:253], v[252:253], v[224:225]
v_pk_mul_f32 v[254:255], v[254:255], v[224:225]
v_cvt_pk_bf16_f32 v176, v248, v249
v_cvt_pk_bf16_f32 v177, v250, v251
v_cvt_pk_bf16_f32 v178, v252, v253
v_cvt_pk_bf16_f32 v179, v254, v255
v_mov_b32 v229, v228
v_accvgpr_read_b32 v240, a32
v_accvgpr_read_b32 v241, a33
v_accvgpr_read_b32 v242, a34
v_accvgpr_read_b32 v243, a35
v_accvgpr_read_b32 v244, a36
v_accvgpr_read_b32 v245, a37
v_accvgpr_read_b32 v246, a38
v_accvgpr_read_b32 v247, a39
v_pk_mul_f32 v[240:241], v[240:241], v[228:229]
v_pk_mul_f32 v[242:243], v[242:243], v[228:229]
v_pk_mul_f32 v[244:245], v[244:245], v[228:229]
v_pk_mul_f32 v[246:247], v[246:247], v[228:229]
v_cvt_pk_bf16_f32 v132, v240, v241
Lstub5:
s_cbranch_execz Lstub9
v_cvt_pk_bf16_f32 v133, v242, v243
v_cvt_pk_bf16_f32 v134, v244, v245
v_cvt_pk_bf16_f32 v135, v246, v247
v_accvgpr_read_b32 v248, a40
v_accvgpr_read_b32 v249, a41
v_accvgpr_read_b32 v250, a42
v_accvgpr_read_b32 v251, a43
v_accvgpr_read_b32 v252, a44
v_accvgpr_read_b32 v253, a45
v_accvgpr_read_b32 v254, a46
v_accvgpr_read_b32 v255, a47
v_pk_mul_f32 v[248:249], v[248:249], v[228:229]
v_pk_mul_f32 v[250:251], v[250:251], v[228:229]
v_pk_mul_f32 v[252:253], v[252:253], v[228:229]
v_pk_mul_f32 v[254:255], v[254:255], v[228:229]
v_cvt_pk_bf16_f32 v148, v248, v249
v_cvt_pk_bf16_f32 v149, v250, v251
v_cvt_pk_bf16_f32 v150, v252, v253
v_cvt_pk_bf16_f32 v151, v254, v255
v_accvgpr_read_b32 v240, a48
v_accvgpr_read_b32 v241, a49
v_accvgpr_read_b32 v242, a50
v_accvgpr_read_b32 v243, a51
v_accvgpr_read_b32 v244, a52
v_accvgpr_read_b32 v245, a53
v_accvgpr_read_b32 v246, a54
v_accvgpr_read_b32 v247, a55
v_pk_mul_f32 v[240:241], v[240:241], v[228:229]
v_pk_mul_f32 v[242:243], v[242:243], v[228:229]
v_pk_mul_f32 v[244:245], v[244:245], v[228:229]
v_pk_mul_f32 v[246:247], v[246:247], v[228:229]
v_cvt_pk_bf16_f32 v164, v240, v241
v_cvt_pk_bf16_f32 v165, v242, v243
v_cvt_pk_bf16_f32 v166, v244, v245
v_cvt_pk_bf16_f32 v167, v246, v247
v_accvgpr_read_b32 v248, a56
v_accvgpr_read_b32 v249, a57
v_accvgpr_read_b32 v250, a58
v_accvgpr_read_b32 v251, a59
v_accvgpr_read_b32 v252, a60
v_accvgpr_read_b32 v253, a61
v_accvgpr_read_b32 v254, a62
v_accvgpr_read_b32 v255, a63
v_pk_mul_f32 v[248:249], v[248:249], v[228:229]
v_pk_mul_f32 v[250:251], v[250:251], v[228:229]
v_pk_mul_f32 v[252:253], v[252:253], v[228:229]
v_pk_mul_f32 v[254:255], v[254:255], v[228:229]
v_cvt_pk_bf16_f32 v180, v248, v249
v_cvt_pk_bf16_f32 v181, v250, v251
v_cvt_pk_bf16_f32 v182, v252, v253
v_cvt_pk_bf16_f32 v183, v254, v255
v_mfma_f32_16x16x32_bf16 v[232:235], v[120:123], v[216:219], v[232:235]
s_add_u32 s82, s82, 0x8000
ds_read_b128 a[160:163], v2 offset:24576
ds_read_b128 a[164:167], v2 offset:25600
v_mfma_f32_16x16x32_bf16 v[232:235], v[120:123], v[200:203], v[232:235]
s_and_b32 s82, s82, 0x1ffff
v_exp_f32 v172, v172
v_mfma_f32_16x16x32_bf16 a[64:67], a[224:227], v[216:219], a[64:67]
s_add_u32 m0, s74, 0
v_exp_f32 v173, v173
v_mfma_f32_16x16x32_bf16 a[64:67], a[192:195], v[200:203], a[64:67]
s_add_u32 s72, s81, 0
buffer_load_dwordx4 v1, s[44:47], s72 offen sc1 lds
v_mfma_f32_16x16x32_bf16 a[68:71], a[196:199], v[200:203], a[68:71]
ds_read_b128 a[168:171], v2 offset:26624
v_cvt_pk_bf16_f32 v220, v172, v173
v_mfma_f32_16x16x32_bf16 a[68:71], a[228:231], v[216:219], a[68:71]
v_exp_f32 v174, v174
v_mfma_f32_16x16x32_bf16 a[72:75], a[232:235], v[216:219], a[72:75]
s_nop 0
ds_read_b128 a[172:175], v2 offset:27648
ds_read_b128 a[176:179], v2 offset:28672
v_mfma_f32_16x16x32_bf16 a[72:75], a[200:203], v[200:203], a[72:75]
v_exp_f32 v175, v175
v_mfma_f32_16x16x32_bf16 a[76:79], a[204:207], v[200:203], a[76:79]
v_exp_f32 v188, v188
v_mfma_f32_16x16x32_bf16 a[76:79], a[236:239], v[216:219], a[76:79]
buffer_store_dwordx4 v[128:131], v1, s[44:47], s70 offen sc1
v_mfma_f32_16x16x32_bf16 a[80:83], a[240:243], v[216:219], a[80:83]
s_waitcnt lgkmcnt(5)
ds_read_b128 a[180:183], v2 offset:29696
v_cvt_pk_bf16_f32 v221, v174, v175
v_mfma_f32_16x16x32_bf16 a[80:83], a[208:211], v[200:203], a[80:83]
v_exp_f32 v189, v189
v_mfma_f32_16x16x32_bf16 a[84:87], a[212:215], v[200:203], a[84:87]
ds_read_b128 a[184:187], v2 offset:30720
v_cvt_pk_bf16_f32 v222, v188, v189
v_mfma_f32_16x16x32_bf16 a[84:87], a[244:247], v[216:219], a[84:87]
v_exp_f32 v190, v190
v_mfma_f32_16x16x32_bf16 a[88:91], a[248:251], v[216:219], a[88:91]
buffer_load_dwordx4 v1, s[44:47], s72 offen offset:1024 sc1 lds
v_mfma_f32_16x16x32_bf16 a[88:91], a[216:219], v[200:203], a[88:91]
s_nop 0
ds_read_b128 a[188:191], v2 offset:31744
ds_read_b128 a[224:227], v2 offset:8192
v_mfma_f32_16x16x32_bf16 a[92:95], a[220:223], v[200:203], a[92:95]
v_exp_f32 v191, v191
v_mfma_f32_16x16x32_bf16 a[92:95], a[252:255], v[216:219], a[92:95]
v_exp_f32 v168, v168
v_mfma_f32_16x16x32_bf16 v[136:139], a[128:131], v[48:51], v[88:91]
ds_read_b128 a[228:231], v2 offset:9216
v_cvt_pk_bf16_f32 v223, v190, v191
v_mfma_f32_16x16x32_bf16 v[136:139], a[132:135], v[52:55], v[136:139]
v_exp_f32 v169, v169
v_mfma_f32_16x16x32_bf16 v[136:139], a[136:139], v[56:59], v[136:139]
buffer_store_dwordx4 v[144:147], v1, s[44:47], s70 offen offset:1024 sc1
v_mfma_f32_16x16x32_bf16 v[136:139], a[140:143], v[60:63], v[136:139]
ds_read_b128 a[232:235], v2 offset:10240
v_cvt_pk_bf16_f32 v216, v168, v169
v_mfma_f32_16x16x32_bf16 v[152:155], a[156:159], v[60:63], v[88:91]
v_exp_f32 v170, v170
v_mfma_f32_16x16x32_bf16 v[152:155], a[152:155], v[56:59], v[152:155]
s_nop 0
ds_read_b128 a[236:239], v2 offset:11264
ds_read_b128 a[240:243], v2 offset:12288
v_mfma_f32_16x16x32_bf16 v[152:155], a[148:151], v[52:55], v[152:155]
v_exp_f32 v171, v171
v_mfma_f32_16x16x32_bf16 v[152:155], a[144:147], v[48:51], v[152:155]
buffer_load_dwordx4 v1, s[44:47], s72 offen offset:2048 sc1 lds
v_mfma_f32_16x16x32_bf16 v[140:143], a[128:131], v[64:67], v[92:95]
v_exp_f32 v184, v184
v_mfma_f32_16x16x32_bf16 v[140:143], a[132:135], v[68:71], v[140:143]
ds_read_b128 a[244:247], v2 offset:13312
v_cvt_pk_bf16_f32 v217, v170, v171
v_mfma_f32_16x16x32_bf16 v[140:143], a[136:139], v[72:75], v[140:143]
v_exp_f32 v185, v185
v_mfma_f32_16x16x32_bf16 v[140:143], a[140:143], v[76:79], v[140:143]
s_nop 0
ds_read_b128 a[248:251], v2 offset:14336
ds_read_b128 a[252:255], v2 offset:15360
v_mfma_f32_16x16x32_bf16 v[156:159], a[156:159], v[76:79], v[92:95]
v_exp_f32 v186, v186
v_mfma_f32_16x16x32_bf16 v[156:159], a[152:155], v[72:75], v[156:159]
buffer_load_dwordx4 v1, s[44:47], s72 offen offset:3072 sc1 lds
v_mfma_f32_16x16x32_bf16 v[156:159], a[148:151], v[68:71], v[156:159]
s_waitcnt vmcnt(14) lgkmcnt(4)
v_exp_f32 v187, v187
v_mfma_f32_16x16x32_bf16 v[156:159], a[144:147], v[64:67], v[156:159]
s_barrier
v_cvt_pk_bf16_f32 v218, v184, v185
v_cvt_pk_bf16_f32 v219, v186, v187
v_add_u32 v2, s82, v1
v_mfma_f32_16x16x32_bf16 v[236:239], v[120:123], v[204:207], v[236:239]
s_xor_b32 s74, s82, 0x10000
v_exp_f32 v136, v136
v_mfma_f32_16x16x32_bf16 v[236:239], v[120:123], v[220:223], v[236:239]
s_add_u32 s74, s74, s64
ds_read_b128 a[128:131], v2 offset:16384
ds_read_b128 a[132:135], v2 offset:17408
v_mfma_f32_16x16x32_bf16 a[96:99], a[192:195], v[204:207], a[96:99]
s_add_u32 s81, s81, 0x8000
v_exp_f32 v137, v137
v_mfma_f32_16x16x32_bf16 a[96:99], a[224:227], v[220:223], a[96:99]
s_add_u32 m0, s74, 16384
v_exp_f32 v138, v138
v_mfma_f32_16x16x32_bf16 a[100:103], a[228:231], v[220:223], a[100:103]
s_add_u32 s72, s81, 16384
buffer_load_dwordx4 v1, s[44:47], s72 offen sc1 lds
v_mfma_f32_16x16x32_bf16 a[100:103], a[196:199], v[204:207], a[100:103]
ds_read_b128 a[136:139], v2 offset:18432
v_cvt_pk_bf16_f32 v200, v136, v137
v_mfma_f32_16x16x32_bf16 a[104:107], a[200:203], v[204:207], a[104:107]
v_exp_f32 v139, v139
v_mfma_f32_16x16x32_bf16 a[104:107], a[232:235], v[220:223], a[104:107]
ds_read_b128 a[140:143], v2 offset:19456
v_cvt_pk_bf16_f32 v201, v138, v139
v_mfma_f32_16x16x32_bf16 a[108:111], a[236:239], v[220:223], a[108:111]
buffer_store_dwordx4 v[160:163], v1, s[44:47], s70 offen offset:2048 sc1
v_mfma_f32_16x16x32_bf16 a[108:111], a[204:207], v[204:207], a[108:111]
v_exp_f32 v152, v152
v_mfma_f32_16x16x32_bf16 a[112:115], a[208:211], v[204:207], a[112:115]
s_waitcnt lgkmcnt(4)
ds_read_b128 a[144:147], v2 offset:20480
ds_read_b128 a[148:151], v2 offset:21504
v_mfma_f32_16x16x32_bf16 a[112:115], a[240:243], v[220:223], a[112:115]
v_exp_f32 v153, v153
v_mfma_f32_16x16x32_bf16 a[116:119], a[244:247], v[220:223], a[116:119]
buffer_load_dwordx4 v1, s[44:47], s72 offen offset:1024 sc1 lds
v_mfma_f32_16x16x32_bf16 a[116:119], a[212:215], v[204:207], a[116:119]
v_exp_f32 v154, v154
v_mfma_f32_16x16x32_bf16 a[120:123], a[216:219], v[204:207], a[120:123]
ds_read_b128 a[152:155], v2 offset:22528
v_cvt_pk_bf16_f32 v202, v152, v153
v_mfma_f32_16x16x32_bf16 a[120:123], a[248:251], v[220:223], a[120:123]
v_exp_f32 v155, v155
v_mfma_f32_16x16x32_bf16 a[124:127], a[252:255], v[220:223], a[124:127]
ds_read_b128 a[156:159], v2 offset:23552
v_cvt_pk_bf16_f32 v203, v154, v155
v_mfma_f32_16x16x32_bf16 a[124:127], a[220:223], v[204:207], a[124:127]
v_exp_f32 v140, v140
v_mfma_f32_16x16x32_bf16 v[172:175], a[160:163], v[64:67], v[92:95]
s_nop 0
ds_read_b128 a[192:195], v2 offset:0
ds_read_b128 a[196:199], v2 offset:1024
v_mfma_f32_16x16x32_bf16 v[172:175], a[164:167], v[68:71], v[172:175]
buffer_store_dwordx4 v[176:179], v1, s[44:47], s70 offen offset:3072 sc1
v_mfma_f32_16x16x32_bf16 v[172:175], a[168:171], v[72:75], v[172:175]
v_exp_f32 v141, v141
v_mfma_f32_16x16x32_bf16 v[172:175], a[172:175], v[76:79], v[172:175]
v_exp_f32 v142, v142
v_mfma_f32_16x16x32_bf16 v[188:191], a[188:191], v[76:79], v[92:95]
s_nop 0
ds_read_b128 a[200:203], v2 offset:2048
ds_read_b128 a[204:207], v2 offset:3072
v_mfma_f32_16x16x32_bf16 v[188:191], a[184:187], v[72:75], v[188:191]
buffer_load_dwordx4 v1, s[44:47], s72 offen offset:2048 sc1 lds
v_mfma_f32_16x16x32_bf16 v[188:191], a[180:183], v[68:71], v[188:191]
s_add_u32 s70, s70, 0x80000
v_exp_f32 v143, v143
v_mfma_f32_16x16x32_bf16 v[188:191], a[176:179], v[64:67], v[188:191]
v_exp_f32 v156, v156
v_mfma_f32_16x16x32_bf16 v[168:171], a[160:163], v[48:51], v[88:91]
s_nop 0
ds_read_b128 a[208:211], v2 offset:4096
ds_read_b128 a[212:215], v2 offset:5120
v_mfma_f32_16x16x32_bf16 v[168:171], a[164:167], v[52:55], v[168:171]
s_nop 0
ds_read_b128 a[216:219], v2 offset:6144
ds_read_b128 a[220:223], v2 offset:7168
v_mfma_f32_16x16x32_bf16 v[168:171], a[168:171], v[56:59], v[168:171]
v_cvt_pk_bf16_f32 v204, v140, v141
v_cvt_pk_bf16_f32 v205, v142, v143
v_mfma_f32_16x16x32_bf16 v[168:171], a[172:175], v[60:63], v[168:171]
buffer_store_dwordx4 v[132:135], v1, s[44:47], s70 offen sc1
v_mfma_f32_16x16x32_bf16 v[184:187], a[188:191], v[60:63], v[88:91]
v_exp_f32 v157, v157
v_mfma_f32_16x16x32_bf16 v[184:187], a[184:187], v[56:59], v[184:187]
v_exp_f32 v158, v158
v_mfma_f32_16x16x32_bf16 v[184:187], a[180:183], v[52:55], v[184:187]
buffer_load_dwordx4 v1, s[44:47], s72 offen offset:3072 sc1 lds
v_mfma_f32_16x16x32_bf16 v[184:187], a[176:179], v[48:51], v[184:187]
s_waitcnt lgkmcnt(4)
v_exp_f32 v159, v159
v_cvt_pk_bf16_f32 v206, v156, v157
v_cvt_pk_bf16_f32 v207, v158, v159
v_mfma_f32_16x16x32_bf16 v[232:235], v[120:123], v[216:219], v[232:235]
s_add_u32 s82, s82, 0x8000
ds_read_b128 a[160:163], v2 offset:24576
ds_read_b128 a[164:167], v2 offset:25600
v_mfma_f32_16x16x32_bf16 v[232:235], v[120:123], v[200:203], v[232:235]
s_and_b32 s82, s82, 0x1ffff
v_exp_f32 v172, v172
v_mfma_f32_16x16x32_bf16 a[64:67], a[224:227], v[216:219], a[64:67]
s_add_u32 m0, s74, 0
v_exp_f32 v173, v173
v_mfma_f32_16x16x32_bf16 a[64:67], a[192:195], v[200:203], a[64:67]
s_add_u32 s72, s81, 0
buffer_load_dwordx4 v1, s[44:47], s72 offen sc1 lds
v_mfma_f32_16x16x32_bf16 a[68:71], a[196:199], v[200:203], a[68:71]
ds_read_b128 a[168:171], v2 offset:26624
v_cvt_pk_bf16_f32 v220, v172, v173
v_mfma_f32_16x16x32_bf16 a[68:71], a[228:231], v[216:219], a[68:71]
v_exp_f32 v174, v174
v_mfma_f32_16x16x32_bf16 a[72:75], a[232:235], v[216:219], a[72:75]
s_nop 0
ds_read_b128 a[172:175], v2 offset:27648
ds_read_b128 a[176:179], v2 offset:28672
v_mfma_f32_16x16x32_bf16 a[72:75], a[200:203], v[200:203], a[72:75]
v_exp_f32 v175, v175
v_mfma_f32_16x16x32_bf16 a[76:79], a[204:207], v[200:203], a[76:79]
buffer_store_dwordx4 v[148:151], v1, s[44:47], s70 offen offset:1024 sc1
v_mfma_f32_16x16x32_bf16 a[76:79], a[236:239], v[216:219], a[76:79]
v_exp_f32 v188, v188
v_mfma_f32_16x16x32_bf16 a[80:83], a[240:243], v[216:219], a[80:83]
s_waitcnt lgkmcnt(5)
ds_read_b128 a[180:183], v2 offset:29696
v_cvt_pk_bf16_f32 v221, v174, v175
v_mfma_f32_16x16x32_bf16 a[80:83], a[208:211], v[200:203], a[80:83]
v_exp_f32 v189, v189
v_mfma_f32_16x16x32_bf16 a[84:87], a[212:215], v[200:203], a[84:87]
buffer_load_dwordx4 v1, s[44:47], s72 offen offset:1024 sc1 lds
v_mfma_f32_16x16x32_bf16 a[84:87], a[244:247], v[216:219], a[84:87]
ds_read_b128 a[184:187], v2 offset:30720
v_cvt_pk_bf16_f32 v222, v188, v189
v_mfma_f32_16x16x32_bf16 a[88:91], a[248:251], v[216:219], a[88:91]
v_exp_f32 v190, v190
v_mfma_f32_16x16x32_bf16 a[88:91], a[216:219], v[200:203], a[88:91]
s_nop 0
ds_read_b128 a[188:191], v2 offset:31744
ds_read_b128 a[224:227], v2 offset:8192
v_mfma_f32_16x16x32_bf16 a[92:95], a[220:223], v[200:203], a[92:95]
v_exp_f32 v191, v191
v_mfma_f32_16x16x32_bf16 a[92:95], a[252:255], v[216:219], a[92:95]
buffer_store_dwordx4 v[164:167], v1, s[44:47], s70 offen offset:2048 sc1
v_mfma_f32_16x16x32_bf16 v[136:139], a[128:131], v[48:51], v[88:91]
v_exp_f32 v168, v168
v_mfma_f32_16x16x32_bf16 v[136:139], a[132:135], v[52:55], v[136:139]
ds_read_b128 a[228:231], v2 offset:9216
v_cvt_pk_bf16_f32 v223, v190, v191
v_mfma_f32_16x16x32_bf16 v[136:139], a[136:139], v[56:59], v[136:139]
v_exp_f32 v169, v169
v_mfma_f32_16x16x32_bf16 v[136:139], a[140:143], v[60:63], v[136:139]
s_nop 0
ds_read_b128 a[232:235], v2 offset:10240
ds_read_b128 a[236:239], v2 offset:11264
v_mfma_f32_16x16x32_bf16 v[152:155], a[156:159], v[60:63], v[88:91]
v_exp_f32 v170, v170
v_mfma_f32_16x16x32_bf16 v[152:155], a[152:155], v[56:59], v[152:155]
buffer_load_dwordx4 v1, s[44:47], s72 offen offset:2048 sc1 lds
v_mfma_f32_16x16x32_bf16 v[152:155], a[148:151], v[52:55], v[152:155]
v_exp_f32 v171, v171
v_mfma_f32_16x16x32_bf16 v[152:155], a[144:147], v[48:51], v[152:155]
s_nop 0
ds_read_b128 a[240:243], v2 offset:12288
ds_read_b128 a[244:247], v2 offset:13312
v_mfma_f32_16x16x32_bf16 v[140:143], a[128:131], v[64:67], v[92:95]
v_exp_f32 v184, v184
v_mfma_f32_16x16x32_bf16 v[140:143], a[132:135], v[68:71], v[140:143]
s_nop 0
ds_read_b128 a[248:251], v2 offset:14336
ds_read_b128 a[252:255], v2 offset:15360
v_mfma_f32_16x16x32_bf16 v[140:143], a[136:139], v[72:75], v[140:143]
v_cvt_pk_bf16_f32 v216, v168, v169
v_cvt_pk_bf16_f32 v217, v170, v171
v_mfma_f32_16x16x32_bf16 v[140:143], a[140:143], v[76:79], v[140:143]
buffer_store_dwordx4 v[180:183], v1, s[44:47], s70 offen offset:3072 sc1
v_mfma_f32_16x16x32_bf16 v[156:159], a[156:159], v[76:79], v[92:95]
v_exp_f32 v185, v185
v_mfma_f32_16x16x32_bf16 v[156:159], a[152:155], v[72:75], v[156:159]
buffer_load_dwordx4 v1, s[44:47], s72 offen offset:3072 sc1 lds
v_mfma_f32_16x16x32_bf16 v[156:159], a[148:151], v[68:71], v[156:159]
s_waitcnt vmcnt(14) lgkmcnt(4)
v_exp_f32 v186, v186
v_mfma_f32_16x16x32_bf16 v[156:159], a[144:147], v[64:67], v[156:159]
s_barrier
v_exp_f32 v187, v187
v_add_u32 v2, s82, v1
v_cvt_pk_bf16_f32 v218, v184, v185
v_cvt_pk_bf16_f32 v219, v186, v187
s_lshl_b32 s83, s60, 2
s_sub_u32 s83, s83, 25
.p2align 5
s_nop 0
s_nop 0
LloopII:
v_mfma_f32_16x16x32_bf16 v[236:239], v[120:123], v[204:207], v[236:239]
s_xor_b32 s74, s82, 0x10000
v_exp_f32 v136, v136
v_mfma_f32_16x16x32_bf16 v[236:239], v[120:123], v[220:223], v[236:239]
s_add_u32 s74, s74, s64
ds_read_b128 a[128:131], v2 offset:16384
ds_read_b128 a[132:135], v2 offset:17408
v_mfma_f32_16x16x32_bf16 a[96:99], a[192:195], v[204:207], a[96:99]
s_add_u32 s81, s81, 0x8000
v_exp_f32 v137, v137
v_mfma_f32_16x16x32_bf16 a[96:99], a[224:227], v[220:223], a[96:99]
s_add_u32 m0, s74, 16384
v_exp_f32 v138, v138
v_mfma_f32_16x16x32_bf16 a[100:103], a[228:231], v[220:223], a[100:103]
s_add_u32 s72, s81, 16384
ds_read_b128 a[136:139], v2 offset:18432
v_cvt_pk_bf16_f32 v200, v136, v137
v_mfma_f32_16x16x32_bf16 a[100:103], a[196:199], v[204:207], a[100:103]
buffer_load_dwordx4 v1, s[44:47], s72 offen sc1 lds
v_mfma_f32_16x16x32_bf16 a[104:107], a[200:203], v[204:207], a[104:107]
v_exp_f32 v139, v139
v_mfma_f32_16x16x32_bf16 a[104:107], a[232:235], v[220:223], a[104:107]
ds_read_b128 a[140:143], v2 offset:19456
v_cvt_pk_bf16_f32 v201, v138, v139
v_mfma_f32_16x16x32_bf16 a[108:111], a[236:239], v[220:223], a[108:111]
v_exp_f32 v152, v152
v_mfma_f32_16x16x32_bf16 a[108:111], a[204:207], v[204:207], a[108:111]
s_nop 0
ds_read_b128 a[144:147], v2 offset:20480
ds_read_b128 a[148:151], v2 offset:21504
v_mfma_f32_16x16x32_bf16 a[112:115], a[208:211], v[204:207], a[112:115]
s_waitcnt lgkmcnt(6)
v_exp_f32 v153, v153
v_mfma_f32_16x16x32_bf16 a[112:115], a[240:243], v[220:223], a[112:115]
v_exp_f32 v154, v154
v_mfma_f32_16x16x32_bf16 a[116:119], a[244:247], v[220:223], a[116:119]
ds_read_b128 a[152:155], v2 offset:22528
v_cvt_pk_bf16_f32 v202, v152, v153
v_mfma_f32_16x16x32_bf16 a[116:119], a[212:215], v[204:207], a[116:119]
buffer_load_dwordx4 v1, s[44:47], s72 offen offset:1024 sc1 lds
v_mfma_f32_16x16x32_bf16 a[120:123], a[216:219], v[204:207], a[120:123]
v_exp_f32 v155, v155
v_mfma_f32_16x16x32_bf16 a[120:123], a[248:251], v[220:223], a[120:123]
ds_read_b128 a[156:159], v2 offset:23552
v_cvt_pk_bf16_f32 v203, v154, v155
v_mfma_f32_16x16x32_bf16 a[124:127], a[252:255], v[220:223], a[124:127]
v_exp_f32 v140, v140
v_mfma_f32_16x16x32_bf16 a[124:127], a[220:223], v[204:207], a[124:127]
s_nop 0
ds_read_b128 a[192:195], v2 offset:0
ds_read_b128 a[196:199], v2 offset:1024
v_mfma_f32_16x16x32_bf16 v[172:175], a[160:163], v[64:67], v[92:95]
v_exp_f32 v141, v141
v_mfma_f32_16x16x32_bf16 v[172:175], a[164:167], v[68:71], v[172:175]
v_exp_f32 v142, v142
v_mfma_f32_16x16x32_bf16 v[172:175], a[168:171], v[72:75], v[172:175]
ds_read_b128 a[200:203], v2 offset:2048
v_cvt_pk_bf16_f32 v204, v140, v141
v_mfma_f32_16x16x32_bf16 v[172:175], a[172:175], v[76:79], v[172:175]
buffer_load_dwordx4 v1, s[44:47], s72 offen offset:2048 sc1 lds
v_mfma_f32_16x16x32_bf16 v[188:191], a[188:191], v[76:79], v[92:95]
v_exp_f32 v143, v143
v_mfma_f32_16x16x32_bf16 v[188:191], a[184:187], v[72:75], v[188:191]
ds_read_b128 a[204:207], v2 offset:3072
v_cvt_pk_bf16_f32 v205, v142, v143
v_mfma_f32_16x16x32_bf16 v[188:191], a[180:183], v[68:71], v[188:191]
v_exp_f32 v156, v156
v_mfma_f32_16x16x32_bf16 v[188:191], a[176:179], v[64:67], v[188:191]
ds_read_b128 a[208:211], v2 offset:4096
v_mfma_f32_16x16x32_bf16 v[168:171], a[160:163], v[48:51], v[88:91]
v_exp_f32 v157, v157
v_mfma_f32_16x16x32_bf16 v[168:171], a[164:167], v[52:55], v[168:171]
ds_read_b128 a[212:215], v2 offset:5120
v_cvt_pk_bf16_f32 v206, v156, v157
v_mfma_f32_16x16x32_bf16 v[168:171], a[168:171], v[56:59], v[168:171]
v_exp_f32 v158, v158
v_mfma_f32_16x16x32_bf16 v[168:171], a[172:175], v[60:63], v[168:171]
ds_read_b128 a[216:219], v2 offset:6144
v_mfma_f32_16x16x32_bf16 v[184:187], a[188:191], v[60:63], v[88:91]
buffer_load_dwordx4 v1, s[44:47], s72 offen offset:3072 sc1 lds
v_mfma_f32_16x16x32_bf16 v[184:187], a[184:187], v[56:59], v[184:187]
v_exp_f32 v159, v159
v_mfma_f32_16x16x32_bf16 v[184:187], a[180:183], v[52:55], v[184:187]
ds_read_b128 a[220:223], v2 offset:7168
v_cvt_pk_bf16_f32 v207, v158, v159
v_mfma_f32_16x16x32_bf16 v[184:187], a[176:179], v[48:51], v[184:187]
s_waitcnt lgkmcnt(4)
v_mfma_f32_16x16x32_bf16 v[232:235], v[120:123], v[216:219], v[232:235]
s_add_u32 s82, s82, 0x8000
ds_read_b128 a[160:163], v2 offset:24576
ds_read_b128 a[164:167], v2 offset:25600
v_mfma_f32_16x16x32_bf16 v[232:235], v[120:123], v[200:203], v[232:235]
s_and_b32 s82, s82, 0x1ffff
v_exp_f32 v172, v172
v_mfma_f32_16x16x32_bf16 a[64:67], a[224:227], v[216:219], a[64:67]
s_add_u32 m0, s74, 0
v_exp_f32 v173, v173
v_mfma_f32_16x16x32_bf16 a[64:67], a[192:195], v[200:203], a[64:67]
s_add_u32 s72, s81, 0
ds_read_b128 a[168:171], v2 offset:26624
v_cvt_pk_bf16_f32 v220, v172, v173
v_mfma_f32_16x16x32_bf16 a[68:71], a[196:199], v[200:203], a[68:71]
v_exp_f32 v174, v174
v_mfma_f32_16x16x32_bf16 a[68:71], a[228:231], v[216:219], a[68:71]
buffer_load_dwordx4 v1, s[44:47], s72 offen sc1 lds
v_mfma_f32_16x16x32_bf16 a[72:75], a[232:235], v[216:219], a[72:75]
s_nop 0
ds_read_b128 a[172:175], v2 offset:27648
ds_read_b128 a[176:179], v2 offset:28672
v_mfma_f32_16x16x32_bf16 a[72:75], a[200:203], v[200:203], a[72:75]
v_exp_f32 v175, v175
v_mfma_f32_16x16x32_bf16 a[76:79], a[204:207], v[200:203], a[76:79]
v_exp_f32 v188, v188
v_mfma_f32_16x16x32_bf16 a[76:79], a[236:239], v[216:219], a[76:79]
ds_read_b128 a[180:183], v2 offset:29696
v_cvt_pk_bf16_f32 v221, v174, v175
v_mfma_f32_16x16x32_bf16 a[80:83], a[240:243], v[216:219], a[80:83]
s_waitcnt lgkmcnt(6)
v_exp_f32 v189, v189
v_mfma_f32_16x16x32_bf16 a[80:83], a[208:211], v[200:203], a[80:83]
ds_read_b128 a[184:187], v2 offset:30720
v_cvt_pk_bf16_f32 v222, v188, v189
v_mfma_f32_16x16x32_bf16 a[84:87], a[212:215], v[200:203], a[84:87]
buffer_load_dwordx4 v1, s[44:47], s72 offen offset:1024 sc1 lds
v_mfma_f32_16x16x32_bf16 a[84:87], a[244:247], v[216:219], a[84:87]
v_exp_f32 v190, v190
v_mfma_f32_16x16x32_bf16 a[88:91], a[248:251], v[216:219], a[88:91]
s_nop 0
ds_read_b128 a[188:191], v2 offset:31744
ds_read_b128 a[224:227], v2 offset:8192
v_mfma_f32_16x16x32_bf16 a[88:91], a[216:219], v[200:203], a[88:91]
v_exp_f32 v191, v191
v_mfma_f32_16x16x32_bf16 a[92:95], a[220:223], v[200:203], a[92:95]
v_exp_f32 v168, v168
v_mfma_f32_16x16x32_bf16 a[92:95], a[252:255], v[216:219], a[92:95]
ds_read_b128 a[228:231], v2 offset:9216
v_cvt_pk_bf16_f32 v223, v190, v191
v_mfma_f32_16x16x32_bf16 v[136:139], a[128:131], v[48:51], v[88:91]
v_exp_f32 v169, v169
v_mfma_f32_16x16x32_bf16 v[136:139], a[132:135], v[52:55], v[136:139]
ds_read_b128 a[232:235], v2 offset:10240
v_cvt_pk_bf16_f32 v216, v168, v169
v_mfma_f32_16x16x32_bf16 v[136:139], a[136:139], v[56:59], v[136:139]
buffer_load_dwordx4 v1, s[44:47], s72 offen offset:2048 sc1 lds
v_mfma_f32_16x16x32_bf16 v[136:139], a[140:143], v[60:63], v[136:139]
v_exp_f32 v170, v170
v_mfma_f32_16x16x32_bf16 v[152:155], a[156:159], v[60:63], v[88:91]
s_nop 0
ds_read_b128 a[236:239], v2 offset:11264
ds_read_b128 a[240:243], v2 offset:12288
v_mfma_f32_16x16x32_bf16 v[152:155], a[152:155], v[56:59], v[152:155]
v_exp_f32 v171, v171
v_mfma_f32_16x16x32_bf16 v[152:155], a[148:151], v[52:55], v[152:155]
v_exp_f32 v184, v184
v_mfma_f32_16x16x32_bf16 v[152:155], a[144:147], v[48:51], v[152:155]
ds_read_b128 a[244:247], v2 offset:13312
v_cvt_pk_bf16_f32 v217, v170, v171
v_mfma_f32_16x16x32_bf16 v[140:143], a[128:131], v[64:67], v[92:95]
v_exp_f32 v185, v185
v_mfma_f32_16x16x32_bf16 v[140:143], a[132:135], v[68:71], v[140:143]
ds_read_b128 a[248:251], v2 offset:14336
v_cvt_pk_bf16_f32 v218, v184, v185
v_mfma_f32_16x16x32_bf16 v[140:143], a[136:139], v[72:75], v[140:143]
buffer_load_dwordx4 v1, s[44:47], s72 offen offset:3072 sc1 lds
v_mfma_f32_16x16x32_bf16 v[140:143], a[140:143], v[76:79], v[140:143]
ds_read_b128 a[252:255], v2 offset:15360
v_add_u32 v2, s82, v1
v_mfma_f32_16x16x32_bf16 v[156:159], a[156:159], v[76:79], v[92:95]
s_waitcnt vmcnt(8) lgkmcnt(4)
v_exp_f32 v186, v186
v_mfma_f32_16x16x32_bf16 v[156:159], a[152:155], v[72:75], v[156:159]
s_barrier
v_exp_f32 v187, v187
v_mfma_f32_16x16x32_bf16 v[156:159], a[148:151], v[68:71], v[156:159]
s_add_u32 s83, s83, 1
v_cvt_pk_bf16_f32 v219, v186, v187
v_mfma_f32_16x16x32_bf16 v[156:159], a[144:147], v[64:67], v[156:159]
s_cbranch_scc0 LloopII
v_mfma_f32_16x16x32_bf16 v[236:239], v[120:123], v[204:207], v[236:239]
s_xor_b32 s74, s82, 0x10000
ds_read_b128 a[128:131], v2 offset:16384
ds_read_b128 a[132:135], v2 offset:17408
v_mfma_f32_16x16x32_bf16 v[236:239], v[120:123], v[220:223], v[236:239]
s_add_u32 s74, s74, s64
v_exp_f32 v136, v136
v_mfma_f32_16x16x32_bf16 a[96:99], a[192:195], v[204:207], a[96:99]
s_add_u32 s81, s81, 0x8000
v_exp_f32 v137, v137
v_mfma_f32_16x16x32_bf16 a[96:99], a[224:227], v[220:223], a[96:99]
s_add_u32 m0, s74, 0
ds_read_b128 a[136:139], v2 offset:18432
v_cvt_pk_bf16_f32 v200, v136, v137
v_mfma_f32_16x16x32_bf16 a[100:103], a[228:231], v[220:223], a[100:103]
s_add_u32 s72, s81, 0
v_exp_f32 v138, v138
v_mfma_f32_16x16x32_bf16 a[100:103], a[196:199], v[204:207], a[100:103]
buffer_load_dwordx4 v1, s[44:47], s72 offen sc1 lds
v_mfma_f32_16x16x32_bf16 a[104:107], a[200:203], v[204:207], a[104:107]
s_nop 0
ds_read_b128 a[140:143], v2 offset:19456
ds_read_b128 a[144:147], v2 offset:20480
v_mfma_f32_16x16x32_bf16 a[104:107], a[232:235], v[220:223], a[104:107]
v_exp_f32 v139, v139
v_mfma_f32_16x16x32_bf16 a[108:111], a[236:239], v[220:223], a[108:111]
v_exp_f32 v152, v152
v_mfma_f32_16x16x32_bf16 a[108:111], a[204:207], v[204:207], a[108:111]
ds_read_b128 a[148:151], v2 offset:21504
v_cvt_pk_bf16_f32 v201, v138, v139
v_mfma_f32_16x16x32_bf16 a[112:115], a[208:211], v[204:207], a[112:115]
s_waitcnt lgkmcnt(6)
v_exp_f32 v153, v153
v_mfma_f32_16x16x32_bf16 a[112:115], a[240:243], v[220:223], a[112:115]
ds_read_b128 a[152:155], v2 offset:22528
v_cvt_pk_bf16_f32 v202, v152, v153
v_mfma_f32_16x16x32_bf16 a[116:119], a[244:247], v[220:223], a[116:119]
v_exp_f32 v154, v154
v_mfma_f32_16x16x32_bf16 a[116:119], a[212:215], v[204:207], a[116:119]
buffer_load_dwordx4 v1, s[44:47], s72 offen offset:1024 sc1 lds
v_mfma_f32_16x16x32_bf16 a[120:123], a[216:219], v[204:207], a[120:123]
s_nop 0
ds_read_b128 a[156:159], v2 offset:23552
ds_read_b128 a[192:195], v2 offset:0
v_mfma_f32_16x16x32_bf16 a[120:123], a[248:251], v[220:223], a[120:123]
v_exp_f32 v155, v155
v_mfma_f32_16x16x32_bf16 a[124:127], a[252:255], v[220:223], a[124:127]
v_exp_f32 v140, v140
v_mfma_f32_16x16x32_bf16 a[124:127], a[220:223], v[204:207], a[124:127]
ds_read_b128 a[196:199], v2 offset:1024
v_cvt_pk_bf16_f32 v203, v154, v155
v_mfma_f32_16x16x32_bf16 v[172:175], a[160:163], v[64:67], v[92:95]
v_exp_f32 v141, v141
v_mfma_f32_16x16x32_bf16 v[172:175], a[164:167], v[68:71], v[172:175]
ds_read_b128 a[200:203], v2 offset:2048
v_cvt_pk_bf16_f32 v204, v140, v141
v_mfma_f32_16x16x32_bf16 v[172:175], a[168:171], v[72:75], v[172:175]
v_exp_f32 v142, v142
v_mfma_f32_16x16x32_bf16 v[172:175], a[172:175], v[76:79], v[172:175]
buffer_load_dwordx4 v1, s[44:47], s72 offen offset:2048 sc1 lds
v_mfma_f32_16x16x32_bf16 v[188:191], a[188:191], v[76:79], v[92:95]
ds_read_b128 a[204:207], v2 offset:3072
v_mfma_f32_16x16x32_bf16 v[188:191], a[184:187], v[72:75], v[188:191]
v_exp_f32 v143, v143
v_mfma_f32_16x16x32_bf16 v[188:191], a[180:183], v[68:71], v[188:191]
ds_read_b128 a[208:211], v2 offset:4096
v_cvt_pk_bf16_f32 v205, v142, v143
v_mfma_f32_16x16x32_bf16 v[188:191], a[176:179], v[64:67], v[188:191]
Lstub6:
s_cbranch_execz Lstub10
v_exp_f32 v156, v156
v_mfma_f32_16x16x32_bf16 v[168:171], a[160:163], v[48:51], v[88:91]
ds_read_b128 a[212:215], v2 offset:5120
v_mfma_f32_16x16x32_bf16 v[168:171], a[164:167], v[52:55], v[168:171]
v_exp_f32 v157, v157
v_mfma_f32_16x16x32_bf16 v[168:171], a[168:171], v[56:59], v[168:171]
ds_read_b128 a[216:219], v2 offset:6144
v_cvt_pk_bf16_f32 v206, v156, v157
v_mfma_f32_16x16x32_bf16 v[168:171], a[172:175], v[60:63], v[168:171]
buffer_load_dwordx4 v1, s[44:47], s72 offen offset:3072 sc1 lds
v_mfma_f32_16x16x32_bf16 v[184:187], a[188:191], v[60:63], v[88:91]
v_exp_f32 v158, v158
v_mfma_f32_16x16x32_bf16 v[184:187], a[184:187], v[56:59], v[184:187]
ds_read_b128 a[220:223], v2 offset:7168
v_mfma_f32_16x16x32_bf16 v[184:187], a[180:183], v[52:55], v[184:187]
s_waitcnt lgkmcnt(4)
v_exp_f32 v159, v159
v_mfma_f32_16x16x32_bf16 v[184:187], a[176:179], v[48:51], v[184:187]
s_barrier
v_cvt_pk_bf16_f32 v207, v158, v159
s_lshr_b32 s69, s93, 4
s_and_b32 s69, s69, 0x7f00
s_add_u32 s69, s69, LHT4-Lpc0
v_lshrrev_b32 v3, 5, v0
v_lshlrev_b32 v3, 7, v3
v_add_u32 v3, s69, v3
v_min_u32 v3, Lcode_end-Lpc0, v3
global_load_dword v4, v3, s[98:99]
v_mfma_f32_16x16x32_bf16 v[232:235], v[120:123], v[216:219], v[232:235]
s_add_u32 s82, s82, 0x8000
ds_read_b128 a[160:163], v2 offset:24576
ds_read_b128 a[164:167], v2 offset:25600
v_mfma_f32_16x16x32_bf16 v[232:235], v[120:123], v[200:203], v[232:235]
s_and_b32 s82, s82, 0x1ffff
v_exp_f32 v172, v172
v_mfma_f32_16x16x32_bf16 a[64:67], a[224:227], v[216:219], a[64:67]
s_add_u32 s66, s58, 3
v_exp_f32 v173, v173
v_mfma_f32_16x16x32_bf16 a[64:67], a[192:195], v[200:203], a[64:67]
s_and_b32 s66, s66, 3
ds_read_b128 a[168:171], v2 offset:26624
v_cvt_pk_bf16_f32 v220, v172, v173
v_mfma_f32_16x16x32_bf16 a[68:71], a[196:199], v[200:203], a[68:71]
s_mul_i32 s66, s66, 4160
v_exp_f32 v174, v174
v_mfma_f32_16x16x32_bf16 a[68:71], a[228:231], v[216:219], a[68:71]
s_add_u32 s66, s66, s92
ds_read_b128 a[172:175], v2 offset:27648
ds_read_b128 a[176:179], v2 offset:28672
v_mfma_f32_16x16x32_bf16 a[72:75], a[232:235], v[216:219], a[72:75]
s_add_u32 m0, s66, 32
v_exp_f32 v175, v175
v_mfma_f32_16x16x32_bf16 a[72:75], a[200:203], v[200:203], a[72:75]
s_add_u32 s72, s93, 0x6
buffer_load_dwordx4 v1, s[36:39], s72 offen lds
v_mfma_f32_16x16x32_bf16 a[76:79], a[204:207], v[200:203], a[76:79]
v_exp_f32 v188, v188
v_mfma_f32_16x16x32_bf16 a[76:79], a[236:239], v[216:219], a[76:79]
ds_read_b128 a[180:183], v2 offset:29696
v_cvt_pk_bf16_f32 v221, v174, v175
v_mfma_f32_16x16x32_bf16 a[80:83], a[240:243], v[216:219], a[80:83]
s_waitcnt lgkmcnt(6)
v_exp_f32 v189, v189
v_mfma_f32_16x16x32_bf16 a[80:83], a[208:211], v[200:203], a[80:83]
ds_read_b128 a[184:187], v2 offset:30720
v_cvt_pk_bf16_f32 v222, v188, v189
v_mfma_f32_16x16x32_bf16 a[84:87], a[212:215], v[200:203], a[84:87]
v_exp_f32 v190, v190
v_mfma_f32_16x16x32_bf16 a[84:87], a[244:247], v[216:219], a[84:87]
buffer_load_dwordx4 v1, s[36:39], s72 offen offset:1024 lds
v_mfma_f32_16x16x32_bf16 a[88:91], a[248:251], v[216:219], a[88:91]
s_nop 0
ds_read_b128 a[188:191], v2 offset:31744
ds_read_b128 a[224:227], v2 offset:8192
v_mfma_f32_16x16x32_bf16 a[88:91], a[216:219], v[200:203], a[88:91]
v_exp_f32 v191, v191
v_mfma_f32_16x16x32_bf16 a[92:95], a[220:223], v[200:203], a[92:95]
v_exp_f32 v168, v168
v_mfma_f32_16x16x32_bf16 a[92:95], a[252:255], v[216:219], a[92:95]
ds_read_b128 a[228:231], v2 offset:9216
v_cvt_pk_bf16_f32 v223, v190, v191
s_cmp_eq_u32 s58, 0
s_cbranch_scc1 Lta28
s_cmp_eq_u32 s58, 1
s_cbranch_scc1 Lnt29
v_mfma_f32_16x16x32_bf16 v[136:139], a[128:131], v[48:51], v[88:91]
v_exp_f32 v169, v169
v_mfma_f32_16x16x32_bf16 v[152:155], a[144:147], v[48:51], v[88:91]
ds_read_b128 a[232:235], v2 offset:10240
v_cvt_pk_bf16_f32 v216, v168, v169
s_branch Ljoin30
Lta28:
v_mfma_f32_16x16x32_bf16 v[136:139], a[128:131], v[48:51], v[104:107]
v_exp_f32 v169, v169
v_mfma_f32_16x16x32_bf16 v[152:155], a[144:147], v[48:51], v[112:115]
ds_read_b128 a[232:235], v2 offset:10240
v_cvt_pk_bf16_f32 v216, v168, v169
s_branch Ljoin30
Lnt29:
v_mfma_f32_16x16x32_bf16 v[136:139], a[128:131], v[48:51], v[88:91]
v_exp_f32 v169, v169
v_mfma_f32_16x16x32_bf16 v[152:155], a[144:147], v[48:51], v[104:107]
ds_read_b128 a[232:235], v2 offset:10240
v_cvt_pk_bf16_f32 v216, v168, v169
Ljoin30:
v_mfma_f32_16x16x32_bf16 v[136:139], a[132:135], v[52:55], v[136:139]
v_exp_f32 v170, v170
v_mfma_f32_16x16x32_bf16 v[136:139], a[136:139], v[56:59], v[136:139]
buffer_load_dwordx4 v1, s[36:39], s72 offen offset:2048 lds
v_mfma_f32_16x16x32_bf16 v[136:139], a[140:143], v[60:63], v[136:139]
ds_read_b128 a[236:239], v2 offset:11264
v_mfma_f32_16x16x32_bf16 v[152:155], a[156:159], v[60:63], v[152:155]
v_exp_f32 v171, v171
v_mfma_f32_16x16x32_bf16 v[152:155], a[152:155], v[56:59], v[152:155]
ds_read_b128 a[240:243], v2 offset:12288
v_cvt_pk_bf16_f32 v217, v170, v171
v_mfma_f32_16x16x32_bf16 v[152:155], a[148:151], v[52:55], v[152:155]
v_exp_f32 v184, v184
v_mfma_f32_16x16x32_bf16 v[140:143], a[128:131], v[64:67], v[92:95]
ds_read_b128 a[244:247], v2 offset:13312
v_mfma_f32_16x16x32_bf16 v[140:143], a[132:135], v[68:71], v[140:143]
v_exp_f32 v185, v185
v_mfma_f32_16x16x32_bf16 v[140:143], a[136:139], v[72:75], v[140:143]
ds_read_b128 a[248:251], v2 offset:14336
v_cvt_pk_bf16_f32 v218, v184, v185
v_mfma_f32_16x16x32_bf16 v[140:143], a[140:143], v[76:79], v[140:143]
buffer_load_dwordx4 v1, s[36:39], s72 offen offset:3072 lds
v_mfma_f32_16x16x32_bf16 v[156:159], a[156:159], v[76:79], v[92:95]
v_exp_f32 v186, v186
v_mfma_f32_16x16x32_bf16 v[156:159], a[152:155], v[72:75], v[156:159]
ds_read_b128 a[252:255], v2 offset:15360
v_add_u32 v2, s82, v1
v_mfma_f32_16x16x32_bf16 v[156:159], a[148:151], v[68:71], v[156:159]
s_waitcnt vmcnt(9) lgkmcnt(0)
v_exp_f32 v187, v187
v_mfma_f32_16x16x32_bf16 v[156:159], a[144:147], v[64:67], v[156:159]
s_barrier
v_cvt_pk_bf16_f32 v219, v186, v187
v_mfma_f32_16x16x32_bf16 v[236:239], v[120:123], v[204:207], v[236:239]
s_mov_b32 m0, s62
v_exp_f32 v136, v136
v_mfma_f32_16x16x32_bf16 v[236:239], v[120:123], v[220:223], v[236:239]
s_add_u32 s72, s93, 0x3000000
ds_read_b128 a[128:131], v2 offset:16384
ds_read_b128 a[132:135], v2 offset:17408
v_mfma_f32_16x16x32_bf16 a[96:99], a[192:195], v[204:207], a[96:99]
s_add_u32 s78, s59, 4
v_exp_f32 v137, v137
v_mfma_f32_16x16x32_bf16 a[96:99], a[224:227], v[220:223], a[96:99]
s_and_b32 s78, s78, 12
buffer_load_dwordx4 v1, s[44:47], s72 offen sc1 lds
v_mfma_f32_16x16x32_bf16 a[100:103], a[228:231], v[220:223], a[100:103]
s_and_b32 s12, s59, 16
v_exp_f32 v138, v138
v_mfma_f32_16x16x32_bf16 a[100:103], a[196:199], v[204:207], a[100:103]
s_or_b32 s78, s78, s12
ds_read_b128 a[136:139], v2 offset:18432
v_cvt_pk_bf16_f32 v200, v136, v137
v_mfma_f32_16x16x32_bf16 a[104:107], a[200:203], v[204:207], a[104:107]
s_add_u32 s12, s61, 0
v_exp_f32 v139, v139
v_mfma_f32_16x16x32_bf16 a[104:107], a[232:235], v[220:223], a[104:107]
s_and_b32 s12, s12, 3
ds_read_b128 a[140:143], v2 offset:19456
v_cvt_pk_bf16_f32 v201, v138, v139
v_mfma_f32_16x16x32_bf16 a[108:111], a[236:239], v[220:223], a[108:111]
s_add_u32 s12, s12, s78
v_exp_f32 v152, v152
v_mfma_f32_16x16x32_bf16 a[108:111], a[204:207], v[204:207], a[108:111]
s_lshl_b32 s12, s12, 18
ds_read_b128 a[144:147], v2 offset:20480
ds_read_b128 a[148:151], v2 offset:21504
v_mfma_f32_16x16x32_bf16 a[112:115], a[208:211], v[204:207], a[112:115]
s_waitcnt lgkmcnt(6)
buffer_load_dwordx4 v1, s[44:47], s72 offen offset:1024 sc1 lds
v_mfma_f32_16x16x32_bf16 a[112:115], a[240:243], v[220:223], a[112:115]
s_add_u32 s12, s12, s94
v_exp_f32 v153, v153
v_mfma_f32_16x16x32_bf16 a[116:119], a[244:247], v[220:223], a[116:119]
s_add_u32 s13, s61, 1
v_exp_f32 v154, v154
v_mfma_f32_16x16x32_bf16 a[116:119], a[212:215], v[204:207], a[116:119]
s_and_b32 s13, s13, 3
ds_read_b128 a[152:155], v2 offset:22528
v_cvt_pk_bf16_f32 v202, v152, v153
v_mfma_f32_16x16x32_bf16 a[120:123], a[216:219], v[204:207], a[120:123]
s_add_u32 s13, s13, s78
buffer_load_dwordx4 v1, s[44:47], s72 offen offset:2048 sc1 lds
v_mfma_f32_16x16x32_bf16 a[120:123], a[248:251], v[220:223], a[120:123]
s_lshl_b32 s13, s13, 18
v_exp_f32 v155, v155
v_mfma_f32_16x16x32_bf16 a[124:127], a[252:255], v[220:223], a[124:127]
s_add_u32 s13, s13, s94
ds_read_b128 a[156:159], v2 offset:23552
v_cvt_pk_bf16_f32 v203, v154, v155
v_mfma_f32_16x16x32_bf16 a[124:127], a[220:223], v[204:207], a[124:127]
s_add_u32 s14, s61, 2
v_exp_f32 v140, v140
s_cmp_eq_u32 s58, 2
s_cbranch_scc1 Lta31
s_cmp_eq_u32 s58, 3
s_cbranch_scc1 Lnt32
v_mfma_f32_16x16x32_bf16 v[168:171], a[160:163], v[48:51], v[112:115]
s_and_b32 s14, s14, 3
ds_read_b128 a[192:195], v2 offset:0
ds_read_b128 a[196:199], v2 offset:1024
v_mfma_f32_16x16x32_bf16 v[184:187], a[176:179], v[48:51], v[112:115]
s_add_u32 s14, s14, s78
v_exp_f32 v141, v141
s_branch Ljoin33
Lta31:
v_mfma_f32_16x16x32_bf16 v[168:171], a[160:163], v[48:51], v[104:107]
s_and_b32 s14, s14, 3
ds_read_b128 a[192:195], v2 offset:0
ds_read_b128 a[196:199], v2 offset:1024
v_mfma_f32_16x16x32_bf16 v[184:187], a[176:179], v[48:51], v[112:115]
s_add_u32 s14, s14, s78
v_exp_f32 v141, v141
s_branch Ljoin33
Lnt32:
v_mfma_f32_16x16x32_bf16 v[168:171], a[160:163], v[48:51], v[88:91]
s_and_b32 s14, s14, 3
ds_read_b128 a[192:195], v2 offset:0
ds_read_b128 a[196:199], v2 offset:1024
v_mfma_f32_16x16x32_bf16 v[184:187], a[176:179], v[48:51], v[104:107]
s_add_u32 s14, s14, s78
v_exp_f32 v141, v141
Ljoin33:
v_mfma_f32_16x16x32_bf16 v[172:175], a[160:163], v[64:67], v[92:95]
s_lshl_b32 s14, s14, 18
buffer_load_dwordx4 v1, s[44:47], s72 offen offset:3072 sc1 lds
v_mfma_f32_16x16x32_bf16 v[172:175], a[164:167], v[68:71], v[172:175]
s_add_u32 s66, s58, 0
v_exp_f32 v142, v142
v_mfma_f32_16x16x32_bf16 v[172:175], a[168:171], v[72:75], v[172:175]
s_and_b32 s66, s66, 3
ds_read_b128 a[200:203], v2 offset:2048
v_cvt_pk_bf16_f32 v204, v140, v141
v_mfma_f32_16x16x32_bf16 v[172:175], a[172:175], v[76:79], v[172:175]
s_mul_i32 s66, s66, 4160
v_exp_f32 v143, v143
v_mfma_f32_16x16x32_bf16 v[188:191], a[188:191], v[76:79], v[92:95]
s_add_u32 s66, s66, s92
ds_read_b128 a[204:207], v2 offset:3072
v_cvt_pk_bf16_f32 v205, v142, v143
v_mfma_f32_16x16x32_bf16 v[188:191], a[184:187], v[72:75], v[188:191]
s_add_u32 m0, s66, 16672
v_exp_f32 v156, v156
v_mfma_f32_16x16x32_bf16 v[188:191], a[180:183], v[68:71], v[188:191]
s_add_u32 s72, s93, 0x0
ds_read_b128 a[208:211], v2 offset:4096
ds_read_b128 a[212:215], v2 offset:5120
v_mfma_f32_16x16x32_bf16 v[188:191], a[176:179], v[64:67], v[188:191]
s_add_u32 s14, s14, s94
buffer_load_dwordx4 v1, s[36:39], s72 offen lds
v_mfma_f32_16x16x32_bf16 v[168:171], a[164:167], v[52:55], v[168:171]
s_add_u32 s15, s61, 3
v_exp_f32 v157, v157
v_mfma_f32_16x16x32_bf16 v[168:171], a[168:171], v[56:59], v[168:171]
s_and_b32 s15, s15, 3
v_exp_f32 v158, v158
v_mfma_f32_16x16x32_bf16 v[168:171], a[172:175], v[60:63], v[168:171]
s_add_u32 s15, s15, s78
ds_read_b128 a[216:219], v2 offset:6144
ds_read_b128 a[220:223], v2 offset:7168
v_mfma_f32_16x16x32_bf16 v[184:187], a[188:191], v[60:63], v[184:187]
s_lshl_b32 s15, s15, 18
buffer_load_dwordx4 v1, s[36:39], s72 offen offset:1024 lds
v_mfma_f32_16x16x32_bf16 v[184:187], a[184:187], v[56:59], v[184:187]
s_add_u32 s15, s15, s94
v_exp_f32 v159, v159
v_mfma_f32_16x16x32_bf16 v[184:187], a[180:183], v[52:55], v[184:187]
s_waitcnt lgkmcnt(4)
v_cvt_pk_bf16_f32 v206, v156, v157
v_cvt_pk_bf16_f32 v207, v158, v159
v_mfma_f32_16x16x32_bf16 v[232:235], v[120:123], v[216:219], v[232:235]
s_add_u32 s82, s82, 0x8000
ds_read_b128 a[160:163], v2 offset:24576
ds_read_b128 a[164:167], v2 offset:25600
v_mfma_f32_16x16x32_bf16 v[232:235], v[120:123], v[200:203], v[232:235]
s_and_b32 s82, s82, 0x1ffff
v_exp_f32 v172, v172
v_mfma_f32_16x16x32_bf16 a[64:67], a[224:227], v[216:219], a[64:67]
v_exp_f32 v173, v173
v_mfma_f32_16x16x32_bf16 a[64:67], a[192:195], v[200:203], a[64:67]
s_nop 0
ds_read_b128 a[168:171], v2 offset:26624
ds_read_b128 a[172:175], v2 offset:27648
v_mfma_f32_16x16x32_bf16 a[68:71], a[196:199], v[200:203], a[68:71]
v_exp_f32 v174, v174
v_mfma_f32_16x16x32_bf16 a[68:71], a[228:231], v[216:219], a[68:71]
v_exp_f32 v175, v175
v_mfma_f32_16x16x32_bf16 a[72:75], a[232:235], v[216:219], a[72:75]
s_nop 0
ds_read_b128 a[176:179], v2 offset:28672
ds_read_b128 a[180:183], v2 offset:29696
v_mfma_f32_16x16x32_bf16 a[72:75], a[200:203], v[200:203], a[72:75]
v_exp_f32 v188, v188
v_mfma_f32_16x16x32_bf16 a[76:79], a[204:207], v[200:203], a[76:79]
s_nop 0
ds_read_b128 a[184:187], v2 offset:30720
ds_read_b128 a[188:191], v2 offset:31744
v_mfma_f32_16x16x32_bf16 a[76:79], a[236:239], v[216:219], a[76:79]
s_nop 0
ds_read_b128 a[224:227], v2 offset:8192
ds_read_b128 a[228:231], v2 offset:9216
v_mfma_f32_16x16x32_bf16 a[80:83], a[240:243], v[216:219], a[80:83]
s_waitcnt lgkmcnt(10)
ds_read_b128 a[232:235], v2 offset:10240
ds_read_b128 a[236:239], v2 offset:11264
v_mfma_f32_16x16x32_bf16 a[80:83], a[208:211], v[200:203], a[80:83]
ds_read_b128 a[240:243], v2 offset:12288
v_cvt_pk_bf16_f32 v220, v172, v173
v_mfma_f32_16x16x32_bf16 a[84:87], a[212:215], v[200:203], a[84:87]
buffer_load_dwordx4 v1, s[36:39], s72 offen offset:2048 lds
v_mfma_f32_16x16x32_bf16 a[84:87], a[244:247], v[216:219], a[84:87]
v_exp_f32 v189, v189
v_mfma_f32_16x16x32_bf16 a[88:91], a[248:251], v[216:219], a[88:91]
v_exp_f32 v190, v190
v_mfma_f32_16x16x32_bf16 a[88:91], a[216:219], v[200:203], a[88:91]
s_nop 0
ds_read_b128 a[244:247], v2 offset:13312
ds_read_b128 a[248:251], v2 offset:14336
v_mfma_f32_16x16x32_bf16 a[92:95], a[220:223], v[200:203], a[92:95]
v_cvt_pk_bf16_f32 v221, v174, v175
v_cvt_pk_bf16_f32 v222, v188, v189
v_mfma_f32_16x16x32_bf16 a[92:95], a[252:255], v[216:219], a[92:95]
v_exp_f32 v191, v191
s_cmp_eq_u32 s58, 0
s_cbranch_scc1 Lta34
s_cmp_eq_u32 s58, 1
s_cbranch_scc1 Lnt35
v_mfma_f32_16x16x32_bf16 v[140:143], a[128:131], v[64:67], v[92:95]
v_exp_f32 v168, v168
v_mfma_f32_16x16x32_bf16 v[156:159], a[144:147], v[64:67], v[92:95]
v_exp_f32 v169, v169
s_branch Ljoin36
Lta34:
v_mfma_f32_16x16x32_bf16 v[140:143], a[128:131], v[64:67], v[108:111]
v_exp_f32 v168, v168
v_mfma_f32_16x16x32_bf16 v[156:159], a[144:147], v[64:67], v[112:115]
v_exp_f32 v169, v169
s_branch Ljoin36
Lnt35:
v_mfma_f32_16x16x32_bf16 v[140:143], a[128:131], v[64:67], v[92:95]
v_exp_f32 v168, v168
v_mfma_f32_16x16x32_bf16 v[156:159], a[144:147], v[64:67], v[108:111]
v_exp_f32 v169, v169
Ljoin36:
v_mfma_f32_16x16x32_bf16 v[140:143], a[132:135], v[68:71], v[140:143]
v_exp_f32 v170, v170
v_mfma_f32_16x16x32_bf16 v[140:143], a[136:139], v[72:75], v[140:143]
ds_read_b128 a[252:255], v2 offset:15360
v_cvt_pk_bf16_f32 v223, v190, v191
v_mfma_f32_16x16x32_bf16 v[140:143], a[140:143], v[76:79], v[140:143]
v_exp_f32 v171, v171
v_mfma_f32_16x16x32_bf16 v[156:159], a[156:159], v[76:79], v[156:159]
buffer_load_dwordx4 v1, s[36:39], s72 offen offset:3072 lds
v_mfma_f32_16x16x32_bf16 v[156:159], a[152:155], v[72:75], v[156:159]
s_waitcnt vmcnt(13) lgkmcnt(4)
v_exp_f32 v184, v184
v_mfma_f32_16x16x32_bf16 v[156:159], a[148:151], v[68:71], v[156:159]
s_barrier
v_cvt_pk_bf16_f32 v216, v168, v169
v_cvt_pk_bf16_f32 v217, v170, v171
v_add_u32 v2, s82, v1
v_exp_f32 v185, v185
v_exp_f32 v186, v186
v_cvt_pk_bf16_f32 v218, v184, v185
v_exp_f32 v187, v187
s_nop 0
v_cvt_pk_bf16_f32 v219, v186, v187
v_mfma_f32_16x16x32_bf16 v[236:239], v[120:123], v[204:207], v[236:239]
s_add_u32 s66, s58, 2
v_exp_f32 v140, v140
v_mfma_f32_16x16x32_bf16 v[236:239], v[120:123], v[220:223], v[236:239]
s_and_b32 s66, s66, 3
v_exp_f32 v141, v141
v_mfma_f32_16x16x32_bf16 a[96:99], a[192:195], v[204:207], a[96:99]
s_mul_i32 s66, s66, 4160
ds_read_b128 a[192:195], v2 offset:0
v_mfma_f32_16x16x32_bf16 a[96:99], a[224:227], v[220:223], a[96:99]
s_add_u32 s66, s66, s92
v_exp_f32 v142, v142
v_mfma_f32_16x16x32_bf16 a[100:103], a[228:231], v[220:223], a[100:103]
s_add_u32 m0, s66, 33312
v_exp_f32 v143, v143
v_mfma_f32_16x16x32_bf16 a[100:103], a[196:199], v[204:207], a[100:103]
s_add_u32 s72, s93, 0x4
buffer_load_dwordx4 v1, s[36:39], s72 offen lds
v_mfma_f32_16x16x32_bf16 a[104:107], a[200:203], v[204:207], a[104:107]
ds_read_b128 a[196:199], v2 offset:1024
v_mfma_f32_16x16x32_bf16 a[104:107], a[232:235], v[220:223], a[104:107]
buffer_load_dwordx4 v1, s[36:39], s72 offen offset:1024 lds
v_mfma_f32_16x16x32_bf16 a[108:111], a[236:239], v[220:223], a[108:111]
ds_read_b128 a[200:203], v2 offset:2048
v_mfma_f32_16x16x32_bf16 a[108:111], a[204:207], v[204:207], a[108:111]
buffer_load_dwordx4 v1, s[36:39], s72 offen offset:2048 lds
v_mfma_f32_16x16x32_bf16 a[112:115], a[208:211], v[204:207], a[112:115]
s_waitcnt lgkmcnt(3)
ds_read_b128 a[204:207], v2 offset:3072
v_mfma_f32_16x16x32_bf16 a[112:115], a[240:243], v[220:223], a[112:115]
buffer_load_dwordx4 v1, s[36:39], s72 offen offset:3072 lds
v_mfma_f32_16x16x32_bf16 a[116:119], a[244:247], v[220:223], a[116:119]
v_exp_f32 v156, v156
v_mfma_f32_16x16x32_bf16 a[116:119], a[212:215], v[204:207], a[116:119]
ds_read_b128 a[208:211], v2 offset:4096
v_mfma_f32_16x16x32_bf16 a[120:123], a[216:219], v[204:207], a[120:123]
buffer_load_dwordx4 v[80:83], v15, s[4:7], s80 offen
v_mfma_f32_16x16x32_bf16 a[120:123], a[248:251], v[220:223], a[120:123]
s_add_u32 s80, s80, 0x4000
v_exp_f32 v157, v157
v_mfma_f32_16x16x32_bf16 a[124:127], a[252:255], v[220:223], a[124:127]
ds_read_b128 a[212:215], v2 offset:5120
v_mfma_f32_16x16x32_bf16 a[124:127], a[220:223], v[204:207], a[124:127]
ds_read_b128 a[216:219], v2 offset:6144
v_cvt_pk_bf16_f32 v204, v140, v141
s_cmp_eq_u32 s58, 2
s_cbranch_scc1 Lta37
s_cmp_eq_u32 s58, 3
s_cbranch_scc1 Lnt38
v_mfma_f32_16x16x32_bf16 v[172:175], a[160:163], v[64:67], v[112:115]
buffer_load_dwordx4 v[84:87], v15, s[4:7], s80 offen
v_mfma_f32_16x16x32_bf16 v[188:191], a[176:179], v[64:67], v[112:115]
s_add_u32 s80, s80, 0x4000
v_exp_f32 v158, v158
s_branch Ljoin39
Lta37:
v_mfma_f32_16x16x32_bf16 v[172:175], a[160:163], v[64:67], v[108:111]
buffer_load_dwordx4 v[84:87], v15, s[4:7], s80 offen
v_mfma_f32_16x16x32_bf16 v[188:191], a[176:179], v[64:67], v[112:115]
s_add_u32 s80, s80, 0x4000
v_exp_f32 v158, v158
s_branch Ljoin39
Lnt38:
v_mfma_f32_16x16x32_bf16 v[172:175], a[160:163], v[64:67], v[92:95]
buffer_load_dwordx4 v[84:87], v15, s[4:7], s80 offen
v_mfma_f32_16x16x32_bf16 v[188:191], a[176:179], v[64:67], v[108:111]
s_add_u32 s80, s80, 0x4000
v_exp_f32 v158, v158
Ljoin39:
v_mfma_f32_16x16x32_bf16 v[172:175], a[164:167], v[68:71], v[172:175]
ds_read_b128 a[220:223], v2 offset:7168
v_cvt_pk_bf16_f32 v205, v142, v143
v_mfma_f32_16x16x32_bf16 v[172:175], a[168:171], v[72:75], v[172:175]
buffer_load_dwordx4 v[96:99], v15, s[4:7], s80 offen
v_mfma_f32_16x16x32_bf16 v[172:175], a[172:175], v[76:79], v[172:175]
s_add_u32 s80, s80, 0x4000
v_exp_f32 v159, v159
v_mfma_f32_16x16x32_bf16 v[188:191], a[188:191], v[76:79], v[188:191]
buffer_load_dwordx4 v[100:103], v15, s[4:7], s80 offen
v_mfma_f32_16x16x32_bf16 v[188:191], a[184:187], v[72:75], v[188:191]
v_cvt_pk_bf16_f32 v206, v156, v157
v_cvt_pk_bf16_f32 v207, v158, v159
v_mfma_f32_16x16x32_bf16 v[188:191], a[180:183], v[68:71], v[188:191]
s_waitcnt lgkmcnt(4)
v_mfma_f32_16x16x32_bf16 v[232:235], v[120:123], v[216:219], v[232:235]
s_add_u32 s82, s82, 0x8000
v_exp_f32 v172, v172
v_mfma_f32_16x16x32_bf16 a[64:67], a[224:227], v[216:219], a[64:67]
s_and_b32 s82, s82, 0x1ffff
ds_read_b128 a[224:227], v2 offset:8192
v_mfma_f32_16x16x32_bf16 a[68:71], a[228:231], v[216:219], a[68:71]
ds_read_b128 a[228:231], v2 offset:9216
v_mfma_f32_16x16x32_bf16 a[72:75], a[232:235], v[216:219], a[72:75]
v_exp_f32 v173, v173
v_mfma_f32_16x16x32_bf16 a[76:79], a[236:239], v[216:219], a[76:79]
s_nop 0
ds_read_b128 a[232:235], v2 offset:10240
ds_read_b128 a[236:239], v2 offset:11264
v_mfma_f32_16x16x32_bf16 a[80:83], a[240:243], v[216:219], a[80:83]
ds_read_b128 a[240:243], v2 offset:12288
v_cvt_pk_bf16_f32 v220, v172, v173
v_mfma_f32_16x16x32_bf16 a[84:87], a[244:247], v[216:219], a[84:87]
ds_read_b128 a[244:247], v2 offset:13312
v_mfma_f32_16x16x32_bf16 a[88:91], a[248:251], v[216:219], a[88:91]
v_exp_f32 v174, v174
v_mfma_f32_16x16x32_bf16 a[92:95], a[252:255], v[216:219], a[92:95]
v_exp_f32 v175, v175
ds_read_b128 a[248:251], v2 offset:14336
ds_read_b128 a[252:255], v2 offset:15360
v_add_u32 v2, s82, v1
v_exp_f32 v188, v188
v_cvt_pk_bf16_f32 v221, v174, v175
v_exp_f32 v189, v189
v_exp_f32 v190, v190
v_cvt_pk_bf16_f32 v222, v188, v189
v_exp_f32 v191, v191
s_nop 0
v_cvt_pk_bf16_f32 v223, v190, v191
s_waitcnt vmcnt(4) lgkmcnt(0)
s_barrier
LHT4:
Lstub7:
s_cbranch_execz Lstub11
v_mfma_f32_16x16x32_bf16 v[236:239], v[120:123], v[204:207], v[236:239]
ds_write_b64 v5, v[12:13]
v_mov_b32 v240, 0
v_mfma_f32_16x16x32_bf16 v[236:239], v[120:123], v[220:223], v[236:239]
v_mov_b32 v241, 0
v_mfma_f32_16x16x32_bf16 a[96:99], a[192:195], v[204:207], a[96:99]
s_nop 0
ds_write_b64 v14, v[240:241]
ds_read_b64 a[128:129], v6 offset:0
v_mfma_f32_16x16x32_bf16 a[96:99], a[224:227], v[220:223], a[96:99]
s_nop 0
ds_read_b64 a[130:131], v6 offset:8
ds_read_b128 a[192:195], v7 offset:3584
v_mfma_f32_16x16x32_bf16 a[100:103], a[228:231], v[220:223], a[100:103]
s_nop 0
ds_read_b64 a[132:133], v6 offset:512
ds_read_b64 a[134:135], v6 offset:520
v_mfma_f32_16x16x32_bf16 a[100:103], a[196:199], v[204:207], a[100:103]
s_nop 0
ds_read_b128 a[196:199], v7 offset:3072
ds_read_b64 a[136:137], v6 offset:1024
v_mfma_f32_16x16x32_bf16 a[104:107], a[200:203], v[204:207], a[104:107]
s_nop 0
ds_read_b64 a[138:139], v6 offset:1032
ds_read_b128 a[200:203], v7 offset:2560
v_mfma_f32_16x16x32_bf16 a[104:107], a[232:235], v[220:223], a[104:107]
v_mfma_f32_16x16x32_bf16 a[108:111], a[236:239], v[220:223], a[108:111]
s_nop 0
ds_read_b64 a[140:141], v6 offset:1536
ds_read_b64 a[142:143], v6 offset:1544
v_mfma_f32_16x16x32_bf16 a[108:111], a[204:207], v[204:207], a[108:111]
s_nop 0
ds_read_b128 a[204:207], v7 offset:2048
ds_read_b64 a[144:145], v6 offset:2048
v_mfma_f32_16x16x32_bf16 a[112:115], a[208:211], v[204:207], a[112:115]
s_lshl_b32 s73, s59, 12
ds_read_b64 a[146:147], v6 offset:2056
ds_read_b128 a[208:211], v7 offset:1536
v_mfma_f32_16x16x32_bf16 a[112:115], a[240:243], v[220:223], a[112:115]
s_add_u32 s73, s73, 0x2000000
v_mfma_f32_16x16x32_bf16 a[116:119], a[244:247], v[220:223], a[116:119]
s_lshl_b32 s70, s68, 2
ds_read_b64 a[148:149], v6 offset:2560
ds_read_b64 a[150:151], v6 offset:2568
v_mfma_f32_16x16x32_bf16 a[116:119], a[212:215], v[204:207], a[116:119]
s_add_u32 s70, s70, s73
ds_read_b128 a[212:215], v7 offset:1024
ds_read_b64 a[152:153], v6 offset:3072
v_mfma_f32_16x16x32_bf16 a[120:123], a[216:219], v[204:207], a[120:123]
s_nop 0
ds_read_b64 a[154:155], v6 offset:3080
ds_read_b128 a[216:219], v7 offset:512
v_mfma_f32_16x16x32_bf16 a[120:123], a[248:251], v[220:223], a[120:123]
v_mfma_f32_16x16x32_bf16 a[124:127], a[252:255], v[220:223], a[124:127]
s_xor_b32 s71, s12, 0x80
ds_read_b64 a[156:157], v6 offset:3584
ds_read_b64 a[158:159], v6 offset:3592
v_mfma_f32_16x16x32_bf16 a[124:127], a[220:223], v[204:207], a[124:127]
s_add_u32 m0, s77, 0
ds_read_b128 a[220:223], v7 offset:0
s_waitcnt lgkmcnt(0)
v_mfma_f32_16x16x32_bf16 v[128:131], v[8:11], a[192:195], 0
s_add_u32 s72, s71, 0
buffer_load_dwordx4 v15, s[24:27], s72 offen lds
v_mfma_f32_16x16x32_bf16 v[128:131], a[128:131], a[192:195], v[128:131]
v_mfma_f32_16x16x32_bf16 v[132:135], v[8:11], a[196:199], 0
s_nop 0
ds_read_b128 a[224:227], v7 offset:3648
ds_read_b64 a[160:161], v6 offset:64
v_mfma_f32_16x16x32_bf16 v[132:135], a[128:131], a[196:199], v[132:135]
v_accvgpr_read_b32 v240, a64
v_accvgpr_read_b32 v241, a65
v_accvgpr_read_b32 v242, a66
v_mfma_f32_16x16x32_bf16 v[132:135], a[132:135], a[192:195], v[132:135]
s_add_u32 s72, s71, 15360
buffer_load_dwordx4 v15, s[24:27], s72 offen offset:1024 lds
v_accvgpr_read_b32 v243, a67
v_mfma_f32_16x16x32_bf16 v[136:139], v[8:11], a[200:203], 0
s_nop 0
ds_read_b64 a[162:163], v6 offset:72
ds_read_b128 a[228:231], v7 offset:3136
v_mfma_f32_16x16x32_bf16 v[136:139], a[128:131], a[200:203], v[136:139]
s_lshl_b32 s95, s75, 20
v_rcp_f32 v232, v232
v_mfma_f32_16x16x32_bf16 v[136:139], a[132:135], a[196:199], v[136:139]
s_lshl_b32 s74, s58, 18
v_rcp_f32 v236, v236
v_accvgpr_read_b32 v244, a68
v_mfma_f32_16x16x32_bf16 v[136:139], a[136:139], a[192:195], v[136:139]
s_add_u32 s95, s95, s74
ds_read_b64 a[164:165], v6 offset:576
ds_read_b64 a[166:167], v6 offset:584
v_accvgpr_read_b32 v245, a69
v_mfma_f32_16x16x32_bf16 v[140:143], v[8:11], a[204:207], 0
s_add_u32 s72, s71, 30720
buffer_load_dwordx4 v15, s[24:27], s72 offen offset:2048 lds
v_accvgpr_read_b32 v246, a70
v_mfma_f32_16x16x32_bf16 v[140:143], a[128:131], a[204:207], v[140:143]
s_add_u32 s95, s95, 0x2000000
v_accvgpr_read_b32 v247, a71
v_mul_f32 v240, v240, v232
v_mul_f32 v241, v241, v232
v_mfma_f32_16x16x32_bf16 v[140:143], a[132:135], a[200:203], v[140:143]
s_sub_u32 s74, 15, s75
ds_read_b128 a[232:235], v7 offset:2624
ds_read_b64 a[168:169], v6 offset:1088
v_mul_f32 v242, v242, v232
v_mfma_f32_16x16x32_bf16 v[140:143], a[136:139], a[196:199], v[140:143]
s_add_u32 s72, s71, 46080
buffer_load_dwordx4 v15, s[24:27], s72 offen offset:3072 lds
v_mul_f32 v243, v243, v232
v_mfma_f32_16x16x32_bf16 v[140:143], a[140:143], a[192:195], v[140:143]
s_min_u32 s74, s74, s75
v_mul_f32 v244, v244, v232
v_mul_f32 v245, v245, v232
v_mul_f32 v246, v246, v232
v_mfma_f32_16x16x32_bf16 v[144:147], v[8:11], a[208:211], 0
s_lshl_b32 s74, s74, 7
ds_read_b64 a[170:171], v6 offset:1096
ds_read_b128 a[236:239], v7 offset:2112
v_mul_f32 v247, v247, v232
v_mfma_f32_16x16x32_bf16 v[144:147], a[128:131], a[208:211], v[144:147]
s_add_u32 s74, s74, 0x3810000
v_cvt_pk_bf16_f32 v240, v240, v241
v_cvt_pk_bf16_f32 v241, v242, v243
v_cvt_pk_bf16_f32 v242, v244, v245
v_mfma_f32_16x16x32_bf16 v[144:147], a[132:135], a[204:207], v[144:147]
s_xor_b32 s85, s77, 0x10000
v_cvt_pk_bf16_f32 v243, v246, v247
v_mfma_f32_16x16x32_bf16 v[144:147], a[136:139], a[200:203], v[144:147]
s_nop 0
ds_read_b64 a[172:173], v6 offset:1600
ds_read_b64 a[174:175], v6 offset:1608
v_mfma_f32_16x16x32_bf16 v[144:147], a[140:143], a[196:199], v[144:147]
Lstub8:
s_cbranch_execz Lret
buffer_store_dwordx4 v[240:243], v1, s[44:47], s70 offen sc1
v_mfma_f32_16x16x32_bf16 v[144:147], a[144:147], a[192:195], v[144:147]
v_accvgpr_read_b32 v248, a72
v_accvgpr_read_b32 v249, a73
v_accvgpr_read_b32 v250, a74
v_mfma_f32_16x16x32_bf16 v[148:151], v[8:11], a[212:215], 0
s_nop 0
ds_read_b128 a[240:243], v7 offset:1600
ds_read_b64 a[176:177], v6 offset:2112
v_accvgpr_read_b32 v251, a75
v_mfma_f32_16x16x32_bf16 v[148:151], a[128:131], a[212:215], v[148:151]
v_accvgpr_read_b32 v252, a76
v_accvgpr_read_b32 v253, a77
v_accvgpr_read_b32 v254, a78
v_mfma_f32_16x16x32_bf16 v[148:151], a[132:135], a[208:211], v[148:151]
v_accvgpr_read_b32 v255, a79
v_mul_f32 v248, v248, v232
v_mul_f32 v249, v249, v232
v_mfma_f32_16x16x32_bf16 v[148:151], a[136:139], a[204:207], v[148:151]
s_nop 0
ds_read_b64 a[178:179], v6 offset:2120
ds_read_b128 a[244:247], v7 offset:1088
v_mul_f32 v250, v250, v232
v_mfma_f32_16x16x32_bf16 v[148:151], a[140:143], a[200:203], v[148:151]
v_mul_f32 v251, v251, v232
v_mul_f32 v252, v252, v232
v_mul_f32 v253, v253, v232
v_mfma_f32_16x16x32_bf16 v[148:151], a[144:147], a[196:199], v[148:151]
v_mul_f32 v254, v254, v232
v_mul_f32 v255, v255, v232
v_cvt_pk_bf16_f32 v248, v248, v249
v_mfma_f32_16x16x32_bf16 v[148:151], a[148:151], a[192:195], v[148:151]
s_nop 0
ds_read_b64 a[180:181], v6 offset:2624
ds_read_b64 a[182:183], v6 offset:2632
v_cvt_pk_bf16_f32 v249, v250, v251
v_mfma_f32_16x16x32_bf16 v[152:155], v[8:11], a[216:219], 0
v_cvt_pk_bf16_f32 v250, v252, v253
v_cvt_pk_bf16_f32 v251, v254, v255
v_mfma_f32_16x16x32_bf16 v[152:155], a[128:131], a[216:219], v[152:155]
buffer_store_dwordx4 v[248:251], v1, s[44:47], s70 offen offset:1024 sc1
v_mfma_f32_16x16x32_bf16 v[152:155], a[132:135], a[212:215], v[152:155]
s_nop 0
ds_read_b128 a[248:251], v7 offset:576
ds_read_b64 a[184:185], v6 offset:3136
v_accvgpr_read_b32 v240, a80
v_mfma_f32_16x16x32_bf16 v[152:155], a[136:139], a[208:211], v[152:155]
v_accvgpr_read_b32 v241, a81
v_accvgpr_read_b32 v242, a82
v_accvgpr_read_b32 v243, a83
v_mfma_f32_16x16x32_bf16 v[152:155], a[140:143], a[204:207], v[152:155]
v_accvgpr_read_b32 v244, a84
v_accvgpr_read_b32 v245, a85
v_accvgpr_read_b32 v246, a86
v_mfma_f32_16x16x32_bf16 v[152:155], a[144:147], a[200:203], v[152:155]
s_nop 0
ds_read_b64 a[186:187], v6 offset:3144
ds_read_b128 a[252:255], v7 offset:64
v_accvgpr_read_b32 v247, a87
v_mfma_f32_16x16x32_bf16 v[152:155], a[148:151], a[196:199], v[152:155]
v_mul_f32 v240, v240, v232
v_mul_f32 v241, v241, v232
v_mul_f32 v242, v242, v232
v_mfma_f32_16x16x32_bf16 v[152:155], a[152:155], a[192:195], v[152:155]
v_mul_f32 v243, v243, v232
v_mul_f32 v244, v244, v232
v_mul_f32 v245, v245, v232
v_mfma_f32_16x16x32_bf16 v[156:159], v[8:11], a[220:223], 0
s_nop 0
ds_read_b64 a[188:189], v6 offset:3648
ds_read_b64 a[190:191], v6 offset:3656
v_mul_f32 v246, v246, v232
v_mfma_f32_16x16x32_bf16 v[156:159], a[128:131], a[220:223], v[156:159]
v_mul_f32 v247, v247, v232
v_cvt_pk_bf16_f32 v240, v240, v241
v_cvt_pk_bf16_f32 v241, v242, v243
v_mfma_f32_16x16x32_bf16 v[156:159], a[132:135], a[216:219], v[156:159]
v_cvt_pk_bf16_f32 v242, v244, v245
v_cvt_pk_bf16_f32 v243, v246, v247
v_mfma_f32_16x16x32_bf16 v[156:159], a[136:139], a[212:215], v[156:159]
buffer_store_dwordx4 v[240:243], v1, s[44:47], s70 offen offset:2048 sc1
v_mfma_f32_16x16x32_bf16 v[156:159], a[140:143], a[208:211], v[156:159]
v_accvgpr_read_b32 v248, a88
v_accvgpr_read_b32 v249, a89
v_accvgpr_read_b32 v250, a90
v_mfma_f32_16x16x32_bf16 v[156:159], a[144:147], a[204:207], v[156:159]
v_accvgpr_read_b32 v251, a91
v_accvgpr_read_b32 v252, a92
v_accvgpr_read_b32 v253, a93
v_mfma_f32_16x16x32_bf16 v[156:159], a[148:151], a[200:203], v[156:159]
v_accvgpr_read_b32 v254, a94
v_accvgpr_read_b32 v255, a95
v_mul_f32 v248, v248, v232
v_mfma_f32_16x16x32_bf16 v[156:159], a[152:155], a[196:199], v[156:159]
v_mul_f32 v249, v249, v232
v_mul_f32 v250, v250, v232
v_mul_f32 v251, v251, v232
v_mfma_f32_16x16x32_bf16 v[156:159], a[156:159], a[192:195], v[156:159]
s_waitcnt lgkmcnt(0)
v_mul_f32 v252, v252, v232
v_mul_f32 v253, v253, v232
v_mul_f32 v254, v254, v232
v_mfma_f32_16x16x32_bf16 v[128:131], a[160:163], a[224:227], v[128:131]
s_nop 0
ds_read_b128 a[192:195], v7 offset:3712
ds_read_b64 a[128:129], v6 offset:128
v_mul_f32 v255, v255, v232
v_mfma_f32_16x16x32_bf16 v[132:135], a[164:167], a[224:227], v[132:135]
v_cvt_pk_bf16_f32 v248, v248, v249
v_cvt_pk_bf16_f32 v249, v250, v251
v_cvt_pk_bf16_f32 v250, v252, v253
v_mfma_f32_16x16x32_bf16 v[132:135], a[160:163], a[228:231], v[132:135]
s_nop 0
ds_read_b64 a[130:131], v6 offset:136
ds_read_b128 a[196:199], v7 offset:3200
v_cvt_pk_bf16_f32 v251, v254, v255
v_mfma_f32_16x16x32_bf16 v[136:139], a[160:163], a[232:235], v[136:139]
buffer_store_dwordx4 v[248:251], v1, s[44:47], s70 offen offset:3072 sc1
v_mfma_f32_16x16x32_bf16 v[136:139], a[164:167], a[228:231], v[136:139]
s_add_u32 s70, s70, 0x80000
v_accvgpr_read_b32 v240, a96
v_accvgpr_read_b32 v241, a97
v_accvgpr_read_b32 v242, a98
v_mfma_f32_16x16x32_bf16 v[136:139], a[168:171], a[224:227], v[136:139]
s_nop 0
ds_read_b64 a[132:133], v6 offset:640
ds_read_b64 a[134:135], v6 offset:648
v_accvgpr_read_b32 v243, a99
v_mfma_f32_16x16x32_bf16 v[140:143], a[172:175], a[224:227], v[140:143]
v_accvgpr_read_b32 v244, a100
v_accvgpr_read_b32 v245, a101
v_accvgpr_read_b32 v246, a102
v_mfma_f32_16x16x32_bf16 v[140:143], a[168:171], a[228:231], v[140:143]
s_nop 0
ds_read_b128 a[200:203], v7 offset:2688
ds_read_b64 a[136:137], v6 offset:1152
v_accvgpr_read_b32 v247, a103
v_mfma_f32_16x16x32_bf16 v[140:143], a[164:167], a[232:235], v[140:143]
v_mul_f32 v240, v240, v236
v_mul_f32 v241, v241, v236
v_mul_f32 v242, v242, v236
v_mfma_f32_16x16x32_bf16 v[140:143], a[160:163], a[236:239], v[140:143]
v_mul_f32 v243, v243, v236
v_mul_f32 v244, v244, v236
v_mul_f32 v245, v245, v236
v_mfma_f32_16x16x32_bf16 v[144:147], a[160:163], a[240:243], v[144:147]
s_nop 0
ds_read_b64 a[138:139], v6 offset:1160
ds_read_b128 a[204:207], v7 offset:2176
v_mul_f32 v246, v246, v236
v_mfma_f32_16x16x32_bf16 v[144:147], a[164:167], a[236:239], v[144:147]
v_mul_f32 v247, v247, v236
v_cvt_pk_bf16_f32 v240, v240, v241
v_cvt_pk_bf16_f32 v241, v242, v243
v_mfma_f32_16x16x32_bf16 v[144:147], a[168:171], a[232:235], v[144:147]
s_nop 0
ds_read_b64 a[140:141], v6 offset:1664
ds_read_b64 a[142:143], v6 offset:1672
v_cvt_pk_bf16_f32 v242, v244, v245
v_mfma_f32_16x16x32_bf16 v[144:147], a[172:175], a[228:231], v[144:147]
v_cvt_pk_bf16_f32 v243, v246, v247
v_mfma_f32_16x16x32_bf16 v[144:147], a[176:179], a[224:227], v[144:147]
buffer_store_dwordx4 v[240:243], v1, s[44:47], s70 offen sc1
v_mfma_f32_16x16x32_bf16 v[148:151], a[180:183], a[224:227], v[148:151]
s_nop 0
ds_read_b128 a[208:211], v7 offset:1664
ds_read_b64 a[144:145], v6 offset:2176
v_accvgpr_read_b32 v248, a104
v_mfma_f32_16x16x32_bf16 v[148:151], a[176:179], a[228:231], v[148:151]
v_accvgpr_read_b32 v249, a105
v_accvgpr_read_b32 v250, a106
v_accvgpr_read_b32 v251, a107
v_mfma_f32_16x16x32_bf16 v[148:151], a[172:175], a[232:235], v[148:151]
v_accvgpr_read_b32 v252, a108
v_accvgpr_read_b32 v253, a109
v_accvgpr_read_b32 v254, a110
v_mfma_f32_16x16x32_bf16 v[148:151], a[168:171], a[236:239], v[148:151]
s_nop 0
ds_read_b64 a[146:147], v6 offset:2184
ds_read_b128 a[212:215], v7 offset:1152
v_accvgpr_read_b32 v255, a111
v_mfma_f32_16x16x32_bf16 v[148:151], a[164:167], a[240:243], v[148:151]
v_mul_f32 v248, v248, v236
v_mul_f32 v249, v249, v236
v_mul_f32 v250, v250, v236
v_mfma_f32_16x16x32_bf16 v[148:151], a[160:163], a[244:247], v[148:151]
s_nop 0
ds_read_b64 a[148:149], v6 offset:2688
ds_read_b64 a[150:151], v6 offset:2696
v_mul_f32 v251, v251, v236
v_mfma_f32_16x16x32_bf16 v[152:155], a[160:163], a[248:251], v[152:155]
v_mul_f32 v252, v252, v236
v_mul_f32 v253, v253, v236
v_mul_f32 v254, v254, v236
v_mfma_f32_16x16x32_bf16 v[152:155], a[164:167], a[244:247], v[152:155]
v_mul_f32 v255, v255, v236
v_cvt_pk_bf16_f32 v248, v248, v249
v_cvt_pk_bf16_f32 v249, v250, v251
v_mfma_f32_16x16x32_bf16 v[152:155], a[168:171], a[240:243], v[152:155]
s_nop 0
ds_read_b128 a[216:219], v7 offset:640
ds_read_b64 a[152:153], v6 offset:3200
v_cvt_pk_bf16_f32 v250, v252, v253
v_mfma_f32_16x16x32_bf16 v[152:155], a[172:175], a[236:239], v[152:155]
v_cvt_pk_bf16_f32 v251, v254, v255
v_mfma_f32_16x16x32_bf16 v[152:155], a[176:179], a[232:235], v[152:155]
s_nop 0
ds_read_b64 a[154:155], v6 offset:3208
ds_read_b128 a[220:223], v7 offset:128
v_mfma_f32_16x16x32_bf16 v[152:155], a[180:183], a[228:231], v[152:155]
buffer_store_dwordx4 v[248:251], v1, s[44:47], s70 offen offset:1024 sc1
v_mfma_f32_16x16x32_bf16 v[152:155], a[184:187], a[224:227], v[152:155]
v_accvgpr_read_b32 v240, a112
v_accvgpr_read_b32 v241, a113
v_accvgpr_read_b32 v242, a114
v_mfma_f32_16x16x32_bf16 v[156:159], a[188:191], a[224:227], v[156:159]
s_nop 0
ds_read_b64 a[156:157], v6 offset:3712
ds_read_b64 a[158:159], v6 offset:3720
v_accvgpr_read_b32 v243, a115
v_mfma_f32_16x16x32_bf16 v[156:159], a[184:187], a[228:231], v[156:159]
v_accvgpr_read_b32 v244, a116
v_accvgpr_read_b32 v245, a117
v_accvgpr_read_b32 v246, a118
v_mfma_f32_16x16x32_bf16 v[156:159], a[180:183], a[232:235], v[156:159]
v_accvgpr_read_b32 v247, a119
v_mul_f32 v240, v240, v236
v_mul_f32 v241, v241, v236
v_mfma_f32_16x16x32_bf16 v[156:159], a[176:179], a[236:239], v[156:159]
v_mul_f32 v242, v242, v236
v_mul_f32 v243, v243, v236
v_mul_f32 v244, v244, v236
v_mfma_f32_16x16x32_bf16 v[156:159], a[172:175], a[240:243], v[156:159]
v_mul_f32 v245, v245, v236
v_mul_f32 v246, v246, v236
v_mul_f32 v247, v247, v236
v_mfma_f32_16x16x32_bf16 v[156:159], a[168:171], a[244:247], v[156:159]
v_cvt_pk_bf16_f32 v240, v240, v241
v_cvt_pk_bf16_f32 v241, v242, v243
v_cvt_pk_bf16_f32 v242, v244, v245
v_mfma_f32_16x16x32_bf16 v[156:159], a[164:167], a[248:251], v[156:159]
v_cvt_pk_bf16_f32 v243, v246, v247
v_mfma_f32_16x16x32_bf16 v[156:159], a[160:163], a[252:255], v[156:159]
s_waitcnt lgkmcnt(0)
buffer_store_dwordx4 v[240:243], v1, s[44:47], s70 offen offset:2048 sc1
v_mfma_f32_16x16x32_bf16 v[128:131], a[128:131], a[192:195], v[128:131]
s_nop 0
ds_read_b128 a[224:227], v7 offset:3776
ds_read_b64 a[160:161], v6 offset:192
v_accvgpr_read_b32 v248, a120
v_mfma_f32_16x16x32_bf16 v[132:135], a[132:135], a[192:195], v[132:135]
v_accvgpr_read_b32 v249, a121
v_accvgpr_read_b32 v250, a122
v_accvgpr_read_b32 v251, a123
v_mfma_f32_16x16x32_bf16 v[132:135], a[128:131], a[196:199], v[132:135]
s_nop 0
ds_read_b64 a[162:163], v6 offset:200
ds_read_b128 a[228:231], v7 offset:3264
v_accvgpr_read_b32 v252, a124
v_mfma_f32_16x16x32_bf16 v[136:139], a[128:131], a[200:203], v[136:139]
v_accvgpr_read_b32 v253, a125
v_accvgpr_read_b32 v254, a126
v_accvgpr_read_b32 v255, a127
v_mfma_f32_16x16x32_bf16 v[136:139], a[132:135], a[196:199], v[136:139]
v_mul_f32 v248, v248, v236
v_mul_f32 v249, v249, v236
v_mul_f32 v250, v250, v236
v_mfma_f32_16x16x32_bf16 v[136:139], a[136:139], a[192:195], v[136:139]
s_nop 0
ds_read_b64 a[164:165], v6 offset:704
ds_read_b64 a[166:167], v6 offset:712
v_mul_f32 v251, v251, v236
v_mfma_f32_16x16x32_bf16 v[140:143], a[140:143], a[192:195], v[140:143]
v_mul_f32 v252, v252, v236
v_mul_f32 v253, v253, v236
v_mul_f32 v254, v254, v236
v_mfma_f32_16x16x32_bf16 v[140:143], a[136:139], a[196:199], v[140:143]
s_nop 0
ds_read_b128 a[232:235], v7 offset:2752
ds_read_b64 a[168:169], v6 offset:1216
v_mul_f32 v255, v255, v236
v_mfma_f32_16x16x32_bf16 v[140:143], a[132:135], a[200:203], v[140:143]
v_cvt_pk_bf16_f32 v248, v248, v249
v_cvt_pk_bf16_f32 v249, v250, v251
v_cvt_pk_bf16_f32 v250, v252, v253
v_mfma_f32_16x16x32_bf16 v[140:143], a[128:131], a[204:207], v[140:143]
v_cvt_pk_bf16_f32 v251, v254, v255
v_mfma_f32_16x16x32_bf16 v[144:147], a[128:131], a[208:211], v[144:147]
s_nop 0
ds_read_b64 a[170:171], v6 offset:1224
ds_read_b128 a[236:239], v7 offset:2240
v_mfma_f32_16x16x32_bf16 v[144:147], a[132:135], a[204:207], v[144:147]
buffer_store_dwordx4 v[248:251], v1, s[44:47], s70 offen offset:3072 sc1
v_mfma_f32_16x16x32_bf16 v[144:147], a[136:139], a[200:203], v[144:147]
s_mov_b32 s73, 0x5d800000
ds_read_b64 a[172:173], v6 offset:1728
ds_read_b64 a[174:175], v6 offset:1736
v_add_f32 v227, v226, v230
v_mfma_f32_16x16x32_bf16 v[144:147], a[140:143], a[196:199], v[144:147]
v_add_f32 v231, v234, v238
v_add_f32 v227, v227, v231
v_cmp_nlt_f32 vcc, v227, s73
v_mfma_f32_16x16x32_bf16 v[144:147], a[144:147], a[192:195], v[144:147]
s_lshl_b32 s73, s58, 2
v_mfma_f32_16x16x32_bf16 v[148:151], a[148:151], a[192:195], v[148:151]
s_add_u32 s73, s73, 163328
ds_read_b128 a[240:243], v7 offset:1728
ds_read_b64 a[176:177], v6 offset:2240
v_mov_b32 v231, s73
v_mfma_f32_16x16x32_bf16 v[148:151], a[144:147], a[196:199], v[148:151]
s_or_b32 s73, vcc_lo, vcc_hi
v_mfma_f32_16x16x32_bf16 v[148:151], a[140:143], a[200:203], v[148:151]
s_min_u32 s73, s73, 1
v_mov_b32 v227, s73
v_mfma_f32_16x16x32_bf16 v[148:151], a[136:139], a[204:207], v[148:151]
s_nop 0
ds_read_b64 a[178:179], v6 offset:2248
ds_read_b128 a[244:247], v7 offset:1216
ds_write_b32 v231, v227
v_mfma_f32_16x16x32_bf16 v[148:151], a[132:135], a[208:211], v[148:151]
v_mfma_f32_16x16x32_bf16 v[148:151], a[128:131], a[212:215], v[148:151]
s_nop 0
ds_read_b64 a[180:181], v6 offset:2752
ds_read_b64 a[182:183], v6 offset:2760
v_mfma_f32_16x16x32_bf16 v[152:155], a[128:131], a[216:219], v[152:155]
v_mfma_f32_16x16x32_bf16 v[152:155], a[132:135], a[212:215], v[152:155]
v_mfma_f32_16x16x32_bf16 v[152:155], a[136:139], a[208:211], v[152:155]
s_nop 0
ds_read_b128 a[248:251], v7 offset:704
ds_read_b64 a[184:185], v6 offset:3264
v_mfma_f32_16x16x32_bf16 v[152:155], a[140:143], a[204:207], v[152:155]
v_mfma_f32_16x16x32_bf16 v[152:155], a[144:147], a[200:203], v[152:155]
s_nop 0
ds_read_b64 a[186:187], v6 offset:3272
ds_read_b128 a[252:255], v7 offset:192
v_mfma_f32_16x16x32_bf16 v[152:155], a[148:151], a[196:199], v[152:155]
v_mfma_f32_16x16x32_bf16 v[152:155], a[152:155], a[192:195], v[152:155]
v_mfma_f32_16x16x32_bf16 v[156:159], a[156:159], a[192:195], v[156:159]
s_nop 0
ds_read_b64 a[188:189], v6 offset:3776
ds_read_b64 a[190:191], v6 offset:3784
v_mfma_f32_16x16x32_bf16 v[156:159], a[152:155], a[196:199], v[156:159]
v_mfma_f32_16x16x32_bf16 v[156:159], a[148:151], a[200:203], v[156:159]
v_mfma_f32_16x16x32_bf16 v[156:159], a[144:147], a[204:207], v[156:159]
v_mfma_f32_16x16x32_bf16 v[156:159], a[140:143], a[208:211], v[156:159]
v_mfma_f32_16x16x32_bf16 v[156:159], a[136:139], a[212:215], v[156:159]
v_mfma_f32_16x16x32_bf16 v[156:159], a[132:135], a[216:219], v[156:159]
v_mfma_f32_16x16x32_bf16 v[156:159], a[128:131], a[220:223], v[156:159]
s_waitcnt lgkmcnt(0)
v_mfma_f32_16x16x32_bf16 v[128:131], a[160:163], a[224:227], v[128:131]
s_nop 0
ds_read_b128 a[192:195], v7 offset:3840
ds_read_b64 a[128:129], v6 offset:256
v_mfma_f32_16x16x32_bf16 v[132:135], a[164:167], a[224:227], v[132:135]
v_mfma_f32_16x16x32_bf16 v[132:135], a[160:163], a[228:231], v[132:135]
s_nop 0
ds_read_b64 a[130:131], v6 offset:264
ds_read_b128 a[196:199], v7 offset:3328
v_mfma_f32_16x16x32_bf16 v[136:139], a[160:163], a[232:235], v[136:139]
v_mfma_f32_16x16x32_bf16 v[136:139], a[164:167], a[228:231], v[136:139]
v_mfma_f32_16x16x32_bf16 v[136:139], a[168:171], a[224:227], v[136:139]
s_nop 0
ds_read_b64 a[132:133], v6 offset:768
ds_read_b64 a[134:135], v6 offset:776
v_mfma_f32_16x16x32_bf16 v[140:143], a[172:175], a[224:227], v[140:143]
v_mfma_f32_16x16x32_bf16 v[140:143], a[168:171], a[228:231], v[140:143]
s_nop 0
ds_read_b128 a[200:203], v7 offset:2816
ds_read_b64 a[136:137], v6 offset:1280
v_mfma_f32_16x16x32_bf16 v[140:143], a[164:167], a[232:235], v[140:143]
v_mfma_f32_16x16x32_bf16 v[140:143], a[160:163], a[236:239], v[140:143]
v_mfma_f32_16x16x32_bf16 v[144:147], a[160:163], a[240:243], v[144:147]
s_nop 0
ds_read_b64 a[138:139], v6 offset:1288
ds_read_b128 a[204:207], v7 offset:2304
v_mfma_f32_16x16x32_bf16 v[144:147], a[164:167], a[236:239], v[144:147]
s_nop 3
s_mov_b64 exec, 0
s_cmp_eq_u32 s58, 0
s_cbranch_scc1 Lstube0
s_cmp_eq_u32 s58, 1
s_cbranch_scc1 Lstube1
s_cmp_eq_u32 s58, 2
s_cbranch_scc1 Lstube2
s_branch Lstube3
Lrete:
s_mov_b64 exec, -1
s_nop 3
v_mfma_f32_16x16x32_bf16 v[144:147], a[168:171], a[232:235], v[144:147]
s_waitcnt vmcnt(0) lgkmcnt(15)
ds_read_b64 a[140:141], v6 offset:1792
ds_read_b64 a[142:143], v6 offset:1800
v_mfma_f32_16x16x32_bf16 v[144:147], a[172:175], a[228:231], v[144:147]
s_barrier
v_mov_b32 v244, 163328
v_mfma_f32_16x16x32_bf16 v[144:147], a[176:179], a[224:227], v[144:147]
s_xor_b32 s71, s12, 0x100
ds_read_b128 v[240:243], v244
v_mfma_f32_16x16x32_bf16 v[148:151], a[180:183], a[224:227], v[148:151]
s_add_u32 m0, s77, 16384
ds_read_b128 a[208:211], v7 offset:1792
ds_read_b64 a[144:145], v6 offset:2304
v_mfma_f32_16x16x32_bf16 v[148:151], a[176:179], a[228:231], v[148:151]
s_add_u32 s72, s71, 0
buffer_load_dwordx4 v15, s[24:27], s72 offen lds
v_mfma_f32_16x16x32_bf16 v[148:151], a[172:175], a[232:235], v[148:151]
v_mfma_f32_16x16x32_bf16 v[148:151], a[168:171], a[236:239], v[148:151]
s_nop 0
ds_read_b64 a[146:147], v6 offset:2312
ds_read_b128 a[212:215], v7 offset:1280
v_mfma_f32_16x16x32_bf16 v[148:151], a[164:167], a[240:243], v[148:151]
s_add_u32 s72, s71, 15360
buffer_load_dwordx4 v15, s[24:27], s72 offen offset:1024 lds
v_mfma_f32_16x16x32_bf16 v[148:151], a[160:163], a[244:247], v[148:151]
s_waitcnt lgkmcnt(4)
ds_read_b64 a[148:149], v6 offset:2816
ds_read_b64 a[150:151], v6 offset:2824
v_mfma_f32_16x16x32_bf16 v[152:155], a[160:163], a[248:251], v[152:155]
v_or3_b32 v240, v240, v241, v242
v_or_b32 v240, v240, v243
v_mfma_f32_16x16x32_bf16 v[152:155], a[164:167], a[244:247], v[152:155]
v_cmp_lt_u32 vcc, s86, v240
s_cbranch_vccnz Lslow
v_mfma_f32_16x16x32_bf16 v[152:155], a[168:171], a[240:243], v[152:155]
s_nop 0
ds_read_b128 a[216:219], v7 offset:768
ds_read_b64 a[152:153], v6 offset:3328
v_mfma_f32_16x16x32_bf16 v[152:155], a[172:175], a[236:239], v[152:155]
v_or_b32 v240, s58, v0
v_mov_b32 v241, 2
v_mfma_f32_16x16x32_bf16 v[152:155], a[176:179], a[232:235], v[152:155]
s_add_u32 s72, s71, 30720
ds_read_b64 a[154:155], v6 offset:3336
ds_read_b128 a[220:223], v7 offset:256
v_mfma_f32_16x16x32_bf16 v[152:155], a[180:183], a[228:231], v[152:155]
buffer_load_dwordx4 v15, s[24:27], s72 offen offset:2048 lds
v_mfma_f32_16x16x32_bf16 v[152:155], a[184:187], a[224:227], v[152:155]
v_min_u32 v240, 1, v240
v_lshlrev_b32 v240, 30, v240
v_mfma_f32_16x16x32_bf16 v[156:159], a[188:191], a[224:227], v[156:159]
s_nop 0
ds_read_b64 a[156:157], v6 offset:3840
ds_read_b64 a[158:159], v6 offset:3848
v_mfma_f32_16x16x32_bf16 v[156:159], a[184:187], a[228:231], v[156:159]
buffer_store_dword v241, v240, s[44:47], s91 offen sc1
v_mfma_f32_16x16x32_bf16 v[156:159], a[180:183], a[232:235], v[156:159]
s_add_u32 s80, s93, 0x3400000
v_and_b32 v166, 7, v0
v_lshlrev_b32 v166, 4, v166
v_mfma_f32_16x16x32_bf16 v[156:159], a[176:179], a[236:239], v[156:159]
s_add_u32 s72, s71, 46080
buffer_load_dwordx4 v15, s[24:27], s72 offen offset:3072 lds
v_mfma_f32_16x16x32_bf16 v[156:159], a[172:175], a[240:243], v[156:159]
v_bfe_u32 v112, v0, 3, 1
v_lshl_add_u32 v166, v112, 8, v166
v_mfma_f32_16x16x32_bf16 v[156:159], a[168:171], a[244:247], v[156:159]
v_bfe_u32 v112, v0, 4, 1
v_lshl_add_u32 v166, v112, 7, v166
v_mfma_f32_16x16x32_bf16 v[156:159], a[164:167], a[248:251], v[156:159]
v_lshrrev_b32 v2, 4, v0
v_lshlrev_b32 v2, 10, v2
v_mfma_f32_16x16x32_bf16 v[156:159], a[160:163], a[252:255], v[156:159]
s_waitcnt lgkmcnt(0)
v_lshrrev_b32 v112, 5, v0
v_lshl_add_u32 v166, v112, 9, v166
v_mfma_f32_16x16x32_bf16 v[128:131], a[128:131], a[192:195], v[128:131]
s_xor_b32 s82, s78, 0
ds_read_b128 a[224:227], v7 offset:3904
ds_read_b64 a[160:161], v6 offset:320
v_mfma_f32_16x16x32_bf16 v[132:135], a[132:135], a[192:195], v[132:135]
s_xor_b32 s71, s12, 0x180
v_and_b32 v112, 15, v0
v_lshrrev_b32 v113, 2, v0
v_mfma_f32_16x16x32_bf16 v[132:135], a[128:131], a[196:199], v[132:135]
s_add_u32 m0, s77, 32768
ds_read_b64 a[162:163], v6 offset:328
ds_read_b128 a[228:231], v7 offset:3392
v_mfma_f32_16x16x32_bf16 v[136:139], a[128:131], a[200:203], v[136:139]
s_add_u32 s72, s71, 0
buffer_load_dwordx4 v15, s[24:27], s72 offen lds
v_mfma_f32_16x16x32_bf16 v[136:139], a[132:135], a[196:199], v[136:139]
s_lshl_b32 s82, s82, 10
v_bfe_u32 v114, v0, 3, 2
v_and_b32 v115, 3, v0
v_mfma_f32_16x16x32_bf16 v[136:139], a[136:139], a[192:195], v[136:139]
s_add_u32 s82, s82, s74
ds_read_b64 a[164:165], v6 offset:832
ds_read_b64 a[166:167], v6 offset:840
v_mfma_f32_16x16x32_bf16 v[140:143], a[140:143], a[192:195], v[140:143]
buffer_load_dword v3, v2, s[44:47], s82 offen sc1
v_mfma_f32_16x16x32_bf16 v[140:143], a[136:139], a[196:199], v[140:143]
s_add_u32 s72, s71, 15360
ds_read_b128 a[232:235], v7 offset:2880
ds_read_b64 a[168:169], v6 offset:1344
v_mfma_f32_16x16x32_bf16 v[140:143], a[132:135], a[200:203], v[140:143]
buffer_load_dwordx4 v15, s[24:27], s72 offen offset:1024 lds
v_mfma_f32_16x16x32_bf16 v[140:143], a[128:131], a[204:207], v[140:143]
v_lshlrev_b32 v8, 7, v113
v_lshl_add_u32 v8, v114, 5, v8
v_mfma_f32_16x16x32_bf16 v[144:147], a[128:131], a[208:211], v[144:147]
s_nop 0
ds_read_b64 a[170:171], v6 offset:1352
ds_read_b128 a[236:239], v7 offset:2368
v_mfma_f32_16x16x32_bf16 v[144:147], a[132:135], a[204:207], v[144:147]
v_lshl_add_u32 v8, v115, 3, v8
v_add_u32 v8, s77, v8
v_mfma_f32_16x16x32_bf16 v[144:147], a[136:139], a[200:203], v[144:147]
s_nop 0
ds_read_b64 a[172:173], v6 offset:1856
ds_read_b64 a[174:175], v6 offset:1864
v_mfma_f32_16x16x32_bf16 v[144:147], a[140:143], a[196:199], v[144:147]
s_add_u32 s72, s71, 30720
buffer_load_dwordx4 v15, s[24:27], s72 offen offset:2048 lds
v_mfma_f32_16x16x32_bf16 v[144:147], a[144:147], a[192:195], v[144:147]
v_subrev_u32 v8, s64, v8
v_xor_b32 v9, 32, v8
v_mfma_f32_16x16x32_bf16 v[148:151], a[148:151], a[192:195], v[148:151]
s_nop 0
ds_read_b128 a[240:243], v7 offset:1856
ds_read_b64 a[176:177], v6 offset:2368
v_mfma_f32_16x16x32_bf16 v[148:151], a[144:147], a[196:199], v[148:151]
v_xor_b32 v10, 64, v8
v_xor_b32 v11, 0x60, v8
v_mfma_f32_16x16x32_bf16 v[148:151], a[140:143], a[200:203], v[148:151]
v_lshlrev_b32 v5, 8, v113
v_and_b32 v114, 1, v0
v_mfma_f32_16x16x32_bf16 v[148:151], a[136:139], a[204:207], v[148:151]
s_nop 0
ds_read_b64 a[178:179], v6 offset:2376
ds_read_b128 a[244:247], v7 offset:1344
v_mfma_f32_16x16x32_bf16 v[148:151], a[132:135], a[208:211], v[148:151]
s_add_u32 s72, s71, 46080
buffer_load_dwordx4 v15, s[24:27], s72 offen offset:3072 lds
v_mfma_f32_16x16x32_bf16 v[148:151], a[128:131], a[212:215], v[148:151]
s_nop 0
ds_read_b64 a[180:181], v6 offset:2880
ds_read_b64 a[182:183], v6 offset:2888
v_mfma_f32_16x16x32_bf16 v[152:155], a[128:131], a[216:219], v[152:155]
v_lshl_add_u32 v5, v114, 7, v5
v_bfe_u32 v114, v0, 1, 1
v_mfma_f32_16x16x32_bf16 v[152:155], a[132:135], a[212:215], v[152:155]
v_lshl_add_u32 v5, v114, 3, v5
v_lshlrev_b32 v114, 1, s58
v_mfma_f32_16x16x32_bf16 v[152:155], a[136:139], a[208:211], v[152:155]
s_nop 0
ds_read_b128 a[248:251], v7 offset:832
ds_read_b64 a[184:185], v6 offset:3392
v_mfma_f32_16x16x32_bf16 v[152:155], a[140:143], a[204:207], v[152:155]
v_xor_b32 v114, v114, v113
v_and_b32 v114, 7, v114
v_mfma_f32_16x16x32_bf16 v[152:155], a[144:147], a[200:203], v[152:155]
s_xor_b32 s71, s13, 0x80
ds_read_b64 a[186:187], v6 offset:3400
ds_read_b128 a[252:255], v7 offset:320
v_mfma_f32_16x16x32_bf16 v[152:155], a[148:151], a[196:199], v[152:155]
s_add_u32 m0, s77, 49152
v_lshl_add_u32 v5, v114, 4, v5
v_add_u32 v5, 147456, v5
v_mfma_f32_16x16x32_bf16 v[152:155], a[152:155], a[192:195], v[152:155]
s_add_u32 s72, s71, 0
buffer_load_dwordx4 v15, s[24:27], s72 offen lds
v_mfma_f32_16x16x32_bf16 v[156:159], a[156:159], a[192:195], v[156:159]
s_nop 0
ds_read_b64 a[188:189], v6 offset:3904
ds_read_b64 a[190:191], v6 offset:3912
v_mfma_f32_16x16x32_bf16 v[156:159], a[152:155], a[196:199], v[156:159]
v_bfe_u32 v114, v0, 1, 2
v_lshrrev_b32 v115, 4, v0
v_mfma_f32_16x16x32_bf16 v[156:159], a[148:151], a[200:203], v[156:159]
v_lshlrev_b32 v116, 7, v112
v_lshl_add_u32 v116, v114, 5, v116
v_mfma_f32_16x16x32_bf16 v[156:159], a[144:147], a[204:207], v[156:159]
s_add_u32 s72, s71, 15360
buffer_load_dwordx4 v15, s[24:27], s72 offen offset:1024 lds
v_mfma_f32_16x16x32_bf16 v[156:159], a[140:143], a[208:211], v[156:159]
v_lshl_add_u32 v116, v115, 3, v116
v_add_u32 v116, s64, v116
v_mfma_f32_16x16x32_bf16 v[156:159], a[136:139], a[212:215], v[156:159]
v_add_u32 v116, 131072, v116
v_xor_b32 v117, 32, v116
v_mfma_f32_16x16x32_bf16 v[156:159], a[132:135], a[216:219], v[156:159]
v_xor_b32 v118, 64, v116
v_xor_b32 v119, 0x60, v116
v_mfma_f32_16x16x32_bf16 v[156:159], a[128:131], a[220:223], v[156:159]
s_waitcnt lgkmcnt(0)
v_mfma_f32_16x16x32_bf16 v[128:131], a[160:163], a[224:227], v[128:131]
s_nop 0
ds_read_b128 a[192:195], v7 offset:3968
ds_read_b64 a[128:129], v6 offset:384
v_mfma_f32_16x16x32_bf16 v[132:135], a[164:167], a[224:227], v[132:135]
s_add_u32 s72, s71, 30720
buffer_load_dwordx4 v15, s[24:27], s72 offen offset:2048 lds
v_mfma_f32_16x16x32_bf16 v[132:135], a[160:163], a[228:231], v[132:135]
s_nop 0
ds_read_b64 a[130:131], v6 offset:392
ds_read_b128 a[196:199], v7 offset:3456
v_mfma_f32_16x16x32_bf16 v[136:139], a[160:163], a[232:235], v[136:139]
Lstub9:
s_cbranch_execz Lret
v_mfma_f32_16x16x32_bf16 v[136:139], a[164:167], a[228:231], v[136:139]
v_mfma_f32_16x16x32_bf16 v[136:139], a[168:171], a[224:227], v[136:139]
s_nop 0
ds_read_b64 a[132:133], v6 offset:896
ds_read_b64 a[134:135], v6 offset:904
v_mfma_f32_16x16x32_bf16 v[140:143], a[172:175], a[224:227], v[140:143]
v_mfma_f32_16x16x32_bf16 v[140:143], a[168:171], a[228:231], v[140:143]
s_add_u32 s72, s71, 46080
ds_read_b128 a[200:203], v7 offset:2944
ds_read_b64 a[136:137], v6 offset:1408
v_mfma_f32_16x16x32_bf16 v[140:143], a[164:167], a[232:235], v[140:143]
buffer_load_dwordx4 v15, s[24:27], s72 offen offset:3072 lds
v_mfma_f32_16x16x32_bf16 v[140:143], a[160:163], a[236:239], v[140:143]
v_mfma_f32_16x16x32_bf16 v[144:147], a[160:163], a[240:243], v[144:147]
s_nop 0
ds_read_b64 a[138:139], v6 offset:1416
ds_read_b128 a[204:207], v7 offset:2432
v_mfma_f32_16x16x32_bf16 v[144:147], a[164:167], a[236:239], v[144:147]
v_mfma_f32_16x16x32_bf16 v[144:147], a[168:171], a[232:235], v[144:147]
s_nop 0
ds_read_b64 a[140:141], v6 offset:1920
ds_read_b64 a[142:143], v6 offset:1928
v_mfma_f32_16x16x32_bf16 v[144:147], a[172:175], a[228:231], v[144:147]
v_mfma_f32_16x16x32_bf16 v[144:147], a[176:179], a[224:227], v[144:147]
v_mfma_f32_16x16x32_bf16 v[148:151], a[180:183], a[224:227], v[148:151]
s_nop 0
ds_read_b128 a[208:211], v7 offset:1920
ds_read_b64 a[144:145], v6 offset:2432
v_mfma_f32_16x16x32_bf16 v[148:151], a[176:179], a[228:231], v[148:151]
v_mfma_f32_16x16x32_bf16 v[148:151], a[172:175], a[232:235], v[148:151]
s_waitcnt vmcnt(7)
v_cmp_gt_u32 vcc, 2, v3
s_or_b32 s81, vcc_lo, vcc_hi
s_cselect_b32 s81, 0x40000000, 0
v_or_b32 v4, s81, v1
v_mfma_f32_16x16x32_bf16 v[148:151], a[168:171], a[236:239], v[148:151]
s_nop 0
ds_read_b64 a[146:147], v6 offset:2440
ds_read_b128 a[212:215], v7 offset:1408
v_mfma_f32_16x16x32_bf16 v[148:151], a[164:167], a[240:243], v[148:151]
v_mfma_f32_16x16x32_bf16 v[148:151], a[160:163], a[244:247], v[148:151]
s_nop 0
ds_read_b64 a[148:149], v6 offset:2944
ds_read_b64 a[150:151], v6 offset:2952
v_mfma_f32_16x16x32_bf16 v[152:155], a[160:163], a[248:251], v[152:155]
v_mfma_f32_16x16x32_bf16 v[152:155], a[164:167], a[244:247], v[152:155]
s_lshr_b32 s69, s12, 18
v_mfma_f32_16x16x32_bf16 v[152:155], a[168:171], a[240:243], v[152:155]
s_lshl_b32 s69, s69, 12
ds_read_b128 a[216:219], v7 offset:896
ds_read_b64 a[152:153], v6 offset:3456
v_mfma_f32_16x16x32_bf16 v[152:155], a[172:175], a[236:239], v[152:155]
s_add_u32 s69, s69, s95
buffer_load_dwordx4 a[0:3], v4, s[44:47], s69 offen sc1
v_mfma_f32_16x16x32_bf16 v[152:155], a[176:179], a[232:235], v[152:155]
s_nop 0
ds_read_b64 a[154:155], v6 offset:3464
ds_read_b128 a[220:223], v7 offset:384
v_mfma_f32_16x16x32_bf16 v[152:155], a[180:183], a[228:231], v[152:155]
v_mfma_f32_16x16x32_bf16 v[152:155], a[184:187], a[224:227], v[152:155]
v_mfma_f32_16x16x32_bf16 v[156:159], a[188:191], a[224:227], v[156:159]
s_nop 0
ds_read_b64 a[156:157], v6 offset:3968
ds_read_b64 a[158:159], v6 offset:3976
v_mfma_f32_16x16x32_bf16 v[156:159], a[184:187], a[228:231], v[156:159]
buffer_load_dwordx4 a[4:7], v4, s[44:47], s69 offen offset:1024 sc1
v_mfma_f32_16x16x32_bf16 v[156:159], a[180:183], a[232:235], v[156:159]
v_mfma_f32_16x16x32_bf16 v[156:159], a[176:179], a[236:239], v[156:159]
v_mfma_f32_16x16x32_bf16 v[156:159], a[172:175], a[240:243], v[156:159]
v_mfma_f32_16x16x32_bf16 v[156:159], a[168:171], a[244:247], v[156:159]
buffer_load_dwordx4 a[8:11], v4, s[44:47], s69 offen offset:2048 sc1
v_mfma_f32_16x16x32_bf16 v[156:159], a[164:167], a[248:251], v[156:159]
v_mfma_f32_16x16x32_bf16 v[156:159], a[160:163], a[252:255], v[156:159]
s_waitcnt lgkmcnt(0)
v_mfma_f32_16x16x32_bf16 v[128:131], a[128:131], a[192:195], v[128:131]
s_nop 0
ds_read_b128 a[224:227], v7 offset:4032
ds_read_b64 a[160:161], v6 offset:448
v_mfma_f32_16x16x32_bf16 v[132:135], a[132:135], a[192:195], v[132:135]
v_mfma_f32_16x16x32_bf16 v[132:135], a[128:131], a[196:199], v[132:135]
s_nop 0
ds_read_b64 a[162:163], v6 offset:456
ds_read_b128 a[228:231], v7 offset:3520
v_mfma_f32_16x16x32_bf16 v[136:139], a[128:131], a[200:203], v[136:139]
buffer_load_dwordx4 a[12:15], v4, s[44:47], s69 offen offset:3072 sc1
v_mfma_f32_16x16x32_bf16 v[136:139], a[132:135], a[196:199], v[136:139]
v_mfma_f32_16x16x32_bf16 v[136:139], a[136:139], a[192:195], v[136:139]
s_nop 0
ds_read_b64 a[164:165], v6 offset:960
ds_read_b64 a[166:167], v6 offset:968
v_mfma_f32_16x16x32_bf16 v[140:143], a[140:143], a[192:195], v[140:143]
v_mfma_f32_16x16x32_bf16 v[140:143], a[136:139], a[196:199], v[140:143]
s_nop 0
ds_read_b128 a[232:235], v7 offset:3008
ds_read_b64 a[168:169], v6 offset:1472
v_mfma_f32_16x16x32_bf16 v[140:143], a[132:135], a[200:203], v[140:143]
s_add_u32 s69, s69, 0x20000
buffer_load_dwordx4 a[16:19], v4, s[44:47], s69 offen sc1
v_mfma_f32_16x16x32_bf16 v[140:143], a[128:131], a[204:207], v[140:143]
v_mfma_f32_16x16x32_bf16 v[144:147], a[128:131], a[208:211], v[144:147]
s_nop 0
ds_read_b64 a[170:171], v6 offset:1480
ds_read_b128 a[236:239], v7 offset:2496
v_mfma_f32_16x16x32_bf16 v[144:147], a[132:135], a[204:207], v[144:147]
v_mfma_f32_16x16x32_bf16 v[144:147], a[136:139], a[200:203], v[144:147]
s_nop 0
ds_read_b64 a[172:173], v6 offset:1984
ds_read_b64 a[174:175], v6 offset:1992
v_mfma_f32_16x16x32_bf16 v[144:147], a[140:143], a[196:199], v[144:147]
buffer_load_dwordx4 a[20:23], v4, s[44:47], s69 offen offset:1024 sc1
v_mfma_f32_16x16x32_bf16 v[144:147], a[144:147], a[192:195], v[144:147]
v_mfma_f32_16x16x32_bf16 v[148:151], a[148:151], a[192:195], v[148:151]
s_nop 0
ds_read_b128 a[240:243], v7 offset:1984
ds_read_b64 a[176:177], v6 offset:2496
v_mfma_f32_16x16x32_bf16 v[148:151], a[144:147], a[196:199], v[148:151]
v_mfma_f32_16x16x32_bf16 v[148:151], a[140:143], a[200:203], v[148:151]
v_mfma_f32_16x16x32_bf16 v[148:151], a[136:139], a[204:207], v[148:151]
s_nop 0
ds_read_b64 a[178:179], v6 offset:2504
ds_read_b128 a[244:247], v7 offset:1472
v_mfma_f32_16x16x32_bf16 v[148:151], a[132:135], a[208:211], v[148:151]
buffer_load_dwordx4 a[24:27], v4, s[44:47], s69 offen offset:2048 sc1
v_mfma_f32_16x16x32_bf16 v[148:151], a[128:131], a[212:215], v[148:151]
s_nop 0
ds_read_b64 a[180:181], v6 offset:3008
ds_read_b64 a[182:183], v6 offset:3016
v_mfma_f32_16x16x32_bf16 v[152:155], a[128:131], a[216:219], v[152:155]
v_mfma_f32_16x16x32_bf16 v[152:155], a[132:135], a[212:215], v[152:155]
v_mfma_f32_16x16x32_bf16 v[152:155], a[136:139], a[208:211], v[152:155]
s_nop 0
ds_read_b128 a[248:251], v7 offset:960
ds_read_b64 a[184:185], v6 offset:3520
v_mfma_f32_16x16x32_bf16 v[152:155], a[140:143], a[204:207], v[152:155]
buffer_load_dwordx4 a[28:31], v4, s[44:47], s69 offen offset:3072 sc1
v_mfma_f32_16x16x32_bf16 v[152:155], a[144:147], a[200:203], v[152:155]
s_nop 0
ds_read_b64 a[186:187], v6 offset:3528
ds_read_b128 a[252:255], v7 offset:448
v_mfma_f32_16x16x32_bf16 v[152:155], a[148:151], a[196:199], v[152:155]
v_mfma_f32_16x16x32_bf16 v[152:155], a[152:155], a[192:195], v[152:155]
s_lshr_b32 s69, s13, 18
v_mfma_f32_16x16x32_bf16 v[156:159], a[156:159], a[192:195], v[156:159]
s_lshl_b32 s69, s69, 12
ds_read_b64 a[188:189], v6 offset:4032
ds_read_b64 a[190:191], v6 offset:4040
v_mfma_f32_16x16x32_bf16 v[156:159], a[152:155], a[196:199], v[156:159]
s_add_u32 s69, s69, s95
buffer_load_dwordx4 a[32:35], v4, s[44:47], s69 offen sc1
v_mfma_f32_16x16x32_bf16 v[156:159], a[148:151], a[200:203], v[156:159]
v_mfma_f32_16x16x32_bf16 v[156:159], a[144:147], a[204:207], v[156:159]
v_mfma_f32_16x16x32_bf16 v[156:159], a[140:143], a[208:211], v[156:159]
v_mfma_f32_16x16x32_bf16 v[156:159], a[136:139], a[212:215], v[156:159]
buffer_load_dwordx4 a[36:39], v4, s[44:47], s69 offen offset:1024 sc1
v_mfma_f32_16x16x32_bf16 v[156:159], a[132:135], a[216:219], v[156:159]
v_mfma_f32_16x16x32_bf16 v[156:159], a[128:131], a[220:223], v[156:159]
s_waitcnt lgkmcnt(0)
v_mfma_f32_16x16x32_bf16 v[128:131], a[160:163], a[224:227], v[128:131]
s_nop 0
ds_read_b64_tr_b16 v[192:193], v8 offset:0
ds_read_b64_tr_b16 v[194:195], v8 offset:2048
v_mfma_f32_16x16x32_bf16 v[132:135], a[164:167], a[224:227], v[132:135]
v_mfma_f32_16x16x32_bf16 v[132:135], a[160:163], a[228:231], v[132:135]
s_nop 0
ds_read_b64_tr_b16 v[196:197], v9 offset:0
ds_read_b64_tr_b16 v[198:199], v9 offset:2048
v_mfma_f32_16x16x32_bf16 v[136:139], a[160:163], a[232:235], v[136:139]
buffer_load_dwordx4 a[40:43], v4, s[44:47], s69 offen offset:2048 sc1
v_mfma_f32_16x16x32_bf16 v[136:139], a[164:167], a[228:231], v[136:139]
s_nop 0
ds_read_b64_tr_b16 v[200:201], v10 offset:0
ds_read_b64_tr_b16 v[202:203], v10 offset:2048
v_mfma_f32_16x16x32_bf16 v[136:139], a[168:171], a[224:227], v[136:139]
v_mfma_f32_16x16x32_bf16 v[140:143], a[172:175], a[224:227], v[140:143]
s_nop 0
ds_read_b64_tr_b16 v[204:205], v11 offset:0
ds_read_b64_tr_b16 v[206:207], v11 offset:2048
v_mfma_f32_16x16x32_bf16 v[140:143], a[168:171], a[228:231], v[140:143]
v_cvt_pk_bf16_f32 v128, v128, v129
v_cvt_pk_bf16_f32 v129, v130, v131
v_cvt_pk_bf16_f32 v130, v132, v133
v_mfma_f32_16x16x32_bf16 v[140:143], a[164:167], a[232:235], v[140:143]
s_nop 0
ds_read_b64_tr_b16 v[208:209], v8 offset:4096
ds_read_b64_tr_b16 v[210:211], v8 offset:6144
v_cvt_pk_bf16_f32 v131, v134, v135
v_mfma_f32_16x16x32_bf16 v[140:143], a[160:163], a[236:239], v[140:143]
s_nop 0
buffer_load_dwordx4 a[44:47], v4, s[44:47], s69 offen offset:3072 sc1
v_permlane32_swap_b32 v128, v130
v_mfma_f32_16x16x32_bf16 v[144:147], a[160:163], a[240:243], v[144:147]
s_nop 0
ds_read_b64_tr_b16 v[212:213], v9 offset:4096
ds_read_b64_tr_b16 v[214:215], v9 offset:6144
v_permlane32_swap_b32 v129, v131
v_mfma_f32_16x16x32_bf16 v[144:147], a[164:167], a[236:239], v[144:147]
buffer_store_dwordx4 v[128:131], v166, s[44:47], s80 offen sc1
v_mfma_f32_16x16x32_bf16 v[144:147], a[168:171], a[232:235], v[144:147]
s_nop 0
ds_read_b64_tr_b16 v[216:217], v10 offset:4096
ds_read_b64_tr_b16 v[218:219], v10 offset:6144
v_mfma_f32_16x16x32_bf16 v[144:147], a[172:175], a[228:231], v[144:147]
s_add_u32 s69, s69, 0x20000
buffer_load_dwordx4 a[48:51], v4, s[44:47], s69 offen sc1
v_mfma_f32_16x16x32_bf16 v[144:147], a[176:179], a[224:227], v[144:147]
s_nop 0
ds_read_b64_tr_b16 v[220:221], v11 offset:4096
ds_read_b64_tr_b16 v[222:223], v11 offset:6144
v_cvt_pk_bf16_f32 v136, v136, v137
v_mfma_f32_16x16x32_bf16 v[148:151], a[180:183], a[224:227], v[148:151]
v_cvt_pk_bf16_f32 v137, v138, v139
v_cvt_pk_bf16_f32 v138, v140, v141
v_cvt_pk_bf16_f32 v139, v142, v143
v_mfma_f32_16x16x32_bf16 v[148:151], a[176:179], a[228:231], v[148:151]
s_nop 0
ds_read_b64_tr_b16 v[224:225], v8 offset:8192
ds_read_b64_tr_b16 v[226:227], v8 offset:10240
v_permlane32_swap_b32 v136, v138
v_mfma_f32_16x16x32_bf16 v[148:151], a[172:175], a[232:235], v[148:151]
v_permlane32_swap_b32 v137, v139
v_mfma_f32_16x16x32_bf16 v[148:151], a[168:171], a[236:239], v[148:151]
s_nop 0
ds_read_b64_tr_b16 v[228:229], v9 offset:8192
ds_read_b64_tr_b16 v[230:231], v9 offset:10240
v_mfma_f32_16x16x32_bf16 v[148:151], a[164:167], a[240:243], v[148:151]
buffer_load_dwordx4 a[52:55], v4, s[44:47], s69 offen offset:1024 sc1
v_mfma_f32_16x16x32_bf16 v[148:151], a[160:163], a[244:247], v[148:151]
s_nop 0
ds_read_b64_tr_b16 v[232:233], v10 offset:8192
ds_read_b64_tr_b16 v[234:235], v10 offset:10240
v_mfma_f32_16x16x32_bf16 v[152:155], a[160:163], a[248:251], v[152:155]
buffer_store_dwordx4 v[136:139], v166, s[44:47], s80 offen offset:1024 sc1
v_mfma_f32_16x16x32_bf16 v[152:155], a[164:167], a[244:247], v[152:155]
s_nop 0
ds_read_b64_tr_b16 v[236:237], v11 offset:8192
ds_read_b64_tr_b16 v[238:239], v11 offset:10240
v_mfma_f32_16x16x32_bf16 v[152:155], a[168:171], a[240:243], v[152:155]
buffer_load_dwordx4 a[56:59], v4, s[44:47], s69 offen offset:2048 sc1
v_mfma_f32_16x16x32_bf16 v[152:155], a[172:175], a[236:239], v[152:155]
s_nop 0
ds_read_b64_tr_b16 v[240:241], v8 offset:12288
ds_read_b64_tr_b16 v[242:243], v8 offset:14336
v_mfma_f32_16x16x32_bf16 v[152:155], a[176:179], a[232:235], v[152:155]
v_cvt_pk_bf16_f32 v144, v144, v145
v_cvt_pk_bf16_f32 v145, v146, v147
v_cvt_pk_bf16_f32 v146, v148, v149
v_mfma_f32_16x16x32_bf16 v[152:155], a[180:183], a[228:231], v[152:155]
s_nop 0
ds_read_b64_tr_b16 v[244:245], v9 offset:12288
ds_read_b64_tr_b16 v[246:247], v9 offset:14336
v_cvt_pk_bf16_f32 v147, v150, v151
v_mfma_f32_16x16x32_bf16 v[152:155], a[184:187], a[224:227], v[152:155]
v_permlane32_swap_b32 v144, v146
v_permlane32_swap_b32 v145, v147
v_mfma_f32_16x16x32_bf16 v[156:159], a[188:191], a[224:227], v[156:159]
s_nop 0
ds_read_b64_tr_b16 v[248:249], v10 offset:12288
ds_read_b64_tr_b16 v[250:251], v10 offset:14336
v_mfma_f32_16x16x32_bf16 v[156:159], a[184:187], a[228:231], v[156:159]
buffer_load_dwordx4 a[60:63], v4, s[44:47], s69 offen offset:3072 sc1
v_mfma_f32_16x16x32_bf16 v[156:159], a[180:183], a[232:235], v[156:159]
s_nop 0
ds_read_b64_tr_b16 v[252:253], v11 offset:12288
ds_read_b64_tr_b16 v[254:255], v11 offset:14336
v_mfma_f32_16x16x32_bf16 v[156:159], a[176:179], a[236:239], v[156:159]
buffer_store_dwordx4 v[144:147], v166, s[44:47], s80 offen offset:2048 sc1
v_mfma_f32_16x16x32_bf16 v[156:159], a[172:175], a[240:243], v[156:159]
v_mfma_f32_16x16x32_bf16 v[156:159], a[168:171], a[244:247], v[156:159]
v_mfma_f32_16x16x32_bf16 v[156:159], a[164:167], a[248:251], v[156:159]
v_mfma_f32_16x16x32_bf16 v[156:159], a[160:163], a[252:255], v[156:159]
v_cvt_pk_bf16_f32 v152, v152, v153
v_cvt_pk_bf16_f32 v153, v154, v155
s_nop 5
v_cvt_pk_bf16_f32 v154, v156, v157
v_cvt_pk_bf16_f32 v155, v158, v159
s_nop 0
v_permlane32_swap_b32 v152, v154
v_permlane32_swap_b32 v153, v155
buffer_store_dwordx4 v[152:155], v166, s[44:47], s80 offen offset:3072 sc1
s_waitcnt vmcnt(12) lgkmcnt(0)
s_cmp_lg_u32 s81, 0
s_cbranch_scc1 Lredo0
Lredo0b:
s_barrier
v_mfma_f32_16x16x32_bf16 v[16:19], v[192:195], a[0:3], 0
s_nop 0
ds_read_b64_tr_b16 v[128:129], v8 offset:16384
ds_read_b64_tr_b16 v[130:131], v8 offset:18432
v_mfma_f32_16x16x32_bf16 v[16:19], v[208:211], a[4:7], v[16:19]
s_xor_b32 s71, s13, 0x100
ds_read_b64_tr_b16 v[132:133], v9 offset:16384
ds_read_b64_tr_b16 v[134:135], v9 offset:18432
v_mfma_f32_16x16x32_bf16 v[16:19], v[224:227], a[8:11], v[16:19]
s_add_u32 m0, s85, 0
ds_read_b64_tr_b16 v[136:137], v10 offset:16384
ds_read_b64_tr_b16 v[138:139], v10 offset:18432
v_mfma_f32_16x16x32_bf16 v[16:19], v[240:243], a[12:15], v[16:19]
s_add_u32 s72, s71, 0
buffer_load_dwordx4 v15, s[24:27], s72 offen lds
v_mfma_f32_16x16x32_bf16 v[32:35], v[240:243], a[28:31], 0
s_lshr_b32 s69, s14, 18
ds_read_b64_tr_b16 v[140:141], v11 offset:16384
ds_read_b64_tr_b16 v[142:143], v11 offset:18432
v_mfma_f32_16x16x32_bf16 v[32:35], v[224:227], a[24:27], v[32:35]
s_lshl_b32 s69, s69, 12
v_add_u32 v4, s64, v1
v_add_u32 v4, 131072, v4
v_mfma_f32_16x16x32_bf16 v[32:35], v[208:211], a[20:23], v[32:35]
s_add_u32 s69, s69, s95
buffer_load_dwordx4 a[64:67], v1, s[44:47], s69 offen sc1
v_mfma_f32_16x16x32_bf16 v[32:35], v[192:195], a[16:19], v[32:35]
s_lshl_b32 s70, s75, 18
ds_read_b64_tr_b16 v[144:145], v8 offset:20480
ds_read_b64_tr_b16 v[146:147], v8 offset:22528
v_mfma_f32_16x16x32_bf16 v[36:39], v[196:199], a[16:19], 0
s_add_u32 s72, s71, 15360
buffer_load_dwordx4 v15, s[24:27], s72 offen offset:1024 lds
v_mfma_f32_16x16x32_bf16 v[36:39], v[212:215], a[20:23], v[36:39]
s_add_u32 s70, s70, s94
ds_read_b64_tr_b16 v[148:149], v9 offset:20480
ds_read_b64_tr_b16 v[150:151], v9 offset:22528
v_mfma_f32_16x16x32_bf16 v[36:39], v[228:231], a[24:27], v[36:39]
s_nop 0
ds_read_b64_tr_b16 v[152:153], v10 offset:20480
ds_read_b64_tr_b16 v[154:155], v10 offset:22528
v_mfma_f32_16x16x32_bf16 v[36:39], v[244:247], a[28:31], v[36:39]
s_nop 0
ds_read_b64_tr_b16 v[156:157], v11 offset:20480
ds_read_b64_tr_b16 v[158:159], v11 offset:22528
v_mfma_f32_16x16x32_bf16 v[20:23], v[244:247], a[12:15], 0
ds_write_b128 v4, v[80:83] offset:0
v_mfma_f32_16x16x32_bf16 v[20:23], v[228:231], a[8:11], v[20:23]
s_nop 0
ds_read_b64_tr_b16 v[160:161], v8 offset:24576
ds_read_b64_tr_b16 v[162:163], v8 offset:26624
v_mfma_f32_16x16x32_bf16 v[20:23], v[212:215], a[4:7], v[20:23]
s_add_u32 s72, s71, 30720
buffer_load_dwordx4 v15, s[24:27], s72 offen offset:2048 lds
v_mfma_f32_16x16x32_bf16 v[20:23], v[196:199], a[0:3], v[20:23]
buffer_load_dwordx4 a[68:71], v1, s[44:47], s69 offen offset:1024 sc1
v_mfma_f32_16x16x32_bf16 v[24:27], v[200:203], a[0:3], 0
s_nop 0
ds_read_b64_tr_b16 v[164:165], v9 offset:24576
ds_read_b64_tr_b16 v[166:167], v9 offset:26624
v_mfma_f32_16x16x32_bf16 v[24:27], v[216:219], a[4:7], v[24:27]
s_nop 0
ds_read_b64_tr_b16 v[168:169], v10 offset:24576
ds_read_b64_tr_b16 v[170:171], v10 offset:26624
v_mfma_f32_16x16x32_bf16 v[24:27], v[232:235], a[8:11], v[24:27]
s_nop 0
ds_read_b64_tr_b16 v[172:173], v11 offset:24576
ds_read_b64_tr_b16 v[174:175], v11 offset:26624
v_mfma_f32_16x16x32_bf16 v[24:27], v[248:251], a[12:15], v[24:27]
ds_write_b128 v4, v[84:87] offset:1024
v_mfma_f32_16x16x32_bf16 v[40:43], v[248:251], a[28:31], 0
s_add_u32 s72, s71, 46080
buffer_load_dwordx4 v15, s[24:27], s72 offen offset:3072 lds
v_mfma_f32_16x16x32_bf16 v[40:43], v[232:235], a[24:27], v[40:43]
s_nop 0
ds_read_b64_tr_b16 v[176:177], v8 offset:28672
ds_read_b64_tr_b16 v[178:179], v8 offset:30720
v_mfma_f32_16x16x32_bf16 v[40:43], v[216:219], a[20:23], v[40:43]
s_nop 0
ds_read_b64_tr_b16 v[180:181], v9 offset:28672
ds_read_b64_tr_b16 v[182:183], v9 offset:30720
v_mfma_f32_16x16x32_bf16 v[40:43], v[200:203], a[16:19], v[40:43]
s_nop 0
ds_read_b64_tr_b16 v[184:185], v10 offset:28672
ds_read_b64_tr_b16 v[186:187], v10 offset:30720
v_mfma_f32_16x16x32_bf16 v[44:47], v[204:207], a[16:19], 0
s_nop 0
ds_read_b64_tr_b16 v[188:189], v11 offset:28672
ds_read_b64_tr_b16 v[190:191], v11 offset:30720
v_mfma_f32_16x16x32_bf16 v[44:47], v[220:223], a[20:23], v[44:47]
buffer_load_dwordx4 a[72:75], v1, s[44:47], s69 offen offset:2048 sc1
v_mfma_f32_16x16x32_bf16 v[44:47], v[236:239], a[24:27], v[44:47]
ds_write_b128 v4, v[96:99] offset:2048
v_mfma_f32_16x16x32_bf16 v[44:47], v[252:255], a[28:31], v[44:47]
s_xor_b32 s71, s13, 0x180
v_mfma_f32_16x16x32_bf16 v[28:31], v[252:255], a[12:15], 0
s_add_u32 m0, s85, 16384
ds_write_b128 v4, v[100:103] offset:3072
v_mfma_f32_16x16x32_bf16 v[28:31], v[236:239], a[8:11], v[28:31]
s_add_u32 s72, s71, 0
v_mfma_f32_16x16x32_bf16 v[28:31], v[220:223], a[4:7], v[28:31]
s_waitcnt vmcnt(31) lgkmcnt(0)
buffer_load_dwordx4 v15, s[24:27], s72 offen lds
v_mfma_f32_16x16x32_bf16 v[28:31], v[204:207], a[0:3], v[28:31]
s_barrier
v_mfma_f32_16x16x32_bf16 v[48:51], v[128:131], a[0:3], 0
s_nop 0
ds_read_b64_tr_b16 v[192:193], v8 offset:32768
ds_read_b64_tr_b16 v[194:195], v8 offset:34816
v_mfma_f32_16x16x32_bf16 v[48:51], v[144:147], a[4:7], v[48:51]
s_nop 0
ds_read_b64_tr_b16 v[196:197], v9 offset:32768
ds_read_b64_tr_b16 v[198:199], v9 offset:34816
v_mfma_f32_16x16x32_bf16 v[48:51], v[160:163], a[8:11], v[48:51]
s_nop 0
ds_read_b64_tr_b16 v[200:201], v10 offset:32768
ds_read_b64_tr_b16 v[202:203], v10 offset:34816
v_mfma_f32_16x16x32_bf16 v[48:51], v[176:179], a[12:15], v[48:51]
s_add_u32 s72, s71, 15360
buffer_load_dwordx4 v15, s[24:27], s72 offen offset:1024 lds
v_mfma_f32_16x16x32_bf16 v[64:67], v[176:179], a[28:31], 0
buffer_load_dwordx4 a[76:79], v1, s[44:47], s69 offen offset:3072 sc1
v_mfma_f32_16x16x32_bf16 v[64:67], v[160:163], a[24:27], v[64:67]
s_nop 0
ds_read_b64_tr_b16 v[204:205], v11 offset:32768
ds_read_b64_tr_b16 v[206:207], v11 offset:34816
v_mfma_f32_16x16x32_bf16 v[64:67], v[144:147], a[20:23], v[64:67]
v_mfma_f32_16x16x32_bf16 v[64:67], v[128:131], a[16:19], v[64:67]
s_nop 0
ds_read_b64_tr_b16 v[208:209], v8 offset:36864
ds_read_b64_tr_b16 v[210:211], v8 offset:38912
v_mfma_f32_16x16x32_bf16 v[68:71], v[132:135], a[16:19], 0
s_nop 0
ds_read_b64_tr_b16 v[212:213], v9 offset:36864
ds_read_b64_tr_b16 v[214:215], v9 offset:38912
v_mfma_f32_16x16x32_bf16 v[68:71], v[148:151], a[20:23], v[68:71]
s_add_u32 s72, s71, 30720
buffer_load_dwordx4 v15, s[24:27], s72 offen offset:2048 lds
v_mfma_f32_16x16x32_bf16 v[68:71], v[164:167], a[24:27], v[68:71]
s_nop 0
ds_read_b64_tr_b16 v[216:217], v10 offset:36864
ds_read_b64_tr_b16 v[218:219], v10 offset:38912
v_mfma_f32_16x16x32_bf16 v[68:71], v[180:183], a[28:31], v[68:71]
s_nop 0
ds_read_b64_tr_b16 v[220:221], v11 offset:36864
ds_read_b64_tr_b16 v[222:223], v11 offset:38912
v_mfma_f32_16x16x32_bf16 v[52:55], v[180:183], a[12:15], 0
v_mfma_f32_16x16x32_bf16 v[52:55], v[164:167], a[8:11], v[52:55]
s_add_u32 s69, s69, 0x20000
buffer_load_dwordx4 a[80:83], v1, s[44:47], s69 offen sc1
v_mfma_f32_16x16x32_bf16 v[52:55], v[148:151], a[4:7], v[52:55]
s_nop 0
ds_read_b64_tr_b16 v[224:225], v8 offset:40960
ds_read_b64_tr_b16 v[226:227], v8 offset:43008
v_mfma_f32_16x16x32_bf16 v[52:55], v[132:135], a[0:3], v[52:55]
s_add_u32 s72, s71, 46080
buffer_load_dwordx4 v15, s[24:27], s72 offen offset:3072 lds
v_mfma_f32_16x16x32_bf16 v[56:59], v[136:139], a[0:3], 0
s_nop 0
ds_read_b64_tr_b16 v[228:229], v9 offset:40960
ds_read_b64_tr_b16 v[230:231], v9 offset:43008
v_mfma_f32_16x16x32_bf16 v[56:59], v[152:155], a[4:7], v[56:59]
s_nop 0
ds_read_b64_tr_b16 v[232:233], v10 offset:40960
ds_read_b64_tr_b16 v[234:235], v10 offset:43008
v_mfma_f32_16x16x32_bf16 v[56:59], v[168:171], a[8:11], v[56:59]
s_nop 0
ds_read_b64_tr_b16 v[236:237], v11 offset:40960
ds_read_b64_tr_b16 v[238:239], v11 offset:43008
v_mfma_f32_16x16x32_bf16 v[56:59], v[184:187], a[12:15], v[56:59]
v_mfma_f32_16x16x32_bf16 v[72:75], v[184:187], a[28:31], 0
s_nop 0
ds_read_b64_tr_b16 v[240:241], v8 offset:45056
ds_read_b64_tr_b16 v[242:243], v8 offset:47104
v_mfma_f32_16x16x32_bf16 v[72:75], v[168:171], a[24:27], v[72:75]
s_nop 0
ds_read_b64_tr_b16 v[244:245], v9 offset:45056
ds_read_b64_tr_b16 v[246:247], v9 offset:47104
v_mfma_f32_16x16x32_bf16 v[72:75], v[152:155], a[20:23], v[72:75]
s_nop 0
ds_read_b64_tr_b16 v[248:249], v10 offset:45056
ds_read_b64_tr_b16 v[250:251], v10 offset:47104
v_mfma_f32_16x16x32_bf16 v[72:75], v[136:139], a[16:19], v[72:75]
s_xor_b32 s71, s14, 0x80
buffer_load_dwordx4 a[84:87], v1, s[44:47], s69 offen offset:1024 sc1
v_mfma_f32_16x16x32_bf16 v[76:79], v[140:143], a[16:19], 0
s_add_u32 m0, s85, 32768
ds_read_b64_tr_b16 v[252:253], v11 offset:45056
ds_read_b64_tr_b16 v[254:255], v11 offset:47104
v_mfma_f32_16x16x32_bf16 v[76:79], v[156:159], a[20:23], v[76:79]
s_add_u32 s72, s71, 0
buffer_load_dwordx4 v15, s[24:27], s72 offen lds
v_mfma_f32_16x16x32_bf16 v[76:79], v[172:175], a[24:27], v[76:79]
v_mfma_f32_16x16x32_bf16 v[76:79], v[188:191], a[28:31], v[76:79]
v_mfma_f32_16x16x32_bf16 v[60:63], v[188:191], a[12:15], 0
v_mfma_f32_16x16x32_bf16 v[60:63], v[172:175], a[8:11], v[60:63]
s_add_u32 s72, s71, 15360
v_mfma_f32_16x16x32_bf16 v[60:63], v[156:159], a[4:7], v[60:63]
s_waitcnt vmcnt(35) lgkmcnt(0)
v_mfma_f32_16x16x32_bf16 v[60:63], v[140:143], a[0:3], v[60:63]
s_barrier
buffer_load_dwordx4 v15, s[24:27], s72 offen offset:1024 lds
v_mfma_f32_16x16x32_bf16 v[80:83], v[192:195], a[0:3], 0
s_nop 0
ds_read_b64_tr_b16 v[128:129], v8 offset:49152
ds_read_b64_tr_b16 v[130:131], v8 offset:51200
v_mfma_f32_16x16x32_bf16 v[80:83], v[208:211], a[4:7], v[80:83]
buffer_load_dwordx4 a[88:91], v1, s[44:47], s69 offen offset:2048 sc1
v_mfma_f32_16x16x32_bf16 v[80:83], v[224:227], a[8:11], v[80:83]
s_nop 0
ds_read_b64_tr_b16 v[132:133], v9 offset:49152
ds_read_b64_tr_b16 v[134:135], v9 offset:51200
v_mfma_f32_16x16x32_bf16 v[80:83], v[240:243], a[12:15], v[80:83]
s_nop 0
ds_read_b64_tr_b16 v[136:137], v10 offset:49152
ds_read_b64_tr_b16 v[138:139], v10 offset:51200
v_mfma_f32_16x16x32_bf16 v[96:99], v[240:243], a[28:31], 0
s_nop 0
ds_read_b64_tr_b16 v[140:141], v11 offset:49152
ds_read_b64_tr_b16 v[142:143], v11 offset:51200
v_mfma_f32_16x16x32_bf16 v[96:99], v[224:227], a[24:27], v[96:99]
s_add_u32 s72, s71, 30720
buffer_load_dwordx4 v15, s[24:27], s72 offen offset:2048 lds
v_mfma_f32_16x16x32_bf16 v[96:99], v[208:211], a[20:23], v[96:99]
v_mfma_f32_16x16x32_bf16 v[96:99], v[192:195], a[16:19], v[96:99]
s_nop 0
ds_read_b64_tr_b16 v[144:145], v8 offset:53248
ds_read_b64_tr_b16 v[146:147], v8 offset:55296
v_mfma_f32_16x16x32_bf16 v[100:103], v[196:199], a[16:19], 0
s_nop 0
ds_read_b64_tr_b16 v[148:149], v9 offset:53248
ds_read_b64_tr_b16 v[150:151], v9 offset:55296
v_mfma_f32_16x16x32_bf16 v[100:103], v[212:215], a[20:23], v[100:103]
s_nop 0
ds_read_b64_tr_b16 v[152:153], v10 offset:53248
ds_read_b64_tr_b16 v[154:155], v10 offset:55296
v_mfma_f32_16x16x32_bf16 v[100:103], v[228:231], a[24:27], v[100:103]
s_nop 0
ds_read_b64_tr_b16 v[156:157], v11 offset:53248
ds_read_b64_tr_b16 v[158:159], v11 offset:55296
v_mfma_f32_16x16x32_bf16 v[100:103], v[244:247], a[28:31], v[100:103]
s_add_u32 s72, s71, 46080
buffer_load_dwordx4 v15, s[24:27], s72 offen offset:3072 lds
v_mfma_f32_16x16x32_bf16 v[84:87], v[244:247], a[12:15], 0
buffer_load_dwordx4 a[92:95], v1, s[44:47], s69 offen offset:3072 sc1
v_mfma_f32_16x16x32_bf16 v[84:87], v[228:231], a[8:11], v[84:87]
v_mfma_f32_16x16x32_bf16 v[84:87], v[212:215], a[4:7], v[84:87]
s_nop 0
ds_read_b64_tr_b16 v[160:161], v8 offset:57344
ds_read_b64_tr_b16 v[162:163], v8 offset:59392
v_mfma_f32_16x16x32_bf16 v[84:87], v[196:199], a[0:3], v[84:87]
s_nop 0
ds_read_b64_tr_b16 v[164:165], v9 offset:57344
ds_read_b64_tr_b16 v[166:167], v9 offset:59392
v_mfma_f32_16x16x32_bf16 v[88:91], v[200:203], a[0:3], 0
s_nop 0
ds_read_b64_tr_b16 v[168:169], v10 offset:57344
ds_read_b64_tr_b16 v[170:171], v10 offset:59392
v_mfma_f32_16x16x32_bf16 v[88:91], v[216:219], a[4:7], v[88:91]
s_xor_b32 s82, s78, 16
ds_read_b64_tr_b16 v[172:173], v11 offset:57344
ds_read_b64_tr_b16 v[174:175], v11 offset:59392
v_mfma_f32_16x16x32_bf16 v[88:91], v[232:235], a[8:11], v[88:91]
s_lshl_b32 s82, s82, 10
v_mfma_f32_16x16x32_bf16 v[88:91], v[248:251], a[12:15], v[88:91]
s_xor_b32 s71, s14, 0x100
ds_read_b64_tr_b16 v[176:177], v8 offset:61440
ds_read_b64_tr_b16 v[178:179], v8 offset:63488
v_mfma_f32_16x16x32_bf16 v[104:107], v[248:251], a[28:31], 0
s_add_u32 m0, s85, 49152
ds_read_b64_tr_b16 v[180:181], v9 offset:61440
ds_read_b64_tr_b16 v[182:183], v9 offset:63488
v_mfma_f32_16x16x32_bf16 v[104:107], v[232:235], a[24:27], v[104:107]
s_add_u32 s72, s71, 0
buffer_load_dwordx4 v15, s[24:27], s72 offen lds
v_mfma_f32_16x16x32_bf16 v[104:107], v[216:219], a[20:23], v[104:107]
s_add_u32 s82, s82, s74
buffer_load_dword v3, v2, s[44:47], s82 offen sc1
v_mfma_f32_16x16x32_bf16 v[104:107], v[200:203], a[16:19], v[104:107]
s_nop 0
ds_read_b64_tr_b16 v[184:185], v10 offset:61440
ds_read_b64_tr_b16 v[186:187], v10 offset:63488
v_mfma_f32_16x16x32_bf16 v[108:111], v[204:207], a[16:19], 0
s_nop 0
ds_read_b64_tr_b16 v[188:189], v11 offset:61440
ds_read_b64_tr_b16 v[190:191], v11 offset:63488
v_mfma_f32_16x16x32_bf16 v[108:111], v[220:223], a[20:23], v[108:111]
Lstube0:
s_cbranch_execz Lstube4
v_mfma_f32_16x16x32_bf16 v[108:111], v[236:239], a[24:27], v[108:111]
s_add_u32 s72, s71, 15360
buffer_load_dwordx4 v15, s[24:27], s72 offen offset:1024 lds
v_mfma_f32_16x16x32_bf16 v[108:111], v[252:255], a[28:31], v[108:111]
s_lshr_b32 s69, s15, 18
v_mfma_f32_16x16x32_bf16 v[92:95], v[252:255], a[12:15], 0
s_lshl_b32 s69, s69, 12
v_xor_b32 v8, 0x10000, v8
v_mfma_f32_16x16x32_bf16 v[92:95], v[236:239], a[8:11], v[92:95]
s_add_u32 s69, s69, s95
v_xor_b32 v9, 0x10000, v9
v_mfma_f32_16x16x32_bf16 v[92:95], v[220:223], a[4:7], v[92:95]
s_waitcnt vmcnt(17) lgkmcnt(0)
v_xor_b32 v10, 0x10000, v10
v_mfma_f32_16x16x32_bf16 v[92:95], v[204:207], a[0:3], v[92:95]
s_barrier
buffer_load_dwordx4 a[96:99], v1, s[44:47], s69 offen sc1
v_xor_b32 v11, 0x10000, v11
v_mfma_f32_16x16x32_bf16 v[16:19], v[128:131], a[32:35], v[16:19]
s_add_u32 s72, s71, 30720
buffer_load_dwordx4 v15, s[24:27], s72 offen offset:2048 lds
v_mfma_f32_16x16x32_bf16 v[16:19], v[144:147], a[36:39], v[16:19]
s_nop 0
ds_read_b64_tr_b16 v[192:193], v8 offset:0
ds_read_b64_tr_b16 v[194:195], v8 offset:2048
v_mfma_f32_16x16x32_bf16 v[16:19], v[160:163], a[40:43], v[16:19]
s_nop 0
ds_read_b64_tr_b16 v[196:197], v9 offset:0
ds_read_b64_tr_b16 v[198:199], v9 offset:2048
v_mfma_f32_16x16x32_bf16 v[16:19], v[176:179], a[44:47], v[16:19]
s_nop 0
ds_read_b64_tr_b16 v[200:201], v10 offset:0
ds_read_b64_tr_b16 v[202:203], v10 offset:2048
v_mfma_f32_16x16x32_bf16 v[32:35], v[176:179], a[60:63], v[32:35]
s_nop 0
ds_read_b64_tr_b16 v[204:205], v11 offset:0
ds_read_b64_tr_b16 v[206:207], v11 offset:2048
v_mfma_f32_16x16x32_bf16 v[32:35], v[160:163], a[56:59], v[32:35]
v_or_b32 v112, s58, v0
v_mov_b32 v113, 3
v_mfma_f32_16x16x32_bf16 v[32:35], v[144:147], a[52:55], v[32:35]
s_add_u32 s72, s71, 46080
buffer_load_dwordx4 v15, s[24:27], s72 offen offset:3072 lds
v_mfma_f32_16x16x32_bf16 v[32:35], v[128:131], a[48:51], v[32:35]
s_nop 0
ds_read_b64_tr_b16 v[208:209], v8 offset:4096
ds_read_b64_tr_b16 v[210:211], v8 offset:6144
v_mfma_f32_16x16x32_bf16 v[36:39], v[132:135], a[48:51], v[36:39]
s_nop 0
ds_read_b64_tr_b16 v[212:213], v9 offset:4096
ds_read_b64_tr_b16 v[214:215], v9 offset:6144
v_mfma_f32_16x16x32_bf16 v[36:39], v[148:151], a[52:55], v[36:39]
buffer_load_dwordx4 a[100:103], v1, s[44:47], s69 offen offset:1024 sc1
v_mfma_f32_16x16x32_bf16 v[36:39], v[164:167], a[56:59], v[36:39]
s_nop 0
ds_read_b64_tr_b16 v[216:217], v10 offset:4096
ds_read_b64_tr_b16 v[218:219], v10 offset:6144
v_mfma_f32_16x16x32_bf16 v[36:39], v[180:183], a[60:63], v[36:39]
v_min_u32 v112, 1, v112
v_lshlrev_b32 v112, 30, v112
v_mfma_f32_16x16x32_bf16 v[20:23], v[180:183], a[44:47], v[20:23]
s_nop 0
ds_read_b64_tr_b16 v[220:221], v11 offset:4096
ds_read_b64_tr_b16 v[222:223], v11 offset:6144
v_mfma_f32_16x16x32_bf16 v[20:23], v[164:167], a[40:43], v[20:23]
s_nop 0
ds_read_b64_tr_b16 v[224:225], v8 offset:8192
ds_read_b64_tr_b16 v[226:227], v8 offset:10240
v_mfma_f32_16x16x32_bf16 v[20:23], v[148:151], a[36:39], v[20:23]
s_xor_b32 s71, s14, 0x180
ds_read_b64_tr_b16 v[228:229], v9 offset:8192
ds_read_b64_tr_b16 v[230:231], v9 offset:10240
v_mfma_f32_16x16x32_bf16 v[20:23], v[132:135], a[32:35], v[20:23]
s_add_u32 m0, s77, 0
buffer_store_dword v113, v112, s[44:47], s91 offen sc1
v_mfma_f32_16x16x32_bf16 v[24:27], v[136:139], a[32:35], v[24:27]
s_add_u32 s72, s71, 0
buffer_load_dwordx4 v15, s[24:27], s72 offen lds
v_mfma_f32_16x16x32_bf16 v[24:27], v[152:155], a[36:39], v[24:27]
s_nop 0
ds_read_b64_tr_b16 v[232:233], v10 offset:8192
ds_read_b64_tr_b16 v[234:235], v10 offset:10240
v_mfma_f32_16x16x32_bf16 v[24:27], v[168:171], a[40:43], v[24:27]
s_nop 0
ds_read_b64_tr_b16 v[236:237], v11 offset:8192
ds_read_b64_tr_b16 v[238:239], v11 offset:10240
v_mfma_f32_16x16x32_bf16 v[24:27], v[184:187], a[44:47], v[24:27]
buffer_load_dwordx4 a[104:107], v1, s[44:47], s69 offen offset:2048 sc1
v_mfma_f32_16x16x32_bf16 v[40:43], v[184:187], a[60:63], v[40:43]
s_nop 0
ds_read_b64_tr_b16 v[240:241], v8 offset:12288
ds_read_b64_tr_b16 v[242:243], v8 offset:14336
v_mfma_f32_16x16x32_bf16 v[40:43], v[168:171], a[56:59], v[40:43]
v_mfma_f32_16x16x32_bf16 v[40:43], v[152:155], a[52:55], v[40:43]
s_add_u32 s72, s71, 15360
buffer_load_dwordx4 v15, s[24:27], s72 offen offset:1024 lds
v_mfma_f32_16x16x32_bf16 v[40:43], v[136:139], a[48:51], v[40:43]
s_nop 0
ds_read_b64_tr_b16 v[244:245], v9 offset:12288
ds_read_b64_tr_b16 v[246:247], v9 offset:14336
v_mfma_f32_16x16x32_bf16 v[44:47], v[140:143], a[48:51], v[44:47]
s_nop 0
ds_read_b64_tr_b16 v[248:249], v10 offset:12288
ds_read_b64_tr_b16 v[250:251], v10 offset:14336
v_mfma_f32_16x16x32_bf16 v[44:47], v[156:159], a[52:55], v[44:47]
s_nop 0
ds_read_b64_tr_b16 v[252:253], v11 offset:12288
ds_read_b64_tr_b16 v[254:255], v11 offset:14336
v_mfma_f32_16x16x32_bf16 v[44:47], v[172:175], a[56:59], v[44:47]
v_mfma_f32_16x16x32_bf16 v[44:47], v[188:191], a[60:63], v[44:47]
v_mfma_f32_16x16x32_bf16 v[28:31], v[188:191], a[44:47], v[28:31]
s_add_u32 s72, s71, 30720
buffer_load_dwordx4 v15, s[24:27], s72 offen offset:2048 lds
v_mfma_f32_16x16x32_bf16 v[28:31], v[172:175], a[40:43], v[28:31]
buffer_load_dwordx4 a[108:111], v1, s[44:47], s69 offen offset:3072 sc1
v_mfma_f32_16x16x32_bf16 v[28:31], v[156:159], a[36:39], v[28:31]
s_waitcnt vmcnt(20) lgkmcnt(0)
v_mfma_f32_16x16x32_bf16 v[28:31], v[140:143], a[32:35], v[28:31]
s_barrier
v_mfma_f32_16x16x32_bf16 v[48:51], v[192:195], a[32:35], v[48:51]
s_nop 0
ds_read_b64_tr_b16 v[128:129], v8 offset:16384
ds_read_b64_tr_b16 v[130:131], v8 offset:18432
v_mfma_f32_16x16x32_bf16 v[48:51], v[208:211], a[36:39], v[48:51]
s_nop 0
ds_read_b64_tr_b16 v[132:133], v9 offset:16384
ds_read_b64_tr_b16 v[134:135], v9 offset:18432
v_mfma_f32_16x16x32_bf16 v[48:51], v[224:227], a[40:43], v[48:51]
s_add_u32 s72, s71, 46080
buffer_load_dwordx4 v15, s[24:27], s72 offen offset:3072 lds
v_mfma_f32_16x16x32_bf16 v[48:51], v[240:243], a[44:47], v[48:51]
s_nop 0
ds_read_b64_tr_b16 v[136:137], v10 offset:16384
ds_read_b64_tr_b16 v[138:139], v10 offset:18432
v_mfma_f32_16x16x32_bf16 v[64:67], v[240:243], a[60:63], v[64:67]
s_nop 0
ds_read_b64_tr_b16 v[140:141], v11 offset:16384
ds_read_b64_tr_b16 v[142:143], v11 offset:18432
v_mfma_f32_16x16x32_bf16 v[64:67], v[224:227], a[56:59], v[64:67]
v_and_b32 v120, 15, v0
v_lshrrev_b32 v121, 4, v0
v_mfma_f32_16x16x32_bf16 v[64:67], v[208:211], a[52:55], v[64:67]
s_nop 0
ds_read_b64_tr_b16 v[144:145], v8 offset:20480
ds_read_b64_tr_b16 v[146:147], v8 offset:22528
v_mfma_f32_16x16x32_bf16 v[64:67], v[192:195], a[48:51], v[64:67]
s_add_u32 s69, s69, 0x20000
buffer_load_dwordx4 a[112:115], v1, s[44:47], s69 offen sc1
v_mfma_f32_16x16x32_bf16 v[68:71], v[196:199], a[48:51], v[68:71]
s_nop 0
ds_read_b64_tr_b16 v[148:149], v9 offset:20480
ds_read_b64_tr_b16 v[150:151], v9 offset:22528
v_mfma_f32_16x16x32_bf16 v[68:71], v[212:215], a[52:55], v[68:71]
s_nop 0
ds_read_b64_tr_b16 v[152:153], v10 offset:20480
ds_read_b64_tr_b16 v[154:155], v10 offset:22528
v_mfma_f32_16x16x32_bf16 v[68:71], v[228:231], a[56:59], v[68:71]
s_xor_b32 s71, s15, 0x80
v_lshlrev_b32 v121, 2, v121
v_sub_u32 v120, v120, v121
v_mfma_f32_16x16x32_bf16 v[68:71], v[244:247], a[60:63], v[68:71]
s_add_u32 m0, s77, 16384
ds_read_b64_tr_b16 v[156:157], v11 offset:20480
ds_read_b64_tr_b16 v[158:159], v11 offset:22528
v_mfma_f32_16x16x32_bf16 v[52:55], v[244:247], a[44:47], v[52:55]
s_add_u32 s72, s71, 0
buffer_load_dwordx4 v15, s[24:27], s72 offen lds
v_mfma_f32_16x16x32_bf16 v[52:55], v[228:231], a[40:43], v[52:55]
s_nop 0
ds_read_b64_tr_b16 v[160:161], v8 offset:24576
ds_read_b64_tr_b16 v[162:163], v8 offset:26624
v_mfma_f32_16x16x32_bf16 v[52:55], v[212:215], a[36:39], v[52:55]
s_nop 0
ds_read_b64_tr_b16 v[164:165], v9 offset:24576
ds_read_b64_tr_b16 v[166:167], v9 offset:26624
v_mfma_f32_16x16x32_bf16 v[52:55], v[196:199], a[32:35], v[52:55]
v_min_u32 v120, 4, v120
v_lshlrev_b32 v120, 3, v120
v_mfma_f32_16x16x32_bf16 v[56:59], v[200:203], a[32:35], v[56:59]
s_nop 0
ds_read_b64_tr_b16 v[168:169], v10 offset:24576
ds_read_b64_tr_b16 v[170:171], v10 offset:26624
v_mfma_f32_16x16x32_bf16 v[56:59], v[216:219], a[36:39], v[56:59]
s_add_u32 s72, s71, 15360
buffer_load_dwordx4 v15, s[24:27], s72 offen offset:1024 lds
v_mfma_f32_16x16x32_bf16 v[56:59], v[232:235], a[40:43], v[56:59]
buffer_load_dwordx4 a[116:119], v1, s[44:47], s69 offen offset:1024 sc1
v_mfma_f32_16x16x32_bf16 v[56:59], v[248:251], a[44:47], v[56:59]
s_nop 0
ds_read_b64_tr_b16 v[172:173], v11 offset:24576
ds_read_b64_tr_b16 v[174:175], v11 offset:26624
v_mfma_f32_16x16x32_bf16 v[72:75], v[248:251], a[60:63], v[72:75]
s_nop 0
ds_read_b64_tr_b16 v[176:177], v8 offset:28672
ds_read_b64_tr_b16 v[178:179], v8 offset:30720
v_mfma_f32_16x16x32_bf16 v[72:75], v[232:235], a[56:59], v[72:75]
v_mov_b32 v122, 0x3f80
v_mov_b32 v123, 0
v_mfma_f32_16x16x32_bf16 v[72:75], v[216:219], a[52:55], v[72:75]
s_nop 0
ds_read_b64_tr_b16 v[180:181], v9 offset:28672
ds_read_b64_tr_b16 v[182:183], v9 offset:30720
v_mfma_f32_16x16x32_bf16 v[72:75], v[200:203], a[48:51], v[72:75]
s_add_u32 s72, s71, 30720
buffer_load_dwordx4 v15, s[24:27], s72 offen offset:2048 lds
v_mfma_f32_16x16x32_bf16 v[76:79], v[204:207], a[48:51], v[76:79]
s_nop 0
ds_read_b64_tr_b16 v[184:185], v10 offset:28672
ds_read_b64_tr_b16 v[186:187], v10 offset:30720
v_mfma_f32_16x16x32_bf16 v[76:79], v[220:223], a[52:55], v[76:79]
s_nop 0
ds_read_b64_tr_b16 v[188:189], v11 offset:28672
ds_read_b64_tr_b16 v[190:191], v11 offset:30720
v_mfma_f32_16x16x32_bf16 v[76:79], v[236:239], a[56:59], v[76:79]
v_lshlrev_b64 v[122:123], v120, v[122:123]
v_mov_b32 v126, 0
v_mfma_f32_16x16x32_bf16 v[76:79], v[252:255], a[60:63], v[76:79]
buffer_load_dwordx4 a[120:123], v1, s[44:47], s69 offen offset:2048 sc1
v_mfma_f32_16x16x32_bf16 v[60:63], v[252:255], a[44:47], v[60:63]
v_lshlrev_b64 v[122:123], v120, v[122:123]
v_mov_b32 v127, 0
v_mfma_f32_16x16x32_bf16 v[60:63], v[236:239], a[40:43], v[60:63]
s_add_u32 s72, s71, 46080
buffer_load_dwordx4 v15, s[24:27], s72 offen offset:3072 lds
v_mfma_f32_16x16x32_bf16 v[60:63], v[220:223], a[36:39], v[60:63]
s_waitcnt vmcnt(22) lgkmcnt(0)
v_mov_b32 v120, 0
v_mov_b32 v121, 0
v_mfma_f32_16x16x32_bf16 v[60:63], v[204:207], a[32:35], v[60:63]
s_barrier
v_mov_b32 v124, v122
v_mov_b32 v125, v123
v_mfma_f32_16x16x32_bf16 v[80:83], v[128:131], a[32:35], v[80:83]
s_nop 0
ds_read_b64_tr_b16 v[192:193], v8 offset:32768
ds_read_b64_tr_b16 v[194:195], v8 offset:34816
v_mfma_f32_16x16x32_bf16 v[80:83], v[144:147], a[36:39], v[80:83]
s_nop 0
ds_read_b64_tr_b16 v[196:197], v9 offset:32768
ds_read_b64_tr_b16 v[198:199], v9 offset:34816
v_mfma_f32_16x16x32_bf16 v[80:83], v[160:163], a[40:43], v[80:83]
s_nop 0
ds_read_b64_tr_b16 v[200:201], v10 offset:32768
ds_read_b64_tr_b16 v[202:203], v10 offset:34816
v_mfma_f32_16x16x32_bf16 v[80:83], v[176:179], a[44:47], v[80:83]
s_nop 0
ds_read_b64_tr_b16 v[204:205], v11 offset:32768
ds_read_b64_tr_b16 v[206:207], v11 offset:34816
v_mfma_f32_16x16x32_bf16 v[96:99], v[176:179], a[60:63], v[96:99]
v_mfma_f32_16x16x32_bf16 v[96:99], v[160:163], a[56:59], v[96:99]
s_xor_b32 s71, s15, 0x100
buffer_load_dwordx4 a[124:127], v1, s[44:47], s69 offen offset:3072 sc1
v_mfma_f32_16x16x32_bf16 v[96:99], v[144:147], a[52:55], v[96:99]
s_add_u32 m0, s77, 32768
ds_read_b64_tr_b16 v[208:209], v8 offset:36864
ds_read_b64_tr_b16 v[210:211], v8 offset:38912
v_mfma_f32_16x16x32_bf16 v[96:99], v[128:131], a[48:51], v[96:99]
s_add_u32 s72, s71, 0
buffer_load_dwordx4 v15, s[24:27], s72 offen lds
v_mfma_f32_16x16x32_bf16 v[100:103], v[132:135], a[48:51], v[100:103]
s_nop 0
ds_read_b64_tr_b16 v[212:213], v9 offset:36864
ds_read_b64_tr_b16 v[214:215], v9 offset:38912
v_mfma_f32_16x16x32_bf16 v[100:103], v[148:151], a[52:55], v[100:103]
s_nop 0
ds_read_b64_tr_b16 v[216:217], v10 offset:36864
ds_read_b64_tr_b16 v[218:219], v10 offset:38912
v_mfma_f32_16x16x32_bf16 v[100:103], v[164:167], a[56:59], v[100:103]
s_nop 0
ds_read_b64_tr_b16 v[220:221], v11 offset:36864
ds_read_b64_tr_b16 v[222:223], v11 offset:38912
v_mfma_f32_16x16x32_bf16 v[100:103], v[180:183], a[60:63], v[100:103]
v_mfma_f32_16x16x32_bf16 v[84:87], v[180:183], a[44:47], v[84:87]
s_nop 0
ds_read_b64_tr_b16 v[224:225], v8 offset:40960
ds_read_b64_tr_b16 v[226:227], v8 offset:43008
v_mfma_f32_16x16x32_bf16 v[84:87], v[164:167], a[40:43], v[84:87]
s_add_u32 s72, s71, 15360
buffer_load_dwordx4 v15, s[24:27], s72 offen offset:1024 lds
v_mfma_f32_16x16x32_bf16 v[84:87], v[148:151], a[36:39], v[84:87]
s_nop 0
ds_read_b64_tr_b16 v[228:229], v9 offset:40960
ds_read_b64_tr_b16 v[230:231], v9 offset:43008
v_mfma_f32_16x16x32_bf16 v[84:87], v[132:135], a[32:35], v[84:87]
s_waitcnt vmcnt(22)
v_cmp_gt_u32 vcc, 2, v3
s_cbranch_vccnz Lspin106
Lback107:
s_lshr_b32 s69, s12, 18
s_lshl_b32 s69, s69, 12
s_add_u32 s69, s69, s95
s_xor_b32 s69, s69, 0x10000
buffer_load_dwordx4 a[128:131], v1, s[44:47], s69 offen sc1
v_mfma_f32_16x16x32_bf16 v[88:91], v[136:139], a[32:35], v[88:91]
s_nop 0
ds_read_b64_tr_b16 v[232:233], v10 offset:40960
ds_read_b64_tr_b16 v[234:235], v10 offset:43008
v_mfma_f32_16x16x32_bf16 v[88:91], v[152:155], a[36:39], v[88:91]
s_nop 0
ds_read_b64_tr_b16 v[236:237], v11 offset:40960
ds_read_b64_tr_b16 v[238:239], v11 offset:43008
v_mfma_f32_16x16x32_bf16 v[88:91], v[168:171], a[40:43], v[88:91]
v_mfma_f32_16x16x32_bf16 v[88:91], v[184:187], a[44:47], v[88:91]
s_add_u32 s72, s71, 30720
buffer_load_dwordx4 v15, s[24:27], s72 offen offset:2048 lds
v_mfma_f32_16x16x32_bf16 v[104:107], v[184:187], a[60:63], v[104:107]
s_nop 0
ds_read_b64_tr_b16 v[240:241], v8 offset:45056
ds_read_b64_tr_b16 v[242:243], v8 offset:47104
v_mfma_f32_16x16x32_bf16 v[104:107], v[168:171], a[56:59], v[104:107]
s_nop 0
ds_read_b64_tr_b16 v[244:245], v9 offset:45056
ds_read_b64_tr_b16 v[246:247], v9 offset:47104
v_mfma_f32_16x16x32_bf16 v[104:107], v[152:155], a[52:55], v[104:107]
s_nop 0
ds_read_b64_tr_b16 v[248:249], v10 offset:45056
ds_read_b64_tr_b16 v[250:251], v10 offset:47104
v_mfma_f32_16x16x32_bf16 v[104:107], v[136:139], a[48:51], v[104:107]
s_nop 0
ds_read_b64_tr_b16 v[252:253], v11 offset:45056
ds_read_b64_tr_b16 v[254:255], v11 offset:47104
v_mfma_f32_16x16x32_bf16 v[108:111], v[140:143], a[48:51], v[108:111]
v_mfma_f32_16x16x32_bf16 v[108:111], v[156:159], a[52:55], v[108:111]
s_add_u32 s72, s71, 46080
buffer_load_dwordx4 v15, s[24:27], s72 offen offset:3072 lds
v_mfma_f32_16x16x32_bf16 v[108:111], v[172:175], a[56:59], v[108:111]
buffer_load_dwordx4 a[132:135], v1, s[44:47], s69 offen offset:1024 sc1
v_mfma_f32_16x16x32_bf16 v[108:111], v[188:191], a[60:63], v[108:111]
v_mfma_f32_16x16x32_bf16 v[92:95], v[188:191], a[44:47], v[92:95]
v_mfma_f32_16x16x32_bf16 v[92:95], v[172:175], a[40:43], v[92:95]
v_mfma_f32_16x16x32_bf16 v[92:95], v[156:159], a[36:39], v[92:95]
s_waitcnt vmcnt(22) lgkmcnt(0)
v_mfma_f32_16x16x32_bf16 v[92:95], v[140:143], a[32:35], v[92:95]
s_barrier
v_mfma_f32_16x16x32_bf16 v[16:19], v[192:195], a[64:67], v[16:19]
s_nop 0
ds_read_b64_tr_b16 v[128:129], v8 offset:49152
ds_read_b64_tr_b16 v[130:131], v8 offset:51200
v_mfma_f32_16x16x32_bf16 v[16:19], v[208:211], a[68:71], v[16:19]
s_xor_b32 s71, s15, 0x180
ds_read_b64_tr_b16 v[132:133], v9 offset:49152
ds_read_b64_tr_b16 v[134:135], v9 offset:51200
v_mfma_f32_16x16x32_bf16 v[16:19], v[224:227], a[72:75], v[16:19]
s_add_u32 m0, s77, 49152
ds_read_b64_tr_b16 v[136:137], v10 offset:49152
ds_read_b64_tr_b16 v[138:139], v10 offset:51200
v_mfma_f32_16x16x32_bf16 v[16:19], v[240:243], a[76:79], v[16:19]
s_add_u32 s72, s71, 0
buffer_load_dwordx4 v15, s[24:27], s72 offen lds
v_mfma_f32_16x16x32_bf16 v[32:35], v[240:243], a[92:95], v[32:35]
buffer_load_dwordx4 a[136:139], v1, s[44:47], s69 offen offset:2048 sc1
v_mfma_f32_16x16x32_bf16 v[32:35], v[224:227], a[88:91], v[32:35]
s_nop 0
ds_read_b64_tr_b16 v[140:141], v11 offset:49152
ds_read_b64_tr_b16 v[142:143], v11 offset:51200
v_mfma_f32_16x16x32_bf16 v[32:35], v[208:211], a[84:87], v[32:35]
v_mfma_f32_16x16x32_bf16 v[32:35], v[192:195], a[80:83], v[32:35]
s_nop 0
ds_read_b64_tr_b16 v[144:145], v8 offset:53248
ds_read_b64_tr_b16 v[146:147], v8 offset:55296
v_mfma_f32_16x16x32_bf16 v[36:39], v[196:199], a[80:83], v[36:39]
s_add_u32 s72, s71, 15360
buffer_load_dwordx4 v15, s[24:27], s72 offen offset:1024 lds
v_mfma_f32_16x16x32_bf16 v[36:39], v[212:215], a[84:87], v[36:39]
s_nop 0
ds_read_b64_tr_b16 v[148:149], v9 offset:53248
ds_read_b64_tr_b16 v[150:151], v9 offset:55296
v_mfma_f32_16x16x32_bf16 v[36:39], v[228:231], a[88:91], v[36:39]
s_nop 0
ds_read_b64_tr_b16 v[152:153], v10 offset:53248
ds_read_b64_tr_b16 v[154:155], v10 offset:55296
v_mfma_f32_16x16x32_bf16 v[36:39], v[244:247], a[92:95], v[36:39]
s_nop 0
ds_read_b64_tr_b16 v[156:157], v11 offset:53248
ds_read_b64_tr_b16 v[158:159], v11 offset:55296
v_mfma_f32_16x16x32_bf16 v[20:23], v[244:247], a[76:79], v[20:23]
v_mfma_f32_16x16x32_bf16 v[20:23], v[228:231], a[72:75], v[20:23]
buffer_load_dwordx4 a[140:143], v1, s[44:47], s69 offen offset:3072 sc1
v_mfma_f32_16x16x32_bf16 v[20:23], v[212:215], a[68:71], v[20:23]
s_add_u32 s72, s71, 30720
buffer_load_dwordx4 v15, s[24:27], s72 offen offset:2048 lds
v_mfma_f32_16x16x32_bf16 v[20:23], v[196:199], a[64:67], v[20:23]
s_nop 0
ds_read_b64_tr_b16 v[160:161], v8 offset:57344
ds_read_b64_tr_b16 v[162:163], v8 offset:59392
v_mfma_f32_16x16x32_bf16 v[24:27], v[200:203], a[64:67], v[24:27]
s_nop 0
ds_read_b64_tr_b16 v[164:165], v9 offset:57344
ds_read_b64_tr_b16 v[166:167], v9 offset:59392
v_mfma_f32_16x16x32_bf16 v[24:27], v[216:219], a[68:71], v[24:27]
s_nop 0
ds_read_b64_tr_b16 v[168:169], v10 offset:57344
ds_read_b64_tr_b16 v[170:171], v10 offset:59392
v_mfma_f32_16x16x32_bf16 v[24:27], v[232:235], a[72:75], v[24:27]
s_nop 0
ds_read_b64_tr_b16 v[172:173], v11 offset:57344
ds_read_b64_tr_b16 v[174:175], v11 offset:59392
v_mfma_f32_16x16x32_bf16 v[24:27], v[248:251], a[76:79], v[24:27]
v_mfma_f32_16x16x32_bf16 v[40:43], v[248:251], a[92:95], v[40:43]
s_add_u32 s72, s71, 46080
buffer_load_dwordx4 v15, s[24:27], s72 offen offset:3072 lds
v_mfma_f32_16x16x32_bf16 v[40:43], v[232:235], a[88:91], v[40:43]
s_nop 0
ds_read_b64_tr_b16 v[176:177], v8 offset:61440
ds_read_b64_tr_b16 v[178:179], v8 offset:63488
v_mfma_f32_16x16x32_bf16 v[40:43], v[216:219], a[84:87], v[40:43]
s_nop 0
ds_read_b64_tr_b16 v[180:181], v9 offset:61440
ds_read_b64_tr_b16 v[182:183], v9 offset:63488
v_mfma_f32_16x16x32_bf16 v[40:43], v[200:203], a[80:83], v[40:43]
s_add_u32 s69, s69, 0x20000
buffer_load_dwordx4 a[144:147], v1, s[44:47], s69 offen sc1
v_mfma_f32_16x16x32_bf16 v[44:47], v[204:207], a[80:83], v[44:47]
s_nop 0
ds_read_b64_tr_b16 v[184:185], v10 offset:61440
ds_read_b64_tr_b16 v[186:187], v10 offset:63488
v_mfma_f32_16x16x32_bf16 v[44:47], v[220:223], a[84:87], v[44:47]
s_nop 0
ds_read_b64_tr_b16 v[188:189], v11 offset:61440
ds_read_b64_tr_b16 v[190:191], v11 offset:63488
v_mfma_f32_16x16x32_bf16 v[44:47], v[236:239], a[88:91], v[44:47]
v_mfma_f32_16x16x32_bf16 v[44:47], v[252:255], a[92:95], v[44:47]
s_xor_b32 s71, s12, 0x400080
v_mfma_f32_16x16x32_bf16 v[28:31], v[252:255], a[76:79], v[28:31]
s_add_u32 m0, s85, 0
v_xor_b32 v8, 0x10000, v8
v_mfma_f32_16x16x32_bf16 v[28:31], v[236:239], a[72:75], v[28:31]
s_add_u32 s72, s71, 0
v_xor_b32 v9, 0x10000, v9
v_mfma_f32_16x16x32_bf16 v[28:31], v[220:223], a[68:71], v[28:31]
s_waitcnt vmcnt(21) lgkmcnt(0)
buffer_load_dwordx4 v15, s[24:27], s72 offen lds
v_xor_b32 v10, 0x10000, v10
v_mfma_f32_16x16x32_bf16 v[28:31], v[204:207], a[64:67], v[28:31]
s_barrier
v_xor_b32 v11, 0x10000, v11
v_mfma_f32_16x16x32_bf16 v[48:51], v[128:131], a[64:67], v[48:51]
s_nop 0
ds_read_b64_tr_b16 v[192:193], v8 offset:0
ds_read_b64_tr_b16 v[194:195], v8 offset:2048
v_mfma_f32_16x16x32_bf16 v[48:51], v[144:147], a[68:71], v[48:51]
buffer_load_dwordx4 a[148:151], v1, s[44:47], s69 offen offset:1024 sc1
v_mfma_f32_16x16x32_bf16 v[48:51], v[160:163], a[72:75], v[48:51]
s_nop 0
ds_read_b64_tr_b16 v[196:197], v9 offset:0
ds_read_b64_tr_b16 v[198:199], v9 offset:2048
v_mfma_f32_16x16x32_bf16 v[48:51], v[176:179], a[76:79], v[48:51]
s_add_u32 s72, s71, 15360
buffer_load_dwordx4 v15, s[24:27], s72 offen offset:1024 lds
v_mfma_f32_16x16x32_bf16 v[64:67], v[176:179], a[92:95], v[64:67]
s_nop 0
ds_read_b64_tr_b16 v[200:201], v10 offset:0
ds_read_b64_tr_b16 v[202:203], v10 offset:2048
v_mfma_f32_16x16x32_bf16 v[64:67], v[160:163], a[88:91], v[64:67]
s_nop 0
ds_read_b64_tr_b16 v[204:205], v11 offset:0
ds_read_b64_tr_b16 v[206:207], v11 offset:2048
v_mfma_f32_16x16x32_bf16 v[64:67], v[144:147], a[84:87], v[64:67]
v_mfma_f32_16x16x32_bf16 v[64:67], v[128:131], a[80:83], v[64:67]
s_nop 0
ds_read_b64_tr_b16 v[208:209], v8 offset:4096
ds_read_b64_tr_b16 v[210:211], v8 offset:6144
v_mfma_f32_16x16x32_bf16 v[68:71], v[132:135], a[80:83], v[68:71]
s_nop 0
ds_read_b64_tr_b16 v[212:213], v9 offset:4096
ds_read_b64_tr_b16 v[214:215], v9 offset:6144
v_mfma_f32_16x16x32_bf16 v[68:71], v[148:151], a[84:87], v[68:71]
s_add_u32 s72, s71, 30720
buffer_load_dwordx4 v15, s[24:27], s72 offen offset:2048 lds
v_mfma_f32_16x16x32_bf16 v[68:71], v[164:167], a[88:91], v[68:71]
s_nop 0
ds_read_b64_tr_b16 v[216:217], v10 offset:4096
ds_read_b64_tr_b16 v[218:219], v10 offset:6144
v_mfma_f32_16x16x32_bf16 v[68:71], v[180:183], a[92:95], v[68:71]
buffer_load_dwordx4 a[152:155], v1, s[44:47], s69 offen offset:2048 sc1
v_mfma_f32_16x16x32_bf16 v[52:55], v[180:183], a[76:79], v[52:55]
s_nop 0
ds_read_b64_tr_b16 v[220:221], v11 offset:4096
ds_read_b64_tr_b16 v[222:223], v11 offset:6144
v_mfma_f32_16x16x32_bf16 v[52:55], v[164:167], a[72:75], v[52:55]
v_mfma_f32_16x16x32_bf16 v[52:55], v[148:151], a[68:71], v[52:55]
s_nop 0
ds_read_b64_tr_b16 v[224:225], v8 offset:8192
ds_read_b64_tr_b16 v[226:227], v8 offset:10240
v_mfma_f32_16x16x32_bf16 v[52:55], v[132:135], a[64:67], v[52:55]
s_add_u32 s72, s71, 46080
buffer_load_dwordx4 v15, s[24:27], s72 offen offset:3072 lds
v_mfma_f32_16x16x32_bf16 v[56:59], v[136:139], a[64:67], v[56:59]
s_nop 0
ds_read_b64_tr_b16 v[228:229], v9 offset:8192
ds_read_b64_tr_b16 v[230:231], v9 offset:10240
v_mfma_f32_16x16x32_bf16 v[56:59], v[152:155], a[68:71], v[56:59]
s_nop 0
ds_read_b64_tr_b16 v[232:233], v10 offset:8192
ds_read_b64_tr_b16 v[234:235], v10 offset:10240
v_mfma_f32_16x16x32_bf16 v[56:59], v[168:171], a[72:75], v[56:59]
s_nop 0
ds_read_b64_tr_b16 v[236:237], v11 offset:8192
ds_read_b64_tr_b16 v[238:239], v11 offset:10240
v_mfma_f32_16x16x32_bf16 v[56:59], v[184:187], a[76:79], v[56:59]
v_mfma_f32_16x16x32_bf16 v[72:75], v[184:187], a[92:95], v[72:75]
s_nop 0
ds_read_b64_tr_b16 v[240:241], v8 offset:12288
ds_read_b64_tr_b16 v[242:243], v8 offset:14336
v_mfma_f32_16x16x32_bf16 v[72:75], v[168:171], a[88:91], v[72:75]
buffer_load_dwordx4 a[156:159], v1, s[44:47], s69 offen offset:3072 sc1
v_mfma_f32_16x16x32_bf16 v[72:75], v[152:155], a[84:87], v[72:75]
s_lshr_b32 s69, s13, 18
ds_read_b64_tr_b16 v[244:245], v9 offset:12288
ds_read_b64_tr_b16 v[246:247], v9 offset:14336
v_mfma_f32_16x16x32_bf16 v[72:75], v[136:139], a[80:83], v[72:75]
s_xor_b32 s71, s12, 0x400100
ds_read_b64_tr_b16 v[248:249], v10 offset:12288
ds_read_b64_tr_b16 v[250:251], v10 offset:14336
v_mfma_f32_16x16x32_bf16 v[76:79], v[140:143], a[80:83], v[76:79]
s_add_u32 m0, s85, 16384
ds_read_b64_tr_b16 v[252:253], v11 offset:12288
ds_read_b64_tr_b16 v[254:255], v11 offset:14336
v_mfma_f32_16x16x32_bf16 v[76:79], v[156:159], a[84:87], v[76:79]
s_add_u32 s72, s71, 0
buffer_load_dwordx4 v15, s[24:27], s72 offen lds
v_mfma_f32_16x16x32_bf16 v[76:79], v[172:175], a[88:91], v[76:79]
s_lshl_b32 s69, s69, 12
v_mfma_f32_16x16x32_bf16 v[76:79], v[188:191], a[92:95], v[76:79]
s_add_u32 s69, s69, s95
v_mfma_f32_16x16x32_bf16 v[60:63], v[188:191], a[76:79], v[60:63]
s_xor_b32 s69, s69, 0x10000
v_mfma_f32_16x16x32_bf16 v[60:63], v[172:175], a[72:75], v[60:63]
s_add_u32 s72, s71, 15360
v_mfma_f32_16x16x32_bf16 v[60:63], v[156:159], a[68:71], v[60:63]
s_waitcnt vmcnt(22) lgkmcnt(0)
buffer_load_dwordx4 a[160:163], v1, s[44:47], s69 offen sc1
v_mfma_f32_16x16x32_bf16 v[60:63], v[140:143], a[64:67], v[60:63]
s_barrier
buffer_load_dwordx4 v15, s[24:27], s72 offen offset:1024 lds
v_mfma_f32_16x16x32_bf16 v[80:83], v[192:195], a[64:67], v[80:83]
s_and_b32 s79, s91, 0xffffcfff
v_lshlrev_b32 v13, 2, v2
buffer_load_dword v14, v13, s[44:47], s79 offen sc1
v_mfma_f32_16x16x32_bf16 v[80:83], v[208:211], a[68:71], v[80:83]
s_nop 0
ds_read_b64_tr_b16 v[128:129], v8 offset:16384
ds_read_b64_tr_b16 v[130:131], v8 offset:18432
v_mfma_f32_16x16x32_bf16 v[80:83], v[224:227], a[72:75], v[80:83]
s_nop 0
ds_read_b64_tr_b16 v[132:133], v9 offset:16384
ds_read_b64_tr_b16 v[134:135], v9 offset:18432
v_mfma_f32_16x16x32_bf16 v[80:83], v[240:243], a[76:79], v[80:83]
s_nop 0
ds_read_b64_tr_b16 v[136:137], v10 offset:16384
ds_read_b64_tr_b16 v[138:139], v10 offset:18432
v_mfma_f32_16x16x32_bf16 v[96:99], v[240:243], a[92:95], v[96:99]
s_nop 0
ds_read_b64_tr_b16 v[140:141], v11 offset:16384
ds_read_b64_tr_b16 v[142:143], v11 offset:18432
v_mfma_f32_16x16x32_bf16 v[96:99], v[224:227], a[88:91], v[96:99]
s_add_u32 s72, s71, 30720
buffer_load_dwordx4 v15, s[24:27], s72 offen offset:2048 lds
v_mfma_f32_16x16x32_bf16 v[96:99], v[208:211], a[84:87], v[96:99]
v_mfma_f32_16x16x32_bf16 v[96:99], v[192:195], a[80:83], v[96:99]
s_nop 0
ds_read_b64_tr_b16 v[144:145], v8 offset:20480
ds_read_b64_tr_b16 v[146:147], v8 offset:22528
v_mfma_f32_16x16x32_bf16 v[100:103], v[196:199], a[80:83], v[100:103]
buffer_load_dwordx4 a[164:167], v1, s[44:47], s69 offen offset:1024 sc1
v_mfma_f32_16x16x32_bf16 v[100:103], v[212:215], a[84:87], v[100:103]
s_nop 0
ds_read_b64_tr_b16 v[148:149], v9 offset:20480
ds_read_b64_tr_b16 v[150:151], v9 offset:22528
v_mfma_f32_16x16x32_bf16 v[100:103], v[228:231], a[88:91], v[100:103]
s_nop 0
ds_read_b64_tr_b16 v[152:153], v10 offset:20480
ds_read_b64_tr_b16 v[154:155], v10 offset:22528
v_mfma_f32_16x16x32_bf16 v[100:103], v[244:247], a[92:95], v[100:103]
s_add_u32 s72, s71, 46080
buffer_load_dwordx4 v15, s[24:27], s72 offen offset:3072 lds
v_mfma_f32_16x16x32_bf16 v[84:87], v[244:247], a[76:79], v[84:87]
s_nop 0
ds_read_b64_tr_b16 v[156:157], v11 offset:20480
ds_read_b64_tr_b16 v[158:159], v11 offset:22528
v_mfma_f32_16x16x32_bf16 v[84:87], v[228:231], a[72:75], v[84:87]
Lstube1:
s_cbranch_execz Lstube5
v_mfma_f32_16x16x32_bf16 v[84:87], v[212:215], a[68:71], v[84:87]
s_nop 0
ds_read_b64_tr_b16 v[160:161], v8 offset:24576
ds_read_b64_tr_b16 v[162:163], v8 offset:26624
v_mfma_f32_16x16x32_bf16 v[84:87], v[196:199], a[64:67], v[84:87]
s_nop 0
ds_read_b64_tr_b16 v[164:165], v9 offset:24576
ds_read_b64_tr_b16 v[166:167], v9 offset:26624
v_mfma_f32_16x16x32_bf16 v[88:91], v[200:203], a[64:67], v[88:91]
s_nop 0
ds_read_b64_tr_b16 v[168:169], v10 offset:24576
ds_read_b64_tr_b16 v[170:171], v10 offset:26624
v_mfma_f32_16x16x32_bf16 v[88:91], v[216:219], a[68:71], v[88:91]
s_nop 0
ds_read_b64_tr_b16 v[172:173], v11 offset:24576
ds_read_b64_tr_b16 v[174:175], v11 offset:26624
v_mfma_f32_16x16x32_bf16 v[88:91], v[232:235], a[72:75], v[88:91]
buffer_load_dwordx4 a[168:171], v1, s[44:47], s69 offen offset:2048 sc1
v_mfma_f32_16x16x32_bf16 v[88:91], v[248:251], a[76:79], v[88:91]
s_xor_b32 s71, s12, 0x400180
v_mfma_f32_16x16x32_bf16 v[104:107], v[248:251], a[92:95], v[104:107]
s_add_u32 m0, s85, 32768
ds_read_b64_tr_b16 v[176:177], v8 offset:28672
ds_read_b64_tr_b16 v[178:179], v8 offset:30720
v_mfma_f32_16x16x32_bf16 v[104:107], v[232:235], a[88:91], v[104:107]
s_add_u32 s72, s71, 0
buffer_load_dwordx4 v15, s[24:27], s72 offen lds
v_mfma_f32_16x16x32_bf16 v[104:107], v[216:219], a[84:87], v[104:107]
s_nop 0
ds_read_b64_tr_b16 v[180:181], v9 offset:28672
ds_read_b64_tr_b16 v[182:183], v9 offset:30720
v_mfma_f32_16x16x32_bf16 v[104:107], v[200:203], a[80:83], v[104:107]
s_nop 0
ds_read_b64_tr_b16 v[184:185], v10 offset:28672
ds_read_b64_tr_b16 v[186:187], v10 offset:30720
v_mfma_f32_16x16x32_bf16 v[108:111], v[204:207], a[80:83], v[108:111]
s_nop 0
ds_read_b64_tr_b16 v[188:189], v11 offset:28672
ds_read_b64_tr_b16 v[190:191], v11 offset:30720
v_mfma_f32_16x16x32_bf16 v[108:111], v[220:223], a[84:87], v[108:111]
v_mfma_f32_16x16x32_bf16 v[108:111], v[236:239], a[88:91], v[108:111]
s_add_u32 s72, s71, 15360
buffer_load_dwordx4 v15, s[24:27], s72 offen offset:1024 lds
v_mfma_f32_16x16x32_bf16 v[108:111], v[252:255], a[92:95], v[108:111]
v_mfma_f32_16x16x32_bf16 v[92:95], v[252:255], a[76:79], v[92:95]
buffer_load_dwordx4 a[172:175], v1, s[44:47], s69 offen offset:3072 sc1
v_mfma_f32_16x16x32_bf16 v[92:95], v[236:239], a[72:75], v[92:95]
v_mfma_f32_16x16x32_bf16 v[92:95], v[220:223], a[68:71], v[92:95]
s_waitcnt vmcnt(26) lgkmcnt(0)
v_mfma_f32_16x16x32_bf16 v[92:95], v[204:207], a[64:67], v[92:95]
s_barrier
v_mfma_f32_16x16x32_bf16 v[16:19], v[128:131], a[96:99], v[16:19]
s_add_u32 s72, s71, 30720
buffer_load_dwordx4 v15, s[24:27], s72 offen offset:2048 lds
v_mfma_f32_16x16x32_bf16 v[16:19], v[144:147], a[100:103], v[16:19]
s_nop 0
ds_read_b64_tr_b16 v[192:193], v8 offset:32768
ds_read_b64_tr_b16 v[194:195], v8 offset:34816
v_mfma_f32_16x16x32_bf16 v[16:19], v[160:163], a[104:107], v[16:19]
s_nop 0
ds_read_b64_tr_b16 v[196:197], v9 offset:32768
ds_read_b64_tr_b16 v[198:199], v9 offset:34816
v_mfma_f32_16x16x32_bf16 v[16:19], v[176:179], a[108:111], v[16:19]
s_nop 0
ds_read_b64_tr_b16 v[200:201], v10 offset:32768
ds_read_b64_tr_b16 v[202:203], v10 offset:34816
v_mfma_f32_16x16x32_bf16 v[32:35], v[176:179], a[124:127], v[32:35]
s_nop 0
ds_read_b64_tr_b16 v[204:205], v11 offset:32768
ds_read_b64_tr_b16 v[206:207], v11 offset:34816
v_mfma_f32_16x16x32_bf16 v[32:35], v[160:163], a[120:123], v[32:35]
v_mfma_f32_16x16x32_bf16 v[32:35], v[144:147], a[116:119], v[32:35]
s_add_u32 s72, s71, 46080
buffer_load_dwordx4 v15, s[24:27], s72 offen offset:3072 lds
v_mfma_f32_16x16x32_bf16 v[32:35], v[128:131], a[112:115], v[32:35]
s_add_u32 s69, s69, 0x20000
buffer_load_dwordx4 a[176:179], v1, s[44:47], s69 offen sc1
v_mfma_f32_16x16x32_bf16 v[36:39], v[132:135], a[112:115], v[36:39]
s_nop 0
ds_read_b64_tr_b16 v[208:209], v8 offset:36864
ds_read_b64_tr_b16 v[210:211], v8 offset:38912
v_mfma_f32_16x16x32_bf16 v[36:39], v[148:151], a[116:119], v[36:39]
s_nop 0
ds_read_b64_tr_b16 v[212:213], v9 offset:36864
ds_read_b64_tr_b16 v[214:215], v9 offset:38912
v_mfma_f32_16x16x32_bf16 v[36:39], v[164:167], a[120:123], v[36:39]
s_nop 0
ds_read_b64_tr_b16 v[216:217], v10 offset:36864
ds_read_b64_tr_b16 v[218:219], v10 offset:38912
v_mfma_f32_16x16x32_bf16 v[36:39], v[180:183], a[124:127], v[36:39]
s_nop 0
ds_read_b64_tr_b16 v[220:221], v11 offset:36864
ds_read_b64_tr_b16 v[222:223], v11 offset:38912
v_mfma_f32_16x16x32_bf16 v[20:23], v[180:183], a[108:111], v[20:23]
v_mfma_f32_16x16x32_bf16 v[20:23], v[164:167], a[104:107], v[20:23]
s_nop 0
ds_read_b64_tr_b16 v[224:225], v8 offset:40960
ds_read_b64_tr_b16 v[226:227], v8 offset:43008
v_mfma_f32_16x16x32_bf16 v[20:23], v[148:151], a[100:103], v[20:23]
s_xor_b32 s71, s13, 0x400080
ds_read_b64_tr_b16 v[228:229], v9 offset:40960
ds_read_b64_tr_b16 v[230:231], v9 offset:43008
v_mfma_f32_16x16x32_bf16 v[20:23], v[132:135], a[96:99], v[20:23]
s_add_u32 m0, s85, 49152
ds_read_b64_tr_b16 v[232:233], v10 offset:40960
ds_read_b64_tr_b16 v[234:235], v10 offset:43008
v_mfma_f32_16x16x32_bf16 v[24:27], v[136:139], a[96:99], v[24:27]
s_add_u32 s72, s71, 0
buffer_load_dwordx4 v15, s[24:27], s72 offen lds
v_mfma_f32_16x16x32_bf16 v[24:27], v[152:155], a[100:103], v[24:27]
buffer_load_dwordx4 a[180:183], v1, s[44:47], s69 offen offset:1024 sc1
v_mfma_f32_16x16x32_bf16 v[24:27], v[168:171], a[104:107], v[24:27]
s_nop 0
ds_read_b64_tr_b16 v[236:237], v11 offset:40960
ds_read_b64_tr_b16 v[238:239], v11 offset:43008
v_mfma_f32_16x16x32_bf16 v[24:27], v[184:187], a[108:111], v[24:27]
v_mfma_f32_16x16x32_bf16 v[40:43], v[184:187], a[124:127], v[40:43]
s_nop 0
ds_read_b64_tr_b16 v[240:241], v8 offset:45056
ds_read_b64_tr_b16 v[242:243], v8 offset:47104
v_mfma_f32_16x16x32_bf16 v[40:43], v[168:171], a[120:123], v[40:43]
s_nop 0
ds_read_b64_tr_b16 v[244:245], v9 offset:45056
ds_read_b64_tr_b16 v[246:247], v9 offset:47104
v_mfma_f32_16x16x32_bf16 v[40:43], v[152:155], a[116:119], v[40:43]
s_add_u32 s72, s71, 15360
buffer_load_dwordx4 v15, s[24:27], s72 offen offset:1024 lds
v_mfma_f32_16x16x32_bf16 v[40:43], v[136:139], a[112:115], v[40:43]
s_nop 0
ds_read_b64_tr_b16 v[248:249], v10 offset:45056
ds_read_b64_tr_b16 v[250:251], v10 offset:47104
v_mfma_f32_16x16x32_bf16 v[44:47], v[140:143], a[112:115], v[44:47]
s_nop 0
ds_read_b64_tr_b16 v[252:253], v11 offset:45056
ds_read_b64_tr_b16 v[254:255], v11 offset:47104
v_mfma_f32_16x16x32_bf16 v[44:47], v[156:159], a[116:119], v[44:47]
v_mfma_f32_16x16x32_bf16 v[44:47], v[172:175], a[120:123], v[44:47]
buffer_load_dwordx4 a[184:187], v1, s[44:47], s69 offen offset:2048 sc1
v_mfma_f32_16x16x32_bf16 v[44:47], v[188:191], a[124:127], v[44:47]
v_mfma_f32_16x16x32_bf16 v[28:31], v[188:191], a[108:111], v[28:31]
s_add_u32 s72, s71, 30720
buffer_load_dwordx4 v15, s[24:27], s72 offen offset:2048 lds
v_mfma_f32_16x16x32_bf16 v[28:31], v[172:175], a[104:107], v[28:31]
v_mfma_f32_16x16x32_bf16 v[28:31], v[156:159], a[100:103], v[28:31]
s_waitcnt vmcnt(27) lgkmcnt(0)
v_mfma_f32_16x16x32_bf16 v[28:31], v[140:143], a[96:99], v[28:31]
s_barrier
v_mfma_f32_16x16x32_bf16 v[48:51], v[192:195], a[96:99], v[48:51]
s_nop 0
ds_read_b64_tr_b16 v[128:129], v8 offset:49152
ds_read_b64_tr_b16 v[130:131], v8 offset:51200
v_mfma_f32_16x16x32_bf16 v[48:51], v[208:211], a[100:103], v[48:51]
s_nop 0
ds_read_b64_tr_b16 v[132:133], v9 offset:49152
ds_read_b64_tr_b16 v[134:135], v9 offset:51200
v_mfma_f32_16x16x32_bf16 v[48:51], v[224:227], a[104:107], v[48:51]
s_add_u32 s72, s71, 46080
buffer_load_dwordx4 v15, s[24:27], s72 offen offset:3072 lds
v_mfma_f32_16x16x32_bf16 v[48:51], v[240:243], a[108:111], v[48:51]
s_nop 0
ds_read_b64_tr_b16 v[136:137], v10 offset:49152
ds_read_b64_tr_b16 v[138:139], v10 offset:51200
v_mfma_f32_16x16x32_bf16 v[64:67], v[240:243], a[124:127], v[64:67]
buffer_load_dwordx4 a[188:191], v1, s[44:47], s69 offen offset:3072 sc1
v_mfma_f32_16x16x32_bf16 v[64:67], v[224:227], a[120:123], v[64:67]
s_nop 0
ds_read_b64_tr_b16 v[140:141], v11 offset:49152
ds_read_b64_tr_b16 v[142:143], v11 offset:51200
v_mfma_f32_16x16x32_bf16 v[64:67], v[208:211], a[116:119], v[64:67]
s_nop 0
ds_read_b64_tr_b16 v[144:145], v8 offset:53248
ds_read_b64_tr_b16 v[146:147], v8 offset:55296
v_mfma_f32_16x16x32_bf16 v[64:67], v[192:195], a[112:115], v[64:67]
s_nop 0
ds_read_b64_tr_b16 v[148:149], v9 offset:53248
ds_read_b64_tr_b16 v[150:151], v9 offset:55296
v_mfma_f32_16x16x32_bf16 v[68:71], v[196:199], a[112:115], v[68:71]
s_lshr_b32 s69, s14, 18
v_mfma_f32_16x16x32_bf16 v[68:71], v[212:215], a[116:119], v[68:71]
s_lshl_b32 s69, s69, 12
ds_read_b64_tr_b16 v[152:153], v10 offset:53248
ds_read_b64_tr_b16 v[154:155], v10 offset:55296
v_mfma_f32_16x16x32_bf16 v[68:71], v[228:231], a[120:123], v[68:71]
s_xor_b32 s71, s14, 0x400080
ds_read_b64_tr_b16 v[156:157], v11 offset:53248
ds_read_b64_tr_b16 v[158:159], v11 offset:55296
v_mfma_f32_16x16x32_bf16 v[68:71], v[244:247], a[124:127], v[68:71]
s_add_u32 m0, s77, 0
ds_read_b64_tr_b16 v[160:161], v8 offset:57344
ds_read_b64_tr_b16 v[162:163], v8 offset:59392
v_mfma_f32_16x16x32_bf16 v[52:55], v[244:247], a[108:111], v[52:55]
s_add_u32 s72, s71, 0
buffer_load_dwordx4 v15, s[24:27], s72 offen lds
v_mfma_f32_16x16x32_bf16 v[52:55], v[228:231], a[104:107], v[52:55]
s_add_u32 s69, s69, s95
ds_read_b64_tr_b16 v[164:165], v9 offset:57344
ds_read_b64_tr_b16 v[166:167], v9 offset:59392
v_mfma_f32_16x16x32_bf16 v[52:55], v[212:215], a[100:103], v[52:55]
s_xor_b32 s69, s69, 0x10000
buffer_load_dwordx4 a[192:195], v1, s[44:47], s69 offen sc1
v_mfma_f32_16x16x32_bf16 v[52:55], v[196:199], a[96:99], v[52:55]
s_nop 0
ds_read_b64_tr_b16 v[168:169], v10 offset:57344
ds_read_b64_tr_b16 v[170:171], v10 offset:59392
v_mfma_f32_16x16x32_bf16 v[56:59], v[200:203], a[96:99], v[56:59]
s_waitcnt vmcnt(19)
v_cmp_gt_u32 vcc, 2, v14
s_cbranch_vccnz Lspin112
Lback113:
v_mfma_f32_16x16x32_bf16 v[56:59], v[216:219], a[100:103], v[56:59]
s_add_u32 s72, s71, 15360
buffer_load_dwordx4 v15, s[24:27], s72 offen offset:1024 lds
v_mfma_f32_16x16x32_bf16 v[56:59], v[232:235], a[104:107], v[56:59]
v_mfma_f32_16x16x32_bf16 v[56:59], v[248:251], a[108:111], v[56:59]
s_nop 0
ds_read_b64_tr_b16 v[172:173], v11 offset:57344
ds_read_b64_tr_b16 v[174:175], v11 offset:59392
v_mfma_f32_16x16x32_bf16 v[72:75], v[248:251], a[124:127], v[72:75]
s_nop 0
ds_read_b64_tr_b16 v[176:177], v8 offset:61440
ds_read_b64_tr_b16 v[178:179], v8 offset:63488
v_mfma_f32_16x16x32_bf16 v[72:75], v[232:235], a[120:123], v[72:75]
s_nop 0
ds_read_b64_tr_b16 v[180:181], v9 offset:61440
ds_read_b64_tr_b16 v[182:183], v9 offset:63488
v_mfma_f32_16x16x32_bf16 v[72:75], v[216:219], a[116:119], v[72:75]
s_nop 0
ds_read_b64_tr_b16 v[184:185], v10 offset:61440
ds_read_b64_tr_b16 v[186:187], v10 offset:63488
v_mfma_f32_16x16x32_bf16 v[72:75], v[200:203], a[112:115], v[72:75]
s_add_u32 s72, s71, 30720
buffer_load_dwordx4 v15, s[24:27], s72 offen offset:2048 lds
v_mfma_f32_16x16x32_bf16 v[76:79], v[204:207], a[112:115], v[76:79]
buffer_load_dwordx4 a[196:199], v1, s[44:47], s69 offen offset:1024 sc1
v_mfma_f32_16x16x32_bf16 v[76:79], v[220:223], a[116:119], v[76:79]
s_nop 0
ds_read_b64_tr_b16 v[188:189], v11 offset:61440
ds_read_b64_tr_b16 v[190:191], v11 offset:63488
v_mfma_f32_16x16x32_bf16 v[76:79], v[236:239], a[120:123], v[76:79]
v_mfma_f32_16x16x32_bf16 v[76:79], v[252:255], a[124:127], v[76:79]
v_mfma_f32_16x16x32_bf16 v[60:63], v[252:255], a[108:111], v[60:63]
v_xor_b32 v8, 0x10000, v8
v_mfma_f32_16x16x32_bf16 v[60:63], v[236:239], a[104:107], v[60:63]
s_add_u32 s72, s71, 46080
buffer_load_dwordx4 v15, s[24:27], s72 offen offset:3072 lds
v_xor_b32 v9, 0x10000, v9
v_mfma_f32_16x16x32_bf16 v[60:63], v[220:223], a[100:103], v[60:63]
s_waitcnt vmcnt(28) lgkmcnt(0)
v_xor_b32 v10, 0x10000, v10
v_mfma_f32_16x16x32_bf16 v[60:63], v[204:207], a[96:99], v[60:63]
s_barrier
v_xor_b32 v11, 0x10000, v11
v_mfma_f32_16x16x32_bf16 v[80:83], v[128:131], a[96:99], v[80:83]
s_lshl_b32 s84, s76, 11
ds_read_b64_tr_b16 v[192:193], v8 offset:0
ds_read_b64_tr_b16 v[194:195], v8 offset:2048
v_mfma_f32_16x16x32_bf16 v[80:83], v[144:147], a[100:103], v[80:83]
s_add_u32 s84, s84, 0x3810000
ds_read_b64_tr_b16 v[196:197], v9 offset:0
ds_read_b64_tr_b16 v[198:199], v9 offset:2048
v_mfma_f32_16x16x32_bf16 v[80:83], v[160:163], a[104:107], v[80:83]
buffer_load_dwordx4 a[200:203], v1, s[44:47], s69 offen offset:2048 sc1
v_mfma_f32_16x16x32_bf16 v[80:83], v[176:179], a[108:111], v[80:83]
s_nop 0
ds_read_b64_tr_b16 v[200:201], v10 offset:0
ds_read_b64_tr_b16 v[202:203], v10 offset:2048
v_mfma_f32_16x16x32_bf16 v[96:99], v[176:179], a[124:127], v[96:99]
s_nop 0
ds_read_b64_tr_b16 v[204:205], v11 offset:0
ds_read_b64_tr_b16 v[206:207], v11 offset:2048
v_mfma_f32_16x16x32_bf16 v[96:99], v[160:163], a[120:123], v[96:99]
s_xor_b32 s71, s15, 0x400080
v_lshrrev_b32 v115, 2, v0
v_lshlrev_b32 v115, 7, v115
v_mfma_f32_16x16x32_bf16 v[96:99], v[144:147], a[116:119], v[96:99]
s_add_u32 m0, s77, 16384
ds_read_b64_tr_b16 v[208:209], v8 offset:4096
ds_read_b64_tr_b16 v[210:211], v8 offset:6144
v_mfma_f32_16x16x32_bf16 v[96:99], v[128:131], a[112:115], v[96:99]
s_add_u32 s72, s71, 0
buffer_load_dwordx4 v15, s[24:27], s72 offen lds
v_mfma_f32_16x16x32_bf16 v[100:103], v[132:135], a[112:115], v[100:103]
s_nop 0
ds_read_b64_tr_b16 v[212:213], v9 offset:4096
ds_read_b64_tr_b16 v[214:215], v9 offset:6144
v_mfma_f32_16x16x32_bf16 v[100:103], v[148:151], a[116:119], v[100:103]
s_nop 0
ds_read_b64_tr_b16 v[216:217], v10 offset:4096
ds_read_b64_tr_b16 v[218:219], v10 offset:6144
v_mfma_f32_16x16x32_bf16 v[100:103], v[164:167], a[120:123], v[100:103]
s_nop 0
ds_read_b64_tr_b16 v[220:221], v11 offset:4096
ds_read_b64_tr_b16 v[222:223], v11 offset:6144
v_mfma_f32_16x16x32_bf16 v[100:103], v[180:183], a[124:127], v[100:103]
buffer_load_dword v114, v115, s[44:47], s84 offen sc1
v_mfma_f32_16x16x32_bf16 v[84:87], v[180:183], a[108:111], v[84:87]
buffer_load_dwordx4 a[204:207], v1, s[44:47], s69 offen offset:3072 sc1
v_mfma_f32_16x16x32_bf16 v[84:87], v[164:167], a[104:107], v[84:87]
s_add_u32 s72, s71, 15360
buffer_load_dwordx4 v15, s[24:27], s72 offen offset:1024 lds
v_mfma_f32_16x16x32_bf16 v[84:87], v[148:151], a[100:103], v[84:87]
s_nop 0
ds_read_b64_tr_b16 v[224:225], v8 offset:8192
ds_read_b64_tr_b16 v[226:227], v8 offset:10240
v_mfma_f32_16x16x32_bf16 v[84:87], v[132:135], a[96:99], v[84:87]
s_nop 0
ds_read_b64_tr_b16 v[228:229], v9 offset:8192
ds_read_b64_tr_b16 v[230:231], v9 offset:10240
v_mfma_f32_16x16x32_bf16 v[88:91], v[136:139], a[96:99], v[88:91]
s_nop 0
ds_read_b64_tr_b16 v[232:233], v10 offset:8192
ds_read_b64_tr_b16 v[234:235], v10 offset:10240
v_mfma_f32_16x16x32_bf16 v[88:91], v[152:155], a[100:103], v[88:91]
s_nop 0
ds_read_b64_tr_b16 v[236:237], v11 offset:8192
ds_read_b64_tr_b16 v[238:239], v11 offset:10240
v_mfma_f32_16x16x32_bf16 v[88:91], v[168:171], a[104:107], v[88:91]
v_mfma_f32_16x16x32_bf16 v[88:91], v[184:187], a[108:111], v[88:91]
s_add_u32 s72, s71, 30720
buffer_load_dwordx4 v15, s[24:27], s72 offen offset:2048 lds
v_mfma_f32_16x16x32_bf16 v[104:107], v[184:187], a[124:127], v[104:107]
s_nop 0
ds_read_b64_tr_b16 v[240:241], v8 offset:12288
ds_read_b64_tr_b16 v[242:243], v8 offset:14336
v_mfma_f32_16x16x32_bf16 v[104:107], v[168:171], a[120:123], v[104:107]
s_nop 0
ds_read_b64_tr_b16 v[244:245], v9 offset:12288
ds_read_b64_tr_b16 v[246:247], v9 offset:14336
v_mfma_f32_16x16x32_bf16 v[104:107], v[152:155], a[116:119], v[104:107]
s_add_u32 s69, s69, 0x20000
buffer_load_dwordx4 a[208:211], v1, s[44:47], s69 offen sc1
v_mfma_f32_16x16x32_bf16 v[104:107], v[136:139], a[112:115], v[104:107]
s_nop 0
ds_read_b64_tr_b16 v[248:249], v10 offset:12288
ds_read_b64_tr_b16 v[250:251], v10 offset:14336
v_mfma_f32_16x16x32_bf16 v[108:111], v[140:143], a[112:115], v[108:111]
s_nop 0
ds_read_b64_tr_b16 v[252:253], v11 offset:12288
ds_read_b64_tr_b16 v[254:255], v11 offset:14336
v_mfma_f32_16x16x32_bf16 v[108:111], v[156:159], a[116:119], v[108:111]
s_add_u32 s72, s71, 46080
buffer_load_dwordx4 v15, s[24:27], s72 offen offset:3072 lds
v_mfma_f32_16x16x32_bf16 v[108:111], v[172:175], a[120:123], v[108:111]
v_mfma_f32_16x16x32_bf16 v[108:111], v[188:191], a[124:127], v[108:111]
v_mfma_f32_16x16x32_bf16 v[92:95], v[188:191], a[108:111], v[92:95]
v_mfma_f32_16x16x32_bf16 v[92:95], v[172:175], a[104:107], v[92:95]
v_mfma_f32_16x16x32_bf16 v[92:95], v[156:159], a[100:103], v[92:95]
s_waitcnt vmcnt(28) lgkmcnt(0)
v_mfma_f32_16x16x32_bf16 v[92:95], v[140:143], a[96:99], v[92:95]
s_barrier
v_mfma_f32_16x16x32_bf16 v[16:19], v[192:195], a[128:131], v[16:19]
buffer_load_dwordx4 a[212:215], v1, s[44:47], s69 offen offset:1024 sc1
v_mfma_f32_16x16x32_bf16 v[16:19], v[208:211], a[132:135], v[16:19]
s_xor_b32 s71, s13, 0x400100
ds_read_b64_tr_b16 v[128:129], v8 offset:16384
ds_read_b64_tr_b16 v[130:131], v8 offset:18432
v_mfma_f32_16x16x32_bf16 v[16:19], v[224:227], a[136:139], v[16:19]
s_add_u32 m0, s77, 32768
ds_read_b64_tr_b16 v[132:133], v9 offset:16384
ds_read_b64_tr_b16 v[134:135], v9 offset:18432
v_mfma_f32_16x16x32_bf16 v[16:19], v[240:243], a[140:143], v[16:19]
s_add_u32 s72, s71, 0
buffer_load_dwordx4 v15, s[24:27], s72 offen lds
v_mfma_f32_16x16x32_bf16 v[32:35], v[240:243], a[156:159], v[32:35]
s_nop 0
ds_read_b64_tr_b16 v[136:137], v10 offset:16384
ds_read_b64_tr_b16 v[138:139], v10 offset:18432
v_mfma_f32_16x16x32_bf16 v[32:35], v[224:227], a[152:155], v[32:35]
s_nop 0
ds_read_b64_tr_b16 v[140:141], v11 offset:16384
ds_read_b64_tr_b16 v[142:143], v11 offset:18432
v_mfma_f32_16x16x32_bf16 v[32:35], v[208:211], a[148:151], v[32:35]
v_mfma_f32_16x16x32_bf16 v[32:35], v[192:195], a[144:147], v[32:35]
s_nop 0
ds_read_b64_tr_b16 v[144:145], v8 offset:20480
ds_read_b64_tr_b16 v[146:147], v8 offset:22528
v_mfma_f32_16x16x32_bf16 v[36:39], v[196:199], a[144:147], v[36:39]
s_add_u32 s72, s71, 15360
buffer_load_dwordx4 v15, s[24:27], s72 offen offset:1024 lds
v_mfma_f32_16x16x32_bf16 v[36:39], v[212:215], a[148:151], v[36:39]
s_nop 0
ds_read_b64_tr_b16 v[148:149], v9 offset:20480
ds_read_b64_tr_b16 v[150:151], v9 offset:22528
v_mfma_f32_16x16x32_bf16 v[36:39], v[228:231], a[152:155], v[36:39]
buffer_load_dwordx4 a[216:219], v1, s[44:47], s69 offen offset:2048 sc1
v_mfma_f32_16x16x32_bf16 v[36:39], v[244:247], a[156:159], v[36:39]
s_nop 0
ds_read_b64_tr_b16 v[152:153], v10 offset:20480
ds_read_b64_tr_b16 v[154:155], v10 offset:22528
v_mfma_f32_16x16x32_bf16 v[20:23], v[244:247], a[140:143], v[20:23]
s_nop 0
ds_read_b64_tr_b16 v[156:157], v11 offset:20480
ds_read_b64_tr_b16 v[158:159], v11 offset:22528
v_mfma_f32_16x16x32_bf16 v[20:23], v[228:231], a[136:139], v[20:23]
v_mfma_f32_16x16x32_bf16 v[20:23], v[212:215], a[132:135], v[20:23]
s_add_u32 s72, s71, 30720
buffer_load_dwordx4 v15, s[24:27], s72 offen offset:2048 lds
v_mfma_f32_16x16x32_bf16 v[20:23], v[196:199], a[128:131], v[20:23]
s_nop 0
ds_read_b64_tr_b16 v[160:161], v8 offset:24576
ds_read_b64_tr_b16 v[162:163], v8 offset:26624
v_mfma_f32_16x16x32_bf16 v[24:27], v[200:203], a[128:131], v[24:27]
s_nop 0
ds_read_b64_tr_b16 v[164:165], v9 offset:24576
ds_read_b64_tr_b16 v[166:167], v9 offset:26624
v_mfma_f32_16x16x32_bf16 v[24:27], v[216:219], a[132:135], v[24:27]
s_nop 0
ds_read_b64_tr_b16 v[168:169], v10 offset:24576
ds_read_b64_tr_b16 v[170:171], v10 offset:26624
v_mfma_f32_16x16x32_bf16 v[24:27], v[232:235], a[136:139], v[24:27]
s_nop 0
ds_read_b64_tr_b16 v[172:173], v11 offset:24576
ds_read_b64_tr_b16 v[174:175], v11 offset:26624
v_mfma_f32_16x16x32_bf16 v[24:27], v[248:251], a[140:143], v[24:27]
v_mfma_f32_16x16x32_bf16 v[40:43], v[248:251], a[156:159], v[40:43]
s_add_u32 s72, s71, 46080
buffer_load_dwordx4 v15, s[24:27], s72 offen offset:3072 lds
v_mfma_f32_16x16x32_bf16 v[40:43], v[232:235], a[152:155], v[40:43]
buffer_load_dwordx4 a[220:223], v1, s[44:47], s69 offen offset:3072 sc1
v_mfma_f32_16x16x32_bf16 v[40:43], v[216:219], a[148:151], v[40:43]
s_nop 0
ds_read_b64_tr_b16 v[176:177], v8 offset:28672
ds_read_b64_tr_b16 v[178:179], v8 offset:30720
v_mfma_f32_16x16x32_bf16 v[40:43], v[200:203], a[144:147], v[40:43]
s_lshr_b32 s69, s15, 18
ds_read_b64_tr_b16 v[180:181], v9 offset:28672
ds_read_b64_tr_b16 v[182:183], v9 offset:30720
v_mfma_f32_16x16x32_bf16 v[44:47], v[204:207], a[144:147], v[44:47]
s_lshl_b32 s69, s69, 12
ds_read_b64_tr_b16 v[184:185], v10 offset:28672
ds_read_b64_tr_b16 v[186:187], v10 offset:30720
v_mfma_f32_16x16x32_bf16 v[44:47], v[220:223], a[148:151], v[44:47]
s_add_u32 s69, s69, s95
ds_read_b64_tr_b16 v[188:189], v11 offset:28672
ds_read_b64_tr_b16 v[190:191], v11 offset:30720
v_mfma_f32_16x16x32_bf16 v[44:47], v[236:239], a[152:155], v[44:47]
s_xor_b32 s69, s69, 0x10000
v_mfma_f32_16x16x32_bf16 v[44:47], v[252:255], a[156:159], v[44:47]
s_xor_b32 s71, s14, 0x400100
v_mfma_f32_16x16x32_bf16 v[28:31], v[252:255], a[140:143], v[28:31]
s_add_u32 m0, s77, 49152
v_mfma_f32_16x16x32_bf16 v[28:31], v[236:239], a[136:139], v[28:31]
s_add_u32 s72, s71, 0
v_mfma_f32_16x16x32_bf16 v[28:31], v[220:223], a[132:135], v[28:31]
s_waitcnt vmcnt(29) lgkmcnt(0)
buffer_load_dwordx4 v15, s[24:27], s72 offen lds
v_mfma_f32_16x16x32_bf16 v[28:31], v[204:207], a[128:131], v[28:31]
s_barrier
buffer_load_dwordx4 a[224:227], v1, s[44:47], s69 offen sc1
v_mfma_f32_16x16x32_bf16 v[48:51], v[128:131], a[128:131], v[48:51]
s_nop 0
ds_read_b64_tr_b16 v[192:193], v8 offset:32768
ds_read_b64_tr_b16 v[194:195], v8 offset:34816
v_mfma_f32_16x16x32_bf16 v[48:51], v[144:147], a[132:135], v[48:51]
s_nop 0
ds_read_b64_tr_b16 v[196:197], v9 offset:32768
ds_read_b64_tr_b16 v[198:199], v9 offset:34816
v_mfma_f32_16x16x32_bf16 v[48:51], v[160:163], a[136:139], v[48:51]
s_nop 0
ds_read_b64_tr_b16 v[200:201], v10 offset:32768
ds_read_b64_tr_b16 v[202:203], v10 offset:34816
v_mfma_f32_16x16x32_bf16 v[48:51], v[176:179], a[140:143], v[48:51]
s_add_u32 s72, s71, 15360
buffer_load_dwordx4 v15, s[24:27], s72 offen offset:1024 lds
v_mfma_f32_16x16x32_bf16 v[64:67], v[176:179], a[156:159], v[64:67]
s_nop 0
ds_read_b64_tr_b16 v[204:205], v11 offset:32768
ds_read_b64_tr_b16 v[206:207], v11 offset:34816
v_mfma_f32_16x16x32_bf16 v[64:67], v[160:163], a[152:155], v[64:67]
v_mfma_f32_16x16x32_bf16 v[64:67], v[144:147], a[148:151], v[64:67]
s_nop 0
ds_read_b64_tr_b16 v[208:209], v8 offset:36864
ds_read_b64_tr_b16 v[210:211], v8 offset:38912
v_mfma_f32_16x16x32_bf16 v[64:67], v[128:131], a[144:147], v[64:67]
s_nop 0
ds_read_b64_tr_b16 v[212:213], v9 offset:36864
ds_read_b64_tr_b16 v[214:215], v9 offset:38912
v_mfma_f32_16x16x32_bf16 v[68:71], v[132:135], a[144:147], v[68:71]
buffer_load_dwordx4 a[228:231], v1, s[44:47], s69 offen offset:1024 sc1
v_mfma_f32_16x16x32_bf16 v[68:71], v[148:151], a[148:151], v[68:71]
s_add_u32 s72, s71, 30720
buffer_load_dwordx4 v15, s[24:27], s72 offen offset:2048 lds
v_mfma_f32_16x16x32_bf16 v[68:71], v[164:167], a[152:155], v[68:71]
s_nop 0
ds_read_b64_tr_b16 v[216:217], v10 offset:36864
ds_read_b64_tr_b16 v[218:219], v10 offset:38912
v_mfma_f32_16x16x32_bf16 v[68:71], v[180:183], a[156:159], v[68:71]
v_mfma_f32_16x16x32_bf16 v[52:55], v[180:183], a[140:143], v[52:55]
s_nop 0
ds_read_b64_tr_b16 v[220:221], v11 offset:36864
ds_read_b64_tr_b16 v[222:223], v11 offset:38912
v_mfma_f32_16x16x32_bf16 v[52:55], v[164:167], a[136:139], v[52:55]
s_nop 0
ds_read_b64_tr_b16 v[224:225], v8 offset:40960
ds_read_b64_tr_b16 v[226:227], v8 offset:43008
v_mfma_f32_16x16x32_bf16 v[52:55], v[148:151], a[132:135], v[52:55]
s_nop 0
ds_read_b64_tr_b16 v[228:229], v9 offset:40960
ds_read_b64_tr_b16 v[230:231], v9 offset:43008
v_mfma_f32_16x16x32_bf16 v[52:55], v[132:135], a[128:131], v[52:55]
s_add_u32 s72, s71, 46080
buffer_load_dwordx4 v15, s[24:27], s72 offen offset:3072 lds
v_mfma_f32_16x16x32_bf16 v[56:59], v[136:139], a[128:131], v[56:59]
v_mfma_f32_16x16x32_bf16 v[56:59], v[152:155], a[132:135], v[56:59]
s_nop 0
ds_read_b64_tr_b16 v[232:233], v10 offset:40960
ds_read_b64_tr_b16 v[234:235], v10 offset:43008
v_mfma_f32_16x16x32_bf16 v[56:59], v[168:171], a[136:139], v[56:59]
buffer_load_dwordx4 a[232:235], v1, s[44:47], s69 offen offset:2048 sc1
v_mfma_f32_16x16x32_bf16 v[56:59], v[184:187], a[140:143], v[56:59]
s_nop 0
ds_read_b64_tr_b16 v[236:237], v11 offset:40960
ds_read_b64_tr_b16 v[238:239], v11 offset:43008
v_mfma_f32_16x16x32_bf16 v[72:75], v[184:187], a[156:159], v[72:75]
s_nop 0
ds_read_b64_tr_b16 v[240:241], v8 offset:45056
ds_read_b64_tr_b16 v[242:243], v8 offset:47104
v_mfma_f32_16x16x32_bf16 v[72:75], v[168:171], a[152:155], v[72:75]
v_mfma_f32_16x16x32_bf16 v[72:75], v[152:155], a[148:151], v[72:75]
s_nop 0
ds_read_b64_tr_b16 v[244:245], v9 offset:45056
ds_read_b64_tr_b16 v[246:247], v9 offset:47104
v_mfma_f32_16x16x32_bf16 v[72:75], v[136:139], a[144:147], v[72:75]
s_xor_b32 s71, s15, 0x400100
ds_read_b64_tr_b16 v[248:249], v10 offset:45056
ds_read_b64_tr_b16 v[250:251], v10 offset:47104
v_mfma_f32_16x16x32_bf16 v[76:79], v[140:143], a[144:147], v[76:79]
s_add_u32 m0, s85, 0
ds_read_b64_tr_b16 v[252:253], v11 offset:45056
ds_read_b64_tr_b16 v[254:255], v11 offset:47104
v_mfma_f32_16x16x32_bf16 v[76:79], v[156:159], a[148:151], v[76:79]
s_add_u32 s72, s71, 0
buffer_load_dwordx4 v15, s[24:27], s72 offen lds
v_mfma_f32_16x16x32_bf16 v[76:79], v[172:175], a[152:155], v[76:79]
v_mfma_f32_16x16x32_bf16 v[76:79], v[188:191], a[156:159], v[76:79]
v_mfma_f32_16x16x32_bf16 v[60:63], v[188:191], a[140:143], v[60:63]
buffer_load_dwordx4 a[236:239], v1, s[44:47], s69 offen offset:3072 sc1
v_mfma_f32_16x16x32_bf16 v[60:63], v[172:175], a[136:139], v[60:63]
s_add_u32 s72, s71, 15360
v_mfma_f32_16x16x32_bf16 v[60:63], v[156:159], a[132:135], v[60:63]
s_waitcnt vmcnt(31) lgkmcnt(0)
v_mfma_f32_16x16x32_bf16 v[60:63], v[140:143], a[128:131], v[60:63]
s_barrier
buffer_load_dwordx4 v15, s[24:27], s72 offen offset:1024 lds
v_mfma_f32_16x16x32_bf16 v[80:83], v[192:195], a[128:131], v[80:83]
s_nop 0
ds_read_b64_tr_b16 v[128:129], v8 offset:49152
ds_read_b64_tr_b16 v[130:131], v8 offset:51200
v_mfma_f32_16x16x32_bf16 v[80:83], v[208:211], a[132:135], v[80:83]
s_nop 0
ds_read_b64_tr_b16 v[132:133], v9 offset:49152
ds_read_b64_tr_b16 v[134:135], v9 offset:51200
v_mfma_f32_16x16x32_bf16 v[80:83], v[224:227], a[136:139], v[80:83]
s_nop 0
ds_read_b64_tr_b16 v[136:137], v10 offset:49152
ds_read_b64_tr_b16 v[138:139], v10 offset:51200
s_waitcnt vmcnt(22)
v_cmp_gt_u32 vcc, 3, v114
s_cbranch_vccnz Lspin109
Lback110:
v_mfma_f32_16x16x32_bf16 v[80:83], v[240:243], a[140:143], v[80:83]
s_lshl_b32 s73, s76, 18
ds_read_b64_tr_b16 v[140:141], v11 offset:49152
ds_read_b64_tr_b16 v[142:143], v11 offset:51200
v_mfma_f32_16x16x32_bf16 v[96:99], v[240:243], a[156:159], v[96:99]
s_lshl_b32 s84, s58, 16
v_mfma_f32_16x16x32_bf16 v[96:99], v[224:227], a[152:155], v[96:99]
s_add_u32 s72, s71, 30720
buffer_load_dwordx4 v15, s[24:27], s72 offen offset:2048 lds
Lstube2:
s_cbranch_execz Lrete
v_mfma_f32_16x16x32_bf16 v[96:99], v[208:211], a[148:151], v[96:99]
s_add_u32 s69, s69, 0x20000
buffer_load_dwordx4 a[240:243], v1, s[44:47], s69 offen sc1
v_mfma_f32_16x16x32_bf16 v[96:99], v[192:195], a[144:147], v[96:99]
s_add_u32 s73, s73, s84
ds_read_b64_tr_b16 v[144:145], v8 offset:53248
ds_read_b64_tr_b16 v[146:147], v8 offset:55296
v_mfma_f32_16x16x32_bf16 v[100:103], v[196:199], a[144:147], v[100:103]
s_lshl_b32 s84, s75, 8
ds_read_b64_tr_b16 v[148:149], v9 offset:53248
ds_read_b64_tr_b16 v[150:151], v9 offset:55296
v_mfma_f32_16x16x32_bf16 v[100:103], v[212:215], a[148:151], v[100:103]
s_add_u32 s73, s73, s84
ds_read_b64_tr_b16 v[152:153], v10 offset:53248
ds_read_b64_tr_b16 v[154:155], v10 offset:55296
v_mfma_f32_16x16x32_bf16 v[100:103], v[228:231], a[152:155], v[100:103]
s_add_u32 s73, s73, 0x3400000
v_lshrrev_b32 v112, 4, v0
v_and_b32 v113, 15, v0
v_mfma_f32_16x16x32_bf16 v[100:103], v[244:247], a[156:159], v[100:103]
s_add_u32 s72, s71, 46080
buffer_load_dwordx4 v15, s[24:27], s72 offen offset:3072 lds
v_mfma_f32_16x16x32_bf16 v[84:87], v[244:247], a[140:143], v[84:87]
s_nop 0
ds_read_b64_tr_b16 v[156:157], v11 offset:53248
ds_read_b64_tr_b16 v[158:159], v11 offset:55296
v_mfma_f32_16x16x32_bf16 v[84:87], v[228:231], a[136:139], v[84:87]
s_nop 0
ds_read_b64_tr_b16 v[160:161], v8 offset:57344
ds_read_b64_tr_b16 v[162:163], v8 offset:59392
v_mfma_f32_16x16x32_bf16 v[84:87], v[212:215], a[132:135], v[84:87]
s_nop 0
ds_read_b64_tr_b16 v[164:165], v9 offset:57344
ds_read_b64_tr_b16 v[166:167], v9 offset:59392
v_mfma_f32_16x16x32_bf16 v[84:87], v[196:199], a[128:131], v[84:87]
v_xor_b32 v12, v113, v112
v_lshlrev_b32 v12, 4, v12
v_mfma_f32_16x16x32_bf16 v[88:91], v[200:203], a[128:131], v[88:91]
buffer_load_dwordx4 a[244:247], v1, s[44:47], s69 offen offset:1024 sc1
v_mfma_f32_16x16x32_bf16 v[88:91], v[216:219], a[132:135], v[88:91]
s_nop 0
ds_read_b64_tr_b16 v[168:169], v10 offset:57344
ds_read_b64_tr_b16 v[170:171], v10 offset:59392
v_mfma_f32_16x16x32_bf16 v[88:91], v[232:235], a[136:139], v[88:91]
s_nop 0
ds_read_b64_tr_b16 v[172:173], v11 offset:57344
ds_read_b64_tr_b16 v[174:175], v11 offset:59392
v_mfma_f32_16x16x32_bf16 v[88:91], v[248:251], a[140:143], v[88:91]
s_xor_b32 s71, s13, 0x400180
ds_read_b64_tr_b16 v[176:177], v8 offset:61440
ds_read_b64_tr_b16 v[178:179], v8 offset:63488
v_mfma_f32_16x16x32_bf16 v[104:107], v[248:251], a[156:159], v[104:107]
s_add_u32 m0, s85, 16384
v_lshl_add_u32 v112, v112, 12, v12
v_xor_b32 v12, 64, v112
v_mfma_f32_16x16x32_bf16 v[104:107], v[232:235], a[152:155], v[104:107]
s_add_u32 s72, s71, 0
buffer_load_dwordx4 v15, s[24:27], s72 offen lds
v_mfma_f32_16x16x32_bf16 v[104:107], v[216:219], a[148:151], v[104:107]
s_nop 0
ds_read_b64_tr_b16 v[180:181], v9 offset:61440
ds_read_b64_tr_b16 v[182:183], v9 offset:63488
v_mfma_f32_16x16x32_bf16 v[104:107], v[200:203], a[144:147], v[104:107]
s_nop 0
ds_read_b64_tr_b16 v[184:185], v10 offset:61440
ds_read_b64_tr_b16 v[186:187], v10 offset:63488
v_mfma_f32_16x16x32_bf16 v[108:111], v[204:207], a[144:147], v[108:111]
s_nop 0
ds_read_b64_tr_b16 v[188:189], v11 offset:61440
ds_read_b64_tr_b16 v[190:191], v11 offset:63488
v_mfma_f32_16x16x32_bf16 v[108:111], v[220:223], a[148:151], v[108:111]
v_lshlrev_b32 v113, 2, v113
v_mfma_f32_16x16x32_bf16 v[108:111], v[236:239], a[152:155], v[108:111]
s_add_u32 s72, s71, 15360
buffer_load_dwordx4 v15, s[24:27], s72 offen offset:1024 lds
v_mfma_f32_16x16x32_bf16 v[108:111], v[252:255], a[156:159], v[108:111]
buffer_load_dwordx4 a[248:251], v1, s[44:47], s69 offen offset:2048 sc1
v_mfma_f32_16x16x32_bf16 v[92:95], v[252:255], a[140:143], v[92:95]
v_xor_b32 v8, 0x10000, v8
v_mfma_f32_16x16x32_bf16 v[92:95], v[236:239], a[136:139], v[92:95]
v_xor_b32 v9, 0x10000, v9
v_mfma_f32_16x16x32_bf16 v[92:95], v[220:223], a[132:135], v[92:95]
s_waitcnt vmcnt(32) lgkmcnt(0)
v_xor_b32 v10, 0x10000, v10
v_mfma_f32_16x16x32_bf16 v[92:95], v[204:207], a[128:131], v[92:95]
s_barrier
v_xor_b32 v11, 0x10000, v11
v_mfma_f32_16x16x32_bf16 v[16:19], v[128:131], a[160:163], v[16:19]
s_add_u32 s72, s71, 30720
buffer_load_dwordx4 v15, s[24:27], s72 offen offset:2048 lds
v_mfma_f32_16x16x32_bf16 v[16:19], v[144:147], a[164:167], v[16:19]
s_nop 0
ds_read_b64_tr_b16 v[192:193], v8 offset:0
ds_read_b64_tr_b16 v[194:195], v8 offset:2048
v_mfma_f32_16x16x32_bf16 v[16:19], v[160:163], a[168:171], v[16:19]
s_nop 0
ds_read_b64_tr_b16 v[196:197], v9 offset:0
ds_read_b64_tr_b16 v[198:199], v9 offset:2048
v_mfma_f32_16x16x32_bf16 v[16:19], v[176:179], a[172:175], v[16:19]
s_nop 0
ds_read_b64_tr_b16 v[200:201], v10 offset:0
ds_read_b64_tr_b16 v[202:203], v10 offset:2048
v_mfma_f32_16x16x32_bf16 v[32:35], v[176:179], a[188:191], v[32:35]
buffer_load_dwordx4 a[252:255], v1, s[44:47], s69 offen offset:3072 sc1
v_mfma_f32_16x16x32_bf16 v[32:35], v[160:163], a[184:187], v[32:35]
v_mfma_f32_16x16x32_bf16 v[32:35], v[144:147], a[180:183], v[32:35]
s_add_u32 s72, s71, 46080
buffer_load_dwordx4 v15, s[24:27], s72 offen offset:3072 lds
v_mfma_f32_16x16x32_bf16 v[32:35], v[128:131], a[176:179], v[32:35]
s_nop 0
ds_read_b64_tr_b16 v[204:205], v11 offset:0
ds_read_b64_tr_b16 v[206:207], v11 offset:2048
v_mfma_f32_16x16x32_bf16 v[36:39], v[132:135], a[176:179], v[36:39]
s_nop 0
ds_read_b64_tr_b16 v[208:209], v8 offset:4096
ds_read_b64_tr_b16 v[210:211], v8 offset:6144
v_mfma_f32_16x16x32_bf16 v[36:39], v[148:151], a[180:183], v[36:39]
s_nop 0
ds_read_b64_tr_b16 v[212:213], v9 offset:4096
ds_read_b64_tr_b16 v[214:215], v9 offset:6144
v_mfma_f32_16x16x32_bf16 v[36:39], v[164:167], a[184:187], v[36:39]
v_mfma_f32_16x16x32_bf16 v[36:39], v[180:183], a[188:191], v[36:39]
s_nop 0
ds_read_b64_tr_b16 v[216:217], v10 offset:4096
ds_read_b64_tr_b16 v[218:219], v10 offset:6144
v_mfma_f32_16x16x32_bf16 v[20:23], v[180:183], a[172:175], v[20:23]
s_nop 0
ds_read_b64_tr_b16 v[220:221], v11 offset:4096
ds_read_b64_tr_b16 v[222:223], v11 offset:6144
v_mfma_f32_16x16x32_bf16 v[20:23], v[164:167], a[168:171], v[20:23]
v_mfma_f32_16x16x32_bf16 v[20:23], v[148:151], a[164:167], v[20:23]
s_xor_b32 s71, s14, 0x400180
ds_read_b64_tr_b16 v[224:225], v8 offset:8192
ds_read_b64_tr_b16 v[226:227], v8 offset:10240
v_mfma_f32_16x16x32_bf16 v[20:23], v[132:135], a[160:163], v[20:23]
s_add_u32 m0, s85, 32768
ds_read_b64_tr_b16 v[228:229], v9 offset:8192
ds_read_b64_tr_b16 v[230:231], v9 offset:10240
v_mfma_f32_16x16x32_bf16 v[24:27], v[136:139], a[160:163], v[24:27]
s_add_u32 s72, s71, 0
buffer_load_dwordx4 v15, s[24:27], s72 offen lds
v_mfma_f32_16x16x32_bf16 v[24:27], v[152:155], a[164:167], v[24:27]
s_nop 0
ds_read_b64_tr_b16 v[232:233], v10 offset:8192
ds_read_b64_tr_b16 v[234:235], v10 offset:10240
v_mfma_f32_16x16x32_bf16 v[24:27], v[168:171], a[168:171], v[24:27]
v_mfma_f32_16x16x32_bf16 v[24:27], v[184:187], a[172:175], v[24:27]
s_nop 0
ds_read_b64_tr_b16 v[236:237], v11 offset:8192
ds_read_b64_tr_b16 v[238:239], v11 offset:10240
v_mfma_f32_16x16x32_bf16 v[40:43], v[184:187], a[188:191], v[40:43]
s_nop 0
ds_read_b64_tr_b16 v[240:241], v8 offset:12288
ds_read_b64_tr_b16 v[242:243], v8 offset:14336
v_mfma_f32_16x16x32_bf16 v[40:43], v[168:171], a[184:187], v[40:43]
s_nop 0
ds_read_b64_tr_b16 v[244:245], v9 offset:12288
ds_read_b64_tr_b16 v[246:247], v9 offset:14336
v_mfma_f32_16x16x32_bf16 v[40:43], v[152:155], a[180:183], v[40:43]
s_add_u32 s72, s71, 15360
buffer_load_dwordx4 v15, s[24:27], s72 offen offset:1024 lds
v_mfma_f32_16x16x32_bf16 v[40:43], v[136:139], a[176:179], v[40:43]
v_mfma_f32_16x16x32_bf16 v[44:47], v[140:143], a[176:179], v[44:47]
s_nop 0
ds_read_b64_tr_b16 v[248:249], v10 offset:12288
ds_read_b64_tr_b16 v[250:251], v10 offset:14336
v_mfma_f32_16x16x32_bf16 v[44:47], v[156:159], a[180:183], v[44:47]
s_nop 0
ds_read_b64_tr_b16 v[252:253], v11 offset:12288
ds_read_b64_tr_b16 v[254:255], v11 offset:14336
v_mfma_f32_16x16x32_bf16 v[44:47], v[172:175], a[184:187], v[44:47]
v_mfma_f32_16x16x32_bf16 v[44:47], v[188:191], a[188:191], v[44:47]
v_mfma_f32_16x16x32_bf16 v[28:31], v[188:191], a[172:175], v[28:31]
s_add_u32 s72, s71, 30720
buffer_load_dwordx4 v15, s[24:27], s72 offen offset:2048 lds
v_mfma_f32_16x16x32_bf16 v[28:31], v[172:175], a[168:171], v[28:31]
v_mfma_f32_16x16x32_bf16 v[28:31], v[156:159], a[164:167], v[28:31]
s_waitcnt vmcnt(23) lgkmcnt(0)
v_mfma_f32_16x16x32_bf16 v[28:31], v[140:143], a[160:163], v[28:31]
s_barrier
v_mfma_f32_16x16x32_bf16 v[16:19], v[192:195], a[192:195], v[16:19]
s_nop 0
ds_read_b64_tr_b16 v[128:129], v8 offset:16384
ds_read_b64_tr_b16 v[130:131], v8 offset:18432
v_mfma_f32_16x16x32_bf16 v[16:19], v[208:211], a[196:199], v[16:19]
s_nop 0
ds_read_b64_tr_b16 v[132:133], v9 offset:16384
ds_read_b64_tr_b16 v[134:135], v9 offset:18432
v_mfma_f32_16x16x32_bf16 v[16:19], v[224:227], a[200:203], v[16:19]
s_add_u32 s72, s71, 46080
buffer_load_dwordx4 v15, s[24:27], s72 offen offset:3072 lds
v_mfma_f32_16x16x32_bf16 v[16:19], v[240:243], a[204:207], v[16:19]
s_nop 0
ds_read_b64_tr_b16 v[136:137], v10 offset:16384
ds_read_b64_tr_b16 v[138:139], v10 offset:18432
v_mfma_f32_16x16x32_bf16 v[32:35], v[240:243], a[220:223], v[32:35]
s_nop 0
ds_read_b64_tr_b16 v[140:141], v11 offset:16384
ds_read_b64_tr_b16 v[142:143], v11 offset:18432
v_mfma_f32_16x16x32_bf16 v[32:35], v[224:227], a[216:219], v[32:35]
v_mfma_f32_16x16x32_bf16 v[32:35], v[208:211], a[212:215], v[32:35]
s_nop 0
ds_read_b64_tr_b16 v[144:145], v8 offset:20480
ds_read_b64_tr_b16 v[146:147], v8 offset:22528
v_mfma_f32_16x16x32_bf16 v[32:35], v[192:195], a[208:211], v[32:35]
s_nop 0
ds_read_b64_tr_b16 v[148:149], v9 offset:20480
ds_read_b64_tr_b16 v[150:151], v9 offset:22528
v_mfma_f32_16x16x32_bf16 v[36:39], v[196:199], a[208:211], v[36:39]
s_nop 0
ds_read_b64_tr_b16 v[152:153], v10 offset:20480
ds_read_b64_tr_b16 v[154:155], v10 offset:22528
v_mfma_f32_16x16x32_bf16 v[36:39], v[212:215], a[212:215], v[36:39]
s_nop 0
ds_read_b64_tr_b16 v[156:157], v11 offset:20480
ds_read_b64_tr_b16 v[158:159], v11 offset:22528
v_mfma_f32_16x16x32_bf16 v[36:39], v[228:231], a[216:219], v[36:39]
v_mfma_f32_16x16x32_bf16 v[36:39], v[244:247], a[220:223], v[36:39]
s_add_u32 m0, s64, 147456
ds_read_b64_tr_b16 v[160:161], v8 offset:24576
ds_read_b64_tr_b16 v[162:163], v8 offset:26624
v_mfma_f32_16x16x32_bf16 v[20:23], v[244:247], a[204:207], v[20:23]
s_add_u32 s72, s73, 0
buffer_load_dwordx4 v112, s[44:47], s72 offen sc1 lds
v_mfma_f32_16x16x32_bf16 v[20:23], v[228:231], a[200:203], v[20:23]
s_nop 0
ds_read_b64_tr_b16 v[164:165], v9 offset:24576
ds_read_b64_tr_b16 v[166:167], v9 offset:26624
v_mfma_f32_16x16x32_bf16 v[20:23], v[212:215], a[196:199], v[20:23]
s_add_u32 s72, s73, 15360
buffer_load_dwordx4 v12, s[44:47], s72 offen offset:1024 sc1 lds
v_mfma_f32_16x16x32_bf16 v[20:23], v[196:199], a[192:195], v[20:23]
s_nop 0
ds_read_b64_tr_b16 v[168:169], v10 offset:24576
ds_read_b64_tr_b16 v[170:171], v10 offset:26624
v_mfma_f32_16x16x32_bf16 v[24:27], v[200:203], a[192:195], v[24:27]
s_nop 0
ds_read_b64_tr_b16 v[172:173], v11 offset:24576
ds_read_b64_tr_b16 v[174:175], v11 offset:26624
v_mfma_f32_16x16x32_bf16 v[24:27], v[216:219], a[196:199], v[24:27]
s_add_u32 s72, s73, 30720
buffer_load_dwordx4 v112, s[44:47], s72 offen offset:2048 sc1 lds
v_mfma_f32_16x16x32_bf16 v[24:27], v[232:235], a[200:203], v[24:27]
v_mfma_f32_16x16x32_bf16 v[24:27], v[248:251], a[204:207], v[24:27]
s_nop 0
ds_read_b64_tr_b16 v[176:177], v8 offset:28672
ds_read_b64_tr_b16 v[178:179], v8 offset:30720
v_mfma_f32_16x16x32_bf16 v[40:43], v[248:251], a[220:223], v[40:43]
s_add_u32 s72, s73, 46080
buffer_load_dwordx4 v12, s[44:47], s72 offen offset:3072 sc1 lds
v_mfma_f32_16x16x32_bf16 v[40:43], v[232:235], a[216:219], v[40:43]
s_xor_b32 s71, s15, 0x400180
ds_read_b64_tr_b16 v[180:181], v9 offset:28672
ds_read_b64_tr_b16 v[182:183], v9 offset:30720
v_mfma_f32_16x16x32_bf16 v[40:43], v[216:219], a[212:215], v[40:43]
s_add_u32 m0, s85, 49152
ds_read_b64_tr_b16 v[184:185], v10 offset:28672
ds_read_b64_tr_b16 v[186:187], v10 offset:30720
v_mfma_f32_16x16x32_bf16 v[40:43], v[200:203], a[208:211], v[40:43]
s_add_u32 s72, s71, 0
buffer_load_dwordx4 v15, s[24:27], s72 offen lds
v_mfma_f32_16x16x32_bf16 v[44:47], v[204:207], a[208:211], v[44:47]
s_nop 0
ds_read_b64_tr_b16 v[188:189], v11 offset:28672
ds_read_b64_tr_b16 v[190:191], v11 offset:30720
v_mfma_f32_16x16x32_bf16 v[44:47], v[220:223], a[212:215], v[44:47]
v_mfma_f32_16x16x32_bf16 v[44:47], v[236:239], a[216:219], v[44:47]
s_add_u32 s72, s71, 15360
buffer_load_dwordx4 v15, s[24:27], s72 offen offset:1024 lds
v_mfma_f32_16x16x32_bf16 v[44:47], v[252:255], a[220:223], v[44:47]
v_mfma_f32_16x16x32_bf16 v[28:31], v[252:255], a[204:207], v[28:31]
v_mfma_f32_16x16x32_bf16 v[28:31], v[236:239], a[200:203], v[28:31]
s_add_u32 s72, s71, 30720
buffer_load_dwordx4 v15, s[24:27], s72 offen offset:2048 lds
v_mfma_f32_16x16x32_bf16 v[28:31], v[220:223], a[196:199], v[28:31]
s_waitcnt vmcnt(12) lgkmcnt(0)
v_mfma_f32_16x16x32_bf16 v[28:31], v[204:207], a[192:195], v[28:31]
s_barrier
v_mfma_f32_16x16x32_bf16 v[16:19], v[128:131], a[224:227], v[16:19]
s_add_u32 s72, s71, 46080
buffer_load_dwordx4 v15, s[24:27], s72 offen offset:3072 lds
v_mfma_f32_16x16x32_bf16 v[16:19], v[144:147], a[228:231], v[16:19]
s_lshl_b32 s73, s75, 9
ds_read_b64_tr_b16 v[192:193], v8 offset:32768
ds_read_b64_tr_b16 v[194:195], v8 offset:34816
v_mfma_f32_16x16x32_bf16 v[16:19], v[160:163], a[232:235], v[16:19]
s_lshl_b32 s84, s58, 7
ds_read_b64_tr_b16 v[196:197], v9 offset:32768
ds_read_b64_tr_b16 v[198:199], v9 offset:34816
v_mfma_f32_16x16x32_bf16 v[16:19], v[176:179], a[236:239], v[16:19]
s_add_u32 s73, s73, s84
ds_read_b64_tr_b16 v[200:201], v10 offset:32768
ds_read_b64_tr_b16 v[202:203], v10 offset:34816
v_mfma_f32_16x16x32_bf16 v[20:23], v[180:183], a[236:239], v[20:23]
s_add_u32 s73, s73, 0x3800000
ds_read_b64_tr_b16 v[204:205], v11 offset:32768
ds_read_b64_tr_b16 v[206:207], v11 offset:34816
v_mfma_f32_16x16x32_bf16 v[20:23], v[164:167], a[232:235], v[20:23]
s_xor_b32 s71, s12, 0x0
buffer_load_dword v6, v113, s[44:47], s73 offen sc1
v_mfma_f32_16x16x32_bf16 v[20:23], v[148:151], a[228:231], v[20:23]
s_add_u32 m0, s77, 0
ds_read_b64_tr_b16 v[208:209], v8 offset:36864
ds_read_b64_tr_b16 v[210:211], v8 offset:38912
v_mfma_f32_16x16x32_bf16 v[20:23], v[132:135], a[224:227], v[20:23]
s_add_u32 s72, s71, 0
buffer_load_dwordx4 v15, s[24:27], s72 offen lds
v_mfma_f32_16x16x32_bf16 v[24:27], v[136:139], a[224:227], v[24:27]
s_nop 0
ds_read_b64_tr_b16 v[212:213], v9 offset:36864
ds_read_b64_tr_b16 v[214:215], v9 offset:38912
v_mfma_f32_16x16x32_bf16 v[24:27], v[152:155], a[228:231], v[24:27]
s_nop 0
ds_read_b64_tr_b16 v[216:217], v10 offset:36864
ds_read_b64_tr_b16 v[218:219], v10 offset:38912
v_mfma_f32_16x16x32_bf16 v[24:27], v[168:171], a[232:235], v[24:27]
buffer_load_dword v7, v113, s[44:47], s73 offen offset:64 sc1
v_mfma_f32_16x16x32_bf16 v[24:27], v[184:187], a[236:239], v[24:27]
s_nop 0
ds_read_b64_tr_b16 v[220:221], v11 offset:36864
ds_read_b64_tr_b16 v[222:223], v11 offset:38912
v_cvt_pk_bf16_f32 v16, v16, v17
v_mfma_f32_16x16x32_bf16 v[28:31], v[188:191], a[236:239], v[28:31]
s_nop 0
ds_read_b64_tr_b16 v[224:225], v8 offset:40960
ds_read_b64_tr_b16 v[226:227], v8 offset:43008
v_cvt_pk_bf16_f32 v17, v18, v19
v_mfma_f32_16x16x32_bf16 v[28:31], v[172:175], a[232:235], v[28:31]
s_add_u32 s72, s71, 15360
buffer_load_dwordx4 v15, s[24:27], s72 offen offset:1024 lds
v_cvt_pk_bf16_f32 v18, v20, v21
v_mfma_f32_16x16x32_bf16 v[28:31], v[156:159], a[228:231], v[28:31]
s_nop 0
ds_read_b64_tr_b16 v[228:229], v9 offset:40960
ds_read_b64_tr_b16 v[230:231], v9 offset:43008
v_cvt_pk_bf16_f32 v19, v22, v23
v_mfma_f32_16x16x32_bf16 v[28:31], v[140:143], a[224:227], v[28:31]
v_mfma_f32_16x16x32_bf16 v[32:35], v[128:131], a[240:243], v[32:35]
s_xor_b32 s80, s93, 0x80000
ds_read_b64_tr_b16 v[232:233], v10 offset:40960
ds_read_b64_tr_b16 v[234:235], v10 offset:43008
v_mfma_f32_16x16x32_bf16 v[32:35], v[144:147], a[244:247], v[32:35]
s_add_u32 s80, s80, 0x3a00000
buffer_store_dwordx4 v[16:19], v1, s[44:47], s80 offen sc1
v_mfma_f32_16x16x32_bf16 v[32:35], v[160:163], a[248:251], v[32:35]
s_nop 0
ds_read_b64_tr_b16 v[236:237], v11 offset:40960
ds_read_b64_tr_b16 v[238:239], v11 offset:43008
v_mfma_f32_16x16x32_bf16 v[32:35], v[176:179], a[252:255], v[32:35]
s_add_u32 s72, s71, 30720
buffer_load_dwordx4 v15, s[24:27], s72 offen offset:2048 lds
v_cvt_pk_bf16_f32 v20, v24, v25
v_mfma_f32_16x16x32_bf16 v[36:39], v[180:183], a[252:255], v[36:39]
s_nop 0
ds_read_b64_tr_b16 v[240:241], v8 offset:45056
ds_read_b64_tr_b16 v[242:243], v8 offset:47104
v_cvt_pk_bf16_f32 v21, v26, v27
v_mfma_f32_16x16x32_bf16 v[36:39], v[164:167], a[248:251], v[36:39]
v_cvt_pk_bf16_f32 v22, v28, v29
v_cvt_pk_bf16_f32 v23, v30, v31
v_mfma_f32_16x16x32_bf16 v[36:39], v[148:151], a[244:247], v[36:39]
s_nop 0
ds_read_b64_tr_b16 v[244:245], v9 offset:45056
ds_read_b64_tr_b16 v[246:247], v9 offset:47104
v_mfma_f32_16x16x32_bf16 v[36:39], v[132:135], a[240:243], v[36:39]
s_nop 0
ds_read_b64_tr_b16 v[248:249], v10 offset:45056
ds_read_b64_tr_b16 v[250:251], v10 offset:47104
v_mfma_f32_16x16x32_bf16 v[40:43], v[136:139], a[240:243], v[40:43]
s_nop 0
ds_read_b64_tr_b16 v[252:253], v11 offset:45056
ds_read_b64_tr_b16 v[254:255], v11 offset:47104
v_mfma_f32_16x16x32_bf16 v[40:43], v[152:155], a[244:247], v[40:43]
s_add_u32 s72, s71, 46080
buffer_load_dwordx4 v15, s[24:27], s72 offen offset:3072 lds
v_mfma_f32_16x16x32_bf16 v[40:43], v[168:171], a[248:251], v[40:43]
v_mfma_f32_16x16x32_bf16 v[40:43], v[184:187], a[252:255], v[40:43]
v_cvt_pk_bf16_f32 v24, v32, v33
v_cvt_pk_bf16_f32 v25, v34, v35
v_cvt_pk_bf16_f32 v26, v36, v37
v_mfma_f32_16x16x32_bf16 v[44:47], v[188:191], a[252:255], v[44:47]
v_cvt_pk_bf16_f32 v27, v38, v39
v_mfma_f32_16x16x32_bf16 v[44:47], v[172:175], a[248:251], v[44:47]
v_mfma_f32_16x16x32_bf16 v[44:47], v[156:159], a[244:247], v[44:47]
s_waitcnt vmcnt(33) lgkmcnt(0)
v_mfma_f32_16x16x32_bf16 v[44:47], v[140:143], a[240:243], v[44:47]
s_barrier
v_mfma_f32_16x16x32_bf16 v[48:51], v[192:195], a[160:163], v[48:51]
s_nop 0
ds_read_b64_tr_b16 v[128:129], v8 offset:49152
ds_read_b64_tr_b16 v[130:131], v8 offset:51200
v_mfma_f32_16x16x32_bf16 v[48:51], v[208:211], a[164:167], v[48:51]
s_xor_b32 s71, s13, 0x0
buffer_store_dwordx4 v[20:23], v1, s[44:47], s80 offen offset:1024 sc1
v_mfma_f32_16x16x32_bf16 v[48:51], v[224:227], a[168:171], v[48:51]
s_add_u32 m0, s77, 16384
ds_read_b64_tr_b16 v[132:133], v9 offset:49152
ds_read_b64_tr_b16 v[134:135], v9 offset:51200
v_mfma_f32_16x16x32_bf16 v[48:51], v[240:243], a[172:175], v[48:51]
s_add_u32 s72, s71, 0
buffer_load_dwordx4 v15, s[24:27], s72 offen lds
v_cvt_pk_bf16_f32 v28, v40, v41
v_mfma_f32_16x16x32_bf16 v[64:67], v[240:243], a[188:191], v[64:67]
s_nop 0
ds_read_b64_tr_b16 v[136:137], v10 offset:49152
ds_read_b64_tr_b16 v[138:139], v10 offset:51200
v_cvt_pk_bf16_f32 v29, v42, v43
v_mfma_f32_16x16x32_bf16 v[64:67], v[224:227], a[184:187], v[64:67]
s_nop 0
ds_read_b64_tr_b16 v[140:141], v11 offset:49152
ds_read_b64_tr_b16 v[142:143], v11 offset:51200
v_cvt_pk_bf16_f32 v30, v44, v45
v_mfma_f32_16x16x32_bf16 v[64:67], v[208:211], a[180:183], v[64:67]
v_cvt_pk_bf16_f32 v31, v46, v47
v_mfma_f32_16x16x32_bf16 v[64:67], v[192:195], a[176:179], v[64:67]
s_nop 0
ds_read_b64_tr_b16 v[144:145], v8 offset:53248
ds_read_b64_tr_b16 v[146:147], v8 offset:55296
v_mfma_f32_16x16x32_bf16 v[68:71], v[196:199], a[176:179], v[68:71]
s_add_u32 s72, s71, 15360
buffer_load_dwordx4 v15, s[24:27], s72 offen offset:1024 lds
v_mfma_f32_16x16x32_bf16 v[68:71], v[212:215], a[180:183], v[68:71]
s_nop 0
ds_read_b64_tr_b16 v[148:149], v9 offset:53248
ds_read_b64_tr_b16 v[150:151], v9 offset:55296
v_mfma_f32_16x16x32_bf16 v[68:71], v[228:231], a[184:187], v[68:71]
s_nop 0
ds_read_b64_tr_b16 v[152:153], v10 offset:53248
ds_read_b64_tr_b16 v[154:155], v10 offset:55296
v_mfma_f32_16x16x32_bf16 v[68:71], v[244:247], a[188:191], v[68:71]
v_mfma_f32_16x16x32_bf16 v[52:55], v[244:247], a[172:175], v[52:55]
s_nop 0
ds_read_b64_tr_b16 v[156:157], v11 offset:53248
ds_read_b64_tr_b16 v[158:159], v11 offset:55296
v_mfma_f32_16x16x32_bf16 v[52:55], v[228:231], a[168:171], v[52:55]
s_nop 0
ds_read_b64_tr_b16 v[160:161], v8 offset:57344
ds_read_b64_tr_b16 v[162:163], v8 offset:59392
v_mfma_f32_16x16x32_bf16 v[52:55], v[212:215], a[164:167], v[52:55]
s_add_u32 s72, s71, 30720
buffer_load_dwordx4 v15, s[24:27], s72 offen offset:2048 lds
v_mfma_f32_16x16x32_bf16 v[52:55], v[196:199], a[160:163], v[52:55]
s_nop 0
ds_read_b64_tr_b16 v[164:165], v9 offset:57344
ds_read_b64_tr_b16 v[166:167], v9 offset:59392
v_mfma_f32_16x16x32_bf16 v[56:59], v[200:203], a[160:163], v[56:59]
v_mfma_f32_16x16x32_bf16 v[56:59], v[216:219], a[164:167], v[56:59]
buffer_store_dwordx4 v[24:27], v1, s[44:47], s80 offen offset:2048 sc1
v_mfma_f32_16x16x32_bf16 v[56:59], v[232:235], a[168:171], v[56:59]
s_nop 0
ds_read_b64_tr_b16 v[168:169], v10 offset:57344
ds_read_b64_tr_b16 v[170:171], v10 offset:59392
v_mfma_f32_16x16x32_bf16 v[56:59], v[248:251], a[172:175], v[56:59]
s_nop 0
ds_read_b64_tr_b16 v[172:173], v11 offset:57344
ds_read_b64_tr_b16 v[174:175], v11 offset:59392
v_mfma_f32_16x16x32_bf16 v[72:75], v[248:251], a[188:191], v[72:75]
s_add_u32 s72, s71, 46080
buffer_load_dwordx4 v15, s[24:27], s72 offen offset:3072 lds
v_mfma_f32_16x16x32_bf16 v[72:75], v[232:235], a[184:187], v[72:75]
s_nop 0
ds_read_b64_tr_b16 v[176:177], v8 offset:61440
ds_read_b64_tr_b16 v[178:179], v8 offset:63488
v_mfma_f32_16x16x32_bf16 v[72:75], v[216:219], a[180:183], v[72:75]
v_mfma_f32_16x16x32_bf16 v[72:75], v[200:203], a[176:179], v[72:75]
s_nop 0
ds_read_b64_tr_b16 v[180:181], v9 offset:61440
ds_read_b64_tr_b16 v[182:183], v9 offset:63488
v_mfma_f32_16x16x32_bf16 v[76:79], v[204:207], a[176:179], v[76:79]
s_nop 0
ds_read_b64_tr_b16 v[184:185], v10 offset:61440
ds_read_b64_tr_b16 v[186:187], v10 offset:63488
v_mfma_f32_16x16x32_bf16 v[76:79], v[220:223], a[180:183], v[76:79]
s_nop 0
ds_read_b64_tr_b16 v[188:189], v11 offset:61440
ds_read_b64_tr_b16 v[190:191], v11 offset:63488
v_mfma_f32_16x16x32_bf16 v[76:79], v[236:239], a[184:187], v[76:79]
v_mfma_f32_16x16x32_bf16 v[76:79], v[252:255], a[188:191], v[76:79]
s_xor_b32 s71, s14, 0x0
v_mfma_f32_16x16x32_bf16 v[60:63], v[252:255], a[172:175], v[60:63]
s_add_u32 m0, s77, 32768
v_xor_b32 v8, 0x10000, v8
v_mfma_f32_16x16x32_bf16 v[60:63], v[236:239], a[168:171], v[60:63]
s_add_u32 s72, s71, 0
v_xor_b32 v9, 0x10000, v9
v_mfma_f32_16x16x32_bf16 v[60:63], v[220:223], a[164:167], v[60:63]
s_waitcnt vmcnt(32) lgkmcnt(0)
buffer_load_dwordx4 v15, s[24:27], s72 offen lds
v_xor_b32 v10, 0x10000, v10
v_mfma_f32_16x16x32_bf16 v[60:63], v[204:207], a[160:163], v[60:63]
s_barrier
v_xor_b32 v11, 0x10000, v11
v_mfma_f32_16x16x32_bf16 v[48:51], v[128:131], a[192:195], v[48:51]
s_nop 0
ds_read_b64_tr_b16 v[192:193], v8 offset:0
ds_read_b64_tr_b16 v[194:195], v8 offset:2048
v_mfma_f32_16x16x32_bf16 v[48:51], v[144:147], a[196:199], v[48:51]
buffer_store_dwordx4 v[28:31], v1, s[44:47], s80 offen offset:3072 sc1
v_mfma_f32_16x16x32_bf16 v[48:51], v[160:163], a[200:203], v[48:51]
s_nop 0
ds_read_b64_tr_b16 v[196:197], v9 offset:0
ds_read_b64_tr_b16 v[198:199], v9 offset:2048
v_mfma_f32_16x16x32_bf16 v[48:51], v[176:179], a[204:207], v[48:51]
s_add_u32 s72, s71, 15360
buffer_load_dwordx4 v15, s[24:27], s72 offen offset:1024 lds
v_mfma_f32_16x16x32_bf16 v[64:67], v[176:179], a[220:223], v[64:67]
s_nop 0
ds_read_b64_tr_b16 v[200:201], v10 offset:0
ds_read_b64_tr_b16 v[202:203], v10 offset:2048
v_mfma_f32_16x16x32_bf16 v[64:67], v[160:163], a[216:219], v[64:67]
v_mfma_f32_16x16x32_bf16 v[64:67], v[144:147], a[212:215], v[64:67]
s_nop 0
ds_read_b64_tr_b16 v[204:205], v11 offset:0
ds_read_b64_tr_b16 v[206:207], v11 offset:2048
v_mfma_f32_16x16x32_bf16 v[64:67], v[128:131], a[208:211], v[64:67]
s_nop 0
ds_read_b64_tr_b16 v[208:209], v8 offset:4096
ds_read_b64_tr_b16 v[210:211], v8 offset:6144
v_mfma_f32_16x16x32_bf16 v[68:71], v[132:135], a[208:211], v[68:71]
s_nop 0
ds_read_b64_tr_b16 v[212:213], v9 offset:4096
ds_read_b64_tr_b16 v[214:215], v9 offset:6144
v_mfma_f32_16x16x32_bf16 v[68:71], v[148:151], a[212:215], v[68:71]
s_add_u32 s72, s71, 30720
buffer_load_dwordx4 v15, s[24:27], s72 offen offset:2048 lds
v_mfma_f32_16x16x32_bf16 v[68:71], v[164:167], a[216:219], v[68:71]
v_mfma_f32_16x16x32_bf16 v[68:71], v[180:183], a[220:223], v[68:71]
s_nop 0
ds_read_b64_tr_b16 v[216:217], v10 offset:4096
ds_read_b64_tr_b16 v[218:219], v10 offset:6144
v_mfma_f32_16x16x32_bf16 v[52:55], v[180:183], a[204:207], v[52:55]
s_nop 0
ds_read_b64_tr_b16 v[220:221], v11 offset:4096
ds_read_b64_tr_b16 v[222:223], v11 offset:6144
v_mfma_f32_16x16x32_bf16 v[52:55], v[164:167], a[200:203], v[52:55]
v_mfma_f32_16x16x32_bf16 v[52:55], v[148:151], a[196:199], v[52:55]
s_nop 0
ds_read_b64_tr_b16 v[224:225], v8 offset:8192
ds_read_b64_tr_b16 v[226:227], v8 offset:10240
v_mfma_f32_16x16x32_bf16 v[52:55], v[132:135], a[192:195], v[52:55]
s_add_u32 s72, s71, 46080
buffer_load_dwordx4 v15, s[24:27], s72 offen offset:3072 lds
v_mfma_f32_16x16x32_bf16 v[56:59], v[136:139], a[192:195], v[56:59]
s_nop 0
ds_read_b64_tr_b16 v[228:229], v9 offset:8192
ds_read_b64_tr_b16 v[230:231], v9 offset:10240
v_mfma_f32_16x16x32_bf16 v[56:59], v[152:155], a[196:199], v[56:59]
s_nop 0
ds_read_b64_tr_b16 v[232:233], v10 offset:8192
ds_read_b64_tr_b16 v[234:235], v10 offset:10240
v_mfma_f32_16x16x32_bf16 v[56:59], v[168:171], a[200:203], v[56:59]
v_mfma_f32_16x16x32_bf16 v[56:59], v[184:187], a[204:207], v[56:59]
s_nop 0
ds_read_b64_tr_b16 v[236:237], v11 offset:8192
ds_read_b64_tr_b16 v[238:239], v11 offset:10240
v_mfma_f32_16x16x32_bf16 v[72:75], v[184:187], a[220:223], v[72:75]
s_nop 0
ds_read_b64_tr_b16 v[240:241], v8 offset:12288
ds_read_b64_tr_b16 v[242:243], v8 offset:14336
v_mfma_f32_16x16x32_bf16 v[72:75], v[168:171], a[216:219], v[72:75]
s_nop 0
ds_read_b64_tr_b16 v[244:245], v9 offset:12288
ds_read_b64_tr_b16 v[246:247], v9 offset:14336
v_mfma_f32_16x16x32_bf16 v[72:75], v[152:155], a[212:215], v[72:75]
Lstube3:
s_cbranch_execz Lrete
v_mfma_f32_16x16x32_bf16 v[72:75], v[136:139], a[208:211], v[72:75]
s_xor_b32 s71, s15, 0x0
ds_read_b64_tr_b16 v[248:249], v10 offset:12288
ds_read_b64_tr_b16 v[250:251], v10 offset:14336
v_mfma_f32_16x16x32_bf16 v[76:79], v[140:143], a[208:211], v[76:79]
s_add_u32 m0, s77, 49152
ds_read_b64_tr_b16 v[252:253], v11 offset:12288
ds_read_b64_tr_b16 v[254:255], v11 offset:14336
v_mfma_f32_16x16x32_bf16 v[76:79], v[156:159], a[212:215], v[76:79]
s_add_u32 s72, s71, 0
buffer_load_dwordx4 v15, s[24:27], s72 offen lds
v_mfma_f32_16x16x32_bf16 v[76:79], v[172:175], a[216:219], v[76:79]
v_mfma_f32_16x16x32_bf16 v[76:79], v[188:191], a[220:223], v[76:79]
v_mfma_f32_16x16x32_bf16 v[60:63], v[188:191], a[204:207], v[60:63]
v_mfma_f32_16x16x32_bf16 v[60:63], v[172:175], a[200:203], v[60:63]
s_add_u32 s72, s71, 15360
v_mfma_f32_16x16x32_bf16 v[60:63], v[156:159], a[196:199], v[60:63]
s_waitcnt vmcnt(31) lgkmcnt(0)
v_mfma_f32_16x16x32_bf16 v[60:63], v[140:143], a[192:195], v[60:63]
s_barrier
buffer_load_dwordx4 v15, s[24:27], s72 offen offset:1024 lds
v_mfma_f32_16x16x32_bf16 v[48:51], v[192:195], a[224:227], v[48:51]
s_nop 0
ds_read_b64_tr_b16 v[128:129], v8 offset:16384
ds_read_b64_tr_b16 v[130:131], v8 offset:18432
v_mfma_f32_16x16x32_bf16 v[48:51], v[208:211], a[228:231], v[48:51]
s_nop 0
ds_read_b64_tr_b16 v[132:133], v9 offset:16384
ds_read_b64_tr_b16 v[134:135], v9 offset:18432
v_mfma_f32_16x16x32_bf16 v[48:51], v[224:227], a[232:235], v[48:51]
s_nop 0
ds_read_b64_tr_b16 v[136:137], v10 offset:16384
ds_read_b64_tr_b16 v[138:139], v10 offset:18432
v_mfma_f32_16x16x32_bf16 v[48:51], v[240:243], a[236:239], v[48:51]
v_mfma_f32_16x16x32_bf16 v[52:55], v[244:247], a[236:239], v[52:55]
s_nop 0
ds_read_b64_tr_b16 v[140:141], v11 offset:16384
ds_read_b64_tr_b16 v[142:143], v11 offset:18432
v_mfma_f32_16x16x32_bf16 v[52:55], v[228:231], a[232:235], v[52:55]
s_add_u32 s72, s71, 30720
buffer_load_dwordx4 v15, s[24:27], s72 offen offset:2048 lds
v_mfma_f32_16x16x32_bf16 v[52:55], v[212:215], a[228:231], v[52:55]
s_nop 0
ds_read_b64_tr_b16 v[144:145], v8 offset:20480
ds_read_b64_tr_b16 v[146:147], v8 offset:22528
v_mfma_f32_16x16x32_bf16 v[52:55], v[196:199], a[224:227], v[52:55]
s_nop 0
ds_read_b64_tr_b16 v[148:149], v9 offset:20480
ds_read_b64_tr_b16 v[150:151], v9 offset:22528
v_mfma_f32_16x16x32_bf16 v[56:59], v[200:203], a[224:227], v[56:59]
v_mfma_f32_16x16x32_bf16 v[56:59], v[216:219], a[228:231], v[56:59]
s_nop 0
ds_read_b64_tr_b16 v[152:153], v10 offset:20480
ds_read_b64_tr_b16 v[154:155], v10 offset:22528
v_mfma_f32_16x16x32_bf16 v[56:59], v[232:235], a[232:235], v[56:59]
s_nop 0
ds_read_b64_tr_b16 v[156:157], v11 offset:20480
ds_read_b64_tr_b16 v[158:159], v11 offset:22528
v_mfma_f32_16x16x32_bf16 v[56:59], v[248:251], a[236:239], v[56:59]
s_add_u32 s72, s71, 46080
buffer_load_dwordx4 v15, s[24:27], s72 offen offset:3072 lds
v_cvt_pk_bf16_f32 v48, v48, v49
v_mfma_f32_16x16x32_bf16 v[60:63], v[252:255], a[236:239], v[60:63]
v_cvt_pk_bf16_f32 v49, v50, v51
v_cvt_pk_bf16_f32 v50, v52, v53
v_cvt_pk_bf16_f32 v51, v54, v55
v_mfma_f32_16x16x32_bf16 v[60:63], v[236:239], a[232:235], v[60:63]
s_nop 0
ds_read_b64_tr_b16 v[160:161], v8 offset:24576
ds_read_b64_tr_b16 v[162:163], v8 offset:26624
v_mfma_f32_16x16x32_bf16 v[60:63], v[220:223], a[228:231], v[60:63]
s_nop 0
ds_read_b64_tr_b16 v[164:165], v9 offset:24576
ds_read_b64_tr_b16 v[166:167], v9 offset:26624
v_mfma_f32_16x16x32_bf16 v[60:63], v[204:207], a[224:227], v[60:63]
s_nop 0
ds_read_b64_tr_b16 v[168:169], v10 offset:24576
ds_read_b64_tr_b16 v[170:171], v10 offset:26624
v_mfma_f32_16x16x32_bf16 v[64:67], v[192:195], a[240:243], v[64:67]
s_xor_b32 s80, s93, 0x100000
v_mfma_f32_16x16x32_bf16 v[64:67], v[208:211], a[244:247], v[64:67]
s_add_u32 s80, s80, 0x3e00000
buffer_store_dwordx4 v[48:51], v1, s[44:47], s80 offen sc1
v_mfma_f32_16x16x32_bf16 v[64:67], v[224:227], a[248:251], v[64:67]
s_nop 0
ds_read_b64_tr_b16 v[172:173], v11 offset:24576
ds_read_b64_tr_b16 v[174:175], v11 offset:26624
v_mfma_f32_16x16x32_bf16 v[64:67], v[240:243], a[252:255], v[64:67]
s_xor_b32 s71, s12, 0x400000
ds_read_b64_tr_b16 v[176:177], v8 offset:28672
ds_read_b64_tr_b16 v[178:179], v8 offset:30720
v_cvt_pk_bf16_f32 v52, v56, v57
v_mfma_f32_16x16x32_bf16 v[68:71], v[244:247], a[252:255], v[68:71]
s_add_u32 m0, s85, 0
ds_read_b64_tr_b16 v[180:181], v9 offset:28672
ds_read_b64_tr_b16 v[182:183], v9 offset:30720
v_cvt_pk_bf16_f32 v53, v58, v59
v_mfma_f32_16x16x32_bf16 v[68:71], v[228:231], a[248:251], v[68:71]
s_add_u32 s72, s71, 0
buffer_load_dwordx4 v15, s[24:27], s72 offen lds
v_cvt_pk_bf16_f32 v54, v60, v61
v_mfma_f32_16x16x32_bf16 v[68:71], v[212:215], a[244:247], v[68:71]
v_cvt_pk_bf16_f32 v55, v62, v63
v_mfma_f32_16x16x32_bf16 v[68:71], v[196:199], a[240:243], v[68:71]
s_nop 0
ds_read_b64_tr_b16 v[184:185], v10 offset:28672
ds_read_b64_tr_b16 v[186:187], v10 offset:30720
v_mfma_f32_16x16x32_bf16 v[72:75], v[200:203], a[240:243], v[72:75]
s_nop 0
ds_read_b64_tr_b16 v[188:189], v11 offset:28672
ds_read_b64_tr_b16 v[190:191], v11 offset:30720
v_mfma_f32_16x16x32_bf16 v[72:75], v[216:219], a[244:247], v[72:75]
v_mfma_f32_16x16x32_bf16 v[72:75], v[232:235], a[248:251], v[72:75]
s_add_u32 s72, s71, 15360
buffer_load_dwordx4 v15, s[24:27], s72 offen offset:1024 lds
v_mfma_f32_16x16x32_bf16 v[72:75], v[248:251], a[252:255], v[72:75]
v_cvt_pk_bf16_f32 v56, v64, v65
v_cvt_pk_bf16_f32 v57, v66, v67
v_cvt_pk_bf16_f32 v58, v68, v69
v_mfma_f32_16x16x32_bf16 v[76:79], v[252:255], a[252:255], v[76:79]
v_cvt_pk_bf16_f32 v59, v70, v71
v_mfma_f32_16x16x32_bf16 v[76:79], v[236:239], a[248:251], v[76:79]
v_mfma_f32_16x16x32_bf16 v[76:79], v[220:223], a[244:247], v[76:79]
s_waitcnt vmcnt(29) lgkmcnt(0)
v_mfma_f32_16x16x32_bf16 v[76:79], v[204:207], a[240:243], v[76:79]
s_barrier
v_mfma_f32_16x16x32_bf16 v[80:83], v[128:131], a[160:163], v[80:83]
s_add_u32 s72, s71, 30720
buffer_load_dwordx4 v15, s[24:27], s72 offen offset:2048 lds
v_mfma_f32_16x16x32_bf16 v[80:83], v[144:147], a[164:167], v[80:83]
s_waitcnt vmcnt(23)
buffer_store_dwordx4 v[52:55], v1, s[44:47], s80 offen offset:1024 sc1
v_mfma_f32_16x16x32_bf16 v[80:83], v[160:163], a[168:171], v[80:83]
s_nop 0
ds_read_b64_tr_b16 v[192:193], v8 offset:32768
ds_read_b64_tr_b16 v[194:195], v8 offset:34816
v_mfma_f32_16x16x32_bf16 v[80:83], v[176:179], a[172:175], v[80:83]
s_nop 0
ds_read_b64_tr_b16 v[196:197], v9 offset:32768
ds_read_b64_tr_b16 v[198:199], v9 offset:34816
v_cvt_pk_bf16_f32 v60, v72, v73
v_mfma_f32_16x16x32_bf16 v[96:99], v[176:179], a[188:191], v[96:99]
s_nop 0
ds_read_b64_tr_b16 v[200:201], v10 offset:32768
ds_read_b64_tr_b16 v[202:203], v10 offset:34816
v_cvt_pk_bf16_f32 v61, v74, v75
v_mfma_f32_16x16x32_bf16 v[96:99], v[160:163], a[184:187], v[96:99]
s_nop 0
ds_read_b64_tr_b16 v[204:205], v11 offset:32768
ds_read_b64_tr_b16 v[206:207], v11 offset:34816
v_cvt_pk_bf16_f32 v62, v76, v77
v_mfma_f32_16x16x32_bf16 v[96:99], v[144:147], a[180:183], v[96:99]
s_add_u32 s72, s71, 46080
buffer_load_dwordx4 v15, s[24:27], s72 offen offset:3072 lds
v_cvt_pk_bf16_f32 v63, v78, v79
v_mfma_f32_16x16x32_bf16 v[96:99], v[128:131], a[176:179], v[96:99]
v_sub_f32 v112, 1.0, v6
v_sub_f32 v113, 1.0, v7
v_mfma_f32_16x16x32_bf16 v[100:103], v[132:135], a[176:179], v[100:103]
s_nop 0
ds_read_b64_tr_b16 v[208:209], v8 offset:36864
ds_read_b64_tr_b16 v[210:211], v8 offset:38912
v_mfma_f32_16x16x32_bf16 v[100:103], v[148:151], a[180:183], v[100:103]
s_nop 0
ds_read_b64_tr_b16 v[212:213], v9 offset:36864
ds_read_b64_tr_b16 v[214:215], v9 offset:38912
v_mfma_f32_16x16x32_bf16 v[100:103], v[164:167], a[184:187], v[100:103]
s_nop 0
ds_read_b64_tr_b16 v[216:217], v10 offset:36864
ds_read_b64_tr_b16 v[218:219], v10 offset:38912
v_mfma_f32_16x16x32_bf16 v[100:103], v[180:183], a[188:191], v[100:103]
v_mfma_f32_16x16x32_bf16 v[84:87], v[180:183], a[172:175], v[84:87]
s_nop 0
ds_read_b64_tr_b16 v[220:221], v11 offset:36864
ds_read_b64_tr_b16 v[222:223], v11 offset:38912
v_mfma_f32_16x16x32_bf16 v[84:87], v[164:167], a[168:171], v[84:87]
s_nop 0
ds_read_b64_tr_b16 v[224:225], v8 offset:40960
ds_read_b64_tr_b16 v[226:227], v8 offset:43008
v_mfma_f32_16x16x32_bf16 v[84:87], v[148:151], a[164:167], v[84:87]
s_xor_b32 s71, s13, 0x400000
ds_read_b64_tr_b16 v[228:229], v9 offset:40960
ds_read_b64_tr_b16 v[230:231], v9 offset:43008
v_mfma_f32_16x16x32_bf16 v[84:87], v[132:135], a[160:163], v[84:87]
s_add_u32 m0, s85, 16384
v_mfma_f32_16x16x32_bf16 v[88:91], v[136:139], a[160:163], v[88:91]
s_add_u32 s72, s71, 0
buffer_load_dwordx4 v15, s[24:27], s72 offen lds
v_mfma_f32_16x16x32_bf16 v[88:91], v[152:155], a[164:167], v[88:91]
buffer_store_dwordx4 v[56:59], v1, s[44:47], s80 offen offset:2048 sc1
v_mfma_f32_16x16x32_bf16 v[88:91], v[168:171], a[168:171], v[88:91]
s_nop 0
ds_read_b64_tr_b16 v[232:233], v10 offset:40960
ds_read_b64_tr_b16 v[234:235], v10 offset:43008
v_mfma_f32_16x16x32_bf16 v[88:91], v[184:187], a[172:175], v[88:91]
s_nop 0
ds_read_b64_tr_b16 v[236:237], v11 offset:40960
ds_read_b64_tr_b16 v[238:239], v11 offset:43008
v_mfma_f32_16x16x32_bf16 v[104:107], v[184:187], a[188:191], v[104:107]
s_nop 0
ds_read_b64_tr_b16 v[240:241], v8 offset:45056
ds_read_b64_tr_b16 v[242:243], v8 offset:47104
v_mfma_f32_16x16x32_bf16 v[104:107], v[168:171], a[184:187], v[104:107]
v_mfma_f32_16x16x32_bf16 v[104:107], v[152:155], a[180:183], v[104:107]
s_add_u32 s72, s71, 15360
buffer_load_dwordx4 v15, s[24:27], s72 offen offset:1024 lds
v_mfma_f32_16x16x32_bf16 v[104:107], v[136:139], a[176:179], v[104:107]
s_nop 0
ds_read_b64_tr_b16 v[244:245], v9 offset:45056
ds_read_b64_tr_b16 v[246:247], v9 offset:47104
v_mfma_f32_16x16x32_bf16 v[108:111], v[140:143], a[176:179], v[108:111]
s_nop 0
ds_read_b64_tr_b16 v[248:249], v10 offset:45056
ds_read_b64_tr_b16 v[250:251], v10 offset:47104
v_mfma_f32_16x16x32_bf16 v[108:111], v[156:159], a[180:183], v[108:111]
s_nop 0
ds_read_b64_tr_b16 v[252:253], v11 offset:45056
ds_read_b64_tr_b16 v[254:255], v11 offset:47104
v_mfma_f32_16x16x32_bf16 v[108:111], v[172:175], a[184:187], v[108:111]
v_mfma_f32_16x16x32_bf16 v[108:111], v[188:191], a[188:191], v[108:111]
v_mfma_f32_16x16x32_bf16 v[92:95], v[188:191], a[172:175], v[92:95]
s_add_u32 s72, s71, 30720
buffer_load_dwordx4 v15, s[24:27], s72 offen offset:2048 lds
v_mfma_f32_16x16x32_bf16 v[92:95], v[172:175], a[168:171], v[92:95]
v_mfma_f32_16x16x32_bf16 v[92:95], v[156:159], a[164:167], v[92:95]
s_waitcnt vmcnt(32) lgkmcnt(0)
v_mfma_f32_16x16x32_bf16 v[92:95], v[140:143], a[160:163], v[92:95]
s_barrier
v_mfma_f32_16x16x32_bf16 v[80:83], v[192:195], a[192:195], v[80:83]
s_nop 0
ds_read_b64_tr_b16 v[128:129], v8 offset:49152
ds_read_b64_tr_b16 v[130:131], v8 offset:51200
v_mfma_f32_16x16x32_bf16 v[80:83], v[208:211], a[196:199], v[80:83]
buffer_store_dwordx4 v[60:63], v1, s[44:47], s80 offen offset:3072 sc1
v_mfma_f32_16x16x32_bf16 v[80:83], v[224:227], a[200:203], v[80:83]
s_add_u32 s72, s71, 46080
buffer_load_dwordx4 v15, s[24:27], s72 offen offset:3072 lds
v_mfma_f32_16x16x32_bf16 v[80:83], v[240:243], a[204:207], v[80:83]
s_nop 0
ds_read_b64_tr_b16 v[132:133], v9 offset:49152
ds_read_b64_tr_b16 v[134:135], v9 offset:51200
v_mfma_f32_16x16x32_bf16 v[96:99], v[240:243], a[220:223], v[96:99]
s_nop 0
ds_read_b64_tr_b16 v[136:137], v10 offset:49152
ds_read_b64_tr_b16 v[138:139], v10 offset:51200
v_mfma_f32_16x16x32_bf16 v[96:99], v[224:227], a[216:219], v[96:99]
s_nop 0
ds_read_b64 v[48:49], v116 offset:0
ds_read_b64_tr_b16 v[64:65], v5 offset:0
v_mfma_f32_16x16x32_bf16 v[96:99], v[208:211], a[212:215], v[96:99]
s_nop 0
ds_read_b64_tr_b16 v[140:141], v11 offset:49152
ds_read_b64_tr_b16 v[142:143], v11 offset:51200
v_mfma_f32_16x16x32_bf16 v[96:99], v[192:195], a[208:211], v[96:99]
s_nop 0
ds_read_b64_tr_b16 v[144:145], v8 offset:53248
ds_read_b64_tr_b16 v[146:147], v8 offset:55296
v_mfma_f32_16x16x32_bf16 v[100:103], v[196:199], a[208:211], v[100:103]
s_nop 0
ds_read_b64_tr_b16 v[148:149], v9 offset:53248
ds_read_b64_tr_b16 v[150:151], v9 offset:55296
v_mfma_f32_16x16x32_bf16 v[100:103], v[212:215], a[212:215], v[100:103]
s_nop 0
ds_read_b64 v[50:51], v117 offset:0
ds_read_b64_tr_b16 v[66:67], v5 offset:4096
v_mfma_f32_16x16x32_bf16 v[100:103], v[228:231], a[216:219], v[100:103]
s_xor_b32 s71, s14, 0x400000
ds_read_b64_tr_b16 v[152:153], v10 offset:53248
ds_read_b64_tr_b16 v[154:155], v10 offset:55296
v_mfma_f32_16x16x32_bf16 v[100:103], v[244:247], a[220:223], v[100:103]
s_add_u32 m0, s85, 32768
ds_read_b64_tr_b16 v[156:157], v11 offset:53248
ds_read_b64_tr_b16 v[158:159], v11 offset:55296
v_mfma_f32_16x16x32_bf16 v[84:87], v[244:247], a[204:207], v[84:87]
s_add_u32 s72, s71, 0
buffer_load_dwordx4 v15, s[24:27], s72 offen lds
v_mfma_f32_16x16x32_bf16 v[84:87], v[228:231], a[200:203], v[84:87]
s_nop 0
ds_read_b64 v[52:53], v118 offset:0
ds_read_b64_tr_b16 v[68:69], v5 offset:8192
v_mfma_f32_16x16x32_bf16 v[84:87], v[212:215], a[196:199], v[84:87]
s_nop 0
ds_read_b64_tr_b16 v[160:161], v8 offset:57344
ds_read_b64_tr_b16 v[162:163], v8 offset:59392
v_mfma_f32_16x16x32_bf16 v[84:87], v[196:199], a[192:195], v[84:87]
s_nop 0
ds_read_b64_tr_b16 v[164:165], v9 offset:57344
ds_read_b64_tr_b16 v[166:167], v9 offset:59392
v_mfma_f32_16x16x32_bf16 v[88:91], v[200:203], a[192:195], v[88:91]
s_nop 0
ds_read_b64_tr_b16 v[168:169], v10 offset:57344
ds_read_b64_tr_b16 v[170:171], v10 offset:59392
v_mfma_f32_16x16x32_bf16 v[88:91], v[216:219], a[196:199], v[88:91]
s_add_u32 s72, s71, 15360
buffer_load_dwordx4 v15, s[24:27], s72 offen offset:1024 lds
v_mfma_f32_16x16x32_bf16 v[88:91], v[232:235], a[200:203], v[88:91]
s_nop 0
ds_read_b64 v[54:55], v119 offset:0
ds_read_b64_tr_b16 v[70:71], v5 offset:12288
v_mfma_f32_16x16x32_bf16 v[88:91], v[248:251], a[204:207], v[88:91]
s_nop 0
ds_read_b64_tr_b16 v[172:173], v11 offset:57344
ds_read_b64_tr_b16 v[174:175], v11 offset:59392
v_mfma_f32_16x16x32_bf16 v[104:107], v[248:251], a[220:223], v[104:107]
s_nop 0
ds_read_b64_tr_b16 v[176:177], v8 offset:61440
ds_read_b64_tr_b16 v[178:179], v8 offset:63488
v_mfma_f32_16x16x32_bf16 v[104:107], v[232:235], a[216:219], v[104:107]
s_nop 0
ds_read_b64_tr_b16 v[180:181], v9 offset:61440
ds_read_b64_tr_b16 v[182:183], v9 offset:63488
v_mfma_f32_16x16x32_bf16 v[104:107], v[216:219], a[212:215], v[104:107]
v_xor_b32 v5, 16, v5
v_mfma_f32_16x16x32_bf16 v[104:107], v[200:203], a[208:211], v[104:107]
s_add_u32 s72, s71, 30720
buffer_load_dwordx4 v15, s[24:27], s72 offen offset:2048 lds
v_mfma_f32_16x16x32_bf16 v[108:111], v[204:207], a[208:211], v[108:111]
s_nop 0
ds_read_b64_tr_b16 v[184:185], v10 offset:61440
ds_read_b64_tr_b16 v[186:187], v10 offset:63488
v_mfma_f32_16x16x32_bf16 v[108:111], v[220:223], a[212:215], v[108:111]
s_nop 0
ds_read_b64_tr_b16 v[188:189], v11 offset:61440
ds_read_b64_tr_b16 v[190:191], v11 offset:63488
v_mfma_f32_16x16x32_bf16 v[108:111], v[236:239], a[216:219], v[108:111]
s_nop 0
ds_read_b64 v[56:57], v116 offset:2048
ds_read_b64_tr_b16 v[72:73], v5 offset:0
v_mfma_f32_16x16x32_bf16 v[108:111], v[252:255], a[220:223], v[108:111]
s_nop 0
ds_read_b64 v[58:59], v117 offset:2048
ds_read_b64_tr_b16 v[74:75], v5 offset:4096
v_mfma_f32_16x16x32_bf16 v[92:95], v[252:255], a[204:207], v[92:95]
ds_read_b64 v[60:61], v118 offset:2048
v_xor_b32 v8, 0x10000, v8
v_mfma_f32_16x16x32_bf16 v[92:95], v[236:239], a[200:203], v[92:95]
s_add_u32 s72, s71, 46080
buffer_load_dwordx4 v15, s[24:27], s72 offen offset:3072 lds
v_xor_b32 v9, 0x10000, v9
v_mfma_f32_16x16x32_bf16 v[92:95], v[220:223], a[196:199], v[92:95]
s_waitcnt vmcnt(31) lgkmcnt(0)
ds_read_b64_tr_b16 v[76:77], v5 offset:8192
v_xor_b32 v10, 0x10000, v10
v_mfma_f32_16x16x32_bf16 v[92:95], v[204:207], a[192:195], v[92:95]
s_barrier
ds_read_b64 v[62:63], v119 offset:2048
v_xor_b32 v11, 0x10000, v11
v_mfma_f32_16x16x32_bf16 v[80:83], v[128:131], a[224:227], v[80:83]
s_nop 0
ds_read_b64_tr_b16 v[192:193], v8 offset:0
ds_read_b64_tr_b16 v[194:195], v8 offset:2048
v_mfma_f32_16x16x32_bf16 v[80:83], v[144:147], a[228:231], v[80:83]
s_nop 0
ds_read_b64_tr_b16 v[196:197], v9 offset:0
ds_read_b64_tr_b16 v[198:199], v9 offset:2048
v_mfma_f32_16x16x32_bf16 v[80:83], v[160:163], a[232:235], v[80:83]
s_nop 0
ds_read_b64_tr_b16 v[200:201], v10 offset:0
ds_read_b64_tr_b16 v[202:203], v10 offset:2048
v_mfma_f32_16x16x32_bf16 v[80:83], v[176:179], a[236:239], v[80:83]
ds_read_b64_tr_b16 v[78:79], v5 offset:12288
v_mfma_f32_16x16x32_bf16 v[84:87], v[180:183], a[236:239], v[84:87]
s_nop 0
ds_read_b64_tr_b16 v[204:205], v11 offset:0
ds_read_b64_tr_b16 v[206:207], v11 offset:2048
v_mfma_f32_16x16x32_bf16 v[84:87], v[164:167], a[232:235], v[84:87]
s_xor_b32 s71, s15, 0x400000
ds_read_b64_tr_b16 v[208:209], v8 offset:4096
ds_read_b64_tr_b16 v[210:211], v8 offset:6144
v_mfma_f32_16x16x32_bf16 v[84:87], v[148:151], a[228:231], v[84:87]
s_add_u32 m0, s85, 49152
ds_read_b64_tr_b16 v[212:213], v9 offset:4096
ds_read_b64_tr_b16 v[214:215], v9 offset:6144
v_mfma_f32_16x16x32_bf16 v[84:87], v[132:135], a[224:227], v[84:87]
s_add_u32 s72, s71, 0
buffer_load_dwordx4 v15, s[24:27], s72 offen lds
v_mfma_f32_16x16x32_bf16 v[88:91], v[136:139], a[224:227], v[88:91]
v_mfma_f32_16x16x32_bf16 v[88:91], v[152:155], a[228:231], v[88:91]
s_waitcnt lgkmcnt(6)
ds_read_b64_tr_b16 v[216:217], v10 offset:4096
ds_read_b64_tr_b16 v[218:219], v10 offset:6144
v_mfma_f32_16x16x32_bf16 v[88:91], v[168:171], a[232:235], v[88:91]
s_nop 0
ds_read_b64_tr_b16 v[220:221], v11 offset:4096
ds_read_b64_tr_b16 v[222:223], v11 offset:6144
v_mfma_f32_16x16x32_bf16 v[88:91], v[184:187], a[236:239], v[88:91]
v_cvt_pk_bf16_f32 v80, v80, v81
v_cvt_pk_bf16_f32 v81, v82, v83
v_cvt_pk_bf16_f32 v82, v84, v85
v_mfma_f32_16x16x32_bf16 v[92:95], v[188:191], a[236:239], v[92:95]
s_nop 0
ds_read_b64_tr_b16 v[224:225], v8 offset:8192
ds_read_b64_tr_b16 v[226:227], v8 offset:10240
v_cvt_pk_bf16_f32 v83, v86, v87
v_mfma_f32_16x16x32_bf16 v[92:95], v[172:175], a[232:235], v[92:95]
s_add_u32 s72, s71, 15360
buffer_load_dwordx4 v15, s[24:27], s72 offen offset:1024 lds
v_mfma_f32_16x16x32_bf16 v[92:95], v[156:159], a[228:231], v[92:95]
s_nop 0
ds_read_b64_tr_b16 v[228:229], v9 offset:8192
ds_read_b64_tr_b16 v[230:231], v9 offset:10240
v_mfma_f32_16x16x32_bf16 v[92:95], v[140:143], a[224:227], v[92:95]
s_nop 0
ds_read_b64_tr_b16 v[232:233], v10 offset:8192
ds_read_b64_tr_b16 v[234:235], v10 offset:10240
v_mfma_f32_16x16x32_bf16 v[96:99], v[128:131], a[240:243], v[96:99]
s_xor_b32 s80, s93, 0x180000
v_and_b32 v114, 0xffff0000, v48
v_lshlrev_b32 v115, 16, v64
v_mfma_f32_16x16x32_bf16 v[96:99], v[144:147], a[244:247], v[96:99]
s_add_u32 s80, s80, 0x4200000
buffer_store_dwordx4 v[80:83], v1, s[44:47], s80 offen sc1
v_mfma_f32_16x16x32_bf16 v[96:99], v[160:163], a[248:251], v[96:99]
s_nop 0
ds_read_b64_tr_b16 v[236:237], v11 offset:8192
ds_read_b64_tr_b16 v[238:239], v11 offset:10240
v_mfma_f32_16x16x32_bf16 v[96:99], v[176:179], a[252:255], v[96:99]
s_add_u32 s72, s71, 30720
buffer_load_dwordx4 v15, s[24:27], s72 offen offset:2048 lds
v_cvt_pk_bf16_f32 v84, v88, v89
v_mfma_f32_16x16x32_bf16 v[100:103], v[180:183], a[252:255], v[100:103]
s_nop 0
ds_read_b64_tr_b16 v[240:241], v8 offset:12288
ds_read_b64_tr_b16 v[242:243], v8 offset:14336
v_cvt_pk_bf16_f32 v85, v90, v91
v_mfma_f32_16x16x32_bf16 v[100:103], v[164:167], a[248:251], v[100:103]
s_nop 0
ds_read_b64_tr_b16 v[244:245], v9 offset:12288
ds_read_b64_tr_b16 v[246:247], v9 offset:14336
v_cvt_pk_bf16_f32 v86, v92, v93
v_mfma_f32_16x16x32_bf16 v[100:103], v[148:151], a[244:247], v[100:103]
v_cvt_pk_bf16_f32 v87, v94, v95
v_lshlrev_b32 v48, 16, v48
v_mfma_f32_16x16x32_bf16 v[100:103], v[132:135], a[240:243], v[100:103]
s_nop 0
ds_read_b64_tr_b16 v[248:249], v10 offset:12288
ds_read_b64_tr_b16 v[250:251], v10 offset:14336
v_mfma_f32_16x16x32_bf16 v[104:107], v[136:139], a[240:243], v[104:107]
s_nop 0
ds_read_b64_tr_b16 v[252:253], v11 offset:12288
ds_read_b64_tr_b16 v[254:255], v11 offset:14336
v_mfma_f32_16x16x32_bf16 v[104:107], v[152:155], a[244:247], v[104:107]
s_add_u32 s72, s71, 46080
buffer_load_dwordx4 v15, s[24:27], s72 offen offset:3072 lds
v_mfma_f32_16x16x32_bf16 v[104:107], v[168:171], a[248:251], v[104:107]
v_and_b32 v64, 0xffff0000, v64
v_mul_f32 v48, v48, v112
v_mfma_f32_16x16x32_bf16 v[104:107], v[184:187], a[252:255], v[104:107]
v_cvt_pk_bf16_f32 v88, v96, v97
v_cvt_pk_bf16_f32 v89, v98, v99
v_cvt_pk_bf16_f32 v90, v100, v101
v_mfma_f32_16x16x32_bf16 v[108:111], v[188:191], a[252:255], v[108:111]
v_cvt_pk_bf16_f32 v91, v102, v103
v_mul_f32 v114, v114, v112
v_mfma_f32_16x16x32_bf16 v[108:111], v[172:175], a[248:251], v[108:111]
v_mul_f32 v48, v48, v115
v_mul_f32 v64, v64, v114
v_mfma_f32_16x16x32_bf16 v[108:111], v[156:159], a[244:247], v[108:111]
s_waitcnt vmcnt(30) lgkmcnt(0)
v_and_b32 v114, 0xffff0000, v49
v_lshlrev_b32 v115, 16, v65
v_mfma_f32_16x16x32_bf16 v[108:111], v[140:143], a[240:243], v[108:111]
s_barrier
v_lshlrev_b32 v49, 16, v49
v_and_b32 v65, 0xffff0000, v65
v_mfma_f32_16x16x32_bf16 v[16:19], v[192:195], a[0:3], 0
s_nop 0
ds_read_b64_tr_b16 v[128:129], v8 offset:16384
ds_read_b64_tr_b16 v[130:131], v8 offset:18432
v_mfma_f32_16x16x32_bf16 v[16:19], v[208:211], a[4:7], v[16:19]
buffer_store_dwordx4 v[84:87], v1, s[44:47], s80 offen offset:1024 sc1
v_mfma_f32_16x16x32_bf16 v[16:19], v[224:227], a[8:11], v[16:19]
s_nop 0
ds_read_b64_tr_b16 v[132:133], v9 offset:16384
ds_read_b64_tr_b16 v[134:135], v9 offset:18432
v_mfma_f32_16x16x32_bf16 v[16:19], v[240:243], a[12:15], v[16:19]
v_cvt_pk_bf16_f32 v92, v104, v105
v_cvt_pk_bf16_f32 v93, v106, v107
v_cvt_pk_bf16_f32 v94, v108, v109
v_mfma_f32_16x16x32_bf16 v[32:35], v[240:243], a[28:31], 0
s_nop 0
ds_read_b64_tr_b16 v[136:137], v10 offset:16384
ds_read_b64_tr_b16 v[138:139], v10 offset:18432
v_cvt_pk_bf16_f32 v95, v110, v111
v_mfma_f32_16x16x32_bf16 v[32:35], v[224:227], a[24:27], v[32:35]
s_nop 0
ds_read_b64_tr_b16 v[140:141], v11 offset:16384
ds_read_b64_tr_b16 v[142:143], v11 offset:18432
v_mfma_f32_16x16x32_bf16 v[32:35], v[208:211], a[20:23], v[32:35]
v_mul_f32 v49, v49, v112
v_mul_f32 v114, v114, v112
v_mfma_f32_16x16x32_bf16 v[32:35], v[192:195], a[16:19], v[32:35]
s_nop 0
ds_read_b64_tr_b16 v[144:145], v8 offset:20480
ds_read_b64_tr_b16 v[146:147], v8 offset:22528
v_mfma_f32_16x16x32_bf16 v[36:39], v[196:199], a[16:19], 0
s_nop 0
ds_read_b64_tr_b16 v[148:149], v9 offset:20480
ds_read_b64_tr_b16 v[150:151], v9 offset:22528
v_mfma_f32_16x16x32_bf16 v[36:39], v[212:215], a[20:23], v[36:39]
v_mul_f32 v49, v49, v115
v_mul_f32 v65, v65, v114
v_mfma_f32_16x16x32_bf16 v[36:39], v[228:231], a[24:27], v[36:39]
s_nop 0
ds_read_b64_tr_b16 v[152:153], v10 offset:20480
ds_read_b64_tr_b16 v[154:155], v10 offset:22528
v_mfma_f32_16x16x32_bf16 v[36:39], v[244:247], a[28:31], v[36:39]
s_nop 0
ds_read_b64_tr_b16 v[156:157], v11 offset:20480
ds_read_b64_tr_b16 v[158:159], v11 offset:22528
v_mfma_f32_16x16x32_bf16 v[20:23], v[244:247], a[12:15], 0
v_and_b32 v114, 0xffff0000, v50
v_lshlrev_b32 v115, 16, v66
v_mfma_f32_16x16x32_bf16 v[20:23], v[228:231], a[8:11], v[20:23]
s_nop 0
ds_read_b64_tr_b16 v[160:161], v8 offset:24576
ds_read_b64_tr_b16 v[162:163], v8 offset:26624
v_mfma_f32_16x16x32_bf16 v[20:23], v[212:215], a[4:7], v[20:23]
v_lshlrev_b32 v50, 16, v50
v_and_b32 v66, 0xffff0000, v66
v_mfma_f32_16x16x32_bf16 v[20:23], v[196:199], a[0:3], v[20:23]
s_nop 0
ds_read_b64_tr_b16 v[164:165], v9 offset:24576
ds_read_b64_tr_b16 v[166:167], v9 offset:26624
v_mfma_f32_16x16x32_bf16 v[24:27], v[200:203], a[0:3], 0
s_nop 0
ds_read_b64_tr_b16 v[168:169], v10 offset:24576
ds_read_b64_tr_b16 v[170:171], v10 offset:26624
v_mfma_f32_16x16x32_bf16 v[24:27], v[216:219], a[4:7], v[24:27]
buffer_store_dwordx4 v[88:91], v1, s[44:47], s80 offen offset:2048 sc1
v_mfma_f32_16x16x32_bf16 v[24:27], v[232:235], a[8:11], v[24:27]
v_mul_f32 v50, v50, v112
v_mul_f32 v114, v114, v112
v_mfma_f32_16x16x32_bf16 v[24:27], v[248:251], a[12:15], v[24:27]
s_nop 0
ds_read_b64_tr_b16 v[172:173], v11 offset:24576
ds_read_b64_tr_b16 v[174:175], v11 offset:26624
v_mfma_f32_16x16x32_bf16 v[40:43], v[248:251], a[28:31], 0
s_nop 0
ds_read_b64_tr_b16 v[176:177], v8 offset:28672
ds_read_b64_tr_b16 v[178:179], v8 offset:30720
v_mfma_f32_16x16x32_bf16 v[40:43], v[232:235], a[24:27], v[40:43]
v_mul_f32 v50, v50, v115
v_mul_f32 v66, v66, v114
v_mfma_f32_16x16x32_bf16 v[40:43], v[216:219], a[20:23], v[40:43]
s_nop 0
ds_read_b64_tr_b16 v[180:181], v9 offset:28672
ds_read_b64_tr_b16 v[182:183], v9 offset:30720
v_mfma_f32_16x16x32_bf16 v[40:43], v[200:203], a[16:19], v[40:43]
s_nop 0
ds_read_b64_tr_b16 v[184:185], v10 offset:28672
ds_read_b64_tr_b16 v[186:187], v10 offset:30720
v_mfma_f32_16x16x32_bf16 v[44:47], v[204:207], a[16:19], 0
v_and_b32 v114, 0xffff0000, v51
v_lshlrev_b32 v115, 16, v67
v_mfma_f32_16x16x32_bf16 v[44:47], v[220:223], a[20:23], v[44:47]
s_nop 0
ds_read_b64_tr_b16 v[188:189], v11 offset:28672
ds_read_b64_tr_b16 v[190:191], v11 offset:30720
v_mfma_f32_16x16x32_bf16 v[44:47], v[236:239], a[24:27], v[44:47]
v_lshlrev_b32 v51, 16, v51
v_and_b32 v67, 0xffff0000, v67
v_mfma_f32_16x16x32_bf16 v[44:47], v[252:255], a[28:31], v[44:47]
v_mul_f32 v51, v51, v112
v_mul_f32 v114, v114, v112
v_mfma_f32_16x16x32_bf16 v[28:31], v[252:255], a[12:15], 0
v_mul_f32 v51, v51, v115
v_mul_f32 v67, v67, v114
v_mfma_f32_16x16x32_bf16 v[28:31], v[236:239], a[8:11], v[28:31]
v_and_b32 v114, 0xffff0000, v52
v_lshlrev_b32 v115, 16, v68
v_mfma_f32_16x16x32_bf16 v[28:31], v[220:223], a[4:7], v[28:31]
s_waitcnt vmcnt(27) lgkmcnt(0)
v_lshlrev_b32 v52, 16, v52
v_and_b32 v68, 0xffff0000, v68
v_mfma_f32_16x16x32_bf16 v[28:31], v[204:207], a[0:3], v[28:31]
Lstube4:
s_cbranch_execz Lrete
s_barrier
v_mul_f32 v52, v52, v112
v_mul_f32 v114, v114, v112
v_mfma_f32_16x16x32_bf16 v[16:19], v[128:131], a[32:35], v[16:19]
s_nop 0
ds_read_b64_tr_b16 v[192:193], v8 offset:32768
ds_read_b64_tr_b16 v[194:195], v8 offset:34816
v_mfma_f32_16x16x32_bf16 v[16:19], v[144:147], a[36:39], v[16:19]
buffer_store_dwordx4 v[92:95], v1, s[44:47], s80 offen offset:3072 sc1
v_mfma_f32_16x16x32_bf16 v[16:19], v[160:163], a[40:43], v[16:19]
s_nop 0
ds_read_b64_tr_b16 v[196:197], v9 offset:32768
ds_read_b64_tr_b16 v[198:199], v9 offset:34816
v_mfma_f32_16x16x32_bf16 v[16:19], v[176:179], a[44:47], v[16:19]
v_mul_f32 v52, v52, v115
v_mul_f32 v68, v68, v114
v_mfma_f32_16x16x32_bf16 v[32:35], v[176:179], a[60:63], v[32:35]
s_nop 0
ds_read_b64_tr_b16 v[200:201], v10 offset:32768
ds_read_b64_tr_b16 v[202:203], v10 offset:34816
v_mfma_f32_16x16x32_bf16 v[32:35], v[160:163], a[56:59], v[32:35]
s_nop 0
ds_read_b64_tr_b16 v[204:205], v11 offset:32768
ds_read_b64_tr_b16 v[206:207], v11 offset:34816
v_mfma_f32_16x16x32_bf16 v[32:35], v[144:147], a[52:55], v[32:35]
v_and_b32 v114, 0xffff0000, v53
v_lshlrev_b32 v115, 16, v69
v_mfma_f32_16x16x32_bf16 v[32:35], v[128:131], a[48:51], v[32:35]
s_nop 0
ds_read_b64_tr_b16 v[208:209], v8 offset:36864
ds_read_b64_tr_b16 v[210:211], v8 offset:38912
v_mfma_f32_16x16x32_bf16 v[36:39], v[132:135], a[48:51], v[36:39]
v_lshlrev_b32 v53, 16, v53
v_and_b32 v69, 0xffff0000, v69
v_mfma_f32_16x16x32_bf16 v[36:39], v[148:151], a[52:55], v[36:39]
s_nop 0
ds_read_b64_tr_b16 v[212:213], v9 offset:36864
ds_read_b64_tr_b16 v[214:215], v9 offset:38912
v_mfma_f32_16x16x32_bf16 v[36:39], v[164:167], a[56:59], v[36:39]
s_nop 0
ds_read_b64_tr_b16 v[216:217], v10 offset:36864
ds_read_b64_tr_b16 v[218:219], v10 offset:38912
v_mfma_f32_16x16x32_bf16 v[36:39], v[180:183], a[60:63], v[36:39]
v_mul_f32 v53, v53, v112
v_mul_f32 v114, v114, v112
v_mfma_f32_16x16x32_bf16 v[20:23], v[180:183], a[44:47], v[20:23]
s_nop 0
ds_read_b64_tr_b16 v[220:221], v11 offset:36864
ds_read_b64_tr_b16 v[222:223], v11 offset:38912
v_mfma_f32_16x16x32_bf16 v[20:23], v[164:167], a[40:43], v[20:23]
v_mul_f32 v53, v53, v115
v_mul_f32 v69, v69, v114
v_mfma_f32_16x16x32_bf16 v[20:23], v[148:151], a[36:39], v[20:23]
s_nop 0
ds_read_b64_tr_b16 v[224:225], v8 offset:40960
ds_read_b64_tr_b16 v[226:227], v8 offset:43008
v_mfma_f32_16x16x32_bf16 v[20:23], v[132:135], a[32:35], v[20:23]
s_nop 0
ds_read_b64_tr_b16 v[228:229], v9 offset:40960
ds_read_b64_tr_b16 v[230:231], v9 offset:43008
v_mfma_f32_16x16x32_bf16 v[24:27], v[136:139], a[32:35], v[24:27]
v_and_b32 v114, 0xffff0000, v54
v_lshlrev_b32 v115, 16, v70
v_mfma_f32_16x16x32_bf16 v[24:27], v[152:155], a[36:39], v[24:27]
s_nop 0
ds_read_b64_tr_b16 v[232:233], v10 offset:40960
ds_read_b64_tr_b16 v[234:235], v10 offset:43008
v_mfma_f32_16x16x32_bf16 v[24:27], v[168:171], a[40:43], v[24:27]
s_nop 0
ds_read_b64_tr_b16 v[236:237], v11 offset:40960
ds_read_b64_tr_b16 v[238:239], v11 offset:43008
v_mfma_f32_16x16x32_bf16 v[24:27], v[184:187], a[44:47], v[24:27]
v_lshlrev_b32 v54, 16, v54
v_and_b32 v70, 0xffff0000, v70
v_mfma_f32_16x16x32_bf16 v[40:43], v[184:187], a[60:63], v[40:43]
s_nop 0
ds_read_b64_tr_b16 v[240:241], v8 offset:45056
ds_read_b64_tr_b16 v[242:243], v8 offset:47104
v_mfma_f32_16x16x32_bf16 v[40:43], v[168:171], a[56:59], v[40:43]
v_mul_f32 v54, v54, v112
v_mul_f32 v114, v114, v112
v_mfma_f32_16x16x32_bf16 v[40:43], v[152:155], a[52:55], v[40:43]
s_nop 0
ds_read_b64_tr_b16 v[244:245], v9 offset:45056
ds_read_b64_tr_b16 v[246:247], v9 offset:47104
v_mfma_f32_16x16x32_bf16 v[40:43], v[136:139], a[48:51], v[40:43]
s_nop 0
ds_read_b64_tr_b16 v[248:249], v10 offset:45056
ds_read_b64_tr_b16 v[250:251], v10 offset:47104
v_mfma_f32_16x16x32_bf16 v[44:47], v[140:143], a[48:51], v[44:47]
v_mul_f32 v54, v54, v115
v_mul_f32 v70, v70, v114
v_mfma_f32_16x16x32_bf16 v[44:47], v[156:159], a[52:55], v[44:47]
s_nop 0
ds_read_b64_tr_b16 v[252:253], v11 offset:45056
ds_read_b64_tr_b16 v[254:255], v11 offset:47104
v_mfma_f32_16x16x32_bf16 v[44:47], v[172:175], a[56:59], v[44:47]
v_and_b32 v114, 0xffff0000, v55
v_lshlrev_b32 v115, 16, v71
v_mfma_f32_16x16x32_bf16 v[44:47], v[188:191], a[60:63], v[44:47]
v_lshlrev_b32 v55, 16, v55
v_and_b32 v71, 0xffff0000, v71
v_mfma_f32_16x16x32_bf16 v[28:31], v[188:191], a[44:47], v[28:31]
v_mul_f32 v55, v55, v112
v_mul_f32 v114, v114, v112
v_mfma_f32_16x16x32_bf16 v[28:31], v[172:175], a[40:43], v[28:31]
s_add_u32 s79, s93, 0x3a00000
v_mul_f32 v55, v55, v115
v_mul_f32 v71, v71, v114
v_mfma_f32_16x16x32_bf16 v[28:31], v[156:159], a[36:39], v[28:31]
s_waitcnt vmcnt(24) lgkmcnt(0)
buffer_load_dwordx4 v[96:99], v1, s[44:47], s79 offen sc1
v_mfma_f32_16x16x32_bf16 v[28:31], v[140:143], a[32:35], v[28:31]
s_barrier
v_and_b32 v114, 0xffff0000, v56
v_lshlrev_b32 v115, 16, v72
v_mfma_f32_16x16x32_bf16 v[16:19], v[192:195], a[64:67], v[16:19]
s_nop 0
ds_read_b64_tr_b16 v[128:129], v8 offset:49152
ds_read_b64_tr_b16 v[130:131], v8 offset:51200
v_mfma_f32_16x16x32_bf16 v[16:19], v[208:211], a[68:71], v[16:19]
s_nop 0
ds_read_b64_tr_b16 v[132:133], v9 offset:49152
ds_read_b64_tr_b16 v[134:135], v9 offset:51200
v_mfma_f32_16x16x32_bf16 v[16:19], v[224:227], a[72:75], v[16:19]
v_lshlrev_b32 v56, 16, v56
v_and_b32 v72, 0xffff0000, v72
v_mfma_f32_16x16x32_bf16 v[16:19], v[240:243], a[76:79], v[16:19]
buffer_load_dwordx4 v[100:103], v1, s[44:47], s79 offen offset:1024 sc1
v_mfma_f32_16x16x32_bf16 v[32:35], v[240:243], a[92:95], v[32:35]
s_nop 0
ds_read_b64_tr_b16 v[136:137], v10 offset:49152
ds_read_b64_tr_b16 v[138:139], v10 offset:51200
v_mfma_f32_16x16x32_bf16 v[32:35], v[224:227], a[88:91], v[32:35]
s_nop 0
ds_read_b64_tr_b16 v[140:141], v11 offset:49152
ds_read_b64_tr_b16 v[142:143], v11 offset:51200
v_mfma_f32_16x16x32_bf16 v[32:35], v[208:211], a[84:87], v[32:35]
v_mul_f32 v56, v56, v113
v_mul_f32 v114, v114, v113
v_mfma_f32_16x16x32_bf16 v[32:35], v[192:195], a[80:83], v[32:35]
s_nop 0
ds_read_b64_tr_b16 v[144:145], v8 offset:53248
ds_read_b64_tr_b16 v[146:147], v8 offset:55296
v_mfma_f32_16x16x32_bf16 v[36:39], v[196:199], a[80:83], v[36:39]
buffer_load_dwordx4 v[104:107], v1, s[44:47], s79 offen offset:2048 sc1
v_mfma_f32_16x16x32_bf16 v[36:39], v[212:215], a[84:87], v[36:39]
s_nop 0
ds_read_b64_tr_b16 v[148:149], v9 offset:53248
ds_read_b64_tr_b16 v[150:151], v9 offset:55296
v_mfma_f32_16x16x32_bf16 v[36:39], v[228:231], a[88:91], v[36:39]
v_mul_f32 v56, v56, v115
v_mul_f32 v72, v72, v114
v_mfma_f32_16x16x32_bf16 v[36:39], v[244:247], a[92:95], v[36:39]
s_nop 0
ds_read_b64_tr_b16 v[152:153], v10 offset:53248
ds_read_b64_tr_b16 v[154:155], v10 offset:55296
v_mfma_f32_16x16x32_bf16 v[20:23], v[244:247], a[76:79], v[20:23]
s_nop 0
ds_read_b64_tr_b16 v[156:157], v11 offset:53248
ds_read_b64_tr_b16 v[158:159], v11 offset:55296
v_mfma_f32_16x16x32_bf16 v[20:23], v[228:231], a[72:75], v[20:23]
buffer_load_dwordx4 v[108:111], v1, s[44:47], s79 offen offset:3072 sc1
v_mfma_f32_16x16x32_bf16 v[20:23], v[212:215], a[68:71], v[20:23]
v_and_b32 v114, 0xffff0000, v57
v_lshlrev_b32 v115, 16, v73
v_mfma_f32_16x16x32_bf16 v[20:23], v[196:199], a[64:67], v[20:23]
s_nop 0
ds_read_b64_tr_b16 v[160:161], v8 offset:57344
ds_read_b64_tr_b16 v[162:163], v8 offset:59392
v_mfma_f32_16x16x32_bf16 v[24:27], v[200:203], a[64:67], v[24:27]
s_nop 0
ds_read_b64_tr_b16 v[164:165], v9 offset:57344
ds_read_b64_tr_b16 v[166:167], v9 offset:59392
v_mfma_f32_16x16x32_bf16 v[24:27], v[216:219], a[68:71], v[24:27]
v_lshlrev_b32 v57, 16, v57
v_and_b32 v73, 0xffff0000, v73
v_mfma_f32_16x16x32_bf16 v[24:27], v[232:235], a[72:75], v[24:27]
s_nop 0
ds_read_b64_tr_b16 v[168:169], v10 offset:57344
ds_read_b64_tr_b16 v[170:171], v10 offset:59392
v_mfma_f32_16x16x32_bf16 v[24:27], v[248:251], a[76:79], v[24:27]
s_nop 0
ds_read_b64_tr_b16 v[172:173], v11 offset:57344
ds_read_b64_tr_b16 v[174:175], v11 offset:59392
v_mfma_f32_16x16x32_bf16 v[40:43], v[248:251], a[92:95], v[40:43]
v_mul_f32 v57, v57, v113
v_mul_f32 v114, v114, v113
v_mfma_f32_16x16x32_bf16 v[40:43], v[232:235], a[88:91], v[40:43]
s_nop 0
ds_read_b64_tr_b16 v[176:177], v8 offset:61440
ds_read_b64_tr_b16 v[178:179], v8 offset:63488
v_mfma_f32_16x16x32_bf16 v[40:43], v[216:219], a[84:87], v[40:43]
s_nop 0
ds_read_b64_tr_b16 v[180:181], v9 offset:61440
ds_read_b64_tr_b16 v[182:183], v9 offset:63488
v_mfma_f32_16x16x32_bf16 v[40:43], v[200:203], a[80:83], v[40:43]
v_mul_f32 v57, v57, v115
v_mul_f32 v73, v73, v114
v_mfma_f32_16x16x32_bf16 v[44:47], v[204:207], a[80:83], v[44:47]
s_nop 0
ds_read_b64_tr_b16 v[184:185], v10 offset:61440
ds_read_b64_tr_b16 v[186:187], v10 offset:63488
v_mfma_f32_16x16x32_bf16 v[44:47], v[220:223], a[84:87], v[44:47]
s_nop 0
ds_read_b64_tr_b16 v[188:189], v11 offset:61440
ds_read_b64_tr_b16 v[190:191], v11 offset:63488
v_mfma_f32_16x16x32_bf16 v[44:47], v[236:239], a[88:91], v[44:47]
v_and_b32 v114, 0xffff0000, v58
v_lshlrev_b32 v115, 16, v74
v_mfma_f32_16x16x32_bf16 v[44:47], v[252:255], a[92:95], v[44:47]
v_lshlrev_b32 v58, 16, v58
v_and_b32 v74, 0xffff0000, v74
v_mfma_f32_16x16x32_bf16 v[28:31], v[252:255], a[76:79], v[28:31]
v_xor_b32 v8, 0x10000, v8
v_mul_f32 v58, v58, v113
v_mfma_f32_16x16x32_bf16 v[28:31], v[236:239], a[72:75], v[28:31]
v_xor_b32 v9, 0x10000, v9
v_mul_f32 v114, v114, v113
v_mfma_f32_16x16x32_bf16 v[28:31], v[220:223], a[68:71], v[28:31]
s_waitcnt vmcnt(22) lgkmcnt(0)
v_xor_b32 v10, 0x10000, v10
v_mul_f32 v58, v58, v115
v_mfma_f32_16x16x32_bf16 v[28:31], v[204:207], a[64:67], v[28:31]
s_barrier
v_xor_b32 v11, 0x10000, v11
v_mul_f32 v74, v74, v114
v_mfma_f32_16x16x32_bf16 v[16:19], v[128:131], a[96:99], v[16:19]
s_nop 0
ds_read_b64_tr_b16 v[192:193], v8 offset:0
ds_read_b64_tr_b16 v[194:195], v8 offset:2048
v_mfma_f32_16x16x32_bf16 v[16:19], v[144:147], a[100:103], v[16:19]
s_nop 0
ds_read_b64_tr_b16 v[196:197], v9 offset:0
ds_read_b64_tr_b16 v[198:199], v9 offset:2048
v_mfma_f32_16x16x32_bf16 v[16:19], v[160:163], a[104:107], v[16:19]
v_and_b32 v114, 0xffff0000, v59
v_lshlrev_b32 v115, 16, v75
v_mfma_f32_16x16x32_bf16 v[16:19], v[176:179], a[108:111], v[16:19]
s_nop 0
ds_read_b64_tr_b16 v[200:201], v10 offset:0
ds_read_b64_tr_b16 v[202:203], v10 offset:2048
v_mfma_f32_16x16x32_bf16 v[32:35], v[176:179], a[124:127], v[32:35]
v_lshlrev_b32 v59, 16, v59
v_and_b32 v75, 0xffff0000, v75
v_mfma_f32_16x16x32_bf16 v[32:35], v[160:163], a[120:123], v[32:35]
s_nop 0
ds_read_b64_tr_b16 v[204:205], v11 offset:0
ds_read_b64_tr_b16 v[206:207], v11 offset:2048
v_mfma_f32_16x16x32_bf16 v[32:35], v[144:147], a[116:119], v[32:35]
s_nop 0
ds_read_b64_tr_b16 v[208:209], v8 offset:4096
ds_read_b64_tr_b16 v[210:211], v8 offset:6144
v_mfma_f32_16x16x32_bf16 v[32:35], v[128:131], a[112:115], v[32:35]
v_mul_f32 v59, v59, v113
v_mul_f32 v114, v114, v113
v_mfma_f32_16x16x32_bf16 v[36:39], v[132:135], a[112:115], v[36:39]
s_nop 0
ds_read_b64_tr_b16 v[212:213], v9 offset:4096
ds_read_b64_tr_b16 v[214:215], v9 offset:6144
v_mfma_f32_16x16x32_bf16 v[36:39], v[148:151], a[116:119], v[36:39]
v_mul_f32 v59, v59, v115
v_mul_f32 v75, v75, v114
v_mfma_f32_16x16x32_bf16 v[36:39], v[164:167], a[120:123], v[36:39]
s_nop 0
ds_read_b64_tr_b16 v[216:217], v10 offset:4096
ds_read_b64_tr_b16 v[218:219], v10 offset:6144
v_mfma_f32_16x16x32_bf16 v[36:39], v[180:183], a[124:127], v[36:39]
s_nop 0
ds_read_b64_tr_b16 v[220:221], v11 offset:4096
ds_read_b64_tr_b16 v[222:223], v11 offset:6144
v_mfma_f32_16x16x32_bf16 v[20:23], v[180:183], a[108:111], v[20:23]
v_and_b32 v114, 0xffff0000, v60
v_lshlrev_b32 v115, 16, v76
v_mfma_f32_16x16x32_bf16 v[20:23], v[164:167], a[104:107], v[20:23]
s_nop 0
ds_read_b64_tr_b16 v[224:225], v8 offset:8192
ds_read_b64_tr_b16 v[226:227], v8 offset:10240
v_mfma_f32_16x16x32_bf16 v[20:23], v[148:151], a[100:103], v[20:23]
v_lshlrev_b32 v60, 16, v60
v_and_b32 v76, 0xffff0000, v76
v_mfma_f32_16x16x32_bf16 v[20:23], v[132:135], a[96:99], v[20:23]
s_nop 0
ds_read_b64_tr_b16 v[228:229], v9 offset:8192
ds_read_b64_tr_b16 v[230:231], v9 offset:10240
v_mfma_f32_16x16x32_bf16 v[24:27], v[136:139], a[96:99], v[24:27]
s_nop 0
ds_read_b64_tr_b16 v[232:233], v10 offset:8192
ds_read_b64_tr_b16 v[234:235], v10 offset:10240
v_mfma_f32_16x16x32_bf16 v[24:27], v[152:155], a[100:103], v[24:27]
v_mul_f32 v60, v60, v113
v_mul_f32 v114, v114, v113
v_mfma_f32_16x16x32_bf16 v[24:27], v[168:171], a[104:107], v[24:27]
s_nop 0
ds_read_b64_tr_b16 v[236:237], v11 offset:8192
ds_read_b64_tr_b16 v[238:239], v11 offset:10240
v_mfma_f32_16x16x32_bf16 v[24:27], v[184:187], a[108:111], v[24:27]
v_mul_f32 v60, v60, v115
v_mul_f32 v76, v76, v114
v_mfma_f32_16x16x32_bf16 v[40:43], v[184:187], a[124:127], v[40:43]
s_nop 0
ds_read_b64_tr_b16 v[240:241], v8 offset:12288
ds_read_b64_tr_b16 v[242:243], v8 offset:14336
v_mfma_f32_16x16x32_bf16 v[40:43], v[168:171], a[120:123], v[40:43]
s_nop 0
ds_read_b64_tr_b16 v[244:245], v9 offset:12288
ds_read_b64_tr_b16 v[246:247], v9 offset:14336
v_mfma_f32_16x16x32_bf16 v[40:43], v[152:155], a[116:119], v[40:43]
v_and_b32 v114, 0xffff0000, v61
v_lshlrev_b32 v115, 16, v77
v_mfma_f32_16x16x32_bf16 v[40:43], v[136:139], a[112:115], v[40:43]
s_nop 0
ds_read_b64_tr_b16 v[248:249], v10 offset:12288
ds_read_b64_tr_b16 v[250:251], v10 offset:14336
v_mfma_f32_16x16x32_bf16 v[44:47], v[140:143], a[112:115], v[44:47]
v_lshlrev_b32 v61, 16, v61
v_and_b32 v77, 0xffff0000, v77
v_mfma_f32_16x16x32_bf16 v[44:47], v[156:159], a[116:119], v[44:47]
s_nop 0
ds_read_b64_tr_b16 v[252:253], v11 offset:12288
ds_read_b64_tr_b16 v[254:255], v11 offset:14336
v_mfma_f32_16x16x32_bf16 v[44:47], v[172:175], a[120:123], v[44:47]
v_mul_f32 v61, v61, v113
v_mul_f32 v114, v114, v113
v_mfma_f32_16x16x32_bf16 v[44:47], v[188:191], a[124:127], v[44:47]
s_waitcnt vmcnt(0)
v_max3_u32 v12, v96, v97, v98
v_max3_u32 v13, v99, v100, v101
v_mfma_f32_16x16x32_bf16 v[28:31], v[188:191], a[108:111], v[28:31]
v_max3_u32 v12, v12, v102, v103
v_max3_u32 v13, v13, v104, v105
v_mfma_f32_16x16x32_bf16 v[28:31], v[172:175], a[104:107], v[28:31]
v_max3_u32 v12, v12, v106, v107
v_max3_u32 v13, v13, v108, v109
v_mfma_f32_16x16x32_bf16 v[28:31], v[156:159], a[100:103], v[28:31]
s_waitcnt vmcnt(16) lgkmcnt(0)
v_max3_u32 v12, v12, v110, v111
v_mul_f32 v61, v61, v115
v_mfma_f32_16x16x32_bf16 v[28:31], v[140:143], a[96:99], v[28:31]
s_barrier
v_max_u32 v12, v12, v13
v_mul_f32 v77, v77, v114
v_mfma_f32_16x16x32_bf16 v[16:19], v[192:195], a[128:131], v[16:19]
v_cmp_le_u32 vcc, 0xff800000, v12
v_and_b32 v114, 0xffff0000, v62
v_mfma_f32_16x16x32_bf16 v[16:19], v[208:211], a[132:135], v[16:19]
s_nop 0
ds_read_b64_tr_b16 v[128:129], v8 offset:16384
ds_read_b64_tr_b16 v[130:131], v8 offset:18432
v_mfma_f32_16x16x32_bf16 v[16:19], v[224:227], a[136:139], v[16:19]
s_cbranch_vccnz Lxspin1
Lxback1:
ds_read_b64_tr_b16 v[132:133], v9 offset:16384
ds_read_b64_tr_b16 v[134:135], v9 offset:18432
v_mfma_f32_16x16x32_bf16 v[16:19], v[240:243], a[140:143], v[16:19]
v_lshlrev_b32 v115, 16, v78
v_lshlrev_b32 v62, 16, v62
v_mfma_f32_16x16x32_bf16 v[16:19], v[124:127], v[96:99], v[16:19]
s_nop 0
ds_read_b64_tr_b16 v[136:137], v10 offset:16384
ds_read_b64_tr_b16 v[138:139], v10 offset:18432
v_mfma_f32_16x16x32_bf16 v[32:35], v[240:243], a[156:159], v[32:35]
v_and_b32 v78, 0xffff0000, v78
v_mul_f32 v62, v62, v113
v_mfma_f32_16x16x32_bf16 v[32:35], v[224:227], a[152:155], v[32:35]
s_add_u32 s82, s93, 0x3e00000
buffer_load_dwordx4 v[80:83], v1, s[44:47], s82 offen sc1
v_mfma_f32_16x16x32_bf16 v[32:35], v[208:211], a[148:151], v[32:35]
s_nop 0
ds_read_b64_tr_b16 v[140:141], v11 offset:16384
ds_read_b64_tr_b16 v[142:143], v11 offset:18432
v_mfma_f32_16x16x32_bf16 v[32:35], v[192:195], a[144:147], v[32:35]
v_mul_f32 v114, v114, v113
v_mul_f32 v62, v62, v115
v_mfma_f32_16x16x32_bf16 v[32:35], v[124:127], v[104:107], v[32:35]
s_nop 0
ds_read_b64_tr_b16 v[144:145], v8 offset:20480
ds_read_b64_tr_b16 v[146:147], v8 offset:22528
v_mfma_f32_16x16x32_bf16 v[36:39], v[196:199], a[144:147], v[36:39]
v_mul_f32 v78, v78, v114
v_and_b32 v114, 0xffff0000, v63
v_mfma_f32_16x16x32_bf16 v[36:39], v[212:215], a[148:151], v[36:39]
buffer_load_dwordx4 v[84:87], v1, s[44:47], s82 offen offset:1024 sc1
v_mfma_f32_16x16x32_bf16 v[36:39], v[228:231], a[152:155], v[36:39]
s_nop 0
ds_read_b64_tr_b16 v[148:149], v9 offset:20480
ds_read_b64_tr_b16 v[150:151], v9 offset:22528
v_mfma_f32_16x16x32_bf16 v[36:39], v[244:247], a[156:159], v[36:39]
v_lshlrev_b32 v115, 16, v79
v_lshlrev_b32 v63, 16, v63
v_mfma_f32_16x16x32_bf16 v[36:39], v[120:123], v[104:107], v[36:39]
s_nop 0
ds_read_b64_tr_b16 v[152:153], v10 offset:20480
ds_read_b64_tr_b16 v[154:155], v10 offset:22528
v_mfma_f32_16x16x32_bf16 v[20:23], v[244:247], a[140:143], v[20:23]
v_and_b32 v79, 0xffff0000, v79
v_mul_f32 v63, v63, v113
v_mfma_f32_16x16x32_bf16 v[20:23], v[228:231], a[136:139], v[20:23]
buffer_load_dwordx4 v[88:91], v1, s[44:47], s82 offen offset:2048 sc1
v_mfma_f32_16x16x32_bf16 v[20:23], v[212:215], a[132:135], v[20:23]
s_nop 0
ds_read_b64_tr_b16 v[156:157], v11 offset:20480
ds_read_b64_tr_b16 v[158:159], v11 offset:22528
v_mfma_f32_16x16x32_bf16 v[20:23], v[196:199], a[128:131], v[20:23]
v_mul_f32 v114, v114, v113
v_mul_f32 v63, v63, v115
v_mfma_f32_16x16x32_bf16 v[20:23], v[120:123], v[96:99], v[20:23]
s_nop 0
ds_read_b64_tr_b16 v[160:161], v8 offset:24576
ds_read_b64_tr_b16 v[162:163], v8 offset:26624
v_mfma_f32_16x16x32_bf16 v[24:27], v[200:203], a[128:131], v[24:27]
s_nop 0
ds_read_b64_tr_b16 v[164:165], v9 offset:24576
ds_read_b64_tr_b16 v[166:167], v9 offset:26624
v_mfma_f32_16x16x32_bf16 v[24:27], v[216:219], a[132:135], v[24:27]
buffer_load_dwordx4 v[92:95], v1, s[44:47], s82 offen offset:3072 sc1
v_mfma_f32_16x16x32_bf16 v[24:27], v[232:235], a[136:139], v[24:27]
v_mul_f32 v79, v79, v114
v_mfma_f32_16x16x32_bf16 v[24:27], v[248:251], a[140:143], v[24:27]
s_nop 0
ds_read_b64_tr_b16 v[168:169], v10 offset:24576
ds_read_b64_tr_b16 v[170:171], v10 offset:26624
v_mfma_f32_16x16x32_bf16 v[24:27], v[124:127], v[100:103], v[24:27]
v_mfma_f32_16x16x32_bf16 v[40:43], v[248:251], a[156:159], v[40:43]
s_nop 0
ds_read_b64_tr_b16 v[172:173], v11 offset:24576
ds_read_b64_tr_b16 v[174:175], v11 offset:26624
v_mfma_f32_16x16x32_bf16 v[40:43], v[232:235], a[152:155], v[40:43]
v_mfma_f32_16x16x32_bf16 v[40:43], v[216:219], a[148:151], v[40:43]
s_nop 0
ds_read_b64_tr_b16 v[176:177], v8 offset:28672
ds_read_b64_tr_b16 v[178:179], v8 offset:30720
v_mfma_f32_16x16x32_bf16 v[40:43], v[200:203], a[144:147], v[40:43]
v_mfma_f32_16x16x32_bf16 v[40:43], v[124:127], v[108:111], v[40:43]
s_nop 0
ds_read_b64_tr_b16 v[180:181], v9 offset:28672
ds_read_b64_tr_b16 v[182:183], v9 offset:30720
v_mfma_f32_16x16x32_bf16 v[44:47], v[204:207], a[144:147], v[44:47]
v_mfma_f32_16x16x32_bf16 v[44:47], v[220:223], a[148:151], v[44:47]
s_nop 0
ds_read_b64_tr_b16 v[184:185], v10 offset:28672
ds_read_b64_tr_b16 v[186:187], v10 offset:30720
v_mfma_f32_16x16x32_bf16 v[44:47], v[236:239], a[152:155], v[44:47]
v_mfma_f32_16x16x32_bf16 v[44:47], v[252:255], a[156:159], v[44:47]
s_nop 0
ds_read_b64_tr_b16 v[188:189], v11 offset:28672
ds_read_b64_tr_b16 v[190:191], v11 offset:30720
v_mfma_f32_16x16x32_bf16 v[44:47], v[120:123], v[108:111], v[44:47]
v_mfma_f32_16x16x32_bf16 v[28:31], v[252:255], a[140:143], v[28:31]
v_mfma_f32_16x16x32_bf16 v[28:31], v[236:239], a[136:139], v[28:31]
v_mfma_f32_16x16x32_bf16 v[28:31], v[220:223], a[132:135], v[28:31]
v_mfma_f32_16x16x32_bf16 v[28:31], v[204:207], a[128:131], v[28:31]
s_waitcnt vmcnt(16) lgkmcnt(0)
v_mfma_f32_16x16x32_bf16 v[28:31], v[120:123], v[100:103], v[28:31]
s_barrier
v_mfma_f32_16x16x32_bf16 v[16:19], v[128:131], a[160:163], v[16:19]
s_nop 0
ds_read_b64_tr_b16 v[192:193], v8 offset:32768
ds_read_b64_tr_b16 v[194:195], v8 offset:34816
v_mfma_f32_16x16x32_bf16 v[16:19], v[144:147], a[164:167], v[16:19]
s_nop 0
ds_read_b64_tr_b16 v[196:197], v9 offset:32768
ds_read_b64_tr_b16 v[198:199], v9 offset:34816
v_mfma_f32_16x16x32_bf16 v[16:19], v[160:163], a[168:171], v[16:19]
s_nop 0
ds_read_b64_tr_b16 v[200:201], v10 offset:32768
ds_read_b64_tr_b16 v[202:203], v10 offset:34816
v_mfma_f32_16x16x32_bf16 v[16:19], v[176:179], a[172:175], v[16:19]
v_mfma_f32_16x16x32_bf16 v[32:35], v[176:179], a[188:191], v[32:35]
s_nop 0
ds_read_b64_tr_b16 v[204:205], v11 offset:32768
ds_read_b64_tr_b16 v[206:207], v11 offset:34816
v_mfma_f32_16x16x32_bf16 v[32:35], v[160:163], a[184:187], v[32:35]
s_nop 0
ds_read_b64_tr_b16 v[208:209], v8 offset:36864
ds_read_b64_tr_b16 v[210:211], v8 offset:38912
v_mfma_f32_16x16x32_bf16 v[32:35], v[144:147], a[180:183], v[32:35]
s_add_u32 s81, s93, 0x4200000
buffer_load_dwordx4 v[96:99], v1, s[44:47], s81 offen sc1
v_mfma_f32_16x16x32_bf16 v[32:35], v[128:131], a[176:179], v[32:35]
v_mfma_f32_16x16x32_bf16 v[36:39], v[132:135], a[176:179], v[36:39]
s_nop 0
ds_read_b64_tr_b16 v[212:213], v9 offset:36864
ds_read_b64_tr_b16 v[214:215], v9 offset:38912
v_mfma_f32_16x16x32_bf16 v[36:39], v[148:151], a[180:183], v[36:39]
s_nop 0
ds_read_b64_tr_b16 v[216:217], v10 offset:36864
ds_read_b64_tr_b16 v[218:219], v10 offset:38912
v_mfma_f32_16x16x32_bf16 v[36:39], v[164:167], a[184:187], v[36:39]
v_mfma_f32_16x16x32_bf16 v[36:39], v[180:183], a[188:191], v[36:39]
buffer_load_dwordx4 v[100:103], v1, s[44:47], s81 offen offset:1024 sc1
v_mfma_f32_16x16x32_bf16 v[20:23], v[180:183], a[172:175], v[20:23]
s_nop 0
ds_read_b64_tr_b16 v[220:221], v11 offset:36864
ds_read_b64_tr_b16 v[222:223], v11 offset:38912
v_mfma_f32_16x16x32_bf16 v[20:23], v[164:167], a[168:171], v[20:23]
s_nop 0
ds_read_b64_tr_b16 v[224:225], v8 offset:40960
ds_read_b64_tr_b16 v[226:227], v8 offset:43008
v_mfma_f32_16x16x32_bf16 v[20:23], v[148:151], a[164:167], v[20:23]
s_nop 0
ds_read_b64_tr_b16 v[228:229], v9 offset:40960
ds_read_b64_tr_b16 v[230:231], v9 offset:43008
v_mfma_f32_16x16x32_bf16 v[20:23], v[132:135], a[160:163], v[20:23]
v_mfma_f32_16x16x32_bf16 v[24:27], v[136:139], a[160:163], v[24:27]
buffer_load_dwordx4 v[104:107], v1, s[44:47], s81 offen offset:2048 sc1
v_mfma_f32_16x16x32_bf16 v[24:27], v[152:155], a[164:167], v[24:27]
s_nop 0
ds_read_b64_tr_b16 v[232:233], v10 offset:40960
ds_read_b64_tr_b16 v[234:235], v10 offset:43008
v_mfma_f32_16x16x32_bf16 v[24:27], v[168:171], a[168:171], v[24:27]
s_nop 0
ds_read_b64_tr_b16 v[236:237], v11 offset:40960
ds_read_b64_tr_b16 v[238:239], v11 offset:43008
v_mfma_f32_16x16x32_bf16 v[24:27], v[184:187], a[172:175], v[24:27]
v_mfma_f32_16x16x32_bf16 v[40:43], v[184:187], a[188:191], v[40:43]
s_nop 0
ds_read_b64_tr_b16 v[240:241], v8 offset:45056
ds_read_b64_tr_b16 v[242:243], v8 offset:47104
v_mfma_f32_16x16x32_bf16 v[40:43], v[168:171], a[184:187], v[40:43]
buffer_load_dwordx4 v[108:111], v1, s[44:47], s81 offen offset:3072 sc1
v_mfma_f32_16x16x32_bf16 v[40:43], v[152:155], a[180:183], v[40:43]
s_nop 0
ds_read_b64_tr_b16 v[244:245], v9 offset:45056
ds_read_b64_tr_b16 v[246:247], v9 offset:47104
v_mfma_f32_16x16x32_bf16 v[40:43], v[136:139], a[176:179], v[40:43]
v_mfma_f32_16x16x32_bf16 v[44:47], v[140:143], a[176:179], v[44:47]
s_nop 0
ds_read_b64_tr_b16 v[248:249], v10 offset:45056
ds_read_b64_tr_b16 v[250:251], v10 offset:47104
v_mfma_f32_16x16x32_bf16 v[44:47], v[156:159], a[180:183], v[44:47]
s_nop 0
ds_read_b64_tr_b16 v[252:253], v11 offset:45056
ds_read_b64_tr_b16 v[254:255], v11 offset:47104
v_mfma_f32_16x16x32_bf16 v[44:47], v[172:175], a[184:187], v[44:47]
v_mfma_f32_16x16x32_bf16 v[44:47], v[188:191], a[188:191], v[44:47]
s_waitcnt vmcnt(4)
v_max3_u32 v12, v80, v81, v82
v_max3_u32 v13, v83, v84, v85
v_mfma_f32_16x16x32_bf16 v[28:31], v[188:191], a[172:175], v[28:31]
v_max3_u32 v12, v12, v86, v87
v_max3_u32 v13, v13, v88, v89
v_mfma_f32_16x16x32_bf16 v[28:31], v[172:175], a[168:171], v[28:31]
v_max3_u32 v12, v12, v90, v91
v_max3_u32 v13, v13, v92, v93
v_mfma_f32_16x16x32_bf16 v[28:31], v[156:159], a[164:167], v[28:31]
s_waitcnt vmcnt(15) lgkmcnt(0)
v_max3_u32 v12, v12, v94, v95
v_mfma_f32_16x16x32_bf16 v[28:31], v[140:143], a[160:163], v[28:31]
s_barrier
v_max_u32 v12, v12, v13
v_mfma_f32_16x16x32_bf16 v[16:19], v[192:195], a[192:195], v[16:19]
v_cmp_le_u32 vcc, 0xff800000, v12
v_mfma_f32_16x16x32_bf16 v[16:19], v[208:211], a[196:199], v[16:19]
s_nop 0
ds_read_b64_tr_b16 v[128:129], v8 offset:49152
ds_read_b64_tr_b16 v[130:131], v8 offset:51200
v_mfma_f32_16x16x32_bf16 v[16:19], v[224:227], a[200:203], v[16:19]
s_cbranch_vccnz Lxspin2
Lxback2:
v_mfma_f32_16x16x32_bf16 v[16:19], v[240:243], a[204:207], v[16:19]
s_nop 0
ds_read_b64_tr_b16 v[132:133], v9 offset:49152
ds_read_b64_tr_b16 v[134:135], v9 offset:51200
v_mfma_f32_16x16x32_bf16 v[16:19], v[124:127], v[80:83], v[16:19]
v_mfma_f32_16x16x32_bf16 v[32:35], v[240:243], a[220:223], v[32:35]
s_nop 0
ds_read_b64_tr_b16 v[136:137], v10 offset:49152
ds_read_b64_tr_b16 v[138:139], v10 offset:51200
v_mfma_f32_16x16x32_bf16 v[32:35], v[224:227], a[216:219], v[32:35]
v_mfma_f32_16x16x32_bf16 v[32:35], v[208:211], a[212:215], v[32:35]
s_nop 0
ds_read_b64_tr_b16 v[140:141], v11 offset:49152
ds_read_b64_tr_b16 v[142:143], v11 offset:51200
v_mfma_f32_16x16x32_bf16 v[32:35], v[192:195], a[208:211], v[32:35]
v_mfma_f32_16x16x32_bf16 v[32:35], v[124:127], v[88:91], v[32:35]
s_nop 0
ds_read_b64_tr_b16 v[144:145], v8 offset:53248
ds_read_b64_tr_b16 v[146:147], v8 offset:55296
v_mfma_f32_16x16x32_bf16 v[36:39], v[196:199], a[208:211], v[36:39]
v_mfma_f32_16x16x32_bf16 v[36:39], v[212:215], a[212:215], v[36:39]
s_nop 0
ds_read_b64_tr_b16 v[148:149], v9 offset:53248
ds_read_b64_tr_b16 v[150:151], v9 offset:55296
v_mfma_f32_16x16x32_bf16 v[36:39], v[228:231], a[216:219], v[36:39]
v_mfma_f32_16x16x32_bf16 v[36:39], v[244:247], a[220:223], v[36:39]
s_nop 0
ds_read_b64_tr_b16 v[152:153], v10 offset:53248
ds_read_b64_tr_b16 v[154:155], v10 offset:55296
v_mfma_f32_16x16x32_bf16 v[36:39], v[120:123], v[88:91], v[36:39]
v_mfma_f32_16x16x32_bf16 v[20:23], v[244:247], a[204:207], v[20:23]
s_nop 0
ds_read_b64_tr_b16 v[156:157], v11 offset:53248
ds_read_b64_tr_b16 v[158:159], v11 offset:55296
v_mfma_f32_16x16x32_bf16 v[20:23], v[228:231], a[200:203], v[20:23]
v_mfma_f32_16x16x32_bf16 v[20:23], v[212:215], a[196:199], v[20:23]
Lstube5:
s_cbranch_execz Lrete
v_mfma_f32_16x16x32_bf16 v[20:23], v[196:199], a[192:195], v[20:23]
s_nop 0
ds_read_b64_tr_b16 v[160:161], v8 offset:57344
ds_read_b64_tr_b16 v[162:163], v8 offset:59392
v_mfma_f32_16x16x32_bf16 v[20:23], v[120:123], v[80:83], v[20:23]
v_mfma_f32_16x16x32_bf16 v[24:27], v[200:203], a[192:195], v[24:27]
s_nop 0
ds_read_b64_tr_b16 v[164:165], v9 offset:57344
ds_read_b64_tr_b16 v[166:167], v9 offset:59392
v_mfma_f32_16x16x32_bf16 v[24:27], v[216:219], a[196:199], v[24:27]
v_mfma_f32_16x16x32_bf16 v[24:27], v[232:235], a[200:203], v[24:27]
s_nop 0
ds_read_b64_tr_b16 v[168:169], v10 offset:57344
ds_read_b64_tr_b16 v[170:171], v10 offset:59392
v_mfma_f32_16x16x32_bf16 v[24:27], v[248:251], a[204:207], v[24:27]
v_mfma_f32_16x16x32_bf16 v[24:27], v[124:127], v[84:87], v[24:27]
s_nop 0
ds_read_b64_tr_b16 v[172:173], v11 offset:57344
ds_read_b64_tr_b16 v[174:175], v11 offset:59392
v_mfma_f32_16x16x32_bf16 v[40:43], v[248:251], a[220:223], v[40:43]
v_mfma_f32_16x16x32_bf16 v[40:43], v[232:235], a[216:219], v[40:43]
s_nop 0
ds_read_b64_tr_b16 v[176:177], v8 offset:61440
ds_read_b64_tr_b16 v[178:179], v8 offset:63488
v_mfma_f32_16x16x32_bf16 v[40:43], v[216:219], a[212:215], v[40:43]
v_mfma_f32_16x16x32_bf16 v[40:43], v[200:203], a[208:211], v[40:43]
s_nop 0
ds_read_b64_tr_b16 v[180:181], v9 offset:61440
ds_read_b64_tr_b16 v[182:183], v9 offset:63488
v_mfma_f32_16x16x32_bf16 v[40:43], v[124:127], v[92:95], v[40:43]
v_mfma_f32_16x16x32_bf16 v[44:47], v[204:207], a[208:211], v[44:47]
s_nop 0
ds_read_b64_tr_b16 v[184:185], v10 offset:61440
ds_read_b64_tr_b16 v[186:187], v10 offset:63488
v_mfma_f32_16x16x32_bf16 v[44:47], v[220:223], a[212:215], v[44:47]
v_mfma_f32_16x16x32_bf16 v[44:47], v[236:239], a[216:219], v[44:47]
s_nop 0
ds_read_b64_tr_b16 v[188:189], v11 offset:61440
ds_read_b64_tr_b16 v[190:191], v11 offset:63488
v_mfma_f32_16x16x32_bf16 v[44:47], v[252:255], a[220:223], v[44:47]
v_mfma_f32_16x16x32_bf16 v[44:47], v[120:123], v[92:95], v[44:47]
v_mfma_f32_16x16x32_bf16 v[28:31], v[252:255], a[204:207], v[28:31]
s_waitcnt vmcnt(0)
v_max3_u32 v12, v96, v97, v98
v_max3_u32 v13, v99, v100, v101
v_mfma_f32_16x16x32_bf16 v[28:31], v[236:239], a[200:203], v[28:31]
v_max3_u32 v12, v12, v102, v103
v_max3_u32 v13, v13, v104, v105
v_mfma_f32_16x16x32_bf16 v[28:31], v[220:223], a[196:199], v[28:31]
v_max3_u32 v12, v12, v106, v107
v_max3_u32 v13, v13, v108, v109
v_mfma_f32_16x16x32_bf16 v[28:31], v[204:207], a[192:195], v[28:31]
s_waitcnt lgkmcnt(0)
v_max3_u32 v12, v12, v110, v111
v_mfma_f32_16x16x32_bf16 v[28:31], v[120:123], v[84:87], v[28:31]
v_max_u32 v12, v12, v13
v_mfma_f32_16x16x32_bf16 v[16:19], v[128:131], a[224:227], v[16:19]
v_cmp_le_u32 vcc, 0xff800000, v12
v_mfma_f32_16x16x32_bf16 v[16:19], v[144:147], a[228:231], v[16:19]
v_mfma_f32_16x16x32_bf16 v[16:19], v[160:163], a[232:235], v[16:19]
s_cbranch_vccnz Lxspin3
Lxback3:
v_mfma_f32_16x16x32_bf16 v[16:19], v[176:179], a[236:239], v[16:19]
v_mfma_f32_16x16x32_bf16 v[16:19], v[124:127], v[96:99], v[16:19]
v_mfma_f32_16x16x32_bf16 v[20:23], v[180:183], a[236:239], v[20:23]
v_mfma_f32_16x16x32_bf16 v[20:23], v[164:167], a[232:235], v[20:23]
v_mfma_f32_16x16x32_bf16 v[20:23], v[148:151], a[228:231], v[20:23]
v_mfma_f32_16x16x32_bf16 v[20:23], v[132:135], a[224:227], v[20:23]
s_nop 3
v_fma_f32 v16, v16, v6, v48
v_fma_f32 v17, v17, v6, v64
v_mfma_f32_16x16x32_bf16 v[20:23], v[120:123], v[96:99], v[20:23]
v_fma_f32 v18, v18, v6, v49
v_fma_f32 v19, v19, v6, v65
v_mfma_f32_16x16x32_bf16 v[24:27], v[136:139], a[224:227], v[24:27]
v_cvt_pk_bf16_f32 v16, v16, v17
v_cvt_pk_bf16_f32 v17, v18, v19
v_mfma_f32_16x16x32_bf16 v[24:27], v[152:155], a[228:231], v[24:27]
ds_write_b64 v116, v[16:17] offset:0
v_mfma_f32_16x16x32_bf16 v[24:27], v[168:171], a[232:235], v[24:27]
v_mfma_f32_16x16x32_bf16 v[24:27], v[184:187], a[236:239], v[24:27]
v_fma_f32 v20, v20, v6, v50
v_fma_f32 v21, v21, v6, v66
v_mfma_f32_16x16x32_bf16 v[24:27], v[124:127], v[100:103], v[24:27]
v_fma_f32 v22, v22, v6, v51
v_fma_f32 v23, v23, v6, v67
v_mfma_f32_16x16x32_bf16 v[28:31], v[188:191], a[236:239], v[28:31]
v_cvt_pk_bf16_f32 v20, v20, v21
v_cvt_pk_bf16_f32 v21, v22, v23
v_mfma_f32_16x16x32_bf16 v[28:31], v[172:175], a[232:235], v[28:31]
ds_write_b64 v117, v[20:21] offset:0
v_mfma_f32_16x16x32_bf16 v[28:31], v[156:159], a[228:231], v[28:31]
v_mfma_f32_16x16x32_bf16 v[28:31], v[140:143], a[224:227], v[28:31]
v_fma_f32 v24, v24, v6, v52
v_fma_f32 v25, v25, v6, v68
v_mfma_f32_16x16x32_bf16 v[28:31], v[120:123], v[100:103], v[28:31]
v_fma_f32 v26, v26, v6, v53
v_fma_f32 v27, v27, v6, v69
v_mfma_f32_16x16x32_bf16 v[32:35], v[128:131], a[240:243], v[32:35]
v_cvt_pk_bf16_f32 v24, v24, v25
v_cvt_pk_bf16_f32 v25, v26, v27
v_mfma_f32_16x16x32_bf16 v[32:35], v[144:147], a[244:247], v[32:35]
ds_write_b64 v118, v[24:25] offset:0
v_mfma_f32_16x16x32_bf16 v[32:35], v[160:163], a[248:251], v[32:35]
v_mfma_f32_16x16x32_bf16 v[32:35], v[176:179], a[252:255], v[32:35]
v_fma_f32 v28, v28, v6, v54
v_fma_f32 v29, v29, v6, v70
v_mfma_f32_16x16x32_bf16 v[32:35], v[124:127], v[104:107], v[32:35]
v_fma_f32 v30, v30, v6, v55
v_fma_f32 v31, v31, v6, v71
v_mfma_f32_16x16x32_bf16 v[36:39], v[180:183], a[252:255], v[36:39]
v_cvt_pk_bf16_f32 v28, v28, v29
v_cvt_pk_bf16_f32 v29, v30, v31
v_mfma_f32_16x16x32_bf16 v[36:39], v[164:167], a[248:251], v[36:39]
s_nop 0
ds_write_b64 v119, v[28:29] offset:0
ds_read_b128 v[192:195], v4 offset:0
v_mfma_f32_16x16x32_bf16 v[36:39], v[148:151], a[244:247], v[36:39]
ds_read_b128 v[196:199], v4 offset:1024
v_mfma_f32_16x16x32_bf16 v[36:39], v[132:135], a[240:243], v[36:39]
v_fma_f32 v32, v32, v7, v56
v_fma_f32 v33, v33, v7, v72
v_mfma_f32_16x16x32_bf16 v[36:39], v[120:123], v[104:107], v[36:39]
v_fma_f32 v34, v34, v7, v57
v_fma_f32 v35, v35, v7, v73
v_mfma_f32_16x16x32_bf16 v[40:43], v[136:139], a[240:243], v[40:43]
v_cvt_pk_bf16_f32 v32, v32, v33
v_cvt_pk_bf16_f32 v33, v34, v35
v_mfma_f32_16x16x32_bf16 v[40:43], v[152:155], a[244:247], v[40:43]
ds_write_b64 v116, v[32:33] offset:2048
v_mfma_f32_16x16x32_bf16 v[40:43], v[168:171], a[248:251], v[40:43]
s_waitcnt lgkmcnt(2)
buffer_store_dwordx4 v[192:195], v15, s[40:43], s70 offen sc1
v_mfma_f32_16x16x32_bf16 v[40:43], v[184:187], a[252:255], v[40:43]
s_add_u32 s70, s70, 0x4000
v_mfma_f32_16x16x32_bf16 v[40:43], v[124:127], v[108:111], v[40:43]
v_fma_f32 v36, v36, v7, v58
v_fma_f32 v37, v37, v7, v74
v_mfma_f32_16x16x32_bf16 v[44:47], v[188:191], a[252:255], v[44:47]
v_fma_f32 v38, v38, v7, v59
v_fma_f32 v39, v39, v7, v75
v_mfma_f32_16x16x32_bf16 v[44:47], v[172:175], a[248:251], v[44:47]
v_cvt_pk_bf16_f32 v36, v36, v37
v_cvt_pk_bf16_f32 v37, v38, v39
v_mfma_f32_16x16x32_bf16 v[44:47], v[156:159], a[244:247], v[44:47]
ds_write_b64 v117, v[36:37] offset:2048
v_mfma_f32_16x16x32_bf16 v[44:47], v[140:143], a[240:243], v[44:47]
v_fma_f32 v40, v40, v7, v60
v_fma_f32 v41, v41, v7, v76
v_mfma_f32_16x16x32_bf16 v[44:47], v[120:123], v[108:111], v[44:47]
v_fma_f32 v42, v42, v7, v61
v_fma_f32 v43, v43, v7, v77
v_cvt_pk_bf16_f32 v40, v40, v41
v_cvt_pk_bf16_f32 v41, v42, v43
ds_write_b64 v118, v[40:41] offset:2048
s_waitcnt lgkmcnt(3)
buffer_store_dwordx4 v[196:199], v15, s[40:43], s70 offen sc1
s_add_u32 s70, s70, 0x4000
v_fma_f32 v44, v44, v7, v62
v_fma_f32 v45, v45, v7, v78
v_fma_f32 v46, v46, v7, v63
v_fma_f32 v47, v47, v7, v79
v_cvt_pk_bf16_f32 v44, v44, v45
v_cvt_pk_bf16_f32 v45, v46, v47
ds_write_b64 v119, v[44:45] offset:2048
ds_read_b128 v[200:203], v4 offset:2048
ds_read_b128 v[204:207], v4 offset:3072
s_waitcnt lgkmcnt(1)
buffer_store_dwordx4 v[200:203], v15, s[40:43], s70 offen sc1
s_add_u32 s70, s70, 0x4000
s_waitcnt lgkmcnt(0)
buffer_store_dwordx4 v[204:207], v15, s[40:43], s70 offen sc1
s_add_u32 s70, s70, 0x4000
Lend:
s_endpgm
Lspin1:
s_mov_b32 s83, 262144
Lsl3:
s_sleep 2
buffer_load_dword v3, v2, s[48:51], 0 offen sc1
s_sub_u32 s83, s83, 1
s_cmp_eq_u32 s83, 0
s_waitcnt vmcnt(0)
s_cbranch_scc1 Lback2
v_cmp_gt_u32 vcc, 8, v3
s_cbranch_vccnz Lsl3
s_branch Lback2
Lspin4:
s_mov_b32 s83, 262144
Lsl6:
s_sleep 2
buffer_load_dword v3, v2, s[44:47], s75 offen sc1
s_sub_u32 s83, s83, 1
s_cmp_eq_u32 s83, 0
s_waitcnt vmcnt(0)
s_cbranch_scc1 Lback5
v_cmp_gt_u32 vcc, 1, v3
s_cbranch_vccnz Lsl6
s_branch Lback5
.p2align 12
s_endpgm
.p2align 7
LP0x:
Lstub10:
s_cbranch_execz Lret
s_cmp_eq_u32 s58, 2
s_cbranch_scc1 Lta10
s_cmp_eq_u32 s58, 3
s_cbranch_scc1 Lnt11
v_mfma_f32_16x16x32_bf16 v[160:163], a[160:163], v[16:19], v[112:115]
s_xor_b32 s74, s82, 0x10000
v_exp_f32 v128, v128
v_mfma_f32_16x16x32_bf16 v[176:179], a[176:179], v[16:19], v[112:115]
s_add_u32 s74, s74, s64
ds_read_b128 a[128:131], v2 offset:16384
ds_read_b128 a[132:135], v2 offset:17408
s_branch Ljoin12
Lta10:
v_mfma_f32_16x16x32_bf16 v[160:163], a[160:163], v[16:19], v[96:99]
s_xor_b32 s74, s82, 0x10000
v_exp_f32 v128, v128
v_mfma_f32_16x16x32_bf16 v[176:179], a[176:179], v[16:19], v[112:115]
s_add_u32 s74, s74, s64
ds_read_b128 a[128:131], v2 offset:16384
ds_read_b128 a[132:135], v2 offset:17408
s_branch Ljoin12
Lnt11:
v_mfma_f32_16x16x32_bf16 v[160:163], a[160:163], v[16:19], v[80:83]
s_xor_b32 s74, s82, 0x10000
v_exp_f32 v128, v128
v_mfma_f32_16x16x32_bf16 v[176:179], a[176:179], v[16:19], v[96:99]
s_add_u32 s74, s74, s64
ds_read_b128 a[128:131], v2 offset:16384
ds_read_b128 a[132:135], v2 offset:17408
Ljoin12:
v_mfma_f32_16x16x32_bf16 v[164:167], a[160:163], v[32:35], v[84:87]
s_add_u32 s81, s81, 0x8000
v_exp_f32 v129, v129
v_mfma_f32_16x16x32_bf16 v[164:167], a[164:167], v[36:39], v[164:167]
s_add_u32 m0, s74, 16384
v_exp_f32 v130, v130
v_mfma_f32_16x16x32_bf16 v[164:167], a[168:171], v[40:43], v[164:167]
s_add_u32 s72, s81, 16384
v_exp_f32 v131, v131
v_mfma_f32_16x16x32_bf16 v[164:167], a[172:175], v[44:47], v[164:167]
v_exp_f32 v144, v144
v_mfma_f32_16x16x32_bf16 v[172:175], a[172:175], v[76:79], v[92:95]
s_nop 0
ds_read_b128 a[136:139], v2 offset:18432
ds_read_b128 a[140:143], v2 offset:19456
v_mfma_f32_16x16x32_bf16 v[172:175], a[168:171], v[72:75], v[172:175]
s_nop 0
ds_read_b128 a[144:147], v2 offset:20480
ds_read_b128 a[148:151], v2 offset:21504
v_mfma_f32_16x16x32_bf16 v[172:175], a[164:167], v[68:71], v[172:175]
s_nop 0
ds_read_b128 a[152:155], v2 offset:22528
ds_read_b128 a[156:159], v2 offset:23552
v_mfma_f32_16x16x32_bf16 v[172:175], a[160:163], v[64:67], v[172:175]
s_nop 0
ds_read_b128 a[192:195], v2 offset:0
ds_read_b128 a[196:199], v2 offset:1024
v_mfma_f32_16x16x32_bf16 v[188:191], a[176:179], v[64:67], v[92:95]
s_nop 0
ds_read_b128 a[200:203], v2 offset:2048
ds_read_b128 a[204:207], v2 offset:3072
v_mfma_f32_16x16x32_bf16 v[188:191], a[180:183], v[68:71], v[188:191]
s_nop 0
ds_read_b128 a[208:211], v2 offset:4096
ds_read_b128 a[212:215], v2 offset:5120
v_mfma_f32_16x16x32_bf16 v[188:191], a[184:187], v[72:75], v[188:191]
s_nop 0
ds_read_b128 a[216:219], v2 offset:6144
ds_read_b128 a[220:223], v2 offset:7168
v_mfma_f32_16x16x32_bf16 v[188:191], a[188:191], v[76:79], v[188:191]
v_cvt_pk_bf16_f32 v192, v128, v129
v_cvt_pk_bf16_f32 v193, v130, v131
v_mfma_f32_16x16x32_bf16 v[180:183], a[188:191], v[44:47], v[84:87]
buffer_load_dwordx4 v1, s[44:47], s72 offen sc1 lds
v_mfma_f32_16x16x32_bf16 v[180:183], a[184:187], v[40:43], v[180:183]
v_exp_f32 v145, v145
v_mfma_f32_16x16x32_bf16 v[180:183], a[180:183], v[36:39], v[180:183]
v_exp_f32 v146, v146
v_mfma_f32_16x16x32_bf16 v[180:183], a[176:179], v[32:35], v[180:183]
v_exp_f32 v147, v147
v_mfma_f32_16x16x32_bf16 v[160:163], a[164:167], v[20:23], v[160:163]
v_exp_f32 v136, v136
v_mfma_f32_16x16x32_bf16 v[160:163], a[168:171], v[24:27], v[160:163]
v_cvt_pk_bf16_f32 v194, v144, v145
v_cvt_pk_bf16_f32 v195, v146, v147
v_mfma_f32_16x16x32_bf16 v[160:163], a[172:175], v[28:31], v[160:163]
v_exp_f32 v137, v137
v_mfma_f32_16x16x32_bf16 v[168:171], a[172:175], v[60:63], v[88:91]
v_exp_f32 v138, v138
v_mfma_f32_16x16x32_bf16 v[168:171], a[168:171], v[56:59], v[168:171]
v_exp_f32 v139, v139
v_mfma_f32_16x16x32_bf16 v[168:171], a[164:167], v[52:55], v[168:171]
v_exp_f32 v152, v152
v_mfma_f32_16x16x32_bf16 v[168:171], a[160:163], v[48:51], v[168:171]
v_cvt_pk_bf16_f32 v200, v136, v137
v_cvt_pk_bf16_f32 v201, v138, v139
v_mfma_f32_16x16x32_bf16 v[184:187], a[176:179], v[48:51], v[88:91]
buffer_load_dwordx4 v1, s[44:47], s72 offen offset:1024 sc1 lds
v_mfma_f32_16x16x32_bf16 v[184:187], a[180:183], v[52:55], v[184:187]
v_exp_f32 v153, v153
v_mfma_f32_16x16x32_bf16 v[184:187], a[184:187], v[56:59], v[184:187]
v_exp_f32 v154, v154
v_mfma_f32_16x16x32_bf16 v[184:187], a[188:191], v[60:63], v[184:187]
v_exp_f32 v155, v155
v_mfma_f32_16x16x32_bf16 v[176:179], a[188:191], v[28:31], v[176:179]
buffer_load_dwordx4 v1, s[44:47], s72 offen offset:2048 sc1 lds
v_mfma_f32_16x16x32_bf16 v[176:179], a[184:187], v[24:27], v[176:179]
buffer_load_dwordx4 v1, s[44:47], s72 offen offset:3072 sc1 lds
v_mfma_f32_16x16x32_bf16 v[176:179], a[180:183], v[20:23], v[176:179]
s_waitcnt lgkmcnt(4)
v_exp_f32 v132, v132
v_cvt_pk_bf16_f32 v202, v152, v153
v_cvt_pk_bf16_f32 v203, v154, v155
v_exp_f32 v133, v133
v_exp_f32 v134, v134
v_cvt_pk_bf16_f32 v196, v132, v133
v_exp_f32 v135, v135
v_exp_f32 v148, v148
v_cvt_pk_bf16_f32 v197, v134, v135
v_exp_f32 v149, v149
v_exp_f32 v150, v150
v_cvt_pk_bf16_f32 v198, v148, v149
v_exp_f32 v151, v151
v_exp_f32 v140, v140
v_cvt_pk_bf16_f32 v199, v150, v151
v_exp_f32 v141, v141
v_exp_f32 v142, v142
v_cvt_pk_bf16_f32 v204, v140, v141
v_exp_f32 v143, v143
v_exp_f32 v156, v156
v_cvt_pk_bf16_f32 v205, v142, v143
v_exp_f32 v157, v157
v_exp_f32 v158, v158
v_cvt_pk_bf16_f32 v206, v156, v157
v_exp_f32 v159, v159
s_nop 0
v_cvt_pk_bf16_f32 v207, v158, v159
v_mfma_f32_16x16x32_bf16 v[224:227], v[120:123], v[192:195], 0
s_add_u32 s82, s82, 0x8000
ds_read_b128 a[160:163], v2 offset:24576
ds_read_b128 a[164:167], v2 offset:25600
v_mfma_f32_16x16x32_bf16 v[232:235], v[120:123], v[200:203], 0
s_and_b32 s82, s82, 0x1ffff
v_exp_f32 v164, v164
v_mfma_f32_16x16x32_bf16 a[0:3], a[192:195], v[192:195], 0
s_add_u32 m0, s74, 0
v_exp_f32 v165, v165
v_mfma_f32_16x16x32_bf16 a[64:67], a[192:195], v[200:203], 0
s_add_u32 s72, s81, 0
v_exp_f32 v166, v166
v_mfma_f32_16x16x32_bf16 a[68:71], a[196:199], v[200:203], 0
buffer_load_dwordx4 v1, s[44:47], s72 offen sc1 lds
v_mfma_f32_16x16x32_bf16 a[4:7], a[196:199], v[192:195], 0
v_exp_f32 v167, v167
v_mfma_f32_16x16x32_bf16 a[8:11], a[200:203], v[192:195], 0
s_nop 0
ds_read_b128 a[168:171], v2 offset:26624
ds_read_b128 a[172:175], v2 offset:27648
v_mfma_f32_16x16x32_bf16 a[72:75], a[200:203], v[200:203], 0
v_exp_f32 v180, v180
v_mfma_f32_16x16x32_bf16 a[76:79], a[204:207], v[200:203], 0
s_nop 0
ds_read_b128 a[176:179], v2 offset:28672
ds_read_b128 a[180:183], v2 offset:29696
v_mfma_f32_16x16x32_bf16 a[12:15], a[204:207], v[192:195], 0
s_waitcnt lgkmcnt(6)
ds_read_b128 a[184:187], v2 offset:30720
ds_read_b128 a[188:191], v2 offset:31744
v_mfma_f32_16x16x32_bf16 a[16:19], a[208:211], v[192:195], 0
s_nop 0
ds_read_b128 a[224:227], v2 offset:8192
ds_read_b128 a[228:231], v2 offset:9216
v_mfma_f32_16x16x32_bf16 a[80:83], a[208:211], v[200:203], 0
s_nop 0
ds_read_b128 a[232:235], v2 offset:10240
ds_read_b128 a[236:239], v2 offset:11264
v_mfma_f32_16x16x32_bf16 a[84:87], a[212:215], v[200:203], 0
s_nop 0
ds_read_b128 a[240:243], v2 offset:12288
ds_read_b128 a[244:247], v2 offset:13312
v_mfma_f32_16x16x32_bf16 a[20:23], a[212:215], v[192:195], 0
s_nop 0
ds_read_b128 a[248:251], v2 offset:14336
ds_read_b128 a[252:255], v2 offset:15360
v_mfma_f32_16x16x32_bf16 a[24:27], a[216:219], v[192:195], 0
v_cvt_pk_bf16_f32 v212, v164, v165
v_cvt_pk_bf16_f32 v213, v166, v167
v_mfma_f32_16x16x32_bf16 a[88:91], a[216:219], v[200:203], 0
v_exp_f32 v181, v181
v_mfma_f32_16x16x32_bf16 a[92:95], a[220:223], v[200:203], 0
v_exp_f32 v182, v182
v_mfma_f32_16x16x32_bf16 a[28:31], a[220:223], v[192:195], 0
buffer_load_dwordx4 v1, s[44:47], s72 offen offset:1024 sc1 lds
s_cmp_eq_u32 s58, 0
s_cbranch_scc1 Lta13
s_cmp_eq_u32 s58, 1
s_cbranch_scc1 Lnt14
v_mfma_f32_16x16x32_bf16 v[132:135], a[128:131], v[32:35], v[84:87]
v_exp_f32 v183, v183
v_mfma_f32_16x16x32_bf16 v[148:151], a[144:147], v[32:35], v[84:87]
v_exp_f32 v172, v172
s_branch Ljoin15
Lta13:
v_mfma_f32_16x16x32_bf16 v[132:135], a[128:131], v[32:35], v[100:103]
v_exp_f32 v183, v183
v_mfma_f32_16x16x32_bf16 v[148:151], a[144:147], v[32:35], v[112:115]
v_exp_f32 v172, v172
s_branch Ljoin15
Lnt14:
v_mfma_f32_16x16x32_bf16 v[132:135], a[128:131], v[32:35], v[84:87]
v_exp_f32 v183, v183
v_mfma_f32_16x16x32_bf16 v[148:151], a[144:147], v[32:35], v[100:103]
v_exp_f32 v172, v172
Ljoin15:
v_mfma_f32_16x16x32_bf16 v[136:139], a[128:131], v[48:51], v[88:91]
v_cvt_pk_bf16_f32 v214, v180, v181
v_cvt_pk_bf16_f32 v215, v182, v183
v_mfma_f32_16x16x32_bf16 v[136:139], a[132:135], v[52:55], v[136:139]
v_exp_f32 v173, v173
v_mfma_f32_16x16x32_bf16 v[136:139], a[136:139], v[56:59], v[136:139]
buffer_load_dwordx4 v1, s[44:47], s72 offen offset:2048 sc1 lds
v_mfma_f32_16x16x32_bf16 v[136:139], a[140:143], v[60:63], v[136:139]
v_exp_f32 v174, v174
v_mfma_f32_16x16x32_bf16 v[152:155], a[156:159], v[60:63], v[88:91]
v_exp_f32 v175, v175
v_mfma_f32_16x16x32_bf16 v[152:155], a[152:155], v[56:59], v[152:155]
v_exp_f32 v188, v188
v_mfma_f32_16x16x32_bf16 v[152:155], a[148:151], v[52:55], v[152:155]
v_cvt_pk_bf16_f32 v220, v172, v173
v_cvt_pk_bf16_f32 v221, v174, v175
v_mfma_f32_16x16x32_bf16 v[152:155], a[144:147], v[48:51], v[152:155]
v_exp_f32 v189, v189
v_mfma_f32_16x16x32_bf16 v[132:135], a[132:135], v[36:39], v[132:135]
buffer_load_dwordx4 v1, s[44:47], s72 offen offset:3072 sc1 lds
v_mfma_f32_16x16x32_bf16 v[132:135], a[136:139], v[40:43], v[132:135]
s_add_u32 s66, s58, 1
v_exp_f32 v190, v190
v_mfma_f32_16x16x32_bf16 v[132:135], a[140:143], v[44:47], v[132:135]
s_and_b32 s66, s66, 3
v_exp_f32 v191, v191
v_mfma_f32_16x16x32_bf16 v[140:143], a[140:143], v[76:79], v[92:95]
s_mul_i32 s66, s66, 4160
v_exp_f32 v160, v160
v_mfma_f32_16x16x32_bf16 v[140:143], a[136:139], v[72:75], v[140:143]
s_add_u32 m0, s66, 131104
v_cvt_pk_bf16_f32 v222, v188, v189
v_cvt_pk_bf16_f32 v223, v190, v191
v_mfma_f32_16x16x32_bf16 v[140:143], a[132:135], v[68:71], v[140:143]
s_add_u32 s72, s93, 0x2
v_exp_f32 v161, v161
v_mfma_f32_16x16x32_bf16 v[140:143], a[128:131], v[64:67], v[140:143]
buffer_load_dwordx4 v1, s[36:39], s72 offen lds
v_mfma_f32_16x16x32_bf16 v[156:159], a[144:147], v[64:67], v[92:95]
v_exp_f32 v162, v162
v_mfma_f32_16x16x32_bf16 v[156:159], a[148:151], v[68:71], v[156:159]
v_exp_f32 v163, v163
v_mfma_f32_16x16x32_bf16 v[156:159], a[152:155], v[72:75], v[156:159]
buffer_load_dwordx4 v1, s[36:39], s72 offen offset:1024 lds
v_mfma_f32_16x16x32_bf16 v[156:159], a[156:159], v[76:79], v[156:159]
buffer_load_dwordx4 v1, s[36:39], s72 offen offset:2048 lds
v_mfma_f32_16x16x32_bf16 v[148:151], a[156:159], v[44:47], v[148:151]
buffer_load_dwordx4 v1, s[36:39], s72 offen offset:3072 lds
v_mfma_f32_16x16x32_bf16 v[148:151], a[152:155], v[40:43], v[148:151]
s_waitcnt vmcnt(12) lgkmcnt(4)
v_exp_f32 v176, v176
v_mfma_f32_16x16x32_bf16 v[148:151], a[148:151], v[36:39], v[148:151]
s_barrier
v_cvt_pk_bf16_f32 v208, v160, v161
v_cvt_pk_bf16_f32 v209, v162, v163
v_add_u32 v2, s82, v1
v_exp_f32 v177, v177
v_exp_f32 v178, v178
v_cvt_pk_bf16_f32 v210, v176, v177
v_exp_f32 v179, v179
v_exp_f32 v168, v168
v_cvt_pk_bf16_f32 v211, v178, v179
v_exp_f32 v169, v169
v_exp_f32 v170, v170
v_cvt_pk_bf16_f32 v216, v168, v169
v_exp_f32 v171, v171
v_exp_f32 v184, v184
v_cvt_pk_bf16_f32 v217, v170, v171
v_exp_f32 v185, v185
v_exp_f32 v186, v186
v_cvt_pk_bf16_f32 v218, v184, v185
v_exp_f32 v187, v187
s_nop 0
v_cvt_pk_bf16_f32 v219, v186, v187
s_branch LLT3
.p2align 12
s_endpgm
.p2align 7
LLT3x:
Lstub11:
s_cbranch_execz Lret
v_mfma_f32_16x16x32_bf16 v[228:231], v[120:123], v[196:199], v[228:231]
s_xor_b32 s74, s82, 0x10000
ds_read_b128 a[128:131], v2 offset:16384
v_and_b32 v240, 15, v0
v_mfma_f32_16x16x32_bf16 v[228:231], v[120:123], v[212:215], v[228:231]
s_add_u32 s74, s74, s64
v_exp_f32 v136, v136
v_mfma_f32_16x16x32_bf16 v[236:239], v[120:123], v[204:207], v[236:239]
s_add_u32 s81, s81, 0x8000
v_exp_f32 v137, v137
v_mfma_f32_16x16x32_bf16 v[236:239], v[120:123], v[220:223], v[236:239]
s_add_u32 m0, s74, 0
ds_read_b128 a[132:135], v2 offset:17408
v_cvt_pk_bf16_f32 v200, v136, v137
v_mfma_f32_16x16x32_bf16 a[32:35], a[192:195], v[196:199], a[32:35]
s_add_u32 s72, s81, 0
buffer_load_dwordx4 v1, s[44:47], s72 offen sc1 lds
v_mfma_f32_16x16x32_bf16 a[32:35], a[224:227], v[212:215], a[32:35]
s_add_u32 s69, s93, 0x3e00000
v_exp_f32 v138, v138
v_mfma_f32_16x16x32_bf16 a[96:99], a[224:227], v[220:223], a[96:99]
ds_read_b128 a[136:139], v2 offset:18432
v_lshrrev_b32 v241, 4, v0
v_mfma_f32_16x16x32_bf16 a[96:99], a[192:195], v[204:207], a[96:99]
v_exp_f32 v139, v139
v_mfma_f32_16x16x32_bf16 a[100:103], a[196:199], v[204:207], a[100:103]
buffer_store_dwordx4 v[112:115], v1, s[44:47], s69 offen sc1
v_mfma_f32_16x16x32_bf16 a[100:103], a[228:231], v[220:223], a[100:103]
v_exp_f32 v152, v152
v_mfma_f32_16x16x32_bf16 a[36:39], a[228:231], v[212:215], a[36:39]
ds_read_b128 a[140:143], v2 offset:19456
v_cvt_pk_bf16_f32 v201, v138, v139
v_mfma_f32_16x16x32_bf16 a[36:39], a[196:199], v[196:199], a[36:39]
v_exp_f32 v153, v153
v_mfma_f32_16x16x32_bf16 a[40:43], a[200:203], v[196:199], a[40:43]
buffer_load_dwordx4 v1, s[44:47], s72 offen offset:1024 sc1 lds
v_mfma_f32_16x16x32_bf16 a[40:43], a[232:235], v[212:215], a[40:43]
ds_read_b128 a[144:147], v2 offset:20480
v_cvt_pk_bf16_f32 v202, v152, v153
v_mfma_f32_16x16x32_bf16 a[104:107], a[232:235], v[220:223], a[104:107]
v_exp_f32 v154, v154
v_mfma_f32_16x16x32_bf16 a[104:107], a[200:203], v[204:207], a[104:107]
v_exp_f32 v155, v155
v_mfma_f32_16x16x32_bf16 a[108:111], a[204:207], v[204:207], a[108:111]
buffer_store_dwordx4 v[112:115], v1, s[44:47], s69 offen offset:1024 sc1
v_mfma_f32_16x16x32_bf16 a[108:111], a[236:239], v[220:223], a[108:111]
ds_read_b128 a[148:151], v2 offset:21504
v_cvt_pk_bf16_f32 v203, v154, v155
v_mfma_f32_16x16x32_bf16 a[44:47], a[236:239], v[212:215], a[44:47]
v_exp_f32 v132, v132
v_mfma_f32_16x16x32_bf16 a[44:47], a[204:207], v[196:199], a[44:47]
ds_read_b128 a[152:155], v2 offset:22528
v_add_u32 v248, 1, v240
v_mfma_f32_16x16x32_bf16 a[48:51], a[208:211], v[196:199], a[48:51]
s_waitcnt lgkmcnt(7)
v_exp_f32 v133, v133
v_mfma_f32_16x16x32_bf16 a[48:51], a[240:243], v[212:215], a[48:51]
buffer_load_dwordx4 v1, s[44:47], s72 offen offset:2048 sc1 lds
v_mfma_f32_16x16x32_bf16 a[112:115], a[240:243], v[220:223], a[112:115]
v_exp_f32 v134, v134
v_mfma_f32_16x16x32_bf16 a[112:115], a[208:211], v[204:207], a[112:115]
ds_read_b128 a[156:159], v2 offset:23552
v_and_b32 v249, 3, v248
v_mfma_f32_16x16x32_bf16 a[116:119], a[212:215], v[204:207], a[116:119]
v_exp_f32 v135, v135
v_mfma_f32_16x16x32_bf16 a[116:119], a[244:247], v[220:223], a[116:119]
buffer_store_dwordx4 v[112:115], v1, s[44:47], s69 offen offset:2048 sc1
v_mfma_f32_16x16x32_bf16 a[52:55], a[244:247], v[212:215], a[52:55]
ds_read_b128 a[192:195], v2 offset:0
v_lshrrev_b32 v248, 2, v248
v_mfma_f32_16x16x32_bf16 a[52:55], a[212:215], v[196:199], a[52:55]
v_exp_f32 v148, v148
v_mfma_f32_16x16x32_bf16 a[56:59], a[216:219], v[196:199], a[56:59]
buffer_load_dwordx4 v1, s[44:47], s72 offen offset:3072 sc1 lds
v_mfma_f32_16x16x32_bf16 a[56:59], a[248:251], v[212:215], a[56:59]
v_exp_f32 v149, v149
v_mfma_f32_16x16x32_bf16 a[120:123], a[248:251], v[220:223], a[120:123]
ds_read_b128 a[196:199], v2 offset:1024
v_mov_b32 v250, 0x20000
v_mfma_f32_16x16x32_bf16 a[120:123], a[216:219], v[204:207], a[120:123]
v_exp_f32 v150, v150
v_mfma_f32_16x16x32_bf16 a[124:127], a[220:223], v[204:207], a[124:127]
ds_read_b128 a[200:203], v2 offset:2048
v_mov_b32 v252, 0x20001
v_mfma_f32_16x16x32_bf16 a[124:127], a[252:255], v[220:223], a[124:127]
buffer_store_dwordx4 v[112:115], v1, s[44:47], s69 offen offset:3072 sc1
v_mfma_f32_16x16x32_bf16 a[60:63], a[252:255], v[212:215], a[60:63]
s_add_u32 s69, s93, 0x4200000
v_exp_f32 v151, v151
v_mfma_f32_16x16x32_bf16 a[60:63], a[220:223], v[196:199], a[60:63]
ds_read_b128 a[204:207], v2 offset:3072
v_cvt_pk_bf16_f32 v196, v132, v133
s_cmp_eq_u32 s58, 2
s_cbranch_scc1 Lta40
s_cmp_eq_u32 s58, 3
s_cbranch_scc1 Lnt41
v_mfma_f32_16x16x32_bf16 v[164:167], a[160:163], v[32:35], v[112:115]
ds_read_b128 a[208:211], v2 offset:4096
v_cvt_pk_bf16_f32 v197, v134, v135
v_mfma_f32_16x16x32_bf16 v[180:183], a[176:179], v[32:35], v[112:115]
v_exp_f32 v140, v140
s_branch Ljoin42
Lta40:
v_mfma_f32_16x16x32_bf16 v[164:167], a[160:163], v[32:35], v[100:103]
ds_read_b128 a[208:211], v2 offset:4096
v_cvt_pk_bf16_f32 v197, v134, v135
v_mfma_f32_16x16x32_bf16 v[180:183], a[176:179], v[32:35], v[112:115]
v_exp_f32 v140, v140
s_branch Ljoin42
Lnt41:
v_mfma_f32_16x16x32_bf16 v[164:167], a[160:163], v[32:35], v[84:87]
ds_read_b128 a[208:211], v2 offset:4096
v_cvt_pk_bf16_f32 v197, v134, v135
v_mfma_f32_16x16x32_bf16 v[180:183], a[176:179], v[32:35], v[100:103]
v_exp_f32 v140, v140
Ljoin42:
v_mfma_f32_16x16x32_bf16 v[164:167], a[164:167], v[36:39], v[164:167]
ds_read_b128 a[212:215], v2 offset:5120
v_cvt_pk_bf16_f32 v198, v148, v149
v_mfma_f32_16x16x32_bf16 v[164:167], a[168:171], v[40:43], v[164:167]
buffer_store_dwordx4 v[112:115], v1, s[44:47], s69 offen sc1
v_mfma_f32_16x16x32_bf16 v[164:167], a[172:175], v[44:47], v[164:167]
v_exp_f32 v141, v141
v_mfma_f32_16x16x32_bf16 v[172:175], a[172:175], v[76:79], v[92:95]
v_exp_f32 v142, v142
v_mfma_f32_16x16x32_bf16 v[172:175], a[168:171], v[72:75], v[172:175]
ds_read_b128 a[216:219], v2 offset:6144
v_cvt_pk_bf16_f32 v199, v150, v151
v_mfma_f32_16x16x32_bf16 v[172:175], a[164:167], v[68:71], v[172:175]
buffer_store_dwordx4 v[112:115], v1, s[44:47], s69 offen offset:1024 sc1
v_mfma_f32_16x16x32_bf16 v[172:175], a[160:163], v[64:67], v[172:175]
v_exp_f32 v143, v143
v_mfma_f32_16x16x32_bf16 v[188:191], a[176:179], v[64:67], v[92:95]
v_exp_f32 v156, v156
v_mfma_f32_16x16x32_bf16 v[188:191], a[180:183], v[68:71], v[188:191]
ds_read_b128 a[220:223], v2 offset:7168
v_cvt_pk_bf16_f32 v204, v140, v141
v_mfma_f32_16x16x32_bf16 v[188:191], a[184:187], v[72:75], v[188:191]
buffer_store_dwordx4 v[112:115], v1, s[44:47], s69 offen offset:2048 sc1
v_mfma_f32_16x16x32_bf16 v[188:191], a[188:191], v[76:79], v[188:191]
v_exp_f32 v157, v157
v_mfma_f32_16x16x32_bf16 v[180:183], a[188:191], v[44:47], v[180:183]
v_exp_f32 v158, v158
v_mfma_f32_16x16x32_bf16 v[180:183], a[184:187], v[40:43], v[180:183]
v_cvt_pk_bf16_f32 v205, v142, v143
v_cvt_pk_bf16_f32 v206, v156, v157
v_mfma_f32_16x16x32_bf16 v[180:183], a[180:183], v[36:39], v[180:183]
buffer_store_dwordx4 v[112:115], v1, s[44:47], s69 offen offset:3072 sc1
v_mfma_f32_16x16x32_bf16 v[168:171], a[160:163], v[48:51], v[88:91]
v_exp_f32 v159, v159
v_mfma_f32_16x16x32_bf16 v[168:171], a[164:167], v[52:55], v[168:171]
v_cvt_pk_bf16_f32 v207, v158, v159
v_lshlrev_b32 v6, 3, v249
v_mfma_f32_16x16x32_bf16 v[168:171], a[168:171], v[56:59], v[168:171]
v_lshrrev_b32 v6, v6, v252
v_and_b32 v6, 3, v6
v_mfma_f32_16x16x32_bf16 v[168:171], a[172:175], v[60:63], v[168:171]
v_cmp_ne_u32 vcc, 1, v249
v_mul_u32_u24 v6, 16640, v6
v_mfma_f32_16x16x32_bf16 v[184:187], a[188:191], v[60:63], v[88:91]
v_add_u32 v6, s92, v6
v_cndmask_b32 v6, v250, v6, vcc
v_mfma_f32_16x16x32_bf16 v[184:187], a[184:187], v[56:59], v[184:187]
v_add_u32 v253, s58, v249
v_and_b32 v253, 3, v253
v_mfma_f32_16x16x32_bf16 v[184:187], a[180:183], v[52:55], v[184:187]
s_waitcnt lgkmcnt(4)
v_mfma_f32_16x16x32_bf16 v[184:187], a[176:179], v[48:51], v[184:187]
s_barrier
s_lshr_b32 s69, s93, 4
s_and_b32 s69, s69, 0x7f00
s_add_u32 s69, s69, LHT4-Lpc0
v_lshrrev_b32 v3, 5, v0
v_lshlrev_b32 v3, 7, v3
v_add_u32 v3, s69, v3
v_min_u32 v3, Lcode_end-Lpc0, v3
global_load_dword v4, v3, s[98:99]
v_mfma_f32_16x16x32_bf16 v[224:227], v[120:123], v[208:211], v[224:227]
s_add_u32 s82, s82, 0x8000
ds_read_b128 a[160:163], v2 offset:24576
ds_read_b128 a[164:167], v2 offset:25600
v_mfma_f32_16x16x32_bf16 v[232:235], v[120:123], v[216:219], v[232:235]
s_and_b32 s82, s82, 0x1ffff
v_exp_f32 v164, v164
v_mfma_f32_16x16x32_bf16 v[232:235], v[120:123], v[200:203], v[232:235]
s_add_u32 s66, s58, 3
v_exp_f32 v165, v165
v_mfma_f32_16x16x32_bf16 a[0:3], a[224:227], v[208:211], a[0:3]
s_and_b32 s66, s66, 3
v_exp_f32 v166, v166
v_mfma_f32_16x16x32_bf16 a[64:67], a[192:195], v[200:203], a[64:67]
s_mul_i32 s66, s66, 4160
ds_read_b128 a[168:171], v2 offset:26624
v_cvt_pk_bf16_f32 v212, v164, v165
v_mfma_f32_16x16x32_bf16 a[64:67], a[224:227], v[216:219], a[64:67]
s_add_u32 s66, s66, s92
v_exp_f32 v167, v167
v_mfma_f32_16x16x32_bf16 a[68:71], a[228:231], v[216:219], a[68:71]
s_add_u32 m0, s66, 32
v_exp_f32 v180, v180
v_mfma_f32_16x16x32_bf16 a[68:71], a[196:199], v[200:203], a[68:71]
s_add_u32 s72, s93, 0x6
buffer_load_dwordx4 v1, s[36:39], s72 offen lds
v_mfma_f32_16x16x32_bf16 a[4:7], a[228:231], v[208:211], a[4:7]
ds_read_b128 a[172:175], v2 offset:27648
v_cvt_pk_bf16_f32 v213, v166, v167
v_mfma_f32_16x16x32_bf16 a[8:11], a[232:235], v[208:211], a[8:11]
v_exp_f32 v181, v181
v_mfma_f32_16x16x32_bf16 a[72:75], a[200:203], v[200:203], a[72:75]
ds_read_b128 a[176:179], v2 offset:28672
v_cvt_pk_bf16_f32 v214, v180, v181
v_mfma_f32_16x16x32_bf16 a[72:75], a[232:235], v[216:219], a[72:75]
v_exp_f32 v182, v182
v_mfma_f32_16x16x32_bf16 a[76:79], a[236:239], v[216:219], a[76:79]
v_exp_f32 v183, v183
v_mfma_f32_16x16x32_bf16 a[76:79], a[204:207], v[200:203], a[76:79]
ds_read_b128 a[180:183], v2 offset:29696
v_cvt_pk_bf16_f32 v215, v182, v183
v_mfma_f32_16x16x32_bf16 a[12:15], a[236:239], v[208:211], a[12:15]
v_exp_f32 v172, v172
v_mfma_f32_16x16x32_bf16 a[16:19], a[240:243], v[208:211], a[16:19]
s_waitcnt lgkmcnt(6)
ds_read_b128 a[184:187], v2 offset:30720
ds_read_b128 a[188:191], v2 offset:31744
v_mfma_f32_16x16x32_bf16 a[80:83], a[208:211], v[200:203], a[80:83]
v_exp_f32 v173, v173
v_mfma_f32_16x16x32_bf16 a[80:83], a[240:243], v[216:219], a[80:83]
buffer_load_dwordx4 v1, s[36:39], s72 offen offset:1024 lds
v_mfma_f32_16x16x32_bf16 a[84:87], a[244:247], v[216:219], a[84:87]
v_exp_f32 v174, v174
v_mfma_f32_16x16x32_bf16 a[84:87], a[212:215], v[200:203], a[84:87]
v_exp_f32 v175, v175
v_mfma_f32_16x16x32_bf16 a[20:23], a[244:247], v[208:211], a[20:23]
ds_read_b128 a[224:227], v2 offset:8192
v_cvt_pk_bf16_f32 v220, v172, v173
v_mfma_f32_16x16x32_bf16 a[24:27], a[248:251], v[208:211], a[24:27]
v_exp_f32 v188, v188
v_mfma_f32_16x16x32_bf16 a[88:91], a[216:219], v[200:203], a[88:91]
v_exp_f32 v189, v189
v_mfma_f32_16x16x32_bf16 a[88:91], a[248:251], v[216:219], a[88:91]
ds_read_b128 a[228:231], v2 offset:9216
v_cvt_pk_bf16_f32 v221, v174, v175
v_mfma_f32_16x16x32_bf16 a[92:95], a[252:255], v[216:219], a[92:95]
v_exp_f32 v190, v190
v_mfma_f32_16x16x32_bf16 a[92:95], a[220:223], v[200:203], a[92:95]
ds_read_b128 a[232:235], v2 offset:10240
v_cvt_pk_bf16_f32 v222, v188, v189
v_mfma_f32_16x16x32_bf16 a[28:31], a[252:255], v[208:211], a[28:31]
v_exp_f32 v191, v191
s_cmp_eq_u32 s58, 0
s_cbranch_scc1 Lta43
s_cmp_eq_u32 s58, 1
s_cbranch_scc1 Lnt44
v_mfma_f32_16x16x32_bf16 v[136:139], a[128:131], v[48:51], v[88:91]
buffer_load_dwordx4 v1, s[36:39], s72 offen offset:2048 lds
v_mfma_f32_16x16x32_bf16 v[152:155], a[144:147], v[48:51], v[88:91]
v_exp_f32 v168, v168
s_branch Ljoin45
Lta43:
v_mfma_f32_16x16x32_bf16 v[136:139], a[128:131], v[48:51], v[104:107]
buffer_load_dwordx4 v1, s[36:39], s72 offen offset:2048 lds
v_mfma_f32_16x16x32_bf16 v[152:155], a[144:147], v[48:51], v[112:115]
v_exp_f32 v168, v168
s_branch Ljoin45
Lnt44:
v_mfma_f32_16x16x32_bf16 v[136:139], a[128:131], v[48:51], v[88:91]
buffer_load_dwordx4 v1, s[36:39], s72 offen offset:2048 lds
v_mfma_f32_16x16x32_bf16 v[152:155], a[144:147], v[48:51], v[104:107]
v_exp_f32 v168, v168
Ljoin45:
v_mfma_f32_16x16x32_bf16 v[136:139], a[132:135], v[52:55], v[136:139]
ds_read_b128 a[236:239], v2 offset:11264
v_cvt_pk_bf16_f32 v223, v190, v191
v_mfma_f32_16x16x32_bf16 v[136:139], a[136:139], v[56:59], v[136:139]
v_exp_f32 v169, v169
v_mfma_f32_16x16x32_bf16 v[136:139], a[140:143], v[60:63], v[136:139]
ds_read_b128 a[240:243], v2 offset:12288
v_cvt_pk_bf16_f32 v216, v168, v169
v_mfma_f32_16x16x32_bf16 v[152:155], a[156:159], v[60:63], v[152:155]
v_exp_f32 v170, v170
v_mfma_f32_16x16x32_bf16 v[152:155], a[152:155], v[56:59], v[152:155]
v_exp_f32 v171, v171
v_mfma_f32_16x16x32_bf16 v[152:155], a[148:151], v[52:55], v[152:155]
ds_read_b128 a[244:247], v2 offset:13312
v_cvt_pk_bf16_f32 v217, v170, v171
v_mfma_f32_16x16x32_bf16 v[140:143], a[128:131], v[64:67], v[92:95]
v_exp_f32 v184, v184
v_mfma_f32_16x16x32_bf16 v[140:143], a[132:135], v[68:71], v[140:143]
ds_read_b128 a[248:251], v2 offset:14336
v_mfma_f32_16x16x32_bf16 v[140:143], a[136:139], v[72:75], v[140:143]
v_exp_f32 v185, v185
v_mfma_f32_16x16x32_bf16 v[140:143], a[140:143], v[76:79], v[140:143]
buffer_load_dwordx4 v1, s[36:39], s72 offen offset:3072 lds
v_mfma_f32_16x16x32_bf16 v[156:159], a[156:159], v[76:79], v[92:95]
ds_read_b128 a[252:255], v2 offset:15360
v_cvt_pk_bf16_f32 v218, v184, v185
v_mfma_f32_16x16x32_bf16 v[156:159], a[152:155], v[72:75], v[156:159]
v_exp_f32 v186, v186
v_mfma_f32_16x16x32_bf16 v[156:159], a[148:151], v[68:71], v[156:159]
s_waitcnt vmcnt(17) lgkmcnt(0)
v_exp_f32 v187, v187
v_mfma_f32_16x16x32_bf16 v[156:159], a[144:147], v[64:67], v[156:159]
s_barrier
v_cvt_pk_bf16_f32 v219, v186, v187
v_add_u32 v2, s82, v1
v_mfma_f32_16x16x32_bf16 v[228:231], v[120:123], v[196:199], v[228:231]
s_mov_b32 m0, s62
v_exp_f32 v136, v136
v_mfma_f32_16x16x32_bf16 v[228:231], v[120:123], v[212:215], v[228:231]
s_add_u32 s72, s93, 0x3000000
ds_read_b128 a[128:131], v2 offset:16384
v_mul_u32_u24 v253, 4160, v253
v_mfma_f32_16x16x32_bf16 v[236:239], v[120:123], v[204:207], v[236:239]
buffer_load_dwordx4 v1, s[44:47], s72 offen sc1 lds
v_mfma_f32_16x16x32_bf16 v[236:239], v[120:123], v[220:223], v[236:239]
v_exp_f32 v137, v137
v_mfma_f32_16x16x32_bf16 a[32:35], a[192:195], v[196:199], a[32:35]
ds_read_b128 a[132:135], v2 offset:17408
v_cvt_pk_bf16_f32 v200, v136, v137
v_mfma_f32_16x16x32_bf16 a[32:35], a[224:227], v[212:215], a[32:35]
v_exp_f32 v138, v138
v_mfma_f32_16x16x32_bf16 a[96:99], a[224:227], v[220:223], a[96:99]
ds_read_b128 a[136:139], v2 offset:18432
v_add_u32 v6, v6, v253
v_mfma_f32_16x16x32_bf16 a[96:99], a[192:195], v[204:207], a[96:99]
buffer_load_dwordx4 v1, s[44:47], s72 offen offset:1024 sc1 lds
v_mfma_f32_16x16x32_bf16 a[100:103], a[196:199], v[204:207], a[100:103]
v_exp_f32 v139, v139
v_mfma_f32_16x16x32_bf16 a[100:103], a[228:231], v[220:223], a[100:103]
ds_read_b128 a[140:143], v2 offset:19456
v_cvt_pk_bf16_f32 v201, v138, v139
v_mfma_f32_16x16x32_bf16 a[36:39], a[228:231], v[212:215], a[36:39]
v_exp_f32 v152, v152
v_mfma_f32_16x16x32_bf16 a[36:39], a[196:199], v[196:199], a[36:39]
ds_read_b128 a[144:147], v2 offset:20480
v_bfe_u32 v251, v0, 2, 2
v_mfma_f32_16x16x32_bf16 a[40:43], a[200:203], v[196:199], a[40:43]
buffer_load_dwordx4 v1, s[44:47], s72 offen offset:2048 sc1 lds
v_mfma_f32_16x16x32_bf16 a[40:43], a[232:235], v[212:215], a[40:43]
v_exp_f32 v153, v153
v_mfma_f32_16x16x32_bf16 a[104:107], a[232:235], v[220:223], a[104:107]
ds_read_b128 a[148:151], v2 offset:21504
v_cvt_pk_bf16_f32 v202, v152, v153
v_mfma_f32_16x16x32_bf16 a[104:107], a[200:203], v[204:207], a[104:107]
buffer_load_dwordx4 v1, s[44:47], s72 offen offset:3072 sc1 lds
v_mfma_f32_16x16x32_bf16 a[108:111], a[204:207], v[204:207], a[108:111]
s_add_u32 s66, s58, 0
v_exp_f32 v154, v154
v_mfma_f32_16x16x32_bf16 a[108:111], a[236:239], v[220:223], a[108:111]
s_and_b32 s66, s66, 3
ds_read_b128 a[152:155], v2 offset:22528
v_lshl_add_u32 v6, v248, 3, v6
v_mfma_f32_16x16x32_bf16 a[44:47], a[236:239], v[212:215], a[44:47]
s_mul_i32 s66, s66, 4160
v_exp_f32 v155, v155
v_mfma_f32_16x16x32_bf16 a[44:47], a[204:207], v[196:199], a[44:47]
s_add_u32 s66, s66, s92
ds_read_b128 a[156:159], v2 offset:23552
v_cvt_pk_bf16_f32 v203, v154, v155
v_mfma_f32_16x16x32_bf16 a[48:51], a[208:211], v[196:199], a[48:51]
s_waitcnt lgkmcnt(8)
v_exp_f32 v140, v140
v_mfma_f32_16x16x32_bf16 a[48:51], a[240:243], v[212:215], a[48:51]
s_add_u32 m0, s66, 16672
ds_read_b128 a[192:195], v2 offset:0
v_lshl_add_u32 v6, v241, 4, v6
v_mfma_f32_16x16x32_bf16 a[112:115], a[240:243], v[220:223], a[112:115]
s_add_u32 s72, s93, 0x0
buffer_load_dwordx4 v1, s[36:39], s72 offen lds
v_mfma_f32_16x16x32_bf16 a[112:115], a[208:211], v[204:207], a[112:115]
buffer_load_dwordx4 v1, s[36:39], s72 offen offset:1024 lds
v_mfma_f32_16x16x32_bf16 a[116:119], a[212:215], v[204:207], a[116:119]
v_exp_f32 v141, v141
v_mfma_f32_16x16x32_bf16 a[116:119], a[244:247], v[220:223], a[116:119]
ds_read_b128 a[196:199], v2 offset:1024
v_lshlrev_b32 v5, 3, v251
v_mfma_f32_16x16x32_bf16 a[52:55], a[244:247], v[212:215], a[52:55]
v_exp_f32 v142, v142
v_mfma_f32_16x16x32_bf16 a[52:55], a[212:215], v[196:199], a[52:55]
ds_read_b128 a[200:203], v2 offset:2048
v_lshrrev_b32 v5, v5, v252
v_mfma_f32_16x16x32_bf16 a[56:59], a[216:219], v[196:199], a[56:59]
buffer_load_dwordx4 v1, s[36:39], s72 offen offset:2048 lds
v_mfma_f32_16x16x32_bf16 a[56:59], a[248:251], v[212:215], a[56:59]
v_exp_f32 v143, v143
v_mfma_f32_16x16x32_bf16 a[120:123], a[248:251], v[220:223], a[120:123]
ds_read_b128 a[204:207], v2 offset:3072
v_and_b32 v5, 3, v5
v_mfma_f32_16x16x32_bf16 a[120:123], a[216:219], v[204:207], a[120:123]
v_exp_f32 v156, v156
v_mfma_f32_16x16x32_bf16 a[124:127], a[220:223], v[204:207], a[124:127]
ds_read_b128 a[208:211], v2 offset:4096
v_cmp_ne_u32 vcc, 1, v251
v_mfma_f32_16x16x32_bf16 a[124:127], a[252:255], v[220:223], a[124:127]
buffer_load_dwordx4 v1, s[36:39], s72 offen offset:3072 lds
v_mfma_f32_16x16x32_bf16 a[60:63], a[252:255], v[212:215], a[60:63]
s_add_u32 s66, s58, 2
v_exp_f32 v157, v157
v_mfma_f32_16x16x32_bf16 a[60:63], a[220:223], v[196:199], a[60:63]
s_and_b32 s66, s66, 3
ds_read_b128 a[212:215], v2 offset:5120
v_cvt_pk_bf16_f32 v204, v140, v141
s_cmp_eq_u32 s58, 2
s_cbranch_scc1 Lta46
s_cmp_eq_u32 s58, 3
s_cbranch_scc1 Lnt47
v_mfma_f32_16x16x32_bf16 v[168:171], a[160:163], v[48:51], v[112:115]
s_mul_i32 s66, s66, 4160
v_exp_f32 v158, v158
v_mfma_f32_16x16x32_bf16 v[184:187], a[176:179], v[48:51], v[112:115]
s_add_u32 s66, s66, s92
ds_read_b128 a[216:219], v2 offset:6144
v_cvt_pk_bf16_f32 v205, v142, v143
s_branch Ljoin48
Lta46:
v_mfma_f32_16x16x32_bf16 v[168:171], a[160:163], v[48:51], v[104:107]
s_mul_i32 s66, s66, 4160
v_exp_f32 v158, v158
v_mfma_f32_16x16x32_bf16 v[184:187], a[176:179], v[48:51], v[112:115]
s_add_u32 s66, s66, s92
ds_read_b128 a[216:219], v2 offset:6144
v_cvt_pk_bf16_f32 v205, v142, v143
s_branch Ljoin48
Lnt47:
v_mfma_f32_16x16x32_bf16 v[168:171], a[160:163], v[48:51], v[88:91]
s_mul_i32 s66, s66, 4160
v_exp_f32 v158, v158
v_mfma_f32_16x16x32_bf16 v[184:187], a[176:179], v[48:51], v[104:107]
s_add_u32 s66, s66, s92
ds_read_b128 a[216:219], v2 offset:6144
v_cvt_pk_bf16_f32 v205, v142, v143
Ljoin48:
v_mfma_f32_16x16x32_bf16 v[172:175], a[160:163], v[64:67], v[92:95]
s_add_u32 m0, s66, 33312
v_exp_f32 v159, v159
v_mfma_f32_16x16x32_bf16 v[172:175], a[164:167], v[68:71], v[172:175]
s_add_u32 s72, s93, 0x4
buffer_load_dwordx4 v1, s[36:39], s72 offen lds
v_mfma_f32_16x16x32_bf16 v[172:175], a[168:171], v[72:75], v[172:175]
ds_read_b128 a[220:223], v2 offset:7168
v_cvt_pk_bf16_f32 v206, v156, v157
v_mfma_f32_16x16x32_bf16 v[172:175], a[172:175], v[76:79], v[172:175]
buffer_load_dwordx4 v1, s[36:39], s72 offen offset:1024 lds
v_mfma_f32_16x16x32_bf16 v[188:191], a[188:191], v[76:79], v[92:95]
v_cvt_pk_bf16_f32 v207, v158, v159
v_mul_u32_u24 v5, 16640, v5
v_mfma_f32_16x16x32_bf16 v[188:191], a[184:187], v[72:75], v[188:191]
v_add_u32 v5, s92, v5
v_cndmask_b32 v5, v250, v5, vcc
v_mfma_f32_16x16x32_bf16 v[188:191], a[180:183], v[68:71], v[188:191]
v_add_u32 v253, s58, v251
v_and_b32 v253, 3, v253
v_mfma_f32_16x16x32_bf16 v[188:191], a[176:179], v[64:67], v[188:191]
v_mul_u32_u24 v253, 4160, v253
v_add_u32 v5, v5, v253
v_mfma_f32_16x16x32_bf16 v[168:171], a[164:167], v[52:55], v[168:171]
s_add_u32 s73, s62, 480
v_lshlrev_b32 v248, 5, v240
v_sub_u32 v248, s73, v248
v_mfma_f32_16x16x32_bf16 v[168:171], a[168:171], v[56:59], v[168:171]
v_lshl_add_u32 v7, v241, 4, v248
v_mfma_f32_16x16x32_bf16 v[168:171], a[172:175], v[60:63], v[168:171]
s_and_b32 s73, s58, 1
v_mfma_f32_16x16x32_bf16 v[184:187], a[188:191], v[60:63], v[184:187]
s_lshl_b32 s73, s73, 4
v_mfma_f32_16x16x32_bf16 v[184:187], a[184:187], v[56:59], v[184:187]
s_lshr_b32 s73, s90, s73
v_mfma_f32_16x16x32_bf16 v[184:187], a[180:183], v[52:55], v[184:187]
s_waitcnt lgkmcnt(4)
s_and_b32 s73, s73, 0xffff
v_lshl_add_u32 v248, v241, 3, v240
v_sub_u32 v248, 15, v248
v_and_b32 v249, 1, v248
v_lshlrev_b32 v249, 4, v249
v_lshlrev_b32 v249, v249, s73
v_lshrrev_b32 v248, 1, v248
v_and_b32 v241, 3, v0
v_cmp_eq_u32 vcc, 0, v248
v_lshl_add_u32 v5, v241, 3, v5
s_nop 0
v_cndmask_b32 v8, 0, v249, vcc
v_cmp_eq_u32 vcc, 1, v248
v_lshlrev_b32 v240, 4, v251
s_nop 0
v_cndmask_b32 v9, 0, v249, vcc
v_cmp_eq_u32 vcc, 2, v248
v_sub_u32 v240, 48, v240
v_lshlrev_b64 v[12:13], 16, s[88:89]
v_cndmask_b32 v10, 0, v249, vcc
v_cmp_eq_u32 vcc, 3, v248
v_lshlrev_b64 v[12:13], v240, v[12:13]
s_nop 0
v_cndmask_b32 v11, 0, v249, vcc
v_cmp_eq_u32 vcc, 3, v241
s_add_u32 s73, s62, 4096
v_lshl_add_u32 v14, v0, 3, s73
v_cndmask_b32 v12, 0, v12, vcc
v_cndmask_b32 v13, 0, v13, vcc
v_lshrrev_b32 v15, 4, v0
v_lshlrev_b32 v15, 1, v15
v_and_b32 v240, 7, v0
v_xor_b32 v15, v15, v240
v_lshlrev_b32 v15, 4, v15
v_lshrrev_b32 v240, 3, v0
v_lshl_add_u32 v15, v240, 11, v15
s_lshr_b32 s75, s59, 1
s_and_b32 s75, s75, 8
s_add_u32 s75, s75, s60
s_lshl_b32 s76, s65, 2
s_lshr_b32 s80, s59, 2
s_and_b32 s80, s80, 3
s_add_u32 s76, s76, s80
s_lshl_b32 s94, s58, 16
s_lshl_b32 s80, s76, 7
s_add_u32 s94, s94, s80
s_lshl_b32 s80, s75, 18
s_add_u32 s80, s80, s94
v_rcp_f32 v224, v224
v_rcp_f32 v228, v228
s_lshl_b32 s73, s59, 12
s_add_u32 s73, s73, 0x2000000
s_lshl_b32 s70, s67, 2
s_add_u32 s70, s70, s73
v_mov_b32 v225, v224
v_accvgpr_read_b32 v240, a0
v_accvgpr_read_b32 v241, a1
v_accvgpr_read_b32 v242, a2
v_accvgpr_read_b32 v243, a3
v_accvgpr_read_b32 v244, a4
v_accvgpr_read_b32 v245, a5
v_accvgpr_read_b32 v246, a6
v_accvgpr_read_b32 v247, a7
v_pk_mul_f32 v[240:241], v[240:241], v[224:225]
v_pk_mul_f32 v[242:243], v[242:243], v[224:225]
v_pk_mul_f32 v[244:245], v[244:245], v[224:225]
v_pk_mul_f32 v[246:247], v[246:247], v[224:225]
buffer_load_dwordx4 v1, s[36:39], s72 offen offset:2048 lds
v_cvt_pk_bf16_f32 v128, v240, v241
v_cvt_pk_bf16_f32 v129, v242, v243
v_cvt_pk_bf16_f32 v130, v244, v245
v_cvt_pk_bf16_f32 v131, v246, v247
v_accvgpr_read_b32 v248, a8
v_accvgpr_read_b32 v249, a9
v_accvgpr_read_b32 v250, a10
v_accvgpr_read_b32 v251, a11
v_accvgpr_read_b32 v252, a12
v_accvgpr_read_b32 v253, a13
v_accvgpr_read_b32 v254, a14
v_accvgpr_read_b32 v255, a15
v_pk_mul_f32 v[248:249], v[248:249], v[224:225]
v_pk_mul_f32 v[250:251], v[250:251], v[224:225]
v_pk_mul_f32 v[252:253], v[252:253], v[224:225]
v_pk_mul_f32 v[254:255], v[254:255], v[224:225]
v_cvt_pk_bf16_f32 v144, v248, v249
v_cvt_pk_bf16_f32 v145, v250, v251
buffer_load_dwordx4 v1, s[36:39], s72 offen offset:3072 lds
v_cvt_pk_bf16_f32 v146, v252, v253
v_cvt_pk_bf16_f32 v147, v254, v255
v_accvgpr_read_b32 v240, a16
v_accvgpr_read_b32 v241, a17
v_accvgpr_read_b32 v242, a18
v_accvgpr_read_b32 v243, a19
v_accvgpr_read_b32 v244, a20
v_accvgpr_read_b32 v245, a21
v_accvgpr_read_b32 v246, a22
v_accvgpr_read_b32 v247, a23
v_pk_mul_f32 v[240:241], v[240:241], v[224:225]
v_pk_mul_f32 v[242:243], v[242:243], v[224:225]
v_pk_mul_f32 v[244:245], v[244:245], v[224:225]
v_pk_mul_f32 v[246:247], v[246:247], v[224:225]
v_cvt_pk_bf16_f32 v160, v240, v241
v_cvt_pk_bf16_f32 v161, v242, v243
v_cvt_pk_bf16_f32 v162, v244, v245
v_cvt_pk_bf16_f32 v163, v246, v247
buffer_load_dwordx4 v[80:83], v15, s[4:7], s80 offen
v_accvgpr_read_b32 v248, a24
v_accvgpr_read_b32 v249, a25
v_accvgpr_read_b32 v250, a26
v_accvgpr_read_b32 v251, a27
v_accvgpr_read_b32 v252, a28
v_accvgpr_read_b32 v253, a29
v_accvgpr_read_b32 v254, a30
v_accvgpr_read_b32 v255, a31
v_pk_mul_f32 v[248:249], v[248:249], v[224:225]
v_pk_mul_f32 v[250:251], v[250:251], v[224:225]
v_pk_mul_f32 v[252:253], v[252:253], v[224:225]
v_pk_mul_f32 v[254:255], v[254:255], v[224:225]
v_cvt_pk_bf16_f32 v176, v248, v249
v_cvt_pk_bf16_f32 v177, v250, v251
v_cvt_pk_bf16_f32 v178, v252, v253
v_cvt_pk_bf16_f32 v179, v254, v255
v_mov_b32 v229, v228
v_accvgpr_read_b32 v240, a32
s_add_u32 s80, s80, 0x4000
buffer_load_dwordx4 v[84:87], v15, s[4:7], s80 offen
v_accvgpr_read_b32 v241, a33
v_accvgpr_read_b32 v242, a34
v_accvgpr_read_b32 v243, a35
v_accvgpr_read_b32 v244, a36
v_accvgpr_read_b32 v245, a37
v_accvgpr_read_b32 v246, a38
v_accvgpr_read_b32 v247, a39
v_pk_mul_f32 v[240:241], v[240:241], v[228:229]
v_pk_mul_f32 v[242:243], v[242:243], v[228:229]
v_pk_mul_f32 v[244:245], v[244:245], v[228:229]
v_pk_mul_f32 v[246:247], v[246:247], v[228:229]
v_cvt_pk_bf16_f32 v132, v240, v241
v_cvt_pk_bf16_f32 v133, v242, v243
v_cvt_pk_bf16_f32 v134, v244, v245
v_cvt_pk_bf16_f32 v135, v246, v247
v_accvgpr_read_b32 v248, a40
v_accvgpr_read_b32 v249, a41
v_accvgpr_read_b32 v250, a42
s_add_u32 s80, s80, 0x4000
buffer_load_dwordx4 v[96:99], v15, s[4:7], s80 offen
v_accvgpr_read_b32 v251, a43
v_accvgpr_read_b32 v252, a44
v_accvgpr_read_b32 v253, a45
v_accvgpr_read_b32 v254, a46
v_accvgpr_read_b32 v255, a47
v_pk_mul_f32 v[248:249], v[248:249], v[228:229]
v_pk_mul_f32 v[250:251], v[250:251], v[228:229]
v_pk_mul_f32 v[252:253], v[252:253], v[228:229]
v_pk_mul_f32 v[254:255], v[254:255], v[228:229]
v_cvt_pk_bf16_f32 v148, v248, v249
v_cvt_pk_bf16_f32 v149, v250, v251
v_cvt_pk_bf16_f32 v150, v252, v253
v_cvt_pk_bf16_f32 v151, v254, v255
v_accvgpr_read_b32 v240, a48
v_accvgpr_read_b32 v241, a49
v_accvgpr_read_b32 v242, a50
v_accvgpr_read_b32 v243, a51
v_accvgpr_read_b32 v244, a52
s_add_u32 s80, s80, 0x4000
buffer_load_dwordx4 v[100:103], v15, s[4:7], s80 offen
v_accvgpr_read_b32 v245, a53
v_accvgpr_read_b32 v246, a54
v_accvgpr_read_b32 v247, a55
v_pk_mul_f32 v[240:241], v[240:241], v[228:229]
v_pk_mul_f32 v[242:243], v[242:243], v[228:229]
v_pk_mul_f32 v[244:245], v[244:245], v[228:229]
v_pk_mul_f32 v[246:247], v[246:247], v[228:229]
v_cvt_pk_bf16_f32 v164, v240, v241
v_cvt_pk_bf16_f32 v165, v242, v243
v_cvt_pk_bf16_f32 v166, v244, v245
v_cvt_pk_bf16_f32 v167, v246, v247
v_accvgpr_read_b32 v248, a56
v_accvgpr_read_b32 v249, a57
v_accvgpr_read_b32 v250, a58
v_accvgpr_read_b32 v251, a59
v_accvgpr_read_b32 v252, a60
v_accvgpr_read_b32 v253, a61
v_accvgpr_read_b32 v254, a62
v_accvgpr_read_b32 v255, a63
v_pk_mul_f32 v[248:249], v[248:249], v[228:229]
v_pk_mul_f32 v[250:251], v[250:251], v[228:229]
v_pk_mul_f32 v[252:253], v[252:253], v[228:229]
v_pk_mul_f32 v[254:255], v[254:255], v[228:229]
v_cvt_pk_bf16_f32 v180, v248, v249
v_cvt_pk_bf16_f32 v181, v250, v251
v_cvt_pk_bf16_f32 v182, v252, v253
v_cvt_pk_bf16_f32 v183, v254, v255
v_mfma_f32_16x16x32_bf16 v[232:235], v[120:123], v[216:219], v[232:235]
s_add_u32 s82, s82, 0x8000
ds_read_b128 a[160:163], v2 offset:24576
ds_read_b128 a[164:167], v2 offset:25600
v_mfma_f32_16x16x32_bf16 v[232:235], v[120:123], v[200:203], v[232:235]
s_and_b32 s82, s82, 0x1ffff
v_exp_f32 v172, v172
v_mfma_f32_16x16x32_bf16 a[64:67], a[224:227], v[216:219], a[64:67]
v_exp_f32 v173, v173
v_mfma_f32_16x16x32_bf16 a[64:67], a[192:195], v[200:203], a[64:67]
s_nop 0
ds_read_b128 a[168:171], v2 offset:26624
ds_read_b128 a[172:175], v2 offset:27648
v_mfma_f32_16x16x32_bf16 a[68:71], a[196:199], v[200:203], a[68:71]
v_exp_f32 v174, v174
v_mfma_f32_16x16x32_bf16 a[68:71], a[228:231], v[216:219], a[68:71]
v_exp_f32 v175, v175
v_mfma_f32_16x16x32_bf16 a[72:75], a[232:235], v[216:219], a[72:75]
buffer_store_dwordx4 v[128:131], v1, s[44:47], s70 offen sc1
v_mfma_f32_16x16x32_bf16 a[72:75], a[200:203], v[200:203], a[72:75]
s_nop 0
ds_read_b128 a[176:179], v2 offset:28672
ds_read_b128 a[180:183], v2 offset:29696
v_mfma_f32_16x16x32_bf16 a[76:79], a[204:207], v[200:203], a[76:79]
v_exp_f32 v188, v188
v_mfma_f32_16x16x32_bf16 a[76:79], a[236:239], v[216:219], a[76:79]
s_nop 0
ds_read_b128 a[184:187], v2 offset:30720
ds_read_b128 a[188:191], v2 offset:31744
v_mfma_f32_16x16x32_bf16 a[80:83], a[240:243], v[216:219], a[80:83]
s_waitcnt lgkmcnt(8)
ds_read_b128 a[224:227], v2 offset:8192
ds_read_b128 a[228:231], v2 offset:9216
v_mfma_f32_16x16x32_bf16 a[80:83], a[208:211], v[200:203], a[80:83]
s_nop 0
ds_read_b128 a[232:235], v2 offset:10240
ds_read_b128 a[236:239], v2 offset:11264
v_mfma_f32_16x16x32_bf16 a[84:87], a[212:215], v[200:203], a[84:87]
ds_read_b128 a[240:243], v2 offset:12288
v_cvt_pk_bf16_f32 v220, v172, v173
v_mfma_f32_16x16x32_bf16 a[84:87], a[244:247], v[216:219], a[84:87]
v_exp_f32 v189, v189
v_mfma_f32_16x16x32_bf16 a[88:91], a[248:251], v[216:219], a[88:91]
v_exp_f32 v190, v190
v_mfma_f32_16x16x32_bf16 a[88:91], a[216:219], v[200:203], a[88:91]
s_nop 0
ds_read_b128 a[244:247], v2 offset:13312
ds_read_b128 a[248:251], v2 offset:14336
v_mfma_f32_16x16x32_bf16 a[92:95], a[220:223], v[200:203], a[92:95]
v_cvt_pk_bf16_f32 v221, v174, v175
v_cvt_pk_bf16_f32 v222, v188, v189
v_mfma_f32_16x16x32_bf16 a[92:95], a[252:255], v[216:219], a[92:95]
v_exp_f32 v191, v191
s_cmp_eq_u32 s58, 0
s_cbranch_scc1 Lta49
s_cmp_eq_u32 s58, 1
s_cbranch_scc1 Lnt50
v_mfma_f32_16x16x32_bf16 v[140:143], a[128:131], v[64:67], v[92:95]
v_exp_f32 v168, v168
v_mfma_f32_16x16x32_bf16 v[156:159], a[144:147], v[64:67], v[92:95]
buffer_store_dwordx4 v[144:147], v1, s[44:47], s70 offen offset:1024 sc1
s_branch Ljoin51
Lta49:
v_mfma_f32_16x16x32_bf16 v[140:143], a[128:131], v[64:67], v[108:111]
v_exp_f32 v168, v168
v_mfma_f32_16x16x32_bf16 v[156:159], a[144:147], v[64:67], v[112:115]
buffer_store_dwordx4 v[144:147], v1, s[44:47], s70 offen offset:1024 sc1
s_branch Ljoin51
Lnt50:
v_mfma_f32_16x16x32_bf16 v[140:143], a[128:131], v[64:67], v[92:95]
v_exp_f32 v168, v168
v_mfma_f32_16x16x32_bf16 v[156:159], a[144:147], v[64:67], v[108:111]
buffer_store_dwordx4 v[144:147], v1, s[44:47], s70 offen offset:1024 sc1
Ljoin51:
v_mfma_f32_16x16x32_bf16 v[140:143], a[132:135], v[68:71], v[140:143]
v_exp_f32 v169, v169
v_mfma_f32_16x16x32_bf16 v[140:143], a[136:139], v[72:75], v[140:143]
v_exp_f32 v170, v170
v_mfma_f32_16x16x32_bf16 v[140:143], a[140:143], v[76:79], v[140:143]
buffer_store_dwordx4 v[160:163], v1, s[44:47], s70 offen offset:2048 sc1
v_mfma_f32_16x16x32_bf16 v[156:159], a[156:159], v[76:79], v[156:159]
ds_read_b128 a[252:255], v2 offset:15360
v_cvt_pk_bf16_f32 v223, v190, v191
v_mfma_f32_16x16x32_bf16 v[156:159], a[152:155], v[72:75], v[156:159]
s_waitcnt vmcnt(24) lgkmcnt(4)
v_exp_f32 v171, v171
v_mfma_f32_16x16x32_bf16 v[156:159], a[148:151], v[68:71], v[156:159]
s_barrier
v_exp_f32 v184, v184
v_add_u32 v2, s82, v1
v_cvt_pk_bf16_f32 v216, v168, v169
v_cvt_pk_bf16_f32 v217, v170, v171
v_exp_f32 v185, v185
v_exp_f32 v186, v186
v_cvt_pk_bf16_f32 v218, v184, v185
v_exp_f32 v187, v187
s_nop 0
v_cvt_pk_bf16_f32 v219, v186, v187
v_mfma_f32_16x16x32_bf16 v[236:239], v[120:123], v[204:207], v[236:239]
s_add_u32 s78, s59, 4
v_exp_f32 v140, v140
v_mfma_f32_16x16x32_bf16 v[236:239], v[120:123], v[220:223], v[236:239]
s_and_b32 s78, s78, 12
v_exp_f32 v141, v141
v_mfma_f32_16x16x32_bf16 a[96:99], a[192:195], v[204:207], a[96:99]
s_and_b32 s12, s59, 16
ds_read_b128 a[192:195], v2 offset:0
v_mfma_f32_16x16x32_bf16 a[96:99], a[224:227], v[220:223], a[96:99]
s_or_b32 s78, s78, s12
buffer_store_dwordx4 v[176:179], v1, s[44:47], s70 offen offset:3072 sc1
v_mfma_f32_16x16x32_bf16 a[100:103], a[228:231], v[220:223], a[100:103]
s_add_u32 s70, s70, 0x80000
v_exp_f32 v142, v142
v_mfma_f32_16x16x32_bf16 a[100:103], a[196:199], v[204:207], a[100:103]
s_add_u32 s12, s61, 0
ds_read_b128 a[196:199], v2 offset:1024
v_mfma_f32_16x16x32_bf16 a[104:107], a[200:203], v[204:207], a[104:107]
s_and_b32 s12, s12, 3
ds_read_b128 a[200:203], v2 offset:2048
v_mfma_f32_16x16x32_bf16 a[104:107], a[232:235], v[220:223], a[104:107]
s_add_u32 s12, s12, s78
v_exp_f32 v143, v143
v_mfma_f32_16x16x32_bf16 a[108:111], a[236:239], v[220:223], a[108:111]
s_lshl_b32 s12, s12, 18
v_exp_f32 v156, v156
v_mfma_f32_16x16x32_bf16 a[108:111], a[204:207], v[204:207], a[108:111]
s_add_u32 s12, s12, s94
ds_read_b128 a[204:207], v2 offset:3072
v_mfma_f32_16x16x32_bf16 a[112:115], a[208:211], v[204:207], a[112:115]
s_waitcnt lgkmcnt(4)
ds_read_b128 a[208:211], v2 offset:4096
v_mfma_f32_16x16x32_bf16 a[112:115], a[240:243], v[220:223], a[112:115]
s_add_u32 s13, s61, 1
buffer_store_dwordx4 v[132:135], v1, s[44:47], s70 offen sc1
v_mfma_f32_16x16x32_bf16 a[116:119], a[244:247], v[220:223], a[116:119]
s_and_b32 s13, s13, 3
v_exp_f32 v157, v157
v_mfma_f32_16x16x32_bf16 a[116:119], a[212:215], v[204:207], a[116:119]
s_add_u32 s13, s13, s78
ds_read_b128 a[212:215], v2 offset:5120
v_mfma_f32_16x16x32_bf16 a[120:123], a[216:219], v[204:207], a[120:123]
s_lshl_b32 s13, s13, 18
v_exp_f32 v158, v158
v_mfma_f32_16x16x32_bf16 a[120:123], a[248:251], v[220:223], a[120:123]
s_add_u32 s13, s13, s94
ds_read_b128 a[216:219], v2 offset:6144
v_mfma_f32_16x16x32_bf16 a[124:127], a[252:255], v[220:223], a[124:127]
s_add_u32 s14, s61, 2
buffer_store_dwordx4 v[148:151], v1, s[44:47], s70 offen offset:1024 sc1
v_mfma_f32_16x16x32_bf16 a[124:127], a[220:223], v[204:207], a[124:127]
s_and_b32 s14, s14, 3
ds_read_b128 a[220:223], v2 offset:7168
v_cvt_pk_bf16_f32 v204, v140, v141
s_cmp_eq_u32 s58, 2
s_cbranch_scc1 Lta52
s_cmp_eq_u32 s58, 3
s_cbranch_scc1 Lnt53
v_mfma_f32_16x16x32_bf16 v[172:175], a[160:163], v[64:67], v[112:115]
s_add_u32 s14, s14, s78
v_cvt_pk_bf16_f32 v205, v142, v143
v_cvt_pk_bf16_f32 v206, v156, v157
v_mfma_f32_16x16x32_bf16 v[188:191], a[176:179], v[64:67], v[112:115]
s_lshl_b32 s14, s14, 18
v_exp_f32 v159, v159
s_branch Ljoin54
Lta52:
v_mfma_f32_16x16x32_bf16 v[172:175], a[160:163], v[64:67], v[108:111]
s_add_u32 s14, s14, s78
v_cvt_pk_bf16_f32 v205, v142, v143
v_cvt_pk_bf16_f32 v206, v156, v157
v_mfma_f32_16x16x32_bf16 v[188:191], a[176:179], v[64:67], v[112:115]
s_lshl_b32 s14, s14, 18
v_exp_f32 v159, v159
s_branch Ljoin54
Lnt53:
v_mfma_f32_16x16x32_bf16 v[172:175], a[160:163], v[64:67], v[92:95]
s_add_u32 s14, s14, s78
v_cvt_pk_bf16_f32 v205, v142, v143
v_cvt_pk_bf16_f32 v206, v156, v157
v_mfma_f32_16x16x32_bf16 v[188:191], a[176:179], v[64:67], v[108:111]
s_lshl_b32 s14, s14, 18
v_exp_f32 v159, v159
Ljoin54:
v_mfma_f32_16x16x32_bf16 v[172:175], a[164:167], v[68:71], v[172:175]
s_add_u32 s14, s14, s94
v_cvt_pk_bf16_f32 v207, v158, v159
v_mfma_f32_16x16x32_bf16 v[172:175], a[168:171], v[72:75], v[172:175]
s_add_u32 s15, s61, 3
v_mfma_f32_16x16x32_bf16 v[172:175], a[172:175], v[76:79], v[172:175]
s_and_b32 s15, s15, 3
v_mfma_f32_16x16x32_bf16 v[188:191], a[188:191], v[76:79], v[188:191]
s_add_u32 s15, s15, s78
v_mfma_f32_16x16x32_bf16 v[188:191], a[184:187], v[72:75], v[188:191]
s_lshl_b32 s15, s15, 18
v_mfma_f32_16x16x32_bf16 v[188:191], a[180:183], v[68:71], v[188:191]
s_waitcnt lgkmcnt(4)
s_add_u32 s15, s15, s94
v_mfma_f32_16x16x32_bf16 v[232:235], v[120:123], v[216:219], v[232:235]
s_add_u32 s82, s82, 0x8000
v_exp_f32 v172, v172
v_mfma_f32_16x16x32_bf16 a[64:67], a[224:227], v[216:219], a[64:67]
s_and_b32 s82, s82, 0x1ffff
ds_read_b128 a[224:227], v2 offset:8192
v_mfma_f32_16x16x32_bf16 a[68:71], a[228:231], v[216:219], a[68:71]
ds_read_b128 a[228:231], v2 offset:9216
v_mfma_f32_16x16x32_bf16 a[72:75], a[232:235], v[216:219], a[72:75]
ds_read_b128 a[232:235], v2 offset:10240
v_mfma_f32_16x16x32_bf16 a[76:79], a[236:239], v[216:219], a[76:79]
buffer_store_dwordx4 v[164:167], v1, s[44:47], s70 offen offset:2048 sc1
v_mfma_f32_16x16x32_bf16 a[80:83], a[240:243], v[216:219], a[80:83]
s_nop 0
ds_read_b128 a[236:239], v2 offset:11264
ds_read_b128 a[240:243], v2 offset:12288
v_mfma_f32_16x16x32_bf16 a[84:87], a[244:247], v[216:219], a[84:87]
ds_read_b128 a[244:247], v2 offset:13312
v_mfma_f32_16x16x32_bf16 a[88:91], a[248:251], v[216:219], a[88:91]
v_exp_f32 v173, v173
v_mfma_f32_16x16x32_bf16 a[92:95], a[252:255], v[216:219], a[92:95]
v_exp_f32 v174, v174
ds_read_b128 a[248:251], v2 offset:14336
ds_read_b128 a[252:255], v2 offset:15360
v_add_u32 v2, s82, v1
buffer_store_dwordx4 v[180:183], v1, s[44:47], s70 offen offset:3072 sc1
v_cvt_pk_bf16_f32 v220, v172, v173
v_exp_f32 v175, v175
v_exp_f32 v188, v188
v_cvt_pk_bf16_f32 v221, v174, v175
v_exp_f32 v189, v189
v_exp_f32 v190, v190
v_cvt_pk_bf16_f32 v222, v188, v189
v_exp_f32 v191, v191
s_nop 0
v_cvt_pk_bf16_f32 v223, v190, v191
s_waitcnt vmcnt(8) lgkmcnt(0)
s_barrier
s_branch LHT4
Lslow:
s_waitcnt vmcnt(0) lgkmcnt(0)
s_barrier
s_mov_b32 s86, 1
s_lshl_b32 s81, s59, 20
s_add_u32 s81, s81, s64
s_sub_u32 s81, s81, 0x4000
s_mov_b32 s83, 0
s_lshl_b32 s75, s60, 3
s_sub_u32 s76, 128, s75
s_add_u32 s74, s75, s58
s_sub_u32 s75, s76, 8
s_add_u32 s75, s75, s58
v_mov_b32 v2, v1
v_lshrrev_b32 v240, 4, v0
v_and_b32 v241, 15, v0
v_lshlrev_b32 v240, 2, v240
v_sub_u32 v240, v241, v240
v_mov_b32 v112, 0xff800000
v_mov_b32 v113, 0xff800000
v_mov_b32 v114, 0xff800000
v_mov_b32 v115, 0xff800000
v_cmp_gt_i32 vcc, 0, v240
v_mov_b32 v120, 0x3f803f80
s_nop 0
v_cndmask_b32 v116, 0, v112, vcc
v_cmp_gt_i32 vcc, 1, v240
v_mov_b32 v121, 0x3f803f80
s_nop 0
v_cndmask_b32 v117, 0, v112, vcc
v_cmp_gt_i32 vcc, 2, v240
v_mov_b32 v122, 0x3f803f80
s_nop 0
v_cndmask_b32 v118, 0, v112, vcc
v_cmp_gt_i32 vcc, 3, v240
v_mov_b32 v123, 0x3f803f80
s_nop 0
v_cndmask_b32 v119, 0, v112, vcc
Lslow1:
s_add_u32 m0, s64, 16384
s_add_u32 s72, s81, 16384
buffer_load_dwordx4 v1, s[44:47], s72 offen sc1 lds
buffer_load_dwordx4 v1, s[44:47], s72 offen offset:1024 sc1 lds
buffer_load_dwordx4 v1, s[44:47], s72 offen offset:2048 sc1 lds
buffer_load_dwordx4 v1, s[44:47], s72 offen offset:3072 sc1 lds
s_add_u32 s81, s81, 0x8000
s_waitcnt vmcnt(0)
s_barrier
ds_read_b128 a[128:131], v2 offset:16384
ds_read_b128 a[132:135], v2 offset:17408
ds_read_b128 a[136:139], v2 offset:18432
ds_read_b128 a[140:143], v2 offset:19456
ds_read_b128 a[144:147], v2 offset:20480
ds_read_b128 a[148:151], v2 offset:21504
ds_read_b128 a[152:155], v2 offset:22528
ds_read_b128 a[156:159], v2 offset:23552
s_waitcnt lgkmcnt(0)
s_add_u32 s73, s74, 0
s_cmp_lt_u32 s73, s83
s_cbranch_scc1 Lsa55
s_cmp_eq_u32 s73, s83
s_cbranch_scc1 Lst56
v_mfma_f32_16x16x32_bf16 v[128:131], a[128:131], v[16:19], 0
s_branch Lsj57
Lst56:
v_mfma_f32_16x16x32_bf16 v[128:131], a[128:131], v[16:19], v[116:119]
Lsj57:
v_mfma_f32_16x16x32_bf16 v[128:131], a[132:135], v[20:23], v[128:131]
v_mfma_f32_16x16x32_bf16 v[128:131], a[136:139], v[24:27], v[128:131]
v_mfma_f32_16x16x32_bf16 v[128:131], a[140:143], v[28:31], v[128:131]
s_nop 7
v_max3_f32 v124, v124, v128, v129
v_max3_f32 v124, v124, v130, v131
Lsa55:
s_add_u32 s73, s74, 4
s_cmp_lt_u32 s73, s83
s_cbranch_scc1 Lsa58
s_cmp_eq_u32 s73, s83
s_cbranch_scc1 Lst59
v_mfma_f32_16x16x32_bf16 v[132:135], a[128:131], v[32:35], 0
s_branch Lsj60
Lst59:
v_mfma_f32_16x16x32_bf16 v[132:135], a[128:131], v[32:35], v[116:119]
Lsj60:
v_mfma_f32_16x16x32_bf16 v[132:135], a[132:135], v[36:39], v[132:135]
v_mfma_f32_16x16x32_bf16 v[132:135], a[136:139], v[40:43], v[132:135]
v_mfma_f32_16x16x32_bf16 v[132:135], a[140:143], v[44:47], v[132:135]
s_nop 7
v_max3_f32 v125, v125, v132, v133
v_max3_f32 v125, v125, v134, v135
Lsa58:
s_add_u32 s73, s75, 0
s_cmp_lt_u32 s73, s83
s_cbranch_scc1 Lsa61
s_cmp_eq_u32 s73, s83
s_cbranch_scc1 Lst62
v_mfma_f32_16x16x32_bf16 v[136:139], a[128:131], v[48:51], 0
s_branch Lsj63
Lst62:
v_mfma_f32_16x16x32_bf16 v[136:139], a[128:131], v[48:51], v[116:119]
Lsj63:
v_mfma_f32_16x16x32_bf16 v[136:139], a[132:135], v[52:55], v[136:139]
v_mfma_f32_16x16x32_bf16 v[136:139], a[136:139], v[56:59], v[136:139]
v_mfma_f32_16x16x32_bf16 v[136:139], a[140:143], v[60:63], v[136:139]
s_nop 7
v_max3_f32 v126, v126, v136, v137
v_max3_f32 v126, v126, v138, v139
Lsa61:
s_add_u32 s73, s75, 4
s_cmp_lt_u32 s73, s83
s_cbranch_scc1 Lsa64
s_cmp_eq_u32 s73, s83
s_cbranch_scc1 Lst65
v_mfma_f32_16x16x32_bf16 v[140:143], a[128:131], v[64:67], 0
s_branch Lsj66
Lst65:
v_mfma_f32_16x16x32_bf16 v[140:143], a[128:131], v[64:67], v[116:119]
Lsj66:
v_mfma_f32_16x16x32_bf16 v[140:143], a[132:135], v[68:71], v[140:143]
v_mfma_f32_16x16x32_bf16 v[140:143], a[136:139], v[72:75], v[140:143]
v_mfma_f32_16x16x32_bf16 v[140:143], a[140:143], v[76:79], v[140:143]
s_nop 7
v_max3_f32 v127, v127, v140, v141
v_max3_f32 v127, v127, v142, v143
Lsa64:
s_add_u32 s83, s83, 1
s_add_u32 s73, s74, 0
s_cmp_lt_u32 s73, s83
s_cbranch_scc1 Lsa67
s_cmp_eq_u32 s73, s83
s_cbranch_scc1 Lst68
v_mfma_f32_16x16x32_bf16 v[144:147], a[144:147], v[16:19], 0
s_branch Lsj69
Lst68:
v_mfma_f32_16x16x32_bf16 v[144:147], a[144:147], v[16:19], v[116:119]
Lsj69:
v_mfma_f32_16x16x32_bf16 v[144:147], a[148:151], v[20:23], v[144:147]
v_mfma_f32_16x16x32_bf16 v[144:147], a[152:155], v[24:27], v[144:147]
v_mfma_f32_16x16x32_bf16 v[144:147], a[156:159], v[28:31], v[144:147]
s_nop 7
v_max3_f32 v124, v124, v144, v145
v_max3_f32 v124, v124, v146, v147
Lsa67:
s_add_u32 s73, s74, 4
s_cmp_lt_u32 s73, s83
s_cbranch_scc1 Lsa70
s_cmp_eq_u32 s73, s83
s_cbranch_scc1 Lst71
v_mfma_f32_16x16x32_bf16 v[148:151], a[144:147], v[32:35], 0
s_branch Lsj72
Lst71:
v_mfma_f32_16x16x32_bf16 v[148:151], a[144:147], v[32:35], v[116:119]
Lsj72:
v_mfma_f32_16x16x32_bf16 v[148:151], a[148:151], v[36:39], v[148:151]
v_mfma_f32_16x16x32_bf16 v[148:151], a[152:155], v[40:43], v[148:151]
v_mfma_f32_16x16x32_bf16 v[148:151], a[156:159], v[44:47], v[148:151]
s_nop 7
v_max3_f32 v125, v125, v148, v149
v_max3_f32 v125, v125, v150, v151
Lsa70:
s_add_u32 s73, s75, 0
s_cmp_lt_u32 s73, s83
s_cbranch_scc1 Lsa73
s_cmp_eq_u32 s73, s83
s_cbranch_scc1 Lst74
v_mfma_f32_16x16x32_bf16 v[152:155], a[144:147], v[48:51], 0
s_branch Lsj75
Lst74:
v_mfma_f32_16x16x32_bf16 v[152:155], a[144:147], v[48:51], v[116:119]
Lsj75:
v_mfma_f32_16x16x32_bf16 v[152:155], a[148:151], v[52:55], v[152:155]
v_mfma_f32_16x16x32_bf16 v[152:155], a[152:155], v[56:59], v[152:155]
v_mfma_f32_16x16x32_bf16 v[152:155], a[156:159], v[60:63], v[152:155]
s_nop 7
v_max3_f32 v126, v126, v152, v153
v_max3_f32 v126, v126, v154, v155
Lsa73:
s_add_u32 s73, s75, 4
s_cmp_lt_u32 s73, s83
s_cbranch_scc1 Lsa76
s_cmp_eq_u32 s73, s83
s_cbranch_scc1 Lst77
v_mfma_f32_16x16x32_bf16 v[156:159], a[144:147], v[64:67], 0
s_branch Lsj78
Lst77:
v_mfma_f32_16x16x32_bf16 v[156:159], a[144:147], v[64:67], v[116:119]
Lsj78:
v_mfma_f32_16x16x32_bf16 v[156:159], a[148:151], v[68:71], v[156:159]
v_mfma_f32_16x16x32_bf16 v[156:159], a[152:155], v[72:75], v[156:159]
v_mfma_f32_16x16x32_bf16 v[156:159], a[156:159], v[76:79], v[156:159]
s_nop 7
v_max3_f32 v127, v127, v156, v157
v_max3_f32 v127, v127, v158, v159
Lsa76:
s_add_u32 s83, s83, 1
ds_read_b128 a[128:131], v2 offset:24576
ds_read_b128 a[132:135], v2 offset:25600
ds_read_b128 a[136:139], v2 offset:26624
ds_read_b128 a[140:143], v2 offset:27648
ds_read_b128 a[144:147], v2 offset:28672
ds_read_b128 a[148:151], v2 offset:29696
ds_read_b128 a[152:155], v2 offset:30720
ds_read_b128 a[156:159], v2 offset:31744
s_waitcnt lgkmcnt(0)
s_add_u32 s73, s74, 0
s_cmp_lt_u32 s73, s83
s_cbranch_scc1 Lsa79
s_cmp_eq_u32 s73, s83
s_cbranch_scc1 Lst80
v_mfma_f32_16x16x32_bf16 v[128:131], a[128:131], v[16:19], 0
s_branch Lsj81
Lst80:
v_mfma_f32_16x16x32_bf16 v[128:131], a[128:131], v[16:19], v[116:119]
Lsj81:
v_mfma_f32_16x16x32_bf16 v[128:131], a[132:135], v[20:23], v[128:131]
v_mfma_f32_16x16x32_bf16 v[128:131], a[136:139], v[24:27], v[128:131]
v_mfma_f32_16x16x32_bf16 v[128:131], a[140:143], v[28:31], v[128:131]
s_nop 7
v_max3_f32 v124, v124, v128, v129
v_max3_f32 v124, v124, v130, v131
Lsa79:
s_add_u32 s73, s74, 4
s_cmp_lt_u32 s73, s83
s_cbranch_scc1 Lsa82
s_cmp_eq_u32 s73, s83
s_cbranch_scc1 Lst83
v_mfma_f32_16x16x32_bf16 v[132:135], a[128:131], v[32:35], 0
s_branch Lsj84
Lst83:
v_mfma_f32_16x16x32_bf16 v[132:135], a[128:131], v[32:35], v[116:119]
Lsj84:
v_mfma_f32_16x16x32_bf16 v[132:135], a[132:135], v[36:39], v[132:135]
v_mfma_f32_16x16x32_bf16 v[132:135], a[136:139], v[40:43], v[132:135]
v_mfma_f32_16x16x32_bf16 v[132:135], a[140:143], v[44:47], v[132:135]
s_nop 7
v_max3_f32 v125, v125, v132, v133
v_max3_f32 v125, v125, v134, v135
Lsa82:
s_add_u32 s73, s75, 0
s_cmp_lt_u32 s73, s83
s_cbranch_scc1 Lsa85
s_cmp_eq_u32 s73, s83
s_cbranch_scc1 Lst86
v_mfma_f32_16x16x32_bf16 v[136:139], a[128:131], v[48:51], 0
s_branch Lsj87
Lst86:
v_mfma_f32_16x16x32_bf16 v[136:139], a[128:131], v[48:51], v[116:119]
Lsj87:
v_mfma_f32_16x16x32_bf16 v[136:139], a[132:135], v[52:55], v[136:139]
v_mfma_f32_16x16x32_bf16 v[136:139], a[136:139], v[56:59], v[136:139]
v_mfma_f32_16x16x32_bf16 v[136:139], a[140:143], v[60:63], v[136:139]
s_nop 7
v_max3_f32 v126, v126, v136, v137
v_max3_f32 v126, v126, v138, v139
Lsa85:
s_add_u32 s73, s75, 4
s_cmp_lt_u32 s73, s83
s_cbranch_scc1 Lsa88
s_cmp_eq_u32 s73, s83
s_cbranch_scc1 Lst89
v_mfma_f32_16x16x32_bf16 v[140:143], a[128:131], v[64:67], 0
s_branch Lsj90
Lst89:
v_mfma_f32_16x16x32_bf16 v[140:143], a[128:131], v[64:67], v[116:119]
Lsj90:
v_mfma_f32_16x16x32_bf16 v[140:143], a[132:135], v[68:71], v[140:143]
v_mfma_f32_16x16x32_bf16 v[140:143], a[136:139], v[72:75], v[140:143]
v_mfma_f32_16x16x32_bf16 v[140:143], a[140:143], v[76:79], v[140:143]
s_nop 7
v_max3_f32 v127, v127, v140, v141
v_max3_f32 v127, v127, v142, v143
Lsa88:
s_add_u32 s83, s83, 1
s_add_u32 s73, s74, 0
s_cmp_lt_u32 s73, s83
s_cbranch_scc1 Lsa91
s_cmp_eq_u32 s73, s83
s_cbranch_scc1 Lst92
v_mfma_f32_16x16x32_bf16 v[144:147], a[144:147], v[16:19], 0
s_branch Lsj93
Lst92:
v_mfma_f32_16x16x32_bf16 v[144:147], a[144:147], v[16:19], v[116:119]
Lsj93:
v_mfma_f32_16x16x32_bf16 v[144:147], a[148:151], v[20:23], v[144:147]
v_mfma_f32_16x16x32_bf16 v[144:147], a[152:155], v[24:27], v[144:147]
v_mfma_f32_16x16x32_bf16 v[144:147], a[156:159], v[28:31], v[144:147]
s_nop 7
v_max3_f32 v124, v124, v144, v145
v_max3_f32 v124, v124, v146, v147
Lsa91:
s_add_u32 s73, s74, 4
s_cmp_lt_u32 s73, s83
s_cbranch_scc1 Lsa94
s_cmp_eq_u32 s73, s83
s_cbranch_scc1 Lst95
v_mfma_f32_16x16x32_bf16 v[148:151], a[144:147], v[32:35], 0
s_branch Lsj96
Lst95:
v_mfma_f32_16x16x32_bf16 v[148:151], a[144:147], v[32:35], v[116:119]
Lsj96:
v_mfma_f32_16x16x32_bf16 v[148:151], a[148:151], v[36:39], v[148:151]
v_mfma_f32_16x16x32_bf16 v[148:151], a[152:155], v[40:43], v[148:151]
v_mfma_f32_16x16x32_bf16 v[148:151], a[156:159], v[44:47], v[148:151]
s_nop 7
v_max3_f32 v125, v125, v148, v149
v_max3_f32 v125, v125, v150, v151
Lsa94:
s_add_u32 s73, s75, 0
s_cmp_lt_u32 s73, s83
s_cbranch_scc1 Lsa97
s_cmp_eq_u32 s73, s83
s_cbranch_scc1 Lst98
v_mfma_f32_16x16x32_bf16 v[152:155], a[144:147], v[48:51], 0
s_branch Lsj99
Lst98:
v_mfma_f32_16x16x32_bf16 v[152:155], a[144:147], v[48:51], v[116:119]
Lsj99:
v_mfma_f32_16x16x32_bf16 v[152:155], a[148:151], v[52:55], v[152:155]
v_mfma_f32_16x16x32_bf16 v[152:155], a[152:155], v[56:59], v[152:155]
v_mfma_f32_16x16x32_bf16 v[152:155], a[156:159], v[60:63], v[152:155]
s_nop 7
v_max3_f32 v126, v126, v152, v153
v_max3_f32 v126, v126, v154, v155
Lsa97:
s_add_u32 s73, s75, 4
s_cmp_lt_u32 s73, s83
s_cbranch_scc1 Lsa100
s_cmp_eq_u32 s73, s83
s_cbranch_scc1 Lst101
v_mfma_f32_16x16x32_bf16 v[156:159], a[144:147], v[64:67], 0
s_branch Lsj102
Lst101:
v_mfma_f32_16x16x32_bf16 v[156:159], a[144:147], v[64:67], v[116:119]
Lsj102:
v_mfma_f32_16x16x32_bf16 v[156:159], a[148:151], v[68:71], v[156:159]
v_mfma_f32_16x16x32_bf16 v[156:159], a[152:155], v[72:75], v[156:159]
v_mfma_f32_16x16x32_bf16 v[156:159], a[156:159], v[76:79], v[156:159]
s_nop 7
v_max3_f32 v127, v127, v156, v157
v_max3_f32 v127, v127, v158, v159
Lsa100:
s_add_u32 s83, s83, 1
s_barrier
s_cmp_lt_u32 s83, s76
s_cbranch_scc1 Lslow1
s_lshl_b32 s81, s59, 20
s_add_u32 s81, s81, s64
s_sub_u32 s81, s81, 0x4000
s_add_u32 m0, s64, 49152
s_add_u32 s72, s81, 16384
buffer_load_dwordx4 v1, s[44:47], s72 offen sc1 lds
buffer_load_dwordx4 v1, s[44:47], s72 offen offset:1024 sc1 lds
buffer_load_dwordx4 v1, s[44:47], s72 offen offset:2048 sc1 lds
buffer_load_dwordx4 v1, s[44:47], s72 offen offset:3072 sc1 lds
s_add_u32 s81, s81, 0x8000
s_add_u32 m0, s64, 81920
s_add_u32 s72, s81, 16384
buffer_load_dwordx4 v1, s[44:47], s72 offen sc1 lds
buffer_load_dwordx4 v1, s[44:47], s72 offen offset:1024 sc1 lds
buffer_load_dwordx4 v1, s[44:47], s72 offen offset:2048 sc1 lds
buffer_load_dwordx4 v1, s[44:47], s72 offen offset:3072 sc1 lds
s_add_u32 m0, s64, 65536
s_add_u32 s72, s81, 0
buffer_load_dwordx4 v1, s[44:47], s72 offen sc1 lds
buffer_load_dwordx4 v1, s[44:47], s72 offen offset:1024 sc1 lds
buffer_load_dwordx4 v1, s[44:47], s72 offen offset:2048 sc1 lds
buffer_load_dwordx4 v1, s[44:47], s72 offen offset:3072 sc1 lds
s_add_u32 s81, s81, 0x8000
s_add_u32 m0, s64, 114688
s_add_u32 s72, s81, 16384
buffer_load_dwordx4 v1, s[44:47], s72 offen sc1 lds
buffer_load_dwordx4 v1, s[44:47], s72 offen offset:1024 sc1 lds
buffer_load_dwordx4 v1, s[44:47], s72 offen offset:2048 sc1 lds
buffer_load_dwordx4 v1, s[44:47], s72 offen offset:3072 sc1 lds
s_add_u32 m0, s64, 98304
s_add_u32 s72, s81, 0
buffer_load_dwordx4 v1, s[44:47], s72 offen sc1 lds
buffer_load_dwordx4 v1, s[44:47], s72 offen offset:1024 sc1 lds
buffer_load_dwordx4 v1, s[44:47], s72 offen offset:2048 sc1 lds
buffer_load_dwordx4 v1, s[44:47], s72 offen offset:3072 sc1 lds
v_add_u32 v2, 0x8000, v1
v_lshrrev_b32 v3, 1, v0
v_lshlrev_b32 v3, 7, v3
s_waitcnt vmcnt(0)
s_barrier
v_accvgpr_write_b32 a32, 0
v_accvgpr_write_b32 a33, 0
v_accvgpr_write_b32 a34, 0
v_accvgpr_write_b32 a35, 0
v_accvgpr_write_b32 a36, 0
v_accvgpr_write_b32 a37, 0
v_accvgpr_write_b32 a38, 0
v_accvgpr_write_b32 a39, 0
v_accvgpr_write_b32 a40, 0
v_accvgpr_write_b32 a41, 0
v_accvgpr_write_b32 a42, 0
v_accvgpr_write_b32 a43, 0
v_accvgpr_write_b32 a44, 0
v_accvgpr_write_b32 a45, 0
v_accvgpr_write_b32 a46, 0
v_accvgpr_write_b32 a47, 0
v_accvgpr_write_b32 a48, 0
v_accvgpr_write_b32 a49, 0
v_accvgpr_write_b32 a50, 0
v_accvgpr_write_b32 a51, 0
v_accvgpr_write_b32 a52, 0
v_accvgpr_write_b32 a53, 0
v_accvgpr_write_b32 a54, 0
v_accvgpr_write_b32 a55, 0
v_accvgpr_write_b32 a56, 0
v_accvgpr_write_b32 a57, 0
v_accvgpr_write_b32 a58, 0
v_accvgpr_write_b32 a59, 0
v_accvgpr_write_b32 a60, 0
v_accvgpr_write_b32 a61, 0
v_accvgpr_write_b32 a62, 0
v_accvgpr_write_b32 a63, 0
v_accvgpr_write_b32 a96, 0
v_accvgpr_write_b32 a97, 0
v_accvgpr_write_b32 a98, 0
v_accvgpr_write_b32 a99, 0
v_accvgpr_write_b32 a100, 0
v_accvgpr_write_b32 a101, 0
v_accvgpr_write_b32 a102, 0
v_accvgpr_write_b32 a103, 0
v_accvgpr_write_b32 a104, 0
v_accvgpr_write_b32 a105, 0
v_accvgpr_write_b32 a106, 0
v_accvgpr_write_b32 a107, 0
v_accvgpr_write_b32 a108, 0
v_accvgpr_write_b32 a109, 0
v_accvgpr_write_b32 a110, 0
v_accvgpr_write_b32 a111, 0
v_accvgpr_write_b32 a112, 0
v_accvgpr_write_b32 a113, 0
v_accvgpr_write_b32 a114, 0
v_accvgpr_write_b32 a115, 0
v_accvgpr_write_b32 a116, 0
v_accvgpr_write_b32 a117, 0
v_accvgpr_write_b32 a118, 0
v_accvgpr_write_b32 a119, 0
v_accvgpr_write_b32 a120, 0
v_accvgpr_write_b32 a121, 0
v_accvgpr_write_b32 a122, 0
v_accvgpr_write_b32 a123, 0
v_accvgpr_write_b32 a124, 0
v_accvgpr_write_b32 a125, 0
v_accvgpr_write_b32 a126, 0
v_accvgpr_write_b32 a127, 0
ds_read_b128 a[128:131], v2 offset:16384
ds_read_b128 a[132:135], v2 offset:17408
ds_read_b128 a[136:139], v2 offset:18432
ds_read_b128 a[140:143], v2 offset:19456
ds_read_b128 a[144:147], v2 offset:20480
ds_read_b128 a[148:151], v2 offset:21504
ds_read_b128 a[152:155], v2 offset:22528
ds_read_b128 a[156:159], v2 offset:23552
s_branch Lattn
Lspin103:
s_mov_b32 s83, 262144
Lsl105:
s_sleep 2
buffer_load_dword v3, v2, s[44:47], s82 offen sc1
s_sub_u32 s83, s83, 1
s_cmp_eq_u32 s83, 0
s_waitcnt vmcnt(0)
s_cbranch_scc1 Lback104
v_cmp_gt_u32 vcc, 2, v3
s_cbranch_vccnz Lsl105
s_branch Lback104
Lspin106:
s_mov_b32 s83, 262144
Lsl108:
s_sleep 2
buffer_load_dword v3, v2, s[44:47], s82 offen sc1
s_sub_u32 s83, s83, 1
s_cmp_eq_u32 s83, 0
s_waitcnt vmcnt(0)
s_cbranch_scc1 Lback107
v_cmp_gt_u32 vcc, 2, v3
s_cbranch_vccnz Lsl108
s_branch Lback107
Lredo0:
s_xor_b32 s82, s78, 0
s_lshl_b32 s82, s82, 10
s_add_u32 s82, s82, s74
buffer_load_dword v3, v2, s[44:47], s82 offen sc1
s_waitcnt vmcnt(0)
v_cmp_gt_u32 vcc, 2, v3
s_cbranch_vccnz Lspin103
Lback104:
s_lshr_b32 s69, s12, 18
s_lshl_b32 s69, s69, 12
s_add_u32 s69, s69, s95
buffer_load_dwordx4 a[0:3], v1, s[44:47], s69 offen sc1
buffer_load_dwordx4 a[4:7], v1, s[44:47], s69 offen offset:1024 sc1
buffer_load_dwordx4 a[8:11], v1, s[44:47], s69 offen offset:2048 sc1
buffer_load_dwordx4 a[12:15], v1, s[44:47], s69 offen offset:3072 sc1
s_add_u32 s69, s69, 0x20000
buffer_load_dwordx4 a[16:19], v1, s[44:47], s69 offen sc1
buffer_load_dwordx4 a[20:23], v1, s[44:47], s69 offen offset:1024 sc1
buffer_load_dwordx4 a[24:27], v1, s[44:47], s69 offen offset:2048 sc1
buffer_load_dwordx4 a[28:31], v1, s[44:47], s69 offen offset:3072 sc1
s_lshr_b32 s69, s13, 18
s_lshl_b32 s69, s69, 12
s_add_u32 s69, s69, s95
buffer_load_dwordx4 a[32:35], v1, s[44:47], s69 offen sc1
buffer_load_dwordx4 a[36:39], v1, s[44:47], s69 offen offset:1024 sc1
buffer_load_dwordx4 a[40:43], v1, s[44:47], s69 offen offset:2048 sc1
buffer_load_dwordx4 a[44:47], v1, s[44:47], s69 offen offset:3072 sc1
s_add_u32 s69, s69, 0x20000
buffer_load_dwordx4 a[48:51], v1, s[44:47], s69 offen sc1
buffer_load_dwordx4 a[52:55], v1, s[44:47], s69 offen offset:1024 sc1
buffer_load_dwordx4 a[56:59], v1, s[44:47], s69 offen offset:2048 sc1
buffer_load_dwordx4 a[60:63], v1, s[44:47], s69 offen offset:3072 sc1
s_waitcnt vmcnt(8)
s_branch Lredo0b
Lspin109:
s_mov_b32 s83, 262144
Lsl111:
s_sleep 2
buffer_load_dword v114, v115, s[44:47], s84 offen sc1
s_sub_u32 s83, s83, 1
s_cmp_eq_u32 s83, 0
s_waitcnt vmcnt(0)
s_cbranch_scc1 Lback110
v_cmp_gt_u32 vcc, 3, v114
s_cbranch_vccnz Lsl111
s_branch Lback110
Lspin112:
s_mov_b32 s83, 262144
Lsl114:
s_sleep 2
buffer_load_dword v14, v13, s[44:47], s79 offen sc1
s_sub_u32 s83, s83, 1
s_cmp_eq_u32 s83, 0
s_waitcnt vmcnt(0)
s_cbranch_scc1 Lback113
v_cmp_gt_u32 vcc, 2, v14
s_cbranch_vccnz Lsl114
s_branch Lback113
Lxspin1:
s_mov_b32 s83, 262144
Lxsl1:
buffer_load_dwordx4 v[96:99], v1, s[44:47], s79 offen sc1
buffer_load_dwordx4 v[100:103], v1, s[44:47], s79 offen offset:1024 sc1
buffer_load_dwordx4 v[104:107], v1, s[44:47], s79 offen offset:2048 sc1
buffer_load_dwordx4 v[108:111], v1, s[44:47], s79 offen offset:3072 sc1
s_sub_u32 s83, s83, 1
s_cmp_eq_u32 s83, 0
s_waitcnt vmcnt(0)
s_cbranch_scc1 Lxback1
v_max3_u32 v12, v96, v97, v98
v_max3_u32 v13, v99, v100, v101
v_max3_u32 v12, v12, v102, v103
v_max3_u32 v13, v13, v104, v105
v_max3_u32 v12, v12, v106, v107
v_max3_u32 v13, v13, v108, v109
v_max3_u32 v12, v12, v110, v111
v_max_u32 v12, v12, v13
v_cmp_le_u32 vcc, 0xff800000, v12
s_cbranch_vccnz Lxsl1
s_branch Lxback1
Lxspin2:
s_mov_b32 s83, 262144
Lxsl2:
buffer_load_dwordx4 v[80:83], v1, s[44:47], s82 offen sc1
buffer_load_dwordx4 v[84:87], v1, s[44:47], s82 offen offset:1024 sc1
buffer_load_dwordx4 v[88:91], v1, s[44:47], s82 offen offset:2048 sc1
buffer_load_dwordx4 v[92:95], v1, s[44:47], s82 offen offset:3072 sc1
s_sub_u32 s83, s83, 1
s_cmp_eq_u32 s83, 0
s_waitcnt vmcnt(0)
s_cbranch_scc1 Lxback2
v_max3_u32 v12, v80, v81, v82
v_max3_u32 v13, v83, v84, v85
v_max3_u32 v12, v12, v86, v87
v_max3_u32 v13, v13, v88, v89
v_max3_u32 v12, v12, v90, v91
v_max3_u32 v13, v13, v92, v93
v_max3_u32 v12, v12, v94, v95
v_max_u32 v12, v12, v13
v_cmp_le_u32 vcc, 0xff800000, v12
s_cbranch_vccnz Lxsl2
s_branch Lxback2
Lxspin3:
s_mov_b32 s83, 262144
Lxsl3:
buffer_load_dwordx4 v[96:99], v1, s[44:47], s81 offen sc1
buffer_load_dwordx4 v[100:103], v1, s[44:47], s81 offen offset:1024 sc1
buffer_load_dwordx4 v[104:107], v1, s[44:47], s81 offen offset:2048 sc1
buffer_load_dwordx4 v[108:111], v1, s[44:47], s81 offen offset:3072 sc1
s_sub_u32 s83, s83, 1
s_cmp_eq_u32 s83, 0
s_waitcnt vmcnt(0)
s_cbranch_scc1 Lxback3
v_max3_u32 v12, v96, v97, v98
v_max3_u32 v13, v99, v100, v101
v_max3_u32 v12, v12, v102, v103
v_max3_u32 v13, v13, v104, v105
v_max3_u32 v12, v12, v106, v107
v_max3_u32 v13, v13, v108, v109
v_max3_u32 v12, v12, v110, v111
v_max_u32 v12, v12, v13
v_cmp_le_u32 vcc, 0xff800000, v12
s_cbranch_vccnz Lxsl3
s_branch Lxback3
Lcode_end:
s_endpgm
.section .rodata,"a"
.p2align 6
.amdhsa_kernel gated_mix__compressed_kv_cla__ssm_conv_h3__prompt_kernel
  .amdhsa_next_free_vgpr 512
  .amdhsa_next_free_sgpr 102
  .amdhsa_accum_offset 256
  .amdhsa_group_segment_fixed_size 0
  .amdhsa_kernarg_size 128
  .amdhsa_user_sgpr_count 2
  .amdhsa_user_sgpr_kernarg_segment_ptr 1
  .amdhsa_system_sgpr_workgroup_id_x 1
  .amdhsa_float_denorm_mode_32 3
.end_amdhsa_kernel
```

```asm
; @launch grid=(256,1,1) block=(256,1,1) lds=163840
.amdgcn_target "amdgcn-amd-amdhsa--gfx950"
.text
.globl gated_mix__compressed_kv_cla__ssm_conv_h3__prompt_kernel
.p2align 8
.type gated_mix__compressed_kv_cla__ssm_conv_h3__prompt_kernel,@function
gated_mix__compressed_kv_cla__ssm_conv_h3__prompt_kernel:
s_cmp_ge_u32 s2, 256
s_cbranch_scc1 Lend
s_load_dwordx2 s[8:9], s[0:1], 8
s_load_dwordx2 s[16:17], s[0:1], 24
s_load_dwordx2 s[20:21], s[0:1], 32
s_load_dwordx2 s[4:5], s[0:1], 0
s_load_dwordx2 s[12:13], s[0:1], 16
s_load_dwordx2 s[24:25], s[0:1], 40
s_load_dwordx2 s[28:29], s[0:1], 56
s_load_dwordx2 s[32:33], s[0:1], 64
s_load_dwordx2 s[52:53], s[0:1], 72
s_load_dwordx2 s[36:37], s[0:1], 80
s_load_dwordx2 s[54:55], s[0:1], 88
s_load_dwordx2 s[56:57], s[0:1], 96
s_load_dwordx2 s[40:41], s[0:1], 104
s_load_dwordx2 s[48:49], s[0:1], 112
s_load_dwordx2 s[44:45], s[0:1], 120
s_getpc_b64 s[98:99]
Lpc0:
s_lshr_b32 s75, s2, 3
v_lshrrev_b32 v26, 3, v0
s_lshl_b32 s73, s75, 12
v_lshlrev_b32 v26, 7, v26
v_add_u32 v26, s73, v26
v_min_u32 v26, Lcode_end-Lpc0, v26
global_load_dword v31, v26, s[98:99]
v_lshrrev_b32 v26, 6, v0
v_and_b32 v0, 63, v0
s_and_b32 s73, s2, 7
v_readfirstlane_b32 s58, v26
s_lshr_b32 s65, s75, 3
s_and_b32 s60, s75, 7
s_lshl_b32 s59, s73, 2
s_add_u32 s59, s59, s65
s_lshl_b32 s61, s65, 1
s_lshl_b32 s63, s58, 13
s_lshl_b32 s64, s58, 12
s_lshl_b32 s67, s60, 18
s_lshl_b32 s76, s58, 16
s_add_u32 s84, s67, s76
s_lshl_b32 s66, s58, 17
s_lshl_b32 s73, s73, 2
s_lshr_b32 s73, 0x67234501, s73
s_and_b32 s73, s73, 7
s_lshl_b32 s74, s65, 3
s_add_u32 s73, s73, s74
s_lshl_b32 s73, s73, 8
s_add_u32 s66, s66, s73
v_lshrrev_b32 v26, 4, v0
v_and_b32 v27, 7, v0
v_xor_b32 v27, v27, v26
v_lshlrev_b32 v27, 4, v27
v_lshrrev_b32 v28, 3, v0
v_lshl_add_u32 v2, v28, 10, v27
v_xor_b32 v3, 64, v2
v_and_b32 v29, 15, v0
v_lshlrev_b32 v30, 1, v26
v_xor_b32 v30, v30, v29
v_lshlrev_b32 v30, 4, v30
v_lshl_add_u32 v6, v26, 13, v30
v_xor_b32 v7, 0x80, v6
s_mov_b32 s10, 0x200000
s_mov_b32 s11, 0x20000
s_mov_b32 s18, 0x400000
s_mov_b32 s19, 0x20000
s_mov_b32 s22, 0x400000
s_mov_b32 s23, 0x20000
s_lshl_b32 s73, s2, 2
s_add_u32 s73, s73, s58
s_lshl_b32 s73, s73, 11
v_lshrrev_b32 v124, 2, v0
v_lshlrev_b32 v124, 7, v124
v_add_u32 v124, s73, v124
s_lshr_b32 s73, s2, 3
s_lshl_b32 s73, s73, 2
s_add_u32 s73, s73, s58
s_lshl_b32 s73, s73, 13
s_and_b32 s74, s66, 0x700
s_add_u32 s73, s73, s74
v_lshrrev_b32 v125, 4, v0
v_lshlrev_b32 v125, 11, v125
v_bfe_u32 v126, v0, 3, 1
v_lshl_add_u32 v125, v126, 7, v125
v_add_u32 v125, s73, v125
s_waitcnt lgkmcnt(0)
s_mov_b32 s80, 0x0
buffer_load_dword v126, v125, s[16:19], s80 offen nt
buffer_load_dword v126, v125, s[16:19], s80 offen sc1
buffer_load_dword v126, v125, s[20:23], s80 offen nt
buffer_load_dword v126, v125, s[20:23], s80 offen sc1
s_and_b32 s73, s65, 1
s_xor_b32 s73, s73, 0
s_lshl_b32 s69, s73, 7
s_add_u32 s69, s69, s84
s_lshl_b32 s71, s73, 19
s_add_u32 s71, s71, s66
s_add_u32 m0, s63, 65536
s_add_u32 s72, s69, 0
buffer_load_dwordx4 v2, s[8:11], s72 offen lds
s_add_u32 s72, s69, 7168
buffer_load_dwordx4 v3, s[8:11], s72 offen offset:1024 lds
s_add_u32 s72, s69, 14336
buffer_load_dwordx4 v2, s[8:11], s72 offen offset:2048 lds
s_add_u32 s72, s69, 21504
buffer_load_dwordx4 v3, s[8:11], s72 offen offset:3072 lds
s_add_u32 m0, s64, 0
s_add_u32 s72, s71, 0
buffer_load_dwordx4 v6, s[16:19], s72 offen nt lds
s_add_u32 s72, s71, 31744
buffer_load_dwordx4 v6, s[16:19], s72 offen offset:1024 nt lds
s_add_u32 s72, s71, 63488
buffer_load_dwordx4 v7, s[16:19], s72 offen offset:2048 nt lds
s_add_u32 s72, s71, 95232
buffer_load_dwordx4 v7, s[16:19], s72 offen offset:3072 nt lds
s_add_u32 m0, s63, 69632
s_add_u32 s72, s69, 32768
buffer_load_dwordx4 v2, s[8:11], s72 offen lds
s_add_u32 s72, s69, 39936
buffer_load_dwordx4 v3, s[8:11], s72 offen offset:1024 lds
s_add_u32 s72, s69, 47104
buffer_load_dwordx4 v2, s[8:11], s72 offen offset:2048 lds
s_add_u32 s72, s69, 54272
buffer_load_dwordx4 v3, s[8:11], s72 offen offset:3072 lds
s_add_u32 m0, s64, 16384
s_add_u32 s72, s71, 0
buffer_load_dwordx4 v6, s[20:23], s72 offen nt lds
s_add_u32 s72, s71, 31744
buffer_load_dwordx4 v6, s[20:23], s72 offen offset:1024 nt lds
s_add_u32 s72, s71, 63488
buffer_load_dwordx4 v7, s[20:23], s72 offen offset:2048 nt lds
s_add_u32 s72, s71, 95232
buffer_load_dwordx4 v7, s[20:23], s72 offen offset:3072 nt lds
buffer_load_dword v126, v124, s[8:11], 0 offen
s_and_b32 s73, s65, 1
s_xor_b32 s73, s73, 1
s_lshl_b32 s69, s73, 7
s_add_u32 s69, s69, s84
s_lshl_b32 s71, s73, 19
s_add_u32 s71, s71, s66
s_add_u32 m0, s63, 98304
s_add_u32 s72, s69, 0
buffer_load_dwordx4 v2, s[8:11], s72 offen lds
s_add_u32 s72, s69, 7168
buffer_load_dwordx4 v3, s[8:11], s72 offen offset:1024 lds
s_add_u32 s72, s69, 14336
buffer_load_dwordx4 v2, s[8:11], s72 offen offset:2048 lds
s_add_u32 s72, s69, 21504
buffer_load_dwordx4 v3, s[8:11], s72 offen offset:3072 lds
s_branch Lmain
.p2align 12
Lmain:
s_mov_b32 s6, 0x400000
s_mov_b32 s7, 0x20000
s_mov_b32 s14, 0x800000
s_mov_b32 s15, 0x20000
s_mov_b32 s26, 0x800000
s_mov_b32 s27, 0x20000
s_mov_b32 s30, 0x400000
s_mov_b32 s31, 0x20000
s_mov_b32 s34, 0x400000
s_mov_b32 s35, 0x20000
s_mov_b32 s38, 0x400000
s_mov_b32 s39, 0x20000
s_mov_b32 s42, 0x400000
s_mov_b32 s43, 0x20000
s_mov_b32 s46, 0x5800000
s_mov_b32 s47, 0x20000
s_mov_b32 s50, 0x100
s_mov_b32 s51, 0x20000
v_lshl_add_u32 v4, v28, 11, v27
v_xor_b32 v5, 64, v4
v_lshlrev_b32 v1, 4, v0
s_sub_u32 s74, 15, s60
s_lshl_b32 s68, s74, 18
s_lshl_b32 s76, s58, 15
s_add_u32 s68, s68, s76
s_add_u32 s67, s67, s76
s_and_b32 s62, s60, 3
s_sub_u32 s62, 16, s62
s_lshl_b32 s91, s59, 3
s_add_u32 s91, s91, s60
s_lshl_b32 s93, s91, 2
s_add_u32 s93, s93, s58
s_lshl_b32 s91, s91, 7
s_add_u32 s91, s91, 0x3810000
s_lshl_b32 s75, s93, 1
s_and_b32 s75, s75, 0xffc
s_lshl_b32 s93, s93, 12
s_load_dwordx2 s[88:89], s[36:37], s93
s_load_dword s90, s[54:55], s75
v_or_b32 v29, s58, v0
v_mov_b32 v30, 0
v_min_u32 v29, 1, v29
v_lshlrev_b32 v29, 30, v29
buffer_store_dword v30, v29, s[44:47], s91 offen sc1
s_xor_b32 s73, s2, 5
s_and_b32 s73, s73, 15
s_lshr_b32 s74, s2, 4
s_lshl_b32 s74, s74, 7
s_lshl_b32 s75, s58, 5
s_add_u32 s74, s74, s75
s_mov_b32 s75, 131072
v_lshrrev_b32 v29, 5, v0
v_lshlrev_b32 v29, 4, v29
v_add_u32 v29, s74, v29
v_and_b32 v30, 31, v0
s_lshl_b32 s73, s73, 5
v_add_u32 v30, s73, v30
v_lshlrev_b32 v26, 11, v29
v_lshl_add_u32 v26, v30, 2, v26
v_subrev_u32 v27, 0x1800, v26
s_lshl_b32 s82, s74, 11
s_lshl_b32 s73, s73, 2
s_add_u32 s82, s82, s73
v_lshrrev_b32 v26, 3, v0
v_and_b32 v32, 7, v0
v_lshlrev_b32 v32, 4, v32
v_lshl_add_u32 v26, v26, 11, v32
v_lshrrev_b32 v98, 5, v0
v_lshlrev_b32 v98, 11, v98
v_and_b32 v32, 31, v0
v_lshl_add_u32 v98, v32, 2, v98
v_add_u32 v98, s63, v98
v_add_u32 v98, s75, v98
v_and_b32 v29, 0x7f, v29
v_sub_u32 v29, 0x70, v29
v_lshlrev_b32 v29, 1, v29
v_and_b32 v32, 31, v0
v_mul_u32_u24 v32, 544, v32
v_add3_u32 v28, v32, v29, s75
v_lshlrev_b32 v30, 4, v30
s_lshl_b32 s73, s2, 14
s_lshl_b32 s74, s58, 12
s_add_u32 s76, s73, s74
v_and_b32 v29, 15, v0
v_lshrrev_b32 v32, 4, v0
v_lshrrev_b32 v24, 1, v29
v_xor_b32 v24, v24, v32
v_lshlrev_b32 v24, 4, v24
v_lshl_add_u32 v24, v29, 7, v24
s_add_u32 s73, s63, 131072
v_add_u32 v16, s73, v24
v_xor_b32 v17, 64, v16
v_subrev_u32 v18, 0x10000, v16
v_subrev_u32 v19, 0x10000, v17
s_lshr_b32 s73, s58, 1
s_lshl_b32 s74, s73, 14
s_add_u32 s74, s74, 0x10000
v_add_u32 v24, s74, v24
v_xor_b32 v25, 64, v24
v_lshrrev_b32 v8, 2, v29
v_and_b32 v9, 1, v32
v_lshl_add_u32 v9, v9, 2, v8
v_lshl_add_u32 v8, v32, 3, v8
v_lshlrev_b32 v8, 8, v8
v_lshl_add_u32 v8, v9, 5, v8
v_and_b32 v29, 3, v0
v_lshl_add_u32 v8, v29, 3, v8
s_and_b32 s74, s58, 1
s_lshl_b32 s75, s74, 7
v_xor_b32 v20, s75, v8
v_xor_b32 v9, 32, v8
v_xor_b32 v10, 64, v8
v_xor_b32 v11, 96, v8
v_xor_b32 v12, 128, v8
v_xor_b32 v13, 160, v8
v_xor_b32 v14, 192, v8
v_xor_b32 v15, 224, v8
v_xor_b32 v21, 32, v20
v_xor_b32 v22, 64, v20
v_xor_b32 v23, 96, v20
s_lshl_b32 s77, s59, 20
s_add_u32 s81, s77, s64
s_sub_u32 s81, s81, 0x4000
s_lshl_b32 s75, s60, 17
s_add_u32 s77, s77, s75
s_lshl_b32 s73, s73, 16
s_add_u32 s77, s77, s73
s_lshl_b32 s75, s74, 12
s_add_u32 s78, s77, s75
s_add_u32 s78, s78, 0x4000
s_lshl_b32 s75, s74, 11
s_add_u32 s77, s77, s75
s_mov_b32 s79, 0x3e0293ee
s_waitcnt vmcnt(6)
s_barrier
ds_read_b64_tr_b16 v[224:225], v20 offset:0
ds_read_b64_tr_b16 v[226:227], v20 offset:1024
ds_read_b64_tr_b16 v[228:229], v20 offset:8192
ds_read_b64_tr_b16 v[230:231], v20 offset:9216
ds_read_b128 v[128:131], v24 offset:0
ds_read_b128 v[132:135], v25 offset:0
ds_read_b128 v[136:139], v24 offset:2048
ds_read_b128 v[140:143], v25 offset:2048
ds_read_b128 v[144:147], v24 offset:4096
ds_read_b128 v[148:151], v25 offset:4096
ds_read_b128 v[152:155], v24 offset:6144
ds_read_b128 v[156:159], v25 offset:6144
ds_read_b128 v[160:163], v24 offset:8192
ds_read_b128 v[164:167], v25 offset:8192
ds_read_b128 v[168:171], v24 offset:10240
ds_read_b128 v[172:175], v25 offset:10240
ds_read_b128 v[176:179], v24 offset:12288
ds_read_b128 v[180:183], v25 offset:12288
ds_read_b128 v[184:187], v24 offset:14336
ds_read_b128 v[188:191], v25 offset:14336
ds_read_b64_tr_b16 v[232:233], v21 offset:0
ds_read_b64_tr_b16 v[234:235], v21 offset:1024
ds_read_b64_tr_b16 v[236:237], v21 offset:8192
ds_read_b64_tr_b16 v[238:239], v21 offset:9216
s_waitcnt lgkmcnt(0)
v_mfma_f32_16x16x32_bf16 a[0:3], v[224:227], v[128:131], 0
s_add_u32 m0, s64, 32768
ds_read_b64_tr_b16 v[240:241], v22 offset:0
v_mfma_f32_16x16x32_bf16 a[0:3], v[228:231], v[132:135], a[0:3]
s_add_u32 s72, s71, 0
buffer_load_dwordx4 v6, s[16:19], s72 offen lds
v_mfma_f32_16x16x32_bf16 a[4:7], v[228:231], v[140:143], 0
s_add_u32 s72, s71, 31744
buffer_load_dwordx4 v6, s[16:19], s72 offen offset:1024 lds
v_mfma_f32_16x16x32_bf16 a[4:7], v[224:227], v[136:139], a[4:7]
ds_read_b64_tr_b16 v[242:243], v22 offset:1024
v_mfma_f32_16x16x32_bf16 a[8:11], v[224:227], v[144:147], 0
s_add_u32 s72, s71, 63488
buffer_load_dwordx4 v7, s[16:19], s72 offen offset:2048 lds
v_mfma_f32_16x16x32_bf16 a[8:11], v[228:231], v[148:151], a[8:11]
v_mfma_f32_16x16x32_bf16 a[12:15], v[228:231], v[156:159], 0
s_add_u32 s72, s71, 95232
buffer_load_dwordx4 v7, s[16:19], s72 offen offset:3072 lds
v_mfma_f32_16x16x32_bf16 a[12:15], v[224:227], v[152:155], a[12:15]
ds_read_b64_tr_b16 v[244:245], v22 offset:8192
v_mfma_f32_16x16x32_bf16 a[16:19], v[224:227], v[160:163], 0
s_add_u32 m0, s63, 102400
v_mfma_f32_16x16x32_bf16 a[16:19], v[228:231], v[164:167], a[16:19]
s_add_u32 s72, s69, 32768
buffer_load_dwordx4 v2, s[8:11], s72 offen lds
v_mfma_f32_16x16x32_bf16 a[20:23], v[228:231], v[172:175], 0
s_add_u32 s72, s69, 39936
buffer_load_dwordx4 v3, s[8:11], s72 offen offset:1024 lds
v_mfma_f32_16x16x32_bf16 a[20:23], v[224:227], v[168:171], a[20:23]
ds_read_b64_tr_b16 v[246:247], v22 offset:9216
v_mfma_f32_16x16x32_bf16 a[24:27], v[224:227], v[176:179], 0
s_add_u32 s72, s69, 47104
buffer_load_dwordx4 v2, s[8:11], s72 offen offset:2048 lds
v_mfma_f32_16x16x32_bf16 a[24:27], v[228:231], v[180:183], a[24:27]
v_mfma_f32_16x16x32_bf16 a[28:31], v[228:231], v[188:191], 0
s_add_u32 s72, s69, 54272
buffer_load_dwordx4 v3, s[8:11], s72 offen offset:3072 lds
v_mfma_f32_16x16x32_bf16 a[28:31], v[224:227], v[184:187], a[28:31]
v_mfma_f32_16x16x32_bf16 a[60:63], v[232:235], v[184:187], 0
s_add_u32 m0, s64, 49152
ds_read_b64_tr_b16 v[248:249], v23 offset:0
v_mfma_f32_16x16x32_bf16 a[60:63], v[236:239], v[188:191], a[60:63]
s_add_u32 s72, s71, 0
buffer_load_dwordx4 v6, s[20:23], s72 offen lds
v_mfma_f32_16x16x32_bf16 a[56:59], v[236:239], v[180:183], 0
s_add_u32 s72, s71, 31744
buffer_load_dwordx4 v6, s[20:23], s72 offen offset:1024 lds
v_mfma_f32_16x16x32_bf16 a[56:59], v[232:235], v[176:179], a[56:59]
ds_read_b64_tr_b16 v[250:251], v23 offset:1024
v_mfma_f32_16x16x32_bf16 a[52:55], v[232:235], v[168:171], 0
s_add_u32 s72, s71, 63488
buffer_load_dwordx4 v7, s[20:23], s72 offen offset:2048 lds
v_mfma_f32_16x16x32_bf16 a[52:55], v[236:239], v[172:175], a[52:55]
v_mfma_f32_16x16x32_bf16 a[48:51], v[236:239], v[164:167], 0
s_add_u32 s72, s71, 95232
buffer_load_dwordx4 v7, s[20:23], s72 offen offset:3072 lds
v_mfma_f32_16x16x32_bf16 a[48:51], v[232:235], v[160:163], a[48:51]
s_mov_b32 s80, 0x100000
buffer_load_dword v126, v125, s[16:19], s80 offen nt
v_mfma_f32_16x16x32_bf16 a[44:47], v[232:235], v[152:155], 0
buffer_load_dword v126, v125, s[16:19], s80 offen sc1
v_mfma_f32_16x16x32_bf16 a[44:47], v[236:239], v[156:159], a[44:47]
buffer_load_dword v126, v125, s[20:23], s80 offen nt
v_mfma_f32_16x16x32_bf16 a[40:43], v[236:239], v[148:151], 0
buffer_load_dword v126, v125, s[20:23], s80 offen sc1
v_mfma_f32_16x16x32_bf16 a[40:43], v[232:235], v[144:147], a[40:43]
ds_read_b64_tr_b16 v[252:253], v23 offset:8192
v_mfma_f32_16x16x32_bf16 a[36:39], v[232:235], v[136:139], 0
ds_read_b64_tr_b16 v[254:255], v23 offset:9216
v_mfma_f32_16x16x32_bf16 a[36:39], v[236:239], v[140:143], a[36:39]
v_mfma_f32_16x16x32_bf16 a[32:35], v[236:239], v[132:135], 0
v_mfma_f32_16x16x32_bf16 a[32:35], v[232:235], v[128:131], a[32:35]
s_waitcnt lgkmcnt(4)
v_mfma_f32_16x16x32_bf16 a[64:67], v[240:243], v[128:131], 0
ds_read_b64_tr_b16 v[224:225], v20 offset:16384
v_mfma_f32_16x16x32_bf16 a[64:67], v[244:247], v[132:135], a[64:67]
v_mfma_f32_16x16x32_bf16 a[68:71], v[244:247], v[140:143], 0
v_mfma_f32_16x16x32_bf16 a[68:71], v[240:243], v[136:139], a[68:71]
ds_read_b64_tr_b16 v[226:227], v20 offset:17408
v_mfma_f32_16x16x32_bf16 a[72:75], v[240:243], v[144:147], 0
v_mfma_f32_16x16x32_bf16 a[72:75], v[244:247], v[148:151], a[72:75]
v_mfma_f32_16x16x32_bf16 a[76:79], v[244:247], v[156:159], 0
v_mfma_f32_16x16x32_bf16 a[76:79], v[240:243], v[152:155], a[76:79]
ds_read_b64_tr_b16 v[228:229], v20 offset:24576
v_mfma_f32_16x16x32_bf16 a[80:83], v[240:243], v[160:163], 0
v_mfma_f32_16x16x32_bf16 a[80:83], v[244:247], v[164:167], a[80:83]
v_mfma_f32_16x16x32_bf16 a[84:87], v[244:247], v[172:175], 0
ds_read_b64_tr_b16 v[230:231], v20 offset:25600
v_mfma_f32_16x16x32_bf16 a[84:87], v[240:243], v[168:171], a[84:87]
v_mfma_f32_16x16x32_bf16 a[88:91], v[240:243], v[176:179], 0
v_mfma_f32_16x16x32_bf16 a[88:91], v[244:247], v[180:183], a[88:91]
v_mfma_f32_16x16x32_bf16 a[92:95], v[244:247], v[188:191], 0
v_mfma_f32_16x16x32_bf16 a[92:95], v[240:243], v[184:187], a[92:95]
s_waitcnt lgkmcnt(4)
v_mfma_f32_16x16x32_bf16 a[124:127], v[248:251], v[184:187], 0
ds_read_b64_tr_b16 v[232:233], v21 offset:16384
v_mfma_f32_16x16x32_bf16 a[124:127], v[252:255], v[188:191], a[124:127]
v_mfma_f32_16x16x32_bf16 a[120:123], v[252:255], v[180:183], 0
v_mfma_f32_16x16x32_bf16 a[120:123], v[248:251], v[176:179], a[120:123]
ds_read_b64_tr_b16 v[234:235], v21 offset:17408
v_mfma_f32_16x16x32_bf16 a[116:119], v[248:251], v[168:171], 0
v_mfma_f32_16x16x32_bf16 a[116:119], v[252:255], v[172:175], a[116:119]
v_mfma_f32_16x16x32_bf16 a[112:115], v[252:255], v[164:167], 0
v_mfma_f32_16x16x32_bf16 a[112:115], v[248:251], v[160:163], a[112:115]
ds_read_b64_tr_b16 v[236:237], v21 offset:24576
v_mfma_f32_16x16x32_bf16 a[108:111], v[248:251], v[152:155], 0
v_mfma_f32_16x16x32_bf16 a[108:111], v[252:255], v[156:159], a[108:111]
v_mfma_f32_16x16x32_bf16 a[104:107], v[252:255], v[148:151], 0
ds_read_b64_tr_b16 v[238:239], v21 offset:25600
v_mfma_f32_16x16x32_bf16 a[104:107], v[248:251], v[144:147], a[104:107]
v_mfma_f32_16x16x32_bf16 a[100:103], v[248:251], v[136:139], 0
v_mfma_f32_16x16x32_bf16 a[100:103], v[252:255], v[140:143], a[100:103]
v_mfma_f32_16x16x32_bf16 a[96:99], v[252:255], v[132:135], 0
v_mfma_f32_16x16x32_bf16 a[96:99], v[248:251], v[128:131], a[96:99]
s_waitcnt lgkmcnt(4)
v_mfma_f32_16x16x32_bf16 a[128:131], v[128:131], v[224:227], 0
ds_read_b64_tr_b16 v[240:241], v22 offset:16384
v_mfma_f32_16x16x32_bf16 a[128:131], v[132:135], v[228:231], a[128:131]
v_mfma_f32_16x16x32_bf16 a[132:135], v[140:143], v[228:231], 0
v_mfma_f32_16x16x32_bf16 a[132:135], v[136:139], v[224:227], a[132:135]
ds_read_b64_tr_b16 v[242:243], v22 offset:17408
v_mfma_f32_16x16x32_bf16 a[136:139], v[144:147], v[224:227], 0
v_mfma_f32_16x16x32_bf16 a[136:139], v[148:151], v[228:231], a[136:139]
v_mfma_f32_16x16x32_bf16 a[140:143], v[156:159], v[228:231], 0
v_mfma_f32_16x16x32_bf16 a[140:143], v[152:155], v[224:227], a[140:143]
ds_read_b64_tr_b16 v[244:245], v22 offset:24576
v_mfma_f32_16x16x32_bf16 a[144:147], v[160:163], v[224:227], 0
v_mfma_f32_16x16x32_bf16 a[144:147], v[164:167], v[228:231], a[144:147]
v_mfma_f32_16x16x32_bf16 a[148:151], v[172:175], v[228:231], 0
ds_read_b64_tr_b16 v[246:247], v22 offset:25600
v_mfma_f32_16x16x32_bf16 a[148:151], v[168:171], v[224:227], a[148:151]
v_mfma_f32_16x16x32_bf16 a[152:155], v[176:179], v[224:227], 0
v_mfma_f32_16x16x32_bf16 a[152:155], v[180:183], v[228:231], a[152:155]
v_mfma_f32_16x16x32_bf16 a[156:159], v[188:191], v[228:231], 0
v_mfma_f32_16x16x32_bf16 a[156:159], v[184:187], v[224:227], a[156:159]
s_waitcnt lgkmcnt(4)
v_mfma_f32_16x16x32_bf16 a[188:191], v[184:187], v[232:235], 0
ds_read_b64_tr_b16 v[248:249], v23 offset:16384
v_mfma_f32_16x16x32_bf16 a[188:191], v[188:191], v[236:239], a[188:191]
v_mfma_f32_16x16x32_bf16 a[184:187], v[180:183], v[236:239], 0
ds_read_b64_tr_b16 v[250:251], v23 offset:17408
v_mfma_f32_16x16x32_bf16 a[184:187], v[176:179], v[232:235], a[184:187]
v_mfma_f32_16x16x32_bf16 a[180:183], v[168:171], v[232:235], 0
ds_read_b64_tr_b16 v[252:253], v23 offset:24576
v_mfma_f32_16x16x32_bf16 a[180:183], v[172:175], v[236:239], a[180:183]
v_mfma_f32_16x16x32_bf16 a[176:179], v[164:167], v[236:239], 0
ds_read_b64_tr_b16 v[254:255], v23 offset:25600
v_mfma_f32_16x16x32_bf16 a[176:179], v[160:163], v[232:235], a[176:179]
v_mfma_f32_16x16x32_bf16 a[172:175], v[152:155], v[232:235], 0
v_mfma_f32_16x16x32_bf16 a[172:175], v[156:159], v[236:239], a[172:175]
v_mfma_f32_16x16x32_bf16 a[168:171], v[148:151], v[236:239], 0
v_mfma_f32_16x16x32_bf16 a[168:171], v[144:147], v[232:235], a[168:171]
v_mfma_f32_16x16x32_bf16 a[164:167], v[136:139], v[232:235], 0
v_mfma_f32_16x16x32_bf16 a[164:167], v[140:143], v[236:239], a[164:167]
v_mfma_f32_16x16x32_bf16 a[160:163], v[132:135], v[236:239], 0
s_waitcnt vmcnt(4) lgkmcnt(0)
v_mfma_f32_16x16x32_bf16 a[160:163], v[128:131], v[232:235], a[160:163]
s_barrier
v_mfma_f32_16x16x32_bf16 a[192:195], v[128:131], v[240:243], 0
s_and_b32 s73, s65, 1
ds_read_b64_tr_b16 v[224:225], v20 offset:32768
v_mfma_f32_16x16x32_bf16 a[192:195], v[132:135], v[244:247], a[192:195]
s_xor_b32 s73, s73, 2
ds_read_b64_tr_b16 v[226:227], v20 offset:33792
v_mfma_f32_16x16x32_bf16 a[196:199], v[140:143], v[244:247], 0
s_lshl_b32 s69, s73, 7
ds_read_b64_tr_b16 v[228:229], v20 offset:40960
v_mfma_f32_16x16x32_bf16 a[196:199], v[136:139], v[240:243], a[196:199]
s_add_u32 s69, s69, s84
ds_read_b64_tr_b16 v[230:231], v20 offset:41984
v_mfma_f32_16x16x32_bf16 a[200:203], v[144:147], v[240:243], 0
s_lshl_b32 s71, s73, 19
ds_read_b128 v[192:195], v24 offset:32768
v_mfma_f32_16x16x32_bf16 a[200:203], v[148:151], v[244:247], a[200:203]
s_add_u32 s71, s71, s66
ds_read_b128 v[196:199], v25 offset:32768
v_mfma_f32_16x16x32_bf16 a[204:207], v[156:159], v[244:247], 0
s_add_u32 m0, s63, 65536
v_mfma_f32_16x16x32_bf16 a[204:207], v[152:155], v[240:243], a[204:207]
s_add_u32 s72, s69, 0
buffer_load_dwordx4 v2, s[8:11], s72 offen lds
v_mfma_f32_16x16x32_bf16 a[208:211], v[160:163], v[240:243], 0
s_add_u32 s72, s69, 7168
buffer_load_dwordx4 v3, s[8:11], s72 offen offset:1024 lds
v_mfma_f32_16x16x32_bf16 a[208:211], v[164:167], v[244:247], a[208:211]
s_add_u32 s72, s69, 14336
buffer_load_dwordx4 v2, s[8:11], s72 offen offset:2048 lds
v_mfma_f32_16x16x32_bf16 a[212:215], v[172:175], v[244:247], 0
ds_read_b128 v[200:203], v24 offset:34816
v_mfma_f32_16x16x32_bf16 a[212:215], v[168:171], v[240:243], a[212:215]
ds_read_b128 v[204:207], v25 offset:34816
v_mfma_f32_16x16x32_bf16 a[216:219], v[176:179], v[240:243], 0
s_add_u32 s72, s69, 21504
buffer_load_dwordx4 v3, s[8:11], s72 offen offset:3072 lds
v_mfma_f32_16x16x32_bf16 a[216:219], v[180:183], v[244:247], a[216:219]
ds_read_b128 v[208:211], v24 offset:36864
v_mfma_f32_16x16x32_bf16 a[220:223], v[188:191], v[244:247], 0
ds_read_b128 v[212:215], v25 offset:36864
v_mfma_f32_16x16x32_bf16 a[220:223], v[184:187], v[240:243], a[220:223]
ds_read_b128 v[216:219], v24 offset:38912
v_mfma_f32_16x16x32_bf16 a[252:255], v[184:187], v[248:251], 0
ds_read_b128 v[220:223], v25 offset:38912
v_mfma_f32_16x16x32_bf16 a[252:255], v[188:191], v[252:255], a[252:255]
s_add_u32 m0, s64, 0
v_mfma_f32_16x16x32_bf16 a[248:251], v[180:183], v[252:255], 0
s_add_u32 s72, s71, 0
buffer_load_dwordx4 v6, s[16:19], s72 offen lds
v_mfma_f32_16x16x32_bf16 a[248:251], v[176:179], v[248:251], a[248:251]
ds_read_b128 v[184:187], v24 offset:40960
v_mfma_f32_16x16x32_bf16 a[244:247], v[168:171], v[248:251], 0
ds_read_b128 v[188:191], v25 offset:40960
v_mfma_f32_16x16x32_bf16 a[244:247], v[172:175], v[252:255], a[244:247]
s_add_u32 s72, s71, 31744
buffer_load_dwordx4 v6, s[16:19], s72 offen offset:1024 lds
v_mfma_f32_16x16x32_bf16 a[240:243], v[164:167], v[252:255], 0
ds_read_b128 v[176:179], v24 offset:43008
v_mfma_f32_16x16x32_bf16 a[240:243], v[160:163], v[248:251], a[240:243]
ds_read_b128 v[180:183], v25 offset:43008
v_mfma_f32_16x16x32_bf16 a[236:239], v[152:155], v[248:251], 0
ds_read_b128 v[168:171], v24 offset:45056
v_mfma_f32_16x16x32_bf16 a[236:239], v[156:159], v[252:255], a[236:239]
s_add_u32 s72, s71, 63488
buffer_load_dwordx4 v7, s[16:19], s72 offen offset:2048 lds
v_mfma_f32_16x16x32_bf16 a[232:235], v[148:151], v[252:255], 0
ds_read_b128 v[172:175], v25 offset:45056
v_mfma_f32_16x16x32_bf16 a[232:235], v[144:147], v[248:251], a[232:235]
ds_read_b128 v[160:163], v24 offset:47104
v_mfma_f32_16x16x32_bf16 a[228:231], v[136:139], v[248:251], 0
ds_read_b128 v[164:167], v25 offset:47104
v_mfma_f32_16x16x32_bf16 a[228:231], v[140:143], v[252:255], a[228:231]
v_mfma_f32_16x16x32_bf16 a[224:227], v[132:135], v[252:255], 0
s_add_u32 s72, s71, 95232
buffer_load_dwordx4 v7, s[16:19], s72 offen offset:3072 lds
v_mfma_f32_16x16x32_bf16 a[224:227], v[128:131], v[248:251], a[224:227]
s_waitcnt lgkmcnt(8)
ds_read_b64_tr_b16 v[232:233], v21 offset:32768
v_mfma_f32_16x16x32_bf16 a[0:3], v[224:227], v[192:195], a[0:3]
ds_read_b64_tr_b16 v[234:235], v21 offset:33792
v_mfma_f32_16x16x32_bf16 a[0:3], v[228:231], v[196:199], a[0:3]
ds_read_b64_tr_b16 v[240:241], v22 offset:32768
v_mfma_f32_16x16x32_bf16 a[4:7], v[228:231], v[204:207], a[4:7]
s_add_u32 m0, s63, 69632
ds_read_b64_tr_b16 v[236:237], v21 offset:40960
v_mfma_f32_16x16x32_bf16 a[4:7], v[224:227], v[200:203], a[4:7]
s_add_u32 s72, s69, 32768
buffer_load_dwordx4 v2, s[8:11], s72 offen lds
v_mfma_f32_16x16x32_bf16 a[8:11], v[224:227], v[208:211], a[8:11]
ds_read_b64_tr_b16 v[238:239], v21 offset:41984
v_mfma_f32_16x16x32_bf16 a[8:11], v[228:231], v[212:215], a[8:11]
v_mfma_f32_16x16x32_bf16 a[12:15], v[228:231], v[220:223], a[12:15]
s_add_u32 s72, s69, 39936
buffer_load_dwordx4 v3, s[8:11], s72 offen offset:1024 lds
v_mfma_f32_16x16x32_bf16 a[12:15], v[224:227], v[216:219], a[12:15]
s_waitcnt lgkmcnt(5)
ds_read_b64_tr_b16 v[242:243], v22 offset:33792
v_mfma_f32_16x16x32_bf16 a[16:19], v[224:227], v[184:187], a[16:19]
v_mfma_f32_16x16x32_bf16 a[16:19], v[228:231], v[188:191], a[16:19]
ds_read_b64_tr_b16 v[244:245], v22 offset:40960
v_mfma_f32_16x16x32_bf16 a[20:23], v[228:231], v[180:183], a[20:23]
v_mfma_f32_16x16x32_bf16 a[20:23], v[224:227], v[176:179], a[20:23]
s_add_u32 s72, s69, 47104
buffer_load_dwordx4 v2, s[8:11], s72 offen offset:2048 lds
v_mfma_f32_16x16x32_bf16 a[24:27], v[224:227], v[168:171], a[24:27]
ds_read_b64_tr_b16 v[246:247], v22 offset:41984
v_mfma_f32_16x16x32_bf16 a[24:27], v[228:231], v[172:175], a[24:27]
v_mfma_f32_16x16x32_bf16 a[28:31], v[228:231], v[164:167], a[28:31]
v_mfma_f32_16x16x32_bf16 a[28:31], v[224:227], v[160:163], a[28:31]
s_waitcnt lgkmcnt(3)
v_mfma_f32_16x16x32_bf16 a[60:63], v[232:235], v[160:163], a[60:63]
s_add_u32 s72, s69, 54272
buffer_load_dwordx4 v3, s[8:11], s72 offen offset:3072 lds
v_mfma_f32_16x16x32_bf16 a[60:63], v[236:239], v[164:167], a[60:63]
ds_read_b64_tr_b16 v[248:249], v23 offset:32768
v_mfma_f32_16x16x32_bf16 a[56:59], v[236:239], v[172:175], a[56:59]
v_mfma_f32_16x16x32_bf16 a[56:59], v[232:235], v[168:171], a[56:59]
s_add_u32 m0, s64, 16384
ds_read_b64_tr_b16 v[250:251], v23 offset:33792
v_mfma_f32_16x16x32_bf16 a[52:55], v[232:235], v[176:179], a[52:55]
s_add_u32 s72, s71, 0
buffer_load_dwordx4 v6, s[20:23], s72 offen lds
v_mfma_f32_16x16x32_bf16 a[52:55], v[236:239], v[180:183], a[52:55]
v_mfma_f32_16x16x32_bf16 a[48:51], v[236:239], v[188:191], a[48:51]
v_mfma_f32_16x16x32_bf16 a[48:51], v[232:235], v[184:187], a[48:51]
ds_read_b64_tr_b16 v[252:253], v23 offset:40960
v_mfma_f32_16x16x32_bf16 a[44:47], v[232:235], v[216:219], a[44:47]
s_add_u32 s72, s71, 31744
buffer_load_dwordx4 v6, s[20:23], s72 offen offset:1024 lds
v_mfma_f32_16x16x32_bf16 a[44:47], v[236:239], v[220:223], a[44:47]
v_mfma_f32_16x16x32_bf16 a[40:43], v[236:239], v[212:215], a[40:43]
ds_read_b64_tr_b16 v[254:255], v23 offset:41984
v_mfma_f32_16x16x32_bf16 a[40:43], v[232:235], v[208:211], a[40:43]
v_mfma_f32_16x16x32_bf16 a[36:39], v[232:235], v[200:203], a[36:39]
s_add_u32 s72, s71, 63488
buffer_load_dwordx4 v7, s[20:23], s72 offen offset:2048 lds
v_mfma_f32_16x16x32_bf16 a[36:39], v[236:239], v[204:207], a[36:39]
v_mfma_f32_16x16x32_bf16 a[32:35], v[236:239], v[196:199], a[32:35]
v_mfma_f32_16x16x32_bf16 a[32:35], v[232:235], v[192:195], a[32:35]
s_waitcnt lgkmcnt(4)
v_mfma_f32_16x16x32_bf16 a[64:67], v[240:243], v[192:195], a[64:67]
s_add_u32 s72, s71, 95232
buffer_load_dwordx4 v7, s[20:23], s72 offen offset:3072 lds
ds_read_b64_tr_b16 v[224:225], v20 offset:49152
v_mfma_f32_16x16x32_bf16 a[64:67], v[244:247], v[196:199], a[64:67]
s_mov_b32 s80, 0x200000
buffer_load_dword v126, v125, s[16:19], s80 offen nt
v_mfma_f32_16x16x32_bf16 a[68:71], v[244:247], v[204:207], a[68:71]
buffer_load_dword v126, v125, s[16:19], s80 offen sc1
v_mfma_f32_16x16x32_bf16 a[68:71], v[240:243], v[200:203], a[68:71]
buffer_load_dword v126, v125, s[20:23], s80 offen nt
ds_read_b64_tr_b16 v[226:227], v20 offset:50176
v_mfma_f32_16x16x32_bf16 a[72:75], v[240:243], v[208:211], a[72:75]
buffer_load_dword v126, v125, s[20:23], s80 offen sc1
v_mfma_f32_16x16x32_bf16 a[72:75], v[244:247], v[212:215], a[72:75]
global_load_dwordx4 v[68:71], v30, s[52:53]
v_mfma_f32_16x16x32_bf16 a[76:79], v[244:247], v[220:223], a[76:79]
buffer_load_dword v33, v27, s[28:31], 0 offen nt
ds_read_b64_tr_b16 v[228:229], v20 offset:57344
v_mfma_f32_16x16x32_bf16 a[76:79], v[240:243], v[216:219], a[76:79]
buffer_load_dword v34, v27, s[28:31], 0 offen offset:2048 nt
v_mfma_f32_16x16x32_bf16 a[80:83], v[240:243], v[184:187], a[80:83]
v_add_u32 v27, 0x1000, v27
v_mfma_f32_16x16x32_bf16 a[80:83], v[244:247], v[188:191], a[80:83]
buffer_load_dword v35, v27, s[28:31], 0 offen nt
v_mfma_f32_16x16x32_bf16 a[84:87], v[244:247], v[180:183], a[84:87]
s_add_u32 m0, s63, 131072
ds_read_b64_tr_b16 v[230:231], v20 offset:58368
v_mfma_f32_16x16x32_bf16 a[84:87], v[240:243], v[176:179], a[84:87]
s_add_u32 s80, s82, 0
buffer_load_dwordx4 v26, s[28:31], s80 offen nt lds
v_mfma_f32_16x16x32_bf16 a[88:91], v[240:243], v[168:171], a[88:91]
s_add_u32 s80, s82, 15360
buffer_load_dwordx4 v26, s[28:31], s80 offen offset:1024 nt lds
v_mfma_f32_16x16x32_bf16 a[88:91], v[244:247], v[172:175], a[88:91]
s_add_u32 s80, s82, 30720
buffer_load_dwordx4 v26, s[28:31], s80 offen offset:2048 nt lds
v_mfma_f32_16x16x32_bf16 a[92:95], v[244:247], v[164:167], a[92:95]
s_add_u32 s80, s82, 46080
buffer_load_dwordx4 v26, s[28:31], s80 offen offset:3072 nt lds
v_mfma_f32_16x16x32_bf16 a[92:95], v[240:243], v[160:163], a[92:95]
s_waitcnt lgkmcnt(4)
v_mfma_f32_16x16x32_bf16 a[124:127], v[248:251], v[160:163], a[124:127]
ds_read_b64_tr_b16 v[232:233], v21 offset:49152
v_mfma_f32_16x16x32_bf16 a[124:127], v[252:255], v[164:167], a[124:127]
v_mfma_f32_16x16x32_bf16 a[120:123], v[252:255], v[172:175], a[120:123]
v_mfma_f32_16x16x32_bf16 a[120:123], v[248:251], v[168:171], a[120:123]
ds_read_b64_tr_b16 v[234:235], v21 offset:50176
v_mfma_f32_16x16x32_bf16 a[116:119], v[248:251], v[176:179], a[116:119]
v_mfma_f32_16x16x32_bf16 a[116:119], v[252:255], v[180:183], a[116:119]
v_mfma_f32_16x16x32_bf16 a[112:115], v[252:255], v[188:191], a[112:115]
v_mfma_f32_16x16x32_bf16 a[112:115], v[248:251], v[184:187], a[112:115]
ds_read_b64_tr_b16 v[236:237], v21 offset:57344
v_mfma_f32_16x16x32_bf16 a[108:111], v[248:251], v[216:219], a[108:111]
v_mfma_f32_16x16x32_bf16 a[108:111], v[252:255], v[220:223], a[108:111]
v_mfma_f32_16x16x32_bf16 a[104:107], v[252:255], v[212:215], a[104:107]
ds_read_b64_tr_b16 v[238:239], v21 offset:58368
v_mfma_f32_16x16x32_bf16 a[104:107], v[248:251], v[208:211], a[104:107]
v_mfma_f32_16x16x32_bf16 a[100:103], v[248:251], v[200:203], a[100:103]
v_mfma_f32_16x16x32_bf16 a[100:103], v[252:255], v[204:207], a[100:103]
v_mfma_f32_16x16x32_bf16 a[96:99], v[252:255], v[196:199], a[96:99]
v_mfma_f32_16x16x32_bf16 a[96:99], v[248:251], v[192:195], a[96:99]
s_waitcnt lgkmcnt(4)
v_mfma_f32_16x16x32_bf16 a[128:131], v[192:195], v[224:227], a[128:131]
ds_read_b64_tr_b16 v[240:241], v22 offset:49152
v_mfma_f32_16x16x32_bf16 a[128:131], v[196:199], v[228:231], a[128:131]
v_mfma_f32_16x16x32_bf16 a[132:135], v[204:207], v[228:231], a[132:135]
v_mfma_f32_16x16x32_bf16 a[132:135], v[200:203], v[224:227], a[132:135]
ds_read_b64_tr_b16 v[242:243], v22 offset:50176
v_mfma_f32_16x16x32_bf16 a[136:139], v[208:211], v[224:227], a[136:139]
v_mfma_f32_16x16x32_bf16 a[136:139], v[212:215], v[228:231], a[136:139]
v_mfma_f32_16x16x32_bf16 a[140:143], v[220:223], v[228:231], a[140:143]
v_mfma_f32_16x16x32_bf16 a[140:143], v[216:219], v[224:227], a[140:143]
ds_read_b64_tr_b16 v[244:245], v22 offset:57344
v_mfma_f32_16x16x32_bf16 a[144:147], v[184:187], v[224:227], a[144:147]
v_mfma_f32_16x16x32_bf16 a[144:147], v[188:191], v[228:231], a[144:147]
v_mfma_f32_16x16x32_bf16 a[148:151], v[180:183], v[228:231], a[148:151]
ds_read_b64_tr_b16 v[246:247], v22 offset:58368
v_mfma_f32_16x16x32_bf16 a[148:151], v[176:179], v[224:227], a[148:151]
v_mfma_f32_16x16x32_bf16 a[152:155], v[168:171], v[224:227], a[152:155]
v_mfma_f32_16x16x32_bf16 a[152:155], v[172:175], v[228:231], a[152:155]
v_mfma_f32_16x16x32_bf16 a[156:159], v[164:167], v[228:231], a[156:159]
v_mfma_f32_16x16x32_bf16 a[156:159], v[160:163], v[224:227], a[156:159]
s_waitcnt lgkmcnt(4)
v_mfma_f32_16x16x32_bf16 a[188:191], v[160:163], v[232:235], a[188:191]
ds_read_b64_tr_b16 v[248:249], v23 offset:49152
v_mfma_f32_16x16x32_bf16 a[188:191], v[164:167], v[236:239], a[188:191]
v_mfma_f32_16x16x32_bf16 a[184:187], v[172:175], v[236:239], a[184:187]
ds_read_b64_tr_b16 v[250:251], v23 offset:50176
v_mfma_f32_16x16x32_bf16 a[184:187], v[168:171], v[232:235], a[184:187]
v_mfma_f32_16x16x32_bf16 a[180:183], v[176:179], v[232:235], a[180:183]
ds_read_b64_tr_b16 v[252:253], v23 offset:57344
v_mfma_f32_16x16x32_bf16 a[180:183], v[180:183], v[236:239], a[180:183]
v_mfma_f32_16x16x32_bf16 a[176:179], v[188:191], v[236:239], a[176:179]
ds_read_b64_tr_b16 v[254:255], v23 offset:58368
v_mfma_f32_16x16x32_bf16 a[176:179], v[184:187], v[232:235], a[176:179]
v_mfma_f32_16x16x32_bf16 a[172:175], v[216:219], v[232:235], a[172:175]
v_mfma_f32_16x16x32_bf16 a[172:175], v[220:223], v[236:239], a[172:175]
v_mfma_f32_16x16x32_bf16 a[168:171], v[212:215], v[236:239], a[168:171]
v_mfma_f32_16x16x32_bf16 a[168:171], v[208:211], v[232:235], a[168:171]
v_mfma_f32_16x16x32_bf16 a[164:167], v[200:203], v[232:235], a[164:167]
v_mfma_f32_16x16x32_bf16 a[164:167], v[204:207], v[236:239], a[164:167]
v_mfma_f32_16x16x32_bf16 a[160:163], v[196:199], v[236:239], a[160:163]
s_waitcnt vmcnt(12) lgkmcnt(0)
v_mfma_f32_16x16x32_bf16 a[160:163], v[192:195], v[232:235], a[160:163]
s_barrier
v_mfma_f32_16x16x32_bf16 a[192:195], v[192:195], v[240:243], a[192:195]
s_and_b32 s73, s65, 1
ds_read_b64_tr_b16 v[224:225], v20 offset:0
v_mfma_f32_16x16x32_bf16 a[192:195], v[196:199], v[244:247], a[192:195]
s_xor_b32 s73, s73, 3
ds_read_b64_tr_b16 v[226:227], v20 offset:1024
v_mfma_f32_16x16x32_bf16 a[196:199], v[204:207], v[244:247], a[196:199]
s_lshl_b32 s69, s73, 7
ds_read_b64_tr_b16 v[228:229], v20 offset:8192
v_mfma_f32_16x16x32_bf16 a[196:199], v[200:203], v[240:243], a[196:199]
s_add_u32 s69, s69, s84
ds_read_b64_tr_b16 v[230:231], v20 offset:9216
v_mfma_f32_16x16x32_bf16 a[200:203], v[208:211], v[240:243], a[200:203]
s_lshl_b32 s71, s73, 19
ds_read_b128 v[128:131], v24 offset:0
v_mfma_f32_16x16x32_bf16 a[200:203], v[212:215], v[244:247], a[200:203]
s_add_u32 s71, s71, s66
ds_read_b128 v[132:135], v25 offset:0
v_mfma_f32_16x16x32_bf16 a[204:207], v[220:223], v[244:247], a[204:207]
s_add_u32 m0, s63, 98304
v_mfma_f32_16x16x32_bf16 a[204:207], v[216:219], v[240:243], a[204:207]
s_add_u32 s72, s69, 0
buffer_load_dwordx4 v2, s[8:11], s72 offen lds
v_mfma_f32_16x16x32_bf16 a[208:211], v[184:187], v[240:243], a[208:211]
s_add_u32 s72, s69, 7168
buffer_load_dwordx4 v3, s[8:11], s72 offen offset:1024 lds
v_mfma_f32_16x16x32_bf16 a[208:211], v[188:191], v[244:247], a[208:211]
s_add_u32 s72, s69, 14336
buffer_load_dwordx4 v2, s[8:11], s72 offen offset:2048 lds
v_mfma_f32_16x16x32_bf16 a[212:215], v[180:183], v[244:247], a[212:215]
ds_read_b128 v[136:139], v24 offset:2048
v_mfma_f32_16x16x32_bf16 a[212:215], v[176:179], v[240:243], a[212:215]
ds_read_b128 v[140:143], v25 offset:2048
v_mfma_f32_16x16x32_bf16 a[216:219], v[168:171], v[240:243], a[216:219]
s_add_u32 s72, s69, 21504
buffer_load_dwordx4 v3, s[8:11], s72 offen offset:3072 lds
v_mfma_f32_16x16x32_bf16 a[216:219], v[172:175], v[244:247], a[216:219]
ds_read_b128 v[144:147], v24 offset:4096
v_mfma_f32_16x16x32_bf16 a[220:223], v[164:167], v[244:247], a[220:223]
ds_read_b128 v[148:151], v25 offset:4096
v_mfma_f32_16x16x32_bf16 a[220:223], v[160:163], v[240:243], a[220:223]
ds_read_b128 v[152:155], v24 offset:6144
v_mfma_f32_16x16x32_bf16 a[252:255], v[160:163], v[248:251], a[252:255]
ds_read_b128 v[156:159], v25 offset:6144
v_mfma_f32_16x16x32_bf16 a[252:255], v[164:167], v[252:255], a[252:255]
s_add_u32 m0, s64, 32768
v_mfma_f32_16x16x32_bf16 a[248:251], v[172:175], v[252:255], a[248:251]
s_add_u32 s72, s71, 0
buffer_load_dwordx4 v6, s[16:19], s72 offen lds
v_mfma_f32_16x16x32_bf16 a[248:251], v[168:171], v[248:251], a[248:251]
ds_read_b128 v[160:163], v24 offset:8192
v_mfma_f32_16x16x32_bf16 a[244:247], v[176:179], v[248:251], a[244:247]
ds_read_b128 v[164:167], v25 offset:8192
v_mfma_f32_16x16x32_bf16 a[244:247], v[180:183], v[252:255], a[244:247]
s_add_u32 s72, s71, 31744
buffer_load_dwordx4 v6, s[16:19], s72 offen offset:1024 lds
v_mfma_f32_16x16x32_bf16 a[240:243], v[188:191], v[252:255], a[240:243]
ds_read_b128 v[168:171], v24 offset:10240
v_mfma_f32_16x16x32_bf16 a[240:243], v[184:187], v[248:251], a[240:243]
ds_read_b128 v[172:175], v25 offset:10240
v_mfma_f32_16x16x32_bf16 a[236:239], v[216:219], v[248:251], a[236:239]
ds_read_b128 v[176:179], v24 offset:12288
v_mfma_f32_16x16x32_bf16 a[236:239], v[220:223], v[252:255], a[236:239]
s_add_u32 s72, s71, 63488
buffer_load_dwordx4 v7, s[16:19], s72 offen offset:2048 lds
v_mfma_f32_16x16x32_bf16 a[232:235], v[212:215], v[252:255], a[232:235]
ds_read_b128 v[180:183], v25 offset:12288
v_mfma_f32_16x16x32_bf16 a[232:235], v[208:211], v[248:251], a[232:235]
ds_read_b128 v[184:187], v24 offset:14336
v_mfma_f32_16x16x32_bf16 a[228:231], v[200:203], v[248:251], a[228:231]
ds_read_b128 v[188:191], v25 offset:14336
v_mfma_f32_16x16x32_bf16 a[228:231], v[204:207], v[252:255], a[228:231]
v_mfma_f32_16x16x32_bf16 a[224:227], v[196:199], v[252:255], a[224:227]
s_add_u32 s72, s71, 95232
buffer_load_dwordx4 v7, s[16:19], s72 offen offset:3072 lds
v_mfma_f32_16x16x32_bf16 a[224:227], v[192:195], v[248:251], a[224:227]
s_waitcnt lgkmcnt(8)
ds_read_b64_tr_b16 v[232:233], v21 offset:0
v_mfma_f32_16x16x32_bf16 a[0:3], v[224:227], v[128:131], a[0:3]
ds_read_b64_tr_b16 v[234:235], v21 offset:1024
v_mfma_f32_16x16x32_bf16 a[0:3], v[228:231], v[132:135], a[0:3]
ds_read_b64_tr_b16 v[240:241], v22 offset:0
v_mfma_f32_16x16x32_bf16 a[4:7], v[228:231], v[140:143], a[4:7]
s_add_u32 m0, s63, 102400
ds_read_b64_tr_b16 v[236:237], v21 offset:8192
v_mfma_f32_16x16x32_bf16 a[4:7], v[224:227], v[136:139], a[4:7]
s_add_u32 s72, s69, 32768
buffer_load_dwordx4 v2, s[8:11], s72 offen lds
v_mfma_f32_16x16x32_bf16 a[8:11], v[224:227], v[144:147], a[8:11]
ds_read_b64_tr_b16 v[238:239], v21 offset:9216
v_mfma_f32_16x16x32_bf16 a[8:11], v[228:231], v[148:151], a[8:11]
v_mfma_f32_16x16x32_bf16 a[12:15], v[228:231], v[156:159], a[12:15]
s_add_u32 s72, s69, 39936
buffer_load_dwordx4 v3, s[8:11], s72 offen offset:1024 lds
v_mfma_f32_16x16x32_bf16 a[12:15], v[224:227], v[152:155], a[12:15]
s_waitcnt lgkmcnt(5)
ds_read_b64_tr_b16 v[242:243], v22 offset:1024
v_mfma_f32_16x16x32_bf16 a[16:19], v[224:227], v[160:163], a[16:19]
v_mfma_f32_16x16x32_bf16 a[16:19], v[228:231], v[164:167], a[16:19]
ds_read_b64_tr_b16 v[244:245], v22 offset:8192
v_mfma_f32_16x16x32_bf16 a[20:23], v[228:231], v[172:175], a[20:23]
v_mfma_f32_16x16x32_bf16 a[20:23], v[224:227], v[168:171], a[20:23]
s_add_u32 s72, s69, 47104
buffer_load_dwordx4 v2, s[8:11], s72 offen offset:2048 lds
v_mfma_f32_16x16x32_bf16 a[24:27], v[224:227], v[176:179], a[24:27]
ds_read_b64_tr_b16 v[246:247], v22 offset:9216
v_mfma_f32_16x16x32_bf16 a[24:27], v[228:231], v[180:183], a[24:27]
v_mfma_f32_16x16x32_bf16 a[28:31], v[228:231], v[188:191], a[28:31]
v_mfma_f32_16x16x32_bf16 a[28:31], v[224:227], v[184:187], a[28:31]
s_waitcnt lgkmcnt(3)
v_mfma_f32_16x16x32_bf16 a[60:63], v[232:235], v[184:187], a[60:63]
s_add_u32 s72, s69, 54272
buffer_load_dwordx4 v3, s[8:11], s72 offen offset:3072 lds
v_mfma_f32_16x16x32_bf16 a[60:63], v[236:239], v[188:191], a[60:63]
ds_read_b64_tr_b16 v[248:249], v23 offset:0
v_mfma_f32_16x16x32_bf16 a[56:59], v[236:239], v[180:183], a[56:59]
v_mfma_f32_16x16x32_bf16 a[56:59], v[232:235], v[176:179], a[56:59]
s_add_u32 m0, s64, 49152
ds_read_b64_tr_b16 v[250:251], v23 offset:1024
v_mfma_f32_16x16x32_bf16 a[52:55], v[232:235], v[168:171], a[52:55]
s_add_u32 s72, s71, 0
buffer_load_dwordx4 v6, s[20:23], s72 offen lds
v_mfma_f32_16x16x32_bf16 a[52:55], v[236:239], v[172:175], a[52:55]
v_mfma_f32_16x16x32_bf16 a[48:51], v[236:239], v[164:167], a[48:51]
v_mfma_f32_16x16x32_bf16 a[48:51], v[232:235], v[160:163], a[48:51]
ds_read_b64_tr_b16 v[252:253], v23 offset:8192
v_mfma_f32_16x16x32_bf16 a[44:47], v[232:235], v[152:155], a[44:47]
s_add_u32 s72, s71, 31744
buffer_load_dwordx4 v6, s[20:23], s72 offen offset:1024 lds
v_mfma_f32_16x16x32_bf16 a[44:47], v[236:239], v[156:159], a[44:47]
v_mfma_f32_16x16x32_bf16 a[40:43], v[236:239], v[148:151], a[40:43]
ds_read_b64_tr_b16 v[254:255], v23 offset:9216
v_mfma_f32_16x16x32_bf16 a[40:43], v[232:235], v[144:147], a[40:43]
v_mfma_f32_16x16x32_bf16 a[36:39], v[232:235], v[136:139], a[36:39]
s_add_u32 s72, s71, 63488
buffer_load_dwordx4 v7, s[20:23], s72 offen offset:2048 lds
v_mfma_f32_16x16x32_bf16 a[36:39], v[236:239], v[140:143], a[36:39]
v_mfma_f32_16x16x32_bf16 a[32:35], v[236:239], v[132:135], a[32:35]
v_mfma_f32_16x16x32_bf16 a[32:35], v[232:235], v[128:131], a[32:35]
s_waitcnt lgkmcnt(4)
v_mfma_f32_16x16x32_bf16 a[64:67], v[240:243], v[128:131], a[64:67]
s_add_u32 s72, s71, 95232
buffer_load_dwordx4 v7, s[20:23], s72 offen offset:3072 lds
v_mfma_f32_16x16x32_bf16 a[64:67], v[244:247], v[132:135], a[64:67]
s_mov_b32 s80, 0x300000
buffer_load_dword v126, v125, s[16:19], s80 offen nt
v_mfma_f32_16x16x32_bf16 a[68:71], v[244:247], v[140:143], a[68:71]
buffer_load_dword v126, v125, s[16:19], s80 offen sc1
v_mfma_f32_16x16x32_bf16 a[68:71], v[240:243], v[136:139], a[68:71]
buffer_load_dword v126, v125, s[20:23], s80 offen nt
v_mfma_f32_16x16x32_bf16 a[72:75], v[240:243], v[144:147], a[72:75]
buffer_load_dword v126, v125, s[20:23], s80 offen sc1
v_mfma_f32_16x16x32_bf16 a[72:75], v[244:247], v[148:151], a[72:75]
s_add_u32 m0, s63, 135168
ds_read_b64_tr_b16 v[224:225], v20 offset:16384
v_mfma_f32_16x16x32_bf16 a[76:79], v[244:247], v[156:159], a[76:79]
s_add_u32 s80, s82, 0
buffer_load_dwordx4 v26, s[32:35], s80 offen nt lds
v_mfma_f32_16x16x32_bf16 a[76:79], v[240:243], v[152:155], a[76:79]
s_add_u32 s80, s82, 15360
buffer_load_dwordx4 v26, s[32:35], s80 offen offset:1024 nt lds
v_mfma_f32_16x16x32_bf16 a[80:83], v[240:243], v[160:163], a[80:83]
s_add_u32 s80, s82, 30720
buffer_load_dwordx4 v26, s[32:35], s80 offen offset:2048 nt lds
v_mfma_f32_16x16x32_bf16 a[80:83], v[244:247], v[164:167], a[80:83]
s_add_u32 s80, s82, 46080
buffer_load_dwordx4 v26, s[32:35], s80 offen offset:3072 nt lds
v_mfma_f32_16x16x32_bf16 a[84:87], v[244:247], v[172:175], a[84:87]
ds_read_b64_tr_b16 v[226:227], v20 offset:17408
v_mfma_f32_16x16x32_bf16 a[84:87], v[240:243], v[168:171], a[84:87]
ds_read_b64_tr_b16 v[228:229], v20 offset:24576
v_mfma_f32_16x16x32_bf16 a[88:91], v[240:243], v[176:179], a[88:91]
ds_read_b64_tr_b16 v[230:231], v20 offset:25600
v_mfma_f32_16x16x32_bf16 a[88:91], v[244:247], v[180:183], a[88:91]
v_mfma_f32_16x16x32_bf16 a[92:95], v[244:247], v[188:191], a[92:95]
v_mfma_f32_16x16x32_bf16 a[92:95], v[240:243], v[184:187], a[92:95]
s_waitcnt lgkmcnt(4)
v_mfma_f32_16x16x32_bf16 a[124:127], v[248:251], v[184:187], a[124:127]
ds_read_b64_tr_b16 v[232:233], v21 offset:16384
v_mfma_f32_16x16x32_bf16 a[124:127], v[252:255], v[188:191], a[124:127]
v_mfma_f32_16x16x32_bf16 a[120:123], v[252:255], v[180:183], a[120:123]
v_mfma_f32_16x16x32_bf16 a[120:123], v[248:251], v[176:179], a[120:123]
ds_read_b64_tr_b16 v[234:235], v21 offset:17408
v_mfma_f32_16x16x32_bf16 a[116:119], v[248:251], v[168:171], a[116:119]
v_mfma_f32_16x16x32_bf16 a[116:119], v[252:255], v[172:175], a[116:119]
v_mfma_f32_16x16x32_bf16 a[112:115], v[252:255], v[164:167], a[112:115]
v_mfma_f32_16x16x32_bf16 a[112:115], v[248:251], v[160:163], a[112:115]
ds_read_b64_tr_b16 v[236:237], v21 offset:24576
v_mfma_f32_16x16x32_bf16 a[108:111], v[248:251], v[152:155], a[108:111]
v_mfma_f32_16x16x32_bf16 a[108:111], v[252:255], v[156:159], a[108:111]
v_mfma_f32_16x16x32_bf16 a[104:107], v[252:255], v[148:151], a[104:107]
ds_read_b64_tr_b16 v[238:239], v21 offset:25600
v_mfma_f32_16x16x32_bf16 a[104:107], v[248:251], v[144:147], a[104:107]
v_mfma_f32_16x16x32_bf16 a[100:103], v[248:251], v[136:139], a[100:103]
v_mfma_f32_16x16x32_bf16 a[100:103], v[252:255], v[140:143], a[100:103]
v_mfma_f32_16x16x32_bf16 a[96:99], v[252:255], v[132:135], a[96:99]
v_mfma_f32_16x16x32_bf16 a[96:99], v[248:251], v[128:131], a[96:99]
s_waitcnt lgkmcnt(4)
v_mfma_f32_16x16x32_bf16 a[128:131], v[128:131], v[224:227], a[128:131]
ds_read_b64_tr_b16 v[240:241], v22 offset:16384
v_mfma_f32_16x16x32_bf16 a[128:131], v[132:135], v[228:231], a[128:131]
v_mfma_f32_16x16x32_bf16 a[132:135], v[140:143], v[228:231], a[132:135]
v_mfma_f32_16x16x32_bf16 a[132:135], v[136:139], v[224:227], a[132:135]
ds_read_b64_tr_b16 v[242:243], v22 offset:17408
v_mfma_f32_16x16x32_bf16 a[136:139], v[144:147], v[224:227], a[136:139]
v_mfma_f32_16x16x32_bf16 a[136:139], v[148:151], v[228:231], a[136:139]
v_mfma_f32_16x16x32_bf16 a[140:143], v[156:159], v[228:231], a[140:143]
v_mfma_f32_16x16x32_bf16 a[140:143], v[152:155], v[224:227], a[140:143]
ds_read_b64_tr_b16 v[244:245], v22 offset:24576
v_mfma_f32_16x16x32_bf16 a[144:147], v[160:163], v[224:227], a[144:147]
v_mfma_f32_16x16x32_bf16 a[144:147], v[164:167], v[228:231], a[144:147]
v_mfma_f32_16x16x32_bf16 a[148:151], v[172:175], v[228:231], a[148:151]
ds_read_b64_tr_b16 v[246:247], v22 offset:25600
v_mfma_f32_16x16x32_bf16 a[148:151], v[168:171], v[224:227], a[148:151]
v_mfma_f32_16x16x32_bf16 a[152:155], v[176:179], v[224:227], a[152:155]
v_mfma_f32_16x16x32_bf16 a[152:155], v[180:183], v[228:231], a[152:155]
v_mfma_f32_16x16x32_bf16 a[156:159], v[188:191], v[228:231], a[156:159]
v_mfma_f32_16x16x32_bf16 a[156:159], v[184:187], v[224:227], a[156:159]
s_waitcnt lgkmcnt(4)
v_mfma_f32_16x16x32_bf16 a[188:191], v[184:187], v[232:235], a[188:191]
ds_read_b64_tr_b16 v[248:249], v23 offset:16384
v_mfma_f32_16x16x32_bf16 a[188:191], v[188:191], v[236:239], a[188:191]
v_mfma_f32_16x16x32_bf16 a[184:187], v[180:183], v[236:239], a[184:187]
ds_read_b64_tr_b16 v[250:251], v23 offset:17408
v_mfma_f32_16x16x32_bf16 a[184:187], v[176:179], v[232:235], a[184:187]
v_mfma_f32_16x16x32_bf16 a[180:183], v[168:171], v[232:235], a[180:183]
ds_read_b64_tr_b16 v[252:253], v23 offset:24576
v_mfma_f32_16x16x32_bf16 a[180:183], v[172:175], v[236:239], a[180:183]
v_mfma_f32_16x16x32_bf16 a[176:179], v[164:167], v[236:239], a[176:179]
ds_read_b64_tr_b16 v[254:255], v23 offset:25600
v_mfma_f32_16x16x32_bf16 a[176:179], v[160:163], v[232:235], a[176:179]
v_mfma_f32_16x16x32_bf16 a[172:175], v[152:155], v[232:235], a[172:175]
v_mfma_f32_16x16x32_bf16 a[172:175], v[156:159], v[236:239], a[172:175]
v_mfma_f32_16x16x32_bf16 a[168:171], v[148:151], v[236:239], a[168:171]
v_mfma_f32_16x16x32_bf16 a[168:171], v[144:147], v[232:235], a[168:171]
v_mfma_f32_16x16x32_bf16 a[164:167], v[136:139], v[232:235], a[164:167]
v_mfma_f32_16x16x32_bf16 a[164:167], v[140:143], v[236:239], a[164:167]
v_mfma_f32_16x16x32_bf16 a[160:163], v[132:135], v[236:239], a[160:163]
s_waitcnt vmcnt(8) lgkmcnt(0)
v_mfma_f32_16x16x32_bf16 a[160:163], v[128:131], v[232:235], a[160:163]
s_barrier
v_mfma_f32_16x16x32_bf16 a[192:195], v[128:131], v[240:243], a[192:195]
s_and_b32 s73, s65, 1
ds_read_b64_tr_b16 v[224:225], v20 offset:32768
v_mfma_f32_16x16x32_bf16 a[192:195], v[132:135], v[244:247], a[192:195]
s_xor_b32 s73, s73, 4
ds_read_b64_tr_b16 v[226:227], v20 offset:33792
v_mfma_f32_16x16x32_bf16 a[196:199], v[140:143], v[244:247], a[196:199]
s_lshl_b32 s69, s73, 7
ds_read_b64_tr_b16 v[228:229], v20 offset:40960
v_mfma_f32_16x16x32_bf16 a[196:199], v[136:139], v[240:243], a[196:199]
s_add_u32 s69, s69, s84
ds_read_b64_tr_b16 v[230:231], v20 offset:41984
v_mfma_f32_16x16x32_bf16 a[200:203], v[144:147], v[240:243], a[200:203]
s_lshl_b32 s71, s73, 19
ds_read_b128 v[192:195], v24 offset:32768
v_mfma_f32_16x16x32_bf16 a[200:203], v[148:151], v[244:247], a[200:203]
s_add_u32 s71, s71, s66
ds_read_b128 v[196:199], v25 offset:32768
v_mfma_f32_16x16x32_bf16 a[204:207], v[156:159], v[244:247], a[204:207]
s_add_u32 m0, s63, 65536
v_mfma_f32_16x16x32_bf16 a[204:207], v[152:155], v[240:243], a[204:207]
s_add_u32 s72, s69, 0
buffer_load_dwordx4 v2, s[8:11], s72 offen lds
v_mfma_f32_16x16x32_bf16 a[208:211], v[160:163], v[240:243], a[208:211]
s_add_u32 s72, s69, 7168
buffer_load_dwordx4 v3, s[8:11], s72 offen offset:1024 lds
v_mfma_f32_16x16x32_bf16 a[208:211], v[164:167], v[244:247], a[208:211]
s_add_u32 s72, s69, 14336
buffer_load_dwordx4 v2, s[8:11], s72 offen offset:2048 lds
v_mfma_f32_16x16x32_bf16 a[212:215], v[172:175], v[244:247], a[212:215]
ds_read_b128 v[200:203], v24 offset:34816
v_mfma_f32_16x16x32_bf16 a[212:215], v[168:171], v[240:243], a[212:215]
ds_read_b128 v[204:207], v25 offset:34816
v_mfma_f32_16x16x32_bf16 a[216:219], v[176:179], v[240:243], a[216:219]
s_add_u32 s72, s69, 21504
buffer_load_dwordx4 v3, s[8:11], s72 offen offset:3072 lds
v_mfma_f32_16x16x32_bf16 a[216:219], v[180:183], v[244:247], a[216:219]
ds_read_b128 v[208:211], v24 offset:36864
v_mfma_f32_16x16x32_bf16 a[220:223], v[188:191], v[244:247], a[220:223]
ds_read_b128 v[212:215], v25 offset:36864
v_mfma_f32_16x16x32_bf16 a[220:223], v[184:187], v[240:243], a[220:223]
ds_read_b128 v[216:219], v24 offset:38912
v_mfma_f32_16x16x32_bf16 a[252:255], v[184:187], v[248:251], a[252:255]
ds_read_b128 v[220:223], v25 offset:38912
v_mfma_f32_16x16x32_bf16 a[252:255], v[188:191], v[252:255], a[252:255]
s_add_u32 m0, s64, 0
v_mfma_f32_16x16x32_bf16 a[248:251], v[180:183], v[252:255], a[248:251]
s_add_u32 s72, s71, 0
buffer_load_dwordx4 v6, s[16:19], s72 offen lds
v_mfma_f32_16x16x32_bf16 a[248:251], v[176:179], v[248:251], a[248:251]
ds_read_b128 v[184:187], v24 offset:40960
v_mfma_f32_16x16x32_bf16 a[244:247], v[168:171], v[248:251], a[244:247]
ds_read_b128 v[188:191], v25 offset:40960
v_mfma_f32_16x16x32_bf16 a[244:247], v[172:175], v[252:255], a[244:247]
s_add_u32 s72, s71, 31744
buffer_load_dwordx4 v6, s[16:19], s72 offen offset:1024 lds
v_mfma_f32_16x16x32_bf16 a[240:243], v[164:167], v[252:255], a[240:243]
ds_read_b128 v[176:179], v24 offset:43008
v_mfma_f32_16x16x32_bf16 a[240:243], v[160:163], v[248:251], a[240:243]
ds_read_b128 v[180:183], v25 offset:43008
v_mfma_f32_16x16x32_bf16 a[236:239], v[152:155], v[248:251], a[236:239]
ds_read_b128 v[168:171], v24 offset:45056
v_mfma_f32_16x16x32_bf16 a[236:239], v[156:159], v[252:255], a[236:239]
s_add_u32 s72, s71, 63488
buffer_load_dwordx4 v7, s[16:19], s72 offen offset:2048 lds
v_mfma_f32_16x16x32_bf16 a[232:235], v[148:151], v[252:255], a[232:235]
ds_read_b128 v[172:175], v25 offset:45056
v_mfma_f32_16x16x32_bf16 a[232:235], v[144:147], v[248:251], a[232:235]
ds_read_b128 v[160:163], v24 offset:47104
v_mfma_f32_16x16x32_bf16 a[228:231], v[136:139], v[248:251], a[228:231]
ds_read_b128 v[164:167], v25 offset:47104
v_mfma_f32_16x16x32_bf16 a[228:231], v[140:143], v[252:255], a[228:231]
v_mfma_f32_16x16x32_bf16 a[224:227], v[132:135], v[252:255], a[224:227]
s_add_u32 s72, s71, 95232
buffer_load_dwordx4 v7, s[16:19], s72 offen offset:3072 lds
v_mfma_f32_16x16x32_bf16 a[224:227], v[128:131], v[248:251], a[224:227]
s_waitcnt lgkmcnt(8)
ds_read_b64_tr_b16 v[232:233], v21 offset:32768
v_mfma_f32_16x16x32_bf16 a[0:3], v[224:227], v[192:195], a[0:3]
ds_read_b64_tr_b16 v[234:235], v21 offset:33792
v_mfma_f32_16x16x32_bf16 a[0:3], v[228:231], v[196:199], a[0:3]
ds_read_b64_tr_b16 v[240:241], v22 offset:32768
v_mfma_f32_16x16x32_bf16 a[4:7], v[228:231], v[204:207], a[4:7]
s_add_u32 m0, s63, 69632
ds_read_b64_tr_b16 v[236:237], v21 offset:40960
v_mfma_f32_16x16x32_bf16 a[4:7], v[224:227], v[200:203], a[4:7]
s_add_u32 s72, s69, 32768
buffer_load_dwordx4 v2, s[8:11], s72 offen lds
v_mfma_f32_16x16x32_bf16 a[8:11], v[224:227], v[208:211], a[8:11]
ds_read_b64_tr_b16 v[238:239], v21 offset:41984
v_mfma_f32_16x16x32_bf16 a[8:11], v[228:231], v[212:215], a[8:11]
v_mfma_f32_16x16x32_bf16 a[12:15], v[228:231], v[220:223], a[12:15]
s_add_u32 s72, s69, 39936
buffer_load_dwordx4 v3, s[8:11], s72 offen offset:1024 lds
v_mfma_f32_16x16x32_bf16 a[12:15], v[224:227], v[216:219], a[12:15]
s_waitcnt lgkmcnt(5)
ds_read_b64_tr_b16 v[242:243], v22 offset:33792
v_mfma_f32_16x16x32_bf16 a[16:19], v[224:227], v[184:187], a[16:19]
v_mfma_f32_16x16x32_bf16 a[16:19], v[228:231], v[188:191], a[16:19]
ds_read_b64_tr_b16 v[244:245], v22 offset:40960
v_mfma_f32_16x16x32_bf16 a[20:23], v[228:231], v[180:183], a[20:23]
v_mfma_f32_16x16x32_bf16 a[20:23], v[224:227], v[176:179], a[20:23]
s_add_u32 s72, s69, 47104
buffer_load_dwordx4 v2, s[8:11], s72 offen offset:2048 lds
v_mfma_f32_16x16x32_bf16 a[24:27], v[224:227], v[168:171], a[24:27]
ds_read_b64_tr_b16 v[246:247], v22 offset:41984
v_mfma_f32_16x16x32_bf16 a[24:27], v[228:231], v[172:175], a[24:27]
v_mfma_f32_16x16x32_bf16 a[28:31], v[228:231], v[164:167], a[28:31]
v_mfma_f32_16x16x32_bf16 a[28:31], v[224:227], v[160:163], a[28:31]
s_waitcnt lgkmcnt(3)
v_mfma_f32_16x16x32_bf16 a[60:63], v[232:235], v[160:163], a[60:63]
s_add_u32 s72, s69, 54272
buffer_load_dwordx4 v3, s[8:11], s72 offen offset:3072 lds
v_mfma_f32_16x16x32_bf16 a[60:63], v[236:239], v[164:167], a[60:63]
ds_read_b64_tr_b16 v[248:249], v23 offset:32768
v_mfma_f32_16x16x32_bf16 a[56:59], v[236:239], v[172:175], a[56:59]
v_mfma_f32_16x16x32_bf16 a[56:59], v[232:235], v[168:171], a[56:59]
s_add_u32 m0, s64, 16384
ds_read_b64_tr_b16 v[250:251], v23 offset:33792
v_mfma_f32_16x16x32_bf16 a[52:55], v[232:235], v[176:179], a[52:55]
s_add_u32 s72, s71, 0
buffer_load_dwordx4 v6, s[20:23], s72 offen lds
v_mfma_f32_16x16x32_bf16 a[52:55], v[236:239], v[180:183], a[52:55]
v_mfma_f32_16x16x32_bf16 a[48:51], v[236:239], v[188:191], a[48:51]
v_mfma_f32_16x16x32_bf16 a[48:51], v[232:235], v[184:187], a[48:51]
ds_read_b64_tr_b16 v[252:253], v23 offset:40960
v_mfma_f32_16x16x32_bf16 a[44:47], v[232:235], v[216:219], a[44:47]
s_add_u32 s72, s71, 31744
buffer_load_dwordx4 v6, s[20:23], s72 offen offset:1024 lds
v_mfma_f32_16x16x32_bf16 a[44:47], v[236:239], v[220:223], a[44:47]
v_mfma_f32_16x16x32_bf16 a[40:43], v[236:239], v[212:215], a[40:43]
ds_read_b64_tr_b16 v[254:255], v23 offset:41984
v_mfma_f32_16x16x32_bf16 a[40:43], v[232:235], v[208:211], a[40:43]
v_mfma_f32_16x16x32_bf16 a[36:39], v[232:235], v[200:203], a[36:39]
s_add_u32 s72, s71, 63488
buffer_load_dwordx4 v7, s[20:23], s72 offen offset:2048 lds
v_mfma_f32_16x16x32_bf16 a[36:39], v[236:239], v[204:207], a[36:39]
v_mfma_f32_16x16x32_bf16 a[32:35], v[236:239], v[196:199], a[32:35]
v_mfma_f32_16x16x32_bf16 a[32:35], v[232:235], v[192:195], a[32:35]
s_waitcnt lgkmcnt(4)
v_mfma_f32_16x16x32_bf16 a[64:67], v[240:243], v[192:195], a[64:67]
s_add_u32 s72, s71, 95232
buffer_load_dwordx4 v7, s[20:23], s72 offen offset:3072 lds
v_mfma_f32_16x16x32_bf16 a[64:67], v[244:247], v[196:199], a[64:67]
buffer_load_dwordx4 v[108:111], v1, s[4:7], s76 offen
v_mfma_f32_16x16x32_bf16 a[68:71], v[244:247], v[204:207], a[68:71]
buffer_load_dwordx4 v[112:115], v1, s[4:7], s76 offen offset:1024
v_mfma_f32_16x16x32_bf16 a[68:71], v[240:243], v[200:203], a[68:71]
buffer_load_dwordx4 v[116:119], v1, s[4:7], s76 offen offset:2048
v_mfma_f32_16x16x32_bf16 a[72:75], v[240:243], v[208:211], a[72:75]
buffer_load_dwordx4 v[120:123], v1, s[4:7], s76 offen offset:3072
v_mfma_f32_16x16x32_bf16 a[72:75], v[244:247], v[212:215], a[72:75]
ds_read_b64_tr_b16 v[224:225], v20 offset:49152
v_mfma_f32_16x16x32_bf16 a[76:79], v[244:247], v[220:223], a[76:79]
v_mfma_f32_16x16x32_bf16 a[76:79], v[240:243], v[216:219], a[76:79]
ds_read_b64_tr_b16 v[226:227], v20 offset:50176
v_mfma_f32_16x16x32_bf16 a[80:83], v[240:243], v[184:187], a[80:83]
v_mfma_f32_16x16x32_bf16 a[80:83], v[244:247], v[188:191], a[80:83]
ds_read_b64_tr_b16 v[228:229], v20 offset:57344
v_mfma_f32_16x16x32_bf16 a[84:87], v[244:247], v[180:183], a[84:87]
v_mfma_f32_16x16x32_bf16 a[84:87], v[240:243], v[176:179], a[84:87]
ds_read_b64_tr_b16 v[230:231], v20 offset:58368
v_mfma_f32_16x16x32_bf16 a[88:91], v[240:243], v[168:171], a[88:91]
v_mfma_f32_16x16x32_bf16 a[88:91], v[244:247], v[172:175], a[88:91]
v_mfma_f32_16x16x32_bf16 a[92:95], v[244:247], v[164:167], a[92:95]
v_mfma_f32_16x16x32_bf16 a[92:95], v[240:243], v[160:163], a[92:95]
s_waitcnt lgkmcnt(4)
v_mfma_f32_16x16x32_bf16 a[124:127], v[248:251], v[160:163], a[124:127]
ds_read_b64_tr_b16 v[232:233], v21 offset:49152
v_mfma_f32_16x16x32_bf16 a[124:127], v[252:255], v[164:167], a[124:127]
v_mfma_f32_16x16x32_bf16 a[120:123], v[252:255], v[172:175], a[120:123]
v_mfma_f32_16x16x32_bf16 a[120:123], v[248:251], v[168:171], a[120:123]
ds_read_b64_tr_b16 v[234:235], v21 offset:50176
v_mfma_f32_16x16x32_bf16 a[116:119], v[248:251], v[176:179], a[116:119]
s_waitcnt vmcnt(20)
ds_read2_b32 v[36:37], v98 offset0:0 offset1:32
ds_read2_b32 v[38:39], v98 offset0:64 offset1:96
v_mfma_f32_16x16x32_bf16 a[116:119], v[252:255], v[180:183], a[116:119]
ds_read2_b32 v[40:41], v98 offset0:128 offset1:160
ds_read2_b32 v[42:43], v98 offset0:192 offset1:224
v_mfma_f32_16x16x32_bf16 a[112:115], v[252:255], v[188:191], a[112:115]
v_add_u32 v98, 1024, v98
v_mfma_f32_16x16x32_bf16 a[112:115], v[248:251], v[184:187], a[112:115]
ds_read_b64_tr_b16 v[236:237], v21 offset:57344
ds_read2_b32 v[44:45], v98 offset0:0 offset1:32
v_mfma_f32_16x16x32_bf16 a[108:111], v[248:251], v[216:219], a[108:111]
ds_read2_b32 v[46:47], v98 offset0:64 offset1:96
ds_read2_b32 v[48:49], v98 offset0:128 offset1:160
v_mfma_f32_16x16x32_bf16 a[108:111], v[252:255], v[220:223], a[108:111]
ds_read2_b32 v[50:51], v98 offset0:192 offset1:224
v_add_u32 v98, 3072, v98
v_mfma_f32_16x16x32_bf16 a[104:107], v[252:255], v[212:215], a[104:107]
ds_read_b64_tr_b16 v[238:239], v21 offset:58368
ds_read2_b32 v[52:53], v98 offset0:0 offset1:32
v_mfma_f32_16x16x32_bf16 a[104:107], v[248:251], v[208:211], a[104:107]
ds_read2_b32 v[54:55], v98 offset0:64 offset1:96
ds_read2_b32 v[56:57], v98 offset0:128 offset1:160
v_mfma_f32_16x16x32_bf16 a[100:103], v[248:251], v[200:203], a[100:103]
ds_read2_b32 v[58:59], v98 offset0:192 offset1:224
v_add_u32 v98, 1024, v98
v_mfma_f32_16x16x32_bf16 a[100:103], v[252:255], v[204:207], a[100:103]
ds_read2_b32 v[60:61], v98 offset0:0 offset1:32
ds_read2_b32 v[62:63], v98 offset0:64 offset1:96
v_mfma_f32_16x16x32_bf16 a[96:99], v[252:255], v[196:199], a[96:99]
ds_read2_b32 v[64:65], v98 offset0:128 offset1:160
ds_read2_b32 v[66:67], v98 offset0:192 offset1:224
v_mfma_f32_16x16x32_bf16 a[96:99], v[248:251], v[192:195], a[96:99]
s_waitcnt lgkmcnt(15)
v_mfma_f32_16x16x32_bf16 a[128:131], v[192:195], v[224:227], a[128:131]
ds_read_b64_tr_b16 v[240:241], v22 offset:49152
v_mfma_f32_16x16x32_bf16 a[128:131], v[196:199], v[228:231], a[128:131]
v_mfma_f32_16x16x32_bf16 a[132:135], v[204:207], v[228:231], a[132:135]
v_mfma_f32_16x16x32_bf16 a[132:135], v[200:203], v[224:227], a[132:135]
ds_read_b64_tr_b16 v[242:243], v22 offset:50176
v_mfma_f32_16x16x32_bf16 a[136:139], v[208:211], v[224:227], a[136:139]
v_mfma_f32_16x16x32_bf16 a[136:139], v[212:215], v[228:231], a[136:139]
v_mfma_f32_16x16x32_bf16 a[140:143], v[220:223], v[228:231], a[140:143]
v_mfma_f32_16x16x32_bf16 a[140:143], v[216:219], v[224:227], a[140:143]
ds_read_b64_tr_b16 v[244:245], v22 offset:57344
v_mfma_f32_16x16x32_bf16 a[144:147], v[184:187], v[224:227], a[144:147]
v_mfma_f32_16x16x32_bf16 a[144:147], v[188:191], v[228:231], a[144:147]
v_mfma_f32_16x16x32_bf16 a[148:151], v[180:183], v[228:231], a[148:151]
ds_read_b64_tr_b16 v[246:247], v22 offset:58368
v_mfma_f32_16x16x32_bf16 a[148:151], v[176:179], v[224:227], a[148:151]
v_mfma_f32_16x16x32_bf16 a[152:155], v[168:171], v[224:227], a[152:155]
v_mfma_f32_16x16x32_bf16 a[152:155], v[172:175], v[228:231], a[152:155]
v_mfma_f32_16x16x32_bf16 a[156:159], v[164:167], v[228:231], a[156:159]
v_mfma_f32_16x16x32_bf16 a[156:159], v[160:163], v[224:227], a[156:159]
s_waitcnt lgkmcnt(12)
v_mfma_f32_16x16x32_bf16 a[188:191], v[160:163], v[232:235], a[188:191]
ds_read_b64_tr_b16 v[248:249], v23 offset:49152
v_mfma_f32_16x16x32_bf16 a[188:191], v[164:167], v[236:239], a[188:191]
v_mfma_f32_16x16x32_bf16 a[184:187], v[172:175], v[236:239], a[184:187]
ds_read_b64_tr_b16 v[250:251], v23 offset:50176
v_mfma_f32_16x16x32_bf16 a[184:187], v[168:171], v[232:235], a[184:187]
v_mfma_f32_16x16x32_bf16 a[180:183], v[176:179], v[232:235], a[180:183]
ds_read_b64_tr_b16 v[252:253], v23 offset:57344
v_mfma_f32_16x16x32_bf16 a[180:183], v[180:183], v[236:239], a[180:183]
v_mfma_f32_16x16x32_bf16 a[176:179], v[188:191], v[236:239], a[176:179]
ds_read_b64_tr_b16 v[254:255], v23 offset:58368
v_mfma_f32_16x16x32_bf16 a[176:179], v[184:187], v[232:235], a[176:179]
v_mfma_f32_16x16x32_bf16 a[172:175], v[216:219], v[232:235], a[172:175]
v_mfma_f32_16x16x32_bf16 a[172:175], v[220:223], v[236:239], a[172:175]
v_mfma_f32_16x16x32_bf16 a[168:171], v[212:215], v[236:239], a[168:171]
v_mfma_f32_16x16x32_bf16 a[168:171], v[208:211], v[232:235], a[168:171]
v_mfma_f32_16x16x32_bf16 a[164:167], v[200:203], v[232:235], a[164:167]
v_mfma_f32_16x16x32_bf16 a[164:167], v[204:207], v[236:239], a[164:167]
v_mfma_f32_16x16x32_bf16 a[160:163], v[196:199], v[236:239], a[160:163]
s_waitcnt vmcnt(4) lgkmcnt(0)
v_mfma_f32_16x16x32_bf16 a[160:163], v[192:195], v[232:235], a[160:163]
s_barrier
v_mfma_f32_16x16x32_bf16 a[192:195], v[192:195], v[240:243], a[192:195]
s_and_b32 s73, s65, 1
ds_read_b64_tr_b16 v[224:225], v20 offset:0
v_lshlrev_b32 v72, 16, v68
v_mfma_f32_16x16x32_bf16 a[192:195], v[196:199], v[244:247], a[192:195]
s_xor_b32 s73, s73, 5
ds_read_b64_tr_b16 v[226:227], v20 offset:1024
v_and_b32 v73, 0xffff0000, v68
v_mfma_f32_16x16x32_bf16 a[196:199], v[204:207], v[244:247], a[196:199]
s_lshl_b32 s69, s73, 7
ds_read_b64_tr_b16 v[228:229], v20 offset:8192
v_lshlrev_b32 v74, 16, v69
v_mfma_f32_16x16x32_bf16 a[196:199], v[200:203], v[240:243], a[196:199]
s_add_u32 s69, s69, s84
ds_read_b64_tr_b16 v[230:231], v20 offset:9216
v_and_b32 v75, 0xffff0000, v69
v_mfma_f32_16x16x32_bf16 a[200:203], v[208:211], v[240:243], a[200:203]
s_lshl_b32 s71, s73, 19
ds_read_b128 v[128:131], v24 offset:0
v_lshlrev_b32 v76, 16, v33
v_mfma_f32_16x16x32_bf16 a[200:203], v[212:215], v[244:247], a[200:203]
s_add_u32 s71, s71, s66
ds_read_b128 v[132:135], v25 offset:0
v_lshlrev_b32 v77, 16, v34
v_mfma_f32_16x16x32_bf16 a[204:207], v[220:223], v[244:247], a[204:207]
s_add_u32 m0, s63, 98304
v_lshlrev_b32 v78, 16, v35
v_lshlrev_b32 v79, 16, v36
v_mfma_f32_16x16x32_bf16 a[204:207], v[216:219], v[240:243], a[204:207]
s_add_u32 s72, s69, 0
buffer_load_dwordx4 v2, s[8:11], s72 offen lds
v_mfma_f32_16x16x32_bf16 a[208:211], v[184:187], v[240:243], a[208:211]
s_add_u32 s72, s69, 7168
buffer_load_dwordx4 v3, s[8:11], s72 offen offset:1024 lds
v_mfma_f32_16x16x32_bf16 a[208:211], v[188:191], v[244:247], a[208:211]
s_add_u32 s72, s69, 14336
buffer_load_dwordx4 v2, s[8:11], s72 offen offset:2048 lds
v_mfma_f32_16x16x32_bf16 a[212:215], v[180:183], v[244:247], a[212:215]
ds_read_b128 v[136:139], v24 offset:2048
v_lshlrev_b32 v80, 16, v37
v_mfma_f32_16x16x32_bf16 a[212:215], v[176:179], v[240:243], a[212:215]
ds_read_b128 v[140:143], v25 offset:2048
v_lshlrev_b32 v81, 16, v38
v_mfma_f32_16x16x32_bf16 a[216:219], v[168:171], v[240:243], a[216:219]
s_add_u32 s72, s69, 21504
buffer_load_dwordx4 v3, s[8:11], s72 offen offset:3072 lds
v_mfma_f32_16x16x32_bf16 a[216:219], v[172:175], v[244:247], a[216:219]
ds_read_b128 v[144:147], v24 offset:4096
v_lshlrev_b32 v82, 16, v39
v_mfma_f32_16x16x32_bf16 a[220:223], v[164:167], v[244:247], a[220:223]
ds_read_b128 v[148:151], v25 offset:4096
v_lshlrev_b32 v83, 16, v40
v_mfma_f32_16x16x32_bf16 a[220:223], v[160:163], v[240:243], a[220:223]
ds_read_b128 v[152:155], v24 offset:6144
v_lshlrev_b32 v84, 16, v41
v_mfma_f32_16x16x32_bf16 a[252:255], v[160:163], v[248:251], a[252:255]
ds_read_b128 v[156:159], v25 offset:6144
v_lshlrev_b32 v85, 16, v42
v_mfma_f32_16x16x32_bf16 a[252:255], v[164:167], v[252:255], a[252:255]
s_add_u32 m0, s64, 32768
v_lshlrev_b32 v86, 16, v43
v_lshlrev_b32 v87, 16, v44
v_mfma_f32_16x16x32_bf16 a[248:251], v[172:175], v[252:255], a[248:251]
s_add_u32 s72, s71, 0
buffer_load_dwordx4 v6, s[16:19], s72 offen lds
v_mfma_f32_16x16x32_bf16 a[248:251], v[168:171], v[248:251], a[248:251]
ds_read_b128 v[160:163], v24 offset:8192
v_lshlrev_b32 v88, 16, v45
v_mfma_f32_16x16x32_bf16 a[244:247], v[176:179], v[248:251], a[244:247]
ds_read_b128 v[164:167], v25 offset:8192
v_lshlrev_b32 v89, 16, v46
v_mfma_f32_16x16x32_bf16 a[244:247], v[180:183], v[252:255], a[244:247]
s_add_u32 s72, s71, 31744
buffer_load_dwordx4 v6, s[16:19], s72 offen offset:1024 lds
v_mfma_f32_16x16x32_bf16 a[240:243], v[188:191], v[252:255], a[240:243]
ds_read_b128 v[168:171], v24 offset:10240
v_lshlrev_b32 v90, 16, v47
v_mfma_f32_16x16x32_bf16 a[240:243], v[184:187], v[248:251], a[240:243]
ds_read_b128 v[172:175], v25 offset:10240
v_lshlrev_b32 v91, 16, v48
v_mfma_f32_16x16x32_bf16 a[236:239], v[216:219], v[248:251], a[236:239]
ds_read_b128 v[176:179], v24 offset:12288
v_lshlrev_b32 v92, 16, v49
v_mfma_f32_16x16x32_bf16 a[236:239], v[220:223], v[252:255], a[236:239]
s_add_u32 s72, s71, 63488
buffer_load_dwordx4 v7, s[16:19], s72 offen offset:2048 lds
v_mfma_f32_16x16x32_bf16 a[232:235], v[212:215], v[252:255], a[232:235]
ds_read_b128 v[180:183], v25 offset:12288
v_lshlrev_b32 v93, 16, v50
v_mfma_f32_16x16x32_bf16 a[232:235], v[208:211], v[248:251], a[232:235]
ds_read_b128 v[184:187], v24 offset:14336
v_lshlrev_b32 v94, 16, v51
v_mfma_f32_16x16x32_bf16 a[228:231], v[200:203], v[248:251], a[228:231]
ds_read_b128 v[188:191], v25 offset:14336
v_mul_f32 v95, v75, v91
v_mfma_f32_16x16x32_bf16 a[228:231], v[204:207], v[252:255], a[228:231]
v_lshlrev_b32 v97, 16, v67
v_fmac_f32 v95, v74, v92
v_mfma_f32_16x16x32_bf16 a[224:227], v[196:199], v[252:255], a[224:227]
s_add_u32 s72, s71, 95232
buffer_load_dwordx4 v7, s[16:19], s72 offen offset:3072 lds
v_mfma_f32_16x16x32_bf16 a[224:227], v[192:195], v[248:251], a[224:227]
s_waitcnt lgkmcnt(8)
ds_read_b64_tr_b16 v[232:233], v21 offset:0
v_fmac_f32 v95, v73, v93
v_mfma_f32_16x16x32_bf16 a[0:3], v[224:227], v[128:131], a[0:3]
ds_read_b64_tr_b16 v[234:235], v21 offset:1024
v_fmac_f32 v95, v72, v94
v_mfma_f32_16x16x32_bf16 a[0:3], v[228:231], v[132:135], a[0:3]
ds_read_b64_tr_b16 v[240:241], v22 offset:0
v_mul_f32 v95, v95, v97
v_mfma_f32_16x16x32_bf16 a[4:7], v[228:231], v[140:143], a[4:7]
s_add_u32 m0, s63, 102400
ds_read_b64_tr_b16 v[236:237], v21 offset:8192
v_mul_f32 v96, v75, v90
v_mfma_f32_16x16x32_bf16 a[4:7], v[224:227], v[136:139], a[4:7]
s_add_u32 s72, s69, 32768
buffer_load_dwordx4 v2, s[8:11], s72 offen lds
v_mfma_f32_16x16x32_bf16 a[8:11], v[224:227], v[144:147], a[8:11]
ds_read_b64_tr_b16 v[238:239], v21 offset:9216
v_lshlrev_b32 v97, 16, v66
v_mfma_f32_16x16x32_bf16 a[8:11], v[228:231], v[148:151], a[8:11]
v_fmac_f32 v96, v74, v91
v_fmac_f32 v96, v73, v92
v_mfma_f32_16x16x32_bf16 a[12:15], v[228:231], v[156:159], a[12:15]
s_add_u32 s72, s69, 39936
buffer_load_dwordx4 v3, s[8:11], s72 offen offset:1024 lds
v_mfma_f32_16x16x32_bf16 a[12:15], v[224:227], v[152:155], a[12:15]
s_waitcnt lgkmcnt(5)
ds_read_b64_tr_b16 v[242:243], v22 offset:1024
v_fmac_f32 v96, v72, v93
v_mfma_f32_16x16x32_bf16 a[16:19], v[224:227], v[160:163], a[16:19]
v_mul_f32 v96, v96, v97
v_cvt_pk_bf16_f32 v100, v95, v96
v_mfma_f32_16x16x32_bf16 a[16:19], v[228:231], v[164:167], a[16:19]
ds_read_b64_tr_b16 v[244:245], v22 offset:8192
v_mul_f32 v95, v75, v89
v_mfma_f32_16x16x32_bf16 a[20:23], v[228:231], v[172:175], a[20:23]
v_lshlrev_b32 v97, 16, v65
v_fmac_f32 v95, v74, v90
v_mfma_f32_16x16x32_bf16 a[20:23], v[224:227], v[168:171], a[20:23]
s_add_u32 s72, s69, 47104
buffer_load_dwordx4 v2, s[8:11], s72 offen offset:2048 lds
v_mfma_f32_16x16x32_bf16 a[24:27], v[224:227], v[176:179], a[24:27]
ds_read_b64_tr_b16 v[246:247], v22 offset:9216
v_fmac_f32 v95, v73, v91
v_mfma_f32_16x16x32_bf16 a[24:27], v[228:231], v[180:183], a[24:27]
v_fmac_f32 v95, v72, v92
v_mul_f32 v95, v95, v97
v_mfma_f32_16x16x32_bf16 a[28:31], v[228:231], v[188:191], a[28:31]
v_mul_f32 v96, v75, v88
v_lshlrev_b32 v97, 16, v64
v_mfma_f32_16x16x32_bf16 a[28:31], v[224:227], v[184:187], a[28:31]
s_waitcnt lgkmcnt(3)
v_fmac_f32 v96, v74, v89
v_fmac_f32 v96, v73, v90
v_mfma_f32_16x16x32_bf16 a[60:63], v[232:235], v[184:187], a[60:63]
s_add_u32 s72, s69, 54272
buffer_load_dwordx4 v3, s[8:11], s72 offen offset:3072 lds
v_mfma_f32_16x16x32_bf16 a[60:63], v[236:239], v[188:191], a[60:63]
ds_read_b64_tr_b16 v[248:249], v23 offset:0
v_fmac_f32 v96, v72, v91
v_mfma_f32_16x16x32_bf16 a[56:59], v[236:239], v[180:183], a[56:59]
v_mul_f32 v96, v96, v97
v_cvt_pk_bf16_f32 v101, v95, v96
v_mfma_f32_16x16x32_bf16 a[56:59], v[232:235], v[176:179], a[56:59]
s_add_u32 m0, s64, 49152
ds_read_b64_tr_b16 v[250:251], v23 offset:1024
v_mul_f32 v95, v75, v87
v_mfma_f32_16x16x32_bf16 a[52:55], v[232:235], v[168:171], a[52:55]
s_add_u32 s72, s71, 0
buffer_load_dwordx4 v6, s[20:23], s72 offen lds
v_mfma_f32_16x16x32_bf16 a[52:55], v[236:239], v[172:175], a[52:55]
v_lshlrev_b32 v97, 16, v63
v_fmac_f32 v95, v74, v88
v_mfma_f32_16x16x32_bf16 a[48:51], v[236:239], v[164:167], a[48:51]
v_fmac_f32 v95, v73, v89
v_fmac_f32 v95, v72, v90
v_mfma_f32_16x16x32_bf16 a[48:51], v[232:235], v[160:163], a[48:51]
ds_read_b64_tr_b16 v[252:253], v23 offset:8192
v_mul_f32 v95, v95, v97
v_mfma_f32_16x16x32_bf16 a[44:47], v[232:235], v[152:155], a[44:47]
s_add_u32 s72, s71, 31744
buffer_load_dwordx4 v6, s[20:23], s72 offen offset:1024 lds
v_mfma_f32_16x16x32_bf16 a[44:47], v[236:239], v[156:159], a[44:47]
v_mul_f32 v96, v75, v86
v_lshlrev_b32 v97, 16, v62
v_mfma_f32_16x16x32_bf16 a[40:43], v[236:239], v[148:151], a[40:43]
ds_read_b64_tr_b16 v[254:255], v23 offset:9216
v_fmac_f32 v96, v74, v87
v_mfma_f32_16x16x32_bf16 a[40:43], v[232:235], v[144:147], a[40:43]
v_fmac_f32 v96, v73, v88
v_fmac_f32 v96, v72, v89
v_mfma_f32_16x16x32_bf16 a[36:39], v[232:235], v[136:139], a[36:39]
s_add_u32 s72, s71, 63488
buffer_load_dwordx4 v7, s[20:23], s72 offen offset:2048 lds
v_mfma_f32_16x16x32_bf16 a[36:39], v[236:239], v[140:143], a[36:39]
v_mul_f32 v96, v96, v97
v_cvt_pk_bf16_f32 v102, v95, v96
v_mfma_f32_16x16x32_bf16 a[32:35], v[236:239], v[132:135], a[32:35]
v_mul_f32 v95, v75, v85
v_lshlrev_b32 v97, 16, v61
v_mfma_f32_16x16x32_bf16 a[32:35], v[232:235], v[128:131], a[32:35]
s_waitcnt lgkmcnt(4)
v_fmac_f32 v95, v74, v86
v_fmac_f32 v95, v73, v87
v_mfma_f32_16x16x32_bf16 a[64:67], v[240:243], v[128:131], a[64:67]
s_add_u32 s72, s71, 95232
buffer_load_dwordx4 v7, s[20:23], s72 offen offset:3072 lds
v_mfma_f32_16x16x32_bf16 a[64:67], v[244:247], v[132:135], a[64:67]
s_mov_b32 s80, 0x0
buffer_load_dword v126, v125, s[12:15], s80 offen
v_mfma_f32_16x16x32_bf16 a[68:71], v[244:247], v[140:143], a[68:71]
s_mov_b32 s80, 0x100000
buffer_load_dword v126, v125, s[12:15], s80 offen
v_mfma_f32_16x16x32_bf16 a[68:71], v[240:243], v[136:139], a[68:71]
s_mov_b32 s80, 0x200000
buffer_load_dword v126, v125, s[12:15], s80 offen
v_mfma_f32_16x16x32_bf16 a[72:75], v[240:243], v[144:147], a[72:75]
s_mov_b32 s80, 0x300000
buffer_load_dword v126, v125, s[12:15], s80 offen
v_mfma_f32_16x16x32_bf16 a[72:75], v[244:247], v[148:151], a[72:75]
ds_read_b64_tr_b16 v[224:225], v20 offset:16384
v_fmac_f32 v95, v72, v88
v_mfma_f32_16x16x32_bf16 a[76:79], v[244:247], v[156:159], a[76:79]
v_mul_f32 v95, v95, v97
v_mul_f32 v96, v75, v84
v_mfma_f32_16x16x32_bf16 a[76:79], v[240:243], v[152:155], a[76:79]
ds_read_b64_tr_b16 v[226:227], v20 offset:17408
v_lshlrev_b32 v97, 16, v60
v_mfma_f32_16x16x32_bf16 a[80:83], v[240:243], v[160:163], a[80:83]
v_fmac_f32 v96, v74, v85
v_fmac_f32 v96, v73, v86
v_mfma_f32_16x16x32_bf16 a[80:83], v[244:247], v[164:167], a[80:83]
ds_read_b64_tr_b16 v[228:229], v20 offset:24576
v_fmac_f32 v96, v72, v87
v_mfma_f32_16x16x32_bf16 a[84:87], v[244:247], v[172:175], a[84:87]
v_mul_f32 v96, v96, v97
v_cvt_pk_bf16_f32 v103, v95, v96
v_mfma_f32_16x16x32_bf16 a[84:87], v[240:243], v[168:171], a[84:87]
ds_read_b64_tr_b16 v[230:231], v20 offset:25600
ds_write_b128 v28, v[100:103] offset:0
v_mfma_f32_16x16x32_bf16 a[88:91], v[240:243], v[176:179], a[88:91]
v_mul_f32 v95, v75, v83
v_lshlrev_b32 v97, 16, v59
v_mfma_f32_16x16x32_bf16 a[88:91], v[244:247], v[180:183], a[88:91]
v_fmac_f32 v95, v74, v84
v_fmac_f32 v95, v73, v85
v_mfma_f32_16x16x32_bf16 a[92:95], v[244:247], v[188:191], a[92:95]
v_fmac_f32 v95, v72, v86
v_mul_f32 v95, v95, v97
v_mfma_f32_16x16x32_bf16 a[92:95], v[240:243], v[184:187], a[92:95]
s_waitcnt lgkmcnt(5)
v_mul_f32 v96, v75, v82
v_lshlrev_b32 v97, 16, v58
v_mfma_f32_16x16x32_bf16 a[124:127], v[248:251], v[184:187], a[124:127]
ds_read_b64_tr_b16 v[232:233], v21 offset:16384
v_fmac_f32 v96, v74, v83
v_mfma_f32_16x16x32_bf16 a[124:127], v[252:255], v[188:191], a[124:127]
v_fmac_f32 v96, v73, v84
v_fmac_f32 v96, v72, v85
v_mfma_f32_16x16x32_bf16 a[120:123], v[252:255], v[180:183], a[120:123]
v_mul_f32 v96, v96, v97
v_cvt_pk_bf16_f32 v104, v95, v96
v_mfma_f32_16x16x32_bf16 a[120:123], v[248:251], v[176:179], a[120:123]
ds_read_b64_tr_b16 v[234:235], v21 offset:17408
v_mul_f32 v95, v75, v81
v_mfma_f32_16x16x32_bf16 a[116:119], v[248:251], v[168:171], a[116:119]
v_lshlrev_b32 v97, 16, v57
v_fmac_f32 v95, v74, v82
v_mfma_f32_16x16x32_bf16 a[116:119], v[252:255], v[172:175], a[116:119]
v_fmac_f32 v95, v73, v83
v_fmac_f32 v95, v72, v84
v_mfma_f32_16x16x32_bf16 a[112:115], v[252:255], v[164:167], a[112:115]
v_mul_f32 v95, v95, v97
v_mul_f32 v96, v75, v80
v_mfma_f32_16x16x32_bf16 a[112:115], v[248:251], v[160:163], a[112:115]
ds_read_b64_tr_b16 v[236:237], v21 offset:24576
v_lshlrev_b32 v97, 16, v56
v_mfma_f32_16x16x32_bf16 a[108:111], v[248:251], v[152:155], a[108:111]
v_fmac_f32 v96, v74, v81
v_fmac_f32 v96, v73, v82
v_mfma_f32_16x16x32_bf16 a[108:111], v[252:255], v[156:159], a[108:111]
v_fmac_f32 v96, v72, v83
v_mul_f32 v96, v96, v97
v_mfma_f32_16x16x32_bf16 a[104:107], v[252:255], v[148:151], a[104:107]
ds_read_b64_tr_b16 v[238:239], v21 offset:25600
v_cvt_pk_bf16_f32 v105, v95, v96
v_mfma_f32_16x16x32_bf16 a[104:107], v[248:251], v[144:147], a[104:107]
v_mul_f32 v95, v75, v79
v_lshlrev_b32 v97, 16, v55
v_mfma_f32_16x16x32_bf16 a[100:103], v[248:251], v[136:139], a[100:103]
v_fmac_f32 v95, v74, v80
v_fmac_f32 v95, v73, v81
v_mfma_f32_16x16x32_bf16 a[100:103], v[252:255], v[140:143], a[100:103]
v_fmac_f32 v95, v72, v82
v_mul_f32 v95, v95, v97
v_mfma_f32_16x16x32_bf16 a[96:99], v[252:255], v[132:135], a[96:99]
v_mul_f32 v96, v75, v78
v_lshlrev_b32 v97, 16, v54
v_mfma_f32_16x16x32_bf16 a[96:99], v[248:251], v[128:131], a[96:99]
s_waitcnt lgkmcnt(5)
v_fmac_f32 v96, v74, v79
v_fmac_f32 v96, v73, v80
v_mfma_f32_16x16x32_bf16 a[128:131], v[128:131], v[224:227], a[128:131]
ds_read_b64_tr_b16 v[240:241], v22 offset:16384
v_fmac_f32 v96, v72, v81
v_mfma_f32_16x16x32_bf16 a[128:131], v[132:135], v[228:231], a[128:131]
v_mul_f32 v96, v96, v97
v_cvt_pk_bf16_f32 v106, v95, v96
v_mfma_f32_16x16x32_bf16 a[132:135], v[140:143], v[228:231], a[132:135]
v_mul_f32 v95, v75, v77
v_lshlrev_b32 v97, 16, v53
v_mfma_f32_16x16x32_bf16 a[132:135], v[136:139], v[224:227], a[132:135]
ds_read_b64_tr_b16 v[242:243], v22 offset:17408
v_fmac_f32 v95, v74, v78
v_mfma_f32_16x16x32_bf16 a[136:139], v[144:147], v[224:227], a[136:139]
v_fmac_f32 v95, v73, v79
v_fmac_f32 v95, v72, v80
v_mfma_f32_16x16x32_bf16 a[136:139], v[148:151], v[228:231], a[136:139]
v_mul_f32 v95, v95, v97
v_mul_f32 v96, v75, v76
v_mfma_f32_16x16x32_bf16 a[140:143], v[156:159], v[228:231], a[140:143]
v_lshlrev_b32 v97, 16, v52
v_fmac_f32 v96, v74, v77
v_mfma_f32_16x16x32_bf16 a[140:143], v[152:155], v[224:227], a[140:143]
ds_read_b64_tr_b16 v[244:245], v22 offset:24576
v_fmac_f32 v96, v73, v78
v_mfma_f32_16x16x32_bf16 a[144:147], v[160:163], v[224:227], a[144:147]
v_fmac_f32 v96, v72, v79
v_mul_f32 v96, v96, v97
v_mfma_f32_16x16x32_bf16 a[144:147], v[164:167], v[228:231], a[144:147]
v_cvt_pk_bf16_f32 v107, v95, v96
v_mfma_f32_16x16x32_bf16 a[148:151], v[172:175], v[228:231], a[148:151]
ds_read_b64_tr_b16 v[246:247], v22 offset:25600
ds_write_b128 v28, v[104:107] offset:16
v_mfma_f32_16x16x32_bf16 a[148:151], v[168:171], v[224:227], a[148:151]
global_load_dwordx4 v[84:87], v1, s[56:57]
v_mfma_f32_16x16x32_bf16 a[152:155], v[176:179], v[224:227], a[152:155]
global_load_dwordx4 v[88:91], v1, s[56:57] offset:1024
v_mfma_f32_16x16x32_bf16 a[152:155], v[180:183], v[228:231], a[152:155]
v_lshlrev_b32 v72, 16, v70
v_and_b32 v73, 0xffff0000, v70
v_mfma_f32_16x16x32_bf16 a[156:159], v[188:191], v[228:231], a[156:159]
v_lshlrev_b32 v74, 16, v71
v_and_b32 v75, 0xffff0000, v71
v_mfma_f32_16x16x32_bf16 a[156:159], v[184:187], v[224:227], a[156:159]
s_waitcnt lgkmcnt(5)
v_and_b32 v33, 0xffff0000, v33
v_and_b32 v34, 0xffff0000, v34
v_mfma_f32_16x16x32_bf16 a[188:191], v[184:187], v[232:235], a[188:191]
ds_read_b64_tr_b16 v[248:249], v23 offset:16384
v_and_b32 v35, 0xffff0000, v35
v_mfma_f32_16x16x32_bf16 a[188:191], v[188:191], v[236:239], a[188:191]
v_and_b32 v36, 0xffff0000, v36
v_and_b32 v37, 0xffff0000, v37
v_mfma_f32_16x16x32_bf16 a[184:187], v[180:183], v[236:239], a[184:187]
ds_read_b64_tr_b16 v[250:251], v23 offset:17408
v_and_b32 v38, 0xffff0000, v38
v_mfma_f32_16x16x32_bf16 a[184:187], v[176:179], v[232:235], a[184:187]
v_and_b32 v39, 0xffff0000, v39
v_and_b32 v40, 0xffff0000, v40
v_mfma_f32_16x16x32_bf16 a[180:183], v[168:171], v[232:235], a[180:183]
ds_read_b64_tr_b16 v[252:253], v23 offset:24576
v_and_b32 v41, 0xffff0000, v41
v_mfma_f32_16x16x32_bf16 a[180:183], v[172:175], v[236:239], a[180:183]
v_and_b32 v42, 0xffff0000, v42
v_and_b32 v43, 0xffff0000, v43
v_mfma_f32_16x16x32_bf16 a[176:179], v[164:167], v[236:239], a[176:179]
ds_read_b64_tr_b16 v[254:255], v23 offset:25600
v_and_b32 v44, 0xffff0000, v44
v_mfma_f32_16x16x32_bf16 a[176:179], v[160:163], v[232:235], a[176:179]
v_and_b32 v45, 0xffff0000, v45
v_and_b32 v46, 0xffff0000, v46
v_mfma_f32_16x16x32_bf16 a[172:175], v[152:155], v[232:235], a[172:175]
v_and_b32 v47, 0xffff0000, v47
v_and_b32 v48, 0xffff0000, v48
v_mfma_f32_16x16x32_bf16 a[172:175], v[156:159], v[236:239], a[172:175]
v_and_b32 v49, 0xffff0000, v49
v_and_b32 v50, 0xffff0000, v50
v_mfma_f32_16x16x32_bf16 a[168:171], v[148:151], v[236:239], a[168:171]
v_and_b32 v51, 0xffff0000, v51
v_mul_f32 v95, v75, v48
v_mfma_f32_16x16x32_bf16 a[168:171], v[144:147], v[232:235], a[168:171]
v_and_b32 v97, 0xffff0000, v67
v_fmac_f32 v95, v74, v49
v_mfma_f32_16x16x32_bf16 a[164:167], v[136:139], v[232:235], a[164:167]
v_fmac_f32 v95, v73, v50
v_fmac_f32 v95, v72, v51
v_mfma_f32_16x16x32_bf16 a[164:167], v[140:143], v[236:239], a[164:167]
v_mul_f32 v95, v95, v97
v_mul_f32 v96, v75, v47
v_mfma_f32_16x16x32_bf16 a[160:163], v[132:135], v[236:239], a[160:163]
s_waitcnt vmcnt(6) lgkmcnt(0)
v_and_b32 v97, 0xffff0000, v66
v_fmac_f32 v96, v74, v48
v_mfma_f32_16x16x32_bf16 a[160:163], v[128:131], v[232:235], a[160:163]
s_barrier
v_fmac_f32 v96, v73, v49
v_fmac_f32 v96, v72, v50
v_mfma_f32_16x16x32_bf16 a[192:195], v[128:131], v[240:243], a[192:195]
s_and_b32 s73, s65, 1
ds_read_b64_tr_b16 v[224:225], v20 offset:32768
v_mul_f32 v96, v96, v97
v_mfma_f32_16x16x32_bf16 a[192:195], v[132:135], v[244:247], a[192:195]
s_xor_b32 s73, s73, 6
ds_read_b64_tr_b16 v[226:227], v20 offset:33792
v_cvt_pk_bf16_f32 v100, v95, v96
v_mfma_f32_16x16x32_bf16 a[196:199], v[140:143], v[244:247], a[196:199]
s_lshl_b32 s69, s73, 7
ds_read_b64_tr_b16 v[228:229], v20 offset:40960
v_mul_f32 v95, v75, v46
v_mfma_f32_16x16x32_bf16 a[196:199], v[136:139], v[240:243], a[196:199]
s_add_u32 s69, s69, s84
ds_read_b64_tr_b16 v[230:231], v20 offset:41984
v_and_b32 v97, 0xffff0000, v65
v_mfma_f32_16x16x32_bf16 a[200:203], v[144:147], v[240:243], a[200:203]
s_lshl_b32 s71, s73, 19
ds_read_b128 v[192:195], v24 offset:32768
v_fmac_f32 v95, v74, v47
v_mfma_f32_16x16x32_bf16 a[200:203], v[148:151], v[244:247], a[200:203]
s_add_u32 s71, s71, s66
ds_read_b128 v[196:199], v25 offset:32768
v_fmac_f32 v95, v73, v48
v_mfma_f32_16x16x32_bf16 a[204:207], v[156:159], v[244:247], a[204:207]
s_add_u32 m0, s63, 65536
v_fmac_f32 v95, v72, v49
v_mul_f32 v95, v95, v97
v_mfma_f32_16x16x32_bf16 a[204:207], v[152:155], v[240:243], a[204:207]
s_add_u32 s72, s69, 0
buffer_load_dwordx4 v2, s[8:11], s72 offen lds
v_mfma_f32_16x16x32_bf16 a[208:211], v[160:163], v[240:243], a[208:211]
s_add_u32 s72, s69, 7168
buffer_load_dwordx4 v3, s[8:11], s72 offen offset:1024 lds
v_mfma_f32_16x16x32_bf16 a[208:211], v[164:167], v[244:247], a[208:211]
s_add_u32 s72, s69, 14336
buffer_load_dwordx4 v2, s[8:11], s72 offen offset:2048 lds
v_mfma_f32_16x16x32_bf16 a[212:215], v[172:175], v[244:247], a[212:215]
ds_read_b128 v[200:203], v24 offset:34816
v_mul_f32 v96, v75, v45
v_mfma_f32_16x16x32_bf16 a[212:215], v[168:171], v[240:243], a[212:215]
ds_read_b128 v[204:207], v25 offset:34816
v_and_b32 v97, 0xffff0000, v64
v_mfma_f32_16x16x32_bf16 a[216:219], v[176:179], v[240:243], a[216:219]
s_add_u32 s72, s69, 21504
buffer_load_dwordx4 v3, s[8:11], s72 offen offset:3072 lds
v_mfma_f32_16x16x32_bf16 a[216:219], v[180:183], v[244:247], a[216:219]
ds_read_b128 v[208:211], v24 offset:36864
v_fmac_f32 v96, v74, v46
v_mfma_f32_16x16x32_bf16 a[220:223], v[188:191], v[244:247], a[220:223]
ds_read_b128 v[212:215], v25 offset:36864
v_fmac_f32 v96, v73, v47
v_mfma_f32_16x16x32_bf16 a[220:223], v[184:187], v[240:243], a[220:223]
ds_read_b128 v[216:219], v24 offset:38912
v_fmac_f32 v96, v72, v48
v_mfma_f32_16x16x32_bf16 a[252:255], v[184:187], v[248:251], a[252:255]
ds_read_b128 v[220:223], v25 offset:38912
v_mul_f32 v96, v96, v97
v_mfma_f32_16x16x32_bf16 a[252:255], v[188:191], v[252:255], a[252:255]
s_add_u32 m0, s64, 0
v_cvt_pk_bf16_f32 v101, v95, v96
v_mul_f32 v95, v75, v44
v_mfma_f32_16x16x32_bf16 a[248:251], v[180:183], v[252:255], a[248:251]
s_add_u32 s72, s71, 0
buffer_load_dwordx4 v6, s[16:19], s72 offen lds
v_mfma_f32_16x16x32_bf16 a[248:251], v[176:179], v[248:251], a[248:251]
ds_read_b128 v[184:187], v24 offset:40960
v_and_b32 v97, 0xffff0000, v63
v_mfma_f32_16x16x32_bf16 a[244:247], v[168:171], v[248:251], a[244:247]
ds_read_b128 v[188:191], v25 offset:40960
v_fmac_f32 v95, v74, v45
v_mfma_f32_16x16x32_bf16 a[244:247], v[172:175], v[252:255], a[244:247]
s_add_u32 s72, s71, 31744
buffer_load_dwordx4 v6, s[16:19], s72 offen offset:1024 lds
v_mfma_f32_16x16x32_bf16 a[240:243], v[164:167], v[252:255], a[240:243]
ds_read_b128 v[176:179], v24 offset:43008
v_fmac_f32 v95, v73, v46
v_mfma_f32_16x16x32_bf16 a[240:243], v[160:163], v[248:251], a[240:243]
ds_read_b128 v[180:183], v25 offset:43008
v_fmac_f32 v95, v72, v47
v_mfma_f32_16x16x32_bf16 a[236:239], v[152:155], v[248:251], a[236:239]
ds_read_b128 v[168:171], v24 offset:45056
v_mul_f32 v95, v95, v97
v_mfma_f32_16x16x32_bf16 a[236:239], v[156:159], v[252:255], a[236:239]
s_add_u32 s72, s71, 63488
buffer_load_dwordx4 v7, s[16:19], s72 offen offset:2048 lds
v_mfma_f32_16x16x32_bf16 a[232:235], v[148:151], v[252:255], a[232:235]
ds_read_b128 v[172:175], v25 offset:45056
v_mul_f32 v96, v75, v43
v_mfma_f32_16x16x32_bf16 a[232:235], v[144:147], v[248:251], a[232:235]
ds_read_b128 v[160:163], v24 offset:47104
v_and_b32 v97, 0xffff0000, v62
v_mfma_f32_16x16x32_bf16 a[228:231], v[136:139], v[248:251], a[228:231]
ds_read_b128 v[164:167], v25 offset:47104
v_fmac_f32 v96, v74, v44
v_mfma_f32_16x16x32_bf16 a[228:231], v[140:143], v[252:255], a[228:231]
v_fmac_f32 v96, v73, v45
v_fmac_f32 v96, v72, v46
v_mfma_f32_16x16x32_bf16 a[224:227], v[132:135], v[252:255], a[224:227]
s_add_u32 s72, s71, 95232
buffer_load_dwordx4 v7, s[16:19], s72 offen offset:3072 lds
v_mfma_f32_16x16x32_bf16 a[224:227], v[128:131], v[248:251], a[224:227]
s_waitcnt lgkmcnt(8)
ds_read_b64_tr_b16 v[232:233], v21 offset:32768
v_mul_f32 v96, v96, v97
v_mfma_f32_16x16x32_bf16 a[0:3], v[224:227], v[192:195], a[0:3]
ds_read_b64_tr_b16 v[234:235], v21 offset:33792
v_cvt_pk_bf16_f32 v102, v95, v96
v_mfma_f32_16x16x32_bf16 a[0:3], v[228:231], v[196:199], a[0:3]
ds_read_b64_tr_b16 v[240:241], v22 offset:32768
v_mul_f32 v95, v75, v42
v_mfma_f32_16x16x32_bf16 a[4:7], v[228:231], v[204:207], a[4:7]
s_add_u32 m0, s63, 69632
ds_read_b64_tr_b16 v[236:237], v21 offset:40960
v_and_b32 v97, 0xffff0000, v61
v_mfma_f32_16x16x32_bf16 a[4:7], v[224:227], v[200:203], a[4:7]
s_add_u32 s72, s69, 32768
buffer_load_dwordx4 v2, s[8:11], s72 offen lds
v_mfma_f32_16x16x32_bf16 a[8:11], v[224:227], v[208:211], a[8:11]
ds_read_b64_tr_b16 v[238:239], v21 offset:41984
v_fmac_f32 v95, v74, v43
v_mfma_f32_16x16x32_bf16 a[8:11], v[228:231], v[212:215], a[8:11]
v_fmac_f32 v95, v73, v44
v_fmac_f32 v95, v72, v45
v_mfma_f32_16x16x32_bf16 a[12:15], v[228:231], v[220:223], a[12:15]
s_add_u32 s72, s69, 39936
buffer_load_dwordx4 v3, s[8:11], s72 offen offset:1024 lds
v_mfma_f32_16x16x32_bf16 a[12:15], v[224:227], v[216:219], a[12:15]
s_waitcnt lgkmcnt(5)
ds_read_b64_tr_b16 v[242:243], v22 offset:33792
v_mul_f32 v95, v95, v97
v_mfma_f32_16x16x32_bf16 a[16:19], v[224:227], v[184:187], a[16:19]
v_mul_f32 v96, v75, v41
v_and_b32 v97, 0xffff0000, v60
v_mfma_f32_16x16x32_bf16 a[16:19], v[228:231], v[188:191], a[16:19]
ds_read_b64_tr_b16 v[244:245], v22 offset:40960
v_fmac_f32 v96, v74, v42
v_mfma_f32_16x16x32_bf16 a[20:23], v[228:231], v[180:183], a[20:23]
v_fmac_f32 v96, v73, v43
v_fmac_f32 v96, v72, v44
v_mfma_f32_16x16x32_bf16 a[20:23], v[224:227], v[176:179], a[20:23]
s_add_u32 s72, s69, 47104
buffer_load_dwordx4 v2, s[8:11], s72 offen offset:2048 lds
v_mfma_f32_16x16x32_bf16 a[24:27], v[224:227], v[168:171], a[24:27]
ds_read_b64_tr_b16 v[246:247], v22 offset:41984
v_mul_f32 v96, v96, v97
v_mfma_f32_16x16x32_bf16 a[24:27], v[228:231], v[172:175], a[24:27]
v_cvt_pk_bf16_f32 v103, v95, v96
v_mfma_f32_16x16x32_bf16 a[28:31], v[228:231], v[164:167], a[28:31]
ds_write_b128 v28, v[100:103] offset:272
v_mul_f32 v95, v75, v40
v_mfma_f32_16x16x32_bf16 a[28:31], v[224:227], v[160:163], a[28:31]
s_waitcnt lgkmcnt(4)
v_and_b32 v97, 0xffff0000, v59
v_fmac_f32 v95, v74, v41
v_mfma_f32_16x16x32_bf16 a[60:63], v[232:235], v[160:163], a[60:63]
s_add_u32 s72, s69, 54272
buffer_load_dwordx4 v3, s[8:11], s72 offen offset:3072 lds
v_mfma_f32_16x16x32_bf16 a[60:63], v[236:239], v[164:167], a[60:63]
ds_read_b64_tr_b16 v[248:249], v23 offset:32768
v_fmac_f32 v95, v73, v42
v_mfma_f32_16x16x32_bf16 a[56:59], v[236:239], v[172:175], a[56:59]
v_fmac_f32 v95, v72, v43
v_mul_f32 v95, v95, v97
v_mfma_f32_16x16x32_bf16 a[56:59], v[232:235], v[168:171], a[56:59]
s_add_u32 m0, s64, 16384
ds_read_b64_tr_b16 v[250:251], v23 offset:33792
v_mul_f32 v96, v75, v39
v_mfma_f32_16x16x32_bf16 a[52:55], v[232:235], v[176:179], a[52:55]
s_add_u32 s72, s71, 0
buffer_load_dwordx4 v6, s[20:23], s72 offen lds
v_mfma_f32_16x16x32_bf16 a[52:55], v[236:239], v[180:183], a[52:55]
v_and_b32 v97, 0xffff0000, v58
v_fmac_f32 v96, v74, v40
v_mfma_f32_16x16x32_bf16 a[48:51], v[236:239], v[188:191], a[48:51]
v_fmac_f32 v96, v73, v41
v_fmac_f32 v96, v72, v42
v_mfma_f32_16x16x32_bf16 a[48:51], v[232:235], v[184:187], a[48:51]
ds_read_b64_tr_b16 v[252:253], v23 offset:40960
v_mul_f32 v96, v96, v97
v_mfma_f32_16x16x32_bf16 a[44:47], v[232:235], v[216:219], a[44:47]
s_add_u32 s72, s71, 31744
buffer_load_dwordx4 v6, s[20:23], s72 offen offset:1024 lds
v_mfma_f32_16x16x32_bf16 a[44:47], v[236:239], v[220:223], a[44:47]
v_cvt_pk_bf16_f32 v104, v95, v96
v_mul_f32 v95, v75, v38
v_mfma_f32_16x16x32_bf16 a[40:43], v[236:239], v[212:215], a[40:43]
ds_read_b64_tr_b16 v[254:255], v23 offset:41984
v_and_b32 v97, 0xffff0000, v57
v_mfma_f32_16x16x32_bf16 a[40:43], v[232:235], v[208:211], a[40:43]
v_fmac_f32 v95, v74, v39
v_fmac_f32 v95, v73, v40
v_mfma_f32_16x16x32_bf16 a[36:39], v[232:235], v[200:203], a[36:39]
s_add_u32 s72, s71, 63488
buffer_load_dwordx4 v7, s[20:23], s72 offen offset:2048 lds
v_mfma_f32_16x16x32_bf16 a[36:39], v[236:239], v[204:207], a[36:39]
v_fmac_f32 v95, v72, v41
v_mul_f32 v95, v95, v97
v_mfma_f32_16x16x32_bf16 a[32:35], v[236:239], v[196:199], a[32:35]
v_mul_f32 v96, v75, v37
v_and_b32 v97, 0xffff0000, v56
v_mfma_f32_16x16x32_bf16 a[32:35], v[232:235], v[192:195], a[32:35]
s_waitcnt lgkmcnt(5)
v_fmac_f32 v96, v74, v38
v_fmac_f32 v96, v73, v39
v_mfma_f32_16x16x32_bf16 a[64:67], v[240:243], v[192:195], a[64:67]
s_add_u32 s72, s71, 95232
buffer_load_dwordx4 v7, s[20:23], s72 offen offset:3072 lds
v_mfma_f32_16x16x32_bf16 a[64:67], v[244:247], v[196:199], a[64:67]
s_mov_b32 s80, 0x400000
buffer_load_dword v126, v125, s[12:15], s80 offen
v_mfma_f32_16x16x32_bf16 a[68:71], v[244:247], v[204:207], a[68:71]
s_mov_b32 s80, 0x500000
buffer_load_dword v126, v125, s[12:15], s80 offen
v_mfma_f32_16x16x32_bf16 a[68:71], v[240:243], v[200:203], a[68:71]
s_mov_b32 s80, 0x600000
buffer_load_dword v126, v125, s[12:15], s80 offen
v_mfma_f32_16x16x32_bf16 a[72:75], v[240:243], v[208:211], a[72:75]
s_mov_b32 s80, 0x700000
buffer_load_dword v126, v125, s[12:15], s80 offen
v_mfma_f32_16x16x32_bf16 a[72:75], v[244:247], v[212:215], a[72:75]
ds_read_b64_tr_b16 v[224:225], v20 offset:49152
v_fmac_f32 v96, v72, v40
v_mfma_f32_16x16x32_bf16 a[76:79], v[244:247], v[220:223], a[76:79]
v_mul_f32 v96, v96, v97
v_cvt_pk_bf16_f32 v105, v95, v96
v_mfma_f32_16x16x32_bf16 a[76:79], v[240:243], v[216:219], a[76:79]
ds_read_b64_tr_b16 v[226:227], v20 offset:50176
v_mul_f32 v95, v75, v36
v_mfma_f32_16x16x32_bf16 a[80:83], v[240:243], v[184:187], a[80:83]
v_and_b32 v97, 0xffff0000, v55
v_fmac_f32 v95, v74, v37
v_mfma_f32_16x16x32_bf16 a[80:83], v[244:247], v[188:191], a[80:83]
ds_read_b64_tr_b16 v[228:229], v20 offset:57344
v_fmac_f32 v95, v73, v38
v_mfma_f32_16x16x32_bf16 a[84:87], v[244:247], v[180:183], a[84:87]
v_fmac_f32 v95, v72, v39
v_mul_f32 v95, v95, v97
v_mfma_f32_16x16x32_bf16 a[84:87], v[240:243], v[176:179], a[84:87]
ds_read_b64_tr_b16 v[230:231], v20 offset:58368
v_mul_f32 v96, v75, v35
v_mfma_f32_16x16x32_bf16 a[88:91], v[240:243], v[168:171], a[88:91]
v_and_b32 v97, 0xffff0000, v54
v_fmac_f32 v96, v74, v36
v_mfma_f32_16x16x32_bf16 a[88:91], v[244:247], v[172:175], a[88:91]
v_fmac_f32 v96, v73, v37
v_fmac_f32 v96, v72, v38
v_mfma_f32_16x16x32_bf16 a[92:95], v[244:247], v[164:167], a[92:95]
v_mul_f32 v96, v96, v97
v_cvt_pk_bf16_f32 v106, v95, v96
v_mfma_f32_16x16x32_bf16 a[92:95], v[240:243], v[160:163], a[92:95]
s_waitcnt lgkmcnt(4)
v_mul_f32 v95, v75, v34
v_and_b32 v97, 0xffff0000, v53
v_mfma_f32_16x16x32_bf16 a[124:127], v[248:251], v[160:163], a[124:127]
ds_read_b64_tr_b16 v[232:233], v21 offset:49152
v_fmac_f32 v95, v74, v35
v_mfma_f32_16x16x32_bf16 a[124:127], v[252:255], v[164:167], a[124:127]
v_fmac_f32 v95, v73, v36
v_fmac_f32 v95, v72, v37
v_mfma_f32_16x16x32_bf16 a[120:123], v[252:255], v[172:175], a[120:123]
v_mul_f32 v95, v95, v97
v_mul_f32 v96, v75, v33
v_mfma_f32_16x16x32_bf16 a[120:123], v[248:251], v[168:171], a[120:123]
ds_read_b64_tr_b16 v[234:235], v21 offset:50176
v_and_b32 v97, 0xffff0000, v52
v_mfma_f32_16x16x32_bf16 a[116:119], v[248:251], v[176:179], a[116:119]
v_fmac_f32 v96, v74, v34
v_fmac_f32 v96, v73, v35
v_mfma_f32_16x16x32_bf16 a[116:119], v[252:255], v[180:183], a[116:119]
v_fmac_f32 v96, v72, v36
v_mul_f32 v96, v96, v97
v_mfma_f32_16x16x32_bf16 a[112:115], v[252:255], v[188:191], a[112:115]
v_cvt_pk_bf16_f32 v107, v95, v96
v_mfma_f32_16x16x32_bf16 a[112:115], v[248:251], v[184:187], a[112:115]
ds_read_b64_tr_b16 v[236:237], v21 offset:57344
ds_write_b128 v28, v[104:107] offset:288
v_mfma_f32_16x16x32_bf16 a[108:111], v[248:251], v[216:219], a[108:111]
v_mfma_f32_16x16x32_bf16 a[108:111], v[252:255], v[220:223], a[108:111]
v_mfma_f32_16x16x32_bf16 a[104:107], v[252:255], v[212:215], a[104:107]
ds_read_b64_tr_b16 v[238:239], v21 offset:58368
v_mfma_f32_16x16x32_bf16 a[104:107], v[248:251], v[208:211], a[104:107]
v_mfma_f32_16x16x32_bf16 a[100:103], v[248:251], v[200:203], a[100:103]
v_mfma_f32_16x16x32_bf16 a[100:103], v[252:255], v[204:207], a[100:103]
v_mfma_f32_16x16x32_bf16 a[96:99], v[252:255], v[196:199], a[96:99]
v_mfma_f32_16x16x32_bf16 a[96:99], v[248:251], v[192:195], a[96:99]
s_waitcnt lgkmcnt(5)
v_mfma_f32_16x16x32_bf16 a[128:131], v[192:195], v[224:227], a[128:131]
ds_read_b64_tr_b16 v[240:241], v22 offset:49152
v_mfma_f32_16x16x32_bf16 a[128:131], v[196:199], v[228:231], a[128:131]
v_mfma_f32_16x16x32_bf16 a[132:135], v[204:207], v[228:231], a[132:135]
v_mfma_f32_16x16x32_bf16 a[132:135], v[200:203], v[224:227], a[132:135]
ds_read_b64_tr_b16 v[242:243], v22 offset:50176
v_mfma_f32_16x16x32_bf16 a[136:139], v[208:211], v[224:227], a[136:139]
v_mfma_f32_16x16x32_bf16 a[136:139], v[212:215], v[228:231], a[136:139]
v_mfma_f32_16x16x32_bf16 a[140:143], v[220:223], v[228:231], a[140:143]
v_mfma_f32_16x16x32_bf16 a[140:143], v[216:219], v[224:227], a[140:143]
ds_read_b64_tr_b16 v[244:245], v22 offset:57344
v_mfma_f32_16x16x32_bf16 a[144:147], v[184:187], v[224:227], a[144:147]
v_mfma_f32_16x16x32_bf16 a[144:147], v[188:191], v[228:231], a[144:147]
v_mfma_f32_16x16x32_bf16 a[148:151], v[180:183], v[228:231], a[148:151]
ds_read_b64_tr_b16 v[246:247], v22 offset:58368
v_mfma_f32_16x16x32_bf16 a[148:151], v[176:179], v[224:227], a[148:151]
v_mfma_f32_16x16x32_bf16 a[152:155], v[168:171], v[224:227], a[152:155]
v_mfma_f32_16x16x32_bf16 a[152:155], v[172:175], v[228:231], a[152:155]
v_mfma_f32_16x16x32_bf16 a[156:159], v[164:167], v[228:231], a[156:159]
v_mfma_f32_16x16x32_bf16 a[156:159], v[160:163], v[224:227], a[156:159]
s_waitcnt lgkmcnt(4)
v_mfma_f32_16x16x32_bf16 a[188:191], v[160:163], v[232:235], a[188:191]
ds_read_b64_tr_b16 v[248:249], v23 offset:49152
v_mfma_f32_16x16x32_bf16 a[188:191], v[164:167], v[236:239], a[188:191]
v_mfma_f32_16x16x32_bf16 a[184:187], v[172:175], v[236:239], a[184:187]
ds_read_b64_tr_b16 v[250:251], v23 offset:50176
v_mfma_f32_16x16x32_bf16 a[184:187], v[168:171], v[232:235], a[184:187]
v_mfma_f32_16x16x32_bf16 a[180:183], v[176:179], v[232:235], a[180:183]
ds_read_b64_tr_b16 v[252:253], v23 offset:57344
v_mfma_f32_16x16x32_bf16 a[180:183], v[180:183], v[236:239], a[180:183]
v_mfma_f32_16x16x32_bf16 a[176:179], v[188:191], v[236:239], a[176:179]
ds_read_b64_tr_b16 v[254:255], v23 offset:58368
v_mfma_f32_16x16x32_bf16 a[176:179], v[184:187], v[232:235], a[176:179]
v_mfma_f32_16x16x32_bf16 a[172:175], v[216:219], v[232:235], a[172:175]
v_mfma_f32_16x16x32_bf16 a[172:175], v[220:223], v[236:239], a[172:175]
v_mfma_f32_16x16x32_bf16 a[168:171], v[212:215], v[236:239], a[168:171]
v_mfma_f32_16x16x32_bf16 a[168:171], v[208:211], v[232:235], a[168:171]
v_mfma_f32_16x16x32_bf16 a[164:167], v[200:203], v[232:235], a[164:167]
v_mfma_f32_16x16x32_bf16 a[164:167], v[204:207], v[236:239], a[164:167]
v_mfma_f32_16x16x32_bf16 a[160:163], v[196:199], v[236:239], a[160:163]
s_waitcnt vmcnt(4) lgkmcnt(0)
v_mfma_f32_16x16x32_bf16 a[160:163], v[192:195], v[232:235], a[160:163]
s_barrier
v_mfma_f32_16x16x32_bf16 a[192:195], v[192:195], v[240:243], a[192:195]
s_and_b32 s73, s65, 1
ds_read_b64_tr_b16 v[224:225], v20 offset:0
v_mfma_f32_16x16x32_bf16 a[192:195], v[196:199], v[244:247], a[192:195]
s_xor_b32 s73, s73, 7
ds_read_b64_tr_b16 v[226:227], v20 offset:1024
v_mfma_f32_16x16x32_bf16 a[196:199], v[204:207], v[244:247], a[196:199]
s_lshl_b32 s69, s73, 7
ds_read_b64_tr_b16 v[228:229], v20 offset:8192
v_mfma_f32_16x16x32_bf16 a[196:199], v[200:203], v[240:243], a[196:199]
s_add_u32 s69, s69, s84
ds_read_b64_tr_b16 v[230:231], v20 offset:9216
v_mfma_f32_16x16x32_bf16 a[200:203], v[208:211], v[240:243], a[200:203]
s_lshl_b32 s71, s73, 19
ds_read_b128 v[128:131], v24 offset:0
v_mfma_f32_16x16x32_bf16 a[200:203], v[212:215], v[244:247], a[200:203]
s_add_u32 s71, s71, s66
ds_read_b128 v[132:135], v25 offset:0
v_mfma_f32_16x16x32_bf16 a[204:207], v[220:223], v[244:247], a[204:207]
s_add_u32 m0, s63, 98304
v_mfma_f32_16x16x32_bf16 a[204:207], v[216:219], v[240:243], a[204:207]
s_add_u32 s72, s69, 0
buffer_load_dwordx4 v2, s[8:11], s72 offen lds
v_mfma_f32_16x16x32_bf16 a[208:211], v[184:187], v[240:243], a[208:211]
s_add_u32 s72, s69, 7168
buffer_load_dwordx4 v3, s[8:11], s72 offen offset:1024 lds
v_mfma_f32_16x16x32_bf16 a[208:211], v[188:191], v[244:247], a[208:211]
s_add_u32 s72, s69, 14336
buffer_load_dwordx4 v2, s[8:11], s72 offen offset:2048 lds
v_mfma_f32_16x16x32_bf16 a[212:215], v[180:183], v[244:247], a[212:215]
s_mul_i32 s74, s58, 4352
ds_read_b128 v[136:139], v24 offset:2048
v_mfma_f32_16x16x32_bf16 a[212:215], v[176:179], v[240:243], a[212:215]
s_add_u32 s74, s74, 131072
ds_read_b128 v[140:143], v25 offset:2048
v_lshrrev_b32 v26, 4, v0
v_mfma_f32_16x16x32_bf16 a[216:219], v[168:171], v[240:243], a[216:219]
s_add_u32 s72, s69, 21504
buffer_load_dwordx4 v3, s[8:11], s72 offen offset:3072 lds
v_mfma_f32_16x16x32_bf16 a[216:219], v[172:175], v[244:247], a[216:219]
ds_read_b128 v[144:147], v24 offset:4096
v_and_b32 v27, 15, v0
v_mfma_f32_16x16x32_bf16 a[220:223], v[164:167], v[244:247], a[220:223]
ds_read_b128 v[148:151], v25 offset:4096
v_lshlrev_b32 v27, 4, v27
v_mfma_f32_16x16x32_bf16 a[220:223], v[160:163], v[240:243], a[220:223]
ds_read_b128 v[152:155], v24 offset:6144
v_mul_u32_u24 v28, 272, v26
v_mfma_f32_16x16x32_bf16 a[252:255], v[160:163], v[248:251], a[252:255]
ds_read_b128 v[156:159], v25 offset:6144
v_add3_u32 v28, v28, v27, s74
v_mfma_f32_16x16x32_bf16 a[252:255], v[164:167], v[252:255], a[252:255]
s_add_u32 m0, s64, 32768
v_lshl_add_u32 v26, v26, 12, v27
v_mfma_f32_16x16x32_bf16 a[248:251], v[172:175], v[252:255], a[248:251]
s_add_u32 s72, s71, 0
buffer_load_dwordx4 v6, s[16:19], s72 offen lds
v_mfma_f32_16x16x32_bf16 a[248:251], v[168:171], v[248:251], a[248:251]
ds_read_b128 v[160:163], v24 offset:8192
ds_read_b128 v[36:39], v28 offset:0
v_mfma_f32_16x16x32_bf16 a[244:247], v[176:179], v[248:251], a[244:247]
ds_read_b128 v[164:167], v25 offset:8192
ds_read_b128 v[40:43], v28 offset:1088
v_mfma_f32_16x16x32_bf16 a[244:247], v[180:183], v[252:255], a[244:247]
s_add_u32 s72, s71, 31744
buffer_load_dwordx4 v6, s[16:19], s72 offen offset:1024 lds
v_mfma_f32_16x16x32_bf16 a[240:243], v[188:191], v[252:255], a[240:243]
ds_read_b128 v[168:171], v24 offset:10240
ds_read_b128 v[44:47], v28 offset:2176
v_mfma_f32_16x16x32_bf16 a[240:243], v[184:187], v[248:251], a[240:243]
ds_read_b128 v[172:175], v25 offset:10240
ds_read_b128 v[48:51], v28 offset:3264
v_mfma_f32_16x16x32_bf16 a[236:239], v[216:219], v[248:251], a[236:239]
s_xor_b32 s74, s2, 5
ds_read_b128 v[176:179], v24 offset:12288
v_mfma_f32_16x16x32_bf16 a[236:239], v[220:223], v[252:255], a[236:239]
s_add_u32 s72, s71, 63488
buffer_load_dwordx4 v7, s[16:19], s72 offen offset:2048 lds
v_mfma_f32_16x16x32_bf16 a[232:235], v[212:215], v[252:255], a[232:235]
s_and_b32 s74, s74, 15
ds_read_b128 v[180:183], v25 offset:12288
v_mfma_f32_16x16x32_bf16 a[232:235], v[208:211], v[248:251], a[232:235]
s_lshl_b32 s74, s74, 2
ds_read_b128 v[184:187], v24 offset:14336
v_mfma_f32_16x16x32_bf16 a[228:231], v[200:203], v[248:251], a[228:231]
s_add_u32 s74, s74, s58
ds_read_b128 v[188:191], v25 offset:14336
v_mfma_f32_16x16x32_bf16 a[228:231], v[204:207], v[252:255], a[228:231]
s_lshl_b32 s74, s74, 16
v_mfma_f32_16x16x32_bf16 a[224:227], v[196:199], v[252:255], a[224:227]
s_add_u32 s72, s71, 95232
buffer_load_dwordx4 v7, s[16:19], s72 offen offset:3072 lds
v_mfma_f32_16x16x32_bf16 a[224:227], v[192:195], v[248:251], a[224:227]
s_waitcnt lgkmcnt(12)
ds_read_b64_tr_b16 v[232:233], v21 offset:0
v_mfma_f32_16x16x32_bf16 a[0:3], v[224:227], v[128:131], a[0:3]
s_lshr_b32 s75, s2, 4
ds_read_b64_tr_b16 v[234:235], v21 offset:1024
v_mfma_f32_16x16x32_bf16 a[0:3], v[228:231], v[132:135], a[0:3]
s_lshl_b32 s75, s75, 8
ds_read_b64_tr_b16 v[240:241], v22 offset:0
v_mfma_f32_16x16x32_bf16 a[4:7], v[228:231], v[140:143], a[4:7]
s_add_u32 m0, s63, 102400
ds_read_b64_tr_b16 v[236:237], v21 offset:8192
v_mfma_f32_16x16x32_bf16 a[4:7], v[224:227], v[136:139], a[4:7]
s_add_u32 s72, s69, 32768
buffer_load_dwordx4 v2, s[8:11], s72 offen lds
v_mfma_f32_16x16x32_bf16 a[8:11], v[224:227], v[144:147], a[8:11]
s_sub_u32 s74, s74, s75
ds_read_b64_tr_b16 v[238:239], v21 offset:9216
v_mfma_f32_16x16x32_bf16 a[8:11], v[228:231], v[148:151], a[8:11]
s_add_u32 s74, s74, 0x3000f00
v_mfma_f32_16x16x32_bf16 a[12:15], v[228:231], v[156:159], a[12:15]
s_add_u32 s72, s69, 39936
buffer_load_dwordx4 v3, s[8:11], s72 offen offset:1024 lds
v_mfma_f32_16x16x32_bf16 a[12:15], v[224:227], v[152:155], a[12:15]
s_waitcnt lgkmcnt(5)
ds_read_b64_tr_b16 v[242:243], v22 offset:1024
v_mfma_f32_16x16x32_bf16 a[16:19], v[224:227], v[160:163], a[16:19]
s_waitcnt vmcnt(30)
v_lshlrev_b32 v78, 16, v84
v_lshlrev_b32 v79, 16, v108
v_mfma_f32_16x16x32_bf16 a[16:19], v[228:231], v[164:167], a[16:19]
ds_read_b64_tr_b16 v[244:245], v22 offset:8192
v_mul_f32 v76, v78, v79
v_mfma_f32_16x16x32_bf16 a[20:23], v[228:231], v[172:175], a[20:23]
v_lshlrev_b32 v80, 16, v116
v_mul_f32 v77, v78, v80
v_mfma_f32_16x16x32_bf16 a[20:23], v[224:227], v[168:171], a[20:23]
s_add_u32 s72, s69, 47104
buffer_load_dwordx4 v2, s[8:11], s72 offen offset:2048 lds
v_mfma_f32_16x16x32_bf16 a[24:27], v[224:227], v[176:179], a[24:27]
ds_read_b64_tr_b16 v[246:247], v22 offset:9216
v_and_b32 v78, 0xffff0000, v84
v_mfma_f32_16x16x32_bf16 a[24:27], v[228:231], v[180:183], a[24:27]
v_and_b32 v79, 0xffff0000, v108
v_fmac_f32 v76, v78, v79
v_mfma_f32_16x16x32_bf16 a[28:31], v[228:231], v[188:191], a[28:31]
v_and_b32 v80, 0xffff0000, v116
v_fmac_f32 v77, v78, v80
v_mfma_f32_16x16x32_bf16 a[28:31], v[224:227], v[184:187], a[28:31]
s_waitcnt lgkmcnt(3)
v_lshlrev_b32 v78, 16, v85
v_lshlrev_b32 v79, 16, v109
v_mfma_f32_16x16x32_bf16 a[60:63], v[232:235], v[184:187], a[60:63]
s_add_u32 s72, s69, 54272
buffer_load_dwordx4 v3, s[8:11], s72 offen offset:3072 lds
v_mfma_f32_16x16x32_bf16 a[60:63], v[236:239], v[188:191], a[60:63]
ds_read_b64_tr_b16 v[248:249], v23 offset:0
v_fmac_f32 v76, v78, v79
v_mfma_f32_16x16x32_bf16 a[56:59], v[236:239], v[180:183], a[56:59]
v_lshlrev_b32 v80, 16, v117
v_fmac_f32 v77, v78, v80
v_mfma_f32_16x16x32_bf16 a[56:59], v[232:235], v[176:179], a[56:59]
s_add_u32 m0, s64, 49152
ds_read_b64_tr_b16 v[250:251], v23 offset:1024
v_and_b32 v78, 0xffff0000, v85
v_mfma_f32_16x16x32_bf16 a[52:55], v[232:235], v[168:171], a[52:55]
s_add_u32 s72, s71, 0
buffer_load_dwordx4 v6, s[20:23], s72 offen lds
v_mfma_f32_16x16x32_bf16 a[52:55], v[236:239], v[172:175], a[52:55]
v_and_b32 v79, 0xffff0000, v109
v_fmac_f32 v76, v78, v79
v_mfma_f32_16x16x32_bf16 a[48:51], v[236:239], v[164:167], a[48:51]
v_and_b32 v80, 0xffff0000, v117
v_fmac_f32 v77, v78, v80
v_mfma_f32_16x16x32_bf16 a[48:51], v[232:235], v[160:163], a[48:51]
ds_read_b64_tr_b16 v[252:253], v23 offset:8192
v_lshlrev_b32 v78, 16, v86
v_mfma_f32_16x16x32_bf16 a[44:47], v[232:235], v[152:155], a[44:47]
s_add_u32 s72, s71, 31744
buffer_load_dwordx4 v6, s[20:23], s72 offen offset:1024 lds
v_mfma_f32_16x16x32_bf16 a[44:47], v[236:239], v[156:159], a[44:47]
v_lshlrev_b32 v79, 16, v110
v_fmac_f32 v76, v78, v79
v_mfma_f32_16x16x32_bf16 a[40:43], v[236:239], v[148:151], a[40:43]
ds_read_b64_tr_b16 v[254:255], v23 offset:9216
v_lshlrev_b32 v80, 16, v118
v_mfma_f32_16x16x32_bf16 a[40:43], v[232:235], v[144:147], a[40:43]
v_fmac_f32 v77, v78, v80
v_and_b32 v78, 0xffff0000, v86
v_mfma_f32_16x16x32_bf16 a[36:39], v[232:235], v[136:139], a[36:39]
s_add_u32 s72, s71, 63488
buffer_load_dwordx4 v7, s[20:23], s72 offen offset:2048 lds
v_mfma_f32_16x16x32_bf16 a[36:39], v[236:239], v[140:143], a[36:39]
v_and_b32 v79, 0xffff0000, v110
v_fmac_f32 v76, v78, v79
v_mfma_f32_16x16x32_bf16 a[32:35], v[236:239], v[132:135], a[32:35]
v_and_b32 v80, 0xffff0000, v118
v_fmac_f32 v77, v78, v80
v_mfma_f32_16x16x32_bf16 a[32:35], v[232:235], v[128:131], a[32:35]
s_waitcnt lgkmcnt(4)
v_lshlrev_b32 v78, 16, v87
v_lshlrev_b32 v79, 16, v111
v_mfma_f32_16x16x32_bf16 a[64:67], v[240:243], v[128:131], a[64:67]
s_add_u32 s72, s71, 95232
buffer_load_dwordx4 v7, s[20:23], s72 offen offset:3072 lds
v_mfma_f32_16x16x32_bf16 a[64:67], v[244:247], v[132:135], a[64:67]
ds_read_b64_tr_b16 v[224:225], v20 offset:16384
v_fmac_f32 v76, v78, v79
v_mfma_f32_16x16x32_bf16 a[68:71], v[244:247], v[140:143], a[68:71]
v_lshlrev_b32 v80, 16, v119
v_fmac_f32 v77, v78, v80
v_mfma_f32_16x16x32_bf16 a[68:71], v[240:243], v[136:139], a[68:71]
v_and_b32 v78, 0xffff0000, v87
v_and_b32 v79, 0xffff0000, v111
v_mfma_f32_16x16x32_bf16 a[72:75], v[240:243], v[144:147], a[72:75]
ds_read_b64_tr_b16 v[226:227], v20 offset:17408
v_fmac_f32 v76, v78, v79
v_mfma_f32_16x16x32_bf16 a[72:75], v[244:247], v[148:151], a[72:75]
v_and_b32 v80, 0xffff0000, v119
v_fmac_f32 v77, v78, v80
v_mfma_f32_16x16x32_bf16 a[76:79], v[244:247], v[156:159], a[76:79]
v_lshlrev_b32 v78, 16, v88
v_lshlrev_b32 v79, 16, v112
v_mfma_f32_16x16x32_bf16 a[76:79], v[240:243], v[152:155], a[76:79]
ds_read_b64_tr_b16 v[228:229], v20 offset:24576
v_fmac_f32 v76, v78, v79
v_mfma_f32_16x16x32_bf16 a[80:83], v[240:243], v[160:163], a[80:83]
s_waitcnt lgkmcnt(15)
buffer_store_dwordx4 v[36:39], v26, s[44:47], s74 offen sc1
v_mfma_f32_16x16x32_bf16 a[80:83], v[244:247], v[164:167], a[80:83]
v_lshlrev_b32 v80, 16, v120
v_fmac_f32 v77, v78, v80
v_mfma_f32_16x16x32_bf16 a[84:87], v[244:247], v[172:175], a[84:87]
v_and_b32 v78, 0xffff0000, v88
v_and_b32 v79, 0xffff0000, v112
v_mfma_f32_16x16x32_bf16 a[84:87], v[240:243], v[168:171], a[84:87]
ds_read_b64_tr_b16 v[230:231], v20 offset:25600
v_fmac_f32 v76, v78, v79
v_mfma_f32_16x16x32_bf16 a[88:91], v[240:243], v[176:179], a[88:91]
v_and_b32 v80, 0xffff0000, v120
v_fmac_f32 v77, v78, v80
v_mfma_f32_16x16x32_bf16 a[88:91], v[244:247], v[180:183], a[88:91]
v_lshlrev_b32 v78, 16, v89
v_lshlrev_b32 v79, 16, v113
v_mfma_f32_16x16x32_bf16 a[92:95], v[244:247], v[188:191], a[92:95]
v_fmac_f32 v76, v78, v79
v_lshlrev_b32 v80, 16, v121
v_mfma_f32_16x16x32_bf16 a[92:95], v[240:243], v[184:187], a[92:95]
s_waitcnt lgkmcnt(4)
v_fmac_f32 v77, v78, v80
v_and_b32 v78, 0xffff0000, v89
v_mfma_f32_16x16x32_bf16 a[124:127], v[248:251], v[184:187], a[124:127]
ds_read_b64_tr_b16 v[232:233], v21 offset:16384
v_and_b32 v79, 0xffff0000, v113
v_mfma_f32_16x16x32_bf16 a[124:127], v[252:255], v[188:191], a[124:127]
v_fmac_f32 v76, v78, v79
v_and_b32 v80, 0xffff0000, v121
v_mfma_f32_16x16x32_bf16 a[120:123], v[252:255], v[180:183], a[120:123]
ds_read_b64_tr_b16 v[234:235], v21 offset:17408
v_fmac_f32 v77, v78, v80
v_mfma_f32_16x16x32_bf16 a[120:123], v[248:251], v[176:179], a[120:123]
v_lshlrev_b32 v78, 16, v90
v_lshlrev_b32 v79, 16, v114
v_mfma_f32_16x16x32_bf16 a[116:119], v[248:251], v[168:171], a[116:119]
s_lshr_b32 s75, s93, 5
v_fmac_f32 v76, v78, v79
v_lshlrev_b32 v80, 16, v122
v_mfma_f32_16x16x32_bf16 a[116:119], v[252:255], v[172:175], a[116:119]
s_add_u32 s74, s74, 0x4000
buffer_store_dwordx4 v[40:43], v26, s[44:47], s74 offen sc1
v_mfma_f32_16x16x32_bf16 a[112:115], v[252:255], v[164:167], a[112:115]
s_and_b32 s75, s75, 0x3f80
ds_read_b64_tr_b16 v[236:237], v21 offset:24576
v_fmac_f32 v77, v78, v80
v_mfma_f32_16x16x32_bf16 a[112:115], v[248:251], v[160:163], a[112:115]
s_add_u32 s75, s75, LcB0-Lpc0
v_lshrrev_b32 v2, 6, v0
v_lshlrev_b32 v2, 7, v2
v_mfma_f32_16x16x32_bf16 a[108:111], v[248:251], v[152:155], a[108:111]
v_add_u32 v2, s75, v2
v_min_u32 v2, Lcode_end-Lpc0, v2
v_mfma_f32_16x16x32_bf16 a[108:111], v[252:255], v[156:159], a[108:111]
global_load_dword v3, v2, s[98:99]
v_mfma_f32_16x16x32_bf16 a[104:107], v[252:255], v[148:151], a[104:107]
v_and_b32 v78, 0xffff0000, v90
v_and_b32 v79, 0xffff0000, v114
v_mfma_f32_16x16x32_bf16 a[104:107], v[248:251], v[144:147], a[104:107]
ds_read_b64_tr_b16 v[238:239], v21 offset:25600
v_fmac_f32 v76, v78, v79
v_mfma_f32_16x16x32_bf16 a[100:103], v[248:251], v[136:139], a[100:103]
v_and_b32 v80, 0xffff0000, v122
v_fmac_f32 v77, v78, v80
v_mfma_f32_16x16x32_bf16 a[100:103], v[252:255], v[140:143], a[100:103]
v_lshlrev_b32 v78, 16, v91
v_lshlrev_b32 v79, 16, v115
v_mfma_f32_16x16x32_bf16 a[96:99], v[252:255], v[132:135], a[96:99]
v_fmac_f32 v76, v78, v79
v_lshlrev_b32 v80, 16, v123
v_mfma_f32_16x16x32_bf16 a[96:99], v[248:251], v[128:131], a[96:99]
s_waitcnt lgkmcnt(4)
v_fmac_f32 v77, v78, v80
v_and_b32 v78, 0xffff0000, v91
v_mfma_f32_16x16x32_bf16 a[128:131], v[128:131], v[224:227], a[128:131]
ds_read_b64_tr_b16 v[240:241], v22 offset:16384
v_and_b32 v79, 0xffff0000, v115
v_mfma_f32_16x16x32_bf16 a[128:131], v[132:135], v[228:231], a[128:131]
v_fmac_f32 v76, v78, v79
v_and_b32 v80, 0xffff0000, v123
v_mfma_f32_16x16x32_bf16 a[132:135], v[140:143], v[228:231], a[132:135]
s_add_u32 s74, s74, 0x4000
buffer_store_dwordx4 v[44:47], v26, s[44:47], s74 offen sc1
v_mfma_f32_16x16x32_bf16 a[132:135], v[136:139], v[224:227], a[132:135]
v_fmac_f32 v77, v78, v80
v_add_f32_dpp v76, v76, v76 row_ror:8 row_mask:0xf bank_mask:0xf
v_mfma_f32_16x16x32_bf16 a[136:139], v[144:147], v[224:227], a[136:139]
ds_read_b64_tr_b16 v[242:243], v22 offset:17408
v_add_f32_dpp v77, v77, v77 row_ror:8 row_mask:0xf bank_mask:0xf
v_mfma_f32_16x16x32_bf16 a[136:139], v[148:151], v[228:231], a[136:139]
v_add_f32_dpp v76, v76, v76 row_ror:4 row_mask:0xf bank_mask:0xf
v_add_f32_dpp v77, v77, v77 row_ror:4 row_mask:0xf bank_mask:0xf
v_mfma_f32_16x16x32_bf16 a[140:143], v[156:159], v[228:231], a[140:143]
v_add_f32_dpp v76, v76, v76 row_ror:2 row_mask:0xf bank_mask:0xf
v_add_f32_dpp v77, v77, v77 row_ror:2 row_mask:0xf bank_mask:0xf
v_mfma_f32_16x16x32_bf16 a[140:143], v[152:155], v[224:227], a[140:143]
ds_read_b64_tr_b16 v[244:245], v22 offset:24576
v_add_f32_dpp v76, v76, v76 row_ror:1 row_mask:0xf bank_mask:0xf
v_mfma_f32_16x16x32_bf16 a[144:147], v[160:163], v[224:227], a[144:147]
v_add_f32_dpp v77, v77, v77 row_ror:1 row_mask:0xf bank_mask:0xf
v_mov_b32 v78, v76
v_mfma_f32_16x16x32_bf16 a[144:147], v[164:167], v[228:231], a[144:147]
v_mov_b32 v79, v77
v_permlane16_swap_b32 v76, v78
v_mfma_f32_16x16x32_bf16 a[148:151], v[172:175], v[228:231], a[148:151]
ds_read_b64_tr_b16 v[246:247], v22 offset:25600
v_permlane16_swap_b32 v77, v79
v_mfma_f32_16x16x32_bf16 a[148:151], v[168:171], v[224:227], a[148:151]
v_add_f32 v76, v76, v78
v_add_f32 v77, v77, v79
v_mfma_f32_16x16x32_bf16 a[152:155], v[176:179], v[224:227], a[152:155]
v_mov_b32 v78, v76
v_mov_b32 v79, v77
v_mfma_f32_16x16x32_bf16 a[152:155], v[180:183], v[228:231], a[152:155]
v_permlane32_swap_b32 v76, v78
v_permlane32_swap_b32 v77, v79
v_mfma_f32_16x16x32_bf16 a[156:159], v[188:191], v[228:231], a[156:159]
v_add_f32 v76, v76, v78
v_add_f32 v77, v77, v79
v_mfma_f32_16x16x32_bf16 a[156:159], v[184:187], v[224:227], a[156:159]
s_waitcnt lgkmcnt(4)
v_mul_f32 v76, 0xbfb8aa3b, v76
v_mul_f32 v77, 0xbfb8aa3b, v77
v_mfma_f32_16x16x32_bf16 a[188:191], v[184:187], v[232:235], a[188:191]
s_add_u32 s74, s74, 0x4000
buffer_store_dwordx4 v[48:51], v26, s[44:47], s74 offen sc1
v_mfma_f32_16x16x32_bf16 a[188:191], v[188:191], v[236:239], a[188:191]
ds_read_b64_tr_b16 v[248:249], v23 offset:16384
v_mfma_f32_16x16x32_bf16 a[184:187], v[180:183], v[236:239], a[184:187]
ds_read_b64_tr_b16 v[250:251], v23 offset:17408
v_mfma_f32_16x16x32_bf16 a[184:187], v[176:179], v[232:235], a[184:187]
v_exp_f32 v76, v76
v_mfma_f32_16x16x32_bf16 a[180:183], v[168:171], v[232:235], a[180:183]
ds_read_b64_tr_b16 v[252:253], v23 offset:24576
v_mfma_f32_16x16x32_bf16 a[180:183], v[172:175], v[236:239], a[180:183]
v_exp_f32 v77, v77
v_mfma_f32_16x16x32_bf16 a[176:179], v[164:167], v[236:239], a[176:179]
ds_read_b64_tr_b16 v[254:255], v23 offset:25600
v_add_f32 v76, 1.0, v76
v_mfma_f32_16x16x32_bf16 a[176:179], v[160:163], v[232:235], a[176:179]
v_add_f32 v77, 1.0, v77
v_mfma_f32_16x16x32_bf16 a[172:175], v[152:155], v[232:235], a[172:175]
v_rcp_f32 v76, v76
v_mfma_f32_16x16x32_bf16 a[172:175], v[156:159], v[236:239], a[172:175]
v_rcp_f32 v77, v77
v_mfma_f32_16x16x32_bf16 a[168:171], v[148:151], v[236:239], a[168:171]
s_lshr_b32 s80, s76, 9
v_mfma_f32_16x16x32_bf16 a[168:171], v[144:147], v[232:235], a[168:171]
s_add_u32 s80, s80, 0x3800000
v_min_u32 v78, 1, v0
v_lshlrev_b32 v78, 30, v78
v_mfma_f32_16x16x32_bf16 a[164:167], v[136:139], v[232:235], a[164:167]
buffer_store_dwordx2 v[76:77], v78, s[44:47], s80 offen sc1
v_mfma_f32_16x16x32_bf16 a[164:167], v[140:143], v[236:239], a[164:167]
v_mfma_f32_16x16x32_bf16 a[160:163], v[132:135], v[236:239], a[160:163]
s_waitcnt vmcnt(6) lgkmcnt(0)
v_mfma_f32_16x16x32_bf16 a[160:163], v[128:131], v[232:235], a[160:163]
s_barrier
v_mfma_f32_16x16x32_bf16 a[192:195], v[128:131], v[240:243], a[192:195]
s_add_u32 s73, s62, 0
ds_read_b64_tr_b16 v[224:225], v20 offset:32768
v_mfma_f32_16x16x32_bf16 a[192:195], v[132:135], v[244:247], a[192:195]
s_add_u32 s70, s73, s65
ds_read_b64_tr_b16 v[226:227], v20 offset:33792
v_mfma_f32_16x16x32_bf16 a[196:199], v[140:143], v[244:247], a[196:199]
s_and_b32 s70, s70, 3
v_mov_b32 v100, v20
v_mov_b32 v101, v21
v_mfma_f32_16x16x32_bf16 a[196:199], v[136:139], v[240:243], a[196:199]
s_and_b32 s73, s73, 12
v_mov_b32 v102, v22
v_mov_b32 v103, v23
v_mfma_f32_16x16x32_bf16 a[200:203], v[144:147], v[240:243], a[200:203]
s_or_b32 s73, s73, s70
ds_read_b64_tr_b16 v[228:229], v20 offset:40960
v_mfma_f32_16x16x32_bf16 a[200:203], v[148:151], v[244:247], a[200:203]
s_lshl_b32 s73, s73, 7
ds_read_b64_tr_b16 v[230:231], v20 offset:41984
v_mfma_f32_16x16x32_bf16 a[204:207], v[156:159], v[244:247], a[204:207]
s_add_u32 s69, s73, s67
ds_read_b128 v[192:195], v24 offset:32768
v_mfma_f32_16x16x32_bf16 a[204:207], v[152:155], v[240:243], a[204:207]
s_add_u32 s70, s73, s68
ds_read_b128 v[196:199], v25 offset:32768
v_mfma_f32_16x16x32_bf16 a[208:211], v[160:163], v[240:243], a[208:211]
s_add_u32 m0, s63, 131072
ds_read_b128 v[200:203], v24 offset:34816
v_mfma_f32_16x16x32_bf16 a[208:211], v[164:167], v[244:247], a[208:211]
s_add_u32 s72, s69, 0
buffer_load_dwordx4 v4, s[4:7], s72 offen lds
v_mfma_f32_16x16x32_bf16 a[212:215], v[172:175], v[244:247], a[212:215]
s_add_u32 s72, s69, 15360
buffer_load_dwordx4 v5, s[4:7], s72 offen offset:1024 lds
v_mfma_f32_16x16x32_bf16 a[212:215], v[168:171], v[240:243], a[212:215]
s_add_u32 s72, s69, 129024
buffer_load_dwordx4 v4, s[4:7], s72 offen offset:2048 lds
v_mfma_f32_16x16x32_bf16 a[216:219], v[176:179], v[240:243], a[216:219]
ds_read_b128 v[204:207], v25 offset:34816
v_mfma_f32_16x16x32_bf16 a[216:219], v[180:183], v[244:247], a[216:219]
ds_read_b128 v[208:211], v24 offset:36864
v_mfma_f32_16x16x32_bf16 a[220:223], v[188:191], v[244:247], a[220:223]
s_add_u32 s72, s69, 144384
buffer_load_dwordx4 v5, s[4:7], s72 offen offset:3072 lds
v_mfma_f32_16x16x32_bf16 a[220:223], v[184:187], v[240:243], a[220:223]
ds_read_b128 v[212:215], v25 offset:36864
v_mfma_f32_16x16x32_bf16 a[252:255], v[184:187], v[248:251], a[252:255]
ds_read_b128 v[216:219], v24 offset:38912
v_mfma_f32_16x16x32_bf16 a[252:255], v[188:191], v[252:255], a[252:255]
ds_read_b128 v[220:223], v25 offset:38912
v_mfma_f32_16x16x32_bf16 a[248:251], v[180:183], v[252:255], a[248:251]
s_add_u32 m0, s63, 135168
ds_read_b128 v[184:187], v24 offset:40960
v_mfma_f32_16x16x32_bf16 a[248:251], v[176:179], v[248:251], a[248:251]
s_add_u32 s72, s70, 0
buffer_load_dwordx4 v4, s[4:7], s72 offen lds
v_mfma_f32_16x16x32_bf16 a[244:247], v[168:171], v[248:251], a[244:247]
ds_read_b128 v[188:191], v25 offset:40960
v_mfma_f32_16x16x32_bf16 a[244:247], v[172:175], v[252:255], a[244:247]
ds_read_b128 v[176:179], v24 offset:43008
v_mfma_f32_16x16x32_bf16 a[240:243], v[164:167], v[252:255], a[240:243]
ds_read_b128 v[180:183], v25 offset:43008
v_mfma_f32_16x16x32_bf16 a[240:243], v[160:163], v[248:251], a[240:243]
s_add_u32 s72, s70, 15360
buffer_load_dwordx4 v5, s[4:7], s72 offen offset:1024 lds
v_mfma_f32_16x16x32_bf16 a[236:239], v[152:155], v[248:251], a[236:239]
ds_read_b128 v[168:171], v24 offset:45056
v_mfma_f32_16x16x32_bf16 a[236:239], v[156:159], v[252:255], a[236:239]
ds_read_b128 v[172:175], v25 offset:45056
v_mfma_f32_16x16x32_bf16 a[232:235], v[148:151], v[252:255], a[232:235]
v_mfma_f32_16x16x32_bf16 a[232:235], v[144:147], v[248:251], a[232:235]
ds_read_b128 v[160:163], v24 offset:47104
v_mfma_f32_16x16x32_bf16 a[228:231], v[136:139], v[248:251], a[228:231]
s_add_u32 s72, s70, 129024
buffer_load_dwordx4 v4, s[4:7], s72 offen offset:2048 lds
v_mfma_f32_16x16x32_bf16 a[228:231], v[140:143], v[252:255], a[228:231]
ds_read_b128 v[164:167], v25 offset:47104
v_mfma_f32_16x16x32_bf16 a[224:227], v[132:135], v[252:255], a[224:227]
ds_read_b64_tr_b16 v[232:233], v101 offset:32768
v_mfma_f32_16x16x32_bf16 a[224:227], v[128:131], v[248:251], a[224:227]
s_waitcnt lgkmcnt(9)
ds_read_b64_tr_b16 v[234:235], v101 offset:33792
v_mfma_f32_16x16x32_bf16 a[0:3], v[224:227], v[192:195], a[0:3]
s_add_u32 s72, s70, 144384
buffer_load_dwordx4 v5, s[4:7], s72 offen offset:3072 lds
v_mfma_f32_16x16x32_bf16 a[0:3], v[228:231], v[196:199], a[0:3]
ds_read_b64_tr_b16 v[240:241], v102 offset:32768
v_mfma_f32_16x16x32_bf16 a[4:7], v[228:231], v[204:207], a[4:7]
ds_read_b64_tr_b16 v[236:237], v101 offset:40960
v_mfma_f32_16x16x32_bf16 a[4:7], v[224:227], v[200:203], a[4:7]
v_mfma_f32_16x16x32_bf16 a[8:11], v[224:227], v[208:211], a[8:11]
ds_read_b64_tr_b16 v[238:239], v101 offset:41984
v_mfma_f32_16x16x32_bf16 a[8:11], v[228:231], v[212:215], a[8:11]
s_lshl_b32 s71, s73, 12
ds_read_b64_tr_b16 v[242:243], v102 offset:33792
v_mfma_f32_16x16x32_bf16 a[12:15], v[228:231], v[220:223], a[12:15]
s_add_u32 s71, s71, s66
v_mfma_f32_16x16x32_bf16 a[12:15], v[224:227], v[216:219], a[12:15]
s_waitcnt lgkmcnt(6)
ds_read_b64_tr_b16 v[244:245], v102 offset:40960
v_mfma_f32_16x16x32_bf16 a[16:19], v[224:227], v[184:187], a[16:19]
s_add_u32 m0, s64, 0
v_mfma_f32_16x16x32_bf16 a[16:19], v[228:231], v[188:191], a[16:19]
s_add_u32 s72, s71, 0
buffer_load_dwordx4 v6, s[12:15], s72 offen lds
v_mfma_f32_16x16x32_bf16 a[20:23], v[228:231], v[180:183], a[20:23]
s_add_u32 s72, s71, 31744
buffer_load_dwordx4 v6, s[12:15], s72 offen offset:1024 lds
v_mfma_f32_16x16x32_bf16 a[20:23], v[224:227], v[176:179], a[20:23]
ds_read_b64_tr_b16 v[246:247], v102 offset:41984
v_mfma_f32_16x16x32_bf16 a[24:27], v[224:227], v[168:171], a[24:27]
v_mfma_f32_16x16x32_bf16 a[24:27], v[228:231], v[172:175], a[24:27]
v_mfma_f32_16x16x32_bf16 a[28:31], v[228:231], v[164:167], a[28:31]
v_mfma_f32_16x16x32_bf16 a[28:31], v[224:227], v[160:163], a[28:31]
s_waitcnt lgkmcnt(3)
v_mfma_f32_16x16x32_bf16 a[60:63], v[232:235], v[160:163], a[60:63]
s_add_u32 s72, s71, 63488
buffer_load_dwordx4 v7, s[12:15], s72 offen offset:2048 lds
v_mfma_f32_16x16x32_bf16 a[60:63], v[236:239], v[164:167], a[60:63]
ds_read_b64_tr_b16 v[248:249], v103 offset:32768
v_mfma_f32_16x16x32_bf16 a[56:59], v[236:239], v[172:175], a[56:59]
v_mfma_f32_16x16x32_bf16 a[56:59], v[232:235], v[168:171], a[56:59]
s_add_u32 s72, s71, 95232
buffer_load_dwordx4 v7, s[12:15], s72 offen offset:3072 lds
v_mfma_f32_16x16x32_bf16 a[52:55], v[232:235], v[176:179], a[52:55]
v_mfma_f32_16x16x32_bf16 a[52:55], v[236:239], v[180:183], a[52:55]
ds_read_b64_tr_b16 v[250:251], v103 offset:33792
v_mfma_f32_16x16x32_bf16 a[48:51], v[236:239], v[188:191], a[48:51]
v_mfma_f32_16x16x32_bf16 a[48:51], v[232:235], v[184:187], a[48:51]
v_mfma_f32_16x16x32_bf16 a[44:47], v[232:235], v[216:219], a[44:47]
s_add_u32 s73, s62, 1
ds_read_b64_tr_b16 v[252:253], v103 offset:40960
v_mfma_f32_16x16x32_bf16 a[44:47], v[236:239], v[220:223], a[44:47]
s_add_u32 s70, s73, s65
v_mfma_f32_16x16x32_bf16 a[40:43], v[236:239], v[212:215], a[40:43]
s_and_b32 s70, s70, 3
v_mfma_f32_16x16x32_bf16 a[40:43], v[232:235], v[208:211], a[40:43]
s_and_b32 s73, s73, 12
ds_read_b64_tr_b16 v[254:255], v103 offset:41984
v_mfma_f32_16x16x32_bf16 a[36:39], v[232:235], v[200:203], a[36:39]
s_or_b32 s73, s73, s70
v_mfma_f32_16x16x32_bf16 a[36:39], v[236:239], v[204:207], a[36:39]
s_lshl_b32 s73, s73, 7
v_mfma_f32_16x16x32_bf16 a[32:35], v[236:239], v[196:199], a[32:35]
s_add_u32 s69, s73, s67
v_mfma_f32_16x16x32_bf16 a[32:35], v[232:235], v[192:195], a[32:35]
s_waitcnt lgkmcnt(4)
v_mfma_f32_16x16x32_bf16 a[64:67], v[240:243], v[192:195], a[64:67]
s_add_u32 s70, s73, s68
ds_read_b64_tr_b16 v[224:225], v100 offset:49152
v_mfma_f32_16x16x32_bf16 a[64:67], v[244:247], v[196:199], a[64:67]
s_add_u32 m0, s63, 65536
v_mfma_f32_16x16x32_bf16 a[68:71], v[244:247], v[204:207], a[68:71]
s_add_u32 s72, s69, 0
buffer_load_dwordx4 v4, s[4:7], s72 offen lds
v_mfma_f32_16x16x32_bf16 a[68:71], v[240:243], v[200:203], a[68:71]
s_add_u32 s72, s69, 15360
buffer_load_dwordx4 v5, s[4:7], s72 offen offset:1024 lds
v_mfma_f32_16x16x32_bf16 a[72:75], v[240:243], v[208:211], a[72:75]
s_add_u32 s72, s69, 129024
buffer_load_dwordx4 v4, s[4:7], s72 offen offset:2048 lds
v_mfma_f32_16x16x32_bf16 a[72:75], v[244:247], v[212:215], a[72:75]
ds_read_b64_tr_b16 v[226:227], v100 offset:50176
v_mfma_f32_16x16x32_bf16 a[76:79], v[244:247], v[220:223], a[76:79]
s_add_u32 s72, s69, 144384
buffer_load_dwordx4 v5, s[4:7], s72 offen offset:3072 lds
v_mfma_f32_16x16x32_bf16 a[76:79], v[240:243], v[216:219], a[76:79]
v_mfma_f32_16x16x32_bf16 a[80:83], v[240:243], v[184:187], a[80:83]
ds_read_b64_tr_b16 v[228:229], v100 offset:57344
v_mfma_f32_16x16x32_bf16 a[80:83], v[244:247], v[188:191], a[80:83]
v_mfma_f32_16x16x32_bf16 a[84:87], v[244:247], v[180:183], a[84:87]
ds_read_b64_tr_b16 v[230:231], v100 offset:58368
v_accvgpr_read_b32 v20, a0
v_mfma_f32_16x16x32_bf16 a[84:87], v[240:243], v[176:179], a[84:87]
s_add_u32 m0, s63, 69632
v_accvgpr_read_b32 v28, a1
v_accvgpr_read_b32 v21, a2
v_mfma_f32_16x16x32_bf16 a[88:91], v[240:243], v[168:171], a[88:91]
s_add_u32 s72, s70, 0
buffer_load_dwordx4 v4, s[4:7], s72 offen lds
v_mfma_f32_16x16x32_bf16 a[88:91], v[244:247], v[172:175], a[88:91]
v_accvgpr_read_b32 v29, a3
v_accvgpr_read_b32 v22, a32
v_mfma_f32_16x16x32_bf16 a[92:95], v[244:247], v[164:167], a[92:95]
v_accvgpr_read_b32 v30, a33
v_accvgpr_read_b32 v23, a34
v_mfma_f32_16x16x32_bf16 a[92:95], v[240:243], v[160:163], a[92:95]
s_waitcnt lgkmcnt(4)
v_accvgpr_read_b32 v31, a35
v_mul_f32 v20, s79, v20
v_mfma_f32_16x16x32_bf16 a[124:127], v[248:251], v[160:163], a[124:127]
s_add_u32 s72, s70, 15360
buffer_load_dwordx4 v5, s[4:7], s72 offen offset:1024 lds
v_mfma_f32_16x16x32_bf16 a[124:127], v[252:255], v[164:167], a[124:127]
ds_read_b64_tr_b16 v[232:233], v101 offset:49152
v_mul_f32 v28, s79, v28
v_mfma_f32_16x16x32_bf16 a[120:123], v[252:255], v[172:175], a[120:123]
v_mul_f32 v21, s79, v21
v_mul_f32 v29, s79, v29
v_mfma_f32_16x16x32_bf16 a[120:123], v[248:251], v[168:171], a[120:123]
ds_read_b64_tr_b16 v[234:235], v101 offset:50176
v_mul_f32 v22, s79, v22
v_mfma_f32_16x16x32_bf16 a[116:119], v[248:251], v[176:179], a[116:119]
s_add_u32 s72, s70, 129024
buffer_load_dwordx4 v4, s[4:7], s72 offen offset:2048 lds
v_mfma_f32_16x16x32_bf16 a[116:119], v[252:255], v[180:183], a[116:119]
v_mul_f32 v30, s79, v30
v_mul_f32 v23, s79, v23
v_mfma_f32_16x16x32_bf16 a[112:115], v[252:255], v[188:191], a[112:115]
v_mul_f32 v31, s79, v31
v_cvt_pk_bf16_f32 v20, v20, v28
v_mfma_f32_16x16x32_bf16 a[112:115], v[248:251], v[184:187], a[112:115]
ds_read_b64_tr_b16 v[236:237], v101 offset:57344
v_cvt_pk_bf16_f32 v21, v21, v29
v_mfma_f32_16x16x32_bf16 a[108:111], v[248:251], v[216:219], a[108:111]
v_cvt_pk_bf16_f32 v22, v22, v30
v_cvt_pk_bf16_f32 v23, v23, v31
v_mfma_f32_16x16x32_bf16 a[108:111], v[252:255], v[220:223], a[108:111]
s_add_u32 s72, s70, 144384
buffer_load_dwordx4 v5, s[4:7], s72 offen offset:3072 lds
v_mfma_f32_16x16x32_bf16 a[104:107], v[252:255], v[212:215], a[104:107]
s_add_u32 s80, s77, 0
buffer_store_dwordx4 v[20:23], v1, s[44:47], s80 offen sc1
v_mfma_f32_16x16x32_bf16 a[104:107], v[248:251], v[208:211], a[104:107]
ds_read_b64_tr_b16 v[238:239], v101 offset:58368
v_mfma_f32_16x16x32_bf16 a[100:103], v[248:251], v[200:203], a[100:103]
v_mfma_f32_16x16x32_bf16 a[100:103], v[252:255], v[204:207], a[100:103]
v_mfma_f32_16x16x32_bf16 a[96:99], v[252:255], v[196:199], a[96:99]
s_lshl_b32 s71, s73, 12
v_mfma_f32_16x16x32_bf16 a[96:99], v[248:251], v[192:195], a[96:99]
s_waitcnt lgkmcnt(4)
LcB0:
v_mfma_f32_16x16x32_bf16 a[128:131], v[192:195], v[224:227], a[128:131]
s_add_u32 s71, s71, s66
ds_read_b64_tr_b16 v[240:241], v102 offset:49152
v_accvgpr_read_b32 v24, a4
v_mfma_f32_16x16x32_bf16 a[128:131], v[196:199], v[228:231], a[128:131]
s_add_u32 m0, s64, 16384
v_accvgpr_read_b32 v28, a5
v_accvgpr_read_b32 v25, a6
v_mfma_f32_16x16x32_bf16 a[132:135], v[204:207], v[228:231], a[132:135]
s_add_u32 s72, s71, 0
buffer_load_dwordx4 v6, s[12:15], s72 offen lds
v_mfma_f32_16x16x32_bf16 a[132:135], v[200:203], v[224:227], a[132:135]
s_add_u32 s72, s71, 31744
buffer_load_dwordx4 v6, s[12:15], s72 offen offset:1024 lds
v_mfma_f32_16x16x32_bf16 a[136:139], v[208:211], v[224:227], a[136:139]
ds_read_b64_tr_b16 v[242:243], v102 offset:50176
v_accvgpr_read_b32 v29, a7
v_mfma_f32_16x16x32_bf16 a[136:139], v[212:215], v[228:231], a[136:139]
v_accvgpr_read_b32 v26, a36
v_accvgpr_read_b32 v30, a37
v_mfma_f32_16x16x32_bf16 a[140:143], v[220:223], v[228:231], a[140:143]
v_accvgpr_read_b32 v27, a38
v_accvgpr_read_b32 v31, a39
v_mfma_f32_16x16x32_bf16 a[140:143], v[216:219], v[224:227], a[140:143]
s_add_u32 s72, s71, 63488
buffer_load_dwordx4 v7, s[12:15], s72 offen offset:2048 lds
v_mfma_f32_16x16x32_bf16 a[144:147], v[184:187], v[224:227], a[144:147]
ds_read_b64_tr_b16 v[244:245], v102 offset:57344
v_mul_f32 v24, s79, v24
v_mfma_f32_16x16x32_bf16 a[144:147], v[188:191], v[228:231], a[144:147]
v_mul_f32 v28, s79, v28
v_mul_f32 v25, s79, v25
v_mfma_f32_16x16x32_bf16 a[148:151], v[180:183], v[228:231], a[148:151]
ds_read_b64_tr_b16 v[246:247], v102 offset:58368
v_mul_f32 v29, s79, v29
v_mfma_f32_16x16x32_bf16 a[148:151], v[176:179], v[224:227], a[148:151]
v_mul_f32 v26, s79, v26
v_mul_f32 v30, s79, v30
v_mfma_f32_16x16x32_bf16 a[152:155], v[168:171], v[224:227], a[152:155]
s_add_u32 s72, s71, 95232
buffer_load_dwordx4 v7, s[12:15], s72 offen offset:3072 lds
v_mfma_f32_16x16x32_bf16 a[152:155], v[172:175], v[228:231], a[152:155]
v_mul_f32 v27, s79, v27
v_mul_f32 v31, s79, v31
v_mfma_f32_16x16x32_bf16 a[156:159], v[164:167], v[228:231], a[156:159]
v_cvt_pk_bf16_f32 v24, v24, v28
v_cvt_pk_bf16_f32 v25, v25, v29
v_mfma_f32_16x16x32_bf16 a[156:159], v[160:163], v[224:227], a[156:159]
s_waitcnt lgkmcnt(4)
v_cvt_pk_bf16_f32 v26, v26, v30
v_cvt_pk_bf16_f32 v27, v27, v31
v_mfma_f32_16x16x32_bf16 a[188:191], v[160:163], v[232:235], a[188:191]
s_add_u32 s80, s77, 4096
ds_read_b64_tr_b16 v[248:249], v103 offset:49152
v_mfma_f32_16x16x32_bf16 a[188:191], v[164:167], v[236:239], a[188:191]
buffer_store_dwordx4 v[24:27], v1, s[44:47], s80 offen sc1
v_mfma_f32_16x16x32_bf16 a[184:187], v[172:175], v[236:239], a[184:187]
ds_read_b64_tr_b16 v[250:251], v103 offset:50176
v_mfma_f32_16x16x32_bf16 a[184:187], v[168:171], v[232:235], a[184:187]
v_mfma_f32_16x16x32_bf16 a[180:183], v[176:179], v[232:235], a[180:183]
ds_read_b64_tr_b16 v[252:253], v103 offset:57344
v_mfma_f32_16x16x32_bf16 a[180:183], v[180:183], v[236:239], a[180:183]
s_add_u32 s73, s62, 2
v_mfma_f32_16x16x32_bf16 a[176:179], v[188:191], v[236:239], a[176:179]
s_add_u32 s70, s73, s65
ds_read_b64_tr_b16 v[254:255], v103 offset:58368
v_accvgpr_read_b32 v20, a8
v_mfma_f32_16x16x32_bf16 a[176:179], v[184:187], v[232:235], a[176:179]
s_and_b32 s70, s70, 3
v_accvgpr_read_b32 v28, a9
v_accvgpr_read_b32 v21, a10
v_mfma_f32_16x16x32_bf16 a[172:175], v[216:219], v[232:235], a[172:175]
s_and_b32 s73, s73, 12
v_accvgpr_read_b32 v29, a11
v_accvgpr_read_b32 v22, a40
v_mfma_f32_16x16x32_bf16 a[172:175], v[220:223], v[236:239], a[172:175]
s_or_b32 s73, s73, s70
v_accvgpr_read_b32 v30, a41
v_accvgpr_read_b32 v23, a42
v_mfma_f32_16x16x32_bf16 a[168:171], v[212:215], v[236:239], a[168:171]
s_lshl_b32 s73, s73, 7
v_accvgpr_read_b32 v31, a43
v_mul_f32 v20, s79, v20
v_mfma_f32_16x16x32_bf16 a[168:171], v[208:211], v[232:235], a[168:171]
s_add_u32 s69, s73, s67
v_mul_f32 v28, s79, v28
v_mul_f32 v21, s79, v21
v_mfma_f32_16x16x32_bf16 a[164:167], v[200:203], v[232:235], a[164:167]
s_add_u32 s70, s73, s68
v_mul_f32 v29, s79, v29
v_mul_f32 v22, s79, v22
v_mfma_f32_16x16x32_bf16 a[164:167], v[204:207], v[236:239], a[164:167]
s_add_u32 m0, s63, 98304
v_mul_f32 v30, s79, v30
v_mul_f32 v23, s79, v23
v_mfma_f32_16x16x32_bf16 a[160:163], v[196:199], v[236:239], a[160:163]
s_waitcnt vmcnt(14) lgkmcnt(0)
v_mul_f32 v31, s79, v31
v_cvt_pk_bf16_f32 v20, v20, v28
v_mfma_f32_16x16x32_bf16 a[160:163], v[192:195], v[232:235], a[160:163]
s_barrier
v_cvt_pk_bf16_f32 v21, v21, v29
v_cvt_pk_bf16_f32 v22, v22, v30
v_mfma_f32_16x16x32_bf16 a[192:195], v[192:195], v[240:243], a[192:195]
s_add_u32 s72, s69, 0
buffer_load_dwordx4 v4, s[4:7], s72 offen lds
v_mfma_f32_16x16x32_bf16 a[192:195], v[196:199], v[244:247], a[192:195]
s_lshl_b32 s74, s59, 2
ds_read_b64_tr_b16 v[64:65], v8 offset:0
v_or_b32 v106, s58, v0
v_mfma_f32_16x16x32_bf16 a[196:199], v[204:207], v[244:247], a[196:199]
ds_read_b64_tr_b16 v[66:67], v8 offset:1024
v_mov_b32 v107, 1
v_mfma_f32_16x16x32_bf16 a[196:199], v[200:203], v[240:243], a[196:199]
ds_read_b64_tr_b16 v[68:69], v8 offset:8192
v_lshlrev_b32 v106, 8, v106
v_mfma_f32_16x16x32_bf16 a[200:203], v[208:211], v[240:243], a[200:203]
ds_read_b64_tr_b16 v[70:71], v8 offset:9216
v_cvt_pk_bf16_f32 v23, v23, v31
v_mfma_f32_16x16x32_bf16 a[200:203], v[212:215], v[244:247], a[200:203]
s_add_u32 s72, s69, 15360
buffer_load_dwordx4 v5, s[4:7], s72 offen offset:1024 lds
v_mfma_f32_16x16x32_bf16 a[204:207], v[220:223], v[244:247], a[204:207]
s_add_u32 s80, s77, 8192
ds_read_b128 v[32:35], v16 offset:0
v_mfma_f32_16x16x32_bf16 a[204:207], v[216:219], v[240:243], a[204:207]
buffer_atomic_add v107, v106, s[48:51], s74 offen sc1
v_mfma_f32_16x16x32_bf16 a[208:211], v[184:187], v[240:243], a[208:211]
ds_read_b128 v[36:39], v17 offset:0
v_mfma_f32_16x16x32_bf16 a[208:211], v[188:191], v[244:247], a[208:211]
ds_read_b128 v[40:43], v16 offset:2048
v_mfma_f32_16x16x32_bf16 a[212:215], v[180:183], v[244:247], a[212:215]
s_add_u32 s72, s69, 129024
buffer_load_dwordx4 v4, s[4:7], s72 offen offset:2048 lds
v_mfma_f32_16x16x32_bf16 a[212:215], v[176:179], v[240:243], a[212:215]
ds_read_b128 v[44:47], v17 offset:2048
v_mfma_f32_16x16x32_bf16 a[216:219], v[168:171], v[240:243], a[216:219]
ds_read_b128 v[48:51], v16 offset:4096
v_accvgpr_read_b32 v24, a128
v_mfma_f32_16x16x32_bf16 a[216:219], v[172:175], v[244:247], a[216:219]
ds_read_b128 v[52:55], v17 offset:4096
v_accvgpr_read_b32 v28, a129
v_mfma_f32_16x16x32_bf16 a[220:223], v[164:167], v[244:247], a[220:223]
buffer_store_dwordx4 v[20:23], v1, s[44:47], s80 offen sc1
v_mfma_f32_16x16x32_bf16 a[220:223], v[160:163], v[240:243], a[220:223]
s_add_u32 s72, s69, 144384
buffer_load_dwordx4 v5, s[4:7], s72 offen offset:3072 lds
v_mfma_f32_16x16x32_bf16 a[252:255], v[160:163], v[248:251], a[252:255]
ds_read_b128 v[56:59], v16 offset:6144
v_accvgpr_read_b32 v25, a130
v_mfma_f32_16x16x32_bf16 a[252:255], v[164:167], v[252:255], a[252:255]
ds_read_b128 v[60:63], v17 offset:6144
v_accvgpr_read_b32 v29, a131
v_mfma_f32_16x16x32_bf16 a[248:251], v[172:175], v[252:255], a[248:251]
ds_read_b64_tr_b16 v[72:73], v9 offset:0
v_accvgpr_read_b32 v26, a132
v_mfma_f32_16x16x32_bf16 a[248:251], v[168:171], v[248:251], a[248:251]
s_add_u32 m0, s63, 102400
ds_read_b64_tr_b16 v[74:75], v9 offset:1024
v_accvgpr_read_b32 v30, a133
v_mfma_f32_16x16x32_bf16 a[244:247], v[176:179], v[248:251], a[244:247]
s_add_u32 s72, s70, 0
buffer_load_dwordx4 v4, s[4:7], s72 offen lds
v_mfma_f32_16x16x32_bf16 a[244:247], v[180:183], v[252:255], a[244:247]
ds_read_b64_tr_b16 v[76:77], v9 offset:8192
v_accvgpr_read_b32 v27, a134
v_mfma_f32_16x16x32_bf16 a[240:243], v[188:191], v[252:255], a[240:243]
v_accvgpr_read_b32 v31, a135
v_cvt_pk_bf16_f32 v24, v24, v28
v_mfma_f32_16x16x32_bf16 a[240:243], v[184:187], v[248:251], a[240:243]
ds_read_b64_tr_b16 v[78:79], v9 offset:9216
v_cvt_pk_bf16_f32 v25, v25, v29
v_mfma_f32_16x16x32_bf16 a[236:239], v[216:219], v[248:251], a[236:239]
ds_read_b64_tr_b16 v[80:81], v10 offset:0
v_cvt_pk_bf16_f32 v26, v26, v30
v_mfma_f32_16x16x32_bf16 a[236:239], v[220:223], v[252:255], a[236:239]
s_add_u32 s72, s70, 15360
buffer_load_dwordx4 v5, s[4:7], s72 offen offset:1024 lds
v_mfma_f32_16x16x32_bf16 a[232:235], v[212:215], v[252:255], a[232:235]
ds_read_b64_tr_b16 v[82:83], v10 offset:1024
v_cvt_pk_bf16_f32 v27, v27, v31
v_mfma_f32_16x16x32_bf16 a[232:235], v[208:211], v[248:251], a[232:235]
s_add_u32 s80, s78, 0
ds_read_b64_tr_b16 v[84:85], v10 offset:8192
v_mfma_f32_16x16x32_bf16 a[228:231], v[200:203], v[248:251], a[228:231]
ds_read_b64_tr_b16 v[86:87], v10 offset:9216
v_mfma_f32_16x16x32_bf16 a[228:231], v[204:207], v[252:255], a[228:231]
buffer_store_dwordx4 v[24:27], v1, s[44:47], s80 offen sc1
v_mfma_f32_16x16x32_bf16 a[224:227], v[196:199], v[252:255], a[224:227]
s_add_u32 s72, s70, 129024
buffer_load_dwordx4 v4, s[4:7], s72 offen offset:2048 lds
v_mfma_f32_16x16x32_bf16 a[224:227], v[192:195], v[248:251], a[224:227]
s_waitcnt lgkmcnt(8)
v_mfma_f32_16x16x32_bf16 v[128:131], v[64:67], v[32:35], 0
ds_read_b64_tr_b16 v[88:89], v11 offset:0
v_mfma_f32_16x16x32_bf16 v[128:131], v[68:71], v[36:39], v[128:131]
ds_read_b64_tr_b16 v[90:91], v11 offset:1024
v_mfma_f32_16x16x32_bf16 v[132:135], v[68:71], v[44:47], 0
v_accvgpr_read_b32 v20, a12
v_accvgpr_read_b32 v28, a13
v_mfma_f32_16x16x32_bf16 v[132:135], v[64:67], v[40:43], v[132:135]
s_add_u32 s72, s70, 144384
buffer_load_dwordx4 v5, s[4:7], s72 offen offset:3072 lds
v_mfma_f32_16x16x32_bf16 v[136:139], v[64:67], v[48:51], 0
s_lshl_b32 s71, s73, 12
ds_read_b64_tr_b16 v[92:93], v11 offset:8192
v_accvgpr_read_b32 v21, a14
v_mfma_f32_16x16x32_bf16 v[136:139], v[68:71], v[52:55], v[136:139]
s_add_u32 s71, s71, s66
v_accvgpr_read_b32 v29, a15
v_accvgpr_read_b32 v22, a44
v_mfma_f32_16x16x32_bf16 v[140:143], v[68:71], v[60:63], 0
s_add_u32 m0, s64, 32768
ds_read_b64_tr_b16 v[94:95], v11 offset:9216
v_accvgpr_read_b32 v30, a45
v_mfma_f32_16x16x32_bf16 v[140:143], v[64:67], v[56:59], v[140:143]
s_waitcnt lgkmcnt(8)
v_accvgpr_read_b32 v23, a46
v_accvgpr_read_b32 v31, a47
v_mfma_f32_16x16x32_bf16 v[156:159], v[72:75], v[56:59], 0
s_add_u32 s72, s71, 0
buffer_load_dwordx4 v6, s[12:15], s72 offen lds
v_mfma_f32_16x16x32_bf16 v[156:159], v[76:79], v[60:63], v[156:159]
s_add_u32 s73, s62, 3
ds_read_b64_tr_b16 v[64:65], v12 offset:0
v_mul_f32 v20, s79, v20
v_mfma_f32_16x16x32_bf16 v[152:155], v[76:79], v[52:55], 0
s_add_u32 s70, s73, s65
ds_read_b64_tr_b16 v[66:67], v12 offset:1024
v_mul_f32 v28, s79, v28
v_mfma_f32_16x16x32_bf16 v[152:155], v[72:75], v[48:51], v[152:155]
s_add_u32 s72, s71, 31744
buffer_load_dwordx4 v6, s[12:15], s72 offen offset:1024 lds
v_mfma_f32_16x16x32_bf16 v[148:151], v[72:75], v[40:43], 0
s_and_b32 s70, s70, 3
v_mul_f32 v21, s79, v21
v_mul_f32 v29, s79, v29
v_mfma_f32_16x16x32_bf16 v[148:151], v[76:79], v[44:47], v[148:151]
s_and_b32 s73, s73, 12
ds_read_b64_tr_b16 v[68:69], v12 offset:8192
v_mul_f32 v22, s79, v22
v_mfma_f32_16x16x32_bf16 v[144:147], v[76:79], v[36:39], 0
s_or_b32 s73, s73, s70
ds_read_b64_tr_b16 v[70:71], v12 offset:9216
v_mul_f32 v30, s79, v30
v_mfma_f32_16x16x32_bf16 v[144:147], v[72:75], v[32:35], v[144:147]
s_waitcnt lgkmcnt(8)
v_mul_f32 v23, s79, v23
v_mul_f32 v31, s79, v31
v_mfma_f32_16x16x32_bf16 v[160:163], v[80:83], v[32:35], 0
s_lshl_b32 s73, s73, 7
ds_read_b64_tr_b16 v[72:73], v13 offset:0
v_cvt_pk_bf16_f32 v20, v20, v28
v_mfma_f32_16x16x32_bf16 v[160:163], v[84:87], v[36:39], v[160:163]
s_add_u32 s72, s71, 63488
buffer_load_dwordx4 v7, s[12:15], s72 offen offset:2048 lds
v_mfma_f32_16x16x32_bf16 v[164:167], v[84:87], v[44:47], 0
s_add_u32 s69, s73, s67
ds_read_b64_tr_b16 v[74:75], v13 offset:1024
v_cvt_pk_bf16_f32 v21, v21, v29
v_mfma_f32_16x16x32_bf16 v[164:167], v[80:83], v[40:43], v[164:167]
s_add_u32 s70, s73, s68
v_cvt_pk_bf16_f32 v22, v22, v30
v_cvt_pk_bf16_f32 v23, v23, v31
v_mfma_f32_16x16x32_bf16 v[168:171], v[80:83], v[48:51], 0
s_waitcnt vmcnt(20)
ds_read_b64_tr_b16 v[76:77], v13 offset:8192
v_mfma_f32_16x16x32_bf16 v[168:171], v[84:87], v[52:55], v[168:171]
s_add_u32 s80, s77, 12288
ds_read_b64_tr_b16 v[78:79], v13 offset:9216
v_mfma_f32_16x16x32_bf16 v[172:175], v[84:87], v[60:63], 0
s_add_u32 s72, s71, 95232
ds_read_b128 v[96:99], v18 offset:0
v_mfma_f32_16x16x32_bf16 v[172:175], v[80:83], v[56:59], v[172:175]
s_waitcnt lgkmcnt(9)
buffer_load_dwordx4 v7, s[12:15], s72 offen offset:3072 lds
v_mfma_f32_16x16x32_bf16 v[188:191], v[88:91], v[56:59], 0
ds_read_b64_tr_b16 v[80:81], v14 offset:0
v_accvgpr_read_b32 v24, a136
v_mfma_f32_16x16x32_bf16 v[188:191], v[92:95], v[60:63], v[188:191]
ds_read_b64_tr_b16 v[82:83], v14 offset:1024
v_accvgpr_read_b32 v28, a137
v_mfma_f32_16x16x32_bf16 v[184:187], v[92:95], v[52:55], 0
ds_read_b128 v[100:103], v19 offset:0
v_accvgpr_read_b32 v25, a138
v_mfma_f32_16x16x32_bf16 v[184:187], v[88:91], v[48:51], v[184:187]
ds_read_b64_tr_b16 v[84:85], v14 offset:8192
v_accvgpr_read_b32 v29, a139
v_mfma_f32_16x16x32_bf16 v[180:183], v[88:91], v[40:43], 0
buffer_store_dwordx4 v[20:23], v1, s[44:47], s80 offen sc1
v_mfma_f32_16x16x32_bf16 v[180:183], v[92:95], v[44:47], v[180:183]
s_add_u32 m0, s63, 131072
ds_read_b64_tr_b16 v[86:87], v14 offset:9216
v_accvgpr_read_b32 v26, a140
v_mfma_f32_16x16x32_bf16 v[176:179], v[92:95], v[36:39], 0
s_add_u32 s72, s69, 0
buffer_load_dwordx4 v4, s[4:7], s72 offen lds
v_mfma_f32_16x16x32_bf16 v[176:179], v[88:91], v[32:35], v[176:179]
s_waitcnt lgkmcnt(10)
ds_read_b128 v[104:107], v18 offset:2048
v_accvgpr_read_b32 v30, a141
v_mfma_f32_16x16x32_bf16 v[192:195], v[64:67], v[32:35], 0
ds_read_b64_tr_b16 v[88:89], v15 offset:0
v_accvgpr_read_b32 v27, a142
v_mfma_f32_16x16x32_bf16 v[192:195], v[68:71], v[36:39], v[192:195]
ds_read_b64_tr_b16 v[90:91], v15 offset:1024
v_accvgpr_read_b32 v31, a143
v_mfma_f32_16x16x32_bf16 v[196:199], v[68:71], v[44:47], 0
ds_read_b64_tr_b16 v[92:93], v15 offset:8192
v_cvt_pk_bf16_f32 v24, v24, v28
v_mfma_f32_16x16x32_bf16 v[196:199], v[64:67], v[40:43], v[196:199]
s_add_u32 s72, s69, 15360
buffer_load_dwordx4 v5, s[4:7], s72 offen offset:1024 lds
v_mfma_f32_16x16x32_bf16 v[200:203], v[64:67], v[48:51], 0
ds_read_b64_tr_b16 v[94:95], v15 offset:9216
v_cvt_pk_bf16_f32 v25, v25, v29
v_mfma_f32_16x16x32_bf16 v[200:203], v[68:71], v[52:55], v[200:203]
ds_read_b128 v[108:111], v19 offset:2048
v_cvt_pk_bf16_f32 v26, v26, v30
v_mfma_f32_16x16x32_bf16 v[204:207], v[68:71], v[60:63], 0
v_cvt_pk_bf16_f32 v27, v27, v31
v_mfma_f32_16x16x32_bf16 v[204:207], v[64:67], v[56:59], v[204:207]
s_waitcnt lgkmcnt(12)
ds_read_b128 v[112:115], v18 offset:4096
v_mfma_f32_16x16x32_bf16 v[220:223], v[72:75], v[56:59], 0
s_add_u32 s72, s69, 129024
buffer_load_dwordx4 v4, s[4:7], s72 offen offset:2048 lds
v_mfma_f32_16x16x32_bf16 v[220:223], v[76:79], v[60:63], v[220:223]
s_add_u32 s80, s78, 8192
buffer_store_dwordx4 v[24:27], v1, s[44:47], s80 offen sc1
v_mfma_f32_16x16x32_bf16 v[216:219], v[76:79], v[52:55], 0
s_waitcnt vmcnt(21) lgkmcnt(2)
ds_read_b128 v[116:119], v19 offset:4096
v_mfma_f32_16x16x32_bf16 v[216:219], v[72:75], v[48:51], v[216:219]
s_barrier
ds_read_b128 v[120:123], v18 offset:6144
v_mfma_f32_16x16x32_bf16 v[212:215], v[72:75], v[40:43], 0
ds_read_b64_tr_b16 v[64:65], v8 offset:16384
ds_read_b64_tr_b16 v[66:67], v8 offset:17408
v_mfma_f32_16x16x32_bf16 v[212:215], v[76:79], v[44:47], v[212:215]
ds_read_b64_tr_b16 v[68:69], v8 offset:24576
v_mfma_f32_16x16x32_bf16 v[208:211], v[76:79], v[36:39], 0
s_add_u32 s72, s69, 144384
buffer_load_dwordx4 v5, s[4:7], s72 offen offset:3072 lds
v_mfma_f32_16x16x32_bf16 v[208:211], v[72:75], v[32:35], v[208:211]
ds_read_b64_tr_b16 v[70:71], v8 offset:25600
v_accvgpr_read_b32 v20, a16
v_mfma_f32_16x16x32_bf16 v[224:227], v[80:83], v[32:35], 0
ds_read_b64_tr_b16 v[72:73], v9 offset:16384
v_accvgpr_read_b32 v28, a17
v_mfma_f32_16x16x32_bf16 v[224:227], v[84:87], v[36:39], v[224:227]
ds_read_b64_tr_b16 v[74:75], v9 offset:17408
v_accvgpr_read_b32 v21, a18
v_mfma_f32_16x16x32_bf16 v[228:231], v[84:87], v[44:47], 0
s_add_u32 m0, s63, 135168
v_accvgpr_read_b32 v29, a19
v_accvgpr_read_b32 v22, a48
v_mfma_f32_16x16x32_bf16 v[228:231], v[80:83], v[40:43], v[228:231]
s_add_u32 s72, s70, 0
buffer_load_dwordx4 v4, s[4:7], s72 offen lds
v_mfma_f32_16x16x32_bf16 v[232:235], v[80:83], v[48:51], 0
ds_read_b64_tr_b16 v[76:77], v9 offset:24576
v_accvgpr_read_b32 v30, a49
v_mfma_f32_16x16x32_bf16 v[232:235], v[84:87], v[52:55], v[232:235]
ds_read_b128 v[124:127], v19 offset:6144
v_accvgpr_read_b32 v23, a50
v_mfma_f32_16x16x32_bf16 v[236:239], v[84:87], v[60:63], 0
ds_read_b64_tr_b16 v[78:79], v9 offset:25600
v_accvgpr_read_b32 v31, a51
v_mfma_f32_16x16x32_bf16 v[236:239], v[80:83], v[56:59], v[236:239]
v_mul_f32 v20, s79, v20
v_mul_f32 v28, s79, v28
v_mfma_f32_16x16x32_bf16 v[252:255], v[88:91], v[56:59], 0
s_add_u32 s72, s70, 15360
buffer_load_dwordx4 v5, s[4:7], s72 offen offset:1024 lds
v_mfma_f32_16x16x32_bf16 v[252:255], v[92:95], v[60:63], v[252:255]
ds_read_b64_tr_b16 v[80:81], v10 offset:16384
v_mul_f32 v21, s79, v21
v_mfma_f32_16x16x32_bf16 v[248:251], v[92:95], v[52:55], 0
ds_read_b64_tr_b16 v[82:83], v10 offset:17408
v_mul_f32 v29, s79, v29
v_mfma_f32_16x16x32_bf16 v[248:251], v[88:91], v[48:51], v[248:251]
v_mul_f32 v22, s79, v22
v_mul_f32 v30, s79, v30
v_mfma_f32_16x16x32_bf16 v[244:247], v[88:91], v[40:43], 0
ds_read_b64_tr_b16 v[84:85], v10 offset:24576
v_mul_f32 v23, s79, v23
v_mfma_f32_16x16x32_bf16 v[244:247], v[92:95], v[44:47], v[244:247]
ds_read_b64_tr_b16 v[86:87], v10 offset:25600
v_mul_f32 v31, s79, v31
v_mfma_f32_16x16x32_bf16 v[240:243], v[92:95], v[36:39], 0
s_add_u32 s72, s70, 129024
buffer_load_dwordx4 v4, s[4:7], s72 offen offset:2048 lds
v_mfma_f32_16x16x32_bf16 v[240:243], v[88:91], v[32:35], v[240:243]
s_waitcnt lgkmcnt(5)
v_cvt_pk_bf16_f32 v20, v20, v28
v_cvt_pk_bf16_f32 v21, v21, v29
v_mfma_f32_16x16x32_bf16 v[128:131], v[64:67], v[96:99], v[128:131]
ds_read_b64_tr_b16 v[88:89], v11 offset:16384
v_cvt_pk_bf16_f32 v22, v22, v30
v_mfma_f32_16x16x32_bf16 v[128:131], v[68:71], v[100:103], v[128:131]
ds_read_b64_tr_b16 v[90:91], v11 offset:17408
v_cvt_pk_bf16_f32 v23, v23, v31
v_mfma_f32_16x16x32_bf16 v[132:135], v[68:71], v[108:111], v[132:135]
s_add_u32 s80, s77, 32768
buffer_store_dwordx4 v[20:23], v1, s[44:47], s80 offen sc1
v_mfma_f32_16x16x32_bf16 v[132:135], v[64:67], v[104:107], v[132:135]
s_add_u32 s72, s70, 144384
buffer_load_dwordx4 v5, s[4:7], s72 offen offset:3072 lds
v_mfma_f32_16x16x32_bf16 v[136:139], v[64:67], v[112:115], v[136:139]
ds_read_b64_tr_b16 v[92:93], v11 offset:24576
v_accvgpr_read_b32 v24, a144
v_mfma_f32_16x16x32_bf16 v[136:139], v[68:71], v[116:119], v[136:139]
s_lshl_b32 s71, s73, 12
v_accvgpr_read_b32 v28, a145
v_accvgpr_read_b32 v25, a146
v_mfma_f32_16x16x32_bf16 v[140:143], v[68:71], v[124:127], v[140:143]
s_add_u32 s71, s71, s66
ds_read_b64_tr_b16 v[94:95], v11 offset:25600
v_accvgpr_read_b32 v29, a147
v_mfma_f32_16x16x32_bf16 v[140:143], v[64:67], v[120:123], v[140:143]
s_waitcnt lgkmcnt(8)
v_accvgpr_read_b32 v26, a148
v_accvgpr_read_b32 v30, a149
v_mfma_f32_16x16x32_bf16 v[156:159], v[72:75], v[120:123], v[156:159]
s_add_u32 m0, s64, 0
ds_read_b64_tr_b16 v[64:65], v12 offset:16384
v_accvgpr_read_b32 v27, a150
v_mfma_f32_16x16x32_bf16 v[156:159], v[76:79], v[124:127], v[156:159]
s_add_u32 s72, s71, 0
buffer_load_dwordx4 v6, s[12:15], s72 offen lds
v_mfma_f32_16x16x32_bf16 v[152:155], v[76:79], v[116:119], v[152:155]
s_add_u32 s73, s62, 4
ds_read_b64_tr_b16 v[66:67], v12 offset:17408
v_accvgpr_read_b32 v31, a151
v_mfma_f32_16x16x32_bf16 v[152:155], v[72:75], v[112:115], v[152:155]
s_add_u32 s70, s73, s65
v_cvt_pk_bf16_f32 v24, v24, v28
v_cvt_pk_bf16_f32 v25, v25, v29
v_mfma_f32_16x16x32_bf16 v[148:151], v[72:75], v[104:107], v[148:151]
s_and_b32 s70, s70, 3
ds_read_b64_tr_b16 v[68:69], v12 offset:24576
v_cvt_pk_bf16_f32 v26, v26, v30
v_mfma_f32_16x16x32_bf16 v[148:151], v[76:79], v[108:111], v[148:151]
s_and_b32 s73, s73, 12
ds_read_b64_tr_b16 v[70:71], v12 offset:25600
v_cvt_pk_bf16_f32 v27, v27, v31
v_mfma_f32_16x16x32_bf16 v[144:147], v[76:79], v[100:103], v[144:147]
s_add_u32 s72, s71, 31744
buffer_load_dwordx4 v6, s[12:15], s72 offen offset:1024 lds
v_mfma_f32_16x16x32_bf16 v[144:147], v[72:75], v[96:99], v[144:147]
s_waitcnt lgkmcnt(8)
v_mfma_f32_16x16x32_bf16 v[160:163], v[80:83], v[96:99], v[160:163]
s_or_b32 s73, s73, s70
ds_read_b64_tr_b16 v[72:73], v13 offset:16384
v_mfma_f32_16x16x32_bf16 v[160:163], v[84:87], v[100:103], v[160:163]
s_lshl_b32 s73, s73, 7
ds_read_b64_tr_b16 v[74:75], v13 offset:17408
v_mfma_f32_16x16x32_bf16 v[164:167], v[84:87], v[108:111], v[164:167]
s_add_u32 s69, s73, s67
v_mfma_f32_16x16x32_bf16 v[164:167], v[80:83], v[104:107], v[164:167]
s_add_u32 s72, s71, 63488
buffer_load_dwordx4 v7, s[12:15], s72 offen offset:2048 lds
v_mfma_f32_16x16x32_bf16 v[168:171], v[80:83], v[112:115], v[168:171]
s_waitcnt vmcnt(18)
ds_read_b64_tr_b16 v[76:77], v13 offset:24576
v_mfma_f32_16x16x32_bf16 v[168:171], v[84:87], v[116:119], v[168:171]
s_add_u32 s70, s73, s68
ds_read_b128 v[32:35], v18 offset:32768
v_mfma_f32_16x16x32_bf16 v[172:175], v[84:87], v[124:127], v[172:175]
s_add_u32 s80, s78, 32768
ds_read_b64_tr_b16 v[78:79], v13 offset:25600
v_mfma_f32_16x16x32_bf16 v[172:175], v[80:83], v[120:123], v[172:175]
s_waitcnt lgkmcnt(9)
ds_read_b128 v[36:39], v19 offset:32768
v_mfma_f32_16x16x32_bf16 v[188:191], v[88:91], v[120:123], v[188:191]
s_add_u32 s72, s71, 95232
buffer_load_dwordx4 v7, s[12:15], s72 offen offset:3072 lds
v_mfma_f32_16x16x32_bf16 v[188:191], v[92:95], v[124:127], v[188:191]
ds_read_b64_tr_b16 v[80:81], v14 offset:16384
v_mfma_f32_16x16x32_bf16 v[184:187], v[92:95], v[116:119], v[184:187]
ds_read_b64_tr_b16 v[82:83], v14 offset:17408
v_mfma_f32_16x16x32_bf16 v[184:187], v[88:91], v[112:115], v[184:187]
buffer_store_dwordx4 v[24:27], v1, s[44:47], s80 offen sc1
v_mfma_f32_16x16x32_bf16 v[180:183], v[88:91], v[104:107], v[180:183]
ds_read_b64_tr_b16 v[84:85], v14 offset:24576
v_accvgpr_read_b32 v20, a20
v_mfma_f32_16x16x32_bf16 v[180:183], v[92:95], v[108:111], v[180:183]
s_add_u32 m0, s63, 65536
ds_read_b64_tr_b16 v[86:87], v14 offset:25600
v_accvgpr_read_b32 v28, a21
v_mfma_f32_16x16x32_bf16 v[176:179], v[92:95], v[100:103], v[176:179]
s_add_u32 s72, s69, 0
buffer_load_dwordx4 v4, s[4:7], s72 offen lds
v_mfma_f32_16x16x32_bf16 v[176:179], v[88:91], v[96:99], v[176:179]
s_waitcnt lgkmcnt(10)
ds_read_b128 v[40:43], v18 offset:34816
v_accvgpr_read_b32 v21, a22
v_mfma_f32_16x16x32_bf16 v[192:195], v[64:67], v[96:99], v[192:195]
ds_read_b64_tr_b16 v[88:89], v15 offset:16384
v_accvgpr_read_b32 v29, a23
v_mfma_f32_16x16x32_bf16 v[192:195], v[68:71], v[100:103], v[192:195]
ds_read_b64_tr_b16 v[90:91], v15 offset:17408
v_accvgpr_read_b32 v22, a52
v_mfma_f32_16x16x32_bf16 v[196:199], v[68:71], v[108:111], v[196:199]
ds_read_b64_tr_b16 v[92:93], v15 offset:24576
v_accvgpr_read_b32 v30, a53
v_mfma_f32_16x16x32_bf16 v[196:199], v[64:67], v[104:107], v[196:199]
s_add_u32 s72, s69, 15360
buffer_load_dwordx4 v5, s[4:7], s72 offen offset:1024 lds
v_mfma_f32_16x16x32_bf16 v[200:203], v[64:67], v[112:115], v[200:203]
ds_read_b64_tr_b16 v[94:95], v15 offset:25600
v_accvgpr_read_b32 v23, a54
v_mfma_f32_16x16x32_bf16 v[200:203], v[68:71], v[116:119], v[200:203]
ds_read_b128 v[44:47], v19 offset:34816
v_accvgpr_read_b32 v31, a55
v_mfma_f32_16x16x32_bf16 v[204:207], v[68:71], v[124:127], v[204:207]
v_mul_f32 v20, s79, v20
v_mul_f32 v28, s79, v28
v_mfma_f32_16x16x32_bf16 v[204:207], v[64:67], v[120:123], v[204:207]
s_waitcnt lgkmcnt(11)
ds_read_b128 v[48:51], v18 offset:36864
v_mul_f32 v21, s79, v21
v_mfma_f32_16x16x32_bf16 v[220:223], v[72:75], v[120:123], v[220:223]
s_add_u32 s72, s69, 129024
buffer_load_dwordx4 v4, s[4:7], s72 offen offset:2048 lds
v_mfma_f32_16x16x32_bf16 v[220:223], v[76:79], v[124:127], v[220:223]
v_mul_f32 v29, s79, v29
v_mul_f32 v22, s79, v22
v_mfma_f32_16x16x32_bf16 v[216:219], v[76:79], v[116:119], v[216:219]
s_waitcnt vmcnt(19) lgkmcnt(2)
ds_read_b128 v[52:55], v19 offset:36864
v_mul_f32 v30, s79, v30
v_mfma_f32_16x16x32_bf16 v[216:219], v[72:75], v[112:115], v[216:219]
s_barrier
ds_read_b128 v[56:59], v18 offset:38912
v_mul_f32 v23, s79, v23
v_mfma_f32_16x16x32_bf16 v[212:215], v[72:75], v[104:107], v[212:215]
ds_read_b64_tr_b16 v[64:65], v8 offset:32768
ds_read_b64_tr_b16 v[66:67], v8 offset:33792
v_mfma_f32_16x16x32_bf16 v[212:215], v[76:79], v[108:111], v[212:215]
ds_read_b64_tr_b16 v[68:69], v8 offset:40960
v_mul_f32 v31, s79, v31
v_mfma_f32_16x16x32_bf16 v[208:211], v[76:79], v[100:103], v[208:211]
s_add_u32 s72, s69, 144384
buffer_load_dwordx4 v5, s[4:7], s72 offen offset:3072 lds
v_mfma_f32_16x16x32_bf16 v[208:211], v[72:75], v[96:99], v[208:211]
ds_read_b64_tr_b16 v[70:71], v8 offset:41984
v_cvt_pk_bf16_f32 v20, v20, v28
v_mfma_f32_16x16x32_bf16 v[224:227], v[80:83], v[96:99], v[224:227]
ds_read_b64_tr_b16 v[72:73], v9 offset:32768
v_cvt_pk_bf16_f32 v21, v21, v29
v_mfma_f32_16x16x32_bf16 v[224:227], v[84:87], v[100:103], v[224:227]
ds_read_b64_tr_b16 v[74:75], v9 offset:33792
v_cvt_pk_bf16_f32 v22, v22, v30
v_mfma_f32_16x16x32_bf16 v[228:231], v[84:87], v[108:111], v[228:231]
s_add_u32 m0, s63, 69632
v_cvt_pk_bf16_f32 v23, v23, v31
v_accvgpr_read_b32 v24, a152
v_mfma_f32_16x16x32_bf16 v[228:231], v[80:83], v[104:107], v[228:231]
s_add_u32 s72, s70, 0
buffer_load_dwordx4 v4, s[4:7], s72 offen lds
v_mfma_f32_16x16x32_bf16 v[232:235], v[80:83], v[112:115], v[232:235]
s_add_u32 s80, s77, 36864
ds_read_b64_tr_b16 v[76:77], v9 offset:40960
v_accvgpr_read_b32 v28, a153
v_mfma_f32_16x16x32_bf16 v[232:235], v[84:87], v[116:119], v[232:235]
ds_read_b128 v[60:63], v19 offset:38912
v_accvgpr_read_b32 v25, a154
v_mfma_f32_16x16x32_bf16 v[236:239], v[84:87], v[124:127], v[236:239]
ds_read_b64_tr_b16 v[78:79], v9 offset:41984
v_accvgpr_read_b32 v29, a155
v_mfma_f32_16x16x32_bf16 v[236:239], v[80:83], v[120:123], v[236:239]
buffer_store_dwordx4 v[20:23], v1, s[44:47], s80 offen sc1
v_mfma_f32_16x16x32_bf16 v[252:255], v[88:91], v[120:123], v[252:255]
s_add_u32 s72, s70, 15360
buffer_load_dwordx4 v5, s[4:7], s72 offen offset:1024 lds
v_mfma_f32_16x16x32_bf16 v[252:255], v[92:95], v[124:127], v[252:255]
ds_read_b64_tr_b16 v[80:81], v10 offset:32768
v_accvgpr_read_b32 v26, a156
v_mfma_f32_16x16x32_bf16 v[248:251], v[92:95], v[116:119], v[248:251]
ds_read_b64_tr_b16 v[82:83], v10 offset:33792
v_accvgpr_read_b32 v30, a157
v_mfma_f32_16x16x32_bf16 v[248:251], v[88:91], v[112:115], v[248:251]
v_accvgpr_read_b32 v27, a158
v_accvgpr_read_b32 v31, a159
v_mfma_f32_16x16x32_bf16 v[244:247], v[88:91], v[104:107], v[244:247]
ds_read_b64_tr_b16 v[84:85], v10 offset:40960
v_cvt_pk_bf16_f32 v24, v24, v28
v_mfma_f32_16x16x32_bf16 v[244:247], v[92:95], v[108:111], v[244:247]
ds_read_b64_tr_b16 v[86:87], v10 offset:41984
v_cvt_pk_bf16_f32 v25, v25, v29
v_mfma_f32_16x16x32_bf16 v[240:243], v[92:95], v[100:103], v[240:243]
s_add_u32 s72, s70, 129024
buffer_load_dwordx4 v4, s[4:7], s72 offen offset:2048 lds
v_mfma_f32_16x16x32_bf16 v[240:243], v[88:91], v[96:99], v[240:243]
s_waitcnt lgkmcnt(5)
v_cvt_pk_bf16_f32 v26, v26, v30
v_cvt_pk_bf16_f32 v27, v27, v31
v_mfma_f32_16x16x32_bf16 v[128:131], v[64:67], v[32:35], v[128:131]
s_add_u32 s80, s78, 40960
ds_read_b64_tr_b16 v[88:89], v11 offset:32768
v_mfma_f32_16x16x32_bf16 v[128:131], v[68:71], v[36:39], v[128:131]
ds_read_b64_tr_b16 v[90:91], v11 offset:33792
v_mfma_f32_16x16x32_bf16 v[132:135], v[68:71], v[44:47], v[132:135]
buffer_store_dwordx4 v[24:27], v1, s[44:47], s80 offen sc1
v_mfma_f32_16x16x32_bf16 v[132:135], v[64:67], v[40:43], v[132:135]
s_add_u32 s72, s70, 144384
buffer_load_dwordx4 v5, s[4:7], s72 offen offset:3072 lds
v_mfma_f32_16x16x32_bf16 v[136:139], v[64:67], v[48:51], v[136:139]
ds_read_b64_tr_b16 v[92:93], v11 offset:40960
v_mfma_f32_16x16x32_bf16 v[136:139], v[68:71], v[52:55], v[136:139]
s_lshl_b32 s71, s73, 12
v_mfma_f32_16x16x32_bf16 v[140:143], v[68:71], v[60:63], v[140:143]
s_add_u32 s71, s71, s66
ds_read_b64_tr_b16 v[94:95], v11 offset:41984
v_mfma_f32_16x16x32_bf16 v[140:143], v[64:67], v[56:59], v[140:143]
s_waitcnt lgkmcnt(8)
v_accvgpr_read_b32 v20, a24
v_accvgpr_read_b32 v28, a25
v_mfma_f32_16x16x32_bf16 v[156:159], v[72:75], v[56:59], v[156:159]
s_add_u32 m0, s64, 16384
ds_read_b64_tr_b16 v[64:65], v12 offset:32768
v_accvgpr_read_b32 v21, a26
v_mfma_f32_16x16x32_bf16 v[156:159], v[76:79], v[60:63], v[156:159]
s_add_u32 s72, s71, 0
buffer_load_dwordx4 v6, s[12:15], s72 offen lds
v_mfma_f32_16x16x32_bf16 v[152:155], v[76:79], v[52:55], v[152:155]
s_add_u32 s73, s62, 5
ds_read_b64_tr_b16 v[66:67], v12 offset:33792
v_accvgpr_read_b32 v29, a27
v_mfma_f32_16x16x32_bf16 v[152:155], v[72:75], v[48:51], v[152:155]
s_add_u32 s70, s73, s65
v_accvgpr_read_b32 v22, a56
v_accvgpr_read_b32 v30, a57
v_mfma_f32_16x16x32_bf16 v[148:151], v[72:75], v[40:43], v[148:151]
s_and_b32 s70, s70, 3
ds_read_b64_tr_b16 v[68:69], v12 offset:40960
v_accvgpr_read_b32 v23, a58
v_mfma_f32_16x16x32_bf16 v[148:151], v[76:79], v[44:47], v[148:151]
s_and_b32 s73, s73, 12
ds_read_b64_tr_b16 v[70:71], v12 offset:41984
v_accvgpr_read_b32 v31, a59
v_mfma_f32_16x16x32_bf16 v[144:147], v[76:79], v[36:39], v[144:147]
s_add_u32 s72, s71, 31744
buffer_load_dwordx4 v6, s[12:15], s72 offen offset:1024 lds
v_mfma_f32_16x16x32_bf16 v[144:147], v[72:75], v[32:35], v[144:147]
s_waitcnt lgkmcnt(8)
v_mul_f32 v20, s79, v20
v_mul_f32 v28, s79, v28
v_mfma_f32_16x16x32_bf16 v[160:163], v[80:83], v[32:35], v[160:163]
s_or_b32 s73, s73, s70
ds_read_b64_tr_b16 v[72:73], v13 offset:32768
v_mul_f32 v21, s79, v21
v_mfma_f32_16x16x32_bf16 v[160:163], v[84:87], v[36:39], v[160:163]
s_lshl_b32 s73, s73, 7
ds_read_b64_tr_b16 v[74:75], v13 offset:33792
v_mul_f32 v29, s79, v29
v_mfma_f32_16x16x32_bf16 v[164:167], v[84:87], v[44:47], v[164:167]
s_add_u32 s69, s73, s67
v_mul_f32 v22, s79, v22
v_mul_f32 v30, s79, v30
v_mfma_f32_16x16x32_bf16 v[164:167], v[80:83], v[40:43], v[164:167]
s_add_u32 s72, s71, 63488
buffer_load_dwordx4 v7, s[12:15], s72 offen offset:2048 lds
v_mfma_f32_16x16x32_bf16 v[168:171], v[80:83], v[48:51], v[168:171]
s_waitcnt vmcnt(18)
ds_read_b64_tr_b16 v[76:77], v13 offset:40960
v_mul_f32 v23, s79, v23
v_mfma_f32_16x16x32_bf16 v[168:171], v[84:87], v[52:55], v[168:171]
s_add_u32 s70, s73, s68
ds_read_b128 v[96:99], v16 offset:0
v_mul_f32 v31, s79, v31
v_mfma_f32_16x16x32_bf16 v[172:175], v[84:87], v[60:63], v[172:175]
ds_read_b64_tr_b16 v[78:79], v13 offset:41984
v_cvt_pk_bf16_f32 v20, v20, v28
v_mfma_f32_16x16x32_bf16 v[172:175], v[80:83], v[56:59], v[172:175]
s_waitcnt lgkmcnt(9)
ds_read_b128 v[100:103], v17 offset:0
v_cvt_pk_bf16_f32 v21, v21, v29
v_mfma_f32_16x16x32_bf16 v[188:191], v[88:91], v[56:59], v[188:191]
s_add_u32 s72, s71, 95232
buffer_load_dwordx4 v7, s[12:15], s72 offen offset:3072 lds
v_mfma_f32_16x16x32_bf16 v[188:191], v[92:95], v[60:63], v[188:191]
ds_read_b64_tr_b16 v[80:81], v14 offset:32768
v_cvt_pk_bf16_f32 v22, v22, v30
v_mfma_f32_16x16x32_bf16 v[184:187], v[92:95], v[52:55], v[184:187]
ds_read_b64_tr_b16 v[82:83], v14 offset:33792
v_cvt_pk_bf16_f32 v23, v23, v31
v_mfma_f32_16x16x32_bf16 v[184:187], v[88:91], v[48:51], v[184:187]
s_add_u32 s80, s77, 40960
buffer_store_dwordx4 v[20:23], v1, s[44:47], s80 offen sc1
v_mfma_f32_16x16x32_bf16 v[180:183], v[88:91], v[40:43], v[180:183]
ds_read_b64_tr_b16 v[84:85], v14 offset:40960
v_mfma_f32_16x16x32_bf16 v[180:183], v[92:95], v[44:47], v[180:183]
s_add_u32 m0, s63, 98304
ds_read_b64_tr_b16 v[86:87], v14 offset:41984
v_accvgpr_read_b32 v24, a160
v_mfma_f32_16x16x32_bf16 v[176:179], v[92:95], v[36:39], v[176:179]
s_add_u32 s72, s69, 0
buffer_load_dwordx4 v4, s[4:7], s72 offen lds
v_mfma_f32_16x16x32_bf16 v[176:179], v[88:91], v[32:35], v[176:179]
s_waitcnt lgkmcnt(10)
ds_read_b128 v[104:107], v16 offset:2048
v_accvgpr_read_b32 v28, a161
v_mfma_f32_16x16x32_bf16 v[192:195], v[64:67], v[32:35], v[192:195]
ds_read_b64_tr_b16 v[88:89], v15 offset:32768
v_accvgpr_read_b32 v25, a162
v_mfma_f32_16x16x32_bf16 v[192:195], v[68:71], v[36:39], v[192:195]
ds_read_b64_tr_b16 v[90:91], v15 offset:33792
v_accvgpr_read_b32 v29, a163
v_mfma_f32_16x16x32_bf16 v[196:199], v[68:71], v[44:47], v[196:199]
ds_read_b64_tr_b16 v[92:93], v15 offset:40960
v_accvgpr_read_b32 v26, a164
v_mfma_f32_16x16x32_bf16 v[196:199], v[64:67], v[40:43], v[196:199]
s_add_u32 s72, s69, 15360
buffer_load_dwordx4 v5, s[4:7], s72 offen offset:1024 lds
v_mfma_f32_16x16x32_bf16 v[200:203], v[64:67], v[48:51], v[200:203]
ds_read_b64_tr_b16 v[94:95], v15 offset:41984
v_accvgpr_read_b32 v30, a165
v_mfma_f32_16x16x32_bf16 v[200:203], v[68:71], v[52:55], v[200:203]
ds_read_b128 v[108:111], v17 offset:2048
v_accvgpr_read_b32 v27, a166
v_mfma_f32_16x16x32_bf16 v[204:207], v[68:71], v[60:63], v[204:207]
v_accvgpr_read_b32 v31, a167
v_cvt_pk_bf16_f32 v24, v24, v28
v_mfma_f32_16x16x32_bf16 v[204:207], v[64:67], v[56:59], v[204:207]
s_waitcnt lgkmcnt(11)
ds_read_b128 v[112:115], v16 offset:4096
v_cvt_pk_bf16_f32 v25, v25, v29
v_mfma_f32_16x16x32_bf16 v[220:223], v[72:75], v[56:59], v[220:223]
s_add_u32 s72, s69, 129024
buffer_load_dwordx4 v4, s[4:7], s72 offen offset:2048 lds
v_mfma_f32_16x16x32_bf16 v[220:223], v[76:79], v[60:63], v[220:223]
v_cvt_pk_bf16_f32 v26, v26, v30
v_cvt_pk_bf16_f32 v27, v27, v31
v_mfma_f32_16x16x32_bf16 v[216:219], v[76:79], v[52:55], v[216:219]
s_waitcnt vmcnt(19) lgkmcnt(2)
ds_read_b128 v[116:119], v17 offset:4096
v_mfma_f32_16x16x32_bf16 v[216:219], v[72:75], v[48:51], v[216:219]
s_barrier
ds_read_b128 v[120:123], v16 offset:6144
v_mfma_f32_16x16x32_bf16 v[212:215], v[72:75], v[40:43], v[212:215]
s_add_u32 s80, s78, 1024
ds_read_b64_tr_b16 v[64:65], v8 offset:0
ds_read_b64_tr_b16 v[66:67], v8 offset:1024
v_mfma_f32_16x16x32_bf16 v[212:215], v[76:79], v[44:47], v[212:215]
ds_read_b64_tr_b16 v[68:69], v8 offset:8192
v_mfma_f32_16x16x32_bf16 v[208:211], v[76:79], v[36:39], v[208:211]
s_add_u32 s72, s69, 144384
buffer_load_dwordx4 v5, s[4:7], s72 offen offset:3072 lds
v_mfma_f32_16x16x32_bf16 v[208:211], v[72:75], v[32:35], v[208:211]
ds_read_b64_tr_b16 v[70:71], v8 offset:9216
v_mfma_f32_16x16x32_bf16 v[224:227], v[80:83], v[32:35], v[224:227]
ds_read_b64_tr_b16 v[72:73], v9 offset:0
v_mfma_f32_16x16x32_bf16 v[224:227], v[84:87], v[36:39], v[224:227]
ds_read_b64_tr_b16 v[74:75], v9 offset:1024
v_mfma_f32_16x16x32_bf16 v[228:231], v[84:87], v[44:47], v[228:231]
s_add_u32 m0, s63, 102400
buffer_store_dwordx4 v[24:27], v1, s[44:47], s80 offen sc1
v_mfma_f32_16x16x32_bf16 v[228:231], v[80:83], v[40:43], v[228:231]
s_add_u32 s72, s70, 0
buffer_load_dwordx4 v4, s[4:7], s72 offen lds
v_mfma_f32_16x16x32_bf16 v[232:235], v[80:83], v[48:51], v[232:235]
ds_read_b64_tr_b16 v[76:77], v9 offset:8192
v_accvgpr_read_b32 v20, a28
v_mfma_f32_16x16x32_bf16 v[232:235], v[84:87], v[52:55], v[232:235]
ds_read_b128 v[124:127], v17 offset:6144
v_accvgpr_read_b32 v28, a29
v_mfma_f32_16x16x32_bf16 v[236:239], v[84:87], v[60:63], v[236:239]
ds_read_b64_tr_b16 v[78:79], v9 offset:9216
v_accvgpr_read_b32 v21, a30
v_mfma_f32_16x16x32_bf16 v[236:239], v[80:83], v[56:59], v[236:239]
v_accvgpr_read_b32 v29, a31
v_accvgpr_read_b32 v22, a60
v_mfma_f32_16x16x32_bf16 v[252:255], v[88:91], v[56:59], v[252:255]
s_add_u32 s72, s70, 15360
buffer_load_dwordx4 v5, s[4:7], s72 offen offset:1024 lds
v_mfma_f32_16x16x32_bf16 v[252:255], v[92:95], v[60:63], v[252:255]
ds_read_b64_tr_b16 v[80:81], v10 offset:0
v_accvgpr_read_b32 v30, a61
v_mfma_f32_16x16x32_bf16 v[248:251], v[92:95], v[52:55], v[248:251]
ds_read_b64_tr_b16 v[82:83], v10 offset:1024
v_accvgpr_read_b32 v23, a62
v_mfma_f32_16x16x32_bf16 v[248:251], v[88:91], v[48:51], v[248:251]
v_accvgpr_read_b32 v31, a63
v_mul_f32 v20, s79, v20
v_mfma_f32_16x16x32_bf16 v[244:247], v[88:91], v[40:43], v[244:247]
ds_read_b64_tr_b16 v[84:85], v10 offset:8192
v_mul_f32 v28, s79, v28
v_mfma_f32_16x16x32_bf16 v[244:247], v[92:95], v[44:47], v[244:247]
ds_read_b64_tr_b16 v[86:87], v10 offset:9216
v_mul_f32 v21, s79, v21
v_mfma_f32_16x16x32_bf16 v[240:243], v[92:95], v[36:39], v[240:243]
s_add_u32 s72, s70, 129024
buffer_load_dwordx4 v4, s[4:7], s72 offen offset:2048 lds
v_mfma_f32_16x16x32_bf16 v[240:243], v[88:91], v[32:35], v[240:243]
s_waitcnt lgkmcnt(5)
v_mul_f32 v29, s79, v29
v_mul_f32 v22, s79, v22
v_mfma_f32_16x16x32_bf16 v[128:131], v[64:67], v[96:99], v[128:131]
ds_read_b64_tr_b16 v[88:89], v11 offset:0
v_mul_f32 v30, s79, v30
v_mfma_f32_16x16x32_bf16 v[128:131], v[68:71], v[100:103], v[128:131]
ds_read_b64_tr_b16 v[90:91], v11 offset:1024
v_mul_f32 v23, s79, v23
v_mfma_f32_16x16x32_bf16 v[132:135], v[68:71], v[108:111], v[132:135]
v_mul_f32 v31, s79, v31
v_cvt_pk_bf16_f32 v20, v20, v28
v_mfma_f32_16x16x32_bf16 v[132:135], v[64:67], v[104:107], v[132:135]
s_add_u32 s72, s70, 144384
buffer_load_dwordx4 v5, s[4:7], s72 offen offset:3072 lds
v_mfma_f32_16x16x32_bf16 v[136:139], v[64:67], v[112:115], v[136:139]
ds_read_b64_tr_b16 v[92:93], v11 offset:8192
v_cvt_pk_bf16_f32 v21, v21, v29
v_mfma_f32_16x16x32_bf16 v[136:139], v[68:71], v[116:119], v[136:139]
s_lshl_b32 s71, s73, 12
v_cvt_pk_bf16_f32 v22, v22, v30
v_cvt_pk_bf16_f32 v23, v23, v31
v_mfma_f32_16x16x32_bf16 v[140:143], v[68:71], v[124:127], v[140:143]
s_add_u32 s71, s71, s66
ds_read_b64_tr_b16 v[94:95], v11 offset:9216
v_mfma_f32_16x16x32_bf16 v[140:143], v[64:67], v[120:123], v[140:143]
s_waitcnt lgkmcnt(8)
v_mfma_f32_16x16x32_bf16 v[156:159], v[72:75], v[120:123], v[156:159]
s_add_u32 m0, s64, 32768
ds_read_b64_tr_b16 v[64:65], v12 offset:0
v_mfma_f32_16x16x32_bf16 v[156:159], v[76:79], v[124:127], v[156:159]
s_add_u32 s72, s71, 0
buffer_load_dwordx4 v6, s[12:15], s72 offen lds
v_mfma_f32_16x16x32_bf16 v[152:155], v[76:79], v[116:119], v[152:155]
s_add_u32 s73, s62, 6
ds_read_b64_tr_b16 v[66:67], v12 offset:1024
v_accvgpr_read_b32 v24, a168
v_mfma_f32_16x16x32_bf16 v[152:155], v[72:75], v[112:115], v[152:155]
s_add_u32 s70, s73, s65
v_accvgpr_read_b32 v28, a169
v_accvgpr_read_b32 v25, a170
v_mfma_f32_16x16x32_bf16 v[148:151], v[72:75], v[104:107], v[148:151]
s_and_b32 s70, s70, 3
ds_read_b64_tr_b16 v[68:69], v12 offset:8192
v_accvgpr_read_b32 v29, a171
v_mfma_f32_16x16x32_bf16 v[148:151], v[76:79], v[108:111], v[148:151]
s_and_b32 s73, s73, 12
ds_read_b64_tr_b16 v[70:71], v12 offset:9216
v_accvgpr_read_b32 v26, a172
v_mfma_f32_16x16x32_bf16 v[144:147], v[76:79], v[100:103], v[144:147]
s_add_u32 s72, s71, 31744
buffer_load_dwordx4 v6, s[12:15], s72 offen offset:1024 lds
v_mfma_f32_16x16x32_bf16 v[144:147], v[72:75], v[96:99], v[144:147]
s_waitcnt lgkmcnt(8)
v_accvgpr_read_b32 v30, a173
v_accvgpr_read_b32 v27, a174
v_mfma_f32_16x16x32_bf16 v[160:163], v[80:83], v[96:99], v[160:163]
s_or_b32 s73, s73, s70
ds_read_b64_tr_b16 v[72:73], v13 offset:0
v_accvgpr_read_b32 v31, a175
v_mfma_f32_16x16x32_bf16 v[160:163], v[84:87], v[100:103], v[160:163]
s_lshl_b32 s73, s73, 7
ds_read_b64_tr_b16 v[74:75], v13 offset:1024
v_cvt_pk_bf16_f32 v24, v24, v28
v_mfma_f32_16x16x32_bf16 v[164:167], v[84:87], v[108:111], v[164:167]
s_add_u32 s69, s73, s67
v_cvt_pk_bf16_f32 v25, v25, v29
v_cvt_pk_bf16_f32 v26, v26, v30
v_mfma_f32_16x16x32_bf16 v[164:167], v[80:83], v[104:107], v[164:167]
s_add_u32 s72, s71, 63488
buffer_load_dwordx4 v7, s[12:15], s72 offen offset:2048 lds
v_mfma_f32_16x16x32_bf16 v[168:171], v[80:83], v[112:115], v[168:171]
s_waitcnt vmcnt(17)
ds_read_b64_tr_b16 v[76:77], v13 offset:8192
v_cvt_pk_bf16_f32 v27, v27, v31
v_mfma_f32_16x16x32_bf16 v[168:171], v[84:87], v[116:119], v[168:171]
s_add_u32 s70, s73, s68
ds_read_b128 v[32:35], v18 offset:0
v_mfma_f32_16x16x32_bf16 v[172:175], v[84:87], v[124:127], v[172:175]
s_add_u32 s80, s77, 45056
ds_read_b64_tr_b16 v[78:79], v13 offset:9216
v_mfma_f32_16x16x32_bf16 v[172:175], v[80:83], v[120:123], v[172:175]
s_waitcnt lgkmcnt(9)
ds_read_b128 v[36:39], v19 offset:0
v_mfma_f32_16x16x32_bf16 v[188:191], v[88:91], v[120:123], v[188:191]
s_add_u32 s72, s71, 95232
buffer_load_dwordx4 v7, s[12:15], s72 offen offset:3072 lds
v_mfma_f32_16x16x32_bf16 v[188:191], v[92:95], v[124:127], v[188:191]
ds_read_b64_tr_b16 v[80:81], v14 offset:0
v_mfma_f32_16x16x32_bf16 v[184:187], v[92:95], v[116:119], v[184:187]
ds_read_b64_tr_b16 v[82:83], v14 offset:1024
v_mfma_f32_16x16x32_bf16 v[184:187], v[88:91], v[112:115], v[184:187]
buffer_store_dwordx4 v[20:23], v1, s[44:47], s80 offen sc1
v_mfma_f32_16x16x32_bf16 v[180:183], v[88:91], v[104:107], v[180:183]
s_add_u32 s80, s78, 9216
ds_read_b64_tr_b16 v[84:85], v14 offset:8192
v_mfma_f32_16x16x32_bf16 v[180:183], v[92:95], v[108:111], v[180:183]
s_add_u32 m0, s63, 131072
ds_read_b64_tr_b16 v[86:87], v14 offset:9216
v_mfma_f32_16x16x32_bf16 v[176:179], v[92:95], v[100:103], v[176:179]
s_add_u32 s72, s69, 0
buffer_load_dwordx4 v4, s[4:7], s72 offen lds
v_mfma_f32_16x16x32_bf16 v[176:179], v[88:91], v[96:99], v[176:179]
s_waitcnt lgkmcnt(10)
ds_read_b128 v[40:43], v18 offset:2048
v_accvgpr_read_b32 v20, a64
v_mfma_f32_16x16x32_bf16 v[192:195], v[64:67], v[96:99], v[192:195]
ds_read_b64_tr_b16 v[88:89], v15 offset:0
v_accvgpr_read_b32 v28, a65
v_mfma_f32_16x16x32_bf16 v[192:195], v[68:71], v[100:103], v[192:195]
ds_read_b64_tr_b16 v[90:91], v15 offset:1024
v_accvgpr_read_b32 v21, a66
v_mfma_f32_16x16x32_bf16 v[196:199], v[68:71], v[108:111], v[196:199]
ds_read_b64_tr_b16 v[92:93], v15 offset:8192
v_accvgpr_read_b32 v29, a67
v_mfma_f32_16x16x32_bf16 v[196:199], v[64:67], v[104:107], v[196:199]
s_add_u32 s72, s69, 15360
buffer_load_dwordx4 v5, s[4:7], s72 offen offset:1024 lds
v_mfma_f32_16x16x32_bf16 v[200:203], v[64:67], v[112:115], v[200:203]
ds_read_b64_tr_b16 v[94:95], v15 offset:9216
v_accvgpr_read_b32 v22, a96
v_mfma_f32_16x16x32_bf16 v[200:203], v[68:71], v[116:119], v[200:203]
ds_read_b128 v[44:47], v19 offset:2048
v_accvgpr_read_b32 v30, a97
v_mfma_f32_16x16x32_bf16 v[204:207], v[68:71], v[124:127], v[204:207]
buffer_store_dwordx4 v[24:27], v1, s[44:47], s80 offen sc1
v_mfma_f32_16x16x32_bf16 v[204:207], v[64:67], v[120:123], v[204:207]
s_waitcnt lgkmcnt(11)
ds_read_b128 v[48:51], v18 offset:4096
v_accvgpr_read_b32 v23, a98
v_mfma_f32_16x16x32_bf16 v[220:223], v[72:75], v[120:123], v[220:223]
s_add_u32 s72, s69, 129024
buffer_load_dwordx4 v4, s[4:7], s72 offen offset:2048 lds
v_mfma_f32_16x16x32_bf16 v[220:223], v[76:79], v[124:127], v[220:223]
v_accvgpr_read_b32 v31, a99
v_mul_f32 v20, s79, v20
v_mfma_f32_16x16x32_bf16 v[216:219], v[76:79], v[116:119], v[216:219]
s_waitcnt vmcnt(19) lgkmcnt(2)
ds_read_b128 v[52:55], v19 offset:4096
v_mul_f32 v28, s79, v28
v_mfma_f32_16x16x32_bf16 v[216:219], v[72:75], v[112:115], v[216:219]
s_barrier
ds_read_b128 v[56:59], v18 offset:6144
v_mul_f32 v21, s79, v21
v_mfma_f32_16x16x32_bf16 v[212:215], v[72:75], v[104:107], v[212:215]
ds_read_b64_tr_b16 v[64:65], v8 offset:16384
ds_read_b64_tr_b16 v[66:67], v8 offset:17408
v_mfma_f32_16x16x32_bf16 v[212:215], v[76:79], v[108:111], v[212:215]
ds_read_b64_tr_b16 v[68:69], v8 offset:24576
v_mul_f32 v29, s79, v29
v_mfma_f32_16x16x32_bf16 v[208:211], v[76:79], v[100:103], v[208:211]
s_add_u32 s72, s69, 144384
buffer_load_dwordx4 v5, s[4:7], s72 offen offset:3072 lds
v_mfma_f32_16x16x32_bf16 v[208:211], v[72:75], v[96:99], v[208:211]
ds_read_b64_tr_b16 v[70:71], v8 offset:25600
v_mul_f32 v22, s79, v22
v_mfma_f32_16x16x32_bf16 v[224:227], v[80:83], v[96:99], v[224:227]
ds_read_b64_tr_b16 v[72:73], v9 offset:16384
v_mul_f32 v30, s79, v30
v_mfma_f32_16x16x32_bf16 v[224:227], v[84:87], v[100:103], v[224:227]
ds_read_b64_tr_b16 v[74:75], v9 offset:17408
v_mul_f32 v23, s79, v23
v_mfma_f32_16x16x32_bf16 v[228:231], v[84:87], v[108:111], v[228:231]
s_add_u32 m0, s63, 135168
v_mul_f32 v31, s79, v31
v_cvt_pk_bf16_f32 v20, v20, v28
v_mfma_f32_16x16x32_bf16 v[228:231], v[80:83], v[104:107], v[228:231]
s_add_u32 s72, s70, 0
buffer_load_dwordx4 v4, s[4:7], s72 offen lds
v_mfma_f32_16x16x32_bf16 v[232:235], v[80:83], v[112:115], v[232:235]
ds_read_b64_tr_b16 v[76:77], v9 offset:24576
v_cvt_pk_bf16_f32 v21, v21, v29
v_mfma_f32_16x16x32_bf16 v[232:235], v[84:87], v[116:119], v[232:235]
ds_read_b128 v[60:63], v19 offset:6144
v_cvt_pk_bf16_f32 v22, v22, v30
v_mfma_f32_16x16x32_bf16 v[236:239], v[84:87], v[124:127], v[236:239]
ds_read_b64_tr_b16 v[78:79], v9 offset:25600
v_cvt_pk_bf16_f32 v23, v23, v31
v_mfma_f32_16x16x32_bf16 v[236:239], v[80:83], v[120:123], v[236:239]
s_add_u32 s80, s77, 1024
buffer_store_dwordx4 v[20:23], v1, s[44:47], s80 offen sc1
v_mfma_f32_16x16x32_bf16 v[252:255], v[88:91], v[120:123], v[252:255]
s_add_u32 s72, s70, 15360
buffer_load_dwordx4 v5, s[4:7], s72 offen offset:1024 lds
v_mfma_f32_16x16x32_bf16 v[252:255], v[92:95], v[124:127], v[252:255]
ds_read_b64_tr_b16 v[80:81], v10 offset:16384
v_accvgpr_read_b32 v24, a176
v_mfma_f32_16x16x32_bf16 v[248:251], v[92:95], v[116:119], v[248:251]
ds_read_b64_tr_b16 v[82:83], v10 offset:17408
v_accvgpr_read_b32 v28, a177
v_mfma_f32_16x16x32_bf16 v[248:251], v[88:91], v[112:115], v[248:251]
v_accvgpr_read_b32 v25, a178
v_accvgpr_read_b32 v29, a179
v_mfma_f32_16x16x32_bf16 v[244:247], v[88:91], v[104:107], v[244:247]
ds_read_b64_tr_b16 v[84:85], v10 offset:24576
v_accvgpr_read_b32 v26, a180
v_mfma_f32_16x16x32_bf16 v[244:247], v[92:95], v[108:111], v[244:247]
ds_read_b64_tr_b16 v[86:87], v10 offset:25600
v_accvgpr_read_b32 v30, a181
v_mfma_f32_16x16x32_bf16 v[240:243], v[92:95], v[100:103], v[240:243]
s_add_u32 s72, s70, 129024
buffer_load_dwordx4 v4, s[4:7], s72 offen offset:2048 lds
v_mfma_f32_16x16x32_bf16 v[240:243], v[88:91], v[96:99], v[240:243]
s_waitcnt lgkmcnt(5)
v_accvgpr_read_b32 v27, a182
v_accvgpr_read_b32 v31, a183
v_mfma_f32_16x16x32_bf16 v[128:131], v[64:67], v[32:35], v[128:131]
ds_read_b64_tr_b16 v[88:89], v11 offset:16384
v_cvt_pk_bf16_f32 v24, v24, v28
v_mfma_f32_16x16x32_bf16 v[128:131], v[68:71], v[36:39], v[128:131]
ds_read_b64_tr_b16 v[90:91], v11 offset:17408
v_cvt_pk_bf16_f32 v25, v25, v29
v_mfma_f32_16x16x32_bf16 v[132:135], v[68:71], v[44:47], v[132:135]
v_cvt_pk_bf16_f32 v26, v26, v30
v_cvt_pk_bf16_f32 v27, v27, v31
v_mfma_f32_16x16x32_bf16 v[132:135], v[64:67], v[40:43], v[132:135]
s_add_u32 s72, s70, 144384
buffer_load_dwordx4 v5, s[4:7], s72 offen offset:3072 lds
v_mfma_f32_16x16x32_bf16 v[136:139], v[64:67], v[48:51], v[136:139]
s_add_u32 s80, s78, 33792
ds_read_b64_tr_b16 v[92:93], v11 offset:24576
v_mfma_f32_16x16x32_bf16 v[136:139], v[68:71], v[52:55], v[136:139]
s_lshl_b32 s71, s73, 12
buffer_store_dwordx4 v[24:27], v1, s[44:47], s80 offen sc1
v_mfma_f32_16x16x32_bf16 v[140:143], v[68:71], v[60:63], v[140:143]
s_add_u32 s71, s71, s66
ds_read_b64_tr_b16 v[94:95], v11 offset:25600
v_mfma_f32_16x16x32_bf16 v[140:143], v[64:67], v[56:59], v[140:143]
s_waitcnt lgkmcnt(8)
v_mfma_f32_16x16x32_bf16 v[156:159], v[72:75], v[56:59], v[156:159]
s_add_u32 m0, s64, 0
ds_read_b64_tr_b16 v[64:65], v12 offset:16384
v_mfma_f32_16x16x32_bf16 v[156:159], v[76:79], v[60:63], v[156:159]
s_add_u32 s72, s71, 0
buffer_load_dwordx4 v6, s[12:15], s72 offen lds
v_mfma_f32_16x16x32_bf16 v[152:155], v[76:79], v[52:55], v[152:155]
s_add_u32 s73, s62, 7
ds_read_b64_tr_b16 v[66:67], v12 offset:17408
v_mfma_f32_16x16x32_bf16 v[152:155], v[72:75], v[48:51], v[152:155]
s_add_u32 s70, s73, s65
v_mfma_f32_16x16x32_bf16 v[148:151], v[72:75], v[40:43], v[148:151]
s_and_b32 s70, s70, 3
ds_read_b64_tr_b16 v[68:69], v12 offset:24576
v_accvgpr_read_b32 v20, a68
v_mfma_f32_16x16x32_bf16 v[148:151], v[76:79], v[44:47], v[148:151]
s_and_b32 s73, s73, 12
ds_read_b64_tr_b16 v[70:71], v12 offset:25600
v_accvgpr_read_b32 v28, a69
v_mfma_f32_16x16x32_bf16 v[144:147], v[76:79], v[36:39], v[144:147]
s_add_u32 s72, s71, 31744
buffer_load_dwordx4 v6, s[12:15], s72 offen offset:1024 lds
v_mfma_f32_16x16x32_bf16 v[144:147], v[72:75], v[32:35], v[144:147]
s_waitcnt lgkmcnt(8)
v_accvgpr_read_b32 v21, a70
v_accvgpr_read_b32 v29, a71
v_mfma_f32_16x16x32_bf16 v[160:163], v[80:83], v[32:35], v[160:163]
s_or_b32 s73, s73, s70
ds_read_b64_tr_b16 v[72:73], v13 offset:16384
v_accvgpr_read_b32 v22, a100
v_mfma_f32_16x16x32_bf16 v[160:163], v[84:87], v[36:39], v[160:163]
s_lshl_b32 s73, s73, 7
ds_read_b64_tr_b16 v[74:75], v13 offset:17408
v_accvgpr_read_b32 v30, a101
v_mfma_f32_16x16x32_bf16 v[164:167], v[84:87], v[44:47], v[164:167]
s_add_u32 s69, s73, s67
v_accvgpr_read_b32 v23, a102
v_accvgpr_read_b32 v31, a103
v_mfma_f32_16x16x32_bf16 v[164:167], v[80:83], v[40:43], v[164:167]
s_add_u32 s72, s71, 63488
buffer_load_dwordx4 v7, s[12:15], s72 offen offset:2048 lds
v_mfma_f32_16x16x32_bf16 v[168:171], v[80:83], v[48:51], v[168:171]
s_waitcnt vmcnt(19)
ds_read_b64_tr_b16 v[76:77], v13 offset:24576
v_mul_f32 v20, s79, v20
v_mfma_f32_16x16x32_bf16 v[168:171], v[84:87], v[52:55], v[168:171]
s_add_u32 s70, s73, s68
ds_read_b128 v[96:99], v18 offset:32768
v_mul_f32 v28, s79, v28
v_mfma_f32_16x16x32_bf16 v[172:175], v[84:87], v[60:63], v[172:175]
ds_read_b64_tr_b16 v[78:79], v13 offset:25600
v_mul_f32 v21, s79, v21
v_mfma_f32_16x16x32_bf16 v[172:175], v[80:83], v[56:59], v[172:175]
s_waitcnt lgkmcnt(9)
ds_read_b128 v[100:103], v19 offset:32768
v_mul_f32 v29, s79, v29
v_mfma_f32_16x16x32_bf16 v[188:191], v[88:91], v[56:59], v[188:191]
s_add_u32 s72, s71, 95232
buffer_load_dwordx4 v7, s[12:15], s72 offen offset:3072 lds
v_mfma_f32_16x16x32_bf16 v[188:191], v[92:95], v[60:63], v[188:191]
ds_read_b64_tr_b16 v[80:81], v14 offset:16384
v_mul_f32 v22, s79, v22
v_mfma_f32_16x16x32_bf16 v[184:187], v[92:95], v[52:55], v[184:187]
ds_read_b64_tr_b16 v[82:83], v14 offset:17408
v_mul_f32 v30, s79, v30
v_mfma_f32_16x16x32_bf16 v[184:187], v[88:91], v[48:51], v[184:187]
v_mul_f32 v23, s79, v23
v_mul_f32 v31, s79, v31
v_mfma_f32_16x16x32_bf16 v[180:183], v[88:91], v[40:43], v[180:183]
ds_read_b64_tr_b16 v[84:85], v14 offset:24576
v_cvt_pk_bf16_f32 v20, v20, v28
v_mfma_f32_16x16x32_bf16 v[180:183], v[92:95], v[44:47], v[180:183]
s_add_u32 m0, s63, 65536
ds_read_b64_tr_b16 v[86:87], v14 offset:25600
v_cvt_pk_bf16_f32 v21, v21, v29
v_mfma_f32_16x16x32_bf16 v[176:179], v[92:95], v[36:39], v[176:179]
s_add_u32 s72, s69, 0
buffer_load_dwordx4 v4, s[4:7], s72 offen lds
v_mfma_f32_16x16x32_bf16 v[176:179], v[88:91], v[32:35], v[176:179]
s_waitcnt lgkmcnt(10)
ds_read_b128 v[104:107], v18 offset:34816
v_cvt_pk_bf16_f32 v22, v22, v30
v_mfma_f32_16x16x32_bf16 v[192:195], v[64:67], v[32:35], v[192:195]
ds_read_b64_tr_b16 v[88:89], v15 offset:16384
v_cvt_pk_bf16_f32 v23, v23, v31
v_mfma_f32_16x16x32_bf16 v[192:195], v[68:71], v[36:39], v[192:195]
s_add_u32 s80, s77, 5120
ds_read_b64_tr_b16 v[90:91], v15 offset:17408
v_mfma_f32_16x16x32_bf16 v[196:199], v[68:71], v[44:47], v[196:199]
ds_read_b64_tr_b16 v[92:93], v15 offset:24576
v_accvgpr_read_b32 v24, a184
v_mfma_f32_16x16x32_bf16 v[196:199], v[64:67], v[40:43], v[196:199]
s_add_u32 s72, s69, 15360
buffer_load_dwordx4 v5, s[4:7], s72 offen offset:1024 lds
v_mfma_f32_16x16x32_bf16 v[200:203], v[64:67], v[48:51], v[200:203]
ds_read_b64_tr_b16 v[94:95], v15 offset:25600
v_accvgpr_read_b32 v28, a185
v_mfma_f32_16x16x32_bf16 v[200:203], v[68:71], v[52:55], v[200:203]
ds_read_b128 v[108:111], v19 offset:34816
v_accvgpr_read_b32 v25, a186
v_mfma_f32_16x16x32_bf16 v[204:207], v[68:71], v[60:63], v[204:207]
buffer_store_dwordx4 v[20:23], v1, s[44:47], s80 offen sc1
v_mfma_f32_16x16x32_bf16 v[204:207], v[64:67], v[56:59], v[204:207]
s_waitcnt lgkmcnt(11)
ds_read_b128 v[112:115], v18 offset:36864
v_accvgpr_read_b32 v29, a187
v_mfma_f32_16x16x32_bf16 v[220:223], v[72:75], v[56:59], v[220:223]
s_add_u32 s72, s69, 129024
buffer_load_dwordx4 v4, s[4:7], s72 offen offset:2048 lds
v_mfma_f32_16x16x32_bf16 v[220:223], v[76:79], v[60:63], v[220:223]
v_accvgpr_read_b32 v26, a188
v_accvgpr_read_b32 v30, a189
v_mfma_f32_16x16x32_bf16 v[216:219], v[76:79], v[52:55], v[216:219]
s_waitcnt vmcnt(20) lgkmcnt(2)
ds_read_b128 v[116:119], v19 offset:36864
v_accvgpr_read_b32 v27, a190
v_mfma_f32_16x16x32_bf16 v[216:219], v[72:75], v[48:51], v[216:219]
s_barrier
ds_read_b128 v[120:123], v18 offset:38912
v_accvgpr_read_b32 v31, a191
v_mfma_f32_16x16x32_bf16 v[212:215], v[72:75], v[40:43], v[212:215]
ds_read_b64_tr_b16 v[64:65], v8 offset:32768
ds_read_b64_tr_b16 v[66:67], v8 offset:33792
v_mfma_f32_16x16x32_bf16 v[212:215], v[76:79], v[44:47], v[212:215]
ds_read_b64_tr_b16 v[68:69], v8 offset:40960
v_cvt_pk_bf16_f32 v24, v24, v28
v_mfma_f32_16x16x32_bf16 v[208:211], v[76:79], v[36:39], v[208:211]
s_add_u32 s72, s69, 144384
buffer_load_dwordx4 v5, s[4:7], s72 offen offset:3072 lds
v_mfma_f32_16x16x32_bf16 v[208:211], v[72:75], v[32:35], v[208:211]
ds_read_b64_tr_b16 v[70:71], v8 offset:41984
v_cvt_pk_bf16_f32 v25, v25, v29
v_mfma_f32_16x16x32_bf16 v[224:227], v[80:83], v[32:35], v[224:227]
ds_read_b64_tr_b16 v[72:73], v9 offset:32768
v_cvt_pk_bf16_f32 v26, v26, v30
v_mfma_f32_16x16x32_bf16 v[224:227], v[84:87], v[36:39], v[224:227]
ds_read_b64_tr_b16 v[74:75], v9 offset:33792
v_cvt_pk_bf16_f32 v27, v27, v31
v_mfma_f32_16x16x32_bf16 v[228:231], v[84:87], v[44:47], v[228:231]
s_add_u32 m0, s63, 69632
v_mfma_f32_16x16x32_bf16 v[228:231], v[80:83], v[40:43], v[228:231]
s_add_u32 s72, s70, 0
buffer_load_dwordx4 v4, s[4:7], s72 offen lds
v_mfma_f32_16x16x32_bf16 v[232:235], v[80:83], v[48:51], v[232:235]
s_add_u32 s80, s78, 41984
ds_read_b64_tr_b16 v[76:77], v9 offset:40960
v_mfma_f32_16x16x32_bf16 v[232:235], v[84:87], v[52:55], v[232:235]
ds_read_b128 v[124:127], v19 offset:38912
v_mfma_f32_16x16x32_bf16 v[236:239], v[84:87], v[60:63], v[236:239]
ds_read_b64_tr_b16 v[78:79], v9 offset:41984
v_mfma_f32_16x16x32_bf16 v[236:239], v[80:83], v[56:59], v[236:239]
buffer_store_dwordx4 v[24:27], v1, s[44:47], s80 offen sc1
v_mfma_f32_16x16x32_bf16 v[252:255], v[88:91], v[56:59], v[252:255]
s_add_u32 s72, s70, 15360
buffer_load_dwordx4 v5, s[4:7], s72 offen offset:1024 lds
v_mfma_f32_16x16x32_bf16 v[252:255], v[92:95], v[60:63], v[252:255]
ds_read_b64_tr_b16 v[80:81], v10 offset:32768
v_accvgpr_read_b32 v20, a72
v_mfma_f32_16x16x32_bf16 v[248:251], v[92:95], v[52:55], v[248:251]
ds_read_b64_tr_b16 v[82:83], v10 offset:33792
v_accvgpr_read_b32 v28, a73
v_mfma_f32_16x16x32_bf16 v[248:251], v[88:91], v[48:51], v[248:251]
v_accvgpr_read_b32 v21, a74
v_accvgpr_read_b32 v29, a75
v_mfma_f32_16x16x32_bf16 v[244:247], v[88:91], v[40:43], v[244:247]
ds_read_b64_tr_b16 v[84:85], v10 offset:40960
v_accvgpr_read_b32 v22, a104
v_mfma_f32_16x16x32_bf16 v[244:247], v[92:95], v[44:47], v[244:247]
ds_read_b64_tr_b16 v[86:87], v10 offset:41984
v_accvgpr_read_b32 v30, a105
v_mfma_f32_16x16x32_bf16 v[240:243], v[92:95], v[36:39], v[240:243]
s_add_u32 s72, s70, 129024
buffer_load_dwordx4 v4, s[4:7], s72 offen offset:2048 lds
v_mfma_f32_16x16x32_bf16 v[240:243], v[88:91], v[32:35], v[240:243]
s_waitcnt lgkmcnt(5)
v_accvgpr_read_b32 v23, a106
v_accvgpr_read_b32 v31, a107
v_mfma_f32_16x16x32_bf16 v[128:131], v[64:67], v[96:99], v[128:131]
s_lshr_b32 s75, s93, 4
ds_read_b64_tr_b16 v[88:89], v11 offset:32768
v_mul_f32 v20, s79, v20
v_mfma_f32_16x16x32_bf16 v[128:131], v[68:71], v[100:103], v[128:131]
s_and_b32 s75, s75, 0x7f00
ds_read_b64_tr_b16 v[90:91], v11 offset:33792
v_mul_f32 v28, s79, v28
v_mfma_f32_16x16x32_bf16 v[132:135], v[68:71], v[108:111], v[132:135]
s_add_u32 s75, s75, LcB1-Lpc0
v_lshrrev_b32 v2, 5, v0
v_lshlrev_b32 v2, 7, v2
v_mfma_f32_16x16x32_bf16 v[132:135], v[64:67], v[104:107], v[132:135]
s_add_u32 s72, s70, 144384
buffer_load_dwordx4 v5, s[4:7], s72 offen offset:3072 lds
v_mfma_f32_16x16x32_bf16 v[136:139], v[64:67], v[112:115], v[136:139]
v_add_u32 v2, s75, v2
v_min_u32 v2, Lcode_end-Lpc0, v2
v_mfma_f32_16x16x32_bf16 v[136:139], v[68:71], v[116:119], v[136:139]
s_lshl_b32 s71, s73, 12
global_load_dword v3, v2, s[98:99]
v_mfma_f32_16x16x32_bf16 v[140:143], v[68:71], v[124:127], v[140:143]
s_add_u32 s71, s71, s66
ds_read_b64_tr_b16 v[92:93], v11 offset:40960
v_mul_f32 v21, s79, v21
v_mfma_f32_16x16x32_bf16 v[140:143], v[64:67], v[120:123], v[140:143]
s_waitcnt lgkmcnt(7)
ds_read_b64_tr_b16 v[94:95], v11 offset:41984
v_mul_f32 v29, s79, v29
v_mfma_f32_16x16x32_bf16 v[156:159], v[72:75], v[120:123], v[156:159]
s_add_u32 m0, s64, 16384
ds_read_b64_tr_b16 v[64:65], v12 offset:32768
v_mul_f32 v22, s79, v22
v_mfma_f32_16x16x32_bf16 v[156:159], v[76:79], v[124:127], v[156:159]
s_add_u32 s72, s71, 0
buffer_load_dwordx4 v6, s[12:15], s72 offen lds
v_mfma_f32_16x16x32_bf16 v[152:155], v[76:79], v[116:119], v[152:155]
s_add_u32 s73, s62, 8
ds_read_b64_tr_b16 v[66:67], v12 offset:33792
v_mul_f32 v30, s79, v30
v_mfma_f32_16x16x32_bf16 v[152:155], v[72:75], v[112:115], v[152:155]
s_add_u32 s70, s73, s65
v_mul_f32 v23, s79, v23
v_mul_f32 v31, s79, v31
v_mfma_f32_16x16x32_bf16 v[148:151], v[72:75], v[104:107], v[148:151]
s_and_b32 s70, s70, 3
ds_read_b64_tr_b16 v[68:69], v12 offset:40960
v_cvt_pk_bf16_f32 v20, v20, v28
v_mfma_f32_16x16x32_bf16 v[148:151], v[76:79], v[108:111], v[148:151]
s_and_b32 s73, s73, 12
ds_read_b64_tr_b16 v[70:71], v12 offset:41984
v_cvt_pk_bf16_f32 v21, v21, v29
v_mfma_f32_16x16x32_bf16 v[144:147], v[76:79], v[100:103], v[144:147]
s_add_u32 s72, s71, 31744
buffer_load_dwordx4 v6, s[12:15], s72 offen offset:1024 lds
v_mfma_f32_16x16x32_bf16 v[144:147], v[72:75], v[96:99], v[144:147]
s_waitcnt lgkmcnt(8)
v_cvt_pk_bf16_f32 v22, v22, v30
v_cvt_pk_bf16_f32 v23, v23, v31
v_mfma_f32_16x16x32_bf16 v[160:163], v[80:83], v[96:99], v[160:163]
s_or_b32 s73, s73, s70
ds_read_b64_tr_b16 v[72:73], v13 offset:32768
v_accvgpr_read_b32 v24, a192
v_mfma_f32_16x16x32_bf16 v[160:163], v[84:87], v[100:103], v[160:163]
s_lshl_b32 s73, s73, 7
ds_read_b64_tr_b16 v[74:75], v13 offset:33792
v_accvgpr_read_b32 v28, a193
v_mfma_f32_16x16x32_bf16 v[164:167], v[84:87], v[108:111], v[164:167]
s_add_u32 s69, s73, s67
v_accvgpr_read_b32 v25, a194
v_accvgpr_read_b32 v29, a195
v_mfma_f32_16x16x32_bf16 v[164:167], v[80:83], v[104:107], v[164:167]
s_add_u32 s72, s71, 63488
buffer_load_dwordx4 v7, s[12:15], s72 offen offset:2048 lds
v_mfma_f32_16x16x32_bf16 v[168:171], v[80:83], v[112:115], v[168:171]
s_waitcnt vmcnt(19)
ds_read_b64_tr_b16 v[76:77], v13 offset:40960
v_accvgpr_read_b32 v26, a196
v_mfma_f32_16x16x32_bf16 v[168:171], v[84:87], v[116:119], v[168:171]
s_add_u32 s70, s73, s68
ds_read_b128 v[32:35], v16 offset:0
v_accvgpr_read_b32 v30, a197
v_mfma_f32_16x16x32_bf16 v[172:175], v[84:87], v[124:127], v[172:175]
s_add_u32 s80, s77, 9216
ds_read_b64_tr_b16 v[78:79], v13 offset:41984
v_accvgpr_read_b32 v27, a198
v_mfma_f32_16x16x32_bf16 v[172:175], v[80:83], v[120:123], v[172:175]
s_waitcnt lgkmcnt(9)
ds_read_b128 v[36:39], v17 offset:0
v_accvgpr_read_b32 v31, a199
v_mfma_f32_16x16x32_bf16 v[188:191], v[88:91], v[120:123], v[188:191]
s_add_u32 s72, s71, 95232
buffer_load_dwordx4 v7, s[12:15], s72 offen offset:3072 lds
v_mfma_f32_16x16x32_bf16 v[188:191], v[92:95], v[124:127], v[188:191]
ds_read_b64_tr_b16 v[80:81], v14 offset:32768
v_cvt_pk_bf16_f32 v24, v24, v28
v_mfma_f32_16x16x32_bf16 v[184:187], v[92:95], v[116:119], v[184:187]
ds_read_b64_tr_b16 v[82:83], v14 offset:33792
v_cvt_pk_bf16_f32 v25, v25, v29
v_mfma_f32_16x16x32_bf16 v[184:187], v[88:91], v[112:115], v[184:187]
buffer_store_dwordx4 v[20:23], v1, s[44:47], s80 offen sc1
v_mfma_f32_16x16x32_bf16 v[180:183], v[88:91], v[104:107], v[180:183]
ds_read_b64_tr_b16 v[84:85], v14 offset:40960
v_cvt_pk_bf16_f32 v26, v26, v30
v_mfma_f32_16x16x32_bf16 v[180:183], v[92:95], v[108:111], v[180:183]
s_add_u32 m0, s63, 98304
ds_read_b64_tr_b16 v[86:87], v14 offset:41984
v_cvt_pk_bf16_f32 v27, v27, v31
v_mfma_f32_16x16x32_bf16 v[176:179], v[92:95], v[100:103], v[176:179]
s_add_u32 s72, s69, 0
buffer_load_dwordx4 v4, s[4:7], s72 offen lds
v_mfma_f32_16x16x32_bf16 v[176:179], v[88:91], v[96:99], v[176:179]
s_waitcnt lgkmcnt(10)
ds_read_b128 v[40:43], v16 offset:2048
v_mfma_f32_16x16x32_bf16 v[192:195], v[64:67], v[96:99], v[192:195]
s_add_u32 s80, s78, 2048
ds_read_b64_tr_b16 v[88:89], v15 offset:32768
v_mfma_f32_16x16x32_bf16 v[192:195], v[68:71], v[100:103], v[192:195]
ds_read_b64_tr_b16 v[90:91], v15 offset:33792
v_mfma_f32_16x16x32_bf16 v[196:199], v[68:71], v[108:111], v[196:199]
ds_read_b64_tr_b16 v[92:93], v15 offset:40960
v_mfma_f32_16x16x32_bf16 v[196:199], v[64:67], v[104:107], v[196:199]
s_add_u32 s72, s69, 15360
buffer_load_dwordx4 v5, s[4:7], s72 offen offset:1024 lds
v_mfma_f32_16x16x32_bf16 v[200:203], v[64:67], v[112:115], v[200:203]
ds_read_b64_tr_b16 v[94:95], v15 offset:41984
v_accvgpr_read_b32 v20, a76
v_mfma_f32_16x16x32_bf16 v[200:203], v[68:71], v[116:119], v[200:203]
ds_read_b128 v[44:47], v17 offset:2048
v_accvgpr_read_b32 v28, a77
v_mfma_f32_16x16x32_bf16 v[204:207], v[68:71], v[124:127], v[204:207]
buffer_store_dwordx4 v[24:27], v1, s[44:47], s80 offen sc1
v_mfma_f32_16x16x32_bf16 v[204:207], v[64:67], v[120:123], v[204:207]
s_waitcnt lgkmcnt(11)
ds_read_b128 v[48:51], v16 offset:4096
v_accvgpr_read_b32 v21, a78
v_mfma_f32_16x16x32_bf16 v[220:223], v[72:75], v[120:123], v[220:223]
s_add_u32 s72, s69, 129024
buffer_load_dwordx4 v4, s[4:7], s72 offen offset:2048 lds
v_mfma_f32_16x16x32_bf16 v[220:223], v[76:79], v[124:127], v[220:223]
v_accvgpr_read_b32 v29, a79
v_accvgpr_read_b32 v22, a108
v_mfma_f32_16x16x32_bf16 v[216:219], v[76:79], v[116:119], v[216:219]
s_waitcnt vmcnt(20) lgkmcnt(2)
ds_read_b128 v[52:55], v17 offset:4096
v_accvgpr_read_b32 v30, a109
v_mfma_f32_16x16x32_bf16 v[216:219], v[72:75], v[112:115], v[216:219]
s_barrier
ds_read_b128 v[56:59], v16 offset:6144
v_accvgpr_read_b32 v23, a110
v_mfma_f32_16x16x32_bf16 v[212:215], v[72:75], v[104:107], v[212:215]
ds_read_b64_tr_b16 v[64:65], v8 offset:0
ds_read_b64_tr_b16 v[66:67], v8 offset:1024
v_mfma_f32_16x16x32_bf16 v[212:215], v[76:79], v[108:111], v[212:215]
ds_read_b64_tr_b16 v[68:69], v8 offset:8192
v_accvgpr_read_b32 v31, a111
v_mfma_f32_16x16x32_bf16 v[208:211], v[76:79], v[100:103], v[208:211]
s_add_u32 s72, s69, 144384
buffer_load_dwordx4 v5, s[4:7], s72 offen offset:3072 lds
v_mfma_f32_16x16x32_bf16 v[208:211], v[72:75], v[96:99], v[208:211]
ds_read_b64_tr_b16 v[70:71], v8 offset:9216
v_mul_f32 v20, s79, v20
v_mfma_f32_16x16x32_bf16 v[224:227], v[80:83], v[96:99], v[224:227]
ds_read_b64_tr_b16 v[72:73], v9 offset:0
v_mul_f32 v28, s79, v28
v_mfma_f32_16x16x32_bf16 v[224:227], v[84:87], v[100:103], v[224:227]
ds_read_b64_tr_b16 v[74:75], v9 offset:1024
v_mul_f32 v21, s79, v21
v_mfma_f32_16x16x32_bf16 v[228:231], v[84:87], v[108:111], v[228:231]
s_add_u32 m0, s63, 102400
v_mul_f32 v29, s79, v29
v_mul_f32 v22, s79, v22
v_mfma_f32_16x16x32_bf16 v[228:231], v[80:83], v[104:107], v[228:231]
s_add_u32 s72, s70, 0
buffer_load_dwordx4 v4, s[4:7], s72 offen lds
v_mfma_f32_16x16x32_bf16 v[232:235], v[80:83], v[112:115], v[232:235]
ds_read_b64_tr_b16 v[76:77], v9 offset:8192
v_mul_f32 v30, s79, v30
v_mfma_f32_16x16x32_bf16 v[232:235], v[84:87], v[116:119], v[232:235]
ds_read_b128 v[60:63], v17 offset:6144
v_mul_f32 v23, s79, v23
v_mfma_f32_16x16x32_bf16 v[236:239], v[84:87], v[124:127], v[236:239]
ds_read_b64_tr_b16 v[78:79], v9 offset:9216
v_mul_f32 v31, s79, v31
v_mfma_f32_16x16x32_bf16 v[236:239], v[80:83], v[120:123], v[236:239]
v_cvt_pk_bf16_f32 v20, v20, v28
v_cvt_pk_bf16_f32 v21, v21, v29
v_mfma_f32_16x16x32_bf16 v[252:255], v[88:91], v[120:123], v[252:255]
s_add_u32 s72, s70, 15360
buffer_load_dwordx4 v5, s[4:7], s72 offen offset:1024 lds
v_mfma_f32_16x16x32_bf16 v[252:255], v[92:95], v[124:127], v[252:255]
ds_read_b64_tr_b16 v[80:81], v10 offset:0
v_cvt_pk_bf16_f32 v22, v22, v30
v_mfma_f32_16x16x32_bf16 v[248:251], v[92:95], v[116:119], v[248:251]
ds_read_b64_tr_b16 v[82:83], v10 offset:1024
v_cvt_pk_bf16_f32 v23, v23, v31
v_mfma_f32_16x16x32_bf16 v[248:251], v[88:91], v[112:115], v[248:251]
s_add_u32 s80, s77, 13312
buffer_store_dwordx4 v[20:23], v1, s[44:47], s80 offen sc1
v_mfma_f32_16x16x32_bf16 v[244:247], v[88:91], v[104:107], v[244:247]
ds_read_b64_tr_b16 v[84:85], v10 offset:8192
v_accvgpr_read_b32 v24, a200
v_mfma_f32_16x16x32_bf16 v[244:247], v[92:95], v[108:111], v[244:247]
ds_read_b64_tr_b16 v[86:87], v10 offset:9216
v_accvgpr_read_b32 v28, a201
v_mfma_f32_16x16x32_bf16 v[240:243], v[92:95], v[100:103], v[240:243]
s_add_u32 s72, s70, 129024
buffer_load_dwordx4 v4, s[4:7], s72 offen offset:2048 lds
v_mfma_f32_16x16x32_bf16 v[240:243], v[88:91], v[96:99], v[240:243]
s_waitcnt lgkmcnt(5)
v_accvgpr_read_b32 v25, a202
v_accvgpr_read_b32 v29, a203
v_mfma_f32_16x16x32_bf16 v[128:131], v[64:67], v[32:35], v[128:131]
ds_read_b64_tr_b16 v[88:89], v11 offset:0
v_accvgpr_read_b32 v26, a204
v_mfma_f32_16x16x32_bf16 v[128:131], v[68:71], v[36:39], v[128:131]
ds_read_b64_tr_b16 v[90:91], v11 offset:1024
v_accvgpr_read_b32 v30, a205
v_mfma_f32_16x16x32_bf16 v[132:135], v[68:71], v[44:47], v[132:135]
v_accvgpr_read_b32 v27, a206
v_accvgpr_read_b32 v31, a207
v_mfma_f32_16x16x32_bf16 v[132:135], v[64:67], v[40:43], v[132:135]
s_add_u32 s72, s70, 144384
buffer_load_dwordx4 v5, s[4:7], s72 offen offset:3072 lds
v_mfma_f32_16x16x32_bf16 v[136:139], v[64:67], v[48:51], v[136:139]
ds_read_b64_tr_b16 v[92:93], v11 offset:8192
v_cvt_pk_bf16_f32 v24, v24, v28
v_mfma_f32_16x16x32_bf16 v[136:139], v[68:71], v[52:55], v[136:139]
s_lshl_b32 s71, s73, 12
v_cvt_pk_bf16_f32 v25, v25, v29
v_cvt_pk_bf16_f32 v26, v26, v30
v_mfma_f32_16x16x32_bf16 v[140:143], v[68:71], v[60:63], v[140:143]
s_add_u32 s71, s71, s66
ds_read_b64_tr_b16 v[94:95], v11 offset:9216
v_cvt_pk_bf16_f32 v27, v27, v31
v_mfma_f32_16x16x32_bf16 v[140:143], v[64:67], v[56:59], v[140:143]
s_waitcnt lgkmcnt(8)
v_mfma_f32_16x16x32_bf16 v[156:159], v[72:75], v[56:59], v[156:159]
s_add_u32 m0, s64, 32768
ds_read_b64_tr_b16 v[64:65], v12 offset:0
v_mfma_f32_16x16x32_bf16 v[156:159], v[76:79], v[60:63], v[156:159]
s_add_u32 s72, s71, 0
buffer_load_dwordx4 v6, s[12:15], s72 offen lds
v_mfma_f32_16x16x32_bf16 v[152:155], v[76:79], v[52:55], v[152:155]
s_add_u32 s73, s62, 9
ds_read_b64_tr_b16 v[66:67], v12 offset:1024
v_mfma_f32_16x16x32_bf16 v[152:155], v[72:75], v[48:51], v[152:155]
s_add_u32 s70, s73, s65
v_mfma_f32_16x16x32_bf16 v[148:151], v[72:75], v[40:43], v[148:151]
s_and_b32 s70, s70, 3
ds_read_b64_tr_b16 v[68:69], v12 offset:8192
v_mfma_f32_16x16x32_bf16 v[148:151], v[76:79], v[44:47], v[148:151]
s_and_b32 s73, s73, 12
ds_read_b64_tr_b16 v[70:71], v12 offset:9216
v_mfma_f32_16x16x32_bf16 v[144:147], v[76:79], v[36:39], v[144:147]
s_add_u32 s72, s71, 31744
buffer_load_dwordx4 v6, s[12:15], s72 offen offset:1024 lds
v_mfma_f32_16x16x32_bf16 v[144:147], v[72:75], v[32:35], v[144:147]
s_waitcnt lgkmcnt(8)
v_mfma_f32_16x16x32_bf16 v[160:163], v[80:83], v[32:35], v[160:163]
s_or_b32 s73, s73, s70
ds_read_b64_tr_b16 v[72:73], v13 offset:0
v_accvgpr_read_b32 v20, a80
v_mfma_f32_16x16x32_bf16 v[160:163], v[84:87], v[36:39], v[160:163]
s_lshl_b32 s73, s73, 7
ds_read_b64_tr_b16 v[74:75], v13 offset:1024
v_accvgpr_read_b32 v28, a81
v_mfma_f32_16x16x32_bf16 v[164:167], v[84:87], v[44:47], v[164:167]
s_add_u32 s69, s73, s67
v_accvgpr_read_b32 v21, a82
v_accvgpr_read_b32 v29, a83
v_mfma_f32_16x16x32_bf16 v[164:167], v[80:83], v[40:43], v[164:167]
s_add_u32 s72, s71, 63488
buffer_load_dwordx4 v7, s[12:15], s72 offen offset:2048 lds
v_mfma_f32_16x16x32_bf16 v[168:171], v[80:83], v[48:51], v[168:171]
s_waitcnt vmcnt(19)
ds_read_b64_tr_b16 v[76:77], v13 offset:8192
v_accvgpr_read_b32 v22, a112
v_mfma_f32_16x16x32_bf16 v[168:171], v[84:87], v[52:55], v[168:171]
s_add_u32 s70, s73, s68
ds_read_b128 v[96:99], v18 offset:0
v_accvgpr_read_b32 v30, a113
v_mfma_f32_16x16x32_bf16 v[172:175], v[84:87], v[60:63], v[172:175]
s_add_u32 s80, s78, 10240
ds_read_b64_tr_b16 v[78:79], v13 offset:9216
v_accvgpr_read_b32 v23, a114
v_mfma_f32_16x16x32_bf16 v[172:175], v[80:83], v[56:59], v[172:175]
s_waitcnt lgkmcnt(9)
ds_read_b128 v[100:103], v19 offset:0
v_accvgpr_read_b32 v31, a115
v_mfma_f32_16x16x32_bf16 v[188:191], v[88:91], v[56:59], v[188:191]
s_add_u32 s72, s71, 95232
buffer_load_dwordx4 v7, s[12:15], s72 offen offset:3072 lds
v_mfma_f32_16x16x32_bf16 v[188:191], v[92:95], v[60:63], v[188:191]
ds_read_b64_tr_b16 v[80:81], v14 offset:0
v_mul_f32 v20, s79, v20
v_mfma_f32_16x16x32_bf16 v[184:187], v[92:95], v[52:55], v[184:187]
ds_read_b64_tr_b16 v[82:83], v14 offset:1024
v_mul_f32 v28, s79, v28
v_mfma_f32_16x16x32_bf16 v[184:187], v[88:91], v[48:51], v[184:187]
buffer_store_dwordx4 v[24:27], v1, s[44:47], s80 offen sc1
v_mfma_f32_16x16x32_bf16 v[180:183], v[88:91], v[40:43], v[180:183]
ds_read_b64_tr_b16 v[84:85], v14 offset:8192
v_mul_f32 v21, s79, v21
v_mfma_f32_16x16x32_bf16 v[180:183], v[92:95], v[44:47], v[180:183]
s_add_u32 m0, s63, 131072
ds_read_b64_tr_b16 v[86:87], v14 offset:9216
v_mul_f32 v29, s79, v29
v_mfma_f32_16x16x32_bf16 v[176:179], v[92:95], v[36:39], v[176:179]
s_add_u32 s72, s69, 0
buffer_load_dwordx4 v4, s[4:7], s72 offen lds
v_mfma_f32_16x16x32_bf16 v[176:179], v[88:91], v[32:35], v[176:179]
s_waitcnt lgkmcnt(10)
ds_read_b128 v[104:107], v18 offset:2048
v_mul_f32 v22, s79, v22
v_mfma_f32_16x16x32_bf16 v[192:195], v[64:67], v[32:35], v[192:195]
ds_read_b64_tr_b16 v[88:89], v15 offset:0
v_mul_f32 v30, s79, v30
v_mfma_f32_16x16x32_bf16 v[192:195], v[68:71], v[36:39], v[192:195]
ds_read_b64_tr_b16 v[90:91], v15 offset:1024
v_mul_f32 v23, s79, v23
v_mfma_f32_16x16x32_bf16 v[196:199], v[68:71], v[44:47], v[196:199]
ds_read_b64_tr_b16 v[92:93], v15 offset:8192
v_mul_f32 v31, s79, v31
v_mfma_f32_16x16x32_bf16 v[196:199], v[64:67], v[40:43], v[196:199]
s_add_u32 s72, s69, 15360
buffer_load_dwordx4 v5, s[4:7], s72 offen offset:1024 lds
v_mfma_f32_16x16x32_bf16 v[200:203], v[64:67], v[48:51], v[200:203]
ds_read_b64_tr_b16 v[94:95], v15 offset:9216
v_cvt_pk_bf16_f32 v20, v20, v28
v_mfma_f32_16x16x32_bf16 v[200:203], v[68:71], v[52:55], v[200:203]
ds_read_b128 v[108:111], v19 offset:2048
v_cvt_pk_bf16_f32 v21, v21, v29
v_mfma_f32_16x16x32_bf16 v[204:207], v[68:71], v[60:63], v[204:207]
v_cvt_pk_bf16_f32 v22, v22, v30
v_cvt_pk_bf16_f32 v23, v23, v31
v_mfma_f32_16x16x32_bf16 v[204:207], v[64:67], v[56:59], v[204:207]
s_waitcnt lgkmcnt(11)
ds_read_b128 v[112:115], v18 offset:4096
v_accvgpr_read_b32 v24, a208
v_mfma_f32_16x16x32_bf16 v[220:223], v[72:75], v[56:59], v[220:223]
s_add_u32 s72, s69, 129024
buffer_load_dwordx4 v4, s[4:7], s72 offen offset:2048 lds
v_mfma_f32_16x16x32_bf16 v[220:223], v[76:79], v[60:63], v[220:223]
s_add_u32 s80, s77, 33792
s_nop 3
s_mov_b64 exec, 0
s_cmp_eq_u32 s58, 0
s_cbranch_scc1 Lstub0
s_cmp_eq_u32 s58, 1
s_cbranch_scc1 Lstub1
s_cmp_eq_u32 s58, 2
s_cbranch_scc1 Lstub2
s_branch Lstub3
Lret:
s_mov_b64 exec, -1
s_nop 3
v_mfma_f32_16x16x32_bf16 v[216:219], v[76:79], v[52:55], v[216:219]
s_waitcnt vmcnt(19) lgkmcnt(2)
ds_read_b128 v[116:119], v19 offset:4096
v_accvgpr_read_b32 v28, a209
v_mfma_f32_16x16x32_bf16 v[216:219], v[72:75], v[48:51], v[216:219]
s_barrier
buffer_store_dwordx4 v[20:23], v1, s[44:47], s80 offen sc1
v_mfma_f32_16x16x32_bf16 v[212:215], v[72:75], v[40:43], v[212:215]
ds_read_b64_tr_b16 v[64:65], v8 offset:16384
ds_read_b64_tr_b16 v[66:67], v8 offset:17408
v_mfma_f32_16x16x32_bf16 v[212:215], v[76:79], v[44:47], v[212:215]
ds_read_b64_tr_b16 v[68:69], v8 offset:24576
v_accvgpr_read_b32 v25, a210
v_mfma_f32_16x16x32_bf16 v[208:211], v[76:79], v[36:39], v[208:211]
s_add_u32 s72, s69, 144384
buffer_load_dwordx4 v5, s[4:7], s72 offen offset:3072 lds
v_mfma_f32_16x16x32_bf16 v[208:211], v[72:75], v[32:35], v[208:211]
ds_read_b64_tr_b16 v[70:71], v8 offset:25600
v_accvgpr_read_b32 v29, a211
v_mfma_f32_16x16x32_bf16 v[224:227], v[80:83], v[32:35], v[224:227]
ds_read_b64_tr_b16 v[72:73], v9 offset:16384
v_accvgpr_read_b32 v26, a212
v_mfma_f32_16x16x32_bf16 v[224:227], v[84:87], v[36:39], v[224:227]
ds_read_b64_tr_b16 v[74:75], v9 offset:17408
v_accvgpr_read_b32 v30, a213
v_mfma_f32_16x16x32_bf16 v[228:231], v[84:87], v[44:47], v[228:231]
s_add_u32 m0, s63, 135168
ds_read_b128 v[120:123], v18 offset:6144
v_accvgpr_read_b32 v27, a214
v_mfma_f32_16x16x32_bf16 v[228:231], v[80:83], v[40:43], v[228:231]
s_add_u32 s72, s70, 0
buffer_load_dwordx4 v4, s[4:7], s72 offen lds
v_mfma_f32_16x16x32_bf16 v[232:235], v[80:83], v[48:51], v[232:235]
ds_read_b64_tr_b16 v[76:77], v9 offset:24576
v_accvgpr_read_b32 v31, a215
v_mfma_f32_16x16x32_bf16 v[232:235], v[84:87], v[52:55], v[232:235]
ds_read_b128 v[124:127], v19 offset:6144
v_cvt_pk_bf16_f32 v24, v24, v28
v_mfma_f32_16x16x32_bf16 v[236:239], v[84:87], v[60:63], v[236:239]
ds_read_b64_tr_b16 v[78:79], v9 offset:25600
v_cvt_pk_bf16_f32 v25, v25, v29
v_mfma_f32_16x16x32_bf16 v[236:239], v[80:83], v[56:59], v[236:239]
v_cvt_pk_bf16_f32 v26, v26, v30
v_cvt_pk_bf16_f32 v27, v27, v31
v_mfma_f32_16x16x32_bf16 v[252:255], v[88:91], v[56:59], v[252:255]
s_add_u32 s72, s70, 15360
buffer_load_dwordx4 v5, s[4:7], s72 offen offset:1024 lds
v_mfma_f32_16x16x32_bf16 v[252:255], v[92:95], v[60:63], v[252:255]
s_add_u32 s80, s78, 34816
ds_read_b64_tr_b16 v[80:81], v10 offset:16384
v_mfma_f32_16x16x32_bf16 v[248:251], v[92:95], v[52:55], v[248:251]
ds_read_b64_tr_b16 v[82:83], v10 offset:17408
v_mfma_f32_16x16x32_bf16 v[248:251], v[88:91], v[48:51], v[248:251]
buffer_store_dwordx4 v[24:27], v1, s[44:47], s80 offen sc1
v_mfma_f32_16x16x32_bf16 v[244:247], v[88:91], v[40:43], v[244:247]
ds_read_b64_tr_b16 v[84:85], v10 offset:24576
v_mfma_f32_16x16x32_bf16 v[244:247], v[92:95], v[44:47], v[244:247]
ds_read_b64_tr_b16 v[86:87], v10 offset:25600
v_accvgpr_read_b32 v20, a84
v_mfma_f32_16x16x32_bf16 v[240:243], v[92:95], v[36:39], v[240:243]
s_add_u32 s72, s70, 129024
buffer_load_dwordx4 v4, s[4:7], s72 offen offset:2048 lds
v_mfma_f32_16x16x32_bf16 v[240:243], v[88:91], v[32:35], v[240:243]
s_waitcnt lgkmcnt(5)
v_accvgpr_read_b32 v28, a85
v_accvgpr_read_b32 v21, a86
v_mfma_f32_16x16x32_bf16 v[128:131], v[64:67], v[96:99], v[128:131]
ds_read_b64_tr_b16 v[88:89], v11 offset:16384
v_accvgpr_read_b32 v29, a87
v_mfma_f32_16x16x32_bf16 v[128:131], v[68:71], v[100:103], v[128:131]
ds_read_b64_tr_b16 v[90:91], v11 offset:17408
v_accvgpr_read_b32 v22, a116
v_mfma_f32_16x16x32_bf16 v[132:135], v[68:71], v[108:111], v[132:135]
v_accvgpr_read_b32 v30, a117
v_accvgpr_read_b32 v23, a118
v_mfma_f32_16x16x32_bf16 v[132:135], v[64:67], v[104:107], v[132:135]
s_add_u32 s72, s70, 144384
buffer_load_dwordx4 v5, s[4:7], s72 offen offset:3072 lds
v_mfma_f32_16x16x32_bf16 v[136:139], v[64:67], v[112:115], v[136:139]
ds_read_b64_tr_b16 v[92:93], v11 offset:24576
v_accvgpr_read_b32 v31, a119
v_mfma_f32_16x16x32_bf16 v[136:139], v[68:71], v[116:119], v[136:139]
s_lshl_b32 s71, s73, 12
v_mul_f32 v20, s79, v20
v_mul_f32 v28, s79, v28
v_mfma_f32_16x16x32_bf16 v[140:143], v[68:71], v[124:127], v[140:143]
s_add_u32 s71, s71, s66
ds_read_b64_tr_b16 v[94:95], v11 offset:25600
v_mul_f32 v21, s79, v21
v_mfma_f32_16x16x32_bf16 v[140:143], v[64:67], v[120:123], v[140:143]
s_waitcnt lgkmcnt(8)
v_mul_f32 v29, s79, v29
v_mul_f32 v22, s79, v22
v_mfma_f32_16x16x32_bf16 v[156:159], v[72:75], v[120:123], v[156:159]
s_add_u32 m0, s64, 0
ds_read_b64_tr_b16 v[64:65], v12 offset:16384
v_mul_f32 v30, s79, v30
v_mfma_f32_16x16x32_bf16 v[156:159], v[76:79], v[124:127], v[156:159]
s_add_u32 s72, s71, 0
buffer_load_dwordx4 v6, s[12:15], s72 offen lds
v_mfma_f32_16x16x32_bf16 v[152:155], v[76:79], v[116:119], v[152:155]
s_add_u32 s73, s62, 10
ds_read_b64_tr_b16 v[66:67], v12 offset:17408
v_mul_f32 v23, s79, v23
v_mfma_f32_16x16x32_bf16 v[152:155], v[72:75], v[112:115], v[152:155]
s_add_u32 s70, s73, s65
v_mul_f32 v31, s79, v31
v_cvt_pk_bf16_f32 v20, v20, v28
v_mfma_f32_16x16x32_bf16 v[148:151], v[72:75], v[104:107], v[148:151]
s_and_b32 s70, s70, 3
ds_read_b64_tr_b16 v[68:69], v12 offset:24576
v_cvt_pk_bf16_f32 v21, v21, v29
v_mfma_f32_16x16x32_bf16 v[148:151], v[76:79], v[108:111], v[148:151]
s_and_b32 s73, s73, 12
ds_read_b64_tr_b16 v[70:71], v12 offset:25600
v_cvt_pk_bf16_f32 v22, v22, v30
v_mfma_f32_16x16x32_bf16 v[144:147], v[76:79], v[100:103], v[144:147]
s_add_u32 s72, s71, 31744
buffer_load_dwordx4 v6, s[12:15], s72 offen offset:1024 lds
v_mfma_f32_16x16x32_bf16 v[144:147], v[72:75], v[96:99], v[144:147]
s_waitcnt lgkmcnt(8)
v_cvt_pk_bf16_f32 v23, v23, v31
v_mfma_f32_16x16x32_bf16 v[160:163], v[80:83], v[96:99], v[160:163]
s_or_b32 s73, s73, s70
ds_read_b64_tr_b16 v[72:73], v13 offset:16384
v_mfma_f32_16x16x32_bf16 v[160:163], v[84:87], v[100:103], v[160:163]
s_lshl_b32 s73, s73, 7
ds_read_b64_tr_b16 v[74:75], v13 offset:17408
v_mfma_f32_16x16x32_bf16 v[164:167], v[84:87], v[108:111], v[164:167]
s_add_u32 s69, s73, s67
v_mfma_f32_16x16x32_bf16 v[164:167], v[80:83], v[104:107], v[164:167]
s_add_u32 s72, s71, 63488
buffer_load_dwordx4 v7, s[12:15], s72 offen offset:2048 lds
v_mfma_f32_16x16x32_bf16 v[168:171], v[80:83], v[112:115], v[168:171]
s_waitcnt vmcnt(18)
ds_read_b64_tr_b16 v[76:77], v13 offset:24576
v_accvgpr_read_b32 v24, a216
v_mfma_f32_16x16x32_bf16 v[168:171], v[84:87], v[116:119], v[168:171]
s_add_u32 s70, s73, s68
ds_read_b128 v[32:35], v18 offset:32768
v_accvgpr_read_b32 v28, a217
v_mfma_f32_16x16x32_bf16 v[172:175], v[84:87], v[124:127], v[172:175]
s_add_u32 s80, s77, 37888
ds_read_b64_tr_b16 v[78:79], v13 offset:25600
v_accvgpr_read_b32 v25, a218
v_mfma_f32_16x16x32_bf16 v[172:175], v[80:83], v[120:123], v[172:175]
s_waitcnt lgkmcnt(9)
ds_read_b128 v[36:39], v19 offset:32768
v_accvgpr_read_b32 v29, a219
v_mfma_f32_16x16x32_bf16 v[188:191], v[88:91], v[120:123], v[188:191]
s_add_u32 s72, s71, 95232
buffer_load_dwordx4 v7, s[12:15], s72 offen offset:3072 lds
v_mfma_f32_16x16x32_bf16 v[188:191], v[92:95], v[124:127], v[188:191]
ds_read_b64_tr_b16 v[80:81], v14 offset:16384
v_accvgpr_read_b32 v26, a220
v_mfma_f32_16x16x32_bf16 v[184:187], v[92:95], v[116:119], v[184:187]
ds_read_b64_tr_b16 v[82:83], v14 offset:17408
v_accvgpr_read_b32 v30, a221
v_mfma_f32_16x16x32_bf16 v[184:187], v[88:91], v[112:115], v[184:187]
buffer_store_dwordx4 v[20:23], v1, s[44:47], s80 offen sc1
v_mfma_f32_16x16x32_bf16 v[180:183], v[88:91], v[104:107], v[180:183]
ds_read_b64_tr_b16 v[84:85], v14 offset:24576
v_accvgpr_read_b32 v27, a222
v_mfma_f32_16x16x32_bf16 v[180:183], v[92:95], v[108:111], v[180:183]
s_add_u32 m0, s63, 65536
ds_read_b64_tr_b16 v[86:87], v14 offset:25600
v_accvgpr_read_b32 v31, a223
v_mfma_f32_16x16x32_bf16 v[176:179], v[92:95], v[100:103], v[176:179]
s_add_u32 s72, s69, 0
buffer_load_dwordx4 v4, s[4:7], s72 offen lds
v_mfma_f32_16x16x32_bf16 v[176:179], v[88:91], v[96:99], v[176:179]
s_waitcnt lgkmcnt(10)
ds_read_b128 v[40:43], v18 offset:34816
v_cvt_pk_bf16_f32 v24, v24, v28
v_mfma_f32_16x16x32_bf16 v[192:195], v[64:67], v[96:99], v[192:195]
ds_read_b64_tr_b16 v[88:89], v15 offset:16384
v_cvt_pk_bf16_f32 v25, v25, v29
v_mfma_f32_16x16x32_bf16 v[192:195], v[68:71], v[100:103], v[192:195]
ds_read_b64_tr_b16 v[90:91], v15 offset:17408
v_cvt_pk_bf16_f32 v26, v26, v30
v_mfma_f32_16x16x32_bf16 v[196:199], v[68:71], v[108:111], v[196:199]
ds_read_b64_tr_b16 v[92:93], v15 offset:24576
v_cvt_pk_bf16_f32 v27, v27, v31
v_mfma_f32_16x16x32_bf16 v[196:199], v[64:67], v[104:107], v[196:199]
s_add_u32 s72, s69, 15360
buffer_load_dwordx4 v5, s[4:7], s72 offen offset:1024 lds
v_mfma_f32_16x16x32_bf16 v[200:203], v[64:67], v[112:115], v[200:203]
s_add_u32 s80, s78, 43008
ds_read_b64_tr_b16 v[94:95], v15 offset:25600
v_mfma_f32_16x16x32_bf16 v[200:203], v[68:71], v[116:119], v[200:203]
ds_read_b128 v[44:47], v19 offset:34816
v_mfma_f32_16x16x32_bf16 v[204:207], v[68:71], v[124:127], v[204:207]
buffer_store_dwordx4 v[24:27], v1, s[44:47], s80 offen sc1
v_mfma_f32_16x16x32_bf16 v[204:207], v[64:67], v[120:123], v[204:207]
s_waitcnt lgkmcnt(11)
ds_read_b128 v[48:51], v18 offset:36864
v_mfma_f32_16x16x32_bf16 v[220:223], v[72:75], v[120:123], v[220:223]
s_add_u32 s72, s69, 129024
buffer_load_dwordx4 v4, s[4:7], s72 offen offset:2048 lds
v_mfma_f32_16x16x32_bf16 v[220:223], v[76:79], v[124:127], v[220:223]
v_accvgpr_read_b32 v20, a88
v_accvgpr_read_b32 v28, a89
v_mfma_f32_16x16x32_bf16 v[216:219], v[76:79], v[116:119], v[216:219]
s_waitcnt vmcnt(20) lgkmcnt(2)
ds_read_b128 v[52:55], v19 offset:36864
v_accvgpr_read_b32 v21, a90
v_mfma_f32_16x16x32_bf16 v[216:219], v[72:75], v[112:115], v[216:219]
s_barrier
ds_read_b128 v[56:59], v18 offset:38912
v_accvgpr_read_b32 v29, a91
v_mfma_f32_16x16x32_bf16 v[212:215], v[72:75], v[104:107], v[212:215]
ds_read_b64_tr_b16 v[64:65], v8 offset:32768
ds_read_b64_tr_b16 v[66:67], v8 offset:33792
v_mfma_f32_16x16x32_bf16 v[212:215], v[76:79], v[108:111], v[212:215]
ds_read_b64_tr_b16 v[68:69], v8 offset:40960
v_accvgpr_read_b32 v22, a120
v_mfma_f32_16x16x32_bf16 v[208:211], v[76:79], v[100:103], v[208:211]
s_add_u32 s72, s69, 144384
buffer_load_dwordx4 v5, s[4:7], s72 offen offset:3072 lds
v_mfma_f32_16x16x32_bf16 v[208:211], v[72:75], v[96:99], v[208:211]
ds_read_b64_tr_b16 v[70:71], v8 offset:41984
v_accvgpr_read_b32 v30, a121
v_mfma_f32_16x16x32_bf16 v[224:227], v[80:83], v[96:99], v[224:227]
ds_read_b64_tr_b16 v[72:73], v9 offset:32768
v_accvgpr_read_b32 v23, a122
v_mfma_f32_16x16x32_bf16 v[224:227], v[84:87], v[100:103], v[224:227]
ds_read_b64_tr_b16 v[74:75], v9 offset:33792
v_accvgpr_read_b32 v31, a123
v_mfma_f32_16x16x32_bf16 v[228:231], v[84:87], v[108:111], v[228:231]
s_add_u32 m0, s63, 69632
v_mul_f32 v20, s79, v20
v_mul_f32 v28, s79, v28
v_mfma_f32_16x16x32_bf16 v[228:231], v[80:83], v[104:107], v[228:231]
s_add_u32 s72, s70, 0
buffer_load_dwordx4 v4, s[4:7], s72 offen lds
v_mfma_f32_16x16x32_bf16 v[232:235], v[80:83], v[112:115], v[232:235]
ds_read_b64_tr_b16 v[76:77], v9 offset:40960
v_mul_f32 v21, s79, v21
v_mfma_f32_16x16x32_bf16 v[232:235], v[84:87], v[116:119], v[232:235]
ds_read_b128 v[60:63], v19 offset:38912
v_mul_f32 v29, s79, v29
v_mfma_f32_16x16x32_bf16 v[236:239], v[84:87], v[124:127], v[236:239]
ds_read_b64_tr_b16 v[78:79], v9 offset:41984
v_mul_f32 v22, s79, v22
v_mfma_f32_16x16x32_bf16 v[236:239], v[80:83], v[120:123], v[236:239]
v_mul_f32 v30, s79, v30
v_mul_f32 v23, s79, v23
v_mfma_f32_16x16x32_bf16 v[252:255], v[88:91], v[120:123], v[252:255]
s_add_u32 s72, s70, 15360
buffer_load_dwordx4 v5, s[4:7], s72 offen offset:1024 lds
v_mfma_f32_16x16x32_bf16 v[252:255], v[92:95], v[124:127], v[252:255]
ds_read_b64_tr_b16 v[80:81], v10 offset:32768
v_mul_f32 v31, s79, v31
v_mfma_f32_16x16x32_bf16 v[248:251], v[92:95], v[116:119], v[248:251]
ds_read_b64_tr_b16 v[82:83], v10 offset:33792
v_cvt_pk_bf16_f32 v20, v20, v28
v_mfma_f32_16x16x32_bf16 v[248:251], v[88:91], v[112:115], v[248:251]
v_cvt_pk_bf16_f32 v21, v21, v29
v_cvt_pk_bf16_f32 v22, v22, v30
v_mfma_f32_16x16x32_bf16 v[244:247], v[88:91], v[104:107], v[244:247]
ds_read_b64_tr_b16 v[84:85], v10 offset:40960
v_cvt_pk_bf16_f32 v23, v23, v31
v_mfma_f32_16x16x32_bf16 v[244:247], v[92:95], v[108:111], v[244:247]
s_add_u32 s80, s77, 41984
ds_read_b64_tr_b16 v[86:87], v10 offset:41984
v_mfma_f32_16x16x32_bf16 v[240:243], v[92:95], v[100:103], v[240:243]
s_add_u32 s72, s70, 129024
buffer_load_dwordx4 v4, s[4:7], s72 offen offset:2048 lds
v_mfma_f32_16x16x32_bf16 v[240:243], v[88:91], v[96:99], v[240:243]
s_waitcnt lgkmcnt(5)
buffer_store_dwordx4 v[20:23], v1, s[44:47], s80 offen sc1
LcB1:
v_mfma_f32_16x16x32_bf16 v[128:131], v[64:67], v[32:35], v[128:131]
ds_read_b64_tr_b16 v[88:89], v11 offset:32768
v_accvgpr_read_b32 v24, a224
v_mfma_f32_16x16x32_bf16 v[128:131], v[68:71], v[36:39], v[128:131]
ds_read_b64_tr_b16 v[90:91], v11 offset:33792
v_accvgpr_read_b32 v28, a225
v_mfma_f32_16x16x32_bf16 v[132:135], v[68:71], v[44:47], v[132:135]
v_accvgpr_read_b32 v25, a226
v_accvgpr_read_b32 v29, a227
v_mfma_f32_16x16x32_bf16 v[132:135], v[64:67], v[40:43], v[132:135]
s_add_u32 s72, s70, 144384
buffer_load_dwordx4 v5, s[4:7], s72 offen offset:3072 lds
v_mfma_f32_16x16x32_bf16 v[136:139], v[64:67], v[48:51], v[136:139]
ds_read_b64_tr_b16 v[92:93], v11 offset:40960
v_accvgpr_read_b32 v26, a228
v_mfma_f32_16x16x32_bf16 v[136:139], v[68:71], v[52:55], v[136:139]
s_lshl_b32 s71, s73, 12
v_accvgpr_read_b32 v30, a229
v_accvgpr_read_b32 v27, a230
v_mfma_f32_16x16x32_bf16 v[140:143], v[68:71], v[60:63], v[140:143]
s_add_u32 s71, s71, s66
ds_read_b64_tr_b16 v[94:95], v11 offset:41984
v_accvgpr_read_b32 v31, a231
v_mfma_f32_16x16x32_bf16 v[140:143], v[64:67], v[56:59], v[140:143]
s_waitcnt lgkmcnt(8)
v_cvt_pk_bf16_f32 v24, v24, v28
v_cvt_pk_bf16_f32 v25, v25, v29
v_mfma_f32_16x16x32_bf16 v[156:159], v[72:75], v[56:59], v[156:159]
s_add_u32 m0, s64, 16384
ds_read_b64_tr_b16 v[64:65], v12 offset:32768
v_cvt_pk_bf16_f32 v26, v26, v30
v_mfma_f32_16x16x32_bf16 v[156:159], v[76:79], v[60:63], v[156:159]
s_add_u32 s72, s71, 0
buffer_load_dwordx4 v6, s[12:15], s72 offen lds
v_mfma_f32_16x16x32_bf16 v[152:155], v[76:79], v[52:55], v[152:155]
s_add_u32 s73, s62, 11
ds_read_b64_tr_b16 v[66:67], v12 offset:33792
v_cvt_pk_bf16_f32 v27, v27, v31
v_mfma_f32_16x16x32_bf16 v[152:155], v[72:75], v[48:51], v[152:155]
s_add_u32 s70, s73, s65
v_mfma_f32_16x16x32_bf16 v[148:151], v[72:75], v[40:43], v[148:151]
s_and_b32 s70, s70, 3
ds_read_b64_tr_b16 v[68:69], v12 offset:40960
v_mfma_f32_16x16x32_bf16 v[148:151], v[76:79], v[44:47], v[148:151]
s_and_b32 s73, s73, 12
ds_read_b64_tr_b16 v[70:71], v12 offset:41984
v_mfma_f32_16x16x32_bf16 v[144:147], v[76:79], v[36:39], v[144:147]
s_add_u32 s72, s71, 31744
buffer_load_dwordx4 v6, s[12:15], s72 offen offset:1024 lds
v_mfma_f32_16x16x32_bf16 v[144:147], v[72:75], v[32:35], v[144:147]
s_waitcnt lgkmcnt(8)
v_mfma_f32_16x16x32_bf16 v[160:163], v[80:83], v[32:35], v[160:163]
s_or_b32 s73, s73, s70
ds_read_b64_tr_b16 v[72:73], v13 offset:32768
v_mfma_f32_16x16x32_bf16 v[160:163], v[84:87], v[36:39], v[160:163]
s_lshl_b32 s73, s73, 7
ds_read_b64_tr_b16 v[74:75], v13 offset:33792
v_mfma_f32_16x16x32_bf16 v[164:167], v[84:87], v[44:47], v[164:167]
s_add_u32 s69, s73, s67
v_mfma_f32_16x16x32_bf16 v[164:167], v[80:83], v[40:43], v[164:167]
s_add_u32 s72, s71, 63488
buffer_load_dwordx4 v7, s[12:15], s72 offen offset:2048 lds
v_mfma_f32_16x16x32_bf16 v[168:171], v[80:83], v[48:51], v[168:171]
s_waitcnt vmcnt(18)
ds_read_b64_tr_b16 v[76:77], v13 offset:40960
v_mfma_f32_16x16x32_bf16 v[168:171], v[84:87], v[52:55], v[168:171]
s_add_u32 s70, s73, s68
ds_read_b128 v[96:99], v16 offset:0
v_accvgpr_read_b32 v20, a92
v_mfma_f32_16x16x32_bf16 v[172:175], v[84:87], v[60:63], v[172:175]
s_add_u32 s80, s78, 3072
ds_read_b64_tr_b16 v[78:79], v13 offset:41984
v_accvgpr_read_b32 v28, a93
v_mfma_f32_16x16x32_bf16 v[172:175], v[80:83], v[56:59], v[172:175]
s_waitcnt lgkmcnt(9)
ds_read_b128 v[100:103], v17 offset:0
v_accvgpr_read_b32 v21, a94
v_mfma_f32_16x16x32_bf16 v[188:191], v[88:91], v[56:59], v[188:191]
s_add_u32 s72, s71, 95232
buffer_load_dwordx4 v7, s[12:15], s72 offen offset:3072 lds
v_mfma_f32_16x16x32_bf16 v[188:191], v[92:95], v[60:63], v[188:191]
ds_read_b64_tr_b16 v[80:81], v14 offset:32768
v_accvgpr_read_b32 v29, a95
v_mfma_f32_16x16x32_bf16 v[184:187], v[92:95], v[52:55], v[184:187]
ds_read_b64_tr_b16 v[82:83], v14 offset:33792
v_accvgpr_read_b32 v22, a124
v_mfma_f32_16x16x32_bf16 v[184:187], v[88:91], v[48:51], v[184:187]
buffer_store_dwordx4 v[24:27], v1, s[44:47], s80 offen sc1
v_mfma_f32_16x16x32_bf16 v[180:183], v[88:91], v[40:43], v[180:183]
ds_read_b64_tr_b16 v[84:85], v14 offset:40960
v_accvgpr_read_b32 v30, a125
v_mfma_f32_16x16x32_bf16 v[180:183], v[92:95], v[44:47], v[180:183]
s_add_u32 m0, s63, 98304
ds_read_b64_tr_b16 v[86:87], v14 offset:41984
v_accvgpr_read_b32 v23, a126
v_mfma_f32_16x16x32_bf16 v[176:179], v[92:95], v[36:39], v[176:179]
s_add_u32 s72, s69, 0
buffer_load_dwordx4 v4, s[4:7], s72 offen lds
v_mfma_f32_16x16x32_bf16 v[176:179], v[88:91], v[32:35], v[176:179]
s_waitcnt lgkmcnt(10)
ds_read_b128 v[104:107], v16 offset:2048
v_accvgpr_read_b32 v31, a127
v_mfma_f32_16x16x32_bf16 v[192:195], v[64:67], v[32:35], v[192:195]
ds_read_b64_tr_b16 v[88:89], v15 offset:32768
v_mul_f32 v20, s79, v20
v_mfma_f32_16x16x32_bf16 v[192:195], v[68:71], v[36:39], v[192:195]
ds_read_b64_tr_b16 v[90:91], v15 offset:33792
v_mul_f32 v28, s79, v28
v_mfma_f32_16x16x32_bf16 v[196:199], v[68:71], v[44:47], v[196:199]
ds_read_b64_tr_b16 v[92:93], v15 offset:40960
v_mul_f32 v21, s79, v21
v_mfma_f32_16x16x32_bf16 v[196:199], v[64:67], v[40:43], v[196:199]
s_add_u32 s72, s69, 15360
buffer_load_dwordx4 v5, s[4:7], s72 offen offset:1024 lds
v_mfma_f32_16x16x32_bf16 v[200:203], v[64:67], v[48:51], v[200:203]
ds_read_b64_tr_b16 v[94:95], v15 offset:41984
v_mul_f32 v29, s79, v29
v_mfma_f32_16x16x32_bf16 v[200:203], v[68:71], v[52:55], v[200:203]
ds_read_b128 v[108:111], v17 offset:2048
v_mul_f32 v22, s79, v22
v_mfma_f32_16x16x32_bf16 v[204:207], v[68:71], v[60:63], v[204:207]
v_mul_f32 v30, s79, v30
v_mul_f32 v23, s79, v23
v_mfma_f32_16x16x32_bf16 v[204:207], v[64:67], v[56:59], v[204:207]
s_waitcnt lgkmcnt(11)
ds_read_b128 v[112:115], v16 offset:4096
v_mul_f32 v31, s79, v31
v_mfma_f32_16x16x32_bf16 v[220:223], v[72:75], v[56:59], v[220:223]
s_add_u32 s72, s69, 129024
buffer_load_dwordx4 v4, s[4:7], s72 offen offset:2048 lds
v_mfma_f32_16x16x32_bf16 v[220:223], v[76:79], v[60:63], v[220:223]
v_cvt_pk_bf16_f32 v20, v20, v28
v_cvt_pk_bf16_f32 v21, v21, v29
v_mfma_f32_16x16x32_bf16 v[216:219], v[76:79], v[52:55], v[216:219]
s_waitcnt vmcnt(19) lgkmcnt(2)
ds_read_b128 v[116:119], v17 offset:4096
v_cvt_pk_bf16_f32 v22, v22, v30
v_mfma_f32_16x16x32_bf16 v[216:219], v[72:75], v[48:51], v[216:219]
s_barrier
ds_read_b128 v[120:123], v16 offset:6144
v_cvt_pk_bf16_f32 v23, v23, v31
v_mfma_f32_16x16x32_bf16 v[212:215], v[72:75], v[40:43], v[212:215]
s_add_u32 s80, s77, 46080
ds_read_b64_tr_b16 v[64:65], v8 offset:0
ds_read_b64_tr_b16 v[66:67], v8 offset:1024
v_mfma_f32_16x16x32_bf16 v[212:215], v[76:79], v[44:47], v[212:215]
ds_read_b64_tr_b16 v[68:69], v8 offset:8192
v_accvgpr_read_b32 v24, a232
v_mfma_f32_16x16x32_bf16 v[208:211], v[76:79], v[36:39], v[208:211]
s_add_u32 s72, s69, 144384
buffer_load_dwordx4 v5, s[4:7], s72 offen offset:3072 lds
v_mfma_f32_16x16x32_bf16 v[208:211], v[72:75], v[32:35], v[208:211]
ds_read_b64_tr_b16 v[70:71], v8 offset:9216
v_accvgpr_read_b32 v28, a233
v_mfma_f32_16x16x32_bf16 v[224:227], v[80:83], v[32:35], v[224:227]
ds_read_b64_tr_b16 v[72:73], v9 offset:0
v_accvgpr_read_b32 v25, a234
v_mfma_f32_16x16x32_bf16 v[224:227], v[84:87], v[36:39], v[224:227]
ds_read_b64_tr_b16 v[74:75], v9 offset:1024
v_accvgpr_read_b32 v29, a235
v_mfma_f32_16x16x32_bf16 v[228:231], v[84:87], v[44:47], v[228:231]
s_add_u32 m0, s63, 102400
buffer_store_dwordx4 v[20:23], v1, s[44:47], s80 offen sc1
v_mfma_f32_16x16x32_bf16 v[228:231], v[80:83], v[40:43], v[228:231]
s_add_u32 s72, s70, 0
buffer_load_dwordx4 v4, s[4:7], s72 offen lds
v_mfma_f32_16x16x32_bf16 v[232:235], v[80:83], v[48:51], v[232:235]
ds_read_b64_tr_b16 v[76:77], v9 offset:8192
v_accvgpr_read_b32 v26, a236
v_mfma_f32_16x16x32_bf16 v[232:235], v[84:87], v[52:55], v[232:235]
ds_read_b128 v[124:127], v17 offset:6144
v_accvgpr_read_b32 v30, a237
v_mfma_f32_16x16x32_bf16 v[236:239], v[84:87], v[60:63], v[236:239]
ds_read_b64_tr_b16 v[78:79], v9 offset:9216
v_accvgpr_read_b32 v27, a238
v_mfma_f32_16x16x32_bf16 v[236:239], v[80:83], v[56:59], v[236:239]
v_accvgpr_read_b32 v31, a239
v_cvt_pk_bf16_f32 v24, v24, v28
v_mfma_f32_16x16x32_bf16 v[252:255], v[88:91], v[56:59], v[252:255]
s_add_u32 s72, s70, 15360
buffer_load_dwordx4 v5, s[4:7], s72 offen offset:1024 lds
v_mfma_f32_16x16x32_bf16 v[252:255], v[92:95], v[60:63], v[252:255]
ds_read_b64_tr_b16 v[80:81], v10 offset:0
v_cvt_pk_bf16_f32 v25, v25, v29
v_mfma_f32_16x16x32_bf16 v[248:251], v[92:95], v[52:55], v[248:251]
ds_read_b64_tr_b16 v[82:83], v10 offset:1024
v_cvt_pk_bf16_f32 v26, v26, v30
v_mfma_f32_16x16x32_bf16 v[248:251], v[88:91], v[48:51], v[248:251]
v_cvt_pk_bf16_f32 v27, v27, v31
v_mfma_f32_16x16x32_bf16 v[244:247], v[88:91], v[40:43], v[244:247]
s_add_u32 s80, s78, 11264
ds_read_b64_tr_b16 v[84:85], v10 offset:8192
v_mfma_f32_16x16x32_bf16 v[244:247], v[92:95], v[44:47], v[244:247]
ds_read_b64_tr_b16 v[86:87], v10 offset:9216
v_mfma_f32_16x16x32_bf16 v[240:243], v[92:95], v[36:39], v[240:243]
s_add_u32 s72, s70, 129024
buffer_load_dwordx4 v4, s[4:7], s72 offen offset:2048 lds
v_mfma_f32_16x16x32_bf16 v[240:243], v[88:91], v[32:35], v[240:243]
s_waitcnt lgkmcnt(5)
buffer_store_dwordx4 v[24:27], v1, s[44:47], s80 offen sc1
v_mfma_f32_16x16x32_bf16 v[128:131], v[64:67], v[96:99], v[128:131]
ds_read_b64_tr_b16 v[88:89], v11 offset:0
v_mfma_f32_16x16x32_bf16 v[128:131], v[68:71], v[100:103], v[128:131]
ds_read_b64_tr_b16 v[90:91], v11 offset:1024
v_accvgpr_read_b32 v20, a240
v_mfma_f32_16x16x32_bf16 v[132:135], v[68:71], v[108:111], v[132:135]
v_accvgpr_read_b32 v28, a241
v_accvgpr_read_b32 v21, a242
v_mfma_f32_16x16x32_bf16 v[132:135], v[64:67], v[104:107], v[132:135]
s_add_u32 s72, s70, 144384
buffer_load_dwordx4 v5, s[4:7], s72 offen offset:3072 lds
v_mfma_f32_16x16x32_bf16 v[136:139], v[64:67], v[112:115], v[136:139]
ds_read_b64_tr_b16 v[92:93], v11 offset:8192
v_accvgpr_read_b32 v29, a243
v_mfma_f32_16x16x32_bf16 v[136:139], v[68:71], v[116:119], v[136:139]
s_lshl_b32 s71, s73, 12
v_accvgpr_read_b32 v22, a244
v_accvgpr_read_b32 v30, a245
v_mfma_f32_16x16x32_bf16 v[140:143], v[68:71], v[124:127], v[140:143]
s_add_u32 s71, s71, s66
ds_read_b64_tr_b16 v[94:95], v11 offset:9216
v_accvgpr_read_b32 v23, a246
v_mfma_f32_16x16x32_bf16 v[140:143], v[64:67], v[120:123], v[140:143]
s_waitcnt lgkmcnt(8)
v_accvgpr_read_b32 v31, a247
v_cvt_pk_bf16_f32 v20, v20, v28
v_mfma_f32_16x16x32_bf16 v[156:159], v[72:75], v[120:123], v[156:159]
s_add_u32 m0, s64, 32768
ds_read_b64_tr_b16 v[64:65], v12 offset:0
v_cvt_pk_bf16_f32 v21, v21, v29
v_mfma_f32_16x16x32_bf16 v[156:159], v[76:79], v[124:127], v[156:159]
s_add_u32 s72, s71, 0
buffer_load_dwordx4 v6, s[12:15], s72 offen lds
v_mfma_f32_16x16x32_bf16 v[152:155], v[76:79], v[116:119], v[152:155]
s_add_u32 s73, s62, 12
ds_read_b64_tr_b16 v[66:67], v12 offset:1024
v_cvt_pk_bf16_f32 v22, v22, v30
v_mfma_f32_16x16x32_bf16 v[152:155], v[72:75], v[112:115], v[152:155]
s_add_u32 s70, s73, s65
v_cvt_pk_bf16_f32 v23, v23, v31
v_mfma_f32_16x16x32_bf16 v[148:151], v[72:75], v[104:107], v[148:151]
s_and_b32 s70, s70, 3
ds_read_b64_tr_b16 v[68:69], v12 offset:8192
v_mfma_f32_16x16x32_bf16 v[148:151], v[76:79], v[108:111], v[148:151]
s_and_b32 s73, s73, 12
ds_read_b64_tr_b16 v[70:71], v12 offset:9216
v_mfma_f32_16x16x32_bf16 v[144:147], v[76:79], v[100:103], v[144:147]
s_add_u32 s72, s71, 31744
buffer_load_dwordx4 v6, s[12:15], s72 offen offset:1024 lds
v_mfma_f32_16x16x32_bf16 v[144:147], v[72:75], v[96:99], v[144:147]
s_waitcnt lgkmcnt(8)
v_mfma_f32_16x16x32_bf16 v[160:163], v[80:83], v[96:99], v[160:163]
s_or_b32 s73, s73, s70
ds_read_b64_tr_b16 v[72:73], v13 offset:0
v_mfma_f32_16x16x32_bf16 v[160:163], v[84:87], v[100:103], v[160:163]
s_lshl_b32 s73, s73, 7
ds_read_b64_tr_b16 v[74:75], v13 offset:1024
v_mfma_f32_16x16x32_bf16 v[164:167], v[84:87], v[108:111], v[164:167]
s_add_u32 s69, s73, s67
v_mfma_f32_16x16x32_bf16 v[164:167], v[80:83], v[104:107], v[164:167]
s_add_u32 s72, s71, 63488
buffer_load_dwordx4 v7, s[12:15], s72 offen offset:2048 lds
v_mfma_f32_16x16x32_bf16 v[168:171], v[80:83], v[112:115], v[168:171]
s_waitcnt vmcnt(18)
ds_read_b64_tr_b16 v[76:77], v13 offset:8192
v_mfma_f32_16x16x32_bf16 v[168:171], v[84:87], v[116:119], v[168:171]
s_add_u32 s70, s73, s68
ds_read_b128 v[32:35], v18 offset:0
v_mfma_f32_16x16x32_bf16 v[172:175], v[84:87], v[124:127], v[172:175]
s_add_u32 s80, s78, 35840
ds_read_b64_tr_b16 v[78:79], v13 offset:9216
v_mfma_f32_16x16x32_bf16 v[172:175], v[80:83], v[120:123], v[172:175]
s_waitcnt lgkmcnt(9)
ds_read_b128 v[36:39], v19 offset:0
v_accvgpr_read_b32 v24, a248
v_mfma_f32_16x16x32_bf16 v[188:191], v[88:91], v[120:123], v[188:191]
s_add_u32 s72, s71, 95232
buffer_load_dwordx4 v7, s[12:15], s72 offen offset:3072 lds
v_mfma_f32_16x16x32_bf16 v[188:191], v[92:95], v[124:127], v[188:191]
ds_read_b64_tr_b16 v[80:81], v14 offset:0
v_accvgpr_read_b32 v28, a249
v_mfma_f32_16x16x32_bf16 v[184:187], v[92:95], v[116:119], v[184:187]
ds_read_b64_tr_b16 v[82:83], v14 offset:1024
v_accvgpr_read_b32 v25, a250
v_mfma_f32_16x16x32_bf16 v[184:187], v[88:91], v[112:115], v[184:187]
buffer_store_dwordx4 v[20:23], v1, s[44:47], s80 offen sc1
v_mfma_f32_16x16x32_bf16 v[180:183], v[88:91], v[104:107], v[180:183]
ds_read_b64_tr_b16 v[84:85], v14 offset:8192
v_accvgpr_read_b32 v29, a251
v_mfma_f32_16x16x32_bf16 v[180:183], v[92:95], v[108:111], v[180:183]
s_add_u32 m0, s63, 131072
ds_read_b64_tr_b16 v[86:87], v14 offset:9216
v_accvgpr_read_b32 v26, a252
v_mfma_f32_16x16x32_bf16 v[176:179], v[92:95], v[100:103], v[176:179]
s_add_u32 s72, s69, 0
buffer_load_dwordx4 v4, s[4:7], s72 offen lds
v_mfma_f32_16x16x32_bf16 v[176:179], v[88:91], v[96:99], v[176:179]
s_waitcnt lgkmcnt(10)
ds_read_b128 v[40:43], v18 offset:2048
v_accvgpr_read_b32 v30, a253
v_mfma_f32_16x16x32_bf16 v[192:195], v[64:67], v[96:99], v[192:195]
ds_read_b64_tr_b16 v[88:89], v15 offset:0
v_accvgpr_read_b32 v27, a254
v_mfma_f32_16x16x32_bf16 v[192:195], v[68:71], v[100:103], v[192:195]
ds_read_b64_tr_b16 v[90:91], v15 offset:1024
v_accvgpr_read_b32 v31, a255
v_mfma_f32_16x16x32_bf16 v[196:199], v[68:71], v[108:111], v[196:199]
ds_read_b64_tr_b16 v[92:93], v15 offset:8192
v_cvt_pk_bf16_f32 v24, v24, v28
v_mfma_f32_16x16x32_bf16 v[196:199], v[64:67], v[104:107], v[196:199]
s_add_u32 s72, s69, 15360
buffer_load_dwordx4 v5, s[4:7], s72 offen offset:1024 lds
v_mfma_f32_16x16x32_bf16 v[200:203], v[64:67], v[112:115], v[200:203]
ds_read_b64_tr_b16 v[94:95], v15 offset:9216
v_cvt_pk_bf16_f32 v25, v25, v29
v_mfma_f32_16x16x32_bf16 v[200:203], v[68:71], v[116:119], v[200:203]
ds_read_b128 v[44:47], v19 offset:2048
v_cvt_pk_bf16_f32 v26, v26, v30
v_mfma_f32_16x16x32_bf16 v[204:207], v[68:71], v[124:127], v[204:207]
v_cvt_pk_bf16_f32 v27, v27, v31
v_mfma_f32_16x16x32_bf16 v[204:207], v[64:67], v[120:123], v[204:207]
s_waitcnt lgkmcnt(11)
ds_read_b128 v[48:51], v18 offset:4096
v_mfma_f32_16x16x32_bf16 v[220:223], v[72:75], v[120:123], v[220:223]
s_add_u32 s72, s69, 129024
buffer_load_dwordx4 v4, s[4:7], s72 offen offset:2048 lds
v_mfma_f32_16x16x32_bf16 v[220:223], v[76:79], v[124:127], v[220:223]
s_add_u32 s80, s78, 44032
ds_read_b128 v[52:55], v19 offset:4096
v_mfma_f32_16x16x32_bf16 v[216:219], v[76:79], v[116:119], v[216:219]
s_waitcnt vmcnt(19) lgkmcnt(3)
buffer_store_dwordx4 v[24:27], v1, s[44:47], s80 offen sc1
v_mfma_f32_16x16x32_bf16 v[216:219], v[72:75], v[112:115], v[216:219]
s_barrier
ds_read_b128 v[56:59], v18 offset:6144
v_mfma_f32_16x16x32_bf16 v[212:215], v[72:75], v[104:107], v[212:215]
ds_read_b64_tr_b16 v[64:65], v8 offset:16384
ds_read_b64_tr_b16 v[66:67], v8 offset:17408
v_mfma_f32_16x16x32_bf16 v[212:215], v[76:79], v[108:111], v[212:215]
ds_read_b64_tr_b16 v[68:69], v8 offset:24576
ds_read_b64_tr_b16 v[70:71], v8 offset:25600
v_mfma_f32_16x16x32_bf16 v[208:211], v[76:79], v[100:103], v[208:211]
s_add_u32 s72, s69, 144384
buffer_load_dwordx4 v5, s[4:7], s72 offen offset:3072 lds
v_mfma_f32_16x16x32_bf16 v[208:211], v[72:75], v[96:99], v[208:211]
v_and_b32 v2, 31, v0
v_lshlrev_b32 v2, 2, v2
v_mfma_f32_16x16x32_bf16 v[224:227], v[80:83], v[96:99], v[224:227]
buffer_load_dword v3, v2, s[48:51], 0 offen sc1
v_mfma_f32_16x16x32_bf16 v[224:227], v[84:87], v[100:103], v[224:227]
ds_read_b64_tr_b16 v[72:73], v9 offset:16384
v_mfma_f32_16x16x32_bf16 v[228:231], v[84:87], v[108:111], v[228:231]
s_add_u32 m0, s63, 135168
ds_read_b64_tr_b16 v[74:75], v9 offset:17408
v_mfma_f32_16x16x32_bf16 v[228:231], v[80:83], v[104:107], v[228:231]
s_add_u32 s72, s70, 0
buffer_load_dwordx4 v4, s[4:7], s72 offen lds
v_mfma_f32_16x16x32_bf16 v[232:235], v[80:83], v[112:115], v[232:235]
ds_read_b128 v[60:63], v19 offset:6144
v_mfma_f32_16x16x32_bf16 v[232:235], v[84:87], v[116:119], v[232:235]
ds_read_b64_tr_b16 v[76:77], v9 offset:24576
v_mfma_f32_16x16x32_bf16 v[236:239], v[84:87], v[124:127], v[236:239]
ds_read_b64_tr_b16 v[78:79], v9 offset:25600
v_mfma_f32_16x16x32_bf16 v[236:239], v[80:83], v[120:123], v[236:239]
v_mfma_f32_16x16x32_bf16 v[252:255], v[88:91], v[120:123], v[252:255]
s_add_u32 s72, s70, 15360
buffer_load_dwordx4 v5, s[4:7], s72 offen offset:1024 lds
v_mfma_f32_16x16x32_bf16 v[252:255], v[92:95], v[124:127], v[252:255]
ds_read_b64_tr_b16 v[80:81], v10 offset:16384
v_mfma_f32_16x16x32_bf16 v[248:251], v[92:95], v[116:119], v[248:251]
ds_read_b64_tr_b16 v[82:83], v10 offset:17408
v_mfma_f32_16x16x32_bf16 v[248:251], v[88:91], v[112:115], v[248:251]
v_mfma_f32_16x16x32_bf16 v[244:247], v[88:91], v[104:107], v[244:247]
ds_read_b64_tr_b16 v[84:85], v10 offset:24576
v_mfma_f32_16x16x32_bf16 v[244:247], v[92:95], v[108:111], v[244:247]
ds_read_b64_tr_b16 v[86:87], v10 offset:25600
v_mfma_f32_16x16x32_bf16 v[240:243], v[92:95], v[100:103], v[240:243]
s_add_u32 s72, s70, 129024
buffer_load_dwordx4 v4, s[4:7], s72 offen offset:2048 lds
v_mfma_f32_16x16x32_bf16 v[240:243], v[88:91], v[96:99], v[240:243]
s_waitcnt lgkmcnt(6)
v_mfma_f32_16x16x32_bf16 v[128:131], v[64:67], v[32:35], v[128:131]
ds_read_b64_tr_b16 v[88:89], v11 offset:16384
v_mfma_f32_16x16x32_bf16 v[128:131], v[68:71], v[36:39], v[128:131]
ds_read_b64_tr_b16 v[90:91], v11 offset:17408
v_mfma_f32_16x16x32_bf16 v[132:135], v[68:71], v[44:47], v[132:135]
v_mfma_f32_16x16x32_bf16 v[132:135], v[64:67], v[40:43], v[132:135]
s_add_u32 s72, s70, 144384
buffer_load_dwordx4 v5, s[4:7], s72 offen offset:3072 lds
v_mfma_f32_16x16x32_bf16 v[136:139], v[64:67], v[48:51], v[136:139]
ds_read_b64_tr_b16 v[92:93], v11 offset:24576
v_mfma_f32_16x16x32_bf16 v[136:139], v[68:71], v[52:55], v[136:139]
s_lshl_b32 s71, s73, 12
v_mfma_f32_16x16x32_bf16 v[140:143], v[68:71], v[60:63], v[140:143]
s_add_u32 s71, s71, s66
ds_read_b64_tr_b16 v[94:95], v11 offset:25600
v_mfma_f32_16x16x32_bf16 v[140:143], v[64:67], v[56:59], v[140:143]
s_waitcnt lgkmcnt(8)
v_mfma_f32_16x16x32_bf16 v[156:159], v[72:75], v[56:59], v[156:159]
s_add_u32 m0, s64, 0
ds_read_b64_tr_b16 v[64:65], v12 offset:16384
v_mfma_f32_16x16x32_bf16 v[156:159], v[76:79], v[60:63], v[156:159]
s_add_u32 s72, s71, 0
buffer_load_dwordx4 v6, s[12:15], s72 offen lds
v_mfma_f32_16x16x32_bf16 v[152:155], v[76:79], v[52:55], v[152:155]
s_add_u32 s73, s62, 13
ds_read_b64_tr_b16 v[66:67], v12 offset:17408
v_mfma_f32_16x16x32_bf16 v[152:155], v[72:75], v[48:51], v[152:155]
s_add_u32 s70, s73, s65
v_mfma_f32_16x16x32_bf16 v[148:151], v[72:75], v[40:43], v[148:151]
s_and_b32 s70, s70, 3
ds_read_b64_tr_b16 v[68:69], v12 offset:24576
v_mfma_f32_16x16x32_bf16 v[148:151], v[76:79], v[44:47], v[148:151]
s_and_b32 s73, s73, 12
ds_read_b64_tr_b16 v[70:71], v12 offset:25600
v_mfma_f32_16x16x32_bf16 v[144:147], v[76:79], v[36:39], v[144:147]
s_add_u32 s72, s71, 31744
buffer_load_dwordx4 v6, s[12:15], s72 offen offset:1024 lds
v_mfma_f32_16x16x32_bf16 v[144:147], v[72:75], v[32:35], v[144:147]
s_waitcnt lgkmcnt(8)
v_mfma_f32_16x16x32_bf16 v[160:163], v[80:83], v[32:35], v[160:163]
s_or_b32 s73, s73, s70
ds_read_b64_tr_b16 v[72:73], v13 offset:16384
v_mfma_f32_16x16x32_bf16 v[160:163], v[84:87], v[36:39], v[160:163]
s_lshl_b32 s73, s73, 7
ds_read_b64_tr_b16 v[74:75], v13 offset:17408
v_mfma_f32_16x16x32_bf16 v[164:167], v[84:87], v[44:47], v[164:167]
s_add_u32 s69, s73, s67
v_mfma_f32_16x16x32_bf16 v[164:167], v[80:83], v[40:43], v[164:167]
s_add_u32 s72, s71, 63488
buffer_load_dwordx4 v7, s[12:15], s72 offen offset:2048 lds
v_mfma_f32_16x16x32_bf16 v[168:171], v[80:83], v[48:51], v[168:171]
s_waitcnt vmcnt(18)
ds_read_b64_tr_b16 v[76:77], v13 offset:24576
v_mfma_f32_16x16x32_bf16 v[168:171], v[84:87], v[52:55], v[168:171]
s_add_u32 s70, s73, s68
ds_read_b128 v[96:99], v18 offset:32768
v_mfma_f32_16x16x32_bf16 v[172:175], v[84:87], v[60:63], v[172:175]
ds_read_b64_tr_b16 v[78:79], v13 offset:25600
v_mfma_f32_16x16x32_bf16 v[172:175], v[80:83], v[56:59], v[172:175]
s_waitcnt lgkmcnt(9)
ds_read_b128 v[100:103], v19 offset:32768
v_mfma_f32_16x16x32_bf16 v[188:191], v[88:91], v[56:59], v[188:191]
s_add_u32 s72, s71, 95232
buffer_load_dwordx4 v7, s[12:15], s72 offen offset:3072 lds
v_mfma_f32_16x16x32_bf16 v[188:191], v[92:95], v[60:63], v[188:191]
ds_read_b64_tr_b16 v[80:81], v14 offset:16384
v_mfma_f32_16x16x32_bf16 v[184:187], v[92:95], v[52:55], v[184:187]
ds_read_b64_tr_b16 v[82:83], v14 offset:17408
v_mfma_f32_16x16x32_bf16 v[184:187], v[88:91], v[48:51], v[184:187]
v_mfma_f32_16x16x32_bf16 v[180:183], v[88:91], v[40:43], v[180:183]
ds_read_b64_tr_b16 v[84:85], v14 offset:24576
v_mfma_f32_16x16x32_bf16 v[180:183], v[92:95], v[44:47], v[180:183]
s_add_u32 m0, s63, 65536
ds_read_b64_tr_b16 v[86:87], v14 offset:25600
v_mfma_f32_16x16x32_bf16 v[176:179], v[92:95], v[36:39], v[176:179]
s_add_u32 s72, s69, 0
buffer_load_dwordx4 v4, s[4:7], s72 offen lds
v_mfma_f32_16x16x32_bf16 v[176:179], v[88:91], v[32:35], v[176:179]
s_waitcnt lgkmcnt(10)
ds_read_b128 v[104:107], v18 offset:34816
v_mfma_f32_16x16x32_bf16 v[192:195], v[64:67], v[32:35], v[192:195]
ds_read_b64_tr_b16 v[88:89], v15 offset:16384
v_mfma_f32_16x16x32_bf16 v[192:195], v[68:71], v[36:39], v[192:195]
ds_read_b64_tr_b16 v[90:91], v15 offset:17408
v_mfma_f32_16x16x32_bf16 v[196:199], v[68:71], v[44:47], v[196:199]
ds_read_b64_tr_b16 v[92:93], v15 offset:24576
v_mfma_f32_16x16x32_bf16 v[196:199], v[64:67], v[40:43], v[196:199]
s_add_u32 s72, s69, 15360
buffer_load_dwordx4 v5, s[4:7], s72 offen offset:1024 lds
v_mfma_f32_16x16x32_bf16 v[200:203], v[64:67], v[48:51], v[200:203]
ds_read_b64_tr_b16 v[94:95], v15 offset:25600
v_mfma_f32_16x16x32_bf16 v[200:203], v[68:71], v[52:55], v[200:203]
ds_read_b128 v[108:111], v19 offset:34816
v_mfma_f32_16x16x32_bf16 v[204:207], v[68:71], v[60:63], v[204:207]
v_mfma_f32_16x16x32_bf16 v[204:207], v[64:67], v[56:59], v[204:207]
s_waitcnt lgkmcnt(11)
ds_read_b128 v[112:115], v18 offset:36864
v_mfma_f32_16x16x32_bf16 v[220:223], v[72:75], v[56:59], v[220:223]
s_add_u32 s72, s69, 129024
buffer_load_dwordx4 v4, s[4:7], s72 offen offset:2048 lds
v_mfma_f32_16x16x32_bf16 v[220:223], v[76:79], v[60:63], v[220:223]
v_mfma_f32_16x16x32_bf16 v[216:219], v[76:79], v[52:55], v[216:219]
s_waitcnt vmcnt(13) lgkmcnt(2)
ds_read_b128 v[116:119], v19 offset:36864
v_mfma_f32_16x16x32_bf16 v[216:219], v[72:75], v[48:51], v[216:219]
s_barrier
ds_read_b128 v[120:123], v18 offset:38912
v_mfma_f32_16x16x32_bf16 v[212:215], v[72:75], v[40:43], v[212:215]
ds_read_b64_tr_b16 v[64:65], v8 offset:32768
ds_read_b64_tr_b16 v[66:67], v8 offset:33792
v_mfma_f32_16x16x32_bf16 v[212:215], v[76:79], v[44:47], v[212:215]
ds_read_b64_tr_b16 v[68:69], v8 offset:40960
v_or_b32 v20, s58, v0
v_mfma_f32_16x16x32_bf16 v[208:211], v[76:79], v[36:39], v[208:211]
s_add_u32 s72, s69, 144384
buffer_load_dwordx4 v5, s[4:7], s72 offen offset:3072 lds
v_mfma_f32_16x16x32_bf16 v[208:211], v[72:75], v[32:35], v[208:211]
ds_read_b64_tr_b16 v[70:71], v8 offset:41984
v_mov_b32 v21, 1
v_mfma_f32_16x16x32_bf16 v[224:227], v[80:83], v[32:35], v[224:227]
ds_read_b64_tr_b16 v[72:73], v9 offset:32768
v_min_u32 v20, 1, v20
v_mfma_f32_16x16x32_bf16 v[224:227], v[84:87], v[36:39], v[224:227]
ds_read_b64_tr_b16 v[74:75], v9 offset:33792
v_lshlrev_b32 v20, 30, v20
v_mfma_f32_16x16x32_bf16 v[228:231], v[84:87], v[44:47], v[228:231]
s_add_u32 m0, s63, 69632
buffer_store_dword v21, v20, s[44:47], s91 offen sc1
v_mfma_f32_16x16x32_bf16 v[228:231], v[80:83], v[40:43], v[228:231]
s_add_u32 s72, s70, 0
buffer_load_dwordx4 v4, s[4:7], s72 offen lds
v_mfma_f32_16x16x32_bf16 v[232:235], v[80:83], v[48:51], v[232:235]
ds_read_b64_tr_b16 v[76:77], v9 offset:40960
v_accvgpr_write_b32 a32, 0
v_mfma_f32_16x16x32_bf16 v[232:235], v[84:87], v[52:55], v[232:235]
ds_read_b128 v[124:127], v19 offset:38912
v_accvgpr_write_b32 a33, 0
v_mfma_f32_16x16x32_bf16 v[236:239], v[84:87], v[60:63], v[236:239]
ds_read_b64_tr_b16 v[78:79], v9 offset:41984
v_accvgpr_write_b32 a34, 0
v_mfma_f32_16x16x32_bf16 v[236:239], v[80:83], v[56:59], v[236:239]
v_accvgpr_write_b32 a35, 0
v_accvgpr_write_b32 a36, 0
v_mfma_f32_16x16x32_bf16 v[252:255], v[88:91], v[56:59], v[252:255]
s_add_u32 s72, s70, 15360
buffer_load_dwordx4 v5, s[4:7], s72 offen offset:1024 lds
v_mfma_f32_16x16x32_bf16 v[252:255], v[92:95], v[60:63], v[252:255]
ds_read_b64_tr_b16 v[80:81], v10 offset:32768
v_accvgpr_write_b32 a37, 0
v_mfma_f32_16x16x32_bf16 v[248:251], v[92:95], v[52:55], v[248:251]
ds_read_b64_tr_b16 v[82:83], v10 offset:33792
v_accvgpr_write_b32 a38, 0
v_mfma_f32_16x16x32_bf16 v[248:251], v[88:91], v[48:51], v[248:251]
v_accvgpr_write_b32 a39, 0
v_accvgpr_write_b32 a40, 0
v_mfma_f32_16x16x32_bf16 v[244:247], v[88:91], v[40:43], v[244:247]
ds_read_b64_tr_b16 v[84:85], v10 offset:40960
v_accvgpr_write_b32 a41, 0
v_mfma_f32_16x16x32_bf16 v[244:247], v[92:95], v[44:47], v[244:247]
ds_read_b64_tr_b16 v[86:87], v10 offset:41984
v_accvgpr_write_b32 a42, 0
v_mfma_f32_16x16x32_bf16 v[240:243], v[92:95], v[36:39], v[240:243]
s_add_u32 s72, s70, 129024
buffer_load_dwordx4 v4, s[4:7], s72 offen offset:2048 lds
v_mfma_f32_16x16x32_bf16 v[240:243], v[88:91], v[32:35], v[240:243]
s_waitcnt lgkmcnt(5)
v_accvgpr_write_b32 a43, 0
v_accvgpr_write_b32 a44, 0
v_mfma_f32_16x16x32_bf16 v[128:131], v[64:67], v[96:99], v[128:131]
ds_read_b64_tr_b16 v[88:89], v11 offset:32768
v_accvgpr_write_b32 a45, 0
v_mfma_f32_16x16x32_bf16 v[128:131], v[68:71], v[100:103], v[128:131]
ds_read_b64_tr_b16 v[90:91], v11 offset:33792
v_accvgpr_write_b32 a46, 0
v_mfma_f32_16x16x32_bf16 v[132:135], v[68:71], v[108:111], v[132:135]
v_accvgpr_write_b32 a47, 0
v_accvgpr_write_b32 a48, 0
v_mfma_f32_16x16x32_bf16 v[132:135], v[64:67], v[104:107], v[132:135]
s_add_u32 s72, s70, 144384
buffer_load_dwordx4 v5, s[4:7], s72 offen offset:3072 lds
v_mfma_f32_16x16x32_bf16 v[136:139], v[64:67], v[112:115], v[136:139]
ds_read_b64_tr_b16 v[92:93], v11 offset:40960
v_accvgpr_write_b32 a49, 0
v_mfma_f32_16x16x32_bf16 v[136:139], v[68:71], v[116:119], v[136:139]
s_lshl_b32 s71, s73, 12
v_accvgpr_write_b32 a50, 0
v_accvgpr_write_b32 a51, 0
v_mfma_f32_16x16x32_bf16 v[140:143], v[68:71], v[124:127], v[140:143]
s_add_u32 s71, s71, s66
ds_read_b64_tr_b16 v[94:95], v11 offset:41984
v_accvgpr_write_b32 a52, 0
v_mfma_f32_16x16x32_bf16 v[140:143], v[64:67], v[120:123], v[140:143]
s_waitcnt lgkmcnt(8)
v_accvgpr_write_b32 a53, 0
v_accvgpr_write_b32 a54, 0
v_mfma_f32_16x16x32_bf16 v[156:159], v[72:75], v[120:123], v[156:159]
s_add_u32 m0, s64, 16384
ds_read_b64_tr_b16 v[64:65], v12 offset:32768
v_accvgpr_write_b32 a55, 0
v_mfma_f32_16x16x32_bf16 v[156:159], v[76:79], v[124:127], v[156:159]
s_add_u32 s72, s71, 0
buffer_load_dwordx4 v6, s[12:15], s72 offen lds
v_mfma_f32_16x16x32_bf16 v[152:155], v[76:79], v[116:119], v[152:155]
s_add_u32 s73, s62, 14
ds_read_b64_tr_b16 v[66:67], v12 offset:33792
v_accvgpr_write_b32 a56, 0
v_mfma_f32_16x16x32_bf16 v[152:155], v[72:75], v[112:115], v[152:155]
s_add_u32 s70, s73, s65
v_accvgpr_write_b32 a57, 0
v_accvgpr_write_b32 a58, 0
v_mfma_f32_16x16x32_bf16 v[148:151], v[72:75], v[104:107], v[148:151]
s_and_b32 s70, s70, 3
ds_read_b64_tr_b16 v[68:69], v12 offset:40960
v_accvgpr_write_b32 a59, 0
v_mfma_f32_16x16x32_bf16 v[148:151], v[76:79], v[108:111], v[148:151]
s_and_b32 s73, s73, 12
ds_read_b64_tr_b16 v[70:71], v12 offset:41984
v_accvgpr_write_b32 a60, 0
v_mfma_f32_16x16x32_bf16 v[144:147], v[76:79], v[100:103], v[144:147]
s_add_u32 s72, s71, 31744
buffer_load_dwordx4 v6, s[12:15], s72 offen offset:1024 lds
v_mfma_f32_16x16x32_bf16 v[144:147], v[72:75], v[96:99], v[144:147]
s_waitcnt lgkmcnt(8)
v_accvgpr_write_b32 a61, 0
v_accvgpr_write_b32 a62, 0
v_mfma_f32_16x16x32_bf16 v[160:163], v[80:83], v[96:99], v[160:163]
s_or_b32 s73, s73, s70
ds_read_b64_tr_b16 v[72:73], v13 offset:32768
v_accvgpr_write_b32 a63, 0
v_mfma_f32_16x16x32_bf16 v[160:163], v[84:87], v[100:103], v[160:163]
s_lshl_b32 s73, s73, 7
ds_read_b64_tr_b16 v[74:75], v13 offset:33792
v_accvgpr_write_b32 a96, 0
v_mfma_f32_16x16x32_bf16 v[164:167], v[84:87], v[108:111], v[164:167]
s_add_u32 s69, s73, s67
v_accvgpr_write_b32 a97, 0
v_accvgpr_write_b32 a98, 0
v_mfma_f32_16x16x32_bf16 v[164:167], v[80:83], v[104:107], v[164:167]
s_add_u32 s72, s71, 63488
buffer_load_dwordx4 v7, s[12:15], s72 offen offset:2048 lds
v_mfma_f32_16x16x32_bf16 v[168:171], v[80:83], v[112:115], v[168:171]
s_waitcnt vmcnt(16)
ds_read_b64_tr_b16 v[76:77], v13 offset:40960
v_accvgpr_write_b32 a99, 0
v_mfma_f32_16x16x32_bf16 v[168:171], v[84:87], v[116:119], v[168:171]
s_add_u32 s70, s73, s68
ds_read_b128 v[32:35], v16 offset:0
v_accvgpr_write_b32 a100, 0
v_mfma_f32_16x16x32_bf16 v[172:175], v[84:87], v[124:127], v[172:175]
ds_read_b64_tr_b16 v[78:79], v13 offset:41984
v_accvgpr_write_b32 a101, 0
v_mfma_f32_16x16x32_bf16 v[172:175], v[80:83], v[120:123], v[172:175]
s_waitcnt lgkmcnt(9)
ds_read_b128 v[36:39], v17 offset:0
v_accvgpr_write_b32 a102, 0
v_mfma_f32_16x16x32_bf16 v[188:191], v[88:91], v[120:123], v[188:191]
s_add_u32 s72, s71, 95232
buffer_load_dwordx4 v7, s[12:15], s72 offen offset:3072 lds
v_mfma_f32_16x16x32_bf16 v[188:191], v[92:95], v[124:127], v[188:191]
ds_read_b64_tr_b16 v[80:81], v14 offset:32768
v_accvgpr_write_b32 a103, 0
v_mfma_f32_16x16x32_bf16 v[184:187], v[92:95], v[116:119], v[184:187]
ds_read_b64_tr_b16 v[82:83], v14 offset:33792
v_accvgpr_write_b32 a104, 0
v_mfma_f32_16x16x32_bf16 v[184:187], v[88:91], v[112:115], v[184:187]
v_accvgpr_write_b32 a105, 0
v_accvgpr_write_b32 a106, 0
v_mfma_f32_16x16x32_bf16 v[180:183], v[88:91], v[104:107], v[180:183]
ds_read_b64_tr_b16 v[84:85], v14 offset:40960
v_accvgpr_write_b32 a107, 0
v_mfma_f32_16x16x32_bf16 v[180:183], v[92:95], v[108:111], v[180:183]
s_add_u32 m0, s63, 98304
ds_read_b64_tr_b16 v[86:87], v14 offset:41984
v_accvgpr_write_b32 a108, 0
v_mfma_f32_16x16x32_bf16 v[176:179], v[92:95], v[100:103], v[176:179]
s_add_u32 s72, s69, 0
buffer_load_dwordx4 v4, s[4:7], s72 offen lds
v_mfma_f32_16x16x32_bf16 v[176:179], v[88:91], v[96:99], v[176:179]
s_waitcnt lgkmcnt(10)
ds_read_b128 v[40:43], v16 offset:2048
v_accvgpr_write_b32 a109, 0
v_mfma_f32_16x16x32_bf16 v[192:195], v[64:67], v[96:99], v[192:195]
ds_read_b64_tr_b16 v[88:89], v15 offset:32768
v_accvgpr_write_b32 a110, 0
v_mfma_f32_16x16x32_bf16 v[192:195], v[68:71], v[100:103], v[192:195]
ds_read_b64_tr_b16 v[90:91], v15 offset:33792
v_accvgpr_write_b32 a111, 0
v_mfma_f32_16x16x32_bf16 v[196:199], v[68:71], v[108:111], v[196:199]
ds_read_b64_tr_b16 v[92:93], v15 offset:40960
v_accvgpr_write_b32 a112, 0
v_mfma_f32_16x16x32_bf16 v[196:199], v[64:67], v[104:107], v[196:199]
s_add_u32 s72, s69, 15360
buffer_load_dwordx4 v5, s[4:7], s72 offen offset:1024 lds
v_mfma_f32_16x16x32_bf16 v[200:203], v[64:67], v[112:115], v[200:203]
ds_read_b64_tr_b16 v[94:95], v15 offset:41984
v_accvgpr_write_b32 a113, 0
v_mfma_f32_16x16x32_bf16 v[200:203], v[68:71], v[116:119], v[200:203]
ds_read_b128 v[44:47], v17 offset:2048
v_accvgpr_write_b32 a114, 0
v_mfma_f32_16x16x32_bf16 v[204:207], v[68:71], v[124:127], v[204:207]
v_accvgpr_write_b32 a115, 0
v_accvgpr_write_b32 a116, 0
v_mfma_f32_16x16x32_bf16 v[204:207], v[64:67], v[120:123], v[204:207]
s_waitcnt lgkmcnt(11)
ds_read_b128 v[48:51], v16 offset:4096
v_accvgpr_write_b32 a117, 0
v_mfma_f32_16x16x32_bf16 v[220:223], v[72:75], v[120:123], v[220:223]
s_add_u32 s72, s69, 129024
buffer_load_dwordx4 v4, s[4:7], s72 offen offset:2048 lds
v_mfma_f32_16x16x32_bf16 v[220:223], v[76:79], v[124:127], v[220:223]
v_accvgpr_write_b32 a118, 0
v_accvgpr_write_b32 a119, 0
v_mfma_f32_16x16x32_bf16 v[216:219], v[76:79], v[116:119], v[216:219]
s_waitcnt vmcnt(16) lgkmcnt(2)
ds_read_b128 v[52:55], v17 offset:4096
v_accvgpr_write_b32 a120, 0
v_mfma_f32_16x16x32_bf16 v[216:219], v[72:75], v[112:115], v[216:219]
s_barrier
ds_read_b128 v[56:59], v16 offset:6144
v_accvgpr_write_b32 a121, 0
v_mfma_f32_16x16x32_bf16 v[212:215], v[72:75], v[104:107], v[212:215]
s_waitcnt vmcnt(24)
v_cmp_gt_u32 vcc, 8, v3
s_cbranch_vccnz Lspin1
Lback2:
v_mfma_f32_16x16x32_bf16 v[212:215], v[76:79], v[108:111], v[212:215]
ds_read_b64_tr_b16 v[64:65], v8 offset:0
ds_read_b64_tr_b16 v[66:67], v8 offset:1024
v_mfma_f32_16x16x32_bf16 v[208:211], v[76:79], v[100:103], v[208:211]
s_add_u32 s72, s69, 144384
buffer_load_dwordx4 v5, s[4:7], s72 offen offset:3072 lds
v_mfma_f32_16x16x32_bf16 v[208:211], v[72:75], v[96:99], v[208:211]
ds_read_b64_tr_b16 v[68:69], v8 offset:8192
ds_read_b64_tr_b16 v[70:71], v8 offset:9216
v_mfma_f32_16x16x32_bf16 v[224:227], v[80:83], v[96:99], v[224:227]
ds_read_b64_tr_b16 v[72:73], v9 offset:0
v_accvgpr_write_b32 a122, 0
v_mfma_f32_16x16x32_bf16 v[224:227], v[84:87], v[100:103], v[224:227]
ds_read_b64_tr_b16 v[74:75], v9 offset:1024
v_accvgpr_write_b32 a123, 0
v_mfma_f32_16x16x32_bf16 v[228:231], v[84:87], v[108:111], v[228:231]
s_add_u32 m0, s63, 102400
v_accvgpr_write_b32 a124, 0
v_accvgpr_write_b32 a125, 0
v_mfma_f32_16x16x32_bf16 v[228:231], v[80:83], v[104:107], v[228:231]
s_add_u32 s72, s70, 0
buffer_load_dwordx4 v4, s[4:7], s72 offen lds
v_mfma_f32_16x16x32_bf16 v[232:235], v[80:83], v[112:115], v[232:235]
ds_read_b64_tr_b16 v[76:77], v9 offset:8192
v_accvgpr_write_b32 a126, 0
v_mfma_f32_16x16x32_bf16 v[232:235], v[84:87], v[116:119], v[232:235]
ds_read_b128 v[60:63], v17 offset:6144
v_accvgpr_write_b32 a127, 0
v_mfma_f32_16x16x32_bf16 v[236:239], v[84:87], v[124:127], v[236:239]
ds_read_b64_tr_b16 v[78:79], v9 offset:9216
v_mfma_f32_16x16x32_bf16 v[236:239], v[80:83], v[120:123], v[236:239]
v_mfma_f32_16x16x32_bf16 v[252:255], v[88:91], v[120:123], v[252:255]
s_add_u32 s72, s70, 15360
buffer_load_dwordx4 v5, s[4:7], s72 offen offset:1024 lds
v_mfma_f32_16x16x32_bf16 v[252:255], v[92:95], v[124:127], v[252:255]
ds_read_b64_tr_b16 v[80:81], v10 offset:0
v_mfma_f32_16x16x32_bf16 v[248:251], v[92:95], v[116:119], v[248:251]
ds_read_b64_tr_b16 v[82:83], v10 offset:1024
v_mfma_f32_16x16x32_bf16 v[248:251], v[88:91], v[112:115], v[248:251]
v_mfma_f32_16x16x32_bf16 v[244:247], v[88:91], v[104:107], v[244:247]
ds_read_b64_tr_b16 v[84:85], v10 offset:8192
v_mfma_f32_16x16x32_bf16 v[244:247], v[92:95], v[108:111], v[244:247]
ds_read_b64_tr_b16 v[86:87], v10 offset:9216
v_mfma_f32_16x16x32_bf16 v[240:243], v[92:95], v[100:103], v[240:243]
s_add_u32 s72, s70, 129024
buffer_load_dwordx4 v4, s[4:7], s72 offen offset:2048 lds
v_mfma_f32_16x16x32_bf16 v[240:243], v[88:91], v[96:99], v[240:243]
s_waitcnt lgkmcnt(5)
v_mfma_f32_16x16x32_bf16 v[128:131], v[64:67], v[32:35], v[128:131]
ds_read_b64_tr_b16 v[88:89], v11 offset:0
v_mfma_f32_16x16x32_bf16 v[128:131], v[68:71], v[36:39], v[128:131]
ds_read_b64_tr_b16 v[90:91], v11 offset:1024
v_mfma_f32_16x16x32_bf16 v[132:135], v[68:71], v[44:47], v[132:135]
v_mfma_f32_16x16x32_bf16 v[132:135], v[64:67], v[40:43], v[132:135]
s_add_u32 s72, s70, 144384
buffer_load_dwordx4 v5, s[4:7], s72 offen offset:3072 lds
v_mfma_f32_16x16x32_bf16 v[136:139], v[64:67], v[48:51], v[136:139]
ds_read_b64_tr_b16 v[92:93], v11 offset:8192
v_mfma_f32_16x16x32_bf16 v[136:139], v[68:71], v[52:55], v[136:139]
s_lshl_b32 s71, s73, 12
v_mfma_f32_16x16x32_bf16 v[140:143], v[68:71], v[60:63], v[140:143]
s_add_u32 s71, s71, s66
ds_read_b64_tr_b16 v[94:95], v11 offset:9216
v_mfma_f32_16x16x32_bf16 v[140:143], v[64:67], v[56:59], v[140:143]
s_waitcnt lgkmcnt(8)
v_mfma_f32_16x16x32_bf16 v[156:159], v[72:75], v[56:59], v[156:159]
s_add_u32 m0, s64, 32768
ds_read_b64_tr_b16 v[64:65], v12 offset:0
v_mfma_f32_16x16x32_bf16 v[156:159], v[76:79], v[60:63], v[156:159]
s_add_u32 s72, s71, 0
buffer_load_dwordx4 v6, s[12:15], s72 offen lds
v_mfma_f32_16x16x32_bf16 v[152:155], v[76:79], v[52:55], v[152:155]
s_add_u32 s73, s62, 15
ds_read_b64_tr_b16 v[66:67], v12 offset:1024
v_mfma_f32_16x16x32_bf16 v[152:155], v[72:75], v[48:51], v[152:155]
s_add_u32 s70, s73, s65
v_mfma_f32_16x16x32_bf16 v[148:151], v[72:75], v[40:43], v[148:151]
s_and_b32 s70, s70, 3
ds_read_b64_tr_b16 v[68:69], v12 offset:8192
v_mfma_f32_16x16x32_bf16 v[148:151], v[76:79], v[44:47], v[148:151]
s_and_b32 s73, s73, 12
ds_read_b64_tr_b16 v[70:71], v12 offset:9216
v_mfma_f32_16x16x32_bf16 v[144:147], v[76:79], v[36:39], v[144:147]
s_add_u32 s72, s71, 31744
buffer_load_dwordx4 v6, s[12:15], s72 offen offset:1024 lds
v_mfma_f32_16x16x32_bf16 v[144:147], v[72:75], v[32:35], v[144:147]
s_waitcnt lgkmcnt(8)
v_mfma_f32_16x16x32_bf16 v[160:163], v[80:83], v[32:35], v[160:163]
s_or_b32 s73, s73, s70
ds_read_b64_tr_b16 v[72:73], v13 offset:0
v_mfma_f32_16x16x32_bf16 v[160:163], v[84:87], v[36:39], v[160:163]
s_lshl_b32 s73, s73, 7
ds_read_b64_tr_b16 v[74:75], v13 offset:1024
v_mfma_f32_16x16x32_bf16 v[164:167], v[84:87], v[44:47], v[164:167]
s_add_u32 s69, s73, s67
v_mfma_f32_16x16x32_bf16 v[164:167], v[80:83], v[40:43], v[164:167]
s_add_u32 s72, s71, 63488
buffer_load_dwordx4 v7, s[12:15], s72 offen offset:2048 lds
v_mfma_f32_16x16x32_bf16 v[168:171], v[80:83], v[48:51], v[168:171]
s_waitcnt vmcnt(15)
ds_read_b64_tr_b16 v[76:77], v13 offset:8192
v_mfma_f32_16x16x32_bf16 v[168:171], v[84:87], v[52:55], v[168:171]
s_add_u32 s70, s73, s68
ds_read_b128 v[96:99], v18 offset:0
v_mfma_f32_16x16x32_bf16 v[172:175], v[84:87], v[60:63], v[172:175]
ds_read_b64_tr_b16 v[78:79], v13 offset:9216
v_mfma_f32_16x16x32_bf16 v[172:175], v[80:83], v[56:59], v[172:175]
s_waitcnt lgkmcnt(9)
ds_read_b128 v[100:103], v19 offset:0
v_mfma_f32_16x16x32_bf16 v[188:191], v[88:91], v[56:59], v[188:191]
s_add_u32 s72, s71, 95232
buffer_load_dwordx4 v7, s[12:15], s72 offen offset:3072 lds
v_mfma_f32_16x16x32_bf16 v[188:191], v[92:95], v[60:63], v[188:191]
ds_read_b64_tr_b16 v[80:81], v14 offset:0
v_mfma_f32_16x16x32_bf16 v[184:187], v[92:95], v[52:55], v[184:187]
ds_read_b64_tr_b16 v[82:83], v14 offset:1024
v_mfma_f32_16x16x32_bf16 v[184:187], v[88:91], v[48:51], v[184:187]
v_mfma_f32_16x16x32_bf16 v[180:183], v[88:91], v[40:43], v[180:183]
ds_read_b64_tr_b16 v[84:85], v14 offset:8192
v_mfma_f32_16x16x32_bf16 v[180:183], v[92:95], v[44:47], v[180:183]
s_add_u32 m0, s63, 131072
ds_read_b64_tr_b16 v[86:87], v14 offset:9216
v_mfma_f32_16x16x32_bf16 v[176:179], v[92:95], v[36:39], v[176:179]
s_add_u32 s72, s69, 0
buffer_load_dwordx4 v4, s[4:7], s72 offen lds
v_mfma_f32_16x16x32_bf16 v[176:179], v[88:91], v[32:35], v[176:179]
s_waitcnt lgkmcnt(10)
ds_read_b128 v[104:107], v18 offset:2048
v_mfma_f32_16x16x32_bf16 v[192:195], v[64:67], v[32:35], v[192:195]
ds_read_b64_tr_b16 v[88:89], v15 offset:0
ds_read_b64_tr_b16 v[90:91], v15 offset:1024
v_mfma_f32_16x16x32_bf16 v[192:195], v[68:71], v[36:39], v[192:195]
ds_read_b64_tr_b16 v[92:93], v15 offset:8192
v_mfma_f32_16x16x32_bf16 v[196:199], v[68:71], v[44:47], v[196:199]
s_and_b32 s75, s91, 0xfffffc7f
v_lshrrev_b32 v2, 3, v0
v_lshlrev_b32 v2, 7, v2
v_mfma_f32_16x16x32_bf16 v[196:199], v[64:67], v[40:43], v[196:199]
s_add_u32 s72, s69, 15360
buffer_load_dwordx4 v5, s[4:7], s72 offen offset:1024 lds
v_mfma_f32_16x16x32_bf16 v[200:203], v[64:67], v[48:51], v[200:203]
buffer_load_dword v3, v2, s[44:47], s75 offen sc1
v_mfma_f32_16x16x32_bf16 v[200:203], v[68:71], v[52:55], v[200:203]
ds_read_b64_tr_b16 v[94:95], v15 offset:9216
v_mfma_f32_16x16x32_bf16 v[204:207], v[68:71], v[60:63], v[204:207]
ds_read_b128 v[108:111], v19 offset:2048
v_mfma_f32_16x16x32_bf16 v[204:207], v[64:67], v[56:59], v[204:207]
s_waitcnt lgkmcnt(11)
v_mfma_f32_16x16x32_bf16 v[220:223], v[72:75], v[56:59], v[220:223]
s_add_u32 s72, s69, 129024
buffer_load_dwordx4 v4, s[4:7], s72 offen offset:2048 lds
v_mfma_f32_16x16x32_bf16 v[220:223], v[76:79], v[60:63], v[220:223]
ds_read_b128 v[112:115], v18 offset:4096
v_mfma_f32_16x16x32_bf16 v[216:219], v[76:79], v[52:55], v[216:219]
s_waitcnt vmcnt(16) lgkmcnt(2)
ds_read_b128 v[116:119], v19 offset:4096
v_mfma_f32_16x16x32_bf16 v[216:219], v[72:75], v[48:51], v[216:219]
s_barrier
v_mfma_f32_16x16x32_bf16 v[212:215], v[72:75], v[40:43], v[212:215]
ds_read_b64_tr_b16 v[64:65], v8 offset:16384
ds_read_b64_tr_b16 v[66:67], v8 offset:17408
v_mfma_f32_16x16x32_bf16 v[212:215], v[76:79], v[44:47], v[212:215]
ds_read_b64_tr_b16 v[68:69], v8 offset:24576
v_mfma_f32_16x16x32_bf16 v[208:211], v[76:79], v[36:39], v[208:211]
s_add_u32 s72, s69, 144384
buffer_load_dwordx4 v5, s[4:7], s72 offen offset:3072 lds
v_mfma_f32_16x16x32_bf16 v[208:211], v[72:75], v[32:35], v[208:211]
ds_read_b64_tr_b16 v[70:71], v8 offset:25600
v_mfma_f32_16x16x32_bf16 v[224:227], v[80:83], v[32:35], v[224:227]
ds_read_b64_tr_b16 v[72:73], v9 offset:16384
v_mfma_f32_16x16x32_bf16 v[224:227], v[84:87], v[36:39], v[224:227]
ds_read_b64_tr_b16 v[74:75], v9 offset:17408
v_mfma_f32_16x16x32_bf16 v[228:231], v[84:87], v[44:47], v[228:231]
s_add_u32 m0, s63, 135168
ds_read_b128 v[120:123], v18 offset:6144
v_mfma_f32_16x16x32_bf16 v[228:231], v[80:83], v[40:43], v[228:231]
s_add_u32 s72, s70, 0
buffer_load_dwordx4 v4, s[4:7], s72 offen lds
v_mfma_f32_16x16x32_bf16 v[232:235], v[80:83], v[48:51], v[232:235]
ds_read_b64_tr_b16 v[76:77], v9 offset:24576
v_mfma_f32_16x16x32_bf16 v[232:235], v[84:87], v[52:55], v[232:235]
ds_read_b128 v[124:127], v19 offset:6144
v_mfma_f32_16x16x32_bf16 v[236:239], v[84:87], v[60:63], v[236:239]
ds_read_b64_tr_b16 v[78:79], v9 offset:25600
v_mfma_f32_16x16x32_bf16 v[236:239], v[80:83], v[56:59], v[236:239]
v_mfma_f32_16x16x32_bf16 v[252:255], v[88:91], v[56:59], v[252:255]
s_add_u32 s72, s70, 15360
buffer_load_dwordx4 v5, s[4:7], s72 offen offset:1024 lds
v_mfma_f32_16x16x32_bf16 v[252:255], v[92:95], v[60:63], v[252:255]
ds_read_b64_tr_b16 v[80:81], v10 offset:16384
v_mfma_f32_16x16x32_bf16 v[248:251], v[92:95], v[52:55], v[248:251]
ds_read_b64_tr_b16 v[82:83], v10 offset:17408
v_mfma_f32_16x16x32_bf16 v[248:251], v[88:91], v[48:51], v[248:251]
v_mfma_f32_16x16x32_bf16 v[244:247], v[88:91], v[40:43], v[244:247]
ds_read_b64_tr_b16 v[84:85], v10 offset:24576
v_mfma_f32_16x16x32_bf16 v[244:247], v[92:95], v[44:47], v[244:247]
ds_read_b64_tr_b16 v[86:87], v10 offset:25600
v_mfma_f32_16x16x32_bf16 v[240:243], v[92:95], v[36:39], v[240:243]
s_add_u32 s72, s70, 129024
buffer_load_dwordx4 v4, s[4:7], s72 offen offset:2048 lds
v_mfma_f32_16x16x32_bf16 v[240:243], v[88:91], v[32:35], v[240:243]
s_waitcnt lgkmcnt(5)
v_mfma_f32_16x16x32_bf16 v[128:131], v[64:67], v[96:99], v[128:131]
ds_read_b64_tr_b16 v[88:89], v11 offset:16384
v_mfma_f32_16x16x32_bf16 v[128:131], v[68:71], v[100:103], v[128:131]
ds_read_b64_tr_b16 v[90:91], v11 offset:17408
v_mfma_f32_16x16x32_bf16 v[132:135], v[68:71], v[108:111], v[132:135]
v_mfma_f32_16x16x32_bf16 v[132:135], v[64:67], v[104:107], v[132:135]
s_add_u32 s72, s70, 144384
buffer_load_dwordx4 v5, s[4:7], s72 offen offset:3072 lds
v_mfma_f32_16x16x32_bf16 v[136:139], v[64:67], v[112:115], v[136:139]
ds_read_b64_tr_b16 v[92:93], v11 offset:24576
v_mfma_f32_16x16x32_bf16 v[136:139], v[68:71], v[116:119], v[136:139]
s_lshl_b32 s71, s73, 12
v_mfma_f32_16x16x32_bf16 v[140:143], v[68:71], v[124:127], v[140:143]
s_add_u32 s71, s71, s66
ds_read_b64_tr_b16 v[94:95], v11 offset:25600
v_mfma_f32_16x16x32_bf16 v[140:143], v[64:67], v[120:123], v[140:143]
s_waitcnt lgkmcnt(8)
v_mfma_f32_16x16x32_bf16 v[156:159], v[72:75], v[120:123], v[156:159]
s_add_u32 m0, s64, 0
ds_read_b64_tr_b16 v[64:65], v12 offset:16384
v_mfma_f32_16x16x32_bf16 v[156:159], v[76:79], v[124:127], v[156:159]
s_add_u32 s72, s71, 0
buffer_load_dwordx4 v6, s[12:15], s72 offen lds
v_mfma_f32_16x16x32_bf16 v[152:155], v[76:79], v[116:119], v[152:155]
ds_read_b64_tr_b16 v[66:67], v12 offset:17408
v_mfma_f32_16x16x32_bf16 v[152:155], v[72:75], v[112:115], v[152:155]
v_mfma_f32_16x16x32_bf16 v[148:151], v[72:75], v[104:107], v[148:151]
ds_read_b64_tr_b16 v[68:69], v12 offset:24576
v_mfma_f32_16x16x32_bf16 v[148:151], v[76:79], v[108:111], v[148:151]
ds_read_b64_tr_b16 v[70:71], v12 offset:25600
v_mfma_f32_16x16x32_bf16 v[144:147], v[76:79], v[100:103], v[144:147]
s_add_u32 s72, s71, 31744
buffer_load_dwordx4 v6, s[12:15], s72 offen offset:1024 lds
v_mfma_f32_16x16x32_bf16 v[144:147], v[72:75], v[96:99], v[144:147]
s_waitcnt lgkmcnt(8)
v_mfma_f32_16x16x32_bf16 v[160:163], v[80:83], v[96:99], v[160:163]
ds_read_b64_tr_b16 v[72:73], v13 offset:16384
v_mfma_f32_16x16x32_bf16 v[160:163], v[84:87], v[100:103], v[160:163]
ds_read_b64_tr_b16 v[74:75], v13 offset:17408
v_mfma_f32_16x16x32_bf16 v[164:167], v[84:87], v[108:111], v[164:167]
v_mfma_f32_16x16x32_bf16 v[164:167], v[80:83], v[104:107], v[164:167]
s_add_u32 s72, s71, 63488
buffer_load_dwordx4 v7, s[12:15], s72 offen offset:2048 lds
v_mfma_f32_16x16x32_bf16 v[168:171], v[80:83], v[112:115], v[168:171]
s_waitcnt vmcnt(16)
ds_read_b64_tr_b16 v[76:77], v13 offset:24576
v_mfma_f32_16x16x32_bf16 v[168:171], v[84:87], v[116:119], v[168:171]
ds_read_b128 v[32:35], v18 offset:32768
v_mfma_f32_16x16x32_bf16 v[172:175], v[84:87], v[124:127], v[172:175]
ds_read_b64_tr_b16 v[78:79], v13 offset:25600
v_mfma_f32_16x16x32_bf16 v[172:175], v[80:83], v[120:123], v[172:175]
s_waitcnt lgkmcnt(9)
ds_read_b128 v[36:39], v19 offset:32768
v_mfma_f32_16x16x32_bf16 v[188:191], v[88:91], v[120:123], v[188:191]
s_add_u32 s72, s71, 95232
buffer_load_dwordx4 v7, s[12:15], s72 offen offset:3072 lds
v_mfma_f32_16x16x32_bf16 v[188:191], v[92:95], v[124:127], v[188:191]
v_accvgpr_write_b32 a0, -1
v_accvgpr_write_b32 a1, -1
v_mfma_f32_16x16x32_bf16 v[184:187], v[92:95], v[116:119], v[184:187]
v_accvgpr_write_b32 a2, -1
v_accvgpr_write_b32 a3, -1
v_mfma_f32_16x16x32_bf16 v[184:187], v[88:91], v[112:115], v[184:187]
s_add_u32 s80, s93, 0x3a00000
ds_read_b64_tr_b16 v[80:81], v14 offset:16384
v_mfma_f32_16x16x32_bf16 v[180:183], v[88:91], v[104:107], v[180:183]
ds_read_b64_tr_b16 v[82:83], v14 offset:17408
v_mfma_f32_16x16x32_bf16 v[180:183], v[92:95], v[108:111], v[180:183]
ds_read_b64_tr_b16 v[84:85], v14 offset:24576
v_mfma_f32_16x16x32_bf16 v[176:179], v[92:95], v[100:103], v[176:179]
ds_read_b64_tr_b16 v[86:87], v14 offset:25600
v_mfma_f32_16x16x32_bf16 v[176:179], v[88:91], v[96:99], v[176:179]
s_waitcnt lgkmcnt(10)
ds_read_b128 v[40:43], v18 offset:34816
v_mfma_f32_16x16x32_bf16 v[192:195], v[64:67], v[96:99], v[192:195]
s_waitcnt vmcnt(10)
v_cmp_gt_u32 vcc, 1, v3
s_cbranch_vccnz Lspin4
Lback5:
v_mfma_f32_16x16x32_bf16 v[192:195], v[68:71], v[100:103], v[192:195]
s_add_u32 m0, s64, 49152
ds_read_b64_tr_b16 v[88:89], v15 offset:16384
ds_read_b64_tr_b16 v[90:91], v15 offset:17408
v_mfma_f32_16x16x32_bf16 v[196:199], v[68:71], v[108:111], v[196:199]
s_add_u32 s72, s81, 16384
buffer_load_dwordx4 v1, s[44:47], s72 offen sc1 lds
v_mfma_f32_16x16x32_bf16 v[196:199], v[64:67], v[104:107], v[196:199]
ds_read_b64_tr_b16 v[92:93], v15 offset:24576
v_mfma_f32_16x16x32_bf16 v[200:203], v[64:67], v[112:115], v[200:203]
ds_read_b64_tr_b16 v[94:95], v15 offset:25600
v_mfma_f32_16x16x32_bf16 v[200:203], v[68:71], v[116:119], v[200:203]
buffer_load_dwordx4 v1, s[44:47], s72 offen offset:1024 sc1 lds
v_mfma_f32_16x16x32_bf16 v[204:207], v[68:71], v[124:127], v[204:207]
ds_read_b128 v[44:47], v19 offset:34816
v_mfma_f32_16x16x32_bf16 v[204:207], v[64:67], v[120:123], v[204:207]
s_waitcnt lgkmcnt(11)
v_mfma_f32_16x16x32_bf16 v[220:223], v[72:75], v[120:123], v[220:223]
ds_read_b128 v[48:51], v18 offset:36864
v_mfma_f32_16x16x32_bf16 v[220:223], v[76:79], v[124:127], v[220:223]
ds_read_b128 v[52:55], v19 offset:36864
v_mfma_f32_16x16x32_bf16 v[216:219], v[76:79], v[116:119], v[216:219]
s_waitcnt vmcnt(15) lgkmcnt(3)
buffer_load_dwordx4 v1, s[44:47], s72 offen offset:2048 sc1 lds
v_mfma_f32_16x16x32_bf16 v[216:219], v[72:75], v[112:115], v[216:219]
s_barrier
ds_read_b128 v[56:59], v18 offset:38912
v_mfma_f32_16x16x32_bf16 v[212:215], v[72:75], v[104:107], v[212:215]
ds_read_b64_tr_b16 v[64:65], v8 offset:32768
ds_read_b64_tr_b16 v[66:67], v8 offset:33792
v_mfma_f32_16x16x32_bf16 v[212:215], v[76:79], v[108:111], v[212:215]
ds_read_b64_tr_b16 v[68:69], v8 offset:40960
v_mfma_f32_16x16x32_bf16 v[208:211], v[76:79], v[100:103], v[208:211]
ds_read_b64_tr_b16 v[70:71], v8 offset:41984
v_mfma_f32_16x16x32_bf16 v[208:211], v[72:75], v[96:99], v[208:211]
buffer_load_dwordx4 v1, s[44:47], s72 offen offset:3072 sc1 lds
v_mfma_f32_16x16x32_bf16 v[224:227], v[80:83], v[96:99], v[224:227]
s_add_u32 s81, s81, 0x8000
ds_read_b64_tr_b16 v[72:73], v9 offset:32768
v_mfma_f32_16x16x32_bf16 v[224:227], v[84:87], v[100:103], v[224:227]
s_add_u32 m0, s64, 81920
ds_read_b64_tr_b16 v[74:75], v9 offset:33792
v_mfma_f32_16x16x32_bf16 v[228:231], v[84:87], v[108:111], v[228:231]
s_add_u32 s72, s81, 16384
buffer_load_dwordx4 v1, s[44:47], s72 offen sc1 lds
v_mfma_f32_16x16x32_bf16 v[228:231], v[80:83], v[104:107], v[228:231]
ds_read_b128 v[60:63], v19 offset:38912
v_mfma_f32_16x16x32_bf16 v[232:235], v[80:83], v[112:115], v[232:235]
buffer_load_dwordx4 v1, s[44:47], s72 offen offset:1024 sc1 lds
v_mfma_f32_16x16x32_bf16 v[232:235], v[84:87], v[116:119], v[232:235]
ds_read_b64_tr_b16 v[76:77], v9 offset:40960
v_mfma_f32_16x16x32_bf16 v[236:239], v[84:87], v[124:127], v[236:239]
ds_read_b64_tr_b16 v[78:79], v9 offset:41984
v_mfma_f32_16x16x32_bf16 v[236:239], v[80:83], v[120:123], v[236:239]
v_mfma_f32_16x16x32_bf16 v[252:255], v[88:91], v[120:123], v[252:255]
ds_read_b64_tr_b16 v[80:81], v10 offset:32768
v_mfma_f32_16x16x32_bf16 v[252:255], v[92:95], v[124:127], v[252:255]
buffer_load_dwordx4 v1, s[44:47], s72 offen offset:2048 sc1 lds
v_mfma_f32_16x16x32_bf16 v[248:251], v[92:95], v[116:119], v[248:251]
ds_read_b64_tr_b16 v[82:83], v10 offset:33792
v_mfma_f32_16x16x32_bf16 v[248:251], v[88:91], v[112:115], v[248:251]
v_mfma_f32_16x16x32_bf16 v[244:247], v[88:91], v[104:107], v[244:247]
ds_read_b64_tr_b16 v[84:85], v10 offset:40960
v_mfma_f32_16x16x32_bf16 v[244:247], v[92:95], v[108:111], v[244:247]
buffer_load_dwordx4 v1, s[44:47], s72 offen offset:3072 sc1 lds
v_mfma_f32_16x16x32_bf16 v[240:243], v[92:95], v[100:103], v[240:243]
ds_read_b64_tr_b16 v[86:87], v10 offset:41984
v_mfma_f32_16x16x32_bf16 v[240:243], v[88:91], v[96:99], v[240:243]
s_waitcnt lgkmcnt(6)
v_mfma_f32_16x16x32_bf16 v[128:131], v[64:67], v[32:35], v[128:131]
ds_read_b64_tr_b16 v[88:89], v11 offset:32768
v_mfma_f32_16x16x32_bf16 v[128:131], v[68:71], v[36:39], v[128:131]
ds_read_b64_tr_b16 v[90:91], v11 offset:33792
v_mfma_f32_16x16x32_bf16 v[132:135], v[68:71], v[44:47], v[132:135]
s_add_u32 m0, s64, 65536
v_mfma_f32_16x16x32_bf16 v[132:135], v[64:67], v[40:43], v[132:135]
s_add_u32 s72, s81, 0
buffer_load_dwordx4 v1, s[44:47], s72 offen sc1 lds
v_mfma_f32_16x16x32_bf16 v[136:139], v[64:67], v[48:51], v[136:139]
ds_read_b64_tr_b16 v[92:93], v11 offset:40960
v_mfma_f32_16x16x32_bf16 v[136:139], v[68:71], v[52:55], v[136:139]
ds_read_b64_tr_b16 v[94:95], v11 offset:41984
v_mfma_f32_16x16x32_bf16 v[140:143], v[68:71], v[60:63], v[140:143]
v_mfma_f32_16x16x32_bf16 v[140:143], v[64:67], v[56:59], v[140:143]
s_waitcnt lgkmcnt(8)
buffer_load_dwordx4 v1, s[44:47], s72 offen offset:1024 sc1 lds
v_mfma_f32_16x16x32_bf16 v[156:159], v[72:75], v[56:59], v[156:159]
ds_read_b64_tr_b16 v[64:65], v12 offset:32768
v_mfma_f32_16x16x32_bf16 v[156:159], v[76:79], v[60:63], v[156:159]
ds_read_b64_tr_b16 v[66:67], v12 offset:33792
v_mfma_f32_16x16x32_bf16 v[152:155], v[76:79], v[52:55], v[152:155]
v_mfma_f32_16x16x32_bf16 v[152:155], v[72:75], v[48:51], v[152:155]
buffer_load_dwordx4 v1, s[44:47], s72 offen offset:2048 sc1 lds
v_mfma_f32_16x16x32_bf16 v[148:151], v[72:75], v[40:43], v[148:151]
ds_read_b64_tr_b16 v[68:69], v12 offset:40960
v_mfma_f32_16x16x32_bf16 v[148:151], v[76:79], v[44:47], v[148:151]
v_mfma_f32_16x16x32_bf16 v[144:147], v[76:79], v[36:39], v[144:147]
ds_read_b64_tr_b16 v[70:71], v12 offset:41984
v_mfma_f32_16x16x32_bf16 v[144:147], v[72:75], v[32:35], v[144:147]
s_waitcnt lgkmcnt(8)
v_mfma_f32_16x16x32_bf16 v[160:163], v[80:83], v[32:35], v[160:163]
buffer_load_dwordx4 v1, s[44:47], s72 offen offset:3072 sc1 lds
v_mfma_f32_16x16x32_bf16 v[160:163], v[84:87], v[36:39], v[160:163]
ds_read_b64_tr_b16 v[72:73], v13 offset:32768
v_mfma_f32_16x16x32_bf16 v[164:167], v[84:87], v[44:47], v[164:167]
ds_read_b64_tr_b16 v[74:75], v13 offset:33792
v_mfma_f32_16x16x32_bf16 v[164:167], v[80:83], v[40:43], v[164:167]
v_mfma_f32_16x16x32_bf16 v[168:171], v[80:83], v[48:51], v[168:171]
s_waitcnt vmcnt(16)
ds_read_b64_tr_b16 v[76:77], v13 offset:40960
v_mfma_f32_16x16x32_bf16 v[168:171], v[84:87], v[52:55], v[168:171]
ds_read_b128 v[96:99], v16 offset:0
v_mfma_f32_16x16x32_bf16 v[172:175], v[84:87], v[60:63], v[172:175]
ds_read_b64_tr_b16 v[78:79], v13 offset:41984
v_mfma_f32_16x16x32_bf16 v[172:175], v[80:83], v[56:59], v[172:175]
s_waitcnt lgkmcnt(9)
v_mfma_f32_16x16x32_bf16 v[188:191], v[88:91], v[56:59], v[188:191]
ds_read_b64_tr_b16 v[80:81], v14 offset:32768
v_mfma_f32_16x16x32_bf16 v[188:191], v[92:95], v[60:63], v[188:191]
ds_read_b128 v[100:103], v17 offset:0
v_mfma_f32_16x16x32_bf16 v[184:187], v[92:95], v[52:55], v[184:187]
ds_read_b64_tr_b16 v[82:83], v14 offset:33792
v_mfma_f32_16x16x32_bf16 v[184:187], v[88:91], v[48:51], v[184:187]
v_mfma_f32_16x16x32_bf16 v[180:183], v[88:91], v[40:43], v[180:183]
ds_read_b64_tr_b16 v[84:85], v14 offset:40960
v_mfma_f32_16x16x32_bf16 v[180:183], v[92:95], v[44:47], v[180:183]
ds_read_b128 v[104:107], v16 offset:2048
v_mfma_f32_16x16x32_bf16 v[176:179], v[92:95], v[36:39], v[176:179]
ds_read_b64_tr_b16 v[86:87], v14 offset:41984
v_mfma_f32_16x16x32_bf16 v[176:179], v[88:91], v[32:35], v[176:179]
s_waitcnt lgkmcnt(11)
v_mfma_f32_16x16x32_bf16 v[192:195], v[64:67], v[32:35], v[192:195]
ds_read_b64_tr_b16 v[88:89], v15 offset:32768
v_mfma_f32_16x16x32_bf16 v[192:195], v[68:71], v[36:39], v[192:195]
ds_read_b64_tr_b16 v[90:91], v15 offset:33792
v_mfma_f32_16x16x32_bf16 v[196:199], v[68:71], v[44:47], v[196:199]
ds_read_b128 v[108:111], v17 offset:2048
v_mfma_f32_16x16x32_bf16 v[196:199], v[64:67], v[40:43], v[196:199]
ds_read_b64_tr_b16 v[92:93], v15 offset:40960
v_mfma_f32_16x16x32_bf16 v[200:203], v[64:67], v[48:51], v[200:203]
ds_read_b64_tr_b16 v[94:95], v15 offset:41984
v_mfma_f32_16x16x32_bf16 v[200:203], v[68:71], v[52:55], v[200:203]
v_mfma_f32_16x16x32_bf16 v[204:207], v[68:71], v[60:63], v[204:207]
ds_read_b128 v[112:115], v16 offset:4096
v_mfma_f32_16x16x32_bf16 v[204:207], v[64:67], v[56:59], v[204:207]
s_waitcnt lgkmcnt(12)
v_mfma_f32_16x16x32_bf16 v[220:223], v[72:75], v[56:59], v[220:223]
ds_read_b128 v[116:119], v17 offset:4096
v_mfma_f32_16x16x32_bf16 v[220:223], v[76:79], v[60:63], v[220:223]
v_mfma_f32_16x16x32_bf16 v[216:219], v[76:79], v[52:55], v[216:219]
s_waitcnt vmcnt(12) lgkmcnt(2)
ds_read_b128 v[120:123], v16 offset:6144
v_mfma_f32_16x16x32_bf16 v[216:219], v[72:75], v[48:51], v[216:219]
s_barrier
v_mfma_f32_16x16x32_bf16 v[212:215], v[72:75], v[40:43], v[212:215]
s_add_u32 s81, s81, 0x8000
ds_read_b64_tr_b16 v[64:65], v8 offset:0
ds_read_b64_tr_b16 v[66:67], v8 offset:1024
v_mfma_f32_16x16x32_bf16 v[212:215], v[76:79], v[44:47], v[212:215]
s_add_u32 m0, s64, 114688
ds_read_b64_tr_b16 v[68:69], v8 offset:8192
v_mfma_f32_16x16x32_bf16 v[208:211], v[76:79], v[36:39], v[208:211]
s_add_u32 s72, s81, 16384
buffer_load_dwordx4 v1, s[44:47], s72 offen sc1 lds
v_mfma_f32_16x16x32_bf16 v[208:211], v[72:75], v[32:35], v[208:211]
ds_read_b64_tr_b16 v[70:71], v8 offset:9216
v_mfma_f32_16x16x32_bf16 v[224:227], v[80:83], v[32:35], v[224:227]
buffer_load_dwordx4 v1, s[44:47], s72 offen offset:1024 sc1 lds
v_mfma_f32_16x16x32_bf16 v[224:227], v[84:87], v[36:39], v[224:227]
ds_read_b64_tr_b16 v[72:73], v9 offset:0
v_mfma_f32_16x16x32_bf16 v[228:231], v[84:87], v[44:47], v[228:231]
ds_read_b64_tr_b16 v[74:75], v9 offset:1024
v_mfma_f32_16x16x32_bf16 v[228:231], v[80:83], v[40:43], v[228:231]
ds_read_b128 v[124:127], v17 offset:6144
v_mfma_f32_16x16x32_bf16 v[232:235], v[80:83], v[48:51], v[232:235]
ds_read_b64_tr_b16 v[76:77], v9 offset:8192
v_mfma_f32_16x16x32_bf16 v[232:235], v[84:87], v[52:55], v[232:235]
buffer_store_dwordx4 a[0:3], v1, s[44:47], s80 offen sc1
v_mfma_f32_16x16x32_bf16 v[236:239], v[84:87], v[60:63], v[236:239]
ds_read_b64_tr_b16 v[78:79], v9 offset:9216
v_mfma_f32_16x16x32_bf16 v[236:239], v[80:83], v[56:59], v[236:239]
v_mfma_f32_16x16x32_bf16 v[252:255], v[88:91], v[56:59], v[252:255]
ds_read_b64_tr_b16 v[80:81], v10 offset:0
v_mfma_f32_16x16x32_bf16 v[252:255], v[92:95], v[60:63], v[252:255]
ds_read_b64_tr_b16 v[82:83], v10 offset:1024
v_mfma_f32_16x16x32_bf16 v[248:251], v[92:95], v[52:55], v[248:251]
buffer_load_dwordx4 v1, s[44:47], s72 offen offset:2048 sc1 lds
v_mfma_f32_16x16x32_bf16 v[248:251], v[88:91], v[48:51], v[248:251]
v_mfma_f32_16x16x32_bf16 v[244:247], v[88:91], v[40:43], v[244:247]
ds_read_b64_tr_b16 v[84:85], v10 offset:8192
v_mfma_f32_16x16x32_bf16 v[244:247], v[92:95], v[44:47], v[244:247]
ds_read_b64_tr_b16 v[86:87], v10 offset:9216
v_mfma_f32_16x16x32_bf16 v[240:243], v[92:95], v[36:39], v[240:243]
buffer_load_dwordx4 v1, s[44:47], s72 offen offset:3072 sc1 lds
v_mfma_f32_16x16x32_bf16 v[240:243], v[88:91], v[32:35], v[240:243]
s_waitcnt lgkmcnt(6)
v_mfma_f32_16x16x32_bf16 v[128:131], v[64:67], v[96:99], v[128:131]
ds_read_b64_tr_b16 v[88:89], v11 offset:0
v_mfma_f32_16x16x32_bf16 v[128:131], v[68:71], v[100:103], v[128:131]
ds_read_b64_tr_b16 v[90:91], v11 offset:1024
v_mfma_f32_16x16x32_bf16 v[132:135], v[68:71], v[108:111], v[132:135]
v_mfma_f32_16x16x32_bf16 v[132:135], v[64:67], v[104:107], v[132:135]
buffer_store_dwordx4 a[0:3], v1, s[44:47], s80 offen offset:1024 sc1
v_mfma_f32_16x16x32_bf16 v[136:139], v[64:67], v[112:115], v[136:139]
ds_read_b64_tr_b16 v[92:93], v11 offset:8192
v_mfma_f32_16x16x32_bf16 v[136:139], v[68:71], v[116:119], v[136:139]
v_mfma_f32_16x16x32_bf16 v[140:143], v[68:71], v[124:127], v[140:143]
ds_read_b64_tr_b16 v[94:95], v11 offset:9216
v_mfma_f32_16x16x32_bf16 v[140:143], v[64:67], v[120:123], v[140:143]
s_waitcnt lgkmcnt(8)
v_mfma_f32_16x16x32_bf16 v[156:159], v[72:75], v[120:123], v[156:159]
s_add_u32 m0, s64, 98304
ds_read_b64_tr_b16 v[64:65], v12 offset:0
v_mfma_f32_16x16x32_bf16 v[156:159], v[76:79], v[124:127], v[156:159]
s_add_u32 s72, s81, 0
buffer_load_dwordx4 v1, s[44:47], s72 offen sc1 lds
v_mfma_f32_16x16x32_bf16 v[152:155], v[76:79], v[116:119], v[152:155]
ds_read_b64_tr_b16 v[66:67], v12 offset:1024
v_mfma_f32_16x16x32_bf16 v[152:155], v[72:75], v[112:115], v[152:155]
v_mfma_f32_16x16x32_bf16 v[148:151], v[72:75], v[104:107], v[148:151]
buffer_load_dwordx4 v1, s[44:47], s72 offen offset:1024 sc1 lds
v_mfma_f32_16x16x32_bf16 v[148:151], v[76:79], v[108:111], v[148:151]
ds_read_b64_tr_b16 v[68:69], v12 offset:8192
v_mfma_f32_16x16x32_bf16 v[144:147], v[76:79], v[100:103], v[144:147]
ds_read_b64_tr_b16 v[70:71], v12 offset:9216
v_mfma_f32_16x16x32_bf16 v[144:147], v[72:75], v[96:99], v[144:147]
s_waitcnt lgkmcnt(8)
v_mfma_f32_16x16x32_bf16 v[160:163], v[80:83], v[96:99], v[160:163]
ds_read_b64_tr_b16 v[72:73], v13 offset:0
v_mfma_f32_16x16x32_bf16 v[160:163], v[84:87], v[100:103], v[160:163]
buffer_store_dwordx4 a[0:3], v1, s[44:47], s80 offen offset:2048 sc1
v_mfma_f32_16x16x32_bf16 v[164:167], v[84:87], v[108:111], v[164:167]
ds_read_b64_tr_b16 v[74:75], v13 offset:1024
v_mfma_f32_16x16x32_bf16 v[164:167], v[80:83], v[104:107], v[164:167]
v_mfma_f32_16x16x32_bf16 v[168:171], v[80:83], v[112:115], v[168:171]
ds_read_b64_tr_b16 v[76:77], v13 offset:8192
v_cvt_pk_bf16_f32 v48, v136, v137
v_mfma_f32_16x16x32_bf16 v[168:171], v[84:87], v[116:119], v[168:171]
ds_read_b64_tr_b16 v[78:79], v13 offset:9216
v_cvt_pk_bf16_f32 v49, v138, v139
v_mfma_f32_16x16x32_bf16 v[172:175], v[84:87], v[124:127], v[172:175]
buffer_load_dwordx4 v1, s[44:47], s72 offen offset:2048 sc1 lds
v_mfma_f32_16x16x32_bf16 v[172:175], v[80:83], v[120:123], v[172:175]
s_waitcnt lgkmcnt(8)
v_cvt_pk_bf16_f32 v50, v152, v153
v_cvt_pk_bf16_f32 v51, v154, v155
v_mfma_f32_16x16x32_bf16 v[188:191], v[88:91], v[120:123], v[188:191]
v_add_u32 v2, 0x8000, v1
v_cvt_pk_bf16_f32 v32, v132, v133
v_mfma_f32_16x16x32_bf16 v[188:191], v[92:95], v[124:127], v[188:191]
ds_read_b64_tr_b16 v[80:81], v14 offset:0
v_cvt_pk_bf16_f32 v33, v134, v135
v_mfma_f32_16x16x32_bf16 v[184:187], v[92:95], v[116:119], v[184:187]
buffer_load_dwordx4 v1, s[44:47], s72 offen offset:3072 sc1 lds
v_mfma_f32_16x16x32_bf16 v[184:187], v[88:91], v[112:115], v[184:187]
ds_read_b64_tr_b16 v[82:83], v14 offset:1024
v_cvt_pk_bf16_f32 v34, v148, v149
v_mfma_f32_16x16x32_bf16 v[180:183], v[88:91], v[104:107], v[180:183]
ds_read_b64_tr_b16 v[84:85], v14 offset:8192
v_cvt_pk_bf16_f32 v35, v150, v151
v_mfma_f32_16x16x32_bf16 v[180:183], v[92:95], v[108:111], v[180:183]
ds_read_b64_tr_b16 v[86:87], v14 offset:9216
v_cvt_pk_bf16_f32 v16, v128, v129
v_mfma_f32_16x16x32_bf16 v[176:179], v[92:95], v[100:103], v[176:179]
v_cvt_pk_bf16_f32 v17, v130, v131
v_cvt_pk_bf16_f32 v18, v144, v145
v_mfma_f32_16x16x32_bf16 v[176:179], v[88:91], v[96:99], v[176:179]
s_waitcnt lgkmcnt(8)
buffer_store_dwordx4 a[0:3], v1, s[44:47], s80 offen offset:3072 sc1
v_mfma_f32_16x16x32_bf16 v[192:195], v[64:67], v[96:99], v[192:195]
ds_read_b64_tr_b16 v[88:89], v15 offset:0
v_cvt_pk_bf16_f32 v19, v146, v147
v_mfma_f32_16x16x32_bf16 v[192:195], v[68:71], v[100:103], v[192:195]
ds_read_b64_tr_b16 v[90:91], v15 offset:1024
v_mfma_f32_16x16x32_bf16 v[196:199], v[68:71], v[108:111], v[196:199]
ds_read_b64_tr_b16 v[92:93], v15 offset:8192
v_mfma_f32_16x16x32_bf16 v[196:199], v[64:67], v[104:107], v[196:199]
ds_read_b64_tr_b16 v[94:95], v15 offset:9216
v_mfma_f32_16x16x32_bf16 v[200:203], v[64:67], v[112:115], v[200:203]
v_lshrrev_b32 v3, 1, v0
v_lshlrev_b32 v3, 7, v3
v_mfma_f32_16x16x32_bf16 v[200:203], v[68:71], v[116:119], v[200:203]
buffer_load_dword v4, v3, s[36:39], s93 offen
v_mfma_f32_16x16x32_bf16 v[204:207], v[68:71], v[124:127], v[204:207]
v_cvt_pk_bf16_f32 v52, v168, v169
v_cvt_pk_bf16_f32 v53, v170, v171
v_mfma_f32_16x16x32_bf16 v[204:207], v[64:67], v[120:123], v[204:207]
s_waitcnt lgkmcnt(8)
v_cvt_pk_bf16_f32 v54, v184, v185
v_cvt_pk_bf16_f32 v55, v186, v187
v_mfma_f32_16x16x32_bf16 v[220:223], v[72:75], v[120:123], v[220:223]
v_cvt_pk_bf16_f32 v36, v164, v165
v_cvt_pk_bf16_f32 v37, v166, v167
v_mfma_f32_16x16x32_bf16 v[220:223], v[76:79], v[124:127], v[220:223]
v_cvt_pk_bf16_f32 v38, v180, v181
v_cvt_pk_bf16_f32 v39, v182, v183
v_mfma_f32_16x16x32_bf16 v[216:219], v[76:79], v[116:119], v[216:219]
s_waitcnt vmcnt(21) lgkmcnt(0)
v_cvt_pk_bf16_f32 v20, v160, v161
v_cvt_pk_bf16_f32 v21, v162, v163
v_mfma_f32_16x16x32_bf16 v[216:219], v[72:75], v[112:115], v[216:219]
s_barrier
v_cvt_pk_bf16_f32 v22, v176, v177
v_cvt_pk_bf16_f32 v23, v178, v179
v_mfma_f32_16x16x32_bf16 v[212:215], v[72:75], v[104:107], v[212:215]
ds_read_b128 a[128:131], v2 offset:16384
v_cvt_pk_bf16_f32 v64, v140, v141
v_mfma_f32_16x16x32_bf16 v[212:215], v[76:79], v[108:111], v[212:215]
v_cvt_pk_bf16_f32 v65, v142, v143
v_cvt_pk_bf16_f32 v66, v156, v157
v_mfma_f32_16x16x32_bf16 v[208:211], v[76:79], v[100:103], v[208:211]
ds_read_b128 a[132:135], v2 offset:17408
v_cvt_pk_bf16_f32 v67, v158, v159
v_mfma_f32_16x16x32_bf16 v[208:211], v[72:75], v[96:99], v[208:211]
v_cvt_pk_bf16_f32 v68, v172, v173
v_cvt_pk_bf16_f32 v69, v174, v175
v_mfma_f32_16x16x32_bf16 v[224:227], v[80:83], v[96:99], v[224:227]
ds_read_b128 a[136:139], v2 offset:18432
v_cvt_pk_bf16_f32 v70, v188, v189
v_mfma_f32_16x16x32_bf16 v[224:227], v[84:87], v[100:103], v[224:227]
v_cvt_pk_bf16_f32 v71, v190, v191
v_mfma_f32_16x16x32_bf16 v[228:231], v[84:87], v[108:111], v[228:231]
ds_read_b128 a[140:143], v2 offset:19456
v_mfma_f32_16x16x32_bf16 v[228:231], v[80:83], v[104:107], v[228:231]
v_mfma_f32_16x16x32_bf16 v[232:235], v[80:83], v[112:115], v[232:235]
ds_read_b128 a[144:147], v2 offset:20480
v_cvt_pk_bf16_f32 v72, v204, v205
v_mfma_f32_16x16x32_bf16 v[232:235], v[84:87], v[116:119], v[232:235]
v_cvt_pk_bf16_f32 v73, v206, v207
v_cvt_pk_bf16_f32 v74, v220, v221
v_mfma_f32_16x16x32_bf16 v[236:239], v[84:87], v[124:127], v[236:239]
ds_read_b128 a[148:151], v2 offset:21504
v_cvt_pk_bf16_f32 v75, v222, v223
v_mfma_f32_16x16x32_bf16 v[236:239], v[80:83], v[120:123], v[236:239]
v_cvt_pk_bf16_f32 v56, v200, v201
v_cvt_pk_bf16_f32 v57, v202, v203
v_mfma_f32_16x16x32_bf16 v[252:255], v[88:91], v[120:123], v[252:255]
ds_read_b128 a[152:155], v2 offset:22528
v_cvt_pk_bf16_f32 v58, v216, v217
v_mfma_f32_16x16x32_bf16 v[252:255], v[92:95], v[124:127], v[252:255]
v_cvt_pk_bf16_f32 v59, v218, v219
v_cvt_pk_bf16_f32 v40, v196, v197
v_mfma_f32_16x16x32_bf16 v[248:251], v[92:95], v[116:119], v[248:251]
ds_read_b128 a[156:159], v2 offset:23552
v_cvt_pk_bf16_f32 v41, v198, v199
v_mfma_f32_16x16x32_bf16 v[248:251], v[88:91], v[112:115], v[248:251]
v_cvt_pk_bf16_f32 v42, v212, v213
v_cvt_pk_bf16_f32 v43, v214, v215
v_mfma_f32_16x16x32_bf16 v[244:247], v[88:91], v[104:107], v[244:247]
v_cvt_pk_bf16_f32 v24, v192, v193
v_cvt_pk_bf16_f32 v25, v194, v195
v_mfma_f32_16x16x32_bf16 v[244:247], v[92:95], v[108:111], v[244:247]
v_cvt_pk_bf16_f32 v26, v208, v209
v_cvt_pk_bf16_f32 v27, v210, v211
v_mfma_f32_16x16x32_bf16 v[240:243], v[92:95], v[100:103], v[240:243]
v_mfma_f32_16x16x32_bf16 v[240:243], v[88:91], v[96:99], v[240:243]
v_cvt_pk_bf16_f32 v76, v236, v237
v_cvt_pk_bf16_f32 v77, v238, v239
v_cvt_pk_bf16_f32 v78, v252, v253
v_cvt_pk_bf16_f32 v79, v254, v255
v_cvt_pk_bf16_f32 v60, v232, v233
v_cvt_pk_bf16_f32 v61, v234, v235
v_cvt_pk_bf16_f32 v62, v248, v249
v_cvt_pk_bf16_f32 v63, v250, v251
v_cvt_pk_bf16_f32 v44, v228, v229
v_cvt_pk_bf16_f32 v45, v230, v231
v_cvt_pk_bf16_f32 v46, v244, v245
v_cvt_pk_bf16_f32 v47, v246, v247
v_cvt_pk_bf16_f32 v28, v224, v225
v_cvt_pk_bf16_f32 v29, v226, v227
v_cvt_pk_bf16_f32 v30, v240, v241
v_cvt_pk_bf16_f32 v31, v242, v243
v_mov_b32 v124, 0xff800000
v_mov_b32 v125, 0xff800000
v_mov_b32 v126, 0xff800000
v_mov_b32 v127, 0xff800000
s_lshl_b32 s84, s60, 2
s_add_u32 s84, s84, s58
s_mov_b32 s86, 0
s_lshr_b32 s52, s66, 8
s_and_b32 s52, s52, 31
s_add_u32 s61, s65, s60
s_and_b32 s73, s60, 1
s_lshl_b32 s73, s73, 16
s_add_u32 s77, s73, s64
s_xor_b32 s73, s73, 0x10000
s_mov_b32 s92, s73
s_mul_i32 s62, s58, 4608
s_add_u32 s62, s62, 143104
s_add_u32 s73, s73, 49920
s_cmp_eq_u32 s58, 0
s_cselect_b32 s62, s73, s62
Lattn:
s_mov_b32 s82, 0x10000
s_waitcnt lgkmcnt(0)
v_mfma_f32_16x16x32_bf16 v[136:139], a[128:131], v[48:51], 0
ds_read_b128 a[160:163], v2 offset:24576
v_lshrrev_b32 v240, 4, v0
v_mfma_f32_16x16x32_bf16 v[136:139], a[132:135], v[52:55], v[136:139]
ds_read_b128 a[164:167], v2 offset:25600
v_and_b32 v241, 15, v0
v_mfma_f32_16x16x32_bf16 v[136:139], a[136:139], v[56:59], v[136:139]
ds_read_b128 a[168:171], v2 offset:26624
v_lshlrev_b32 v240, 2, v240
v_mfma_f32_16x16x32_bf16 v[136:139], a[140:143], v[60:63], v[136:139]
ds_read_b128 a[172:175], v2 offset:27648
v_sub_u32 v240, v241, v240
v_mfma_f32_16x16x32_bf16 v[140:143], a[140:143], v[76:79], 0
ds_read_b128 a[176:179], v2 offset:28672
v_mov_b32 v112, 0xff800000
v_mfma_f32_16x16x32_bf16 v[140:143], a[136:139], v[72:75], v[140:143]
ds_read_b128 a[180:183], v2 offset:29696
v_mov_b32 v113, 0xff800000
v_mfma_f32_16x16x32_bf16 v[140:143], a[132:135], v[68:71], v[140:143]
ds_read_b128 a[184:187], v2 offset:30720
v_mov_b32 v114, 0xff800000
v_mfma_f32_16x16x32_bf16 v[140:143], a[128:131], v[64:67], v[140:143]
ds_read_b128 a[188:191], v2 offset:31744
v_mov_b32 v115, 0xff800000
v_mfma_f32_16x16x32_bf16 v[156:159], a[144:147], v[64:67], 0
v_cmp_gt_i32 vcc, 0, v240
v_mov_b32 v120, 0x3f803f80
v_mfma_f32_16x16x32_bf16 v[156:159], a[148:151], v[68:71], v[156:159]
v_cndmask_b32 v116, 0, v112, vcc
v_cmp_gt_i32 vcc, 1, v240
v_mfma_f32_16x16x32_bf16 v[156:159], a[152:155], v[72:75], v[156:159]
v_mov_b32 v121, 0x3f803f80
v_cndmask_b32 v117, 0, v112, vcc
v_mfma_f32_16x16x32_bf16 v[156:159], a[156:159], v[76:79], v[156:159]
v_cmp_gt_i32 vcc, 2, v240
v_mov_b32 v122, 0x3f803f80
v_mfma_f32_16x16x32_bf16 v[152:155], a[156:159], v[60:63], 0
v_cndmask_b32 v118, 0, v112, vcc
v_cmp_gt_i32 vcc, 3, v240
v_mfma_f32_16x16x32_bf16 v[152:155], a[152:155], v[56:59], v[152:155]
v_mov_b32 v123, 0x3f803f80
v_cndmask_b32 v119, 0, v112, vcc
v_mfma_f32_16x16x32_bf16 v[152:155], a[148:151], v[52:55], v[152:155]
v_mov_b32 v228, 0
v_mov_b32 v229, 0
v_mfma_f32_16x16x32_bf16 v[152:155], a[144:147], v[48:51], v[152:155]
v_mov_b32 v230, 0
v_mov_b32 v231, 0
s_cmp_eq_u32 s84, 0
s_cbranch_scc1 Lta7
s_cmp_eq_u32 s84, 1
s_cbranch_scc1 Lnt8
v_mfma_f32_16x16x32_bf16 v[128:131], a[128:131], v[16:19], 0
Lstub0:
s_cbranch_execz Lstub4
v_mov_b32 v236, 0
v_mov_b32 v237, 0
v_mfma_f32_16x16x32_bf16 v[144:147], a[144:147], v[16:19], 0
v_mov_b32 v238, 0
v_mov_b32 v239, 0
s_branch Ljoin9
Lta7:
v_mfma_f32_16x16x32_bf16 v[128:131], a[128:131], v[16:19], v[116:119]
v_mov_b32 v236, 0
v_mov_b32 v237, 0
v_mfma_f32_16x16x32_bf16 v[144:147], a[144:147], v[16:19], v[112:115]
v_mov_b32 v238, 0
v_mov_b32 v239, 0
s_branch Ljoin9
Lnt8:
v_mfma_f32_16x16x32_bf16 v[128:131], a[128:131], v[16:19], 0
v_mov_b32 v236, 0
v_mov_b32 v237, 0
v_mfma_f32_16x16x32_bf16 v[144:147], a[144:147], v[16:19], v[116:119]
v_mov_b32 v238, 0
v_mov_b32 v239, 0
Ljoin9:
v_mfma_f32_16x16x32_bf16 v[128:131], a[132:135], v[20:23], v[128:131]
v_mfma_f32_16x16x32_bf16 v[128:131], a[136:139], v[24:27], v[128:131]
v_mfma_f32_16x16x32_bf16 v[128:131], a[140:143], v[28:31], v[128:131]
v_max3_f32 v240, v136, v137, v126
v_max3_f32 v242, v140, v141, v127
v_mfma_f32_16x16x32_bf16 v[132:135], a[140:143], v[44:47], 0
v_max3_f32 v240, v240, v138, v139
v_max3_f32 v242, v242, v142, v143
v_mfma_f32_16x16x32_bf16 v[132:135], a[136:139], v[40:43], v[132:135]
v_max3_f32 v240, v240, v152, v153
v_max3_f32 v242, v242, v156, v157
v_mfma_f32_16x16x32_bf16 v[132:135], a[132:135], v[36:39], v[132:135]
v_max3_f32 v240, v240, v154, v155
v_max3_f32 v242, v242, v158, v159
v_mfma_f32_16x16x32_bf16 v[132:135], a[128:131], v[32:35], v[132:135]
v_mov_b32 v241, v240
v_mov_b32 v243, v242
v_mfma_f32_16x16x32_bf16 v[148:151], a[144:147], v[32:35], 0
v_permlane16_swap_b32 v240, v241
v_permlane16_swap_b32 v242, v243
v_mfma_f32_16x16x32_bf16 v[148:151], a[148:151], v[36:39], v[148:151]
v_max_f32 v240, v240, v241
v_max_f32 v242, v242, v243
v_mfma_f32_16x16x32_bf16 v[148:151], a[152:155], v[40:43], v[148:151]
v_mov_b32 v241, v240
v_mov_b32 v243, v242
v_mfma_f32_16x16x32_bf16 v[148:151], a[156:159], v[44:47], v[148:151]
v_permlane32_swap_b32 v240, v241
v_permlane32_swap_b32 v242, v243
v_mfma_f32_16x16x32_bf16 v[144:147], a[156:159], v[28:31], v[144:147]
v_max_f32 v240, v240, v241
v_max_f32 v242, v242, v243
v_mfma_f32_16x16x32_bf16 v[144:147], a[152:155], v[24:27], v[144:147]
v_mfma_f32_16x16x32_bf16 v[144:147], a[148:151], v[20:23], v[144:147]
v_sub_f32 v88, 0, v240
v_sub_f32 v89, 0, v240
v_pk_add_f32 v[90:91], v[88:89], 0
v_pk_add_f32 v[104:105], v[116:117], v[88:89]
v_pk_add_f32 v[106:107], v[118:119], v[88:89]
v_pk_add_f32 v[136:137], v[136:137], v[88:89]
v_pk_add_f32 v[138:139], v[138:139], v[88:89]
v_pk_add_f32 v[152:153], v[152:153], v[88:89]
v_pk_add_f32 v[154:155], v[154:155], v[88:89]
v_sub_f32 v92, 0, v242
v_sub_f32 v93, 0, v242
v_pk_add_f32 v[94:95], v[92:93], 0
v_pk_add_f32 v[108:109], v[116:117], v[92:93]
v_pk_add_f32 v[110:111], v[118:119], v[92:93]
v_pk_add_f32 v[140:141], v[140:141], v[92:93]
v_pk_add_f32 v[142:143], v[142:143], v[92:93]
v_pk_add_f32 v[156:157], v[156:157], v[92:93]
v_pk_add_f32 v[158:159], v[158:159], v[92:93]
v_max3_f32 v240, v128, v129, v124
v_max3_f32 v242, v132, v133, v125
v_max3_f32 v240, v240, v130, v131
v_max3_f32 v242, v242, v134, v135
v_max3_f32 v240, v240, v144, v145
v_max3_f32 v242, v242, v148, v149
v_max3_f32 v240, v240, v146, v147
v_max3_f32 v242, v242, v150, v151
v_mov_b32 v241, v240
v_mov_b32 v243, v242
s_nop 0
v_permlane16_swap_b32 v240, v241
v_permlane16_swap_b32 v242, v243
v_max_f32 v240, v240, v241
v_max_f32 v242, v242, v243
v_mov_b32 v241, v240
v_mov_b32 v243, v242
s_nop 0
v_permlane32_swap_b32 v240, v241
v_permlane32_swap_b32 v242, v243
v_max_f32 v240, v240, v241
v_max_f32 v242, v242, v243
v_sub_f32 v80, 0, v240
v_sub_f32 v81, 0, v240
v_pk_add_f32 v[82:83], v[80:81], 0
v_pk_add_f32 v[96:97], v[116:117], v[80:81]
v_pk_add_f32 v[98:99], v[118:119], v[80:81]
v_pk_add_f32 v[128:129], v[128:129], v[80:81]
v_pk_add_f32 v[130:131], v[130:131], v[80:81]
v_pk_add_f32 v[144:145], v[144:145], v[80:81]
v_pk_add_f32 v[146:147], v[146:147], v[80:81]
v_sub_f32 v84, 0, v242
v_sub_f32 v85, 0, v242
v_pk_add_f32 v[86:87], v[84:85], 0
v_pk_add_f32 v[100:101], v[116:117], v[84:85]
v_pk_add_f32 v[102:103], v[118:119], v[84:85]
v_pk_add_f32 v[132:133], v[132:133], v[84:85]
v_pk_add_f32 v[134:135], v[134:135], v[84:85]
v_pk_add_f32 v[148:149], v[148:149], v[84:85]
v_pk_add_f32 v[150:151], v[150:151], v[84:85]
v_add_u32 v2, s82, v1
s_waitcnt vmcnt(13) lgkmcnt(0)
s_barrier
s_cmp_eq_u32 s60, 0
s_cbranch_scc1 LP0x
v_mfma_f32_16x16x32_bf16 v[164:167], a[160:163], v[32:35], v[84:87]
s_xor_b32 s74, s82, 0x10000
v_exp_f32 v128, v128
v_mfma_f32_16x16x32_bf16 v[164:167], a[164:167], v[36:39], v[164:167]
s_add_u32 s74, s74, s64
ds_read_b128 a[128:131], v2 offset:16384
ds_read_b128 a[132:135], v2 offset:17408
v_mfma_f32_16x16x32_bf16 v[164:167], a[168:171], v[40:43], v[164:167]
s_add_u32 s81, s81, 0x8000
v_exp_f32 v129, v129
v_mfma_f32_16x16x32_bf16 v[164:167], a[172:175], v[44:47], v[164:167]
s_add_u32 m0, s74, 16384
v_exp_f32 v130, v130
v_mfma_f32_16x16x32_bf16 v[172:175], a[172:175], v[76:79], v[92:95]
s_add_u32 s72, s81, 16384
v_exp_f32 v131, v131
v_mfma_f32_16x16x32_bf16 v[172:175], a[168:171], v[72:75], v[172:175]
v_exp_f32 v144, v144
v_mfma_f32_16x16x32_bf16 v[172:175], a[164:167], v[68:71], v[172:175]
s_nop 0
ds_read_b128 a[136:139], v2 offset:18432
ds_read_b128 a[140:143], v2 offset:19456
v_mfma_f32_16x16x32_bf16 v[172:175], a[160:163], v[64:67], v[172:175]
s_nop 0
ds_read_b128 a[144:147], v2 offset:20480
ds_read_b128 a[148:151], v2 offset:21504
v_mfma_f32_16x16x32_bf16 v[188:191], a[176:179], v[64:67], v[92:95]
s_nop 0
ds_read_b128 a[152:155], v2 offset:22528
ds_read_b128 a[156:159], v2 offset:23552
v_mfma_f32_16x16x32_bf16 v[188:191], a[180:183], v[68:71], v[188:191]
s_nop 0
ds_read_b128 a[192:195], v2 offset:0
ds_read_b128 a[196:199], v2 offset:1024
v_mfma_f32_16x16x32_bf16 v[188:191], a[184:187], v[72:75], v[188:191]
s_nop 0
ds_read_b128 a[200:203], v2 offset:2048
ds_read_b128 a[204:207], v2 offset:3072
v_mfma_f32_16x16x32_bf16 v[188:191], a[188:191], v[76:79], v[188:191]
s_nop 0
ds_read_b128 a[208:211], v2 offset:4096
ds_read_b128 a[212:215], v2 offset:5120
v_mfma_f32_16x16x32_bf16 v[180:183], a[188:191], v[44:47], v[84:87]
s_nop 0
ds_read_b128 a[216:219], v2 offset:6144
ds_read_b128 a[220:223], v2 offset:7168
v_mfma_f32_16x16x32_bf16 v[180:183], a[184:187], v[40:43], v[180:183]
v_cvt_pk_bf16_f32 v192, v128, v129
v_cvt_pk_bf16_f32 v193, v130, v131
v_mfma_f32_16x16x32_bf16 v[180:183], a[180:183], v[36:39], v[180:183]
buffer_load_dwordx4 v1, s[44:47], s72 offen sc1 lds
v_mfma_f32_16x16x32_bf16 v[180:183], a[176:179], v[32:35], v[180:183]
v_exp_f32 v145, v145
v_mfma_f32_16x16x32_bf16 v[160:163], a[160:163], v[16:19], v[80:83]
v_exp_f32 v146, v146
v_mfma_f32_16x16x32_bf16 v[160:163], a[164:167], v[20:23], v[160:163]
v_exp_f32 v147, v147
v_mfma_f32_16x16x32_bf16 v[160:163], a[168:171], v[24:27], v[160:163]
v_exp_f32 v136, v136
v_mfma_f32_16x16x32_bf16 v[160:163], a[172:175], v[28:31], v[160:163]
v_cvt_pk_bf16_f32 v194, v144, v145
v_cvt_pk_bf16_f32 v195, v146, v147
v_mfma_f32_16x16x32_bf16 v[168:171], a[172:175], v[60:63], v[88:91]
v_exp_f32 v137, v137
v_mfma_f32_16x16x32_bf16 v[168:171], a[168:171], v[56:59], v[168:171]
v_exp_f32 v138, v138
v_mfma_f32_16x16x32_bf16 v[168:171], a[164:167], v[52:55], v[168:171]
v_exp_f32 v139, v139
v_mfma_f32_16x16x32_bf16 v[168:171], a[160:163], v[48:51], v[168:171]
v_exp_f32 v152, v152
v_mfma_f32_16x16x32_bf16 v[184:187], a[176:179], v[48:51], v[88:91]
v_cvt_pk_bf16_f32 v200, v136, v137
v_cvt_pk_bf16_f32 v201, v138, v139
v_mfma_f32_16x16x32_bf16 v[184:187], a[180:183], v[52:55], v[184:187]
buffer_load_dwordx4 v1, s[44:47], s72 offen offset:1024 sc1 lds
v_mfma_f32_16x16x32_bf16 v[184:187], a[184:187], v[56:59], v[184:187]
v_exp_f32 v153, v153
v_mfma_f32_16x16x32_bf16 v[184:187], a[188:191], v[60:63], v[184:187]
v_exp_f32 v154, v154
v_mfma_f32_16x16x32_bf16 v[176:179], a[188:191], v[28:31], v[80:83]
v_exp_f32 v155, v155
v_mfma_f32_16x16x32_bf16 v[176:179], a[184:187], v[24:27], v[176:179]
buffer_load_dwordx4 v1, s[44:47], s72 offen offset:2048 sc1 lds
v_mfma_f32_16x16x32_bf16 v[176:179], a[180:183], v[20:23], v[176:179]
buffer_load_dwordx4 v1, s[44:47], s72 offen offset:3072 sc1 lds
v_mfma_f32_16x16x32_bf16 v[176:179], a[176:179], v[16:19], v[176:179]
s_waitcnt lgkmcnt(4)
v_exp_f32 v132, v132
v_cvt_pk_bf16_f32 v202, v152, v153
v_cvt_pk_bf16_f32 v203, v154, v155
v_exp_f32 v133, v133
v_exp_f32 v134, v134
v_cvt_pk_bf16_f32 v196, v132, v133
v_exp_f32 v135, v135
v_exp_f32 v148, v148
v_cvt_pk_bf16_f32 v197, v134, v135
v_exp_f32 v149, v149
v_exp_f32 v150, v150
v_cvt_pk_bf16_f32 v198, v148, v149
v_exp_f32 v151, v151
v_exp_f32 v140, v140
v_cvt_pk_bf16_f32 v199, v150, v151
v_exp_f32 v141, v141
v_exp_f32 v142, v142
v_cvt_pk_bf16_f32 v204, v140, v141
v_exp_f32 v143, v143
v_exp_f32 v156, v156
v_cvt_pk_bf16_f32 v205, v142, v143
v_exp_f32 v157, v157
v_exp_f32 v158, v158
v_cvt_pk_bf16_f32 v206, v156, v157
v_exp_f32 v159, v159
s_nop 0
v_cvt_pk_bf16_f32 v207, v158, v159
v_mfma_f32_16x16x32_bf16 v[224:227], v[120:123], v[192:195], 0
s_add_u32 s82, s82, 0x8000
ds_read_b128 a[160:163], v2 offset:24576
ds_read_b128 a[164:167], v2 offset:25600
v_mfma_f32_16x16x32_bf16 v[232:235], v[120:123], v[200:203], 0
s_and_b32 s82, s82, 0x1ffff
v_exp_f32 v164, v164
v_mfma_f32_16x16x32_bf16 a[0:3], a[192:195], v[192:195], 0
s_add_u32 m0, s74, 0
v_exp_f32 v165, v165
v_mfma_f32_16x16x32_bf16 a[64:67], a[192:195], v[200:203], 0
s_add_u32 s72, s81, 0
v_exp_f32 v166, v166
v_mfma_f32_16x16x32_bf16 a[68:71], a[196:199], v[200:203], 0
buffer_load_dwordx4 v1, s[44:47], s72 offen sc1 lds
v_mfma_f32_16x16x32_bf16 a[4:7], a[196:199], v[192:195], 0
v_exp_f32 v167, v167
v_mfma_f32_16x16x32_bf16 a[8:11], a[200:203], v[192:195], 0
ds_read_b128 a[168:171], v2 offset:26624
v_cvt_pk_bf16_f32 v212, v164, v165
v_mfma_f32_16x16x32_bf16 a[72:75], a[200:203], v[200:203], 0
v_exp_f32 v180, v180
v_mfma_f32_16x16x32_bf16 a[76:79], a[204:207], v[200:203], 0
v_exp_f32 v181, v181
v_mfma_f32_16x16x32_bf16 a[12:15], a[204:207], v[192:195], 0
s_waitcnt lgkmcnt(3)
ds_read_b128 a[172:175], v2 offset:27648
v_cvt_pk_bf16_f32 v213, v166, v167
v_mfma_f32_16x16x32_bf16 a[16:19], a[208:211], v[192:195], 0
v_exp_f32 v182, v182
v_mfma_f32_16x16x32_bf16 a[80:83], a[208:211], v[200:203], 0
buffer_load_dwordx4 v1, s[44:47], s72 offen offset:1024 sc1 lds
v_mfma_f32_16x16x32_bf16 a[84:87], a[212:215], v[200:203], 0
v_exp_f32 v183, v183
v_mfma_f32_16x16x32_bf16 a[20:23], a[212:215], v[192:195], 0
s_nop 0
ds_read_b128 a[176:179], v2 offset:28672
ds_read_b128 a[180:183], v2 offset:29696
v_mfma_f32_16x16x32_bf16 a[24:27], a[216:219], v[192:195], 0
v_exp_f32 v172, v172
v_mfma_f32_16x16x32_bf16 a[88:91], a[216:219], v[200:203], 0
s_nop 0
ds_read_b128 a[184:187], v2 offset:30720
ds_read_b128 a[188:191], v2 offset:31744
v_mfma_f32_16x16x32_bf16 a[92:95], a[220:223], v[200:203], 0
s_nop 0
ds_read_b128 a[224:227], v2 offset:8192
ds_read_b128 a[228:231], v2 offset:9216
v_mfma_f32_16x16x32_bf16 a[28:31], a[220:223], v[192:195], 0
s_nop 0
ds_read_b128 a[232:235], v2 offset:10240
ds_read_b128 a[236:239], v2 offset:11264
v_mfma_f32_16x16x32_bf16 v[128:131], a[128:131], v[16:19], v[80:83]
s_nop 0
ds_read_b128 a[240:243], v2 offset:12288
ds_read_b128 a[244:247], v2 offset:13312
v_mfma_f32_16x16x32_bf16 v[128:131], a[132:135], v[20:23], v[128:131]
s_nop 0
ds_read_b128 a[248:251], v2 offset:14336
ds_read_b128 a[252:255], v2 offset:15360
v_mfma_f32_16x16x32_bf16 v[128:131], a[136:139], v[24:27], v[128:131]
v_cvt_pk_bf16_f32 v214, v180, v181
v_cvt_pk_bf16_f32 v215, v182, v183
v_mfma_f32_16x16x32_bf16 v[128:131], a[140:143], v[28:31], v[128:131]
v_exp_f32 v173, v173
v_mfma_f32_16x16x32_bf16 v[136:139], a[140:143], v[60:63], v[88:91]
v_exp_f32 v174, v174
v_mfma_f32_16x16x32_bf16 v[136:139], a[136:139], v[56:59], v[136:139]
buffer_load_dwordx4 v1, s[44:47], s72 offen offset:2048 sc1 lds
v_mfma_f32_16x16x32_bf16 v[136:139], a[132:135], v[52:55], v[136:139]
v_exp_f32 v175, v175
v_mfma_f32_16x16x32_bf16 v[136:139], a[128:131], v[48:51], v[136:139]
v_exp_f32 v188, v188
v_mfma_f32_16x16x32_bf16 v[152:155], a[144:147], v[48:51], v[88:91]
v_cvt_pk_bf16_f32 v220, v172, v173
v_cvt_pk_bf16_f32 v221, v174, v175
v_mfma_f32_16x16x32_bf16 v[152:155], a[148:151], v[52:55], v[152:155]
v_exp_f32 v189, v189
v_mfma_f32_16x16x32_bf16 v[152:155], a[152:155], v[56:59], v[152:155]
v_exp_f32 v190, v190
v_mfma_f32_16x16x32_bf16 v[152:155], a[156:159], v[60:63], v[152:155]
buffer_load_dwordx4 v1, s[44:47], s72 offen offset:3072 sc1 lds
v_mfma_f32_16x16x32_bf16 v[144:147], a[156:159], v[28:31], v[80:83]
s_add_u32 s66, s58, 1
v_exp_f32 v191, v191
v_mfma_f32_16x16x32_bf16 v[144:147], a[152:155], v[24:27], v[144:147]
s_and_b32 s66, s66, 3
v_exp_f32 v160, v160
v_mfma_f32_16x16x32_bf16 v[144:147], a[148:151], v[20:23], v[144:147]
s_mul_i32 s66, s66, 4160
v_cvt_pk_bf16_f32 v222, v188, v189
v_cvt_pk_bf16_f32 v223, v190, v191
v_mfma_f32_16x16x32_bf16 v[144:147], a[144:147], v[16:19], v[144:147]
s_add_u32 m0, s66, 131104
v_exp_f32 v161, v161
v_mfma_f32_16x16x32_bf16 v[132:135], a[128:131], v[32:35], v[84:87]
s_add_u32 s72, s93, 0x2
buffer_load_dwordx4 v1, s[36:39], s72 offen lds
v_mfma_f32_16x16x32_bf16 v[132:135], a[132:135], v[36:39], v[132:135]
v_exp_f32 v162, v162
v_mfma_f32_16x16x32_bf16 v[132:135], a[136:139], v[40:43], v[132:135]
v_exp_f32 v163, v163
v_mfma_f32_16x16x32_bf16 v[132:135], a[140:143], v[44:47], v[132:135]
v_exp_f32 v176, v176
v_mfma_f32_16x16x32_bf16 v[140:143], a[140:143], v[76:79], v[92:95]
v_cvt_pk_bf16_f32 v208, v160, v161
v_cvt_pk_bf16_f32 v209, v162, v163
v_mfma_f32_16x16x32_bf16 v[140:143], a[136:139], v[72:75], v[140:143]
v_exp_f32 v177, v177
v_mfma_f32_16x16x32_bf16 v[140:143], a[132:135], v[68:71], v[140:143]
buffer_load_dwordx4 v1, s[36:39], s72 offen offset:1024 lds
v_mfma_f32_16x16x32_bf16 v[140:143], a[128:131], v[64:67], v[140:143]
v_exp_f32 v178, v178
v_mfma_f32_16x16x32_bf16 v[156:159], a[144:147], v[64:67], v[92:95]
v_exp_f32 v179, v179
v_mfma_f32_16x16x32_bf16 v[156:159], a[148:151], v[68:71], v[156:159]
v_exp_f32 v168, v168
v_mfma_f32_16x16x32_bf16 v[156:159], a[152:155], v[72:75], v[156:159]
v_cvt_pk_bf16_f32 v210, v176, v177
v_cvt_pk_bf16_f32 v211, v178, v179
v_mfma_f32_16x16x32_bf16 v[156:159], a[156:159], v[76:79], v[156:159]
v_exp_f32 v169, v169
v_mfma_f32_16x16x32_bf16 v[148:151], a[156:159], v[44:47], v[84:87]
buffer_load_dwordx4 v1, s[36:39], s72 offen offset:2048 lds
v_mfma_f32_16x16x32_bf16 v[148:151], a[152:155], v[40:43], v[148:151]
buffer_load_dwordx4 v1, s[36:39], s72 offen offset:3072 lds
v_mfma_f32_16x16x32_bf16 v[148:151], a[148:151], v[36:39], v[148:151]
s_waitcnt vmcnt(12) lgkmcnt(4)
v_exp_f32 v170, v170
v_mfma_f32_16x16x32_bf16 v[148:151], a[144:147], v[32:35], v[148:151]
s_barrier
v_exp_f32 v171, v171
v_add_u32 v2, s82, v1
v_cvt_pk_bf16_f32 v216, v168, v169
v_exp_f32 v184, v184
v_cvt_pk_bf16_f32 v217, v170, v171
v_exp_f32 v185, v185
v_exp_f32 v186, v186
v_cvt_pk_bf16_f32 v218, v184, v185
v_exp_f32 v187, v187
s_nop 0
v_cvt_pk_bf16_f32 v219, v186, v187
s_lshl_b32 s75, s59, 4
s_and_b32 s76, s84, 15
s_add_u32 s75, s75, s76
s_lshl_b32 s75, s75, 14
s_cmp_ge_u32 s60, 4
s_cselect_b32 s75, s75, 0x40001000
s_lshl_b32 s83, s60, 1
s_sub_u32 s83, 2, s83
s_cmp_eq_u32 s83, 0
s_cbranch_scc1 LLT1
.p2align 5
s_nop 0
s_nop 0
LloopI:
v_mfma_f32_16x16x32_bf16 v[228:231], v[120:123], v[196:199], v[228:231]
s_xor_b32 s74, s82, 0x10000
v_exp_f32 v128, v128
v_mfma_f32_16x16x32_bf16 v[228:231], v[120:123], v[212:215], v[228:231]
s_add_u32 s74, s74, s64
ds_read_b128 a[128:131], v2 offset:16384
v_add_u32 v15, s75, v3
v_mfma_f32_16x16x32_bf16 v[236:239], v[120:123], v[204:207], v[236:239]
s_add_u32 s81, s81, 0x8000
v_exp_f32 v129, v129
v_mfma_f32_16x16x32_bf16 v[236:239], v[120:123], v[220:223], v[236:239]
s_add_u32 m0, s74, 16384
v_exp_f32 v130, v130
v_mfma_f32_16x16x32_bf16 a[32:35], a[192:195], v[196:199], a[32:35]
s_add_u32 s72, s81, 16384
ds_read_b128 a[132:135], v2 offset:17408
v_cvt_pk_bf16_f32 v192, v128, v129
v_mfma_f32_16x16x32_bf16 a[32:35], a[224:227], v[212:215], a[32:35]
v_exp_f32 v131, v131
v_mfma_f32_16x16x32_bf16 a[96:99], a[224:227], v[220:223], a[96:99]
v_exp_f32 v144, v144
v_mfma_f32_16x16x32_bf16 a[96:99], a[192:195], v[204:207], a[96:99]
ds_read_b128 a[136:139], v2 offset:18432
v_cvt_pk_bf16_f32 v193, v130, v131
v_mfma_f32_16x16x32_bf16 a[100:103], a[196:199], v[204:207], a[100:103]
buffer_load_dwordx4 v1, s[44:47], s72 offen sc1 lds
v_mfma_f32_16x16x32_bf16 a[100:103], a[228:231], v[220:223], a[100:103]
v_exp_f32 v145, v145
v_mfma_f32_16x16x32_bf16 a[36:39], a[228:231], v[212:215], a[36:39]
v_exp_f32 v146, v146
v_mfma_f32_16x16x32_bf16 a[36:39], a[196:199], v[196:199], a[36:39]
ds_read_b128 a[140:143], v2 offset:19456
v_cvt_pk_bf16_f32 v194, v144, v145
v_mfma_f32_16x16x32_bf16 a[40:43], a[200:203], v[196:199], a[40:43]
v_exp_f32 v147, v147
v_mfma_f32_16x16x32_bf16 a[40:43], a[232:235], v[212:215], a[40:43]
v_exp_f32 v136, v136
v_mfma_f32_16x16x32_bf16 a[104:107], a[232:235], v[220:223], a[104:107]
ds_read_b128 a[144:147], v2 offset:20480
v_cvt_pk_bf16_f32 v195, v146, v147
v_mfma_f32_16x16x32_bf16 a[104:107], a[200:203], v[204:207], a[104:107]
v_exp_f32 v137, v137
v_mfma_f32_16x16x32_bf16 a[108:111], a[204:207], v[204:207], a[108:111]
v_exp_f32 v138, v138
v_mfma_f32_16x16x32_bf16 a[108:111], a[236:239], v[220:223], a[108:111]
ds_read_b128 a[148:151], v2 offset:21504
v_cvt_pk_bf16_f32 v200, v136, v137
v_mfma_f32_16x16x32_bf16 a[44:47], a[236:239], v[212:215], a[44:47]
v_exp_f32 v139, v139
v_mfma_f32_16x16x32_bf16 a[44:47], a[204:207], v[196:199], a[44:47]
v_exp_f32 v152, v152
v_mfma_f32_16x16x32_bf16 a[48:51], a[208:211], v[196:199], a[48:51]
s_waitcnt lgkmcnt(6)
ds_read_b128 a[152:155], v2 offset:22528
v_cvt_pk_bf16_f32 v201, v138, v139
v_mfma_f32_16x16x32_bf16 a[48:51], a[240:243], v[212:215], a[48:51]
buffer_load_dwordx4 v1, s[44:47], s72 offen offset:1024 sc1 lds
v_mfma_f32_16x16x32_bf16 a[112:115], a[240:243], v[220:223], a[112:115]
v_exp_f32 v153, v153
v_mfma_f32_16x16x32_bf16 a[112:115], a[208:211], v[204:207], a[112:115]
v_exp_f32 v154, v154
v_mfma_f32_16x16x32_bf16 a[116:119], a[212:215], v[204:207], a[116:119]
ds_read_b128 a[156:159], v2 offset:23552
v_cvt_pk_bf16_f32 v202, v152, v153
v_mfma_f32_16x16x32_bf16 a[116:119], a[244:247], v[220:223], a[116:119]
v_exp_f32 v155, v155
v_mfma_f32_16x16x32_bf16 a[52:55], a[244:247], v[212:215], a[52:55]
v_exp_f32 v132, v132
v_mfma_f32_16x16x32_bf16 a[52:55], a[212:215], v[196:199], a[52:55]
ds_read_b128 a[192:195], v2 offset:0
v_cvt_pk_bf16_f32 v203, v154, v155
v_mfma_f32_16x16x32_bf16 a[56:59], a[216:219], v[196:199], a[56:59]
v_exp_f32 v133, v133
v_mfma_f32_16x16x32_bf16 a[56:59], a[248:251], v[212:215], a[56:59]
v_exp_f32 v134, v134
v_mfma_f32_16x16x32_bf16 a[120:123], a[248:251], v[220:223], a[120:123]
ds_read_b128 a[196:199], v2 offset:1024
v_mfma_f32_16x16x32_bf16 a[120:123], a[216:219], v[204:207], a[120:123]
v_exp_f32 v135, v135
v_mfma_f32_16x16x32_bf16 a[124:127], a[220:223], v[204:207], a[124:127]
v_exp_f32 v148, v148
v_mfma_f32_16x16x32_bf16 a[124:127], a[252:255], v[220:223], a[124:127]
ds_read_b128 a[200:203], v2 offset:2048
v_mfma_f32_16x16x32_bf16 a[60:63], a[252:255], v[212:215], a[60:63]
buffer_load_dwordx4 v1, s[44:47], s72 offen offset:2048 sc1 lds
v_mfma_f32_16x16x32_bf16 a[60:63], a[220:223], v[196:199], a[60:63]
ds_read_b128 a[204:207], v2 offset:3072
v_cvt_pk_bf16_f32 v196, v132, v133
v_mfma_f32_16x16x32_bf16 v[164:167], a[160:163], v[32:35], v[84:87]
v_exp_f32 v149, v149
v_mfma_f32_16x16x32_bf16 v[164:167], a[164:167], v[36:39], v[164:167]
v_exp_f32 v150, v150
v_mfma_f32_16x16x32_bf16 v[164:167], a[168:171], v[40:43], v[164:167]
ds_read_b128 a[208:211], v2 offset:4096
v_cvt_pk_bf16_f32 v197, v134, v135
v_mfma_f32_16x16x32_bf16 v[164:167], a[172:175], v[44:47], v[164:167]
v_exp_f32 v151, v151
v_mfma_f32_16x16x32_bf16 v[172:175], a[172:175], v[76:79], v[92:95]
v_exp_f32 v140, v140
v_mfma_f32_16x16x32_bf16 v[172:175], a[168:171], v[72:75], v[172:175]
ds_read_b128 a[212:215], v2 offset:5120
v_cvt_pk_bf16_f32 v198, v148, v149
v_mfma_f32_16x16x32_bf16 v[172:175], a[164:167], v[68:71], v[172:175]
v_exp_f32 v141, v141
v_mfma_f32_16x16x32_bf16 v[172:175], a[160:163], v[64:67], v[172:175]
v_exp_f32 v142, v142
v_mfma_f32_16x16x32_bf16 v[188:191], a[176:179], v[64:67], v[92:95]
ds_read_b128 a[216:219], v2 offset:6144
v_cvt_pk_bf16_f32 v199, v150, v151
v_mfma_f32_16x16x32_bf16 v[188:191], a[180:183], v[68:71], v[188:191]
v_exp_f32 v143, v143
v_mfma_f32_16x16x32_bf16 v[188:191], a[184:187], v[72:75], v[188:191]
v_exp_f32 v156, v156
v_mfma_f32_16x16x32_bf16 v[188:191], a[188:191], v[76:79], v[188:191]
ds_read_b128 a[220:223], v2 offset:7168
v_cvt_pk_bf16_f32 v204, v140, v141
v_mfma_f32_16x16x32_bf16 v[180:183], a[188:191], v[44:47], v[84:87]
buffer_load_dwordx4 v1, s[44:47], s72 offen offset:3072 sc1 lds
v_mfma_f32_16x16x32_bf16 v[180:183], a[184:187], v[40:43], v[180:183]
v_exp_f32 v157, v157
v_mfma_f32_16x16x32_bf16 v[180:183], a[180:183], v[36:39], v[180:183]
v_exp_f32 v158, v158
v_mfma_f32_16x16x32_bf16 v[180:183], a[176:179], v[32:35], v[180:183]
v_cvt_pk_bf16_f32 v205, v142, v143
v_cvt_pk_bf16_f32 v206, v156, v157
v_mfma_f32_16x16x32_bf16 v[160:163], a[160:163], v[16:19], v[80:83]
v_exp_f32 v159, v159
v_mfma_f32_16x16x32_bf16 v[160:163], a[164:167], v[20:23], v[160:163]
v_cvt_pk_bf16_f32 v207, v158, v159
v_mfma_f32_16x16x32_bf16 v[160:163], a[168:171], v[24:27], v[160:163]
v_mfma_f32_16x16x32_bf16 v[160:163], a[172:175], v[28:31], v[160:163]
v_mfma_f32_16x16x32_bf16 v[168:171], a[172:175], v[60:63], v[88:91]
v_mfma_f32_16x16x32_bf16 v[168:171], a[168:171], v[56:59], v[168:171]
v_mfma_f32_16x16x32_bf16 v[168:171], a[164:167], v[52:55], v[168:171]
v_mfma_f32_16x16x32_bf16 v[168:171], a[160:163], v[48:51], v[168:171]
v_mfma_f32_16x16x32_bf16 v[184:187], a[176:179], v[48:51], v[88:91]
v_mfma_f32_16x16x32_bf16 v[184:187], a[180:183], v[52:55], v[184:187]
v_mfma_f32_16x16x32_bf16 v[184:187], a[184:187], v[56:59], v[184:187]
v_mfma_f32_16x16x32_bf16 v[184:187], a[188:191], v[60:63], v[184:187]
v_mfma_f32_16x16x32_bf16 v[176:179], a[188:191], v[28:31], v[80:83]
v_mfma_f32_16x16x32_bf16 v[176:179], a[184:187], v[24:27], v[176:179]
v_mfma_f32_16x16x32_bf16 v[176:179], a[180:183], v[20:23], v[176:179]
v_mfma_f32_16x16x32_bf16 v[176:179], a[176:179], v[16:19], v[176:179]
s_waitcnt lgkmcnt(4)
v_mfma_f32_16x16x32_bf16 v[224:227], v[120:123], v[208:211], v[224:227]
s_add_u32 s82, s82, 0x8000
ds_read_b128 a[160:163], v2 offset:24576
v_mfma_f32_16x16x32_bf16 v[224:227], v[120:123], v[192:195], v[224:227]
s_and_b32 s82, s82, 0x1ffff
v_exp_f32 v164, v164
v_mfma_f32_16x16x32_bf16 v[232:235], v[120:123], v[216:219], v[232:235]
s_add_u32 m0, s74, 0
v_exp_f32 v165, v165
v_mfma_f32_16x16x32_bf16 v[232:235], v[120:123], v[200:203], v[232:235]
s_add_u32 s72, s81, 0
ds_read_b128 a[164:167], v2 offset:25600
v_cvt_pk_bf16_f32 v212, v164, v165
v_mfma_f32_16x16x32_bf16 a[0:3], a[224:227], v[208:211], a[0:3]
v_exp_f32 v166, v166
v_mfma_f32_16x16x32_bf16 a[0:3], a[192:195], v[192:195], a[0:3]
v_exp_f32 v167, v167
v_mfma_f32_16x16x32_bf16 a[64:67], a[192:195], v[200:203], a[64:67]
buffer_load_dwordx4 v1, s[44:47], s72 offen sc1 lds
v_mfma_f32_16x16x32_bf16 a[64:67], a[224:227], v[216:219], a[64:67]
ds_read_b128 a[168:171], v2 offset:26624
v_cvt_pk_bf16_f32 v213, v166, v167
v_mfma_f32_16x16x32_bf16 a[68:71], a[228:231], v[216:219], a[68:71]
v_exp_f32 v180, v180
v_mfma_f32_16x16x32_bf16 a[68:71], a[196:199], v[200:203], a[68:71]
v_exp_f32 v181, v181
v_mfma_f32_16x16x32_bf16 a[4:7], a[196:199], v[192:195], a[4:7]
ds_read_b128 a[172:175], v2 offset:27648
v_cvt_pk_bf16_f32 v214, v180, v181
v_mfma_f32_16x16x32_bf16 a[4:7], a[228:231], v[208:211], a[4:7]
v_exp_f32 v182, v182
v_mfma_f32_16x16x32_bf16 a[8:11], a[232:235], v[208:211], a[8:11]
v_exp_f32 v183, v183
v_mfma_f32_16x16x32_bf16 a[8:11], a[200:203], v[192:195], a[8:11]
ds_read_b128 a[176:179], v2 offset:28672
v_cvt_pk_bf16_f32 v215, v182, v183
v_mfma_f32_16x16x32_bf16 a[72:75], a[200:203], v[200:203], a[72:75]
v_exp_f32 v172, v172
v_mfma_f32_16x16x32_bf16 a[72:75], a[232:235], v[216:219], a[72:75]
v_exp_f32 v173, v173
v_mfma_f32_16x16x32_bf16 a[76:79], a[236:239], v[216:219], a[76:79]
ds_read_b128 a[180:183], v2 offset:29696
v_cvt_pk_bf16_f32 v220, v172, v173
v_mfma_f32_16x16x32_bf16 a[76:79], a[204:207], v[200:203], a[76:79]
buffer_load_dwordx4 v1, s[44:47], s72 offen offset:1024 sc1 lds
v_mfma_f32_16x16x32_bf16 a[12:15], a[204:207], v[192:195], a[12:15]
v_exp_f32 v174, v174
v_mfma_f32_16x16x32_bf16 a[12:15], a[236:239], v[208:211], a[12:15]
v_exp_f32 v175, v175
v_mfma_f32_16x16x32_bf16 a[16:19], a[240:243], v[208:211], a[16:19]
s_waitcnt lgkmcnt(6)
ds_read_b128 a[184:187], v2 offset:30720
v_cvt_pk_bf16_f32 v221, v174, v175
v_mfma_f32_16x16x32_bf16 a[16:19], a[208:211], v[192:195], a[16:19]
v_exp_f32 v188, v188
v_mfma_f32_16x16x32_bf16 a[80:83], a[208:211], v[200:203], a[80:83]
v_exp_f32 v189, v189
v_mfma_f32_16x16x32_bf16 a[80:83], a[240:243], v[216:219], a[80:83]
ds_read_b128 a[188:191], v2 offset:31744
v_cvt_pk_bf16_f32 v222, v188, v189
v_mfma_f32_16x16x32_bf16 a[84:87], a[244:247], v[216:219], a[84:87]
v_exp_f32 v190, v190
v_mfma_f32_16x16x32_bf16 a[84:87], a[212:215], v[200:203], a[84:87]
v_exp_f32 v191, v191
v_mfma_f32_16x16x32_bf16 a[20:23], a[212:215], v[192:195], a[20:23]
ds_read_b128 a[224:227], v2 offset:8192
v_cvt_pk_bf16_f32 v223, v190, v191
v_mfma_f32_16x16x32_bf16 a[20:23], a[244:247], v[208:211], a[20:23]
v_exp_f32 v160, v160
v_mfma_f32_16x16x32_bf16 a[24:27], a[248:251], v[208:211], a[24:27]
buffer_load_dwordx4 v1, s[44:47], s72 offen offset:2048 sc1 lds
v_mfma_f32_16x16x32_bf16 a[24:27], a[216:219], v[192:195], a[24:27]
v_exp_f32 v161, v161
v_mfma_f32_16x16x32_bf16 a[88:91], a[216:219], v[200:203], a[88:91]
ds_read_b128 a[228:231], v2 offset:9216
v_mfma_f32_16x16x32_bf16 a[88:91], a[248:251], v[216:219], a[88:91]
v_exp_f32 v162, v162
v_mfma_f32_16x16x32_bf16 a[92:95], a[252:255], v[216:219], a[92:95]
v_exp_f32 v163, v163
v_mfma_f32_16x16x32_bf16 a[92:95], a[220:223], v[200:203], a[92:95]
ds_read_b128 a[232:235], v2 offset:10240
v_mfma_f32_16x16x32_bf16 a[28:31], a[220:223], v[192:195], a[28:31]
v_exp_f32 v176, v176
v_mfma_f32_16x16x32_bf16 a[28:31], a[252:255], v[208:211], a[28:31]
ds_read_b128 a[236:239], v2 offset:11264
v_cvt_pk_bf16_f32 v208, v160, v161
v_mfma_f32_16x16x32_bf16 v[128:131], a[128:131], v[16:19], v[80:83]
Lstub1:
s_cbranch_execz Lstub5
v_exp_f32 v177, v177
v_mfma_f32_16x16x32_bf16 v[128:131], a[132:135], v[20:23], v[128:131]
v_exp_f32 v178, v178
v_mfma_f32_16x16x32_bf16 v[128:131], a[136:139], v[24:27], v[128:131]
ds_read_b128 a[240:243], v2 offset:12288
v_cvt_pk_bf16_f32 v209, v162, v163
v_mfma_f32_16x16x32_bf16 v[128:131], a[140:143], v[28:31], v[128:131]
buffer_load_dwordx4 v1, s[44:47], s72 offen offset:3072 sc1 lds
v_mfma_f32_16x16x32_bf16 v[136:139], a[140:143], v[60:63], v[88:91]
s_add_u32 s75, s75, 0x1000
v_exp_f32 v179, v179
v_mfma_f32_16x16x32_bf16 v[136:139], a[136:139], v[56:59], v[136:139]
s_and_b32 s76, s75, 0x3000
v_exp_f32 v168, v168
v_mfma_f32_16x16x32_bf16 v[136:139], a[132:135], v[52:55], v[136:139]
s_cselect_b32 s75, s75, 0x40001000
ds_read_b128 a[244:247], v2 offset:13312
v_cvt_pk_bf16_f32 v210, v176, v177
v_mfma_f32_16x16x32_bf16 v[136:139], a[128:131], v[48:51], v[136:139]
v_exp_f32 v169, v169
v_mfma_f32_16x16x32_bf16 v[152:155], a[144:147], v[48:51], v[88:91]
v_exp_f32 v170, v170
v_mfma_f32_16x16x32_bf16 v[152:155], a[148:151], v[52:55], v[152:155]
ds_read_b128 a[248:251], v2 offset:14336
v_cvt_pk_bf16_f32 v211, v178, v179
v_mfma_f32_16x16x32_bf16 v[152:155], a[152:155], v[56:59], v[152:155]
v_exp_f32 v171, v171
v_mfma_f32_16x16x32_bf16 v[152:155], a[156:159], v[60:63], v[152:155]
v_exp_f32 v184, v184
v_mfma_f32_16x16x32_bf16 v[144:147], a[156:159], v[28:31], v[80:83]
ds_read_b128 a[252:255], v2 offset:15360
v_cvt_pk_bf16_f32 v216, v168, v169
v_mfma_f32_16x16x32_bf16 v[144:147], a[152:155], v[24:27], v[144:147]
buffer_load_dword v4, v15, s[24:27], 0 offen
v_mfma_f32_16x16x32_bf16 v[144:147], a[148:151], v[20:23], v[144:147]
v_exp_f32 v185, v185
v_mfma_f32_16x16x32_bf16 v[144:147], a[144:147], v[16:19], v[144:147]
v_exp_f32 v186, v186
v_mfma_f32_16x16x32_bf16 v[132:135], a[128:131], v[32:35], v[84:87]
v_cvt_pk_bf16_f32 v217, v170, v171
v_cvt_pk_bf16_f32 v218, v184, v185
v_mfma_f32_16x16x32_bf16 v[132:135], a[132:135], v[36:39], v[132:135]
v_exp_f32 v187, v187
v_mfma_f32_16x16x32_bf16 v[132:135], a[136:139], v[40:43], v[132:135]
v_cvt_pk_bf16_f32 v219, v186, v187
v_add_u32 v2, s82, v1
v_mfma_f32_16x16x32_bf16 v[132:135], a[140:143], v[44:47], v[132:135]
v_mfma_f32_16x16x32_bf16 v[140:143], a[140:143], v[76:79], v[92:95]
v_mfma_f32_16x16x32_bf16 v[140:143], a[136:139], v[72:75], v[140:143]
v_mfma_f32_16x16x32_bf16 v[140:143], a[132:135], v[68:71], v[140:143]
v_mfma_f32_16x16x32_bf16 v[140:143], a[128:131], v[64:67], v[140:143]
v_mfma_f32_16x16x32_bf16 v[156:159], a[144:147], v[64:67], v[92:95]
v_mfma_f32_16x16x32_bf16 v[156:159], a[148:151], v[68:71], v[156:159]
v_mfma_f32_16x16x32_bf16 v[156:159], a[152:155], v[72:75], v[156:159]
v_mfma_f32_16x16x32_bf16 v[156:159], a[156:159], v[76:79], v[156:159]
v_mfma_f32_16x16x32_bf16 v[148:151], a[156:159], v[44:47], v[84:87]
s_waitcnt vmcnt(9) lgkmcnt(4)
v_mfma_f32_16x16x32_bf16 v[148:151], a[152:155], v[40:43], v[148:151]
s_barrier
v_mfma_f32_16x16x32_bf16 v[148:151], a[148:151], v[36:39], v[148:151]
s_add_u32 s83, s83, 1
v_mfma_f32_16x16x32_bf16 v[148:151], a[144:147], v[32:35], v[148:151]
s_cbranch_scc0 LloopI
LLT1:
Lstub2:
s_cbranch_execz Lstub6
v_mfma_f32_16x16x32_bf16 v[228:231], v[120:123], v[196:199], v[228:231]
s_xor_b32 s74, s82, 0x10000
v_exp_f32 v128, v128
v_mfma_f32_16x16x32_bf16 v[228:231], v[120:123], v[212:215], v[228:231]
s_add_u32 s74, s74, s64
ds_read_b128 a[128:131], v2 offset:16384
v_mfma_f32_16x16x32_bf16 v[236:239], v[120:123], v[204:207], v[236:239]
s_add_u32 s81, s81, 0x8000
v_exp_f32 v129, v129
v_mfma_f32_16x16x32_bf16 v[236:239], v[120:123], v[220:223], v[236:239]
s_add_u32 m0, s74, 16384
v_exp_f32 v130, v130
v_mfma_f32_16x16x32_bf16 a[32:35], a[192:195], v[196:199], a[32:35]
s_add_u32 s72, s81, 16384
ds_read_b128 a[132:135], v2 offset:17408
v_cvt_pk_bf16_f32 v192, v128, v129
v_mfma_f32_16x16x32_bf16 a[32:35], a[224:227], v[212:215], a[32:35]
v_exp_f32 v131, v131
v_mfma_f32_16x16x32_bf16 a[96:99], a[224:227], v[220:223], a[96:99]
v_exp_f32 v144, v144
v_mfma_f32_16x16x32_bf16 a[96:99], a[192:195], v[204:207], a[96:99]
ds_read_b128 a[136:139], v2 offset:18432
v_cvt_pk_bf16_f32 v193, v130, v131
v_mfma_f32_16x16x32_bf16 a[100:103], a[196:199], v[204:207], a[100:103]
buffer_load_dwordx4 v1, s[44:47], s72 offen sc1 lds
v_mfma_f32_16x16x32_bf16 a[100:103], a[228:231], v[220:223], a[100:103]
v_exp_f32 v145, v145
v_mfma_f32_16x16x32_bf16 a[36:39], a[228:231], v[212:215], a[36:39]
v_exp_f32 v146, v146
v_mfma_f32_16x16x32_bf16 a[36:39], a[196:199], v[196:199], a[36:39]
ds_read_b128 a[140:143], v2 offset:19456
v_cvt_pk_bf16_f32 v194, v144, v145
v_mfma_f32_16x16x32_bf16 a[40:43], a[200:203], v[196:199], a[40:43]
v_exp_f32 v147, v147
v_mfma_f32_16x16x32_bf16 a[40:43], a[232:235], v[212:215], a[40:43]
v_exp_f32 v136, v136
v_mfma_f32_16x16x32_bf16 a[104:107], a[232:235], v[220:223], a[104:107]
ds_read_b128 a[144:147], v2 offset:20480
v_cvt_pk_bf16_f32 v195, v146, v147
v_mfma_f32_16x16x32_bf16 a[104:107], a[200:203], v[204:207], a[104:107]
v_exp_f32 v137, v137
v_mfma_f32_16x16x32_bf16 a[108:111], a[204:207], v[204:207], a[108:111]
v_exp_f32 v138, v138
v_mfma_f32_16x16x32_bf16 a[108:111], a[236:239], v[220:223], a[108:111]
ds_read_b128 a[148:151], v2 offset:21504
v_cvt_pk_bf16_f32 v200, v136, v137
v_mfma_f32_16x16x32_bf16 a[44:47], a[236:239], v[212:215], a[44:47]
v_exp_f32 v139, v139
v_mfma_f32_16x16x32_bf16 a[44:47], a[204:207], v[196:199], a[44:47]
v_exp_f32 v152, v152
v_mfma_f32_16x16x32_bf16 a[48:51], a[208:211], v[196:199], a[48:51]
s_waitcnt lgkmcnt(6)
ds_read_b128 a[152:155], v2 offset:22528
v_cvt_pk_bf16_f32 v201, v138, v139
v_mfma_f32_16x16x32_bf16 a[48:51], a[240:243], v[212:215], a[48:51]
buffer_load_dwordx4 v1, s[44:47], s72 offen offset:1024 sc1 lds
v_mfma_f32_16x16x32_bf16 a[112:115], a[240:243], v[220:223], a[112:115]
v_exp_f32 v153, v153
v_mfma_f32_16x16x32_bf16 a[112:115], a[208:211], v[204:207], a[112:115]
v_exp_f32 v154, v154
v_mfma_f32_16x16x32_bf16 a[116:119], a[212:215], v[204:207], a[116:119]
ds_read_b128 a[156:159], v2 offset:23552
v_cvt_pk_bf16_f32 v202, v152, v153
v_mfma_f32_16x16x32_bf16 a[116:119], a[244:247], v[220:223], a[116:119]
v_exp_f32 v155, v155
v_mfma_f32_16x16x32_bf16 a[52:55], a[244:247], v[212:215], a[52:55]
v_exp_f32 v132, v132
v_mfma_f32_16x16x32_bf16 a[52:55], a[212:215], v[196:199], a[52:55]
ds_read_b128 a[192:195], v2 offset:0
v_cvt_pk_bf16_f32 v203, v154, v155
v_mfma_f32_16x16x32_bf16 a[56:59], a[216:219], v[196:199], a[56:59]
v_exp_f32 v133, v133
v_mfma_f32_16x16x32_bf16 a[56:59], a[248:251], v[212:215], a[56:59]
v_exp_f32 v134, v134
v_mfma_f32_16x16x32_bf16 a[120:123], a[248:251], v[220:223], a[120:123]
ds_read_b128 a[196:199], v2 offset:1024
v_mfma_f32_16x16x32_bf16 a[120:123], a[216:219], v[204:207], a[120:123]
v_exp_f32 v135, v135
v_mfma_f32_16x16x32_bf16 a[124:127], a[220:223], v[204:207], a[124:127]
v_exp_f32 v148, v148
v_mfma_f32_16x16x32_bf16 a[124:127], a[252:255], v[220:223], a[124:127]
ds_read_b128 a[200:203], v2 offset:2048
v_mfma_f32_16x16x32_bf16 a[60:63], a[252:255], v[212:215], a[60:63]
buffer_load_dwordx4 v1, s[44:47], s72 offen offset:2048 sc1 lds
v_mfma_f32_16x16x32_bf16 a[60:63], a[220:223], v[196:199], a[60:63]
ds_read_b128 a[204:207], v2 offset:3072
v_cvt_pk_bf16_f32 v196, v132, v133
v_mfma_f32_16x16x32_bf16 v[164:167], a[160:163], v[32:35], v[84:87]
v_exp_f32 v149, v149
v_mfma_f32_16x16x32_bf16 v[164:167], a[164:167], v[36:39], v[164:167]
v_exp_f32 v150, v150
v_mfma_f32_16x16x32_bf16 v[164:167], a[168:171], v[40:43], v[164:167]
ds_read_b128 a[208:211], v2 offset:4096
v_cvt_pk_bf16_f32 v197, v134, v135
v_mfma_f32_16x16x32_bf16 v[164:167], a[172:175], v[44:47], v[164:167]
v_exp_f32 v151, v151
v_mfma_f32_16x16x32_bf16 v[172:175], a[172:175], v[76:79], v[92:95]
v_exp_f32 v140, v140
v_mfma_f32_16x16x32_bf16 v[172:175], a[168:171], v[72:75], v[172:175]
ds_read_b128 a[212:215], v2 offset:5120
v_cvt_pk_bf16_f32 v198, v148, v149
v_mfma_f32_16x16x32_bf16 v[172:175], a[164:167], v[68:71], v[172:175]
v_exp_f32 v141, v141
v_mfma_f32_16x16x32_bf16 v[172:175], a[160:163], v[64:67], v[172:175]
v_exp_f32 v142, v142
v_mfma_f32_16x16x32_bf16 v[188:191], a[176:179], v[64:67], v[92:95]
ds_read_b128 a[216:219], v2 offset:6144
v_cvt_pk_bf16_f32 v199, v150, v151
v_mfma_f32_16x16x32_bf16 v[188:191], a[180:183], v[68:71], v[188:191]
v_exp_f32 v143, v143
v_mfma_f32_16x16x32_bf16 v[188:191], a[184:187], v[72:75], v[188:191]
v_exp_f32 v156, v156
v_mfma_f32_16x16x32_bf16 v[188:191], a[188:191], v[76:79], v[188:191]
ds_read_b128 a[220:223], v2 offset:7168
v_cvt_pk_bf16_f32 v204, v140, v141
v_mfma_f32_16x16x32_bf16 v[180:183], a[188:191], v[44:47], v[84:87]
buffer_load_dwordx4 v1, s[44:47], s72 offen offset:3072 sc1 lds
v_mfma_f32_16x16x32_bf16 v[180:183], a[184:187], v[40:43], v[180:183]
v_exp_f32 v157, v157
v_mfma_f32_16x16x32_bf16 v[180:183], a[180:183], v[36:39], v[180:183]
v_exp_f32 v158, v158
v_mfma_f32_16x16x32_bf16 v[180:183], a[176:179], v[32:35], v[180:183]
v_cvt_pk_bf16_f32 v205, v142, v143
v_cvt_pk_bf16_f32 v206, v156, v157
v_mfma_f32_16x16x32_bf16 v[160:163], a[160:163], v[16:19], v[80:83]
v_exp_f32 v159, v159
v_mfma_f32_16x16x32_bf16 v[160:163], a[164:167], v[20:23], v[160:163]
v_cvt_pk_bf16_f32 v207, v158, v159
v_mfma_f32_16x16x32_bf16 v[160:163], a[168:171], v[24:27], v[160:163]
v_mfma_f32_16x16x32_bf16 v[160:163], a[172:175], v[28:31], v[160:163]
v_mfma_f32_16x16x32_bf16 v[168:171], a[172:175], v[60:63], v[88:91]
v_mfma_f32_16x16x32_bf16 v[168:171], a[168:171], v[56:59], v[168:171]
v_mfma_f32_16x16x32_bf16 v[168:171], a[164:167], v[52:55], v[168:171]
v_mfma_f32_16x16x32_bf16 v[168:171], a[160:163], v[48:51], v[168:171]
v_mfma_f32_16x16x32_bf16 v[184:187], a[176:179], v[48:51], v[88:91]
v_mfma_f32_16x16x32_bf16 v[184:187], a[180:183], v[52:55], v[184:187]
v_mfma_f32_16x16x32_bf16 v[184:187], a[184:187], v[56:59], v[184:187]
v_mfma_f32_16x16x32_bf16 v[184:187], a[188:191], v[60:63], v[184:187]
v_mfma_f32_16x16x32_bf16 v[176:179], a[188:191], v[28:31], v[80:83]
v_mfma_f32_16x16x32_bf16 v[176:179], a[184:187], v[24:27], v[176:179]
v_mfma_f32_16x16x32_bf16 v[176:179], a[180:183], v[20:23], v[176:179]
v_mfma_f32_16x16x32_bf16 v[176:179], a[176:179], v[16:19], v[176:179]
s_waitcnt lgkmcnt(4)
v_mfma_f32_16x16x32_bf16 v[224:227], v[120:123], v[208:211], v[224:227]
s_add_u32 s82, s82, 0x8000
ds_read_b128 a[160:163], v2 offset:24576
v_mfma_f32_16x16x32_bf16 v[224:227], v[120:123], v[192:195], v[224:227]
s_and_b32 s82, s82, 0x1ffff
v_exp_f32 v164, v164
v_mfma_f32_16x16x32_bf16 v[232:235], v[120:123], v[216:219], v[232:235]
s_add_u32 m0, s74, 0
v_exp_f32 v165, v165
v_mfma_f32_16x16x32_bf16 v[232:235], v[120:123], v[200:203], v[232:235]
s_add_u32 s72, s81, 0
ds_read_b128 a[164:167], v2 offset:25600
v_cvt_pk_bf16_f32 v212, v164, v165
v_mfma_f32_16x16x32_bf16 a[0:3], a[224:227], v[208:211], a[0:3]
v_exp_f32 v166, v166
v_mfma_f32_16x16x32_bf16 a[0:3], a[192:195], v[192:195], a[0:3]
v_exp_f32 v167, v167
v_mfma_f32_16x16x32_bf16 a[64:67], a[192:195], v[200:203], a[64:67]
ds_read_b128 a[168:171], v2 offset:26624
v_cvt_pk_bf16_f32 v213, v166, v167
v_mfma_f32_16x16x32_bf16 a[64:67], a[224:227], v[216:219], a[64:67]
v_exp_f32 v180, v180
v_mfma_f32_16x16x32_bf16 a[68:71], a[228:231], v[216:219], a[68:71]
buffer_load_dwordx4 v1, s[44:47], s72 offen sc1 lds
v_mfma_f32_16x16x32_bf16 a[68:71], a[196:199], v[200:203], a[68:71]
v_exp_f32 v181, v181
v_mfma_f32_16x16x32_bf16 a[4:7], a[196:199], v[192:195], a[4:7]
ds_read_b128 a[172:175], v2 offset:27648
v_cvt_pk_bf16_f32 v214, v180, v181
v_mfma_f32_16x16x32_bf16 a[4:7], a[228:231], v[208:211], a[4:7]
v_exp_f32 v182, v182
v_mfma_f32_16x16x32_bf16 a[8:11], a[232:235], v[208:211], a[8:11]
v_exp_f32 v183, v183
v_mfma_f32_16x16x32_bf16 a[8:11], a[200:203], v[192:195], a[8:11]
ds_read_b128 a[176:179], v2 offset:28672
v_cvt_pk_bf16_f32 v215, v182, v183
v_mfma_f32_16x16x32_bf16 a[72:75], a[200:203], v[200:203], a[72:75]
v_exp_f32 v172, v172
v_mfma_f32_16x16x32_bf16 a[72:75], a[232:235], v[216:219], a[72:75]
v_exp_f32 v173, v173
v_mfma_f32_16x16x32_bf16 a[76:79], a[236:239], v[216:219], a[76:79]
ds_read_b128 a[180:183], v2 offset:29696
v_cvt_pk_bf16_f32 v220, v172, v173
v_mfma_f32_16x16x32_bf16 a[76:79], a[204:207], v[200:203], a[76:79]
v_exp_f32 v174, v174
v_mfma_f32_16x16x32_bf16 a[12:15], a[204:207], v[192:195], a[12:15]
v_exp_f32 v175, v175
v_mfma_f32_16x16x32_bf16 a[12:15], a[236:239], v[208:211], a[12:15]
ds_read_b128 a[184:187], v2 offset:30720
v_cvt_pk_bf16_f32 v221, v174, v175
v_mfma_f32_16x16x32_bf16 a[16:19], a[240:243], v[208:211], a[16:19]
s_waitcnt lgkmcnt(7)
v_exp_f32 v188, v188
v_mfma_f32_16x16x32_bf16 a[16:19], a[208:211], v[192:195], a[16:19]
buffer_load_dwordx4 v1, s[44:47], s72 offen offset:1024 sc1 lds
v_mfma_f32_16x16x32_bf16 a[80:83], a[208:211], v[200:203], a[80:83]
v_exp_f32 v189, v189
v_mfma_f32_16x16x32_bf16 a[80:83], a[240:243], v[216:219], a[80:83]
ds_read_b128 a[188:191], v2 offset:31744
v_cvt_pk_bf16_f32 v222, v188, v189
v_mfma_f32_16x16x32_bf16 a[84:87], a[244:247], v[216:219], a[84:87]
v_exp_f32 v190, v190
v_mfma_f32_16x16x32_bf16 a[84:87], a[212:215], v[200:203], a[84:87]
v_exp_f32 v191, v191
v_mfma_f32_16x16x32_bf16 a[20:23], a[212:215], v[192:195], a[20:23]
ds_read_b128 a[224:227], v2 offset:8192
v_cvt_pk_bf16_f32 v223, v190, v191
v_mfma_f32_16x16x32_bf16 a[20:23], a[244:247], v[208:211], a[20:23]
v_exp_f32 v160, v160
v_mfma_f32_16x16x32_bf16 a[24:27], a[248:251], v[208:211], a[24:27]
v_exp_f32 v161, v161
v_mfma_f32_16x16x32_bf16 a[24:27], a[216:219], v[192:195], a[24:27]
ds_read_b128 a[228:231], v2 offset:9216
v_mfma_f32_16x16x32_bf16 a[88:91], a[216:219], v[200:203], a[88:91]
v_exp_f32 v162, v162
v_mfma_f32_16x16x32_bf16 a[88:91], a[248:251], v[216:219], a[88:91]
v_exp_f32 v163, v163
v_mfma_f32_16x16x32_bf16 a[92:95], a[252:255], v[216:219], a[92:95]
ds_read_b128 a[232:235], v2 offset:10240
v_mfma_f32_16x16x32_bf16 a[92:95], a[220:223], v[200:203], a[92:95]
v_exp_f32 v176, v176
v_mfma_f32_16x16x32_bf16 a[28:31], a[220:223], v[192:195], a[28:31]
buffer_load_dwordx4 v1, s[44:47], s72 offen offset:2048 sc1 lds
v_mfma_f32_16x16x32_bf16 a[28:31], a[252:255], v[208:211], a[28:31]
ds_read_b128 a[236:239], v2 offset:11264
v_cvt_pk_bf16_f32 v208, v160, v161
s_cmp_eq_u32 s58, 0
s_cbranch_scc1 Lta16
s_cmp_eq_u32 s58, 1
s_cbranch_scc1 Lnt17
v_mfma_f32_16x16x32_bf16 v[128:131], a[128:131], v[16:19], v[80:83]
v_exp_f32 v177, v177
v_mfma_f32_16x16x32_bf16 v[144:147], a[144:147], v[16:19], v[80:83]
v_exp_f32 v178, v178
s_branch Ljoin18
Lta16:
v_mfma_f32_16x16x32_bf16 v[128:131], a[128:131], v[16:19], v[96:99]
v_exp_f32 v177, v177
v_mfma_f32_16x16x32_bf16 v[144:147], a[144:147], v[16:19], v[112:115]
v_exp_f32 v178, v178
s_branch Ljoin18
Lnt17:
v_mfma_f32_16x16x32_bf16 v[128:131], a[128:131], v[16:19], v[80:83]
v_exp_f32 v177, v177
v_mfma_f32_16x16x32_bf16 v[144:147], a[144:147], v[16:19], v[96:99]
v_exp_f32 v178, v178
Ljoin18:
v_mfma_f32_16x16x32_bf16 v[128:131], a[132:135], v[20:23], v[128:131]
ds_read_b128 a[240:243], v2 offset:12288
v_cvt_pk_bf16_f32 v209, v162, v163
v_mfma_f32_16x16x32_bf16 v[128:131], a[136:139], v[24:27], v[128:131]
v_exp_f32 v179, v179
v_mfma_f32_16x16x32_bf16 v[128:131], a[140:143], v[28:31], v[128:131]
v_exp_f32 v168, v168
v_mfma_f32_16x16x32_bf16 v[136:139], a[140:143], v[60:63], v[88:91]
ds_read_b128 a[244:247], v2 offset:13312
v_cvt_pk_bf16_f32 v210, v176, v177
v_mfma_f32_16x16x32_bf16 v[136:139], a[136:139], v[56:59], v[136:139]
v_exp_f32 v169, v169
v_mfma_f32_16x16x32_bf16 v[136:139], a[132:135], v[52:55], v[136:139]
v_exp_f32 v170, v170
v_mfma_f32_16x16x32_bf16 v[136:139], a[128:131], v[48:51], v[136:139]
ds_read_b128 a[248:251], v2 offset:14336
v_cvt_pk_bf16_f32 v211, v178, v179
v_mfma_f32_16x16x32_bf16 v[152:155], a[144:147], v[48:51], v[88:91]
v_exp_f32 v171, v171
v_mfma_f32_16x16x32_bf16 v[152:155], a[148:151], v[52:55], v[152:155]
v_exp_f32 v184, v184
v_mfma_f32_16x16x32_bf16 v[152:155], a[152:155], v[56:59], v[152:155]
ds_read_b128 a[252:255], v2 offset:15360
v_cvt_pk_bf16_f32 v216, v168, v169
v_mfma_f32_16x16x32_bf16 v[152:155], a[156:159], v[60:63], v[152:155]
buffer_load_dwordx4 v1, s[44:47], s72 offen offset:3072 sc1 lds
v_mfma_f32_16x16x32_bf16 v[144:147], a[156:159], v[28:31], v[144:147]
v_exp_f32 v185, v185
v_mfma_f32_16x16x32_bf16 v[144:147], a[152:155], v[24:27], v[144:147]
v_exp_f32 v186, v186
v_mfma_f32_16x16x32_bf16 v[144:147], a[148:151], v[20:23], v[144:147]
v_cvt_pk_bf16_f32 v217, v170, v171
v_cvt_pk_bf16_f32 v218, v184, v185
v_mfma_f32_16x16x32_bf16 v[132:135], a[128:131], v[32:35], v[84:87]
v_exp_f32 v187, v187
v_mfma_f32_16x16x32_bf16 v[132:135], a[132:135], v[36:39], v[132:135]
v_cvt_pk_bf16_f32 v219, v186, v187
v_add_u32 v2, s82, v1
v_mfma_f32_16x16x32_bf16 v[132:135], a[136:139], v[40:43], v[132:135]
v_mfma_f32_16x16x32_bf16 v[132:135], a[140:143], v[44:47], v[132:135]
v_mfma_f32_16x16x32_bf16 v[140:143], a[140:143], v[76:79], v[92:95]
v_mfma_f32_16x16x32_bf16 v[140:143], a[136:139], v[72:75], v[140:143]
v_mfma_f32_16x16x32_bf16 v[140:143], a[132:135], v[68:71], v[140:143]
v_mfma_f32_16x16x32_bf16 v[140:143], a[128:131], v[64:67], v[140:143]
v_mfma_f32_16x16x32_bf16 v[156:159], a[144:147], v[64:67], v[92:95]
v_mfma_f32_16x16x32_bf16 v[156:159], a[148:151], v[68:71], v[156:159]
v_mfma_f32_16x16x32_bf16 v[156:159], a[152:155], v[72:75], v[156:159]
v_mfma_f32_16x16x32_bf16 v[156:159], a[156:159], v[76:79], v[156:159]
v_mfma_f32_16x16x32_bf16 v[148:151], a[156:159], v[44:47], v[84:87]
v_mfma_f32_16x16x32_bf16 v[148:151], a[152:155], v[40:43], v[148:151]
v_mfma_f32_16x16x32_bf16 v[148:151], a[148:151], v[36:39], v[148:151]
s_waitcnt vmcnt(8) lgkmcnt(4)
v_mfma_f32_16x16x32_bf16 v[148:151], a[144:147], v[32:35], v[148:151]
s_barrier
v_mfma_f32_16x16x32_bf16 v[228:231], v[120:123], v[196:199], v[228:231]
s_xor_b32 s74, s82, 0x10000
v_exp_f32 v128, v128
v_mfma_f32_16x16x32_bf16 v[228:231], v[120:123], v[212:215], v[228:231]
s_add_u32 s74, s74, s64
ds_read_b128 a[128:131], v2 offset:16384
v_mfma_f32_16x16x32_bf16 v[236:239], v[120:123], v[204:207], v[236:239]
s_add_u32 s81, s81, 0x8000
v_exp_f32 v129, v129
v_mfma_f32_16x16x32_bf16 v[236:239], v[120:123], v[220:223], v[236:239]
s_add_u32 m0, s74, 16384
v_exp_f32 v130, v130
v_mfma_f32_16x16x32_bf16 a[32:35], a[192:195], v[196:199], a[32:35]
s_add_u32 s72, s81, 16384
ds_read_b128 a[132:135], v2 offset:17408
v_cvt_pk_bf16_f32 v192, v128, v129
v_mfma_f32_16x16x32_bf16 a[32:35], a[224:227], v[212:215], a[32:35]
v_exp_f32 v131, v131
v_mfma_f32_16x16x32_bf16 a[96:99], a[224:227], v[220:223], a[96:99]
v_exp_f32 v144, v144
v_mfma_f32_16x16x32_bf16 a[96:99], a[192:195], v[204:207], a[96:99]
ds_read_b128 a[136:139], v2 offset:18432
v_cvt_pk_bf16_f32 v193, v130, v131
v_mfma_f32_16x16x32_bf16 a[100:103], a[196:199], v[204:207], a[100:103]
buffer_load_dwordx4 v1, s[44:47], s72 offen sc1 lds
v_mfma_f32_16x16x32_bf16 a[100:103], a[228:231], v[220:223], a[100:103]
v_exp_f32 v145, v145
v_mfma_f32_16x16x32_bf16 a[36:39], a[228:231], v[212:215], a[36:39]
v_exp_f32 v146, v146
v_mfma_f32_16x16x32_bf16 a[36:39], a[196:199], v[196:199], a[36:39]
ds_read_b128 a[140:143], v2 offset:19456
v_cvt_pk_bf16_f32 v194, v144, v145
v_mfma_f32_16x16x32_bf16 a[40:43], a[200:203], v[196:199], a[40:43]
v_exp_f32 v147, v147
v_mfma_f32_16x16x32_bf16 a[40:43], a[232:235], v[212:215], a[40:43]
v_exp_f32 v136, v136
v_mfma_f32_16x16x32_bf16 a[104:107], a[232:235], v[220:223], a[104:107]
ds_read_b128 a[144:147], v2 offset:20480
v_cvt_pk_bf16_f32 v195, v146, v147
v_mfma_f32_16x16x32_bf16 a[104:107], a[200:203], v[204:207], a[104:107]
v_exp_f32 v137, v137
v_mfma_f32_16x16x32_bf16 a[108:111], a[204:207], v[204:207], a[108:111]
v_exp_f32 v138, v138
v_mfma_f32_16x16x32_bf16 a[108:111], a[236:239], v[220:223], a[108:111]
ds_read_b128 a[148:151], v2 offset:21504
v_cvt_pk_bf16_f32 v200, v136, v137
v_mfma_f32_16x16x32_bf16 a[44:47], a[236:239], v[212:215], a[44:47]
v_exp_f32 v139, v139
v_mfma_f32_16x16x32_bf16 a[44:47], a[204:207], v[196:199], a[44:47]
v_exp_f32 v152, v152
v_mfma_f32_16x16x32_bf16 a[48:51], a[208:211], v[196:199], a[48:51]
s_waitcnt lgkmcnt(6)
ds_read_b128 a[152:155], v2 offset:22528
v_cvt_pk_bf16_f32 v201, v138, v139
v_mfma_f32_16x16x32_bf16 a[48:51], a[240:243], v[212:215], a[48:51]
buffer_load_dwordx4 v1, s[44:47], s72 offen offset:1024 sc1 lds
v_mfma_f32_16x16x32_bf16 a[112:115], a[240:243], v[220:223], a[112:115]
v_exp_f32 v153, v153
v_mfma_f32_16x16x32_bf16 a[112:115], a[208:211], v[204:207], a[112:115]
v_exp_f32 v154, v154
v_mfma_f32_16x16x32_bf16 a[116:119], a[212:215], v[204:207], a[116:119]
ds_read_b128 a[156:159], v2 offset:23552
v_cvt_pk_bf16_f32 v202, v152, v153
v_mfma_f32_16x16x32_bf16 a[116:119], a[244:247], v[220:223], a[116:119]
v_exp_f32 v155, v155
v_mfma_f32_16x16x32_bf16 a[52:55], a[244:247], v[212:215], a[52:55]
v_exp_f32 v132, v132
v_mfma_f32_16x16x32_bf16 a[52:55], a[212:215], v[196:199], a[52:55]
ds_read_b128 a[192:195], v2 offset:0
v_cvt_pk_bf16_f32 v203, v154, v155
v_mfma_f32_16x16x32_bf16 a[56:59], a[216:219], v[196:199], a[56:59]
v_exp_f32 v133, v133
v_mfma_f32_16x16x32_bf16 a[56:59], a[248:251], v[212:215], a[56:59]
v_exp_f32 v134, v134
v_mfma_f32_16x16x32_bf16 a[120:123], a[248:251], v[220:223], a[120:123]
ds_read_b128 a[196:199], v2 offset:1024
v_mfma_f32_16x16x32_bf16 a[120:123], a[216:219], v[204:207], a[120:123]
v_exp_f32 v135, v135
v_mfma_f32_16x16x32_bf16 a[124:127], a[220:223], v[204:207], a[124:127]
v_exp_f32 v148, v148
v_mfma_f32_16x16x32_bf16 a[124:127], a[252:255], v[220:223], a[124:127]
ds_read_b128 a[200:203], v2 offset:2048
v_mfma_f32_16x16x32_bf16 a[60:63], a[252:255], v[212:215], a[60:63]
buffer_load_dwordx4 v1, s[44:47], s72 offen offset:2048 sc1 lds
v_mfma_f32_16x16x32_bf16 a[60:63], a[220:223], v[196:199], a[60:63]
ds_read_b128 a[204:207], v2 offset:3072
v_cvt_pk_bf16_f32 v196, v132, v133
s_cmp_eq_u32 s58, 2
s_cbranch_scc1 Lta19
s_cmp_eq_u32 s58, 3
s_cbranch_scc1 Lnt20
v_mfma_f32_16x16x32_bf16 v[160:163], a[160:163], v[16:19], v[112:115]
v_exp_f32 v149, v149
v_mfma_f32_16x16x32_bf16 v[176:179], a[176:179], v[16:19], v[112:115]
v_exp_f32 v150, v150
s_branch Ljoin21
Lta19:
v_mfma_f32_16x16x32_bf16 v[160:163], a[160:163], v[16:19], v[96:99]
v_exp_f32 v149, v149
v_mfma_f32_16x16x32_bf16 v[176:179], a[176:179], v[16:19], v[112:115]
v_exp_f32 v150, v150
s_branch Ljoin21
Lnt20:
v_mfma_f32_16x16x32_bf16 v[160:163], a[160:163], v[16:19], v[80:83]
v_exp_f32 v149, v149
v_mfma_f32_16x16x32_bf16 v[176:179], a[176:179], v[16:19], v[96:99]
v_exp_f32 v150, v150
Ljoin21:
v_mfma_f32_16x16x32_bf16 v[164:167], a[160:163], v[32:35], v[84:87]
ds_read_b128 a[208:211], v2 offset:4096
v_cvt_pk_bf16_f32 v197, v134, v135
v_mfma_f32_16x16x32_bf16 v[164:167], a[164:167], v[36:39], v[164:167]
v_exp_f32 v151, v151
v_mfma_f32_16x16x32_bf16 v[164:167], a[168:171], v[40:43], v[164:167]
v_exp_f32 v140, v140
v_mfma_f32_16x16x32_bf16 v[164:167], a[172:175], v[44:47], v[164:167]
ds_read_b128 a[212:215], v2 offset:5120
v_cvt_pk_bf16_f32 v198, v148, v149
v_mfma_f32_16x16x32_bf16 v[172:175], a[172:175], v[76:79], v[92:95]
v_exp_f32 v141, v141
v_mfma_f32_16x16x32_bf16 v[172:175], a[168:171], v[72:75], v[172:175]
v_exp_f32 v142, v142
v_mfma_f32_16x16x32_bf16 v[172:175], a[164:167], v[68:71], v[172:175]
ds_read_b128 a[216:219], v2 offset:6144
v_cvt_pk_bf16_f32 v199, v150, v151
v_mfma_f32_16x16x32_bf16 v[172:175], a[160:163], v[64:67], v[172:175]
v_exp_f32 v143, v143
v_mfma_f32_16x16x32_bf16 v[188:191], a[176:179], v[64:67], v[92:95]
v_exp_f32 v156, v156
v_mfma_f32_16x16x32_bf16 v[188:191], a[180:183], v[68:71], v[188:191]
ds_read_b128 a[220:223], v2 offset:7168
v_cvt_pk_bf16_f32 v204, v140, v141
v_mfma_f32_16x16x32_bf16 v[188:191], a[184:187], v[72:75], v[188:191]
buffer_load_dwordx4 v1, s[44:47], s72 offen offset:3072 sc1 lds
v_mfma_f32_16x16x32_bf16 v[188:191], a[188:191], v[76:79], v[188:191]
v_exp_f32 v157, v157
v_mfma_f32_16x16x32_bf16 v[180:183], a[188:191], v[44:47], v[84:87]
v_exp_f32 v158, v158
v_mfma_f32_16x16x32_bf16 v[180:183], a[184:187], v[40:43], v[180:183]
v_cvt_pk_bf16_f32 v205, v142, v143
v_cvt_pk_bf16_f32 v206, v156, v157
v_mfma_f32_16x16x32_bf16 v[180:183], a[180:183], v[36:39], v[180:183]
v_exp_f32 v159, v159
v_mfma_f32_16x16x32_bf16 v[180:183], a[176:179], v[32:35], v[180:183]
v_cvt_pk_bf16_f32 v207, v158, v159
v_mfma_f32_16x16x32_bf16 v[160:163], a[164:167], v[20:23], v[160:163]
v_mfma_f32_16x16x32_bf16 v[160:163], a[168:171], v[24:27], v[160:163]
v_mfma_f32_16x16x32_bf16 v[160:163], a[172:175], v[28:31], v[160:163]
v_mfma_f32_16x16x32_bf16 v[168:171], a[172:175], v[60:63], v[88:91]
v_mfma_f32_16x16x32_bf16 v[168:171], a[168:171], v[56:59], v[168:171]
v_mfma_f32_16x16x32_bf16 v[168:171], a[164:167], v[52:55], v[168:171]
v_mfma_f32_16x16x32_bf16 v[168:171], a[160:163], v[48:51], v[168:171]
v_mfma_f32_16x16x32_bf16 v[184:187], a[176:179], v[48:51], v[88:91]
v_mfma_f32_16x16x32_bf16 v[184:187], a[180:183], v[52:55], v[184:187]
v_mfma_f32_16x16x32_bf16 v[184:187], a[184:187], v[56:59], v[184:187]
v_mfma_f32_16x16x32_bf16 v[184:187], a[188:191], v[60:63], v[184:187]
v_mfma_f32_16x16x32_bf16 v[176:179], a[188:191], v[28:31], v[176:179]
v_mfma_f32_16x16x32_bf16 v[176:179], a[184:187], v[24:27], v[176:179]
v_mfma_f32_16x16x32_bf16 v[176:179], a[180:183], v[20:23], v[176:179]
s_waitcnt lgkmcnt(4)
v_mfma_f32_16x16x32_bf16 v[224:227], v[120:123], v[208:211], v[224:227]
s_add_u32 s82, s82, 0x8000
ds_read_b128 a[160:163], v2 offset:24576
v_mfma_f32_16x16x32_bf16 v[224:227], v[120:123], v[192:195], v[224:227]
s_and_b32 s82, s82, 0x1ffff
v_exp_f32 v164, v164
v_mfma_f32_16x16x32_bf16 v[232:235], v[120:123], v[216:219], v[232:235]
s_add_u32 m0, s74, 0
v_exp_f32 v165, v165
v_mfma_f32_16x16x32_bf16 v[232:235], v[120:123], v[200:203], v[232:235]
s_add_u32 s72, s81, 0
ds_read_b128 a[164:167], v2 offset:25600
v_cvt_pk_bf16_f32 v212, v164, v165
v_mfma_f32_16x16x32_bf16 a[0:3], a[224:227], v[208:211], a[0:3]
v_exp_f32 v166, v166
v_mfma_f32_16x16x32_bf16 a[0:3], a[192:195], v[192:195], a[0:3]
v_exp_f32 v167, v167
v_mfma_f32_16x16x32_bf16 a[64:67], a[192:195], v[200:203], a[64:67]
ds_read_b128 a[168:171], v2 offset:26624
v_cvt_pk_bf16_f32 v213, v166, v167
v_mfma_f32_16x16x32_bf16 a[64:67], a[224:227], v[216:219], a[64:67]
v_exp_f32 v180, v180
v_mfma_f32_16x16x32_bf16 a[68:71], a[228:231], v[216:219], a[68:71]
buffer_load_dwordx4 v1, s[44:47], s72 offen sc1 lds
v_mfma_f32_16x16x32_bf16 a[68:71], a[196:199], v[200:203], a[68:71]
v_exp_f32 v181, v181
v_mfma_f32_16x16x32_bf16 a[4:7], a[196:199], v[192:195], a[4:7]
ds_read_b128 a[172:175], v2 offset:27648
v_cvt_pk_bf16_f32 v214, v180, v181
v_mfma_f32_16x16x32_bf16 a[4:7], a[228:231], v[208:211], a[4:7]
v_exp_f32 v182, v182
v_mfma_f32_16x16x32_bf16 a[8:11], a[232:235], v[208:211], a[8:11]
v_exp_f32 v183, v183
v_mfma_f32_16x16x32_bf16 a[8:11], a[200:203], v[192:195], a[8:11]
ds_read_b128 a[176:179], v2 offset:28672
v_cvt_pk_bf16_f32 v215, v182, v183
v_mfma_f32_16x16x32_bf16 a[72:75], a[200:203], v[200:203], a[72:75]
v_exp_f32 v172, v172
v_mfma_f32_16x16x32_bf16 a[72:75], a[232:235], v[216:219], a[72:75]
v_exp_f32 v173, v173
v_mfma_f32_16x16x32_bf16 a[76:79], a[236:239], v[216:219], a[76:79]
ds_read_b128 a[180:183], v2 offset:29696
v_cvt_pk_bf16_f32 v220, v172, v173
v_mfma_f32_16x16x32_bf16 a[76:79], a[204:207], v[200:203], a[76:79]
v_exp_f32 v174, v174
v_mfma_f32_16x16x32_bf16 a[12:15], a[204:207], v[192:195], a[12:15]
v_exp_f32 v175, v175
v_mfma_f32_16x16x32_bf16 a[12:15], a[236:239], v[208:211], a[12:15]
ds_read_b128 a[184:187], v2 offset:30720
v_cvt_pk_bf16_f32 v221, v174, v175
v_mfma_f32_16x16x32_bf16 a[16:19], a[240:243], v[208:211], a[16:19]
s_waitcnt lgkmcnt(7)
v_exp_f32 v188, v188
v_mfma_f32_16x16x32_bf16 a[16:19], a[208:211], v[192:195], a[16:19]
buffer_load_dwordx4 v1, s[44:47], s72 offen offset:1024 sc1 lds
v_mfma_f32_16x16x32_bf16 a[80:83], a[208:211], v[200:203], a[80:83]
v_exp_f32 v189, v189
v_mfma_f32_16x16x32_bf16 a[80:83], a[240:243], v[216:219], a[80:83]
ds_read_b128 a[188:191], v2 offset:31744
v_cvt_pk_bf16_f32 v222, v188, v189
v_mfma_f32_16x16x32_bf16 a[84:87], a[244:247], v[216:219], a[84:87]
v_exp_f32 v190, v190
v_mfma_f32_16x16x32_bf16 a[84:87], a[212:215], v[200:203], a[84:87]
v_exp_f32 v191, v191
v_mfma_f32_16x16x32_bf16 a[20:23], a[212:215], v[192:195], a[20:23]
ds_read_b128 a[224:227], v2 offset:8192
v_cvt_pk_bf16_f32 v223, v190, v191
v_mfma_f32_16x16x32_bf16 a[20:23], a[244:247], v[208:211], a[20:23]
v_exp_f32 v160, v160
v_mfma_f32_16x16x32_bf16 a[24:27], a[248:251], v[208:211], a[24:27]
Lstub3:
s_cbranch_execz Lstub7
v_exp_f32 v161, v161
v_mfma_f32_16x16x32_bf16 a[24:27], a[216:219], v[192:195], a[24:27]
ds_read_b128 a[228:231], v2 offset:9216
v_mfma_f32_16x16x32_bf16 a[88:91], a[216:219], v[200:203], a[88:91]
v_exp_f32 v162, v162
v_mfma_f32_16x16x32_bf16 a[88:91], a[248:251], v[216:219], a[88:91]
v_exp_f32 v163, v163
v_mfma_f32_16x16x32_bf16 a[92:95], a[252:255], v[216:219], a[92:95]
ds_read_b128 a[232:235], v2 offset:10240
v_mfma_f32_16x16x32_bf16 a[92:95], a[220:223], v[200:203], a[92:95]
v_exp_f32 v176, v176
v_mfma_f32_16x16x32_bf16 a[28:31], a[220:223], v[192:195], a[28:31]
buffer_load_dwordx4 v1, s[44:47], s72 offen offset:2048 sc1 lds
v_mfma_f32_16x16x32_bf16 a[28:31], a[252:255], v[208:211], a[28:31]
ds_read_b128 a[236:239], v2 offset:11264
v_cvt_pk_bf16_f32 v208, v160, v161
s_cmp_eq_u32 s58, 0
s_cbranch_scc1 Lta22
s_cmp_eq_u32 s58, 1
s_cbranch_scc1 Lnt23
v_mfma_f32_16x16x32_bf16 v[132:135], a[128:131], v[32:35], v[84:87]
v_exp_f32 v177, v177
v_mfma_f32_16x16x32_bf16 v[148:151], a[144:147], v[32:35], v[84:87]
v_exp_f32 v178, v178
s_branch Ljoin24
Lta22:
v_mfma_f32_16x16x32_bf16 v[132:135], a[128:131], v[32:35], v[100:103]
v_exp_f32 v177, v177
v_mfma_f32_16x16x32_bf16 v[148:151], a[144:147], v[32:35], v[112:115]
v_exp_f32 v178, v178
s_branch Ljoin24
Lnt23:
v_mfma_f32_16x16x32_bf16 v[132:135], a[128:131], v[32:35], v[84:87]
v_exp_f32 v177, v177
v_mfma_f32_16x16x32_bf16 v[148:151], a[144:147], v[32:35], v[100:103]
v_exp_f32 v178, v178
Ljoin24:
v_mfma_f32_16x16x32_bf16 v[136:139], a[128:131], v[48:51], v[88:91]
ds_read_b128 a[240:243], v2 offset:12288
v_cvt_pk_bf16_f32 v209, v162, v163
v_mfma_f32_16x16x32_bf16 v[136:139], a[132:135], v[52:55], v[136:139]
v_exp_f32 v179, v179
v_mfma_f32_16x16x32_bf16 v[136:139], a[136:139], v[56:59], v[136:139]
v_exp_f32 v168, v168
v_mfma_f32_16x16x32_bf16 v[136:139], a[140:143], v[60:63], v[136:139]
ds_read_b128 a[244:247], v2 offset:13312
v_cvt_pk_bf16_f32 v210, v176, v177
v_mfma_f32_16x16x32_bf16 v[152:155], a[156:159], v[60:63], v[88:91]
v_exp_f32 v169, v169
v_mfma_f32_16x16x32_bf16 v[152:155], a[152:155], v[56:59], v[152:155]
v_exp_f32 v170, v170
v_mfma_f32_16x16x32_bf16 v[152:155], a[148:151], v[52:55], v[152:155]
ds_read_b128 a[248:251], v2 offset:14336
v_cvt_pk_bf16_f32 v211, v178, v179
v_mfma_f32_16x16x32_bf16 v[152:155], a[144:147], v[48:51], v[152:155]
v_exp_f32 v171, v171
v_mfma_f32_16x16x32_bf16 v[132:135], a[132:135], v[36:39], v[132:135]
v_exp_f32 v184, v184
v_mfma_f32_16x16x32_bf16 v[132:135], a[136:139], v[40:43], v[132:135]
ds_read_b128 a[252:255], v2 offset:15360
v_cvt_pk_bf16_f32 v216, v168, v169
v_mfma_f32_16x16x32_bf16 v[132:135], a[140:143], v[44:47], v[132:135]
buffer_load_dwordx4 v1, s[44:47], s72 offen offset:3072 sc1 lds
v_mfma_f32_16x16x32_bf16 v[140:143], a[140:143], v[76:79], v[92:95]
v_exp_f32 v185, v185
v_mfma_f32_16x16x32_bf16 v[140:143], a[136:139], v[72:75], v[140:143]
v_exp_f32 v186, v186
v_mfma_f32_16x16x32_bf16 v[140:143], a[132:135], v[68:71], v[140:143]
v_cvt_pk_bf16_f32 v217, v170, v171
v_cvt_pk_bf16_f32 v218, v184, v185
v_mfma_f32_16x16x32_bf16 v[140:143], a[128:131], v[64:67], v[140:143]
v_exp_f32 v187, v187
v_mfma_f32_16x16x32_bf16 v[156:159], a[144:147], v[64:67], v[92:95]
v_cvt_pk_bf16_f32 v219, v186, v187
v_add_u32 v2, s82, v1
v_mfma_f32_16x16x32_bf16 v[156:159], a[148:151], v[68:71], v[156:159]
v_mfma_f32_16x16x32_bf16 v[156:159], a[152:155], v[72:75], v[156:159]
v_mfma_f32_16x16x32_bf16 v[156:159], a[156:159], v[76:79], v[156:159]
v_mfma_f32_16x16x32_bf16 v[148:151], a[156:159], v[44:47], v[148:151]
v_mfma_f32_16x16x32_bf16 v[148:151], a[152:155], v[40:43], v[148:151]
s_waitcnt vmcnt(8) lgkmcnt(4)
v_mfma_f32_16x16x32_bf16 v[148:151], a[148:151], v[36:39], v[148:151]
s_barrier
s_cmp_eq_u32 s60, 7
s_cbranch_scc1 LLT3x
LLT3:
Lstub4:
s_cbranch_execz Lstub8
v_mfma_f32_16x16x32_bf16 v[228:231], v[120:123], v[196:199], v[228:231]
s_xor_b32 s74, s82, 0x10000
v_exp_f32 v136, v136
v_mfma_f32_16x16x32_bf16 v[228:231], v[120:123], v[212:215], v[228:231]
s_add_u32 s74, s74, s64
ds_read_b128 a[128:131], v2 offset:16384
v_and_b32 v240, 15, v0
v_mfma_f32_16x16x32_bf16 v[236:239], v[120:123], v[204:207], v[236:239]
s_add_u32 s81, s81, 0x8000
v_exp_f32 v137, v137
v_mfma_f32_16x16x32_bf16 v[236:239], v[120:123], v[220:223], v[236:239]
s_add_u32 m0, s74, 16384
ds_read_b128 a[132:135], v2 offset:17408
v_cvt_pk_bf16_f32 v200, v136, v137
v_mfma_f32_16x16x32_bf16 a[32:35], a[192:195], v[196:199], a[32:35]
s_add_u32 s72, s81, 16384
buffer_load_dwordx4 v1, s[44:47], s72 offen sc1 lds
v_mfma_f32_16x16x32_bf16 a[32:35], a[224:227], v[212:215], a[32:35]
s_add_u32 s69, s93, 0x3e00000
v_exp_f32 v138, v138
v_mfma_f32_16x16x32_bf16 a[96:99], a[224:227], v[220:223], a[96:99]
v_exp_f32 v139, v139
v_mfma_f32_16x16x32_bf16 a[96:99], a[192:195], v[204:207], a[96:99]
ds_read_b128 a[136:139], v2 offset:18432
v_cvt_pk_bf16_f32 v201, v138, v139
v_mfma_f32_16x16x32_bf16 a[100:103], a[196:199], v[204:207], a[100:103]
v_exp_f32 v152, v152
v_mfma_f32_16x16x32_bf16 a[100:103], a[228:231], v[220:223], a[100:103]
ds_read_b128 a[140:143], v2 offset:19456
v_lshrrev_b32 v241, 4, v0
v_mfma_f32_16x16x32_bf16 a[36:39], a[228:231], v[212:215], a[36:39]
buffer_store_dwordx4 v[112:115], v1, s[44:47], s69 offen sc1
v_mfma_f32_16x16x32_bf16 a[36:39], a[196:199], v[196:199], a[36:39]
v_exp_f32 v153, v153
v_mfma_f32_16x16x32_bf16 a[40:43], a[200:203], v[196:199], a[40:43]
v_exp_f32 v154, v154
v_mfma_f32_16x16x32_bf16 a[40:43], a[232:235], v[212:215], a[40:43]
ds_read_b128 a[144:147], v2 offset:20480
v_cvt_pk_bf16_f32 v202, v152, v153
v_mfma_f32_16x16x32_bf16 a[104:107], a[232:235], v[220:223], a[104:107]
v_exp_f32 v155, v155
v_mfma_f32_16x16x32_bf16 a[104:107], a[200:203], v[204:207], a[104:107]
ds_read_b128 a[148:151], v2 offset:21504
v_cvt_pk_bf16_f32 v203, v154, v155
v_mfma_f32_16x16x32_bf16 a[108:111], a[204:207], v[204:207], a[108:111]
buffer_load_dwordx4 v1, s[44:47], s72 offen offset:1024 sc1 lds
v_mfma_f32_16x16x32_bf16 a[108:111], a[236:239], v[220:223], a[108:111]
v_exp_f32 v132, v132
v_mfma_f32_16x16x32_bf16 a[44:47], a[236:239], v[212:215], a[44:47]
v_exp_f32 v133, v133
v_mfma_f32_16x16x32_bf16 a[44:47], a[204:207], v[196:199], a[44:47]
ds_read_b128 a[152:155], v2 offset:22528
v_add_u32 v248, 1, v240
v_mfma_f32_16x16x32_bf16 a[48:51], a[208:211], v[196:199], a[48:51]
s_waitcnt lgkmcnt(7)
v_exp_f32 v134, v134
v_mfma_f32_16x16x32_bf16 a[48:51], a[240:243], v[212:215], a[48:51]
ds_read_b128 a[156:159], v2 offset:23552
v_and_b32 v249, 3, v248
v_mfma_f32_16x16x32_bf16 a[112:115], a[240:243], v[220:223], a[112:115]
buffer_store_dwordx4 v[112:115], v1, s[44:47], s69 offen offset:1024 sc1
v_mfma_f32_16x16x32_bf16 a[112:115], a[208:211], v[204:207], a[112:115]
v_exp_f32 v135, v135
v_mfma_f32_16x16x32_bf16 a[116:119], a[212:215], v[204:207], a[116:119]
v_exp_f32 v148, v148
v_mfma_f32_16x16x32_bf16 a[116:119], a[244:247], v[220:223], a[116:119]
ds_read_b128 a[192:195], v2 offset:0
v_lshrrev_b32 v248, 2, v248
v_mfma_f32_16x16x32_bf16 a[52:55], a[244:247], v[212:215], a[52:55]
v_exp_f32 v149, v149
v_mfma_f32_16x16x32_bf16 a[52:55], a[212:215], v[196:199], a[52:55]
ds_read_b128 a[196:199], v2 offset:1024
v_mov_b32 v250, 0x20000
v_mfma_f32_16x16x32_bf16 a[56:59], a[216:219], v[196:199], a[56:59]
buffer_load_dwordx4 v1, s[44:47], s72 offen offset:2048 sc1 lds
v_mfma_f32_16x16x32_bf16 a[56:59], a[248:251], v[212:215], a[56:59]
v_exp_f32 v150, v150
v_mfma_f32_16x16x32_bf16 a[120:123], a[248:251], v[220:223], a[120:123]
v_exp_f32 v151, v151
v_mfma_f32_16x16x32_bf16 a[120:123], a[216:219], v[204:207], a[120:123]
ds_read_b128 a[200:203], v2 offset:2048
v_mov_b32 v252, 0x20001
v_mfma_f32_16x16x32_bf16 a[124:127], a[220:223], v[204:207], a[124:127]
v_exp_f32 v140, v140
v_mfma_f32_16x16x32_bf16 a[124:127], a[252:255], v[220:223], a[124:127]
ds_read_b128 a[204:207], v2 offset:3072
v_lshlrev_b32 v6, 3, v249
v_mfma_f32_16x16x32_bf16 a[60:63], a[252:255], v[212:215], a[60:63]
buffer_store_dwordx4 v[112:115], v1, s[44:47], s69 offen offset:2048 sc1
v_mfma_f32_16x16x32_bf16 a[60:63], a[220:223], v[196:199], a[60:63]
ds_read_b128 a[208:211], v2 offset:4096
v_cvt_pk_bf16_f32 v196, v132, v133
s_cmp_eq_u32 s58, 2
s_cbranch_scc1 Lta25
s_cmp_eq_u32 s58, 3
s_cbranch_scc1 Lnt26
v_mfma_f32_16x16x32_bf16 v[164:167], a[160:163], v[32:35], v[112:115]
ds_read_b128 a[212:215], v2 offset:5120
v_cvt_pk_bf16_f32 v197, v134, v135
v_mfma_f32_16x16x32_bf16 v[180:183], a[176:179], v[32:35], v[112:115]
ds_read_b128 a[216:219], v2 offset:6144
v_cvt_pk_bf16_f32 v198, v148, v149
s_branch Ljoin27
Lta25:
v_mfma_f32_16x16x32_bf16 v[164:167], a[160:163], v[32:35], v[100:103]
ds_read_b128 a[212:215], v2 offset:5120
v_cvt_pk_bf16_f32 v197, v134, v135
v_mfma_f32_16x16x32_bf16 v[180:183], a[176:179], v[32:35], v[112:115]
ds_read_b128 a[216:219], v2 offset:6144
v_cvt_pk_bf16_f32 v198, v148, v149
s_branch Ljoin27
Lnt26:
v_mfma_f32_16x16x32_bf16 v[164:167], a[160:163], v[32:35], v[84:87]
ds_read_b128 a[212:215], v2 offset:5120
v_cvt_pk_bf16_f32 v197, v134, v135
v_mfma_f32_16x16x32_bf16 v[180:183], a[176:179], v[32:35], v[100:103]
ds_read_b128 a[216:219], v2 offset:6144
v_cvt_pk_bf16_f32 v198, v148, v149
Ljoin27:
v_mfma_f32_16x16x32_bf16 v[164:167], a[164:167], v[36:39], v[164:167]
v_exp_f32 v141, v141
v_mfma_f32_16x16x32_bf16 v[164:167], a[168:171], v[40:43], v[164:167]
v_exp_f32 v142, v142
v_mfma_f32_16x16x32_bf16 v[164:167], a[172:175], v[44:47], v[164:167]
ds_read_b128 a[220:223], v2 offset:7168
v_cvt_pk_bf16_f32 v199, v150, v151
v_mfma_f32_16x16x32_bf16 v[172:175], a[172:175], v[76:79], v[92:95]
v_exp_f32 v143, v143
v_mfma_f32_16x16x32_bf16 v[172:175], a[168:171], v[72:75], v[172:175]
buffer_load_dwordx4 v1, s[44:47], s72 offen offset:3072 sc1 lds
v_mfma_f32_16x16x32_bf16 v[172:175], a[164:167], v[68:71], v[172:175]
v_exp_f32 v156, v156
v_mfma_f32_16x16x32_bf16 v[172:175], a[160:163], v[64:67], v[172:175]
v_cvt_pk_bf16_f32 v204, v140, v141
v_cvt_pk_bf16_f32 v205, v142, v143
v_mfma_f32_16x16x32_bf16 v[188:191], a[176:179], v[64:67], v[92:95]
v_exp_f32 v157, v157
v_mfma_f32_16x16x32_bf16 v[188:191], a[180:183], v[68:71], v[188:191]
v_exp_f32 v158, v158
v_mfma_f32_16x16x32_bf16 v[188:191], a[184:187], v[72:75], v[188:191]
buffer_store_dwordx4 v[112:115], v1, s[44:47], s69 offen offset:3072 sc1
v_mfma_f32_16x16x32_bf16 v[188:191], a[188:191], v[76:79], v[188:191]
v_exp_f32 v159, v159
v_mfma_f32_16x16x32_bf16 v[180:183], a[188:191], v[44:47], v[180:183]
v_cvt_pk_bf16_f32 v206, v156, v157
v_cvt_pk_bf16_f32 v207, v158, v159
v_mfma_f32_16x16x32_bf16 v[180:183], a[184:187], v[40:43], v[180:183]
v_lshrrev_b32 v6, v6, v252
v_and_b32 v6, 3, v6
v_mfma_f32_16x16x32_bf16 v[180:183], a[180:183], v[36:39], v[180:183]
v_cmp_ne_u32 vcc, 1, v249
v_mul_u32_u24 v6, 16640, v6
v_mfma_f32_16x16x32_bf16 v[168:171], a[160:163], v[48:51], v[88:91]
v_add_u32 v6, s92, v6
v_cndmask_b32 v6, v250, v6, vcc
v_mfma_f32_16x16x32_bf16 v[168:171], a[164:167], v[52:55], v[168:171]
v_add_u32 v253, s58, v249
v_and_b32 v253, 3, v253
v_mfma_f32_16x16x32_bf16 v[168:171], a[168:171], v[56:59], v[168:171]
v_mul_u32_u24 v253, 4160, v253
v_add_u32 v6, v6, v253
v_mfma_f32_16x16x32_bf16 v[168:171], a[172:175], v[60:63], v[168:171]
v_bfe_u32 v251, v0, 2, 2
v_lshl_add_u32 v6, v248, 3, v6
v_mfma_f32_16x16x32_bf16 v[184:187], a[188:191], v[60:63], v[88:91]
v_lshl_add_u32 v6, v241, 4, v6
v_lshlrev_b32 v5, 3, v251
v_mfma_f32_16x16x32_bf16 v[184:187], a[184:187], v[56:59], v[184:187]
v_lshrrev_b32 v5, v5, v252
v_and_b32 v5, 3, v5
v_mfma_f32_16x16x32_bf16 v[184:187], a[180:183], v[52:55], v[184:187]
v_cmp_ne_u32 vcc, 1, v251
v_mul_u32_u24 v5, 16640, v5
v_mfma_f32_16x16x32_bf16 v[184:187], a[176:179], v[48:51], v[184:187]
s_waitcnt lgkmcnt(4)
v_mfma_f32_16x16x32_bf16 v[224:227], v[120:123], v[208:211], v[224:227]
s_add_u32 s82, s82, 0x8000
ds_read_b128 a[160:163], v2 offset:24576
ds_read_b128 a[164:167], v2 offset:25600
v_mfma_f32_16x16x32_bf16 v[232:235], v[120:123], v[216:219], v[232:235]
s_and_b32 s82, s82, 0x1ffff
v_exp_f32 v164, v164
v_mfma_f32_16x16x32_bf16 v[232:235], v[120:123], v[200:203], v[232:235]
s_add_u32 m0, s74, 0
v_exp_f32 v165, v165
v_mfma_f32_16x16x32_bf16 a[0:3], a[224:227], v[208:211], a[0:3]
s_add_u32 s72, s81, 0
v_exp_f32 v166, v166
v_mfma_f32_16x16x32_bf16 a[64:67], a[192:195], v[200:203], a[64:67]
ds_read_b128 a[168:171], v2 offset:26624
v_cvt_pk_bf16_f32 v212, v164, v165
v_mfma_f32_16x16x32_bf16 a[64:67], a[224:227], v[216:219], a[64:67]
v_exp_f32 v167, v167
v_mfma_f32_16x16x32_bf16 a[68:71], a[228:231], v[216:219], a[68:71]
buffer_load_dwordx4 v1, s[44:47], s72 offen sc1 lds
v_mfma_f32_16x16x32_bf16 a[68:71], a[196:199], v[200:203], a[68:71]
v_exp_f32 v180, v180
v_mfma_f32_16x16x32_bf16 a[4:7], a[228:231], v[208:211], a[4:7]
ds_read_b128 a[172:175], v2 offset:27648
v_cvt_pk_bf16_f32 v213, v166, v167
v_mfma_f32_16x16x32_bf16 a[8:11], a[232:235], v[208:211], a[8:11]
v_exp_f32 v181, v181
v_mfma_f32_16x16x32_bf16 a[72:75], a[200:203], v[200:203], a[72:75]
ds_read_b128 a[176:179], v2 offset:28672
v_cvt_pk_bf16_f32 v214, v180, v181
v_mfma_f32_16x16x32_bf16 a[72:75], a[232:235], v[216:219], a[72:75]
v_exp_f32 v182, v182
v_mfma_f32_16x16x32_bf16 a[76:79], a[236:239], v[216:219], a[76:79]
v_exp_f32 v183, v183
v_mfma_f32_16x16x32_bf16 a[76:79], a[204:207], v[200:203], a[76:79]
ds_read_b128 a[180:183], v2 offset:29696
v_cvt_pk_bf16_f32 v215, v182, v183
v_mfma_f32_16x16x32_bf16 a[12:15], a[236:239], v[208:211], a[12:15]
v_exp_f32 v172, v172
v_mfma_f32_16x16x32_bf16 a[16:19], a[240:243], v[208:211], a[16:19]
s_waitcnt lgkmcnt(6)
ds_read_b128 a[184:187], v2 offset:30720
ds_read_b128 a[188:191], v2 offset:31744
v_mfma_f32_16x16x32_bf16 a[80:83], a[208:211], v[200:203], a[80:83]
v_exp_f32 v173, v173
v_mfma_f32_16x16x32_bf16 a[80:83], a[240:243], v[216:219], a[80:83]
buffer_load_dwordx4 v1, s[44:47], s72 offen offset:1024 sc1 lds
v_mfma_f32_16x16x32_bf16 a[84:87], a[244:247], v[216:219], a[84:87]
v_exp_f32 v174, v174
v_mfma_f32_16x16x32_bf16 a[84:87], a[212:215], v[200:203], a[84:87]
v_exp_f32 v175, v175
v_mfma_f32_16x16x32_bf16 a[20:23], a[244:247], v[208:211], a[20:23]
ds_read_b128 a[224:227], v2 offset:8192
v_cvt_pk_bf16_f32 v220, v172, v173
v_mfma_f32_16x16x32_bf16 a[24:27], a[248:251], v[208:211], a[24:27]
v_exp_f32 v188, v188
v_mfma_f32_16x16x32_bf16 a[88:91], a[216:219], v[200:203], a[88:91]
v_exp_f32 v189, v189
v_mfma_f32_16x16x32_bf16 a[88:91], a[248:251], v[216:219], a[88:91]
ds_read_b128 a[228:231], v2 offset:9216
v_cvt_pk_bf16_f32 v221, v174, v175
v_mfma_f32_16x16x32_bf16 a[92:95], a[252:255], v[216:219], a[92:95]
v_exp_f32 v190, v190
v_mfma_f32_16x16x32_bf16 a[92:95], a[220:223], v[200:203], a[92:95]
ds_read_b128 a[232:235], v2 offset:10240
v_cvt_pk_bf16_f32 v222, v188, v189
v_mfma_f32_16x16x32_bf16 a[28:31], a[252:255], v[208:211], a[28:31]
v_exp_f32 v191, v191
v_mfma_f32_16x16x32_bf16 v[136:139], a[128:131], v[48:51], v[88:91]
buffer_load_dwordx4 v1, s[44:47], s72 offen offset:2048 sc1 lds
v_mfma_f32_16x16x32_bf16 v[136:139], a[132:135], v[52:55], v[136:139]
v_exp_f32 v168, v168
v_mfma_f32_16x16x32_bf16 v[136:139], a[136:139], v[56:59], v[136:139]
ds_read_b128 a[236:239], v2 offset:11264
v_cvt_pk_bf16_f32 v223, v190, v191
v_mfma_f32_16x16x32_bf16 v[136:139], a[140:143], v[60:63], v[136:139]
v_exp_f32 v169, v169
v_mfma_f32_16x16x32_bf16 v[152:155], a[156:159], v[60:63], v[88:91]
ds_read_b128 a[240:243], v2 offset:12288
v_cvt_pk_bf16_f32 v216, v168, v169
v_mfma_f32_16x16x32_bf16 v[152:155], a[152:155], v[56:59], v[152:155]
v_exp_f32 v170, v170
v_mfma_f32_16x16x32_bf16 v[152:155], a[148:151], v[52:55], v[152:155]
v_exp_f32 v171, v171
v_mfma_f32_16x16x32_bf16 v[152:155], a[144:147], v[48:51], v[152:155]
ds_read_b128 a[244:247], v2 offset:13312
v_cvt_pk_bf16_f32 v217, v170, v171
v_mfma_f32_16x16x32_bf16 v[140:143], a[128:131], v[64:67], v[92:95]
v_exp_f32 v184, v184
v_mfma_f32_16x16x32_bf16 v[140:143], a[132:135], v[68:71], v[140:143]
ds_read_b128 a[248:251], v2 offset:14336
v_mfma_f32_16x16x32_bf16 v[140:143], a[136:139], v[72:75], v[140:143]
v_exp_f32 v185, v185
v_mfma_f32_16x16x32_bf16 v[140:143], a[140:143], v[76:79], v[140:143]
buffer_load_dwordx4 v1, s[44:47], s72 offen offset:3072 sc1 lds
v_mfma_f32_16x16x32_bf16 v[156:159], a[156:159], v[76:79], v[92:95]
ds_read_b128 a[252:255], v2 offset:15360
v_cvt_pk_bf16_f32 v218, v184, v185
v_mfma_f32_16x16x32_bf16 v[156:159], a[152:155], v[72:75], v[156:159]
v_exp_f32 v186, v186
v_mfma_f32_16x16x32_bf16 v[156:159], a[148:151], v[68:71], v[156:159]
s_waitcnt vmcnt(12) lgkmcnt(4)
v_exp_f32 v187, v187
v_mfma_f32_16x16x32_bf16 v[156:159], a[144:147], v[64:67], v[156:159]
s_barrier
v_cvt_pk_bf16_f32 v219, v186, v187
v_add_u32 v2, s82, v1
v_mfma_f32_16x16x32_bf16 v[228:231], v[120:123], v[196:199], v[228:231]
s_xor_b32 s74, s82, 0x10000
v_exp_f32 v136, v136
v_mfma_f32_16x16x32_bf16 v[228:231], v[120:123], v[212:215], v[228:231]
s_add_u32 s74, s74, s64
ds_read_b128 a[128:131], v2 offset:16384
v_add_u32 v5, s92, v5
v_mfma_f32_16x16x32_bf16 v[236:239], v[120:123], v[204:207], v[236:239]
s_add_u32 s81, s81, 0x8000
v_exp_f32 v137, v137
v_mfma_f32_16x16x32_bf16 v[236:239], v[120:123], v[220:223], v[236:239]
s_add_u32 m0, s74, 16384
ds_read_b128 a[132:135], v2 offset:17408
v_cvt_pk_bf16_f32 v200, v136, v137
v_mfma_f32_16x16x32_bf16 a[32:35], a[192:195], v[196:199], a[32:35]
s_add_u32 s72, s81, 16384
buffer_load_dwordx4 v1, s[44:47], s72 offen sc1 lds
v_mfma_f32_16x16x32_bf16 a[32:35], a[224:227], v[212:215], a[32:35]
s_add_u32 s69, s93, 0x4200000
v_exp_f32 v138, v138
v_mfma_f32_16x16x32_bf16 a[96:99], a[224:227], v[220:223], a[96:99]
ds_read_b128 a[136:139], v2 offset:18432
v_cndmask_b32 v5, v250, v5, vcc
v_mfma_f32_16x16x32_bf16 a[96:99], a[192:195], v[204:207], a[96:99]
v_exp_f32 v139, v139
v_mfma_f32_16x16x32_bf16 a[100:103], a[196:199], v[204:207], a[100:103]
ds_read_b128 a[140:143], v2 offset:19456
v_cvt_pk_bf16_f32 v201, v138, v139
v_mfma_f32_16x16x32_bf16 a[100:103], a[228:231], v[220:223], a[100:103]
buffer_store_dwordx4 v[112:115], v1, s[44:47], s69 offen sc1
v_mfma_f32_16x16x32_bf16 a[36:39], a[228:231], v[212:215], a[36:39]
v_exp_f32 v152, v152
v_mfma_f32_16x16x32_bf16 a[36:39], a[196:199], v[196:199], a[36:39]
ds_read_b128 a[144:147], v2 offset:20480
v_add_u32 v253, s58, v251
v_mfma_f32_16x16x32_bf16 a[40:43], a[200:203], v[196:199], a[40:43]
v_exp_f32 v153, v153
v_mfma_f32_16x16x32_bf16 a[40:43], a[232:235], v[212:215], a[40:43]
ds_read_b128 a[148:151], v2 offset:21504
v_cvt_pk_bf16_f32 v202, v152, v153
v_mfma_f32_16x16x32_bf16 a[104:107], a[232:235], v[220:223], a[104:107]
buffer_load_dwordx4 v1, s[44:47], s72 offen offset:1024 sc1 lds
v_mfma_f32_16x16x32_bf16 a[104:107], a[200:203], v[204:207], a[104:107]
v_exp_f32 v154, v154
v_mfma_f32_16x16x32_bf16 a[108:111], a[204:207], v[204:207], a[108:111]
ds_read_b128 a[152:155], v2 offset:22528
v_and_b32 v253, 3, v253
v_mfma_f32_16x16x32_bf16 a[108:111], a[236:239], v[220:223], a[108:111]
v_exp_f32 v155, v155
v_mfma_f32_16x16x32_bf16 a[44:47], a[236:239], v[212:215], a[44:47]
ds_read_b128 a[156:159], v2 offset:23552
v_cvt_pk_bf16_f32 v203, v154, v155
v_mfma_f32_16x16x32_bf16 a[44:47], a[204:207], v[196:199], a[44:47]
buffer_store_dwordx4 v[112:115], v1, s[44:47], s69 offen offset:1024 sc1
v_mfma_f32_16x16x32_bf16 a[48:51], a[208:211], v[196:199], a[48:51]
s_waitcnt lgkmcnt(8)
v_exp_f32 v140, v140
v_mfma_f32_16x16x32_bf16 a[48:51], a[240:243], v[212:215], a[48:51]
ds_read_b128 a[192:195], v2 offset:0
v_mul_u32_u24 v253, 4160, v253
v_mfma_f32_16x16x32_bf16 a[112:115], a[240:243], v[220:223], a[112:115]
v_exp_f32 v141, v141
v_mfma_f32_16x16x32_bf16 a[112:115], a[208:211], v[204:207], a[112:115]
ds_read_b128 a[196:199], v2 offset:1024
v_add_u32 v5, v5, v253
v_mfma_f32_16x16x32_bf16 a[116:119], a[212:215], v[204:207], a[116:119]
s_add_u32 s73, s62, 480
buffer_load_dwordx4 v1, s[44:47], s72 offen offset:2048 sc1 lds
v_mfma_f32_16x16x32_bf16 a[116:119], a[244:247], v[220:223], a[116:119]
v_exp_f32 v142, v142
v_mfma_f32_16x16x32_bf16 a[52:55], a[244:247], v[212:215], a[52:55]
ds_read_b128 a[200:203], v2 offset:2048
v_lshlrev_b32 v248, 5, v240
v_mfma_f32_16x16x32_bf16 a[52:55], a[212:215], v[196:199], a[52:55]
v_exp_f32 v143, v143
v_mfma_f32_16x16x32_bf16 a[56:59], a[216:219], v[196:199], a[56:59]
ds_read_b128 a[204:207], v2 offset:3072
v_sub_u32 v248, s73, v248
v_mfma_f32_16x16x32_bf16 a[56:59], a[248:251], v[212:215], a[56:59]
buffer_store_dwordx4 v[112:115], v1, s[44:47], s69 offen offset:2048 sc1
v_mfma_f32_16x16x32_bf16 a[120:123], a[248:251], v[220:223], a[120:123]
v_exp_f32 v156, v156
v_mfma_f32_16x16x32_bf16 a[120:123], a[216:219], v[204:207], a[120:123]
ds_read_b128 a[208:211], v2 offset:4096
v_lshl_add_u32 v7, v241, 4, v248
v_mfma_f32_16x16x32_bf16 a[124:127], a[220:223], v[204:207], a[124:127]
s_and_b32 s73, s58, 1
v_exp_f32 v157, v157
v_mfma_f32_16x16x32_bf16 a[124:127], a[252:255], v[220:223], a[124:127]
s_lshl_b32 s73, s73, 4
ds_read_b128 a[212:215], v2 offset:5120
v_mfma_f32_16x16x32_bf16 a[60:63], a[252:255], v[212:215], a[60:63]
s_lshr_b32 s73, s90, s73
buffer_load_dwordx4 v1, s[44:47], s72 offen offset:3072 sc1 lds
v_mfma_f32_16x16x32_bf16 a[60:63], a[220:223], v[196:199], a[60:63]
s_and_b32 s73, s73, 0xffff
ds_read_b128 a[216:219], v2 offset:6144
v_cvt_pk_bf16_f32 v204, v140, v141
v_mfma_f32_16x16x32_bf16 v[172:175], a[160:163], v[64:67], v[92:95]
v_exp_f32 v158, v158
v_mfma_f32_16x16x32_bf16 v[172:175], a[164:167], v[68:71], v[172:175]
ds_read_b128 a[220:223], v2 offset:7168
v_cvt_pk_bf16_f32 v205, v142, v143
v_mfma_f32_16x16x32_bf16 v[172:175], a[168:171], v[72:75], v[172:175]
v_exp_f32 v159, v159
v_mfma_f32_16x16x32_bf16 v[172:175], a[172:175], v[76:79], v[172:175]
buffer_store_dwordx4 v[112:115], v1, s[44:47], s69 offen offset:3072 sc1
v_mfma_f32_16x16x32_bf16 v[188:191], a[188:191], v[76:79], v[92:95]
v_cvt_pk_bf16_f32 v206, v156, v157
v_cvt_pk_bf16_f32 v207, v158, v159
v_mfma_f32_16x16x32_bf16 v[188:191], a[184:187], v[72:75], v[188:191]
v_lshl_add_u32 v248, v241, 3, v240
v_sub_u32 v248, 15, v248
v_mfma_f32_16x16x32_bf16 v[188:191], a[180:183], v[68:71], v[188:191]
v_and_b32 v249, 1, v248
v_lshlrev_b32 v249, 4, v249
v_mfma_f32_16x16x32_bf16 v[188:191], a[176:179], v[64:67], v[188:191]
v_lshlrev_b32 v249, v249, s73
v_lshrrev_b32 v248, 1, v248
v_mfma_f32_16x16x32_bf16 v[168:171], a[160:163], v[48:51], v[88:91]
v_and_b32 v241, 3, v0
v_cmp_eq_u32 vcc, 0, v248
v_mfma_f32_16x16x32_bf16 v[168:171], a[164:167], v[52:55], v[168:171]
v_lshl_add_u32 v5, v241, 3, v5
v_cndmask_b32 v8, 0, v249, vcc
v_mfma_f32_16x16x32_bf16 v[168:171], a[168:171], v[56:59], v[168:171]
v_cmp_eq_u32 vcc, 1, v248
v_lshlrev_b32 v240, 4, v251
v_mfma_f32_16x16x32_bf16 v[168:171], a[172:175], v[60:63], v[168:171]
v_cndmask_b32 v9, 0, v249, vcc
v_cmp_eq_u32 vcc, 2, v248
v_mfma_f32_16x16x32_bf16 v[184:187], a[188:191], v[60:63], v[88:91]
v_sub_u32 v240, 48, v240
v_lshlrev_b64 v[12:13], 16, s[88:89]
v_mfma_f32_16x16x32_bf16 v[184:187], a[184:187], v[56:59], v[184:187]
v_cndmask_b32 v10, 0, v249, vcc
v_cmp_eq_u32 vcc, 3, v248
v_mfma_f32_16x16x32_bf16 v[184:187], a[180:183], v[52:55], v[184:187]
v_lshlrev_b64 v[12:13], v240, v[12:13]
v_cndmask_b32 v11, 0, v249, vcc
v_mfma_f32_16x16x32_bf16 v[184:187], a[176:179], v[48:51], v[184:187]
s_waitcnt lgkmcnt(4)
v_cmp_eq_u32 vcc, 3, v241
s_add_u32 s73, s62, 4096
v_lshl_add_u32 v14, v0, 3, s73
v_cndmask_b32 v12, 0, v12, vcc
v_cndmask_b32 v13, 0, v13, vcc
v_lshrrev_b32 v15, 4, v0
v_lshlrev_b32 v15, 1, v15
v_and_b32 v240, 7, v0
v_xor_b32 v15, v15, v240
v_lshlrev_b32 v15, 4, v15
v_lshrrev_b32 v240, 3, v0
v_lshl_add_u32 v15, v240, 11, v15
s_lshr_b32 s75, s59, 1
s_and_b32 s75, s75, 8
s_add_u32 s75, s75, s60
s_lshl_b32 s76, s65, 2
s_lshr_b32 s80, s59, 2
s_and_b32 s80, s80, 3
s_add_u32 s76, s76, s80
s_lshl_b32 s94, s58, 16
s_lshl_b32 s80, s76, 7
s_add_u32 s94, s94, s80
s_lshl_b32 s80, s75, 18
s_add_u32 s80, s80, s94
v_rcp_f32 v224, v224
v_rcp_f32 v228, v228
s_lshl_b32 s73, s52, 12
s_add_u32 s73, s73, 0x2000000
s_lshl_b32 s70, s67, 2
s_add_u32 s70, s70, s73
v_mov_b32 v225, v224
v_accvgpr_read_b32 v240, a0
v_accvgpr_read_b32 v241, a1
v_accvgpr_read_b32 v242, a2
v_accvgpr_read_b32 v243, a3
v_accvgpr_read_b32 v244, a4
v_accvgpr_read_b32 v245, a5
v_accvgpr_read_b32 v246, a6
v_accvgpr_read_b32 v247, a7
v_pk_mul_f32 v[240:241], v[240:241], v[224:225]
v_pk_mul_f32 v[242:243], v[242:243], v[224:225]
v_pk_mul_f32 v[244:245], v[244:245], v[224:225]
v_pk_mul_f32 v[246:247], v[246:247], v[224:225]
v_cvt_pk_bf16_f32 v128, v240, v241
v_cvt_pk_bf16_f32 v129, v242, v243
v_cvt_pk_bf16_f32 v130, v244, v245
v_cvt_pk_bf16_f32 v131, v246, v247
v_accvgpr_read_b32 v248, a8
v_accvgpr_read_b32 v249, a9
v_accvgpr_read_b32 v250, a10
v_accvgpr_read_b32 v251, a11
v_accvgpr_read_b32 v252, a12
v_accvgpr_read_b32 v253, a13
v_accvgpr_read_b32 v254, a14
v_accvgpr_read_b32 v255, a15
v_pk_mul_f32 v[248:249], v[248:249], v[224:225]
v_pk_mul_f32 v[250:251], v[250:251], v[224:225]
v_pk_mul_f32 v[252:253], v[252:253], v[224:225]
v_pk_mul_f32 v[254:255], v[254:255], v[224:225]
v_cvt_pk_bf16_f32 v144, v248, v249
v_cvt_pk_bf16_f32 v145, v250, v251
v_cvt_pk_bf16_f32 v146, v252, v253
v_cvt_pk_bf16_f32 v147, v254, v255
v_accvgpr_read_b32 v240, a16
v_accvgpr_read_b32 v241, a17
v_accvgpr_read_b32 v242, a18
v_accvgpr_read_b32 v243, a19
v_accvgpr_read_b32 v244, a20
v_accvgpr_read_b32 v245, a21
v_accvgpr_read_b32 v246, a22
v_accvgpr_read_b32 v247, a23
v_pk_mul_f32 v[240:241], v[240:241], v[224:225]
v_pk_mul_f32 v[242:243], v[242:243], v[224:225]
v_pk_mul_f32 v[244:245], v[244:245], v[224:225]
v_pk_mul_f32 v[246:247], v[246:247], v[224:225]
v_cvt_pk_bf16_f32 v160, v240, v241
v_cvt_pk_bf16_f32 v161, v242, v243
v_cvt_pk_bf16_f32 v162, v244, v245
v_cvt_pk_bf16_f32 v163, v246, v247
v_accvgpr_read_b32 v248, a24
v_accvgpr_read_b32 v249, a25
v_accvgpr_read_b32 v250, a26
v_accvgpr_read_b32 v251, a27
v_accvgpr_read_b32 v252, a28
v_accvgpr_read_b32 v253, a29
v_accvgpr_read_b32 v254, a30
v_accvgpr_read_b32 v255, a31
v_pk_mul_f32 v[248:249], v[248:249], v[224:225]
v_pk_mul_f32 v[250:251], v[250:251], v[224:225]
v_pk_mul_f32 v[252:253], v[252:253], v[224:225]
v_pk_mul_f32 v[254:255], v[254:255], v[224:225]
v_cvt_pk_bf16_f32 v176, v248, v249
v_cvt_pk_bf16_f32 v177, v250, v251
v_cvt_pk_bf16_f32 v178, v252, v253
v_cvt_pk_bf16_f32 v179, v254, v255
v_mov_b32 v229, v228
v_accvgpr_read_b32 v240, a32
v_accvgpr_read_b32 v241, a33
v_accvgpr_read_b32 v242, a34
v_accvgpr_read_b32 v243, a35
v_accvgpr_read_b32 v244, a36
v_accvgpr_read_b32 v245, a37
v_accvgpr_read_b32 v246, a38
v_accvgpr_read_b32 v247, a39
v_pk_mul_f32 v[240:241], v[240:241], v[228:229]
Lstub5:
s_cbranch_execz Lstub9
v_pk_mul_f32 v[242:243], v[242:243], v[228:229]
v_pk_mul_f32 v[244:245], v[244:245], v[228:229]
v_pk_mul_f32 v[246:247], v[246:247], v[228:229]
v_cvt_pk_bf16_f32 v132, v240, v241
v_cvt_pk_bf16_f32 v133, v242, v243
v_cvt_pk_bf16_f32 v134, v244, v245
v_cvt_pk_bf16_f32 v135, v246, v247
v_accvgpr_read_b32 v248, a40
v_accvgpr_read_b32 v249, a41
v_accvgpr_read_b32 v250, a42
v_accvgpr_read_b32 v251, a43
v_accvgpr_read_b32 v252, a44
v_accvgpr_read_b32 v253, a45
v_accvgpr_read_b32 v254, a46
v_accvgpr_read_b32 v255, a47
v_pk_mul_f32 v[248:249], v[248:249], v[228:229]
v_pk_mul_f32 v[250:251], v[250:251], v[228:229]
v_pk_mul_f32 v[252:253], v[252:253], v[228:229]
v_pk_mul_f32 v[254:255], v[254:255], v[228:229]
v_cvt_pk_bf16_f32 v148, v248, v249
v_cvt_pk_bf16_f32 v149, v250, v251
v_cvt_pk_bf16_f32 v150, v252, v253
v_cvt_pk_bf16_f32 v151, v254, v255
v_accvgpr_read_b32 v240, a48
v_accvgpr_read_b32 v241, a49
v_accvgpr_read_b32 v242, a50
v_accvgpr_read_b32 v243, a51
v_accvgpr_read_b32 v244, a52
v_accvgpr_read_b32 v245, a53
v_accvgpr_read_b32 v246, a54
v_accvgpr_read_b32 v247, a55
v_pk_mul_f32 v[240:241], v[240:241], v[228:229]
v_pk_mul_f32 v[242:243], v[242:243], v[228:229]
v_pk_mul_f32 v[244:245], v[244:245], v[228:229]
v_pk_mul_f32 v[246:247], v[246:247], v[228:229]
v_cvt_pk_bf16_f32 v164, v240, v241
v_cvt_pk_bf16_f32 v165, v242, v243
v_cvt_pk_bf16_f32 v166, v244, v245
v_cvt_pk_bf16_f32 v167, v246, v247
v_accvgpr_read_b32 v248, a56
v_accvgpr_read_b32 v249, a57
v_accvgpr_read_b32 v250, a58
v_accvgpr_read_b32 v251, a59
v_accvgpr_read_b32 v252, a60
v_accvgpr_read_b32 v253, a61
v_accvgpr_read_b32 v254, a62
v_accvgpr_read_b32 v255, a63
v_pk_mul_f32 v[248:249], v[248:249], v[228:229]
v_pk_mul_f32 v[250:251], v[250:251], v[228:229]
v_pk_mul_f32 v[252:253], v[252:253], v[228:229]
v_pk_mul_f32 v[254:255], v[254:255], v[228:229]
v_cvt_pk_bf16_f32 v180, v248, v249
v_cvt_pk_bf16_f32 v181, v250, v251
v_cvt_pk_bf16_f32 v182, v252, v253
v_cvt_pk_bf16_f32 v183, v254, v255
v_mfma_f32_16x16x32_bf16 v[232:235], v[120:123], v[216:219], v[232:235]
s_add_u32 s82, s82, 0x8000
ds_read_b128 a[160:163], v2 offset:24576
ds_read_b128 a[164:167], v2 offset:25600
v_mfma_f32_16x16x32_bf16 v[232:235], v[120:123], v[200:203], v[232:235]
s_and_b32 s82, s82, 0x1ffff
v_exp_f32 v172, v172
v_mfma_f32_16x16x32_bf16 a[64:67], a[224:227], v[216:219], a[64:67]
s_add_u32 m0, s74, 0
v_exp_f32 v173, v173
v_mfma_f32_16x16x32_bf16 a[64:67], a[192:195], v[200:203], a[64:67]
s_add_u32 s72, s81, 0
buffer_load_dwordx4 v1, s[44:47], s72 offen sc1 lds
v_mfma_f32_16x16x32_bf16 a[68:71], a[196:199], v[200:203], a[68:71]
ds_read_b128 a[168:171], v2 offset:26624
v_cvt_pk_bf16_f32 v220, v172, v173
v_mfma_f32_16x16x32_bf16 a[68:71], a[228:231], v[216:219], a[68:71]
v_exp_f32 v174, v174
v_mfma_f32_16x16x32_bf16 a[72:75], a[232:235], v[216:219], a[72:75]
s_nop 0
ds_read_b128 a[172:175], v2 offset:27648
ds_read_b128 a[176:179], v2 offset:28672
v_mfma_f32_16x16x32_bf16 a[72:75], a[200:203], v[200:203], a[72:75]
v_exp_f32 v175, v175
v_mfma_f32_16x16x32_bf16 a[76:79], a[204:207], v[200:203], a[76:79]
v_exp_f32 v188, v188
v_mfma_f32_16x16x32_bf16 a[76:79], a[236:239], v[216:219], a[76:79]
buffer_store_dwordx4 v[128:131], v1, s[44:47], s70 offen sc1
v_mfma_f32_16x16x32_bf16 a[80:83], a[240:243], v[216:219], a[80:83]
s_waitcnt lgkmcnt(5)
ds_read_b128 a[180:183], v2 offset:29696
v_cvt_pk_bf16_f32 v221, v174, v175
v_mfma_f32_16x16x32_bf16 a[80:83], a[208:211], v[200:203], a[80:83]
v_exp_f32 v189, v189
v_mfma_f32_16x16x32_bf16 a[84:87], a[212:215], v[200:203], a[84:87]
ds_read_b128 a[184:187], v2 offset:30720
v_cvt_pk_bf16_f32 v222, v188, v189
v_mfma_f32_16x16x32_bf16 a[84:87], a[244:247], v[216:219], a[84:87]
v_exp_f32 v190, v190
v_mfma_f32_16x16x32_bf16 a[88:91], a[248:251], v[216:219], a[88:91]
buffer_load_dwordx4 v1, s[44:47], s72 offen offset:1024 sc1 lds
v_mfma_f32_16x16x32_bf16 a[88:91], a[216:219], v[200:203], a[88:91]
s_nop 0
ds_read_b128 a[188:191], v2 offset:31744
ds_read_b128 a[224:227], v2 offset:8192
v_mfma_f32_16x16x32_bf16 a[92:95], a[220:223], v[200:203], a[92:95]
v_exp_f32 v191, v191
v_mfma_f32_16x16x32_bf16 a[92:95], a[252:255], v[216:219], a[92:95]
v_exp_f32 v168, v168
v_mfma_f32_16x16x32_bf16 v[136:139], a[128:131], v[48:51], v[88:91]
ds_read_b128 a[228:231], v2 offset:9216
v_cvt_pk_bf16_f32 v223, v190, v191
v_mfma_f32_16x16x32_bf16 v[136:139], a[132:135], v[52:55], v[136:139]
v_exp_f32 v169, v169
v_mfma_f32_16x16x32_bf16 v[136:139], a[136:139], v[56:59], v[136:139]
buffer_store_dwordx4 v[144:147], v1, s[44:47], s70 offen offset:1024 sc1
v_mfma_f32_16x16x32_bf16 v[136:139], a[140:143], v[60:63], v[136:139]
ds_read_b128 a[232:235], v2 offset:10240
v_cvt_pk_bf16_f32 v216, v168, v169
v_mfma_f32_16x16x32_bf16 v[152:155], a[156:159], v[60:63], v[88:91]
v_exp_f32 v170, v170
v_mfma_f32_16x16x32_bf16 v[152:155], a[152:155], v[56:59], v[152:155]
s_nop 0
ds_read_b128 a[236:239], v2 offset:11264
ds_read_b128 a[240:243], v2 offset:12288
v_mfma_f32_16x16x32_bf16 v[152:155], a[148:151], v[52:55], v[152:155]
v_exp_f32 v171, v171
v_mfma_f32_16x16x32_bf16 v[152:155], a[144:147], v[48:51], v[152:155]
buffer_load_dwordx4 v1, s[44:47], s72 offen offset:2048 sc1 lds
v_mfma_f32_16x16x32_bf16 v[140:143], a[128:131], v[64:67], v[92:95]
v_exp_f32 v184, v184
v_mfma_f32_16x16x32_bf16 v[140:143], a[132:135], v[68:71], v[140:143]
ds_read_b128 a[244:247], v2 offset:13312
v_cvt_pk_bf16_f32 v217, v170, v171
v_mfma_f32_16x16x32_bf16 v[140:143], a[136:139], v[72:75], v[140:143]
v_exp_f32 v185, v185
v_mfma_f32_16x16x32_bf16 v[140:143], a[140:143], v[76:79], v[140:143]
s_nop 0
ds_read_b128 a[248:251], v2 offset:14336
ds_read_b128 a[252:255], v2 offset:15360
v_mfma_f32_16x16x32_bf16 v[156:159], a[156:159], v[76:79], v[92:95]
v_exp_f32 v186, v186
v_mfma_f32_16x16x32_bf16 v[156:159], a[152:155], v[72:75], v[156:159]
buffer_load_dwordx4 v1, s[44:47], s72 offen offset:3072 sc1 lds
v_mfma_f32_16x16x32_bf16 v[156:159], a[148:151], v[68:71], v[156:159]
s_waitcnt vmcnt(14) lgkmcnt(4)
v_exp_f32 v187, v187
v_mfma_f32_16x16x32_bf16 v[156:159], a[144:147], v[64:67], v[156:159]
s_barrier
v_cvt_pk_bf16_f32 v218, v184, v185
v_cvt_pk_bf16_f32 v219, v186, v187
v_add_u32 v2, s82, v1
v_mfma_f32_16x16x32_bf16 v[236:239], v[120:123], v[204:207], v[236:239]
s_xor_b32 s74, s82, 0x10000
v_exp_f32 v136, v136
v_mfma_f32_16x16x32_bf16 v[236:239], v[120:123], v[220:223], v[236:239]
s_add_u32 s74, s74, s64
ds_read_b128 a[128:131], v2 offset:16384
ds_read_b128 a[132:135], v2 offset:17408
v_mfma_f32_16x16x32_bf16 a[96:99], a[192:195], v[204:207], a[96:99]
s_add_u32 s81, s81, 0x8000
v_exp_f32 v137, v137
v_mfma_f32_16x16x32_bf16 a[96:99], a[224:227], v[220:223], a[96:99]
s_add_u32 m0, s74, 16384
v_exp_f32 v138, v138
v_mfma_f32_16x16x32_bf16 a[100:103], a[228:231], v[220:223], a[100:103]
s_add_u32 s72, s81, 16384
buffer_load_dwordx4 v1, s[44:47], s72 offen sc1 lds
v_mfma_f32_16x16x32_bf16 a[100:103], a[196:199], v[204:207], a[100:103]
ds_read_b128 a[136:139], v2 offset:18432
v_cvt_pk_bf16_f32 v200, v136, v137
v_mfma_f32_16x16x32_bf16 a[104:107], a[200:203], v[204:207], a[104:107]
v_exp_f32 v139, v139
v_mfma_f32_16x16x32_bf16 a[104:107], a[232:235], v[220:223], a[104:107]
ds_read_b128 a[140:143], v2 offset:19456
v_cvt_pk_bf16_f32 v201, v138, v139
v_mfma_f32_16x16x32_bf16 a[108:111], a[236:239], v[220:223], a[108:111]
buffer_store_dwordx4 v[160:163], v1, s[44:47], s70 offen offset:2048 sc1
v_mfma_f32_16x16x32_bf16 a[108:111], a[204:207], v[204:207], a[108:111]
v_exp_f32 v152, v152
v_mfma_f32_16x16x32_bf16 a[112:115], a[208:211], v[204:207], a[112:115]
s_waitcnt lgkmcnt(4)
ds_read_b128 a[144:147], v2 offset:20480
ds_read_b128 a[148:151], v2 offset:21504
v_mfma_f32_16x16x32_bf16 a[112:115], a[240:243], v[220:223], a[112:115]
v_exp_f32 v153, v153
v_mfma_f32_16x16x32_bf16 a[116:119], a[244:247], v[220:223], a[116:119]
buffer_load_dwordx4 v1, s[44:47], s72 offen offset:1024 sc1 lds
v_mfma_f32_16x16x32_bf16 a[116:119], a[212:215], v[204:207], a[116:119]
v_exp_f32 v154, v154
v_mfma_f32_16x16x32_bf16 a[120:123], a[216:219], v[204:207], a[120:123]
ds_read_b128 a[152:155], v2 offset:22528
v_cvt_pk_bf16_f32 v202, v152, v153
v_mfma_f32_16x16x32_bf16 a[120:123], a[248:251], v[220:223], a[120:123]
v_exp_f32 v155, v155
v_mfma_f32_16x16x32_bf16 a[124:127], a[252:255], v[220:223], a[124:127]
ds_read_b128 a[156:159], v2 offset:23552
v_cvt_pk_bf16_f32 v203, v154, v155
v_mfma_f32_16x16x32_bf16 a[124:127], a[220:223], v[204:207], a[124:127]
v_exp_f32 v140, v140
v_mfma_f32_16x16x32_bf16 v[172:175], a[160:163], v[64:67], v[92:95]
s_nop 0
ds_read_b128 a[192:195], v2 offset:0
ds_read_b128 a[196:199], v2 offset:1024
v_mfma_f32_16x16x32_bf16 v[172:175], a[164:167], v[68:71], v[172:175]
buffer_store_dwordx4 v[176:179], v1, s[44:47], s70 offen offset:3072 sc1
v_mfma_f32_16x16x32_bf16 v[172:175], a[168:171], v[72:75], v[172:175]
v_exp_f32 v141, v141
v_mfma_f32_16x16x32_bf16 v[172:175], a[172:175], v[76:79], v[172:175]
v_exp_f32 v142, v142
v_mfma_f32_16x16x32_bf16 v[188:191], a[188:191], v[76:79], v[92:95]
s_nop 0
ds_read_b128 a[200:203], v2 offset:2048
ds_read_b128 a[204:207], v2 offset:3072
v_mfma_f32_16x16x32_bf16 v[188:191], a[184:187], v[72:75], v[188:191]
buffer_load_dwordx4 v1, s[44:47], s72 offen offset:2048 sc1 lds
v_mfma_f32_16x16x32_bf16 v[188:191], a[180:183], v[68:71], v[188:191]
s_add_u32 s70, s70, 0x80000
v_exp_f32 v143, v143
v_mfma_f32_16x16x32_bf16 v[188:191], a[176:179], v[64:67], v[188:191]
v_exp_f32 v156, v156
v_mfma_f32_16x16x32_bf16 v[168:171], a[160:163], v[48:51], v[88:91]
s_nop 0
ds_read_b128 a[208:211], v2 offset:4096
ds_read_b128 a[212:215], v2 offset:5120
v_mfma_f32_16x16x32_bf16 v[168:171], a[164:167], v[52:55], v[168:171]
s_nop 0
ds_read_b128 a[216:219], v2 offset:6144
ds_read_b128 a[220:223], v2 offset:7168
v_mfma_f32_16x16x32_bf16 v[168:171], a[168:171], v[56:59], v[168:171]
v_cvt_pk_bf16_f32 v204, v140, v141
v_cvt_pk_bf16_f32 v205, v142, v143
v_mfma_f32_16x16x32_bf16 v[168:171], a[172:175], v[60:63], v[168:171]
buffer_store_dwordx4 v[132:135], v1, s[44:47], s70 offen sc1
v_mfma_f32_16x16x32_bf16 v[184:187], a[188:191], v[60:63], v[88:91]
v_exp_f32 v157, v157
v_mfma_f32_16x16x32_bf16 v[184:187], a[184:187], v[56:59], v[184:187]
v_exp_f32 v158, v158
v_mfma_f32_16x16x32_bf16 v[184:187], a[180:183], v[52:55], v[184:187]
buffer_load_dwordx4 v1, s[44:47], s72 offen offset:3072 sc1 lds
v_mfma_f32_16x16x32_bf16 v[184:187], a[176:179], v[48:51], v[184:187]
s_waitcnt lgkmcnt(4)
v_exp_f32 v159, v159
v_cvt_pk_bf16_f32 v206, v156, v157
v_cvt_pk_bf16_f32 v207, v158, v159
v_mfma_f32_16x16x32_bf16 v[232:235], v[120:123], v[216:219], v[232:235]
s_add_u32 s82, s82, 0x8000
ds_read_b128 a[160:163], v2 offset:24576
ds_read_b128 a[164:167], v2 offset:25600
v_mfma_f32_16x16x32_bf16 v[232:235], v[120:123], v[200:203], v[232:235]
s_and_b32 s82, s82, 0x1ffff
v_exp_f32 v172, v172
v_mfma_f32_16x16x32_bf16 a[64:67], a[224:227], v[216:219], a[64:67]
s_add_u32 m0, s74, 0
v_exp_f32 v173, v173
v_mfma_f32_16x16x32_bf16 a[64:67], a[192:195], v[200:203], a[64:67]
s_add_u32 s72, s81, 0
buffer_load_dwordx4 v1, s[44:47], s72 offen sc1 lds
v_mfma_f32_16x16x32_bf16 a[68:71], a[196:199], v[200:203], a[68:71]
ds_read_b128 a[168:171], v2 offset:26624
v_cvt_pk_bf16_f32 v220, v172, v173
v_mfma_f32_16x16x32_bf16 a[68:71], a[228:231], v[216:219], a[68:71]
v_exp_f32 v174, v174
v_mfma_f32_16x16x32_bf16 a[72:75], a[232:235], v[216:219], a[72:75]
s_nop 0
ds_read_b128 a[172:175], v2 offset:27648
ds_read_b128 a[176:179], v2 offset:28672
v_mfma_f32_16x16x32_bf16 a[72:75], a[200:203], v[200:203], a[72:75]
v_exp_f32 v175, v175
v_mfma_f32_16x16x32_bf16 a[76:79], a[204:207], v[200:203], a[76:79]
buffer_store_dwordx4 v[148:151], v1, s[44:47], s70 offen offset:1024 sc1
v_mfma_f32_16x16x32_bf16 a[76:79], a[236:239], v[216:219], a[76:79]
v_exp_f32 v188, v188
v_mfma_f32_16x16x32_bf16 a[80:83], a[240:243], v[216:219], a[80:83]
s_waitcnt lgkmcnt(5)
ds_read_b128 a[180:183], v2 offset:29696
v_cvt_pk_bf16_f32 v221, v174, v175
v_mfma_f32_16x16x32_bf16 a[80:83], a[208:211], v[200:203], a[80:83]
v_exp_f32 v189, v189
v_mfma_f32_16x16x32_bf16 a[84:87], a[212:215], v[200:203], a[84:87]
buffer_load_dwordx4 v1, s[44:47], s72 offen offset:1024 sc1 lds
v_mfma_f32_16x16x32_bf16 a[84:87], a[244:247], v[216:219], a[84:87]
ds_read_b128 a[184:187], v2 offset:30720
v_cvt_pk_bf16_f32 v222, v188, v189
v_mfma_f32_16x16x32_bf16 a[88:91], a[248:251], v[216:219], a[88:91]
v_exp_f32 v190, v190
v_mfma_f32_16x16x32_bf16 a[88:91], a[216:219], v[200:203], a[88:91]
s_nop 0
ds_read_b128 a[188:191], v2 offset:31744
ds_read_b128 a[224:227], v2 offset:8192
v_mfma_f32_16x16x32_bf16 a[92:95], a[220:223], v[200:203], a[92:95]
v_exp_f32 v191, v191
v_mfma_f32_16x16x32_bf16 a[92:95], a[252:255], v[216:219], a[92:95]
buffer_store_dwordx4 v[164:167], v1, s[44:47], s70 offen offset:2048 sc1
v_mfma_f32_16x16x32_bf16 v[136:139], a[128:131], v[48:51], v[88:91]
v_exp_f32 v168, v168
v_mfma_f32_16x16x32_bf16 v[136:139], a[132:135], v[52:55], v[136:139]
ds_read_b128 a[228:231], v2 offset:9216
v_cvt_pk_bf16_f32 v223, v190, v191
v_mfma_f32_16x16x32_bf16 v[136:139], a[136:139], v[56:59], v[136:139]
v_exp_f32 v169, v169
v_mfma_f32_16x16x32_bf16 v[136:139], a[140:143], v[60:63], v[136:139]
s_nop 0
ds_read_b128 a[232:235], v2 offset:10240
ds_read_b128 a[236:239], v2 offset:11264
v_mfma_f32_16x16x32_bf16 v[152:155], a[156:159], v[60:63], v[88:91]
v_exp_f32 v170, v170
v_mfma_f32_16x16x32_bf16 v[152:155], a[152:155], v[56:59], v[152:155]
buffer_load_dwordx4 v1, s[44:47], s72 offen offset:2048 sc1 lds
v_mfma_f32_16x16x32_bf16 v[152:155], a[148:151], v[52:55], v[152:155]
v_exp_f32 v171, v171
v_mfma_f32_16x16x32_bf16 v[152:155], a[144:147], v[48:51], v[152:155]
s_nop 0
ds_read_b128 a[240:243], v2 offset:12288
ds_read_b128 a[244:247], v2 offset:13312
v_mfma_f32_16x16x32_bf16 v[140:143], a[128:131], v[64:67], v[92:95]
v_exp_f32 v184, v184
v_mfma_f32_16x16x32_bf16 v[140:143], a[132:135], v[68:71], v[140:143]
s_nop 0
ds_read_b128 a[248:251], v2 offset:14336
ds_read_b128 a[252:255], v2 offset:15360
v_mfma_f32_16x16x32_bf16 v[140:143], a[136:139], v[72:75], v[140:143]
v_cvt_pk_bf16_f32 v216, v168, v169
v_cvt_pk_bf16_f32 v217, v170, v171
v_mfma_f32_16x16x32_bf16 v[140:143], a[140:143], v[76:79], v[140:143]
buffer_store_dwordx4 v[180:183], v1, s[44:47], s70 offen offset:3072 sc1
v_mfma_f32_16x16x32_bf16 v[156:159], a[156:159], v[76:79], v[92:95]
v_exp_f32 v185, v185
v_mfma_f32_16x16x32_bf16 v[156:159], a[152:155], v[72:75], v[156:159]
buffer_load_dwordx4 v1, s[44:47], s72 offen offset:3072 sc1 lds
v_mfma_f32_16x16x32_bf16 v[156:159], a[148:151], v[68:71], v[156:159]
s_waitcnt vmcnt(14) lgkmcnt(4)
v_exp_f32 v186, v186
v_mfma_f32_16x16x32_bf16 v[156:159], a[144:147], v[64:67], v[156:159]
s_barrier
v_exp_f32 v187, v187
v_add_u32 v2, s82, v1
v_cvt_pk_bf16_f32 v218, v184, v185
v_cvt_pk_bf16_f32 v219, v186, v187
s_lshl_b32 s83, s60, 2
s_sub_u32 s83, s83, 25
.p2align 5
s_nop 0
s_nop 0
LloopII:
v_mfma_f32_16x16x32_bf16 v[236:239], v[120:123], v[204:207], v[236:239]
s_xor_b32 s74, s82, 0x10000
v_exp_f32 v136, v136
v_mfma_f32_16x16x32_bf16 v[236:239], v[120:123], v[220:223], v[236:239]
s_add_u32 s74, s74, s64
ds_read_b128 a[128:131], v2 offset:16384
ds_read_b128 a[132:135], v2 offset:17408
v_mfma_f32_16x16x32_bf16 a[96:99], a[192:195], v[204:207], a[96:99]
s_add_u32 s81, s81, 0x8000
v_exp_f32 v137, v137
v_mfma_f32_16x16x32_bf16 a[96:99], a[224:227], v[220:223], a[96:99]
s_add_u32 m0, s74, 16384
v_exp_f32 v138, v138
v_mfma_f32_16x16x32_bf16 a[100:103], a[228:231], v[220:223], a[100:103]
s_add_u32 s72, s81, 16384
ds_read_b128 a[136:139], v2 offset:18432
v_cvt_pk_bf16_f32 v200, v136, v137
v_mfma_f32_16x16x32_bf16 a[100:103], a[196:199], v[204:207], a[100:103]
buffer_load_dwordx4 v1, s[44:47], s72 offen sc1 lds
v_mfma_f32_16x16x32_bf16 a[104:107], a[200:203], v[204:207], a[104:107]
v_exp_f32 v139, v139
v_mfma_f32_16x16x32_bf16 a[104:107], a[232:235], v[220:223], a[104:107]
ds_read_b128 a[140:143], v2 offset:19456
v_cvt_pk_bf16_f32 v201, v138, v139
v_mfma_f32_16x16x32_bf16 a[108:111], a[236:239], v[220:223], a[108:111]
v_exp_f32 v152, v152
v_mfma_f32_16x16x32_bf16 a[108:111], a[204:207], v[204:207], a[108:111]
s_nop 0
ds_read_b128 a[144:147], v2 offset:20480
ds_read_b128 a[148:151], v2 offset:21504
v_mfma_f32_16x16x32_bf16 a[112:115], a[208:211], v[204:207], a[112:115]
s_waitcnt lgkmcnt(6)
v_exp_f32 v153, v153
v_mfma_f32_16x16x32_bf16 a[112:115], a[240:243], v[220:223], a[112:115]
v_exp_f32 v154, v154
v_mfma_f32_16x16x32_bf16 a[116:119], a[244:247], v[220:223], a[116:119]
ds_read_b128 a[152:155], v2 offset:22528
v_cvt_pk_bf16_f32 v202, v152, v153
v_mfma_f32_16x16x32_bf16 a[116:119], a[212:215], v[204:207], a[116:119]
buffer_load_dwordx4 v1, s[44:47], s72 offen offset:1024 sc1 lds
v_mfma_f32_16x16x32_bf16 a[120:123], a[216:219], v[204:207], a[120:123]
v_exp_f32 v155, v155
v_mfma_f32_16x16x32_bf16 a[120:123], a[248:251], v[220:223], a[120:123]
ds_read_b128 a[156:159], v2 offset:23552
v_cvt_pk_bf16_f32 v203, v154, v155
v_mfma_f32_16x16x32_bf16 a[124:127], a[252:255], v[220:223], a[124:127]
v_exp_f32 v140, v140
v_mfma_f32_16x16x32_bf16 a[124:127], a[220:223], v[204:207], a[124:127]
s_nop 0
ds_read_b128 a[192:195], v2 offset:0
ds_read_b128 a[196:199], v2 offset:1024
v_mfma_f32_16x16x32_bf16 v[172:175], a[160:163], v[64:67], v[92:95]
v_exp_f32 v141, v141
v_mfma_f32_16x16x32_bf16 v[172:175], a[164:167], v[68:71], v[172:175]
v_exp_f32 v142, v142
v_mfma_f32_16x16x32_bf16 v[172:175], a[168:171], v[72:75], v[172:175]
ds_read_b128 a[200:203], v2 offset:2048
v_cvt_pk_bf16_f32 v204, v140, v141
v_mfma_f32_16x16x32_bf16 v[172:175], a[172:175], v[76:79], v[172:175]
buffer_load_dwordx4 v1, s[44:47], s72 offen offset:2048 sc1 lds
v_mfma_f32_16x16x32_bf16 v[188:191], a[188:191], v[76:79], v[92:95]
v_exp_f32 v143, v143
v_mfma_f32_16x16x32_bf16 v[188:191], a[184:187], v[72:75], v[188:191]
ds_read_b128 a[204:207], v2 offset:3072
v_cvt_pk_bf16_f32 v205, v142, v143
v_mfma_f32_16x16x32_bf16 v[188:191], a[180:183], v[68:71], v[188:191]
v_exp_f32 v156, v156
v_mfma_f32_16x16x32_bf16 v[188:191], a[176:179], v[64:67], v[188:191]
ds_read_b128 a[208:211], v2 offset:4096
v_mfma_f32_16x16x32_bf16 v[168:171], a[160:163], v[48:51], v[88:91]
v_exp_f32 v157, v157
v_mfma_f32_16x16x32_bf16 v[168:171], a[164:167], v[52:55], v[168:171]
ds_read_b128 a[212:215], v2 offset:5120
v_cvt_pk_bf16_f32 v206, v156, v157
v_mfma_f32_16x16x32_bf16 v[168:171], a[168:171], v[56:59], v[168:171]
v_exp_f32 v158, v158
v_mfma_f32_16x16x32_bf16 v[168:171], a[172:175], v[60:63], v[168:171]
ds_read_b128 a[216:219], v2 offset:6144
v_mfma_f32_16x16x32_bf16 v[184:187], a[188:191], v[60:63], v[88:91]
buffer_load_dwordx4 v1, s[44:47], s72 offen offset:3072 sc1 lds
v_mfma_f32_16x16x32_bf16 v[184:187], a[184:187], v[56:59], v[184:187]
v_exp_f32 v159, v159
v_mfma_f32_16x16x32_bf16 v[184:187], a[180:183], v[52:55], v[184:187]
ds_read_b128 a[220:223], v2 offset:7168
v_cvt_pk_bf16_f32 v207, v158, v159
v_mfma_f32_16x16x32_bf16 v[184:187], a[176:179], v[48:51], v[184:187]
s_waitcnt lgkmcnt(4)
v_mfma_f32_16x16x32_bf16 v[232:235], v[120:123], v[216:219], v[232:235]
s_add_u32 s82, s82, 0x8000
ds_read_b128 a[160:163], v2 offset:24576
ds_read_b128 a[164:167], v2 offset:25600
v_mfma_f32_16x16x32_bf16 v[232:235], v[120:123], v[200:203], v[232:235]
s_and_b32 s82, s82, 0x1ffff
v_exp_f32 v172, v172
v_mfma_f32_16x16x32_bf16 a[64:67], a[224:227], v[216:219], a[64:67]
s_add_u32 m0, s74, 0
v_exp_f32 v173, v173
v_mfma_f32_16x16x32_bf16 a[64:67], a[192:195], v[200:203], a[64:67]
s_add_u32 s72, s81, 0
ds_read_b128 a[168:171], v2 offset:26624
v_cvt_pk_bf16_f32 v220, v172, v173
v_mfma_f32_16x16x32_bf16 a[68:71], a[196:199], v[200:203], a[68:71]
v_exp_f32 v174, v174
v_mfma_f32_16x16x32_bf16 a[68:71], a[228:231], v[216:219], a[68:71]
buffer_load_dwordx4 v1, s[44:47], s72 offen sc1 lds
v_mfma_f32_16x16x32_bf16 a[72:75], a[232:235], v[216:219], a[72:75]
s_nop 0
ds_read_b128 a[172:175], v2 offset:27648
ds_read_b128 a[176:179], v2 offset:28672
v_mfma_f32_16x16x32_bf16 a[72:75], a[200:203], v[200:203], a[72:75]
v_exp_f32 v175, v175
v_mfma_f32_16x16x32_bf16 a[76:79], a[204:207], v[200:203], a[76:79]
v_exp_f32 v188, v188
v_mfma_f32_16x16x32_bf16 a[76:79], a[236:239], v[216:219], a[76:79]
ds_read_b128 a[180:183], v2 offset:29696
v_cvt_pk_bf16_f32 v221, v174, v175
v_mfma_f32_16x16x32_bf16 a[80:83], a[240:243], v[216:219], a[80:83]
s_waitcnt lgkmcnt(6)
v_exp_f32 v189, v189
v_mfma_f32_16x16x32_bf16 a[80:83], a[208:211], v[200:203], a[80:83]
ds_read_b128 a[184:187], v2 offset:30720
v_cvt_pk_bf16_f32 v222, v188, v189
v_mfma_f32_16x16x32_bf16 a[84:87], a[212:215], v[200:203], a[84:87]
buffer_load_dwordx4 v1, s[44:47], s72 offen offset:1024 sc1 lds
v_mfma_f32_16x16x32_bf16 a[84:87], a[244:247], v[216:219], a[84:87]
v_exp_f32 v190, v190
v_mfma_f32_16x16x32_bf16 a[88:91], a[248:251], v[216:219], a[88:91]
s_nop 0
ds_read_b128 a[188:191], v2 offset:31744
ds_read_b128 a[224:227], v2 offset:8192
v_mfma_f32_16x16x32_bf16 a[88:91], a[216:219], v[200:203], a[88:91]
v_exp_f32 v191, v191
v_mfma_f32_16x16x32_bf16 a[92:95], a[220:223], v[200:203], a[92:95]
v_exp_f32 v168, v168
v_mfma_f32_16x16x32_bf16 a[92:95], a[252:255], v[216:219], a[92:95]
ds_read_b128 a[228:231], v2 offset:9216
v_cvt_pk_bf16_f32 v223, v190, v191
v_mfma_f32_16x16x32_bf16 v[136:139], a[128:131], v[48:51], v[88:91]
v_exp_f32 v169, v169
v_mfma_f32_16x16x32_bf16 v[136:139], a[132:135], v[52:55], v[136:139]
ds_read_b128 a[232:235], v2 offset:10240
v_cvt_pk_bf16_f32 v216, v168, v169
v_mfma_f32_16x16x32_bf16 v[136:139], a[136:139], v[56:59], v[136:139]
buffer_load_dwordx4 v1, s[44:47], s72 offen offset:2048 sc1 lds
v_mfma_f32_16x16x32_bf16 v[136:139], a[140:143], v[60:63], v[136:139]
v_exp_f32 v170, v170
v_mfma_f32_16x16x32_bf16 v[152:155], a[156:159], v[60:63], v[88:91]
s_nop 0
ds_read_b128 a[236:239], v2 offset:11264
ds_read_b128 a[240:243], v2 offset:12288
v_mfma_f32_16x16x32_bf16 v[152:155], a[152:155], v[56:59], v[152:155]
v_exp_f32 v171, v171
v_mfma_f32_16x16x32_bf16 v[152:155], a[148:151], v[52:55], v[152:155]
v_exp_f32 v184, v184
v_mfma_f32_16x16x32_bf16 v[152:155], a[144:147], v[48:51], v[152:155]
ds_read_b128 a[244:247], v2 offset:13312
v_cvt_pk_bf16_f32 v217, v170, v171
v_mfma_f32_16x16x32_bf16 v[140:143], a[128:131], v[64:67], v[92:95]
v_exp_f32 v185, v185
v_mfma_f32_16x16x32_bf16 v[140:143], a[132:135], v[68:71], v[140:143]
ds_read_b128 a[248:251], v2 offset:14336
v_cvt_pk_bf16_f32 v218, v184, v185
v_mfma_f32_16x16x32_bf16 v[140:143], a[136:139], v[72:75], v[140:143]
buffer_load_dwordx4 v1, s[44:47], s72 offen offset:3072 sc1 lds
v_mfma_f32_16x16x32_bf16 v[140:143], a[140:143], v[76:79], v[140:143]
ds_read_b128 a[252:255], v2 offset:15360
v_add_u32 v2, s82, v1
v_mfma_f32_16x16x32_bf16 v[156:159], a[156:159], v[76:79], v[92:95]
s_waitcnt vmcnt(8) lgkmcnt(4)
v_exp_f32 v186, v186
v_mfma_f32_16x16x32_bf16 v[156:159], a[152:155], v[72:75], v[156:159]
s_barrier
v_exp_f32 v187, v187
v_mfma_f32_16x16x32_bf16 v[156:159], a[148:151], v[68:71], v[156:159]
s_add_u32 s83, s83, 1
v_cvt_pk_bf16_f32 v219, v186, v187
v_mfma_f32_16x16x32_bf16 v[156:159], a[144:147], v[64:67], v[156:159]
s_cbranch_scc0 LloopII
v_mfma_f32_16x16x32_bf16 v[236:239], v[120:123], v[204:207], v[236:239]
s_xor_b32 s74, s82, 0x10000
ds_read_b128 a[128:131], v2 offset:16384
ds_read_b128 a[132:135], v2 offset:17408
v_mfma_f32_16x16x32_bf16 v[236:239], v[120:123], v[220:223], v[236:239]
s_add_u32 s74, s74, s64
v_exp_f32 v136, v136
v_mfma_f32_16x16x32_bf16 a[96:99], a[192:195], v[204:207], a[96:99]
s_add_u32 s81, s81, 0x8000
v_exp_f32 v137, v137
v_mfma_f32_16x16x32_bf16 a[96:99], a[224:227], v[220:223], a[96:99]
s_add_u32 m0, s74, 0
ds_read_b128 a[136:139], v2 offset:18432
v_cvt_pk_bf16_f32 v200, v136, v137
v_mfma_f32_16x16x32_bf16 a[100:103], a[228:231], v[220:223], a[100:103]
s_add_u32 s72, s81, 0
v_exp_f32 v138, v138
v_mfma_f32_16x16x32_bf16 a[100:103], a[196:199], v[204:207], a[100:103]
buffer_load_dwordx4 v1, s[44:47], s72 offen sc1 lds
v_mfma_f32_16x16x32_bf16 a[104:107], a[200:203], v[204:207], a[104:107]
s_nop 0
ds_read_b128 a[140:143], v2 offset:19456
ds_read_b128 a[144:147], v2 offset:20480
v_mfma_f32_16x16x32_bf16 a[104:107], a[232:235], v[220:223], a[104:107]
v_exp_f32 v139, v139
v_mfma_f32_16x16x32_bf16 a[108:111], a[236:239], v[220:223], a[108:111]
v_exp_f32 v152, v152
v_mfma_f32_16x16x32_bf16 a[108:111], a[204:207], v[204:207], a[108:111]
ds_read_b128 a[148:151], v2 offset:21504
v_cvt_pk_bf16_f32 v201, v138, v139
v_mfma_f32_16x16x32_bf16 a[112:115], a[208:211], v[204:207], a[112:115]
s_waitcnt lgkmcnt(6)
v_exp_f32 v153, v153
v_mfma_f32_16x16x32_bf16 a[112:115], a[240:243], v[220:223], a[112:115]
ds_read_b128 a[152:155], v2 offset:22528
v_cvt_pk_bf16_f32 v202, v152, v153
v_mfma_f32_16x16x32_bf16 a[116:119], a[244:247], v[220:223], a[116:119]
v_exp_f32 v154, v154
v_mfma_f32_16x16x32_bf16 a[116:119], a[212:215], v[204:207], a[116:119]
buffer_load_dwordx4 v1, s[44:47], s72 offen offset:1024 sc1 lds
v_mfma_f32_16x16x32_bf16 a[120:123], a[216:219], v[204:207], a[120:123]
s_nop 0
ds_read_b128 a[156:159], v2 offset:23552
ds_read_b128 a[192:195], v2 offset:0
v_mfma_f32_16x16x32_bf16 a[120:123], a[248:251], v[220:223], a[120:123]
v_exp_f32 v155, v155
v_mfma_f32_16x16x32_bf16 a[124:127], a[252:255], v[220:223], a[124:127]
v_exp_f32 v140, v140
v_mfma_f32_16x16x32_bf16 a[124:127], a[220:223], v[204:207], a[124:127]
ds_read_b128 a[196:199], v2 offset:1024
v_cvt_pk_bf16_f32 v203, v154, v155
v_mfma_f32_16x16x32_bf16 v[172:175], a[160:163], v[64:67], v[92:95]
v_exp_f32 v141, v141
v_mfma_f32_16x16x32_bf16 v[172:175], a[164:167], v[68:71], v[172:175]
ds_read_b128 a[200:203], v2 offset:2048
v_cvt_pk_bf16_f32 v204, v140, v141
v_mfma_f32_16x16x32_bf16 v[172:175], a[168:171], v[72:75], v[172:175]
v_exp_f32 v142, v142
v_mfma_f32_16x16x32_bf16 v[172:175], a[172:175], v[76:79], v[172:175]
buffer_load_dwordx4 v1, s[44:47], s72 offen offset:2048 sc1 lds
v_mfma_f32_16x16x32_bf16 v[188:191], a[188:191], v[76:79], v[92:95]
ds_read_b128 a[204:207], v2 offset:3072
v_mfma_f32_16x16x32_bf16 v[188:191], a[184:187], v[72:75], v[188:191]
Lstub6:
s_cbranch_execz Lstub10
v_exp_f32 v143, v143
v_mfma_f32_16x16x32_bf16 v[188:191], a[180:183], v[68:71], v[188:191]
ds_read_b128 a[208:211], v2 offset:4096
v_cvt_pk_bf16_f32 v205, v142, v143
v_mfma_f32_16x16x32_bf16 v[188:191], a[176:179], v[64:67], v[188:191]
v_exp_f32 v156, v156
v_mfma_f32_16x16x32_bf16 v[168:171], a[160:163], v[48:51], v[88:91]
ds_read_b128 a[212:215], v2 offset:5120
v_mfma_f32_16x16x32_bf16 v[168:171], a[164:167], v[52:55], v[168:171]
v_exp_f32 v157, v157
v_mfma_f32_16x16x32_bf16 v[168:171], a[168:171], v[56:59], v[168:171]
ds_read_b128 a[216:219], v2 offset:6144
v_cvt_pk_bf16_f32 v206, v156, v157
v_mfma_f32_16x16x32_bf16 v[168:171], a[172:175], v[60:63], v[168:171]
buffer_load_dwordx4 v1, s[44:47], s72 offen offset:3072 sc1 lds
v_mfma_f32_16x16x32_bf16 v[184:187], a[188:191], v[60:63], v[88:91]
v_exp_f32 v158, v158
v_mfma_f32_16x16x32_bf16 v[184:187], a[184:187], v[56:59], v[184:187]
ds_read_b128 a[220:223], v2 offset:7168
v_mfma_f32_16x16x32_bf16 v[184:187], a[180:183], v[52:55], v[184:187]
s_waitcnt lgkmcnt(4)
v_exp_f32 v159, v159
v_mfma_f32_16x16x32_bf16 v[184:187], a[176:179], v[48:51], v[184:187]
s_barrier
v_cvt_pk_bf16_f32 v207, v158, v159
s_lshr_b32 s69, s93, 4
s_and_b32 s69, s69, 0x7f00
s_add_u32 s69, s69, LHT4-Lpc0
v_lshrrev_b32 v3, 5, v0
v_lshlrev_b32 v3, 7, v3
v_add_u32 v3, s69, v3
v_min_u32 v3, Lcode_end-Lpc0, v3
global_load_dword v4, v3, s[98:99]
v_mfma_f32_16x16x32_bf16 v[232:235], v[120:123], v[216:219], v[232:235]
s_add_u32 s82, s82, 0x8000
ds_read_b128 a[160:163], v2 offset:24576
ds_read_b128 a[164:167], v2 offset:25600
v_mfma_f32_16x16x32_bf16 v[232:235], v[120:123], v[200:203], v[232:235]
s_and_b32 s82, s82, 0x1ffff
v_exp_f32 v172, v172
v_mfma_f32_16x16x32_bf16 a[64:67], a[224:227], v[216:219], a[64:67]
s_add_u32 s66, s58, 3
v_exp_f32 v173, v173
v_mfma_f32_16x16x32_bf16 a[64:67], a[192:195], v[200:203], a[64:67]
s_and_b32 s66, s66, 3
ds_read_b128 a[168:171], v2 offset:26624
v_cvt_pk_bf16_f32 v220, v172, v173
v_mfma_f32_16x16x32_bf16 a[68:71], a[196:199], v[200:203], a[68:71]
s_mul_i32 s66, s66, 4160
v_exp_f32 v174, v174
v_mfma_f32_16x16x32_bf16 a[68:71], a[228:231], v[216:219], a[68:71]
s_add_u32 s66, s66, s92
ds_read_b128 a[172:175], v2 offset:27648
ds_read_b128 a[176:179], v2 offset:28672
v_mfma_f32_16x16x32_bf16 a[72:75], a[232:235], v[216:219], a[72:75]
s_add_u32 m0, s66, 32
v_exp_f32 v175, v175
v_mfma_f32_16x16x32_bf16 a[72:75], a[200:203], v[200:203], a[72:75]
s_add_u32 s72, s93, 0x6
buffer_load_dwordx4 v1, s[36:39], s72 offen lds
v_mfma_f32_16x16x32_bf16 a[76:79], a[204:207], v[200:203], a[76:79]
v_exp_f32 v188, v188
v_mfma_f32_16x16x32_bf16 a[76:79], a[236:239], v[216:219], a[76:79]
ds_read_b128 a[180:183], v2 offset:29696
v_cvt_pk_bf16_f32 v221, v174, v175
v_mfma_f32_16x16x32_bf16 a[80:83], a[240:243], v[216:219], a[80:83]
s_waitcnt lgkmcnt(6)
v_exp_f32 v189, v189
v_mfma_f32_16x16x32_bf16 a[80:83], a[208:211], v[200:203], a[80:83]
ds_read_b128 a[184:187], v2 offset:30720
v_cvt_pk_bf16_f32 v222, v188, v189
v_mfma_f32_16x16x32_bf16 a[84:87], a[212:215], v[200:203], a[84:87]
v_exp_f32 v190, v190
v_mfma_f32_16x16x32_bf16 a[84:87], a[244:247], v[216:219], a[84:87]
buffer_load_dwordx4 v1, s[36:39], s72 offen offset:1024 lds
v_mfma_f32_16x16x32_bf16 a[88:91], a[248:251], v[216:219], a[88:91]
s_nop 0
ds_read_b128 a[188:191], v2 offset:31744
ds_read_b128 a[224:227], v2 offset:8192
v_mfma_f32_16x16x32_bf16 a[88:91], a[216:219], v[200:203], a[88:91]
v_exp_f32 v191, v191
v_mfma_f32_16x16x32_bf16 a[92:95], a[220:223], v[200:203], a[92:95]
v_exp_f32 v168, v168
v_mfma_f32_16x16x32_bf16 a[92:95], a[252:255], v[216:219], a[92:95]
ds_read_b128 a[228:231], v2 offset:9216
v_cvt_pk_bf16_f32 v223, v190, v191
s_cmp_eq_u32 s58, 0
s_cbranch_scc1 Lta28
s_cmp_eq_u32 s58, 1
s_cbranch_scc1 Lnt29
v_mfma_f32_16x16x32_bf16 v[136:139], a[128:131], v[48:51], v[88:91]
v_exp_f32 v169, v169
v_mfma_f32_16x16x32_bf16 v[152:155], a[144:147], v[48:51], v[88:91]
ds_read_b128 a[232:235], v2 offset:10240
v_cvt_pk_bf16_f32 v216, v168, v169
s_branch Ljoin30
Lta28:
v_mfma_f32_16x16x32_bf16 v[136:139], a[128:131], v[48:51], v[104:107]
v_exp_f32 v169, v169
v_mfma_f32_16x16x32_bf16 v[152:155], a[144:147], v[48:51], v[112:115]
ds_read_b128 a[232:235], v2 offset:10240
v_cvt_pk_bf16_f32 v216, v168, v169
s_branch Ljoin30
Lnt29:
v_mfma_f32_16x16x32_bf16 v[136:139], a[128:131], v[48:51], v[88:91]
v_exp_f32 v169, v169
v_mfma_f32_16x16x32_bf16 v[152:155], a[144:147], v[48:51], v[104:107]
ds_read_b128 a[232:235], v2 offset:10240
v_cvt_pk_bf16_f32 v216, v168, v169
Ljoin30:
v_mfma_f32_16x16x32_bf16 v[136:139], a[132:135], v[52:55], v[136:139]
v_exp_f32 v170, v170
v_mfma_f32_16x16x32_bf16 v[136:139], a[136:139], v[56:59], v[136:139]
buffer_load_dwordx4 v1, s[36:39], s72 offen offset:2048 lds
v_mfma_f32_16x16x32_bf16 v[136:139], a[140:143], v[60:63], v[136:139]
ds_read_b128 a[236:239], v2 offset:11264
v_mfma_f32_16x16x32_bf16 v[152:155], a[156:159], v[60:63], v[152:155]
v_exp_f32 v171, v171
v_mfma_f32_16x16x32_bf16 v[152:155], a[152:155], v[56:59], v[152:155]
ds_read_b128 a[240:243], v2 offset:12288
v_cvt_pk_bf16_f32 v217, v170, v171
v_mfma_f32_16x16x32_bf16 v[152:155], a[148:151], v[52:55], v[152:155]
v_exp_f32 v184, v184
v_mfma_f32_16x16x32_bf16 v[140:143], a[128:131], v[64:67], v[92:95]
ds_read_b128 a[244:247], v2 offset:13312
v_mfma_f32_16x16x32_bf16 v[140:143], a[132:135], v[68:71], v[140:143]
v_exp_f32 v185, v185
v_mfma_f32_16x16x32_bf16 v[140:143], a[136:139], v[72:75], v[140:143]
ds_read_b128 a[248:251], v2 offset:14336
v_cvt_pk_bf16_f32 v218, v184, v185
v_mfma_f32_16x16x32_bf16 v[140:143], a[140:143], v[76:79], v[140:143]
buffer_load_dwordx4 v1, s[36:39], s72 offen offset:3072 lds
v_mfma_f32_16x16x32_bf16 v[156:159], a[156:159], v[76:79], v[92:95]
v_exp_f32 v186, v186
v_mfma_f32_16x16x32_bf16 v[156:159], a[152:155], v[72:75], v[156:159]
ds_read_b128 a[252:255], v2 offset:15360
v_add_u32 v2, s82, v1
v_mfma_f32_16x16x32_bf16 v[156:159], a[148:151], v[68:71], v[156:159]
s_waitcnt vmcnt(9) lgkmcnt(0)
v_exp_f32 v187, v187
v_mfma_f32_16x16x32_bf16 v[156:159], a[144:147], v[64:67], v[156:159]
s_barrier
v_cvt_pk_bf16_f32 v219, v186, v187
v_mfma_f32_16x16x32_bf16 v[236:239], v[120:123], v[204:207], v[236:239]
s_mov_b32 m0, s62
v_exp_f32 v136, v136
v_mfma_f32_16x16x32_bf16 v[236:239], v[120:123], v[220:223], v[236:239]
s_add_u32 s72, s93, 0x3000000
ds_read_b128 a[128:131], v2 offset:16384
ds_read_b128 a[132:135], v2 offset:17408
v_mfma_f32_16x16x32_bf16 a[96:99], a[192:195], v[204:207], a[96:99]
s_add_u32 s78, s59, 4
v_exp_f32 v137, v137
v_mfma_f32_16x16x32_bf16 a[96:99], a[224:227], v[220:223], a[96:99]
s_and_b32 s78, s78, 12
buffer_load_dwordx4 v1, s[44:47], s72 offen sc1 lds
v_mfma_f32_16x16x32_bf16 a[100:103], a[228:231], v[220:223], a[100:103]
s_lshl_b32 s78, s78, 1
v_exp_f32 v138, v138
v_mfma_f32_16x16x32_bf16 a[100:103], a[196:199], v[204:207], a[100:103]
s_lshr_b32 s79, 0x67234501, s78
ds_read_b128 a[136:139], v2 offset:18432
v_cvt_pk_bf16_f32 v200, v136, v137
v_mfma_f32_16x16x32_bf16 a[104:107], a[200:203], v[204:207], a[104:107]
s_and_b32 s79, s79, 7
v_exp_f32 v139, v139
v_mfma_f32_16x16x32_bf16 a[104:107], a[232:235], v[220:223], a[104:107]
s_lshl_b32 s79, s79, 18
ds_read_b128 a[140:143], v2 offset:19456
v_cvt_pk_bf16_f32 v201, v138, v139
v_mfma_f32_16x16x32_bf16 a[108:111], a[236:239], v[220:223], a[108:111]
s_add_u32 s79, s79, s94
v_exp_f32 v152, v152
v_mfma_f32_16x16x32_bf16 a[108:111], a[204:207], v[204:207], a[108:111]
s_add_u32 s12, s61, 0
ds_read_b128 a[144:147], v2 offset:20480
ds_read_b128 a[148:151], v2 offset:21504
v_mfma_f32_16x16x32_bf16 a[112:115], a[208:211], v[204:207], a[112:115]
s_waitcnt lgkmcnt(6)
buffer_load_dwordx4 v1, s[44:47], s72 offen offset:1024 sc1 lds
v_mfma_f32_16x16x32_bf16 a[112:115], a[240:243], v[220:223], a[112:115]
s_and_b32 s12, s12, 3
v_exp_f32 v153, v153
v_mfma_f32_16x16x32_bf16 a[116:119], a[244:247], v[220:223], a[116:119]
s_lshl_b32 s12, s12, 21
v_exp_f32 v154, v154
v_mfma_f32_16x16x32_bf16 a[116:119], a[212:215], v[204:207], a[116:119]
s_add_u32 s12, s12, s79
ds_read_b128 a[152:155], v2 offset:22528
v_cvt_pk_bf16_f32 v202, v152, v153
v_mfma_f32_16x16x32_bf16 a[120:123], a[216:219], v[204:207], a[120:123]
s_add_u32 s13, s61, 1
buffer_load_dwordx4 v1, s[44:47], s72 offen offset:2048 sc1 lds
v_mfma_f32_16x16x32_bf16 a[120:123], a[248:251], v[220:223], a[120:123]
s_and_b32 s13, s13, 3
v_exp_f32 v155, v155
v_mfma_f32_16x16x32_bf16 a[124:127], a[252:255], v[220:223], a[124:127]
s_lshl_b32 s13, s13, 21
ds_read_b128 a[156:159], v2 offset:23552
v_cvt_pk_bf16_f32 v203, v154, v155
v_mfma_f32_16x16x32_bf16 a[124:127], a[220:223], v[204:207], a[124:127]
s_add_u32 s13, s13, s79
v_exp_f32 v140, v140
s_cmp_eq_u32 s58, 2
s_cbranch_scc1 Lta31
s_cmp_eq_u32 s58, 3
s_cbranch_scc1 Lnt32
v_mfma_f32_16x16x32_bf16 v[168:171], a[160:163], v[48:51], v[112:115]
s_add_u32 s14, s61, 2
ds_read_b128 a[192:195], v2 offset:0
ds_read_b128 a[196:199], v2 offset:1024
v_mfma_f32_16x16x32_bf16 v[184:187], a[176:179], v[48:51], v[112:115]
s_and_b32 s14, s14, 3
v_exp_f32 v141, v141
s_branch Ljoin33
Lta31:
v_mfma_f32_16x16x32_bf16 v[168:171], a[160:163], v[48:51], v[104:107]
s_add_u32 s14, s61, 2
ds_read_b128 a[192:195], v2 offset:0
ds_read_b128 a[196:199], v2 offset:1024
v_mfma_f32_16x16x32_bf16 v[184:187], a[176:179], v[48:51], v[112:115]
s_and_b32 s14, s14, 3
v_exp_f32 v141, v141
s_branch Ljoin33
Lnt32:
v_mfma_f32_16x16x32_bf16 v[168:171], a[160:163], v[48:51], v[88:91]
s_add_u32 s14, s61, 2
ds_read_b128 a[192:195], v2 offset:0
ds_read_b128 a[196:199], v2 offset:1024
v_mfma_f32_16x16x32_bf16 v[184:187], a[176:179], v[48:51], v[104:107]
s_and_b32 s14, s14, 3
v_exp_f32 v141, v141
Ljoin33:
v_mfma_f32_16x16x32_bf16 v[172:175], a[160:163], v[64:67], v[92:95]
s_lshl_b32 s14, s14, 21
buffer_load_dwordx4 v1, s[44:47], s72 offen offset:3072 sc1 lds
v_mfma_f32_16x16x32_bf16 v[172:175], a[164:167], v[68:71], v[172:175]
s_add_u32 s66, s58, 0
v_exp_f32 v142, v142
v_mfma_f32_16x16x32_bf16 v[172:175], a[168:171], v[72:75], v[172:175]
s_and_b32 s66, s66, 3
ds_read_b128 a[200:203], v2 offset:2048
v_cvt_pk_bf16_f32 v204, v140, v141
v_mfma_f32_16x16x32_bf16 v[172:175], a[172:175], v[76:79], v[172:175]
s_mul_i32 s66, s66, 4160
v_exp_f32 v143, v143
v_mfma_f32_16x16x32_bf16 v[188:191], a[188:191], v[76:79], v[92:95]
s_add_u32 s66, s66, s92
ds_read_b128 a[204:207], v2 offset:3072
v_cvt_pk_bf16_f32 v205, v142, v143
v_mfma_f32_16x16x32_bf16 v[188:191], a[184:187], v[72:75], v[188:191]
s_add_u32 m0, s66, 16672
v_exp_f32 v156, v156
v_mfma_f32_16x16x32_bf16 v[188:191], a[180:183], v[68:71], v[188:191]
s_add_u32 s72, s93, 0x0
ds_read_b128 a[208:211], v2 offset:4096
ds_read_b128 a[212:215], v2 offset:5120
v_mfma_f32_16x16x32_bf16 v[188:191], a[176:179], v[64:67], v[188:191]
s_add_u32 s14, s14, s79
buffer_load_dwordx4 v1, s[36:39], s72 offen lds
v_mfma_f32_16x16x32_bf16 v[168:171], a[164:167], v[52:55], v[168:171]
s_add_u32 s15, s61, 3
v_exp_f32 v157, v157
v_mfma_f32_16x16x32_bf16 v[168:171], a[168:171], v[56:59], v[168:171]
s_and_b32 s15, s15, 3
v_exp_f32 v158, v158
v_mfma_f32_16x16x32_bf16 v[168:171], a[172:175], v[60:63], v[168:171]
s_lshl_b32 s15, s15, 21
ds_read_b128 a[216:219], v2 offset:6144
ds_read_b128 a[220:223], v2 offset:7168
v_mfma_f32_16x16x32_bf16 v[184:187], a[188:191], v[60:63], v[184:187]
s_add_u32 s15, s15, s79
buffer_load_dwordx4 v1, s[36:39], s72 offen offset:1024 lds
v_mfma_f32_16x16x32_bf16 v[184:187], a[184:187], v[56:59], v[184:187]
v_exp_f32 v159, v159
v_mfma_f32_16x16x32_bf16 v[184:187], a[180:183], v[52:55], v[184:187]
s_waitcnt lgkmcnt(4)
v_cvt_pk_bf16_f32 v206, v156, v157
v_cvt_pk_bf16_f32 v207, v158, v159
v_mfma_f32_16x16x32_bf16 v[232:235], v[120:123], v[216:219], v[232:235]
s_add_u32 s82, s82, 0x8000
ds_read_b128 a[160:163], v2 offset:24576
ds_read_b128 a[164:167], v2 offset:25600
v_mfma_f32_16x16x32_bf16 v[232:235], v[120:123], v[200:203], v[232:235]
s_and_b32 s82, s82, 0x1ffff
v_exp_f32 v172, v172
v_mfma_f32_16x16x32_bf16 a[64:67], a[224:227], v[216:219], a[64:67]
v_exp_f32 v173, v173
v_mfma_f32_16x16x32_bf16 a[64:67], a[192:195], v[200:203], a[64:67]
s_nop 0
ds_read_b128 a[168:171], v2 offset:26624
ds_read_b128 a[172:175], v2 offset:27648
v_mfma_f32_16x16x32_bf16 a[68:71], a[196:199], v[200:203], a[68:71]
v_exp_f32 v174, v174
v_mfma_f32_16x16x32_bf16 a[68:71], a[228:231], v[216:219], a[68:71]
v_exp_f32 v175, v175
v_mfma_f32_16x16x32_bf16 a[72:75], a[232:235], v[216:219], a[72:75]
s_nop 0
ds_read_b128 a[176:179], v2 offset:28672
ds_read_b128 a[180:183], v2 offset:29696
v_mfma_f32_16x16x32_bf16 a[72:75], a[200:203], v[200:203], a[72:75]
v_exp_f32 v188, v188
v_mfma_f32_16x16x32_bf16 a[76:79], a[204:207], v[200:203], a[76:79]
s_nop 0
ds_read_b128 a[184:187], v2 offset:30720
ds_read_b128 a[188:191], v2 offset:31744
v_mfma_f32_16x16x32_bf16 a[76:79], a[236:239], v[216:219], a[76:79]
s_nop 0
ds_read_b128 a[224:227], v2 offset:8192
ds_read_b128 a[228:231], v2 offset:9216
v_mfma_f32_16x16x32_bf16 a[80:83], a[240:243], v[216:219], a[80:83]
s_waitcnt lgkmcnt(10)
ds_read_b128 a[232:235], v2 offset:10240
ds_read_b128 a[236:239], v2 offset:11264
v_mfma_f32_16x16x32_bf16 a[80:83], a[208:211], v[200:203], a[80:83]
ds_read_b128 a[240:243], v2 offset:12288
v_cvt_pk_bf16_f32 v220, v172, v173
v_mfma_f32_16x16x32_bf16 a[84:87], a[212:215], v[200:203], a[84:87]
buffer_load_dwordx4 v1, s[36:39], s72 offen offset:2048 lds
v_mfma_f32_16x16x32_bf16 a[84:87], a[244:247], v[216:219], a[84:87]
v_exp_f32 v189, v189
v_mfma_f32_16x16x32_bf16 a[88:91], a[248:251], v[216:219], a[88:91]
v_exp_f32 v190, v190
v_mfma_f32_16x16x32_bf16 a[88:91], a[216:219], v[200:203], a[88:91]
s_nop 0
ds_read_b128 a[244:247], v2 offset:13312
ds_read_b128 a[248:251], v2 offset:14336
v_mfma_f32_16x16x32_bf16 a[92:95], a[220:223], v[200:203], a[92:95]
v_cvt_pk_bf16_f32 v221, v174, v175
v_cvt_pk_bf16_f32 v222, v188, v189
v_mfma_f32_16x16x32_bf16 a[92:95], a[252:255], v[216:219], a[92:95]
v_exp_f32 v191, v191
s_cmp_eq_u32 s58, 0
s_cbranch_scc1 Lta34
s_cmp_eq_u32 s58, 1
s_cbranch_scc1 Lnt35
v_mfma_f32_16x16x32_bf16 v[140:143], a[128:131], v[64:67], v[92:95]
v_exp_f32 v168, v168
v_mfma_f32_16x16x32_bf16 v[156:159], a[144:147], v[64:67], v[92:95]
v_exp_f32 v169, v169
s_branch Ljoin36
Lta34:
v_mfma_f32_16x16x32_bf16 v[140:143], a[128:131], v[64:67], v[108:111]
v_exp_f32 v168, v168
v_mfma_f32_16x16x32_bf16 v[156:159], a[144:147], v[64:67], v[112:115]
v_exp_f32 v169, v169
s_branch Ljoin36
Lnt35:
v_mfma_f32_16x16x32_bf16 v[140:143], a[128:131], v[64:67], v[92:95]
v_exp_f32 v168, v168
v_mfma_f32_16x16x32_bf16 v[156:159], a[144:147], v[64:67], v[108:111]
v_exp_f32 v169, v169
Ljoin36:
v_mfma_f32_16x16x32_bf16 v[140:143], a[132:135], v[68:71], v[140:143]
v_exp_f32 v170, v170
v_mfma_f32_16x16x32_bf16 v[140:143], a[136:139], v[72:75], v[140:143]
ds_read_b128 a[252:255], v2 offset:15360
v_cvt_pk_bf16_f32 v223, v190, v191
v_mfma_f32_16x16x32_bf16 v[140:143], a[140:143], v[76:79], v[140:143]
v_exp_f32 v171, v171
v_mfma_f32_16x16x32_bf16 v[156:159], a[156:159], v[76:79], v[156:159]
buffer_load_dwordx4 v1, s[36:39], s72 offen offset:3072 lds
v_mfma_f32_16x16x32_bf16 v[156:159], a[152:155], v[72:75], v[156:159]
s_waitcnt vmcnt(13) lgkmcnt(4)
v_exp_f32 v184, v184
v_mfma_f32_16x16x32_bf16 v[156:159], a[148:151], v[68:71], v[156:159]
s_barrier
v_cvt_pk_bf16_f32 v216, v168, v169
v_cvt_pk_bf16_f32 v217, v170, v171
v_add_u32 v2, s82, v1
v_exp_f32 v185, v185
v_exp_f32 v186, v186
v_cvt_pk_bf16_f32 v218, v184, v185
v_exp_f32 v187, v187
s_nop 0
v_cvt_pk_bf16_f32 v219, v186, v187
v_mfma_f32_16x16x32_bf16 v[236:239], v[120:123], v[204:207], v[236:239]
s_add_u32 s66, s58, 2
v_exp_f32 v140, v140
v_mfma_f32_16x16x32_bf16 v[236:239], v[120:123], v[220:223], v[236:239]
s_and_b32 s66, s66, 3
v_exp_f32 v141, v141
v_mfma_f32_16x16x32_bf16 a[96:99], a[192:195], v[204:207], a[96:99]
s_mul_i32 s66, s66, 4160
ds_read_b128 a[192:195], v2 offset:0
v_mfma_f32_16x16x32_bf16 a[96:99], a[224:227], v[220:223], a[96:99]
s_add_u32 s66, s66, s92
v_exp_f32 v142, v142
v_mfma_f32_16x16x32_bf16 a[100:103], a[228:231], v[220:223], a[100:103]
s_add_u32 m0, s66, 33312
v_exp_f32 v143, v143
v_mfma_f32_16x16x32_bf16 a[100:103], a[196:199], v[204:207], a[100:103]
s_add_u32 s72, s93, 0x4
buffer_load_dwordx4 v1, s[36:39], s72 offen lds
v_mfma_f32_16x16x32_bf16 a[104:107], a[200:203], v[204:207], a[104:107]
ds_read_b128 a[196:199], v2 offset:1024
v_mfma_f32_16x16x32_bf16 a[104:107], a[232:235], v[220:223], a[104:107]
buffer_load_dwordx4 v1, s[36:39], s72 offen offset:1024 lds
v_mfma_f32_16x16x32_bf16 a[108:111], a[236:239], v[220:223], a[108:111]
ds_read_b128 a[200:203], v2 offset:2048
v_mfma_f32_16x16x32_bf16 a[108:111], a[204:207], v[204:207], a[108:111]
buffer_load_dwordx4 v1, s[36:39], s72 offen offset:2048 lds
v_mfma_f32_16x16x32_bf16 a[112:115], a[208:211], v[204:207], a[112:115]
s_waitcnt lgkmcnt(3)
ds_read_b128 a[204:207], v2 offset:3072
v_mfma_f32_16x16x32_bf16 a[112:115], a[240:243], v[220:223], a[112:115]
buffer_load_dwordx4 v1, s[36:39], s72 offen offset:3072 lds
v_mfma_f32_16x16x32_bf16 a[116:119], a[244:247], v[220:223], a[116:119]
v_exp_f32 v156, v156
v_mfma_f32_16x16x32_bf16 a[116:119], a[212:215], v[204:207], a[116:119]
ds_read_b128 a[208:211], v2 offset:4096
v_mfma_f32_16x16x32_bf16 a[120:123], a[216:219], v[204:207], a[120:123]
buffer_load_dwordx4 v[80:83], v15, s[4:7], s80 offen
v_mfma_f32_16x16x32_bf16 a[120:123], a[248:251], v[220:223], a[120:123]
s_add_u32 s80, s80, 0x4000
v_exp_f32 v157, v157
v_mfma_f32_16x16x32_bf16 a[124:127], a[252:255], v[220:223], a[124:127]
ds_read_b128 a[212:215], v2 offset:5120
v_mfma_f32_16x16x32_bf16 a[124:127], a[220:223], v[204:207], a[124:127]
ds_read_b128 a[216:219], v2 offset:6144
v_cvt_pk_bf16_f32 v204, v140, v141
s_cmp_eq_u32 s58, 2
s_cbranch_scc1 Lta37
s_cmp_eq_u32 s58, 3
s_cbranch_scc1 Lnt38
v_mfma_f32_16x16x32_bf16 v[172:175], a[160:163], v[64:67], v[112:115]
buffer_load_dwordx4 v[84:87], v15, s[4:7], s80 offen
v_mfma_f32_16x16x32_bf16 v[188:191], a[176:179], v[64:67], v[112:115]
s_add_u32 s80, s80, 0x4000
v_exp_f32 v158, v158
s_branch Ljoin39
Lta37:
v_mfma_f32_16x16x32_bf16 v[172:175], a[160:163], v[64:67], v[108:111]
buffer_load_dwordx4 v[84:87], v15, s[4:7], s80 offen
v_mfma_f32_16x16x32_bf16 v[188:191], a[176:179], v[64:67], v[112:115]
s_add_u32 s80, s80, 0x4000
v_exp_f32 v158, v158
s_branch Ljoin39
Lnt38:
v_mfma_f32_16x16x32_bf16 v[172:175], a[160:163], v[64:67], v[92:95]
buffer_load_dwordx4 v[84:87], v15, s[4:7], s80 offen
v_mfma_f32_16x16x32_bf16 v[188:191], a[176:179], v[64:67], v[108:111]
s_add_u32 s80, s80, 0x4000
v_exp_f32 v158, v158
Ljoin39:
v_mfma_f32_16x16x32_bf16 v[172:175], a[164:167], v[68:71], v[172:175]
ds_read_b128 a[220:223], v2 offset:7168
v_cvt_pk_bf16_f32 v205, v142, v143
v_mfma_f32_16x16x32_bf16 v[172:175], a[168:171], v[72:75], v[172:175]
buffer_load_dwordx4 v[96:99], v15, s[4:7], s80 offen
v_mfma_f32_16x16x32_bf16 v[172:175], a[172:175], v[76:79], v[172:175]
s_add_u32 s80, s80, 0x4000
v_exp_f32 v159, v159
v_mfma_f32_16x16x32_bf16 v[188:191], a[188:191], v[76:79], v[188:191]
buffer_load_dwordx4 v[100:103], v15, s[4:7], s80 offen
v_mfma_f32_16x16x32_bf16 v[188:191], a[184:187], v[72:75], v[188:191]
v_cvt_pk_bf16_f32 v206, v156, v157
v_cvt_pk_bf16_f32 v207, v158, v159
v_mfma_f32_16x16x32_bf16 v[188:191], a[180:183], v[68:71], v[188:191]
s_waitcnt lgkmcnt(4)
v_mfma_f32_16x16x32_bf16 v[232:235], v[120:123], v[216:219], v[232:235]
s_add_u32 s82, s82, 0x8000
v_exp_f32 v172, v172
v_mfma_f32_16x16x32_bf16 a[64:67], a[224:227], v[216:219], a[64:67]
s_and_b32 s82, s82, 0x1ffff
ds_read_b128 a[224:227], v2 offset:8192
v_mfma_f32_16x16x32_bf16 a[68:71], a[228:231], v[216:219], a[68:71]
ds_read_b128 a[228:231], v2 offset:9216
v_mfma_f32_16x16x32_bf16 a[72:75], a[232:235], v[216:219], a[72:75]
v_exp_f32 v173, v173
v_mfma_f32_16x16x32_bf16 a[76:79], a[236:239], v[216:219], a[76:79]
s_nop 0
ds_read_b128 a[232:235], v2 offset:10240
ds_read_b128 a[236:239], v2 offset:11264
v_mfma_f32_16x16x32_bf16 a[80:83], a[240:243], v[216:219], a[80:83]
ds_read_b128 a[240:243], v2 offset:12288
v_cvt_pk_bf16_f32 v220, v172, v173
v_mfma_f32_16x16x32_bf16 a[84:87], a[244:247], v[216:219], a[84:87]
ds_read_b128 a[244:247], v2 offset:13312
v_mfma_f32_16x16x32_bf16 a[88:91], a[248:251], v[216:219], a[88:91]
v_exp_f32 v174, v174
v_mfma_f32_16x16x32_bf16 a[92:95], a[252:255], v[216:219], a[92:95]
v_exp_f32 v175, v175
ds_read_b128 a[248:251], v2 offset:14336
ds_read_b128 a[252:255], v2 offset:15360
v_add_u32 v2, s82, v1
v_exp_f32 v188, v188
v_cvt_pk_bf16_f32 v221, v174, v175
v_exp_f32 v189, v189
v_exp_f32 v190, v190
v_cvt_pk_bf16_f32 v222, v188, v189
v_exp_f32 v191, v191
s_nop 0
v_cvt_pk_bf16_f32 v223, v190, v191
s_waitcnt vmcnt(4) lgkmcnt(0)
s_barrier
LHT4:
Lstub7:
s_cbranch_execz Lstub11
v_mfma_f32_16x16x32_bf16 v[236:239], v[120:123], v[204:207], v[236:239]
ds_write_b64 v5, v[12:13]
v_mov_b32 v240, 0
v_mfma_f32_16x16x32_bf16 v[236:239], v[120:123], v[220:223], v[236:239]
v_mov_b32 v241, 0
v_mfma_f32_16x16x32_bf16 a[96:99], a[192:195], v[204:207], a[96:99]
s_nop 0
ds_write_b64 v14, v[240:241]
ds_read_b64 a[128:129], v6 offset:0
v_mfma_f32_16x16x32_bf16 a[96:99], a[224:227], v[220:223], a[96:99]
s_nop 0
ds_read_b64 a[130:131], v6 offset:8
ds_read_b128 a[192:195], v7 offset:3584
v_mfma_f32_16x16x32_bf16 a[100:103], a[228:231], v[220:223], a[100:103]
s_nop 0
ds_read_b64 a[132:133], v6 offset:512
ds_read_b64 a[134:135], v6 offset:520
v_mfma_f32_16x16x32_bf16 a[100:103], a[196:199], v[204:207], a[100:103]
s_nop 0
ds_read_b128 a[196:199], v7 offset:3072
ds_read_b64 a[136:137], v6 offset:1024
v_mfma_f32_16x16x32_bf16 a[104:107], a[200:203], v[204:207], a[104:107]
s_nop 0
ds_read_b64 a[138:139], v6 offset:1032
ds_read_b128 a[200:203], v7 offset:2560
v_mfma_f32_16x16x32_bf16 a[104:107], a[232:235], v[220:223], a[104:107]
v_mfma_f32_16x16x32_bf16 a[108:111], a[236:239], v[220:223], a[108:111]
s_nop 0
ds_read_b64 a[140:141], v6 offset:1536
ds_read_b64 a[142:143], v6 offset:1544
v_mfma_f32_16x16x32_bf16 a[108:111], a[204:207], v[204:207], a[108:111]
s_nop 0
ds_read_b128 a[204:207], v7 offset:2048
ds_read_b64 a[144:145], v6 offset:2048
v_mfma_f32_16x16x32_bf16 a[112:115], a[208:211], v[204:207], a[112:115]
s_lshl_b32 s73, s52, 12
ds_read_b64 a[146:147], v6 offset:2056
ds_read_b128 a[208:211], v7 offset:1536
v_mfma_f32_16x16x32_bf16 a[112:115], a[240:243], v[220:223], a[112:115]
s_add_u32 s73, s73, 0x2000000
v_mfma_f32_16x16x32_bf16 a[116:119], a[244:247], v[220:223], a[116:119]
s_lshl_b32 s70, s68, 2
ds_read_b64 a[148:149], v6 offset:2560
ds_read_b64 a[150:151], v6 offset:2568
v_mfma_f32_16x16x32_bf16 a[116:119], a[212:215], v[204:207], a[116:119]
s_add_u32 s70, s70, s73
ds_read_b128 a[212:215], v7 offset:1024
ds_read_b64 a[152:153], v6 offset:3072
v_mfma_f32_16x16x32_bf16 a[120:123], a[216:219], v[204:207], a[120:123]
s_nop 0
ds_read_b64 a[154:155], v6 offset:3080
ds_read_b128 a[216:219], v7 offset:512
v_mfma_f32_16x16x32_bf16 a[120:123], a[248:251], v[220:223], a[120:123]
v_mfma_f32_16x16x32_bf16 a[124:127], a[252:255], v[220:223], a[124:127]
s_xor_b32 s71, s12, 0x80
ds_read_b64 a[156:157], v6 offset:3584
ds_read_b64 a[158:159], v6 offset:3592
v_mfma_f32_16x16x32_bf16 a[124:127], a[220:223], v[204:207], a[124:127]
s_add_u32 m0, s77, 0
ds_read_b128 a[220:223], v7 offset:0
s_waitcnt lgkmcnt(0)
v_mfma_f32_16x16x32_bf16 v[128:131], v[8:11], a[192:195], 0
s_add_u32 s72, s71, 0
buffer_load_dwordx4 v15, s[24:27], s72 offen lds
v_mfma_f32_16x16x32_bf16 v[128:131], a[128:131], a[192:195], v[128:131]
v_mfma_f32_16x16x32_bf16 v[132:135], v[8:11], a[196:199], 0
s_nop 0
ds_read_b128 a[224:227], v7 offset:3648
ds_read_b64 a[160:161], v6 offset:64
v_mfma_f32_16x16x32_bf16 v[132:135], a[128:131], a[196:199], v[132:135]
v_accvgpr_read_b32 v240, a64
v_accvgpr_read_b32 v241, a65
v_accvgpr_read_b32 v242, a66
v_mfma_f32_16x16x32_bf16 v[132:135], a[132:135], a[192:195], v[132:135]
s_add_u32 s72, s71, 15360
buffer_load_dwordx4 v15, s[24:27], s72 offen offset:1024 lds
v_accvgpr_read_b32 v243, a67
v_mfma_f32_16x16x32_bf16 v[136:139], v[8:11], a[200:203], 0
s_nop 0
ds_read_b64 a[162:163], v6 offset:72
ds_read_b128 a[228:231], v7 offset:3136
v_mfma_f32_16x16x32_bf16 v[136:139], a[128:131], a[200:203], v[136:139]
s_lshl_b32 s95, s75, 20
v_rcp_f32 v232, v232
v_mfma_f32_16x16x32_bf16 v[136:139], a[132:135], a[196:199], v[136:139]
s_lshl_b32 s74, s58, 18
v_rcp_f32 v236, v236
v_accvgpr_read_b32 v244, a68
v_mfma_f32_16x16x32_bf16 v[136:139], a[136:139], a[192:195], v[136:139]
s_add_u32 s95, s95, s74
ds_read_b64 a[164:165], v6 offset:576
ds_read_b64 a[166:167], v6 offset:584
v_accvgpr_read_b32 v245, a69
v_mfma_f32_16x16x32_bf16 v[140:143], v[8:11], a[204:207], 0
s_add_u32 s72, s71, 30720
buffer_load_dwordx4 v15, s[24:27], s72 offen offset:2048 lds
v_accvgpr_read_b32 v246, a70
v_mfma_f32_16x16x32_bf16 v[140:143], a[128:131], a[204:207], v[140:143]
s_add_u32 s95, s95, 0x2000000
v_accvgpr_read_b32 v247, a71
v_mul_f32 v240, v240, v232
v_mul_f32 v241, v241, v232
v_mfma_f32_16x16x32_bf16 v[140:143], a[132:135], a[200:203], v[140:143]
s_sub_u32 s74, 15, s75
ds_read_b128 a[232:235], v7 offset:2624
ds_read_b64 a[168:169], v6 offset:1088
v_mul_f32 v242, v242, v232
v_mfma_f32_16x16x32_bf16 v[140:143], a[136:139], a[196:199], v[140:143]
s_add_u32 s72, s71, 46080
buffer_load_dwordx4 v15, s[24:27], s72 offen offset:3072 lds
v_mul_f32 v243, v243, v232
v_mfma_f32_16x16x32_bf16 v[140:143], a[140:143], a[192:195], v[140:143]
s_min_u32 s74, s74, s75
v_mul_f32 v244, v244, v232
v_mul_f32 v245, v245, v232
v_mul_f32 v246, v246, v232
v_mfma_f32_16x16x32_bf16 v[144:147], v[8:11], a[208:211], 0
s_lshl_b32 s74, s74, 7
ds_read_b64 a[170:171], v6 offset:1096
ds_read_b128 a[236:239], v7 offset:2112
v_mul_f32 v247, v247, v232
v_mfma_f32_16x16x32_bf16 v[144:147], a[128:131], a[208:211], v[144:147]
s_add_u32 s74, s74, 0x3810000
v_cvt_pk_bf16_f32 v240, v240, v241
v_cvt_pk_bf16_f32 v241, v242, v243
v_cvt_pk_bf16_f32 v242, v244, v245
v_mfma_f32_16x16x32_bf16 v[144:147], a[132:135], a[204:207], v[144:147]
s_xor_b32 s85, s77, 0x10000
v_cvt_pk_bf16_f32 v243, v246, v247
v_mfma_f32_16x16x32_bf16 v[144:147], a[136:139], a[200:203], v[144:147]
s_nop 0
ds_read_b64 a[172:173], v6 offset:1600
ds_read_b64 a[174:175], v6 offset:1608
v_mfma_f32_16x16x32_bf16 v[144:147], a[140:143], a[196:199], v[144:147]
Lstub8:
s_cbranch_execz Lret
buffer_store_dwordx4 v[240:243], v1, s[44:47], s70 offen sc1
v_mfma_f32_16x16x32_bf16 v[144:147], a[144:147], a[192:195], v[144:147]
v_accvgpr_read_b32 v248, a72
v_accvgpr_read_b32 v249, a73
v_accvgpr_read_b32 v250, a74
v_mfma_f32_16x16x32_bf16 v[148:151], v[8:11], a[212:215], 0
s_nop 0
ds_read_b128 a[240:243], v7 offset:1600
ds_read_b64 a[176:177], v6 offset:2112
v_accvgpr_read_b32 v251, a75
v_mfma_f32_16x16x32_bf16 v[148:151], a[128:131], a[212:215], v[148:151]
v_accvgpr_read_b32 v252, a76
v_accvgpr_read_b32 v253, a77
v_accvgpr_read_b32 v254, a78
v_mfma_f32_16x16x32_bf16 v[148:151], a[132:135], a[208:211], v[148:151]
v_accvgpr_read_b32 v255, a79
v_mul_f32 v248, v248, v232
v_mul_f32 v249, v249, v232
v_mfma_f32_16x16x32_bf16 v[148:151], a[136:139], a[204:207], v[148:151]
s_nop 0
ds_read_b64 a[178:179], v6 offset:2120
ds_read_b128 a[244:247], v7 offset:1088
v_mul_f32 v250, v250, v232
v_mfma_f32_16x16x32_bf16 v[148:151], a[140:143], a[200:203], v[148:151]
v_mul_f32 v251, v251, v232
v_mul_f32 v252, v252, v232
v_mul_f32 v253, v253, v232
v_mfma_f32_16x16x32_bf16 v[148:151], a[144:147], a[196:199], v[148:151]
v_mul_f32 v254, v254, v232
v_mul_f32 v255, v255, v232
v_cvt_pk_bf16_f32 v248, v248, v249
v_mfma_f32_16x16x32_bf16 v[148:151], a[148:151], a[192:195], v[148:151]
s_nop 0
ds_read_b64 a[180:181], v6 offset:2624
ds_read_b64 a[182:183], v6 offset:2632
v_cvt_pk_bf16_f32 v249, v250, v251
v_mfma_f32_16x16x32_bf16 v[152:155], v[8:11], a[216:219], 0
v_cvt_pk_bf16_f32 v250, v252, v253
v_cvt_pk_bf16_f32 v251, v254, v255
v_mfma_f32_16x16x32_bf16 v[152:155], a[128:131], a[216:219], v[152:155]
buffer_store_dwordx4 v[248:251], v1, s[44:47], s70 offen offset:1024 sc1
v_mfma_f32_16x16x32_bf16 v[152:155], a[132:135], a[212:215], v[152:155]
s_nop 0
ds_read_b128 a[248:251], v7 offset:576
ds_read_b64 a[184:185], v6 offset:3136
v_accvgpr_read_b32 v240, a80
v_mfma_f32_16x16x32_bf16 v[152:155], a[136:139], a[208:211], v[152:155]
v_accvgpr_read_b32 v241, a81
v_accvgpr_read_b32 v242, a82
v_accvgpr_read_b32 v243, a83
v_mfma_f32_16x16x32_bf16 v[152:155], a[140:143], a[204:207], v[152:155]
v_accvgpr_read_b32 v244, a84
v_accvgpr_read_b32 v245, a85
v_accvgpr_read_b32 v246, a86
v_mfma_f32_16x16x32_bf16 v[152:155], a[144:147], a[200:203], v[152:155]
s_nop 0
ds_read_b64 a[186:187], v6 offset:3144
ds_read_b128 a[252:255], v7 offset:64
v_accvgpr_read_b32 v247, a87
v_mfma_f32_16x16x32_bf16 v[152:155], a[148:151], a[196:199], v[152:155]
v_mul_f32 v240, v240, v232
v_mul_f32 v241, v241, v232
v_mul_f32 v242, v242, v232
v_mfma_f32_16x16x32_bf16 v[152:155], a[152:155], a[192:195], v[152:155]
v_mul_f32 v243, v243, v232
v_mul_f32 v244, v244, v232
v_mul_f32 v245, v245, v232
v_mfma_f32_16x16x32_bf16 v[156:159], v[8:11], a[220:223], 0
s_nop 0
ds_read_b64 a[188:189], v6 offset:3648
ds_read_b64 a[190:191], v6 offset:3656
v_mul_f32 v246, v246, v232
v_mfma_f32_16x16x32_bf16 v[156:159], a[128:131], a[220:223], v[156:159]
v_mul_f32 v247, v247, v232
v_cvt_pk_bf16_f32 v240, v240, v241
v_cvt_pk_bf16_f32 v241, v242, v243
v_mfma_f32_16x16x32_bf16 v[156:159], a[132:135], a[216:219], v[156:159]
v_cvt_pk_bf16_f32 v242, v244, v245
v_cvt_pk_bf16_f32 v243, v246, v247
v_mfma_f32_16x16x32_bf16 v[156:159], a[136:139], a[212:215], v[156:159]
buffer_store_dwordx4 v[240:243], v1, s[44:47], s70 offen offset:2048 sc1
v_mfma_f32_16x16x32_bf16 v[156:159], a[140:143], a[208:211], v[156:159]
v_accvgpr_read_b32 v248, a88
v_accvgpr_read_b32 v249, a89
v_accvgpr_read_b32 v250, a90
v_mfma_f32_16x16x32_bf16 v[156:159], a[144:147], a[204:207], v[156:159]
v_accvgpr_read_b32 v251, a91
v_accvgpr_read_b32 v252, a92
v_accvgpr_read_b32 v253, a93
v_mfma_f32_16x16x32_bf16 v[156:159], a[148:151], a[200:203], v[156:159]
v_accvgpr_read_b32 v254, a94
v_accvgpr_read_b32 v255, a95
v_mul_f32 v248, v248, v232
v_mfma_f32_16x16x32_bf16 v[156:159], a[152:155], a[196:199], v[156:159]
v_mul_f32 v249, v249, v232
v_mul_f32 v250, v250, v232
v_mul_f32 v251, v251, v232
v_mfma_f32_16x16x32_bf16 v[156:159], a[156:159], a[192:195], v[156:159]
s_waitcnt lgkmcnt(0)
v_mul_f32 v252, v252, v232
v_mul_f32 v253, v253, v232
v_mul_f32 v254, v254, v232
v_mfma_f32_16x16x32_bf16 v[128:131], a[160:163], a[224:227], v[128:131]
s_nop 0
ds_read_b128 a[192:195], v7 offset:3712
ds_read_b64 a[128:129], v6 offset:128
v_mul_f32 v255, v255, v232
v_mfma_f32_16x16x32_bf16 v[132:135], a[164:167], a[224:227], v[132:135]
v_cvt_pk_bf16_f32 v248, v248, v249
v_cvt_pk_bf16_f32 v249, v250, v251
v_cvt_pk_bf16_f32 v250, v252, v253
v_mfma_f32_16x16x32_bf16 v[132:135], a[160:163], a[228:231], v[132:135]
s_nop 0
ds_read_b64 a[130:131], v6 offset:136
ds_read_b128 a[196:199], v7 offset:3200
v_cvt_pk_bf16_f32 v251, v254, v255
v_mfma_f32_16x16x32_bf16 v[136:139], a[160:163], a[232:235], v[136:139]
buffer_store_dwordx4 v[248:251], v1, s[44:47], s70 offen offset:3072 sc1
v_mfma_f32_16x16x32_bf16 v[136:139], a[164:167], a[228:231], v[136:139]
s_add_u32 s70, s70, 0x80000
v_accvgpr_read_b32 v240, a96
v_accvgpr_read_b32 v241, a97
v_accvgpr_read_b32 v242, a98
v_mfma_f32_16x16x32_bf16 v[136:139], a[168:171], a[224:227], v[136:139]
s_nop 0
ds_read_b64 a[132:133], v6 offset:640
ds_read_b64 a[134:135], v6 offset:648
v_accvgpr_read_b32 v243, a99
v_mfma_f32_16x16x32_bf16 v[140:143], a[172:175], a[224:227], v[140:143]
v_accvgpr_read_b32 v244, a100
v_accvgpr_read_b32 v245, a101
v_accvgpr_read_b32 v246, a102
v_mfma_f32_16x16x32_bf16 v[140:143], a[168:171], a[228:231], v[140:143]
s_nop 0
ds_read_b128 a[200:203], v7 offset:2688
ds_read_b64 a[136:137], v6 offset:1152
v_accvgpr_read_b32 v247, a103
v_mfma_f32_16x16x32_bf16 v[140:143], a[164:167], a[232:235], v[140:143]
v_mul_f32 v240, v240, v236
v_mul_f32 v241, v241, v236
v_mul_f32 v242, v242, v236
v_mfma_f32_16x16x32_bf16 v[140:143], a[160:163], a[236:239], v[140:143]
v_mul_f32 v243, v243, v236
v_mul_f32 v244, v244, v236
v_mul_f32 v245, v245, v236
v_mfma_f32_16x16x32_bf16 v[144:147], a[160:163], a[240:243], v[144:147]
s_nop 0
ds_read_b64 a[138:139], v6 offset:1160
ds_read_b128 a[204:207], v7 offset:2176
v_mul_f32 v246, v246, v236
v_mfma_f32_16x16x32_bf16 v[144:147], a[164:167], a[236:239], v[144:147]
v_mul_f32 v247, v247, v236
v_cvt_pk_bf16_f32 v240, v240, v241
v_cvt_pk_bf16_f32 v241, v242, v243
v_mfma_f32_16x16x32_bf16 v[144:147], a[168:171], a[232:235], v[144:147]
s_nop 0
ds_read_b64 a[140:141], v6 offset:1664
ds_read_b64 a[142:143], v6 offset:1672
v_cvt_pk_bf16_f32 v242, v244, v245
v_mfma_f32_16x16x32_bf16 v[144:147], a[172:175], a[228:231], v[144:147]
v_cvt_pk_bf16_f32 v243, v246, v247
v_mfma_f32_16x16x32_bf16 v[144:147], a[176:179], a[224:227], v[144:147]
buffer_store_dwordx4 v[240:243], v1, s[44:47], s70 offen sc1
v_mfma_f32_16x16x32_bf16 v[148:151], a[180:183], a[224:227], v[148:151]
s_nop 0
ds_read_b128 a[208:211], v7 offset:1664
ds_read_b64 a[144:145], v6 offset:2176
v_accvgpr_read_b32 v248, a104
v_mfma_f32_16x16x32_bf16 v[148:151], a[176:179], a[228:231], v[148:151]
v_accvgpr_read_b32 v249, a105
v_accvgpr_read_b32 v250, a106
v_accvgpr_read_b32 v251, a107
v_mfma_f32_16x16x32_bf16 v[148:151], a[172:175], a[232:235], v[148:151]
v_accvgpr_read_b32 v252, a108
v_accvgpr_read_b32 v253, a109
v_accvgpr_read_b32 v254, a110
v_mfma_f32_16x16x32_bf16 v[148:151], a[168:171], a[236:239], v[148:151]
s_nop 0
ds_read_b64 a[146:147], v6 offset:2184
ds_read_b128 a[212:215], v7 offset:1152
v_accvgpr_read_b32 v255, a111
v_mfma_f32_16x16x32_bf16 v[148:151], a[164:167], a[240:243], v[148:151]
v_mul_f32 v248, v248, v236
v_mul_f32 v249, v249, v236
v_mul_f32 v250, v250, v236
v_mfma_f32_16x16x32_bf16 v[148:151], a[160:163], a[244:247], v[148:151]
s_nop 0
ds_read_b64 a[148:149], v6 offset:2688
ds_read_b64 a[150:151], v6 offset:2696
v_mul_f32 v251, v251, v236
v_mfma_f32_16x16x32_bf16 v[152:155], a[160:163], a[248:251], v[152:155]
v_mul_f32 v252, v252, v236
v_mul_f32 v253, v253, v236
v_mul_f32 v254, v254, v236
v_mfma_f32_16x16x32_bf16 v[152:155], a[164:167], a[244:247], v[152:155]
v_mul_f32 v255, v255, v236
v_cvt_pk_bf16_f32 v248, v248, v249
v_cvt_pk_bf16_f32 v249, v250, v251
v_mfma_f32_16x16x32_bf16 v[152:155], a[168:171], a[240:243], v[152:155]
s_nop 0
ds_read_b128 a[216:219], v7 offset:640
ds_read_b64 a[152:153], v6 offset:3200
v_cvt_pk_bf16_f32 v250, v252, v253
v_mfma_f32_16x16x32_bf16 v[152:155], a[172:175], a[236:239], v[152:155]
v_cvt_pk_bf16_f32 v251, v254, v255
v_mfma_f32_16x16x32_bf16 v[152:155], a[176:179], a[232:235], v[152:155]
s_nop 0
ds_read_b64 a[154:155], v6 offset:3208
ds_read_b128 a[220:223], v7 offset:128
v_mfma_f32_16x16x32_bf16 v[152:155], a[180:183], a[228:231], v[152:155]
buffer_store_dwordx4 v[248:251], v1, s[44:47], s70 offen offset:1024 sc1
v_mfma_f32_16x16x32_bf16 v[152:155], a[184:187], a[224:227], v[152:155]
v_accvgpr_read_b32 v240, a112
v_accvgpr_read_b32 v241, a113
v_accvgpr_read_b32 v242, a114
v_mfma_f32_16x16x32_bf16 v[156:159], a[188:191], a[224:227], v[156:159]
s_nop 0
ds_read_b64 a[156:157], v6 offset:3712
ds_read_b64 a[158:159], v6 offset:3720
v_accvgpr_read_b32 v243, a115
v_mfma_f32_16x16x32_bf16 v[156:159], a[184:187], a[228:231], v[156:159]
v_accvgpr_read_b32 v244, a116
v_accvgpr_read_b32 v245, a117
v_accvgpr_read_b32 v246, a118
v_mfma_f32_16x16x32_bf16 v[156:159], a[180:183], a[232:235], v[156:159]
v_accvgpr_read_b32 v247, a119
v_mul_f32 v240, v240, v236
v_mul_f32 v241, v241, v236
v_mfma_f32_16x16x32_bf16 v[156:159], a[176:179], a[236:239], v[156:159]
v_mul_f32 v242, v242, v236
v_mul_f32 v243, v243, v236
v_mul_f32 v244, v244, v236
v_mfma_f32_16x16x32_bf16 v[156:159], a[172:175], a[240:243], v[156:159]
v_mul_f32 v245, v245, v236
v_mul_f32 v246, v246, v236
v_mul_f32 v247, v247, v236
v_mfma_f32_16x16x32_bf16 v[156:159], a[168:171], a[244:247], v[156:159]
v_cvt_pk_bf16_f32 v240, v240, v241
v_cvt_pk_bf16_f32 v241, v242, v243
v_cvt_pk_bf16_f32 v242, v244, v245
v_mfma_f32_16x16x32_bf16 v[156:159], a[164:167], a[248:251], v[156:159]
v_cvt_pk_bf16_f32 v243, v246, v247
v_mfma_f32_16x16x32_bf16 v[156:159], a[160:163], a[252:255], v[156:159]
s_waitcnt lgkmcnt(0)
buffer_store_dwordx4 v[240:243], v1, s[44:47], s70 offen offset:2048 sc1
v_mfma_f32_16x16x32_bf16 v[128:131], a[128:131], a[192:195], v[128:131]
s_nop 0
ds_read_b128 a[224:227], v7 offset:3776
ds_read_b64 a[160:161], v6 offset:192
v_accvgpr_read_b32 v248, a120
v_mfma_f32_16x16x32_bf16 v[132:135], a[132:135], a[192:195], v[132:135]
v_accvgpr_read_b32 v249, a121
v_accvgpr_read_b32 v250, a122
v_accvgpr_read_b32 v251, a123
v_mfma_f32_16x16x32_bf16 v[132:135], a[128:131], a[196:199], v[132:135]
s_nop 0
ds_read_b64 a[162:163], v6 offset:200
ds_read_b128 a[228:231], v7 offset:3264
v_accvgpr_read_b32 v252, a124
v_mfma_f32_16x16x32_bf16 v[136:139], a[128:131], a[200:203], v[136:139]
v_accvgpr_read_b32 v253, a125
v_accvgpr_read_b32 v254, a126
v_accvgpr_read_b32 v255, a127
v_mfma_f32_16x16x32_bf16 v[136:139], a[132:135], a[196:199], v[136:139]
v_mul_f32 v248, v248, v236
v_mul_f32 v249, v249, v236
v_mul_f32 v250, v250, v236
v_mfma_f32_16x16x32_bf16 v[136:139], a[136:139], a[192:195], v[136:139]
s_nop 0
ds_read_b64 a[164:165], v6 offset:704
ds_read_b64 a[166:167], v6 offset:712
v_mul_f32 v251, v251, v236
v_mfma_f32_16x16x32_bf16 v[140:143], a[140:143], a[192:195], v[140:143]
v_mul_f32 v252, v252, v236
v_mul_f32 v253, v253, v236
v_mul_f32 v254, v254, v236
v_mfma_f32_16x16x32_bf16 v[140:143], a[136:139], a[196:199], v[140:143]
s_nop 0
ds_read_b128 a[232:235], v7 offset:2752
ds_read_b64 a[168:169], v6 offset:1216
v_mul_f32 v255, v255, v236
v_mfma_f32_16x16x32_bf16 v[140:143], a[132:135], a[200:203], v[140:143]
v_cvt_pk_bf16_f32 v248, v248, v249
v_cvt_pk_bf16_f32 v249, v250, v251
v_cvt_pk_bf16_f32 v250, v252, v253
v_mfma_f32_16x16x32_bf16 v[140:143], a[128:131], a[204:207], v[140:143]
v_cvt_pk_bf16_f32 v251, v254, v255
v_mfma_f32_16x16x32_bf16 v[144:147], a[128:131], a[208:211], v[144:147]
s_nop 0
ds_read_b64 a[170:171], v6 offset:1224
ds_read_b128 a[236:239], v7 offset:2240
v_mfma_f32_16x16x32_bf16 v[144:147], a[132:135], a[204:207], v[144:147]
buffer_store_dwordx4 v[248:251], v1, s[44:47], s70 offen offset:3072 sc1
v_mfma_f32_16x16x32_bf16 v[144:147], a[136:139], a[200:203], v[144:147]
s_mov_b32 s73, 0x5d800000
ds_read_b64 a[172:173], v6 offset:1728
ds_read_b64 a[174:175], v6 offset:1736
v_add_f32 v227, v226, v230
v_mfma_f32_16x16x32_bf16 v[144:147], a[140:143], a[196:199], v[144:147]
v_add_f32 v231, v234, v238
v_add_f32 v227, v227, v231
v_cmp_nlt_f32 vcc, v227, s73
v_mfma_f32_16x16x32_bf16 v[144:147], a[144:147], a[192:195], v[144:147]
s_lshl_b32 s73, s58, 2
v_mfma_f32_16x16x32_bf16 v[148:151], a[148:151], a[192:195], v[148:151]
s_add_u32 s73, s73, 163328
ds_read_b128 a[240:243], v7 offset:1728
ds_read_b64 a[176:177], v6 offset:2240
v_mov_b32 v231, s73
v_mfma_f32_16x16x32_bf16 v[148:151], a[144:147], a[196:199], v[148:151]
s_or_b32 s73, vcc_lo, vcc_hi
v_mfma_f32_16x16x32_bf16 v[148:151], a[140:143], a[200:203], v[148:151]
s_min_u32 s73, s73, 1
v_mov_b32 v227, s73
v_mfma_f32_16x16x32_bf16 v[148:151], a[136:139], a[204:207], v[148:151]
s_nop 0
ds_read_b64 a[178:179], v6 offset:2248
ds_read_b128 a[244:247], v7 offset:1216
ds_write_b32 v231, v227
v_mfma_f32_16x16x32_bf16 v[148:151], a[132:135], a[208:211], v[148:151]
v_mfma_f32_16x16x32_bf16 v[148:151], a[128:131], a[212:215], v[148:151]
s_nop 0
ds_read_b64 a[180:181], v6 offset:2752
ds_read_b64 a[182:183], v6 offset:2760
v_mfma_f32_16x16x32_bf16 v[152:155], a[128:131], a[216:219], v[152:155]
v_mfma_f32_16x16x32_bf16 v[152:155], a[132:135], a[212:215], v[152:155]
v_mfma_f32_16x16x32_bf16 v[152:155], a[136:139], a[208:211], v[152:155]
s_nop 0
ds_read_b128 a[248:251], v7 offset:704
ds_read_b64 a[184:185], v6 offset:3264
v_mfma_f32_16x16x32_bf16 v[152:155], a[140:143], a[204:207], v[152:155]
v_mfma_f32_16x16x32_bf16 v[152:155], a[144:147], a[200:203], v[152:155]
s_nop 0
ds_read_b64 a[186:187], v6 offset:3272
ds_read_b128 a[252:255], v7 offset:192
v_mfma_f32_16x16x32_bf16 v[152:155], a[148:151], a[196:199], v[152:155]
v_mfma_f32_16x16x32_bf16 v[152:155], a[152:155], a[192:195], v[152:155]
v_mfma_f32_16x16x32_bf16 v[156:159], a[156:159], a[192:195], v[156:159]
s_nop 0
ds_read_b64 a[188:189], v6 offset:3776
ds_read_b64 a[190:191], v6 offset:3784
v_mfma_f32_16x16x32_bf16 v[156:159], a[152:155], a[196:199], v[156:159]
v_mfma_f32_16x16x32_bf16 v[156:159], a[148:151], a[200:203], v[156:159]
v_mfma_f32_16x16x32_bf16 v[156:159], a[144:147], a[204:207], v[156:159]
v_mfma_f32_16x16x32_bf16 v[156:159], a[140:143], a[208:211], v[156:159]
v_mfma_f32_16x16x32_bf16 v[156:159], a[136:139], a[212:215], v[156:159]
v_mfma_f32_16x16x32_bf16 v[156:159], a[132:135], a[216:219], v[156:159]
v_mfma_f32_16x16x32_bf16 v[156:159], a[128:131], a[220:223], v[156:159]
s_waitcnt lgkmcnt(0)
v_mfma_f32_16x16x32_bf16 v[128:131], a[160:163], a[224:227], v[128:131]
s_nop 0
ds_read_b128 a[192:195], v7 offset:3840
ds_read_b64 a[128:129], v6 offset:256
v_mfma_f32_16x16x32_bf16 v[132:135], a[164:167], a[224:227], v[132:135]
v_mfma_f32_16x16x32_bf16 v[132:135], a[160:163], a[228:231], v[132:135]
s_nop 0
ds_read_b64 a[130:131], v6 offset:264
ds_read_b128 a[196:199], v7 offset:3328
v_mfma_f32_16x16x32_bf16 v[136:139], a[160:163], a[232:235], v[136:139]
v_mfma_f32_16x16x32_bf16 v[136:139], a[164:167], a[228:231], v[136:139]
v_mfma_f32_16x16x32_bf16 v[136:139], a[168:171], a[224:227], v[136:139]
s_nop 0
ds_read_b64 a[132:133], v6 offset:768
ds_read_b64 a[134:135], v6 offset:776
v_mfma_f32_16x16x32_bf16 v[140:143], a[172:175], a[224:227], v[140:143]
v_mfma_f32_16x16x32_bf16 v[140:143], a[168:171], a[228:231], v[140:143]
s_nop 0
ds_read_b128 a[200:203], v7 offset:2816
ds_read_b64 a[136:137], v6 offset:1280
v_mfma_f32_16x16x32_bf16 v[140:143], a[164:167], a[232:235], v[140:143]
v_mfma_f32_16x16x32_bf16 v[140:143], a[160:163], a[236:239], v[140:143]
v_mfma_f32_16x16x32_bf16 v[144:147], a[160:163], a[240:243], v[144:147]
s_nop 0
ds_read_b64 a[138:139], v6 offset:1288
ds_read_b128 a[204:207], v7 offset:2304
v_mfma_f32_16x16x32_bf16 v[144:147], a[164:167], a[236:239], v[144:147]
s_nop 3
s_mov_b64 exec, 0
s_cmp_eq_u32 s58, 0
s_cbranch_scc1 Lstube0
s_cmp_eq_u32 s58, 1
s_cbranch_scc1 Lstube1
s_cmp_eq_u32 s58, 2
s_cbranch_scc1 Lstube2
s_branch Lstube3
Lrete:
s_mov_b64 exec, -1
s_nop 3
v_mfma_f32_16x16x32_bf16 v[144:147], a[168:171], a[232:235], v[144:147]
s_waitcnt vmcnt(0) lgkmcnt(15)
ds_read_b64 a[140:141], v6 offset:1792
ds_read_b64 a[142:143], v6 offset:1800
v_mfma_f32_16x16x32_bf16 v[144:147], a[172:175], a[228:231], v[144:147]
s_barrier
v_mov_b32 v244, 163328
v_mfma_f32_16x16x32_bf16 v[144:147], a[176:179], a[224:227], v[144:147]
s_xor_b32 s71, s12, 0x100
ds_read_b128 v[240:243], v244
v_mfma_f32_16x16x32_bf16 v[148:151], a[180:183], a[224:227], v[148:151]
s_add_u32 m0, s77, 16384
ds_read_b128 a[208:211], v7 offset:1792
ds_read_b64 a[144:145], v6 offset:2304
v_mfma_f32_16x16x32_bf16 v[148:151], a[176:179], a[228:231], v[148:151]
s_add_u32 s72, s71, 0
buffer_load_dwordx4 v15, s[24:27], s72 offen lds
v_mfma_f32_16x16x32_bf16 v[148:151], a[172:175], a[232:235], v[148:151]
v_mfma_f32_16x16x32_bf16 v[148:151], a[168:171], a[236:239], v[148:151]
s_nop 0
ds_read_b64 a[146:147], v6 offset:2312
ds_read_b128 a[212:215], v7 offset:1280
v_mfma_f32_16x16x32_bf16 v[148:151], a[164:167], a[240:243], v[148:151]
s_add_u32 s72, s71, 15360
buffer_load_dwordx4 v15, s[24:27], s72 offen offset:1024 lds
v_mfma_f32_16x16x32_bf16 v[148:151], a[160:163], a[244:247], v[148:151]
s_waitcnt lgkmcnt(4)
ds_read_b64 a[148:149], v6 offset:2816
ds_read_b64 a[150:151], v6 offset:2824
v_mfma_f32_16x16x32_bf16 v[152:155], a[160:163], a[248:251], v[152:155]
v_or3_b32 v240, v240, v241, v242
v_or_b32 v240, v240, v243
v_mfma_f32_16x16x32_bf16 v[152:155], a[164:167], a[244:247], v[152:155]
v_cmp_lt_u32 vcc, s86, v240
s_cbranch_vccnz Lslow
v_mfma_f32_16x16x32_bf16 v[152:155], a[168:171], a[240:243], v[152:155]
s_nop 0
ds_read_b128 a[216:219], v7 offset:768
ds_read_b64 a[152:153], v6 offset:3328
v_mfma_f32_16x16x32_bf16 v[152:155], a[172:175], a[236:239], v[152:155]
v_or_b32 v240, s58, v0
v_mov_b32 v241, 2
v_mfma_f32_16x16x32_bf16 v[152:155], a[176:179], a[232:235], v[152:155]
s_add_u32 s72, s71, 30720
ds_read_b64 a[154:155], v6 offset:3336
ds_read_b128 a[220:223], v7 offset:256
v_mfma_f32_16x16x32_bf16 v[152:155], a[180:183], a[228:231], v[152:155]
buffer_load_dwordx4 v15, s[24:27], s72 offen offset:2048 lds
v_mfma_f32_16x16x32_bf16 v[152:155], a[184:187], a[224:227], v[152:155]
v_min_u32 v240, 1, v240
v_lshlrev_b32 v240, 30, v240
v_mfma_f32_16x16x32_bf16 v[156:159], a[188:191], a[224:227], v[156:159]
s_nop 0
ds_read_b64 a[156:157], v6 offset:3840
ds_read_b64 a[158:159], v6 offset:3848
v_mfma_f32_16x16x32_bf16 v[156:159], a[184:187], a[228:231], v[156:159]
buffer_store_dword v241, v240, s[44:47], s91 offen sc1
v_mfma_f32_16x16x32_bf16 v[156:159], a[180:183], a[232:235], v[156:159]
s_add_u32 s80, s93, 0x3400000
v_and_b32 v166, 7, v0
v_lshlrev_b32 v166, 4, v166
v_mfma_f32_16x16x32_bf16 v[156:159], a[176:179], a[236:239], v[156:159]
s_add_u32 s72, s71, 46080
buffer_load_dwordx4 v15, s[24:27], s72 offen offset:3072 lds
v_mfma_f32_16x16x32_bf16 v[156:159], a[172:175], a[240:243], v[156:159]
v_bfe_u32 v112, v0, 3, 1
v_lshl_add_u32 v166, v112, 8, v166
v_mfma_f32_16x16x32_bf16 v[156:159], a[168:171], a[244:247], v[156:159]
v_bfe_u32 v112, v0, 4, 1
v_lshl_add_u32 v166, v112, 7, v166
v_mfma_f32_16x16x32_bf16 v[156:159], a[164:167], a[248:251], v[156:159]
v_lshrrev_b32 v2, 4, v0
v_lshlrev_b32 v2, 10, v2
v_mfma_f32_16x16x32_bf16 v[156:159], a[160:163], a[252:255], v[156:159]
s_waitcnt lgkmcnt(0)
v_lshrrev_b32 v112, 5, v0
v_lshl_add_u32 v166, v112, 9, v166
v_mfma_f32_16x16x32_bf16 v[128:131], a[128:131], a[192:195], v[128:131]
s_xor_b32 s82, s78, 0
ds_read_b128 a[224:227], v7 offset:3904
ds_read_b64 a[160:161], v6 offset:320
v_mfma_f32_16x16x32_bf16 v[132:135], a[132:135], a[192:195], v[132:135]
s_xor_b32 s71, s12, 0x180
v_and_b32 v112, 15, v0
v_lshrrev_b32 v113, 2, v0
v_mfma_f32_16x16x32_bf16 v[132:135], a[128:131], a[196:199], v[132:135]
s_add_u32 m0, s77, 32768
ds_read_b64 a[162:163], v6 offset:328
ds_read_b128 a[228:231], v7 offset:3392
v_mfma_f32_16x16x32_bf16 v[136:139], a[128:131], a[200:203], v[136:139]
s_add_u32 s72, s71, 0
buffer_load_dwordx4 v15, s[24:27], s72 offen lds
v_mfma_f32_16x16x32_bf16 v[136:139], a[132:135], a[196:199], v[136:139]
s_lshl_b32 s82, s82, 10
v_bfe_u32 v114, v0, 3, 2
v_and_b32 v115, 3, v0
v_mfma_f32_16x16x32_bf16 v[136:139], a[136:139], a[192:195], v[136:139]
s_add_u32 s82, s82, s74
ds_read_b64 a[164:165], v6 offset:832
ds_read_b64 a[166:167], v6 offset:840
v_mfma_f32_16x16x32_bf16 v[140:143], a[140:143], a[192:195], v[140:143]
buffer_load_dword v3, v2, s[44:47], s82 offen sc1
v_mfma_f32_16x16x32_bf16 v[140:143], a[136:139], a[196:199], v[140:143]
s_add_u32 s72, s71, 15360
ds_read_b128 a[232:235], v7 offset:2880
ds_read_b64 a[168:169], v6 offset:1344
v_mfma_f32_16x16x32_bf16 v[140:143], a[132:135], a[200:203], v[140:143]
buffer_load_dwordx4 v15, s[24:27], s72 offen offset:1024 lds
v_mfma_f32_16x16x32_bf16 v[140:143], a[128:131], a[204:207], v[140:143]
v_lshlrev_b32 v8, 7, v113
v_lshl_add_u32 v8, v114, 5, v8
v_mfma_f32_16x16x32_bf16 v[144:147], a[128:131], a[208:211], v[144:147]
s_nop 0
ds_read_b64 a[170:171], v6 offset:1352
ds_read_b128 a[236:239], v7 offset:2368
v_mfma_f32_16x16x32_bf16 v[144:147], a[132:135], a[204:207], v[144:147]
v_lshl_add_u32 v8, v115, 3, v8
v_add_u32 v8, s77, v8
v_mfma_f32_16x16x32_bf16 v[144:147], a[136:139], a[200:203], v[144:147]
s_nop 0
ds_read_b64 a[172:173], v6 offset:1856
ds_read_b64 a[174:175], v6 offset:1864
v_mfma_f32_16x16x32_bf16 v[144:147], a[140:143], a[196:199], v[144:147]
s_add_u32 s72, s71, 30720
buffer_load_dwordx4 v15, s[24:27], s72 offen offset:2048 lds
v_mfma_f32_16x16x32_bf16 v[144:147], a[144:147], a[192:195], v[144:147]
v_subrev_u32 v8, s64, v8
v_xor_b32 v9, 32, v8
v_mfma_f32_16x16x32_bf16 v[148:151], a[148:151], a[192:195], v[148:151]
s_nop 0
ds_read_b128 a[240:243], v7 offset:1856
ds_read_b64 a[176:177], v6 offset:2368
v_mfma_f32_16x16x32_bf16 v[148:151], a[144:147], a[196:199], v[148:151]
v_xor_b32 v10, 64, v8
v_xor_b32 v11, 0x60, v8
v_mfma_f32_16x16x32_bf16 v[148:151], a[140:143], a[200:203], v[148:151]
v_lshlrev_b32 v5, 8, v113
v_and_b32 v114, 1, v0
v_mfma_f32_16x16x32_bf16 v[148:151], a[136:139], a[204:207], v[148:151]
s_nop 0
ds_read_b64 a[178:179], v6 offset:2376
ds_read_b128 a[244:247], v7 offset:1344
v_mfma_f32_16x16x32_bf16 v[148:151], a[132:135], a[208:211], v[148:151]
s_add_u32 s72, s71, 46080
buffer_load_dwordx4 v15, s[24:27], s72 offen offset:3072 lds
v_mfma_f32_16x16x32_bf16 v[148:151], a[128:131], a[212:215], v[148:151]
s_nop 0
ds_read_b64 a[180:181], v6 offset:2880
ds_read_b64 a[182:183], v6 offset:2888
v_mfma_f32_16x16x32_bf16 v[152:155], a[128:131], a[216:219], v[152:155]
v_lshl_add_u32 v5, v114, 7, v5
v_bfe_u32 v114, v0, 1, 1
v_mfma_f32_16x16x32_bf16 v[152:155], a[132:135], a[212:215], v[152:155]
v_lshl_add_u32 v5, v114, 3, v5
v_lshlrev_b32 v114, 1, s58
v_mfma_f32_16x16x32_bf16 v[152:155], a[136:139], a[208:211], v[152:155]
s_nop 0
ds_read_b128 a[248:251], v7 offset:832
ds_read_b64 a[184:185], v6 offset:3392
v_mfma_f32_16x16x32_bf16 v[152:155], a[140:143], a[204:207], v[152:155]
v_xor_b32 v114, v114, v113
v_and_b32 v114, 7, v114
v_mfma_f32_16x16x32_bf16 v[152:155], a[144:147], a[200:203], v[152:155]
s_xor_b32 s71, s13, 0x80
ds_read_b64 a[186:187], v6 offset:3400
ds_read_b128 a[252:255], v7 offset:320
v_mfma_f32_16x16x32_bf16 v[152:155], a[148:151], a[196:199], v[152:155]
s_add_u32 m0, s77, 49152
v_lshl_add_u32 v5, v114, 4, v5
v_add_u32 v5, 147456, v5
v_mfma_f32_16x16x32_bf16 v[152:155], a[152:155], a[192:195], v[152:155]
s_add_u32 s72, s71, 0
buffer_load_dwordx4 v15, s[24:27], s72 offen lds
v_mfma_f32_16x16x32_bf16 v[156:159], a[156:159], a[192:195], v[156:159]
s_nop 0
ds_read_b64 a[188:189], v6 offset:3904
ds_read_b64 a[190:191], v6 offset:3912
v_mfma_f32_16x16x32_bf16 v[156:159], a[152:155], a[196:199], v[156:159]
v_bfe_u32 v114, v0, 1, 2
v_lshrrev_b32 v115, 4, v0
v_mfma_f32_16x16x32_bf16 v[156:159], a[148:151], a[200:203], v[156:159]
v_lshlrev_b32 v116, 7, v112
v_lshl_add_u32 v116, v114, 5, v116
v_mfma_f32_16x16x32_bf16 v[156:159], a[144:147], a[204:207], v[156:159]
s_add_u32 s72, s71, 15360
buffer_load_dwordx4 v15, s[24:27], s72 offen offset:1024 lds
v_mfma_f32_16x16x32_bf16 v[156:159], a[140:143], a[208:211], v[156:159]
v_lshl_add_u32 v116, v115, 3, v116
v_add_u32 v116, s64, v116
v_mfma_f32_16x16x32_bf16 v[156:159], a[136:139], a[212:215], v[156:159]
v_add_u32 v116, 131072, v116
v_xor_b32 v117, 32, v116
v_mfma_f32_16x16x32_bf16 v[156:159], a[132:135], a[216:219], v[156:159]
v_xor_b32 v118, 64, v116
v_xor_b32 v119, 0x60, v116
v_mfma_f32_16x16x32_bf16 v[156:159], a[128:131], a[220:223], v[156:159]
s_waitcnt lgkmcnt(0)
v_mfma_f32_16x16x32_bf16 v[128:131], a[160:163], a[224:227], v[128:131]
s_nop 0
ds_read_b128 a[192:195], v7 offset:3968
ds_read_b64 a[128:129], v6 offset:384
v_mfma_f32_16x16x32_bf16 v[132:135], a[164:167], a[224:227], v[132:135]
s_add_u32 s72, s71, 30720
buffer_load_dwordx4 v15, s[24:27], s72 offen offset:2048 lds
v_mfma_f32_16x16x32_bf16 v[132:135], a[160:163], a[228:231], v[132:135]
s_nop 0
ds_read_b64 a[130:131], v6 offset:392
Lstub9:
s_cbranch_execz Lret
ds_read_b128 a[196:199], v7 offset:3456
v_mfma_f32_16x16x32_bf16 v[136:139], a[160:163], a[232:235], v[136:139]
v_mfma_f32_16x16x32_bf16 v[136:139], a[164:167], a[228:231], v[136:139]
v_mfma_f32_16x16x32_bf16 v[136:139], a[168:171], a[224:227], v[136:139]
s_nop 0
ds_read_b64 a[132:133], v6 offset:896
ds_read_b64 a[134:135], v6 offset:904
v_mfma_f32_16x16x32_bf16 v[140:143], a[172:175], a[224:227], v[140:143]
v_mfma_f32_16x16x32_bf16 v[140:143], a[168:171], a[228:231], v[140:143]
s_add_u32 s72, s71, 46080
ds_read_b128 a[200:203], v7 offset:2944
ds_read_b64 a[136:137], v6 offset:1408
v_mfma_f32_16x16x32_bf16 v[140:143], a[164:167], a[232:235], v[140:143]
buffer_load_dwordx4 v15, s[24:27], s72 offen offset:3072 lds
v_mfma_f32_16x16x32_bf16 v[140:143], a[160:163], a[236:239], v[140:143]
v_mfma_f32_16x16x32_bf16 v[144:147], a[160:163], a[240:243], v[144:147]
s_nop 0
ds_read_b64 a[138:139], v6 offset:1416
ds_read_b128 a[204:207], v7 offset:2432
v_mfma_f32_16x16x32_bf16 v[144:147], a[164:167], a[236:239], v[144:147]
v_mfma_f32_16x16x32_bf16 v[144:147], a[168:171], a[232:235], v[144:147]
s_nop 0
ds_read_b64 a[140:141], v6 offset:1920
ds_read_b64 a[142:143], v6 offset:1928
v_mfma_f32_16x16x32_bf16 v[144:147], a[172:175], a[228:231], v[144:147]
v_mfma_f32_16x16x32_bf16 v[144:147], a[176:179], a[224:227], v[144:147]
v_mfma_f32_16x16x32_bf16 v[148:151], a[180:183], a[224:227], v[148:151]
s_nop 0
ds_read_b128 a[208:211], v7 offset:1920
ds_read_b64 a[144:145], v6 offset:2432
v_mfma_f32_16x16x32_bf16 v[148:151], a[176:179], a[228:231], v[148:151]
v_mfma_f32_16x16x32_bf16 v[148:151], a[172:175], a[232:235], v[148:151]
s_waitcnt vmcnt(7)
v_cmp_gt_u32 vcc, 2, v3
s_or_b32 s81, vcc_lo, vcc_hi
s_cselect_b32 s81, 0x40000000, 0
v_or_b32 v4, s81, v1
v_mfma_f32_16x16x32_bf16 v[148:151], a[168:171], a[236:239], v[148:151]
s_nop 0
ds_read_b64 a[146:147], v6 offset:2440
ds_read_b128 a[212:215], v7 offset:1408
v_mfma_f32_16x16x32_bf16 v[148:151], a[164:167], a[240:243], v[148:151]
v_mfma_f32_16x16x32_bf16 v[148:151], a[160:163], a[244:247], v[148:151]
s_nop 0
ds_read_b64 a[148:149], v6 offset:2944
ds_read_b64 a[150:151], v6 offset:2952
v_mfma_f32_16x16x32_bf16 v[152:155], a[160:163], a[248:251], v[152:155]
v_mfma_f32_16x16x32_bf16 v[152:155], a[164:167], a[244:247], v[152:155]
s_lshr_b32 s69, s12, 18
v_mfma_f32_16x16x32_bf16 v[152:155], a[168:171], a[240:243], v[152:155]
s_lshl_b32 s69, s69, 12
ds_read_b128 a[216:219], v7 offset:896
ds_read_b64 a[152:153], v6 offset:3456
v_mfma_f32_16x16x32_bf16 v[152:155], a[172:175], a[236:239], v[152:155]
s_add_u32 s69, s69, s95
buffer_load_dwordx4 a[0:3], v4, s[44:47], s69 offen sc1
v_mfma_f32_16x16x32_bf16 v[152:155], a[176:179], a[232:235], v[152:155]
s_nop 0
ds_read_b64 a[154:155], v6 offset:3464
ds_read_b128 a[220:223], v7 offset:384
v_mfma_f32_16x16x32_bf16 v[152:155], a[180:183], a[228:231], v[152:155]
v_mfma_f32_16x16x32_bf16 v[152:155], a[184:187], a[224:227], v[152:155]
v_mfma_f32_16x16x32_bf16 v[156:159], a[188:191], a[224:227], v[156:159]
s_nop 0
ds_read_b64 a[156:157], v6 offset:3968
ds_read_b64 a[158:159], v6 offset:3976
v_mfma_f32_16x16x32_bf16 v[156:159], a[184:187], a[228:231], v[156:159]
buffer_load_dwordx4 a[4:7], v4, s[44:47], s69 offen offset:1024 sc1
v_mfma_f32_16x16x32_bf16 v[156:159], a[180:183], a[232:235], v[156:159]
v_mfma_f32_16x16x32_bf16 v[156:159], a[176:179], a[236:239], v[156:159]
v_mfma_f32_16x16x32_bf16 v[156:159], a[172:175], a[240:243], v[156:159]
v_mfma_f32_16x16x32_bf16 v[156:159], a[168:171], a[244:247], v[156:159]
buffer_load_dwordx4 a[8:11], v4, s[44:47], s69 offen offset:2048 sc1
v_mfma_f32_16x16x32_bf16 v[156:159], a[164:167], a[248:251], v[156:159]
v_mfma_f32_16x16x32_bf16 v[156:159], a[160:163], a[252:255], v[156:159]
s_waitcnt lgkmcnt(0)
v_mfma_f32_16x16x32_bf16 v[128:131], a[128:131], a[192:195], v[128:131]
s_nop 0
ds_read_b128 a[224:227], v7 offset:4032
ds_read_b64 a[160:161], v6 offset:448
v_mfma_f32_16x16x32_bf16 v[132:135], a[132:135], a[192:195], v[132:135]
v_mfma_f32_16x16x32_bf16 v[132:135], a[128:131], a[196:199], v[132:135]
s_nop 0
ds_read_b64 a[162:163], v6 offset:456
ds_read_b128 a[228:231], v7 offset:3520
v_mfma_f32_16x16x32_bf16 v[136:139], a[128:131], a[200:203], v[136:139]
buffer_load_dwordx4 a[12:15], v4, s[44:47], s69 offen offset:3072 sc1
v_mfma_f32_16x16x32_bf16 v[136:139], a[132:135], a[196:199], v[136:139]
v_mfma_f32_16x16x32_bf16 v[136:139], a[136:139], a[192:195], v[136:139]
s_nop 0
ds_read_b64 a[164:165], v6 offset:960
ds_read_b64 a[166:167], v6 offset:968
v_mfma_f32_16x16x32_bf16 v[140:143], a[140:143], a[192:195], v[140:143]
v_mfma_f32_16x16x32_bf16 v[140:143], a[136:139], a[196:199], v[140:143]
s_nop 0
ds_read_b128 a[232:235], v7 offset:3008
ds_read_b64 a[168:169], v6 offset:1472
v_mfma_f32_16x16x32_bf16 v[140:143], a[132:135], a[200:203], v[140:143]
s_add_u32 s69, s69, 0x20000
buffer_load_dwordx4 a[16:19], v4, s[44:47], s69 offen sc1
v_mfma_f32_16x16x32_bf16 v[140:143], a[128:131], a[204:207], v[140:143]
v_mfma_f32_16x16x32_bf16 v[144:147], a[128:131], a[208:211], v[144:147]
s_nop 0
ds_read_b64 a[170:171], v6 offset:1480
ds_read_b128 a[236:239], v7 offset:2496
v_mfma_f32_16x16x32_bf16 v[144:147], a[132:135], a[204:207], v[144:147]
v_mfma_f32_16x16x32_bf16 v[144:147], a[136:139], a[200:203], v[144:147]
s_nop 0
ds_read_b64 a[172:173], v6 offset:1984
ds_read_b64 a[174:175], v6 offset:1992
v_mfma_f32_16x16x32_bf16 v[144:147], a[140:143], a[196:199], v[144:147]
buffer_load_dwordx4 a[20:23], v4, s[44:47], s69 offen offset:1024 sc1
v_mfma_f32_16x16x32_bf16 v[144:147], a[144:147], a[192:195], v[144:147]
v_mfma_f32_16x16x32_bf16 v[148:151], a[148:151], a[192:195], v[148:151]
s_nop 0
ds_read_b128 a[240:243], v7 offset:1984
ds_read_b64 a[176:177], v6 offset:2496
v_mfma_f32_16x16x32_bf16 v[148:151], a[144:147], a[196:199], v[148:151]
v_mfma_f32_16x16x32_bf16 v[148:151], a[140:143], a[200:203], v[148:151]
v_mfma_f32_16x16x32_bf16 v[148:151], a[136:139], a[204:207], v[148:151]
s_nop 0
ds_read_b64 a[178:179], v6 offset:2504
ds_read_b128 a[244:247], v7 offset:1472
v_mfma_f32_16x16x32_bf16 v[148:151], a[132:135], a[208:211], v[148:151]
buffer_load_dwordx4 a[24:27], v4, s[44:47], s69 offen offset:2048 sc1
v_mfma_f32_16x16x32_bf16 v[148:151], a[128:131], a[212:215], v[148:151]
s_nop 0
ds_read_b64 a[180:181], v6 offset:3008
ds_read_b64 a[182:183], v6 offset:3016
v_mfma_f32_16x16x32_bf16 v[152:155], a[128:131], a[216:219], v[152:155]
v_mfma_f32_16x16x32_bf16 v[152:155], a[132:135], a[212:215], v[152:155]
v_mfma_f32_16x16x32_bf16 v[152:155], a[136:139], a[208:211], v[152:155]
s_nop 0
ds_read_b128 a[248:251], v7 offset:960
ds_read_b64 a[184:185], v6 offset:3520
v_mfma_f32_16x16x32_bf16 v[152:155], a[140:143], a[204:207], v[152:155]
buffer_load_dwordx4 a[28:31], v4, s[44:47], s69 offen offset:3072 sc1
v_mfma_f32_16x16x32_bf16 v[152:155], a[144:147], a[200:203], v[152:155]
s_nop 0
ds_read_b64 a[186:187], v6 offset:3528
ds_read_b128 a[252:255], v7 offset:448
v_mfma_f32_16x16x32_bf16 v[152:155], a[148:151], a[196:199], v[152:155]
v_mfma_f32_16x16x32_bf16 v[152:155], a[152:155], a[192:195], v[152:155]
s_lshr_b32 s69, s13, 18
v_mfma_f32_16x16x32_bf16 v[156:159], a[156:159], a[192:195], v[156:159]
s_lshl_b32 s69, s69, 12
ds_read_b64 a[188:189], v6 offset:4032
ds_read_b64 a[190:191], v6 offset:4040
v_mfma_f32_16x16x32_bf16 v[156:159], a[152:155], a[196:199], v[156:159]
s_add_u32 s69, s69, s95
buffer_load_dwordx4 a[32:35], v4, s[44:47], s69 offen sc1
v_mfma_f32_16x16x32_bf16 v[156:159], a[148:151], a[200:203], v[156:159]
v_mfma_f32_16x16x32_bf16 v[156:159], a[144:147], a[204:207], v[156:159]
v_mfma_f32_16x16x32_bf16 v[156:159], a[140:143], a[208:211], v[156:159]
v_mfma_f32_16x16x32_bf16 v[156:159], a[136:139], a[212:215], v[156:159]
buffer_load_dwordx4 a[36:39], v4, s[44:47], s69 offen offset:1024 sc1
v_mfma_f32_16x16x32_bf16 v[156:159], a[132:135], a[216:219], v[156:159]
v_mfma_f32_16x16x32_bf16 v[156:159], a[128:131], a[220:223], v[156:159]
s_waitcnt lgkmcnt(0)
v_mfma_f32_16x16x32_bf16 v[128:131], a[160:163], a[224:227], v[128:131]
s_nop 0
ds_read_b64_tr_b16 v[192:193], v8 offset:0
ds_read_b64_tr_b16 v[194:195], v8 offset:2048
v_mfma_f32_16x16x32_bf16 v[132:135], a[164:167], a[224:227], v[132:135]
v_mfma_f32_16x16x32_bf16 v[132:135], a[160:163], a[228:231], v[132:135]
s_nop 0
ds_read_b64_tr_b16 v[196:197], v9 offset:0
ds_read_b64_tr_b16 v[198:199], v9 offset:2048
v_mfma_f32_16x16x32_bf16 v[136:139], a[160:163], a[232:235], v[136:139]
buffer_load_dwordx4 a[40:43], v4, s[44:47], s69 offen offset:2048 sc1
v_mfma_f32_16x16x32_bf16 v[136:139], a[164:167], a[228:231], v[136:139]
s_nop 0
ds_read_b64_tr_b16 v[200:201], v10 offset:0
ds_read_b64_tr_b16 v[202:203], v10 offset:2048
v_mfma_f32_16x16x32_bf16 v[136:139], a[168:171], a[224:227], v[136:139]
v_mfma_f32_16x16x32_bf16 v[140:143], a[172:175], a[224:227], v[140:143]
s_nop 0
ds_read_b64_tr_b16 v[204:205], v11 offset:0
ds_read_b64_tr_b16 v[206:207], v11 offset:2048
v_mfma_f32_16x16x32_bf16 v[140:143], a[168:171], a[228:231], v[140:143]
v_cvt_pk_bf16_f32 v128, v128, v129
v_cvt_pk_bf16_f32 v129, v130, v131
v_cvt_pk_bf16_f32 v130, v132, v133
v_mfma_f32_16x16x32_bf16 v[140:143], a[164:167], a[232:235], v[140:143]
s_nop 0
ds_read_b64_tr_b16 v[208:209], v8 offset:4096
ds_read_b64_tr_b16 v[210:211], v8 offset:6144
v_cvt_pk_bf16_f32 v131, v134, v135
v_mfma_f32_16x16x32_bf16 v[140:143], a[160:163], a[236:239], v[140:143]
s_nop 0
buffer_load_dwordx4 a[44:47], v4, s[44:47], s69 offen offset:3072 sc1
v_permlane32_swap_b32 v128, v130
v_mfma_f32_16x16x32_bf16 v[144:147], a[160:163], a[240:243], v[144:147]
s_nop 0
ds_read_b64_tr_b16 v[212:213], v9 offset:4096
ds_read_b64_tr_b16 v[214:215], v9 offset:6144
v_permlane32_swap_b32 v129, v131
v_mfma_f32_16x16x32_bf16 v[144:147], a[164:167], a[236:239], v[144:147]
buffer_store_dwordx4 v[128:131], v166, s[44:47], s80 offen sc1
v_mfma_f32_16x16x32_bf16 v[144:147], a[168:171], a[232:235], v[144:147]
s_nop 0
ds_read_b64_tr_b16 v[216:217], v10 offset:4096
ds_read_b64_tr_b16 v[218:219], v10 offset:6144
v_mfma_f32_16x16x32_bf16 v[144:147], a[172:175], a[228:231], v[144:147]
s_add_u32 s69, s69, 0x20000
buffer_load_dwordx4 a[48:51], v4, s[44:47], s69 offen sc1
v_mfma_f32_16x16x32_bf16 v[144:147], a[176:179], a[224:227], v[144:147]
s_nop 0
ds_read_b64_tr_b16 v[220:221], v11 offset:4096
ds_read_b64_tr_b16 v[222:223], v11 offset:6144
v_cvt_pk_bf16_f32 v136, v136, v137
v_mfma_f32_16x16x32_bf16 v[148:151], a[180:183], a[224:227], v[148:151]
v_cvt_pk_bf16_f32 v137, v138, v139
v_cvt_pk_bf16_f32 v138, v140, v141
v_cvt_pk_bf16_f32 v139, v142, v143
v_mfma_f32_16x16x32_bf16 v[148:151], a[176:179], a[228:231], v[148:151]
s_nop 0
ds_read_b64_tr_b16 v[224:225], v8 offset:8192
ds_read_b64_tr_b16 v[226:227], v8 offset:10240
v_permlane32_swap_b32 v136, v138
v_mfma_f32_16x16x32_bf16 v[148:151], a[172:175], a[232:235], v[148:151]
v_permlane32_swap_b32 v137, v139
v_mfma_f32_16x16x32_bf16 v[148:151], a[168:171], a[236:239], v[148:151]
s_nop 0
ds_read_b64_tr_b16 v[228:229], v9 offset:8192
ds_read_b64_tr_b16 v[230:231], v9 offset:10240
v_mfma_f32_16x16x32_bf16 v[148:151], a[164:167], a[240:243], v[148:151]
buffer_load_dwordx4 a[52:55], v4, s[44:47], s69 offen offset:1024 sc1
v_mfma_f32_16x16x32_bf16 v[148:151], a[160:163], a[244:247], v[148:151]
s_nop 0
ds_read_b64_tr_b16 v[232:233], v10 offset:8192
ds_read_b64_tr_b16 v[234:235], v10 offset:10240
v_mfma_f32_16x16x32_bf16 v[152:155], a[160:163], a[248:251], v[152:155]
buffer_store_dwordx4 v[136:139], v166, s[44:47], s80 offen offset:1024 sc1
v_mfma_f32_16x16x32_bf16 v[152:155], a[164:167], a[244:247], v[152:155]
s_nop 0
ds_read_b64_tr_b16 v[236:237], v11 offset:8192
ds_read_b64_tr_b16 v[238:239], v11 offset:10240
v_mfma_f32_16x16x32_bf16 v[152:155], a[168:171], a[240:243], v[152:155]
buffer_load_dwordx4 a[56:59], v4, s[44:47], s69 offen offset:2048 sc1
v_mfma_f32_16x16x32_bf16 v[152:155], a[172:175], a[236:239], v[152:155]
s_nop 0
ds_read_b64_tr_b16 v[240:241], v8 offset:12288
ds_read_b64_tr_b16 v[242:243], v8 offset:14336
v_mfma_f32_16x16x32_bf16 v[152:155], a[176:179], a[232:235], v[152:155]
v_cvt_pk_bf16_f32 v144, v144, v145
v_cvt_pk_bf16_f32 v145, v146, v147
v_cvt_pk_bf16_f32 v146, v148, v149
v_mfma_f32_16x16x32_bf16 v[152:155], a[180:183], a[228:231], v[152:155]
s_nop 0
ds_read_b64_tr_b16 v[244:245], v9 offset:12288
ds_read_b64_tr_b16 v[246:247], v9 offset:14336
v_cvt_pk_bf16_f32 v147, v150, v151
v_mfma_f32_16x16x32_bf16 v[152:155], a[184:187], a[224:227], v[152:155]
v_permlane32_swap_b32 v144, v146
v_permlane32_swap_b32 v145, v147
v_mfma_f32_16x16x32_bf16 v[156:159], a[188:191], a[224:227], v[156:159]
s_nop 0
ds_read_b64_tr_b16 v[248:249], v10 offset:12288
ds_read_b64_tr_b16 v[250:251], v10 offset:14336
v_mfma_f32_16x16x32_bf16 v[156:159], a[184:187], a[228:231], v[156:159]
buffer_load_dwordx4 a[60:63], v4, s[44:47], s69 offen offset:3072 sc1
v_mfma_f32_16x16x32_bf16 v[156:159], a[180:183], a[232:235], v[156:159]
s_nop 0
ds_read_b64_tr_b16 v[252:253], v11 offset:12288
ds_read_b64_tr_b16 v[254:255], v11 offset:14336
v_mfma_f32_16x16x32_bf16 v[156:159], a[176:179], a[236:239], v[156:159]
buffer_store_dwordx4 v[144:147], v166, s[44:47], s80 offen offset:2048 sc1
v_mfma_f32_16x16x32_bf16 v[156:159], a[172:175], a[240:243], v[156:159]
v_mfma_f32_16x16x32_bf16 v[156:159], a[168:171], a[244:247], v[156:159]
v_mfma_f32_16x16x32_bf16 v[156:159], a[164:167], a[248:251], v[156:159]
v_mfma_f32_16x16x32_bf16 v[156:159], a[160:163], a[252:255], v[156:159]
v_cvt_pk_bf16_f32 v152, v152, v153
v_cvt_pk_bf16_f32 v153, v154, v155
s_nop 5
v_cvt_pk_bf16_f32 v154, v156, v157
v_cvt_pk_bf16_f32 v155, v158, v159
s_nop 0
v_permlane32_swap_b32 v152, v154
v_permlane32_swap_b32 v153, v155
buffer_store_dwordx4 v[152:155], v166, s[44:47], s80 offen offset:3072 sc1
s_waitcnt vmcnt(12) lgkmcnt(0)
s_cmp_lg_u32 s81, 0
s_cbranch_scc1 Lredo0
Lredo0b:
s_barrier
v_mfma_f32_16x16x32_bf16 v[16:19], v[192:195], a[0:3], 0
s_nop 0
ds_read_b64_tr_b16 v[128:129], v8 offset:16384
ds_read_b64_tr_b16 v[130:131], v8 offset:18432
v_mfma_f32_16x16x32_bf16 v[16:19], v[208:211], a[4:7], v[16:19]
s_xor_b32 s71, s13, 0x100
ds_read_b64_tr_b16 v[132:133], v9 offset:16384
ds_read_b64_tr_b16 v[134:135], v9 offset:18432
v_mfma_f32_16x16x32_bf16 v[16:19], v[224:227], a[8:11], v[16:19]
s_add_u32 m0, s85, 0
ds_read_b64_tr_b16 v[136:137], v10 offset:16384
ds_read_b64_tr_b16 v[138:139], v10 offset:18432
v_mfma_f32_16x16x32_bf16 v[16:19], v[240:243], a[12:15], v[16:19]
s_add_u32 s72, s71, 0
buffer_load_dwordx4 v15, s[24:27], s72 offen lds
v_mfma_f32_16x16x32_bf16 v[32:35], v[240:243], a[28:31], 0
s_lshr_b32 s69, s14, 18
ds_read_b64_tr_b16 v[140:141], v11 offset:16384
ds_read_b64_tr_b16 v[142:143], v11 offset:18432
v_mfma_f32_16x16x32_bf16 v[32:35], v[224:227], a[24:27], v[32:35]
s_lshl_b32 s69, s69, 12
v_add_u32 v4, s64, v1
v_add_u32 v4, 131072, v4
v_mfma_f32_16x16x32_bf16 v[32:35], v[208:211], a[20:23], v[32:35]
s_add_u32 s69, s69, s95
buffer_load_dwordx4 a[64:67], v1, s[44:47], s69 offen sc1
v_mfma_f32_16x16x32_bf16 v[32:35], v[192:195], a[16:19], v[32:35]
s_lshl_b32 s70, s75, 18
ds_read_b64_tr_b16 v[144:145], v8 offset:20480
ds_read_b64_tr_b16 v[146:147], v8 offset:22528
v_mfma_f32_16x16x32_bf16 v[36:39], v[196:199], a[16:19], 0
s_add_u32 s72, s71, 15360
buffer_load_dwordx4 v15, s[24:27], s72 offen offset:1024 lds
v_mfma_f32_16x16x32_bf16 v[36:39], v[212:215], a[20:23], v[36:39]
s_add_u32 s70, s70, s94
ds_read_b64_tr_b16 v[148:149], v9 offset:20480
ds_read_b64_tr_b16 v[150:151], v9 offset:22528
v_mfma_f32_16x16x32_bf16 v[36:39], v[228:231], a[24:27], v[36:39]
s_nop 0
ds_read_b64_tr_b16 v[152:153], v10 offset:20480
ds_read_b64_tr_b16 v[154:155], v10 offset:22528
v_mfma_f32_16x16x32_bf16 v[36:39], v[244:247], a[28:31], v[36:39]
s_nop 0
ds_read_b64_tr_b16 v[156:157], v11 offset:20480
ds_read_b64_tr_b16 v[158:159], v11 offset:22528
v_mfma_f32_16x16x32_bf16 v[20:23], v[244:247], a[12:15], 0
ds_write_b128 v4, v[80:83] offset:0
v_mfma_f32_16x16x32_bf16 v[20:23], v[228:231], a[8:11], v[20:23]
s_nop 0
ds_read_b64_tr_b16 v[160:161], v8 offset:24576
ds_read_b64_tr_b16 v[162:163], v8 offset:26624
v_mfma_f32_16x16x32_bf16 v[20:23], v[212:215], a[4:7], v[20:23]
s_add_u32 s72, s71, 30720
buffer_load_dwordx4 v15, s[24:27], s72 offen offset:2048 lds
v_mfma_f32_16x16x32_bf16 v[20:23], v[196:199], a[0:3], v[20:23]
buffer_load_dwordx4 a[68:71], v1, s[44:47], s69 offen offset:1024 sc1
v_mfma_f32_16x16x32_bf16 v[24:27], v[200:203], a[0:3], 0
s_nop 0
ds_read_b64_tr_b16 v[164:165], v9 offset:24576
ds_read_b64_tr_b16 v[166:167], v9 offset:26624
v_mfma_f32_16x16x32_bf16 v[24:27], v[216:219], a[4:7], v[24:27]
s_nop 0
ds_read_b64_tr_b16 v[168:169], v10 offset:24576
ds_read_b64_tr_b16 v[170:171], v10 offset:26624
v_mfma_f32_16x16x32_bf16 v[24:27], v[232:235], a[8:11], v[24:27]
s_nop 0
ds_read_b64_tr_b16 v[172:173], v11 offset:24576
ds_read_b64_tr_b16 v[174:175], v11 offset:26624
v_mfma_f32_16x16x32_bf16 v[24:27], v[248:251], a[12:15], v[24:27]
ds_write_b128 v4, v[84:87] offset:1024
v_mfma_f32_16x16x32_bf16 v[40:43], v[248:251], a[28:31], 0
s_add_u32 s72, s71, 46080
buffer_load_dwordx4 v15, s[24:27], s72 offen offset:3072 lds
v_mfma_f32_16x16x32_bf16 v[40:43], v[232:235], a[24:27], v[40:43]
s_nop 0
ds_read_b64_tr_b16 v[176:177], v8 offset:28672
ds_read_b64_tr_b16 v[178:179], v8 offset:30720
v_mfma_f32_16x16x32_bf16 v[40:43], v[216:219], a[20:23], v[40:43]
s_nop 0
ds_read_b64_tr_b16 v[180:181], v9 offset:28672
ds_read_b64_tr_b16 v[182:183], v9 offset:30720
v_mfma_f32_16x16x32_bf16 v[40:43], v[200:203], a[16:19], v[40:43]
s_nop 0
ds_read_b64_tr_b16 v[184:185], v10 offset:28672
ds_read_b64_tr_b16 v[186:187], v10 offset:30720
v_mfma_f32_16x16x32_bf16 v[44:47], v[204:207], a[16:19], 0
s_nop 0
ds_read_b64_tr_b16 v[188:189], v11 offset:28672
ds_read_b64_tr_b16 v[190:191], v11 offset:30720
v_mfma_f32_16x16x32_bf16 v[44:47], v[220:223], a[20:23], v[44:47]
buffer_load_dwordx4 a[72:75], v1, s[44:47], s69 offen offset:2048 sc1
v_mfma_f32_16x16x32_bf16 v[44:47], v[236:239], a[24:27], v[44:47]
ds_write_b128 v4, v[96:99] offset:2048
v_mfma_f32_16x16x32_bf16 v[44:47], v[252:255], a[28:31], v[44:47]
s_xor_b32 s71, s13, 0x180
v_mfma_f32_16x16x32_bf16 v[28:31], v[252:255], a[12:15], 0
s_add_u32 m0, s85, 16384
ds_write_b128 v4, v[100:103] offset:3072
v_mfma_f32_16x16x32_bf16 v[28:31], v[236:239], a[8:11], v[28:31]
s_add_u32 s72, s71, 0
v_mfma_f32_16x16x32_bf16 v[28:31], v[220:223], a[4:7], v[28:31]
s_waitcnt vmcnt(31) lgkmcnt(0)
buffer_load_dwordx4 v15, s[24:27], s72 offen lds
v_mfma_f32_16x16x32_bf16 v[28:31], v[204:207], a[0:3], v[28:31]
s_barrier
v_mfma_f32_16x16x32_bf16 v[48:51], v[128:131], a[0:3], 0
s_nop 0
ds_read_b64_tr_b16 v[192:193], v8 offset:32768
ds_read_b64_tr_b16 v[194:195], v8 offset:34816
v_mfma_f32_16x16x32_bf16 v[48:51], v[144:147], a[4:7], v[48:51]
s_nop 0
ds_read_b64_tr_b16 v[196:197], v9 offset:32768
ds_read_b64_tr_b16 v[198:199], v9 offset:34816
v_mfma_f32_16x16x32_bf16 v[48:51], v[160:163], a[8:11], v[48:51]
s_nop 0
ds_read_b64_tr_b16 v[200:201], v10 offset:32768
ds_read_b64_tr_b16 v[202:203], v10 offset:34816
v_mfma_f32_16x16x32_bf16 v[48:51], v[176:179], a[12:15], v[48:51]
s_add_u32 s72, s71, 15360
buffer_load_dwordx4 v15, s[24:27], s72 offen offset:1024 lds
v_mfma_f32_16x16x32_bf16 v[64:67], v[176:179], a[28:31], 0
buffer_load_dwordx4 a[76:79], v1, s[44:47], s69 offen offset:3072 sc1
v_mfma_f32_16x16x32_bf16 v[64:67], v[160:163], a[24:27], v[64:67]
s_nop 0
ds_read_b64_tr_b16 v[204:205], v11 offset:32768
ds_read_b64_tr_b16 v[206:207], v11 offset:34816
v_mfma_f32_16x16x32_bf16 v[64:67], v[144:147], a[20:23], v[64:67]
v_mfma_f32_16x16x32_bf16 v[64:67], v[128:131], a[16:19], v[64:67]
s_nop 0
ds_read_b64_tr_b16 v[208:209], v8 offset:36864
ds_read_b64_tr_b16 v[210:211], v8 offset:38912
v_mfma_f32_16x16x32_bf16 v[68:71], v[132:135], a[16:19], 0
s_nop 0
ds_read_b64_tr_b16 v[212:213], v9 offset:36864
ds_read_b64_tr_b16 v[214:215], v9 offset:38912
v_mfma_f32_16x16x32_bf16 v[68:71], v[148:151], a[20:23], v[68:71]
s_add_u32 s72, s71, 30720
buffer_load_dwordx4 v15, s[24:27], s72 offen offset:2048 lds
v_mfma_f32_16x16x32_bf16 v[68:71], v[164:167], a[24:27], v[68:71]
s_nop 0
ds_read_b64_tr_b16 v[216:217], v10 offset:36864
ds_read_b64_tr_b16 v[218:219], v10 offset:38912
v_mfma_f32_16x16x32_bf16 v[68:71], v[180:183], a[28:31], v[68:71]
s_nop 0
ds_read_b64_tr_b16 v[220:221], v11 offset:36864
ds_read_b64_tr_b16 v[222:223], v11 offset:38912
v_mfma_f32_16x16x32_bf16 v[52:55], v[180:183], a[12:15], 0
v_mfma_f32_16x16x32_bf16 v[52:55], v[164:167], a[8:11], v[52:55]
s_add_u32 s69, s69, 0x20000
buffer_load_dwordx4 a[80:83], v1, s[44:47], s69 offen sc1
v_mfma_f32_16x16x32_bf16 v[52:55], v[148:151], a[4:7], v[52:55]
s_nop 0
ds_read_b64_tr_b16 v[224:225], v8 offset:40960
ds_read_b64_tr_b16 v[226:227], v8 offset:43008
v_mfma_f32_16x16x32_bf16 v[52:55], v[132:135], a[0:3], v[52:55]
s_add_u32 s72, s71, 46080
buffer_load_dwordx4 v15, s[24:27], s72 offen offset:3072 lds
v_mfma_f32_16x16x32_bf16 v[56:59], v[136:139], a[0:3], 0
s_nop 0
ds_read_b64_tr_b16 v[228:229], v9 offset:40960
ds_read_b64_tr_b16 v[230:231], v9 offset:43008
v_mfma_f32_16x16x32_bf16 v[56:59], v[152:155], a[4:7], v[56:59]
s_nop 0
ds_read_b64_tr_b16 v[232:233], v10 offset:40960
ds_read_b64_tr_b16 v[234:235], v10 offset:43008
v_mfma_f32_16x16x32_bf16 v[56:59], v[168:171], a[8:11], v[56:59]
s_nop 0
ds_read_b64_tr_b16 v[236:237], v11 offset:40960
ds_read_b64_tr_b16 v[238:239], v11 offset:43008
v_mfma_f32_16x16x32_bf16 v[56:59], v[184:187], a[12:15], v[56:59]
v_mfma_f32_16x16x32_bf16 v[72:75], v[184:187], a[28:31], 0
s_nop 0
ds_read_b64_tr_b16 v[240:241], v8 offset:45056
ds_read_b64_tr_b16 v[242:243], v8 offset:47104
v_mfma_f32_16x16x32_bf16 v[72:75], v[168:171], a[24:27], v[72:75]
s_nop 0
ds_read_b64_tr_b16 v[244:245], v9 offset:45056
ds_read_b64_tr_b16 v[246:247], v9 offset:47104
v_mfma_f32_16x16x32_bf16 v[72:75], v[152:155], a[20:23], v[72:75]
s_nop 0
ds_read_b64_tr_b16 v[248:249], v10 offset:45056
ds_read_b64_tr_b16 v[250:251], v10 offset:47104
v_mfma_f32_16x16x32_bf16 v[72:75], v[136:139], a[16:19], v[72:75]
s_xor_b32 s71, s14, 0x80
buffer_load_dwordx4 a[84:87], v1, s[44:47], s69 offen offset:1024 sc1
v_mfma_f32_16x16x32_bf16 v[76:79], v[140:143], a[16:19], 0
s_add_u32 m0, s85, 32768
ds_read_b64_tr_b16 v[252:253], v11 offset:45056
ds_read_b64_tr_b16 v[254:255], v11 offset:47104
v_mfma_f32_16x16x32_bf16 v[76:79], v[156:159], a[20:23], v[76:79]
s_add_u32 s72, s71, 0
buffer_load_dwordx4 v15, s[24:27], s72 offen lds
v_mfma_f32_16x16x32_bf16 v[76:79], v[172:175], a[24:27], v[76:79]
v_mfma_f32_16x16x32_bf16 v[76:79], v[188:191], a[28:31], v[76:79]
v_mfma_f32_16x16x32_bf16 v[60:63], v[188:191], a[12:15], 0
v_mfma_f32_16x16x32_bf16 v[60:63], v[172:175], a[8:11], v[60:63]
s_add_u32 s72, s71, 15360
v_mfma_f32_16x16x32_bf16 v[60:63], v[156:159], a[4:7], v[60:63]
s_waitcnt vmcnt(35) lgkmcnt(0)
v_mfma_f32_16x16x32_bf16 v[60:63], v[140:143], a[0:3], v[60:63]
s_barrier
buffer_load_dwordx4 v15, s[24:27], s72 offen offset:1024 lds
v_mfma_f32_16x16x32_bf16 v[80:83], v[192:195], a[0:3], 0
s_nop 0
ds_read_b64_tr_b16 v[128:129], v8 offset:49152
ds_read_b64_tr_b16 v[130:131], v8 offset:51200
v_mfma_f32_16x16x32_bf16 v[80:83], v[208:211], a[4:7], v[80:83]
buffer_load_dwordx4 a[88:91], v1, s[44:47], s69 offen offset:2048 sc1
v_mfma_f32_16x16x32_bf16 v[80:83], v[224:227], a[8:11], v[80:83]
s_nop 0
ds_read_b64_tr_b16 v[132:133], v9 offset:49152
ds_read_b64_tr_b16 v[134:135], v9 offset:51200
v_mfma_f32_16x16x32_bf16 v[80:83], v[240:243], a[12:15], v[80:83]
s_nop 0
ds_read_b64_tr_b16 v[136:137], v10 offset:49152
ds_read_b64_tr_b16 v[138:139], v10 offset:51200
v_mfma_f32_16x16x32_bf16 v[96:99], v[240:243], a[28:31], 0
s_nop 0
ds_read_b64_tr_b16 v[140:141], v11 offset:49152
ds_read_b64_tr_b16 v[142:143], v11 offset:51200
v_mfma_f32_16x16x32_bf16 v[96:99], v[224:227], a[24:27], v[96:99]
s_add_u32 s72, s71, 30720
buffer_load_dwordx4 v15, s[24:27], s72 offen offset:2048 lds
v_mfma_f32_16x16x32_bf16 v[96:99], v[208:211], a[20:23], v[96:99]
v_mfma_f32_16x16x32_bf16 v[96:99], v[192:195], a[16:19], v[96:99]
s_nop 0
ds_read_b64_tr_b16 v[144:145], v8 offset:53248
ds_read_b64_tr_b16 v[146:147], v8 offset:55296
v_mfma_f32_16x16x32_bf16 v[100:103], v[196:199], a[16:19], 0
s_nop 0
ds_read_b64_tr_b16 v[148:149], v9 offset:53248
ds_read_b64_tr_b16 v[150:151], v9 offset:55296
v_mfma_f32_16x16x32_bf16 v[100:103], v[212:215], a[20:23], v[100:103]
s_nop 0
ds_read_b64_tr_b16 v[152:153], v10 offset:53248
ds_read_b64_tr_b16 v[154:155], v10 offset:55296
v_mfma_f32_16x16x32_bf16 v[100:103], v[228:231], a[24:27], v[100:103]
s_nop 0
ds_read_b64_tr_b16 v[156:157], v11 offset:53248
ds_read_b64_tr_b16 v[158:159], v11 offset:55296
v_mfma_f32_16x16x32_bf16 v[100:103], v[244:247], a[28:31], v[100:103]
s_add_u32 s72, s71, 46080
buffer_load_dwordx4 v15, s[24:27], s72 offen offset:3072 lds
v_mfma_f32_16x16x32_bf16 v[84:87], v[244:247], a[12:15], 0
buffer_load_dwordx4 a[92:95], v1, s[44:47], s69 offen offset:3072 sc1
v_mfma_f32_16x16x32_bf16 v[84:87], v[228:231], a[8:11], v[84:87]
v_mfma_f32_16x16x32_bf16 v[84:87], v[212:215], a[4:7], v[84:87]
s_nop 0
ds_read_b64_tr_b16 v[160:161], v8 offset:57344
ds_read_b64_tr_b16 v[162:163], v8 offset:59392
v_mfma_f32_16x16x32_bf16 v[84:87], v[196:199], a[0:3], v[84:87]
s_nop 0
ds_read_b64_tr_b16 v[164:165], v9 offset:57344
ds_read_b64_tr_b16 v[166:167], v9 offset:59392
v_mfma_f32_16x16x32_bf16 v[88:91], v[200:203], a[0:3], 0
s_nop 0
ds_read_b64_tr_b16 v[168:169], v10 offset:57344
ds_read_b64_tr_b16 v[170:171], v10 offset:59392
v_mfma_f32_16x16x32_bf16 v[88:91], v[216:219], a[4:7], v[88:91]
s_xor_b32 s82, s78, 4
ds_read_b64_tr_b16 v[172:173], v11 offset:57344
ds_read_b64_tr_b16 v[174:175], v11 offset:59392
v_mfma_f32_16x16x32_bf16 v[88:91], v[232:235], a[8:11], v[88:91]
s_lshl_b32 s82, s82, 10
v_mfma_f32_16x16x32_bf16 v[88:91], v[248:251], a[12:15], v[88:91]
s_xor_b32 s71, s14, 0x100
ds_read_b64_tr_b16 v[176:177], v8 offset:61440
ds_read_b64_tr_b16 v[178:179], v8 offset:63488
v_mfma_f32_16x16x32_bf16 v[104:107], v[248:251], a[28:31], 0
s_add_u32 m0, s85, 49152
ds_read_b64_tr_b16 v[180:181], v9 offset:61440
ds_read_b64_tr_b16 v[182:183], v9 offset:63488
v_mfma_f32_16x16x32_bf16 v[104:107], v[232:235], a[24:27], v[104:107]
s_add_u32 s72, s71, 0
buffer_load_dwordx4 v15, s[24:27], s72 offen lds
v_mfma_f32_16x16x32_bf16 v[104:107], v[216:219], a[20:23], v[104:107]
s_add_u32 s82, s82, s74
buffer_load_dword v3, v2, s[44:47], s82 offen sc1
v_mfma_f32_16x16x32_bf16 v[104:107], v[200:203], a[16:19], v[104:107]
s_nop 0
ds_read_b64_tr_b16 v[184:185], v10 offset:61440
ds_read_b64_tr_b16 v[186:187], v10 offset:63488
v_mfma_f32_16x16x32_bf16 v[108:111], v[204:207], a[16:19], 0
s_nop 0
ds_read_b64_tr_b16 v[188:189], v11 offset:61440
ds_read_b64_tr_b16 v[190:191], v11 offset:63488
Lstube0:
s_cbranch_execz Lstube4
v_mfma_f32_16x16x32_bf16 v[108:111], v[220:223], a[20:23], v[108:111]
v_mfma_f32_16x16x32_bf16 v[108:111], v[236:239], a[24:27], v[108:111]
s_add_u32 s72, s71, 15360
buffer_load_dwordx4 v15, s[24:27], s72 offen offset:1024 lds
v_mfma_f32_16x16x32_bf16 v[108:111], v[252:255], a[28:31], v[108:111]
s_lshr_b32 s69, s15, 18
v_mfma_f32_16x16x32_bf16 v[92:95], v[252:255], a[12:15], 0
s_lshl_b32 s69, s69, 12
v_xor_b32 v8, 0x10000, v8
v_mfma_f32_16x16x32_bf16 v[92:95], v[236:239], a[8:11], v[92:95]
s_add_u32 s69, s69, s95
v_xor_b32 v9, 0x10000, v9
v_mfma_f32_16x16x32_bf16 v[92:95], v[220:223], a[4:7], v[92:95]
s_waitcnt vmcnt(17) lgkmcnt(0)
v_xor_b32 v10, 0x10000, v10
v_mfma_f32_16x16x32_bf16 v[92:95], v[204:207], a[0:3], v[92:95]
s_barrier
buffer_load_dwordx4 a[96:99], v1, s[44:47], s69 offen sc1
v_xor_b32 v11, 0x10000, v11
v_mfma_f32_16x16x32_bf16 v[16:19], v[128:131], a[32:35], v[16:19]
s_add_u32 s72, s71, 30720
buffer_load_dwordx4 v15, s[24:27], s72 offen offset:2048 lds
v_mfma_f32_16x16x32_bf16 v[16:19], v[144:147], a[36:39], v[16:19]
s_nop 0
ds_read_b64_tr_b16 v[192:193], v8 offset:0
ds_read_b64_tr_b16 v[194:195], v8 offset:2048
v_mfma_f32_16x16x32_bf16 v[16:19], v[160:163], a[40:43], v[16:19]
s_nop 0
ds_read_b64_tr_b16 v[196:197], v9 offset:0
ds_read_b64_tr_b16 v[198:199], v9 offset:2048
v_mfma_f32_16x16x32_bf16 v[16:19], v[176:179], a[44:47], v[16:19]
s_nop 0
ds_read_b64_tr_b16 v[200:201], v10 offset:0
ds_read_b64_tr_b16 v[202:203], v10 offset:2048
v_mfma_f32_16x16x32_bf16 v[32:35], v[176:179], a[60:63], v[32:35]
s_nop 0
ds_read_b64_tr_b16 v[204:205], v11 offset:0
ds_read_b64_tr_b16 v[206:207], v11 offset:2048
v_mfma_f32_16x16x32_bf16 v[32:35], v[160:163], a[56:59], v[32:35]
v_or_b32 v112, s58, v0
v_mov_b32 v113, 3
v_mfma_f32_16x16x32_bf16 v[32:35], v[144:147], a[52:55], v[32:35]
s_add_u32 s72, s71, 46080
buffer_load_dwordx4 v15, s[24:27], s72 offen offset:3072 lds
v_mfma_f32_16x16x32_bf16 v[32:35], v[128:131], a[48:51], v[32:35]
s_nop 0
ds_read_b64_tr_b16 v[208:209], v8 offset:4096
ds_read_b64_tr_b16 v[210:211], v8 offset:6144
v_mfma_f32_16x16x32_bf16 v[36:39], v[132:135], a[48:51], v[36:39]
s_nop 0
ds_read_b64_tr_b16 v[212:213], v9 offset:4096
ds_read_b64_tr_b16 v[214:215], v9 offset:6144
v_mfma_f32_16x16x32_bf16 v[36:39], v[148:151], a[52:55], v[36:39]
buffer_load_dwordx4 a[100:103], v1, s[44:47], s69 offen offset:1024 sc1
v_mfma_f32_16x16x32_bf16 v[36:39], v[164:167], a[56:59], v[36:39]
s_nop 0
ds_read_b64_tr_b16 v[216:217], v10 offset:4096
ds_read_b64_tr_b16 v[218:219], v10 offset:6144
v_mfma_f32_16x16x32_bf16 v[36:39], v[180:183], a[60:63], v[36:39]
v_min_u32 v112, 1, v112
v_lshlrev_b32 v112, 30, v112
v_mfma_f32_16x16x32_bf16 v[20:23], v[180:183], a[44:47], v[20:23]
s_nop 0
ds_read_b64_tr_b16 v[220:221], v11 offset:4096
ds_read_b64_tr_b16 v[222:223], v11 offset:6144
v_mfma_f32_16x16x32_bf16 v[20:23], v[164:167], a[40:43], v[20:23]
s_nop 0
ds_read_b64_tr_b16 v[224:225], v8 offset:8192
ds_read_b64_tr_b16 v[226:227], v8 offset:10240
v_mfma_f32_16x16x32_bf16 v[20:23], v[148:151], a[36:39], v[20:23]
s_xor_b32 s71, s14, 0x180
ds_read_b64_tr_b16 v[228:229], v9 offset:8192
ds_read_b64_tr_b16 v[230:231], v9 offset:10240
v_mfma_f32_16x16x32_bf16 v[20:23], v[132:135], a[32:35], v[20:23]
s_add_u32 m0, s77, 0
buffer_store_dword v113, v112, s[44:47], s91 offen sc1
v_mfma_f32_16x16x32_bf16 v[24:27], v[136:139], a[32:35], v[24:27]
s_add_u32 s72, s71, 0
buffer_load_dwordx4 v15, s[24:27], s72 offen lds
v_mfma_f32_16x16x32_bf16 v[24:27], v[152:155], a[36:39], v[24:27]
s_nop 0
ds_read_b64_tr_b16 v[232:233], v10 offset:8192
ds_read_b64_tr_b16 v[234:235], v10 offset:10240
v_mfma_f32_16x16x32_bf16 v[24:27], v[168:171], a[40:43], v[24:27]
s_nop 0
ds_read_b64_tr_b16 v[236:237], v11 offset:8192
ds_read_b64_tr_b16 v[238:239], v11 offset:10240
v_mfma_f32_16x16x32_bf16 v[24:27], v[184:187], a[44:47], v[24:27]
buffer_load_dwordx4 a[104:107], v1, s[44:47], s69 offen offset:2048 sc1
v_mfma_f32_16x16x32_bf16 v[40:43], v[184:187], a[60:63], v[40:43]
s_nop 0
ds_read_b64_tr_b16 v[240:241], v8 offset:12288
ds_read_b64_tr_b16 v[242:243], v8 offset:14336
v_mfma_f32_16x16x32_bf16 v[40:43], v[168:171], a[56:59], v[40:43]
v_mfma_f32_16x16x32_bf16 v[40:43], v[152:155], a[52:55], v[40:43]
s_add_u32 s72, s71, 15360
buffer_load_dwordx4 v15, s[24:27], s72 offen offset:1024 lds
v_mfma_f32_16x16x32_bf16 v[40:43], v[136:139], a[48:51], v[40:43]
s_nop 0
ds_read_b64_tr_b16 v[244:245], v9 offset:12288
ds_read_b64_tr_b16 v[246:247], v9 offset:14336
v_mfma_f32_16x16x32_bf16 v[44:47], v[140:143], a[48:51], v[44:47]
s_nop 0
ds_read_b64_tr_b16 v[248:249], v10 offset:12288
ds_read_b64_tr_b16 v[250:251], v10 offset:14336
v_mfma_f32_16x16x32_bf16 v[44:47], v[156:159], a[52:55], v[44:47]
s_nop 0
ds_read_b64_tr_b16 v[252:253], v11 offset:12288
ds_read_b64_tr_b16 v[254:255], v11 offset:14336
v_mfma_f32_16x16x32_bf16 v[44:47], v[172:175], a[56:59], v[44:47]
v_mfma_f32_16x16x32_bf16 v[44:47], v[188:191], a[60:63], v[44:47]
v_mfma_f32_16x16x32_bf16 v[28:31], v[188:191], a[44:47], v[28:31]
s_add_u32 s72, s71, 30720
buffer_load_dwordx4 v15, s[24:27], s72 offen offset:2048 lds
v_mfma_f32_16x16x32_bf16 v[28:31], v[172:175], a[40:43], v[28:31]
buffer_load_dwordx4 a[108:111], v1, s[44:47], s69 offen offset:3072 sc1
v_mfma_f32_16x16x32_bf16 v[28:31], v[156:159], a[36:39], v[28:31]
s_waitcnt vmcnt(20) lgkmcnt(0)
v_mfma_f32_16x16x32_bf16 v[28:31], v[140:143], a[32:35], v[28:31]
s_barrier
v_mfma_f32_16x16x32_bf16 v[48:51], v[192:195], a[32:35], v[48:51]
s_nop 0
ds_read_b64_tr_b16 v[128:129], v8 offset:16384
ds_read_b64_tr_b16 v[130:131], v8 offset:18432
v_mfma_f32_16x16x32_bf16 v[48:51], v[208:211], a[36:39], v[48:51]
s_nop 0
ds_read_b64_tr_b16 v[132:133], v9 offset:16384
ds_read_b64_tr_b16 v[134:135], v9 offset:18432
v_mfma_f32_16x16x32_bf16 v[48:51], v[224:227], a[40:43], v[48:51]
s_add_u32 s72, s71, 46080
buffer_load_dwordx4 v15, s[24:27], s72 offen offset:3072 lds
v_mfma_f32_16x16x32_bf16 v[48:51], v[240:243], a[44:47], v[48:51]
s_nop 0
ds_read_b64_tr_b16 v[136:137], v10 offset:16384
ds_read_b64_tr_b16 v[138:139], v10 offset:18432
v_mfma_f32_16x16x32_bf16 v[64:67], v[240:243], a[60:63], v[64:67]
s_nop 0
ds_read_b64_tr_b16 v[140:141], v11 offset:16384
ds_read_b64_tr_b16 v[142:143], v11 offset:18432
v_mfma_f32_16x16x32_bf16 v[64:67], v[224:227], a[56:59], v[64:67]
v_and_b32 v120, 15, v0
v_lshrrev_b32 v121, 4, v0
v_mfma_f32_16x16x32_bf16 v[64:67], v[208:211], a[52:55], v[64:67]
s_nop 0
ds_read_b64_tr_b16 v[144:145], v8 offset:20480
ds_read_b64_tr_b16 v[146:147], v8 offset:22528
v_mfma_f32_16x16x32_bf16 v[64:67], v[192:195], a[48:51], v[64:67]
s_add_u32 s69, s69, 0x20000
buffer_load_dwordx4 a[112:115], v1, s[44:47], s69 offen sc1
v_mfma_f32_16x16x32_bf16 v[68:71], v[196:199], a[48:51], v[68:71]
s_nop 0
ds_read_b64_tr_b16 v[148:149], v9 offset:20480
ds_read_b64_tr_b16 v[150:151], v9 offset:22528
v_mfma_f32_16x16x32_bf16 v[68:71], v[212:215], a[52:55], v[68:71]
s_nop 0
ds_read_b64_tr_b16 v[152:153], v10 offset:20480
ds_read_b64_tr_b16 v[154:155], v10 offset:22528
v_mfma_f32_16x16x32_bf16 v[68:71], v[228:231], a[56:59], v[68:71]
s_xor_b32 s71, s15, 0x80
v_lshlrev_b32 v121, 2, v121
v_sub_u32 v120, v120, v121
v_mfma_f32_16x16x32_bf16 v[68:71], v[244:247], a[60:63], v[68:71]
s_add_u32 m0, s77, 16384
ds_read_b64_tr_b16 v[156:157], v11 offset:20480
ds_read_b64_tr_b16 v[158:159], v11 offset:22528
v_mfma_f32_16x16x32_bf16 v[52:55], v[244:247], a[44:47], v[52:55]
s_add_u32 s72, s71, 0
buffer_load_dwordx4 v15, s[24:27], s72 offen lds
v_mfma_f32_16x16x32_bf16 v[52:55], v[228:231], a[40:43], v[52:55]
s_nop 0
ds_read_b64_tr_b16 v[160:161], v8 offset:24576
ds_read_b64_tr_b16 v[162:163], v8 offset:26624
v_mfma_f32_16x16x32_bf16 v[52:55], v[212:215], a[36:39], v[52:55]
s_nop 0
ds_read_b64_tr_b16 v[164:165], v9 offset:24576
ds_read_b64_tr_b16 v[166:167], v9 offset:26624
v_mfma_f32_16x16x32_bf16 v[52:55], v[196:199], a[32:35], v[52:55]
v_min_u32 v120, 4, v120
v_lshlrev_b32 v120, 3, v120
v_mfma_f32_16x16x32_bf16 v[56:59], v[200:203], a[32:35], v[56:59]
s_nop 0
ds_read_b64_tr_b16 v[168:169], v10 offset:24576
ds_read_b64_tr_b16 v[170:171], v10 offset:26624
v_mfma_f32_16x16x32_bf16 v[56:59], v[216:219], a[36:39], v[56:59]
s_add_u32 s72, s71, 15360
buffer_load_dwordx4 v15, s[24:27], s72 offen offset:1024 lds
v_mfma_f32_16x16x32_bf16 v[56:59], v[232:235], a[40:43], v[56:59]
buffer_load_dwordx4 a[116:119], v1, s[44:47], s69 offen offset:1024 sc1
v_mfma_f32_16x16x32_bf16 v[56:59], v[248:251], a[44:47], v[56:59]
s_nop 0
ds_read_b64_tr_b16 v[172:173], v11 offset:24576
ds_read_b64_tr_b16 v[174:175], v11 offset:26624
v_mfma_f32_16x16x32_bf16 v[72:75], v[248:251], a[60:63], v[72:75]
s_nop 0
ds_read_b64_tr_b16 v[176:177], v8 offset:28672
ds_read_b64_tr_b16 v[178:179], v8 offset:30720
v_mfma_f32_16x16x32_bf16 v[72:75], v[232:235], a[56:59], v[72:75]
v_mov_b32 v122, 0x3f80
v_mov_b32 v123, 0
v_mfma_f32_16x16x32_bf16 v[72:75], v[216:219], a[52:55], v[72:75]
s_nop 0
ds_read_b64_tr_b16 v[180:181], v9 offset:28672
ds_read_b64_tr_b16 v[182:183], v9 offset:30720
v_mfma_f32_16x16x32_bf16 v[72:75], v[200:203], a[48:51], v[72:75]
s_add_u32 s72, s71, 30720
buffer_load_dwordx4 v15, s[24:27], s72 offen offset:2048 lds
v_mfma_f32_16x16x32_bf16 v[76:79], v[204:207], a[48:51], v[76:79]
s_nop 0
ds_read_b64_tr_b16 v[184:185], v10 offset:28672
ds_read_b64_tr_b16 v[186:187], v10 offset:30720
v_mfma_f32_16x16x32_bf16 v[76:79], v[220:223], a[52:55], v[76:79]
s_nop 0
ds_read_b64_tr_b16 v[188:189], v11 offset:28672
ds_read_b64_tr_b16 v[190:191], v11 offset:30720
v_mfma_f32_16x16x32_bf16 v[76:79], v[236:239], a[56:59], v[76:79]
v_lshlrev_b64 v[122:123], v120, v[122:123]
v_mov_b32 v126, 0
v_mfma_f32_16x16x32_bf16 v[76:79], v[252:255], a[60:63], v[76:79]
buffer_load_dwordx4 a[120:123], v1, s[44:47], s69 offen offset:2048 sc1
v_mfma_f32_16x16x32_bf16 v[60:63], v[252:255], a[44:47], v[60:63]
v_lshlrev_b64 v[122:123], v120, v[122:123]
v_mov_b32 v127, 0
v_mfma_f32_16x16x32_bf16 v[60:63], v[236:239], a[40:43], v[60:63]
s_add_u32 s72, s71, 46080
buffer_load_dwordx4 v15, s[24:27], s72 offen offset:3072 lds
v_mfma_f32_16x16x32_bf16 v[60:63], v[220:223], a[36:39], v[60:63]
s_waitcnt vmcnt(22) lgkmcnt(0)
v_mov_b32 v120, 0
v_mov_b32 v121, 0
v_mfma_f32_16x16x32_bf16 v[60:63], v[204:207], a[32:35], v[60:63]
s_barrier
v_mov_b32 v124, v122
v_mov_b32 v125, v123
v_mfma_f32_16x16x32_bf16 v[80:83], v[128:131], a[32:35], v[80:83]
s_nop 0
ds_read_b64_tr_b16 v[192:193], v8 offset:32768
ds_read_b64_tr_b16 v[194:195], v8 offset:34816
v_mfma_f32_16x16x32_bf16 v[80:83], v[144:147], a[36:39], v[80:83]
s_nop 0
ds_read_b64_tr_b16 v[196:197], v9 offset:32768
ds_read_b64_tr_b16 v[198:199], v9 offset:34816
v_mfma_f32_16x16x32_bf16 v[80:83], v[160:163], a[40:43], v[80:83]
s_nop 0
ds_read_b64_tr_b16 v[200:201], v10 offset:32768
ds_read_b64_tr_b16 v[202:203], v10 offset:34816
v_mfma_f32_16x16x32_bf16 v[80:83], v[176:179], a[44:47], v[80:83]
s_nop 0
ds_read_b64_tr_b16 v[204:205], v11 offset:32768
ds_read_b64_tr_b16 v[206:207], v11 offset:34816
v_mfma_f32_16x16x32_bf16 v[96:99], v[176:179], a[60:63], v[96:99]
v_mfma_f32_16x16x32_bf16 v[96:99], v[160:163], a[56:59], v[96:99]
s_xor_b32 s71, s15, 0x100
buffer_load_dwordx4 a[124:127], v1, s[44:47], s69 offen offset:3072 sc1
v_mfma_f32_16x16x32_bf16 v[96:99], v[144:147], a[52:55], v[96:99]
s_add_u32 m0, s77, 32768
ds_read_b64_tr_b16 v[208:209], v8 offset:36864
ds_read_b64_tr_b16 v[210:211], v8 offset:38912
v_mfma_f32_16x16x32_bf16 v[96:99], v[128:131], a[48:51], v[96:99]
s_add_u32 s72, s71, 0
buffer_load_dwordx4 v15, s[24:27], s72 offen lds
v_mfma_f32_16x16x32_bf16 v[100:103], v[132:135], a[48:51], v[100:103]
s_nop 0
ds_read_b64_tr_b16 v[212:213], v9 offset:36864
ds_read_b64_tr_b16 v[214:215], v9 offset:38912
v_mfma_f32_16x16x32_bf16 v[100:103], v[148:151], a[52:55], v[100:103]
s_nop 0
ds_read_b64_tr_b16 v[216:217], v10 offset:36864
ds_read_b64_tr_b16 v[218:219], v10 offset:38912
v_mfma_f32_16x16x32_bf16 v[100:103], v[164:167], a[56:59], v[100:103]
s_nop 0
ds_read_b64_tr_b16 v[220:221], v11 offset:36864
ds_read_b64_tr_b16 v[222:223], v11 offset:38912
v_mfma_f32_16x16x32_bf16 v[100:103], v[180:183], a[60:63], v[100:103]
v_mfma_f32_16x16x32_bf16 v[84:87], v[180:183], a[44:47], v[84:87]
s_nop 0
ds_read_b64_tr_b16 v[224:225], v8 offset:40960
ds_read_b64_tr_b16 v[226:227], v8 offset:43008
v_mfma_f32_16x16x32_bf16 v[84:87], v[164:167], a[40:43], v[84:87]
s_add_u32 s72, s71, 15360
buffer_load_dwordx4 v15, s[24:27], s72 offen offset:1024 lds
v_mfma_f32_16x16x32_bf16 v[84:87], v[148:151], a[36:39], v[84:87]
s_nop 0
ds_read_b64_tr_b16 v[228:229], v9 offset:40960
ds_read_b64_tr_b16 v[230:231], v9 offset:43008
v_mfma_f32_16x16x32_bf16 v[84:87], v[132:135], a[32:35], v[84:87]
s_waitcnt vmcnt(22)
v_cmp_gt_u32 vcc, 2, v3
s_cbranch_vccnz Lspin106
Lback107:
s_lshr_b32 s69, s12, 18
s_lshl_b32 s69, s69, 12
s_add_u32 s69, s69, s95
s_xor_b32 s69, s69, 0x1000
buffer_load_dwordx4 a[128:131], v1, s[44:47], s69 offen sc1
v_mfma_f32_16x16x32_bf16 v[88:91], v[136:139], a[32:35], v[88:91]
s_nop 0
ds_read_b64_tr_b16 v[232:233], v10 offset:40960
ds_read_b64_tr_b16 v[234:235], v10 offset:43008
v_mfma_f32_16x16x32_bf16 v[88:91], v[152:155], a[36:39], v[88:91]
s_nop 0
ds_read_b64_tr_b16 v[236:237], v11 offset:40960
ds_read_b64_tr_b16 v[238:239], v11 offset:43008
v_mfma_f32_16x16x32_bf16 v[88:91], v[168:171], a[40:43], v[88:91]
v_mfma_f32_16x16x32_bf16 v[88:91], v[184:187], a[44:47], v[88:91]
s_add_u32 s72, s71, 30720
buffer_load_dwordx4 v15, s[24:27], s72 offen offset:2048 lds
v_mfma_f32_16x16x32_bf16 v[104:107], v[184:187], a[60:63], v[104:107]
s_nop 0
ds_read_b64_tr_b16 v[240:241], v8 offset:45056
ds_read_b64_tr_b16 v[242:243], v8 offset:47104
v_mfma_f32_16x16x32_bf16 v[104:107], v[168:171], a[56:59], v[104:107]
s_nop 0
ds_read_b64_tr_b16 v[244:245], v9 offset:45056
ds_read_b64_tr_b16 v[246:247], v9 offset:47104
v_mfma_f32_16x16x32_bf16 v[104:107], v[152:155], a[52:55], v[104:107]
s_nop 0
ds_read_b64_tr_b16 v[248:249], v10 offset:45056
ds_read_b64_tr_b16 v[250:251], v10 offset:47104
v_mfma_f32_16x16x32_bf16 v[104:107], v[136:139], a[48:51], v[104:107]
s_nop 0
ds_read_b64_tr_b16 v[252:253], v11 offset:45056
ds_read_b64_tr_b16 v[254:255], v11 offset:47104
v_mfma_f32_16x16x32_bf16 v[108:111], v[140:143], a[48:51], v[108:111]
v_mfma_f32_16x16x32_bf16 v[108:111], v[156:159], a[52:55], v[108:111]
s_add_u32 s72, s71, 46080
buffer_load_dwordx4 v15, s[24:27], s72 offen offset:3072 lds
v_mfma_f32_16x16x32_bf16 v[108:111], v[172:175], a[56:59], v[108:111]
buffer_load_dwordx4 a[132:135], v1, s[44:47], s69 offen offset:1024 sc1
v_mfma_f32_16x16x32_bf16 v[108:111], v[188:191], a[60:63], v[108:111]
v_mfma_f32_16x16x32_bf16 v[92:95], v[188:191], a[44:47], v[92:95]
v_mfma_f32_16x16x32_bf16 v[92:95], v[172:175], a[40:43], v[92:95]
v_mfma_f32_16x16x32_bf16 v[92:95], v[156:159], a[36:39], v[92:95]
s_waitcnt vmcnt(22) lgkmcnt(0)
v_mfma_f32_16x16x32_bf16 v[92:95], v[140:143], a[32:35], v[92:95]
s_barrier
v_mfma_f32_16x16x32_bf16 v[16:19], v[192:195], a[64:67], v[16:19]
s_nop 0
ds_read_b64_tr_b16 v[128:129], v8 offset:49152
ds_read_b64_tr_b16 v[130:131], v8 offset:51200
v_mfma_f32_16x16x32_bf16 v[16:19], v[208:211], a[68:71], v[16:19]
s_xor_b32 s71, s15, 0x180
ds_read_b64_tr_b16 v[132:133], v9 offset:49152
ds_read_b64_tr_b16 v[134:135], v9 offset:51200
v_mfma_f32_16x16x32_bf16 v[16:19], v[224:227], a[72:75], v[16:19]
s_add_u32 m0, s77, 49152
ds_read_b64_tr_b16 v[136:137], v10 offset:49152
ds_read_b64_tr_b16 v[138:139], v10 offset:51200
v_mfma_f32_16x16x32_bf16 v[16:19], v[240:243], a[76:79], v[16:19]
s_add_u32 s72, s71, 0
buffer_load_dwordx4 v15, s[24:27], s72 offen lds
v_mfma_f32_16x16x32_bf16 v[32:35], v[240:243], a[92:95], v[32:35]
buffer_load_dwordx4 a[136:139], v1, s[44:47], s69 offen offset:2048 sc1
v_mfma_f32_16x16x32_bf16 v[32:35], v[224:227], a[88:91], v[32:35]
s_nop 0
ds_read_b64_tr_b16 v[140:141], v11 offset:49152
ds_read_b64_tr_b16 v[142:143], v11 offset:51200
v_mfma_f32_16x16x32_bf16 v[32:35], v[208:211], a[84:87], v[32:35]
v_mfma_f32_16x16x32_bf16 v[32:35], v[192:195], a[80:83], v[32:35]
s_nop 0
ds_read_b64_tr_b16 v[144:145], v8 offset:53248
ds_read_b64_tr_b16 v[146:147], v8 offset:55296
v_mfma_f32_16x16x32_bf16 v[36:39], v[196:199], a[80:83], v[36:39]
s_add_u32 s72, s71, 15360
buffer_load_dwordx4 v15, s[24:27], s72 offen offset:1024 lds
v_mfma_f32_16x16x32_bf16 v[36:39], v[212:215], a[84:87], v[36:39]
s_nop 0
ds_read_b64_tr_b16 v[148:149], v9 offset:53248
ds_read_b64_tr_b16 v[150:151], v9 offset:55296
v_mfma_f32_16x16x32_bf16 v[36:39], v[228:231], a[88:91], v[36:39]
s_nop 0
ds_read_b64_tr_b16 v[152:153], v10 offset:53248
ds_read_b64_tr_b16 v[154:155], v10 offset:55296
v_mfma_f32_16x16x32_bf16 v[36:39], v[244:247], a[92:95], v[36:39]
s_nop 0
ds_read_b64_tr_b16 v[156:157], v11 offset:53248
ds_read_b64_tr_b16 v[158:159], v11 offset:55296
v_mfma_f32_16x16x32_bf16 v[20:23], v[244:247], a[76:79], v[20:23]
v_mfma_f32_16x16x32_bf16 v[20:23], v[228:231], a[72:75], v[20:23]
buffer_load_dwordx4 a[140:143], v1, s[44:47], s69 offen offset:3072 sc1
v_mfma_f32_16x16x32_bf16 v[20:23], v[212:215], a[68:71], v[20:23]
s_add_u32 s72, s71, 30720
buffer_load_dwordx4 v15, s[24:27], s72 offen offset:2048 lds
v_mfma_f32_16x16x32_bf16 v[20:23], v[196:199], a[64:67], v[20:23]
s_nop 0
ds_read_b64_tr_b16 v[160:161], v8 offset:57344
ds_read_b64_tr_b16 v[162:163], v8 offset:59392
v_mfma_f32_16x16x32_bf16 v[24:27], v[200:203], a[64:67], v[24:27]
s_nop 0
ds_read_b64_tr_b16 v[164:165], v9 offset:57344
ds_read_b64_tr_b16 v[166:167], v9 offset:59392
v_mfma_f32_16x16x32_bf16 v[24:27], v[216:219], a[68:71], v[24:27]
s_nop 0
ds_read_b64_tr_b16 v[168:169], v10 offset:57344
ds_read_b64_tr_b16 v[170:171], v10 offset:59392
v_mfma_f32_16x16x32_bf16 v[24:27], v[232:235], a[72:75], v[24:27]
s_nop 0
ds_read_b64_tr_b16 v[172:173], v11 offset:57344
ds_read_b64_tr_b16 v[174:175], v11 offset:59392
v_mfma_f32_16x16x32_bf16 v[24:27], v[248:251], a[76:79], v[24:27]
v_mfma_f32_16x16x32_bf16 v[40:43], v[248:251], a[92:95], v[40:43]
s_add_u32 s72, s71, 46080
buffer_load_dwordx4 v15, s[24:27], s72 offen offset:3072 lds
v_mfma_f32_16x16x32_bf16 v[40:43], v[232:235], a[88:91], v[40:43]
s_nop 0
ds_read_b64_tr_b16 v[176:177], v8 offset:61440
ds_read_b64_tr_b16 v[178:179], v8 offset:63488
v_mfma_f32_16x16x32_bf16 v[40:43], v[216:219], a[84:87], v[40:43]
s_nop 0
ds_read_b64_tr_b16 v[180:181], v9 offset:61440
ds_read_b64_tr_b16 v[182:183], v9 offset:63488
v_mfma_f32_16x16x32_bf16 v[40:43], v[200:203], a[80:83], v[40:43]
s_add_u32 s69, s69, 0x20000
buffer_load_dwordx4 a[144:147], v1, s[44:47], s69 offen sc1
v_mfma_f32_16x16x32_bf16 v[44:47], v[204:207], a[80:83], v[44:47]
s_nop 0
ds_read_b64_tr_b16 v[184:185], v10 offset:61440
ds_read_b64_tr_b16 v[186:187], v10 offset:63488
v_mfma_f32_16x16x32_bf16 v[44:47], v[220:223], a[84:87], v[44:47]
s_nop 0
ds_read_b64_tr_b16 v[188:189], v11 offset:61440
ds_read_b64_tr_b16 v[190:191], v11 offset:63488
v_mfma_f32_16x16x32_bf16 v[44:47], v[236:239], a[88:91], v[44:47]
v_mfma_f32_16x16x32_bf16 v[44:47], v[252:255], a[92:95], v[44:47]
s_xor_b32 s71, s12, 0x40080
v_mfma_f32_16x16x32_bf16 v[28:31], v[252:255], a[76:79], v[28:31]
s_add_u32 m0, s85, 0
v_xor_b32 v8, 0x10000, v8
v_mfma_f32_16x16x32_bf16 v[28:31], v[236:239], a[72:75], v[28:31]
s_add_u32 s72, s71, 0
v_xor_b32 v9, 0x10000, v9
v_mfma_f32_16x16x32_bf16 v[28:31], v[220:223], a[68:71], v[28:31]
s_waitcnt vmcnt(21) lgkmcnt(0)
buffer_load_dwordx4 v15, s[24:27], s72 offen lds
v_xor_b32 v10, 0x10000, v10
v_mfma_f32_16x16x32_bf16 v[28:31], v[204:207], a[64:67], v[28:31]
s_barrier
v_xor_b32 v11, 0x10000, v11
v_mfma_f32_16x16x32_bf16 v[48:51], v[128:131], a[64:67], v[48:51]
s_nop 0
ds_read_b64_tr_b16 v[192:193], v8 offset:0
ds_read_b64_tr_b16 v[194:195], v8 offset:2048
v_mfma_f32_16x16x32_bf16 v[48:51], v[144:147], a[68:71], v[48:51]
buffer_load_dwordx4 a[148:151], v1, s[44:47], s69 offen offset:1024 sc1
v_mfma_f32_16x16x32_bf16 v[48:51], v[160:163], a[72:75], v[48:51]
s_nop 0
ds_read_b64_tr_b16 v[196:197], v9 offset:0
ds_read_b64_tr_b16 v[198:199], v9 offset:2048
v_mfma_f32_16x16x32_bf16 v[48:51], v[176:179], a[76:79], v[48:51]
s_add_u32 s72, s71, 15360
buffer_load_dwordx4 v15, s[24:27], s72 offen offset:1024 lds
v_mfma_f32_16x16x32_bf16 v[64:67], v[176:179], a[92:95], v[64:67]
s_nop 0
ds_read_b64_tr_b16 v[200:201], v10 offset:0
ds_read_b64_tr_b16 v[202:203], v10 offset:2048
v_mfma_f32_16x16x32_bf16 v[64:67], v[160:163], a[88:91], v[64:67]
s_nop 0
ds_read_b64_tr_b16 v[204:205], v11 offset:0
ds_read_b64_tr_b16 v[206:207], v11 offset:2048
v_mfma_f32_16x16x32_bf16 v[64:67], v[144:147], a[84:87], v[64:67]
v_mfma_f32_16x16x32_bf16 v[64:67], v[128:131], a[80:83], v[64:67]
s_nop 0
ds_read_b64_tr_b16 v[208:209], v8 offset:4096
ds_read_b64_tr_b16 v[210:211], v8 offset:6144
v_mfma_f32_16x16x32_bf16 v[68:71], v[132:135], a[80:83], v[68:71]
s_nop 0
ds_read_b64_tr_b16 v[212:213], v9 offset:4096
ds_read_b64_tr_b16 v[214:215], v9 offset:6144
v_mfma_f32_16x16x32_bf16 v[68:71], v[148:151], a[84:87], v[68:71]
s_add_u32 s72, s71, 30720
buffer_load_dwordx4 v15, s[24:27], s72 offen offset:2048 lds
v_mfma_f32_16x16x32_bf16 v[68:71], v[164:167], a[88:91], v[68:71]
s_nop 0
ds_read_b64_tr_b16 v[216:217], v10 offset:4096
ds_read_b64_tr_b16 v[218:219], v10 offset:6144
v_mfma_f32_16x16x32_bf16 v[68:71], v[180:183], a[92:95], v[68:71]
buffer_load_dwordx4 a[152:155], v1, s[44:47], s69 offen offset:2048 sc1
v_mfma_f32_16x16x32_bf16 v[52:55], v[180:183], a[76:79], v[52:55]
s_nop 0
ds_read_b64_tr_b16 v[220:221], v11 offset:4096
ds_read_b64_tr_b16 v[222:223], v11 offset:6144
v_mfma_f32_16x16x32_bf16 v[52:55], v[164:167], a[72:75], v[52:55]
v_mfma_f32_16x16x32_bf16 v[52:55], v[148:151], a[68:71], v[52:55]
s_nop 0
ds_read_b64_tr_b16 v[224:225], v8 offset:8192
ds_read_b64_tr_b16 v[226:227], v8 offset:10240
v_mfma_f32_16x16x32_bf16 v[52:55], v[132:135], a[64:67], v[52:55]
s_add_u32 s72, s71, 46080
buffer_load_dwordx4 v15, s[24:27], s72 offen offset:3072 lds
v_mfma_f32_16x16x32_bf16 v[56:59], v[136:139], a[64:67], v[56:59]
s_nop 0
ds_read_b64_tr_b16 v[228:229], v9 offset:8192
ds_read_b64_tr_b16 v[230:231], v9 offset:10240
v_mfma_f32_16x16x32_bf16 v[56:59], v[152:155], a[68:71], v[56:59]
s_nop 0
ds_read_b64_tr_b16 v[232:233], v10 offset:8192
ds_read_b64_tr_b16 v[234:235], v10 offset:10240
v_mfma_f32_16x16x32_bf16 v[56:59], v[168:171], a[72:75], v[56:59]
s_nop 0
ds_read_b64_tr_b16 v[236:237], v11 offset:8192
ds_read_b64_tr_b16 v[238:239], v11 offset:10240
v_mfma_f32_16x16x32_bf16 v[56:59], v[184:187], a[76:79], v[56:59]
v_mfma_f32_16x16x32_bf16 v[72:75], v[184:187], a[92:95], v[72:75]
s_nop 0
ds_read_b64_tr_b16 v[240:241], v8 offset:12288
ds_read_b64_tr_b16 v[242:243], v8 offset:14336
v_mfma_f32_16x16x32_bf16 v[72:75], v[168:171], a[88:91], v[72:75]
buffer_load_dwordx4 a[156:159], v1, s[44:47], s69 offen offset:3072 sc1
v_mfma_f32_16x16x32_bf16 v[72:75], v[152:155], a[84:87], v[72:75]
s_lshr_b32 s69, s13, 18
ds_read_b64_tr_b16 v[244:245], v9 offset:12288
ds_read_b64_tr_b16 v[246:247], v9 offset:14336
v_mfma_f32_16x16x32_bf16 v[72:75], v[136:139], a[80:83], v[72:75]
s_xor_b32 s71, s12, 0x40100
ds_read_b64_tr_b16 v[248:249], v10 offset:12288
ds_read_b64_tr_b16 v[250:251], v10 offset:14336
v_mfma_f32_16x16x32_bf16 v[76:79], v[140:143], a[80:83], v[76:79]
s_add_u32 m0, s85, 16384
ds_read_b64_tr_b16 v[252:253], v11 offset:12288
ds_read_b64_tr_b16 v[254:255], v11 offset:14336
v_mfma_f32_16x16x32_bf16 v[76:79], v[156:159], a[84:87], v[76:79]
s_add_u32 s72, s71, 0
buffer_load_dwordx4 v15, s[24:27], s72 offen lds
v_mfma_f32_16x16x32_bf16 v[76:79], v[172:175], a[88:91], v[76:79]
s_lshl_b32 s69, s69, 12
v_mfma_f32_16x16x32_bf16 v[76:79], v[188:191], a[92:95], v[76:79]
s_add_u32 s69, s69, s95
v_mfma_f32_16x16x32_bf16 v[60:63], v[188:191], a[76:79], v[60:63]
s_xor_b32 s69, s69, 0x1000
v_mfma_f32_16x16x32_bf16 v[60:63], v[172:175], a[72:75], v[60:63]
s_add_u32 s72, s71, 15360
v_mfma_f32_16x16x32_bf16 v[60:63], v[156:159], a[68:71], v[60:63]
s_waitcnt vmcnt(22) lgkmcnt(0)
buffer_load_dwordx4 a[160:163], v1, s[44:47], s69 offen sc1
v_mfma_f32_16x16x32_bf16 v[60:63], v[140:143], a[64:67], v[60:63]
s_barrier
buffer_load_dwordx4 v15, s[24:27], s72 offen offset:1024 lds
v_mfma_f32_16x16x32_bf16 v[80:83], v[192:195], a[64:67], v[80:83]
s_and_b32 s79, s91, 0xffffcfff
v_lshlrev_b32 v13, 2, v2
buffer_load_dword v14, v13, s[44:47], s79 offen sc1
v_mfma_f32_16x16x32_bf16 v[80:83], v[208:211], a[68:71], v[80:83]
s_nop 0
ds_read_b64_tr_b16 v[128:129], v8 offset:16384
ds_read_b64_tr_b16 v[130:131], v8 offset:18432
v_mfma_f32_16x16x32_bf16 v[80:83], v[224:227], a[72:75], v[80:83]
s_nop 0
ds_read_b64_tr_b16 v[132:133], v9 offset:16384
ds_read_b64_tr_b16 v[134:135], v9 offset:18432
v_mfma_f32_16x16x32_bf16 v[80:83], v[240:243], a[76:79], v[80:83]
s_nop 0
ds_read_b64_tr_b16 v[136:137], v10 offset:16384
ds_read_b64_tr_b16 v[138:139], v10 offset:18432
v_mfma_f32_16x16x32_bf16 v[96:99], v[240:243], a[92:95], v[96:99]
s_nop 0
ds_read_b64_tr_b16 v[140:141], v11 offset:16384
ds_read_b64_tr_b16 v[142:143], v11 offset:18432
v_mfma_f32_16x16x32_bf16 v[96:99], v[224:227], a[88:91], v[96:99]
s_add_u32 s72, s71, 30720
buffer_load_dwordx4 v15, s[24:27], s72 offen offset:2048 lds
v_mfma_f32_16x16x32_bf16 v[96:99], v[208:211], a[84:87], v[96:99]
v_mfma_f32_16x16x32_bf16 v[96:99], v[192:195], a[80:83], v[96:99]
s_nop 0
ds_read_b64_tr_b16 v[144:145], v8 offset:20480
ds_read_b64_tr_b16 v[146:147], v8 offset:22528
v_mfma_f32_16x16x32_bf16 v[100:103], v[196:199], a[80:83], v[100:103]
buffer_load_dwordx4 a[164:167], v1, s[44:47], s69 offen offset:1024 sc1
v_mfma_f32_16x16x32_bf16 v[100:103], v[212:215], a[84:87], v[100:103]
s_nop 0
ds_read_b64_tr_b16 v[148:149], v9 offset:20480
ds_read_b64_tr_b16 v[150:151], v9 offset:22528
v_mfma_f32_16x16x32_bf16 v[100:103], v[228:231], a[88:91], v[100:103]
s_nop 0
ds_read_b64_tr_b16 v[152:153], v10 offset:20480
ds_read_b64_tr_b16 v[154:155], v10 offset:22528
v_mfma_f32_16x16x32_bf16 v[100:103], v[244:247], a[92:95], v[100:103]
s_add_u32 s72, s71, 46080
buffer_load_dwordx4 v15, s[24:27], s72 offen offset:3072 lds
Lstube1:
s_cbranch_execz Lstube5
v_mfma_f32_16x16x32_bf16 v[84:87], v[244:247], a[76:79], v[84:87]
s_nop 0
ds_read_b64_tr_b16 v[156:157], v11 offset:20480
ds_read_b64_tr_b16 v[158:159], v11 offset:22528
v_mfma_f32_16x16x32_bf16 v[84:87], v[228:231], a[72:75], v[84:87]
v_mfma_f32_16x16x32_bf16 v[84:87], v[212:215], a[68:71], v[84:87]
s_nop 0
ds_read_b64_tr_b16 v[160:161], v8 offset:24576
ds_read_b64_tr_b16 v[162:163], v8 offset:26624
v_mfma_f32_16x16x32_bf16 v[84:87], v[196:199], a[64:67], v[84:87]
s_nop 0
ds_read_b64_tr_b16 v[164:165], v9 offset:24576
ds_read_b64_tr_b16 v[166:167], v9 offset:26624
v_mfma_f32_16x16x32_bf16 v[88:91], v[200:203], a[64:67], v[88:91]
s_nop 0
ds_read_b64_tr_b16 v[168:169], v10 offset:24576
ds_read_b64_tr_b16 v[170:171], v10 offset:26624
v_mfma_f32_16x16x32_bf16 v[88:91], v[216:219], a[68:71], v[88:91]
s_nop 0
ds_read_b64_tr_b16 v[172:173], v11 offset:24576
ds_read_b64_tr_b16 v[174:175], v11 offset:26624
v_mfma_f32_16x16x32_bf16 v[88:91], v[232:235], a[72:75], v[88:91]
buffer_load_dwordx4 a[168:171], v1, s[44:47], s69 offen offset:2048 sc1
v_mfma_f32_16x16x32_bf16 v[88:91], v[248:251], a[76:79], v[88:91]
s_xor_b32 s71, s12, 0x40180
v_mfma_f32_16x16x32_bf16 v[104:107], v[248:251], a[92:95], v[104:107]
s_add_u32 m0, s85, 32768
ds_read_b64_tr_b16 v[176:177], v8 offset:28672
ds_read_b64_tr_b16 v[178:179], v8 offset:30720
v_mfma_f32_16x16x32_bf16 v[104:107], v[232:235], a[88:91], v[104:107]
s_add_u32 s72, s71, 0
buffer_load_dwordx4 v15, s[24:27], s72 offen lds
v_mfma_f32_16x16x32_bf16 v[104:107], v[216:219], a[84:87], v[104:107]
s_nop 0
ds_read_b64_tr_b16 v[180:181], v9 offset:28672
ds_read_b64_tr_b16 v[182:183], v9 offset:30720
v_mfma_f32_16x16x32_bf16 v[104:107], v[200:203], a[80:83], v[104:107]
s_nop 0
ds_read_b64_tr_b16 v[184:185], v10 offset:28672
ds_read_b64_tr_b16 v[186:187], v10 offset:30720
v_mfma_f32_16x16x32_bf16 v[108:111], v[204:207], a[80:83], v[108:111]
s_nop 0
ds_read_b64_tr_b16 v[188:189], v11 offset:28672
ds_read_b64_tr_b16 v[190:191], v11 offset:30720
v_mfma_f32_16x16x32_bf16 v[108:111], v[220:223], a[84:87], v[108:111]
v_mfma_f32_16x16x32_bf16 v[108:111], v[236:239], a[88:91], v[108:111]
s_add_u32 s72, s71, 15360
buffer_load_dwordx4 v15, s[24:27], s72 offen offset:1024 lds
v_mfma_f32_16x16x32_bf16 v[108:111], v[252:255], a[92:95], v[108:111]
v_mfma_f32_16x16x32_bf16 v[92:95], v[252:255], a[76:79], v[92:95]
buffer_load_dwordx4 a[172:175], v1, s[44:47], s69 offen offset:3072 sc1
v_mfma_f32_16x16x32_bf16 v[92:95], v[236:239], a[72:75], v[92:95]
v_mfma_f32_16x16x32_bf16 v[92:95], v[220:223], a[68:71], v[92:95]
s_waitcnt vmcnt(26) lgkmcnt(0)
v_mfma_f32_16x16x32_bf16 v[92:95], v[204:207], a[64:67], v[92:95]
s_barrier
v_mfma_f32_16x16x32_bf16 v[16:19], v[128:131], a[96:99], v[16:19]
s_add_u32 s72, s71, 30720
buffer_load_dwordx4 v15, s[24:27], s72 offen offset:2048 lds
v_mfma_f32_16x16x32_bf16 v[16:19], v[144:147], a[100:103], v[16:19]
s_nop 0
ds_read_b64_tr_b16 v[192:193], v8 offset:32768
ds_read_b64_tr_b16 v[194:195], v8 offset:34816
v_mfma_f32_16x16x32_bf16 v[16:19], v[160:163], a[104:107], v[16:19]
s_nop 0
ds_read_b64_tr_b16 v[196:197], v9 offset:32768
ds_read_b64_tr_b16 v[198:199], v9 offset:34816
v_mfma_f32_16x16x32_bf16 v[16:19], v[176:179], a[108:111], v[16:19]
s_nop 0
ds_read_b64_tr_b16 v[200:201], v10 offset:32768
ds_read_b64_tr_b16 v[202:203], v10 offset:34816
v_mfma_f32_16x16x32_bf16 v[32:35], v[176:179], a[124:127], v[32:35]
s_nop 0
ds_read_b64_tr_b16 v[204:205], v11 offset:32768
ds_read_b64_tr_b16 v[206:207], v11 offset:34816
v_mfma_f32_16x16x32_bf16 v[32:35], v[160:163], a[120:123], v[32:35]
v_mfma_f32_16x16x32_bf16 v[32:35], v[144:147], a[116:119], v[32:35]
s_add_u32 s72, s71, 46080
buffer_load_dwordx4 v15, s[24:27], s72 offen offset:3072 lds
v_mfma_f32_16x16x32_bf16 v[32:35], v[128:131], a[112:115], v[32:35]
s_add_u32 s69, s69, 0x20000
buffer_load_dwordx4 a[176:179], v1, s[44:47], s69 offen sc1
v_mfma_f32_16x16x32_bf16 v[36:39], v[132:135], a[112:115], v[36:39]
s_nop 0
ds_read_b64_tr_b16 v[208:209], v8 offset:36864
ds_read_b64_tr_b16 v[210:211], v8 offset:38912
v_mfma_f32_16x16x32_bf16 v[36:39], v[148:151], a[116:119], v[36:39]
s_nop 0
ds_read_b64_tr_b16 v[212:213], v9 offset:36864
ds_read_b64_tr_b16 v[214:215], v9 offset:38912
v_mfma_f32_16x16x32_bf16 v[36:39], v[164:167], a[120:123], v[36:39]
s_nop 0
ds_read_b64_tr_b16 v[216:217], v10 offset:36864
ds_read_b64_tr_b16 v[218:219], v10 offset:38912
v_mfma_f32_16x16x32_bf16 v[36:39], v[180:183], a[124:127], v[36:39]
s_nop 0
ds_read_b64_tr_b16 v[220:221], v11 offset:36864
ds_read_b64_tr_b16 v[222:223], v11 offset:38912
v_mfma_f32_16x16x32_bf16 v[20:23], v[180:183], a[108:111], v[20:23]
v_mfma_f32_16x16x32_bf16 v[20:23], v[164:167], a[104:107], v[20:23]
s_nop 0
ds_read_b64_tr_b16 v[224:225], v8 offset:40960
ds_read_b64_tr_b16 v[226:227], v8 offset:43008
v_mfma_f32_16x16x32_bf16 v[20:23], v[148:151], a[100:103], v[20:23]
s_xor_b32 s71, s13, 0x40080
ds_read_b64_tr_b16 v[228:229], v9 offset:40960
ds_read_b64_tr_b16 v[230:231], v9 offset:43008
v_mfma_f32_16x16x32_bf16 v[20:23], v[132:135], a[96:99], v[20:23]
s_add_u32 m0, s85, 49152
ds_read_b64_tr_b16 v[232:233], v10 offset:40960
ds_read_b64_tr_b16 v[234:235], v10 offset:43008
v_mfma_f32_16x16x32_bf16 v[24:27], v[136:139], a[96:99], v[24:27]
s_add_u32 s72, s71, 0
buffer_load_dwordx4 v15, s[24:27], s72 offen lds
v_mfma_f32_16x16x32_bf16 v[24:27], v[152:155], a[100:103], v[24:27]
buffer_load_dwordx4 a[180:183], v1, s[44:47], s69 offen offset:1024 sc1
v_mfma_f32_16x16x32_bf16 v[24:27], v[168:171], a[104:107], v[24:27]
s_nop 0
ds_read_b64_tr_b16 v[236:237], v11 offset:40960
ds_read_b64_tr_b16 v[238:239], v11 offset:43008
v_mfma_f32_16x16x32_bf16 v[24:27], v[184:187], a[108:111], v[24:27]
v_mfma_f32_16x16x32_bf16 v[40:43], v[184:187], a[124:127], v[40:43]
s_nop 0
ds_read_b64_tr_b16 v[240:241], v8 offset:45056
ds_read_b64_tr_b16 v[242:243], v8 offset:47104
v_mfma_f32_16x16x32_bf16 v[40:43], v[168:171], a[120:123], v[40:43]
s_nop 0
ds_read_b64_tr_b16 v[244:245], v9 offset:45056
ds_read_b64_tr_b16 v[246:247], v9 offset:47104
v_mfma_f32_16x16x32_bf16 v[40:43], v[152:155], a[116:119], v[40:43]
s_add_u32 s72, s71, 15360
buffer_load_dwordx4 v15, s[24:27], s72 offen offset:1024 lds
v_mfma_f32_16x16x32_bf16 v[40:43], v[136:139], a[112:115], v[40:43]
s_nop 0
ds_read_b64_tr_b16 v[248:249], v10 offset:45056
ds_read_b64_tr_b16 v[250:251], v10 offset:47104
v_mfma_f32_16x16x32_bf16 v[44:47], v[140:143], a[112:115], v[44:47]
s_nop 0
ds_read_b64_tr_b16 v[252:253], v11 offset:45056
ds_read_b64_tr_b16 v[254:255], v11 offset:47104
v_mfma_f32_16x16x32_bf16 v[44:47], v[156:159], a[116:119], v[44:47]
v_mfma_f32_16x16x32_bf16 v[44:47], v[172:175], a[120:123], v[44:47]
buffer_load_dwordx4 a[184:187], v1, s[44:47], s69 offen offset:2048 sc1
v_mfma_f32_16x16x32_bf16 v[44:47], v[188:191], a[124:127], v[44:47]
v_mfma_f32_16x16x32_bf16 v[28:31], v[188:191], a[108:111], v[28:31]
s_add_u32 s72, s71, 30720
buffer_load_dwordx4 v15, s[24:27], s72 offen offset:2048 lds
v_mfma_f32_16x16x32_bf16 v[28:31], v[172:175], a[104:107], v[28:31]
v_mfma_f32_16x16x32_bf16 v[28:31], v[156:159], a[100:103], v[28:31]
s_waitcnt vmcnt(27) lgkmcnt(0)
v_mfma_f32_16x16x32_bf16 v[28:31], v[140:143], a[96:99], v[28:31]
s_barrier
v_mfma_f32_16x16x32_bf16 v[48:51], v[192:195], a[96:99], v[48:51]
s_nop 0
ds_read_b64_tr_b16 v[128:129], v8 offset:49152
ds_read_b64_tr_b16 v[130:131], v8 offset:51200
v_mfma_f32_16x16x32_bf16 v[48:51], v[208:211], a[100:103], v[48:51]
s_nop 0
ds_read_b64_tr_b16 v[132:133], v9 offset:49152
ds_read_b64_tr_b16 v[134:135], v9 offset:51200
v_mfma_f32_16x16x32_bf16 v[48:51], v[224:227], a[104:107], v[48:51]
s_add_u32 s72, s71, 46080
buffer_load_dwordx4 v15, s[24:27], s72 offen offset:3072 lds
v_mfma_f32_16x16x32_bf16 v[48:51], v[240:243], a[108:111], v[48:51]
s_nop 0
ds_read_b64_tr_b16 v[136:137], v10 offset:49152
ds_read_b64_tr_b16 v[138:139], v10 offset:51200
v_mfma_f32_16x16x32_bf16 v[64:67], v[240:243], a[124:127], v[64:67]
buffer_load_dwordx4 a[188:191], v1, s[44:47], s69 offen offset:3072 sc1
v_mfma_f32_16x16x32_bf16 v[64:67], v[224:227], a[120:123], v[64:67]
s_nop 0
ds_read_b64_tr_b16 v[140:141], v11 offset:49152
ds_read_b64_tr_b16 v[142:143], v11 offset:51200
v_mfma_f32_16x16x32_bf16 v[64:67], v[208:211], a[116:119], v[64:67]
s_nop 0
ds_read_b64_tr_b16 v[144:145], v8 offset:53248
ds_read_b64_tr_b16 v[146:147], v8 offset:55296
v_mfma_f32_16x16x32_bf16 v[64:67], v[192:195], a[112:115], v[64:67]
s_nop 0
ds_read_b64_tr_b16 v[148:149], v9 offset:53248
ds_read_b64_tr_b16 v[150:151], v9 offset:55296
v_mfma_f32_16x16x32_bf16 v[68:71], v[196:199], a[112:115], v[68:71]
s_lshr_b32 s69, s14, 18
v_mfma_f32_16x16x32_bf16 v[68:71], v[212:215], a[116:119], v[68:71]
s_lshl_b32 s69, s69, 12
ds_read_b64_tr_b16 v[152:153], v10 offset:53248
ds_read_b64_tr_b16 v[154:155], v10 offset:55296
v_mfma_f32_16x16x32_bf16 v[68:71], v[228:231], a[120:123], v[68:71]
s_xor_b32 s71, s14, 0x40080
ds_read_b64_tr_b16 v[156:157], v11 offset:53248
ds_read_b64_tr_b16 v[158:159], v11 offset:55296
v_mfma_f32_16x16x32_bf16 v[68:71], v[244:247], a[124:127], v[68:71]
s_add_u32 m0, s77, 0
ds_read_b64_tr_b16 v[160:161], v8 offset:57344
ds_read_b64_tr_b16 v[162:163], v8 offset:59392
v_mfma_f32_16x16x32_bf16 v[52:55], v[244:247], a[108:111], v[52:55]
s_add_u32 s72, s71, 0
buffer_load_dwordx4 v15, s[24:27], s72 offen lds
v_mfma_f32_16x16x32_bf16 v[52:55], v[228:231], a[104:107], v[52:55]
s_add_u32 s69, s69, s95
ds_read_b64_tr_b16 v[164:165], v9 offset:57344
ds_read_b64_tr_b16 v[166:167], v9 offset:59392
v_mfma_f32_16x16x32_bf16 v[52:55], v[212:215], a[100:103], v[52:55]
s_xor_b32 s69, s69, 0x1000
buffer_load_dwordx4 a[192:195], v1, s[44:47], s69 offen sc1
v_mfma_f32_16x16x32_bf16 v[52:55], v[196:199], a[96:99], v[52:55]
s_nop 0
ds_read_b64_tr_b16 v[168:169], v10 offset:57344
ds_read_b64_tr_b16 v[170:171], v10 offset:59392
v_mfma_f32_16x16x32_bf16 v[56:59], v[200:203], a[96:99], v[56:59]
s_waitcnt vmcnt(19)
v_cmp_gt_u32 vcc, 2, v14
s_cbranch_vccnz Lspin112
Lback113:
v_mfma_f32_16x16x32_bf16 v[56:59], v[216:219], a[100:103], v[56:59]
s_add_u32 s72, s71, 15360
buffer_load_dwordx4 v15, s[24:27], s72 offen offset:1024 lds
v_mfma_f32_16x16x32_bf16 v[56:59], v[232:235], a[104:107], v[56:59]
v_mfma_f32_16x16x32_bf16 v[56:59], v[248:251], a[108:111], v[56:59]
s_nop 0
ds_read_b64_tr_b16 v[172:173], v11 offset:57344
ds_read_b64_tr_b16 v[174:175], v11 offset:59392
v_mfma_f32_16x16x32_bf16 v[72:75], v[248:251], a[124:127], v[72:75]
s_nop 0
ds_read_b64_tr_b16 v[176:177], v8 offset:61440
ds_read_b64_tr_b16 v[178:179], v8 offset:63488
v_mfma_f32_16x16x32_bf16 v[72:75], v[232:235], a[120:123], v[72:75]
s_nop 0
ds_read_b64_tr_b16 v[180:181], v9 offset:61440
ds_read_b64_tr_b16 v[182:183], v9 offset:63488
v_mfma_f32_16x16x32_bf16 v[72:75], v[216:219], a[116:119], v[72:75]
s_nop 0
ds_read_b64_tr_b16 v[184:185], v10 offset:61440
ds_read_b64_tr_b16 v[186:187], v10 offset:63488
v_mfma_f32_16x16x32_bf16 v[72:75], v[200:203], a[112:115], v[72:75]
s_add_u32 s72, s71, 30720
buffer_load_dwordx4 v15, s[24:27], s72 offen offset:2048 lds
v_mfma_f32_16x16x32_bf16 v[76:79], v[204:207], a[112:115], v[76:79]
buffer_load_dwordx4 a[196:199], v1, s[44:47], s69 offen offset:1024 sc1
v_mfma_f32_16x16x32_bf16 v[76:79], v[220:223], a[116:119], v[76:79]
s_nop 0
ds_read_b64_tr_b16 v[188:189], v11 offset:61440
ds_read_b64_tr_b16 v[190:191], v11 offset:63488
v_mfma_f32_16x16x32_bf16 v[76:79], v[236:239], a[120:123], v[76:79]
v_mfma_f32_16x16x32_bf16 v[76:79], v[252:255], a[124:127], v[76:79]
v_mfma_f32_16x16x32_bf16 v[60:63], v[252:255], a[108:111], v[60:63]
v_xor_b32 v8, 0x10000, v8
v_mfma_f32_16x16x32_bf16 v[60:63], v[236:239], a[104:107], v[60:63]
s_add_u32 s72, s71, 46080
buffer_load_dwordx4 v15, s[24:27], s72 offen offset:3072 lds
v_xor_b32 v9, 0x10000, v9
v_mfma_f32_16x16x32_bf16 v[60:63], v[220:223], a[100:103], v[60:63]
s_waitcnt vmcnt(28) lgkmcnt(0)
v_xor_b32 v10, 0x10000, v10
v_mfma_f32_16x16x32_bf16 v[60:63], v[204:207], a[96:99], v[60:63]
s_barrier
v_xor_b32 v11, 0x10000, v11
v_mfma_f32_16x16x32_bf16 v[80:83], v[128:131], a[96:99], v[80:83]
s_lshl_b32 s84, s76, 11
ds_read_b64_tr_b16 v[192:193], v8 offset:0
ds_read_b64_tr_b16 v[194:195], v8 offset:2048
v_mfma_f32_16x16x32_bf16 v[80:83], v[144:147], a[100:103], v[80:83]
s_add_u32 s84, s84, 0x3810000
ds_read_b64_tr_b16 v[196:197], v9 offset:0
ds_read_b64_tr_b16 v[198:199], v9 offset:2048
v_mfma_f32_16x16x32_bf16 v[80:83], v[160:163], a[104:107], v[80:83]
buffer_load_dwordx4 a[200:203], v1, s[44:47], s69 offen offset:2048 sc1
v_mfma_f32_16x16x32_bf16 v[80:83], v[176:179], a[108:111], v[80:83]
s_nop 0
ds_read_b64_tr_b16 v[200:201], v10 offset:0
ds_read_b64_tr_b16 v[202:203], v10 offset:2048
v_mfma_f32_16x16x32_bf16 v[96:99], v[176:179], a[124:127], v[96:99]
s_nop 0
ds_read_b64_tr_b16 v[204:205], v11 offset:0
ds_read_b64_tr_b16 v[206:207], v11 offset:2048
v_mfma_f32_16x16x32_bf16 v[96:99], v[160:163], a[120:123], v[96:99]
s_xor_b32 s71, s15, 0x40080
v_lshrrev_b32 v115, 2, v0
v_lshlrev_b32 v115, 7, v115
v_mfma_f32_16x16x32_bf16 v[96:99], v[144:147], a[116:119], v[96:99]
s_add_u32 m0, s77, 16384
ds_read_b64_tr_b16 v[208:209], v8 offset:4096
ds_read_b64_tr_b16 v[210:211], v8 offset:6144
v_mfma_f32_16x16x32_bf16 v[96:99], v[128:131], a[112:115], v[96:99]
s_add_u32 s72, s71, 0
buffer_load_dwordx4 v15, s[24:27], s72 offen lds
v_mfma_f32_16x16x32_bf16 v[100:103], v[132:135], a[112:115], v[100:103]
s_nop 0
ds_read_b64_tr_b16 v[212:213], v9 offset:4096
ds_read_b64_tr_b16 v[214:215], v9 offset:6144
v_mfma_f32_16x16x32_bf16 v[100:103], v[148:151], a[116:119], v[100:103]
s_nop 0
ds_read_b64_tr_b16 v[216:217], v10 offset:4096
ds_read_b64_tr_b16 v[218:219], v10 offset:6144
v_mfma_f32_16x16x32_bf16 v[100:103], v[164:167], a[120:123], v[100:103]
s_nop 0
ds_read_b64_tr_b16 v[220:221], v11 offset:4096
ds_read_b64_tr_b16 v[222:223], v11 offset:6144
v_mfma_f32_16x16x32_bf16 v[100:103], v[180:183], a[124:127], v[100:103]
buffer_load_dword v114, v115, s[44:47], s84 offen sc1
v_mfma_f32_16x16x32_bf16 v[84:87], v[180:183], a[108:111], v[84:87]
buffer_load_dwordx4 a[204:207], v1, s[44:47], s69 offen offset:3072 sc1
v_mfma_f32_16x16x32_bf16 v[84:87], v[164:167], a[104:107], v[84:87]
s_add_u32 s72, s71, 15360
buffer_load_dwordx4 v15, s[24:27], s72 offen offset:1024 lds
v_mfma_f32_16x16x32_bf16 v[84:87], v[148:151], a[100:103], v[84:87]
s_nop 0
ds_read_b64_tr_b16 v[224:225], v8 offset:8192
ds_read_b64_tr_b16 v[226:227], v8 offset:10240
v_mfma_f32_16x16x32_bf16 v[84:87], v[132:135], a[96:99], v[84:87]
s_nop 0
ds_read_b64_tr_b16 v[228:229], v9 offset:8192
ds_read_b64_tr_b16 v[230:231], v9 offset:10240
v_mfma_f32_16x16x32_bf16 v[88:91], v[136:139], a[96:99], v[88:91]
s_nop 0
ds_read_b64_tr_b16 v[232:233], v10 offset:8192
ds_read_b64_tr_b16 v[234:235], v10 offset:10240
v_mfma_f32_16x16x32_bf16 v[88:91], v[152:155], a[100:103], v[88:91]
s_nop 0
ds_read_b64_tr_b16 v[236:237], v11 offset:8192
ds_read_b64_tr_b16 v[238:239], v11 offset:10240
v_mfma_f32_16x16x32_bf16 v[88:91], v[168:171], a[104:107], v[88:91]
v_mfma_f32_16x16x32_bf16 v[88:91], v[184:187], a[108:111], v[88:91]
s_add_u32 s72, s71, 30720
buffer_load_dwordx4 v15, s[24:27], s72 offen offset:2048 lds
v_mfma_f32_16x16x32_bf16 v[104:107], v[184:187], a[124:127], v[104:107]
s_nop 0
ds_read_b64_tr_b16 v[240:241], v8 offset:12288
ds_read_b64_tr_b16 v[242:243], v8 offset:14336
v_mfma_f32_16x16x32_bf16 v[104:107], v[168:171], a[120:123], v[104:107]
s_nop 0
ds_read_b64_tr_b16 v[244:245], v9 offset:12288
ds_read_b64_tr_b16 v[246:247], v9 offset:14336
v_mfma_f32_16x16x32_bf16 v[104:107], v[152:155], a[116:119], v[104:107]
s_add_u32 s69, s69, 0x20000
buffer_load_dwordx4 a[208:211], v1, s[44:47], s69 offen sc1
v_mfma_f32_16x16x32_bf16 v[104:107], v[136:139], a[112:115], v[104:107]
s_nop 0
ds_read_b64_tr_b16 v[248:249], v10 offset:12288
ds_read_b64_tr_b16 v[250:251], v10 offset:14336
v_mfma_f32_16x16x32_bf16 v[108:111], v[140:143], a[112:115], v[108:111]
s_nop 0
ds_read_b64_tr_b16 v[252:253], v11 offset:12288
ds_read_b64_tr_b16 v[254:255], v11 offset:14336
v_mfma_f32_16x16x32_bf16 v[108:111], v[156:159], a[116:119], v[108:111]
s_add_u32 s72, s71, 46080
buffer_load_dwordx4 v15, s[24:27], s72 offen offset:3072 lds
v_mfma_f32_16x16x32_bf16 v[108:111], v[172:175], a[120:123], v[108:111]
v_mfma_f32_16x16x32_bf16 v[108:111], v[188:191], a[124:127], v[108:111]
v_mfma_f32_16x16x32_bf16 v[92:95], v[188:191], a[108:111], v[92:95]
v_mfma_f32_16x16x32_bf16 v[92:95], v[172:175], a[104:107], v[92:95]
v_mfma_f32_16x16x32_bf16 v[92:95], v[156:159], a[100:103], v[92:95]
s_waitcnt vmcnt(28) lgkmcnt(0)
v_mfma_f32_16x16x32_bf16 v[92:95], v[140:143], a[96:99], v[92:95]
s_barrier
v_mfma_f32_16x16x32_bf16 v[16:19], v[192:195], a[128:131], v[16:19]
buffer_load_dwordx4 a[212:215], v1, s[44:47], s69 offen offset:1024 sc1
v_mfma_f32_16x16x32_bf16 v[16:19], v[208:211], a[132:135], v[16:19]
s_xor_b32 s71, s13, 0x40100
ds_read_b64_tr_b16 v[128:129], v8 offset:16384
ds_read_b64_tr_b16 v[130:131], v8 offset:18432
v_mfma_f32_16x16x32_bf16 v[16:19], v[224:227], a[136:139], v[16:19]
s_add_u32 m0, s77, 32768
ds_read_b64_tr_b16 v[132:133], v9 offset:16384
ds_read_b64_tr_b16 v[134:135], v9 offset:18432
v_mfma_f32_16x16x32_bf16 v[16:19], v[240:243], a[140:143], v[16:19]
s_add_u32 s72, s71, 0
buffer_load_dwordx4 v15, s[24:27], s72 offen lds
v_mfma_f32_16x16x32_bf16 v[32:35], v[240:243], a[156:159], v[32:35]
s_nop 0
ds_read_b64_tr_b16 v[136:137], v10 offset:16384
ds_read_b64_tr_b16 v[138:139], v10 offset:18432
v_mfma_f32_16x16x32_bf16 v[32:35], v[224:227], a[152:155], v[32:35]
s_nop 0
ds_read_b64_tr_b16 v[140:141], v11 offset:16384
ds_read_b64_tr_b16 v[142:143], v11 offset:18432
v_mfma_f32_16x16x32_bf16 v[32:35], v[208:211], a[148:151], v[32:35]
v_mfma_f32_16x16x32_bf16 v[32:35], v[192:195], a[144:147], v[32:35]
s_nop 0
ds_read_b64_tr_b16 v[144:145], v8 offset:20480
ds_read_b64_tr_b16 v[146:147], v8 offset:22528
v_mfma_f32_16x16x32_bf16 v[36:39], v[196:199], a[144:147], v[36:39]
s_add_u32 s72, s71, 15360
buffer_load_dwordx4 v15, s[24:27], s72 offen offset:1024 lds
v_mfma_f32_16x16x32_bf16 v[36:39], v[212:215], a[148:151], v[36:39]
s_nop 0
ds_read_b64_tr_b16 v[148:149], v9 offset:20480
ds_read_b64_tr_b16 v[150:151], v9 offset:22528
v_mfma_f32_16x16x32_bf16 v[36:39], v[228:231], a[152:155], v[36:39]
buffer_load_dwordx4 a[216:219], v1, s[44:47], s69 offen offset:2048 sc1
v_mfma_f32_16x16x32_bf16 v[36:39], v[244:247], a[156:159], v[36:39]
s_nop 0
ds_read_b64_tr_b16 v[152:153], v10 offset:20480
ds_read_b64_tr_b16 v[154:155], v10 offset:22528
v_mfma_f32_16x16x32_bf16 v[20:23], v[244:247], a[140:143], v[20:23]
s_nop 0
ds_read_b64_tr_b16 v[156:157], v11 offset:20480
ds_read_b64_tr_b16 v[158:159], v11 offset:22528
v_mfma_f32_16x16x32_bf16 v[20:23], v[228:231], a[136:139], v[20:23]
v_mfma_f32_16x16x32_bf16 v[20:23], v[212:215], a[132:135], v[20:23]
s_add_u32 s72, s71, 30720
buffer_load_dwordx4 v15, s[24:27], s72 offen offset:2048 lds
v_mfma_f32_16x16x32_bf16 v[20:23], v[196:199], a[128:131], v[20:23]
s_nop 0
ds_read_b64_tr_b16 v[160:161], v8 offset:24576
ds_read_b64_tr_b16 v[162:163], v8 offset:26624
v_mfma_f32_16x16x32_bf16 v[24:27], v[200:203], a[128:131], v[24:27]
s_nop 0
ds_read_b64_tr_b16 v[164:165], v9 offset:24576
ds_read_b64_tr_b16 v[166:167], v9 offset:26624
v_mfma_f32_16x16x32_bf16 v[24:27], v[216:219], a[132:135], v[24:27]
s_nop 0
ds_read_b64_tr_b16 v[168:169], v10 offset:24576
ds_read_b64_tr_b16 v[170:171], v10 offset:26624
v_mfma_f32_16x16x32_bf16 v[24:27], v[232:235], a[136:139], v[24:27]
s_nop 0
ds_read_b64_tr_b16 v[172:173], v11 offset:24576
ds_read_b64_tr_b16 v[174:175], v11 offset:26624
v_mfma_f32_16x16x32_bf16 v[24:27], v[248:251], a[140:143], v[24:27]
v_mfma_f32_16x16x32_bf16 v[40:43], v[248:251], a[156:159], v[40:43]
s_add_u32 s72, s71, 46080
buffer_load_dwordx4 v15, s[24:27], s72 offen offset:3072 lds
v_mfma_f32_16x16x32_bf16 v[40:43], v[232:235], a[152:155], v[40:43]
buffer_load_dwordx4 a[220:223], v1, s[44:47], s69 offen offset:3072 sc1
v_mfma_f32_16x16x32_bf16 v[40:43], v[216:219], a[148:151], v[40:43]
s_nop 0
ds_read_b64_tr_b16 v[176:177], v8 offset:28672
ds_read_b64_tr_b16 v[178:179], v8 offset:30720
v_mfma_f32_16x16x32_bf16 v[40:43], v[200:203], a[144:147], v[40:43]
s_lshr_b32 s69, s15, 18
ds_read_b64_tr_b16 v[180:181], v9 offset:28672
ds_read_b64_tr_b16 v[182:183], v9 offset:30720
v_mfma_f32_16x16x32_bf16 v[44:47], v[204:207], a[144:147], v[44:47]
s_lshl_b32 s69, s69, 12
ds_read_b64_tr_b16 v[184:185], v10 offset:28672
ds_read_b64_tr_b16 v[186:187], v10 offset:30720
v_mfma_f32_16x16x32_bf16 v[44:47], v[220:223], a[148:151], v[44:47]
s_add_u32 s69, s69, s95
ds_read_b64_tr_b16 v[188:189], v11 offset:28672
ds_read_b64_tr_b16 v[190:191], v11 offset:30720
v_mfma_f32_16x16x32_bf16 v[44:47], v[236:239], a[152:155], v[44:47]
s_xor_b32 s69, s69, 0x1000
v_mfma_f32_16x16x32_bf16 v[44:47], v[252:255], a[156:159], v[44:47]
s_xor_b32 s71, s14, 0x40100
v_mfma_f32_16x16x32_bf16 v[28:31], v[252:255], a[140:143], v[28:31]
s_add_u32 m0, s77, 49152
v_mfma_f32_16x16x32_bf16 v[28:31], v[236:239], a[136:139], v[28:31]
s_add_u32 s72, s71, 0
v_mfma_f32_16x16x32_bf16 v[28:31], v[220:223], a[132:135], v[28:31]
s_waitcnt vmcnt(29) lgkmcnt(0)
buffer_load_dwordx4 v15, s[24:27], s72 offen lds
v_mfma_f32_16x16x32_bf16 v[28:31], v[204:207], a[128:131], v[28:31]
s_barrier
buffer_load_dwordx4 a[224:227], v1, s[44:47], s69 offen sc1
v_mfma_f32_16x16x32_bf16 v[48:51], v[128:131], a[128:131], v[48:51]
s_nop 0
ds_read_b64_tr_b16 v[192:193], v8 offset:32768
ds_read_b64_tr_b16 v[194:195], v8 offset:34816
v_mfma_f32_16x16x32_bf16 v[48:51], v[144:147], a[132:135], v[48:51]
s_nop 0
ds_read_b64_tr_b16 v[196:197], v9 offset:32768
ds_read_b64_tr_b16 v[198:199], v9 offset:34816
v_mfma_f32_16x16x32_bf16 v[48:51], v[160:163], a[136:139], v[48:51]
s_nop 0
ds_read_b64_tr_b16 v[200:201], v10 offset:32768
ds_read_b64_tr_b16 v[202:203], v10 offset:34816
v_mfma_f32_16x16x32_bf16 v[48:51], v[176:179], a[140:143], v[48:51]
s_add_u32 s72, s71, 15360
buffer_load_dwordx4 v15, s[24:27], s72 offen offset:1024 lds
v_mfma_f32_16x16x32_bf16 v[64:67], v[176:179], a[156:159], v[64:67]
s_nop 0
ds_read_b64_tr_b16 v[204:205], v11 offset:32768
ds_read_b64_tr_b16 v[206:207], v11 offset:34816
v_mfma_f32_16x16x32_bf16 v[64:67], v[160:163], a[152:155], v[64:67]
v_mfma_f32_16x16x32_bf16 v[64:67], v[144:147], a[148:151], v[64:67]
s_nop 0
ds_read_b64_tr_b16 v[208:209], v8 offset:36864
ds_read_b64_tr_b16 v[210:211], v8 offset:38912
v_mfma_f32_16x16x32_bf16 v[64:67], v[128:131], a[144:147], v[64:67]
s_nop 0
ds_read_b64_tr_b16 v[212:213], v9 offset:36864
ds_read_b64_tr_b16 v[214:215], v9 offset:38912
v_mfma_f32_16x16x32_bf16 v[68:71], v[132:135], a[144:147], v[68:71]
buffer_load_dwordx4 a[228:231], v1, s[44:47], s69 offen offset:1024 sc1
v_mfma_f32_16x16x32_bf16 v[68:71], v[148:151], a[148:151], v[68:71]
s_add_u32 s72, s71, 30720
buffer_load_dwordx4 v15, s[24:27], s72 offen offset:2048 lds
v_mfma_f32_16x16x32_bf16 v[68:71], v[164:167], a[152:155], v[68:71]
s_nop 0
ds_read_b64_tr_b16 v[216:217], v10 offset:36864
ds_read_b64_tr_b16 v[218:219], v10 offset:38912
v_mfma_f32_16x16x32_bf16 v[68:71], v[180:183], a[156:159], v[68:71]
v_mfma_f32_16x16x32_bf16 v[52:55], v[180:183], a[140:143], v[52:55]
s_nop 0
ds_read_b64_tr_b16 v[220:221], v11 offset:36864
ds_read_b64_tr_b16 v[222:223], v11 offset:38912
v_mfma_f32_16x16x32_bf16 v[52:55], v[164:167], a[136:139], v[52:55]
s_nop 0
ds_read_b64_tr_b16 v[224:225], v8 offset:40960
ds_read_b64_tr_b16 v[226:227], v8 offset:43008
v_mfma_f32_16x16x32_bf16 v[52:55], v[148:151], a[132:135], v[52:55]
s_nop 0
ds_read_b64_tr_b16 v[228:229], v9 offset:40960
ds_read_b64_tr_b16 v[230:231], v9 offset:43008
v_mfma_f32_16x16x32_bf16 v[52:55], v[132:135], a[128:131], v[52:55]
s_add_u32 s72, s71, 46080
buffer_load_dwordx4 v15, s[24:27], s72 offen offset:3072 lds
v_mfma_f32_16x16x32_bf16 v[56:59], v[136:139], a[128:131], v[56:59]
v_mfma_f32_16x16x32_bf16 v[56:59], v[152:155], a[132:135], v[56:59]
s_nop 0
ds_read_b64_tr_b16 v[232:233], v10 offset:40960
ds_read_b64_tr_b16 v[234:235], v10 offset:43008
v_mfma_f32_16x16x32_bf16 v[56:59], v[168:171], a[136:139], v[56:59]
buffer_load_dwordx4 a[232:235], v1, s[44:47], s69 offen offset:2048 sc1
v_mfma_f32_16x16x32_bf16 v[56:59], v[184:187], a[140:143], v[56:59]
s_nop 0
ds_read_b64_tr_b16 v[236:237], v11 offset:40960
ds_read_b64_tr_b16 v[238:239], v11 offset:43008
v_mfma_f32_16x16x32_bf16 v[72:75], v[184:187], a[156:159], v[72:75]
s_nop 0
ds_read_b64_tr_b16 v[240:241], v8 offset:45056
ds_read_b64_tr_b16 v[242:243], v8 offset:47104
v_mfma_f32_16x16x32_bf16 v[72:75], v[168:171], a[152:155], v[72:75]
v_mfma_f32_16x16x32_bf16 v[72:75], v[152:155], a[148:151], v[72:75]
s_nop 0
ds_read_b64_tr_b16 v[244:245], v9 offset:45056
ds_read_b64_tr_b16 v[246:247], v9 offset:47104
v_mfma_f32_16x16x32_bf16 v[72:75], v[136:139], a[144:147], v[72:75]
s_xor_b32 s71, s15, 0x40100
ds_read_b64_tr_b16 v[248:249], v10 offset:45056
ds_read_b64_tr_b16 v[250:251], v10 offset:47104
v_mfma_f32_16x16x32_bf16 v[76:79], v[140:143], a[144:147], v[76:79]
s_add_u32 m0, s85, 0
ds_read_b64_tr_b16 v[252:253], v11 offset:45056
ds_read_b64_tr_b16 v[254:255], v11 offset:47104
v_mfma_f32_16x16x32_bf16 v[76:79], v[156:159], a[148:151], v[76:79]
s_add_u32 s72, s71, 0
buffer_load_dwordx4 v15, s[24:27], s72 offen lds
v_mfma_f32_16x16x32_bf16 v[76:79], v[172:175], a[152:155], v[76:79]
v_mfma_f32_16x16x32_bf16 v[76:79], v[188:191], a[156:159], v[76:79]
v_mfma_f32_16x16x32_bf16 v[60:63], v[188:191], a[140:143], v[60:63]
buffer_load_dwordx4 a[236:239], v1, s[44:47], s69 offen offset:3072 sc1
v_mfma_f32_16x16x32_bf16 v[60:63], v[172:175], a[136:139], v[60:63]
s_add_u32 s72, s71, 15360
v_mfma_f32_16x16x32_bf16 v[60:63], v[156:159], a[132:135], v[60:63]
s_waitcnt vmcnt(31) lgkmcnt(0)
v_mfma_f32_16x16x32_bf16 v[60:63], v[140:143], a[128:131], v[60:63]
s_barrier
buffer_load_dwordx4 v15, s[24:27], s72 offen offset:1024 lds
v_mfma_f32_16x16x32_bf16 v[80:83], v[192:195], a[128:131], v[80:83]
s_nop 0
ds_read_b64_tr_b16 v[128:129], v8 offset:49152
ds_read_b64_tr_b16 v[130:131], v8 offset:51200
v_mfma_f32_16x16x32_bf16 v[80:83], v[208:211], a[132:135], v[80:83]
s_nop 0
ds_read_b64_tr_b16 v[132:133], v9 offset:49152
ds_read_b64_tr_b16 v[134:135], v9 offset:51200
v_mfma_f32_16x16x32_bf16 v[80:83], v[224:227], a[136:139], v[80:83]
s_nop 0
ds_read_b64_tr_b16 v[136:137], v10 offset:49152
ds_read_b64_tr_b16 v[138:139], v10 offset:51200
s_waitcnt vmcnt(22)
v_cmp_gt_u32 vcc, 3, v114
s_cbranch_vccnz Lspin109
Lback110:
v_mfma_f32_16x16x32_bf16 v[80:83], v[240:243], a[140:143], v[80:83]
s_lshl_b32 s73, s76, 18
ds_read_b64_tr_b16 v[140:141], v11 offset:49152
ds_read_b64_tr_b16 v[142:143], v11 offset:51200
v_mfma_f32_16x16x32_bf16 v[96:99], v[240:243], a[156:159], v[96:99]
Lstube2:
s_cbranch_execz Lrete
s_lshl_b32 s84, s58, 16
v_mfma_f32_16x16x32_bf16 v[96:99], v[224:227], a[152:155], v[96:99]
s_add_u32 s72, s71, 30720
buffer_load_dwordx4 v15, s[24:27], s72 offen offset:2048 lds
v_mfma_f32_16x16x32_bf16 v[96:99], v[208:211], a[148:151], v[96:99]
s_add_u32 s69, s69, 0x20000
buffer_load_dwordx4 a[240:243], v1, s[44:47], s69 offen sc1
v_mfma_f32_16x16x32_bf16 v[96:99], v[192:195], a[144:147], v[96:99]
s_add_u32 s73, s73, s84
ds_read_b64_tr_b16 v[144:145], v8 offset:53248
ds_read_b64_tr_b16 v[146:147], v8 offset:55296
v_mfma_f32_16x16x32_bf16 v[100:103], v[196:199], a[144:147], v[100:103]
s_lshl_b32 s84, s75, 8
ds_read_b64_tr_b16 v[148:149], v9 offset:53248
ds_read_b64_tr_b16 v[150:151], v9 offset:55296
v_mfma_f32_16x16x32_bf16 v[100:103], v[212:215], a[148:151], v[100:103]
s_add_u32 s73, s73, s84
ds_read_b64_tr_b16 v[152:153], v10 offset:53248
ds_read_b64_tr_b16 v[154:155], v10 offset:55296
v_mfma_f32_16x16x32_bf16 v[100:103], v[228:231], a[152:155], v[100:103]
s_add_u32 s73, s73, 0x3400000
v_lshrrev_b32 v112, 4, v0
v_and_b32 v113, 15, v0
v_mfma_f32_16x16x32_bf16 v[100:103], v[244:247], a[156:159], v[100:103]
s_add_u32 s72, s71, 46080
buffer_load_dwordx4 v15, s[24:27], s72 offen offset:3072 lds
v_mfma_f32_16x16x32_bf16 v[84:87], v[244:247], a[140:143], v[84:87]
s_nop 0
ds_read_b64_tr_b16 v[156:157], v11 offset:53248
ds_read_b64_tr_b16 v[158:159], v11 offset:55296
v_mfma_f32_16x16x32_bf16 v[84:87], v[228:231], a[136:139], v[84:87]
s_nop 0
ds_read_b64_tr_b16 v[160:161], v8 offset:57344
ds_read_b64_tr_b16 v[162:163], v8 offset:59392
v_mfma_f32_16x16x32_bf16 v[84:87], v[212:215], a[132:135], v[84:87]
s_nop 0
ds_read_b64_tr_b16 v[164:165], v9 offset:57344
ds_read_b64_tr_b16 v[166:167], v9 offset:59392
v_mfma_f32_16x16x32_bf16 v[84:87], v[196:199], a[128:131], v[84:87]
v_xor_b32 v12, v113, v112
v_lshlrev_b32 v12, 4, v12
v_mfma_f32_16x16x32_bf16 v[88:91], v[200:203], a[128:131], v[88:91]
buffer_load_dwordx4 a[244:247], v1, s[44:47], s69 offen offset:1024 sc1
v_mfma_f32_16x16x32_bf16 v[88:91], v[216:219], a[132:135], v[88:91]
s_nop 0
ds_read_b64_tr_b16 v[168:169], v10 offset:57344
ds_read_b64_tr_b16 v[170:171], v10 offset:59392
v_mfma_f32_16x16x32_bf16 v[88:91], v[232:235], a[136:139], v[88:91]
s_nop 0
ds_read_b64_tr_b16 v[172:173], v11 offset:57344
ds_read_b64_tr_b16 v[174:175], v11 offset:59392
v_mfma_f32_16x16x32_bf16 v[88:91], v[248:251], a[140:143], v[88:91]
s_xor_b32 s71, s13, 0x40180
ds_read_b64_tr_b16 v[176:177], v8 offset:61440
ds_read_b64_tr_b16 v[178:179], v8 offset:63488
v_mfma_f32_16x16x32_bf16 v[104:107], v[248:251], a[156:159], v[104:107]
s_add_u32 m0, s85, 16384
v_lshl_add_u32 v112, v112, 12, v12
v_xor_b32 v12, 64, v112
v_mfma_f32_16x16x32_bf16 v[104:107], v[232:235], a[152:155], v[104:107]
s_add_u32 s72, s71, 0
buffer_load_dwordx4 v15, s[24:27], s72 offen lds
v_mfma_f32_16x16x32_bf16 v[104:107], v[216:219], a[148:151], v[104:107]
s_nop 0
ds_read_b64_tr_b16 v[180:181], v9 offset:61440
ds_read_b64_tr_b16 v[182:183], v9 offset:63488
v_mfma_f32_16x16x32_bf16 v[104:107], v[200:203], a[144:147], v[104:107]
s_nop 0
ds_read_b64_tr_b16 v[184:185], v10 offset:61440
ds_read_b64_tr_b16 v[186:187], v10 offset:63488
v_mfma_f32_16x16x32_bf16 v[108:111], v[204:207], a[144:147], v[108:111]
s_nop 0
ds_read_b64_tr_b16 v[188:189], v11 offset:61440
ds_read_b64_tr_b16 v[190:191], v11 offset:63488
v_mfma_f32_16x16x32_bf16 v[108:111], v[220:223], a[148:151], v[108:111]
v_lshlrev_b32 v113, 2, v113
v_mfma_f32_16x16x32_bf16 v[108:111], v[236:239], a[152:155], v[108:111]
s_add_u32 s72, s71, 15360
buffer_load_dwordx4 v15, s[24:27], s72 offen offset:1024 lds
v_mfma_f32_16x16x32_bf16 v[108:111], v[252:255], a[156:159], v[108:111]
buffer_load_dwordx4 a[248:251], v1, s[44:47], s69 offen offset:2048 sc1
v_mfma_f32_16x16x32_bf16 v[92:95], v[252:255], a[140:143], v[92:95]
v_xor_b32 v8, 0x10000, v8
v_mfma_f32_16x16x32_bf16 v[92:95], v[236:239], a[136:139], v[92:95]
v_xor_b32 v9, 0x10000, v9
v_mfma_f32_16x16x32_bf16 v[92:95], v[220:223], a[132:135], v[92:95]
s_waitcnt vmcnt(32) lgkmcnt(0)
v_xor_b32 v10, 0x10000, v10
v_mfma_f32_16x16x32_bf16 v[92:95], v[204:207], a[128:131], v[92:95]
s_barrier
v_xor_b32 v11, 0x10000, v11
v_mfma_f32_16x16x32_bf16 v[16:19], v[128:131], a[160:163], v[16:19]
s_add_u32 s72, s71, 30720
buffer_load_dwordx4 v15, s[24:27], s72 offen offset:2048 lds
v_mfma_f32_16x16x32_bf16 v[16:19], v[144:147], a[164:167], v[16:19]
s_nop 0
ds_read_b64_tr_b16 v[192:193], v8 offset:0
ds_read_b64_tr_b16 v[194:195], v8 offset:2048
v_mfma_f32_16x16x32_bf16 v[16:19], v[160:163], a[168:171], v[16:19]
s_nop 0
ds_read_b64_tr_b16 v[196:197], v9 offset:0
ds_read_b64_tr_b16 v[198:199], v9 offset:2048
v_mfma_f32_16x16x32_bf16 v[16:19], v[176:179], a[172:175], v[16:19]
s_nop 0
ds_read_b64_tr_b16 v[200:201], v10 offset:0
ds_read_b64_tr_b16 v[202:203], v10 offset:2048
v_mfma_f32_16x16x32_bf16 v[32:35], v[176:179], a[188:191], v[32:35]
buffer_load_dwordx4 a[252:255], v1, s[44:47], s69 offen offset:3072 sc1
v_mfma_f32_16x16x32_bf16 v[32:35], v[160:163], a[184:187], v[32:35]
v_mfma_f32_16x16x32_bf16 v[32:35], v[144:147], a[180:183], v[32:35]
s_add_u32 s72, s71, 46080
buffer_load_dwordx4 v15, s[24:27], s72 offen offset:3072 lds
v_mfma_f32_16x16x32_bf16 v[32:35], v[128:131], a[176:179], v[32:35]
s_nop 0
ds_read_b64_tr_b16 v[204:205], v11 offset:0
ds_read_b64_tr_b16 v[206:207], v11 offset:2048
v_mfma_f32_16x16x32_bf16 v[36:39], v[132:135], a[176:179], v[36:39]
s_nop 0
ds_read_b64_tr_b16 v[208:209], v8 offset:4096
ds_read_b64_tr_b16 v[210:211], v8 offset:6144
v_mfma_f32_16x16x32_bf16 v[36:39], v[148:151], a[180:183], v[36:39]
s_nop 0
ds_read_b64_tr_b16 v[212:213], v9 offset:4096
ds_read_b64_tr_b16 v[214:215], v9 offset:6144
v_mfma_f32_16x16x32_bf16 v[36:39], v[164:167], a[184:187], v[36:39]
v_mfma_f32_16x16x32_bf16 v[36:39], v[180:183], a[188:191], v[36:39]
s_nop 0
ds_read_b64_tr_b16 v[216:217], v10 offset:4096
ds_read_b64_tr_b16 v[218:219], v10 offset:6144
v_mfma_f32_16x16x32_bf16 v[20:23], v[180:183], a[172:175], v[20:23]
s_nop 0
ds_read_b64_tr_b16 v[220:221], v11 offset:4096
ds_read_b64_tr_b16 v[222:223], v11 offset:6144
v_mfma_f32_16x16x32_bf16 v[20:23], v[164:167], a[168:171], v[20:23]
v_mfma_f32_16x16x32_bf16 v[20:23], v[148:151], a[164:167], v[20:23]
s_xor_b32 s71, s14, 0x40180
ds_read_b64_tr_b16 v[224:225], v8 offset:8192
ds_read_b64_tr_b16 v[226:227], v8 offset:10240
v_mfma_f32_16x16x32_bf16 v[20:23], v[132:135], a[160:163], v[20:23]
s_add_u32 m0, s85, 32768
ds_read_b64_tr_b16 v[228:229], v9 offset:8192
ds_read_b64_tr_b16 v[230:231], v9 offset:10240
v_mfma_f32_16x16x32_bf16 v[24:27], v[136:139], a[160:163], v[24:27]
s_add_u32 s72, s71, 0
buffer_load_dwordx4 v15, s[24:27], s72 offen lds
v_mfma_f32_16x16x32_bf16 v[24:27], v[152:155], a[164:167], v[24:27]
s_nop 0
ds_read_b64_tr_b16 v[232:233], v10 offset:8192
ds_read_b64_tr_b16 v[234:235], v10 offset:10240
v_mfma_f32_16x16x32_bf16 v[24:27], v[168:171], a[168:171], v[24:27]
v_mfma_f32_16x16x32_bf16 v[24:27], v[184:187], a[172:175], v[24:27]
s_nop 0
ds_read_b64_tr_b16 v[236:237], v11 offset:8192
ds_read_b64_tr_b16 v[238:239], v11 offset:10240
v_mfma_f32_16x16x32_bf16 v[40:43], v[184:187], a[188:191], v[40:43]
s_nop 0
ds_read_b64_tr_b16 v[240:241], v8 offset:12288
ds_read_b64_tr_b16 v[242:243], v8 offset:14336
v_mfma_f32_16x16x32_bf16 v[40:43], v[168:171], a[184:187], v[40:43]
s_nop 0
ds_read_b64_tr_b16 v[244:245], v9 offset:12288
ds_read_b64_tr_b16 v[246:247], v9 offset:14336
v_mfma_f32_16x16x32_bf16 v[40:43], v[152:155], a[180:183], v[40:43]
s_add_u32 s72, s71, 15360
buffer_load_dwordx4 v15, s[24:27], s72 offen offset:1024 lds
v_mfma_f32_16x16x32_bf16 v[40:43], v[136:139], a[176:179], v[40:43]
v_mfma_f32_16x16x32_bf16 v[44:47], v[140:143], a[176:179], v[44:47]
s_nop 0
ds_read_b64_tr_b16 v[248:249], v10 offset:12288
ds_read_b64_tr_b16 v[250:251], v10 offset:14336
v_mfma_f32_16x16x32_bf16 v[44:47], v[156:159], a[180:183], v[44:47]
s_nop 0
ds_read_b64_tr_b16 v[252:253], v11 offset:12288
ds_read_b64_tr_b16 v[254:255], v11 offset:14336
v_mfma_f32_16x16x32_bf16 v[44:47], v[172:175], a[184:187], v[44:47]
v_mfma_f32_16x16x32_bf16 v[44:47], v[188:191], a[188:191], v[44:47]
v_mfma_f32_16x16x32_bf16 v[28:31], v[188:191], a[172:175], v[28:31]
s_add_u32 s72, s71, 30720
buffer_load_dwordx4 v15, s[24:27], s72 offen offset:2048 lds
v_mfma_f32_16x16x32_bf16 v[28:31], v[172:175], a[168:171], v[28:31]
v_mfma_f32_16x16x32_bf16 v[28:31], v[156:159], a[164:167], v[28:31]
s_waitcnt vmcnt(23) lgkmcnt(0)
v_mfma_f32_16x16x32_bf16 v[28:31], v[140:143], a[160:163], v[28:31]
s_barrier
v_mfma_f32_16x16x32_bf16 v[16:19], v[192:195], a[192:195], v[16:19]
s_nop 0
ds_read_b64_tr_b16 v[128:129], v8 offset:16384
ds_read_b64_tr_b16 v[130:131], v8 offset:18432
v_mfma_f32_16x16x32_bf16 v[16:19], v[208:211], a[196:199], v[16:19]
s_nop 0
ds_read_b64_tr_b16 v[132:133], v9 offset:16384
ds_read_b64_tr_b16 v[134:135], v9 offset:18432
v_mfma_f32_16x16x32_bf16 v[16:19], v[224:227], a[200:203], v[16:19]
s_add_u32 s72, s71, 46080
buffer_load_dwordx4 v15, s[24:27], s72 offen offset:3072 lds
v_mfma_f32_16x16x32_bf16 v[16:19], v[240:243], a[204:207], v[16:19]
s_nop 0
ds_read_b64_tr_b16 v[136:137], v10 offset:16384
ds_read_b64_tr_b16 v[138:139], v10 offset:18432
v_mfma_f32_16x16x32_bf16 v[32:35], v[240:243], a[220:223], v[32:35]
s_nop 0
ds_read_b64_tr_b16 v[140:141], v11 offset:16384
ds_read_b64_tr_b16 v[142:143], v11 offset:18432
v_mfma_f32_16x16x32_bf16 v[32:35], v[224:227], a[216:219], v[32:35]
v_mfma_f32_16x16x32_bf16 v[32:35], v[208:211], a[212:215], v[32:35]
s_nop 0
ds_read_b64_tr_b16 v[144:145], v8 offset:20480
ds_read_b64_tr_b16 v[146:147], v8 offset:22528
v_mfma_f32_16x16x32_bf16 v[32:35], v[192:195], a[208:211], v[32:35]
s_nop 0
ds_read_b64_tr_b16 v[148:149], v9 offset:20480
ds_read_b64_tr_b16 v[150:151], v9 offset:22528
v_mfma_f32_16x16x32_bf16 v[36:39], v[196:199], a[208:211], v[36:39]
s_nop 0
ds_read_b64_tr_b16 v[152:153], v10 offset:20480
ds_read_b64_tr_b16 v[154:155], v10 offset:22528
v_mfma_f32_16x16x32_bf16 v[36:39], v[212:215], a[212:215], v[36:39]
s_nop 0
ds_read_b64_tr_b16 v[156:157], v11 offset:20480
ds_read_b64_tr_b16 v[158:159], v11 offset:22528
v_mfma_f32_16x16x32_bf16 v[36:39], v[228:231], a[216:219], v[36:39]
v_mfma_f32_16x16x32_bf16 v[36:39], v[244:247], a[220:223], v[36:39]
s_add_u32 m0, s64, 147456
ds_read_b64_tr_b16 v[160:161], v8 offset:24576
ds_read_b64_tr_b16 v[162:163], v8 offset:26624
v_mfma_f32_16x16x32_bf16 v[20:23], v[244:247], a[204:207], v[20:23]
s_add_u32 s72, s73, 0
buffer_load_dwordx4 v112, s[44:47], s72 offen sc1 lds
v_mfma_f32_16x16x32_bf16 v[20:23], v[228:231], a[200:203], v[20:23]
s_nop 0
ds_read_b64_tr_b16 v[164:165], v9 offset:24576
ds_read_b64_tr_b16 v[166:167], v9 offset:26624
v_mfma_f32_16x16x32_bf16 v[20:23], v[212:215], a[196:199], v[20:23]
s_add_u32 s72, s73, 15360
buffer_load_dwordx4 v12, s[44:47], s72 offen offset:1024 sc1 lds
v_mfma_f32_16x16x32_bf16 v[20:23], v[196:199], a[192:195], v[20:23]
s_nop 0
ds_read_b64_tr_b16 v[168:169], v10 offset:24576
ds_read_b64_tr_b16 v[170:171], v10 offset:26624
v_mfma_f32_16x16x32_bf16 v[24:27], v[200:203], a[192:195], v[24:27]
s_nop 0
ds_read_b64_tr_b16 v[172:173], v11 offset:24576
ds_read_b64_tr_b16 v[174:175], v11 offset:26624
v_mfma_f32_16x16x32_bf16 v[24:27], v[216:219], a[196:199], v[24:27]
s_add_u32 s72, s73, 30720
buffer_load_dwordx4 v112, s[44:47], s72 offen offset:2048 sc1 lds
v_mfma_f32_16x16x32_bf16 v[24:27], v[232:235], a[200:203], v[24:27]
v_mfma_f32_16x16x32_bf16 v[24:27], v[248:251], a[204:207], v[24:27]
s_nop 0
ds_read_b64_tr_b16 v[176:177], v8 offset:28672
ds_read_b64_tr_b16 v[178:179], v8 offset:30720
v_mfma_f32_16x16x32_bf16 v[40:43], v[248:251], a[220:223], v[40:43]
s_add_u32 s72, s73, 46080
buffer_load_dwordx4 v12, s[44:47], s72 offen offset:3072 sc1 lds
v_mfma_f32_16x16x32_bf16 v[40:43], v[232:235], a[216:219], v[40:43]
s_xor_b32 s71, s15, 0x40180
ds_read_b64_tr_b16 v[180:181], v9 offset:28672
ds_read_b64_tr_b16 v[182:183], v9 offset:30720
v_mfma_f32_16x16x32_bf16 v[40:43], v[216:219], a[212:215], v[40:43]
s_add_u32 m0, s85, 49152
ds_read_b64_tr_b16 v[184:185], v10 offset:28672
ds_read_b64_tr_b16 v[186:187], v10 offset:30720
v_mfma_f32_16x16x32_bf16 v[40:43], v[200:203], a[208:211], v[40:43]
s_add_u32 s72, s71, 0
buffer_load_dwordx4 v15, s[24:27], s72 offen lds
v_mfma_f32_16x16x32_bf16 v[44:47], v[204:207], a[208:211], v[44:47]
s_nop 0
ds_read_b64_tr_b16 v[188:189], v11 offset:28672
ds_read_b64_tr_b16 v[190:191], v11 offset:30720
v_mfma_f32_16x16x32_bf16 v[44:47], v[220:223], a[212:215], v[44:47]
v_mfma_f32_16x16x32_bf16 v[44:47], v[236:239], a[216:219], v[44:47]
s_add_u32 s72, s71, 15360
buffer_load_dwordx4 v15, s[24:27], s72 offen offset:1024 lds
v_mfma_f32_16x16x32_bf16 v[44:47], v[252:255], a[220:223], v[44:47]
v_mfma_f32_16x16x32_bf16 v[28:31], v[252:255], a[204:207], v[28:31]
v_mfma_f32_16x16x32_bf16 v[28:31], v[236:239], a[200:203], v[28:31]
s_add_u32 s72, s71, 30720
buffer_load_dwordx4 v15, s[24:27], s72 offen offset:2048 lds
v_mfma_f32_16x16x32_bf16 v[28:31], v[220:223], a[196:199], v[28:31]
s_waitcnt vmcnt(12) lgkmcnt(0)
v_mfma_f32_16x16x32_bf16 v[28:31], v[204:207], a[192:195], v[28:31]
s_barrier
v_mfma_f32_16x16x32_bf16 v[16:19], v[128:131], a[224:227], v[16:19]
s_add_u32 s72, s71, 46080
buffer_load_dwordx4 v15, s[24:27], s72 offen offset:3072 lds
v_mfma_f32_16x16x32_bf16 v[16:19], v[144:147], a[228:231], v[16:19]
s_lshl_b32 s73, s75, 9
ds_read_b64_tr_b16 v[192:193], v8 offset:32768
ds_read_b64_tr_b16 v[194:195], v8 offset:34816
v_mfma_f32_16x16x32_bf16 v[16:19], v[160:163], a[232:235], v[16:19]
s_lshl_b32 s84, s58, 7
ds_read_b64_tr_b16 v[196:197], v9 offset:32768
ds_read_b64_tr_b16 v[198:199], v9 offset:34816
v_mfma_f32_16x16x32_bf16 v[16:19], v[176:179], a[236:239], v[16:19]
s_add_u32 s73, s73, s84
ds_read_b64_tr_b16 v[200:201], v10 offset:32768
ds_read_b64_tr_b16 v[202:203], v10 offset:34816
v_mfma_f32_16x16x32_bf16 v[20:23], v[180:183], a[236:239], v[20:23]
s_add_u32 s73, s73, 0x3800000
ds_read_b64_tr_b16 v[204:205], v11 offset:32768
ds_read_b64_tr_b16 v[206:207], v11 offset:34816
v_mfma_f32_16x16x32_bf16 v[20:23], v[164:167], a[232:235], v[20:23]
s_xor_b32 s71, s12, 0x0
buffer_load_dword v6, v113, s[44:47], s73 offen sc1
v_mfma_f32_16x16x32_bf16 v[20:23], v[148:151], a[228:231], v[20:23]
s_add_u32 m0, s77, 0
ds_read_b64_tr_b16 v[208:209], v8 offset:36864
ds_read_b64_tr_b16 v[210:211], v8 offset:38912
v_mfma_f32_16x16x32_bf16 v[20:23], v[132:135], a[224:227], v[20:23]
s_add_u32 s72, s71, 0
buffer_load_dwordx4 v15, s[24:27], s72 offen lds
v_mfma_f32_16x16x32_bf16 v[24:27], v[136:139], a[224:227], v[24:27]
s_nop 0
ds_read_b64_tr_b16 v[212:213], v9 offset:36864
ds_read_b64_tr_b16 v[214:215], v9 offset:38912
v_mfma_f32_16x16x32_bf16 v[24:27], v[152:155], a[228:231], v[24:27]
s_nop 0
ds_read_b64_tr_b16 v[216:217], v10 offset:36864
ds_read_b64_tr_b16 v[218:219], v10 offset:38912
v_mfma_f32_16x16x32_bf16 v[24:27], v[168:171], a[232:235], v[24:27]
buffer_load_dword v7, v113, s[44:47], s73 offen offset:64 sc1
v_mfma_f32_16x16x32_bf16 v[24:27], v[184:187], a[236:239], v[24:27]
s_nop 0
ds_read_b64_tr_b16 v[220:221], v11 offset:36864
ds_read_b64_tr_b16 v[222:223], v11 offset:38912
v_cvt_pk_bf16_f32 v16, v16, v17
v_mfma_f32_16x16x32_bf16 v[28:31], v[188:191], a[236:239], v[28:31]
s_nop 0
ds_read_b64_tr_b16 v[224:225], v8 offset:40960
ds_read_b64_tr_b16 v[226:227], v8 offset:43008
v_cvt_pk_bf16_f32 v17, v18, v19
v_mfma_f32_16x16x32_bf16 v[28:31], v[172:175], a[232:235], v[28:31]
s_add_u32 s72, s71, 15360
buffer_load_dwordx4 v15, s[24:27], s72 offen offset:1024 lds
v_cvt_pk_bf16_f32 v18, v20, v21
v_mfma_f32_16x16x32_bf16 v[28:31], v[156:159], a[228:231], v[28:31]
s_nop 0
ds_read_b64_tr_b16 v[228:229], v9 offset:40960
ds_read_b64_tr_b16 v[230:231], v9 offset:43008
v_cvt_pk_bf16_f32 v19, v22, v23
v_mfma_f32_16x16x32_bf16 v[28:31], v[140:143], a[224:227], v[28:31]
v_mfma_f32_16x16x32_bf16 v[32:35], v[128:131], a[240:243], v[32:35]
s_xor_b32 s80, s93, 0x80000
ds_read_b64_tr_b16 v[232:233], v10 offset:40960
ds_read_b64_tr_b16 v[234:235], v10 offset:43008
v_mfma_f32_16x16x32_bf16 v[32:35], v[144:147], a[244:247], v[32:35]
s_add_u32 s80, s80, 0x3a00000
buffer_store_dwordx4 v[16:19], v1, s[44:47], s80 offen sc1
v_mfma_f32_16x16x32_bf16 v[32:35], v[160:163], a[248:251], v[32:35]
s_nop 0
ds_read_b64_tr_b16 v[236:237], v11 offset:40960
ds_read_b64_tr_b16 v[238:239], v11 offset:43008
v_mfma_f32_16x16x32_bf16 v[32:35], v[176:179], a[252:255], v[32:35]
s_add_u32 s72, s71, 30720
buffer_load_dwordx4 v15, s[24:27], s72 offen offset:2048 lds
v_cvt_pk_bf16_f32 v20, v24, v25
v_mfma_f32_16x16x32_bf16 v[36:39], v[180:183], a[252:255], v[36:39]
s_nop 0
ds_read_b64_tr_b16 v[240:241], v8 offset:45056
ds_read_b64_tr_b16 v[242:243], v8 offset:47104
v_cvt_pk_bf16_f32 v21, v26, v27
v_mfma_f32_16x16x32_bf16 v[36:39], v[164:167], a[248:251], v[36:39]
v_cvt_pk_bf16_f32 v22, v28, v29
v_cvt_pk_bf16_f32 v23, v30, v31
v_mfma_f32_16x16x32_bf16 v[36:39], v[148:151], a[244:247], v[36:39]
s_nop 0
ds_read_b64_tr_b16 v[244:245], v9 offset:45056
ds_read_b64_tr_b16 v[246:247], v9 offset:47104
v_mfma_f32_16x16x32_bf16 v[36:39], v[132:135], a[240:243], v[36:39]
s_nop 0
ds_read_b64_tr_b16 v[248:249], v10 offset:45056
ds_read_b64_tr_b16 v[250:251], v10 offset:47104
v_mfma_f32_16x16x32_bf16 v[40:43], v[136:139], a[240:243], v[40:43]
s_nop 0
ds_read_b64_tr_b16 v[252:253], v11 offset:45056
ds_read_b64_tr_b16 v[254:255], v11 offset:47104
v_mfma_f32_16x16x32_bf16 v[40:43], v[152:155], a[244:247], v[40:43]
s_add_u32 s72, s71, 46080
buffer_load_dwordx4 v15, s[24:27], s72 offen offset:3072 lds
v_mfma_f32_16x16x32_bf16 v[40:43], v[168:171], a[248:251], v[40:43]
v_mfma_f32_16x16x32_bf16 v[40:43], v[184:187], a[252:255], v[40:43]
v_cvt_pk_bf16_f32 v24, v32, v33
v_cvt_pk_bf16_f32 v25, v34, v35
v_cvt_pk_bf16_f32 v26, v36, v37
v_mfma_f32_16x16x32_bf16 v[44:47], v[188:191], a[252:255], v[44:47]
v_cvt_pk_bf16_f32 v27, v38, v39
v_mfma_f32_16x16x32_bf16 v[44:47], v[172:175], a[248:251], v[44:47]
v_mfma_f32_16x16x32_bf16 v[44:47], v[156:159], a[244:247], v[44:47]
s_waitcnt vmcnt(33) lgkmcnt(0)
v_mfma_f32_16x16x32_bf16 v[44:47], v[140:143], a[240:243], v[44:47]
s_barrier
v_mfma_f32_16x16x32_bf16 v[48:51], v[192:195], a[160:163], v[48:51]
s_nop 0
ds_read_b64_tr_b16 v[128:129], v8 offset:49152
ds_read_b64_tr_b16 v[130:131], v8 offset:51200
v_mfma_f32_16x16x32_bf16 v[48:51], v[208:211], a[164:167], v[48:51]
s_xor_b32 s71, s13, 0x0
buffer_store_dwordx4 v[20:23], v1, s[44:47], s80 offen offset:1024 sc1
v_mfma_f32_16x16x32_bf16 v[48:51], v[224:227], a[168:171], v[48:51]
s_add_u32 m0, s77, 16384
ds_read_b64_tr_b16 v[132:133], v9 offset:49152
ds_read_b64_tr_b16 v[134:135], v9 offset:51200
v_mfma_f32_16x16x32_bf16 v[48:51], v[240:243], a[172:175], v[48:51]
s_add_u32 s72, s71, 0
buffer_load_dwordx4 v15, s[24:27], s72 offen lds
v_cvt_pk_bf16_f32 v28, v40, v41
v_mfma_f32_16x16x32_bf16 v[64:67], v[240:243], a[188:191], v[64:67]
s_nop 0
ds_read_b64_tr_b16 v[136:137], v10 offset:49152
ds_read_b64_tr_b16 v[138:139], v10 offset:51200
v_cvt_pk_bf16_f32 v29, v42, v43
v_mfma_f32_16x16x32_bf16 v[64:67], v[224:227], a[184:187], v[64:67]
s_nop 0
ds_read_b64_tr_b16 v[140:141], v11 offset:49152
ds_read_b64_tr_b16 v[142:143], v11 offset:51200
v_cvt_pk_bf16_f32 v30, v44, v45
v_mfma_f32_16x16x32_bf16 v[64:67], v[208:211], a[180:183], v[64:67]
v_cvt_pk_bf16_f32 v31, v46, v47
v_mfma_f32_16x16x32_bf16 v[64:67], v[192:195], a[176:179], v[64:67]
s_nop 0
ds_read_b64_tr_b16 v[144:145], v8 offset:53248
ds_read_b64_tr_b16 v[146:147], v8 offset:55296
v_mfma_f32_16x16x32_bf16 v[68:71], v[196:199], a[176:179], v[68:71]
s_add_u32 s72, s71, 15360
buffer_load_dwordx4 v15, s[24:27], s72 offen offset:1024 lds
v_mfma_f32_16x16x32_bf16 v[68:71], v[212:215], a[180:183], v[68:71]
s_nop 0
ds_read_b64_tr_b16 v[148:149], v9 offset:53248
ds_read_b64_tr_b16 v[150:151], v9 offset:55296
v_mfma_f32_16x16x32_bf16 v[68:71], v[228:231], a[184:187], v[68:71]
s_nop 0
ds_read_b64_tr_b16 v[152:153], v10 offset:53248
ds_read_b64_tr_b16 v[154:155], v10 offset:55296
v_mfma_f32_16x16x32_bf16 v[68:71], v[244:247], a[188:191], v[68:71]
v_mfma_f32_16x16x32_bf16 v[52:55], v[244:247], a[172:175], v[52:55]
s_nop 0
ds_read_b64_tr_b16 v[156:157], v11 offset:53248
ds_read_b64_tr_b16 v[158:159], v11 offset:55296
v_mfma_f32_16x16x32_bf16 v[52:55], v[228:231], a[168:171], v[52:55]
s_nop 0
ds_read_b64_tr_b16 v[160:161], v8 offset:57344
ds_read_b64_tr_b16 v[162:163], v8 offset:59392
v_mfma_f32_16x16x32_bf16 v[52:55], v[212:215], a[164:167], v[52:55]
s_add_u32 s72, s71, 30720
buffer_load_dwordx4 v15, s[24:27], s72 offen offset:2048 lds
v_mfma_f32_16x16x32_bf16 v[52:55], v[196:199], a[160:163], v[52:55]
s_nop 0
ds_read_b64_tr_b16 v[164:165], v9 offset:57344
ds_read_b64_tr_b16 v[166:167], v9 offset:59392
v_mfma_f32_16x16x32_bf16 v[56:59], v[200:203], a[160:163], v[56:59]
v_mfma_f32_16x16x32_bf16 v[56:59], v[216:219], a[164:167], v[56:59]
buffer_store_dwordx4 v[24:27], v1, s[44:47], s80 offen offset:2048 sc1
v_mfma_f32_16x16x32_bf16 v[56:59], v[232:235], a[168:171], v[56:59]
s_nop 0
ds_read_b64_tr_b16 v[168:169], v10 offset:57344
ds_read_b64_tr_b16 v[170:171], v10 offset:59392
v_mfma_f32_16x16x32_bf16 v[56:59], v[248:251], a[172:175], v[56:59]
s_nop 0
ds_read_b64_tr_b16 v[172:173], v11 offset:57344
ds_read_b64_tr_b16 v[174:175], v11 offset:59392
v_mfma_f32_16x16x32_bf16 v[72:75], v[248:251], a[188:191], v[72:75]
s_add_u32 s72, s71, 46080
buffer_load_dwordx4 v15, s[24:27], s72 offen offset:3072 lds
v_mfma_f32_16x16x32_bf16 v[72:75], v[232:235], a[184:187], v[72:75]
s_nop 0
ds_read_b64_tr_b16 v[176:177], v8 offset:61440
ds_read_b64_tr_b16 v[178:179], v8 offset:63488
v_mfma_f32_16x16x32_bf16 v[72:75], v[216:219], a[180:183], v[72:75]
v_mfma_f32_16x16x32_bf16 v[72:75], v[200:203], a[176:179], v[72:75]
s_nop 0
ds_read_b64_tr_b16 v[180:181], v9 offset:61440
ds_read_b64_tr_b16 v[182:183], v9 offset:63488
v_mfma_f32_16x16x32_bf16 v[76:79], v[204:207], a[176:179], v[76:79]
s_nop 0
ds_read_b64_tr_b16 v[184:185], v10 offset:61440
ds_read_b64_tr_b16 v[186:187], v10 offset:63488
v_mfma_f32_16x16x32_bf16 v[76:79], v[220:223], a[180:183], v[76:79]
s_nop 0
ds_read_b64_tr_b16 v[188:189], v11 offset:61440
ds_read_b64_tr_b16 v[190:191], v11 offset:63488
v_mfma_f32_16x16x32_bf16 v[76:79], v[236:239], a[184:187], v[76:79]
v_mfma_f32_16x16x32_bf16 v[76:79], v[252:255], a[188:191], v[76:79]
s_xor_b32 s71, s14, 0x0
v_mfma_f32_16x16x32_bf16 v[60:63], v[252:255], a[172:175], v[60:63]
s_add_u32 m0, s77, 32768
v_xor_b32 v8, 0x10000, v8
v_mfma_f32_16x16x32_bf16 v[60:63], v[236:239], a[168:171], v[60:63]
s_add_u32 s72, s71, 0
v_xor_b32 v9, 0x10000, v9
v_mfma_f32_16x16x32_bf16 v[60:63], v[220:223], a[164:167], v[60:63]
s_waitcnt vmcnt(32) lgkmcnt(0)
buffer_load_dwordx4 v15, s[24:27], s72 offen lds
v_xor_b32 v10, 0x10000, v10
v_mfma_f32_16x16x32_bf16 v[60:63], v[204:207], a[160:163], v[60:63]
s_barrier
v_xor_b32 v11, 0x10000, v11
v_mfma_f32_16x16x32_bf16 v[48:51], v[128:131], a[192:195], v[48:51]
s_nop 0
ds_read_b64_tr_b16 v[192:193], v8 offset:0
ds_read_b64_tr_b16 v[194:195], v8 offset:2048
v_mfma_f32_16x16x32_bf16 v[48:51], v[144:147], a[196:199], v[48:51]
buffer_store_dwordx4 v[28:31], v1, s[44:47], s80 offen offset:3072 sc1
v_mfma_f32_16x16x32_bf16 v[48:51], v[160:163], a[200:203], v[48:51]
s_nop 0
ds_read_b64_tr_b16 v[196:197], v9 offset:0
ds_read_b64_tr_b16 v[198:199], v9 offset:2048
v_mfma_f32_16x16x32_bf16 v[48:51], v[176:179], a[204:207], v[48:51]
s_add_u32 s72, s71, 15360
buffer_load_dwordx4 v15, s[24:27], s72 offen offset:1024 lds
v_mfma_f32_16x16x32_bf16 v[64:67], v[176:179], a[220:223], v[64:67]
s_nop 0
ds_read_b64_tr_b16 v[200:201], v10 offset:0
ds_read_b64_tr_b16 v[202:203], v10 offset:2048
v_mfma_f32_16x16x32_bf16 v[64:67], v[160:163], a[216:219], v[64:67]
v_mfma_f32_16x16x32_bf16 v[64:67], v[144:147], a[212:215], v[64:67]
s_nop 0
ds_read_b64_tr_b16 v[204:205], v11 offset:0
ds_read_b64_tr_b16 v[206:207], v11 offset:2048
v_mfma_f32_16x16x32_bf16 v[64:67], v[128:131], a[208:211], v[64:67]
s_nop 0
ds_read_b64_tr_b16 v[208:209], v8 offset:4096
ds_read_b64_tr_b16 v[210:211], v8 offset:6144
v_mfma_f32_16x16x32_bf16 v[68:71], v[132:135], a[208:211], v[68:71]
s_nop 0
ds_read_b64_tr_b16 v[212:213], v9 offset:4096
ds_read_b64_tr_b16 v[214:215], v9 offset:6144
v_mfma_f32_16x16x32_bf16 v[68:71], v[148:151], a[212:215], v[68:71]
s_add_u32 s72, s71, 30720
buffer_load_dwordx4 v15, s[24:27], s72 offen offset:2048 lds
v_mfma_f32_16x16x32_bf16 v[68:71], v[164:167], a[216:219], v[68:71]
v_mfma_f32_16x16x32_bf16 v[68:71], v[180:183], a[220:223], v[68:71]
s_nop 0
ds_read_b64_tr_b16 v[216:217], v10 offset:4096
ds_read_b64_tr_b16 v[218:219], v10 offset:6144
v_mfma_f32_16x16x32_bf16 v[52:55], v[180:183], a[204:207], v[52:55]
s_nop 0
ds_read_b64_tr_b16 v[220:221], v11 offset:4096
ds_read_b64_tr_b16 v[222:223], v11 offset:6144
v_mfma_f32_16x16x32_bf16 v[52:55], v[164:167], a[200:203], v[52:55]
v_mfma_f32_16x16x32_bf16 v[52:55], v[148:151], a[196:199], v[52:55]
s_nop 0
ds_read_b64_tr_b16 v[224:225], v8 offset:8192
ds_read_b64_tr_b16 v[226:227], v8 offset:10240
v_mfma_f32_16x16x32_bf16 v[52:55], v[132:135], a[192:195], v[52:55]
s_add_u32 s72, s71, 46080
buffer_load_dwordx4 v15, s[24:27], s72 offen offset:3072 lds
v_mfma_f32_16x16x32_bf16 v[56:59], v[136:139], a[192:195], v[56:59]
s_nop 0
ds_read_b64_tr_b16 v[228:229], v9 offset:8192
ds_read_b64_tr_b16 v[230:231], v9 offset:10240
v_mfma_f32_16x16x32_bf16 v[56:59], v[152:155], a[196:199], v[56:59]
s_nop 0
ds_read_b64_tr_b16 v[232:233], v10 offset:8192
ds_read_b64_tr_b16 v[234:235], v10 offset:10240
v_mfma_f32_16x16x32_bf16 v[56:59], v[168:171], a[200:203], v[56:59]
v_mfma_f32_16x16x32_bf16 v[56:59], v[184:187], a[204:207], v[56:59]
s_nop 0
ds_read_b64_tr_b16 v[236:237], v11 offset:8192
ds_read_b64_tr_b16 v[238:239], v11 offset:10240
v_mfma_f32_16x16x32_bf16 v[72:75], v[184:187], a[220:223], v[72:75]
s_nop 0
ds_read_b64_tr_b16 v[240:241], v8 offset:12288
ds_read_b64_tr_b16 v[242:243], v8 offset:14336
v_mfma_f32_16x16x32_bf16 v[72:75], v[168:171], a[216:219], v[72:75]
s_nop 0
Lstube3:
s_cbranch_execz Lrete
ds_read_b64_tr_b16 v[244:245], v9 offset:12288
ds_read_b64_tr_b16 v[246:247], v9 offset:14336
v_mfma_f32_16x16x32_bf16 v[72:75], v[152:155], a[212:215], v[72:75]
v_mfma_f32_16x16x32_bf16 v[72:75], v[136:139], a[208:211], v[72:75]
s_xor_b32 s71, s15, 0x0
ds_read_b64_tr_b16 v[248:249], v10 offset:12288
ds_read_b64_tr_b16 v[250:251], v10 offset:14336
v_mfma_f32_16x16x32_bf16 v[76:79], v[140:143], a[208:211], v[76:79]
s_add_u32 m0, s77, 49152
ds_read_b64_tr_b16 v[252:253], v11 offset:12288
ds_read_b64_tr_b16 v[254:255], v11 offset:14336
v_mfma_f32_16x16x32_bf16 v[76:79], v[156:159], a[212:215], v[76:79]
s_add_u32 s72, s71, 0
buffer_load_dwordx4 v15, s[24:27], s72 offen lds
v_mfma_f32_16x16x32_bf16 v[76:79], v[172:175], a[216:219], v[76:79]
v_mfma_f32_16x16x32_bf16 v[76:79], v[188:191], a[220:223], v[76:79]
v_mfma_f32_16x16x32_bf16 v[60:63], v[188:191], a[204:207], v[60:63]
v_mfma_f32_16x16x32_bf16 v[60:63], v[172:175], a[200:203], v[60:63]
s_add_u32 s72, s71, 15360
v_mfma_f32_16x16x32_bf16 v[60:63], v[156:159], a[196:199], v[60:63]
s_waitcnt vmcnt(31) lgkmcnt(0)
v_mfma_f32_16x16x32_bf16 v[60:63], v[140:143], a[192:195], v[60:63]
s_barrier
buffer_load_dwordx4 v15, s[24:27], s72 offen offset:1024 lds
v_mfma_f32_16x16x32_bf16 v[48:51], v[192:195], a[224:227], v[48:51]
s_nop 0
ds_read_b64_tr_b16 v[128:129], v8 offset:16384
ds_read_b64_tr_b16 v[130:131], v8 offset:18432
v_mfma_f32_16x16x32_bf16 v[48:51], v[208:211], a[228:231], v[48:51]
s_nop 0
ds_read_b64_tr_b16 v[132:133], v9 offset:16384
ds_read_b64_tr_b16 v[134:135], v9 offset:18432
v_mfma_f32_16x16x32_bf16 v[48:51], v[224:227], a[232:235], v[48:51]
s_nop 0
ds_read_b64_tr_b16 v[136:137], v10 offset:16384
ds_read_b64_tr_b16 v[138:139], v10 offset:18432
v_mfma_f32_16x16x32_bf16 v[48:51], v[240:243], a[236:239], v[48:51]
v_mfma_f32_16x16x32_bf16 v[52:55], v[244:247], a[236:239], v[52:55]
s_nop 0
ds_read_b64_tr_b16 v[140:141], v11 offset:16384
ds_read_b64_tr_b16 v[142:143], v11 offset:18432
v_mfma_f32_16x16x32_bf16 v[52:55], v[228:231], a[232:235], v[52:55]
s_add_u32 s72, s71, 30720
buffer_load_dwordx4 v15, s[24:27], s72 offen offset:2048 lds
v_mfma_f32_16x16x32_bf16 v[52:55], v[212:215], a[228:231], v[52:55]
s_nop 0
ds_read_b64_tr_b16 v[144:145], v8 offset:20480
ds_read_b64_tr_b16 v[146:147], v8 offset:22528
v_mfma_f32_16x16x32_bf16 v[52:55], v[196:199], a[224:227], v[52:55]
s_nop 0
ds_read_b64_tr_b16 v[148:149], v9 offset:20480
ds_read_b64_tr_b16 v[150:151], v9 offset:22528
v_mfma_f32_16x16x32_bf16 v[56:59], v[200:203], a[224:227], v[56:59]
v_mfma_f32_16x16x32_bf16 v[56:59], v[216:219], a[228:231], v[56:59]
s_nop 0
ds_read_b64_tr_b16 v[152:153], v10 offset:20480
ds_read_b64_tr_b16 v[154:155], v10 offset:22528
v_mfma_f32_16x16x32_bf16 v[56:59], v[232:235], a[232:235], v[56:59]
s_nop 0
ds_read_b64_tr_b16 v[156:157], v11 offset:20480
ds_read_b64_tr_b16 v[158:159], v11 offset:22528
v_mfma_f32_16x16x32_bf16 v[56:59], v[248:251], a[236:239], v[56:59]
s_add_u32 s72, s71, 46080
buffer_load_dwordx4 v15, s[24:27], s72 offen offset:3072 lds
v_cvt_pk_bf16_f32 v48, v48, v49
v_mfma_f32_16x16x32_bf16 v[60:63], v[252:255], a[236:239], v[60:63]
v_cvt_pk_bf16_f32 v49, v50, v51
v_cvt_pk_bf16_f32 v50, v52, v53
v_cvt_pk_bf16_f32 v51, v54, v55
v_mfma_f32_16x16x32_bf16 v[60:63], v[236:239], a[232:235], v[60:63]
s_nop 0
ds_read_b64_tr_b16 v[160:161], v8 offset:24576
ds_read_b64_tr_b16 v[162:163], v8 offset:26624
v_mfma_f32_16x16x32_bf16 v[60:63], v[220:223], a[228:231], v[60:63]
s_nop 0
ds_read_b64_tr_b16 v[164:165], v9 offset:24576
ds_read_b64_tr_b16 v[166:167], v9 offset:26624
v_mfma_f32_16x16x32_bf16 v[60:63], v[204:207], a[224:227], v[60:63]
s_nop 0
ds_read_b64_tr_b16 v[168:169], v10 offset:24576
ds_read_b64_tr_b16 v[170:171], v10 offset:26624
v_mfma_f32_16x16x32_bf16 v[64:67], v[192:195], a[240:243], v[64:67]
s_xor_b32 s80, s93, 0x100000
v_mfma_f32_16x16x32_bf16 v[64:67], v[208:211], a[244:247], v[64:67]
s_add_u32 s80, s80, 0x3e00000
buffer_store_dwordx4 v[48:51], v1, s[44:47], s80 offen sc1
v_mfma_f32_16x16x32_bf16 v[64:67], v[224:227], a[248:251], v[64:67]
s_nop 0
ds_read_b64_tr_b16 v[172:173], v11 offset:24576
ds_read_b64_tr_b16 v[174:175], v11 offset:26624
v_mfma_f32_16x16x32_bf16 v[64:67], v[240:243], a[252:255], v[64:67]
s_xor_b32 s71, s12, 0x40000
ds_read_b64_tr_b16 v[176:177], v8 offset:28672
ds_read_b64_tr_b16 v[178:179], v8 offset:30720
v_cvt_pk_bf16_f32 v52, v56, v57
v_mfma_f32_16x16x32_bf16 v[68:71], v[244:247], a[252:255], v[68:71]
s_add_u32 m0, s85, 0
ds_read_b64_tr_b16 v[180:181], v9 offset:28672
ds_read_b64_tr_b16 v[182:183], v9 offset:30720
v_cvt_pk_bf16_f32 v53, v58, v59
v_mfma_f32_16x16x32_bf16 v[68:71], v[228:231], a[248:251], v[68:71]
s_add_u32 s72, s71, 0
buffer_load_dwordx4 v15, s[24:27], s72 offen lds
v_cvt_pk_bf16_f32 v54, v60, v61
v_mfma_f32_16x16x32_bf16 v[68:71], v[212:215], a[244:247], v[68:71]
v_cvt_pk_bf16_f32 v55, v62, v63
v_mfma_f32_16x16x32_bf16 v[68:71], v[196:199], a[240:243], v[68:71]
s_nop 0
ds_read_b64_tr_b16 v[184:185], v10 offset:28672
ds_read_b64_tr_b16 v[186:187], v10 offset:30720
v_mfma_f32_16x16x32_bf16 v[72:75], v[200:203], a[240:243], v[72:75]
s_nop 0
ds_read_b64_tr_b16 v[188:189], v11 offset:28672
ds_read_b64_tr_b16 v[190:191], v11 offset:30720
v_mfma_f32_16x16x32_bf16 v[72:75], v[216:219], a[244:247], v[72:75]
v_mfma_f32_16x16x32_bf16 v[72:75], v[232:235], a[248:251], v[72:75]
s_add_u32 s72, s71, 15360
buffer_load_dwordx4 v15, s[24:27], s72 offen offset:1024 lds
v_mfma_f32_16x16x32_bf16 v[72:75], v[248:251], a[252:255], v[72:75]
v_cvt_pk_bf16_f32 v56, v64, v65
v_cvt_pk_bf16_f32 v57, v66, v67
v_cvt_pk_bf16_f32 v58, v68, v69
v_mfma_f32_16x16x32_bf16 v[76:79], v[252:255], a[252:255], v[76:79]
v_cvt_pk_bf16_f32 v59, v70, v71
v_mfma_f32_16x16x32_bf16 v[76:79], v[236:239], a[248:251], v[76:79]
v_mfma_f32_16x16x32_bf16 v[76:79], v[220:223], a[244:247], v[76:79]
s_waitcnt vmcnt(29) lgkmcnt(0)
v_mfma_f32_16x16x32_bf16 v[76:79], v[204:207], a[240:243], v[76:79]
s_barrier
v_mfma_f32_16x16x32_bf16 v[80:83], v[128:131], a[160:163], v[80:83]
s_add_u32 s72, s71, 30720
buffer_load_dwordx4 v15, s[24:27], s72 offen offset:2048 lds
v_mfma_f32_16x16x32_bf16 v[80:83], v[144:147], a[164:167], v[80:83]
s_waitcnt vmcnt(23)
buffer_store_dwordx4 v[52:55], v1, s[44:47], s80 offen offset:1024 sc1
v_mfma_f32_16x16x32_bf16 v[80:83], v[160:163], a[168:171], v[80:83]
s_nop 0
ds_read_b64_tr_b16 v[192:193], v8 offset:32768
ds_read_b64_tr_b16 v[194:195], v8 offset:34816
v_mfma_f32_16x16x32_bf16 v[80:83], v[176:179], a[172:175], v[80:83]
s_nop 0
ds_read_b64_tr_b16 v[196:197], v9 offset:32768
ds_read_b64_tr_b16 v[198:199], v9 offset:34816
v_cvt_pk_bf16_f32 v60, v72, v73
v_mfma_f32_16x16x32_bf16 v[96:99], v[176:179], a[188:191], v[96:99]
s_nop 0
ds_read_b64_tr_b16 v[200:201], v10 offset:32768
ds_read_b64_tr_b16 v[202:203], v10 offset:34816
v_cvt_pk_bf16_f32 v61, v74, v75
v_mfma_f32_16x16x32_bf16 v[96:99], v[160:163], a[184:187], v[96:99]
s_nop 0
ds_read_b64_tr_b16 v[204:205], v11 offset:32768
ds_read_b64_tr_b16 v[206:207], v11 offset:34816
v_cvt_pk_bf16_f32 v62, v76, v77
v_mfma_f32_16x16x32_bf16 v[96:99], v[144:147], a[180:183], v[96:99]
s_add_u32 s72, s71, 46080
buffer_load_dwordx4 v15, s[24:27], s72 offen offset:3072 lds
v_cvt_pk_bf16_f32 v63, v78, v79
v_mfma_f32_16x16x32_bf16 v[96:99], v[128:131], a[176:179], v[96:99]
v_sub_f32 v112, 1.0, v6
v_sub_f32 v113, 1.0, v7
v_mfma_f32_16x16x32_bf16 v[100:103], v[132:135], a[176:179], v[100:103]
s_nop 0
ds_read_b64_tr_b16 v[208:209], v8 offset:36864
ds_read_b64_tr_b16 v[210:211], v8 offset:38912
v_mfma_f32_16x16x32_bf16 v[100:103], v[148:151], a[180:183], v[100:103]
s_nop 0
ds_read_b64_tr_b16 v[212:213], v9 offset:36864
ds_read_b64_tr_b16 v[214:215], v9 offset:38912
v_mfma_f32_16x16x32_bf16 v[100:103], v[164:167], a[184:187], v[100:103]
s_nop 0
ds_read_b64_tr_b16 v[216:217], v10 offset:36864
ds_read_b64_tr_b16 v[218:219], v10 offset:38912
v_mfma_f32_16x16x32_bf16 v[100:103], v[180:183], a[188:191], v[100:103]
v_mfma_f32_16x16x32_bf16 v[84:87], v[180:183], a[172:175], v[84:87]
s_nop 0
ds_read_b64_tr_b16 v[220:221], v11 offset:36864
ds_read_b64_tr_b16 v[222:223], v11 offset:38912
v_mfma_f32_16x16x32_bf16 v[84:87], v[164:167], a[168:171], v[84:87]
s_nop 0
ds_read_b64_tr_b16 v[224:225], v8 offset:40960
ds_read_b64_tr_b16 v[226:227], v8 offset:43008
v_mfma_f32_16x16x32_bf16 v[84:87], v[148:151], a[164:167], v[84:87]
s_xor_b32 s71, s13, 0x40000
ds_read_b64_tr_b16 v[228:229], v9 offset:40960
ds_read_b64_tr_b16 v[230:231], v9 offset:43008
v_mfma_f32_16x16x32_bf16 v[84:87], v[132:135], a[160:163], v[84:87]
s_add_u32 m0, s85, 16384
v_mfma_f32_16x16x32_bf16 v[88:91], v[136:139], a[160:163], v[88:91]
s_add_u32 s72, s71, 0
buffer_load_dwordx4 v15, s[24:27], s72 offen lds
v_mfma_f32_16x16x32_bf16 v[88:91], v[152:155], a[164:167], v[88:91]
buffer_store_dwordx4 v[56:59], v1, s[44:47], s80 offen offset:2048 sc1
v_mfma_f32_16x16x32_bf16 v[88:91], v[168:171], a[168:171], v[88:91]
s_nop 0
ds_read_b64_tr_b16 v[232:233], v10 offset:40960
ds_read_b64_tr_b16 v[234:235], v10 offset:43008
v_mfma_f32_16x16x32_bf16 v[88:91], v[184:187], a[172:175], v[88:91]
s_nop 0
ds_read_b64_tr_b16 v[236:237], v11 offset:40960
ds_read_b64_tr_b16 v[238:239], v11 offset:43008
v_mfma_f32_16x16x32_bf16 v[104:107], v[184:187], a[188:191], v[104:107]
s_nop 0
ds_read_b64_tr_b16 v[240:241], v8 offset:45056
ds_read_b64_tr_b16 v[242:243], v8 offset:47104
v_mfma_f32_16x16x32_bf16 v[104:107], v[168:171], a[184:187], v[104:107]
v_mfma_f32_16x16x32_bf16 v[104:107], v[152:155], a[180:183], v[104:107]
s_add_u32 s72, s71, 15360
buffer_load_dwordx4 v15, s[24:27], s72 offen offset:1024 lds
v_mfma_f32_16x16x32_bf16 v[104:107], v[136:139], a[176:179], v[104:107]
s_nop 0
ds_read_b64_tr_b16 v[244:245], v9 offset:45056
ds_read_b64_tr_b16 v[246:247], v9 offset:47104
v_mfma_f32_16x16x32_bf16 v[108:111], v[140:143], a[176:179], v[108:111]
s_nop 0
ds_read_b64_tr_b16 v[248:249], v10 offset:45056
ds_read_b64_tr_b16 v[250:251], v10 offset:47104
v_mfma_f32_16x16x32_bf16 v[108:111], v[156:159], a[180:183], v[108:111]
s_nop 0
ds_read_b64_tr_b16 v[252:253], v11 offset:45056
ds_read_b64_tr_b16 v[254:255], v11 offset:47104
v_mfma_f32_16x16x32_bf16 v[108:111], v[172:175], a[184:187], v[108:111]
v_mfma_f32_16x16x32_bf16 v[108:111], v[188:191], a[188:191], v[108:111]
v_mfma_f32_16x16x32_bf16 v[92:95], v[188:191], a[172:175], v[92:95]
s_add_u32 s72, s71, 30720
buffer_load_dwordx4 v15, s[24:27], s72 offen offset:2048 lds
v_mfma_f32_16x16x32_bf16 v[92:95], v[172:175], a[168:171], v[92:95]
v_mfma_f32_16x16x32_bf16 v[92:95], v[156:159], a[164:167], v[92:95]
s_waitcnt vmcnt(32) lgkmcnt(0)
v_mfma_f32_16x16x32_bf16 v[92:95], v[140:143], a[160:163], v[92:95]
s_barrier
v_mfma_f32_16x16x32_bf16 v[80:83], v[192:195], a[192:195], v[80:83]
s_nop 0
ds_read_b64_tr_b16 v[128:129], v8 offset:49152
ds_read_b64_tr_b16 v[130:131], v8 offset:51200
v_mfma_f32_16x16x32_bf16 v[80:83], v[208:211], a[196:199], v[80:83]
buffer_store_dwordx4 v[60:63], v1, s[44:47], s80 offen offset:3072 sc1
v_mfma_f32_16x16x32_bf16 v[80:83], v[224:227], a[200:203], v[80:83]
s_add_u32 s72, s71, 46080
buffer_load_dwordx4 v15, s[24:27], s72 offen offset:3072 lds
v_mfma_f32_16x16x32_bf16 v[80:83], v[240:243], a[204:207], v[80:83]
s_nop 0
ds_read_b64_tr_b16 v[132:133], v9 offset:49152
ds_read_b64_tr_b16 v[134:135], v9 offset:51200
v_mfma_f32_16x16x32_bf16 v[96:99], v[240:243], a[220:223], v[96:99]
s_nop 0
ds_read_b64_tr_b16 v[136:137], v10 offset:49152
ds_read_b64_tr_b16 v[138:139], v10 offset:51200
v_mfma_f32_16x16x32_bf16 v[96:99], v[224:227], a[216:219], v[96:99]
s_nop 0
ds_read_b64 v[48:49], v116 offset:0
ds_read_b64_tr_b16 v[64:65], v5 offset:0
v_mfma_f32_16x16x32_bf16 v[96:99], v[208:211], a[212:215], v[96:99]
s_nop 0
ds_read_b64_tr_b16 v[140:141], v11 offset:49152
ds_read_b64_tr_b16 v[142:143], v11 offset:51200
v_mfma_f32_16x16x32_bf16 v[96:99], v[192:195], a[208:211], v[96:99]
s_nop 0
ds_read_b64_tr_b16 v[144:145], v8 offset:53248
ds_read_b64_tr_b16 v[146:147], v8 offset:55296
v_mfma_f32_16x16x32_bf16 v[100:103], v[196:199], a[208:211], v[100:103]
s_nop 0
ds_read_b64_tr_b16 v[148:149], v9 offset:53248
ds_read_b64_tr_b16 v[150:151], v9 offset:55296
v_mfma_f32_16x16x32_bf16 v[100:103], v[212:215], a[212:215], v[100:103]
s_nop 0
ds_read_b64 v[50:51], v117 offset:0
ds_read_b64_tr_b16 v[66:67], v5 offset:4096
v_mfma_f32_16x16x32_bf16 v[100:103], v[228:231], a[216:219], v[100:103]
s_xor_b32 s71, s14, 0x40000
ds_read_b64_tr_b16 v[152:153], v10 offset:53248
ds_read_b64_tr_b16 v[154:155], v10 offset:55296
v_mfma_f32_16x16x32_bf16 v[100:103], v[244:247], a[220:223], v[100:103]
s_add_u32 m0, s85, 32768
ds_read_b64_tr_b16 v[156:157], v11 offset:53248
ds_read_b64_tr_b16 v[158:159], v11 offset:55296
v_mfma_f32_16x16x32_bf16 v[84:87], v[244:247], a[204:207], v[84:87]
s_add_u32 s72, s71, 0
buffer_load_dwordx4 v15, s[24:27], s72 offen lds
v_mfma_f32_16x16x32_bf16 v[84:87], v[228:231], a[200:203], v[84:87]
s_nop 0
ds_read_b64 v[52:53], v118 offset:0
ds_read_b64_tr_b16 v[68:69], v5 offset:8192
v_mfma_f32_16x16x32_bf16 v[84:87], v[212:215], a[196:199], v[84:87]
s_nop 0
ds_read_b64_tr_b16 v[160:161], v8 offset:57344
ds_read_b64_tr_b16 v[162:163], v8 offset:59392
v_mfma_f32_16x16x32_bf16 v[84:87], v[196:199], a[192:195], v[84:87]
s_nop 0
ds_read_b64_tr_b16 v[164:165], v9 offset:57344
ds_read_b64_tr_b16 v[166:167], v9 offset:59392
v_mfma_f32_16x16x32_bf16 v[88:91], v[200:203], a[192:195], v[88:91]
s_nop 0
ds_read_b64_tr_b16 v[168:169], v10 offset:57344
ds_read_b64_tr_b16 v[170:171], v10 offset:59392
v_mfma_f32_16x16x32_bf16 v[88:91], v[216:219], a[196:199], v[88:91]
s_add_u32 s72, s71, 15360
buffer_load_dwordx4 v15, s[24:27], s72 offen offset:1024 lds
v_mfma_f32_16x16x32_bf16 v[88:91], v[232:235], a[200:203], v[88:91]
s_nop 0
ds_read_b64 v[54:55], v119 offset:0
ds_read_b64_tr_b16 v[70:71], v5 offset:12288
v_mfma_f32_16x16x32_bf16 v[88:91], v[248:251], a[204:207], v[88:91]
s_nop 0
ds_read_b64_tr_b16 v[172:173], v11 offset:57344
ds_read_b64_tr_b16 v[174:175], v11 offset:59392
v_mfma_f32_16x16x32_bf16 v[104:107], v[248:251], a[220:223], v[104:107]
s_nop 0
ds_read_b64_tr_b16 v[176:177], v8 offset:61440
ds_read_b64_tr_b16 v[178:179], v8 offset:63488
v_mfma_f32_16x16x32_bf16 v[104:107], v[232:235], a[216:219], v[104:107]
s_nop 0
ds_read_b64_tr_b16 v[180:181], v9 offset:61440
ds_read_b64_tr_b16 v[182:183], v9 offset:63488
v_mfma_f32_16x16x32_bf16 v[104:107], v[216:219], a[212:215], v[104:107]
v_xor_b32 v5, 16, v5
v_mfma_f32_16x16x32_bf16 v[104:107], v[200:203], a[208:211], v[104:107]
s_add_u32 s72, s71, 30720
buffer_load_dwordx4 v15, s[24:27], s72 offen offset:2048 lds
v_mfma_f32_16x16x32_bf16 v[108:111], v[204:207], a[208:211], v[108:111]
s_nop 0
ds_read_b64_tr_b16 v[184:185], v10 offset:61440
ds_read_b64_tr_b16 v[186:187], v10 offset:63488
v_mfma_f32_16x16x32_bf16 v[108:111], v[220:223], a[212:215], v[108:111]
s_nop 0
ds_read_b64_tr_b16 v[188:189], v11 offset:61440
ds_read_b64_tr_b16 v[190:191], v11 offset:63488
v_mfma_f32_16x16x32_bf16 v[108:111], v[236:239], a[216:219], v[108:111]
s_nop 0
ds_read_b64 v[56:57], v116 offset:2048
ds_read_b64_tr_b16 v[72:73], v5 offset:0
v_mfma_f32_16x16x32_bf16 v[108:111], v[252:255], a[220:223], v[108:111]
s_nop 0
ds_read_b64 v[58:59], v117 offset:2048
ds_read_b64_tr_b16 v[74:75], v5 offset:4096
v_mfma_f32_16x16x32_bf16 v[92:95], v[252:255], a[204:207], v[92:95]
ds_read_b64 v[60:61], v118 offset:2048
v_xor_b32 v8, 0x10000, v8
v_mfma_f32_16x16x32_bf16 v[92:95], v[236:239], a[200:203], v[92:95]
s_add_u32 s72, s71, 46080
buffer_load_dwordx4 v15, s[24:27], s72 offen offset:3072 lds
v_xor_b32 v9, 0x10000, v9
v_mfma_f32_16x16x32_bf16 v[92:95], v[220:223], a[196:199], v[92:95]
s_waitcnt vmcnt(31) lgkmcnt(0)
ds_read_b64_tr_b16 v[76:77], v5 offset:8192
v_xor_b32 v10, 0x10000, v10
v_mfma_f32_16x16x32_bf16 v[92:95], v[204:207], a[192:195], v[92:95]
s_barrier
ds_read_b64 v[62:63], v119 offset:2048
v_xor_b32 v11, 0x10000, v11
v_mfma_f32_16x16x32_bf16 v[80:83], v[128:131], a[224:227], v[80:83]
s_nop 0
ds_read_b64_tr_b16 v[192:193], v8 offset:0
ds_read_b64_tr_b16 v[194:195], v8 offset:2048
v_mfma_f32_16x16x32_bf16 v[80:83], v[144:147], a[228:231], v[80:83]
s_nop 0
ds_read_b64_tr_b16 v[196:197], v9 offset:0
ds_read_b64_tr_b16 v[198:199], v9 offset:2048
v_mfma_f32_16x16x32_bf16 v[80:83], v[160:163], a[232:235], v[80:83]
s_nop 0
ds_read_b64_tr_b16 v[200:201], v10 offset:0
ds_read_b64_tr_b16 v[202:203], v10 offset:2048
v_mfma_f32_16x16x32_bf16 v[80:83], v[176:179], a[236:239], v[80:83]
ds_read_b64_tr_b16 v[78:79], v5 offset:12288
v_mfma_f32_16x16x32_bf16 v[84:87], v[180:183], a[236:239], v[84:87]
s_nop 0
ds_read_b64_tr_b16 v[204:205], v11 offset:0
ds_read_b64_tr_b16 v[206:207], v11 offset:2048
v_mfma_f32_16x16x32_bf16 v[84:87], v[164:167], a[232:235], v[84:87]
s_xor_b32 s71, s15, 0x40000
ds_read_b64_tr_b16 v[208:209], v8 offset:4096
ds_read_b64_tr_b16 v[210:211], v8 offset:6144
v_mfma_f32_16x16x32_bf16 v[84:87], v[148:151], a[228:231], v[84:87]
s_add_u32 m0, s85, 49152
ds_read_b64_tr_b16 v[212:213], v9 offset:4096
ds_read_b64_tr_b16 v[214:215], v9 offset:6144
v_mfma_f32_16x16x32_bf16 v[84:87], v[132:135], a[224:227], v[84:87]
s_add_u32 s72, s71, 0
buffer_load_dwordx4 v15, s[24:27], s72 offen lds
v_mfma_f32_16x16x32_bf16 v[88:91], v[136:139], a[224:227], v[88:91]
v_mfma_f32_16x16x32_bf16 v[88:91], v[152:155], a[228:231], v[88:91]
s_waitcnt lgkmcnt(6)
ds_read_b64_tr_b16 v[216:217], v10 offset:4096
ds_read_b64_tr_b16 v[218:219], v10 offset:6144
v_mfma_f32_16x16x32_bf16 v[88:91], v[168:171], a[232:235], v[88:91]
s_nop 0
ds_read_b64_tr_b16 v[220:221], v11 offset:4096
ds_read_b64_tr_b16 v[222:223], v11 offset:6144
v_mfma_f32_16x16x32_bf16 v[88:91], v[184:187], a[236:239], v[88:91]
v_cvt_pk_bf16_f32 v80, v80, v81
v_cvt_pk_bf16_f32 v81, v82, v83
v_cvt_pk_bf16_f32 v82, v84, v85
v_mfma_f32_16x16x32_bf16 v[92:95], v[188:191], a[236:239], v[92:95]
s_nop 0
ds_read_b64_tr_b16 v[224:225], v8 offset:8192
ds_read_b64_tr_b16 v[226:227], v8 offset:10240
v_cvt_pk_bf16_f32 v83, v86, v87
v_mfma_f32_16x16x32_bf16 v[92:95], v[172:175], a[232:235], v[92:95]
s_add_u32 s72, s71, 15360
buffer_load_dwordx4 v15, s[24:27], s72 offen offset:1024 lds
v_mfma_f32_16x16x32_bf16 v[92:95], v[156:159], a[228:231], v[92:95]
s_nop 0
ds_read_b64_tr_b16 v[228:229], v9 offset:8192
ds_read_b64_tr_b16 v[230:231], v9 offset:10240
v_mfma_f32_16x16x32_bf16 v[92:95], v[140:143], a[224:227], v[92:95]
s_nop 0
ds_read_b64_tr_b16 v[232:233], v10 offset:8192
ds_read_b64_tr_b16 v[234:235], v10 offset:10240
v_mfma_f32_16x16x32_bf16 v[96:99], v[128:131], a[240:243], v[96:99]
s_xor_b32 s80, s93, 0x180000
v_and_b32 v114, 0xffff0000, v48
v_lshlrev_b32 v115, 16, v64
v_mfma_f32_16x16x32_bf16 v[96:99], v[144:147], a[244:247], v[96:99]
s_add_u32 s80, s80, 0x4200000
buffer_store_dwordx4 v[80:83], v1, s[44:47], s80 offen sc1
v_mfma_f32_16x16x32_bf16 v[96:99], v[160:163], a[248:251], v[96:99]
s_nop 0
ds_read_b64_tr_b16 v[236:237], v11 offset:8192
ds_read_b64_tr_b16 v[238:239], v11 offset:10240
v_mfma_f32_16x16x32_bf16 v[96:99], v[176:179], a[252:255], v[96:99]
s_add_u32 s72, s71, 30720
buffer_load_dwordx4 v15, s[24:27], s72 offen offset:2048 lds
v_cvt_pk_bf16_f32 v84, v88, v89
v_mfma_f32_16x16x32_bf16 v[100:103], v[180:183], a[252:255], v[100:103]
s_nop 0
ds_read_b64_tr_b16 v[240:241], v8 offset:12288
ds_read_b64_tr_b16 v[242:243], v8 offset:14336
v_cvt_pk_bf16_f32 v85, v90, v91
v_mfma_f32_16x16x32_bf16 v[100:103], v[164:167], a[248:251], v[100:103]
s_nop 0
ds_read_b64_tr_b16 v[244:245], v9 offset:12288
ds_read_b64_tr_b16 v[246:247], v9 offset:14336
v_cvt_pk_bf16_f32 v86, v92, v93
v_mfma_f32_16x16x32_bf16 v[100:103], v[148:151], a[244:247], v[100:103]
v_cvt_pk_bf16_f32 v87, v94, v95
v_lshlrev_b32 v48, 16, v48
v_mfma_f32_16x16x32_bf16 v[100:103], v[132:135], a[240:243], v[100:103]
s_nop 0
ds_read_b64_tr_b16 v[248:249], v10 offset:12288
ds_read_b64_tr_b16 v[250:251], v10 offset:14336
v_mfma_f32_16x16x32_bf16 v[104:107], v[136:139], a[240:243], v[104:107]
s_nop 0
ds_read_b64_tr_b16 v[252:253], v11 offset:12288
ds_read_b64_tr_b16 v[254:255], v11 offset:14336
v_mfma_f32_16x16x32_bf16 v[104:107], v[152:155], a[244:247], v[104:107]
s_add_u32 s72, s71, 46080
buffer_load_dwordx4 v15, s[24:27], s72 offen offset:3072 lds
v_mfma_f32_16x16x32_bf16 v[104:107], v[168:171], a[248:251], v[104:107]
v_and_b32 v64, 0xffff0000, v64
v_mul_f32 v48, v48, v112
v_mfma_f32_16x16x32_bf16 v[104:107], v[184:187], a[252:255], v[104:107]
v_cvt_pk_bf16_f32 v88, v96, v97
v_cvt_pk_bf16_f32 v89, v98, v99
v_cvt_pk_bf16_f32 v90, v100, v101
v_mfma_f32_16x16x32_bf16 v[108:111], v[188:191], a[252:255], v[108:111]
v_cvt_pk_bf16_f32 v91, v102, v103
v_mul_f32 v114, v114, v112
v_mfma_f32_16x16x32_bf16 v[108:111], v[172:175], a[248:251], v[108:111]
v_mul_f32 v48, v48, v115
v_mul_f32 v64, v64, v114
v_mfma_f32_16x16x32_bf16 v[108:111], v[156:159], a[244:247], v[108:111]
s_waitcnt vmcnt(30) lgkmcnt(0)
v_and_b32 v114, 0xffff0000, v49
v_lshlrev_b32 v115, 16, v65
v_mfma_f32_16x16x32_bf16 v[108:111], v[140:143], a[240:243], v[108:111]
s_barrier
v_lshlrev_b32 v49, 16, v49
v_and_b32 v65, 0xffff0000, v65
v_mfma_f32_16x16x32_bf16 v[16:19], v[192:195], a[0:3], 0
s_nop 0
ds_read_b64_tr_b16 v[128:129], v8 offset:16384
ds_read_b64_tr_b16 v[130:131], v8 offset:18432
v_mfma_f32_16x16x32_bf16 v[16:19], v[208:211], a[4:7], v[16:19]
buffer_store_dwordx4 v[84:87], v1, s[44:47], s80 offen offset:1024 sc1
v_mfma_f32_16x16x32_bf16 v[16:19], v[224:227], a[8:11], v[16:19]
s_nop 0
ds_read_b64_tr_b16 v[132:133], v9 offset:16384
ds_read_b64_tr_b16 v[134:135], v9 offset:18432
v_mfma_f32_16x16x32_bf16 v[16:19], v[240:243], a[12:15], v[16:19]
v_cvt_pk_bf16_f32 v92, v104, v105
v_cvt_pk_bf16_f32 v93, v106, v107
v_cvt_pk_bf16_f32 v94, v108, v109
v_mfma_f32_16x16x32_bf16 v[32:35], v[240:243], a[28:31], 0
s_nop 0
ds_read_b64_tr_b16 v[136:137], v10 offset:16384
ds_read_b64_tr_b16 v[138:139], v10 offset:18432
v_cvt_pk_bf16_f32 v95, v110, v111
v_mfma_f32_16x16x32_bf16 v[32:35], v[224:227], a[24:27], v[32:35]
s_nop 0
ds_read_b64_tr_b16 v[140:141], v11 offset:16384
ds_read_b64_tr_b16 v[142:143], v11 offset:18432
v_mfma_f32_16x16x32_bf16 v[32:35], v[208:211], a[20:23], v[32:35]
v_mul_f32 v49, v49, v112
v_mul_f32 v114, v114, v112
v_mfma_f32_16x16x32_bf16 v[32:35], v[192:195], a[16:19], v[32:35]
s_nop 0
ds_read_b64_tr_b16 v[144:145], v8 offset:20480
ds_read_b64_tr_b16 v[146:147], v8 offset:22528
v_mfma_f32_16x16x32_bf16 v[36:39], v[196:199], a[16:19], 0
s_nop 0
ds_read_b64_tr_b16 v[148:149], v9 offset:20480
ds_read_b64_tr_b16 v[150:151], v9 offset:22528
v_mfma_f32_16x16x32_bf16 v[36:39], v[212:215], a[20:23], v[36:39]
v_mul_f32 v49, v49, v115
v_mul_f32 v65, v65, v114
v_mfma_f32_16x16x32_bf16 v[36:39], v[228:231], a[24:27], v[36:39]
s_nop 0
ds_read_b64_tr_b16 v[152:153], v10 offset:20480
ds_read_b64_tr_b16 v[154:155], v10 offset:22528
v_mfma_f32_16x16x32_bf16 v[36:39], v[244:247], a[28:31], v[36:39]
s_nop 0
ds_read_b64_tr_b16 v[156:157], v11 offset:20480
ds_read_b64_tr_b16 v[158:159], v11 offset:22528
v_mfma_f32_16x16x32_bf16 v[20:23], v[244:247], a[12:15], 0
v_and_b32 v114, 0xffff0000, v50
v_lshlrev_b32 v115, 16, v66
v_mfma_f32_16x16x32_bf16 v[20:23], v[228:231], a[8:11], v[20:23]
s_nop 0
ds_read_b64_tr_b16 v[160:161], v8 offset:24576
ds_read_b64_tr_b16 v[162:163], v8 offset:26624
v_mfma_f32_16x16x32_bf16 v[20:23], v[212:215], a[4:7], v[20:23]
v_lshlrev_b32 v50, 16, v50
v_and_b32 v66, 0xffff0000, v66
v_mfma_f32_16x16x32_bf16 v[20:23], v[196:199], a[0:3], v[20:23]
s_nop 0
ds_read_b64_tr_b16 v[164:165], v9 offset:24576
ds_read_b64_tr_b16 v[166:167], v9 offset:26624
v_mfma_f32_16x16x32_bf16 v[24:27], v[200:203], a[0:3], 0
s_nop 0
ds_read_b64_tr_b16 v[168:169], v10 offset:24576
ds_read_b64_tr_b16 v[170:171], v10 offset:26624
v_mfma_f32_16x16x32_bf16 v[24:27], v[216:219], a[4:7], v[24:27]
buffer_store_dwordx4 v[88:91], v1, s[44:47], s80 offen offset:2048 sc1
v_mfma_f32_16x16x32_bf16 v[24:27], v[232:235], a[8:11], v[24:27]
v_mul_f32 v50, v50, v112
v_mul_f32 v114, v114, v112
v_mfma_f32_16x16x32_bf16 v[24:27], v[248:251], a[12:15], v[24:27]
s_nop 0
ds_read_b64_tr_b16 v[172:173], v11 offset:24576
ds_read_b64_tr_b16 v[174:175], v11 offset:26624
v_mfma_f32_16x16x32_bf16 v[40:43], v[248:251], a[28:31], 0
s_nop 0
ds_read_b64_tr_b16 v[176:177], v8 offset:28672
ds_read_b64_tr_b16 v[178:179], v8 offset:30720
v_mfma_f32_16x16x32_bf16 v[40:43], v[232:235], a[24:27], v[40:43]
v_mul_f32 v50, v50, v115
v_mul_f32 v66, v66, v114
v_mfma_f32_16x16x32_bf16 v[40:43], v[216:219], a[20:23], v[40:43]
s_nop 0
ds_read_b64_tr_b16 v[180:181], v9 offset:28672
ds_read_b64_tr_b16 v[182:183], v9 offset:30720
v_mfma_f32_16x16x32_bf16 v[40:43], v[200:203], a[16:19], v[40:43]
s_nop 0
ds_read_b64_tr_b16 v[184:185], v10 offset:28672
ds_read_b64_tr_b16 v[186:187], v10 offset:30720
v_mfma_f32_16x16x32_bf16 v[44:47], v[204:207], a[16:19], 0
v_and_b32 v114, 0xffff0000, v51
v_lshlrev_b32 v115, 16, v67
v_mfma_f32_16x16x32_bf16 v[44:47], v[220:223], a[20:23], v[44:47]
s_nop 0
ds_read_b64_tr_b16 v[188:189], v11 offset:28672
ds_read_b64_tr_b16 v[190:191], v11 offset:30720
v_mfma_f32_16x16x32_bf16 v[44:47], v[236:239], a[24:27], v[44:47]
v_lshlrev_b32 v51, 16, v51
v_and_b32 v67, 0xffff0000, v67
v_mfma_f32_16x16x32_bf16 v[44:47], v[252:255], a[28:31], v[44:47]
v_mul_f32 v51, v51, v112
v_mul_f32 v114, v114, v112
v_mfma_f32_16x16x32_bf16 v[28:31], v[252:255], a[12:15], 0
Lstube4:
s_cbranch_execz Lrete
v_mul_f32 v51, v51, v115
v_mul_f32 v67, v67, v114
v_mfma_f32_16x16x32_bf16 v[28:31], v[236:239], a[8:11], v[28:31]
v_and_b32 v114, 0xffff0000, v52
v_lshlrev_b32 v115, 16, v68
v_mfma_f32_16x16x32_bf16 v[28:31], v[220:223], a[4:7], v[28:31]
s_waitcnt vmcnt(27) lgkmcnt(0)
v_lshlrev_b32 v52, 16, v52
v_and_b32 v68, 0xffff0000, v68
v_mfma_f32_16x16x32_bf16 v[28:31], v[204:207], a[0:3], v[28:31]
s_barrier
v_mul_f32 v52, v52, v112
v_mul_f32 v114, v114, v112
v_mfma_f32_16x16x32_bf16 v[16:19], v[128:131], a[32:35], v[16:19]
s_nop 0
ds_read_b64_tr_b16 v[192:193], v8 offset:32768
ds_read_b64_tr_b16 v[194:195], v8 offset:34816
v_mfma_f32_16x16x32_bf16 v[16:19], v[144:147], a[36:39], v[16:19]
buffer_store_dwordx4 v[92:95], v1, s[44:47], s80 offen offset:3072 sc1
v_mfma_f32_16x16x32_bf16 v[16:19], v[160:163], a[40:43], v[16:19]
s_nop 0
ds_read_b64_tr_b16 v[196:197], v9 offset:32768
ds_read_b64_tr_b16 v[198:199], v9 offset:34816
v_mfma_f32_16x16x32_bf16 v[16:19], v[176:179], a[44:47], v[16:19]
v_mul_f32 v52, v52, v115
v_mul_f32 v68, v68, v114
v_mfma_f32_16x16x32_bf16 v[32:35], v[176:179], a[60:63], v[32:35]
s_nop 0
ds_read_b64_tr_b16 v[200:201], v10 offset:32768
ds_read_b64_tr_b16 v[202:203], v10 offset:34816
v_mfma_f32_16x16x32_bf16 v[32:35], v[160:163], a[56:59], v[32:35]
s_nop 0
ds_read_b64_tr_b16 v[204:205], v11 offset:32768
ds_read_b64_tr_b16 v[206:207], v11 offset:34816
v_mfma_f32_16x16x32_bf16 v[32:35], v[144:147], a[52:55], v[32:35]
v_and_b32 v114, 0xffff0000, v53
v_lshlrev_b32 v115, 16, v69
v_mfma_f32_16x16x32_bf16 v[32:35], v[128:131], a[48:51], v[32:35]
s_nop 0
ds_read_b64_tr_b16 v[208:209], v8 offset:36864
ds_read_b64_tr_b16 v[210:211], v8 offset:38912
v_mfma_f32_16x16x32_bf16 v[36:39], v[132:135], a[48:51], v[36:39]
v_lshlrev_b32 v53, 16, v53
v_and_b32 v69, 0xffff0000, v69
v_mfma_f32_16x16x32_bf16 v[36:39], v[148:151], a[52:55], v[36:39]
s_nop 0
ds_read_b64_tr_b16 v[212:213], v9 offset:36864
ds_read_b64_tr_b16 v[214:215], v9 offset:38912
v_mfma_f32_16x16x32_bf16 v[36:39], v[164:167], a[56:59], v[36:39]
s_nop 0
ds_read_b64_tr_b16 v[216:217], v10 offset:36864
ds_read_b64_tr_b16 v[218:219], v10 offset:38912
v_mfma_f32_16x16x32_bf16 v[36:39], v[180:183], a[60:63], v[36:39]
v_mul_f32 v53, v53, v112
v_mul_f32 v114, v114, v112
v_mfma_f32_16x16x32_bf16 v[20:23], v[180:183], a[44:47], v[20:23]
s_nop 0
ds_read_b64_tr_b16 v[220:221], v11 offset:36864
ds_read_b64_tr_b16 v[222:223], v11 offset:38912
v_mfma_f32_16x16x32_bf16 v[20:23], v[164:167], a[40:43], v[20:23]
v_mul_f32 v53, v53, v115
v_mul_f32 v69, v69, v114
v_mfma_f32_16x16x32_bf16 v[20:23], v[148:151], a[36:39], v[20:23]
s_nop 0
ds_read_b64_tr_b16 v[224:225], v8 offset:40960
ds_read_b64_tr_b16 v[226:227], v8 offset:43008
v_mfma_f32_16x16x32_bf16 v[20:23], v[132:135], a[32:35], v[20:23]
s_nop 0
ds_read_b64_tr_b16 v[228:229], v9 offset:40960
ds_read_b64_tr_b16 v[230:231], v9 offset:43008
v_mfma_f32_16x16x32_bf16 v[24:27], v[136:139], a[32:35], v[24:27]
v_and_b32 v114, 0xffff0000, v54
v_lshlrev_b32 v115, 16, v70
v_mfma_f32_16x16x32_bf16 v[24:27], v[152:155], a[36:39], v[24:27]
s_nop 0
ds_read_b64_tr_b16 v[232:233], v10 offset:40960
ds_read_b64_tr_b16 v[234:235], v10 offset:43008
v_mfma_f32_16x16x32_bf16 v[24:27], v[168:171], a[40:43], v[24:27]
s_nop 0
ds_read_b64_tr_b16 v[236:237], v11 offset:40960
ds_read_b64_tr_b16 v[238:239], v11 offset:43008
v_mfma_f32_16x16x32_bf16 v[24:27], v[184:187], a[44:47], v[24:27]
v_lshlrev_b32 v54, 16, v54
v_and_b32 v70, 0xffff0000, v70
v_mfma_f32_16x16x32_bf16 v[40:43], v[184:187], a[60:63], v[40:43]
s_nop 0
ds_read_b64_tr_b16 v[240:241], v8 offset:45056
ds_read_b64_tr_b16 v[242:243], v8 offset:47104
v_mfma_f32_16x16x32_bf16 v[40:43], v[168:171], a[56:59], v[40:43]
v_mul_f32 v54, v54, v112
v_mul_f32 v114, v114, v112
v_mfma_f32_16x16x32_bf16 v[40:43], v[152:155], a[52:55], v[40:43]
s_nop 0
ds_read_b64_tr_b16 v[244:245], v9 offset:45056
ds_read_b64_tr_b16 v[246:247], v9 offset:47104
v_mfma_f32_16x16x32_bf16 v[40:43], v[136:139], a[48:51], v[40:43]
s_nop 0
ds_read_b64_tr_b16 v[248:249], v10 offset:45056
ds_read_b64_tr_b16 v[250:251], v10 offset:47104
v_mfma_f32_16x16x32_bf16 v[44:47], v[140:143], a[48:51], v[44:47]
v_mul_f32 v54, v54, v115
v_mul_f32 v70, v70, v114
v_mfma_f32_16x16x32_bf16 v[44:47], v[156:159], a[52:55], v[44:47]
s_nop 0
ds_read_b64_tr_b16 v[252:253], v11 offset:45056
ds_read_b64_tr_b16 v[254:255], v11 offset:47104
v_mfma_f32_16x16x32_bf16 v[44:47], v[172:175], a[56:59], v[44:47]
v_and_b32 v114, 0xffff0000, v55
v_lshlrev_b32 v115, 16, v71
v_mfma_f32_16x16x32_bf16 v[44:47], v[188:191], a[60:63], v[44:47]
v_lshlrev_b32 v55, 16, v55
v_and_b32 v71, 0xffff0000, v71
v_mfma_f32_16x16x32_bf16 v[28:31], v[188:191], a[44:47], v[28:31]
v_mul_f32 v55, v55, v112
v_mul_f32 v114, v114, v112
v_mfma_f32_16x16x32_bf16 v[28:31], v[172:175], a[40:43], v[28:31]
s_add_u32 s79, s93, 0x3a00000
v_mul_f32 v55, v55, v115
v_mul_f32 v71, v71, v114
v_mfma_f32_16x16x32_bf16 v[28:31], v[156:159], a[36:39], v[28:31]
s_waitcnt vmcnt(24) lgkmcnt(0)
buffer_load_dwordx4 v[96:99], v1, s[44:47], s79 offen sc1
v_mfma_f32_16x16x32_bf16 v[28:31], v[140:143], a[32:35], v[28:31]
s_barrier
v_and_b32 v114, 0xffff0000, v56
v_lshlrev_b32 v115, 16, v72
v_mfma_f32_16x16x32_bf16 v[16:19], v[192:195], a[64:67], v[16:19]
s_nop 0
ds_read_b64_tr_b16 v[128:129], v8 offset:49152
ds_read_b64_tr_b16 v[130:131], v8 offset:51200
v_mfma_f32_16x16x32_bf16 v[16:19], v[208:211], a[68:71], v[16:19]
s_nop 0
ds_read_b64_tr_b16 v[132:133], v9 offset:49152
ds_read_b64_tr_b16 v[134:135], v9 offset:51200
v_mfma_f32_16x16x32_bf16 v[16:19], v[224:227], a[72:75], v[16:19]
v_lshlrev_b32 v56, 16, v56
v_and_b32 v72, 0xffff0000, v72
v_mfma_f32_16x16x32_bf16 v[16:19], v[240:243], a[76:79], v[16:19]
buffer_load_dwordx4 v[100:103], v1, s[44:47], s79 offen offset:1024 sc1
v_mfma_f32_16x16x32_bf16 v[32:35], v[240:243], a[92:95], v[32:35]
s_nop 0
ds_read_b64_tr_b16 v[136:137], v10 offset:49152
ds_read_b64_tr_b16 v[138:139], v10 offset:51200
v_mfma_f32_16x16x32_bf16 v[32:35], v[224:227], a[88:91], v[32:35]
s_nop 0
ds_read_b64_tr_b16 v[140:141], v11 offset:49152
ds_read_b64_tr_b16 v[142:143], v11 offset:51200
v_mfma_f32_16x16x32_bf16 v[32:35], v[208:211], a[84:87], v[32:35]
v_mul_f32 v56, v56, v113
v_mul_f32 v114, v114, v113
v_mfma_f32_16x16x32_bf16 v[32:35], v[192:195], a[80:83], v[32:35]
s_nop 0
ds_read_b64_tr_b16 v[144:145], v8 offset:53248
ds_read_b64_tr_b16 v[146:147], v8 offset:55296
v_mfma_f32_16x16x32_bf16 v[36:39], v[196:199], a[80:83], v[36:39]
buffer_load_dwordx4 v[104:107], v1, s[44:47], s79 offen offset:2048 sc1
v_mfma_f32_16x16x32_bf16 v[36:39], v[212:215], a[84:87], v[36:39]
s_nop 0
ds_read_b64_tr_b16 v[148:149], v9 offset:53248
ds_read_b64_tr_b16 v[150:151], v9 offset:55296
v_mfma_f32_16x16x32_bf16 v[36:39], v[228:231], a[88:91], v[36:39]
v_mul_f32 v56, v56, v115
v_mul_f32 v72, v72, v114
v_mfma_f32_16x16x32_bf16 v[36:39], v[244:247], a[92:95], v[36:39]
s_nop 0
ds_read_b64_tr_b16 v[152:153], v10 offset:53248
ds_read_b64_tr_b16 v[154:155], v10 offset:55296
v_mfma_f32_16x16x32_bf16 v[20:23], v[244:247], a[76:79], v[20:23]
s_nop 0
ds_read_b64_tr_b16 v[156:157], v11 offset:53248
ds_read_b64_tr_b16 v[158:159], v11 offset:55296
v_mfma_f32_16x16x32_bf16 v[20:23], v[228:231], a[72:75], v[20:23]
buffer_load_dwordx4 v[108:111], v1, s[44:47], s79 offen offset:3072 sc1
v_mfma_f32_16x16x32_bf16 v[20:23], v[212:215], a[68:71], v[20:23]
v_and_b32 v114, 0xffff0000, v57
v_lshlrev_b32 v115, 16, v73
v_mfma_f32_16x16x32_bf16 v[20:23], v[196:199], a[64:67], v[20:23]
s_nop 0
ds_read_b64_tr_b16 v[160:161], v8 offset:57344
ds_read_b64_tr_b16 v[162:163], v8 offset:59392
v_mfma_f32_16x16x32_bf16 v[24:27], v[200:203], a[64:67], v[24:27]
s_nop 0
ds_read_b64_tr_b16 v[164:165], v9 offset:57344
ds_read_b64_tr_b16 v[166:167], v9 offset:59392
v_mfma_f32_16x16x32_bf16 v[24:27], v[216:219], a[68:71], v[24:27]
v_lshlrev_b32 v57, 16, v57
v_and_b32 v73, 0xffff0000, v73
v_mfma_f32_16x16x32_bf16 v[24:27], v[232:235], a[72:75], v[24:27]
s_nop 0
ds_read_b64_tr_b16 v[168:169], v10 offset:57344
ds_read_b64_tr_b16 v[170:171], v10 offset:59392
v_mfma_f32_16x16x32_bf16 v[24:27], v[248:251], a[76:79], v[24:27]
s_nop 0
ds_read_b64_tr_b16 v[172:173], v11 offset:57344
ds_read_b64_tr_b16 v[174:175], v11 offset:59392
v_mfma_f32_16x16x32_bf16 v[40:43], v[248:251], a[92:95], v[40:43]
v_mul_f32 v57, v57, v113
v_mul_f32 v114, v114, v113
v_mfma_f32_16x16x32_bf16 v[40:43], v[232:235], a[88:91], v[40:43]
s_nop 0
ds_read_b64_tr_b16 v[176:177], v8 offset:61440
ds_read_b64_tr_b16 v[178:179], v8 offset:63488
v_mfma_f32_16x16x32_bf16 v[40:43], v[216:219], a[84:87], v[40:43]
s_nop 0
ds_read_b64_tr_b16 v[180:181], v9 offset:61440
ds_read_b64_tr_b16 v[182:183], v9 offset:63488
v_mfma_f32_16x16x32_bf16 v[40:43], v[200:203], a[80:83], v[40:43]
v_mul_f32 v57, v57, v115
v_mul_f32 v73, v73, v114
v_mfma_f32_16x16x32_bf16 v[44:47], v[204:207], a[80:83], v[44:47]
s_nop 0
ds_read_b64_tr_b16 v[184:185], v10 offset:61440
ds_read_b64_tr_b16 v[186:187], v10 offset:63488
v_mfma_f32_16x16x32_bf16 v[44:47], v[220:223], a[84:87], v[44:47]
s_nop 0
ds_read_b64_tr_b16 v[188:189], v11 offset:61440
ds_read_b64_tr_b16 v[190:191], v11 offset:63488
v_mfma_f32_16x16x32_bf16 v[44:47], v[236:239], a[88:91], v[44:47]
v_and_b32 v114, 0xffff0000, v58
v_lshlrev_b32 v115, 16, v74
v_mfma_f32_16x16x32_bf16 v[44:47], v[252:255], a[92:95], v[44:47]
v_lshlrev_b32 v58, 16, v58
v_and_b32 v74, 0xffff0000, v74
v_mfma_f32_16x16x32_bf16 v[28:31], v[252:255], a[76:79], v[28:31]
v_xor_b32 v8, 0x10000, v8
v_mul_f32 v58, v58, v113
v_mfma_f32_16x16x32_bf16 v[28:31], v[236:239], a[72:75], v[28:31]
v_xor_b32 v9, 0x10000, v9
v_mul_f32 v114, v114, v113
v_mfma_f32_16x16x32_bf16 v[28:31], v[220:223], a[68:71], v[28:31]
s_waitcnt vmcnt(22) lgkmcnt(0)
v_xor_b32 v10, 0x10000, v10
v_mul_f32 v58, v58, v115
v_mfma_f32_16x16x32_bf16 v[28:31], v[204:207], a[64:67], v[28:31]
s_barrier
v_xor_b32 v11, 0x10000, v11
v_mul_f32 v74, v74, v114
v_mfma_f32_16x16x32_bf16 v[16:19], v[128:131], a[96:99], v[16:19]
s_nop 0
ds_read_b64_tr_b16 v[192:193], v8 offset:0
ds_read_b64_tr_b16 v[194:195], v8 offset:2048
v_mfma_f32_16x16x32_bf16 v[16:19], v[144:147], a[100:103], v[16:19]
s_nop 0
ds_read_b64_tr_b16 v[196:197], v9 offset:0
ds_read_b64_tr_b16 v[198:199], v9 offset:2048
v_mfma_f32_16x16x32_bf16 v[16:19], v[160:163], a[104:107], v[16:19]
v_and_b32 v114, 0xffff0000, v59
v_lshlrev_b32 v115, 16, v75
v_mfma_f32_16x16x32_bf16 v[16:19], v[176:179], a[108:111], v[16:19]
s_nop 0
ds_read_b64_tr_b16 v[200:201], v10 offset:0
ds_read_b64_tr_b16 v[202:203], v10 offset:2048
v_mfma_f32_16x16x32_bf16 v[32:35], v[176:179], a[124:127], v[32:35]
v_lshlrev_b32 v59, 16, v59
v_and_b32 v75, 0xffff0000, v75
v_mfma_f32_16x16x32_bf16 v[32:35], v[160:163], a[120:123], v[32:35]
s_nop 0
ds_read_b64_tr_b16 v[204:205], v11 offset:0
ds_read_b64_tr_b16 v[206:207], v11 offset:2048
v_mfma_f32_16x16x32_bf16 v[32:35], v[144:147], a[116:119], v[32:35]
s_nop 0
ds_read_b64_tr_b16 v[208:209], v8 offset:4096
ds_read_b64_tr_b16 v[210:211], v8 offset:6144
v_mfma_f32_16x16x32_bf16 v[32:35], v[128:131], a[112:115], v[32:35]
v_mul_f32 v59, v59, v113
v_mul_f32 v114, v114, v113
v_mfma_f32_16x16x32_bf16 v[36:39], v[132:135], a[112:115], v[36:39]
s_nop 0
ds_read_b64_tr_b16 v[212:213], v9 offset:4096
ds_read_b64_tr_b16 v[214:215], v9 offset:6144
v_mfma_f32_16x16x32_bf16 v[36:39], v[148:151], a[116:119], v[36:39]
v_mul_f32 v59, v59, v115
v_mul_f32 v75, v75, v114
v_mfma_f32_16x16x32_bf16 v[36:39], v[164:167], a[120:123], v[36:39]
s_nop 0
ds_read_b64_tr_b16 v[216:217], v10 offset:4096
ds_read_b64_tr_b16 v[218:219], v10 offset:6144
v_mfma_f32_16x16x32_bf16 v[36:39], v[180:183], a[124:127], v[36:39]
s_nop 0
ds_read_b64_tr_b16 v[220:221], v11 offset:4096
ds_read_b64_tr_b16 v[222:223], v11 offset:6144
v_mfma_f32_16x16x32_bf16 v[20:23], v[180:183], a[108:111], v[20:23]
v_and_b32 v114, 0xffff0000, v60
v_lshlrev_b32 v115, 16, v76
v_mfma_f32_16x16x32_bf16 v[20:23], v[164:167], a[104:107], v[20:23]
s_nop 0
ds_read_b64_tr_b16 v[224:225], v8 offset:8192
ds_read_b64_tr_b16 v[226:227], v8 offset:10240
v_mfma_f32_16x16x32_bf16 v[20:23], v[148:151], a[100:103], v[20:23]
v_lshlrev_b32 v60, 16, v60
v_and_b32 v76, 0xffff0000, v76
v_mfma_f32_16x16x32_bf16 v[20:23], v[132:135], a[96:99], v[20:23]
s_nop 0
ds_read_b64_tr_b16 v[228:229], v9 offset:8192
ds_read_b64_tr_b16 v[230:231], v9 offset:10240
v_mfma_f32_16x16x32_bf16 v[24:27], v[136:139], a[96:99], v[24:27]
s_nop 0
ds_read_b64_tr_b16 v[232:233], v10 offset:8192
ds_read_b64_tr_b16 v[234:235], v10 offset:10240
v_mfma_f32_16x16x32_bf16 v[24:27], v[152:155], a[100:103], v[24:27]
v_mul_f32 v60, v60, v113
v_mul_f32 v114, v114, v113
v_mfma_f32_16x16x32_bf16 v[24:27], v[168:171], a[104:107], v[24:27]
s_nop 0
ds_read_b64_tr_b16 v[236:237], v11 offset:8192
ds_read_b64_tr_b16 v[238:239], v11 offset:10240
v_mfma_f32_16x16x32_bf16 v[24:27], v[184:187], a[108:111], v[24:27]
v_mul_f32 v60, v60, v115
v_mul_f32 v76, v76, v114
v_mfma_f32_16x16x32_bf16 v[40:43], v[184:187], a[124:127], v[40:43]
s_nop 0
ds_read_b64_tr_b16 v[240:241], v8 offset:12288
ds_read_b64_tr_b16 v[242:243], v8 offset:14336
v_mfma_f32_16x16x32_bf16 v[40:43], v[168:171], a[120:123], v[40:43]
s_nop 0
ds_read_b64_tr_b16 v[244:245], v9 offset:12288
ds_read_b64_tr_b16 v[246:247], v9 offset:14336
v_mfma_f32_16x16x32_bf16 v[40:43], v[152:155], a[116:119], v[40:43]
v_and_b32 v114, 0xffff0000, v61
v_lshlrev_b32 v115, 16, v77
v_mfma_f32_16x16x32_bf16 v[40:43], v[136:139], a[112:115], v[40:43]
s_nop 0
ds_read_b64_tr_b16 v[248:249], v10 offset:12288
ds_read_b64_tr_b16 v[250:251], v10 offset:14336
v_mfma_f32_16x16x32_bf16 v[44:47], v[140:143], a[112:115], v[44:47]
v_lshlrev_b32 v61, 16, v61
v_and_b32 v77, 0xffff0000, v77
v_mfma_f32_16x16x32_bf16 v[44:47], v[156:159], a[116:119], v[44:47]
s_nop 0
ds_read_b64_tr_b16 v[252:253], v11 offset:12288
ds_read_b64_tr_b16 v[254:255], v11 offset:14336
v_mfma_f32_16x16x32_bf16 v[44:47], v[172:175], a[120:123], v[44:47]
v_mul_f32 v61, v61, v113
v_mul_f32 v114, v114, v113
v_mfma_f32_16x16x32_bf16 v[44:47], v[188:191], a[124:127], v[44:47]
s_waitcnt vmcnt(0)
v_max3_u32 v12, v96, v97, v98
v_max3_u32 v13, v99, v100, v101
v_mfma_f32_16x16x32_bf16 v[28:31], v[188:191], a[108:111], v[28:31]
v_max3_u32 v12, v12, v102, v103
v_max3_u32 v13, v13, v104, v105
v_mfma_f32_16x16x32_bf16 v[28:31], v[172:175], a[104:107], v[28:31]
v_max3_u32 v12, v12, v106, v107
v_max3_u32 v13, v13, v108, v109
v_mfma_f32_16x16x32_bf16 v[28:31], v[156:159], a[100:103], v[28:31]
s_waitcnt vmcnt(16) lgkmcnt(0)
v_max3_u32 v12, v12, v110, v111
v_mul_f32 v61, v61, v115
v_mfma_f32_16x16x32_bf16 v[28:31], v[140:143], a[96:99], v[28:31]
s_barrier
v_max_u32 v12, v12, v13
v_mul_f32 v77, v77, v114
v_mfma_f32_16x16x32_bf16 v[16:19], v[192:195], a[128:131], v[16:19]
v_cmp_le_u32 vcc, 0xff800000, v12
v_and_b32 v114, 0xffff0000, v62
v_mfma_f32_16x16x32_bf16 v[16:19], v[208:211], a[132:135], v[16:19]
s_nop 0
ds_read_b64_tr_b16 v[128:129], v8 offset:16384
ds_read_b64_tr_b16 v[130:131], v8 offset:18432
v_mfma_f32_16x16x32_bf16 v[16:19], v[224:227], a[136:139], v[16:19]
s_cbranch_vccnz Lxspin1
Lxback1:
ds_read_b64_tr_b16 v[132:133], v9 offset:16384
ds_read_b64_tr_b16 v[134:135], v9 offset:18432
v_mfma_f32_16x16x32_bf16 v[16:19], v[240:243], a[140:143], v[16:19]
v_lshlrev_b32 v115, 16, v78
v_lshlrev_b32 v62, 16, v62
v_mfma_f32_16x16x32_bf16 v[16:19], v[124:127], v[96:99], v[16:19]
s_nop 0
ds_read_b64_tr_b16 v[136:137], v10 offset:16384
ds_read_b64_tr_b16 v[138:139], v10 offset:18432
v_mfma_f32_16x16x32_bf16 v[32:35], v[240:243], a[156:159], v[32:35]
v_and_b32 v78, 0xffff0000, v78
v_mul_f32 v62, v62, v113
v_mfma_f32_16x16x32_bf16 v[32:35], v[224:227], a[152:155], v[32:35]
s_add_u32 s82, s93, 0x3e00000
buffer_load_dwordx4 v[80:83], v1, s[44:47], s82 offen sc1
v_mfma_f32_16x16x32_bf16 v[32:35], v[208:211], a[148:151], v[32:35]
s_nop 0
ds_read_b64_tr_b16 v[140:141], v11 offset:16384
ds_read_b64_tr_b16 v[142:143], v11 offset:18432
v_mfma_f32_16x16x32_bf16 v[32:35], v[192:195], a[144:147], v[32:35]
v_mul_f32 v114, v114, v113
v_mul_f32 v62, v62, v115
v_mfma_f32_16x16x32_bf16 v[32:35], v[124:127], v[104:107], v[32:35]
s_nop 0
ds_read_b64_tr_b16 v[144:145], v8 offset:20480
ds_read_b64_tr_b16 v[146:147], v8 offset:22528
v_mfma_f32_16x16x32_bf16 v[36:39], v[196:199], a[144:147], v[36:39]
v_mul_f32 v78, v78, v114
v_and_b32 v114, 0xffff0000, v63
v_mfma_f32_16x16x32_bf16 v[36:39], v[212:215], a[148:151], v[36:39]
buffer_load_dwordx4 v[84:87], v1, s[44:47], s82 offen offset:1024 sc1
v_mfma_f32_16x16x32_bf16 v[36:39], v[228:231], a[152:155], v[36:39]
s_nop 0
ds_read_b64_tr_b16 v[148:149], v9 offset:20480
ds_read_b64_tr_b16 v[150:151], v9 offset:22528
v_mfma_f32_16x16x32_bf16 v[36:39], v[244:247], a[156:159], v[36:39]
v_lshlrev_b32 v115, 16, v79
v_lshlrev_b32 v63, 16, v63
v_mfma_f32_16x16x32_bf16 v[36:39], v[120:123], v[104:107], v[36:39]
s_nop 0
ds_read_b64_tr_b16 v[152:153], v10 offset:20480
ds_read_b64_tr_b16 v[154:155], v10 offset:22528
v_mfma_f32_16x16x32_bf16 v[20:23], v[244:247], a[140:143], v[20:23]
v_and_b32 v79, 0xffff0000, v79
v_mul_f32 v63, v63, v113
v_mfma_f32_16x16x32_bf16 v[20:23], v[228:231], a[136:139], v[20:23]
buffer_load_dwordx4 v[88:91], v1, s[44:47], s82 offen offset:2048 sc1
v_mfma_f32_16x16x32_bf16 v[20:23], v[212:215], a[132:135], v[20:23]
s_nop 0
ds_read_b64_tr_b16 v[156:157], v11 offset:20480
ds_read_b64_tr_b16 v[158:159], v11 offset:22528
v_mfma_f32_16x16x32_bf16 v[20:23], v[196:199], a[128:131], v[20:23]
v_mul_f32 v114, v114, v113
v_mul_f32 v63, v63, v115
v_mfma_f32_16x16x32_bf16 v[20:23], v[120:123], v[96:99], v[20:23]
s_nop 0
ds_read_b64_tr_b16 v[160:161], v8 offset:24576
ds_read_b64_tr_b16 v[162:163], v8 offset:26624
v_mfma_f32_16x16x32_bf16 v[24:27], v[200:203], a[128:131], v[24:27]
s_nop 0
ds_read_b64_tr_b16 v[164:165], v9 offset:24576
ds_read_b64_tr_b16 v[166:167], v9 offset:26624
v_mfma_f32_16x16x32_bf16 v[24:27], v[216:219], a[132:135], v[24:27]
buffer_load_dwordx4 v[92:95], v1, s[44:47], s82 offen offset:3072 sc1
v_mfma_f32_16x16x32_bf16 v[24:27], v[232:235], a[136:139], v[24:27]
v_mul_f32 v79, v79, v114
v_mfma_f32_16x16x32_bf16 v[24:27], v[248:251], a[140:143], v[24:27]
s_nop 0
ds_read_b64_tr_b16 v[168:169], v10 offset:24576
ds_read_b64_tr_b16 v[170:171], v10 offset:26624
v_mfma_f32_16x16x32_bf16 v[24:27], v[124:127], v[100:103], v[24:27]
v_mfma_f32_16x16x32_bf16 v[40:43], v[248:251], a[156:159], v[40:43]
s_nop 0
ds_read_b64_tr_b16 v[172:173], v11 offset:24576
ds_read_b64_tr_b16 v[174:175], v11 offset:26624
v_mfma_f32_16x16x32_bf16 v[40:43], v[232:235], a[152:155], v[40:43]
v_mfma_f32_16x16x32_bf16 v[40:43], v[216:219], a[148:151], v[40:43]
s_nop 0
ds_read_b64_tr_b16 v[176:177], v8 offset:28672
ds_read_b64_tr_b16 v[178:179], v8 offset:30720
v_mfma_f32_16x16x32_bf16 v[40:43], v[200:203], a[144:147], v[40:43]
v_mfma_f32_16x16x32_bf16 v[40:43], v[124:127], v[108:111], v[40:43]
s_nop 0
ds_read_b64_tr_b16 v[180:181], v9 offset:28672
ds_read_b64_tr_b16 v[182:183], v9 offset:30720
v_mfma_f32_16x16x32_bf16 v[44:47], v[204:207], a[144:147], v[44:47]
v_mfma_f32_16x16x32_bf16 v[44:47], v[220:223], a[148:151], v[44:47]
s_nop 0
ds_read_b64_tr_b16 v[184:185], v10 offset:28672
ds_read_b64_tr_b16 v[186:187], v10 offset:30720
v_mfma_f32_16x16x32_bf16 v[44:47], v[236:239], a[152:155], v[44:47]
v_mfma_f32_16x16x32_bf16 v[44:47], v[252:255], a[156:159], v[44:47]
s_nop 0
ds_read_b64_tr_b16 v[188:189], v11 offset:28672
ds_read_b64_tr_b16 v[190:191], v11 offset:30720
v_mfma_f32_16x16x32_bf16 v[44:47], v[120:123], v[108:111], v[44:47]
v_mfma_f32_16x16x32_bf16 v[28:31], v[252:255], a[140:143], v[28:31]
v_mfma_f32_16x16x32_bf16 v[28:31], v[236:239], a[136:139], v[28:31]
v_mfma_f32_16x16x32_bf16 v[28:31], v[220:223], a[132:135], v[28:31]
v_mfma_f32_16x16x32_bf16 v[28:31], v[204:207], a[128:131], v[28:31]
s_waitcnt vmcnt(16) lgkmcnt(0)
v_mfma_f32_16x16x32_bf16 v[28:31], v[120:123], v[100:103], v[28:31]
s_barrier
v_mfma_f32_16x16x32_bf16 v[16:19], v[128:131], a[160:163], v[16:19]
s_nop 0
ds_read_b64_tr_b16 v[192:193], v8 offset:32768
ds_read_b64_tr_b16 v[194:195], v8 offset:34816
v_mfma_f32_16x16x32_bf16 v[16:19], v[144:147], a[164:167], v[16:19]
s_nop 0
ds_read_b64_tr_b16 v[196:197], v9 offset:32768
ds_read_b64_tr_b16 v[198:199], v9 offset:34816
v_mfma_f32_16x16x32_bf16 v[16:19], v[160:163], a[168:171], v[16:19]
s_nop 0
ds_read_b64_tr_b16 v[200:201], v10 offset:32768
ds_read_b64_tr_b16 v[202:203], v10 offset:34816
v_mfma_f32_16x16x32_bf16 v[16:19], v[176:179], a[172:175], v[16:19]
v_mfma_f32_16x16x32_bf16 v[32:35], v[176:179], a[188:191], v[32:35]
s_nop 0
ds_read_b64_tr_b16 v[204:205], v11 offset:32768
ds_read_b64_tr_b16 v[206:207], v11 offset:34816
v_mfma_f32_16x16x32_bf16 v[32:35], v[160:163], a[184:187], v[32:35]
s_nop 0
ds_read_b64_tr_b16 v[208:209], v8 offset:36864
ds_read_b64_tr_b16 v[210:211], v8 offset:38912
v_mfma_f32_16x16x32_bf16 v[32:35], v[144:147], a[180:183], v[32:35]
s_add_u32 s81, s93, 0x4200000
buffer_load_dwordx4 v[96:99], v1, s[44:47], s81 offen sc1
v_mfma_f32_16x16x32_bf16 v[32:35], v[128:131], a[176:179], v[32:35]
v_mfma_f32_16x16x32_bf16 v[36:39], v[132:135], a[176:179], v[36:39]
s_nop 0
ds_read_b64_tr_b16 v[212:213], v9 offset:36864
ds_read_b64_tr_b16 v[214:215], v9 offset:38912
v_mfma_f32_16x16x32_bf16 v[36:39], v[148:151], a[180:183], v[36:39]
s_nop 0
ds_read_b64_tr_b16 v[216:217], v10 offset:36864
ds_read_b64_tr_b16 v[218:219], v10 offset:38912
v_mfma_f32_16x16x32_bf16 v[36:39], v[164:167], a[184:187], v[36:39]
v_mfma_f32_16x16x32_bf16 v[36:39], v[180:183], a[188:191], v[36:39]
buffer_load_dwordx4 v[100:103], v1, s[44:47], s81 offen offset:1024 sc1
v_mfma_f32_16x16x32_bf16 v[20:23], v[180:183], a[172:175], v[20:23]
s_nop 0
ds_read_b64_tr_b16 v[220:221], v11 offset:36864
ds_read_b64_tr_b16 v[222:223], v11 offset:38912
v_mfma_f32_16x16x32_bf16 v[20:23], v[164:167], a[168:171], v[20:23]
s_nop 0
ds_read_b64_tr_b16 v[224:225], v8 offset:40960
ds_read_b64_tr_b16 v[226:227], v8 offset:43008
v_mfma_f32_16x16x32_bf16 v[20:23], v[148:151], a[164:167], v[20:23]
s_nop 0
ds_read_b64_tr_b16 v[228:229], v9 offset:40960
ds_read_b64_tr_b16 v[230:231], v9 offset:43008
v_mfma_f32_16x16x32_bf16 v[20:23], v[132:135], a[160:163], v[20:23]
v_mfma_f32_16x16x32_bf16 v[24:27], v[136:139], a[160:163], v[24:27]
buffer_load_dwordx4 v[104:107], v1, s[44:47], s81 offen offset:2048 sc1
v_mfma_f32_16x16x32_bf16 v[24:27], v[152:155], a[164:167], v[24:27]
s_nop 0
ds_read_b64_tr_b16 v[232:233], v10 offset:40960
ds_read_b64_tr_b16 v[234:235], v10 offset:43008
v_mfma_f32_16x16x32_bf16 v[24:27], v[168:171], a[168:171], v[24:27]
s_nop 0
ds_read_b64_tr_b16 v[236:237], v11 offset:40960
ds_read_b64_tr_b16 v[238:239], v11 offset:43008
v_mfma_f32_16x16x32_bf16 v[24:27], v[184:187], a[172:175], v[24:27]
v_mfma_f32_16x16x32_bf16 v[40:43], v[184:187], a[188:191], v[40:43]
s_nop 0
ds_read_b64_tr_b16 v[240:241], v8 offset:45056
ds_read_b64_tr_b16 v[242:243], v8 offset:47104
v_mfma_f32_16x16x32_bf16 v[40:43], v[168:171], a[184:187], v[40:43]
buffer_load_dwordx4 v[108:111], v1, s[44:47], s81 offen offset:3072 sc1
v_mfma_f32_16x16x32_bf16 v[40:43], v[152:155], a[180:183], v[40:43]
s_nop 0
ds_read_b64_tr_b16 v[244:245], v9 offset:45056
ds_read_b64_tr_b16 v[246:247], v9 offset:47104
v_mfma_f32_16x16x32_bf16 v[40:43], v[136:139], a[176:179], v[40:43]
v_mfma_f32_16x16x32_bf16 v[44:47], v[140:143], a[176:179], v[44:47]
s_nop 0
ds_read_b64_tr_b16 v[248:249], v10 offset:45056
ds_read_b64_tr_b16 v[250:251], v10 offset:47104
v_mfma_f32_16x16x32_bf16 v[44:47], v[156:159], a[180:183], v[44:47]
s_nop 0
ds_read_b64_tr_b16 v[252:253], v11 offset:45056
ds_read_b64_tr_b16 v[254:255], v11 offset:47104
v_mfma_f32_16x16x32_bf16 v[44:47], v[172:175], a[184:187], v[44:47]
v_mfma_f32_16x16x32_bf16 v[44:47], v[188:191], a[188:191], v[44:47]
s_waitcnt vmcnt(4)
v_max3_u32 v12, v80, v81, v82
v_max3_u32 v13, v83, v84, v85
v_mfma_f32_16x16x32_bf16 v[28:31], v[188:191], a[172:175], v[28:31]
v_max3_u32 v12, v12, v86, v87
v_max3_u32 v13, v13, v88, v89
v_mfma_f32_16x16x32_bf16 v[28:31], v[172:175], a[168:171], v[28:31]
v_max3_u32 v12, v12, v90, v91
v_max3_u32 v13, v13, v92, v93
v_mfma_f32_16x16x32_bf16 v[28:31], v[156:159], a[164:167], v[28:31]
s_waitcnt vmcnt(15) lgkmcnt(0)
v_max3_u32 v12, v12, v94, v95
v_mfma_f32_16x16x32_bf16 v[28:31], v[140:143], a[160:163], v[28:31]
s_barrier
v_max_u32 v12, v12, v13
v_mfma_f32_16x16x32_bf16 v[16:19], v[192:195], a[192:195], v[16:19]
v_cmp_le_u32 vcc, 0xff800000, v12
v_mfma_f32_16x16x32_bf16 v[16:19], v[208:211], a[196:199], v[16:19]
s_nop 0
ds_read_b64_tr_b16 v[128:129], v8 offset:49152
ds_read_b64_tr_b16 v[130:131], v8 offset:51200
v_mfma_f32_16x16x32_bf16 v[16:19], v[224:227], a[200:203], v[16:19]
s_cbranch_vccnz Lxspin2
Lxback2:
v_mfma_f32_16x16x32_bf16 v[16:19], v[240:243], a[204:207], v[16:19]
s_nop 0
ds_read_b64_tr_b16 v[132:133], v9 offset:49152
ds_read_b64_tr_b16 v[134:135], v9 offset:51200
v_mfma_f32_16x16x32_bf16 v[16:19], v[124:127], v[80:83], v[16:19]
v_mfma_f32_16x16x32_bf16 v[32:35], v[240:243], a[220:223], v[32:35]
s_nop 0
ds_read_b64_tr_b16 v[136:137], v10 offset:49152
ds_read_b64_tr_b16 v[138:139], v10 offset:51200
v_mfma_f32_16x16x32_bf16 v[32:35], v[224:227], a[216:219], v[32:35]
v_mfma_f32_16x16x32_bf16 v[32:35], v[208:211], a[212:215], v[32:35]
s_nop 0
ds_read_b64_tr_b16 v[140:141], v11 offset:49152
ds_read_b64_tr_b16 v[142:143], v11 offset:51200
v_mfma_f32_16x16x32_bf16 v[32:35], v[192:195], a[208:211], v[32:35]
v_mfma_f32_16x16x32_bf16 v[32:35], v[124:127], v[88:91], v[32:35]
s_nop 0
ds_read_b64_tr_b16 v[144:145], v8 offset:53248
ds_read_b64_tr_b16 v[146:147], v8 offset:55296
v_mfma_f32_16x16x32_bf16 v[36:39], v[196:199], a[208:211], v[36:39]
v_mfma_f32_16x16x32_bf16 v[36:39], v[212:215], a[212:215], v[36:39]
s_nop 0
ds_read_b64_tr_b16 v[148:149], v9 offset:53248
ds_read_b64_tr_b16 v[150:151], v9 offset:55296
v_mfma_f32_16x16x32_bf16 v[36:39], v[228:231], a[216:219], v[36:39]
v_mfma_f32_16x16x32_bf16 v[36:39], v[244:247], a[220:223], v[36:39]
s_nop 0
ds_read_b64_tr_b16 v[152:153], v10 offset:53248
ds_read_b64_tr_b16 v[154:155], v10 offset:55296
v_mfma_f32_16x16x32_bf16 v[36:39], v[120:123], v[88:91], v[36:39]
v_mfma_f32_16x16x32_bf16 v[20:23], v[244:247], a[204:207], v[20:23]
s_nop 0
ds_read_b64_tr_b16 v[156:157], v11 offset:53248
ds_read_b64_tr_b16 v[158:159], v11 offset:55296
v_mfma_f32_16x16x32_bf16 v[20:23], v[228:231], a[200:203], v[20:23]
Lstube5:
s_cbranch_execz Lrete
v_mfma_f32_16x16x32_bf16 v[20:23], v[212:215], a[196:199], v[20:23]
v_mfma_f32_16x16x32_bf16 v[20:23], v[196:199], a[192:195], v[20:23]
s_nop 0
ds_read_b64_tr_b16 v[160:161], v8 offset:57344
ds_read_b64_tr_b16 v[162:163], v8 offset:59392
v_mfma_f32_16x16x32_bf16 v[20:23], v[120:123], v[80:83], v[20:23]
v_mfma_f32_16x16x32_bf16 v[24:27], v[200:203], a[192:195], v[24:27]
s_nop 0
ds_read_b64_tr_b16 v[164:165], v9 offset:57344
ds_read_b64_tr_b16 v[166:167], v9 offset:59392
v_mfma_f32_16x16x32_bf16 v[24:27], v[216:219], a[196:199], v[24:27]
v_mfma_f32_16x16x32_bf16 v[24:27], v[232:235], a[200:203], v[24:27]
s_nop 0
ds_read_b64_tr_b16 v[168:169], v10 offset:57344
ds_read_b64_tr_b16 v[170:171], v10 offset:59392
v_mfma_f32_16x16x32_bf16 v[24:27], v[248:251], a[204:207], v[24:27]
v_mfma_f32_16x16x32_bf16 v[24:27], v[124:127], v[84:87], v[24:27]
s_nop 0
ds_read_b64_tr_b16 v[172:173], v11 offset:57344
ds_read_b64_tr_b16 v[174:175], v11 offset:59392
v_mfma_f32_16x16x32_bf16 v[40:43], v[248:251], a[220:223], v[40:43]
v_mfma_f32_16x16x32_bf16 v[40:43], v[232:235], a[216:219], v[40:43]
s_nop 0
ds_read_b64_tr_b16 v[176:177], v8 offset:61440
ds_read_b64_tr_b16 v[178:179], v8 offset:63488
v_mfma_f32_16x16x32_bf16 v[40:43], v[216:219], a[212:215], v[40:43]
v_mfma_f32_16x16x32_bf16 v[40:43], v[200:203], a[208:211], v[40:43]
s_nop 0
ds_read_b64_tr_b16 v[180:181], v9 offset:61440
ds_read_b64_tr_b16 v[182:183], v9 offset:63488
v_mfma_f32_16x16x32_bf16 v[40:43], v[124:127], v[92:95], v[40:43]
v_mfma_f32_16x16x32_bf16 v[44:47], v[204:207], a[208:211], v[44:47]
s_nop 0
ds_read_b64_tr_b16 v[184:185], v10 offset:61440
ds_read_b64_tr_b16 v[186:187], v10 offset:63488
v_mfma_f32_16x16x32_bf16 v[44:47], v[220:223], a[212:215], v[44:47]
v_mfma_f32_16x16x32_bf16 v[44:47], v[236:239], a[216:219], v[44:47]
s_nop 0
ds_read_b64_tr_b16 v[188:189], v11 offset:61440
ds_read_b64_tr_b16 v[190:191], v11 offset:63488
v_mfma_f32_16x16x32_bf16 v[44:47], v[252:255], a[220:223], v[44:47]
v_mfma_f32_16x16x32_bf16 v[44:47], v[120:123], v[92:95], v[44:47]
v_mfma_f32_16x16x32_bf16 v[28:31], v[252:255], a[204:207], v[28:31]
s_waitcnt vmcnt(0)
v_max3_u32 v12, v96, v97, v98
v_max3_u32 v13, v99, v100, v101
v_mfma_f32_16x16x32_bf16 v[28:31], v[236:239], a[200:203], v[28:31]
v_max3_u32 v12, v12, v102, v103
v_max3_u32 v13, v13, v104, v105
v_mfma_f32_16x16x32_bf16 v[28:31], v[220:223], a[196:199], v[28:31]
v_max3_u32 v12, v12, v106, v107
v_max3_u32 v13, v13, v108, v109
v_mfma_f32_16x16x32_bf16 v[28:31], v[204:207], a[192:195], v[28:31]
s_waitcnt lgkmcnt(0)
v_max3_u32 v12, v12, v110, v111
v_mfma_f32_16x16x32_bf16 v[28:31], v[120:123], v[84:87], v[28:31]
v_max_u32 v12, v12, v13
v_mfma_f32_16x16x32_bf16 v[16:19], v[128:131], a[224:227], v[16:19]
v_cmp_le_u32 vcc, 0xff800000, v12
v_mfma_f32_16x16x32_bf16 v[16:19], v[144:147], a[228:231], v[16:19]
v_mfma_f32_16x16x32_bf16 v[16:19], v[160:163], a[232:235], v[16:19]
s_cbranch_vccnz Lxspin3
Lxback3:
v_mfma_f32_16x16x32_bf16 v[16:19], v[176:179], a[236:239], v[16:19]
v_mfma_f32_16x16x32_bf16 v[16:19], v[124:127], v[96:99], v[16:19]
v_mfma_f32_16x16x32_bf16 v[20:23], v[180:183], a[236:239], v[20:23]
v_mfma_f32_16x16x32_bf16 v[20:23], v[164:167], a[232:235], v[20:23]
v_mfma_f32_16x16x32_bf16 v[20:23], v[148:151], a[228:231], v[20:23]
v_mfma_f32_16x16x32_bf16 v[20:23], v[132:135], a[224:227], v[20:23]
s_nop 3
v_fma_f32 v16, v16, v6, v48
v_fma_f32 v17, v17, v6, v64
v_mfma_f32_16x16x32_bf16 v[20:23], v[120:123], v[96:99], v[20:23]
v_fma_f32 v18, v18, v6, v49
v_fma_f32 v19, v19, v6, v65
v_mfma_f32_16x16x32_bf16 v[24:27], v[136:139], a[224:227], v[24:27]
v_cvt_pk_bf16_f32 v16, v16, v17
v_cvt_pk_bf16_f32 v17, v18, v19
v_mfma_f32_16x16x32_bf16 v[24:27], v[152:155], a[228:231], v[24:27]
ds_write_b64 v116, v[16:17] offset:0
v_mfma_f32_16x16x32_bf16 v[24:27], v[168:171], a[232:235], v[24:27]
v_mfma_f32_16x16x32_bf16 v[24:27], v[184:187], a[236:239], v[24:27]
v_fma_f32 v20, v20, v6, v50
v_fma_f32 v21, v21, v6, v66
v_mfma_f32_16x16x32_bf16 v[24:27], v[124:127], v[100:103], v[24:27]
v_fma_f32 v22, v22, v6, v51
v_fma_f32 v23, v23, v6, v67
v_mfma_f32_16x16x32_bf16 v[28:31], v[188:191], a[236:239], v[28:31]
v_cvt_pk_bf16_f32 v20, v20, v21
v_cvt_pk_bf16_f32 v21, v22, v23
v_mfma_f32_16x16x32_bf16 v[28:31], v[172:175], a[232:235], v[28:31]
ds_write_b64 v117, v[20:21] offset:0
v_mfma_f32_16x16x32_bf16 v[28:31], v[156:159], a[228:231], v[28:31]
v_mfma_f32_16x16x32_bf16 v[28:31], v[140:143], a[224:227], v[28:31]
v_fma_f32 v24, v24, v6, v52
v_fma_f32 v25, v25, v6, v68
v_mfma_f32_16x16x32_bf16 v[28:31], v[120:123], v[100:103], v[28:31]
v_fma_f32 v26, v26, v6, v53
v_fma_f32 v27, v27, v6, v69
v_mfma_f32_16x16x32_bf16 v[32:35], v[128:131], a[240:243], v[32:35]
v_cvt_pk_bf16_f32 v24, v24, v25
v_cvt_pk_bf16_f32 v25, v26, v27
v_mfma_f32_16x16x32_bf16 v[32:35], v[144:147], a[244:247], v[32:35]
ds_write_b64 v118, v[24:25] offset:0
v_mfma_f32_16x16x32_bf16 v[32:35], v[160:163], a[248:251], v[32:35]
v_mfma_f32_16x16x32_bf16 v[32:35], v[176:179], a[252:255], v[32:35]
v_fma_f32 v28, v28, v6, v54
v_fma_f32 v29, v29, v6, v70
v_mfma_f32_16x16x32_bf16 v[32:35], v[124:127], v[104:107], v[32:35]
v_fma_f32 v30, v30, v6, v55
v_fma_f32 v31, v31, v6, v71
v_mfma_f32_16x16x32_bf16 v[36:39], v[180:183], a[252:255], v[36:39]
v_cvt_pk_bf16_f32 v28, v28, v29
v_cvt_pk_bf16_f32 v29, v30, v31
v_mfma_f32_16x16x32_bf16 v[36:39], v[164:167], a[248:251], v[36:39]
s_nop 0
ds_write_b64 v119, v[28:29] offset:0
ds_read_b128 v[192:195], v4 offset:0
v_mfma_f32_16x16x32_bf16 v[36:39], v[148:151], a[244:247], v[36:39]
ds_read_b128 v[196:199], v4 offset:1024
v_mfma_f32_16x16x32_bf16 v[36:39], v[132:135], a[240:243], v[36:39]
v_fma_f32 v32, v32, v7, v56
v_fma_f32 v33, v33, v7, v72
v_mfma_f32_16x16x32_bf16 v[36:39], v[120:123], v[104:107], v[36:39]
v_fma_f32 v34, v34, v7, v57
v_fma_f32 v35, v35, v7, v73
v_mfma_f32_16x16x32_bf16 v[40:43], v[136:139], a[240:243], v[40:43]
v_cvt_pk_bf16_f32 v32, v32, v33
v_cvt_pk_bf16_f32 v33, v34, v35
v_mfma_f32_16x16x32_bf16 v[40:43], v[152:155], a[244:247], v[40:43]
ds_write_b64 v116, v[32:33] offset:2048
v_mfma_f32_16x16x32_bf16 v[40:43], v[168:171], a[248:251], v[40:43]
s_waitcnt lgkmcnt(2)
buffer_store_dwordx4 v[192:195], v15, s[40:43], s70 offen sc1
v_mfma_f32_16x16x32_bf16 v[40:43], v[184:187], a[252:255], v[40:43]
s_add_u32 s70, s70, 0x4000
v_mfma_f32_16x16x32_bf16 v[40:43], v[124:127], v[108:111], v[40:43]
v_fma_f32 v36, v36, v7, v58
v_fma_f32 v37, v37, v7, v74
v_mfma_f32_16x16x32_bf16 v[44:47], v[188:191], a[252:255], v[44:47]
v_fma_f32 v38, v38, v7, v59
v_fma_f32 v39, v39, v7, v75
v_mfma_f32_16x16x32_bf16 v[44:47], v[172:175], a[248:251], v[44:47]
v_cvt_pk_bf16_f32 v36, v36, v37
v_cvt_pk_bf16_f32 v37, v38, v39
v_mfma_f32_16x16x32_bf16 v[44:47], v[156:159], a[244:247], v[44:47]
ds_write_b64 v117, v[36:37] offset:2048
v_mfma_f32_16x16x32_bf16 v[44:47], v[140:143], a[240:243], v[44:47]
v_fma_f32 v40, v40, v7, v60
v_fma_f32 v41, v41, v7, v76
v_mfma_f32_16x16x32_bf16 v[44:47], v[120:123], v[108:111], v[44:47]
v_fma_f32 v42, v42, v7, v61
v_fma_f32 v43, v43, v7, v77
v_cvt_pk_bf16_f32 v40, v40, v41
v_cvt_pk_bf16_f32 v41, v42, v43
ds_write_b64 v118, v[40:41] offset:2048
s_waitcnt lgkmcnt(3)
buffer_store_dwordx4 v[196:199], v15, s[40:43], s70 offen sc1
s_add_u32 s70, s70, 0x4000
v_fma_f32 v44, v44, v7, v62
v_fma_f32 v45, v45, v7, v78
v_fma_f32 v46, v46, v7, v63
v_fma_f32 v47, v47, v7, v79
v_cvt_pk_bf16_f32 v44, v44, v45
v_cvt_pk_bf16_f32 v45, v46, v47
ds_write_b64 v119, v[44:45] offset:2048
ds_read_b128 v[200:203], v4 offset:2048
ds_read_b128 v[204:207], v4 offset:3072
s_waitcnt lgkmcnt(1)
buffer_store_dwordx4 v[200:203], v15, s[40:43], s70 offen sc1
s_add_u32 s70, s70, 0x4000
s_waitcnt lgkmcnt(0)
buffer_store_dwordx4 v[204:207], v15, s[40:43], s70 offen sc1
s_add_u32 s70, s70, 0x4000
Lend:
s_endpgm
Lspin1:
s_mov_b32 s83, 262144
Lsl3:
s_sleep 2
buffer_load_dword v3, v2, s[48:51], 0 offen sc1
s_sub_u32 s83, s83, 1
s_cmp_eq_u32 s83, 0
s_waitcnt vmcnt(0)
s_cbranch_scc1 Lback2
v_cmp_gt_u32 vcc, 8, v3
s_cbranch_vccnz Lsl3
s_branch Lback2
Lspin4:
s_mov_b32 s83, 262144
Lsl6:
s_sleep 2
buffer_load_dword v3, v2, s[44:47], s75 offen sc1
s_sub_u32 s83, s83, 1
s_cmp_eq_u32 s83, 0
s_waitcnt vmcnt(0)
s_cbranch_scc1 Lback5
v_cmp_gt_u32 vcc, 1, v3
s_cbranch_vccnz Lsl6
s_branch Lback5
.p2align 12
s_endpgm
.p2align 7
LP0x:
Lstub10:
s_cbranch_execz Lret
s_cmp_eq_u32 s58, 2
s_cbranch_scc1 Lta10
s_cmp_eq_u32 s58, 3
s_cbranch_scc1 Lnt11
v_mfma_f32_16x16x32_bf16 v[160:163], a[160:163], v[16:19], v[112:115]
s_xor_b32 s74, s82, 0x10000
v_exp_f32 v128, v128
v_mfma_f32_16x16x32_bf16 v[176:179], a[176:179], v[16:19], v[112:115]
s_add_u32 s74, s74, s64
ds_read_b128 a[128:131], v2 offset:16384
ds_read_b128 a[132:135], v2 offset:17408
s_branch Ljoin12
Lta10:
v_mfma_f32_16x16x32_bf16 v[160:163], a[160:163], v[16:19], v[96:99]
s_xor_b32 s74, s82, 0x10000
v_exp_f32 v128, v128
v_mfma_f32_16x16x32_bf16 v[176:179], a[176:179], v[16:19], v[112:115]
s_add_u32 s74, s74, s64
ds_read_b128 a[128:131], v2 offset:16384
ds_read_b128 a[132:135], v2 offset:17408
s_branch Ljoin12
Lnt11:
v_mfma_f32_16x16x32_bf16 v[160:163], a[160:163], v[16:19], v[80:83]
s_xor_b32 s74, s82, 0x10000
v_exp_f32 v128, v128
v_mfma_f32_16x16x32_bf16 v[176:179], a[176:179], v[16:19], v[96:99]
s_add_u32 s74, s74, s64
ds_read_b128 a[128:131], v2 offset:16384
ds_read_b128 a[132:135], v2 offset:17408
Ljoin12:
v_mfma_f32_16x16x32_bf16 v[164:167], a[160:163], v[32:35], v[84:87]
s_add_u32 s81, s81, 0x8000
v_exp_f32 v129, v129
v_mfma_f32_16x16x32_bf16 v[164:167], a[164:167], v[36:39], v[164:167]
s_add_u32 m0, s74, 16384
v_exp_f32 v130, v130
v_mfma_f32_16x16x32_bf16 v[164:167], a[168:171], v[40:43], v[164:167]
s_add_u32 s72, s81, 16384
v_exp_f32 v131, v131
v_mfma_f32_16x16x32_bf16 v[164:167], a[172:175], v[44:47], v[164:167]
v_exp_f32 v144, v144
v_mfma_f32_16x16x32_bf16 v[172:175], a[172:175], v[76:79], v[92:95]
s_nop 0
ds_read_b128 a[136:139], v2 offset:18432
ds_read_b128 a[140:143], v2 offset:19456
v_mfma_f32_16x16x32_bf16 v[172:175], a[168:171], v[72:75], v[172:175]
s_nop 0
ds_read_b128 a[144:147], v2 offset:20480
ds_read_b128 a[148:151], v2 offset:21504
v_mfma_f32_16x16x32_bf16 v[172:175], a[164:167], v[68:71], v[172:175]
s_nop 0
ds_read_b128 a[152:155], v2 offset:22528
ds_read_b128 a[156:159], v2 offset:23552
v_mfma_f32_16x16x32_bf16 v[172:175], a[160:163], v[64:67], v[172:175]
s_nop 0
ds_read_b128 a[192:195], v2 offset:0
ds_read_b128 a[196:199], v2 offset:1024
v_mfma_f32_16x16x32_bf16 v[188:191], a[176:179], v[64:67], v[92:95]
s_nop 0
ds_read_b128 a[200:203], v2 offset:2048
ds_read_b128 a[204:207], v2 offset:3072
v_mfma_f32_16x16x32_bf16 v[188:191], a[180:183], v[68:71], v[188:191]
s_nop 0
ds_read_b128 a[208:211], v2 offset:4096
ds_read_b128 a[212:215], v2 offset:5120
v_mfma_f32_16x16x32_bf16 v[188:191], a[184:187], v[72:75], v[188:191]
s_nop 0
ds_read_b128 a[216:219], v2 offset:6144
ds_read_b128 a[220:223], v2 offset:7168
v_mfma_f32_16x16x32_bf16 v[188:191], a[188:191], v[76:79], v[188:191]
v_cvt_pk_bf16_f32 v192, v128, v129
v_cvt_pk_bf16_f32 v193, v130, v131
v_mfma_f32_16x16x32_bf16 v[180:183], a[188:191], v[44:47], v[84:87]
buffer_load_dwordx4 v1, s[44:47], s72 offen sc1 lds
v_mfma_f32_16x16x32_bf16 v[180:183], a[184:187], v[40:43], v[180:183]
v_exp_f32 v145, v145
v_mfma_f32_16x16x32_bf16 v[180:183], a[180:183], v[36:39], v[180:183]
v_exp_f32 v146, v146
v_mfma_f32_16x16x32_bf16 v[180:183], a[176:179], v[32:35], v[180:183]
v_exp_f32 v147, v147
v_mfma_f32_16x16x32_bf16 v[160:163], a[164:167], v[20:23], v[160:163]
v_exp_f32 v136, v136
v_mfma_f32_16x16x32_bf16 v[160:163], a[168:171], v[24:27], v[160:163]
v_cvt_pk_bf16_f32 v194, v144, v145
v_cvt_pk_bf16_f32 v195, v146, v147
v_mfma_f32_16x16x32_bf16 v[160:163], a[172:175], v[28:31], v[160:163]
v_exp_f32 v137, v137
v_mfma_f32_16x16x32_bf16 v[168:171], a[172:175], v[60:63], v[88:91]
v_exp_f32 v138, v138
v_mfma_f32_16x16x32_bf16 v[168:171], a[168:171], v[56:59], v[168:171]
v_exp_f32 v139, v139
v_mfma_f32_16x16x32_bf16 v[168:171], a[164:167], v[52:55], v[168:171]
v_exp_f32 v152, v152
v_mfma_f32_16x16x32_bf16 v[168:171], a[160:163], v[48:51], v[168:171]
v_cvt_pk_bf16_f32 v200, v136, v137
v_cvt_pk_bf16_f32 v201, v138, v139
v_mfma_f32_16x16x32_bf16 v[184:187], a[176:179], v[48:51], v[88:91]
buffer_load_dwordx4 v1, s[44:47], s72 offen offset:1024 sc1 lds
v_mfma_f32_16x16x32_bf16 v[184:187], a[180:183], v[52:55], v[184:187]
v_exp_f32 v153, v153
v_mfma_f32_16x16x32_bf16 v[184:187], a[184:187], v[56:59], v[184:187]
v_exp_f32 v154, v154
v_mfma_f32_16x16x32_bf16 v[184:187], a[188:191], v[60:63], v[184:187]
v_exp_f32 v155, v155
v_mfma_f32_16x16x32_bf16 v[176:179], a[188:191], v[28:31], v[176:179]
buffer_load_dwordx4 v1, s[44:47], s72 offen offset:2048 sc1 lds
v_mfma_f32_16x16x32_bf16 v[176:179], a[184:187], v[24:27], v[176:179]
buffer_load_dwordx4 v1, s[44:47], s72 offen offset:3072 sc1 lds
v_mfma_f32_16x16x32_bf16 v[176:179], a[180:183], v[20:23], v[176:179]
s_waitcnt lgkmcnt(4)
v_exp_f32 v132, v132
v_cvt_pk_bf16_f32 v202, v152, v153
v_cvt_pk_bf16_f32 v203, v154, v155
v_exp_f32 v133, v133
v_exp_f32 v134, v134
v_cvt_pk_bf16_f32 v196, v132, v133
v_exp_f32 v135, v135
v_exp_f32 v148, v148
v_cvt_pk_bf16_f32 v197, v134, v135
v_exp_f32 v149, v149
v_exp_f32 v150, v150
v_cvt_pk_bf16_f32 v198, v148, v149
v_exp_f32 v151, v151
v_exp_f32 v140, v140
v_cvt_pk_bf16_f32 v199, v150, v151
v_exp_f32 v141, v141
v_exp_f32 v142, v142
v_cvt_pk_bf16_f32 v204, v140, v141
v_exp_f32 v143, v143
v_exp_f32 v156, v156
v_cvt_pk_bf16_f32 v205, v142, v143
v_exp_f32 v157, v157
v_exp_f32 v158, v158
v_cvt_pk_bf16_f32 v206, v156, v157
v_exp_f32 v159, v159
s_nop 0
v_cvt_pk_bf16_f32 v207, v158, v159
v_mfma_f32_16x16x32_bf16 v[224:227], v[120:123], v[192:195], 0
s_add_u32 s82, s82, 0x8000
ds_read_b128 a[160:163], v2 offset:24576
ds_read_b128 a[164:167], v2 offset:25600
v_mfma_f32_16x16x32_bf16 v[232:235], v[120:123], v[200:203], 0
s_and_b32 s82, s82, 0x1ffff
v_exp_f32 v164, v164
v_mfma_f32_16x16x32_bf16 a[0:3], a[192:195], v[192:195], 0
s_add_u32 m0, s74, 0
v_exp_f32 v165, v165
v_mfma_f32_16x16x32_bf16 a[64:67], a[192:195], v[200:203], 0
s_add_u32 s72, s81, 0
v_exp_f32 v166, v166
v_mfma_f32_16x16x32_bf16 a[68:71], a[196:199], v[200:203], 0
buffer_load_dwordx4 v1, s[44:47], s72 offen sc1 lds
v_mfma_f32_16x16x32_bf16 a[4:7], a[196:199], v[192:195], 0
v_exp_f32 v167, v167
v_mfma_f32_16x16x32_bf16 a[8:11], a[200:203], v[192:195], 0
s_nop 0
ds_read_b128 a[168:171], v2 offset:26624
ds_read_b128 a[172:175], v2 offset:27648
v_mfma_f32_16x16x32_bf16 a[72:75], a[200:203], v[200:203], 0
v_exp_f32 v180, v180
v_mfma_f32_16x16x32_bf16 a[76:79], a[204:207], v[200:203], 0
s_nop 0
ds_read_b128 a[176:179], v2 offset:28672
ds_read_b128 a[180:183], v2 offset:29696
v_mfma_f32_16x16x32_bf16 a[12:15], a[204:207], v[192:195], 0
s_waitcnt lgkmcnt(6)
ds_read_b128 a[184:187], v2 offset:30720
ds_read_b128 a[188:191], v2 offset:31744
v_mfma_f32_16x16x32_bf16 a[16:19], a[208:211], v[192:195], 0
s_nop 0
ds_read_b128 a[224:227], v2 offset:8192
ds_read_b128 a[228:231], v2 offset:9216
v_mfma_f32_16x16x32_bf16 a[80:83], a[208:211], v[200:203], 0
s_nop 0
ds_read_b128 a[232:235], v2 offset:10240
ds_read_b128 a[236:239], v2 offset:11264
v_mfma_f32_16x16x32_bf16 a[84:87], a[212:215], v[200:203], 0
s_nop 0
ds_read_b128 a[240:243], v2 offset:12288
ds_read_b128 a[244:247], v2 offset:13312
v_mfma_f32_16x16x32_bf16 a[20:23], a[212:215], v[192:195], 0
s_nop 0
ds_read_b128 a[248:251], v2 offset:14336
ds_read_b128 a[252:255], v2 offset:15360
v_mfma_f32_16x16x32_bf16 a[24:27], a[216:219], v[192:195], 0
v_cvt_pk_bf16_f32 v212, v164, v165
v_cvt_pk_bf16_f32 v213, v166, v167
v_mfma_f32_16x16x32_bf16 a[88:91], a[216:219], v[200:203], 0
v_exp_f32 v181, v181
v_mfma_f32_16x16x32_bf16 a[92:95], a[220:223], v[200:203], 0
v_exp_f32 v182, v182
v_mfma_f32_16x16x32_bf16 a[28:31], a[220:223], v[192:195], 0
buffer_load_dwordx4 v1, s[44:47], s72 offen offset:1024 sc1 lds
s_cmp_eq_u32 s58, 0
s_cbranch_scc1 Lta13
s_cmp_eq_u32 s58, 1
s_cbranch_scc1 Lnt14
v_mfma_f32_16x16x32_bf16 v[132:135], a[128:131], v[32:35], v[84:87]
v_exp_f32 v183, v183
v_mfma_f32_16x16x32_bf16 v[148:151], a[144:147], v[32:35], v[84:87]
v_exp_f32 v172, v172
s_branch Ljoin15
Lta13:
v_mfma_f32_16x16x32_bf16 v[132:135], a[128:131], v[32:35], v[100:103]
v_exp_f32 v183, v183
v_mfma_f32_16x16x32_bf16 v[148:151], a[144:147], v[32:35], v[112:115]
v_exp_f32 v172, v172
s_branch Ljoin15
Lnt14:
v_mfma_f32_16x16x32_bf16 v[132:135], a[128:131], v[32:35], v[84:87]
v_exp_f32 v183, v183
v_mfma_f32_16x16x32_bf16 v[148:151], a[144:147], v[32:35], v[100:103]
v_exp_f32 v172, v172
Ljoin15:
v_mfma_f32_16x16x32_bf16 v[136:139], a[128:131], v[48:51], v[88:91]
v_cvt_pk_bf16_f32 v214, v180, v181
v_cvt_pk_bf16_f32 v215, v182, v183
v_mfma_f32_16x16x32_bf16 v[136:139], a[132:135], v[52:55], v[136:139]
v_exp_f32 v173, v173
v_mfma_f32_16x16x32_bf16 v[136:139], a[136:139], v[56:59], v[136:139]
buffer_load_dwordx4 v1, s[44:47], s72 offen offset:2048 sc1 lds
v_mfma_f32_16x16x32_bf16 v[136:139], a[140:143], v[60:63], v[136:139]
v_exp_f32 v174, v174
v_mfma_f32_16x16x32_bf16 v[152:155], a[156:159], v[60:63], v[88:91]
v_exp_f32 v175, v175
v_mfma_f32_16x16x32_bf16 v[152:155], a[152:155], v[56:59], v[152:155]
v_exp_f32 v188, v188
v_mfma_f32_16x16x32_bf16 v[152:155], a[148:151], v[52:55], v[152:155]
v_cvt_pk_bf16_f32 v220, v172, v173
v_cvt_pk_bf16_f32 v221, v174, v175
v_mfma_f32_16x16x32_bf16 v[152:155], a[144:147], v[48:51], v[152:155]
v_exp_f32 v189, v189
v_mfma_f32_16x16x32_bf16 v[132:135], a[132:135], v[36:39], v[132:135]
buffer_load_dwordx4 v1, s[44:47], s72 offen offset:3072 sc1 lds
v_mfma_f32_16x16x32_bf16 v[132:135], a[136:139], v[40:43], v[132:135]
s_add_u32 s66, s58, 1
v_exp_f32 v190, v190
v_mfma_f32_16x16x32_bf16 v[132:135], a[140:143], v[44:47], v[132:135]
s_and_b32 s66, s66, 3
v_exp_f32 v191, v191
v_mfma_f32_16x16x32_bf16 v[140:143], a[140:143], v[76:79], v[92:95]
s_mul_i32 s66, s66, 4160
v_exp_f32 v160, v160
v_mfma_f32_16x16x32_bf16 v[140:143], a[136:139], v[72:75], v[140:143]
s_add_u32 m0, s66, 131104
v_cvt_pk_bf16_f32 v222, v188, v189
v_cvt_pk_bf16_f32 v223, v190, v191
v_mfma_f32_16x16x32_bf16 v[140:143], a[132:135], v[68:71], v[140:143]
s_add_u32 s72, s93, 0x2
v_exp_f32 v161, v161
v_mfma_f32_16x16x32_bf16 v[140:143], a[128:131], v[64:67], v[140:143]
buffer_load_dwordx4 v1, s[36:39], s72 offen lds
v_mfma_f32_16x16x32_bf16 v[156:159], a[144:147], v[64:67], v[92:95]
v_exp_f32 v162, v162
v_mfma_f32_16x16x32_bf16 v[156:159], a[148:151], v[68:71], v[156:159]
v_exp_f32 v163, v163
v_mfma_f32_16x16x32_bf16 v[156:159], a[152:155], v[72:75], v[156:159]
buffer_load_dwordx4 v1, s[36:39], s72 offen offset:1024 lds
v_mfma_f32_16x16x32_bf16 v[156:159], a[156:159], v[76:79], v[156:159]
buffer_load_dwordx4 v1, s[36:39], s72 offen offset:2048 lds
v_mfma_f32_16x16x32_bf16 v[148:151], a[156:159], v[44:47], v[148:151]
buffer_load_dwordx4 v1, s[36:39], s72 offen offset:3072 lds
v_mfma_f32_16x16x32_bf16 v[148:151], a[152:155], v[40:43], v[148:151]
s_waitcnt vmcnt(12) lgkmcnt(4)
v_exp_f32 v176, v176
v_mfma_f32_16x16x32_bf16 v[148:151], a[148:151], v[36:39], v[148:151]
s_barrier
v_cvt_pk_bf16_f32 v208, v160, v161
v_cvt_pk_bf16_f32 v209, v162, v163
v_add_u32 v2, s82, v1
v_exp_f32 v177, v177
v_exp_f32 v178, v178
v_cvt_pk_bf16_f32 v210, v176, v177
v_exp_f32 v179, v179
v_exp_f32 v168, v168
v_cvt_pk_bf16_f32 v211, v178, v179
v_exp_f32 v169, v169
v_exp_f32 v170, v170
v_cvt_pk_bf16_f32 v216, v168, v169
v_exp_f32 v171, v171
v_exp_f32 v184, v184
v_cvt_pk_bf16_f32 v217, v170, v171
v_exp_f32 v185, v185
v_exp_f32 v186, v186
v_cvt_pk_bf16_f32 v218, v184, v185
v_exp_f32 v187, v187
s_nop 0
v_cvt_pk_bf16_f32 v219, v186, v187
s_branch LLT3
.p2align 12
s_endpgm
.p2align 7
LLT3x:
Lstub11:
s_cbranch_execz Lret
v_mfma_f32_16x16x32_bf16 v[228:231], v[120:123], v[196:199], v[228:231]
s_xor_b32 s74, s82, 0x10000
ds_read_b128 a[128:131], v2 offset:16384
v_and_b32 v240, 15, v0
v_mfma_f32_16x16x32_bf16 v[228:231], v[120:123], v[212:215], v[228:231]
s_add_u32 s74, s74, s64
v_exp_f32 v136, v136
v_mfma_f32_16x16x32_bf16 v[236:239], v[120:123], v[204:207], v[236:239]
s_add_u32 s81, s81, 0x8000
v_exp_f32 v137, v137
v_mfma_f32_16x16x32_bf16 v[236:239], v[120:123], v[220:223], v[236:239]
s_add_u32 m0, s74, 0
ds_read_b128 a[132:135], v2 offset:17408
v_cvt_pk_bf16_f32 v200, v136, v137
v_mfma_f32_16x16x32_bf16 a[32:35], a[192:195], v[196:199], a[32:35]
s_add_u32 s72, s81, 0
buffer_load_dwordx4 v1, s[44:47], s72 offen sc1 lds
v_mfma_f32_16x16x32_bf16 a[32:35], a[224:227], v[212:215], a[32:35]
s_add_u32 s69, s93, 0x3e00000
v_exp_f32 v138, v138
v_mfma_f32_16x16x32_bf16 a[96:99], a[224:227], v[220:223], a[96:99]
ds_read_b128 a[136:139], v2 offset:18432
v_lshrrev_b32 v241, 4, v0
v_mfma_f32_16x16x32_bf16 a[96:99], a[192:195], v[204:207], a[96:99]
v_exp_f32 v139, v139
v_mfma_f32_16x16x32_bf16 a[100:103], a[196:199], v[204:207], a[100:103]
buffer_store_dwordx4 v[112:115], v1, s[44:47], s69 offen sc1
v_mfma_f32_16x16x32_bf16 a[100:103], a[228:231], v[220:223], a[100:103]
v_exp_f32 v152, v152
v_mfma_f32_16x16x32_bf16 a[36:39], a[228:231], v[212:215], a[36:39]
ds_read_b128 a[140:143], v2 offset:19456
v_cvt_pk_bf16_f32 v201, v138, v139
v_mfma_f32_16x16x32_bf16 a[36:39], a[196:199], v[196:199], a[36:39]
v_exp_f32 v153, v153
v_mfma_f32_16x16x32_bf16 a[40:43], a[200:203], v[196:199], a[40:43]
buffer_load_dwordx4 v1, s[44:47], s72 offen offset:1024 sc1 lds
v_mfma_f32_16x16x32_bf16 a[40:43], a[232:235], v[212:215], a[40:43]
ds_read_b128 a[144:147], v2 offset:20480
v_cvt_pk_bf16_f32 v202, v152, v153
v_mfma_f32_16x16x32_bf16 a[104:107], a[232:235], v[220:223], a[104:107]
v_exp_f32 v154, v154
v_mfma_f32_16x16x32_bf16 a[104:107], a[200:203], v[204:207], a[104:107]
v_exp_f32 v155, v155
v_mfma_f32_16x16x32_bf16 a[108:111], a[204:207], v[204:207], a[108:111]
buffer_store_dwordx4 v[112:115], v1, s[44:47], s69 offen offset:1024 sc1
v_mfma_f32_16x16x32_bf16 a[108:111], a[236:239], v[220:223], a[108:111]
ds_read_b128 a[148:151], v2 offset:21504
v_cvt_pk_bf16_f32 v203, v154, v155
v_mfma_f32_16x16x32_bf16 a[44:47], a[236:239], v[212:215], a[44:47]
v_exp_f32 v132, v132
v_mfma_f32_16x16x32_bf16 a[44:47], a[204:207], v[196:199], a[44:47]
ds_read_b128 a[152:155], v2 offset:22528
v_add_u32 v248, 1, v240
v_mfma_f32_16x16x32_bf16 a[48:51], a[208:211], v[196:199], a[48:51]
s_waitcnt lgkmcnt(7)
v_exp_f32 v133, v133
v_mfma_f32_16x16x32_bf16 a[48:51], a[240:243], v[212:215], a[48:51]
buffer_load_dwordx4 v1, s[44:47], s72 offen offset:2048 sc1 lds
v_mfma_f32_16x16x32_bf16 a[112:115], a[240:243], v[220:223], a[112:115]
v_exp_f32 v134, v134
v_mfma_f32_16x16x32_bf16 a[112:115], a[208:211], v[204:207], a[112:115]
ds_read_b128 a[156:159], v2 offset:23552
v_and_b32 v249, 3, v248
v_mfma_f32_16x16x32_bf16 a[116:119], a[212:215], v[204:207], a[116:119]
v_exp_f32 v135, v135
v_mfma_f32_16x16x32_bf16 a[116:119], a[244:247], v[220:223], a[116:119]
buffer_store_dwordx4 v[112:115], v1, s[44:47], s69 offen offset:2048 sc1
v_mfma_f32_16x16x32_bf16 a[52:55], a[244:247], v[212:215], a[52:55]
ds_read_b128 a[192:195], v2 offset:0
v_lshrrev_b32 v248, 2, v248
v_mfma_f32_16x16x32_bf16 a[52:55], a[212:215], v[196:199], a[52:55]
v_exp_f32 v148, v148
v_mfma_f32_16x16x32_bf16 a[56:59], a[216:219], v[196:199], a[56:59]
buffer_load_dwordx4 v1, s[44:47], s72 offen offset:3072 sc1 lds
v_mfma_f32_16x16x32_bf16 a[56:59], a[248:251], v[212:215], a[56:59]
v_exp_f32 v149, v149
v_mfma_f32_16x16x32_bf16 a[120:123], a[248:251], v[220:223], a[120:123]
ds_read_b128 a[196:199], v2 offset:1024
v_mov_b32 v250, 0x20000
v_mfma_f32_16x16x32_bf16 a[120:123], a[216:219], v[204:207], a[120:123]
v_exp_f32 v150, v150
v_mfma_f32_16x16x32_bf16 a[124:127], a[220:223], v[204:207], a[124:127]
ds_read_b128 a[200:203], v2 offset:2048
v_mov_b32 v252, 0x20001
v_mfma_f32_16x16x32_bf16 a[124:127], a[252:255], v[220:223], a[124:127]
buffer_store_dwordx4 v[112:115], v1, s[44:47], s69 offen offset:3072 sc1
v_mfma_f32_16x16x32_bf16 a[60:63], a[252:255], v[212:215], a[60:63]
s_add_u32 s69, s93, 0x4200000
v_exp_f32 v151, v151
v_mfma_f32_16x16x32_bf16 a[60:63], a[220:223], v[196:199], a[60:63]
ds_read_b128 a[204:207], v2 offset:3072
v_cvt_pk_bf16_f32 v196, v132, v133
s_cmp_eq_u32 s58, 2
s_cbranch_scc1 Lta40
s_cmp_eq_u32 s58, 3
s_cbranch_scc1 Lnt41
v_mfma_f32_16x16x32_bf16 v[164:167], a[160:163], v[32:35], v[112:115]
ds_read_b128 a[208:211], v2 offset:4096
v_cvt_pk_bf16_f32 v197, v134, v135
v_mfma_f32_16x16x32_bf16 v[180:183], a[176:179], v[32:35], v[112:115]
v_exp_f32 v140, v140
s_branch Ljoin42
Lta40:
v_mfma_f32_16x16x32_bf16 v[164:167], a[160:163], v[32:35], v[100:103]
ds_read_b128 a[208:211], v2 offset:4096
v_cvt_pk_bf16_f32 v197, v134, v135
v_mfma_f32_16x16x32_bf16 v[180:183], a[176:179], v[32:35], v[112:115]
v_exp_f32 v140, v140
s_branch Ljoin42
Lnt41:
v_mfma_f32_16x16x32_bf16 v[164:167], a[160:163], v[32:35], v[84:87]
ds_read_b128 a[208:211], v2 offset:4096
v_cvt_pk_bf16_f32 v197, v134, v135
v_mfma_f32_16x16x32_bf16 v[180:183], a[176:179], v[32:35], v[100:103]
v_exp_f32 v140, v140
Ljoin42:
v_mfma_f32_16x16x32_bf16 v[164:167], a[164:167], v[36:39], v[164:167]
ds_read_b128 a[212:215], v2 offset:5120
v_cvt_pk_bf16_f32 v198, v148, v149
v_mfma_f32_16x16x32_bf16 v[164:167], a[168:171], v[40:43], v[164:167]
buffer_store_dwordx4 v[112:115], v1, s[44:47], s69 offen sc1
v_mfma_f32_16x16x32_bf16 v[164:167], a[172:175], v[44:47], v[164:167]
v_exp_f32 v141, v141
v_mfma_f32_16x16x32_bf16 v[172:175], a[172:175], v[76:79], v[92:95]
v_exp_f32 v142, v142
v_mfma_f32_16x16x32_bf16 v[172:175], a[168:171], v[72:75], v[172:175]
ds_read_b128 a[216:219], v2 offset:6144
v_cvt_pk_bf16_f32 v199, v150, v151
v_mfma_f32_16x16x32_bf16 v[172:175], a[164:167], v[68:71], v[172:175]
buffer_store_dwordx4 v[112:115], v1, s[44:47], s69 offen offset:1024 sc1
v_mfma_f32_16x16x32_bf16 v[172:175], a[160:163], v[64:67], v[172:175]
v_exp_f32 v143, v143
v_mfma_f32_16x16x32_bf16 v[188:191], a[176:179], v[64:67], v[92:95]
v_exp_f32 v156, v156
v_mfma_f32_16x16x32_bf16 v[188:191], a[180:183], v[68:71], v[188:191]
ds_read_b128 a[220:223], v2 offset:7168
v_cvt_pk_bf16_f32 v204, v140, v141
v_mfma_f32_16x16x32_bf16 v[188:191], a[184:187], v[72:75], v[188:191]
buffer_store_dwordx4 v[112:115], v1, s[44:47], s69 offen offset:2048 sc1
v_mfma_f32_16x16x32_bf16 v[188:191], a[188:191], v[76:79], v[188:191]
v_exp_f32 v157, v157
v_mfma_f32_16x16x32_bf16 v[180:183], a[188:191], v[44:47], v[180:183]
v_exp_f32 v158, v158
v_mfma_f32_16x16x32_bf16 v[180:183], a[184:187], v[40:43], v[180:183]
v_cvt_pk_bf16_f32 v205, v142, v143
v_cvt_pk_bf16_f32 v206, v156, v157
v_mfma_f32_16x16x32_bf16 v[180:183], a[180:183], v[36:39], v[180:183]
buffer_store_dwordx4 v[112:115], v1, s[44:47], s69 offen offset:3072 sc1
v_mfma_f32_16x16x32_bf16 v[168:171], a[160:163], v[48:51], v[88:91]
v_exp_f32 v159, v159
v_mfma_f32_16x16x32_bf16 v[168:171], a[164:167], v[52:55], v[168:171]
v_cvt_pk_bf16_f32 v207, v158, v159
v_lshlrev_b32 v6, 3, v249
v_mfma_f32_16x16x32_bf16 v[168:171], a[168:171], v[56:59], v[168:171]
v_lshrrev_b32 v6, v6, v252
v_and_b32 v6, 3, v6
v_mfma_f32_16x16x32_bf16 v[168:171], a[172:175], v[60:63], v[168:171]
v_cmp_ne_u32 vcc, 1, v249
v_mul_u32_u24 v6, 16640, v6
v_mfma_f32_16x16x32_bf16 v[184:187], a[188:191], v[60:63], v[88:91]
v_add_u32 v6, s92, v6
v_cndmask_b32 v6, v250, v6, vcc
v_mfma_f32_16x16x32_bf16 v[184:187], a[184:187], v[56:59], v[184:187]
v_add_u32 v253, s58, v249
v_and_b32 v253, 3, v253
v_mfma_f32_16x16x32_bf16 v[184:187], a[180:183], v[52:55], v[184:187]
s_waitcnt lgkmcnt(4)
v_mfma_f32_16x16x32_bf16 v[184:187], a[176:179], v[48:51], v[184:187]
s_barrier
s_lshr_b32 s69, s93, 4
s_and_b32 s69, s69, 0x7f00
s_add_u32 s69, s69, LHT4-Lpc0
v_lshrrev_b32 v3, 5, v0
v_lshlrev_b32 v3, 7, v3
v_add_u32 v3, s69, v3
v_min_u32 v3, Lcode_end-Lpc0, v3
global_load_dword v4, v3, s[98:99]
v_mfma_f32_16x16x32_bf16 v[224:227], v[120:123], v[208:211], v[224:227]
s_add_u32 s82, s82, 0x8000
ds_read_b128 a[160:163], v2 offset:24576
ds_read_b128 a[164:167], v2 offset:25600
v_mfma_f32_16x16x32_bf16 v[232:235], v[120:123], v[216:219], v[232:235]
s_and_b32 s82, s82, 0x1ffff
v_exp_f32 v164, v164
v_mfma_f32_16x16x32_bf16 v[232:235], v[120:123], v[200:203], v[232:235]
s_add_u32 s66, s58, 3
v_exp_f32 v165, v165
v_mfma_f32_16x16x32_bf16 a[0:3], a[224:227], v[208:211], a[0:3]
s_and_b32 s66, s66, 3
v_exp_f32 v166, v166
v_mfma_f32_16x16x32_bf16 a[64:67], a[192:195], v[200:203], a[64:67]
s_mul_i32 s66, s66, 4160
ds_read_b128 a[168:171], v2 offset:26624
v_cvt_pk_bf16_f32 v212, v164, v165
v_mfma_f32_16x16x32_bf16 a[64:67], a[224:227], v[216:219], a[64:67]
s_add_u32 s66, s66, s92
v_exp_f32 v167, v167
v_mfma_f32_16x16x32_bf16 a[68:71], a[228:231], v[216:219], a[68:71]
s_add_u32 m0, s66, 32
v_exp_f32 v180, v180
v_mfma_f32_16x16x32_bf16 a[68:71], a[196:199], v[200:203], a[68:71]
s_add_u32 s72, s93, 0x6
buffer_load_dwordx4 v1, s[36:39], s72 offen lds
v_mfma_f32_16x16x32_bf16 a[4:7], a[228:231], v[208:211], a[4:7]
ds_read_b128 a[172:175], v2 offset:27648
v_cvt_pk_bf16_f32 v213, v166, v167
v_mfma_f32_16x16x32_bf16 a[8:11], a[232:235], v[208:211], a[8:11]
v_exp_f32 v181, v181
v_mfma_f32_16x16x32_bf16 a[72:75], a[200:203], v[200:203], a[72:75]
ds_read_b128 a[176:179], v2 offset:28672
v_cvt_pk_bf16_f32 v214, v180, v181
v_mfma_f32_16x16x32_bf16 a[72:75], a[232:235], v[216:219], a[72:75]
v_exp_f32 v182, v182
v_mfma_f32_16x16x32_bf16 a[76:79], a[236:239], v[216:219], a[76:79]
v_exp_f32 v183, v183
v_mfma_f32_16x16x32_bf16 a[76:79], a[204:207], v[200:203], a[76:79]
ds_read_b128 a[180:183], v2 offset:29696
v_cvt_pk_bf16_f32 v215, v182, v183
v_mfma_f32_16x16x32_bf16 a[12:15], a[236:239], v[208:211], a[12:15]
v_exp_f32 v172, v172
v_mfma_f32_16x16x32_bf16 a[16:19], a[240:243], v[208:211], a[16:19]
s_waitcnt lgkmcnt(6)
ds_read_b128 a[184:187], v2 offset:30720
ds_read_b128 a[188:191], v2 offset:31744
v_mfma_f32_16x16x32_bf16 a[80:83], a[208:211], v[200:203], a[80:83]
v_exp_f32 v173, v173
v_mfma_f32_16x16x32_bf16 a[80:83], a[240:243], v[216:219], a[80:83]
buffer_load_dwordx4 v1, s[36:39], s72 offen offset:1024 lds
v_mfma_f32_16x16x32_bf16 a[84:87], a[244:247], v[216:219], a[84:87]
v_exp_f32 v174, v174
v_mfma_f32_16x16x32_bf16 a[84:87], a[212:215], v[200:203], a[84:87]
v_exp_f32 v175, v175
v_mfma_f32_16x16x32_bf16 a[20:23], a[244:247], v[208:211], a[20:23]
ds_read_b128 a[224:227], v2 offset:8192
v_cvt_pk_bf16_f32 v220, v172, v173
v_mfma_f32_16x16x32_bf16 a[24:27], a[248:251], v[208:211], a[24:27]
v_exp_f32 v188, v188
v_mfma_f32_16x16x32_bf16 a[88:91], a[216:219], v[200:203], a[88:91]
v_exp_f32 v189, v189
v_mfma_f32_16x16x32_bf16 a[88:91], a[248:251], v[216:219], a[88:91]
ds_read_b128 a[228:231], v2 offset:9216
v_cvt_pk_bf16_f32 v221, v174, v175
v_mfma_f32_16x16x32_bf16 a[92:95], a[252:255], v[216:219], a[92:95]
v_exp_f32 v190, v190
v_mfma_f32_16x16x32_bf16 a[92:95], a[220:223], v[200:203], a[92:95]
ds_read_b128 a[232:235], v2 offset:10240
v_cvt_pk_bf16_f32 v222, v188, v189
v_mfma_f32_16x16x32_bf16 a[28:31], a[252:255], v[208:211], a[28:31]
v_exp_f32 v191, v191
s_cmp_eq_u32 s58, 0
s_cbranch_scc1 Lta43
s_cmp_eq_u32 s58, 1
s_cbranch_scc1 Lnt44
v_mfma_f32_16x16x32_bf16 v[136:139], a[128:131], v[48:51], v[88:91]
buffer_load_dwordx4 v1, s[36:39], s72 offen offset:2048 lds
v_mfma_f32_16x16x32_bf16 v[152:155], a[144:147], v[48:51], v[88:91]
v_exp_f32 v168, v168
s_branch Ljoin45
Lta43:
v_mfma_f32_16x16x32_bf16 v[136:139], a[128:131], v[48:51], v[104:107]
buffer_load_dwordx4 v1, s[36:39], s72 offen offset:2048 lds
v_mfma_f32_16x16x32_bf16 v[152:155], a[144:147], v[48:51], v[112:115]
v_exp_f32 v168, v168
s_branch Ljoin45
Lnt44:
v_mfma_f32_16x16x32_bf16 v[136:139], a[128:131], v[48:51], v[88:91]
buffer_load_dwordx4 v1, s[36:39], s72 offen offset:2048 lds
v_mfma_f32_16x16x32_bf16 v[152:155], a[144:147], v[48:51], v[104:107]
v_exp_f32 v168, v168
Ljoin45:
v_mfma_f32_16x16x32_bf16 v[136:139], a[132:135], v[52:55], v[136:139]
ds_read_b128 a[236:239], v2 offset:11264
v_cvt_pk_bf16_f32 v223, v190, v191
v_mfma_f32_16x16x32_bf16 v[136:139], a[136:139], v[56:59], v[136:139]
v_exp_f32 v169, v169
v_mfma_f32_16x16x32_bf16 v[136:139], a[140:143], v[60:63], v[136:139]
ds_read_b128 a[240:243], v2 offset:12288
v_cvt_pk_bf16_f32 v216, v168, v169
v_mfma_f32_16x16x32_bf16 v[152:155], a[156:159], v[60:63], v[152:155]
v_exp_f32 v170, v170
v_mfma_f32_16x16x32_bf16 v[152:155], a[152:155], v[56:59], v[152:155]
v_exp_f32 v171, v171
v_mfma_f32_16x16x32_bf16 v[152:155], a[148:151], v[52:55], v[152:155]
ds_read_b128 a[244:247], v2 offset:13312
v_cvt_pk_bf16_f32 v217, v170, v171
v_mfma_f32_16x16x32_bf16 v[140:143], a[128:131], v[64:67], v[92:95]
v_exp_f32 v184, v184
v_mfma_f32_16x16x32_bf16 v[140:143], a[132:135], v[68:71], v[140:143]
ds_read_b128 a[248:251], v2 offset:14336
v_mfma_f32_16x16x32_bf16 v[140:143], a[136:139], v[72:75], v[140:143]
v_exp_f32 v185, v185
v_mfma_f32_16x16x32_bf16 v[140:143], a[140:143], v[76:79], v[140:143]
buffer_load_dwordx4 v1, s[36:39], s72 offen offset:3072 lds
v_mfma_f32_16x16x32_bf16 v[156:159], a[156:159], v[76:79], v[92:95]
ds_read_b128 a[252:255], v2 offset:15360
v_cvt_pk_bf16_f32 v218, v184, v185
v_mfma_f32_16x16x32_bf16 v[156:159], a[152:155], v[72:75], v[156:159]
v_exp_f32 v186, v186
v_mfma_f32_16x16x32_bf16 v[156:159], a[148:151], v[68:71], v[156:159]
s_waitcnt vmcnt(17) lgkmcnt(0)
v_exp_f32 v187, v187
v_mfma_f32_16x16x32_bf16 v[156:159], a[144:147], v[64:67], v[156:159]
s_barrier
v_cvt_pk_bf16_f32 v219, v186, v187
v_add_u32 v2, s82, v1
v_mfma_f32_16x16x32_bf16 v[228:231], v[120:123], v[196:199], v[228:231]
s_mov_b32 m0, s62
v_exp_f32 v136, v136
v_mfma_f32_16x16x32_bf16 v[228:231], v[120:123], v[212:215], v[228:231]
s_add_u32 s72, s93, 0x3000000
ds_read_b128 a[128:131], v2 offset:16384
v_mul_u32_u24 v253, 4160, v253
v_mfma_f32_16x16x32_bf16 v[236:239], v[120:123], v[204:207], v[236:239]
buffer_load_dwordx4 v1, s[44:47], s72 offen sc1 lds
v_mfma_f32_16x16x32_bf16 v[236:239], v[120:123], v[220:223], v[236:239]
v_exp_f32 v137, v137
v_mfma_f32_16x16x32_bf16 a[32:35], a[192:195], v[196:199], a[32:35]
ds_read_b128 a[132:135], v2 offset:17408
v_cvt_pk_bf16_f32 v200, v136, v137
v_mfma_f32_16x16x32_bf16 a[32:35], a[224:227], v[212:215], a[32:35]
v_exp_f32 v138, v138
v_mfma_f32_16x16x32_bf16 a[96:99], a[224:227], v[220:223], a[96:99]
ds_read_b128 a[136:139], v2 offset:18432
v_add_u32 v6, v6, v253
v_mfma_f32_16x16x32_bf16 a[96:99], a[192:195], v[204:207], a[96:99]
buffer_load_dwordx4 v1, s[44:47], s72 offen offset:1024 sc1 lds
v_mfma_f32_16x16x32_bf16 a[100:103], a[196:199], v[204:207], a[100:103]
v_exp_f32 v139, v139
v_mfma_f32_16x16x32_bf16 a[100:103], a[228:231], v[220:223], a[100:103]
ds_read_b128 a[140:143], v2 offset:19456
v_cvt_pk_bf16_f32 v201, v138, v139
v_mfma_f32_16x16x32_bf16 a[36:39], a[228:231], v[212:215], a[36:39]
v_exp_f32 v152, v152
v_mfma_f32_16x16x32_bf16 a[36:39], a[196:199], v[196:199], a[36:39]
ds_read_b128 a[144:147], v2 offset:20480
v_bfe_u32 v251, v0, 2, 2
v_mfma_f32_16x16x32_bf16 a[40:43], a[200:203], v[196:199], a[40:43]
buffer_load_dwordx4 v1, s[44:47], s72 offen offset:2048 sc1 lds
v_mfma_f32_16x16x32_bf16 a[40:43], a[232:235], v[212:215], a[40:43]
v_exp_f32 v153, v153
v_mfma_f32_16x16x32_bf16 a[104:107], a[232:235], v[220:223], a[104:107]
ds_read_b128 a[148:151], v2 offset:21504
v_cvt_pk_bf16_f32 v202, v152, v153
v_mfma_f32_16x16x32_bf16 a[104:107], a[200:203], v[204:207], a[104:107]
buffer_load_dwordx4 v1, s[44:47], s72 offen offset:3072 sc1 lds
v_mfma_f32_16x16x32_bf16 a[108:111], a[204:207], v[204:207], a[108:111]
s_add_u32 s66, s58, 0
v_exp_f32 v154, v154
v_mfma_f32_16x16x32_bf16 a[108:111], a[236:239], v[220:223], a[108:111]
s_and_b32 s66, s66, 3
ds_read_b128 a[152:155], v2 offset:22528
v_lshl_add_u32 v6, v248, 3, v6
v_mfma_f32_16x16x32_bf16 a[44:47], a[236:239], v[212:215], a[44:47]
s_mul_i32 s66, s66, 4160
v_exp_f32 v155, v155
v_mfma_f32_16x16x32_bf16 a[44:47], a[204:207], v[196:199], a[44:47]
s_add_u32 s66, s66, s92
ds_read_b128 a[156:159], v2 offset:23552
v_cvt_pk_bf16_f32 v203, v154, v155
v_mfma_f32_16x16x32_bf16 a[48:51], a[208:211], v[196:199], a[48:51]
s_waitcnt lgkmcnt(8)
v_exp_f32 v140, v140
v_mfma_f32_16x16x32_bf16 a[48:51], a[240:243], v[212:215], a[48:51]
s_add_u32 m0, s66, 16672
ds_read_b128 a[192:195], v2 offset:0
v_lshl_add_u32 v6, v241, 4, v6
v_mfma_f32_16x16x32_bf16 a[112:115], a[240:243], v[220:223], a[112:115]
s_add_u32 s72, s93, 0x0
buffer_load_dwordx4 v1, s[36:39], s72 offen lds
v_mfma_f32_16x16x32_bf16 a[112:115], a[208:211], v[204:207], a[112:115]
buffer_load_dwordx4 v1, s[36:39], s72 offen offset:1024 lds
v_mfma_f32_16x16x32_bf16 a[116:119], a[212:215], v[204:207], a[116:119]
v_exp_f32 v141, v141
v_mfma_f32_16x16x32_bf16 a[116:119], a[244:247], v[220:223], a[116:119]
ds_read_b128 a[196:199], v2 offset:1024
v_lshlrev_b32 v5, 3, v251
v_mfma_f32_16x16x32_bf16 a[52:55], a[244:247], v[212:215], a[52:55]
v_exp_f32 v142, v142
v_mfma_f32_16x16x32_bf16 a[52:55], a[212:215], v[196:199], a[52:55]
ds_read_b128 a[200:203], v2 offset:2048
v_lshrrev_b32 v5, v5, v252
v_mfma_f32_16x16x32_bf16 a[56:59], a[216:219], v[196:199], a[56:59]
buffer_load_dwordx4 v1, s[36:39], s72 offen offset:2048 lds
v_mfma_f32_16x16x32_bf16 a[56:59], a[248:251], v[212:215], a[56:59]
v_exp_f32 v143, v143
v_mfma_f32_16x16x32_bf16 a[120:123], a[248:251], v[220:223], a[120:123]
ds_read_b128 a[204:207], v2 offset:3072
v_and_b32 v5, 3, v5
v_mfma_f32_16x16x32_bf16 a[120:123], a[216:219], v[204:207], a[120:123]
v_exp_f32 v156, v156
v_mfma_f32_16x16x32_bf16 a[124:127], a[220:223], v[204:207], a[124:127]
ds_read_b128 a[208:211], v2 offset:4096
v_cmp_ne_u32 vcc, 1, v251
v_mfma_f32_16x16x32_bf16 a[124:127], a[252:255], v[220:223], a[124:127]
buffer_load_dwordx4 v1, s[36:39], s72 offen offset:3072 lds
v_mfma_f32_16x16x32_bf16 a[60:63], a[252:255], v[212:215], a[60:63]
s_add_u32 s66, s58, 2
v_exp_f32 v157, v157
v_mfma_f32_16x16x32_bf16 a[60:63], a[220:223], v[196:199], a[60:63]
s_and_b32 s66, s66, 3
ds_read_b128 a[212:215], v2 offset:5120
v_cvt_pk_bf16_f32 v204, v140, v141
s_cmp_eq_u32 s58, 2
s_cbranch_scc1 Lta46
s_cmp_eq_u32 s58, 3
s_cbranch_scc1 Lnt47
v_mfma_f32_16x16x32_bf16 v[168:171], a[160:163], v[48:51], v[112:115]
s_mul_i32 s66, s66, 4160
v_exp_f32 v158, v158
v_mfma_f32_16x16x32_bf16 v[184:187], a[176:179], v[48:51], v[112:115]
s_add_u32 s66, s66, s92
ds_read_b128 a[216:219], v2 offset:6144
v_cvt_pk_bf16_f32 v205, v142, v143
s_branch Ljoin48
Lta46:
v_mfma_f32_16x16x32_bf16 v[168:171], a[160:163], v[48:51], v[104:107]
s_mul_i32 s66, s66, 4160
v_exp_f32 v158, v158
v_mfma_f32_16x16x32_bf16 v[184:187], a[176:179], v[48:51], v[112:115]
s_add_u32 s66, s66, s92
ds_read_b128 a[216:219], v2 offset:6144
v_cvt_pk_bf16_f32 v205, v142, v143
s_branch Ljoin48
Lnt47:
v_mfma_f32_16x16x32_bf16 v[168:171], a[160:163], v[48:51], v[88:91]
s_mul_i32 s66, s66, 4160
v_exp_f32 v158, v158
v_mfma_f32_16x16x32_bf16 v[184:187], a[176:179], v[48:51], v[104:107]
s_add_u32 s66, s66, s92
ds_read_b128 a[216:219], v2 offset:6144
v_cvt_pk_bf16_f32 v205, v142, v143
Ljoin48:
v_mfma_f32_16x16x32_bf16 v[172:175], a[160:163], v[64:67], v[92:95]
s_add_u32 m0, s66, 33312
v_exp_f32 v159, v159
v_mfma_f32_16x16x32_bf16 v[172:175], a[164:167], v[68:71], v[172:175]
s_add_u32 s72, s93, 0x4
buffer_load_dwordx4 v1, s[36:39], s72 offen lds
v_mfma_f32_16x16x32_bf16 v[172:175], a[168:171], v[72:75], v[172:175]
ds_read_b128 a[220:223], v2 offset:7168
v_cvt_pk_bf16_f32 v206, v156, v157
v_mfma_f32_16x16x32_bf16 v[172:175], a[172:175], v[76:79], v[172:175]
buffer_load_dwordx4 v1, s[36:39], s72 offen offset:1024 lds
v_mfma_f32_16x16x32_bf16 v[188:191], a[188:191], v[76:79], v[92:95]
v_cvt_pk_bf16_f32 v207, v158, v159
v_mul_u32_u24 v5, 16640, v5
v_mfma_f32_16x16x32_bf16 v[188:191], a[184:187], v[72:75], v[188:191]
v_add_u32 v5, s92, v5
v_cndmask_b32 v5, v250, v5, vcc
v_mfma_f32_16x16x32_bf16 v[188:191], a[180:183], v[68:71], v[188:191]
v_add_u32 v253, s58, v251
v_and_b32 v253, 3, v253
v_mfma_f32_16x16x32_bf16 v[188:191], a[176:179], v[64:67], v[188:191]
v_mul_u32_u24 v253, 4160, v253
v_add_u32 v5, v5, v253
v_mfma_f32_16x16x32_bf16 v[168:171], a[164:167], v[52:55], v[168:171]
s_add_u32 s73, s62, 480
v_lshlrev_b32 v248, 5, v240
v_sub_u32 v248, s73, v248
v_mfma_f32_16x16x32_bf16 v[168:171], a[168:171], v[56:59], v[168:171]
v_lshl_add_u32 v7, v241, 4, v248
v_mfma_f32_16x16x32_bf16 v[168:171], a[172:175], v[60:63], v[168:171]
s_and_b32 s73, s58, 1
v_mfma_f32_16x16x32_bf16 v[184:187], a[188:191], v[60:63], v[184:187]
s_lshl_b32 s73, s73, 4
v_mfma_f32_16x16x32_bf16 v[184:187], a[184:187], v[56:59], v[184:187]
s_lshr_b32 s73, s90, s73
v_mfma_f32_16x16x32_bf16 v[184:187], a[180:183], v[52:55], v[184:187]
s_waitcnt lgkmcnt(4)
s_and_b32 s73, s73, 0xffff
v_lshl_add_u32 v248, v241, 3, v240
v_sub_u32 v248, 15, v248
v_and_b32 v249, 1, v248
v_lshlrev_b32 v249, 4, v249
v_lshlrev_b32 v249, v249, s73
v_lshrrev_b32 v248, 1, v248
v_and_b32 v241, 3, v0
v_cmp_eq_u32 vcc, 0, v248
v_lshl_add_u32 v5, v241, 3, v5
s_nop 0
v_cndmask_b32 v8, 0, v249, vcc
v_cmp_eq_u32 vcc, 1, v248
v_lshlrev_b32 v240, 4, v251
s_nop 0
v_cndmask_b32 v9, 0, v249, vcc
v_cmp_eq_u32 vcc, 2, v248
v_sub_u32 v240, 48, v240
v_lshlrev_b64 v[12:13], 16, s[88:89]
v_cndmask_b32 v10, 0, v249, vcc
v_cmp_eq_u32 vcc, 3, v248
v_lshlrev_b64 v[12:13], v240, v[12:13]
s_nop 0
v_cndmask_b32 v11, 0, v249, vcc
v_cmp_eq_u32 vcc, 3, v241
s_add_u32 s73, s62, 4096
v_lshl_add_u32 v14, v0, 3, s73
v_cndmask_b32 v12, 0, v12, vcc
v_cndmask_b32 v13, 0, v13, vcc
v_lshrrev_b32 v15, 4, v0
v_lshlrev_b32 v15, 1, v15
v_and_b32 v240, 7, v0
v_xor_b32 v15, v15, v240
v_lshlrev_b32 v15, 4, v15
v_lshrrev_b32 v240, 3, v0
v_lshl_add_u32 v15, v240, 11, v15
s_lshr_b32 s75, s59, 1
s_and_b32 s75, s75, 8
s_add_u32 s75, s75, s60
s_lshl_b32 s76, s65, 2
s_lshr_b32 s80, s59, 2
s_and_b32 s80, s80, 3
s_add_u32 s76, s76, s80
s_lshl_b32 s94, s58, 16
s_lshl_b32 s80, s76, 7
s_add_u32 s94, s94, s80
s_lshl_b32 s80, s75, 18
s_add_u32 s80, s80, s94
v_rcp_f32 v224, v224
v_rcp_f32 v228, v228
s_lshl_b32 s73, s52, 12
s_add_u32 s73, s73, 0x2000000
s_lshl_b32 s70, s67, 2
s_add_u32 s70, s70, s73
v_mov_b32 v225, v224
v_accvgpr_read_b32 v240, a0
v_accvgpr_read_b32 v241, a1
v_accvgpr_read_b32 v242, a2
v_accvgpr_read_b32 v243, a3
v_accvgpr_read_b32 v244, a4
v_accvgpr_read_b32 v245, a5
v_accvgpr_read_b32 v246, a6
v_accvgpr_read_b32 v247, a7
v_pk_mul_f32 v[240:241], v[240:241], v[224:225]
v_pk_mul_f32 v[242:243], v[242:243], v[224:225]
v_pk_mul_f32 v[244:245], v[244:245], v[224:225]
v_pk_mul_f32 v[246:247], v[246:247], v[224:225]
buffer_load_dwordx4 v1, s[36:39], s72 offen offset:2048 lds
v_cvt_pk_bf16_f32 v128, v240, v241
v_cvt_pk_bf16_f32 v129, v242, v243
v_cvt_pk_bf16_f32 v130, v244, v245
v_cvt_pk_bf16_f32 v131, v246, v247
v_accvgpr_read_b32 v248, a8
v_accvgpr_read_b32 v249, a9
v_accvgpr_read_b32 v250, a10
v_accvgpr_read_b32 v251, a11
v_accvgpr_read_b32 v252, a12
v_accvgpr_read_b32 v253, a13
v_accvgpr_read_b32 v254, a14
v_accvgpr_read_b32 v255, a15
v_pk_mul_f32 v[248:249], v[248:249], v[224:225]
v_pk_mul_f32 v[250:251], v[250:251], v[224:225]
v_pk_mul_f32 v[252:253], v[252:253], v[224:225]
v_pk_mul_f32 v[254:255], v[254:255], v[224:225]
v_cvt_pk_bf16_f32 v144, v248, v249
v_cvt_pk_bf16_f32 v145, v250, v251
buffer_load_dwordx4 v1, s[36:39], s72 offen offset:3072 lds
v_cvt_pk_bf16_f32 v146, v252, v253
v_cvt_pk_bf16_f32 v147, v254, v255
v_accvgpr_read_b32 v240, a16
v_accvgpr_read_b32 v241, a17
v_accvgpr_read_b32 v242, a18
v_accvgpr_read_b32 v243, a19
v_accvgpr_read_b32 v244, a20
v_accvgpr_read_b32 v245, a21
v_accvgpr_read_b32 v246, a22
v_accvgpr_read_b32 v247, a23
v_pk_mul_f32 v[240:241], v[240:241], v[224:225]
v_pk_mul_f32 v[242:243], v[242:243], v[224:225]
v_pk_mul_f32 v[244:245], v[244:245], v[224:225]
v_pk_mul_f32 v[246:247], v[246:247], v[224:225]
v_cvt_pk_bf16_f32 v160, v240, v241
v_cvt_pk_bf16_f32 v161, v242, v243
v_cvt_pk_bf16_f32 v162, v244, v245
v_cvt_pk_bf16_f32 v163, v246, v247
buffer_load_dwordx4 v[80:83], v15, s[4:7], s80 offen
v_accvgpr_read_b32 v248, a24
v_accvgpr_read_b32 v249, a25
v_accvgpr_read_b32 v250, a26
v_accvgpr_read_b32 v251, a27
v_accvgpr_read_b32 v252, a28
v_accvgpr_read_b32 v253, a29
v_accvgpr_read_b32 v254, a30
v_accvgpr_read_b32 v255, a31
v_pk_mul_f32 v[248:249], v[248:249], v[224:225]
v_pk_mul_f32 v[250:251], v[250:251], v[224:225]
v_pk_mul_f32 v[252:253], v[252:253], v[224:225]
v_pk_mul_f32 v[254:255], v[254:255], v[224:225]
v_cvt_pk_bf16_f32 v176, v248, v249
v_cvt_pk_bf16_f32 v177, v250, v251
v_cvt_pk_bf16_f32 v178, v252, v253
v_cvt_pk_bf16_f32 v179, v254, v255
v_mov_b32 v229, v228
v_accvgpr_read_b32 v240, a32
s_add_u32 s80, s80, 0x4000
buffer_load_dwordx4 v[84:87], v15, s[4:7], s80 offen
v_accvgpr_read_b32 v241, a33
v_accvgpr_read_b32 v242, a34
v_accvgpr_read_b32 v243, a35
v_accvgpr_read_b32 v244, a36
v_accvgpr_read_b32 v245, a37
v_accvgpr_read_b32 v246, a38
v_accvgpr_read_b32 v247, a39
v_pk_mul_f32 v[240:241], v[240:241], v[228:229]
v_pk_mul_f32 v[242:243], v[242:243], v[228:229]
v_pk_mul_f32 v[244:245], v[244:245], v[228:229]
v_pk_mul_f32 v[246:247], v[246:247], v[228:229]
v_cvt_pk_bf16_f32 v132, v240, v241
v_cvt_pk_bf16_f32 v133, v242, v243
v_cvt_pk_bf16_f32 v134, v244, v245
v_cvt_pk_bf16_f32 v135, v246, v247
v_accvgpr_read_b32 v248, a40
v_accvgpr_read_b32 v249, a41
v_accvgpr_read_b32 v250, a42
s_add_u32 s80, s80, 0x4000
buffer_load_dwordx4 v[96:99], v15, s[4:7], s80 offen
v_accvgpr_read_b32 v251, a43
v_accvgpr_read_b32 v252, a44
v_accvgpr_read_b32 v253, a45
v_accvgpr_read_b32 v254, a46
v_accvgpr_read_b32 v255, a47
v_pk_mul_f32 v[248:249], v[248:249], v[228:229]
v_pk_mul_f32 v[250:251], v[250:251], v[228:229]
v_pk_mul_f32 v[252:253], v[252:253], v[228:229]
v_pk_mul_f32 v[254:255], v[254:255], v[228:229]
v_cvt_pk_bf16_f32 v148, v248, v249
v_cvt_pk_bf16_f32 v149, v250, v251
v_cvt_pk_bf16_f32 v150, v252, v253
v_cvt_pk_bf16_f32 v151, v254, v255
v_accvgpr_read_b32 v240, a48
v_accvgpr_read_b32 v241, a49
v_accvgpr_read_b32 v242, a50
v_accvgpr_read_b32 v243, a51
v_accvgpr_read_b32 v244, a52
s_add_u32 s80, s80, 0x4000
buffer_load_dwordx4 v[100:103], v15, s[4:7], s80 offen
v_accvgpr_read_b32 v245, a53
v_accvgpr_read_b32 v246, a54
v_accvgpr_read_b32 v247, a55
v_pk_mul_f32 v[240:241], v[240:241], v[228:229]
v_pk_mul_f32 v[242:243], v[242:243], v[228:229]
v_pk_mul_f32 v[244:245], v[244:245], v[228:229]
v_pk_mul_f32 v[246:247], v[246:247], v[228:229]
v_cvt_pk_bf16_f32 v164, v240, v241
v_cvt_pk_bf16_f32 v165, v242, v243
v_cvt_pk_bf16_f32 v166, v244, v245
v_cvt_pk_bf16_f32 v167, v246, v247
v_accvgpr_read_b32 v248, a56
v_accvgpr_read_b32 v249, a57
v_accvgpr_read_b32 v250, a58
v_accvgpr_read_b32 v251, a59
v_accvgpr_read_b32 v252, a60
v_accvgpr_read_b32 v253, a61
v_accvgpr_read_b32 v254, a62
v_accvgpr_read_b32 v255, a63
v_pk_mul_f32 v[248:249], v[248:249], v[228:229]
v_pk_mul_f32 v[250:251], v[250:251], v[228:229]
v_pk_mul_f32 v[252:253], v[252:253], v[228:229]
v_pk_mul_f32 v[254:255], v[254:255], v[228:229]
v_cvt_pk_bf16_f32 v180, v248, v249
v_cvt_pk_bf16_f32 v181, v250, v251
v_cvt_pk_bf16_f32 v182, v252, v253
v_cvt_pk_bf16_f32 v183, v254, v255
v_mfma_f32_16x16x32_bf16 v[232:235], v[120:123], v[216:219], v[232:235]
s_add_u32 s82, s82, 0x8000
ds_read_b128 a[160:163], v2 offset:24576
ds_read_b128 a[164:167], v2 offset:25600
v_mfma_f32_16x16x32_bf16 v[232:235], v[120:123], v[200:203], v[232:235]
s_and_b32 s82, s82, 0x1ffff
v_exp_f32 v172, v172
v_mfma_f32_16x16x32_bf16 a[64:67], a[224:227], v[216:219], a[64:67]
v_exp_f32 v173, v173
v_mfma_f32_16x16x32_bf16 a[64:67], a[192:195], v[200:203], a[64:67]
s_nop 0
ds_read_b128 a[168:171], v2 offset:26624
ds_read_b128 a[172:175], v2 offset:27648
v_mfma_f32_16x16x32_bf16 a[68:71], a[196:199], v[200:203], a[68:71]
v_exp_f32 v174, v174
v_mfma_f32_16x16x32_bf16 a[68:71], a[228:231], v[216:219], a[68:71]
v_exp_f32 v175, v175
v_mfma_f32_16x16x32_bf16 a[72:75], a[232:235], v[216:219], a[72:75]
buffer_store_dwordx4 v[128:131], v1, s[44:47], s70 offen sc1
v_mfma_f32_16x16x32_bf16 a[72:75], a[200:203], v[200:203], a[72:75]
s_nop 0
ds_read_b128 a[176:179], v2 offset:28672
ds_read_b128 a[180:183], v2 offset:29696
v_mfma_f32_16x16x32_bf16 a[76:79], a[204:207], v[200:203], a[76:79]
v_exp_f32 v188, v188
v_mfma_f32_16x16x32_bf16 a[76:79], a[236:239], v[216:219], a[76:79]
s_nop 0
ds_read_b128 a[184:187], v2 offset:30720
ds_read_b128 a[188:191], v2 offset:31744
v_mfma_f32_16x16x32_bf16 a[80:83], a[240:243], v[216:219], a[80:83]
s_waitcnt lgkmcnt(8)
ds_read_b128 a[224:227], v2 offset:8192
ds_read_b128 a[228:231], v2 offset:9216
v_mfma_f32_16x16x32_bf16 a[80:83], a[208:211], v[200:203], a[80:83]
s_nop 0
ds_read_b128 a[232:235], v2 offset:10240
ds_read_b128 a[236:239], v2 offset:11264
v_mfma_f32_16x16x32_bf16 a[84:87], a[212:215], v[200:203], a[84:87]
ds_read_b128 a[240:243], v2 offset:12288
v_cvt_pk_bf16_f32 v220, v172, v173
v_mfma_f32_16x16x32_bf16 a[84:87], a[244:247], v[216:219], a[84:87]
v_exp_f32 v189, v189
v_mfma_f32_16x16x32_bf16 a[88:91], a[248:251], v[216:219], a[88:91]
v_exp_f32 v190, v190
v_mfma_f32_16x16x32_bf16 a[88:91], a[216:219], v[200:203], a[88:91]
s_nop 0
ds_read_b128 a[244:247], v2 offset:13312
ds_read_b128 a[248:251], v2 offset:14336
v_mfma_f32_16x16x32_bf16 a[92:95], a[220:223], v[200:203], a[92:95]
v_cvt_pk_bf16_f32 v221, v174, v175
v_cvt_pk_bf16_f32 v222, v188, v189
v_mfma_f32_16x16x32_bf16 a[92:95], a[252:255], v[216:219], a[92:95]
v_exp_f32 v191, v191
s_cmp_eq_u32 s58, 0
s_cbranch_scc1 Lta49
s_cmp_eq_u32 s58, 1
s_cbranch_scc1 Lnt50
v_mfma_f32_16x16x32_bf16 v[140:143], a[128:131], v[64:67], v[92:95]
v_exp_f32 v168, v168
v_mfma_f32_16x16x32_bf16 v[156:159], a[144:147], v[64:67], v[92:95]
buffer_store_dwordx4 v[144:147], v1, s[44:47], s70 offen offset:1024 sc1
s_branch Ljoin51
Lta49:
v_mfma_f32_16x16x32_bf16 v[140:143], a[128:131], v[64:67], v[108:111]
v_exp_f32 v168, v168
v_mfma_f32_16x16x32_bf16 v[156:159], a[144:147], v[64:67], v[112:115]
buffer_store_dwordx4 v[144:147], v1, s[44:47], s70 offen offset:1024 sc1
s_branch Ljoin51
Lnt50:
v_mfma_f32_16x16x32_bf16 v[140:143], a[128:131], v[64:67], v[92:95]
v_exp_f32 v168, v168
v_mfma_f32_16x16x32_bf16 v[156:159], a[144:147], v[64:67], v[108:111]
buffer_store_dwordx4 v[144:147], v1, s[44:47], s70 offen offset:1024 sc1
Ljoin51:
v_mfma_f32_16x16x32_bf16 v[140:143], a[132:135], v[68:71], v[140:143]
v_exp_f32 v169, v169
v_mfma_f32_16x16x32_bf16 v[140:143], a[136:139], v[72:75], v[140:143]
v_exp_f32 v170, v170
v_mfma_f32_16x16x32_bf16 v[140:143], a[140:143], v[76:79], v[140:143]
buffer_store_dwordx4 v[160:163], v1, s[44:47], s70 offen offset:2048 sc1
v_mfma_f32_16x16x32_bf16 v[156:159], a[156:159], v[76:79], v[156:159]
ds_read_b128 a[252:255], v2 offset:15360
v_cvt_pk_bf16_f32 v223, v190, v191
v_mfma_f32_16x16x32_bf16 v[156:159], a[152:155], v[72:75], v[156:159]
s_waitcnt vmcnt(24) lgkmcnt(4)
v_exp_f32 v171, v171
v_mfma_f32_16x16x32_bf16 v[156:159], a[148:151], v[68:71], v[156:159]
s_barrier
v_exp_f32 v184, v184
v_add_u32 v2, s82, v1
v_cvt_pk_bf16_f32 v216, v168, v169
v_cvt_pk_bf16_f32 v217, v170, v171
v_exp_f32 v185, v185
v_exp_f32 v186, v186
v_cvt_pk_bf16_f32 v218, v184, v185
v_exp_f32 v187, v187
s_nop 0
v_cvt_pk_bf16_f32 v219, v186, v187
v_mfma_f32_16x16x32_bf16 v[236:239], v[120:123], v[204:207], v[236:239]
s_add_u32 s78, s59, 4
v_exp_f32 v140, v140
v_mfma_f32_16x16x32_bf16 v[236:239], v[120:123], v[220:223], v[236:239]
s_and_b32 s78, s78, 12
v_exp_f32 v141, v141
v_mfma_f32_16x16x32_bf16 a[96:99], a[192:195], v[204:207], a[96:99]
s_lshl_b32 s78, s78, 1
ds_read_b128 a[192:195], v2 offset:0
v_mfma_f32_16x16x32_bf16 a[96:99], a[224:227], v[220:223], a[96:99]
s_lshr_b32 s79, 0x67234501, s78
buffer_store_dwordx4 v[176:179], v1, s[44:47], s70 offen offset:3072 sc1
v_mfma_f32_16x16x32_bf16 a[100:103], a[228:231], v[220:223], a[100:103]
s_add_u32 s70, s70, 0x80000
v_exp_f32 v142, v142
v_mfma_f32_16x16x32_bf16 a[100:103], a[196:199], v[204:207], a[100:103]
s_and_b32 s79, s79, 7
ds_read_b128 a[196:199], v2 offset:1024
v_mfma_f32_16x16x32_bf16 a[104:107], a[200:203], v[204:207], a[104:107]
s_lshl_b32 s79, s79, 18
ds_read_b128 a[200:203], v2 offset:2048
v_mfma_f32_16x16x32_bf16 a[104:107], a[232:235], v[220:223], a[104:107]
s_add_u32 s79, s79, s94
v_exp_f32 v143, v143
v_mfma_f32_16x16x32_bf16 a[108:111], a[236:239], v[220:223], a[108:111]
s_add_u32 s12, s61, 0
v_exp_f32 v156, v156
v_mfma_f32_16x16x32_bf16 a[108:111], a[204:207], v[204:207], a[108:111]
s_and_b32 s12, s12, 3
ds_read_b128 a[204:207], v2 offset:3072
v_mfma_f32_16x16x32_bf16 a[112:115], a[208:211], v[204:207], a[112:115]
s_waitcnt lgkmcnt(4)
ds_read_b128 a[208:211], v2 offset:4096
v_mfma_f32_16x16x32_bf16 a[112:115], a[240:243], v[220:223], a[112:115]
s_lshl_b32 s12, s12, 21
buffer_store_dwordx4 v[132:135], v1, s[44:47], s70 offen sc1
v_mfma_f32_16x16x32_bf16 a[116:119], a[244:247], v[220:223], a[116:119]
s_add_u32 s12, s12, s79
v_exp_f32 v157, v157
v_mfma_f32_16x16x32_bf16 a[116:119], a[212:215], v[204:207], a[116:119]
s_add_u32 s13, s61, 1
ds_read_b128 a[212:215], v2 offset:5120
v_mfma_f32_16x16x32_bf16 a[120:123], a[216:219], v[204:207], a[120:123]
s_and_b32 s13, s13, 3
v_exp_f32 v158, v158
v_mfma_f32_16x16x32_bf16 a[120:123], a[248:251], v[220:223], a[120:123]
s_lshl_b32 s13, s13, 21
ds_read_b128 a[216:219], v2 offset:6144
v_mfma_f32_16x16x32_bf16 a[124:127], a[252:255], v[220:223], a[124:127]
s_add_u32 s13, s13, s79
buffer_store_dwordx4 v[148:151], v1, s[44:47], s70 offen offset:1024 sc1
v_mfma_f32_16x16x32_bf16 a[124:127], a[220:223], v[204:207], a[124:127]
s_add_u32 s14, s61, 2
ds_read_b128 a[220:223], v2 offset:7168
v_cvt_pk_bf16_f32 v204, v140, v141
s_cmp_eq_u32 s58, 2
s_cbranch_scc1 Lta52
s_cmp_eq_u32 s58, 3
s_cbranch_scc1 Lnt53
v_mfma_f32_16x16x32_bf16 v[172:175], a[160:163], v[64:67], v[112:115]
s_and_b32 s14, s14, 3
v_cvt_pk_bf16_f32 v205, v142, v143
v_cvt_pk_bf16_f32 v206, v156, v157
v_mfma_f32_16x16x32_bf16 v[188:191], a[176:179], v[64:67], v[112:115]
s_lshl_b32 s14, s14, 21
v_exp_f32 v159, v159
s_branch Ljoin54
Lta52:
v_mfma_f32_16x16x32_bf16 v[172:175], a[160:163], v[64:67], v[108:111]
s_and_b32 s14, s14, 3
v_cvt_pk_bf16_f32 v205, v142, v143
v_cvt_pk_bf16_f32 v206, v156, v157
v_mfma_f32_16x16x32_bf16 v[188:191], a[176:179], v[64:67], v[112:115]
s_lshl_b32 s14, s14, 21
v_exp_f32 v159, v159
s_branch Ljoin54
Lnt53:
v_mfma_f32_16x16x32_bf16 v[172:175], a[160:163], v[64:67], v[92:95]
s_and_b32 s14, s14, 3
v_cvt_pk_bf16_f32 v205, v142, v143
v_cvt_pk_bf16_f32 v206, v156, v157
v_mfma_f32_16x16x32_bf16 v[188:191], a[176:179], v[64:67], v[108:111]
s_lshl_b32 s14, s14, 21
v_exp_f32 v159, v159
Ljoin54:
v_mfma_f32_16x16x32_bf16 v[172:175], a[164:167], v[68:71], v[172:175]
s_add_u32 s14, s14, s79
v_cvt_pk_bf16_f32 v207, v158, v159
v_mfma_f32_16x16x32_bf16 v[172:175], a[168:171], v[72:75], v[172:175]
s_add_u32 s15, s61, 3
v_mfma_f32_16x16x32_bf16 v[172:175], a[172:175], v[76:79], v[172:175]
s_and_b32 s15, s15, 3
v_mfma_f32_16x16x32_bf16 v[188:191], a[188:191], v[76:79], v[188:191]
s_lshl_b32 s15, s15, 21
v_mfma_f32_16x16x32_bf16 v[188:191], a[184:187], v[72:75], v[188:191]
s_add_u32 s15, s15, s79
v_mfma_f32_16x16x32_bf16 v[188:191], a[180:183], v[68:71], v[188:191]
s_waitcnt lgkmcnt(4)
v_mfma_f32_16x16x32_bf16 v[232:235], v[120:123], v[216:219], v[232:235]
s_add_u32 s82, s82, 0x8000
v_exp_f32 v172, v172
v_mfma_f32_16x16x32_bf16 a[64:67], a[224:227], v[216:219], a[64:67]
s_and_b32 s82, s82, 0x1ffff
ds_read_b128 a[224:227], v2 offset:8192
v_mfma_f32_16x16x32_bf16 a[68:71], a[228:231], v[216:219], a[68:71]
ds_read_b128 a[228:231], v2 offset:9216
v_mfma_f32_16x16x32_bf16 a[72:75], a[232:235], v[216:219], a[72:75]
ds_read_b128 a[232:235], v2 offset:10240
v_mfma_f32_16x16x32_bf16 a[76:79], a[236:239], v[216:219], a[76:79]
buffer_store_dwordx4 v[164:167], v1, s[44:47], s70 offen offset:2048 sc1
v_mfma_f32_16x16x32_bf16 a[80:83], a[240:243], v[216:219], a[80:83]
s_nop 0
ds_read_b128 a[236:239], v2 offset:11264
ds_read_b128 a[240:243], v2 offset:12288
v_mfma_f32_16x16x32_bf16 a[84:87], a[244:247], v[216:219], a[84:87]
ds_read_b128 a[244:247], v2 offset:13312
v_mfma_f32_16x16x32_bf16 a[88:91], a[248:251], v[216:219], a[88:91]
v_exp_f32 v173, v173
v_mfma_f32_16x16x32_bf16 a[92:95], a[252:255], v[216:219], a[92:95]
v_exp_f32 v174, v174
ds_read_b128 a[248:251], v2 offset:14336
ds_read_b128 a[252:255], v2 offset:15360
v_add_u32 v2, s82, v1
buffer_store_dwordx4 v[180:183], v1, s[44:47], s70 offen offset:3072 sc1
v_cvt_pk_bf16_f32 v220, v172, v173
v_exp_f32 v175, v175
v_exp_f32 v188, v188
v_cvt_pk_bf16_f32 v221, v174, v175
v_exp_f32 v189, v189
v_exp_f32 v190, v190
v_cvt_pk_bf16_f32 v222, v188, v189
v_exp_f32 v191, v191
s_nop 0
v_cvt_pk_bf16_f32 v223, v190, v191
s_waitcnt vmcnt(8) lgkmcnt(0)
s_barrier
s_branch LHT4
Lslow:
s_waitcnt vmcnt(0) lgkmcnt(0)
s_barrier
s_mov_b32 s86, 1
s_lshl_b32 s81, s59, 20
s_add_u32 s81, s81, s64
s_sub_u32 s81, s81, 0x4000
s_mov_b32 s83, 0
s_lshl_b32 s75, s60, 3
s_sub_u32 s76, 128, s75
s_add_u32 s74, s75, s58
s_sub_u32 s75, s76, 8
s_add_u32 s75, s75, s58
v_mov_b32 v2, v1
v_lshrrev_b32 v240, 4, v0
v_and_b32 v241, 15, v0
v_lshlrev_b32 v240, 2, v240
v_sub_u32 v240, v241, v240
v_mov_b32 v112, 0xff800000
v_mov_b32 v113, 0xff800000
v_mov_b32 v114, 0xff800000
v_mov_b32 v115, 0xff800000
v_cmp_gt_i32 vcc, 0, v240
v_mov_b32 v120, 0x3f803f80
s_nop 0
v_cndmask_b32 v116, 0, v112, vcc
v_cmp_gt_i32 vcc, 1, v240
v_mov_b32 v121, 0x3f803f80
s_nop 0
v_cndmask_b32 v117, 0, v112, vcc
v_cmp_gt_i32 vcc, 2, v240
v_mov_b32 v122, 0x3f803f80
s_nop 0
v_cndmask_b32 v118, 0, v112, vcc
v_cmp_gt_i32 vcc, 3, v240
v_mov_b32 v123, 0x3f803f80
s_nop 0
v_cndmask_b32 v119, 0, v112, vcc
Lslow1:
s_add_u32 m0, s64, 16384
s_add_u32 s72, s81, 16384
buffer_load_dwordx4 v1, s[44:47], s72 offen sc1 lds
buffer_load_dwordx4 v1, s[44:47], s72 offen offset:1024 sc1 lds
buffer_load_dwordx4 v1, s[44:47], s72 offen offset:2048 sc1 lds
buffer_load_dwordx4 v1, s[44:47], s72 offen offset:3072 sc1 lds
s_add_u32 s81, s81, 0x8000
s_waitcnt vmcnt(0)
s_barrier
ds_read_b128 a[128:131], v2 offset:16384
ds_read_b128 a[132:135], v2 offset:17408
ds_read_b128 a[136:139], v2 offset:18432
ds_read_b128 a[140:143], v2 offset:19456
ds_read_b128 a[144:147], v2 offset:20480
ds_read_b128 a[148:151], v2 offset:21504
ds_read_b128 a[152:155], v2 offset:22528
ds_read_b128 a[156:159], v2 offset:23552
s_waitcnt lgkmcnt(0)
s_add_u32 s73, s74, 0
s_cmp_lt_u32 s73, s83
s_cbranch_scc1 Lsa55
s_cmp_eq_u32 s73, s83
s_cbranch_scc1 Lst56
v_mfma_f32_16x16x32_bf16 v[128:131], a[128:131], v[16:19], 0
s_branch Lsj57
Lst56:
v_mfma_f32_16x16x32_bf16 v[128:131], a[128:131], v[16:19], v[116:119]
Lsj57:
v_mfma_f32_16x16x32_bf16 v[128:131], a[132:135], v[20:23], v[128:131]
v_mfma_f32_16x16x32_bf16 v[128:131], a[136:139], v[24:27], v[128:131]
v_mfma_f32_16x16x32_bf16 v[128:131], a[140:143], v[28:31], v[128:131]
s_nop 7
v_max3_f32 v124, v124, v128, v129
v_max3_f32 v124, v124, v130, v131
Lsa55:
s_add_u32 s73, s74, 4
s_cmp_lt_u32 s73, s83
s_cbranch_scc1 Lsa58
s_cmp_eq_u32 s73, s83
s_cbranch_scc1 Lst59
v_mfma_f32_16x16x32_bf16 v[132:135], a[128:131], v[32:35], 0
s_branch Lsj60
Lst59:
v_mfma_f32_16x16x32_bf16 v[132:135], a[128:131], v[32:35], v[116:119]
Lsj60:
v_mfma_f32_16x16x32_bf16 v[132:135], a[132:135], v[36:39], v[132:135]
v_mfma_f32_16x16x32_bf16 v[132:135], a[136:139], v[40:43], v[132:135]
v_mfma_f32_16x16x32_bf16 v[132:135], a[140:143], v[44:47], v[132:135]
s_nop 7
v_max3_f32 v125, v125, v132, v133
v_max3_f32 v125, v125, v134, v135
Lsa58:
s_add_u32 s73, s75, 0
s_cmp_lt_u32 s73, s83
s_cbranch_scc1 Lsa61
s_cmp_eq_u32 s73, s83
s_cbranch_scc1 Lst62
v_mfma_f32_16x16x32_bf16 v[136:139], a[128:131], v[48:51], 0
s_branch Lsj63
Lst62:
v_mfma_f32_16x16x32_bf16 v[136:139], a[128:131], v[48:51], v[116:119]
Lsj63:
v_mfma_f32_16x16x32_bf16 v[136:139], a[132:135], v[52:55], v[136:139]
v_mfma_f32_16x16x32_bf16 v[136:139], a[136:139], v[56:59], v[136:139]
v_mfma_f32_16x16x32_bf16 v[136:139], a[140:143], v[60:63], v[136:139]
s_nop 7
v_max3_f32 v126, v126, v136, v137
v_max3_f32 v126, v126, v138, v139
Lsa61:
s_add_u32 s73, s75, 4
s_cmp_lt_u32 s73, s83
s_cbranch_scc1 Lsa64
s_cmp_eq_u32 s73, s83
s_cbranch_scc1 Lst65
v_mfma_f32_16x16x32_bf16 v[140:143], a[128:131], v[64:67], 0
s_branch Lsj66
Lst65:
v_mfma_f32_16x16x32_bf16 v[140:143], a[128:131], v[64:67], v[116:119]
Lsj66:
v_mfma_f32_16x16x32_bf16 v[140:143], a[132:135], v[68:71], v[140:143]
v_mfma_f32_16x16x32_bf16 v[140:143], a[136:139], v[72:75], v[140:143]
v_mfma_f32_16x16x32_bf16 v[140:143], a[140:143], v[76:79], v[140:143]
s_nop 7
v_max3_f32 v127, v127, v140, v141
v_max3_f32 v127, v127, v142, v143
Lsa64:
s_add_u32 s83, s83, 1
s_add_u32 s73, s74, 0
s_cmp_lt_u32 s73, s83
s_cbranch_scc1 Lsa67
s_cmp_eq_u32 s73, s83
s_cbranch_scc1 Lst68
v_mfma_f32_16x16x32_bf16 v[144:147], a[144:147], v[16:19], 0
s_branch Lsj69
Lst68:
v_mfma_f32_16x16x32_bf16 v[144:147], a[144:147], v[16:19], v[116:119]
Lsj69:
v_mfma_f32_16x16x32_bf16 v[144:147], a[148:151], v[20:23], v[144:147]
v_mfma_f32_16x16x32_bf16 v[144:147], a[152:155], v[24:27], v[144:147]
v_mfma_f32_16x16x32_bf16 v[144:147], a[156:159], v[28:31], v[144:147]
s_nop 7
v_max3_f32 v124, v124, v144, v145
v_max3_f32 v124, v124, v146, v147
Lsa67:
s_add_u32 s73, s74, 4
s_cmp_lt_u32 s73, s83
s_cbranch_scc1 Lsa70
s_cmp_eq_u32 s73, s83
s_cbranch_scc1 Lst71
v_mfma_f32_16x16x32_bf16 v[148:151], a[144:147], v[32:35], 0
s_branch Lsj72
Lst71:
v_mfma_f32_16x16x32_bf16 v[148:151], a[144:147], v[32:35], v[116:119]
Lsj72:
v_mfma_f32_16x16x32_bf16 v[148:151], a[148:151], v[36:39], v[148:151]
v_mfma_f32_16x16x32_bf16 v[148:151], a[152:155], v[40:43], v[148:151]
v_mfma_f32_16x16x32_bf16 v[148:151], a[156:159], v[44:47], v[148:151]
s_nop 7
v_max3_f32 v125, v125, v148, v149
v_max3_f32 v125, v125, v150, v151
Lsa70:
s_add_u32 s73, s75, 0
s_cmp_lt_u32 s73, s83
s_cbranch_scc1 Lsa73
s_cmp_eq_u32 s73, s83
s_cbranch_scc1 Lst74
v_mfma_f32_16x16x32_bf16 v[152:155], a[144:147], v[48:51], 0
s_branch Lsj75
Lst74:
v_mfma_f32_16x16x32_bf16 v[152:155], a[144:147], v[48:51], v[116:119]
Lsj75:
v_mfma_f32_16x16x32_bf16 v[152:155], a[148:151], v[52:55], v[152:155]
v_mfma_f32_16x16x32_bf16 v[152:155], a[152:155], v[56:59], v[152:155]
v_mfma_f32_16x16x32_bf16 v[152:155], a[156:159], v[60:63], v[152:155]
s_nop 7
v_max3_f32 v126, v126, v152, v153
v_max3_f32 v126, v126, v154, v155
Lsa73:
s_add_u32 s73, s75, 4
s_cmp_lt_u32 s73, s83
s_cbranch_scc1 Lsa76
s_cmp_eq_u32 s73, s83
s_cbranch_scc1 Lst77
v_mfma_f32_16x16x32_bf16 v[156:159], a[144:147], v[64:67], 0
s_branch Lsj78
Lst77:
v_mfma_f32_16x16x32_bf16 v[156:159], a[144:147], v[64:67], v[116:119]
Lsj78:
v_mfma_f32_16x16x32_bf16 v[156:159], a[148:151], v[68:71], v[156:159]
v_mfma_f32_16x16x32_bf16 v[156:159], a[152:155], v[72:75], v[156:159]
v_mfma_f32_16x16x32_bf16 v[156:159], a[156:159], v[76:79], v[156:159]
s_nop 7
v_max3_f32 v127, v127, v156, v157
v_max3_f32 v127, v127, v158, v159
Lsa76:
s_add_u32 s83, s83, 1
ds_read_b128 a[128:131], v2 offset:24576
ds_read_b128 a[132:135], v2 offset:25600
ds_read_b128 a[136:139], v2 offset:26624
ds_read_b128 a[140:143], v2 offset:27648
ds_read_b128 a[144:147], v2 offset:28672
ds_read_b128 a[148:151], v2 offset:29696
ds_read_b128 a[152:155], v2 offset:30720
ds_read_b128 a[156:159], v2 offset:31744
s_waitcnt lgkmcnt(0)
s_add_u32 s73, s74, 0
s_cmp_lt_u32 s73, s83
s_cbranch_scc1 Lsa79
s_cmp_eq_u32 s73, s83
s_cbranch_scc1 Lst80
v_mfma_f32_16x16x32_bf16 v[128:131], a[128:131], v[16:19], 0
s_branch Lsj81
Lst80:
v_mfma_f32_16x16x32_bf16 v[128:131], a[128:131], v[16:19], v[116:119]
Lsj81:
v_mfma_f32_16x16x32_bf16 v[128:131], a[132:135], v[20:23], v[128:131]
v_mfma_f32_16x16x32_bf16 v[128:131], a[136:139], v[24:27], v[128:131]
v_mfma_f32_16x16x32_bf16 v[128:131], a[140:143], v[28:31], v[128:131]
s_nop 7
v_max3_f32 v124, v124, v128, v129
v_max3_f32 v124, v124, v130, v131
Lsa79:
s_add_u32 s73, s74, 4
s_cmp_lt_u32 s73, s83
s_cbranch_scc1 Lsa82
s_cmp_eq_u32 s73, s83
s_cbranch_scc1 Lst83
v_mfma_f32_16x16x32_bf16 v[132:135], a[128:131], v[32:35], 0
s_branch Lsj84
Lst83:
v_mfma_f32_16x16x32_bf16 v[132:135], a[128:131], v[32:35], v[116:119]
Lsj84:
v_mfma_f32_16x16x32_bf16 v[132:135], a[132:135], v[36:39], v[132:135]
v_mfma_f32_16x16x32_bf16 v[132:135], a[136:139], v[40:43], v[132:135]
v_mfma_f32_16x16x32_bf16 v[132:135], a[140:143], v[44:47], v[132:135]
s_nop 7
v_max3_f32 v125, v125, v132, v133
v_max3_f32 v125, v125, v134, v135
Lsa82:
s_add_u32 s73, s75, 0
s_cmp_lt_u32 s73, s83
s_cbranch_scc1 Lsa85
s_cmp_eq_u32 s73, s83
s_cbranch_scc1 Lst86
v_mfma_f32_16x16x32_bf16 v[136:139], a[128:131], v[48:51], 0
s_branch Lsj87
Lst86:
v_mfma_f32_16x16x32_bf16 v[136:139], a[128:131], v[48:51], v[116:119]
Lsj87:
v_mfma_f32_16x16x32_bf16 v[136:139], a[132:135], v[52:55], v[136:139]
v_mfma_f32_16x16x32_bf16 v[136:139], a[136:139], v[56:59], v[136:139]
v_mfma_f32_16x16x32_bf16 v[136:139], a[140:143], v[60:63], v[136:139]
s_nop 7
v_max3_f32 v126, v126, v136, v137
v_max3_f32 v126, v126, v138, v139
Lsa85:
s_add_u32 s73, s75, 4
s_cmp_lt_u32 s73, s83
s_cbranch_scc1 Lsa88
s_cmp_eq_u32 s73, s83
s_cbranch_scc1 Lst89
v_mfma_f32_16x16x32_bf16 v[140:143], a[128:131], v[64:67], 0
s_branch Lsj90
Lst89:
v_mfma_f32_16x16x32_bf16 v[140:143], a[128:131], v[64:67], v[116:119]
Lsj90:
v_mfma_f32_16x16x32_bf16 v[140:143], a[132:135], v[68:71], v[140:143]
v_mfma_f32_16x16x32_bf16 v[140:143], a[136:139], v[72:75], v[140:143]
v_mfma_f32_16x16x32_bf16 v[140:143], a[140:143], v[76:79], v[140:143]
s_nop 7
v_max3_f32 v127, v127, v140, v141
v_max3_f32 v127, v127, v142, v143
Lsa88:
s_add_u32 s83, s83, 1
s_add_u32 s73, s74, 0
s_cmp_lt_u32 s73, s83
s_cbranch_scc1 Lsa91
s_cmp_eq_u32 s73, s83
s_cbranch_scc1 Lst92
v_mfma_f32_16x16x32_bf16 v[144:147], a[144:147], v[16:19], 0
s_branch Lsj93
Lst92:
v_mfma_f32_16x16x32_bf16 v[144:147], a[144:147], v[16:19], v[116:119]
Lsj93:
v_mfma_f32_16x16x32_bf16 v[144:147], a[148:151], v[20:23], v[144:147]
v_mfma_f32_16x16x32_bf16 v[144:147], a[152:155], v[24:27], v[144:147]
v_mfma_f32_16x16x32_bf16 v[144:147], a[156:159], v[28:31], v[144:147]
s_nop 7
v_max3_f32 v124, v124, v144, v145
v_max3_f32 v124, v124, v146, v147
Lsa91:
s_add_u32 s73, s74, 4
s_cmp_lt_u32 s73, s83
s_cbranch_scc1 Lsa94
s_cmp_eq_u32 s73, s83
s_cbranch_scc1 Lst95
v_mfma_f32_16x16x32_bf16 v[148:151], a[144:147], v[32:35], 0
s_branch Lsj96
Lst95:
v_mfma_f32_16x16x32_bf16 v[148:151], a[144:147], v[32:35], v[116:119]
Lsj96:
v_mfma_f32_16x16x32_bf16 v[148:151], a[148:151], v[36:39], v[148:151]
v_mfma_f32_16x16x32_bf16 v[148:151], a[152:155], v[40:43], v[148:151]
v_mfma_f32_16x16x32_bf16 v[148:151], a[156:159], v[44:47], v[148:151]
s_nop 7
v_max3_f32 v125, v125, v148, v149
v_max3_f32 v125, v125, v150, v151
Lsa94:
s_add_u32 s73, s75, 0
s_cmp_lt_u32 s73, s83
s_cbranch_scc1 Lsa97
s_cmp_eq_u32 s73, s83
s_cbranch_scc1 Lst98
v_mfma_f32_16x16x32_bf16 v[152:155], a[144:147], v[48:51], 0
s_branch Lsj99
Lst98:
v_mfma_f32_16x16x32_bf16 v[152:155], a[144:147], v[48:51], v[116:119]
Lsj99:
v_mfma_f32_16x16x32_bf16 v[152:155], a[148:151], v[52:55], v[152:155]
v_mfma_f32_16x16x32_bf16 v[152:155], a[152:155], v[56:59], v[152:155]
v_mfma_f32_16x16x32_bf16 v[152:155], a[156:159], v[60:63], v[152:155]
s_nop 7
v_max3_f32 v126, v126, v152, v153
v_max3_f32 v126, v126, v154, v155
Lsa97:
s_add_u32 s73, s75, 4
s_cmp_lt_u32 s73, s83
s_cbranch_scc1 Lsa100
s_cmp_eq_u32 s73, s83
s_cbranch_scc1 Lst101
v_mfma_f32_16x16x32_bf16 v[156:159], a[144:147], v[64:67], 0
s_branch Lsj102
Lst101:
v_mfma_f32_16x16x32_bf16 v[156:159], a[144:147], v[64:67], v[116:119]
Lsj102:
v_mfma_f32_16x16x32_bf16 v[156:159], a[148:151], v[68:71], v[156:159]
v_mfma_f32_16x16x32_bf16 v[156:159], a[152:155], v[72:75], v[156:159]
v_mfma_f32_16x16x32_bf16 v[156:159], a[156:159], v[76:79], v[156:159]
s_nop 7
v_max3_f32 v127, v127, v156, v157
v_max3_f32 v127, v127, v158, v159
Lsa100:
s_add_u32 s83, s83, 1
s_barrier
s_cmp_lt_u32 s83, s76
s_cbranch_scc1 Lslow1
s_lshl_b32 s81, s59, 20
s_add_u32 s81, s81, s64
s_sub_u32 s81, s81, 0x4000
s_add_u32 m0, s64, 49152
s_add_u32 s72, s81, 16384
buffer_load_dwordx4 v1, s[44:47], s72 offen sc1 lds
buffer_load_dwordx4 v1, s[44:47], s72 offen offset:1024 sc1 lds
buffer_load_dwordx4 v1, s[44:47], s72 offen offset:2048 sc1 lds
buffer_load_dwordx4 v1, s[44:47], s72 offen offset:3072 sc1 lds
s_add_u32 s81, s81, 0x8000
s_add_u32 m0, s64, 81920
s_add_u32 s72, s81, 16384
buffer_load_dwordx4 v1, s[44:47], s72 offen sc1 lds
buffer_load_dwordx4 v1, s[44:47], s72 offen offset:1024 sc1 lds
buffer_load_dwordx4 v1, s[44:47], s72 offen offset:2048 sc1 lds
buffer_load_dwordx4 v1, s[44:47], s72 offen offset:3072 sc1 lds
s_add_u32 m0, s64, 65536
s_add_u32 s72, s81, 0
buffer_load_dwordx4 v1, s[44:47], s72 offen sc1 lds
buffer_load_dwordx4 v1, s[44:47], s72 offen offset:1024 sc1 lds
buffer_load_dwordx4 v1, s[44:47], s72 offen offset:2048 sc1 lds
buffer_load_dwordx4 v1, s[44:47], s72 offen offset:3072 sc1 lds
s_add_u32 s81, s81, 0x8000
s_add_u32 m0, s64, 114688
s_add_u32 s72, s81, 16384
buffer_load_dwordx4 v1, s[44:47], s72 offen sc1 lds
buffer_load_dwordx4 v1, s[44:47], s72 offen offset:1024 sc1 lds
buffer_load_dwordx4 v1, s[44:47], s72 offen offset:2048 sc1 lds
buffer_load_dwordx4 v1, s[44:47], s72 offen offset:3072 sc1 lds
s_add_u32 m0, s64, 98304
s_add_u32 s72, s81, 0
buffer_load_dwordx4 v1, s[44:47], s72 offen sc1 lds
buffer_load_dwordx4 v1, s[44:47], s72 offen offset:1024 sc1 lds
buffer_load_dwordx4 v1, s[44:47], s72 offen offset:2048 sc1 lds
buffer_load_dwordx4 v1, s[44:47], s72 offen offset:3072 sc1 lds
v_add_u32 v2, 0x8000, v1
v_lshrrev_b32 v3, 1, v0
v_lshlrev_b32 v3, 7, v3
s_waitcnt vmcnt(0)
s_barrier
v_accvgpr_write_b32 a32, 0
v_accvgpr_write_b32 a33, 0
v_accvgpr_write_b32 a34, 0
v_accvgpr_write_b32 a35, 0
v_accvgpr_write_b32 a36, 0
v_accvgpr_write_b32 a37, 0
v_accvgpr_write_b32 a38, 0
v_accvgpr_write_b32 a39, 0
v_accvgpr_write_b32 a40, 0
v_accvgpr_write_b32 a41, 0
v_accvgpr_write_b32 a42, 0
v_accvgpr_write_b32 a43, 0
v_accvgpr_write_b32 a44, 0
v_accvgpr_write_b32 a45, 0
v_accvgpr_write_b32 a46, 0
v_accvgpr_write_b32 a47, 0
v_accvgpr_write_b32 a48, 0
v_accvgpr_write_b32 a49, 0
v_accvgpr_write_b32 a50, 0
v_accvgpr_write_b32 a51, 0
v_accvgpr_write_b32 a52, 0
v_accvgpr_write_b32 a53, 0
v_accvgpr_write_b32 a54, 0
v_accvgpr_write_b32 a55, 0
v_accvgpr_write_b32 a56, 0
v_accvgpr_write_b32 a57, 0
v_accvgpr_write_b32 a58, 0
v_accvgpr_write_b32 a59, 0
v_accvgpr_write_b32 a60, 0
v_accvgpr_write_b32 a61, 0
v_accvgpr_write_b32 a62, 0
v_accvgpr_write_b32 a63, 0
v_accvgpr_write_b32 a96, 0
v_accvgpr_write_b32 a97, 0
v_accvgpr_write_b32 a98, 0
v_accvgpr_write_b32 a99, 0
v_accvgpr_write_b32 a100, 0
v_accvgpr_write_b32 a101, 0
v_accvgpr_write_b32 a102, 0
v_accvgpr_write_b32 a103, 0
v_accvgpr_write_b32 a104, 0
v_accvgpr_write_b32 a105, 0
v_accvgpr_write_b32 a106, 0
v_accvgpr_write_b32 a107, 0
v_accvgpr_write_b32 a108, 0
v_accvgpr_write_b32 a109, 0
v_accvgpr_write_b32 a110, 0
v_accvgpr_write_b32 a111, 0
v_accvgpr_write_b32 a112, 0
v_accvgpr_write_b32 a113, 0
v_accvgpr_write_b32 a114, 0
v_accvgpr_write_b32 a115, 0
v_accvgpr_write_b32 a116, 0
v_accvgpr_write_b32 a117, 0
v_accvgpr_write_b32 a118, 0
v_accvgpr_write_b32 a119, 0
v_accvgpr_write_b32 a120, 0
v_accvgpr_write_b32 a121, 0
v_accvgpr_write_b32 a122, 0
v_accvgpr_write_b32 a123, 0
v_accvgpr_write_b32 a124, 0
v_accvgpr_write_b32 a125, 0
v_accvgpr_write_b32 a126, 0
v_accvgpr_write_b32 a127, 0
ds_read_b128 a[128:131], v2 offset:16384
ds_read_b128 a[132:135], v2 offset:17408
ds_read_b128 a[136:139], v2 offset:18432
ds_read_b128 a[140:143], v2 offset:19456
ds_read_b128 a[144:147], v2 offset:20480
ds_read_b128 a[148:151], v2 offset:21504
ds_read_b128 a[152:155], v2 offset:22528
ds_read_b128 a[156:159], v2 offset:23552
s_branch Lattn
Lspin103:
s_mov_b32 s83, 262144
Lsl105:
s_sleep 2
buffer_load_dword v3, v2, s[44:47], s82 offen sc1
s_sub_u32 s83, s83, 1
s_cmp_eq_u32 s83, 0
s_waitcnt vmcnt(0)
s_cbranch_scc1 Lback104
v_cmp_gt_u32 vcc, 2, v3
s_cbranch_vccnz Lsl105
s_branch Lback104
Lspin106:
s_mov_b32 s83, 262144
Lsl108:
s_sleep 2
buffer_load_dword v3, v2, s[44:47], s82 offen sc1
s_sub_u32 s83, s83, 1
s_cmp_eq_u32 s83, 0
s_waitcnt vmcnt(0)
s_cbranch_scc1 Lback107
v_cmp_gt_u32 vcc, 2, v3
s_cbranch_vccnz Lsl108
s_branch Lback107
Lredo0:
s_xor_b32 s82, s78, 0
s_lshl_b32 s82, s82, 10
s_add_u32 s82, s82, s74
buffer_load_dword v3, v2, s[44:47], s82 offen sc1
s_waitcnt vmcnt(0)
v_cmp_gt_u32 vcc, 2, v3
s_cbranch_vccnz Lspin103
Lback104:
s_lshr_b32 s69, s12, 18
s_lshl_b32 s69, s69, 12
s_add_u32 s69, s69, s95
buffer_load_dwordx4 a[0:3], v1, s[44:47], s69 offen sc1
buffer_load_dwordx4 a[4:7], v1, s[44:47], s69 offen offset:1024 sc1
buffer_load_dwordx4 a[8:11], v1, s[44:47], s69 offen offset:2048 sc1
buffer_load_dwordx4 a[12:15], v1, s[44:47], s69 offen offset:3072 sc1
s_add_u32 s69, s69, 0x20000
buffer_load_dwordx4 a[16:19], v1, s[44:47], s69 offen sc1
buffer_load_dwordx4 a[20:23], v1, s[44:47], s69 offen offset:1024 sc1
buffer_load_dwordx4 a[24:27], v1, s[44:47], s69 offen offset:2048 sc1
buffer_load_dwordx4 a[28:31], v1, s[44:47], s69 offen offset:3072 sc1
s_lshr_b32 s69, s13, 18
s_lshl_b32 s69, s69, 12
s_add_u32 s69, s69, s95
buffer_load_dwordx4 a[32:35], v1, s[44:47], s69 offen sc1
buffer_load_dwordx4 a[36:39], v1, s[44:47], s69 offen offset:1024 sc1
buffer_load_dwordx4 a[40:43], v1, s[44:47], s69 offen offset:2048 sc1
buffer_load_dwordx4 a[44:47], v1, s[44:47], s69 offen offset:3072 sc1
s_add_u32 s69, s69, 0x20000
buffer_load_dwordx4 a[48:51], v1, s[44:47], s69 offen sc1
buffer_load_dwordx4 a[52:55], v1, s[44:47], s69 offen offset:1024 sc1
buffer_load_dwordx4 a[56:59], v1, s[44:47], s69 offen offset:2048 sc1
buffer_load_dwordx4 a[60:63], v1, s[44:47], s69 offen offset:3072 sc1
s_waitcnt vmcnt(8)
s_branch Lredo0b
Lspin109:
s_mov_b32 s83, 262144
Lsl111:
s_sleep 2
buffer_load_dword v114, v115, s[44:47], s84 offen sc1
s_sub_u32 s83, s83, 1
s_cmp_eq_u32 s83, 0
s_waitcnt vmcnt(0)
s_cbranch_scc1 Lback110
v_cmp_gt_u32 vcc, 3, v114
s_cbranch_vccnz Lsl111
s_branch Lback110
Lspin112:
s_mov_b32 s83, 262144
Lsl114:
s_sleep 2
buffer_load_dword v14, v13, s[44:47], s79 offen sc1
s_sub_u32 s83, s83, 1
s_cmp_eq_u32 s83, 0
s_waitcnt vmcnt(0)
s_cbranch_scc1 Lback113
v_cmp_gt_u32 vcc, 2, v14
s_cbranch_vccnz Lsl114
s_branch Lback113
Lxspin1:
s_mov_b32 s83, 262144
Lxsl1:
buffer_load_dwordx4 v[96:99], v1, s[44:47], s79 offen sc1
buffer_load_dwordx4 v[100:103], v1, s[44:47], s79 offen offset:1024 sc1
buffer_load_dwordx4 v[104:107], v1, s[44:47], s79 offen offset:2048 sc1
buffer_load_dwordx4 v[108:111], v1, s[44:47], s79 offen offset:3072 sc1
s_sub_u32 s83, s83, 1
s_cmp_eq_u32 s83, 0
s_waitcnt vmcnt(0)
s_cbranch_scc1 Lxback1
v_max3_u32 v12, v96, v97, v98
v_max3_u32 v13, v99, v100, v101
v_max3_u32 v12, v12, v102, v103
v_max3_u32 v13, v13, v104, v105
v_max3_u32 v12, v12, v106, v107
v_max3_u32 v13, v13, v108, v109
v_max3_u32 v12, v12, v110, v111
v_max_u32 v12, v12, v13
v_cmp_le_u32 vcc, 0xff800000, v12
s_cbranch_vccnz Lxsl1
s_branch Lxback1
Lxspin2:
s_mov_b32 s83, 262144
Lxsl2:
buffer_load_dwordx4 v[80:83], v1, s[44:47], s82 offen sc1
buffer_load_dwordx4 v[84:87], v1, s[44:47], s82 offen offset:1024 sc1
buffer_load_dwordx4 v[88:91], v1, s[44:47], s82 offen offset:2048 sc1
buffer_load_dwordx4 v[92:95], v1, s[44:47], s82 offen offset:3072 sc1
s_sub_u32 s83, s83, 1
s_cmp_eq_u32 s83, 0
s_waitcnt vmcnt(0)
s_cbranch_scc1 Lxback2
v_max3_u32 v12, v80, v81, v82
v_max3_u32 v13, v83, v84, v85
v_max3_u32 v12, v12, v86, v87
v_max3_u32 v13, v13, v88, v89
v_max3_u32 v12, v12, v90, v91
v_max3_u32 v13, v13, v92, v93
v_max3_u32 v12, v12, v94, v95
v_max_u32 v12, v12, v13
v_cmp_le_u32 vcc, 0xff800000, v12
s_cbranch_vccnz Lxsl2
s_branch Lxback2
Lxspin3:
s_mov_b32 s83, 262144
Lxsl3:
buffer_load_dwordx4 v[96:99], v1, s[44:47], s81 offen sc1
buffer_load_dwordx4 v[100:103], v1, s[44:47], s81 offen offset:1024 sc1
buffer_load_dwordx4 v[104:107], v1, s[44:47], s81 offen offset:2048 sc1
buffer_load_dwordx4 v[108:111], v1, s[44:47], s81 offen offset:3072 sc1
s_sub_u32 s83, s83, 1
s_cmp_eq_u32 s83, 0
s_waitcnt vmcnt(0)
s_cbranch_scc1 Lxback3
v_max3_u32 v12, v96, v97, v98
v_max3_u32 v13, v99, v100, v101
v_max3_u32 v12, v12, v102, v103
v_max3_u32 v13, v13, v104, v105
v_max3_u32 v12, v12, v106, v107
v_max3_u32 v13, v13, v108, v109
v_max3_u32 v12, v12, v110, v111
v_max_u32 v12, v12, v13
v_cmp_le_u32 vcc, 0xff800000, v12
s_cbranch_vccnz Lxsl3
s_branch Lxback3
Lcode_end:
s_endpgm
.section .rodata,"a"
.p2align 6
.amdhsa_kernel gated_mix__compressed_kv_cla__ssm_conv_h3__prompt_kernel
  .amdhsa_next_free_vgpr 512
  .amdhsa_next_free_sgpr 102
  .amdhsa_accum_offset 256
  .amdhsa_group_segment_fixed_size 0
  .amdhsa_kernarg_size 128
  .amdhsa_user_sgpr_count 2
  .amdhsa_user_sgpr_kernarg_segment_ptr 1
  .amdhsa_system_sgpr_workgroup_id_x 1
  .amdhsa_float_denorm_mode_32 3
.end_amdhsa_kernel
```

```asm
; @launch grid=(256,1,1) block=(256,1,1) lds=163840
.amdgcn_target "amdgcn-amd-amdhsa--gfx950"
.text
.globl gated_mix__compressed_kv_cla__ssm_conv_h3__prompt_kernel
.p2align 8
.type gated_mix__compressed_kv_cla__ssm_conv_h3__prompt_kernel,@function
gated_mix__compressed_kv_cla__ssm_conv_h3__prompt_kernel:
s_cmp_ge_u32 s2, 256
s_cbranch_scc1 Lend
s_load_dwordx2 s[8:9], s[0:1], 8
s_load_dwordx2 s[16:17], s[0:1], 24
s_load_dwordx2 s[20:21], s[0:1], 32
s_load_dwordx2 s[4:5], s[0:1], 0
s_load_dwordx2 s[12:13], s[0:1], 16
s_load_dwordx2 s[24:25], s[0:1], 40
s_load_dwordx2 s[28:29], s[0:1], 56
s_load_dwordx2 s[32:33], s[0:1], 64
s_load_dwordx2 s[52:53], s[0:1], 72
s_load_dwordx2 s[36:37], s[0:1], 80
s_load_dwordx2 s[54:55], s[0:1], 88
s_load_dwordx2 s[56:57], s[0:1], 96
s_load_dwordx2 s[40:41], s[0:1], 104
s_load_dwordx2 s[48:49], s[0:1], 112
s_load_dwordx2 s[44:45], s[0:1], 120
s_getpc_b64 s[98:99]
Lpc0:
s_lshr_b32 s75, s2, 3
v_lshrrev_b32 v26, 3, v0
s_lshl_b32 s73, s75, 12
v_lshlrev_b32 v26, 7, v26
v_add_u32 v26, s73, v26
v_min_u32 v26, Lcode_end-Lpc0, v26
global_load_dword v31, v26, s[98:99]
v_lshrrev_b32 v26, 6, v0
v_and_b32 v0, 63, v0
s_and_b32 s73, s2, 7
v_readfirstlane_b32 s58, v26
s_lshr_b32 s65, s75, 3
s_and_b32 s60, s75, 7
s_lshl_b32 s59, s73, 2
s_add_u32 s59, s59, s65
s_lshl_b32 s61, s65, 1
s_lshl_b32 s63, s58, 13
s_lshl_b32 s64, s58, 12
s_lshl_b32 s67, s60, 18
s_lshl_b32 s76, s58, 16
s_add_u32 s84, s67, s76
s_lshl_b32 s66, s58, 17
s_lshl_b32 s73, s73, 2
s_lshr_b32 s73, 0x67234501, s73
s_and_b32 s73, s73, 7
s_lshl_b32 s74, s65, 3
s_add_u32 s73, s73, s74
s_lshl_b32 s73, s73, 8
s_add_u32 s66, s66, s73
v_lshrrev_b32 v26, 4, v0
v_and_b32 v27, 7, v0
v_xor_b32 v27, v27, v26
v_lshlrev_b32 v27, 4, v27
v_lshrrev_b32 v28, 3, v0
v_lshl_add_u32 v2, v28, 10, v27
v_xor_b32 v3, 64, v2
v_and_b32 v29, 15, v0
v_lshlrev_b32 v30, 1, v26
v_xor_b32 v30, v30, v29
v_lshlrev_b32 v30, 4, v30
v_lshl_add_u32 v6, v26, 13, v30
v_xor_b32 v7, 0x80, v6
s_mov_b32 s10, 0x200000
s_mov_b32 s11, 0x20000
s_mov_b32 s18, 0x400000
s_mov_b32 s19, 0x20000
s_mov_b32 s22, 0x400000
s_mov_b32 s23, 0x20000
s_lshl_b32 s73, s2, 2
s_add_u32 s73, s73, s58
s_lshl_b32 s73, s73, 11
v_lshrrev_b32 v124, 2, v0
v_lshlrev_b32 v124, 7, v124
v_add_u32 v124, s73, v124
s_lshr_b32 s73, s2, 3
s_lshl_b32 s73, s73, 2
s_add_u32 s73, s73, s58
s_lshl_b32 s73, s73, 13
s_and_b32 s74, s66, 0x700
s_add_u32 s73, s73, s74
v_lshrrev_b32 v125, 4, v0
v_lshlrev_b32 v125, 11, v125
v_bfe_u32 v126, v0, 3, 1
v_lshl_add_u32 v125, v126, 7, v125
v_add_u32 v125, s73, v125
s_waitcnt lgkmcnt(0)
s_mov_b32 s80, 0x0
buffer_load_dword v126, v125, s[16:19], s80 offen
buffer_load_dword v126, v125, s[20:23], s80 offen
s_and_b32 s73, s65, 1
s_xor_b32 s73, s73, 0
s_lshl_b32 s69, s73, 7
s_add_u32 s69, s69, s84
s_lshl_b32 s71, s73, 19
s_add_u32 s71, s71, s66
s_add_u32 m0, s63, 65536
s_add_u32 s72, s69, 0
buffer_load_dwordx4 v2, s[8:11], s72 offen lds
s_add_u32 s72, s69, 7168
buffer_load_dwordx4 v3, s[8:11], s72 offen offset:1024 lds
s_add_u32 s72, s69, 14336
buffer_load_dwordx4 v2, s[8:11], s72 offen offset:2048 lds
s_add_u32 s72, s69, 21504
buffer_load_dwordx4 v3, s[8:11], s72 offen offset:3072 lds
s_add_u32 m0, s64, 0
s_add_u32 s72, s71, 0
buffer_load_dwordx4 v6, s[16:19], s72 offen lds
s_add_u32 s72, s71, 31744
buffer_load_dwordx4 v6, s[16:19], s72 offen offset:1024 lds
s_add_u32 s72, s71, 63488
buffer_load_dwordx4 v7, s[16:19], s72 offen offset:2048 lds
s_add_u32 s72, s71, 95232
buffer_load_dwordx4 v7, s[16:19], s72 offen offset:3072 lds
s_add_u32 m0, s63, 69632
s_add_u32 s72, s69, 32768
buffer_load_dwordx4 v2, s[8:11], s72 offen lds
s_add_u32 s72, s69, 39936
buffer_load_dwordx4 v3, s[8:11], s72 offen offset:1024 lds
s_add_u32 s72, s69, 47104
buffer_load_dwordx4 v2, s[8:11], s72 offen offset:2048 lds
s_add_u32 s72, s69, 54272
buffer_load_dwordx4 v3, s[8:11], s72 offen offset:3072 lds
s_add_u32 m0, s64, 16384
s_add_u32 s72, s71, 0
buffer_load_dwordx4 v6, s[20:23], s72 offen lds
s_add_u32 s72, s71, 31744
buffer_load_dwordx4 v6, s[20:23], s72 offen offset:1024 lds
s_add_u32 s72, s71, 63488
buffer_load_dwordx4 v7, s[20:23], s72 offen offset:2048 lds
s_add_u32 s72, s71, 95232
buffer_load_dwordx4 v7, s[20:23], s72 offen offset:3072 lds
buffer_load_dword v126, v124, s[8:11], 0 offen
s_and_b32 s73, s65, 1
s_xor_b32 s73, s73, 1
s_lshl_b32 s69, s73, 7
s_add_u32 s69, s69, s84
s_lshl_b32 s71, s73, 19
s_add_u32 s71, s71, s66
s_add_u32 m0, s63, 98304
s_add_u32 s72, s69, 0
buffer_load_dwordx4 v2, s[8:11], s72 offen lds
s_add_u32 s72, s69, 7168
buffer_load_dwordx4 v3, s[8:11], s72 offen offset:1024 lds
s_add_u32 s72, s69, 14336
buffer_load_dwordx4 v2, s[8:11], s72 offen offset:2048 lds
s_add_u32 s72, s69, 21504
buffer_load_dwordx4 v3, s[8:11], s72 offen offset:3072 lds
s_branch Lmain
.p2align 12
Lmain:
s_mov_b32 s6, 0x400000
s_mov_b32 s7, 0x20000
s_mov_b32 s14, 0x800000
s_mov_b32 s15, 0x20000
s_mov_b32 s26, 0x800000
s_mov_b32 s27, 0x20000
s_mov_b32 s30, 0x400000
s_mov_b32 s31, 0x20000
s_mov_b32 s34, 0x400000
s_mov_b32 s35, 0x20000
s_mov_b32 s38, 0x400000
s_mov_b32 s39, 0x20000
s_mov_b32 s42, 0x400000
s_mov_b32 s43, 0x20000
s_mov_b32 s46, 0x5800000
s_mov_b32 s47, 0x20000
s_mov_b32 s50, 0x100
s_mov_b32 s51, 0x20000
v_lshl_add_u32 v4, v28, 11, v27
v_xor_b32 v5, 64, v4
v_lshlrev_b32 v1, 4, v0
s_sub_u32 s74, 15, s60
s_lshl_b32 s68, s74, 18
s_lshl_b32 s76, s58, 15
s_add_u32 s68, s68, s76
s_add_u32 s67, s67, s76
s_and_b32 s62, s60, 3
s_sub_u32 s62, 16, s62
s_lshl_b32 s91, s59, 3
s_add_u32 s91, s91, s60
s_lshl_b32 s93, s91, 2
s_add_u32 s93, s93, s58
s_lshl_b32 s91, s91, 7
s_add_u32 s91, s91, 0x3810000
s_lshl_b32 s75, s93, 1
s_and_b32 s75, s75, 0xffc
s_lshl_b32 s93, s93, 12
s_load_dwordx2 s[88:89], s[36:37], s93
s_load_dword s90, s[54:55], s75
v_or_b32 v29, s58, v0
v_mov_b32 v30, 0
v_min_u32 v29, 1, v29
v_lshlrev_b32 v29, 30, v29
buffer_store_dword v30, v29, s[44:47], s91 offen sc1
s_xor_b32 s73, s2, 5
s_and_b32 s73, s73, 15
s_lshr_b32 s74, s2, 4
s_lshl_b32 s74, s74, 7
s_lshl_b32 s75, s58, 5
s_add_u32 s74, s74, s75
s_mov_b32 s75, 131072
v_lshrrev_b32 v29, 5, v0
v_lshlrev_b32 v29, 4, v29
v_add_u32 v29, s74, v29
v_and_b32 v30, 31, v0
s_lshl_b32 s73, s73, 5
v_add_u32 v30, s73, v30
v_lshlrev_b32 v26, 11, v29
v_lshl_add_u32 v26, v30, 2, v26
v_subrev_u32 v27, 0x1800, v26
s_lshl_b32 s82, s74, 11
s_lshl_b32 s73, s73, 2
s_add_u32 s82, s82, s73
v_lshrrev_b32 v26, 3, v0
v_and_b32 v32, 7, v0
v_lshlrev_b32 v32, 4, v32
v_lshl_add_u32 v26, v26, 11, v32
v_lshrrev_b32 v98, 5, v0
v_lshlrev_b32 v98, 11, v98
v_and_b32 v32, 31, v0
v_lshl_add_u32 v98, v32, 2, v98
v_add_u32 v98, s63, v98
v_add_u32 v98, s75, v98
v_and_b32 v29, 0x7f, v29
v_sub_u32 v29, 0x70, v29
v_lshlrev_b32 v29, 1, v29
v_and_b32 v32, 31, v0
v_mul_u32_u24 v32, 544, v32
v_add3_u32 v28, v32, v29, s75
v_lshlrev_b32 v30, 4, v30
s_lshl_b32 s73, s2, 14
s_lshl_b32 s74, s58, 12
s_add_u32 s76, s73, s74
v_and_b32 v29, 15, v0
v_lshrrev_b32 v32, 4, v0
v_lshrrev_b32 v24, 1, v29
v_xor_b32 v24, v24, v32
v_lshlrev_b32 v24, 4, v24
v_lshl_add_u32 v24, v29, 7, v24
s_add_u32 s73, s63, 131072
v_add_u32 v16, s73, v24
v_xor_b32 v17, 64, v16
v_subrev_u32 v18, 0x10000, v16
v_subrev_u32 v19, 0x10000, v17
s_lshr_b32 s73, s58, 1
s_lshl_b32 s74, s73, 14
s_add_u32 s74, s74, 0x10000
v_add_u32 v24, s74, v24
v_xor_b32 v25, 64, v24
v_lshrrev_b32 v8, 2, v29
v_and_b32 v9, 1, v32
v_lshl_add_u32 v9, v9, 2, v8
v_lshl_add_u32 v8, v32, 3, v8
v_lshlrev_b32 v8, 8, v8
v_lshl_add_u32 v8, v9, 5, v8
v_and_b32 v29, 3, v0
v_lshl_add_u32 v8, v29, 3, v8
s_and_b32 s74, s58, 1
s_lshl_b32 s75, s74, 7
v_xor_b32 v20, s75, v8
v_xor_b32 v9, 32, v8
v_xor_b32 v10, 64, v8
v_xor_b32 v11, 96, v8
v_xor_b32 v12, 128, v8
v_xor_b32 v13, 160, v8
v_xor_b32 v14, 192, v8
v_xor_b32 v15, 224, v8
v_xor_b32 v21, 32, v20
v_xor_b32 v22, 64, v20
v_xor_b32 v23, 96, v20
s_lshl_b32 s77, s59, 20
s_add_u32 s81, s77, s64
s_sub_u32 s81, s81, 0x4000
s_lshl_b32 s75, s60, 17
s_add_u32 s77, s77, s75
s_lshl_b32 s73, s73, 16
s_add_u32 s77, s77, s73
s_lshl_b32 s75, s74, 12
s_add_u32 s78, s77, s75
s_add_u32 s78, s78, 0x4000
s_lshl_b32 s75, s74, 11
s_add_u32 s77, s77, s75
s_mov_b32 s79, 0x3e0293ee
s_waitcnt vmcnt(6)
s_barrier
ds_read_b64_tr_b16 v[224:225], v20 offset:0
ds_read_b64_tr_b16 v[226:227], v20 offset:1024
ds_read_b64_tr_b16 v[228:229], v20 offset:8192
ds_read_b64_tr_b16 v[230:231], v20 offset:9216
ds_read_b128 v[128:131], v24 offset:0
ds_read_b128 v[132:135], v25 offset:0
ds_read_b128 v[136:139], v24 offset:2048
ds_read_b128 v[140:143], v25 offset:2048
ds_read_b128 v[144:147], v24 offset:4096
ds_read_b128 v[148:151], v25 offset:4096
ds_read_b128 v[152:155], v24 offset:6144
ds_read_b128 v[156:159], v25 offset:6144
ds_read_b128 v[160:163], v24 offset:8192
ds_read_b128 v[164:167], v25 offset:8192
ds_read_b128 v[168:171], v24 offset:10240
ds_read_b128 v[172:175], v25 offset:10240
ds_read_b128 v[176:179], v24 offset:12288
ds_read_b128 v[180:183], v25 offset:12288
ds_read_b128 v[184:187], v24 offset:14336
ds_read_b128 v[188:191], v25 offset:14336
ds_read_b64_tr_b16 v[232:233], v21 offset:0
ds_read_b64_tr_b16 v[234:235], v21 offset:1024
ds_read_b64_tr_b16 v[236:237], v21 offset:8192
ds_read_b64_tr_b16 v[238:239], v21 offset:9216
s_waitcnt lgkmcnt(0)
v_mfma_f32_16x16x32_bf16 a[0:3], v[224:227], v[128:131], 0
s_add_u32 m0, s64, 32768
ds_read_b64_tr_b16 v[240:241], v22 offset:0
v_mfma_f32_16x16x32_bf16 a[0:3], v[228:231], v[132:135], a[0:3]
s_add_u32 s72, s71, 0
buffer_load_dwordx4 v6, s[16:19], s72 offen lds
v_mfma_f32_16x16x32_bf16 a[4:7], v[228:231], v[140:143], 0
s_add_u32 s72, s71, 31744
buffer_load_dwordx4 v6, s[16:19], s72 offen offset:1024 lds
v_mfma_f32_16x16x32_bf16 a[4:7], v[224:227], v[136:139], a[4:7]
ds_read_b64_tr_b16 v[242:243], v22 offset:1024
v_mfma_f32_16x16x32_bf16 a[8:11], v[224:227], v[144:147], 0
s_add_u32 s72, s71, 63488
buffer_load_dwordx4 v7, s[16:19], s72 offen offset:2048 lds
v_mfma_f32_16x16x32_bf16 a[8:11], v[228:231], v[148:151], a[8:11]
v_mfma_f32_16x16x32_bf16 a[12:15], v[228:231], v[156:159], 0
s_add_u32 s72, s71, 95232
buffer_load_dwordx4 v7, s[16:19], s72 offen offset:3072 lds
v_mfma_f32_16x16x32_bf16 a[12:15], v[224:227], v[152:155], a[12:15]
ds_read_b64_tr_b16 v[244:245], v22 offset:8192
v_mfma_f32_16x16x32_bf16 a[16:19], v[224:227], v[160:163], 0
s_add_u32 m0, s63, 102400
v_mfma_f32_16x16x32_bf16 a[16:19], v[228:231], v[164:167], a[16:19]
s_add_u32 s72, s69, 32768
buffer_load_dwordx4 v2, s[8:11], s72 offen lds
v_mfma_f32_16x16x32_bf16 a[20:23], v[228:231], v[172:175], 0
s_add_u32 s72, s69, 39936
buffer_load_dwordx4 v3, s[8:11], s72 offen offset:1024 lds
v_mfma_f32_16x16x32_bf16 a[20:23], v[224:227], v[168:171], a[20:23]
ds_read_b64_tr_b16 v[246:247], v22 offset:9216
v_mfma_f32_16x16x32_bf16 a[24:27], v[224:227], v[176:179], 0
s_add_u32 s72, s69, 47104
buffer_load_dwordx4 v2, s[8:11], s72 offen offset:2048 lds
v_mfma_f32_16x16x32_bf16 a[24:27], v[228:231], v[180:183], a[24:27]
v_mfma_f32_16x16x32_bf16 a[28:31], v[228:231], v[188:191], 0
s_add_u32 s72, s69, 54272
buffer_load_dwordx4 v3, s[8:11], s72 offen offset:3072 lds
v_mfma_f32_16x16x32_bf16 a[28:31], v[224:227], v[184:187], a[28:31]
v_mfma_f32_16x16x32_bf16 a[60:63], v[232:235], v[184:187], 0
s_add_u32 m0, s64, 49152
ds_read_b64_tr_b16 v[248:249], v23 offset:0
v_mfma_f32_16x16x32_bf16 a[60:63], v[236:239], v[188:191], a[60:63]
s_add_u32 s72, s71, 0
buffer_load_dwordx4 v6, s[20:23], s72 offen lds
v_mfma_f32_16x16x32_bf16 a[56:59], v[236:239], v[180:183], 0
s_add_u32 s72, s71, 31744
buffer_load_dwordx4 v6, s[20:23], s72 offen offset:1024 lds
v_mfma_f32_16x16x32_bf16 a[56:59], v[232:235], v[176:179], a[56:59]
v_mfma_f32_16x16x32_bf16 a[52:55], v[232:235], v[168:171], 0
s_add_u32 s72, s71, 63488
buffer_load_dwordx4 v7, s[20:23], s72 offen offset:2048 lds
v_mfma_f32_16x16x32_bf16 a[52:55], v[236:239], v[172:175], a[52:55]
ds_read_b64_tr_b16 v[250:251], v23 offset:1024
v_mfma_f32_16x16x32_bf16 a[48:51], v[236:239], v[164:167], 0
s_add_u32 s72, s71, 95232
buffer_load_dwordx4 v7, s[20:23], s72 offen offset:3072 lds
v_mfma_f32_16x16x32_bf16 a[48:51], v[232:235], v[160:163], a[48:51]
s_mov_b32 s80, 0x100000
buffer_load_dword v126, v125, s[16:19], s80 offen
v_mfma_f32_16x16x32_bf16 a[44:47], v[232:235], v[152:155], 0
buffer_load_dword v126, v125, s[20:23], s80 offen
v_mfma_f32_16x16x32_bf16 a[44:47], v[236:239], v[156:159], a[44:47]
v_mfma_f32_16x16x32_bf16 a[40:43], v[236:239], v[148:151], 0
ds_read_b64_tr_b16 v[252:253], v23 offset:8192
v_mfma_f32_16x16x32_bf16 a[40:43], v[232:235], v[144:147], a[40:43]
v_mfma_f32_16x16x32_bf16 a[36:39], v[232:235], v[136:139], 0
ds_read_b64_tr_b16 v[254:255], v23 offset:9216
v_mfma_f32_16x16x32_bf16 a[36:39], v[236:239], v[140:143], a[36:39]
v_mfma_f32_16x16x32_bf16 a[32:35], v[236:239], v[132:135], 0
v_mfma_f32_16x16x32_bf16 a[32:35], v[232:235], v[128:131], a[32:35]
s_waitcnt lgkmcnt(4)
v_mfma_f32_16x16x32_bf16 a[64:67], v[240:243], v[128:131], 0
ds_read_b64_tr_b16 v[224:225], v20 offset:16384
v_mfma_f32_16x16x32_bf16 a[64:67], v[244:247], v[132:135], a[64:67]
v_mfma_f32_16x16x32_bf16 a[68:71], v[244:247], v[140:143], 0
v_mfma_f32_16x16x32_bf16 a[68:71], v[240:243], v[136:139], a[68:71]
ds_read_b64_tr_b16 v[226:227], v20 offset:17408
v_mfma_f32_16x16x32_bf16 a[72:75], v[240:243], v[144:147], 0
v_mfma_f32_16x16x32_bf16 a[72:75], v[244:247], v[148:151], a[72:75]
v_mfma_f32_16x16x32_bf16 a[76:79], v[244:247], v[156:159], 0
v_mfma_f32_16x16x32_bf16 a[76:79], v[240:243], v[152:155], a[76:79]
ds_read_b64_tr_b16 v[228:229], v20 offset:24576
v_mfma_f32_16x16x32_bf16 a[80:83], v[240:243], v[160:163], 0
v_mfma_f32_16x16x32_bf16 a[80:83], v[244:247], v[164:167], a[80:83]
v_mfma_f32_16x16x32_bf16 a[84:87], v[244:247], v[172:175], 0
ds_read_b64_tr_b16 v[230:231], v20 offset:25600
v_mfma_f32_16x16x32_bf16 a[84:87], v[240:243], v[168:171], a[84:87]
v_mfma_f32_16x16x32_bf16 a[88:91], v[240:243], v[176:179], 0
v_mfma_f32_16x16x32_bf16 a[88:91], v[244:247], v[180:183], a[88:91]
v_mfma_f32_16x16x32_bf16 a[92:95], v[244:247], v[188:191], 0
v_mfma_f32_16x16x32_bf16 a[92:95], v[240:243], v[184:187], a[92:95]
s_waitcnt lgkmcnt(4)
v_mfma_f32_16x16x32_bf16 a[124:127], v[248:251], v[184:187], 0
ds_read_b64_tr_b16 v[232:233], v21 offset:16384
v_mfma_f32_16x16x32_bf16 a[124:127], v[252:255], v[188:191], a[124:127]
v_mfma_f32_16x16x32_bf16 a[120:123], v[252:255], v[180:183], 0
v_mfma_f32_16x16x32_bf16 a[120:123], v[248:251], v[176:179], a[120:123]
ds_read_b64_tr_b16 v[234:235], v21 offset:17408
v_mfma_f32_16x16x32_bf16 a[116:119], v[248:251], v[168:171], 0
v_mfma_f32_16x16x32_bf16 a[116:119], v[252:255], v[172:175], a[116:119]
v_mfma_f32_16x16x32_bf16 a[112:115], v[252:255], v[164:167], 0
v_mfma_f32_16x16x32_bf16 a[112:115], v[248:251], v[160:163], a[112:115]
ds_read_b64_tr_b16 v[236:237], v21 offset:24576
v_mfma_f32_16x16x32_bf16 a[108:111], v[248:251], v[152:155], 0
v_mfma_f32_16x16x32_bf16 a[108:111], v[252:255], v[156:159], a[108:111]
v_mfma_f32_16x16x32_bf16 a[104:107], v[252:255], v[148:151], 0
ds_read_b64_tr_b16 v[238:239], v21 offset:25600
v_mfma_f32_16x16x32_bf16 a[104:107], v[248:251], v[144:147], a[104:107]
v_mfma_f32_16x16x32_bf16 a[100:103], v[248:251], v[136:139], 0
v_mfma_f32_16x16x32_bf16 a[100:103], v[252:255], v[140:143], a[100:103]
v_mfma_f32_16x16x32_bf16 a[96:99], v[252:255], v[132:135], 0
v_mfma_f32_16x16x32_bf16 a[96:99], v[248:251], v[128:131], a[96:99]
s_waitcnt lgkmcnt(4)
v_mfma_f32_16x16x32_bf16 a[128:131], v[128:131], v[224:227], 0
ds_read_b64_tr_b16 v[240:241], v22 offset:16384
v_mfma_f32_16x16x32_bf16 a[128:131], v[132:135], v[228:231], a[128:131]
v_mfma_f32_16x16x32_bf16 a[132:135], v[140:143], v[228:231], 0
v_mfma_f32_16x16x32_bf16 a[132:135], v[136:139], v[224:227], a[132:135]
ds_read_b64_tr_b16 v[242:243], v22 offset:17408
v_mfma_f32_16x16x32_bf16 a[136:139], v[144:147], v[224:227], 0
v_mfma_f32_16x16x32_bf16 a[136:139], v[148:151], v[228:231], a[136:139]
v_mfma_f32_16x16x32_bf16 a[140:143], v[156:159], v[228:231], 0
v_mfma_f32_16x16x32_bf16 a[140:143], v[152:155], v[224:227], a[140:143]
ds_read_b64_tr_b16 v[244:245], v22 offset:24576
v_mfma_f32_16x16x32_bf16 a[144:147], v[160:163], v[224:227], 0
v_mfma_f32_16x16x32_bf16 a[144:147], v[164:167], v[228:231], a[144:147]
v_mfma_f32_16x16x32_bf16 a[148:151], v[172:175], v[228:231], 0
ds_read_b64_tr_b16 v[246:247], v22 offset:25600
v_mfma_f32_16x16x32_bf16 a[148:151], v[168:171], v[224:227], a[148:151]
v_mfma_f32_16x16x32_bf16 a[152:155], v[176:179], v[224:227], 0
v_mfma_f32_16x16x32_bf16 a[152:155], v[180:183], v[228:231], a[152:155]
v_mfma_f32_16x16x32_bf16 a[156:159], v[188:191], v[228:231], 0
v_mfma_f32_16x16x32_bf16 a[156:159], v[184:187], v[224:227], a[156:159]
s_waitcnt lgkmcnt(4)
v_mfma_f32_16x16x32_bf16 a[188:191], v[184:187], v[232:235], 0
ds_read_b64_tr_b16 v[248:249], v23 offset:16384
v_mfma_f32_16x16x32_bf16 a[188:191], v[188:191], v[236:239], a[188:191]
v_mfma_f32_16x16x32_bf16 a[184:187], v[180:183], v[236:239], 0
ds_read_b64_tr_b16 v[250:251], v23 offset:17408
v_mfma_f32_16x16x32_bf16 a[184:187], v[176:179], v[232:235], a[184:187]
v_mfma_f32_16x16x32_bf16 a[180:183], v[168:171], v[232:235], 0
ds_read_b64_tr_b16 v[252:253], v23 offset:24576
v_mfma_f32_16x16x32_bf16 a[180:183], v[172:175], v[236:239], a[180:183]
v_mfma_f32_16x16x32_bf16 a[176:179], v[164:167], v[236:239], 0
ds_read_b64_tr_b16 v[254:255], v23 offset:25600
v_mfma_f32_16x16x32_bf16 a[176:179], v[160:163], v[232:235], a[176:179]
v_mfma_f32_16x16x32_bf16 a[172:175], v[152:155], v[232:235], 0
v_mfma_f32_16x16x32_bf16 a[172:175], v[156:159], v[236:239], a[172:175]
v_mfma_f32_16x16x32_bf16 a[168:171], v[148:151], v[236:239], 0
v_mfma_f32_16x16x32_bf16 a[168:171], v[144:147], v[232:235], a[168:171]
v_mfma_f32_16x16x32_bf16 a[164:167], v[136:139], v[232:235], 0
v_mfma_f32_16x16x32_bf16 a[164:167], v[140:143], v[236:239], a[164:167]
v_mfma_f32_16x16x32_bf16 a[160:163], v[132:135], v[236:239], 0
s_waitcnt vmcnt(2) lgkmcnt(0)
v_mfma_f32_16x16x32_bf16 a[160:163], v[128:131], v[232:235], a[160:163]
s_barrier
v_mfma_f32_16x16x32_bf16 a[192:195], v[128:131], v[240:243], 0
s_and_b32 s73, s65, 1
ds_read_b64_tr_b16 v[224:225], v20 offset:32768
v_mfma_f32_16x16x32_bf16 a[192:195], v[132:135], v[244:247], a[192:195]
s_xor_b32 s73, s73, 2
ds_read_b64_tr_b16 v[226:227], v20 offset:33792
v_mfma_f32_16x16x32_bf16 a[196:199], v[140:143], v[244:247], 0
s_lshl_b32 s69, s73, 7
ds_read_b64_tr_b16 v[228:229], v20 offset:40960
v_mfma_f32_16x16x32_bf16 a[196:199], v[136:139], v[240:243], a[196:199]
s_add_u32 s69, s69, s84
ds_read_b64_tr_b16 v[230:231], v20 offset:41984
v_mfma_f32_16x16x32_bf16 a[200:203], v[144:147], v[240:243], 0
s_lshl_b32 s71, s73, 19
ds_read_b128 v[192:195], v24 offset:32768
v_mfma_f32_16x16x32_bf16 a[200:203], v[148:151], v[244:247], a[200:203]
s_add_u32 s71, s71, s66
ds_read_b128 v[196:199], v25 offset:32768
v_mfma_f32_16x16x32_bf16 a[204:207], v[156:159], v[244:247], 0
s_add_u32 m0, s63, 65536
v_mfma_f32_16x16x32_bf16 a[204:207], v[152:155], v[240:243], a[204:207]
s_add_u32 s72, s69, 0
buffer_load_dwordx4 v2, s[8:11], s72 offen lds
v_mfma_f32_16x16x32_bf16 a[208:211], v[160:163], v[240:243], 0
s_add_u32 s72, s69, 7168
buffer_load_dwordx4 v3, s[8:11], s72 offen offset:1024 lds
v_mfma_f32_16x16x32_bf16 a[208:211], v[164:167], v[244:247], a[208:211]
s_add_u32 s72, s69, 14336
buffer_load_dwordx4 v2, s[8:11], s72 offen offset:2048 lds
v_mfma_f32_16x16x32_bf16 a[212:215], v[172:175], v[244:247], 0
ds_read_b128 v[200:203], v24 offset:34816
v_mfma_f32_16x16x32_bf16 a[212:215], v[168:171], v[240:243], a[212:215]
ds_read_b128 v[204:207], v25 offset:34816
v_mfma_f32_16x16x32_bf16 a[216:219], v[176:179], v[240:243], 0
s_add_u32 s72, s69, 21504
buffer_load_dwordx4 v3, s[8:11], s72 offen offset:3072 lds
v_mfma_f32_16x16x32_bf16 a[216:219], v[180:183], v[244:247], a[216:219]
ds_read_b128 v[208:211], v24 offset:36864
v_mfma_f32_16x16x32_bf16 a[220:223], v[188:191], v[244:247], 0
ds_read_b128 v[212:215], v25 offset:36864
v_mfma_f32_16x16x32_bf16 a[220:223], v[184:187], v[240:243], a[220:223]
ds_read_b128 v[216:219], v24 offset:38912
v_mfma_f32_16x16x32_bf16 a[252:255], v[184:187], v[248:251], 0
ds_read_b128 v[220:223], v25 offset:38912
v_mfma_f32_16x16x32_bf16 a[252:255], v[188:191], v[252:255], a[252:255]
s_add_u32 m0, s64, 0
v_mfma_f32_16x16x32_bf16 a[248:251], v[180:183], v[252:255], 0
s_add_u32 s72, s71, 0
buffer_load_dwordx4 v6, s[16:19], s72 offen lds
v_mfma_f32_16x16x32_bf16 a[248:251], v[176:179], v[248:251], a[248:251]
ds_read_b128 v[184:187], v24 offset:40960
v_mfma_f32_16x16x32_bf16 a[244:247], v[168:171], v[248:251], 0
ds_read_b128 v[188:191], v25 offset:40960
v_mfma_f32_16x16x32_bf16 a[244:247], v[172:175], v[252:255], a[244:247]
s_add_u32 s72, s71, 31744
buffer_load_dwordx4 v6, s[16:19], s72 offen offset:1024 lds
v_mfma_f32_16x16x32_bf16 a[240:243], v[164:167], v[252:255], 0
ds_read_b128 v[176:179], v24 offset:43008
v_mfma_f32_16x16x32_bf16 a[240:243], v[160:163], v[248:251], a[240:243]
ds_read_b128 v[180:183], v25 offset:43008
v_mfma_f32_16x16x32_bf16 a[236:239], v[152:155], v[248:251], 0
ds_read_b128 v[168:171], v24 offset:45056
v_mfma_f32_16x16x32_bf16 a[236:239], v[156:159], v[252:255], a[236:239]
s_add_u32 s72, s71, 63488
buffer_load_dwordx4 v7, s[16:19], s72 offen offset:2048 lds
v_mfma_f32_16x16x32_bf16 a[232:235], v[148:151], v[252:255], 0
ds_read_b128 v[172:175], v25 offset:45056
v_mfma_f32_16x16x32_bf16 a[232:235], v[144:147], v[248:251], a[232:235]
ds_read_b128 v[160:163], v24 offset:47104
v_mfma_f32_16x16x32_bf16 a[228:231], v[136:139], v[248:251], 0
ds_read_b128 v[164:167], v25 offset:47104
v_mfma_f32_16x16x32_bf16 a[228:231], v[140:143], v[252:255], a[228:231]
v_mfma_f32_16x16x32_bf16 a[224:227], v[132:135], v[252:255], 0
s_add_u32 s72, s71, 95232
buffer_load_dwordx4 v7, s[16:19], s72 offen offset:3072 lds
v_mfma_f32_16x16x32_bf16 a[224:227], v[128:131], v[248:251], a[224:227]
s_waitcnt lgkmcnt(8)
ds_read_b64_tr_b16 v[232:233], v21 offset:32768
v_mfma_f32_16x16x32_bf16 a[0:3], v[224:227], v[192:195], a[0:3]
ds_read_b64_tr_b16 v[234:235], v21 offset:33792
v_mfma_f32_16x16x32_bf16 a[0:3], v[228:231], v[196:199], a[0:3]
ds_read_b64_tr_b16 v[240:241], v22 offset:32768
v_mfma_f32_16x16x32_bf16 a[4:7], v[228:231], v[204:207], a[4:7]
s_add_u32 m0, s63, 69632
ds_read_b64_tr_b16 v[236:237], v21 offset:40960
v_mfma_f32_16x16x32_bf16 a[4:7], v[224:227], v[200:203], a[4:7]
s_add_u32 s72, s69, 32768
buffer_load_dwordx4 v2, s[8:11], s72 offen lds
v_mfma_f32_16x16x32_bf16 a[8:11], v[224:227], v[208:211], a[8:11]
ds_read_b64_tr_b16 v[238:239], v21 offset:41984
v_mfma_f32_16x16x32_bf16 a[8:11], v[228:231], v[212:215], a[8:11]
v_mfma_f32_16x16x32_bf16 a[12:15], v[228:231], v[220:223], a[12:15]
s_add_u32 s72, s69, 39936
buffer_load_dwordx4 v3, s[8:11], s72 offen offset:1024 lds
v_mfma_f32_16x16x32_bf16 a[12:15], v[224:227], v[216:219], a[12:15]
s_waitcnt lgkmcnt(5)
ds_read_b64_tr_b16 v[242:243], v22 offset:33792
v_mfma_f32_16x16x32_bf16 a[16:19], v[224:227], v[184:187], a[16:19]
v_mfma_f32_16x16x32_bf16 a[16:19], v[228:231], v[188:191], a[16:19]
ds_read_b64_tr_b16 v[244:245], v22 offset:40960
v_mfma_f32_16x16x32_bf16 a[20:23], v[228:231], v[180:183], a[20:23]
v_mfma_f32_16x16x32_bf16 a[20:23], v[224:227], v[176:179], a[20:23]
s_add_u32 s72, s69, 47104
buffer_load_dwordx4 v2, s[8:11], s72 offen offset:2048 lds
v_mfma_f32_16x16x32_bf16 a[24:27], v[224:227], v[168:171], a[24:27]
ds_read_b64_tr_b16 v[246:247], v22 offset:41984
v_mfma_f32_16x16x32_bf16 a[24:27], v[228:231], v[172:175], a[24:27]
v_mfma_f32_16x16x32_bf16 a[28:31], v[228:231], v[164:167], a[28:31]
v_mfma_f32_16x16x32_bf16 a[28:31], v[224:227], v[160:163], a[28:31]
s_waitcnt lgkmcnt(3)
v_mfma_f32_16x16x32_bf16 a[60:63], v[232:235], v[160:163], a[60:63]
s_add_u32 s72, s69, 54272
buffer_load_dwordx4 v3, s[8:11], s72 offen offset:3072 lds
v_mfma_f32_16x16x32_bf16 a[60:63], v[236:239], v[164:167], a[60:63]
ds_read_b64_tr_b16 v[248:249], v23 offset:32768
v_mfma_f32_16x16x32_bf16 a[56:59], v[236:239], v[172:175], a[56:59]
v_mfma_f32_16x16x32_bf16 a[56:59], v[232:235], v[168:171], a[56:59]
s_add_u32 m0, s64, 16384
ds_read_b64_tr_b16 v[250:251], v23 offset:33792
v_mfma_f32_16x16x32_bf16 a[52:55], v[232:235], v[176:179], a[52:55]
s_add_u32 s72, s71, 0
buffer_load_dwordx4 v6, s[20:23], s72 offen lds
v_mfma_f32_16x16x32_bf16 a[52:55], v[236:239], v[180:183], a[52:55]
v_mfma_f32_16x16x32_bf16 a[48:51], v[236:239], v[188:191], a[48:51]
v_mfma_f32_16x16x32_bf16 a[48:51], v[232:235], v[184:187], a[48:51]
ds_read_b64_tr_b16 v[252:253], v23 offset:40960
v_mfma_f32_16x16x32_bf16 a[44:47], v[232:235], v[216:219], a[44:47]
s_add_u32 s72, s71, 31744
buffer_load_dwordx4 v6, s[20:23], s72 offen offset:1024 lds
v_mfma_f32_16x16x32_bf16 a[44:47], v[236:239], v[220:223], a[44:47]
v_mfma_f32_16x16x32_bf16 a[40:43], v[236:239], v[212:215], a[40:43]
ds_read_b64_tr_b16 v[254:255], v23 offset:41984
v_mfma_f32_16x16x32_bf16 a[40:43], v[232:235], v[208:211], a[40:43]
v_mfma_f32_16x16x32_bf16 a[36:39], v[232:235], v[200:203], a[36:39]
s_add_u32 s72, s71, 63488
buffer_load_dwordx4 v7, s[20:23], s72 offen offset:2048 lds
v_mfma_f32_16x16x32_bf16 a[36:39], v[236:239], v[204:207], a[36:39]
v_mfma_f32_16x16x32_bf16 a[32:35], v[236:239], v[196:199], a[32:35]
v_mfma_f32_16x16x32_bf16 a[32:35], v[232:235], v[192:195], a[32:35]
s_waitcnt lgkmcnt(4)
v_mfma_f32_16x16x32_bf16 a[64:67], v[240:243], v[192:195], a[64:67]
s_add_u32 s72, s71, 95232
buffer_load_dwordx4 v7, s[20:23], s72 offen offset:3072 lds
v_mfma_f32_16x16x32_bf16 a[64:67], v[244:247], v[196:199], a[64:67]
s_mov_b32 s80, 0x200000
buffer_load_dword v126, v125, s[16:19], s80 offen
v_mfma_f32_16x16x32_bf16 a[68:71], v[244:247], v[204:207], a[68:71]
buffer_load_dword v126, v125, s[20:23], s80 offen
v_mfma_f32_16x16x32_bf16 a[68:71], v[240:243], v[200:203], a[68:71]
global_load_dwordx4 v[68:71], v30, s[52:53]
v_mfma_f32_16x16x32_bf16 a[72:75], v[240:243], v[208:211], a[72:75]
buffer_load_dword v33, v27, s[28:31], 0 offen nt
v_mfma_f32_16x16x32_bf16 a[72:75], v[244:247], v[212:215], a[72:75]
buffer_load_dword v34, v27, s[28:31], 0 offen offset:2048 nt
v_mfma_f32_16x16x32_bf16 a[76:79], v[244:247], v[220:223], a[76:79]
v_add_u32 v27, 0x1000, v27
v_mfma_f32_16x16x32_bf16 a[76:79], v[240:243], v[216:219], a[76:79]
buffer_load_dword v35, v27, s[28:31], 0 offen nt
v_mfma_f32_16x16x32_bf16 a[80:83], v[240:243], v[184:187], a[80:83]
s_add_u32 m0, s63, 131072
ds_read_b64_tr_b16 v[224:225], v20 offset:49152
ds_read_b64_tr_b16 v[226:227], v20 offset:50176
v_mfma_f32_16x16x32_bf16 a[80:83], v[244:247], v[188:191], a[80:83]
s_add_u32 s80, s82, 0
buffer_load_dwordx4 v26, s[28:31], s80 offen nt lds
v_mfma_f32_16x16x32_bf16 a[84:87], v[244:247], v[180:183], a[84:87]
s_add_u32 s80, s82, 15360
buffer_load_dwordx4 v26, s[28:31], s80 offen offset:1024 nt lds
v_mfma_f32_16x16x32_bf16 a[84:87], v[240:243], v[176:179], a[84:87]
s_add_u32 s80, s82, 30720
buffer_load_dwordx4 v26, s[28:31], s80 offen offset:2048 nt lds
v_mfma_f32_16x16x32_bf16 a[88:91], v[240:243], v[168:171], a[88:91]
s_add_u32 s80, s82, 46080
buffer_load_dwordx4 v26, s[28:31], s80 offen offset:3072 nt lds
v_mfma_f32_16x16x32_bf16 a[88:91], v[244:247], v[172:175], a[88:91]
ds_read_b64_tr_b16 v[228:229], v20 offset:57344
ds_read_b64_tr_b16 v[230:231], v20 offset:58368
v_mfma_f32_16x16x32_bf16 a[92:95], v[244:247], v[164:167], a[92:95]
v_mfma_f32_16x16x32_bf16 a[92:95], v[240:243], v[160:163], a[92:95]
s_waitcnt lgkmcnt(4)
v_mfma_f32_16x16x32_bf16 a[124:127], v[248:251], v[160:163], a[124:127]
ds_read_b64_tr_b16 v[232:233], v21 offset:49152
v_mfma_f32_16x16x32_bf16 a[124:127], v[252:255], v[164:167], a[124:127]
v_mfma_f32_16x16x32_bf16 a[120:123], v[252:255], v[172:175], a[120:123]
v_mfma_f32_16x16x32_bf16 a[120:123], v[248:251], v[168:171], a[120:123]
ds_read_b64_tr_b16 v[234:235], v21 offset:50176
v_mfma_f32_16x16x32_bf16 a[116:119], v[248:251], v[176:179], a[116:119]
v_mfma_f32_16x16x32_bf16 a[116:119], v[252:255], v[180:183], a[116:119]
v_mfma_f32_16x16x32_bf16 a[112:115], v[252:255], v[188:191], a[112:115]
v_mfma_f32_16x16x32_bf16 a[112:115], v[248:251], v[184:187], a[112:115]
ds_read_b64_tr_b16 v[236:237], v21 offset:57344
v_mfma_f32_16x16x32_bf16 a[108:111], v[248:251], v[216:219], a[108:111]
v_mfma_f32_16x16x32_bf16 a[108:111], v[252:255], v[220:223], a[108:111]
v_mfma_f32_16x16x32_bf16 a[104:107], v[252:255], v[212:215], a[104:107]
ds_read_b64_tr_b16 v[238:239], v21 offset:58368
v_mfma_f32_16x16x32_bf16 a[104:107], v[248:251], v[208:211], a[104:107]
v_mfma_f32_16x16x32_bf16 a[100:103], v[248:251], v[200:203], a[100:103]
v_mfma_f32_16x16x32_bf16 a[100:103], v[252:255], v[204:207], a[100:103]
v_mfma_f32_16x16x32_bf16 a[96:99], v[252:255], v[196:199], a[96:99]
v_mfma_f32_16x16x32_bf16 a[96:99], v[248:251], v[192:195], a[96:99]
s_waitcnt lgkmcnt(4)
v_mfma_f32_16x16x32_bf16 a[128:131], v[192:195], v[224:227], a[128:131]
ds_read_b64_tr_b16 v[240:241], v22 offset:49152
v_mfma_f32_16x16x32_bf16 a[128:131], v[196:199], v[228:231], a[128:131]
v_mfma_f32_16x16x32_bf16 a[132:135], v[204:207], v[228:231], a[132:135]
v_mfma_f32_16x16x32_bf16 a[132:135], v[200:203], v[224:227], a[132:135]
ds_read_b64_tr_b16 v[242:243], v22 offset:50176
v_mfma_f32_16x16x32_bf16 a[136:139], v[208:211], v[224:227], a[136:139]
v_mfma_f32_16x16x32_bf16 a[136:139], v[212:215], v[228:231], a[136:139]
v_mfma_f32_16x16x32_bf16 a[140:143], v[220:223], v[228:231], a[140:143]
v_mfma_f32_16x16x32_bf16 a[140:143], v[216:219], v[224:227], a[140:143]
ds_read_b64_tr_b16 v[244:245], v22 offset:57344
v_mfma_f32_16x16x32_bf16 a[144:147], v[184:187], v[224:227], a[144:147]
v_mfma_f32_16x16x32_bf16 a[144:147], v[188:191], v[228:231], a[144:147]
v_mfma_f32_16x16x32_bf16 a[148:151], v[180:183], v[228:231], a[148:151]
ds_read_b64_tr_b16 v[246:247], v22 offset:58368
v_mfma_f32_16x16x32_bf16 a[148:151], v[176:179], v[224:227], a[148:151]
v_mfma_f32_16x16x32_bf16 a[152:155], v[168:171], v[224:227], a[152:155]
v_mfma_f32_16x16x32_bf16 a[152:155], v[172:175], v[228:231], a[152:155]
v_mfma_f32_16x16x32_bf16 a[156:159], v[164:167], v[228:231], a[156:159]
v_mfma_f32_16x16x32_bf16 a[156:159], v[160:163], v[224:227], a[156:159]
s_waitcnt lgkmcnt(4)
v_mfma_f32_16x16x32_bf16 a[188:191], v[160:163], v[232:235], a[188:191]
ds_read_b64_tr_b16 v[248:249], v23 offset:49152
v_mfma_f32_16x16x32_bf16 a[188:191], v[164:167], v[236:239], a[188:191]
v_mfma_f32_16x16x32_bf16 a[184:187], v[172:175], v[236:239], a[184:187]
ds_read_b64_tr_b16 v[250:251], v23 offset:50176
v_mfma_f32_16x16x32_bf16 a[184:187], v[168:171], v[232:235], a[184:187]
v_mfma_f32_16x16x32_bf16 a[180:183], v[176:179], v[232:235], a[180:183]
ds_read_b64_tr_b16 v[252:253], v23 offset:57344
v_mfma_f32_16x16x32_bf16 a[180:183], v[180:183], v[236:239], a[180:183]
v_mfma_f32_16x16x32_bf16 a[176:179], v[188:191], v[236:239], a[176:179]
ds_read_b64_tr_b16 v[254:255], v23 offset:58368
v_mfma_f32_16x16x32_bf16 a[176:179], v[184:187], v[232:235], a[176:179]
v_mfma_f32_16x16x32_bf16 a[172:175], v[216:219], v[232:235], a[172:175]
v_mfma_f32_16x16x32_bf16 a[172:175], v[220:223], v[236:239], a[172:175]
v_mfma_f32_16x16x32_bf16 a[168:171], v[212:215], v[236:239], a[168:171]
v_mfma_f32_16x16x32_bf16 a[168:171], v[208:211], v[232:235], a[168:171]
v_mfma_f32_16x16x32_bf16 a[164:167], v[200:203], v[232:235], a[164:167]
v_mfma_f32_16x16x32_bf16 a[164:167], v[204:207], v[236:239], a[164:167]
v_mfma_f32_16x16x32_bf16 a[160:163], v[196:199], v[236:239], a[160:163]
s_waitcnt vmcnt(10) lgkmcnt(0)
v_mfma_f32_16x16x32_bf16 a[160:163], v[192:195], v[232:235], a[160:163]
s_barrier
v_mfma_f32_16x16x32_bf16 a[192:195], v[192:195], v[240:243], a[192:195]
s_and_b32 s73, s65, 1
ds_read_b64_tr_b16 v[224:225], v20 offset:0
v_mfma_f32_16x16x32_bf16 a[192:195], v[196:199], v[244:247], a[192:195]
s_xor_b32 s73, s73, 3
ds_read_b64_tr_b16 v[226:227], v20 offset:1024
v_mfma_f32_16x16x32_bf16 a[196:199], v[204:207], v[244:247], a[196:199]
s_lshl_b32 s69, s73, 7
ds_read_b64_tr_b16 v[228:229], v20 offset:8192
v_mfma_f32_16x16x32_bf16 a[196:199], v[200:203], v[240:243], a[196:199]
s_add_u32 s69, s69, s84
ds_read_b64_tr_b16 v[230:231], v20 offset:9216
v_mfma_f32_16x16x32_bf16 a[200:203], v[208:211], v[240:243], a[200:203]
s_lshl_b32 s71, s73, 19
ds_read_b128 v[128:131], v24 offset:0
v_mfma_f32_16x16x32_bf16 a[200:203], v[212:215], v[244:247], a[200:203]
s_add_u32 s71, s71, s66
ds_read_b128 v[132:135], v25 offset:0
v_mfma_f32_16x16x32_bf16 a[204:207], v[220:223], v[244:247], a[204:207]
s_add_u32 m0, s63, 98304
v_mfma_f32_16x16x32_bf16 a[204:207], v[216:219], v[240:243], a[204:207]
s_add_u32 s72, s69, 0
buffer_load_dwordx4 v2, s[8:11], s72 offen lds
v_mfma_f32_16x16x32_bf16 a[208:211], v[184:187], v[240:243], a[208:211]
s_add_u32 s72, s69, 7168
buffer_load_dwordx4 v3, s[8:11], s72 offen offset:1024 lds
v_mfma_f32_16x16x32_bf16 a[208:211], v[188:191], v[244:247], a[208:211]
s_add_u32 s72, s69, 14336
buffer_load_dwordx4 v2, s[8:11], s72 offen offset:2048 lds
v_mfma_f32_16x16x32_bf16 a[212:215], v[180:183], v[244:247], a[212:215]
ds_read_b128 v[136:139], v24 offset:2048
v_mfma_f32_16x16x32_bf16 a[212:215], v[176:179], v[240:243], a[212:215]
ds_read_b128 v[140:143], v25 offset:2048
v_mfma_f32_16x16x32_bf16 a[216:219], v[168:171], v[240:243], a[216:219]
s_add_u32 s72, s69, 21504
buffer_load_dwordx4 v3, s[8:11], s72 offen offset:3072 lds
v_mfma_f32_16x16x32_bf16 a[216:219], v[172:175], v[244:247], a[216:219]
ds_read_b128 v[144:147], v24 offset:4096
v_mfma_f32_16x16x32_bf16 a[220:223], v[164:167], v[244:247], a[220:223]
ds_read_b128 v[148:151], v25 offset:4096
v_mfma_f32_16x16x32_bf16 a[220:223], v[160:163], v[240:243], a[220:223]
ds_read_b128 v[152:155], v24 offset:6144
v_mfma_f32_16x16x32_bf16 a[252:255], v[160:163], v[248:251], a[252:255]
ds_read_b128 v[156:159], v25 offset:6144
v_mfma_f32_16x16x32_bf16 a[252:255], v[164:167], v[252:255], a[252:255]
s_add_u32 m0, s64, 32768
v_mfma_f32_16x16x32_bf16 a[248:251], v[172:175], v[252:255], a[248:251]
s_add_u32 s72, s71, 0
buffer_load_dwordx4 v6, s[16:19], s72 offen lds
v_mfma_f32_16x16x32_bf16 a[248:251], v[168:171], v[248:251], a[248:251]
ds_read_b128 v[160:163], v24 offset:8192
v_mfma_f32_16x16x32_bf16 a[244:247], v[176:179], v[248:251], a[244:247]
ds_read_b128 v[164:167], v25 offset:8192
v_mfma_f32_16x16x32_bf16 a[244:247], v[180:183], v[252:255], a[244:247]
s_add_u32 s72, s71, 31744
buffer_load_dwordx4 v6, s[16:19], s72 offen offset:1024 lds
v_mfma_f32_16x16x32_bf16 a[240:243], v[188:191], v[252:255], a[240:243]
ds_read_b128 v[168:171], v24 offset:10240
v_mfma_f32_16x16x32_bf16 a[240:243], v[184:187], v[248:251], a[240:243]
ds_read_b128 v[172:175], v25 offset:10240
v_mfma_f32_16x16x32_bf16 a[236:239], v[216:219], v[248:251], a[236:239]
ds_read_b128 v[176:179], v24 offset:12288
v_mfma_f32_16x16x32_bf16 a[236:239], v[220:223], v[252:255], a[236:239]
s_add_u32 s72, s71, 63488
buffer_load_dwordx4 v7, s[16:19], s72 offen offset:2048 lds
v_mfma_f32_16x16x32_bf16 a[232:235], v[212:215], v[252:255], a[232:235]
ds_read_b128 v[180:183], v25 offset:12288
v_mfma_f32_16x16x32_bf16 a[232:235], v[208:211], v[248:251], a[232:235]
ds_read_b128 v[184:187], v24 offset:14336
v_mfma_f32_16x16x32_bf16 a[228:231], v[200:203], v[248:251], a[228:231]
ds_read_b128 v[188:191], v25 offset:14336
v_mfma_f32_16x16x32_bf16 a[228:231], v[204:207], v[252:255], a[228:231]
v_mfma_f32_16x16x32_bf16 a[224:227], v[196:199], v[252:255], a[224:227]
s_add_u32 s72, s71, 95232
buffer_load_dwordx4 v7, s[16:19], s72 offen offset:3072 lds
v_mfma_f32_16x16x32_bf16 a[224:227], v[192:195], v[248:251], a[224:227]
s_waitcnt lgkmcnt(8)
ds_read_b64_tr_b16 v[232:233], v21 offset:0
v_mfma_f32_16x16x32_bf16 a[0:3], v[224:227], v[128:131], a[0:3]
ds_read_b64_tr_b16 v[234:235], v21 offset:1024
v_mfma_f32_16x16x32_bf16 a[0:3], v[228:231], v[132:135], a[0:3]
ds_read_b64_tr_b16 v[240:241], v22 offset:0
v_mfma_f32_16x16x32_bf16 a[4:7], v[228:231], v[140:143], a[4:7]
s_add_u32 m0, s63, 102400
ds_read_b64_tr_b16 v[236:237], v21 offset:8192
v_mfma_f32_16x16x32_bf16 a[4:7], v[224:227], v[136:139], a[4:7]
s_add_u32 s72, s69, 32768
buffer_load_dwordx4 v2, s[8:11], s72 offen lds
v_mfma_f32_16x16x32_bf16 a[8:11], v[224:227], v[144:147], a[8:11]
ds_read_b64_tr_b16 v[238:239], v21 offset:9216
v_mfma_f32_16x16x32_bf16 a[8:11], v[228:231], v[148:151], a[8:11]
v_mfma_f32_16x16x32_bf16 a[12:15], v[228:231], v[156:159], a[12:15]
s_add_u32 s72, s69, 39936
buffer_load_dwordx4 v3, s[8:11], s72 offen offset:1024 lds
v_mfma_f32_16x16x32_bf16 a[12:15], v[224:227], v[152:155], a[12:15]
s_waitcnt lgkmcnt(5)
ds_read_b64_tr_b16 v[242:243], v22 offset:1024
v_mfma_f32_16x16x32_bf16 a[16:19], v[224:227], v[160:163], a[16:19]
v_mfma_f32_16x16x32_bf16 a[16:19], v[228:231], v[164:167], a[16:19]
ds_read_b64_tr_b16 v[244:245], v22 offset:8192
v_mfma_f32_16x16x32_bf16 a[20:23], v[228:231], v[172:175], a[20:23]
v_mfma_f32_16x16x32_bf16 a[20:23], v[224:227], v[168:171], a[20:23]
s_add_u32 s72, s69, 47104
buffer_load_dwordx4 v2, s[8:11], s72 offen offset:2048 lds
v_mfma_f32_16x16x32_bf16 a[24:27], v[224:227], v[176:179], a[24:27]
ds_read_b64_tr_b16 v[246:247], v22 offset:9216
v_mfma_f32_16x16x32_bf16 a[24:27], v[228:231], v[180:183], a[24:27]
v_mfma_f32_16x16x32_bf16 a[28:31], v[228:231], v[188:191], a[28:31]
v_mfma_f32_16x16x32_bf16 a[28:31], v[224:227], v[184:187], a[28:31]
s_waitcnt lgkmcnt(3)
v_mfma_f32_16x16x32_bf16 a[60:63], v[232:235], v[184:187], a[60:63]
s_add_u32 s72, s69, 54272
buffer_load_dwordx4 v3, s[8:11], s72 offen offset:3072 lds
v_mfma_f32_16x16x32_bf16 a[60:63], v[236:239], v[188:191], a[60:63]
ds_read_b64_tr_b16 v[248:249], v23 offset:0
v_mfma_f32_16x16x32_bf16 a[56:59], v[236:239], v[180:183], a[56:59]
v_mfma_f32_16x16x32_bf16 a[56:59], v[232:235], v[176:179], a[56:59]
s_add_u32 m0, s64, 49152
ds_read_b64_tr_b16 v[250:251], v23 offset:1024
v_mfma_f32_16x16x32_bf16 a[52:55], v[232:235], v[168:171], a[52:55]
s_add_u32 s72, s71, 0
buffer_load_dwordx4 v6, s[20:23], s72 offen lds
v_mfma_f32_16x16x32_bf16 a[52:55], v[236:239], v[172:175], a[52:55]
v_mfma_f32_16x16x32_bf16 a[48:51], v[236:239], v[164:167], a[48:51]
v_mfma_f32_16x16x32_bf16 a[48:51], v[232:235], v[160:163], a[48:51]
ds_read_b64_tr_b16 v[252:253], v23 offset:8192
v_mfma_f32_16x16x32_bf16 a[44:47], v[232:235], v[152:155], a[44:47]
s_add_u32 s72, s71, 31744
buffer_load_dwordx4 v6, s[20:23], s72 offen offset:1024 lds
v_mfma_f32_16x16x32_bf16 a[44:47], v[236:239], v[156:159], a[44:47]
v_mfma_f32_16x16x32_bf16 a[40:43], v[236:239], v[148:151], a[40:43]
ds_read_b64_tr_b16 v[254:255], v23 offset:9216
v_mfma_f32_16x16x32_bf16 a[40:43], v[232:235], v[144:147], a[40:43]
v_mfma_f32_16x16x32_bf16 a[36:39], v[232:235], v[136:139], a[36:39]
s_add_u32 s72, s71, 63488
buffer_load_dwordx4 v7, s[20:23], s72 offen offset:2048 lds
v_mfma_f32_16x16x32_bf16 a[36:39], v[236:239], v[140:143], a[36:39]
v_mfma_f32_16x16x32_bf16 a[32:35], v[236:239], v[132:135], a[32:35]
v_mfma_f32_16x16x32_bf16 a[32:35], v[232:235], v[128:131], a[32:35]
s_waitcnt lgkmcnt(4)
v_mfma_f32_16x16x32_bf16 a[64:67], v[240:243], v[128:131], a[64:67]
s_add_u32 s72, s71, 95232
buffer_load_dwordx4 v7, s[20:23], s72 offen offset:3072 lds
v_mfma_f32_16x16x32_bf16 a[64:67], v[244:247], v[132:135], a[64:67]
s_mov_b32 s80, 0x300000
buffer_load_dword v126, v125, s[16:19], s80 offen
v_mfma_f32_16x16x32_bf16 a[68:71], v[244:247], v[140:143], a[68:71]
buffer_load_dword v126, v125, s[20:23], s80 offen
v_mfma_f32_16x16x32_bf16 a[68:71], v[240:243], v[136:139], a[68:71]
s_add_u32 m0, s63, 135168
ds_read_b64_tr_b16 v[224:225], v20 offset:16384
v_mfma_f32_16x16x32_bf16 a[72:75], v[240:243], v[144:147], a[72:75]
s_add_u32 s80, s82, 0
buffer_load_dwordx4 v26, s[32:35], s80 offen nt lds
v_mfma_f32_16x16x32_bf16 a[72:75], v[244:247], v[148:151], a[72:75]
s_add_u32 s80, s82, 15360
buffer_load_dwordx4 v26, s[32:35], s80 offen offset:1024 nt lds
v_mfma_f32_16x16x32_bf16 a[76:79], v[244:247], v[156:159], a[76:79]
s_add_u32 s80, s82, 30720
buffer_load_dwordx4 v26, s[32:35], s80 offen offset:2048 nt lds
v_mfma_f32_16x16x32_bf16 a[76:79], v[240:243], v[152:155], a[76:79]
s_add_u32 s80, s82, 46080
buffer_load_dwordx4 v26, s[32:35], s80 offen offset:3072 nt lds
v_mfma_f32_16x16x32_bf16 a[80:83], v[240:243], v[160:163], a[80:83]
ds_read_b64_tr_b16 v[226:227], v20 offset:17408
v_mfma_f32_16x16x32_bf16 a[80:83], v[244:247], v[164:167], a[80:83]
v_mfma_f32_16x16x32_bf16 a[84:87], v[244:247], v[172:175], a[84:87]
ds_read_b64_tr_b16 v[228:229], v20 offset:24576
v_mfma_f32_16x16x32_bf16 a[84:87], v[240:243], v[168:171], a[84:87]
v_mfma_f32_16x16x32_bf16 a[88:91], v[240:243], v[176:179], a[88:91]
ds_read_b64_tr_b16 v[230:231], v20 offset:25600
v_mfma_f32_16x16x32_bf16 a[88:91], v[244:247], v[180:183], a[88:91]
v_mfma_f32_16x16x32_bf16 a[92:95], v[244:247], v[188:191], a[92:95]
v_mfma_f32_16x16x32_bf16 a[92:95], v[240:243], v[184:187], a[92:95]
s_waitcnt lgkmcnt(4)
v_mfma_f32_16x16x32_bf16 a[124:127], v[248:251], v[184:187], a[124:127]
ds_read_b64_tr_b16 v[232:233], v21 offset:16384
v_mfma_f32_16x16x32_bf16 a[124:127], v[252:255], v[188:191], a[124:127]
v_mfma_f32_16x16x32_bf16 a[120:123], v[252:255], v[180:183], a[120:123]
v_mfma_f32_16x16x32_bf16 a[120:123], v[248:251], v[176:179], a[120:123]
ds_read_b64_tr_b16 v[234:235], v21 offset:17408
v_mfma_f32_16x16x32_bf16 a[116:119], v[248:251], v[168:171], a[116:119]
v_mfma_f32_16x16x32_bf16 a[116:119], v[252:255], v[172:175], a[116:119]
v_mfma_f32_16x16x32_bf16 a[112:115], v[252:255], v[164:167], a[112:115]
v_mfma_f32_16x16x32_bf16 a[112:115], v[248:251], v[160:163], a[112:115]
ds_read_b64_tr_b16 v[236:237], v21 offset:24576
v_mfma_f32_16x16x32_bf16 a[108:111], v[248:251], v[152:155], a[108:111]
v_mfma_f32_16x16x32_bf16 a[108:111], v[252:255], v[156:159], a[108:111]
v_mfma_f32_16x16x32_bf16 a[104:107], v[252:255], v[148:151], a[104:107]
ds_read_b64_tr_b16 v[238:239], v21 offset:25600
v_mfma_f32_16x16x32_bf16 a[104:107], v[248:251], v[144:147], a[104:107]
v_mfma_f32_16x16x32_bf16 a[100:103], v[248:251], v[136:139], a[100:103]
v_mfma_f32_16x16x32_bf16 a[100:103], v[252:255], v[140:143], a[100:103]
v_mfma_f32_16x16x32_bf16 a[96:99], v[252:255], v[132:135], a[96:99]
v_mfma_f32_16x16x32_bf16 a[96:99], v[248:251], v[128:131], a[96:99]
s_waitcnt lgkmcnt(4)
v_mfma_f32_16x16x32_bf16 a[128:131], v[128:131], v[224:227], a[128:131]
ds_read_b64_tr_b16 v[240:241], v22 offset:16384
v_mfma_f32_16x16x32_bf16 a[128:131], v[132:135], v[228:231], a[128:131]
v_mfma_f32_16x16x32_bf16 a[132:135], v[140:143], v[228:231], a[132:135]
v_mfma_f32_16x16x32_bf16 a[132:135], v[136:139], v[224:227], a[132:135]
ds_read_b64_tr_b16 v[242:243], v22 offset:17408
v_mfma_f32_16x16x32_bf16 a[136:139], v[144:147], v[224:227], a[136:139]
v_mfma_f32_16x16x32_bf16 a[136:139], v[148:151], v[228:231], a[136:139]
v_mfma_f32_16x16x32_bf16 a[140:143], v[156:159], v[228:231], a[140:143]
v_mfma_f32_16x16x32_bf16 a[140:143], v[152:155], v[224:227], a[140:143]
ds_read_b64_tr_b16 v[244:245], v22 offset:24576
v_mfma_f32_16x16x32_bf16 a[144:147], v[160:163], v[224:227], a[144:147]
v_mfma_f32_16x16x32_bf16 a[144:147], v[164:167], v[228:231], a[144:147]
v_mfma_f32_16x16x32_bf16 a[148:151], v[172:175], v[228:231], a[148:151]
ds_read_b64_tr_b16 v[246:247], v22 offset:25600
v_mfma_f32_16x16x32_bf16 a[148:151], v[168:171], v[224:227], a[148:151]
v_mfma_f32_16x16x32_bf16 a[152:155], v[176:179], v[224:227], a[152:155]
v_mfma_f32_16x16x32_bf16 a[152:155], v[180:183], v[228:231], a[152:155]
v_mfma_f32_16x16x32_bf16 a[156:159], v[188:191], v[228:231], a[156:159]
v_mfma_f32_16x16x32_bf16 a[156:159], v[184:187], v[224:227], a[156:159]
s_waitcnt lgkmcnt(4)
v_mfma_f32_16x16x32_bf16 a[188:191], v[184:187], v[232:235], a[188:191]
ds_read_b64_tr_b16 v[248:249], v23 offset:16384
v_mfma_f32_16x16x32_bf16 a[188:191], v[188:191], v[236:239], a[188:191]
v_mfma_f32_16x16x32_bf16 a[184:187], v[180:183], v[236:239], a[184:187]
ds_read_b64_tr_b16 v[250:251], v23 offset:17408
v_mfma_f32_16x16x32_bf16 a[184:187], v[176:179], v[232:235], a[184:187]
v_mfma_f32_16x16x32_bf16 a[180:183], v[168:171], v[232:235], a[180:183]
ds_read_b64_tr_b16 v[252:253], v23 offset:24576
v_mfma_f32_16x16x32_bf16 a[180:183], v[172:175], v[236:239], a[180:183]
v_mfma_f32_16x16x32_bf16 a[176:179], v[164:167], v[236:239], a[176:179]
ds_read_b64_tr_b16 v[254:255], v23 offset:25600
v_mfma_f32_16x16x32_bf16 a[176:179], v[160:163], v[232:235], a[176:179]
v_mfma_f32_16x16x32_bf16 a[172:175], v[152:155], v[232:235], a[172:175]
v_mfma_f32_16x16x32_bf16 a[172:175], v[156:159], v[236:239], a[172:175]
v_mfma_f32_16x16x32_bf16 a[168:171], v[148:151], v[236:239], a[168:171]
v_mfma_f32_16x16x32_bf16 a[168:171], v[144:147], v[232:235], a[168:171]
v_mfma_f32_16x16x32_bf16 a[164:167], v[136:139], v[232:235], a[164:167]
v_mfma_f32_16x16x32_bf16 a[164:167], v[140:143], v[236:239], a[164:167]
v_mfma_f32_16x16x32_bf16 a[160:163], v[132:135], v[236:239], a[160:163]
s_waitcnt vmcnt(6) lgkmcnt(0)
v_mfma_f32_16x16x32_bf16 a[160:163], v[128:131], v[232:235], a[160:163]
s_barrier
v_mfma_f32_16x16x32_bf16 a[192:195], v[128:131], v[240:243], a[192:195]
s_and_b32 s73, s65, 1
ds_read_b64_tr_b16 v[224:225], v20 offset:32768
v_mfma_f32_16x16x32_bf16 a[192:195], v[132:135], v[244:247], a[192:195]
s_xor_b32 s73, s73, 4
ds_read_b64_tr_b16 v[226:227], v20 offset:33792
v_mfma_f32_16x16x32_bf16 a[196:199], v[140:143], v[244:247], a[196:199]
s_lshl_b32 s69, s73, 7
ds_read_b64_tr_b16 v[228:229], v20 offset:40960
v_mfma_f32_16x16x32_bf16 a[196:199], v[136:139], v[240:243], a[196:199]
s_add_u32 s69, s69, s84
ds_read_b64_tr_b16 v[230:231], v20 offset:41984
v_mfma_f32_16x16x32_bf16 a[200:203], v[144:147], v[240:243], a[200:203]
s_lshl_b32 s71, s73, 19
ds_read_b128 v[192:195], v24 offset:32768
v_mfma_f32_16x16x32_bf16 a[200:203], v[148:151], v[244:247], a[200:203]
s_add_u32 s71, s71, s66
ds_read_b128 v[196:199], v25 offset:32768
v_mfma_f32_16x16x32_bf16 a[204:207], v[156:159], v[244:247], a[204:207]
s_add_u32 m0, s63, 65536
v_mfma_f32_16x16x32_bf16 a[204:207], v[152:155], v[240:243], a[204:207]
s_add_u32 s72, s69, 0
buffer_load_dwordx4 v2, s[8:11], s72 offen lds
v_mfma_f32_16x16x32_bf16 a[208:211], v[160:163], v[240:243], a[208:211]
s_add_u32 s72, s69, 7168
buffer_load_dwordx4 v3, s[8:11], s72 offen offset:1024 lds
v_mfma_f32_16x16x32_bf16 a[208:211], v[164:167], v[244:247], a[208:211]
s_add_u32 s72, s69, 14336
buffer_load_dwordx4 v2, s[8:11], s72 offen offset:2048 lds
v_mfma_f32_16x16x32_bf16 a[212:215], v[172:175], v[244:247], a[212:215]
ds_read_b128 v[200:203], v24 offset:34816
v_mfma_f32_16x16x32_bf16 a[212:215], v[168:171], v[240:243], a[212:215]
ds_read_b128 v[204:207], v25 offset:34816
v_mfma_f32_16x16x32_bf16 a[216:219], v[176:179], v[240:243], a[216:219]
s_add_u32 s72, s69, 21504
buffer_load_dwordx4 v3, s[8:11], s72 offen offset:3072 lds
v_mfma_f32_16x16x32_bf16 a[216:219], v[180:183], v[244:247], a[216:219]
ds_read_b128 v[208:211], v24 offset:36864
v_mfma_f32_16x16x32_bf16 a[220:223], v[188:191], v[244:247], a[220:223]
ds_read_b128 v[212:215], v25 offset:36864
v_mfma_f32_16x16x32_bf16 a[220:223], v[184:187], v[240:243], a[220:223]
ds_read_b128 v[216:219], v24 offset:38912
v_mfma_f32_16x16x32_bf16 a[252:255], v[184:187], v[248:251], a[252:255]
ds_read_b128 v[220:223], v25 offset:38912
v_mfma_f32_16x16x32_bf16 a[252:255], v[188:191], v[252:255], a[252:255]
s_add_u32 m0, s64, 0
v_mfma_f32_16x16x32_bf16 a[248:251], v[180:183], v[252:255], a[248:251]
s_add_u32 s72, s71, 0
buffer_load_dwordx4 v6, s[16:19], s72 offen lds
v_mfma_f32_16x16x32_bf16 a[248:251], v[176:179], v[248:251], a[248:251]
ds_read_b128 v[184:187], v24 offset:40960
v_mfma_f32_16x16x32_bf16 a[244:247], v[168:171], v[248:251], a[244:247]
ds_read_b128 v[188:191], v25 offset:40960
v_mfma_f32_16x16x32_bf16 a[244:247], v[172:175], v[252:255], a[244:247]
s_add_u32 s72, s71, 31744
buffer_load_dwordx4 v6, s[16:19], s72 offen offset:1024 lds
v_mfma_f32_16x16x32_bf16 a[240:243], v[164:167], v[252:255], a[240:243]
ds_read_b128 v[176:179], v24 offset:43008
v_mfma_f32_16x16x32_bf16 a[240:243], v[160:163], v[248:251], a[240:243]
ds_read_b128 v[180:183], v25 offset:43008
v_mfma_f32_16x16x32_bf16 a[236:239], v[152:155], v[248:251], a[236:239]
ds_read_b128 v[168:171], v24 offset:45056
v_mfma_f32_16x16x32_bf16 a[236:239], v[156:159], v[252:255], a[236:239]
s_add_u32 s72, s71, 63488
buffer_load_dwordx4 v7, s[16:19], s72 offen offset:2048 lds
v_mfma_f32_16x16x32_bf16 a[232:235], v[148:151], v[252:255], a[232:235]
ds_read_b128 v[172:175], v25 offset:45056
v_mfma_f32_16x16x32_bf16 a[232:235], v[144:147], v[248:251], a[232:235]
ds_read_b128 v[160:163], v24 offset:47104
v_mfma_f32_16x16x32_bf16 a[228:231], v[136:139], v[248:251], a[228:231]
ds_read_b128 v[164:167], v25 offset:47104
v_mfma_f32_16x16x32_bf16 a[228:231], v[140:143], v[252:255], a[228:231]
v_mfma_f32_16x16x32_bf16 a[224:227], v[132:135], v[252:255], a[224:227]
s_add_u32 s72, s71, 95232
buffer_load_dwordx4 v7, s[16:19], s72 offen offset:3072 lds
v_mfma_f32_16x16x32_bf16 a[224:227], v[128:131], v[248:251], a[224:227]
s_waitcnt lgkmcnt(8)
ds_read_b64_tr_b16 v[232:233], v21 offset:32768
v_mfma_f32_16x16x32_bf16 a[0:3], v[224:227], v[192:195], a[0:3]
ds_read_b64_tr_b16 v[234:235], v21 offset:33792
v_mfma_f32_16x16x32_bf16 a[0:3], v[228:231], v[196:199], a[0:3]
ds_read_b64_tr_b16 v[240:241], v22 offset:32768
v_mfma_f32_16x16x32_bf16 a[4:7], v[228:231], v[204:207], a[4:7]
s_add_u32 m0, s63, 69632
ds_read_b64_tr_b16 v[236:237], v21 offset:40960
v_mfma_f32_16x16x32_bf16 a[4:7], v[224:227], v[200:203], a[4:7]
s_add_u32 s72, s69, 32768
buffer_load_dwordx4 v2, s[8:11], s72 offen lds
v_mfma_f32_16x16x32_bf16 a[8:11], v[224:227], v[208:211], a[8:11]
ds_read_b64_tr_b16 v[238:239], v21 offset:41984
v_mfma_f32_16x16x32_bf16 a[8:11], v[228:231], v[212:215], a[8:11]
v_mfma_f32_16x16x32_bf16 a[12:15], v[228:231], v[220:223], a[12:15]
s_add_u32 s72, s69, 39936
buffer_load_dwordx4 v3, s[8:11], s72 offen offset:1024 lds
v_mfma_f32_16x16x32_bf16 a[12:15], v[224:227], v[216:219], a[12:15]
s_waitcnt lgkmcnt(5)
ds_read_b64_tr_b16 v[242:243], v22 offset:33792
v_mfma_f32_16x16x32_bf16 a[16:19], v[224:227], v[184:187], a[16:19]
v_mfma_f32_16x16x32_bf16 a[16:19], v[228:231], v[188:191], a[16:19]
ds_read_b64_tr_b16 v[244:245], v22 offset:40960
v_mfma_f32_16x16x32_bf16 a[20:23], v[228:231], v[180:183], a[20:23]
v_mfma_f32_16x16x32_bf16 a[20:23], v[224:227], v[176:179], a[20:23]
s_add_u32 s72, s69, 47104
buffer_load_dwordx4 v2, s[8:11], s72 offen offset:2048 lds
v_mfma_f32_16x16x32_bf16 a[24:27], v[224:227], v[168:171], a[24:27]
ds_read_b64_tr_b16 v[246:247], v22 offset:41984
v_mfma_f32_16x16x32_bf16 a[24:27], v[228:231], v[172:175], a[24:27]
v_mfma_f32_16x16x32_bf16 a[28:31], v[228:231], v[164:167], a[28:31]
v_mfma_f32_16x16x32_bf16 a[28:31], v[224:227], v[160:163], a[28:31]
s_waitcnt lgkmcnt(3)
v_mfma_f32_16x16x32_bf16 a[60:63], v[232:235], v[160:163], a[60:63]
s_add_u32 s72, s69, 54272
buffer_load_dwordx4 v3, s[8:11], s72 offen offset:3072 lds
v_mfma_f32_16x16x32_bf16 a[60:63], v[236:239], v[164:167], a[60:63]
ds_read_b64_tr_b16 v[248:249], v23 offset:32768
v_mfma_f32_16x16x32_bf16 a[56:59], v[236:239], v[172:175], a[56:59]
v_mfma_f32_16x16x32_bf16 a[56:59], v[232:235], v[168:171], a[56:59]
s_add_u32 m0, s64, 16384
ds_read_b64_tr_b16 v[250:251], v23 offset:33792
v_mfma_f32_16x16x32_bf16 a[52:55], v[232:235], v[176:179], a[52:55]
s_add_u32 s72, s71, 0
buffer_load_dwordx4 v6, s[20:23], s72 offen lds
v_mfma_f32_16x16x32_bf16 a[52:55], v[236:239], v[180:183], a[52:55]
v_mfma_f32_16x16x32_bf16 a[48:51], v[236:239], v[188:191], a[48:51]
v_mfma_f32_16x16x32_bf16 a[48:51], v[232:235], v[184:187], a[48:51]
ds_read_b64_tr_b16 v[252:253], v23 offset:40960
v_mfma_f32_16x16x32_bf16 a[44:47], v[232:235], v[216:219], a[44:47]
s_add_u32 s72, s71, 31744
buffer_load_dwordx4 v6, s[20:23], s72 offen offset:1024 lds
v_mfma_f32_16x16x32_bf16 a[44:47], v[236:239], v[220:223], a[44:47]
v_mfma_f32_16x16x32_bf16 a[40:43], v[236:239], v[212:215], a[40:43]
ds_read_b64_tr_b16 v[254:255], v23 offset:41984
v_mfma_f32_16x16x32_bf16 a[40:43], v[232:235], v[208:211], a[40:43]
v_mfma_f32_16x16x32_bf16 a[36:39], v[232:235], v[200:203], a[36:39]
s_add_u32 s72, s71, 63488
buffer_load_dwordx4 v7, s[20:23], s72 offen offset:2048 lds
v_mfma_f32_16x16x32_bf16 a[36:39], v[236:239], v[204:207], a[36:39]
v_mfma_f32_16x16x32_bf16 a[32:35], v[236:239], v[196:199], a[32:35]
v_mfma_f32_16x16x32_bf16 a[32:35], v[232:235], v[192:195], a[32:35]
s_waitcnt lgkmcnt(4)
v_mfma_f32_16x16x32_bf16 a[64:67], v[240:243], v[192:195], a[64:67]
s_add_u32 s72, s71, 95232
buffer_load_dwordx4 v7, s[20:23], s72 offen offset:3072 lds
v_mfma_f32_16x16x32_bf16 a[64:67], v[244:247], v[196:199], a[64:67]
buffer_load_dwordx4 v[108:111], v1, s[4:7], s76 offen
v_mfma_f32_16x16x32_bf16 a[68:71], v[244:247], v[204:207], a[68:71]
buffer_load_dwordx4 v[112:115], v1, s[4:7], s76 offen offset:1024
v_mfma_f32_16x16x32_bf16 a[68:71], v[240:243], v[200:203], a[68:71]
buffer_load_dwordx4 v[116:119], v1, s[4:7], s76 offen offset:2048
v_mfma_f32_16x16x32_bf16 a[72:75], v[240:243], v[208:211], a[72:75]
buffer_load_dwordx4 v[120:123], v1, s[4:7], s76 offen offset:3072
v_mfma_f32_16x16x32_bf16 a[72:75], v[244:247], v[212:215], a[72:75]
ds_read_b64_tr_b16 v[224:225], v20 offset:49152
v_mfma_f32_16x16x32_bf16 a[76:79], v[244:247], v[220:223], a[76:79]
v_mfma_f32_16x16x32_bf16 a[76:79], v[240:243], v[216:219], a[76:79]
ds_read_b64_tr_b16 v[226:227], v20 offset:50176
v_mfma_f32_16x16x32_bf16 a[80:83], v[240:243], v[184:187], a[80:83]
v_mfma_f32_16x16x32_bf16 a[80:83], v[244:247], v[188:191], a[80:83]
ds_read_b64_tr_b16 v[228:229], v20 offset:57344
v_mfma_f32_16x16x32_bf16 a[84:87], v[244:247], v[180:183], a[84:87]
v_mfma_f32_16x16x32_bf16 a[84:87], v[240:243], v[176:179], a[84:87]
ds_read_b64_tr_b16 v[230:231], v20 offset:58368
v_mfma_f32_16x16x32_bf16 a[88:91], v[240:243], v[168:171], a[88:91]
v_mfma_f32_16x16x32_bf16 a[88:91], v[244:247], v[172:175], a[88:91]
v_mfma_f32_16x16x32_bf16 a[92:95], v[244:247], v[164:167], a[92:95]
v_mfma_f32_16x16x32_bf16 a[92:95], v[240:243], v[160:163], a[92:95]
s_waitcnt lgkmcnt(4)
v_mfma_f32_16x16x32_bf16 a[124:127], v[248:251], v[160:163], a[124:127]
ds_read_b64_tr_b16 v[232:233], v21 offset:49152
v_mfma_f32_16x16x32_bf16 a[124:127], v[252:255], v[164:167], a[124:127]
v_mfma_f32_16x16x32_bf16 a[120:123], v[252:255], v[172:175], a[120:123]
v_mfma_f32_16x16x32_bf16 a[120:123], v[248:251], v[168:171], a[120:123]
ds_read_b64_tr_b16 v[234:235], v21 offset:50176
v_mfma_f32_16x16x32_bf16 a[116:119], v[248:251], v[176:179], a[116:119]
s_waitcnt vmcnt(20)
ds_read2_b32 v[36:37], v98 offset0:0 offset1:32
ds_read2_b32 v[38:39], v98 offset0:64 offset1:96
v_mfma_f32_16x16x32_bf16 a[116:119], v[252:255], v[180:183], a[116:119]
ds_read2_b32 v[40:41], v98 offset0:128 offset1:160
ds_read2_b32 v[42:43], v98 offset0:192 offset1:224
v_mfma_f32_16x16x32_bf16 a[112:115], v[252:255], v[188:191], a[112:115]
v_add_u32 v98, 1024, v98
v_mfma_f32_16x16x32_bf16 a[112:115], v[248:251], v[184:187], a[112:115]
ds_read_b64_tr_b16 v[236:237], v21 offset:57344
ds_read2_b32 v[44:45], v98 offset0:0 offset1:32
v_mfma_f32_16x16x32_bf16 a[108:111], v[248:251], v[216:219], a[108:111]
ds_read2_b32 v[46:47], v98 offset0:64 offset1:96
ds_read2_b32 v[48:49], v98 offset0:128 offset1:160
v_mfma_f32_16x16x32_bf16 a[108:111], v[252:255], v[220:223], a[108:111]
ds_read2_b32 v[50:51], v98 offset0:192 offset1:224
v_add_u32 v98, 3072, v98
v_mfma_f32_16x16x32_bf16 a[104:107], v[252:255], v[212:215], a[104:107]
ds_read_b64_tr_b16 v[238:239], v21 offset:58368
ds_read2_b32 v[52:53], v98 offset0:0 offset1:32
v_mfma_f32_16x16x32_bf16 a[104:107], v[248:251], v[208:211], a[104:107]
ds_read2_b32 v[54:55], v98 offset0:64 offset1:96
ds_read2_b32 v[56:57], v98 offset0:128 offset1:160
v_mfma_f32_16x16x32_bf16 a[100:103], v[248:251], v[200:203], a[100:103]
ds_read2_b32 v[58:59], v98 offset0:192 offset1:224
v_add_u32 v98, 1024, v98
v_mfma_f32_16x16x32_bf16 a[100:103], v[252:255], v[204:207], a[100:103]
ds_read2_b32 v[60:61], v98 offset0:0 offset1:32
ds_read2_b32 v[62:63], v98 offset0:64 offset1:96
v_mfma_f32_16x16x32_bf16 a[96:99], v[252:255], v[196:199], a[96:99]
ds_read2_b32 v[64:65], v98 offset0:128 offset1:160
ds_read2_b32 v[66:67], v98 offset0:192 offset1:224
v_mfma_f32_16x16x32_bf16 a[96:99], v[248:251], v[192:195], a[96:99]
s_waitcnt lgkmcnt(15)
v_mfma_f32_16x16x32_bf16 a[128:131], v[192:195], v[224:227], a[128:131]
ds_read_b64_tr_b16 v[240:241], v22 offset:49152
v_mfma_f32_16x16x32_bf16 a[128:131], v[196:199], v[228:231], a[128:131]
v_mfma_f32_16x16x32_bf16 a[132:135], v[204:207], v[228:231], a[132:135]
v_mfma_f32_16x16x32_bf16 a[132:135], v[200:203], v[224:227], a[132:135]
ds_read_b64_tr_b16 v[242:243], v22 offset:50176
v_mfma_f32_16x16x32_bf16 a[136:139], v[208:211], v[224:227], a[136:139]
v_mfma_f32_16x16x32_bf16 a[136:139], v[212:215], v[228:231], a[136:139]
v_mfma_f32_16x16x32_bf16 a[140:143], v[220:223], v[228:231], a[140:143]
v_mfma_f32_16x16x32_bf16 a[140:143], v[216:219], v[224:227], a[140:143]
ds_read_b64_tr_b16 v[244:245], v22 offset:57344
v_mfma_f32_16x16x32_bf16 a[144:147], v[184:187], v[224:227], a[144:147]
v_mfma_f32_16x16x32_bf16 a[144:147], v[188:191], v[228:231], a[144:147]
v_mfma_f32_16x16x32_bf16 a[148:151], v[180:183], v[228:231], a[148:151]
ds_read_b64_tr_b16 v[246:247], v22 offset:58368
v_mfma_f32_16x16x32_bf16 a[148:151], v[176:179], v[224:227], a[148:151]
v_mfma_f32_16x16x32_bf16 a[152:155], v[168:171], v[224:227], a[152:155]
v_mfma_f32_16x16x32_bf16 a[152:155], v[172:175], v[228:231], a[152:155]
v_mfma_f32_16x16x32_bf16 a[156:159], v[164:167], v[228:231], a[156:159]
v_mfma_f32_16x16x32_bf16 a[156:159], v[160:163], v[224:227], a[156:159]
s_waitcnt lgkmcnt(12)
v_mfma_f32_16x16x32_bf16 a[188:191], v[160:163], v[232:235], a[188:191]
ds_read_b64_tr_b16 v[248:249], v23 offset:49152
v_mfma_f32_16x16x32_bf16 a[188:191], v[164:167], v[236:239], a[188:191]
v_mfma_f32_16x16x32_bf16 a[184:187], v[172:175], v[236:239], a[184:187]
ds_read_b64_tr_b16 v[250:251], v23 offset:50176
v_mfma_f32_16x16x32_bf16 a[184:187], v[168:171], v[232:235], a[184:187]
v_mfma_f32_16x16x32_bf16 a[180:183], v[176:179], v[232:235], a[180:183]
ds_read_b64_tr_b16 v[252:253], v23 offset:57344
v_mfma_f32_16x16x32_bf16 a[180:183], v[180:183], v[236:239], a[180:183]
v_mfma_f32_16x16x32_bf16 a[176:179], v[188:191], v[236:239], a[176:179]
ds_read_b64_tr_b16 v[254:255], v23 offset:58368
v_mfma_f32_16x16x32_bf16 a[176:179], v[184:187], v[232:235], a[176:179]
v_mfma_f32_16x16x32_bf16 a[172:175], v[216:219], v[232:235], a[172:175]
v_mfma_f32_16x16x32_bf16 a[172:175], v[220:223], v[236:239], a[172:175]
v_mfma_f32_16x16x32_bf16 a[168:171], v[212:215], v[236:239], a[168:171]
v_mfma_f32_16x16x32_bf16 a[168:171], v[208:211], v[232:235], a[168:171]
v_mfma_f32_16x16x32_bf16 a[164:167], v[200:203], v[232:235], a[164:167]
v_mfma_f32_16x16x32_bf16 a[164:167], v[204:207], v[236:239], a[164:167]
v_mfma_f32_16x16x32_bf16 a[160:163], v[196:199], v[236:239], a[160:163]
s_waitcnt vmcnt(4) lgkmcnt(0)
v_mfma_f32_16x16x32_bf16 a[160:163], v[192:195], v[232:235], a[160:163]
s_barrier
v_mfma_f32_16x16x32_bf16 a[192:195], v[192:195], v[240:243], a[192:195]
s_and_b32 s73, s65, 1
ds_read_b64_tr_b16 v[224:225], v20 offset:0
v_lshlrev_b32 v72, 16, v68
v_mfma_f32_16x16x32_bf16 a[192:195], v[196:199], v[244:247], a[192:195]
s_xor_b32 s73, s73, 5
ds_read_b64_tr_b16 v[226:227], v20 offset:1024
v_and_b32 v73, 0xffff0000, v68
v_mfma_f32_16x16x32_bf16 a[196:199], v[204:207], v[244:247], a[196:199]
s_lshl_b32 s69, s73, 7
ds_read_b64_tr_b16 v[228:229], v20 offset:8192
v_lshlrev_b32 v74, 16, v69
v_mfma_f32_16x16x32_bf16 a[196:199], v[200:203], v[240:243], a[196:199]
s_add_u32 s69, s69, s84
ds_read_b64_tr_b16 v[230:231], v20 offset:9216
v_and_b32 v75, 0xffff0000, v69
v_mfma_f32_16x16x32_bf16 a[200:203], v[208:211], v[240:243], a[200:203]
s_lshl_b32 s71, s73, 19
ds_read_b128 v[128:131], v24 offset:0
v_lshlrev_b32 v76, 16, v33
v_mfma_f32_16x16x32_bf16 a[200:203], v[212:215], v[244:247], a[200:203]
s_add_u32 s71, s71, s66
ds_read_b128 v[132:135], v25 offset:0
v_lshlrev_b32 v77, 16, v34
v_mfma_f32_16x16x32_bf16 a[204:207], v[220:223], v[244:247], a[204:207]
s_add_u32 m0, s63, 98304
v_lshlrev_b32 v78, 16, v35
v_lshlrev_b32 v79, 16, v36
v_mfma_f32_16x16x32_bf16 a[204:207], v[216:219], v[240:243], a[204:207]
s_add_u32 s72, s69, 0
buffer_load_dwordx4 v2, s[8:11], s72 offen lds
v_mfma_f32_16x16x32_bf16 a[208:211], v[184:187], v[240:243], a[208:211]
s_add_u32 s72, s69, 7168
buffer_load_dwordx4 v3, s[8:11], s72 offen offset:1024 lds
v_mfma_f32_16x16x32_bf16 a[208:211], v[188:191], v[244:247], a[208:211]
s_add_u32 s72, s69, 14336
buffer_load_dwordx4 v2, s[8:11], s72 offen offset:2048 lds
v_mfma_f32_16x16x32_bf16 a[212:215], v[180:183], v[244:247], a[212:215]
ds_read_b128 v[136:139], v24 offset:2048
v_lshlrev_b32 v80, 16, v37
v_mfma_f32_16x16x32_bf16 a[212:215], v[176:179], v[240:243], a[212:215]
ds_read_b128 v[140:143], v25 offset:2048
v_lshlrev_b32 v81, 16, v38
v_mfma_f32_16x16x32_bf16 a[216:219], v[168:171], v[240:243], a[216:219]
s_add_u32 s72, s69, 21504
buffer_load_dwordx4 v3, s[8:11], s72 offen offset:3072 lds
v_mfma_f32_16x16x32_bf16 a[216:219], v[172:175], v[244:247], a[216:219]
ds_read_b128 v[144:147], v24 offset:4096
v_lshlrev_b32 v82, 16, v39
v_mfma_f32_16x16x32_bf16 a[220:223], v[164:167], v[244:247], a[220:223]
ds_read_b128 v[148:151], v25 offset:4096
v_lshlrev_b32 v83, 16, v40
v_mfma_f32_16x16x32_bf16 a[220:223], v[160:163], v[240:243], a[220:223]
ds_read_b128 v[152:155], v24 offset:6144
v_lshlrev_b32 v84, 16, v41
v_mfma_f32_16x16x32_bf16 a[252:255], v[160:163], v[248:251], a[252:255]
ds_read_b128 v[156:159], v25 offset:6144
v_lshlrev_b32 v85, 16, v42
v_mfma_f32_16x16x32_bf16 a[252:255], v[164:167], v[252:255], a[252:255]
s_add_u32 m0, s64, 32768
v_lshlrev_b32 v86, 16, v43
v_lshlrev_b32 v87, 16, v44
v_mfma_f32_16x16x32_bf16 a[248:251], v[172:175], v[252:255], a[248:251]
s_add_u32 s72, s71, 0
buffer_load_dwordx4 v6, s[16:19], s72 offen lds
v_mfma_f32_16x16x32_bf16 a[248:251], v[168:171], v[248:251], a[248:251]
ds_read_b128 v[160:163], v24 offset:8192
v_lshlrev_b32 v88, 16, v45
v_mfma_f32_16x16x32_bf16 a[244:247], v[176:179], v[248:251], a[244:247]
ds_read_b128 v[164:167], v25 offset:8192
v_lshlrev_b32 v89, 16, v46
v_mfma_f32_16x16x32_bf16 a[244:247], v[180:183], v[252:255], a[244:247]
s_add_u32 s72, s71, 31744
buffer_load_dwordx4 v6, s[16:19], s72 offen offset:1024 lds
v_mfma_f32_16x16x32_bf16 a[240:243], v[188:191], v[252:255], a[240:243]
ds_read_b128 v[168:171], v24 offset:10240
v_lshlrev_b32 v90, 16, v47
v_mfma_f32_16x16x32_bf16 a[240:243], v[184:187], v[248:251], a[240:243]
ds_read_b128 v[172:175], v25 offset:10240
v_lshlrev_b32 v91, 16, v48
v_mfma_f32_16x16x32_bf16 a[236:239], v[216:219], v[248:251], a[236:239]
ds_read_b128 v[176:179], v24 offset:12288
v_lshlrev_b32 v92, 16, v49
v_mfma_f32_16x16x32_bf16 a[236:239], v[220:223], v[252:255], a[236:239]
s_add_u32 s72, s71, 63488
buffer_load_dwordx4 v7, s[16:19], s72 offen offset:2048 lds
v_mfma_f32_16x16x32_bf16 a[232:235], v[212:215], v[252:255], a[232:235]
ds_read_b128 v[180:183], v25 offset:12288
v_lshlrev_b32 v93, 16, v50
v_mfma_f32_16x16x32_bf16 a[232:235], v[208:211], v[248:251], a[232:235]
ds_read_b128 v[184:187], v24 offset:14336
v_lshlrev_b32 v94, 16, v51
v_mfma_f32_16x16x32_bf16 a[228:231], v[200:203], v[248:251], a[228:231]
ds_read_b128 v[188:191], v25 offset:14336
v_mul_f32 v95, v75, v91
v_mfma_f32_16x16x32_bf16 a[228:231], v[204:207], v[252:255], a[228:231]
v_lshlrev_b32 v97, 16, v67
v_fmac_f32 v95, v74, v92
v_mfma_f32_16x16x32_bf16 a[224:227], v[196:199], v[252:255], a[224:227]
s_add_u32 s72, s71, 95232
buffer_load_dwordx4 v7, s[16:19], s72 offen offset:3072 lds
v_mfma_f32_16x16x32_bf16 a[224:227], v[192:195], v[248:251], a[224:227]
s_waitcnt lgkmcnt(8)
ds_read_b64_tr_b16 v[232:233], v21 offset:0
v_fmac_f32 v95, v73, v93
v_mfma_f32_16x16x32_bf16 a[0:3], v[224:227], v[128:131], a[0:3]
ds_read_b64_tr_b16 v[234:235], v21 offset:1024
v_fmac_f32 v95, v72, v94
v_mfma_f32_16x16x32_bf16 a[0:3], v[228:231], v[132:135], a[0:3]
ds_read_b64_tr_b16 v[240:241], v22 offset:0
v_mul_f32 v95, v95, v97
v_mfma_f32_16x16x32_bf16 a[4:7], v[228:231], v[140:143], a[4:7]
s_add_u32 m0, s63, 102400
ds_read_b64_tr_b16 v[236:237], v21 offset:8192
v_mul_f32 v96, v75, v90
v_mfma_f32_16x16x32_bf16 a[4:7], v[224:227], v[136:139], a[4:7]
s_add_u32 s72, s69, 32768
buffer_load_dwordx4 v2, s[8:11], s72 offen lds
v_mfma_f32_16x16x32_bf16 a[8:11], v[224:227], v[144:147], a[8:11]
ds_read_b64_tr_b16 v[238:239], v21 offset:9216
v_lshlrev_b32 v97, 16, v66
v_mfma_f32_16x16x32_bf16 a[8:11], v[228:231], v[148:151], a[8:11]
v_fmac_f32 v96, v74, v91
v_fmac_f32 v96, v73, v92
v_mfma_f32_16x16x32_bf16 a[12:15], v[228:231], v[156:159], a[12:15]
s_add_u32 s72, s69, 39936
buffer_load_dwordx4 v3, s[8:11], s72 offen offset:1024 lds
v_mfma_f32_16x16x32_bf16 a[12:15], v[224:227], v[152:155], a[12:15]
s_waitcnt lgkmcnt(5)
ds_read_b64_tr_b16 v[242:243], v22 offset:1024
v_fmac_f32 v96, v72, v93
v_mfma_f32_16x16x32_bf16 a[16:19], v[224:227], v[160:163], a[16:19]
v_mul_f32 v96, v96, v97
v_cvt_pk_bf16_f32 v100, v95, v96
v_mfma_f32_16x16x32_bf16 a[16:19], v[228:231], v[164:167], a[16:19]
ds_read_b64_tr_b16 v[244:245], v22 offset:8192
v_mul_f32 v95, v75, v89
v_mfma_f32_16x16x32_bf16 a[20:23], v[228:231], v[172:175], a[20:23]
v_lshlrev_b32 v97, 16, v65
v_fmac_f32 v95, v74, v90
v_mfma_f32_16x16x32_bf16 a[20:23], v[224:227], v[168:171], a[20:23]
s_add_u32 s72, s69, 47104
buffer_load_dwordx4 v2, s[8:11], s72 offen offset:2048 lds
v_mfma_f32_16x16x32_bf16 a[24:27], v[224:227], v[176:179], a[24:27]
ds_read_b64_tr_b16 v[246:247], v22 offset:9216
v_fmac_f32 v95, v73, v91
v_mfma_f32_16x16x32_bf16 a[24:27], v[228:231], v[180:183], a[24:27]
v_fmac_f32 v95, v72, v92
v_mul_f32 v95, v95, v97
v_mfma_f32_16x16x32_bf16 a[28:31], v[228:231], v[188:191], a[28:31]
v_mul_f32 v96, v75, v88
v_lshlrev_b32 v97, 16, v64
v_mfma_f32_16x16x32_bf16 a[28:31], v[224:227], v[184:187], a[28:31]
s_waitcnt lgkmcnt(3)
v_fmac_f32 v96, v74, v89
v_fmac_f32 v96, v73, v90
v_mfma_f32_16x16x32_bf16 a[60:63], v[232:235], v[184:187], a[60:63]
s_add_u32 s72, s69, 54272
buffer_load_dwordx4 v3, s[8:11], s72 offen offset:3072 lds
v_mfma_f32_16x16x32_bf16 a[60:63], v[236:239], v[188:191], a[60:63]
ds_read_b64_tr_b16 v[248:249], v23 offset:0
v_fmac_f32 v96, v72, v91
v_mfma_f32_16x16x32_bf16 a[56:59], v[236:239], v[180:183], a[56:59]
v_mul_f32 v96, v96, v97
v_cvt_pk_bf16_f32 v101, v95, v96
v_mfma_f32_16x16x32_bf16 a[56:59], v[232:235], v[176:179], a[56:59]
s_add_u32 m0, s64, 49152
ds_read_b64_tr_b16 v[250:251], v23 offset:1024
v_mul_f32 v95, v75, v87
v_mfma_f32_16x16x32_bf16 a[52:55], v[232:235], v[168:171], a[52:55]
s_add_u32 s72, s71, 0
buffer_load_dwordx4 v6, s[20:23], s72 offen lds
v_mfma_f32_16x16x32_bf16 a[52:55], v[236:239], v[172:175], a[52:55]
v_lshlrev_b32 v97, 16, v63
v_fmac_f32 v95, v74, v88
v_mfma_f32_16x16x32_bf16 a[48:51], v[236:239], v[164:167], a[48:51]
v_fmac_f32 v95, v73, v89
v_fmac_f32 v95, v72, v90
v_mfma_f32_16x16x32_bf16 a[48:51], v[232:235], v[160:163], a[48:51]
ds_read_b64_tr_b16 v[252:253], v23 offset:8192
v_mul_f32 v95, v95, v97
v_mfma_f32_16x16x32_bf16 a[44:47], v[232:235], v[152:155], a[44:47]
s_add_u32 s72, s71, 31744
buffer_load_dwordx4 v6, s[20:23], s72 offen offset:1024 lds
v_mfma_f32_16x16x32_bf16 a[44:47], v[236:239], v[156:159], a[44:47]
v_mul_f32 v96, v75, v86
v_lshlrev_b32 v97, 16, v62
v_mfma_f32_16x16x32_bf16 a[40:43], v[236:239], v[148:151], a[40:43]
ds_read_b64_tr_b16 v[254:255], v23 offset:9216
v_fmac_f32 v96, v74, v87
v_mfma_f32_16x16x32_bf16 a[40:43], v[232:235], v[144:147], a[40:43]
v_fmac_f32 v96, v73, v88
v_fmac_f32 v96, v72, v89
v_mfma_f32_16x16x32_bf16 a[36:39], v[232:235], v[136:139], a[36:39]
s_add_u32 s72, s71, 63488
buffer_load_dwordx4 v7, s[20:23], s72 offen offset:2048 lds
v_mfma_f32_16x16x32_bf16 a[36:39], v[236:239], v[140:143], a[36:39]
v_mul_f32 v96, v96, v97
v_cvt_pk_bf16_f32 v102, v95, v96
v_mfma_f32_16x16x32_bf16 a[32:35], v[236:239], v[132:135], a[32:35]
v_mul_f32 v95, v75, v85
v_lshlrev_b32 v97, 16, v61
v_mfma_f32_16x16x32_bf16 a[32:35], v[232:235], v[128:131], a[32:35]
s_waitcnt lgkmcnt(4)
v_fmac_f32 v95, v74, v86
v_fmac_f32 v95, v73, v87
v_mfma_f32_16x16x32_bf16 a[64:67], v[240:243], v[128:131], a[64:67]
s_add_u32 s72, s71, 95232
buffer_load_dwordx4 v7, s[20:23], s72 offen offset:3072 lds
v_mfma_f32_16x16x32_bf16 a[64:67], v[244:247], v[132:135], a[64:67]
s_mov_b32 s80, 0x0
buffer_load_dword v126, v125, s[12:15], s80 offen
v_mfma_f32_16x16x32_bf16 a[68:71], v[244:247], v[140:143], a[68:71]
s_mov_b32 s80, 0x100000
buffer_load_dword v126, v125, s[12:15], s80 offen
v_mfma_f32_16x16x32_bf16 a[68:71], v[240:243], v[136:139], a[68:71]
s_mov_b32 s80, 0x200000
buffer_load_dword v126, v125, s[12:15], s80 offen
v_mfma_f32_16x16x32_bf16 a[72:75], v[240:243], v[144:147], a[72:75]
s_mov_b32 s80, 0x300000
buffer_load_dword v126, v125, s[12:15], s80 offen
v_mfma_f32_16x16x32_bf16 a[72:75], v[244:247], v[148:151], a[72:75]
ds_read_b64_tr_b16 v[224:225], v20 offset:16384
v_fmac_f32 v95, v72, v88
v_mfma_f32_16x16x32_bf16 a[76:79], v[244:247], v[156:159], a[76:79]
v_mul_f32 v95, v95, v97
v_mul_f32 v96, v75, v84
v_mfma_f32_16x16x32_bf16 a[76:79], v[240:243], v[152:155], a[76:79]
ds_read_b64_tr_b16 v[226:227], v20 offset:17408
v_lshlrev_b32 v97, 16, v60
v_mfma_f32_16x16x32_bf16 a[80:83], v[240:243], v[160:163], a[80:83]
v_fmac_f32 v96, v74, v85
v_fmac_f32 v96, v73, v86
v_mfma_f32_16x16x32_bf16 a[80:83], v[244:247], v[164:167], a[80:83]
ds_read_b64_tr_b16 v[228:229], v20 offset:24576
v_fmac_f32 v96, v72, v87
v_mfma_f32_16x16x32_bf16 a[84:87], v[244:247], v[172:175], a[84:87]
v_mul_f32 v96, v96, v97
v_cvt_pk_bf16_f32 v103, v95, v96
v_mfma_f32_16x16x32_bf16 a[84:87], v[240:243], v[168:171], a[84:87]
ds_read_b64_tr_b16 v[230:231], v20 offset:25600
ds_write_b128 v28, v[100:103] offset:0
v_mfma_f32_16x16x32_bf16 a[88:91], v[240:243], v[176:179], a[88:91]
v_mul_f32 v95, v75, v83
v_lshlrev_b32 v97, 16, v59
v_mfma_f32_16x16x32_bf16 a[88:91], v[244:247], v[180:183], a[88:91]
v_fmac_f32 v95, v74, v84
v_fmac_f32 v95, v73, v85
v_mfma_f32_16x16x32_bf16 a[92:95], v[244:247], v[188:191], a[92:95]
v_fmac_f32 v95, v72, v86
v_mul_f32 v95, v95, v97
v_mfma_f32_16x16x32_bf16 a[92:95], v[240:243], v[184:187], a[92:95]
s_waitcnt lgkmcnt(5)
v_mul_f32 v96, v75, v82
v_lshlrev_b32 v97, 16, v58
v_mfma_f32_16x16x32_bf16 a[124:127], v[248:251], v[184:187], a[124:127]
ds_read_b64_tr_b16 v[232:233], v21 offset:16384
v_fmac_f32 v96, v74, v83
v_mfma_f32_16x16x32_bf16 a[124:127], v[252:255], v[188:191], a[124:127]
v_fmac_f32 v96, v73, v84
v_fmac_f32 v96, v72, v85
v_mfma_f32_16x16x32_bf16 a[120:123], v[252:255], v[180:183], a[120:123]
v_mul_f32 v96, v96, v97
v_cvt_pk_bf16_f32 v104, v95, v96
v_mfma_f32_16x16x32_bf16 a[120:123], v[248:251], v[176:179], a[120:123]
ds_read_b64_tr_b16 v[234:235], v21 offset:17408
v_mul_f32 v95, v75, v81
v_mfma_f32_16x16x32_bf16 a[116:119], v[248:251], v[168:171], a[116:119]
v_lshlrev_b32 v97, 16, v57
v_fmac_f32 v95, v74, v82
v_mfma_f32_16x16x32_bf16 a[116:119], v[252:255], v[172:175], a[116:119]
v_fmac_f32 v95, v73, v83
v_fmac_f32 v95, v72, v84
v_mfma_f32_16x16x32_bf16 a[112:115], v[252:255], v[164:167], a[112:115]
v_mul_f32 v95, v95, v97
v_mul_f32 v96, v75, v80
v_mfma_f32_16x16x32_bf16 a[112:115], v[248:251], v[160:163], a[112:115]
ds_read_b64_tr_b16 v[236:237], v21 offset:24576
v_lshlrev_b32 v97, 16, v56
v_mfma_f32_16x16x32_bf16 a[108:111], v[248:251], v[152:155], a[108:111]
v_fmac_f32 v96, v74, v81
v_fmac_f32 v96, v73, v82
v_mfma_f32_16x16x32_bf16 a[108:111], v[252:255], v[156:159], a[108:111]
v_fmac_f32 v96, v72, v83
v_mul_f32 v96, v96, v97
v_mfma_f32_16x16x32_bf16 a[104:107], v[252:255], v[148:151], a[104:107]
ds_read_b64_tr_b16 v[238:239], v21 offset:25600
v_cvt_pk_bf16_f32 v105, v95, v96
v_mfma_f32_16x16x32_bf16 a[104:107], v[248:251], v[144:147], a[104:107]
v_mul_f32 v95, v75, v79
v_lshlrev_b32 v97, 16, v55
v_mfma_f32_16x16x32_bf16 a[100:103], v[248:251], v[136:139], a[100:103]
v_fmac_f32 v95, v74, v80
v_fmac_f32 v95, v73, v81
v_mfma_f32_16x16x32_bf16 a[100:103], v[252:255], v[140:143], a[100:103]
v_fmac_f32 v95, v72, v82
v_mul_f32 v95, v95, v97
v_mfma_f32_16x16x32_bf16 a[96:99], v[252:255], v[132:135], a[96:99]
v_mul_f32 v96, v75, v78
v_lshlrev_b32 v97, 16, v54
v_mfma_f32_16x16x32_bf16 a[96:99], v[248:251], v[128:131], a[96:99]
s_waitcnt lgkmcnt(5)
v_fmac_f32 v96, v74, v79
v_fmac_f32 v96, v73, v80
v_mfma_f32_16x16x32_bf16 a[128:131], v[128:131], v[224:227], a[128:131]
ds_read_b64_tr_b16 v[240:241], v22 offset:16384
v_fmac_f32 v96, v72, v81
v_mfma_f32_16x16x32_bf16 a[128:131], v[132:135], v[228:231], a[128:131]
v_mul_f32 v96, v96, v97
v_cvt_pk_bf16_f32 v106, v95, v96
v_mfma_f32_16x16x32_bf16 a[132:135], v[140:143], v[228:231], a[132:135]
v_mul_f32 v95, v75, v77
v_lshlrev_b32 v97, 16, v53
v_mfma_f32_16x16x32_bf16 a[132:135], v[136:139], v[224:227], a[132:135]
ds_read_b64_tr_b16 v[242:243], v22 offset:17408
v_fmac_f32 v95, v74, v78
v_mfma_f32_16x16x32_bf16 a[136:139], v[144:147], v[224:227], a[136:139]
v_fmac_f32 v95, v73, v79
v_fmac_f32 v95, v72, v80
v_mfma_f32_16x16x32_bf16 a[136:139], v[148:151], v[228:231], a[136:139]
v_mul_f32 v95, v95, v97
v_mul_f32 v96, v75, v76
v_mfma_f32_16x16x32_bf16 a[140:143], v[156:159], v[228:231], a[140:143]
v_lshlrev_b32 v97, 16, v52
v_fmac_f32 v96, v74, v77
v_mfma_f32_16x16x32_bf16 a[140:143], v[152:155], v[224:227], a[140:143]
ds_read_b64_tr_b16 v[244:245], v22 offset:24576
v_fmac_f32 v96, v73, v78
v_mfma_f32_16x16x32_bf16 a[144:147], v[160:163], v[224:227], a[144:147]
v_fmac_f32 v96, v72, v79
v_mul_f32 v96, v96, v97
v_mfma_f32_16x16x32_bf16 a[144:147], v[164:167], v[228:231], a[144:147]
v_cvt_pk_bf16_f32 v107, v95, v96
v_mfma_f32_16x16x32_bf16 a[148:151], v[172:175], v[228:231], a[148:151]
ds_read_b64_tr_b16 v[246:247], v22 offset:25600
ds_write_b128 v28, v[104:107] offset:16
v_mfma_f32_16x16x32_bf16 a[148:151], v[168:171], v[224:227], a[148:151]
global_load_dwordx4 v[84:87], v1, s[56:57]
v_mfma_f32_16x16x32_bf16 a[152:155], v[176:179], v[224:227], a[152:155]
global_load_dwordx4 v[88:91], v1, s[56:57] offset:1024
v_mfma_f32_16x16x32_bf16 a[152:155], v[180:183], v[228:231], a[152:155]
v_lshlrev_b32 v72, 16, v70
v_and_b32 v73, 0xffff0000, v70
v_mfma_f32_16x16x32_bf16 a[156:159], v[188:191], v[228:231], a[156:159]
v_lshlrev_b32 v74, 16, v71
v_and_b32 v75, 0xffff0000, v71
v_mfma_f32_16x16x32_bf16 a[156:159], v[184:187], v[224:227], a[156:159]
s_waitcnt lgkmcnt(5)
v_and_b32 v33, 0xffff0000, v33
v_and_b32 v34, 0xffff0000, v34
v_mfma_f32_16x16x32_bf16 a[188:191], v[184:187], v[232:235], a[188:191]
ds_read_b64_tr_b16 v[248:249], v23 offset:16384
v_and_b32 v35, 0xffff0000, v35
v_mfma_f32_16x16x32_bf16 a[188:191], v[188:191], v[236:239], a[188:191]
v_and_b32 v36, 0xffff0000, v36
v_and_b32 v37, 0xffff0000, v37
v_mfma_f32_16x16x32_bf16 a[184:187], v[180:183], v[236:239], a[184:187]
ds_read_b64_tr_b16 v[250:251], v23 offset:17408
v_and_b32 v38, 0xffff0000, v38
v_mfma_f32_16x16x32_bf16 a[184:187], v[176:179], v[232:235], a[184:187]
v_and_b32 v39, 0xffff0000, v39
v_and_b32 v40, 0xffff0000, v40
v_mfma_f32_16x16x32_bf16 a[180:183], v[168:171], v[232:235], a[180:183]
ds_read_b64_tr_b16 v[252:253], v23 offset:24576
v_and_b32 v41, 0xffff0000, v41
v_mfma_f32_16x16x32_bf16 a[180:183], v[172:175], v[236:239], a[180:183]
v_and_b32 v42, 0xffff0000, v42
v_and_b32 v43, 0xffff0000, v43
v_mfma_f32_16x16x32_bf16 a[176:179], v[164:167], v[236:239], a[176:179]
ds_read_b64_tr_b16 v[254:255], v23 offset:25600
v_and_b32 v44, 0xffff0000, v44
v_mfma_f32_16x16x32_bf16 a[176:179], v[160:163], v[232:235], a[176:179]
v_and_b32 v45, 0xffff0000, v45
v_and_b32 v46, 0xffff0000, v46
v_mfma_f32_16x16x32_bf16 a[172:175], v[152:155], v[232:235], a[172:175]
v_and_b32 v47, 0xffff0000, v47
v_and_b32 v48, 0xffff0000, v48
v_mfma_f32_16x16x32_bf16 a[172:175], v[156:159], v[236:239], a[172:175]
v_and_b32 v49, 0xffff0000, v49
v_and_b32 v50, 0xffff0000, v50
v_mfma_f32_16x16x32_bf16 a[168:171], v[148:151], v[236:239], a[168:171]
v_and_b32 v51, 0xffff0000, v51
v_mul_f32 v95, v75, v48
v_mfma_f32_16x16x32_bf16 a[168:171], v[144:147], v[232:235], a[168:171]
v_and_b32 v97, 0xffff0000, v67
v_fmac_f32 v95, v74, v49
v_mfma_f32_16x16x32_bf16 a[164:167], v[136:139], v[232:235], a[164:167]
v_fmac_f32 v95, v73, v50
v_fmac_f32 v95, v72, v51
v_mfma_f32_16x16x32_bf16 a[164:167], v[140:143], v[236:239], a[164:167]
v_mul_f32 v95, v95, v97
v_mul_f32 v96, v75, v47
v_mfma_f32_16x16x32_bf16 a[160:163], v[132:135], v[236:239], a[160:163]
s_waitcnt vmcnt(6) lgkmcnt(0)
v_and_b32 v97, 0xffff0000, v66
v_fmac_f32 v96, v74, v48
v_mfma_f32_16x16x32_bf16 a[160:163], v[128:131], v[232:235], a[160:163]
s_barrier
v_fmac_f32 v96, v73, v49
v_fmac_f32 v96, v72, v50
v_mfma_f32_16x16x32_bf16 a[192:195], v[128:131], v[240:243], a[192:195]
s_and_b32 s73, s65, 1
ds_read_b64_tr_b16 v[224:225], v20 offset:32768
v_mul_f32 v96, v96, v97
v_mfma_f32_16x16x32_bf16 a[192:195], v[132:135], v[244:247], a[192:195]
s_xor_b32 s73, s73, 6
ds_read_b64_tr_b16 v[226:227], v20 offset:33792
v_cvt_pk_bf16_f32 v100, v95, v96
v_mfma_f32_16x16x32_bf16 a[196:199], v[140:143], v[244:247], a[196:199]
s_lshl_b32 s69, s73, 7
ds_read_b64_tr_b16 v[228:229], v20 offset:40960
v_mul_f32 v95, v75, v46
v_mfma_f32_16x16x32_bf16 a[196:199], v[136:139], v[240:243], a[196:199]
s_add_u32 s69, s69, s84
ds_read_b64_tr_b16 v[230:231], v20 offset:41984
v_and_b32 v97, 0xffff0000, v65
v_mfma_f32_16x16x32_bf16 a[200:203], v[144:147], v[240:243], a[200:203]
s_lshl_b32 s71, s73, 19
ds_read_b128 v[192:195], v24 offset:32768
v_fmac_f32 v95, v74, v47
v_mfma_f32_16x16x32_bf16 a[200:203], v[148:151], v[244:247], a[200:203]
s_add_u32 s71, s71, s66
ds_read_b128 v[196:199], v25 offset:32768
v_fmac_f32 v95, v73, v48
v_mfma_f32_16x16x32_bf16 a[204:207], v[156:159], v[244:247], a[204:207]
s_add_u32 m0, s63, 65536
v_fmac_f32 v95, v72, v49
v_mul_f32 v95, v95, v97
v_mfma_f32_16x16x32_bf16 a[204:207], v[152:155], v[240:243], a[204:207]
s_add_u32 s72, s69, 0
buffer_load_dwordx4 v2, s[8:11], s72 offen lds
v_mfma_f32_16x16x32_bf16 a[208:211], v[160:163], v[240:243], a[208:211]
s_add_u32 s72, s69, 7168
buffer_load_dwordx4 v3, s[8:11], s72 offen offset:1024 lds
v_mfma_f32_16x16x32_bf16 a[208:211], v[164:167], v[244:247], a[208:211]
s_add_u32 s72, s69, 14336
buffer_load_dwordx4 v2, s[8:11], s72 offen offset:2048 lds
v_mfma_f32_16x16x32_bf16 a[212:215], v[172:175], v[244:247], a[212:215]
ds_read_b128 v[200:203], v24 offset:34816
v_mul_f32 v96, v75, v45
v_mfma_f32_16x16x32_bf16 a[212:215], v[168:171], v[240:243], a[212:215]
ds_read_b128 v[204:207], v25 offset:34816
v_and_b32 v97, 0xffff0000, v64
v_mfma_f32_16x16x32_bf16 a[216:219], v[176:179], v[240:243], a[216:219]
s_add_u32 s72, s69, 21504
buffer_load_dwordx4 v3, s[8:11], s72 offen offset:3072 lds
v_mfma_f32_16x16x32_bf16 a[216:219], v[180:183], v[244:247], a[216:219]
ds_read_b128 v[208:211], v24 offset:36864
v_fmac_f32 v96, v74, v46
v_mfma_f32_16x16x32_bf16 a[220:223], v[188:191], v[244:247], a[220:223]
ds_read_b128 v[212:215], v25 offset:36864
v_fmac_f32 v96, v73, v47
v_mfma_f32_16x16x32_bf16 a[220:223], v[184:187], v[240:243], a[220:223]
ds_read_b128 v[216:219], v24 offset:38912
v_fmac_f32 v96, v72, v48
v_mfma_f32_16x16x32_bf16 a[252:255], v[184:187], v[248:251], a[252:255]
ds_read_b128 v[220:223], v25 offset:38912
v_mul_f32 v96, v96, v97
v_mfma_f32_16x16x32_bf16 a[252:255], v[188:191], v[252:255], a[252:255]
s_add_u32 m0, s64, 0
v_cvt_pk_bf16_f32 v101, v95, v96
v_mul_f32 v95, v75, v44
v_mfma_f32_16x16x32_bf16 a[248:251], v[180:183], v[252:255], a[248:251]
s_add_u32 s72, s71, 0
buffer_load_dwordx4 v6, s[16:19], s72 offen lds
v_mfma_f32_16x16x32_bf16 a[248:251], v[176:179], v[248:251], a[248:251]
ds_read_b128 v[184:187], v24 offset:40960
v_and_b32 v97, 0xffff0000, v63
v_mfma_f32_16x16x32_bf16 a[244:247], v[168:171], v[248:251], a[244:247]
ds_read_b128 v[188:191], v25 offset:40960
v_fmac_f32 v95, v74, v45
v_mfma_f32_16x16x32_bf16 a[244:247], v[172:175], v[252:255], a[244:247]
s_add_u32 s72, s71, 31744
buffer_load_dwordx4 v6, s[16:19], s72 offen offset:1024 lds
v_mfma_f32_16x16x32_bf16 a[240:243], v[164:167], v[252:255], a[240:243]
ds_read_b128 v[176:179], v24 offset:43008
v_fmac_f32 v95, v73, v46
v_mfma_f32_16x16x32_bf16 a[240:243], v[160:163], v[248:251], a[240:243]
ds_read_b128 v[180:183], v25 offset:43008
v_fmac_f32 v95, v72, v47
v_mfma_f32_16x16x32_bf16 a[236:239], v[152:155], v[248:251], a[236:239]
ds_read_b128 v[168:171], v24 offset:45056
v_mul_f32 v95, v95, v97
v_mfma_f32_16x16x32_bf16 a[236:239], v[156:159], v[252:255], a[236:239]
s_add_u32 s72, s71, 63488
buffer_load_dwordx4 v7, s[16:19], s72 offen offset:2048 lds
v_mfma_f32_16x16x32_bf16 a[232:235], v[148:151], v[252:255], a[232:235]
ds_read_b128 v[172:175], v25 offset:45056
v_mul_f32 v96, v75, v43
v_mfma_f32_16x16x32_bf16 a[232:235], v[144:147], v[248:251], a[232:235]
ds_read_b128 v[160:163], v24 offset:47104
v_and_b32 v97, 0xffff0000, v62
v_mfma_f32_16x16x32_bf16 a[228:231], v[136:139], v[248:251], a[228:231]
ds_read_b128 v[164:167], v25 offset:47104
v_fmac_f32 v96, v74, v44
v_mfma_f32_16x16x32_bf16 a[228:231], v[140:143], v[252:255], a[228:231]
v_fmac_f32 v96, v73, v45
v_fmac_f32 v96, v72, v46
v_mfma_f32_16x16x32_bf16 a[224:227], v[132:135], v[252:255], a[224:227]
s_add_u32 s72, s71, 95232
buffer_load_dwordx4 v7, s[16:19], s72 offen offset:3072 lds
v_mfma_f32_16x16x32_bf16 a[224:227], v[128:131], v[248:251], a[224:227]
s_waitcnt lgkmcnt(8)
ds_read_b64_tr_b16 v[232:233], v21 offset:32768
v_mul_f32 v96, v96, v97
v_mfma_f32_16x16x32_bf16 a[0:3], v[224:227], v[192:195], a[0:3]
ds_read_b64_tr_b16 v[234:235], v21 offset:33792
v_cvt_pk_bf16_f32 v102, v95, v96
v_mfma_f32_16x16x32_bf16 a[0:3], v[228:231], v[196:199], a[0:3]
ds_read_b64_tr_b16 v[240:241], v22 offset:32768
v_mul_f32 v95, v75, v42
v_mfma_f32_16x16x32_bf16 a[4:7], v[228:231], v[204:207], a[4:7]
s_add_u32 m0, s63, 69632
ds_read_b64_tr_b16 v[236:237], v21 offset:40960
v_and_b32 v97, 0xffff0000, v61
v_mfma_f32_16x16x32_bf16 a[4:7], v[224:227], v[200:203], a[4:7]
s_add_u32 s72, s69, 32768
buffer_load_dwordx4 v2, s[8:11], s72 offen lds
v_mfma_f32_16x16x32_bf16 a[8:11], v[224:227], v[208:211], a[8:11]
ds_read_b64_tr_b16 v[238:239], v21 offset:41984
v_fmac_f32 v95, v74, v43
v_mfma_f32_16x16x32_bf16 a[8:11], v[228:231], v[212:215], a[8:11]
v_fmac_f32 v95, v73, v44
v_fmac_f32 v95, v72, v45
v_mfma_f32_16x16x32_bf16 a[12:15], v[228:231], v[220:223], a[12:15]
s_add_u32 s72, s69, 39936
buffer_load_dwordx4 v3, s[8:11], s72 offen offset:1024 lds
v_mfma_f32_16x16x32_bf16 a[12:15], v[224:227], v[216:219], a[12:15]
s_waitcnt lgkmcnt(5)
ds_read_b64_tr_b16 v[242:243], v22 offset:33792
v_mul_f32 v95, v95, v97
v_mfma_f32_16x16x32_bf16 a[16:19], v[224:227], v[184:187], a[16:19]
v_mul_f32 v96, v75, v41
v_and_b32 v97, 0xffff0000, v60
v_mfma_f32_16x16x32_bf16 a[16:19], v[228:231], v[188:191], a[16:19]
ds_read_b64_tr_b16 v[244:245], v22 offset:40960
v_fmac_f32 v96, v74, v42
v_mfma_f32_16x16x32_bf16 a[20:23], v[228:231], v[180:183], a[20:23]
v_fmac_f32 v96, v73, v43
v_fmac_f32 v96, v72, v44
v_mfma_f32_16x16x32_bf16 a[20:23], v[224:227], v[176:179], a[20:23]
s_add_u32 s72, s69, 47104
buffer_load_dwordx4 v2, s[8:11], s72 offen offset:2048 lds
v_mfma_f32_16x16x32_bf16 a[24:27], v[224:227], v[168:171], a[24:27]
ds_read_b64_tr_b16 v[246:247], v22 offset:41984
v_mul_f32 v96, v96, v97
v_mfma_f32_16x16x32_bf16 a[24:27], v[228:231], v[172:175], a[24:27]
v_cvt_pk_bf16_f32 v103, v95, v96
v_mfma_f32_16x16x32_bf16 a[28:31], v[228:231], v[164:167], a[28:31]
ds_write_b128 v28, v[100:103] offset:272
v_mul_f32 v95, v75, v40
v_mfma_f32_16x16x32_bf16 a[28:31], v[224:227], v[160:163], a[28:31]
s_waitcnt lgkmcnt(4)
v_and_b32 v97, 0xffff0000, v59
v_fmac_f32 v95, v74, v41
v_mfma_f32_16x16x32_bf16 a[60:63], v[232:235], v[160:163], a[60:63]
s_add_u32 s72, s69, 54272
buffer_load_dwordx4 v3, s[8:11], s72 offen offset:3072 lds
v_mfma_f32_16x16x32_bf16 a[60:63], v[236:239], v[164:167], a[60:63]
ds_read_b64_tr_b16 v[248:249], v23 offset:32768
v_fmac_f32 v95, v73, v42
v_mfma_f32_16x16x32_bf16 a[56:59], v[236:239], v[172:175], a[56:59]
v_fmac_f32 v95, v72, v43
v_mul_f32 v95, v95, v97
v_mfma_f32_16x16x32_bf16 a[56:59], v[232:235], v[168:171], a[56:59]
s_add_u32 m0, s64, 16384
ds_read_b64_tr_b16 v[250:251], v23 offset:33792
v_mul_f32 v96, v75, v39
v_mfma_f32_16x16x32_bf16 a[52:55], v[232:235], v[176:179], a[52:55]
s_add_u32 s72, s71, 0
buffer_load_dwordx4 v6, s[20:23], s72 offen lds
v_mfma_f32_16x16x32_bf16 a[52:55], v[236:239], v[180:183], a[52:55]
v_and_b32 v97, 0xffff0000, v58
v_fmac_f32 v96, v74, v40
v_mfma_f32_16x16x32_bf16 a[48:51], v[236:239], v[188:191], a[48:51]
v_fmac_f32 v96, v73, v41
v_fmac_f32 v96, v72, v42
v_mfma_f32_16x16x32_bf16 a[48:51], v[232:235], v[184:187], a[48:51]
ds_read_b64_tr_b16 v[252:253], v23 offset:40960
v_mul_f32 v96, v96, v97
v_mfma_f32_16x16x32_bf16 a[44:47], v[232:235], v[216:219], a[44:47]
s_add_u32 s72, s71, 31744
buffer_load_dwordx4 v6, s[20:23], s72 offen offset:1024 lds
v_mfma_f32_16x16x32_bf16 a[44:47], v[236:239], v[220:223], a[44:47]
v_cvt_pk_bf16_f32 v104, v95, v96
v_mul_f32 v95, v75, v38
v_mfma_f32_16x16x32_bf16 a[40:43], v[236:239], v[212:215], a[40:43]
ds_read_b64_tr_b16 v[254:255], v23 offset:41984
v_and_b32 v97, 0xffff0000, v57
v_mfma_f32_16x16x32_bf16 a[40:43], v[232:235], v[208:211], a[40:43]
v_fmac_f32 v95, v74, v39
v_fmac_f32 v95, v73, v40
v_mfma_f32_16x16x32_bf16 a[36:39], v[232:235], v[200:203], a[36:39]
s_add_u32 s72, s71, 63488
buffer_load_dwordx4 v7, s[20:23], s72 offen offset:2048 lds
v_mfma_f32_16x16x32_bf16 a[36:39], v[236:239], v[204:207], a[36:39]
v_fmac_f32 v95, v72, v41
v_mul_f32 v95, v95, v97
v_mfma_f32_16x16x32_bf16 a[32:35], v[236:239], v[196:199], a[32:35]
v_mul_f32 v96, v75, v37
v_and_b32 v97, 0xffff0000, v56
v_mfma_f32_16x16x32_bf16 a[32:35], v[232:235], v[192:195], a[32:35]
s_waitcnt lgkmcnt(5)
v_fmac_f32 v96, v74, v38
v_fmac_f32 v96, v73, v39
v_mfma_f32_16x16x32_bf16 a[64:67], v[240:243], v[192:195], a[64:67]
s_add_u32 s72, s71, 95232
buffer_load_dwordx4 v7, s[20:23], s72 offen offset:3072 lds
v_mfma_f32_16x16x32_bf16 a[64:67], v[244:247], v[196:199], a[64:67]
s_mov_b32 s80, 0x400000
buffer_load_dword v126, v125, s[12:15], s80 offen
v_mfma_f32_16x16x32_bf16 a[68:71], v[244:247], v[204:207], a[68:71]
s_mov_b32 s80, 0x500000
buffer_load_dword v126, v125, s[12:15], s80 offen
v_mfma_f32_16x16x32_bf16 a[68:71], v[240:243], v[200:203], a[68:71]
s_mov_b32 s80, 0x600000
buffer_load_dword v126, v125, s[12:15], s80 offen
v_mfma_f32_16x16x32_bf16 a[72:75], v[240:243], v[208:211], a[72:75]
s_mov_b32 s80, 0x700000
buffer_load_dword v126, v125, s[12:15], s80 offen
v_mfma_f32_16x16x32_bf16 a[72:75], v[244:247], v[212:215], a[72:75]
ds_read_b64_tr_b16 v[224:225], v20 offset:49152
v_fmac_f32 v96, v72, v40
v_mfma_f32_16x16x32_bf16 a[76:79], v[244:247], v[220:223], a[76:79]
v_mul_f32 v96, v96, v97
v_cvt_pk_bf16_f32 v105, v95, v96
v_mfma_f32_16x16x32_bf16 a[76:79], v[240:243], v[216:219], a[76:79]
ds_read_b64_tr_b16 v[226:227], v20 offset:50176
v_mul_f32 v95, v75, v36
v_mfma_f32_16x16x32_bf16 a[80:83], v[240:243], v[184:187], a[80:83]
v_and_b32 v97, 0xffff0000, v55
v_fmac_f32 v95, v74, v37
v_mfma_f32_16x16x32_bf16 a[80:83], v[244:247], v[188:191], a[80:83]
ds_read_b64_tr_b16 v[228:229], v20 offset:57344
v_fmac_f32 v95, v73, v38
v_mfma_f32_16x16x32_bf16 a[84:87], v[244:247], v[180:183], a[84:87]
v_fmac_f32 v95, v72, v39
v_mul_f32 v95, v95, v97
v_mfma_f32_16x16x32_bf16 a[84:87], v[240:243], v[176:179], a[84:87]
ds_read_b64_tr_b16 v[230:231], v20 offset:58368
v_mul_f32 v96, v75, v35
v_mfma_f32_16x16x32_bf16 a[88:91], v[240:243], v[168:171], a[88:91]
v_and_b32 v97, 0xffff0000, v54
v_fmac_f32 v96, v74, v36
v_mfma_f32_16x16x32_bf16 a[88:91], v[244:247], v[172:175], a[88:91]
v_fmac_f32 v96, v73, v37
v_fmac_f32 v96, v72, v38
v_mfma_f32_16x16x32_bf16 a[92:95], v[244:247], v[164:167], a[92:95]
v_mul_f32 v96, v96, v97
v_cvt_pk_bf16_f32 v106, v95, v96
v_mfma_f32_16x16x32_bf16 a[92:95], v[240:243], v[160:163], a[92:95]
s_waitcnt lgkmcnt(4)
v_mul_f32 v95, v75, v34
v_and_b32 v97, 0xffff0000, v53
v_mfma_f32_16x16x32_bf16 a[124:127], v[248:251], v[160:163], a[124:127]
ds_read_b64_tr_b16 v[232:233], v21 offset:49152
v_fmac_f32 v95, v74, v35
v_mfma_f32_16x16x32_bf16 a[124:127], v[252:255], v[164:167], a[124:127]
v_fmac_f32 v95, v73, v36
v_fmac_f32 v95, v72, v37
v_mfma_f32_16x16x32_bf16 a[120:123], v[252:255], v[172:175], a[120:123]
v_mul_f32 v95, v95, v97
v_mul_f32 v96, v75, v33
v_mfma_f32_16x16x32_bf16 a[120:123], v[248:251], v[168:171], a[120:123]
ds_read_b64_tr_b16 v[234:235], v21 offset:50176
v_and_b32 v97, 0xffff0000, v52
v_mfma_f32_16x16x32_bf16 a[116:119], v[248:251], v[176:179], a[116:119]
v_fmac_f32 v96, v74, v34
v_fmac_f32 v96, v73, v35
v_mfma_f32_16x16x32_bf16 a[116:119], v[252:255], v[180:183], a[116:119]
v_fmac_f32 v96, v72, v36
v_mul_f32 v96, v96, v97
v_mfma_f32_16x16x32_bf16 a[112:115], v[252:255], v[188:191], a[112:115]
v_cvt_pk_bf16_f32 v107, v95, v96
v_mfma_f32_16x16x32_bf16 a[112:115], v[248:251], v[184:187], a[112:115]
ds_read_b64_tr_b16 v[236:237], v21 offset:57344
ds_write_b128 v28, v[104:107] offset:288
v_mfma_f32_16x16x32_bf16 a[108:111], v[248:251], v[216:219], a[108:111]
v_mfma_f32_16x16x32_bf16 a[108:111], v[252:255], v[220:223], a[108:111]
v_mfma_f32_16x16x32_bf16 a[104:107], v[252:255], v[212:215], a[104:107]
ds_read_b64_tr_b16 v[238:239], v21 offset:58368
v_mfma_f32_16x16x32_bf16 a[104:107], v[248:251], v[208:211], a[104:107]
v_mfma_f32_16x16x32_bf16 a[100:103], v[248:251], v[200:203], a[100:103]
v_mfma_f32_16x16x32_bf16 a[100:103], v[252:255], v[204:207], a[100:103]
v_mfma_f32_16x16x32_bf16 a[96:99], v[252:255], v[196:199], a[96:99]
v_mfma_f32_16x16x32_bf16 a[96:99], v[248:251], v[192:195], a[96:99]
s_waitcnt lgkmcnt(5)
v_mfma_f32_16x16x32_bf16 a[128:131], v[192:195], v[224:227], a[128:131]
ds_read_b64_tr_b16 v[240:241], v22 offset:49152
v_mfma_f32_16x16x32_bf16 a[128:131], v[196:199], v[228:231], a[128:131]
v_mfma_f32_16x16x32_bf16 a[132:135], v[204:207], v[228:231], a[132:135]
v_mfma_f32_16x16x32_bf16 a[132:135], v[200:203], v[224:227], a[132:135]
ds_read_b64_tr_b16 v[242:243], v22 offset:50176
v_mfma_f32_16x16x32_bf16 a[136:139], v[208:211], v[224:227], a[136:139]
v_mfma_f32_16x16x32_bf16 a[136:139], v[212:215], v[228:231], a[136:139]
v_mfma_f32_16x16x32_bf16 a[140:143], v[220:223], v[228:231], a[140:143]
v_mfma_f32_16x16x32_bf16 a[140:143], v[216:219], v[224:227], a[140:143]
ds_read_b64_tr_b16 v[244:245], v22 offset:57344
v_mfma_f32_16x16x32_bf16 a[144:147], v[184:187], v[224:227], a[144:147]
v_mfma_f32_16x16x32_bf16 a[144:147], v[188:191], v[228:231], a[144:147]
v_mfma_f32_16x16x32_bf16 a[148:151], v[180:183], v[228:231], a[148:151]
ds_read_b64_tr_b16 v[246:247], v22 offset:58368
v_mfma_f32_16x16x32_bf16 a[148:151], v[176:179], v[224:227], a[148:151]
v_mfma_f32_16x16x32_bf16 a[152:155], v[168:171], v[224:227], a[152:155]
v_mfma_f32_16x16x32_bf16 a[152:155], v[172:175], v[228:231], a[152:155]
v_mfma_f32_16x16x32_bf16 a[156:159], v[164:167], v[228:231], a[156:159]
v_mfma_f32_16x16x32_bf16 a[156:159], v[160:163], v[224:227], a[156:159]
s_waitcnt lgkmcnt(4)
v_mfma_f32_16x16x32_bf16 a[188:191], v[160:163], v[232:235], a[188:191]
ds_read_b64_tr_b16 v[248:249], v23 offset:49152
v_mfma_f32_16x16x32_bf16 a[188:191], v[164:167], v[236:239], a[188:191]
v_mfma_f32_16x16x32_bf16 a[184:187], v[172:175], v[236:239], a[184:187]
ds_read_b64_tr_b16 v[250:251], v23 offset:50176
v_mfma_f32_16x16x32_bf16 a[184:187], v[168:171], v[232:235], a[184:187]
v_mfma_f32_16x16x32_bf16 a[180:183], v[176:179], v[232:235], a[180:183]
ds_read_b64_tr_b16 v[252:253], v23 offset:57344
v_mfma_f32_16x16x32_bf16 a[180:183], v[180:183], v[236:239], a[180:183]
v_mfma_f32_16x16x32_bf16 a[176:179], v[188:191], v[236:239], a[176:179]
ds_read_b64_tr_b16 v[254:255], v23 offset:58368
v_mfma_f32_16x16x32_bf16 a[176:179], v[184:187], v[232:235], a[176:179]
v_mfma_f32_16x16x32_bf16 a[172:175], v[216:219], v[232:235], a[172:175]
v_mfma_f32_16x16x32_bf16 a[172:175], v[220:223], v[236:239], a[172:175]
v_mfma_f32_16x16x32_bf16 a[168:171], v[212:215], v[236:239], a[168:171]
v_mfma_f32_16x16x32_bf16 a[168:171], v[208:211], v[232:235], a[168:171]
v_mfma_f32_16x16x32_bf16 a[164:167], v[200:203], v[232:235], a[164:167]
v_mfma_f32_16x16x32_bf16 a[164:167], v[204:207], v[236:239], a[164:167]
v_mfma_f32_16x16x32_bf16 a[160:163], v[196:199], v[236:239], a[160:163]
s_waitcnt vmcnt(4) lgkmcnt(0)
v_mfma_f32_16x16x32_bf16 a[160:163], v[192:195], v[232:235], a[160:163]
s_barrier
v_mfma_f32_16x16x32_bf16 a[192:195], v[192:195], v[240:243], a[192:195]
s_and_b32 s73, s65, 1
ds_read_b64_tr_b16 v[224:225], v20 offset:0
v_mfma_f32_16x16x32_bf16 a[192:195], v[196:199], v[244:247], a[192:195]
s_xor_b32 s73, s73, 7
ds_read_b64_tr_b16 v[226:227], v20 offset:1024
v_mfma_f32_16x16x32_bf16 a[196:199], v[204:207], v[244:247], a[196:199]
s_lshl_b32 s69, s73, 7
ds_read_b64_tr_b16 v[228:229], v20 offset:8192
v_mfma_f32_16x16x32_bf16 a[196:199], v[200:203], v[240:243], a[196:199]
s_add_u32 s69, s69, s84
ds_read_b64_tr_b16 v[230:231], v20 offset:9216
v_mfma_f32_16x16x32_bf16 a[200:203], v[208:211], v[240:243], a[200:203]
s_lshl_b32 s71, s73, 19
ds_read_b128 v[128:131], v24 offset:0
v_mfma_f32_16x16x32_bf16 a[200:203], v[212:215], v[244:247], a[200:203]
s_add_u32 s71, s71, s66
ds_read_b128 v[132:135], v25 offset:0
v_mfma_f32_16x16x32_bf16 a[204:207], v[220:223], v[244:247], a[204:207]
s_add_u32 m0, s63, 98304
v_mfma_f32_16x16x32_bf16 a[204:207], v[216:219], v[240:243], a[204:207]
s_add_u32 s72, s69, 0
buffer_load_dwordx4 v2, s[8:11], s72 offen lds
v_mfma_f32_16x16x32_bf16 a[208:211], v[184:187], v[240:243], a[208:211]
s_add_u32 s72, s69, 7168
buffer_load_dwordx4 v3, s[8:11], s72 offen offset:1024 lds
v_mfma_f32_16x16x32_bf16 a[208:211], v[188:191], v[244:247], a[208:211]
s_add_u32 s72, s69, 14336
buffer_load_dwordx4 v2, s[8:11], s72 offen offset:2048 lds
v_mfma_f32_16x16x32_bf16 a[212:215], v[180:183], v[244:247], a[212:215]
s_mul_i32 s74, s58, 4352
ds_read_b128 v[136:139], v24 offset:2048
v_mfma_f32_16x16x32_bf16 a[212:215], v[176:179], v[240:243], a[212:215]
s_add_u32 s74, s74, 131072
ds_read_b128 v[140:143], v25 offset:2048
v_lshrrev_b32 v26, 4, v0
v_mfma_f32_16x16x32_bf16 a[216:219], v[168:171], v[240:243], a[216:219]
s_add_u32 s72, s69, 21504
buffer_load_dwordx4 v3, s[8:11], s72 offen offset:3072 lds
v_mfma_f32_16x16x32_bf16 a[216:219], v[172:175], v[244:247], a[216:219]
ds_read_b128 v[144:147], v24 offset:4096
v_and_b32 v27, 15, v0
v_mfma_f32_16x16x32_bf16 a[220:223], v[164:167], v[244:247], a[220:223]
ds_read_b128 v[148:151], v25 offset:4096
v_lshlrev_b32 v27, 4, v27
v_mfma_f32_16x16x32_bf16 a[220:223], v[160:163], v[240:243], a[220:223]
ds_read_b128 v[152:155], v24 offset:6144
v_mul_u32_u24 v28, 272, v26
v_mfma_f32_16x16x32_bf16 a[252:255], v[160:163], v[248:251], a[252:255]
ds_read_b128 v[156:159], v25 offset:6144
v_add3_u32 v28, v28, v27, s74
v_mfma_f32_16x16x32_bf16 a[252:255], v[164:167], v[252:255], a[252:255]
s_add_u32 m0, s64, 32768
v_lshl_add_u32 v26, v26, 12, v27
v_mfma_f32_16x16x32_bf16 a[248:251], v[172:175], v[252:255], a[248:251]
s_add_u32 s72, s71, 0
buffer_load_dwordx4 v6, s[16:19], s72 offen lds
v_mfma_f32_16x16x32_bf16 a[248:251], v[168:171], v[248:251], a[248:251]
ds_read_b128 v[160:163], v24 offset:8192
ds_read_b128 v[36:39], v28 offset:0
v_mfma_f32_16x16x32_bf16 a[244:247], v[176:179], v[248:251], a[244:247]
ds_read_b128 v[164:167], v25 offset:8192
ds_read_b128 v[40:43], v28 offset:1088
v_mfma_f32_16x16x32_bf16 a[244:247], v[180:183], v[252:255], a[244:247]
s_add_u32 s72, s71, 31744
buffer_load_dwordx4 v6, s[16:19], s72 offen offset:1024 lds
v_mfma_f32_16x16x32_bf16 a[240:243], v[188:191], v[252:255], a[240:243]
ds_read_b128 v[168:171], v24 offset:10240
ds_read_b128 v[44:47], v28 offset:2176
v_mfma_f32_16x16x32_bf16 a[240:243], v[184:187], v[248:251], a[240:243]
ds_read_b128 v[172:175], v25 offset:10240
ds_read_b128 v[48:51], v28 offset:3264
v_mfma_f32_16x16x32_bf16 a[236:239], v[216:219], v[248:251], a[236:239]
s_xor_b32 s74, s2, 5
ds_read_b128 v[176:179], v24 offset:12288
v_mfma_f32_16x16x32_bf16 a[236:239], v[220:223], v[252:255], a[236:239]
s_add_u32 s72, s71, 63488
buffer_load_dwordx4 v7, s[16:19], s72 offen offset:2048 lds
v_mfma_f32_16x16x32_bf16 a[232:235], v[212:215], v[252:255], a[232:235]
s_and_b32 s74, s74, 15
ds_read_b128 v[180:183], v25 offset:12288
v_mfma_f32_16x16x32_bf16 a[232:235], v[208:211], v[248:251], a[232:235]
s_lshl_b32 s74, s74, 2
ds_read_b128 v[184:187], v24 offset:14336
v_mfma_f32_16x16x32_bf16 a[228:231], v[200:203], v[248:251], a[228:231]
s_add_u32 s74, s74, s58
ds_read_b128 v[188:191], v25 offset:14336
v_mfma_f32_16x16x32_bf16 a[228:231], v[204:207], v[252:255], a[228:231]
s_lshl_b32 s74, s74, 16
v_mfma_f32_16x16x32_bf16 a[224:227], v[196:199], v[252:255], a[224:227]
s_add_u32 s72, s71, 95232
buffer_load_dwordx4 v7, s[16:19], s72 offen offset:3072 lds
v_mfma_f32_16x16x32_bf16 a[224:227], v[192:195], v[248:251], a[224:227]
s_waitcnt lgkmcnt(12)
ds_read_b64_tr_b16 v[232:233], v21 offset:0
v_mfma_f32_16x16x32_bf16 a[0:3], v[224:227], v[128:131], a[0:3]
s_lshr_b32 s75, s2, 4
ds_read_b64_tr_b16 v[234:235], v21 offset:1024
v_mfma_f32_16x16x32_bf16 a[0:3], v[228:231], v[132:135], a[0:3]
s_lshl_b32 s75, s75, 8
ds_read_b64_tr_b16 v[240:241], v22 offset:0
v_mfma_f32_16x16x32_bf16 a[4:7], v[228:231], v[140:143], a[4:7]
s_add_u32 m0, s63, 102400
ds_read_b64_tr_b16 v[236:237], v21 offset:8192
v_mfma_f32_16x16x32_bf16 a[4:7], v[224:227], v[136:139], a[4:7]
s_add_u32 s72, s69, 32768
buffer_load_dwordx4 v2, s[8:11], s72 offen lds
v_mfma_f32_16x16x32_bf16 a[8:11], v[224:227], v[144:147], a[8:11]
s_sub_u32 s74, s74, s75
ds_read_b64_tr_b16 v[238:239], v21 offset:9216
v_mfma_f32_16x16x32_bf16 a[8:11], v[228:231], v[148:151], a[8:11]
s_add_u32 s74, s74, 0x3000f00
v_mfma_f32_16x16x32_bf16 a[12:15], v[228:231], v[156:159], a[12:15]
s_add_u32 s72, s69, 39936
buffer_load_dwordx4 v3, s[8:11], s72 offen offset:1024 lds
v_mfma_f32_16x16x32_bf16 a[12:15], v[224:227], v[152:155], a[12:15]
s_waitcnt lgkmcnt(5)
ds_read_b64_tr_b16 v[242:243], v22 offset:1024
v_mfma_f32_16x16x32_bf16 a[16:19], v[224:227], v[160:163], a[16:19]
s_waitcnt vmcnt(30)
v_lshlrev_b32 v78, 16, v84
v_lshlrev_b32 v79, 16, v108
v_mfma_f32_16x16x32_bf16 a[16:19], v[228:231], v[164:167], a[16:19]
ds_read_b64_tr_b16 v[244:245], v22 offset:8192
v_mul_f32 v76, v78, v79
v_mfma_f32_16x16x32_bf16 a[20:23], v[228:231], v[172:175], a[20:23]
v_lshlrev_b32 v80, 16, v116
v_mul_f32 v77, v78, v80
v_mfma_f32_16x16x32_bf16 a[20:23], v[224:227], v[168:171], a[20:23]
s_add_u32 s72, s69, 47104
buffer_load_dwordx4 v2, s[8:11], s72 offen offset:2048 lds
v_mfma_f32_16x16x32_bf16 a[24:27], v[224:227], v[176:179], a[24:27]
ds_read_b64_tr_b16 v[246:247], v22 offset:9216
v_and_b32 v78, 0xffff0000, v84
v_mfma_f32_16x16x32_bf16 a[24:27], v[228:231], v[180:183], a[24:27]
v_and_b32 v79, 0xffff0000, v108
v_fmac_f32 v76, v78, v79
v_mfma_f32_16x16x32_bf16 a[28:31], v[228:231], v[188:191], a[28:31]
v_and_b32 v80, 0xffff0000, v116
v_fmac_f32 v77, v78, v80
v_mfma_f32_16x16x32_bf16 a[28:31], v[224:227], v[184:187], a[28:31]
s_waitcnt lgkmcnt(3)
v_lshlrev_b32 v78, 16, v85
v_lshlrev_b32 v79, 16, v109
v_mfma_f32_16x16x32_bf16 a[60:63], v[232:235], v[184:187], a[60:63]
s_add_u32 s72, s69, 54272
buffer_load_dwordx4 v3, s[8:11], s72 offen offset:3072 lds
v_mfma_f32_16x16x32_bf16 a[60:63], v[236:239], v[188:191], a[60:63]
ds_read_b64_tr_b16 v[248:249], v23 offset:0
v_fmac_f32 v76, v78, v79
v_mfma_f32_16x16x32_bf16 a[56:59], v[236:239], v[180:183], a[56:59]
v_lshlrev_b32 v80, 16, v117
v_fmac_f32 v77, v78, v80
v_mfma_f32_16x16x32_bf16 a[56:59], v[232:235], v[176:179], a[56:59]
s_add_u32 m0, s64, 49152
ds_read_b64_tr_b16 v[250:251], v23 offset:1024
v_and_b32 v78, 0xffff0000, v85
v_mfma_f32_16x16x32_bf16 a[52:55], v[232:235], v[168:171], a[52:55]
s_add_u32 s72, s71, 0
buffer_load_dwordx4 v6, s[20:23], s72 offen lds
v_mfma_f32_16x16x32_bf16 a[52:55], v[236:239], v[172:175], a[52:55]
v_and_b32 v79, 0xffff0000, v109
v_fmac_f32 v76, v78, v79
v_mfma_f32_16x16x32_bf16 a[48:51], v[236:239], v[164:167], a[48:51]
v_and_b32 v80, 0xffff0000, v117
v_fmac_f32 v77, v78, v80
v_mfma_f32_16x16x32_bf16 a[48:51], v[232:235], v[160:163], a[48:51]
ds_read_b64_tr_b16 v[252:253], v23 offset:8192
v_lshlrev_b32 v78, 16, v86
v_mfma_f32_16x16x32_bf16 a[44:47], v[232:235], v[152:155], a[44:47]
s_add_u32 s72, s71, 31744
buffer_load_dwordx4 v6, s[20:23], s72 offen offset:1024 lds
v_mfma_f32_16x16x32_bf16 a[44:47], v[236:239], v[156:159], a[44:47]
v_lshlrev_b32 v79, 16, v110
v_fmac_f32 v76, v78, v79
v_mfma_f32_16x16x32_bf16 a[40:43], v[236:239], v[148:151], a[40:43]
ds_read_b64_tr_b16 v[254:255], v23 offset:9216
v_lshlrev_b32 v80, 16, v118
v_mfma_f32_16x16x32_bf16 a[40:43], v[232:235], v[144:147], a[40:43]
v_fmac_f32 v77, v78, v80
v_and_b32 v78, 0xffff0000, v86
v_mfma_f32_16x16x32_bf16 a[36:39], v[232:235], v[136:139], a[36:39]
s_add_u32 s72, s71, 63488
buffer_load_dwordx4 v7, s[20:23], s72 offen offset:2048 lds
v_mfma_f32_16x16x32_bf16 a[36:39], v[236:239], v[140:143], a[36:39]
v_and_b32 v79, 0xffff0000, v110
v_fmac_f32 v76, v78, v79
v_mfma_f32_16x16x32_bf16 a[32:35], v[236:239], v[132:135], a[32:35]
v_and_b32 v80, 0xffff0000, v118
v_fmac_f32 v77, v78, v80
v_mfma_f32_16x16x32_bf16 a[32:35], v[232:235], v[128:131], a[32:35]
s_waitcnt lgkmcnt(4)
v_lshlrev_b32 v78, 16, v87
v_lshlrev_b32 v79, 16, v111
v_mfma_f32_16x16x32_bf16 a[64:67], v[240:243], v[128:131], a[64:67]
s_add_u32 s72, s71, 95232
buffer_load_dwordx4 v7, s[20:23], s72 offen offset:3072 lds
v_mfma_f32_16x16x32_bf16 a[64:67], v[244:247], v[132:135], a[64:67]
ds_read_b64_tr_b16 v[224:225], v20 offset:16384
v_fmac_f32 v76, v78, v79
v_mfma_f32_16x16x32_bf16 a[68:71], v[244:247], v[140:143], a[68:71]
v_lshlrev_b32 v80, 16, v119
v_fmac_f32 v77, v78, v80
v_mfma_f32_16x16x32_bf16 a[68:71], v[240:243], v[136:139], a[68:71]
v_and_b32 v78, 0xffff0000, v87
v_and_b32 v79, 0xffff0000, v111
v_mfma_f32_16x16x32_bf16 a[72:75], v[240:243], v[144:147], a[72:75]
ds_read_b64_tr_b16 v[226:227], v20 offset:17408
v_fmac_f32 v76, v78, v79
v_mfma_f32_16x16x32_bf16 a[72:75], v[244:247], v[148:151], a[72:75]
v_and_b32 v80, 0xffff0000, v119
v_fmac_f32 v77, v78, v80
v_mfma_f32_16x16x32_bf16 a[76:79], v[244:247], v[156:159], a[76:79]
v_lshlrev_b32 v78, 16, v88
v_lshlrev_b32 v79, 16, v112
v_mfma_f32_16x16x32_bf16 a[76:79], v[240:243], v[152:155], a[76:79]
ds_read_b64_tr_b16 v[228:229], v20 offset:24576
v_fmac_f32 v76, v78, v79
v_mfma_f32_16x16x32_bf16 a[80:83], v[240:243], v[160:163], a[80:83]
s_waitcnt lgkmcnt(15)
buffer_store_dwordx4 v[36:39], v26, s[44:47], s74 offen sc1
v_mfma_f32_16x16x32_bf16 a[80:83], v[244:247], v[164:167], a[80:83]
v_lshlrev_b32 v80, 16, v120
v_fmac_f32 v77, v78, v80
v_mfma_f32_16x16x32_bf16 a[84:87], v[244:247], v[172:175], a[84:87]
v_and_b32 v78, 0xffff0000, v88
v_and_b32 v79, 0xffff0000, v112
v_mfma_f32_16x16x32_bf16 a[84:87], v[240:243], v[168:171], a[84:87]
ds_read_b64_tr_b16 v[230:231], v20 offset:25600
v_fmac_f32 v76, v78, v79
v_mfma_f32_16x16x32_bf16 a[88:91], v[240:243], v[176:179], a[88:91]
v_and_b32 v80, 0xffff0000, v120
v_fmac_f32 v77, v78, v80
v_mfma_f32_16x16x32_bf16 a[88:91], v[244:247], v[180:183], a[88:91]
v_lshlrev_b32 v78, 16, v89
v_lshlrev_b32 v79, 16, v113
v_mfma_f32_16x16x32_bf16 a[92:95], v[244:247], v[188:191], a[92:95]
v_fmac_f32 v76, v78, v79
v_lshlrev_b32 v80, 16, v121
v_mfma_f32_16x16x32_bf16 a[92:95], v[240:243], v[184:187], a[92:95]
s_waitcnt lgkmcnt(4)
v_fmac_f32 v77, v78, v80
v_and_b32 v78, 0xffff0000, v89
v_mfma_f32_16x16x32_bf16 a[124:127], v[248:251], v[184:187], a[124:127]
ds_read_b64_tr_b16 v[232:233], v21 offset:16384
v_and_b32 v79, 0xffff0000, v113
v_mfma_f32_16x16x32_bf16 a[124:127], v[252:255], v[188:191], a[124:127]
v_fmac_f32 v76, v78, v79
v_and_b32 v80, 0xffff0000, v121
v_mfma_f32_16x16x32_bf16 a[120:123], v[252:255], v[180:183], a[120:123]
ds_read_b64_tr_b16 v[234:235], v21 offset:17408
v_fmac_f32 v77, v78, v80
v_mfma_f32_16x16x32_bf16 a[120:123], v[248:251], v[176:179], a[120:123]
v_lshlrev_b32 v78, 16, v90
v_lshlrev_b32 v79, 16, v114
v_mfma_f32_16x16x32_bf16 a[116:119], v[248:251], v[168:171], a[116:119]
s_lshr_b32 s75, s93, 5
v_fmac_f32 v76, v78, v79
v_lshlrev_b32 v80, 16, v122
v_mfma_f32_16x16x32_bf16 a[116:119], v[252:255], v[172:175], a[116:119]
s_add_u32 s74, s74, 0x4000
buffer_store_dwordx4 v[40:43], v26, s[44:47], s74 offen sc1
v_mfma_f32_16x16x32_bf16 a[112:115], v[252:255], v[164:167], a[112:115]
s_and_b32 s75, s75, 0x3f80
ds_read_b64_tr_b16 v[236:237], v21 offset:24576
v_fmac_f32 v77, v78, v80
v_mfma_f32_16x16x32_bf16 a[112:115], v[248:251], v[160:163], a[112:115]
s_add_u32 s75, s75, LcB0-Lpc0
v_lshrrev_b32 v2, 6, v0
v_lshlrev_b32 v2, 7, v2
v_mfma_f32_16x16x32_bf16 a[108:111], v[248:251], v[152:155], a[108:111]
v_add_u32 v2, s75, v2
v_min_u32 v2, Lcode_end-Lpc0, v2
v_mfma_f32_16x16x32_bf16 a[108:111], v[252:255], v[156:159], a[108:111]
global_load_dword v3, v2, s[98:99]
v_mfma_f32_16x16x32_bf16 a[104:107], v[252:255], v[148:151], a[104:107]
v_and_b32 v78, 0xffff0000, v90
v_and_b32 v79, 0xffff0000, v114
v_mfma_f32_16x16x32_bf16 a[104:107], v[248:251], v[144:147], a[104:107]
ds_read_b64_tr_b16 v[238:239], v21 offset:25600
v_fmac_f32 v76, v78, v79
v_mfma_f32_16x16x32_bf16 a[100:103], v[248:251], v[136:139], a[100:103]
v_and_b32 v80, 0xffff0000, v122
v_fmac_f32 v77, v78, v80
v_mfma_f32_16x16x32_bf16 a[100:103], v[252:255], v[140:143], a[100:103]
v_lshlrev_b32 v78, 16, v91
v_lshlrev_b32 v79, 16, v115
v_mfma_f32_16x16x32_bf16 a[96:99], v[252:255], v[132:135], a[96:99]
v_fmac_f32 v76, v78, v79
v_lshlrev_b32 v80, 16, v123
v_mfma_f32_16x16x32_bf16 a[96:99], v[248:251], v[128:131], a[96:99]
s_waitcnt lgkmcnt(4)
v_fmac_f32 v77, v78, v80
v_and_b32 v78, 0xffff0000, v91
v_mfma_f32_16x16x32_bf16 a[128:131], v[128:131], v[224:227], a[128:131]
ds_read_b64_tr_b16 v[240:241], v22 offset:16384
v_and_b32 v79, 0xffff0000, v115
v_mfma_f32_16x16x32_bf16 a[128:131], v[132:135], v[228:231], a[128:131]
v_fmac_f32 v76, v78, v79
v_and_b32 v80, 0xffff0000, v123
v_mfma_f32_16x16x32_bf16 a[132:135], v[140:143], v[228:231], a[132:135]
s_add_u32 s74, s74, 0x4000
buffer_store_dwordx4 v[44:47], v26, s[44:47], s74 offen sc1
v_mfma_f32_16x16x32_bf16 a[132:135], v[136:139], v[224:227], a[132:135]
v_fmac_f32 v77, v78, v80
v_add_f32_dpp v76, v76, v76 row_ror:8 row_mask:0xf bank_mask:0xf
v_mfma_f32_16x16x32_bf16 a[136:139], v[144:147], v[224:227], a[136:139]
ds_read_b64_tr_b16 v[242:243], v22 offset:17408
v_add_f32_dpp v77, v77, v77 row_ror:8 row_mask:0xf bank_mask:0xf
v_mfma_f32_16x16x32_bf16 a[136:139], v[148:151], v[228:231], a[136:139]
v_add_f32_dpp v76, v76, v76 row_ror:4 row_mask:0xf bank_mask:0xf
v_add_f32_dpp v77, v77, v77 row_ror:4 row_mask:0xf bank_mask:0xf
v_mfma_f32_16x16x32_bf16 a[140:143], v[156:159], v[228:231], a[140:143]
v_add_f32_dpp v76, v76, v76 row_ror:2 row_mask:0xf bank_mask:0xf
v_add_f32_dpp v77, v77, v77 row_ror:2 row_mask:0xf bank_mask:0xf
v_mfma_f32_16x16x32_bf16 a[140:143], v[152:155], v[224:227], a[140:143]
ds_read_b64_tr_b16 v[244:245], v22 offset:24576
v_add_f32_dpp v76, v76, v76 row_ror:1 row_mask:0xf bank_mask:0xf
v_mfma_f32_16x16x32_bf16 a[144:147], v[160:163], v[224:227], a[144:147]
v_add_f32_dpp v77, v77, v77 row_ror:1 row_mask:0xf bank_mask:0xf
v_mov_b32 v78, v76
v_mfma_f32_16x16x32_bf16 a[144:147], v[164:167], v[228:231], a[144:147]
v_mov_b32 v79, v77
v_permlane16_swap_b32 v76, v78
v_mfma_f32_16x16x32_bf16 a[148:151], v[172:175], v[228:231], a[148:151]
ds_read_b64_tr_b16 v[246:247], v22 offset:25600
v_permlane16_swap_b32 v77, v79
v_mfma_f32_16x16x32_bf16 a[148:151], v[168:171], v[224:227], a[148:151]
v_add_f32 v76, v76, v78
v_add_f32 v77, v77, v79
v_mfma_f32_16x16x32_bf16 a[152:155], v[176:179], v[224:227], a[152:155]
v_mov_b32 v78, v76
v_mov_b32 v79, v77
v_mfma_f32_16x16x32_bf16 a[152:155], v[180:183], v[228:231], a[152:155]
v_permlane32_swap_b32 v76, v78
v_permlane32_swap_b32 v77, v79
v_mfma_f32_16x16x32_bf16 a[156:159], v[188:191], v[228:231], a[156:159]
v_add_f32 v76, v76, v78
v_add_f32 v77, v77, v79
v_mfma_f32_16x16x32_bf16 a[156:159], v[184:187], v[224:227], a[156:159]
s_waitcnt lgkmcnt(4)
v_mul_f32 v76, 0xbfb8aa3b, v76
v_mul_f32 v77, 0xbfb8aa3b, v77
v_mfma_f32_16x16x32_bf16 a[188:191], v[184:187], v[232:235], a[188:191]
s_add_u32 s74, s74, 0x4000
buffer_store_dwordx4 v[48:51], v26, s[44:47], s74 offen sc1
v_mfma_f32_16x16x32_bf16 a[188:191], v[188:191], v[236:239], a[188:191]
ds_read_b64_tr_b16 v[248:249], v23 offset:16384
v_mfma_f32_16x16x32_bf16 a[184:187], v[180:183], v[236:239], a[184:187]
ds_read_b64_tr_b16 v[250:251], v23 offset:17408
v_mfma_f32_16x16x32_bf16 a[184:187], v[176:179], v[232:235], a[184:187]
v_exp_f32 v76, v76
v_mfma_f32_16x16x32_bf16 a[180:183], v[168:171], v[232:235], a[180:183]
ds_read_b64_tr_b16 v[252:253], v23 offset:24576
v_mfma_f32_16x16x32_bf16 a[180:183], v[172:175], v[236:239], a[180:183]
v_exp_f32 v77, v77
v_mfma_f32_16x16x32_bf16 a[176:179], v[164:167], v[236:239], a[176:179]
ds_read_b64_tr_b16 v[254:255], v23 offset:25600
v_add_f32 v76, 1.0, v76
v_mfma_f32_16x16x32_bf16 a[176:179], v[160:163], v[232:235], a[176:179]
v_add_f32 v77, 1.0, v77
v_mfma_f32_16x16x32_bf16 a[172:175], v[152:155], v[232:235], a[172:175]
v_rcp_f32 v76, v76
v_mfma_f32_16x16x32_bf16 a[172:175], v[156:159], v[236:239], a[172:175]
v_rcp_f32 v77, v77
v_mfma_f32_16x16x32_bf16 a[168:171], v[148:151], v[236:239], a[168:171]
s_lshr_b32 s80, s76, 9
v_mfma_f32_16x16x32_bf16 a[168:171], v[144:147], v[232:235], a[168:171]
s_add_u32 s80, s80, 0x3800000
v_min_u32 v78, 1, v0
v_lshlrev_b32 v78, 30, v78
v_mfma_f32_16x16x32_bf16 a[164:167], v[136:139], v[232:235], a[164:167]
buffer_store_dwordx2 v[76:77], v78, s[44:47], s80 offen sc1
v_mfma_f32_16x16x32_bf16 a[164:167], v[140:143], v[236:239], a[164:167]
v_mfma_f32_16x16x32_bf16 a[160:163], v[132:135], v[236:239], a[160:163]
s_waitcnt vmcnt(6) lgkmcnt(0)
v_mfma_f32_16x16x32_bf16 a[160:163], v[128:131], v[232:235], a[160:163]
s_barrier
v_mfma_f32_16x16x32_bf16 a[192:195], v[128:131], v[240:243], a[192:195]
s_add_u32 s73, s62, 0
ds_read_b64_tr_b16 v[224:225], v20 offset:32768
v_mfma_f32_16x16x32_bf16 a[192:195], v[132:135], v[244:247], a[192:195]
s_add_u32 s70, s73, s65
ds_read_b64_tr_b16 v[226:227], v20 offset:33792
v_mfma_f32_16x16x32_bf16 a[196:199], v[140:143], v[244:247], a[196:199]
s_and_b32 s70, s70, 3
v_mov_b32 v100, v20
v_mov_b32 v101, v21
v_mfma_f32_16x16x32_bf16 a[196:199], v[136:139], v[240:243], a[196:199]
s_and_b32 s73, s73, 12
v_mov_b32 v102, v22
v_mov_b32 v103, v23
v_mfma_f32_16x16x32_bf16 a[200:203], v[144:147], v[240:243], a[200:203]
s_or_b32 s73, s73, s70
ds_read_b64_tr_b16 v[228:229], v20 offset:40960
v_mfma_f32_16x16x32_bf16 a[200:203], v[148:151], v[244:247], a[200:203]
s_lshl_b32 s73, s73, 7
ds_read_b64_tr_b16 v[230:231], v20 offset:41984
v_mfma_f32_16x16x32_bf16 a[204:207], v[156:159], v[244:247], a[204:207]
s_add_u32 s69, s73, s67
ds_read_b128 v[192:195], v24 offset:32768
v_mfma_f32_16x16x32_bf16 a[204:207], v[152:155], v[240:243], a[204:207]
s_add_u32 s70, s73, s68
ds_read_b128 v[196:199], v25 offset:32768
v_mfma_f32_16x16x32_bf16 a[208:211], v[160:163], v[240:243], a[208:211]
s_add_u32 m0, s63, 131072
ds_read_b128 v[200:203], v24 offset:34816
v_mfma_f32_16x16x32_bf16 a[208:211], v[164:167], v[244:247], a[208:211]
s_add_u32 s72, s69, 0
buffer_load_dwordx4 v4, s[4:7], s72 offen lds
v_mfma_f32_16x16x32_bf16 a[212:215], v[172:175], v[244:247], a[212:215]
s_add_u32 s72, s69, 15360
buffer_load_dwordx4 v5, s[4:7], s72 offen offset:1024 lds
v_mfma_f32_16x16x32_bf16 a[212:215], v[168:171], v[240:243], a[212:215]
s_add_u32 s72, s69, 129024
buffer_load_dwordx4 v4, s[4:7], s72 offen offset:2048 lds
v_mfma_f32_16x16x32_bf16 a[216:219], v[176:179], v[240:243], a[216:219]
ds_read_b128 v[204:207], v25 offset:34816
v_mfma_f32_16x16x32_bf16 a[216:219], v[180:183], v[244:247], a[216:219]
ds_read_b128 v[208:211], v24 offset:36864
v_mfma_f32_16x16x32_bf16 a[220:223], v[188:191], v[244:247], a[220:223]
s_add_u32 s72, s69, 144384
buffer_load_dwordx4 v5, s[4:7], s72 offen offset:3072 lds
v_mfma_f32_16x16x32_bf16 a[220:223], v[184:187], v[240:243], a[220:223]
ds_read_b128 v[212:215], v25 offset:36864
v_mfma_f32_16x16x32_bf16 a[252:255], v[184:187], v[248:251], a[252:255]
ds_read_b128 v[216:219], v24 offset:38912
v_mfma_f32_16x16x32_bf16 a[252:255], v[188:191], v[252:255], a[252:255]
ds_read_b128 v[220:223], v25 offset:38912
v_mfma_f32_16x16x32_bf16 a[248:251], v[180:183], v[252:255], a[248:251]
s_add_u32 m0, s63, 135168
ds_read_b128 v[184:187], v24 offset:40960
v_mfma_f32_16x16x32_bf16 a[248:251], v[176:179], v[248:251], a[248:251]
s_add_u32 s72, s70, 0
buffer_load_dwordx4 v4, s[4:7], s72 offen lds
v_mfma_f32_16x16x32_bf16 a[244:247], v[168:171], v[248:251], a[244:247]
ds_read_b128 v[188:191], v25 offset:40960
v_mfma_f32_16x16x32_bf16 a[244:247], v[172:175], v[252:255], a[244:247]
ds_read_b128 v[176:179], v24 offset:43008
v_mfma_f32_16x16x32_bf16 a[240:243], v[164:167], v[252:255], a[240:243]
ds_read_b128 v[180:183], v25 offset:43008
v_mfma_f32_16x16x32_bf16 a[240:243], v[160:163], v[248:251], a[240:243]
s_add_u32 s72, s70, 15360
buffer_load_dwordx4 v5, s[4:7], s72 offen offset:1024 lds
v_mfma_f32_16x16x32_bf16 a[236:239], v[152:155], v[248:251], a[236:239]
ds_read_b128 v[168:171], v24 offset:45056
v_mfma_f32_16x16x32_bf16 a[236:239], v[156:159], v[252:255], a[236:239]
ds_read_b128 v[172:175], v25 offset:45056
v_mfma_f32_16x16x32_bf16 a[232:235], v[148:151], v[252:255], a[232:235]
v_mfma_f32_16x16x32_bf16 a[232:235], v[144:147], v[248:251], a[232:235]
ds_read_b128 v[160:163], v24 offset:47104
v_mfma_f32_16x16x32_bf16 a[228:231], v[136:139], v[248:251], a[228:231]
s_add_u32 s72, s70, 129024
buffer_load_dwordx4 v4, s[4:7], s72 offen offset:2048 lds
v_mfma_f32_16x16x32_bf16 a[228:231], v[140:143], v[252:255], a[228:231]
ds_read_b128 v[164:167], v25 offset:47104
v_mfma_f32_16x16x32_bf16 a[224:227], v[132:135], v[252:255], a[224:227]
ds_read_b64_tr_b16 v[232:233], v101 offset:32768
v_mfma_f32_16x16x32_bf16 a[224:227], v[128:131], v[248:251], a[224:227]
s_waitcnt lgkmcnt(9)
ds_read_b64_tr_b16 v[234:235], v101 offset:33792
v_mfma_f32_16x16x32_bf16 a[0:3], v[224:227], v[192:195], a[0:3]
s_add_u32 s72, s70, 144384
buffer_load_dwordx4 v5, s[4:7], s72 offen offset:3072 lds
v_mfma_f32_16x16x32_bf16 a[0:3], v[228:231], v[196:199], a[0:3]
ds_read_b64_tr_b16 v[240:241], v102 offset:32768
v_mfma_f32_16x16x32_bf16 a[4:7], v[228:231], v[204:207], a[4:7]
ds_read_b64_tr_b16 v[236:237], v101 offset:40960
v_mfma_f32_16x16x32_bf16 a[4:7], v[224:227], v[200:203], a[4:7]
v_mfma_f32_16x16x32_bf16 a[8:11], v[224:227], v[208:211], a[8:11]
ds_read_b64_tr_b16 v[238:239], v101 offset:41984
v_mfma_f32_16x16x32_bf16 a[8:11], v[228:231], v[212:215], a[8:11]
s_lshl_b32 s71, s73, 12
ds_read_b64_tr_b16 v[242:243], v102 offset:33792
v_mfma_f32_16x16x32_bf16 a[12:15], v[228:231], v[220:223], a[12:15]
s_add_u32 s71, s71, s66
v_mfma_f32_16x16x32_bf16 a[12:15], v[224:227], v[216:219], a[12:15]
s_waitcnt lgkmcnt(6)
ds_read_b64_tr_b16 v[244:245], v102 offset:40960
v_mfma_f32_16x16x32_bf16 a[16:19], v[224:227], v[184:187], a[16:19]
s_add_u32 m0, s64, 0
v_mfma_f32_16x16x32_bf16 a[16:19], v[228:231], v[188:191], a[16:19]
s_add_u32 s72, s71, 0
buffer_load_dwordx4 v6, s[12:15], s72 offen lds
v_mfma_f32_16x16x32_bf16 a[20:23], v[228:231], v[180:183], a[20:23]
s_add_u32 s72, s71, 31744
buffer_load_dwordx4 v6, s[12:15], s72 offen offset:1024 lds
v_mfma_f32_16x16x32_bf16 a[20:23], v[224:227], v[176:179], a[20:23]
ds_read_b64_tr_b16 v[246:247], v102 offset:41984
v_mfma_f32_16x16x32_bf16 a[24:27], v[224:227], v[168:171], a[24:27]
v_mfma_f32_16x16x32_bf16 a[24:27], v[228:231], v[172:175], a[24:27]
v_mfma_f32_16x16x32_bf16 a[28:31], v[228:231], v[164:167], a[28:31]
v_mfma_f32_16x16x32_bf16 a[28:31], v[224:227], v[160:163], a[28:31]
s_waitcnt lgkmcnt(3)
v_mfma_f32_16x16x32_bf16 a[60:63], v[232:235], v[160:163], a[60:63]
s_add_u32 s72, s71, 63488
buffer_load_dwordx4 v7, s[12:15], s72 offen offset:2048 lds
v_mfma_f32_16x16x32_bf16 a[60:63], v[236:239], v[164:167], a[60:63]
ds_read_b64_tr_b16 v[248:249], v103 offset:32768
v_mfma_f32_16x16x32_bf16 a[56:59], v[236:239], v[172:175], a[56:59]
v_mfma_f32_16x16x32_bf16 a[56:59], v[232:235], v[168:171], a[56:59]
s_add_u32 s72, s71, 95232
buffer_load_dwordx4 v7, s[12:15], s72 offen offset:3072 lds
v_mfma_f32_16x16x32_bf16 a[52:55], v[232:235], v[176:179], a[52:55]
v_mfma_f32_16x16x32_bf16 a[52:55], v[236:239], v[180:183], a[52:55]
ds_read_b64_tr_b16 v[250:251], v103 offset:33792
v_mfma_f32_16x16x32_bf16 a[48:51], v[236:239], v[188:191], a[48:51]
v_mfma_f32_16x16x32_bf16 a[48:51], v[232:235], v[184:187], a[48:51]
v_mfma_f32_16x16x32_bf16 a[44:47], v[232:235], v[216:219], a[44:47]
s_add_u32 s73, s62, 1
ds_read_b64_tr_b16 v[252:253], v103 offset:40960
v_mfma_f32_16x16x32_bf16 a[44:47], v[236:239], v[220:223], a[44:47]
s_add_u32 s70, s73, s65
v_mfma_f32_16x16x32_bf16 a[40:43], v[236:239], v[212:215], a[40:43]
s_and_b32 s70, s70, 3
v_mfma_f32_16x16x32_bf16 a[40:43], v[232:235], v[208:211], a[40:43]
s_and_b32 s73, s73, 12
ds_read_b64_tr_b16 v[254:255], v103 offset:41984
v_mfma_f32_16x16x32_bf16 a[36:39], v[232:235], v[200:203], a[36:39]
s_or_b32 s73, s73, s70
v_mfma_f32_16x16x32_bf16 a[36:39], v[236:239], v[204:207], a[36:39]
s_lshl_b32 s73, s73, 7
v_mfma_f32_16x16x32_bf16 a[32:35], v[236:239], v[196:199], a[32:35]
s_add_u32 s69, s73, s67
v_mfma_f32_16x16x32_bf16 a[32:35], v[232:235], v[192:195], a[32:35]
s_waitcnt lgkmcnt(4)
v_mfma_f32_16x16x32_bf16 a[64:67], v[240:243], v[192:195], a[64:67]
s_add_u32 s70, s73, s68
ds_read_b64_tr_b16 v[224:225], v100 offset:49152
v_mfma_f32_16x16x32_bf16 a[64:67], v[244:247], v[196:199], a[64:67]
s_add_u32 m0, s63, 65536
v_mfma_f32_16x16x32_bf16 a[68:71], v[244:247], v[204:207], a[68:71]
s_add_u32 s72, s69, 0
buffer_load_dwordx4 v4, s[4:7], s72 offen lds
v_mfma_f32_16x16x32_bf16 a[68:71], v[240:243], v[200:203], a[68:71]
s_add_u32 s72, s69, 15360
buffer_load_dwordx4 v5, s[4:7], s72 offen offset:1024 lds
v_mfma_f32_16x16x32_bf16 a[72:75], v[240:243], v[208:211], a[72:75]
s_add_u32 s72, s69, 129024
buffer_load_dwordx4 v4, s[4:7], s72 offen offset:2048 lds
v_mfma_f32_16x16x32_bf16 a[72:75], v[244:247], v[212:215], a[72:75]
ds_read_b64_tr_b16 v[226:227], v100 offset:50176
v_mfma_f32_16x16x32_bf16 a[76:79], v[244:247], v[220:223], a[76:79]
s_add_u32 s72, s69, 144384
buffer_load_dwordx4 v5, s[4:7], s72 offen offset:3072 lds
v_mfma_f32_16x16x32_bf16 a[76:79], v[240:243], v[216:219], a[76:79]
v_mfma_f32_16x16x32_bf16 a[80:83], v[240:243], v[184:187], a[80:83]
ds_read_b64_tr_b16 v[228:229], v100 offset:57344
v_mfma_f32_16x16x32_bf16 a[80:83], v[244:247], v[188:191], a[80:83]
v_mfma_f32_16x16x32_bf16 a[84:87], v[244:247], v[180:183], a[84:87]
ds_read_b64_tr_b16 v[230:231], v100 offset:58368
v_accvgpr_read_b32 v20, a0
v_mfma_f32_16x16x32_bf16 a[84:87], v[240:243], v[176:179], a[84:87]
s_add_u32 m0, s63, 69632
v_accvgpr_read_b32 v28, a1
v_accvgpr_read_b32 v21, a2
v_mfma_f32_16x16x32_bf16 a[88:91], v[240:243], v[168:171], a[88:91]
s_add_u32 s72, s70, 0
buffer_load_dwordx4 v4, s[4:7], s72 offen lds
v_mfma_f32_16x16x32_bf16 a[88:91], v[244:247], v[172:175], a[88:91]
v_accvgpr_read_b32 v29, a3
v_accvgpr_read_b32 v22, a32
v_mfma_f32_16x16x32_bf16 a[92:95], v[244:247], v[164:167], a[92:95]
v_accvgpr_read_b32 v30, a33
v_accvgpr_read_b32 v23, a34
v_mfma_f32_16x16x32_bf16 a[92:95], v[240:243], v[160:163], a[92:95]
s_waitcnt lgkmcnt(4)
v_accvgpr_read_b32 v31, a35
v_mul_f32 v20, s79, v20
v_mfma_f32_16x16x32_bf16 a[124:127], v[248:251], v[160:163], a[124:127]
s_add_u32 s72, s70, 15360
buffer_load_dwordx4 v5, s[4:7], s72 offen offset:1024 lds
v_mfma_f32_16x16x32_bf16 a[124:127], v[252:255], v[164:167], a[124:127]
ds_read_b64_tr_b16 v[232:233], v101 offset:49152
v_mul_f32 v28, s79, v28
v_mfma_f32_16x16x32_bf16 a[120:123], v[252:255], v[172:175], a[120:123]
v_mul_f32 v21, s79, v21
v_mul_f32 v29, s79, v29
v_mfma_f32_16x16x32_bf16 a[120:123], v[248:251], v[168:171], a[120:123]
ds_read_b64_tr_b16 v[234:235], v101 offset:50176
v_mul_f32 v22, s79, v22
v_mfma_f32_16x16x32_bf16 a[116:119], v[248:251], v[176:179], a[116:119]
s_add_u32 s72, s70, 129024
buffer_load_dwordx4 v4, s[4:7], s72 offen offset:2048 lds
v_mfma_f32_16x16x32_bf16 a[116:119], v[252:255], v[180:183], a[116:119]
v_mul_f32 v30, s79, v30
v_mul_f32 v23, s79, v23
v_mfma_f32_16x16x32_bf16 a[112:115], v[252:255], v[188:191], a[112:115]
v_mul_f32 v31, s79, v31
v_cvt_pk_bf16_f32 v20, v20, v28
v_mfma_f32_16x16x32_bf16 a[112:115], v[248:251], v[184:187], a[112:115]
ds_read_b64_tr_b16 v[236:237], v101 offset:57344
v_cvt_pk_bf16_f32 v21, v21, v29
v_mfma_f32_16x16x32_bf16 a[108:111], v[248:251], v[216:219], a[108:111]
v_cvt_pk_bf16_f32 v22, v22, v30
v_cvt_pk_bf16_f32 v23, v23, v31
v_mfma_f32_16x16x32_bf16 a[108:111], v[252:255], v[220:223], a[108:111]
s_add_u32 s72, s70, 144384
buffer_load_dwordx4 v5, s[4:7], s72 offen offset:3072 lds
v_mfma_f32_16x16x32_bf16 a[104:107], v[252:255], v[212:215], a[104:107]
s_add_u32 s80, s77, 0
buffer_store_dwordx4 v[20:23], v1, s[44:47], s80 offen sc1
v_mfma_f32_16x16x32_bf16 a[104:107], v[248:251], v[208:211], a[104:107]
ds_read_b64_tr_b16 v[238:239], v101 offset:58368
v_mfma_f32_16x16x32_bf16 a[100:103], v[248:251], v[200:203], a[100:103]
v_mfma_f32_16x16x32_bf16 a[100:103], v[252:255], v[204:207], a[100:103]
v_mfma_f32_16x16x32_bf16 a[96:99], v[252:255], v[196:199], a[96:99]
s_lshl_b32 s71, s73, 12
v_mfma_f32_16x16x32_bf16 a[96:99], v[248:251], v[192:195], a[96:99]
s_waitcnt lgkmcnt(4)
LcB0:
v_mfma_f32_16x16x32_bf16 a[128:131], v[192:195], v[224:227], a[128:131]
s_add_u32 s71, s71, s66
ds_read_b64_tr_b16 v[240:241], v102 offset:49152
v_accvgpr_read_b32 v24, a4
v_mfma_f32_16x16x32_bf16 a[128:131], v[196:199], v[228:231], a[128:131]
s_add_u32 m0, s64, 16384
v_accvgpr_read_b32 v28, a5
v_accvgpr_read_b32 v25, a6
v_mfma_f32_16x16x32_bf16 a[132:135], v[204:207], v[228:231], a[132:135]
s_add_u32 s72, s71, 0
buffer_load_dwordx4 v6, s[12:15], s72 offen lds
v_mfma_f32_16x16x32_bf16 a[132:135], v[200:203], v[224:227], a[132:135]
s_add_u32 s72, s71, 31744
buffer_load_dwordx4 v6, s[12:15], s72 offen offset:1024 lds
v_mfma_f32_16x16x32_bf16 a[136:139], v[208:211], v[224:227], a[136:139]
ds_read_b64_tr_b16 v[242:243], v102 offset:50176
v_accvgpr_read_b32 v29, a7
v_mfma_f32_16x16x32_bf16 a[136:139], v[212:215], v[228:231], a[136:139]
v_accvgpr_read_b32 v26, a36
v_accvgpr_read_b32 v30, a37
v_mfma_f32_16x16x32_bf16 a[140:143], v[220:223], v[228:231], a[140:143]
v_accvgpr_read_b32 v27, a38
v_accvgpr_read_b32 v31, a39
v_mfma_f32_16x16x32_bf16 a[140:143], v[216:219], v[224:227], a[140:143]
s_add_u32 s72, s71, 63488
buffer_load_dwordx4 v7, s[12:15], s72 offen offset:2048 lds
v_mfma_f32_16x16x32_bf16 a[144:147], v[184:187], v[224:227], a[144:147]
ds_read_b64_tr_b16 v[244:245], v102 offset:57344
v_mul_f32 v24, s79, v24
v_mfma_f32_16x16x32_bf16 a[144:147], v[188:191], v[228:231], a[144:147]
v_mul_f32 v28, s79, v28
v_mul_f32 v25, s79, v25
v_mfma_f32_16x16x32_bf16 a[148:151], v[180:183], v[228:231], a[148:151]
ds_read_b64_tr_b16 v[246:247], v102 offset:58368
v_mul_f32 v29, s79, v29
v_mfma_f32_16x16x32_bf16 a[148:151], v[176:179], v[224:227], a[148:151]
v_mul_f32 v26, s79, v26
v_mul_f32 v30, s79, v30
v_mfma_f32_16x16x32_bf16 a[152:155], v[168:171], v[224:227], a[152:155]
s_add_u32 s72, s71, 95232
buffer_load_dwordx4 v7, s[12:15], s72 offen offset:3072 lds
v_mfma_f32_16x16x32_bf16 a[152:155], v[172:175], v[228:231], a[152:155]
v_mul_f32 v27, s79, v27
v_mul_f32 v31, s79, v31
v_mfma_f32_16x16x32_bf16 a[156:159], v[164:167], v[228:231], a[156:159]
v_cvt_pk_bf16_f32 v24, v24, v28
v_cvt_pk_bf16_f32 v25, v25, v29
v_mfma_f32_16x16x32_bf16 a[156:159], v[160:163], v[224:227], a[156:159]
s_waitcnt lgkmcnt(4)
v_cvt_pk_bf16_f32 v26, v26, v30
v_cvt_pk_bf16_f32 v27, v27, v31
v_mfma_f32_16x16x32_bf16 a[188:191], v[160:163], v[232:235], a[188:191]
s_add_u32 s80, s77, 4096
ds_read_b64_tr_b16 v[248:249], v103 offset:49152
v_mfma_f32_16x16x32_bf16 a[188:191], v[164:167], v[236:239], a[188:191]
buffer_store_dwordx4 v[24:27], v1, s[44:47], s80 offen sc1
v_mfma_f32_16x16x32_bf16 a[184:187], v[172:175], v[236:239], a[184:187]
ds_read_b64_tr_b16 v[250:251], v103 offset:50176
v_mfma_f32_16x16x32_bf16 a[184:187], v[168:171], v[232:235], a[184:187]
v_mfma_f32_16x16x32_bf16 a[180:183], v[176:179], v[232:235], a[180:183]
ds_read_b64_tr_b16 v[252:253], v103 offset:57344
v_mfma_f32_16x16x32_bf16 a[180:183], v[180:183], v[236:239], a[180:183]
s_add_u32 s73, s62, 2
v_mfma_f32_16x16x32_bf16 a[176:179], v[188:191], v[236:239], a[176:179]
s_add_u32 s70, s73, s65
ds_read_b64_tr_b16 v[254:255], v103 offset:58368
v_accvgpr_read_b32 v20, a8
v_mfma_f32_16x16x32_bf16 a[176:179], v[184:187], v[232:235], a[176:179]
s_and_b32 s70, s70, 3
v_accvgpr_read_b32 v28, a9
v_accvgpr_read_b32 v21, a10
v_mfma_f32_16x16x32_bf16 a[172:175], v[216:219], v[232:235], a[172:175]
s_and_b32 s73, s73, 12
v_accvgpr_read_b32 v29, a11
v_accvgpr_read_b32 v22, a40
v_mfma_f32_16x16x32_bf16 a[172:175], v[220:223], v[236:239], a[172:175]
s_or_b32 s73, s73, s70
v_accvgpr_read_b32 v30, a41
v_accvgpr_read_b32 v23, a42
v_mfma_f32_16x16x32_bf16 a[168:171], v[212:215], v[236:239], a[168:171]
s_lshl_b32 s73, s73, 7
v_accvgpr_read_b32 v31, a43
v_mul_f32 v20, s79, v20
v_mfma_f32_16x16x32_bf16 a[168:171], v[208:211], v[232:235], a[168:171]
s_add_u32 s69, s73, s67
v_mul_f32 v28, s79, v28
v_mul_f32 v21, s79, v21
v_mfma_f32_16x16x32_bf16 a[164:167], v[200:203], v[232:235], a[164:167]
s_add_u32 s70, s73, s68
v_mul_f32 v29, s79, v29
v_mul_f32 v22, s79, v22
v_mfma_f32_16x16x32_bf16 a[164:167], v[204:207], v[236:239], a[164:167]
s_add_u32 m0, s63, 98304
v_mul_f32 v30, s79, v30
v_mul_f32 v23, s79, v23
v_mfma_f32_16x16x32_bf16 a[160:163], v[196:199], v[236:239], a[160:163]
s_waitcnt vmcnt(14) lgkmcnt(0)
v_mul_f32 v31, s79, v31
v_cvt_pk_bf16_f32 v20, v20, v28
v_mfma_f32_16x16x32_bf16 a[160:163], v[192:195], v[232:235], a[160:163]
s_barrier
v_cvt_pk_bf16_f32 v21, v21, v29
v_cvt_pk_bf16_f32 v22, v22, v30
v_mfma_f32_16x16x32_bf16 a[192:195], v[192:195], v[240:243], a[192:195]
s_add_u32 s72, s69, 0
buffer_load_dwordx4 v4, s[4:7], s72 offen lds
v_mfma_f32_16x16x32_bf16 a[192:195], v[196:199], v[244:247], a[192:195]
s_lshl_b32 s74, s59, 2
ds_read_b64_tr_b16 v[64:65], v8 offset:0
v_or_b32 v106, s58, v0
v_mfma_f32_16x16x32_bf16 a[196:199], v[204:207], v[244:247], a[196:199]
ds_read_b64_tr_b16 v[66:67], v8 offset:1024
v_mov_b32 v107, 1
v_mfma_f32_16x16x32_bf16 a[196:199], v[200:203], v[240:243], a[196:199]
ds_read_b64_tr_b16 v[68:69], v8 offset:8192
v_lshlrev_b32 v106, 8, v106
v_mfma_f32_16x16x32_bf16 a[200:203], v[208:211], v[240:243], a[200:203]
ds_read_b64_tr_b16 v[70:71], v8 offset:9216
v_cvt_pk_bf16_f32 v23, v23, v31
v_mfma_f32_16x16x32_bf16 a[200:203], v[212:215], v[244:247], a[200:203]
s_add_u32 s72, s69, 15360
buffer_load_dwordx4 v5, s[4:7], s72 offen offset:1024 lds
v_mfma_f32_16x16x32_bf16 a[204:207], v[220:223], v[244:247], a[204:207]
s_add_u32 s80, s77, 8192
ds_read_b128 v[32:35], v16 offset:0
v_mfma_f32_16x16x32_bf16 a[204:207], v[216:219], v[240:243], a[204:207]
buffer_atomic_add v107, v106, s[48:51], s74 offen sc1
v_mfma_f32_16x16x32_bf16 a[208:211], v[184:187], v[240:243], a[208:211]
ds_read_b128 v[36:39], v17 offset:0
v_mfma_f32_16x16x32_bf16 a[208:211], v[188:191], v[244:247], a[208:211]
ds_read_b128 v[40:43], v16 offset:2048
v_mfma_f32_16x16x32_bf16 a[212:215], v[180:183], v[244:247], a[212:215]
s_add_u32 s72, s69, 129024
buffer_load_dwordx4 v4, s[4:7], s72 offen offset:2048 lds
v_mfma_f32_16x16x32_bf16 a[212:215], v[176:179], v[240:243], a[212:215]
ds_read_b128 v[44:47], v17 offset:2048
v_mfma_f32_16x16x32_bf16 a[216:219], v[168:171], v[240:243], a[216:219]
ds_read_b128 v[48:51], v16 offset:4096
v_accvgpr_read_b32 v24, a128
v_mfma_f32_16x16x32_bf16 a[216:219], v[172:175], v[244:247], a[216:219]
ds_read_b128 v[52:55], v17 offset:4096
v_accvgpr_read_b32 v28, a129
v_mfma_f32_16x16x32_bf16 a[220:223], v[164:167], v[244:247], a[220:223]
buffer_store_dwordx4 v[20:23], v1, s[44:47], s80 offen sc1
v_mfma_f32_16x16x32_bf16 a[220:223], v[160:163], v[240:243], a[220:223]
s_add_u32 s72, s69, 144384
buffer_load_dwordx4 v5, s[4:7], s72 offen offset:3072 lds
v_mfma_f32_16x16x32_bf16 a[252:255], v[160:163], v[248:251], a[252:255]
ds_read_b128 v[56:59], v16 offset:6144
v_accvgpr_read_b32 v25, a130
v_mfma_f32_16x16x32_bf16 a[252:255], v[164:167], v[252:255], a[252:255]
ds_read_b128 v[60:63], v17 offset:6144
v_accvgpr_read_b32 v29, a131
v_mfma_f32_16x16x32_bf16 a[248:251], v[172:175], v[252:255], a[248:251]
ds_read_b64_tr_b16 v[72:73], v9 offset:0
v_accvgpr_read_b32 v26, a132
v_mfma_f32_16x16x32_bf16 a[248:251], v[168:171], v[248:251], a[248:251]
s_add_u32 m0, s63, 102400
ds_read_b64_tr_b16 v[74:75], v9 offset:1024
v_accvgpr_read_b32 v30, a133
v_mfma_f32_16x16x32_bf16 a[244:247], v[176:179], v[248:251], a[244:247]
s_add_u32 s72, s70, 0
buffer_load_dwordx4 v4, s[4:7], s72 offen lds
v_mfma_f32_16x16x32_bf16 a[244:247], v[180:183], v[252:255], a[244:247]
ds_read_b64_tr_b16 v[76:77], v9 offset:8192
v_accvgpr_read_b32 v27, a134
v_mfma_f32_16x16x32_bf16 a[240:243], v[188:191], v[252:255], a[240:243]
v_accvgpr_read_b32 v31, a135
v_cvt_pk_bf16_f32 v24, v24, v28
v_mfma_f32_16x16x32_bf16 a[240:243], v[184:187], v[248:251], a[240:243]
ds_read_b64_tr_b16 v[78:79], v9 offset:9216
v_cvt_pk_bf16_f32 v25, v25, v29
v_mfma_f32_16x16x32_bf16 a[236:239], v[216:219], v[248:251], a[236:239]
ds_read_b64_tr_b16 v[80:81], v10 offset:0
v_cvt_pk_bf16_f32 v26, v26, v30
v_mfma_f32_16x16x32_bf16 a[236:239], v[220:223], v[252:255], a[236:239]
s_add_u32 s72, s70, 15360
buffer_load_dwordx4 v5, s[4:7], s72 offen offset:1024 lds
v_mfma_f32_16x16x32_bf16 a[232:235], v[212:215], v[252:255], a[232:235]
ds_read_b64_tr_b16 v[82:83], v10 offset:1024
v_cvt_pk_bf16_f32 v27, v27, v31
v_mfma_f32_16x16x32_bf16 a[232:235], v[208:211], v[248:251], a[232:235]
s_add_u32 s80, s78, 0
ds_read_b64_tr_b16 v[84:85], v10 offset:8192
v_mfma_f32_16x16x32_bf16 a[228:231], v[200:203], v[248:251], a[228:231]
ds_read_b64_tr_b16 v[86:87], v10 offset:9216
v_mfma_f32_16x16x32_bf16 a[228:231], v[204:207], v[252:255], a[228:231]
buffer_store_dwordx4 v[24:27], v1, s[44:47], s80 offen sc1
v_mfma_f32_16x16x32_bf16 a[224:227], v[196:199], v[252:255], a[224:227]
s_add_u32 s72, s70, 129024
buffer_load_dwordx4 v4, s[4:7], s72 offen offset:2048 lds
v_mfma_f32_16x16x32_bf16 a[224:227], v[192:195], v[248:251], a[224:227]
s_waitcnt lgkmcnt(8)
v_mfma_f32_16x16x32_bf16 v[128:131], v[64:67], v[32:35], 0
ds_read_b64_tr_b16 v[88:89], v11 offset:0
v_mfma_f32_16x16x32_bf16 v[128:131], v[68:71], v[36:39], v[128:131]
ds_read_b64_tr_b16 v[90:91], v11 offset:1024
v_mfma_f32_16x16x32_bf16 v[132:135], v[68:71], v[44:47], 0
v_accvgpr_read_b32 v20, a12
v_accvgpr_read_b32 v28, a13
v_mfma_f32_16x16x32_bf16 v[132:135], v[64:67], v[40:43], v[132:135]
s_add_u32 s72, s70, 144384
buffer_load_dwordx4 v5, s[4:7], s72 offen offset:3072 lds
v_mfma_f32_16x16x32_bf16 v[136:139], v[64:67], v[48:51], 0
s_lshl_b32 s71, s73, 12
ds_read_b64_tr_b16 v[92:93], v11 offset:8192
v_accvgpr_read_b32 v21, a14
v_mfma_f32_16x16x32_bf16 v[136:139], v[68:71], v[52:55], v[136:139]
s_add_u32 s71, s71, s66
v_accvgpr_read_b32 v29, a15
v_accvgpr_read_b32 v22, a44
v_mfma_f32_16x16x32_bf16 v[140:143], v[68:71], v[60:63], 0
s_add_u32 m0, s64, 32768
ds_read_b64_tr_b16 v[94:95], v11 offset:9216
v_accvgpr_read_b32 v30, a45
v_mfma_f32_16x16x32_bf16 v[140:143], v[64:67], v[56:59], v[140:143]
s_waitcnt lgkmcnt(8)
v_accvgpr_read_b32 v23, a46
v_accvgpr_read_b32 v31, a47
v_mfma_f32_16x16x32_bf16 v[156:159], v[72:75], v[56:59], 0
s_add_u32 s72, s71, 0
buffer_load_dwordx4 v6, s[12:15], s72 offen lds
v_mfma_f32_16x16x32_bf16 v[156:159], v[76:79], v[60:63], v[156:159]
s_add_u32 s73, s62, 3
ds_read_b64_tr_b16 v[64:65], v12 offset:0
v_mul_f32 v20, s79, v20
v_mfma_f32_16x16x32_bf16 v[152:155], v[76:79], v[52:55], 0
s_add_u32 s70, s73, s65
ds_read_b64_tr_b16 v[66:67], v12 offset:1024
v_mul_f32 v28, s79, v28
v_mfma_f32_16x16x32_bf16 v[152:155], v[72:75], v[48:51], v[152:155]
s_add_u32 s72, s71, 31744
buffer_load_dwordx4 v6, s[12:15], s72 offen offset:1024 lds
v_mfma_f32_16x16x32_bf16 v[148:151], v[72:75], v[40:43], 0
s_and_b32 s70, s70, 3
v_mul_f32 v21, s79, v21
v_mul_f32 v29, s79, v29
v_mfma_f32_16x16x32_bf16 v[148:151], v[76:79], v[44:47], v[148:151]
s_and_b32 s73, s73, 12
ds_read_b64_tr_b16 v[68:69], v12 offset:8192
v_mul_f32 v22, s79, v22
v_mfma_f32_16x16x32_bf16 v[144:147], v[76:79], v[36:39], 0
s_or_b32 s73, s73, s70
ds_read_b64_tr_b16 v[70:71], v12 offset:9216
v_mul_f32 v30, s79, v30
v_mfma_f32_16x16x32_bf16 v[144:147], v[72:75], v[32:35], v[144:147]
s_waitcnt lgkmcnt(8)
v_mul_f32 v23, s79, v23
v_mul_f32 v31, s79, v31
v_mfma_f32_16x16x32_bf16 v[160:163], v[80:83], v[32:35], 0
s_lshl_b32 s73, s73, 7
ds_read_b64_tr_b16 v[72:73], v13 offset:0
v_cvt_pk_bf16_f32 v20, v20, v28
v_mfma_f32_16x16x32_bf16 v[160:163], v[84:87], v[36:39], v[160:163]
s_add_u32 s72, s71, 63488
buffer_load_dwordx4 v7, s[12:15], s72 offen offset:2048 lds
v_mfma_f32_16x16x32_bf16 v[164:167], v[84:87], v[44:47], 0
s_add_u32 s69, s73, s67
ds_read_b64_tr_b16 v[74:75], v13 offset:1024
v_cvt_pk_bf16_f32 v21, v21, v29
v_mfma_f32_16x16x32_bf16 v[164:167], v[80:83], v[40:43], v[164:167]
s_add_u32 s70, s73, s68
v_cvt_pk_bf16_f32 v22, v22, v30
v_cvt_pk_bf16_f32 v23, v23, v31
v_mfma_f32_16x16x32_bf16 v[168:171], v[80:83], v[48:51], 0
s_waitcnt vmcnt(20)
ds_read_b64_tr_b16 v[76:77], v13 offset:8192
v_mfma_f32_16x16x32_bf16 v[168:171], v[84:87], v[52:55], v[168:171]
s_add_u32 s80, s77, 12288
ds_read_b64_tr_b16 v[78:79], v13 offset:9216
v_mfma_f32_16x16x32_bf16 v[172:175], v[84:87], v[60:63], 0
s_add_u32 s72, s71, 95232
ds_read_b128 v[96:99], v18 offset:0
v_mfma_f32_16x16x32_bf16 v[172:175], v[80:83], v[56:59], v[172:175]
s_waitcnt lgkmcnt(9)
buffer_load_dwordx4 v7, s[12:15], s72 offen offset:3072 lds
v_mfma_f32_16x16x32_bf16 v[188:191], v[88:91], v[56:59], 0
ds_read_b64_tr_b16 v[80:81], v14 offset:0
v_accvgpr_read_b32 v24, a136
v_mfma_f32_16x16x32_bf16 v[188:191], v[92:95], v[60:63], v[188:191]
ds_read_b64_tr_b16 v[82:83], v14 offset:1024
v_accvgpr_read_b32 v28, a137
v_mfma_f32_16x16x32_bf16 v[184:187], v[92:95], v[52:55], 0
ds_read_b128 v[100:103], v19 offset:0
v_accvgpr_read_b32 v25, a138
v_mfma_f32_16x16x32_bf16 v[184:187], v[88:91], v[48:51], v[184:187]
ds_read_b64_tr_b16 v[84:85], v14 offset:8192
v_accvgpr_read_b32 v29, a139
v_mfma_f32_16x16x32_bf16 v[180:183], v[88:91], v[40:43], 0
buffer_store_dwordx4 v[20:23], v1, s[44:47], s80 offen sc1
v_mfma_f32_16x16x32_bf16 v[180:183], v[92:95], v[44:47], v[180:183]
s_add_u32 m0, s63, 131072
ds_read_b64_tr_b16 v[86:87], v14 offset:9216
v_accvgpr_read_b32 v26, a140
v_mfma_f32_16x16x32_bf16 v[176:179], v[92:95], v[36:39], 0
s_add_u32 s72, s69, 0
buffer_load_dwordx4 v4, s[4:7], s72 offen lds
v_mfma_f32_16x16x32_bf16 v[176:179], v[88:91], v[32:35], v[176:179]
s_waitcnt lgkmcnt(10)
ds_read_b128 v[104:107], v18 offset:2048
v_accvgpr_read_b32 v30, a141
v_mfma_f32_16x16x32_bf16 v[192:195], v[64:67], v[32:35], 0
ds_read_b64_tr_b16 v[88:89], v15 offset:0
v_accvgpr_read_b32 v27, a142
v_mfma_f32_16x16x32_bf16 v[192:195], v[68:71], v[36:39], v[192:195]
ds_read_b64_tr_b16 v[90:91], v15 offset:1024
v_accvgpr_read_b32 v31, a143
v_mfma_f32_16x16x32_bf16 v[196:199], v[68:71], v[44:47], 0
ds_read_b64_tr_b16 v[92:93], v15 offset:8192
v_cvt_pk_bf16_f32 v24, v24, v28
v_mfma_f32_16x16x32_bf16 v[196:199], v[64:67], v[40:43], v[196:199]
s_add_u32 s72, s69, 15360
buffer_load_dwordx4 v5, s[4:7], s72 offen offset:1024 lds
v_mfma_f32_16x16x32_bf16 v[200:203], v[64:67], v[48:51], 0
ds_read_b64_tr_b16 v[94:95], v15 offset:9216
v_cvt_pk_bf16_f32 v25, v25, v29
v_mfma_f32_16x16x32_bf16 v[200:203], v[68:71], v[52:55], v[200:203]
ds_read_b128 v[108:111], v19 offset:2048
v_cvt_pk_bf16_f32 v26, v26, v30
v_mfma_f32_16x16x32_bf16 v[204:207], v[68:71], v[60:63], 0
v_cvt_pk_bf16_f32 v27, v27, v31
v_mfma_f32_16x16x32_bf16 v[204:207], v[64:67], v[56:59], v[204:207]
s_waitcnt lgkmcnt(12)
ds_read_b128 v[112:115], v18 offset:4096
v_mfma_f32_16x16x32_bf16 v[220:223], v[72:75], v[56:59], 0
s_add_u32 s72, s69, 129024
buffer_load_dwordx4 v4, s[4:7], s72 offen offset:2048 lds
v_mfma_f32_16x16x32_bf16 v[220:223], v[76:79], v[60:63], v[220:223]
s_add_u32 s80, s78, 8192
buffer_store_dwordx4 v[24:27], v1, s[44:47], s80 offen sc1
v_mfma_f32_16x16x32_bf16 v[216:219], v[76:79], v[52:55], 0
s_waitcnt vmcnt(21) lgkmcnt(2)
ds_read_b128 v[116:119], v19 offset:4096
v_mfma_f32_16x16x32_bf16 v[216:219], v[72:75], v[48:51], v[216:219]
s_barrier
ds_read_b128 v[120:123], v18 offset:6144
v_mfma_f32_16x16x32_bf16 v[212:215], v[72:75], v[40:43], 0
ds_read_b64_tr_b16 v[64:65], v8 offset:16384
ds_read_b64_tr_b16 v[66:67], v8 offset:17408
v_mfma_f32_16x16x32_bf16 v[212:215], v[76:79], v[44:47], v[212:215]
ds_read_b64_tr_b16 v[68:69], v8 offset:24576
v_mfma_f32_16x16x32_bf16 v[208:211], v[76:79], v[36:39], 0
s_add_u32 s72, s69, 144384
buffer_load_dwordx4 v5, s[4:7], s72 offen offset:3072 lds
v_mfma_f32_16x16x32_bf16 v[208:211], v[72:75], v[32:35], v[208:211]
ds_read_b64_tr_b16 v[70:71], v8 offset:25600
v_accvgpr_read_b32 v20, a16
v_mfma_f32_16x16x32_bf16 v[224:227], v[80:83], v[32:35], 0
ds_read_b64_tr_b16 v[72:73], v9 offset:16384
v_accvgpr_read_b32 v28, a17
v_mfma_f32_16x16x32_bf16 v[224:227], v[84:87], v[36:39], v[224:227]
ds_read_b64_tr_b16 v[74:75], v9 offset:17408
v_accvgpr_read_b32 v21, a18
v_mfma_f32_16x16x32_bf16 v[228:231], v[84:87], v[44:47], 0
s_add_u32 m0, s63, 135168
v_accvgpr_read_b32 v29, a19
v_accvgpr_read_b32 v22, a48
v_mfma_f32_16x16x32_bf16 v[228:231], v[80:83], v[40:43], v[228:231]
s_add_u32 s72, s70, 0
buffer_load_dwordx4 v4, s[4:7], s72 offen lds
v_mfma_f32_16x16x32_bf16 v[232:235], v[80:83], v[48:51], 0
ds_read_b64_tr_b16 v[76:77], v9 offset:24576
v_accvgpr_read_b32 v30, a49
v_mfma_f32_16x16x32_bf16 v[232:235], v[84:87], v[52:55], v[232:235]
ds_read_b128 v[124:127], v19 offset:6144
v_accvgpr_read_b32 v23, a50
v_mfma_f32_16x16x32_bf16 v[236:239], v[84:87], v[60:63], 0
ds_read_b64_tr_b16 v[78:79], v9 offset:25600
v_accvgpr_read_b32 v31, a51
v_mfma_f32_16x16x32_bf16 v[236:239], v[80:83], v[56:59], v[236:239]
v_mul_f32 v20, s79, v20
v_mul_f32 v28, s79, v28
v_mfma_f32_16x16x32_bf16 v[252:255], v[88:91], v[56:59], 0
s_add_u32 s72, s70, 15360
buffer_load_dwordx4 v5, s[4:7], s72 offen offset:1024 lds
v_mfma_f32_16x16x32_bf16 v[252:255], v[92:95], v[60:63], v[252:255]
ds_read_b64_tr_b16 v[80:81], v10 offset:16384
v_mul_f32 v21, s79, v21
v_mfma_f32_16x16x32_bf16 v[248:251], v[92:95], v[52:55], 0
ds_read_b64_tr_b16 v[82:83], v10 offset:17408
v_mul_f32 v29, s79, v29
v_mfma_f32_16x16x32_bf16 v[248:251], v[88:91], v[48:51], v[248:251]
v_mul_f32 v22, s79, v22
v_mul_f32 v30, s79, v30
v_mfma_f32_16x16x32_bf16 v[244:247], v[88:91], v[40:43], 0
ds_read_b64_tr_b16 v[84:85], v10 offset:24576
v_mul_f32 v23, s79, v23
v_mfma_f32_16x16x32_bf16 v[244:247], v[92:95], v[44:47], v[244:247]
ds_read_b64_tr_b16 v[86:87], v10 offset:25600
v_mul_f32 v31, s79, v31
v_mfma_f32_16x16x32_bf16 v[240:243], v[92:95], v[36:39], 0
s_add_u32 s72, s70, 129024
buffer_load_dwordx4 v4, s[4:7], s72 offen offset:2048 lds
v_mfma_f32_16x16x32_bf16 v[240:243], v[88:91], v[32:35], v[240:243]
s_waitcnt lgkmcnt(5)
v_cvt_pk_bf16_f32 v20, v20, v28
v_cvt_pk_bf16_f32 v21, v21, v29
v_mfma_f32_16x16x32_bf16 v[128:131], v[64:67], v[96:99], v[128:131]
ds_read_b64_tr_b16 v[88:89], v11 offset:16384
v_cvt_pk_bf16_f32 v22, v22, v30
v_mfma_f32_16x16x32_bf16 v[128:131], v[68:71], v[100:103], v[128:131]
ds_read_b64_tr_b16 v[90:91], v11 offset:17408
v_cvt_pk_bf16_f32 v23, v23, v31
v_mfma_f32_16x16x32_bf16 v[132:135], v[68:71], v[108:111], v[132:135]
s_add_u32 s80, s77, 32768
buffer_store_dwordx4 v[20:23], v1, s[44:47], s80 offen sc1
v_mfma_f32_16x16x32_bf16 v[132:135], v[64:67], v[104:107], v[132:135]
s_add_u32 s72, s70, 144384
buffer_load_dwordx4 v5, s[4:7], s72 offen offset:3072 lds
v_mfma_f32_16x16x32_bf16 v[136:139], v[64:67], v[112:115], v[136:139]
ds_read_b64_tr_b16 v[92:93], v11 offset:24576
v_accvgpr_read_b32 v24, a144
v_mfma_f32_16x16x32_bf16 v[136:139], v[68:71], v[116:119], v[136:139]
s_lshl_b32 s71, s73, 12
v_accvgpr_read_b32 v28, a145
v_accvgpr_read_b32 v25, a146
v_mfma_f32_16x16x32_bf16 v[140:143], v[68:71], v[124:127], v[140:143]
s_add_u32 s71, s71, s66
ds_read_b64_tr_b16 v[94:95], v11 offset:25600
v_accvgpr_read_b32 v29, a147
v_mfma_f32_16x16x32_bf16 v[140:143], v[64:67], v[120:123], v[140:143]
s_waitcnt lgkmcnt(8)
v_accvgpr_read_b32 v26, a148
v_accvgpr_read_b32 v30, a149
v_mfma_f32_16x16x32_bf16 v[156:159], v[72:75], v[120:123], v[156:159]
s_add_u32 m0, s64, 0
ds_read_b64_tr_b16 v[64:65], v12 offset:16384
v_accvgpr_read_b32 v27, a150
v_mfma_f32_16x16x32_bf16 v[156:159], v[76:79], v[124:127], v[156:159]
s_add_u32 s72, s71, 0
buffer_load_dwordx4 v6, s[12:15], s72 offen lds
v_mfma_f32_16x16x32_bf16 v[152:155], v[76:79], v[116:119], v[152:155]
s_add_u32 s73, s62, 4
ds_read_b64_tr_b16 v[66:67], v12 offset:17408
v_accvgpr_read_b32 v31, a151
v_mfma_f32_16x16x32_bf16 v[152:155], v[72:75], v[112:115], v[152:155]
s_add_u32 s70, s73, s65
v_cvt_pk_bf16_f32 v24, v24, v28
v_cvt_pk_bf16_f32 v25, v25, v29
v_mfma_f32_16x16x32_bf16 v[148:151], v[72:75], v[104:107], v[148:151]
s_and_b32 s70, s70, 3
ds_read_b64_tr_b16 v[68:69], v12 offset:24576
v_cvt_pk_bf16_f32 v26, v26, v30
v_mfma_f32_16x16x32_bf16 v[148:151], v[76:79], v[108:111], v[148:151]
s_and_b32 s73, s73, 12
ds_read_b64_tr_b16 v[70:71], v12 offset:25600
v_cvt_pk_bf16_f32 v27, v27, v31
v_mfma_f32_16x16x32_bf16 v[144:147], v[76:79], v[100:103], v[144:147]
s_add_u32 s72, s71, 31744
buffer_load_dwordx4 v6, s[12:15], s72 offen offset:1024 lds
v_mfma_f32_16x16x32_bf16 v[144:147], v[72:75], v[96:99], v[144:147]
s_waitcnt lgkmcnt(8)
v_mfma_f32_16x16x32_bf16 v[160:163], v[80:83], v[96:99], v[160:163]
s_or_b32 s73, s73, s70
ds_read_b64_tr_b16 v[72:73], v13 offset:16384
v_mfma_f32_16x16x32_bf16 v[160:163], v[84:87], v[100:103], v[160:163]
s_lshl_b32 s73, s73, 7
ds_read_b64_tr_b16 v[74:75], v13 offset:17408
v_mfma_f32_16x16x32_bf16 v[164:167], v[84:87], v[108:111], v[164:167]
s_add_u32 s69, s73, s67
v_mfma_f32_16x16x32_bf16 v[164:167], v[80:83], v[104:107], v[164:167]
s_add_u32 s72, s71, 63488
buffer_load_dwordx4 v7, s[12:15], s72 offen offset:2048 lds
v_mfma_f32_16x16x32_bf16 v[168:171], v[80:83], v[112:115], v[168:171]
s_waitcnt vmcnt(18)
ds_read_b64_tr_b16 v[76:77], v13 offset:24576
v_mfma_f32_16x16x32_bf16 v[168:171], v[84:87], v[116:119], v[168:171]
s_add_u32 s70, s73, s68
ds_read_b128 v[32:35], v18 offset:32768
v_mfma_f32_16x16x32_bf16 v[172:175], v[84:87], v[124:127], v[172:175]
s_add_u32 s80, s78, 32768
ds_read_b64_tr_b16 v[78:79], v13 offset:25600
v_mfma_f32_16x16x32_bf16 v[172:175], v[80:83], v[120:123], v[172:175]
s_waitcnt lgkmcnt(9)
ds_read_b128 v[36:39], v19 offset:32768
v_mfma_f32_16x16x32_bf16 v[188:191], v[88:91], v[120:123], v[188:191]
s_add_u32 s72, s71, 95232
buffer_load_dwordx4 v7, s[12:15], s72 offen offset:3072 lds
v_mfma_f32_16x16x32_bf16 v[188:191], v[92:95], v[124:127], v[188:191]
ds_read_b64_tr_b16 v[80:81], v14 offset:16384
v_mfma_f32_16x16x32_bf16 v[184:187], v[92:95], v[116:119], v[184:187]
ds_read_b64_tr_b16 v[82:83], v14 offset:17408
v_mfma_f32_16x16x32_bf16 v[184:187], v[88:91], v[112:115], v[184:187]
buffer_store_dwordx4 v[24:27], v1, s[44:47], s80 offen sc1
v_mfma_f32_16x16x32_bf16 v[180:183], v[88:91], v[104:107], v[180:183]
ds_read_b64_tr_b16 v[84:85], v14 offset:24576
v_accvgpr_read_b32 v20, a20
v_mfma_f32_16x16x32_bf16 v[180:183], v[92:95], v[108:111], v[180:183]
s_add_u32 m0, s63, 65536
ds_read_b64_tr_b16 v[86:87], v14 offset:25600
v_accvgpr_read_b32 v28, a21
v_mfma_f32_16x16x32_bf16 v[176:179], v[92:95], v[100:103], v[176:179]
s_add_u32 s72, s69, 0
buffer_load_dwordx4 v4, s[4:7], s72 offen lds
v_mfma_f32_16x16x32_bf16 v[176:179], v[88:91], v[96:99], v[176:179]
s_waitcnt lgkmcnt(10)
ds_read_b128 v[40:43], v18 offset:34816
v_accvgpr_read_b32 v21, a22
v_mfma_f32_16x16x32_bf16 v[192:195], v[64:67], v[96:99], v[192:195]
ds_read_b64_tr_b16 v[88:89], v15 offset:16384
v_accvgpr_read_b32 v29, a23
v_mfma_f32_16x16x32_bf16 v[192:195], v[68:71], v[100:103], v[192:195]
ds_read_b64_tr_b16 v[90:91], v15 offset:17408
v_accvgpr_read_b32 v22, a52
v_mfma_f32_16x16x32_bf16 v[196:199], v[68:71], v[108:111], v[196:199]
ds_read_b64_tr_b16 v[92:93], v15 offset:24576
v_accvgpr_read_b32 v30, a53
v_mfma_f32_16x16x32_bf16 v[196:199], v[64:67], v[104:107], v[196:199]
s_add_u32 s72, s69, 15360
buffer_load_dwordx4 v5, s[4:7], s72 offen offset:1024 lds
v_mfma_f32_16x16x32_bf16 v[200:203], v[64:67], v[112:115], v[200:203]
ds_read_b64_tr_b16 v[94:95], v15 offset:25600
v_accvgpr_read_b32 v23, a54
v_mfma_f32_16x16x32_bf16 v[200:203], v[68:71], v[116:119], v[200:203]
ds_read_b128 v[44:47], v19 offset:34816
v_accvgpr_read_b32 v31, a55
v_mfma_f32_16x16x32_bf16 v[204:207], v[68:71], v[124:127], v[204:207]
v_mul_f32 v20, s79, v20
v_mul_f32 v28, s79, v28
v_mfma_f32_16x16x32_bf16 v[204:207], v[64:67], v[120:123], v[204:207]
s_waitcnt lgkmcnt(11)
ds_read_b128 v[48:51], v18 offset:36864
v_mul_f32 v21, s79, v21
v_mfma_f32_16x16x32_bf16 v[220:223], v[72:75], v[120:123], v[220:223]
s_add_u32 s72, s69, 129024
buffer_load_dwordx4 v4, s[4:7], s72 offen offset:2048 lds
v_mfma_f32_16x16x32_bf16 v[220:223], v[76:79], v[124:127], v[220:223]
v_mul_f32 v29, s79, v29
v_mul_f32 v22, s79, v22
v_mfma_f32_16x16x32_bf16 v[216:219], v[76:79], v[116:119], v[216:219]
s_waitcnt vmcnt(19) lgkmcnt(2)
ds_read_b128 v[52:55], v19 offset:36864
v_mul_f32 v30, s79, v30
v_mfma_f32_16x16x32_bf16 v[216:219], v[72:75], v[112:115], v[216:219]
s_barrier
ds_read_b128 v[56:59], v18 offset:38912
v_mul_f32 v23, s79, v23
v_mfma_f32_16x16x32_bf16 v[212:215], v[72:75], v[104:107], v[212:215]
ds_read_b64_tr_b16 v[64:65], v8 offset:32768
ds_read_b64_tr_b16 v[66:67], v8 offset:33792
v_mfma_f32_16x16x32_bf16 v[212:215], v[76:79], v[108:111], v[212:215]
ds_read_b64_tr_b16 v[68:69], v8 offset:40960
v_mul_f32 v31, s79, v31
v_mfma_f32_16x16x32_bf16 v[208:211], v[76:79], v[100:103], v[208:211]
s_add_u32 s72, s69, 144384
buffer_load_dwordx4 v5, s[4:7], s72 offen offset:3072 lds
v_mfma_f32_16x16x32_bf16 v[208:211], v[72:75], v[96:99], v[208:211]
ds_read_b64_tr_b16 v[70:71], v8 offset:41984
v_cvt_pk_bf16_f32 v20, v20, v28
v_mfma_f32_16x16x32_bf16 v[224:227], v[80:83], v[96:99], v[224:227]
ds_read_b64_tr_b16 v[72:73], v9 offset:32768
v_cvt_pk_bf16_f32 v21, v21, v29
v_mfma_f32_16x16x32_bf16 v[224:227], v[84:87], v[100:103], v[224:227]
ds_read_b64_tr_b16 v[74:75], v9 offset:33792
v_cvt_pk_bf16_f32 v22, v22, v30
v_mfma_f32_16x16x32_bf16 v[228:231], v[84:87], v[108:111], v[228:231]
s_add_u32 m0, s63, 69632
v_cvt_pk_bf16_f32 v23, v23, v31
v_accvgpr_read_b32 v24, a152
v_mfma_f32_16x16x32_bf16 v[228:231], v[80:83], v[104:107], v[228:231]
s_add_u32 s72, s70, 0
buffer_load_dwordx4 v4, s[4:7], s72 offen lds
v_mfma_f32_16x16x32_bf16 v[232:235], v[80:83], v[112:115], v[232:235]
s_add_u32 s80, s77, 36864
ds_read_b64_tr_b16 v[76:77], v9 offset:40960
v_accvgpr_read_b32 v28, a153
v_mfma_f32_16x16x32_bf16 v[232:235], v[84:87], v[116:119], v[232:235]
ds_read_b128 v[60:63], v19 offset:38912
v_accvgpr_read_b32 v25, a154
v_mfma_f32_16x16x32_bf16 v[236:239], v[84:87], v[124:127], v[236:239]
ds_read_b64_tr_b16 v[78:79], v9 offset:41984
v_accvgpr_read_b32 v29, a155
v_mfma_f32_16x16x32_bf16 v[236:239], v[80:83], v[120:123], v[236:239]
buffer_store_dwordx4 v[20:23], v1, s[44:47], s80 offen sc1
v_mfma_f32_16x16x32_bf16 v[252:255], v[88:91], v[120:123], v[252:255]
s_add_u32 s72, s70, 15360
buffer_load_dwordx4 v5, s[4:7], s72 offen offset:1024 lds
v_mfma_f32_16x16x32_bf16 v[252:255], v[92:95], v[124:127], v[252:255]
ds_read_b64_tr_b16 v[80:81], v10 offset:32768
v_accvgpr_read_b32 v26, a156
v_mfma_f32_16x16x32_bf16 v[248:251], v[92:95], v[116:119], v[248:251]
ds_read_b64_tr_b16 v[82:83], v10 offset:33792
v_accvgpr_read_b32 v30, a157
v_mfma_f32_16x16x32_bf16 v[248:251], v[88:91], v[112:115], v[248:251]
v_accvgpr_read_b32 v27, a158
v_accvgpr_read_b32 v31, a159
v_mfma_f32_16x16x32_bf16 v[244:247], v[88:91], v[104:107], v[244:247]
ds_read_b64_tr_b16 v[84:85], v10 offset:40960
v_cvt_pk_bf16_f32 v24, v24, v28
v_mfma_f32_16x16x32_bf16 v[244:247], v[92:95], v[108:111], v[244:247]
ds_read_b64_tr_b16 v[86:87], v10 offset:41984
v_cvt_pk_bf16_f32 v25, v25, v29
v_mfma_f32_16x16x32_bf16 v[240:243], v[92:95], v[100:103], v[240:243]
s_add_u32 s72, s70, 129024
buffer_load_dwordx4 v4, s[4:7], s72 offen offset:2048 lds
v_mfma_f32_16x16x32_bf16 v[240:243], v[88:91], v[96:99], v[240:243]
s_waitcnt lgkmcnt(5)
v_cvt_pk_bf16_f32 v26, v26, v30
v_cvt_pk_bf16_f32 v27, v27, v31
v_mfma_f32_16x16x32_bf16 v[128:131], v[64:67], v[32:35], v[128:131]
s_add_u32 s80, s78, 40960
ds_read_b64_tr_b16 v[88:89], v11 offset:32768
v_mfma_f32_16x16x32_bf16 v[128:131], v[68:71], v[36:39], v[128:131]
ds_read_b64_tr_b16 v[90:91], v11 offset:33792
v_mfma_f32_16x16x32_bf16 v[132:135], v[68:71], v[44:47], v[132:135]
buffer_store_dwordx4 v[24:27], v1, s[44:47], s80 offen sc1
v_mfma_f32_16x16x32_bf16 v[132:135], v[64:67], v[40:43], v[132:135]
s_add_u32 s72, s70, 144384
buffer_load_dwordx4 v5, s[4:7], s72 offen offset:3072 lds
v_mfma_f32_16x16x32_bf16 v[136:139], v[64:67], v[48:51], v[136:139]
ds_read_b64_tr_b16 v[92:93], v11 offset:40960
v_mfma_f32_16x16x32_bf16 v[136:139], v[68:71], v[52:55], v[136:139]
s_lshl_b32 s71, s73, 12
v_mfma_f32_16x16x32_bf16 v[140:143], v[68:71], v[60:63], v[140:143]
s_add_u32 s71, s71, s66
ds_read_b64_tr_b16 v[94:95], v11 offset:41984
v_mfma_f32_16x16x32_bf16 v[140:143], v[64:67], v[56:59], v[140:143]
s_waitcnt lgkmcnt(8)
v_accvgpr_read_b32 v20, a24
v_accvgpr_read_b32 v28, a25
v_mfma_f32_16x16x32_bf16 v[156:159], v[72:75], v[56:59], v[156:159]
s_add_u32 m0, s64, 16384
ds_read_b64_tr_b16 v[64:65], v12 offset:32768
v_accvgpr_read_b32 v21, a26
v_mfma_f32_16x16x32_bf16 v[156:159], v[76:79], v[60:63], v[156:159]
s_add_u32 s72, s71, 0
buffer_load_dwordx4 v6, s[12:15], s72 offen lds
v_mfma_f32_16x16x32_bf16 v[152:155], v[76:79], v[52:55], v[152:155]
s_add_u32 s73, s62, 5
ds_read_b64_tr_b16 v[66:67], v12 offset:33792
v_accvgpr_read_b32 v29, a27
v_mfma_f32_16x16x32_bf16 v[152:155], v[72:75], v[48:51], v[152:155]
s_add_u32 s70, s73, s65
v_accvgpr_read_b32 v22, a56
v_accvgpr_read_b32 v30, a57
v_mfma_f32_16x16x32_bf16 v[148:151], v[72:75], v[40:43], v[148:151]
s_and_b32 s70, s70, 3
ds_read_b64_tr_b16 v[68:69], v12 offset:40960
v_accvgpr_read_b32 v23, a58
v_mfma_f32_16x16x32_bf16 v[148:151], v[76:79], v[44:47], v[148:151]
s_and_b32 s73, s73, 12
ds_read_b64_tr_b16 v[70:71], v12 offset:41984
v_accvgpr_read_b32 v31, a59
v_mfma_f32_16x16x32_bf16 v[144:147], v[76:79], v[36:39], v[144:147]
s_add_u32 s72, s71, 31744
buffer_load_dwordx4 v6, s[12:15], s72 offen offset:1024 lds
v_mfma_f32_16x16x32_bf16 v[144:147], v[72:75], v[32:35], v[144:147]
s_waitcnt lgkmcnt(8)
v_mul_f32 v20, s79, v20
v_mul_f32 v28, s79, v28
v_mfma_f32_16x16x32_bf16 v[160:163], v[80:83], v[32:35], v[160:163]
s_or_b32 s73, s73, s70
ds_read_b64_tr_b16 v[72:73], v13 offset:32768
v_mul_f32 v21, s79, v21
v_mfma_f32_16x16x32_bf16 v[160:163], v[84:87], v[36:39], v[160:163]
s_lshl_b32 s73, s73, 7
ds_read_b64_tr_b16 v[74:75], v13 offset:33792
v_mul_f32 v29, s79, v29
v_mfma_f32_16x16x32_bf16 v[164:167], v[84:87], v[44:47], v[164:167]
s_add_u32 s69, s73, s67
v_mul_f32 v22, s79, v22
v_mul_f32 v30, s79, v30
v_mfma_f32_16x16x32_bf16 v[164:167], v[80:83], v[40:43], v[164:167]
s_add_u32 s72, s71, 63488
buffer_load_dwordx4 v7, s[12:15], s72 offen offset:2048 lds
v_mfma_f32_16x16x32_bf16 v[168:171], v[80:83], v[48:51], v[168:171]
s_waitcnt vmcnt(18)
ds_read_b64_tr_b16 v[76:77], v13 offset:40960
v_mul_f32 v23, s79, v23
v_mfma_f32_16x16x32_bf16 v[168:171], v[84:87], v[52:55], v[168:171]
s_add_u32 s70, s73, s68
ds_read_b128 v[96:99], v16 offset:0
v_mul_f32 v31, s79, v31
v_mfma_f32_16x16x32_bf16 v[172:175], v[84:87], v[60:63], v[172:175]
ds_read_b64_tr_b16 v[78:79], v13 offset:41984
v_cvt_pk_bf16_f32 v20, v20, v28
v_mfma_f32_16x16x32_bf16 v[172:175], v[80:83], v[56:59], v[172:175]
s_waitcnt lgkmcnt(9)
ds_read_b128 v[100:103], v17 offset:0
v_cvt_pk_bf16_f32 v21, v21, v29
v_mfma_f32_16x16x32_bf16 v[188:191], v[88:91], v[56:59], v[188:191]
s_add_u32 s72, s71, 95232
buffer_load_dwordx4 v7, s[12:15], s72 offen offset:3072 lds
v_mfma_f32_16x16x32_bf16 v[188:191], v[92:95], v[60:63], v[188:191]
ds_read_b64_tr_b16 v[80:81], v14 offset:32768
v_cvt_pk_bf16_f32 v22, v22, v30
v_mfma_f32_16x16x32_bf16 v[184:187], v[92:95], v[52:55], v[184:187]
ds_read_b64_tr_b16 v[82:83], v14 offset:33792
v_cvt_pk_bf16_f32 v23, v23, v31
v_mfma_f32_16x16x32_bf16 v[184:187], v[88:91], v[48:51], v[184:187]
s_add_u32 s80, s77, 40960
buffer_store_dwordx4 v[20:23], v1, s[44:47], s80 offen sc1
v_mfma_f32_16x16x32_bf16 v[180:183], v[88:91], v[40:43], v[180:183]
ds_read_b64_tr_b16 v[84:85], v14 offset:40960
v_mfma_f32_16x16x32_bf16 v[180:183], v[92:95], v[44:47], v[180:183]
s_add_u32 m0, s63, 98304
ds_read_b64_tr_b16 v[86:87], v14 offset:41984
v_accvgpr_read_b32 v24, a160
v_mfma_f32_16x16x32_bf16 v[176:179], v[92:95], v[36:39], v[176:179]
s_add_u32 s72, s69, 0
buffer_load_dwordx4 v4, s[4:7], s72 offen lds
v_mfma_f32_16x16x32_bf16 v[176:179], v[88:91], v[32:35], v[176:179]
s_waitcnt lgkmcnt(10)
ds_read_b128 v[104:107], v16 offset:2048
v_accvgpr_read_b32 v28, a161
v_mfma_f32_16x16x32_bf16 v[192:195], v[64:67], v[32:35], v[192:195]
ds_read_b64_tr_b16 v[88:89], v15 offset:32768
v_accvgpr_read_b32 v25, a162
v_mfma_f32_16x16x32_bf16 v[192:195], v[68:71], v[36:39], v[192:195]
ds_read_b64_tr_b16 v[90:91], v15 offset:33792
v_accvgpr_read_b32 v29, a163
v_mfma_f32_16x16x32_bf16 v[196:199], v[68:71], v[44:47], v[196:199]
ds_read_b64_tr_b16 v[92:93], v15 offset:40960
v_accvgpr_read_b32 v26, a164
v_mfma_f32_16x16x32_bf16 v[196:199], v[64:67], v[40:43], v[196:199]
s_add_u32 s72, s69, 15360
buffer_load_dwordx4 v5, s[4:7], s72 offen offset:1024 lds
v_mfma_f32_16x16x32_bf16 v[200:203], v[64:67], v[48:51], v[200:203]
ds_read_b64_tr_b16 v[94:95], v15 offset:41984
v_accvgpr_read_b32 v30, a165
v_mfma_f32_16x16x32_bf16 v[200:203], v[68:71], v[52:55], v[200:203]
ds_read_b128 v[108:111], v17 offset:2048
v_accvgpr_read_b32 v27, a166
v_mfma_f32_16x16x32_bf16 v[204:207], v[68:71], v[60:63], v[204:207]
v_accvgpr_read_b32 v31, a167
v_cvt_pk_bf16_f32 v24, v24, v28
v_mfma_f32_16x16x32_bf16 v[204:207], v[64:67], v[56:59], v[204:207]
s_waitcnt lgkmcnt(11)
ds_read_b128 v[112:115], v16 offset:4096
v_cvt_pk_bf16_f32 v25, v25, v29
v_mfma_f32_16x16x32_bf16 v[220:223], v[72:75], v[56:59], v[220:223]
s_add_u32 s72, s69, 129024
buffer_load_dwordx4 v4, s[4:7], s72 offen offset:2048 lds
v_mfma_f32_16x16x32_bf16 v[220:223], v[76:79], v[60:63], v[220:223]
v_cvt_pk_bf16_f32 v26, v26, v30
v_cvt_pk_bf16_f32 v27, v27, v31
v_mfma_f32_16x16x32_bf16 v[216:219], v[76:79], v[52:55], v[216:219]
s_waitcnt vmcnt(19) lgkmcnt(2)
ds_read_b128 v[116:119], v17 offset:4096
v_mfma_f32_16x16x32_bf16 v[216:219], v[72:75], v[48:51], v[216:219]
s_barrier
ds_read_b128 v[120:123], v16 offset:6144
v_mfma_f32_16x16x32_bf16 v[212:215], v[72:75], v[40:43], v[212:215]
s_add_u32 s80, s78, 1024
ds_read_b64_tr_b16 v[64:65], v8 offset:0
ds_read_b64_tr_b16 v[66:67], v8 offset:1024
v_mfma_f32_16x16x32_bf16 v[212:215], v[76:79], v[44:47], v[212:215]
ds_read_b64_tr_b16 v[68:69], v8 offset:8192
v_mfma_f32_16x16x32_bf16 v[208:211], v[76:79], v[36:39], v[208:211]
s_add_u32 s72, s69, 144384
buffer_load_dwordx4 v5, s[4:7], s72 offen offset:3072 lds
v_mfma_f32_16x16x32_bf16 v[208:211], v[72:75], v[32:35], v[208:211]
ds_read_b64_tr_b16 v[70:71], v8 offset:9216
v_mfma_f32_16x16x32_bf16 v[224:227], v[80:83], v[32:35], v[224:227]
ds_read_b64_tr_b16 v[72:73], v9 offset:0
v_mfma_f32_16x16x32_bf16 v[224:227], v[84:87], v[36:39], v[224:227]
ds_read_b64_tr_b16 v[74:75], v9 offset:1024
v_mfma_f32_16x16x32_bf16 v[228:231], v[84:87], v[44:47], v[228:231]
s_add_u32 m0, s63, 102400
buffer_store_dwordx4 v[24:27], v1, s[44:47], s80 offen sc1
v_mfma_f32_16x16x32_bf16 v[228:231], v[80:83], v[40:43], v[228:231]
s_add_u32 s72, s70, 0
buffer_load_dwordx4 v4, s[4:7], s72 offen lds
v_mfma_f32_16x16x32_bf16 v[232:235], v[80:83], v[48:51], v[232:235]
ds_read_b64_tr_b16 v[76:77], v9 offset:8192
v_accvgpr_read_b32 v20, a28
v_mfma_f32_16x16x32_bf16 v[232:235], v[84:87], v[52:55], v[232:235]
ds_read_b128 v[124:127], v17 offset:6144
v_accvgpr_read_b32 v28, a29
v_mfma_f32_16x16x32_bf16 v[236:239], v[84:87], v[60:63], v[236:239]
ds_read_b64_tr_b16 v[78:79], v9 offset:9216
v_accvgpr_read_b32 v21, a30
v_mfma_f32_16x16x32_bf16 v[236:239], v[80:83], v[56:59], v[236:239]
v_accvgpr_read_b32 v29, a31
v_accvgpr_read_b32 v22, a60
v_mfma_f32_16x16x32_bf16 v[252:255], v[88:91], v[56:59], v[252:255]
s_add_u32 s72, s70, 15360
buffer_load_dwordx4 v5, s[4:7], s72 offen offset:1024 lds
v_mfma_f32_16x16x32_bf16 v[252:255], v[92:95], v[60:63], v[252:255]
ds_read_b64_tr_b16 v[80:81], v10 offset:0
v_accvgpr_read_b32 v30, a61
v_mfma_f32_16x16x32_bf16 v[248:251], v[92:95], v[52:55], v[248:251]
ds_read_b64_tr_b16 v[82:83], v10 offset:1024
v_accvgpr_read_b32 v23, a62
v_mfma_f32_16x16x32_bf16 v[248:251], v[88:91], v[48:51], v[248:251]
v_accvgpr_read_b32 v31, a63
v_mul_f32 v20, s79, v20
v_mfma_f32_16x16x32_bf16 v[244:247], v[88:91], v[40:43], v[244:247]
ds_read_b64_tr_b16 v[84:85], v10 offset:8192
v_mul_f32 v28, s79, v28
v_mfma_f32_16x16x32_bf16 v[244:247], v[92:95], v[44:47], v[244:247]
ds_read_b64_tr_b16 v[86:87], v10 offset:9216
v_mul_f32 v21, s79, v21
v_mfma_f32_16x16x32_bf16 v[240:243], v[92:95], v[36:39], v[240:243]
s_add_u32 s72, s70, 129024
buffer_load_dwordx4 v4, s[4:7], s72 offen offset:2048 lds
v_mfma_f32_16x16x32_bf16 v[240:243], v[88:91], v[32:35], v[240:243]
s_waitcnt lgkmcnt(5)
v_mul_f32 v29, s79, v29
v_mul_f32 v22, s79, v22
v_mfma_f32_16x16x32_bf16 v[128:131], v[64:67], v[96:99], v[128:131]
ds_read_b64_tr_b16 v[88:89], v11 offset:0
v_mul_f32 v30, s79, v30
v_mfma_f32_16x16x32_bf16 v[128:131], v[68:71], v[100:103], v[128:131]
ds_read_b64_tr_b16 v[90:91], v11 offset:1024
v_mul_f32 v23, s79, v23
v_mfma_f32_16x16x32_bf16 v[132:135], v[68:71], v[108:111], v[132:135]
v_mul_f32 v31, s79, v31
v_cvt_pk_bf16_f32 v20, v20, v28
v_mfma_f32_16x16x32_bf16 v[132:135], v[64:67], v[104:107], v[132:135]
s_add_u32 s72, s70, 144384
buffer_load_dwordx4 v5, s[4:7], s72 offen offset:3072 lds
v_mfma_f32_16x16x32_bf16 v[136:139], v[64:67], v[112:115], v[136:139]
ds_read_b64_tr_b16 v[92:93], v11 offset:8192
v_cvt_pk_bf16_f32 v21, v21, v29
v_mfma_f32_16x16x32_bf16 v[136:139], v[68:71], v[116:119], v[136:139]
s_lshl_b32 s71, s73, 12
v_cvt_pk_bf16_f32 v22, v22, v30
v_cvt_pk_bf16_f32 v23, v23, v31
v_mfma_f32_16x16x32_bf16 v[140:143], v[68:71], v[124:127], v[140:143]
s_add_u32 s71, s71, s66
ds_read_b64_tr_b16 v[94:95], v11 offset:9216
v_mfma_f32_16x16x32_bf16 v[140:143], v[64:67], v[120:123], v[140:143]
s_waitcnt lgkmcnt(8)
v_mfma_f32_16x16x32_bf16 v[156:159], v[72:75], v[120:123], v[156:159]
s_add_u32 m0, s64, 32768
ds_read_b64_tr_b16 v[64:65], v12 offset:0
v_mfma_f32_16x16x32_bf16 v[156:159], v[76:79], v[124:127], v[156:159]
s_add_u32 s72, s71, 0
buffer_load_dwordx4 v6, s[12:15], s72 offen lds
v_mfma_f32_16x16x32_bf16 v[152:155], v[76:79], v[116:119], v[152:155]
s_add_u32 s73, s62, 6
ds_read_b64_tr_b16 v[66:67], v12 offset:1024
v_accvgpr_read_b32 v24, a168
v_mfma_f32_16x16x32_bf16 v[152:155], v[72:75], v[112:115], v[152:155]
s_add_u32 s70, s73, s65
v_accvgpr_read_b32 v28, a169
v_accvgpr_read_b32 v25, a170
v_mfma_f32_16x16x32_bf16 v[148:151], v[72:75], v[104:107], v[148:151]
s_and_b32 s70, s70, 3
ds_read_b64_tr_b16 v[68:69], v12 offset:8192
v_accvgpr_read_b32 v29, a171
v_mfma_f32_16x16x32_bf16 v[148:151], v[76:79], v[108:111], v[148:151]
s_and_b32 s73, s73, 12
ds_read_b64_tr_b16 v[70:71], v12 offset:9216
v_accvgpr_read_b32 v26, a172
v_mfma_f32_16x16x32_bf16 v[144:147], v[76:79], v[100:103], v[144:147]
s_add_u32 s72, s71, 31744
buffer_load_dwordx4 v6, s[12:15], s72 offen offset:1024 lds
v_mfma_f32_16x16x32_bf16 v[144:147], v[72:75], v[96:99], v[144:147]
s_waitcnt lgkmcnt(8)
v_accvgpr_read_b32 v30, a173
v_accvgpr_read_b32 v27, a174
v_mfma_f32_16x16x32_bf16 v[160:163], v[80:83], v[96:99], v[160:163]
s_or_b32 s73, s73, s70
ds_read_b64_tr_b16 v[72:73], v13 offset:0
v_accvgpr_read_b32 v31, a175
v_mfma_f32_16x16x32_bf16 v[160:163], v[84:87], v[100:103], v[160:163]
s_lshl_b32 s73, s73, 7
ds_read_b64_tr_b16 v[74:75], v13 offset:1024
v_cvt_pk_bf16_f32 v24, v24, v28
v_mfma_f32_16x16x32_bf16 v[164:167], v[84:87], v[108:111], v[164:167]
s_add_u32 s69, s73, s67
v_cvt_pk_bf16_f32 v25, v25, v29
v_cvt_pk_bf16_f32 v26, v26, v30
v_mfma_f32_16x16x32_bf16 v[164:167], v[80:83], v[104:107], v[164:167]
s_add_u32 s72, s71, 63488
buffer_load_dwordx4 v7, s[12:15], s72 offen offset:2048 lds
v_mfma_f32_16x16x32_bf16 v[168:171], v[80:83], v[112:115], v[168:171]
s_waitcnt vmcnt(17)
ds_read_b64_tr_b16 v[76:77], v13 offset:8192
v_cvt_pk_bf16_f32 v27, v27, v31
v_mfma_f32_16x16x32_bf16 v[168:171], v[84:87], v[116:119], v[168:171]
s_add_u32 s70, s73, s68
ds_read_b128 v[32:35], v18 offset:0
v_mfma_f32_16x16x32_bf16 v[172:175], v[84:87], v[124:127], v[172:175]
s_add_u32 s80, s77, 45056
ds_read_b64_tr_b16 v[78:79], v13 offset:9216
v_mfma_f32_16x16x32_bf16 v[172:175], v[80:83], v[120:123], v[172:175]
s_waitcnt lgkmcnt(9)
ds_read_b128 v[36:39], v19 offset:0
v_mfma_f32_16x16x32_bf16 v[188:191], v[88:91], v[120:123], v[188:191]
s_add_u32 s72, s71, 95232
buffer_load_dwordx4 v7, s[12:15], s72 offen offset:3072 lds
v_mfma_f32_16x16x32_bf16 v[188:191], v[92:95], v[124:127], v[188:191]
ds_read_b64_tr_b16 v[80:81], v14 offset:0
v_mfma_f32_16x16x32_bf16 v[184:187], v[92:95], v[116:119], v[184:187]
ds_read_b64_tr_b16 v[82:83], v14 offset:1024
v_mfma_f32_16x16x32_bf16 v[184:187], v[88:91], v[112:115], v[184:187]
buffer_store_dwordx4 v[20:23], v1, s[44:47], s80 offen sc1
v_mfma_f32_16x16x32_bf16 v[180:183], v[88:91], v[104:107], v[180:183]
s_add_u32 s80, s78, 9216
ds_read_b64_tr_b16 v[84:85], v14 offset:8192
v_mfma_f32_16x16x32_bf16 v[180:183], v[92:95], v[108:111], v[180:183]
s_add_u32 m0, s63, 131072
ds_read_b64_tr_b16 v[86:87], v14 offset:9216
v_mfma_f32_16x16x32_bf16 v[176:179], v[92:95], v[100:103], v[176:179]
s_add_u32 s72, s69, 0
buffer_load_dwordx4 v4, s[4:7], s72 offen lds
v_mfma_f32_16x16x32_bf16 v[176:179], v[88:91], v[96:99], v[176:179]
s_waitcnt lgkmcnt(10)
ds_read_b128 v[40:43], v18 offset:2048
v_accvgpr_read_b32 v20, a64
v_mfma_f32_16x16x32_bf16 v[192:195], v[64:67], v[96:99], v[192:195]
ds_read_b64_tr_b16 v[88:89], v15 offset:0
v_accvgpr_read_b32 v28, a65
v_mfma_f32_16x16x32_bf16 v[192:195], v[68:71], v[100:103], v[192:195]
ds_read_b64_tr_b16 v[90:91], v15 offset:1024
v_accvgpr_read_b32 v21, a66
v_mfma_f32_16x16x32_bf16 v[196:199], v[68:71], v[108:111], v[196:199]
ds_read_b64_tr_b16 v[92:93], v15 offset:8192
v_accvgpr_read_b32 v29, a67
v_mfma_f32_16x16x32_bf16 v[196:199], v[64:67], v[104:107], v[196:199]
s_add_u32 s72, s69, 15360
buffer_load_dwordx4 v5, s[4:7], s72 offen offset:1024 lds
v_mfma_f32_16x16x32_bf16 v[200:203], v[64:67], v[112:115], v[200:203]
ds_read_b64_tr_b16 v[94:95], v15 offset:9216
v_accvgpr_read_b32 v22, a96
v_mfma_f32_16x16x32_bf16 v[200:203], v[68:71], v[116:119], v[200:203]
ds_read_b128 v[44:47], v19 offset:2048
v_accvgpr_read_b32 v30, a97
v_mfma_f32_16x16x32_bf16 v[204:207], v[68:71], v[124:127], v[204:207]
buffer_store_dwordx4 v[24:27], v1, s[44:47], s80 offen sc1
v_mfma_f32_16x16x32_bf16 v[204:207], v[64:67], v[120:123], v[204:207]
s_waitcnt lgkmcnt(11)
ds_read_b128 v[48:51], v18 offset:4096
v_accvgpr_read_b32 v23, a98
v_mfma_f32_16x16x32_bf16 v[220:223], v[72:75], v[120:123], v[220:223]
s_add_u32 s72, s69, 129024
buffer_load_dwordx4 v4, s[4:7], s72 offen offset:2048 lds
v_mfma_f32_16x16x32_bf16 v[220:223], v[76:79], v[124:127], v[220:223]
v_accvgpr_read_b32 v31, a99
v_mul_f32 v20, s79, v20
v_mfma_f32_16x16x32_bf16 v[216:219], v[76:79], v[116:119], v[216:219]
s_waitcnt vmcnt(19) lgkmcnt(2)
ds_read_b128 v[52:55], v19 offset:4096
v_mul_f32 v28, s79, v28
v_mfma_f32_16x16x32_bf16 v[216:219], v[72:75], v[112:115], v[216:219]
s_barrier
ds_read_b128 v[56:59], v18 offset:6144
v_mul_f32 v21, s79, v21
v_mfma_f32_16x16x32_bf16 v[212:215], v[72:75], v[104:107], v[212:215]
ds_read_b64_tr_b16 v[64:65], v8 offset:16384
ds_read_b64_tr_b16 v[66:67], v8 offset:17408
v_mfma_f32_16x16x32_bf16 v[212:215], v[76:79], v[108:111], v[212:215]
ds_read_b64_tr_b16 v[68:69], v8 offset:24576
v_mul_f32 v29, s79, v29
v_mfma_f32_16x16x32_bf16 v[208:211], v[76:79], v[100:103], v[208:211]
s_add_u32 s72, s69, 144384
buffer_load_dwordx4 v5, s[4:7], s72 offen offset:3072 lds
v_mfma_f32_16x16x32_bf16 v[208:211], v[72:75], v[96:99], v[208:211]
ds_read_b64_tr_b16 v[70:71], v8 offset:25600
v_mul_f32 v22, s79, v22
v_mfma_f32_16x16x32_bf16 v[224:227], v[80:83], v[96:99], v[224:227]
ds_read_b64_tr_b16 v[72:73], v9 offset:16384
v_mul_f32 v30, s79, v30
v_mfma_f32_16x16x32_bf16 v[224:227], v[84:87], v[100:103], v[224:227]
ds_read_b64_tr_b16 v[74:75], v9 offset:17408
v_mul_f32 v23, s79, v23
v_mfma_f32_16x16x32_bf16 v[228:231], v[84:87], v[108:111], v[228:231]
s_add_u32 m0, s63, 135168
v_mul_f32 v31, s79, v31
v_cvt_pk_bf16_f32 v20, v20, v28
v_mfma_f32_16x16x32_bf16 v[228:231], v[80:83], v[104:107], v[228:231]
s_add_u32 s72, s70, 0
buffer_load_dwordx4 v4, s[4:7], s72 offen lds
v_mfma_f32_16x16x32_bf16 v[232:235], v[80:83], v[112:115], v[232:235]
ds_read_b64_tr_b16 v[76:77], v9 offset:24576
v_cvt_pk_bf16_f32 v21, v21, v29
v_mfma_f32_16x16x32_bf16 v[232:235], v[84:87], v[116:119], v[232:235]
ds_read_b128 v[60:63], v19 offset:6144
v_cvt_pk_bf16_f32 v22, v22, v30
v_mfma_f32_16x16x32_bf16 v[236:239], v[84:87], v[124:127], v[236:239]
ds_read_b64_tr_b16 v[78:79], v9 offset:25600
v_cvt_pk_bf16_f32 v23, v23, v31
v_mfma_f32_16x16x32_bf16 v[236:239], v[80:83], v[120:123], v[236:239]
s_add_u32 s80, s77, 1024
buffer_store_dwordx4 v[20:23], v1, s[44:47], s80 offen sc1
v_mfma_f32_16x16x32_bf16 v[252:255], v[88:91], v[120:123], v[252:255]
s_add_u32 s72, s70, 15360
buffer_load_dwordx4 v5, s[4:7], s72 offen offset:1024 lds
v_mfma_f32_16x16x32_bf16 v[252:255], v[92:95], v[124:127], v[252:255]
ds_read_b64_tr_b16 v[80:81], v10 offset:16384
v_accvgpr_read_b32 v24, a176
v_mfma_f32_16x16x32_bf16 v[248:251], v[92:95], v[116:119], v[248:251]
ds_read_b64_tr_b16 v[82:83], v10 offset:17408
v_accvgpr_read_b32 v28, a177
v_mfma_f32_16x16x32_bf16 v[248:251], v[88:91], v[112:115], v[248:251]
v_accvgpr_read_b32 v25, a178
v_accvgpr_read_b32 v29, a179
v_mfma_f32_16x16x32_bf16 v[244:247], v[88:91], v[104:107], v[244:247]
ds_read_b64_tr_b16 v[84:85], v10 offset:24576
v_accvgpr_read_b32 v26, a180
v_mfma_f32_16x16x32_bf16 v[244:247], v[92:95], v[108:111], v[244:247]
ds_read_b64_tr_b16 v[86:87], v10 offset:25600
v_accvgpr_read_b32 v30, a181
v_mfma_f32_16x16x32_bf16 v[240:243], v[92:95], v[100:103], v[240:243]
s_add_u32 s72, s70, 129024
buffer_load_dwordx4 v4, s[4:7], s72 offen offset:2048 lds
v_mfma_f32_16x16x32_bf16 v[240:243], v[88:91], v[96:99], v[240:243]
s_waitcnt lgkmcnt(5)
v_accvgpr_read_b32 v27, a182
v_accvgpr_read_b32 v31, a183
v_mfma_f32_16x16x32_bf16 v[128:131], v[64:67], v[32:35], v[128:131]
ds_read_b64_tr_b16 v[88:89], v11 offset:16384
v_cvt_pk_bf16_f32 v24, v24, v28
v_mfma_f32_16x16x32_bf16 v[128:131], v[68:71], v[36:39], v[128:131]
ds_read_b64_tr_b16 v[90:91], v11 offset:17408
v_cvt_pk_bf16_f32 v25, v25, v29
v_mfma_f32_16x16x32_bf16 v[132:135], v[68:71], v[44:47], v[132:135]
v_cvt_pk_bf16_f32 v26, v26, v30
v_cvt_pk_bf16_f32 v27, v27, v31
v_mfma_f32_16x16x32_bf16 v[132:135], v[64:67], v[40:43], v[132:135]
s_add_u32 s72, s70, 144384
buffer_load_dwordx4 v5, s[4:7], s72 offen offset:3072 lds
v_mfma_f32_16x16x32_bf16 v[136:139], v[64:67], v[48:51], v[136:139]
s_add_u32 s80, s78, 33792
ds_read_b64_tr_b16 v[92:93], v11 offset:24576
v_mfma_f32_16x16x32_bf16 v[136:139], v[68:71], v[52:55], v[136:139]
s_lshl_b32 s71, s73, 12
buffer_store_dwordx4 v[24:27], v1, s[44:47], s80 offen sc1
v_mfma_f32_16x16x32_bf16 v[140:143], v[68:71], v[60:63], v[140:143]
s_add_u32 s71, s71, s66
ds_read_b64_tr_b16 v[94:95], v11 offset:25600
v_mfma_f32_16x16x32_bf16 v[140:143], v[64:67], v[56:59], v[140:143]
s_waitcnt lgkmcnt(8)
v_mfma_f32_16x16x32_bf16 v[156:159], v[72:75], v[56:59], v[156:159]
s_add_u32 m0, s64, 0
ds_read_b64_tr_b16 v[64:65], v12 offset:16384
v_mfma_f32_16x16x32_bf16 v[156:159], v[76:79], v[60:63], v[156:159]
s_add_u32 s72, s71, 0
buffer_load_dwordx4 v6, s[12:15], s72 offen lds
v_mfma_f32_16x16x32_bf16 v[152:155], v[76:79], v[52:55], v[152:155]
s_add_u32 s73, s62, 7
ds_read_b64_tr_b16 v[66:67], v12 offset:17408
v_mfma_f32_16x16x32_bf16 v[152:155], v[72:75], v[48:51], v[152:155]
s_add_u32 s70, s73, s65
v_mfma_f32_16x16x32_bf16 v[148:151], v[72:75], v[40:43], v[148:151]
s_and_b32 s70, s70, 3
ds_read_b64_tr_b16 v[68:69], v12 offset:24576
v_accvgpr_read_b32 v20, a68
v_mfma_f32_16x16x32_bf16 v[148:151], v[76:79], v[44:47], v[148:151]
s_and_b32 s73, s73, 12
ds_read_b64_tr_b16 v[70:71], v12 offset:25600
v_accvgpr_read_b32 v28, a69
v_mfma_f32_16x16x32_bf16 v[144:147], v[76:79], v[36:39], v[144:147]
s_add_u32 s72, s71, 31744
buffer_load_dwordx4 v6, s[12:15], s72 offen offset:1024 lds
v_mfma_f32_16x16x32_bf16 v[144:147], v[72:75], v[32:35], v[144:147]
s_waitcnt lgkmcnt(8)
v_accvgpr_read_b32 v21, a70
v_accvgpr_read_b32 v29, a71
v_mfma_f32_16x16x32_bf16 v[160:163], v[80:83], v[32:35], v[160:163]
s_or_b32 s73, s73, s70
ds_read_b64_tr_b16 v[72:73], v13 offset:16384
v_accvgpr_read_b32 v22, a100
v_mfma_f32_16x16x32_bf16 v[160:163], v[84:87], v[36:39], v[160:163]
s_lshl_b32 s73, s73, 7
ds_read_b64_tr_b16 v[74:75], v13 offset:17408
v_accvgpr_read_b32 v30, a101
v_mfma_f32_16x16x32_bf16 v[164:167], v[84:87], v[44:47], v[164:167]
s_add_u32 s69, s73, s67
v_accvgpr_read_b32 v23, a102
v_accvgpr_read_b32 v31, a103
v_mfma_f32_16x16x32_bf16 v[164:167], v[80:83], v[40:43], v[164:167]
s_add_u32 s72, s71, 63488
buffer_load_dwordx4 v7, s[12:15], s72 offen offset:2048 lds
v_mfma_f32_16x16x32_bf16 v[168:171], v[80:83], v[48:51], v[168:171]
s_waitcnt vmcnt(19)
ds_read_b64_tr_b16 v[76:77], v13 offset:24576
v_mul_f32 v20, s79, v20
v_mfma_f32_16x16x32_bf16 v[168:171], v[84:87], v[52:55], v[168:171]
s_add_u32 s70, s73, s68
ds_read_b128 v[96:99], v18 offset:32768
v_mul_f32 v28, s79, v28
v_mfma_f32_16x16x32_bf16 v[172:175], v[84:87], v[60:63], v[172:175]
ds_read_b64_tr_b16 v[78:79], v13 offset:25600
v_mul_f32 v21, s79, v21
v_mfma_f32_16x16x32_bf16 v[172:175], v[80:83], v[56:59], v[172:175]
s_waitcnt lgkmcnt(9)
ds_read_b128 v[100:103], v19 offset:32768
v_mul_f32 v29, s79, v29
v_mfma_f32_16x16x32_bf16 v[188:191], v[88:91], v[56:59], v[188:191]
s_add_u32 s72, s71, 95232
buffer_load_dwordx4 v7, s[12:15], s72 offen offset:3072 lds
v_mfma_f32_16x16x32_bf16 v[188:191], v[92:95], v[60:63], v[188:191]
ds_read_b64_tr_b16 v[80:81], v14 offset:16384
v_mul_f32 v22, s79, v22
v_mfma_f32_16x16x32_bf16 v[184:187], v[92:95], v[52:55], v[184:187]
ds_read_b64_tr_b16 v[82:83], v14 offset:17408
v_mul_f32 v30, s79, v30
v_mfma_f32_16x16x32_bf16 v[184:187], v[88:91], v[48:51], v[184:187]
v_mul_f32 v23, s79, v23
v_mul_f32 v31, s79, v31
v_mfma_f32_16x16x32_bf16 v[180:183], v[88:91], v[40:43], v[180:183]
ds_read_b64_tr_b16 v[84:85], v14 offset:24576
v_cvt_pk_bf16_f32 v20, v20, v28
v_mfma_f32_16x16x32_bf16 v[180:183], v[92:95], v[44:47], v[180:183]
s_add_u32 m0, s63, 65536
ds_read_b64_tr_b16 v[86:87], v14 offset:25600
v_cvt_pk_bf16_f32 v21, v21, v29
v_mfma_f32_16x16x32_bf16 v[176:179], v[92:95], v[36:39], v[176:179]
s_add_u32 s72, s69, 0
buffer_load_dwordx4 v4, s[4:7], s72 offen lds
v_mfma_f32_16x16x32_bf16 v[176:179], v[88:91], v[32:35], v[176:179]
s_waitcnt lgkmcnt(10)
ds_read_b128 v[104:107], v18 offset:34816
v_cvt_pk_bf16_f32 v22, v22, v30
v_mfma_f32_16x16x32_bf16 v[192:195], v[64:67], v[32:35], v[192:195]
ds_read_b64_tr_b16 v[88:89], v15 offset:16384
v_cvt_pk_bf16_f32 v23, v23, v31
v_mfma_f32_16x16x32_bf16 v[192:195], v[68:71], v[36:39], v[192:195]
s_add_u32 s80, s77, 5120
ds_read_b64_tr_b16 v[90:91], v15 offset:17408
v_mfma_f32_16x16x32_bf16 v[196:199], v[68:71], v[44:47], v[196:199]
ds_read_b64_tr_b16 v[92:93], v15 offset:24576
v_accvgpr_read_b32 v24, a184
v_mfma_f32_16x16x32_bf16 v[196:199], v[64:67], v[40:43], v[196:199]
s_add_u32 s72, s69, 15360
buffer_load_dwordx4 v5, s[4:7], s72 offen offset:1024 lds
v_mfma_f32_16x16x32_bf16 v[200:203], v[64:67], v[48:51], v[200:203]
ds_read_b64_tr_b16 v[94:95], v15 offset:25600
v_accvgpr_read_b32 v28, a185
v_mfma_f32_16x16x32_bf16 v[200:203], v[68:71], v[52:55], v[200:203]
ds_read_b128 v[108:111], v19 offset:34816
v_accvgpr_read_b32 v25, a186
v_mfma_f32_16x16x32_bf16 v[204:207], v[68:71], v[60:63], v[204:207]
buffer_store_dwordx4 v[20:23], v1, s[44:47], s80 offen sc1
v_mfma_f32_16x16x32_bf16 v[204:207], v[64:67], v[56:59], v[204:207]
s_waitcnt lgkmcnt(11)
ds_read_b128 v[112:115], v18 offset:36864
v_accvgpr_read_b32 v29, a187
v_mfma_f32_16x16x32_bf16 v[220:223], v[72:75], v[56:59], v[220:223]
s_add_u32 s72, s69, 129024
buffer_load_dwordx4 v4, s[4:7], s72 offen offset:2048 lds
v_mfma_f32_16x16x32_bf16 v[220:223], v[76:79], v[60:63], v[220:223]
v_accvgpr_read_b32 v26, a188
v_accvgpr_read_b32 v30, a189
v_mfma_f32_16x16x32_bf16 v[216:219], v[76:79], v[52:55], v[216:219]
s_waitcnt vmcnt(20) lgkmcnt(2)
ds_read_b128 v[116:119], v19 offset:36864
v_accvgpr_read_b32 v27, a190
v_mfma_f32_16x16x32_bf16 v[216:219], v[72:75], v[48:51], v[216:219]
s_barrier
ds_read_b128 v[120:123], v18 offset:38912
v_accvgpr_read_b32 v31, a191
v_mfma_f32_16x16x32_bf16 v[212:215], v[72:75], v[40:43], v[212:215]
ds_read_b64_tr_b16 v[64:65], v8 offset:32768
ds_read_b64_tr_b16 v[66:67], v8 offset:33792
v_mfma_f32_16x16x32_bf16 v[212:215], v[76:79], v[44:47], v[212:215]
ds_read_b64_tr_b16 v[68:69], v8 offset:40960
v_cvt_pk_bf16_f32 v24, v24, v28
v_mfma_f32_16x16x32_bf16 v[208:211], v[76:79], v[36:39], v[208:211]
s_add_u32 s72, s69, 144384
buffer_load_dwordx4 v5, s[4:7], s72 offen offset:3072 lds
v_mfma_f32_16x16x32_bf16 v[208:211], v[72:75], v[32:35], v[208:211]
ds_read_b64_tr_b16 v[70:71], v8 offset:41984
v_cvt_pk_bf16_f32 v25, v25, v29
v_mfma_f32_16x16x32_bf16 v[224:227], v[80:83], v[32:35], v[224:227]
ds_read_b64_tr_b16 v[72:73], v9 offset:32768
v_cvt_pk_bf16_f32 v26, v26, v30
v_mfma_f32_16x16x32_bf16 v[224:227], v[84:87], v[36:39], v[224:227]
ds_read_b64_tr_b16 v[74:75], v9 offset:33792
v_cvt_pk_bf16_f32 v27, v27, v31
v_mfma_f32_16x16x32_bf16 v[228:231], v[84:87], v[44:47], v[228:231]
s_add_u32 m0, s63, 69632
v_mfma_f32_16x16x32_bf16 v[228:231], v[80:83], v[40:43], v[228:231]
s_add_u32 s72, s70, 0
buffer_load_dwordx4 v4, s[4:7], s72 offen lds
v_mfma_f32_16x16x32_bf16 v[232:235], v[80:83], v[48:51], v[232:235]
s_add_u32 s80, s78, 41984
ds_read_b64_tr_b16 v[76:77], v9 offset:40960
v_mfma_f32_16x16x32_bf16 v[232:235], v[84:87], v[52:55], v[232:235]
ds_read_b128 v[124:127], v19 offset:38912
v_mfma_f32_16x16x32_bf16 v[236:239], v[84:87], v[60:63], v[236:239]
ds_read_b64_tr_b16 v[78:79], v9 offset:41984
v_mfma_f32_16x16x32_bf16 v[236:239], v[80:83], v[56:59], v[236:239]
buffer_store_dwordx4 v[24:27], v1, s[44:47], s80 offen sc1
v_mfma_f32_16x16x32_bf16 v[252:255], v[88:91], v[56:59], v[252:255]
s_add_u32 s72, s70, 15360
buffer_load_dwordx4 v5, s[4:7], s72 offen offset:1024 lds
v_mfma_f32_16x16x32_bf16 v[252:255], v[92:95], v[60:63], v[252:255]
ds_read_b64_tr_b16 v[80:81], v10 offset:32768
v_accvgpr_read_b32 v20, a72
v_mfma_f32_16x16x32_bf16 v[248:251], v[92:95], v[52:55], v[248:251]
ds_read_b64_tr_b16 v[82:83], v10 offset:33792
v_accvgpr_read_b32 v28, a73
v_mfma_f32_16x16x32_bf16 v[248:251], v[88:91], v[48:51], v[248:251]
v_accvgpr_read_b32 v21, a74
v_accvgpr_read_b32 v29, a75
v_mfma_f32_16x16x32_bf16 v[244:247], v[88:91], v[40:43], v[244:247]
ds_read_b64_tr_b16 v[84:85], v10 offset:40960
v_accvgpr_read_b32 v22, a104
v_mfma_f32_16x16x32_bf16 v[244:247], v[92:95], v[44:47], v[244:247]
ds_read_b64_tr_b16 v[86:87], v10 offset:41984
v_accvgpr_read_b32 v30, a105
v_mfma_f32_16x16x32_bf16 v[240:243], v[92:95], v[36:39], v[240:243]
s_add_u32 s72, s70, 129024
buffer_load_dwordx4 v4, s[4:7], s72 offen offset:2048 lds
v_mfma_f32_16x16x32_bf16 v[240:243], v[88:91], v[32:35], v[240:243]
s_waitcnt lgkmcnt(5)
v_accvgpr_read_b32 v23, a106
v_accvgpr_read_b32 v31, a107
v_mfma_f32_16x16x32_bf16 v[128:131], v[64:67], v[96:99], v[128:131]
s_lshr_b32 s75, s93, 4
ds_read_b64_tr_b16 v[88:89], v11 offset:32768
v_mul_f32 v20, s79, v20
v_mfma_f32_16x16x32_bf16 v[128:131], v[68:71], v[100:103], v[128:131]
s_and_b32 s75, s75, 0x7f00
ds_read_b64_tr_b16 v[90:91], v11 offset:33792
v_mul_f32 v28, s79, v28
v_mfma_f32_16x16x32_bf16 v[132:135], v[68:71], v[108:111], v[132:135]
s_add_u32 s75, s75, LcB1-Lpc0
v_lshrrev_b32 v2, 5, v0
v_lshlrev_b32 v2, 7, v2
v_mfma_f32_16x16x32_bf16 v[132:135], v[64:67], v[104:107], v[132:135]
s_add_u32 s72, s70, 144384
buffer_load_dwordx4 v5, s[4:7], s72 offen offset:3072 lds
v_mfma_f32_16x16x32_bf16 v[136:139], v[64:67], v[112:115], v[136:139]
v_add_u32 v2, s75, v2
v_min_u32 v2, Lcode_end-Lpc0, v2
v_mfma_f32_16x16x32_bf16 v[136:139], v[68:71], v[116:119], v[136:139]
s_lshl_b32 s71, s73, 12
global_load_dword v3, v2, s[98:99]
v_mfma_f32_16x16x32_bf16 v[140:143], v[68:71], v[124:127], v[140:143]
s_add_u32 s71, s71, s66
ds_read_b64_tr_b16 v[92:93], v11 offset:40960
v_mul_f32 v21, s79, v21
v_mfma_f32_16x16x32_bf16 v[140:143], v[64:67], v[120:123], v[140:143]
s_waitcnt lgkmcnt(7)
ds_read_b64_tr_b16 v[94:95], v11 offset:41984
v_mul_f32 v29, s79, v29
v_mfma_f32_16x16x32_bf16 v[156:159], v[72:75], v[120:123], v[156:159]
s_add_u32 m0, s64, 16384
ds_read_b64_tr_b16 v[64:65], v12 offset:32768
v_mul_f32 v22, s79, v22
v_mfma_f32_16x16x32_bf16 v[156:159], v[76:79], v[124:127], v[156:159]
s_add_u32 s72, s71, 0
buffer_load_dwordx4 v6, s[12:15], s72 offen lds
v_mfma_f32_16x16x32_bf16 v[152:155], v[76:79], v[116:119], v[152:155]
s_add_u32 s73, s62, 8
ds_read_b64_tr_b16 v[66:67], v12 offset:33792
v_mul_f32 v30, s79, v30
v_mfma_f32_16x16x32_bf16 v[152:155], v[72:75], v[112:115], v[152:155]
s_add_u32 s70, s73, s65
v_mul_f32 v23, s79, v23
v_mul_f32 v31, s79, v31
v_mfma_f32_16x16x32_bf16 v[148:151], v[72:75], v[104:107], v[148:151]
s_and_b32 s70, s70, 3
ds_read_b64_tr_b16 v[68:69], v12 offset:40960
v_cvt_pk_bf16_f32 v20, v20, v28
v_mfma_f32_16x16x32_bf16 v[148:151], v[76:79], v[108:111], v[148:151]
s_and_b32 s73, s73, 12
ds_read_b64_tr_b16 v[70:71], v12 offset:41984
v_cvt_pk_bf16_f32 v21, v21, v29
v_mfma_f32_16x16x32_bf16 v[144:147], v[76:79], v[100:103], v[144:147]
s_add_u32 s72, s71, 31744
buffer_load_dwordx4 v6, s[12:15], s72 offen offset:1024 lds
v_mfma_f32_16x16x32_bf16 v[144:147], v[72:75], v[96:99], v[144:147]
s_waitcnt lgkmcnt(8)
v_cvt_pk_bf16_f32 v22, v22, v30
v_cvt_pk_bf16_f32 v23, v23, v31
v_mfma_f32_16x16x32_bf16 v[160:163], v[80:83], v[96:99], v[160:163]
s_or_b32 s73, s73, s70
ds_read_b64_tr_b16 v[72:73], v13 offset:32768
v_accvgpr_read_b32 v24, a192
v_mfma_f32_16x16x32_bf16 v[160:163], v[84:87], v[100:103], v[160:163]
s_lshl_b32 s73, s73, 7
ds_read_b64_tr_b16 v[74:75], v13 offset:33792
v_accvgpr_read_b32 v28, a193
v_mfma_f32_16x16x32_bf16 v[164:167], v[84:87], v[108:111], v[164:167]
s_add_u32 s69, s73, s67
v_accvgpr_read_b32 v25, a194
v_accvgpr_read_b32 v29, a195
v_mfma_f32_16x16x32_bf16 v[164:167], v[80:83], v[104:107], v[164:167]
s_add_u32 s72, s71, 63488
buffer_load_dwordx4 v7, s[12:15], s72 offen offset:2048 lds
v_mfma_f32_16x16x32_bf16 v[168:171], v[80:83], v[112:115], v[168:171]
s_waitcnt vmcnt(19)
ds_read_b64_tr_b16 v[76:77], v13 offset:40960
v_accvgpr_read_b32 v26, a196
v_mfma_f32_16x16x32_bf16 v[168:171], v[84:87], v[116:119], v[168:171]
s_add_u32 s70, s73, s68
ds_read_b128 v[32:35], v16 offset:0
v_accvgpr_read_b32 v30, a197
v_mfma_f32_16x16x32_bf16 v[172:175], v[84:87], v[124:127], v[172:175]
s_add_u32 s80, s77, 9216
ds_read_b64_tr_b16 v[78:79], v13 offset:41984
v_accvgpr_read_b32 v27, a198
v_mfma_f32_16x16x32_bf16 v[172:175], v[80:83], v[120:123], v[172:175]
s_waitcnt lgkmcnt(9)
ds_read_b128 v[36:39], v17 offset:0
v_accvgpr_read_b32 v31, a199
v_mfma_f32_16x16x32_bf16 v[188:191], v[88:91], v[120:123], v[188:191]
s_add_u32 s72, s71, 95232
buffer_load_dwordx4 v7, s[12:15], s72 offen offset:3072 lds
v_mfma_f32_16x16x32_bf16 v[188:191], v[92:95], v[124:127], v[188:191]
ds_read_b64_tr_b16 v[80:81], v14 offset:32768
v_cvt_pk_bf16_f32 v24, v24, v28
v_mfma_f32_16x16x32_bf16 v[184:187], v[92:95], v[116:119], v[184:187]
ds_read_b64_tr_b16 v[82:83], v14 offset:33792
v_cvt_pk_bf16_f32 v25, v25, v29
v_mfma_f32_16x16x32_bf16 v[184:187], v[88:91], v[112:115], v[184:187]
buffer_store_dwordx4 v[20:23], v1, s[44:47], s80 offen sc1
v_mfma_f32_16x16x32_bf16 v[180:183], v[88:91], v[104:107], v[180:183]
ds_read_b64_tr_b16 v[84:85], v14 offset:40960
v_cvt_pk_bf16_f32 v26, v26, v30
v_mfma_f32_16x16x32_bf16 v[180:183], v[92:95], v[108:111], v[180:183]
s_add_u32 m0, s63, 98304
ds_read_b64_tr_b16 v[86:87], v14 offset:41984
v_cvt_pk_bf16_f32 v27, v27, v31
v_mfma_f32_16x16x32_bf16 v[176:179], v[92:95], v[100:103], v[176:179]
s_add_u32 s72, s69, 0
buffer_load_dwordx4 v4, s[4:7], s72 offen lds
v_mfma_f32_16x16x32_bf16 v[176:179], v[88:91], v[96:99], v[176:179]
s_waitcnt lgkmcnt(10)
ds_read_b128 v[40:43], v16 offset:2048
v_mfma_f32_16x16x32_bf16 v[192:195], v[64:67], v[96:99], v[192:195]
s_add_u32 s80, s78, 2048
ds_read_b64_tr_b16 v[88:89], v15 offset:32768
v_mfma_f32_16x16x32_bf16 v[192:195], v[68:71], v[100:103], v[192:195]
ds_read_b64_tr_b16 v[90:91], v15 offset:33792
v_mfma_f32_16x16x32_bf16 v[196:199], v[68:71], v[108:111], v[196:199]
ds_read_b64_tr_b16 v[92:93], v15 offset:40960
v_mfma_f32_16x16x32_bf16 v[196:199], v[64:67], v[104:107], v[196:199]
s_add_u32 s72, s69, 15360
buffer_load_dwordx4 v5, s[4:7], s72 offen offset:1024 lds
v_mfma_f32_16x16x32_bf16 v[200:203], v[64:67], v[112:115], v[200:203]
ds_read_b64_tr_b16 v[94:95], v15 offset:41984
v_accvgpr_read_b32 v20, a76
v_mfma_f32_16x16x32_bf16 v[200:203], v[68:71], v[116:119], v[200:203]
ds_read_b128 v[44:47], v17 offset:2048
v_accvgpr_read_b32 v28, a77
v_mfma_f32_16x16x32_bf16 v[204:207], v[68:71], v[124:127], v[204:207]
buffer_store_dwordx4 v[24:27], v1, s[44:47], s80 offen sc1
v_mfma_f32_16x16x32_bf16 v[204:207], v[64:67], v[120:123], v[204:207]
s_waitcnt lgkmcnt(11)
ds_read_b128 v[48:51], v16 offset:4096
v_accvgpr_read_b32 v21, a78
v_mfma_f32_16x16x32_bf16 v[220:223], v[72:75], v[120:123], v[220:223]
s_add_u32 s72, s69, 129024
buffer_load_dwordx4 v4, s[4:7], s72 offen offset:2048 lds
v_mfma_f32_16x16x32_bf16 v[220:223], v[76:79], v[124:127], v[220:223]
v_accvgpr_read_b32 v29, a79
v_accvgpr_read_b32 v22, a108
v_mfma_f32_16x16x32_bf16 v[216:219], v[76:79], v[116:119], v[216:219]
s_waitcnt vmcnt(20) lgkmcnt(2)
ds_read_b128 v[52:55], v17 offset:4096
v_accvgpr_read_b32 v30, a109
v_mfma_f32_16x16x32_bf16 v[216:219], v[72:75], v[112:115], v[216:219]
s_barrier
ds_read_b128 v[56:59], v16 offset:6144
v_accvgpr_read_b32 v23, a110
v_mfma_f32_16x16x32_bf16 v[212:215], v[72:75], v[104:107], v[212:215]
ds_read_b64_tr_b16 v[64:65], v8 offset:0
ds_read_b64_tr_b16 v[66:67], v8 offset:1024
v_mfma_f32_16x16x32_bf16 v[212:215], v[76:79], v[108:111], v[212:215]
ds_read_b64_tr_b16 v[68:69], v8 offset:8192
v_accvgpr_read_b32 v31, a111
v_mfma_f32_16x16x32_bf16 v[208:211], v[76:79], v[100:103], v[208:211]
s_add_u32 s72, s69, 144384
buffer_load_dwordx4 v5, s[4:7], s72 offen offset:3072 lds
v_mfma_f32_16x16x32_bf16 v[208:211], v[72:75], v[96:99], v[208:211]
ds_read_b64_tr_b16 v[70:71], v8 offset:9216
v_mul_f32 v20, s79, v20
v_mfma_f32_16x16x32_bf16 v[224:227], v[80:83], v[96:99], v[224:227]
ds_read_b64_tr_b16 v[72:73], v9 offset:0
v_mul_f32 v28, s79, v28
v_mfma_f32_16x16x32_bf16 v[224:227], v[84:87], v[100:103], v[224:227]
ds_read_b64_tr_b16 v[74:75], v9 offset:1024
v_mul_f32 v21, s79, v21
v_mfma_f32_16x16x32_bf16 v[228:231], v[84:87], v[108:111], v[228:231]
s_add_u32 m0, s63, 102400
v_mul_f32 v29, s79, v29
v_mul_f32 v22, s79, v22
v_mfma_f32_16x16x32_bf16 v[228:231], v[80:83], v[104:107], v[228:231]
s_add_u32 s72, s70, 0
buffer_load_dwordx4 v4, s[4:7], s72 offen lds
v_mfma_f32_16x16x32_bf16 v[232:235], v[80:83], v[112:115], v[232:235]
ds_read_b64_tr_b16 v[76:77], v9 offset:8192
v_mul_f32 v30, s79, v30
v_mfma_f32_16x16x32_bf16 v[232:235], v[84:87], v[116:119], v[232:235]
ds_read_b128 v[60:63], v17 offset:6144
v_mul_f32 v23, s79, v23
v_mfma_f32_16x16x32_bf16 v[236:239], v[84:87], v[124:127], v[236:239]
ds_read_b64_tr_b16 v[78:79], v9 offset:9216
v_mul_f32 v31, s79, v31
v_mfma_f32_16x16x32_bf16 v[236:239], v[80:83], v[120:123], v[236:239]
v_cvt_pk_bf16_f32 v20, v20, v28
v_cvt_pk_bf16_f32 v21, v21, v29
v_mfma_f32_16x16x32_bf16 v[252:255], v[88:91], v[120:123], v[252:255]
s_add_u32 s72, s70, 15360
buffer_load_dwordx4 v5, s[4:7], s72 offen offset:1024 lds
v_mfma_f32_16x16x32_bf16 v[252:255], v[92:95], v[124:127], v[252:255]
ds_read_b64_tr_b16 v[80:81], v10 offset:0
v_cvt_pk_bf16_f32 v22, v22, v30
v_mfma_f32_16x16x32_bf16 v[248:251], v[92:95], v[116:119], v[248:251]
ds_read_b64_tr_b16 v[82:83], v10 offset:1024
v_cvt_pk_bf16_f32 v23, v23, v31
v_mfma_f32_16x16x32_bf16 v[248:251], v[88:91], v[112:115], v[248:251]
s_add_u32 s80, s77, 13312
buffer_store_dwordx4 v[20:23], v1, s[44:47], s80 offen sc1
v_mfma_f32_16x16x32_bf16 v[244:247], v[88:91], v[104:107], v[244:247]
ds_read_b64_tr_b16 v[84:85], v10 offset:8192
v_accvgpr_read_b32 v24, a200
v_mfma_f32_16x16x32_bf16 v[244:247], v[92:95], v[108:111], v[244:247]
ds_read_b64_tr_b16 v[86:87], v10 offset:9216
v_accvgpr_read_b32 v28, a201
v_mfma_f32_16x16x32_bf16 v[240:243], v[92:95], v[100:103], v[240:243]
s_add_u32 s72, s70, 129024
buffer_load_dwordx4 v4, s[4:7], s72 offen offset:2048 lds
v_mfma_f32_16x16x32_bf16 v[240:243], v[88:91], v[96:99], v[240:243]
s_waitcnt lgkmcnt(5)
v_accvgpr_read_b32 v25, a202
v_accvgpr_read_b32 v29, a203
v_mfma_f32_16x16x32_bf16 v[128:131], v[64:67], v[32:35], v[128:131]
ds_read_b64_tr_b16 v[88:89], v11 offset:0
v_accvgpr_read_b32 v26, a204
v_mfma_f32_16x16x32_bf16 v[128:131], v[68:71], v[36:39], v[128:131]
ds_read_b64_tr_b16 v[90:91], v11 offset:1024
v_accvgpr_read_b32 v30, a205
v_mfma_f32_16x16x32_bf16 v[132:135], v[68:71], v[44:47], v[132:135]
v_accvgpr_read_b32 v27, a206
v_accvgpr_read_b32 v31, a207
v_mfma_f32_16x16x32_bf16 v[132:135], v[64:67], v[40:43], v[132:135]
s_add_u32 s72, s70, 144384
buffer_load_dwordx4 v5, s[4:7], s72 offen offset:3072 lds
v_mfma_f32_16x16x32_bf16 v[136:139], v[64:67], v[48:51], v[136:139]
ds_read_b64_tr_b16 v[92:93], v11 offset:8192
v_cvt_pk_bf16_f32 v24, v24, v28
v_mfma_f32_16x16x32_bf16 v[136:139], v[68:71], v[52:55], v[136:139]
s_lshl_b32 s71, s73, 12
v_cvt_pk_bf16_f32 v25, v25, v29
v_cvt_pk_bf16_f32 v26, v26, v30
v_mfma_f32_16x16x32_bf16 v[140:143], v[68:71], v[60:63], v[140:143]
s_add_u32 s71, s71, s66
ds_read_b64_tr_b16 v[94:95], v11 offset:9216
v_cvt_pk_bf16_f32 v27, v27, v31
v_mfma_f32_16x16x32_bf16 v[140:143], v[64:67], v[56:59], v[140:143]
s_waitcnt lgkmcnt(8)
v_mfma_f32_16x16x32_bf16 v[156:159], v[72:75], v[56:59], v[156:159]
s_add_u32 m0, s64, 32768
ds_read_b64_tr_b16 v[64:65], v12 offset:0
v_mfma_f32_16x16x32_bf16 v[156:159], v[76:79], v[60:63], v[156:159]
s_add_u32 s72, s71, 0
buffer_load_dwordx4 v6, s[12:15], s72 offen lds
v_mfma_f32_16x16x32_bf16 v[152:155], v[76:79], v[52:55], v[152:155]
s_add_u32 s73, s62, 9
ds_read_b64_tr_b16 v[66:67], v12 offset:1024
v_mfma_f32_16x16x32_bf16 v[152:155], v[72:75], v[48:51], v[152:155]
s_add_u32 s70, s73, s65
v_mfma_f32_16x16x32_bf16 v[148:151], v[72:75], v[40:43], v[148:151]
s_and_b32 s70, s70, 3
ds_read_b64_tr_b16 v[68:69], v12 offset:8192
v_mfma_f32_16x16x32_bf16 v[148:151], v[76:79], v[44:47], v[148:151]
s_and_b32 s73, s73, 12
ds_read_b64_tr_b16 v[70:71], v12 offset:9216
v_mfma_f32_16x16x32_bf16 v[144:147], v[76:79], v[36:39], v[144:147]
s_add_u32 s72, s71, 31744
buffer_load_dwordx4 v6, s[12:15], s72 offen offset:1024 lds
v_mfma_f32_16x16x32_bf16 v[144:147], v[72:75], v[32:35], v[144:147]
s_waitcnt lgkmcnt(8)
v_mfma_f32_16x16x32_bf16 v[160:163], v[80:83], v[32:35], v[160:163]
s_or_b32 s73, s73, s70
ds_read_b64_tr_b16 v[72:73], v13 offset:0
v_accvgpr_read_b32 v20, a80
v_mfma_f32_16x16x32_bf16 v[160:163], v[84:87], v[36:39], v[160:163]
s_lshl_b32 s73, s73, 7
ds_read_b64_tr_b16 v[74:75], v13 offset:1024
v_accvgpr_read_b32 v28, a81
v_mfma_f32_16x16x32_bf16 v[164:167], v[84:87], v[44:47], v[164:167]
s_add_u32 s69, s73, s67
v_accvgpr_read_b32 v21, a82
v_accvgpr_read_b32 v29, a83
v_mfma_f32_16x16x32_bf16 v[164:167], v[80:83], v[40:43], v[164:167]
s_add_u32 s72, s71, 63488
buffer_load_dwordx4 v7, s[12:15], s72 offen offset:2048 lds
v_mfma_f32_16x16x32_bf16 v[168:171], v[80:83], v[48:51], v[168:171]
s_waitcnt vmcnt(19)
ds_read_b64_tr_b16 v[76:77], v13 offset:8192
v_accvgpr_read_b32 v22, a112
v_mfma_f32_16x16x32_bf16 v[168:171], v[84:87], v[52:55], v[168:171]
s_add_u32 s70, s73, s68
ds_read_b128 v[96:99], v18 offset:0
v_accvgpr_read_b32 v30, a113
v_mfma_f32_16x16x32_bf16 v[172:175], v[84:87], v[60:63], v[172:175]
s_add_u32 s80, s78, 10240
ds_read_b64_tr_b16 v[78:79], v13 offset:9216
v_accvgpr_read_b32 v23, a114
v_mfma_f32_16x16x32_bf16 v[172:175], v[80:83], v[56:59], v[172:175]
s_waitcnt lgkmcnt(9)
ds_read_b128 v[100:103], v19 offset:0
v_accvgpr_read_b32 v31, a115
v_mfma_f32_16x16x32_bf16 v[188:191], v[88:91], v[56:59], v[188:191]
s_add_u32 s72, s71, 95232
buffer_load_dwordx4 v7, s[12:15], s72 offen offset:3072 lds
v_mfma_f32_16x16x32_bf16 v[188:191], v[92:95], v[60:63], v[188:191]
ds_read_b64_tr_b16 v[80:81], v14 offset:0
v_mul_f32 v20, s79, v20
v_mfma_f32_16x16x32_bf16 v[184:187], v[92:95], v[52:55], v[184:187]
ds_read_b64_tr_b16 v[82:83], v14 offset:1024
v_mul_f32 v28, s79, v28
v_mfma_f32_16x16x32_bf16 v[184:187], v[88:91], v[48:51], v[184:187]
buffer_store_dwordx4 v[24:27], v1, s[44:47], s80 offen sc1
v_mfma_f32_16x16x32_bf16 v[180:183], v[88:91], v[40:43], v[180:183]
ds_read_b64_tr_b16 v[84:85], v14 offset:8192
v_mul_f32 v21, s79, v21
v_mfma_f32_16x16x32_bf16 v[180:183], v[92:95], v[44:47], v[180:183]
s_add_u32 m0, s63, 131072
ds_read_b64_tr_b16 v[86:87], v14 offset:9216
v_mul_f32 v29, s79, v29
v_mfma_f32_16x16x32_bf16 v[176:179], v[92:95], v[36:39], v[176:179]
s_add_u32 s72, s69, 0
buffer_load_dwordx4 v4, s[4:7], s72 offen lds
v_mfma_f32_16x16x32_bf16 v[176:179], v[88:91], v[32:35], v[176:179]
s_waitcnt lgkmcnt(10)
ds_read_b128 v[104:107], v18 offset:2048
v_mul_f32 v22, s79, v22
v_mfma_f32_16x16x32_bf16 v[192:195], v[64:67], v[32:35], v[192:195]
ds_read_b64_tr_b16 v[88:89], v15 offset:0
v_mul_f32 v30, s79, v30
v_mfma_f32_16x16x32_bf16 v[192:195], v[68:71], v[36:39], v[192:195]
ds_read_b64_tr_b16 v[90:91], v15 offset:1024
v_mul_f32 v23, s79, v23
v_mfma_f32_16x16x32_bf16 v[196:199], v[68:71], v[44:47], v[196:199]
ds_read_b64_tr_b16 v[92:93], v15 offset:8192
v_mul_f32 v31, s79, v31
v_mfma_f32_16x16x32_bf16 v[196:199], v[64:67], v[40:43], v[196:199]
s_add_u32 s72, s69, 15360
buffer_load_dwordx4 v5, s[4:7], s72 offen offset:1024 lds
v_mfma_f32_16x16x32_bf16 v[200:203], v[64:67], v[48:51], v[200:203]
ds_read_b64_tr_b16 v[94:95], v15 offset:9216
v_cvt_pk_bf16_f32 v20, v20, v28
v_mfma_f32_16x16x32_bf16 v[200:203], v[68:71], v[52:55], v[200:203]
ds_read_b128 v[108:111], v19 offset:2048
v_cvt_pk_bf16_f32 v21, v21, v29
v_mfma_f32_16x16x32_bf16 v[204:207], v[68:71], v[60:63], v[204:207]
v_cvt_pk_bf16_f32 v22, v22, v30
v_cvt_pk_bf16_f32 v23, v23, v31
v_mfma_f32_16x16x32_bf16 v[204:207], v[64:67], v[56:59], v[204:207]
s_waitcnt lgkmcnt(11)
ds_read_b128 v[112:115], v18 offset:4096
v_accvgpr_read_b32 v24, a208
v_mfma_f32_16x16x32_bf16 v[220:223], v[72:75], v[56:59], v[220:223]
s_add_u32 s72, s69, 129024
buffer_load_dwordx4 v4, s[4:7], s72 offen offset:2048 lds
v_mfma_f32_16x16x32_bf16 v[220:223], v[76:79], v[60:63], v[220:223]
s_add_u32 s80, s77, 33792
s_nop 3
s_mov_b64 exec, 0
s_cmp_eq_u32 s58, 0
s_cbranch_scc1 Lstub0
s_cmp_eq_u32 s58, 1
s_cbranch_scc1 Lstub1
s_cmp_eq_u32 s58, 2
s_cbranch_scc1 Lstub2
s_branch Lstub3
Lret:
s_mov_b64 exec, -1
s_nop 3
v_mfma_f32_16x16x32_bf16 v[216:219], v[76:79], v[52:55], v[216:219]
s_waitcnt vmcnt(19) lgkmcnt(2)
ds_read_b128 v[116:119], v19 offset:4096
v_accvgpr_read_b32 v28, a209
v_mfma_f32_16x16x32_bf16 v[216:219], v[72:75], v[48:51], v[216:219]
s_barrier
buffer_store_dwordx4 v[20:23], v1, s[44:47], s80 offen sc1
v_mfma_f32_16x16x32_bf16 v[212:215], v[72:75], v[40:43], v[212:215]
ds_read_b64_tr_b16 v[64:65], v8 offset:16384
ds_read_b64_tr_b16 v[66:67], v8 offset:17408
v_mfma_f32_16x16x32_bf16 v[212:215], v[76:79], v[44:47], v[212:215]
ds_read_b64_tr_b16 v[68:69], v8 offset:24576
v_accvgpr_read_b32 v25, a210
v_mfma_f32_16x16x32_bf16 v[208:211], v[76:79], v[36:39], v[208:211]
s_add_u32 s72, s69, 144384
buffer_load_dwordx4 v5, s[4:7], s72 offen offset:3072 lds
v_mfma_f32_16x16x32_bf16 v[208:211], v[72:75], v[32:35], v[208:211]
ds_read_b64_tr_b16 v[70:71], v8 offset:25600
v_accvgpr_read_b32 v29, a211
v_mfma_f32_16x16x32_bf16 v[224:227], v[80:83], v[32:35], v[224:227]
ds_read_b64_tr_b16 v[72:73], v9 offset:16384
v_accvgpr_read_b32 v26, a212
v_mfma_f32_16x16x32_bf16 v[224:227], v[84:87], v[36:39], v[224:227]
ds_read_b64_tr_b16 v[74:75], v9 offset:17408
v_accvgpr_read_b32 v30, a213
v_mfma_f32_16x16x32_bf16 v[228:231], v[84:87], v[44:47], v[228:231]
s_add_u32 m0, s63, 135168
ds_read_b128 v[120:123], v18 offset:6144
v_accvgpr_read_b32 v27, a214
v_mfma_f32_16x16x32_bf16 v[228:231], v[80:83], v[40:43], v[228:231]
s_add_u32 s72, s70, 0
buffer_load_dwordx4 v4, s[4:7], s72 offen lds
v_mfma_f32_16x16x32_bf16 v[232:235], v[80:83], v[48:51], v[232:235]
ds_read_b64_tr_b16 v[76:77], v9 offset:24576
v_accvgpr_read_b32 v31, a215
v_mfma_f32_16x16x32_bf16 v[232:235], v[84:87], v[52:55], v[232:235]
ds_read_b128 v[124:127], v19 offset:6144
v_cvt_pk_bf16_f32 v24, v24, v28
v_mfma_f32_16x16x32_bf16 v[236:239], v[84:87], v[60:63], v[236:239]
ds_read_b64_tr_b16 v[78:79], v9 offset:25600
v_cvt_pk_bf16_f32 v25, v25, v29
v_mfma_f32_16x16x32_bf16 v[236:239], v[80:83], v[56:59], v[236:239]
v_cvt_pk_bf16_f32 v26, v26, v30
v_cvt_pk_bf16_f32 v27, v27, v31
v_mfma_f32_16x16x32_bf16 v[252:255], v[88:91], v[56:59], v[252:255]
s_add_u32 s72, s70, 15360
buffer_load_dwordx4 v5, s[4:7], s72 offen offset:1024 lds
v_mfma_f32_16x16x32_bf16 v[252:255], v[92:95], v[60:63], v[252:255]
s_add_u32 s80, s78, 34816
ds_read_b64_tr_b16 v[80:81], v10 offset:16384
v_mfma_f32_16x16x32_bf16 v[248:251], v[92:95], v[52:55], v[248:251]
ds_read_b64_tr_b16 v[82:83], v10 offset:17408
v_mfma_f32_16x16x32_bf16 v[248:251], v[88:91], v[48:51], v[248:251]
buffer_store_dwordx4 v[24:27], v1, s[44:47], s80 offen sc1
v_mfma_f32_16x16x32_bf16 v[244:247], v[88:91], v[40:43], v[244:247]
ds_read_b64_tr_b16 v[84:85], v10 offset:24576
v_mfma_f32_16x16x32_bf16 v[244:247], v[92:95], v[44:47], v[244:247]
ds_read_b64_tr_b16 v[86:87], v10 offset:25600
v_accvgpr_read_b32 v20, a84
v_mfma_f32_16x16x32_bf16 v[240:243], v[92:95], v[36:39], v[240:243]
s_add_u32 s72, s70, 129024
buffer_load_dwordx4 v4, s[4:7], s72 offen offset:2048 lds
v_mfma_f32_16x16x32_bf16 v[240:243], v[88:91], v[32:35], v[240:243]
s_waitcnt lgkmcnt(5)
v_accvgpr_read_b32 v28, a85
v_accvgpr_read_b32 v21, a86
v_mfma_f32_16x16x32_bf16 v[128:131], v[64:67], v[96:99], v[128:131]
ds_read_b64_tr_b16 v[88:89], v11 offset:16384
v_accvgpr_read_b32 v29, a87
v_mfma_f32_16x16x32_bf16 v[128:131], v[68:71], v[100:103], v[128:131]
ds_read_b64_tr_b16 v[90:91], v11 offset:17408
v_accvgpr_read_b32 v22, a116
v_mfma_f32_16x16x32_bf16 v[132:135], v[68:71], v[108:111], v[132:135]
v_accvgpr_read_b32 v30, a117
v_accvgpr_read_b32 v23, a118
v_mfma_f32_16x16x32_bf16 v[132:135], v[64:67], v[104:107], v[132:135]
s_add_u32 s72, s70, 144384
buffer_load_dwordx4 v5, s[4:7], s72 offen offset:3072 lds
v_mfma_f32_16x16x32_bf16 v[136:139], v[64:67], v[112:115], v[136:139]
ds_read_b64_tr_b16 v[92:93], v11 offset:24576
v_accvgpr_read_b32 v31, a119
v_mfma_f32_16x16x32_bf16 v[136:139], v[68:71], v[116:119], v[136:139]
s_lshl_b32 s71, s73, 12
v_mul_f32 v20, s79, v20
v_mul_f32 v28, s79, v28
v_mfma_f32_16x16x32_bf16 v[140:143], v[68:71], v[124:127], v[140:143]
s_add_u32 s71, s71, s66
ds_read_b64_tr_b16 v[94:95], v11 offset:25600
v_mul_f32 v21, s79, v21
v_mfma_f32_16x16x32_bf16 v[140:143], v[64:67], v[120:123], v[140:143]
s_waitcnt lgkmcnt(8)
v_mul_f32 v29, s79, v29
v_mul_f32 v22, s79, v22
v_mfma_f32_16x16x32_bf16 v[156:159], v[72:75], v[120:123], v[156:159]
s_add_u32 m0, s64, 0
ds_read_b64_tr_b16 v[64:65], v12 offset:16384
v_mul_f32 v30, s79, v30
v_mfma_f32_16x16x32_bf16 v[156:159], v[76:79], v[124:127], v[156:159]
s_add_u32 s72, s71, 0
buffer_load_dwordx4 v6, s[12:15], s72 offen lds
v_mfma_f32_16x16x32_bf16 v[152:155], v[76:79], v[116:119], v[152:155]
s_add_u32 s73, s62, 10
ds_read_b64_tr_b16 v[66:67], v12 offset:17408
v_mul_f32 v23, s79, v23
v_mfma_f32_16x16x32_bf16 v[152:155], v[72:75], v[112:115], v[152:155]
s_add_u32 s70, s73, s65
v_mul_f32 v31, s79, v31
v_cvt_pk_bf16_f32 v20, v20, v28
v_mfma_f32_16x16x32_bf16 v[148:151], v[72:75], v[104:107], v[148:151]
s_and_b32 s70, s70, 3
ds_read_b64_tr_b16 v[68:69], v12 offset:24576
v_cvt_pk_bf16_f32 v21, v21, v29
v_mfma_f32_16x16x32_bf16 v[148:151], v[76:79], v[108:111], v[148:151]
s_and_b32 s73, s73, 12
ds_read_b64_tr_b16 v[70:71], v12 offset:25600
v_cvt_pk_bf16_f32 v22, v22, v30
v_mfma_f32_16x16x32_bf16 v[144:147], v[76:79], v[100:103], v[144:147]
s_add_u32 s72, s71, 31744
buffer_load_dwordx4 v6, s[12:15], s72 offen offset:1024 lds
v_mfma_f32_16x16x32_bf16 v[144:147], v[72:75], v[96:99], v[144:147]
s_waitcnt lgkmcnt(8)
v_cvt_pk_bf16_f32 v23, v23, v31
v_mfma_f32_16x16x32_bf16 v[160:163], v[80:83], v[96:99], v[160:163]
s_or_b32 s73, s73, s70
ds_read_b64_tr_b16 v[72:73], v13 offset:16384
v_mfma_f32_16x16x32_bf16 v[160:163], v[84:87], v[100:103], v[160:163]
s_lshl_b32 s73, s73, 7
ds_read_b64_tr_b16 v[74:75], v13 offset:17408
v_mfma_f32_16x16x32_bf16 v[164:167], v[84:87], v[108:111], v[164:167]
s_add_u32 s69, s73, s67
v_mfma_f32_16x16x32_bf16 v[164:167], v[80:83], v[104:107], v[164:167]
s_add_u32 s72, s71, 63488
buffer_load_dwordx4 v7, s[12:15], s72 offen offset:2048 lds
v_mfma_f32_16x16x32_bf16 v[168:171], v[80:83], v[112:115], v[168:171]
s_waitcnt vmcnt(18)
ds_read_b64_tr_b16 v[76:77], v13 offset:24576
v_accvgpr_read_b32 v24, a216
v_mfma_f32_16x16x32_bf16 v[168:171], v[84:87], v[116:119], v[168:171]
s_add_u32 s70, s73, s68
ds_read_b128 v[32:35], v18 offset:32768
v_accvgpr_read_b32 v28, a217
v_mfma_f32_16x16x32_bf16 v[172:175], v[84:87], v[124:127], v[172:175]
s_add_u32 s80, s77, 37888
ds_read_b64_tr_b16 v[78:79], v13 offset:25600
v_accvgpr_read_b32 v25, a218
v_mfma_f32_16x16x32_bf16 v[172:175], v[80:83], v[120:123], v[172:175]
s_waitcnt lgkmcnt(9)
ds_read_b128 v[36:39], v19 offset:32768
v_accvgpr_read_b32 v29, a219
v_mfma_f32_16x16x32_bf16 v[188:191], v[88:91], v[120:123], v[188:191]
s_add_u32 s72, s71, 95232
buffer_load_dwordx4 v7, s[12:15], s72 offen offset:3072 lds
v_mfma_f32_16x16x32_bf16 v[188:191], v[92:95], v[124:127], v[188:191]
ds_read_b64_tr_b16 v[80:81], v14 offset:16384
v_accvgpr_read_b32 v26, a220
v_mfma_f32_16x16x32_bf16 v[184:187], v[92:95], v[116:119], v[184:187]
ds_read_b64_tr_b16 v[82:83], v14 offset:17408
v_accvgpr_read_b32 v30, a221
v_mfma_f32_16x16x32_bf16 v[184:187], v[88:91], v[112:115], v[184:187]
buffer_store_dwordx4 v[20:23], v1, s[44:47], s80 offen sc1
v_mfma_f32_16x16x32_bf16 v[180:183], v[88:91], v[104:107], v[180:183]
ds_read_b64_tr_b16 v[84:85], v14 offset:24576
v_accvgpr_read_b32 v27, a222
v_mfma_f32_16x16x32_bf16 v[180:183], v[92:95], v[108:111], v[180:183]
s_add_u32 m0, s63, 65536
ds_read_b64_tr_b16 v[86:87], v14 offset:25600
v_accvgpr_read_b32 v31, a223
v_mfma_f32_16x16x32_bf16 v[176:179], v[92:95], v[100:103], v[176:179]
s_add_u32 s72, s69, 0
buffer_load_dwordx4 v4, s[4:7], s72 offen lds
v_mfma_f32_16x16x32_bf16 v[176:179], v[88:91], v[96:99], v[176:179]
s_waitcnt lgkmcnt(10)
ds_read_b128 v[40:43], v18 offset:34816
v_cvt_pk_bf16_f32 v24, v24, v28
v_mfma_f32_16x16x32_bf16 v[192:195], v[64:67], v[96:99], v[192:195]
ds_read_b64_tr_b16 v[88:89], v15 offset:16384
v_cvt_pk_bf16_f32 v25, v25, v29
v_mfma_f32_16x16x32_bf16 v[192:195], v[68:71], v[100:103], v[192:195]
ds_read_b64_tr_b16 v[90:91], v15 offset:17408
v_cvt_pk_bf16_f32 v26, v26, v30
v_mfma_f32_16x16x32_bf16 v[196:199], v[68:71], v[108:111], v[196:199]
ds_read_b64_tr_b16 v[92:93], v15 offset:24576
v_cvt_pk_bf16_f32 v27, v27, v31
v_mfma_f32_16x16x32_bf16 v[196:199], v[64:67], v[104:107], v[196:199]
s_add_u32 s72, s69, 15360
buffer_load_dwordx4 v5, s[4:7], s72 offen offset:1024 lds
v_mfma_f32_16x16x32_bf16 v[200:203], v[64:67], v[112:115], v[200:203]
s_add_u32 s80, s78, 43008
ds_read_b64_tr_b16 v[94:95], v15 offset:25600
v_mfma_f32_16x16x32_bf16 v[200:203], v[68:71], v[116:119], v[200:203]
ds_read_b128 v[44:47], v19 offset:34816
v_mfma_f32_16x16x32_bf16 v[204:207], v[68:71], v[124:127], v[204:207]
buffer_store_dwordx4 v[24:27], v1, s[44:47], s80 offen sc1
v_mfma_f32_16x16x32_bf16 v[204:207], v[64:67], v[120:123], v[204:207]
s_waitcnt lgkmcnt(11)
ds_read_b128 v[48:51], v18 offset:36864
v_mfma_f32_16x16x32_bf16 v[220:223], v[72:75], v[120:123], v[220:223]
s_add_u32 s72, s69, 129024
buffer_load_dwordx4 v4, s[4:7], s72 offen offset:2048 lds
v_mfma_f32_16x16x32_bf16 v[220:223], v[76:79], v[124:127], v[220:223]
v_accvgpr_read_b32 v20, a88
v_accvgpr_read_b32 v28, a89
v_mfma_f32_16x16x32_bf16 v[216:219], v[76:79], v[116:119], v[216:219]
s_waitcnt vmcnt(20) lgkmcnt(2)
ds_read_b128 v[52:55], v19 offset:36864
v_accvgpr_read_b32 v21, a90
v_mfma_f32_16x16x32_bf16 v[216:219], v[72:75], v[112:115], v[216:219]
s_barrier
ds_read_b128 v[56:59], v18 offset:38912
v_accvgpr_read_b32 v29, a91
v_mfma_f32_16x16x32_bf16 v[212:215], v[72:75], v[104:107], v[212:215]
ds_read_b64_tr_b16 v[64:65], v8 offset:32768
ds_read_b64_tr_b16 v[66:67], v8 offset:33792
v_mfma_f32_16x16x32_bf16 v[212:215], v[76:79], v[108:111], v[212:215]
ds_read_b64_tr_b16 v[68:69], v8 offset:40960
v_accvgpr_read_b32 v22, a120
v_mfma_f32_16x16x32_bf16 v[208:211], v[76:79], v[100:103], v[208:211]
s_add_u32 s72, s69, 144384
buffer_load_dwordx4 v5, s[4:7], s72 offen offset:3072 lds
v_mfma_f32_16x16x32_bf16 v[208:211], v[72:75], v[96:99], v[208:211]
ds_read_b64_tr_b16 v[70:71], v8 offset:41984
v_accvgpr_read_b32 v30, a121
v_mfma_f32_16x16x32_bf16 v[224:227], v[80:83], v[96:99], v[224:227]
ds_read_b64_tr_b16 v[72:73], v9 offset:32768
v_accvgpr_read_b32 v23, a122
v_mfma_f32_16x16x32_bf16 v[224:227], v[84:87], v[100:103], v[224:227]
ds_read_b64_tr_b16 v[74:75], v9 offset:33792
v_accvgpr_read_b32 v31, a123
v_mfma_f32_16x16x32_bf16 v[228:231], v[84:87], v[108:111], v[228:231]
s_add_u32 m0, s63, 69632
v_mul_f32 v20, s79, v20
v_mul_f32 v28, s79, v28
v_mfma_f32_16x16x32_bf16 v[228:231], v[80:83], v[104:107], v[228:231]
s_add_u32 s72, s70, 0
buffer_load_dwordx4 v4, s[4:7], s72 offen lds
v_mfma_f32_16x16x32_bf16 v[232:235], v[80:83], v[112:115], v[232:235]
ds_read_b64_tr_b16 v[76:77], v9 offset:40960
v_mul_f32 v21, s79, v21
v_mfma_f32_16x16x32_bf16 v[232:235], v[84:87], v[116:119], v[232:235]
ds_read_b128 v[60:63], v19 offset:38912
v_mul_f32 v29, s79, v29
v_mfma_f32_16x16x32_bf16 v[236:239], v[84:87], v[124:127], v[236:239]
ds_read_b64_tr_b16 v[78:79], v9 offset:41984
v_mul_f32 v22, s79, v22
v_mfma_f32_16x16x32_bf16 v[236:239], v[80:83], v[120:123], v[236:239]
v_mul_f32 v30, s79, v30
v_mul_f32 v23, s79, v23
v_mfma_f32_16x16x32_bf16 v[252:255], v[88:91], v[120:123], v[252:255]
s_add_u32 s72, s70, 15360
buffer_load_dwordx4 v5, s[4:7], s72 offen offset:1024 lds
v_mfma_f32_16x16x32_bf16 v[252:255], v[92:95], v[124:127], v[252:255]
ds_read_b64_tr_b16 v[80:81], v10 offset:32768
v_mul_f32 v31, s79, v31
v_mfma_f32_16x16x32_bf16 v[248:251], v[92:95], v[116:119], v[248:251]
ds_read_b64_tr_b16 v[82:83], v10 offset:33792
v_cvt_pk_bf16_f32 v20, v20, v28
v_mfma_f32_16x16x32_bf16 v[248:251], v[88:91], v[112:115], v[248:251]
v_cvt_pk_bf16_f32 v21, v21, v29
v_cvt_pk_bf16_f32 v22, v22, v30
v_mfma_f32_16x16x32_bf16 v[244:247], v[88:91], v[104:107], v[244:247]
ds_read_b64_tr_b16 v[84:85], v10 offset:40960
v_cvt_pk_bf16_f32 v23, v23, v31
v_mfma_f32_16x16x32_bf16 v[244:247], v[92:95], v[108:111], v[244:247]
s_add_u32 s80, s77, 41984
ds_read_b64_tr_b16 v[86:87], v10 offset:41984
v_mfma_f32_16x16x32_bf16 v[240:243], v[92:95], v[100:103], v[240:243]
s_add_u32 s72, s70, 129024
buffer_load_dwordx4 v4, s[4:7], s72 offen offset:2048 lds
v_mfma_f32_16x16x32_bf16 v[240:243], v[88:91], v[96:99], v[240:243]
s_waitcnt lgkmcnt(5)
buffer_store_dwordx4 v[20:23], v1, s[44:47], s80 offen sc1
LcB1:
v_mfma_f32_16x16x32_bf16 v[128:131], v[64:67], v[32:35], v[128:131]
ds_read_b64_tr_b16 v[88:89], v11 offset:32768
v_accvgpr_read_b32 v24, a224
v_mfma_f32_16x16x32_bf16 v[128:131], v[68:71], v[36:39], v[128:131]
ds_read_b64_tr_b16 v[90:91], v11 offset:33792
v_accvgpr_read_b32 v28, a225
v_mfma_f32_16x16x32_bf16 v[132:135], v[68:71], v[44:47], v[132:135]
v_accvgpr_read_b32 v25, a226
v_accvgpr_read_b32 v29, a227
v_mfma_f32_16x16x32_bf16 v[132:135], v[64:67], v[40:43], v[132:135]
s_add_u32 s72, s70, 144384
buffer_load_dwordx4 v5, s[4:7], s72 offen offset:3072 lds
v_mfma_f32_16x16x32_bf16 v[136:139], v[64:67], v[48:51], v[136:139]
ds_read_b64_tr_b16 v[92:93], v11 offset:40960
v_accvgpr_read_b32 v26, a228
v_mfma_f32_16x16x32_bf16 v[136:139], v[68:71], v[52:55], v[136:139]
s_lshl_b32 s71, s73, 12
v_accvgpr_read_b32 v30, a229
v_accvgpr_read_b32 v27, a230
v_mfma_f32_16x16x32_bf16 v[140:143], v[68:71], v[60:63], v[140:143]
s_add_u32 s71, s71, s66
ds_read_b64_tr_b16 v[94:95], v11 offset:41984
v_accvgpr_read_b32 v31, a231
v_mfma_f32_16x16x32_bf16 v[140:143], v[64:67], v[56:59], v[140:143]
s_waitcnt lgkmcnt(8)
v_cvt_pk_bf16_f32 v24, v24, v28
v_cvt_pk_bf16_f32 v25, v25, v29
v_mfma_f32_16x16x32_bf16 v[156:159], v[72:75], v[56:59], v[156:159]
s_add_u32 m0, s64, 16384
ds_read_b64_tr_b16 v[64:65], v12 offset:32768
v_cvt_pk_bf16_f32 v26, v26, v30
v_mfma_f32_16x16x32_bf16 v[156:159], v[76:79], v[60:63], v[156:159]
s_add_u32 s72, s71, 0
buffer_load_dwordx4 v6, s[12:15], s72 offen lds
v_mfma_f32_16x16x32_bf16 v[152:155], v[76:79], v[52:55], v[152:155]
s_add_u32 s73, s62, 11
ds_read_b64_tr_b16 v[66:67], v12 offset:33792
v_cvt_pk_bf16_f32 v27, v27, v31
v_mfma_f32_16x16x32_bf16 v[152:155], v[72:75], v[48:51], v[152:155]
s_add_u32 s70, s73, s65
v_mfma_f32_16x16x32_bf16 v[148:151], v[72:75], v[40:43], v[148:151]
s_and_b32 s70, s70, 3
ds_read_b64_tr_b16 v[68:69], v12 offset:40960
v_mfma_f32_16x16x32_bf16 v[148:151], v[76:79], v[44:47], v[148:151]
s_and_b32 s73, s73, 12
ds_read_b64_tr_b16 v[70:71], v12 offset:41984
v_mfma_f32_16x16x32_bf16 v[144:147], v[76:79], v[36:39], v[144:147]
s_add_u32 s72, s71, 31744
buffer_load_dwordx4 v6, s[12:15], s72 offen offset:1024 lds
v_mfma_f32_16x16x32_bf16 v[144:147], v[72:75], v[32:35], v[144:147]
s_waitcnt lgkmcnt(8)
v_mfma_f32_16x16x32_bf16 v[160:163], v[80:83], v[32:35], v[160:163]
s_or_b32 s73, s73, s70
ds_read_b64_tr_b16 v[72:73], v13 offset:32768
v_mfma_f32_16x16x32_bf16 v[160:163], v[84:87], v[36:39], v[160:163]
s_lshl_b32 s73, s73, 7
ds_read_b64_tr_b16 v[74:75], v13 offset:33792
v_mfma_f32_16x16x32_bf16 v[164:167], v[84:87], v[44:47], v[164:167]
s_add_u32 s69, s73, s67
v_mfma_f32_16x16x32_bf16 v[164:167], v[80:83], v[40:43], v[164:167]
s_add_u32 s72, s71, 63488
buffer_load_dwordx4 v7, s[12:15], s72 offen offset:2048 lds
v_mfma_f32_16x16x32_bf16 v[168:171], v[80:83], v[48:51], v[168:171]
s_waitcnt vmcnt(18)
ds_read_b64_tr_b16 v[76:77], v13 offset:40960
v_mfma_f32_16x16x32_bf16 v[168:171], v[84:87], v[52:55], v[168:171]
s_add_u32 s70, s73, s68
ds_read_b128 v[96:99], v16 offset:0
v_accvgpr_read_b32 v20, a92
v_mfma_f32_16x16x32_bf16 v[172:175], v[84:87], v[60:63], v[172:175]
s_add_u32 s80, s78, 3072
ds_read_b64_tr_b16 v[78:79], v13 offset:41984
v_accvgpr_read_b32 v28, a93
v_mfma_f32_16x16x32_bf16 v[172:175], v[80:83], v[56:59], v[172:175]
s_waitcnt lgkmcnt(9)
ds_read_b128 v[100:103], v17 offset:0
v_accvgpr_read_b32 v21, a94
v_mfma_f32_16x16x32_bf16 v[188:191], v[88:91], v[56:59], v[188:191]
s_add_u32 s72, s71, 95232
buffer_load_dwordx4 v7, s[12:15], s72 offen offset:3072 lds
v_mfma_f32_16x16x32_bf16 v[188:191], v[92:95], v[60:63], v[188:191]
ds_read_b64_tr_b16 v[80:81], v14 offset:32768
v_accvgpr_read_b32 v29, a95
v_mfma_f32_16x16x32_bf16 v[184:187], v[92:95], v[52:55], v[184:187]
ds_read_b64_tr_b16 v[82:83], v14 offset:33792
v_accvgpr_read_b32 v22, a124
v_mfma_f32_16x16x32_bf16 v[184:187], v[88:91], v[48:51], v[184:187]
buffer_store_dwordx4 v[24:27], v1, s[44:47], s80 offen sc1
v_mfma_f32_16x16x32_bf16 v[180:183], v[88:91], v[40:43], v[180:183]
ds_read_b64_tr_b16 v[84:85], v14 offset:40960
v_accvgpr_read_b32 v30, a125
v_mfma_f32_16x16x32_bf16 v[180:183], v[92:95], v[44:47], v[180:183]
s_add_u32 m0, s63, 98304
ds_read_b64_tr_b16 v[86:87], v14 offset:41984
v_accvgpr_read_b32 v23, a126
v_mfma_f32_16x16x32_bf16 v[176:179], v[92:95], v[36:39], v[176:179]
s_add_u32 s72, s69, 0
buffer_load_dwordx4 v4, s[4:7], s72 offen lds
v_mfma_f32_16x16x32_bf16 v[176:179], v[88:91], v[32:35], v[176:179]
s_waitcnt lgkmcnt(10)
ds_read_b128 v[104:107], v16 offset:2048
v_accvgpr_read_b32 v31, a127
v_mfma_f32_16x16x32_bf16 v[192:195], v[64:67], v[32:35], v[192:195]
ds_read_b64_tr_b16 v[88:89], v15 offset:32768
v_mul_f32 v20, s79, v20
v_mfma_f32_16x16x32_bf16 v[192:195], v[68:71], v[36:39], v[192:195]
ds_read_b64_tr_b16 v[90:91], v15 offset:33792
v_mul_f32 v28, s79, v28
v_mfma_f32_16x16x32_bf16 v[196:199], v[68:71], v[44:47], v[196:199]
ds_read_b64_tr_b16 v[92:93], v15 offset:40960
v_mul_f32 v21, s79, v21
v_mfma_f32_16x16x32_bf16 v[196:199], v[64:67], v[40:43], v[196:199]
s_add_u32 s72, s69, 15360
buffer_load_dwordx4 v5, s[4:7], s72 offen offset:1024 lds
v_mfma_f32_16x16x32_bf16 v[200:203], v[64:67], v[48:51], v[200:203]
ds_read_b64_tr_b16 v[94:95], v15 offset:41984
v_mul_f32 v29, s79, v29
v_mfma_f32_16x16x32_bf16 v[200:203], v[68:71], v[52:55], v[200:203]
ds_read_b128 v[108:111], v17 offset:2048
v_mul_f32 v22, s79, v22
v_mfma_f32_16x16x32_bf16 v[204:207], v[68:71], v[60:63], v[204:207]
v_mul_f32 v30, s79, v30
v_mul_f32 v23, s79, v23
v_mfma_f32_16x16x32_bf16 v[204:207], v[64:67], v[56:59], v[204:207]
s_waitcnt lgkmcnt(11)
ds_read_b128 v[112:115], v16 offset:4096
v_mul_f32 v31, s79, v31
v_mfma_f32_16x16x32_bf16 v[220:223], v[72:75], v[56:59], v[220:223]
s_add_u32 s72, s69, 129024
buffer_load_dwordx4 v4, s[4:7], s72 offen offset:2048 lds
v_mfma_f32_16x16x32_bf16 v[220:223], v[76:79], v[60:63], v[220:223]
v_cvt_pk_bf16_f32 v20, v20, v28
v_cvt_pk_bf16_f32 v21, v21, v29
v_mfma_f32_16x16x32_bf16 v[216:219], v[76:79], v[52:55], v[216:219]
s_waitcnt vmcnt(19) lgkmcnt(2)
ds_read_b128 v[116:119], v17 offset:4096
v_cvt_pk_bf16_f32 v22, v22, v30
v_mfma_f32_16x16x32_bf16 v[216:219], v[72:75], v[48:51], v[216:219]
s_barrier
ds_read_b128 v[120:123], v16 offset:6144
v_cvt_pk_bf16_f32 v23, v23, v31
v_mfma_f32_16x16x32_bf16 v[212:215], v[72:75], v[40:43], v[212:215]
s_add_u32 s80, s77, 46080
ds_read_b64_tr_b16 v[64:65], v8 offset:0
ds_read_b64_tr_b16 v[66:67], v8 offset:1024
v_mfma_f32_16x16x32_bf16 v[212:215], v[76:79], v[44:47], v[212:215]
ds_read_b64_tr_b16 v[68:69], v8 offset:8192
v_accvgpr_read_b32 v24, a232
v_mfma_f32_16x16x32_bf16 v[208:211], v[76:79], v[36:39], v[208:211]
s_add_u32 s72, s69, 144384
buffer_load_dwordx4 v5, s[4:7], s72 offen offset:3072 lds
v_mfma_f32_16x16x32_bf16 v[208:211], v[72:75], v[32:35], v[208:211]
ds_read_b64_tr_b16 v[70:71], v8 offset:9216
v_accvgpr_read_b32 v28, a233
v_mfma_f32_16x16x32_bf16 v[224:227], v[80:83], v[32:35], v[224:227]
ds_read_b64_tr_b16 v[72:73], v9 offset:0
v_accvgpr_read_b32 v25, a234
v_mfma_f32_16x16x32_bf16 v[224:227], v[84:87], v[36:39], v[224:227]
ds_read_b64_tr_b16 v[74:75], v9 offset:1024
v_accvgpr_read_b32 v29, a235
v_mfma_f32_16x16x32_bf16 v[228:231], v[84:87], v[44:47], v[228:231]
s_add_u32 m0, s63, 102400
buffer_store_dwordx4 v[20:23], v1, s[44:47], s80 offen sc1
v_mfma_f32_16x16x32_bf16 v[228:231], v[80:83], v[40:43], v[228:231]
s_add_u32 s72, s70, 0
buffer_load_dwordx4 v4, s[4:7], s72 offen lds
v_mfma_f32_16x16x32_bf16 v[232:235], v[80:83], v[48:51], v[232:235]
ds_read_b64_tr_b16 v[76:77], v9 offset:8192
v_accvgpr_read_b32 v26, a236
v_mfma_f32_16x16x32_bf16 v[232:235], v[84:87], v[52:55], v[232:235]
ds_read_b128 v[124:127], v17 offset:6144
v_accvgpr_read_b32 v30, a237
v_mfma_f32_16x16x32_bf16 v[236:239], v[84:87], v[60:63], v[236:239]
ds_read_b64_tr_b16 v[78:79], v9 offset:9216
v_accvgpr_read_b32 v27, a238
v_mfma_f32_16x16x32_bf16 v[236:239], v[80:83], v[56:59], v[236:239]
v_accvgpr_read_b32 v31, a239
v_cvt_pk_bf16_f32 v24, v24, v28
v_mfma_f32_16x16x32_bf16 v[252:255], v[88:91], v[56:59], v[252:255]
s_add_u32 s72, s70, 15360
buffer_load_dwordx4 v5, s[4:7], s72 offen offset:1024 lds
v_mfma_f32_16x16x32_bf16 v[252:255], v[92:95], v[60:63], v[252:255]
ds_read_b64_tr_b16 v[80:81], v10 offset:0
v_cvt_pk_bf16_f32 v25, v25, v29
v_mfma_f32_16x16x32_bf16 v[248:251], v[92:95], v[52:55], v[248:251]
ds_read_b64_tr_b16 v[82:83], v10 offset:1024
v_cvt_pk_bf16_f32 v26, v26, v30
v_mfma_f32_16x16x32_bf16 v[248:251], v[88:91], v[48:51], v[248:251]
v_cvt_pk_bf16_f32 v27, v27, v31
v_mfma_f32_16x16x32_bf16 v[244:247], v[88:91], v[40:43], v[244:247]
s_add_u32 s80, s78, 11264
ds_read_b64_tr_b16 v[84:85], v10 offset:8192
v_mfma_f32_16x16x32_bf16 v[244:247], v[92:95], v[44:47], v[244:247]
ds_read_b64_tr_b16 v[86:87], v10 offset:9216
v_mfma_f32_16x16x32_bf16 v[240:243], v[92:95], v[36:39], v[240:243]
s_add_u32 s72, s70, 129024
buffer_load_dwordx4 v4, s[4:7], s72 offen offset:2048 lds
v_mfma_f32_16x16x32_bf16 v[240:243], v[88:91], v[32:35], v[240:243]
s_waitcnt lgkmcnt(5)
buffer_store_dwordx4 v[24:27], v1, s[44:47], s80 offen sc1
v_mfma_f32_16x16x32_bf16 v[128:131], v[64:67], v[96:99], v[128:131]
ds_read_b64_tr_b16 v[88:89], v11 offset:0
v_mfma_f32_16x16x32_bf16 v[128:131], v[68:71], v[100:103], v[128:131]
ds_read_b64_tr_b16 v[90:91], v11 offset:1024
v_accvgpr_read_b32 v20, a240
v_mfma_f32_16x16x32_bf16 v[132:135], v[68:71], v[108:111], v[132:135]
v_accvgpr_read_b32 v28, a241
v_accvgpr_read_b32 v21, a242
v_mfma_f32_16x16x32_bf16 v[132:135], v[64:67], v[104:107], v[132:135]
s_add_u32 s72, s70, 144384
buffer_load_dwordx4 v5, s[4:7], s72 offen offset:3072 lds
v_mfma_f32_16x16x32_bf16 v[136:139], v[64:67], v[112:115], v[136:139]
ds_read_b64_tr_b16 v[92:93], v11 offset:8192
v_accvgpr_read_b32 v29, a243
v_mfma_f32_16x16x32_bf16 v[136:139], v[68:71], v[116:119], v[136:139]
s_lshl_b32 s71, s73, 12
v_accvgpr_read_b32 v22, a244
v_accvgpr_read_b32 v30, a245
v_mfma_f32_16x16x32_bf16 v[140:143], v[68:71], v[124:127], v[140:143]
s_add_u32 s71, s71, s66
ds_read_b64_tr_b16 v[94:95], v11 offset:9216
v_accvgpr_read_b32 v23, a246
v_mfma_f32_16x16x32_bf16 v[140:143], v[64:67], v[120:123], v[140:143]
s_waitcnt lgkmcnt(8)
v_accvgpr_read_b32 v31, a247
v_cvt_pk_bf16_f32 v20, v20, v28
v_mfma_f32_16x16x32_bf16 v[156:159], v[72:75], v[120:123], v[156:159]
s_add_u32 m0, s64, 32768
ds_read_b64_tr_b16 v[64:65], v12 offset:0
v_cvt_pk_bf16_f32 v21, v21, v29
v_mfma_f32_16x16x32_bf16 v[156:159], v[76:79], v[124:127], v[156:159]
s_add_u32 s72, s71, 0
buffer_load_dwordx4 v6, s[12:15], s72 offen lds
v_mfma_f32_16x16x32_bf16 v[152:155], v[76:79], v[116:119], v[152:155]
s_add_u32 s73, s62, 12
ds_read_b64_tr_b16 v[66:67], v12 offset:1024
v_cvt_pk_bf16_f32 v22, v22, v30
v_mfma_f32_16x16x32_bf16 v[152:155], v[72:75], v[112:115], v[152:155]
s_add_u32 s70, s73, s65
v_cvt_pk_bf16_f32 v23, v23, v31
v_mfma_f32_16x16x32_bf16 v[148:151], v[72:75], v[104:107], v[148:151]
s_and_b32 s70, s70, 3
ds_read_b64_tr_b16 v[68:69], v12 offset:8192
v_mfma_f32_16x16x32_bf16 v[148:151], v[76:79], v[108:111], v[148:151]
s_and_b32 s73, s73, 12
ds_read_b64_tr_b16 v[70:71], v12 offset:9216
v_mfma_f32_16x16x32_bf16 v[144:147], v[76:79], v[100:103], v[144:147]
s_add_u32 s72, s71, 31744
buffer_load_dwordx4 v6, s[12:15], s72 offen offset:1024 lds
v_mfma_f32_16x16x32_bf16 v[144:147], v[72:75], v[96:99], v[144:147]
s_waitcnt lgkmcnt(8)
v_mfma_f32_16x16x32_bf16 v[160:163], v[80:83], v[96:99], v[160:163]
s_or_b32 s73, s73, s70
ds_read_b64_tr_b16 v[72:73], v13 offset:0
v_mfma_f32_16x16x32_bf16 v[160:163], v[84:87], v[100:103], v[160:163]
s_lshl_b32 s73, s73, 7
ds_read_b64_tr_b16 v[74:75], v13 offset:1024
v_mfma_f32_16x16x32_bf16 v[164:167], v[84:87], v[108:111], v[164:167]
s_add_u32 s69, s73, s67
v_mfma_f32_16x16x32_bf16 v[164:167], v[80:83], v[104:107], v[164:167]
s_add_u32 s72, s71, 63488
buffer_load_dwordx4 v7, s[12:15], s72 offen offset:2048 lds
v_mfma_f32_16x16x32_bf16 v[168:171], v[80:83], v[112:115], v[168:171]
s_waitcnt vmcnt(18)
ds_read_b64_tr_b16 v[76:77], v13 offset:8192
v_mfma_f32_16x16x32_bf16 v[168:171], v[84:87], v[116:119], v[168:171]
s_add_u32 s70, s73, s68
ds_read_b128 v[32:35], v18 offset:0
v_mfma_f32_16x16x32_bf16 v[172:175], v[84:87], v[124:127], v[172:175]
s_add_u32 s80, s78, 35840
ds_read_b64_tr_b16 v[78:79], v13 offset:9216
v_mfma_f32_16x16x32_bf16 v[172:175], v[80:83], v[120:123], v[172:175]
s_waitcnt lgkmcnt(9)
ds_read_b128 v[36:39], v19 offset:0
v_accvgpr_read_b32 v24, a248
v_mfma_f32_16x16x32_bf16 v[188:191], v[88:91], v[120:123], v[188:191]
s_add_u32 s72, s71, 95232
buffer_load_dwordx4 v7, s[12:15], s72 offen offset:3072 lds
v_mfma_f32_16x16x32_bf16 v[188:191], v[92:95], v[124:127], v[188:191]
ds_read_b64_tr_b16 v[80:81], v14 offset:0
v_accvgpr_read_b32 v28, a249
v_mfma_f32_16x16x32_bf16 v[184:187], v[92:95], v[116:119], v[184:187]
ds_read_b64_tr_b16 v[82:83], v14 offset:1024
v_accvgpr_read_b32 v25, a250
v_mfma_f32_16x16x32_bf16 v[184:187], v[88:91], v[112:115], v[184:187]
buffer_store_dwordx4 v[20:23], v1, s[44:47], s80 offen sc1
v_mfma_f32_16x16x32_bf16 v[180:183], v[88:91], v[104:107], v[180:183]
ds_read_b64_tr_b16 v[84:85], v14 offset:8192
v_accvgpr_read_b32 v29, a251
v_mfma_f32_16x16x32_bf16 v[180:183], v[92:95], v[108:111], v[180:183]
s_add_u32 m0, s63, 131072
ds_read_b64_tr_b16 v[86:87], v14 offset:9216
v_accvgpr_read_b32 v26, a252
v_mfma_f32_16x16x32_bf16 v[176:179], v[92:95], v[100:103], v[176:179]
s_add_u32 s72, s69, 0
buffer_load_dwordx4 v4, s[4:7], s72 offen lds
v_mfma_f32_16x16x32_bf16 v[176:179], v[88:91], v[96:99], v[176:179]
s_waitcnt lgkmcnt(10)
ds_read_b128 v[40:43], v18 offset:2048
v_accvgpr_read_b32 v30, a253
v_mfma_f32_16x16x32_bf16 v[192:195], v[64:67], v[96:99], v[192:195]
ds_read_b64_tr_b16 v[88:89], v15 offset:0
v_accvgpr_read_b32 v27, a254
v_mfma_f32_16x16x32_bf16 v[192:195], v[68:71], v[100:103], v[192:195]
ds_read_b64_tr_b16 v[90:91], v15 offset:1024
v_accvgpr_read_b32 v31, a255
v_mfma_f32_16x16x32_bf16 v[196:199], v[68:71], v[108:111], v[196:199]
ds_read_b64_tr_b16 v[92:93], v15 offset:8192
v_cvt_pk_bf16_f32 v24, v24, v28
v_mfma_f32_16x16x32_bf16 v[196:199], v[64:67], v[104:107], v[196:199]
s_add_u32 s72, s69, 15360
buffer_load_dwordx4 v5, s[4:7], s72 offen offset:1024 lds
v_mfma_f32_16x16x32_bf16 v[200:203], v[64:67], v[112:115], v[200:203]
ds_read_b64_tr_b16 v[94:95], v15 offset:9216
v_cvt_pk_bf16_f32 v25, v25, v29
v_mfma_f32_16x16x32_bf16 v[200:203], v[68:71], v[116:119], v[200:203]
ds_read_b128 v[44:47], v19 offset:2048
v_cvt_pk_bf16_f32 v26, v26, v30
v_mfma_f32_16x16x32_bf16 v[204:207], v[68:71], v[124:127], v[204:207]
v_cvt_pk_bf16_f32 v27, v27, v31
v_mfma_f32_16x16x32_bf16 v[204:207], v[64:67], v[120:123], v[204:207]
s_waitcnt lgkmcnt(11)
ds_read_b128 v[48:51], v18 offset:4096
v_mfma_f32_16x16x32_bf16 v[220:223], v[72:75], v[120:123], v[220:223]
s_add_u32 s72, s69, 129024
buffer_load_dwordx4 v4, s[4:7], s72 offen offset:2048 lds
v_mfma_f32_16x16x32_bf16 v[220:223], v[76:79], v[124:127], v[220:223]
s_add_u32 s80, s78, 44032
ds_read_b128 v[52:55], v19 offset:4096
v_mfma_f32_16x16x32_bf16 v[216:219], v[76:79], v[116:119], v[216:219]
s_waitcnt vmcnt(19) lgkmcnt(3)
buffer_store_dwordx4 v[24:27], v1, s[44:47], s80 offen sc1
v_mfma_f32_16x16x32_bf16 v[216:219], v[72:75], v[112:115], v[216:219]
s_barrier
ds_read_b128 v[56:59], v18 offset:6144
v_mfma_f32_16x16x32_bf16 v[212:215], v[72:75], v[104:107], v[212:215]
ds_read_b64_tr_b16 v[64:65], v8 offset:16384
ds_read_b64_tr_b16 v[66:67], v8 offset:17408
v_mfma_f32_16x16x32_bf16 v[212:215], v[76:79], v[108:111], v[212:215]
ds_read_b64_tr_b16 v[68:69], v8 offset:24576
ds_read_b64_tr_b16 v[70:71], v8 offset:25600
v_mfma_f32_16x16x32_bf16 v[208:211], v[76:79], v[100:103], v[208:211]
s_add_u32 s72, s69, 144384
buffer_load_dwordx4 v5, s[4:7], s72 offen offset:3072 lds
v_mfma_f32_16x16x32_bf16 v[208:211], v[72:75], v[96:99], v[208:211]
v_and_b32 v2, 31, v0
v_lshlrev_b32 v2, 2, v2
v_mfma_f32_16x16x32_bf16 v[224:227], v[80:83], v[96:99], v[224:227]
buffer_load_dword v3, v2, s[48:51], 0 offen sc1
v_mfma_f32_16x16x32_bf16 v[224:227], v[84:87], v[100:103], v[224:227]
ds_read_b64_tr_b16 v[72:73], v9 offset:16384
v_mfma_f32_16x16x32_bf16 v[228:231], v[84:87], v[108:111], v[228:231]
s_add_u32 m0, s63, 135168
ds_read_b64_tr_b16 v[74:75], v9 offset:17408
v_mfma_f32_16x16x32_bf16 v[228:231], v[80:83], v[104:107], v[228:231]
s_add_u32 s72, s70, 0
buffer_load_dwordx4 v4, s[4:7], s72 offen lds
v_mfma_f32_16x16x32_bf16 v[232:235], v[80:83], v[112:115], v[232:235]
ds_read_b128 v[60:63], v19 offset:6144
v_mfma_f32_16x16x32_bf16 v[232:235], v[84:87], v[116:119], v[232:235]
ds_read_b64_tr_b16 v[76:77], v9 offset:24576
v_mfma_f32_16x16x32_bf16 v[236:239], v[84:87], v[124:127], v[236:239]
ds_read_b64_tr_b16 v[78:79], v9 offset:25600
v_mfma_f32_16x16x32_bf16 v[236:239], v[80:83], v[120:123], v[236:239]
v_mfma_f32_16x16x32_bf16 v[252:255], v[88:91], v[120:123], v[252:255]
s_add_u32 s72, s70, 15360
buffer_load_dwordx4 v5, s[4:7], s72 offen offset:1024 lds
v_mfma_f32_16x16x32_bf16 v[252:255], v[92:95], v[124:127], v[252:255]
ds_read_b64_tr_b16 v[80:81], v10 offset:16384
v_mfma_f32_16x16x32_bf16 v[248:251], v[92:95], v[116:119], v[248:251]
ds_read_b64_tr_b16 v[82:83], v10 offset:17408
v_mfma_f32_16x16x32_bf16 v[248:251], v[88:91], v[112:115], v[248:251]
v_mfma_f32_16x16x32_bf16 v[244:247], v[88:91], v[104:107], v[244:247]
ds_read_b64_tr_b16 v[84:85], v10 offset:24576
v_mfma_f32_16x16x32_bf16 v[244:247], v[92:95], v[108:111], v[244:247]
ds_read_b64_tr_b16 v[86:87], v10 offset:25600
v_mfma_f32_16x16x32_bf16 v[240:243], v[92:95], v[100:103], v[240:243]
s_add_u32 s72, s70, 129024
buffer_load_dwordx4 v4, s[4:7], s72 offen offset:2048 lds
v_mfma_f32_16x16x32_bf16 v[240:243], v[88:91], v[96:99], v[240:243]
s_waitcnt lgkmcnt(6)
v_mfma_f32_16x16x32_bf16 v[128:131], v[64:67], v[32:35], v[128:131]
ds_read_b64_tr_b16 v[88:89], v11 offset:16384
v_mfma_f32_16x16x32_bf16 v[128:131], v[68:71], v[36:39], v[128:131]
ds_read_b64_tr_b16 v[90:91], v11 offset:17408
v_mfma_f32_16x16x32_bf16 v[132:135], v[68:71], v[44:47], v[132:135]
v_mfma_f32_16x16x32_bf16 v[132:135], v[64:67], v[40:43], v[132:135]
s_add_u32 s72, s70, 144384
buffer_load_dwordx4 v5, s[4:7], s72 offen offset:3072 lds
v_mfma_f32_16x16x32_bf16 v[136:139], v[64:67], v[48:51], v[136:139]
ds_read_b64_tr_b16 v[92:93], v11 offset:24576
v_mfma_f32_16x16x32_bf16 v[136:139], v[68:71], v[52:55], v[136:139]
s_lshl_b32 s71, s73, 12
v_mfma_f32_16x16x32_bf16 v[140:143], v[68:71], v[60:63], v[140:143]
s_add_u32 s71, s71, s66
ds_read_b64_tr_b16 v[94:95], v11 offset:25600
v_mfma_f32_16x16x32_bf16 v[140:143], v[64:67], v[56:59], v[140:143]
s_waitcnt lgkmcnt(8)
v_mfma_f32_16x16x32_bf16 v[156:159], v[72:75], v[56:59], v[156:159]
s_add_u32 m0, s64, 0
ds_read_b64_tr_b16 v[64:65], v12 offset:16384
v_mfma_f32_16x16x32_bf16 v[156:159], v[76:79], v[60:63], v[156:159]
s_add_u32 s72, s71, 0
buffer_load_dwordx4 v6, s[12:15], s72 offen lds
v_mfma_f32_16x16x32_bf16 v[152:155], v[76:79], v[52:55], v[152:155]
s_add_u32 s73, s62, 13
ds_read_b64_tr_b16 v[66:67], v12 offset:17408
v_mfma_f32_16x16x32_bf16 v[152:155], v[72:75], v[48:51], v[152:155]
s_add_u32 s70, s73, s65
v_mfma_f32_16x16x32_bf16 v[148:151], v[72:75], v[40:43], v[148:151]
s_and_b32 s70, s70, 3
ds_read_b64_tr_b16 v[68:69], v12 offset:24576
v_mfma_f32_16x16x32_bf16 v[148:151], v[76:79], v[44:47], v[148:151]
s_and_b32 s73, s73, 12
ds_read_b64_tr_b16 v[70:71], v12 offset:25600
v_mfma_f32_16x16x32_bf16 v[144:147], v[76:79], v[36:39], v[144:147]
s_add_u32 s72, s71, 31744
buffer_load_dwordx4 v6, s[12:15], s72 offen offset:1024 lds
v_mfma_f32_16x16x32_bf16 v[144:147], v[72:75], v[32:35], v[144:147]
s_waitcnt lgkmcnt(8)
v_mfma_f32_16x16x32_bf16 v[160:163], v[80:83], v[32:35], v[160:163]
s_or_b32 s73, s73, s70
ds_read_b64_tr_b16 v[72:73], v13 offset:16384
v_mfma_f32_16x16x32_bf16 v[160:163], v[84:87], v[36:39], v[160:163]
s_lshl_b32 s73, s73, 7
ds_read_b64_tr_b16 v[74:75], v13 offset:17408
v_mfma_f32_16x16x32_bf16 v[164:167], v[84:87], v[44:47], v[164:167]
s_add_u32 s69, s73, s67
v_mfma_f32_16x16x32_bf16 v[164:167], v[80:83], v[40:43], v[164:167]
s_add_u32 s72, s71, 63488
buffer_load_dwordx4 v7, s[12:15], s72 offen offset:2048 lds
v_mfma_f32_16x16x32_bf16 v[168:171], v[80:83], v[48:51], v[168:171]
s_waitcnt vmcnt(18)
ds_read_b64_tr_b16 v[76:77], v13 offset:24576
v_mfma_f32_16x16x32_bf16 v[168:171], v[84:87], v[52:55], v[168:171]
s_add_u32 s70, s73, s68
ds_read_b128 v[96:99], v18 offset:32768
v_mfma_f32_16x16x32_bf16 v[172:175], v[84:87], v[60:63], v[172:175]
ds_read_b64_tr_b16 v[78:79], v13 offset:25600
v_mfma_f32_16x16x32_bf16 v[172:175], v[80:83], v[56:59], v[172:175]
s_waitcnt lgkmcnt(9)
ds_read_b128 v[100:103], v19 offset:32768
v_mfma_f32_16x16x32_bf16 v[188:191], v[88:91], v[56:59], v[188:191]
s_add_u32 s72, s71, 95232
buffer_load_dwordx4 v7, s[12:15], s72 offen offset:3072 lds
v_mfma_f32_16x16x32_bf16 v[188:191], v[92:95], v[60:63], v[188:191]
ds_read_b64_tr_b16 v[80:81], v14 offset:16384
v_mfma_f32_16x16x32_bf16 v[184:187], v[92:95], v[52:55], v[184:187]
ds_read_b64_tr_b16 v[82:83], v14 offset:17408
v_mfma_f32_16x16x32_bf16 v[184:187], v[88:91], v[48:51], v[184:187]
v_mfma_f32_16x16x32_bf16 v[180:183], v[88:91], v[40:43], v[180:183]
ds_read_b64_tr_b16 v[84:85], v14 offset:24576
v_mfma_f32_16x16x32_bf16 v[180:183], v[92:95], v[44:47], v[180:183]
s_add_u32 m0, s63, 65536
ds_read_b64_tr_b16 v[86:87], v14 offset:25600
v_mfma_f32_16x16x32_bf16 v[176:179], v[92:95], v[36:39], v[176:179]
s_add_u32 s72, s69, 0
buffer_load_dwordx4 v4, s[4:7], s72 offen lds
v_mfma_f32_16x16x32_bf16 v[176:179], v[88:91], v[32:35], v[176:179]
s_waitcnt lgkmcnt(10)
ds_read_b128 v[104:107], v18 offset:34816
v_mfma_f32_16x16x32_bf16 v[192:195], v[64:67], v[32:35], v[192:195]
ds_read_b64_tr_b16 v[88:89], v15 offset:16384
v_mfma_f32_16x16x32_bf16 v[192:195], v[68:71], v[36:39], v[192:195]
ds_read_b64_tr_b16 v[90:91], v15 offset:17408
v_mfma_f32_16x16x32_bf16 v[196:199], v[68:71], v[44:47], v[196:199]
ds_read_b64_tr_b16 v[92:93], v15 offset:24576
v_mfma_f32_16x16x32_bf16 v[196:199], v[64:67], v[40:43], v[196:199]
s_add_u32 s72, s69, 15360
buffer_load_dwordx4 v5, s[4:7], s72 offen offset:1024 lds
v_mfma_f32_16x16x32_bf16 v[200:203], v[64:67], v[48:51], v[200:203]
ds_read_b64_tr_b16 v[94:95], v15 offset:25600
v_mfma_f32_16x16x32_bf16 v[200:203], v[68:71], v[52:55], v[200:203]
ds_read_b128 v[108:111], v19 offset:34816
v_mfma_f32_16x16x32_bf16 v[204:207], v[68:71], v[60:63], v[204:207]
v_mfma_f32_16x16x32_bf16 v[204:207], v[64:67], v[56:59], v[204:207]
s_waitcnt lgkmcnt(11)
ds_read_b128 v[112:115], v18 offset:36864
v_mfma_f32_16x16x32_bf16 v[220:223], v[72:75], v[56:59], v[220:223]
s_add_u32 s72, s69, 129024
buffer_load_dwordx4 v4, s[4:7], s72 offen offset:2048 lds
v_mfma_f32_16x16x32_bf16 v[220:223], v[76:79], v[60:63], v[220:223]
v_mfma_f32_16x16x32_bf16 v[216:219], v[76:79], v[52:55], v[216:219]
s_waitcnt vmcnt(13) lgkmcnt(2)
ds_read_b128 v[116:119], v19 offset:36864
v_mfma_f32_16x16x32_bf16 v[216:219], v[72:75], v[48:51], v[216:219]
s_barrier
ds_read_b128 v[120:123], v18 offset:38912
v_mfma_f32_16x16x32_bf16 v[212:215], v[72:75], v[40:43], v[212:215]
ds_read_b64_tr_b16 v[64:65], v8 offset:32768
ds_read_b64_tr_b16 v[66:67], v8 offset:33792
v_mfma_f32_16x16x32_bf16 v[212:215], v[76:79], v[44:47], v[212:215]
ds_read_b64_tr_b16 v[68:69], v8 offset:40960
v_or_b32 v20, s58, v0
v_mfma_f32_16x16x32_bf16 v[208:211], v[76:79], v[36:39], v[208:211]
s_add_u32 s72, s69, 144384
buffer_load_dwordx4 v5, s[4:7], s72 offen offset:3072 lds
v_mfma_f32_16x16x32_bf16 v[208:211], v[72:75], v[32:35], v[208:211]
ds_read_b64_tr_b16 v[70:71], v8 offset:41984
v_mov_b32 v21, 1
v_mfma_f32_16x16x32_bf16 v[224:227], v[80:83], v[32:35], v[224:227]
ds_read_b64_tr_b16 v[72:73], v9 offset:32768
v_min_u32 v20, 1, v20
v_mfma_f32_16x16x32_bf16 v[224:227], v[84:87], v[36:39], v[224:227]
ds_read_b64_tr_b16 v[74:75], v9 offset:33792
v_lshlrev_b32 v20, 30, v20
v_mfma_f32_16x16x32_bf16 v[228:231], v[84:87], v[44:47], v[228:231]
s_add_u32 m0, s63, 69632
buffer_store_dword v21, v20, s[44:47], s91 offen sc1
v_mfma_f32_16x16x32_bf16 v[228:231], v[80:83], v[40:43], v[228:231]
s_add_u32 s72, s70, 0
buffer_load_dwordx4 v4, s[4:7], s72 offen lds
v_mfma_f32_16x16x32_bf16 v[232:235], v[80:83], v[48:51], v[232:235]
ds_read_b64_tr_b16 v[76:77], v9 offset:40960
v_accvgpr_write_b32 a32, 0
v_mfma_f32_16x16x32_bf16 v[232:235], v[84:87], v[52:55], v[232:235]
ds_read_b128 v[124:127], v19 offset:38912
v_accvgpr_write_b32 a33, 0
v_mfma_f32_16x16x32_bf16 v[236:239], v[84:87], v[60:63], v[236:239]
ds_read_b64_tr_b16 v[78:79], v9 offset:41984
v_accvgpr_write_b32 a34, 0
v_mfma_f32_16x16x32_bf16 v[236:239], v[80:83], v[56:59], v[236:239]
v_accvgpr_write_b32 a35, 0
v_accvgpr_write_b32 a36, 0
v_mfma_f32_16x16x32_bf16 v[252:255], v[88:91], v[56:59], v[252:255]
s_add_u32 s72, s70, 15360
buffer_load_dwordx4 v5, s[4:7], s72 offen offset:1024 lds
v_mfma_f32_16x16x32_bf16 v[252:255], v[92:95], v[60:63], v[252:255]
ds_read_b64_tr_b16 v[80:81], v10 offset:32768
v_accvgpr_write_b32 a37, 0
v_mfma_f32_16x16x32_bf16 v[248:251], v[92:95], v[52:55], v[248:251]
ds_read_b64_tr_b16 v[82:83], v10 offset:33792
v_accvgpr_write_b32 a38, 0
v_mfma_f32_16x16x32_bf16 v[248:251], v[88:91], v[48:51], v[248:251]
v_accvgpr_write_b32 a39, 0
v_accvgpr_write_b32 a40, 0
v_mfma_f32_16x16x32_bf16 v[244:247], v[88:91], v[40:43], v[244:247]
ds_read_b64_tr_b16 v[84:85], v10 offset:40960
v_accvgpr_write_b32 a41, 0
v_mfma_f32_16x16x32_bf16 v[244:247], v[92:95], v[44:47], v[244:247]
ds_read_b64_tr_b16 v[86:87], v10 offset:41984
v_accvgpr_write_b32 a42, 0
v_mfma_f32_16x16x32_bf16 v[240:243], v[92:95], v[36:39], v[240:243]
s_add_u32 s72, s70, 129024
buffer_load_dwordx4 v4, s[4:7], s72 offen offset:2048 lds
v_mfma_f32_16x16x32_bf16 v[240:243], v[88:91], v[32:35], v[240:243]
s_waitcnt lgkmcnt(5)
v_accvgpr_write_b32 a43, 0
v_accvgpr_write_b32 a44, 0
v_mfma_f32_16x16x32_bf16 v[128:131], v[64:67], v[96:99], v[128:131]
ds_read_b64_tr_b16 v[88:89], v11 offset:32768
v_accvgpr_write_b32 a45, 0
v_mfma_f32_16x16x32_bf16 v[128:131], v[68:71], v[100:103], v[128:131]
ds_read_b64_tr_b16 v[90:91], v11 offset:33792
v_accvgpr_write_b32 a46, 0
v_mfma_f32_16x16x32_bf16 v[132:135], v[68:71], v[108:111], v[132:135]
v_accvgpr_write_b32 a47, 0
v_accvgpr_write_b32 a48, 0
v_mfma_f32_16x16x32_bf16 v[132:135], v[64:67], v[104:107], v[132:135]
s_add_u32 s72, s70, 144384
buffer_load_dwordx4 v5, s[4:7], s72 offen offset:3072 lds
v_mfma_f32_16x16x32_bf16 v[136:139], v[64:67], v[112:115], v[136:139]
ds_read_b64_tr_b16 v[92:93], v11 offset:40960
v_accvgpr_write_b32 a49, 0
v_mfma_f32_16x16x32_bf16 v[136:139], v[68:71], v[116:119], v[136:139]
s_lshl_b32 s71, s73, 12
v_accvgpr_write_b32 a50, 0
v_accvgpr_write_b32 a51, 0
v_mfma_f32_16x16x32_bf16 v[140:143], v[68:71], v[124:127], v[140:143]
s_add_u32 s71, s71, s66
ds_read_b64_tr_b16 v[94:95], v11 offset:41984
v_accvgpr_write_b32 a52, 0
v_mfma_f32_16x16x32_bf16 v[140:143], v[64:67], v[120:123], v[140:143]
s_waitcnt lgkmcnt(8)
v_accvgpr_write_b32 a53, 0
v_accvgpr_write_b32 a54, 0
v_mfma_f32_16x16x32_bf16 v[156:159], v[72:75], v[120:123], v[156:159]
s_add_u32 m0, s64, 16384
ds_read_b64_tr_b16 v[64:65], v12 offset:32768
v_accvgpr_write_b32 a55, 0
v_mfma_f32_16x16x32_bf16 v[156:159], v[76:79], v[124:127], v[156:159]
s_add_u32 s72, s71, 0
buffer_load_dwordx4 v6, s[12:15], s72 offen lds
v_mfma_f32_16x16x32_bf16 v[152:155], v[76:79], v[116:119], v[152:155]
s_add_u32 s73, s62, 14
ds_read_b64_tr_b16 v[66:67], v12 offset:33792
v_accvgpr_write_b32 a56, 0
v_mfma_f32_16x16x32_bf16 v[152:155], v[72:75], v[112:115], v[152:155]
s_add_u32 s70, s73, s65
v_accvgpr_write_b32 a57, 0
v_accvgpr_write_b32 a58, 0
v_mfma_f32_16x16x32_bf16 v[148:151], v[72:75], v[104:107], v[148:151]
s_and_b32 s70, s70, 3
ds_read_b64_tr_b16 v[68:69], v12 offset:40960
v_accvgpr_write_b32 a59, 0
v_mfma_f32_16x16x32_bf16 v[148:151], v[76:79], v[108:111], v[148:151]
s_and_b32 s73, s73, 12
ds_read_b64_tr_b16 v[70:71], v12 offset:41984
v_accvgpr_write_b32 a60, 0
v_mfma_f32_16x16x32_bf16 v[144:147], v[76:79], v[100:103], v[144:147]
s_add_u32 s72, s71, 31744
buffer_load_dwordx4 v6, s[12:15], s72 offen offset:1024 lds
v_mfma_f32_16x16x32_bf16 v[144:147], v[72:75], v[96:99], v[144:147]
s_waitcnt lgkmcnt(8)
v_accvgpr_write_b32 a61, 0
v_accvgpr_write_b32 a62, 0
v_mfma_f32_16x16x32_bf16 v[160:163], v[80:83], v[96:99], v[160:163]
s_or_b32 s73, s73, s70
ds_read_b64_tr_b16 v[72:73], v13 offset:32768
v_accvgpr_write_b32 a63, 0
v_mfma_f32_16x16x32_bf16 v[160:163], v[84:87], v[100:103], v[160:163]
s_lshl_b32 s73, s73, 7
ds_read_b64_tr_b16 v[74:75], v13 offset:33792
v_accvgpr_write_b32 a96, 0
v_mfma_f32_16x16x32_bf16 v[164:167], v[84:87], v[108:111], v[164:167]
s_add_u32 s69, s73, s67
v_accvgpr_write_b32 a97, 0
v_accvgpr_write_b32 a98, 0
v_mfma_f32_16x16x32_bf16 v[164:167], v[80:83], v[104:107], v[164:167]
s_add_u32 s72, s71, 63488
buffer_load_dwordx4 v7, s[12:15], s72 offen offset:2048 lds
v_mfma_f32_16x16x32_bf16 v[168:171], v[80:83], v[112:115], v[168:171]
s_waitcnt vmcnt(16)
ds_read_b64_tr_b16 v[76:77], v13 offset:40960
v_accvgpr_write_b32 a99, 0
v_mfma_f32_16x16x32_bf16 v[168:171], v[84:87], v[116:119], v[168:171]
s_add_u32 s70, s73, s68
ds_read_b128 v[32:35], v16 offset:0
v_accvgpr_write_b32 a100, 0
v_mfma_f32_16x16x32_bf16 v[172:175], v[84:87], v[124:127], v[172:175]
ds_read_b64_tr_b16 v[78:79], v13 offset:41984
v_accvgpr_write_b32 a101, 0
v_mfma_f32_16x16x32_bf16 v[172:175], v[80:83], v[120:123], v[172:175]
s_waitcnt lgkmcnt(9)
ds_read_b128 v[36:39], v17 offset:0
v_accvgpr_write_b32 a102, 0
v_mfma_f32_16x16x32_bf16 v[188:191], v[88:91], v[120:123], v[188:191]
s_add_u32 s72, s71, 95232
buffer_load_dwordx4 v7, s[12:15], s72 offen offset:3072 lds
v_mfma_f32_16x16x32_bf16 v[188:191], v[92:95], v[124:127], v[188:191]
ds_read_b64_tr_b16 v[80:81], v14 offset:32768
v_accvgpr_write_b32 a103, 0
v_mfma_f32_16x16x32_bf16 v[184:187], v[92:95], v[116:119], v[184:187]
ds_read_b64_tr_b16 v[82:83], v14 offset:33792
v_accvgpr_write_b32 a104, 0
v_mfma_f32_16x16x32_bf16 v[184:187], v[88:91], v[112:115], v[184:187]
v_accvgpr_write_b32 a105, 0
v_accvgpr_write_b32 a106, 0
v_mfma_f32_16x16x32_bf16 v[180:183], v[88:91], v[104:107], v[180:183]
ds_read_b64_tr_b16 v[84:85], v14 offset:40960
v_accvgpr_write_b32 a107, 0
v_mfma_f32_16x16x32_bf16 v[180:183], v[92:95], v[108:111], v[180:183]
s_add_u32 m0, s63, 98304
ds_read_b64_tr_b16 v[86:87], v14 offset:41984
v_accvgpr_write_b32 a108, 0
v_mfma_f32_16x16x32_bf16 v[176:179], v[92:95], v[100:103], v[176:179]
s_add_u32 s72, s69, 0
buffer_load_dwordx4 v4, s[4:7], s72 offen lds
v_mfma_f32_16x16x32_bf16 v[176:179], v[88:91], v[96:99], v[176:179]
s_waitcnt lgkmcnt(10)
ds_read_b128 v[40:43], v16 offset:2048
v_accvgpr_write_b32 a109, 0
v_mfma_f32_16x16x32_bf16 v[192:195], v[64:67], v[96:99], v[192:195]
ds_read_b64_tr_b16 v[88:89], v15 offset:32768
v_accvgpr_write_b32 a110, 0
v_mfma_f32_16x16x32_bf16 v[192:195], v[68:71], v[100:103], v[192:195]
ds_read_b64_tr_b16 v[90:91], v15 offset:33792
v_accvgpr_write_b32 a111, 0
v_mfma_f32_16x16x32_bf16 v[196:199], v[68:71], v[108:111], v[196:199]
ds_read_b64_tr_b16 v[92:93], v15 offset:40960
v_accvgpr_write_b32 a112, 0
v_mfma_f32_16x16x32_bf16 v[196:199], v[64:67], v[104:107], v[196:199]
s_add_u32 s72, s69, 15360
buffer_load_dwordx4 v5, s[4:7], s72 offen offset:1024 lds
v_mfma_f32_16x16x32_bf16 v[200:203], v[64:67], v[112:115], v[200:203]
ds_read_b64_tr_b16 v[94:95], v15 offset:41984
v_accvgpr_write_b32 a113, 0
v_mfma_f32_16x16x32_bf16 v[200:203], v[68:71], v[116:119], v[200:203]
ds_read_b128 v[44:47], v17 offset:2048
v_accvgpr_write_b32 a114, 0
v_mfma_f32_16x16x32_bf16 v[204:207], v[68:71], v[124:127], v[204:207]
v_accvgpr_write_b32 a115, 0
v_accvgpr_write_b32 a116, 0
v_mfma_f32_16x16x32_bf16 v[204:207], v[64:67], v[120:123], v[204:207]
s_waitcnt lgkmcnt(11)
ds_read_b128 v[48:51], v16 offset:4096
v_accvgpr_write_b32 a117, 0
v_mfma_f32_16x16x32_bf16 v[220:223], v[72:75], v[120:123], v[220:223]
s_add_u32 s72, s69, 129024
buffer_load_dwordx4 v4, s[4:7], s72 offen offset:2048 lds
v_mfma_f32_16x16x32_bf16 v[220:223], v[76:79], v[124:127], v[220:223]
v_accvgpr_write_b32 a118, 0
v_accvgpr_write_b32 a119, 0
v_mfma_f32_16x16x32_bf16 v[216:219], v[76:79], v[116:119], v[216:219]
s_waitcnt vmcnt(16) lgkmcnt(2)
ds_read_b128 v[52:55], v17 offset:4096
v_accvgpr_write_b32 a120, 0
v_mfma_f32_16x16x32_bf16 v[216:219], v[72:75], v[112:115], v[216:219]
s_barrier
ds_read_b128 v[56:59], v16 offset:6144
v_accvgpr_write_b32 a121, 0
v_mfma_f32_16x16x32_bf16 v[212:215], v[72:75], v[104:107], v[212:215]
s_waitcnt vmcnt(24)
v_cmp_gt_u32 vcc, 8, v3
s_cbranch_vccnz Lspin1
Lback2:
v_mfma_f32_16x16x32_bf16 v[212:215], v[76:79], v[108:111], v[212:215]
ds_read_b64_tr_b16 v[64:65], v8 offset:0
ds_read_b64_tr_b16 v[66:67], v8 offset:1024
v_mfma_f32_16x16x32_bf16 v[208:211], v[76:79], v[100:103], v[208:211]
s_add_u32 s72, s69, 144384
buffer_load_dwordx4 v5, s[4:7], s72 offen offset:3072 lds
v_mfma_f32_16x16x32_bf16 v[208:211], v[72:75], v[96:99], v[208:211]
ds_read_b64_tr_b16 v[68:69], v8 offset:8192
ds_read_b64_tr_b16 v[70:71], v8 offset:9216
v_mfma_f32_16x16x32_bf16 v[224:227], v[80:83], v[96:99], v[224:227]
ds_read_b64_tr_b16 v[72:73], v9 offset:0
v_accvgpr_write_b32 a122, 0
v_mfma_f32_16x16x32_bf16 v[224:227], v[84:87], v[100:103], v[224:227]
ds_read_b64_tr_b16 v[74:75], v9 offset:1024
v_accvgpr_write_b32 a123, 0
v_mfma_f32_16x16x32_bf16 v[228:231], v[84:87], v[108:111], v[228:231]
s_add_u32 m0, s63, 102400
v_accvgpr_write_b32 a124, 0
v_accvgpr_write_b32 a125, 0
v_mfma_f32_16x16x32_bf16 v[228:231], v[80:83], v[104:107], v[228:231]
s_add_u32 s72, s70, 0
buffer_load_dwordx4 v4, s[4:7], s72 offen lds
v_mfma_f32_16x16x32_bf16 v[232:235], v[80:83], v[112:115], v[232:235]
ds_read_b64_tr_b16 v[76:77], v9 offset:8192
v_accvgpr_write_b32 a126, 0
v_mfma_f32_16x16x32_bf16 v[232:235], v[84:87], v[116:119], v[232:235]
ds_read_b128 v[60:63], v17 offset:6144
v_accvgpr_write_b32 a127, 0
v_mfma_f32_16x16x32_bf16 v[236:239], v[84:87], v[124:127], v[236:239]
ds_read_b64_tr_b16 v[78:79], v9 offset:9216
v_mfma_f32_16x16x32_bf16 v[236:239], v[80:83], v[120:123], v[236:239]
v_mfma_f32_16x16x32_bf16 v[252:255], v[88:91], v[120:123], v[252:255]
s_add_u32 s72, s70, 15360
buffer_load_dwordx4 v5, s[4:7], s72 offen offset:1024 lds
v_mfma_f32_16x16x32_bf16 v[252:255], v[92:95], v[124:127], v[252:255]
ds_read_b64_tr_b16 v[80:81], v10 offset:0
v_mfma_f32_16x16x32_bf16 v[248:251], v[92:95], v[116:119], v[248:251]
ds_read_b64_tr_b16 v[82:83], v10 offset:1024
v_mfma_f32_16x16x32_bf16 v[248:251], v[88:91], v[112:115], v[248:251]
v_mfma_f32_16x16x32_bf16 v[244:247], v[88:91], v[104:107], v[244:247]
ds_read_b64_tr_b16 v[84:85], v10 offset:8192
v_mfma_f32_16x16x32_bf16 v[244:247], v[92:95], v[108:111], v[244:247]
ds_read_b64_tr_b16 v[86:87], v10 offset:9216
v_mfma_f32_16x16x32_bf16 v[240:243], v[92:95], v[100:103], v[240:243]
s_add_u32 s72, s70, 129024
buffer_load_dwordx4 v4, s[4:7], s72 offen offset:2048 lds
v_mfma_f32_16x16x32_bf16 v[240:243], v[88:91], v[96:99], v[240:243]
s_waitcnt lgkmcnt(5)
v_mfma_f32_16x16x32_bf16 v[128:131], v[64:67], v[32:35], v[128:131]
ds_read_b64_tr_b16 v[88:89], v11 offset:0
v_mfma_f32_16x16x32_bf16 v[128:131], v[68:71], v[36:39], v[128:131]
ds_read_b64_tr_b16 v[90:91], v11 offset:1024
v_mfma_f32_16x16x32_bf16 v[132:135], v[68:71], v[44:47], v[132:135]
v_mfma_f32_16x16x32_bf16 v[132:135], v[64:67], v[40:43], v[132:135]
s_add_u32 s72, s70, 144384
buffer_load_dwordx4 v5, s[4:7], s72 offen offset:3072 lds
v_mfma_f32_16x16x32_bf16 v[136:139], v[64:67], v[48:51], v[136:139]
ds_read_b64_tr_b16 v[92:93], v11 offset:8192
v_mfma_f32_16x16x32_bf16 v[136:139], v[68:71], v[52:55], v[136:139]
s_lshl_b32 s71, s73, 12
v_mfma_f32_16x16x32_bf16 v[140:143], v[68:71], v[60:63], v[140:143]
s_add_u32 s71, s71, s66
ds_read_b64_tr_b16 v[94:95], v11 offset:9216
v_mfma_f32_16x16x32_bf16 v[140:143], v[64:67], v[56:59], v[140:143]
s_waitcnt lgkmcnt(8)
v_mfma_f32_16x16x32_bf16 v[156:159], v[72:75], v[56:59], v[156:159]
s_add_u32 m0, s64, 32768
ds_read_b64_tr_b16 v[64:65], v12 offset:0
v_mfma_f32_16x16x32_bf16 v[156:159], v[76:79], v[60:63], v[156:159]
s_add_u32 s72, s71, 0
buffer_load_dwordx4 v6, s[12:15], s72 offen lds
v_mfma_f32_16x16x32_bf16 v[152:155], v[76:79], v[52:55], v[152:155]
s_add_u32 s73, s62, 15
ds_read_b64_tr_b16 v[66:67], v12 offset:1024
v_mfma_f32_16x16x32_bf16 v[152:155], v[72:75], v[48:51], v[152:155]
s_add_u32 s70, s73, s65
v_mfma_f32_16x16x32_bf16 v[148:151], v[72:75], v[40:43], v[148:151]
s_and_b32 s70, s70, 3
ds_read_b64_tr_b16 v[68:69], v12 offset:8192
v_mfma_f32_16x16x32_bf16 v[148:151], v[76:79], v[44:47], v[148:151]
s_and_b32 s73, s73, 12
ds_read_b64_tr_b16 v[70:71], v12 offset:9216
v_mfma_f32_16x16x32_bf16 v[144:147], v[76:79], v[36:39], v[144:147]
s_add_u32 s72, s71, 31744
buffer_load_dwordx4 v6, s[12:15], s72 offen offset:1024 lds
v_mfma_f32_16x16x32_bf16 v[144:147], v[72:75], v[32:35], v[144:147]
s_waitcnt lgkmcnt(8)
v_mfma_f32_16x16x32_bf16 v[160:163], v[80:83], v[32:35], v[160:163]
s_or_b32 s73, s73, s70
ds_read_b64_tr_b16 v[72:73], v13 offset:0
v_mfma_f32_16x16x32_bf16 v[160:163], v[84:87], v[36:39], v[160:163]
s_lshl_b32 s73, s73, 7
ds_read_b64_tr_b16 v[74:75], v13 offset:1024
v_mfma_f32_16x16x32_bf16 v[164:167], v[84:87], v[44:47], v[164:167]
s_add_u32 s69, s73, s67
v_mfma_f32_16x16x32_bf16 v[164:167], v[80:83], v[40:43], v[164:167]
s_add_u32 s72, s71, 63488
buffer_load_dwordx4 v7, s[12:15], s72 offen offset:2048 lds
v_mfma_f32_16x16x32_bf16 v[168:171], v[80:83], v[48:51], v[168:171]
s_waitcnt vmcnt(15)
ds_read_b64_tr_b16 v[76:77], v13 offset:8192
v_mfma_f32_16x16x32_bf16 v[168:171], v[84:87], v[52:55], v[168:171]
s_add_u32 s70, s73, s68
ds_read_b128 v[96:99], v18 offset:0
v_mfma_f32_16x16x32_bf16 v[172:175], v[84:87], v[60:63], v[172:175]
ds_read_b64_tr_b16 v[78:79], v13 offset:9216
v_mfma_f32_16x16x32_bf16 v[172:175], v[80:83], v[56:59], v[172:175]
s_waitcnt lgkmcnt(9)
ds_read_b128 v[100:103], v19 offset:0
v_mfma_f32_16x16x32_bf16 v[188:191], v[88:91], v[56:59], v[188:191]
s_add_u32 s72, s71, 95232
buffer_load_dwordx4 v7, s[12:15], s72 offen offset:3072 lds
v_mfma_f32_16x16x32_bf16 v[188:191], v[92:95], v[60:63], v[188:191]
ds_read_b64_tr_b16 v[80:81], v14 offset:0
v_mfma_f32_16x16x32_bf16 v[184:187], v[92:95], v[52:55], v[184:187]
ds_read_b64_tr_b16 v[82:83], v14 offset:1024
v_mfma_f32_16x16x32_bf16 v[184:187], v[88:91], v[48:51], v[184:187]
v_mfma_f32_16x16x32_bf16 v[180:183], v[88:91], v[40:43], v[180:183]
ds_read_b64_tr_b16 v[84:85], v14 offset:8192
v_mfma_f32_16x16x32_bf16 v[180:183], v[92:95], v[44:47], v[180:183]
s_add_u32 m0, s63, 131072
ds_read_b64_tr_b16 v[86:87], v14 offset:9216
v_mfma_f32_16x16x32_bf16 v[176:179], v[92:95], v[36:39], v[176:179]
s_add_u32 s72, s69, 0
buffer_load_dwordx4 v4, s[4:7], s72 offen lds
v_mfma_f32_16x16x32_bf16 v[176:179], v[88:91], v[32:35], v[176:179]
s_waitcnt lgkmcnt(10)
ds_read_b128 v[104:107], v18 offset:2048
v_mfma_f32_16x16x32_bf16 v[192:195], v[64:67], v[32:35], v[192:195]
ds_read_b64_tr_b16 v[88:89], v15 offset:0
ds_read_b64_tr_b16 v[90:91], v15 offset:1024
v_mfma_f32_16x16x32_bf16 v[192:195], v[68:71], v[36:39], v[192:195]
ds_read_b64_tr_b16 v[92:93], v15 offset:8192
v_mfma_f32_16x16x32_bf16 v[196:199], v[68:71], v[44:47], v[196:199]
s_and_b32 s75, s91, 0xfffffc7f
v_lshrrev_b32 v2, 3, v0
v_lshlrev_b32 v2, 7, v2
v_mfma_f32_16x16x32_bf16 v[196:199], v[64:67], v[40:43], v[196:199]
s_add_u32 s72, s69, 15360
buffer_load_dwordx4 v5, s[4:7], s72 offen offset:1024 lds
v_mfma_f32_16x16x32_bf16 v[200:203], v[64:67], v[48:51], v[200:203]
buffer_load_dword v3, v2, s[44:47], s75 offen sc1
v_mfma_f32_16x16x32_bf16 v[200:203], v[68:71], v[52:55], v[200:203]
ds_read_b64_tr_b16 v[94:95], v15 offset:9216
v_mfma_f32_16x16x32_bf16 v[204:207], v[68:71], v[60:63], v[204:207]
ds_read_b128 v[108:111], v19 offset:2048
v_mfma_f32_16x16x32_bf16 v[204:207], v[64:67], v[56:59], v[204:207]
s_waitcnt lgkmcnt(11)
v_mfma_f32_16x16x32_bf16 v[220:223], v[72:75], v[56:59], v[220:223]
s_add_u32 s72, s69, 129024
buffer_load_dwordx4 v4, s[4:7], s72 offen offset:2048 lds
v_mfma_f32_16x16x32_bf16 v[220:223], v[76:79], v[60:63], v[220:223]
ds_read_b128 v[112:115], v18 offset:4096
v_mfma_f32_16x16x32_bf16 v[216:219], v[76:79], v[52:55], v[216:219]
s_waitcnt vmcnt(16) lgkmcnt(2)
ds_read_b128 v[116:119], v19 offset:4096
v_mfma_f32_16x16x32_bf16 v[216:219], v[72:75], v[48:51], v[216:219]
s_barrier
v_mfma_f32_16x16x32_bf16 v[212:215], v[72:75], v[40:43], v[212:215]
ds_read_b64_tr_b16 v[64:65], v8 offset:16384
ds_read_b64_tr_b16 v[66:67], v8 offset:17408
v_mfma_f32_16x16x32_bf16 v[212:215], v[76:79], v[44:47], v[212:215]
ds_read_b64_tr_b16 v[68:69], v8 offset:24576
v_mfma_f32_16x16x32_bf16 v[208:211], v[76:79], v[36:39], v[208:211]
s_add_u32 s72, s69, 144384
buffer_load_dwordx4 v5, s[4:7], s72 offen offset:3072 lds
v_mfma_f32_16x16x32_bf16 v[208:211], v[72:75], v[32:35], v[208:211]
ds_read_b64_tr_b16 v[70:71], v8 offset:25600
v_mfma_f32_16x16x32_bf16 v[224:227], v[80:83], v[32:35], v[224:227]
ds_read_b64_tr_b16 v[72:73], v9 offset:16384
v_mfma_f32_16x16x32_bf16 v[224:227], v[84:87], v[36:39], v[224:227]
ds_read_b64_tr_b16 v[74:75], v9 offset:17408
v_mfma_f32_16x16x32_bf16 v[228:231], v[84:87], v[44:47], v[228:231]
s_add_u32 m0, s63, 135168
ds_read_b128 v[120:123], v18 offset:6144
v_mfma_f32_16x16x32_bf16 v[228:231], v[80:83], v[40:43], v[228:231]
s_add_u32 s72, s70, 0
buffer_load_dwordx4 v4, s[4:7], s72 offen lds
v_mfma_f32_16x16x32_bf16 v[232:235], v[80:83], v[48:51], v[232:235]
ds_read_b64_tr_b16 v[76:77], v9 offset:24576
v_mfma_f32_16x16x32_bf16 v[232:235], v[84:87], v[52:55], v[232:235]
ds_read_b128 v[124:127], v19 offset:6144
v_mfma_f32_16x16x32_bf16 v[236:239], v[84:87], v[60:63], v[236:239]
ds_read_b64_tr_b16 v[78:79], v9 offset:25600
v_mfma_f32_16x16x32_bf16 v[236:239], v[80:83], v[56:59], v[236:239]
v_mfma_f32_16x16x32_bf16 v[252:255], v[88:91], v[56:59], v[252:255]
s_add_u32 s72, s70, 15360
buffer_load_dwordx4 v5, s[4:7], s72 offen offset:1024 lds
v_mfma_f32_16x16x32_bf16 v[252:255], v[92:95], v[60:63], v[252:255]
ds_read_b64_tr_b16 v[80:81], v10 offset:16384
v_mfma_f32_16x16x32_bf16 v[248:251], v[92:95], v[52:55], v[248:251]
ds_read_b64_tr_b16 v[82:83], v10 offset:17408
v_mfma_f32_16x16x32_bf16 v[248:251], v[88:91], v[48:51], v[248:251]
v_mfma_f32_16x16x32_bf16 v[244:247], v[88:91], v[40:43], v[244:247]
ds_read_b64_tr_b16 v[84:85], v10 offset:24576
v_mfma_f32_16x16x32_bf16 v[244:247], v[92:95], v[44:47], v[244:247]
ds_read_b64_tr_b16 v[86:87], v10 offset:25600
v_mfma_f32_16x16x32_bf16 v[240:243], v[92:95], v[36:39], v[240:243]
s_add_u32 s72, s70, 129024
buffer_load_dwordx4 v4, s[4:7], s72 offen offset:2048 lds
v_mfma_f32_16x16x32_bf16 v[240:243], v[88:91], v[32:35], v[240:243]
s_waitcnt lgkmcnt(5)
v_mfma_f32_16x16x32_bf16 v[128:131], v[64:67], v[96:99], v[128:131]
ds_read_b64_tr_b16 v[88:89], v11 offset:16384
v_mfma_f32_16x16x32_bf16 v[128:131], v[68:71], v[100:103], v[128:131]
ds_read_b64_tr_b16 v[90:91], v11 offset:17408
v_mfma_f32_16x16x32_bf16 v[132:135], v[68:71], v[108:111], v[132:135]
v_mfma_f32_16x16x32_bf16 v[132:135], v[64:67], v[104:107], v[132:135]
s_add_u32 s72, s70, 144384
buffer_load_dwordx4 v5, s[4:7], s72 offen offset:3072 lds
v_mfma_f32_16x16x32_bf16 v[136:139], v[64:67], v[112:115], v[136:139]
ds_read_b64_tr_b16 v[92:93], v11 offset:24576
v_mfma_f32_16x16x32_bf16 v[136:139], v[68:71], v[116:119], v[136:139]
s_lshl_b32 s71, s73, 12
v_mfma_f32_16x16x32_bf16 v[140:143], v[68:71], v[124:127], v[140:143]
s_add_u32 s71, s71, s66
ds_read_b64_tr_b16 v[94:95], v11 offset:25600
v_mfma_f32_16x16x32_bf16 v[140:143], v[64:67], v[120:123], v[140:143]
s_waitcnt lgkmcnt(8)
v_mfma_f32_16x16x32_bf16 v[156:159], v[72:75], v[120:123], v[156:159]
s_add_u32 m0, s64, 0
ds_read_b64_tr_b16 v[64:65], v12 offset:16384
v_mfma_f32_16x16x32_bf16 v[156:159], v[76:79], v[124:127], v[156:159]
s_add_u32 s72, s71, 0
buffer_load_dwordx4 v6, s[12:15], s72 offen lds
v_mfma_f32_16x16x32_bf16 v[152:155], v[76:79], v[116:119], v[152:155]
ds_read_b64_tr_b16 v[66:67], v12 offset:17408
v_mfma_f32_16x16x32_bf16 v[152:155], v[72:75], v[112:115], v[152:155]
v_mfma_f32_16x16x32_bf16 v[148:151], v[72:75], v[104:107], v[148:151]
ds_read_b64_tr_b16 v[68:69], v12 offset:24576
v_mfma_f32_16x16x32_bf16 v[148:151], v[76:79], v[108:111], v[148:151]
ds_read_b64_tr_b16 v[70:71], v12 offset:25600
v_mfma_f32_16x16x32_bf16 v[144:147], v[76:79], v[100:103], v[144:147]
s_add_u32 s72, s71, 31744
buffer_load_dwordx4 v6, s[12:15], s72 offen offset:1024 lds
v_mfma_f32_16x16x32_bf16 v[144:147], v[72:75], v[96:99], v[144:147]
s_waitcnt lgkmcnt(8)
v_mfma_f32_16x16x32_bf16 v[160:163], v[80:83], v[96:99], v[160:163]
ds_read_b64_tr_b16 v[72:73], v13 offset:16384
v_mfma_f32_16x16x32_bf16 v[160:163], v[84:87], v[100:103], v[160:163]
ds_read_b64_tr_b16 v[74:75], v13 offset:17408
v_mfma_f32_16x16x32_bf16 v[164:167], v[84:87], v[108:111], v[164:167]
v_mfma_f32_16x16x32_bf16 v[164:167], v[80:83], v[104:107], v[164:167]
s_add_u32 s72, s71, 63488
buffer_load_dwordx4 v7, s[12:15], s72 offen offset:2048 lds
v_mfma_f32_16x16x32_bf16 v[168:171], v[80:83], v[112:115], v[168:171]
s_waitcnt vmcnt(16)
ds_read_b64_tr_b16 v[76:77], v13 offset:24576
v_mfma_f32_16x16x32_bf16 v[168:171], v[84:87], v[116:119], v[168:171]
ds_read_b128 v[32:35], v18 offset:32768
v_mfma_f32_16x16x32_bf16 v[172:175], v[84:87], v[124:127], v[172:175]
ds_read_b64_tr_b16 v[78:79], v13 offset:25600
v_mfma_f32_16x16x32_bf16 v[172:175], v[80:83], v[120:123], v[172:175]
s_waitcnt lgkmcnt(9)
ds_read_b128 v[36:39], v19 offset:32768
v_mfma_f32_16x16x32_bf16 v[188:191], v[88:91], v[120:123], v[188:191]
s_add_u32 s72, s71, 95232
buffer_load_dwordx4 v7, s[12:15], s72 offen offset:3072 lds
v_mfma_f32_16x16x32_bf16 v[188:191], v[92:95], v[124:127], v[188:191]
v_accvgpr_write_b32 a0, -1
v_accvgpr_write_b32 a1, -1
v_mfma_f32_16x16x32_bf16 v[184:187], v[92:95], v[116:119], v[184:187]
v_accvgpr_write_b32 a2, -1
v_accvgpr_write_b32 a3, -1
v_mfma_f32_16x16x32_bf16 v[184:187], v[88:91], v[112:115], v[184:187]
s_add_u32 s80, s93, 0x3a00000
ds_read_b64_tr_b16 v[80:81], v14 offset:16384
v_mfma_f32_16x16x32_bf16 v[180:183], v[88:91], v[104:107], v[180:183]
ds_read_b64_tr_b16 v[82:83], v14 offset:17408
v_mfma_f32_16x16x32_bf16 v[180:183], v[92:95], v[108:111], v[180:183]
ds_read_b64_tr_b16 v[84:85], v14 offset:24576
v_mfma_f32_16x16x32_bf16 v[176:179], v[92:95], v[100:103], v[176:179]
ds_read_b64_tr_b16 v[86:87], v14 offset:25600
v_mfma_f32_16x16x32_bf16 v[176:179], v[88:91], v[96:99], v[176:179]
s_waitcnt lgkmcnt(10)
ds_read_b128 v[40:43], v18 offset:34816
v_mfma_f32_16x16x32_bf16 v[192:195], v[64:67], v[96:99], v[192:195]
s_waitcnt vmcnt(10)
v_cmp_gt_u32 vcc, 1, v3
s_cbranch_vccnz Lspin4
Lback5:
v_mfma_f32_16x16x32_bf16 v[192:195], v[68:71], v[100:103], v[192:195]
s_add_u32 m0, s64, 49152
ds_read_b64_tr_b16 v[88:89], v15 offset:16384
ds_read_b64_tr_b16 v[90:91], v15 offset:17408
v_mfma_f32_16x16x32_bf16 v[196:199], v[68:71], v[108:111], v[196:199]
s_add_u32 s72, s81, 16384
buffer_load_dwordx4 v1, s[44:47], s72 offen sc1 lds
v_mfma_f32_16x16x32_bf16 v[196:199], v[64:67], v[104:107], v[196:199]
ds_read_b64_tr_b16 v[92:93], v15 offset:24576
v_mfma_f32_16x16x32_bf16 v[200:203], v[64:67], v[112:115], v[200:203]
ds_read_b64_tr_b16 v[94:95], v15 offset:25600
v_mfma_f32_16x16x32_bf16 v[200:203], v[68:71], v[116:119], v[200:203]
buffer_load_dwordx4 v1, s[44:47], s72 offen offset:1024 sc1 lds
v_mfma_f32_16x16x32_bf16 v[204:207], v[68:71], v[124:127], v[204:207]
ds_read_b128 v[44:47], v19 offset:34816
v_mfma_f32_16x16x32_bf16 v[204:207], v[64:67], v[120:123], v[204:207]
s_waitcnt lgkmcnt(11)
v_mfma_f32_16x16x32_bf16 v[220:223], v[72:75], v[120:123], v[220:223]
ds_read_b128 v[48:51], v18 offset:36864
v_mfma_f32_16x16x32_bf16 v[220:223], v[76:79], v[124:127], v[220:223]
ds_read_b128 v[52:55], v19 offset:36864
v_mfma_f32_16x16x32_bf16 v[216:219], v[76:79], v[116:119], v[216:219]
s_waitcnt vmcnt(15) lgkmcnt(3)
buffer_load_dwordx4 v1, s[44:47], s72 offen offset:2048 sc1 lds
v_mfma_f32_16x16x32_bf16 v[216:219], v[72:75], v[112:115], v[216:219]
s_barrier
ds_read_b128 v[56:59], v18 offset:38912
v_mfma_f32_16x16x32_bf16 v[212:215], v[72:75], v[104:107], v[212:215]
ds_read_b64_tr_b16 v[64:65], v8 offset:32768
ds_read_b64_tr_b16 v[66:67], v8 offset:33792
v_mfma_f32_16x16x32_bf16 v[212:215], v[76:79], v[108:111], v[212:215]
ds_read_b64_tr_b16 v[68:69], v8 offset:40960
v_mfma_f32_16x16x32_bf16 v[208:211], v[76:79], v[100:103], v[208:211]
ds_read_b64_tr_b16 v[70:71], v8 offset:41984
v_mfma_f32_16x16x32_bf16 v[208:211], v[72:75], v[96:99], v[208:211]
buffer_load_dwordx4 v1, s[44:47], s72 offen offset:3072 sc1 lds
v_mfma_f32_16x16x32_bf16 v[224:227], v[80:83], v[96:99], v[224:227]
s_add_u32 s81, s81, 0x8000
ds_read_b64_tr_b16 v[72:73], v9 offset:32768
v_mfma_f32_16x16x32_bf16 v[224:227], v[84:87], v[100:103], v[224:227]
s_add_u32 m0, s64, 81920
ds_read_b64_tr_b16 v[74:75], v9 offset:33792
v_mfma_f32_16x16x32_bf16 v[228:231], v[84:87], v[108:111], v[228:231]
s_add_u32 s72, s81, 16384
buffer_load_dwordx4 v1, s[44:47], s72 offen sc1 lds
v_mfma_f32_16x16x32_bf16 v[228:231], v[80:83], v[104:107], v[228:231]
ds_read_b128 v[60:63], v19 offset:38912
v_mfma_f32_16x16x32_bf16 v[232:235], v[80:83], v[112:115], v[232:235]
buffer_load_dwordx4 v1, s[44:47], s72 offen offset:1024 sc1 lds
v_mfma_f32_16x16x32_bf16 v[232:235], v[84:87], v[116:119], v[232:235]
ds_read_b64_tr_b16 v[76:77], v9 offset:40960
v_mfma_f32_16x16x32_bf16 v[236:239], v[84:87], v[124:127], v[236:239]
ds_read_b64_tr_b16 v[78:79], v9 offset:41984
v_mfma_f32_16x16x32_bf16 v[236:239], v[80:83], v[120:123], v[236:239]
v_mfma_f32_16x16x32_bf16 v[252:255], v[88:91], v[120:123], v[252:255]
ds_read_b64_tr_b16 v[80:81], v10 offset:32768
v_mfma_f32_16x16x32_bf16 v[252:255], v[92:95], v[124:127], v[252:255]
buffer_load_dwordx4 v1, s[44:47], s72 offen offset:2048 sc1 lds
v_mfma_f32_16x16x32_bf16 v[248:251], v[92:95], v[116:119], v[248:251]
ds_read_b64_tr_b16 v[82:83], v10 offset:33792
v_mfma_f32_16x16x32_bf16 v[248:251], v[88:91], v[112:115], v[248:251]
v_mfma_f32_16x16x32_bf16 v[244:247], v[88:91], v[104:107], v[244:247]
ds_read_b64_tr_b16 v[84:85], v10 offset:40960
v_mfma_f32_16x16x32_bf16 v[244:247], v[92:95], v[108:111], v[244:247]
buffer_load_dwordx4 v1, s[44:47], s72 offen offset:3072 sc1 lds
v_mfma_f32_16x16x32_bf16 v[240:243], v[92:95], v[100:103], v[240:243]
ds_read_b64_tr_b16 v[86:87], v10 offset:41984
v_mfma_f32_16x16x32_bf16 v[240:243], v[88:91], v[96:99], v[240:243]
s_waitcnt lgkmcnt(6)
v_mfma_f32_16x16x32_bf16 v[128:131], v[64:67], v[32:35], v[128:131]
ds_read_b64_tr_b16 v[88:89], v11 offset:32768
v_mfma_f32_16x16x32_bf16 v[128:131], v[68:71], v[36:39], v[128:131]
ds_read_b64_tr_b16 v[90:91], v11 offset:33792
v_mfma_f32_16x16x32_bf16 v[132:135], v[68:71], v[44:47], v[132:135]
s_add_u32 m0, s64, 65536
v_mfma_f32_16x16x32_bf16 v[132:135], v[64:67], v[40:43], v[132:135]
s_add_u32 s72, s81, 0
buffer_load_dwordx4 v1, s[44:47], s72 offen sc1 lds
v_mfma_f32_16x16x32_bf16 v[136:139], v[64:67], v[48:51], v[136:139]
ds_read_b64_tr_b16 v[92:93], v11 offset:40960
v_mfma_f32_16x16x32_bf16 v[136:139], v[68:71], v[52:55], v[136:139]
ds_read_b64_tr_b16 v[94:95], v11 offset:41984
v_mfma_f32_16x16x32_bf16 v[140:143], v[68:71], v[60:63], v[140:143]
v_mfma_f32_16x16x32_bf16 v[140:143], v[64:67], v[56:59], v[140:143]
s_waitcnt lgkmcnt(8)
buffer_load_dwordx4 v1, s[44:47], s72 offen offset:1024 sc1 lds
v_mfma_f32_16x16x32_bf16 v[156:159], v[72:75], v[56:59], v[156:159]
ds_read_b64_tr_b16 v[64:65], v12 offset:32768
v_mfma_f32_16x16x32_bf16 v[156:159], v[76:79], v[60:63], v[156:159]
ds_read_b64_tr_b16 v[66:67], v12 offset:33792
v_mfma_f32_16x16x32_bf16 v[152:155], v[76:79], v[52:55], v[152:155]
v_mfma_f32_16x16x32_bf16 v[152:155], v[72:75], v[48:51], v[152:155]
buffer_load_dwordx4 v1, s[44:47], s72 offen offset:2048 sc1 lds
v_mfma_f32_16x16x32_bf16 v[148:151], v[72:75], v[40:43], v[148:151]
ds_read_b64_tr_b16 v[68:69], v12 offset:40960
v_mfma_f32_16x16x32_bf16 v[148:151], v[76:79], v[44:47], v[148:151]
v_mfma_f32_16x16x32_bf16 v[144:147], v[76:79], v[36:39], v[144:147]
ds_read_b64_tr_b16 v[70:71], v12 offset:41984
v_mfma_f32_16x16x32_bf16 v[144:147], v[72:75], v[32:35], v[144:147]
s_waitcnt lgkmcnt(8)
v_mfma_f32_16x16x32_bf16 v[160:163], v[80:83], v[32:35], v[160:163]
buffer_load_dwordx4 v1, s[44:47], s72 offen offset:3072 sc1 lds
v_mfma_f32_16x16x32_bf16 v[160:163], v[84:87], v[36:39], v[160:163]
ds_read_b64_tr_b16 v[72:73], v13 offset:32768
v_mfma_f32_16x16x32_bf16 v[164:167], v[84:87], v[44:47], v[164:167]
ds_read_b64_tr_b16 v[74:75], v13 offset:33792
v_mfma_f32_16x16x32_bf16 v[164:167], v[80:83], v[40:43], v[164:167]
v_mfma_f32_16x16x32_bf16 v[168:171], v[80:83], v[48:51], v[168:171]
s_waitcnt vmcnt(16)
ds_read_b64_tr_b16 v[76:77], v13 offset:40960
v_mfma_f32_16x16x32_bf16 v[168:171], v[84:87], v[52:55], v[168:171]
ds_read_b128 v[96:99], v16 offset:0
v_mfma_f32_16x16x32_bf16 v[172:175], v[84:87], v[60:63], v[172:175]
ds_read_b64_tr_b16 v[78:79], v13 offset:41984
v_mfma_f32_16x16x32_bf16 v[172:175], v[80:83], v[56:59], v[172:175]
s_waitcnt lgkmcnt(9)
v_mfma_f32_16x16x32_bf16 v[188:191], v[88:91], v[56:59], v[188:191]
ds_read_b64_tr_b16 v[80:81], v14 offset:32768
v_mfma_f32_16x16x32_bf16 v[188:191], v[92:95], v[60:63], v[188:191]
ds_read_b128 v[100:103], v17 offset:0
v_mfma_f32_16x16x32_bf16 v[184:187], v[92:95], v[52:55], v[184:187]
ds_read_b64_tr_b16 v[82:83], v14 offset:33792
v_mfma_f32_16x16x32_bf16 v[184:187], v[88:91], v[48:51], v[184:187]
v_mfma_f32_16x16x32_bf16 v[180:183], v[88:91], v[40:43], v[180:183]
ds_read_b64_tr_b16 v[84:85], v14 offset:40960
v_mfma_f32_16x16x32_bf16 v[180:183], v[92:95], v[44:47], v[180:183]
ds_read_b128 v[104:107], v16 offset:2048
v_mfma_f32_16x16x32_bf16 v[176:179], v[92:95], v[36:39], v[176:179]
ds_read_b64_tr_b16 v[86:87], v14 offset:41984
v_mfma_f32_16x16x32_bf16 v[176:179], v[88:91], v[32:35], v[176:179]
s_waitcnt lgkmcnt(11)
v_mfma_f32_16x16x32_bf16 v[192:195], v[64:67], v[32:35], v[192:195]
ds_read_b64_tr_b16 v[88:89], v15 offset:32768
v_mfma_f32_16x16x32_bf16 v[192:195], v[68:71], v[36:39], v[192:195]
ds_read_b64_tr_b16 v[90:91], v15 offset:33792
v_mfma_f32_16x16x32_bf16 v[196:199], v[68:71], v[44:47], v[196:199]
ds_read_b128 v[108:111], v17 offset:2048
v_mfma_f32_16x16x32_bf16 v[196:199], v[64:67], v[40:43], v[196:199]
ds_read_b64_tr_b16 v[92:93], v15 offset:40960
v_mfma_f32_16x16x32_bf16 v[200:203], v[64:67], v[48:51], v[200:203]
ds_read_b64_tr_b16 v[94:95], v15 offset:41984
v_mfma_f32_16x16x32_bf16 v[200:203], v[68:71], v[52:55], v[200:203]
v_mfma_f32_16x16x32_bf16 v[204:207], v[68:71], v[60:63], v[204:207]
ds_read_b128 v[112:115], v16 offset:4096
v_mfma_f32_16x16x32_bf16 v[204:207], v[64:67], v[56:59], v[204:207]
s_waitcnt lgkmcnt(12)
v_mfma_f32_16x16x32_bf16 v[220:223], v[72:75], v[56:59], v[220:223]
ds_read_b128 v[116:119], v17 offset:4096
v_mfma_f32_16x16x32_bf16 v[220:223], v[76:79], v[60:63], v[220:223]
v_mfma_f32_16x16x32_bf16 v[216:219], v[76:79], v[52:55], v[216:219]
s_waitcnt vmcnt(12) lgkmcnt(2)
ds_read_b128 v[120:123], v16 offset:6144
v_mfma_f32_16x16x32_bf16 v[216:219], v[72:75], v[48:51], v[216:219]
s_barrier
v_mfma_f32_16x16x32_bf16 v[212:215], v[72:75], v[40:43], v[212:215]
s_add_u32 s81, s81, 0x8000
ds_read_b64_tr_b16 v[64:65], v8 offset:0
ds_read_b64_tr_b16 v[66:67], v8 offset:1024
v_mfma_f32_16x16x32_bf16 v[212:215], v[76:79], v[44:47], v[212:215]
s_add_u32 m0, s64, 114688
ds_read_b64_tr_b16 v[68:69], v8 offset:8192
v_mfma_f32_16x16x32_bf16 v[208:211], v[76:79], v[36:39], v[208:211]
s_add_u32 s72, s81, 16384
buffer_load_dwordx4 v1, s[44:47], s72 offen sc1 lds
v_mfma_f32_16x16x32_bf16 v[208:211], v[72:75], v[32:35], v[208:211]
ds_read_b64_tr_b16 v[70:71], v8 offset:9216
v_mfma_f32_16x16x32_bf16 v[224:227], v[80:83], v[32:35], v[224:227]
buffer_load_dwordx4 v1, s[44:47], s72 offen offset:1024 sc1 lds
v_mfma_f32_16x16x32_bf16 v[224:227], v[84:87], v[36:39], v[224:227]
ds_read_b64_tr_b16 v[72:73], v9 offset:0
v_mfma_f32_16x16x32_bf16 v[228:231], v[84:87], v[44:47], v[228:231]
ds_read_b64_tr_b16 v[74:75], v9 offset:1024
v_mfma_f32_16x16x32_bf16 v[228:231], v[80:83], v[40:43], v[228:231]
ds_read_b128 v[124:127], v17 offset:6144
v_mfma_f32_16x16x32_bf16 v[232:235], v[80:83], v[48:51], v[232:235]
ds_read_b64_tr_b16 v[76:77], v9 offset:8192
v_mfma_f32_16x16x32_bf16 v[232:235], v[84:87], v[52:55], v[232:235]
buffer_store_dwordx4 a[0:3], v1, s[44:47], s80 offen sc1
v_mfma_f32_16x16x32_bf16 v[236:239], v[84:87], v[60:63], v[236:239]
ds_read_b64_tr_b16 v[78:79], v9 offset:9216
v_mfma_f32_16x16x32_bf16 v[236:239], v[80:83], v[56:59], v[236:239]
v_mfma_f32_16x16x32_bf16 v[252:255], v[88:91], v[56:59], v[252:255]
ds_read_b64_tr_b16 v[80:81], v10 offset:0
v_mfma_f32_16x16x32_bf16 v[252:255], v[92:95], v[60:63], v[252:255]
ds_read_b64_tr_b16 v[82:83], v10 offset:1024
v_mfma_f32_16x16x32_bf16 v[248:251], v[92:95], v[52:55], v[248:251]
buffer_load_dwordx4 v1, s[44:47], s72 offen offset:2048 sc1 lds
v_mfma_f32_16x16x32_bf16 v[248:251], v[88:91], v[48:51], v[248:251]
v_mfma_f32_16x16x32_bf16 v[244:247], v[88:91], v[40:43], v[244:247]
ds_read_b64_tr_b16 v[84:85], v10 offset:8192
v_mfma_f32_16x16x32_bf16 v[244:247], v[92:95], v[44:47], v[244:247]
ds_read_b64_tr_b16 v[86:87], v10 offset:9216
v_mfma_f32_16x16x32_bf16 v[240:243], v[92:95], v[36:39], v[240:243]
buffer_load_dwordx4 v1, s[44:47], s72 offen offset:3072 sc1 lds
v_mfma_f32_16x16x32_bf16 v[240:243], v[88:91], v[32:35], v[240:243]
s_waitcnt lgkmcnt(6)
v_mfma_f32_16x16x32_bf16 v[128:131], v[64:67], v[96:99], v[128:131]
ds_read_b64_tr_b16 v[88:89], v11 offset:0
v_mfma_f32_16x16x32_bf16 v[128:131], v[68:71], v[100:103], v[128:131]
ds_read_b64_tr_b16 v[90:91], v11 offset:1024
v_mfma_f32_16x16x32_bf16 v[132:135], v[68:71], v[108:111], v[132:135]
v_mfma_f32_16x16x32_bf16 v[132:135], v[64:67], v[104:107], v[132:135]
buffer_store_dwordx4 a[0:3], v1, s[44:47], s80 offen offset:1024 sc1
v_mfma_f32_16x16x32_bf16 v[136:139], v[64:67], v[112:115], v[136:139]
ds_read_b64_tr_b16 v[92:93], v11 offset:8192
v_mfma_f32_16x16x32_bf16 v[136:139], v[68:71], v[116:119], v[136:139]
v_mfma_f32_16x16x32_bf16 v[140:143], v[68:71], v[124:127], v[140:143]
ds_read_b64_tr_b16 v[94:95], v11 offset:9216
v_mfma_f32_16x16x32_bf16 v[140:143], v[64:67], v[120:123], v[140:143]
s_waitcnt lgkmcnt(8)
v_mfma_f32_16x16x32_bf16 v[156:159], v[72:75], v[120:123], v[156:159]
s_add_u32 m0, s64, 98304
ds_read_b64_tr_b16 v[64:65], v12 offset:0
v_mfma_f32_16x16x32_bf16 v[156:159], v[76:79], v[124:127], v[156:159]
s_add_u32 s72, s81, 0
buffer_load_dwordx4 v1, s[44:47], s72 offen sc1 lds
v_mfma_f32_16x16x32_bf16 v[152:155], v[76:79], v[116:119], v[152:155]
ds_read_b64_tr_b16 v[66:67], v12 offset:1024
v_mfma_f32_16x16x32_bf16 v[152:155], v[72:75], v[112:115], v[152:155]
v_mfma_f32_16x16x32_bf16 v[148:151], v[72:75], v[104:107], v[148:151]
buffer_load_dwordx4 v1, s[44:47], s72 offen offset:1024 sc1 lds
v_mfma_f32_16x16x32_bf16 v[148:151], v[76:79], v[108:111], v[148:151]
ds_read_b64_tr_b16 v[68:69], v12 offset:8192
v_mfma_f32_16x16x32_bf16 v[144:147], v[76:79], v[100:103], v[144:147]
ds_read_b64_tr_b16 v[70:71], v12 offset:9216
v_mfma_f32_16x16x32_bf16 v[144:147], v[72:75], v[96:99], v[144:147]
s_waitcnt lgkmcnt(8)
v_mfma_f32_16x16x32_bf16 v[160:163], v[80:83], v[96:99], v[160:163]
ds_read_b64_tr_b16 v[72:73], v13 offset:0
v_mfma_f32_16x16x32_bf16 v[160:163], v[84:87], v[100:103], v[160:163]
buffer_store_dwordx4 a[0:3], v1, s[44:47], s80 offen offset:2048 sc1
v_mfma_f32_16x16x32_bf16 v[164:167], v[84:87], v[108:111], v[164:167]
ds_read_b64_tr_b16 v[74:75], v13 offset:1024
v_mfma_f32_16x16x32_bf16 v[164:167], v[80:83], v[104:107], v[164:167]
v_mfma_f32_16x16x32_bf16 v[168:171], v[80:83], v[112:115], v[168:171]
ds_read_b64_tr_b16 v[76:77], v13 offset:8192
v_cvt_pk_bf16_f32 v48, v136, v137
v_mfma_f32_16x16x32_bf16 v[168:171], v[84:87], v[116:119], v[168:171]
ds_read_b64_tr_b16 v[78:79], v13 offset:9216
v_cvt_pk_bf16_f32 v49, v138, v139
v_mfma_f32_16x16x32_bf16 v[172:175], v[84:87], v[124:127], v[172:175]
buffer_load_dwordx4 v1, s[44:47], s72 offen offset:2048 sc1 lds
v_mfma_f32_16x16x32_bf16 v[172:175], v[80:83], v[120:123], v[172:175]
s_waitcnt lgkmcnt(8)
v_cvt_pk_bf16_f32 v50, v152, v153
v_cvt_pk_bf16_f32 v51, v154, v155
v_mfma_f32_16x16x32_bf16 v[188:191], v[88:91], v[120:123], v[188:191]
v_add_u32 v2, 0x8000, v1
v_cvt_pk_bf16_f32 v32, v132, v133
v_mfma_f32_16x16x32_bf16 v[188:191], v[92:95], v[124:127], v[188:191]
ds_read_b64_tr_b16 v[80:81], v14 offset:0
v_cvt_pk_bf16_f32 v33, v134, v135
v_mfma_f32_16x16x32_bf16 v[184:187], v[92:95], v[116:119], v[184:187]
buffer_load_dwordx4 v1, s[44:47], s72 offen offset:3072 sc1 lds
v_mfma_f32_16x16x32_bf16 v[184:187], v[88:91], v[112:115], v[184:187]
ds_read_b64_tr_b16 v[82:83], v14 offset:1024
v_cvt_pk_bf16_f32 v34, v148, v149
v_mfma_f32_16x16x32_bf16 v[180:183], v[88:91], v[104:107], v[180:183]
ds_read_b64_tr_b16 v[84:85], v14 offset:8192
v_cvt_pk_bf16_f32 v35, v150, v151
v_mfma_f32_16x16x32_bf16 v[180:183], v[92:95], v[108:111], v[180:183]
ds_read_b64_tr_b16 v[86:87], v14 offset:9216
v_cvt_pk_bf16_f32 v16, v128, v129
v_mfma_f32_16x16x32_bf16 v[176:179], v[92:95], v[100:103], v[176:179]
v_cvt_pk_bf16_f32 v17, v130, v131
v_cvt_pk_bf16_f32 v18, v144, v145
v_mfma_f32_16x16x32_bf16 v[176:179], v[88:91], v[96:99], v[176:179]
s_waitcnt lgkmcnt(8)
buffer_store_dwordx4 a[0:3], v1, s[44:47], s80 offen offset:3072 sc1
v_mfma_f32_16x16x32_bf16 v[192:195], v[64:67], v[96:99], v[192:195]
ds_read_b64_tr_b16 v[88:89], v15 offset:0
v_cvt_pk_bf16_f32 v19, v146, v147
v_mfma_f32_16x16x32_bf16 v[192:195], v[68:71], v[100:103], v[192:195]
ds_read_b64_tr_b16 v[90:91], v15 offset:1024
v_mfma_f32_16x16x32_bf16 v[196:199], v[68:71], v[108:111], v[196:199]
ds_read_b64_tr_b16 v[92:93], v15 offset:8192
v_mfma_f32_16x16x32_bf16 v[196:199], v[64:67], v[104:107], v[196:199]
ds_read_b64_tr_b16 v[94:95], v15 offset:9216
v_mfma_f32_16x16x32_bf16 v[200:203], v[64:67], v[112:115], v[200:203]
v_lshrrev_b32 v3, 1, v0
v_lshlrev_b32 v3, 7, v3
v_mfma_f32_16x16x32_bf16 v[200:203], v[68:71], v[116:119], v[200:203]
buffer_load_dword v4, v3, s[36:39], s93 offen
v_mfma_f32_16x16x32_bf16 v[204:207], v[68:71], v[124:127], v[204:207]
v_cvt_pk_bf16_f32 v52, v168, v169
v_cvt_pk_bf16_f32 v53, v170, v171
v_mfma_f32_16x16x32_bf16 v[204:207], v[64:67], v[120:123], v[204:207]
s_waitcnt lgkmcnt(8)
v_cvt_pk_bf16_f32 v54, v184, v185
v_cvt_pk_bf16_f32 v55, v186, v187
v_mfma_f32_16x16x32_bf16 v[220:223], v[72:75], v[120:123], v[220:223]
v_cvt_pk_bf16_f32 v36, v164, v165
v_cvt_pk_bf16_f32 v37, v166, v167
v_mfma_f32_16x16x32_bf16 v[220:223], v[76:79], v[124:127], v[220:223]
v_cvt_pk_bf16_f32 v38, v180, v181
v_cvt_pk_bf16_f32 v39, v182, v183
v_mfma_f32_16x16x32_bf16 v[216:219], v[76:79], v[116:119], v[216:219]
s_waitcnt vmcnt(21) lgkmcnt(0)
v_cvt_pk_bf16_f32 v20, v160, v161
v_cvt_pk_bf16_f32 v21, v162, v163
v_mfma_f32_16x16x32_bf16 v[216:219], v[72:75], v[112:115], v[216:219]
s_barrier
v_cvt_pk_bf16_f32 v22, v176, v177
v_cvt_pk_bf16_f32 v23, v178, v179
v_mfma_f32_16x16x32_bf16 v[212:215], v[72:75], v[104:107], v[212:215]
ds_read_b128 a[128:131], v2 offset:16384
v_cvt_pk_bf16_f32 v64, v140, v141
v_mfma_f32_16x16x32_bf16 v[212:215], v[76:79], v[108:111], v[212:215]
v_cvt_pk_bf16_f32 v65, v142, v143
v_cvt_pk_bf16_f32 v66, v156, v157
v_mfma_f32_16x16x32_bf16 v[208:211], v[76:79], v[100:103], v[208:211]
ds_read_b128 a[132:135], v2 offset:17408
v_cvt_pk_bf16_f32 v67, v158, v159
v_mfma_f32_16x16x32_bf16 v[208:211], v[72:75], v[96:99], v[208:211]
v_cvt_pk_bf16_f32 v68, v172, v173
v_cvt_pk_bf16_f32 v69, v174, v175
v_mfma_f32_16x16x32_bf16 v[224:227], v[80:83], v[96:99], v[224:227]
ds_read_b128 a[136:139], v2 offset:18432
v_cvt_pk_bf16_f32 v70, v188, v189
v_mfma_f32_16x16x32_bf16 v[224:227], v[84:87], v[100:103], v[224:227]
v_cvt_pk_bf16_f32 v71, v190, v191
v_mfma_f32_16x16x32_bf16 v[228:231], v[84:87], v[108:111], v[228:231]
ds_read_b128 a[140:143], v2 offset:19456
v_mfma_f32_16x16x32_bf16 v[228:231], v[80:83], v[104:107], v[228:231]
v_mfma_f32_16x16x32_bf16 v[232:235], v[80:83], v[112:115], v[232:235]
ds_read_b128 a[144:147], v2 offset:20480
v_cvt_pk_bf16_f32 v72, v204, v205
v_mfma_f32_16x16x32_bf16 v[232:235], v[84:87], v[116:119], v[232:235]
v_cvt_pk_bf16_f32 v73, v206, v207
v_cvt_pk_bf16_f32 v74, v220, v221
v_mfma_f32_16x16x32_bf16 v[236:239], v[84:87], v[124:127], v[236:239]
ds_read_b128 a[148:151], v2 offset:21504
v_cvt_pk_bf16_f32 v75, v222, v223
v_mfma_f32_16x16x32_bf16 v[236:239], v[80:83], v[120:123], v[236:239]
v_cvt_pk_bf16_f32 v56, v200, v201
v_cvt_pk_bf16_f32 v57, v202, v203
v_mfma_f32_16x16x32_bf16 v[252:255], v[88:91], v[120:123], v[252:255]
ds_read_b128 a[152:155], v2 offset:22528
v_cvt_pk_bf16_f32 v58, v216, v217
v_mfma_f32_16x16x32_bf16 v[252:255], v[92:95], v[124:127], v[252:255]
v_cvt_pk_bf16_f32 v59, v218, v219
v_cvt_pk_bf16_f32 v40, v196, v197
v_mfma_f32_16x16x32_bf16 v[248:251], v[92:95], v[116:119], v[248:251]
ds_read_b128 a[156:159], v2 offset:23552
v_cvt_pk_bf16_f32 v41, v198, v199
v_mfma_f32_16x16x32_bf16 v[248:251], v[88:91], v[112:115], v[248:251]
v_cvt_pk_bf16_f32 v42, v212, v213
v_cvt_pk_bf16_f32 v43, v214, v215
v_mfma_f32_16x16x32_bf16 v[244:247], v[88:91], v[104:107], v[244:247]
v_cvt_pk_bf16_f32 v24, v192, v193
v_cvt_pk_bf16_f32 v25, v194, v195
v_mfma_f32_16x16x32_bf16 v[244:247], v[92:95], v[108:111], v[244:247]
v_cvt_pk_bf16_f32 v26, v208, v209
v_cvt_pk_bf16_f32 v27, v210, v211
v_mfma_f32_16x16x32_bf16 v[240:243], v[92:95], v[100:103], v[240:243]
v_mfma_f32_16x16x32_bf16 v[240:243], v[88:91], v[96:99], v[240:243]
v_cvt_pk_bf16_f32 v76, v236, v237
v_cvt_pk_bf16_f32 v77, v238, v239
v_cvt_pk_bf16_f32 v78, v252, v253
v_cvt_pk_bf16_f32 v79, v254, v255
v_cvt_pk_bf16_f32 v60, v232, v233
v_cvt_pk_bf16_f32 v61, v234, v235
v_cvt_pk_bf16_f32 v62, v248, v249
v_cvt_pk_bf16_f32 v63, v250, v251
v_cvt_pk_bf16_f32 v44, v228, v229
v_cvt_pk_bf16_f32 v45, v230, v231
v_cvt_pk_bf16_f32 v46, v244, v245
v_cvt_pk_bf16_f32 v47, v246, v247
v_cvt_pk_bf16_f32 v28, v224, v225
v_cvt_pk_bf16_f32 v29, v226, v227
v_cvt_pk_bf16_f32 v30, v240, v241
v_cvt_pk_bf16_f32 v31, v242, v243
v_mov_b32 v124, 0xff800000
v_mov_b32 v125, 0xff800000
v_mov_b32 v126, 0xff800000
v_mov_b32 v127, 0xff800000
s_lshl_b32 s84, s60, 2
s_add_u32 s84, s84, s58
s_mov_b32 s86, 0
s_lshr_b32 s52, s66, 8
s_and_b32 s52, s52, 31
s_add_u32 s61, s65, s60
s_and_b32 s73, s60, 1
s_lshl_b32 s73, s73, 16
s_add_u32 s77, s73, s64
s_xor_b32 s73, s73, 0x10000
s_mov_b32 s92, s73
s_mul_i32 s62, s58, 4608
s_add_u32 s62, s62, 143104
s_add_u32 s73, s73, 49920
s_cmp_eq_u32 s58, 0
s_cselect_b32 s62, s73, s62
Lattn:
s_mov_b32 s82, 0x10000
s_waitcnt lgkmcnt(0)
v_mfma_f32_16x16x32_bf16 v[136:139], a[128:131], v[48:51], 0
ds_read_b128 a[160:163], v2 offset:24576
v_lshrrev_b32 v240, 4, v0
v_mfma_f32_16x16x32_bf16 v[136:139], a[132:135], v[52:55], v[136:139]
ds_read_b128 a[164:167], v2 offset:25600
v_and_b32 v241, 15, v0
v_mfma_f32_16x16x32_bf16 v[136:139], a[136:139], v[56:59], v[136:139]
ds_read_b128 a[168:171], v2 offset:26624
v_lshlrev_b32 v240, 2, v240
v_mfma_f32_16x16x32_bf16 v[136:139], a[140:143], v[60:63], v[136:139]
ds_read_b128 a[172:175], v2 offset:27648
v_sub_u32 v240, v241, v240
v_mfma_f32_16x16x32_bf16 v[140:143], a[140:143], v[76:79], 0
ds_read_b128 a[176:179], v2 offset:28672
v_mov_b32 v112, 0xff800000
v_mfma_f32_16x16x32_bf16 v[140:143], a[136:139], v[72:75], v[140:143]
ds_read_b128 a[180:183], v2 offset:29696
v_mov_b32 v113, 0xff800000
v_mfma_f32_16x16x32_bf16 v[140:143], a[132:135], v[68:71], v[140:143]
ds_read_b128 a[184:187], v2 offset:30720
v_mov_b32 v114, 0xff800000
v_mfma_f32_16x16x32_bf16 v[140:143], a[128:131], v[64:67], v[140:143]
ds_read_b128 a[188:191], v2 offset:31744
v_mov_b32 v115, 0xff800000
v_mfma_f32_16x16x32_bf16 v[156:159], a[144:147], v[64:67], 0
v_cmp_gt_i32 vcc, 0, v240
v_mov_b32 v120, 0x3f803f80
v_mfma_f32_16x16x32_bf16 v[156:159], a[148:151], v[68:71], v[156:159]
v_cndmask_b32 v116, 0, v112, vcc
v_cmp_gt_i32 vcc, 1, v240
v_mfma_f32_16x16x32_bf16 v[156:159], a[152:155], v[72:75], v[156:159]
v_mov_b32 v121, 0x3f803f80
v_cndmask_b32 v117, 0, v112, vcc
v_mfma_f32_16x16x32_bf16 v[156:159], a[156:159], v[76:79], v[156:159]
v_cmp_gt_i32 vcc, 2, v240
v_mov_b32 v122, 0x3f803f80
v_mfma_f32_16x16x32_bf16 v[152:155], a[156:159], v[60:63], 0
v_cndmask_b32 v118, 0, v112, vcc
v_cmp_gt_i32 vcc, 3, v240
v_mfma_f32_16x16x32_bf16 v[152:155], a[152:155], v[56:59], v[152:155]
v_mov_b32 v123, 0x3f803f80
v_cndmask_b32 v119, 0, v112, vcc
v_mfma_f32_16x16x32_bf16 v[152:155], a[148:151], v[52:55], v[152:155]
v_mov_b32 v228, 0
v_mov_b32 v229, 0
v_mfma_f32_16x16x32_bf16 v[152:155], a[144:147], v[48:51], v[152:155]
v_mov_b32 v230, 0
v_mov_b32 v231, 0
s_cmp_eq_u32 s84, 0
s_cbranch_scc1 Lta7
s_cmp_eq_u32 s84, 1
s_cbranch_scc1 Lnt8
v_mfma_f32_16x16x32_bf16 v[128:131], a[128:131], v[16:19], 0
v_mov_b32 v236, 0
v_mov_b32 v237, 0
v_mfma_f32_16x16x32_bf16 v[144:147], a[144:147], v[16:19], 0
v_mov_b32 v238, 0
v_mov_b32 v239, 0
s_branch Ljoin9
Lta7:
v_mfma_f32_16x16x32_bf16 v[128:131], a[128:131], v[16:19], v[116:119]
Lstub0:
s_cbranch_execz Lstub4
v_mov_b32 v236, 0
v_mov_b32 v237, 0
v_mfma_f32_16x16x32_bf16 v[144:147], a[144:147], v[16:19], v[112:115]
v_mov_b32 v238, 0
v_mov_b32 v239, 0
s_branch Ljoin9
Lnt8:
v_mfma_f32_16x16x32_bf16 v[128:131], a[128:131], v[16:19], 0
v_mov_b32 v236, 0
v_mov_b32 v237, 0
v_mfma_f32_16x16x32_bf16 v[144:147], a[144:147], v[16:19], v[116:119]
v_mov_b32 v238, 0
v_mov_b32 v239, 0
Ljoin9:
v_mfma_f32_16x16x32_bf16 v[128:131], a[132:135], v[20:23], v[128:131]
v_mfma_f32_16x16x32_bf16 v[128:131], a[136:139], v[24:27], v[128:131]
v_mfma_f32_16x16x32_bf16 v[128:131], a[140:143], v[28:31], v[128:131]
v_max3_f32 v240, v136, v137, v126
v_max3_f32 v242, v140, v141, v127
v_mfma_f32_16x16x32_bf16 v[132:135], a[140:143], v[44:47], 0
v_max3_f32 v240, v240, v138, v139
v_max3_f32 v242, v242, v142, v143
v_mfma_f32_16x16x32_bf16 v[132:135], a[136:139], v[40:43], v[132:135]
v_max3_f32 v240, v240, v152, v153
v_max3_f32 v242, v242, v156, v157
v_mfma_f32_16x16x32_bf16 v[132:135], a[132:135], v[36:39], v[132:135]
v_max3_f32 v240, v240, v154, v155
v_max3_f32 v242, v242, v158, v159
v_mfma_f32_16x16x32_bf16 v[132:135], a[128:131], v[32:35], v[132:135]
v_mov_b32 v241, v240
v_mov_b32 v243, v242
v_mfma_f32_16x16x32_bf16 v[148:151], a[144:147], v[32:35], 0
v_permlane16_swap_b32 v240, v241
v_permlane16_swap_b32 v242, v243
v_mfma_f32_16x16x32_bf16 v[148:151], a[148:151], v[36:39], v[148:151]
v_max_f32 v240, v240, v241
v_max_f32 v242, v242, v243
v_mfma_f32_16x16x32_bf16 v[148:151], a[152:155], v[40:43], v[148:151]
v_mov_b32 v241, v240
v_mov_b32 v243, v242
v_mfma_f32_16x16x32_bf16 v[148:151], a[156:159], v[44:47], v[148:151]
v_permlane32_swap_b32 v240, v241
v_permlane32_swap_b32 v242, v243
v_mfma_f32_16x16x32_bf16 v[144:147], a[156:159], v[28:31], v[144:147]
v_max_f32 v240, v240, v241
v_max_f32 v242, v242, v243
v_mfma_f32_16x16x32_bf16 v[144:147], a[152:155], v[24:27], v[144:147]
v_mfma_f32_16x16x32_bf16 v[144:147], a[148:151], v[20:23], v[144:147]
v_sub_f32 v88, 0, v240
v_sub_f32 v89, 0, v240
v_pk_add_f32 v[90:91], v[88:89], 0
v_pk_add_f32 v[104:105], v[116:117], v[88:89]
v_pk_add_f32 v[106:107], v[118:119], v[88:89]
v_pk_add_f32 v[136:137], v[136:137], v[88:89]
v_pk_add_f32 v[138:139], v[138:139], v[88:89]
v_pk_add_f32 v[152:153], v[152:153], v[88:89]
v_pk_add_f32 v[154:155], v[154:155], v[88:89]
v_sub_f32 v92, 0, v242
v_sub_f32 v93, 0, v242
v_pk_add_f32 v[94:95], v[92:93], 0
v_pk_add_f32 v[108:109], v[116:117], v[92:93]
v_pk_add_f32 v[110:111], v[118:119], v[92:93]
v_pk_add_f32 v[140:141], v[140:141], v[92:93]
v_pk_add_f32 v[142:143], v[142:143], v[92:93]
v_pk_add_f32 v[156:157], v[156:157], v[92:93]
v_pk_add_f32 v[158:159], v[158:159], v[92:93]
v_max3_f32 v240, v128, v129, v124
v_max3_f32 v242, v132, v133, v125
v_max3_f32 v240, v240, v130, v131
v_max3_f32 v242, v242, v134, v135
v_max3_f32 v240, v240, v144, v145
v_max3_f32 v242, v242, v148, v149
v_max3_f32 v240, v240, v146, v147
v_max3_f32 v242, v242, v150, v151
v_mov_b32 v241, v240
v_mov_b32 v243, v242
s_nop 0
v_permlane16_swap_b32 v240, v241
v_permlane16_swap_b32 v242, v243
v_max_f32 v240, v240, v241
v_max_f32 v242, v242, v243
v_mov_b32 v241, v240
v_mov_b32 v243, v242
s_nop 0
v_permlane32_swap_b32 v240, v241
v_permlane32_swap_b32 v242, v243
v_max_f32 v240, v240, v241
v_max_f32 v242, v242, v243
v_sub_f32 v80, 0, v240
v_sub_f32 v81, 0, v240
v_pk_add_f32 v[82:83], v[80:81], 0
v_pk_add_f32 v[96:97], v[116:117], v[80:81]
v_pk_add_f32 v[98:99], v[118:119], v[80:81]
v_pk_add_f32 v[128:129], v[128:129], v[80:81]
v_pk_add_f32 v[130:131], v[130:131], v[80:81]
v_pk_add_f32 v[144:145], v[144:145], v[80:81]
v_pk_add_f32 v[146:147], v[146:147], v[80:81]
v_sub_f32 v84, 0, v242
v_sub_f32 v85, 0, v242
v_pk_add_f32 v[86:87], v[84:85], 0
v_pk_add_f32 v[100:101], v[116:117], v[84:85]
v_pk_add_f32 v[102:103], v[118:119], v[84:85]
v_pk_add_f32 v[132:133], v[132:133], v[84:85]
v_pk_add_f32 v[134:135], v[134:135], v[84:85]
v_pk_add_f32 v[148:149], v[148:149], v[84:85]
v_pk_add_f32 v[150:151], v[150:151], v[84:85]
v_add_u32 v2, s82, v1
s_waitcnt vmcnt(13) lgkmcnt(0)
s_barrier
s_cmp_eq_u32 s60, 0
s_cbranch_scc1 LP0x
v_mfma_f32_16x16x32_bf16 v[164:167], a[160:163], v[32:35], v[84:87]
s_xor_b32 s74, s82, 0x10000
v_exp_f32 v128, v128
v_mfma_f32_16x16x32_bf16 v[164:167], a[164:167], v[36:39], v[164:167]
s_add_u32 s74, s74, s64
ds_read_b128 a[128:131], v2 offset:16384
ds_read_b128 a[132:135], v2 offset:17408
v_mfma_f32_16x16x32_bf16 v[164:167], a[168:171], v[40:43], v[164:167]
s_add_u32 s81, s81, 0x8000
v_exp_f32 v129, v129
v_mfma_f32_16x16x32_bf16 v[164:167], a[172:175], v[44:47], v[164:167]
s_add_u32 m0, s74, 16384
v_exp_f32 v130, v130
v_mfma_f32_16x16x32_bf16 v[172:175], a[172:175], v[76:79], v[92:95]
s_add_u32 s72, s81, 16384
v_exp_f32 v131, v131
v_mfma_f32_16x16x32_bf16 v[172:175], a[168:171], v[72:75], v[172:175]
v_exp_f32 v144, v144
v_mfma_f32_16x16x32_bf16 v[172:175], a[164:167], v[68:71], v[172:175]
s_nop 0
ds_read_b128 a[136:139], v2 offset:18432
ds_read_b128 a[140:143], v2 offset:19456
v_mfma_f32_16x16x32_bf16 v[172:175], a[160:163], v[64:67], v[172:175]
s_nop 0
ds_read_b128 a[144:147], v2 offset:20480
ds_read_b128 a[148:151], v2 offset:21504
v_mfma_f32_16x16x32_bf16 v[188:191], a[176:179], v[64:67], v[92:95]
s_nop 0
ds_read_b128 a[152:155], v2 offset:22528
ds_read_b128 a[156:159], v2 offset:23552
v_mfma_f32_16x16x32_bf16 v[188:191], a[180:183], v[68:71], v[188:191]
s_nop 0
ds_read_b128 a[192:195], v2 offset:0
ds_read_b128 a[196:199], v2 offset:1024
v_mfma_f32_16x16x32_bf16 v[188:191], a[184:187], v[72:75], v[188:191]
s_nop 0
ds_read_b128 a[200:203], v2 offset:2048
ds_read_b128 a[204:207], v2 offset:3072
v_mfma_f32_16x16x32_bf16 v[188:191], a[188:191], v[76:79], v[188:191]
s_nop 0
ds_read_b128 a[208:211], v2 offset:4096
ds_read_b128 a[212:215], v2 offset:5120
v_mfma_f32_16x16x32_bf16 v[180:183], a[188:191], v[44:47], v[84:87]
s_nop 0
ds_read_b128 a[216:219], v2 offset:6144
ds_read_b128 a[220:223], v2 offset:7168
v_mfma_f32_16x16x32_bf16 v[180:183], a[184:187], v[40:43], v[180:183]
v_cvt_pk_bf16_f32 v192, v128, v129
v_cvt_pk_bf16_f32 v193, v130, v131
v_mfma_f32_16x16x32_bf16 v[180:183], a[180:183], v[36:39], v[180:183]
buffer_load_dwordx4 v1, s[44:47], s72 offen sc1 lds
v_mfma_f32_16x16x32_bf16 v[180:183], a[176:179], v[32:35], v[180:183]
v_exp_f32 v145, v145
v_mfma_f32_16x16x32_bf16 v[160:163], a[160:163], v[16:19], v[80:83]
v_exp_f32 v146, v146
v_mfma_f32_16x16x32_bf16 v[160:163], a[164:167], v[20:23], v[160:163]
v_exp_f32 v147, v147
v_mfma_f32_16x16x32_bf16 v[160:163], a[168:171], v[24:27], v[160:163]
v_exp_f32 v136, v136
v_mfma_f32_16x16x32_bf16 v[160:163], a[172:175], v[28:31], v[160:163]
v_cvt_pk_bf16_f32 v194, v144, v145
v_cvt_pk_bf16_f32 v195, v146, v147
v_mfma_f32_16x16x32_bf16 v[168:171], a[172:175], v[60:63], v[88:91]
v_exp_f32 v137, v137
v_mfma_f32_16x16x32_bf16 v[168:171], a[168:171], v[56:59], v[168:171]
v_exp_f32 v138, v138
v_mfma_f32_16x16x32_bf16 v[168:171], a[164:167], v[52:55], v[168:171]
v_exp_f32 v139, v139
v_mfma_f32_16x16x32_bf16 v[168:171], a[160:163], v[48:51], v[168:171]
v_exp_f32 v152, v152
v_mfma_f32_16x16x32_bf16 v[184:187], a[176:179], v[48:51], v[88:91]
v_cvt_pk_bf16_f32 v200, v136, v137
v_cvt_pk_bf16_f32 v201, v138, v139
v_mfma_f32_16x16x32_bf16 v[184:187], a[180:183], v[52:55], v[184:187]
buffer_load_dwordx4 v1, s[44:47], s72 offen offset:1024 sc1 lds
v_mfma_f32_16x16x32_bf16 v[184:187], a[184:187], v[56:59], v[184:187]
v_exp_f32 v153, v153
v_mfma_f32_16x16x32_bf16 v[184:187], a[188:191], v[60:63], v[184:187]
v_exp_f32 v154, v154
v_mfma_f32_16x16x32_bf16 v[176:179], a[188:191], v[28:31], v[80:83]
v_exp_f32 v155, v155
v_mfma_f32_16x16x32_bf16 v[176:179], a[184:187], v[24:27], v[176:179]
buffer_load_dwordx4 v1, s[44:47], s72 offen offset:2048 sc1 lds
v_mfma_f32_16x16x32_bf16 v[176:179], a[180:183], v[20:23], v[176:179]
buffer_load_dwordx4 v1, s[44:47], s72 offen offset:3072 sc1 lds
v_mfma_f32_16x16x32_bf16 v[176:179], a[176:179], v[16:19], v[176:179]
s_waitcnt lgkmcnt(4)
v_exp_f32 v132, v132
v_cvt_pk_bf16_f32 v202, v152, v153
v_cvt_pk_bf16_f32 v203, v154, v155
v_exp_f32 v133, v133
v_exp_f32 v134, v134
v_cvt_pk_bf16_f32 v196, v132, v133
v_exp_f32 v135, v135
v_exp_f32 v148, v148
v_cvt_pk_bf16_f32 v197, v134, v135
v_exp_f32 v149, v149
v_exp_f32 v150, v150
v_cvt_pk_bf16_f32 v198, v148, v149
v_exp_f32 v151, v151
v_exp_f32 v140, v140
v_cvt_pk_bf16_f32 v199, v150, v151
v_exp_f32 v141, v141
v_exp_f32 v142, v142
v_cvt_pk_bf16_f32 v204, v140, v141
v_exp_f32 v143, v143
v_exp_f32 v156, v156
v_cvt_pk_bf16_f32 v205, v142, v143
v_exp_f32 v157, v157
v_exp_f32 v158, v158
v_cvt_pk_bf16_f32 v206, v156, v157
v_exp_f32 v159, v159
s_nop 0
v_cvt_pk_bf16_f32 v207, v158, v159
v_mfma_f32_16x16x32_bf16 v[224:227], v[120:123], v[192:195], 0
s_add_u32 s82, s82, 0x8000
ds_read_b128 a[160:163], v2 offset:24576
ds_read_b128 a[164:167], v2 offset:25600
v_mfma_f32_16x16x32_bf16 v[232:235], v[120:123], v[200:203], 0
s_and_b32 s82, s82, 0x1ffff
v_exp_f32 v164, v164
v_mfma_f32_16x16x32_bf16 a[0:3], a[192:195], v[192:195], 0
s_add_u32 m0, s74, 0
v_exp_f32 v165, v165
v_mfma_f32_16x16x32_bf16 a[64:67], a[192:195], v[200:203], 0
s_add_u32 s72, s81, 0
v_exp_f32 v166, v166
v_mfma_f32_16x16x32_bf16 a[68:71], a[196:199], v[200:203], 0
buffer_load_dwordx4 v1, s[44:47], s72 offen sc1 lds
v_mfma_f32_16x16x32_bf16 a[4:7], a[196:199], v[192:195], 0
v_exp_f32 v167, v167
v_mfma_f32_16x16x32_bf16 a[8:11], a[200:203], v[192:195], 0
ds_read_b128 a[168:171], v2 offset:26624
v_cvt_pk_bf16_f32 v212, v164, v165
v_mfma_f32_16x16x32_bf16 a[72:75], a[200:203], v[200:203], 0
v_exp_f32 v180, v180
v_mfma_f32_16x16x32_bf16 a[76:79], a[204:207], v[200:203], 0
v_exp_f32 v181, v181
v_mfma_f32_16x16x32_bf16 a[12:15], a[204:207], v[192:195], 0
s_waitcnt lgkmcnt(3)
ds_read_b128 a[172:175], v2 offset:27648
v_cvt_pk_bf16_f32 v213, v166, v167
v_mfma_f32_16x16x32_bf16 a[16:19], a[208:211], v[192:195], 0
v_exp_f32 v182, v182
v_mfma_f32_16x16x32_bf16 a[80:83], a[208:211], v[200:203], 0
buffer_load_dwordx4 v1, s[44:47], s72 offen offset:1024 sc1 lds
v_mfma_f32_16x16x32_bf16 a[84:87], a[212:215], v[200:203], 0
v_exp_f32 v183, v183
v_mfma_f32_16x16x32_bf16 a[20:23], a[212:215], v[192:195], 0
s_nop 0
ds_read_b128 a[176:179], v2 offset:28672
ds_read_b128 a[180:183], v2 offset:29696
v_mfma_f32_16x16x32_bf16 a[24:27], a[216:219], v[192:195], 0
v_exp_f32 v172, v172
v_mfma_f32_16x16x32_bf16 a[88:91], a[216:219], v[200:203], 0
s_nop 0
ds_read_b128 a[184:187], v2 offset:30720
ds_read_b128 a[188:191], v2 offset:31744
v_mfma_f32_16x16x32_bf16 a[92:95], a[220:223], v[200:203], 0
s_nop 0
ds_read_b128 a[224:227], v2 offset:8192
ds_read_b128 a[228:231], v2 offset:9216
v_mfma_f32_16x16x32_bf16 a[28:31], a[220:223], v[192:195], 0
s_nop 0
ds_read_b128 a[232:235], v2 offset:10240
ds_read_b128 a[236:239], v2 offset:11264
v_mfma_f32_16x16x32_bf16 v[128:131], a[128:131], v[16:19], v[80:83]
s_nop 0
ds_read_b128 a[240:243], v2 offset:12288
ds_read_b128 a[244:247], v2 offset:13312
v_mfma_f32_16x16x32_bf16 v[128:131], a[132:135], v[20:23], v[128:131]
s_nop 0
ds_read_b128 a[248:251], v2 offset:14336
ds_read_b128 a[252:255], v2 offset:15360
v_mfma_f32_16x16x32_bf16 v[128:131], a[136:139], v[24:27], v[128:131]
v_cvt_pk_bf16_f32 v214, v180, v181
v_cvt_pk_bf16_f32 v215, v182, v183
v_mfma_f32_16x16x32_bf16 v[128:131], a[140:143], v[28:31], v[128:131]
v_exp_f32 v173, v173
v_mfma_f32_16x16x32_bf16 v[136:139], a[140:143], v[60:63], v[88:91]
v_exp_f32 v174, v174
v_mfma_f32_16x16x32_bf16 v[136:139], a[136:139], v[56:59], v[136:139]
buffer_load_dwordx4 v1, s[44:47], s72 offen offset:2048 sc1 lds
v_mfma_f32_16x16x32_bf16 v[136:139], a[132:135], v[52:55], v[136:139]
v_exp_f32 v175, v175
v_mfma_f32_16x16x32_bf16 v[136:139], a[128:131], v[48:51], v[136:139]
v_exp_f32 v188, v188
v_mfma_f32_16x16x32_bf16 v[152:155], a[144:147], v[48:51], v[88:91]
v_cvt_pk_bf16_f32 v220, v172, v173
v_cvt_pk_bf16_f32 v221, v174, v175
v_mfma_f32_16x16x32_bf16 v[152:155], a[148:151], v[52:55], v[152:155]
v_exp_f32 v189, v189
v_mfma_f32_16x16x32_bf16 v[152:155], a[152:155], v[56:59], v[152:155]
v_exp_f32 v190, v190
v_mfma_f32_16x16x32_bf16 v[152:155], a[156:159], v[60:63], v[152:155]
buffer_load_dwordx4 v1, s[44:47], s72 offen offset:3072 sc1 lds
v_mfma_f32_16x16x32_bf16 v[144:147], a[156:159], v[28:31], v[80:83]
s_add_u32 s66, s58, 1
v_exp_f32 v191, v191
v_mfma_f32_16x16x32_bf16 v[144:147], a[152:155], v[24:27], v[144:147]
s_and_b32 s66, s66, 3
v_exp_f32 v160, v160
v_mfma_f32_16x16x32_bf16 v[144:147], a[148:151], v[20:23], v[144:147]
s_mul_i32 s66, s66, 4160
v_cvt_pk_bf16_f32 v222, v188, v189
v_cvt_pk_bf16_f32 v223, v190, v191
v_mfma_f32_16x16x32_bf16 v[144:147], a[144:147], v[16:19], v[144:147]
s_add_u32 m0, s66, 131104
v_exp_f32 v161, v161
v_mfma_f32_16x16x32_bf16 v[132:135], a[128:131], v[32:35], v[84:87]
s_add_u32 s72, s93, 0x2
buffer_load_dwordx4 v1, s[36:39], s72 offen lds
v_mfma_f32_16x16x32_bf16 v[132:135], a[132:135], v[36:39], v[132:135]
v_exp_f32 v162, v162
v_mfma_f32_16x16x32_bf16 v[132:135], a[136:139], v[40:43], v[132:135]
v_exp_f32 v163, v163
v_mfma_f32_16x16x32_bf16 v[132:135], a[140:143], v[44:47], v[132:135]
v_exp_f32 v176, v176
v_mfma_f32_16x16x32_bf16 v[140:143], a[140:143], v[76:79], v[92:95]
v_cvt_pk_bf16_f32 v208, v160, v161
v_cvt_pk_bf16_f32 v209, v162, v163
v_mfma_f32_16x16x32_bf16 v[140:143], a[136:139], v[72:75], v[140:143]
v_exp_f32 v177, v177
v_mfma_f32_16x16x32_bf16 v[140:143], a[132:135], v[68:71], v[140:143]
buffer_load_dwordx4 v1, s[36:39], s72 offen offset:1024 lds
v_mfma_f32_16x16x32_bf16 v[140:143], a[128:131], v[64:67], v[140:143]
v_exp_f32 v178, v178
v_mfma_f32_16x16x32_bf16 v[156:159], a[144:147], v[64:67], v[92:95]
v_exp_f32 v179, v179
v_mfma_f32_16x16x32_bf16 v[156:159], a[148:151], v[68:71], v[156:159]
v_exp_f32 v168, v168
v_mfma_f32_16x16x32_bf16 v[156:159], a[152:155], v[72:75], v[156:159]
v_cvt_pk_bf16_f32 v210, v176, v177
v_cvt_pk_bf16_f32 v211, v178, v179
v_mfma_f32_16x16x32_bf16 v[156:159], a[156:159], v[76:79], v[156:159]
v_exp_f32 v169, v169
v_mfma_f32_16x16x32_bf16 v[148:151], a[156:159], v[44:47], v[84:87]
buffer_load_dwordx4 v1, s[36:39], s72 offen offset:2048 lds
v_mfma_f32_16x16x32_bf16 v[148:151], a[152:155], v[40:43], v[148:151]
buffer_load_dwordx4 v1, s[36:39], s72 offen offset:3072 lds
v_mfma_f32_16x16x32_bf16 v[148:151], a[148:151], v[36:39], v[148:151]
s_waitcnt vmcnt(12) lgkmcnt(4)
v_exp_f32 v170, v170
v_mfma_f32_16x16x32_bf16 v[148:151], a[144:147], v[32:35], v[148:151]
s_barrier
v_exp_f32 v171, v171
v_add_u32 v2, s82, v1
v_cvt_pk_bf16_f32 v216, v168, v169
v_exp_f32 v184, v184
v_cvt_pk_bf16_f32 v217, v170, v171
v_exp_f32 v185, v185
v_exp_f32 v186, v186
v_cvt_pk_bf16_f32 v218, v184, v185
v_exp_f32 v187, v187
s_nop 0
v_cvt_pk_bf16_f32 v219, v186, v187
s_lshl_b32 s75, s59, 4
s_and_b32 s76, s84, 15
s_add_u32 s75, s75, s76
s_lshl_b32 s75, s75, 14
s_cmp_ge_u32 s60, 4
s_cselect_b32 s75, s75, 0x40001000
s_lshl_b32 s83, s60, 1
s_sub_u32 s83, 2, s83
s_cmp_eq_u32 s83, 0
s_cbranch_scc1 LLT1
.p2align 5
s_nop 0
s_nop 0
LloopI:
v_mfma_f32_16x16x32_bf16 v[228:231], v[120:123], v[196:199], v[228:231]
s_xor_b32 s74, s82, 0x10000
v_exp_f32 v128, v128
v_mfma_f32_16x16x32_bf16 v[228:231], v[120:123], v[212:215], v[228:231]
s_add_u32 s74, s74, s64
ds_read_b128 a[128:131], v2 offset:16384
v_add_u32 v15, s75, v3
v_mfma_f32_16x16x32_bf16 v[236:239], v[120:123], v[204:207], v[236:239]
s_add_u32 s81, s81, 0x8000
v_exp_f32 v129, v129
v_mfma_f32_16x16x32_bf16 v[236:239], v[120:123], v[220:223], v[236:239]
s_add_u32 m0, s74, 16384
v_exp_f32 v130, v130
v_mfma_f32_16x16x32_bf16 a[32:35], a[192:195], v[196:199], a[32:35]
s_add_u32 s72, s81, 16384
ds_read_b128 a[132:135], v2 offset:17408
v_cvt_pk_bf16_f32 v192, v128, v129
v_mfma_f32_16x16x32_bf16 a[32:35], a[224:227], v[212:215], a[32:35]
v_exp_f32 v131, v131
v_mfma_f32_16x16x32_bf16 a[96:99], a[224:227], v[220:223], a[96:99]
v_exp_f32 v144, v144
v_mfma_f32_16x16x32_bf16 a[96:99], a[192:195], v[204:207], a[96:99]
ds_read_b128 a[136:139], v2 offset:18432
v_cvt_pk_bf16_f32 v193, v130, v131
v_mfma_f32_16x16x32_bf16 a[100:103], a[196:199], v[204:207], a[100:103]
buffer_load_dwordx4 v1, s[44:47], s72 offen sc1 lds
v_mfma_f32_16x16x32_bf16 a[100:103], a[228:231], v[220:223], a[100:103]
v_exp_f32 v145, v145
v_mfma_f32_16x16x32_bf16 a[36:39], a[228:231], v[212:215], a[36:39]
v_exp_f32 v146, v146
v_mfma_f32_16x16x32_bf16 a[36:39], a[196:199], v[196:199], a[36:39]
ds_read_b128 a[140:143], v2 offset:19456
v_cvt_pk_bf16_f32 v194, v144, v145
v_mfma_f32_16x16x32_bf16 a[40:43], a[200:203], v[196:199], a[40:43]
v_exp_f32 v147, v147
v_mfma_f32_16x16x32_bf16 a[40:43], a[232:235], v[212:215], a[40:43]
v_exp_f32 v136, v136
v_mfma_f32_16x16x32_bf16 a[104:107], a[232:235], v[220:223], a[104:107]
ds_read_b128 a[144:147], v2 offset:20480
v_cvt_pk_bf16_f32 v195, v146, v147
v_mfma_f32_16x16x32_bf16 a[104:107], a[200:203], v[204:207], a[104:107]
v_exp_f32 v137, v137
v_mfma_f32_16x16x32_bf16 a[108:111], a[204:207], v[204:207], a[108:111]
v_exp_f32 v138, v138
v_mfma_f32_16x16x32_bf16 a[108:111], a[236:239], v[220:223], a[108:111]
ds_read_b128 a[148:151], v2 offset:21504
v_cvt_pk_bf16_f32 v200, v136, v137
v_mfma_f32_16x16x32_bf16 a[44:47], a[236:239], v[212:215], a[44:47]
v_exp_f32 v139, v139
v_mfma_f32_16x16x32_bf16 a[44:47], a[204:207], v[196:199], a[44:47]
v_exp_f32 v152, v152
v_mfma_f32_16x16x32_bf16 a[48:51], a[208:211], v[196:199], a[48:51]
s_waitcnt lgkmcnt(6)
ds_read_b128 a[152:155], v2 offset:22528
v_cvt_pk_bf16_f32 v201, v138, v139
v_mfma_f32_16x16x32_bf16 a[48:51], a[240:243], v[212:215], a[48:51]
buffer_load_dwordx4 v1, s[44:47], s72 offen offset:1024 sc1 lds
v_mfma_f32_16x16x32_bf16 a[112:115], a[240:243], v[220:223], a[112:115]
v_exp_f32 v153, v153
v_mfma_f32_16x16x32_bf16 a[112:115], a[208:211], v[204:207], a[112:115]
v_exp_f32 v154, v154
v_mfma_f32_16x16x32_bf16 a[116:119], a[212:215], v[204:207], a[116:119]
ds_read_b128 a[156:159], v2 offset:23552
v_cvt_pk_bf16_f32 v202, v152, v153
v_mfma_f32_16x16x32_bf16 a[116:119], a[244:247], v[220:223], a[116:119]
v_exp_f32 v155, v155
v_mfma_f32_16x16x32_bf16 a[52:55], a[244:247], v[212:215], a[52:55]
v_exp_f32 v132, v132
v_mfma_f32_16x16x32_bf16 a[52:55], a[212:215], v[196:199], a[52:55]
ds_read_b128 a[192:195], v2 offset:0
v_cvt_pk_bf16_f32 v203, v154, v155
v_mfma_f32_16x16x32_bf16 a[56:59], a[216:219], v[196:199], a[56:59]
v_exp_f32 v133, v133
v_mfma_f32_16x16x32_bf16 a[56:59], a[248:251], v[212:215], a[56:59]
v_exp_f32 v134, v134
v_mfma_f32_16x16x32_bf16 a[120:123], a[248:251], v[220:223], a[120:123]
ds_read_b128 a[196:199], v2 offset:1024
v_mfma_f32_16x16x32_bf16 a[120:123], a[216:219], v[204:207], a[120:123]
v_exp_f32 v135, v135
v_mfma_f32_16x16x32_bf16 a[124:127], a[220:223], v[204:207], a[124:127]
v_exp_f32 v148, v148
v_mfma_f32_16x16x32_bf16 a[124:127], a[252:255], v[220:223], a[124:127]
ds_read_b128 a[200:203], v2 offset:2048
v_mfma_f32_16x16x32_bf16 a[60:63], a[252:255], v[212:215], a[60:63]
buffer_load_dwordx4 v1, s[44:47], s72 offen offset:2048 sc1 lds
v_mfma_f32_16x16x32_bf16 a[60:63], a[220:223], v[196:199], a[60:63]
ds_read_b128 a[204:207], v2 offset:3072
v_cvt_pk_bf16_f32 v196, v132, v133
v_mfma_f32_16x16x32_bf16 v[164:167], a[160:163], v[32:35], v[84:87]
v_exp_f32 v149, v149
v_mfma_f32_16x16x32_bf16 v[164:167], a[164:167], v[36:39], v[164:167]
v_exp_f32 v150, v150
v_mfma_f32_16x16x32_bf16 v[164:167], a[168:171], v[40:43], v[164:167]
ds_read_b128 a[208:211], v2 offset:4096
v_cvt_pk_bf16_f32 v197, v134, v135
v_mfma_f32_16x16x32_bf16 v[164:167], a[172:175], v[44:47], v[164:167]
v_exp_f32 v151, v151
v_mfma_f32_16x16x32_bf16 v[172:175], a[172:175], v[76:79], v[92:95]
v_exp_f32 v140, v140
v_mfma_f32_16x16x32_bf16 v[172:175], a[168:171], v[72:75], v[172:175]
ds_read_b128 a[212:215], v2 offset:5120
v_cvt_pk_bf16_f32 v198, v148, v149
v_mfma_f32_16x16x32_bf16 v[172:175], a[164:167], v[68:71], v[172:175]
v_exp_f32 v141, v141
v_mfma_f32_16x16x32_bf16 v[172:175], a[160:163], v[64:67], v[172:175]
v_exp_f32 v142, v142
v_mfma_f32_16x16x32_bf16 v[188:191], a[176:179], v[64:67], v[92:95]
ds_read_b128 a[216:219], v2 offset:6144
v_cvt_pk_bf16_f32 v199, v150, v151
v_mfma_f32_16x16x32_bf16 v[188:191], a[180:183], v[68:71], v[188:191]
v_exp_f32 v143, v143
v_mfma_f32_16x16x32_bf16 v[188:191], a[184:187], v[72:75], v[188:191]
v_exp_f32 v156, v156
v_mfma_f32_16x16x32_bf16 v[188:191], a[188:191], v[76:79], v[188:191]
ds_read_b128 a[220:223], v2 offset:7168
v_cvt_pk_bf16_f32 v204, v140, v141
v_mfma_f32_16x16x32_bf16 v[180:183], a[188:191], v[44:47], v[84:87]
buffer_load_dwordx4 v1, s[44:47], s72 offen offset:3072 sc1 lds
v_mfma_f32_16x16x32_bf16 v[180:183], a[184:187], v[40:43], v[180:183]
v_exp_f32 v157, v157
v_mfma_f32_16x16x32_bf16 v[180:183], a[180:183], v[36:39], v[180:183]
v_exp_f32 v158, v158
v_mfma_f32_16x16x32_bf16 v[180:183], a[176:179], v[32:35], v[180:183]
v_cvt_pk_bf16_f32 v205, v142, v143
v_cvt_pk_bf16_f32 v206, v156, v157
v_mfma_f32_16x16x32_bf16 v[160:163], a[160:163], v[16:19], v[80:83]
v_exp_f32 v159, v159
v_mfma_f32_16x16x32_bf16 v[160:163], a[164:167], v[20:23], v[160:163]
v_cvt_pk_bf16_f32 v207, v158, v159
v_mfma_f32_16x16x32_bf16 v[160:163], a[168:171], v[24:27], v[160:163]
v_mfma_f32_16x16x32_bf16 v[160:163], a[172:175], v[28:31], v[160:163]
v_mfma_f32_16x16x32_bf16 v[168:171], a[172:175], v[60:63], v[88:91]
v_mfma_f32_16x16x32_bf16 v[168:171], a[168:171], v[56:59], v[168:171]
v_mfma_f32_16x16x32_bf16 v[168:171], a[164:167], v[52:55], v[168:171]
v_mfma_f32_16x16x32_bf16 v[168:171], a[160:163], v[48:51], v[168:171]
v_mfma_f32_16x16x32_bf16 v[184:187], a[176:179], v[48:51], v[88:91]
v_mfma_f32_16x16x32_bf16 v[184:187], a[180:183], v[52:55], v[184:187]
v_mfma_f32_16x16x32_bf16 v[184:187], a[184:187], v[56:59], v[184:187]
v_mfma_f32_16x16x32_bf16 v[184:187], a[188:191], v[60:63], v[184:187]
v_mfma_f32_16x16x32_bf16 v[176:179], a[188:191], v[28:31], v[80:83]
v_mfma_f32_16x16x32_bf16 v[176:179], a[184:187], v[24:27], v[176:179]
v_mfma_f32_16x16x32_bf16 v[176:179], a[180:183], v[20:23], v[176:179]
v_mfma_f32_16x16x32_bf16 v[176:179], a[176:179], v[16:19], v[176:179]
s_waitcnt lgkmcnt(4)
v_mfma_f32_16x16x32_bf16 v[224:227], v[120:123], v[208:211], v[224:227]
s_add_u32 s82, s82, 0x8000
ds_read_b128 a[160:163], v2 offset:24576
v_mfma_f32_16x16x32_bf16 v[224:227], v[120:123], v[192:195], v[224:227]
s_and_b32 s82, s82, 0x1ffff
v_exp_f32 v164, v164
v_mfma_f32_16x16x32_bf16 v[232:235], v[120:123], v[216:219], v[232:235]
s_add_u32 m0, s74, 0
v_exp_f32 v165, v165
v_mfma_f32_16x16x32_bf16 v[232:235], v[120:123], v[200:203], v[232:235]
s_add_u32 s72, s81, 0
ds_read_b128 a[164:167], v2 offset:25600
v_cvt_pk_bf16_f32 v212, v164, v165
v_mfma_f32_16x16x32_bf16 a[0:3], a[224:227], v[208:211], a[0:3]
v_exp_f32 v166, v166
v_mfma_f32_16x16x32_bf16 a[0:3], a[192:195], v[192:195], a[0:3]
v_exp_f32 v167, v167
v_mfma_f32_16x16x32_bf16 a[64:67], a[192:195], v[200:203], a[64:67]
buffer_load_dwordx4 v1, s[44:47], s72 offen sc1 lds
v_mfma_f32_16x16x32_bf16 a[64:67], a[224:227], v[216:219], a[64:67]
ds_read_b128 a[168:171], v2 offset:26624
v_cvt_pk_bf16_f32 v213, v166, v167
v_mfma_f32_16x16x32_bf16 a[68:71], a[228:231], v[216:219], a[68:71]
v_exp_f32 v180, v180
v_mfma_f32_16x16x32_bf16 a[68:71], a[196:199], v[200:203], a[68:71]
v_exp_f32 v181, v181
v_mfma_f32_16x16x32_bf16 a[4:7], a[196:199], v[192:195], a[4:7]
ds_read_b128 a[172:175], v2 offset:27648
v_cvt_pk_bf16_f32 v214, v180, v181
v_mfma_f32_16x16x32_bf16 a[4:7], a[228:231], v[208:211], a[4:7]
v_exp_f32 v182, v182
v_mfma_f32_16x16x32_bf16 a[8:11], a[232:235], v[208:211], a[8:11]
v_exp_f32 v183, v183
v_mfma_f32_16x16x32_bf16 a[8:11], a[200:203], v[192:195], a[8:11]
ds_read_b128 a[176:179], v2 offset:28672
v_cvt_pk_bf16_f32 v215, v182, v183
v_mfma_f32_16x16x32_bf16 a[72:75], a[200:203], v[200:203], a[72:75]
v_exp_f32 v172, v172
v_mfma_f32_16x16x32_bf16 a[72:75], a[232:235], v[216:219], a[72:75]
v_exp_f32 v173, v173
v_mfma_f32_16x16x32_bf16 a[76:79], a[236:239], v[216:219], a[76:79]
ds_read_b128 a[180:183], v2 offset:29696
v_cvt_pk_bf16_f32 v220, v172, v173
v_mfma_f32_16x16x32_bf16 a[76:79], a[204:207], v[200:203], a[76:79]
buffer_load_dwordx4 v1, s[44:47], s72 offen offset:1024 sc1 lds
v_mfma_f32_16x16x32_bf16 a[12:15], a[204:207], v[192:195], a[12:15]
v_exp_f32 v174, v174
v_mfma_f32_16x16x32_bf16 a[12:15], a[236:239], v[208:211], a[12:15]
v_exp_f32 v175, v175
v_mfma_f32_16x16x32_bf16 a[16:19], a[240:243], v[208:211], a[16:19]
s_waitcnt lgkmcnt(6)
ds_read_b128 a[184:187], v2 offset:30720
v_cvt_pk_bf16_f32 v221, v174, v175
v_mfma_f32_16x16x32_bf16 a[16:19], a[208:211], v[192:195], a[16:19]
v_exp_f32 v188, v188
v_mfma_f32_16x16x32_bf16 a[80:83], a[208:211], v[200:203], a[80:83]
v_exp_f32 v189, v189
v_mfma_f32_16x16x32_bf16 a[80:83], a[240:243], v[216:219], a[80:83]
ds_read_b128 a[188:191], v2 offset:31744
v_cvt_pk_bf16_f32 v222, v188, v189
v_mfma_f32_16x16x32_bf16 a[84:87], a[244:247], v[216:219], a[84:87]
v_exp_f32 v190, v190
v_mfma_f32_16x16x32_bf16 a[84:87], a[212:215], v[200:203], a[84:87]
v_exp_f32 v191, v191
v_mfma_f32_16x16x32_bf16 a[20:23], a[212:215], v[192:195], a[20:23]
ds_read_b128 a[224:227], v2 offset:8192
v_cvt_pk_bf16_f32 v223, v190, v191
v_mfma_f32_16x16x32_bf16 a[20:23], a[244:247], v[208:211], a[20:23]
v_exp_f32 v160, v160
v_mfma_f32_16x16x32_bf16 a[24:27], a[248:251], v[208:211], a[24:27]
buffer_load_dwordx4 v1, s[44:47], s72 offen offset:2048 sc1 lds
v_mfma_f32_16x16x32_bf16 a[24:27], a[216:219], v[192:195], a[24:27]
v_exp_f32 v161, v161
v_mfma_f32_16x16x32_bf16 a[88:91], a[216:219], v[200:203], a[88:91]
ds_read_b128 a[228:231], v2 offset:9216
v_mfma_f32_16x16x32_bf16 a[88:91], a[248:251], v[216:219], a[88:91]
v_exp_f32 v162, v162
v_mfma_f32_16x16x32_bf16 a[92:95], a[252:255], v[216:219], a[92:95]
v_exp_f32 v163, v163
v_mfma_f32_16x16x32_bf16 a[92:95], a[220:223], v[200:203], a[92:95]
ds_read_b128 a[232:235], v2 offset:10240
v_mfma_f32_16x16x32_bf16 a[28:31], a[220:223], v[192:195], a[28:31]
v_exp_f32 v176, v176
v_mfma_f32_16x16x32_bf16 a[28:31], a[252:255], v[208:211], a[28:31]
ds_read_b128 a[236:239], v2 offset:11264
v_cvt_pk_bf16_f32 v208, v160, v161
v_mfma_f32_16x16x32_bf16 v[128:131], a[128:131], v[16:19], v[80:83]
v_exp_f32 v177, v177
v_mfma_f32_16x16x32_bf16 v[128:131], a[132:135], v[20:23], v[128:131]
v_exp_f32 v178, v178
v_mfma_f32_16x16x32_bf16 v[128:131], a[136:139], v[24:27], v[128:131]
ds_read_b128 a[240:243], v2 offset:12288
v_cvt_pk_bf16_f32 v209, v162, v163
v_mfma_f32_16x16x32_bf16 v[128:131], a[140:143], v[28:31], v[128:131]
Lstub1:
s_cbranch_execz Lstub5
buffer_load_dwordx4 v1, s[44:47], s72 offen offset:3072 sc1 lds
v_mfma_f32_16x16x32_bf16 v[136:139], a[140:143], v[60:63], v[88:91]
s_add_u32 s75, s75, 0x1000
v_exp_f32 v179, v179
v_mfma_f32_16x16x32_bf16 v[136:139], a[136:139], v[56:59], v[136:139]
s_and_b32 s76, s75, 0x3000
v_exp_f32 v168, v168
v_mfma_f32_16x16x32_bf16 v[136:139], a[132:135], v[52:55], v[136:139]
s_cselect_b32 s75, s75, 0x40001000
ds_read_b128 a[244:247], v2 offset:13312
v_cvt_pk_bf16_f32 v210, v176, v177
v_mfma_f32_16x16x32_bf16 v[136:139], a[128:131], v[48:51], v[136:139]
v_exp_f32 v169, v169
v_mfma_f32_16x16x32_bf16 v[152:155], a[144:147], v[48:51], v[88:91]
v_exp_f32 v170, v170
v_mfma_f32_16x16x32_bf16 v[152:155], a[148:151], v[52:55], v[152:155]
ds_read_b128 a[248:251], v2 offset:14336
v_cvt_pk_bf16_f32 v211, v178, v179
v_mfma_f32_16x16x32_bf16 v[152:155], a[152:155], v[56:59], v[152:155]
v_exp_f32 v171, v171
v_mfma_f32_16x16x32_bf16 v[152:155], a[156:159], v[60:63], v[152:155]
v_exp_f32 v184, v184
v_mfma_f32_16x16x32_bf16 v[144:147], a[156:159], v[28:31], v[80:83]
ds_read_b128 a[252:255], v2 offset:15360
v_cvt_pk_bf16_f32 v216, v168, v169
v_mfma_f32_16x16x32_bf16 v[144:147], a[152:155], v[24:27], v[144:147]
buffer_load_dword v4, v15, s[24:27], 0 offen
v_mfma_f32_16x16x32_bf16 v[144:147], a[148:151], v[20:23], v[144:147]
v_exp_f32 v185, v185
v_mfma_f32_16x16x32_bf16 v[144:147], a[144:147], v[16:19], v[144:147]
v_exp_f32 v186, v186
v_mfma_f32_16x16x32_bf16 v[132:135], a[128:131], v[32:35], v[84:87]
v_cvt_pk_bf16_f32 v217, v170, v171
v_cvt_pk_bf16_f32 v218, v184, v185
v_mfma_f32_16x16x32_bf16 v[132:135], a[132:135], v[36:39], v[132:135]
v_exp_f32 v187, v187
v_mfma_f32_16x16x32_bf16 v[132:135], a[136:139], v[40:43], v[132:135]
v_cvt_pk_bf16_f32 v219, v186, v187
v_add_u32 v2, s82, v1
v_mfma_f32_16x16x32_bf16 v[132:135], a[140:143], v[44:47], v[132:135]
v_mfma_f32_16x16x32_bf16 v[140:143], a[140:143], v[76:79], v[92:95]
v_mfma_f32_16x16x32_bf16 v[140:143], a[136:139], v[72:75], v[140:143]
v_mfma_f32_16x16x32_bf16 v[140:143], a[132:135], v[68:71], v[140:143]
v_mfma_f32_16x16x32_bf16 v[140:143], a[128:131], v[64:67], v[140:143]
v_mfma_f32_16x16x32_bf16 v[156:159], a[144:147], v[64:67], v[92:95]
v_mfma_f32_16x16x32_bf16 v[156:159], a[148:151], v[68:71], v[156:159]
v_mfma_f32_16x16x32_bf16 v[156:159], a[152:155], v[72:75], v[156:159]
v_mfma_f32_16x16x32_bf16 v[156:159], a[156:159], v[76:79], v[156:159]
v_mfma_f32_16x16x32_bf16 v[148:151], a[156:159], v[44:47], v[84:87]
s_waitcnt vmcnt(9) lgkmcnt(4)
v_mfma_f32_16x16x32_bf16 v[148:151], a[152:155], v[40:43], v[148:151]
s_barrier
v_mfma_f32_16x16x32_bf16 v[148:151], a[148:151], v[36:39], v[148:151]
s_add_u32 s83, s83, 1
v_mfma_f32_16x16x32_bf16 v[148:151], a[144:147], v[32:35], v[148:151]
s_cbranch_scc0 LloopI
LLT1:
Lstub2:
s_cbranch_execz Lstub6
v_mfma_f32_16x16x32_bf16 v[228:231], v[120:123], v[196:199], v[228:231]
s_xor_b32 s74, s82, 0x10000
v_exp_f32 v128, v128
v_mfma_f32_16x16x32_bf16 v[228:231], v[120:123], v[212:215], v[228:231]
s_add_u32 s74, s74, s64
ds_read_b128 a[128:131], v2 offset:16384
v_mfma_f32_16x16x32_bf16 v[236:239], v[120:123], v[204:207], v[236:239]
s_add_u32 s81, s81, 0x8000
v_exp_f32 v129, v129
v_mfma_f32_16x16x32_bf16 v[236:239], v[120:123], v[220:223], v[236:239]
s_add_u32 m0, s74, 16384
v_exp_f32 v130, v130
v_mfma_f32_16x16x32_bf16 a[32:35], a[192:195], v[196:199], a[32:35]
s_add_u32 s72, s81, 16384
ds_read_b128 a[132:135], v2 offset:17408
v_cvt_pk_bf16_f32 v192, v128, v129
v_mfma_f32_16x16x32_bf16 a[32:35], a[224:227], v[212:215], a[32:35]
v_exp_f32 v131, v131
v_mfma_f32_16x16x32_bf16 a[96:99], a[224:227], v[220:223], a[96:99]
v_exp_f32 v144, v144
v_mfma_f32_16x16x32_bf16 a[96:99], a[192:195], v[204:207], a[96:99]
ds_read_b128 a[136:139], v2 offset:18432
v_cvt_pk_bf16_f32 v193, v130, v131
v_mfma_f32_16x16x32_bf16 a[100:103], a[196:199], v[204:207], a[100:103]
buffer_load_dwordx4 v1, s[44:47], s72 offen sc1 lds
v_mfma_f32_16x16x32_bf16 a[100:103], a[228:231], v[220:223], a[100:103]
v_exp_f32 v145, v145
v_mfma_f32_16x16x32_bf16 a[36:39], a[228:231], v[212:215], a[36:39]
v_exp_f32 v146, v146
v_mfma_f32_16x16x32_bf16 a[36:39], a[196:199], v[196:199], a[36:39]
ds_read_b128 a[140:143], v2 offset:19456
v_cvt_pk_bf16_f32 v194, v144, v145
v_mfma_f32_16x16x32_bf16 a[40:43], a[200:203], v[196:199], a[40:43]
v_exp_f32 v147, v147
v_mfma_f32_16x16x32_bf16 a[40:43], a[232:235], v[212:215], a[40:43]
v_exp_f32 v136, v136
v_mfma_f32_16x16x32_bf16 a[104:107], a[232:235], v[220:223], a[104:107]
ds_read_b128 a[144:147], v2 offset:20480
v_cvt_pk_bf16_f32 v195, v146, v147
v_mfma_f32_16x16x32_bf16 a[104:107], a[200:203], v[204:207], a[104:107]
v_exp_f32 v137, v137
v_mfma_f32_16x16x32_bf16 a[108:111], a[204:207], v[204:207], a[108:111]
v_exp_f32 v138, v138
v_mfma_f32_16x16x32_bf16 a[108:111], a[236:239], v[220:223], a[108:111]
ds_read_b128 a[148:151], v2 offset:21504
v_cvt_pk_bf16_f32 v200, v136, v137
v_mfma_f32_16x16x32_bf16 a[44:47], a[236:239], v[212:215], a[44:47]
v_exp_f32 v139, v139
v_mfma_f32_16x16x32_bf16 a[44:47], a[204:207], v[196:199], a[44:47]
v_exp_f32 v152, v152
v_mfma_f32_16x16x32_bf16 a[48:51], a[208:211], v[196:199], a[48:51]
s_waitcnt lgkmcnt(6)
ds_read_b128 a[152:155], v2 offset:22528
v_cvt_pk_bf16_f32 v201, v138, v139
v_mfma_f32_16x16x32_bf16 a[48:51], a[240:243], v[212:215], a[48:51]
buffer_load_dwordx4 v1, s[44:47], s72 offen offset:1024 sc1 lds
v_mfma_f32_16x16x32_bf16 a[112:115], a[240:243], v[220:223], a[112:115]
v_exp_f32 v153, v153
v_mfma_f32_16x16x32_bf16 a[112:115], a[208:211], v[204:207], a[112:115]
v_exp_f32 v154, v154
v_mfma_f32_16x16x32_bf16 a[116:119], a[212:215], v[204:207], a[116:119]
ds_read_b128 a[156:159], v2 offset:23552
v_cvt_pk_bf16_f32 v202, v152, v153
v_mfma_f32_16x16x32_bf16 a[116:119], a[244:247], v[220:223], a[116:119]
v_exp_f32 v155, v155
v_mfma_f32_16x16x32_bf16 a[52:55], a[244:247], v[212:215], a[52:55]
v_exp_f32 v132, v132
v_mfma_f32_16x16x32_bf16 a[52:55], a[212:215], v[196:199], a[52:55]
ds_read_b128 a[192:195], v2 offset:0
v_cvt_pk_bf16_f32 v203, v154, v155
v_mfma_f32_16x16x32_bf16 a[56:59], a[216:219], v[196:199], a[56:59]
v_exp_f32 v133, v133
v_mfma_f32_16x16x32_bf16 a[56:59], a[248:251], v[212:215], a[56:59]
v_exp_f32 v134, v134
v_mfma_f32_16x16x32_bf16 a[120:123], a[248:251], v[220:223], a[120:123]
ds_read_b128 a[196:199], v2 offset:1024
v_mfma_f32_16x16x32_bf16 a[120:123], a[216:219], v[204:207], a[120:123]
v_exp_f32 v135, v135
v_mfma_f32_16x16x32_bf16 a[124:127], a[220:223], v[204:207], a[124:127]
v_exp_f32 v148, v148
v_mfma_f32_16x16x32_bf16 a[124:127], a[252:255], v[220:223], a[124:127]
ds_read_b128 a[200:203], v2 offset:2048
v_mfma_f32_16x16x32_bf16 a[60:63], a[252:255], v[212:215], a[60:63]
buffer_load_dwordx4 v1, s[44:47], s72 offen offset:2048 sc1 lds
v_mfma_f32_16x16x32_bf16 a[60:63], a[220:223], v[196:199], a[60:63]
ds_read_b128 a[204:207], v2 offset:3072
v_cvt_pk_bf16_f32 v196, v132, v133
v_mfma_f32_16x16x32_bf16 v[164:167], a[160:163], v[32:35], v[84:87]
v_exp_f32 v149, v149
v_mfma_f32_16x16x32_bf16 v[164:167], a[164:167], v[36:39], v[164:167]
v_exp_f32 v150, v150
v_mfma_f32_16x16x32_bf16 v[164:167], a[168:171], v[40:43], v[164:167]
ds_read_b128 a[208:211], v2 offset:4096
v_cvt_pk_bf16_f32 v197, v134, v135
v_mfma_f32_16x16x32_bf16 v[164:167], a[172:175], v[44:47], v[164:167]
v_exp_f32 v151, v151
v_mfma_f32_16x16x32_bf16 v[172:175], a[172:175], v[76:79], v[92:95]
v_exp_f32 v140, v140
v_mfma_f32_16x16x32_bf16 v[172:175], a[168:171], v[72:75], v[172:175]
ds_read_b128 a[212:215], v2 offset:5120
v_cvt_pk_bf16_f32 v198, v148, v149
v_mfma_f32_16x16x32_bf16 v[172:175], a[164:167], v[68:71], v[172:175]
v_exp_f32 v141, v141
v_mfma_f32_16x16x32_bf16 v[172:175], a[160:163], v[64:67], v[172:175]
v_exp_f32 v142, v142
v_mfma_f32_16x16x32_bf16 v[188:191], a[176:179], v[64:67], v[92:95]
ds_read_b128 a[216:219], v2 offset:6144
v_cvt_pk_bf16_f32 v199, v150, v151
v_mfma_f32_16x16x32_bf16 v[188:191], a[180:183], v[68:71], v[188:191]
v_exp_f32 v143, v143
v_mfma_f32_16x16x32_bf16 v[188:191], a[184:187], v[72:75], v[188:191]
v_exp_f32 v156, v156
v_mfma_f32_16x16x32_bf16 v[188:191], a[188:191], v[76:79], v[188:191]
ds_read_b128 a[220:223], v2 offset:7168
v_cvt_pk_bf16_f32 v204, v140, v141
v_mfma_f32_16x16x32_bf16 v[180:183], a[188:191], v[44:47], v[84:87]
buffer_load_dwordx4 v1, s[44:47], s72 offen offset:3072 sc1 lds
v_mfma_f32_16x16x32_bf16 v[180:183], a[184:187], v[40:43], v[180:183]
v_exp_f32 v157, v157
v_mfma_f32_16x16x32_bf16 v[180:183], a[180:183], v[36:39], v[180:183]
v_exp_f32 v158, v158
v_mfma_f32_16x16x32_bf16 v[180:183], a[176:179], v[32:35], v[180:183]
v_cvt_pk_bf16_f32 v205, v142, v143
v_cvt_pk_bf16_f32 v206, v156, v157
v_mfma_f32_16x16x32_bf16 v[160:163], a[160:163], v[16:19], v[80:83]
v_exp_f32 v159, v159
v_mfma_f32_16x16x32_bf16 v[160:163], a[164:167], v[20:23], v[160:163]
v_cvt_pk_bf16_f32 v207, v158, v159
v_mfma_f32_16x16x32_bf16 v[160:163], a[168:171], v[24:27], v[160:163]
v_mfma_f32_16x16x32_bf16 v[160:163], a[172:175], v[28:31], v[160:163]
v_mfma_f32_16x16x32_bf16 v[168:171], a[172:175], v[60:63], v[88:91]
v_mfma_f32_16x16x32_bf16 v[168:171], a[168:171], v[56:59], v[168:171]
v_mfma_f32_16x16x32_bf16 v[168:171], a[164:167], v[52:55], v[168:171]
v_mfma_f32_16x16x32_bf16 v[168:171], a[160:163], v[48:51], v[168:171]
v_mfma_f32_16x16x32_bf16 v[184:187], a[176:179], v[48:51], v[88:91]
v_mfma_f32_16x16x32_bf16 v[184:187], a[180:183], v[52:55], v[184:187]
v_mfma_f32_16x16x32_bf16 v[184:187], a[184:187], v[56:59], v[184:187]
v_mfma_f32_16x16x32_bf16 v[184:187], a[188:191], v[60:63], v[184:187]
v_mfma_f32_16x16x32_bf16 v[176:179], a[188:191], v[28:31], v[80:83]
v_mfma_f32_16x16x32_bf16 v[176:179], a[184:187], v[24:27], v[176:179]
v_mfma_f32_16x16x32_bf16 v[176:179], a[180:183], v[20:23], v[176:179]
v_mfma_f32_16x16x32_bf16 v[176:179], a[176:179], v[16:19], v[176:179]
s_waitcnt lgkmcnt(4)
v_mfma_f32_16x16x32_bf16 v[224:227], v[120:123], v[208:211], v[224:227]
s_add_u32 s82, s82, 0x8000
ds_read_b128 a[160:163], v2 offset:24576
v_mfma_f32_16x16x32_bf16 v[224:227], v[120:123], v[192:195], v[224:227]
s_and_b32 s82, s82, 0x1ffff
v_exp_f32 v164, v164
v_mfma_f32_16x16x32_bf16 v[232:235], v[120:123], v[216:219], v[232:235]
s_add_u32 m0, s74, 0
v_exp_f32 v165, v165
v_mfma_f32_16x16x32_bf16 v[232:235], v[120:123], v[200:203], v[232:235]
s_add_u32 s72, s81, 0
ds_read_b128 a[164:167], v2 offset:25600
v_cvt_pk_bf16_f32 v212, v164, v165
v_mfma_f32_16x16x32_bf16 a[0:3], a[224:227], v[208:211], a[0:3]
v_exp_f32 v166, v166
v_mfma_f32_16x16x32_bf16 a[0:3], a[192:195], v[192:195], a[0:3]
v_exp_f32 v167, v167
v_mfma_f32_16x16x32_bf16 a[64:67], a[192:195], v[200:203], a[64:67]
ds_read_b128 a[168:171], v2 offset:26624
v_cvt_pk_bf16_f32 v213, v166, v167
v_mfma_f32_16x16x32_bf16 a[64:67], a[224:227], v[216:219], a[64:67]
v_exp_f32 v180, v180
v_mfma_f32_16x16x32_bf16 a[68:71], a[228:231], v[216:219], a[68:71]
buffer_load_dwordx4 v1, s[44:47], s72 offen sc1 lds
v_mfma_f32_16x16x32_bf16 a[68:71], a[196:199], v[200:203], a[68:71]
v_exp_f32 v181, v181
v_mfma_f32_16x16x32_bf16 a[4:7], a[196:199], v[192:195], a[4:7]
ds_read_b128 a[172:175], v2 offset:27648
v_cvt_pk_bf16_f32 v214, v180, v181
v_mfma_f32_16x16x32_bf16 a[4:7], a[228:231], v[208:211], a[4:7]
v_exp_f32 v182, v182
v_mfma_f32_16x16x32_bf16 a[8:11], a[232:235], v[208:211], a[8:11]
v_exp_f32 v183, v183
v_mfma_f32_16x16x32_bf16 a[8:11], a[200:203], v[192:195], a[8:11]
ds_read_b128 a[176:179], v2 offset:28672
v_cvt_pk_bf16_f32 v215, v182, v183
v_mfma_f32_16x16x32_bf16 a[72:75], a[200:203], v[200:203], a[72:75]
v_exp_f32 v172, v172
v_mfma_f32_16x16x32_bf16 a[72:75], a[232:235], v[216:219], a[72:75]
v_exp_f32 v173, v173
v_mfma_f32_16x16x32_bf16 a[76:79], a[236:239], v[216:219], a[76:79]
ds_read_b128 a[180:183], v2 offset:29696
v_cvt_pk_bf16_f32 v220, v172, v173
v_mfma_f32_16x16x32_bf16 a[76:79], a[204:207], v[200:203], a[76:79]
v_exp_f32 v174, v174
v_mfma_f32_16x16x32_bf16 a[12:15], a[204:207], v[192:195], a[12:15]
v_exp_f32 v175, v175
v_mfma_f32_16x16x32_bf16 a[12:15], a[236:239], v[208:211], a[12:15]
ds_read_b128 a[184:187], v2 offset:30720
v_cvt_pk_bf16_f32 v221, v174, v175
v_mfma_f32_16x16x32_bf16 a[16:19], a[240:243], v[208:211], a[16:19]
s_waitcnt lgkmcnt(7)
v_exp_f32 v188, v188
v_mfma_f32_16x16x32_bf16 a[16:19], a[208:211], v[192:195], a[16:19]
buffer_load_dwordx4 v1, s[44:47], s72 offen offset:1024 sc1 lds
v_mfma_f32_16x16x32_bf16 a[80:83], a[208:211], v[200:203], a[80:83]
v_exp_f32 v189, v189
v_mfma_f32_16x16x32_bf16 a[80:83], a[240:243], v[216:219], a[80:83]
ds_read_b128 a[188:191], v2 offset:31744
v_cvt_pk_bf16_f32 v222, v188, v189
v_mfma_f32_16x16x32_bf16 a[84:87], a[244:247], v[216:219], a[84:87]
v_exp_f32 v190, v190
v_mfma_f32_16x16x32_bf16 a[84:87], a[212:215], v[200:203], a[84:87]
v_exp_f32 v191, v191
v_mfma_f32_16x16x32_bf16 a[20:23], a[212:215], v[192:195], a[20:23]
ds_read_b128 a[224:227], v2 offset:8192
v_cvt_pk_bf16_f32 v223, v190, v191
v_mfma_f32_16x16x32_bf16 a[20:23], a[244:247], v[208:211], a[20:23]
v_exp_f32 v160, v160
v_mfma_f32_16x16x32_bf16 a[24:27], a[248:251], v[208:211], a[24:27]
v_exp_f32 v161, v161
v_mfma_f32_16x16x32_bf16 a[24:27], a[216:219], v[192:195], a[24:27]
ds_read_b128 a[228:231], v2 offset:9216
v_mfma_f32_16x16x32_bf16 a[88:91], a[216:219], v[200:203], a[88:91]
v_exp_f32 v162, v162
v_mfma_f32_16x16x32_bf16 a[88:91], a[248:251], v[216:219], a[88:91]
v_exp_f32 v163, v163
v_mfma_f32_16x16x32_bf16 a[92:95], a[252:255], v[216:219], a[92:95]
ds_read_b128 a[232:235], v2 offset:10240
v_mfma_f32_16x16x32_bf16 a[92:95], a[220:223], v[200:203], a[92:95]
v_exp_f32 v176, v176
v_mfma_f32_16x16x32_bf16 a[28:31], a[220:223], v[192:195], a[28:31]
buffer_load_dwordx4 v1, s[44:47], s72 offen offset:2048 sc1 lds
v_mfma_f32_16x16x32_bf16 a[28:31], a[252:255], v[208:211], a[28:31]
ds_read_b128 a[236:239], v2 offset:11264
v_cvt_pk_bf16_f32 v208, v160, v161
s_cmp_eq_u32 s58, 0
s_cbranch_scc1 Lta16
s_cmp_eq_u32 s58, 1
s_cbranch_scc1 Lnt17
v_mfma_f32_16x16x32_bf16 v[128:131], a[128:131], v[16:19], v[80:83]
v_exp_f32 v177, v177
v_mfma_f32_16x16x32_bf16 v[144:147], a[144:147], v[16:19], v[80:83]
v_exp_f32 v178, v178
s_branch Ljoin18
Lta16:
v_mfma_f32_16x16x32_bf16 v[128:131], a[128:131], v[16:19], v[96:99]
v_exp_f32 v177, v177
v_mfma_f32_16x16x32_bf16 v[144:147], a[144:147], v[16:19], v[112:115]
v_exp_f32 v178, v178
s_branch Ljoin18
Lnt17:
v_mfma_f32_16x16x32_bf16 v[128:131], a[128:131], v[16:19], v[80:83]
v_exp_f32 v177, v177
v_mfma_f32_16x16x32_bf16 v[144:147], a[144:147], v[16:19], v[96:99]
v_exp_f32 v178, v178
Ljoin18:
v_mfma_f32_16x16x32_bf16 v[128:131], a[132:135], v[20:23], v[128:131]
ds_read_b128 a[240:243], v2 offset:12288
v_cvt_pk_bf16_f32 v209, v162, v163
v_mfma_f32_16x16x32_bf16 v[128:131], a[136:139], v[24:27], v[128:131]
v_exp_f32 v179, v179
v_mfma_f32_16x16x32_bf16 v[128:131], a[140:143], v[28:31], v[128:131]
v_exp_f32 v168, v168
v_mfma_f32_16x16x32_bf16 v[136:139], a[140:143], v[60:63], v[88:91]
ds_read_b128 a[244:247], v2 offset:13312
v_cvt_pk_bf16_f32 v210, v176, v177
v_mfma_f32_16x16x32_bf16 v[136:139], a[136:139], v[56:59], v[136:139]
v_exp_f32 v169, v169
v_mfma_f32_16x16x32_bf16 v[136:139], a[132:135], v[52:55], v[136:139]
v_exp_f32 v170, v170
v_mfma_f32_16x16x32_bf16 v[136:139], a[128:131], v[48:51], v[136:139]
ds_read_b128 a[248:251], v2 offset:14336
v_cvt_pk_bf16_f32 v211, v178, v179
v_mfma_f32_16x16x32_bf16 v[152:155], a[144:147], v[48:51], v[88:91]
v_exp_f32 v171, v171
v_mfma_f32_16x16x32_bf16 v[152:155], a[148:151], v[52:55], v[152:155]
v_exp_f32 v184, v184
v_mfma_f32_16x16x32_bf16 v[152:155], a[152:155], v[56:59], v[152:155]
ds_read_b128 a[252:255], v2 offset:15360
v_cvt_pk_bf16_f32 v216, v168, v169
v_mfma_f32_16x16x32_bf16 v[152:155], a[156:159], v[60:63], v[152:155]
buffer_load_dwordx4 v1, s[44:47], s72 offen offset:3072 sc1 lds
v_mfma_f32_16x16x32_bf16 v[144:147], a[156:159], v[28:31], v[144:147]
v_exp_f32 v185, v185
v_mfma_f32_16x16x32_bf16 v[144:147], a[152:155], v[24:27], v[144:147]
v_exp_f32 v186, v186
v_mfma_f32_16x16x32_bf16 v[144:147], a[148:151], v[20:23], v[144:147]
v_cvt_pk_bf16_f32 v217, v170, v171
v_cvt_pk_bf16_f32 v218, v184, v185
v_mfma_f32_16x16x32_bf16 v[132:135], a[128:131], v[32:35], v[84:87]
v_exp_f32 v187, v187
v_mfma_f32_16x16x32_bf16 v[132:135], a[132:135], v[36:39], v[132:135]
v_cvt_pk_bf16_f32 v219, v186, v187
v_add_u32 v2, s82, v1
v_mfma_f32_16x16x32_bf16 v[132:135], a[136:139], v[40:43], v[132:135]
v_mfma_f32_16x16x32_bf16 v[132:135], a[140:143], v[44:47], v[132:135]
v_mfma_f32_16x16x32_bf16 v[140:143], a[140:143], v[76:79], v[92:95]
v_mfma_f32_16x16x32_bf16 v[140:143], a[136:139], v[72:75], v[140:143]
v_mfma_f32_16x16x32_bf16 v[140:143], a[132:135], v[68:71], v[140:143]
v_mfma_f32_16x16x32_bf16 v[140:143], a[128:131], v[64:67], v[140:143]
v_mfma_f32_16x16x32_bf16 v[156:159], a[144:147], v[64:67], v[92:95]
v_mfma_f32_16x16x32_bf16 v[156:159], a[148:151], v[68:71], v[156:159]
v_mfma_f32_16x16x32_bf16 v[156:159], a[152:155], v[72:75], v[156:159]
v_mfma_f32_16x16x32_bf16 v[156:159], a[156:159], v[76:79], v[156:159]
v_mfma_f32_16x16x32_bf16 v[148:151], a[156:159], v[44:47], v[84:87]
v_mfma_f32_16x16x32_bf16 v[148:151], a[152:155], v[40:43], v[148:151]
v_mfma_f32_16x16x32_bf16 v[148:151], a[148:151], v[36:39], v[148:151]
s_waitcnt vmcnt(8) lgkmcnt(4)
v_mfma_f32_16x16x32_bf16 v[148:151], a[144:147], v[32:35], v[148:151]
s_barrier
v_mfma_f32_16x16x32_bf16 v[228:231], v[120:123], v[196:199], v[228:231]
s_xor_b32 s74, s82, 0x10000
v_exp_f32 v128, v128
v_mfma_f32_16x16x32_bf16 v[228:231], v[120:123], v[212:215], v[228:231]
s_add_u32 s74, s74, s64
ds_read_b128 a[128:131], v2 offset:16384
v_mfma_f32_16x16x32_bf16 v[236:239], v[120:123], v[204:207], v[236:239]
s_add_u32 s81, s81, 0x8000
v_exp_f32 v129, v129
v_mfma_f32_16x16x32_bf16 v[236:239], v[120:123], v[220:223], v[236:239]
s_add_u32 m0, s74, 16384
v_exp_f32 v130, v130
v_mfma_f32_16x16x32_bf16 a[32:35], a[192:195], v[196:199], a[32:35]
s_add_u32 s72, s81, 16384
ds_read_b128 a[132:135], v2 offset:17408
v_cvt_pk_bf16_f32 v192, v128, v129
v_mfma_f32_16x16x32_bf16 a[32:35], a[224:227], v[212:215], a[32:35]
v_exp_f32 v131, v131
v_mfma_f32_16x16x32_bf16 a[96:99], a[224:227], v[220:223], a[96:99]
v_exp_f32 v144, v144
v_mfma_f32_16x16x32_bf16 a[96:99], a[192:195], v[204:207], a[96:99]
ds_read_b128 a[136:139], v2 offset:18432
v_cvt_pk_bf16_f32 v193, v130, v131
v_mfma_f32_16x16x32_bf16 a[100:103], a[196:199], v[204:207], a[100:103]
buffer_load_dwordx4 v1, s[44:47], s72 offen sc1 lds
v_mfma_f32_16x16x32_bf16 a[100:103], a[228:231], v[220:223], a[100:103]
v_exp_f32 v145, v145
v_mfma_f32_16x16x32_bf16 a[36:39], a[228:231], v[212:215], a[36:39]
v_exp_f32 v146, v146
v_mfma_f32_16x16x32_bf16 a[36:39], a[196:199], v[196:199], a[36:39]
ds_read_b128 a[140:143], v2 offset:19456
v_cvt_pk_bf16_f32 v194, v144, v145
v_mfma_f32_16x16x32_bf16 a[40:43], a[200:203], v[196:199], a[40:43]
v_exp_f32 v147, v147
v_mfma_f32_16x16x32_bf16 a[40:43], a[232:235], v[212:215], a[40:43]
v_exp_f32 v136, v136
v_mfma_f32_16x16x32_bf16 a[104:107], a[232:235], v[220:223], a[104:107]
ds_read_b128 a[144:147], v2 offset:20480
v_cvt_pk_bf16_f32 v195, v146, v147
v_mfma_f32_16x16x32_bf16 a[104:107], a[200:203], v[204:207], a[104:107]
v_exp_f32 v137, v137
v_mfma_f32_16x16x32_bf16 a[108:111], a[204:207], v[204:207], a[108:111]
v_exp_f32 v138, v138
v_mfma_f32_16x16x32_bf16 a[108:111], a[236:239], v[220:223], a[108:111]
ds_read_b128 a[148:151], v2 offset:21504
v_cvt_pk_bf16_f32 v200, v136, v137
v_mfma_f32_16x16x32_bf16 a[44:47], a[236:239], v[212:215], a[44:47]
v_exp_f32 v139, v139
v_mfma_f32_16x16x32_bf16 a[44:47], a[204:207], v[196:199], a[44:47]
v_exp_f32 v152, v152
v_mfma_f32_16x16x32_bf16 a[48:51], a[208:211], v[196:199], a[48:51]
s_waitcnt lgkmcnt(6)
ds_read_b128 a[152:155], v2 offset:22528
v_cvt_pk_bf16_f32 v201, v138, v139
v_mfma_f32_16x16x32_bf16 a[48:51], a[240:243], v[212:215], a[48:51]
buffer_load_dwordx4 v1, s[44:47], s72 offen offset:1024 sc1 lds
v_mfma_f32_16x16x32_bf16 a[112:115], a[240:243], v[220:223], a[112:115]
v_exp_f32 v153, v153
v_mfma_f32_16x16x32_bf16 a[112:115], a[208:211], v[204:207], a[112:115]
v_exp_f32 v154, v154
v_mfma_f32_16x16x32_bf16 a[116:119], a[212:215], v[204:207], a[116:119]
ds_read_b128 a[156:159], v2 offset:23552
v_cvt_pk_bf16_f32 v202, v152, v153
v_mfma_f32_16x16x32_bf16 a[116:119], a[244:247], v[220:223], a[116:119]
v_exp_f32 v155, v155
v_mfma_f32_16x16x32_bf16 a[52:55], a[244:247], v[212:215], a[52:55]
v_exp_f32 v132, v132
v_mfma_f32_16x16x32_bf16 a[52:55], a[212:215], v[196:199], a[52:55]
ds_read_b128 a[192:195], v2 offset:0
v_cvt_pk_bf16_f32 v203, v154, v155
v_mfma_f32_16x16x32_bf16 a[56:59], a[216:219], v[196:199], a[56:59]
v_exp_f32 v133, v133
v_mfma_f32_16x16x32_bf16 a[56:59], a[248:251], v[212:215], a[56:59]
v_exp_f32 v134, v134
v_mfma_f32_16x16x32_bf16 a[120:123], a[248:251], v[220:223], a[120:123]
ds_read_b128 a[196:199], v2 offset:1024
v_mfma_f32_16x16x32_bf16 a[120:123], a[216:219], v[204:207], a[120:123]
v_exp_f32 v135, v135
v_mfma_f32_16x16x32_bf16 a[124:127], a[220:223], v[204:207], a[124:127]
v_exp_f32 v148, v148
v_mfma_f32_16x16x32_bf16 a[124:127], a[252:255], v[220:223], a[124:127]
ds_read_b128 a[200:203], v2 offset:2048
v_mfma_f32_16x16x32_bf16 a[60:63], a[252:255], v[212:215], a[60:63]
buffer_load_dwordx4 v1, s[44:47], s72 offen offset:2048 sc1 lds
v_mfma_f32_16x16x32_bf16 a[60:63], a[220:223], v[196:199], a[60:63]
ds_read_b128 a[204:207], v2 offset:3072
v_cvt_pk_bf16_f32 v196, v132, v133
s_cmp_eq_u32 s58, 2
s_cbranch_scc1 Lta19
s_cmp_eq_u32 s58, 3
s_cbranch_scc1 Lnt20
v_mfma_f32_16x16x32_bf16 v[160:163], a[160:163], v[16:19], v[112:115]
v_exp_f32 v149, v149
v_mfma_f32_16x16x32_bf16 v[176:179], a[176:179], v[16:19], v[112:115]
v_exp_f32 v150, v150
s_branch Ljoin21
Lta19:
v_mfma_f32_16x16x32_bf16 v[160:163], a[160:163], v[16:19], v[96:99]
v_exp_f32 v149, v149
v_mfma_f32_16x16x32_bf16 v[176:179], a[176:179], v[16:19], v[112:115]
v_exp_f32 v150, v150
s_branch Ljoin21
Lnt20:
v_mfma_f32_16x16x32_bf16 v[160:163], a[160:163], v[16:19], v[80:83]
v_exp_f32 v149, v149
v_mfma_f32_16x16x32_bf16 v[176:179], a[176:179], v[16:19], v[96:99]
v_exp_f32 v150, v150
Ljoin21:
v_mfma_f32_16x16x32_bf16 v[164:167], a[160:163], v[32:35], v[84:87]
ds_read_b128 a[208:211], v2 offset:4096
v_cvt_pk_bf16_f32 v197, v134, v135
v_mfma_f32_16x16x32_bf16 v[164:167], a[164:167], v[36:39], v[164:167]
v_exp_f32 v151, v151
v_mfma_f32_16x16x32_bf16 v[164:167], a[168:171], v[40:43], v[164:167]
v_exp_f32 v140, v140
v_mfma_f32_16x16x32_bf16 v[164:167], a[172:175], v[44:47], v[164:167]
ds_read_b128 a[212:215], v2 offset:5120
v_cvt_pk_bf16_f32 v198, v148, v149
v_mfma_f32_16x16x32_bf16 v[172:175], a[172:175], v[76:79], v[92:95]
v_exp_f32 v141, v141
v_mfma_f32_16x16x32_bf16 v[172:175], a[168:171], v[72:75], v[172:175]
v_exp_f32 v142, v142
v_mfma_f32_16x16x32_bf16 v[172:175], a[164:167], v[68:71], v[172:175]
ds_read_b128 a[216:219], v2 offset:6144
v_cvt_pk_bf16_f32 v199, v150, v151
v_mfma_f32_16x16x32_bf16 v[172:175], a[160:163], v[64:67], v[172:175]
v_exp_f32 v143, v143
v_mfma_f32_16x16x32_bf16 v[188:191], a[176:179], v[64:67], v[92:95]
v_exp_f32 v156, v156
v_mfma_f32_16x16x32_bf16 v[188:191], a[180:183], v[68:71], v[188:191]
ds_read_b128 a[220:223], v2 offset:7168
v_cvt_pk_bf16_f32 v204, v140, v141
v_mfma_f32_16x16x32_bf16 v[188:191], a[184:187], v[72:75], v[188:191]
buffer_load_dwordx4 v1, s[44:47], s72 offen offset:3072 sc1 lds
v_mfma_f32_16x16x32_bf16 v[188:191], a[188:191], v[76:79], v[188:191]
v_exp_f32 v157, v157
v_mfma_f32_16x16x32_bf16 v[180:183], a[188:191], v[44:47], v[84:87]
v_exp_f32 v158, v158
v_mfma_f32_16x16x32_bf16 v[180:183], a[184:187], v[40:43], v[180:183]
v_cvt_pk_bf16_f32 v205, v142, v143
v_cvt_pk_bf16_f32 v206, v156, v157
v_mfma_f32_16x16x32_bf16 v[180:183], a[180:183], v[36:39], v[180:183]
v_exp_f32 v159, v159
v_mfma_f32_16x16x32_bf16 v[180:183], a[176:179], v[32:35], v[180:183]
v_cvt_pk_bf16_f32 v207, v158, v159
v_mfma_f32_16x16x32_bf16 v[160:163], a[164:167], v[20:23], v[160:163]
v_mfma_f32_16x16x32_bf16 v[160:163], a[168:171], v[24:27], v[160:163]
v_mfma_f32_16x16x32_bf16 v[160:163], a[172:175], v[28:31], v[160:163]
v_mfma_f32_16x16x32_bf16 v[168:171], a[172:175], v[60:63], v[88:91]
v_mfma_f32_16x16x32_bf16 v[168:171], a[168:171], v[56:59], v[168:171]
v_mfma_f32_16x16x32_bf16 v[168:171], a[164:167], v[52:55], v[168:171]
v_mfma_f32_16x16x32_bf16 v[168:171], a[160:163], v[48:51], v[168:171]
v_mfma_f32_16x16x32_bf16 v[184:187], a[176:179], v[48:51], v[88:91]
v_mfma_f32_16x16x32_bf16 v[184:187], a[180:183], v[52:55], v[184:187]
v_mfma_f32_16x16x32_bf16 v[184:187], a[184:187], v[56:59], v[184:187]
v_mfma_f32_16x16x32_bf16 v[184:187], a[188:191], v[60:63], v[184:187]
v_mfma_f32_16x16x32_bf16 v[176:179], a[188:191], v[28:31], v[176:179]
v_mfma_f32_16x16x32_bf16 v[176:179], a[184:187], v[24:27], v[176:179]
v_mfma_f32_16x16x32_bf16 v[176:179], a[180:183], v[20:23], v[176:179]
s_waitcnt lgkmcnt(4)
v_mfma_f32_16x16x32_bf16 v[224:227], v[120:123], v[208:211], v[224:227]
s_add_u32 s82, s82, 0x8000
ds_read_b128 a[160:163], v2 offset:24576
v_mfma_f32_16x16x32_bf16 v[224:227], v[120:123], v[192:195], v[224:227]
s_and_b32 s82, s82, 0x1ffff
v_exp_f32 v164, v164
v_mfma_f32_16x16x32_bf16 v[232:235], v[120:123], v[216:219], v[232:235]
s_add_u32 m0, s74, 0
v_exp_f32 v165, v165
v_mfma_f32_16x16x32_bf16 v[232:235], v[120:123], v[200:203], v[232:235]
s_add_u32 s72, s81, 0
ds_read_b128 a[164:167], v2 offset:25600
v_cvt_pk_bf16_f32 v212, v164, v165
v_mfma_f32_16x16x32_bf16 a[0:3], a[224:227], v[208:211], a[0:3]
v_exp_f32 v166, v166
v_mfma_f32_16x16x32_bf16 a[0:3], a[192:195], v[192:195], a[0:3]
v_exp_f32 v167, v167
v_mfma_f32_16x16x32_bf16 a[64:67], a[192:195], v[200:203], a[64:67]
ds_read_b128 a[168:171], v2 offset:26624
v_cvt_pk_bf16_f32 v213, v166, v167
v_mfma_f32_16x16x32_bf16 a[64:67], a[224:227], v[216:219], a[64:67]
v_exp_f32 v180, v180
v_mfma_f32_16x16x32_bf16 a[68:71], a[228:231], v[216:219], a[68:71]
buffer_load_dwordx4 v1, s[44:47], s72 offen sc1 lds
v_mfma_f32_16x16x32_bf16 a[68:71], a[196:199], v[200:203], a[68:71]
v_exp_f32 v181, v181
v_mfma_f32_16x16x32_bf16 a[4:7], a[196:199], v[192:195], a[4:7]
ds_read_b128 a[172:175], v2 offset:27648
v_cvt_pk_bf16_f32 v214, v180, v181
v_mfma_f32_16x16x32_bf16 a[4:7], a[228:231], v[208:211], a[4:7]
v_exp_f32 v182, v182
v_mfma_f32_16x16x32_bf16 a[8:11], a[232:235], v[208:211], a[8:11]
v_exp_f32 v183, v183
v_mfma_f32_16x16x32_bf16 a[8:11], a[200:203], v[192:195], a[8:11]
ds_read_b128 a[176:179], v2 offset:28672
v_cvt_pk_bf16_f32 v215, v182, v183
v_mfma_f32_16x16x32_bf16 a[72:75], a[200:203], v[200:203], a[72:75]
v_exp_f32 v172, v172
v_mfma_f32_16x16x32_bf16 a[72:75], a[232:235], v[216:219], a[72:75]
v_exp_f32 v173, v173
v_mfma_f32_16x16x32_bf16 a[76:79], a[236:239], v[216:219], a[76:79]
ds_read_b128 a[180:183], v2 offset:29696
v_cvt_pk_bf16_f32 v220, v172, v173
v_mfma_f32_16x16x32_bf16 a[76:79], a[204:207], v[200:203], a[76:79]
v_exp_f32 v174, v174
v_mfma_f32_16x16x32_bf16 a[12:15], a[204:207], v[192:195], a[12:15]
v_exp_f32 v175, v175
v_mfma_f32_16x16x32_bf16 a[12:15], a[236:239], v[208:211], a[12:15]
ds_read_b128 a[184:187], v2 offset:30720
v_cvt_pk_bf16_f32 v221, v174, v175
v_mfma_f32_16x16x32_bf16 a[16:19], a[240:243], v[208:211], a[16:19]
s_waitcnt lgkmcnt(7)
v_exp_f32 v188, v188
v_mfma_f32_16x16x32_bf16 a[16:19], a[208:211], v[192:195], a[16:19]
buffer_load_dwordx4 v1, s[44:47], s72 offen offset:1024 sc1 lds
v_mfma_f32_16x16x32_bf16 a[80:83], a[208:211], v[200:203], a[80:83]
v_exp_f32 v189, v189
v_mfma_f32_16x16x32_bf16 a[80:83], a[240:243], v[216:219], a[80:83]
ds_read_b128 a[188:191], v2 offset:31744
v_cvt_pk_bf16_f32 v222, v188, v189
v_mfma_f32_16x16x32_bf16 a[84:87], a[244:247], v[216:219], a[84:87]
v_exp_f32 v190, v190
v_mfma_f32_16x16x32_bf16 a[84:87], a[212:215], v[200:203], a[84:87]
v_exp_f32 v191, v191
v_mfma_f32_16x16x32_bf16 a[20:23], a[212:215], v[192:195], a[20:23]
ds_read_b128 a[224:227], v2 offset:8192
v_cvt_pk_bf16_f32 v223, v190, v191
v_mfma_f32_16x16x32_bf16 a[20:23], a[244:247], v[208:211], a[20:23]
v_exp_f32 v160, v160
v_mfma_f32_16x16x32_bf16 a[24:27], a[248:251], v[208:211], a[24:27]
v_exp_f32 v161, v161
v_mfma_f32_16x16x32_bf16 a[24:27], a[216:219], v[192:195], a[24:27]
ds_read_b128 a[228:231], v2 offset:9216
v_mfma_f32_16x16x32_bf16 a[88:91], a[216:219], v[200:203], a[88:91]
v_exp_f32 v162, v162
v_mfma_f32_16x16x32_bf16 a[88:91], a[248:251], v[216:219], a[88:91]
v_exp_f32 v163, v163
v_mfma_f32_16x16x32_bf16 a[92:95], a[252:255], v[216:219], a[92:95]
ds_read_b128 a[232:235], v2 offset:10240
v_mfma_f32_16x16x32_bf16 a[92:95], a[220:223], v[200:203], a[92:95]
Lstub3:
s_cbranch_execz Lstub7
v_exp_f32 v176, v176
v_mfma_f32_16x16x32_bf16 a[28:31], a[220:223], v[192:195], a[28:31]
buffer_load_dwordx4 v1, s[44:47], s72 offen offset:2048 sc1 lds
v_mfma_f32_16x16x32_bf16 a[28:31], a[252:255], v[208:211], a[28:31]
ds_read_b128 a[236:239], v2 offset:11264
v_cvt_pk_bf16_f32 v208, v160, v161
s_cmp_eq_u32 s58, 0
s_cbranch_scc1 Lta22
s_cmp_eq_u32 s58, 1
s_cbranch_scc1 Lnt23
v_mfma_f32_16x16x32_bf16 v[132:135], a[128:131], v[32:35], v[84:87]
v_exp_f32 v177, v177
v_mfma_f32_16x16x32_bf16 v[148:151], a[144:147], v[32:35], v[84:87]
v_exp_f32 v178, v178
s_branch Ljoin24
Lta22:
v_mfma_f32_16x16x32_bf16 v[132:135], a[128:131], v[32:35], v[100:103]
v_exp_f32 v177, v177
v_mfma_f32_16x16x32_bf16 v[148:151], a[144:147], v[32:35], v[112:115]
v_exp_f32 v178, v178
s_branch Ljoin24
Lnt23:
v_mfma_f32_16x16x32_bf16 v[132:135], a[128:131], v[32:35], v[84:87]
v_exp_f32 v177, v177
v_mfma_f32_16x16x32_bf16 v[148:151], a[144:147], v[32:35], v[100:103]
v_exp_f32 v178, v178
Ljoin24:
v_mfma_f32_16x16x32_bf16 v[136:139], a[128:131], v[48:51], v[88:91]
ds_read_b128 a[240:243], v2 offset:12288
v_cvt_pk_bf16_f32 v209, v162, v163
v_mfma_f32_16x16x32_bf16 v[136:139], a[132:135], v[52:55], v[136:139]
v_exp_f32 v179, v179
v_mfma_f32_16x16x32_bf16 v[136:139], a[136:139], v[56:59], v[136:139]
v_exp_f32 v168, v168
v_mfma_f32_16x16x32_bf16 v[136:139], a[140:143], v[60:63], v[136:139]
ds_read_b128 a[244:247], v2 offset:13312
v_cvt_pk_bf16_f32 v210, v176, v177
v_mfma_f32_16x16x32_bf16 v[152:155], a[156:159], v[60:63], v[88:91]
v_exp_f32 v169, v169
v_mfma_f32_16x16x32_bf16 v[152:155], a[152:155], v[56:59], v[152:155]
v_exp_f32 v170, v170
v_mfma_f32_16x16x32_bf16 v[152:155], a[148:151], v[52:55], v[152:155]
ds_read_b128 a[248:251], v2 offset:14336
v_cvt_pk_bf16_f32 v211, v178, v179
v_mfma_f32_16x16x32_bf16 v[152:155], a[144:147], v[48:51], v[152:155]
v_exp_f32 v171, v171
v_mfma_f32_16x16x32_bf16 v[132:135], a[132:135], v[36:39], v[132:135]
v_exp_f32 v184, v184
v_mfma_f32_16x16x32_bf16 v[132:135], a[136:139], v[40:43], v[132:135]
ds_read_b128 a[252:255], v2 offset:15360
v_cvt_pk_bf16_f32 v216, v168, v169
v_mfma_f32_16x16x32_bf16 v[132:135], a[140:143], v[44:47], v[132:135]
buffer_load_dwordx4 v1, s[44:47], s72 offen offset:3072 sc1 lds
v_mfma_f32_16x16x32_bf16 v[140:143], a[140:143], v[76:79], v[92:95]
v_exp_f32 v185, v185
v_mfma_f32_16x16x32_bf16 v[140:143], a[136:139], v[72:75], v[140:143]
v_exp_f32 v186, v186
v_mfma_f32_16x16x32_bf16 v[140:143], a[132:135], v[68:71], v[140:143]
v_cvt_pk_bf16_f32 v217, v170, v171
v_cvt_pk_bf16_f32 v218, v184, v185
v_mfma_f32_16x16x32_bf16 v[140:143], a[128:131], v[64:67], v[140:143]
v_exp_f32 v187, v187
v_mfma_f32_16x16x32_bf16 v[156:159], a[144:147], v[64:67], v[92:95]
v_cvt_pk_bf16_f32 v219, v186, v187
v_add_u32 v2, s82, v1
v_mfma_f32_16x16x32_bf16 v[156:159], a[148:151], v[68:71], v[156:159]
v_mfma_f32_16x16x32_bf16 v[156:159], a[152:155], v[72:75], v[156:159]
v_mfma_f32_16x16x32_bf16 v[156:159], a[156:159], v[76:79], v[156:159]
v_mfma_f32_16x16x32_bf16 v[148:151], a[156:159], v[44:47], v[148:151]
v_mfma_f32_16x16x32_bf16 v[148:151], a[152:155], v[40:43], v[148:151]
s_waitcnt vmcnt(8) lgkmcnt(4)
v_mfma_f32_16x16x32_bf16 v[148:151], a[148:151], v[36:39], v[148:151]
s_barrier
s_cmp_eq_u32 s60, 7
s_cbranch_scc1 LLT3x
LLT3:
Lstub4:
s_cbranch_execz Lstub8
v_mfma_f32_16x16x32_bf16 v[228:231], v[120:123], v[196:199], v[228:231]
s_xor_b32 s74, s82, 0x10000
v_exp_f32 v136, v136
v_mfma_f32_16x16x32_bf16 v[228:231], v[120:123], v[212:215], v[228:231]
s_add_u32 s74, s74, s64
ds_read_b128 a[128:131], v2 offset:16384
v_and_b32 v240, 15, v0
v_mfma_f32_16x16x32_bf16 v[236:239], v[120:123], v[204:207], v[236:239]
s_add_u32 s81, s81, 0x8000
v_exp_f32 v137, v137
v_mfma_f32_16x16x32_bf16 v[236:239], v[120:123], v[220:223], v[236:239]
s_add_u32 m0, s74, 16384
ds_read_b128 a[132:135], v2 offset:17408
v_cvt_pk_bf16_f32 v200, v136, v137
v_mfma_f32_16x16x32_bf16 a[32:35], a[192:195], v[196:199], a[32:35]
s_add_u32 s72, s81, 16384
buffer_load_dwordx4 v1, s[44:47], s72 offen sc1 lds
v_mfma_f32_16x16x32_bf16 a[32:35], a[224:227], v[212:215], a[32:35]
s_add_u32 s69, s93, 0x3e00000
v_exp_f32 v138, v138
v_mfma_f32_16x16x32_bf16 a[96:99], a[224:227], v[220:223], a[96:99]
v_exp_f32 v139, v139
v_mfma_f32_16x16x32_bf16 a[96:99], a[192:195], v[204:207], a[96:99]
ds_read_b128 a[136:139], v2 offset:18432
v_cvt_pk_bf16_f32 v201, v138, v139
v_mfma_f32_16x16x32_bf16 a[100:103], a[196:199], v[204:207], a[100:103]
v_exp_f32 v152, v152
v_mfma_f32_16x16x32_bf16 a[100:103], a[228:231], v[220:223], a[100:103]
ds_read_b128 a[140:143], v2 offset:19456
v_lshrrev_b32 v241, 4, v0
v_mfma_f32_16x16x32_bf16 a[36:39], a[228:231], v[212:215], a[36:39]
buffer_store_dwordx4 v[112:115], v1, s[44:47], s69 offen sc1
v_mfma_f32_16x16x32_bf16 a[36:39], a[196:199], v[196:199], a[36:39]
v_exp_f32 v153, v153
v_mfma_f32_16x16x32_bf16 a[40:43], a[200:203], v[196:199], a[40:43]
v_exp_f32 v154, v154
v_mfma_f32_16x16x32_bf16 a[40:43], a[232:235], v[212:215], a[40:43]
ds_read_b128 a[144:147], v2 offset:20480
v_cvt_pk_bf16_f32 v202, v152, v153
v_mfma_f32_16x16x32_bf16 a[104:107], a[232:235], v[220:223], a[104:107]
v_exp_f32 v155, v155
v_mfma_f32_16x16x32_bf16 a[104:107], a[200:203], v[204:207], a[104:107]
ds_read_b128 a[148:151], v2 offset:21504
v_cvt_pk_bf16_f32 v203, v154, v155
v_mfma_f32_16x16x32_bf16 a[108:111], a[204:207], v[204:207], a[108:111]
buffer_load_dwordx4 v1, s[44:47], s72 offen offset:1024 sc1 lds
v_mfma_f32_16x16x32_bf16 a[108:111], a[236:239], v[220:223], a[108:111]
v_exp_f32 v132, v132
v_mfma_f32_16x16x32_bf16 a[44:47], a[236:239], v[212:215], a[44:47]
v_exp_f32 v133, v133
v_mfma_f32_16x16x32_bf16 a[44:47], a[204:207], v[196:199], a[44:47]
ds_read_b128 a[152:155], v2 offset:22528
v_add_u32 v248, 1, v240
v_mfma_f32_16x16x32_bf16 a[48:51], a[208:211], v[196:199], a[48:51]
s_waitcnt lgkmcnt(7)
v_exp_f32 v134, v134
v_mfma_f32_16x16x32_bf16 a[48:51], a[240:243], v[212:215], a[48:51]
ds_read_b128 a[156:159], v2 offset:23552
v_and_b32 v249, 3, v248
v_mfma_f32_16x16x32_bf16 a[112:115], a[240:243], v[220:223], a[112:115]
buffer_store_dwordx4 v[112:115], v1, s[44:47], s69 offen offset:1024 sc1
v_mfma_f32_16x16x32_bf16 a[112:115], a[208:211], v[204:207], a[112:115]
v_exp_f32 v135, v135
v_mfma_f32_16x16x32_bf16 a[116:119], a[212:215], v[204:207], a[116:119]
v_exp_f32 v148, v148
v_mfma_f32_16x16x32_bf16 a[116:119], a[244:247], v[220:223], a[116:119]
ds_read_b128 a[192:195], v2 offset:0
v_lshrrev_b32 v248, 2, v248
v_mfma_f32_16x16x32_bf16 a[52:55], a[244:247], v[212:215], a[52:55]
v_exp_f32 v149, v149
v_mfma_f32_16x16x32_bf16 a[52:55], a[212:215], v[196:199], a[52:55]
ds_read_b128 a[196:199], v2 offset:1024
v_mov_b32 v250, 0x20000
v_mfma_f32_16x16x32_bf16 a[56:59], a[216:219], v[196:199], a[56:59]
buffer_load_dwordx4 v1, s[44:47], s72 offen offset:2048 sc1 lds
v_mfma_f32_16x16x32_bf16 a[56:59], a[248:251], v[212:215], a[56:59]
v_exp_f32 v150, v150
v_mfma_f32_16x16x32_bf16 a[120:123], a[248:251], v[220:223], a[120:123]
v_exp_f32 v151, v151
v_mfma_f32_16x16x32_bf16 a[120:123], a[216:219], v[204:207], a[120:123]
ds_read_b128 a[200:203], v2 offset:2048
v_mov_b32 v252, 0x20001
v_mfma_f32_16x16x32_bf16 a[124:127], a[220:223], v[204:207], a[124:127]
v_exp_f32 v140, v140
v_mfma_f32_16x16x32_bf16 a[124:127], a[252:255], v[220:223], a[124:127]
ds_read_b128 a[204:207], v2 offset:3072
v_lshlrev_b32 v6, 3, v249
v_mfma_f32_16x16x32_bf16 a[60:63], a[252:255], v[212:215], a[60:63]
buffer_store_dwordx4 v[112:115], v1, s[44:47], s69 offen offset:2048 sc1
v_mfma_f32_16x16x32_bf16 a[60:63], a[220:223], v[196:199], a[60:63]
ds_read_b128 a[208:211], v2 offset:4096
v_cvt_pk_bf16_f32 v196, v132, v133
s_cmp_eq_u32 s58, 2
s_cbranch_scc1 Lta25
s_cmp_eq_u32 s58, 3
s_cbranch_scc1 Lnt26
v_mfma_f32_16x16x32_bf16 v[164:167], a[160:163], v[32:35], v[112:115]
ds_read_b128 a[212:215], v2 offset:5120
v_cvt_pk_bf16_f32 v197, v134, v135
v_mfma_f32_16x16x32_bf16 v[180:183], a[176:179], v[32:35], v[112:115]
ds_read_b128 a[216:219], v2 offset:6144
v_cvt_pk_bf16_f32 v198, v148, v149
s_branch Ljoin27
Lta25:
v_mfma_f32_16x16x32_bf16 v[164:167], a[160:163], v[32:35], v[100:103]
ds_read_b128 a[212:215], v2 offset:5120
v_cvt_pk_bf16_f32 v197, v134, v135
v_mfma_f32_16x16x32_bf16 v[180:183], a[176:179], v[32:35], v[112:115]
ds_read_b128 a[216:219], v2 offset:6144
v_cvt_pk_bf16_f32 v198, v148, v149
s_branch Ljoin27
Lnt26:
v_mfma_f32_16x16x32_bf16 v[164:167], a[160:163], v[32:35], v[84:87]
ds_read_b128 a[212:215], v2 offset:5120
v_cvt_pk_bf16_f32 v197, v134, v135
v_mfma_f32_16x16x32_bf16 v[180:183], a[176:179], v[32:35], v[100:103]
ds_read_b128 a[216:219], v2 offset:6144
v_cvt_pk_bf16_f32 v198, v148, v149
Ljoin27:
v_mfma_f32_16x16x32_bf16 v[164:167], a[164:167], v[36:39], v[164:167]
v_exp_f32 v141, v141
v_mfma_f32_16x16x32_bf16 v[164:167], a[168:171], v[40:43], v[164:167]
v_exp_f32 v142, v142
v_mfma_f32_16x16x32_bf16 v[164:167], a[172:175], v[44:47], v[164:167]
ds_read_b128 a[220:223], v2 offset:7168
v_cvt_pk_bf16_f32 v199, v150, v151
v_mfma_f32_16x16x32_bf16 v[172:175], a[172:175], v[76:79], v[92:95]
v_exp_f32 v143, v143
v_mfma_f32_16x16x32_bf16 v[172:175], a[168:171], v[72:75], v[172:175]
buffer_load_dwordx4 v1, s[44:47], s72 offen offset:3072 sc1 lds
v_mfma_f32_16x16x32_bf16 v[172:175], a[164:167], v[68:71], v[172:175]
v_exp_f32 v156, v156
v_mfma_f32_16x16x32_bf16 v[172:175], a[160:163], v[64:67], v[172:175]
v_cvt_pk_bf16_f32 v204, v140, v141
v_cvt_pk_bf16_f32 v205, v142, v143
v_mfma_f32_16x16x32_bf16 v[188:191], a[176:179], v[64:67], v[92:95]
v_exp_f32 v157, v157
v_mfma_f32_16x16x32_bf16 v[188:191], a[180:183], v[68:71], v[188:191]
v_exp_f32 v158, v158
v_mfma_f32_16x16x32_bf16 v[188:191], a[184:187], v[72:75], v[188:191]
buffer_store_dwordx4 v[112:115], v1, s[44:47], s69 offen offset:3072 sc1
v_mfma_f32_16x16x32_bf16 v[188:191], a[188:191], v[76:79], v[188:191]
v_exp_f32 v159, v159
v_mfma_f32_16x16x32_bf16 v[180:183], a[188:191], v[44:47], v[180:183]
v_cvt_pk_bf16_f32 v206, v156, v157
v_cvt_pk_bf16_f32 v207, v158, v159
v_mfma_f32_16x16x32_bf16 v[180:183], a[184:187], v[40:43], v[180:183]
v_lshrrev_b32 v6, v6, v252
v_and_b32 v6, 3, v6
v_mfma_f32_16x16x32_bf16 v[180:183], a[180:183], v[36:39], v[180:183]
v_cmp_ne_u32 vcc, 1, v249
v_mul_u32_u24 v6, 16640, v6
v_mfma_f32_16x16x32_bf16 v[168:171], a[160:163], v[48:51], v[88:91]
v_add_u32 v6, s92, v6
v_cndmask_b32 v6, v250, v6, vcc
v_mfma_f32_16x16x32_bf16 v[168:171], a[164:167], v[52:55], v[168:171]
v_add_u32 v253, s58, v249
v_and_b32 v253, 3, v253
v_mfma_f32_16x16x32_bf16 v[168:171], a[168:171], v[56:59], v[168:171]
v_mul_u32_u24 v253, 4160, v253
v_add_u32 v6, v6, v253
v_mfma_f32_16x16x32_bf16 v[168:171], a[172:175], v[60:63], v[168:171]
v_bfe_u32 v251, v0, 2, 2
v_lshl_add_u32 v6, v248, 3, v6
v_mfma_f32_16x16x32_bf16 v[184:187], a[188:191], v[60:63], v[88:91]
v_lshl_add_u32 v6, v241, 4, v6
v_lshlrev_b32 v5, 3, v251
v_mfma_f32_16x16x32_bf16 v[184:187], a[184:187], v[56:59], v[184:187]
v_lshrrev_b32 v5, v5, v252
v_and_b32 v5, 3, v5
v_mfma_f32_16x16x32_bf16 v[184:187], a[180:183], v[52:55], v[184:187]
v_cmp_ne_u32 vcc, 1, v251
v_mul_u32_u24 v5, 16640, v5
v_mfma_f32_16x16x32_bf16 v[184:187], a[176:179], v[48:51], v[184:187]
s_waitcnt lgkmcnt(4)
v_mfma_f32_16x16x32_bf16 v[224:227], v[120:123], v[208:211], v[224:227]
s_add_u32 s82, s82, 0x8000
ds_read_b128 a[160:163], v2 offset:24576
ds_read_b128 a[164:167], v2 offset:25600
v_mfma_f32_16x16x32_bf16 v[232:235], v[120:123], v[216:219], v[232:235]
s_and_b32 s82, s82, 0x1ffff
v_exp_f32 v164, v164
v_mfma_f32_16x16x32_bf16 v[232:235], v[120:123], v[200:203], v[232:235]
s_add_u32 m0, s74, 0
v_exp_f32 v165, v165
v_mfma_f32_16x16x32_bf16 a[0:3], a[224:227], v[208:211], a[0:3]
s_add_u32 s72, s81, 0
v_exp_f32 v166, v166
v_mfma_f32_16x16x32_bf16 a[64:67], a[192:195], v[200:203], a[64:67]
ds_read_b128 a[168:171], v2 offset:26624
v_cvt_pk_bf16_f32 v212, v164, v165
v_mfma_f32_16x16x32_bf16 a[64:67], a[224:227], v[216:219], a[64:67]
v_exp_f32 v167, v167
v_mfma_f32_16x16x32_bf16 a[68:71], a[228:231], v[216:219], a[68:71]
buffer_load_dwordx4 v1, s[44:47], s72 offen sc1 lds
v_mfma_f32_16x16x32_bf16 a[68:71], a[196:199], v[200:203], a[68:71]
v_exp_f32 v180, v180
v_mfma_f32_16x16x32_bf16 a[4:7], a[228:231], v[208:211], a[4:7]
ds_read_b128 a[172:175], v2 offset:27648
v_cvt_pk_bf16_f32 v213, v166, v167
v_mfma_f32_16x16x32_bf16 a[8:11], a[232:235], v[208:211], a[8:11]
v_exp_f32 v181, v181
v_mfma_f32_16x16x32_bf16 a[72:75], a[200:203], v[200:203], a[72:75]
ds_read_b128 a[176:179], v2 offset:28672
v_cvt_pk_bf16_f32 v214, v180, v181
v_mfma_f32_16x16x32_bf16 a[72:75], a[232:235], v[216:219], a[72:75]
v_exp_f32 v182, v182
v_mfma_f32_16x16x32_bf16 a[76:79], a[236:239], v[216:219], a[76:79]
v_exp_f32 v183, v183
v_mfma_f32_16x16x32_bf16 a[76:79], a[204:207], v[200:203], a[76:79]
ds_read_b128 a[180:183], v2 offset:29696
v_cvt_pk_bf16_f32 v215, v182, v183
v_mfma_f32_16x16x32_bf16 a[12:15], a[236:239], v[208:211], a[12:15]
v_exp_f32 v172, v172
v_mfma_f32_16x16x32_bf16 a[16:19], a[240:243], v[208:211], a[16:19]
s_waitcnt lgkmcnt(6)
ds_read_b128 a[184:187], v2 offset:30720
ds_read_b128 a[188:191], v2 offset:31744
v_mfma_f32_16x16x32_bf16 a[80:83], a[208:211], v[200:203], a[80:83]
v_exp_f32 v173, v173
v_mfma_f32_16x16x32_bf16 a[80:83], a[240:243], v[216:219], a[80:83]
buffer_load_dwordx4 v1, s[44:47], s72 offen offset:1024 sc1 lds
v_mfma_f32_16x16x32_bf16 a[84:87], a[244:247], v[216:219], a[84:87]
v_exp_f32 v174, v174
v_mfma_f32_16x16x32_bf16 a[84:87], a[212:215], v[200:203], a[84:87]
v_exp_f32 v175, v175
v_mfma_f32_16x16x32_bf16 a[20:23], a[244:247], v[208:211], a[20:23]
ds_read_b128 a[224:227], v2 offset:8192
v_cvt_pk_bf16_f32 v220, v172, v173
v_mfma_f32_16x16x32_bf16 a[24:27], a[248:251], v[208:211], a[24:27]
v_exp_f32 v188, v188
v_mfma_f32_16x16x32_bf16 a[88:91], a[216:219], v[200:203], a[88:91]
v_exp_f32 v189, v189
v_mfma_f32_16x16x32_bf16 a[88:91], a[248:251], v[216:219], a[88:91]
ds_read_b128 a[228:231], v2 offset:9216
v_cvt_pk_bf16_f32 v221, v174, v175
v_mfma_f32_16x16x32_bf16 a[92:95], a[252:255], v[216:219], a[92:95]
v_exp_f32 v190, v190
v_mfma_f32_16x16x32_bf16 a[92:95], a[220:223], v[200:203], a[92:95]
ds_read_b128 a[232:235], v2 offset:10240
v_cvt_pk_bf16_f32 v222, v188, v189
v_mfma_f32_16x16x32_bf16 a[28:31], a[252:255], v[208:211], a[28:31]
v_exp_f32 v191, v191
v_mfma_f32_16x16x32_bf16 v[136:139], a[128:131], v[48:51], v[88:91]
buffer_load_dwordx4 v1, s[44:47], s72 offen offset:2048 sc1 lds
v_mfma_f32_16x16x32_bf16 v[136:139], a[132:135], v[52:55], v[136:139]
v_exp_f32 v168, v168
v_mfma_f32_16x16x32_bf16 v[136:139], a[136:139], v[56:59], v[136:139]
ds_read_b128 a[236:239], v2 offset:11264
v_cvt_pk_bf16_f32 v223, v190, v191
v_mfma_f32_16x16x32_bf16 v[136:139], a[140:143], v[60:63], v[136:139]
v_exp_f32 v169, v169
v_mfma_f32_16x16x32_bf16 v[152:155], a[156:159], v[60:63], v[88:91]
ds_read_b128 a[240:243], v2 offset:12288
v_cvt_pk_bf16_f32 v216, v168, v169
v_mfma_f32_16x16x32_bf16 v[152:155], a[152:155], v[56:59], v[152:155]
v_exp_f32 v170, v170
v_mfma_f32_16x16x32_bf16 v[152:155], a[148:151], v[52:55], v[152:155]
v_exp_f32 v171, v171
v_mfma_f32_16x16x32_bf16 v[152:155], a[144:147], v[48:51], v[152:155]
ds_read_b128 a[244:247], v2 offset:13312
v_cvt_pk_bf16_f32 v217, v170, v171
v_mfma_f32_16x16x32_bf16 v[140:143], a[128:131], v[64:67], v[92:95]
v_exp_f32 v184, v184
v_mfma_f32_16x16x32_bf16 v[140:143], a[132:135], v[68:71], v[140:143]
ds_read_b128 a[248:251], v2 offset:14336
v_mfma_f32_16x16x32_bf16 v[140:143], a[136:139], v[72:75], v[140:143]
v_exp_f32 v185, v185
v_mfma_f32_16x16x32_bf16 v[140:143], a[140:143], v[76:79], v[140:143]
buffer_load_dwordx4 v1, s[44:47], s72 offen offset:3072 sc1 lds
v_mfma_f32_16x16x32_bf16 v[156:159], a[156:159], v[76:79], v[92:95]
ds_read_b128 a[252:255], v2 offset:15360
v_cvt_pk_bf16_f32 v218, v184, v185
v_mfma_f32_16x16x32_bf16 v[156:159], a[152:155], v[72:75], v[156:159]
v_exp_f32 v186, v186
v_mfma_f32_16x16x32_bf16 v[156:159], a[148:151], v[68:71], v[156:159]
s_waitcnt vmcnt(12) lgkmcnt(4)
v_exp_f32 v187, v187
v_mfma_f32_16x16x32_bf16 v[156:159], a[144:147], v[64:67], v[156:159]
s_barrier
v_cvt_pk_bf16_f32 v219, v186, v187
v_add_u32 v2, s82, v1
v_mfma_f32_16x16x32_bf16 v[228:231], v[120:123], v[196:199], v[228:231]
s_xor_b32 s74, s82, 0x10000
v_exp_f32 v136, v136
v_mfma_f32_16x16x32_bf16 v[228:231], v[120:123], v[212:215], v[228:231]
s_add_u32 s74, s74, s64
ds_read_b128 a[128:131], v2 offset:16384
v_add_u32 v5, s92, v5
v_mfma_f32_16x16x32_bf16 v[236:239], v[120:123], v[204:207], v[236:239]
s_add_u32 s81, s81, 0x8000
v_exp_f32 v137, v137
v_mfma_f32_16x16x32_bf16 v[236:239], v[120:123], v[220:223], v[236:239]
s_add_u32 m0, s74, 16384
ds_read_b128 a[132:135], v2 offset:17408
v_cvt_pk_bf16_f32 v200, v136, v137
v_mfma_f32_16x16x32_bf16 a[32:35], a[192:195], v[196:199], a[32:35]
s_add_u32 s72, s81, 16384
buffer_load_dwordx4 v1, s[44:47], s72 offen sc1 lds
v_mfma_f32_16x16x32_bf16 a[32:35], a[224:227], v[212:215], a[32:35]
s_add_u32 s69, s93, 0x4200000
v_exp_f32 v138, v138
v_mfma_f32_16x16x32_bf16 a[96:99], a[224:227], v[220:223], a[96:99]
ds_read_b128 a[136:139], v2 offset:18432
v_cndmask_b32 v5, v250, v5, vcc
v_mfma_f32_16x16x32_bf16 a[96:99], a[192:195], v[204:207], a[96:99]
v_exp_f32 v139, v139
v_mfma_f32_16x16x32_bf16 a[100:103], a[196:199], v[204:207], a[100:103]
ds_read_b128 a[140:143], v2 offset:19456
v_cvt_pk_bf16_f32 v201, v138, v139
v_mfma_f32_16x16x32_bf16 a[100:103], a[228:231], v[220:223], a[100:103]
buffer_store_dwordx4 v[112:115], v1, s[44:47], s69 offen sc1
v_mfma_f32_16x16x32_bf16 a[36:39], a[228:231], v[212:215], a[36:39]
v_exp_f32 v152, v152
v_mfma_f32_16x16x32_bf16 a[36:39], a[196:199], v[196:199], a[36:39]
ds_read_b128 a[144:147], v2 offset:20480
v_add_u32 v253, s58, v251
v_mfma_f32_16x16x32_bf16 a[40:43], a[200:203], v[196:199], a[40:43]
v_exp_f32 v153, v153
v_mfma_f32_16x16x32_bf16 a[40:43], a[232:235], v[212:215], a[40:43]
ds_read_b128 a[148:151], v2 offset:21504
v_cvt_pk_bf16_f32 v202, v152, v153
v_mfma_f32_16x16x32_bf16 a[104:107], a[232:235], v[220:223], a[104:107]
buffer_load_dwordx4 v1, s[44:47], s72 offen offset:1024 sc1 lds
v_mfma_f32_16x16x32_bf16 a[104:107], a[200:203], v[204:207], a[104:107]
v_exp_f32 v154, v154
v_mfma_f32_16x16x32_bf16 a[108:111], a[204:207], v[204:207], a[108:111]
ds_read_b128 a[152:155], v2 offset:22528
v_and_b32 v253, 3, v253
v_mfma_f32_16x16x32_bf16 a[108:111], a[236:239], v[220:223], a[108:111]
v_exp_f32 v155, v155
v_mfma_f32_16x16x32_bf16 a[44:47], a[236:239], v[212:215], a[44:47]
ds_read_b128 a[156:159], v2 offset:23552
v_cvt_pk_bf16_f32 v203, v154, v155
v_mfma_f32_16x16x32_bf16 a[44:47], a[204:207], v[196:199], a[44:47]
buffer_store_dwordx4 v[112:115], v1, s[44:47], s69 offen offset:1024 sc1
v_mfma_f32_16x16x32_bf16 a[48:51], a[208:211], v[196:199], a[48:51]
s_waitcnt lgkmcnt(8)
v_exp_f32 v140, v140
v_mfma_f32_16x16x32_bf16 a[48:51], a[240:243], v[212:215], a[48:51]
ds_read_b128 a[192:195], v2 offset:0
v_mul_u32_u24 v253, 4160, v253
v_mfma_f32_16x16x32_bf16 a[112:115], a[240:243], v[220:223], a[112:115]
v_exp_f32 v141, v141
v_mfma_f32_16x16x32_bf16 a[112:115], a[208:211], v[204:207], a[112:115]
ds_read_b128 a[196:199], v2 offset:1024
v_add_u32 v5, v5, v253
v_mfma_f32_16x16x32_bf16 a[116:119], a[212:215], v[204:207], a[116:119]
s_add_u32 s73, s62, 480
buffer_load_dwordx4 v1, s[44:47], s72 offen offset:2048 sc1 lds
v_mfma_f32_16x16x32_bf16 a[116:119], a[244:247], v[220:223], a[116:119]
v_exp_f32 v142, v142
v_mfma_f32_16x16x32_bf16 a[52:55], a[244:247], v[212:215], a[52:55]
ds_read_b128 a[200:203], v2 offset:2048
v_lshlrev_b32 v248, 5, v240
v_mfma_f32_16x16x32_bf16 a[52:55], a[212:215], v[196:199], a[52:55]
v_exp_f32 v143, v143
v_mfma_f32_16x16x32_bf16 a[56:59], a[216:219], v[196:199], a[56:59]
ds_read_b128 a[204:207], v2 offset:3072
v_sub_u32 v248, s73, v248
v_mfma_f32_16x16x32_bf16 a[56:59], a[248:251], v[212:215], a[56:59]
buffer_store_dwordx4 v[112:115], v1, s[44:47], s69 offen offset:2048 sc1
v_mfma_f32_16x16x32_bf16 a[120:123], a[248:251], v[220:223], a[120:123]
v_exp_f32 v156, v156
v_mfma_f32_16x16x32_bf16 a[120:123], a[216:219], v[204:207], a[120:123]
ds_read_b128 a[208:211], v2 offset:4096
v_lshl_add_u32 v7, v241, 4, v248
v_mfma_f32_16x16x32_bf16 a[124:127], a[220:223], v[204:207], a[124:127]
s_and_b32 s73, s58, 1
v_exp_f32 v157, v157
v_mfma_f32_16x16x32_bf16 a[124:127], a[252:255], v[220:223], a[124:127]
s_lshl_b32 s73, s73, 4
ds_read_b128 a[212:215], v2 offset:5120
v_mfma_f32_16x16x32_bf16 a[60:63], a[252:255], v[212:215], a[60:63]
s_lshr_b32 s73, s90, s73
buffer_load_dwordx4 v1, s[44:47], s72 offen offset:3072 sc1 lds
v_mfma_f32_16x16x32_bf16 a[60:63], a[220:223], v[196:199], a[60:63]
s_and_b32 s73, s73, 0xffff
ds_read_b128 a[216:219], v2 offset:6144
v_cvt_pk_bf16_f32 v204, v140, v141
v_mfma_f32_16x16x32_bf16 v[172:175], a[160:163], v[64:67], v[92:95]
v_exp_f32 v158, v158
v_mfma_f32_16x16x32_bf16 v[172:175], a[164:167], v[68:71], v[172:175]
ds_read_b128 a[220:223], v2 offset:7168
v_cvt_pk_bf16_f32 v205, v142, v143
v_mfma_f32_16x16x32_bf16 v[172:175], a[168:171], v[72:75], v[172:175]
v_exp_f32 v159, v159
v_mfma_f32_16x16x32_bf16 v[172:175], a[172:175], v[76:79], v[172:175]
buffer_store_dwordx4 v[112:115], v1, s[44:47], s69 offen offset:3072 sc1
v_mfma_f32_16x16x32_bf16 v[188:191], a[188:191], v[76:79], v[92:95]
v_cvt_pk_bf16_f32 v206, v156, v157
v_cvt_pk_bf16_f32 v207, v158, v159
v_mfma_f32_16x16x32_bf16 v[188:191], a[184:187], v[72:75], v[188:191]
v_lshl_add_u32 v248, v241, 3, v240
v_sub_u32 v248, 15, v248
v_mfma_f32_16x16x32_bf16 v[188:191], a[180:183], v[68:71], v[188:191]
v_and_b32 v249, 1, v248
v_lshlrev_b32 v249, 4, v249
v_mfma_f32_16x16x32_bf16 v[188:191], a[176:179], v[64:67], v[188:191]
v_lshlrev_b32 v249, v249, s73
v_lshrrev_b32 v248, 1, v248
v_mfma_f32_16x16x32_bf16 v[168:171], a[160:163], v[48:51], v[88:91]
v_and_b32 v241, 3, v0
v_cmp_eq_u32 vcc, 0, v248
v_mfma_f32_16x16x32_bf16 v[168:171], a[164:167], v[52:55], v[168:171]
v_lshl_add_u32 v5, v241, 3, v5
v_cndmask_b32 v8, 0, v249, vcc
v_mfma_f32_16x16x32_bf16 v[168:171], a[168:171], v[56:59], v[168:171]
v_cmp_eq_u32 vcc, 1, v248
v_lshlrev_b32 v240, 4, v251
v_mfma_f32_16x16x32_bf16 v[168:171], a[172:175], v[60:63], v[168:171]
v_cndmask_b32 v9, 0, v249, vcc
v_cmp_eq_u32 vcc, 2, v248
v_mfma_f32_16x16x32_bf16 v[184:187], a[188:191], v[60:63], v[88:91]
v_sub_u32 v240, 48, v240
v_lshlrev_b64 v[12:13], 16, s[88:89]
v_mfma_f32_16x16x32_bf16 v[184:187], a[184:187], v[56:59], v[184:187]
v_cndmask_b32 v10, 0, v249, vcc
v_cmp_eq_u32 vcc, 3, v248
v_mfma_f32_16x16x32_bf16 v[184:187], a[180:183], v[52:55], v[184:187]
v_lshlrev_b64 v[12:13], v240, v[12:13]
v_cndmask_b32 v11, 0, v249, vcc
v_mfma_f32_16x16x32_bf16 v[184:187], a[176:179], v[48:51], v[184:187]
s_waitcnt lgkmcnt(4)
v_cmp_eq_u32 vcc, 3, v241
s_add_u32 s73, s62, 4096
v_lshl_add_u32 v14, v0, 3, s73
v_cndmask_b32 v12, 0, v12, vcc
v_cndmask_b32 v13, 0, v13, vcc
v_lshrrev_b32 v15, 4, v0
v_lshlrev_b32 v15, 1, v15
v_and_b32 v240, 7, v0
v_xor_b32 v15, v15, v240
v_lshlrev_b32 v15, 4, v15
v_lshrrev_b32 v240, 3, v0
v_lshl_add_u32 v15, v240, 11, v15
s_lshr_b32 s75, s59, 1
s_and_b32 s75, s75, 8
s_add_u32 s75, s75, s60
s_lshl_b32 s76, s65, 2
s_lshr_b32 s80, s59, 2
s_and_b32 s80, s80, 3
s_add_u32 s76, s76, s80
s_lshl_b32 s94, s58, 16
s_lshl_b32 s80, s76, 7
s_add_u32 s94, s94, s80
s_lshl_b32 s80, s75, 18
s_add_u32 s80, s80, s94
v_rcp_f32 v224, v224
v_rcp_f32 v228, v228
s_lshl_b32 s73, s52, 12
s_add_u32 s73, s73, 0x2000000
s_lshl_b32 s70, s67, 2
s_add_u32 s70, s70, s73
v_mov_b32 v225, v224
v_accvgpr_read_b32 v240, a0
v_accvgpr_read_b32 v241, a1
v_accvgpr_read_b32 v242, a2
v_accvgpr_read_b32 v243, a3
v_accvgpr_read_b32 v244, a4
v_accvgpr_read_b32 v245, a5
v_accvgpr_read_b32 v246, a6
v_accvgpr_read_b32 v247, a7
v_pk_mul_f32 v[240:241], v[240:241], v[224:225]
v_pk_mul_f32 v[242:243], v[242:243], v[224:225]
v_pk_mul_f32 v[244:245], v[244:245], v[224:225]
v_pk_mul_f32 v[246:247], v[246:247], v[224:225]
v_cvt_pk_bf16_f32 v128, v240, v241
v_cvt_pk_bf16_f32 v129, v242, v243
v_cvt_pk_bf16_f32 v130, v244, v245
v_cvt_pk_bf16_f32 v131, v246, v247
v_accvgpr_read_b32 v248, a8
v_accvgpr_read_b32 v249, a9
v_accvgpr_read_b32 v250, a10
v_accvgpr_read_b32 v251, a11
v_accvgpr_read_b32 v252, a12
v_accvgpr_read_b32 v253, a13
v_accvgpr_read_b32 v254, a14
v_accvgpr_read_b32 v255, a15
v_pk_mul_f32 v[248:249], v[248:249], v[224:225]
v_pk_mul_f32 v[250:251], v[250:251], v[224:225]
v_pk_mul_f32 v[252:253], v[252:253], v[224:225]
v_pk_mul_f32 v[254:255], v[254:255], v[224:225]
v_cvt_pk_bf16_f32 v144, v248, v249
v_cvt_pk_bf16_f32 v145, v250, v251
v_cvt_pk_bf16_f32 v146, v252, v253
v_cvt_pk_bf16_f32 v147, v254, v255
v_accvgpr_read_b32 v240, a16
v_accvgpr_read_b32 v241, a17
v_accvgpr_read_b32 v242, a18
v_accvgpr_read_b32 v243, a19
v_accvgpr_read_b32 v244, a20
v_accvgpr_read_b32 v245, a21
v_accvgpr_read_b32 v246, a22
v_accvgpr_read_b32 v247, a23
v_pk_mul_f32 v[240:241], v[240:241], v[224:225]
v_pk_mul_f32 v[242:243], v[242:243], v[224:225]
v_pk_mul_f32 v[244:245], v[244:245], v[224:225]
v_pk_mul_f32 v[246:247], v[246:247], v[224:225]
v_cvt_pk_bf16_f32 v160, v240, v241
v_cvt_pk_bf16_f32 v161, v242, v243
v_cvt_pk_bf16_f32 v162, v244, v245
v_cvt_pk_bf16_f32 v163, v246, v247
v_accvgpr_read_b32 v248, a24
v_accvgpr_read_b32 v249, a25
v_accvgpr_read_b32 v250, a26
v_accvgpr_read_b32 v251, a27
v_accvgpr_read_b32 v252, a28
v_accvgpr_read_b32 v253, a29
v_accvgpr_read_b32 v254, a30
v_accvgpr_read_b32 v255, a31
v_pk_mul_f32 v[248:249], v[248:249], v[224:225]
v_pk_mul_f32 v[250:251], v[250:251], v[224:225]
v_pk_mul_f32 v[252:253], v[252:253], v[224:225]
v_pk_mul_f32 v[254:255], v[254:255], v[224:225]
v_cvt_pk_bf16_f32 v176, v248, v249
v_cvt_pk_bf16_f32 v177, v250, v251
v_cvt_pk_bf16_f32 v178, v252, v253
v_cvt_pk_bf16_f32 v179, v254, v255
v_mov_b32 v229, v228
v_accvgpr_read_b32 v240, a32
v_accvgpr_read_b32 v241, a33
v_accvgpr_read_b32 v242, a34
v_accvgpr_read_b32 v243, a35
v_accvgpr_read_b32 v244, a36
v_accvgpr_read_b32 v245, a37
v_accvgpr_read_b32 v246, a38
v_accvgpr_read_b32 v247, a39
v_pk_mul_f32 v[240:241], v[240:241], v[228:229]
v_pk_mul_f32 v[242:243], v[242:243], v[228:229]
v_pk_mul_f32 v[244:245], v[244:245], v[228:229]
v_pk_mul_f32 v[246:247], v[246:247], v[228:229]
v_cvt_pk_bf16_f32 v132, v240, v241
v_cvt_pk_bf16_f32 v133, v242, v243
v_cvt_pk_bf16_f32 v134, v244, v245
v_cvt_pk_bf16_f32 v135, v246, v247
v_accvgpr_read_b32 v248, a40
Lstub5:
s_cbranch_execz Lstub9
v_accvgpr_read_b32 v249, a41
v_accvgpr_read_b32 v250, a42
v_accvgpr_read_b32 v251, a43
v_accvgpr_read_b32 v252, a44
v_accvgpr_read_b32 v253, a45
v_accvgpr_read_b32 v254, a46
v_accvgpr_read_b32 v255, a47
v_pk_mul_f32 v[248:249], v[248:249], v[228:229]
v_pk_mul_f32 v[250:251], v[250:251], v[228:229]
v_pk_mul_f32 v[252:253], v[252:253], v[228:229]
v_pk_mul_f32 v[254:255], v[254:255], v[228:229]
v_cvt_pk_bf16_f32 v148, v248, v249
v_cvt_pk_bf16_f32 v149, v250, v251
v_cvt_pk_bf16_f32 v150, v252, v253
v_cvt_pk_bf16_f32 v151, v254, v255
v_accvgpr_read_b32 v240, a48
v_accvgpr_read_b32 v241, a49
v_accvgpr_read_b32 v242, a50
v_accvgpr_read_b32 v243, a51
v_accvgpr_read_b32 v244, a52
v_accvgpr_read_b32 v245, a53
v_accvgpr_read_b32 v246, a54
v_accvgpr_read_b32 v247, a55
v_pk_mul_f32 v[240:241], v[240:241], v[228:229]
v_pk_mul_f32 v[242:243], v[242:243], v[228:229]
v_pk_mul_f32 v[244:245], v[244:245], v[228:229]
v_pk_mul_f32 v[246:247], v[246:247], v[228:229]
v_cvt_pk_bf16_f32 v164, v240, v241
v_cvt_pk_bf16_f32 v165, v242, v243
v_cvt_pk_bf16_f32 v166, v244, v245
v_cvt_pk_bf16_f32 v167, v246, v247
v_accvgpr_read_b32 v248, a56
v_accvgpr_read_b32 v249, a57
v_accvgpr_read_b32 v250, a58
v_accvgpr_read_b32 v251, a59
v_accvgpr_read_b32 v252, a60
v_accvgpr_read_b32 v253, a61
v_accvgpr_read_b32 v254, a62
v_accvgpr_read_b32 v255, a63
v_pk_mul_f32 v[248:249], v[248:249], v[228:229]
v_pk_mul_f32 v[250:251], v[250:251], v[228:229]
v_pk_mul_f32 v[252:253], v[252:253], v[228:229]
v_pk_mul_f32 v[254:255], v[254:255], v[228:229]
v_cvt_pk_bf16_f32 v180, v248, v249
v_cvt_pk_bf16_f32 v181, v250, v251
v_cvt_pk_bf16_f32 v182, v252, v253
v_cvt_pk_bf16_f32 v183, v254, v255
v_mfma_f32_16x16x32_bf16 v[232:235], v[120:123], v[216:219], v[232:235]
s_add_u32 s82, s82, 0x8000
ds_read_b128 a[160:163], v2 offset:24576
ds_read_b128 a[164:167], v2 offset:25600
v_mfma_f32_16x16x32_bf16 v[232:235], v[120:123], v[200:203], v[232:235]
s_and_b32 s82, s82, 0x1ffff
v_exp_f32 v172, v172
v_mfma_f32_16x16x32_bf16 a[64:67], a[224:227], v[216:219], a[64:67]
s_add_u32 m0, s74, 0
v_exp_f32 v173, v173
v_mfma_f32_16x16x32_bf16 a[64:67], a[192:195], v[200:203], a[64:67]
s_add_u32 s72, s81, 0
buffer_load_dwordx4 v1, s[44:47], s72 offen sc1 lds
v_mfma_f32_16x16x32_bf16 a[68:71], a[196:199], v[200:203], a[68:71]
ds_read_b128 a[168:171], v2 offset:26624
v_cvt_pk_bf16_f32 v220, v172, v173
v_mfma_f32_16x16x32_bf16 a[68:71], a[228:231], v[216:219], a[68:71]
v_exp_f32 v174, v174
v_mfma_f32_16x16x32_bf16 a[72:75], a[232:235], v[216:219], a[72:75]
s_nop 0
ds_read_b128 a[172:175], v2 offset:27648
ds_read_b128 a[176:179], v2 offset:28672
v_mfma_f32_16x16x32_bf16 a[72:75], a[200:203], v[200:203], a[72:75]
v_exp_f32 v175, v175
v_mfma_f32_16x16x32_bf16 a[76:79], a[204:207], v[200:203], a[76:79]
v_exp_f32 v188, v188
v_mfma_f32_16x16x32_bf16 a[76:79], a[236:239], v[216:219], a[76:79]
buffer_store_dwordx4 v[128:131], v1, s[44:47], s70 offen sc1
v_mfma_f32_16x16x32_bf16 a[80:83], a[240:243], v[216:219], a[80:83]
s_waitcnt lgkmcnt(5)
ds_read_b128 a[180:183], v2 offset:29696
v_cvt_pk_bf16_f32 v221, v174, v175
v_mfma_f32_16x16x32_bf16 a[80:83], a[208:211], v[200:203], a[80:83]
v_exp_f32 v189, v189
v_mfma_f32_16x16x32_bf16 a[84:87], a[212:215], v[200:203], a[84:87]
ds_read_b128 a[184:187], v2 offset:30720
v_cvt_pk_bf16_f32 v222, v188, v189
v_mfma_f32_16x16x32_bf16 a[84:87], a[244:247], v[216:219], a[84:87]
v_exp_f32 v190, v190
v_mfma_f32_16x16x32_bf16 a[88:91], a[248:251], v[216:219], a[88:91]
buffer_load_dwordx4 v1, s[44:47], s72 offen offset:1024 sc1 lds
v_mfma_f32_16x16x32_bf16 a[88:91], a[216:219], v[200:203], a[88:91]
s_nop 0
ds_read_b128 a[188:191], v2 offset:31744
ds_read_b128 a[224:227], v2 offset:8192
v_mfma_f32_16x16x32_bf16 a[92:95], a[220:223], v[200:203], a[92:95]
v_exp_f32 v191, v191
v_mfma_f32_16x16x32_bf16 a[92:95], a[252:255], v[216:219], a[92:95]
v_exp_f32 v168, v168
v_mfma_f32_16x16x32_bf16 v[136:139], a[128:131], v[48:51], v[88:91]
ds_read_b128 a[228:231], v2 offset:9216
v_cvt_pk_bf16_f32 v223, v190, v191
v_mfma_f32_16x16x32_bf16 v[136:139], a[132:135], v[52:55], v[136:139]
v_exp_f32 v169, v169
v_mfma_f32_16x16x32_bf16 v[136:139], a[136:139], v[56:59], v[136:139]
buffer_store_dwordx4 v[144:147], v1, s[44:47], s70 offen offset:1024 sc1
v_mfma_f32_16x16x32_bf16 v[136:139], a[140:143], v[60:63], v[136:139]
ds_read_b128 a[232:235], v2 offset:10240
v_cvt_pk_bf16_f32 v216, v168, v169
v_mfma_f32_16x16x32_bf16 v[152:155], a[156:159], v[60:63], v[88:91]
v_exp_f32 v170, v170
v_mfma_f32_16x16x32_bf16 v[152:155], a[152:155], v[56:59], v[152:155]
s_nop 0
ds_read_b128 a[236:239], v2 offset:11264
ds_read_b128 a[240:243], v2 offset:12288
v_mfma_f32_16x16x32_bf16 v[152:155], a[148:151], v[52:55], v[152:155]
v_exp_f32 v171, v171
v_mfma_f32_16x16x32_bf16 v[152:155], a[144:147], v[48:51], v[152:155]
buffer_load_dwordx4 v1, s[44:47], s72 offen offset:2048 sc1 lds
v_mfma_f32_16x16x32_bf16 v[140:143], a[128:131], v[64:67], v[92:95]
v_exp_f32 v184, v184
v_mfma_f32_16x16x32_bf16 v[140:143], a[132:135], v[68:71], v[140:143]
ds_read_b128 a[244:247], v2 offset:13312
v_cvt_pk_bf16_f32 v217, v170, v171
v_mfma_f32_16x16x32_bf16 v[140:143], a[136:139], v[72:75], v[140:143]
v_exp_f32 v185, v185
v_mfma_f32_16x16x32_bf16 v[140:143], a[140:143], v[76:79], v[140:143]
s_nop 0
ds_read_b128 a[248:251], v2 offset:14336
ds_read_b128 a[252:255], v2 offset:15360
v_mfma_f32_16x16x32_bf16 v[156:159], a[156:159], v[76:79], v[92:95]
v_exp_f32 v186, v186
v_mfma_f32_16x16x32_bf16 v[156:159], a[152:155], v[72:75], v[156:159]
buffer_load_dwordx4 v1, s[44:47], s72 offen offset:3072 sc1 lds
v_mfma_f32_16x16x32_bf16 v[156:159], a[148:151], v[68:71], v[156:159]
s_waitcnt vmcnt(14) lgkmcnt(4)
v_exp_f32 v187, v187
v_mfma_f32_16x16x32_bf16 v[156:159], a[144:147], v[64:67], v[156:159]
s_barrier
v_cvt_pk_bf16_f32 v218, v184, v185
v_cvt_pk_bf16_f32 v219, v186, v187
v_add_u32 v2, s82, v1
v_mfma_f32_16x16x32_bf16 v[236:239], v[120:123], v[204:207], v[236:239]
s_xor_b32 s74, s82, 0x10000
v_exp_f32 v136, v136
v_mfma_f32_16x16x32_bf16 v[236:239], v[120:123], v[220:223], v[236:239]
s_add_u32 s74, s74, s64
ds_read_b128 a[128:131], v2 offset:16384
ds_read_b128 a[132:135], v2 offset:17408
v_mfma_f32_16x16x32_bf16 a[96:99], a[192:195], v[204:207], a[96:99]
s_add_u32 s81, s81, 0x8000
v_exp_f32 v137, v137
v_mfma_f32_16x16x32_bf16 a[96:99], a[224:227], v[220:223], a[96:99]
s_add_u32 m0, s74, 16384
v_exp_f32 v138, v138
v_mfma_f32_16x16x32_bf16 a[100:103], a[228:231], v[220:223], a[100:103]
s_add_u32 s72, s81, 16384
buffer_load_dwordx4 v1, s[44:47], s72 offen sc1 lds
v_mfma_f32_16x16x32_bf16 a[100:103], a[196:199], v[204:207], a[100:103]
ds_read_b128 a[136:139], v2 offset:18432
v_cvt_pk_bf16_f32 v200, v136, v137
v_mfma_f32_16x16x32_bf16 a[104:107], a[200:203], v[204:207], a[104:107]
v_exp_f32 v139, v139
v_mfma_f32_16x16x32_bf16 a[104:107], a[232:235], v[220:223], a[104:107]
ds_read_b128 a[140:143], v2 offset:19456
v_cvt_pk_bf16_f32 v201, v138, v139
v_mfma_f32_16x16x32_bf16 a[108:111], a[236:239], v[220:223], a[108:111]
buffer_store_dwordx4 v[160:163], v1, s[44:47], s70 offen offset:2048 sc1
v_mfma_f32_16x16x32_bf16 a[108:111], a[204:207], v[204:207], a[108:111]
v_exp_f32 v152, v152
v_mfma_f32_16x16x32_bf16 a[112:115], a[208:211], v[204:207], a[112:115]
s_waitcnt lgkmcnt(4)
ds_read_b128 a[144:147], v2 offset:20480
ds_read_b128 a[148:151], v2 offset:21504
v_mfma_f32_16x16x32_bf16 a[112:115], a[240:243], v[220:223], a[112:115]
v_exp_f32 v153, v153
v_mfma_f32_16x16x32_bf16 a[116:119], a[244:247], v[220:223], a[116:119]
buffer_load_dwordx4 v1, s[44:47], s72 offen offset:1024 sc1 lds
v_mfma_f32_16x16x32_bf16 a[116:119], a[212:215], v[204:207], a[116:119]
v_exp_f32 v154, v154
v_mfma_f32_16x16x32_bf16 a[120:123], a[216:219], v[204:207], a[120:123]
ds_read_b128 a[152:155], v2 offset:22528
v_cvt_pk_bf16_f32 v202, v152, v153
v_mfma_f32_16x16x32_bf16 a[120:123], a[248:251], v[220:223], a[120:123]
v_exp_f32 v155, v155
v_mfma_f32_16x16x32_bf16 a[124:127], a[252:255], v[220:223], a[124:127]
ds_read_b128 a[156:159], v2 offset:23552
v_cvt_pk_bf16_f32 v203, v154, v155
v_mfma_f32_16x16x32_bf16 a[124:127], a[220:223], v[204:207], a[124:127]
v_exp_f32 v140, v140
v_mfma_f32_16x16x32_bf16 v[172:175], a[160:163], v[64:67], v[92:95]
s_nop 0
ds_read_b128 a[192:195], v2 offset:0
ds_read_b128 a[196:199], v2 offset:1024
v_mfma_f32_16x16x32_bf16 v[172:175], a[164:167], v[68:71], v[172:175]
buffer_store_dwordx4 v[176:179], v1, s[44:47], s70 offen offset:3072 sc1
v_mfma_f32_16x16x32_bf16 v[172:175], a[168:171], v[72:75], v[172:175]
v_exp_f32 v141, v141
v_mfma_f32_16x16x32_bf16 v[172:175], a[172:175], v[76:79], v[172:175]
v_exp_f32 v142, v142
v_mfma_f32_16x16x32_bf16 v[188:191], a[188:191], v[76:79], v[92:95]
s_nop 0
ds_read_b128 a[200:203], v2 offset:2048
ds_read_b128 a[204:207], v2 offset:3072
v_mfma_f32_16x16x32_bf16 v[188:191], a[184:187], v[72:75], v[188:191]
buffer_load_dwordx4 v1, s[44:47], s72 offen offset:2048 sc1 lds
v_mfma_f32_16x16x32_bf16 v[188:191], a[180:183], v[68:71], v[188:191]
s_add_u32 s70, s70, 0x80000
v_exp_f32 v143, v143
v_mfma_f32_16x16x32_bf16 v[188:191], a[176:179], v[64:67], v[188:191]
v_exp_f32 v156, v156
v_mfma_f32_16x16x32_bf16 v[168:171], a[160:163], v[48:51], v[88:91]
s_nop 0
ds_read_b128 a[208:211], v2 offset:4096
ds_read_b128 a[212:215], v2 offset:5120
v_mfma_f32_16x16x32_bf16 v[168:171], a[164:167], v[52:55], v[168:171]
s_nop 0
ds_read_b128 a[216:219], v2 offset:6144
ds_read_b128 a[220:223], v2 offset:7168
v_mfma_f32_16x16x32_bf16 v[168:171], a[168:171], v[56:59], v[168:171]
v_cvt_pk_bf16_f32 v204, v140, v141
v_cvt_pk_bf16_f32 v205, v142, v143
v_mfma_f32_16x16x32_bf16 v[168:171], a[172:175], v[60:63], v[168:171]
buffer_store_dwordx4 v[132:135], v1, s[44:47], s70 offen sc1
v_mfma_f32_16x16x32_bf16 v[184:187], a[188:191], v[60:63], v[88:91]
v_exp_f32 v157, v157
v_mfma_f32_16x16x32_bf16 v[184:187], a[184:187], v[56:59], v[184:187]
v_exp_f32 v158, v158
v_mfma_f32_16x16x32_bf16 v[184:187], a[180:183], v[52:55], v[184:187]
buffer_load_dwordx4 v1, s[44:47], s72 offen offset:3072 sc1 lds
v_mfma_f32_16x16x32_bf16 v[184:187], a[176:179], v[48:51], v[184:187]
s_waitcnt lgkmcnt(4)
v_exp_f32 v159, v159
v_cvt_pk_bf16_f32 v206, v156, v157
v_cvt_pk_bf16_f32 v207, v158, v159
v_mfma_f32_16x16x32_bf16 v[232:235], v[120:123], v[216:219], v[232:235]
s_add_u32 s82, s82, 0x8000
ds_read_b128 a[160:163], v2 offset:24576
ds_read_b128 a[164:167], v2 offset:25600
v_mfma_f32_16x16x32_bf16 v[232:235], v[120:123], v[200:203], v[232:235]
s_and_b32 s82, s82, 0x1ffff
v_exp_f32 v172, v172
v_mfma_f32_16x16x32_bf16 a[64:67], a[224:227], v[216:219], a[64:67]
s_add_u32 m0, s74, 0
v_exp_f32 v173, v173
v_mfma_f32_16x16x32_bf16 a[64:67], a[192:195], v[200:203], a[64:67]
s_add_u32 s72, s81, 0
buffer_load_dwordx4 v1, s[44:47], s72 offen sc1 lds
v_mfma_f32_16x16x32_bf16 a[68:71], a[196:199], v[200:203], a[68:71]
ds_read_b128 a[168:171], v2 offset:26624
v_cvt_pk_bf16_f32 v220, v172, v173
v_mfma_f32_16x16x32_bf16 a[68:71], a[228:231], v[216:219], a[68:71]
v_exp_f32 v174, v174
v_mfma_f32_16x16x32_bf16 a[72:75], a[232:235], v[216:219], a[72:75]
s_nop 0
ds_read_b128 a[172:175], v2 offset:27648
ds_read_b128 a[176:179], v2 offset:28672
v_mfma_f32_16x16x32_bf16 a[72:75], a[200:203], v[200:203], a[72:75]
v_exp_f32 v175, v175
v_mfma_f32_16x16x32_bf16 a[76:79], a[204:207], v[200:203], a[76:79]
buffer_store_dwordx4 v[148:151], v1, s[44:47], s70 offen offset:1024 sc1
v_mfma_f32_16x16x32_bf16 a[76:79], a[236:239], v[216:219], a[76:79]
v_exp_f32 v188, v188
v_mfma_f32_16x16x32_bf16 a[80:83], a[240:243], v[216:219], a[80:83]
s_waitcnt lgkmcnt(5)
ds_read_b128 a[180:183], v2 offset:29696
v_cvt_pk_bf16_f32 v221, v174, v175
v_mfma_f32_16x16x32_bf16 a[80:83], a[208:211], v[200:203], a[80:83]
v_exp_f32 v189, v189
v_mfma_f32_16x16x32_bf16 a[84:87], a[212:215], v[200:203], a[84:87]
buffer_load_dwordx4 v1, s[44:47], s72 offen offset:1024 sc1 lds
v_mfma_f32_16x16x32_bf16 a[84:87], a[244:247], v[216:219], a[84:87]
ds_read_b128 a[184:187], v2 offset:30720
v_cvt_pk_bf16_f32 v222, v188, v189
v_mfma_f32_16x16x32_bf16 a[88:91], a[248:251], v[216:219], a[88:91]
v_exp_f32 v190, v190
v_mfma_f32_16x16x32_bf16 a[88:91], a[216:219], v[200:203], a[88:91]
s_nop 0
ds_read_b128 a[188:191], v2 offset:31744
ds_read_b128 a[224:227], v2 offset:8192
v_mfma_f32_16x16x32_bf16 a[92:95], a[220:223], v[200:203], a[92:95]
v_exp_f32 v191, v191
v_mfma_f32_16x16x32_bf16 a[92:95], a[252:255], v[216:219], a[92:95]
buffer_store_dwordx4 v[164:167], v1, s[44:47], s70 offen offset:2048 sc1
v_mfma_f32_16x16x32_bf16 v[136:139], a[128:131], v[48:51], v[88:91]
v_exp_f32 v168, v168
v_mfma_f32_16x16x32_bf16 v[136:139], a[132:135], v[52:55], v[136:139]
ds_read_b128 a[228:231], v2 offset:9216
v_cvt_pk_bf16_f32 v223, v190, v191
v_mfma_f32_16x16x32_bf16 v[136:139], a[136:139], v[56:59], v[136:139]
v_exp_f32 v169, v169
v_mfma_f32_16x16x32_bf16 v[136:139], a[140:143], v[60:63], v[136:139]
s_nop 0
ds_read_b128 a[232:235], v2 offset:10240
ds_read_b128 a[236:239], v2 offset:11264
v_mfma_f32_16x16x32_bf16 v[152:155], a[156:159], v[60:63], v[88:91]
v_exp_f32 v170, v170
v_mfma_f32_16x16x32_bf16 v[152:155], a[152:155], v[56:59], v[152:155]
buffer_load_dwordx4 v1, s[44:47], s72 offen offset:2048 sc1 lds
v_mfma_f32_16x16x32_bf16 v[152:155], a[148:151], v[52:55], v[152:155]
v_exp_f32 v171, v171
v_mfma_f32_16x16x32_bf16 v[152:155], a[144:147], v[48:51], v[152:155]
s_nop 0
ds_read_b128 a[240:243], v2 offset:12288
ds_read_b128 a[244:247], v2 offset:13312
v_mfma_f32_16x16x32_bf16 v[140:143], a[128:131], v[64:67], v[92:95]
v_exp_f32 v184, v184
v_mfma_f32_16x16x32_bf16 v[140:143], a[132:135], v[68:71], v[140:143]
s_nop 0
ds_read_b128 a[248:251], v2 offset:14336
ds_read_b128 a[252:255], v2 offset:15360
v_mfma_f32_16x16x32_bf16 v[140:143], a[136:139], v[72:75], v[140:143]
v_cvt_pk_bf16_f32 v216, v168, v169
v_cvt_pk_bf16_f32 v217, v170, v171
v_mfma_f32_16x16x32_bf16 v[140:143], a[140:143], v[76:79], v[140:143]
buffer_store_dwordx4 v[180:183], v1, s[44:47], s70 offen offset:3072 sc1
v_mfma_f32_16x16x32_bf16 v[156:159], a[156:159], v[76:79], v[92:95]
v_exp_f32 v185, v185
v_mfma_f32_16x16x32_bf16 v[156:159], a[152:155], v[72:75], v[156:159]
buffer_load_dwordx4 v1, s[44:47], s72 offen offset:3072 sc1 lds
v_mfma_f32_16x16x32_bf16 v[156:159], a[148:151], v[68:71], v[156:159]
s_waitcnt vmcnt(14) lgkmcnt(4)
v_exp_f32 v186, v186
v_mfma_f32_16x16x32_bf16 v[156:159], a[144:147], v[64:67], v[156:159]
s_barrier
v_exp_f32 v187, v187
v_add_u32 v2, s82, v1
v_cvt_pk_bf16_f32 v218, v184, v185
v_cvt_pk_bf16_f32 v219, v186, v187
s_lshl_b32 s83, s60, 2
s_sub_u32 s83, s83, 25
.p2align 5
s_nop 0
s_nop 0
LloopII:
v_mfma_f32_16x16x32_bf16 v[236:239], v[120:123], v[204:207], v[236:239]
s_xor_b32 s74, s82, 0x10000
v_exp_f32 v136, v136
v_mfma_f32_16x16x32_bf16 v[236:239], v[120:123], v[220:223], v[236:239]
s_add_u32 s74, s74, s64
ds_read_b128 a[128:131], v2 offset:16384
ds_read_b128 a[132:135], v2 offset:17408
v_mfma_f32_16x16x32_bf16 a[96:99], a[192:195], v[204:207], a[96:99]
s_add_u32 s81, s81, 0x8000
v_exp_f32 v137, v137
v_mfma_f32_16x16x32_bf16 a[96:99], a[224:227], v[220:223], a[96:99]
s_add_u32 m0, s74, 16384
v_exp_f32 v138, v138
v_mfma_f32_16x16x32_bf16 a[100:103], a[228:231], v[220:223], a[100:103]
s_add_u32 s72, s81, 16384
ds_read_b128 a[136:139], v2 offset:18432
v_cvt_pk_bf16_f32 v200, v136, v137
v_mfma_f32_16x16x32_bf16 a[100:103], a[196:199], v[204:207], a[100:103]
buffer_load_dwordx4 v1, s[44:47], s72 offen sc1 lds
v_mfma_f32_16x16x32_bf16 a[104:107], a[200:203], v[204:207], a[104:107]
v_exp_f32 v139, v139
v_mfma_f32_16x16x32_bf16 a[104:107], a[232:235], v[220:223], a[104:107]
ds_read_b128 a[140:143], v2 offset:19456
v_cvt_pk_bf16_f32 v201, v138, v139
v_mfma_f32_16x16x32_bf16 a[108:111], a[236:239], v[220:223], a[108:111]
v_exp_f32 v152, v152
v_mfma_f32_16x16x32_bf16 a[108:111], a[204:207], v[204:207], a[108:111]
s_nop 0
ds_read_b128 a[144:147], v2 offset:20480
ds_read_b128 a[148:151], v2 offset:21504
v_mfma_f32_16x16x32_bf16 a[112:115], a[208:211], v[204:207], a[112:115]
s_waitcnt lgkmcnt(6)
v_exp_f32 v153, v153
v_mfma_f32_16x16x32_bf16 a[112:115], a[240:243], v[220:223], a[112:115]
v_exp_f32 v154, v154
v_mfma_f32_16x16x32_bf16 a[116:119], a[244:247], v[220:223], a[116:119]
ds_read_b128 a[152:155], v2 offset:22528
v_cvt_pk_bf16_f32 v202, v152, v153
v_mfma_f32_16x16x32_bf16 a[116:119], a[212:215], v[204:207], a[116:119]
buffer_load_dwordx4 v1, s[44:47], s72 offen offset:1024 sc1 lds
v_mfma_f32_16x16x32_bf16 a[120:123], a[216:219], v[204:207], a[120:123]
v_exp_f32 v155, v155
v_mfma_f32_16x16x32_bf16 a[120:123], a[248:251], v[220:223], a[120:123]
ds_read_b128 a[156:159], v2 offset:23552
v_cvt_pk_bf16_f32 v203, v154, v155
v_mfma_f32_16x16x32_bf16 a[124:127], a[252:255], v[220:223], a[124:127]
v_exp_f32 v140, v140
v_mfma_f32_16x16x32_bf16 a[124:127], a[220:223], v[204:207], a[124:127]
s_nop 0
ds_read_b128 a[192:195], v2 offset:0
ds_read_b128 a[196:199], v2 offset:1024
v_mfma_f32_16x16x32_bf16 v[172:175], a[160:163], v[64:67], v[92:95]
v_exp_f32 v141, v141
v_mfma_f32_16x16x32_bf16 v[172:175], a[164:167], v[68:71], v[172:175]
v_exp_f32 v142, v142
v_mfma_f32_16x16x32_bf16 v[172:175], a[168:171], v[72:75], v[172:175]
ds_read_b128 a[200:203], v2 offset:2048
v_cvt_pk_bf16_f32 v204, v140, v141
v_mfma_f32_16x16x32_bf16 v[172:175], a[172:175], v[76:79], v[172:175]
buffer_load_dwordx4 v1, s[44:47], s72 offen offset:2048 sc1 lds
v_mfma_f32_16x16x32_bf16 v[188:191], a[188:191], v[76:79], v[92:95]
v_exp_f32 v143, v143
v_mfma_f32_16x16x32_bf16 v[188:191], a[184:187], v[72:75], v[188:191]
ds_read_b128 a[204:207], v2 offset:3072
v_cvt_pk_bf16_f32 v205, v142, v143
v_mfma_f32_16x16x32_bf16 v[188:191], a[180:183], v[68:71], v[188:191]
v_exp_f32 v156, v156
v_mfma_f32_16x16x32_bf16 v[188:191], a[176:179], v[64:67], v[188:191]
ds_read_b128 a[208:211], v2 offset:4096
v_mfma_f32_16x16x32_bf16 v[168:171], a[160:163], v[48:51], v[88:91]
v_exp_f32 v157, v157
v_mfma_f32_16x16x32_bf16 v[168:171], a[164:167], v[52:55], v[168:171]
ds_read_b128 a[212:215], v2 offset:5120
v_cvt_pk_bf16_f32 v206, v156, v157
v_mfma_f32_16x16x32_bf16 v[168:171], a[168:171], v[56:59], v[168:171]
v_exp_f32 v158, v158
v_mfma_f32_16x16x32_bf16 v[168:171], a[172:175], v[60:63], v[168:171]
ds_read_b128 a[216:219], v2 offset:6144
v_mfma_f32_16x16x32_bf16 v[184:187], a[188:191], v[60:63], v[88:91]
buffer_load_dwordx4 v1, s[44:47], s72 offen offset:3072 sc1 lds
v_mfma_f32_16x16x32_bf16 v[184:187], a[184:187], v[56:59], v[184:187]
v_exp_f32 v159, v159
v_mfma_f32_16x16x32_bf16 v[184:187], a[180:183], v[52:55], v[184:187]
ds_read_b128 a[220:223], v2 offset:7168
v_cvt_pk_bf16_f32 v207, v158, v159
v_mfma_f32_16x16x32_bf16 v[184:187], a[176:179], v[48:51], v[184:187]
s_waitcnt lgkmcnt(4)
v_mfma_f32_16x16x32_bf16 v[232:235], v[120:123], v[216:219], v[232:235]
s_add_u32 s82, s82, 0x8000
ds_read_b128 a[160:163], v2 offset:24576
ds_read_b128 a[164:167], v2 offset:25600
v_mfma_f32_16x16x32_bf16 v[232:235], v[120:123], v[200:203], v[232:235]
s_and_b32 s82, s82, 0x1ffff
v_exp_f32 v172, v172
v_mfma_f32_16x16x32_bf16 a[64:67], a[224:227], v[216:219], a[64:67]
s_add_u32 m0, s74, 0
v_exp_f32 v173, v173
v_mfma_f32_16x16x32_bf16 a[64:67], a[192:195], v[200:203], a[64:67]
s_add_u32 s72, s81, 0
ds_read_b128 a[168:171], v2 offset:26624
v_cvt_pk_bf16_f32 v220, v172, v173
v_mfma_f32_16x16x32_bf16 a[68:71], a[196:199], v[200:203], a[68:71]
v_exp_f32 v174, v174
v_mfma_f32_16x16x32_bf16 a[68:71], a[228:231], v[216:219], a[68:71]
buffer_load_dwordx4 v1, s[44:47], s72 offen sc1 lds
v_mfma_f32_16x16x32_bf16 a[72:75], a[232:235], v[216:219], a[72:75]
s_nop 0
ds_read_b128 a[172:175], v2 offset:27648
ds_read_b128 a[176:179], v2 offset:28672
v_mfma_f32_16x16x32_bf16 a[72:75], a[200:203], v[200:203], a[72:75]
v_exp_f32 v175, v175
v_mfma_f32_16x16x32_bf16 a[76:79], a[204:207], v[200:203], a[76:79]
v_exp_f32 v188, v188
v_mfma_f32_16x16x32_bf16 a[76:79], a[236:239], v[216:219], a[76:79]
ds_read_b128 a[180:183], v2 offset:29696
v_cvt_pk_bf16_f32 v221, v174, v175
v_mfma_f32_16x16x32_bf16 a[80:83], a[240:243], v[216:219], a[80:83]
s_waitcnt lgkmcnt(6)
v_exp_f32 v189, v189
v_mfma_f32_16x16x32_bf16 a[80:83], a[208:211], v[200:203], a[80:83]
ds_read_b128 a[184:187], v2 offset:30720
v_cvt_pk_bf16_f32 v222, v188, v189
v_mfma_f32_16x16x32_bf16 a[84:87], a[212:215], v[200:203], a[84:87]
buffer_load_dwordx4 v1, s[44:47], s72 offen offset:1024 sc1 lds
v_mfma_f32_16x16x32_bf16 a[84:87], a[244:247], v[216:219], a[84:87]
v_exp_f32 v190, v190
v_mfma_f32_16x16x32_bf16 a[88:91], a[248:251], v[216:219], a[88:91]
s_nop 0
ds_read_b128 a[188:191], v2 offset:31744
ds_read_b128 a[224:227], v2 offset:8192
v_mfma_f32_16x16x32_bf16 a[88:91], a[216:219], v[200:203], a[88:91]
v_exp_f32 v191, v191
v_mfma_f32_16x16x32_bf16 a[92:95], a[220:223], v[200:203], a[92:95]
v_exp_f32 v168, v168
v_mfma_f32_16x16x32_bf16 a[92:95], a[252:255], v[216:219], a[92:95]
ds_read_b128 a[228:231], v2 offset:9216
v_cvt_pk_bf16_f32 v223, v190, v191
v_mfma_f32_16x16x32_bf16 v[136:139], a[128:131], v[48:51], v[88:91]
v_exp_f32 v169, v169
v_mfma_f32_16x16x32_bf16 v[136:139], a[132:135], v[52:55], v[136:139]
ds_read_b128 a[232:235], v2 offset:10240
v_cvt_pk_bf16_f32 v216, v168, v169
v_mfma_f32_16x16x32_bf16 v[136:139], a[136:139], v[56:59], v[136:139]
buffer_load_dwordx4 v1, s[44:47], s72 offen offset:2048 sc1 lds
v_mfma_f32_16x16x32_bf16 v[136:139], a[140:143], v[60:63], v[136:139]
v_exp_f32 v170, v170
v_mfma_f32_16x16x32_bf16 v[152:155], a[156:159], v[60:63], v[88:91]
s_nop 0
ds_read_b128 a[236:239], v2 offset:11264
ds_read_b128 a[240:243], v2 offset:12288
v_mfma_f32_16x16x32_bf16 v[152:155], a[152:155], v[56:59], v[152:155]
v_exp_f32 v171, v171
v_mfma_f32_16x16x32_bf16 v[152:155], a[148:151], v[52:55], v[152:155]
v_exp_f32 v184, v184
v_mfma_f32_16x16x32_bf16 v[152:155], a[144:147], v[48:51], v[152:155]
ds_read_b128 a[244:247], v2 offset:13312
v_cvt_pk_bf16_f32 v217, v170, v171
v_mfma_f32_16x16x32_bf16 v[140:143], a[128:131], v[64:67], v[92:95]
v_exp_f32 v185, v185
v_mfma_f32_16x16x32_bf16 v[140:143], a[132:135], v[68:71], v[140:143]
ds_read_b128 a[248:251], v2 offset:14336
v_cvt_pk_bf16_f32 v218, v184, v185
v_mfma_f32_16x16x32_bf16 v[140:143], a[136:139], v[72:75], v[140:143]
buffer_load_dwordx4 v1, s[44:47], s72 offen offset:3072 sc1 lds
v_mfma_f32_16x16x32_bf16 v[140:143], a[140:143], v[76:79], v[140:143]
ds_read_b128 a[252:255], v2 offset:15360
v_add_u32 v2, s82, v1
v_mfma_f32_16x16x32_bf16 v[156:159], a[156:159], v[76:79], v[92:95]
s_waitcnt vmcnt(8) lgkmcnt(4)
v_exp_f32 v186, v186
v_mfma_f32_16x16x32_bf16 v[156:159], a[152:155], v[72:75], v[156:159]
s_barrier
v_exp_f32 v187, v187
v_mfma_f32_16x16x32_bf16 v[156:159], a[148:151], v[68:71], v[156:159]
s_add_u32 s83, s83, 1
v_cvt_pk_bf16_f32 v219, v186, v187
v_mfma_f32_16x16x32_bf16 v[156:159], a[144:147], v[64:67], v[156:159]
s_cbranch_scc0 LloopII
v_mfma_f32_16x16x32_bf16 v[236:239], v[120:123], v[204:207], v[236:239]
s_xor_b32 s74, s82, 0x10000
ds_read_b128 a[128:131], v2 offset:16384
ds_read_b128 a[132:135], v2 offset:17408
v_mfma_f32_16x16x32_bf16 v[236:239], v[120:123], v[220:223], v[236:239]
s_add_u32 s74, s74, s64
v_exp_f32 v136, v136
v_mfma_f32_16x16x32_bf16 a[96:99], a[192:195], v[204:207], a[96:99]
s_add_u32 s81, s81, 0x8000
v_exp_f32 v137, v137
v_mfma_f32_16x16x32_bf16 a[96:99], a[224:227], v[220:223], a[96:99]
s_add_u32 m0, s74, 0
ds_read_b128 a[136:139], v2 offset:18432
v_cvt_pk_bf16_f32 v200, v136, v137
v_mfma_f32_16x16x32_bf16 a[100:103], a[228:231], v[220:223], a[100:103]
s_add_u32 s72, s81, 0
v_exp_f32 v138, v138
v_mfma_f32_16x16x32_bf16 a[100:103], a[196:199], v[204:207], a[100:103]
buffer_load_dwordx4 v1, s[44:47], s72 offen sc1 lds
v_mfma_f32_16x16x32_bf16 a[104:107], a[200:203], v[204:207], a[104:107]
s_nop 0
ds_read_b128 a[140:143], v2 offset:19456
ds_read_b128 a[144:147], v2 offset:20480
v_mfma_f32_16x16x32_bf16 a[104:107], a[232:235], v[220:223], a[104:107]
v_exp_f32 v139, v139
v_mfma_f32_16x16x32_bf16 a[108:111], a[236:239], v[220:223], a[108:111]
v_exp_f32 v152, v152
v_mfma_f32_16x16x32_bf16 a[108:111], a[204:207], v[204:207], a[108:111]
ds_read_b128 a[148:151], v2 offset:21504
v_cvt_pk_bf16_f32 v201, v138, v139
v_mfma_f32_16x16x32_bf16 a[112:115], a[208:211], v[204:207], a[112:115]
s_waitcnt lgkmcnt(6)
v_exp_f32 v153, v153
v_mfma_f32_16x16x32_bf16 a[112:115], a[240:243], v[220:223], a[112:115]
ds_read_b128 a[152:155], v2 offset:22528
v_cvt_pk_bf16_f32 v202, v152, v153
v_mfma_f32_16x16x32_bf16 a[116:119], a[244:247], v[220:223], a[116:119]
v_exp_f32 v154, v154
v_mfma_f32_16x16x32_bf16 a[116:119], a[212:215], v[204:207], a[116:119]
buffer_load_dwordx4 v1, s[44:47], s72 offen offset:1024 sc1 lds
v_mfma_f32_16x16x32_bf16 a[120:123], a[216:219], v[204:207], a[120:123]
s_nop 0
ds_read_b128 a[156:159], v2 offset:23552
ds_read_b128 a[192:195], v2 offset:0
v_mfma_f32_16x16x32_bf16 a[120:123], a[248:251], v[220:223], a[120:123]
v_exp_f32 v155, v155
v_mfma_f32_16x16x32_bf16 a[124:127], a[252:255], v[220:223], a[124:127]
v_exp_f32 v140, v140
v_mfma_f32_16x16x32_bf16 a[124:127], a[220:223], v[204:207], a[124:127]
ds_read_b128 a[196:199], v2 offset:1024
v_cvt_pk_bf16_f32 v203, v154, v155
v_mfma_f32_16x16x32_bf16 v[172:175], a[160:163], v[64:67], v[92:95]
v_exp_f32 v141, v141
v_mfma_f32_16x16x32_bf16 v[172:175], a[164:167], v[68:71], v[172:175]
ds_read_b128 a[200:203], v2 offset:2048
v_cvt_pk_bf16_f32 v204, v140, v141
v_mfma_f32_16x16x32_bf16 v[172:175], a[168:171], v[72:75], v[172:175]
v_exp_f32 v142, v142
v_mfma_f32_16x16x32_bf16 v[172:175], a[172:175], v[76:79], v[172:175]
buffer_load_dwordx4 v1, s[44:47], s72 offen offset:2048 sc1 lds
v_mfma_f32_16x16x32_bf16 v[188:191], a[188:191], v[76:79], v[92:95]
ds_read_b128 a[204:207], v2 offset:3072
v_mfma_f32_16x16x32_bf16 v[188:191], a[184:187], v[72:75], v[188:191]
v_exp_f32 v143, v143
v_mfma_f32_16x16x32_bf16 v[188:191], a[180:183], v[68:71], v[188:191]
ds_read_b128 a[208:211], v2 offset:4096
v_cvt_pk_bf16_f32 v205, v142, v143
v_mfma_f32_16x16x32_bf16 v[188:191], a[176:179], v[64:67], v[188:191]
v_exp_f32 v156, v156
v_mfma_f32_16x16x32_bf16 v[168:171], a[160:163], v[48:51], v[88:91]
ds_read_b128 a[212:215], v2 offset:5120
v_mfma_f32_16x16x32_bf16 v[168:171], a[164:167], v[52:55], v[168:171]
Lstub6:
s_cbranch_execz Lstub10
v_exp_f32 v157, v157
v_mfma_f32_16x16x32_bf16 v[168:171], a[168:171], v[56:59], v[168:171]
ds_read_b128 a[216:219], v2 offset:6144
v_cvt_pk_bf16_f32 v206, v156, v157
v_mfma_f32_16x16x32_bf16 v[168:171], a[172:175], v[60:63], v[168:171]
buffer_load_dwordx4 v1, s[44:47], s72 offen offset:3072 sc1 lds
v_mfma_f32_16x16x32_bf16 v[184:187], a[188:191], v[60:63], v[88:91]
v_exp_f32 v158, v158
v_mfma_f32_16x16x32_bf16 v[184:187], a[184:187], v[56:59], v[184:187]
ds_read_b128 a[220:223], v2 offset:7168
v_mfma_f32_16x16x32_bf16 v[184:187], a[180:183], v[52:55], v[184:187]
s_waitcnt lgkmcnt(4)
v_exp_f32 v159, v159
v_mfma_f32_16x16x32_bf16 v[184:187], a[176:179], v[48:51], v[184:187]
s_barrier
v_cvt_pk_bf16_f32 v207, v158, v159
s_lshr_b32 s69, s93, 4
s_and_b32 s69, s69, 0x7f00
s_add_u32 s69, s69, LHT4-Lpc0
v_lshrrev_b32 v3, 5, v0
v_lshlrev_b32 v3, 7, v3
v_add_u32 v3, s69, v3
v_min_u32 v3, Lcode_end-Lpc0, v3
global_load_dword v4, v3, s[98:99]
v_mfma_f32_16x16x32_bf16 v[232:235], v[120:123], v[216:219], v[232:235]
s_add_u32 s82, s82, 0x8000
ds_read_b128 a[160:163], v2 offset:24576
ds_read_b128 a[164:167], v2 offset:25600
v_mfma_f32_16x16x32_bf16 v[232:235], v[120:123], v[200:203], v[232:235]
s_and_b32 s82, s82, 0x1ffff
v_exp_f32 v172, v172
v_mfma_f32_16x16x32_bf16 a[64:67], a[224:227], v[216:219], a[64:67]
s_add_u32 s66, s58, 3
v_exp_f32 v173, v173
v_mfma_f32_16x16x32_bf16 a[64:67], a[192:195], v[200:203], a[64:67]
s_and_b32 s66, s66, 3
ds_read_b128 a[168:171], v2 offset:26624
v_cvt_pk_bf16_f32 v220, v172, v173
v_mfma_f32_16x16x32_bf16 a[68:71], a[196:199], v[200:203], a[68:71]
s_mul_i32 s66, s66, 4160
v_exp_f32 v174, v174
v_mfma_f32_16x16x32_bf16 a[68:71], a[228:231], v[216:219], a[68:71]
s_add_u32 s66, s66, s92
ds_read_b128 a[172:175], v2 offset:27648
ds_read_b128 a[176:179], v2 offset:28672
v_mfma_f32_16x16x32_bf16 a[72:75], a[232:235], v[216:219], a[72:75]
s_add_u32 m0, s66, 32
v_exp_f32 v175, v175
v_mfma_f32_16x16x32_bf16 a[72:75], a[200:203], v[200:203], a[72:75]
s_add_u32 s72, s93, 0x6
buffer_load_dwordx4 v1, s[36:39], s72 offen lds
v_mfma_f32_16x16x32_bf16 a[76:79], a[204:207], v[200:203], a[76:79]
v_exp_f32 v188, v188
v_mfma_f32_16x16x32_bf16 a[76:79], a[236:239], v[216:219], a[76:79]
ds_read_b128 a[180:183], v2 offset:29696
v_cvt_pk_bf16_f32 v221, v174, v175
v_mfma_f32_16x16x32_bf16 a[80:83], a[240:243], v[216:219], a[80:83]
s_waitcnt lgkmcnt(6)
v_exp_f32 v189, v189
v_mfma_f32_16x16x32_bf16 a[80:83], a[208:211], v[200:203], a[80:83]
ds_read_b128 a[184:187], v2 offset:30720
v_cvt_pk_bf16_f32 v222, v188, v189
v_mfma_f32_16x16x32_bf16 a[84:87], a[212:215], v[200:203], a[84:87]
v_exp_f32 v190, v190
v_mfma_f32_16x16x32_bf16 a[84:87], a[244:247], v[216:219], a[84:87]
buffer_load_dwordx4 v1, s[36:39], s72 offen offset:1024 lds
v_mfma_f32_16x16x32_bf16 a[88:91], a[248:251], v[216:219], a[88:91]
s_nop 0
ds_read_b128 a[188:191], v2 offset:31744
ds_read_b128 a[224:227], v2 offset:8192
v_mfma_f32_16x16x32_bf16 a[88:91], a[216:219], v[200:203], a[88:91]
v_exp_f32 v191, v191
v_mfma_f32_16x16x32_bf16 a[92:95], a[220:223], v[200:203], a[92:95]
v_exp_f32 v168, v168
v_mfma_f32_16x16x32_bf16 a[92:95], a[252:255], v[216:219], a[92:95]
ds_read_b128 a[228:231], v2 offset:9216
v_cvt_pk_bf16_f32 v223, v190, v191
s_cmp_eq_u32 s58, 0
s_cbranch_scc1 Lta28
s_cmp_eq_u32 s58, 1
s_cbranch_scc1 Lnt29
v_mfma_f32_16x16x32_bf16 v[136:139], a[128:131], v[48:51], v[88:91]
v_exp_f32 v169, v169
v_mfma_f32_16x16x32_bf16 v[152:155], a[144:147], v[48:51], v[88:91]
ds_read_b128 a[232:235], v2 offset:10240
v_cvt_pk_bf16_f32 v216, v168, v169
s_branch Ljoin30
Lta28:
v_mfma_f32_16x16x32_bf16 v[136:139], a[128:131], v[48:51], v[104:107]
v_exp_f32 v169, v169
v_mfma_f32_16x16x32_bf16 v[152:155], a[144:147], v[48:51], v[112:115]
ds_read_b128 a[232:235], v2 offset:10240
v_cvt_pk_bf16_f32 v216, v168, v169
s_branch Ljoin30
Lnt29:
v_mfma_f32_16x16x32_bf16 v[136:139], a[128:131], v[48:51], v[88:91]
v_exp_f32 v169, v169
v_mfma_f32_16x16x32_bf16 v[152:155], a[144:147], v[48:51], v[104:107]
ds_read_b128 a[232:235], v2 offset:10240
v_cvt_pk_bf16_f32 v216, v168, v169
Ljoin30:
v_mfma_f32_16x16x32_bf16 v[136:139], a[132:135], v[52:55], v[136:139]
v_exp_f32 v170, v170
v_mfma_f32_16x16x32_bf16 v[136:139], a[136:139], v[56:59], v[136:139]
buffer_load_dwordx4 v1, s[36:39], s72 offen offset:2048 lds
v_mfma_f32_16x16x32_bf16 v[136:139], a[140:143], v[60:63], v[136:139]
ds_read_b128 a[236:239], v2 offset:11264
v_mfma_f32_16x16x32_bf16 v[152:155], a[156:159], v[60:63], v[152:155]
v_exp_f32 v171, v171
v_mfma_f32_16x16x32_bf16 v[152:155], a[152:155], v[56:59], v[152:155]
ds_read_b128 a[240:243], v2 offset:12288
v_cvt_pk_bf16_f32 v217, v170, v171
v_mfma_f32_16x16x32_bf16 v[152:155], a[148:151], v[52:55], v[152:155]
v_exp_f32 v184, v184
v_mfma_f32_16x16x32_bf16 v[140:143], a[128:131], v[64:67], v[92:95]
ds_read_b128 a[244:247], v2 offset:13312
v_mfma_f32_16x16x32_bf16 v[140:143], a[132:135], v[68:71], v[140:143]
v_exp_f32 v185, v185
v_mfma_f32_16x16x32_bf16 v[140:143], a[136:139], v[72:75], v[140:143]
ds_read_b128 a[248:251], v2 offset:14336
v_cvt_pk_bf16_f32 v218, v184, v185
v_mfma_f32_16x16x32_bf16 v[140:143], a[140:143], v[76:79], v[140:143]
buffer_load_dwordx4 v1, s[36:39], s72 offen offset:3072 lds
v_mfma_f32_16x16x32_bf16 v[156:159], a[156:159], v[76:79], v[92:95]
v_exp_f32 v186, v186
v_mfma_f32_16x16x32_bf16 v[156:159], a[152:155], v[72:75], v[156:159]
ds_read_b128 a[252:255], v2 offset:15360
v_add_u32 v2, s82, v1
v_mfma_f32_16x16x32_bf16 v[156:159], a[148:151], v[68:71], v[156:159]
s_waitcnt vmcnt(9) lgkmcnt(0)
v_exp_f32 v187, v187
v_mfma_f32_16x16x32_bf16 v[156:159], a[144:147], v[64:67], v[156:159]
s_barrier
v_cvt_pk_bf16_f32 v219, v186, v187
v_mfma_f32_16x16x32_bf16 v[236:239], v[120:123], v[204:207], v[236:239]
s_mov_b32 m0, s62
v_exp_f32 v136, v136
v_mfma_f32_16x16x32_bf16 v[236:239], v[120:123], v[220:223], v[236:239]
s_add_u32 s72, s93, 0x3000000
ds_read_b128 a[128:131], v2 offset:16384
ds_read_b128 a[132:135], v2 offset:17408
v_mfma_f32_16x16x32_bf16 a[96:99], a[192:195], v[204:207], a[96:99]
s_add_u32 s78, s59, 4
v_exp_f32 v137, v137
v_mfma_f32_16x16x32_bf16 a[96:99], a[224:227], v[220:223], a[96:99]
s_and_b32 s78, s78, 12
buffer_load_dwordx4 v1, s[44:47], s72 offen sc1 lds
v_mfma_f32_16x16x32_bf16 a[100:103], a[228:231], v[220:223], a[100:103]
s_lshl_b32 s78, s78, 1
v_exp_f32 v138, v138
v_mfma_f32_16x16x32_bf16 a[100:103], a[196:199], v[204:207], a[100:103]
s_lshr_b32 s79, 0x67234501, s78
ds_read_b128 a[136:139], v2 offset:18432
v_cvt_pk_bf16_f32 v200, v136, v137
v_mfma_f32_16x16x32_bf16 a[104:107], a[200:203], v[204:207], a[104:107]
s_and_b32 s79, s79, 7
v_exp_f32 v139, v139
v_mfma_f32_16x16x32_bf16 a[104:107], a[232:235], v[220:223], a[104:107]
s_lshl_b32 s79, s79, 18
ds_read_b128 a[140:143], v2 offset:19456
v_cvt_pk_bf16_f32 v201, v138, v139
v_mfma_f32_16x16x32_bf16 a[108:111], a[236:239], v[220:223], a[108:111]
s_add_u32 s79, s79, s94
v_exp_f32 v152, v152
v_mfma_f32_16x16x32_bf16 a[108:111], a[204:207], v[204:207], a[108:111]
s_add_u32 s12, s61, 0
ds_read_b128 a[144:147], v2 offset:20480
ds_read_b128 a[148:151], v2 offset:21504
v_mfma_f32_16x16x32_bf16 a[112:115], a[208:211], v[204:207], a[112:115]
s_waitcnt lgkmcnt(6)
buffer_load_dwordx4 v1, s[44:47], s72 offen offset:1024 sc1 lds
v_mfma_f32_16x16x32_bf16 a[112:115], a[240:243], v[220:223], a[112:115]
s_and_b32 s12, s12, 3
v_exp_f32 v153, v153
v_mfma_f32_16x16x32_bf16 a[116:119], a[244:247], v[220:223], a[116:119]
s_lshl_b32 s12, s12, 21
v_exp_f32 v154, v154
v_mfma_f32_16x16x32_bf16 a[116:119], a[212:215], v[204:207], a[116:119]
s_add_u32 s12, s12, s79
ds_read_b128 a[152:155], v2 offset:22528
v_cvt_pk_bf16_f32 v202, v152, v153
v_mfma_f32_16x16x32_bf16 a[120:123], a[216:219], v[204:207], a[120:123]
s_add_u32 s13, s61, 1
buffer_load_dwordx4 v1, s[44:47], s72 offen offset:2048 sc1 lds
v_mfma_f32_16x16x32_bf16 a[120:123], a[248:251], v[220:223], a[120:123]
s_and_b32 s13, s13, 3
v_exp_f32 v155, v155
v_mfma_f32_16x16x32_bf16 a[124:127], a[252:255], v[220:223], a[124:127]
s_lshl_b32 s13, s13, 21
ds_read_b128 a[156:159], v2 offset:23552
v_cvt_pk_bf16_f32 v203, v154, v155
v_mfma_f32_16x16x32_bf16 a[124:127], a[220:223], v[204:207], a[124:127]
s_add_u32 s13, s13, s79
v_exp_f32 v140, v140
s_cmp_eq_u32 s58, 2
s_cbranch_scc1 Lta31
s_cmp_eq_u32 s58, 3
s_cbranch_scc1 Lnt32
v_mfma_f32_16x16x32_bf16 v[168:171], a[160:163], v[48:51], v[112:115]
s_add_u32 s14, s61, 2
ds_read_b128 a[192:195], v2 offset:0
ds_read_b128 a[196:199], v2 offset:1024
v_mfma_f32_16x16x32_bf16 v[184:187], a[176:179], v[48:51], v[112:115]
s_and_b32 s14, s14, 3
v_exp_f32 v141, v141
s_branch Ljoin33
Lta31:
v_mfma_f32_16x16x32_bf16 v[168:171], a[160:163], v[48:51], v[104:107]
s_add_u32 s14, s61, 2
ds_read_b128 a[192:195], v2 offset:0
ds_read_b128 a[196:199], v2 offset:1024
v_mfma_f32_16x16x32_bf16 v[184:187], a[176:179], v[48:51], v[112:115]
s_and_b32 s14, s14, 3
v_exp_f32 v141, v141
s_branch Ljoin33
Lnt32:
v_mfma_f32_16x16x32_bf16 v[168:171], a[160:163], v[48:51], v[88:91]
s_add_u32 s14, s61, 2
ds_read_b128 a[192:195], v2 offset:0
ds_read_b128 a[196:199], v2 offset:1024
v_mfma_f32_16x16x32_bf16 v[184:187], a[176:179], v[48:51], v[104:107]
s_and_b32 s14, s14, 3
v_exp_f32 v141, v141
Ljoin33:
v_mfma_f32_16x16x32_bf16 v[172:175], a[160:163], v[64:67], v[92:95]
s_lshl_b32 s14, s14, 21
buffer_load_dwordx4 v1, s[44:47], s72 offen offset:3072 sc1 lds
v_mfma_f32_16x16x32_bf16 v[172:175], a[164:167], v[68:71], v[172:175]
s_add_u32 s66, s58, 0
v_exp_f32 v142, v142
v_mfma_f32_16x16x32_bf16 v[172:175], a[168:171], v[72:75], v[172:175]
s_and_b32 s66, s66, 3
ds_read_b128 a[200:203], v2 offset:2048
v_cvt_pk_bf16_f32 v204, v140, v141
v_mfma_f32_16x16x32_bf16 v[172:175], a[172:175], v[76:79], v[172:175]
s_mul_i32 s66, s66, 4160
v_exp_f32 v143, v143
v_mfma_f32_16x16x32_bf16 v[188:191], a[188:191], v[76:79], v[92:95]
s_add_u32 s66, s66, s92
ds_read_b128 a[204:207], v2 offset:3072
v_cvt_pk_bf16_f32 v205, v142, v143
v_mfma_f32_16x16x32_bf16 v[188:191], a[184:187], v[72:75], v[188:191]
s_add_u32 m0, s66, 16672
v_exp_f32 v156, v156
v_mfma_f32_16x16x32_bf16 v[188:191], a[180:183], v[68:71], v[188:191]
s_add_u32 s72, s93, 0x0
ds_read_b128 a[208:211], v2 offset:4096
ds_read_b128 a[212:215], v2 offset:5120
v_mfma_f32_16x16x32_bf16 v[188:191], a[176:179], v[64:67], v[188:191]
s_add_u32 s14, s14, s79
buffer_load_dwordx4 v1, s[36:39], s72 offen lds
v_mfma_f32_16x16x32_bf16 v[168:171], a[164:167], v[52:55], v[168:171]
s_add_u32 s15, s61, 3
v_exp_f32 v157, v157
v_mfma_f32_16x16x32_bf16 v[168:171], a[168:171], v[56:59], v[168:171]
s_and_b32 s15, s15, 3
v_exp_f32 v158, v158
v_mfma_f32_16x16x32_bf16 v[168:171], a[172:175], v[60:63], v[168:171]
s_lshl_b32 s15, s15, 21
ds_read_b128 a[216:219], v2 offset:6144
ds_read_b128 a[220:223], v2 offset:7168
v_mfma_f32_16x16x32_bf16 v[184:187], a[188:191], v[60:63], v[184:187]
s_add_u32 s15, s15, s79
buffer_load_dwordx4 v1, s[36:39], s72 offen offset:1024 lds
v_mfma_f32_16x16x32_bf16 v[184:187], a[184:187], v[56:59], v[184:187]
v_exp_f32 v159, v159
v_mfma_f32_16x16x32_bf16 v[184:187], a[180:183], v[52:55], v[184:187]
s_waitcnt lgkmcnt(4)
v_cvt_pk_bf16_f32 v206, v156, v157
v_cvt_pk_bf16_f32 v207, v158, v159
v_mfma_f32_16x16x32_bf16 v[232:235], v[120:123], v[216:219], v[232:235]
s_add_u32 s82, s82, 0x8000
ds_read_b128 a[160:163], v2 offset:24576
ds_read_b128 a[164:167], v2 offset:25600
v_mfma_f32_16x16x32_bf16 v[232:235], v[120:123], v[200:203], v[232:235]
s_and_b32 s82, s82, 0x1ffff
v_exp_f32 v172, v172
v_mfma_f32_16x16x32_bf16 a[64:67], a[224:227], v[216:219], a[64:67]
v_exp_f32 v173, v173
v_mfma_f32_16x16x32_bf16 a[64:67], a[192:195], v[200:203], a[64:67]
s_nop 0
ds_read_b128 a[168:171], v2 offset:26624
ds_read_b128 a[172:175], v2 offset:27648
v_mfma_f32_16x16x32_bf16 a[68:71], a[196:199], v[200:203], a[68:71]
v_exp_f32 v174, v174
v_mfma_f32_16x16x32_bf16 a[68:71], a[228:231], v[216:219], a[68:71]
v_exp_f32 v175, v175
v_mfma_f32_16x16x32_bf16 a[72:75], a[232:235], v[216:219], a[72:75]
s_nop 0
ds_read_b128 a[176:179], v2 offset:28672
ds_read_b128 a[180:183], v2 offset:29696
v_mfma_f32_16x16x32_bf16 a[72:75], a[200:203], v[200:203], a[72:75]
v_exp_f32 v188, v188
v_mfma_f32_16x16x32_bf16 a[76:79], a[204:207], v[200:203], a[76:79]
s_nop 0
ds_read_b128 a[184:187], v2 offset:30720
ds_read_b128 a[188:191], v2 offset:31744
v_mfma_f32_16x16x32_bf16 a[76:79], a[236:239], v[216:219], a[76:79]
s_nop 0
ds_read_b128 a[224:227], v2 offset:8192
ds_read_b128 a[228:231], v2 offset:9216
v_mfma_f32_16x16x32_bf16 a[80:83], a[240:243], v[216:219], a[80:83]
s_waitcnt lgkmcnt(10)
ds_read_b128 a[232:235], v2 offset:10240
ds_read_b128 a[236:239], v2 offset:11264
v_mfma_f32_16x16x32_bf16 a[80:83], a[208:211], v[200:203], a[80:83]
ds_read_b128 a[240:243], v2 offset:12288
v_cvt_pk_bf16_f32 v220, v172, v173
v_mfma_f32_16x16x32_bf16 a[84:87], a[212:215], v[200:203], a[84:87]
buffer_load_dwordx4 v1, s[36:39], s72 offen offset:2048 lds
v_mfma_f32_16x16x32_bf16 a[84:87], a[244:247], v[216:219], a[84:87]
v_exp_f32 v189, v189
v_mfma_f32_16x16x32_bf16 a[88:91], a[248:251], v[216:219], a[88:91]
v_exp_f32 v190, v190
v_mfma_f32_16x16x32_bf16 a[88:91], a[216:219], v[200:203], a[88:91]
s_nop 0
ds_read_b128 a[244:247], v2 offset:13312
ds_read_b128 a[248:251], v2 offset:14336
v_mfma_f32_16x16x32_bf16 a[92:95], a[220:223], v[200:203], a[92:95]
v_cvt_pk_bf16_f32 v221, v174, v175
v_cvt_pk_bf16_f32 v222, v188, v189
v_mfma_f32_16x16x32_bf16 a[92:95], a[252:255], v[216:219], a[92:95]
v_exp_f32 v191, v191
s_cmp_eq_u32 s58, 0
s_cbranch_scc1 Lta34
s_cmp_eq_u32 s58, 1
s_cbranch_scc1 Lnt35
v_mfma_f32_16x16x32_bf16 v[140:143], a[128:131], v[64:67], v[92:95]
v_exp_f32 v168, v168
v_mfma_f32_16x16x32_bf16 v[156:159], a[144:147], v[64:67], v[92:95]
v_exp_f32 v169, v169
s_branch Ljoin36
Lta34:
v_mfma_f32_16x16x32_bf16 v[140:143], a[128:131], v[64:67], v[108:111]
v_exp_f32 v168, v168
v_mfma_f32_16x16x32_bf16 v[156:159], a[144:147], v[64:67], v[112:115]
v_exp_f32 v169, v169
s_branch Ljoin36
Lnt35:
v_mfma_f32_16x16x32_bf16 v[140:143], a[128:131], v[64:67], v[92:95]
v_exp_f32 v168, v168
v_mfma_f32_16x16x32_bf16 v[156:159], a[144:147], v[64:67], v[108:111]
v_exp_f32 v169, v169
Ljoin36:
v_mfma_f32_16x16x32_bf16 v[140:143], a[132:135], v[68:71], v[140:143]
v_exp_f32 v170, v170
v_mfma_f32_16x16x32_bf16 v[140:143], a[136:139], v[72:75], v[140:143]
ds_read_b128 a[252:255], v2 offset:15360
v_cvt_pk_bf16_f32 v223, v190, v191
v_mfma_f32_16x16x32_bf16 v[140:143], a[140:143], v[76:79], v[140:143]
v_exp_f32 v171, v171
v_mfma_f32_16x16x32_bf16 v[156:159], a[156:159], v[76:79], v[156:159]
buffer_load_dwordx4 v1, s[36:39], s72 offen offset:3072 lds
v_mfma_f32_16x16x32_bf16 v[156:159], a[152:155], v[72:75], v[156:159]
s_waitcnt vmcnt(13) lgkmcnt(4)
v_exp_f32 v184, v184
v_mfma_f32_16x16x32_bf16 v[156:159], a[148:151], v[68:71], v[156:159]
s_barrier
v_cvt_pk_bf16_f32 v216, v168, v169
v_cvt_pk_bf16_f32 v217, v170, v171
v_add_u32 v2, s82, v1
v_exp_f32 v185, v185
v_exp_f32 v186, v186
v_cvt_pk_bf16_f32 v218, v184, v185
v_exp_f32 v187, v187
s_nop 0
v_cvt_pk_bf16_f32 v219, v186, v187
v_mfma_f32_16x16x32_bf16 v[236:239], v[120:123], v[204:207], v[236:239]
s_add_u32 s66, s58, 2
v_exp_f32 v140, v140
v_mfma_f32_16x16x32_bf16 v[236:239], v[120:123], v[220:223], v[236:239]
s_and_b32 s66, s66, 3
v_exp_f32 v141, v141
v_mfma_f32_16x16x32_bf16 a[96:99], a[192:195], v[204:207], a[96:99]
s_mul_i32 s66, s66, 4160
ds_read_b128 a[192:195], v2 offset:0
v_mfma_f32_16x16x32_bf16 a[96:99], a[224:227], v[220:223], a[96:99]
s_add_u32 s66, s66, s92
v_exp_f32 v142, v142
v_mfma_f32_16x16x32_bf16 a[100:103], a[228:231], v[220:223], a[100:103]
s_add_u32 m0, s66, 33312
v_exp_f32 v143, v143
v_mfma_f32_16x16x32_bf16 a[100:103], a[196:199], v[204:207], a[100:103]
s_add_u32 s72, s93, 0x4
buffer_load_dwordx4 v1, s[36:39], s72 offen lds
v_mfma_f32_16x16x32_bf16 a[104:107], a[200:203], v[204:207], a[104:107]
ds_read_b128 a[196:199], v2 offset:1024
v_mfma_f32_16x16x32_bf16 a[104:107], a[232:235], v[220:223], a[104:107]
buffer_load_dwordx4 v1, s[36:39], s72 offen offset:1024 lds
v_mfma_f32_16x16x32_bf16 a[108:111], a[236:239], v[220:223], a[108:111]
ds_read_b128 a[200:203], v2 offset:2048
v_mfma_f32_16x16x32_bf16 a[108:111], a[204:207], v[204:207], a[108:111]
buffer_load_dwordx4 v1, s[36:39], s72 offen offset:2048 lds
v_mfma_f32_16x16x32_bf16 a[112:115], a[208:211], v[204:207], a[112:115]
s_waitcnt lgkmcnt(3)
ds_read_b128 a[204:207], v2 offset:3072
v_mfma_f32_16x16x32_bf16 a[112:115], a[240:243], v[220:223], a[112:115]
buffer_load_dwordx4 v1, s[36:39], s72 offen offset:3072 lds
v_mfma_f32_16x16x32_bf16 a[116:119], a[244:247], v[220:223], a[116:119]
v_exp_f32 v156, v156
v_mfma_f32_16x16x32_bf16 a[116:119], a[212:215], v[204:207], a[116:119]
ds_read_b128 a[208:211], v2 offset:4096
v_mfma_f32_16x16x32_bf16 a[120:123], a[216:219], v[204:207], a[120:123]
buffer_load_dwordx4 v[80:83], v15, s[4:7], s80 offen
v_mfma_f32_16x16x32_bf16 a[120:123], a[248:251], v[220:223], a[120:123]
s_add_u32 s80, s80, 0x4000
v_exp_f32 v157, v157
v_mfma_f32_16x16x32_bf16 a[124:127], a[252:255], v[220:223], a[124:127]
ds_read_b128 a[212:215], v2 offset:5120
v_mfma_f32_16x16x32_bf16 a[124:127], a[220:223], v[204:207], a[124:127]
ds_read_b128 a[216:219], v2 offset:6144
v_cvt_pk_bf16_f32 v204, v140, v141
s_cmp_eq_u32 s58, 2
s_cbranch_scc1 Lta37
s_cmp_eq_u32 s58, 3
s_cbranch_scc1 Lnt38
v_mfma_f32_16x16x32_bf16 v[172:175], a[160:163], v[64:67], v[112:115]
buffer_load_dwordx4 v[84:87], v15, s[4:7], s80 offen
v_mfma_f32_16x16x32_bf16 v[188:191], a[176:179], v[64:67], v[112:115]
s_add_u32 s80, s80, 0x4000
v_exp_f32 v158, v158
s_branch Ljoin39
Lta37:
v_mfma_f32_16x16x32_bf16 v[172:175], a[160:163], v[64:67], v[108:111]
buffer_load_dwordx4 v[84:87], v15, s[4:7], s80 offen
v_mfma_f32_16x16x32_bf16 v[188:191], a[176:179], v[64:67], v[112:115]
s_add_u32 s80, s80, 0x4000
v_exp_f32 v158, v158
s_branch Ljoin39
Lnt38:
v_mfma_f32_16x16x32_bf16 v[172:175], a[160:163], v[64:67], v[92:95]
buffer_load_dwordx4 v[84:87], v15, s[4:7], s80 offen
v_mfma_f32_16x16x32_bf16 v[188:191], a[176:179], v[64:67], v[108:111]
s_add_u32 s80, s80, 0x4000
v_exp_f32 v158, v158
Ljoin39:
v_mfma_f32_16x16x32_bf16 v[172:175], a[164:167], v[68:71], v[172:175]
ds_read_b128 a[220:223], v2 offset:7168
v_cvt_pk_bf16_f32 v205, v142, v143
v_mfma_f32_16x16x32_bf16 v[172:175], a[168:171], v[72:75], v[172:175]
buffer_load_dwordx4 v[96:99], v15, s[4:7], s80 offen
v_mfma_f32_16x16x32_bf16 v[172:175], a[172:175], v[76:79], v[172:175]
s_add_u32 s80, s80, 0x4000
v_exp_f32 v159, v159
v_mfma_f32_16x16x32_bf16 v[188:191], a[188:191], v[76:79], v[188:191]
buffer_load_dwordx4 v[100:103], v15, s[4:7], s80 offen
v_mfma_f32_16x16x32_bf16 v[188:191], a[184:187], v[72:75], v[188:191]
v_cvt_pk_bf16_f32 v206, v156, v157
v_cvt_pk_bf16_f32 v207, v158, v159
v_mfma_f32_16x16x32_bf16 v[188:191], a[180:183], v[68:71], v[188:191]
s_waitcnt lgkmcnt(4)
v_mfma_f32_16x16x32_bf16 v[232:235], v[120:123], v[216:219], v[232:235]
s_add_u32 s82, s82, 0x8000
v_exp_f32 v172, v172
v_mfma_f32_16x16x32_bf16 a[64:67], a[224:227], v[216:219], a[64:67]
s_and_b32 s82, s82, 0x1ffff
ds_read_b128 a[224:227], v2 offset:8192
v_mfma_f32_16x16x32_bf16 a[68:71], a[228:231], v[216:219], a[68:71]
ds_read_b128 a[228:231], v2 offset:9216
v_mfma_f32_16x16x32_bf16 a[72:75], a[232:235], v[216:219], a[72:75]
v_exp_f32 v173, v173
v_mfma_f32_16x16x32_bf16 a[76:79], a[236:239], v[216:219], a[76:79]
s_nop 0
ds_read_b128 a[232:235], v2 offset:10240
ds_read_b128 a[236:239], v2 offset:11264
v_mfma_f32_16x16x32_bf16 a[80:83], a[240:243], v[216:219], a[80:83]
ds_read_b128 a[240:243], v2 offset:12288
v_cvt_pk_bf16_f32 v220, v172, v173
v_mfma_f32_16x16x32_bf16 a[84:87], a[244:247], v[216:219], a[84:87]
ds_read_b128 a[244:247], v2 offset:13312
v_mfma_f32_16x16x32_bf16 a[88:91], a[248:251], v[216:219], a[88:91]
v_exp_f32 v174, v174
v_mfma_f32_16x16x32_bf16 a[92:95], a[252:255], v[216:219], a[92:95]
v_exp_f32 v175, v175
ds_read_b128 a[248:251], v2 offset:14336
ds_read_b128 a[252:255], v2 offset:15360
v_add_u32 v2, s82, v1
v_exp_f32 v188, v188
v_cvt_pk_bf16_f32 v221, v174, v175
v_exp_f32 v189, v189
v_exp_f32 v190, v190
v_cvt_pk_bf16_f32 v222, v188, v189
v_exp_f32 v191, v191
s_nop 0
v_cvt_pk_bf16_f32 v223, v190, v191
s_waitcnt vmcnt(4) lgkmcnt(0)
s_barrier
LHT4:
Lstub7:
s_cbranch_execz Lstub11
v_mfma_f32_16x16x32_bf16 v[236:239], v[120:123], v[204:207], v[236:239]
ds_write_b64 v5, v[12:13]
v_mov_b32 v240, 0
v_mfma_f32_16x16x32_bf16 v[236:239], v[120:123], v[220:223], v[236:239]
v_mov_b32 v241, 0
v_mfma_f32_16x16x32_bf16 a[96:99], a[192:195], v[204:207], a[96:99]
s_nop 0
ds_write_b64 v14, v[240:241]
ds_read_b64 a[128:129], v6 offset:0
v_mfma_f32_16x16x32_bf16 a[96:99], a[224:227], v[220:223], a[96:99]
s_nop 0
ds_read_b64 a[130:131], v6 offset:8
ds_read_b128 a[192:195], v7 offset:3584
v_mfma_f32_16x16x32_bf16 a[100:103], a[228:231], v[220:223], a[100:103]
s_nop 0
ds_read_b64 a[132:133], v6 offset:512
ds_read_b64 a[134:135], v6 offset:520
v_mfma_f32_16x16x32_bf16 a[100:103], a[196:199], v[204:207], a[100:103]
s_nop 0
ds_read_b128 a[196:199], v7 offset:3072
ds_read_b64 a[136:137], v6 offset:1024
v_mfma_f32_16x16x32_bf16 a[104:107], a[200:203], v[204:207], a[104:107]
s_nop 0
ds_read_b64 a[138:139], v6 offset:1032
ds_read_b128 a[200:203], v7 offset:2560
v_mfma_f32_16x16x32_bf16 a[104:107], a[232:235], v[220:223], a[104:107]
v_mfma_f32_16x16x32_bf16 a[108:111], a[236:239], v[220:223], a[108:111]
s_nop 0
ds_read_b64 a[140:141], v6 offset:1536
ds_read_b64 a[142:143], v6 offset:1544
v_mfma_f32_16x16x32_bf16 a[108:111], a[204:207], v[204:207], a[108:111]
s_nop 0
ds_read_b128 a[204:207], v7 offset:2048
ds_read_b64 a[144:145], v6 offset:2048
v_mfma_f32_16x16x32_bf16 a[112:115], a[208:211], v[204:207], a[112:115]
s_lshl_b32 s73, s52, 12
ds_read_b64 a[146:147], v6 offset:2056
ds_read_b128 a[208:211], v7 offset:1536
v_mfma_f32_16x16x32_bf16 a[112:115], a[240:243], v[220:223], a[112:115]
s_add_u32 s73, s73, 0x2000000
v_mfma_f32_16x16x32_bf16 a[116:119], a[244:247], v[220:223], a[116:119]
s_lshl_b32 s70, s68, 2
ds_read_b64 a[148:149], v6 offset:2560
ds_read_b64 a[150:151], v6 offset:2568
v_mfma_f32_16x16x32_bf16 a[116:119], a[212:215], v[204:207], a[116:119]
s_add_u32 s70, s70, s73
ds_read_b128 a[212:215], v7 offset:1024
ds_read_b64 a[152:153], v6 offset:3072
v_mfma_f32_16x16x32_bf16 a[120:123], a[216:219], v[204:207], a[120:123]
s_nop 0
ds_read_b64 a[154:155], v6 offset:3080
ds_read_b128 a[216:219], v7 offset:512
v_mfma_f32_16x16x32_bf16 a[120:123], a[248:251], v[220:223], a[120:123]
v_mfma_f32_16x16x32_bf16 a[124:127], a[252:255], v[220:223], a[124:127]
s_xor_b32 s71, s12, 0x80
ds_read_b64 a[156:157], v6 offset:3584
ds_read_b64 a[158:159], v6 offset:3592
v_mfma_f32_16x16x32_bf16 a[124:127], a[220:223], v[204:207], a[124:127]
s_add_u32 m0, s77, 0
ds_read_b128 a[220:223], v7 offset:0
s_waitcnt lgkmcnt(0)
v_mfma_f32_16x16x32_bf16 v[128:131], v[8:11], a[192:195], 0
s_add_u32 s72, s71, 0
buffer_load_dwordx4 v15, s[24:27], s72 offen lds
v_mfma_f32_16x16x32_bf16 v[128:131], a[128:131], a[192:195], v[128:131]
v_mfma_f32_16x16x32_bf16 v[132:135], v[8:11], a[196:199], 0
s_nop 0
ds_read_b128 a[224:227], v7 offset:3648
ds_read_b64 a[160:161], v6 offset:64
v_mfma_f32_16x16x32_bf16 v[132:135], a[128:131], a[196:199], v[132:135]
v_accvgpr_read_b32 v240, a64
v_accvgpr_read_b32 v241, a65
v_accvgpr_read_b32 v242, a66
v_mfma_f32_16x16x32_bf16 v[132:135], a[132:135], a[192:195], v[132:135]
s_add_u32 s72, s71, 15360
buffer_load_dwordx4 v15, s[24:27], s72 offen offset:1024 lds
v_accvgpr_read_b32 v243, a67
v_mfma_f32_16x16x32_bf16 v[136:139], v[8:11], a[200:203], 0
s_nop 0
ds_read_b64 a[162:163], v6 offset:72
ds_read_b128 a[228:231], v7 offset:3136
v_mfma_f32_16x16x32_bf16 v[136:139], a[128:131], a[200:203], v[136:139]
s_lshl_b32 s95, s75, 20
v_rcp_f32 v232, v232
v_mfma_f32_16x16x32_bf16 v[136:139], a[132:135], a[196:199], v[136:139]
s_lshl_b32 s74, s58, 18
v_rcp_f32 v236, v236
v_accvgpr_read_b32 v244, a68
v_mfma_f32_16x16x32_bf16 v[136:139], a[136:139], a[192:195], v[136:139]
s_add_u32 s95, s95, s74
ds_read_b64 a[164:165], v6 offset:576
ds_read_b64 a[166:167], v6 offset:584
v_accvgpr_read_b32 v245, a69
v_mfma_f32_16x16x32_bf16 v[140:143], v[8:11], a[204:207], 0
s_add_u32 s72, s71, 30720
buffer_load_dwordx4 v15, s[24:27], s72 offen offset:2048 lds
v_accvgpr_read_b32 v246, a70
v_mfma_f32_16x16x32_bf16 v[140:143], a[128:131], a[204:207], v[140:143]
s_add_u32 s95, s95, 0x2000000
v_accvgpr_read_b32 v247, a71
v_mul_f32 v240, v240, v232
v_mul_f32 v241, v241, v232
v_mfma_f32_16x16x32_bf16 v[140:143], a[132:135], a[200:203], v[140:143]
s_sub_u32 s74, 15, s75
ds_read_b128 a[232:235], v7 offset:2624
ds_read_b64 a[168:169], v6 offset:1088
v_mul_f32 v242, v242, v232
v_mfma_f32_16x16x32_bf16 v[140:143], a[136:139], a[196:199], v[140:143]
s_add_u32 s72, s71, 46080
buffer_load_dwordx4 v15, s[24:27], s72 offen offset:3072 lds
v_mul_f32 v243, v243, v232
v_mfma_f32_16x16x32_bf16 v[140:143], a[140:143], a[192:195], v[140:143]
s_min_u32 s74, s74, s75
v_mul_f32 v244, v244, v232
v_mul_f32 v245, v245, v232
v_mul_f32 v246, v246, v232
v_mfma_f32_16x16x32_bf16 v[144:147], v[8:11], a[208:211], 0
s_lshl_b32 s74, s74, 7
ds_read_b64 a[170:171], v6 offset:1096
ds_read_b128 a[236:239], v7 offset:2112
v_mul_f32 v247, v247, v232
v_mfma_f32_16x16x32_bf16 v[144:147], a[128:131], a[208:211], v[144:147]
s_add_u32 s74, s74, 0x3810000
v_cvt_pk_bf16_f32 v240, v240, v241
v_cvt_pk_bf16_f32 v241, v242, v243
v_cvt_pk_bf16_f32 v242, v244, v245
v_mfma_f32_16x16x32_bf16 v[144:147], a[132:135], a[204:207], v[144:147]
s_xor_b32 s85, s77, 0x10000
v_cvt_pk_bf16_f32 v243, v246, v247
v_mfma_f32_16x16x32_bf16 v[144:147], a[136:139], a[200:203], v[144:147]
s_nop 0
ds_read_b64 a[172:173], v6 offset:1600
ds_read_b64 a[174:175], v6 offset:1608
v_mfma_f32_16x16x32_bf16 v[144:147], a[140:143], a[196:199], v[144:147]
buffer_store_dwordx4 v[240:243], v1, s[44:47], s70 offen sc1
v_mfma_f32_16x16x32_bf16 v[144:147], a[144:147], a[192:195], v[144:147]
v_accvgpr_read_b32 v248, a72
v_accvgpr_read_b32 v249, a73
v_accvgpr_read_b32 v250, a74
v_mfma_f32_16x16x32_bf16 v[148:151], v[8:11], a[212:215], 0
s_nop 0
ds_read_b128 a[240:243], v7 offset:1600
ds_read_b64 a[176:177], v6 offset:2112
Lstub8:
s_cbranch_execz Lret
v_accvgpr_read_b32 v251, a75
v_mfma_f32_16x16x32_bf16 v[148:151], a[128:131], a[212:215], v[148:151]
v_accvgpr_read_b32 v252, a76
v_accvgpr_read_b32 v253, a77
v_accvgpr_read_b32 v254, a78
v_mfma_f32_16x16x32_bf16 v[148:151], a[132:135], a[208:211], v[148:151]
v_accvgpr_read_b32 v255, a79
v_mul_f32 v248, v248, v232
v_mul_f32 v249, v249, v232
v_mfma_f32_16x16x32_bf16 v[148:151], a[136:139], a[204:207], v[148:151]
s_nop 0
ds_read_b64 a[178:179], v6 offset:2120
ds_read_b128 a[244:247], v7 offset:1088
v_mul_f32 v250, v250, v232
v_mfma_f32_16x16x32_bf16 v[148:151], a[140:143], a[200:203], v[148:151]
v_mul_f32 v251, v251, v232
v_mul_f32 v252, v252, v232
v_mul_f32 v253, v253, v232
v_mfma_f32_16x16x32_bf16 v[148:151], a[144:147], a[196:199], v[148:151]
v_mul_f32 v254, v254, v232
v_mul_f32 v255, v255, v232
v_cvt_pk_bf16_f32 v248, v248, v249
v_mfma_f32_16x16x32_bf16 v[148:151], a[148:151], a[192:195], v[148:151]
s_nop 0
ds_read_b64 a[180:181], v6 offset:2624
ds_read_b64 a[182:183], v6 offset:2632
v_cvt_pk_bf16_f32 v249, v250, v251
v_mfma_f32_16x16x32_bf16 v[152:155], v[8:11], a[216:219], 0
v_cvt_pk_bf16_f32 v250, v252, v253
v_cvt_pk_bf16_f32 v251, v254, v255
v_mfma_f32_16x16x32_bf16 v[152:155], a[128:131], a[216:219], v[152:155]
buffer_store_dwordx4 v[248:251], v1, s[44:47], s70 offen offset:1024 sc1
v_mfma_f32_16x16x32_bf16 v[152:155], a[132:135], a[212:215], v[152:155]
s_nop 0
ds_read_b128 a[248:251], v7 offset:576
ds_read_b64 a[184:185], v6 offset:3136
v_accvgpr_read_b32 v240, a80
v_mfma_f32_16x16x32_bf16 v[152:155], a[136:139], a[208:211], v[152:155]
v_accvgpr_read_b32 v241, a81
v_accvgpr_read_b32 v242, a82
v_accvgpr_read_b32 v243, a83
v_mfma_f32_16x16x32_bf16 v[152:155], a[140:143], a[204:207], v[152:155]
v_accvgpr_read_b32 v244, a84
v_accvgpr_read_b32 v245, a85
v_accvgpr_read_b32 v246, a86
v_mfma_f32_16x16x32_bf16 v[152:155], a[144:147], a[200:203], v[152:155]
s_nop 0
ds_read_b64 a[186:187], v6 offset:3144
ds_read_b128 a[252:255], v7 offset:64
v_accvgpr_read_b32 v247, a87
v_mfma_f32_16x16x32_bf16 v[152:155], a[148:151], a[196:199], v[152:155]
v_mul_f32 v240, v240, v232
v_mul_f32 v241, v241, v232
v_mul_f32 v242, v242, v232
v_mfma_f32_16x16x32_bf16 v[152:155], a[152:155], a[192:195], v[152:155]
v_mul_f32 v243, v243, v232
v_mul_f32 v244, v244, v232
v_mul_f32 v245, v245, v232
v_mfma_f32_16x16x32_bf16 v[156:159], v[8:11], a[220:223], 0
s_nop 0
ds_read_b64 a[188:189], v6 offset:3648
ds_read_b64 a[190:191], v6 offset:3656
v_mul_f32 v246, v246, v232
v_mfma_f32_16x16x32_bf16 v[156:159], a[128:131], a[220:223], v[156:159]
v_mul_f32 v247, v247, v232
v_cvt_pk_bf16_f32 v240, v240, v241
v_cvt_pk_bf16_f32 v241, v242, v243
v_mfma_f32_16x16x32_bf16 v[156:159], a[132:135], a[216:219], v[156:159]
v_cvt_pk_bf16_f32 v242, v244, v245
v_cvt_pk_bf16_f32 v243, v246, v247
v_mfma_f32_16x16x32_bf16 v[156:159], a[136:139], a[212:215], v[156:159]
buffer_store_dwordx4 v[240:243], v1, s[44:47], s70 offen offset:2048 sc1
v_mfma_f32_16x16x32_bf16 v[156:159], a[140:143], a[208:211], v[156:159]
v_accvgpr_read_b32 v248, a88
v_accvgpr_read_b32 v249, a89
v_accvgpr_read_b32 v250, a90
v_mfma_f32_16x16x32_bf16 v[156:159], a[144:147], a[204:207], v[156:159]
v_accvgpr_read_b32 v251, a91
v_accvgpr_read_b32 v252, a92
v_accvgpr_read_b32 v253, a93
v_mfma_f32_16x16x32_bf16 v[156:159], a[148:151], a[200:203], v[156:159]
v_accvgpr_read_b32 v254, a94
v_accvgpr_read_b32 v255, a95
v_mul_f32 v248, v248, v232
v_mfma_f32_16x16x32_bf16 v[156:159], a[152:155], a[196:199], v[156:159]
v_mul_f32 v249, v249, v232
v_mul_f32 v250, v250, v232
v_mul_f32 v251, v251, v232
v_mfma_f32_16x16x32_bf16 v[156:159], a[156:159], a[192:195], v[156:159]
s_waitcnt lgkmcnt(0)
v_mul_f32 v252, v252, v232
v_mul_f32 v253, v253, v232
v_mul_f32 v254, v254, v232
v_mfma_f32_16x16x32_bf16 v[128:131], a[160:163], a[224:227], v[128:131]
s_nop 0
ds_read_b128 a[192:195], v7 offset:3712
ds_read_b64 a[128:129], v6 offset:128
v_mul_f32 v255, v255, v232
v_mfma_f32_16x16x32_bf16 v[132:135], a[164:167], a[224:227], v[132:135]
v_cvt_pk_bf16_f32 v248, v248, v249
v_cvt_pk_bf16_f32 v249, v250, v251
v_cvt_pk_bf16_f32 v250, v252, v253
v_mfma_f32_16x16x32_bf16 v[132:135], a[160:163], a[228:231], v[132:135]
s_nop 0
ds_read_b64 a[130:131], v6 offset:136
ds_read_b128 a[196:199], v7 offset:3200
v_cvt_pk_bf16_f32 v251, v254, v255
v_mfma_f32_16x16x32_bf16 v[136:139], a[160:163], a[232:235], v[136:139]
buffer_store_dwordx4 v[248:251], v1, s[44:47], s70 offen offset:3072 sc1
v_mfma_f32_16x16x32_bf16 v[136:139], a[164:167], a[228:231], v[136:139]
s_add_u32 s70, s70, 0x80000
v_accvgpr_read_b32 v240, a96
v_accvgpr_read_b32 v241, a97
v_accvgpr_read_b32 v242, a98
v_mfma_f32_16x16x32_bf16 v[136:139], a[168:171], a[224:227], v[136:139]
s_nop 0
ds_read_b64 a[132:133], v6 offset:640
ds_read_b64 a[134:135], v6 offset:648
v_accvgpr_read_b32 v243, a99
v_mfma_f32_16x16x32_bf16 v[140:143], a[172:175], a[224:227], v[140:143]
v_accvgpr_read_b32 v244, a100
v_accvgpr_read_b32 v245, a101
v_accvgpr_read_b32 v246, a102
v_mfma_f32_16x16x32_bf16 v[140:143], a[168:171], a[228:231], v[140:143]
s_nop 0
ds_read_b128 a[200:203], v7 offset:2688
ds_read_b64 a[136:137], v6 offset:1152
v_accvgpr_read_b32 v247, a103
v_mfma_f32_16x16x32_bf16 v[140:143], a[164:167], a[232:235], v[140:143]
v_mul_f32 v240, v240, v236
v_mul_f32 v241, v241, v236
v_mul_f32 v242, v242, v236
v_mfma_f32_16x16x32_bf16 v[140:143], a[160:163], a[236:239], v[140:143]
v_mul_f32 v243, v243, v236
v_mul_f32 v244, v244, v236
v_mul_f32 v245, v245, v236
v_mfma_f32_16x16x32_bf16 v[144:147], a[160:163], a[240:243], v[144:147]
s_nop 0
ds_read_b64 a[138:139], v6 offset:1160
ds_read_b128 a[204:207], v7 offset:2176
v_mul_f32 v246, v246, v236
v_mfma_f32_16x16x32_bf16 v[144:147], a[164:167], a[236:239], v[144:147]
v_mul_f32 v247, v247, v236
v_cvt_pk_bf16_f32 v240, v240, v241
v_cvt_pk_bf16_f32 v241, v242, v243
v_mfma_f32_16x16x32_bf16 v[144:147], a[168:171], a[232:235], v[144:147]
s_nop 0
ds_read_b64 a[140:141], v6 offset:1664
ds_read_b64 a[142:143], v6 offset:1672
v_cvt_pk_bf16_f32 v242, v244, v245
v_mfma_f32_16x16x32_bf16 v[144:147], a[172:175], a[228:231], v[144:147]
v_cvt_pk_bf16_f32 v243, v246, v247
v_mfma_f32_16x16x32_bf16 v[144:147], a[176:179], a[224:227], v[144:147]
buffer_store_dwordx4 v[240:243], v1, s[44:47], s70 offen sc1
v_mfma_f32_16x16x32_bf16 v[148:151], a[180:183], a[224:227], v[148:151]
s_nop 0
ds_read_b128 a[208:211], v7 offset:1664
ds_read_b64 a[144:145], v6 offset:2176
v_accvgpr_read_b32 v248, a104
v_mfma_f32_16x16x32_bf16 v[148:151], a[176:179], a[228:231], v[148:151]
v_accvgpr_read_b32 v249, a105
v_accvgpr_read_b32 v250, a106
v_accvgpr_read_b32 v251, a107
v_mfma_f32_16x16x32_bf16 v[148:151], a[172:175], a[232:235], v[148:151]
v_accvgpr_read_b32 v252, a108
v_accvgpr_read_b32 v253, a109
v_accvgpr_read_b32 v254, a110
v_mfma_f32_16x16x32_bf16 v[148:151], a[168:171], a[236:239], v[148:151]
s_nop 0
ds_read_b64 a[146:147], v6 offset:2184
ds_read_b128 a[212:215], v7 offset:1152
v_accvgpr_read_b32 v255, a111
v_mfma_f32_16x16x32_bf16 v[148:151], a[164:167], a[240:243], v[148:151]
v_mul_f32 v248, v248, v236
v_mul_f32 v249, v249, v236
v_mul_f32 v250, v250, v236
v_mfma_f32_16x16x32_bf16 v[148:151], a[160:163], a[244:247], v[148:151]
s_nop 0
ds_read_b64 a[148:149], v6 offset:2688
ds_read_b64 a[150:151], v6 offset:2696
v_mul_f32 v251, v251, v236
v_mfma_f32_16x16x32_bf16 v[152:155], a[160:163], a[248:251], v[152:155]
v_mul_f32 v252, v252, v236
v_mul_f32 v253, v253, v236
v_mul_f32 v254, v254, v236
v_mfma_f32_16x16x32_bf16 v[152:155], a[164:167], a[244:247], v[152:155]
v_mul_f32 v255, v255, v236
v_cvt_pk_bf16_f32 v248, v248, v249
v_cvt_pk_bf16_f32 v249, v250, v251
v_mfma_f32_16x16x32_bf16 v[152:155], a[168:171], a[240:243], v[152:155]
s_nop 0
ds_read_b128 a[216:219], v7 offset:640
ds_read_b64 a[152:153], v6 offset:3200
v_cvt_pk_bf16_f32 v250, v252, v253
v_mfma_f32_16x16x32_bf16 v[152:155], a[172:175], a[236:239], v[152:155]
v_cvt_pk_bf16_f32 v251, v254, v255
v_mfma_f32_16x16x32_bf16 v[152:155], a[176:179], a[232:235], v[152:155]
s_nop 0
ds_read_b64 a[154:155], v6 offset:3208
ds_read_b128 a[220:223], v7 offset:128
v_mfma_f32_16x16x32_bf16 v[152:155], a[180:183], a[228:231], v[152:155]
buffer_store_dwordx4 v[248:251], v1, s[44:47], s70 offen offset:1024 sc1
v_mfma_f32_16x16x32_bf16 v[152:155], a[184:187], a[224:227], v[152:155]
v_accvgpr_read_b32 v240, a112
v_accvgpr_read_b32 v241, a113
v_accvgpr_read_b32 v242, a114
v_mfma_f32_16x16x32_bf16 v[156:159], a[188:191], a[224:227], v[156:159]
s_nop 0
ds_read_b64 a[156:157], v6 offset:3712
ds_read_b64 a[158:159], v6 offset:3720
v_accvgpr_read_b32 v243, a115
v_mfma_f32_16x16x32_bf16 v[156:159], a[184:187], a[228:231], v[156:159]
v_accvgpr_read_b32 v244, a116
v_accvgpr_read_b32 v245, a117
v_accvgpr_read_b32 v246, a118
v_mfma_f32_16x16x32_bf16 v[156:159], a[180:183], a[232:235], v[156:159]
v_accvgpr_read_b32 v247, a119
v_mul_f32 v240, v240, v236
v_mul_f32 v241, v241, v236
v_mfma_f32_16x16x32_bf16 v[156:159], a[176:179], a[236:239], v[156:159]
v_mul_f32 v242, v242, v236
v_mul_f32 v243, v243, v236
v_mul_f32 v244, v244, v236
v_mfma_f32_16x16x32_bf16 v[156:159], a[172:175], a[240:243], v[156:159]
v_mul_f32 v245, v245, v236
v_mul_f32 v246, v246, v236
v_mul_f32 v247, v247, v236
v_mfma_f32_16x16x32_bf16 v[156:159], a[168:171], a[244:247], v[156:159]
v_cvt_pk_bf16_f32 v240, v240, v241
v_cvt_pk_bf16_f32 v241, v242, v243
v_cvt_pk_bf16_f32 v242, v244, v245
v_mfma_f32_16x16x32_bf16 v[156:159], a[164:167], a[248:251], v[156:159]
v_cvt_pk_bf16_f32 v243, v246, v247
v_mfma_f32_16x16x32_bf16 v[156:159], a[160:163], a[252:255], v[156:159]
s_waitcnt lgkmcnt(0)
buffer_store_dwordx4 v[240:243], v1, s[44:47], s70 offen offset:2048 sc1
v_mfma_f32_16x16x32_bf16 v[128:131], a[128:131], a[192:195], v[128:131]
s_nop 0
ds_read_b128 a[224:227], v7 offset:3776
ds_read_b64 a[160:161], v6 offset:192
v_accvgpr_read_b32 v248, a120
v_mfma_f32_16x16x32_bf16 v[132:135], a[132:135], a[192:195], v[132:135]
v_accvgpr_read_b32 v249, a121
v_accvgpr_read_b32 v250, a122
v_accvgpr_read_b32 v251, a123
v_mfma_f32_16x16x32_bf16 v[132:135], a[128:131], a[196:199], v[132:135]
s_nop 0
ds_read_b64 a[162:163], v6 offset:200
ds_read_b128 a[228:231], v7 offset:3264
v_accvgpr_read_b32 v252, a124
v_mfma_f32_16x16x32_bf16 v[136:139], a[128:131], a[200:203], v[136:139]
v_accvgpr_read_b32 v253, a125
v_accvgpr_read_b32 v254, a126
v_accvgpr_read_b32 v255, a127
v_mfma_f32_16x16x32_bf16 v[136:139], a[132:135], a[196:199], v[136:139]
v_mul_f32 v248, v248, v236
v_mul_f32 v249, v249, v236
v_mul_f32 v250, v250, v236
v_mfma_f32_16x16x32_bf16 v[136:139], a[136:139], a[192:195], v[136:139]
s_nop 0
ds_read_b64 a[164:165], v6 offset:704
ds_read_b64 a[166:167], v6 offset:712
v_mul_f32 v251, v251, v236
v_mfma_f32_16x16x32_bf16 v[140:143], a[140:143], a[192:195], v[140:143]
v_mul_f32 v252, v252, v236
v_mul_f32 v253, v253, v236
v_mul_f32 v254, v254, v236
v_mfma_f32_16x16x32_bf16 v[140:143], a[136:139], a[196:199], v[140:143]
s_nop 0
ds_read_b128 a[232:235], v7 offset:2752
ds_read_b64 a[168:169], v6 offset:1216
v_mul_f32 v255, v255, v236
v_mfma_f32_16x16x32_bf16 v[140:143], a[132:135], a[200:203], v[140:143]
v_cvt_pk_bf16_f32 v248, v248, v249
v_cvt_pk_bf16_f32 v249, v250, v251
v_cvt_pk_bf16_f32 v250, v252, v253
v_mfma_f32_16x16x32_bf16 v[140:143], a[128:131], a[204:207], v[140:143]
v_cvt_pk_bf16_f32 v251, v254, v255
v_mfma_f32_16x16x32_bf16 v[144:147], a[128:131], a[208:211], v[144:147]
s_nop 0
ds_read_b64 a[170:171], v6 offset:1224
ds_read_b128 a[236:239], v7 offset:2240
v_mfma_f32_16x16x32_bf16 v[144:147], a[132:135], a[204:207], v[144:147]
buffer_store_dwordx4 v[248:251], v1, s[44:47], s70 offen offset:3072 sc1
v_mfma_f32_16x16x32_bf16 v[144:147], a[136:139], a[200:203], v[144:147]
s_mov_b32 s73, 0x5d800000
ds_read_b64 a[172:173], v6 offset:1728
ds_read_b64 a[174:175], v6 offset:1736
v_add_f32 v227, v226, v230
v_mfma_f32_16x16x32_bf16 v[144:147], a[140:143], a[196:199], v[144:147]
v_add_f32 v231, v234, v238
v_add_f32 v227, v227, v231
v_cmp_nlt_f32 vcc, v227, s73
v_mfma_f32_16x16x32_bf16 v[144:147], a[144:147], a[192:195], v[144:147]
s_lshl_b32 s73, s58, 2
v_mfma_f32_16x16x32_bf16 v[148:151], a[148:151], a[192:195], v[148:151]
s_add_u32 s73, s73, 163328
ds_read_b128 a[240:243], v7 offset:1728
ds_read_b64 a[176:177], v6 offset:2240
v_mov_b32 v231, s73
v_mfma_f32_16x16x32_bf16 v[148:151], a[144:147], a[196:199], v[148:151]
s_or_b32 s73, vcc_lo, vcc_hi
v_mfma_f32_16x16x32_bf16 v[148:151], a[140:143], a[200:203], v[148:151]
s_min_u32 s73, s73, 1
v_mov_b32 v227, s73
v_mfma_f32_16x16x32_bf16 v[148:151], a[136:139], a[204:207], v[148:151]
s_nop 0
ds_read_b64 a[178:179], v6 offset:2248
ds_read_b128 a[244:247], v7 offset:1216
ds_write_b32 v231, v227
v_mfma_f32_16x16x32_bf16 v[148:151], a[132:135], a[208:211], v[148:151]
v_mfma_f32_16x16x32_bf16 v[148:151], a[128:131], a[212:215], v[148:151]
s_nop 0
ds_read_b64 a[180:181], v6 offset:2752
ds_read_b64 a[182:183], v6 offset:2760
v_mfma_f32_16x16x32_bf16 v[152:155], a[128:131], a[216:219], v[152:155]
v_mfma_f32_16x16x32_bf16 v[152:155], a[132:135], a[212:215], v[152:155]
v_mfma_f32_16x16x32_bf16 v[152:155], a[136:139], a[208:211], v[152:155]
s_nop 0
ds_read_b128 a[248:251], v7 offset:704
ds_read_b64 a[184:185], v6 offset:3264
v_mfma_f32_16x16x32_bf16 v[152:155], a[140:143], a[204:207], v[152:155]
v_mfma_f32_16x16x32_bf16 v[152:155], a[144:147], a[200:203], v[152:155]
s_nop 0
ds_read_b64 a[186:187], v6 offset:3272
ds_read_b128 a[252:255], v7 offset:192
v_mfma_f32_16x16x32_bf16 v[152:155], a[148:151], a[196:199], v[152:155]
v_mfma_f32_16x16x32_bf16 v[152:155], a[152:155], a[192:195], v[152:155]
v_mfma_f32_16x16x32_bf16 v[156:159], a[156:159], a[192:195], v[156:159]
s_nop 0
ds_read_b64 a[188:189], v6 offset:3776
ds_read_b64 a[190:191], v6 offset:3784
v_mfma_f32_16x16x32_bf16 v[156:159], a[152:155], a[196:199], v[156:159]
v_mfma_f32_16x16x32_bf16 v[156:159], a[148:151], a[200:203], v[156:159]
v_mfma_f32_16x16x32_bf16 v[156:159], a[144:147], a[204:207], v[156:159]
v_mfma_f32_16x16x32_bf16 v[156:159], a[140:143], a[208:211], v[156:159]
v_mfma_f32_16x16x32_bf16 v[156:159], a[136:139], a[212:215], v[156:159]
v_mfma_f32_16x16x32_bf16 v[156:159], a[132:135], a[216:219], v[156:159]
v_mfma_f32_16x16x32_bf16 v[156:159], a[128:131], a[220:223], v[156:159]
s_waitcnt lgkmcnt(0)
v_mfma_f32_16x16x32_bf16 v[128:131], a[160:163], a[224:227], v[128:131]
s_nop 0
ds_read_b128 a[192:195], v7 offset:3840
ds_read_b64 a[128:129], v6 offset:256
v_mfma_f32_16x16x32_bf16 v[132:135], a[164:167], a[224:227], v[132:135]
v_mfma_f32_16x16x32_bf16 v[132:135], a[160:163], a[228:231], v[132:135]
s_nop 0
ds_read_b64 a[130:131], v6 offset:264
ds_read_b128 a[196:199], v7 offset:3328
v_mfma_f32_16x16x32_bf16 v[136:139], a[160:163], a[232:235], v[136:139]
v_mfma_f32_16x16x32_bf16 v[136:139], a[164:167], a[228:231], v[136:139]
v_mfma_f32_16x16x32_bf16 v[136:139], a[168:171], a[224:227], v[136:139]
s_nop 0
ds_read_b64 a[132:133], v6 offset:768
ds_read_b64 a[134:135], v6 offset:776
v_mfma_f32_16x16x32_bf16 v[140:143], a[172:175], a[224:227], v[140:143]
v_mfma_f32_16x16x32_bf16 v[140:143], a[168:171], a[228:231], v[140:143]
s_nop 0
ds_read_b128 a[200:203], v7 offset:2816
ds_read_b64 a[136:137], v6 offset:1280
v_mfma_f32_16x16x32_bf16 v[140:143], a[164:167], a[232:235], v[140:143]
v_mfma_f32_16x16x32_bf16 v[140:143], a[160:163], a[236:239], v[140:143]
v_mfma_f32_16x16x32_bf16 v[144:147], a[160:163], a[240:243], v[144:147]
s_nop 0
ds_read_b64 a[138:139], v6 offset:1288
ds_read_b128 a[204:207], v7 offset:2304
v_mfma_f32_16x16x32_bf16 v[144:147], a[164:167], a[236:239], v[144:147]
s_nop 3
s_mov_b64 exec, 0
s_cmp_eq_u32 s58, 0
s_cbranch_scc1 Lstube0
s_cmp_eq_u32 s58, 1
s_cbranch_scc1 Lstube1
s_cmp_eq_u32 s58, 2
s_cbranch_scc1 Lstube2
s_branch Lstube3
Lrete:
s_mov_b64 exec, -1
s_nop 3
v_mfma_f32_16x16x32_bf16 v[144:147], a[168:171], a[232:235], v[144:147]
s_waitcnt vmcnt(0) lgkmcnt(15)
ds_read_b64 a[140:141], v6 offset:1792
ds_read_b64 a[142:143], v6 offset:1800
v_mfma_f32_16x16x32_bf16 v[144:147], a[172:175], a[228:231], v[144:147]
s_barrier
v_mov_b32 v244, 163328
v_mfma_f32_16x16x32_bf16 v[144:147], a[176:179], a[224:227], v[144:147]
s_xor_b32 s71, s12, 0x100
ds_read_b128 v[240:243], v244
v_mfma_f32_16x16x32_bf16 v[148:151], a[180:183], a[224:227], v[148:151]
s_add_u32 m0, s77, 16384
ds_read_b128 a[208:211], v7 offset:1792
ds_read_b64 a[144:145], v6 offset:2304
v_mfma_f32_16x16x32_bf16 v[148:151], a[176:179], a[228:231], v[148:151]
s_add_u32 s72, s71, 0
buffer_load_dwordx4 v15, s[24:27], s72 offen lds
v_mfma_f32_16x16x32_bf16 v[148:151], a[172:175], a[232:235], v[148:151]
v_mfma_f32_16x16x32_bf16 v[148:151], a[168:171], a[236:239], v[148:151]
s_nop 0
ds_read_b64 a[146:147], v6 offset:2312
ds_read_b128 a[212:215], v7 offset:1280
v_mfma_f32_16x16x32_bf16 v[148:151], a[164:167], a[240:243], v[148:151]
s_add_u32 s72, s71, 15360
buffer_load_dwordx4 v15, s[24:27], s72 offen offset:1024 lds
v_mfma_f32_16x16x32_bf16 v[148:151], a[160:163], a[244:247], v[148:151]
s_waitcnt lgkmcnt(4)
ds_read_b64 a[148:149], v6 offset:2816
ds_read_b64 a[150:151], v6 offset:2824
v_mfma_f32_16x16x32_bf16 v[152:155], a[160:163], a[248:251], v[152:155]
v_or3_b32 v240, v240, v241, v242
v_or_b32 v240, v240, v243
v_mfma_f32_16x16x32_bf16 v[152:155], a[164:167], a[244:247], v[152:155]
v_cmp_lt_u32 vcc, s86, v240
s_cbranch_vccnz Lslow
v_mfma_f32_16x16x32_bf16 v[152:155], a[168:171], a[240:243], v[152:155]
s_nop 0
ds_read_b128 a[216:219], v7 offset:768
ds_read_b64 a[152:153], v6 offset:3328
v_mfma_f32_16x16x32_bf16 v[152:155], a[172:175], a[236:239], v[152:155]
v_or_b32 v240, s58, v0
v_mov_b32 v241, 2
v_mfma_f32_16x16x32_bf16 v[152:155], a[176:179], a[232:235], v[152:155]
s_add_u32 s72, s71, 30720
ds_read_b64 a[154:155], v6 offset:3336
ds_read_b128 a[220:223], v7 offset:256
v_mfma_f32_16x16x32_bf16 v[152:155], a[180:183], a[228:231], v[152:155]
buffer_load_dwordx4 v15, s[24:27], s72 offen offset:2048 lds
v_mfma_f32_16x16x32_bf16 v[152:155], a[184:187], a[224:227], v[152:155]
v_min_u32 v240, 1, v240
v_lshlrev_b32 v240, 30, v240
v_mfma_f32_16x16x32_bf16 v[156:159], a[188:191], a[224:227], v[156:159]
s_nop 0
ds_read_b64 a[156:157], v6 offset:3840
ds_read_b64 a[158:159], v6 offset:3848
v_mfma_f32_16x16x32_bf16 v[156:159], a[184:187], a[228:231], v[156:159]
buffer_store_dword v241, v240, s[44:47], s91 offen sc1
v_mfma_f32_16x16x32_bf16 v[156:159], a[180:183], a[232:235], v[156:159]
s_add_u32 s80, s93, 0x3400000
v_and_b32 v166, 7, v0
v_lshlrev_b32 v166, 4, v166
v_mfma_f32_16x16x32_bf16 v[156:159], a[176:179], a[236:239], v[156:159]
s_add_u32 s72, s71, 46080
buffer_load_dwordx4 v15, s[24:27], s72 offen offset:3072 lds
v_mfma_f32_16x16x32_bf16 v[156:159], a[172:175], a[240:243], v[156:159]
v_bfe_u32 v112, v0, 3, 1
v_lshl_add_u32 v166, v112, 8, v166
v_mfma_f32_16x16x32_bf16 v[156:159], a[168:171], a[244:247], v[156:159]
v_bfe_u32 v112, v0, 4, 1
v_lshl_add_u32 v166, v112, 7, v166
v_mfma_f32_16x16x32_bf16 v[156:159], a[164:167], a[248:251], v[156:159]
v_lshrrev_b32 v2, 4, v0
v_lshlrev_b32 v2, 10, v2
v_mfma_f32_16x16x32_bf16 v[156:159], a[160:163], a[252:255], v[156:159]
s_waitcnt lgkmcnt(0)
v_lshrrev_b32 v112, 5, v0
v_lshl_add_u32 v166, v112, 9, v166
v_mfma_f32_16x16x32_bf16 v[128:131], a[128:131], a[192:195], v[128:131]
s_xor_b32 s82, s78, 0
ds_read_b128 a[224:227], v7 offset:3904
ds_read_b64 a[160:161], v6 offset:320
v_mfma_f32_16x16x32_bf16 v[132:135], a[132:135], a[192:195], v[132:135]
s_xor_b32 s71, s12, 0x180
v_and_b32 v112, 15, v0
v_lshrrev_b32 v113, 2, v0
v_mfma_f32_16x16x32_bf16 v[132:135], a[128:131], a[196:199], v[132:135]
s_add_u32 m0, s77, 32768
ds_read_b64 a[162:163], v6 offset:328
ds_read_b128 a[228:231], v7 offset:3392
v_mfma_f32_16x16x32_bf16 v[136:139], a[128:131], a[200:203], v[136:139]
s_add_u32 s72, s71, 0
buffer_load_dwordx4 v15, s[24:27], s72 offen lds
v_mfma_f32_16x16x32_bf16 v[136:139], a[132:135], a[196:199], v[136:139]
s_lshl_b32 s82, s82, 10
v_bfe_u32 v114, v0, 3, 2
v_and_b32 v115, 3, v0
v_mfma_f32_16x16x32_bf16 v[136:139], a[136:139], a[192:195], v[136:139]
s_add_u32 s82, s82, s74
ds_read_b64 a[164:165], v6 offset:832
ds_read_b64 a[166:167], v6 offset:840
v_mfma_f32_16x16x32_bf16 v[140:143], a[140:143], a[192:195], v[140:143]
buffer_load_dword v3, v2, s[44:47], s82 offen sc1
v_mfma_f32_16x16x32_bf16 v[140:143], a[136:139], a[196:199], v[140:143]
s_add_u32 s72, s71, 15360
ds_read_b128 a[232:235], v7 offset:2880
ds_read_b64 a[168:169], v6 offset:1344
v_mfma_f32_16x16x32_bf16 v[140:143], a[132:135], a[200:203], v[140:143]
buffer_load_dwordx4 v15, s[24:27], s72 offen offset:1024 lds
v_mfma_f32_16x16x32_bf16 v[140:143], a[128:131], a[204:207], v[140:143]
v_lshlrev_b32 v8, 7, v113
v_lshl_add_u32 v8, v114, 5, v8
v_mfma_f32_16x16x32_bf16 v[144:147], a[128:131], a[208:211], v[144:147]
s_nop 0
ds_read_b64 a[170:171], v6 offset:1352
ds_read_b128 a[236:239], v7 offset:2368
v_mfma_f32_16x16x32_bf16 v[144:147], a[132:135], a[204:207], v[144:147]
v_lshl_add_u32 v8, v115, 3, v8
v_add_u32 v8, s77, v8
v_mfma_f32_16x16x32_bf16 v[144:147], a[136:139], a[200:203], v[144:147]
s_nop 0
ds_read_b64 a[172:173], v6 offset:1856
ds_read_b64 a[174:175], v6 offset:1864
v_mfma_f32_16x16x32_bf16 v[144:147], a[140:143], a[196:199], v[144:147]
s_add_u32 s72, s71, 30720
buffer_load_dwordx4 v15, s[24:27], s72 offen offset:2048 lds
v_mfma_f32_16x16x32_bf16 v[144:147], a[144:147], a[192:195], v[144:147]
v_subrev_u32 v8, s64, v8
v_xor_b32 v9, 32, v8
v_mfma_f32_16x16x32_bf16 v[148:151], a[148:151], a[192:195], v[148:151]
s_nop 0
ds_read_b128 a[240:243], v7 offset:1856
ds_read_b64 a[176:177], v6 offset:2368
v_mfma_f32_16x16x32_bf16 v[148:151], a[144:147], a[196:199], v[148:151]
v_xor_b32 v10, 64, v8
v_xor_b32 v11, 0x60, v8
v_mfma_f32_16x16x32_bf16 v[148:151], a[140:143], a[200:203], v[148:151]
v_lshlrev_b32 v5, 8, v113
v_and_b32 v114, 1, v0
v_mfma_f32_16x16x32_bf16 v[148:151], a[136:139], a[204:207], v[148:151]
s_nop 0
ds_read_b64 a[178:179], v6 offset:2376
ds_read_b128 a[244:247], v7 offset:1344
v_mfma_f32_16x16x32_bf16 v[148:151], a[132:135], a[208:211], v[148:151]
s_add_u32 s72, s71, 46080
buffer_load_dwordx4 v15, s[24:27], s72 offen offset:3072 lds
v_mfma_f32_16x16x32_bf16 v[148:151], a[128:131], a[212:215], v[148:151]
s_nop 0
ds_read_b64 a[180:181], v6 offset:2880
ds_read_b64 a[182:183], v6 offset:2888
v_mfma_f32_16x16x32_bf16 v[152:155], a[128:131], a[216:219], v[152:155]
v_lshl_add_u32 v5, v114, 7, v5
v_bfe_u32 v114, v0, 1, 1
v_mfma_f32_16x16x32_bf16 v[152:155], a[132:135], a[212:215], v[152:155]
v_lshl_add_u32 v5, v114, 3, v5
v_lshlrev_b32 v114, 1, s58
v_mfma_f32_16x16x32_bf16 v[152:155], a[136:139], a[208:211], v[152:155]
s_nop 0
ds_read_b128 a[248:251], v7 offset:832
ds_read_b64 a[184:185], v6 offset:3392
v_mfma_f32_16x16x32_bf16 v[152:155], a[140:143], a[204:207], v[152:155]
v_xor_b32 v114, v114, v113
v_and_b32 v114, 7, v114
v_mfma_f32_16x16x32_bf16 v[152:155], a[144:147], a[200:203], v[152:155]
s_xor_b32 s71, s13, 0x80
ds_read_b64 a[186:187], v6 offset:3400
ds_read_b128 a[252:255], v7 offset:320
v_mfma_f32_16x16x32_bf16 v[152:155], a[148:151], a[196:199], v[152:155]
s_add_u32 m0, s77, 49152
v_lshl_add_u32 v5, v114, 4, v5
v_add_u32 v5, 147456, v5
v_mfma_f32_16x16x32_bf16 v[152:155], a[152:155], a[192:195], v[152:155]
s_add_u32 s72, s71, 0
buffer_load_dwordx4 v15, s[24:27], s72 offen lds
v_mfma_f32_16x16x32_bf16 v[156:159], a[156:159], a[192:195], v[156:159]
s_nop 0
ds_read_b64 a[188:189], v6 offset:3904
ds_read_b64 a[190:191], v6 offset:3912
v_mfma_f32_16x16x32_bf16 v[156:159], a[152:155], a[196:199], v[156:159]
v_bfe_u32 v114, v0, 1, 2
v_lshrrev_b32 v115, 4, v0
v_mfma_f32_16x16x32_bf16 v[156:159], a[148:151], a[200:203], v[156:159]
v_lshlrev_b32 v116, 7, v112
v_lshl_add_u32 v116, v114, 5, v116
v_mfma_f32_16x16x32_bf16 v[156:159], a[144:147], a[204:207], v[156:159]
s_add_u32 s72, s71, 15360
buffer_load_dwordx4 v15, s[24:27], s72 offen offset:1024 lds
v_mfma_f32_16x16x32_bf16 v[156:159], a[140:143], a[208:211], v[156:159]
v_lshl_add_u32 v116, v115, 3, v116
v_add_u32 v116, s64, v116
v_mfma_f32_16x16x32_bf16 v[156:159], a[136:139], a[212:215], v[156:159]
v_add_u32 v116, 131072, v116
v_xor_b32 v117, 32, v116
v_mfma_f32_16x16x32_bf16 v[156:159], a[132:135], a[216:219], v[156:159]
v_xor_b32 v118, 64, v116
v_xor_b32 v119, 0x60, v116
v_mfma_f32_16x16x32_bf16 v[156:159], a[128:131], a[220:223], v[156:159]
s_waitcnt lgkmcnt(0)
v_mfma_f32_16x16x32_bf16 v[128:131], a[160:163], a[224:227], v[128:131]
s_nop 0
ds_read_b128 a[192:195], v7 offset:3968
ds_read_b64 a[128:129], v6 offset:384
v_mfma_f32_16x16x32_bf16 v[132:135], a[164:167], a[224:227], v[132:135]
s_add_u32 s72, s71, 30720
buffer_load_dwordx4 v15, s[24:27], s72 offen offset:2048 lds
v_mfma_f32_16x16x32_bf16 v[132:135], a[160:163], a[228:231], v[132:135]
s_nop 0
ds_read_b64 a[130:131], v6 offset:392
ds_read_b128 a[196:199], v7 offset:3456
v_mfma_f32_16x16x32_bf16 v[136:139], a[160:163], a[232:235], v[136:139]
v_mfma_f32_16x16x32_bf16 v[136:139], a[164:167], a[228:231], v[136:139]
Lstub9:
s_cbranch_execz Lret
v_mfma_f32_16x16x32_bf16 v[136:139], a[168:171], a[224:227], v[136:139]
s_nop 0
ds_read_b64 a[132:133], v6 offset:896
ds_read_b64 a[134:135], v6 offset:904
v_mfma_f32_16x16x32_bf16 v[140:143], a[172:175], a[224:227], v[140:143]
v_mfma_f32_16x16x32_bf16 v[140:143], a[168:171], a[228:231], v[140:143]
s_add_u32 s72, s71, 46080
ds_read_b128 a[200:203], v7 offset:2944
ds_read_b64 a[136:137], v6 offset:1408
v_mfma_f32_16x16x32_bf16 v[140:143], a[164:167], a[232:235], v[140:143]
buffer_load_dwordx4 v15, s[24:27], s72 offen offset:3072 lds
v_mfma_f32_16x16x32_bf16 v[140:143], a[160:163], a[236:239], v[140:143]
v_mfma_f32_16x16x32_bf16 v[144:147], a[160:163], a[240:243], v[144:147]
s_nop 0
ds_read_b64 a[138:139], v6 offset:1416
ds_read_b128 a[204:207], v7 offset:2432
v_mfma_f32_16x16x32_bf16 v[144:147], a[164:167], a[236:239], v[144:147]
v_mfma_f32_16x16x32_bf16 v[144:147], a[168:171], a[232:235], v[144:147]
s_nop 0
ds_read_b64 a[140:141], v6 offset:1920
ds_read_b64 a[142:143], v6 offset:1928
v_mfma_f32_16x16x32_bf16 v[144:147], a[172:175], a[228:231], v[144:147]
v_mfma_f32_16x16x32_bf16 v[144:147], a[176:179], a[224:227], v[144:147]
v_mfma_f32_16x16x32_bf16 v[148:151], a[180:183], a[224:227], v[148:151]
s_nop 0
ds_read_b128 a[208:211], v7 offset:1920
ds_read_b64 a[144:145], v6 offset:2432
v_mfma_f32_16x16x32_bf16 v[148:151], a[176:179], a[228:231], v[148:151]
v_mfma_f32_16x16x32_bf16 v[148:151], a[172:175], a[232:235], v[148:151]
s_waitcnt vmcnt(7)
v_cmp_gt_u32 vcc, 2, v3
s_or_b32 s81, vcc_lo, vcc_hi
s_cselect_b32 s81, 0x40000000, 0
v_or_b32 v4, s81, v1
v_mfma_f32_16x16x32_bf16 v[148:151], a[168:171], a[236:239], v[148:151]
s_nop 0
ds_read_b64 a[146:147], v6 offset:2440
ds_read_b128 a[212:215], v7 offset:1408
v_mfma_f32_16x16x32_bf16 v[148:151], a[164:167], a[240:243], v[148:151]
v_mfma_f32_16x16x32_bf16 v[148:151], a[160:163], a[244:247], v[148:151]
s_nop 0
ds_read_b64 a[148:149], v6 offset:2944
ds_read_b64 a[150:151], v6 offset:2952
v_mfma_f32_16x16x32_bf16 v[152:155], a[160:163], a[248:251], v[152:155]
v_mfma_f32_16x16x32_bf16 v[152:155], a[164:167], a[244:247], v[152:155]
s_lshr_b32 s69, s12, 18
v_mfma_f32_16x16x32_bf16 v[152:155], a[168:171], a[240:243], v[152:155]
s_lshl_b32 s69, s69, 12
ds_read_b128 a[216:219], v7 offset:896
ds_read_b64 a[152:153], v6 offset:3456
v_mfma_f32_16x16x32_bf16 v[152:155], a[172:175], a[236:239], v[152:155]
s_add_u32 s69, s69, s95
buffer_load_dwordx4 a[0:3], v4, s[44:47], s69 offen sc1
v_mfma_f32_16x16x32_bf16 v[152:155], a[176:179], a[232:235], v[152:155]
s_nop 0
ds_read_b64 a[154:155], v6 offset:3464
ds_read_b128 a[220:223], v7 offset:384
v_mfma_f32_16x16x32_bf16 v[152:155], a[180:183], a[228:231], v[152:155]
v_mfma_f32_16x16x32_bf16 v[152:155], a[184:187], a[224:227], v[152:155]
v_mfma_f32_16x16x32_bf16 v[156:159], a[188:191], a[224:227], v[156:159]
s_nop 0
ds_read_b64 a[156:157], v6 offset:3968
ds_read_b64 a[158:159], v6 offset:3976
v_mfma_f32_16x16x32_bf16 v[156:159], a[184:187], a[228:231], v[156:159]
buffer_load_dwordx4 a[4:7], v4, s[44:47], s69 offen offset:1024 sc1
v_mfma_f32_16x16x32_bf16 v[156:159], a[180:183], a[232:235], v[156:159]
v_mfma_f32_16x16x32_bf16 v[156:159], a[176:179], a[236:239], v[156:159]
v_mfma_f32_16x16x32_bf16 v[156:159], a[172:175], a[240:243], v[156:159]
v_mfma_f32_16x16x32_bf16 v[156:159], a[168:171], a[244:247], v[156:159]
buffer_load_dwordx4 a[8:11], v4, s[44:47], s69 offen offset:2048 sc1
v_mfma_f32_16x16x32_bf16 v[156:159], a[164:167], a[248:251], v[156:159]
v_mfma_f32_16x16x32_bf16 v[156:159], a[160:163], a[252:255], v[156:159]
s_waitcnt lgkmcnt(0)
v_mfma_f32_16x16x32_bf16 v[128:131], a[128:131], a[192:195], v[128:131]
s_nop 0
ds_read_b128 a[224:227], v7 offset:4032
ds_read_b64 a[160:161], v6 offset:448
v_mfma_f32_16x16x32_bf16 v[132:135], a[132:135], a[192:195], v[132:135]
v_mfma_f32_16x16x32_bf16 v[132:135], a[128:131], a[196:199], v[132:135]
s_nop 0
ds_read_b64 a[162:163], v6 offset:456
ds_read_b128 a[228:231], v7 offset:3520
v_mfma_f32_16x16x32_bf16 v[136:139], a[128:131], a[200:203], v[136:139]
buffer_load_dwordx4 a[12:15], v4, s[44:47], s69 offen offset:3072 sc1
v_mfma_f32_16x16x32_bf16 v[136:139], a[132:135], a[196:199], v[136:139]
v_mfma_f32_16x16x32_bf16 v[136:139], a[136:139], a[192:195], v[136:139]
s_nop 0
ds_read_b64 a[164:165], v6 offset:960
ds_read_b64 a[166:167], v6 offset:968
v_mfma_f32_16x16x32_bf16 v[140:143], a[140:143], a[192:195], v[140:143]
v_mfma_f32_16x16x32_bf16 v[140:143], a[136:139], a[196:199], v[140:143]
s_nop 0
ds_read_b128 a[232:235], v7 offset:3008
ds_read_b64 a[168:169], v6 offset:1472
v_mfma_f32_16x16x32_bf16 v[140:143], a[132:135], a[200:203], v[140:143]
s_add_u32 s69, s69, 0x20000
buffer_load_dwordx4 a[16:19], v4, s[44:47], s69 offen sc1
v_mfma_f32_16x16x32_bf16 v[140:143], a[128:131], a[204:207], v[140:143]
v_mfma_f32_16x16x32_bf16 v[144:147], a[128:131], a[208:211], v[144:147]
s_nop 0
ds_read_b64 a[170:171], v6 offset:1480
ds_read_b128 a[236:239], v7 offset:2496
v_mfma_f32_16x16x32_bf16 v[144:147], a[132:135], a[204:207], v[144:147]
v_mfma_f32_16x16x32_bf16 v[144:147], a[136:139], a[200:203], v[144:147]
s_nop 0
ds_read_b64 a[172:173], v6 offset:1984
ds_read_b64 a[174:175], v6 offset:1992
v_mfma_f32_16x16x32_bf16 v[144:147], a[140:143], a[196:199], v[144:147]
buffer_load_dwordx4 a[20:23], v4, s[44:47], s69 offen offset:1024 sc1
v_mfma_f32_16x16x32_bf16 v[144:147], a[144:147], a[192:195], v[144:147]
v_mfma_f32_16x16x32_bf16 v[148:151], a[148:151], a[192:195], v[148:151]
s_nop 0
ds_read_b128 a[240:243], v7 offset:1984
ds_read_b64 a[176:177], v6 offset:2496
v_mfma_f32_16x16x32_bf16 v[148:151], a[144:147], a[196:199], v[148:151]
v_mfma_f32_16x16x32_bf16 v[148:151], a[140:143], a[200:203], v[148:151]
v_mfma_f32_16x16x32_bf16 v[148:151], a[136:139], a[204:207], v[148:151]
s_nop 0
ds_read_b64 a[178:179], v6 offset:2504
ds_read_b128 a[244:247], v7 offset:1472
v_mfma_f32_16x16x32_bf16 v[148:151], a[132:135], a[208:211], v[148:151]
buffer_load_dwordx4 a[24:27], v4, s[44:47], s69 offen offset:2048 sc1
v_mfma_f32_16x16x32_bf16 v[148:151], a[128:131], a[212:215], v[148:151]
s_nop 0
ds_read_b64 a[180:181], v6 offset:3008
ds_read_b64 a[182:183], v6 offset:3016
v_mfma_f32_16x16x32_bf16 v[152:155], a[128:131], a[216:219], v[152:155]
v_mfma_f32_16x16x32_bf16 v[152:155], a[132:135], a[212:215], v[152:155]
v_mfma_f32_16x16x32_bf16 v[152:155], a[136:139], a[208:211], v[152:155]
s_nop 0
ds_read_b128 a[248:251], v7 offset:960
ds_read_b64 a[184:185], v6 offset:3520
v_mfma_f32_16x16x32_bf16 v[152:155], a[140:143], a[204:207], v[152:155]
buffer_load_dwordx4 a[28:31], v4, s[44:47], s69 offen offset:3072 sc1
v_mfma_f32_16x16x32_bf16 v[152:155], a[144:147], a[200:203], v[152:155]
s_nop 0
ds_read_b64 a[186:187], v6 offset:3528
ds_read_b128 a[252:255], v7 offset:448
v_mfma_f32_16x16x32_bf16 v[152:155], a[148:151], a[196:199], v[152:155]
v_mfma_f32_16x16x32_bf16 v[152:155], a[152:155], a[192:195], v[152:155]
s_lshr_b32 s69, s13, 18
v_mfma_f32_16x16x32_bf16 v[156:159], a[156:159], a[192:195], v[156:159]
s_lshl_b32 s69, s69, 12
ds_read_b64 a[188:189], v6 offset:4032
ds_read_b64 a[190:191], v6 offset:4040
v_mfma_f32_16x16x32_bf16 v[156:159], a[152:155], a[196:199], v[156:159]
s_add_u32 s69, s69, s95
buffer_load_dwordx4 a[32:35], v4, s[44:47], s69 offen sc1
v_mfma_f32_16x16x32_bf16 v[156:159], a[148:151], a[200:203], v[156:159]
v_mfma_f32_16x16x32_bf16 v[156:159], a[144:147], a[204:207], v[156:159]
v_mfma_f32_16x16x32_bf16 v[156:159], a[140:143], a[208:211], v[156:159]
v_mfma_f32_16x16x32_bf16 v[156:159], a[136:139], a[212:215], v[156:159]
buffer_load_dwordx4 a[36:39], v4, s[44:47], s69 offen offset:1024 sc1
v_mfma_f32_16x16x32_bf16 v[156:159], a[132:135], a[216:219], v[156:159]
v_mfma_f32_16x16x32_bf16 v[156:159], a[128:131], a[220:223], v[156:159]
s_waitcnt lgkmcnt(0)
v_mfma_f32_16x16x32_bf16 v[128:131], a[160:163], a[224:227], v[128:131]
s_nop 0
ds_read_b64_tr_b16 v[192:193], v8 offset:0
ds_read_b64_tr_b16 v[194:195], v8 offset:2048
v_mfma_f32_16x16x32_bf16 v[132:135], a[164:167], a[224:227], v[132:135]
v_mfma_f32_16x16x32_bf16 v[132:135], a[160:163], a[228:231], v[132:135]
s_nop 0
ds_read_b64_tr_b16 v[196:197], v9 offset:0
ds_read_b64_tr_b16 v[198:199], v9 offset:2048
v_mfma_f32_16x16x32_bf16 v[136:139], a[160:163], a[232:235], v[136:139]
buffer_load_dwordx4 a[40:43], v4, s[44:47], s69 offen offset:2048 sc1
v_mfma_f32_16x16x32_bf16 v[136:139], a[164:167], a[228:231], v[136:139]
s_nop 0
ds_read_b64_tr_b16 v[200:201], v10 offset:0
ds_read_b64_tr_b16 v[202:203], v10 offset:2048
v_mfma_f32_16x16x32_bf16 v[136:139], a[168:171], a[224:227], v[136:139]
v_mfma_f32_16x16x32_bf16 v[140:143], a[172:175], a[224:227], v[140:143]
s_nop 0
ds_read_b64_tr_b16 v[204:205], v11 offset:0
ds_read_b64_tr_b16 v[206:207], v11 offset:2048
v_mfma_f32_16x16x32_bf16 v[140:143], a[168:171], a[228:231], v[140:143]
v_cvt_pk_bf16_f32 v128, v128, v129
v_cvt_pk_bf16_f32 v129, v130, v131
v_cvt_pk_bf16_f32 v130, v132, v133
v_mfma_f32_16x16x32_bf16 v[140:143], a[164:167], a[232:235], v[140:143]
s_nop 0
ds_read_b64_tr_b16 v[208:209], v8 offset:4096
ds_read_b64_tr_b16 v[210:211], v8 offset:6144
v_cvt_pk_bf16_f32 v131, v134, v135
v_mfma_f32_16x16x32_bf16 v[140:143], a[160:163], a[236:239], v[140:143]
s_nop 0
buffer_load_dwordx4 a[44:47], v4, s[44:47], s69 offen offset:3072 sc1
v_permlane32_swap_b32 v128, v130
v_mfma_f32_16x16x32_bf16 v[144:147], a[160:163], a[240:243], v[144:147]
s_nop 0
ds_read_b64_tr_b16 v[212:213], v9 offset:4096
ds_read_b64_tr_b16 v[214:215], v9 offset:6144
v_permlane32_swap_b32 v129, v131
v_mfma_f32_16x16x32_bf16 v[144:147], a[164:167], a[236:239], v[144:147]
buffer_store_dwordx4 v[128:131], v166, s[44:47], s80 offen sc1
v_mfma_f32_16x16x32_bf16 v[144:147], a[168:171], a[232:235], v[144:147]
s_nop 0
ds_read_b64_tr_b16 v[216:217], v10 offset:4096
ds_read_b64_tr_b16 v[218:219], v10 offset:6144
v_mfma_f32_16x16x32_bf16 v[144:147], a[172:175], a[228:231], v[144:147]
s_add_u32 s69, s69, 0x20000
buffer_load_dwordx4 a[48:51], v4, s[44:47], s69 offen sc1
v_mfma_f32_16x16x32_bf16 v[144:147], a[176:179], a[224:227], v[144:147]
s_nop 0
ds_read_b64_tr_b16 v[220:221], v11 offset:4096
ds_read_b64_tr_b16 v[222:223], v11 offset:6144
v_cvt_pk_bf16_f32 v136, v136, v137
v_mfma_f32_16x16x32_bf16 v[148:151], a[180:183], a[224:227], v[148:151]
v_cvt_pk_bf16_f32 v137, v138, v139
v_cvt_pk_bf16_f32 v138, v140, v141
v_cvt_pk_bf16_f32 v139, v142, v143
v_mfma_f32_16x16x32_bf16 v[148:151], a[176:179], a[228:231], v[148:151]
s_nop 0
ds_read_b64_tr_b16 v[224:225], v8 offset:8192
ds_read_b64_tr_b16 v[226:227], v8 offset:10240
v_permlane32_swap_b32 v136, v138
v_mfma_f32_16x16x32_bf16 v[148:151], a[172:175], a[232:235], v[148:151]
v_permlane32_swap_b32 v137, v139
v_mfma_f32_16x16x32_bf16 v[148:151], a[168:171], a[236:239], v[148:151]
s_nop 0
ds_read_b64_tr_b16 v[228:229], v9 offset:8192
ds_read_b64_tr_b16 v[230:231], v9 offset:10240
v_mfma_f32_16x16x32_bf16 v[148:151], a[164:167], a[240:243], v[148:151]
buffer_load_dwordx4 a[52:55], v4, s[44:47], s69 offen offset:1024 sc1
v_mfma_f32_16x16x32_bf16 v[148:151], a[160:163], a[244:247], v[148:151]
s_nop 0
ds_read_b64_tr_b16 v[232:233], v10 offset:8192
ds_read_b64_tr_b16 v[234:235], v10 offset:10240
v_mfma_f32_16x16x32_bf16 v[152:155], a[160:163], a[248:251], v[152:155]
buffer_store_dwordx4 v[136:139], v166, s[44:47], s80 offen offset:1024 sc1
v_mfma_f32_16x16x32_bf16 v[152:155], a[164:167], a[244:247], v[152:155]
s_nop 0
ds_read_b64_tr_b16 v[236:237], v11 offset:8192
ds_read_b64_tr_b16 v[238:239], v11 offset:10240
v_mfma_f32_16x16x32_bf16 v[152:155], a[168:171], a[240:243], v[152:155]
buffer_load_dwordx4 a[56:59], v4, s[44:47], s69 offen offset:2048 sc1
v_mfma_f32_16x16x32_bf16 v[152:155], a[172:175], a[236:239], v[152:155]
s_nop 0
ds_read_b64_tr_b16 v[240:241], v8 offset:12288
ds_read_b64_tr_b16 v[242:243], v8 offset:14336
v_mfma_f32_16x16x32_bf16 v[152:155], a[176:179], a[232:235], v[152:155]
v_cvt_pk_bf16_f32 v144, v144, v145
v_cvt_pk_bf16_f32 v145, v146, v147
v_cvt_pk_bf16_f32 v146, v148, v149
v_mfma_f32_16x16x32_bf16 v[152:155], a[180:183], a[228:231], v[152:155]
s_nop 0
ds_read_b64_tr_b16 v[244:245], v9 offset:12288
ds_read_b64_tr_b16 v[246:247], v9 offset:14336
v_cvt_pk_bf16_f32 v147, v150, v151
v_mfma_f32_16x16x32_bf16 v[152:155], a[184:187], a[224:227], v[152:155]
v_permlane32_swap_b32 v144, v146
v_permlane32_swap_b32 v145, v147
v_mfma_f32_16x16x32_bf16 v[156:159], a[188:191], a[224:227], v[156:159]
s_nop 0
ds_read_b64_tr_b16 v[248:249], v10 offset:12288
ds_read_b64_tr_b16 v[250:251], v10 offset:14336
v_mfma_f32_16x16x32_bf16 v[156:159], a[184:187], a[228:231], v[156:159]
buffer_load_dwordx4 a[60:63], v4, s[44:47], s69 offen offset:3072 sc1
v_mfma_f32_16x16x32_bf16 v[156:159], a[180:183], a[232:235], v[156:159]
s_nop 0
ds_read_b64_tr_b16 v[252:253], v11 offset:12288
ds_read_b64_tr_b16 v[254:255], v11 offset:14336
v_mfma_f32_16x16x32_bf16 v[156:159], a[176:179], a[236:239], v[156:159]
buffer_store_dwordx4 v[144:147], v166, s[44:47], s80 offen offset:2048 sc1
v_mfma_f32_16x16x32_bf16 v[156:159], a[172:175], a[240:243], v[156:159]
v_mfma_f32_16x16x32_bf16 v[156:159], a[168:171], a[244:247], v[156:159]
v_mfma_f32_16x16x32_bf16 v[156:159], a[164:167], a[248:251], v[156:159]
v_mfma_f32_16x16x32_bf16 v[156:159], a[160:163], a[252:255], v[156:159]
v_cvt_pk_bf16_f32 v152, v152, v153
v_cvt_pk_bf16_f32 v153, v154, v155
s_nop 5
v_cvt_pk_bf16_f32 v154, v156, v157
v_cvt_pk_bf16_f32 v155, v158, v159
s_nop 0
v_permlane32_swap_b32 v152, v154
v_permlane32_swap_b32 v153, v155
buffer_store_dwordx4 v[152:155], v166, s[44:47], s80 offen offset:3072 sc1
s_waitcnt vmcnt(12) lgkmcnt(0)
s_cmp_lg_u32 s81, 0
s_cbranch_scc1 Lredo0
Lredo0b:
s_barrier
v_mfma_f32_16x16x32_bf16 v[16:19], v[192:195], a[0:3], 0
s_nop 0
ds_read_b64_tr_b16 v[128:129], v8 offset:16384
ds_read_b64_tr_b16 v[130:131], v8 offset:18432
v_mfma_f32_16x16x32_bf16 v[16:19], v[208:211], a[4:7], v[16:19]
s_xor_b32 s71, s13, 0x100
ds_read_b64_tr_b16 v[132:133], v9 offset:16384
ds_read_b64_tr_b16 v[134:135], v9 offset:18432
v_mfma_f32_16x16x32_bf16 v[16:19], v[224:227], a[8:11], v[16:19]
s_add_u32 m0, s85, 0
ds_read_b64_tr_b16 v[136:137], v10 offset:16384
ds_read_b64_tr_b16 v[138:139], v10 offset:18432
v_mfma_f32_16x16x32_bf16 v[16:19], v[240:243], a[12:15], v[16:19]
s_add_u32 s72, s71, 0
buffer_load_dwordx4 v15, s[24:27], s72 offen lds
v_mfma_f32_16x16x32_bf16 v[32:35], v[240:243], a[28:31], 0
s_lshr_b32 s69, s14, 18
ds_read_b64_tr_b16 v[140:141], v11 offset:16384
ds_read_b64_tr_b16 v[142:143], v11 offset:18432
v_mfma_f32_16x16x32_bf16 v[32:35], v[224:227], a[24:27], v[32:35]
s_lshl_b32 s69, s69, 12
v_add_u32 v4, s64, v1
v_add_u32 v4, 131072, v4
v_mfma_f32_16x16x32_bf16 v[32:35], v[208:211], a[20:23], v[32:35]
s_add_u32 s69, s69, s95
buffer_load_dwordx4 a[64:67], v1, s[44:47], s69 offen sc1
v_mfma_f32_16x16x32_bf16 v[32:35], v[192:195], a[16:19], v[32:35]
s_lshl_b32 s70, s75, 18
ds_read_b64_tr_b16 v[144:145], v8 offset:20480
ds_read_b64_tr_b16 v[146:147], v8 offset:22528
v_mfma_f32_16x16x32_bf16 v[36:39], v[196:199], a[16:19], 0
s_add_u32 s72, s71, 15360
buffer_load_dwordx4 v15, s[24:27], s72 offen offset:1024 lds
v_mfma_f32_16x16x32_bf16 v[36:39], v[212:215], a[20:23], v[36:39]
s_add_u32 s70, s70, s94
ds_read_b64_tr_b16 v[148:149], v9 offset:20480
ds_read_b64_tr_b16 v[150:151], v9 offset:22528
v_mfma_f32_16x16x32_bf16 v[36:39], v[228:231], a[24:27], v[36:39]
s_nop 0
ds_read_b64_tr_b16 v[152:153], v10 offset:20480
ds_read_b64_tr_b16 v[154:155], v10 offset:22528
v_mfma_f32_16x16x32_bf16 v[36:39], v[244:247], a[28:31], v[36:39]
s_nop 0
ds_read_b64_tr_b16 v[156:157], v11 offset:20480
ds_read_b64_tr_b16 v[158:159], v11 offset:22528
v_mfma_f32_16x16x32_bf16 v[20:23], v[244:247], a[12:15], 0
ds_write_b128 v4, v[80:83] offset:0
v_mfma_f32_16x16x32_bf16 v[20:23], v[228:231], a[8:11], v[20:23]
s_nop 0
ds_read_b64_tr_b16 v[160:161], v8 offset:24576
ds_read_b64_tr_b16 v[162:163], v8 offset:26624
v_mfma_f32_16x16x32_bf16 v[20:23], v[212:215], a[4:7], v[20:23]
s_add_u32 s72, s71, 30720
buffer_load_dwordx4 v15, s[24:27], s72 offen offset:2048 lds
v_mfma_f32_16x16x32_bf16 v[20:23], v[196:199], a[0:3], v[20:23]
buffer_load_dwordx4 a[68:71], v1, s[44:47], s69 offen offset:1024 sc1
v_mfma_f32_16x16x32_bf16 v[24:27], v[200:203], a[0:3], 0
s_nop 0
ds_read_b64_tr_b16 v[164:165], v9 offset:24576
ds_read_b64_tr_b16 v[166:167], v9 offset:26624
v_mfma_f32_16x16x32_bf16 v[24:27], v[216:219], a[4:7], v[24:27]
s_nop 0
ds_read_b64_tr_b16 v[168:169], v10 offset:24576
ds_read_b64_tr_b16 v[170:171], v10 offset:26624
v_mfma_f32_16x16x32_bf16 v[24:27], v[232:235], a[8:11], v[24:27]
s_nop 0
ds_read_b64_tr_b16 v[172:173], v11 offset:24576
ds_read_b64_tr_b16 v[174:175], v11 offset:26624
v_mfma_f32_16x16x32_bf16 v[24:27], v[248:251], a[12:15], v[24:27]
ds_write_b128 v4, v[84:87] offset:1024
v_mfma_f32_16x16x32_bf16 v[40:43], v[248:251], a[28:31], 0
s_add_u32 s72, s71, 46080
buffer_load_dwordx4 v15, s[24:27], s72 offen offset:3072 lds
v_mfma_f32_16x16x32_bf16 v[40:43], v[232:235], a[24:27], v[40:43]
s_nop 0
ds_read_b64_tr_b16 v[176:177], v8 offset:28672
ds_read_b64_tr_b16 v[178:179], v8 offset:30720
v_mfma_f32_16x16x32_bf16 v[40:43], v[216:219], a[20:23], v[40:43]
s_nop 0
ds_read_b64_tr_b16 v[180:181], v9 offset:28672
ds_read_b64_tr_b16 v[182:183], v9 offset:30720
v_mfma_f32_16x16x32_bf16 v[40:43], v[200:203], a[16:19], v[40:43]
s_nop 0
ds_read_b64_tr_b16 v[184:185], v10 offset:28672
ds_read_b64_tr_b16 v[186:187], v10 offset:30720
v_mfma_f32_16x16x32_bf16 v[44:47], v[204:207], a[16:19], 0
s_nop 0
ds_read_b64_tr_b16 v[188:189], v11 offset:28672
ds_read_b64_tr_b16 v[190:191], v11 offset:30720
v_mfma_f32_16x16x32_bf16 v[44:47], v[220:223], a[20:23], v[44:47]
buffer_load_dwordx4 a[72:75], v1, s[44:47], s69 offen offset:2048 sc1
v_mfma_f32_16x16x32_bf16 v[44:47], v[236:239], a[24:27], v[44:47]
ds_write_b128 v4, v[96:99] offset:2048
v_mfma_f32_16x16x32_bf16 v[44:47], v[252:255], a[28:31], v[44:47]
s_xor_b32 s71, s13, 0x180
v_mfma_f32_16x16x32_bf16 v[28:31], v[252:255], a[12:15], 0
s_add_u32 m0, s85, 16384
ds_write_b128 v4, v[100:103] offset:3072
v_mfma_f32_16x16x32_bf16 v[28:31], v[236:239], a[8:11], v[28:31]
s_add_u32 s72, s71, 0
v_mfma_f32_16x16x32_bf16 v[28:31], v[220:223], a[4:7], v[28:31]
s_waitcnt vmcnt(31) lgkmcnt(0)
buffer_load_dwordx4 v15, s[24:27], s72 offen lds
v_mfma_f32_16x16x32_bf16 v[28:31], v[204:207], a[0:3], v[28:31]
s_barrier
v_mfma_f32_16x16x32_bf16 v[48:51], v[128:131], a[0:3], 0
s_nop 0
ds_read_b64_tr_b16 v[192:193], v8 offset:32768
ds_read_b64_tr_b16 v[194:195], v8 offset:34816
v_mfma_f32_16x16x32_bf16 v[48:51], v[144:147], a[4:7], v[48:51]
s_nop 0
ds_read_b64_tr_b16 v[196:197], v9 offset:32768
ds_read_b64_tr_b16 v[198:199], v9 offset:34816
v_mfma_f32_16x16x32_bf16 v[48:51], v[160:163], a[8:11], v[48:51]
s_nop 0
ds_read_b64_tr_b16 v[200:201], v10 offset:32768
ds_read_b64_tr_b16 v[202:203], v10 offset:34816
v_mfma_f32_16x16x32_bf16 v[48:51], v[176:179], a[12:15], v[48:51]
s_add_u32 s72, s71, 15360
buffer_load_dwordx4 v15, s[24:27], s72 offen offset:1024 lds
v_mfma_f32_16x16x32_bf16 v[64:67], v[176:179], a[28:31], 0
buffer_load_dwordx4 a[76:79], v1, s[44:47], s69 offen offset:3072 sc1
v_mfma_f32_16x16x32_bf16 v[64:67], v[160:163], a[24:27], v[64:67]
s_nop 0
ds_read_b64_tr_b16 v[204:205], v11 offset:32768
ds_read_b64_tr_b16 v[206:207], v11 offset:34816
v_mfma_f32_16x16x32_bf16 v[64:67], v[144:147], a[20:23], v[64:67]
v_mfma_f32_16x16x32_bf16 v[64:67], v[128:131], a[16:19], v[64:67]
s_nop 0
ds_read_b64_tr_b16 v[208:209], v8 offset:36864
ds_read_b64_tr_b16 v[210:211], v8 offset:38912
v_mfma_f32_16x16x32_bf16 v[68:71], v[132:135], a[16:19], 0
s_nop 0
ds_read_b64_tr_b16 v[212:213], v9 offset:36864
ds_read_b64_tr_b16 v[214:215], v9 offset:38912
v_mfma_f32_16x16x32_bf16 v[68:71], v[148:151], a[20:23], v[68:71]
s_add_u32 s72, s71, 30720
buffer_load_dwordx4 v15, s[24:27], s72 offen offset:2048 lds
v_mfma_f32_16x16x32_bf16 v[68:71], v[164:167], a[24:27], v[68:71]
s_nop 0
ds_read_b64_tr_b16 v[216:217], v10 offset:36864
ds_read_b64_tr_b16 v[218:219], v10 offset:38912
v_mfma_f32_16x16x32_bf16 v[68:71], v[180:183], a[28:31], v[68:71]
s_nop 0
ds_read_b64_tr_b16 v[220:221], v11 offset:36864
ds_read_b64_tr_b16 v[222:223], v11 offset:38912
v_mfma_f32_16x16x32_bf16 v[52:55], v[180:183], a[12:15], 0
v_mfma_f32_16x16x32_bf16 v[52:55], v[164:167], a[8:11], v[52:55]
s_add_u32 s69, s69, 0x20000
buffer_load_dwordx4 a[80:83], v1, s[44:47], s69 offen sc1
v_mfma_f32_16x16x32_bf16 v[52:55], v[148:151], a[4:7], v[52:55]
s_nop 0
ds_read_b64_tr_b16 v[224:225], v8 offset:40960
ds_read_b64_tr_b16 v[226:227], v8 offset:43008
v_mfma_f32_16x16x32_bf16 v[52:55], v[132:135], a[0:3], v[52:55]
s_add_u32 s72, s71, 46080
buffer_load_dwordx4 v15, s[24:27], s72 offen offset:3072 lds
v_mfma_f32_16x16x32_bf16 v[56:59], v[136:139], a[0:3], 0
s_nop 0
ds_read_b64_tr_b16 v[228:229], v9 offset:40960
ds_read_b64_tr_b16 v[230:231], v9 offset:43008
v_mfma_f32_16x16x32_bf16 v[56:59], v[152:155], a[4:7], v[56:59]
s_nop 0
ds_read_b64_tr_b16 v[232:233], v10 offset:40960
ds_read_b64_tr_b16 v[234:235], v10 offset:43008
v_mfma_f32_16x16x32_bf16 v[56:59], v[168:171], a[8:11], v[56:59]
s_nop 0
ds_read_b64_tr_b16 v[236:237], v11 offset:40960
ds_read_b64_tr_b16 v[238:239], v11 offset:43008
v_mfma_f32_16x16x32_bf16 v[56:59], v[184:187], a[12:15], v[56:59]
v_mfma_f32_16x16x32_bf16 v[72:75], v[184:187], a[28:31], 0
s_nop 0
ds_read_b64_tr_b16 v[240:241], v8 offset:45056
ds_read_b64_tr_b16 v[242:243], v8 offset:47104
v_mfma_f32_16x16x32_bf16 v[72:75], v[168:171], a[24:27], v[72:75]
s_nop 0
ds_read_b64_tr_b16 v[244:245], v9 offset:45056
ds_read_b64_tr_b16 v[246:247], v9 offset:47104
v_mfma_f32_16x16x32_bf16 v[72:75], v[152:155], a[20:23], v[72:75]
s_nop 0
ds_read_b64_tr_b16 v[248:249], v10 offset:45056
ds_read_b64_tr_b16 v[250:251], v10 offset:47104
v_mfma_f32_16x16x32_bf16 v[72:75], v[136:139], a[16:19], v[72:75]
s_xor_b32 s71, s14, 0x80
buffer_load_dwordx4 a[84:87], v1, s[44:47], s69 offen offset:1024 sc1
v_mfma_f32_16x16x32_bf16 v[76:79], v[140:143], a[16:19], 0
s_add_u32 m0, s85, 32768
ds_read_b64_tr_b16 v[252:253], v11 offset:45056
ds_read_b64_tr_b16 v[254:255], v11 offset:47104
v_mfma_f32_16x16x32_bf16 v[76:79], v[156:159], a[20:23], v[76:79]
s_add_u32 s72, s71, 0
buffer_load_dwordx4 v15, s[24:27], s72 offen lds
v_mfma_f32_16x16x32_bf16 v[76:79], v[172:175], a[24:27], v[76:79]
v_mfma_f32_16x16x32_bf16 v[76:79], v[188:191], a[28:31], v[76:79]
v_mfma_f32_16x16x32_bf16 v[60:63], v[188:191], a[12:15], 0
v_mfma_f32_16x16x32_bf16 v[60:63], v[172:175], a[8:11], v[60:63]
s_add_u32 s72, s71, 15360
v_mfma_f32_16x16x32_bf16 v[60:63], v[156:159], a[4:7], v[60:63]
s_waitcnt vmcnt(35) lgkmcnt(0)
v_mfma_f32_16x16x32_bf16 v[60:63], v[140:143], a[0:3], v[60:63]
s_barrier
buffer_load_dwordx4 v15, s[24:27], s72 offen offset:1024 lds
v_mfma_f32_16x16x32_bf16 v[80:83], v[192:195], a[0:3], 0
s_nop 0
ds_read_b64_tr_b16 v[128:129], v8 offset:49152
ds_read_b64_tr_b16 v[130:131], v8 offset:51200
v_mfma_f32_16x16x32_bf16 v[80:83], v[208:211], a[4:7], v[80:83]
buffer_load_dwordx4 a[88:91], v1, s[44:47], s69 offen offset:2048 sc1
v_mfma_f32_16x16x32_bf16 v[80:83], v[224:227], a[8:11], v[80:83]
s_nop 0
ds_read_b64_tr_b16 v[132:133], v9 offset:49152
ds_read_b64_tr_b16 v[134:135], v9 offset:51200
v_mfma_f32_16x16x32_bf16 v[80:83], v[240:243], a[12:15], v[80:83]
s_nop 0
ds_read_b64_tr_b16 v[136:137], v10 offset:49152
ds_read_b64_tr_b16 v[138:139], v10 offset:51200
v_mfma_f32_16x16x32_bf16 v[96:99], v[240:243], a[28:31], 0
s_nop 0
ds_read_b64_tr_b16 v[140:141], v11 offset:49152
ds_read_b64_tr_b16 v[142:143], v11 offset:51200
v_mfma_f32_16x16x32_bf16 v[96:99], v[224:227], a[24:27], v[96:99]
s_add_u32 s72, s71, 30720
buffer_load_dwordx4 v15, s[24:27], s72 offen offset:2048 lds
v_mfma_f32_16x16x32_bf16 v[96:99], v[208:211], a[20:23], v[96:99]
v_mfma_f32_16x16x32_bf16 v[96:99], v[192:195], a[16:19], v[96:99]
s_nop 0
ds_read_b64_tr_b16 v[144:145], v8 offset:53248
ds_read_b64_tr_b16 v[146:147], v8 offset:55296
v_mfma_f32_16x16x32_bf16 v[100:103], v[196:199], a[16:19], 0
s_nop 0
ds_read_b64_tr_b16 v[148:149], v9 offset:53248
ds_read_b64_tr_b16 v[150:151], v9 offset:55296
v_mfma_f32_16x16x32_bf16 v[100:103], v[212:215], a[20:23], v[100:103]
s_nop 0
ds_read_b64_tr_b16 v[152:153], v10 offset:53248
ds_read_b64_tr_b16 v[154:155], v10 offset:55296
v_mfma_f32_16x16x32_bf16 v[100:103], v[228:231], a[24:27], v[100:103]
s_nop 0
ds_read_b64_tr_b16 v[156:157], v11 offset:53248
ds_read_b64_tr_b16 v[158:159], v11 offset:55296
v_mfma_f32_16x16x32_bf16 v[100:103], v[244:247], a[28:31], v[100:103]
s_add_u32 s72, s71, 46080
buffer_load_dwordx4 v15, s[24:27], s72 offen offset:3072 lds
v_mfma_f32_16x16x32_bf16 v[84:87], v[244:247], a[12:15], 0
buffer_load_dwordx4 a[92:95], v1, s[44:47], s69 offen offset:3072 sc1
v_mfma_f32_16x16x32_bf16 v[84:87], v[228:231], a[8:11], v[84:87]
v_mfma_f32_16x16x32_bf16 v[84:87], v[212:215], a[4:7], v[84:87]
s_nop 0
ds_read_b64_tr_b16 v[160:161], v8 offset:57344
ds_read_b64_tr_b16 v[162:163], v8 offset:59392
v_mfma_f32_16x16x32_bf16 v[84:87], v[196:199], a[0:3], v[84:87]
s_nop 0
ds_read_b64_tr_b16 v[164:165], v9 offset:57344
ds_read_b64_tr_b16 v[166:167], v9 offset:59392
v_mfma_f32_16x16x32_bf16 v[88:91], v[200:203], a[0:3], 0
s_nop 0
ds_read_b64_tr_b16 v[168:169], v10 offset:57344
ds_read_b64_tr_b16 v[170:171], v10 offset:59392
v_mfma_f32_16x16x32_bf16 v[88:91], v[216:219], a[4:7], v[88:91]
s_xor_b32 s82, s78, 4
ds_read_b64_tr_b16 v[172:173], v11 offset:57344
ds_read_b64_tr_b16 v[174:175], v11 offset:59392
v_mfma_f32_16x16x32_bf16 v[88:91], v[232:235], a[8:11], v[88:91]
s_lshl_b32 s82, s82, 10
v_mfma_f32_16x16x32_bf16 v[88:91], v[248:251], a[12:15], v[88:91]
s_xor_b32 s71, s14, 0x100
ds_read_b64_tr_b16 v[176:177], v8 offset:61440
ds_read_b64_tr_b16 v[178:179], v8 offset:63488
v_mfma_f32_16x16x32_bf16 v[104:107], v[248:251], a[28:31], 0
s_add_u32 m0, s85, 49152
ds_read_b64_tr_b16 v[180:181], v9 offset:61440
ds_read_b64_tr_b16 v[182:183], v9 offset:63488
v_mfma_f32_16x16x32_bf16 v[104:107], v[232:235], a[24:27], v[104:107]
s_add_u32 s72, s71, 0
buffer_load_dwordx4 v15, s[24:27], s72 offen lds
v_mfma_f32_16x16x32_bf16 v[104:107], v[216:219], a[20:23], v[104:107]
s_add_u32 s82, s82, s74
buffer_load_dword v3, v2, s[44:47], s82 offen sc1
v_mfma_f32_16x16x32_bf16 v[104:107], v[200:203], a[16:19], v[104:107]
s_nop 0
ds_read_b64_tr_b16 v[184:185], v10 offset:61440
ds_read_b64_tr_b16 v[186:187], v10 offset:63488
v_mfma_f32_16x16x32_bf16 v[108:111], v[204:207], a[16:19], 0
s_nop 0
ds_read_b64_tr_b16 v[188:189], v11 offset:61440
ds_read_b64_tr_b16 v[190:191], v11 offset:63488
v_mfma_f32_16x16x32_bf16 v[108:111], v[220:223], a[20:23], v[108:111]
v_mfma_f32_16x16x32_bf16 v[108:111], v[236:239], a[24:27], v[108:111]
s_add_u32 s72, s71, 15360
buffer_load_dwordx4 v15, s[24:27], s72 offen offset:1024 lds
v_mfma_f32_16x16x32_bf16 v[108:111], v[252:255], a[28:31], v[108:111]
s_lshr_b32 s69, s15, 18
v_mfma_f32_16x16x32_bf16 v[92:95], v[252:255], a[12:15], 0
s_lshl_b32 s69, s69, 12
v_xor_b32 v8, 0x10000, v8
Lstube0:
s_cbranch_execz Lstube4
v_mfma_f32_16x16x32_bf16 v[92:95], v[236:239], a[8:11], v[92:95]
s_add_u32 s69, s69, s95
v_xor_b32 v9, 0x10000, v9
v_mfma_f32_16x16x32_bf16 v[92:95], v[220:223], a[4:7], v[92:95]
s_waitcnt vmcnt(17) lgkmcnt(0)
v_xor_b32 v10, 0x10000, v10
v_mfma_f32_16x16x32_bf16 v[92:95], v[204:207], a[0:3], v[92:95]
s_barrier
buffer_load_dwordx4 a[96:99], v1, s[44:47], s69 offen sc1
v_xor_b32 v11, 0x10000, v11
v_mfma_f32_16x16x32_bf16 v[16:19], v[128:131], a[32:35], v[16:19]
s_add_u32 s72, s71, 30720
buffer_load_dwordx4 v15, s[24:27], s72 offen offset:2048 lds
v_mfma_f32_16x16x32_bf16 v[16:19], v[144:147], a[36:39], v[16:19]
s_nop 0
ds_read_b64_tr_b16 v[192:193], v8 offset:0
ds_read_b64_tr_b16 v[194:195], v8 offset:2048
v_mfma_f32_16x16x32_bf16 v[16:19], v[160:163], a[40:43], v[16:19]
s_nop 0
ds_read_b64_tr_b16 v[196:197], v9 offset:0
ds_read_b64_tr_b16 v[198:199], v9 offset:2048
v_mfma_f32_16x16x32_bf16 v[16:19], v[176:179], a[44:47], v[16:19]
s_nop 0
ds_read_b64_tr_b16 v[200:201], v10 offset:0
ds_read_b64_tr_b16 v[202:203], v10 offset:2048
v_mfma_f32_16x16x32_bf16 v[32:35], v[176:179], a[60:63], v[32:35]
s_nop 0
ds_read_b64_tr_b16 v[204:205], v11 offset:0
ds_read_b64_tr_b16 v[206:207], v11 offset:2048
v_mfma_f32_16x16x32_bf16 v[32:35], v[160:163], a[56:59], v[32:35]
v_or_b32 v112, s58, v0
v_mov_b32 v113, 3
v_mfma_f32_16x16x32_bf16 v[32:35], v[144:147], a[52:55], v[32:35]
s_add_u32 s72, s71, 46080
buffer_load_dwordx4 v15, s[24:27], s72 offen offset:3072 lds
v_mfma_f32_16x16x32_bf16 v[32:35], v[128:131], a[48:51], v[32:35]
s_nop 0
ds_read_b64_tr_b16 v[208:209], v8 offset:4096
ds_read_b64_tr_b16 v[210:211], v8 offset:6144
v_mfma_f32_16x16x32_bf16 v[36:39], v[132:135], a[48:51], v[36:39]
s_nop 0
ds_read_b64_tr_b16 v[212:213], v9 offset:4096
ds_read_b64_tr_b16 v[214:215], v9 offset:6144
v_mfma_f32_16x16x32_bf16 v[36:39], v[148:151], a[52:55], v[36:39]
buffer_load_dwordx4 a[100:103], v1, s[44:47], s69 offen offset:1024 sc1
v_mfma_f32_16x16x32_bf16 v[36:39], v[164:167], a[56:59], v[36:39]
s_nop 0
ds_read_b64_tr_b16 v[216:217], v10 offset:4096
ds_read_b64_tr_b16 v[218:219], v10 offset:6144
v_mfma_f32_16x16x32_bf16 v[36:39], v[180:183], a[60:63], v[36:39]
v_min_u32 v112, 1, v112
v_lshlrev_b32 v112, 30, v112
v_mfma_f32_16x16x32_bf16 v[20:23], v[180:183], a[44:47], v[20:23]
s_nop 0
ds_read_b64_tr_b16 v[220:221], v11 offset:4096
ds_read_b64_tr_b16 v[222:223], v11 offset:6144
v_mfma_f32_16x16x32_bf16 v[20:23], v[164:167], a[40:43], v[20:23]
s_nop 0
ds_read_b64_tr_b16 v[224:225], v8 offset:8192
ds_read_b64_tr_b16 v[226:227], v8 offset:10240
v_mfma_f32_16x16x32_bf16 v[20:23], v[148:151], a[36:39], v[20:23]
s_xor_b32 s71, s14, 0x180
ds_read_b64_tr_b16 v[228:229], v9 offset:8192
ds_read_b64_tr_b16 v[230:231], v9 offset:10240
v_mfma_f32_16x16x32_bf16 v[20:23], v[132:135], a[32:35], v[20:23]
s_add_u32 m0, s77, 0
buffer_store_dword v113, v112, s[44:47], s91 offen sc1
v_mfma_f32_16x16x32_bf16 v[24:27], v[136:139], a[32:35], v[24:27]
s_add_u32 s72, s71, 0
buffer_load_dwordx4 v15, s[24:27], s72 offen lds
v_mfma_f32_16x16x32_bf16 v[24:27], v[152:155], a[36:39], v[24:27]
s_nop 0
ds_read_b64_tr_b16 v[232:233], v10 offset:8192
ds_read_b64_tr_b16 v[234:235], v10 offset:10240
v_mfma_f32_16x16x32_bf16 v[24:27], v[168:171], a[40:43], v[24:27]
s_nop 0
ds_read_b64_tr_b16 v[236:237], v11 offset:8192
ds_read_b64_tr_b16 v[238:239], v11 offset:10240
v_mfma_f32_16x16x32_bf16 v[24:27], v[184:187], a[44:47], v[24:27]
buffer_load_dwordx4 a[104:107], v1, s[44:47], s69 offen offset:2048 sc1
v_mfma_f32_16x16x32_bf16 v[40:43], v[184:187], a[60:63], v[40:43]
s_nop 0
ds_read_b64_tr_b16 v[240:241], v8 offset:12288
ds_read_b64_tr_b16 v[242:243], v8 offset:14336
v_mfma_f32_16x16x32_bf16 v[40:43], v[168:171], a[56:59], v[40:43]
v_mfma_f32_16x16x32_bf16 v[40:43], v[152:155], a[52:55], v[40:43]
s_add_u32 s72, s71, 15360
buffer_load_dwordx4 v15, s[24:27], s72 offen offset:1024 lds
v_mfma_f32_16x16x32_bf16 v[40:43], v[136:139], a[48:51], v[40:43]
s_nop 0
ds_read_b64_tr_b16 v[244:245], v9 offset:12288
ds_read_b64_tr_b16 v[246:247], v9 offset:14336
v_mfma_f32_16x16x32_bf16 v[44:47], v[140:143], a[48:51], v[44:47]
s_nop 0
ds_read_b64_tr_b16 v[248:249], v10 offset:12288
ds_read_b64_tr_b16 v[250:251], v10 offset:14336
v_mfma_f32_16x16x32_bf16 v[44:47], v[156:159], a[52:55], v[44:47]
s_nop 0
ds_read_b64_tr_b16 v[252:253], v11 offset:12288
ds_read_b64_tr_b16 v[254:255], v11 offset:14336
v_mfma_f32_16x16x32_bf16 v[44:47], v[172:175], a[56:59], v[44:47]
v_mfma_f32_16x16x32_bf16 v[44:47], v[188:191], a[60:63], v[44:47]
v_mfma_f32_16x16x32_bf16 v[28:31], v[188:191], a[44:47], v[28:31]
s_add_u32 s72, s71, 30720
buffer_load_dwordx4 v15, s[24:27], s72 offen offset:2048 lds
v_mfma_f32_16x16x32_bf16 v[28:31], v[172:175], a[40:43], v[28:31]
buffer_load_dwordx4 a[108:111], v1, s[44:47], s69 offen offset:3072 sc1
v_mfma_f32_16x16x32_bf16 v[28:31], v[156:159], a[36:39], v[28:31]
s_waitcnt vmcnt(20) lgkmcnt(0)
v_mfma_f32_16x16x32_bf16 v[28:31], v[140:143], a[32:35], v[28:31]
s_barrier
v_mfma_f32_16x16x32_bf16 v[48:51], v[192:195], a[32:35], v[48:51]
s_nop 0
ds_read_b64_tr_b16 v[128:129], v8 offset:16384
ds_read_b64_tr_b16 v[130:131], v8 offset:18432
v_mfma_f32_16x16x32_bf16 v[48:51], v[208:211], a[36:39], v[48:51]
s_nop 0
ds_read_b64_tr_b16 v[132:133], v9 offset:16384
ds_read_b64_tr_b16 v[134:135], v9 offset:18432
v_mfma_f32_16x16x32_bf16 v[48:51], v[224:227], a[40:43], v[48:51]
s_add_u32 s72, s71, 46080
buffer_load_dwordx4 v15, s[24:27], s72 offen offset:3072 lds
v_mfma_f32_16x16x32_bf16 v[48:51], v[240:243], a[44:47], v[48:51]
s_nop 0
ds_read_b64_tr_b16 v[136:137], v10 offset:16384
ds_read_b64_tr_b16 v[138:139], v10 offset:18432
v_mfma_f32_16x16x32_bf16 v[64:67], v[240:243], a[60:63], v[64:67]
s_nop 0
ds_read_b64_tr_b16 v[140:141], v11 offset:16384
ds_read_b64_tr_b16 v[142:143], v11 offset:18432
v_mfma_f32_16x16x32_bf16 v[64:67], v[224:227], a[56:59], v[64:67]
v_and_b32 v120, 15, v0
v_lshrrev_b32 v121, 4, v0
v_mfma_f32_16x16x32_bf16 v[64:67], v[208:211], a[52:55], v[64:67]
s_nop 0
ds_read_b64_tr_b16 v[144:145], v8 offset:20480
ds_read_b64_tr_b16 v[146:147], v8 offset:22528
v_mfma_f32_16x16x32_bf16 v[64:67], v[192:195], a[48:51], v[64:67]
s_add_u32 s69, s69, 0x20000
buffer_load_dwordx4 a[112:115], v1, s[44:47], s69 offen sc1
v_mfma_f32_16x16x32_bf16 v[68:71], v[196:199], a[48:51], v[68:71]
s_nop 0
ds_read_b64_tr_b16 v[148:149], v9 offset:20480
ds_read_b64_tr_b16 v[150:151], v9 offset:22528
v_mfma_f32_16x16x32_bf16 v[68:71], v[212:215], a[52:55], v[68:71]
s_nop 0
ds_read_b64_tr_b16 v[152:153], v10 offset:20480
ds_read_b64_tr_b16 v[154:155], v10 offset:22528
v_mfma_f32_16x16x32_bf16 v[68:71], v[228:231], a[56:59], v[68:71]
s_xor_b32 s71, s15, 0x80
v_lshlrev_b32 v121, 2, v121
v_sub_u32 v120, v120, v121
v_mfma_f32_16x16x32_bf16 v[68:71], v[244:247], a[60:63], v[68:71]
s_add_u32 m0, s77, 16384
ds_read_b64_tr_b16 v[156:157], v11 offset:20480
ds_read_b64_tr_b16 v[158:159], v11 offset:22528
v_mfma_f32_16x16x32_bf16 v[52:55], v[244:247], a[44:47], v[52:55]
s_add_u32 s72, s71, 0
buffer_load_dwordx4 v15, s[24:27], s72 offen lds
v_mfma_f32_16x16x32_bf16 v[52:55], v[228:231], a[40:43], v[52:55]
s_nop 0
ds_read_b64_tr_b16 v[160:161], v8 offset:24576
ds_read_b64_tr_b16 v[162:163], v8 offset:26624
v_mfma_f32_16x16x32_bf16 v[52:55], v[212:215], a[36:39], v[52:55]
s_nop 0
ds_read_b64_tr_b16 v[164:165], v9 offset:24576
ds_read_b64_tr_b16 v[166:167], v9 offset:26624
v_mfma_f32_16x16x32_bf16 v[52:55], v[196:199], a[32:35], v[52:55]
v_min_u32 v120, 4, v120
v_lshlrev_b32 v120, 3, v120
v_mfma_f32_16x16x32_bf16 v[56:59], v[200:203], a[32:35], v[56:59]
s_nop 0
ds_read_b64_tr_b16 v[168:169], v10 offset:24576
ds_read_b64_tr_b16 v[170:171], v10 offset:26624
v_mfma_f32_16x16x32_bf16 v[56:59], v[216:219], a[36:39], v[56:59]
s_add_u32 s72, s71, 15360
buffer_load_dwordx4 v15, s[24:27], s72 offen offset:1024 lds
v_mfma_f32_16x16x32_bf16 v[56:59], v[232:235], a[40:43], v[56:59]
buffer_load_dwordx4 a[116:119], v1, s[44:47], s69 offen offset:1024 sc1
v_mfma_f32_16x16x32_bf16 v[56:59], v[248:251], a[44:47], v[56:59]
s_nop 0
ds_read_b64_tr_b16 v[172:173], v11 offset:24576
ds_read_b64_tr_b16 v[174:175], v11 offset:26624
v_mfma_f32_16x16x32_bf16 v[72:75], v[248:251], a[60:63], v[72:75]
s_nop 0
ds_read_b64_tr_b16 v[176:177], v8 offset:28672
ds_read_b64_tr_b16 v[178:179], v8 offset:30720
v_mfma_f32_16x16x32_bf16 v[72:75], v[232:235], a[56:59], v[72:75]
v_mov_b32 v122, 0x3f80
v_mov_b32 v123, 0
v_mfma_f32_16x16x32_bf16 v[72:75], v[216:219], a[52:55], v[72:75]
s_nop 0
ds_read_b64_tr_b16 v[180:181], v9 offset:28672
ds_read_b64_tr_b16 v[182:183], v9 offset:30720
v_mfma_f32_16x16x32_bf16 v[72:75], v[200:203], a[48:51], v[72:75]
s_add_u32 s72, s71, 30720
buffer_load_dwordx4 v15, s[24:27], s72 offen offset:2048 lds
v_mfma_f32_16x16x32_bf16 v[76:79], v[204:207], a[48:51], v[76:79]
s_nop 0
ds_read_b64_tr_b16 v[184:185], v10 offset:28672
ds_read_b64_tr_b16 v[186:187], v10 offset:30720
v_mfma_f32_16x16x32_bf16 v[76:79], v[220:223], a[52:55], v[76:79]
s_nop 0
ds_read_b64_tr_b16 v[188:189], v11 offset:28672
ds_read_b64_tr_b16 v[190:191], v11 offset:30720
v_mfma_f32_16x16x32_bf16 v[76:79], v[236:239], a[56:59], v[76:79]
v_lshlrev_b64 v[122:123], v120, v[122:123]
v_mov_b32 v126, 0
v_mfma_f32_16x16x32_bf16 v[76:79], v[252:255], a[60:63], v[76:79]
buffer_load_dwordx4 a[120:123], v1, s[44:47], s69 offen offset:2048 sc1
v_mfma_f32_16x16x32_bf16 v[60:63], v[252:255], a[44:47], v[60:63]
v_lshlrev_b64 v[122:123], v120, v[122:123]
v_mov_b32 v127, 0
v_mfma_f32_16x16x32_bf16 v[60:63], v[236:239], a[40:43], v[60:63]
s_add_u32 s72, s71, 46080
buffer_load_dwordx4 v15, s[24:27], s72 offen offset:3072 lds
v_mfma_f32_16x16x32_bf16 v[60:63], v[220:223], a[36:39], v[60:63]
s_waitcnt vmcnt(22) lgkmcnt(0)
v_mov_b32 v120, 0
v_mov_b32 v121, 0
v_mfma_f32_16x16x32_bf16 v[60:63], v[204:207], a[32:35], v[60:63]
s_barrier
v_mov_b32 v124, v122
v_mov_b32 v125, v123
v_mfma_f32_16x16x32_bf16 v[80:83], v[128:131], a[32:35], v[80:83]
s_nop 0
ds_read_b64_tr_b16 v[192:193], v8 offset:32768
ds_read_b64_tr_b16 v[194:195], v8 offset:34816
v_mfma_f32_16x16x32_bf16 v[80:83], v[144:147], a[36:39], v[80:83]
s_nop 0
ds_read_b64_tr_b16 v[196:197], v9 offset:32768
ds_read_b64_tr_b16 v[198:199], v9 offset:34816
v_mfma_f32_16x16x32_bf16 v[80:83], v[160:163], a[40:43], v[80:83]
s_nop 0
ds_read_b64_tr_b16 v[200:201], v10 offset:32768
ds_read_b64_tr_b16 v[202:203], v10 offset:34816
v_mfma_f32_16x16x32_bf16 v[80:83], v[176:179], a[44:47], v[80:83]
s_nop 0
ds_read_b64_tr_b16 v[204:205], v11 offset:32768
ds_read_b64_tr_b16 v[206:207], v11 offset:34816
v_mfma_f32_16x16x32_bf16 v[96:99], v[176:179], a[60:63], v[96:99]
v_mfma_f32_16x16x32_bf16 v[96:99], v[160:163], a[56:59], v[96:99]
s_xor_b32 s71, s15, 0x100
buffer_load_dwordx4 a[124:127], v1, s[44:47], s69 offen offset:3072 sc1
v_mfma_f32_16x16x32_bf16 v[96:99], v[144:147], a[52:55], v[96:99]
s_add_u32 m0, s77, 32768
ds_read_b64_tr_b16 v[208:209], v8 offset:36864
ds_read_b64_tr_b16 v[210:211], v8 offset:38912
v_mfma_f32_16x16x32_bf16 v[96:99], v[128:131], a[48:51], v[96:99]
s_add_u32 s72, s71, 0
buffer_load_dwordx4 v15, s[24:27], s72 offen lds
v_mfma_f32_16x16x32_bf16 v[100:103], v[132:135], a[48:51], v[100:103]
s_nop 0
ds_read_b64_tr_b16 v[212:213], v9 offset:36864
ds_read_b64_tr_b16 v[214:215], v9 offset:38912
v_mfma_f32_16x16x32_bf16 v[100:103], v[148:151], a[52:55], v[100:103]
s_nop 0
ds_read_b64_tr_b16 v[216:217], v10 offset:36864
ds_read_b64_tr_b16 v[218:219], v10 offset:38912
v_mfma_f32_16x16x32_bf16 v[100:103], v[164:167], a[56:59], v[100:103]
s_nop 0
ds_read_b64_tr_b16 v[220:221], v11 offset:36864
ds_read_b64_tr_b16 v[222:223], v11 offset:38912
v_mfma_f32_16x16x32_bf16 v[100:103], v[180:183], a[60:63], v[100:103]
v_mfma_f32_16x16x32_bf16 v[84:87], v[180:183], a[44:47], v[84:87]
s_nop 0
ds_read_b64_tr_b16 v[224:225], v8 offset:40960
ds_read_b64_tr_b16 v[226:227], v8 offset:43008
v_mfma_f32_16x16x32_bf16 v[84:87], v[164:167], a[40:43], v[84:87]
s_add_u32 s72, s71, 15360
buffer_load_dwordx4 v15, s[24:27], s72 offen offset:1024 lds
v_mfma_f32_16x16x32_bf16 v[84:87], v[148:151], a[36:39], v[84:87]
s_nop 0
ds_read_b64_tr_b16 v[228:229], v9 offset:40960
ds_read_b64_tr_b16 v[230:231], v9 offset:43008
v_mfma_f32_16x16x32_bf16 v[84:87], v[132:135], a[32:35], v[84:87]
s_waitcnt vmcnt(22)
v_cmp_gt_u32 vcc, 2, v3
s_cbranch_vccnz Lspin106
Lback107:
s_lshr_b32 s69, s12, 18
s_lshl_b32 s69, s69, 12
s_add_u32 s69, s69, s95
s_xor_b32 s69, s69, 0x1000
buffer_load_dwordx4 a[128:131], v1, s[44:47], s69 offen sc1
v_mfma_f32_16x16x32_bf16 v[88:91], v[136:139], a[32:35], v[88:91]
s_nop 0
ds_read_b64_tr_b16 v[232:233], v10 offset:40960
ds_read_b64_tr_b16 v[234:235], v10 offset:43008
v_mfma_f32_16x16x32_bf16 v[88:91], v[152:155], a[36:39], v[88:91]
s_nop 0
ds_read_b64_tr_b16 v[236:237], v11 offset:40960
ds_read_b64_tr_b16 v[238:239], v11 offset:43008
v_mfma_f32_16x16x32_bf16 v[88:91], v[168:171], a[40:43], v[88:91]
v_mfma_f32_16x16x32_bf16 v[88:91], v[184:187], a[44:47], v[88:91]
s_add_u32 s72, s71, 30720
buffer_load_dwordx4 v15, s[24:27], s72 offen offset:2048 lds
v_mfma_f32_16x16x32_bf16 v[104:107], v[184:187], a[60:63], v[104:107]
s_nop 0
ds_read_b64_tr_b16 v[240:241], v8 offset:45056
ds_read_b64_tr_b16 v[242:243], v8 offset:47104
v_mfma_f32_16x16x32_bf16 v[104:107], v[168:171], a[56:59], v[104:107]
s_nop 0
ds_read_b64_tr_b16 v[244:245], v9 offset:45056
ds_read_b64_tr_b16 v[246:247], v9 offset:47104
v_mfma_f32_16x16x32_bf16 v[104:107], v[152:155], a[52:55], v[104:107]
s_nop 0
ds_read_b64_tr_b16 v[248:249], v10 offset:45056
ds_read_b64_tr_b16 v[250:251], v10 offset:47104
v_mfma_f32_16x16x32_bf16 v[104:107], v[136:139], a[48:51], v[104:107]
s_nop 0
ds_read_b64_tr_b16 v[252:253], v11 offset:45056
ds_read_b64_tr_b16 v[254:255], v11 offset:47104
v_mfma_f32_16x16x32_bf16 v[108:111], v[140:143], a[48:51], v[108:111]
v_mfma_f32_16x16x32_bf16 v[108:111], v[156:159], a[52:55], v[108:111]
s_add_u32 s72, s71, 46080
buffer_load_dwordx4 v15, s[24:27], s72 offen offset:3072 lds
v_mfma_f32_16x16x32_bf16 v[108:111], v[172:175], a[56:59], v[108:111]
buffer_load_dwordx4 a[132:135], v1, s[44:47], s69 offen offset:1024 sc1
v_mfma_f32_16x16x32_bf16 v[108:111], v[188:191], a[60:63], v[108:111]
v_mfma_f32_16x16x32_bf16 v[92:95], v[188:191], a[44:47], v[92:95]
v_mfma_f32_16x16x32_bf16 v[92:95], v[172:175], a[40:43], v[92:95]
v_mfma_f32_16x16x32_bf16 v[92:95], v[156:159], a[36:39], v[92:95]
s_waitcnt vmcnt(22) lgkmcnt(0)
v_mfma_f32_16x16x32_bf16 v[92:95], v[140:143], a[32:35], v[92:95]
s_barrier
v_mfma_f32_16x16x32_bf16 v[16:19], v[192:195], a[64:67], v[16:19]
s_nop 0
ds_read_b64_tr_b16 v[128:129], v8 offset:49152
ds_read_b64_tr_b16 v[130:131], v8 offset:51200
v_mfma_f32_16x16x32_bf16 v[16:19], v[208:211], a[68:71], v[16:19]
s_xor_b32 s71, s15, 0x180
ds_read_b64_tr_b16 v[132:133], v9 offset:49152
ds_read_b64_tr_b16 v[134:135], v9 offset:51200
v_mfma_f32_16x16x32_bf16 v[16:19], v[224:227], a[72:75], v[16:19]
s_add_u32 m0, s77, 49152
ds_read_b64_tr_b16 v[136:137], v10 offset:49152
ds_read_b64_tr_b16 v[138:139], v10 offset:51200
v_mfma_f32_16x16x32_bf16 v[16:19], v[240:243], a[76:79], v[16:19]
s_add_u32 s72, s71, 0
buffer_load_dwordx4 v15, s[24:27], s72 offen lds
v_mfma_f32_16x16x32_bf16 v[32:35], v[240:243], a[92:95], v[32:35]
buffer_load_dwordx4 a[136:139], v1, s[44:47], s69 offen offset:2048 sc1
v_mfma_f32_16x16x32_bf16 v[32:35], v[224:227], a[88:91], v[32:35]
s_nop 0
ds_read_b64_tr_b16 v[140:141], v11 offset:49152
ds_read_b64_tr_b16 v[142:143], v11 offset:51200
v_mfma_f32_16x16x32_bf16 v[32:35], v[208:211], a[84:87], v[32:35]
v_mfma_f32_16x16x32_bf16 v[32:35], v[192:195], a[80:83], v[32:35]
s_nop 0
ds_read_b64_tr_b16 v[144:145], v8 offset:53248
ds_read_b64_tr_b16 v[146:147], v8 offset:55296
v_mfma_f32_16x16x32_bf16 v[36:39], v[196:199], a[80:83], v[36:39]
s_add_u32 s72, s71, 15360
buffer_load_dwordx4 v15, s[24:27], s72 offen offset:1024 lds
v_mfma_f32_16x16x32_bf16 v[36:39], v[212:215], a[84:87], v[36:39]
s_nop 0
ds_read_b64_tr_b16 v[148:149], v9 offset:53248
ds_read_b64_tr_b16 v[150:151], v9 offset:55296
v_mfma_f32_16x16x32_bf16 v[36:39], v[228:231], a[88:91], v[36:39]
s_nop 0
ds_read_b64_tr_b16 v[152:153], v10 offset:53248
ds_read_b64_tr_b16 v[154:155], v10 offset:55296
v_mfma_f32_16x16x32_bf16 v[36:39], v[244:247], a[92:95], v[36:39]
s_nop 0
ds_read_b64_tr_b16 v[156:157], v11 offset:53248
ds_read_b64_tr_b16 v[158:159], v11 offset:55296
v_mfma_f32_16x16x32_bf16 v[20:23], v[244:247], a[76:79], v[20:23]
v_mfma_f32_16x16x32_bf16 v[20:23], v[228:231], a[72:75], v[20:23]
buffer_load_dwordx4 a[140:143], v1, s[44:47], s69 offen offset:3072 sc1
v_mfma_f32_16x16x32_bf16 v[20:23], v[212:215], a[68:71], v[20:23]
s_add_u32 s72, s71, 30720
buffer_load_dwordx4 v15, s[24:27], s72 offen offset:2048 lds
v_mfma_f32_16x16x32_bf16 v[20:23], v[196:199], a[64:67], v[20:23]
s_nop 0
ds_read_b64_tr_b16 v[160:161], v8 offset:57344
ds_read_b64_tr_b16 v[162:163], v8 offset:59392
v_mfma_f32_16x16x32_bf16 v[24:27], v[200:203], a[64:67], v[24:27]
s_nop 0
ds_read_b64_tr_b16 v[164:165], v9 offset:57344
ds_read_b64_tr_b16 v[166:167], v9 offset:59392
v_mfma_f32_16x16x32_bf16 v[24:27], v[216:219], a[68:71], v[24:27]
s_nop 0
ds_read_b64_tr_b16 v[168:169], v10 offset:57344
ds_read_b64_tr_b16 v[170:171], v10 offset:59392
v_mfma_f32_16x16x32_bf16 v[24:27], v[232:235], a[72:75], v[24:27]
s_nop 0
ds_read_b64_tr_b16 v[172:173], v11 offset:57344
ds_read_b64_tr_b16 v[174:175], v11 offset:59392
v_mfma_f32_16x16x32_bf16 v[24:27], v[248:251], a[76:79], v[24:27]
v_mfma_f32_16x16x32_bf16 v[40:43], v[248:251], a[92:95], v[40:43]
s_add_u32 s72, s71, 46080
buffer_load_dwordx4 v15, s[24:27], s72 offen offset:3072 lds
v_mfma_f32_16x16x32_bf16 v[40:43], v[232:235], a[88:91], v[40:43]
s_nop 0
ds_read_b64_tr_b16 v[176:177], v8 offset:61440
ds_read_b64_tr_b16 v[178:179], v8 offset:63488
v_mfma_f32_16x16x32_bf16 v[40:43], v[216:219], a[84:87], v[40:43]
s_nop 0
ds_read_b64_tr_b16 v[180:181], v9 offset:61440
ds_read_b64_tr_b16 v[182:183], v9 offset:63488
v_mfma_f32_16x16x32_bf16 v[40:43], v[200:203], a[80:83], v[40:43]
s_add_u32 s69, s69, 0x20000
buffer_load_dwordx4 a[144:147], v1, s[44:47], s69 offen sc1
v_mfma_f32_16x16x32_bf16 v[44:47], v[204:207], a[80:83], v[44:47]
s_nop 0
ds_read_b64_tr_b16 v[184:185], v10 offset:61440
ds_read_b64_tr_b16 v[186:187], v10 offset:63488
v_mfma_f32_16x16x32_bf16 v[44:47], v[220:223], a[84:87], v[44:47]
s_nop 0
ds_read_b64_tr_b16 v[188:189], v11 offset:61440
ds_read_b64_tr_b16 v[190:191], v11 offset:63488
v_mfma_f32_16x16x32_bf16 v[44:47], v[236:239], a[88:91], v[44:47]
v_mfma_f32_16x16x32_bf16 v[44:47], v[252:255], a[92:95], v[44:47]
s_xor_b32 s71, s12, 0x40080
v_mfma_f32_16x16x32_bf16 v[28:31], v[252:255], a[76:79], v[28:31]
s_add_u32 m0, s85, 0
v_xor_b32 v8, 0x10000, v8
v_mfma_f32_16x16x32_bf16 v[28:31], v[236:239], a[72:75], v[28:31]
s_add_u32 s72, s71, 0
v_xor_b32 v9, 0x10000, v9
v_mfma_f32_16x16x32_bf16 v[28:31], v[220:223], a[68:71], v[28:31]
s_waitcnt vmcnt(21) lgkmcnt(0)
buffer_load_dwordx4 v15, s[24:27], s72 offen lds
v_xor_b32 v10, 0x10000, v10
v_mfma_f32_16x16x32_bf16 v[28:31], v[204:207], a[64:67], v[28:31]
s_barrier
v_xor_b32 v11, 0x10000, v11
v_mfma_f32_16x16x32_bf16 v[48:51], v[128:131], a[64:67], v[48:51]
s_nop 0
ds_read_b64_tr_b16 v[192:193], v8 offset:0
ds_read_b64_tr_b16 v[194:195], v8 offset:2048
v_mfma_f32_16x16x32_bf16 v[48:51], v[144:147], a[68:71], v[48:51]
buffer_load_dwordx4 a[148:151], v1, s[44:47], s69 offen offset:1024 sc1
v_mfma_f32_16x16x32_bf16 v[48:51], v[160:163], a[72:75], v[48:51]
s_nop 0
ds_read_b64_tr_b16 v[196:197], v9 offset:0
ds_read_b64_tr_b16 v[198:199], v9 offset:2048
v_mfma_f32_16x16x32_bf16 v[48:51], v[176:179], a[76:79], v[48:51]
s_add_u32 s72, s71, 15360
buffer_load_dwordx4 v15, s[24:27], s72 offen offset:1024 lds
v_mfma_f32_16x16x32_bf16 v[64:67], v[176:179], a[92:95], v[64:67]
s_nop 0
ds_read_b64_tr_b16 v[200:201], v10 offset:0
ds_read_b64_tr_b16 v[202:203], v10 offset:2048
v_mfma_f32_16x16x32_bf16 v[64:67], v[160:163], a[88:91], v[64:67]
s_nop 0
ds_read_b64_tr_b16 v[204:205], v11 offset:0
ds_read_b64_tr_b16 v[206:207], v11 offset:2048
v_mfma_f32_16x16x32_bf16 v[64:67], v[144:147], a[84:87], v[64:67]
v_mfma_f32_16x16x32_bf16 v[64:67], v[128:131], a[80:83], v[64:67]
s_nop 0
ds_read_b64_tr_b16 v[208:209], v8 offset:4096
ds_read_b64_tr_b16 v[210:211], v8 offset:6144
v_mfma_f32_16x16x32_bf16 v[68:71], v[132:135], a[80:83], v[68:71]
s_nop 0
ds_read_b64_tr_b16 v[212:213], v9 offset:4096
ds_read_b64_tr_b16 v[214:215], v9 offset:6144
v_mfma_f32_16x16x32_bf16 v[68:71], v[148:151], a[84:87], v[68:71]
s_add_u32 s72, s71, 30720
buffer_load_dwordx4 v15, s[24:27], s72 offen offset:2048 lds
v_mfma_f32_16x16x32_bf16 v[68:71], v[164:167], a[88:91], v[68:71]
s_nop 0
ds_read_b64_tr_b16 v[216:217], v10 offset:4096
ds_read_b64_tr_b16 v[218:219], v10 offset:6144
v_mfma_f32_16x16x32_bf16 v[68:71], v[180:183], a[92:95], v[68:71]
buffer_load_dwordx4 a[152:155], v1, s[44:47], s69 offen offset:2048 sc1
v_mfma_f32_16x16x32_bf16 v[52:55], v[180:183], a[76:79], v[52:55]
s_nop 0
ds_read_b64_tr_b16 v[220:221], v11 offset:4096
ds_read_b64_tr_b16 v[222:223], v11 offset:6144
v_mfma_f32_16x16x32_bf16 v[52:55], v[164:167], a[72:75], v[52:55]
v_mfma_f32_16x16x32_bf16 v[52:55], v[148:151], a[68:71], v[52:55]
s_nop 0
ds_read_b64_tr_b16 v[224:225], v8 offset:8192
ds_read_b64_tr_b16 v[226:227], v8 offset:10240
v_mfma_f32_16x16x32_bf16 v[52:55], v[132:135], a[64:67], v[52:55]
s_add_u32 s72, s71, 46080
buffer_load_dwordx4 v15, s[24:27], s72 offen offset:3072 lds
v_mfma_f32_16x16x32_bf16 v[56:59], v[136:139], a[64:67], v[56:59]
s_nop 0
ds_read_b64_tr_b16 v[228:229], v9 offset:8192
ds_read_b64_tr_b16 v[230:231], v9 offset:10240
v_mfma_f32_16x16x32_bf16 v[56:59], v[152:155], a[68:71], v[56:59]
s_nop 0
ds_read_b64_tr_b16 v[232:233], v10 offset:8192
ds_read_b64_tr_b16 v[234:235], v10 offset:10240
v_mfma_f32_16x16x32_bf16 v[56:59], v[168:171], a[72:75], v[56:59]
s_nop 0
ds_read_b64_tr_b16 v[236:237], v11 offset:8192
ds_read_b64_tr_b16 v[238:239], v11 offset:10240
v_mfma_f32_16x16x32_bf16 v[56:59], v[184:187], a[76:79], v[56:59]
v_mfma_f32_16x16x32_bf16 v[72:75], v[184:187], a[92:95], v[72:75]
s_nop 0
ds_read_b64_tr_b16 v[240:241], v8 offset:12288
ds_read_b64_tr_b16 v[242:243], v8 offset:14336
v_mfma_f32_16x16x32_bf16 v[72:75], v[168:171], a[88:91], v[72:75]
buffer_load_dwordx4 a[156:159], v1, s[44:47], s69 offen offset:3072 sc1
v_mfma_f32_16x16x32_bf16 v[72:75], v[152:155], a[84:87], v[72:75]
s_lshr_b32 s69, s13, 18
ds_read_b64_tr_b16 v[244:245], v9 offset:12288
ds_read_b64_tr_b16 v[246:247], v9 offset:14336
v_mfma_f32_16x16x32_bf16 v[72:75], v[136:139], a[80:83], v[72:75]
s_xor_b32 s71, s12, 0x40100
ds_read_b64_tr_b16 v[248:249], v10 offset:12288
ds_read_b64_tr_b16 v[250:251], v10 offset:14336
v_mfma_f32_16x16x32_bf16 v[76:79], v[140:143], a[80:83], v[76:79]
s_add_u32 m0, s85, 16384
ds_read_b64_tr_b16 v[252:253], v11 offset:12288
ds_read_b64_tr_b16 v[254:255], v11 offset:14336
v_mfma_f32_16x16x32_bf16 v[76:79], v[156:159], a[84:87], v[76:79]
s_add_u32 s72, s71, 0
buffer_load_dwordx4 v15, s[24:27], s72 offen lds
v_mfma_f32_16x16x32_bf16 v[76:79], v[172:175], a[88:91], v[76:79]
s_lshl_b32 s69, s69, 12
v_mfma_f32_16x16x32_bf16 v[76:79], v[188:191], a[92:95], v[76:79]
s_add_u32 s69, s69, s95
v_mfma_f32_16x16x32_bf16 v[60:63], v[188:191], a[76:79], v[60:63]
s_xor_b32 s69, s69, 0x1000
v_mfma_f32_16x16x32_bf16 v[60:63], v[172:175], a[72:75], v[60:63]
s_add_u32 s72, s71, 15360
v_mfma_f32_16x16x32_bf16 v[60:63], v[156:159], a[68:71], v[60:63]
s_waitcnt vmcnt(22) lgkmcnt(0)
buffer_load_dwordx4 a[160:163], v1, s[44:47], s69 offen sc1
v_mfma_f32_16x16x32_bf16 v[60:63], v[140:143], a[64:67], v[60:63]
s_barrier
buffer_load_dwordx4 v15, s[24:27], s72 offen offset:1024 lds
v_mfma_f32_16x16x32_bf16 v[80:83], v[192:195], a[64:67], v[80:83]
s_and_b32 s79, s91, 0xffffcfff
v_lshlrev_b32 v13, 2, v2
buffer_load_dword v14, v13, s[44:47], s79 offen sc1
v_mfma_f32_16x16x32_bf16 v[80:83], v[208:211], a[68:71], v[80:83]
s_nop 0
ds_read_b64_tr_b16 v[128:129], v8 offset:16384
ds_read_b64_tr_b16 v[130:131], v8 offset:18432
v_mfma_f32_16x16x32_bf16 v[80:83], v[224:227], a[72:75], v[80:83]
s_nop 0
ds_read_b64_tr_b16 v[132:133], v9 offset:16384
ds_read_b64_tr_b16 v[134:135], v9 offset:18432
v_mfma_f32_16x16x32_bf16 v[80:83], v[240:243], a[76:79], v[80:83]
s_nop 0
ds_read_b64_tr_b16 v[136:137], v10 offset:16384
ds_read_b64_tr_b16 v[138:139], v10 offset:18432
v_mfma_f32_16x16x32_bf16 v[96:99], v[240:243], a[92:95], v[96:99]
s_nop 0
ds_read_b64_tr_b16 v[140:141], v11 offset:16384
ds_read_b64_tr_b16 v[142:143], v11 offset:18432
v_mfma_f32_16x16x32_bf16 v[96:99], v[224:227], a[88:91], v[96:99]
s_add_u32 s72, s71, 30720
buffer_load_dwordx4 v15, s[24:27], s72 offen offset:2048 lds
v_mfma_f32_16x16x32_bf16 v[96:99], v[208:211], a[84:87], v[96:99]
v_mfma_f32_16x16x32_bf16 v[96:99], v[192:195], a[80:83], v[96:99]
s_nop 0
ds_read_b64_tr_b16 v[144:145], v8 offset:20480
ds_read_b64_tr_b16 v[146:147], v8 offset:22528
v_mfma_f32_16x16x32_bf16 v[100:103], v[196:199], a[80:83], v[100:103]
buffer_load_dwordx4 a[164:167], v1, s[44:47], s69 offen offset:1024 sc1
v_mfma_f32_16x16x32_bf16 v[100:103], v[212:215], a[84:87], v[100:103]
s_nop 0
ds_read_b64_tr_b16 v[148:149], v9 offset:20480
ds_read_b64_tr_b16 v[150:151], v9 offset:22528
v_mfma_f32_16x16x32_bf16 v[100:103], v[228:231], a[88:91], v[100:103]
s_nop 0
ds_read_b64_tr_b16 v[152:153], v10 offset:20480
ds_read_b64_tr_b16 v[154:155], v10 offset:22528
v_mfma_f32_16x16x32_bf16 v[100:103], v[244:247], a[92:95], v[100:103]
s_add_u32 s72, s71, 46080
buffer_load_dwordx4 v15, s[24:27], s72 offen offset:3072 lds
v_mfma_f32_16x16x32_bf16 v[84:87], v[244:247], a[76:79], v[84:87]
s_nop 0
ds_read_b64_tr_b16 v[156:157], v11 offset:20480
ds_read_b64_tr_b16 v[158:159], v11 offset:22528
v_mfma_f32_16x16x32_bf16 v[84:87], v[228:231], a[72:75], v[84:87]
Lstube1:
s_cbranch_execz Lstube5
v_mfma_f32_16x16x32_bf16 v[84:87], v[212:215], a[68:71], v[84:87]
s_nop 0
ds_read_b64_tr_b16 v[160:161], v8 offset:24576
ds_read_b64_tr_b16 v[162:163], v8 offset:26624
v_mfma_f32_16x16x32_bf16 v[84:87], v[196:199], a[64:67], v[84:87]
s_nop 0
ds_read_b64_tr_b16 v[164:165], v9 offset:24576
ds_read_b64_tr_b16 v[166:167], v9 offset:26624
v_mfma_f32_16x16x32_bf16 v[88:91], v[200:203], a[64:67], v[88:91]
s_nop 0
ds_read_b64_tr_b16 v[168:169], v10 offset:24576
ds_read_b64_tr_b16 v[170:171], v10 offset:26624
v_mfma_f32_16x16x32_bf16 v[88:91], v[216:219], a[68:71], v[88:91]
s_nop 0
ds_read_b64_tr_b16 v[172:173], v11 offset:24576
ds_read_b64_tr_b16 v[174:175], v11 offset:26624
v_mfma_f32_16x16x32_bf16 v[88:91], v[232:235], a[72:75], v[88:91]
buffer_load_dwordx4 a[168:171], v1, s[44:47], s69 offen offset:2048 sc1
v_mfma_f32_16x16x32_bf16 v[88:91], v[248:251], a[76:79], v[88:91]
s_xor_b32 s71, s12, 0x40180
v_mfma_f32_16x16x32_bf16 v[104:107], v[248:251], a[92:95], v[104:107]
s_add_u32 m0, s85, 32768
ds_read_b64_tr_b16 v[176:177], v8 offset:28672
ds_read_b64_tr_b16 v[178:179], v8 offset:30720
v_mfma_f32_16x16x32_bf16 v[104:107], v[232:235], a[88:91], v[104:107]
s_add_u32 s72, s71, 0
buffer_load_dwordx4 v15, s[24:27], s72 offen lds
v_mfma_f32_16x16x32_bf16 v[104:107], v[216:219], a[84:87], v[104:107]
s_nop 0
ds_read_b64_tr_b16 v[180:181], v9 offset:28672
ds_read_b64_tr_b16 v[182:183], v9 offset:30720
v_mfma_f32_16x16x32_bf16 v[104:107], v[200:203], a[80:83], v[104:107]
s_nop 0
ds_read_b64_tr_b16 v[184:185], v10 offset:28672
ds_read_b64_tr_b16 v[186:187], v10 offset:30720
v_mfma_f32_16x16x32_bf16 v[108:111], v[204:207], a[80:83], v[108:111]
s_nop 0
ds_read_b64_tr_b16 v[188:189], v11 offset:28672
ds_read_b64_tr_b16 v[190:191], v11 offset:30720
v_mfma_f32_16x16x32_bf16 v[108:111], v[220:223], a[84:87], v[108:111]
v_mfma_f32_16x16x32_bf16 v[108:111], v[236:239], a[88:91], v[108:111]
s_add_u32 s72, s71, 15360
buffer_load_dwordx4 v15, s[24:27], s72 offen offset:1024 lds
v_mfma_f32_16x16x32_bf16 v[108:111], v[252:255], a[92:95], v[108:111]
v_mfma_f32_16x16x32_bf16 v[92:95], v[252:255], a[76:79], v[92:95]
buffer_load_dwordx4 a[172:175], v1, s[44:47], s69 offen offset:3072 sc1
v_mfma_f32_16x16x32_bf16 v[92:95], v[236:239], a[72:75], v[92:95]
v_mfma_f32_16x16x32_bf16 v[92:95], v[220:223], a[68:71], v[92:95]
s_waitcnt vmcnt(26) lgkmcnt(0)
v_mfma_f32_16x16x32_bf16 v[92:95], v[204:207], a[64:67], v[92:95]
s_barrier
v_mfma_f32_16x16x32_bf16 v[16:19], v[128:131], a[96:99], v[16:19]
s_add_u32 s72, s71, 30720
buffer_load_dwordx4 v15, s[24:27], s72 offen offset:2048 lds
v_mfma_f32_16x16x32_bf16 v[16:19], v[144:147], a[100:103], v[16:19]
s_nop 0
ds_read_b64_tr_b16 v[192:193], v8 offset:32768
ds_read_b64_tr_b16 v[194:195], v8 offset:34816
v_mfma_f32_16x16x32_bf16 v[16:19], v[160:163], a[104:107], v[16:19]
s_nop 0
ds_read_b64_tr_b16 v[196:197], v9 offset:32768
ds_read_b64_tr_b16 v[198:199], v9 offset:34816
v_mfma_f32_16x16x32_bf16 v[16:19], v[176:179], a[108:111], v[16:19]
s_nop 0
ds_read_b64_tr_b16 v[200:201], v10 offset:32768
ds_read_b64_tr_b16 v[202:203], v10 offset:34816
v_mfma_f32_16x16x32_bf16 v[32:35], v[176:179], a[124:127], v[32:35]
s_nop 0
ds_read_b64_tr_b16 v[204:205], v11 offset:32768
ds_read_b64_tr_b16 v[206:207], v11 offset:34816
v_mfma_f32_16x16x32_bf16 v[32:35], v[160:163], a[120:123], v[32:35]
v_mfma_f32_16x16x32_bf16 v[32:35], v[144:147], a[116:119], v[32:35]
s_add_u32 s72, s71, 46080
buffer_load_dwordx4 v15, s[24:27], s72 offen offset:3072 lds
v_mfma_f32_16x16x32_bf16 v[32:35], v[128:131], a[112:115], v[32:35]
s_add_u32 s69, s69, 0x20000
buffer_load_dwordx4 a[176:179], v1, s[44:47], s69 offen sc1
v_mfma_f32_16x16x32_bf16 v[36:39], v[132:135], a[112:115], v[36:39]
s_nop 0
ds_read_b64_tr_b16 v[208:209], v8 offset:36864
ds_read_b64_tr_b16 v[210:211], v8 offset:38912
v_mfma_f32_16x16x32_bf16 v[36:39], v[148:151], a[116:119], v[36:39]
s_nop 0
ds_read_b64_tr_b16 v[212:213], v9 offset:36864
ds_read_b64_tr_b16 v[214:215], v9 offset:38912
v_mfma_f32_16x16x32_bf16 v[36:39], v[164:167], a[120:123], v[36:39]
s_nop 0
ds_read_b64_tr_b16 v[216:217], v10 offset:36864
ds_read_b64_tr_b16 v[218:219], v10 offset:38912
v_mfma_f32_16x16x32_bf16 v[36:39], v[180:183], a[124:127], v[36:39]
s_nop 0
ds_read_b64_tr_b16 v[220:221], v11 offset:36864
ds_read_b64_tr_b16 v[222:223], v11 offset:38912
v_mfma_f32_16x16x32_bf16 v[20:23], v[180:183], a[108:111], v[20:23]
v_mfma_f32_16x16x32_bf16 v[20:23], v[164:167], a[104:107], v[20:23]
s_nop 0
ds_read_b64_tr_b16 v[224:225], v8 offset:40960
ds_read_b64_tr_b16 v[226:227], v8 offset:43008
v_mfma_f32_16x16x32_bf16 v[20:23], v[148:151], a[100:103], v[20:23]
s_xor_b32 s71, s13, 0x40080
ds_read_b64_tr_b16 v[228:229], v9 offset:40960
ds_read_b64_tr_b16 v[230:231], v9 offset:43008
v_mfma_f32_16x16x32_bf16 v[20:23], v[132:135], a[96:99], v[20:23]
s_add_u32 m0, s85, 49152
ds_read_b64_tr_b16 v[232:233], v10 offset:40960
ds_read_b64_tr_b16 v[234:235], v10 offset:43008
v_mfma_f32_16x16x32_bf16 v[24:27], v[136:139], a[96:99], v[24:27]
s_add_u32 s72, s71, 0
buffer_load_dwordx4 v15, s[24:27], s72 offen lds
v_mfma_f32_16x16x32_bf16 v[24:27], v[152:155], a[100:103], v[24:27]
buffer_load_dwordx4 a[180:183], v1, s[44:47], s69 offen offset:1024 sc1
v_mfma_f32_16x16x32_bf16 v[24:27], v[168:171], a[104:107], v[24:27]
s_nop 0
ds_read_b64_tr_b16 v[236:237], v11 offset:40960
ds_read_b64_tr_b16 v[238:239], v11 offset:43008
v_mfma_f32_16x16x32_bf16 v[24:27], v[184:187], a[108:111], v[24:27]
v_mfma_f32_16x16x32_bf16 v[40:43], v[184:187], a[124:127], v[40:43]
s_nop 0
ds_read_b64_tr_b16 v[240:241], v8 offset:45056
ds_read_b64_tr_b16 v[242:243], v8 offset:47104
v_mfma_f32_16x16x32_bf16 v[40:43], v[168:171], a[120:123], v[40:43]
s_nop 0
ds_read_b64_tr_b16 v[244:245], v9 offset:45056
ds_read_b64_tr_b16 v[246:247], v9 offset:47104
v_mfma_f32_16x16x32_bf16 v[40:43], v[152:155], a[116:119], v[40:43]
s_add_u32 s72, s71, 15360
buffer_load_dwordx4 v15, s[24:27], s72 offen offset:1024 lds
v_mfma_f32_16x16x32_bf16 v[40:43], v[136:139], a[112:115], v[40:43]
s_nop 0
ds_read_b64_tr_b16 v[248:249], v10 offset:45056
ds_read_b64_tr_b16 v[250:251], v10 offset:47104
v_mfma_f32_16x16x32_bf16 v[44:47], v[140:143], a[112:115], v[44:47]
s_nop 0
ds_read_b64_tr_b16 v[252:253], v11 offset:45056
ds_read_b64_tr_b16 v[254:255], v11 offset:47104
v_mfma_f32_16x16x32_bf16 v[44:47], v[156:159], a[116:119], v[44:47]
v_mfma_f32_16x16x32_bf16 v[44:47], v[172:175], a[120:123], v[44:47]
buffer_load_dwordx4 a[184:187], v1, s[44:47], s69 offen offset:2048 sc1
v_mfma_f32_16x16x32_bf16 v[44:47], v[188:191], a[124:127], v[44:47]
v_mfma_f32_16x16x32_bf16 v[28:31], v[188:191], a[108:111], v[28:31]
s_add_u32 s72, s71, 30720
buffer_load_dwordx4 v15, s[24:27], s72 offen offset:2048 lds
v_mfma_f32_16x16x32_bf16 v[28:31], v[172:175], a[104:107], v[28:31]
v_mfma_f32_16x16x32_bf16 v[28:31], v[156:159], a[100:103], v[28:31]
s_waitcnt vmcnt(27) lgkmcnt(0)
v_mfma_f32_16x16x32_bf16 v[28:31], v[140:143], a[96:99], v[28:31]
s_barrier
v_mfma_f32_16x16x32_bf16 v[48:51], v[192:195], a[96:99], v[48:51]
s_nop 0
ds_read_b64_tr_b16 v[128:129], v8 offset:49152
ds_read_b64_tr_b16 v[130:131], v8 offset:51200
v_mfma_f32_16x16x32_bf16 v[48:51], v[208:211], a[100:103], v[48:51]
s_nop 0
ds_read_b64_tr_b16 v[132:133], v9 offset:49152
ds_read_b64_tr_b16 v[134:135], v9 offset:51200
v_mfma_f32_16x16x32_bf16 v[48:51], v[224:227], a[104:107], v[48:51]
s_add_u32 s72, s71, 46080
buffer_load_dwordx4 v15, s[24:27], s72 offen offset:3072 lds
v_mfma_f32_16x16x32_bf16 v[48:51], v[240:243], a[108:111], v[48:51]
s_nop 0
ds_read_b64_tr_b16 v[136:137], v10 offset:49152
ds_read_b64_tr_b16 v[138:139], v10 offset:51200
v_mfma_f32_16x16x32_bf16 v[64:67], v[240:243], a[124:127], v[64:67]
buffer_load_dwordx4 a[188:191], v1, s[44:47], s69 offen offset:3072 sc1
v_mfma_f32_16x16x32_bf16 v[64:67], v[224:227], a[120:123], v[64:67]
s_nop 0
ds_read_b64_tr_b16 v[140:141], v11 offset:49152
ds_read_b64_tr_b16 v[142:143], v11 offset:51200
v_mfma_f32_16x16x32_bf16 v[64:67], v[208:211], a[116:119], v[64:67]
s_nop 0
ds_read_b64_tr_b16 v[144:145], v8 offset:53248
ds_read_b64_tr_b16 v[146:147], v8 offset:55296
v_mfma_f32_16x16x32_bf16 v[64:67], v[192:195], a[112:115], v[64:67]
s_nop 0
ds_read_b64_tr_b16 v[148:149], v9 offset:53248
ds_read_b64_tr_b16 v[150:151], v9 offset:55296
v_mfma_f32_16x16x32_bf16 v[68:71], v[196:199], a[112:115], v[68:71]
s_lshr_b32 s69, s14, 18
v_mfma_f32_16x16x32_bf16 v[68:71], v[212:215], a[116:119], v[68:71]
s_lshl_b32 s69, s69, 12
ds_read_b64_tr_b16 v[152:153], v10 offset:53248
ds_read_b64_tr_b16 v[154:155], v10 offset:55296
v_mfma_f32_16x16x32_bf16 v[68:71], v[228:231], a[120:123], v[68:71]
s_xor_b32 s71, s14, 0x40080
ds_read_b64_tr_b16 v[156:157], v11 offset:53248
ds_read_b64_tr_b16 v[158:159], v11 offset:55296
v_mfma_f32_16x16x32_bf16 v[68:71], v[244:247], a[124:127], v[68:71]
s_add_u32 m0, s77, 0
ds_read_b64_tr_b16 v[160:161], v8 offset:57344
ds_read_b64_tr_b16 v[162:163], v8 offset:59392
v_mfma_f32_16x16x32_bf16 v[52:55], v[244:247], a[108:111], v[52:55]
s_add_u32 s72, s71, 0
buffer_load_dwordx4 v15, s[24:27], s72 offen lds
v_mfma_f32_16x16x32_bf16 v[52:55], v[228:231], a[104:107], v[52:55]
s_add_u32 s69, s69, s95
ds_read_b64_tr_b16 v[164:165], v9 offset:57344
ds_read_b64_tr_b16 v[166:167], v9 offset:59392
v_mfma_f32_16x16x32_bf16 v[52:55], v[212:215], a[100:103], v[52:55]
s_xor_b32 s69, s69, 0x1000
buffer_load_dwordx4 a[192:195], v1, s[44:47], s69 offen sc1
v_mfma_f32_16x16x32_bf16 v[52:55], v[196:199], a[96:99], v[52:55]
s_nop 0
ds_read_b64_tr_b16 v[168:169], v10 offset:57344
ds_read_b64_tr_b16 v[170:171], v10 offset:59392
v_mfma_f32_16x16x32_bf16 v[56:59], v[200:203], a[96:99], v[56:59]
s_waitcnt vmcnt(19)
v_cmp_gt_u32 vcc, 2, v14
s_cbranch_vccnz Lspin112
Lback113:
v_mfma_f32_16x16x32_bf16 v[56:59], v[216:219], a[100:103], v[56:59]
s_add_u32 s72, s71, 15360
buffer_load_dwordx4 v15, s[24:27], s72 offen offset:1024 lds
v_mfma_f32_16x16x32_bf16 v[56:59], v[232:235], a[104:107], v[56:59]
v_mfma_f32_16x16x32_bf16 v[56:59], v[248:251], a[108:111], v[56:59]
s_nop 0
ds_read_b64_tr_b16 v[172:173], v11 offset:57344
ds_read_b64_tr_b16 v[174:175], v11 offset:59392
v_mfma_f32_16x16x32_bf16 v[72:75], v[248:251], a[124:127], v[72:75]
s_nop 0
ds_read_b64_tr_b16 v[176:177], v8 offset:61440
ds_read_b64_tr_b16 v[178:179], v8 offset:63488
v_mfma_f32_16x16x32_bf16 v[72:75], v[232:235], a[120:123], v[72:75]
s_nop 0
ds_read_b64_tr_b16 v[180:181], v9 offset:61440
ds_read_b64_tr_b16 v[182:183], v9 offset:63488
v_mfma_f32_16x16x32_bf16 v[72:75], v[216:219], a[116:119], v[72:75]
s_nop 0
ds_read_b64_tr_b16 v[184:185], v10 offset:61440
ds_read_b64_tr_b16 v[186:187], v10 offset:63488
v_mfma_f32_16x16x32_bf16 v[72:75], v[200:203], a[112:115], v[72:75]
s_add_u32 s72, s71, 30720
buffer_load_dwordx4 v15, s[24:27], s72 offen offset:2048 lds
v_mfma_f32_16x16x32_bf16 v[76:79], v[204:207], a[112:115], v[76:79]
buffer_load_dwordx4 a[196:199], v1, s[44:47], s69 offen offset:1024 sc1
v_mfma_f32_16x16x32_bf16 v[76:79], v[220:223], a[116:119], v[76:79]
s_nop 0
ds_read_b64_tr_b16 v[188:189], v11 offset:61440
ds_read_b64_tr_b16 v[190:191], v11 offset:63488
v_mfma_f32_16x16x32_bf16 v[76:79], v[236:239], a[120:123], v[76:79]
v_mfma_f32_16x16x32_bf16 v[76:79], v[252:255], a[124:127], v[76:79]
v_mfma_f32_16x16x32_bf16 v[60:63], v[252:255], a[108:111], v[60:63]
v_xor_b32 v8, 0x10000, v8
v_mfma_f32_16x16x32_bf16 v[60:63], v[236:239], a[104:107], v[60:63]
s_add_u32 s72, s71, 46080
buffer_load_dwordx4 v15, s[24:27], s72 offen offset:3072 lds
v_xor_b32 v9, 0x10000, v9
v_mfma_f32_16x16x32_bf16 v[60:63], v[220:223], a[100:103], v[60:63]
s_waitcnt vmcnt(28) lgkmcnt(0)
v_xor_b32 v10, 0x10000, v10
v_mfma_f32_16x16x32_bf16 v[60:63], v[204:207], a[96:99], v[60:63]
s_barrier
v_xor_b32 v11, 0x10000, v11
v_mfma_f32_16x16x32_bf16 v[80:83], v[128:131], a[96:99], v[80:83]
s_lshl_b32 s84, s76, 11
ds_read_b64_tr_b16 v[192:193], v8 offset:0
ds_read_b64_tr_b16 v[194:195], v8 offset:2048
v_mfma_f32_16x16x32_bf16 v[80:83], v[144:147], a[100:103], v[80:83]
s_add_u32 s84, s84, 0x3810000
ds_read_b64_tr_b16 v[196:197], v9 offset:0
ds_read_b64_tr_b16 v[198:199], v9 offset:2048
v_mfma_f32_16x16x32_bf16 v[80:83], v[160:163], a[104:107], v[80:83]
buffer_load_dwordx4 a[200:203], v1, s[44:47], s69 offen offset:2048 sc1
v_mfma_f32_16x16x32_bf16 v[80:83], v[176:179], a[108:111], v[80:83]
s_nop 0
ds_read_b64_tr_b16 v[200:201], v10 offset:0
ds_read_b64_tr_b16 v[202:203], v10 offset:2048
v_mfma_f32_16x16x32_bf16 v[96:99], v[176:179], a[124:127], v[96:99]
s_nop 0
ds_read_b64_tr_b16 v[204:205], v11 offset:0
ds_read_b64_tr_b16 v[206:207], v11 offset:2048
v_mfma_f32_16x16x32_bf16 v[96:99], v[160:163], a[120:123], v[96:99]
s_xor_b32 s71, s15, 0x40080
v_lshrrev_b32 v115, 2, v0
v_lshlrev_b32 v115, 7, v115
v_mfma_f32_16x16x32_bf16 v[96:99], v[144:147], a[116:119], v[96:99]
s_add_u32 m0, s77, 16384
ds_read_b64_tr_b16 v[208:209], v8 offset:4096
ds_read_b64_tr_b16 v[210:211], v8 offset:6144
v_mfma_f32_16x16x32_bf16 v[96:99], v[128:131], a[112:115], v[96:99]
s_add_u32 s72, s71, 0
buffer_load_dwordx4 v15, s[24:27], s72 offen lds
v_mfma_f32_16x16x32_bf16 v[100:103], v[132:135], a[112:115], v[100:103]
s_nop 0
ds_read_b64_tr_b16 v[212:213], v9 offset:4096
ds_read_b64_tr_b16 v[214:215], v9 offset:6144
v_mfma_f32_16x16x32_bf16 v[100:103], v[148:151], a[116:119], v[100:103]
s_nop 0
ds_read_b64_tr_b16 v[216:217], v10 offset:4096
ds_read_b64_tr_b16 v[218:219], v10 offset:6144
v_mfma_f32_16x16x32_bf16 v[100:103], v[164:167], a[120:123], v[100:103]
s_nop 0
ds_read_b64_tr_b16 v[220:221], v11 offset:4096
ds_read_b64_tr_b16 v[222:223], v11 offset:6144
v_mfma_f32_16x16x32_bf16 v[100:103], v[180:183], a[124:127], v[100:103]
buffer_load_dword v114, v115, s[44:47], s84 offen sc1
v_mfma_f32_16x16x32_bf16 v[84:87], v[180:183], a[108:111], v[84:87]
buffer_load_dwordx4 a[204:207], v1, s[44:47], s69 offen offset:3072 sc1
v_mfma_f32_16x16x32_bf16 v[84:87], v[164:167], a[104:107], v[84:87]
s_add_u32 s72, s71, 15360
buffer_load_dwordx4 v15, s[24:27], s72 offen offset:1024 lds
v_mfma_f32_16x16x32_bf16 v[84:87], v[148:151], a[100:103], v[84:87]
s_nop 0
ds_read_b64_tr_b16 v[224:225], v8 offset:8192
ds_read_b64_tr_b16 v[226:227], v8 offset:10240
v_mfma_f32_16x16x32_bf16 v[84:87], v[132:135], a[96:99], v[84:87]
s_nop 0
ds_read_b64_tr_b16 v[228:229], v9 offset:8192
ds_read_b64_tr_b16 v[230:231], v9 offset:10240
v_mfma_f32_16x16x32_bf16 v[88:91], v[136:139], a[96:99], v[88:91]
s_nop 0
ds_read_b64_tr_b16 v[232:233], v10 offset:8192
ds_read_b64_tr_b16 v[234:235], v10 offset:10240
v_mfma_f32_16x16x32_bf16 v[88:91], v[152:155], a[100:103], v[88:91]
s_nop 0
ds_read_b64_tr_b16 v[236:237], v11 offset:8192
ds_read_b64_tr_b16 v[238:239], v11 offset:10240
v_mfma_f32_16x16x32_bf16 v[88:91], v[168:171], a[104:107], v[88:91]
v_mfma_f32_16x16x32_bf16 v[88:91], v[184:187], a[108:111], v[88:91]
s_add_u32 s72, s71, 30720
buffer_load_dwordx4 v15, s[24:27], s72 offen offset:2048 lds
v_mfma_f32_16x16x32_bf16 v[104:107], v[184:187], a[124:127], v[104:107]
s_nop 0
ds_read_b64_tr_b16 v[240:241], v8 offset:12288
ds_read_b64_tr_b16 v[242:243], v8 offset:14336
v_mfma_f32_16x16x32_bf16 v[104:107], v[168:171], a[120:123], v[104:107]
s_nop 0
ds_read_b64_tr_b16 v[244:245], v9 offset:12288
ds_read_b64_tr_b16 v[246:247], v9 offset:14336
v_mfma_f32_16x16x32_bf16 v[104:107], v[152:155], a[116:119], v[104:107]
s_add_u32 s69, s69, 0x20000
buffer_load_dwordx4 a[208:211], v1, s[44:47], s69 offen sc1
v_mfma_f32_16x16x32_bf16 v[104:107], v[136:139], a[112:115], v[104:107]
s_nop 0
ds_read_b64_tr_b16 v[248:249], v10 offset:12288
ds_read_b64_tr_b16 v[250:251], v10 offset:14336
v_mfma_f32_16x16x32_bf16 v[108:111], v[140:143], a[112:115], v[108:111]
s_nop 0
ds_read_b64_tr_b16 v[252:253], v11 offset:12288
ds_read_b64_tr_b16 v[254:255], v11 offset:14336
v_mfma_f32_16x16x32_bf16 v[108:111], v[156:159], a[116:119], v[108:111]
s_add_u32 s72, s71, 46080
buffer_load_dwordx4 v15, s[24:27], s72 offen offset:3072 lds
v_mfma_f32_16x16x32_bf16 v[108:111], v[172:175], a[120:123], v[108:111]
v_mfma_f32_16x16x32_bf16 v[108:111], v[188:191], a[124:127], v[108:111]
v_mfma_f32_16x16x32_bf16 v[92:95], v[188:191], a[108:111], v[92:95]
v_mfma_f32_16x16x32_bf16 v[92:95], v[172:175], a[104:107], v[92:95]
v_mfma_f32_16x16x32_bf16 v[92:95], v[156:159], a[100:103], v[92:95]
s_waitcnt vmcnt(28) lgkmcnt(0)
v_mfma_f32_16x16x32_bf16 v[92:95], v[140:143], a[96:99], v[92:95]
s_barrier
v_mfma_f32_16x16x32_bf16 v[16:19], v[192:195], a[128:131], v[16:19]
buffer_load_dwordx4 a[212:215], v1, s[44:47], s69 offen offset:1024 sc1
v_mfma_f32_16x16x32_bf16 v[16:19], v[208:211], a[132:135], v[16:19]
s_xor_b32 s71, s13, 0x40100
ds_read_b64_tr_b16 v[128:129], v8 offset:16384
ds_read_b64_tr_b16 v[130:131], v8 offset:18432
v_mfma_f32_16x16x32_bf16 v[16:19], v[224:227], a[136:139], v[16:19]
s_add_u32 m0, s77, 32768
ds_read_b64_tr_b16 v[132:133], v9 offset:16384
ds_read_b64_tr_b16 v[134:135], v9 offset:18432
v_mfma_f32_16x16x32_bf16 v[16:19], v[240:243], a[140:143], v[16:19]
s_add_u32 s72, s71, 0
buffer_load_dwordx4 v15, s[24:27], s72 offen lds
v_mfma_f32_16x16x32_bf16 v[32:35], v[240:243], a[156:159], v[32:35]
s_nop 0
ds_read_b64_tr_b16 v[136:137], v10 offset:16384
ds_read_b64_tr_b16 v[138:139], v10 offset:18432
v_mfma_f32_16x16x32_bf16 v[32:35], v[224:227], a[152:155], v[32:35]
s_nop 0
ds_read_b64_tr_b16 v[140:141], v11 offset:16384
ds_read_b64_tr_b16 v[142:143], v11 offset:18432
v_mfma_f32_16x16x32_bf16 v[32:35], v[208:211], a[148:151], v[32:35]
v_mfma_f32_16x16x32_bf16 v[32:35], v[192:195], a[144:147], v[32:35]
s_nop 0
ds_read_b64_tr_b16 v[144:145], v8 offset:20480
ds_read_b64_tr_b16 v[146:147], v8 offset:22528
v_mfma_f32_16x16x32_bf16 v[36:39], v[196:199], a[144:147], v[36:39]
s_add_u32 s72, s71, 15360
buffer_load_dwordx4 v15, s[24:27], s72 offen offset:1024 lds
v_mfma_f32_16x16x32_bf16 v[36:39], v[212:215], a[148:151], v[36:39]
s_nop 0
ds_read_b64_tr_b16 v[148:149], v9 offset:20480
ds_read_b64_tr_b16 v[150:151], v9 offset:22528
v_mfma_f32_16x16x32_bf16 v[36:39], v[228:231], a[152:155], v[36:39]
buffer_load_dwordx4 a[216:219], v1, s[44:47], s69 offen offset:2048 sc1
v_mfma_f32_16x16x32_bf16 v[36:39], v[244:247], a[156:159], v[36:39]
s_nop 0
ds_read_b64_tr_b16 v[152:153], v10 offset:20480
ds_read_b64_tr_b16 v[154:155], v10 offset:22528
v_mfma_f32_16x16x32_bf16 v[20:23], v[244:247], a[140:143], v[20:23]
s_nop 0
ds_read_b64_tr_b16 v[156:157], v11 offset:20480
ds_read_b64_tr_b16 v[158:159], v11 offset:22528
v_mfma_f32_16x16x32_bf16 v[20:23], v[228:231], a[136:139], v[20:23]
v_mfma_f32_16x16x32_bf16 v[20:23], v[212:215], a[132:135], v[20:23]
s_add_u32 s72, s71, 30720
buffer_load_dwordx4 v15, s[24:27], s72 offen offset:2048 lds
v_mfma_f32_16x16x32_bf16 v[20:23], v[196:199], a[128:131], v[20:23]
s_nop 0
ds_read_b64_tr_b16 v[160:161], v8 offset:24576
ds_read_b64_tr_b16 v[162:163], v8 offset:26624
v_mfma_f32_16x16x32_bf16 v[24:27], v[200:203], a[128:131], v[24:27]
s_nop 0
ds_read_b64_tr_b16 v[164:165], v9 offset:24576
ds_read_b64_tr_b16 v[166:167], v9 offset:26624
v_mfma_f32_16x16x32_bf16 v[24:27], v[216:219], a[132:135], v[24:27]
s_nop 0
ds_read_b64_tr_b16 v[168:169], v10 offset:24576
ds_read_b64_tr_b16 v[170:171], v10 offset:26624
v_mfma_f32_16x16x32_bf16 v[24:27], v[232:235], a[136:139], v[24:27]
s_nop 0
ds_read_b64_tr_b16 v[172:173], v11 offset:24576
ds_read_b64_tr_b16 v[174:175], v11 offset:26624
v_mfma_f32_16x16x32_bf16 v[24:27], v[248:251], a[140:143], v[24:27]
v_mfma_f32_16x16x32_bf16 v[40:43], v[248:251], a[156:159], v[40:43]
s_add_u32 s72, s71, 46080
buffer_load_dwordx4 v15, s[24:27], s72 offen offset:3072 lds
v_mfma_f32_16x16x32_bf16 v[40:43], v[232:235], a[152:155], v[40:43]
buffer_load_dwordx4 a[220:223], v1, s[44:47], s69 offen offset:3072 sc1
v_mfma_f32_16x16x32_bf16 v[40:43], v[216:219], a[148:151], v[40:43]
s_nop 0
ds_read_b64_tr_b16 v[176:177], v8 offset:28672
ds_read_b64_tr_b16 v[178:179], v8 offset:30720
v_mfma_f32_16x16x32_bf16 v[40:43], v[200:203], a[144:147], v[40:43]
s_lshr_b32 s69, s15, 18
ds_read_b64_tr_b16 v[180:181], v9 offset:28672
ds_read_b64_tr_b16 v[182:183], v9 offset:30720
v_mfma_f32_16x16x32_bf16 v[44:47], v[204:207], a[144:147], v[44:47]
s_lshl_b32 s69, s69, 12
ds_read_b64_tr_b16 v[184:185], v10 offset:28672
ds_read_b64_tr_b16 v[186:187], v10 offset:30720
v_mfma_f32_16x16x32_bf16 v[44:47], v[220:223], a[148:151], v[44:47]
s_add_u32 s69, s69, s95
ds_read_b64_tr_b16 v[188:189], v11 offset:28672
ds_read_b64_tr_b16 v[190:191], v11 offset:30720
v_mfma_f32_16x16x32_bf16 v[44:47], v[236:239], a[152:155], v[44:47]
s_xor_b32 s69, s69, 0x1000
v_mfma_f32_16x16x32_bf16 v[44:47], v[252:255], a[156:159], v[44:47]
s_xor_b32 s71, s14, 0x40100
v_mfma_f32_16x16x32_bf16 v[28:31], v[252:255], a[140:143], v[28:31]
s_add_u32 m0, s77, 49152
v_mfma_f32_16x16x32_bf16 v[28:31], v[236:239], a[136:139], v[28:31]
s_add_u32 s72, s71, 0
v_mfma_f32_16x16x32_bf16 v[28:31], v[220:223], a[132:135], v[28:31]
s_waitcnt vmcnt(29) lgkmcnt(0)
buffer_load_dwordx4 v15, s[24:27], s72 offen lds
v_mfma_f32_16x16x32_bf16 v[28:31], v[204:207], a[128:131], v[28:31]
s_barrier
buffer_load_dwordx4 a[224:227], v1, s[44:47], s69 offen sc1
v_mfma_f32_16x16x32_bf16 v[48:51], v[128:131], a[128:131], v[48:51]
s_nop 0
ds_read_b64_tr_b16 v[192:193], v8 offset:32768
ds_read_b64_tr_b16 v[194:195], v8 offset:34816
v_mfma_f32_16x16x32_bf16 v[48:51], v[144:147], a[132:135], v[48:51]
s_nop 0
ds_read_b64_tr_b16 v[196:197], v9 offset:32768
ds_read_b64_tr_b16 v[198:199], v9 offset:34816
v_mfma_f32_16x16x32_bf16 v[48:51], v[160:163], a[136:139], v[48:51]
s_nop 0
ds_read_b64_tr_b16 v[200:201], v10 offset:32768
ds_read_b64_tr_b16 v[202:203], v10 offset:34816
v_mfma_f32_16x16x32_bf16 v[48:51], v[176:179], a[140:143], v[48:51]
s_add_u32 s72, s71, 15360
buffer_load_dwordx4 v15, s[24:27], s72 offen offset:1024 lds
v_mfma_f32_16x16x32_bf16 v[64:67], v[176:179], a[156:159], v[64:67]
s_nop 0
ds_read_b64_tr_b16 v[204:205], v11 offset:32768
ds_read_b64_tr_b16 v[206:207], v11 offset:34816
v_mfma_f32_16x16x32_bf16 v[64:67], v[160:163], a[152:155], v[64:67]
v_mfma_f32_16x16x32_bf16 v[64:67], v[144:147], a[148:151], v[64:67]
s_nop 0
ds_read_b64_tr_b16 v[208:209], v8 offset:36864
ds_read_b64_tr_b16 v[210:211], v8 offset:38912
v_mfma_f32_16x16x32_bf16 v[64:67], v[128:131], a[144:147], v[64:67]
s_nop 0
ds_read_b64_tr_b16 v[212:213], v9 offset:36864
ds_read_b64_tr_b16 v[214:215], v9 offset:38912
v_mfma_f32_16x16x32_bf16 v[68:71], v[132:135], a[144:147], v[68:71]
buffer_load_dwordx4 a[228:231], v1, s[44:47], s69 offen offset:1024 sc1
v_mfma_f32_16x16x32_bf16 v[68:71], v[148:151], a[148:151], v[68:71]
s_add_u32 s72, s71, 30720
buffer_load_dwordx4 v15, s[24:27], s72 offen offset:2048 lds
v_mfma_f32_16x16x32_bf16 v[68:71], v[164:167], a[152:155], v[68:71]
s_nop 0
ds_read_b64_tr_b16 v[216:217], v10 offset:36864
ds_read_b64_tr_b16 v[218:219], v10 offset:38912
v_mfma_f32_16x16x32_bf16 v[68:71], v[180:183], a[156:159], v[68:71]
v_mfma_f32_16x16x32_bf16 v[52:55], v[180:183], a[140:143], v[52:55]
s_nop 0
ds_read_b64_tr_b16 v[220:221], v11 offset:36864
ds_read_b64_tr_b16 v[222:223], v11 offset:38912
v_mfma_f32_16x16x32_bf16 v[52:55], v[164:167], a[136:139], v[52:55]
s_nop 0
ds_read_b64_tr_b16 v[224:225], v8 offset:40960
ds_read_b64_tr_b16 v[226:227], v8 offset:43008
v_mfma_f32_16x16x32_bf16 v[52:55], v[148:151], a[132:135], v[52:55]
s_nop 0
ds_read_b64_tr_b16 v[228:229], v9 offset:40960
ds_read_b64_tr_b16 v[230:231], v9 offset:43008
v_mfma_f32_16x16x32_bf16 v[52:55], v[132:135], a[128:131], v[52:55]
s_add_u32 s72, s71, 46080
buffer_load_dwordx4 v15, s[24:27], s72 offen offset:3072 lds
v_mfma_f32_16x16x32_bf16 v[56:59], v[136:139], a[128:131], v[56:59]
v_mfma_f32_16x16x32_bf16 v[56:59], v[152:155], a[132:135], v[56:59]
s_nop 0
ds_read_b64_tr_b16 v[232:233], v10 offset:40960
ds_read_b64_tr_b16 v[234:235], v10 offset:43008
v_mfma_f32_16x16x32_bf16 v[56:59], v[168:171], a[136:139], v[56:59]
buffer_load_dwordx4 a[232:235], v1, s[44:47], s69 offen offset:2048 sc1
v_mfma_f32_16x16x32_bf16 v[56:59], v[184:187], a[140:143], v[56:59]
s_nop 0
ds_read_b64_tr_b16 v[236:237], v11 offset:40960
ds_read_b64_tr_b16 v[238:239], v11 offset:43008
v_mfma_f32_16x16x32_bf16 v[72:75], v[184:187], a[156:159], v[72:75]
s_nop 0
ds_read_b64_tr_b16 v[240:241], v8 offset:45056
ds_read_b64_tr_b16 v[242:243], v8 offset:47104
v_mfma_f32_16x16x32_bf16 v[72:75], v[168:171], a[152:155], v[72:75]
v_mfma_f32_16x16x32_bf16 v[72:75], v[152:155], a[148:151], v[72:75]
s_nop 0
ds_read_b64_tr_b16 v[244:245], v9 offset:45056
ds_read_b64_tr_b16 v[246:247], v9 offset:47104
v_mfma_f32_16x16x32_bf16 v[72:75], v[136:139], a[144:147], v[72:75]
s_xor_b32 s71, s15, 0x40100
ds_read_b64_tr_b16 v[248:249], v10 offset:45056
ds_read_b64_tr_b16 v[250:251], v10 offset:47104
v_mfma_f32_16x16x32_bf16 v[76:79], v[140:143], a[144:147], v[76:79]
s_add_u32 m0, s85, 0
ds_read_b64_tr_b16 v[252:253], v11 offset:45056
ds_read_b64_tr_b16 v[254:255], v11 offset:47104
v_mfma_f32_16x16x32_bf16 v[76:79], v[156:159], a[148:151], v[76:79]
s_add_u32 s72, s71, 0
buffer_load_dwordx4 v15, s[24:27], s72 offen lds
v_mfma_f32_16x16x32_bf16 v[76:79], v[172:175], a[152:155], v[76:79]
v_mfma_f32_16x16x32_bf16 v[76:79], v[188:191], a[156:159], v[76:79]
v_mfma_f32_16x16x32_bf16 v[60:63], v[188:191], a[140:143], v[60:63]
buffer_load_dwordx4 a[236:239], v1, s[44:47], s69 offen offset:3072 sc1
v_mfma_f32_16x16x32_bf16 v[60:63], v[172:175], a[136:139], v[60:63]
s_add_u32 s72, s71, 15360
v_mfma_f32_16x16x32_bf16 v[60:63], v[156:159], a[132:135], v[60:63]
s_waitcnt vmcnt(31) lgkmcnt(0)
v_mfma_f32_16x16x32_bf16 v[60:63], v[140:143], a[128:131], v[60:63]
s_barrier
buffer_load_dwordx4 v15, s[24:27], s72 offen offset:1024 lds
v_mfma_f32_16x16x32_bf16 v[80:83], v[192:195], a[128:131], v[80:83]
s_nop 0
ds_read_b64_tr_b16 v[128:129], v8 offset:49152
ds_read_b64_tr_b16 v[130:131], v8 offset:51200
v_mfma_f32_16x16x32_bf16 v[80:83], v[208:211], a[132:135], v[80:83]
s_nop 0
ds_read_b64_tr_b16 v[132:133], v9 offset:49152
ds_read_b64_tr_b16 v[134:135], v9 offset:51200
v_mfma_f32_16x16x32_bf16 v[80:83], v[224:227], a[136:139], v[80:83]
s_nop 0
ds_read_b64_tr_b16 v[136:137], v10 offset:49152
ds_read_b64_tr_b16 v[138:139], v10 offset:51200
s_waitcnt vmcnt(22)
v_cmp_gt_u32 vcc, 3, v114
s_cbranch_vccnz Lspin109
Lback110:
v_mfma_f32_16x16x32_bf16 v[80:83], v[240:243], a[140:143], v[80:83]
s_lshl_b32 s73, s76, 18
ds_read_b64_tr_b16 v[140:141], v11 offset:49152
ds_read_b64_tr_b16 v[142:143], v11 offset:51200
v_mfma_f32_16x16x32_bf16 v[96:99], v[240:243], a[156:159], v[96:99]
s_lshl_b32 s84, s58, 16
v_mfma_f32_16x16x32_bf16 v[96:99], v[224:227], a[152:155], v[96:99]
s_add_u32 s72, s71, 30720
buffer_load_dwordx4 v15, s[24:27], s72 offen offset:2048 lds
v_mfma_f32_16x16x32_bf16 v[96:99], v[208:211], a[148:151], v[96:99]
s_add_u32 s69, s69, 0x20000
buffer_load_dwordx4 a[240:243], v1, s[44:47], s69 offen sc1
v_mfma_f32_16x16x32_bf16 v[96:99], v[192:195], a[144:147], v[96:99]
Lstube2:
s_cbranch_execz Lrete
s_add_u32 s73, s73, s84
ds_read_b64_tr_b16 v[144:145], v8 offset:53248
ds_read_b64_tr_b16 v[146:147], v8 offset:55296
v_mfma_f32_16x16x32_bf16 v[100:103], v[196:199], a[144:147], v[100:103]
s_lshl_b32 s84, s75, 8
ds_read_b64_tr_b16 v[148:149], v9 offset:53248
ds_read_b64_tr_b16 v[150:151], v9 offset:55296
v_mfma_f32_16x16x32_bf16 v[100:103], v[212:215], a[148:151], v[100:103]
s_add_u32 s73, s73, s84
ds_read_b64_tr_b16 v[152:153], v10 offset:53248
ds_read_b64_tr_b16 v[154:155], v10 offset:55296
v_mfma_f32_16x16x32_bf16 v[100:103], v[228:231], a[152:155], v[100:103]
s_add_u32 s73, s73, 0x3400000
v_lshrrev_b32 v112, 4, v0
v_and_b32 v113, 15, v0
v_mfma_f32_16x16x32_bf16 v[100:103], v[244:247], a[156:159], v[100:103]
s_add_u32 s72, s71, 46080
buffer_load_dwordx4 v15, s[24:27], s72 offen offset:3072 lds
v_mfma_f32_16x16x32_bf16 v[84:87], v[244:247], a[140:143], v[84:87]
s_nop 0
ds_read_b64_tr_b16 v[156:157], v11 offset:53248
ds_read_b64_tr_b16 v[158:159], v11 offset:55296
v_mfma_f32_16x16x32_bf16 v[84:87], v[228:231], a[136:139], v[84:87]
s_nop 0
ds_read_b64_tr_b16 v[160:161], v8 offset:57344
ds_read_b64_tr_b16 v[162:163], v8 offset:59392
v_mfma_f32_16x16x32_bf16 v[84:87], v[212:215], a[132:135], v[84:87]
s_nop 0
ds_read_b64_tr_b16 v[164:165], v9 offset:57344
ds_read_b64_tr_b16 v[166:167], v9 offset:59392
v_mfma_f32_16x16x32_bf16 v[84:87], v[196:199], a[128:131], v[84:87]
v_xor_b32 v12, v113, v112
v_lshlrev_b32 v12, 4, v12
v_mfma_f32_16x16x32_bf16 v[88:91], v[200:203], a[128:131], v[88:91]
buffer_load_dwordx4 a[244:247], v1, s[44:47], s69 offen offset:1024 sc1
v_mfma_f32_16x16x32_bf16 v[88:91], v[216:219], a[132:135], v[88:91]
s_nop 0
ds_read_b64_tr_b16 v[168:169], v10 offset:57344
ds_read_b64_tr_b16 v[170:171], v10 offset:59392
v_mfma_f32_16x16x32_bf16 v[88:91], v[232:235], a[136:139], v[88:91]
s_nop 0
ds_read_b64_tr_b16 v[172:173], v11 offset:57344
ds_read_b64_tr_b16 v[174:175], v11 offset:59392
v_mfma_f32_16x16x32_bf16 v[88:91], v[248:251], a[140:143], v[88:91]
s_xor_b32 s71, s13, 0x40180
ds_read_b64_tr_b16 v[176:177], v8 offset:61440
ds_read_b64_tr_b16 v[178:179], v8 offset:63488
v_mfma_f32_16x16x32_bf16 v[104:107], v[248:251], a[156:159], v[104:107]
s_add_u32 m0, s85, 16384
v_lshl_add_u32 v112, v112, 12, v12
v_xor_b32 v12, 64, v112
v_mfma_f32_16x16x32_bf16 v[104:107], v[232:235], a[152:155], v[104:107]
s_add_u32 s72, s71, 0
buffer_load_dwordx4 v15, s[24:27], s72 offen lds
v_mfma_f32_16x16x32_bf16 v[104:107], v[216:219], a[148:151], v[104:107]
s_nop 0
ds_read_b64_tr_b16 v[180:181], v9 offset:61440
ds_read_b64_tr_b16 v[182:183], v9 offset:63488
v_mfma_f32_16x16x32_bf16 v[104:107], v[200:203], a[144:147], v[104:107]
s_nop 0
ds_read_b64_tr_b16 v[184:185], v10 offset:61440
ds_read_b64_tr_b16 v[186:187], v10 offset:63488
v_mfma_f32_16x16x32_bf16 v[108:111], v[204:207], a[144:147], v[108:111]
s_nop 0
ds_read_b64_tr_b16 v[188:189], v11 offset:61440
ds_read_b64_tr_b16 v[190:191], v11 offset:63488
v_mfma_f32_16x16x32_bf16 v[108:111], v[220:223], a[148:151], v[108:111]
v_lshlrev_b32 v113, 2, v113
v_mfma_f32_16x16x32_bf16 v[108:111], v[236:239], a[152:155], v[108:111]
s_add_u32 s72, s71, 15360
buffer_load_dwordx4 v15, s[24:27], s72 offen offset:1024 lds
v_mfma_f32_16x16x32_bf16 v[108:111], v[252:255], a[156:159], v[108:111]
buffer_load_dwordx4 a[248:251], v1, s[44:47], s69 offen offset:2048 sc1
v_mfma_f32_16x16x32_bf16 v[92:95], v[252:255], a[140:143], v[92:95]
v_xor_b32 v8, 0x10000, v8
v_mfma_f32_16x16x32_bf16 v[92:95], v[236:239], a[136:139], v[92:95]
v_xor_b32 v9, 0x10000, v9
v_mfma_f32_16x16x32_bf16 v[92:95], v[220:223], a[132:135], v[92:95]
s_waitcnt vmcnt(32) lgkmcnt(0)
v_xor_b32 v10, 0x10000, v10
v_mfma_f32_16x16x32_bf16 v[92:95], v[204:207], a[128:131], v[92:95]
s_barrier
v_xor_b32 v11, 0x10000, v11
v_mfma_f32_16x16x32_bf16 v[16:19], v[128:131], a[160:163], v[16:19]
s_add_u32 s72, s71, 30720
buffer_load_dwordx4 v15, s[24:27], s72 offen offset:2048 lds
v_mfma_f32_16x16x32_bf16 v[16:19], v[144:147], a[164:167], v[16:19]
s_nop 0
ds_read_b64_tr_b16 v[192:193], v8 offset:0
ds_read_b64_tr_b16 v[194:195], v8 offset:2048
v_mfma_f32_16x16x32_bf16 v[16:19], v[160:163], a[168:171], v[16:19]
s_nop 0
ds_read_b64_tr_b16 v[196:197], v9 offset:0
ds_read_b64_tr_b16 v[198:199], v9 offset:2048
v_mfma_f32_16x16x32_bf16 v[16:19], v[176:179], a[172:175], v[16:19]
s_nop 0
ds_read_b64_tr_b16 v[200:201], v10 offset:0
ds_read_b64_tr_b16 v[202:203], v10 offset:2048
v_mfma_f32_16x16x32_bf16 v[32:35], v[176:179], a[188:191], v[32:35]
buffer_load_dwordx4 a[252:255], v1, s[44:47], s69 offen offset:3072 sc1
v_mfma_f32_16x16x32_bf16 v[32:35], v[160:163], a[184:187], v[32:35]
v_mfma_f32_16x16x32_bf16 v[32:35], v[144:147], a[180:183], v[32:35]
s_add_u32 s72, s71, 46080
buffer_load_dwordx4 v15, s[24:27], s72 offen offset:3072 lds
v_mfma_f32_16x16x32_bf16 v[32:35], v[128:131], a[176:179], v[32:35]
s_nop 0
ds_read_b64_tr_b16 v[204:205], v11 offset:0
ds_read_b64_tr_b16 v[206:207], v11 offset:2048
v_mfma_f32_16x16x32_bf16 v[36:39], v[132:135], a[176:179], v[36:39]
s_nop 0
ds_read_b64_tr_b16 v[208:209], v8 offset:4096
ds_read_b64_tr_b16 v[210:211], v8 offset:6144
v_mfma_f32_16x16x32_bf16 v[36:39], v[148:151], a[180:183], v[36:39]
s_nop 0
ds_read_b64_tr_b16 v[212:213], v9 offset:4096
ds_read_b64_tr_b16 v[214:215], v9 offset:6144
v_mfma_f32_16x16x32_bf16 v[36:39], v[164:167], a[184:187], v[36:39]
v_mfma_f32_16x16x32_bf16 v[36:39], v[180:183], a[188:191], v[36:39]
s_nop 0
ds_read_b64_tr_b16 v[216:217], v10 offset:4096
ds_read_b64_tr_b16 v[218:219], v10 offset:6144
v_mfma_f32_16x16x32_bf16 v[20:23], v[180:183], a[172:175], v[20:23]
s_nop 0
ds_read_b64_tr_b16 v[220:221], v11 offset:4096
ds_read_b64_tr_b16 v[222:223], v11 offset:6144
v_mfma_f32_16x16x32_bf16 v[20:23], v[164:167], a[168:171], v[20:23]
v_mfma_f32_16x16x32_bf16 v[20:23], v[148:151], a[164:167], v[20:23]
s_xor_b32 s71, s14, 0x40180
ds_read_b64_tr_b16 v[224:225], v8 offset:8192
ds_read_b64_tr_b16 v[226:227], v8 offset:10240
v_mfma_f32_16x16x32_bf16 v[20:23], v[132:135], a[160:163], v[20:23]
s_add_u32 m0, s85, 32768
ds_read_b64_tr_b16 v[228:229], v9 offset:8192
ds_read_b64_tr_b16 v[230:231], v9 offset:10240
v_mfma_f32_16x16x32_bf16 v[24:27], v[136:139], a[160:163], v[24:27]
s_add_u32 s72, s71, 0
buffer_load_dwordx4 v15, s[24:27], s72 offen lds
v_mfma_f32_16x16x32_bf16 v[24:27], v[152:155], a[164:167], v[24:27]
s_nop 0
ds_read_b64_tr_b16 v[232:233], v10 offset:8192
ds_read_b64_tr_b16 v[234:235], v10 offset:10240
v_mfma_f32_16x16x32_bf16 v[24:27], v[168:171], a[168:171], v[24:27]
v_mfma_f32_16x16x32_bf16 v[24:27], v[184:187], a[172:175], v[24:27]
s_nop 0
ds_read_b64_tr_b16 v[236:237], v11 offset:8192
ds_read_b64_tr_b16 v[238:239], v11 offset:10240
v_mfma_f32_16x16x32_bf16 v[40:43], v[184:187], a[188:191], v[40:43]
s_nop 0
ds_read_b64_tr_b16 v[240:241], v8 offset:12288
ds_read_b64_tr_b16 v[242:243], v8 offset:14336
v_mfma_f32_16x16x32_bf16 v[40:43], v[168:171], a[184:187], v[40:43]
s_nop 0
ds_read_b64_tr_b16 v[244:245], v9 offset:12288
ds_read_b64_tr_b16 v[246:247], v9 offset:14336
v_mfma_f32_16x16x32_bf16 v[40:43], v[152:155], a[180:183], v[40:43]
s_add_u32 s72, s71, 15360
buffer_load_dwordx4 v15, s[24:27], s72 offen offset:1024 lds
v_mfma_f32_16x16x32_bf16 v[40:43], v[136:139], a[176:179], v[40:43]
v_mfma_f32_16x16x32_bf16 v[44:47], v[140:143], a[176:179], v[44:47]
s_nop 0
ds_read_b64_tr_b16 v[248:249], v10 offset:12288
ds_read_b64_tr_b16 v[250:251], v10 offset:14336
v_mfma_f32_16x16x32_bf16 v[44:47], v[156:159], a[180:183], v[44:47]
s_nop 0
ds_read_b64_tr_b16 v[252:253], v11 offset:12288
ds_read_b64_tr_b16 v[254:255], v11 offset:14336
v_mfma_f32_16x16x32_bf16 v[44:47], v[172:175], a[184:187], v[44:47]
v_mfma_f32_16x16x32_bf16 v[44:47], v[188:191], a[188:191], v[44:47]
v_mfma_f32_16x16x32_bf16 v[28:31], v[188:191], a[172:175], v[28:31]
s_add_u32 s72, s71, 30720
buffer_load_dwordx4 v15, s[24:27], s72 offen offset:2048 lds
v_mfma_f32_16x16x32_bf16 v[28:31], v[172:175], a[168:171], v[28:31]
v_mfma_f32_16x16x32_bf16 v[28:31], v[156:159], a[164:167], v[28:31]
s_waitcnt vmcnt(23) lgkmcnt(0)
v_mfma_f32_16x16x32_bf16 v[28:31], v[140:143], a[160:163], v[28:31]
s_barrier
v_mfma_f32_16x16x32_bf16 v[16:19], v[192:195], a[192:195], v[16:19]
s_nop 0
ds_read_b64_tr_b16 v[128:129], v8 offset:16384
ds_read_b64_tr_b16 v[130:131], v8 offset:18432
v_mfma_f32_16x16x32_bf16 v[16:19], v[208:211], a[196:199], v[16:19]
s_nop 0
ds_read_b64_tr_b16 v[132:133], v9 offset:16384
ds_read_b64_tr_b16 v[134:135], v9 offset:18432
v_mfma_f32_16x16x32_bf16 v[16:19], v[224:227], a[200:203], v[16:19]
s_add_u32 s72, s71, 46080
buffer_load_dwordx4 v15, s[24:27], s72 offen offset:3072 lds
v_mfma_f32_16x16x32_bf16 v[16:19], v[240:243], a[204:207], v[16:19]
s_nop 0
ds_read_b64_tr_b16 v[136:137], v10 offset:16384
ds_read_b64_tr_b16 v[138:139], v10 offset:18432
v_mfma_f32_16x16x32_bf16 v[32:35], v[240:243], a[220:223], v[32:35]
s_nop 0
ds_read_b64_tr_b16 v[140:141], v11 offset:16384
ds_read_b64_tr_b16 v[142:143], v11 offset:18432
v_mfma_f32_16x16x32_bf16 v[32:35], v[224:227], a[216:219], v[32:35]
v_mfma_f32_16x16x32_bf16 v[32:35], v[208:211], a[212:215], v[32:35]
s_nop 0
ds_read_b64_tr_b16 v[144:145], v8 offset:20480
ds_read_b64_tr_b16 v[146:147], v8 offset:22528
v_mfma_f32_16x16x32_bf16 v[32:35], v[192:195], a[208:211], v[32:35]
s_nop 0
ds_read_b64_tr_b16 v[148:149], v9 offset:20480
ds_read_b64_tr_b16 v[150:151], v9 offset:22528
v_mfma_f32_16x16x32_bf16 v[36:39], v[196:199], a[208:211], v[36:39]
s_nop 0
ds_read_b64_tr_b16 v[152:153], v10 offset:20480
ds_read_b64_tr_b16 v[154:155], v10 offset:22528
v_mfma_f32_16x16x32_bf16 v[36:39], v[212:215], a[212:215], v[36:39]
s_nop 0
ds_read_b64_tr_b16 v[156:157], v11 offset:20480
ds_read_b64_tr_b16 v[158:159], v11 offset:22528
v_mfma_f32_16x16x32_bf16 v[36:39], v[228:231], a[216:219], v[36:39]
v_mfma_f32_16x16x32_bf16 v[36:39], v[244:247], a[220:223], v[36:39]
s_add_u32 m0, s64, 147456
ds_read_b64_tr_b16 v[160:161], v8 offset:24576
ds_read_b64_tr_b16 v[162:163], v8 offset:26624
v_mfma_f32_16x16x32_bf16 v[20:23], v[244:247], a[204:207], v[20:23]
s_add_u32 s72, s73, 0
buffer_load_dwordx4 v112, s[44:47], s72 offen sc1 lds
v_mfma_f32_16x16x32_bf16 v[20:23], v[228:231], a[200:203], v[20:23]
s_nop 0
ds_read_b64_tr_b16 v[164:165], v9 offset:24576
ds_read_b64_tr_b16 v[166:167], v9 offset:26624
v_mfma_f32_16x16x32_bf16 v[20:23], v[212:215], a[196:199], v[20:23]
s_add_u32 s72, s73, 15360
buffer_load_dwordx4 v12, s[44:47], s72 offen offset:1024 sc1 lds
v_mfma_f32_16x16x32_bf16 v[20:23], v[196:199], a[192:195], v[20:23]
s_nop 0
ds_read_b64_tr_b16 v[168:169], v10 offset:24576
ds_read_b64_tr_b16 v[170:171], v10 offset:26624
v_mfma_f32_16x16x32_bf16 v[24:27], v[200:203], a[192:195], v[24:27]
s_nop 0
ds_read_b64_tr_b16 v[172:173], v11 offset:24576
ds_read_b64_tr_b16 v[174:175], v11 offset:26624
v_mfma_f32_16x16x32_bf16 v[24:27], v[216:219], a[196:199], v[24:27]
s_add_u32 s72, s73, 30720
buffer_load_dwordx4 v112, s[44:47], s72 offen offset:2048 sc1 lds
v_mfma_f32_16x16x32_bf16 v[24:27], v[232:235], a[200:203], v[24:27]
v_mfma_f32_16x16x32_bf16 v[24:27], v[248:251], a[204:207], v[24:27]
s_nop 0
ds_read_b64_tr_b16 v[176:177], v8 offset:28672
ds_read_b64_tr_b16 v[178:179], v8 offset:30720
v_mfma_f32_16x16x32_bf16 v[40:43], v[248:251], a[220:223], v[40:43]
s_add_u32 s72, s73, 46080
buffer_load_dwordx4 v12, s[44:47], s72 offen offset:3072 sc1 lds
v_mfma_f32_16x16x32_bf16 v[40:43], v[232:235], a[216:219], v[40:43]
s_xor_b32 s71, s15, 0x40180
ds_read_b64_tr_b16 v[180:181], v9 offset:28672
ds_read_b64_tr_b16 v[182:183], v9 offset:30720
v_mfma_f32_16x16x32_bf16 v[40:43], v[216:219], a[212:215], v[40:43]
s_add_u32 m0, s85, 49152
ds_read_b64_tr_b16 v[184:185], v10 offset:28672
ds_read_b64_tr_b16 v[186:187], v10 offset:30720
v_mfma_f32_16x16x32_bf16 v[40:43], v[200:203], a[208:211], v[40:43]
s_add_u32 s72, s71, 0
buffer_load_dwordx4 v15, s[24:27], s72 offen lds
v_mfma_f32_16x16x32_bf16 v[44:47], v[204:207], a[208:211], v[44:47]
s_nop 0
ds_read_b64_tr_b16 v[188:189], v11 offset:28672
ds_read_b64_tr_b16 v[190:191], v11 offset:30720
v_mfma_f32_16x16x32_bf16 v[44:47], v[220:223], a[212:215], v[44:47]
v_mfma_f32_16x16x32_bf16 v[44:47], v[236:239], a[216:219], v[44:47]
s_add_u32 s72, s71, 15360
buffer_load_dwordx4 v15, s[24:27], s72 offen offset:1024 lds
v_mfma_f32_16x16x32_bf16 v[44:47], v[252:255], a[220:223], v[44:47]
v_mfma_f32_16x16x32_bf16 v[28:31], v[252:255], a[204:207], v[28:31]
v_mfma_f32_16x16x32_bf16 v[28:31], v[236:239], a[200:203], v[28:31]
s_add_u32 s72, s71, 30720
buffer_load_dwordx4 v15, s[24:27], s72 offen offset:2048 lds
v_mfma_f32_16x16x32_bf16 v[28:31], v[220:223], a[196:199], v[28:31]
s_waitcnt vmcnt(12) lgkmcnt(0)
v_mfma_f32_16x16x32_bf16 v[28:31], v[204:207], a[192:195], v[28:31]
s_barrier
v_mfma_f32_16x16x32_bf16 v[16:19], v[128:131], a[224:227], v[16:19]
s_add_u32 s72, s71, 46080
buffer_load_dwordx4 v15, s[24:27], s72 offen offset:3072 lds
v_mfma_f32_16x16x32_bf16 v[16:19], v[144:147], a[228:231], v[16:19]
s_lshl_b32 s73, s75, 9
ds_read_b64_tr_b16 v[192:193], v8 offset:32768
ds_read_b64_tr_b16 v[194:195], v8 offset:34816
v_mfma_f32_16x16x32_bf16 v[16:19], v[160:163], a[232:235], v[16:19]
s_lshl_b32 s84, s58, 7
ds_read_b64_tr_b16 v[196:197], v9 offset:32768
ds_read_b64_tr_b16 v[198:199], v9 offset:34816
v_mfma_f32_16x16x32_bf16 v[16:19], v[176:179], a[236:239], v[16:19]
s_add_u32 s73, s73, s84
ds_read_b64_tr_b16 v[200:201], v10 offset:32768
ds_read_b64_tr_b16 v[202:203], v10 offset:34816
v_mfma_f32_16x16x32_bf16 v[20:23], v[180:183], a[236:239], v[20:23]
s_add_u32 s73, s73, 0x3800000
ds_read_b64_tr_b16 v[204:205], v11 offset:32768
ds_read_b64_tr_b16 v[206:207], v11 offset:34816
v_mfma_f32_16x16x32_bf16 v[20:23], v[164:167], a[232:235], v[20:23]
s_xor_b32 s71, s12, 0x0
buffer_load_dword v6, v113, s[44:47], s73 offen sc1
v_mfma_f32_16x16x32_bf16 v[20:23], v[148:151], a[228:231], v[20:23]
s_add_u32 m0, s77, 0
ds_read_b64_tr_b16 v[208:209], v8 offset:36864
ds_read_b64_tr_b16 v[210:211], v8 offset:38912
v_mfma_f32_16x16x32_bf16 v[20:23], v[132:135], a[224:227], v[20:23]
s_add_u32 s72, s71, 0
buffer_load_dwordx4 v15, s[24:27], s72 offen lds
v_mfma_f32_16x16x32_bf16 v[24:27], v[136:139], a[224:227], v[24:27]
s_nop 0
ds_read_b64_tr_b16 v[212:213], v9 offset:36864
ds_read_b64_tr_b16 v[214:215], v9 offset:38912
v_mfma_f32_16x16x32_bf16 v[24:27], v[152:155], a[228:231], v[24:27]
s_nop 0
ds_read_b64_tr_b16 v[216:217], v10 offset:36864
ds_read_b64_tr_b16 v[218:219], v10 offset:38912
v_mfma_f32_16x16x32_bf16 v[24:27], v[168:171], a[232:235], v[24:27]
buffer_load_dword v7, v113, s[44:47], s73 offen offset:64 sc1
v_mfma_f32_16x16x32_bf16 v[24:27], v[184:187], a[236:239], v[24:27]
s_nop 0
ds_read_b64_tr_b16 v[220:221], v11 offset:36864
ds_read_b64_tr_b16 v[222:223], v11 offset:38912
v_cvt_pk_bf16_f32 v16, v16, v17
v_mfma_f32_16x16x32_bf16 v[28:31], v[188:191], a[236:239], v[28:31]
s_nop 0
ds_read_b64_tr_b16 v[224:225], v8 offset:40960
ds_read_b64_tr_b16 v[226:227], v8 offset:43008
v_cvt_pk_bf16_f32 v17, v18, v19
v_mfma_f32_16x16x32_bf16 v[28:31], v[172:175], a[232:235], v[28:31]
s_add_u32 s72, s71, 15360
buffer_load_dwordx4 v15, s[24:27], s72 offen offset:1024 lds
v_cvt_pk_bf16_f32 v18, v20, v21
v_mfma_f32_16x16x32_bf16 v[28:31], v[156:159], a[228:231], v[28:31]
s_nop 0
ds_read_b64_tr_b16 v[228:229], v9 offset:40960
ds_read_b64_tr_b16 v[230:231], v9 offset:43008
v_cvt_pk_bf16_f32 v19, v22, v23
v_mfma_f32_16x16x32_bf16 v[28:31], v[140:143], a[224:227], v[28:31]
v_mfma_f32_16x16x32_bf16 v[32:35], v[128:131], a[240:243], v[32:35]
s_xor_b32 s80, s93, 0x80000
ds_read_b64_tr_b16 v[232:233], v10 offset:40960
ds_read_b64_tr_b16 v[234:235], v10 offset:43008
v_mfma_f32_16x16x32_bf16 v[32:35], v[144:147], a[244:247], v[32:35]
s_add_u32 s80, s80, 0x3a00000
buffer_store_dwordx4 v[16:19], v1, s[44:47], s80 offen sc1
v_mfma_f32_16x16x32_bf16 v[32:35], v[160:163], a[248:251], v[32:35]
s_nop 0
ds_read_b64_tr_b16 v[236:237], v11 offset:40960
ds_read_b64_tr_b16 v[238:239], v11 offset:43008
v_mfma_f32_16x16x32_bf16 v[32:35], v[176:179], a[252:255], v[32:35]
s_add_u32 s72, s71, 30720
buffer_load_dwordx4 v15, s[24:27], s72 offen offset:2048 lds
v_cvt_pk_bf16_f32 v20, v24, v25
v_mfma_f32_16x16x32_bf16 v[36:39], v[180:183], a[252:255], v[36:39]
s_nop 0
ds_read_b64_tr_b16 v[240:241], v8 offset:45056
ds_read_b64_tr_b16 v[242:243], v8 offset:47104
v_cvt_pk_bf16_f32 v21, v26, v27
v_mfma_f32_16x16x32_bf16 v[36:39], v[164:167], a[248:251], v[36:39]
v_cvt_pk_bf16_f32 v22, v28, v29
v_cvt_pk_bf16_f32 v23, v30, v31
v_mfma_f32_16x16x32_bf16 v[36:39], v[148:151], a[244:247], v[36:39]
s_nop 0
ds_read_b64_tr_b16 v[244:245], v9 offset:45056
ds_read_b64_tr_b16 v[246:247], v9 offset:47104
v_mfma_f32_16x16x32_bf16 v[36:39], v[132:135], a[240:243], v[36:39]
s_nop 0
ds_read_b64_tr_b16 v[248:249], v10 offset:45056
ds_read_b64_tr_b16 v[250:251], v10 offset:47104
v_mfma_f32_16x16x32_bf16 v[40:43], v[136:139], a[240:243], v[40:43]
s_nop 0
ds_read_b64_tr_b16 v[252:253], v11 offset:45056
ds_read_b64_tr_b16 v[254:255], v11 offset:47104
v_mfma_f32_16x16x32_bf16 v[40:43], v[152:155], a[244:247], v[40:43]
s_add_u32 s72, s71, 46080
buffer_load_dwordx4 v15, s[24:27], s72 offen offset:3072 lds
v_mfma_f32_16x16x32_bf16 v[40:43], v[168:171], a[248:251], v[40:43]
v_mfma_f32_16x16x32_bf16 v[40:43], v[184:187], a[252:255], v[40:43]
v_cvt_pk_bf16_f32 v24, v32, v33
v_cvt_pk_bf16_f32 v25, v34, v35
v_cvt_pk_bf16_f32 v26, v36, v37
v_mfma_f32_16x16x32_bf16 v[44:47], v[188:191], a[252:255], v[44:47]
v_cvt_pk_bf16_f32 v27, v38, v39
v_mfma_f32_16x16x32_bf16 v[44:47], v[172:175], a[248:251], v[44:47]
v_mfma_f32_16x16x32_bf16 v[44:47], v[156:159], a[244:247], v[44:47]
s_waitcnt vmcnt(33) lgkmcnt(0)
v_mfma_f32_16x16x32_bf16 v[44:47], v[140:143], a[240:243], v[44:47]
s_barrier
v_mfma_f32_16x16x32_bf16 v[48:51], v[192:195], a[160:163], v[48:51]
s_nop 0
ds_read_b64_tr_b16 v[128:129], v8 offset:49152
ds_read_b64_tr_b16 v[130:131], v8 offset:51200
v_mfma_f32_16x16x32_bf16 v[48:51], v[208:211], a[164:167], v[48:51]
s_xor_b32 s71, s13, 0x0
buffer_store_dwordx4 v[20:23], v1, s[44:47], s80 offen offset:1024 sc1
v_mfma_f32_16x16x32_bf16 v[48:51], v[224:227], a[168:171], v[48:51]
s_add_u32 m0, s77, 16384
ds_read_b64_tr_b16 v[132:133], v9 offset:49152
ds_read_b64_tr_b16 v[134:135], v9 offset:51200
v_mfma_f32_16x16x32_bf16 v[48:51], v[240:243], a[172:175], v[48:51]
s_add_u32 s72, s71, 0
buffer_load_dwordx4 v15, s[24:27], s72 offen lds
v_cvt_pk_bf16_f32 v28, v40, v41
v_mfma_f32_16x16x32_bf16 v[64:67], v[240:243], a[188:191], v[64:67]
s_nop 0
ds_read_b64_tr_b16 v[136:137], v10 offset:49152
ds_read_b64_tr_b16 v[138:139], v10 offset:51200
v_cvt_pk_bf16_f32 v29, v42, v43
v_mfma_f32_16x16x32_bf16 v[64:67], v[224:227], a[184:187], v[64:67]
s_nop 0
ds_read_b64_tr_b16 v[140:141], v11 offset:49152
ds_read_b64_tr_b16 v[142:143], v11 offset:51200
v_cvt_pk_bf16_f32 v30, v44, v45
v_mfma_f32_16x16x32_bf16 v[64:67], v[208:211], a[180:183], v[64:67]
v_cvt_pk_bf16_f32 v31, v46, v47
v_mfma_f32_16x16x32_bf16 v[64:67], v[192:195], a[176:179], v[64:67]
s_nop 0
ds_read_b64_tr_b16 v[144:145], v8 offset:53248
ds_read_b64_tr_b16 v[146:147], v8 offset:55296
v_mfma_f32_16x16x32_bf16 v[68:71], v[196:199], a[176:179], v[68:71]
s_add_u32 s72, s71, 15360
buffer_load_dwordx4 v15, s[24:27], s72 offen offset:1024 lds
v_mfma_f32_16x16x32_bf16 v[68:71], v[212:215], a[180:183], v[68:71]
s_nop 0
ds_read_b64_tr_b16 v[148:149], v9 offset:53248
ds_read_b64_tr_b16 v[150:151], v9 offset:55296
v_mfma_f32_16x16x32_bf16 v[68:71], v[228:231], a[184:187], v[68:71]
s_nop 0
ds_read_b64_tr_b16 v[152:153], v10 offset:53248
ds_read_b64_tr_b16 v[154:155], v10 offset:55296
v_mfma_f32_16x16x32_bf16 v[68:71], v[244:247], a[188:191], v[68:71]
v_mfma_f32_16x16x32_bf16 v[52:55], v[244:247], a[172:175], v[52:55]
s_nop 0
ds_read_b64_tr_b16 v[156:157], v11 offset:53248
ds_read_b64_tr_b16 v[158:159], v11 offset:55296
v_mfma_f32_16x16x32_bf16 v[52:55], v[228:231], a[168:171], v[52:55]
s_nop 0
ds_read_b64_tr_b16 v[160:161], v8 offset:57344
ds_read_b64_tr_b16 v[162:163], v8 offset:59392
v_mfma_f32_16x16x32_bf16 v[52:55], v[212:215], a[164:167], v[52:55]
s_add_u32 s72, s71, 30720
buffer_load_dwordx4 v15, s[24:27], s72 offen offset:2048 lds
v_mfma_f32_16x16x32_bf16 v[52:55], v[196:199], a[160:163], v[52:55]
s_nop 0
ds_read_b64_tr_b16 v[164:165], v9 offset:57344
ds_read_b64_tr_b16 v[166:167], v9 offset:59392
v_mfma_f32_16x16x32_bf16 v[56:59], v[200:203], a[160:163], v[56:59]
v_mfma_f32_16x16x32_bf16 v[56:59], v[216:219], a[164:167], v[56:59]
buffer_store_dwordx4 v[24:27], v1, s[44:47], s80 offen offset:2048 sc1
v_mfma_f32_16x16x32_bf16 v[56:59], v[232:235], a[168:171], v[56:59]
s_nop 0
ds_read_b64_tr_b16 v[168:169], v10 offset:57344
ds_read_b64_tr_b16 v[170:171], v10 offset:59392
v_mfma_f32_16x16x32_bf16 v[56:59], v[248:251], a[172:175], v[56:59]
s_nop 0
ds_read_b64_tr_b16 v[172:173], v11 offset:57344
ds_read_b64_tr_b16 v[174:175], v11 offset:59392
v_mfma_f32_16x16x32_bf16 v[72:75], v[248:251], a[188:191], v[72:75]
s_add_u32 s72, s71, 46080
buffer_load_dwordx4 v15, s[24:27], s72 offen offset:3072 lds
v_mfma_f32_16x16x32_bf16 v[72:75], v[232:235], a[184:187], v[72:75]
s_nop 0
ds_read_b64_tr_b16 v[176:177], v8 offset:61440
ds_read_b64_tr_b16 v[178:179], v8 offset:63488
v_mfma_f32_16x16x32_bf16 v[72:75], v[216:219], a[180:183], v[72:75]
v_mfma_f32_16x16x32_bf16 v[72:75], v[200:203], a[176:179], v[72:75]
s_nop 0
ds_read_b64_tr_b16 v[180:181], v9 offset:61440
ds_read_b64_tr_b16 v[182:183], v9 offset:63488
v_mfma_f32_16x16x32_bf16 v[76:79], v[204:207], a[176:179], v[76:79]
s_nop 0
ds_read_b64_tr_b16 v[184:185], v10 offset:61440
ds_read_b64_tr_b16 v[186:187], v10 offset:63488
v_mfma_f32_16x16x32_bf16 v[76:79], v[220:223], a[180:183], v[76:79]
s_nop 0
ds_read_b64_tr_b16 v[188:189], v11 offset:61440
ds_read_b64_tr_b16 v[190:191], v11 offset:63488
v_mfma_f32_16x16x32_bf16 v[76:79], v[236:239], a[184:187], v[76:79]
v_mfma_f32_16x16x32_bf16 v[76:79], v[252:255], a[188:191], v[76:79]
s_xor_b32 s71, s14, 0x0
v_mfma_f32_16x16x32_bf16 v[60:63], v[252:255], a[172:175], v[60:63]
s_add_u32 m0, s77, 32768
v_xor_b32 v8, 0x10000, v8
v_mfma_f32_16x16x32_bf16 v[60:63], v[236:239], a[168:171], v[60:63]
s_add_u32 s72, s71, 0
v_xor_b32 v9, 0x10000, v9
v_mfma_f32_16x16x32_bf16 v[60:63], v[220:223], a[164:167], v[60:63]
s_waitcnt vmcnt(32) lgkmcnt(0)
buffer_load_dwordx4 v15, s[24:27], s72 offen lds
v_xor_b32 v10, 0x10000, v10
v_mfma_f32_16x16x32_bf16 v[60:63], v[204:207], a[160:163], v[60:63]
s_barrier
v_xor_b32 v11, 0x10000, v11
v_mfma_f32_16x16x32_bf16 v[48:51], v[128:131], a[192:195], v[48:51]
s_nop 0
ds_read_b64_tr_b16 v[192:193], v8 offset:0
ds_read_b64_tr_b16 v[194:195], v8 offset:2048
v_mfma_f32_16x16x32_bf16 v[48:51], v[144:147], a[196:199], v[48:51]
buffer_store_dwordx4 v[28:31], v1, s[44:47], s80 offen offset:3072 sc1
v_mfma_f32_16x16x32_bf16 v[48:51], v[160:163], a[200:203], v[48:51]
s_nop 0
ds_read_b64_tr_b16 v[196:197], v9 offset:0
ds_read_b64_tr_b16 v[198:199], v9 offset:2048
v_mfma_f32_16x16x32_bf16 v[48:51], v[176:179], a[204:207], v[48:51]
s_add_u32 s72, s71, 15360
buffer_load_dwordx4 v15, s[24:27], s72 offen offset:1024 lds
v_mfma_f32_16x16x32_bf16 v[64:67], v[176:179], a[220:223], v[64:67]
s_nop 0
ds_read_b64_tr_b16 v[200:201], v10 offset:0
ds_read_b64_tr_b16 v[202:203], v10 offset:2048
v_mfma_f32_16x16x32_bf16 v[64:67], v[160:163], a[216:219], v[64:67]
v_mfma_f32_16x16x32_bf16 v[64:67], v[144:147], a[212:215], v[64:67]
s_nop 0
ds_read_b64_tr_b16 v[204:205], v11 offset:0
ds_read_b64_tr_b16 v[206:207], v11 offset:2048
v_mfma_f32_16x16x32_bf16 v[64:67], v[128:131], a[208:211], v[64:67]
s_nop 0
ds_read_b64_tr_b16 v[208:209], v8 offset:4096
ds_read_b64_tr_b16 v[210:211], v8 offset:6144
v_mfma_f32_16x16x32_bf16 v[68:71], v[132:135], a[208:211], v[68:71]
s_nop 0
ds_read_b64_tr_b16 v[212:213], v9 offset:4096
ds_read_b64_tr_b16 v[214:215], v9 offset:6144
v_mfma_f32_16x16x32_bf16 v[68:71], v[148:151], a[212:215], v[68:71]
s_add_u32 s72, s71, 30720
buffer_load_dwordx4 v15, s[24:27], s72 offen offset:2048 lds
v_mfma_f32_16x16x32_bf16 v[68:71], v[164:167], a[216:219], v[68:71]
v_mfma_f32_16x16x32_bf16 v[68:71], v[180:183], a[220:223], v[68:71]
s_nop 0
ds_read_b64_tr_b16 v[216:217], v10 offset:4096
ds_read_b64_tr_b16 v[218:219], v10 offset:6144
v_mfma_f32_16x16x32_bf16 v[52:55], v[180:183], a[204:207], v[52:55]
s_nop 0
ds_read_b64_tr_b16 v[220:221], v11 offset:4096
ds_read_b64_tr_b16 v[222:223], v11 offset:6144
v_mfma_f32_16x16x32_bf16 v[52:55], v[164:167], a[200:203], v[52:55]
v_mfma_f32_16x16x32_bf16 v[52:55], v[148:151], a[196:199], v[52:55]
s_nop 0
ds_read_b64_tr_b16 v[224:225], v8 offset:8192
ds_read_b64_tr_b16 v[226:227], v8 offset:10240
v_mfma_f32_16x16x32_bf16 v[52:55], v[132:135], a[192:195], v[52:55]
s_add_u32 s72, s71, 46080
buffer_load_dwordx4 v15, s[24:27], s72 offen offset:3072 lds
v_mfma_f32_16x16x32_bf16 v[56:59], v[136:139], a[192:195], v[56:59]
s_nop 0
ds_read_b64_tr_b16 v[228:229], v9 offset:8192
ds_read_b64_tr_b16 v[230:231], v9 offset:10240
v_mfma_f32_16x16x32_bf16 v[56:59], v[152:155], a[196:199], v[56:59]
s_nop 0
ds_read_b64_tr_b16 v[232:233], v10 offset:8192
ds_read_b64_tr_b16 v[234:235], v10 offset:10240
v_mfma_f32_16x16x32_bf16 v[56:59], v[168:171], a[200:203], v[56:59]
v_mfma_f32_16x16x32_bf16 v[56:59], v[184:187], a[204:207], v[56:59]
s_nop 0
ds_read_b64_tr_b16 v[236:237], v11 offset:8192
ds_read_b64_tr_b16 v[238:239], v11 offset:10240
v_mfma_f32_16x16x32_bf16 v[72:75], v[184:187], a[220:223], v[72:75]
s_nop 0
ds_read_b64_tr_b16 v[240:241], v8 offset:12288
ds_read_b64_tr_b16 v[242:243], v8 offset:14336
v_mfma_f32_16x16x32_bf16 v[72:75], v[168:171], a[216:219], v[72:75]
s_nop 0
ds_read_b64_tr_b16 v[244:245], v9 offset:12288
ds_read_b64_tr_b16 v[246:247], v9 offset:14336
v_mfma_f32_16x16x32_bf16 v[72:75], v[152:155], a[212:215], v[72:75]
Lstube3:
s_cbranch_execz Lrete
v_mfma_f32_16x16x32_bf16 v[72:75], v[136:139], a[208:211], v[72:75]
s_xor_b32 s71, s15, 0x0
ds_read_b64_tr_b16 v[248:249], v10 offset:12288
ds_read_b64_tr_b16 v[250:251], v10 offset:14336
v_mfma_f32_16x16x32_bf16 v[76:79], v[140:143], a[208:211], v[76:79]
s_add_u32 m0, s77, 49152
ds_read_b64_tr_b16 v[252:253], v11 offset:12288
ds_read_b64_tr_b16 v[254:255], v11 offset:14336
v_mfma_f32_16x16x32_bf16 v[76:79], v[156:159], a[212:215], v[76:79]
s_add_u32 s72, s71, 0
buffer_load_dwordx4 v15, s[24:27], s72 offen lds
v_mfma_f32_16x16x32_bf16 v[76:79], v[172:175], a[216:219], v[76:79]
v_mfma_f32_16x16x32_bf16 v[76:79], v[188:191], a[220:223], v[76:79]
v_mfma_f32_16x16x32_bf16 v[60:63], v[188:191], a[204:207], v[60:63]
v_mfma_f32_16x16x32_bf16 v[60:63], v[172:175], a[200:203], v[60:63]
s_add_u32 s72, s71, 15360
v_mfma_f32_16x16x32_bf16 v[60:63], v[156:159], a[196:199], v[60:63]
s_waitcnt vmcnt(31) lgkmcnt(0)
v_mfma_f32_16x16x32_bf16 v[60:63], v[140:143], a[192:195], v[60:63]
s_barrier
buffer_load_dwordx4 v15, s[24:27], s72 offen offset:1024 lds
v_mfma_f32_16x16x32_bf16 v[48:51], v[192:195], a[224:227], v[48:51]
s_nop 0
ds_read_b64_tr_b16 v[128:129], v8 offset:16384
ds_read_b64_tr_b16 v[130:131], v8 offset:18432
v_mfma_f32_16x16x32_bf16 v[48:51], v[208:211], a[228:231], v[48:51]
s_nop 0
ds_read_b64_tr_b16 v[132:133], v9 offset:16384
ds_read_b64_tr_b16 v[134:135], v9 offset:18432
v_mfma_f32_16x16x32_bf16 v[48:51], v[224:227], a[232:235], v[48:51]
s_nop 0
ds_read_b64_tr_b16 v[136:137], v10 offset:16384
ds_read_b64_tr_b16 v[138:139], v10 offset:18432
v_mfma_f32_16x16x32_bf16 v[48:51], v[240:243], a[236:239], v[48:51]
v_mfma_f32_16x16x32_bf16 v[52:55], v[244:247], a[236:239], v[52:55]
s_nop 0
ds_read_b64_tr_b16 v[140:141], v11 offset:16384
ds_read_b64_tr_b16 v[142:143], v11 offset:18432
v_mfma_f32_16x16x32_bf16 v[52:55], v[228:231], a[232:235], v[52:55]
s_add_u32 s72, s71, 30720
buffer_load_dwordx4 v15, s[24:27], s72 offen offset:2048 lds
v_mfma_f32_16x16x32_bf16 v[52:55], v[212:215], a[228:231], v[52:55]
s_nop 0
ds_read_b64_tr_b16 v[144:145], v8 offset:20480
ds_read_b64_tr_b16 v[146:147], v8 offset:22528
v_mfma_f32_16x16x32_bf16 v[52:55], v[196:199], a[224:227], v[52:55]
s_nop 0
ds_read_b64_tr_b16 v[148:149], v9 offset:20480
ds_read_b64_tr_b16 v[150:151], v9 offset:22528
v_mfma_f32_16x16x32_bf16 v[56:59], v[200:203], a[224:227], v[56:59]
v_mfma_f32_16x16x32_bf16 v[56:59], v[216:219], a[228:231], v[56:59]
s_nop 0
ds_read_b64_tr_b16 v[152:153], v10 offset:20480
ds_read_b64_tr_b16 v[154:155], v10 offset:22528
v_mfma_f32_16x16x32_bf16 v[56:59], v[232:235], a[232:235], v[56:59]
s_nop 0
ds_read_b64_tr_b16 v[156:157], v11 offset:20480
ds_read_b64_tr_b16 v[158:159], v11 offset:22528
v_mfma_f32_16x16x32_bf16 v[56:59], v[248:251], a[236:239], v[56:59]
s_add_u32 s72, s71, 46080
buffer_load_dwordx4 v15, s[24:27], s72 offen offset:3072 lds
v_cvt_pk_bf16_f32 v48, v48, v49
v_mfma_f32_16x16x32_bf16 v[60:63], v[252:255], a[236:239], v[60:63]
v_cvt_pk_bf16_f32 v49, v50, v51
v_cvt_pk_bf16_f32 v50, v52, v53
v_cvt_pk_bf16_f32 v51, v54, v55
v_mfma_f32_16x16x32_bf16 v[60:63], v[236:239], a[232:235], v[60:63]
s_nop 0
ds_read_b64_tr_b16 v[160:161], v8 offset:24576
ds_read_b64_tr_b16 v[162:163], v8 offset:26624
v_mfma_f32_16x16x32_bf16 v[60:63], v[220:223], a[228:231], v[60:63]
s_nop 0
ds_read_b64_tr_b16 v[164:165], v9 offset:24576
ds_read_b64_tr_b16 v[166:167], v9 offset:26624
v_mfma_f32_16x16x32_bf16 v[60:63], v[204:207], a[224:227], v[60:63]
s_nop 0
ds_read_b64_tr_b16 v[168:169], v10 offset:24576
ds_read_b64_tr_b16 v[170:171], v10 offset:26624
v_mfma_f32_16x16x32_bf16 v[64:67], v[192:195], a[240:243], v[64:67]
s_xor_b32 s80, s93, 0x100000
v_mfma_f32_16x16x32_bf16 v[64:67], v[208:211], a[244:247], v[64:67]
s_add_u32 s80, s80, 0x3e00000
buffer_store_dwordx4 v[48:51], v1, s[44:47], s80 offen sc1
v_mfma_f32_16x16x32_bf16 v[64:67], v[224:227], a[248:251], v[64:67]
s_nop 0
ds_read_b64_tr_b16 v[172:173], v11 offset:24576
ds_read_b64_tr_b16 v[174:175], v11 offset:26624
v_mfma_f32_16x16x32_bf16 v[64:67], v[240:243], a[252:255], v[64:67]
s_xor_b32 s71, s12, 0x40000
ds_read_b64_tr_b16 v[176:177], v8 offset:28672
ds_read_b64_tr_b16 v[178:179], v8 offset:30720
v_cvt_pk_bf16_f32 v52, v56, v57
v_mfma_f32_16x16x32_bf16 v[68:71], v[244:247], a[252:255], v[68:71]
s_add_u32 m0, s85, 0
ds_read_b64_tr_b16 v[180:181], v9 offset:28672
ds_read_b64_tr_b16 v[182:183], v9 offset:30720
v_cvt_pk_bf16_f32 v53, v58, v59
v_mfma_f32_16x16x32_bf16 v[68:71], v[228:231], a[248:251], v[68:71]
s_add_u32 s72, s71, 0
buffer_load_dwordx4 v15, s[24:27], s72 offen lds
v_cvt_pk_bf16_f32 v54, v60, v61
v_mfma_f32_16x16x32_bf16 v[68:71], v[212:215], a[244:247], v[68:71]
v_cvt_pk_bf16_f32 v55, v62, v63
v_mfma_f32_16x16x32_bf16 v[68:71], v[196:199], a[240:243], v[68:71]
s_nop 0
ds_read_b64_tr_b16 v[184:185], v10 offset:28672
ds_read_b64_tr_b16 v[186:187], v10 offset:30720
v_mfma_f32_16x16x32_bf16 v[72:75], v[200:203], a[240:243], v[72:75]
s_nop 0
ds_read_b64_tr_b16 v[188:189], v11 offset:28672
ds_read_b64_tr_b16 v[190:191], v11 offset:30720
v_mfma_f32_16x16x32_bf16 v[72:75], v[216:219], a[244:247], v[72:75]
v_mfma_f32_16x16x32_bf16 v[72:75], v[232:235], a[248:251], v[72:75]
s_add_u32 s72, s71, 15360
buffer_load_dwordx4 v15, s[24:27], s72 offen offset:1024 lds
v_mfma_f32_16x16x32_bf16 v[72:75], v[248:251], a[252:255], v[72:75]
v_cvt_pk_bf16_f32 v56, v64, v65
v_cvt_pk_bf16_f32 v57, v66, v67
v_cvt_pk_bf16_f32 v58, v68, v69
v_mfma_f32_16x16x32_bf16 v[76:79], v[252:255], a[252:255], v[76:79]
v_cvt_pk_bf16_f32 v59, v70, v71
v_mfma_f32_16x16x32_bf16 v[76:79], v[236:239], a[248:251], v[76:79]
v_mfma_f32_16x16x32_bf16 v[76:79], v[220:223], a[244:247], v[76:79]
s_waitcnt vmcnt(29) lgkmcnt(0)
v_mfma_f32_16x16x32_bf16 v[76:79], v[204:207], a[240:243], v[76:79]
s_barrier
v_mfma_f32_16x16x32_bf16 v[80:83], v[128:131], a[160:163], v[80:83]
s_add_u32 s72, s71, 30720
buffer_load_dwordx4 v15, s[24:27], s72 offen offset:2048 lds
v_mfma_f32_16x16x32_bf16 v[80:83], v[144:147], a[164:167], v[80:83]
s_waitcnt vmcnt(23)
buffer_store_dwordx4 v[52:55], v1, s[44:47], s80 offen offset:1024 sc1
v_mfma_f32_16x16x32_bf16 v[80:83], v[160:163], a[168:171], v[80:83]
s_nop 0
ds_read_b64_tr_b16 v[192:193], v8 offset:32768
ds_read_b64_tr_b16 v[194:195], v8 offset:34816
v_mfma_f32_16x16x32_bf16 v[80:83], v[176:179], a[172:175], v[80:83]
s_nop 0
ds_read_b64_tr_b16 v[196:197], v9 offset:32768
ds_read_b64_tr_b16 v[198:199], v9 offset:34816
v_cvt_pk_bf16_f32 v60, v72, v73
v_mfma_f32_16x16x32_bf16 v[96:99], v[176:179], a[188:191], v[96:99]
s_nop 0
ds_read_b64_tr_b16 v[200:201], v10 offset:32768
ds_read_b64_tr_b16 v[202:203], v10 offset:34816
v_cvt_pk_bf16_f32 v61, v74, v75
v_mfma_f32_16x16x32_bf16 v[96:99], v[160:163], a[184:187], v[96:99]
s_nop 0
ds_read_b64_tr_b16 v[204:205], v11 offset:32768
ds_read_b64_tr_b16 v[206:207], v11 offset:34816
v_cvt_pk_bf16_f32 v62, v76, v77
v_mfma_f32_16x16x32_bf16 v[96:99], v[144:147], a[180:183], v[96:99]
s_add_u32 s72, s71, 46080
buffer_load_dwordx4 v15, s[24:27], s72 offen offset:3072 lds
v_cvt_pk_bf16_f32 v63, v78, v79
v_mfma_f32_16x16x32_bf16 v[96:99], v[128:131], a[176:179], v[96:99]
v_sub_f32 v112, 1.0, v6
v_sub_f32 v113, 1.0, v7
v_mfma_f32_16x16x32_bf16 v[100:103], v[132:135], a[176:179], v[100:103]
s_nop 0
ds_read_b64_tr_b16 v[208:209], v8 offset:36864
ds_read_b64_tr_b16 v[210:211], v8 offset:38912
v_mfma_f32_16x16x32_bf16 v[100:103], v[148:151], a[180:183], v[100:103]
s_nop 0
ds_read_b64_tr_b16 v[212:213], v9 offset:36864
ds_read_b64_tr_b16 v[214:215], v9 offset:38912
v_mfma_f32_16x16x32_bf16 v[100:103], v[164:167], a[184:187], v[100:103]
s_nop 0
ds_read_b64_tr_b16 v[216:217], v10 offset:36864
ds_read_b64_tr_b16 v[218:219], v10 offset:38912
v_mfma_f32_16x16x32_bf16 v[100:103], v[180:183], a[188:191], v[100:103]
v_mfma_f32_16x16x32_bf16 v[84:87], v[180:183], a[172:175], v[84:87]
s_nop 0
ds_read_b64_tr_b16 v[220:221], v11 offset:36864
ds_read_b64_tr_b16 v[222:223], v11 offset:38912
v_mfma_f32_16x16x32_bf16 v[84:87], v[164:167], a[168:171], v[84:87]
s_nop 0
ds_read_b64_tr_b16 v[224:225], v8 offset:40960
ds_read_b64_tr_b16 v[226:227], v8 offset:43008
v_mfma_f32_16x16x32_bf16 v[84:87], v[148:151], a[164:167], v[84:87]
s_xor_b32 s71, s13, 0x40000
ds_read_b64_tr_b16 v[228:229], v9 offset:40960
ds_read_b64_tr_b16 v[230:231], v9 offset:43008
v_mfma_f32_16x16x32_bf16 v[84:87], v[132:135], a[160:163], v[84:87]
s_add_u32 m0, s85, 16384
v_mfma_f32_16x16x32_bf16 v[88:91], v[136:139], a[160:163], v[88:91]
s_add_u32 s72, s71, 0
buffer_load_dwordx4 v15, s[24:27], s72 offen lds
v_mfma_f32_16x16x32_bf16 v[88:91], v[152:155], a[164:167], v[88:91]
buffer_store_dwordx4 v[56:59], v1, s[44:47], s80 offen offset:2048 sc1
v_mfma_f32_16x16x32_bf16 v[88:91], v[168:171], a[168:171], v[88:91]
s_nop 0
ds_read_b64_tr_b16 v[232:233], v10 offset:40960
ds_read_b64_tr_b16 v[234:235], v10 offset:43008
v_mfma_f32_16x16x32_bf16 v[88:91], v[184:187], a[172:175], v[88:91]
s_nop 0
ds_read_b64_tr_b16 v[236:237], v11 offset:40960
ds_read_b64_tr_b16 v[238:239], v11 offset:43008
v_mfma_f32_16x16x32_bf16 v[104:107], v[184:187], a[188:191], v[104:107]
s_nop 0
ds_read_b64_tr_b16 v[240:241], v8 offset:45056
ds_read_b64_tr_b16 v[242:243], v8 offset:47104
v_mfma_f32_16x16x32_bf16 v[104:107], v[168:171], a[184:187], v[104:107]
v_mfma_f32_16x16x32_bf16 v[104:107], v[152:155], a[180:183], v[104:107]
s_add_u32 s72, s71, 15360
buffer_load_dwordx4 v15, s[24:27], s72 offen offset:1024 lds
v_mfma_f32_16x16x32_bf16 v[104:107], v[136:139], a[176:179], v[104:107]
s_nop 0
ds_read_b64_tr_b16 v[244:245], v9 offset:45056
ds_read_b64_tr_b16 v[246:247], v9 offset:47104
v_mfma_f32_16x16x32_bf16 v[108:111], v[140:143], a[176:179], v[108:111]
s_nop 0
ds_read_b64_tr_b16 v[248:249], v10 offset:45056
ds_read_b64_tr_b16 v[250:251], v10 offset:47104
v_mfma_f32_16x16x32_bf16 v[108:111], v[156:159], a[180:183], v[108:111]
s_nop 0
ds_read_b64_tr_b16 v[252:253], v11 offset:45056
ds_read_b64_tr_b16 v[254:255], v11 offset:47104
v_mfma_f32_16x16x32_bf16 v[108:111], v[172:175], a[184:187], v[108:111]
v_mfma_f32_16x16x32_bf16 v[108:111], v[188:191], a[188:191], v[108:111]
v_mfma_f32_16x16x32_bf16 v[92:95], v[188:191], a[172:175], v[92:95]
s_add_u32 s72, s71, 30720
buffer_load_dwordx4 v15, s[24:27], s72 offen offset:2048 lds
v_mfma_f32_16x16x32_bf16 v[92:95], v[172:175], a[168:171], v[92:95]
v_mfma_f32_16x16x32_bf16 v[92:95], v[156:159], a[164:167], v[92:95]
s_waitcnt vmcnt(32) lgkmcnt(0)
v_mfma_f32_16x16x32_bf16 v[92:95], v[140:143], a[160:163], v[92:95]
s_barrier
v_mfma_f32_16x16x32_bf16 v[80:83], v[192:195], a[192:195], v[80:83]
s_nop 0
ds_read_b64_tr_b16 v[128:129], v8 offset:49152
ds_read_b64_tr_b16 v[130:131], v8 offset:51200
v_mfma_f32_16x16x32_bf16 v[80:83], v[208:211], a[196:199], v[80:83]
buffer_store_dwordx4 v[60:63], v1, s[44:47], s80 offen offset:3072 sc1
v_mfma_f32_16x16x32_bf16 v[80:83], v[224:227], a[200:203], v[80:83]
s_add_u32 s72, s71, 46080
buffer_load_dwordx4 v15, s[24:27], s72 offen offset:3072 lds
v_mfma_f32_16x16x32_bf16 v[80:83], v[240:243], a[204:207], v[80:83]
s_nop 0
ds_read_b64_tr_b16 v[132:133], v9 offset:49152
ds_read_b64_tr_b16 v[134:135], v9 offset:51200
v_mfma_f32_16x16x32_bf16 v[96:99], v[240:243], a[220:223], v[96:99]
s_nop 0
ds_read_b64_tr_b16 v[136:137], v10 offset:49152
ds_read_b64_tr_b16 v[138:139], v10 offset:51200
v_mfma_f32_16x16x32_bf16 v[96:99], v[224:227], a[216:219], v[96:99]
s_nop 0
ds_read_b64 v[48:49], v116 offset:0
ds_read_b64_tr_b16 v[64:65], v5 offset:0
v_mfma_f32_16x16x32_bf16 v[96:99], v[208:211], a[212:215], v[96:99]
s_nop 0
ds_read_b64_tr_b16 v[140:141], v11 offset:49152
ds_read_b64_tr_b16 v[142:143], v11 offset:51200
v_mfma_f32_16x16x32_bf16 v[96:99], v[192:195], a[208:211], v[96:99]
s_nop 0
ds_read_b64_tr_b16 v[144:145], v8 offset:53248
ds_read_b64_tr_b16 v[146:147], v8 offset:55296
v_mfma_f32_16x16x32_bf16 v[100:103], v[196:199], a[208:211], v[100:103]
s_nop 0
ds_read_b64_tr_b16 v[148:149], v9 offset:53248
ds_read_b64_tr_b16 v[150:151], v9 offset:55296
v_mfma_f32_16x16x32_bf16 v[100:103], v[212:215], a[212:215], v[100:103]
s_nop 0
ds_read_b64 v[50:51], v117 offset:0
ds_read_b64_tr_b16 v[66:67], v5 offset:4096
v_mfma_f32_16x16x32_bf16 v[100:103], v[228:231], a[216:219], v[100:103]
s_xor_b32 s71, s14, 0x40000
ds_read_b64_tr_b16 v[152:153], v10 offset:53248
ds_read_b64_tr_b16 v[154:155], v10 offset:55296
v_mfma_f32_16x16x32_bf16 v[100:103], v[244:247], a[220:223], v[100:103]
s_add_u32 m0, s85, 32768
ds_read_b64_tr_b16 v[156:157], v11 offset:53248
ds_read_b64_tr_b16 v[158:159], v11 offset:55296
v_mfma_f32_16x16x32_bf16 v[84:87], v[244:247], a[204:207], v[84:87]
s_add_u32 s72, s71, 0
buffer_load_dwordx4 v15, s[24:27], s72 offen lds
v_mfma_f32_16x16x32_bf16 v[84:87], v[228:231], a[200:203], v[84:87]
s_nop 0
ds_read_b64 v[52:53], v118 offset:0
ds_read_b64_tr_b16 v[68:69], v5 offset:8192
v_mfma_f32_16x16x32_bf16 v[84:87], v[212:215], a[196:199], v[84:87]
s_nop 0
ds_read_b64_tr_b16 v[160:161], v8 offset:57344
ds_read_b64_tr_b16 v[162:163], v8 offset:59392
v_mfma_f32_16x16x32_bf16 v[84:87], v[196:199], a[192:195], v[84:87]
s_nop 0
ds_read_b64_tr_b16 v[164:165], v9 offset:57344
ds_read_b64_tr_b16 v[166:167], v9 offset:59392
v_mfma_f32_16x16x32_bf16 v[88:91], v[200:203], a[192:195], v[88:91]
s_nop 0
ds_read_b64_tr_b16 v[168:169], v10 offset:57344
ds_read_b64_tr_b16 v[170:171], v10 offset:59392
v_mfma_f32_16x16x32_bf16 v[88:91], v[216:219], a[196:199], v[88:91]
s_add_u32 s72, s71, 15360
buffer_load_dwordx4 v15, s[24:27], s72 offen offset:1024 lds
v_mfma_f32_16x16x32_bf16 v[88:91], v[232:235], a[200:203], v[88:91]
s_nop 0
ds_read_b64 v[54:55], v119 offset:0
ds_read_b64_tr_b16 v[70:71], v5 offset:12288
v_mfma_f32_16x16x32_bf16 v[88:91], v[248:251], a[204:207], v[88:91]
s_nop 0
ds_read_b64_tr_b16 v[172:173], v11 offset:57344
ds_read_b64_tr_b16 v[174:175], v11 offset:59392
v_mfma_f32_16x16x32_bf16 v[104:107], v[248:251], a[220:223], v[104:107]
s_nop 0
ds_read_b64_tr_b16 v[176:177], v8 offset:61440
ds_read_b64_tr_b16 v[178:179], v8 offset:63488
v_mfma_f32_16x16x32_bf16 v[104:107], v[232:235], a[216:219], v[104:107]
s_nop 0
ds_read_b64_tr_b16 v[180:181], v9 offset:61440
ds_read_b64_tr_b16 v[182:183], v9 offset:63488
v_mfma_f32_16x16x32_bf16 v[104:107], v[216:219], a[212:215], v[104:107]
v_xor_b32 v5, 16, v5
v_mfma_f32_16x16x32_bf16 v[104:107], v[200:203], a[208:211], v[104:107]
s_add_u32 s72, s71, 30720
buffer_load_dwordx4 v15, s[24:27], s72 offen offset:2048 lds
v_mfma_f32_16x16x32_bf16 v[108:111], v[204:207], a[208:211], v[108:111]
s_nop 0
ds_read_b64_tr_b16 v[184:185], v10 offset:61440
ds_read_b64_tr_b16 v[186:187], v10 offset:63488
v_mfma_f32_16x16x32_bf16 v[108:111], v[220:223], a[212:215], v[108:111]
s_nop 0
ds_read_b64_tr_b16 v[188:189], v11 offset:61440
ds_read_b64_tr_b16 v[190:191], v11 offset:63488
v_mfma_f32_16x16x32_bf16 v[108:111], v[236:239], a[216:219], v[108:111]
s_nop 0
ds_read_b64 v[56:57], v116 offset:2048
ds_read_b64_tr_b16 v[72:73], v5 offset:0
v_mfma_f32_16x16x32_bf16 v[108:111], v[252:255], a[220:223], v[108:111]
s_nop 0
ds_read_b64 v[58:59], v117 offset:2048
ds_read_b64_tr_b16 v[74:75], v5 offset:4096
v_mfma_f32_16x16x32_bf16 v[92:95], v[252:255], a[204:207], v[92:95]
ds_read_b64 v[60:61], v118 offset:2048
v_xor_b32 v8, 0x10000, v8
v_mfma_f32_16x16x32_bf16 v[92:95], v[236:239], a[200:203], v[92:95]
s_add_u32 s72, s71, 46080
buffer_load_dwordx4 v15, s[24:27], s72 offen offset:3072 lds
v_xor_b32 v9, 0x10000, v9
v_mfma_f32_16x16x32_bf16 v[92:95], v[220:223], a[196:199], v[92:95]
s_waitcnt vmcnt(31) lgkmcnt(0)
ds_read_b64_tr_b16 v[76:77], v5 offset:8192
v_xor_b32 v10, 0x10000, v10
v_mfma_f32_16x16x32_bf16 v[92:95], v[204:207], a[192:195], v[92:95]
s_barrier
ds_read_b64 v[62:63], v119 offset:2048
v_xor_b32 v11, 0x10000, v11
v_mfma_f32_16x16x32_bf16 v[80:83], v[128:131], a[224:227], v[80:83]
s_nop 0
ds_read_b64_tr_b16 v[192:193], v8 offset:0
ds_read_b64_tr_b16 v[194:195], v8 offset:2048
v_mfma_f32_16x16x32_bf16 v[80:83], v[144:147], a[228:231], v[80:83]
s_nop 0
ds_read_b64_tr_b16 v[196:197], v9 offset:0
ds_read_b64_tr_b16 v[198:199], v9 offset:2048
v_mfma_f32_16x16x32_bf16 v[80:83], v[160:163], a[232:235], v[80:83]
s_nop 0
ds_read_b64_tr_b16 v[200:201], v10 offset:0
ds_read_b64_tr_b16 v[202:203], v10 offset:2048
v_mfma_f32_16x16x32_bf16 v[80:83], v[176:179], a[236:239], v[80:83]
ds_read_b64_tr_b16 v[78:79], v5 offset:12288
v_mfma_f32_16x16x32_bf16 v[84:87], v[180:183], a[236:239], v[84:87]
s_nop 0
ds_read_b64_tr_b16 v[204:205], v11 offset:0
ds_read_b64_tr_b16 v[206:207], v11 offset:2048
v_mfma_f32_16x16x32_bf16 v[84:87], v[164:167], a[232:235], v[84:87]
s_xor_b32 s71, s15, 0x40000
ds_read_b64_tr_b16 v[208:209], v8 offset:4096
ds_read_b64_tr_b16 v[210:211], v8 offset:6144
v_mfma_f32_16x16x32_bf16 v[84:87], v[148:151], a[228:231], v[84:87]
s_add_u32 m0, s85, 49152
ds_read_b64_tr_b16 v[212:213], v9 offset:4096
ds_read_b64_tr_b16 v[214:215], v9 offset:6144
v_mfma_f32_16x16x32_bf16 v[84:87], v[132:135], a[224:227], v[84:87]
s_add_u32 s72, s71, 0
buffer_load_dwordx4 v15, s[24:27], s72 offen lds
v_mfma_f32_16x16x32_bf16 v[88:91], v[136:139], a[224:227], v[88:91]
v_mfma_f32_16x16x32_bf16 v[88:91], v[152:155], a[228:231], v[88:91]
s_waitcnt lgkmcnt(6)
ds_read_b64_tr_b16 v[216:217], v10 offset:4096
ds_read_b64_tr_b16 v[218:219], v10 offset:6144
v_mfma_f32_16x16x32_bf16 v[88:91], v[168:171], a[232:235], v[88:91]
s_nop 0
ds_read_b64_tr_b16 v[220:221], v11 offset:4096
ds_read_b64_tr_b16 v[222:223], v11 offset:6144
v_mfma_f32_16x16x32_bf16 v[88:91], v[184:187], a[236:239], v[88:91]
v_cvt_pk_bf16_f32 v80, v80, v81
v_cvt_pk_bf16_f32 v81, v82, v83
v_cvt_pk_bf16_f32 v82, v84, v85
v_mfma_f32_16x16x32_bf16 v[92:95], v[188:191], a[236:239], v[92:95]
s_nop 0
ds_read_b64_tr_b16 v[224:225], v8 offset:8192
ds_read_b64_tr_b16 v[226:227], v8 offset:10240
v_cvt_pk_bf16_f32 v83, v86, v87
v_mfma_f32_16x16x32_bf16 v[92:95], v[172:175], a[232:235], v[92:95]
s_add_u32 s72, s71, 15360
buffer_load_dwordx4 v15, s[24:27], s72 offen offset:1024 lds
v_mfma_f32_16x16x32_bf16 v[92:95], v[156:159], a[228:231], v[92:95]
s_nop 0
ds_read_b64_tr_b16 v[228:229], v9 offset:8192
ds_read_b64_tr_b16 v[230:231], v9 offset:10240
v_mfma_f32_16x16x32_bf16 v[92:95], v[140:143], a[224:227], v[92:95]
s_nop 0
ds_read_b64_tr_b16 v[232:233], v10 offset:8192
ds_read_b64_tr_b16 v[234:235], v10 offset:10240
v_mfma_f32_16x16x32_bf16 v[96:99], v[128:131], a[240:243], v[96:99]
s_xor_b32 s80, s93, 0x180000
v_and_b32 v114, 0xffff0000, v48
v_lshlrev_b32 v115, 16, v64
v_mfma_f32_16x16x32_bf16 v[96:99], v[144:147], a[244:247], v[96:99]
s_add_u32 s80, s80, 0x4200000
buffer_store_dwordx4 v[80:83], v1, s[44:47], s80 offen sc1
v_mfma_f32_16x16x32_bf16 v[96:99], v[160:163], a[248:251], v[96:99]
s_nop 0
ds_read_b64_tr_b16 v[236:237], v11 offset:8192
ds_read_b64_tr_b16 v[238:239], v11 offset:10240
v_mfma_f32_16x16x32_bf16 v[96:99], v[176:179], a[252:255], v[96:99]
s_add_u32 s72, s71, 30720
buffer_load_dwordx4 v15, s[24:27], s72 offen offset:2048 lds
v_cvt_pk_bf16_f32 v84, v88, v89
v_mfma_f32_16x16x32_bf16 v[100:103], v[180:183], a[252:255], v[100:103]
s_nop 0
ds_read_b64_tr_b16 v[240:241], v8 offset:12288
ds_read_b64_tr_b16 v[242:243], v8 offset:14336
v_cvt_pk_bf16_f32 v85, v90, v91
v_mfma_f32_16x16x32_bf16 v[100:103], v[164:167], a[248:251], v[100:103]
s_nop 0
ds_read_b64_tr_b16 v[244:245], v9 offset:12288
ds_read_b64_tr_b16 v[246:247], v9 offset:14336
v_cvt_pk_bf16_f32 v86, v92, v93
v_mfma_f32_16x16x32_bf16 v[100:103], v[148:151], a[244:247], v[100:103]
v_cvt_pk_bf16_f32 v87, v94, v95
v_lshlrev_b32 v48, 16, v48
v_mfma_f32_16x16x32_bf16 v[100:103], v[132:135], a[240:243], v[100:103]
s_nop 0
ds_read_b64_tr_b16 v[248:249], v10 offset:12288
ds_read_b64_tr_b16 v[250:251], v10 offset:14336
v_mfma_f32_16x16x32_bf16 v[104:107], v[136:139], a[240:243], v[104:107]
s_nop 0
ds_read_b64_tr_b16 v[252:253], v11 offset:12288
ds_read_b64_tr_b16 v[254:255], v11 offset:14336
v_mfma_f32_16x16x32_bf16 v[104:107], v[152:155], a[244:247], v[104:107]
s_add_u32 s72, s71, 46080
buffer_load_dwordx4 v15, s[24:27], s72 offen offset:3072 lds
v_mfma_f32_16x16x32_bf16 v[104:107], v[168:171], a[248:251], v[104:107]
v_and_b32 v64, 0xffff0000, v64
v_mul_f32 v48, v48, v112
v_mfma_f32_16x16x32_bf16 v[104:107], v[184:187], a[252:255], v[104:107]
v_cvt_pk_bf16_f32 v88, v96, v97
v_cvt_pk_bf16_f32 v89, v98, v99
v_cvt_pk_bf16_f32 v90, v100, v101
v_mfma_f32_16x16x32_bf16 v[108:111], v[188:191], a[252:255], v[108:111]
v_cvt_pk_bf16_f32 v91, v102, v103
v_mul_f32 v114, v114, v112
v_mfma_f32_16x16x32_bf16 v[108:111], v[172:175], a[248:251], v[108:111]
v_mul_f32 v48, v48, v115
v_mul_f32 v64, v64, v114
v_mfma_f32_16x16x32_bf16 v[108:111], v[156:159], a[244:247], v[108:111]
s_waitcnt vmcnt(30) lgkmcnt(0)
v_and_b32 v114, 0xffff0000, v49
v_lshlrev_b32 v115, 16, v65
v_mfma_f32_16x16x32_bf16 v[108:111], v[140:143], a[240:243], v[108:111]
s_barrier
v_lshlrev_b32 v49, 16, v49
v_and_b32 v65, 0xffff0000, v65
v_mfma_f32_16x16x32_bf16 v[16:19], v[192:195], a[0:3], 0
s_nop 0
ds_read_b64_tr_b16 v[128:129], v8 offset:16384
ds_read_b64_tr_b16 v[130:131], v8 offset:18432
v_mfma_f32_16x16x32_bf16 v[16:19], v[208:211], a[4:7], v[16:19]
buffer_store_dwordx4 v[84:87], v1, s[44:47], s80 offen offset:1024 sc1
v_mfma_f32_16x16x32_bf16 v[16:19], v[224:227], a[8:11], v[16:19]
s_nop 0
ds_read_b64_tr_b16 v[132:133], v9 offset:16384
ds_read_b64_tr_b16 v[134:135], v9 offset:18432
v_mfma_f32_16x16x32_bf16 v[16:19], v[240:243], a[12:15], v[16:19]
v_cvt_pk_bf16_f32 v92, v104, v105
v_cvt_pk_bf16_f32 v93, v106, v107
v_cvt_pk_bf16_f32 v94, v108, v109
v_mfma_f32_16x16x32_bf16 v[32:35], v[240:243], a[28:31], 0
s_nop 0
ds_read_b64_tr_b16 v[136:137], v10 offset:16384
ds_read_b64_tr_b16 v[138:139], v10 offset:18432
v_cvt_pk_bf16_f32 v95, v110, v111
v_mfma_f32_16x16x32_bf16 v[32:35], v[224:227], a[24:27], v[32:35]
s_nop 0
ds_read_b64_tr_b16 v[140:141], v11 offset:16384
ds_read_b64_tr_b16 v[142:143], v11 offset:18432
v_mfma_f32_16x16x32_bf16 v[32:35], v[208:211], a[20:23], v[32:35]
v_mul_f32 v49, v49, v112
v_mul_f32 v114, v114, v112
v_mfma_f32_16x16x32_bf16 v[32:35], v[192:195], a[16:19], v[32:35]
s_nop 0
ds_read_b64_tr_b16 v[144:145], v8 offset:20480
ds_read_b64_tr_b16 v[146:147], v8 offset:22528
v_mfma_f32_16x16x32_bf16 v[36:39], v[196:199], a[16:19], 0
s_nop 0
ds_read_b64_tr_b16 v[148:149], v9 offset:20480
ds_read_b64_tr_b16 v[150:151], v9 offset:22528
v_mfma_f32_16x16x32_bf16 v[36:39], v[212:215], a[20:23], v[36:39]
v_mul_f32 v49, v49, v115
v_mul_f32 v65, v65, v114
v_mfma_f32_16x16x32_bf16 v[36:39], v[228:231], a[24:27], v[36:39]
s_nop 0
ds_read_b64_tr_b16 v[152:153], v10 offset:20480
ds_read_b64_tr_b16 v[154:155], v10 offset:22528
v_mfma_f32_16x16x32_bf16 v[36:39], v[244:247], a[28:31], v[36:39]
s_nop 0
ds_read_b64_tr_b16 v[156:157], v11 offset:20480
ds_read_b64_tr_b16 v[158:159], v11 offset:22528
v_mfma_f32_16x16x32_bf16 v[20:23], v[244:247], a[12:15], 0
v_and_b32 v114, 0xffff0000, v50
v_lshlrev_b32 v115, 16, v66
v_mfma_f32_16x16x32_bf16 v[20:23], v[228:231], a[8:11], v[20:23]
s_nop 0
ds_read_b64_tr_b16 v[160:161], v8 offset:24576
ds_read_b64_tr_b16 v[162:163], v8 offset:26624
v_mfma_f32_16x16x32_bf16 v[20:23], v[212:215], a[4:7], v[20:23]
v_lshlrev_b32 v50, 16, v50
v_and_b32 v66, 0xffff0000, v66
v_mfma_f32_16x16x32_bf16 v[20:23], v[196:199], a[0:3], v[20:23]
s_nop 0
ds_read_b64_tr_b16 v[164:165], v9 offset:24576
ds_read_b64_tr_b16 v[166:167], v9 offset:26624
v_mfma_f32_16x16x32_bf16 v[24:27], v[200:203], a[0:3], 0
s_nop 0
ds_read_b64_tr_b16 v[168:169], v10 offset:24576
ds_read_b64_tr_b16 v[170:171], v10 offset:26624
v_mfma_f32_16x16x32_bf16 v[24:27], v[216:219], a[4:7], v[24:27]
buffer_store_dwordx4 v[88:91], v1, s[44:47], s80 offen offset:2048 sc1
v_mfma_f32_16x16x32_bf16 v[24:27], v[232:235], a[8:11], v[24:27]
v_mul_f32 v50, v50, v112
v_mul_f32 v114, v114, v112
v_mfma_f32_16x16x32_bf16 v[24:27], v[248:251], a[12:15], v[24:27]
s_nop 0
ds_read_b64_tr_b16 v[172:173], v11 offset:24576
ds_read_b64_tr_b16 v[174:175], v11 offset:26624
v_mfma_f32_16x16x32_bf16 v[40:43], v[248:251], a[28:31], 0
s_nop 0
ds_read_b64_tr_b16 v[176:177], v8 offset:28672
ds_read_b64_tr_b16 v[178:179], v8 offset:30720
v_mfma_f32_16x16x32_bf16 v[40:43], v[232:235], a[24:27], v[40:43]
v_mul_f32 v50, v50, v115
v_mul_f32 v66, v66, v114
v_mfma_f32_16x16x32_bf16 v[40:43], v[216:219], a[20:23], v[40:43]
s_nop 0
ds_read_b64_tr_b16 v[180:181], v9 offset:28672
ds_read_b64_tr_b16 v[182:183], v9 offset:30720
v_mfma_f32_16x16x32_bf16 v[40:43], v[200:203], a[16:19], v[40:43]
s_nop 0
ds_read_b64_tr_b16 v[184:185], v10 offset:28672
ds_read_b64_tr_b16 v[186:187], v10 offset:30720
v_mfma_f32_16x16x32_bf16 v[44:47], v[204:207], a[16:19], 0
v_and_b32 v114, 0xffff0000, v51
v_lshlrev_b32 v115, 16, v67
v_mfma_f32_16x16x32_bf16 v[44:47], v[220:223], a[20:23], v[44:47]
s_nop 0
ds_read_b64_tr_b16 v[188:189], v11 offset:28672
ds_read_b64_tr_b16 v[190:191], v11 offset:30720
v_mfma_f32_16x16x32_bf16 v[44:47], v[236:239], a[24:27], v[44:47]
v_lshlrev_b32 v51, 16, v51
v_and_b32 v67, 0xffff0000, v67
v_mfma_f32_16x16x32_bf16 v[44:47], v[252:255], a[28:31], v[44:47]
v_mul_f32 v51, v51, v112
v_mul_f32 v114, v114, v112
v_mfma_f32_16x16x32_bf16 v[28:31], v[252:255], a[12:15], 0
v_mul_f32 v51, v51, v115
v_mul_f32 v67, v67, v114
v_mfma_f32_16x16x32_bf16 v[28:31], v[236:239], a[8:11], v[28:31]
v_and_b32 v114, 0xffff0000, v52
v_lshlrev_b32 v115, 16, v68
v_mfma_f32_16x16x32_bf16 v[28:31], v[220:223], a[4:7], v[28:31]
s_waitcnt vmcnt(27) lgkmcnt(0)
v_lshlrev_b32 v52, 16, v52
v_and_b32 v68, 0xffff0000, v68
v_mfma_f32_16x16x32_bf16 v[28:31], v[204:207], a[0:3], v[28:31]
s_barrier
v_mul_f32 v52, v52, v112
v_mul_f32 v114, v114, v112
v_mfma_f32_16x16x32_bf16 v[16:19], v[128:131], a[32:35], v[16:19]
s_nop 0
ds_read_b64_tr_b16 v[192:193], v8 offset:32768
Lstube4:
s_cbranch_execz Lrete
ds_read_b64_tr_b16 v[194:195], v8 offset:34816
v_mfma_f32_16x16x32_bf16 v[16:19], v[144:147], a[36:39], v[16:19]
buffer_store_dwordx4 v[92:95], v1, s[44:47], s80 offen offset:3072 sc1
v_mfma_f32_16x16x32_bf16 v[16:19], v[160:163], a[40:43], v[16:19]
s_nop 0
ds_read_b64_tr_b16 v[196:197], v9 offset:32768
ds_read_b64_tr_b16 v[198:199], v9 offset:34816
v_mfma_f32_16x16x32_bf16 v[16:19], v[176:179], a[44:47], v[16:19]
v_mul_f32 v52, v52, v115
v_mul_f32 v68, v68, v114
v_mfma_f32_16x16x32_bf16 v[32:35], v[176:179], a[60:63], v[32:35]
s_nop 0
ds_read_b64_tr_b16 v[200:201], v10 offset:32768
ds_read_b64_tr_b16 v[202:203], v10 offset:34816
v_mfma_f32_16x16x32_bf16 v[32:35], v[160:163], a[56:59], v[32:35]
s_nop 0
ds_read_b64_tr_b16 v[204:205], v11 offset:32768
ds_read_b64_tr_b16 v[206:207], v11 offset:34816
v_mfma_f32_16x16x32_bf16 v[32:35], v[144:147], a[52:55], v[32:35]
v_and_b32 v114, 0xffff0000, v53
v_lshlrev_b32 v115, 16, v69
v_mfma_f32_16x16x32_bf16 v[32:35], v[128:131], a[48:51], v[32:35]
s_nop 0
ds_read_b64_tr_b16 v[208:209], v8 offset:36864
ds_read_b64_tr_b16 v[210:211], v8 offset:38912
v_mfma_f32_16x16x32_bf16 v[36:39], v[132:135], a[48:51], v[36:39]
v_lshlrev_b32 v53, 16, v53
v_and_b32 v69, 0xffff0000, v69
v_mfma_f32_16x16x32_bf16 v[36:39], v[148:151], a[52:55], v[36:39]
s_nop 0
ds_read_b64_tr_b16 v[212:213], v9 offset:36864
ds_read_b64_tr_b16 v[214:215], v9 offset:38912
v_mfma_f32_16x16x32_bf16 v[36:39], v[164:167], a[56:59], v[36:39]
s_nop 0
ds_read_b64_tr_b16 v[216:217], v10 offset:36864
ds_read_b64_tr_b16 v[218:219], v10 offset:38912
v_mfma_f32_16x16x32_bf16 v[36:39], v[180:183], a[60:63], v[36:39]
v_mul_f32 v53, v53, v112
v_mul_f32 v114, v114, v112
v_mfma_f32_16x16x32_bf16 v[20:23], v[180:183], a[44:47], v[20:23]
s_nop 0
ds_read_b64_tr_b16 v[220:221], v11 offset:36864
ds_read_b64_tr_b16 v[222:223], v11 offset:38912
v_mfma_f32_16x16x32_bf16 v[20:23], v[164:167], a[40:43], v[20:23]
v_mul_f32 v53, v53, v115
v_mul_f32 v69, v69, v114
v_mfma_f32_16x16x32_bf16 v[20:23], v[148:151], a[36:39], v[20:23]
s_nop 0
ds_read_b64_tr_b16 v[224:225], v8 offset:40960
ds_read_b64_tr_b16 v[226:227], v8 offset:43008
v_mfma_f32_16x16x32_bf16 v[20:23], v[132:135], a[32:35], v[20:23]
s_nop 0
ds_read_b64_tr_b16 v[228:229], v9 offset:40960
ds_read_b64_tr_b16 v[230:231], v9 offset:43008
v_mfma_f32_16x16x32_bf16 v[24:27], v[136:139], a[32:35], v[24:27]
v_and_b32 v114, 0xffff0000, v54
v_lshlrev_b32 v115, 16, v70
v_mfma_f32_16x16x32_bf16 v[24:27], v[152:155], a[36:39], v[24:27]
s_nop 0
ds_read_b64_tr_b16 v[232:233], v10 offset:40960
ds_read_b64_tr_b16 v[234:235], v10 offset:43008
v_mfma_f32_16x16x32_bf16 v[24:27], v[168:171], a[40:43], v[24:27]
s_nop 0
ds_read_b64_tr_b16 v[236:237], v11 offset:40960
ds_read_b64_tr_b16 v[238:239], v11 offset:43008
v_mfma_f32_16x16x32_bf16 v[24:27], v[184:187], a[44:47], v[24:27]
v_lshlrev_b32 v54, 16, v54
v_and_b32 v70, 0xffff0000, v70
v_mfma_f32_16x16x32_bf16 v[40:43], v[184:187], a[60:63], v[40:43]
s_nop 0
ds_read_b64_tr_b16 v[240:241], v8 offset:45056
ds_read_b64_tr_b16 v[242:243], v8 offset:47104
v_mfma_f32_16x16x32_bf16 v[40:43], v[168:171], a[56:59], v[40:43]
v_mul_f32 v54, v54, v112
v_mul_f32 v114, v114, v112
v_mfma_f32_16x16x32_bf16 v[40:43], v[152:155], a[52:55], v[40:43]
s_nop 0
ds_read_b64_tr_b16 v[244:245], v9 offset:45056
ds_read_b64_tr_b16 v[246:247], v9 offset:47104
v_mfma_f32_16x16x32_bf16 v[40:43], v[136:139], a[48:51], v[40:43]
s_nop 0
ds_read_b64_tr_b16 v[248:249], v10 offset:45056
ds_read_b64_tr_b16 v[250:251], v10 offset:47104
v_mfma_f32_16x16x32_bf16 v[44:47], v[140:143], a[48:51], v[44:47]
v_mul_f32 v54, v54, v115
v_mul_f32 v70, v70, v114
v_mfma_f32_16x16x32_bf16 v[44:47], v[156:159], a[52:55], v[44:47]
s_nop 0
ds_read_b64_tr_b16 v[252:253], v11 offset:45056
ds_read_b64_tr_b16 v[254:255], v11 offset:47104
v_mfma_f32_16x16x32_bf16 v[44:47], v[172:175], a[56:59], v[44:47]
v_and_b32 v114, 0xffff0000, v55
v_lshlrev_b32 v115, 16, v71
v_mfma_f32_16x16x32_bf16 v[44:47], v[188:191], a[60:63], v[44:47]
v_lshlrev_b32 v55, 16, v55
v_and_b32 v71, 0xffff0000, v71
v_mfma_f32_16x16x32_bf16 v[28:31], v[188:191], a[44:47], v[28:31]
v_mul_f32 v55, v55, v112
v_mul_f32 v114, v114, v112
v_mfma_f32_16x16x32_bf16 v[28:31], v[172:175], a[40:43], v[28:31]
s_add_u32 s79, s93, 0x3a00000
v_mul_f32 v55, v55, v115
v_mul_f32 v71, v71, v114
v_mfma_f32_16x16x32_bf16 v[28:31], v[156:159], a[36:39], v[28:31]
s_waitcnt vmcnt(24) lgkmcnt(0)
buffer_load_dwordx4 v[96:99], v1, s[44:47], s79 offen sc1
v_mfma_f32_16x16x32_bf16 v[28:31], v[140:143], a[32:35], v[28:31]
s_barrier
v_and_b32 v114, 0xffff0000, v56
v_lshlrev_b32 v115, 16, v72
v_mfma_f32_16x16x32_bf16 v[16:19], v[192:195], a[64:67], v[16:19]
s_nop 0
ds_read_b64_tr_b16 v[128:129], v8 offset:49152
ds_read_b64_tr_b16 v[130:131], v8 offset:51200
v_mfma_f32_16x16x32_bf16 v[16:19], v[208:211], a[68:71], v[16:19]
s_nop 0
ds_read_b64_tr_b16 v[132:133], v9 offset:49152
ds_read_b64_tr_b16 v[134:135], v9 offset:51200
v_mfma_f32_16x16x32_bf16 v[16:19], v[224:227], a[72:75], v[16:19]
v_lshlrev_b32 v56, 16, v56
v_and_b32 v72, 0xffff0000, v72
v_mfma_f32_16x16x32_bf16 v[16:19], v[240:243], a[76:79], v[16:19]
buffer_load_dwordx4 v[100:103], v1, s[44:47], s79 offen offset:1024 sc1
v_mfma_f32_16x16x32_bf16 v[32:35], v[240:243], a[92:95], v[32:35]
s_nop 0
ds_read_b64_tr_b16 v[136:137], v10 offset:49152
ds_read_b64_tr_b16 v[138:139], v10 offset:51200
v_mfma_f32_16x16x32_bf16 v[32:35], v[224:227], a[88:91], v[32:35]
s_nop 0
ds_read_b64_tr_b16 v[140:141], v11 offset:49152
ds_read_b64_tr_b16 v[142:143], v11 offset:51200
v_mfma_f32_16x16x32_bf16 v[32:35], v[208:211], a[84:87], v[32:35]
v_mul_f32 v56, v56, v113
v_mul_f32 v114, v114, v113
v_mfma_f32_16x16x32_bf16 v[32:35], v[192:195], a[80:83], v[32:35]
s_nop 0
ds_read_b64_tr_b16 v[144:145], v8 offset:53248
ds_read_b64_tr_b16 v[146:147], v8 offset:55296
v_mfma_f32_16x16x32_bf16 v[36:39], v[196:199], a[80:83], v[36:39]
buffer_load_dwordx4 v[104:107], v1, s[44:47], s79 offen offset:2048 sc1
v_mfma_f32_16x16x32_bf16 v[36:39], v[212:215], a[84:87], v[36:39]
s_nop 0
ds_read_b64_tr_b16 v[148:149], v9 offset:53248
ds_read_b64_tr_b16 v[150:151], v9 offset:55296
v_mfma_f32_16x16x32_bf16 v[36:39], v[228:231], a[88:91], v[36:39]
v_mul_f32 v56, v56, v115
v_mul_f32 v72, v72, v114
v_mfma_f32_16x16x32_bf16 v[36:39], v[244:247], a[92:95], v[36:39]
s_nop 0
ds_read_b64_tr_b16 v[152:153], v10 offset:53248
ds_read_b64_tr_b16 v[154:155], v10 offset:55296
v_mfma_f32_16x16x32_bf16 v[20:23], v[244:247], a[76:79], v[20:23]
s_nop 0
ds_read_b64_tr_b16 v[156:157], v11 offset:53248
ds_read_b64_tr_b16 v[158:159], v11 offset:55296
v_mfma_f32_16x16x32_bf16 v[20:23], v[228:231], a[72:75], v[20:23]
buffer_load_dwordx4 v[108:111], v1, s[44:47], s79 offen offset:3072 sc1
v_mfma_f32_16x16x32_bf16 v[20:23], v[212:215], a[68:71], v[20:23]
v_and_b32 v114, 0xffff0000, v57
v_lshlrev_b32 v115, 16, v73
v_mfma_f32_16x16x32_bf16 v[20:23], v[196:199], a[64:67], v[20:23]
s_nop 0
ds_read_b64_tr_b16 v[160:161], v8 offset:57344
ds_read_b64_tr_b16 v[162:163], v8 offset:59392
v_mfma_f32_16x16x32_bf16 v[24:27], v[200:203], a[64:67], v[24:27]
s_nop 0
ds_read_b64_tr_b16 v[164:165], v9 offset:57344
ds_read_b64_tr_b16 v[166:167], v9 offset:59392
v_mfma_f32_16x16x32_bf16 v[24:27], v[216:219], a[68:71], v[24:27]
v_lshlrev_b32 v57, 16, v57
v_and_b32 v73, 0xffff0000, v73
v_mfma_f32_16x16x32_bf16 v[24:27], v[232:235], a[72:75], v[24:27]
s_nop 0
ds_read_b64_tr_b16 v[168:169], v10 offset:57344
ds_read_b64_tr_b16 v[170:171], v10 offset:59392
v_mfma_f32_16x16x32_bf16 v[24:27], v[248:251], a[76:79], v[24:27]
s_nop 0
ds_read_b64_tr_b16 v[172:173], v11 offset:57344
ds_read_b64_tr_b16 v[174:175], v11 offset:59392
v_mfma_f32_16x16x32_bf16 v[40:43], v[248:251], a[92:95], v[40:43]
v_mul_f32 v57, v57, v113
v_mul_f32 v114, v114, v113
v_mfma_f32_16x16x32_bf16 v[40:43], v[232:235], a[88:91], v[40:43]
s_nop 0
ds_read_b64_tr_b16 v[176:177], v8 offset:61440
ds_read_b64_tr_b16 v[178:179], v8 offset:63488
v_mfma_f32_16x16x32_bf16 v[40:43], v[216:219], a[84:87], v[40:43]
s_nop 0
ds_read_b64_tr_b16 v[180:181], v9 offset:61440
ds_read_b64_tr_b16 v[182:183], v9 offset:63488
v_mfma_f32_16x16x32_bf16 v[40:43], v[200:203], a[80:83], v[40:43]
v_mul_f32 v57, v57, v115
v_mul_f32 v73, v73, v114
v_mfma_f32_16x16x32_bf16 v[44:47], v[204:207], a[80:83], v[44:47]
s_nop 0
ds_read_b64_tr_b16 v[184:185], v10 offset:61440
ds_read_b64_tr_b16 v[186:187], v10 offset:63488
v_mfma_f32_16x16x32_bf16 v[44:47], v[220:223], a[84:87], v[44:47]
s_nop 0
ds_read_b64_tr_b16 v[188:189], v11 offset:61440
ds_read_b64_tr_b16 v[190:191], v11 offset:63488
v_mfma_f32_16x16x32_bf16 v[44:47], v[236:239], a[88:91], v[44:47]
v_and_b32 v114, 0xffff0000, v58
v_lshlrev_b32 v115, 16, v74
v_mfma_f32_16x16x32_bf16 v[44:47], v[252:255], a[92:95], v[44:47]
v_lshlrev_b32 v58, 16, v58
v_and_b32 v74, 0xffff0000, v74
v_mfma_f32_16x16x32_bf16 v[28:31], v[252:255], a[76:79], v[28:31]
v_xor_b32 v8, 0x10000, v8
v_mul_f32 v58, v58, v113
v_mfma_f32_16x16x32_bf16 v[28:31], v[236:239], a[72:75], v[28:31]
v_xor_b32 v9, 0x10000, v9
v_mul_f32 v114, v114, v113
v_mfma_f32_16x16x32_bf16 v[28:31], v[220:223], a[68:71], v[28:31]
s_waitcnt vmcnt(22) lgkmcnt(0)
v_xor_b32 v10, 0x10000, v10
v_mul_f32 v58, v58, v115
v_mfma_f32_16x16x32_bf16 v[28:31], v[204:207], a[64:67], v[28:31]
s_barrier
v_xor_b32 v11, 0x10000, v11
v_mul_f32 v74, v74, v114
v_mfma_f32_16x16x32_bf16 v[16:19], v[128:131], a[96:99], v[16:19]
s_nop 0
ds_read_b64_tr_b16 v[192:193], v8 offset:0
ds_read_b64_tr_b16 v[194:195], v8 offset:2048
v_mfma_f32_16x16x32_bf16 v[16:19], v[144:147], a[100:103], v[16:19]
s_nop 0
ds_read_b64_tr_b16 v[196:197], v9 offset:0
ds_read_b64_tr_b16 v[198:199], v9 offset:2048
v_mfma_f32_16x16x32_bf16 v[16:19], v[160:163], a[104:107], v[16:19]
v_and_b32 v114, 0xffff0000, v59
v_lshlrev_b32 v115, 16, v75
v_mfma_f32_16x16x32_bf16 v[16:19], v[176:179], a[108:111], v[16:19]
s_nop 0
ds_read_b64_tr_b16 v[200:201], v10 offset:0
ds_read_b64_tr_b16 v[202:203], v10 offset:2048
v_mfma_f32_16x16x32_bf16 v[32:35], v[176:179], a[124:127], v[32:35]
v_lshlrev_b32 v59, 16, v59
v_and_b32 v75, 0xffff0000, v75
v_mfma_f32_16x16x32_bf16 v[32:35], v[160:163], a[120:123], v[32:35]
s_nop 0
ds_read_b64_tr_b16 v[204:205], v11 offset:0
ds_read_b64_tr_b16 v[206:207], v11 offset:2048
v_mfma_f32_16x16x32_bf16 v[32:35], v[144:147], a[116:119], v[32:35]
s_nop 0
ds_read_b64_tr_b16 v[208:209], v8 offset:4096
ds_read_b64_tr_b16 v[210:211], v8 offset:6144
v_mfma_f32_16x16x32_bf16 v[32:35], v[128:131], a[112:115], v[32:35]
v_mul_f32 v59, v59, v113
v_mul_f32 v114, v114, v113
v_mfma_f32_16x16x32_bf16 v[36:39], v[132:135], a[112:115], v[36:39]
s_nop 0
ds_read_b64_tr_b16 v[212:213], v9 offset:4096
ds_read_b64_tr_b16 v[214:215], v9 offset:6144
v_mfma_f32_16x16x32_bf16 v[36:39], v[148:151], a[116:119], v[36:39]
v_mul_f32 v59, v59, v115
v_mul_f32 v75, v75, v114
v_mfma_f32_16x16x32_bf16 v[36:39], v[164:167], a[120:123], v[36:39]
s_nop 0
ds_read_b64_tr_b16 v[216:217], v10 offset:4096
ds_read_b64_tr_b16 v[218:219], v10 offset:6144
v_mfma_f32_16x16x32_bf16 v[36:39], v[180:183], a[124:127], v[36:39]
s_nop 0
ds_read_b64_tr_b16 v[220:221], v11 offset:4096
ds_read_b64_tr_b16 v[222:223], v11 offset:6144
v_mfma_f32_16x16x32_bf16 v[20:23], v[180:183], a[108:111], v[20:23]
v_and_b32 v114, 0xffff0000, v60
v_lshlrev_b32 v115, 16, v76
v_mfma_f32_16x16x32_bf16 v[20:23], v[164:167], a[104:107], v[20:23]
s_nop 0
ds_read_b64_tr_b16 v[224:225], v8 offset:8192
ds_read_b64_tr_b16 v[226:227], v8 offset:10240
v_mfma_f32_16x16x32_bf16 v[20:23], v[148:151], a[100:103], v[20:23]
v_lshlrev_b32 v60, 16, v60
v_and_b32 v76, 0xffff0000, v76
v_mfma_f32_16x16x32_bf16 v[20:23], v[132:135], a[96:99], v[20:23]
s_nop 0
ds_read_b64_tr_b16 v[228:229], v9 offset:8192
ds_read_b64_tr_b16 v[230:231], v9 offset:10240
v_mfma_f32_16x16x32_bf16 v[24:27], v[136:139], a[96:99], v[24:27]
s_nop 0
ds_read_b64_tr_b16 v[232:233], v10 offset:8192
ds_read_b64_tr_b16 v[234:235], v10 offset:10240
v_mfma_f32_16x16x32_bf16 v[24:27], v[152:155], a[100:103], v[24:27]
v_mul_f32 v60, v60, v113
v_mul_f32 v114, v114, v113
v_mfma_f32_16x16x32_bf16 v[24:27], v[168:171], a[104:107], v[24:27]
s_nop 0
ds_read_b64_tr_b16 v[236:237], v11 offset:8192
ds_read_b64_tr_b16 v[238:239], v11 offset:10240
v_mfma_f32_16x16x32_bf16 v[24:27], v[184:187], a[108:111], v[24:27]
v_mul_f32 v60, v60, v115
v_mul_f32 v76, v76, v114
v_mfma_f32_16x16x32_bf16 v[40:43], v[184:187], a[124:127], v[40:43]
s_nop 0
ds_read_b64_tr_b16 v[240:241], v8 offset:12288
ds_read_b64_tr_b16 v[242:243], v8 offset:14336
v_mfma_f32_16x16x32_bf16 v[40:43], v[168:171], a[120:123], v[40:43]
s_nop 0
ds_read_b64_tr_b16 v[244:245], v9 offset:12288
ds_read_b64_tr_b16 v[246:247], v9 offset:14336
v_mfma_f32_16x16x32_bf16 v[40:43], v[152:155], a[116:119], v[40:43]
v_and_b32 v114, 0xffff0000, v61
v_lshlrev_b32 v115, 16, v77
v_mfma_f32_16x16x32_bf16 v[40:43], v[136:139], a[112:115], v[40:43]
s_nop 0
ds_read_b64_tr_b16 v[248:249], v10 offset:12288
ds_read_b64_tr_b16 v[250:251], v10 offset:14336
v_mfma_f32_16x16x32_bf16 v[44:47], v[140:143], a[112:115], v[44:47]
v_lshlrev_b32 v61, 16, v61
v_and_b32 v77, 0xffff0000, v77
v_mfma_f32_16x16x32_bf16 v[44:47], v[156:159], a[116:119], v[44:47]
s_nop 0
ds_read_b64_tr_b16 v[252:253], v11 offset:12288
ds_read_b64_tr_b16 v[254:255], v11 offset:14336
v_mfma_f32_16x16x32_bf16 v[44:47], v[172:175], a[120:123], v[44:47]
v_mul_f32 v61, v61, v113
v_mul_f32 v114, v114, v113
v_mfma_f32_16x16x32_bf16 v[44:47], v[188:191], a[124:127], v[44:47]
s_waitcnt vmcnt(0)
v_max3_u32 v12, v96, v97, v98
v_max3_u32 v13, v99, v100, v101
v_mfma_f32_16x16x32_bf16 v[28:31], v[188:191], a[108:111], v[28:31]
v_max3_u32 v12, v12, v102, v103
v_max3_u32 v13, v13, v104, v105
v_mfma_f32_16x16x32_bf16 v[28:31], v[172:175], a[104:107], v[28:31]
v_max3_u32 v12, v12, v106, v107
v_max3_u32 v13, v13, v108, v109
v_mfma_f32_16x16x32_bf16 v[28:31], v[156:159], a[100:103], v[28:31]
s_waitcnt vmcnt(16) lgkmcnt(0)
v_max3_u32 v12, v12, v110, v111
v_mul_f32 v61, v61, v115
v_mfma_f32_16x16x32_bf16 v[28:31], v[140:143], a[96:99], v[28:31]
s_barrier
v_max_u32 v12, v12, v13
v_mul_f32 v77, v77, v114
v_mfma_f32_16x16x32_bf16 v[16:19], v[192:195], a[128:131], v[16:19]
v_cmp_le_u32 vcc, 0xff800000, v12
v_and_b32 v114, 0xffff0000, v62
v_mfma_f32_16x16x32_bf16 v[16:19], v[208:211], a[132:135], v[16:19]
s_nop 0
ds_read_b64_tr_b16 v[128:129], v8 offset:16384
ds_read_b64_tr_b16 v[130:131], v8 offset:18432
v_mfma_f32_16x16x32_bf16 v[16:19], v[224:227], a[136:139], v[16:19]
s_cbranch_vccnz Lxspin1
Lxback1:
ds_read_b64_tr_b16 v[132:133], v9 offset:16384
ds_read_b64_tr_b16 v[134:135], v9 offset:18432
v_mfma_f32_16x16x32_bf16 v[16:19], v[240:243], a[140:143], v[16:19]
v_lshlrev_b32 v115, 16, v78
v_lshlrev_b32 v62, 16, v62
v_mfma_f32_16x16x32_bf16 v[16:19], v[124:127], v[96:99], v[16:19]
s_nop 0
ds_read_b64_tr_b16 v[136:137], v10 offset:16384
ds_read_b64_tr_b16 v[138:139], v10 offset:18432
v_mfma_f32_16x16x32_bf16 v[32:35], v[240:243], a[156:159], v[32:35]
v_and_b32 v78, 0xffff0000, v78
v_mul_f32 v62, v62, v113
v_mfma_f32_16x16x32_bf16 v[32:35], v[224:227], a[152:155], v[32:35]
s_add_u32 s82, s93, 0x3e00000
buffer_load_dwordx4 v[80:83], v1, s[44:47], s82 offen sc1
v_mfma_f32_16x16x32_bf16 v[32:35], v[208:211], a[148:151], v[32:35]
s_nop 0
ds_read_b64_tr_b16 v[140:141], v11 offset:16384
ds_read_b64_tr_b16 v[142:143], v11 offset:18432
v_mfma_f32_16x16x32_bf16 v[32:35], v[192:195], a[144:147], v[32:35]
v_mul_f32 v114, v114, v113
v_mul_f32 v62, v62, v115
v_mfma_f32_16x16x32_bf16 v[32:35], v[124:127], v[104:107], v[32:35]
s_nop 0
ds_read_b64_tr_b16 v[144:145], v8 offset:20480
ds_read_b64_tr_b16 v[146:147], v8 offset:22528
v_mfma_f32_16x16x32_bf16 v[36:39], v[196:199], a[144:147], v[36:39]
v_mul_f32 v78, v78, v114
v_and_b32 v114, 0xffff0000, v63
v_mfma_f32_16x16x32_bf16 v[36:39], v[212:215], a[148:151], v[36:39]
buffer_load_dwordx4 v[84:87], v1, s[44:47], s82 offen offset:1024 sc1
v_mfma_f32_16x16x32_bf16 v[36:39], v[228:231], a[152:155], v[36:39]
s_nop 0
ds_read_b64_tr_b16 v[148:149], v9 offset:20480
ds_read_b64_tr_b16 v[150:151], v9 offset:22528
v_mfma_f32_16x16x32_bf16 v[36:39], v[244:247], a[156:159], v[36:39]
v_lshlrev_b32 v115, 16, v79
v_lshlrev_b32 v63, 16, v63
v_mfma_f32_16x16x32_bf16 v[36:39], v[120:123], v[104:107], v[36:39]
s_nop 0
ds_read_b64_tr_b16 v[152:153], v10 offset:20480
ds_read_b64_tr_b16 v[154:155], v10 offset:22528
v_mfma_f32_16x16x32_bf16 v[20:23], v[244:247], a[140:143], v[20:23]
v_and_b32 v79, 0xffff0000, v79
v_mul_f32 v63, v63, v113
v_mfma_f32_16x16x32_bf16 v[20:23], v[228:231], a[136:139], v[20:23]
buffer_load_dwordx4 v[88:91], v1, s[44:47], s82 offen offset:2048 sc1
v_mfma_f32_16x16x32_bf16 v[20:23], v[212:215], a[132:135], v[20:23]
s_nop 0
ds_read_b64_tr_b16 v[156:157], v11 offset:20480
ds_read_b64_tr_b16 v[158:159], v11 offset:22528
v_mfma_f32_16x16x32_bf16 v[20:23], v[196:199], a[128:131], v[20:23]
v_mul_f32 v114, v114, v113
v_mul_f32 v63, v63, v115
v_mfma_f32_16x16x32_bf16 v[20:23], v[120:123], v[96:99], v[20:23]
s_nop 0
ds_read_b64_tr_b16 v[160:161], v8 offset:24576
ds_read_b64_tr_b16 v[162:163], v8 offset:26624
v_mfma_f32_16x16x32_bf16 v[24:27], v[200:203], a[128:131], v[24:27]
s_nop 0
ds_read_b64_tr_b16 v[164:165], v9 offset:24576
ds_read_b64_tr_b16 v[166:167], v9 offset:26624
v_mfma_f32_16x16x32_bf16 v[24:27], v[216:219], a[132:135], v[24:27]
buffer_load_dwordx4 v[92:95], v1, s[44:47], s82 offen offset:3072 sc1
v_mfma_f32_16x16x32_bf16 v[24:27], v[232:235], a[136:139], v[24:27]
v_mul_f32 v79, v79, v114
v_mfma_f32_16x16x32_bf16 v[24:27], v[248:251], a[140:143], v[24:27]
s_nop 0
ds_read_b64_tr_b16 v[168:169], v10 offset:24576
ds_read_b64_tr_b16 v[170:171], v10 offset:26624
v_mfma_f32_16x16x32_bf16 v[24:27], v[124:127], v[100:103], v[24:27]
v_mfma_f32_16x16x32_bf16 v[40:43], v[248:251], a[156:159], v[40:43]
s_nop 0
ds_read_b64_tr_b16 v[172:173], v11 offset:24576
ds_read_b64_tr_b16 v[174:175], v11 offset:26624
v_mfma_f32_16x16x32_bf16 v[40:43], v[232:235], a[152:155], v[40:43]
v_mfma_f32_16x16x32_bf16 v[40:43], v[216:219], a[148:151], v[40:43]
s_nop 0
ds_read_b64_tr_b16 v[176:177], v8 offset:28672
ds_read_b64_tr_b16 v[178:179], v8 offset:30720
v_mfma_f32_16x16x32_bf16 v[40:43], v[200:203], a[144:147], v[40:43]
v_mfma_f32_16x16x32_bf16 v[40:43], v[124:127], v[108:111], v[40:43]
s_nop 0
ds_read_b64_tr_b16 v[180:181], v9 offset:28672
ds_read_b64_tr_b16 v[182:183], v9 offset:30720
v_mfma_f32_16x16x32_bf16 v[44:47], v[204:207], a[144:147], v[44:47]
v_mfma_f32_16x16x32_bf16 v[44:47], v[220:223], a[148:151], v[44:47]
s_nop 0
ds_read_b64_tr_b16 v[184:185], v10 offset:28672
ds_read_b64_tr_b16 v[186:187], v10 offset:30720
v_mfma_f32_16x16x32_bf16 v[44:47], v[236:239], a[152:155], v[44:47]
v_mfma_f32_16x16x32_bf16 v[44:47], v[252:255], a[156:159], v[44:47]
s_nop 0
ds_read_b64_tr_b16 v[188:189], v11 offset:28672
ds_read_b64_tr_b16 v[190:191], v11 offset:30720
v_mfma_f32_16x16x32_bf16 v[44:47], v[120:123], v[108:111], v[44:47]
v_mfma_f32_16x16x32_bf16 v[28:31], v[252:255], a[140:143], v[28:31]
v_mfma_f32_16x16x32_bf16 v[28:31], v[236:239], a[136:139], v[28:31]
v_mfma_f32_16x16x32_bf16 v[28:31], v[220:223], a[132:135], v[28:31]
v_mfma_f32_16x16x32_bf16 v[28:31], v[204:207], a[128:131], v[28:31]
s_waitcnt vmcnt(16) lgkmcnt(0)
v_mfma_f32_16x16x32_bf16 v[28:31], v[120:123], v[100:103], v[28:31]
s_barrier
v_mfma_f32_16x16x32_bf16 v[16:19], v[128:131], a[160:163], v[16:19]
s_nop 0
ds_read_b64_tr_b16 v[192:193], v8 offset:32768
ds_read_b64_tr_b16 v[194:195], v8 offset:34816
v_mfma_f32_16x16x32_bf16 v[16:19], v[144:147], a[164:167], v[16:19]
s_nop 0
ds_read_b64_tr_b16 v[196:197], v9 offset:32768
ds_read_b64_tr_b16 v[198:199], v9 offset:34816
v_mfma_f32_16x16x32_bf16 v[16:19], v[160:163], a[168:171], v[16:19]
s_nop 0
ds_read_b64_tr_b16 v[200:201], v10 offset:32768
ds_read_b64_tr_b16 v[202:203], v10 offset:34816
v_mfma_f32_16x16x32_bf16 v[16:19], v[176:179], a[172:175], v[16:19]
v_mfma_f32_16x16x32_bf16 v[32:35], v[176:179], a[188:191], v[32:35]
s_nop 0
ds_read_b64_tr_b16 v[204:205], v11 offset:32768
ds_read_b64_tr_b16 v[206:207], v11 offset:34816
v_mfma_f32_16x16x32_bf16 v[32:35], v[160:163], a[184:187], v[32:35]
s_nop 0
ds_read_b64_tr_b16 v[208:209], v8 offset:36864
ds_read_b64_tr_b16 v[210:211], v8 offset:38912
v_mfma_f32_16x16x32_bf16 v[32:35], v[144:147], a[180:183], v[32:35]
s_add_u32 s81, s93, 0x4200000
buffer_load_dwordx4 v[96:99], v1, s[44:47], s81 offen sc1
v_mfma_f32_16x16x32_bf16 v[32:35], v[128:131], a[176:179], v[32:35]
v_mfma_f32_16x16x32_bf16 v[36:39], v[132:135], a[176:179], v[36:39]
s_nop 0
ds_read_b64_tr_b16 v[212:213], v9 offset:36864
ds_read_b64_tr_b16 v[214:215], v9 offset:38912
v_mfma_f32_16x16x32_bf16 v[36:39], v[148:151], a[180:183], v[36:39]
s_nop 0
ds_read_b64_tr_b16 v[216:217], v10 offset:36864
ds_read_b64_tr_b16 v[218:219], v10 offset:38912
v_mfma_f32_16x16x32_bf16 v[36:39], v[164:167], a[184:187], v[36:39]
v_mfma_f32_16x16x32_bf16 v[36:39], v[180:183], a[188:191], v[36:39]
buffer_load_dwordx4 v[100:103], v1, s[44:47], s81 offen offset:1024 sc1
v_mfma_f32_16x16x32_bf16 v[20:23], v[180:183], a[172:175], v[20:23]
s_nop 0
ds_read_b64_tr_b16 v[220:221], v11 offset:36864
ds_read_b64_tr_b16 v[222:223], v11 offset:38912
v_mfma_f32_16x16x32_bf16 v[20:23], v[164:167], a[168:171], v[20:23]
s_nop 0
ds_read_b64_tr_b16 v[224:225], v8 offset:40960
ds_read_b64_tr_b16 v[226:227], v8 offset:43008
v_mfma_f32_16x16x32_bf16 v[20:23], v[148:151], a[164:167], v[20:23]
s_nop 0
ds_read_b64_tr_b16 v[228:229], v9 offset:40960
ds_read_b64_tr_b16 v[230:231], v9 offset:43008
v_mfma_f32_16x16x32_bf16 v[20:23], v[132:135], a[160:163], v[20:23]
v_mfma_f32_16x16x32_bf16 v[24:27], v[136:139], a[160:163], v[24:27]
buffer_load_dwordx4 v[104:107], v1, s[44:47], s81 offen offset:2048 sc1
v_mfma_f32_16x16x32_bf16 v[24:27], v[152:155], a[164:167], v[24:27]
s_nop 0
ds_read_b64_tr_b16 v[232:233], v10 offset:40960
ds_read_b64_tr_b16 v[234:235], v10 offset:43008
v_mfma_f32_16x16x32_bf16 v[24:27], v[168:171], a[168:171], v[24:27]
s_nop 0
ds_read_b64_tr_b16 v[236:237], v11 offset:40960
ds_read_b64_tr_b16 v[238:239], v11 offset:43008
v_mfma_f32_16x16x32_bf16 v[24:27], v[184:187], a[172:175], v[24:27]
v_mfma_f32_16x16x32_bf16 v[40:43], v[184:187], a[188:191], v[40:43]
s_nop 0
ds_read_b64_tr_b16 v[240:241], v8 offset:45056
ds_read_b64_tr_b16 v[242:243], v8 offset:47104
v_mfma_f32_16x16x32_bf16 v[40:43], v[168:171], a[184:187], v[40:43]
buffer_load_dwordx4 v[108:111], v1, s[44:47], s81 offen offset:3072 sc1
v_mfma_f32_16x16x32_bf16 v[40:43], v[152:155], a[180:183], v[40:43]
s_nop 0
ds_read_b64_tr_b16 v[244:245], v9 offset:45056
ds_read_b64_tr_b16 v[246:247], v9 offset:47104
v_mfma_f32_16x16x32_bf16 v[40:43], v[136:139], a[176:179], v[40:43]
v_mfma_f32_16x16x32_bf16 v[44:47], v[140:143], a[176:179], v[44:47]
s_nop 0
ds_read_b64_tr_b16 v[248:249], v10 offset:45056
ds_read_b64_tr_b16 v[250:251], v10 offset:47104
v_mfma_f32_16x16x32_bf16 v[44:47], v[156:159], a[180:183], v[44:47]
s_nop 0
ds_read_b64_tr_b16 v[252:253], v11 offset:45056
ds_read_b64_tr_b16 v[254:255], v11 offset:47104
v_mfma_f32_16x16x32_bf16 v[44:47], v[172:175], a[184:187], v[44:47]
v_mfma_f32_16x16x32_bf16 v[44:47], v[188:191], a[188:191], v[44:47]
s_waitcnt vmcnt(4)
v_max3_u32 v12, v80, v81, v82
v_max3_u32 v13, v83, v84, v85
v_mfma_f32_16x16x32_bf16 v[28:31], v[188:191], a[172:175], v[28:31]
v_max3_u32 v12, v12, v86, v87
v_max3_u32 v13, v13, v88, v89
v_mfma_f32_16x16x32_bf16 v[28:31], v[172:175], a[168:171], v[28:31]
v_max3_u32 v12, v12, v90, v91
v_max3_u32 v13, v13, v92, v93
v_mfma_f32_16x16x32_bf16 v[28:31], v[156:159], a[164:167], v[28:31]
s_waitcnt vmcnt(15) lgkmcnt(0)
v_max3_u32 v12, v12, v94, v95
v_mfma_f32_16x16x32_bf16 v[28:31], v[140:143], a[160:163], v[28:31]
s_barrier
v_max_u32 v12, v12, v13
v_mfma_f32_16x16x32_bf16 v[16:19], v[192:195], a[192:195], v[16:19]
v_cmp_le_u32 vcc, 0xff800000, v12
v_mfma_f32_16x16x32_bf16 v[16:19], v[208:211], a[196:199], v[16:19]
s_nop 0
ds_read_b64_tr_b16 v[128:129], v8 offset:49152
ds_read_b64_tr_b16 v[130:131], v8 offset:51200
v_mfma_f32_16x16x32_bf16 v[16:19], v[224:227], a[200:203], v[16:19]
s_cbranch_vccnz Lxspin2
Lxback2:
v_mfma_f32_16x16x32_bf16 v[16:19], v[240:243], a[204:207], v[16:19]
s_nop 0
ds_read_b64_tr_b16 v[132:133], v9 offset:49152
ds_read_b64_tr_b16 v[134:135], v9 offset:51200
v_mfma_f32_16x16x32_bf16 v[16:19], v[124:127], v[80:83], v[16:19]
v_mfma_f32_16x16x32_bf16 v[32:35], v[240:243], a[220:223], v[32:35]
s_nop 0
ds_read_b64_tr_b16 v[136:137], v10 offset:49152
ds_read_b64_tr_b16 v[138:139], v10 offset:51200
v_mfma_f32_16x16x32_bf16 v[32:35], v[224:227], a[216:219], v[32:35]
v_mfma_f32_16x16x32_bf16 v[32:35], v[208:211], a[212:215], v[32:35]
s_nop 0
ds_read_b64_tr_b16 v[140:141], v11 offset:49152
ds_read_b64_tr_b16 v[142:143], v11 offset:51200
v_mfma_f32_16x16x32_bf16 v[32:35], v[192:195], a[208:211], v[32:35]
v_mfma_f32_16x16x32_bf16 v[32:35], v[124:127], v[88:91], v[32:35]
s_nop 0
ds_read_b64_tr_b16 v[144:145], v8 offset:53248
ds_read_b64_tr_b16 v[146:147], v8 offset:55296
v_mfma_f32_16x16x32_bf16 v[36:39], v[196:199], a[208:211], v[36:39]
v_mfma_f32_16x16x32_bf16 v[36:39], v[212:215], a[212:215], v[36:39]
s_nop 0
ds_read_b64_tr_b16 v[148:149], v9 offset:53248
ds_read_b64_tr_b16 v[150:151], v9 offset:55296
v_mfma_f32_16x16x32_bf16 v[36:39], v[228:231], a[216:219], v[36:39]
v_mfma_f32_16x16x32_bf16 v[36:39], v[244:247], a[220:223], v[36:39]
s_nop 0
ds_read_b64_tr_b16 v[152:153], v10 offset:53248
ds_read_b64_tr_b16 v[154:155], v10 offset:55296
v_mfma_f32_16x16x32_bf16 v[36:39], v[120:123], v[88:91], v[36:39]
v_mfma_f32_16x16x32_bf16 v[20:23], v[244:247], a[204:207], v[20:23]
s_nop 0
ds_read_b64_tr_b16 v[156:157], v11 offset:53248
ds_read_b64_tr_b16 v[158:159], v11 offset:55296
v_mfma_f32_16x16x32_bf16 v[20:23], v[228:231], a[200:203], v[20:23]
v_mfma_f32_16x16x32_bf16 v[20:23], v[212:215], a[196:199], v[20:23]
v_mfma_f32_16x16x32_bf16 v[20:23], v[196:199], a[192:195], v[20:23]
s_nop 0
ds_read_b64_tr_b16 v[160:161], v8 offset:57344
ds_read_b64_tr_b16 v[162:163], v8 offset:59392
v_mfma_f32_16x16x32_bf16 v[20:23], v[120:123], v[80:83], v[20:23]
Lstube5:
s_cbranch_execz Lrete
v_mfma_f32_16x16x32_bf16 v[24:27], v[200:203], a[192:195], v[24:27]
s_nop 0
ds_read_b64_tr_b16 v[164:165], v9 offset:57344
ds_read_b64_tr_b16 v[166:167], v9 offset:59392
v_mfma_f32_16x16x32_bf16 v[24:27], v[216:219], a[196:199], v[24:27]
v_mfma_f32_16x16x32_bf16 v[24:27], v[232:235], a[200:203], v[24:27]
s_nop 0
ds_read_b64_tr_b16 v[168:169], v10 offset:57344
ds_read_b64_tr_b16 v[170:171], v10 offset:59392
v_mfma_f32_16x16x32_bf16 v[24:27], v[248:251], a[204:207], v[24:27]
v_mfma_f32_16x16x32_bf16 v[24:27], v[124:127], v[84:87], v[24:27]
s_nop 0
ds_read_b64_tr_b16 v[172:173], v11 offset:57344
ds_read_b64_tr_b16 v[174:175], v11 offset:59392
v_mfma_f32_16x16x32_bf16 v[40:43], v[248:251], a[220:223], v[40:43]
v_mfma_f32_16x16x32_bf16 v[40:43], v[232:235], a[216:219], v[40:43]
s_nop 0
ds_read_b64_tr_b16 v[176:177], v8 offset:61440
ds_read_b64_tr_b16 v[178:179], v8 offset:63488
v_mfma_f32_16x16x32_bf16 v[40:43], v[216:219], a[212:215], v[40:43]
v_mfma_f32_16x16x32_bf16 v[40:43], v[200:203], a[208:211], v[40:43]
s_nop 0
ds_read_b64_tr_b16 v[180:181], v9 offset:61440
ds_read_b64_tr_b16 v[182:183], v9 offset:63488
v_mfma_f32_16x16x32_bf16 v[40:43], v[124:127], v[92:95], v[40:43]
v_mfma_f32_16x16x32_bf16 v[44:47], v[204:207], a[208:211], v[44:47]
s_nop 0
ds_read_b64_tr_b16 v[184:185], v10 offset:61440
ds_read_b64_tr_b16 v[186:187], v10 offset:63488
v_mfma_f32_16x16x32_bf16 v[44:47], v[220:223], a[212:215], v[44:47]
v_mfma_f32_16x16x32_bf16 v[44:47], v[236:239], a[216:219], v[44:47]
s_nop 0
ds_read_b64_tr_b16 v[188:189], v11 offset:61440
ds_read_b64_tr_b16 v[190:191], v11 offset:63488
v_mfma_f32_16x16x32_bf16 v[44:47], v[252:255], a[220:223], v[44:47]
v_mfma_f32_16x16x32_bf16 v[44:47], v[120:123], v[92:95], v[44:47]
v_mfma_f32_16x16x32_bf16 v[28:31], v[252:255], a[204:207], v[28:31]
s_waitcnt vmcnt(0)
v_max3_u32 v12, v96, v97, v98
v_max3_u32 v13, v99, v100, v101
v_mfma_f32_16x16x32_bf16 v[28:31], v[236:239], a[200:203], v[28:31]
v_max3_u32 v12, v12, v102, v103
v_max3_u32 v13, v13, v104, v105
v_mfma_f32_16x16x32_bf16 v[28:31], v[220:223], a[196:199], v[28:31]
v_max3_u32 v12, v12, v106, v107
v_max3_u32 v13, v13, v108, v109
v_mfma_f32_16x16x32_bf16 v[28:31], v[204:207], a[192:195], v[28:31]
s_waitcnt lgkmcnt(0)
v_max3_u32 v12, v12, v110, v111
v_mfma_f32_16x16x32_bf16 v[28:31], v[120:123], v[84:87], v[28:31]
v_max_u32 v12, v12, v13
v_mfma_f32_16x16x32_bf16 v[16:19], v[128:131], a[224:227], v[16:19]
v_cmp_le_u32 vcc, 0xff800000, v12
v_mfma_f32_16x16x32_bf16 v[16:19], v[144:147], a[228:231], v[16:19]
v_mfma_f32_16x16x32_bf16 v[16:19], v[160:163], a[232:235], v[16:19]
s_cbranch_vccnz Lxspin3
Lxback3:
v_mfma_f32_16x16x32_bf16 v[16:19], v[176:179], a[236:239], v[16:19]
v_mfma_f32_16x16x32_bf16 v[16:19], v[124:127], v[96:99], v[16:19]
v_mfma_f32_16x16x32_bf16 v[20:23], v[180:183], a[236:239], v[20:23]
v_mfma_f32_16x16x32_bf16 v[20:23], v[164:167], a[232:235], v[20:23]
v_mfma_f32_16x16x32_bf16 v[20:23], v[148:151], a[228:231], v[20:23]
v_mfma_f32_16x16x32_bf16 v[20:23], v[132:135], a[224:227], v[20:23]
s_nop 3
v_fma_f32 v16, v16, v6, v48
v_fma_f32 v17, v17, v6, v64
v_mfma_f32_16x16x32_bf16 v[20:23], v[120:123], v[96:99], v[20:23]
v_fma_f32 v18, v18, v6, v49
v_fma_f32 v19, v19, v6, v65
v_mfma_f32_16x16x32_bf16 v[24:27], v[136:139], a[224:227], v[24:27]
v_cvt_pk_bf16_f32 v16, v16, v17
v_cvt_pk_bf16_f32 v17, v18, v19
v_mfma_f32_16x16x32_bf16 v[24:27], v[152:155], a[228:231], v[24:27]
ds_write_b64 v116, v[16:17] offset:0
v_mfma_f32_16x16x32_bf16 v[24:27], v[168:171], a[232:235], v[24:27]
v_mfma_f32_16x16x32_bf16 v[24:27], v[184:187], a[236:239], v[24:27]
v_fma_f32 v20, v20, v6, v50
v_fma_f32 v21, v21, v6, v66
v_mfma_f32_16x16x32_bf16 v[24:27], v[124:127], v[100:103], v[24:27]
v_fma_f32 v22, v22, v6, v51
v_fma_f32 v23, v23, v6, v67
v_mfma_f32_16x16x32_bf16 v[28:31], v[188:191], a[236:239], v[28:31]
v_cvt_pk_bf16_f32 v20, v20, v21
v_cvt_pk_bf16_f32 v21, v22, v23
v_mfma_f32_16x16x32_bf16 v[28:31], v[172:175], a[232:235], v[28:31]
ds_write_b64 v117, v[20:21] offset:0
v_mfma_f32_16x16x32_bf16 v[28:31], v[156:159], a[228:231], v[28:31]
v_mfma_f32_16x16x32_bf16 v[28:31], v[140:143], a[224:227], v[28:31]
v_fma_f32 v24, v24, v6, v52
v_fma_f32 v25, v25, v6, v68
v_mfma_f32_16x16x32_bf16 v[28:31], v[120:123], v[100:103], v[28:31]
v_fma_f32 v26, v26, v6, v53
v_fma_f32 v27, v27, v6, v69
v_mfma_f32_16x16x32_bf16 v[32:35], v[128:131], a[240:243], v[32:35]
v_cvt_pk_bf16_f32 v24, v24, v25
v_cvt_pk_bf16_f32 v25, v26, v27
v_mfma_f32_16x16x32_bf16 v[32:35], v[144:147], a[244:247], v[32:35]
ds_write_b64 v118, v[24:25] offset:0
v_mfma_f32_16x16x32_bf16 v[32:35], v[160:163], a[248:251], v[32:35]
v_mfma_f32_16x16x32_bf16 v[32:35], v[176:179], a[252:255], v[32:35]
v_fma_f32 v28, v28, v6, v54
v_fma_f32 v29, v29, v6, v70
v_mfma_f32_16x16x32_bf16 v[32:35], v[124:127], v[104:107], v[32:35]
v_fma_f32 v30, v30, v6, v55
v_fma_f32 v31, v31, v6, v71
v_mfma_f32_16x16x32_bf16 v[36:39], v[180:183], a[252:255], v[36:39]
v_cvt_pk_bf16_f32 v28, v28, v29
v_cvt_pk_bf16_f32 v29, v30, v31
v_mfma_f32_16x16x32_bf16 v[36:39], v[164:167], a[248:251], v[36:39]
s_nop 0
ds_write_b64 v119, v[28:29] offset:0
ds_read_b128 v[192:195], v4 offset:0
v_mfma_f32_16x16x32_bf16 v[36:39], v[148:151], a[244:247], v[36:39]
ds_read_b128 v[196:199], v4 offset:1024
v_mfma_f32_16x16x32_bf16 v[36:39], v[132:135], a[240:243], v[36:39]
v_fma_f32 v32, v32, v7, v56
v_fma_f32 v33, v33, v7, v72
v_mfma_f32_16x16x32_bf16 v[36:39], v[120:123], v[104:107], v[36:39]
v_fma_f32 v34, v34, v7, v57
v_fma_f32 v35, v35, v7, v73
v_mfma_f32_16x16x32_bf16 v[40:43], v[136:139], a[240:243], v[40:43]
v_cvt_pk_bf16_f32 v32, v32, v33
v_cvt_pk_bf16_f32 v33, v34, v35
v_mfma_f32_16x16x32_bf16 v[40:43], v[152:155], a[244:247], v[40:43]
ds_write_b64 v116, v[32:33] offset:2048
v_mfma_f32_16x16x32_bf16 v[40:43], v[168:171], a[248:251], v[40:43]
s_waitcnt lgkmcnt(2)
buffer_store_dwordx4 v[192:195], v15, s[40:43], s70 offen sc1
v_mfma_f32_16x16x32_bf16 v[40:43], v[184:187], a[252:255], v[40:43]
s_add_u32 s70, s70, 0x4000
v_mfma_f32_16x16x32_bf16 v[40:43], v[124:127], v[108:111], v[40:43]
v_fma_f32 v36, v36, v7, v58
v_fma_f32 v37, v37, v7, v74
v_mfma_f32_16x16x32_bf16 v[44:47], v[188:191], a[252:255], v[44:47]
v_fma_f32 v38, v38, v7, v59
v_fma_f32 v39, v39, v7, v75
v_mfma_f32_16x16x32_bf16 v[44:47], v[172:175], a[248:251], v[44:47]
v_cvt_pk_bf16_f32 v36, v36, v37
v_cvt_pk_bf16_f32 v37, v38, v39
v_mfma_f32_16x16x32_bf16 v[44:47], v[156:159], a[244:247], v[44:47]
ds_write_b64 v117, v[36:37] offset:2048
v_mfma_f32_16x16x32_bf16 v[44:47], v[140:143], a[240:243], v[44:47]
v_fma_f32 v40, v40, v7, v60
v_fma_f32 v41, v41, v7, v76
v_mfma_f32_16x16x32_bf16 v[44:47], v[120:123], v[108:111], v[44:47]
v_fma_f32 v42, v42, v7, v61
v_fma_f32 v43, v43, v7, v77
v_cvt_pk_bf16_f32 v40, v40, v41
v_cvt_pk_bf16_f32 v41, v42, v43
ds_write_b64 v118, v[40:41] offset:2048
s_waitcnt lgkmcnt(3)
buffer_store_dwordx4 v[196:199], v15, s[40:43], s70 offen sc1
s_add_u32 s70, s70, 0x4000
v_fma_f32 v44, v44, v7, v62
v_fma_f32 v45, v45, v7, v78
v_fma_f32 v46, v46, v7, v63
v_fma_f32 v47, v47, v7, v79
v_cvt_pk_bf16_f32 v44, v44, v45
v_cvt_pk_bf16_f32 v45, v46, v47
ds_write_b64 v119, v[44:45] offset:2048
ds_read_b128 v[200:203], v4 offset:2048
ds_read_b128 v[204:207], v4 offset:3072
s_waitcnt lgkmcnt(1)
buffer_store_dwordx4 v[200:203], v15, s[40:43], s70 offen sc1
s_add_u32 s70, s70, 0x4000
s_waitcnt lgkmcnt(0)
buffer_store_dwordx4 v[204:207], v15, s[40:43], s70 offen sc1
s_add_u32 s70, s70, 0x4000
Lend:
s_endpgm
Lspin1:
s_mov_b32 s83, 262144
Lsl3:
s_sleep 2
buffer_load_dword v3, v2, s[48:51], 0 offen sc1
s_sub_u32 s83, s83, 1
s_cmp_eq_u32 s83, 0
s_waitcnt vmcnt(0)
s_cbranch_scc1 Lback2
v_cmp_gt_u32 vcc, 8, v3
s_cbranch_vccnz Lsl3
s_branch Lback2
Lspin4:
s_mov_b32 s83, 262144
Lsl6:
s_sleep 2
buffer_load_dword v3, v2, s[44:47], s75 offen sc1
s_sub_u32 s83, s83, 1
s_cmp_eq_u32 s83, 0
s_waitcnt vmcnt(0)
s_cbranch_scc1 Lback5
v_cmp_gt_u32 vcc, 1, v3
s_cbranch_vccnz Lsl6
s_branch Lback5
.p2align 12
s_endpgm
.p2align 7
LP0x:
Lstub10:
s_cbranch_execz Lret
s_cmp_eq_u32 s58, 2
s_cbranch_scc1 Lta10
s_cmp_eq_u32 s58, 3
s_cbranch_scc1 Lnt11
v_mfma_f32_16x16x32_bf16 v[160:163], a[160:163], v[16:19], v[112:115]
s_xor_b32 s74, s82, 0x10000
v_exp_f32 v128, v128
v_mfma_f32_16x16x32_bf16 v[176:179], a[176:179], v[16:19], v[112:115]
s_add_u32 s74, s74, s64
ds_read_b128 a[128:131], v2 offset:16384
ds_read_b128 a[132:135], v2 offset:17408
s_branch Ljoin12
Lta10:
v_mfma_f32_16x16x32_bf16 v[160:163], a[160:163], v[16:19], v[96:99]
s_xor_b32 s74, s82, 0x10000
v_exp_f32 v128, v128
v_mfma_f32_16x16x32_bf16 v[176:179], a[176:179], v[16:19], v[112:115]
s_add_u32 s74, s74, s64
ds_read_b128 a[128:131], v2 offset:16384
ds_read_b128 a[132:135], v2 offset:17408
s_branch Ljoin12
Lnt11:
v_mfma_f32_16x16x32_bf16 v[160:163], a[160:163], v[16:19], v[80:83]
s_xor_b32 s74, s82, 0x10000
v_exp_f32 v128, v128
v_mfma_f32_16x16x32_bf16 v[176:179], a[176:179], v[16:19], v[96:99]
s_add_u32 s74, s74, s64
ds_read_b128 a[128:131], v2 offset:16384
ds_read_b128 a[132:135], v2 offset:17408
Ljoin12:
v_mfma_f32_16x16x32_bf16 v[164:167], a[160:163], v[32:35], v[84:87]
s_add_u32 s81, s81, 0x8000
v_exp_f32 v129, v129
v_mfma_f32_16x16x32_bf16 v[164:167], a[164:167], v[36:39], v[164:167]
s_add_u32 m0, s74, 16384
v_exp_f32 v130, v130
v_mfma_f32_16x16x32_bf16 v[164:167], a[168:171], v[40:43], v[164:167]
s_add_u32 s72, s81, 16384
v_exp_f32 v131, v131
v_mfma_f32_16x16x32_bf16 v[164:167], a[172:175], v[44:47], v[164:167]
v_exp_f32 v144, v144
v_mfma_f32_16x16x32_bf16 v[172:175], a[172:175], v[76:79], v[92:95]
s_nop 0
ds_read_b128 a[136:139], v2 offset:18432
ds_read_b128 a[140:143], v2 offset:19456
v_mfma_f32_16x16x32_bf16 v[172:175], a[168:171], v[72:75], v[172:175]
s_nop 0
ds_read_b128 a[144:147], v2 offset:20480
ds_read_b128 a[148:151], v2 offset:21504
v_mfma_f32_16x16x32_bf16 v[172:175], a[164:167], v[68:71], v[172:175]
s_nop 0
ds_read_b128 a[152:155], v2 offset:22528
ds_read_b128 a[156:159], v2 offset:23552
v_mfma_f32_16x16x32_bf16 v[172:175], a[160:163], v[64:67], v[172:175]
s_nop 0
ds_read_b128 a[192:195], v2 offset:0
ds_read_b128 a[196:199], v2 offset:1024
v_mfma_f32_16x16x32_bf16 v[188:191], a[176:179], v[64:67], v[92:95]
s_nop 0
ds_read_b128 a[200:203], v2 offset:2048
ds_read_b128 a[204:207], v2 offset:3072
v_mfma_f32_16x16x32_bf16 v[188:191], a[180:183], v[68:71], v[188:191]
s_nop 0
ds_read_b128 a[208:211], v2 offset:4096
ds_read_b128 a[212:215], v2 offset:5120
v_mfma_f32_16x16x32_bf16 v[188:191], a[184:187], v[72:75], v[188:191]
s_nop 0
ds_read_b128 a[216:219], v2 offset:6144
ds_read_b128 a[220:223], v2 offset:7168
v_mfma_f32_16x16x32_bf16 v[188:191], a[188:191], v[76:79], v[188:191]
v_cvt_pk_bf16_f32 v192, v128, v129
v_cvt_pk_bf16_f32 v193, v130, v131
v_mfma_f32_16x16x32_bf16 v[180:183], a[188:191], v[44:47], v[84:87]
buffer_load_dwordx4 v1, s[44:47], s72 offen sc1 lds
v_mfma_f32_16x16x32_bf16 v[180:183], a[184:187], v[40:43], v[180:183]
v_exp_f32 v145, v145
v_mfma_f32_16x16x32_bf16 v[180:183], a[180:183], v[36:39], v[180:183]
v_exp_f32 v146, v146
v_mfma_f32_16x16x32_bf16 v[180:183], a[176:179], v[32:35], v[180:183]
v_exp_f32 v147, v147
v_mfma_f32_16x16x32_bf16 v[160:163], a[164:167], v[20:23], v[160:163]
v_exp_f32 v136, v136
v_mfma_f32_16x16x32_bf16 v[160:163], a[168:171], v[24:27], v[160:163]
v_cvt_pk_bf16_f32 v194, v144, v145
v_cvt_pk_bf16_f32 v195, v146, v147
v_mfma_f32_16x16x32_bf16 v[160:163], a[172:175], v[28:31], v[160:163]
v_exp_f32 v137, v137
v_mfma_f32_16x16x32_bf16 v[168:171], a[172:175], v[60:63], v[88:91]
v_exp_f32 v138, v138
v_mfma_f32_16x16x32_bf16 v[168:171], a[168:171], v[56:59], v[168:171]
v_exp_f32 v139, v139
v_mfma_f32_16x16x32_bf16 v[168:171], a[164:167], v[52:55], v[168:171]
v_exp_f32 v152, v152
v_mfma_f32_16x16x32_bf16 v[168:171], a[160:163], v[48:51], v[168:171]
v_cvt_pk_bf16_f32 v200, v136, v137
v_cvt_pk_bf16_f32 v201, v138, v139
v_mfma_f32_16x16x32_bf16 v[184:187], a[176:179], v[48:51], v[88:91]
buffer_load_dwordx4 v1, s[44:47], s72 offen offset:1024 sc1 lds
v_mfma_f32_16x16x32_bf16 v[184:187], a[180:183], v[52:55], v[184:187]
v_exp_f32 v153, v153
v_mfma_f32_16x16x32_bf16 v[184:187], a[184:187], v[56:59], v[184:187]
v_exp_f32 v154, v154
v_mfma_f32_16x16x32_bf16 v[184:187], a[188:191], v[60:63], v[184:187]
v_exp_f32 v155, v155
v_mfma_f32_16x16x32_bf16 v[176:179], a[188:191], v[28:31], v[176:179]
buffer_load_dwordx4 v1, s[44:47], s72 offen offset:2048 sc1 lds
v_mfma_f32_16x16x32_bf16 v[176:179], a[184:187], v[24:27], v[176:179]
buffer_load_dwordx4 v1, s[44:47], s72 offen offset:3072 sc1 lds
v_mfma_f32_16x16x32_bf16 v[176:179], a[180:183], v[20:23], v[176:179]
s_waitcnt lgkmcnt(4)
v_exp_f32 v132, v132
v_cvt_pk_bf16_f32 v202, v152, v153
v_cvt_pk_bf16_f32 v203, v154, v155
v_exp_f32 v133, v133
v_exp_f32 v134, v134
v_cvt_pk_bf16_f32 v196, v132, v133
v_exp_f32 v135, v135
v_exp_f32 v148, v148
v_cvt_pk_bf16_f32 v197, v134, v135
v_exp_f32 v149, v149
v_exp_f32 v150, v150
v_cvt_pk_bf16_f32 v198, v148, v149
v_exp_f32 v151, v151
v_exp_f32 v140, v140
v_cvt_pk_bf16_f32 v199, v150, v151
v_exp_f32 v141, v141
v_exp_f32 v142, v142
v_cvt_pk_bf16_f32 v204, v140, v141
v_exp_f32 v143, v143
v_exp_f32 v156, v156
v_cvt_pk_bf16_f32 v205, v142, v143
v_exp_f32 v157, v157
v_exp_f32 v158, v158
v_cvt_pk_bf16_f32 v206, v156, v157
v_exp_f32 v159, v159
s_nop 0
v_cvt_pk_bf16_f32 v207, v158, v159
v_mfma_f32_16x16x32_bf16 v[224:227], v[120:123], v[192:195], 0
s_add_u32 s82, s82, 0x8000
ds_read_b128 a[160:163], v2 offset:24576
ds_read_b128 a[164:167], v2 offset:25600
v_mfma_f32_16x16x32_bf16 v[232:235], v[120:123], v[200:203], 0
s_and_b32 s82, s82, 0x1ffff
v_exp_f32 v164, v164
v_mfma_f32_16x16x32_bf16 a[0:3], a[192:195], v[192:195], 0
s_add_u32 m0, s74, 0
v_exp_f32 v165, v165
v_mfma_f32_16x16x32_bf16 a[64:67], a[192:195], v[200:203], 0
s_add_u32 s72, s81, 0
v_exp_f32 v166, v166
v_mfma_f32_16x16x32_bf16 a[68:71], a[196:199], v[200:203], 0
buffer_load_dwordx4 v1, s[44:47], s72 offen sc1 lds
v_mfma_f32_16x16x32_bf16 a[4:7], a[196:199], v[192:195], 0
v_exp_f32 v167, v167
v_mfma_f32_16x16x32_bf16 a[8:11], a[200:203], v[192:195], 0
s_nop 0
ds_read_b128 a[168:171], v2 offset:26624
ds_read_b128 a[172:175], v2 offset:27648
v_mfma_f32_16x16x32_bf16 a[72:75], a[200:203], v[200:203], 0
v_exp_f32 v180, v180
v_mfma_f32_16x16x32_bf16 a[76:79], a[204:207], v[200:203], 0
s_nop 0
ds_read_b128 a[176:179], v2 offset:28672
ds_read_b128 a[180:183], v2 offset:29696
v_mfma_f32_16x16x32_bf16 a[12:15], a[204:207], v[192:195], 0
s_waitcnt lgkmcnt(6)
ds_read_b128 a[184:187], v2 offset:30720
ds_read_b128 a[188:191], v2 offset:31744
v_mfma_f32_16x16x32_bf16 a[16:19], a[208:211], v[192:195], 0
s_nop 0
ds_read_b128 a[224:227], v2 offset:8192
ds_read_b128 a[228:231], v2 offset:9216
v_mfma_f32_16x16x32_bf16 a[80:83], a[208:211], v[200:203], 0
s_nop 0
ds_read_b128 a[232:235], v2 offset:10240
ds_read_b128 a[236:239], v2 offset:11264
v_mfma_f32_16x16x32_bf16 a[84:87], a[212:215], v[200:203], 0
s_nop 0
ds_read_b128 a[240:243], v2 offset:12288
ds_read_b128 a[244:247], v2 offset:13312
v_mfma_f32_16x16x32_bf16 a[20:23], a[212:215], v[192:195], 0
s_nop 0
ds_read_b128 a[248:251], v2 offset:14336
ds_read_b128 a[252:255], v2 offset:15360
v_mfma_f32_16x16x32_bf16 a[24:27], a[216:219], v[192:195], 0
v_cvt_pk_bf16_f32 v212, v164, v165
v_cvt_pk_bf16_f32 v213, v166, v167
v_mfma_f32_16x16x32_bf16 a[88:91], a[216:219], v[200:203], 0
v_exp_f32 v181, v181
v_mfma_f32_16x16x32_bf16 a[92:95], a[220:223], v[200:203], 0
v_exp_f32 v182, v182
v_mfma_f32_16x16x32_bf16 a[28:31], a[220:223], v[192:195], 0
buffer_load_dwordx4 v1, s[44:47], s72 offen offset:1024 sc1 lds
s_cmp_eq_u32 s58, 0
s_cbranch_scc1 Lta13
s_cmp_eq_u32 s58, 1
s_cbranch_scc1 Lnt14
v_mfma_f32_16x16x32_bf16 v[132:135], a[128:131], v[32:35], v[84:87]
v_exp_f32 v183, v183
v_mfma_f32_16x16x32_bf16 v[148:151], a[144:147], v[32:35], v[84:87]
v_exp_f32 v172, v172
s_branch Ljoin15
Lta13:
v_mfma_f32_16x16x32_bf16 v[132:135], a[128:131], v[32:35], v[100:103]
v_exp_f32 v183, v183
v_mfma_f32_16x16x32_bf16 v[148:151], a[144:147], v[32:35], v[112:115]
v_exp_f32 v172, v172
s_branch Ljoin15
Lnt14:
v_mfma_f32_16x16x32_bf16 v[132:135], a[128:131], v[32:35], v[84:87]
v_exp_f32 v183, v183
v_mfma_f32_16x16x32_bf16 v[148:151], a[144:147], v[32:35], v[100:103]
v_exp_f32 v172, v172
Ljoin15:
v_mfma_f32_16x16x32_bf16 v[136:139], a[128:131], v[48:51], v[88:91]
v_cvt_pk_bf16_f32 v214, v180, v181
v_cvt_pk_bf16_f32 v215, v182, v183
v_mfma_f32_16x16x32_bf16 v[136:139], a[132:135], v[52:55], v[136:139]
v_exp_f32 v173, v173
v_mfma_f32_16x16x32_bf16 v[136:139], a[136:139], v[56:59], v[136:139]
buffer_load_dwordx4 v1, s[44:47], s72 offen offset:2048 sc1 lds
v_mfma_f32_16x16x32_bf16 v[136:139], a[140:143], v[60:63], v[136:139]
v_exp_f32 v174, v174
v_mfma_f32_16x16x32_bf16 v[152:155], a[156:159], v[60:63], v[88:91]
v_exp_f32 v175, v175
v_mfma_f32_16x16x32_bf16 v[152:155], a[152:155], v[56:59], v[152:155]
v_exp_f32 v188, v188
v_mfma_f32_16x16x32_bf16 v[152:155], a[148:151], v[52:55], v[152:155]
v_cvt_pk_bf16_f32 v220, v172, v173
v_cvt_pk_bf16_f32 v221, v174, v175
v_mfma_f32_16x16x32_bf16 v[152:155], a[144:147], v[48:51], v[152:155]
v_exp_f32 v189, v189
v_mfma_f32_16x16x32_bf16 v[132:135], a[132:135], v[36:39], v[132:135]
buffer_load_dwordx4 v1, s[44:47], s72 offen offset:3072 sc1 lds
v_mfma_f32_16x16x32_bf16 v[132:135], a[136:139], v[40:43], v[132:135]
s_add_u32 s66, s58, 1
v_exp_f32 v190, v190
v_mfma_f32_16x16x32_bf16 v[132:135], a[140:143], v[44:47], v[132:135]
s_and_b32 s66, s66, 3
v_exp_f32 v191, v191
v_mfma_f32_16x16x32_bf16 v[140:143], a[140:143], v[76:79], v[92:95]
s_mul_i32 s66, s66, 4160
v_exp_f32 v160, v160
v_mfma_f32_16x16x32_bf16 v[140:143], a[136:139], v[72:75], v[140:143]
s_add_u32 m0, s66, 131104
v_cvt_pk_bf16_f32 v222, v188, v189
v_cvt_pk_bf16_f32 v223, v190, v191
v_mfma_f32_16x16x32_bf16 v[140:143], a[132:135], v[68:71], v[140:143]
s_add_u32 s72, s93, 0x2
v_exp_f32 v161, v161
v_mfma_f32_16x16x32_bf16 v[140:143], a[128:131], v[64:67], v[140:143]
buffer_load_dwordx4 v1, s[36:39], s72 offen lds
v_mfma_f32_16x16x32_bf16 v[156:159], a[144:147], v[64:67], v[92:95]
v_exp_f32 v162, v162
v_mfma_f32_16x16x32_bf16 v[156:159], a[148:151], v[68:71], v[156:159]
v_exp_f32 v163, v163
v_mfma_f32_16x16x32_bf16 v[156:159], a[152:155], v[72:75], v[156:159]
buffer_load_dwordx4 v1, s[36:39], s72 offen offset:1024 lds
v_mfma_f32_16x16x32_bf16 v[156:159], a[156:159], v[76:79], v[156:159]
buffer_load_dwordx4 v1, s[36:39], s72 offen offset:2048 lds
v_mfma_f32_16x16x32_bf16 v[148:151], a[156:159], v[44:47], v[148:151]
buffer_load_dwordx4 v1, s[36:39], s72 offen offset:3072 lds
v_mfma_f32_16x16x32_bf16 v[148:151], a[152:155], v[40:43], v[148:151]
s_waitcnt vmcnt(12) lgkmcnt(4)
v_exp_f32 v176, v176
v_mfma_f32_16x16x32_bf16 v[148:151], a[148:151], v[36:39], v[148:151]
s_barrier
v_cvt_pk_bf16_f32 v208, v160, v161
v_cvt_pk_bf16_f32 v209, v162, v163
v_add_u32 v2, s82, v1
v_exp_f32 v177, v177
v_exp_f32 v178, v178
v_cvt_pk_bf16_f32 v210, v176, v177
v_exp_f32 v179, v179
v_exp_f32 v168, v168
v_cvt_pk_bf16_f32 v211, v178, v179
v_exp_f32 v169, v169
v_exp_f32 v170, v170
v_cvt_pk_bf16_f32 v216, v168, v169
v_exp_f32 v171, v171
v_exp_f32 v184, v184
v_cvt_pk_bf16_f32 v217, v170, v171
v_exp_f32 v185, v185
v_exp_f32 v186, v186
v_cvt_pk_bf16_f32 v218, v184, v185
v_exp_f32 v187, v187
s_nop 0
v_cvt_pk_bf16_f32 v219, v186, v187
s_branch LLT3
.p2align 12
s_endpgm
.p2align 7
LLT3x:
Lstub11:
s_cbranch_execz Lret
v_mfma_f32_16x16x32_bf16 v[228:231], v[120:123], v[196:199], v[228:231]
s_xor_b32 s74, s82, 0x10000
ds_read_b128 a[128:131], v2 offset:16384
v_and_b32 v240, 15, v0
v_mfma_f32_16x16x32_bf16 v[228:231], v[120:123], v[212:215], v[228:231]
s_add_u32 s74, s74, s64
v_exp_f32 v136, v136
v_mfma_f32_16x16x32_bf16 v[236:239], v[120:123], v[204:207], v[236:239]
s_add_u32 s81, s81, 0x8000
v_exp_f32 v137, v137
v_mfma_f32_16x16x32_bf16 v[236:239], v[120:123], v[220:223], v[236:239]
s_add_u32 m0, s74, 0
ds_read_b128 a[132:135], v2 offset:17408
v_cvt_pk_bf16_f32 v200, v136, v137
v_mfma_f32_16x16x32_bf16 a[32:35], a[192:195], v[196:199], a[32:35]
s_add_u32 s72, s81, 0
buffer_load_dwordx4 v1, s[44:47], s72 offen sc1 lds
v_mfma_f32_16x16x32_bf16 a[32:35], a[224:227], v[212:215], a[32:35]
s_add_u32 s69, s93, 0x3e00000
v_exp_f32 v138, v138
v_mfma_f32_16x16x32_bf16 a[96:99], a[224:227], v[220:223], a[96:99]
ds_read_b128 a[136:139], v2 offset:18432
v_lshrrev_b32 v241, 4, v0
v_mfma_f32_16x16x32_bf16 a[96:99], a[192:195], v[204:207], a[96:99]
v_exp_f32 v139, v139
v_mfma_f32_16x16x32_bf16 a[100:103], a[196:199], v[204:207], a[100:103]
buffer_store_dwordx4 v[112:115], v1, s[44:47], s69 offen sc1
v_mfma_f32_16x16x32_bf16 a[100:103], a[228:231], v[220:223], a[100:103]
v_exp_f32 v152, v152
v_mfma_f32_16x16x32_bf16 a[36:39], a[228:231], v[212:215], a[36:39]
ds_read_b128 a[140:143], v2 offset:19456
v_cvt_pk_bf16_f32 v201, v138, v139
v_mfma_f32_16x16x32_bf16 a[36:39], a[196:199], v[196:199], a[36:39]
v_exp_f32 v153, v153
v_mfma_f32_16x16x32_bf16 a[40:43], a[200:203], v[196:199], a[40:43]
buffer_load_dwordx4 v1, s[44:47], s72 offen offset:1024 sc1 lds
v_mfma_f32_16x16x32_bf16 a[40:43], a[232:235], v[212:215], a[40:43]
ds_read_b128 a[144:147], v2 offset:20480
v_cvt_pk_bf16_f32 v202, v152, v153
v_mfma_f32_16x16x32_bf16 a[104:107], a[232:235], v[220:223], a[104:107]
v_exp_f32 v154, v154
v_mfma_f32_16x16x32_bf16 a[104:107], a[200:203], v[204:207], a[104:107]
v_exp_f32 v155, v155
v_mfma_f32_16x16x32_bf16 a[108:111], a[204:207], v[204:207], a[108:111]
buffer_store_dwordx4 v[112:115], v1, s[44:47], s69 offen offset:1024 sc1
v_mfma_f32_16x16x32_bf16 a[108:111], a[236:239], v[220:223], a[108:111]
ds_read_b128 a[148:151], v2 offset:21504
v_cvt_pk_bf16_f32 v203, v154, v155
v_mfma_f32_16x16x32_bf16 a[44:47], a[236:239], v[212:215], a[44:47]
v_exp_f32 v132, v132
v_mfma_f32_16x16x32_bf16 a[44:47], a[204:207], v[196:199], a[44:47]
ds_read_b128 a[152:155], v2 offset:22528
v_add_u32 v248, 1, v240
v_mfma_f32_16x16x32_bf16 a[48:51], a[208:211], v[196:199], a[48:51]
s_waitcnt lgkmcnt(7)
v_exp_f32 v133, v133
v_mfma_f32_16x16x32_bf16 a[48:51], a[240:243], v[212:215], a[48:51]
buffer_load_dwordx4 v1, s[44:47], s72 offen offset:2048 sc1 lds
v_mfma_f32_16x16x32_bf16 a[112:115], a[240:243], v[220:223], a[112:115]
v_exp_f32 v134, v134
v_mfma_f32_16x16x32_bf16 a[112:115], a[208:211], v[204:207], a[112:115]
ds_read_b128 a[156:159], v2 offset:23552
v_and_b32 v249, 3, v248
v_mfma_f32_16x16x32_bf16 a[116:119], a[212:215], v[204:207], a[116:119]
v_exp_f32 v135, v135
v_mfma_f32_16x16x32_bf16 a[116:119], a[244:247], v[220:223], a[116:119]
buffer_store_dwordx4 v[112:115], v1, s[44:47], s69 offen offset:2048 sc1
v_mfma_f32_16x16x32_bf16 a[52:55], a[244:247], v[212:215], a[52:55]
ds_read_b128 a[192:195], v2 offset:0
v_lshrrev_b32 v248, 2, v248
v_mfma_f32_16x16x32_bf16 a[52:55], a[212:215], v[196:199], a[52:55]
v_exp_f32 v148, v148
v_mfma_f32_16x16x32_bf16 a[56:59], a[216:219], v[196:199], a[56:59]
buffer_load_dwordx4 v1, s[44:47], s72 offen offset:3072 sc1 lds
v_mfma_f32_16x16x32_bf16 a[56:59], a[248:251], v[212:215], a[56:59]
v_exp_f32 v149, v149
v_mfma_f32_16x16x32_bf16 a[120:123], a[248:251], v[220:223], a[120:123]
ds_read_b128 a[196:199], v2 offset:1024
v_mov_b32 v250, 0x20000
v_mfma_f32_16x16x32_bf16 a[120:123], a[216:219], v[204:207], a[120:123]
v_exp_f32 v150, v150
v_mfma_f32_16x16x32_bf16 a[124:127], a[220:223], v[204:207], a[124:127]
ds_read_b128 a[200:203], v2 offset:2048
v_mov_b32 v252, 0x20001
v_mfma_f32_16x16x32_bf16 a[124:127], a[252:255], v[220:223], a[124:127]
buffer_store_dwordx4 v[112:115], v1, s[44:47], s69 offen offset:3072 sc1
v_mfma_f32_16x16x32_bf16 a[60:63], a[252:255], v[212:215], a[60:63]
s_add_u32 s69, s93, 0x4200000
v_exp_f32 v151, v151
v_mfma_f32_16x16x32_bf16 a[60:63], a[220:223], v[196:199], a[60:63]
ds_read_b128 a[204:207], v2 offset:3072
v_cvt_pk_bf16_f32 v196, v132, v133
s_cmp_eq_u32 s58, 2
s_cbranch_scc1 Lta40
s_cmp_eq_u32 s58, 3
s_cbranch_scc1 Lnt41
v_mfma_f32_16x16x32_bf16 v[164:167], a[160:163], v[32:35], v[112:115]
ds_read_b128 a[208:211], v2 offset:4096
v_cvt_pk_bf16_f32 v197, v134, v135
v_mfma_f32_16x16x32_bf16 v[180:183], a[176:179], v[32:35], v[112:115]
v_exp_f32 v140, v140
s_branch Ljoin42
Lta40:
v_mfma_f32_16x16x32_bf16 v[164:167], a[160:163], v[32:35], v[100:103]
ds_read_b128 a[208:211], v2 offset:4096
v_cvt_pk_bf16_f32 v197, v134, v135
v_mfma_f32_16x16x32_bf16 v[180:183], a[176:179], v[32:35], v[112:115]
v_exp_f32 v140, v140
s_branch Ljoin42
Lnt41:
v_mfma_f32_16x16x32_bf16 v[164:167], a[160:163], v[32:35], v[84:87]
ds_read_b128 a[208:211], v2 offset:4096
v_cvt_pk_bf16_f32 v197, v134, v135
v_mfma_f32_16x16x32_bf16 v[180:183], a[176:179], v[32:35], v[100:103]
v_exp_f32 v140, v140
Ljoin42:
v_mfma_f32_16x16x32_bf16 v[164:167], a[164:167], v[36:39], v[164:167]
ds_read_b128 a[212:215], v2 offset:5120
v_cvt_pk_bf16_f32 v198, v148, v149
v_mfma_f32_16x16x32_bf16 v[164:167], a[168:171], v[40:43], v[164:167]
buffer_store_dwordx4 v[112:115], v1, s[44:47], s69 offen sc1
v_mfma_f32_16x16x32_bf16 v[164:167], a[172:175], v[44:47], v[164:167]
v_exp_f32 v141, v141
v_mfma_f32_16x16x32_bf16 v[172:175], a[172:175], v[76:79], v[92:95]
v_exp_f32 v142, v142
v_mfma_f32_16x16x32_bf16 v[172:175], a[168:171], v[72:75], v[172:175]
ds_read_b128 a[216:219], v2 offset:6144
v_cvt_pk_bf16_f32 v199, v150, v151
v_mfma_f32_16x16x32_bf16 v[172:175], a[164:167], v[68:71], v[172:175]
buffer_store_dwordx4 v[112:115], v1, s[44:47], s69 offen offset:1024 sc1
v_mfma_f32_16x16x32_bf16 v[172:175], a[160:163], v[64:67], v[172:175]
v_exp_f32 v143, v143
v_mfma_f32_16x16x32_bf16 v[188:191], a[176:179], v[64:67], v[92:95]
v_exp_f32 v156, v156
v_mfma_f32_16x16x32_bf16 v[188:191], a[180:183], v[68:71], v[188:191]
ds_read_b128 a[220:223], v2 offset:7168
v_cvt_pk_bf16_f32 v204, v140, v141
v_mfma_f32_16x16x32_bf16 v[188:191], a[184:187], v[72:75], v[188:191]
buffer_store_dwordx4 v[112:115], v1, s[44:47], s69 offen offset:2048 sc1
v_mfma_f32_16x16x32_bf16 v[188:191], a[188:191], v[76:79], v[188:191]
v_exp_f32 v157, v157
v_mfma_f32_16x16x32_bf16 v[180:183], a[188:191], v[44:47], v[180:183]
v_exp_f32 v158, v158
v_mfma_f32_16x16x32_bf16 v[180:183], a[184:187], v[40:43], v[180:183]
v_cvt_pk_bf16_f32 v205, v142, v143
v_cvt_pk_bf16_f32 v206, v156, v157
v_mfma_f32_16x16x32_bf16 v[180:183], a[180:183], v[36:39], v[180:183]
buffer_store_dwordx4 v[112:115], v1, s[44:47], s69 offen offset:3072 sc1
v_mfma_f32_16x16x32_bf16 v[168:171], a[160:163], v[48:51], v[88:91]
v_exp_f32 v159, v159
v_mfma_f32_16x16x32_bf16 v[168:171], a[164:167], v[52:55], v[168:171]
v_cvt_pk_bf16_f32 v207, v158, v159
v_lshlrev_b32 v6, 3, v249
v_mfma_f32_16x16x32_bf16 v[168:171], a[168:171], v[56:59], v[168:171]
v_lshrrev_b32 v6, v6, v252
v_and_b32 v6, 3, v6
v_mfma_f32_16x16x32_bf16 v[168:171], a[172:175], v[60:63], v[168:171]
v_cmp_ne_u32 vcc, 1, v249
v_mul_u32_u24 v6, 16640, v6
v_mfma_f32_16x16x32_bf16 v[184:187], a[188:191], v[60:63], v[88:91]
v_add_u32 v6, s92, v6
v_cndmask_b32 v6, v250, v6, vcc
v_mfma_f32_16x16x32_bf16 v[184:187], a[184:187], v[56:59], v[184:187]
v_add_u32 v253, s58, v249
v_and_b32 v253, 3, v253
v_mfma_f32_16x16x32_bf16 v[184:187], a[180:183], v[52:55], v[184:187]
s_waitcnt lgkmcnt(4)
v_mfma_f32_16x16x32_bf16 v[184:187], a[176:179], v[48:51], v[184:187]
s_barrier
s_lshr_b32 s69, s93, 4
s_and_b32 s69, s69, 0x7f00
s_add_u32 s69, s69, LHT4-Lpc0
v_lshrrev_b32 v3, 5, v0
v_lshlrev_b32 v3, 7, v3
v_add_u32 v3, s69, v3
v_min_u32 v3, Lcode_end-Lpc0, v3
global_load_dword v4, v3, s[98:99]
v_mfma_f32_16x16x32_bf16 v[224:227], v[120:123], v[208:211], v[224:227]
s_add_u32 s82, s82, 0x8000
ds_read_b128 a[160:163], v2 offset:24576
ds_read_b128 a[164:167], v2 offset:25600
v_mfma_f32_16x16x32_bf16 v[232:235], v[120:123], v[216:219], v[232:235]
s_and_b32 s82, s82, 0x1ffff
v_exp_f32 v164, v164
v_mfma_f32_16x16x32_bf16 v[232:235], v[120:123], v[200:203], v[232:235]
s_add_u32 s66, s58, 3
v_exp_f32 v165, v165
v_mfma_f32_16x16x32_bf16 a[0:3], a[224:227], v[208:211], a[0:3]
s_and_b32 s66, s66, 3
v_exp_f32 v166, v166
v_mfma_f32_16x16x32_bf16 a[64:67], a[192:195], v[200:203], a[64:67]
s_mul_i32 s66, s66, 4160
ds_read_b128 a[168:171], v2 offset:26624
v_cvt_pk_bf16_f32 v212, v164, v165
v_mfma_f32_16x16x32_bf16 a[64:67], a[224:227], v[216:219], a[64:67]
s_add_u32 s66, s66, s92
v_exp_f32 v167, v167
v_mfma_f32_16x16x32_bf16 a[68:71], a[228:231], v[216:219], a[68:71]
s_add_u32 m0, s66, 32
v_exp_f32 v180, v180
v_mfma_f32_16x16x32_bf16 a[68:71], a[196:199], v[200:203], a[68:71]
s_add_u32 s72, s93, 0x6
buffer_load_dwordx4 v1, s[36:39], s72 offen lds
v_mfma_f32_16x16x32_bf16 a[4:7], a[228:231], v[208:211], a[4:7]
ds_read_b128 a[172:175], v2 offset:27648
v_cvt_pk_bf16_f32 v213, v166, v167
v_mfma_f32_16x16x32_bf16 a[8:11], a[232:235], v[208:211], a[8:11]
v_exp_f32 v181, v181
v_mfma_f32_16x16x32_bf16 a[72:75], a[200:203], v[200:203], a[72:75]
ds_read_b128 a[176:179], v2 offset:28672
v_cvt_pk_bf16_f32 v214, v180, v181
v_mfma_f32_16x16x32_bf16 a[72:75], a[232:235], v[216:219], a[72:75]
v_exp_f32 v182, v182
v_mfma_f32_16x16x32_bf16 a[76:79], a[236:239], v[216:219], a[76:79]
v_exp_f32 v183, v183
v_mfma_f32_16x16x32_bf16 a[76:79], a[204:207], v[200:203], a[76:79]
ds_read_b128 a[180:183], v2 offset:29696
v_cvt_pk_bf16_f32 v215, v182, v183
v_mfma_f32_16x16x32_bf16 a[12:15], a[236:239], v[208:211], a[12:15]
v_exp_f32 v172, v172
v_mfma_f32_16x16x32_bf16 a[16:19], a[240:243], v[208:211], a[16:19]
s_waitcnt lgkmcnt(6)
ds_read_b128 a[184:187], v2 offset:30720
ds_read_b128 a[188:191], v2 offset:31744
v_mfma_f32_16x16x32_bf16 a[80:83], a[208:211], v[200:203], a[80:83]
v_exp_f32 v173, v173
v_mfma_f32_16x16x32_bf16 a[80:83], a[240:243], v[216:219], a[80:83]
buffer_load_dwordx4 v1, s[36:39], s72 offen offset:1024 lds
v_mfma_f32_16x16x32_bf16 a[84:87], a[244:247], v[216:219], a[84:87]
v_exp_f32 v174, v174
v_mfma_f32_16x16x32_bf16 a[84:87], a[212:215], v[200:203], a[84:87]
v_exp_f32 v175, v175
v_mfma_f32_16x16x32_bf16 a[20:23], a[244:247], v[208:211], a[20:23]
ds_read_b128 a[224:227], v2 offset:8192
v_cvt_pk_bf16_f32 v220, v172, v173
v_mfma_f32_16x16x32_bf16 a[24:27], a[248:251], v[208:211], a[24:27]
v_exp_f32 v188, v188
v_mfma_f32_16x16x32_bf16 a[88:91], a[216:219], v[200:203], a[88:91]
v_exp_f32 v189, v189
v_mfma_f32_16x16x32_bf16 a[88:91], a[248:251], v[216:219], a[88:91]
ds_read_b128 a[228:231], v2 offset:9216
v_cvt_pk_bf16_f32 v221, v174, v175
v_mfma_f32_16x16x32_bf16 a[92:95], a[252:255], v[216:219], a[92:95]
v_exp_f32 v190, v190
v_mfma_f32_16x16x32_bf16 a[92:95], a[220:223], v[200:203], a[92:95]
ds_read_b128 a[232:235], v2 offset:10240
v_cvt_pk_bf16_f32 v222, v188, v189
v_mfma_f32_16x16x32_bf16 a[28:31], a[252:255], v[208:211], a[28:31]
v_exp_f32 v191, v191
s_cmp_eq_u32 s58, 0
s_cbranch_scc1 Lta43
s_cmp_eq_u32 s58, 1
s_cbranch_scc1 Lnt44
v_mfma_f32_16x16x32_bf16 v[136:139], a[128:131], v[48:51], v[88:91]
buffer_load_dwordx4 v1, s[36:39], s72 offen offset:2048 lds
v_mfma_f32_16x16x32_bf16 v[152:155], a[144:147], v[48:51], v[88:91]
v_exp_f32 v168, v168
s_branch Ljoin45
Lta43:
v_mfma_f32_16x16x32_bf16 v[136:139], a[128:131], v[48:51], v[104:107]
buffer_load_dwordx4 v1, s[36:39], s72 offen offset:2048 lds
v_mfma_f32_16x16x32_bf16 v[152:155], a[144:147], v[48:51], v[112:115]
v_exp_f32 v168, v168
s_branch Ljoin45
Lnt44:
v_mfma_f32_16x16x32_bf16 v[136:139], a[128:131], v[48:51], v[88:91]
buffer_load_dwordx4 v1, s[36:39], s72 offen offset:2048 lds
v_mfma_f32_16x16x32_bf16 v[152:155], a[144:147], v[48:51], v[104:107]
v_exp_f32 v168, v168
Ljoin45:
v_mfma_f32_16x16x32_bf16 v[136:139], a[132:135], v[52:55], v[136:139]
ds_read_b128 a[236:239], v2 offset:11264
v_cvt_pk_bf16_f32 v223, v190, v191
v_mfma_f32_16x16x32_bf16 v[136:139], a[136:139], v[56:59], v[136:139]
v_exp_f32 v169, v169
v_mfma_f32_16x16x32_bf16 v[136:139], a[140:143], v[60:63], v[136:139]
ds_read_b128 a[240:243], v2 offset:12288
v_cvt_pk_bf16_f32 v216, v168, v169
v_mfma_f32_16x16x32_bf16 v[152:155], a[156:159], v[60:63], v[152:155]
v_exp_f32 v170, v170
v_mfma_f32_16x16x32_bf16 v[152:155], a[152:155], v[56:59], v[152:155]
v_exp_f32 v171, v171
v_mfma_f32_16x16x32_bf16 v[152:155], a[148:151], v[52:55], v[152:155]
ds_read_b128 a[244:247], v2 offset:13312
v_cvt_pk_bf16_f32 v217, v170, v171
v_mfma_f32_16x16x32_bf16 v[140:143], a[128:131], v[64:67], v[92:95]
v_exp_f32 v184, v184
v_mfma_f32_16x16x32_bf16 v[140:143], a[132:135], v[68:71], v[140:143]
ds_read_b128 a[248:251], v2 offset:14336
v_mfma_f32_16x16x32_bf16 v[140:143], a[136:139], v[72:75], v[140:143]
v_exp_f32 v185, v185
v_mfma_f32_16x16x32_bf16 v[140:143], a[140:143], v[76:79], v[140:143]
buffer_load_dwordx4 v1, s[36:39], s72 offen offset:3072 lds
v_mfma_f32_16x16x32_bf16 v[156:159], a[156:159], v[76:79], v[92:95]
ds_read_b128 a[252:255], v2 offset:15360
v_cvt_pk_bf16_f32 v218, v184, v185
v_mfma_f32_16x16x32_bf16 v[156:159], a[152:155], v[72:75], v[156:159]
v_exp_f32 v186, v186
v_mfma_f32_16x16x32_bf16 v[156:159], a[148:151], v[68:71], v[156:159]
s_waitcnt vmcnt(17) lgkmcnt(0)
v_exp_f32 v187, v187
v_mfma_f32_16x16x32_bf16 v[156:159], a[144:147], v[64:67], v[156:159]
s_barrier
v_cvt_pk_bf16_f32 v219, v186, v187
v_add_u32 v2, s82, v1
v_mfma_f32_16x16x32_bf16 v[228:231], v[120:123], v[196:199], v[228:231]
s_mov_b32 m0, s62
v_exp_f32 v136, v136
v_mfma_f32_16x16x32_bf16 v[228:231], v[120:123], v[212:215], v[228:231]
s_add_u32 s72, s93, 0x3000000
ds_read_b128 a[128:131], v2 offset:16384
v_mul_u32_u24 v253, 4160, v253
v_mfma_f32_16x16x32_bf16 v[236:239], v[120:123], v[204:207], v[236:239]
buffer_load_dwordx4 v1, s[44:47], s72 offen sc1 lds
v_mfma_f32_16x16x32_bf16 v[236:239], v[120:123], v[220:223], v[236:239]
v_exp_f32 v137, v137
v_mfma_f32_16x16x32_bf16 a[32:35], a[192:195], v[196:199], a[32:35]
ds_read_b128 a[132:135], v2 offset:17408
v_cvt_pk_bf16_f32 v200, v136, v137
v_mfma_f32_16x16x32_bf16 a[32:35], a[224:227], v[212:215], a[32:35]
v_exp_f32 v138, v138
v_mfma_f32_16x16x32_bf16 a[96:99], a[224:227], v[220:223], a[96:99]
ds_read_b128 a[136:139], v2 offset:18432
v_add_u32 v6, v6, v253
v_mfma_f32_16x16x32_bf16 a[96:99], a[192:195], v[204:207], a[96:99]
buffer_load_dwordx4 v1, s[44:47], s72 offen offset:1024 sc1 lds
v_mfma_f32_16x16x32_bf16 a[100:103], a[196:199], v[204:207], a[100:103]
v_exp_f32 v139, v139
v_mfma_f32_16x16x32_bf16 a[100:103], a[228:231], v[220:223], a[100:103]
ds_read_b128 a[140:143], v2 offset:19456
v_cvt_pk_bf16_f32 v201, v138, v139
v_mfma_f32_16x16x32_bf16 a[36:39], a[228:231], v[212:215], a[36:39]
v_exp_f32 v152, v152
v_mfma_f32_16x16x32_bf16 a[36:39], a[196:199], v[196:199], a[36:39]
ds_read_b128 a[144:147], v2 offset:20480
v_bfe_u32 v251, v0, 2, 2
v_mfma_f32_16x16x32_bf16 a[40:43], a[200:203], v[196:199], a[40:43]
buffer_load_dwordx4 v1, s[44:47], s72 offen offset:2048 sc1 lds
v_mfma_f32_16x16x32_bf16 a[40:43], a[232:235], v[212:215], a[40:43]
v_exp_f32 v153, v153
v_mfma_f32_16x16x32_bf16 a[104:107], a[232:235], v[220:223], a[104:107]
ds_read_b128 a[148:151], v2 offset:21504
v_cvt_pk_bf16_f32 v202, v152, v153
v_mfma_f32_16x16x32_bf16 a[104:107], a[200:203], v[204:207], a[104:107]
buffer_load_dwordx4 v1, s[44:47], s72 offen offset:3072 sc1 lds
v_mfma_f32_16x16x32_bf16 a[108:111], a[204:207], v[204:207], a[108:111]
s_add_u32 s66, s58, 0
v_exp_f32 v154, v154
v_mfma_f32_16x16x32_bf16 a[108:111], a[236:239], v[220:223], a[108:111]
s_and_b32 s66, s66, 3
ds_read_b128 a[152:155], v2 offset:22528
v_lshl_add_u32 v6, v248, 3, v6
v_mfma_f32_16x16x32_bf16 a[44:47], a[236:239], v[212:215], a[44:47]
s_mul_i32 s66, s66, 4160
v_exp_f32 v155, v155
v_mfma_f32_16x16x32_bf16 a[44:47], a[204:207], v[196:199], a[44:47]
s_add_u32 s66, s66, s92
ds_read_b128 a[156:159], v2 offset:23552
v_cvt_pk_bf16_f32 v203, v154, v155
v_mfma_f32_16x16x32_bf16 a[48:51], a[208:211], v[196:199], a[48:51]
s_waitcnt lgkmcnt(8)
v_exp_f32 v140, v140
v_mfma_f32_16x16x32_bf16 a[48:51], a[240:243], v[212:215], a[48:51]
s_add_u32 m0, s66, 16672
ds_read_b128 a[192:195], v2 offset:0
v_lshl_add_u32 v6, v241, 4, v6
v_mfma_f32_16x16x32_bf16 a[112:115], a[240:243], v[220:223], a[112:115]
s_add_u32 s72, s93, 0x0
buffer_load_dwordx4 v1, s[36:39], s72 offen lds
v_mfma_f32_16x16x32_bf16 a[112:115], a[208:211], v[204:207], a[112:115]
buffer_load_dwordx4 v1, s[36:39], s72 offen offset:1024 lds
v_mfma_f32_16x16x32_bf16 a[116:119], a[212:215], v[204:207], a[116:119]
v_exp_f32 v141, v141
v_mfma_f32_16x16x32_bf16 a[116:119], a[244:247], v[220:223], a[116:119]
ds_read_b128 a[196:199], v2 offset:1024
v_lshlrev_b32 v5, 3, v251
v_mfma_f32_16x16x32_bf16 a[52:55], a[244:247], v[212:215], a[52:55]
v_exp_f32 v142, v142
v_mfma_f32_16x16x32_bf16 a[52:55], a[212:215], v[196:199], a[52:55]
ds_read_b128 a[200:203], v2 offset:2048
v_lshrrev_b32 v5, v5, v252
v_mfma_f32_16x16x32_bf16 a[56:59], a[216:219], v[196:199], a[56:59]
buffer_load_dwordx4 v1, s[36:39], s72 offen offset:2048 lds
v_mfma_f32_16x16x32_bf16 a[56:59], a[248:251], v[212:215], a[56:59]
v_exp_f32 v143, v143
v_mfma_f32_16x16x32_bf16 a[120:123], a[248:251], v[220:223], a[120:123]
ds_read_b128 a[204:207], v2 offset:3072
v_and_b32 v5, 3, v5
v_mfma_f32_16x16x32_bf16 a[120:123], a[216:219], v[204:207], a[120:123]
v_exp_f32 v156, v156
v_mfma_f32_16x16x32_bf16 a[124:127], a[220:223], v[204:207], a[124:127]
ds_read_b128 a[208:211], v2 offset:4096
v_cmp_ne_u32 vcc, 1, v251
v_mfma_f32_16x16x32_bf16 a[124:127], a[252:255], v[220:223], a[124:127]
buffer_load_dwordx4 v1, s[36:39], s72 offen offset:3072 lds
v_mfma_f32_16x16x32_bf16 a[60:63], a[252:255], v[212:215], a[60:63]
s_add_u32 s66, s58, 2
v_exp_f32 v157, v157
v_mfma_f32_16x16x32_bf16 a[60:63], a[220:223], v[196:199], a[60:63]
s_and_b32 s66, s66, 3
ds_read_b128 a[212:215], v2 offset:5120
v_cvt_pk_bf16_f32 v204, v140, v141
s_cmp_eq_u32 s58, 2
s_cbranch_scc1 Lta46
s_cmp_eq_u32 s58, 3
s_cbranch_scc1 Lnt47
v_mfma_f32_16x16x32_bf16 v[168:171], a[160:163], v[48:51], v[112:115]
s_mul_i32 s66, s66, 4160
v_exp_f32 v158, v158
v_mfma_f32_16x16x32_bf16 v[184:187], a[176:179], v[48:51], v[112:115]
s_add_u32 s66, s66, s92
ds_read_b128 a[216:219], v2 offset:6144
v_cvt_pk_bf16_f32 v205, v142, v143
s_branch Ljoin48
Lta46:
v_mfma_f32_16x16x32_bf16 v[168:171], a[160:163], v[48:51], v[104:107]
s_mul_i32 s66, s66, 4160
v_exp_f32 v158, v158
v_mfma_f32_16x16x32_bf16 v[184:187], a[176:179], v[48:51], v[112:115]
s_add_u32 s66, s66, s92
ds_read_b128 a[216:219], v2 offset:6144
v_cvt_pk_bf16_f32 v205, v142, v143
s_branch Ljoin48
Lnt47:
v_mfma_f32_16x16x32_bf16 v[168:171], a[160:163], v[48:51], v[88:91]
s_mul_i32 s66, s66, 4160
v_exp_f32 v158, v158
v_mfma_f32_16x16x32_bf16 v[184:187], a[176:179], v[48:51], v[104:107]
s_add_u32 s66, s66, s92
ds_read_b128 a[216:219], v2 offset:6144
v_cvt_pk_bf16_f32 v205, v142, v143
Ljoin48:
v_mfma_f32_16x16x32_bf16 v[172:175], a[160:163], v[64:67], v[92:95]
s_add_u32 m0, s66, 33312
v_exp_f32 v159, v159
v_mfma_f32_16x16x32_bf16 v[172:175], a[164:167], v[68:71], v[172:175]
s_add_u32 s72, s93, 0x4
buffer_load_dwordx4 v1, s[36:39], s72 offen lds
v_mfma_f32_16x16x32_bf16 v[172:175], a[168:171], v[72:75], v[172:175]
ds_read_b128 a[220:223], v2 offset:7168
v_cvt_pk_bf16_f32 v206, v156, v157
v_mfma_f32_16x16x32_bf16 v[172:175], a[172:175], v[76:79], v[172:175]
buffer_load_dwordx4 v1, s[36:39], s72 offen offset:1024 lds
v_mfma_f32_16x16x32_bf16 v[188:191], a[188:191], v[76:79], v[92:95]
v_cvt_pk_bf16_f32 v207, v158, v159
v_mul_u32_u24 v5, 16640, v5
v_mfma_f32_16x16x32_bf16 v[188:191], a[184:187], v[72:75], v[188:191]
v_add_u32 v5, s92, v5
v_cndmask_b32 v5, v250, v5, vcc
v_mfma_f32_16x16x32_bf16 v[188:191], a[180:183], v[68:71], v[188:191]
v_add_u32 v253, s58, v251
v_and_b32 v253, 3, v253
v_mfma_f32_16x16x32_bf16 v[188:191], a[176:179], v[64:67], v[188:191]
v_mul_u32_u24 v253, 4160, v253
v_add_u32 v5, v5, v253
v_mfma_f32_16x16x32_bf16 v[168:171], a[164:167], v[52:55], v[168:171]
s_add_u32 s73, s62, 480
v_lshlrev_b32 v248, 5, v240
v_sub_u32 v248, s73, v248
v_mfma_f32_16x16x32_bf16 v[168:171], a[168:171], v[56:59], v[168:171]
v_lshl_add_u32 v7, v241, 4, v248
v_mfma_f32_16x16x32_bf16 v[168:171], a[172:175], v[60:63], v[168:171]
s_and_b32 s73, s58, 1
v_mfma_f32_16x16x32_bf16 v[184:187], a[188:191], v[60:63], v[184:187]
s_lshl_b32 s73, s73, 4
v_mfma_f32_16x16x32_bf16 v[184:187], a[184:187], v[56:59], v[184:187]
s_lshr_b32 s73, s90, s73
v_mfma_f32_16x16x32_bf16 v[184:187], a[180:183], v[52:55], v[184:187]
s_waitcnt lgkmcnt(4)
s_and_b32 s73, s73, 0xffff
v_lshl_add_u32 v248, v241, 3, v240
v_sub_u32 v248, 15, v248
v_and_b32 v249, 1, v248
v_lshlrev_b32 v249, 4, v249
v_lshlrev_b32 v249, v249, s73
v_lshrrev_b32 v248, 1, v248
v_and_b32 v241, 3, v0
v_cmp_eq_u32 vcc, 0, v248
v_lshl_add_u32 v5, v241, 3, v5
s_nop 0
v_cndmask_b32 v8, 0, v249, vcc
v_cmp_eq_u32 vcc, 1, v248
v_lshlrev_b32 v240, 4, v251
s_nop 0
v_cndmask_b32 v9, 0, v249, vcc
v_cmp_eq_u32 vcc, 2, v248
v_sub_u32 v240, 48, v240
v_lshlrev_b64 v[12:13], 16, s[88:89]
v_cndmask_b32 v10, 0, v249, vcc
v_cmp_eq_u32 vcc, 3, v248
v_lshlrev_b64 v[12:13], v240, v[12:13]
s_nop 0
v_cndmask_b32 v11, 0, v249, vcc
v_cmp_eq_u32 vcc, 3, v241
s_add_u32 s73, s62, 4096
v_lshl_add_u32 v14, v0, 3, s73
v_cndmask_b32 v12, 0, v12, vcc
v_cndmask_b32 v13, 0, v13, vcc
v_lshrrev_b32 v15, 4, v0
v_lshlrev_b32 v15, 1, v15
v_and_b32 v240, 7, v0
v_xor_b32 v15, v15, v240
v_lshlrev_b32 v15, 4, v15
v_lshrrev_b32 v240, 3, v0
v_lshl_add_u32 v15, v240, 11, v15
s_lshr_b32 s75, s59, 1
s_and_b32 s75, s75, 8
s_add_u32 s75, s75, s60
s_lshl_b32 s76, s65, 2
s_lshr_b32 s80, s59, 2
s_and_b32 s80, s80, 3
s_add_u32 s76, s76, s80
s_lshl_b32 s94, s58, 16
s_lshl_b32 s80, s76, 7
s_add_u32 s94, s94, s80
s_lshl_b32 s80, s75, 18
s_add_u32 s80, s80, s94
v_rcp_f32 v224, v224
v_rcp_f32 v228, v228
s_lshl_b32 s73, s52, 12
s_add_u32 s73, s73, 0x2000000
s_lshl_b32 s70, s67, 2
s_add_u32 s70, s70, s73
v_mov_b32 v225, v224
v_accvgpr_read_b32 v240, a0
v_accvgpr_read_b32 v241, a1
v_accvgpr_read_b32 v242, a2
v_accvgpr_read_b32 v243, a3
v_accvgpr_read_b32 v244, a4
v_accvgpr_read_b32 v245, a5
v_accvgpr_read_b32 v246, a6
v_accvgpr_read_b32 v247, a7
v_pk_mul_f32 v[240:241], v[240:241], v[224:225]
v_pk_mul_f32 v[242:243], v[242:243], v[224:225]
v_pk_mul_f32 v[244:245], v[244:245], v[224:225]
v_pk_mul_f32 v[246:247], v[246:247], v[224:225]
buffer_load_dwordx4 v1, s[36:39], s72 offen offset:2048 lds
v_cvt_pk_bf16_f32 v128, v240, v241
v_cvt_pk_bf16_f32 v129, v242, v243
v_cvt_pk_bf16_f32 v130, v244, v245
v_cvt_pk_bf16_f32 v131, v246, v247
v_accvgpr_read_b32 v248, a8
v_accvgpr_read_b32 v249, a9
v_accvgpr_read_b32 v250, a10
v_accvgpr_read_b32 v251, a11
v_accvgpr_read_b32 v252, a12
v_accvgpr_read_b32 v253, a13
v_accvgpr_read_b32 v254, a14
v_accvgpr_read_b32 v255, a15
v_pk_mul_f32 v[248:249], v[248:249], v[224:225]
v_pk_mul_f32 v[250:251], v[250:251], v[224:225]
v_pk_mul_f32 v[252:253], v[252:253], v[224:225]
v_pk_mul_f32 v[254:255], v[254:255], v[224:225]
v_cvt_pk_bf16_f32 v144, v248, v249
v_cvt_pk_bf16_f32 v145, v250, v251
buffer_load_dwordx4 v1, s[36:39], s72 offen offset:3072 lds
v_cvt_pk_bf16_f32 v146, v252, v253
v_cvt_pk_bf16_f32 v147, v254, v255
v_accvgpr_read_b32 v240, a16
v_accvgpr_read_b32 v241, a17
v_accvgpr_read_b32 v242, a18
v_accvgpr_read_b32 v243, a19
v_accvgpr_read_b32 v244, a20
v_accvgpr_read_b32 v245, a21
v_accvgpr_read_b32 v246, a22
v_accvgpr_read_b32 v247, a23
v_pk_mul_f32 v[240:241], v[240:241], v[224:225]
v_pk_mul_f32 v[242:243], v[242:243], v[224:225]
v_pk_mul_f32 v[244:245], v[244:245], v[224:225]
v_pk_mul_f32 v[246:247], v[246:247], v[224:225]
v_cvt_pk_bf16_f32 v160, v240, v241
v_cvt_pk_bf16_f32 v161, v242, v243
v_cvt_pk_bf16_f32 v162, v244, v245
v_cvt_pk_bf16_f32 v163, v246, v247
buffer_load_dwordx4 v[80:83], v15, s[4:7], s80 offen
v_accvgpr_read_b32 v248, a24
v_accvgpr_read_b32 v249, a25
v_accvgpr_read_b32 v250, a26
v_accvgpr_read_b32 v251, a27
v_accvgpr_read_b32 v252, a28
v_accvgpr_read_b32 v253, a29
v_accvgpr_read_b32 v254, a30
v_accvgpr_read_b32 v255, a31
v_pk_mul_f32 v[248:249], v[248:249], v[224:225]
v_pk_mul_f32 v[250:251], v[250:251], v[224:225]
v_pk_mul_f32 v[252:253], v[252:253], v[224:225]
v_pk_mul_f32 v[254:255], v[254:255], v[224:225]
v_cvt_pk_bf16_f32 v176, v248, v249
v_cvt_pk_bf16_f32 v177, v250, v251
v_cvt_pk_bf16_f32 v178, v252, v253
v_cvt_pk_bf16_f32 v179, v254, v255
v_mov_b32 v229, v228
v_accvgpr_read_b32 v240, a32
s_add_u32 s80, s80, 0x4000
buffer_load_dwordx4 v[84:87], v15, s[4:7], s80 offen
v_accvgpr_read_b32 v241, a33
v_accvgpr_read_b32 v242, a34
v_accvgpr_read_b32 v243, a35
v_accvgpr_read_b32 v244, a36
v_accvgpr_read_b32 v245, a37
v_accvgpr_read_b32 v246, a38
v_accvgpr_read_b32 v247, a39
v_pk_mul_f32 v[240:241], v[240:241], v[228:229]
v_pk_mul_f32 v[242:243], v[242:243], v[228:229]
v_pk_mul_f32 v[244:245], v[244:245], v[228:229]
v_pk_mul_f32 v[246:247], v[246:247], v[228:229]
v_cvt_pk_bf16_f32 v132, v240, v241
v_cvt_pk_bf16_f32 v133, v242, v243
v_cvt_pk_bf16_f32 v134, v244, v245
v_cvt_pk_bf16_f32 v135, v246, v247
v_accvgpr_read_b32 v248, a40
v_accvgpr_read_b32 v249, a41
v_accvgpr_read_b32 v250, a42
s_add_u32 s80, s80, 0x4000
buffer_load_dwordx4 v[96:99], v15, s[4:7], s80 offen
v_accvgpr_read_b32 v251, a43
v_accvgpr_read_b32 v252, a44
v_accvgpr_read_b32 v253, a45
v_accvgpr_read_b32 v254, a46
v_accvgpr_read_b32 v255, a47
v_pk_mul_f32 v[248:249], v[248:249], v[228:229]
v_pk_mul_f32 v[250:251], v[250:251], v[228:229]
v_pk_mul_f32 v[252:253], v[252:253], v[228:229]
v_pk_mul_f32 v[254:255], v[254:255], v[228:229]
v_cvt_pk_bf16_f32 v148, v248, v249
v_cvt_pk_bf16_f32 v149, v250, v251
v_cvt_pk_bf16_f32 v150, v252, v253
v_cvt_pk_bf16_f32 v151, v254, v255
v_accvgpr_read_b32 v240, a48
v_accvgpr_read_b32 v241, a49
v_accvgpr_read_b32 v242, a50
v_accvgpr_read_b32 v243, a51
v_accvgpr_read_b32 v244, a52
s_add_u32 s80, s80, 0x4000
buffer_load_dwordx4 v[100:103], v15, s[4:7], s80 offen
v_accvgpr_read_b32 v245, a53
v_accvgpr_read_b32 v246, a54
v_accvgpr_read_b32 v247, a55
v_pk_mul_f32 v[240:241], v[240:241], v[228:229]
v_pk_mul_f32 v[242:243], v[242:243], v[228:229]
v_pk_mul_f32 v[244:245], v[244:245], v[228:229]
v_pk_mul_f32 v[246:247], v[246:247], v[228:229]
v_cvt_pk_bf16_f32 v164, v240, v241
v_cvt_pk_bf16_f32 v165, v242, v243
v_cvt_pk_bf16_f32 v166, v244, v245
v_cvt_pk_bf16_f32 v167, v246, v247
v_accvgpr_read_b32 v248, a56
v_accvgpr_read_b32 v249, a57
v_accvgpr_read_b32 v250, a58
v_accvgpr_read_b32 v251, a59
v_accvgpr_read_b32 v252, a60
v_accvgpr_read_b32 v253, a61
v_accvgpr_read_b32 v254, a62
v_accvgpr_read_b32 v255, a63
v_pk_mul_f32 v[248:249], v[248:249], v[228:229]
v_pk_mul_f32 v[250:251], v[250:251], v[228:229]
v_pk_mul_f32 v[252:253], v[252:253], v[228:229]
v_pk_mul_f32 v[254:255], v[254:255], v[228:229]
v_cvt_pk_bf16_f32 v180, v248, v249
v_cvt_pk_bf16_f32 v181, v250, v251
v_cvt_pk_bf16_f32 v182, v252, v253
v_cvt_pk_bf16_f32 v183, v254, v255
v_mfma_f32_16x16x32_bf16 v[232:235], v[120:123], v[216:219], v[232:235]
s_add_u32 s82, s82, 0x8000
ds_read_b128 a[160:163], v2 offset:24576
ds_read_b128 a[164:167], v2 offset:25600
v_mfma_f32_16x16x32_bf16 v[232:235], v[120:123], v[200:203], v[232:235]
s_and_b32 s82, s82, 0x1ffff
v_exp_f32 v172, v172
v_mfma_f32_16x16x32_bf16 a[64:67], a[224:227], v[216:219], a[64:67]
v_exp_f32 v173, v173
v_mfma_f32_16x16x32_bf16 a[64:67], a[192:195], v[200:203], a[64:67]
s_nop 0
ds_read_b128 a[168:171], v2 offset:26624
ds_read_b128 a[172:175], v2 offset:27648
v_mfma_f32_16x16x32_bf16 a[68:71], a[196:199], v[200:203], a[68:71]
v_exp_f32 v174, v174
v_mfma_f32_16x16x32_bf16 a[68:71], a[228:231], v[216:219], a[68:71]
v_exp_f32 v175, v175
v_mfma_f32_16x16x32_bf16 a[72:75], a[232:235], v[216:219], a[72:75]
buffer_store_dwordx4 v[128:131], v1, s[44:47], s70 offen sc1
v_mfma_f32_16x16x32_bf16 a[72:75], a[200:203], v[200:203], a[72:75]
s_nop 0
ds_read_b128 a[176:179], v2 offset:28672
ds_read_b128 a[180:183], v2 offset:29696
v_mfma_f32_16x16x32_bf16 a[76:79], a[204:207], v[200:203], a[76:79]
v_exp_f32 v188, v188
v_mfma_f32_16x16x32_bf16 a[76:79], a[236:239], v[216:219], a[76:79]
s_nop 0
ds_read_b128 a[184:187], v2 offset:30720
ds_read_b128 a[188:191], v2 offset:31744
v_mfma_f32_16x16x32_bf16 a[80:83], a[240:243], v[216:219], a[80:83]
s_waitcnt lgkmcnt(8)
ds_read_b128 a[224:227], v2 offset:8192
ds_read_b128 a[228:231], v2 offset:9216
v_mfma_f32_16x16x32_bf16 a[80:83], a[208:211], v[200:203], a[80:83]
s_nop 0
ds_read_b128 a[232:235], v2 offset:10240
ds_read_b128 a[236:239], v2 offset:11264
v_mfma_f32_16x16x32_bf16 a[84:87], a[212:215], v[200:203], a[84:87]
ds_read_b128 a[240:243], v2 offset:12288
v_cvt_pk_bf16_f32 v220, v172, v173
v_mfma_f32_16x16x32_bf16 a[84:87], a[244:247], v[216:219], a[84:87]
v_exp_f32 v189, v189
v_mfma_f32_16x16x32_bf16 a[88:91], a[248:251], v[216:219], a[88:91]
v_exp_f32 v190, v190
v_mfma_f32_16x16x32_bf16 a[88:91], a[216:219], v[200:203], a[88:91]
s_nop 0
ds_read_b128 a[244:247], v2 offset:13312
ds_read_b128 a[248:251], v2 offset:14336
v_mfma_f32_16x16x32_bf16 a[92:95], a[220:223], v[200:203], a[92:95]
v_cvt_pk_bf16_f32 v221, v174, v175
v_cvt_pk_bf16_f32 v222, v188, v189
v_mfma_f32_16x16x32_bf16 a[92:95], a[252:255], v[216:219], a[92:95]
v_exp_f32 v191, v191
s_cmp_eq_u32 s58, 0
s_cbranch_scc1 Lta49
s_cmp_eq_u32 s58, 1
s_cbranch_scc1 Lnt50
v_mfma_f32_16x16x32_bf16 v[140:143], a[128:131], v[64:67], v[92:95]
v_exp_f32 v168, v168
v_mfma_f32_16x16x32_bf16 v[156:159], a[144:147], v[64:67], v[92:95]
buffer_store_dwordx4 v[144:147], v1, s[44:47], s70 offen offset:1024 sc1
s_branch Ljoin51
Lta49:
v_mfma_f32_16x16x32_bf16 v[140:143], a[128:131], v[64:67], v[108:111]
v_exp_f32 v168, v168
v_mfma_f32_16x16x32_bf16 v[156:159], a[144:147], v[64:67], v[112:115]
buffer_store_dwordx4 v[144:147], v1, s[44:47], s70 offen offset:1024 sc1
s_branch Ljoin51
Lnt50:
v_mfma_f32_16x16x32_bf16 v[140:143], a[128:131], v[64:67], v[92:95]
v_exp_f32 v168, v168
v_mfma_f32_16x16x32_bf16 v[156:159], a[144:147], v[64:67], v[108:111]
buffer_store_dwordx4 v[144:147], v1, s[44:47], s70 offen offset:1024 sc1
Ljoin51:
v_mfma_f32_16x16x32_bf16 v[140:143], a[132:135], v[68:71], v[140:143]
v_exp_f32 v169, v169
v_mfma_f32_16x16x32_bf16 v[140:143], a[136:139], v[72:75], v[140:143]
v_exp_f32 v170, v170
v_mfma_f32_16x16x32_bf16 v[140:143], a[140:143], v[76:79], v[140:143]
buffer_store_dwordx4 v[160:163], v1, s[44:47], s70 offen offset:2048 sc1
v_mfma_f32_16x16x32_bf16 v[156:159], a[156:159], v[76:79], v[156:159]
ds_read_b128 a[252:255], v2 offset:15360
v_cvt_pk_bf16_f32 v223, v190, v191
v_mfma_f32_16x16x32_bf16 v[156:159], a[152:155], v[72:75], v[156:159]
s_waitcnt vmcnt(24) lgkmcnt(4)
v_exp_f32 v171, v171
v_mfma_f32_16x16x32_bf16 v[156:159], a[148:151], v[68:71], v[156:159]
s_barrier
v_exp_f32 v184, v184
v_add_u32 v2, s82, v1
v_cvt_pk_bf16_f32 v216, v168, v169
v_cvt_pk_bf16_f32 v217, v170, v171
v_exp_f32 v185, v185
v_exp_f32 v186, v186
v_cvt_pk_bf16_f32 v218, v184, v185
v_exp_f32 v187, v187
s_nop 0
v_cvt_pk_bf16_f32 v219, v186, v187
v_mfma_f32_16x16x32_bf16 v[236:239], v[120:123], v[204:207], v[236:239]
s_add_u32 s78, s59, 4
v_exp_f32 v140, v140
v_mfma_f32_16x16x32_bf16 v[236:239], v[120:123], v[220:223], v[236:239]
s_and_b32 s78, s78, 12
v_exp_f32 v141, v141
v_mfma_f32_16x16x32_bf16 a[96:99], a[192:195], v[204:207], a[96:99]
s_lshl_b32 s78, s78, 1
ds_read_b128 a[192:195], v2 offset:0
v_mfma_f32_16x16x32_bf16 a[96:99], a[224:227], v[220:223], a[96:99]
s_lshr_b32 s79, 0x67234501, s78
buffer_store_dwordx4 v[176:179], v1, s[44:47], s70 offen offset:3072 sc1
v_mfma_f32_16x16x32_bf16 a[100:103], a[228:231], v[220:223], a[100:103]
s_add_u32 s70, s70, 0x80000
v_exp_f32 v142, v142
v_mfma_f32_16x16x32_bf16 a[100:103], a[196:199], v[204:207], a[100:103]
s_and_b32 s79, s79, 7
ds_read_b128 a[196:199], v2 offset:1024
v_mfma_f32_16x16x32_bf16 a[104:107], a[200:203], v[204:207], a[104:107]
s_lshl_b32 s79, s79, 18
ds_read_b128 a[200:203], v2 offset:2048
v_mfma_f32_16x16x32_bf16 a[104:107], a[232:235], v[220:223], a[104:107]
s_add_u32 s79, s79, s94
v_exp_f32 v143, v143
v_mfma_f32_16x16x32_bf16 a[108:111], a[236:239], v[220:223], a[108:111]
s_add_u32 s12, s61, 0
v_exp_f32 v156, v156
v_mfma_f32_16x16x32_bf16 a[108:111], a[204:207], v[204:207], a[108:111]
s_and_b32 s12, s12, 3
ds_read_b128 a[204:207], v2 offset:3072
v_mfma_f32_16x16x32_bf16 a[112:115], a[208:211], v[204:207], a[112:115]
s_waitcnt lgkmcnt(4)
ds_read_b128 a[208:211], v2 offset:4096
v_mfma_f32_16x16x32_bf16 a[112:115], a[240:243], v[220:223], a[112:115]
s_lshl_b32 s12, s12, 21
buffer_store_dwordx4 v[132:135], v1, s[44:47], s70 offen sc1
v_mfma_f32_16x16x32_bf16 a[116:119], a[244:247], v[220:223], a[116:119]
s_add_u32 s12, s12, s79
v_exp_f32 v157, v157
v_mfma_f32_16x16x32_bf16 a[116:119], a[212:215], v[204:207], a[116:119]
s_add_u32 s13, s61, 1
ds_read_b128 a[212:215], v2 offset:5120
v_mfma_f32_16x16x32_bf16 a[120:123], a[216:219], v[204:207], a[120:123]
s_and_b32 s13, s13, 3
v_exp_f32 v158, v158
v_mfma_f32_16x16x32_bf16 a[120:123], a[248:251], v[220:223], a[120:123]
s_lshl_b32 s13, s13, 21
ds_read_b128 a[216:219], v2 offset:6144
v_mfma_f32_16x16x32_bf16 a[124:127], a[252:255], v[220:223], a[124:127]
s_add_u32 s13, s13, s79
buffer_store_dwordx4 v[148:151], v1, s[44:47], s70 offen offset:1024 sc1
v_mfma_f32_16x16x32_bf16 a[124:127], a[220:223], v[204:207], a[124:127]
s_add_u32 s14, s61, 2
ds_read_b128 a[220:223], v2 offset:7168
v_cvt_pk_bf16_f32 v204, v140, v141
s_cmp_eq_u32 s58, 2
s_cbranch_scc1 Lta52
s_cmp_eq_u32 s58, 3
s_cbranch_scc1 Lnt53
v_mfma_f32_16x16x32_bf16 v[172:175], a[160:163], v[64:67], v[112:115]
s_and_b32 s14, s14, 3
v_cvt_pk_bf16_f32 v205, v142, v143
v_cvt_pk_bf16_f32 v206, v156, v157
v_mfma_f32_16x16x32_bf16 v[188:191], a[176:179], v[64:67], v[112:115]
s_lshl_b32 s14, s14, 21
v_exp_f32 v159, v159
s_branch Ljoin54
Lta52:
v_mfma_f32_16x16x32_bf16 v[172:175], a[160:163], v[64:67], v[108:111]
s_and_b32 s14, s14, 3
v_cvt_pk_bf16_f32 v205, v142, v143
v_cvt_pk_bf16_f32 v206, v156, v157
v_mfma_f32_16x16x32_bf16 v[188:191], a[176:179], v[64:67], v[112:115]
s_lshl_b32 s14, s14, 21
v_exp_f32 v159, v159
s_branch Ljoin54
Lnt53:
v_mfma_f32_16x16x32_bf16 v[172:175], a[160:163], v[64:67], v[92:95]
s_and_b32 s14, s14, 3
v_cvt_pk_bf16_f32 v205, v142, v143
v_cvt_pk_bf16_f32 v206, v156, v157
v_mfma_f32_16x16x32_bf16 v[188:191], a[176:179], v[64:67], v[108:111]
s_lshl_b32 s14, s14, 21
v_exp_f32 v159, v159
Ljoin54:
v_mfma_f32_16x16x32_bf16 v[172:175], a[164:167], v[68:71], v[172:175]
s_add_u32 s14, s14, s79
v_cvt_pk_bf16_f32 v207, v158, v159
v_mfma_f32_16x16x32_bf16 v[172:175], a[168:171], v[72:75], v[172:175]
s_add_u32 s15, s61, 3
v_mfma_f32_16x16x32_bf16 v[172:175], a[172:175], v[76:79], v[172:175]
s_and_b32 s15, s15, 3
v_mfma_f32_16x16x32_bf16 v[188:191], a[188:191], v[76:79], v[188:191]
s_lshl_b32 s15, s15, 21
v_mfma_f32_16x16x32_bf16 v[188:191], a[184:187], v[72:75], v[188:191]
s_add_u32 s15, s15, s79
v_mfma_f32_16x16x32_bf16 v[188:191], a[180:183], v[68:71], v[188:191]
s_waitcnt lgkmcnt(4)
v_mfma_f32_16x16x32_bf16 v[232:235], v[120:123], v[216:219], v[232:235]
s_add_u32 s82, s82, 0x8000
v_exp_f32 v172, v172
v_mfma_f32_16x16x32_bf16 a[64:67], a[224:227], v[216:219], a[64:67]
s_and_b32 s82, s82, 0x1ffff
ds_read_b128 a[224:227], v2 offset:8192
v_mfma_f32_16x16x32_bf16 a[68:71], a[228:231], v[216:219], a[68:71]
ds_read_b128 a[228:231], v2 offset:9216
v_mfma_f32_16x16x32_bf16 a[72:75], a[232:235], v[216:219], a[72:75]
ds_read_b128 a[232:235], v2 offset:10240
v_mfma_f32_16x16x32_bf16 a[76:79], a[236:239], v[216:219], a[76:79]
buffer_store_dwordx4 v[164:167], v1, s[44:47], s70 offen offset:2048 sc1
v_mfma_f32_16x16x32_bf16 a[80:83], a[240:243], v[216:219], a[80:83]
s_nop 0
ds_read_b128 a[236:239], v2 offset:11264
ds_read_b128 a[240:243], v2 offset:12288
v_mfma_f32_16x16x32_bf16 a[84:87], a[244:247], v[216:219], a[84:87]
ds_read_b128 a[244:247], v2 offset:13312
v_mfma_f32_16x16x32_bf16 a[88:91], a[248:251], v[216:219], a[88:91]
v_exp_f32 v173, v173
v_mfma_f32_16x16x32_bf16 a[92:95], a[252:255], v[216:219], a[92:95]
v_exp_f32 v174, v174
ds_read_b128 a[248:251], v2 offset:14336
ds_read_b128 a[252:255], v2 offset:15360
v_add_u32 v2, s82, v1
buffer_store_dwordx4 v[180:183], v1, s[44:47], s70 offen offset:3072 sc1
v_cvt_pk_bf16_f32 v220, v172, v173
v_exp_f32 v175, v175
v_exp_f32 v188, v188
v_cvt_pk_bf16_f32 v221, v174, v175
v_exp_f32 v189, v189
v_exp_f32 v190, v190
v_cvt_pk_bf16_f32 v222, v188, v189
v_exp_f32 v191, v191
s_nop 0
v_cvt_pk_bf16_f32 v223, v190, v191
s_waitcnt vmcnt(8) lgkmcnt(0)
s_barrier
s_branch LHT4
Lslow:
s_waitcnt vmcnt(0) lgkmcnt(0)
s_barrier
s_mov_b32 s86, 1
s_lshl_b32 s81, s59, 20
s_add_u32 s81, s81, s64
s_sub_u32 s81, s81, 0x4000
s_mov_b32 s83, 0
s_lshl_b32 s75, s60, 3
s_sub_u32 s76, 128, s75
s_add_u32 s74, s75, s58
s_sub_u32 s75, s76, 8
s_add_u32 s75, s75, s58
v_mov_b32 v2, v1
v_lshrrev_b32 v240, 4, v0
v_and_b32 v241, 15, v0
v_lshlrev_b32 v240, 2, v240
v_sub_u32 v240, v241, v240
v_mov_b32 v112, 0xff800000
v_mov_b32 v113, 0xff800000
v_mov_b32 v114, 0xff800000
v_mov_b32 v115, 0xff800000
v_cmp_gt_i32 vcc, 0, v240
v_mov_b32 v120, 0x3f803f80
s_nop 0
v_cndmask_b32 v116, 0, v112, vcc
v_cmp_gt_i32 vcc, 1, v240
v_mov_b32 v121, 0x3f803f80
s_nop 0
v_cndmask_b32 v117, 0, v112, vcc
v_cmp_gt_i32 vcc, 2, v240
v_mov_b32 v122, 0x3f803f80
s_nop 0
v_cndmask_b32 v118, 0, v112, vcc
v_cmp_gt_i32 vcc, 3, v240
v_mov_b32 v123, 0x3f803f80
s_nop 0
v_cndmask_b32 v119, 0, v112, vcc
Lslow1:
s_add_u32 m0, s64, 16384
s_add_u32 s72, s81, 16384
buffer_load_dwordx4 v1, s[44:47], s72 offen sc1 lds
buffer_load_dwordx4 v1, s[44:47], s72 offen offset:1024 sc1 lds
buffer_load_dwordx4 v1, s[44:47], s72 offen offset:2048 sc1 lds
buffer_load_dwordx4 v1, s[44:47], s72 offen offset:3072 sc1 lds
s_add_u32 s81, s81, 0x8000
s_waitcnt vmcnt(0)
s_barrier
ds_read_b128 a[128:131], v2 offset:16384
ds_read_b128 a[132:135], v2 offset:17408
ds_read_b128 a[136:139], v2 offset:18432
ds_read_b128 a[140:143], v2 offset:19456
ds_read_b128 a[144:147], v2 offset:20480
ds_read_b128 a[148:151], v2 offset:21504
ds_read_b128 a[152:155], v2 offset:22528
ds_read_b128 a[156:159], v2 offset:23552
s_waitcnt lgkmcnt(0)
s_add_u32 s73, s74, 0
s_cmp_lt_u32 s73, s83
s_cbranch_scc1 Lsa55
s_cmp_eq_u32 s73, s83
s_cbranch_scc1 Lst56
v_mfma_f32_16x16x32_bf16 v[128:131], a[128:131], v[16:19], 0
s_branch Lsj57
Lst56:
v_mfma_f32_16x16x32_bf16 v[128:131], a[128:131], v[16:19], v[116:119]
Lsj57:
v_mfma_f32_16x16x32_bf16 v[128:131], a[132:135], v[20:23], v[128:131]
v_mfma_f32_16x16x32_bf16 v[128:131], a[136:139], v[24:27], v[128:131]
v_mfma_f32_16x16x32_bf16 v[128:131], a[140:143], v[28:31], v[128:131]
s_nop 7
v_max3_f32 v124, v124, v128, v129
v_max3_f32 v124, v124, v130, v131
Lsa55:
s_add_u32 s73, s74, 4
s_cmp_lt_u32 s73, s83
s_cbranch_scc1 Lsa58
s_cmp_eq_u32 s73, s83
s_cbranch_scc1 Lst59
v_mfma_f32_16x16x32_bf16 v[132:135], a[128:131], v[32:35], 0
s_branch Lsj60
Lst59:
v_mfma_f32_16x16x32_bf16 v[132:135], a[128:131], v[32:35], v[116:119]
Lsj60:
v_mfma_f32_16x16x32_bf16 v[132:135], a[132:135], v[36:39], v[132:135]
v_mfma_f32_16x16x32_bf16 v[132:135], a[136:139], v[40:43], v[132:135]
v_mfma_f32_16x16x32_bf16 v[132:135], a[140:143], v[44:47], v[132:135]
s_nop 7
v_max3_f32 v125, v125, v132, v133
v_max3_f32 v125, v125, v134, v135
Lsa58:
s_add_u32 s73, s75, 0
s_cmp_lt_u32 s73, s83
s_cbranch_scc1 Lsa61
s_cmp_eq_u32 s73, s83
s_cbranch_scc1 Lst62
v_mfma_f32_16x16x32_bf16 v[136:139], a[128:131], v[48:51], 0
s_branch Lsj63
Lst62:
v_mfma_f32_16x16x32_bf16 v[136:139], a[128:131], v[48:51], v[116:119]
Lsj63:
v_mfma_f32_16x16x32_bf16 v[136:139], a[132:135], v[52:55], v[136:139]
v_mfma_f32_16x16x32_bf16 v[136:139], a[136:139], v[56:59], v[136:139]
v_mfma_f32_16x16x32_bf16 v[136:139], a[140:143], v[60:63], v[136:139]
s_nop 7
v_max3_f32 v126, v126, v136, v137
v_max3_f32 v126, v126, v138, v139
Lsa61:
s_add_u32 s73, s75, 4
s_cmp_lt_u32 s73, s83
s_cbranch_scc1 Lsa64
s_cmp_eq_u32 s73, s83
s_cbranch_scc1 Lst65
v_mfma_f32_16x16x32_bf16 v[140:143], a[128:131], v[64:67], 0
s_branch Lsj66
Lst65:
v_mfma_f32_16x16x32_bf16 v[140:143], a[128:131], v[64:67], v[116:119]
Lsj66:
v_mfma_f32_16x16x32_bf16 v[140:143], a[132:135], v[68:71], v[140:143]
v_mfma_f32_16x16x32_bf16 v[140:143], a[136:139], v[72:75], v[140:143]
v_mfma_f32_16x16x32_bf16 v[140:143], a[140:143], v[76:79], v[140:143]
s_nop 7
v_max3_f32 v127, v127, v140, v141
v_max3_f32 v127, v127, v142, v143
Lsa64:
s_add_u32 s83, s83, 1
s_add_u32 s73, s74, 0
s_cmp_lt_u32 s73, s83
s_cbranch_scc1 Lsa67
s_cmp_eq_u32 s73, s83
s_cbranch_scc1 Lst68
v_mfma_f32_16x16x32_bf16 v[144:147], a[144:147], v[16:19], 0
s_branch Lsj69
Lst68:
v_mfma_f32_16x16x32_bf16 v[144:147], a[144:147], v[16:19], v[116:119]
Lsj69:
v_mfma_f32_16x16x32_bf16 v[144:147], a[148:151], v[20:23], v[144:147]
v_mfma_f32_16x16x32_bf16 v[144:147], a[152:155], v[24:27], v[144:147]
v_mfma_f32_16x16x32_bf16 v[144:147], a[156:159], v[28:31], v[144:147]
s_nop 7
v_max3_f32 v124, v124, v144, v145
v_max3_f32 v124, v124, v146, v147
Lsa67:
s_add_u32 s73, s74, 4
s_cmp_lt_u32 s73, s83
s_cbranch_scc1 Lsa70
s_cmp_eq_u32 s73, s83
s_cbranch_scc1 Lst71
v_mfma_f32_16x16x32_bf16 v[148:151], a[144:147], v[32:35], 0
s_branch Lsj72
Lst71:
v_mfma_f32_16x16x32_bf16 v[148:151], a[144:147], v[32:35], v[116:119]
Lsj72:
v_mfma_f32_16x16x32_bf16 v[148:151], a[148:151], v[36:39], v[148:151]
v_mfma_f32_16x16x32_bf16 v[148:151], a[152:155], v[40:43], v[148:151]
v_mfma_f32_16x16x32_bf16 v[148:151], a[156:159], v[44:47], v[148:151]
s_nop 7
v_max3_f32 v125, v125, v148, v149
v_max3_f32 v125, v125, v150, v151
Lsa70:
s_add_u32 s73, s75, 0
s_cmp_lt_u32 s73, s83
s_cbranch_scc1 Lsa73
s_cmp_eq_u32 s73, s83
s_cbranch_scc1 Lst74
v_mfma_f32_16x16x32_bf16 v[152:155], a[144:147], v[48:51], 0
s_branch Lsj75
Lst74:
v_mfma_f32_16x16x32_bf16 v[152:155], a[144:147], v[48:51], v[116:119]
Lsj75:
v_mfma_f32_16x16x32_bf16 v[152:155], a[148:151], v[52:55], v[152:155]
v_mfma_f32_16x16x32_bf16 v[152:155], a[152:155], v[56:59], v[152:155]
v_mfma_f32_16x16x32_bf16 v[152:155], a[156:159], v[60:63], v[152:155]
s_nop 7
v_max3_f32 v126, v126, v152, v153
v_max3_f32 v126, v126, v154, v155
Lsa73:
s_add_u32 s73, s75, 4
s_cmp_lt_u32 s73, s83
s_cbranch_scc1 Lsa76
s_cmp_eq_u32 s73, s83
s_cbranch_scc1 Lst77
v_mfma_f32_16x16x32_bf16 v[156:159], a[144:147], v[64:67], 0
s_branch Lsj78
Lst77:
v_mfma_f32_16x16x32_bf16 v[156:159], a[144:147], v[64:67], v[116:119]
Lsj78:
v_mfma_f32_16x16x32_bf16 v[156:159], a[148:151], v[68:71], v[156:159]
v_mfma_f32_16x16x32_bf16 v[156:159], a[152:155], v[72:75], v[156:159]
v_mfma_f32_16x16x32_bf16 v[156:159], a[156:159], v[76:79], v[156:159]
s_nop 7
v_max3_f32 v127, v127, v156, v157
v_max3_f32 v127, v127, v158, v159
Lsa76:
s_add_u32 s83, s83, 1
ds_read_b128 a[128:131], v2 offset:24576
ds_read_b128 a[132:135], v2 offset:25600
ds_read_b128 a[136:139], v2 offset:26624
ds_read_b128 a[140:143], v2 offset:27648
ds_read_b128 a[144:147], v2 offset:28672
ds_read_b128 a[148:151], v2 offset:29696
ds_read_b128 a[152:155], v2 offset:30720
ds_read_b128 a[156:159], v2 offset:31744
s_waitcnt lgkmcnt(0)
s_add_u32 s73, s74, 0
s_cmp_lt_u32 s73, s83
s_cbranch_scc1 Lsa79
s_cmp_eq_u32 s73, s83
s_cbranch_scc1 Lst80
v_mfma_f32_16x16x32_bf16 v[128:131], a[128:131], v[16:19], 0
s_branch Lsj81
Lst80:
v_mfma_f32_16x16x32_bf16 v[128:131], a[128:131], v[16:19], v[116:119]
Lsj81:
v_mfma_f32_16x16x32_bf16 v[128:131], a[132:135], v[20:23], v[128:131]
v_mfma_f32_16x16x32_bf16 v[128:131], a[136:139], v[24:27], v[128:131]
v_mfma_f32_16x16x32_bf16 v[128:131], a[140:143], v[28:31], v[128:131]
s_nop 7
v_max3_f32 v124, v124, v128, v129
v_max3_f32 v124, v124, v130, v131
Lsa79:
s_add_u32 s73, s74, 4
s_cmp_lt_u32 s73, s83
s_cbranch_scc1 Lsa82
s_cmp_eq_u32 s73, s83
s_cbranch_scc1 Lst83
v_mfma_f32_16x16x32_bf16 v[132:135], a[128:131], v[32:35], 0
s_branch Lsj84
Lst83:
v_mfma_f32_16x16x32_bf16 v[132:135], a[128:131], v[32:35], v[116:119]
Lsj84:
v_mfma_f32_16x16x32_bf16 v[132:135], a[132:135], v[36:39], v[132:135]
v_mfma_f32_16x16x32_bf16 v[132:135], a[136:139], v[40:43], v[132:135]
v_mfma_f32_16x16x32_bf16 v[132:135], a[140:143], v[44:47], v[132:135]
s_nop 7
v_max3_f32 v125, v125, v132, v133
v_max3_f32 v125, v125, v134, v135
Lsa82:
s_add_u32 s73, s75, 0
s_cmp_lt_u32 s73, s83
s_cbranch_scc1 Lsa85
s_cmp_eq_u32 s73, s83
s_cbranch_scc1 Lst86
v_mfma_f32_16x16x32_bf16 v[136:139], a[128:131], v[48:51], 0
s_branch Lsj87
Lst86:
v_mfma_f32_16x16x32_bf16 v[136:139], a[128:131], v[48:51], v[116:119]
Lsj87:
v_mfma_f32_16x16x32_bf16 v[136:139], a[132:135], v[52:55], v[136:139]
v_mfma_f32_16x16x32_bf16 v[136:139], a[136:139], v[56:59], v[136:139]
v_mfma_f32_16x16x32_bf16 v[136:139], a[140:143], v[60:63], v[136:139]
s_nop 7
v_max3_f32 v126, v126, v136, v137
v_max3_f32 v126, v126, v138, v139
Lsa85:
s_add_u32 s73, s75, 4
s_cmp_lt_u32 s73, s83
s_cbranch_scc1 Lsa88
s_cmp_eq_u32 s73, s83
s_cbranch_scc1 Lst89
v_mfma_f32_16x16x32_bf16 v[140:143], a[128:131], v[64:67], 0
s_branch Lsj90
Lst89:
v_mfma_f32_16x16x32_bf16 v[140:143], a[128:131], v[64:67], v[116:119]
Lsj90:
v_mfma_f32_16x16x32_bf16 v[140:143], a[132:135], v[68:71], v[140:143]
v_mfma_f32_16x16x32_bf16 v[140:143], a[136:139], v[72:75], v[140:143]
v_mfma_f32_16x16x32_bf16 v[140:143], a[140:143], v[76:79], v[140:143]
s_nop 7
v_max3_f32 v127, v127, v140, v141
v_max3_f32 v127, v127, v142, v143
Lsa88:
s_add_u32 s83, s83, 1
s_add_u32 s73, s74, 0
s_cmp_lt_u32 s73, s83
s_cbranch_scc1 Lsa91
s_cmp_eq_u32 s73, s83
s_cbranch_scc1 Lst92
v_mfma_f32_16x16x32_bf16 v[144:147], a[144:147], v[16:19], 0
s_branch Lsj93
Lst92:
v_mfma_f32_16x16x32_bf16 v[144:147], a[144:147], v[16:19], v[116:119]
Lsj93:
v_mfma_f32_16x16x32_bf16 v[144:147], a[148:151], v[20:23], v[144:147]
v_mfma_f32_16x16x32_bf16 v[144:147], a[152:155], v[24:27], v[144:147]
v_mfma_f32_16x16x32_bf16 v[144:147], a[156:159], v[28:31], v[144:147]
s_nop 7
v_max3_f32 v124, v124, v144, v145
v_max3_f32 v124, v124, v146, v147
Lsa91:
s_add_u32 s73, s74, 4
s_cmp_lt_u32 s73, s83
s_cbranch_scc1 Lsa94
s_cmp_eq_u32 s73, s83
s_cbranch_scc1 Lst95
v_mfma_f32_16x16x32_bf16 v[148:151], a[144:147], v[32:35], 0
s_branch Lsj96
Lst95:
v_mfma_f32_16x16x32_bf16 v[148:151], a[144:147], v[32:35], v[116:119]
Lsj96:
v_mfma_f32_16x16x32_bf16 v[148:151], a[148:151], v[36:39], v[148:151]
v_mfma_f32_16x16x32_bf16 v[148:151], a[152:155], v[40:43], v[148:151]
v_mfma_f32_16x16x32_bf16 v[148:151], a[156:159], v[44:47], v[148:151]
s_nop 7
v_max3_f32 v125, v125, v148, v149
v_max3_f32 v125, v125, v150, v151
Lsa94:
s_add_u32 s73, s75, 0
s_cmp_lt_u32 s73, s83
s_cbranch_scc1 Lsa97
s_cmp_eq_u32 s73, s83
s_cbranch_scc1 Lst98
v_mfma_f32_16x16x32_bf16 v[152:155], a[144:147], v[48:51], 0
s_branch Lsj99
Lst98:
v_mfma_f32_16x16x32_bf16 v[152:155], a[144:147], v[48:51], v[116:119]
Lsj99:
v_mfma_f32_16x16x32_bf16 v[152:155], a[148:151], v[52:55], v[152:155]
v_mfma_f32_16x16x32_bf16 v[152:155], a[152:155], v[56:59], v[152:155]
v_mfma_f32_16x16x32_bf16 v[152:155], a[156:159], v[60:63], v[152:155]
s_nop 7
v_max3_f32 v126, v126, v152, v153
v_max3_f32 v126, v126, v154, v155
Lsa97:
s_add_u32 s73, s75, 4
s_cmp_lt_u32 s73, s83
s_cbranch_scc1 Lsa100
s_cmp_eq_u32 s73, s83
s_cbranch_scc1 Lst101
v_mfma_f32_16x16x32_bf16 v[156:159], a[144:147], v[64:67], 0
s_branch Lsj102
Lst101:
v_mfma_f32_16x16x32_bf16 v[156:159], a[144:147], v[64:67], v[116:119]
Lsj102:
v_mfma_f32_16x16x32_bf16 v[156:159], a[148:151], v[68:71], v[156:159]
v_mfma_f32_16x16x32_bf16 v[156:159], a[152:155], v[72:75], v[156:159]
v_mfma_f32_16x16x32_bf16 v[156:159], a[156:159], v[76:79], v[156:159]
s_nop 7
v_max3_f32 v127, v127, v156, v157
v_max3_f32 v127, v127, v158, v159
Lsa100:
s_add_u32 s83, s83, 1
s_barrier
s_cmp_lt_u32 s83, s76
s_cbranch_scc1 Lslow1
s_lshl_b32 s81, s59, 20
s_add_u32 s81, s81, s64
s_sub_u32 s81, s81, 0x4000
s_add_u32 m0, s64, 49152
s_add_u32 s72, s81, 16384
buffer_load_dwordx4 v1, s[44:47], s72 offen sc1 lds
buffer_load_dwordx4 v1, s[44:47], s72 offen offset:1024 sc1 lds
buffer_load_dwordx4 v1, s[44:47], s72 offen offset:2048 sc1 lds
buffer_load_dwordx4 v1, s[44:47], s72 offen offset:3072 sc1 lds
s_add_u32 s81, s81, 0x8000
s_add_u32 m0, s64, 81920
s_add_u32 s72, s81, 16384
buffer_load_dwordx4 v1, s[44:47], s72 offen sc1 lds
buffer_load_dwordx4 v1, s[44:47], s72 offen offset:1024 sc1 lds
buffer_load_dwordx4 v1, s[44:47], s72 offen offset:2048 sc1 lds
buffer_load_dwordx4 v1, s[44:47], s72 offen offset:3072 sc1 lds
s_add_u32 m0, s64, 65536
s_add_u32 s72, s81, 0
buffer_load_dwordx4 v1, s[44:47], s72 offen sc1 lds
buffer_load_dwordx4 v1, s[44:47], s72 offen offset:1024 sc1 lds
buffer_load_dwordx4 v1, s[44:47], s72 offen offset:2048 sc1 lds
buffer_load_dwordx4 v1, s[44:47], s72 offen offset:3072 sc1 lds
s_add_u32 s81, s81, 0x8000
s_add_u32 m0, s64, 114688
s_add_u32 s72, s81, 16384
buffer_load_dwordx4 v1, s[44:47], s72 offen sc1 lds
buffer_load_dwordx4 v1, s[44:47], s72 offen offset:1024 sc1 lds
buffer_load_dwordx4 v1, s[44:47], s72 offen offset:2048 sc1 lds
buffer_load_dwordx4 v1, s[44:47], s72 offen offset:3072 sc1 lds
s_add_u32 m0, s64, 98304
s_add_u32 s72, s81, 0
buffer_load_dwordx4 v1, s[44:47], s72 offen sc1 lds
buffer_load_dwordx4 v1, s[44:47], s72 offen offset:1024 sc1 lds
buffer_load_dwordx4 v1, s[44:47], s72 offen offset:2048 sc1 lds
buffer_load_dwordx4 v1, s[44:47], s72 offen offset:3072 sc1 lds
v_add_u32 v2, 0x8000, v1
v_lshrrev_b32 v3, 1, v0
v_lshlrev_b32 v3, 7, v3
s_waitcnt vmcnt(0)
s_barrier
v_accvgpr_write_b32 a32, 0
v_accvgpr_write_b32 a33, 0
v_accvgpr_write_b32 a34, 0
v_accvgpr_write_b32 a35, 0
v_accvgpr_write_b32 a36, 0
v_accvgpr_write_b32 a37, 0
v_accvgpr_write_b32 a38, 0
v_accvgpr_write_b32 a39, 0
v_accvgpr_write_b32 a40, 0
v_accvgpr_write_b32 a41, 0
v_accvgpr_write_b32 a42, 0
v_accvgpr_write_b32 a43, 0
v_accvgpr_write_b32 a44, 0
v_accvgpr_write_b32 a45, 0
v_accvgpr_write_b32 a46, 0
v_accvgpr_write_b32 a47, 0
v_accvgpr_write_b32 a48, 0
v_accvgpr_write_b32 a49, 0
v_accvgpr_write_b32 a50, 0
v_accvgpr_write_b32 a51, 0
v_accvgpr_write_b32 a52, 0
v_accvgpr_write_b32 a53, 0
v_accvgpr_write_b32 a54, 0
v_accvgpr_write_b32 a55, 0
v_accvgpr_write_b32 a56, 0
v_accvgpr_write_b32 a57, 0
v_accvgpr_write_b32 a58, 0
v_accvgpr_write_b32 a59, 0
v_accvgpr_write_b32 a60, 0
v_accvgpr_write_b32 a61, 0
v_accvgpr_write_b32 a62, 0
v_accvgpr_write_b32 a63, 0
v_accvgpr_write_b32 a96, 0
v_accvgpr_write_b32 a97, 0
v_accvgpr_write_b32 a98, 0
v_accvgpr_write_b32 a99, 0
v_accvgpr_write_b32 a100, 0
v_accvgpr_write_b32 a101, 0
v_accvgpr_write_b32 a102, 0
v_accvgpr_write_b32 a103, 0
v_accvgpr_write_b32 a104, 0
v_accvgpr_write_b32 a105, 0
v_accvgpr_write_b32 a106, 0
v_accvgpr_write_b32 a107, 0
v_accvgpr_write_b32 a108, 0
v_accvgpr_write_b32 a109, 0
v_accvgpr_write_b32 a110, 0
v_accvgpr_write_b32 a111, 0
v_accvgpr_write_b32 a112, 0
v_accvgpr_write_b32 a113, 0
v_accvgpr_write_b32 a114, 0
v_accvgpr_write_b32 a115, 0
v_accvgpr_write_b32 a116, 0
v_accvgpr_write_b32 a117, 0
v_accvgpr_write_b32 a118, 0
v_accvgpr_write_b32 a119, 0
v_accvgpr_write_b32 a120, 0
v_accvgpr_write_b32 a121, 0
v_accvgpr_write_b32 a122, 0
v_accvgpr_write_b32 a123, 0
v_accvgpr_write_b32 a124, 0
v_accvgpr_write_b32 a125, 0
v_accvgpr_write_b32 a126, 0
v_accvgpr_write_b32 a127, 0
ds_read_b128 a[128:131], v2 offset:16384
ds_read_b128 a[132:135], v2 offset:17408
ds_read_b128 a[136:139], v2 offset:18432
ds_read_b128 a[140:143], v2 offset:19456
ds_read_b128 a[144:147], v2 offset:20480
ds_read_b128 a[148:151], v2 offset:21504
ds_read_b128 a[152:155], v2 offset:22528
ds_read_b128 a[156:159], v2 offset:23552
s_branch Lattn
Lspin103:
s_mov_b32 s83, 262144
Lsl105:
s_sleep 2
buffer_load_dword v3, v2, s[44:47], s82 offen sc1
s_sub_u32 s83, s83, 1
s_cmp_eq_u32 s83, 0
s_waitcnt vmcnt(0)
s_cbranch_scc1 Lback104
v_cmp_gt_u32 vcc, 2, v3
s_cbranch_vccnz Lsl105
s_branch Lback104
Lspin106:
s_mov_b32 s83, 262144
Lsl108:
s_sleep 2
buffer_load_dword v3, v2, s[44:47], s82 offen sc1
s_sub_u32 s83, s83, 1
s_cmp_eq_u32 s83, 0
s_waitcnt vmcnt(0)
s_cbranch_scc1 Lback107
v_cmp_gt_u32 vcc, 2, v3
s_cbranch_vccnz Lsl108
s_branch Lback107
Lredo0:
s_xor_b32 s82, s78, 0
s_lshl_b32 s82, s82, 10
s_add_u32 s82, s82, s74
buffer_load_dword v3, v2, s[44:47], s82 offen sc1
s_waitcnt vmcnt(0)
v_cmp_gt_u32 vcc, 2, v3
s_cbranch_vccnz Lspin103
Lback104:
s_lshr_b32 s69, s12, 18
s_lshl_b32 s69, s69, 12
s_add_u32 s69, s69, s95
buffer_load_dwordx4 a[0:3], v1, s[44:47], s69 offen sc1
buffer_load_dwordx4 a[4:7], v1, s[44:47], s69 offen offset:1024 sc1
buffer_load_dwordx4 a[8:11], v1, s[44:47], s69 offen offset:2048 sc1
buffer_load_dwordx4 a[12:15], v1, s[44:47], s69 offen offset:3072 sc1
s_add_u32 s69, s69, 0x20000
buffer_load_dwordx4 a[16:19], v1, s[44:47], s69 offen sc1
buffer_load_dwordx4 a[20:23], v1, s[44:47], s69 offen offset:1024 sc1
buffer_load_dwordx4 a[24:27], v1, s[44:47], s69 offen offset:2048 sc1
buffer_load_dwordx4 a[28:31], v1, s[44:47], s69 offen offset:3072 sc1
s_lshr_b32 s69, s13, 18
s_lshl_b32 s69, s69, 12
s_add_u32 s69, s69, s95
buffer_load_dwordx4 a[32:35], v1, s[44:47], s69 offen sc1
buffer_load_dwordx4 a[36:39], v1, s[44:47], s69 offen offset:1024 sc1
buffer_load_dwordx4 a[40:43], v1, s[44:47], s69 offen offset:2048 sc1
buffer_load_dwordx4 a[44:47], v1, s[44:47], s69 offen offset:3072 sc1
s_add_u32 s69, s69, 0x20000
buffer_load_dwordx4 a[48:51], v1, s[44:47], s69 offen sc1
buffer_load_dwordx4 a[52:55], v1, s[44:47], s69 offen offset:1024 sc1
buffer_load_dwordx4 a[56:59], v1, s[44:47], s69 offen offset:2048 sc1
buffer_load_dwordx4 a[60:63], v1, s[44:47], s69 offen offset:3072 sc1
s_waitcnt vmcnt(8)
s_branch Lredo0b
Lspin109:
s_mov_b32 s83, 262144
Lsl111:
s_sleep 2
buffer_load_dword v114, v115, s[44:47], s84 offen sc1
s_sub_u32 s83, s83, 1
s_cmp_eq_u32 s83, 0
s_waitcnt vmcnt(0)
s_cbranch_scc1 Lback110
v_cmp_gt_u32 vcc, 3, v114
s_cbranch_vccnz Lsl111
s_branch Lback110
Lspin112:
s_mov_b32 s83, 262144
Lsl114:
s_sleep 2
buffer_load_dword v14, v13, s[44:47], s79 offen sc1
s_sub_u32 s83, s83, 1
s_cmp_eq_u32 s83, 0
s_waitcnt vmcnt(0)
s_cbranch_scc1 Lback113
v_cmp_gt_u32 vcc, 2, v14
s_cbranch_vccnz Lsl114
s_branch Lback113
Lxspin1:
s_mov_b32 s83, 262144
Lxsl1:
buffer_load_dwordx4 v[96:99], v1, s[44:47], s79 offen sc1
buffer_load_dwordx4 v[100:103], v1, s[44:47], s79 offen offset:1024 sc1
buffer_load_dwordx4 v[104:107], v1, s[44:47], s79 offen offset:2048 sc1
buffer_load_dwordx4 v[108:111], v1, s[44:47], s79 offen offset:3072 sc1
s_sub_u32 s83, s83, 1
s_cmp_eq_u32 s83, 0
s_waitcnt vmcnt(0)
s_cbranch_scc1 Lxback1
v_max3_u32 v12, v96, v97, v98
v_max3_u32 v13, v99, v100, v101
v_max3_u32 v12, v12, v102, v103
v_max3_u32 v13, v13, v104, v105
v_max3_u32 v12, v12, v106, v107
v_max3_u32 v13, v13, v108, v109
v_max3_u32 v12, v12, v110, v111
v_max_u32 v12, v12, v13
v_cmp_le_u32 vcc, 0xff800000, v12
s_cbranch_vccnz Lxsl1
s_branch Lxback1
Lxspin2:
s_mov_b32 s83, 262144
Lxsl2:
buffer_load_dwordx4 v[80:83], v1, s[44:47], s82 offen sc1
buffer_load_dwordx4 v[84:87], v1, s[44:47], s82 offen offset:1024 sc1
buffer_load_dwordx4 v[88:91], v1, s[44:47], s82 offen offset:2048 sc1
buffer_load_dwordx4 v[92:95], v1, s[44:47], s82 offen offset:3072 sc1
s_sub_u32 s83, s83, 1
s_cmp_eq_u32 s83, 0
s_waitcnt vmcnt(0)
s_cbranch_scc1 Lxback2
v_max3_u32 v12, v80, v81, v82
v_max3_u32 v13, v83, v84, v85
v_max3_u32 v12, v12, v86, v87
v_max3_u32 v13, v13, v88, v89
v_max3_u32 v12, v12, v90, v91
v_max3_u32 v13, v13, v92, v93
v_max3_u32 v12, v12, v94, v95
v_max_u32 v12, v12, v13
v_cmp_le_u32 vcc, 0xff800000, v12
s_cbranch_vccnz Lxsl2
s_branch Lxback2
Lxspin3:
s_mov_b32 s83, 262144
Lxsl3:
buffer_load_dwordx4 v[96:99], v1, s[44:47], s81 offen sc1
buffer_load_dwordx4 v[100:103], v1, s[44:47], s81 offen offset:1024 sc1
buffer_load_dwordx4 v[104:107], v1, s[44:47], s81 offen offset:2048 sc1
buffer_load_dwordx4 v[108:111], v1, s[44:47], s81 offen offset:3072 sc1
s_sub_u32 s83, s83, 1
s_cmp_eq_u32 s83, 0
s_waitcnt vmcnt(0)
s_cbranch_scc1 Lxback3
v_max3_u32 v12, v96, v97, v98
v_max3_u32 v13, v99, v100, v101
v_max3_u32 v12, v12, v102, v103
v_max3_u32 v13, v13, v104, v105
v_max3_u32 v12, v12, v106, v107
v_max3_u32 v13, v13, v108, v109
v_max3_u32 v12, v12, v110, v111
v_max_u32 v12, v12, v13
v_cmp_le_u32 vcc, 0xff800000, v12
s_cbranch_vccnz Lxsl3
s_branch Lxback3
Lcode_end:
s_endpgm
.section .rodata,"a"
.p2align 6
.amdhsa_kernel gated_mix__compressed_kv_cla__ssm_conv_h3__prompt_kernel
  .amdhsa_next_free_vgpr 512
  .amdhsa_next_free_sgpr 102
  .amdhsa_accum_offset 256
  .amdhsa_group_segment_fixed_size 0
  .amdhsa_kernarg_size 128
  .amdhsa_user_sgpr_count 2
  .amdhsa_user_sgpr_kernarg_segment_ptr 1
  .amdhsa_system_sgpr_workgroup_id_x 1
  .amdhsa_float_denorm_mode_32 3
.end_amdhsa_kernel
```

```asm
; @launch grid=(256,1,1) block=(256,1,1) lds=163840
.amdgcn_target "amdgcn-amd-amdhsa--gfx950"
.text
.globl gated_mix__compressed_kv_cla__ssm_conv_h3__prompt_kernel
.p2align 8
.type gated_mix__compressed_kv_cla__ssm_conv_h3__prompt_kernel,@function
gated_mix__compressed_kv_cla__ssm_conv_h3__prompt_kernel:
s_cmp_ge_u32 s2, 256
s_cbranch_scc1 Lend
s_load_dwordx2 s[8:9], s[0:1], 8
s_load_dwordx2 s[16:17], s[0:1], 24
s_load_dwordx2 s[20:21], s[0:1], 32
s_load_dwordx2 s[4:5], s[0:1], 0
s_load_dwordx2 s[12:13], s[0:1], 16
s_load_dwordx2 s[24:25], s[0:1], 40
s_load_dwordx2 s[28:29], s[0:1], 56
s_load_dwordx2 s[32:33], s[0:1], 64
s_load_dwordx2 s[52:53], s[0:1], 72
s_load_dwordx2 s[36:37], s[0:1], 80
s_load_dwordx2 s[54:55], s[0:1], 88
s_load_dwordx2 s[56:57], s[0:1], 96
s_load_dwordx2 s[40:41], s[0:1], 104
s_load_dwordx2 s[48:49], s[0:1], 112
s_load_dwordx2 s[44:45], s[0:1], 120
s_getpc_b64 s[98:99]
Lpc0:
s_lshr_b32 s75, s2, 3
v_lshrrev_b32 v26, 3, v0
s_lshl_b32 s73, s75, 12
v_lshlrev_b32 v26, 7, v26
v_add_u32 v26, s73, v26
v_min_u32 v26, Lcode_end-Lpc0, v26
global_load_dword v31, v26, s[98:99]
v_lshrrev_b32 v26, 6, v0
v_and_b32 v0, 63, v0
s_and_b32 s73, s2, 7
v_readfirstlane_b32 s58, v26
s_lshr_b32 s65, s75, 3
s_and_b32 s60, s75, 7
s_lshl_b32 s59, s73, 2
s_add_u32 s59, s59, s65
s_lshl_b32 s61, s65, 1
s_lshl_b32 s63, s58, 13
s_lshl_b32 s64, s58, 12
s_lshl_b32 s67, s60, 18
s_lshl_b32 s76, s58, 16
s_add_u32 s84, s67, s76
s_lshl_b32 s66, s58, 17
s_lshl_b32 s73, s73, 2
s_lshr_b32 s73, 0x67234501, s73
s_and_b32 s73, s73, 7
s_lshl_b32 s74, s65, 3
s_add_u32 s73, s73, s74
s_lshl_b32 s73, s73, 8
s_add_u32 s66, s66, s73
v_lshrrev_b32 v26, 4, v0
v_and_b32 v27, 7, v0
v_xor_b32 v27, v27, v26
v_lshlrev_b32 v27, 4, v27
v_lshrrev_b32 v28, 3, v0
v_lshl_add_u32 v2, v28, 10, v27
v_xor_b32 v3, 64, v2
v_and_b32 v29, 15, v0
v_lshlrev_b32 v30, 1, v26
v_xor_b32 v30, v30, v29
v_lshlrev_b32 v30, 4, v30
v_lshl_add_u32 v6, v26, 13, v30
v_xor_b32 v7, 0x80, v6
s_mov_b32 s10, 0x200000
s_mov_b32 s11, 0x20000
s_mov_b32 s18, 0x400000
s_mov_b32 s19, 0x20000
s_mov_b32 s22, 0x400000
s_mov_b32 s23, 0x20000
s_lshl_b32 s73, s2, 2
s_add_u32 s73, s73, s58
s_lshl_b32 s73, s73, 11
v_lshrrev_b32 v124, 2, v0
v_lshlrev_b32 v124, 7, v124
v_add_u32 v124, s73, v124
s_lshr_b32 s73, s2, 3
s_lshl_b32 s73, s73, 2
s_add_u32 s73, s73, s58
s_lshl_b32 s73, s73, 13
s_and_b32 s74, s66, 0x700
s_add_u32 s73, s73, s74
v_lshrrev_b32 v125, 4, v0
v_lshlrev_b32 v125, 11, v125
v_bfe_u32 v126, v0, 3, 1
v_lshl_add_u32 v125, v126, 7, v125
v_add_u32 v125, s73, v125
s_waitcnt lgkmcnt(0)
s_and_b32 s73, s65, 1
s_xor_b32 s73, s73, 0
s_lshl_b32 s69, s73, 7
s_add_u32 s69, s69, s84
s_lshl_b32 s71, s73, 19
s_add_u32 s71, s71, s66
s_add_u32 m0, s63, 65536
s_add_u32 s72, s69, 0
buffer_load_dwordx4 v2, s[8:11], s72 offen lds
s_add_u32 s72, s69, 7168
buffer_load_dwordx4 v3, s[8:11], s72 offen offset:1024 lds
s_add_u32 s72, s69, 14336
buffer_load_dwordx4 v2, s[8:11], s72 offen offset:2048 lds
s_add_u32 s72, s69, 21504
buffer_load_dwordx4 v3, s[8:11], s72 offen offset:3072 lds
s_add_u32 m0, s64, 0
s_add_u32 s72, s71, 0
buffer_load_dwordx4 v6, s[16:19], s72 offen lds
s_add_u32 s72, s71, 31744
buffer_load_dwordx4 v6, s[16:19], s72 offen offset:1024 lds
s_add_u32 s72, s71, 63488
buffer_load_dwordx4 v7, s[16:19], s72 offen offset:2048 lds
s_add_u32 s72, s71, 95232
buffer_load_dwordx4 v7, s[16:19], s72 offen offset:3072 lds
s_add_u32 m0, s63, 69632
s_add_u32 s72, s69, 32768
buffer_load_dwordx4 v2, s[8:11], s72 offen lds
s_add_u32 s72, s69, 39936
buffer_load_dwordx4 v3, s[8:11], s72 offen offset:1024 lds
s_add_u32 s72, s69, 47104
buffer_load_dwordx4 v2, s[8:11], s72 offen offset:2048 lds
s_add_u32 s72, s69, 54272
buffer_load_dwordx4 v3, s[8:11], s72 offen offset:3072 lds
s_add_u32 m0, s64, 16384
s_add_u32 s72, s71, 0
buffer_load_dwordx4 v6, s[20:23], s72 offen lds
s_add_u32 s72, s71, 31744
buffer_load_dwordx4 v6, s[20:23], s72 offen offset:1024 lds
s_add_u32 s72, s71, 63488
buffer_load_dwordx4 v7, s[20:23], s72 offen offset:2048 lds
s_add_u32 s72, s71, 95232
buffer_load_dwordx4 v7, s[20:23], s72 offen offset:3072 lds
s_mov_b32 s80, 0x0
buffer_load_dword v126, v125, s[16:19], s80 offen
buffer_load_dword v126, v125, s[20:23], s80 offen
buffer_load_dword v126, v124, s[8:11], 0 offen
s_and_b32 s73, s65, 1
s_xor_b32 s73, s73, 1
s_lshl_b32 s69, s73, 7
s_add_u32 s69, s69, s84
s_lshl_b32 s71, s73, 19
s_add_u32 s71, s71, s66
s_add_u32 m0, s63, 98304
s_add_u32 s72, s69, 0
buffer_load_dwordx4 v2, s[8:11], s72 offen lds
s_add_u32 s72, s69, 7168
buffer_load_dwordx4 v3, s[8:11], s72 offen offset:1024 lds
s_add_u32 s72, s69, 14336
buffer_load_dwordx4 v2, s[8:11], s72 offen offset:2048 lds
s_add_u32 s72, s69, 21504
buffer_load_dwordx4 v3, s[8:11], s72 offen offset:3072 lds
s_branch Lmain
.p2align 12
Lmain:
s_mov_b32 s6, 0x400000
s_mov_b32 s7, 0x20000
s_mov_b32 s14, 0x800000
s_mov_b32 s15, 0x20000
s_mov_b32 s26, 0x800000
s_mov_b32 s27, 0x20000
s_mov_b32 s30, 0x400000
s_mov_b32 s31, 0x20000
s_mov_b32 s34, 0x400000
s_mov_b32 s35, 0x20000
s_mov_b32 s38, 0x400000
s_mov_b32 s39, 0x20000
s_mov_b32 s42, 0x400000
s_mov_b32 s43, 0x20000
s_mov_b32 s46, 0x5800000
s_mov_b32 s47, 0x20000
s_mov_b32 s50, 0x100
s_mov_b32 s51, 0x20000
v_lshl_add_u32 v4, v28, 11, v27
v_xor_b32 v5, 64, v4
v_lshlrev_b32 v1, 4, v0
s_sub_u32 s74, 15, s60
s_lshl_b32 s68, s74, 18
s_lshl_b32 s76, s58, 15
s_add_u32 s68, s68, s76
s_add_u32 s67, s67, s76
s_and_b32 s62, s60, 3
s_sub_u32 s62, 16, s62
s_lshl_b32 s91, s59, 3
s_add_u32 s91, s91, s60
s_lshl_b32 s93, s91, 2
s_add_u32 s93, s93, s58
s_lshl_b32 s91, s91, 7
s_add_u32 s91, s91, 0x3810000
s_lshl_b32 s75, s93, 1
s_and_b32 s75, s75, 0xffc
s_lshl_b32 s93, s93, 12
s_load_dwordx2 s[88:89], s[36:37], s93
s_load_dword s90, s[54:55], s75
v_or_b32 v29, s58, v0
v_mov_b32 v30, 0
v_min_u32 v29, 1, v29
v_lshlrev_b32 v29, 30, v29
buffer_store_dword v30, v29, s[44:47], s91 offen sc1
s_xor_b32 s73, s2, 5
s_and_b32 s73, s73, 15
s_lshr_b32 s74, s2, 4
s_lshl_b32 s74, s74, 7
s_lshl_b32 s75, s58, 5
s_add_u32 s74, s74, s75
s_mov_b32 s75, 131072
v_lshrrev_b32 v29, 5, v0
v_lshlrev_b32 v29, 4, v29
v_add_u32 v29, s74, v29
v_and_b32 v30, 31, v0
s_lshl_b32 s73, s73, 5
v_add_u32 v30, s73, v30
v_lshlrev_b32 v26, 11, v29
v_lshl_add_u32 v26, v30, 2, v26
v_subrev_u32 v27, 0x1800, v26
s_lshl_b32 s82, s74, 11
s_lshl_b32 s73, s73, 2
s_add_u32 s82, s82, s73
v_lshrrev_b32 v26, 3, v0
v_and_b32 v32, 7, v0
v_lshlrev_b32 v32, 4, v32
v_lshl_add_u32 v26, v26, 11, v32
v_lshrrev_b32 v98, 5, v0
v_lshlrev_b32 v98, 11, v98
v_and_b32 v32, 31, v0
v_lshl_add_u32 v98, v32, 2, v98
v_add_u32 v98, s63, v98
v_add_u32 v98, s75, v98
v_and_b32 v29, 0x7f, v29
v_sub_u32 v29, 0x70, v29
v_lshlrev_b32 v29, 1, v29
v_and_b32 v32, 7, v0
v_mul_u32_u24 v32, 544, v32
v_add3_u32 v28, v32, v29, s75
v_bfe_u32 v32, v0, 3, 2
v_lshl_add_u32 v28, v32, 13, v28
v_lshlrev_b32 v30, 4, v30
s_lshl_b32 s73, s2, 14
s_lshl_b32 s74, s58, 12
s_add_u32 s76, s73, s74
v_and_b32 v29, 15, v0
v_lshrrev_b32 v32, 4, v0
v_lshrrev_b32 v24, 1, v29
v_xor_b32 v24, v24, v32
v_lshlrev_b32 v24, 4, v24
v_lshl_add_u32 v24, v29, 7, v24
s_add_u32 s73, s63, 131072
v_add_u32 v16, s73, v24
v_xor_b32 v17, 64, v16
v_subrev_u32 v18, 0x10000, v16
v_subrev_u32 v19, 0x10000, v17
s_lshr_b32 s73, s58, 1
s_lshl_b32 s74, s73, 14
s_add_u32 s74, s74, 0x10000
v_add_u32 v24, s74, v24
v_xor_b32 v25, 64, v24
v_lshrrev_b32 v8, 2, v29
v_and_b32 v9, 1, v32
v_lshl_add_u32 v9, v9, 2, v8
v_lshl_add_u32 v8, v32, 3, v8
v_lshlrev_b32 v8, 8, v8
v_lshl_add_u32 v8, v9, 5, v8
v_and_b32 v29, 3, v0
v_lshl_add_u32 v8, v29, 3, v8
s_and_b32 s74, s58, 1
s_lshl_b32 s75, s74, 7
v_xor_b32 v20, s75, v8
v_xor_b32 v9, 32, v8
v_xor_b32 v10, 64, v8
v_xor_b32 v11, 96, v8
v_xor_b32 v12, 128, v8
v_xor_b32 v13, 160, v8
v_xor_b32 v14, 192, v8
v_xor_b32 v15, 224, v8
v_xor_b32 v21, 32, v20
v_xor_b32 v22, 64, v20
v_xor_b32 v23, 96, v20
s_lshl_b32 s77, s59, 20
s_add_u32 s81, s77, s64
s_sub_u32 s81, s81, 0x4000
s_lshl_b32 s75, s60, 17
s_add_u32 s77, s77, s75
s_lshl_b32 s73, s73, 16
s_add_u32 s77, s77, s73
s_lshl_b32 s75, s74, 12
s_add_u32 s78, s77, s75
s_add_u32 s78, s78, 0x4000
s_lshl_b32 s75, s74, 11
s_add_u32 s77, s77, s75
s_mov_b32 s79, 0x3e0293ee
s_waitcnt vmcnt(8)
s_barrier
ds_read_b64_tr_b16 v[224:225], v20 offset:0
ds_read_b64_tr_b16 v[226:227], v20 offset:1024
ds_read_b64_tr_b16 v[228:229], v20 offset:8192
ds_read_b64_tr_b16 v[230:231], v20 offset:9216
ds_read_b128 v[128:131], v24 offset:0
ds_read_b128 v[132:135], v25 offset:0
ds_read_b128 v[136:139], v24 offset:2048
ds_read_b128 v[140:143], v25 offset:2048
ds_read_b128 v[144:147], v24 offset:4096
ds_read_b128 v[148:151], v25 offset:4096
ds_read_b128 v[152:155], v24 offset:6144
ds_read_b128 v[156:159], v25 offset:6144
ds_read_b128 v[160:163], v24 offset:8192
ds_read_b128 v[164:167], v25 offset:8192
ds_read_b128 v[168:171], v24 offset:10240
ds_read_b128 v[172:175], v25 offset:10240
ds_read_b128 v[176:179], v24 offset:12288
ds_read_b128 v[180:183], v25 offset:12288
ds_read_b128 v[184:187], v24 offset:14336
ds_read_b128 v[188:191], v25 offset:14336
ds_read_b64_tr_b16 v[232:233], v21 offset:0
ds_read_b64_tr_b16 v[234:235], v21 offset:1024
ds_read_b64_tr_b16 v[236:237], v21 offset:8192
ds_read_b64_tr_b16 v[238:239], v21 offset:9216
s_waitcnt lgkmcnt(0)
v_mfma_f32_16x16x32_bf16 a[0:3], v[224:227], v[128:131], 0
s_add_u32 m0, s64, 32768
ds_read_b64_tr_b16 v[240:241], v22 offset:0
v_mfma_f32_16x16x32_bf16 a[0:3], v[228:231], v[132:135], a[0:3]
s_add_u32 s72, s71, 0
buffer_load_dwordx4 v6, s[16:19], s72 offen lds
v_mfma_f32_16x16x32_bf16 a[4:7], v[228:231], v[140:143], 0
s_add_u32 s72, s71, 31744
buffer_load_dwordx4 v6, s[16:19], s72 offen offset:1024 lds
v_mfma_f32_16x16x32_bf16 a[4:7], v[224:227], v[136:139], a[4:7]
ds_read_b64_tr_b16 v[242:243], v22 offset:1024
v_mfma_f32_16x16x32_bf16 a[8:11], v[224:227], v[144:147], 0
s_add_u32 s72, s71, 63488
buffer_load_dwordx4 v7, s[16:19], s72 offen offset:2048 lds
v_mfma_f32_16x16x32_bf16 a[8:11], v[228:231], v[148:151], a[8:11]
v_mfma_f32_16x16x32_bf16 a[12:15], v[228:231], v[156:159], 0
s_add_u32 s72, s71, 95232
buffer_load_dwordx4 v7, s[16:19], s72 offen offset:3072 lds
v_mfma_f32_16x16x32_bf16 a[12:15], v[224:227], v[152:155], a[12:15]
ds_read_b64_tr_b16 v[244:245], v22 offset:8192
v_mfma_f32_16x16x32_bf16 a[16:19], v[224:227], v[160:163], 0
s_add_u32 m0, s63, 102400
v_mfma_f32_16x16x32_bf16 a[16:19], v[228:231], v[164:167], a[16:19]
s_add_u32 s72, s69, 32768
buffer_load_dwordx4 v2, s[8:11], s72 offen lds
v_mfma_f32_16x16x32_bf16 a[20:23], v[228:231], v[172:175], 0
s_add_u32 s72, s69, 39936
buffer_load_dwordx4 v3, s[8:11], s72 offen offset:1024 lds
v_mfma_f32_16x16x32_bf16 a[20:23], v[224:227], v[168:171], a[20:23]
ds_read_b64_tr_b16 v[246:247], v22 offset:9216
v_mfma_f32_16x16x32_bf16 a[24:27], v[224:227], v[176:179], 0
s_add_u32 s72, s69, 47104
buffer_load_dwordx4 v2, s[8:11], s72 offen offset:2048 lds
v_mfma_f32_16x16x32_bf16 a[24:27], v[228:231], v[180:183], a[24:27]
v_mfma_f32_16x16x32_bf16 a[28:31], v[228:231], v[188:191], 0
s_add_u32 s72, s69, 54272
buffer_load_dwordx4 v3, s[8:11], s72 offen offset:3072 lds
v_mfma_f32_16x16x32_bf16 a[28:31], v[224:227], v[184:187], a[28:31]
v_mfma_f32_16x16x32_bf16 a[60:63], v[232:235], v[184:187], 0
s_add_u32 m0, s64, 49152
ds_read_b64_tr_b16 v[248:249], v23 offset:0
v_mfma_f32_16x16x32_bf16 a[60:63], v[236:239], v[188:191], a[60:63]
s_add_u32 s72, s71, 0
buffer_load_dwordx4 v6, s[20:23], s72 offen lds
v_mfma_f32_16x16x32_bf16 a[56:59], v[236:239], v[180:183], 0
s_add_u32 s72, s71, 31744
buffer_load_dwordx4 v6, s[20:23], s72 offen offset:1024 lds
v_mfma_f32_16x16x32_bf16 a[56:59], v[232:235], v[176:179], a[56:59]
v_mfma_f32_16x16x32_bf16 a[52:55], v[232:235], v[168:171], 0
s_add_u32 s72, s71, 63488
buffer_load_dwordx4 v7, s[20:23], s72 offen offset:2048 lds
v_mfma_f32_16x16x32_bf16 a[52:55], v[236:239], v[172:175], a[52:55]
ds_read_b64_tr_b16 v[250:251], v23 offset:1024
v_mfma_f32_16x16x32_bf16 a[48:51], v[236:239], v[164:167], 0
s_add_u32 s72, s71, 95232
buffer_load_dwordx4 v7, s[20:23], s72 offen offset:3072 lds
v_mfma_f32_16x16x32_bf16 a[48:51], v[232:235], v[160:163], a[48:51]
s_mov_b32 s80, 0x100000
buffer_load_dword v126, v125, s[16:19], s80 offen
v_mfma_f32_16x16x32_bf16 a[44:47], v[232:235], v[152:155], 0
buffer_load_dword v126, v125, s[20:23], s80 offen
v_mfma_f32_16x16x32_bf16 a[44:47], v[236:239], v[156:159], a[44:47]
v_mfma_f32_16x16x32_bf16 a[40:43], v[236:239], v[148:151], 0
ds_read_b64_tr_b16 v[252:253], v23 offset:8192
v_mfma_f32_16x16x32_bf16 a[40:43], v[232:235], v[144:147], a[40:43]
v_mfma_f32_16x16x32_bf16 a[36:39], v[232:235], v[136:139], 0
ds_read_b64_tr_b16 v[254:255], v23 offset:9216
v_mfma_f32_16x16x32_bf16 a[36:39], v[236:239], v[140:143], a[36:39]
v_mfma_f32_16x16x32_bf16 a[32:35], v[236:239], v[132:135], 0
v_mfma_f32_16x16x32_bf16 a[32:35], v[232:235], v[128:131], a[32:35]
s_waitcnt lgkmcnt(4)
v_mfma_f32_16x16x32_bf16 a[64:67], v[240:243], v[128:131], 0
ds_read_b64_tr_b16 v[224:225], v20 offset:16384
v_mfma_f32_16x16x32_bf16 a[64:67], v[244:247], v[132:135], a[64:67]
v_mfma_f32_16x16x32_bf16 a[68:71], v[244:247], v[140:143], 0
v_mfma_f32_16x16x32_bf16 a[68:71], v[240:243], v[136:139], a[68:71]
ds_read_b64_tr_b16 v[226:227], v20 offset:17408
v_mfma_f32_16x16x32_bf16 a[72:75], v[240:243], v[144:147], 0
v_mfma_f32_16x16x32_bf16 a[72:75], v[244:247], v[148:151], a[72:75]
v_mfma_f32_16x16x32_bf16 a[76:79], v[244:247], v[156:159], 0
v_mfma_f32_16x16x32_bf16 a[76:79], v[240:243], v[152:155], a[76:79]
ds_read_b64_tr_b16 v[228:229], v20 offset:24576
v_mfma_f32_16x16x32_bf16 a[80:83], v[240:243], v[160:163], 0
v_mfma_f32_16x16x32_bf16 a[80:83], v[244:247], v[164:167], a[80:83]
v_mfma_f32_16x16x32_bf16 a[84:87], v[244:247], v[172:175], 0
ds_read_b64_tr_b16 v[230:231], v20 offset:25600
v_mfma_f32_16x16x32_bf16 a[84:87], v[240:243], v[168:171], a[84:87]
v_mfma_f32_16x16x32_bf16 a[88:91], v[240:243], v[176:179], 0
v_mfma_f32_16x16x32_bf16 a[88:91], v[244:247], v[180:183], a[88:91]
v_mfma_f32_16x16x32_bf16 a[92:95], v[244:247], v[188:191], 0
v_mfma_f32_16x16x32_bf16 a[92:95], v[240:243], v[184:187], a[92:95]
s_waitcnt lgkmcnt(4)
v_mfma_f32_16x16x32_bf16 a[124:127], v[248:251], v[184:187], 0
ds_read_b64_tr_b16 v[232:233], v21 offset:16384
v_mfma_f32_16x16x32_bf16 a[124:127], v[252:255], v[188:191], a[124:127]
v_mfma_f32_16x16x32_bf16 a[120:123], v[252:255], v[180:183], 0
v_mfma_f32_16x16x32_bf16 a[120:123], v[248:251], v[176:179], a[120:123]
ds_read_b64_tr_b16 v[234:235], v21 offset:17408
v_mfma_f32_16x16x32_bf16 a[116:119], v[248:251], v[168:171], 0
v_mfma_f32_16x16x32_bf16 a[116:119], v[252:255], v[172:175], a[116:119]
v_mfma_f32_16x16x32_bf16 a[112:115], v[252:255], v[164:167], 0
v_mfma_f32_16x16x32_bf16 a[112:115], v[248:251], v[160:163], a[112:115]
ds_read_b64_tr_b16 v[236:237], v21 offset:24576
v_mfma_f32_16x16x32_bf16 a[108:111], v[248:251], v[152:155], 0
v_mfma_f32_16x16x32_bf16 a[108:111], v[252:255], v[156:159], a[108:111]
v_mfma_f32_16x16x32_bf16 a[104:107], v[252:255], v[148:151], 0
ds_read_b64_tr_b16 v[238:239], v21 offset:25600
v_mfma_f32_16x16x32_bf16 a[104:107], v[248:251], v[144:147], a[104:107]
v_mfma_f32_16x16x32_bf16 a[100:103], v[248:251], v[136:139], 0
v_mfma_f32_16x16x32_bf16 a[100:103], v[252:255], v[140:143], a[100:103]
v_mfma_f32_16x16x32_bf16 a[96:99], v[252:255], v[132:135], 0
v_mfma_f32_16x16x32_bf16 a[96:99], v[248:251], v[128:131], a[96:99]
s_waitcnt lgkmcnt(4)
v_mfma_f32_16x16x32_bf16 a[128:131], v[128:131], v[224:227], 0
ds_read_b64_tr_b16 v[240:241], v22 offset:16384
v_mfma_f32_16x16x32_bf16 a[128:131], v[132:135], v[228:231], a[128:131]
v_mfma_f32_16x16x32_bf16 a[132:135], v[140:143], v[228:231], 0
v_mfma_f32_16x16x32_bf16 a[132:135], v[136:139], v[224:227], a[132:135]
ds_read_b64_tr_b16 v[242:243], v22 offset:17408
v_mfma_f32_16x16x32_bf16 a[136:139], v[144:147], v[224:227], 0
v_mfma_f32_16x16x32_bf16 a[136:139], v[148:151], v[228:231], a[136:139]
v_mfma_f32_16x16x32_bf16 a[140:143], v[156:159], v[228:231], 0
v_mfma_f32_16x16x32_bf16 a[140:143], v[152:155], v[224:227], a[140:143]
ds_read_b64_tr_b16 v[244:245], v22 offset:24576
v_mfma_f32_16x16x32_bf16 a[144:147], v[160:163], v[224:227], 0
v_mfma_f32_16x16x32_bf16 a[144:147], v[164:167], v[228:231], a[144:147]
v_mfma_f32_16x16x32_bf16 a[148:151], v[172:175], v[228:231], 0
ds_read_b64_tr_b16 v[246:247], v22 offset:25600
v_mfma_f32_16x16x32_bf16 a[148:151], v[168:171], v[224:227], a[148:151]
v_mfma_f32_16x16x32_bf16 a[152:155], v[176:179], v[224:227], 0
v_mfma_f32_16x16x32_bf16 a[152:155], v[180:183], v[228:231], a[152:155]
v_mfma_f32_16x16x32_bf16 a[156:159], v[188:191], v[228:231], 0
v_mfma_f32_16x16x32_bf16 a[156:159], v[184:187], v[224:227], a[156:159]
s_waitcnt lgkmcnt(4)
v_mfma_f32_16x16x32_bf16 a[188:191], v[184:187], v[232:235], 0
ds_read_b64_tr_b16 v[248:249], v23 offset:16384
v_mfma_f32_16x16x32_bf16 a[188:191], v[188:191], v[236:239], a[188:191]
v_mfma_f32_16x16x32_bf16 a[184:187], v[180:183], v[236:239], 0
ds_read_b64_tr_b16 v[250:251], v23 offset:17408
v_mfma_f32_16x16x32_bf16 a[184:187], v[176:179], v[232:235], a[184:187]
v_mfma_f32_16x16x32_bf16 a[180:183], v[168:171], v[232:235], 0
ds_read_b64_tr_b16 v[252:253], v23 offset:24576
v_mfma_f32_16x16x32_bf16 a[180:183], v[172:175], v[236:239], a[180:183]
v_mfma_f32_16x16x32_bf16 a[176:179], v[164:167], v[236:239], 0
ds_read_b64_tr_b16 v[254:255], v23 offset:25600
v_mfma_f32_16x16x32_bf16 a[176:179], v[160:163], v[232:235], a[176:179]
v_mfma_f32_16x16x32_bf16 a[172:175], v[152:155], v[232:235], 0
v_mfma_f32_16x16x32_bf16 a[172:175], v[156:159], v[236:239], a[172:175]
v_mfma_f32_16x16x32_bf16 a[168:171], v[148:151], v[236:239], 0
v_mfma_f32_16x16x32_bf16 a[168:171], v[144:147], v[232:235], a[168:171]
v_mfma_f32_16x16x32_bf16 a[164:167], v[136:139], v[232:235], 0
v_mfma_f32_16x16x32_bf16 a[164:167], v[140:143], v[236:239], a[164:167]
v_mfma_f32_16x16x32_bf16 a[160:163], v[132:135], v[236:239], 0
s_waitcnt vmcnt(2) lgkmcnt(0)
v_mfma_f32_16x16x32_bf16 a[160:163], v[128:131], v[232:235], a[160:163]
s_barrier
v_mfma_f32_16x16x32_bf16 a[192:195], v[128:131], v[240:243], 0
s_and_b32 s73, s65, 1
ds_read_b64_tr_b16 v[224:225], v20 offset:32768
v_mfma_f32_16x16x32_bf16 a[192:195], v[132:135], v[244:247], a[192:195]
s_xor_b32 s73, s73, 2
ds_read_b64_tr_b16 v[226:227], v20 offset:33792
v_mfma_f32_16x16x32_bf16 a[196:199], v[140:143], v[244:247], 0
s_lshl_b32 s69, s73, 7
ds_read_b64_tr_b16 v[228:229], v20 offset:40960
v_mfma_f32_16x16x32_bf16 a[196:199], v[136:139], v[240:243], a[196:199]
s_add_u32 s69, s69, s84
ds_read_b64_tr_b16 v[230:231], v20 offset:41984
v_mfma_f32_16x16x32_bf16 a[200:203], v[144:147], v[240:243], 0
s_lshl_b32 s71, s73, 19
ds_read_b128 v[192:195], v24 offset:32768
v_mfma_f32_16x16x32_bf16 a[200:203], v[148:151], v[244:247], a[200:203]
s_add_u32 s71, s71, s66
ds_read_b128 v[196:199], v25 offset:32768
v_mfma_f32_16x16x32_bf16 a[204:207], v[156:159], v[244:247], 0
s_add_u32 m0, s63, 65536
v_mfma_f32_16x16x32_bf16 a[204:207], v[152:155], v[240:243], a[204:207]
s_add_u32 s72, s69, 0
buffer_load_dwordx4 v2, s[8:11], s72 offen lds
v_mfma_f32_16x16x32_bf16 a[208:211], v[160:163], v[240:243], 0
s_add_u32 s72, s69, 7168
buffer_load_dwordx4 v3, s[8:11], s72 offen offset:1024 lds
v_mfma_f32_16x16x32_bf16 a[208:211], v[164:167], v[244:247], a[208:211]
s_add_u32 s72, s69, 14336
buffer_load_dwordx4 v2, s[8:11], s72 offen offset:2048 lds
v_mfma_f32_16x16x32_bf16 a[212:215], v[172:175], v[244:247], 0
ds_read_b128 v[200:203], v24 offset:34816
v_mfma_f32_16x16x32_bf16 a[212:215], v[168:171], v[240:243], a[212:215]
ds_read_b128 v[204:207], v25 offset:34816
v_mfma_f32_16x16x32_bf16 a[216:219], v[176:179], v[240:243], 0
s_add_u32 s72, s69, 21504
buffer_load_dwordx4 v3, s[8:11], s72 offen offset:3072 lds
v_mfma_f32_16x16x32_bf16 a[216:219], v[180:183], v[244:247], a[216:219]
ds_read_b128 v[208:211], v24 offset:36864
v_mfma_f32_16x16x32_bf16 a[220:223], v[188:191], v[244:247], 0
ds_read_b128 v[212:215], v25 offset:36864
v_mfma_f32_16x16x32_bf16 a[220:223], v[184:187], v[240:243], a[220:223]
ds_read_b128 v[216:219], v24 offset:38912
v_mfma_f32_16x16x32_bf16 a[252:255], v[184:187], v[248:251], 0
ds_read_b128 v[220:223], v25 offset:38912
v_mfma_f32_16x16x32_bf16 a[252:255], v[188:191], v[252:255], a[252:255]
s_add_u32 m0, s64, 0
v_mfma_f32_16x16x32_bf16 a[248:251], v[180:183], v[252:255], 0
s_add_u32 s72, s71, 0
buffer_load_dwordx4 v6, s[16:19], s72 offen lds
v_mfma_f32_16x16x32_bf16 a[248:251], v[176:179], v[248:251], a[248:251]
ds_read_b128 v[184:187], v24 offset:40960
v_mfma_f32_16x16x32_bf16 a[244:247], v[168:171], v[248:251], 0
ds_read_b128 v[188:191], v25 offset:40960
v_mfma_f32_16x16x32_bf16 a[244:247], v[172:175], v[252:255], a[244:247]
s_add_u32 s72, s71, 31744
buffer_load_dwordx4 v6, s[16:19], s72 offen offset:1024 lds
v_mfma_f32_16x16x32_bf16 a[240:243], v[164:167], v[252:255], 0
ds_read_b128 v[176:179], v24 offset:43008
v_mfma_f32_16x16x32_bf16 a[240:243], v[160:163], v[248:251], a[240:243]
ds_read_b128 v[180:183], v25 offset:43008
v_mfma_f32_16x16x32_bf16 a[236:239], v[152:155], v[248:251], 0
ds_read_b128 v[168:171], v24 offset:45056
v_mfma_f32_16x16x32_bf16 a[236:239], v[156:159], v[252:255], a[236:239]
s_add_u32 s72, s71, 63488
buffer_load_dwordx4 v7, s[16:19], s72 offen offset:2048 lds
v_mfma_f32_16x16x32_bf16 a[232:235], v[148:151], v[252:255], 0
ds_read_b128 v[172:175], v25 offset:45056
v_mfma_f32_16x16x32_bf16 a[232:235], v[144:147], v[248:251], a[232:235]
ds_read_b128 v[160:163], v24 offset:47104
v_mfma_f32_16x16x32_bf16 a[228:231], v[136:139], v[248:251], 0
ds_read_b128 v[164:167], v25 offset:47104
v_mfma_f32_16x16x32_bf16 a[228:231], v[140:143], v[252:255], a[228:231]
v_mfma_f32_16x16x32_bf16 a[224:227], v[132:135], v[252:255], 0
s_add_u32 s72, s71, 95232
buffer_load_dwordx4 v7, s[16:19], s72 offen offset:3072 lds
v_mfma_f32_16x16x32_bf16 a[224:227], v[128:131], v[248:251], a[224:227]
s_waitcnt lgkmcnt(8)
ds_read_b64_tr_b16 v[232:233], v21 offset:32768
v_mfma_f32_16x16x32_bf16 a[0:3], v[224:227], v[192:195], a[0:3]
ds_read_b64_tr_b16 v[234:235], v21 offset:33792
v_mfma_f32_16x16x32_bf16 a[0:3], v[228:231], v[196:199], a[0:3]
ds_read_b64_tr_b16 v[240:241], v22 offset:32768
v_mfma_f32_16x16x32_bf16 a[4:7], v[228:231], v[204:207], a[4:7]
s_add_u32 m0, s63, 69632
ds_read_b64_tr_b16 v[236:237], v21 offset:40960
v_mfma_f32_16x16x32_bf16 a[4:7], v[224:227], v[200:203], a[4:7]
s_add_u32 s72, s69, 32768
buffer_load_dwordx4 v2, s[8:11], s72 offen lds
v_mfma_f32_16x16x32_bf16 a[8:11], v[224:227], v[208:211], a[8:11]
ds_read_b64_tr_b16 v[238:239], v21 offset:41984
v_mfma_f32_16x16x32_bf16 a[8:11], v[228:231], v[212:215], a[8:11]
v_mfma_f32_16x16x32_bf16 a[12:15], v[228:231], v[220:223], a[12:15]
s_add_u32 s72, s69, 39936
buffer_load_dwordx4 v3, s[8:11], s72 offen offset:1024 lds
v_mfma_f32_16x16x32_bf16 a[12:15], v[224:227], v[216:219], a[12:15]
s_waitcnt lgkmcnt(5)
ds_read_b64_tr_b16 v[242:243], v22 offset:33792
v_mfma_f32_16x16x32_bf16 a[16:19], v[224:227], v[184:187], a[16:19]
v_mfma_f32_16x16x32_bf16 a[16:19], v[228:231], v[188:191], a[16:19]
ds_read_b64_tr_b16 v[244:245], v22 offset:40960
v_mfma_f32_16x16x32_bf16 a[20:23], v[228:231], v[180:183], a[20:23]
v_mfma_f32_16x16x32_bf16 a[20:23], v[224:227], v[176:179], a[20:23]
s_add_u32 s72, s69, 47104
buffer_load_dwordx4 v2, s[8:11], s72 offen offset:2048 lds
v_mfma_f32_16x16x32_bf16 a[24:27], v[224:227], v[168:171], a[24:27]
ds_read_b64_tr_b16 v[246:247], v22 offset:41984
v_mfma_f32_16x16x32_bf16 a[24:27], v[228:231], v[172:175], a[24:27]
v_mfma_f32_16x16x32_bf16 a[28:31], v[228:231], v[164:167], a[28:31]
v_mfma_f32_16x16x32_bf16 a[28:31], v[224:227], v[160:163], a[28:31]
s_waitcnt lgkmcnt(3)
v_mfma_f32_16x16x32_bf16 a[60:63], v[232:235], v[160:163], a[60:63]
s_add_u32 s72, s69, 54272
buffer_load_dwordx4 v3, s[8:11], s72 offen offset:3072 lds
v_mfma_f32_16x16x32_bf16 a[60:63], v[236:239], v[164:167], a[60:63]
ds_read_b64_tr_b16 v[248:249], v23 offset:32768
v_mfma_f32_16x16x32_bf16 a[56:59], v[236:239], v[172:175], a[56:59]
v_mfma_f32_16x16x32_bf16 a[56:59], v[232:235], v[168:171], a[56:59]
s_add_u32 m0, s64, 16384
ds_read_b64_tr_b16 v[250:251], v23 offset:33792
v_mfma_f32_16x16x32_bf16 a[52:55], v[232:235], v[176:179], a[52:55]
s_add_u32 s72, s71, 0
buffer_load_dwordx4 v6, s[20:23], s72 offen lds
v_mfma_f32_16x16x32_bf16 a[52:55], v[236:239], v[180:183], a[52:55]
v_mfma_f32_16x16x32_bf16 a[48:51], v[236:239], v[188:191], a[48:51]
v_mfma_f32_16x16x32_bf16 a[48:51], v[232:235], v[184:187], a[48:51]
ds_read_b64_tr_b16 v[252:253], v23 offset:40960
v_mfma_f32_16x16x32_bf16 a[44:47], v[232:235], v[216:219], a[44:47]
s_add_u32 s72, s71, 31744
buffer_load_dwordx4 v6, s[20:23], s72 offen offset:1024 lds
v_mfma_f32_16x16x32_bf16 a[44:47], v[236:239], v[220:223], a[44:47]
v_mfma_f32_16x16x32_bf16 a[40:43], v[236:239], v[212:215], a[40:43]
ds_read_b64_tr_b16 v[254:255], v23 offset:41984
v_mfma_f32_16x16x32_bf16 a[40:43], v[232:235], v[208:211], a[40:43]
v_mfma_f32_16x16x32_bf16 a[36:39], v[232:235], v[200:203], a[36:39]
s_add_u32 s72, s71, 63488
buffer_load_dwordx4 v7, s[20:23], s72 offen offset:2048 lds
v_mfma_f32_16x16x32_bf16 a[36:39], v[236:239], v[204:207], a[36:39]
v_mfma_f32_16x16x32_bf16 a[32:35], v[236:239], v[196:199], a[32:35]
v_mfma_f32_16x16x32_bf16 a[32:35], v[232:235], v[192:195], a[32:35]
s_waitcnt lgkmcnt(4)
v_mfma_f32_16x16x32_bf16 a[64:67], v[240:243], v[192:195], a[64:67]
s_add_u32 s72, s71, 95232
buffer_load_dwordx4 v7, s[20:23], s72 offen offset:3072 lds
v_mfma_f32_16x16x32_bf16 a[64:67], v[244:247], v[196:199], a[64:67]
s_mov_b32 s80, 0x200000
buffer_load_dword v126, v125, s[16:19], s80 offen
v_mfma_f32_16x16x32_bf16 a[68:71], v[244:247], v[204:207], a[68:71]
buffer_load_dword v126, v125, s[20:23], s80 offen
v_mfma_f32_16x16x32_bf16 a[68:71], v[240:243], v[200:203], a[68:71]
global_load_dwordx4 v[68:71], v30, s[52:53]
v_mfma_f32_16x16x32_bf16 a[72:75], v[240:243], v[208:211], a[72:75]
buffer_load_dword v33, v27, s[28:31], 0 offen nt
v_mfma_f32_16x16x32_bf16 a[72:75], v[244:247], v[212:215], a[72:75]
buffer_load_dword v34, v27, s[28:31], 0 offen offset:2048 nt
v_mfma_f32_16x16x32_bf16 a[76:79], v[244:247], v[220:223], a[76:79]
v_add_u32 v27, 0x1000, v27
v_mfma_f32_16x16x32_bf16 a[76:79], v[240:243], v[216:219], a[76:79]
buffer_load_dword v35, v27, s[28:31], 0 offen nt
v_mfma_f32_16x16x32_bf16 a[80:83], v[240:243], v[184:187], a[80:83]
s_add_u32 m0, s63, 131072
ds_read_b64_tr_b16 v[224:225], v20 offset:49152
ds_read_b64_tr_b16 v[226:227], v20 offset:50176
v_mfma_f32_16x16x32_bf16 a[80:83], v[244:247], v[188:191], a[80:83]
s_add_u32 s80, s82, 0
buffer_load_dwordx4 v26, s[28:31], s80 offen nt lds
v_mfma_f32_16x16x32_bf16 a[84:87], v[244:247], v[180:183], a[84:87]
s_add_u32 s80, s82, 15360
buffer_load_dwordx4 v26, s[28:31], s80 offen offset:1024 nt lds
v_mfma_f32_16x16x32_bf16 a[84:87], v[240:243], v[176:179], a[84:87]
s_add_u32 s80, s82, 30720
buffer_load_dwordx4 v26, s[28:31], s80 offen offset:2048 nt lds
v_mfma_f32_16x16x32_bf16 a[88:91], v[240:243], v[168:171], a[88:91]
s_add_u32 s80, s82, 46080
buffer_load_dwordx4 v26, s[28:31], s80 offen offset:3072 nt lds
v_mfma_f32_16x16x32_bf16 a[88:91], v[244:247], v[172:175], a[88:91]
ds_read_b64_tr_b16 v[228:229], v20 offset:57344
ds_read_b64_tr_b16 v[230:231], v20 offset:58368
v_mfma_f32_16x16x32_bf16 a[92:95], v[244:247], v[164:167], a[92:95]
v_mfma_f32_16x16x32_bf16 a[92:95], v[240:243], v[160:163], a[92:95]
s_waitcnt lgkmcnt(4)
v_mfma_f32_16x16x32_bf16 a[124:127], v[248:251], v[160:163], a[124:127]
ds_read_b64_tr_b16 v[232:233], v21 offset:49152
v_mfma_f32_16x16x32_bf16 a[124:127], v[252:255], v[164:167], a[124:127]
v_mfma_f32_16x16x32_bf16 a[120:123], v[252:255], v[172:175], a[120:123]
v_mfma_f32_16x16x32_bf16 a[120:123], v[248:251], v[168:171], a[120:123]
ds_read_b64_tr_b16 v[234:235], v21 offset:50176
v_mfma_f32_16x16x32_bf16 a[116:119], v[248:251], v[176:179], a[116:119]
v_mfma_f32_16x16x32_bf16 a[116:119], v[252:255], v[180:183], a[116:119]
v_mfma_f32_16x16x32_bf16 a[112:115], v[252:255], v[188:191], a[112:115]
v_mfma_f32_16x16x32_bf16 a[112:115], v[248:251], v[184:187], a[112:115]
ds_read_b64_tr_b16 v[236:237], v21 offset:57344
v_mfma_f32_16x16x32_bf16 a[108:111], v[248:251], v[216:219], a[108:111]
v_mfma_f32_16x16x32_bf16 a[108:111], v[252:255], v[220:223], a[108:111]
v_mfma_f32_16x16x32_bf16 a[104:107], v[252:255], v[212:215], a[104:107]
ds_read_b64_tr_b16 v[238:239], v21 offset:58368
v_mfma_f32_16x16x32_bf16 a[104:107], v[248:251], v[208:211], a[104:107]
v_mfma_f32_16x16x32_bf16 a[100:103], v[248:251], v[200:203], a[100:103]
v_mfma_f32_16x16x32_bf16 a[100:103], v[252:255], v[204:207], a[100:103]
v_mfma_f32_16x16x32_bf16 a[96:99], v[252:255], v[196:199], a[96:99]
v_mfma_f32_16x16x32_bf16 a[96:99], v[248:251], v[192:195], a[96:99]
s_waitcnt lgkmcnt(4)
v_mfma_f32_16x16x32_bf16 a[128:131], v[192:195], v[224:227], a[128:131]
ds_read_b64_tr_b16 v[240:241], v22 offset:49152
v_mfma_f32_16x16x32_bf16 a[128:131], v[196:199], v[228:231], a[128:131]
v_mfma_f32_16x16x32_bf16 a[132:135], v[204:207], v[228:231], a[132:135]
v_mfma_f32_16x16x32_bf16 a[132:135], v[200:203], v[224:227], a[132:135]
ds_read_b64_tr_b16 v[242:243], v22 offset:50176
v_mfma_f32_16x16x32_bf16 a[136:139], v[208:211], v[224:227], a[136:139]
v_mfma_f32_16x16x32_bf16 a[136:139], v[212:215], v[228:231], a[136:139]
v_mfma_f32_16x16x32_bf16 a[140:143], v[220:223], v[228:231], a[140:143]
v_mfma_f32_16x16x32_bf16 a[140:143], v[216:219], v[224:227], a[140:143]
ds_read_b64_tr_b16 v[244:245], v22 offset:57344
v_mfma_f32_16x16x32_bf16 a[144:147], v[184:187], v[224:227], a[144:147]
v_mfma_f32_16x16x32_bf16 a[144:147], v[188:191], v[228:231], a[144:147]
v_mfma_f32_16x16x32_bf16 a[148:151], v[180:183], v[228:231], a[148:151]
ds_read_b64_tr_b16 v[246:247], v22 offset:58368
v_mfma_f32_16x16x32_bf16 a[148:151], v[176:179], v[224:227], a[148:151]
v_mfma_f32_16x16x32_bf16 a[152:155], v[168:171], v[224:227], a[152:155]
v_mfma_f32_16x16x32_bf16 a[152:155], v[172:175], v[228:231], a[152:155]
v_mfma_f32_16x16x32_bf16 a[156:159], v[164:167], v[228:231], a[156:159]
v_mfma_f32_16x16x32_bf16 a[156:159], v[160:163], v[224:227], a[156:159]
s_waitcnt lgkmcnt(4)
v_mfma_f32_16x16x32_bf16 a[188:191], v[160:163], v[232:235], a[188:191]
ds_read_b64_tr_b16 v[248:249], v23 offset:49152
v_mfma_f32_16x16x32_bf16 a[188:191], v[164:167], v[236:239], a[188:191]
v_mfma_f32_16x16x32_bf16 a[184:187], v[172:175], v[236:239], a[184:187]
ds_read_b64_tr_b16 v[250:251], v23 offset:50176
v_mfma_f32_16x16x32_bf16 a[184:187], v[168:171], v[232:235], a[184:187]
v_mfma_f32_16x16x32_bf16 a[180:183], v[176:179], v[232:235], a[180:183]
ds_read_b64_tr_b16 v[252:253], v23 offset:57344
v_mfma_f32_16x16x32_bf16 a[180:183], v[180:183], v[236:239], a[180:183]
v_mfma_f32_16x16x32_bf16 a[176:179], v[188:191], v[236:239], a[176:179]
ds_read_b64_tr_b16 v[254:255], v23 offset:58368
v_mfma_f32_16x16x32_bf16 a[176:179], v[184:187], v[232:235], a[176:179]
v_mfma_f32_16x16x32_bf16 a[172:175], v[216:219], v[232:235], a[172:175]
v_mfma_f32_16x16x32_bf16 a[172:175], v[220:223], v[236:239], a[172:175]
v_mfma_f32_16x16x32_bf16 a[168:171], v[212:215], v[236:239], a[168:171]
v_mfma_f32_16x16x32_bf16 a[168:171], v[208:211], v[232:235], a[168:171]
v_mfma_f32_16x16x32_bf16 a[164:167], v[200:203], v[232:235], a[164:167]
v_mfma_f32_16x16x32_bf16 a[164:167], v[204:207], v[236:239], a[164:167]
v_mfma_f32_16x16x32_bf16 a[160:163], v[196:199], v[236:239], a[160:163]
s_waitcnt vmcnt(10) lgkmcnt(0)
v_mfma_f32_16x16x32_bf16 a[160:163], v[192:195], v[232:235], a[160:163]
s_barrier
v_mfma_f32_16x16x32_bf16 a[192:195], v[192:195], v[240:243], a[192:195]
s_and_b32 s73, s65, 1
ds_read_b64_tr_b16 v[224:225], v20 offset:0
v_mfma_f32_16x16x32_bf16 a[192:195], v[196:199], v[244:247], a[192:195]
s_xor_b32 s73, s73, 3
ds_read_b64_tr_b16 v[226:227], v20 offset:1024
v_mfma_f32_16x16x32_bf16 a[196:199], v[204:207], v[244:247], a[196:199]
s_lshl_b32 s69, s73, 7
ds_read_b64_tr_b16 v[228:229], v20 offset:8192
v_mfma_f32_16x16x32_bf16 a[196:199], v[200:203], v[240:243], a[196:199]
s_add_u32 s69, s69, s84
ds_read_b64_tr_b16 v[230:231], v20 offset:9216
v_mfma_f32_16x16x32_bf16 a[200:203], v[208:211], v[240:243], a[200:203]
s_lshl_b32 s71, s73, 19
ds_read_b128 v[128:131], v24 offset:0
v_mfma_f32_16x16x32_bf16 a[200:203], v[212:215], v[244:247], a[200:203]
s_add_u32 s71, s71, s66
ds_read_b128 v[132:135], v25 offset:0
v_mfma_f32_16x16x32_bf16 a[204:207], v[220:223], v[244:247], a[204:207]
s_add_u32 m0, s63, 98304
v_mfma_f32_16x16x32_bf16 a[204:207], v[216:219], v[240:243], a[204:207]
s_add_u32 s72, s69, 0
buffer_load_dwordx4 v2, s[8:11], s72 offen lds
v_mfma_f32_16x16x32_bf16 a[208:211], v[184:187], v[240:243], a[208:211]
s_add_u32 s72, s69, 7168
buffer_load_dwordx4 v3, s[8:11], s72 offen offset:1024 lds
v_mfma_f32_16x16x32_bf16 a[208:211], v[188:191], v[244:247], a[208:211]
s_add_u32 s72, s69, 14336
buffer_load_dwordx4 v2, s[8:11], s72 offen offset:2048 lds
v_mfma_f32_16x16x32_bf16 a[212:215], v[180:183], v[244:247], a[212:215]
ds_read_b128 v[136:139], v24 offset:2048
v_mfma_f32_16x16x32_bf16 a[212:215], v[176:179], v[240:243], a[212:215]
ds_read_b128 v[140:143], v25 offset:2048
v_mfma_f32_16x16x32_bf16 a[216:219], v[168:171], v[240:243], a[216:219]
s_add_u32 s72, s69, 21504
buffer_load_dwordx4 v3, s[8:11], s72 offen offset:3072 lds
v_mfma_f32_16x16x32_bf16 a[216:219], v[172:175], v[244:247], a[216:219]
ds_read_b128 v[144:147], v24 offset:4096
v_mfma_f32_16x16x32_bf16 a[220:223], v[164:167], v[244:247], a[220:223]
ds_read_b128 v[148:151], v25 offset:4096
v_mfma_f32_16x16x32_bf16 a[220:223], v[160:163], v[240:243], a[220:223]
ds_read_b128 v[152:155], v24 offset:6144
v_mfma_f32_16x16x32_bf16 a[252:255], v[160:163], v[248:251], a[252:255]
ds_read_b128 v[156:159], v25 offset:6144
v_mfma_f32_16x16x32_bf16 a[252:255], v[164:167], v[252:255], a[252:255]
s_add_u32 m0, s64, 32768
v_mfma_f32_16x16x32_bf16 a[248:251], v[172:175], v[252:255], a[248:251]
s_add_u32 s72, s71, 0
buffer_load_dwordx4 v6, s[16:19], s72 offen lds
v_mfma_f32_16x16x32_bf16 a[248:251], v[168:171], v[248:251], a[248:251]
ds_read_b128 v[160:163], v24 offset:8192
v_mfma_f32_16x16x32_bf16 a[244:247], v[176:179], v[248:251], a[244:247]
ds_read_b128 v[164:167], v25 offset:8192
v_mfma_f32_16x16x32_bf16 a[244:247], v[180:183], v[252:255], a[244:247]
s_add_u32 s72, s71, 31744
buffer_load_dwordx4 v6, s[16:19], s72 offen offset:1024 lds
v_mfma_f32_16x16x32_bf16 a[240:243], v[188:191], v[252:255], a[240:243]
ds_read_b128 v[168:171], v24 offset:10240
v_mfma_f32_16x16x32_bf16 a[240:243], v[184:187], v[248:251], a[240:243]
ds_read_b128 v[172:175], v25 offset:10240
v_mfma_f32_16x16x32_bf16 a[236:239], v[216:219], v[248:251], a[236:239]
ds_read_b128 v[176:179], v24 offset:12288
v_mfma_f32_16x16x32_bf16 a[236:239], v[220:223], v[252:255], a[236:239]
s_add_u32 s72, s71, 63488
buffer_load_dwordx4 v7, s[16:19], s72 offen offset:2048 lds
v_mfma_f32_16x16x32_bf16 a[232:235], v[212:215], v[252:255], a[232:235]
ds_read_b128 v[180:183], v25 offset:12288
v_mfma_f32_16x16x32_bf16 a[232:235], v[208:211], v[248:251], a[232:235]
ds_read_b128 v[184:187], v24 offset:14336
v_mfma_f32_16x16x32_bf16 a[228:231], v[200:203], v[248:251], a[228:231]
ds_read_b128 v[188:191], v25 offset:14336
v_mfma_f32_16x16x32_bf16 a[228:231], v[204:207], v[252:255], a[228:231]
v_mfma_f32_16x16x32_bf16 a[224:227], v[196:199], v[252:255], a[224:227]
s_add_u32 s72, s71, 95232
buffer_load_dwordx4 v7, s[16:19], s72 offen offset:3072 lds
v_mfma_f32_16x16x32_bf16 a[224:227], v[192:195], v[248:251], a[224:227]
s_waitcnt lgkmcnt(8)
ds_read_b64_tr_b16 v[232:233], v21 offset:0
v_mfma_f32_16x16x32_bf16 a[0:3], v[224:227], v[128:131], a[0:3]
ds_read_b64_tr_b16 v[234:235], v21 offset:1024
v_mfma_f32_16x16x32_bf16 a[0:3], v[228:231], v[132:135], a[0:3]
ds_read_b64_tr_b16 v[240:241], v22 offset:0
v_mfma_f32_16x16x32_bf16 a[4:7], v[228:231], v[140:143], a[4:7]
s_add_u32 m0, s63, 102400
ds_read_b64_tr_b16 v[236:237], v21 offset:8192
v_mfma_f32_16x16x32_bf16 a[4:7], v[224:227], v[136:139], a[4:7]
s_add_u32 s72, s69, 32768
buffer_load_dwordx4 v2, s[8:11], s72 offen lds
v_mfma_f32_16x16x32_bf16 a[8:11], v[224:227], v[144:147], a[8:11]
ds_read_b64_tr_b16 v[238:239], v21 offset:9216
v_mfma_f32_16x16x32_bf16 a[8:11], v[228:231], v[148:151], a[8:11]
v_mfma_f32_16x16x32_bf16 a[12:15], v[228:231], v[156:159], a[12:15]
s_add_u32 s72, s69, 39936
buffer_load_dwordx4 v3, s[8:11], s72 offen offset:1024 lds
v_mfma_f32_16x16x32_bf16 a[12:15], v[224:227], v[152:155], a[12:15]
s_waitcnt lgkmcnt(5)
ds_read_b64_tr_b16 v[242:243], v22 offset:1024
v_mfma_f32_16x16x32_bf16 a[16:19], v[224:227], v[160:163], a[16:19]
v_mfma_f32_16x16x32_bf16 a[16:19], v[228:231], v[164:167], a[16:19]
ds_read_b64_tr_b16 v[244:245], v22 offset:8192
v_mfma_f32_16x16x32_bf16 a[20:23], v[228:231], v[172:175], a[20:23]
v_mfma_f32_16x16x32_bf16 a[20:23], v[224:227], v[168:171], a[20:23]
s_add_u32 s72, s69, 47104
buffer_load_dwordx4 v2, s[8:11], s72 offen offset:2048 lds
v_mfma_f32_16x16x32_bf16 a[24:27], v[224:227], v[176:179], a[24:27]
ds_read_b64_tr_b16 v[246:247], v22 offset:9216
v_mfma_f32_16x16x32_bf16 a[24:27], v[228:231], v[180:183], a[24:27]
v_mfma_f32_16x16x32_bf16 a[28:31], v[228:231], v[188:191], a[28:31]
v_mfma_f32_16x16x32_bf16 a[28:31], v[224:227], v[184:187], a[28:31]
s_waitcnt lgkmcnt(3)
v_mfma_f32_16x16x32_bf16 a[60:63], v[232:235], v[184:187], a[60:63]
s_add_u32 s72, s69, 54272
buffer_load_dwordx4 v3, s[8:11], s72 offen offset:3072 lds
v_mfma_f32_16x16x32_bf16 a[60:63], v[236:239], v[188:191], a[60:63]
ds_read_b64_tr_b16 v[248:249], v23 offset:0
v_mfma_f32_16x16x32_bf16 a[56:59], v[236:239], v[180:183], a[56:59]
v_mfma_f32_16x16x32_bf16 a[56:59], v[232:235], v[176:179], a[56:59]
s_add_u32 m0, s64, 49152
ds_read_b64_tr_b16 v[250:251], v23 offset:1024
v_mfma_f32_16x16x32_bf16 a[52:55], v[232:235], v[168:171], a[52:55]
s_add_u32 s72, s71, 0
buffer_load_dwordx4 v6, s[20:23], s72 offen lds
v_mfma_f32_16x16x32_bf16 a[52:55], v[236:239], v[172:175], a[52:55]
v_mfma_f32_16x16x32_bf16 a[48:51], v[236:239], v[164:167], a[48:51]
v_mfma_f32_16x16x32_bf16 a[48:51], v[232:235], v[160:163], a[48:51]
ds_read_b64_tr_b16 v[252:253], v23 offset:8192
v_mfma_f32_16x16x32_bf16 a[44:47], v[232:235], v[152:155], a[44:47]
s_add_u32 s72, s71, 31744
buffer_load_dwordx4 v6, s[20:23], s72 offen offset:1024 lds
v_mfma_f32_16x16x32_bf16 a[44:47], v[236:239], v[156:159], a[44:47]
v_mfma_f32_16x16x32_bf16 a[40:43], v[236:239], v[148:151], a[40:43]
ds_read_b64_tr_b16 v[254:255], v23 offset:9216
v_mfma_f32_16x16x32_bf16 a[40:43], v[232:235], v[144:147], a[40:43]
v_mfma_f32_16x16x32_bf16 a[36:39], v[232:235], v[136:139], a[36:39]
s_add_u32 s72, s71, 63488
buffer_load_dwordx4 v7, s[20:23], s72 offen offset:2048 lds
v_mfma_f32_16x16x32_bf16 a[36:39], v[236:239], v[140:143], a[36:39]
v_mfma_f32_16x16x32_bf16 a[32:35], v[236:239], v[132:135], a[32:35]
v_mfma_f32_16x16x32_bf16 a[32:35], v[232:235], v[128:131], a[32:35]
s_waitcnt lgkmcnt(4)
v_mfma_f32_16x16x32_bf16 a[64:67], v[240:243], v[128:131], a[64:67]
s_add_u32 s72, s71, 95232
buffer_load_dwordx4 v7, s[20:23], s72 offen offset:3072 lds
v_mfma_f32_16x16x32_bf16 a[64:67], v[244:247], v[132:135], a[64:67]
s_mov_b32 s80, 0x300000
buffer_load_dword v126, v125, s[16:19], s80 offen
v_mfma_f32_16x16x32_bf16 a[68:71], v[244:247], v[140:143], a[68:71]
buffer_load_dword v126, v125, s[20:23], s80 offen
v_mfma_f32_16x16x32_bf16 a[68:71], v[240:243], v[136:139], a[68:71]
s_add_u32 m0, s63, 135168
ds_read_b64_tr_b16 v[224:225], v20 offset:16384
v_mfma_f32_16x16x32_bf16 a[72:75], v[240:243], v[144:147], a[72:75]
s_add_u32 s80, s82, 0
buffer_load_dwordx4 v26, s[32:35], s80 offen nt lds
v_mfma_f32_16x16x32_bf16 a[72:75], v[244:247], v[148:151], a[72:75]
s_add_u32 s80, s82, 15360
buffer_load_dwordx4 v26, s[32:35], s80 offen offset:1024 nt lds
v_mfma_f32_16x16x32_bf16 a[76:79], v[244:247], v[156:159], a[76:79]
s_add_u32 s80, s82, 30720
buffer_load_dwordx4 v26, s[32:35], s80 offen offset:2048 nt lds
v_mfma_f32_16x16x32_bf16 a[76:79], v[240:243], v[152:155], a[76:79]
s_add_u32 s80, s82, 46080
buffer_load_dwordx4 v26, s[32:35], s80 offen offset:3072 nt lds
v_mfma_f32_16x16x32_bf16 a[80:83], v[240:243], v[160:163], a[80:83]
ds_read_b64_tr_b16 v[226:227], v20 offset:17408
v_mfma_f32_16x16x32_bf16 a[80:83], v[244:247], v[164:167], a[80:83]
v_mfma_f32_16x16x32_bf16 a[84:87], v[244:247], v[172:175], a[84:87]
ds_read_b64_tr_b16 v[228:229], v20 offset:24576
v_mfma_f32_16x16x32_bf16 a[84:87], v[240:243], v[168:171], a[84:87]
v_mfma_f32_16x16x32_bf16 a[88:91], v[240:243], v[176:179], a[88:91]
ds_read_b64_tr_b16 v[230:231], v20 offset:25600
v_mfma_f32_16x16x32_bf16 a[88:91], v[244:247], v[180:183], a[88:91]
v_mfma_f32_16x16x32_bf16 a[92:95], v[244:247], v[188:191], a[92:95]
v_mfma_f32_16x16x32_bf16 a[92:95], v[240:243], v[184:187], a[92:95]
s_waitcnt lgkmcnt(4)
v_mfma_f32_16x16x32_bf16 a[124:127], v[248:251], v[184:187], a[124:127]
ds_read_b64_tr_b16 v[232:233], v21 offset:16384
v_mfma_f32_16x16x32_bf16 a[124:127], v[252:255], v[188:191], a[124:127]
v_mfma_f32_16x16x32_bf16 a[120:123], v[252:255], v[180:183], a[120:123]
v_mfma_f32_16x16x32_bf16 a[120:123], v[248:251], v[176:179], a[120:123]
ds_read_b64_tr_b16 v[234:235], v21 offset:17408
v_mfma_f32_16x16x32_bf16 a[116:119], v[248:251], v[168:171], a[116:119]
v_mfma_f32_16x16x32_bf16 a[116:119], v[252:255], v[172:175], a[116:119]
v_mfma_f32_16x16x32_bf16 a[112:115], v[252:255], v[164:167], a[112:115]
v_mfma_f32_16x16x32_bf16 a[112:115], v[248:251], v[160:163], a[112:115]
ds_read_b64_tr_b16 v[236:237], v21 offset:24576
v_mfma_f32_16x16x32_bf16 a[108:111], v[248:251], v[152:155], a[108:111]
v_mfma_f32_16x16x32_bf16 a[108:111], v[252:255], v[156:159], a[108:111]
v_mfma_f32_16x16x32_bf16 a[104:107], v[252:255], v[148:151], a[104:107]
ds_read_b64_tr_b16 v[238:239], v21 offset:25600
v_mfma_f32_16x16x32_bf16 a[104:107], v[248:251], v[144:147], a[104:107]
v_mfma_f32_16x16x32_bf16 a[100:103], v[248:251], v[136:139], a[100:103]
v_mfma_f32_16x16x32_bf16 a[100:103], v[252:255], v[140:143], a[100:103]
v_mfma_f32_16x16x32_bf16 a[96:99], v[252:255], v[132:135], a[96:99]
v_mfma_f32_16x16x32_bf16 a[96:99], v[248:251], v[128:131], a[96:99]
s_waitcnt lgkmcnt(4)
v_mfma_f32_16x16x32_bf16 a[128:131], v[128:131], v[224:227], a[128:131]
ds_read_b64_tr_b16 v[240:241], v22 offset:16384
v_mfma_f32_16x16x32_bf16 a[128:131], v[132:135], v[228:231], a[128:131]
v_mfma_f32_16x16x32_bf16 a[132:135], v[140:143], v[228:231], a[132:135]
v_mfma_f32_16x16x32_bf16 a[132:135], v[136:139], v[224:227], a[132:135]
ds_read_b64_tr_b16 v[242:243], v22 offset:17408
v_mfma_f32_16x16x32_bf16 a[136:139], v[144:147], v[224:227], a[136:139]
v_mfma_f32_16x16x32_bf16 a[136:139], v[148:151], v[228:231], a[136:139]
v_mfma_f32_16x16x32_bf16 a[140:143], v[156:159], v[228:231], a[140:143]
v_mfma_f32_16x16x32_bf16 a[140:143], v[152:155], v[224:227], a[140:143]
ds_read_b64_tr_b16 v[244:245], v22 offset:24576
v_mfma_f32_16x16x32_bf16 a[144:147], v[160:163], v[224:227], a[144:147]
v_mfma_f32_16x16x32_bf16 a[144:147], v[164:167], v[228:231], a[144:147]
v_mfma_f32_16x16x32_bf16 a[148:151], v[172:175], v[228:231], a[148:151]
ds_read_b64_tr_b16 v[246:247], v22 offset:25600
v_mfma_f32_16x16x32_bf16 a[148:151], v[168:171], v[224:227], a[148:151]
v_mfma_f32_16x16x32_bf16 a[152:155], v[176:179], v[224:227], a[152:155]
v_mfma_f32_16x16x32_bf16 a[152:155], v[180:183], v[228:231], a[152:155]
v_mfma_f32_16x16x32_bf16 a[156:159], v[188:191], v[228:231], a[156:159]
v_mfma_f32_16x16x32_bf16 a[156:159], v[184:187], v[224:227], a[156:159]
s_waitcnt lgkmcnt(4)
v_mfma_f32_16x16x32_bf16 a[188:191], v[184:187], v[232:235], a[188:191]
ds_read_b64_tr_b16 v[248:249], v23 offset:16384
v_mfma_f32_16x16x32_bf16 a[188:191], v[188:191], v[236:239], a[188:191]
v_mfma_f32_16x16x32_bf16 a[184:187], v[180:183], v[236:239], a[184:187]
ds_read_b64_tr_b16 v[250:251], v23 offset:17408
v_mfma_f32_16x16x32_bf16 a[184:187], v[176:179], v[232:235], a[184:187]
v_mfma_f32_16x16x32_bf16 a[180:183], v[168:171], v[232:235], a[180:183]
ds_read_b64_tr_b16 v[252:253], v23 offset:24576
v_mfma_f32_16x16x32_bf16 a[180:183], v[172:175], v[236:239], a[180:183]
v_mfma_f32_16x16x32_bf16 a[176:179], v[164:167], v[236:239], a[176:179]
ds_read_b64_tr_b16 v[254:255], v23 offset:25600
v_mfma_f32_16x16x32_bf16 a[176:179], v[160:163], v[232:235], a[176:179]
v_mfma_f32_16x16x32_bf16 a[172:175], v[152:155], v[232:235], a[172:175]
v_mfma_f32_16x16x32_bf16 a[172:175], v[156:159], v[236:239], a[172:175]
v_mfma_f32_16x16x32_bf16 a[168:171], v[148:151], v[236:239], a[168:171]
v_mfma_f32_16x16x32_bf16 a[168:171], v[144:147], v[232:235], a[168:171]
v_mfma_f32_16x16x32_bf16 a[164:167], v[136:139], v[232:235], a[164:167]
v_mfma_f32_16x16x32_bf16 a[164:167], v[140:143], v[236:239], a[164:167]
v_mfma_f32_16x16x32_bf16 a[160:163], v[132:135], v[236:239], a[160:163]
s_waitcnt vmcnt(6) lgkmcnt(0)
v_mfma_f32_16x16x32_bf16 a[160:163], v[128:131], v[232:235], a[160:163]
s_barrier
v_mfma_f32_16x16x32_bf16 a[192:195], v[128:131], v[240:243], a[192:195]
s_and_b32 s73, s65, 1
ds_read_b64_tr_b16 v[224:225], v20 offset:32768
v_mfma_f32_16x16x32_bf16 a[192:195], v[132:135], v[244:247], a[192:195]
s_xor_b32 s73, s73, 4
ds_read_b64_tr_b16 v[226:227], v20 offset:33792
v_mfma_f32_16x16x32_bf16 a[196:199], v[140:143], v[244:247], a[196:199]
s_lshl_b32 s69, s73, 7
ds_read_b64_tr_b16 v[228:229], v20 offset:40960
v_mfma_f32_16x16x32_bf16 a[196:199], v[136:139], v[240:243], a[196:199]
s_add_u32 s69, s69, s84
ds_read_b64_tr_b16 v[230:231], v20 offset:41984
v_mfma_f32_16x16x32_bf16 a[200:203], v[144:147], v[240:243], a[200:203]
s_lshl_b32 s71, s73, 19
ds_read_b128 v[192:195], v24 offset:32768
v_mfma_f32_16x16x32_bf16 a[200:203], v[148:151], v[244:247], a[200:203]
s_add_u32 s71, s71, s66
ds_read_b128 v[196:199], v25 offset:32768
v_mfma_f32_16x16x32_bf16 a[204:207], v[156:159], v[244:247], a[204:207]
s_add_u32 m0, s63, 65536
v_mfma_f32_16x16x32_bf16 a[204:207], v[152:155], v[240:243], a[204:207]
s_add_u32 s72, s69, 0
buffer_load_dwordx4 v2, s[8:11], s72 offen lds
v_mfma_f32_16x16x32_bf16 a[208:211], v[160:163], v[240:243], a[208:211]
s_add_u32 s72, s69, 7168
buffer_load_dwordx4 v3, s[8:11], s72 offen offset:1024 lds
v_mfma_f32_16x16x32_bf16 a[208:211], v[164:167], v[244:247], a[208:211]
s_add_u32 s72, s69, 14336
buffer_load_dwordx4 v2, s[8:11], s72 offen offset:2048 lds
v_mfma_f32_16x16x32_bf16 a[212:215], v[172:175], v[244:247], a[212:215]
ds_read_b128 v[200:203], v24 offset:34816
v_mfma_f32_16x16x32_bf16 a[212:215], v[168:171], v[240:243], a[212:215]
ds_read_b128 v[204:207], v25 offset:34816
v_mfma_f32_16x16x32_bf16 a[216:219], v[176:179], v[240:243], a[216:219]
s_add_u32 s72, s69, 21504
buffer_load_dwordx4 v3, s[8:11], s72 offen offset:3072 lds
v_mfma_f32_16x16x32_bf16 a[216:219], v[180:183], v[244:247], a[216:219]
ds_read_b128 v[208:211], v24 offset:36864
v_mfma_f32_16x16x32_bf16 a[220:223], v[188:191], v[244:247], a[220:223]
ds_read_b128 v[212:215], v25 offset:36864
v_mfma_f32_16x16x32_bf16 a[220:223], v[184:187], v[240:243], a[220:223]
ds_read_b128 v[216:219], v24 offset:38912
v_mfma_f32_16x16x32_bf16 a[252:255], v[184:187], v[248:251], a[252:255]
ds_read_b128 v[220:223], v25 offset:38912
v_mfma_f32_16x16x32_bf16 a[252:255], v[188:191], v[252:255], a[252:255]
s_add_u32 m0, s64, 0
v_mfma_f32_16x16x32_bf16 a[248:251], v[180:183], v[252:255], a[248:251]
s_add_u32 s72, s71, 0
buffer_load_dwordx4 v6, s[16:19], s72 offen lds
v_mfma_f32_16x16x32_bf16 a[248:251], v[176:179], v[248:251], a[248:251]
ds_read_b128 v[184:187], v24 offset:40960
v_mfma_f32_16x16x32_bf16 a[244:247], v[168:171], v[248:251], a[244:247]
ds_read_b128 v[188:191], v25 offset:40960
v_mfma_f32_16x16x32_bf16 a[244:247], v[172:175], v[252:255], a[244:247]
s_add_u32 s72, s71, 31744
buffer_load_dwordx4 v6, s[16:19], s72 offen offset:1024 lds
v_mfma_f32_16x16x32_bf16 a[240:243], v[164:167], v[252:255], a[240:243]
ds_read_b128 v[176:179], v24 offset:43008
v_mfma_f32_16x16x32_bf16 a[240:243], v[160:163], v[248:251], a[240:243]
ds_read_b128 v[180:183], v25 offset:43008
v_mfma_f32_16x16x32_bf16 a[236:239], v[152:155], v[248:251], a[236:239]
ds_read_b128 v[168:171], v24 offset:45056
v_mfma_f32_16x16x32_bf16 a[236:239], v[156:159], v[252:255], a[236:239]
s_add_u32 s72, s71, 63488
buffer_load_dwordx4 v7, s[16:19], s72 offen offset:2048 lds
v_mfma_f32_16x16x32_bf16 a[232:235], v[148:151], v[252:255], a[232:235]
ds_read_b128 v[172:175], v25 offset:45056
v_mfma_f32_16x16x32_bf16 a[232:235], v[144:147], v[248:251], a[232:235]
ds_read_b128 v[160:163], v24 offset:47104
v_mfma_f32_16x16x32_bf16 a[228:231], v[136:139], v[248:251], a[228:231]
ds_read_b128 v[164:167], v25 offset:47104
v_mfma_f32_16x16x32_bf16 a[228:231], v[140:143], v[252:255], a[228:231]
v_mfma_f32_16x16x32_bf16 a[224:227], v[132:135], v[252:255], a[224:227]
s_add_u32 s72, s71, 95232
buffer_load_dwordx4 v7, s[16:19], s72 offen offset:3072 lds
v_mfma_f32_16x16x32_bf16 a[224:227], v[128:131], v[248:251], a[224:227]
s_waitcnt lgkmcnt(8)
ds_read_b64_tr_b16 v[232:233], v21 offset:32768
v_mfma_f32_16x16x32_bf16 a[0:3], v[224:227], v[192:195], a[0:3]
ds_read_b64_tr_b16 v[234:235], v21 offset:33792
v_mfma_f32_16x16x32_bf16 a[0:3], v[228:231], v[196:199], a[0:3]
ds_read_b64_tr_b16 v[240:241], v22 offset:32768
v_mfma_f32_16x16x32_bf16 a[4:7], v[228:231], v[204:207], a[4:7]
s_add_u32 m0, s63, 69632
ds_read_b64_tr_b16 v[236:237], v21 offset:40960
v_mfma_f32_16x16x32_bf16 a[4:7], v[224:227], v[200:203], a[4:7]
s_add_u32 s72, s69, 32768
buffer_load_dwordx4 v2, s[8:11], s72 offen lds
v_mfma_f32_16x16x32_bf16 a[8:11], v[224:227], v[208:211], a[8:11]
ds_read_b64_tr_b16 v[238:239], v21 offset:41984
v_mfma_f32_16x16x32_bf16 a[8:11], v[228:231], v[212:215], a[8:11]
v_mfma_f32_16x16x32_bf16 a[12:15], v[228:231], v[220:223], a[12:15]
s_add_u32 s72, s69, 39936
buffer_load_dwordx4 v3, s[8:11], s72 offen offset:1024 lds
v_mfma_f32_16x16x32_bf16 a[12:15], v[224:227], v[216:219], a[12:15]
s_waitcnt lgkmcnt(5)
ds_read_b64_tr_b16 v[242:243], v22 offset:33792
v_mfma_f32_16x16x32_bf16 a[16:19], v[224:227], v[184:187], a[16:19]
v_mfma_f32_16x16x32_bf16 a[16:19], v[228:231], v[188:191], a[16:19]
ds_read_b64_tr_b16 v[244:245], v22 offset:40960
v_mfma_f32_16x16x32_bf16 a[20:23], v[228:231], v[180:183], a[20:23]
v_mfma_f32_16x16x32_bf16 a[20:23], v[224:227], v[176:179], a[20:23]
s_add_u32 s72, s69, 47104
buffer_load_dwordx4 v2, s[8:11], s72 offen offset:2048 lds
v_mfma_f32_16x16x32_bf16 a[24:27], v[224:227], v[168:171], a[24:27]
ds_read_b64_tr_b16 v[246:247], v22 offset:41984
v_mfma_f32_16x16x32_bf16 a[24:27], v[228:231], v[172:175], a[24:27]
v_mfma_f32_16x16x32_bf16 a[28:31], v[228:231], v[164:167], a[28:31]
v_mfma_f32_16x16x32_bf16 a[28:31], v[224:227], v[160:163], a[28:31]
s_waitcnt lgkmcnt(3)
v_mfma_f32_16x16x32_bf16 a[60:63], v[232:235], v[160:163], a[60:63]
s_add_u32 s72, s69, 54272
buffer_load_dwordx4 v3, s[8:11], s72 offen offset:3072 lds
v_mfma_f32_16x16x32_bf16 a[60:63], v[236:239], v[164:167], a[60:63]
ds_read_b64_tr_b16 v[248:249], v23 offset:32768
v_mfma_f32_16x16x32_bf16 a[56:59], v[236:239], v[172:175], a[56:59]
v_mfma_f32_16x16x32_bf16 a[56:59], v[232:235], v[168:171], a[56:59]
s_add_u32 m0, s64, 16384
ds_read_b64_tr_b16 v[250:251], v23 offset:33792
v_mfma_f32_16x16x32_bf16 a[52:55], v[232:235], v[176:179], a[52:55]
s_add_u32 s72, s71, 0
buffer_load_dwordx4 v6, s[20:23], s72 offen lds
v_mfma_f32_16x16x32_bf16 a[52:55], v[236:239], v[180:183], a[52:55]
v_mfma_f32_16x16x32_bf16 a[48:51], v[236:239], v[188:191], a[48:51]
v_mfma_f32_16x16x32_bf16 a[48:51], v[232:235], v[184:187], a[48:51]
ds_read_b64_tr_b16 v[252:253], v23 offset:40960
v_mfma_f32_16x16x32_bf16 a[44:47], v[232:235], v[216:219], a[44:47]
s_add_u32 s72, s71, 31744
buffer_load_dwordx4 v6, s[20:23], s72 offen offset:1024 lds
v_mfma_f32_16x16x32_bf16 a[44:47], v[236:239], v[220:223], a[44:47]
v_mfma_f32_16x16x32_bf16 a[40:43], v[236:239], v[212:215], a[40:43]
ds_read_b64_tr_b16 v[254:255], v23 offset:41984
v_mfma_f32_16x16x32_bf16 a[40:43], v[232:235], v[208:211], a[40:43]
v_mfma_f32_16x16x32_bf16 a[36:39], v[232:235], v[200:203], a[36:39]
s_add_u32 s72, s71, 63488
buffer_load_dwordx4 v7, s[20:23], s72 offen offset:2048 lds
v_mfma_f32_16x16x32_bf16 a[36:39], v[236:239], v[204:207], a[36:39]
v_mfma_f32_16x16x32_bf16 a[32:35], v[236:239], v[196:199], a[32:35]
v_mfma_f32_16x16x32_bf16 a[32:35], v[232:235], v[192:195], a[32:35]
s_waitcnt lgkmcnt(4)
v_mfma_f32_16x16x32_bf16 a[64:67], v[240:243], v[192:195], a[64:67]
s_add_u32 s72, s71, 95232
buffer_load_dwordx4 v7, s[20:23], s72 offen offset:3072 lds
v_mfma_f32_16x16x32_bf16 a[64:67], v[244:247], v[196:199], a[64:67]
buffer_load_dwordx4 v[108:111], v1, s[4:7], s76 offen
v_mfma_f32_16x16x32_bf16 a[68:71], v[244:247], v[204:207], a[68:71]
buffer_load_dwordx4 v[112:115], v1, s[4:7], s76 offen offset:1024
v_mfma_f32_16x16x32_bf16 a[68:71], v[240:243], v[200:203], a[68:71]
buffer_load_dwordx4 v[116:119], v1, s[4:7], s76 offen offset:2048
v_mfma_f32_16x16x32_bf16 a[72:75], v[240:243], v[208:211], a[72:75]
buffer_load_dwordx4 v[120:123], v1, s[4:7], s76 offen offset:3072
v_mfma_f32_16x16x32_bf16 a[72:75], v[244:247], v[212:215], a[72:75]
ds_read_b64_tr_b16 v[224:225], v20 offset:49152
v_mfma_f32_16x16x32_bf16 a[76:79], v[244:247], v[220:223], a[76:79]
v_mfma_f32_16x16x32_bf16 a[76:79], v[240:243], v[216:219], a[76:79]
ds_read_b64_tr_b16 v[226:227], v20 offset:50176
v_mfma_f32_16x16x32_bf16 a[80:83], v[240:243], v[184:187], a[80:83]
v_mfma_f32_16x16x32_bf16 a[80:83], v[244:247], v[188:191], a[80:83]
ds_read_b64_tr_b16 v[228:229], v20 offset:57344
v_mfma_f32_16x16x32_bf16 a[84:87], v[244:247], v[180:183], a[84:87]
v_mfma_f32_16x16x32_bf16 a[84:87], v[240:243], v[176:179], a[84:87]
ds_read_b64_tr_b16 v[230:231], v20 offset:58368
v_mfma_f32_16x16x32_bf16 a[88:91], v[240:243], v[168:171], a[88:91]
v_mfma_f32_16x16x32_bf16 a[88:91], v[244:247], v[172:175], a[88:91]
v_mfma_f32_16x16x32_bf16 a[92:95], v[244:247], v[164:167], a[92:95]
v_mfma_f32_16x16x32_bf16 a[92:95], v[240:243], v[160:163], a[92:95]
s_waitcnt lgkmcnt(4)
v_mfma_f32_16x16x32_bf16 a[124:127], v[248:251], v[160:163], a[124:127]
ds_read_b64_tr_b16 v[232:233], v21 offset:49152
v_mfma_f32_16x16x32_bf16 a[124:127], v[252:255], v[164:167], a[124:127]
v_mfma_f32_16x16x32_bf16 a[120:123], v[252:255], v[172:175], a[120:123]
v_mfma_f32_16x16x32_bf16 a[120:123], v[248:251], v[168:171], a[120:123]
ds_read_b64_tr_b16 v[234:235], v21 offset:50176
v_mfma_f32_16x16x32_bf16 a[116:119], v[248:251], v[176:179], a[116:119]
s_waitcnt vmcnt(20)
ds_read2_b32 v[36:37], v98 offset0:0 offset1:32
ds_read2_b32 v[38:39], v98 offset0:64 offset1:96
v_mfma_f32_16x16x32_bf16 a[116:119], v[252:255], v[180:183], a[116:119]
ds_read2_b32 v[40:41], v98 offset0:128 offset1:160
ds_read2_b32 v[42:43], v98 offset0:192 offset1:224
v_mfma_f32_16x16x32_bf16 a[112:115], v[252:255], v[188:191], a[112:115]
v_add_u32 v98, 1024, v98
v_mfma_f32_16x16x32_bf16 a[112:115], v[248:251], v[184:187], a[112:115]
ds_read_b64_tr_b16 v[236:237], v21 offset:57344
ds_read2_b32 v[44:45], v98 offset0:0 offset1:32
v_mfma_f32_16x16x32_bf16 a[108:111], v[248:251], v[216:219], a[108:111]
ds_read2_b32 v[46:47], v98 offset0:64 offset1:96
ds_read2_b32 v[48:49], v98 offset0:128 offset1:160
v_mfma_f32_16x16x32_bf16 a[108:111], v[252:255], v[220:223], a[108:111]
ds_read2_b32 v[50:51], v98 offset0:192 offset1:224
v_add_u32 v98, 3072, v98
v_mfma_f32_16x16x32_bf16 a[104:107], v[252:255], v[212:215], a[104:107]
ds_read_b64_tr_b16 v[238:239], v21 offset:58368
ds_read2_b32 v[52:53], v98 offset0:0 offset1:32
v_mfma_f32_16x16x32_bf16 a[104:107], v[248:251], v[208:211], a[104:107]
ds_read2_b32 v[54:55], v98 offset0:64 offset1:96
ds_read2_b32 v[56:57], v98 offset0:128 offset1:160
v_mfma_f32_16x16x32_bf16 a[100:103], v[248:251], v[200:203], a[100:103]
ds_read2_b32 v[58:59], v98 offset0:192 offset1:224
v_add_u32 v98, 1024, v98
v_mfma_f32_16x16x32_bf16 a[100:103], v[252:255], v[204:207], a[100:103]
ds_read2_b32 v[60:61], v98 offset0:0 offset1:32
ds_read2_b32 v[62:63], v98 offset0:64 offset1:96
v_mfma_f32_16x16x32_bf16 a[96:99], v[252:255], v[196:199], a[96:99]
ds_read2_b32 v[64:65], v98 offset0:128 offset1:160
ds_read2_b32 v[66:67], v98 offset0:192 offset1:224
v_mfma_f32_16x16x32_bf16 a[96:99], v[248:251], v[192:195], a[96:99]
s_waitcnt lgkmcnt(15)
v_mfma_f32_16x16x32_bf16 a[128:131], v[192:195], v[224:227], a[128:131]
ds_read_b64_tr_b16 v[240:241], v22 offset:49152
v_mfma_f32_16x16x32_bf16 a[128:131], v[196:199], v[228:231], a[128:131]
v_mfma_f32_16x16x32_bf16 a[132:135], v[204:207], v[228:231], a[132:135]
v_mfma_f32_16x16x32_bf16 a[132:135], v[200:203], v[224:227], a[132:135]
ds_read_b64_tr_b16 v[242:243], v22 offset:50176
v_mfma_f32_16x16x32_bf16 a[136:139], v[208:211], v[224:227], a[136:139]
v_mfma_f32_16x16x32_bf16 a[136:139], v[212:215], v[228:231], a[136:139]
v_mfma_f32_16x16x32_bf16 a[140:143], v[220:223], v[228:231], a[140:143]
v_mfma_f32_16x16x32_bf16 a[140:143], v[216:219], v[224:227], a[140:143]
ds_read_b64_tr_b16 v[244:245], v22 offset:57344
v_mfma_f32_16x16x32_bf16 a[144:147], v[184:187], v[224:227], a[144:147]
v_mfma_f32_16x16x32_bf16 a[144:147], v[188:191], v[228:231], a[144:147]
v_mfma_f32_16x16x32_bf16 a[148:151], v[180:183], v[228:231], a[148:151]
ds_read_b64_tr_b16 v[246:247], v22 offset:58368
v_mfma_f32_16x16x32_bf16 a[148:151], v[176:179], v[224:227], a[148:151]
v_mfma_f32_16x16x32_bf16 a[152:155], v[168:171], v[224:227], a[152:155]
v_mfma_f32_16x16x32_bf16 a[152:155], v[172:175], v[228:231], a[152:155]
v_mfma_f32_16x16x32_bf16 a[156:159], v[164:167], v[228:231], a[156:159]
v_mfma_f32_16x16x32_bf16 a[156:159], v[160:163], v[224:227], a[156:159]
s_waitcnt lgkmcnt(12)
v_mfma_f32_16x16x32_bf16 a[188:191], v[160:163], v[232:235], a[188:191]
ds_read_b64_tr_b16 v[248:249], v23 offset:49152
v_mfma_f32_16x16x32_bf16 a[188:191], v[164:167], v[236:239], a[188:191]
v_mfma_f32_16x16x32_bf16 a[184:187], v[172:175], v[236:239], a[184:187]
ds_read_b64_tr_b16 v[250:251], v23 offset:50176
v_mfma_f32_16x16x32_bf16 a[184:187], v[168:171], v[232:235], a[184:187]
v_mfma_f32_16x16x32_bf16 a[180:183], v[176:179], v[232:235], a[180:183]
ds_read_b64_tr_b16 v[252:253], v23 offset:57344
v_mfma_f32_16x16x32_bf16 a[180:183], v[180:183], v[236:239], a[180:183]
v_mfma_f32_16x16x32_bf16 a[176:179], v[188:191], v[236:239], a[176:179]
ds_read_b64_tr_b16 v[254:255], v23 offset:58368
v_mfma_f32_16x16x32_bf16 a[176:179], v[184:187], v[232:235], a[176:179]
v_mfma_f32_16x16x32_bf16 a[172:175], v[216:219], v[232:235], a[172:175]
v_mfma_f32_16x16x32_bf16 a[172:175], v[220:223], v[236:239], a[172:175]
v_mfma_f32_16x16x32_bf16 a[168:171], v[212:215], v[236:239], a[168:171]
v_mfma_f32_16x16x32_bf16 a[168:171], v[208:211], v[232:235], a[168:171]
v_mfma_f32_16x16x32_bf16 a[164:167], v[200:203], v[232:235], a[164:167]
v_mfma_f32_16x16x32_bf16 a[164:167], v[204:207], v[236:239], a[164:167]
v_mfma_f32_16x16x32_bf16 a[160:163], v[196:199], v[236:239], a[160:163]
s_waitcnt vmcnt(4) lgkmcnt(0)
v_mfma_f32_16x16x32_bf16 a[160:163], v[192:195], v[232:235], a[160:163]
s_barrier
v_mfma_f32_16x16x32_bf16 a[192:195], v[192:195], v[240:243], a[192:195]
s_and_b32 s73, s65, 1
ds_read_b64_tr_b16 v[224:225], v20 offset:0
v_lshlrev_b32 v72, 16, v68
v_mfma_f32_16x16x32_bf16 a[192:195], v[196:199], v[244:247], a[192:195]
s_xor_b32 s73, s73, 5
ds_read_b64_tr_b16 v[226:227], v20 offset:1024
v_and_b32 v73, 0xffff0000, v68
v_mfma_f32_16x16x32_bf16 a[196:199], v[204:207], v[244:247], a[196:199]
s_lshl_b32 s69, s73, 7
ds_read_b64_tr_b16 v[228:229], v20 offset:8192
v_lshlrev_b32 v74, 16, v69
v_mfma_f32_16x16x32_bf16 a[196:199], v[200:203], v[240:243], a[196:199]
s_add_u32 s69, s69, s84
ds_read_b64_tr_b16 v[230:231], v20 offset:9216
v_and_b32 v75, 0xffff0000, v69
v_mfma_f32_16x16x32_bf16 a[200:203], v[208:211], v[240:243], a[200:203]
s_lshl_b32 s71, s73, 19
ds_read_b128 v[128:131], v24 offset:0
v_lshlrev_b32 v76, 16, v33
v_mfma_f32_16x16x32_bf16 a[200:203], v[212:215], v[244:247], a[200:203]
s_add_u32 s71, s71, s66
ds_read_b128 v[132:135], v25 offset:0
v_lshlrev_b32 v77, 16, v34
v_mfma_f32_16x16x32_bf16 a[204:207], v[220:223], v[244:247], a[204:207]
s_add_u32 m0, s63, 98304
v_lshlrev_b32 v78, 16, v35
v_lshlrev_b32 v79, 16, v36
v_mfma_f32_16x16x32_bf16 a[204:207], v[216:219], v[240:243], a[204:207]
s_add_u32 s72, s69, 0
buffer_load_dwordx4 v2, s[8:11], s72 offen lds
v_mfma_f32_16x16x32_bf16 a[208:211], v[184:187], v[240:243], a[208:211]
s_add_u32 s72, s69, 7168
buffer_load_dwordx4 v3, s[8:11], s72 offen offset:1024 lds
v_mfma_f32_16x16x32_bf16 a[208:211], v[188:191], v[244:247], a[208:211]
s_add_u32 s72, s69, 14336
buffer_load_dwordx4 v2, s[8:11], s72 offen offset:2048 lds
v_mfma_f32_16x16x32_bf16 a[212:215], v[180:183], v[244:247], a[212:215]
ds_read_b128 v[136:139], v24 offset:2048
v_lshlrev_b32 v80, 16, v37
v_mfma_f32_16x16x32_bf16 a[212:215], v[176:179], v[240:243], a[212:215]
ds_read_b128 v[140:143], v25 offset:2048
v_lshlrev_b32 v81, 16, v38
v_mfma_f32_16x16x32_bf16 a[216:219], v[168:171], v[240:243], a[216:219]
s_add_u32 s72, s69, 21504
buffer_load_dwordx4 v3, s[8:11], s72 offen offset:3072 lds
v_mfma_f32_16x16x32_bf16 a[216:219], v[172:175], v[244:247], a[216:219]
ds_read_b128 v[144:147], v24 offset:4096
v_lshlrev_b32 v82, 16, v39
v_mfma_f32_16x16x32_bf16 a[220:223], v[164:167], v[244:247], a[220:223]
ds_read_b128 v[148:151], v25 offset:4096
v_lshlrev_b32 v83, 16, v40
v_mfma_f32_16x16x32_bf16 a[220:223], v[160:163], v[240:243], a[220:223]
ds_read_b128 v[152:155], v24 offset:6144
v_lshlrev_b32 v84, 16, v41
v_mfma_f32_16x16x32_bf16 a[252:255], v[160:163], v[248:251], a[252:255]
ds_read_b128 v[156:159], v25 offset:6144
v_lshlrev_b32 v85, 16, v42
v_mfma_f32_16x16x32_bf16 a[252:255], v[164:167], v[252:255], a[252:255]
s_add_u32 m0, s64, 32768
v_lshlrev_b32 v86, 16, v43
v_lshlrev_b32 v87, 16, v44
v_mfma_f32_16x16x32_bf16 a[248:251], v[172:175], v[252:255], a[248:251]
s_add_u32 s72, s71, 0
buffer_load_dwordx4 v6, s[16:19], s72 offen lds
v_mfma_f32_16x16x32_bf16 a[248:251], v[168:171], v[248:251], a[248:251]
ds_read_b128 v[160:163], v24 offset:8192
v_lshlrev_b32 v88, 16, v45
v_mfma_f32_16x16x32_bf16 a[244:247], v[176:179], v[248:251], a[244:247]
ds_read_b128 v[164:167], v25 offset:8192
v_lshlrev_b32 v89, 16, v46
v_mfma_f32_16x16x32_bf16 a[244:247], v[180:183], v[252:255], a[244:247]
s_add_u32 s72, s71, 31744
buffer_load_dwordx4 v6, s[16:19], s72 offen offset:1024 lds
v_mfma_f32_16x16x32_bf16 a[240:243], v[188:191], v[252:255], a[240:243]
ds_read_b128 v[168:171], v24 offset:10240
v_lshlrev_b32 v90, 16, v47
v_mfma_f32_16x16x32_bf16 a[240:243], v[184:187], v[248:251], a[240:243]
ds_read_b128 v[172:175], v25 offset:10240
v_lshlrev_b32 v91, 16, v48
v_mfma_f32_16x16x32_bf16 a[236:239], v[216:219], v[248:251], a[236:239]
ds_read_b128 v[176:179], v24 offset:12288
v_lshlrev_b32 v92, 16, v49
v_mfma_f32_16x16x32_bf16 a[236:239], v[220:223], v[252:255], a[236:239]
s_add_u32 s72, s71, 63488
buffer_load_dwordx4 v7, s[16:19], s72 offen offset:2048 lds
v_mfma_f32_16x16x32_bf16 a[232:235], v[212:215], v[252:255], a[232:235]
ds_read_b128 v[180:183], v25 offset:12288
v_lshlrev_b32 v93, 16, v50
v_mfma_f32_16x16x32_bf16 a[232:235], v[208:211], v[248:251], a[232:235]
ds_read_b128 v[184:187], v24 offset:14336
v_lshlrev_b32 v94, 16, v51
v_mfma_f32_16x16x32_bf16 a[228:231], v[200:203], v[248:251], a[228:231]
ds_read_b128 v[188:191], v25 offset:14336
v_mul_f32 v95, v75, v91
v_mfma_f32_16x16x32_bf16 a[228:231], v[204:207], v[252:255], a[228:231]
v_lshlrev_b32 v97, 16, v67
v_fmac_f32 v95, v74, v92
v_mfma_f32_16x16x32_bf16 a[224:227], v[196:199], v[252:255], a[224:227]
s_add_u32 s72, s71, 95232
buffer_load_dwordx4 v7, s[16:19], s72 offen offset:3072 lds
v_mfma_f32_16x16x32_bf16 a[224:227], v[192:195], v[248:251], a[224:227]
s_waitcnt lgkmcnt(8)
ds_read_b64_tr_b16 v[232:233], v21 offset:0
v_fmac_f32 v95, v73, v93
v_mfma_f32_16x16x32_bf16 a[0:3], v[224:227], v[128:131], a[0:3]
ds_read_b64_tr_b16 v[234:235], v21 offset:1024
v_fmac_f32 v95, v72, v94
v_mfma_f32_16x16x32_bf16 a[0:3], v[228:231], v[132:135], a[0:3]
ds_read_b64_tr_b16 v[240:241], v22 offset:0
v_mul_f32 v95, v95, v97
v_mfma_f32_16x16x32_bf16 a[4:7], v[228:231], v[140:143], a[4:7]
s_add_u32 m0, s63, 102400
ds_read_b64_tr_b16 v[236:237], v21 offset:8192
v_mul_f32 v96, v75, v90
v_mfma_f32_16x16x32_bf16 a[4:7], v[224:227], v[136:139], a[4:7]
s_add_u32 s72, s69, 32768
buffer_load_dwordx4 v2, s[8:11], s72 offen lds
v_mfma_f32_16x16x32_bf16 a[8:11], v[224:227], v[144:147], a[8:11]
ds_read_b64_tr_b16 v[238:239], v21 offset:9216
v_lshlrev_b32 v97, 16, v66
v_mfma_f32_16x16x32_bf16 a[8:11], v[228:231], v[148:151], a[8:11]
v_fmac_f32 v96, v74, v91
v_fmac_f32 v96, v73, v92
v_mfma_f32_16x16x32_bf16 a[12:15], v[228:231], v[156:159], a[12:15]
s_add_u32 s72, s69, 39936
buffer_load_dwordx4 v3, s[8:11], s72 offen offset:1024 lds
v_mfma_f32_16x16x32_bf16 a[12:15], v[224:227], v[152:155], a[12:15]
s_waitcnt lgkmcnt(5)
ds_read_b64_tr_b16 v[242:243], v22 offset:1024
v_fmac_f32 v96, v72, v93
v_mfma_f32_16x16x32_bf16 a[16:19], v[224:227], v[160:163], a[16:19]
v_mul_f32 v96, v96, v97
v_cvt_pk_bf16_f32 v100, v95, v96
v_mfma_f32_16x16x32_bf16 a[16:19], v[228:231], v[164:167], a[16:19]
ds_read_b64_tr_b16 v[244:245], v22 offset:8192
v_mul_f32 v95, v75, v89
v_mfma_f32_16x16x32_bf16 a[20:23], v[228:231], v[172:175], a[20:23]
v_lshlrev_b32 v97, 16, v65
v_fmac_f32 v95, v74, v90
v_mfma_f32_16x16x32_bf16 a[20:23], v[224:227], v[168:171], a[20:23]
s_add_u32 s72, s69, 47104
buffer_load_dwordx4 v2, s[8:11], s72 offen offset:2048 lds
v_mfma_f32_16x16x32_bf16 a[24:27], v[224:227], v[176:179], a[24:27]
ds_read_b64_tr_b16 v[246:247], v22 offset:9216
v_fmac_f32 v95, v73, v91
v_mfma_f32_16x16x32_bf16 a[24:27], v[228:231], v[180:183], a[24:27]
v_fmac_f32 v95, v72, v92
v_mul_f32 v95, v95, v97
v_mfma_f32_16x16x32_bf16 a[28:31], v[228:231], v[188:191], a[28:31]
v_mul_f32 v96, v75, v88
v_lshlrev_b32 v97, 16, v64
v_mfma_f32_16x16x32_bf16 a[28:31], v[224:227], v[184:187], a[28:31]
s_waitcnt lgkmcnt(3)
v_fmac_f32 v96, v74, v89
v_fmac_f32 v96, v73, v90
v_mfma_f32_16x16x32_bf16 a[60:63], v[232:235], v[184:187], a[60:63]
s_add_u32 s72, s69, 54272
buffer_load_dwordx4 v3, s[8:11], s72 offen offset:3072 lds
v_mfma_f32_16x16x32_bf16 a[60:63], v[236:239], v[188:191], a[60:63]
ds_read_b64_tr_b16 v[248:249], v23 offset:0
v_fmac_f32 v96, v72, v91
v_mfma_f32_16x16x32_bf16 a[56:59], v[236:239], v[180:183], a[56:59]
v_mul_f32 v96, v96, v97
v_cvt_pk_bf16_f32 v101, v95, v96
v_mfma_f32_16x16x32_bf16 a[56:59], v[232:235], v[176:179], a[56:59]
s_add_u32 m0, s64, 49152
ds_read_b64_tr_b16 v[250:251], v23 offset:1024
v_mul_f32 v95, v75, v87
v_mfma_f32_16x16x32_bf16 a[52:55], v[232:235], v[168:171], a[52:55]
s_add_u32 s72, s71, 0
buffer_load_dwordx4 v6, s[20:23], s72 offen lds
v_mfma_f32_16x16x32_bf16 a[52:55], v[236:239], v[172:175], a[52:55]
v_lshlrev_b32 v97, 16, v63
v_fmac_f32 v95, v74, v88
v_mfma_f32_16x16x32_bf16 a[48:51], v[236:239], v[164:167], a[48:51]
v_fmac_f32 v95, v73, v89
v_fmac_f32 v95, v72, v90
v_mfma_f32_16x16x32_bf16 a[48:51], v[232:235], v[160:163], a[48:51]
ds_read_b64_tr_b16 v[252:253], v23 offset:8192
v_mul_f32 v95, v95, v97
v_mfma_f32_16x16x32_bf16 a[44:47], v[232:235], v[152:155], a[44:47]
s_add_u32 s72, s71, 31744
buffer_load_dwordx4 v6, s[20:23], s72 offen offset:1024 lds
v_mfma_f32_16x16x32_bf16 a[44:47], v[236:239], v[156:159], a[44:47]
v_mul_f32 v96, v75, v86
v_lshlrev_b32 v97, 16, v62
v_mfma_f32_16x16x32_bf16 a[40:43], v[236:239], v[148:151], a[40:43]
ds_read_b64_tr_b16 v[254:255], v23 offset:9216
v_fmac_f32 v96, v74, v87
v_mfma_f32_16x16x32_bf16 a[40:43], v[232:235], v[144:147], a[40:43]
v_fmac_f32 v96, v73, v88
v_fmac_f32 v96, v72, v89
v_mfma_f32_16x16x32_bf16 a[36:39], v[232:235], v[136:139], a[36:39]
s_add_u32 s72, s71, 63488
buffer_load_dwordx4 v7, s[20:23], s72 offen offset:2048 lds
v_mfma_f32_16x16x32_bf16 a[36:39], v[236:239], v[140:143], a[36:39]
v_mul_f32 v96, v96, v97
v_cvt_pk_bf16_f32 v102, v95, v96
v_mfma_f32_16x16x32_bf16 a[32:35], v[236:239], v[132:135], a[32:35]
v_mul_f32 v95, v75, v85
v_lshlrev_b32 v97, 16, v61
v_mfma_f32_16x16x32_bf16 a[32:35], v[232:235], v[128:131], a[32:35]
s_waitcnt lgkmcnt(4)
v_fmac_f32 v95, v74, v86
v_fmac_f32 v95, v73, v87
v_mfma_f32_16x16x32_bf16 a[64:67], v[240:243], v[128:131], a[64:67]
s_add_u32 s72, s71, 95232
buffer_load_dwordx4 v7, s[20:23], s72 offen offset:3072 lds
v_mfma_f32_16x16x32_bf16 a[64:67], v[244:247], v[132:135], a[64:67]
s_mov_b32 s80, 0x0
buffer_load_dword v126, v125, s[12:15], s80 offen
v_mfma_f32_16x16x32_bf16 a[68:71], v[244:247], v[140:143], a[68:71]
s_mov_b32 s80, 0x100000
buffer_load_dword v126, v125, s[12:15], s80 offen
v_mfma_f32_16x16x32_bf16 a[68:71], v[240:243], v[136:139], a[68:71]
s_mov_b32 s80, 0x200000
buffer_load_dword v126, v125, s[12:15], s80 offen
v_mfma_f32_16x16x32_bf16 a[72:75], v[240:243], v[144:147], a[72:75]
s_mov_b32 s80, 0x300000
buffer_load_dword v126, v125, s[12:15], s80 offen
v_mfma_f32_16x16x32_bf16 a[72:75], v[244:247], v[148:151], a[72:75]
ds_read_b64_tr_b16 v[224:225], v20 offset:16384
v_fmac_f32 v95, v72, v88
v_mfma_f32_16x16x32_bf16 a[76:79], v[244:247], v[156:159], a[76:79]
v_mul_f32 v95, v95, v97
v_mul_f32 v96, v75, v84
v_mfma_f32_16x16x32_bf16 a[76:79], v[240:243], v[152:155], a[76:79]
ds_read_b64_tr_b16 v[226:227], v20 offset:17408
v_lshlrev_b32 v97, 16, v60
v_mfma_f32_16x16x32_bf16 a[80:83], v[240:243], v[160:163], a[80:83]
v_fmac_f32 v96, v74, v85
v_fmac_f32 v96, v73, v86
v_mfma_f32_16x16x32_bf16 a[80:83], v[244:247], v[164:167], a[80:83]
ds_read_b64_tr_b16 v[228:229], v20 offset:24576
v_fmac_f32 v96, v72, v87
v_mfma_f32_16x16x32_bf16 a[84:87], v[244:247], v[172:175], a[84:87]
v_mul_f32 v96, v96, v97
v_cvt_pk_bf16_f32 v103, v95, v96
v_mfma_f32_16x16x32_bf16 a[84:87], v[240:243], v[168:171], a[84:87]
ds_read_b64_tr_b16 v[230:231], v20 offset:25600
ds_write_b128 v28, v[100:103] offset:0
v_mfma_f32_16x16x32_bf16 a[88:91], v[240:243], v[176:179], a[88:91]
v_mul_f32 v95, v75, v83
v_lshlrev_b32 v97, 16, v59
v_mfma_f32_16x16x32_bf16 a[88:91], v[244:247], v[180:183], a[88:91]
v_fmac_f32 v95, v74, v84
v_fmac_f32 v95, v73, v85
v_mfma_f32_16x16x32_bf16 a[92:95], v[244:247], v[188:191], a[92:95]
v_fmac_f32 v95, v72, v86
v_mul_f32 v95, v95, v97
v_mfma_f32_16x16x32_bf16 a[92:95], v[240:243], v[184:187], a[92:95]
s_waitcnt lgkmcnt(5)
v_mul_f32 v96, v75, v82
v_lshlrev_b32 v97, 16, v58
v_mfma_f32_16x16x32_bf16 a[124:127], v[248:251], v[184:187], a[124:127]
ds_read_b64_tr_b16 v[232:233], v21 offset:16384
v_fmac_f32 v96, v74, v83
v_mfma_f32_16x16x32_bf16 a[124:127], v[252:255], v[188:191], a[124:127]
v_fmac_f32 v96, v73, v84
v_fmac_f32 v96, v72, v85
v_mfma_f32_16x16x32_bf16 a[120:123], v[252:255], v[180:183], a[120:123]
v_mul_f32 v96, v96, v97
v_cvt_pk_bf16_f32 v104, v95, v96
v_mfma_f32_16x16x32_bf16 a[120:123], v[248:251], v[176:179], a[120:123]
ds_read_b64_tr_b16 v[234:235], v21 offset:17408
v_mul_f32 v95, v75, v81
v_mfma_f32_16x16x32_bf16 a[116:119], v[248:251], v[168:171], a[116:119]
v_lshlrev_b32 v97, 16, v57
v_fmac_f32 v95, v74, v82
v_mfma_f32_16x16x32_bf16 a[116:119], v[252:255], v[172:175], a[116:119]
v_fmac_f32 v95, v73, v83
v_fmac_f32 v95, v72, v84
v_mfma_f32_16x16x32_bf16 a[112:115], v[252:255], v[164:167], a[112:115]
v_mul_f32 v95, v95, v97
v_mul_f32 v96, v75, v80
v_mfma_f32_16x16x32_bf16 a[112:115], v[248:251], v[160:163], a[112:115]
ds_read_b64_tr_b16 v[236:237], v21 offset:24576
v_lshlrev_b32 v97, 16, v56
v_mfma_f32_16x16x32_bf16 a[108:111], v[248:251], v[152:155], a[108:111]
v_fmac_f32 v96, v74, v81
v_fmac_f32 v96, v73, v82
v_mfma_f32_16x16x32_bf16 a[108:111], v[252:255], v[156:159], a[108:111]
v_fmac_f32 v96, v72, v83
v_mul_f32 v96, v96, v97
v_mfma_f32_16x16x32_bf16 a[104:107], v[252:255], v[148:151], a[104:107]
ds_read_b64_tr_b16 v[238:239], v21 offset:25600
v_cvt_pk_bf16_f32 v105, v95, v96
v_mfma_f32_16x16x32_bf16 a[104:107], v[248:251], v[144:147], a[104:107]
v_mul_f32 v95, v75, v79
v_lshlrev_b32 v97, 16, v55
v_mfma_f32_16x16x32_bf16 a[100:103], v[248:251], v[136:139], a[100:103]
v_fmac_f32 v95, v74, v80
v_fmac_f32 v95, v73, v81
v_mfma_f32_16x16x32_bf16 a[100:103], v[252:255], v[140:143], a[100:103]
v_fmac_f32 v95, v72, v82
v_mul_f32 v95, v95, v97
v_mfma_f32_16x16x32_bf16 a[96:99], v[252:255], v[132:135], a[96:99]
v_mul_f32 v96, v75, v78
v_lshlrev_b32 v97, 16, v54
v_mfma_f32_16x16x32_bf16 a[96:99], v[248:251], v[128:131], a[96:99]
s_waitcnt lgkmcnt(5)
v_fmac_f32 v96, v74, v79
v_fmac_f32 v96, v73, v80
v_mfma_f32_16x16x32_bf16 a[128:131], v[128:131], v[224:227], a[128:131]
ds_read_b64_tr_b16 v[240:241], v22 offset:16384
v_fmac_f32 v96, v72, v81
v_mfma_f32_16x16x32_bf16 a[128:131], v[132:135], v[228:231], a[128:131]
v_mul_f32 v96, v96, v97
v_cvt_pk_bf16_f32 v106, v95, v96
v_mfma_f32_16x16x32_bf16 a[132:135], v[140:143], v[228:231], a[132:135]
v_mul_f32 v95, v75, v77
v_lshlrev_b32 v97, 16, v53
v_mfma_f32_16x16x32_bf16 a[132:135], v[136:139], v[224:227], a[132:135]
ds_read_b64_tr_b16 v[242:243], v22 offset:17408
v_fmac_f32 v95, v74, v78
v_mfma_f32_16x16x32_bf16 a[136:139], v[144:147], v[224:227], a[136:139]
v_fmac_f32 v95, v73, v79
v_fmac_f32 v95, v72, v80
v_mfma_f32_16x16x32_bf16 a[136:139], v[148:151], v[228:231], a[136:139]
v_mul_f32 v95, v95, v97
v_mul_f32 v96, v75, v76
v_mfma_f32_16x16x32_bf16 a[140:143], v[156:159], v[228:231], a[140:143]
v_lshlrev_b32 v97, 16, v52
v_fmac_f32 v96, v74, v77
v_mfma_f32_16x16x32_bf16 a[140:143], v[152:155], v[224:227], a[140:143]
ds_read_b64_tr_b16 v[244:245], v22 offset:24576
v_fmac_f32 v96, v73, v78
v_mfma_f32_16x16x32_bf16 a[144:147], v[160:163], v[224:227], a[144:147]
v_fmac_f32 v96, v72, v79
v_mul_f32 v96, v96, v97
v_mfma_f32_16x16x32_bf16 a[144:147], v[164:167], v[228:231], a[144:147]
v_cvt_pk_bf16_f32 v107, v95, v96
v_mfma_f32_16x16x32_bf16 a[148:151], v[172:175], v[228:231], a[148:151]
ds_read_b64_tr_b16 v[246:247], v22 offset:25600
ds_write_b128 v28, v[104:107] offset:16
v_mfma_f32_16x16x32_bf16 a[148:151], v[168:171], v[224:227], a[148:151]
global_load_dwordx4 v[84:87], v1, s[56:57]
v_mfma_f32_16x16x32_bf16 a[152:155], v[176:179], v[224:227], a[152:155]
global_load_dwordx4 v[88:91], v1, s[56:57] offset:1024
v_mfma_f32_16x16x32_bf16 a[152:155], v[180:183], v[228:231], a[152:155]
v_lshlrev_b32 v72, 16, v70
v_and_b32 v73, 0xffff0000, v70
v_mfma_f32_16x16x32_bf16 a[156:159], v[188:191], v[228:231], a[156:159]
v_lshlrev_b32 v74, 16, v71
v_and_b32 v75, 0xffff0000, v71
v_mfma_f32_16x16x32_bf16 a[156:159], v[184:187], v[224:227], a[156:159]
s_waitcnt lgkmcnt(5)
v_and_b32 v33, 0xffff0000, v33
v_and_b32 v34, 0xffff0000, v34
v_mfma_f32_16x16x32_bf16 a[188:191], v[184:187], v[232:235], a[188:191]
ds_read_b64_tr_b16 v[248:249], v23 offset:16384
v_and_b32 v35, 0xffff0000, v35
v_mfma_f32_16x16x32_bf16 a[188:191], v[188:191], v[236:239], a[188:191]
v_and_b32 v36, 0xffff0000, v36
v_and_b32 v37, 0xffff0000, v37
v_mfma_f32_16x16x32_bf16 a[184:187], v[180:183], v[236:239], a[184:187]
ds_read_b64_tr_b16 v[250:251], v23 offset:17408
v_and_b32 v38, 0xffff0000, v38
v_mfma_f32_16x16x32_bf16 a[184:187], v[176:179], v[232:235], a[184:187]
v_and_b32 v39, 0xffff0000, v39
v_and_b32 v40, 0xffff0000, v40
v_mfma_f32_16x16x32_bf16 a[180:183], v[168:171], v[232:235], a[180:183]
ds_read_b64_tr_b16 v[252:253], v23 offset:24576
v_and_b32 v41, 0xffff0000, v41
v_mfma_f32_16x16x32_bf16 a[180:183], v[172:175], v[236:239], a[180:183]
v_and_b32 v42, 0xffff0000, v42
v_and_b32 v43, 0xffff0000, v43
v_mfma_f32_16x16x32_bf16 a[176:179], v[164:167], v[236:239], a[176:179]
ds_read_b64_tr_b16 v[254:255], v23 offset:25600
v_and_b32 v44, 0xffff0000, v44
v_mfma_f32_16x16x32_bf16 a[176:179], v[160:163], v[232:235], a[176:179]
v_and_b32 v45, 0xffff0000, v45
v_and_b32 v46, 0xffff0000, v46
v_mfma_f32_16x16x32_bf16 a[172:175], v[152:155], v[232:235], a[172:175]
v_and_b32 v47, 0xffff0000, v47
v_and_b32 v48, 0xffff0000, v48
v_mfma_f32_16x16x32_bf16 a[172:175], v[156:159], v[236:239], a[172:175]
v_and_b32 v49, 0xffff0000, v49
v_and_b32 v50, 0xffff0000, v50
v_mfma_f32_16x16x32_bf16 a[168:171], v[148:151], v[236:239], a[168:171]
v_and_b32 v51, 0xffff0000, v51
v_mul_f32 v95, v75, v48
v_mfma_f32_16x16x32_bf16 a[168:171], v[144:147], v[232:235], a[168:171]
v_and_b32 v97, 0xffff0000, v67
v_fmac_f32 v95, v74, v49
v_mfma_f32_16x16x32_bf16 a[164:167], v[136:139], v[232:235], a[164:167]
v_fmac_f32 v95, v73, v50
v_fmac_f32 v95, v72, v51
v_mfma_f32_16x16x32_bf16 a[164:167], v[140:143], v[236:239], a[164:167]
v_mul_f32 v95, v95, v97
v_mul_f32 v96, v75, v47
v_mfma_f32_16x16x32_bf16 a[160:163], v[132:135], v[236:239], a[160:163]
s_waitcnt vmcnt(6) lgkmcnt(0)
v_and_b32 v97, 0xffff0000, v66
v_fmac_f32 v96, v74, v48
v_mfma_f32_16x16x32_bf16 a[160:163], v[128:131], v[232:235], a[160:163]
s_barrier
v_fmac_f32 v96, v73, v49
v_fmac_f32 v96, v72, v50
v_mfma_f32_16x16x32_bf16 a[192:195], v[128:131], v[240:243], a[192:195]
s_and_b32 s73, s65, 1
ds_read_b64_tr_b16 v[224:225], v20 offset:32768
v_mul_f32 v96, v96, v97
v_mfma_f32_16x16x32_bf16 a[192:195], v[132:135], v[244:247], a[192:195]
s_xor_b32 s73, s73, 6
ds_read_b64_tr_b16 v[226:227], v20 offset:33792
v_cvt_pk_bf16_f32 v100, v95, v96
v_mfma_f32_16x16x32_bf16 a[196:199], v[140:143], v[244:247], a[196:199]
s_lshl_b32 s69, s73, 7
ds_read_b64_tr_b16 v[228:229], v20 offset:40960
v_mul_f32 v95, v75, v46
v_mfma_f32_16x16x32_bf16 a[196:199], v[136:139], v[240:243], a[196:199]
s_add_u32 s69, s69, s84
ds_read_b64_tr_b16 v[230:231], v20 offset:41984
v_and_b32 v97, 0xffff0000, v65
v_mfma_f32_16x16x32_bf16 a[200:203], v[144:147], v[240:243], a[200:203]
s_lshl_b32 s71, s73, 19
ds_read_b128 v[192:195], v24 offset:32768
v_fmac_f32 v95, v74, v47
v_mfma_f32_16x16x32_bf16 a[200:203], v[148:151], v[244:247], a[200:203]
s_add_u32 s71, s71, s66
ds_read_b128 v[196:199], v25 offset:32768
v_fmac_f32 v95, v73, v48
v_mfma_f32_16x16x32_bf16 a[204:207], v[156:159], v[244:247], a[204:207]
s_add_u32 m0, s63, 65536
v_fmac_f32 v95, v72, v49
v_mul_f32 v95, v95, v97
v_mfma_f32_16x16x32_bf16 a[204:207], v[152:155], v[240:243], a[204:207]
s_add_u32 s72, s69, 0
buffer_load_dwordx4 v2, s[8:11], s72 offen lds
v_mfma_f32_16x16x32_bf16 a[208:211], v[160:163], v[240:243], a[208:211]
s_add_u32 s72, s69, 7168
buffer_load_dwordx4 v3, s[8:11], s72 offen offset:1024 lds
v_mfma_f32_16x16x32_bf16 a[208:211], v[164:167], v[244:247], a[208:211]
s_add_u32 s72, s69, 14336
buffer_load_dwordx4 v2, s[8:11], s72 offen offset:2048 lds
v_mfma_f32_16x16x32_bf16 a[212:215], v[172:175], v[244:247], a[212:215]
ds_read_b128 v[200:203], v24 offset:34816
v_mul_f32 v96, v75, v45
v_mfma_f32_16x16x32_bf16 a[212:215], v[168:171], v[240:243], a[212:215]
ds_read_b128 v[204:207], v25 offset:34816
v_and_b32 v97, 0xffff0000, v64
v_mfma_f32_16x16x32_bf16 a[216:219], v[176:179], v[240:243], a[216:219]
s_add_u32 s72, s69, 21504
buffer_load_dwordx4 v3, s[8:11], s72 offen offset:3072 lds
v_mfma_f32_16x16x32_bf16 a[216:219], v[180:183], v[244:247], a[216:219]
ds_read_b128 v[208:211], v24 offset:36864
v_fmac_f32 v96, v74, v46
v_mfma_f32_16x16x32_bf16 a[220:223], v[188:191], v[244:247], a[220:223]
ds_read_b128 v[212:215], v25 offset:36864
v_fmac_f32 v96, v73, v47
v_mfma_f32_16x16x32_bf16 a[220:223], v[184:187], v[240:243], a[220:223]
ds_read_b128 v[216:219], v24 offset:38912
v_fmac_f32 v96, v72, v48
v_mfma_f32_16x16x32_bf16 a[252:255], v[184:187], v[248:251], a[252:255]
ds_read_b128 v[220:223], v25 offset:38912
v_mul_f32 v96, v96, v97
v_mfma_f32_16x16x32_bf16 a[252:255], v[188:191], v[252:255], a[252:255]
s_add_u32 m0, s64, 0
v_cvt_pk_bf16_f32 v101, v95, v96
v_mul_f32 v95, v75, v44
v_mfma_f32_16x16x32_bf16 a[248:251], v[180:183], v[252:255], a[248:251]
s_add_u32 s72, s71, 0
buffer_load_dwordx4 v6, s[16:19], s72 offen lds
v_mfma_f32_16x16x32_bf16 a[248:251], v[176:179], v[248:251], a[248:251]
ds_read_b128 v[184:187], v24 offset:40960
v_and_b32 v97, 0xffff0000, v63
v_mfma_f32_16x16x32_bf16 a[244:247], v[168:171], v[248:251], a[244:247]
ds_read_b128 v[188:191], v25 offset:40960
v_fmac_f32 v95, v74, v45
v_mfma_f32_16x16x32_bf16 a[244:247], v[172:175], v[252:255], a[244:247]
s_add_u32 s72, s71, 31744
buffer_load_dwordx4 v6, s[16:19], s72 offen offset:1024 lds
v_mfma_f32_16x16x32_bf16 a[240:243], v[164:167], v[252:255], a[240:243]
ds_read_b128 v[176:179], v24 offset:43008
v_fmac_f32 v95, v73, v46
v_mfma_f32_16x16x32_bf16 a[240:243], v[160:163], v[248:251], a[240:243]
ds_read_b128 v[180:183], v25 offset:43008
v_fmac_f32 v95, v72, v47
v_mfma_f32_16x16x32_bf16 a[236:239], v[152:155], v[248:251], a[236:239]
ds_read_b128 v[168:171], v24 offset:45056
v_mul_f32 v95, v95, v97
v_mfma_f32_16x16x32_bf16 a[236:239], v[156:159], v[252:255], a[236:239]
s_add_u32 s72, s71, 63488
buffer_load_dwordx4 v7, s[16:19], s72 offen offset:2048 lds
v_mfma_f32_16x16x32_bf16 a[232:235], v[148:151], v[252:255], a[232:235]
ds_read_b128 v[172:175], v25 offset:45056
v_mul_f32 v96, v75, v43
v_mfma_f32_16x16x32_bf16 a[232:235], v[144:147], v[248:251], a[232:235]
ds_read_b128 v[160:163], v24 offset:47104
v_and_b32 v97, 0xffff0000, v62
v_mfma_f32_16x16x32_bf16 a[228:231], v[136:139], v[248:251], a[228:231]
ds_read_b128 v[164:167], v25 offset:47104
v_fmac_f32 v96, v74, v44
v_mfma_f32_16x16x32_bf16 a[228:231], v[140:143], v[252:255], a[228:231]
v_fmac_f32 v96, v73, v45
v_fmac_f32 v96, v72, v46
v_mfma_f32_16x16x32_bf16 a[224:227], v[132:135], v[252:255], a[224:227]
s_add_u32 s72, s71, 95232
buffer_load_dwordx4 v7, s[16:19], s72 offen offset:3072 lds
v_mfma_f32_16x16x32_bf16 a[224:227], v[128:131], v[248:251], a[224:227]
s_waitcnt lgkmcnt(8)
ds_read_b64_tr_b16 v[232:233], v21 offset:32768
v_mul_f32 v96, v96, v97
v_mfma_f32_16x16x32_bf16 a[0:3], v[224:227], v[192:195], a[0:3]
ds_read_b64_tr_b16 v[234:235], v21 offset:33792
v_cvt_pk_bf16_f32 v102, v95, v96
v_mfma_f32_16x16x32_bf16 a[0:3], v[228:231], v[196:199], a[0:3]
ds_read_b64_tr_b16 v[240:241], v22 offset:32768
v_mul_f32 v95, v75, v42
v_mfma_f32_16x16x32_bf16 a[4:7], v[228:231], v[204:207], a[4:7]
s_add_u32 m0, s63, 69632
ds_read_b64_tr_b16 v[236:237], v21 offset:40960
v_and_b32 v97, 0xffff0000, v61
v_mfma_f32_16x16x32_bf16 a[4:7], v[224:227], v[200:203], a[4:7]
s_add_u32 s72, s69, 32768
buffer_load_dwordx4 v2, s[8:11], s72 offen lds
v_mfma_f32_16x16x32_bf16 a[8:11], v[224:227], v[208:211], a[8:11]
ds_read_b64_tr_b16 v[238:239], v21 offset:41984
v_fmac_f32 v95, v74, v43
v_mfma_f32_16x16x32_bf16 a[8:11], v[228:231], v[212:215], a[8:11]
v_fmac_f32 v95, v73, v44
v_fmac_f32 v95, v72, v45
v_mfma_f32_16x16x32_bf16 a[12:15], v[228:231], v[220:223], a[12:15]
s_add_u32 s72, s69, 39936
buffer_load_dwordx4 v3, s[8:11], s72 offen offset:1024 lds
v_mfma_f32_16x16x32_bf16 a[12:15], v[224:227], v[216:219], a[12:15]
s_waitcnt lgkmcnt(5)
ds_read_b64_tr_b16 v[242:243], v22 offset:33792
v_mul_f32 v95, v95, v97
v_mfma_f32_16x16x32_bf16 a[16:19], v[224:227], v[184:187], a[16:19]
v_mul_f32 v96, v75, v41
v_and_b32 v97, 0xffff0000, v60
v_mfma_f32_16x16x32_bf16 a[16:19], v[228:231], v[188:191], a[16:19]
ds_read_b64_tr_b16 v[244:245], v22 offset:40960
v_fmac_f32 v96, v74, v42
v_mfma_f32_16x16x32_bf16 a[20:23], v[228:231], v[180:183], a[20:23]
v_fmac_f32 v96, v73, v43
v_fmac_f32 v96, v72, v44
v_mfma_f32_16x16x32_bf16 a[20:23], v[224:227], v[176:179], a[20:23]
s_add_u32 s72, s69, 47104
buffer_load_dwordx4 v2, s[8:11], s72 offen offset:2048 lds
v_mfma_f32_16x16x32_bf16 a[24:27], v[224:227], v[168:171], a[24:27]
ds_read_b64_tr_b16 v[246:247], v22 offset:41984
v_mul_f32 v96, v96, v97
v_mfma_f32_16x16x32_bf16 a[24:27], v[228:231], v[172:175], a[24:27]
v_cvt_pk_bf16_f32 v103, v95, v96
v_mfma_f32_16x16x32_bf16 a[28:31], v[228:231], v[164:167], a[28:31]
ds_write_b128 v28, v[100:103] offset:272
v_mul_f32 v95, v75, v40
v_mfma_f32_16x16x32_bf16 a[28:31], v[224:227], v[160:163], a[28:31]
s_waitcnt lgkmcnt(4)
v_and_b32 v97, 0xffff0000, v59
v_fmac_f32 v95, v74, v41
v_mfma_f32_16x16x32_bf16 a[60:63], v[232:235], v[160:163], a[60:63]
s_add_u32 s72, s69, 54272
buffer_load_dwordx4 v3, s[8:11], s72 offen offset:3072 lds
v_mfma_f32_16x16x32_bf16 a[60:63], v[236:239], v[164:167], a[60:63]
ds_read_b64_tr_b16 v[248:249], v23 offset:32768
v_fmac_f32 v95, v73, v42
v_mfma_f32_16x16x32_bf16 a[56:59], v[236:239], v[172:175], a[56:59]
v_fmac_f32 v95, v72, v43
v_mul_f32 v95, v95, v97
v_mfma_f32_16x16x32_bf16 a[56:59], v[232:235], v[168:171], a[56:59]
s_add_u32 m0, s64, 16384
ds_read_b64_tr_b16 v[250:251], v23 offset:33792
v_mul_f32 v96, v75, v39
v_mfma_f32_16x16x32_bf16 a[52:55], v[232:235], v[176:179], a[52:55]
s_add_u32 s72, s71, 0
buffer_load_dwordx4 v6, s[20:23], s72 offen lds
v_mfma_f32_16x16x32_bf16 a[52:55], v[236:239], v[180:183], a[52:55]
v_and_b32 v97, 0xffff0000, v58
v_fmac_f32 v96, v74, v40
v_mfma_f32_16x16x32_bf16 a[48:51], v[236:239], v[188:191], a[48:51]
v_fmac_f32 v96, v73, v41
v_fmac_f32 v96, v72, v42
v_mfma_f32_16x16x32_bf16 a[48:51], v[232:235], v[184:187], a[48:51]
ds_read_b64_tr_b16 v[252:253], v23 offset:40960
v_mul_f32 v96, v96, v97
v_mfma_f32_16x16x32_bf16 a[44:47], v[232:235], v[216:219], a[44:47]
s_add_u32 s72, s71, 31744
buffer_load_dwordx4 v6, s[20:23], s72 offen offset:1024 lds
v_mfma_f32_16x16x32_bf16 a[44:47], v[236:239], v[220:223], a[44:47]
v_cvt_pk_bf16_f32 v104, v95, v96
v_mul_f32 v95, v75, v38
v_mfma_f32_16x16x32_bf16 a[40:43], v[236:239], v[212:215], a[40:43]
ds_read_b64_tr_b16 v[254:255], v23 offset:41984
v_and_b32 v97, 0xffff0000, v57
v_mfma_f32_16x16x32_bf16 a[40:43], v[232:235], v[208:211], a[40:43]
v_fmac_f32 v95, v74, v39
v_fmac_f32 v95, v73, v40
v_mfma_f32_16x16x32_bf16 a[36:39], v[232:235], v[200:203], a[36:39]
s_add_u32 s72, s71, 63488
buffer_load_dwordx4 v7, s[20:23], s72 offen offset:2048 lds
v_mfma_f32_16x16x32_bf16 a[36:39], v[236:239], v[204:207], a[36:39]
v_fmac_f32 v95, v72, v41
v_mul_f32 v95, v95, v97
v_mfma_f32_16x16x32_bf16 a[32:35], v[236:239], v[196:199], a[32:35]
v_mul_f32 v96, v75, v37
v_and_b32 v97, 0xffff0000, v56
v_mfma_f32_16x16x32_bf16 a[32:35], v[232:235], v[192:195], a[32:35]
s_waitcnt lgkmcnt(5)
v_fmac_f32 v96, v74, v38
v_fmac_f32 v96, v73, v39
v_mfma_f32_16x16x32_bf16 a[64:67], v[240:243], v[192:195], a[64:67]
s_add_u32 s72, s71, 95232
buffer_load_dwordx4 v7, s[20:23], s72 offen offset:3072 lds
v_mfma_f32_16x16x32_bf16 a[64:67], v[244:247], v[196:199], a[64:67]
s_mov_b32 s80, 0x400000
buffer_load_dword v126, v125, s[12:15], s80 offen
v_mfma_f32_16x16x32_bf16 a[68:71], v[244:247], v[204:207], a[68:71]
s_mov_b32 s80, 0x500000
buffer_load_dword v126, v125, s[12:15], s80 offen
v_mfma_f32_16x16x32_bf16 a[68:71], v[240:243], v[200:203], a[68:71]
s_mov_b32 s80, 0x600000
buffer_load_dword v126, v125, s[12:15], s80 offen
v_mfma_f32_16x16x32_bf16 a[72:75], v[240:243], v[208:211], a[72:75]
s_mov_b32 s80, 0x700000
buffer_load_dword v126, v125, s[12:15], s80 offen
v_mfma_f32_16x16x32_bf16 a[72:75], v[244:247], v[212:215], a[72:75]
ds_read_b64_tr_b16 v[224:225], v20 offset:49152
v_fmac_f32 v96, v72, v40
v_mfma_f32_16x16x32_bf16 a[76:79], v[244:247], v[220:223], a[76:79]
v_mul_f32 v96, v96, v97
v_cvt_pk_bf16_f32 v105, v95, v96
v_mfma_f32_16x16x32_bf16 a[76:79], v[240:243], v[216:219], a[76:79]
ds_read_b64_tr_b16 v[226:227], v20 offset:50176
v_mul_f32 v95, v75, v36
v_mfma_f32_16x16x32_bf16 a[80:83], v[240:243], v[184:187], a[80:83]
v_and_b32 v97, 0xffff0000, v55
v_fmac_f32 v95, v74, v37
v_mfma_f32_16x16x32_bf16 a[80:83], v[244:247], v[188:191], a[80:83]
ds_read_b64_tr_b16 v[228:229], v20 offset:57344
v_fmac_f32 v95, v73, v38
v_mfma_f32_16x16x32_bf16 a[84:87], v[244:247], v[180:183], a[84:87]
v_fmac_f32 v95, v72, v39
v_mul_f32 v95, v95, v97
v_mfma_f32_16x16x32_bf16 a[84:87], v[240:243], v[176:179], a[84:87]
ds_read_b64_tr_b16 v[230:231], v20 offset:58368
v_mul_f32 v96, v75, v35
v_mfma_f32_16x16x32_bf16 a[88:91], v[240:243], v[168:171], a[88:91]
v_and_b32 v97, 0xffff0000, v54
v_fmac_f32 v96, v74, v36
v_mfma_f32_16x16x32_bf16 a[88:91], v[244:247], v[172:175], a[88:91]
v_fmac_f32 v96, v73, v37
v_fmac_f32 v96, v72, v38
v_mfma_f32_16x16x32_bf16 a[92:95], v[244:247], v[164:167], a[92:95]
v_mul_f32 v96, v96, v97
v_cvt_pk_bf16_f32 v106, v95, v96
v_mfma_f32_16x16x32_bf16 a[92:95], v[240:243], v[160:163], a[92:95]
s_waitcnt lgkmcnt(4)
v_mul_f32 v95, v75, v34
v_and_b32 v97, 0xffff0000, v53
v_mfma_f32_16x16x32_bf16 a[124:127], v[248:251], v[160:163], a[124:127]
ds_read_b64_tr_b16 v[232:233], v21 offset:49152
v_fmac_f32 v95, v74, v35
v_mfma_f32_16x16x32_bf16 a[124:127], v[252:255], v[164:167], a[124:127]
v_fmac_f32 v95, v73, v36
v_fmac_f32 v95, v72, v37
v_mfma_f32_16x16x32_bf16 a[120:123], v[252:255], v[172:175], a[120:123]
v_mul_f32 v95, v95, v97
v_mul_f32 v96, v75, v33
v_mfma_f32_16x16x32_bf16 a[120:123], v[248:251], v[168:171], a[120:123]
ds_read_b64_tr_b16 v[234:235], v21 offset:50176
v_and_b32 v97, 0xffff0000, v52
v_mfma_f32_16x16x32_bf16 a[116:119], v[248:251], v[176:179], a[116:119]
v_fmac_f32 v96, v74, v34
v_fmac_f32 v96, v73, v35
v_mfma_f32_16x16x32_bf16 a[116:119], v[252:255], v[180:183], a[116:119]
v_fmac_f32 v96, v72, v36
v_mul_f32 v96, v96, v97
v_mfma_f32_16x16x32_bf16 a[112:115], v[252:255], v[188:191], a[112:115]
v_cvt_pk_bf16_f32 v107, v95, v96
v_mfma_f32_16x16x32_bf16 a[112:115], v[248:251], v[184:187], a[112:115]
ds_read_b64_tr_b16 v[236:237], v21 offset:57344
ds_write_b128 v28, v[104:107] offset:288
v_mfma_f32_16x16x32_bf16 a[108:111], v[248:251], v[216:219], a[108:111]
v_mfma_f32_16x16x32_bf16 a[108:111], v[252:255], v[220:223], a[108:111]
v_mfma_f32_16x16x32_bf16 a[104:107], v[252:255], v[212:215], a[104:107]
ds_read_b64_tr_b16 v[238:239], v21 offset:58368
v_mfma_f32_16x16x32_bf16 a[104:107], v[248:251], v[208:211], a[104:107]
v_mfma_f32_16x16x32_bf16 a[100:103], v[248:251], v[200:203], a[100:103]
v_mfma_f32_16x16x32_bf16 a[100:103], v[252:255], v[204:207], a[100:103]
v_mfma_f32_16x16x32_bf16 a[96:99], v[252:255], v[196:199], a[96:99]
v_mfma_f32_16x16x32_bf16 a[96:99], v[248:251], v[192:195], a[96:99]
s_waitcnt lgkmcnt(5)
v_mfma_f32_16x16x32_bf16 a[128:131], v[192:195], v[224:227], a[128:131]
ds_read_b64_tr_b16 v[240:241], v22 offset:49152
v_mfma_f32_16x16x32_bf16 a[128:131], v[196:199], v[228:231], a[128:131]
v_mfma_f32_16x16x32_bf16 a[132:135], v[204:207], v[228:231], a[132:135]
v_mfma_f32_16x16x32_bf16 a[132:135], v[200:203], v[224:227], a[132:135]
ds_read_b64_tr_b16 v[242:243], v22 offset:50176
v_mfma_f32_16x16x32_bf16 a[136:139], v[208:211], v[224:227], a[136:139]
v_mfma_f32_16x16x32_bf16 a[136:139], v[212:215], v[228:231], a[136:139]
v_mfma_f32_16x16x32_bf16 a[140:143], v[220:223], v[228:231], a[140:143]
v_mfma_f32_16x16x32_bf16 a[140:143], v[216:219], v[224:227], a[140:143]
ds_read_b64_tr_b16 v[244:245], v22 offset:57344
v_mfma_f32_16x16x32_bf16 a[144:147], v[184:187], v[224:227], a[144:147]
v_mfma_f32_16x16x32_bf16 a[144:147], v[188:191], v[228:231], a[144:147]
v_mfma_f32_16x16x32_bf16 a[148:151], v[180:183], v[228:231], a[148:151]
ds_read_b64_tr_b16 v[246:247], v22 offset:58368
v_mfma_f32_16x16x32_bf16 a[148:151], v[176:179], v[224:227], a[148:151]
v_mfma_f32_16x16x32_bf16 a[152:155], v[168:171], v[224:227], a[152:155]
v_mfma_f32_16x16x32_bf16 a[152:155], v[172:175], v[228:231], a[152:155]
v_mfma_f32_16x16x32_bf16 a[156:159], v[164:167], v[228:231], a[156:159]
v_mfma_f32_16x16x32_bf16 a[156:159], v[160:163], v[224:227], a[156:159]
s_waitcnt lgkmcnt(4)
v_mfma_f32_16x16x32_bf16 a[188:191], v[160:163], v[232:235], a[188:191]
ds_read_b64_tr_b16 v[248:249], v23 offset:49152
v_mfma_f32_16x16x32_bf16 a[188:191], v[164:167], v[236:239], a[188:191]
v_mfma_f32_16x16x32_bf16 a[184:187], v[172:175], v[236:239], a[184:187]
ds_read_b64_tr_b16 v[250:251], v23 offset:50176
v_mfma_f32_16x16x32_bf16 a[184:187], v[168:171], v[232:235], a[184:187]
v_mfma_f32_16x16x32_bf16 a[180:183], v[176:179], v[232:235], a[180:183]
ds_read_b64_tr_b16 v[252:253], v23 offset:57344
v_mfma_f32_16x16x32_bf16 a[180:183], v[180:183], v[236:239], a[180:183]
v_mfma_f32_16x16x32_bf16 a[176:179], v[188:191], v[236:239], a[176:179]
ds_read_b64_tr_b16 v[254:255], v23 offset:58368
v_mfma_f32_16x16x32_bf16 a[176:179], v[184:187], v[232:235], a[176:179]
v_mfma_f32_16x16x32_bf16 a[172:175], v[216:219], v[232:235], a[172:175]
v_mfma_f32_16x16x32_bf16 a[172:175], v[220:223], v[236:239], a[172:175]
v_mfma_f32_16x16x32_bf16 a[168:171], v[212:215], v[236:239], a[168:171]
v_mfma_f32_16x16x32_bf16 a[168:171], v[208:211], v[232:235], a[168:171]
v_mfma_f32_16x16x32_bf16 a[164:167], v[200:203], v[232:235], a[164:167]
v_mfma_f32_16x16x32_bf16 a[164:167], v[204:207], v[236:239], a[164:167]
v_mfma_f32_16x16x32_bf16 a[160:163], v[196:199], v[236:239], a[160:163]
s_waitcnt vmcnt(4) lgkmcnt(0)
v_mfma_f32_16x16x32_bf16 a[160:163], v[192:195], v[232:235], a[160:163]
s_barrier
v_mfma_f32_16x16x32_bf16 a[192:195], v[192:195], v[240:243], a[192:195]
s_and_b32 s73, s65, 1
ds_read_b64_tr_b16 v[224:225], v20 offset:0
v_mfma_f32_16x16x32_bf16 a[192:195], v[196:199], v[244:247], a[192:195]
s_xor_b32 s73, s73, 7
ds_read_b64_tr_b16 v[226:227], v20 offset:1024
v_mfma_f32_16x16x32_bf16 a[196:199], v[204:207], v[244:247], a[196:199]
s_lshl_b32 s69, s73, 7
ds_read_b64_tr_b16 v[228:229], v20 offset:8192
v_mfma_f32_16x16x32_bf16 a[196:199], v[200:203], v[240:243], a[196:199]
s_add_u32 s69, s69, s84
ds_read_b64_tr_b16 v[230:231], v20 offset:9216
v_mfma_f32_16x16x32_bf16 a[200:203], v[208:211], v[240:243], a[200:203]
s_lshl_b32 s71, s73, 19
ds_read_b128 v[128:131], v24 offset:0
v_mfma_f32_16x16x32_bf16 a[200:203], v[212:215], v[244:247], a[200:203]
s_add_u32 s71, s71, s66
ds_read_b128 v[132:135], v25 offset:0
v_mfma_f32_16x16x32_bf16 a[204:207], v[220:223], v[244:247], a[204:207]
s_add_u32 m0, s63, 98304
v_mfma_f32_16x16x32_bf16 a[204:207], v[216:219], v[240:243], a[204:207]
s_add_u32 s72, s69, 0
buffer_load_dwordx4 v2, s[8:11], s72 offen lds
v_mfma_f32_16x16x32_bf16 a[208:211], v[184:187], v[240:243], a[208:211]
s_add_u32 s72, s69, 7168
buffer_load_dwordx4 v3, s[8:11], s72 offen offset:1024 lds
v_mfma_f32_16x16x32_bf16 a[208:211], v[188:191], v[244:247], a[208:211]
s_add_u32 s72, s69, 14336
buffer_load_dwordx4 v2, s[8:11], s72 offen offset:2048 lds
v_mfma_f32_16x16x32_bf16 a[212:215], v[180:183], v[244:247], a[212:215]
s_add_u32 s74, s63, 131072
ds_read_b128 v[136:139], v24 offset:2048
v_lshrrev_b32 v26, 4, v0
v_mfma_f32_16x16x32_bf16 a[212:215], v[176:179], v[240:243], a[212:215]
ds_read_b128 v[140:143], v25 offset:2048
v_and_b32 v27, 15, v0
v_mfma_f32_16x16x32_bf16 a[216:219], v[168:171], v[240:243], a[216:219]
s_add_u32 s72, s69, 21504
buffer_load_dwordx4 v3, s[8:11], s72 offen offset:3072 lds
v_mfma_f32_16x16x32_bf16 a[216:219], v[172:175], v[244:247], a[216:219]
ds_read_b128 v[144:147], v24 offset:4096
v_lshlrev_b32 v27, 4, v27
v_mfma_f32_16x16x32_bf16 a[220:223], v[164:167], v[244:247], a[220:223]
ds_read_b128 v[148:151], v25 offset:4096
v_mul_u32_u24 v28, 272, v26
v_mfma_f32_16x16x32_bf16 a[220:223], v[160:163], v[240:243], a[220:223]
ds_read_b128 v[152:155], v24 offset:6144
v_add3_u32 v28, v28, v27, s74
v_mfma_f32_16x16x32_bf16 a[252:255], v[160:163], v[248:251], a[252:255]
ds_read_b128 v[156:159], v25 offset:6144
v_lshl_add_u32 v26, v26, 12, v27
v_mfma_f32_16x16x32_bf16 a[252:255], v[164:167], v[252:255], a[252:255]
s_add_u32 m0, s64, 32768
ds_read_b128 v[36:39], v28 offset:0
ds_read_b128 v[40:43], v28 offset:1088
v_mfma_f32_16x16x32_bf16 a[248:251], v[172:175], v[252:255], a[248:251]
s_add_u32 s72, s71, 0
buffer_load_dwordx4 v6, s[16:19], s72 offen lds
v_mfma_f32_16x16x32_bf16 a[248:251], v[168:171], v[248:251], a[248:251]
ds_read_b128 v[160:163], v24 offset:8192
ds_read_b128 v[44:47], v28 offset:2176
v_mfma_f32_16x16x32_bf16 a[244:247], v[176:179], v[248:251], a[244:247]
ds_read_b128 v[164:167], v25 offset:8192
ds_read_b128 v[48:51], v28 offset:3264
v_mfma_f32_16x16x32_bf16 a[244:247], v[180:183], v[252:255], a[244:247]
s_add_u32 s72, s71, 31744
buffer_load_dwordx4 v6, s[16:19], s72 offen offset:1024 lds
v_mfma_f32_16x16x32_bf16 a[240:243], v[188:191], v[252:255], a[240:243]
s_xor_b32 s74, s2, 5
ds_read_b128 v[168:171], v24 offset:10240
v_mfma_f32_16x16x32_bf16 a[240:243], v[184:187], v[248:251], a[240:243]
s_and_b32 s74, s74, 15
ds_read_b128 v[172:175], v25 offset:10240
v_mfma_f32_16x16x32_bf16 a[236:239], v[216:219], v[248:251], a[236:239]
s_lshl_b32 s74, s74, 2
ds_read_b128 v[176:179], v24 offset:12288
v_mfma_f32_16x16x32_bf16 a[236:239], v[220:223], v[252:255], a[236:239]
s_add_u32 s72, s71, 63488
buffer_load_dwordx4 v7, s[16:19], s72 offen offset:2048 lds
v_mfma_f32_16x16x32_bf16 a[232:235], v[212:215], v[252:255], a[232:235]
s_add_u32 s74, s74, s58
ds_read_b128 v[180:183], v25 offset:12288
v_mfma_f32_16x16x32_bf16 a[232:235], v[208:211], v[248:251], a[232:235]
s_lshl_b32 s74, s74, 16
ds_read_b128 v[184:187], v24 offset:14336
v_mfma_f32_16x16x32_bf16 a[228:231], v[200:203], v[248:251], a[228:231]
s_lshr_b32 s75, s2, 4
ds_read_b128 v[188:191], v25 offset:14336
v_mfma_f32_16x16x32_bf16 a[228:231], v[204:207], v[252:255], a[228:231]
s_lshl_b32 s75, s75, 8
v_mfma_f32_16x16x32_bf16 a[224:227], v[196:199], v[252:255], a[224:227]
s_add_u32 s72, s71, 95232
buffer_load_dwordx4 v7, s[16:19], s72 offen offset:3072 lds
v_mfma_f32_16x16x32_bf16 a[224:227], v[192:195], v[248:251], a[224:227]
s_waitcnt lgkmcnt(12)
ds_read_b64_tr_b16 v[232:233], v21 offset:0
v_mfma_f32_16x16x32_bf16 a[0:3], v[224:227], v[128:131], a[0:3]
s_sub_u32 s74, s74, s75
ds_read_b64_tr_b16 v[234:235], v21 offset:1024
v_mfma_f32_16x16x32_bf16 a[0:3], v[228:231], v[132:135], a[0:3]
s_add_u32 s74, s74, 0x3000f00
ds_read_b64_tr_b16 v[240:241], v22 offset:0
v_mfma_f32_16x16x32_bf16 a[4:7], v[228:231], v[140:143], a[4:7]
s_add_u32 m0, s63, 102400
ds_read_b64_tr_b16 v[236:237], v21 offset:8192
v_mfma_f32_16x16x32_bf16 a[4:7], v[224:227], v[136:139], a[4:7]
s_add_u32 s72, s69, 32768
buffer_load_dwordx4 v2, s[8:11], s72 offen lds
v_mfma_f32_16x16x32_bf16 a[8:11], v[224:227], v[144:147], a[8:11]
s_waitcnt vmcnt(29)
ds_read_b64_tr_b16 v[238:239], v21 offset:9216
v_lshlrev_b32 v78, 16, v84
v_mfma_f32_16x16x32_bf16 a[8:11], v[228:231], v[148:151], a[8:11]
v_lshlrev_b32 v79, 16, v108
v_mul_f32 v76, v78, v79
v_mfma_f32_16x16x32_bf16 a[12:15], v[228:231], v[156:159], a[12:15]
s_add_u32 s72, s69, 39936
buffer_load_dwordx4 v3, s[8:11], s72 offen offset:1024 lds
v_mfma_f32_16x16x32_bf16 a[12:15], v[224:227], v[152:155], a[12:15]
s_waitcnt lgkmcnt(5)
ds_read_b64_tr_b16 v[242:243], v22 offset:1024
v_lshlrev_b32 v80, 16, v116
v_mfma_f32_16x16x32_bf16 a[16:19], v[224:227], v[160:163], a[16:19]
v_mul_f32 v77, v78, v80
v_and_b32 v78, 0xffff0000, v84
v_mfma_f32_16x16x32_bf16 a[16:19], v[228:231], v[164:167], a[16:19]
ds_read_b64_tr_b16 v[244:245], v22 offset:8192
v_and_b32 v79, 0xffff0000, v108
v_mfma_f32_16x16x32_bf16 a[20:23], v[228:231], v[172:175], a[20:23]
v_fmac_f32 v76, v78, v79
v_and_b32 v80, 0xffff0000, v116
v_mfma_f32_16x16x32_bf16 a[20:23], v[224:227], v[168:171], a[20:23]
s_add_u32 s72, s69, 47104
buffer_load_dwordx4 v2, s[8:11], s72 offen offset:2048 lds
v_mfma_f32_16x16x32_bf16 a[24:27], v[224:227], v[176:179], a[24:27]
ds_read_b64_tr_b16 v[246:247], v22 offset:9216
v_fmac_f32 v77, v78, v80
v_mfma_f32_16x16x32_bf16 a[24:27], v[228:231], v[180:183], a[24:27]
v_lshlrev_b32 v78, 16, v85
v_lshlrev_b32 v79, 16, v109
v_mfma_f32_16x16x32_bf16 a[28:31], v[228:231], v[188:191], a[28:31]
v_fmac_f32 v76, v78, v79
v_lshlrev_b32 v80, 16, v117
v_mfma_f32_16x16x32_bf16 a[28:31], v[224:227], v[184:187], a[28:31]
s_waitcnt lgkmcnt(3)
v_fmac_f32 v77, v78, v80
v_and_b32 v78, 0xffff0000, v85
v_mfma_f32_16x16x32_bf16 a[60:63], v[232:235], v[184:187], a[60:63]
s_add_u32 s72, s69, 54272
buffer_load_dwordx4 v3, s[8:11], s72 offen offset:3072 lds
v_mfma_f32_16x16x32_bf16 a[60:63], v[236:239], v[188:191], a[60:63]
ds_read_b64_tr_b16 v[248:249], v23 offset:0
v_and_b32 v79, 0xffff0000, v109
v_mfma_f32_16x16x32_bf16 a[56:59], v[236:239], v[180:183], a[56:59]
v_fmac_f32 v76, v78, v79
v_and_b32 v80, 0xffff0000, v117
v_mfma_f32_16x16x32_bf16 a[56:59], v[232:235], v[176:179], a[56:59]
s_add_u32 m0, s64, 49152
ds_read_b64_tr_b16 v[250:251], v23 offset:1024
v_fmac_f32 v77, v78, v80
v_mfma_f32_16x16x32_bf16 a[52:55], v[232:235], v[168:171], a[52:55]
s_add_u32 s72, s71, 0
buffer_load_dwordx4 v6, s[20:23], s72 offen lds
v_mfma_f32_16x16x32_bf16 a[52:55], v[236:239], v[172:175], a[52:55]
v_lshlrev_b32 v78, 16, v86
v_lshlrev_b32 v79, 16, v110
v_mfma_f32_16x16x32_bf16 a[48:51], v[236:239], v[164:167], a[48:51]
v_fmac_f32 v76, v78, v79
v_lshlrev_b32 v80, 16, v118
v_mfma_f32_16x16x32_bf16 a[48:51], v[232:235], v[160:163], a[48:51]
ds_read_b64_tr_b16 v[252:253], v23 offset:8192
v_fmac_f32 v77, v78, v80
v_mfma_f32_16x16x32_bf16 a[44:47], v[232:235], v[152:155], a[44:47]
s_add_u32 s72, s71, 31744
buffer_load_dwordx4 v6, s[20:23], s72 offen offset:1024 lds
v_mfma_f32_16x16x32_bf16 a[44:47], v[236:239], v[156:159], a[44:47]
v_and_b32 v78, 0xffff0000, v86
v_and_b32 v79, 0xffff0000, v110
v_mfma_f32_16x16x32_bf16 a[40:43], v[236:239], v[148:151], a[40:43]
ds_read_b64_tr_b16 v[254:255], v23 offset:9216
v_fmac_f32 v76, v78, v79
v_mfma_f32_16x16x32_bf16 a[40:43], v[232:235], v[144:147], a[40:43]
v_and_b32 v80, 0xffff0000, v118
v_fmac_f32 v77, v78, v80
v_mfma_f32_16x16x32_bf16 a[36:39], v[232:235], v[136:139], a[36:39]
s_add_u32 s72, s71, 63488
buffer_load_dwordx4 v7, s[20:23], s72 offen offset:2048 lds
v_mfma_f32_16x16x32_bf16 a[36:39], v[236:239], v[140:143], a[36:39]
v_lshlrev_b32 v78, 16, v87
v_lshlrev_b32 v79, 16, v111
v_mfma_f32_16x16x32_bf16 a[32:35], v[236:239], v[132:135], a[32:35]
v_fmac_f32 v76, v78, v79
v_lshlrev_b32 v80, 16, v119
v_mfma_f32_16x16x32_bf16 a[32:35], v[232:235], v[128:131], a[32:35]
s_waitcnt lgkmcnt(4)
v_fmac_f32 v77, v78, v80
v_and_b32 v78, 0xffff0000, v87
v_mfma_f32_16x16x32_bf16 a[64:67], v[240:243], v[128:131], a[64:67]
s_add_u32 s72, s71, 95232
buffer_load_dwordx4 v7, s[20:23], s72 offen offset:3072 lds
v_mfma_f32_16x16x32_bf16 a[64:67], v[244:247], v[132:135], a[64:67]
s_waitcnt lgkmcnt(15)
ds_read_b64_tr_b16 v[224:225], v20 offset:16384
v_and_b32 v79, 0xffff0000, v111
v_mfma_f32_16x16x32_bf16 a[68:71], v[244:247], v[140:143], a[68:71]
s_add_u32 s73, s62, 0
v_fmac_f32 v76, v78, v79
v_and_b32 v80, 0xffff0000, v119
v_mfma_f32_16x16x32_bf16 a[68:71], v[240:243], v[136:139], a[68:71]
s_add_u32 s70, s73, s65
ds_read_b64_tr_b16 v[226:227], v20 offset:17408
v_fmac_f32 v77, v78, v80
v_mfma_f32_16x16x32_bf16 a[72:75], v[240:243], v[144:147], a[72:75]
s_and_b32 s70, s70, 3
v_lshlrev_b32 v78, 16, v88
v_lshlrev_b32 v79, 16, v112
v_mfma_f32_16x16x32_bf16 a[72:75], v[244:247], v[148:151], a[72:75]
s_and_b32 s73, s73, 12
v_fmac_f32 v76, v78, v79
v_lshlrev_b32 v80, 16, v120
v_mfma_f32_16x16x32_bf16 a[76:79], v[244:247], v[156:159], a[76:79]
s_or_b32 s73, s73, s70
ds_read_b64_tr_b16 v[228:229], v20 offset:24576
v_fmac_f32 v77, v78, v80
v_mfma_f32_16x16x32_bf16 a[76:79], v[240:243], v[152:155], a[76:79]
s_lshl_b32 s73, s73, 7
v_and_b32 v78, 0xffff0000, v88
v_and_b32 v79, 0xffff0000, v112
v_mfma_f32_16x16x32_bf16 a[80:83], v[240:243], v[160:163], a[80:83]
s_add_u32 s69, s73, s67
ds_read_b64_tr_b16 v[230:231], v20 offset:25600
v_fmac_f32 v76, v78, v79
v_mfma_f32_16x16x32_bf16 a[80:83], v[244:247], v[164:167], a[80:83]
s_add_u32 s70, s73, s68
v_and_b32 v80, 0xffff0000, v120
v_fmac_f32 v77, v78, v80
v_mfma_f32_16x16x32_bf16 a[84:87], v[244:247], v[172:175], a[84:87]
s_add_u32 m0, s63, 131072
v_lshlrev_b32 v78, 16, v89
v_lshlrev_b32 v79, 16, v113
v_mfma_f32_16x16x32_bf16 a[84:87], v[240:243], v[168:171], a[84:87]
s_add_u32 s72, s69, 0
buffer_load_dwordx4 v4, s[4:7], s72 offen lds
v_mfma_f32_16x16x32_bf16 a[88:91], v[240:243], v[176:179], a[88:91]
s_add_u32 s72, s69, 15360
buffer_load_dwordx4 v5, s[4:7], s72 offen offset:1024 lds
v_mfma_f32_16x16x32_bf16 a[88:91], v[244:247], v[180:183], a[88:91]
s_add_u32 s72, s69, 129024
buffer_load_dwordx4 v4, s[4:7], s72 offen offset:2048 lds
v_mfma_f32_16x16x32_bf16 a[92:95], v[244:247], v[188:191], a[92:95]
s_add_u32 s72, s69, 144384
buffer_load_dwordx4 v5, s[4:7], s72 offen offset:3072 lds
v_mfma_f32_16x16x32_bf16 a[92:95], v[240:243], v[184:187], a[92:95]
s_waitcnt lgkmcnt(4)
v_fmac_f32 v76, v78, v79
v_lshlrev_b32 v80, 16, v121
v_mfma_f32_16x16x32_bf16 a[124:127], v[248:251], v[184:187], a[124:127]
ds_read_b64_tr_b16 v[232:233], v21 offset:16384
v_fmac_f32 v77, v78, v80
v_mfma_f32_16x16x32_bf16 a[124:127], v[252:255], v[188:191], a[124:127]
v_and_b32 v78, 0xffff0000, v89
v_and_b32 v79, 0xffff0000, v113
v_mfma_f32_16x16x32_bf16 a[120:123], v[252:255], v[180:183], a[120:123]
ds_read_b64_tr_b16 v[234:235], v21 offset:17408
v_fmac_f32 v76, v78, v79
v_mfma_f32_16x16x32_bf16 a[120:123], v[248:251], v[176:179], a[120:123]
s_add_u32 m0, s63, 135168
v_and_b32 v80, 0xffff0000, v121
v_fmac_f32 v77, v78, v80
v_mfma_f32_16x16x32_bf16 a[116:119], v[248:251], v[168:171], a[116:119]
s_add_u32 s72, s70, 0
buffer_load_dwordx4 v4, s[4:7], s72 offen lds
v_mfma_f32_16x16x32_bf16 a[116:119], v[252:255], v[172:175], a[116:119]
s_lshr_b32 s75, s93, 5
ds_read_b64_tr_b16 v[236:237], v21 offset:24576
v_lshlrev_b32 v78, 16, v90
v_mfma_f32_16x16x32_bf16 a[112:115], v[252:255], v[164:167], a[112:115]
s_and_b32 s75, s75, 0x3f80
v_lshlrev_b32 v79, 16, v114
v_fmac_f32 v76, v78, v79
v_mfma_f32_16x16x32_bf16 a[112:115], v[248:251], v[160:163], a[112:115]
s_add_u32 s75, s75, LcB0-Lpc0
v_lshrrev_b32 v2, 6, v0
v_lshlrev_b32 v2, 7, v2
v_mfma_f32_16x16x32_bf16 a[108:111], v[248:251], v[152:155], a[108:111]
s_add_u32 s72, s70, 15360
buffer_load_dwordx4 v5, s[4:7], s72 offen offset:1024 lds
v_mfma_f32_16x16x32_bf16 a[108:111], v[252:255], v[156:159], a[108:111]
v_add_u32 v2, s75, v2
v_min_u32 v2, Lcode_end-Lpc0, v2
v_mfma_f32_16x16x32_bf16 a[104:107], v[252:255], v[148:151], a[104:107]
global_load_dword v3, v2, s[98:99]
v_mfma_f32_16x16x32_bf16 a[104:107], v[248:251], v[144:147], a[104:107]
ds_read_b64_tr_b16 v[238:239], v21 offset:25600
v_lshlrev_b32 v80, 16, v122
v_mfma_f32_16x16x32_bf16 a[100:103], v[248:251], v[136:139], a[100:103]
s_add_u32 s72, s70, 129024
buffer_load_dwordx4 v4, s[4:7], s72 offen offset:2048 lds
v_mfma_f32_16x16x32_bf16 a[100:103], v[252:255], v[140:143], a[100:103]
v_fmac_f32 v77, v78, v80
v_and_b32 v78, 0xffff0000, v90
v_mfma_f32_16x16x32_bf16 a[96:99], v[252:255], v[132:135], a[96:99]
v_and_b32 v79, 0xffff0000, v114
v_fmac_f32 v76, v78, v79
v_mfma_f32_16x16x32_bf16 a[96:99], v[248:251], v[128:131], a[96:99]
s_waitcnt lgkmcnt(4)
v_and_b32 v80, 0xffff0000, v122
v_fmac_f32 v77, v78, v80
v_mfma_f32_16x16x32_bf16 a[128:131], v[128:131], v[224:227], a[128:131]
ds_read_b64_tr_b16 v[240:241], v22 offset:16384
v_lshlrev_b32 v78, 16, v91
v_mfma_f32_16x16x32_bf16 a[128:131], v[132:135], v[228:231], a[128:131]
s_add_u32 s72, s70, 144384
buffer_load_dwordx4 v5, s[4:7], s72 offen offset:3072 lds
v_mfma_f32_16x16x32_bf16 a[132:135], v[140:143], v[228:231], a[132:135]
v_lshlrev_b32 v79, 16, v115
v_fmac_f32 v76, v78, v79
v_mfma_f32_16x16x32_bf16 a[132:135], v[136:139], v[224:227], a[132:135]
v_lshlrev_b32 v80, 16, v123
v_fmac_f32 v77, v78, v80
v_mfma_f32_16x16x32_bf16 a[136:139], v[144:147], v[224:227], a[136:139]
ds_read_b64_tr_b16 v[242:243], v22 offset:17408
v_and_b32 v78, 0xffff0000, v91
v_mfma_f32_16x16x32_bf16 a[136:139], v[148:151], v[228:231], a[136:139]
v_and_b32 v79, 0xffff0000, v115
v_fmac_f32 v76, v78, v79
v_mfma_f32_16x16x32_bf16 a[140:143], v[156:159], v[228:231], a[140:143]
v_and_b32 v80, 0xffff0000, v123
v_fmac_f32 v77, v78, v80
v_mfma_f32_16x16x32_bf16 a[140:143], v[152:155], v[224:227], a[140:143]
ds_read_b64_tr_b16 v[244:245], v22 offset:24576
v_add_f32_dpp v76, v76, v76 row_ror:8 row_mask:0xf bank_mask:0xf
v_mfma_f32_16x16x32_bf16 a[144:147], v[160:163], v[224:227], a[144:147]
v_add_f32_dpp v77, v77, v77 row_ror:8 row_mask:0xf bank_mask:0xf
v_add_f32_dpp v76, v76, v76 row_ror:4 row_mask:0xf bank_mask:0xf
v_mfma_f32_16x16x32_bf16 a[144:147], v[164:167], v[228:231], a[144:147]
v_add_f32_dpp v77, v77, v77 row_ror:4 row_mask:0xf bank_mask:0xf
v_add_f32_dpp v76, v76, v76 row_ror:2 row_mask:0xf bank_mask:0xf
v_mfma_f32_16x16x32_bf16 a[148:151], v[172:175], v[228:231], a[148:151]
ds_read_b64_tr_b16 v[246:247], v22 offset:25600
v_add_f32_dpp v77, v77, v77 row_ror:2 row_mask:0xf bank_mask:0xf
v_mfma_f32_16x16x32_bf16 a[148:151], v[168:171], v[224:227], a[148:151]
v_add_f32_dpp v76, v76, v76 row_ror:1 row_mask:0xf bank_mask:0xf
v_add_f32_dpp v77, v77, v77 row_ror:1 row_mask:0xf bank_mask:0xf
v_mfma_f32_16x16x32_bf16 a[152:155], v[176:179], v[224:227], a[152:155]
v_mov_b32 v78, v76
v_mov_b32 v79, v77
v_mfma_f32_16x16x32_bf16 a[152:155], v[180:183], v[228:231], a[152:155]
v_permlane16_swap_b32 v76, v78
v_permlane16_swap_b32 v77, v79
v_mfma_f32_16x16x32_bf16 a[156:159], v[188:191], v[228:231], a[156:159]
v_add_f32 v76, v76, v78
v_add_f32 v77, v77, v79
v_mfma_f32_16x16x32_bf16 a[156:159], v[184:187], v[224:227], a[156:159]
s_waitcnt lgkmcnt(4)
v_mov_b32 v78, v76
v_mov_b32 v79, v77
v_mfma_f32_16x16x32_bf16 a[188:191], v[184:187], v[232:235], a[188:191]
ds_read_b64_tr_b16 v[248:249], v23 offset:16384
v_permlane32_swap_b32 v76, v78
v_mfma_f32_16x16x32_bf16 a[188:191], v[188:191], v[236:239], a[188:191]
v_permlane32_swap_b32 v77, v79
v_add_f32 v76, v76, v78
v_mfma_f32_16x16x32_bf16 a[184:187], v[180:183], v[236:239], a[184:187]
ds_read_b64_tr_b16 v[250:251], v23 offset:17408
v_add_f32 v77, v77, v79
v_mfma_f32_16x16x32_bf16 a[184:187], v[176:179], v[232:235], a[184:187]
v_mul_f32 v76, 0xbfb8aa3b, v76
v_mul_f32 v77, 0xbfb8aa3b, v77
v_mfma_f32_16x16x32_bf16 a[180:183], v[168:171], v[232:235], a[180:183]
ds_read_b64_tr_b16 v[252:253], v23 offset:24576
v_mfma_f32_16x16x32_bf16 a[180:183], v[172:175], v[236:239], a[180:183]
v_exp_f32 v76, v76
v_mfma_f32_16x16x32_bf16 a[176:179], v[164:167], v[236:239], a[176:179]
ds_read_b64_tr_b16 v[254:255], v23 offset:25600
v_mfma_f32_16x16x32_bf16 a[176:179], v[160:163], v[232:235], a[176:179]
v_exp_f32 v77, v77
v_mfma_f32_16x16x32_bf16 a[172:175], v[152:155], v[232:235], a[172:175]
v_add_f32 v76, 1.0, v76
v_add_f32 v77, 1.0, v77
v_mfma_f32_16x16x32_bf16 a[172:175], v[156:159], v[236:239], a[172:175]
v_rcp_f32 v76, v76
v_mfma_f32_16x16x32_bf16 a[168:171], v[148:151], v[236:239], a[168:171]
v_rcp_f32 v77, v77
v_mfma_f32_16x16x32_bf16 a[168:171], v[144:147], v[232:235], a[168:171]
s_lshr_b32 s80, s76, 9
v_mfma_f32_16x16x32_bf16 a[164:167], v[136:139], v[232:235], a[164:167]
s_add_u32 s80, s80, 0x3800000
v_min_u32 v78, 1, v0
v_lshlrev_b32 v78, 30, v78
v_mfma_f32_16x16x32_bf16 a[164:167], v[140:143], v[236:239], a[164:167]
buffer_store_dwordx2 v[76:77], v78, s[44:47], s80 offen sc1
v_mfma_f32_16x16x32_bf16 a[160:163], v[132:135], v[236:239], a[160:163]
s_waitcnt vmcnt(10) lgkmcnt(0)
v_mfma_f32_16x16x32_bf16 a[160:163], v[128:131], v[232:235], a[160:163]
s_barrier
v_mfma_f32_16x16x32_bf16 a[192:195], v[128:131], v[240:243], a[192:195]
s_lshl_b32 s71, s73, 12
ds_read_b64_tr_b16 v[224:225], v20 offset:32768
v_mfma_f32_16x16x32_bf16 a[192:195], v[132:135], v[244:247], a[192:195]
s_add_u32 s71, s71, s66
ds_read_b64_tr_b16 v[226:227], v20 offset:33792
v_mfma_f32_16x16x32_bf16 a[196:199], v[140:143], v[244:247], a[196:199]
s_add_u32 m0, s64, 0
v_mov_b32 v100, v20
v_mov_b32 v101, v21
v_mfma_f32_16x16x32_bf16 a[196:199], v[136:139], v[240:243], a[196:199]
s_add_u32 s72, s71, 0
buffer_load_dwordx4 v6, s[12:15], s72 offen lds
v_mfma_f32_16x16x32_bf16 a[200:203], v[144:147], v[240:243], a[200:203]
v_mov_b32 v102, v22
v_mov_b32 v103, v23
v_mfma_f32_16x16x32_bf16 a[200:203], v[148:151], v[244:247], a[200:203]
ds_read_b64_tr_b16 v[228:229], v20 offset:40960
v_mfma_f32_16x16x32_bf16 a[204:207], v[156:159], v[244:247], a[204:207]
s_add_u32 s72, s71, 31744
buffer_load_dwordx4 v6, s[12:15], s72 offen offset:1024 lds
v_mfma_f32_16x16x32_bf16 a[204:207], v[152:155], v[240:243], a[204:207]
ds_read_b64_tr_b16 v[230:231], v20 offset:41984
v_mfma_f32_16x16x32_bf16 a[208:211], v[160:163], v[240:243], a[208:211]
s_waitcnt lgkmcnt(15)
buffer_store_dwordx4 v[36:39], v26, s[44:47], s74 offen sc1
v_mfma_f32_16x16x32_bf16 a[208:211], v[164:167], v[244:247], a[208:211]
ds_read_b128 v[192:195], v24 offset:32768
v_mfma_f32_16x16x32_bf16 a[212:215], v[172:175], v[244:247], a[212:215]
ds_read_b128 v[196:199], v25 offset:32768
v_mfma_f32_16x16x32_bf16 a[212:215], v[168:171], v[240:243], a[212:215]
ds_read_b128 v[200:203], v24 offset:34816
v_mfma_f32_16x16x32_bf16 a[216:219], v[176:179], v[240:243], a[216:219]
s_add_u32 s72, s71, 63488
buffer_load_dwordx4 v7, s[12:15], s72 offen offset:2048 lds
v_mfma_f32_16x16x32_bf16 a[216:219], v[180:183], v[244:247], a[216:219]
ds_read_b128 v[204:207], v25 offset:34816
v_mfma_f32_16x16x32_bf16 a[220:223], v[188:191], v[244:247], a[220:223]
ds_read_b128 v[208:211], v24 offset:36864
v_mfma_f32_16x16x32_bf16 a[220:223], v[184:187], v[240:243], a[220:223]
ds_read_b128 v[212:215], v25 offset:36864
v_mfma_f32_16x16x32_bf16 a[252:255], v[184:187], v[248:251], a[252:255]
ds_read_b128 v[216:219], v24 offset:38912
v_mfma_f32_16x16x32_bf16 a[252:255], v[188:191], v[252:255], a[252:255]
ds_read_b128 v[220:223], v25 offset:38912
v_mfma_f32_16x16x32_bf16 a[248:251], v[180:183], v[252:255], a[248:251]
s_add_u32 s72, s71, 95232
buffer_load_dwordx4 v7, s[12:15], s72 offen offset:3072 lds
v_mfma_f32_16x16x32_bf16 a[248:251], v[176:179], v[248:251], a[248:251]
ds_read_b128 v[184:187], v24 offset:40960
v_mfma_f32_16x16x32_bf16 a[244:247], v[168:171], v[248:251], a[244:247]
ds_read_b128 v[188:191], v25 offset:40960
v_mfma_f32_16x16x32_bf16 a[244:247], v[172:175], v[252:255], a[244:247]
ds_read_b128 v[176:179], v24 offset:43008
v_mfma_f32_16x16x32_bf16 a[240:243], v[164:167], v[252:255], a[240:243]
ds_read_b128 v[180:183], v25 offset:43008
v_mfma_f32_16x16x32_bf16 a[240:243], v[160:163], v[248:251], a[240:243]
v_mfma_f32_16x16x32_bf16 a[236:239], v[152:155], v[248:251], a[236:239]
s_add_u32 s74, s74, 0x4000
buffer_store_dwordx4 v[40:43], v26, s[44:47], s74 offen sc1
v_mfma_f32_16x16x32_bf16 a[236:239], v[156:159], v[252:255], a[236:239]
s_add_u32 s73, s62, 1
ds_read_b128 v[168:171], v24 offset:45056
v_mfma_f32_16x16x32_bf16 a[232:235], v[148:151], v[252:255], a[232:235]
s_add_u32 s70, s73, s65
ds_read_b128 v[172:175], v25 offset:45056
v_mfma_f32_16x16x32_bf16 a[232:235], v[144:147], v[248:251], a[232:235]
s_and_b32 s70, s70, 3
ds_read_b128 v[160:163], v24 offset:47104
v_mfma_f32_16x16x32_bf16 a[228:231], v[136:139], v[248:251], a[228:231]
s_and_b32 s73, s73, 12
ds_read_b128 v[164:167], v25 offset:47104
v_mfma_f32_16x16x32_bf16 a[228:231], v[140:143], v[252:255], a[228:231]
s_or_b32 s73, s73, s70
v_mfma_f32_16x16x32_bf16 a[224:227], v[132:135], v[252:255], a[224:227]
s_lshl_b32 s73, s73, 7
ds_read_b64_tr_b16 v[232:233], v101 offset:32768
v_mfma_f32_16x16x32_bf16 a[224:227], v[128:131], v[248:251], a[224:227]
s_waitcnt lgkmcnt(9)
ds_read_b64_tr_b16 v[234:235], v101 offset:33792
v_mfma_f32_16x16x32_bf16 a[0:3], v[224:227], v[192:195], a[0:3]
s_add_u32 s69, s73, s67
ds_read_b64_tr_b16 v[236:237], v101 offset:40960
v_mfma_f32_16x16x32_bf16 a[0:3], v[228:231], v[196:199], a[0:3]
s_add_u32 s70, s73, s68
ds_read_b64_tr_b16 v[238:239], v101 offset:41984
v_mfma_f32_16x16x32_bf16 a[4:7], v[228:231], v[204:207], a[4:7]
s_add_u32 m0, s63, 65536
ds_read_b64_tr_b16 v[240:241], v102 offset:32768
v_mfma_f32_16x16x32_bf16 a[4:7], v[224:227], v[200:203], a[4:7]
s_add_u32 s72, s69, 0
buffer_load_dwordx4 v4, s[4:7], s72 offen lds
v_mfma_f32_16x16x32_bf16 a[8:11], v[224:227], v[208:211], a[8:11]
s_add_u32 s72, s69, 15360
buffer_load_dwordx4 v5, s[4:7], s72 offen offset:1024 lds
v_mfma_f32_16x16x32_bf16 a[8:11], v[228:231], v[212:215], a[8:11]
s_add_u32 s72, s69, 129024
buffer_load_dwordx4 v4, s[4:7], s72 offen offset:2048 lds
v_mfma_f32_16x16x32_bf16 a[12:15], v[228:231], v[220:223], a[12:15]
ds_read_b64_tr_b16 v[242:243], v102 offset:33792
v_mfma_f32_16x16x32_bf16 a[12:15], v[224:227], v[216:219], a[12:15]
s_waitcnt lgkmcnt(6)
v_mfma_f32_16x16x32_bf16 a[16:19], v[224:227], v[184:187], a[16:19]
s_add_u32 s74, s74, 0x4000
buffer_store_dwordx4 v[44:47], v26, s[44:47], s74 offen sc1
v_mfma_f32_16x16x32_bf16 a[16:19], v[228:231], v[188:191], a[16:19]
ds_read_b64_tr_b16 v[244:245], v102 offset:40960
v_mfma_f32_16x16x32_bf16 a[20:23], v[228:231], v[180:183], a[20:23]
v_mfma_f32_16x16x32_bf16 a[20:23], v[224:227], v[176:179], a[20:23]
ds_read_b64_tr_b16 v[246:247], v102 offset:41984
v_mfma_f32_16x16x32_bf16 a[24:27], v[224:227], v[168:171], a[24:27]
s_add_u32 s72, s69, 144384
buffer_load_dwordx4 v5, s[4:7], s72 offen offset:3072 lds
v_mfma_f32_16x16x32_bf16 a[24:27], v[228:231], v[172:175], a[24:27]
v_mfma_f32_16x16x32_bf16 a[28:31], v[228:231], v[164:167], a[28:31]
v_mfma_f32_16x16x32_bf16 a[28:31], v[224:227], v[160:163], a[28:31]
s_waitcnt lgkmcnt(4)
v_mfma_f32_16x16x32_bf16 a[60:63], v[232:235], v[160:163], a[60:63]
ds_read_b64_tr_b16 v[248:249], v103 offset:32768
v_mfma_f32_16x16x32_bf16 a[60:63], v[236:239], v[164:167], a[60:63]
v_mfma_f32_16x16x32_bf16 a[56:59], v[236:239], v[172:175], a[56:59]
s_add_u32 m0, s63, 69632
ds_read_b64_tr_b16 v[250:251], v103 offset:33792
v_mfma_f32_16x16x32_bf16 a[56:59], v[232:235], v[168:171], a[56:59]
s_add_u32 s72, s70, 0
buffer_load_dwordx4 v4, s[4:7], s72 offen lds
v_mfma_f32_16x16x32_bf16 a[52:55], v[232:235], v[176:179], a[52:55]
v_mfma_f32_16x16x32_bf16 a[52:55], v[236:239], v[180:183], a[52:55]
v_mfma_f32_16x16x32_bf16 a[48:51], v[236:239], v[188:191], a[48:51]
ds_read_b64_tr_b16 v[252:253], v103 offset:40960
v_mfma_f32_16x16x32_bf16 a[48:51], v[232:235], v[184:187], a[48:51]
v_mfma_f32_16x16x32_bf16 a[44:47], v[232:235], v[216:219], a[44:47]
s_add_u32 s72, s70, 15360
buffer_load_dwordx4 v5, s[4:7], s72 offen offset:1024 lds
v_mfma_f32_16x16x32_bf16 a[44:47], v[236:239], v[220:223], a[44:47]
s_add_u32 s74, s74, 0x4000
buffer_store_dwordx4 v[48:51], v26, s[44:47], s74 offen sc1
v_mfma_f32_16x16x32_bf16 a[40:43], v[236:239], v[212:215], a[40:43]
v_mfma_f32_16x16x32_bf16 a[40:43], v[232:235], v[208:211], a[40:43]
ds_read_b64_tr_b16 v[254:255], v103 offset:41984
v_mfma_f32_16x16x32_bf16 a[36:39], v[232:235], v[200:203], a[36:39]
v_mfma_f32_16x16x32_bf16 a[36:39], v[236:239], v[204:207], a[36:39]
v_mfma_f32_16x16x32_bf16 a[32:35], v[236:239], v[196:199], a[32:35]
v_mfma_f32_16x16x32_bf16 a[32:35], v[232:235], v[192:195], a[32:35]
s_waitcnt lgkmcnt(4)
v_mfma_f32_16x16x32_bf16 a[64:67], v[240:243], v[192:195], a[64:67]
s_add_u32 s72, s70, 129024
buffer_load_dwordx4 v4, s[4:7], s72 offen offset:2048 lds
v_mfma_f32_16x16x32_bf16 a[64:67], v[244:247], v[196:199], a[64:67]
ds_read_b64_tr_b16 v[224:225], v100 offset:49152
v_mfma_f32_16x16x32_bf16 a[68:71], v[244:247], v[204:207], a[68:71]
v_mfma_f32_16x16x32_bf16 a[68:71], v[240:243], v[200:203], a[68:71]
v_mfma_f32_16x16x32_bf16 a[72:75], v[240:243], v[208:211], a[72:75]
ds_read_b64_tr_b16 v[226:227], v100 offset:50176
v_mfma_f32_16x16x32_bf16 a[72:75], v[244:247], v[212:215], a[72:75]
s_add_u32 s72, s70, 144384
buffer_load_dwordx4 v5, s[4:7], s72 offen offset:3072 lds
v_mfma_f32_16x16x32_bf16 a[76:79], v[244:247], v[220:223], a[76:79]
v_mfma_f32_16x16x32_bf16 a[76:79], v[240:243], v[216:219], a[76:79]
v_mfma_f32_16x16x32_bf16 a[80:83], v[240:243], v[184:187], a[80:83]
ds_read_b64_tr_b16 v[228:229], v100 offset:57344
v_mfma_f32_16x16x32_bf16 a[80:83], v[244:247], v[188:191], a[80:83]
v_mfma_f32_16x16x32_bf16 a[84:87], v[244:247], v[180:183], a[84:87]
v_accvgpr_read_b32 v20, a0
v_accvgpr_read_b32 v28, a1
v_mfma_f32_16x16x32_bf16 a[84:87], v[240:243], v[176:179], a[84:87]
s_lshl_b32 s71, s73, 12
ds_read_b64_tr_b16 v[230:231], v100 offset:58368
v_accvgpr_read_b32 v21, a2
v_mfma_f32_16x16x32_bf16 a[88:91], v[240:243], v[168:171], a[88:91]
s_add_u32 s71, s71, s66
v_accvgpr_read_b32 v29, a3
v_accvgpr_read_b32 v22, a32
v_mfma_f32_16x16x32_bf16 a[88:91], v[244:247], v[172:175], a[88:91]
s_add_u32 m0, s64, 16384
v_accvgpr_read_b32 v30, a33
v_accvgpr_read_b32 v23, a34
v_mfma_f32_16x16x32_bf16 a[92:95], v[244:247], v[164:167], a[92:95]
s_add_u32 s72, s71, 0
buffer_load_dwordx4 v6, s[12:15], s72 offen lds
v_mfma_f32_16x16x32_bf16 a[92:95], v[240:243], v[160:163], a[92:95]
s_waitcnt lgkmcnt(4)
v_accvgpr_read_b32 v31, a35
v_mul_f32 v20, s79, v20
v_mfma_f32_16x16x32_bf16 a[124:127], v[248:251], v[160:163], a[124:127]
ds_read_b64_tr_b16 v[232:233], v101 offset:49152
v_mul_f32 v28, s79, v28
v_mfma_f32_16x16x32_bf16 a[124:127], v[252:255], v[164:167], a[124:127]
v_mul_f32 v21, s79, v21
v_mul_f32 v29, s79, v29
v_mfma_f32_16x16x32_bf16 a[120:123], v[252:255], v[172:175], a[120:123]
s_add_u32 s72, s71, 31744
buffer_load_dwordx4 v6, s[12:15], s72 offen offset:1024 lds
v_mfma_f32_16x16x32_bf16 a[120:123], v[248:251], v[168:171], a[120:123]
v_mul_f32 v22, s79, v22
v_mul_f32 v30, s79, v30
v_mfma_f32_16x16x32_bf16 a[116:119], v[248:251], v[176:179], a[116:119]
ds_read_b64_tr_b16 v[234:235], v101 offset:50176
v_mul_f32 v23, s79, v23
v_mfma_f32_16x16x32_bf16 a[116:119], v[252:255], v[180:183], a[116:119]
v_mul_f32 v31, s79, v31
v_cvt_pk_bf16_f32 v20, v20, v28
v_mfma_f32_16x16x32_bf16 a[112:115], v[252:255], v[188:191], a[112:115]
v_cvt_pk_bf16_f32 v21, v21, v29
v_cvt_pk_bf16_f32 v22, v22, v30
v_mfma_f32_16x16x32_bf16 a[112:115], v[248:251], v[184:187], a[112:115]
ds_read_b64_tr_b16 v[236:237], v101 offset:57344
v_cvt_pk_bf16_f32 v23, v23, v31
v_mfma_f32_16x16x32_bf16 a[108:111], v[248:251], v[216:219], a[108:111]
s_add_u32 s72, s71, 63488
buffer_load_dwordx4 v7, s[12:15], s72 offen offset:2048 lds
v_mfma_f32_16x16x32_bf16 a[108:111], v[252:255], v[220:223], a[108:111]
s_add_u32 s80, s77, 0
buffer_store_dwordx4 v[20:23], v1, s[44:47], s80 offen sc1
v_mfma_f32_16x16x32_bf16 a[104:107], v[252:255], v[212:215], a[104:107]
v_mfma_f32_16x16x32_bf16 a[104:107], v[248:251], v[208:211], a[104:107]
ds_read_b64_tr_b16 v[238:239], v101 offset:58368
v_mfma_f32_16x16x32_bf16 a[100:103], v[248:251], v[200:203], a[100:103]
v_mfma_f32_16x16x32_bf16 a[100:103], v[252:255], v[204:207], a[100:103]
v_mfma_f32_16x16x32_bf16 a[96:99], v[252:255], v[196:199], a[96:99]
s_add_u32 s72, s71, 95232
buffer_load_dwordx4 v7, s[12:15], s72 offen offset:3072 lds
v_mfma_f32_16x16x32_bf16 a[96:99], v[248:251], v[192:195], a[96:99]
s_waitcnt lgkmcnt(4)
LcB0:
v_mfma_f32_16x16x32_bf16 a[128:131], v[192:195], v[224:227], a[128:131]
ds_read_b64_tr_b16 v[240:241], v102 offset:49152
v_accvgpr_read_b32 v24, a4
v_mfma_f32_16x16x32_bf16 a[128:131], v[196:199], v[228:231], a[128:131]
v_accvgpr_read_b32 v28, a5
v_accvgpr_read_b32 v25, a6
v_mfma_f32_16x16x32_bf16 a[132:135], v[204:207], v[228:231], a[132:135]
v_accvgpr_read_b32 v29, a7
v_accvgpr_read_b32 v26, a36
v_mfma_f32_16x16x32_bf16 a[132:135], v[200:203], v[224:227], a[132:135]
ds_read_b64_tr_b16 v[242:243], v102 offset:50176
v_accvgpr_read_b32 v30, a37
v_mfma_f32_16x16x32_bf16 a[136:139], v[208:211], v[224:227], a[136:139]
v_accvgpr_read_b32 v27, a38
v_accvgpr_read_b32 v31, a39
v_mfma_f32_16x16x32_bf16 a[136:139], v[212:215], v[228:231], a[136:139]
v_mul_f32 v24, s79, v24
v_mul_f32 v28, s79, v28
v_mfma_f32_16x16x32_bf16 a[140:143], v[220:223], v[228:231], a[140:143]
v_mul_f32 v25, s79, v25
v_mul_f32 v29, s79, v29
v_mfma_f32_16x16x32_bf16 a[140:143], v[216:219], v[224:227], a[140:143]
ds_read_b64_tr_b16 v[244:245], v102 offset:57344
v_mul_f32 v26, s79, v26
v_mfma_f32_16x16x32_bf16 a[144:147], v[184:187], v[224:227], a[144:147]
v_mul_f32 v30, s79, v30
v_mul_f32 v27, s79, v27
v_mfma_f32_16x16x32_bf16 a[144:147], v[188:191], v[228:231], a[144:147]
v_mul_f32 v31, s79, v31
v_cvt_pk_bf16_f32 v24, v24, v28
v_mfma_f32_16x16x32_bf16 a[148:151], v[180:183], v[228:231], a[148:151]
ds_read_b64_tr_b16 v[246:247], v102 offset:58368
v_cvt_pk_bf16_f32 v25, v25, v29
v_mfma_f32_16x16x32_bf16 a[148:151], v[176:179], v[224:227], a[148:151]
v_cvt_pk_bf16_f32 v26, v26, v30
v_cvt_pk_bf16_f32 v27, v27, v31
v_mfma_f32_16x16x32_bf16 a[152:155], v[168:171], v[224:227], a[152:155]
s_add_u32 s80, s77, 4096
buffer_store_dwordx4 v[24:27], v1, s[44:47], s80 offen sc1
v_mfma_f32_16x16x32_bf16 a[152:155], v[172:175], v[228:231], a[152:155]
v_mfma_f32_16x16x32_bf16 a[156:159], v[164:167], v[228:231], a[156:159]
v_mfma_f32_16x16x32_bf16 a[156:159], v[160:163], v[224:227], a[156:159]
s_waitcnt lgkmcnt(4)
v_mfma_f32_16x16x32_bf16 a[188:191], v[160:163], v[232:235], a[188:191]
ds_read_b64_tr_b16 v[248:249], v103 offset:49152
v_mfma_f32_16x16x32_bf16 a[188:191], v[164:167], v[236:239], a[188:191]
v_mfma_f32_16x16x32_bf16 a[184:187], v[172:175], v[236:239], a[184:187]
ds_read_b64_tr_b16 v[250:251], v103 offset:50176
v_mfma_f32_16x16x32_bf16 a[184:187], v[168:171], v[232:235], a[184:187]
v_mfma_f32_16x16x32_bf16 a[180:183], v[176:179], v[232:235], a[180:183]
ds_read_b64_tr_b16 v[252:253], v103 offset:57344
v_mfma_f32_16x16x32_bf16 a[180:183], v[180:183], v[236:239], a[180:183]
s_add_u32 s73, s62, 2
v_mfma_f32_16x16x32_bf16 a[176:179], v[188:191], v[236:239], a[176:179]
s_add_u32 s70, s73, s65
ds_read_b64_tr_b16 v[254:255], v103 offset:58368
v_accvgpr_read_b32 v20, a8
v_mfma_f32_16x16x32_bf16 a[176:179], v[184:187], v[232:235], a[176:179]
s_and_b32 s70, s70, 3
v_accvgpr_read_b32 v28, a9
v_accvgpr_read_b32 v21, a10
v_mfma_f32_16x16x32_bf16 a[172:175], v[216:219], v[232:235], a[172:175]
s_and_b32 s73, s73, 12
v_accvgpr_read_b32 v29, a11
v_accvgpr_read_b32 v22, a40
v_mfma_f32_16x16x32_bf16 a[172:175], v[220:223], v[236:239], a[172:175]
s_or_b32 s73, s73, s70
v_accvgpr_read_b32 v30, a41
v_accvgpr_read_b32 v23, a42
v_mfma_f32_16x16x32_bf16 a[168:171], v[212:215], v[236:239], a[168:171]
s_lshl_b32 s73, s73, 7
v_accvgpr_read_b32 v31, a43
v_mul_f32 v20, s79, v20
v_mfma_f32_16x16x32_bf16 a[168:171], v[208:211], v[232:235], a[168:171]
s_add_u32 s69, s73, s67
v_mul_f32 v28, s79, v28
v_mul_f32 v21, s79, v21
v_mfma_f32_16x16x32_bf16 a[164:167], v[200:203], v[232:235], a[164:167]
s_add_u32 s70, s73, s68
v_mul_f32 v29, s79, v29
v_mul_f32 v22, s79, v22
v_mfma_f32_16x16x32_bf16 a[164:167], v[204:207], v[236:239], a[164:167]
s_add_u32 m0, s63, 98304
v_mul_f32 v30, s79, v30
v_mul_f32 v23, s79, v23
v_mfma_f32_16x16x32_bf16 a[160:163], v[196:199], v[236:239], a[160:163]
s_waitcnt vmcnt(8) lgkmcnt(0)
v_mul_f32 v31, s79, v31
v_cvt_pk_bf16_f32 v20, v20, v28
v_mfma_f32_16x16x32_bf16 a[160:163], v[192:195], v[232:235], a[160:163]
s_barrier
v_cvt_pk_bf16_f32 v21, v21, v29
v_cvt_pk_bf16_f32 v22, v22, v30
v_mfma_f32_16x16x32_bf16 a[192:195], v[192:195], v[240:243], a[192:195]
s_add_u32 s72, s69, 0
buffer_load_dwordx4 v4, s[4:7], s72 offen lds
v_mfma_f32_16x16x32_bf16 a[192:195], v[196:199], v[244:247], a[192:195]
s_lshl_b32 s74, s59, 2
ds_read_b64_tr_b16 v[64:65], v8 offset:0
v_or_b32 v106, s58, v0
v_mfma_f32_16x16x32_bf16 a[196:199], v[204:207], v[244:247], a[196:199]
ds_read_b64_tr_b16 v[66:67], v8 offset:1024
v_mov_b32 v107, 1
v_mfma_f32_16x16x32_bf16 a[196:199], v[200:203], v[240:243], a[196:199]
ds_read_b64_tr_b16 v[68:69], v8 offset:8192
v_lshlrev_b32 v106, 8, v106
v_mfma_f32_16x16x32_bf16 a[200:203], v[208:211], v[240:243], a[200:203]
ds_read_b64_tr_b16 v[70:71], v8 offset:9216
v_cvt_pk_bf16_f32 v23, v23, v31
v_mfma_f32_16x16x32_bf16 a[200:203], v[212:215], v[244:247], a[200:203]
s_add_u32 s72, s69, 15360
buffer_load_dwordx4 v5, s[4:7], s72 offen offset:1024 lds
v_mfma_f32_16x16x32_bf16 a[204:207], v[220:223], v[244:247], a[204:207]
s_add_u32 s80, s77, 8192
ds_read_b128 v[32:35], v16 offset:0
v_mfma_f32_16x16x32_bf16 a[204:207], v[216:219], v[240:243], a[204:207]
buffer_atomic_add v107, v106, s[48:51], s74 offen sc1
v_mfma_f32_16x16x32_bf16 a[208:211], v[184:187], v[240:243], a[208:211]
ds_read_b128 v[36:39], v17 offset:0
v_mfma_f32_16x16x32_bf16 a[208:211], v[188:191], v[244:247], a[208:211]
ds_read_b128 v[40:43], v16 offset:2048
v_mfma_f32_16x16x32_bf16 a[212:215], v[180:183], v[244:247], a[212:215]
s_add_u32 s72, s69, 129024
buffer_load_dwordx4 v4, s[4:7], s72 offen offset:2048 lds
v_mfma_f32_16x16x32_bf16 a[212:215], v[176:179], v[240:243], a[212:215]
ds_read_b128 v[44:47], v17 offset:2048
v_mfma_f32_16x16x32_bf16 a[216:219], v[168:171], v[240:243], a[216:219]
ds_read_b128 v[48:51], v16 offset:4096
v_accvgpr_read_b32 v24, a128
v_mfma_f32_16x16x32_bf16 a[216:219], v[172:175], v[244:247], a[216:219]
ds_read_b128 v[52:55], v17 offset:4096
v_accvgpr_read_b32 v28, a129
v_mfma_f32_16x16x32_bf16 a[220:223], v[164:167], v[244:247], a[220:223]
buffer_store_dwordx4 v[20:23], v1, s[44:47], s80 offen sc1
v_mfma_f32_16x16x32_bf16 a[220:223], v[160:163], v[240:243], a[220:223]
s_add_u32 s72, s69, 144384
buffer_load_dwordx4 v5, s[4:7], s72 offen offset:3072 lds
v_mfma_f32_16x16x32_bf16 a[252:255], v[160:163], v[248:251], a[252:255]
ds_read_b128 v[56:59], v16 offset:6144
v_accvgpr_read_b32 v25, a130
v_mfma_f32_16x16x32_bf16 a[252:255], v[164:167], v[252:255], a[252:255]
ds_read_b128 v[60:63], v17 offset:6144
v_accvgpr_read_b32 v29, a131
v_mfma_f32_16x16x32_bf16 a[248:251], v[172:175], v[252:255], a[248:251]
ds_read_b64_tr_b16 v[72:73], v9 offset:0
v_accvgpr_read_b32 v26, a132
v_mfma_f32_16x16x32_bf16 a[248:251], v[168:171], v[248:251], a[248:251]
s_add_u32 m0, s63, 102400
ds_read_b64_tr_b16 v[74:75], v9 offset:1024
v_accvgpr_read_b32 v30, a133
v_mfma_f32_16x16x32_bf16 a[244:247], v[176:179], v[248:251], a[244:247]
s_add_u32 s72, s70, 0
buffer_load_dwordx4 v4, s[4:7], s72 offen lds
v_mfma_f32_16x16x32_bf16 a[244:247], v[180:183], v[252:255], a[244:247]
ds_read_b64_tr_b16 v[76:77], v9 offset:8192
v_accvgpr_read_b32 v27, a134
v_mfma_f32_16x16x32_bf16 a[240:243], v[188:191], v[252:255], a[240:243]
v_accvgpr_read_b32 v31, a135
v_cvt_pk_bf16_f32 v24, v24, v28
v_mfma_f32_16x16x32_bf16 a[240:243], v[184:187], v[248:251], a[240:243]
ds_read_b64_tr_b16 v[78:79], v9 offset:9216
v_cvt_pk_bf16_f32 v25, v25, v29
v_mfma_f32_16x16x32_bf16 a[236:239], v[216:219], v[248:251], a[236:239]
ds_read_b64_tr_b16 v[80:81], v10 offset:0
v_cvt_pk_bf16_f32 v26, v26, v30
v_mfma_f32_16x16x32_bf16 a[236:239], v[220:223], v[252:255], a[236:239]
s_add_u32 s72, s70, 15360
buffer_load_dwordx4 v5, s[4:7], s72 offen offset:1024 lds
v_mfma_f32_16x16x32_bf16 a[232:235], v[212:215], v[252:255], a[232:235]
ds_read_b64_tr_b16 v[82:83], v10 offset:1024
v_cvt_pk_bf16_f32 v27, v27, v31
v_mfma_f32_16x16x32_bf16 a[232:235], v[208:211], v[248:251], a[232:235]
s_add_u32 s80, s78, 0
ds_read_b64_tr_b16 v[84:85], v10 offset:8192
v_mfma_f32_16x16x32_bf16 a[228:231], v[200:203], v[248:251], a[228:231]
ds_read_b64_tr_b16 v[86:87], v10 offset:9216
v_mfma_f32_16x16x32_bf16 a[228:231], v[204:207], v[252:255], a[228:231]
buffer_store_dwordx4 v[24:27], v1, s[44:47], s80 offen sc1
v_mfma_f32_16x16x32_bf16 a[224:227], v[196:199], v[252:255], a[224:227]
s_add_u32 s72, s70, 129024
buffer_load_dwordx4 v4, s[4:7], s72 offen offset:2048 lds
v_mfma_f32_16x16x32_bf16 a[224:227], v[192:195], v[248:251], a[224:227]
s_waitcnt lgkmcnt(8)
v_mfma_f32_16x16x32_bf16 v[128:131], v[64:67], v[32:35], 0
ds_read_b64_tr_b16 v[88:89], v11 offset:0
v_mfma_f32_16x16x32_bf16 v[128:131], v[68:71], v[36:39], v[128:131]
ds_read_b64_tr_b16 v[90:91], v11 offset:1024
v_mfma_f32_16x16x32_bf16 v[132:135], v[68:71], v[44:47], 0
v_accvgpr_read_b32 v20, a12
v_accvgpr_read_b32 v28, a13
v_mfma_f32_16x16x32_bf16 v[132:135], v[64:67], v[40:43], v[132:135]
s_add_u32 s72, s70, 144384
buffer_load_dwordx4 v5, s[4:7], s72 offen offset:3072 lds
v_mfma_f32_16x16x32_bf16 v[136:139], v[64:67], v[48:51], 0
s_lshl_b32 s71, s73, 12
ds_read_b64_tr_b16 v[92:93], v11 offset:8192
v_accvgpr_read_b32 v21, a14
v_mfma_f32_16x16x32_bf16 v[136:139], v[68:71], v[52:55], v[136:139]
s_add_u32 s71, s71, s66
v_accvgpr_read_b32 v29, a15
v_accvgpr_read_b32 v22, a44
v_mfma_f32_16x16x32_bf16 v[140:143], v[68:71], v[60:63], 0
s_add_u32 m0, s64, 32768
ds_read_b64_tr_b16 v[94:95], v11 offset:9216
v_accvgpr_read_b32 v30, a45
v_mfma_f32_16x16x32_bf16 v[140:143], v[64:67], v[56:59], v[140:143]
s_waitcnt lgkmcnt(8)
v_accvgpr_read_b32 v23, a46
v_accvgpr_read_b32 v31, a47
v_mfma_f32_16x16x32_bf16 v[156:159], v[72:75], v[56:59], 0
s_add_u32 s72, s71, 0
buffer_load_dwordx4 v6, s[12:15], s72 offen lds
v_mfma_f32_16x16x32_bf16 v[156:159], v[76:79], v[60:63], v[156:159]
s_add_u32 s73, s62, 3
ds_read_b64_tr_b16 v[64:65], v12 offset:0
v_mul_f32 v20, s79, v20
v_mfma_f32_16x16x32_bf16 v[152:155], v[76:79], v[52:55], 0
s_add_u32 s70, s73, s65
ds_read_b64_tr_b16 v[66:67], v12 offset:1024
v_mul_f32 v28, s79, v28
v_mfma_f32_16x16x32_bf16 v[152:155], v[72:75], v[48:51], v[152:155]
s_add_u32 s72, s71, 31744
buffer_load_dwordx4 v6, s[12:15], s72 offen offset:1024 lds
v_mfma_f32_16x16x32_bf16 v[148:151], v[72:75], v[40:43], 0
s_and_b32 s70, s70, 3
v_mul_f32 v21, s79, v21
v_mul_f32 v29, s79, v29
v_mfma_f32_16x16x32_bf16 v[148:151], v[76:79], v[44:47], v[148:151]
s_and_b32 s73, s73, 12
ds_read_b64_tr_b16 v[68:69], v12 offset:8192
v_mul_f32 v22, s79, v22
v_mfma_f32_16x16x32_bf16 v[144:147], v[76:79], v[36:39], 0
s_or_b32 s73, s73, s70
ds_read_b64_tr_b16 v[70:71], v12 offset:9216
v_mul_f32 v30, s79, v30
v_mfma_f32_16x16x32_bf16 v[144:147], v[72:75], v[32:35], v[144:147]
s_waitcnt lgkmcnt(8)
v_mul_f32 v23, s79, v23
v_mul_f32 v31, s79, v31
v_mfma_f32_16x16x32_bf16 v[160:163], v[80:83], v[32:35], 0
s_lshl_b32 s73, s73, 7
ds_read_b64_tr_b16 v[72:73], v13 offset:0
v_cvt_pk_bf16_f32 v20, v20, v28
v_mfma_f32_16x16x32_bf16 v[160:163], v[84:87], v[36:39], v[160:163]
s_add_u32 s72, s71, 63488
buffer_load_dwordx4 v7, s[12:15], s72 offen offset:2048 lds
v_mfma_f32_16x16x32_bf16 v[164:167], v[84:87], v[44:47], 0
s_add_u32 s69, s73, s67
ds_read_b64_tr_b16 v[74:75], v13 offset:1024
v_cvt_pk_bf16_f32 v21, v21, v29
v_mfma_f32_16x16x32_bf16 v[164:167], v[80:83], v[40:43], v[164:167]
s_add_u32 s70, s73, s68
v_cvt_pk_bf16_f32 v22, v22, v30
v_cvt_pk_bf16_f32 v23, v23, v31
v_mfma_f32_16x16x32_bf16 v[168:171], v[80:83], v[48:51], 0
s_waitcnt vmcnt(20)
ds_read_b64_tr_b16 v[76:77], v13 offset:8192
v_mfma_f32_16x16x32_bf16 v[168:171], v[84:87], v[52:55], v[168:171]
s_add_u32 s80, s77, 12288
ds_read_b64_tr_b16 v[78:79], v13 offset:9216
v_mfma_f32_16x16x32_bf16 v[172:175], v[84:87], v[60:63], 0
s_add_u32 s72, s71, 95232
ds_read_b128 v[96:99], v18 offset:0
v_mfma_f32_16x16x32_bf16 v[172:175], v[80:83], v[56:59], v[172:175]
s_waitcnt lgkmcnt(9)
buffer_load_dwordx4 v7, s[12:15], s72 offen offset:3072 lds
v_mfma_f32_16x16x32_bf16 v[188:191], v[88:91], v[56:59], 0
ds_read_b64_tr_b16 v[80:81], v14 offset:0
v_accvgpr_read_b32 v24, a136
v_mfma_f32_16x16x32_bf16 v[188:191], v[92:95], v[60:63], v[188:191]
ds_read_b64_tr_b16 v[82:83], v14 offset:1024
v_accvgpr_read_b32 v28, a137
v_mfma_f32_16x16x32_bf16 v[184:187], v[92:95], v[52:55], 0
ds_read_b128 v[100:103], v19 offset:0
v_accvgpr_read_b32 v25, a138
v_mfma_f32_16x16x32_bf16 v[184:187], v[88:91], v[48:51], v[184:187]
ds_read_b64_tr_b16 v[84:85], v14 offset:8192
v_accvgpr_read_b32 v29, a139
v_mfma_f32_16x16x32_bf16 v[180:183], v[88:91], v[40:43], 0
buffer_store_dwordx4 v[20:23], v1, s[44:47], s80 offen sc1
v_mfma_f32_16x16x32_bf16 v[180:183], v[92:95], v[44:47], v[180:183]
s_add_u32 m0, s63, 131072
ds_read_b64_tr_b16 v[86:87], v14 offset:9216
v_accvgpr_read_b32 v26, a140
v_mfma_f32_16x16x32_bf16 v[176:179], v[92:95], v[36:39], 0
s_add_u32 s72, s69, 0
buffer_load_dwordx4 v4, s[4:7], s72 offen lds
v_mfma_f32_16x16x32_bf16 v[176:179], v[88:91], v[32:35], v[176:179]
s_waitcnt lgkmcnt(10)
ds_read_b128 v[104:107], v18 offset:2048
v_accvgpr_read_b32 v30, a141
v_mfma_f32_16x16x32_bf16 v[192:195], v[64:67], v[32:35], 0
ds_read_b64_tr_b16 v[88:89], v15 offset:0
v_accvgpr_read_b32 v27, a142
v_mfma_f32_16x16x32_bf16 v[192:195], v[68:71], v[36:39], v[192:195]
ds_read_b64_tr_b16 v[90:91], v15 offset:1024
v_accvgpr_read_b32 v31, a143
v_mfma_f32_16x16x32_bf16 v[196:199], v[68:71], v[44:47], 0
ds_read_b64_tr_b16 v[92:93], v15 offset:8192
v_cvt_pk_bf16_f32 v24, v24, v28
v_mfma_f32_16x16x32_bf16 v[196:199], v[64:67], v[40:43], v[196:199]
s_add_u32 s72, s69, 15360
buffer_load_dwordx4 v5, s[4:7], s72 offen offset:1024 lds
v_mfma_f32_16x16x32_bf16 v[200:203], v[64:67], v[48:51], 0
ds_read_b64_tr_b16 v[94:95], v15 offset:9216
v_cvt_pk_bf16_f32 v25, v25, v29
v_mfma_f32_16x16x32_bf16 v[200:203], v[68:71], v[52:55], v[200:203]
ds_read_b128 v[108:111], v19 offset:2048
v_cvt_pk_bf16_f32 v26, v26, v30
v_mfma_f32_16x16x32_bf16 v[204:207], v[68:71], v[60:63], 0
v_cvt_pk_bf16_f32 v27, v27, v31
v_mfma_f32_16x16x32_bf16 v[204:207], v[64:67], v[56:59], v[204:207]
s_waitcnt lgkmcnt(12)
ds_read_b128 v[112:115], v18 offset:4096
v_mfma_f32_16x16x32_bf16 v[220:223], v[72:75], v[56:59], 0
s_add_u32 s72, s69, 129024
buffer_load_dwordx4 v4, s[4:7], s72 offen offset:2048 lds
v_mfma_f32_16x16x32_bf16 v[220:223], v[76:79], v[60:63], v[220:223]
s_add_u32 s80, s78, 8192
buffer_store_dwordx4 v[24:27], v1, s[44:47], s80 offen sc1
v_mfma_f32_16x16x32_bf16 v[216:219], v[76:79], v[52:55], 0
s_waitcnt vmcnt(21) lgkmcnt(2)
ds_read_b128 v[116:119], v19 offset:4096
v_mfma_f32_16x16x32_bf16 v[216:219], v[72:75], v[48:51], v[216:219]
s_barrier
ds_read_b128 v[120:123], v18 offset:6144
v_mfma_f32_16x16x32_bf16 v[212:215], v[72:75], v[40:43], 0
ds_read_b64_tr_b16 v[64:65], v8 offset:16384
ds_read_b64_tr_b16 v[66:67], v8 offset:17408
v_mfma_f32_16x16x32_bf16 v[212:215], v[76:79], v[44:47], v[212:215]
ds_read_b64_tr_b16 v[68:69], v8 offset:24576
v_mfma_f32_16x16x32_bf16 v[208:211], v[76:79], v[36:39], 0
s_add_u32 s72, s69, 144384
buffer_load_dwordx4 v5, s[4:7], s72 offen offset:3072 lds
v_mfma_f32_16x16x32_bf16 v[208:211], v[72:75], v[32:35], v[208:211]
ds_read_b64_tr_b16 v[70:71], v8 offset:25600
v_accvgpr_read_b32 v20, a16
v_mfma_f32_16x16x32_bf16 v[224:227], v[80:83], v[32:35], 0
ds_read_b64_tr_b16 v[72:73], v9 offset:16384
v_accvgpr_read_b32 v28, a17
v_mfma_f32_16x16x32_bf16 v[224:227], v[84:87], v[36:39], v[224:227]
ds_read_b64_tr_b16 v[74:75], v9 offset:17408
v_accvgpr_read_b32 v21, a18
v_mfma_f32_16x16x32_bf16 v[228:231], v[84:87], v[44:47], 0
s_add_u32 m0, s63, 135168
v_accvgpr_read_b32 v29, a19
v_accvgpr_read_b32 v22, a48
v_mfma_f32_16x16x32_bf16 v[228:231], v[80:83], v[40:43], v[228:231]
s_add_u32 s72, s70, 0
buffer_load_dwordx4 v4, s[4:7], s72 offen lds
v_mfma_f32_16x16x32_bf16 v[232:235], v[80:83], v[48:51], 0
ds_read_b64_tr_b16 v[76:77], v9 offset:24576
v_accvgpr_read_b32 v30, a49
v_mfma_f32_16x16x32_bf16 v[232:235], v[84:87], v[52:55], v[232:235]
ds_read_b128 v[124:127], v19 offset:6144
v_accvgpr_read_b32 v23, a50
v_mfma_f32_16x16x32_bf16 v[236:239], v[84:87], v[60:63], 0
ds_read_b64_tr_b16 v[78:79], v9 offset:25600
v_accvgpr_read_b32 v31, a51
v_mfma_f32_16x16x32_bf16 v[236:239], v[80:83], v[56:59], v[236:239]
v_mul_f32 v20, s79, v20
v_mul_f32 v28, s79, v28
v_mfma_f32_16x16x32_bf16 v[252:255], v[88:91], v[56:59], 0
s_add_u32 s72, s70, 15360
buffer_load_dwordx4 v5, s[4:7], s72 offen offset:1024 lds
v_mfma_f32_16x16x32_bf16 v[252:255], v[92:95], v[60:63], v[252:255]
ds_read_b64_tr_b16 v[80:81], v10 offset:16384
v_mul_f32 v21, s79, v21
v_mfma_f32_16x16x32_bf16 v[248:251], v[92:95], v[52:55], 0
ds_read_b64_tr_b16 v[82:83], v10 offset:17408
v_mul_f32 v29, s79, v29
v_mfma_f32_16x16x32_bf16 v[248:251], v[88:91], v[48:51], v[248:251]
v_mul_f32 v22, s79, v22
v_mul_f32 v30, s79, v30
v_mfma_f32_16x16x32_bf16 v[244:247], v[88:91], v[40:43], 0
ds_read_b64_tr_b16 v[84:85], v10 offset:24576
v_mul_f32 v23, s79, v23
v_mfma_f32_16x16x32_bf16 v[244:247], v[92:95], v[44:47], v[244:247]
ds_read_b64_tr_b16 v[86:87], v10 offset:25600
v_mul_f32 v31, s79, v31
v_mfma_f32_16x16x32_bf16 v[240:243], v[92:95], v[36:39], 0
s_add_u32 s72, s70, 129024
buffer_load_dwordx4 v4, s[4:7], s72 offen offset:2048 lds
v_mfma_f32_16x16x32_bf16 v[240:243], v[88:91], v[32:35], v[240:243]
s_waitcnt lgkmcnt(5)
v_cvt_pk_bf16_f32 v20, v20, v28
v_cvt_pk_bf16_f32 v21, v21, v29
v_mfma_f32_16x16x32_bf16 v[128:131], v[64:67], v[96:99], v[128:131]
ds_read_b64_tr_b16 v[88:89], v11 offset:16384
v_cvt_pk_bf16_f32 v22, v22, v30
v_mfma_f32_16x16x32_bf16 v[128:131], v[68:71], v[100:103], v[128:131]
ds_read_b64_tr_b16 v[90:91], v11 offset:17408
v_cvt_pk_bf16_f32 v23, v23, v31
v_mfma_f32_16x16x32_bf16 v[132:135], v[68:71], v[108:111], v[132:135]
s_add_u32 s80, s77, 32768
buffer_store_dwordx4 v[20:23], v1, s[44:47], s80 offen sc1
v_mfma_f32_16x16x32_bf16 v[132:135], v[64:67], v[104:107], v[132:135]
s_add_u32 s72, s70, 144384
buffer_load_dwordx4 v5, s[4:7], s72 offen offset:3072 lds
v_mfma_f32_16x16x32_bf16 v[136:139], v[64:67], v[112:115], v[136:139]
ds_read_b64_tr_b16 v[92:93], v11 offset:24576
v_accvgpr_read_b32 v24, a144
v_mfma_f32_16x16x32_bf16 v[136:139], v[68:71], v[116:119], v[136:139]
s_lshl_b32 s71, s73, 12
v_accvgpr_read_b32 v28, a145
v_accvgpr_read_b32 v25, a146
v_mfma_f32_16x16x32_bf16 v[140:143], v[68:71], v[124:127], v[140:143]
s_add_u32 s71, s71, s66
ds_read_b64_tr_b16 v[94:95], v11 offset:25600
v_accvgpr_read_b32 v29, a147
v_mfma_f32_16x16x32_bf16 v[140:143], v[64:67], v[120:123], v[140:143]
s_waitcnt lgkmcnt(8)
v_accvgpr_read_b32 v26, a148
v_accvgpr_read_b32 v30, a149
v_mfma_f32_16x16x32_bf16 v[156:159], v[72:75], v[120:123], v[156:159]
s_add_u32 m0, s64, 0
ds_read_b64_tr_b16 v[64:65], v12 offset:16384
v_accvgpr_read_b32 v27, a150
v_mfma_f32_16x16x32_bf16 v[156:159], v[76:79], v[124:127], v[156:159]
s_add_u32 s72, s71, 0
buffer_load_dwordx4 v6, s[12:15], s72 offen lds
v_mfma_f32_16x16x32_bf16 v[152:155], v[76:79], v[116:119], v[152:155]
s_add_u32 s73, s62, 4
ds_read_b64_tr_b16 v[66:67], v12 offset:17408
v_accvgpr_read_b32 v31, a151
v_mfma_f32_16x16x32_bf16 v[152:155], v[72:75], v[112:115], v[152:155]
s_add_u32 s70, s73, s65
v_cvt_pk_bf16_f32 v24, v24, v28
v_cvt_pk_bf16_f32 v25, v25, v29
v_mfma_f32_16x16x32_bf16 v[148:151], v[72:75], v[104:107], v[148:151]
s_and_b32 s70, s70, 3
ds_read_b64_tr_b16 v[68:69], v12 offset:24576
v_cvt_pk_bf16_f32 v26, v26, v30
v_mfma_f32_16x16x32_bf16 v[148:151], v[76:79], v[108:111], v[148:151]
s_and_b32 s73, s73, 12
ds_read_b64_tr_b16 v[70:71], v12 offset:25600
v_cvt_pk_bf16_f32 v27, v27, v31
v_mfma_f32_16x16x32_bf16 v[144:147], v[76:79], v[100:103], v[144:147]
s_add_u32 s72, s71, 31744
buffer_load_dwordx4 v6, s[12:15], s72 offen offset:1024 lds
v_mfma_f32_16x16x32_bf16 v[144:147], v[72:75], v[96:99], v[144:147]
s_waitcnt lgkmcnt(8)
v_mfma_f32_16x16x32_bf16 v[160:163], v[80:83], v[96:99], v[160:163]
s_or_b32 s73, s73, s70
ds_read_b64_tr_b16 v[72:73], v13 offset:16384
v_mfma_f32_16x16x32_bf16 v[160:163], v[84:87], v[100:103], v[160:163]
s_lshl_b32 s73, s73, 7
ds_read_b64_tr_b16 v[74:75], v13 offset:17408
v_mfma_f32_16x16x32_bf16 v[164:167], v[84:87], v[108:111], v[164:167]
s_add_u32 s69, s73, s67
v_mfma_f32_16x16x32_bf16 v[164:167], v[80:83], v[104:107], v[164:167]
s_add_u32 s72, s71, 63488
buffer_load_dwordx4 v7, s[12:15], s72 offen offset:2048 lds
v_mfma_f32_16x16x32_bf16 v[168:171], v[80:83], v[112:115], v[168:171]
s_waitcnt vmcnt(18)
ds_read_b64_tr_b16 v[76:77], v13 offset:24576
v_mfma_f32_16x16x32_bf16 v[168:171], v[84:87], v[116:119], v[168:171]
s_add_u32 s70, s73, s68
ds_read_b128 v[32:35], v18 offset:32768
v_mfma_f32_16x16x32_bf16 v[172:175], v[84:87], v[124:127], v[172:175]
s_add_u32 s80, s78, 32768
ds_read_b64_tr_b16 v[78:79], v13 offset:25600
v_mfma_f32_16x16x32_bf16 v[172:175], v[80:83], v[120:123], v[172:175]
s_waitcnt lgkmcnt(9)
ds_read_b128 v[36:39], v19 offset:32768
v_mfma_f32_16x16x32_bf16 v[188:191], v[88:91], v[120:123], v[188:191]
s_add_u32 s72, s71, 95232
buffer_load_dwordx4 v7, s[12:15], s72 offen offset:3072 lds
v_mfma_f32_16x16x32_bf16 v[188:191], v[92:95], v[124:127], v[188:191]
ds_read_b64_tr_b16 v[80:81], v14 offset:16384
v_mfma_f32_16x16x32_bf16 v[184:187], v[92:95], v[116:119], v[184:187]
ds_read_b64_tr_b16 v[82:83], v14 offset:17408
v_mfma_f32_16x16x32_bf16 v[184:187], v[88:91], v[112:115], v[184:187]
buffer_store_dwordx4 v[24:27], v1, s[44:47], s80 offen sc1
v_mfma_f32_16x16x32_bf16 v[180:183], v[88:91], v[104:107], v[180:183]
ds_read_b64_tr_b16 v[84:85], v14 offset:24576
v_accvgpr_read_b32 v20, a20
v_mfma_f32_16x16x32_bf16 v[180:183], v[92:95], v[108:111], v[180:183]
s_add_u32 m0, s63, 65536
ds_read_b64_tr_b16 v[86:87], v14 offset:25600
v_accvgpr_read_b32 v28, a21
v_mfma_f32_16x16x32_bf16 v[176:179], v[92:95], v[100:103], v[176:179]
s_add_u32 s72, s69, 0
buffer_load_dwordx4 v4, s[4:7], s72 offen lds
v_mfma_f32_16x16x32_bf16 v[176:179], v[88:91], v[96:99], v[176:179]
s_waitcnt lgkmcnt(10)
ds_read_b128 v[40:43], v18 offset:34816
v_accvgpr_read_b32 v21, a22
v_mfma_f32_16x16x32_bf16 v[192:195], v[64:67], v[96:99], v[192:195]
ds_read_b64_tr_b16 v[88:89], v15 offset:16384
v_accvgpr_read_b32 v29, a23
v_mfma_f32_16x16x32_bf16 v[192:195], v[68:71], v[100:103], v[192:195]
ds_read_b64_tr_b16 v[90:91], v15 offset:17408
v_accvgpr_read_b32 v22, a52
v_mfma_f32_16x16x32_bf16 v[196:199], v[68:71], v[108:111], v[196:199]
ds_read_b64_tr_b16 v[92:93], v15 offset:24576
v_accvgpr_read_b32 v30, a53
v_mfma_f32_16x16x32_bf16 v[196:199], v[64:67], v[104:107], v[196:199]
s_add_u32 s72, s69, 15360
buffer_load_dwordx4 v5, s[4:7], s72 offen offset:1024 lds
v_mfma_f32_16x16x32_bf16 v[200:203], v[64:67], v[112:115], v[200:203]
ds_read_b64_tr_b16 v[94:95], v15 offset:25600
v_accvgpr_read_b32 v23, a54
v_mfma_f32_16x16x32_bf16 v[200:203], v[68:71], v[116:119], v[200:203]
ds_read_b128 v[44:47], v19 offset:34816
v_accvgpr_read_b32 v31, a55
v_mfma_f32_16x16x32_bf16 v[204:207], v[68:71], v[124:127], v[204:207]
v_mul_f32 v20, s79, v20
v_mul_f32 v28, s79, v28
v_mfma_f32_16x16x32_bf16 v[204:207], v[64:67], v[120:123], v[204:207]
s_waitcnt lgkmcnt(11)
ds_read_b128 v[48:51], v18 offset:36864
v_mul_f32 v21, s79, v21
v_mfma_f32_16x16x32_bf16 v[220:223], v[72:75], v[120:123], v[220:223]
s_add_u32 s72, s69, 129024
buffer_load_dwordx4 v4, s[4:7], s72 offen offset:2048 lds
v_mfma_f32_16x16x32_bf16 v[220:223], v[76:79], v[124:127], v[220:223]
v_mul_f32 v29, s79, v29
v_mul_f32 v22, s79, v22
v_mfma_f32_16x16x32_bf16 v[216:219], v[76:79], v[116:119], v[216:219]
s_waitcnt vmcnt(19) lgkmcnt(2)
ds_read_b128 v[52:55], v19 offset:36864
v_mul_f32 v30, s79, v30
v_mfma_f32_16x16x32_bf16 v[216:219], v[72:75], v[112:115], v[216:219]
s_barrier
ds_read_b128 v[56:59], v18 offset:38912
v_mul_f32 v23, s79, v23
v_mfma_f32_16x16x32_bf16 v[212:215], v[72:75], v[104:107], v[212:215]
ds_read_b64_tr_b16 v[64:65], v8 offset:32768
ds_read_b64_tr_b16 v[66:67], v8 offset:33792
v_mfma_f32_16x16x32_bf16 v[212:215], v[76:79], v[108:111], v[212:215]
ds_read_b64_tr_b16 v[68:69], v8 offset:40960
v_mul_f32 v31, s79, v31
v_mfma_f32_16x16x32_bf16 v[208:211], v[76:79], v[100:103], v[208:211]
s_add_u32 s72, s69, 144384
buffer_load_dwordx4 v5, s[4:7], s72 offen offset:3072 lds
v_mfma_f32_16x16x32_bf16 v[208:211], v[72:75], v[96:99], v[208:211]
ds_read_b64_tr_b16 v[70:71], v8 offset:41984
v_cvt_pk_bf16_f32 v20, v20, v28
v_mfma_f32_16x16x32_bf16 v[224:227], v[80:83], v[96:99], v[224:227]
ds_read_b64_tr_b16 v[72:73], v9 offset:32768
v_cvt_pk_bf16_f32 v21, v21, v29
v_mfma_f32_16x16x32_bf16 v[224:227], v[84:87], v[100:103], v[224:227]
ds_read_b64_tr_b16 v[74:75], v9 offset:33792
v_cvt_pk_bf16_f32 v22, v22, v30
v_mfma_f32_16x16x32_bf16 v[228:231], v[84:87], v[108:111], v[228:231]
s_add_u32 m0, s63, 69632
v_cvt_pk_bf16_f32 v23, v23, v31
v_accvgpr_read_b32 v24, a152
v_mfma_f32_16x16x32_bf16 v[228:231], v[80:83], v[104:107], v[228:231]
s_add_u32 s72, s70, 0
buffer_load_dwordx4 v4, s[4:7], s72 offen lds
v_mfma_f32_16x16x32_bf16 v[232:235], v[80:83], v[112:115], v[232:235]
s_add_u32 s80, s77, 36864
ds_read_b64_tr_b16 v[76:77], v9 offset:40960
v_accvgpr_read_b32 v28, a153
v_mfma_f32_16x16x32_bf16 v[232:235], v[84:87], v[116:119], v[232:235]
ds_read_b128 v[60:63], v19 offset:38912
v_accvgpr_read_b32 v25, a154
v_mfma_f32_16x16x32_bf16 v[236:239], v[84:87], v[124:127], v[236:239]
ds_read_b64_tr_b16 v[78:79], v9 offset:41984
v_accvgpr_read_b32 v29, a155
v_mfma_f32_16x16x32_bf16 v[236:239], v[80:83], v[120:123], v[236:239]
buffer_store_dwordx4 v[20:23], v1, s[44:47], s80 offen sc1
v_mfma_f32_16x16x32_bf16 v[252:255], v[88:91], v[120:123], v[252:255]
s_add_u32 s72, s70, 15360
buffer_load_dwordx4 v5, s[4:7], s72 offen offset:1024 lds
v_mfma_f32_16x16x32_bf16 v[252:255], v[92:95], v[124:127], v[252:255]
ds_read_b64_tr_b16 v[80:81], v10 offset:32768
v_accvgpr_read_b32 v26, a156
v_mfma_f32_16x16x32_bf16 v[248:251], v[92:95], v[116:119], v[248:251]
ds_read_b64_tr_b16 v[82:83], v10 offset:33792
v_accvgpr_read_b32 v30, a157
v_mfma_f32_16x16x32_bf16 v[248:251], v[88:91], v[112:115], v[248:251]
v_accvgpr_read_b32 v27, a158
v_accvgpr_read_b32 v31, a159
v_mfma_f32_16x16x32_bf16 v[244:247], v[88:91], v[104:107], v[244:247]
ds_read_b64_tr_b16 v[84:85], v10 offset:40960
v_cvt_pk_bf16_f32 v24, v24, v28
v_mfma_f32_16x16x32_bf16 v[244:247], v[92:95], v[108:111], v[244:247]
ds_read_b64_tr_b16 v[86:87], v10 offset:41984
v_cvt_pk_bf16_f32 v25, v25, v29
v_mfma_f32_16x16x32_bf16 v[240:243], v[92:95], v[100:103], v[240:243]
s_add_u32 s72, s70, 129024
buffer_load_dwordx4 v4, s[4:7], s72 offen offset:2048 lds
v_mfma_f32_16x16x32_bf16 v[240:243], v[88:91], v[96:99], v[240:243]
s_waitcnt lgkmcnt(5)
v_cvt_pk_bf16_f32 v26, v26, v30
v_cvt_pk_bf16_f32 v27, v27, v31
v_mfma_f32_16x16x32_bf16 v[128:131], v[64:67], v[32:35], v[128:131]
s_add_u32 s80, s78, 40960
ds_read_b64_tr_b16 v[88:89], v11 offset:32768
v_mfma_f32_16x16x32_bf16 v[128:131], v[68:71], v[36:39], v[128:131]
ds_read_b64_tr_b16 v[90:91], v11 offset:33792
v_mfma_f32_16x16x32_bf16 v[132:135], v[68:71], v[44:47], v[132:135]
buffer_store_dwordx4 v[24:27], v1, s[44:47], s80 offen sc1
v_mfma_f32_16x16x32_bf16 v[132:135], v[64:67], v[40:43], v[132:135]
s_add_u32 s72, s70, 144384
buffer_load_dwordx4 v5, s[4:7], s72 offen offset:3072 lds
v_mfma_f32_16x16x32_bf16 v[136:139], v[64:67], v[48:51], v[136:139]
ds_read_b64_tr_b16 v[92:93], v11 offset:40960
v_mfma_f32_16x16x32_bf16 v[136:139], v[68:71], v[52:55], v[136:139]
s_lshl_b32 s71, s73, 12
v_mfma_f32_16x16x32_bf16 v[140:143], v[68:71], v[60:63], v[140:143]
s_add_u32 s71, s71, s66
ds_read_b64_tr_b16 v[94:95], v11 offset:41984
v_mfma_f32_16x16x32_bf16 v[140:143], v[64:67], v[56:59], v[140:143]
s_waitcnt lgkmcnt(8)
v_accvgpr_read_b32 v20, a24
v_accvgpr_read_b32 v28, a25
v_mfma_f32_16x16x32_bf16 v[156:159], v[72:75], v[56:59], v[156:159]
s_add_u32 m0, s64, 16384
ds_read_b64_tr_b16 v[64:65], v12 offset:32768
v_accvgpr_read_b32 v21, a26
v_mfma_f32_16x16x32_bf16 v[156:159], v[76:79], v[60:63], v[156:159]
s_add_u32 s72, s71, 0
buffer_load_dwordx4 v6, s[12:15], s72 offen lds
v_mfma_f32_16x16x32_bf16 v[152:155], v[76:79], v[52:55], v[152:155]
s_add_u32 s73, s62, 5
ds_read_b64_tr_b16 v[66:67], v12 offset:33792
v_accvgpr_read_b32 v29, a27
v_mfma_f32_16x16x32_bf16 v[152:155], v[72:75], v[48:51], v[152:155]
s_add_u32 s70, s73, s65
v_accvgpr_read_b32 v22, a56
v_accvgpr_read_b32 v30, a57
v_mfma_f32_16x16x32_bf16 v[148:151], v[72:75], v[40:43], v[148:151]
s_and_b32 s70, s70, 3
ds_read_b64_tr_b16 v[68:69], v12 offset:40960
v_accvgpr_read_b32 v23, a58
v_mfma_f32_16x16x32_bf16 v[148:151], v[76:79], v[44:47], v[148:151]
s_and_b32 s73, s73, 12
ds_read_b64_tr_b16 v[70:71], v12 offset:41984
v_accvgpr_read_b32 v31, a59
v_mfma_f32_16x16x32_bf16 v[144:147], v[76:79], v[36:39], v[144:147]
s_add_u32 s72, s71, 31744
buffer_load_dwordx4 v6, s[12:15], s72 offen offset:1024 lds
v_mfma_f32_16x16x32_bf16 v[144:147], v[72:75], v[32:35], v[144:147]
s_waitcnt lgkmcnt(8)
v_mul_f32 v20, s79, v20
v_mul_f32 v28, s79, v28
v_mfma_f32_16x16x32_bf16 v[160:163], v[80:83], v[32:35], v[160:163]
s_or_b32 s73, s73, s70
ds_read_b64_tr_b16 v[72:73], v13 offset:32768
v_mul_f32 v21, s79, v21
v_mfma_f32_16x16x32_bf16 v[160:163], v[84:87], v[36:39], v[160:163]
s_lshl_b32 s73, s73, 7
ds_read_b64_tr_b16 v[74:75], v13 offset:33792
v_mul_f32 v29, s79, v29
v_mfma_f32_16x16x32_bf16 v[164:167], v[84:87], v[44:47], v[164:167]
s_add_u32 s69, s73, s67
v_mul_f32 v22, s79, v22
v_mul_f32 v30, s79, v30
v_mfma_f32_16x16x32_bf16 v[164:167], v[80:83], v[40:43], v[164:167]
s_add_u32 s72, s71, 63488
buffer_load_dwordx4 v7, s[12:15], s72 offen offset:2048 lds
v_mfma_f32_16x16x32_bf16 v[168:171], v[80:83], v[48:51], v[168:171]
s_waitcnt vmcnt(18)
ds_read_b64_tr_b16 v[76:77], v13 offset:40960
v_mul_f32 v23, s79, v23
v_mfma_f32_16x16x32_bf16 v[168:171], v[84:87], v[52:55], v[168:171]
s_add_u32 s70, s73, s68
ds_read_b128 v[96:99], v16 offset:0
v_mul_f32 v31, s79, v31
v_mfma_f32_16x16x32_bf16 v[172:175], v[84:87], v[60:63], v[172:175]
ds_read_b64_tr_b16 v[78:79], v13 offset:41984
v_cvt_pk_bf16_f32 v20, v20, v28
v_mfma_f32_16x16x32_bf16 v[172:175], v[80:83], v[56:59], v[172:175]
s_waitcnt lgkmcnt(9)
ds_read_b128 v[100:103], v17 offset:0
v_cvt_pk_bf16_f32 v21, v21, v29
v_mfma_f32_16x16x32_bf16 v[188:191], v[88:91], v[56:59], v[188:191]
s_add_u32 s72, s71, 95232
buffer_load_dwordx4 v7, s[12:15], s72 offen offset:3072 lds
v_mfma_f32_16x16x32_bf16 v[188:191], v[92:95], v[60:63], v[188:191]
ds_read_b64_tr_b16 v[80:81], v14 offset:32768
v_cvt_pk_bf16_f32 v22, v22, v30
v_mfma_f32_16x16x32_bf16 v[184:187], v[92:95], v[52:55], v[184:187]
ds_read_b64_tr_b16 v[82:83], v14 offset:33792
v_cvt_pk_bf16_f32 v23, v23, v31
v_mfma_f32_16x16x32_bf16 v[184:187], v[88:91], v[48:51], v[184:187]
s_add_u32 s80, s77, 40960
buffer_store_dwordx4 v[20:23], v1, s[44:47], s80 offen sc1
v_mfma_f32_16x16x32_bf16 v[180:183], v[88:91], v[40:43], v[180:183]
ds_read_b64_tr_b16 v[84:85], v14 offset:40960
v_mfma_f32_16x16x32_bf16 v[180:183], v[92:95], v[44:47], v[180:183]
s_add_u32 m0, s63, 98304
ds_read_b64_tr_b16 v[86:87], v14 offset:41984
v_accvgpr_read_b32 v24, a160
v_mfma_f32_16x16x32_bf16 v[176:179], v[92:95], v[36:39], v[176:179]
s_add_u32 s72, s69, 0
buffer_load_dwordx4 v4, s[4:7], s72 offen lds
v_mfma_f32_16x16x32_bf16 v[176:179], v[88:91], v[32:35], v[176:179]
s_waitcnt lgkmcnt(10)
ds_read_b128 v[104:107], v16 offset:2048
v_accvgpr_read_b32 v28, a161
v_mfma_f32_16x16x32_bf16 v[192:195], v[64:67], v[32:35], v[192:195]
ds_read_b64_tr_b16 v[88:89], v15 offset:32768
v_accvgpr_read_b32 v25, a162
v_mfma_f32_16x16x32_bf16 v[192:195], v[68:71], v[36:39], v[192:195]
ds_read_b64_tr_b16 v[90:91], v15 offset:33792
v_accvgpr_read_b32 v29, a163
v_mfma_f32_16x16x32_bf16 v[196:199], v[68:71], v[44:47], v[196:199]
ds_read_b64_tr_b16 v[92:93], v15 offset:40960
v_accvgpr_read_b32 v26, a164
v_mfma_f32_16x16x32_bf16 v[196:199], v[64:67], v[40:43], v[196:199]
s_add_u32 s72, s69, 15360
buffer_load_dwordx4 v5, s[4:7], s72 offen offset:1024 lds
v_mfma_f32_16x16x32_bf16 v[200:203], v[64:67], v[48:51], v[200:203]
ds_read_b64_tr_b16 v[94:95], v15 offset:41984
v_accvgpr_read_b32 v30, a165
v_mfma_f32_16x16x32_bf16 v[200:203], v[68:71], v[52:55], v[200:203]
ds_read_b128 v[108:111], v17 offset:2048
v_accvgpr_read_b32 v27, a166
v_mfma_f32_16x16x32_bf16 v[204:207], v[68:71], v[60:63], v[204:207]
v_accvgpr_read_b32 v31, a167
v_cvt_pk_bf16_f32 v24, v24, v28
v_mfma_f32_16x16x32_bf16 v[204:207], v[64:67], v[56:59], v[204:207]
s_waitcnt lgkmcnt(11)
ds_read_b128 v[112:115], v16 offset:4096
v_cvt_pk_bf16_f32 v25, v25, v29
v_mfma_f32_16x16x32_bf16 v[220:223], v[72:75], v[56:59], v[220:223]
s_add_u32 s72, s69, 129024
buffer_load_dwordx4 v4, s[4:7], s72 offen offset:2048 lds
v_mfma_f32_16x16x32_bf16 v[220:223], v[76:79], v[60:63], v[220:223]
v_cvt_pk_bf16_f32 v26, v26, v30
v_cvt_pk_bf16_f32 v27, v27, v31
v_mfma_f32_16x16x32_bf16 v[216:219], v[76:79], v[52:55], v[216:219]
s_waitcnt vmcnt(19) lgkmcnt(2)
ds_read_b128 v[116:119], v17 offset:4096
v_mfma_f32_16x16x32_bf16 v[216:219], v[72:75], v[48:51], v[216:219]
s_barrier
ds_read_b128 v[120:123], v16 offset:6144
v_mfma_f32_16x16x32_bf16 v[212:215], v[72:75], v[40:43], v[212:215]
s_add_u32 s80, s78, 1024
ds_read_b64_tr_b16 v[64:65], v8 offset:0
ds_read_b64_tr_b16 v[66:67], v8 offset:1024
v_mfma_f32_16x16x32_bf16 v[212:215], v[76:79], v[44:47], v[212:215]
ds_read_b64_tr_b16 v[68:69], v8 offset:8192
v_mfma_f32_16x16x32_bf16 v[208:211], v[76:79], v[36:39], v[208:211]
s_add_u32 s72, s69, 144384
buffer_load_dwordx4 v5, s[4:7], s72 offen offset:3072 lds
v_mfma_f32_16x16x32_bf16 v[208:211], v[72:75], v[32:35], v[208:211]
ds_read_b64_tr_b16 v[70:71], v8 offset:9216
v_mfma_f32_16x16x32_bf16 v[224:227], v[80:83], v[32:35], v[224:227]
ds_read_b64_tr_b16 v[72:73], v9 offset:0
v_mfma_f32_16x16x32_bf16 v[224:227], v[84:87], v[36:39], v[224:227]
ds_read_b64_tr_b16 v[74:75], v9 offset:1024
v_mfma_f32_16x16x32_bf16 v[228:231], v[84:87], v[44:47], v[228:231]
s_add_u32 m0, s63, 102400
buffer_store_dwordx4 v[24:27], v1, s[44:47], s80 offen sc1
v_mfma_f32_16x16x32_bf16 v[228:231], v[80:83], v[40:43], v[228:231]
s_add_u32 s72, s70, 0
buffer_load_dwordx4 v4, s[4:7], s72 offen lds
v_mfma_f32_16x16x32_bf16 v[232:235], v[80:83], v[48:51], v[232:235]
ds_read_b64_tr_b16 v[76:77], v9 offset:8192
v_accvgpr_read_b32 v20, a28
v_mfma_f32_16x16x32_bf16 v[232:235], v[84:87], v[52:55], v[232:235]
ds_read_b128 v[124:127], v17 offset:6144
v_accvgpr_read_b32 v28, a29
v_mfma_f32_16x16x32_bf16 v[236:239], v[84:87], v[60:63], v[236:239]
ds_read_b64_tr_b16 v[78:79], v9 offset:9216
v_accvgpr_read_b32 v21, a30
v_mfma_f32_16x16x32_bf16 v[236:239], v[80:83], v[56:59], v[236:239]
v_accvgpr_read_b32 v29, a31
v_accvgpr_read_b32 v22, a60
v_mfma_f32_16x16x32_bf16 v[252:255], v[88:91], v[56:59], v[252:255]
s_add_u32 s72, s70, 15360
buffer_load_dwordx4 v5, s[4:7], s72 offen offset:1024 lds
v_mfma_f32_16x16x32_bf16 v[252:255], v[92:95], v[60:63], v[252:255]
ds_read_b64_tr_b16 v[80:81], v10 offset:0
v_accvgpr_read_b32 v30, a61
v_mfma_f32_16x16x32_bf16 v[248:251], v[92:95], v[52:55], v[248:251]
ds_read_b64_tr_b16 v[82:83], v10 offset:1024
v_accvgpr_read_b32 v23, a62
v_mfma_f32_16x16x32_bf16 v[248:251], v[88:91], v[48:51], v[248:251]
v_accvgpr_read_b32 v31, a63
v_mul_f32 v20, s79, v20
v_mfma_f32_16x16x32_bf16 v[244:247], v[88:91], v[40:43], v[244:247]
ds_read_b64_tr_b16 v[84:85], v10 offset:8192
v_mul_f32 v28, s79, v28
v_mfma_f32_16x16x32_bf16 v[244:247], v[92:95], v[44:47], v[244:247]
ds_read_b64_tr_b16 v[86:87], v10 offset:9216
v_mul_f32 v21, s79, v21
v_mfma_f32_16x16x32_bf16 v[240:243], v[92:95], v[36:39], v[240:243]
s_add_u32 s72, s70, 129024
buffer_load_dwordx4 v4, s[4:7], s72 offen offset:2048 lds
v_mfma_f32_16x16x32_bf16 v[240:243], v[88:91], v[32:35], v[240:243]
s_waitcnt lgkmcnt(5)
v_mul_f32 v29, s79, v29
v_mul_f32 v22, s79, v22
v_mfma_f32_16x16x32_bf16 v[128:131], v[64:67], v[96:99], v[128:131]
ds_read_b64_tr_b16 v[88:89], v11 offset:0
v_mul_f32 v30, s79, v30
v_mfma_f32_16x16x32_bf16 v[128:131], v[68:71], v[100:103], v[128:131]
ds_read_b64_tr_b16 v[90:91], v11 offset:1024
v_mul_f32 v23, s79, v23
v_mfma_f32_16x16x32_bf16 v[132:135], v[68:71], v[108:111], v[132:135]
v_mul_f32 v31, s79, v31
v_cvt_pk_bf16_f32 v20, v20, v28
v_mfma_f32_16x16x32_bf16 v[132:135], v[64:67], v[104:107], v[132:135]
s_add_u32 s72, s70, 144384
buffer_load_dwordx4 v5, s[4:7], s72 offen offset:3072 lds
v_mfma_f32_16x16x32_bf16 v[136:139], v[64:67], v[112:115], v[136:139]
ds_read_b64_tr_b16 v[92:93], v11 offset:8192
v_cvt_pk_bf16_f32 v21, v21, v29
v_mfma_f32_16x16x32_bf16 v[136:139], v[68:71], v[116:119], v[136:139]
s_lshl_b32 s71, s73, 12
v_cvt_pk_bf16_f32 v22, v22, v30
v_cvt_pk_bf16_f32 v23, v23, v31
v_mfma_f32_16x16x32_bf16 v[140:143], v[68:71], v[124:127], v[140:143]
s_add_u32 s71, s71, s66
ds_read_b64_tr_b16 v[94:95], v11 offset:9216
v_mfma_f32_16x16x32_bf16 v[140:143], v[64:67], v[120:123], v[140:143]
s_waitcnt lgkmcnt(8)
v_mfma_f32_16x16x32_bf16 v[156:159], v[72:75], v[120:123], v[156:159]
s_add_u32 m0, s64, 32768
ds_read_b64_tr_b16 v[64:65], v12 offset:0
v_mfma_f32_16x16x32_bf16 v[156:159], v[76:79], v[124:127], v[156:159]
s_add_u32 s72, s71, 0
buffer_load_dwordx4 v6, s[12:15], s72 offen lds
v_mfma_f32_16x16x32_bf16 v[152:155], v[76:79], v[116:119], v[152:155]
s_add_u32 s73, s62, 6
ds_read_b64_tr_b16 v[66:67], v12 offset:1024
v_accvgpr_read_b32 v24, a168
v_mfma_f32_16x16x32_bf16 v[152:155], v[72:75], v[112:115], v[152:155]
s_add_u32 s70, s73, s65
v_accvgpr_read_b32 v28, a169
v_accvgpr_read_b32 v25, a170
v_mfma_f32_16x16x32_bf16 v[148:151], v[72:75], v[104:107], v[148:151]
s_and_b32 s70, s70, 3
ds_read_b64_tr_b16 v[68:69], v12 offset:8192
v_accvgpr_read_b32 v29, a171
v_mfma_f32_16x16x32_bf16 v[148:151], v[76:79], v[108:111], v[148:151]
s_and_b32 s73, s73, 12
ds_read_b64_tr_b16 v[70:71], v12 offset:9216
v_accvgpr_read_b32 v26, a172
v_mfma_f32_16x16x32_bf16 v[144:147], v[76:79], v[100:103], v[144:147]
s_add_u32 s72, s71, 31744
buffer_load_dwordx4 v6, s[12:15], s72 offen offset:1024 lds
v_mfma_f32_16x16x32_bf16 v[144:147], v[72:75], v[96:99], v[144:147]
s_waitcnt lgkmcnt(8)
v_accvgpr_read_b32 v30, a173
v_accvgpr_read_b32 v27, a174
v_mfma_f32_16x16x32_bf16 v[160:163], v[80:83], v[96:99], v[160:163]
s_or_b32 s73, s73, s70
ds_read_b64_tr_b16 v[72:73], v13 offset:0
v_accvgpr_read_b32 v31, a175
v_mfma_f32_16x16x32_bf16 v[160:163], v[84:87], v[100:103], v[160:163]
s_lshl_b32 s73, s73, 7
ds_read_b64_tr_b16 v[74:75], v13 offset:1024
v_cvt_pk_bf16_f32 v24, v24, v28
v_mfma_f32_16x16x32_bf16 v[164:167], v[84:87], v[108:111], v[164:167]
s_add_u32 s69, s73, s67
v_cvt_pk_bf16_f32 v25, v25, v29
v_cvt_pk_bf16_f32 v26, v26, v30
v_mfma_f32_16x16x32_bf16 v[164:167], v[80:83], v[104:107], v[164:167]
s_add_u32 s72, s71, 63488
buffer_load_dwordx4 v7, s[12:15], s72 offen offset:2048 lds
v_mfma_f32_16x16x32_bf16 v[168:171], v[80:83], v[112:115], v[168:171]
s_waitcnt vmcnt(17)
ds_read_b64_tr_b16 v[76:77], v13 offset:8192
v_cvt_pk_bf16_f32 v27, v27, v31
v_mfma_f32_16x16x32_bf16 v[168:171], v[84:87], v[116:119], v[168:171]
s_add_u32 s70, s73, s68
ds_read_b128 v[32:35], v18 offset:0
v_mfma_f32_16x16x32_bf16 v[172:175], v[84:87], v[124:127], v[172:175]
s_add_u32 s80, s77, 45056
ds_read_b64_tr_b16 v[78:79], v13 offset:9216
v_mfma_f32_16x16x32_bf16 v[172:175], v[80:83], v[120:123], v[172:175]
s_waitcnt lgkmcnt(9)
ds_read_b128 v[36:39], v19 offset:0
v_mfma_f32_16x16x32_bf16 v[188:191], v[88:91], v[120:123], v[188:191]
s_add_u32 s72, s71, 95232
buffer_load_dwordx4 v7, s[12:15], s72 offen offset:3072 lds
v_mfma_f32_16x16x32_bf16 v[188:191], v[92:95], v[124:127], v[188:191]
ds_read_b64_tr_b16 v[80:81], v14 offset:0
v_mfma_f32_16x16x32_bf16 v[184:187], v[92:95], v[116:119], v[184:187]
ds_read_b64_tr_b16 v[82:83], v14 offset:1024
v_mfma_f32_16x16x32_bf16 v[184:187], v[88:91], v[112:115], v[184:187]
buffer_store_dwordx4 v[20:23], v1, s[44:47], s80 offen sc1
v_mfma_f32_16x16x32_bf16 v[180:183], v[88:91], v[104:107], v[180:183]
s_add_u32 s80, s78, 9216
ds_read_b64_tr_b16 v[84:85], v14 offset:8192
v_mfma_f32_16x16x32_bf16 v[180:183], v[92:95], v[108:111], v[180:183]
s_add_u32 m0, s63, 131072
ds_read_b64_tr_b16 v[86:87], v14 offset:9216
v_mfma_f32_16x16x32_bf16 v[176:179], v[92:95], v[100:103], v[176:179]
s_add_u32 s72, s69, 0
buffer_load_dwordx4 v4, s[4:7], s72 offen lds
v_mfma_f32_16x16x32_bf16 v[176:179], v[88:91], v[96:99], v[176:179]
s_waitcnt lgkmcnt(10)
ds_read_b128 v[40:43], v18 offset:2048
v_accvgpr_read_b32 v20, a64
v_mfma_f32_16x16x32_bf16 v[192:195], v[64:67], v[96:99], v[192:195]
ds_read_b64_tr_b16 v[88:89], v15 offset:0
v_accvgpr_read_b32 v28, a65
v_mfma_f32_16x16x32_bf16 v[192:195], v[68:71], v[100:103], v[192:195]
ds_read_b64_tr_b16 v[90:91], v15 offset:1024
v_accvgpr_read_b32 v21, a66
v_mfma_f32_16x16x32_bf16 v[196:199], v[68:71], v[108:111], v[196:199]
ds_read_b64_tr_b16 v[92:93], v15 offset:8192
v_accvgpr_read_b32 v29, a67
v_mfma_f32_16x16x32_bf16 v[196:199], v[64:67], v[104:107], v[196:199]
s_add_u32 s72, s69, 15360
buffer_load_dwordx4 v5, s[4:7], s72 offen offset:1024 lds
v_mfma_f32_16x16x32_bf16 v[200:203], v[64:67], v[112:115], v[200:203]
ds_read_b64_tr_b16 v[94:95], v15 offset:9216
v_accvgpr_read_b32 v22, a96
v_mfma_f32_16x16x32_bf16 v[200:203], v[68:71], v[116:119], v[200:203]
ds_read_b128 v[44:47], v19 offset:2048
v_accvgpr_read_b32 v30, a97
v_mfma_f32_16x16x32_bf16 v[204:207], v[68:71], v[124:127], v[204:207]
buffer_store_dwordx4 v[24:27], v1, s[44:47], s80 offen sc1
v_mfma_f32_16x16x32_bf16 v[204:207], v[64:67], v[120:123], v[204:207]
s_waitcnt lgkmcnt(11)
ds_read_b128 v[48:51], v18 offset:4096
v_accvgpr_read_b32 v23, a98
v_mfma_f32_16x16x32_bf16 v[220:223], v[72:75], v[120:123], v[220:223]
s_add_u32 s72, s69, 129024
buffer_load_dwordx4 v4, s[4:7], s72 offen offset:2048 lds
v_mfma_f32_16x16x32_bf16 v[220:223], v[76:79], v[124:127], v[220:223]
v_accvgpr_read_b32 v31, a99
v_mul_f32 v20, s79, v20
v_mfma_f32_16x16x32_bf16 v[216:219], v[76:79], v[116:119], v[216:219]
s_waitcnt vmcnt(19) lgkmcnt(2)
ds_read_b128 v[52:55], v19 offset:4096
v_mul_f32 v28, s79, v28
v_mfma_f32_16x16x32_bf16 v[216:219], v[72:75], v[112:115], v[216:219]
s_barrier
ds_read_b128 v[56:59], v18 offset:6144
v_mul_f32 v21, s79, v21
v_mfma_f32_16x16x32_bf16 v[212:215], v[72:75], v[104:107], v[212:215]
ds_read_b64_tr_b16 v[64:65], v8 offset:16384
ds_read_b64_tr_b16 v[66:67], v8 offset:17408
v_mfma_f32_16x16x32_bf16 v[212:215], v[76:79], v[108:111], v[212:215]
ds_read_b64_tr_b16 v[68:69], v8 offset:24576
v_mul_f32 v29, s79, v29
v_mfma_f32_16x16x32_bf16 v[208:211], v[76:79], v[100:103], v[208:211]
s_add_u32 s72, s69, 144384
buffer_load_dwordx4 v5, s[4:7], s72 offen offset:3072 lds
v_mfma_f32_16x16x32_bf16 v[208:211], v[72:75], v[96:99], v[208:211]
ds_read_b64_tr_b16 v[70:71], v8 offset:25600
v_mul_f32 v22, s79, v22
v_mfma_f32_16x16x32_bf16 v[224:227], v[80:83], v[96:99], v[224:227]
ds_read_b64_tr_b16 v[72:73], v9 offset:16384
v_mul_f32 v30, s79, v30
v_mfma_f32_16x16x32_bf16 v[224:227], v[84:87], v[100:103], v[224:227]
ds_read_b64_tr_b16 v[74:75], v9 offset:17408
v_mul_f32 v23, s79, v23
v_mfma_f32_16x16x32_bf16 v[228:231], v[84:87], v[108:111], v[228:231]
s_add_u32 m0, s63, 135168
v_mul_f32 v31, s79, v31
v_cvt_pk_bf16_f32 v20, v20, v28
v_mfma_f32_16x16x32_bf16 v[228:231], v[80:83], v[104:107], v[228:231]
s_add_u32 s72, s70, 0
buffer_load_dwordx4 v4, s[4:7], s72 offen lds
v_mfma_f32_16x16x32_bf16 v[232:235], v[80:83], v[112:115], v[232:235]
ds_read_b64_tr_b16 v[76:77], v9 offset:24576
v_cvt_pk_bf16_f32 v21, v21, v29
v_mfma_f32_16x16x32_bf16 v[232:235], v[84:87], v[116:119], v[232:235]
ds_read_b128 v[60:63], v19 offset:6144
v_cvt_pk_bf16_f32 v22, v22, v30
v_mfma_f32_16x16x32_bf16 v[236:239], v[84:87], v[124:127], v[236:239]
ds_read_b64_tr_b16 v[78:79], v9 offset:25600
v_cvt_pk_bf16_f32 v23, v23, v31
v_mfma_f32_16x16x32_bf16 v[236:239], v[80:83], v[120:123], v[236:239]
s_add_u32 s80, s77, 1024
buffer_store_dwordx4 v[20:23], v1, s[44:47], s80 offen sc1
v_mfma_f32_16x16x32_bf16 v[252:255], v[88:91], v[120:123], v[252:255]
s_add_u32 s72, s70, 15360
buffer_load_dwordx4 v5, s[4:7], s72 offen offset:1024 lds
v_mfma_f32_16x16x32_bf16 v[252:255], v[92:95], v[124:127], v[252:255]
ds_read_b64_tr_b16 v[80:81], v10 offset:16384
v_accvgpr_read_b32 v24, a176
v_mfma_f32_16x16x32_bf16 v[248:251], v[92:95], v[116:119], v[248:251]
ds_read_b64_tr_b16 v[82:83], v10 offset:17408
v_accvgpr_read_b32 v28, a177
v_mfma_f32_16x16x32_bf16 v[248:251], v[88:91], v[112:115], v[248:251]
v_accvgpr_read_b32 v25, a178
v_accvgpr_read_b32 v29, a179
v_mfma_f32_16x16x32_bf16 v[244:247], v[88:91], v[104:107], v[244:247]
ds_read_b64_tr_b16 v[84:85], v10 offset:24576
v_accvgpr_read_b32 v26, a180
v_mfma_f32_16x16x32_bf16 v[244:247], v[92:95], v[108:111], v[244:247]
ds_read_b64_tr_b16 v[86:87], v10 offset:25600
v_accvgpr_read_b32 v30, a181
v_mfma_f32_16x16x32_bf16 v[240:243], v[92:95], v[100:103], v[240:243]
s_add_u32 s72, s70, 129024
buffer_load_dwordx4 v4, s[4:7], s72 offen offset:2048 lds
v_mfma_f32_16x16x32_bf16 v[240:243], v[88:91], v[96:99], v[240:243]
s_waitcnt lgkmcnt(5)
v_accvgpr_read_b32 v27, a182
v_accvgpr_read_b32 v31, a183
v_mfma_f32_16x16x32_bf16 v[128:131], v[64:67], v[32:35], v[128:131]
ds_read_b64_tr_b16 v[88:89], v11 offset:16384
v_cvt_pk_bf16_f32 v24, v24, v28
v_mfma_f32_16x16x32_bf16 v[128:131], v[68:71], v[36:39], v[128:131]
ds_read_b64_tr_b16 v[90:91], v11 offset:17408
v_cvt_pk_bf16_f32 v25, v25, v29
v_mfma_f32_16x16x32_bf16 v[132:135], v[68:71], v[44:47], v[132:135]
v_cvt_pk_bf16_f32 v26, v26, v30
v_cvt_pk_bf16_f32 v27, v27, v31
v_mfma_f32_16x16x32_bf16 v[132:135], v[64:67], v[40:43], v[132:135]
s_add_u32 s72, s70, 144384
buffer_load_dwordx4 v5, s[4:7], s72 offen offset:3072 lds
v_mfma_f32_16x16x32_bf16 v[136:139], v[64:67], v[48:51], v[136:139]
s_add_u32 s80, s78, 33792
ds_read_b64_tr_b16 v[92:93], v11 offset:24576
v_mfma_f32_16x16x32_bf16 v[136:139], v[68:71], v[52:55], v[136:139]
s_lshl_b32 s71, s73, 12
buffer_store_dwordx4 v[24:27], v1, s[44:47], s80 offen sc1
v_mfma_f32_16x16x32_bf16 v[140:143], v[68:71], v[60:63], v[140:143]
s_add_u32 s71, s71, s66
ds_read_b64_tr_b16 v[94:95], v11 offset:25600
v_mfma_f32_16x16x32_bf16 v[140:143], v[64:67], v[56:59], v[140:143]
s_waitcnt lgkmcnt(8)
v_mfma_f32_16x16x32_bf16 v[156:159], v[72:75], v[56:59], v[156:159]
s_add_u32 m0, s64, 0
ds_read_b64_tr_b16 v[64:65], v12 offset:16384
v_mfma_f32_16x16x32_bf16 v[156:159], v[76:79], v[60:63], v[156:159]
s_add_u32 s72, s71, 0
buffer_load_dwordx4 v6, s[12:15], s72 offen lds
v_mfma_f32_16x16x32_bf16 v[152:155], v[76:79], v[52:55], v[152:155]
s_add_u32 s73, s62, 7
ds_read_b64_tr_b16 v[66:67], v12 offset:17408
v_mfma_f32_16x16x32_bf16 v[152:155], v[72:75], v[48:51], v[152:155]
s_add_u32 s70, s73, s65
v_mfma_f32_16x16x32_bf16 v[148:151], v[72:75], v[40:43], v[148:151]
s_and_b32 s70, s70, 3
ds_read_b64_tr_b16 v[68:69], v12 offset:24576
v_accvgpr_read_b32 v20, a68
v_mfma_f32_16x16x32_bf16 v[148:151], v[76:79], v[44:47], v[148:151]
s_and_b32 s73, s73, 12
ds_read_b64_tr_b16 v[70:71], v12 offset:25600
v_accvgpr_read_b32 v28, a69
v_mfma_f32_16x16x32_bf16 v[144:147], v[76:79], v[36:39], v[144:147]
s_add_u32 s72, s71, 31744
buffer_load_dwordx4 v6, s[12:15], s72 offen offset:1024 lds
v_mfma_f32_16x16x32_bf16 v[144:147], v[72:75], v[32:35], v[144:147]
s_waitcnt lgkmcnt(8)
v_accvgpr_read_b32 v21, a70
v_accvgpr_read_b32 v29, a71
v_mfma_f32_16x16x32_bf16 v[160:163], v[80:83], v[32:35], v[160:163]
s_or_b32 s73, s73, s70
ds_read_b64_tr_b16 v[72:73], v13 offset:16384
v_accvgpr_read_b32 v22, a100
v_mfma_f32_16x16x32_bf16 v[160:163], v[84:87], v[36:39], v[160:163]
s_lshl_b32 s73, s73, 7
ds_read_b64_tr_b16 v[74:75], v13 offset:17408
v_accvgpr_read_b32 v30, a101
v_mfma_f32_16x16x32_bf16 v[164:167], v[84:87], v[44:47], v[164:167]
s_add_u32 s69, s73, s67
v_accvgpr_read_b32 v23, a102
v_accvgpr_read_b32 v31, a103
v_mfma_f32_16x16x32_bf16 v[164:167], v[80:83], v[40:43], v[164:167]
s_add_u32 s72, s71, 63488
buffer_load_dwordx4 v7, s[12:15], s72 offen offset:2048 lds
v_mfma_f32_16x16x32_bf16 v[168:171], v[80:83], v[48:51], v[168:171]
s_waitcnt vmcnt(19)
ds_read_b64_tr_b16 v[76:77], v13 offset:24576
v_mul_f32 v20, s79, v20
v_mfma_f32_16x16x32_bf16 v[168:171], v[84:87], v[52:55], v[168:171]
s_add_u32 s70, s73, s68
ds_read_b128 v[96:99], v18 offset:32768
v_mul_f32 v28, s79, v28
v_mfma_f32_16x16x32_bf16 v[172:175], v[84:87], v[60:63], v[172:175]
ds_read_b64_tr_b16 v[78:79], v13 offset:25600
v_mul_f32 v21, s79, v21
v_mfma_f32_16x16x32_bf16 v[172:175], v[80:83], v[56:59], v[172:175]
s_waitcnt lgkmcnt(9)
ds_read_b128 v[100:103], v19 offset:32768
v_mul_f32 v29, s79, v29
v_mfma_f32_16x16x32_bf16 v[188:191], v[88:91], v[56:59], v[188:191]
s_add_u32 s72, s71, 95232
buffer_load_dwordx4 v7, s[12:15], s72 offen offset:3072 lds
v_mfma_f32_16x16x32_bf16 v[188:191], v[92:95], v[60:63], v[188:191]
ds_read_b64_tr_b16 v[80:81], v14 offset:16384
v_mul_f32 v22, s79, v22
v_mfma_f32_16x16x32_bf16 v[184:187], v[92:95], v[52:55], v[184:187]
ds_read_b64_tr_b16 v[82:83], v14 offset:17408
v_mul_f32 v30, s79, v30
v_mfma_f32_16x16x32_bf16 v[184:187], v[88:91], v[48:51], v[184:187]
v_mul_f32 v23, s79, v23
v_mul_f32 v31, s79, v31
v_mfma_f32_16x16x32_bf16 v[180:183], v[88:91], v[40:43], v[180:183]
ds_read_b64_tr_b16 v[84:85], v14 offset:24576
v_cvt_pk_bf16_f32 v20, v20, v28
v_mfma_f32_16x16x32_bf16 v[180:183], v[92:95], v[44:47], v[180:183]
s_add_u32 m0, s63, 65536
ds_read_b64_tr_b16 v[86:87], v14 offset:25600
v_cvt_pk_bf16_f32 v21, v21, v29
v_mfma_f32_16x16x32_bf16 v[176:179], v[92:95], v[36:39], v[176:179]
s_add_u32 s72, s69, 0
buffer_load_dwordx4 v4, s[4:7], s72 offen lds
v_mfma_f32_16x16x32_bf16 v[176:179], v[88:91], v[32:35], v[176:179]
s_waitcnt lgkmcnt(10)
ds_read_b128 v[104:107], v18 offset:34816
v_cvt_pk_bf16_f32 v22, v22, v30
v_mfma_f32_16x16x32_bf16 v[192:195], v[64:67], v[32:35], v[192:195]
ds_read_b64_tr_b16 v[88:89], v15 offset:16384
v_cvt_pk_bf16_f32 v23, v23, v31
v_mfma_f32_16x16x32_bf16 v[192:195], v[68:71], v[36:39], v[192:195]
s_add_u32 s80, s77, 5120
ds_read_b64_tr_b16 v[90:91], v15 offset:17408
v_mfma_f32_16x16x32_bf16 v[196:199], v[68:71], v[44:47], v[196:199]
ds_read_b64_tr_b16 v[92:93], v15 offset:24576
v_accvgpr_read_b32 v24, a184
v_mfma_f32_16x16x32_bf16 v[196:199], v[64:67], v[40:43], v[196:199]
s_add_u32 s72, s69, 15360
buffer_load_dwordx4 v5, s[4:7], s72 offen offset:1024 lds
v_mfma_f32_16x16x32_bf16 v[200:203], v[64:67], v[48:51], v[200:203]
ds_read_b64_tr_b16 v[94:95], v15 offset:25600
v_accvgpr_read_b32 v28, a185
v_mfma_f32_16x16x32_bf16 v[200:203], v[68:71], v[52:55], v[200:203]
ds_read_b128 v[108:111], v19 offset:34816
v_accvgpr_read_b32 v25, a186
v_mfma_f32_16x16x32_bf16 v[204:207], v[68:71], v[60:63], v[204:207]
buffer_store_dwordx4 v[20:23], v1, s[44:47], s80 offen sc1
v_mfma_f32_16x16x32_bf16 v[204:207], v[64:67], v[56:59], v[204:207]
s_waitcnt lgkmcnt(11)
ds_read_b128 v[112:115], v18 offset:36864
v_accvgpr_read_b32 v29, a187
v_mfma_f32_16x16x32_bf16 v[220:223], v[72:75], v[56:59], v[220:223]
s_add_u32 s72, s69, 129024
buffer_load_dwordx4 v4, s[4:7], s72 offen offset:2048 lds
v_mfma_f32_16x16x32_bf16 v[220:223], v[76:79], v[60:63], v[220:223]
v_accvgpr_read_b32 v26, a188
v_accvgpr_read_b32 v30, a189
v_mfma_f32_16x16x32_bf16 v[216:219], v[76:79], v[52:55], v[216:219]
s_waitcnt vmcnt(20) lgkmcnt(2)
ds_read_b128 v[116:119], v19 offset:36864
v_accvgpr_read_b32 v27, a190
v_mfma_f32_16x16x32_bf16 v[216:219], v[72:75], v[48:51], v[216:219]
s_barrier
ds_read_b128 v[120:123], v18 offset:38912
v_accvgpr_read_b32 v31, a191
v_mfma_f32_16x16x32_bf16 v[212:215], v[72:75], v[40:43], v[212:215]
ds_read_b64_tr_b16 v[64:65], v8 offset:32768
ds_read_b64_tr_b16 v[66:67], v8 offset:33792
v_mfma_f32_16x16x32_bf16 v[212:215], v[76:79], v[44:47], v[212:215]
ds_read_b64_tr_b16 v[68:69], v8 offset:40960
v_cvt_pk_bf16_f32 v24, v24, v28
v_mfma_f32_16x16x32_bf16 v[208:211], v[76:79], v[36:39], v[208:211]
s_add_u32 s72, s69, 144384
buffer_load_dwordx4 v5, s[4:7], s72 offen offset:3072 lds
v_mfma_f32_16x16x32_bf16 v[208:211], v[72:75], v[32:35], v[208:211]
ds_read_b64_tr_b16 v[70:71], v8 offset:41984
v_cvt_pk_bf16_f32 v25, v25, v29
v_mfma_f32_16x16x32_bf16 v[224:227], v[80:83], v[32:35], v[224:227]
ds_read_b64_tr_b16 v[72:73], v9 offset:32768
v_cvt_pk_bf16_f32 v26, v26, v30
v_mfma_f32_16x16x32_bf16 v[224:227], v[84:87], v[36:39], v[224:227]
ds_read_b64_tr_b16 v[74:75], v9 offset:33792
v_cvt_pk_bf16_f32 v27, v27, v31
v_mfma_f32_16x16x32_bf16 v[228:231], v[84:87], v[44:47], v[228:231]
s_add_u32 m0, s63, 69632
v_mfma_f32_16x16x32_bf16 v[228:231], v[80:83], v[40:43], v[228:231]
s_add_u32 s72, s70, 0
buffer_load_dwordx4 v4, s[4:7], s72 offen lds
v_mfma_f32_16x16x32_bf16 v[232:235], v[80:83], v[48:51], v[232:235]
s_add_u32 s80, s78, 41984
ds_read_b64_tr_b16 v[76:77], v9 offset:40960
v_mfma_f32_16x16x32_bf16 v[232:235], v[84:87], v[52:55], v[232:235]
ds_read_b128 v[124:127], v19 offset:38912
v_mfma_f32_16x16x32_bf16 v[236:239], v[84:87], v[60:63], v[236:239]
ds_read_b64_tr_b16 v[78:79], v9 offset:41984
v_mfma_f32_16x16x32_bf16 v[236:239], v[80:83], v[56:59], v[236:239]
buffer_store_dwordx4 v[24:27], v1, s[44:47], s80 offen sc1
v_mfma_f32_16x16x32_bf16 v[252:255], v[88:91], v[56:59], v[252:255]
s_add_u32 s72, s70, 15360
buffer_load_dwordx4 v5, s[4:7], s72 offen offset:1024 lds
v_mfma_f32_16x16x32_bf16 v[252:255], v[92:95], v[60:63], v[252:255]
ds_read_b64_tr_b16 v[80:81], v10 offset:32768
v_accvgpr_read_b32 v20, a72
v_mfma_f32_16x16x32_bf16 v[248:251], v[92:95], v[52:55], v[248:251]
ds_read_b64_tr_b16 v[82:83], v10 offset:33792
v_accvgpr_read_b32 v28, a73
v_mfma_f32_16x16x32_bf16 v[248:251], v[88:91], v[48:51], v[248:251]
v_accvgpr_read_b32 v21, a74
v_accvgpr_read_b32 v29, a75
v_mfma_f32_16x16x32_bf16 v[244:247], v[88:91], v[40:43], v[244:247]
ds_read_b64_tr_b16 v[84:85], v10 offset:40960
v_accvgpr_read_b32 v22, a104
v_mfma_f32_16x16x32_bf16 v[244:247], v[92:95], v[44:47], v[244:247]
ds_read_b64_tr_b16 v[86:87], v10 offset:41984
v_accvgpr_read_b32 v30, a105
v_mfma_f32_16x16x32_bf16 v[240:243], v[92:95], v[36:39], v[240:243]
s_add_u32 s72, s70, 129024
buffer_load_dwordx4 v4, s[4:7], s72 offen offset:2048 lds
v_mfma_f32_16x16x32_bf16 v[240:243], v[88:91], v[32:35], v[240:243]
s_waitcnt lgkmcnt(5)
v_accvgpr_read_b32 v23, a106
v_accvgpr_read_b32 v31, a107
v_mfma_f32_16x16x32_bf16 v[128:131], v[64:67], v[96:99], v[128:131]
s_lshr_b32 s75, s93, 4
ds_read_b64_tr_b16 v[88:89], v11 offset:32768
v_mul_f32 v20, s79, v20
v_mfma_f32_16x16x32_bf16 v[128:131], v[68:71], v[100:103], v[128:131]
s_and_b32 s75, s75, 0x7f00
ds_read_b64_tr_b16 v[90:91], v11 offset:33792
v_mul_f32 v28, s79, v28
v_mfma_f32_16x16x32_bf16 v[132:135], v[68:71], v[108:111], v[132:135]
s_add_u32 s75, s75, LcB1-Lpc0
v_lshrrev_b32 v2, 5, v0
v_lshlrev_b32 v2, 7, v2
v_mfma_f32_16x16x32_bf16 v[132:135], v[64:67], v[104:107], v[132:135]
s_add_u32 s72, s70, 144384
buffer_load_dwordx4 v5, s[4:7], s72 offen offset:3072 lds
v_mfma_f32_16x16x32_bf16 v[136:139], v[64:67], v[112:115], v[136:139]
v_add_u32 v2, s75, v2
v_min_u32 v2, Lcode_end-Lpc0, v2
v_mfma_f32_16x16x32_bf16 v[136:139], v[68:71], v[116:119], v[136:139]
s_lshl_b32 s71, s73, 12
global_load_dword v3, v2, s[98:99]
v_mfma_f32_16x16x32_bf16 v[140:143], v[68:71], v[124:127], v[140:143]
s_add_u32 s71, s71, s66
ds_read_b64_tr_b16 v[92:93], v11 offset:40960
v_mul_f32 v21, s79, v21
v_mfma_f32_16x16x32_bf16 v[140:143], v[64:67], v[120:123], v[140:143]
s_waitcnt lgkmcnt(7)
ds_read_b64_tr_b16 v[94:95], v11 offset:41984
v_mul_f32 v29, s79, v29
v_mfma_f32_16x16x32_bf16 v[156:159], v[72:75], v[120:123], v[156:159]
s_add_u32 m0, s64, 16384
ds_read_b64_tr_b16 v[64:65], v12 offset:32768
v_mul_f32 v22, s79, v22
v_mfma_f32_16x16x32_bf16 v[156:159], v[76:79], v[124:127], v[156:159]
s_add_u32 s72, s71, 0
buffer_load_dwordx4 v6, s[12:15], s72 offen lds
v_mfma_f32_16x16x32_bf16 v[152:155], v[76:79], v[116:119], v[152:155]
s_add_u32 s73, s62, 8
ds_read_b64_tr_b16 v[66:67], v12 offset:33792
v_mul_f32 v30, s79, v30
v_mfma_f32_16x16x32_bf16 v[152:155], v[72:75], v[112:115], v[152:155]
s_add_u32 s70, s73, s65
v_mul_f32 v23, s79, v23
v_mul_f32 v31, s79, v31
v_mfma_f32_16x16x32_bf16 v[148:151], v[72:75], v[104:107], v[148:151]
s_and_b32 s70, s70, 3
ds_read_b64_tr_b16 v[68:69], v12 offset:40960
v_cvt_pk_bf16_f32 v20, v20, v28
v_mfma_f32_16x16x32_bf16 v[148:151], v[76:79], v[108:111], v[148:151]
s_and_b32 s73, s73, 12
ds_read_b64_tr_b16 v[70:71], v12 offset:41984
v_cvt_pk_bf16_f32 v21, v21, v29
v_mfma_f32_16x16x32_bf16 v[144:147], v[76:79], v[100:103], v[144:147]
s_add_u32 s72, s71, 31744
buffer_load_dwordx4 v6, s[12:15], s72 offen offset:1024 lds
v_mfma_f32_16x16x32_bf16 v[144:147], v[72:75], v[96:99], v[144:147]
s_waitcnt lgkmcnt(8)
v_cvt_pk_bf16_f32 v22, v22, v30
v_cvt_pk_bf16_f32 v23, v23, v31
v_mfma_f32_16x16x32_bf16 v[160:163], v[80:83], v[96:99], v[160:163]
s_or_b32 s73, s73, s70
ds_read_b64_tr_b16 v[72:73], v13 offset:32768
v_accvgpr_read_b32 v24, a192
v_mfma_f32_16x16x32_bf16 v[160:163], v[84:87], v[100:103], v[160:163]
s_lshl_b32 s73, s73, 7
ds_read_b64_tr_b16 v[74:75], v13 offset:33792
v_accvgpr_read_b32 v28, a193
v_mfma_f32_16x16x32_bf16 v[164:167], v[84:87], v[108:111], v[164:167]
s_add_u32 s69, s73, s67
v_accvgpr_read_b32 v25, a194
v_accvgpr_read_b32 v29, a195
v_mfma_f32_16x16x32_bf16 v[164:167], v[80:83], v[104:107], v[164:167]
s_add_u32 s72, s71, 63488
buffer_load_dwordx4 v7, s[12:15], s72 offen offset:2048 lds
v_mfma_f32_16x16x32_bf16 v[168:171], v[80:83], v[112:115], v[168:171]
s_waitcnt vmcnt(19)
ds_read_b64_tr_b16 v[76:77], v13 offset:40960
v_accvgpr_read_b32 v26, a196
v_mfma_f32_16x16x32_bf16 v[168:171], v[84:87], v[116:119], v[168:171]
s_add_u32 s70, s73, s68
ds_read_b128 v[32:35], v16 offset:0
v_accvgpr_read_b32 v30, a197
v_mfma_f32_16x16x32_bf16 v[172:175], v[84:87], v[124:127], v[172:175]
s_add_u32 s80, s77, 9216
ds_read_b64_tr_b16 v[78:79], v13 offset:41984
v_accvgpr_read_b32 v27, a198
v_mfma_f32_16x16x32_bf16 v[172:175], v[80:83], v[120:123], v[172:175]
s_waitcnt lgkmcnt(9)
ds_read_b128 v[36:39], v17 offset:0
v_accvgpr_read_b32 v31, a199
v_mfma_f32_16x16x32_bf16 v[188:191], v[88:91], v[120:123], v[188:191]
s_add_u32 s72, s71, 95232
buffer_load_dwordx4 v7, s[12:15], s72 offen offset:3072 lds
v_mfma_f32_16x16x32_bf16 v[188:191], v[92:95], v[124:127], v[188:191]
ds_read_b64_tr_b16 v[80:81], v14 offset:32768
v_cvt_pk_bf16_f32 v24, v24, v28
v_mfma_f32_16x16x32_bf16 v[184:187], v[92:95], v[116:119], v[184:187]
ds_read_b64_tr_b16 v[82:83], v14 offset:33792
v_cvt_pk_bf16_f32 v25, v25, v29
v_mfma_f32_16x16x32_bf16 v[184:187], v[88:91], v[112:115], v[184:187]
buffer_store_dwordx4 v[20:23], v1, s[44:47], s80 offen sc1
v_mfma_f32_16x16x32_bf16 v[180:183], v[88:91], v[104:107], v[180:183]
ds_read_b64_tr_b16 v[84:85], v14 offset:40960
v_cvt_pk_bf16_f32 v26, v26, v30
v_mfma_f32_16x16x32_bf16 v[180:183], v[92:95], v[108:111], v[180:183]
s_add_u32 m0, s63, 98304
ds_read_b64_tr_b16 v[86:87], v14 offset:41984
v_cvt_pk_bf16_f32 v27, v27, v31
v_mfma_f32_16x16x32_bf16 v[176:179], v[92:95], v[100:103], v[176:179]
s_add_u32 s72, s69, 0
buffer_load_dwordx4 v4, s[4:7], s72 offen lds
v_mfma_f32_16x16x32_bf16 v[176:179], v[88:91], v[96:99], v[176:179]
s_waitcnt lgkmcnt(10)
ds_read_b128 v[40:43], v16 offset:2048
v_mfma_f32_16x16x32_bf16 v[192:195], v[64:67], v[96:99], v[192:195]
s_add_u32 s80, s78, 2048
ds_read_b64_tr_b16 v[88:89], v15 offset:32768
v_mfma_f32_16x16x32_bf16 v[192:195], v[68:71], v[100:103], v[192:195]
ds_read_b64_tr_b16 v[90:91], v15 offset:33792
v_mfma_f32_16x16x32_bf16 v[196:199], v[68:71], v[108:111], v[196:199]
ds_read_b64_tr_b16 v[92:93], v15 offset:40960
v_mfma_f32_16x16x32_bf16 v[196:199], v[64:67], v[104:107], v[196:199]
s_add_u32 s72, s69, 15360
buffer_load_dwordx4 v5, s[4:7], s72 offen offset:1024 lds
v_mfma_f32_16x16x32_bf16 v[200:203], v[64:67], v[112:115], v[200:203]
ds_read_b64_tr_b16 v[94:95], v15 offset:41984
v_accvgpr_read_b32 v20, a76
v_mfma_f32_16x16x32_bf16 v[200:203], v[68:71], v[116:119], v[200:203]
ds_read_b128 v[44:47], v17 offset:2048
v_accvgpr_read_b32 v28, a77
v_mfma_f32_16x16x32_bf16 v[204:207], v[68:71], v[124:127], v[204:207]
buffer_store_dwordx4 v[24:27], v1, s[44:47], s80 offen sc1
v_mfma_f32_16x16x32_bf16 v[204:207], v[64:67], v[120:123], v[204:207]
s_waitcnt lgkmcnt(11)
ds_read_b128 v[48:51], v16 offset:4096
v_accvgpr_read_b32 v21, a78
v_mfma_f32_16x16x32_bf16 v[220:223], v[72:75], v[120:123], v[220:223]
s_add_u32 s72, s69, 129024
buffer_load_dwordx4 v4, s[4:7], s72 offen offset:2048 lds
v_mfma_f32_16x16x32_bf16 v[220:223], v[76:79], v[124:127], v[220:223]
v_accvgpr_read_b32 v29, a79
v_accvgpr_read_b32 v22, a108
v_mfma_f32_16x16x32_bf16 v[216:219], v[76:79], v[116:119], v[216:219]
s_waitcnt vmcnt(20) lgkmcnt(2)
ds_read_b128 v[52:55], v17 offset:4096
v_accvgpr_read_b32 v30, a109
v_mfma_f32_16x16x32_bf16 v[216:219], v[72:75], v[112:115], v[216:219]
s_barrier
ds_read_b128 v[56:59], v16 offset:6144
v_accvgpr_read_b32 v23, a110
v_mfma_f32_16x16x32_bf16 v[212:215], v[72:75], v[104:107], v[212:215]
ds_read_b64_tr_b16 v[64:65], v8 offset:0
ds_read_b64_tr_b16 v[66:67], v8 offset:1024
v_mfma_f32_16x16x32_bf16 v[212:215], v[76:79], v[108:111], v[212:215]
ds_read_b64_tr_b16 v[68:69], v8 offset:8192
v_accvgpr_read_b32 v31, a111
v_mfma_f32_16x16x32_bf16 v[208:211], v[76:79], v[100:103], v[208:211]
s_add_u32 s72, s69, 144384
buffer_load_dwordx4 v5, s[4:7], s72 offen offset:3072 lds
v_mfma_f32_16x16x32_bf16 v[208:211], v[72:75], v[96:99], v[208:211]
ds_read_b64_tr_b16 v[70:71], v8 offset:9216
v_mul_f32 v20, s79, v20
v_mfma_f32_16x16x32_bf16 v[224:227], v[80:83], v[96:99], v[224:227]
ds_read_b64_tr_b16 v[72:73], v9 offset:0
v_mul_f32 v28, s79, v28
v_mfma_f32_16x16x32_bf16 v[224:227], v[84:87], v[100:103], v[224:227]
ds_read_b64_tr_b16 v[74:75], v9 offset:1024
v_mul_f32 v21, s79, v21
v_mfma_f32_16x16x32_bf16 v[228:231], v[84:87], v[108:111], v[228:231]
s_add_u32 m0, s63, 102400
v_mul_f32 v29, s79, v29
v_mul_f32 v22, s79, v22
v_mfma_f32_16x16x32_bf16 v[228:231], v[80:83], v[104:107], v[228:231]
s_add_u32 s72, s70, 0
buffer_load_dwordx4 v4, s[4:7], s72 offen lds
v_mfma_f32_16x16x32_bf16 v[232:235], v[80:83], v[112:115], v[232:235]
ds_read_b64_tr_b16 v[76:77], v9 offset:8192
v_mul_f32 v30, s79, v30
v_mfma_f32_16x16x32_bf16 v[232:235], v[84:87], v[116:119], v[232:235]
ds_read_b128 v[60:63], v17 offset:6144
v_mul_f32 v23, s79, v23
v_mfma_f32_16x16x32_bf16 v[236:239], v[84:87], v[124:127], v[236:239]
ds_read_b64_tr_b16 v[78:79], v9 offset:9216
v_mul_f32 v31, s79, v31
v_mfma_f32_16x16x32_bf16 v[236:239], v[80:83], v[120:123], v[236:239]
v_cvt_pk_bf16_f32 v20, v20, v28
v_cvt_pk_bf16_f32 v21, v21, v29
v_mfma_f32_16x16x32_bf16 v[252:255], v[88:91], v[120:123], v[252:255]
s_add_u32 s72, s70, 15360
buffer_load_dwordx4 v5, s[4:7], s72 offen offset:1024 lds
v_mfma_f32_16x16x32_bf16 v[252:255], v[92:95], v[124:127], v[252:255]
ds_read_b64_tr_b16 v[80:81], v10 offset:0
v_cvt_pk_bf16_f32 v22, v22, v30
v_mfma_f32_16x16x32_bf16 v[248:251], v[92:95], v[116:119], v[248:251]
ds_read_b64_tr_b16 v[82:83], v10 offset:1024
v_cvt_pk_bf16_f32 v23, v23, v31
v_mfma_f32_16x16x32_bf16 v[248:251], v[88:91], v[112:115], v[248:251]
s_add_u32 s80, s77, 13312
buffer_store_dwordx4 v[20:23], v1, s[44:47], s80 offen sc1
v_mfma_f32_16x16x32_bf16 v[244:247], v[88:91], v[104:107], v[244:247]
ds_read_b64_tr_b16 v[84:85], v10 offset:8192
v_accvgpr_read_b32 v24, a200
v_mfma_f32_16x16x32_bf16 v[244:247], v[92:95], v[108:111], v[244:247]
ds_read_b64_tr_b16 v[86:87], v10 offset:9216
v_accvgpr_read_b32 v28, a201
v_mfma_f32_16x16x32_bf16 v[240:243], v[92:95], v[100:103], v[240:243]
s_add_u32 s72, s70, 129024
buffer_load_dwordx4 v4, s[4:7], s72 offen offset:2048 lds
v_mfma_f32_16x16x32_bf16 v[240:243], v[88:91], v[96:99], v[240:243]
s_waitcnt lgkmcnt(5)
v_accvgpr_read_b32 v25, a202
v_accvgpr_read_b32 v29, a203
v_mfma_f32_16x16x32_bf16 v[128:131], v[64:67], v[32:35], v[128:131]
ds_read_b64_tr_b16 v[88:89], v11 offset:0
v_accvgpr_read_b32 v26, a204
v_mfma_f32_16x16x32_bf16 v[128:131], v[68:71], v[36:39], v[128:131]
ds_read_b64_tr_b16 v[90:91], v11 offset:1024
v_accvgpr_read_b32 v30, a205
v_mfma_f32_16x16x32_bf16 v[132:135], v[68:71], v[44:47], v[132:135]
v_accvgpr_read_b32 v27, a206
v_accvgpr_read_b32 v31, a207
v_mfma_f32_16x16x32_bf16 v[132:135], v[64:67], v[40:43], v[132:135]
s_add_u32 s72, s70, 144384
buffer_load_dwordx4 v5, s[4:7], s72 offen offset:3072 lds
v_mfma_f32_16x16x32_bf16 v[136:139], v[64:67], v[48:51], v[136:139]
ds_read_b64_tr_b16 v[92:93], v11 offset:8192
v_cvt_pk_bf16_f32 v24, v24, v28
v_mfma_f32_16x16x32_bf16 v[136:139], v[68:71], v[52:55], v[136:139]
s_lshl_b32 s71, s73, 12
v_cvt_pk_bf16_f32 v25, v25, v29
v_cvt_pk_bf16_f32 v26, v26, v30
v_mfma_f32_16x16x32_bf16 v[140:143], v[68:71], v[60:63], v[140:143]
s_add_u32 s71, s71, s66
ds_read_b64_tr_b16 v[94:95], v11 offset:9216
v_cvt_pk_bf16_f32 v27, v27, v31
v_mfma_f32_16x16x32_bf16 v[140:143], v[64:67], v[56:59], v[140:143]
s_waitcnt lgkmcnt(8)
v_mfma_f32_16x16x32_bf16 v[156:159], v[72:75], v[56:59], v[156:159]
s_add_u32 m0, s64, 32768
ds_read_b64_tr_b16 v[64:65], v12 offset:0
v_mfma_f32_16x16x32_bf16 v[156:159], v[76:79], v[60:63], v[156:159]
s_add_u32 s72, s71, 0
buffer_load_dwordx4 v6, s[12:15], s72 offen lds
v_mfma_f32_16x16x32_bf16 v[152:155], v[76:79], v[52:55], v[152:155]
s_add_u32 s73, s62, 9
ds_read_b64_tr_b16 v[66:67], v12 offset:1024
v_mfma_f32_16x16x32_bf16 v[152:155], v[72:75], v[48:51], v[152:155]
s_add_u32 s70, s73, s65
v_mfma_f32_16x16x32_bf16 v[148:151], v[72:75], v[40:43], v[148:151]
s_and_b32 s70, s70, 3
ds_read_b64_tr_b16 v[68:69], v12 offset:8192
v_mfma_f32_16x16x32_bf16 v[148:151], v[76:79], v[44:47], v[148:151]
s_and_b32 s73, s73, 12
ds_read_b64_tr_b16 v[70:71], v12 offset:9216
v_mfma_f32_16x16x32_bf16 v[144:147], v[76:79], v[36:39], v[144:147]
s_add_u32 s72, s71, 31744
buffer_load_dwordx4 v6, s[12:15], s72 offen offset:1024 lds
v_mfma_f32_16x16x32_bf16 v[144:147], v[72:75], v[32:35], v[144:147]
s_waitcnt lgkmcnt(8)
v_mfma_f32_16x16x32_bf16 v[160:163], v[80:83], v[32:35], v[160:163]
s_or_b32 s73, s73, s70
ds_read_b64_tr_b16 v[72:73], v13 offset:0
v_accvgpr_read_b32 v20, a80
v_mfma_f32_16x16x32_bf16 v[160:163], v[84:87], v[36:39], v[160:163]
s_lshl_b32 s73, s73, 7
ds_read_b64_tr_b16 v[74:75], v13 offset:1024
v_accvgpr_read_b32 v28, a81
v_mfma_f32_16x16x32_bf16 v[164:167], v[84:87], v[44:47], v[164:167]
s_add_u32 s69, s73, s67
v_accvgpr_read_b32 v21, a82
v_accvgpr_read_b32 v29, a83
v_mfma_f32_16x16x32_bf16 v[164:167], v[80:83], v[40:43], v[164:167]
s_add_u32 s72, s71, 63488
buffer_load_dwordx4 v7, s[12:15], s72 offen offset:2048 lds
v_mfma_f32_16x16x32_bf16 v[168:171], v[80:83], v[48:51], v[168:171]
s_waitcnt vmcnt(19)
ds_read_b64_tr_b16 v[76:77], v13 offset:8192
v_accvgpr_read_b32 v22, a112
v_mfma_f32_16x16x32_bf16 v[168:171], v[84:87], v[52:55], v[168:171]
s_add_u32 s70, s73, s68
ds_read_b128 v[96:99], v18 offset:0
v_accvgpr_read_b32 v30, a113
v_mfma_f32_16x16x32_bf16 v[172:175], v[84:87], v[60:63], v[172:175]
s_add_u32 s80, s78, 10240
ds_read_b64_tr_b16 v[78:79], v13 offset:9216
v_accvgpr_read_b32 v23, a114
v_mfma_f32_16x16x32_bf16 v[172:175], v[80:83], v[56:59], v[172:175]
s_waitcnt lgkmcnt(9)
ds_read_b128 v[100:103], v19 offset:0
v_accvgpr_read_b32 v31, a115
v_mfma_f32_16x16x32_bf16 v[188:191], v[88:91], v[56:59], v[188:191]
s_add_u32 s72, s71, 95232
buffer_load_dwordx4 v7, s[12:15], s72 offen offset:3072 lds
v_mfma_f32_16x16x32_bf16 v[188:191], v[92:95], v[60:63], v[188:191]
ds_read_b64_tr_b16 v[80:81], v14 offset:0
v_mul_f32 v20, s79, v20
v_mfma_f32_16x16x32_bf16 v[184:187], v[92:95], v[52:55], v[184:187]
ds_read_b64_tr_b16 v[82:83], v14 offset:1024
v_mul_f32 v28, s79, v28
v_mfma_f32_16x16x32_bf16 v[184:187], v[88:91], v[48:51], v[184:187]
buffer_store_dwordx4 v[24:27], v1, s[44:47], s80 offen sc1
v_mfma_f32_16x16x32_bf16 v[180:183], v[88:91], v[40:43], v[180:183]
ds_read_b64_tr_b16 v[84:85], v14 offset:8192
v_mul_f32 v21, s79, v21
v_mfma_f32_16x16x32_bf16 v[180:183], v[92:95], v[44:47], v[180:183]
s_add_u32 m0, s63, 131072
ds_read_b64_tr_b16 v[86:87], v14 offset:9216
v_mul_f32 v29, s79, v29
v_mfma_f32_16x16x32_bf16 v[176:179], v[92:95], v[36:39], v[176:179]
s_add_u32 s72, s69, 0
buffer_load_dwordx4 v4, s[4:7], s72 offen lds
v_mfma_f32_16x16x32_bf16 v[176:179], v[88:91], v[32:35], v[176:179]
s_waitcnt lgkmcnt(10)
ds_read_b128 v[104:107], v18 offset:2048
v_mul_f32 v22, s79, v22
v_mfma_f32_16x16x32_bf16 v[192:195], v[64:67], v[32:35], v[192:195]
ds_read_b64_tr_b16 v[88:89], v15 offset:0
v_mul_f32 v30, s79, v30
v_mfma_f32_16x16x32_bf16 v[192:195], v[68:71], v[36:39], v[192:195]
ds_read_b64_tr_b16 v[90:91], v15 offset:1024
v_mul_f32 v23, s79, v23
v_mfma_f32_16x16x32_bf16 v[196:199], v[68:71], v[44:47], v[196:199]
ds_read_b64_tr_b16 v[92:93], v15 offset:8192
v_mul_f32 v31, s79, v31
v_mfma_f32_16x16x32_bf16 v[196:199], v[64:67], v[40:43], v[196:199]
s_add_u32 s72, s69, 15360
buffer_load_dwordx4 v5, s[4:7], s72 offen offset:1024 lds
v_mfma_f32_16x16x32_bf16 v[200:203], v[64:67], v[48:51], v[200:203]
ds_read_b64_tr_b16 v[94:95], v15 offset:9216
v_cvt_pk_bf16_f32 v20, v20, v28
v_mfma_f32_16x16x32_bf16 v[200:203], v[68:71], v[52:55], v[200:203]
ds_read_b128 v[108:111], v19 offset:2048
v_cvt_pk_bf16_f32 v21, v21, v29
v_mfma_f32_16x16x32_bf16 v[204:207], v[68:71], v[60:63], v[204:207]
v_cvt_pk_bf16_f32 v22, v22, v30
v_cvt_pk_bf16_f32 v23, v23, v31
v_mfma_f32_16x16x32_bf16 v[204:207], v[64:67], v[56:59], v[204:207]
s_waitcnt lgkmcnt(11)
ds_read_b128 v[112:115], v18 offset:4096
v_accvgpr_read_b32 v24, a208
v_mfma_f32_16x16x32_bf16 v[220:223], v[72:75], v[56:59], v[220:223]
s_add_u32 s72, s69, 129024
buffer_load_dwordx4 v4, s[4:7], s72 offen offset:2048 lds
v_mfma_f32_16x16x32_bf16 v[220:223], v[76:79], v[60:63], v[220:223]
s_add_u32 s80, s77, 33792
s_nop 3
s_mov_b64 exec, 0
s_cmp_eq_u32 s58, 0
s_cbranch_scc1 Lstub0
s_cmp_eq_u32 s58, 1
s_cbranch_scc1 Lstub1
s_cmp_eq_u32 s58, 2
s_cbranch_scc1 Lstub2
s_branch Lstub3
Lret:
s_mov_b64 exec, -1
s_nop 3
v_mfma_f32_16x16x32_bf16 v[216:219], v[76:79], v[52:55], v[216:219]
s_waitcnt vmcnt(19) lgkmcnt(2)
ds_read_b128 v[116:119], v19 offset:4096
v_accvgpr_read_b32 v28, a209
v_mfma_f32_16x16x32_bf16 v[216:219], v[72:75], v[48:51], v[216:219]
s_barrier
buffer_store_dwordx4 v[20:23], v1, s[44:47], s80 offen sc1
v_mfma_f32_16x16x32_bf16 v[212:215], v[72:75], v[40:43], v[212:215]
ds_read_b64_tr_b16 v[64:65], v8 offset:16384
ds_read_b64_tr_b16 v[66:67], v8 offset:17408
v_mfma_f32_16x16x32_bf16 v[212:215], v[76:79], v[44:47], v[212:215]
ds_read_b64_tr_b16 v[68:69], v8 offset:24576
v_accvgpr_read_b32 v25, a210
v_mfma_f32_16x16x32_bf16 v[208:211], v[76:79], v[36:39], v[208:211]
s_add_u32 s72, s69, 144384
buffer_load_dwordx4 v5, s[4:7], s72 offen offset:3072 lds
v_mfma_f32_16x16x32_bf16 v[208:211], v[72:75], v[32:35], v[208:211]
ds_read_b64_tr_b16 v[70:71], v8 offset:25600
v_accvgpr_read_b32 v29, a211
v_mfma_f32_16x16x32_bf16 v[224:227], v[80:83], v[32:35], v[224:227]
ds_read_b64_tr_b16 v[72:73], v9 offset:16384
v_accvgpr_read_b32 v26, a212
v_mfma_f32_16x16x32_bf16 v[224:227], v[84:87], v[36:39], v[224:227]
ds_read_b64_tr_b16 v[74:75], v9 offset:17408
v_accvgpr_read_b32 v30, a213
v_mfma_f32_16x16x32_bf16 v[228:231], v[84:87], v[44:47], v[228:231]
s_add_u32 m0, s63, 135168
ds_read_b128 v[120:123], v18 offset:6144
v_accvgpr_read_b32 v27, a214
v_mfma_f32_16x16x32_bf16 v[228:231], v[80:83], v[40:43], v[228:231]
s_add_u32 s72, s70, 0
buffer_load_dwordx4 v4, s[4:7], s72 offen lds
v_mfma_f32_16x16x32_bf16 v[232:235], v[80:83], v[48:51], v[232:235]
ds_read_b64_tr_b16 v[76:77], v9 offset:24576
v_accvgpr_read_b32 v31, a215
v_mfma_f32_16x16x32_bf16 v[232:235], v[84:87], v[52:55], v[232:235]
ds_read_b128 v[124:127], v19 offset:6144
v_cvt_pk_bf16_f32 v24, v24, v28
v_mfma_f32_16x16x32_bf16 v[236:239], v[84:87], v[60:63], v[236:239]
ds_read_b64_tr_b16 v[78:79], v9 offset:25600
v_cvt_pk_bf16_f32 v25, v25, v29
v_mfma_f32_16x16x32_bf16 v[236:239], v[80:83], v[56:59], v[236:239]
v_cvt_pk_bf16_f32 v26, v26, v30
v_cvt_pk_bf16_f32 v27, v27, v31
v_mfma_f32_16x16x32_bf16 v[252:255], v[88:91], v[56:59], v[252:255]
s_add_u32 s72, s70, 15360
buffer_load_dwordx4 v5, s[4:7], s72 offen offset:1024 lds
v_mfma_f32_16x16x32_bf16 v[252:255], v[92:95], v[60:63], v[252:255]
s_add_u32 s80, s78, 34816
ds_read_b64_tr_b16 v[80:81], v10 offset:16384
v_mfma_f32_16x16x32_bf16 v[248:251], v[92:95], v[52:55], v[248:251]
ds_read_b64_tr_b16 v[82:83], v10 offset:17408
v_mfma_f32_16x16x32_bf16 v[248:251], v[88:91], v[48:51], v[248:251]
buffer_store_dwordx4 v[24:27], v1, s[44:47], s80 offen sc1
v_mfma_f32_16x16x32_bf16 v[244:247], v[88:91], v[40:43], v[244:247]
ds_read_b64_tr_b16 v[84:85], v10 offset:24576
v_mfma_f32_16x16x32_bf16 v[244:247], v[92:95], v[44:47], v[244:247]
ds_read_b64_tr_b16 v[86:87], v10 offset:25600
v_accvgpr_read_b32 v20, a84
v_mfma_f32_16x16x32_bf16 v[240:243], v[92:95], v[36:39], v[240:243]
s_add_u32 s72, s70, 129024
buffer_load_dwordx4 v4, s[4:7], s72 offen offset:2048 lds
v_mfma_f32_16x16x32_bf16 v[240:243], v[88:91], v[32:35], v[240:243]
s_waitcnt lgkmcnt(5)
v_accvgpr_read_b32 v28, a85
v_accvgpr_read_b32 v21, a86
v_mfma_f32_16x16x32_bf16 v[128:131], v[64:67], v[96:99], v[128:131]
ds_read_b64_tr_b16 v[88:89], v11 offset:16384
v_accvgpr_read_b32 v29, a87
v_mfma_f32_16x16x32_bf16 v[128:131], v[68:71], v[100:103], v[128:131]
ds_read_b64_tr_b16 v[90:91], v11 offset:17408
v_accvgpr_read_b32 v22, a116
v_mfma_f32_16x16x32_bf16 v[132:135], v[68:71], v[108:111], v[132:135]
v_accvgpr_read_b32 v30, a117
v_accvgpr_read_b32 v23, a118
v_mfma_f32_16x16x32_bf16 v[132:135], v[64:67], v[104:107], v[132:135]
s_add_u32 s72, s70, 144384
buffer_load_dwordx4 v5, s[4:7], s72 offen offset:3072 lds
v_mfma_f32_16x16x32_bf16 v[136:139], v[64:67], v[112:115], v[136:139]
ds_read_b64_tr_b16 v[92:93], v11 offset:24576
v_accvgpr_read_b32 v31, a119
v_mfma_f32_16x16x32_bf16 v[136:139], v[68:71], v[116:119], v[136:139]
s_lshl_b32 s71, s73, 12
v_mul_f32 v20, s79, v20
v_mul_f32 v28, s79, v28
v_mfma_f32_16x16x32_bf16 v[140:143], v[68:71], v[124:127], v[140:143]
s_add_u32 s71, s71, s66
ds_read_b64_tr_b16 v[94:95], v11 offset:25600
v_mul_f32 v21, s79, v21
v_mfma_f32_16x16x32_bf16 v[140:143], v[64:67], v[120:123], v[140:143]
s_waitcnt lgkmcnt(8)
v_mul_f32 v29, s79, v29
v_mul_f32 v22, s79, v22
v_mfma_f32_16x16x32_bf16 v[156:159], v[72:75], v[120:123], v[156:159]
s_add_u32 m0, s64, 0
ds_read_b64_tr_b16 v[64:65], v12 offset:16384
v_mul_f32 v30, s79, v30
v_mfma_f32_16x16x32_bf16 v[156:159], v[76:79], v[124:127], v[156:159]
s_add_u32 s72, s71, 0
buffer_load_dwordx4 v6, s[12:15], s72 offen lds
v_mfma_f32_16x16x32_bf16 v[152:155], v[76:79], v[116:119], v[152:155]
s_add_u32 s73, s62, 10
ds_read_b64_tr_b16 v[66:67], v12 offset:17408
v_mul_f32 v23, s79, v23
v_mfma_f32_16x16x32_bf16 v[152:155], v[72:75], v[112:115], v[152:155]
s_add_u32 s70, s73, s65
v_mul_f32 v31, s79, v31
v_cvt_pk_bf16_f32 v20, v20, v28
v_mfma_f32_16x16x32_bf16 v[148:151], v[72:75], v[104:107], v[148:151]
s_and_b32 s70, s70, 3
ds_read_b64_tr_b16 v[68:69], v12 offset:24576
v_cvt_pk_bf16_f32 v21, v21, v29
v_mfma_f32_16x16x32_bf16 v[148:151], v[76:79], v[108:111], v[148:151]
s_and_b32 s73, s73, 12
ds_read_b64_tr_b16 v[70:71], v12 offset:25600
v_cvt_pk_bf16_f32 v22, v22, v30
v_mfma_f32_16x16x32_bf16 v[144:147], v[76:79], v[100:103], v[144:147]
s_add_u32 s72, s71, 31744
buffer_load_dwordx4 v6, s[12:15], s72 offen offset:1024 lds
v_mfma_f32_16x16x32_bf16 v[144:147], v[72:75], v[96:99], v[144:147]
s_waitcnt lgkmcnt(8)
v_cvt_pk_bf16_f32 v23, v23, v31
v_mfma_f32_16x16x32_bf16 v[160:163], v[80:83], v[96:99], v[160:163]
s_or_b32 s73, s73, s70
ds_read_b64_tr_b16 v[72:73], v13 offset:16384
v_mfma_f32_16x16x32_bf16 v[160:163], v[84:87], v[100:103], v[160:163]
s_lshl_b32 s73, s73, 7
ds_read_b64_tr_b16 v[74:75], v13 offset:17408
v_mfma_f32_16x16x32_bf16 v[164:167], v[84:87], v[108:111], v[164:167]
s_add_u32 s69, s73, s67
v_mfma_f32_16x16x32_bf16 v[164:167], v[80:83], v[104:107], v[164:167]
s_add_u32 s72, s71, 63488
buffer_load_dwordx4 v7, s[12:15], s72 offen offset:2048 lds
v_mfma_f32_16x16x32_bf16 v[168:171], v[80:83], v[112:115], v[168:171]
s_waitcnt vmcnt(18)
ds_read_b64_tr_b16 v[76:77], v13 offset:24576
v_accvgpr_read_b32 v24, a216
v_mfma_f32_16x16x32_bf16 v[168:171], v[84:87], v[116:119], v[168:171]
s_add_u32 s70, s73, s68
ds_read_b128 v[32:35], v18 offset:32768
v_accvgpr_read_b32 v28, a217
v_mfma_f32_16x16x32_bf16 v[172:175], v[84:87], v[124:127], v[172:175]
s_add_u32 s80, s77, 37888
ds_read_b64_tr_b16 v[78:79], v13 offset:25600
v_accvgpr_read_b32 v25, a218
v_mfma_f32_16x16x32_bf16 v[172:175], v[80:83], v[120:123], v[172:175]
s_waitcnt lgkmcnt(9)
ds_read_b128 v[36:39], v19 offset:32768
v_accvgpr_read_b32 v29, a219
v_mfma_f32_16x16x32_bf16 v[188:191], v[88:91], v[120:123], v[188:191]
s_add_u32 s72, s71, 95232
buffer_load_dwordx4 v7, s[12:15], s72 offen offset:3072 lds
v_mfma_f32_16x16x32_bf16 v[188:191], v[92:95], v[124:127], v[188:191]
ds_read_b64_tr_b16 v[80:81], v14 offset:16384
v_accvgpr_read_b32 v26, a220
v_mfma_f32_16x16x32_bf16 v[184:187], v[92:95], v[116:119], v[184:187]
ds_read_b64_tr_b16 v[82:83], v14 offset:17408
v_accvgpr_read_b32 v30, a221
v_mfma_f32_16x16x32_bf16 v[184:187], v[88:91], v[112:115], v[184:187]
buffer_store_dwordx4 v[20:23], v1, s[44:47], s80 offen sc1
v_mfma_f32_16x16x32_bf16 v[180:183], v[88:91], v[104:107], v[180:183]
ds_read_b64_tr_b16 v[84:85], v14 offset:24576
v_accvgpr_read_b32 v27, a222
v_mfma_f32_16x16x32_bf16 v[180:183], v[92:95], v[108:111], v[180:183]
s_add_u32 m0, s63, 65536
ds_read_b64_tr_b16 v[86:87], v14 offset:25600
v_accvgpr_read_b32 v31, a223
v_mfma_f32_16x16x32_bf16 v[176:179], v[92:95], v[100:103], v[176:179]
s_add_u32 s72, s69, 0
buffer_load_dwordx4 v4, s[4:7], s72 offen lds
v_mfma_f32_16x16x32_bf16 v[176:179], v[88:91], v[96:99], v[176:179]
s_waitcnt lgkmcnt(10)
ds_read_b128 v[40:43], v18 offset:34816
v_cvt_pk_bf16_f32 v24, v24, v28
v_mfma_f32_16x16x32_bf16 v[192:195], v[64:67], v[96:99], v[192:195]
ds_read_b64_tr_b16 v[88:89], v15 offset:16384
v_cvt_pk_bf16_f32 v25, v25, v29
v_mfma_f32_16x16x32_bf16 v[192:195], v[68:71], v[100:103], v[192:195]
ds_read_b64_tr_b16 v[90:91], v15 offset:17408
v_cvt_pk_bf16_f32 v26, v26, v30
v_mfma_f32_16x16x32_bf16 v[196:199], v[68:71], v[108:111], v[196:199]
ds_read_b64_tr_b16 v[92:93], v15 offset:24576
v_cvt_pk_bf16_f32 v27, v27, v31
v_mfma_f32_16x16x32_bf16 v[196:199], v[64:67], v[104:107], v[196:199]
s_add_u32 s72, s69, 15360
buffer_load_dwordx4 v5, s[4:7], s72 offen offset:1024 lds
v_mfma_f32_16x16x32_bf16 v[200:203], v[64:67], v[112:115], v[200:203]
s_add_u32 s80, s78, 43008
ds_read_b64_tr_b16 v[94:95], v15 offset:25600
v_mfma_f32_16x16x32_bf16 v[200:203], v[68:71], v[116:119], v[200:203]
ds_read_b128 v[44:47], v19 offset:34816
v_mfma_f32_16x16x32_bf16 v[204:207], v[68:71], v[124:127], v[204:207]
buffer_store_dwordx4 v[24:27], v1, s[44:47], s80 offen sc1
v_mfma_f32_16x16x32_bf16 v[204:207], v[64:67], v[120:123], v[204:207]
s_waitcnt lgkmcnt(11)
ds_read_b128 v[48:51], v18 offset:36864
v_mfma_f32_16x16x32_bf16 v[220:223], v[72:75], v[120:123], v[220:223]
s_add_u32 s72, s69, 129024
buffer_load_dwordx4 v4, s[4:7], s72 offen offset:2048 lds
v_mfma_f32_16x16x32_bf16 v[220:223], v[76:79], v[124:127], v[220:223]
v_accvgpr_read_b32 v20, a88
v_accvgpr_read_b32 v28, a89
v_mfma_f32_16x16x32_bf16 v[216:219], v[76:79], v[116:119], v[216:219]
s_waitcnt vmcnt(20) lgkmcnt(2)
ds_read_b128 v[52:55], v19 offset:36864
v_accvgpr_read_b32 v21, a90
v_mfma_f32_16x16x32_bf16 v[216:219], v[72:75], v[112:115], v[216:219]
s_barrier
ds_read_b128 v[56:59], v18 offset:38912
v_accvgpr_read_b32 v29, a91
v_mfma_f32_16x16x32_bf16 v[212:215], v[72:75], v[104:107], v[212:215]
ds_read_b64_tr_b16 v[64:65], v8 offset:32768
ds_read_b64_tr_b16 v[66:67], v8 offset:33792
v_mfma_f32_16x16x32_bf16 v[212:215], v[76:79], v[108:111], v[212:215]
ds_read_b64_tr_b16 v[68:69], v8 offset:40960
v_accvgpr_read_b32 v22, a120
v_mfma_f32_16x16x32_bf16 v[208:211], v[76:79], v[100:103], v[208:211]
s_add_u32 s72, s69, 144384
buffer_load_dwordx4 v5, s[4:7], s72 offen offset:3072 lds
v_mfma_f32_16x16x32_bf16 v[208:211], v[72:75], v[96:99], v[208:211]
ds_read_b64_tr_b16 v[70:71], v8 offset:41984
v_accvgpr_read_b32 v30, a121
v_mfma_f32_16x16x32_bf16 v[224:227], v[80:83], v[96:99], v[224:227]
ds_read_b64_tr_b16 v[72:73], v9 offset:32768
v_accvgpr_read_b32 v23, a122
v_mfma_f32_16x16x32_bf16 v[224:227], v[84:87], v[100:103], v[224:227]
ds_read_b64_tr_b16 v[74:75], v9 offset:33792
v_accvgpr_read_b32 v31, a123
v_mfma_f32_16x16x32_bf16 v[228:231], v[84:87], v[108:111], v[228:231]
s_add_u32 m0, s63, 69632
v_mul_f32 v20, s79, v20
v_mul_f32 v28, s79, v28
v_mfma_f32_16x16x32_bf16 v[228:231], v[80:83], v[104:107], v[228:231]
s_add_u32 s72, s70, 0
buffer_load_dwordx4 v4, s[4:7], s72 offen lds
v_mfma_f32_16x16x32_bf16 v[232:235], v[80:83], v[112:115], v[232:235]
ds_read_b64_tr_b16 v[76:77], v9 offset:40960
v_mul_f32 v21, s79, v21
v_mfma_f32_16x16x32_bf16 v[232:235], v[84:87], v[116:119], v[232:235]
ds_read_b128 v[60:63], v19 offset:38912
v_mul_f32 v29, s79, v29
v_mfma_f32_16x16x32_bf16 v[236:239], v[84:87], v[124:127], v[236:239]
ds_read_b64_tr_b16 v[78:79], v9 offset:41984
v_mul_f32 v22, s79, v22
v_mfma_f32_16x16x32_bf16 v[236:239], v[80:83], v[120:123], v[236:239]
v_mul_f32 v30, s79, v30
v_mul_f32 v23, s79, v23
v_mfma_f32_16x16x32_bf16 v[252:255], v[88:91], v[120:123], v[252:255]
s_add_u32 s72, s70, 15360
buffer_load_dwordx4 v5, s[4:7], s72 offen offset:1024 lds
v_mfma_f32_16x16x32_bf16 v[252:255], v[92:95], v[124:127], v[252:255]
ds_read_b64_tr_b16 v[80:81], v10 offset:32768
v_mul_f32 v31, s79, v31
v_mfma_f32_16x16x32_bf16 v[248:251], v[92:95], v[116:119], v[248:251]
ds_read_b64_tr_b16 v[82:83], v10 offset:33792
v_cvt_pk_bf16_f32 v20, v20, v28
v_mfma_f32_16x16x32_bf16 v[248:251], v[88:91], v[112:115], v[248:251]
v_cvt_pk_bf16_f32 v21, v21, v29
v_cvt_pk_bf16_f32 v22, v22, v30
v_mfma_f32_16x16x32_bf16 v[244:247], v[88:91], v[104:107], v[244:247]
ds_read_b64_tr_b16 v[84:85], v10 offset:40960
v_cvt_pk_bf16_f32 v23, v23, v31
v_mfma_f32_16x16x32_bf16 v[244:247], v[92:95], v[108:111], v[244:247]
s_add_u32 s80, s77, 41984
ds_read_b64_tr_b16 v[86:87], v10 offset:41984
v_mfma_f32_16x16x32_bf16 v[240:243], v[92:95], v[100:103], v[240:243]
s_add_u32 s72, s70, 129024
buffer_load_dwordx4 v4, s[4:7], s72 offen offset:2048 lds
v_mfma_f32_16x16x32_bf16 v[240:243], v[88:91], v[96:99], v[240:243]
s_waitcnt lgkmcnt(5)
buffer_store_dwordx4 v[20:23], v1, s[44:47], s80 offen sc1
LcB1:
v_mfma_f32_16x16x32_bf16 v[128:131], v[64:67], v[32:35], v[128:131]
ds_read_b64_tr_b16 v[88:89], v11 offset:32768
v_accvgpr_read_b32 v24, a224
v_mfma_f32_16x16x32_bf16 v[128:131], v[68:71], v[36:39], v[128:131]
ds_read_b64_tr_b16 v[90:91], v11 offset:33792
v_accvgpr_read_b32 v28, a225
v_mfma_f32_16x16x32_bf16 v[132:135], v[68:71], v[44:47], v[132:135]
v_accvgpr_read_b32 v25, a226
v_accvgpr_read_b32 v29, a227
v_mfma_f32_16x16x32_bf16 v[132:135], v[64:67], v[40:43], v[132:135]
s_add_u32 s72, s70, 144384
buffer_load_dwordx4 v5, s[4:7], s72 offen offset:3072 lds
v_mfma_f32_16x16x32_bf16 v[136:139], v[64:67], v[48:51], v[136:139]
ds_read_b64_tr_b16 v[92:93], v11 offset:40960
v_accvgpr_read_b32 v26, a228
v_mfma_f32_16x16x32_bf16 v[136:139], v[68:71], v[52:55], v[136:139]
s_lshl_b32 s71, s73, 12
v_accvgpr_read_b32 v30, a229
v_accvgpr_read_b32 v27, a230
v_mfma_f32_16x16x32_bf16 v[140:143], v[68:71], v[60:63], v[140:143]
s_add_u32 s71, s71, s66
ds_read_b64_tr_b16 v[94:95], v11 offset:41984
v_accvgpr_read_b32 v31, a231
v_mfma_f32_16x16x32_bf16 v[140:143], v[64:67], v[56:59], v[140:143]
s_waitcnt lgkmcnt(8)
v_cvt_pk_bf16_f32 v24, v24, v28
v_cvt_pk_bf16_f32 v25, v25, v29
v_mfma_f32_16x16x32_bf16 v[156:159], v[72:75], v[56:59], v[156:159]
s_add_u32 m0, s64, 16384
ds_read_b64_tr_b16 v[64:65], v12 offset:32768
v_cvt_pk_bf16_f32 v26, v26, v30
v_mfma_f32_16x16x32_bf16 v[156:159], v[76:79], v[60:63], v[156:159]
s_add_u32 s72, s71, 0
buffer_load_dwordx4 v6, s[12:15], s72 offen lds
v_mfma_f32_16x16x32_bf16 v[152:155], v[76:79], v[52:55], v[152:155]
s_add_u32 s73, s62, 11
ds_read_b64_tr_b16 v[66:67], v12 offset:33792
v_cvt_pk_bf16_f32 v27, v27, v31
v_mfma_f32_16x16x32_bf16 v[152:155], v[72:75], v[48:51], v[152:155]
s_add_u32 s70, s73, s65
v_mfma_f32_16x16x32_bf16 v[148:151], v[72:75], v[40:43], v[148:151]
s_and_b32 s70, s70, 3
ds_read_b64_tr_b16 v[68:69], v12 offset:40960
v_mfma_f32_16x16x32_bf16 v[148:151], v[76:79], v[44:47], v[148:151]
s_and_b32 s73, s73, 12
ds_read_b64_tr_b16 v[70:71], v12 offset:41984
v_mfma_f32_16x16x32_bf16 v[144:147], v[76:79], v[36:39], v[144:147]
s_add_u32 s72, s71, 31744
buffer_load_dwordx4 v6, s[12:15], s72 offen offset:1024 lds
v_mfma_f32_16x16x32_bf16 v[144:147], v[72:75], v[32:35], v[144:147]
s_waitcnt lgkmcnt(8)
v_mfma_f32_16x16x32_bf16 v[160:163], v[80:83], v[32:35], v[160:163]
s_or_b32 s73, s73, s70
ds_read_b64_tr_b16 v[72:73], v13 offset:32768
v_mfma_f32_16x16x32_bf16 v[160:163], v[84:87], v[36:39], v[160:163]
s_lshl_b32 s73, s73, 7
ds_read_b64_tr_b16 v[74:75], v13 offset:33792
v_mfma_f32_16x16x32_bf16 v[164:167], v[84:87], v[44:47], v[164:167]
s_add_u32 s69, s73, s67
v_mfma_f32_16x16x32_bf16 v[164:167], v[80:83], v[40:43], v[164:167]
s_add_u32 s72, s71, 63488
buffer_load_dwordx4 v7, s[12:15], s72 offen offset:2048 lds
v_mfma_f32_16x16x32_bf16 v[168:171], v[80:83], v[48:51], v[168:171]
s_waitcnt vmcnt(18)
ds_read_b64_tr_b16 v[76:77], v13 offset:40960
v_mfma_f32_16x16x32_bf16 v[168:171], v[84:87], v[52:55], v[168:171]
s_add_u32 s70, s73, s68
ds_read_b128 v[96:99], v16 offset:0
v_accvgpr_read_b32 v20, a92
v_mfma_f32_16x16x32_bf16 v[172:175], v[84:87], v[60:63], v[172:175]
s_add_u32 s80, s78, 3072
ds_read_b64_tr_b16 v[78:79], v13 offset:41984
v_accvgpr_read_b32 v28, a93
v_mfma_f32_16x16x32_bf16 v[172:175], v[80:83], v[56:59], v[172:175]
s_waitcnt lgkmcnt(9)
ds_read_b128 v[100:103], v17 offset:0
v_accvgpr_read_b32 v21, a94
v_mfma_f32_16x16x32_bf16 v[188:191], v[88:91], v[56:59], v[188:191]
s_add_u32 s72, s71, 95232
buffer_load_dwordx4 v7, s[12:15], s72 offen offset:3072 lds
v_mfma_f32_16x16x32_bf16 v[188:191], v[92:95], v[60:63], v[188:191]
ds_read_b64_tr_b16 v[80:81], v14 offset:32768
v_accvgpr_read_b32 v29, a95
v_mfma_f32_16x16x32_bf16 v[184:187], v[92:95], v[52:55], v[184:187]
ds_read_b64_tr_b16 v[82:83], v14 offset:33792
v_accvgpr_read_b32 v22, a124
v_mfma_f32_16x16x32_bf16 v[184:187], v[88:91], v[48:51], v[184:187]
buffer_store_dwordx4 v[24:27], v1, s[44:47], s80 offen sc1
v_mfma_f32_16x16x32_bf16 v[180:183], v[88:91], v[40:43], v[180:183]
ds_read_b64_tr_b16 v[84:85], v14 offset:40960
v_accvgpr_read_b32 v30, a125
v_mfma_f32_16x16x32_bf16 v[180:183], v[92:95], v[44:47], v[180:183]
s_add_u32 m0, s63, 98304
ds_read_b64_tr_b16 v[86:87], v14 offset:41984
v_accvgpr_read_b32 v23, a126
v_mfma_f32_16x16x32_bf16 v[176:179], v[92:95], v[36:39], v[176:179]
s_add_u32 s72, s69, 0
buffer_load_dwordx4 v4, s[4:7], s72 offen lds
v_mfma_f32_16x16x32_bf16 v[176:179], v[88:91], v[32:35], v[176:179]
s_waitcnt lgkmcnt(10)
ds_read_b128 v[104:107], v16 offset:2048
v_accvgpr_read_b32 v31, a127
v_mfma_f32_16x16x32_bf16 v[192:195], v[64:67], v[32:35], v[192:195]
ds_read_b64_tr_b16 v[88:89], v15 offset:32768
v_mul_f32 v20, s79, v20
v_mfma_f32_16x16x32_bf16 v[192:195], v[68:71], v[36:39], v[192:195]
ds_read_b64_tr_b16 v[90:91], v15 offset:33792
v_mul_f32 v28, s79, v28
v_mfma_f32_16x16x32_bf16 v[196:199], v[68:71], v[44:47], v[196:199]
ds_read_b64_tr_b16 v[92:93], v15 offset:40960
v_mul_f32 v21, s79, v21
v_mfma_f32_16x16x32_bf16 v[196:199], v[64:67], v[40:43], v[196:199]
s_add_u32 s72, s69, 15360
buffer_load_dwordx4 v5, s[4:7], s72 offen offset:1024 lds
v_mfma_f32_16x16x32_bf16 v[200:203], v[64:67], v[48:51], v[200:203]
ds_read_b64_tr_b16 v[94:95], v15 offset:41984
v_mul_f32 v29, s79, v29
v_mfma_f32_16x16x32_bf16 v[200:203], v[68:71], v[52:55], v[200:203]
ds_read_b128 v[108:111], v17 offset:2048
v_mul_f32 v22, s79, v22
v_mfma_f32_16x16x32_bf16 v[204:207], v[68:71], v[60:63], v[204:207]
v_mul_f32 v30, s79, v30
v_mul_f32 v23, s79, v23
v_mfma_f32_16x16x32_bf16 v[204:207], v[64:67], v[56:59], v[204:207]
s_waitcnt lgkmcnt(11)
ds_read_b128 v[112:115], v16 offset:4096
v_mul_f32 v31, s79, v31
v_mfma_f32_16x16x32_bf16 v[220:223], v[72:75], v[56:59], v[220:223]
s_add_u32 s72, s69, 129024
buffer_load_dwordx4 v4, s[4:7], s72 offen offset:2048 lds
v_mfma_f32_16x16x32_bf16 v[220:223], v[76:79], v[60:63], v[220:223]
v_cvt_pk_bf16_f32 v20, v20, v28
v_cvt_pk_bf16_f32 v21, v21, v29
v_mfma_f32_16x16x32_bf16 v[216:219], v[76:79], v[52:55], v[216:219]
s_waitcnt vmcnt(19) lgkmcnt(2)
ds_read_b128 v[116:119], v17 offset:4096
v_cvt_pk_bf16_f32 v22, v22, v30
v_mfma_f32_16x16x32_bf16 v[216:219], v[72:75], v[48:51], v[216:219]
s_barrier
ds_read_b128 v[120:123], v16 offset:6144
v_cvt_pk_bf16_f32 v23, v23, v31
v_mfma_f32_16x16x32_bf16 v[212:215], v[72:75], v[40:43], v[212:215]
s_add_u32 s80, s77, 46080
ds_read_b64_tr_b16 v[64:65], v8 offset:0
ds_read_b64_tr_b16 v[66:67], v8 offset:1024
v_mfma_f32_16x16x32_bf16 v[212:215], v[76:79], v[44:47], v[212:215]
ds_read_b64_tr_b16 v[68:69], v8 offset:8192
v_accvgpr_read_b32 v24, a232
v_mfma_f32_16x16x32_bf16 v[208:211], v[76:79], v[36:39], v[208:211]
s_add_u32 s72, s69, 144384
buffer_load_dwordx4 v5, s[4:7], s72 offen offset:3072 lds
v_mfma_f32_16x16x32_bf16 v[208:211], v[72:75], v[32:35], v[208:211]
ds_read_b64_tr_b16 v[70:71], v8 offset:9216
v_accvgpr_read_b32 v28, a233
v_mfma_f32_16x16x32_bf16 v[224:227], v[80:83], v[32:35], v[224:227]
ds_read_b64_tr_b16 v[72:73], v9 offset:0
v_accvgpr_read_b32 v25, a234
v_mfma_f32_16x16x32_bf16 v[224:227], v[84:87], v[36:39], v[224:227]
ds_read_b64_tr_b16 v[74:75], v9 offset:1024
v_accvgpr_read_b32 v29, a235
v_mfma_f32_16x16x32_bf16 v[228:231], v[84:87], v[44:47], v[228:231]
s_add_u32 m0, s63, 102400
buffer_store_dwordx4 v[20:23], v1, s[44:47], s80 offen sc1
v_mfma_f32_16x16x32_bf16 v[228:231], v[80:83], v[40:43], v[228:231]
s_add_u32 s72, s70, 0
buffer_load_dwordx4 v4, s[4:7], s72 offen lds
v_mfma_f32_16x16x32_bf16 v[232:235], v[80:83], v[48:51], v[232:235]
ds_read_b64_tr_b16 v[76:77], v9 offset:8192
v_accvgpr_read_b32 v26, a236
v_mfma_f32_16x16x32_bf16 v[232:235], v[84:87], v[52:55], v[232:235]
ds_read_b128 v[124:127], v17 offset:6144
v_accvgpr_read_b32 v30, a237
v_mfma_f32_16x16x32_bf16 v[236:239], v[84:87], v[60:63], v[236:239]
ds_read_b64_tr_b16 v[78:79], v9 offset:9216
v_accvgpr_read_b32 v27, a238
v_mfma_f32_16x16x32_bf16 v[236:239], v[80:83], v[56:59], v[236:239]
v_accvgpr_read_b32 v31, a239
v_cvt_pk_bf16_f32 v24, v24, v28
v_mfma_f32_16x16x32_bf16 v[252:255], v[88:91], v[56:59], v[252:255]
s_add_u32 s72, s70, 15360
buffer_load_dwordx4 v5, s[4:7], s72 offen offset:1024 lds
v_mfma_f32_16x16x32_bf16 v[252:255], v[92:95], v[60:63], v[252:255]
ds_read_b64_tr_b16 v[80:81], v10 offset:0
v_cvt_pk_bf16_f32 v25, v25, v29
v_mfma_f32_16x16x32_bf16 v[248:251], v[92:95], v[52:55], v[248:251]
ds_read_b64_tr_b16 v[82:83], v10 offset:1024
v_cvt_pk_bf16_f32 v26, v26, v30
v_mfma_f32_16x16x32_bf16 v[248:251], v[88:91], v[48:51], v[248:251]
v_cvt_pk_bf16_f32 v27, v27, v31
v_mfma_f32_16x16x32_bf16 v[244:247], v[88:91], v[40:43], v[244:247]
s_add_u32 s80, s78, 11264
ds_read_b64_tr_b16 v[84:85], v10 offset:8192
v_mfma_f32_16x16x32_bf16 v[244:247], v[92:95], v[44:47], v[244:247]
ds_read_b64_tr_b16 v[86:87], v10 offset:9216
v_mfma_f32_16x16x32_bf16 v[240:243], v[92:95], v[36:39], v[240:243]
s_add_u32 s72, s70, 129024
buffer_load_dwordx4 v4, s[4:7], s72 offen offset:2048 lds
v_mfma_f32_16x16x32_bf16 v[240:243], v[88:91], v[32:35], v[240:243]
s_waitcnt lgkmcnt(5)
buffer_store_dwordx4 v[24:27], v1, s[44:47], s80 offen sc1
v_mfma_f32_16x16x32_bf16 v[128:131], v[64:67], v[96:99], v[128:131]
ds_read_b64_tr_b16 v[88:89], v11 offset:0
v_mfma_f32_16x16x32_bf16 v[128:131], v[68:71], v[100:103], v[128:131]
ds_read_b64_tr_b16 v[90:91], v11 offset:1024
v_accvgpr_read_b32 v20, a240
v_mfma_f32_16x16x32_bf16 v[132:135], v[68:71], v[108:111], v[132:135]
v_accvgpr_read_b32 v28, a241
v_accvgpr_read_b32 v21, a242
v_mfma_f32_16x16x32_bf16 v[132:135], v[64:67], v[104:107], v[132:135]
s_add_u32 s72, s70, 144384
buffer_load_dwordx4 v5, s[4:7], s72 offen offset:3072 lds
v_mfma_f32_16x16x32_bf16 v[136:139], v[64:67], v[112:115], v[136:139]
ds_read_b64_tr_b16 v[92:93], v11 offset:8192
v_accvgpr_read_b32 v29, a243
v_mfma_f32_16x16x32_bf16 v[136:139], v[68:71], v[116:119], v[136:139]
s_lshl_b32 s71, s73, 12
v_accvgpr_read_b32 v22, a244
v_accvgpr_read_b32 v30, a245
v_mfma_f32_16x16x32_bf16 v[140:143], v[68:71], v[124:127], v[140:143]
s_add_u32 s71, s71, s66
ds_read_b64_tr_b16 v[94:95], v11 offset:9216
v_accvgpr_read_b32 v23, a246
v_mfma_f32_16x16x32_bf16 v[140:143], v[64:67], v[120:123], v[140:143]
s_waitcnt lgkmcnt(8)
v_accvgpr_read_b32 v31, a247
v_cvt_pk_bf16_f32 v20, v20, v28
v_mfma_f32_16x16x32_bf16 v[156:159], v[72:75], v[120:123], v[156:159]
s_add_u32 m0, s64, 32768
ds_read_b64_tr_b16 v[64:65], v12 offset:0
v_cvt_pk_bf16_f32 v21, v21, v29
v_mfma_f32_16x16x32_bf16 v[156:159], v[76:79], v[124:127], v[156:159]
s_add_u32 s72, s71, 0
buffer_load_dwordx4 v6, s[12:15], s72 offen lds
v_mfma_f32_16x16x32_bf16 v[152:155], v[76:79], v[116:119], v[152:155]
s_add_u32 s73, s62, 12
ds_read_b64_tr_b16 v[66:67], v12 offset:1024
v_cvt_pk_bf16_f32 v22, v22, v30
v_mfma_f32_16x16x32_bf16 v[152:155], v[72:75], v[112:115], v[152:155]
s_add_u32 s70, s73, s65
v_cvt_pk_bf16_f32 v23, v23, v31
v_mfma_f32_16x16x32_bf16 v[148:151], v[72:75], v[104:107], v[148:151]
s_and_b32 s70, s70, 3
ds_read_b64_tr_b16 v[68:69], v12 offset:8192
v_mfma_f32_16x16x32_bf16 v[148:151], v[76:79], v[108:111], v[148:151]
s_and_b32 s73, s73, 12
ds_read_b64_tr_b16 v[70:71], v12 offset:9216
v_mfma_f32_16x16x32_bf16 v[144:147], v[76:79], v[100:103], v[144:147]
s_add_u32 s72, s71, 31744
buffer_load_dwordx4 v6, s[12:15], s72 offen offset:1024 lds
v_mfma_f32_16x16x32_bf16 v[144:147], v[72:75], v[96:99], v[144:147]
s_waitcnt lgkmcnt(8)
v_mfma_f32_16x16x32_bf16 v[160:163], v[80:83], v[96:99], v[160:163]
s_or_b32 s73, s73, s70
ds_read_b64_tr_b16 v[72:73], v13 offset:0
v_mfma_f32_16x16x32_bf16 v[160:163], v[84:87], v[100:103], v[160:163]
s_lshl_b32 s73, s73, 7
ds_read_b64_tr_b16 v[74:75], v13 offset:1024
v_mfma_f32_16x16x32_bf16 v[164:167], v[84:87], v[108:111], v[164:167]
s_add_u32 s69, s73, s67
v_mfma_f32_16x16x32_bf16 v[164:167], v[80:83], v[104:107], v[164:167]
s_add_u32 s72, s71, 63488
buffer_load_dwordx4 v7, s[12:15], s72 offen offset:2048 lds
v_mfma_f32_16x16x32_bf16 v[168:171], v[80:83], v[112:115], v[168:171]
s_waitcnt vmcnt(18)
ds_read_b64_tr_b16 v[76:77], v13 offset:8192
v_mfma_f32_16x16x32_bf16 v[168:171], v[84:87], v[116:119], v[168:171]
s_add_u32 s70, s73, s68
ds_read_b128 v[32:35], v18 offset:0
v_mfma_f32_16x16x32_bf16 v[172:175], v[84:87], v[124:127], v[172:175]
s_add_u32 s80, s78, 35840
ds_read_b64_tr_b16 v[78:79], v13 offset:9216
v_mfma_f32_16x16x32_bf16 v[172:175], v[80:83], v[120:123], v[172:175]
s_waitcnt lgkmcnt(9)
ds_read_b128 v[36:39], v19 offset:0
v_accvgpr_read_b32 v24, a248
v_mfma_f32_16x16x32_bf16 v[188:191], v[88:91], v[120:123], v[188:191]
s_add_u32 s72, s71, 95232
buffer_load_dwordx4 v7, s[12:15], s72 offen offset:3072 lds
v_mfma_f32_16x16x32_bf16 v[188:191], v[92:95], v[124:127], v[188:191]
ds_read_b64_tr_b16 v[80:81], v14 offset:0
v_accvgpr_read_b32 v28, a249
v_mfma_f32_16x16x32_bf16 v[184:187], v[92:95], v[116:119], v[184:187]
ds_read_b64_tr_b16 v[82:83], v14 offset:1024
v_accvgpr_read_b32 v25, a250
v_mfma_f32_16x16x32_bf16 v[184:187], v[88:91], v[112:115], v[184:187]
buffer_store_dwordx4 v[20:23], v1, s[44:47], s80 offen sc1
v_mfma_f32_16x16x32_bf16 v[180:183], v[88:91], v[104:107], v[180:183]
ds_read_b64_tr_b16 v[84:85], v14 offset:8192
v_accvgpr_read_b32 v29, a251
v_mfma_f32_16x16x32_bf16 v[180:183], v[92:95], v[108:111], v[180:183]
s_add_u32 m0, s63, 131072
ds_read_b64_tr_b16 v[86:87], v14 offset:9216
v_accvgpr_read_b32 v26, a252
v_mfma_f32_16x16x32_bf16 v[176:179], v[92:95], v[100:103], v[176:179]
s_add_u32 s72, s69, 0
buffer_load_dwordx4 v4, s[4:7], s72 offen lds
v_mfma_f32_16x16x32_bf16 v[176:179], v[88:91], v[96:99], v[176:179]
s_waitcnt lgkmcnt(10)
ds_read_b128 v[40:43], v18 offset:2048
v_accvgpr_read_b32 v30, a253
v_mfma_f32_16x16x32_bf16 v[192:195], v[64:67], v[96:99], v[192:195]
ds_read_b64_tr_b16 v[88:89], v15 offset:0
v_accvgpr_read_b32 v27, a254
v_mfma_f32_16x16x32_bf16 v[192:195], v[68:71], v[100:103], v[192:195]
ds_read_b64_tr_b16 v[90:91], v15 offset:1024
v_accvgpr_read_b32 v31, a255
v_mfma_f32_16x16x32_bf16 v[196:199], v[68:71], v[108:111], v[196:199]
ds_read_b64_tr_b16 v[92:93], v15 offset:8192
v_cvt_pk_bf16_f32 v24, v24, v28
v_mfma_f32_16x16x32_bf16 v[196:199], v[64:67], v[104:107], v[196:199]
s_add_u32 s72, s69, 15360
buffer_load_dwordx4 v5, s[4:7], s72 offen offset:1024 lds
v_mfma_f32_16x16x32_bf16 v[200:203], v[64:67], v[112:115], v[200:203]
ds_read_b64_tr_b16 v[94:95], v15 offset:9216
v_cvt_pk_bf16_f32 v25, v25, v29
v_mfma_f32_16x16x32_bf16 v[200:203], v[68:71], v[116:119], v[200:203]
ds_read_b128 v[44:47], v19 offset:2048
v_cvt_pk_bf16_f32 v26, v26, v30
v_mfma_f32_16x16x32_bf16 v[204:207], v[68:71], v[124:127], v[204:207]
v_cvt_pk_bf16_f32 v27, v27, v31
v_mfma_f32_16x16x32_bf16 v[204:207], v[64:67], v[120:123], v[204:207]
s_waitcnt lgkmcnt(11)
ds_read_b128 v[48:51], v18 offset:4096
v_mfma_f32_16x16x32_bf16 v[220:223], v[72:75], v[120:123], v[220:223]
s_add_u32 s72, s69, 129024
buffer_load_dwordx4 v4, s[4:7], s72 offen offset:2048 lds
v_mfma_f32_16x16x32_bf16 v[220:223], v[76:79], v[124:127], v[220:223]
s_add_u32 s80, s78, 44032
ds_read_b128 v[52:55], v19 offset:4096
v_mfma_f32_16x16x32_bf16 v[216:219], v[76:79], v[116:119], v[216:219]
s_waitcnt vmcnt(19) lgkmcnt(3)
buffer_store_dwordx4 v[24:27], v1, s[44:47], s80 offen sc1
v_mfma_f32_16x16x32_bf16 v[216:219], v[72:75], v[112:115], v[216:219]
s_barrier
ds_read_b128 v[56:59], v18 offset:6144
v_mfma_f32_16x16x32_bf16 v[212:215], v[72:75], v[104:107], v[212:215]
ds_read_b64_tr_b16 v[64:65], v8 offset:16384
ds_read_b64_tr_b16 v[66:67], v8 offset:17408
v_mfma_f32_16x16x32_bf16 v[212:215], v[76:79], v[108:111], v[212:215]
ds_read_b64_tr_b16 v[68:69], v8 offset:24576
ds_read_b64_tr_b16 v[70:71], v8 offset:25600
v_mfma_f32_16x16x32_bf16 v[208:211], v[76:79], v[100:103], v[208:211]
s_add_u32 s72, s69, 144384
buffer_load_dwordx4 v5, s[4:7], s72 offen offset:3072 lds
v_mfma_f32_16x16x32_bf16 v[208:211], v[72:75], v[96:99], v[208:211]
v_and_b32 v2, 31, v0
v_lshlrev_b32 v2, 2, v2
v_mfma_f32_16x16x32_bf16 v[224:227], v[80:83], v[96:99], v[224:227]
buffer_load_dword v3, v2, s[48:51], 0 offen sc1
v_mfma_f32_16x16x32_bf16 v[224:227], v[84:87], v[100:103], v[224:227]
ds_read_b64_tr_b16 v[72:73], v9 offset:16384
v_mfma_f32_16x16x32_bf16 v[228:231], v[84:87], v[108:111], v[228:231]
s_add_u32 m0, s63, 135168
ds_read_b64_tr_b16 v[74:75], v9 offset:17408
v_mfma_f32_16x16x32_bf16 v[228:231], v[80:83], v[104:107], v[228:231]
s_add_u32 s72, s70, 0
buffer_load_dwordx4 v4, s[4:7], s72 offen lds
v_mfma_f32_16x16x32_bf16 v[232:235], v[80:83], v[112:115], v[232:235]
ds_read_b128 v[60:63], v19 offset:6144
v_mfma_f32_16x16x32_bf16 v[232:235], v[84:87], v[116:119], v[232:235]
ds_read_b64_tr_b16 v[76:77], v9 offset:24576
v_mfma_f32_16x16x32_bf16 v[236:239], v[84:87], v[124:127], v[236:239]
ds_read_b64_tr_b16 v[78:79], v9 offset:25600
v_mfma_f32_16x16x32_bf16 v[236:239], v[80:83], v[120:123], v[236:239]
v_mfma_f32_16x16x32_bf16 v[252:255], v[88:91], v[120:123], v[252:255]
s_add_u32 s72, s70, 15360
buffer_load_dwordx4 v5, s[4:7], s72 offen offset:1024 lds
v_mfma_f32_16x16x32_bf16 v[252:255], v[92:95], v[124:127], v[252:255]
ds_read_b64_tr_b16 v[80:81], v10 offset:16384
v_mfma_f32_16x16x32_bf16 v[248:251], v[92:95], v[116:119], v[248:251]
ds_read_b64_tr_b16 v[82:83], v10 offset:17408
v_mfma_f32_16x16x32_bf16 v[248:251], v[88:91], v[112:115], v[248:251]
v_mfma_f32_16x16x32_bf16 v[244:247], v[88:91], v[104:107], v[244:247]
ds_read_b64_tr_b16 v[84:85], v10 offset:24576
v_mfma_f32_16x16x32_bf16 v[244:247], v[92:95], v[108:111], v[244:247]
ds_read_b64_tr_b16 v[86:87], v10 offset:25600
v_mfma_f32_16x16x32_bf16 v[240:243], v[92:95], v[100:103], v[240:243]
s_add_u32 s72, s70, 129024
buffer_load_dwordx4 v4, s[4:7], s72 offen offset:2048 lds
v_mfma_f32_16x16x32_bf16 v[240:243], v[88:91], v[96:99], v[240:243]
s_waitcnt lgkmcnt(6)
v_mfma_f32_16x16x32_bf16 v[128:131], v[64:67], v[32:35], v[128:131]
ds_read_b64_tr_b16 v[88:89], v11 offset:16384
v_mfma_f32_16x16x32_bf16 v[128:131], v[68:71], v[36:39], v[128:131]
ds_read_b64_tr_b16 v[90:91], v11 offset:17408
v_mfma_f32_16x16x32_bf16 v[132:135], v[68:71], v[44:47], v[132:135]
v_mfma_f32_16x16x32_bf16 v[132:135], v[64:67], v[40:43], v[132:135]
s_add_u32 s72, s70, 144384
buffer_load_dwordx4 v5, s[4:7], s72 offen offset:3072 lds
v_mfma_f32_16x16x32_bf16 v[136:139], v[64:67], v[48:51], v[136:139]
ds_read_b64_tr_b16 v[92:93], v11 offset:24576
v_mfma_f32_16x16x32_bf16 v[136:139], v[68:71], v[52:55], v[136:139]
s_lshl_b32 s71, s73, 12
v_mfma_f32_16x16x32_bf16 v[140:143], v[68:71], v[60:63], v[140:143]
s_add_u32 s71, s71, s66
ds_read_b64_tr_b16 v[94:95], v11 offset:25600
v_mfma_f32_16x16x32_bf16 v[140:143], v[64:67], v[56:59], v[140:143]
s_waitcnt lgkmcnt(8)
v_mfma_f32_16x16x32_bf16 v[156:159], v[72:75], v[56:59], v[156:159]
s_add_u32 m0, s64, 0
ds_read_b64_tr_b16 v[64:65], v12 offset:16384
v_mfma_f32_16x16x32_bf16 v[156:159], v[76:79], v[60:63], v[156:159]
s_add_u32 s72, s71, 0
buffer_load_dwordx4 v6, s[12:15], s72 offen lds
v_mfma_f32_16x16x32_bf16 v[152:155], v[76:79], v[52:55], v[152:155]
s_add_u32 s73, s62, 13
ds_read_b64_tr_b16 v[66:67], v12 offset:17408
v_mfma_f32_16x16x32_bf16 v[152:155], v[72:75], v[48:51], v[152:155]
s_add_u32 s70, s73, s65
v_mfma_f32_16x16x32_bf16 v[148:151], v[72:75], v[40:43], v[148:151]
s_and_b32 s70, s70, 3
ds_read_b64_tr_b16 v[68:69], v12 offset:24576
v_mfma_f32_16x16x32_bf16 v[148:151], v[76:79], v[44:47], v[148:151]
s_and_b32 s73, s73, 12
ds_read_b64_tr_b16 v[70:71], v12 offset:25600
v_mfma_f32_16x16x32_bf16 v[144:147], v[76:79], v[36:39], v[144:147]
s_add_u32 s72, s71, 31744
buffer_load_dwordx4 v6, s[12:15], s72 offen offset:1024 lds
v_mfma_f32_16x16x32_bf16 v[144:147], v[72:75], v[32:35], v[144:147]
s_waitcnt lgkmcnt(8)
v_mfma_f32_16x16x32_bf16 v[160:163], v[80:83], v[32:35], v[160:163]
s_or_b32 s73, s73, s70
ds_read_b64_tr_b16 v[72:73], v13 offset:16384
v_mfma_f32_16x16x32_bf16 v[160:163], v[84:87], v[36:39], v[160:163]
s_lshl_b32 s73, s73, 7
ds_read_b64_tr_b16 v[74:75], v13 offset:17408
v_mfma_f32_16x16x32_bf16 v[164:167], v[84:87], v[44:47], v[164:167]
s_add_u32 s69, s73, s67
v_mfma_f32_16x16x32_bf16 v[164:167], v[80:83], v[40:43], v[164:167]
s_add_u32 s72, s71, 63488
buffer_load_dwordx4 v7, s[12:15], s72 offen offset:2048 lds
v_mfma_f32_16x16x32_bf16 v[168:171], v[80:83], v[48:51], v[168:171]
s_waitcnt vmcnt(18)
ds_read_b64_tr_b16 v[76:77], v13 offset:24576
v_mfma_f32_16x16x32_bf16 v[168:171], v[84:87], v[52:55], v[168:171]
s_add_u32 s70, s73, s68
ds_read_b128 v[96:99], v18 offset:32768
v_mfma_f32_16x16x32_bf16 v[172:175], v[84:87], v[60:63], v[172:175]
ds_read_b64_tr_b16 v[78:79], v13 offset:25600
v_mfma_f32_16x16x32_bf16 v[172:175], v[80:83], v[56:59], v[172:175]
s_waitcnt lgkmcnt(9)
ds_read_b128 v[100:103], v19 offset:32768
v_mfma_f32_16x16x32_bf16 v[188:191], v[88:91], v[56:59], v[188:191]
s_add_u32 s72, s71, 95232
buffer_load_dwordx4 v7, s[12:15], s72 offen offset:3072 lds
v_mfma_f32_16x16x32_bf16 v[188:191], v[92:95], v[60:63], v[188:191]
ds_read_b64_tr_b16 v[80:81], v14 offset:16384
v_mfma_f32_16x16x32_bf16 v[184:187], v[92:95], v[52:55], v[184:187]
ds_read_b64_tr_b16 v[82:83], v14 offset:17408
v_mfma_f32_16x16x32_bf16 v[184:187], v[88:91], v[48:51], v[184:187]
v_mfma_f32_16x16x32_bf16 v[180:183], v[88:91], v[40:43], v[180:183]
ds_read_b64_tr_b16 v[84:85], v14 offset:24576
v_mfma_f32_16x16x32_bf16 v[180:183], v[92:95], v[44:47], v[180:183]
s_add_u32 m0, s63, 65536
ds_read_b64_tr_b16 v[86:87], v14 offset:25600
v_mfma_f32_16x16x32_bf16 v[176:179], v[92:95], v[36:39], v[176:179]
s_add_u32 s72, s69, 0
buffer_load_dwordx4 v4, s[4:7], s72 offen lds
v_mfma_f32_16x16x32_bf16 v[176:179], v[88:91], v[32:35], v[176:179]
s_waitcnt lgkmcnt(10)
ds_read_b128 v[104:107], v18 offset:34816
v_mfma_f32_16x16x32_bf16 v[192:195], v[64:67], v[32:35], v[192:195]
ds_read_b64_tr_b16 v[88:89], v15 offset:16384
v_mfma_f32_16x16x32_bf16 v[192:195], v[68:71], v[36:39], v[192:195]
ds_read_b64_tr_b16 v[90:91], v15 offset:17408
v_mfma_f32_16x16x32_bf16 v[196:199], v[68:71], v[44:47], v[196:199]
ds_read_b64_tr_b16 v[92:93], v15 offset:24576
v_mfma_f32_16x16x32_bf16 v[196:199], v[64:67], v[40:43], v[196:199]
s_add_u32 s72, s69, 15360
buffer_load_dwordx4 v5, s[4:7], s72 offen offset:1024 lds
v_mfma_f32_16x16x32_bf16 v[200:203], v[64:67], v[48:51], v[200:203]
ds_read_b64_tr_b16 v[94:95], v15 offset:25600
v_mfma_f32_16x16x32_bf16 v[200:203], v[68:71], v[52:55], v[200:203]
ds_read_b128 v[108:111], v19 offset:34816
v_mfma_f32_16x16x32_bf16 v[204:207], v[68:71], v[60:63], v[204:207]
v_mfma_f32_16x16x32_bf16 v[204:207], v[64:67], v[56:59], v[204:207]
s_waitcnt lgkmcnt(11)
ds_read_b128 v[112:115], v18 offset:36864
v_mfma_f32_16x16x32_bf16 v[220:223], v[72:75], v[56:59], v[220:223]
s_add_u32 s72, s69, 129024
buffer_load_dwordx4 v4, s[4:7], s72 offen offset:2048 lds
v_mfma_f32_16x16x32_bf16 v[220:223], v[76:79], v[60:63], v[220:223]
v_mfma_f32_16x16x32_bf16 v[216:219], v[76:79], v[52:55], v[216:219]
s_waitcnt vmcnt(13) lgkmcnt(2)
ds_read_b128 v[116:119], v19 offset:36864
v_mfma_f32_16x16x32_bf16 v[216:219], v[72:75], v[48:51], v[216:219]
s_barrier
ds_read_b128 v[120:123], v18 offset:38912
v_mfma_f32_16x16x32_bf16 v[212:215], v[72:75], v[40:43], v[212:215]
ds_read_b64_tr_b16 v[64:65], v8 offset:32768
ds_read_b64_tr_b16 v[66:67], v8 offset:33792
v_mfma_f32_16x16x32_bf16 v[212:215], v[76:79], v[44:47], v[212:215]
ds_read_b64_tr_b16 v[68:69], v8 offset:40960
v_or_b32 v20, s58, v0
v_mfma_f32_16x16x32_bf16 v[208:211], v[76:79], v[36:39], v[208:211]
s_add_u32 s72, s69, 144384
buffer_load_dwordx4 v5, s[4:7], s72 offen offset:3072 lds
v_mfma_f32_16x16x32_bf16 v[208:211], v[72:75], v[32:35], v[208:211]
ds_read_b64_tr_b16 v[70:71], v8 offset:41984
v_mov_b32 v21, 1
v_mfma_f32_16x16x32_bf16 v[224:227], v[80:83], v[32:35], v[224:227]
ds_read_b64_tr_b16 v[72:73], v9 offset:32768
v_min_u32 v20, 1, v20
v_mfma_f32_16x16x32_bf16 v[224:227], v[84:87], v[36:39], v[224:227]
ds_read_b64_tr_b16 v[74:75], v9 offset:33792
v_lshlrev_b32 v20, 30, v20
v_mfma_f32_16x16x32_bf16 v[228:231], v[84:87], v[44:47], v[228:231]
s_add_u32 m0, s63, 69632
buffer_store_dword v21, v20, s[44:47], s91 offen sc1
v_mfma_f32_16x16x32_bf16 v[228:231], v[80:83], v[40:43], v[228:231]
s_add_u32 s72, s70, 0
buffer_load_dwordx4 v4, s[4:7], s72 offen lds
v_mfma_f32_16x16x32_bf16 v[232:235], v[80:83], v[48:51], v[232:235]
ds_read_b64_tr_b16 v[76:77], v9 offset:40960
v_accvgpr_write_b32 a32, 0
v_mfma_f32_16x16x32_bf16 v[232:235], v[84:87], v[52:55], v[232:235]
ds_read_b128 v[124:127], v19 offset:38912
v_accvgpr_write_b32 a33, 0
v_mfma_f32_16x16x32_bf16 v[236:239], v[84:87], v[60:63], v[236:239]
ds_read_b64_tr_b16 v[78:79], v9 offset:41984
v_accvgpr_write_b32 a34, 0
v_mfma_f32_16x16x32_bf16 v[236:239], v[80:83], v[56:59], v[236:239]
v_accvgpr_write_b32 a35, 0
v_accvgpr_write_b32 a36, 0
v_mfma_f32_16x16x32_bf16 v[252:255], v[88:91], v[56:59], v[252:255]
s_add_u32 s72, s70, 15360
buffer_load_dwordx4 v5, s[4:7], s72 offen offset:1024 lds
v_mfma_f32_16x16x32_bf16 v[252:255], v[92:95], v[60:63], v[252:255]
ds_read_b64_tr_b16 v[80:81], v10 offset:32768
v_accvgpr_write_b32 a37, 0
v_mfma_f32_16x16x32_bf16 v[248:251], v[92:95], v[52:55], v[248:251]
ds_read_b64_tr_b16 v[82:83], v10 offset:33792
v_accvgpr_write_b32 a38, 0
v_mfma_f32_16x16x32_bf16 v[248:251], v[88:91], v[48:51], v[248:251]
v_accvgpr_write_b32 a39, 0
v_accvgpr_write_b32 a40, 0
v_mfma_f32_16x16x32_bf16 v[244:247], v[88:91], v[40:43], v[244:247]
ds_read_b64_tr_b16 v[84:85], v10 offset:40960
v_accvgpr_write_b32 a41, 0
v_mfma_f32_16x16x32_bf16 v[244:247], v[92:95], v[44:47], v[244:247]
ds_read_b64_tr_b16 v[86:87], v10 offset:41984
v_accvgpr_write_b32 a42, 0
v_mfma_f32_16x16x32_bf16 v[240:243], v[92:95], v[36:39], v[240:243]
s_add_u32 s72, s70, 129024
buffer_load_dwordx4 v4, s[4:7], s72 offen offset:2048 lds
v_mfma_f32_16x16x32_bf16 v[240:243], v[88:91], v[32:35], v[240:243]
s_waitcnt lgkmcnt(5)
v_accvgpr_write_b32 a43, 0
v_accvgpr_write_b32 a44, 0
v_mfma_f32_16x16x32_bf16 v[128:131], v[64:67], v[96:99], v[128:131]
ds_read_b64_tr_b16 v[88:89], v11 offset:32768
v_accvgpr_write_b32 a45, 0
v_mfma_f32_16x16x32_bf16 v[128:131], v[68:71], v[100:103], v[128:131]
ds_read_b64_tr_b16 v[90:91], v11 offset:33792
v_accvgpr_write_b32 a46, 0
v_mfma_f32_16x16x32_bf16 v[132:135], v[68:71], v[108:111], v[132:135]
v_accvgpr_write_b32 a47, 0
v_accvgpr_write_b32 a48, 0
v_mfma_f32_16x16x32_bf16 v[132:135], v[64:67], v[104:107], v[132:135]
s_add_u32 s72, s70, 144384
buffer_load_dwordx4 v5, s[4:7], s72 offen offset:3072 lds
v_mfma_f32_16x16x32_bf16 v[136:139], v[64:67], v[112:115], v[136:139]
ds_read_b64_tr_b16 v[92:93], v11 offset:40960
v_accvgpr_write_b32 a49, 0
v_mfma_f32_16x16x32_bf16 v[136:139], v[68:71], v[116:119], v[136:139]
s_lshl_b32 s71, s73, 12
v_accvgpr_write_b32 a50, 0
v_accvgpr_write_b32 a51, 0
v_mfma_f32_16x16x32_bf16 v[140:143], v[68:71], v[124:127], v[140:143]
s_add_u32 s71, s71, s66
ds_read_b64_tr_b16 v[94:95], v11 offset:41984
v_accvgpr_write_b32 a52, 0
v_mfma_f32_16x16x32_bf16 v[140:143], v[64:67], v[120:123], v[140:143]
s_waitcnt lgkmcnt(8)
v_accvgpr_write_b32 a53, 0
v_accvgpr_write_b32 a54, 0
v_mfma_f32_16x16x32_bf16 v[156:159], v[72:75], v[120:123], v[156:159]
s_add_u32 m0, s64, 16384
ds_read_b64_tr_b16 v[64:65], v12 offset:32768
v_accvgpr_write_b32 a55, 0
v_mfma_f32_16x16x32_bf16 v[156:159], v[76:79], v[124:127], v[156:159]
s_add_u32 s72, s71, 0
buffer_load_dwordx4 v6, s[12:15], s72 offen lds
v_mfma_f32_16x16x32_bf16 v[152:155], v[76:79], v[116:119], v[152:155]
s_add_u32 s73, s62, 14
ds_read_b64_tr_b16 v[66:67], v12 offset:33792
v_accvgpr_write_b32 a56, 0
v_mfma_f32_16x16x32_bf16 v[152:155], v[72:75], v[112:115], v[152:155]
s_add_u32 s70, s73, s65
v_accvgpr_write_b32 a57, 0
v_accvgpr_write_b32 a58, 0
v_mfma_f32_16x16x32_bf16 v[148:151], v[72:75], v[104:107], v[148:151]
s_and_b32 s70, s70, 3
ds_read_b64_tr_b16 v[68:69], v12 offset:40960
v_accvgpr_write_b32 a59, 0
v_mfma_f32_16x16x32_bf16 v[148:151], v[76:79], v[108:111], v[148:151]
s_and_b32 s73, s73, 12
ds_read_b64_tr_b16 v[70:71], v12 offset:41984
v_accvgpr_write_b32 a60, 0
v_mfma_f32_16x16x32_bf16 v[144:147], v[76:79], v[100:103], v[144:147]
s_add_u32 s72, s71, 31744
buffer_load_dwordx4 v6, s[12:15], s72 offen offset:1024 lds
v_mfma_f32_16x16x32_bf16 v[144:147], v[72:75], v[96:99], v[144:147]
s_waitcnt lgkmcnt(8)
v_accvgpr_write_b32 a61, 0
v_accvgpr_write_b32 a62, 0
v_mfma_f32_16x16x32_bf16 v[160:163], v[80:83], v[96:99], v[160:163]
s_or_b32 s73, s73, s70
ds_read_b64_tr_b16 v[72:73], v13 offset:32768
v_accvgpr_write_b32 a63, 0
v_mfma_f32_16x16x32_bf16 v[160:163], v[84:87], v[100:103], v[160:163]
s_lshl_b32 s73, s73, 7
ds_read_b64_tr_b16 v[74:75], v13 offset:33792
v_accvgpr_write_b32 a96, 0
v_mfma_f32_16x16x32_bf16 v[164:167], v[84:87], v[108:111], v[164:167]
s_add_u32 s69, s73, s67
v_accvgpr_write_b32 a97, 0
v_accvgpr_write_b32 a98, 0
v_mfma_f32_16x16x32_bf16 v[164:167], v[80:83], v[104:107], v[164:167]
s_add_u32 s72, s71, 63488
buffer_load_dwordx4 v7, s[12:15], s72 offen offset:2048 lds
v_mfma_f32_16x16x32_bf16 v[168:171], v[80:83], v[112:115], v[168:171]
s_waitcnt vmcnt(16)
ds_read_b64_tr_b16 v[76:77], v13 offset:40960
v_accvgpr_write_b32 a99, 0
v_mfma_f32_16x16x32_bf16 v[168:171], v[84:87], v[116:119], v[168:171]
s_add_u32 s70, s73, s68
ds_read_b128 v[32:35], v16 offset:0
v_accvgpr_write_b32 a100, 0
v_mfma_f32_16x16x32_bf16 v[172:175], v[84:87], v[124:127], v[172:175]
ds_read_b64_tr_b16 v[78:79], v13 offset:41984
v_accvgpr_write_b32 a101, 0
v_mfma_f32_16x16x32_bf16 v[172:175], v[80:83], v[120:123], v[172:175]
s_waitcnt lgkmcnt(9)
ds_read_b128 v[36:39], v17 offset:0
v_accvgpr_write_b32 a102, 0
v_mfma_f32_16x16x32_bf16 v[188:191], v[88:91], v[120:123], v[188:191]
s_add_u32 s72, s71, 95232
buffer_load_dwordx4 v7, s[12:15], s72 offen offset:3072 lds
v_mfma_f32_16x16x32_bf16 v[188:191], v[92:95], v[124:127], v[188:191]
ds_read_b64_tr_b16 v[80:81], v14 offset:32768
v_accvgpr_write_b32 a103, 0
v_mfma_f32_16x16x32_bf16 v[184:187], v[92:95], v[116:119], v[184:187]
ds_read_b64_tr_b16 v[82:83], v14 offset:33792
v_accvgpr_write_b32 a104, 0
v_mfma_f32_16x16x32_bf16 v[184:187], v[88:91], v[112:115], v[184:187]
v_accvgpr_write_b32 a105, 0
v_accvgpr_write_b32 a106, 0
v_mfma_f32_16x16x32_bf16 v[180:183], v[88:91], v[104:107], v[180:183]
ds_read_b64_tr_b16 v[84:85], v14 offset:40960
v_accvgpr_write_b32 a107, 0
v_mfma_f32_16x16x32_bf16 v[180:183], v[92:95], v[108:111], v[180:183]
s_add_u32 m0, s63, 98304
ds_read_b64_tr_b16 v[86:87], v14 offset:41984
v_accvgpr_write_b32 a108, 0
v_mfma_f32_16x16x32_bf16 v[176:179], v[92:95], v[100:103], v[176:179]
s_add_u32 s72, s69, 0
buffer_load_dwordx4 v4, s[4:7], s72 offen lds
v_mfma_f32_16x16x32_bf16 v[176:179], v[88:91], v[96:99], v[176:179]
s_waitcnt lgkmcnt(10)
ds_read_b128 v[40:43], v16 offset:2048
v_accvgpr_write_b32 a109, 0
v_mfma_f32_16x16x32_bf16 v[192:195], v[64:67], v[96:99], v[192:195]
ds_read_b64_tr_b16 v[88:89], v15 offset:32768
v_accvgpr_write_b32 a110, 0
v_mfma_f32_16x16x32_bf16 v[192:195], v[68:71], v[100:103], v[192:195]
ds_read_b64_tr_b16 v[90:91], v15 offset:33792
v_accvgpr_write_b32 a111, 0
v_mfma_f32_16x16x32_bf16 v[196:199], v[68:71], v[108:111], v[196:199]
ds_read_b64_tr_b16 v[92:93], v15 offset:40960
v_accvgpr_write_b32 a112, 0
v_mfma_f32_16x16x32_bf16 v[196:199], v[64:67], v[104:107], v[196:199]
s_add_u32 s72, s69, 15360
buffer_load_dwordx4 v5, s[4:7], s72 offen offset:1024 lds
v_mfma_f32_16x16x32_bf16 v[200:203], v[64:67], v[112:115], v[200:203]
ds_read_b64_tr_b16 v[94:95], v15 offset:41984
v_accvgpr_write_b32 a113, 0
v_mfma_f32_16x16x32_bf16 v[200:203], v[68:71], v[116:119], v[200:203]
ds_read_b128 v[44:47], v17 offset:2048
v_accvgpr_write_b32 a114, 0
v_mfma_f32_16x16x32_bf16 v[204:207], v[68:71], v[124:127], v[204:207]
v_accvgpr_write_b32 a115, 0
v_accvgpr_write_b32 a116, 0
v_mfma_f32_16x16x32_bf16 v[204:207], v[64:67], v[120:123], v[204:207]
s_waitcnt lgkmcnt(11)
ds_read_b128 v[48:51], v16 offset:4096
v_accvgpr_write_b32 a117, 0
v_mfma_f32_16x16x32_bf16 v[220:223], v[72:75], v[120:123], v[220:223]
s_add_u32 s72, s69, 129024
buffer_load_dwordx4 v4, s[4:7], s72 offen offset:2048 lds
v_mfma_f32_16x16x32_bf16 v[220:223], v[76:79], v[124:127], v[220:223]
v_accvgpr_write_b32 a118, 0
v_accvgpr_write_b32 a119, 0
v_mfma_f32_16x16x32_bf16 v[216:219], v[76:79], v[116:119], v[216:219]
s_waitcnt vmcnt(16) lgkmcnt(2)
ds_read_b128 v[52:55], v17 offset:4096
v_accvgpr_write_b32 a120, 0
v_mfma_f32_16x16x32_bf16 v[216:219], v[72:75], v[112:115], v[216:219]
s_barrier
ds_read_b128 v[56:59], v16 offset:6144
v_accvgpr_write_b32 a121, 0
v_mfma_f32_16x16x32_bf16 v[212:215], v[72:75], v[104:107], v[212:215]
s_waitcnt vmcnt(24)
v_cmp_gt_u32 vcc, 8, v3
s_cbranch_vccnz Lspin1
Lback2:
v_mfma_f32_16x16x32_bf16 v[212:215], v[76:79], v[108:111], v[212:215]
ds_read_b64_tr_b16 v[64:65], v8 offset:0
ds_read_b64_tr_b16 v[66:67], v8 offset:1024
v_mfma_f32_16x16x32_bf16 v[208:211], v[76:79], v[100:103], v[208:211]
s_add_u32 s72, s69, 144384
buffer_load_dwordx4 v5, s[4:7], s72 offen offset:3072 lds
v_mfma_f32_16x16x32_bf16 v[208:211], v[72:75], v[96:99], v[208:211]
ds_read_b64_tr_b16 v[68:69], v8 offset:8192
ds_read_b64_tr_b16 v[70:71], v8 offset:9216
v_mfma_f32_16x16x32_bf16 v[224:227], v[80:83], v[96:99], v[224:227]
ds_read_b64_tr_b16 v[72:73], v9 offset:0
v_accvgpr_write_b32 a122, 0
v_mfma_f32_16x16x32_bf16 v[224:227], v[84:87], v[100:103], v[224:227]
ds_read_b64_tr_b16 v[74:75], v9 offset:1024
v_accvgpr_write_b32 a123, 0
v_mfma_f32_16x16x32_bf16 v[228:231], v[84:87], v[108:111], v[228:231]
s_add_u32 m0, s63, 102400
v_accvgpr_write_b32 a124, 0
v_accvgpr_write_b32 a125, 0
v_mfma_f32_16x16x32_bf16 v[228:231], v[80:83], v[104:107], v[228:231]
s_add_u32 s72, s70, 0
buffer_load_dwordx4 v4, s[4:7], s72 offen lds
v_mfma_f32_16x16x32_bf16 v[232:235], v[80:83], v[112:115], v[232:235]
ds_read_b64_tr_b16 v[76:77], v9 offset:8192
v_accvgpr_write_b32 a126, 0
v_mfma_f32_16x16x32_bf16 v[232:235], v[84:87], v[116:119], v[232:235]
ds_read_b128 v[60:63], v17 offset:6144
v_accvgpr_write_b32 a127, 0
v_mfma_f32_16x16x32_bf16 v[236:239], v[84:87], v[124:127], v[236:239]
ds_read_b64_tr_b16 v[78:79], v9 offset:9216
v_mfma_f32_16x16x32_bf16 v[236:239], v[80:83], v[120:123], v[236:239]
v_mfma_f32_16x16x32_bf16 v[252:255], v[88:91], v[120:123], v[252:255]
s_add_u32 s72, s70, 15360
buffer_load_dwordx4 v5, s[4:7], s72 offen offset:1024 lds
v_mfma_f32_16x16x32_bf16 v[252:255], v[92:95], v[124:127], v[252:255]
ds_read_b64_tr_b16 v[80:81], v10 offset:0
v_mfma_f32_16x16x32_bf16 v[248:251], v[92:95], v[116:119], v[248:251]
ds_read_b64_tr_b16 v[82:83], v10 offset:1024
v_mfma_f32_16x16x32_bf16 v[248:251], v[88:91], v[112:115], v[248:251]
v_mfma_f32_16x16x32_bf16 v[244:247], v[88:91], v[104:107], v[244:247]
ds_read_b64_tr_b16 v[84:85], v10 offset:8192
v_mfma_f32_16x16x32_bf16 v[244:247], v[92:95], v[108:111], v[244:247]
ds_read_b64_tr_b16 v[86:87], v10 offset:9216
v_mfma_f32_16x16x32_bf16 v[240:243], v[92:95], v[100:103], v[240:243]
s_add_u32 s72, s70, 129024
buffer_load_dwordx4 v4, s[4:7], s72 offen offset:2048 lds
v_mfma_f32_16x16x32_bf16 v[240:243], v[88:91], v[96:99], v[240:243]
s_waitcnt lgkmcnt(5)
v_mfma_f32_16x16x32_bf16 v[128:131], v[64:67], v[32:35], v[128:131]
ds_read_b64_tr_b16 v[88:89], v11 offset:0
v_mfma_f32_16x16x32_bf16 v[128:131], v[68:71], v[36:39], v[128:131]
ds_read_b64_tr_b16 v[90:91], v11 offset:1024
v_mfma_f32_16x16x32_bf16 v[132:135], v[68:71], v[44:47], v[132:135]
v_mfma_f32_16x16x32_bf16 v[132:135], v[64:67], v[40:43], v[132:135]
s_add_u32 s72, s70, 144384
buffer_load_dwordx4 v5, s[4:7], s72 offen offset:3072 lds
v_mfma_f32_16x16x32_bf16 v[136:139], v[64:67], v[48:51], v[136:139]
ds_read_b64_tr_b16 v[92:93], v11 offset:8192
v_mfma_f32_16x16x32_bf16 v[136:139], v[68:71], v[52:55], v[136:139]
s_lshl_b32 s71, s73, 12
v_mfma_f32_16x16x32_bf16 v[140:143], v[68:71], v[60:63], v[140:143]
s_add_u32 s71, s71, s66
ds_read_b64_tr_b16 v[94:95], v11 offset:9216
v_mfma_f32_16x16x32_bf16 v[140:143], v[64:67], v[56:59], v[140:143]
s_waitcnt lgkmcnt(8)
v_mfma_f32_16x16x32_bf16 v[156:159], v[72:75], v[56:59], v[156:159]
s_add_u32 m0, s64, 32768
ds_read_b64_tr_b16 v[64:65], v12 offset:0
v_mfma_f32_16x16x32_bf16 v[156:159], v[76:79], v[60:63], v[156:159]
s_add_u32 s72, s71, 0
buffer_load_dwordx4 v6, s[12:15], s72 offen lds
v_mfma_f32_16x16x32_bf16 v[152:155], v[76:79], v[52:55], v[152:155]
s_add_u32 s73, s62, 15
ds_read_b64_tr_b16 v[66:67], v12 offset:1024
v_mfma_f32_16x16x32_bf16 v[152:155], v[72:75], v[48:51], v[152:155]
s_add_u32 s70, s73, s65
v_mfma_f32_16x16x32_bf16 v[148:151], v[72:75], v[40:43], v[148:151]
s_and_b32 s70, s70, 3
ds_read_b64_tr_b16 v[68:69], v12 offset:8192
v_mfma_f32_16x16x32_bf16 v[148:151], v[76:79], v[44:47], v[148:151]
s_and_b32 s73, s73, 12
ds_read_b64_tr_b16 v[70:71], v12 offset:9216
v_mfma_f32_16x16x32_bf16 v[144:147], v[76:79], v[36:39], v[144:147]
s_add_u32 s72, s71, 31744
buffer_load_dwordx4 v6, s[12:15], s72 offen offset:1024 lds
v_mfma_f32_16x16x32_bf16 v[144:147], v[72:75], v[32:35], v[144:147]
s_waitcnt lgkmcnt(8)
v_mfma_f32_16x16x32_bf16 v[160:163], v[80:83], v[32:35], v[160:163]
s_or_b32 s73, s73, s70
ds_read_b64_tr_b16 v[72:73], v13 offset:0
v_mfma_f32_16x16x32_bf16 v[160:163], v[84:87], v[36:39], v[160:163]
s_lshl_b32 s73, s73, 7
ds_read_b64_tr_b16 v[74:75], v13 offset:1024
v_mfma_f32_16x16x32_bf16 v[164:167], v[84:87], v[44:47], v[164:167]
s_add_u32 s69, s73, s67
v_mfma_f32_16x16x32_bf16 v[164:167], v[80:83], v[40:43], v[164:167]
s_add_u32 s72, s71, 63488
buffer_load_dwordx4 v7, s[12:15], s72 offen offset:2048 lds
v_mfma_f32_16x16x32_bf16 v[168:171], v[80:83], v[48:51], v[168:171]
s_waitcnt vmcnt(15)
ds_read_b64_tr_b16 v[76:77], v13 offset:8192
v_mfma_f32_16x16x32_bf16 v[168:171], v[84:87], v[52:55], v[168:171]
s_add_u32 s70, s73, s68
ds_read_b128 v[96:99], v18 offset:0
v_mfma_f32_16x16x32_bf16 v[172:175], v[84:87], v[60:63], v[172:175]
ds_read_b64_tr_b16 v[78:79], v13 offset:9216
v_mfma_f32_16x16x32_bf16 v[172:175], v[80:83], v[56:59], v[172:175]
s_waitcnt lgkmcnt(9)
ds_read_b128 v[100:103], v19 offset:0
v_mfma_f32_16x16x32_bf16 v[188:191], v[88:91], v[56:59], v[188:191]
s_add_u32 s72, s71, 95232
buffer_load_dwordx4 v7, s[12:15], s72 offen offset:3072 lds
v_mfma_f32_16x16x32_bf16 v[188:191], v[92:95], v[60:63], v[188:191]
ds_read_b64_tr_b16 v[80:81], v14 offset:0
v_mfma_f32_16x16x32_bf16 v[184:187], v[92:95], v[52:55], v[184:187]
ds_read_b64_tr_b16 v[82:83], v14 offset:1024
v_mfma_f32_16x16x32_bf16 v[184:187], v[88:91], v[48:51], v[184:187]
v_mfma_f32_16x16x32_bf16 v[180:183], v[88:91], v[40:43], v[180:183]
ds_read_b64_tr_b16 v[84:85], v14 offset:8192
v_mfma_f32_16x16x32_bf16 v[180:183], v[92:95], v[44:47], v[180:183]
s_add_u32 m0, s63, 131072
ds_read_b64_tr_b16 v[86:87], v14 offset:9216
v_mfma_f32_16x16x32_bf16 v[176:179], v[92:95], v[36:39], v[176:179]
s_add_u32 s72, s69, 0
buffer_load_dwordx4 v4, s[4:7], s72 offen lds
v_mfma_f32_16x16x32_bf16 v[176:179], v[88:91], v[32:35], v[176:179]
s_waitcnt lgkmcnt(10)
ds_read_b128 v[104:107], v18 offset:2048
v_mfma_f32_16x16x32_bf16 v[192:195], v[64:67], v[32:35], v[192:195]
ds_read_b64_tr_b16 v[88:89], v15 offset:0
ds_read_b64_tr_b16 v[90:91], v15 offset:1024
v_mfma_f32_16x16x32_bf16 v[192:195], v[68:71], v[36:39], v[192:195]
ds_read_b64_tr_b16 v[92:93], v15 offset:8192
v_mfma_f32_16x16x32_bf16 v[196:199], v[68:71], v[44:47], v[196:199]
s_and_b32 s75, s91, 0xfffffc7f
v_lshrrev_b32 v2, 3, v0
v_lshlrev_b32 v2, 7, v2
v_mfma_f32_16x16x32_bf16 v[196:199], v[64:67], v[40:43], v[196:199]
s_add_u32 s72, s69, 15360
buffer_load_dwordx4 v5, s[4:7], s72 offen offset:1024 lds
v_mfma_f32_16x16x32_bf16 v[200:203], v[64:67], v[48:51], v[200:203]
buffer_load_dword v3, v2, s[44:47], s75 offen sc1
v_mfma_f32_16x16x32_bf16 v[200:203], v[68:71], v[52:55], v[200:203]
ds_read_b64_tr_b16 v[94:95], v15 offset:9216
v_mfma_f32_16x16x32_bf16 v[204:207], v[68:71], v[60:63], v[204:207]
ds_read_b128 v[108:111], v19 offset:2048
v_mfma_f32_16x16x32_bf16 v[204:207], v[64:67], v[56:59], v[204:207]
s_waitcnt lgkmcnt(11)
v_mfma_f32_16x16x32_bf16 v[220:223], v[72:75], v[56:59], v[220:223]
s_add_u32 s72, s69, 129024
buffer_load_dwordx4 v4, s[4:7], s72 offen offset:2048 lds
v_mfma_f32_16x16x32_bf16 v[220:223], v[76:79], v[60:63], v[220:223]
ds_read_b128 v[112:115], v18 offset:4096
v_mfma_f32_16x16x32_bf16 v[216:219], v[76:79], v[52:55], v[216:219]
s_waitcnt vmcnt(16) lgkmcnt(2)
ds_read_b128 v[116:119], v19 offset:4096
v_mfma_f32_16x16x32_bf16 v[216:219], v[72:75], v[48:51], v[216:219]
s_barrier
v_mfma_f32_16x16x32_bf16 v[212:215], v[72:75], v[40:43], v[212:215]
ds_read_b64_tr_b16 v[64:65], v8 offset:16384
ds_read_b64_tr_b16 v[66:67], v8 offset:17408
v_mfma_f32_16x16x32_bf16 v[212:215], v[76:79], v[44:47], v[212:215]
ds_read_b64_tr_b16 v[68:69], v8 offset:24576
v_mfma_f32_16x16x32_bf16 v[208:211], v[76:79], v[36:39], v[208:211]
s_add_u32 s72, s69, 144384
buffer_load_dwordx4 v5, s[4:7], s72 offen offset:3072 lds
v_mfma_f32_16x16x32_bf16 v[208:211], v[72:75], v[32:35], v[208:211]
ds_read_b64_tr_b16 v[70:71], v8 offset:25600
v_mfma_f32_16x16x32_bf16 v[224:227], v[80:83], v[32:35], v[224:227]
ds_read_b64_tr_b16 v[72:73], v9 offset:16384
v_mfma_f32_16x16x32_bf16 v[224:227], v[84:87], v[36:39], v[224:227]
ds_read_b64_tr_b16 v[74:75], v9 offset:17408
v_mfma_f32_16x16x32_bf16 v[228:231], v[84:87], v[44:47], v[228:231]
s_add_u32 m0, s63, 135168
ds_read_b128 v[120:123], v18 offset:6144
v_mfma_f32_16x16x32_bf16 v[228:231], v[80:83], v[40:43], v[228:231]
s_add_u32 s72, s70, 0
buffer_load_dwordx4 v4, s[4:7], s72 offen lds
v_mfma_f32_16x16x32_bf16 v[232:235], v[80:83], v[48:51], v[232:235]
ds_read_b64_tr_b16 v[76:77], v9 offset:24576
v_mfma_f32_16x16x32_bf16 v[232:235], v[84:87], v[52:55], v[232:235]
ds_read_b128 v[124:127], v19 offset:6144
v_mfma_f32_16x16x32_bf16 v[236:239], v[84:87], v[60:63], v[236:239]
ds_read_b64_tr_b16 v[78:79], v9 offset:25600
v_mfma_f32_16x16x32_bf16 v[236:239], v[80:83], v[56:59], v[236:239]
v_mfma_f32_16x16x32_bf16 v[252:255], v[88:91], v[56:59], v[252:255]
s_add_u32 s72, s70, 15360
buffer_load_dwordx4 v5, s[4:7], s72 offen offset:1024 lds
v_mfma_f32_16x16x32_bf16 v[252:255], v[92:95], v[60:63], v[252:255]
ds_read_b64_tr_b16 v[80:81], v10 offset:16384
v_mfma_f32_16x16x32_bf16 v[248:251], v[92:95], v[52:55], v[248:251]
ds_read_b64_tr_b16 v[82:83], v10 offset:17408
v_mfma_f32_16x16x32_bf16 v[248:251], v[88:91], v[48:51], v[248:251]
v_mfma_f32_16x16x32_bf16 v[244:247], v[88:91], v[40:43], v[244:247]
ds_read_b64_tr_b16 v[84:85], v10 offset:24576
v_mfma_f32_16x16x32_bf16 v[244:247], v[92:95], v[44:47], v[244:247]
ds_read_b64_tr_b16 v[86:87], v10 offset:25600
v_mfma_f32_16x16x32_bf16 v[240:243], v[92:95], v[36:39], v[240:243]
s_add_u32 s72, s70, 129024
buffer_load_dwordx4 v4, s[4:7], s72 offen offset:2048 lds
v_mfma_f32_16x16x32_bf16 v[240:243], v[88:91], v[32:35], v[240:243]
s_waitcnt lgkmcnt(5)
v_mfma_f32_16x16x32_bf16 v[128:131], v[64:67], v[96:99], v[128:131]
ds_read_b64_tr_b16 v[88:89], v11 offset:16384
v_mfma_f32_16x16x32_bf16 v[128:131], v[68:71], v[100:103], v[128:131]
ds_read_b64_tr_b16 v[90:91], v11 offset:17408
v_mfma_f32_16x16x32_bf16 v[132:135], v[68:71], v[108:111], v[132:135]
v_mfma_f32_16x16x32_bf16 v[132:135], v[64:67], v[104:107], v[132:135]
s_add_u32 s72, s70, 144384
buffer_load_dwordx4 v5, s[4:7], s72 offen offset:3072 lds
v_mfma_f32_16x16x32_bf16 v[136:139], v[64:67], v[112:115], v[136:139]
ds_read_b64_tr_b16 v[92:93], v11 offset:24576
v_mfma_f32_16x16x32_bf16 v[136:139], v[68:71], v[116:119], v[136:139]
s_lshl_b32 s71, s73, 12
v_mfma_f32_16x16x32_bf16 v[140:143], v[68:71], v[124:127], v[140:143]
s_add_u32 s71, s71, s66
ds_read_b64_tr_b16 v[94:95], v11 offset:25600
v_mfma_f32_16x16x32_bf16 v[140:143], v[64:67], v[120:123], v[140:143]
s_waitcnt lgkmcnt(8)
v_mfma_f32_16x16x32_bf16 v[156:159], v[72:75], v[120:123], v[156:159]
s_add_u32 m0, s64, 0
ds_read_b64_tr_b16 v[64:65], v12 offset:16384
v_mfma_f32_16x16x32_bf16 v[156:159], v[76:79], v[124:127], v[156:159]
s_add_u32 s72, s71, 0
buffer_load_dwordx4 v6, s[12:15], s72 offen lds
v_mfma_f32_16x16x32_bf16 v[152:155], v[76:79], v[116:119], v[152:155]
ds_read_b64_tr_b16 v[66:67], v12 offset:17408
v_mfma_f32_16x16x32_bf16 v[152:155], v[72:75], v[112:115], v[152:155]
v_mfma_f32_16x16x32_bf16 v[148:151], v[72:75], v[104:107], v[148:151]
ds_read_b64_tr_b16 v[68:69], v12 offset:24576
v_mfma_f32_16x16x32_bf16 v[148:151], v[76:79], v[108:111], v[148:151]
ds_read_b64_tr_b16 v[70:71], v12 offset:25600
v_mfma_f32_16x16x32_bf16 v[144:147], v[76:79], v[100:103], v[144:147]
s_add_u32 s72, s71, 31744
buffer_load_dwordx4 v6, s[12:15], s72 offen offset:1024 lds
v_mfma_f32_16x16x32_bf16 v[144:147], v[72:75], v[96:99], v[144:147]
s_waitcnt lgkmcnt(8)
v_mfma_f32_16x16x32_bf16 v[160:163], v[80:83], v[96:99], v[160:163]
ds_read_b64_tr_b16 v[72:73], v13 offset:16384
v_mfma_f32_16x16x32_bf16 v[160:163], v[84:87], v[100:103], v[160:163]
ds_read_b64_tr_b16 v[74:75], v13 offset:17408
v_mfma_f32_16x16x32_bf16 v[164:167], v[84:87], v[108:111], v[164:167]
v_mfma_f32_16x16x32_bf16 v[164:167], v[80:83], v[104:107], v[164:167]
s_add_u32 s72, s71, 63488
buffer_load_dwordx4 v7, s[12:15], s72 offen offset:2048 lds
v_mfma_f32_16x16x32_bf16 v[168:171], v[80:83], v[112:115], v[168:171]
s_waitcnt vmcnt(16)
ds_read_b64_tr_b16 v[76:77], v13 offset:24576
v_mfma_f32_16x16x32_bf16 v[168:171], v[84:87], v[116:119], v[168:171]
ds_read_b128 v[32:35], v18 offset:32768
v_mfma_f32_16x16x32_bf16 v[172:175], v[84:87], v[124:127], v[172:175]
ds_read_b64_tr_b16 v[78:79], v13 offset:25600
v_mfma_f32_16x16x32_bf16 v[172:175], v[80:83], v[120:123], v[172:175]
s_waitcnt lgkmcnt(9)
ds_read_b128 v[36:39], v19 offset:32768
v_mfma_f32_16x16x32_bf16 v[188:191], v[88:91], v[120:123], v[188:191]
s_add_u32 s72, s71, 95232
buffer_load_dwordx4 v7, s[12:15], s72 offen offset:3072 lds
v_mfma_f32_16x16x32_bf16 v[188:191], v[92:95], v[124:127], v[188:191]
v_accvgpr_write_b32 a0, -1
v_accvgpr_write_b32 a1, -1
v_mfma_f32_16x16x32_bf16 v[184:187], v[92:95], v[116:119], v[184:187]
v_accvgpr_write_b32 a2, -1
v_accvgpr_write_b32 a3, -1
v_mfma_f32_16x16x32_bf16 v[184:187], v[88:91], v[112:115], v[184:187]
s_add_u32 s80, s93, 0x3a00000
ds_read_b64_tr_b16 v[80:81], v14 offset:16384
v_mfma_f32_16x16x32_bf16 v[180:183], v[88:91], v[104:107], v[180:183]
ds_read_b64_tr_b16 v[82:83], v14 offset:17408
v_mfma_f32_16x16x32_bf16 v[180:183], v[92:95], v[108:111], v[180:183]
ds_read_b64_tr_b16 v[84:85], v14 offset:24576
v_mfma_f32_16x16x32_bf16 v[176:179], v[92:95], v[100:103], v[176:179]
ds_read_b64_tr_b16 v[86:87], v14 offset:25600
v_mfma_f32_16x16x32_bf16 v[176:179], v[88:91], v[96:99], v[176:179]
s_waitcnt lgkmcnt(10)
ds_read_b128 v[40:43], v18 offset:34816
v_mfma_f32_16x16x32_bf16 v[192:195], v[64:67], v[96:99], v[192:195]
s_waitcnt vmcnt(10)
v_cmp_gt_u32 vcc, 1, v3
s_cbranch_vccnz Lspin4
Lback5:
v_mfma_f32_16x16x32_bf16 v[192:195], v[68:71], v[100:103], v[192:195]
s_add_u32 m0, s64, 49152
ds_read_b64_tr_b16 v[88:89], v15 offset:16384
ds_read_b64_tr_b16 v[90:91], v15 offset:17408
v_mfma_f32_16x16x32_bf16 v[196:199], v[68:71], v[108:111], v[196:199]
s_add_u32 s72, s81, 16384
buffer_load_dwordx4 v1, s[44:47], s72 offen sc1 lds
v_mfma_f32_16x16x32_bf16 v[196:199], v[64:67], v[104:107], v[196:199]
ds_read_b64_tr_b16 v[92:93], v15 offset:24576
v_mfma_f32_16x16x32_bf16 v[200:203], v[64:67], v[112:115], v[200:203]
ds_read_b64_tr_b16 v[94:95], v15 offset:25600
v_mfma_f32_16x16x32_bf16 v[200:203], v[68:71], v[116:119], v[200:203]
buffer_load_dwordx4 v1, s[44:47], s72 offen offset:1024 sc1 lds
v_mfma_f32_16x16x32_bf16 v[204:207], v[68:71], v[124:127], v[204:207]
ds_read_b128 v[44:47], v19 offset:34816
v_mfma_f32_16x16x32_bf16 v[204:207], v[64:67], v[120:123], v[204:207]
s_waitcnt lgkmcnt(11)
v_mfma_f32_16x16x32_bf16 v[220:223], v[72:75], v[120:123], v[220:223]
ds_read_b128 v[48:51], v18 offset:36864
v_mfma_f32_16x16x32_bf16 v[220:223], v[76:79], v[124:127], v[220:223]
ds_read_b128 v[52:55], v19 offset:36864
v_mfma_f32_16x16x32_bf16 v[216:219], v[76:79], v[116:119], v[216:219]
s_waitcnt vmcnt(15) lgkmcnt(3)
buffer_load_dwordx4 v1, s[44:47], s72 offen offset:2048 sc1 lds
v_mfma_f32_16x16x32_bf16 v[216:219], v[72:75], v[112:115], v[216:219]
s_barrier
ds_read_b128 v[56:59], v18 offset:38912
v_mfma_f32_16x16x32_bf16 v[212:215], v[72:75], v[104:107], v[212:215]
ds_read_b64_tr_b16 v[64:65], v8 offset:32768
ds_read_b64_tr_b16 v[66:67], v8 offset:33792
v_mfma_f32_16x16x32_bf16 v[212:215], v[76:79], v[108:111], v[212:215]
ds_read_b64_tr_b16 v[68:69], v8 offset:40960
v_mfma_f32_16x16x32_bf16 v[208:211], v[76:79], v[100:103], v[208:211]
ds_read_b64_tr_b16 v[70:71], v8 offset:41984
v_mfma_f32_16x16x32_bf16 v[208:211], v[72:75], v[96:99], v[208:211]
buffer_load_dwordx4 v1, s[44:47], s72 offen offset:3072 sc1 lds
v_mfma_f32_16x16x32_bf16 v[224:227], v[80:83], v[96:99], v[224:227]
s_add_u32 s81, s81, 0x8000
ds_read_b64_tr_b16 v[72:73], v9 offset:32768
v_mfma_f32_16x16x32_bf16 v[224:227], v[84:87], v[100:103], v[224:227]
s_add_u32 m0, s64, 81920
ds_read_b64_tr_b16 v[74:75], v9 offset:33792
v_mfma_f32_16x16x32_bf16 v[228:231], v[84:87], v[108:111], v[228:231]
s_add_u32 s72, s81, 16384
buffer_load_dwordx4 v1, s[44:47], s72 offen sc1 lds
v_mfma_f32_16x16x32_bf16 v[228:231], v[80:83], v[104:107], v[228:231]
ds_read_b128 v[60:63], v19 offset:38912
v_mfma_f32_16x16x32_bf16 v[232:235], v[80:83], v[112:115], v[232:235]
buffer_load_dwordx4 v1, s[44:47], s72 offen offset:1024 sc1 lds
v_mfma_f32_16x16x32_bf16 v[232:235], v[84:87], v[116:119], v[232:235]
ds_read_b64_tr_b16 v[76:77], v9 offset:40960
v_mfma_f32_16x16x32_bf16 v[236:239], v[84:87], v[124:127], v[236:239]
ds_read_b64_tr_b16 v[78:79], v9 offset:41984
v_mfma_f32_16x16x32_bf16 v[236:239], v[80:83], v[120:123], v[236:239]
v_mfma_f32_16x16x32_bf16 v[252:255], v[88:91], v[120:123], v[252:255]
ds_read_b64_tr_b16 v[80:81], v10 offset:32768
v_mfma_f32_16x16x32_bf16 v[252:255], v[92:95], v[124:127], v[252:255]
buffer_load_dwordx4 v1, s[44:47], s72 offen offset:2048 sc1 lds
v_mfma_f32_16x16x32_bf16 v[248:251], v[92:95], v[116:119], v[248:251]
ds_read_b64_tr_b16 v[82:83], v10 offset:33792
v_mfma_f32_16x16x32_bf16 v[248:251], v[88:91], v[112:115], v[248:251]
v_mfma_f32_16x16x32_bf16 v[244:247], v[88:91], v[104:107], v[244:247]
ds_read_b64_tr_b16 v[84:85], v10 offset:40960
v_mfma_f32_16x16x32_bf16 v[244:247], v[92:95], v[108:111], v[244:247]
buffer_load_dwordx4 v1, s[44:47], s72 offen offset:3072 sc1 lds
v_mfma_f32_16x16x32_bf16 v[240:243], v[92:95], v[100:103], v[240:243]
ds_read_b64_tr_b16 v[86:87], v10 offset:41984
v_mfma_f32_16x16x32_bf16 v[240:243], v[88:91], v[96:99], v[240:243]
s_waitcnt lgkmcnt(6)
v_mfma_f32_16x16x32_bf16 v[128:131], v[64:67], v[32:35], v[128:131]
ds_read_b64_tr_b16 v[88:89], v11 offset:32768
v_mfma_f32_16x16x32_bf16 v[128:131], v[68:71], v[36:39], v[128:131]
ds_read_b64_tr_b16 v[90:91], v11 offset:33792
v_mfma_f32_16x16x32_bf16 v[132:135], v[68:71], v[44:47], v[132:135]
s_add_u32 m0, s64, 65536
v_mfma_f32_16x16x32_bf16 v[132:135], v[64:67], v[40:43], v[132:135]
s_add_u32 s72, s81, 0
buffer_load_dwordx4 v1, s[44:47], s72 offen sc1 lds
v_mfma_f32_16x16x32_bf16 v[136:139], v[64:67], v[48:51], v[136:139]
ds_read_b64_tr_b16 v[92:93], v11 offset:40960
v_mfma_f32_16x16x32_bf16 v[136:139], v[68:71], v[52:55], v[136:139]
ds_read_b64_tr_b16 v[94:95], v11 offset:41984
v_mfma_f32_16x16x32_bf16 v[140:143], v[68:71], v[60:63], v[140:143]
v_mfma_f32_16x16x32_bf16 v[140:143], v[64:67], v[56:59], v[140:143]
s_waitcnt lgkmcnt(8)
buffer_load_dwordx4 v1, s[44:47], s72 offen offset:1024 sc1 lds
v_mfma_f32_16x16x32_bf16 v[156:159], v[72:75], v[56:59], v[156:159]
ds_read_b64_tr_b16 v[64:65], v12 offset:32768
v_mfma_f32_16x16x32_bf16 v[156:159], v[76:79], v[60:63], v[156:159]
ds_read_b64_tr_b16 v[66:67], v12 offset:33792
v_mfma_f32_16x16x32_bf16 v[152:155], v[76:79], v[52:55], v[152:155]
v_mfma_f32_16x16x32_bf16 v[152:155], v[72:75], v[48:51], v[152:155]
buffer_load_dwordx4 v1, s[44:47], s72 offen offset:2048 sc1 lds
v_mfma_f32_16x16x32_bf16 v[148:151], v[72:75], v[40:43], v[148:151]
ds_read_b64_tr_b16 v[68:69], v12 offset:40960
v_mfma_f32_16x16x32_bf16 v[148:151], v[76:79], v[44:47], v[148:151]
v_mfma_f32_16x16x32_bf16 v[144:147], v[76:79], v[36:39], v[144:147]
ds_read_b64_tr_b16 v[70:71], v12 offset:41984
v_mfma_f32_16x16x32_bf16 v[144:147], v[72:75], v[32:35], v[144:147]
s_waitcnt lgkmcnt(8)
v_mfma_f32_16x16x32_bf16 v[160:163], v[80:83], v[32:35], v[160:163]
buffer_load_dwordx4 v1, s[44:47], s72 offen offset:3072 sc1 lds
v_mfma_f32_16x16x32_bf16 v[160:163], v[84:87], v[36:39], v[160:163]
ds_read_b64_tr_b16 v[72:73], v13 offset:32768
v_mfma_f32_16x16x32_bf16 v[164:167], v[84:87], v[44:47], v[164:167]
ds_read_b64_tr_b16 v[74:75], v13 offset:33792
v_mfma_f32_16x16x32_bf16 v[164:167], v[80:83], v[40:43], v[164:167]
v_mfma_f32_16x16x32_bf16 v[168:171], v[80:83], v[48:51], v[168:171]
s_waitcnt vmcnt(16)
ds_read_b64_tr_b16 v[76:77], v13 offset:40960
v_mfma_f32_16x16x32_bf16 v[168:171], v[84:87], v[52:55], v[168:171]
ds_read_b128 v[96:99], v16 offset:0
v_mfma_f32_16x16x32_bf16 v[172:175], v[84:87], v[60:63], v[172:175]
ds_read_b64_tr_b16 v[78:79], v13 offset:41984
v_mfma_f32_16x16x32_bf16 v[172:175], v[80:83], v[56:59], v[172:175]
s_waitcnt lgkmcnt(9)
v_mfma_f32_16x16x32_bf16 v[188:191], v[88:91], v[56:59], v[188:191]
ds_read_b64_tr_b16 v[80:81], v14 offset:32768
v_mfma_f32_16x16x32_bf16 v[188:191], v[92:95], v[60:63], v[188:191]
ds_read_b128 v[100:103], v17 offset:0
v_mfma_f32_16x16x32_bf16 v[184:187], v[92:95], v[52:55], v[184:187]
ds_read_b64_tr_b16 v[82:83], v14 offset:33792
v_mfma_f32_16x16x32_bf16 v[184:187], v[88:91], v[48:51], v[184:187]
v_mfma_f32_16x16x32_bf16 v[180:183], v[88:91], v[40:43], v[180:183]
ds_read_b64_tr_b16 v[84:85], v14 offset:40960
v_mfma_f32_16x16x32_bf16 v[180:183], v[92:95], v[44:47], v[180:183]
ds_read_b128 v[104:107], v16 offset:2048
v_mfma_f32_16x16x32_bf16 v[176:179], v[92:95], v[36:39], v[176:179]
ds_read_b64_tr_b16 v[86:87], v14 offset:41984
v_mfma_f32_16x16x32_bf16 v[176:179], v[88:91], v[32:35], v[176:179]
s_waitcnt lgkmcnt(11)
v_mfma_f32_16x16x32_bf16 v[192:195], v[64:67], v[32:35], v[192:195]
ds_read_b64_tr_b16 v[88:89], v15 offset:32768
v_mfma_f32_16x16x32_bf16 v[192:195], v[68:71], v[36:39], v[192:195]
ds_read_b64_tr_b16 v[90:91], v15 offset:33792
v_mfma_f32_16x16x32_bf16 v[196:199], v[68:71], v[44:47], v[196:199]
ds_read_b128 v[108:111], v17 offset:2048
v_mfma_f32_16x16x32_bf16 v[196:199], v[64:67], v[40:43], v[196:199]
ds_read_b64_tr_b16 v[92:93], v15 offset:40960
v_mfma_f32_16x16x32_bf16 v[200:203], v[64:67], v[48:51], v[200:203]
ds_read_b64_tr_b16 v[94:95], v15 offset:41984
v_mfma_f32_16x16x32_bf16 v[200:203], v[68:71], v[52:55], v[200:203]
v_mfma_f32_16x16x32_bf16 v[204:207], v[68:71], v[60:63], v[204:207]
ds_read_b128 v[112:115], v16 offset:4096
v_mfma_f32_16x16x32_bf16 v[204:207], v[64:67], v[56:59], v[204:207]
s_waitcnt lgkmcnt(12)
v_mfma_f32_16x16x32_bf16 v[220:223], v[72:75], v[56:59], v[220:223]
ds_read_b128 v[116:119], v17 offset:4096
v_mfma_f32_16x16x32_bf16 v[220:223], v[76:79], v[60:63], v[220:223]
v_mfma_f32_16x16x32_bf16 v[216:219], v[76:79], v[52:55], v[216:219]
s_waitcnt vmcnt(12) lgkmcnt(2)
ds_read_b128 v[120:123], v16 offset:6144
v_mfma_f32_16x16x32_bf16 v[216:219], v[72:75], v[48:51], v[216:219]
s_barrier
v_mfma_f32_16x16x32_bf16 v[212:215], v[72:75], v[40:43], v[212:215]
s_add_u32 s81, s81, 0x8000
ds_read_b64_tr_b16 v[64:65], v8 offset:0
ds_read_b64_tr_b16 v[66:67], v8 offset:1024
v_mfma_f32_16x16x32_bf16 v[212:215], v[76:79], v[44:47], v[212:215]
s_add_u32 m0, s64, 114688
ds_read_b64_tr_b16 v[68:69], v8 offset:8192
v_mfma_f32_16x16x32_bf16 v[208:211], v[76:79], v[36:39], v[208:211]
s_add_u32 s72, s81, 16384
buffer_load_dwordx4 v1, s[44:47], s72 offen sc1 lds
v_mfma_f32_16x16x32_bf16 v[208:211], v[72:75], v[32:35], v[208:211]
ds_read_b64_tr_b16 v[70:71], v8 offset:9216
v_mfma_f32_16x16x32_bf16 v[224:227], v[80:83], v[32:35], v[224:227]
buffer_load_dwordx4 v1, s[44:47], s72 offen offset:1024 sc1 lds
v_mfma_f32_16x16x32_bf16 v[224:227], v[84:87], v[36:39], v[224:227]
ds_read_b64_tr_b16 v[72:73], v9 offset:0
v_mfma_f32_16x16x32_bf16 v[228:231], v[84:87], v[44:47], v[228:231]
ds_read_b64_tr_b16 v[74:75], v9 offset:1024
v_mfma_f32_16x16x32_bf16 v[228:231], v[80:83], v[40:43], v[228:231]
ds_read_b128 v[124:127], v17 offset:6144
v_mfma_f32_16x16x32_bf16 v[232:235], v[80:83], v[48:51], v[232:235]
ds_read_b64_tr_b16 v[76:77], v9 offset:8192
v_mfma_f32_16x16x32_bf16 v[232:235], v[84:87], v[52:55], v[232:235]
buffer_store_dwordx4 a[0:3], v1, s[44:47], s80 offen sc1
v_mfma_f32_16x16x32_bf16 v[236:239], v[84:87], v[60:63], v[236:239]
ds_read_b64_tr_b16 v[78:79], v9 offset:9216
v_mfma_f32_16x16x32_bf16 v[236:239], v[80:83], v[56:59], v[236:239]
v_mfma_f32_16x16x32_bf16 v[252:255], v[88:91], v[56:59], v[252:255]
ds_read_b64_tr_b16 v[80:81], v10 offset:0
v_mfma_f32_16x16x32_bf16 v[252:255], v[92:95], v[60:63], v[252:255]
ds_read_b64_tr_b16 v[82:83], v10 offset:1024
v_mfma_f32_16x16x32_bf16 v[248:251], v[92:95], v[52:55], v[248:251]
buffer_load_dwordx4 v1, s[44:47], s72 offen offset:2048 sc1 lds
v_mfma_f32_16x16x32_bf16 v[248:251], v[88:91], v[48:51], v[248:251]
v_mfma_f32_16x16x32_bf16 v[244:247], v[88:91], v[40:43], v[244:247]
ds_read_b64_tr_b16 v[84:85], v10 offset:8192
v_mfma_f32_16x16x32_bf16 v[244:247], v[92:95], v[44:47], v[244:247]
ds_read_b64_tr_b16 v[86:87], v10 offset:9216
v_mfma_f32_16x16x32_bf16 v[240:243], v[92:95], v[36:39], v[240:243]
buffer_load_dwordx4 v1, s[44:47], s72 offen offset:3072 sc1 lds
v_mfma_f32_16x16x32_bf16 v[240:243], v[88:91], v[32:35], v[240:243]
s_waitcnt lgkmcnt(6)
v_mfma_f32_16x16x32_bf16 v[128:131], v[64:67], v[96:99], v[128:131]
ds_read_b64_tr_b16 v[88:89], v11 offset:0
v_mfma_f32_16x16x32_bf16 v[128:131], v[68:71], v[100:103], v[128:131]
ds_read_b64_tr_b16 v[90:91], v11 offset:1024
v_mfma_f32_16x16x32_bf16 v[132:135], v[68:71], v[108:111], v[132:135]
v_mfma_f32_16x16x32_bf16 v[132:135], v[64:67], v[104:107], v[132:135]
buffer_store_dwordx4 a[0:3], v1, s[44:47], s80 offen offset:1024 sc1
v_mfma_f32_16x16x32_bf16 v[136:139], v[64:67], v[112:115], v[136:139]
ds_read_b64_tr_b16 v[92:93], v11 offset:8192
v_mfma_f32_16x16x32_bf16 v[136:139], v[68:71], v[116:119], v[136:139]
v_mfma_f32_16x16x32_bf16 v[140:143], v[68:71], v[124:127], v[140:143]
ds_read_b64_tr_b16 v[94:95], v11 offset:9216
v_mfma_f32_16x16x32_bf16 v[140:143], v[64:67], v[120:123], v[140:143]
s_waitcnt lgkmcnt(8)
v_mfma_f32_16x16x32_bf16 v[156:159], v[72:75], v[120:123], v[156:159]
s_add_u32 m0, s64, 98304
ds_read_b64_tr_b16 v[64:65], v12 offset:0
v_mfma_f32_16x16x32_bf16 v[156:159], v[76:79], v[124:127], v[156:159]
s_add_u32 s72, s81, 0
buffer_load_dwordx4 v1, s[44:47], s72 offen sc1 lds
v_mfma_f32_16x16x32_bf16 v[152:155], v[76:79], v[116:119], v[152:155]
ds_read_b64_tr_b16 v[66:67], v12 offset:1024
v_mfma_f32_16x16x32_bf16 v[152:155], v[72:75], v[112:115], v[152:155]
v_mfma_f32_16x16x32_bf16 v[148:151], v[72:75], v[104:107], v[148:151]
buffer_load_dwordx4 v1, s[44:47], s72 offen offset:1024 sc1 lds
v_mfma_f32_16x16x32_bf16 v[148:151], v[76:79], v[108:111], v[148:151]
ds_read_b64_tr_b16 v[68:69], v12 offset:8192
v_mfma_f32_16x16x32_bf16 v[144:147], v[76:79], v[100:103], v[144:147]
ds_read_b64_tr_b16 v[70:71], v12 offset:9216
v_mfma_f32_16x16x32_bf16 v[144:147], v[72:75], v[96:99], v[144:147]
s_waitcnt lgkmcnt(8)
v_mfma_f32_16x16x32_bf16 v[160:163], v[80:83], v[96:99], v[160:163]
ds_read_b64_tr_b16 v[72:73], v13 offset:0
v_mfma_f32_16x16x32_bf16 v[160:163], v[84:87], v[100:103], v[160:163]
buffer_store_dwordx4 a[0:3], v1, s[44:47], s80 offen offset:2048 sc1
v_mfma_f32_16x16x32_bf16 v[164:167], v[84:87], v[108:111], v[164:167]
ds_read_b64_tr_b16 v[74:75], v13 offset:1024
v_mfma_f32_16x16x32_bf16 v[164:167], v[80:83], v[104:107], v[164:167]
v_mfma_f32_16x16x32_bf16 v[168:171], v[80:83], v[112:115], v[168:171]
ds_read_b64_tr_b16 v[76:77], v13 offset:8192
v_cvt_pk_bf16_f32 v48, v136, v137
v_mfma_f32_16x16x32_bf16 v[168:171], v[84:87], v[116:119], v[168:171]
ds_read_b64_tr_b16 v[78:79], v13 offset:9216
v_cvt_pk_bf16_f32 v49, v138, v139
v_mfma_f32_16x16x32_bf16 v[172:175], v[84:87], v[124:127], v[172:175]
buffer_load_dwordx4 v1, s[44:47], s72 offen offset:2048 sc1 lds
v_mfma_f32_16x16x32_bf16 v[172:175], v[80:83], v[120:123], v[172:175]
s_waitcnt lgkmcnt(8)
v_cvt_pk_bf16_f32 v50, v152, v153
v_cvt_pk_bf16_f32 v51, v154, v155
v_mfma_f32_16x16x32_bf16 v[188:191], v[88:91], v[120:123], v[188:191]
v_add_u32 v2, 0x8000, v1
v_cvt_pk_bf16_f32 v32, v132, v133
v_mfma_f32_16x16x32_bf16 v[188:191], v[92:95], v[124:127], v[188:191]
ds_read_b64_tr_b16 v[80:81], v14 offset:0
v_cvt_pk_bf16_f32 v33, v134, v135
v_mfma_f32_16x16x32_bf16 v[184:187], v[92:95], v[116:119], v[184:187]
buffer_load_dwordx4 v1, s[44:47], s72 offen offset:3072 sc1 lds
v_mfma_f32_16x16x32_bf16 v[184:187], v[88:91], v[112:115], v[184:187]
ds_read_b64_tr_b16 v[82:83], v14 offset:1024
v_cvt_pk_bf16_f32 v34, v148, v149
v_mfma_f32_16x16x32_bf16 v[180:183], v[88:91], v[104:107], v[180:183]
ds_read_b64_tr_b16 v[84:85], v14 offset:8192
v_cvt_pk_bf16_f32 v35, v150, v151
v_mfma_f32_16x16x32_bf16 v[180:183], v[92:95], v[108:111], v[180:183]
ds_read_b64_tr_b16 v[86:87], v14 offset:9216
v_cvt_pk_bf16_f32 v16, v128, v129
v_mfma_f32_16x16x32_bf16 v[176:179], v[92:95], v[100:103], v[176:179]
v_cvt_pk_bf16_f32 v17, v130, v131
v_cvt_pk_bf16_f32 v18, v144, v145
v_mfma_f32_16x16x32_bf16 v[176:179], v[88:91], v[96:99], v[176:179]
s_waitcnt lgkmcnt(8)
buffer_store_dwordx4 a[0:3], v1, s[44:47], s80 offen offset:3072 sc1
v_mfma_f32_16x16x32_bf16 v[192:195], v[64:67], v[96:99], v[192:195]
ds_read_b64_tr_b16 v[88:89], v15 offset:0
v_cvt_pk_bf16_f32 v19, v146, v147
v_mfma_f32_16x16x32_bf16 v[192:195], v[68:71], v[100:103], v[192:195]
ds_read_b64_tr_b16 v[90:91], v15 offset:1024
v_mfma_f32_16x16x32_bf16 v[196:199], v[68:71], v[108:111], v[196:199]
ds_read_b64_tr_b16 v[92:93], v15 offset:8192
v_mfma_f32_16x16x32_bf16 v[196:199], v[64:67], v[104:107], v[196:199]
ds_read_b64_tr_b16 v[94:95], v15 offset:9216
v_mfma_f32_16x16x32_bf16 v[200:203], v[64:67], v[112:115], v[200:203]
v_lshrrev_b32 v3, 1, v0
v_lshlrev_b32 v3, 7, v3
v_mfma_f32_16x16x32_bf16 v[200:203], v[68:71], v[116:119], v[200:203]
buffer_load_dword v4, v3, s[36:39], s93 offen
v_mfma_f32_16x16x32_bf16 v[204:207], v[68:71], v[124:127], v[204:207]
v_cvt_pk_bf16_f32 v52, v168, v169
v_cvt_pk_bf16_f32 v53, v170, v171
v_mfma_f32_16x16x32_bf16 v[204:207], v[64:67], v[120:123], v[204:207]
s_waitcnt lgkmcnt(8)
v_cvt_pk_bf16_f32 v54, v184, v185
v_cvt_pk_bf16_f32 v55, v186, v187
v_mfma_f32_16x16x32_bf16 v[220:223], v[72:75], v[120:123], v[220:223]
v_cvt_pk_bf16_f32 v36, v164, v165
v_cvt_pk_bf16_f32 v37, v166, v167
v_mfma_f32_16x16x32_bf16 v[220:223], v[76:79], v[124:127], v[220:223]
v_cvt_pk_bf16_f32 v38, v180, v181
v_cvt_pk_bf16_f32 v39, v182, v183
v_mfma_f32_16x16x32_bf16 v[216:219], v[76:79], v[116:119], v[216:219]
s_waitcnt vmcnt(21) lgkmcnt(0)
v_cvt_pk_bf16_f32 v20, v160, v161
v_cvt_pk_bf16_f32 v21, v162, v163
v_mfma_f32_16x16x32_bf16 v[216:219], v[72:75], v[112:115], v[216:219]
s_barrier
v_cvt_pk_bf16_f32 v22, v176, v177
v_cvt_pk_bf16_f32 v23, v178, v179
v_mfma_f32_16x16x32_bf16 v[212:215], v[72:75], v[104:107], v[212:215]
ds_read_b128 a[128:131], v2 offset:16384
v_cvt_pk_bf16_f32 v64, v140, v141
v_mfma_f32_16x16x32_bf16 v[212:215], v[76:79], v[108:111], v[212:215]
v_cvt_pk_bf16_f32 v65, v142, v143
v_cvt_pk_bf16_f32 v66, v156, v157
v_mfma_f32_16x16x32_bf16 v[208:211], v[76:79], v[100:103], v[208:211]
ds_read_b128 a[132:135], v2 offset:17408
v_cvt_pk_bf16_f32 v67, v158, v159
v_mfma_f32_16x16x32_bf16 v[208:211], v[72:75], v[96:99], v[208:211]
v_cvt_pk_bf16_f32 v68, v172, v173
v_cvt_pk_bf16_f32 v69, v174, v175
v_mfma_f32_16x16x32_bf16 v[224:227], v[80:83], v[96:99], v[224:227]
ds_read_b128 a[136:139], v2 offset:18432
v_cvt_pk_bf16_f32 v70, v188, v189
v_mfma_f32_16x16x32_bf16 v[224:227], v[84:87], v[100:103], v[224:227]
v_cvt_pk_bf16_f32 v71, v190, v191
v_mfma_f32_16x16x32_bf16 v[228:231], v[84:87], v[108:111], v[228:231]
ds_read_b128 a[140:143], v2 offset:19456
v_mfma_f32_16x16x32_bf16 v[228:231], v[80:83], v[104:107], v[228:231]
v_mfma_f32_16x16x32_bf16 v[232:235], v[80:83], v[112:115], v[232:235]
ds_read_b128 a[144:147], v2 offset:20480
v_cvt_pk_bf16_f32 v72, v204, v205
v_mfma_f32_16x16x32_bf16 v[232:235], v[84:87], v[116:119], v[232:235]
v_cvt_pk_bf16_f32 v73, v206, v207
v_cvt_pk_bf16_f32 v74, v220, v221
v_mfma_f32_16x16x32_bf16 v[236:239], v[84:87], v[124:127], v[236:239]
ds_read_b128 a[148:151], v2 offset:21504
v_cvt_pk_bf16_f32 v75, v222, v223
v_mfma_f32_16x16x32_bf16 v[236:239], v[80:83], v[120:123], v[236:239]
v_cvt_pk_bf16_f32 v56, v200, v201
v_cvt_pk_bf16_f32 v57, v202, v203
v_mfma_f32_16x16x32_bf16 v[252:255], v[88:91], v[120:123], v[252:255]
ds_read_b128 a[152:155], v2 offset:22528
v_cvt_pk_bf16_f32 v58, v216, v217
v_mfma_f32_16x16x32_bf16 v[252:255], v[92:95], v[124:127], v[252:255]
v_cvt_pk_bf16_f32 v59, v218, v219
v_cvt_pk_bf16_f32 v40, v196, v197
v_mfma_f32_16x16x32_bf16 v[248:251], v[92:95], v[116:119], v[248:251]
ds_read_b128 a[156:159], v2 offset:23552
v_cvt_pk_bf16_f32 v41, v198, v199
v_mfma_f32_16x16x32_bf16 v[248:251], v[88:91], v[112:115], v[248:251]
v_cvt_pk_bf16_f32 v42, v212, v213
v_cvt_pk_bf16_f32 v43, v214, v215
v_mfma_f32_16x16x32_bf16 v[244:247], v[88:91], v[104:107], v[244:247]
v_cvt_pk_bf16_f32 v24, v192, v193
v_cvt_pk_bf16_f32 v25, v194, v195
v_mfma_f32_16x16x32_bf16 v[244:247], v[92:95], v[108:111], v[244:247]
v_cvt_pk_bf16_f32 v26, v208, v209
v_cvt_pk_bf16_f32 v27, v210, v211
v_mfma_f32_16x16x32_bf16 v[240:243], v[92:95], v[100:103], v[240:243]
v_mfma_f32_16x16x32_bf16 v[240:243], v[88:91], v[96:99], v[240:243]
v_cvt_pk_bf16_f32 v76, v236, v237
v_cvt_pk_bf16_f32 v77, v238, v239
v_cvt_pk_bf16_f32 v78, v252, v253
v_cvt_pk_bf16_f32 v79, v254, v255
v_cvt_pk_bf16_f32 v60, v232, v233
v_cvt_pk_bf16_f32 v61, v234, v235
v_cvt_pk_bf16_f32 v62, v248, v249
v_cvt_pk_bf16_f32 v63, v250, v251
v_cvt_pk_bf16_f32 v44, v228, v229
v_cvt_pk_bf16_f32 v45, v230, v231
v_cvt_pk_bf16_f32 v46, v244, v245
v_cvt_pk_bf16_f32 v47, v246, v247
v_cvt_pk_bf16_f32 v28, v224, v225
v_cvt_pk_bf16_f32 v29, v226, v227
v_cvt_pk_bf16_f32 v30, v240, v241
v_cvt_pk_bf16_f32 v31, v242, v243
v_mov_b32 v124, 0xff800000
v_mov_b32 v125, 0xff800000
v_mov_b32 v126, 0xff800000
v_mov_b32 v127, 0xff800000
s_lshl_b32 s84, s60, 2
s_add_u32 s84, s84, s58
s_mov_b32 s86, 0
s_lshr_b32 s52, s66, 8
s_and_b32 s52, s52, 31
s_add_u32 s61, s65, s60
s_and_b32 s73, s60, 1
s_lshl_b32 s73, s73, 16
s_add_u32 s77, s73, s64
s_xor_b32 s73, s73, 0x10000
s_mov_b32 s92, s73
s_mul_i32 s62, s58, 4608
s_add_u32 s62, s62, 143104
s_add_u32 s73, s73, 49920
s_cmp_eq_u32 s58, 0
s_cselect_b32 s62, s73, s62
Lattn:
s_mov_b32 s82, 0x10000
s_waitcnt lgkmcnt(0)
v_mfma_f32_16x16x32_bf16 v[136:139], a[128:131], v[48:51], 0
ds_read_b128 a[160:163], v2 offset:24576
v_lshrrev_b32 v240, 4, v0
v_mfma_f32_16x16x32_bf16 v[136:139], a[132:135], v[52:55], v[136:139]
ds_read_b128 a[164:167], v2 offset:25600
v_and_b32 v241, 15, v0
v_mfma_f32_16x16x32_bf16 v[136:139], a[136:139], v[56:59], v[136:139]
ds_read_b128 a[168:171], v2 offset:26624
v_lshlrev_b32 v240, 2, v240
v_mfma_f32_16x16x32_bf16 v[136:139], a[140:143], v[60:63], v[136:139]
ds_read_b128 a[172:175], v2 offset:27648
v_sub_u32 v240, v241, v240
v_mfma_f32_16x16x32_bf16 v[140:143], a[140:143], v[76:79], 0
ds_read_b128 a[176:179], v2 offset:28672
v_mov_b32 v112, 0xff800000
v_mfma_f32_16x16x32_bf16 v[140:143], a[136:139], v[72:75], v[140:143]
ds_read_b128 a[180:183], v2 offset:29696
v_mov_b32 v113, 0xff800000
v_mfma_f32_16x16x32_bf16 v[140:143], a[132:135], v[68:71], v[140:143]
ds_read_b128 a[184:187], v2 offset:30720
v_mov_b32 v114, 0xff800000
v_mfma_f32_16x16x32_bf16 v[140:143], a[128:131], v[64:67], v[140:143]
ds_read_b128 a[188:191], v2 offset:31744
v_mov_b32 v115, 0xff800000
v_mfma_f32_16x16x32_bf16 v[156:159], a[144:147], v[64:67], 0
v_cmp_gt_i32 vcc, 0, v240
v_mov_b32 v120, 0x3f803f80
v_mfma_f32_16x16x32_bf16 v[156:159], a[148:151], v[68:71], v[156:159]
v_cndmask_b32 v116, 0, v112, vcc
v_cmp_gt_i32 vcc, 1, v240
v_mfma_f32_16x16x32_bf16 v[156:159], a[152:155], v[72:75], v[156:159]
v_mov_b32 v121, 0x3f803f80
v_cndmask_b32 v117, 0, v112, vcc
v_mfma_f32_16x16x32_bf16 v[156:159], a[156:159], v[76:79], v[156:159]
v_cmp_gt_i32 vcc, 2, v240
v_mov_b32 v122, 0x3f803f80
v_mfma_f32_16x16x32_bf16 v[152:155], a[156:159], v[60:63], 0
v_cndmask_b32 v118, 0, v112, vcc
v_cmp_gt_i32 vcc, 3, v240
v_mfma_f32_16x16x32_bf16 v[152:155], a[152:155], v[56:59], v[152:155]
v_mov_b32 v123, 0x3f803f80
v_cndmask_b32 v119, 0, v112, vcc
v_mfma_f32_16x16x32_bf16 v[152:155], a[148:151], v[52:55], v[152:155]
v_mov_b32 v228, 0
v_mov_b32 v229, 0
v_mfma_f32_16x16x32_bf16 v[152:155], a[144:147], v[48:51], v[152:155]
v_mov_b32 v230, 0
v_mov_b32 v231, 0
s_cmp_eq_u32 s84, 0
s_cbranch_scc1 Lta7
s_cmp_eq_u32 s84, 1
s_cbranch_scc1 Lnt8
v_mfma_f32_16x16x32_bf16 v[128:131], a[128:131], v[16:19], 0
v_mov_b32 v236, 0
v_mov_b32 v237, 0
v_mfma_f32_16x16x32_bf16 v[144:147], a[144:147], v[16:19], 0
Lstub0:
s_cbranch_execz Lstub4
v_mov_b32 v238, 0
v_mov_b32 v239, 0
s_branch Ljoin9
Lta7:
v_mfma_f32_16x16x32_bf16 v[128:131], a[128:131], v[16:19], v[116:119]
v_mov_b32 v236, 0
v_mov_b32 v237, 0
v_mfma_f32_16x16x32_bf16 v[144:147], a[144:147], v[16:19], v[112:115]
v_mov_b32 v238, 0
v_mov_b32 v239, 0
s_branch Ljoin9
Lnt8:
v_mfma_f32_16x16x32_bf16 v[128:131], a[128:131], v[16:19], 0
v_mov_b32 v236, 0
v_mov_b32 v237, 0
v_mfma_f32_16x16x32_bf16 v[144:147], a[144:147], v[16:19], v[116:119]
v_mov_b32 v238, 0
v_mov_b32 v239, 0
Ljoin9:
v_mfma_f32_16x16x32_bf16 v[128:131], a[132:135], v[20:23], v[128:131]
v_mfma_f32_16x16x32_bf16 v[128:131], a[136:139], v[24:27], v[128:131]
v_mfma_f32_16x16x32_bf16 v[128:131], a[140:143], v[28:31], v[128:131]
v_max3_f32 v240, v136, v137, v126
v_max3_f32 v242, v140, v141, v127
v_mfma_f32_16x16x32_bf16 v[132:135], a[140:143], v[44:47], 0
v_max3_f32 v240, v240, v138, v139
v_max3_f32 v242, v242, v142, v143
v_mfma_f32_16x16x32_bf16 v[132:135], a[136:139], v[40:43], v[132:135]
v_max3_f32 v240, v240, v152, v153
v_max3_f32 v242, v242, v156, v157
v_mfma_f32_16x16x32_bf16 v[132:135], a[132:135], v[36:39], v[132:135]
v_max3_f32 v240, v240, v154, v155
v_max3_f32 v242, v242, v158, v159
v_mfma_f32_16x16x32_bf16 v[132:135], a[128:131], v[32:35], v[132:135]
v_mov_b32 v241, v240
v_mov_b32 v243, v242
v_mfma_f32_16x16x32_bf16 v[148:151], a[144:147], v[32:35], 0
v_permlane16_swap_b32 v240, v241
v_permlane16_swap_b32 v242, v243
v_mfma_f32_16x16x32_bf16 v[148:151], a[148:151], v[36:39], v[148:151]
v_max_f32 v240, v240, v241
v_max_f32 v242, v242, v243
v_mfma_f32_16x16x32_bf16 v[148:151], a[152:155], v[40:43], v[148:151]
v_mov_b32 v241, v240
v_mov_b32 v243, v242
v_mfma_f32_16x16x32_bf16 v[148:151], a[156:159], v[44:47], v[148:151]
v_permlane32_swap_b32 v240, v241
v_permlane32_swap_b32 v242, v243
v_mfma_f32_16x16x32_bf16 v[144:147], a[156:159], v[28:31], v[144:147]
v_max_f32 v240, v240, v241
v_max_f32 v242, v242, v243
v_mfma_f32_16x16x32_bf16 v[144:147], a[152:155], v[24:27], v[144:147]
v_mfma_f32_16x16x32_bf16 v[144:147], a[148:151], v[20:23], v[144:147]
v_sub_f32 v88, 0, v240
v_sub_f32 v89, 0, v240
v_pk_add_f32 v[90:91], v[88:89], 0
v_pk_add_f32 v[104:105], v[116:117], v[88:89]
v_pk_add_f32 v[106:107], v[118:119], v[88:89]
v_pk_add_f32 v[136:137], v[136:137], v[88:89]
v_pk_add_f32 v[138:139], v[138:139], v[88:89]
v_pk_add_f32 v[152:153], v[152:153], v[88:89]
v_pk_add_f32 v[154:155], v[154:155], v[88:89]
v_sub_f32 v92, 0, v242
v_sub_f32 v93, 0, v242
v_pk_add_f32 v[94:95], v[92:93], 0
v_pk_add_f32 v[108:109], v[116:117], v[92:93]
v_pk_add_f32 v[110:111], v[118:119], v[92:93]
v_pk_add_f32 v[140:141], v[140:141], v[92:93]
v_pk_add_f32 v[142:143], v[142:143], v[92:93]
v_pk_add_f32 v[156:157], v[156:157], v[92:93]
v_pk_add_f32 v[158:159], v[158:159], v[92:93]
v_max3_f32 v240, v128, v129, v124
v_max3_f32 v242, v132, v133, v125
v_max3_f32 v240, v240, v130, v131
v_max3_f32 v242, v242, v134, v135
v_max3_f32 v240, v240, v144, v145
v_max3_f32 v242, v242, v148, v149
v_max3_f32 v240, v240, v146, v147
v_max3_f32 v242, v242, v150, v151
v_mov_b32 v241, v240
v_mov_b32 v243, v242
s_nop 0
v_permlane16_swap_b32 v240, v241
v_permlane16_swap_b32 v242, v243
v_max_f32 v240, v240, v241
v_max_f32 v242, v242, v243
v_mov_b32 v241, v240
v_mov_b32 v243, v242
s_nop 0
v_permlane32_swap_b32 v240, v241
v_permlane32_swap_b32 v242, v243
v_max_f32 v240, v240, v241
v_max_f32 v242, v242, v243
v_sub_f32 v80, 0, v240
v_sub_f32 v81, 0, v240
v_pk_add_f32 v[82:83], v[80:81], 0
v_pk_add_f32 v[96:97], v[116:117], v[80:81]
v_pk_add_f32 v[98:99], v[118:119], v[80:81]
v_pk_add_f32 v[128:129], v[128:129], v[80:81]
v_pk_add_f32 v[130:131], v[130:131], v[80:81]
v_pk_add_f32 v[144:145], v[144:145], v[80:81]
v_pk_add_f32 v[146:147], v[146:147], v[80:81]
v_sub_f32 v84, 0, v242
v_sub_f32 v85, 0, v242
v_pk_add_f32 v[86:87], v[84:85], 0
v_pk_add_f32 v[100:101], v[116:117], v[84:85]
v_pk_add_f32 v[102:103], v[118:119], v[84:85]
v_pk_add_f32 v[132:133], v[132:133], v[84:85]
v_pk_add_f32 v[134:135], v[134:135], v[84:85]
v_pk_add_f32 v[148:149], v[148:149], v[84:85]
v_pk_add_f32 v[150:151], v[150:151], v[84:85]
v_add_u32 v2, s82, v1
s_waitcnt vmcnt(13) lgkmcnt(0)
s_barrier
s_cmp_eq_u32 s60, 0
s_cbranch_scc1 LP0x
v_mfma_f32_16x16x32_bf16 v[164:167], a[160:163], v[32:35], v[84:87]
s_xor_b32 s74, s82, 0x10000
v_exp_f32 v128, v128
v_mfma_f32_16x16x32_bf16 v[164:167], a[164:167], v[36:39], v[164:167]
s_add_u32 s74, s74, s64
ds_read_b128 a[128:131], v2 offset:16384
ds_read_b128 a[132:135], v2 offset:17408
v_mfma_f32_16x16x32_bf16 v[164:167], a[168:171], v[40:43], v[164:167]
s_add_u32 s81, s81, 0x8000
v_exp_f32 v129, v129
v_mfma_f32_16x16x32_bf16 v[164:167], a[172:175], v[44:47], v[164:167]
s_add_u32 m0, s74, 16384
v_exp_f32 v130, v130
v_mfma_f32_16x16x32_bf16 v[172:175], a[172:175], v[76:79], v[92:95]
s_add_u32 s72, s81, 16384
v_exp_f32 v131, v131
v_mfma_f32_16x16x32_bf16 v[172:175], a[168:171], v[72:75], v[172:175]
v_exp_f32 v144, v144
v_mfma_f32_16x16x32_bf16 v[172:175], a[164:167], v[68:71], v[172:175]
s_nop 0
ds_read_b128 a[136:139], v2 offset:18432
ds_read_b128 a[140:143], v2 offset:19456
v_mfma_f32_16x16x32_bf16 v[172:175], a[160:163], v[64:67], v[172:175]
s_nop 0
ds_read_b128 a[144:147], v2 offset:20480
ds_read_b128 a[148:151], v2 offset:21504
v_mfma_f32_16x16x32_bf16 v[188:191], a[176:179], v[64:67], v[92:95]
s_nop 0
ds_read_b128 a[152:155], v2 offset:22528
ds_read_b128 a[156:159], v2 offset:23552
v_mfma_f32_16x16x32_bf16 v[188:191], a[180:183], v[68:71], v[188:191]
s_nop 0
ds_read_b128 a[192:195], v2 offset:0
ds_read_b128 a[196:199], v2 offset:1024
v_mfma_f32_16x16x32_bf16 v[188:191], a[184:187], v[72:75], v[188:191]
s_nop 0
ds_read_b128 a[200:203], v2 offset:2048
ds_read_b128 a[204:207], v2 offset:3072
v_mfma_f32_16x16x32_bf16 v[188:191], a[188:191], v[76:79], v[188:191]
s_nop 0
ds_read_b128 a[208:211], v2 offset:4096
ds_read_b128 a[212:215], v2 offset:5120
v_mfma_f32_16x16x32_bf16 v[180:183], a[188:191], v[44:47], v[84:87]
s_nop 0
ds_read_b128 a[216:219], v2 offset:6144
ds_read_b128 a[220:223], v2 offset:7168
v_mfma_f32_16x16x32_bf16 v[180:183], a[184:187], v[40:43], v[180:183]
v_cvt_pk_bf16_f32 v192, v128, v129
v_cvt_pk_bf16_f32 v193, v130, v131
v_mfma_f32_16x16x32_bf16 v[180:183], a[180:183], v[36:39], v[180:183]
buffer_load_dwordx4 v1, s[44:47], s72 offen sc1 lds
v_mfma_f32_16x16x32_bf16 v[180:183], a[176:179], v[32:35], v[180:183]
v_exp_f32 v145, v145
v_mfma_f32_16x16x32_bf16 v[160:163], a[160:163], v[16:19], v[80:83]
v_exp_f32 v146, v146
v_mfma_f32_16x16x32_bf16 v[160:163], a[164:167], v[20:23], v[160:163]
v_exp_f32 v147, v147
v_mfma_f32_16x16x32_bf16 v[160:163], a[168:171], v[24:27], v[160:163]
v_exp_f32 v136, v136
v_mfma_f32_16x16x32_bf16 v[160:163], a[172:175], v[28:31], v[160:163]
v_cvt_pk_bf16_f32 v194, v144, v145
v_cvt_pk_bf16_f32 v195, v146, v147
v_mfma_f32_16x16x32_bf16 v[168:171], a[172:175], v[60:63], v[88:91]
v_exp_f32 v137, v137
v_mfma_f32_16x16x32_bf16 v[168:171], a[168:171], v[56:59], v[168:171]
v_exp_f32 v138, v138
v_mfma_f32_16x16x32_bf16 v[168:171], a[164:167], v[52:55], v[168:171]
v_exp_f32 v139, v139
v_mfma_f32_16x16x32_bf16 v[168:171], a[160:163], v[48:51], v[168:171]
v_exp_f32 v152, v152
v_mfma_f32_16x16x32_bf16 v[184:187], a[176:179], v[48:51], v[88:91]
v_cvt_pk_bf16_f32 v200, v136, v137
v_cvt_pk_bf16_f32 v201, v138, v139
v_mfma_f32_16x16x32_bf16 v[184:187], a[180:183], v[52:55], v[184:187]
buffer_load_dwordx4 v1, s[44:47], s72 offen offset:1024 sc1 lds
v_mfma_f32_16x16x32_bf16 v[184:187], a[184:187], v[56:59], v[184:187]
v_exp_f32 v153, v153
v_mfma_f32_16x16x32_bf16 v[184:187], a[188:191], v[60:63], v[184:187]
v_exp_f32 v154, v154
v_mfma_f32_16x16x32_bf16 v[176:179], a[188:191], v[28:31], v[80:83]
v_exp_f32 v155, v155
v_mfma_f32_16x16x32_bf16 v[176:179], a[184:187], v[24:27], v[176:179]
buffer_load_dwordx4 v1, s[44:47], s72 offen offset:2048 sc1 lds
v_mfma_f32_16x16x32_bf16 v[176:179], a[180:183], v[20:23], v[176:179]
buffer_load_dwordx4 v1, s[44:47], s72 offen offset:3072 sc1 lds
v_mfma_f32_16x16x32_bf16 v[176:179], a[176:179], v[16:19], v[176:179]
s_waitcnt lgkmcnt(4)
v_exp_f32 v132, v132
v_cvt_pk_bf16_f32 v202, v152, v153
v_cvt_pk_bf16_f32 v203, v154, v155
v_exp_f32 v133, v133
v_exp_f32 v134, v134
v_cvt_pk_bf16_f32 v196, v132, v133
v_exp_f32 v135, v135
v_exp_f32 v148, v148
v_cvt_pk_bf16_f32 v197, v134, v135
v_exp_f32 v149, v149
v_exp_f32 v150, v150
v_cvt_pk_bf16_f32 v198, v148, v149
v_exp_f32 v151, v151
v_exp_f32 v140, v140
v_cvt_pk_bf16_f32 v199, v150, v151
v_exp_f32 v141, v141
v_exp_f32 v142, v142
v_cvt_pk_bf16_f32 v204, v140, v141
v_exp_f32 v143, v143
v_exp_f32 v156, v156
v_cvt_pk_bf16_f32 v205, v142, v143
v_exp_f32 v157, v157
v_exp_f32 v158, v158
v_cvt_pk_bf16_f32 v206, v156, v157
v_exp_f32 v159, v159
s_nop 0
v_cvt_pk_bf16_f32 v207, v158, v159
v_mfma_f32_16x16x32_bf16 v[224:227], v[120:123], v[192:195], 0
s_add_u32 s82, s82, 0x8000
ds_read_b128 a[160:163], v2 offset:24576
ds_read_b128 a[164:167], v2 offset:25600
v_mfma_f32_16x16x32_bf16 v[232:235], v[120:123], v[200:203], 0
s_and_b32 s82, s82, 0x1ffff
v_exp_f32 v164, v164
v_mfma_f32_16x16x32_bf16 a[0:3], a[192:195], v[192:195], 0
s_add_u32 m0, s74, 0
v_exp_f32 v165, v165
v_mfma_f32_16x16x32_bf16 a[64:67], a[192:195], v[200:203], 0
s_add_u32 s72, s81, 0
v_exp_f32 v166, v166
v_mfma_f32_16x16x32_bf16 a[68:71], a[196:199], v[200:203], 0
buffer_load_dwordx4 v1, s[44:47], s72 offen sc1 lds
v_mfma_f32_16x16x32_bf16 a[4:7], a[196:199], v[192:195], 0
v_exp_f32 v167, v167
v_mfma_f32_16x16x32_bf16 a[8:11], a[200:203], v[192:195], 0
ds_read_b128 a[168:171], v2 offset:26624
v_cvt_pk_bf16_f32 v212, v164, v165
v_mfma_f32_16x16x32_bf16 a[72:75], a[200:203], v[200:203], 0
v_exp_f32 v180, v180
v_mfma_f32_16x16x32_bf16 a[76:79], a[204:207], v[200:203], 0
v_exp_f32 v181, v181
v_mfma_f32_16x16x32_bf16 a[12:15], a[204:207], v[192:195], 0
s_waitcnt lgkmcnt(3)
ds_read_b128 a[172:175], v2 offset:27648
v_cvt_pk_bf16_f32 v213, v166, v167
v_mfma_f32_16x16x32_bf16 a[16:19], a[208:211], v[192:195], 0
v_exp_f32 v182, v182
v_mfma_f32_16x16x32_bf16 a[80:83], a[208:211], v[200:203], 0
buffer_load_dwordx4 v1, s[44:47], s72 offen offset:1024 sc1 lds
v_mfma_f32_16x16x32_bf16 a[84:87], a[212:215], v[200:203], 0
v_exp_f32 v183, v183
v_mfma_f32_16x16x32_bf16 a[20:23], a[212:215], v[192:195], 0
s_nop 0
ds_read_b128 a[176:179], v2 offset:28672
ds_read_b128 a[180:183], v2 offset:29696
v_mfma_f32_16x16x32_bf16 a[24:27], a[216:219], v[192:195], 0
v_exp_f32 v172, v172
v_mfma_f32_16x16x32_bf16 a[88:91], a[216:219], v[200:203], 0
s_nop 0
ds_read_b128 a[184:187], v2 offset:30720
ds_read_b128 a[188:191], v2 offset:31744
v_mfma_f32_16x16x32_bf16 a[92:95], a[220:223], v[200:203], 0
s_nop 0
ds_read_b128 a[224:227], v2 offset:8192
ds_read_b128 a[228:231], v2 offset:9216
v_mfma_f32_16x16x32_bf16 a[28:31], a[220:223], v[192:195], 0
s_nop 0
ds_read_b128 a[232:235], v2 offset:10240
ds_read_b128 a[236:239], v2 offset:11264
v_mfma_f32_16x16x32_bf16 v[128:131], a[128:131], v[16:19], v[80:83]
s_nop 0
ds_read_b128 a[240:243], v2 offset:12288
ds_read_b128 a[244:247], v2 offset:13312
v_mfma_f32_16x16x32_bf16 v[128:131], a[132:135], v[20:23], v[128:131]
s_nop 0
ds_read_b128 a[248:251], v2 offset:14336
ds_read_b128 a[252:255], v2 offset:15360
v_mfma_f32_16x16x32_bf16 v[128:131], a[136:139], v[24:27], v[128:131]
v_cvt_pk_bf16_f32 v214, v180, v181
v_cvt_pk_bf16_f32 v215, v182, v183
v_mfma_f32_16x16x32_bf16 v[128:131], a[140:143], v[28:31], v[128:131]
v_exp_f32 v173, v173
v_mfma_f32_16x16x32_bf16 v[136:139], a[140:143], v[60:63], v[88:91]
v_exp_f32 v174, v174
v_mfma_f32_16x16x32_bf16 v[136:139], a[136:139], v[56:59], v[136:139]
buffer_load_dwordx4 v1, s[44:47], s72 offen offset:2048 sc1 lds
v_mfma_f32_16x16x32_bf16 v[136:139], a[132:135], v[52:55], v[136:139]
v_exp_f32 v175, v175
v_mfma_f32_16x16x32_bf16 v[136:139], a[128:131], v[48:51], v[136:139]
v_exp_f32 v188, v188
v_mfma_f32_16x16x32_bf16 v[152:155], a[144:147], v[48:51], v[88:91]
v_cvt_pk_bf16_f32 v220, v172, v173
v_cvt_pk_bf16_f32 v221, v174, v175
v_mfma_f32_16x16x32_bf16 v[152:155], a[148:151], v[52:55], v[152:155]
v_exp_f32 v189, v189
v_mfma_f32_16x16x32_bf16 v[152:155], a[152:155], v[56:59], v[152:155]
v_exp_f32 v190, v190
v_mfma_f32_16x16x32_bf16 v[152:155], a[156:159], v[60:63], v[152:155]
buffer_load_dwordx4 v1, s[44:47], s72 offen offset:3072 sc1 lds
v_mfma_f32_16x16x32_bf16 v[144:147], a[156:159], v[28:31], v[80:83]
s_add_u32 s66, s58, 1
v_exp_f32 v191, v191
v_mfma_f32_16x16x32_bf16 v[144:147], a[152:155], v[24:27], v[144:147]
s_and_b32 s66, s66, 3
v_exp_f32 v160, v160
v_mfma_f32_16x16x32_bf16 v[144:147], a[148:151], v[20:23], v[144:147]
s_mul_i32 s66, s66, 4160
v_cvt_pk_bf16_f32 v222, v188, v189
v_cvt_pk_bf16_f32 v223, v190, v191
v_mfma_f32_16x16x32_bf16 v[144:147], a[144:147], v[16:19], v[144:147]
s_add_u32 m0, s66, 131104
v_exp_f32 v161, v161
v_mfma_f32_16x16x32_bf16 v[132:135], a[128:131], v[32:35], v[84:87]
s_add_u32 s72, s93, 0x2
buffer_load_dwordx4 v1, s[36:39], s72 offen lds
v_mfma_f32_16x16x32_bf16 v[132:135], a[132:135], v[36:39], v[132:135]
v_exp_f32 v162, v162
v_mfma_f32_16x16x32_bf16 v[132:135], a[136:139], v[40:43], v[132:135]
v_exp_f32 v163, v163
v_mfma_f32_16x16x32_bf16 v[132:135], a[140:143], v[44:47], v[132:135]
v_exp_f32 v176, v176
v_mfma_f32_16x16x32_bf16 v[140:143], a[140:143], v[76:79], v[92:95]
v_cvt_pk_bf16_f32 v208, v160, v161
v_cvt_pk_bf16_f32 v209, v162, v163
v_mfma_f32_16x16x32_bf16 v[140:143], a[136:139], v[72:75], v[140:143]
v_exp_f32 v177, v177
v_mfma_f32_16x16x32_bf16 v[140:143], a[132:135], v[68:71], v[140:143]
buffer_load_dwordx4 v1, s[36:39], s72 offen offset:1024 lds
v_mfma_f32_16x16x32_bf16 v[140:143], a[128:131], v[64:67], v[140:143]
v_exp_f32 v178, v178
v_mfma_f32_16x16x32_bf16 v[156:159], a[144:147], v[64:67], v[92:95]
v_exp_f32 v179, v179
v_mfma_f32_16x16x32_bf16 v[156:159], a[148:151], v[68:71], v[156:159]
v_exp_f32 v168, v168
v_mfma_f32_16x16x32_bf16 v[156:159], a[152:155], v[72:75], v[156:159]
v_cvt_pk_bf16_f32 v210, v176, v177
v_cvt_pk_bf16_f32 v211, v178, v179
v_mfma_f32_16x16x32_bf16 v[156:159], a[156:159], v[76:79], v[156:159]
v_exp_f32 v169, v169
v_mfma_f32_16x16x32_bf16 v[148:151], a[156:159], v[44:47], v[84:87]
buffer_load_dwordx4 v1, s[36:39], s72 offen offset:2048 lds
v_mfma_f32_16x16x32_bf16 v[148:151], a[152:155], v[40:43], v[148:151]
buffer_load_dwordx4 v1, s[36:39], s72 offen offset:3072 lds
v_mfma_f32_16x16x32_bf16 v[148:151], a[148:151], v[36:39], v[148:151]
s_waitcnt vmcnt(12) lgkmcnt(4)
v_exp_f32 v170, v170
v_mfma_f32_16x16x32_bf16 v[148:151], a[144:147], v[32:35], v[148:151]
s_barrier
v_exp_f32 v171, v171
v_add_u32 v2, s82, v1
v_cvt_pk_bf16_f32 v216, v168, v169
v_exp_f32 v184, v184
v_cvt_pk_bf16_f32 v217, v170, v171
v_exp_f32 v185, v185
v_exp_f32 v186, v186
v_cvt_pk_bf16_f32 v218, v184, v185
v_exp_f32 v187, v187
s_nop 0
v_cvt_pk_bf16_f32 v219, v186, v187
s_lshl_b32 s75, s59, 4
s_and_b32 s76, s84, 15
s_add_u32 s75, s75, s76
s_lshl_b32 s75, s75, 14
s_cmp_ge_u32 s60, 4
s_cselect_b32 s75, s75, 0x40001000
s_lshl_b32 s83, s60, 1
s_sub_u32 s83, 2, s83
s_cmp_eq_u32 s83, 0
s_cbranch_scc1 LLT1
.p2align 5
s_nop 0
s_nop 0
LloopI:
v_mfma_f32_16x16x32_bf16 v[228:231], v[120:123], v[196:199], v[228:231]
s_xor_b32 s74, s82, 0x10000
v_exp_f32 v128, v128
v_mfma_f32_16x16x32_bf16 v[228:231], v[120:123], v[212:215], v[228:231]
s_add_u32 s74, s74, s64
ds_read_b128 a[128:131], v2 offset:16384
v_add_u32 v15, s75, v3
v_mfma_f32_16x16x32_bf16 v[236:239], v[120:123], v[204:207], v[236:239]
s_add_u32 s81, s81, 0x8000
v_exp_f32 v129, v129
v_mfma_f32_16x16x32_bf16 v[236:239], v[120:123], v[220:223], v[236:239]
s_add_u32 m0, s74, 16384
v_exp_f32 v130, v130
v_mfma_f32_16x16x32_bf16 a[32:35], a[192:195], v[196:199], a[32:35]
s_add_u32 s72, s81, 16384
ds_read_b128 a[132:135], v2 offset:17408
v_cvt_pk_bf16_f32 v192, v128, v129
v_mfma_f32_16x16x32_bf16 a[32:35], a[224:227], v[212:215], a[32:35]
v_exp_f32 v131, v131
v_mfma_f32_16x16x32_bf16 a[96:99], a[224:227], v[220:223], a[96:99]
v_exp_f32 v144, v144
v_mfma_f32_16x16x32_bf16 a[96:99], a[192:195], v[204:207], a[96:99]
ds_read_b128 a[136:139], v2 offset:18432
v_cvt_pk_bf16_f32 v193, v130, v131
v_mfma_f32_16x16x32_bf16 a[100:103], a[196:199], v[204:207], a[100:103]
buffer_load_dwordx4 v1, s[44:47], s72 offen sc1 lds
v_mfma_f32_16x16x32_bf16 a[100:103], a[228:231], v[220:223], a[100:103]
v_exp_f32 v145, v145
v_mfma_f32_16x16x32_bf16 a[36:39], a[228:231], v[212:215], a[36:39]
v_exp_f32 v146, v146
v_mfma_f32_16x16x32_bf16 a[36:39], a[196:199], v[196:199], a[36:39]
ds_read_b128 a[140:143], v2 offset:19456
v_cvt_pk_bf16_f32 v194, v144, v145
v_mfma_f32_16x16x32_bf16 a[40:43], a[200:203], v[196:199], a[40:43]
v_exp_f32 v147, v147
v_mfma_f32_16x16x32_bf16 a[40:43], a[232:235], v[212:215], a[40:43]
v_exp_f32 v136, v136
v_mfma_f32_16x16x32_bf16 a[104:107], a[232:235], v[220:223], a[104:107]
ds_read_b128 a[144:147], v2 offset:20480
v_cvt_pk_bf16_f32 v195, v146, v147
v_mfma_f32_16x16x32_bf16 a[104:107], a[200:203], v[204:207], a[104:107]
v_exp_f32 v137, v137
v_mfma_f32_16x16x32_bf16 a[108:111], a[204:207], v[204:207], a[108:111]
v_exp_f32 v138, v138
v_mfma_f32_16x16x32_bf16 a[108:111], a[236:239], v[220:223], a[108:111]
ds_read_b128 a[148:151], v2 offset:21504
v_cvt_pk_bf16_f32 v200, v136, v137
v_mfma_f32_16x16x32_bf16 a[44:47], a[236:239], v[212:215], a[44:47]
v_exp_f32 v139, v139
v_mfma_f32_16x16x32_bf16 a[44:47], a[204:207], v[196:199], a[44:47]
v_exp_f32 v152, v152
v_mfma_f32_16x16x32_bf16 a[48:51], a[208:211], v[196:199], a[48:51]
s_waitcnt lgkmcnt(6)
ds_read_b128 a[152:155], v2 offset:22528
v_cvt_pk_bf16_f32 v201, v138, v139
v_mfma_f32_16x16x32_bf16 a[48:51], a[240:243], v[212:215], a[48:51]
buffer_load_dwordx4 v1, s[44:47], s72 offen offset:1024 sc1 lds
v_mfma_f32_16x16x32_bf16 a[112:115], a[240:243], v[220:223], a[112:115]
v_exp_f32 v153, v153
v_mfma_f32_16x16x32_bf16 a[112:115], a[208:211], v[204:207], a[112:115]
v_exp_f32 v154, v154
v_mfma_f32_16x16x32_bf16 a[116:119], a[212:215], v[204:207], a[116:119]
ds_read_b128 a[156:159], v2 offset:23552
v_cvt_pk_bf16_f32 v202, v152, v153
v_mfma_f32_16x16x32_bf16 a[116:119], a[244:247], v[220:223], a[116:119]
v_exp_f32 v155, v155
v_mfma_f32_16x16x32_bf16 a[52:55], a[244:247], v[212:215], a[52:55]
v_exp_f32 v132, v132
v_mfma_f32_16x16x32_bf16 a[52:55], a[212:215], v[196:199], a[52:55]
ds_read_b128 a[192:195], v2 offset:0
v_cvt_pk_bf16_f32 v203, v154, v155
v_mfma_f32_16x16x32_bf16 a[56:59], a[216:219], v[196:199], a[56:59]
v_exp_f32 v133, v133
v_mfma_f32_16x16x32_bf16 a[56:59], a[248:251], v[212:215], a[56:59]
v_exp_f32 v134, v134
v_mfma_f32_16x16x32_bf16 a[120:123], a[248:251], v[220:223], a[120:123]
ds_read_b128 a[196:199], v2 offset:1024
v_mfma_f32_16x16x32_bf16 a[120:123], a[216:219], v[204:207], a[120:123]
v_exp_f32 v135, v135
v_mfma_f32_16x16x32_bf16 a[124:127], a[220:223], v[204:207], a[124:127]
v_exp_f32 v148, v148
v_mfma_f32_16x16x32_bf16 a[124:127], a[252:255], v[220:223], a[124:127]
ds_read_b128 a[200:203], v2 offset:2048
v_mfma_f32_16x16x32_bf16 a[60:63], a[252:255], v[212:215], a[60:63]
buffer_load_dwordx4 v1, s[44:47], s72 offen offset:2048 sc1 lds
v_mfma_f32_16x16x32_bf16 a[60:63], a[220:223], v[196:199], a[60:63]
ds_read_b128 a[204:207], v2 offset:3072
v_cvt_pk_bf16_f32 v196, v132, v133
v_mfma_f32_16x16x32_bf16 v[164:167], a[160:163], v[32:35], v[84:87]
v_exp_f32 v149, v149
v_mfma_f32_16x16x32_bf16 v[164:167], a[164:167], v[36:39], v[164:167]
v_exp_f32 v150, v150
v_mfma_f32_16x16x32_bf16 v[164:167], a[168:171], v[40:43], v[164:167]
ds_read_b128 a[208:211], v2 offset:4096
v_cvt_pk_bf16_f32 v197, v134, v135
v_mfma_f32_16x16x32_bf16 v[164:167], a[172:175], v[44:47], v[164:167]
v_exp_f32 v151, v151
v_mfma_f32_16x16x32_bf16 v[172:175], a[172:175], v[76:79], v[92:95]
v_exp_f32 v140, v140
v_mfma_f32_16x16x32_bf16 v[172:175], a[168:171], v[72:75], v[172:175]
ds_read_b128 a[212:215], v2 offset:5120
v_cvt_pk_bf16_f32 v198, v148, v149
v_mfma_f32_16x16x32_bf16 v[172:175], a[164:167], v[68:71], v[172:175]
v_exp_f32 v141, v141
v_mfma_f32_16x16x32_bf16 v[172:175], a[160:163], v[64:67], v[172:175]
v_exp_f32 v142, v142
v_mfma_f32_16x16x32_bf16 v[188:191], a[176:179], v[64:67], v[92:95]
ds_read_b128 a[216:219], v2 offset:6144
v_cvt_pk_bf16_f32 v199, v150, v151
v_mfma_f32_16x16x32_bf16 v[188:191], a[180:183], v[68:71], v[188:191]
v_exp_f32 v143, v143
v_mfma_f32_16x16x32_bf16 v[188:191], a[184:187], v[72:75], v[188:191]
v_exp_f32 v156, v156
v_mfma_f32_16x16x32_bf16 v[188:191], a[188:191], v[76:79], v[188:191]
ds_read_b128 a[220:223], v2 offset:7168
v_cvt_pk_bf16_f32 v204, v140, v141
v_mfma_f32_16x16x32_bf16 v[180:183], a[188:191], v[44:47], v[84:87]
buffer_load_dwordx4 v1, s[44:47], s72 offen offset:3072 sc1 lds
v_mfma_f32_16x16x32_bf16 v[180:183], a[184:187], v[40:43], v[180:183]
v_exp_f32 v157, v157
v_mfma_f32_16x16x32_bf16 v[180:183], a[180:183], v[36:39], v[180:183]
v_exp_f32 v158, v158
v_mfma_f32_16x16x32_bf16 v[180:183], a[176:179], v[32:35], v[180:183]
v_cvt_pk_bf16_f32 v205, v142, v143
v_cvt_pk_bf16_f32 v206, v156, v157
v_mfma_f32_16x16x32_bf16 v[160:163], a[160:163], v[16:19], v[80:83]
v_exp_f32 v159, v159
v_mfma_f32_16x16x32_bf16 v[160:163], a[164:167], v[20:23], v[160:163]
v_cvt_pk_bf16_f32 v207, v158, v159
v_mfma_f32_16x16x32_bf16 v[160:163], a[168:171], v[24:27], v[160:163]
v_mfma_f32_16x16x32_bf16 v[160:163], a[172:175], v[28:31], v[160:163]
v_mfma_f32_16x16x32_bf16 v[168:171], a[172:175], v[60:63], v[88:91]
v_mfma_f32_16x16x32_bf16 v[168:171], a[168:171], v[56:59], v[168:171]
v_mfma_f32_16x16x32_bf16 v[168:171], a[164:167], v[52:55], v[168:171]
v_mfma_f32_16x16x32_bf16 v[168:171], a[160:163], v[48:51], v[168:171]
v_mfma_f32_16x16x32_bf16 v[184:187], a[176:179], v[48:51], v[88:91]
v_mfma_f32_16x16x32_bf16 v[184:187], a[180:183], v[52:55], v[184:187]
v_mfma_f32_16x16x32_bf16 v[184:187], a[184:187], v[56:59], v[184:187]
v_mfma_f32_16x16x32_bf16 v[184:187], a[188:191], v[60:63], v[184:187]
v_mfma_f32_16x16x32_bf16 v[176:179], a[188:191], v[28:31], v[80:83]
v_mfma_f32_16x16x32_bf16 v[176:179], a[184:187], v[24:27], v[176:179]
v_mfma_f32_16x16x32_bf16 v[176:179], a[180:183], v[20:23], v[176:179]
v_mfma_f32_16x16x32_bf16 v[176:179], a[176:179], v[16:19], v[176:179]
s_waitcnt lgkmcnt(4)
v_mfma_f32_16x16x32_bf16 v[224:227], v[120:123], v[208:211], v[224:227]
s_add_u32 s82, s82, 0x8000
ds_read_b128 a[160:163], v2 offset:24576
v_mfma_f32_16x16x32_bf16 v[224:227], v[120:123], v[192:195], v[224:227]
s_and_b32 s82, s82, 0x1ffff
v_exp_f32 v164, v164
v_mfma_f32_16x16x32_bf16 v[232:235], v[120:123], v[216:219], v[232:235]
s_add_u32 m0, s74, 0
v_exp_f32 v165, v165
v_mfma_f32_16x16x32_bf16 v[232:235], v[120:123], v[200:203], v[232:235]
s_add_u32 s72, s81, 0
ds_read_b128 a[164:167], v2 offset:25600
v_cvt_pk_bf16_f32 v212, v164, v165
v_mfma_f32_16x16x32_bf16 a[0:3], a[224:227], v[208:211], a[0:3]
v_exp_f32 v166, v166
v_mfma_f32_16x16x32_bf16 a[0:3], a[192:195], v[192:195], a[0:3]
v_exp_f32 v167, v167
v_mfma_f32_16x16x32_bf16 a[64:67], a[192:195], v[200:203], a[64:67]
buffer_load_dwordx4 v1, s[44:47], s72 offen sc1 lds
v_mfma_f32_16x16x32_bf16 a[64:67], a[224:227], v[216:219], a[64:67]
ds_read_b128 a[168:171], v2 offset:26624
v_cvt_pk_bf16_f32 v213, v166, v167
v_mfma_f32_16x16x32_bf16 a[68:71], a[228:231], v[216:219], a[68:71]
v_exp_f32 v180, v180
v_mfma_f32_16x16x32_bf16 a[68:71], a[196:199], v[200:203], a[68:71]
v_exp_f32 v181, v181
v_mfma_f32_16x16x32_bf16 a[4:7], a[196:199], v[192:195], a[4:7]
ds_read_b128 a[172:175], v2 offset:27648
v_cvt_pk_bf16_f32 v214, v180, v181
v_mfma_f32_16x16x32_bf16 a[4:7], a[228:231], v[208:211], a[4:7]
v_exp_f32 v182, v182
v_mfma_f32_16x16x32_bf16 a[8:11], a[232:235], v[208:211], a[8:11]
v_exp_f32 v183, v183
v_mfma_f32_16x16x32_bf16 a[8:11], a[200:203], v[192:195], a[8:11]
ds_read_b128 a[176:179], v2 offset:28672
v_cvt_pk_bf16_f32 v215, v182, v183
v_mfma_f32_16x16x32_bf16 a[72:75], a[200:203], v[200:203], a[72:75]
v_exp_f32 v172, v172
v_mfma_f32_16x16x32_bf16 a[72:75], a[232:235], v[216:219], a[72:75]
v_exp_f32 v173, v173
v_mfma_f32_16x16x32_bf16 a[76:79], a[236:239], v[216:219], a[76:79]
ds_read_b128 a[180:183], v2 offset:29696
v_cvt_pk_bf16_f32 v220, v172, v173
v_mfma_f32_16x16x32_bf16 a[76:79], a[204:207], v[200:203], a[76:79]
buffer_load_dwordx4 v1, s[44:47], s72 offen offset:1024 sc1 lds
v_mfma_f32_16x16x32_bf16 a[12:15], a[204:207], v[192:195], a[12:15]
v_exp_f32 v174, v174
v_mfma_f32_16x16x32_bf16 a[12:15], a[236:239], v[208:211], a[12:15]
v_exp_f32 v175, v175
v_mfma_f32_16x16x32_bf16 a[16:19], a[240:243], v[208:211], a[16:19]
s_waitcnt lgkmcnt(6)
ds_read_b128 a[184:187], v2 offset:30720
v_cvt_pk_bf16_f32 v221, v174, v175
v_mfma_f32_16x16x32_bf16 a[16:19], a[208:211], v[192:195], a[16:19]
v_exp_f32 v188, v188
v_mfma_f32_16x16x32_bf16 a[80:83], a[208:211], v[200:203], a[80:83]
v_exp_f32 v189, v189
v_mfma_f32_16x16x32_bf16 a[80:83], a[240:243], v[216:219], a[80:83]
ds_read_b128 a[188:191], v2 offset:31744
v_cvt_pk_bf16_f32 v222, v188, v189
v_mfma_f32_16x16x32_bf16 a[84:87], a[244:247], v[216:219], a[84:87]
v_exp_f32 v190, v190
v_mfma_f32_16x16x32_bf16 a[84:87], a[212:215], v[200:203], a[84:87]
v_exp_f32 v191, v191
v_mfma_f32_16x16x32_bf16 a[20:23], a[212:215], v[192:195], a[20:23]
ds_read_b128 a[224:227], v2 offset:8192
v_cvt_pk_bf16_f32 v223, v190, v191
v_mfma_f32_16x16x32_bf16 a[20:23], a[244:247], v[208:211], a[20:23]
v_exp_f32 v160, v160
v_mfma_f32_16x16x32_bf16 a[24:27], a[248:251], v[208:211], a[24:27]
buffer_load_dwordx4 v1, s[44:47], s72 offen offset:2048 sc1 lds
v_mfma_f32_16x16x32_bf16 a[24:27], a[216:219], v[192:195], a[24:27]
v_exp_f32 v161, v161
v_mfma_f32_16x16x32_bf16 a[88:91], a[216:219], v[200:203], a[88:91]
ds_read_b128 a[228:231], v2 offset:9216
v_mfma_f32_16x16x32_bf16 a[88:91], a[248:251], v[216:219], a[88:91]
v_exp_f32 v162, v162
v_mfma_f32_16x16x32_bf16 a[92:95], a[252:255], v[216:219], a[92:95]
v_exp_f32 v163, v163
v_mfma_f32_16x16x32_bf16 a[92:95], a[220:223], v[200:203], a[92:95]
ds_read_b128 a[232:235], v2 offset:10240
v_mfma_f32_16x16x32_bf16 a[28:31], a[220:223], v[192:195], a[28:31]
v_exp_f32 v176, v176
v_mfma_f32_16x16x32_bf16 a[28:31], a[252:255], v[208:211], a[28:31]
ds_read_b128 a[236:239], v2 offset:11264
v_cvt_pk_bf16_f32 v208, v160, v161
v_mfma_f32_16x16x32_bf16 v[128:131], a[128:131], v[16:19], v[80:83]
v_exp_f32 v177, v177
v_mfma_f32_16x16x32_bf16 v[128:131], a[132:135], v[20:23], v[128:131]
v_exp_f32 v178, v178
v_mfma_f32_16x16x32_bf16 v[128:131], a[136:139], v[24:27], v[128:131]
Lstub1:
s_cbranch_execz Lstub5
ds_read_b128 a[240:243], v2 offset:12288
v_cvt_pk_bf16_f32 v209, v162, v163
v_mfma_f32_16x16x32_bf16 v[128:131], a[140:143], v[28:31], v[128:131]
buffer_load_dwordx4 v1, s[44:47], s72 offen offset:3072 sc1 lds
v_mfma_f32_16x16x32_bf16 v[136:139], a[140:143], v[60:63], v[88:91]
s_add_u32 s75, s75, 0x1000
v_exp_f32 v179, v179
v_mfma_f32_16x16x32_bf16 v[136:139], a[136:139], v[56:59], v[136:139]
s_and_b32 s76, s75, 0x3000
v_exp_f32 v168, v168
v_mfma_f32_16x16x32_bf16 v[136:139], a[132:135], v[52:55], v[136:139]
s_cselect_b32 s75, s75, 0x40001000
ds_read_b128 a[244:247], v2 offset:13312
v_cvt_pk_bf16_f32 v210, v176, v177
v_mfma_f32_16x16x32_bf16 v[136:139], a[128:131], v[48:51], v[136:139]
v_exp_f32 v169, v169
v_mfma_f32_16x16x32_bf16 v[152:155], a[144:147], v[48:51], v[88:91]
v_exp_f32 v170, v170
v_mfma_f32_16x16x32_bf16 v[152:155], a[148:151], v[52:55], v[152:155]
ds_read_b128 a[248:251], v2 offset:14336
v_cvt_pk_bf16_f32 v211, v178, v179
v_mfma_f32_16x16x32_bf16 v[152:155], a[152:155], v[56:59], v[152:155]
v_exp_f32 v171, v171
v_mfma_f32_16x16x32_bf16 v[152:155], a[156:159], v[60:63], v[152:155]
v_exp_f32 v184, v184
v_mfma_f32_16x16x32_bf16 v[144:147], a[156:159], v[28:31], v[80:83]
ds_read_b128 a[252:255], v2 offset:15360
v_cvt_pk_bf16_f32 v216, v168, v169
v_mfma_f32_16x16x32_bf16 v[144:147], a[152:155], v[24:27], v[144:147]
buffer_load_dword v4, v15, s[24:27], 0 offen
v_mfma_f32_16x16x32_bf16 v[144:147], a[148:151], v[20:23], v[144:147]
v_exp_f32 v185, v185
v_mfma_f32_16x16x32_bf16 v[144:147], a[144:147], v[16:19], v[144:147]
v_exp_f32 v186, v186
v_mfma_f32_16x16x32_bf16 v[132:135], a[128:131], v[32:35], v[84:87]
v_cvt_pk_bf16_f32 v217, v170, v171
v_cvt_pk_bf16_f32 v218, v184, v185
v_mfma_f32_16x16x32_bf16 v[132:135], a[132:135], v[36:39], v[132:135]
v_exp_f32 v187, v187
v_mfma_f32_16x16x32_bf16 v[132:135], a[136:139], v[40:43], v[132:135]
v_cvt_pk_bf16_f32 v219, v186, v187
v_add_u32 v2, s82, v1
v_mfma_f32_16x16x32_bf16 v[132:135], a[140:143], v[44:47], v[132:135]
v_mfma_f32_16x16x32_bf16 v[140:143], a[140:143], v[76:79], v[92:95]
v_mfma_f32_16x16x32_bf16 v[140:143], a[136:139], v[72:75], v[140:143]
v_mfma_f32_16x16x32_bf16 v[140:143], a[132:135], v[68:71], v[140:143]
v_mfma_f32_16x16x32_bf16 v[140:143], a[128:131], v[64:67], v[140:143]
v_mfma_f32_16x16x32_bf16 v[156:159], a[144:147], v[64:67], v[92:95]
v_mfma_f32_16x16x32_bf16 v[156:159], a[148:151], v[68:71], v[156:159]
v_mfma_f32_16x16x32_bf16 v[156:159], a[152:155], v[72:75], v[156:159]
v_mfma_f32_16x16x32_bf16 v[156:159], a[156:159], v[76:79], v[156:159]
v_mfma_f32_16x16x32_bf16 v[148:151], a[156:159], v[44:47], v[84:87]
s_waitcnt vmcnt(9) lgkmcnt(4)
v_mfma_f32_16x16x32_bf16 v[148:151], a[152:155], v[40:43], v[148:151]
s_barrier
v_mfma_f32_16x16x32_bf16 v[148:151], a[148:151], v[36:39], v[148:151]
s_add_u32 s83, s83, 1
v_mfma_f32_16x16x32_bf16 v[148:151], a[144:147], v[32:35], v[148:151]
s_cbranch_scc0 LloopI
LLT1:
Lstub2:
s_cbranch_execz Lstub6
v_mfma_f32_16x16x32_bf16 v[228:231], v[120:123], v[196:199], v[228:231]
s_xor_b32 s74, s82, 0x10000
v_exp_f32 v128, v128
v_mfma_f32_16x16x32_bf16 v[228:231], v[120:123], v[212:215], v[228:231]
s_add_u32 s74, s74, s64
ds_read_b128 a[128:131], v2 offset:16384
v_mfma_f32_16x16x32_bf16 v[236:239], v[120:123], v[204:207], v[236:239]
s_add_u32 s81, s81, 0x8000
v_exp_f32 v129, v129
v_mfma_f32_16x16x32_bf16 v[236:239], v[120:123], v[220:223], v[236:239]
s_add_u32 m0, s74, 16384
v_exp_f32 v130, v130
v_mfma_f32_16x16x32_bf16 a[32:35], a[192:195], v[196:199], a[32:35]
s_add_u32 s72, s81, 16384
ds_read_b128 a[132:135], v2 offset:17408
v_cvt_pk_bf16_f32 v192, v128, v129
v_mfma_f32_16x16x32_bf16 a[32:35], a[224:227], v[212:215], a[32:35]
v_exp_f32 v131, v131
v_mfma_f32_16x16x32_bf16 a[96:99], a[224:227], v[220:223], a[96:99]
v_exp_f32 v144, v144
v_mfma_f32_16x16x32_bf16 a[96:99], a[192:195], v[204:207], a[96:99]
ds_read_b128 a[136:139], v2 offset:18432
v_cvt_pk_bf16_f32 v193, v130, v131
v_mfma_f32_16x16x32_bf16 a[100:103], a[196:199], v[204:207], a[100:103]
buffer_load_dwordx4 v1, s[44:47], s72 offen sc1 lds
v_mfma_f32_16x16x32_bf16 a[100:103], a[228:231], v[220:223], a[100:103]
v_exp_f32 v145, v145
v_mfma_f32_16x16x32_bf16 a[36:39], a[228:231], v[212:215], a[36:39]
v_exp_f32 v146, v146
v_mfma_f32_16x16x32_bf16 a[36:39], a[196:199], v[196:199], a[36:39]
ds_read_b128 a[140:143], v2 offset:19456
v_cvt_pk_bf16_f32 v194, v144, v145
v_mfma_f32_16x16x32_bf16 a[40:43], a[200:203], v[196:199], a[40:43]
v_exp_f32 v147, v147
v_mfma_f32_16x16x32_bf16 a[40:43], a[232:235], v[212:215], a[40:43]
v_exp_f32 v136, v136
v_mfma_f32_16x16x32_bf16 a[104:107], a[232:235], v[220:223], a[104:107]
ds_read_b128 a[144:147], v2 offset:20480
v_cvt_pk_bf16_f32 v195, v146, v147
v_mfma_f32_16x16x32_bf16 a[104:107], a[200:203], v[204:207], a[104:107]
v_exp_f32 v137, v137
v_mfma_f32_16x16x32_bf16 a[108:111], a[204:207], v[204:207], a[108:111]
v_exp_f32 v138, v138
v_mfma_f32_16x16x32_bf16 a[108:111], a[236:239], v[220:223], a[108:111]
ds_read_b128 a[148:151], v2 offset:21504
v_cvt_pk_bf16_f32 v200, v136, v137
v_mfma_f32_16x16x32_bf16 a[44:47], a[236:239], v[212:215], a[44:47]
v_exp_f32 v139, v139
v_mfma_f32_16x16x32_bf16 a[44:47], a[204:207], v[196:199], a[44:47]
v_exp_f32 v152, v152
v_mfma_f32_16x16x32_bf16 a[48:51], a[208:211], v[196:199], a[48:51]
s_waitcnt lgkmcnt(6)
ds_read_b128 a[152:155], v2 offset:22528
v_cvt_pk_bf16_f32 v201, v138, v139
v_mfma_f32_16x16x32_bf16 a[48:51], a[240:243], v[212:215], a[48:51]
buffer_load_dwordx4 v1, s[44:47], s72 offen offset:1024 sc1 lds
v_mfma_f32_16x16x32_bf16 a[112:115], a[240:243], v[220:223], a[112:115]
v_exp_f32 v153, v153
v_mfma_f32_16x16x32_bf16 a[112:115], a[208:211], v[204:207], a[112:115]
v_exp_f32 v154, v154
v_mfma_f32_16x16x32_bf16 a[116:119], a[212:215], v[204:207], a[116:119]
ds_read_b128 a[156:159], v2 offset:23552
v_cvt_pk_bf16_f32 v202, v152, v153
v_mfma_f32_16x16x32_bf16 a[116:119], a[244:247], v[220:223], a[116:119]
v_exp_f32 v155, v155
v_mfma_f32_16x16x32_bf16 a[52:55], a[244:247], v[212:215], a[52:55]
v_exp_f32 v132, v132
v_mfma_f32_16x16x32_bf16 a[52:55], a[212:215], v[196:199], a[52:55]
ds_read_b128 a[192:195], v2 offset:0
v_cvt_pk_bf16_f32 v203, v154, v155
v_mfma_f32_16x16x32_bf16 a[56:59], a[216:219], v[196:199], a[56:59]
v_exp_f32 v133, v133
v_mfma_f32_16x16x32_bf16 a[56:59], a[248:251], v[212:215], a[56:59]
v_exp_f32 v134, v134
v_mfma_f32_16x16x32_bf16 a[120:123], a[248:251], v[220:223], a[120:123]
ds_read_b128 a[196:199], v2 offset:1024
v_mfma_f32_16x16x32_bf16 a[120:123], a[216:219], v[204:207], a[120:123]
v_exp_f32 v135, v135
v_mfma_f32_16x16x32_bf16 a[124:127], a[220:223], v[204:207], a[124:127]
v_exp_f32 v148, v148
v_mfma_f32_16x16x32_bf16 a[124:127], a[252:255], v[220:223], a[124:127]
ds_read_b128 a[200:203], v2 offset:2048
v_mfma_f32_16x16x32_bf16 a[60:63], a[252:255], v[212:215], a[60:63]
buffer_load_dwordx4 v1, s[44:47], s72 offen offset:2048 sc1 lds
v_mfma_f32_16x16x32_bf16 a[60:63], a[220:223], v[196:199], a[60:63]
ds_read_b128 a[204:207], v2 offset:3072
v_cvt_pk_bf16_f32 v196, v132, v133
v_mfma_f32_16x16x32_bf16 v[164:167], a[160:163], v[32:35], v[84:87]
v_exp_f32 v149, v149
v_mfma_f32_16x16x32_bf16 v[164:167], a[164:167], v[36:39], v[164:167]
v_exp_f32 v150, v150
v_mfma_f32_16x16x32_bf16 v[164:167], a[168:171], v[40:43], v[164:167]
ds_read_b128 a[208:211], v2 offset:4096
v_cvt_pk_bf16_f32 v197, v134, v135
v_mfma_f32_16x16x32_bf16 v[164:167], a[172:175], v[44:47], v[164:167]
v_exp_f32 v151, v151
v_mfma_f32_16x16x32_bf16 v[172:175], a[172:175], v[76:79], v[92:95]
v_exp_f32 v140, v140
v_mfma_f32_16x16x32_bf16 v[172:175], a[168:171], v[72:75], v[172:175]
ds_read_b128 a[212:215], v2 offset:5120
v_cvt_pk_bf16_f32 v198, v148, v149
v_mfma_f32_16x16x32_bf16 v[172:175], a[164:167], v[68:71], v[172:175]
v_exp_f32 v141, v141
v_mfma_f32_16x16x32_bf16 v[172:175], a[160:163], v[64:67], v[172:175]
v_exp_f32 v142, v142
v_mfma_f32_16x16x32_bf16 v[188:191], a[176:179], v[64:67], v[92:95]
ds_read_b128 a[216:219], v2 offset:6144
v_cvt_pk_bf16_f32 v199, v150, v151
v_mfma_f32_16x16x32_bf16 v[188:191], a[180:183], v[68:71], v[188:191]
v_exp_f32 v143, v143
v_mfma_f32_16x16x32_bf16 v[188:191], a[184:187], v[72:75], v[188:191]
v_exp_f32 v156, v156
v_mfma_f32_16x16x32_bf16 v[188:191], a[188:191], v[76:79], v[188:191]
ds_read_b128 a[220:223], v2 offset:7168
v_cvt_pk_bf16_f32 v204, v140, v141
v_mfma_f32_16x16x32_bf16 v[180:183], a[188:191], v[44:47], v[84:87]
buffer_load_dwordx4 v1, s[44:47], s72 offen offset:3072 sc1 lds
v_mfma_f32_16x16x32_bf16 v[180:183], a[184:187], v[40:43], v[180:183]
v_exp_f32 v157, v157
v_mfma_f32_16x16x32_bf16 v[180:183], a[180:183], v[36:39], v[180:183]
v_exp_f32 v158, v158
v_mfma_f32_16x16x32_bf16 v[180:183], a[176:179], v[32:35], v[180:183]
v_cvt_pk_bf16_f32 v205, v142, v143
v_cvt_pk_bf16_f32 v206, v156, v157
v_mfma_f32_16x16x32_bf16 v[160:163], a[160:163], v[16:19], v[80:83]
v_exp_f32 v159, v159
v_mfma_f32_16x16x32_bf16 v[160:163], a[164:167], v[20:23], v[160:163]
v_cvt_pk_bf16_f32 v207, v158, v159
v_mfma_f32_16x16x32_bf16 v[160:163], a[168:171], v[24:27], v[160:163]
v_mfma_f32_16x16x32_bf16 v[160:163], a[172:175], v[28:31], v[160:163]
v_mfma_f32_16x16x32_bf16 v[168:171], a[172:175], v[60:63], v[88:91]
v_mfma_f32_16x16x32_bf16 v[168:171], a[168:171], v[56:59], v[168:171]
v_mfma_f32_16x16x32_bf16 v[168:171], a[164:167], v[52:55], v[168:171]
v_mfma_f32_16x16x32_bf16 v[168:171], a[160:163], v[48:51], v[168:171]
v_mfma_f32_16x16x32_bf16 v[184:187], a[176:179], v[48:51], v[88:91]
v_mfma_f32_16x16x32_bf16 v[184:187], a[180:183], v[52:55], v[184:187]
v_mfma_f32_16x16x32_bf16 v[184:187], a[184:187], v[56:59], v[184:187]
v_mfma_f32_16x16x32_bf16 v[184:187], a[188:191], v[60:63], v[184:187]
v_mfma_f32_16x16x32_bf16 v[176:179], a[188:191], v[28:31], v[80:83]
v_mfma_f32_16x16x32_bf16 v[176:179], a[184:187], v[24:27], v[176:179]
v_mfma_f32_16x16x32_bf16 v[176:179], a[180:183], v[20:23], v[176:179]
v_mfma_f32_16x16x32_bf16 v[176:179], a[176:179], v[16:19], v[176:179]
s_waitcnt lgkmcnt(4)
v_mfma_f32_16x16x32_bf16 v[224:227], v[120:123], v[208:211], v[224:227]
s_add_u32 s82, s82, 0x8000
ds_read_b128 a[160:163], v2 offset:24576
v_mfma_f32_16x16x32_bf16 v[224:227], v[120:123], v[192:195], v[224:227]
s_and_b32 s82, s82, 0x1ffff
v_exp_f32 v164, v164
v_mfma_f32_16x16x32_bf16 v[232:235], v[120:123], v[216:219], v[232:235]
s_add_u32 m0, s74, 0
v_exp_f32 v165, v165
v_mfma_f32_16x16x32_bf16 v[232:235], v[120:123], v[200:203], v[232:235]
s_add_u32 s72, s81, 0
ds_read_b128 a[164:167], v2 offset:25600
v_cvt_pk_bf16_f32 v212, v164, v165
v_mfma_f32_16x16x32_bf16 a[0:3], a[224:227], v[208:211], a[0:3]
v_exp_f32 v166, v166
v_mfma_f32_16x16x32_bf16 a[0:3], a[192:195], v[192:195], a[0:3]
v_exp_f32 v167, v167
v_mfma_f32_16x16x32_bf16 a[64:67], a[192:195], v[200:203], a[64:67]
ds_read_b128 a[168:171], v2 offset:26624
v_cvt_pk_bf16_f32 v213, v166, v167
v_mfma_f32_16x16x32_bf16 a[64:67], a[224:227], v[216:219], a[64:67]
v_exp_f32 v180, v180
v_mfma_f32_16x16x32_bf16 a[68:71], a[228:231], v[216:219], a[68:71]
buffer_load_dwordx4 v1, s[44:47], s72 offen sc1 lds
v_mfma_f32_16x16x32_bf16 a[68:71], a[196:199], v[200:203], a[68:71]
v_exp_f32 v181, v181
v_mfma_f32_16x16x32_bf16 a[4:7], a[196:199], v[192:195], a[4:7]
ds_read_b128 a[172:175], v2 offset:27648
v_cvt_pk_bf16_f32 v214, v180, v181
v_mfma_f32_16x16x32_bf16 a[4:7], a[228:231], v[208:211], a[4:7]
v_exp_f32 v182, v182
v_mfma_f32_16x16x32_bf16 a[8:11], a[232:235], v[208:211], a[8:11]
v_exp_f32 v183, v183
v_mfma_f32_16x16x32_bf16 a[8:11], a[200:203], v[192:195], a[8:11]
ds_read_b128 a[176:179], v2 offset:28672
v_cvt_pk_bf16_f32 v215, v182, v183
v_mfma_f32_16x16x32_bf16 a[72:75], a[200:203], v[200:203], a[72:75]
v_exp_f32 v172, v172
v_mfma_f32_16x16x32_bf16 a[72:75], a[232:235], v[216:219], a[72:75]
v_exp_f32 v173, v173
v_mfma_f32_16x16x32_bf16 a[76:79], a[236:239], v[216:219], a[76:79]
ds_read_b128 a[180:183], v2 offset:29696
v_cvt_pk_bf16_f32 v220, v172, v173
v_mfma_f32_16x16x32_bf16 a[76:79], a[204:207], v[200:203], a[76:79]
v_exp_f32 v174, v174
v_mfma_f32_16x16x32_bf16 a[12:15], a[204:207], v[192:195], a[12:15]
v_exp_f32 v175, v175
v_mfma_f32_16x16x32_bf16 a[12:15], a[236:239], v[208:211], a[12:15]
ds_read_b128 a[184:187], v2 offset:30720
v_cvt_pk_bf16_f32 v221, v174, v175
v_mfma_f32_16x16x32_bf16 a[16:19], a[240:243], v[208:211], a[16:19]
s_waitcnt lgkmcnt(7)
v_exp_f32 v188, v188
v_mfma_f32_16x16x32_bf16 a[16:19], a[208:211], v[192:195], a[16:19]
buffer_load_dwordx4 v1, s[44:47], s72 offen offset:1024 sc1 lds
v_mfma_f32_16x16x32_bf16 a[80:83], a[208:211], v[200:203], a[80:83]
v_exp_f32 v189, v189
v_mfma_f32_16x16x32_bf16 a[80:83], a[240:243], v[216:219], a[80:83]
ds_read_b128 a[188:191], v2 offset:31744
v_cvt_pk_bf16_f32 v222, v188, v189
v_mfma_f32_16x16x32_bf16 a[84:87], a[244:247], v[216:219], a[84:87]
v_exp_f32 v190, v190
v_mfma_f32_16x16x32_bf16 a[84:87], a[212:215], v[200:203], a[84:87]
v_exp_f32 v191, v191
v_mfma_f32_16x16x32_bf16 a[20:23], a[212:215], v[192:195], a[20:23]
ds_read_b128 a[224:227], v2 offset:8192
v_cvt_pk_bf16_f32 v223, v190, v191
v_mfma_f32_16x16x32_bf16 a[20:23], a[244:247], v[208:211], a[20:23]
v_exp_f32 v160, v160
v_mfma_f32_16x16x32_bf16 a[24:27], a[248:251], v[208:211], a[24:27]
v_exp_f32 v161, v161
v_mfma_f32_16x16x32_bf16 a[24:27], a[216:219], v[192:195], a[24:27]
ds_read_b128 a[228:231], v2 offset:9216
v_mfma_f32_16x16x32_bf16 a[88:91], a[216:219], v[200:203], a[88:91]
v_exp_f32 v162, v162
v_mfma_f32_16x16x32_bf16 a[88:91], a[248:251], v[216:219], a[88:91]
v_exp_f32 v163, v163
v_mfma_f32_16x16x32_bf16 a[92:95], a[252:255], v[216:219], a[92:95]
ds_read_b128 a[232:235], v2 offset:10240
v_mfma_f32_16x16x32_bf16 a[92:95], a[220:223], v[200:203], a[92:95]
v_exp_f32 v176, v176
v_mfma_f32_16x16x32_bf16 a[28:31], a[220:223], v[192:195], a[28:31]
buffer_load_dwordx4 v1, s[44:47], s72 offen offset:2048 sc1 lds
v_mfma_f32_16x16x32_bf16 a[28:31], a[252:255], v[208:211], a[28:31]
ds_read_b128 a[236:239], v2 offset:11264
v_cvt_pk_bf16_f32 v208, v160, v161
s_cmp_eq_u32 s58, 0
s_cbranch_scc1 Lta16
s_cmp_eq_u32 s58, 1
s_cbranch_scc1 Lnt17
v_mfma_f32_16x16x32_bf16 v[128:131], a[128:131], v[16:19], v[80:83]
v_exp_f32 v177, v177
v_mfma_f32_16x16x32_bf16 v[144:147], a[144:147], v[16:19], v[80:83]
v_exp_f32 v178, v178
s_branch Ljoin18
Lta16:
v_mfma_f32_16x16x32_bf16 v[128:131], a[128:131], v[16:19], v[96:99]
v_exp_f32 v177, v177
v_mfma_f32_16x16x32_bf16 v[144:147], a[144:147], v[16:19], v[112:115]
v_exp_f32 v178, v178
s_branch Ljoin18
Lnt17:
v_mfma_f32_16x16x32_bf16 v[128:131], a[128:131], v[16:19], v[80:83]
v_exp_f32 v177, v177
v_mfma_f32_16x16x32_bf16 v[144:147], a[144:147], v[16:19], v[96:99]
v_exp_f32 v178, v178
Ljoin18:
v_mfma_f32_16x16x32_bf16 v[128:131], a[132:135], v[20:23], v[128:131]
ds_read_b128 a[240:243], v2 offset:12288
v_cvt_pk_bf16_f32 v209, v162, v163
v_mfma_f32_16x16x32_bf16 v[128:131], a[136:139], v[24:27], v[128:131]
v_exp_f32 v179, v179
v_mfma_f32_16x16x32_bf16 v[128:131], a[140:143], v[28:31], v[128:131]
v_exp_f32 v168, v168
v_mfma_f32_16x16x32_bf16 v[136:139], a[140:143], v[60:63], v[88:91]
ds_read_b128 a[244:247], v2 offset:13312
v_cvt_pk_bf16_f32 v210, v176, v177
v_mfma_f32_16x16x32_bf16 v[136:139], a[136:139], v[56:59], v[136:139]
v_exp_f32 v169, v169
v_mfma_f32_16x16x32_bf16 v[136:139], a[132:135], v[52:55], v[136:139]
v_exp_f32 v170, v170
v_mfma_f32_16x16x32_bf16 v[136:139], a[128:131], v[48:51], v[136:139]
ds_read_b128 a[248:251], v2 offset:14336
v_cvt_pk_bf16_f32 v211, v178, v179
v_mfma_f32_16x16x32_bf16 v[152:155], a[144:147], v[48:51], v[88:91]
v_exp_f32 v171, v171
v_mfma_f32_16x16x32_bf16 v[152:155], a[148:151], v[52:55], v[152:155]
v_exp_f32 v184, v184
v_mfma_f32_16x16x32_bf16 v[152:155], a[152:155], v[56:59], v[152:155]
ds_read_b128 a[252:255], v2 offset:15360
v_cvt_pk_bf16_f32 v216, v168, v169
v_mfma_f32_16x16x32_bf16 v[152:155], a[156:159], v[60:63], v[152:155]
buffer_load_dwordx4 v1, s[44:47], s72 offen offset:3072 sc1 lds
v_mfma_f32_16x16x32_bf16 v[144:147], a[156:159], v[28:31], v[144:147]
v_exp_f32 v185, v185
v_mfma_f32_16x16x32_bf16 v[144:147], a[152:155], v[24:27], v[144:147]
v_exp_f32 v186, v186
v_mfma_f32_16x16x32_bf16 v[144:147], a[148:151], v[20:23], v[144:147]
v_cvt_pk_bf16_f32 v217, v170, v171
v_cvt_pk_bf16_f32 v218, v184, v185
v_mfma_f32_16x16x32_bf16 v[132:135], a[128:131], v[32:35], v[84:87]
v_exp_f32 v187, v187
v_mfma_f32_16x16x32_bf16 v[132:135], a[132:135], v[36:39], v[132:135]
v_cvt_pk_bf16_f32 v219, v186, v187
v_add_u32 v2, s82, v1
v_mfma_f32_16x16x32_bf16 v[132:135], a[136:139], v[40:43], v[132:135]
v_mfma_f32_16x16x32_bf16 v[132:135], a[140:143], v[44:47], v[132:135]
v_mfma_f32_16x16x32_bf16 v[140:143], a[140:143], v[76:79], v[92:95]
v_mfma_f32_16x16x32_bf16 v[140:143], a[136:139], v[72:75], v[140:143]
v_mfma_f32_16x16x32_bf16 v[140:143], a[132:135], v[68:71], v[140:143]
v_mfma_f32_16x16x32_bf16 v[140:143], a[128:131], v[64:67], v[140:143]
v_mfma_f32_16x16x32_bf16 v[156:159], a[144:147], v[64:67], v[92:95]
v_mfma_f32_16x16x32_bf16 v[156:159], a[148:151], v[68:71], v[156:159]
v_mfma_f32_16x16x32_bf16 v[156:159], a[152:155], v[72:75], v[156:159]
v_mfma_f32_16x16x32_bf16 v[156:159], a[156:159], v[76:79], v[156:159]
v_mfma_f32_16x16x32_bf16 v[148:151], a[156:159], v[44:47], v[84:87]
v_mfma_f32_16x16x32_bf16 v[148:151], a[152:155], v[40:43], v[148:151]
v_mfma_f32_16x16x32_bf16 v[148:151], a[148:151], v[36:39], v[148:151]
s_waitcnt vmcnt(8) lgkmcnt(4)
v_mfma_f32_16x16x32_bf16 v[148:151], a[144:147], v[32:35], v[148:151]
s_barrier
v_mfma_f32_16x16x32_bf16 v[228:231], v[120:123], v[196:199], v[228:231]
s_xor_b32 s74, s82, 0x10000
v_exp_f32 v128, v128
v_mfma_f32_16x16x32_bf16 v[228:231], v[120:123], v[212:215], v[228:231]
s_add_u32 s74, s74, s64
ds_read_b128 a[128:131], v2 offset:16384
v_mfma_f32_16x16x32_bf16 v[236:239], v[120:123], v[204:207], v[236:239]
s_add_u32 s81, s81, 0x8000
v_exp_f32 v129, v129
v_mfma_f32_16x16x32_bf16 v[236:239], v[120:123], v[220:223], v[236:239]
s_add_u32 m0, s74, 16384
v_exp_f32 v130, v130
v_mfma_f32_16x16x32_bf16 a[32:35], a[192:195], v[196:199], a[32:35]
s_add_u32 s72, s81, 16384
ds_read_b128 a[132:135], v2 offset:17408
v_cvt_pk_bf16_f32 v192, v128, v129
v_mfma_f32_16x16x32_bf16 a[32:35], a[224:227], v[212:215], a[32:35]
v_exp_f32 v131, v131
v_mfma_f32_16x16x32_bf16 a[96:99], a[224:227], v[220:223], a[96:99]
v_exp_f32 v144, v144
v_mfma_f32_16x16x32_bf16 a[96:99], a[192:195], v[204:207], a[96:99]
ds_read_b128 a[136:139], v2 offset:18432
v_cvt_pk_bf16_f32 v193, v130, v131
v_mfma_f32_16x16x32_bf16 a[100:103], a[196:199], v[204:207], a[100:103]
buffer_load_dwordx4 v1, s[44:47], s72 offen sc1 lds
v_mfma_f32_16x16x32_bf16 a[100:103], a[228:231], v[220:223], a[100:103]
v_exp_f32 v145, v145
v_mfma_f32_16x16x32_bf16 a[36:39], a[228:231], v[212:215], a[36:39]
v_exp_f32 v146, v146
v_mfma_f32_16x16x32_bf16 a[36:39], a[196:199], v[196:199], a[36:39]
ds_read_b128 a[140:143], v2 offset:19456
v_cvt_pk_bf16_f32 v194, v144, v145
v_mfma_f32_16x16x32_bf16 a[40:43], a[200:203], v[196:199], a[40:43]
v_exp_f32 v147, v147
v_mfma_f32_16x16x32_bf16 a[40:43], a[232:235], v[212:215], a[40:43]
v_exp_f32 v136, v136
v_mfma_f32_16x16x32_bf16 a[104:107], a[232:235], v[220:223], a[104:107]
ds_read_b128 a[144:147], v2 offset:20480
v_cvt_pk_bf16_f32 v195, v146, v147
v_mfma_f32_16x16x32_bf16 a[104:107], a[200:203], v[204:207], a[104:107]
v_exp_f32 v137, v137
v_mfma_f32_16x16x32_bf16 a[108:111], a[204:207], v[204:207], a[108:111]
v_exp_f32 v138, v138
v_mfma_f32_16x16x32_bf16 a[108:111], a[236:239], v[220:223], a[108:111]
ds_read_b128 a[148:151], v2 offset:21504
v_cvt_pk_bf16_f32 v200, v136, v137
v_mfma_f32_16x16x32_bf16 a[44:47], a[236:239], v[212:215], a[44:47]
v_exp_f32 v139, v139
v_mfma_f32_16x16x32_bf16 a[44:47], a[204:207], v[196:199], a[44:47]
v_exp_f32 v152, v152
v_mfma_f32_16x16x32_bf16 a[48:51], a[208:211], v[196:199], a[48:51]
s_waitcnt lgkmcnt(6)
ds_read_b128 a[152:155], v2 offset:22528
v_cvt_pk_bf16_f32 v201, v138, v139
v_mfma_f32_16x16x32_bf16 a[48:51], a[240:243], v[212:215], a[48:51]
buffer_load_dwordx4 v1, s[44:47], s72 offen offset:1024 sc1 lds
v_mfma_f32_16x16x32_bf16 a[112:115], a[240:243], v[220:223], a[112:115]
v_exp_f32 v153, v153
v_mfma_f32_16x16x32_bf16 a[112:115], a[208:211], v[204:207], a[112:115]
v_exp_f32 v154, v154
v_mfma_f32_16x16x32_bf16 a[116:119], a[212:215], v[204:207], a[116:119]
ds_read_b128 a[156:159], v2 offset:23552
v_cvt_pk_bf16_f32 v202, v152, v153
v_mfma_f32_16x16x32_bf16 a[116:119], a[244:247], v[220:223], a[116:119]
v_exp_f32 v155, v155
v_mfma_f32_16x16x32_bf16 a[52:55], a[244:247], v[212:215], a[52:55]
v_exp_f32 v132, v132
v_mfma_f32_16x16x32_bf16 a[52:55], a[212:215], v[196:199], a[52:55]
ds_read_b128 a[192:195], v2 offset:0
v_cvt_pk_bf16_f32 v203, v154, v155
v_mfma_f32_16x16x32_bf16 a[56:59], a[216:219], v[196:199], a[56:59]
v_exp_f32 v133, v133
v_mfma_f32_16x16x32_bf16 a[56:59], a[248:251], v[212:215], a[56:59]
v_exp_f32 v134, v134
v_mfma_f32_16x16x32_bf16 a[120:123], a[248:251], v[220:223], a[120:123]
ds_read_b128 a[196:199], v2 offset:1024
v_mfma_f32_16x16x32_bf16 a[120:123], a[216:219], v[204:207], a[120:123]
v_exp_f32 v135, v135
v_mfma_f32_16x16x32_bf16 a[124:127], a[220:223], v[204:207], a[124:127]
v_exp_f32 v148, v148
v_mfma_f32_16x16x32_bf16 a[124:127], a[252:255], v[220:223], a[124:127]
ds_read_b128 a[200:203], v2 offset:2048
v_mfma_f32_16x16x32_bf16 a[60:63], a[252:255], v[212:215], a[60:63]
buffer_load_dwordx4 v1, s[44:47], s72 offen offset:2048 sc1 lds
v_mfma_f32_16x16x32_bf16 a[60:63], a[220:223], v[196:199], a[60:63]
ds_read_b128 a[204:207], v2 offset:3072
v_cvt_pk_bf16_f32 v196, v132, v133
s_cmp_eq_u32 s58, 2
s_cbranch_scc1 Lta19
s_cmp_eq_u32 s58, 3
s_cbranch_scc1 Lnt20
v_mfma_f32_16x16x32_bf16 v[160:163], a[160:163], v[16:19], v[112:115]
v_exp_f32 v149, v149
v_mfma_f32_16x16x32_bf16 v[176:179], a[176:179], v[16:19], v[112:115]
v_exp_f32 v150, v150
s_branch Ljoin21
Lta19:
v_mfma_f32_16x16x32_bf16 v[160:163], a[160:163], v[16:19], v[96:99]
v_exp_f32 v149, v149
v_mfma_f32_16x16x32_bf16 v[176:179], a[176:179], v[16:19], v[112:115]
v_exp_f32 v150, v150
s_branch Ljoin21
Lnt20:
v_mfma_f32_16x16x32_bf16 v[160:163], a[160:163], v[16:19], v[80:83]
v_exp_f32 v149, v149
v_mfma_f32_16x16x32_bf16 v[176:179], a[176:179], v[16:19], v[96:99]
v_exp_f32 v150, v150
Ljoin21:
v_mfma_f32_16x16x32_bf16 v[164:167], a[160:163], v[32:35], v[84:87]
ds_read_b128 a[208:211], v2 offset:4096
v_cvt_pk_bf16_f32 v197, v134, v135
v_mfma_f32_16x16x32_bf16 v[164:167], a[164:167], v[36:39], v[164:167]
v_exp_f32 v151, v151
v_mfma_f32_16x16x32_bf16 v[164:167], a[168:171], v[40:43], v[164:167]
v_exp_f32 v140, v140
v_mfma_f32_16x16x32_bf16 v[164:167], a[172:175], v[44:47], v[164:167]
ds_read_b128 a[212:215], v2 offset:5120
v_cvt_pk_bf16_f32 v198, v148, v149
v_mfma_f32_16x16x32_bf16 v[172:175], a[172:175], v[76:79], v[92:95]
v_exp_f32 v141, v141
v_mfma_f32_16x16x32_bf16 v[172:175], a[168:171], v[72:75], v[172:175]
v_exp_f32 v142, v142
v_mfma_f32_16x16x32_bf16 v[172:175], a[164:167], v[68:71], v[172:175]
ds_read_b128 a[216:219], v2 offset:6144
v_cvt_pk_bf16_f32 v199, v150, v151
v_mfma_f32_16x16x32_bf16 v[172:175], a[160:163], v[64:67], v[172:175]
v_exp_f32 v143, v143
v_mfma_f32_16x16x32_bf16 v[188:191], a[176:179], v[64:67], v[92:95]
v_exp_f32 v156, v156
v_mfma_f32_16x16x32_bf16 v[188:191], a[180:183], v[68:71], v[188:191]
ds_read_b128 a[220:223], v2 offset:7168
v_cvt_pk_bf16_f32 v204, v140, v141
v_mfma_f32_16x16x32_bf16 v[188:191], a[184:187], v[72:75], v[188:191]
buffer_load_dwordx4 v1, s[44:47], s72 offen offset:3072 sc1 lds
v_mfma_f32_16x16x32_bf16 v[188:191], a[188:191], v[76:79], v[188:191]
v_exp_f32 v157, v157
v_mfma_f32_16x16x32_bf16 v[180:183], a[188:191], v[44:47], v[84:87]
v_exp_f32 v158, v158
v_mfma_f32_16x16x32_bf16 v[180:183], a[184:187], v[40:43], v[180:183]
v_cvt_pk_bf16_f32 v205, v142, v143
v_cvt_pk_bf16_f32 v206, v156, v157
v_mfma_f32_16x16x32_bf16 v[180:183], a[180:183], v[36:39], v[180:183]
v_exp_f32 v159, v159
v_mfma_f32_16x16x32_bf16 v[180:183], a[176:179], v[32:35], v[180:183]
v_cvt_pk_bf16_f32 v207, v158, v159
v_mfma_f32_16x16x32_bf16 v[160:163], a[164:167], v[20:23], v[160:163]
v_mfma_f32_16x16x32_bf16 v[160:163], a[168:171], v[24:27], v[160:163]
v_mfma_f32_16x16x32_bf16 v[160:163], a[172:175], v[28:31], v[160:163]
v_mfma_f32_16x16x32_bf16 v[168:171], a[172:175], v[60:63], v[88:91]
v_mfma_f32_16x16x32_bf16 v[168:171], a[168:171], v[56:59], v[168:171]
v_mfma_f32_16x16x32_bf16 v[168:171], a[164:167], v[52:55], v[168:171]
v_mfma_f32_16x16x32_bf16 v[168:171], a[160:163], v[48:51], v[168:171]
v_mfma_f32_16x16x32_bf16 v[184:187], a[176:179], v[48:51], v[88:91]
v_mfma_f32_16x16x32_bf16 v[184:187], a[180:183], v[52:55], v[184:187]
v_mfma_f32_16x16x32_bf16 v[184:187], a[184:187], v[56:59], v[184:187]
v_mfma_f32_16x16x32_bf16 v[184:187], a[188:191], v[60:63], v[184:187]
v_mfma_f32_16x16x32_bf16 v[176:179], a[188:191], v[28:31], v[176:179]
v_mfma_f32_16x16x32_bf16 v[176:179], a[184:187], v[24:27], v[176:179]
v_mfma_f32_16x16x32_bf16 v[176:179], a[180:183], v[20:23], v[176:179]
s_waitcnt lgkmcnt(4)
v_mfma_f32_16x16x32_bf16 v[224:227], v[120:123], v[208:211], v[224:227]
s_add_u32 s82, s82, 0x8000
ds_read_b128 a[160:163], v2 offset:24576
v_mfma_f32_16x16x32_bf16 v[224:227], v[120:123], v[192:195], v[224:227]
s_and_b32 s82, s82, 0x1ffff
v_exp_f32 v164, v164
v_mfma_f32_16x16x32_bf16 v[232:235], v[120:123], v[216:219], v[232:235]
s_add_u32 m0, s74, 0
v_exp_f32 v165, v165
v_mfma_f32_16x16x32_bf16 v[232:235], v[120:123], v[200:203], v[232:235]
s_add_u32 s72, s81, 0
ds_read_b128 a[164:167], v2 offset:25600
v_cvt_pk_bf16_f32 v212, v164, v165
v_mfma_f32_16x16x32_bf16 a[0:3], a[224:227], v[208:211], a[0:3]
v_exp_f32 v166, v166
v_mfma_f32_16x16x32_bf16 a[0:3], a[192:195], v[192:195], a[0:3]
v_exp_f32 v167, v167
v_mfma_f32_16x16x32_bf16 a[64:67], a[192:195], v[200:203], a[64:67]
ds_read_b128 a[168:171], v2 offset:26624
v_cvt_pk_bf16_f32 v213, v166, v167
v_mfma_f32_16x16x32_bf16 a[64:67], a[224:227], v[216:219], a[64:67]
v_exp_f32 v180, v180
v_mfma_f32_16x16x32_bf16 a[68:71], a[228:231], v[216:219], a[68:71]
buffer_load_dwordx4 v1, s[44:47], s72 offen sc1 lds
v_mfma_f32_16x16x32_bf16 a[68:71], a[196:199], v[200:203], a[68:71]
v_exp_f32 v181, v181
v_mfma_f32_16x16x32_bf16 a[4:7], a[196:199], v[192:195], a[4:7]
ds_read_b128 a[172:175], v2 offset:27648
v_cvt_pk_bf16_f32 v214, v180, v181
v_mfma_f32_16x16x32_bf16 a[4:7], a[228:231], v[208:211], a[4:7]
v_exp_f32 v182, v182
v_mfma_f32_16x16x32_bf16 a[8:11], a[232:235], v[208:211], a[8:11]
v_exp_f32 v183, v183
v_mfma_f32_16x16x32_bf16 a[8:11], a[200:203], v[192:195], a[8:11]
ds_read_b128 a[176:179], v2 offset:28672
v_cvt_pk_bf16_f32 v215, v182, v183
v_mfma_f32_16x16x32_bf16 a[72:75], a[200:203], v[200:203], a[72:75]
v_exp_f32 v172, v172
v_mfma_f32_16x16x32_bf16 a[72:75], a[232:235], v[216:219], a[72:75]
v_exp_f32 v173, v173
v_mfma_f32_16x16x32_bf16 a[76:79], a[236:239], v[216:219], a[76:79]
ds_read_b128 a[180:183], v2 offset:29696
v_cvt_pk_bf16_f32 v220, v172, v173
v_mfma_f32_16x16x32_bf16 a[76:79], a[204:207], v[200:203], a[76:79]
v_exp_f32 v174, v174
v_mfma_f32_16x16x32_bf16 a[12:15], a[204:207], v[192:195], a[12:15]
v_exp_f32 v175, v175
v_mfma_f32_16x16x32_bf16 a[12:15], a[236:239], v[208:211], a[12:15]
ds_read_b128 a[184:187], v2 offset:30720
v_cvt_pk_bf16_f32 v221, v174, v175
v_mfma_f32_16x16x32_bf16 a[16:19], a[240:243], v[208:211], a[16:19]
s_waitcnt lgkmcnt(7)
v_exp_f32 v188, v188
v_mfma_f32_16x16x32_bf16 a[16:19], a[208:211], v[192:195], a[16:19]
buffer_load_dwordx4 v1, s[44:47], s72 offen offset:1024 sc1 lds
v_mfma_f32_16x16x32_bf16 a[80:83], a[208:211], v[200:203], a[80:83]
v_exp_f32 v189, v189
v_mfma_f32_16x16x32_bf16 a[80:83], a[240:243], v[216:219], a[80:83]
ds_read_b128 a[188:191], v2 offset:31744
v_cvt_pk_bf16_f32 v222, v188, v189
v_mfma_f32_16x16x32_bf16 a[84:87], a[244:247], v[216:219], a[84:87]
v_exp_f32 v190, v190
v_mfma_f32_16x16x32_bf16 a[84:87], a[212:215], v[200:203], a[84:87]
v_exp_f32 v191, v191
v_mfma_f32_16x16x32_bf16 a[20:23], a[212:215], v[192:195], a[20:23]
ds_read_b128 a[224:227], v2 offset:8192
v_cvt_pk_bf16_f32 v223, v190, v191
v_mfma_f32_16x16x32_bf16 a[20:23], a[244:247], v[208:211], a[20:23]
v_exp_f32 v160, v160
v_mfma_f32_16x16x32_bf16 a[24:27], a[248:251], v[208:211], a[24:27]
v_exp_f32 v161, v161
v_mfma_f32_16x16x32_bf16 a[24:27], a[216:219], v[192:195], a[24:27]
ds_read_b128 a[228:231], v2 offset:9216
v_mfma_f32_16x16x32_bf16 a[88:91], a[216:219], v[200:203], a[88:91]
v_exp_f32 v162, v162
v_mfma_f32_16x16x32_bf16 a[88:91], a[248:251], v[216:219], a[88:91]
Lstub3:
s_cbranch_execz Lstub7
v_exp_f32 v163, v163
v_mfma_f32_16x16x32_bf16 a[92:95], a[252:255], v[216:219], a[92:95]
ds_read_b128 a[232:235], v2 offset:10240
v_mfma_f32_16x16x32_bf16 a[92:95], a[220:223], v[200:203], a[92:95]
v_exp_f32 v176, v176
v_mfma_f32_16x16x32_bf16 a[28:31], a[220:223], v[192:195], a[28:31]
buffer_load_dwordx4 v1, s[44:47], s72 offen offset:2048 sc1 lds
v_mfma_f32_16x16x32_bf16 a[28:31], a[252:255], v[208:211], a[28:31]
ds_read_b128 a[236:239], v2 offset:11264
v_cvt_pk_bf16_f32 v208, v160, v161
s_cmp_eq_u32 s58, 0
s_cbranch_scc1 Lta22
s_cmp_eq_u32 s58, 1
s_cbranch_scc1 Lnt23
v_mfma_f32_16x16x32_bf16 v[132:135], a[128:131], v[32:35], v[84:87]
v_exp_f32 v177, v177
v_mfma_f32_16x16x32_bf16 v[148:151], a[144:147], v[32:35], v[84:87]
v_exp_f32 v178, v178
s_branch Ljoin24
Lta22:
v_mfma_f32_16x16x32_bf16 v[132:135], a[128:131], v[32:35], v[100:103]
v_exp_f32 v177, v177
v_mfma_f32_16x16x32_bf16 v[148:151], a[144:147], v[32:35], v[112:115]
v_exp_f32 v178, v178
s_branch Ljoin24
Lnt23:
v_mfma_f32_16x16x32_bf16 v[132:135], a[128:131], v[32:35], v[84:87]
v_exp_f32 v177, v177
v_mfma_f32_16x16x32_bf16 v[148:151], a[144:147], v[32:35], v[100:103]
v_exp_f32 v178, v178
Ljoin24:
v_mfma_f32_16x16x32_bf16 v[136:139], a[128:131], v[48:51], v[88:91]
ds_read_b128 a[240:243], v2 offset:12288
v_cvt_pk_bf16_f32 v209, v162, v163
v_mfma_f32_16x16x32_bf16 v[136:139], a[132:135], v[52:55], v[136:139]
v_exp_f32 v179, v179
v_mfma_f32_16x16x32_bf16 v[136:139], a[136:139], v[56:59], v[136:139]
v_exp_f32 v168, v168
v_mfma_f32_16x16x32_bf16 v[136:139], a[140:143], v[60:63], v[136:139]
ds_read_b128 a[244:247], v2 offset:13312
v_cvt_pk_bf16_f32 v210, v176, v177
v_mfma_f32_16x16x32_bf16 v[152:155], a[156:159], v[60:63], v[88:91]
v_exp_f32 v169, v169
v_mfma_f32_16x16x32_bf16 v[152:155], a[152:155], v[56:59], v[152:155]
v_exp_f32 v170, v170
v_mfma_f32_16x16x32_bf16 v[152:155], a[148:151], v[52:55], v[152:155]
ds_read_b128 a[248:251], v2 offset:14336
v_cvt_pk_bf16_f32 v211, v178, v179
v_mfma_f32_16x16x32_bf16 v[152:155], a[144:147], v[48:51], v[152:155]
v_exp_f32 v171, v171
v_mfma_f32_16x16x32_bf16 v[132:135], a[132:135], v[36:39], v[132:135]
v_exp_f32 v184, v184
v_mfma_f32_16x16x32_bf16 v[132:135], a[136:139], v[40:43], v[132:135]
ds_read_b128 a[252:255], v2 offset:15360
v_cvt_pk_bf16_f32 v216, v168, v169
v_mfma_f32_16x16x32_bf16 v[132:135], a[140:143], v[44:47], v[132:135]
buffer_load_dwordx4 v1, s[44:47], s72 offen offset:3072 sc1 lds
v_mfma_f32_16x16x32_bf16 v[140:143], a[140:143], v[76:79], v[92:95]
v_exp_f32 v185, v185
v_mfma_f32_16x16x32_bf16 v[140:143], a[136:139], v[72:75], v[140:143]
v_exp_f32 v186, v186
v_mfma_f32_16x16x32_bf16 v[140:143], a[132:135], v[68:71], v[140:143]
v_cvt_pk_bf16_f32 v217, v170, v171
v_cvt_pk_bf16_f32 v218, v184, v185
v_mfma_f32_16x16x32_bf16 v[140:143], a[128:131], v[64:67], v[140:143]
v_exp_f32 v187, v187
v_mfma_f32_16x16x32_bf16 v[156:159], a[144:147], v[64:67], v[92:95]
v_cvt_pk_bf16_f32 v219, v186, v187
v_add_u32 v2, s82, v1
v_mfma_f32_16x16x32_bf16 v[156:159], a[148:151], v[68:71], v[156:159]
v_mfma_f32_16x16x32_bf16 v[156:159], a[152:155], v[72:75], v[156:159]
v_mfma_f32_16x16x32_bf16 v[156:159], a[156:159], v[76:79], v[156:159]
v_mfma_f32_16x16x32_bf16 v[148:151], a[156:159], v[44:47], v[148:151]
v_mfma_f32_16x16x32_bf16 v[148:151], a[152:155], v[40:43], v[148:151]
s_waitcnt vmcnt(8) lgkmcnt(4)
v_mfma_f32_16x16x32_bf16 v[148:151], a[148:151], v[36:39], v[148:151]
s_barrier
s_cmp_eq_u32 s60, 7
s_cbranch_scc1 LLT3x
LLT3:
Lstub4:
s_cbranch_execz Lstub8
v_mfma_f32_16x16x32_bf16 v[228:231], v[120:123], v[196:199], v[228:231]
s_xor_b32 s74, s82, 0x10000
v_exp_f32 v136, v136
v_mfma_f32_16x16x32_bf16 v[228:231], v[120:123], v[212:215], v[228:231]
s_add_u32 s74, s74, s64
ds_read_b128 a[128:131], v2 offset:16384
v_and_b32 v240, 15, v0
v_mfma_f32_16x16x32_bf16 v[236:239], v[120:123], v[204:207], v[236:239]
s_add_u32 s81, s81, 0x8000
v_exp_f32 v137, v137
v_mfma_f32_16x16x32_bf16 v[236:239], v[120:123], v[220:223], v[236:239]
s_add_u32 m0, s74, 16384
ds_read_b128 a[132:135], v2 offset:17408
v_cvt_pk_bf16_f32 v200, v136, v137
v_mfma_f32_16x16x32_bf16 a[32:35], a[192:195], v[196:199], a[32:35]
s_add_u32 s72, s81, 16384
buffer_load_dwordx4 v1, s[44:47], s72 offen sc1 lds
v_mfma_f32_16x16x32_bf16 a[32:35], a[224:227], v[212:215], a[32:35]
s_add_u32 s69, s93, 0x3e00000
v_exp_f32 v138, v138
v_mfma_f32_16x16x32_bf16 a[96:99], a[224:227], v[220:223], a[96:99]
v_exp_f32 v139, v139
v_mfma_f32_16x16x32_bf16 a[96:99], a[192:195], v[204:207], a[96:99]
ds_read_b128 a[136:139], v2 offset:18432
v_cvt_pk_bf16_f32 v201, v138, v139
v_mfma_f32_16x16x32_bf16 a[100:103], a[196:199], v[204:207], a[100:103]
v_exp_f32 v152, v152
v_mfma_f32_16x16x32_bf16 a[100:103], a[228:231], v[220:223], a[100:103]
ds_read_b128 a[140:143], v2 offset:19456
v_lshrrev_b32 v241, 4, v0
v_mfma_f32_16x16x32_bf16 a[36:39], a[228:231], v[212:215], a[36:39]
buffer_store_dwordx4 v[112:115], v1, s[44:47], s69 offen sc1
v_mfma_f32_16x16x32_bf16 a[36:39], a[196:199], v[196:199], a[36:39]
v_exp_f32 v153, v153
v_mfma_f32_16x16x32_bf16 a[40:43], a[200:203], v[196:199], a[40:43]
v_exp_f32 v154, v154
v_mfma_f32_16x16x32_bf16 a[40:43], a[232:235], v[212:215], a[40:43]
ds_read_b128 a[144:147], v2 offset:20480
v_cvt_pk_bf16_f32 v202, v152, v153
v_mfma_f32_16x16x32_bf16 a[104:107], a[232:235], v[220:223], a[104:107]
v_exp_f32 v155, v155
v_mfma_f32_16x16x32_bf16 a[104:107], a[200:203], v[204:207], a[104:107]
ds_read_b128 a[148:151], v2 offset:21504
v_cvt_pk_bf16_f32 v203, v154, v155
v_mfma_f32_16x16x32_bf16 a[108:111], a[204:207], v[204:207], a[108:111]
buffer_load_dwordx4 v1, s[44:47], s72 offen offset:1024 sc1 lds
v_mfma_f32_16x16x32_bf16 a[108:111], a[236:239], v[220:223], a[108:111]
v_exp_f32 v132, v132
v_mfma_f32_16x16x32_bf16 a[44:47], a[236:239], v[212:215], a[44:47]
v_exp_f32 v133, v133
v_mfma_f32_16x16x32_bf16 a[44:47], a[204:207], v[196:199], a[44:47]
ds_read_b128 a[152:155], v2 offset:22528
v_add_u32 v248, 1, v240
v_mfma_f32_16x16x32_bf16 a[48:51], a[208:211], v[196:199], a[48:51]
s_waitcnt lgkmcnt(7)
v_exp_f32 v134, v134
v_mfma_f32_16x16x32_bf16 a[48:51], a[240:243], v[212:215], a[48:51]
ds_read_b128 a[156:159], v2 offset:23552
v_and_b32 v249, 3, v248
v_mfma_f32_16x16x32_bf16 a[112:115], a[240:243], v[220:223], a[112:115]
buffer_store_dwordx4 v[112:115], v1, s[44:47], s69 offen offset:1024 sc1
v_mfma_f32_16x16x32_bf16 a[112:115], a[208:211], v[204:207], a[112:115]
v_exp_f32 v135, v135
v_mfma_f32_16x16x32_bf16 a[116:119], a[212:215], v[204:207], a[116:119]
v_exp_f32 v148, v148
v_mfma_f32_16x16x32_bf16 a[116:119], a[244:247], v[220:223], a[116:119]
ds_read_b128 a[192:195], v2 offset:0
v_lshrrev_b32 v248, 2, v248
v_mfma_f32_16x16x32_bf16 a[52:55], a[244:247], v[212:215], a[52:55]
v_exp_f32 v149, v149
v_mfma_f32_16x16x32_bf16 a[52:55], a[212:215], v[196:199], a[52:55]
ds_read_b128 a[196:199], v2 offset:1024
v_mov_b32 v250, 0x20000
v_mfma_f32_16x16x32_bf16 a[56:59], a[216:219], v[196:199], a[56:59]
buffer_load_dwordx4 v1, s[44:47], s72 offen offset:2048 sc1 lds
v_mfma_f32_16x16x32_bf16 a[56:59], a[248:251], v[212:215], a[56:59]
v_exp_f32 v150, v150
v_mfma_f32_16x16x32_bf16 a[120:123], a[248:251], v[220:223], a[120:123]
v_exp_f32 v151, v151
v_mfma_f32_16x16x32_bf16 a[120:123], a[216:219], v[204:207], a[120:123]
ds_read_b128 a[200:203], v2 offset:2048
v_mov_b32 v252, 0x20001
v_mfma_f32_16x16x32_bf16 a[124:127], a[220:223], v[204:207], a[124:127]
v_exp_f32 v140, v140
v_mfma_f32_16x16x32_bf16 a[124:127], a[252:255], v[220:223], a[124:127]
ds_read_b128 a[204:207], v2 offset:3072
v_lshlrev_b32 v6, 3, v249
v_mfma_f32_16x16x32_bf16 a[60:63], a[252:255], v[212:215], a[60:63]
buffer_store_dwordx4 v[112:115], v1, s[44:47], s69 offen offset:2048 sc1
v_mfma_f32_16x16x32_bf16 a[60:63], a[220:223], v[196:199], a[60:63]
ds_read_b128 a[208:211], v2 offset:4096
v_cvt_pk_bf16_f32 v196, v132, v133
s_cmp_eq_u32 s58, 2
s_cbranch_scc1 Lta25
s_cmp_eq_u32 s58, 3
s_cbranch_scc1 Lnt26
v_mfma_f32_16x16x32_bf16 v[164:167], a[160:163], v[32:35], v[112:115]
ds_read_b128 a[212:215], v2 offset:5120
v_cvt_pk_bf16_f32 v197, v134, v135
v_mfma_f32_16x16x32_bf16 v[180:183], a[176:179], v[32:35], v[112:115]
ds_read_b128 a[216:219], v2 offset:6144
v_cvt_pk_bf16_f32 v198, v148, v149
s_branch Ljoin27
Lta25:
v_mfma_f32_16x16x32_bf16 v[164:167], a[160:163], v[32:35], v[100:103]
ds_read_b128 a[212:215], v2 offset:5120
v_cvt_pk_bf16_f32 v197, v134, v135
v_mfma_f32_16x16x32_bf16 v[180:183], a[176:179], v[32:35], v[112:115]
ds_read_b128 a[216:219], v2 offset:6144
v_cvt_pk_bf16_f32 v198, v148, v149
s_branch Ljoin27
Lnt26:
v_mfma_f32_16x16x32_bf16 v[164:167], a[160:163], v[32:35], v[84:87]
ds_read_b128 a[212:215], v2 offset:5120
v_cvt_pk_bf16_f32 v197, v134, v135
v_mfma_f32_16x16x32_bf16 v[180:183], a[176:179], v[32:35], v[100:103]
ds_read_b128 a[216:219], v2 offset:6144
v_cvt_pk_bf16_f32 v198, v148, v149
Ljoin27:
v_mfma_f32_16x16x32_bf16 v[164:167], a[164:167], v[36:39], v[164:167]
v_exp_f32 v141, v141
v_mfma_f32_16x16x32_bf16 v[164:167], a[168:171], v[40:43], v[164:167]
v_exp_f32 v142, v142
v_mfma_f32_16x16x32_bf16 v[164:167], a[172:175], v[44:47], v[164:167]
ds_read_b128 a[220:223], v2 offset:7168
v_cvt_pk_bf16_f32 v199, v150, v151
v_mfma_f32_16x16x32_bf16 v[172:175], a[172:175], v[76:79], v[92:95]
v_exp_f32 v143, v143
v_mfma_f32_16x16x32_bf16 v[172:175], a[168:171], v[72:75], v[172:175]
buffer_load_dwordx4 v1, s[44:47], s72 offen offset:3072 sc1 lds
v_mfma_f32_16x16x32_bf16 v[172:175], a[164:167], v[68:71], v[172:175]
v_exp_f32 v156, v156
v_mfma_f32_16x16x32_bf16 v[172:175], a[160:163], v[64:67], v[172:175]
v_cvt_pk_bf16_f32 v204, v140, v141
v_cvt_pk_bf16_f32 v205, v142, v143
v_mfma_f32_16x16x32_bf16 v[188:191], a[176:179], v[64:67], v[92:95]
v_exp_f32 v157, v157
v_mfma_f32_16x16x32_bf16 v[188:191], a[180:183], v[68:71], v[188:191]
v_exp_f32 v158, v158
v_mfma_f32_16x16x32_bf16 v[188:191], a[184:187], v[72:75], v[188:191]
buffer_store_dwordx4 v[112:115], v1, s[44:47], s69 offen offset:3072 sc1
v_mfma_f32_16x16x32_bf16 v[188:191], a[188:191], v[76:79], v[188:191]
v_exp_f32 v159, v159
v_mfma_f32_16x16x32_bf16 v[180:183], a[188:191], v[44:47], v[180:183]
v_cvt_pk_bf16_f32 v206, v156, v157
v_cvt_pk_bf16_f32 v207, v158, v159
v_mfma_f32_16x16x32_bf16 v[180:183], a[184:187], v[40:43], v[180:183]
v_lshrrev_b32 v6, v6, v252
v_and_b32 v6, 3, v6
v_mfma_f32_16x16x32_bf16 v[180:183], a[180:183], v[36:39], v[180:183]
v_cmp_ne_u32 vcc, 1, v249
v_mul_u32_u24 v6, 16640, v6
v_mfma_f32_16x16x32_bf16 v[168:171], a[160:163], v[48:51], v[88:91]
v_add_u32 v6, s92, v6
v_cndmask_b32 v6, v250, v6, vcc
v_mfma_f32_16x16x32_bf16 v[168:171], a[164:167], v[52:55], v[168:171]
v_add_u32 v253, s58, v249
v_and_b32 v253, 3, v253
v_mfma_f32_16x16x32_bf16 v[168:171], a[168:171], v[56:59], v[168:171]
v_mul_u32_u24 v253, 4160, v253
v_add_u32 v6, v6, v253
v_mfma_f32_16x16x32_bf16 v[168:171], a[172:175], v[60:63], v[168:171]
v_bfe_u32 v251, v0, 2, 2
v_lshl_add_u32 v6, v248, 3, v6
v_mfma_f32_16x16x32_bf16 v[184:187], a[188:191], v[60:63], v[88:91]
v_lshl_add_u32 v6, v241, 4, v6
v_lshlrev_b32 v5, 3, v251
v_mfma_f32_16x16x32_bf16 v[184:187], a[184:187], v[56:59], v[184:187]
v_lshrrev_b32 v5, v5, v252
v_and_b32 v5, 3, v5
v_mfma_f32_16x16x32_bf16 v[184:187], a[180:183], v[52:55], v[184:187]
v_cmp_ne_u32 vcc, 1, v251
v_mul_u32_u24 v5, 16640, v5
v_mfma_f32_16x16x32_bf16 v[184:187], a[176:179], v[48:51], v[184:187]
s_waitcnt lgkmcnt(4)
v_mfma_f32_16x16x32_bf16 v[224:227], v[120:123], v[208:211], v[224:227]
s_add_u32 s82, s82, 0x8000
ds_read_b128 a[160:163], v2 offset:24576
ds_read_b128 a[164:167], v2 offset:25600
v_mfma_f32_16x16x32_bf16 v[232:235], v[120:123], v[216:219], v[232:235]
s_and_b32 s82, s82, 0x1ffff
v_exp_f32 v164, v164
v_mfma_f32_16x16x32_bf16 v[232:235], v[120:123], v[200:203], v[232:235]
s_add_u32 m0, s74, 0
v_exp_f32 v165, v165
v_mfma_f32_16x16x32_bf16 a[0:3], a[224:227], v[208:211], a[0:3]
s_add_u32 s72, s81, 0
v_exp_f32 v166, v166
v_mfma_f32_16x16x32_bf16 a[64:67], a[192:195], v[200:203], a[64:67]
ds_read_b128 a[168:171], v2 offset:26624
v_cvt_pk_bf16_f32 v212, v164, v165
v_mfma_f32_16x16x32_bf16 a[64:67], a[224:227], v[216:219], a[64:67]
v_exp_f32 v167, v167
v_mfma_f32_16x16x32_bf16 a[68:71], a[228:231], v[216:219], a[68:71]
buffer_load_dwordx4 v1, s[44:47], s72 offen sc1 lds
v_mfma_f32_16x16x32_bf16 a[68:71], a[196:199], v[200:203], a[68:71]
v_exp_f32 v180, v180
v_mfma_f32_16x16x32_bf16 a[4:7], a[228:231], v[208:211], a[4:7]
ds_read_b128 a[172:175], v2 offset:27648
v_cvt_pk_bf16_f32 v213, v166, v167
v_mfma_f32_16x16x32_bf16 a[8:11], a[232:235], v[208:211], a[8:11]
v_exp_f32 v181, v181
v_mfma_f32_16x16x32_bf16 a[72:75], a[200:203], v[200:203], a[72:75]
ds_read_b128 a[176:179], v2 offset:28672
v_cvt_pk_bf16_f32 v214, v180, v181
v_mfma_f32_16x16x32_bf16 a[72:75], a[232:235], v[216:219], a[72:75]
v_exp_f32 v182, v182
v_mfma_f32_16x16x32_bf16 a[76:79], a[236:239], v[216:219], a[76:79]
v_exp_f32 v183, v183
v_mfma_f32_16x16x32_bf16 a[76:79], a[204:207], v[200:203], a[76:79]
ds_read_b128 a[180:183], v2 offset:29696
v_cvt_pk_bf16_f32 v215, v182, v183
v_mfma_f32_16x16x32_bf16 a[12:15], a[236:239], v[208:211], a[12:15]
v_exp_f32 v172, v172
v_mfma_f32_16x16x32_bf16 a[16:19], a[240:243], v[208:211], a[16:19]
s_waitcnt lgkmcnt(6)
ds_read_b128 a[184:187], v2 offset:30720
ds_read_b128 a[188:191], v2 offset:31744
v_mfma_f32_16x16x32_bf16 a[80:83], a[208:211], v[200:203], a[80:83]
v_exp_f32 v173, v173
v_mfma_f32_16x16x32_bf16 a[80:83], a[240:243], v[216:219], a[80:83]
buffer_load_dwordx4 v1, s[44:47], s72 offen offset:1024 sc1 lds
v_mfma_f32_16x16x32_bf16 a[84:87], a[244:247], v[216:219], a[84:87]
v_exp_f32 v174, v174
v_mfma_f32_16x16x32_bf16 a[84:87], a[212:215], v[200:203], a[84:87]
v_exp_f32 v175, v175
v_mfma_f32_16x16x32_bf16 a[20:23], a[244:247], v[208:211], a[20:23]
ds_read_b128 a[224:227], v2 offset:8192
v_cvt_pk_bf16_f32 v220, v172, v173
v_mfma_f32_16x16x32_bf16 a[24:27], a[248:251], v[208:211], a[24:27]
v_exp_f32 v188, v188
v_mfma_f32_16x16x32_bf16 a[88:91], a[216:219], v[200:203], a[88:91]
v_exp_f32 v189, v189
v_mfma_f32_16x16x32_bf16 a[88:91], a[248:251], v[216:219], a[88:91]
ds_read_b128 a[228:231], v2 offset:9216
v_cvt_pk_bf16_f32 v221, v174, v175
v_mfma_f32_16x16x32_bf16 a[92:95], a[252:255], v[216:219], a[92:95]
v_exp_f32 v190, v190
v_mfma_f32_16x16x32_bf16 a[92:95], a[220:223], v[200:203], a[92:95]
ds_read_b128 a[232:235], v2 offset:10240
v_cvt_pk_bf16_f32 v222, v188, v189
v_mfma_f32_16x16x32_bf16 a[28:31], a[252:255], v[208:211], a[28:31]
v_exp_f32 v191, v191
v_mfma_f32_16x16x32_bf16 v[136:139], a[128:131], v[48:51], v[88:91]
buffer_load_dwordx4 v1, s[44:47], s72 offen offset:2048 sc1 lds
v_mfma_f32_16x16x32_bf16 v[136:139], a[132:135], v[52:55], v[136:139]
v_exp_f32 v168, v168
v_mfma_f32_16x16x32_bf16 v[136:139], a[136:139], v[56:59], v[136:139]
ds_read_b128 a[236:239], v2 offset:11264
v_cvt_pk_bf16_f32 v223, v190, v191
v_mfma_f32_16x16x32_bf16 v[136:139], a[140:143], v[60:63], v[136:139]
v_exp_f32 v169, v169
v_mfma_f32_16x16x32_bf16 v[152:155], a[156:159], v[60:63], v[88:91]
ds_read_b128 a[240:243], v2 offset:12288
v_cvt_pk_bf16_f32 v216, v168, v169
v_mfma_f32_16x16x32_bf16 v[152:155], a[152:155], v[56:59], v[152:155]
v_exp_f32 v170, v170
v_mfma_f32_16x16x32_bf16 v[152:155], a[148:151], v[52:55], v[152:155]
v_exp_f32 v171, v171
v_mfma_f32_16x16x32_bf16 v[152:155], a[144:147], v[48:51], v[152:155]
ds_read_b128 a[244:247], v2 offset:13312
v_cvt_pk_bf16_f32 v217, v170, v171
v_mfma_f32_16x16x32_bf16 v[140:143], a[128:131], v[64:67], v[92:95]
v_exp_f32 v184, v184
v_mfma_f32_16x16x32_bf16 v[140:143], a[132:135], v[68:71], v[140:143]
ds_read_b128 a[248:251], v2 offset:14336
v_mfma_f32_16x16x32_bf16 v[140:143], a[136:139], v[72:75], v[140:143]
v_exp_f32 v185, v185
v_mfma_f32_16x16x32_bf16 v[140:143], a[140:143], v[76:79], v[140:143]
buffer_load_dwordx4 v1, s[44:47], s72 offen offset:3072 sc1 lds
v_mfma_f32_16x16x32_bf16 v[156:159], a[156:159], v[76:79], v[92:95]
ds_read_b128 a[252:255], v2 offset:15360
v_cvt_pk_bf16_f32 v218, v184, v185
v_mfma_f32_16x16x32_bf16 v[156:159], a[152:155], v[72:75], v[156:159]
v_exp_f32 v186, v186
v_mfma_f32_16x16x32_bf16 v[156:159], a[148:151], v[68:71], v[156:159]
s_waitcnt vmcnt(12) lgkmcnt(4)
v_exp_f32 v187, v187
v_mfma_f32_16x16x32_bf16 v[156:159], a[144:147], v[64:67], v[156:159]
s_barrier
v_cvt_pk_bf16_f32 v219, v186, v187
v_add_u32 v2, s82, v1
v_mfma_f32_16x16x32_bf16 v[228:231], v[120:123], v[196:199], v[228:231]
s_xor_b32 s74, s82, 0x10000
v_exp_f32 v136, v136
v_mfma_f32_16x16x32_bf16 v[228:231], v[120:123], v[212:215], v[228:231]
s_add_u32 s74, s74, s64
ds_read_b128 a[128:131], v2 offset:16384
v_add_u32 v5, s92, v5
v_mfma_f32_16x16x32_bf16 v[236:239], v[120:123], v[204:207], v[236:239]
s_add_u32 s81, s81, 0x8000
v_exp_f32 v137, v137
v_mfma_f32_16x16x32_bf16 v[236:239], v[120:123], v[220:223], v[236:239]
s_add_u32 m0, s74, 16384
ds_read_b128 a[132:135], v2 offset:17408
v_cvt_pk_bf16_f32 v200, v136, v137
v_mfma_f32_16x16x32_bf16 a[32:35], a[192:195], v[196:199], a[32:35]
s_add_u32 s72, s81, 16384
buffer_load_dwordx4 v1, s[44:47], s72 offen sc1 lds
v_mfma_f32_16x16x32_bf16 a[32:35], a[224:227], v[212:215], a[32:35]
s_add_u32 s69, s93, 0x4200000
v_exp_f32 v138, v138
v_mfma_f32_16x16x32_bf16 a[96:99], a[224:227], v[220:223], a[96:99]
ds_read_b128 a[136:139], v2 offset:18432
v_cndmask_b32 v5, v250, v5, vcc
v_mfma_f32_16x16x32_bf16 a[96:99], a[192:195], v[204:207], a[96:99]
v_exp_f32 v139, v139
v_mfma_f32_16x16x32_bf16 a[100:103], a[196:199], v[204:207], a[100:103]
ds_read_b128 a[140:143], v2 offset:19456
v_cvt_pk_bf16_f32 v201, v138, v139
v_mfma_f32_16x16x32_bf16 a[100:103], a[228:231], v[220:223], a[100:103]
buffer_store_dwordx4 v[112:115], v1, s[44:47], s69 offen sc1
v_mfma_f32_16x16x32_bf16 a[36:39], a[228:231], v[212:215], a[36:39]
v_exp_f32 v152, v152
v_mfma_f32_16x16x32_bf16 a[36:39], a[196:199], v[196:199], a[36:39]
ds_read_b128 a[144:147], v2 offset:20480
v_add_u32 v253, s58, v251
v_mfma_f32_16x16x32_bf16 a[40:43], a[200:203], v[196:199], a[40:43]
v_exp_f32 v153, v153
v_mfma_f32_16x16x32_bf16 a[40:43], a[232:235], v[212:215], a[40:43]
ds_read_b128 a[148:151], v2 offset:21504
v_cvt_pk_bf16_f32 v202, v152, v153
v_mfma_f32_16x16x32_bf16 a[104:107], a[232:235], v[220:223], a[104:107]
buffer_load_dwordx4 v1, s[44:47], s72 offen offset:1024 sc1 lds
v_mfma_f32_16x16x32_bf16 a[104:107], a[200:203], v[204:207], a[104:107]
v_exp_f32 v154, v154
v_mfma_f32_16x16x32_bf16 a[108:111], a[204:207], v[204:207], a[108:111]
ds_read_b128 a[152:155], v2 offset:22528
v_and_b32 v253, 3, v253
v_mfma_f32_16x16x32_bf16 a[108:111], a[236:239], v[220:223], a[108:111]
v_exp_f32 v155, v155
v_mfma_f32_16x16x32_bf16 a[44:47], a[236:239], v[212:215], a[44:47]
ds_read_b128 a[156:159], v2 offset:23552
v_cvt_pk_bf16_f32 v203, v154, v155
v_mfma_f32_16x16x32_bf16 a[44:47], a[204:207], v[196:199], a[44:47]
buffer_store_dwordx4 v[112:115], v1, s[44:47], s69 offen offset:1024 sc1
v_mfma_f32_16x16x32_bf16 a[48:51], a[208:211], v[196:199], a[48:51]
s_waitcnt lgkmcnt(8)
v_exp_f32 v140, v140
v_mfma_f32_16x16x32_bf16 a[48:51], a[240:243], v[212:215], a[48:51]
ds_read_b128 a[192:195], v2 offset:0
v_mul_u32_u24 v253, 4160, v253
v_mfma_f32_16x16x32_bf16 a[112:115], a[240:243], v[220:223], a[112:115]
v_exp_f32 v141, v141
v_mfma_f32_16x16x32_bf16 a[112:115], a[208:211], v[204:207], a[112:115]
ds_read_b128 a[196:199], v2 offset:1024
v_add_u32 v5, v5, v253
v_mfma_f32_16x16x32_bf16 a[116:119], a[212:215], v[204:207], a[116:119]
s_add_u32 s73, s62, 480
buffer_load_dwordx4 v1, s[44:47], s72 offen offset:2048 sc1 lds
v_mfma_f32_16x16x32_bf16 a[116:119], a[244:247], v[220:223], a[116:119]
v_exp_f32 v142, v142
v_mfma_f32_16x16x32_bf16 a[52:55], a[244:247], v[212:215], a[52:55]
ds_read_b128 a[200:203], v2 offset:2048
v_lshlrev_b32 v248, 5, v240
v_mfma_f32_16x16x32_bf16 a[52:55], a[212:215], v[196:199], a[52:55]
v_exp_f32 v143, v143
v_mfma_f32_16x16x32_bf16 a[56:59], a[216:219], v[196:199], a[56:59]
ds_read_b128 a[204:207], v2 offset:3072
v_sub_u32 v248, s73, v248
v_mfma_f32_16x16x32_bf16 a[56:59], a[248:251], v[212:215], a[56:59]
buffer_store_dwordx4 v[112:115], v1, s[44:47], s69 offen offset:2048 sc1
v_mfma_f32_16x16x32_bf16 a[120:123], a[248:251], v[220:223], a[120:123]
v_exp_f32 v156, v156
v_mfma_f32_16x16x32_bf16 a[120:123], a[216:219], v[204:207], a[120:123]
ds_read_b128 a[208:211], v2 offset:4096
v_lshl_add_u32 v7, v241, 4, v248
v_mfma_f32_16x16x32_bf16 a[124:127], a[220:223], v[204:207], a[124:127]
s_and_b32 s73, s58, 1
v_exp_f32 v157, v157
v_mfma_f32_16x16x32_bf16 a[124:127], a[252:255], v[220:223], a[124:127]
s_lshl_b32 s73, s73, 4
ds_read_b128 a[212:215], v2 offset:5120
v_mfma_f32_16x16x32_bf16 a[60:63], a[252:255], v[212:215], a[60:63]
s_lshr_b32 s73, s90, s73
buffer_load_dwordx4 v1, s[44:47], s72 offen offset:3072 sc1 lds
v_mfma_f32_16x16x32_bf16 a[60:63], a[220:223], v[196:199], a[60:63]
s_and_b32 s73, s73, 0xffff
ds_read_b128 a[216:219], v2 offset:6144
v_cvt_pk_bf16_f32 v204, v140, v141
v_mfma_f32_16x16x32_bf16 v[172:175], a[160:163], v[64:67], v[92:95]
v_exp_f32 v158, v158
v_mfma_f32_16x16x32_bf16 v[172:175], a[164:167], v[68:71], v[172:175]
ds_read_b128 a[220:223], v2 offset:7168
v_cvt_pk_bf16_f32 v205, v142, v143
v_mfma_f32_16x16x32_bf16 v[172:175], a[168:171], v[72:75], v[172:175]
v_exp_f32 v159, v159
v_mfma_f32_16x16x32_bf16 v[172:175], a[172:175], v[76:79], v[172:175]
buffer_store_dwordx4 v[112:115], v1, s[44:47], s69 offen offset:3072 sc1
v_mfma_f32_16x16x32_bf16 v[188:191], a[188:191], v[76:79], v[92:95]
v_cvt_pk_bf16_f32 v206, v156, v157
v_cvt_pk_bf16_f32 v207, v158, v159
v_mfma_f32_16x16x32_bf16 v[188:191], a[184:187], v[72:75], v[188:191]
v_lshl_add_u32 v248, v241, 3, v240
v_sub_u32 v248, 15, v248
v_mfma_f32_16x16x32_bf16 v[188:191], a[180:183], v[68:71], v[188:191]
v_and_b32 v249, 1, v248
v_lshlrev_b32 v249, 4, v249
v_mfma_f32_16x16x32_bf16 v[188:191], a[176:179], v[64:67], v[188:191]
v_lshlrev_b32 v249, v249, s73
v_lshrrev_b32 v248, 1, v248
v_mfma_f32_16x16x32_bf16 v[168:171], a[160:163], v[48:51], v[88:91]
v_and_b32 v241, 3, v0
v_cmp_eq_u32 vcc, 0, v248
v_mfma_f32_16x16x32_bf16 v[168:171], a[164:167], v[52:55], v[168:171]
v_lshl_add_u32 v5, v241, 3, v5
v_cndmask_b32 v8, 0, v249, vcc
v_mfma_f32_16x16x32_bf16 v[168:171], a[168:171], v[56:59], v[168:171]
v_cmp_eq_u32 vcc, 1, v248
v_lshlrev_b32 v240, 4, v251
v_mfma_f32_16x16x32_bf16 v[168:171], a[172:175], v[60:63], v[168:171]
v_cndmask_b32 v9, 0, v249, vcc
v_cmp_eq_u32 vcc, 2, v248
v_mfma_f32_16x16x32_bf16 v[184:187], a[188:191], v[60:63], v[88:91]
v_sub_u32 v240, 48, v240
v_lshlrev_b64 v[12:13], 16, s[88:89]
v_mfma_f32_16x16x32_bf16 v[184:187], a[184:187], v[56:59], v[184:187]
v_cndmask_b32 v10, 0, v249, vcc
v_cmp_eq_u32 vcc, 3, v248
v_mfma_f32_16x16x32_bf16 v[184:187], a[180:183], v[52:55], v[184:187]
v_lshlrev_b64 v[12:13], v240, v[12:13]
v_cndmask_b32 v11, 0, v249, vcc
v_mfma_f32_16x16x32_bf16 v[184:187], a[176:179], v[48:51], v[184:187]
s_waitcnt lgkmcnt(4)
v_cmp_eq_u32 vcc, 3, v241
s_add_u32 s73, s62, 4096
v_lshl_add_u32 v14, v0, 3, s73
v_cndmask_b32 v12, 0, v12, vcc
v_cndmask_b32 v13, 0, v13, vcc
v_lshrrev_b32 v15, 4, v0
v_lshlrev_b32 v15, 1, v15
v_and_b32 v240, 7, v0
v_xor_b32 v15, v15, v240
v_lshlrev_b32 v15, 4, v15
v_lshrrev_b32 v240, 3, v0
v_lshl_add_u32 v15, v240, 11, v15
s_lshr_b32 s75, s59, 1
s_and_b32 s75, s75, 8
s_add_u32 s75, s75, s60
s_lshl_b32 s76, s65, 2
s_lshr_b32 s80, s59, 2
s_and_b32 s80, s80, 3
s_add_u32 s76, s76, s80
s_lshl_b32 s94, s58, 16
s_lshl_b32 s80, s76, 7
s_add_u32 s94, s94, s80
s_lshl_b32 s80, s75, 18
s_add_u32 s80, s80, s94
v_rcp_f32 v224, v224
v_rcp_f32 v228, v228
s_lshl_b32 s73, s52, 12
s_add_u32 s73, s73, 0x2000000
s_lshl_b32 s70, s67, 2
s_add_u32 s70, s70, s73
v_mov_b32 v225, v224
v_accvgpr_read_b32 v240, a0
v_accvgpr_read_b32 v241, a1
v_accvgpr_read_b32 v242, a2
v_accvgpr_read_b32 v243, a3
v_accvgpr_read_b32 v244, a4
v_accvgpr_read_b32 v245, a5
v_accvgpr_read_b32 v246, a6
v_accvgpr_read_b32 v247, a7
v_pk_mul_f32 v[240:241], v[240:241], v[224:225]
v_pk_mul_f32 v[242:243], v[242:243], v[224:225]
v_pk_mul_f32 v[244:245], v[244:245], v[224:225]
v_pk_mul_f32 v[246:247], v[246:247], v[224:225]
v_cvt_pk_bf16_f32 v128, v240, v241
v_cvt_pk_bf16_f32 v129, v242, v243
v_cvt_pk_bf16_f32 v130, v244, v245
v_cvt_pk_bf16_f32 v131, v246, v247
v_accvgpr_read_b32 v248, a8
v_accvgpr_read_b32 v249, a9
v_accvgpr_read_b32 v250, a10
v_accvgpr_read_b32 v251, a11
v_accvgpr_read_b32 v252, a12
v_accvgpr_read_b32 v253, a13
v_accvgpr_read_b32 v254, a14
v_accvgpr_read_b32 v255, a15
v_pk_mul_f32 v[248:249], v[248:249], v[224:225]
v_pk_mul_f32 v[250:251], v[250:251], v[224:225]
v_pk_mul_f32 v[252:253], v[252:253], v[224:225]
v_pk_mul_f32 v[254:255], v[254:255], v[224:225]
v_cvt_pk_bf16_f32 v144, v248, v249
v_cvt_pk_bf16_f32 v145, v250, v251
v_cvt_pk_bf16_f32 v146, v252, v253
v_cvt_pk_bf16_f32 v147, v254, v255
v_accvgpr_read_b32 v240, a16
v_accvgpr_read_b32 v241, a17
v_accvgpr_read_b32 v242, a18
v_accvgpr_read_b32 v243, a19
v_accvgpr_read_b32 v244, a20
v_accvgpr_read_b32 v245, a21
v_accvgpr_read_b32 v246, a22
v_accvgpr_read_b32 v247, a23
v_pk_mul_f32 v[240:241], v[240:241], v[224:225]
v_pk_mul_f32 v[242:243], v[242:243], v[224:225]
v_pk_mul_f32 v[244:245], v[244:245], v[224:225]
v_pk_mul_f32 v[246:247], v[246:247], v[224:225]
v_cvt_pk_bf16_f32 v160, v240, v241
v_cvt_pk_bf16_f32 v161, v242, v243
v_cvt_pk_bf16_f32 v162, v244, v245
v_cvt_pk_bf16_f32 v163, v246, v247
v_accvgpr_read_b32 v248, a24
v_accvgpr_read_b32 v249, a25
v_accvgpr_read_b32 v250, a26
v_accvgpr_read_b32 v251, a27
v_accvgpr_read_b32 v252, a28
v_accvgpr_read_b32 v253, a29
v_accvgpr_read_b32 v254, a30
v_accvgpr_read_b32 v255, a31
v_pk_mul_f32 v[248:249], v[248:249], v[224:225]
v_pk_mul_f32 v[250:251], v[250:251], v[224:225]
v_pk_mul_f32 v[252:253], v[252:253], v[224:225]
v_pk_mul_f32 v[254:255], v[254:255], v[224:225]
v_cvt_pk_bf16_f32 v176, v248, v249
v_cvt_pk_bf16_f32 v177, v250, v251
v_cvt_pk_bf16_f32 v178, v252, v253
v_cvt_pk_bf16_f32 v179, v254, v255
v_mov_b32 v229, v228
v_accvgpr_read_b32 v240, a32
v_accvgpr_read_b32 v241, a33
v_accvgpr_read_b32 v242, a34
v_accvgpr_read_b32 v243, a35
v_accvgpr_read_b32 v244, a36
v_accvgpr_read_b32 v245, a37
v_accvgpr_read_b32 v246, a38
v_accvgpr_read_b32 v247, a39
v_pk_mul_f32 v[240:241], v[240:241], v[228:229]
v_pk_mul_f32 v[242:243], v[242:243], v[228:229]
v_pk_mul_f32 v[244:245], v[244:245], v[228:229]
v_pk_mul_f32 v[246:247], v[246:247], v[228:229]
v_cvt_pk_bf16_f32 v132, v240, v241
Lstub5:
s_cbranch_execz Lstub9
v_cvt_pk_bf16_f32 v133, v242, v243
v_cvt_pk_bf16_f32 v134, v244, v245
v_cvt_pk_bf16_f32 v135, v246, v247
v_accvgpr_read_b32 v248, a40
v_accvgpr_read_b32 v249, a41
v_accvgpr_read_b32 v250, a42
v_accvgpr_read_b32 v251, a43
v_accvgpr_read_b32 v252, a44
v_accvgpr_read_b32 v253, a45
v_accvgpr_read_b32 v254, a46
v_accvgpr_read_b32 v255, a47
v_pk_mul_f32 v[248:249], v[248:249], v[228:229]
v_pk_mul_f32 v[250:251], v[250:251], v[228:229]
v_pk_mul_f32 v[252:253], v[252:253], v[228:229]
v_pk_mul_f32 v[254:255], v[254:255], v[228:229]
v_cvt_pk_bf16_f32 v148, v248, v249
v_cvt_pk_bf16_f32 v149, v250, v251
v_cvt_pk_bf16_f32 v150, v252, v253
v_cvt_pk_bf16_f32 v151, v254, v255
v_accvgpr_read_b32 v240, a48
v_accvgpr_read_b32 v241, a49
v_accvgpr_read_b32 v242, a50
v_accvgpr_read_b32 v243, a51
v_accvgpr_read_b32 v244, a52
v_accvgpr_read_b32 v245, a53
v_accvgpr_read_b32 v246, a54
v_accvgpr_read_b32 v247, a55
v_pk_mul_f32 v[240:241], v[240:241], v[228:229]
v_pk_mul_f32 v[242:243], v[242:243], v[228:229]
v_pk_mul_f32 v[244:245], v[244:245], v[228:229]
v_pk_mul_f32 v[246:247], v[246:247], v[228:229]
v_cvt_pk_bf16_f32 v164, v240, v241
v_cvt_pk_bf16_f32 v165, v242, v243
v_cvt_pk_bf16_f32 v166, v244, v245
v_cvt_pk_bf16_f32 v167, v246, v247
v_accvgpr_read_b32 v248, a56
v_accvgpr_read_b32 v249, a57
v_accvgpr_read_b32 v250, a58
v_accvgpr_read_b32 v251, a59
v_accvgpr_read_b32 v252, a60
v_accvgpr_read_b32 v253, a61
v_accvgpr_read_b32 v254, a62
v_accvgpr_read_b32 v255, a63
v_pk_mul_f32 v[248:249], v[248:249], v[228:229]
v_pk_mul_f32 v[250:251], v[250:251], v[228:229]
v_pk_mul_f32 v[252:253], v[252:253], v[228:229]
v_pk_mul_f32 v[254:255], v[254:255], v[228:229]
v_cvt_pk_bf16_f32 v180, v248, v249
v_cvt_pk_bf16_f32 v181, v250, v251
v_cvt_pk_bf16_f32 v182, v252, v253
v_cvt_pk_bf16_f32 v183, v254, v255
v_mfma_f32_16x16x32_bf16 v[232:235], v[120:123], v[216:219], v[232:235]
s_add_u32 s82, s82, 0x8000
ds_read_b128 a[160:163], v2 offset:24576
ds_read_b128 a[164:167], v2 offset:25600
v_mfma_f32_16x16x32_bf16 v[232:235], v[120:123], v[200:203], v[232:235]
s_and_b32 s82, s82, 0x1ffff
v_exp_f32 v172, v172
v_mfma_f32_16x16x32_bf16 a[64:67], a[224:227], v[216:219], a[64:67]
s_add_u32 m0, s74, 0
v_exp_f32 v173, v173
v_mfma_f32_16x16x32_bf16 a[64:67], a[192:195], v[200:203], a[64:67]
s_add_u32 s72, s81, 0
buffer_load_dwordx4 v1, s[44:47], s72 offen sc1 lds
v_mfma_f32_16x16x32_bf16 a[68:71], a[196:199], v[200:203], a[68:71]
ds_read_b128 a[168:171], v2 offset:26624
v_cvt_pk_bf16_f32 v220, v172, v173
v_mfma_f32_16x16x32_bf16 a[68:71], a[228:231], v[216:219], a[68:71]
v_exp_f32 v174, v174
v_mfma_f32_16x16x32_bf16 a[72:75], a[232:235], v[216:219], a[72:75]
s_nop 0
ds_read_b128 a[172:175], v2 offset:27648
ds_read_b128 a[176:179], v2 offset:28672
v_mfma_f32_16x16x32_bf16 a[72:75], a[200:203], v[200:203], a[72:75]
v_exp_f32 v175, v175
v_mfma_f32_16x16x32_bf16 a[76:79], a[204:207], v[200:203], a[76:79]
v_exp_f32 v188, v188
v_mfma_f32_16x16x32_bf16 a[76:79], a[236:239], v[216:219], a[76:79]
buffer_store_dwordx4 v[128:131], v1, s[44:47], s70 offen sc1
v_mfma_f32_16x16x32_bf16 a[80:83], a[240:243], v[216:219], a[80:83]
s_waitcnt lgkmcnt(5)
ds_read_b128 a[180:183], v2 offset:29696
v_cvt_pk_bf16_f32 v221, v174, v175
v_mfma_f32_16x16x32_bf16 a[80:83], a[208:211], v[200:203], a[80:83]
v_exp_f32 v189, v189
v_mfma_f32_16x16x32_bf16 a[84:87], a[212:215], v[200:203], a[84:87]
ds_read_b128 a[184:187], v2 offset:30720
v_cvt_pk_bf16_f32 v222, v188, v189
v_mfma_f32_16x16x32_bf16 a[84:87], a[244:247], v[216:219], a[84:87]
v_exp_f32 v190, v190
v_mfma_f32_16x16x32_bf16 a[88:91], a[248:251], v[216:219], a[88:91]
buffer_load_dwordx4 v1, s[44:47], s72 offen offset:1024 sc1 lds
v_mfma_f32_16x16x32_bf16 a[88:91], a[216:219], v[200:203], a[88:91]
s_nop 0
ds_read_b128 a[188:191], v2 offset:31744
ds_read_b128 a[224:227], v2 offset:8192
v_mfma_f32_16x16x32_bf16 a[92:95], a[220:223], v[200:203], a[92:95]
v_exp_f32 v191, v191
v_mfma_f32_16x16x32_bf16 a[92:95], a[252:255], v[216:219], a[92:95]
v_exp_f32 v168, v168
v_mfma_f32_16x16x32_bf16 v[136:139], a[128:131], v[48:51], v[88:91]
ds_read_b128 a[228:231], v2 offset:9216
v_cvt_pk_bf16_f32 v223, v190, v191
v_mfma_f32_16x16x32_bf16 v[136:139], a[132:135], v[52:55], v[136:139]
v_exp_f32 v169, v169
v_mfma_f32_16x16x32_bf16 v[136:139], a[136:139], v[56:59], v[136:139]
buffer_store_dwordx4 v[144:147], v1, s[44:47], s70 offen offset:1024 sc1
v_mfma_f32_16x16x32_bf16 v[136:139], a[140:143], v[60:63], v[136:139]
ds_read_b128 a[232:235], v2 offset:10240
v_cvt_pk_bf16_f32 v216, v168, v169
v_mfma_f32_16x16x32_bf16 v[152:155], a[156:159], v[60:63], v[88:91]
v_exp_f32 v170, v170
v_mfma_f32_16x16x32_bf16 v[152:155], a[152:155], v[56:59], v[152:155]
s_nop 0
ds_read_b128 a[236:239], v2 offset:11264
ds_read_b128 a[240:243], v2 offset:12288
v_mfma_f32_16x16x32_bf16 v[152:155], a[148:151], v[52:55], v[152:155]
v_exp_f32 v171, v171
v_mfma_f32_16x16x32_bf16 v[152:155], a[144:147], v[48:51], v[152:155]
buffer_load_dwordx4 v1, s[44:47], s72 offen offset:2048 sc1 lds
v_mfma_f32_16x16x32_bf16 v[140:143], a[128:131], v[64:67], v[92:95]
v_exp_f32 v184, v184
v_mfma_f32_16x16x32_bf16 v[140:143], a[132:135], v[68:71], v[140:143]
ds_read_b128 a[244:247], v2 offset:13312
v_cvt_pk_bf16_f32 v217, v170, v171
v_mfma_f32_16x16x32_bf16 v[140:143], a[136:139], v[72:75], v[140:143]
v_exp_f32 v185, v185
v_mfma_f32_16x16x32_bf16 v[140:143], a[140:143], v[76:79], v[140:143]
s_nop 0
ds_read_b128 a[248:251], v2 offset:14336
ds_read_b128 a[252:255], v2 offset:15360
v_mfma_f32_16x16x32_bf16 v[156:159], a[156:159], v[76:79], v[92:95]
v_exp_f32 v186, v186
v_mfma_f32_16x16x32_bf16 v[156:159], a[152:155], v[72:75], v[156:159]
buffer_load_dwordx4 v1, s[44:47], s72 offen offset:3072 sc1 lds
v_mfma_f32_16x16x32_bf16 v[156:159], a[148:151], v[68:71], v[156:159]
s_waitcnt vmcnt(14) lgkmcnt(4)
v_exp_f32 v187, v187
v_mfma_f32_16x16x32_bf16 v[156:159], a[144:147], v[64:67], v[156:159]
s_barrier
v_cvt_pk_bf16_f32 v218, v184, v185
v_cvt_pk_bf16_f32 v219, v186, v187
v_add_u32 v2, s82, v1
v_mfma_f32_16x16x32_bf16 v[236:239], v[120:123], v[204:207], v[236:239]
s_xor_b32 s74, s82, 0x10000
v_exp_f32 v136, v136
v_mfma_f32_16x16x32_bf16 v[236:239], v[120:123], v[220:223], v[236:239]
s_add_u32 s74, s74, s64
ds_read_b128 a[128:131], v2 offset:16384
ds_read_b128 a[132:135], v2 offset:17408
v_mfma_f32_16x16x32_bf16 a[96:99], a[192:195], v[204:207], a[96:99]
s_add_u32 s81, s81, 0x8000
v_exp_f32 v137, v137
v_mfma_f32_16x16x32_bf16 a[96:99], a[224:227], v[220:223], a[96:99]
s_add_u32 m0, s74, 16384
v_exp_f32 v138, v138
v_mfma_f32_16x16x32_bf16 a[100:103], a[228:231], v[220:223], a[100:103]
s_add_u32 s72, s81, 16384
buffer_load_dwordx4 v1, s[44:47], s72 offen sc1 lds
v_mfma_f32_16x16x32_bf16 a[100:103], a[196:199], v[204:207], a[100:103]
ds_read_b128 a[136:139], v2 offset:18432
v_cvt_pk_bf16_f32 v200, v136, v137
v_mfma_f32_16x16x32_bf16 a[104:107], a[200:203], v[204:207], a[104:107]
v_exp_f32 v139, v139
v_mfma_f32_16x16x32_bf16 a[104:107], a[232:235], v[220:223], a[104:107]
ds_read_b128 a[140:143], v2 offset:19456
v_cvt_pk_bf16_f32 v201, v138, v139
v_mfma_f32_16x16x32_bf16 a[108:111], a[236:239], v[220:223], a[108:111]
buffer_store_dwordx4 v[160:163], v1, s[44:47], s70 offen offset:2048 sc1
v_mfma_f32_16x16x32_bf16 a[108:111], a[204:207], v[204:207], a[108:111]
v_exp_f32 v152, v152
v_mfma_f32_16x16x32_bf16 a[112:115], a[208:211], v[204:207], a[112:115]
s_waitcnt lgkmcnt(4)
ds_read_b128 a[144:147], v2 offset:20480
ds_read_b128 a[148:151], v2 offset:21504
v_mfma_f32_16x16x32_bf16 a[112:115], a[240:243], v[220:223], a[112:115]
v_exp_f32 v153, v153
v_mfma_f32_16x16x32_bf16 a[116:119], a[244:247], v[220:223], a[116:119]
buffer_load_dwordx4 v1, s[44:47], s72 offen offset:1024 sc1 lds
v_mfma_f32_16x16x32_bf16 a[116:119], a[212:215], v[204:207], a[116:119]
v_exp_f32 v154, v154
v_mfma_f32_16x16x32_bf16 a[120:123], a[216:219], v[204:207], a[120:123]
ds_read_b128 a[152:155], v2 offset:22528
v_cvt_pk_bf16_f32 v202, v152, v153
v_mfma_f32_16x16x32_bf16 a[120:123], a[248:251], v[220:223], a[120:123]
v_exp_f32 v155, v155
v_mfma_f32_16x16x32_bf16 a[124:127], a[252:255], v[220:223], a[124:127]
ds_read_b128 a[156:159], v2 offset:23552
v_cvt_pk_bf16_f32 v203, v154, v155
v_mfma_f32_16x16x32_bf16 a[124:127], a[220:223], v[204:207], a[124:127]
v_exp_f32 v140, v140
v_mfma_f32_16x16x32_bf16 v[172:175], a[160:163], v[64:67], v[92:95]
s_nop 0
ds_read_b128 a[192:195], v2 offset:0
ds_read_b128 a[196:199], v2 offset:1024
v_mfma_f32_16x16x32_bf16 v[172:175], a[164:167], v[68:71], v[172:175]
buffer_store_dwordx4 v[176:179], v1, s[44:47], s70 offen offset:3072 sc1
v_mfma_f32_16x16x32_bf16 v[172:175], a[168:171], v[72:75], v[172:175]
v_exp_f32 v141, v141
v_mfma_f32_16x16x32_bf16 v[172:175], a[172:175], v[76:79], v[172:175]
v_exp_f32 v142, v142
v_mfma_f32_16x16x32_bf16 v[188:191], a[188:191], v[76:79], v[92:95]
s_nop 0
ds_read_b128 a[200:203], v2 offset:2048
ds_read_b128 a[204:207], v2 offset:3072
v_mfma_f32_16x16x32_bf16 v[188:191], a[184:187], v[72:75], v[188:191]
buffer_load_dwordx4 v1, s[44:47], s72 offen offset:2048 sc1 lds
v_mfma_f32_16x16x32_bf16 v[188:191], a[180:183], v[68:71], v[188:191]
s_add_u32 s70, s70, 0x80000
v_exp_f32 v143, v143
v_mfma_f32_16x16x32_bf16 v[188:191], a[176:179], v[64:67], v[188:191]
v_exp_f32 v156, v156
v_mfma_f32_16x16x32_bf16 v[168:171], a[160:163], v[48:51], v[88:91]
s_nop 0
ds_read_b128 a[208:211], v2 offset:4096
ds_read_b128 a[212:215], v2 offset:5120
v_mfma_f32_16x16x32_bf16 v[168:171], a[164:167], v[52:55], v[168:171]
s_nop 0
ds_read_b128 a[216:219], v2 offset:6144
ds_read_b128 a[220:223], v2 offset:7168
v_mfma_f32_16x16x32_bf16 v[168:171], a[168:171], v[56:59], v[168:171]
v_cvt_pk_bf16_f32 v204, v140, v141
v_cvt_pk_bf16_f32 v205, v142, v143
v_mfma_f32_16x16x32_bf16 v[168:171], a[172:175], v[60:63], v[168:171]
buffer_store_dwordx4 v[132:135], v1, s[44:47], s70 offen sc1
v_mfma_f32_16x16x32_bf16 v[184:187], a[188:191], v[60:63], v[88:91]
v_exp_f32 v157, v157
v_mfma_f32_16x16x32_bf16 v[184:187], a[184:187], v[56:59], v[184:187]
v_exp_f32 v158, v158
v_mfma_f32_16x16x32_bf16 v[184:187], a[180:183], v[52:55], v[184:187]
buffer_load_dwordx4 v1, s[44:47], s72 offen offset:3072 sc1 lds
v_mfma_f32_16x16x32_bf16 v[184:187], a[176:179], v[48:51], v[184:187]
s_waitcnt lgkmcnt(4)
v_exp_f32 v159, v159
v_cvt_pk_bf16_f32 v206, v156, v157
v_cvt_pk_bf16_f32 v207, v158, v159
v_mfma_f32_16x16x32_bf16 v[232:235], v[120:123], v[216:219], v[232:235]
s_add_u32 s82, s82, 0x8000
ds_read_b128 a[160:163], v2 offset:24576
ds_read_b128 a[164:167], v2 offset:25600
v_mfma_f32_16x16x32_bf16 v[232:235], v[120:123], v[200:203], v[232:235]
s_and_b32 s82, s82, 0x1ffff
v_exp_f32 v172, v172
v_mfma_f32_16x16x32_bf16 a[64:67], a[224:227], v[216:219], a[64:67]
s_add_u32 m0, s74, 0
v_exp_f32 v173, v173
v_mfma_f32_16x16x32_bf16 a[64:67], a[192:195], v[200:203], a[64:67]
s_add_u32 s72, s81, 0
buffer_load_dwordx4 v1, s[44:47], s72 offen sc1 lds
v_mfma_f32_16x16x32_bf16 a[68:71], a[196:199], v[200:203], a[68:71]
ds_read_b128 a[168:171], v2 offset:26624
v_cvt_pk_bf16_f32 v220, v172, v173
v_mfma_f32_16x16x32_bf16 a[68:71], a[228:231], v[216:219], a[68:71]
v_exp_f32 v174, v174
v_mfma_f32_16x16x32_bf16 a[72:75], a[232:235], v[216:219], a[72:75]
s_nop 0
ds_read_b128 a[172:175], v2 offset:27648
ds_read_b128 a[176:179], v2 offset:28672
v_mfma_f32_16x16x32_bf16 a[72:75], a[200:203], v[200:203], a[72:75]
v_exp_f32 v175, v175
v_mfma_f32_16x16x32_bf16 a[76:79], a[204:207], v[200:203], a[76:79]
buffer_store_dwordx4 v[148:151], v1, s[44:47], s70 offen offset:1024 sc1
v_mfma_f32_16x16x32_bf16 a[76:79], a[236:239], v[216:219], a[76:79]
v_exp_f32 v188, v188
v_mfma_f32_16x16x32_bf16 a[80:83], a[240:243], v[216:219], a[80:83]
s_waitcnt lgkmcnt(5)
ds_read_b128 a[180:183], v2 offset:29696
v_cvt_pk_bf16_f32 v221, v174, v175
v_mfma_f32_16x16x32_bf16 a[80:83], a[208:211], v[200:203], a[80:83]
v_exp_f32 v189, v189
v_mfma_f32_16x16x32_bf16 a[84:87], a[212:215], v[200:203], a[84:87]
buffer_load_dwordx4 v1, s[44:47], s72 offen offset:1024 sc1 lds
v_mfma_f32_16x16x32_bf16 a[84:87], a[244:247], v[216:219], a[84:87]
ds_read_b128 a[184:187], v2 offset:30720
v_cvt_pk_bf16_f32 v222, v188, v189
v_mfma_f32_16x16x32_bf16 a[88:91], a[248:251], v[216:219], a[88:91]
v_exp_f32 v190, v190
v_mfma_f32_16x16x32_bf16 a[88:91], a[216:219], v[200:203], a[88:91]
s_nop 0
ds_read_b128 a[188:191], v2 offset:31744
ds_read_b128 a[224:227], v2 offset:8192
v_mfma_f32_16x16x32_bf16 a[92:95], a[220:223], v[200:203], a[92:95]
v_exp_f32 v191, v191
v_mfma_f32_16x16x32_bf16 a[92:95], a[252:255], v[216:219], a[92:95]
buffer_store_dwordx4 v[164:167], v1, s[44:47], s70 offen offset:2048 sc1
v_mfma_f32_16x16x32_bf16 v[136:139], a[128:131], v[48:51], v[88:91]
v_exp_f32 v168, v168
v_mfma_f32_16x16x32_bf16 v[136:139], a[132:135], v[52:55], v[136:139]
ds_read_b128 a[228:231], v2 offset:9216
v_cvt_pk_bf16_f32 v223, v190, v191
v_mfma_f32_16x16x32_bf16 v[136:139], a[136:139], v[56:59], v[136:139]
v_exp_f32 v169, v169
v_mfma_f32_16x16x32_bf16 v[136:139], a[140:143], v[60:63], v[136:139]
s_nop 0
ds_read_b128 a[232:235], v2 offset:10240
ds_read_b128 a[236:239], v2 offset:11264
v_mfma_f32_16x16x32_bf16 v[152:155], a[156:159], v[60:63], v[88:91]
v_exp_f32 v170, v170
v_mfma_f32_16x16x32_bf16 v[152:155], a[152:155], v[56:59], v[152:155]
buffer_load_dwordx4 v1, s[44:47], s72 offen offset:2048 sc1 lds
v_mfma_f32_16x16x32_bf16 v[152:155], a[148:151], v[52:55], v[152:155]
v_exp_f32 v171, v171
v_mfma_f32_16x16x32_bf16 v[152:155], a[144:147], v[48:51], v[152:155]
s_nop 0
ds_read_b128 a[240:243], v2 offset:12288
ds_read_b128 a[244:247], v2 offset:13312
v_mfma_f32_16x16x32_bf16 v[140:143], a[128:131], v[64:67], v[92:95]
v_exp_f32 v184, v184
v_mfma_f32_16x16x32_bf16 v[140:143], a[132:135], v[68:71], v[140:143]
s_nop 0
ds_read_b128 a[248:251], v2 offset:14336
ds_read_b128 a[252:255], v2 offset:15360
v_mfma_f32_16x16x32_bf16 v[140:143], a[136:139], v[72:75], v[140:143]
v_cvt_pk_bf16_f32 v216, v168, v169
v_cvt_pk_bf16_f32 v217, v170, v171
v_mfma_f32_16x16x32_bf16 v[140:143], a[140:143], v[76:79], v[140:143]
buffer_store_dwordx4 v[180:183], v1, s[44:47], s70 offen offset:3072 sc1
v_mfma_f32_16x16x32_bf16 v[156:159], a[156:159], v[76:79], v[92:95]
v_exp_f32 v185, v185
v_mfma_f32_16x16x32_bf16 v[156:159], a[152:155], v[72:75], v[156:159]
buffer_load_dwordx4 v1, s[44:47], s72 offen offset:3072 sc1 lds
v_mfma_f32_16x16x32_bf16 v[156:159], a[148:151], v[68:71], v[156:159]
s_waitcnt vmcnt(14) lgkmcnt(4)
v_exp_f32 v186, v186
v_mfma_f32_16x16x32_bf16 v[156:159], a[144:147], v[64:67], v[156:159]
s_barrier
v_exp_f32 v187, v187
v_add_u32 v2, s82, v1
v_cvt_pk_bf16_f32 v218, v184, v185
v_cvt_pk_bf16_f32 v219, v186, v187
s_lshl_b32 s83, s60, 2
s_sub_u32 s83, s83, 25
.p2align 5
s_nop 0
s_nop 0
LloopII:
v_mfma_f32_16x16x32_bf16 v[236:239], v[120:123], v[204:207], v[236:239]
s_xor_b32 s74, s82, 0x10000
v_exp_f32 v136, v136
v_mfma_f32_16x16x32_bf16 v[236:239], v[120:123], v[220:223], v[236:239]
s_add_u32 s74, s74, s64
ds_read_b128 a[128:131], v2 offset:16384
ds_read_b128 a[132:135], v2 offset:17408
v_mfma_f32_16x16x32_bf16 a[96:99], a[192:195], v[204:207], a[96:99]
s_add_u32 s81, s81, 0x8000
v_exp_f32 v137, v137
v_mfma_f32_16x16x32_bf16 a[96:99], a[224:227], v[220:223], a[96:99]
s_add_u32 m0, s74, 16384
v_exp_f32 v138, v138
v_mfma_f32_16x16x32_bf16 a[100:103], a[228:231], v[220:223], a[100:103]
s_add_u32 s72, s81, 16384
ds_read_b128 a[136:139], v2 offset:18432
v_cvt_pk_bf16_f32 v200, v136, v137
v_mfma_f32_16x16x32_bf16 a[100:103], a[196:199], v[204:207], a[100:103]
buffer_load_dwordx4 v1, s[44:47], s72 offen sc1 lds
v_mfma_f32_16x16x32_bf16 a[104:107], a[200:203], v[204:207], a[104:107]
v_exp_f32 v139, v139
v_mfma_f32_16x16x32_bf16 a[104:107], a[232:235], v[220:223], a[104:107]
ds_read_b128 a[140:143], v2 offset:19456
v_cvt_pk_bf16_f32 v201, v138, v139
v_mfma_f32_16x16x32_bf16 a[108:111], a[236:239], v[220:223], a[108:111]
v_exp_f32 v152, v152
v_mfma_f32_16x16x32_bf16 a[108:111], a[204:207], v[204:207], a[108:111]
s_nop 0
ds_read_b128 a[144:147], v2 offset:20480
ds_read_b128 a[148:151], v2 offset:21504
v_mfma_f32_16x16x32_bf16 a[112:115], a[208:211], v[204:207], a[112:115]
s_waitcnt lgkmcnt(6)
v_exp_f32 v153, v153
v_mfma_f32_16x16x32_bf16 a[112:115], a[240:243], v[220:223], a[112:115]
v_exp_f32 v154, v154
v_mfma_f32_16x16x32_bf16 a[116:119], a[244:247], v[220:223], a[116:119]
ds_read_b128 a[152:155], v2 offset:22528
v_cvt_pk_bf16_f32 v202, v152, v153
v_mfma_f32_16x16x32_bf16 a[116:119], a[212:215], v[204:207], a[116:119]
buffer_load_dwordx4 v1, s[44:47], s72 offen offset:1024 sc1 lds
v_mfma_f32_16x16x32_bf16 a[120:123], a[216:219], v[204:207], a[120:123]
v_exp_f32 v155, v155
v_mfma_f32_16x16x32_bf16 a[120:123], a[248:251], v[220:223], a[120:123]
ds_read_b128 a[156:159], v2 offset:23552
v_cvt_pk_bf16_f32 v203, v154, v155
v_mfma_f32_16x16x32_bf16 a[124:127], a[252:255], v[220:223], a[124:127]
v_exp_f32 v140, v140
v_mfma_f32_16x16x32_bf16 a[124:127], a[220:223], v[204:207], a[124:127]
s_nop 0
ds_read_b128 a[192:195], v2 offset:0
ds_read_b128 a[196:199], v2 offset:1024
v_mfma_f32_16x16x32_bf16 v[172:175], a[160:163], v[64:67], v[92:95]
v_exp_f32 v141, v141
v_mfma_f32_16x16x32_bf16 v[172:175], a[164:167], v[68:71], v[172:175]
v_exp_f32 v142, v142
v_mfma_f32_16x16x32_bf16 v[172:175], a[168:171], v[72:75], v[172:175]
ds_read_b128 a[200:203], v2 offset:2048
v_cvt_pk_bf16_f32 v204, v140, v141
v_mfma_f32_16x16x32_bf16 v[172:175], a[172:175], v[76:79], v[172:175]
buffer_load_dwordx4 v1, s[44:47], s72 offen offset:2048 sc1 lds
v_mfma_f32_16x16x32_bf16 v[188:191], a[188:191], v[76:79], v[92:95]
v_exp_f32 v143, v143
v_mfma_f32_16x16x32_bf16 v[188:191], a[184:187], v[72:75], v[188:191]
ds_read_b128 a[204:207], v2 offset:3072
v_cvt_pk_bf16_f32 v205, v142, v143
v_mfma_f32_16x16x32_bf16 v[188:191], a[180:183], v[68:71], v[188:191]
v_exp_f32 v156, v156
v_mfma_f32_16x16x32_bf16 v[188:191], a[176:179], v[64:67], v[188:191]
ds_read_b128 a[208:211], v2 offset:4096
v_mfma_f32_16x16x32_bf16 v[168:171], a[160:163], v[48:51], v[88:91]
v_exp_f32 v157, v157
v_mfma_f32_16x16x32_bf16 v[168:171], a[164:167], v[52:55], v[168:171]
ds_read_b128 a[212:215], v2 offset:5120
v_cvt_pk_bf16_f32 v206, v156, v157
v_mfma_f32_16x16x32_bf16 v[168:171], a[168:171], v[56:59], v[168:171]
v_exp_f32 v158, v158
v_mfma_f32_16x16x32_bf16 v[168:171], a[172:175], v[60:63], v[168:171]
ds_read_b128 a[216:219], v2 offset:6144
v_mfma_f32_16x16x32_bf16 v[184:187], a[188:191], v[60:63], v[88:91]
buffer_load_dwordx4 v1, s[44:47], s72 offen offset:3072 sc1 lds
v_mfma_f32_16x16x32_bf16 v[184:187], a[184:187], v[56:59], v[184:187]
v_exp_f32 v159, v159
v_mfma_f32_16x16x32_bf16 v[184:187], a[180:183], v[52:55], v[184:187]
ds_read_b128 a[220:223], v2 offset:7168
v_cvt_pk_bf16_f32 v207, v158, v159
v_mfma_f32_16x16x32_bf16 v[184:187], a[176:179], v[48:51], v[184:187]
s_waitcnt lgkmcnt(4)
v_mfma_f32_16x16x32_bf16 v[232:235], v[120:123], v[216:219], v[232:235]
s_add_u32 s82, s82, 0x8000
ds_read_b128 a[160:163], v2 offset:24576
ds_read_b128 a[164:167], v2 offset:25600
v_mfma_f32_16x16x32_bf16 v[232:235], v[120:123], v[200:203], v[232:235]
s_and_b32 s82, s82, 0x1ffff
v_exp_f32 v172, v172
v_mfma_f32_16x16x32_bf16 a[64:67], a[224:227], v[216:219], a[64:67]
s_add_u32 m0, s74, 0
v_exp_f32 v173, v173
v_mfma_f32_16x16x32_bf16 a[64:67], a[192:195], v[200:203], a[64:67]
s_add_u32 s72, s81, 0
ds_read_b128 a[168:171], v2 offset:26624
v_cvt_pk_bf16_f32 v220, v172, v173
v_mfma_f32_16x16x32_bf16 a[68:71], a[196:199], v[200:203], a[68:71]
v_exp_f32 v174, v174
v_mfma_f32_16x16x32_bf16 a[68:71], a[228:231], v[216:219], a[68:71]
buffer_load_dwordx4 v1, s[44:47], s72 offen sc1 lds
v_mfma_f32_16x16x32_bf16 a[72:75], a[232:235], v[216:219], a[72:75]
s_nop 0
ds_read_b128 a[172:175], v2 offset:27648
ds_read_b128 a[176:179], v2 offset:28672
v_mfma_f32_16x16x32_bf16 a[72:75], a[200:203], v[200:203], a[72:75]
v_exp_f32 v175, v175
v_mfma_f32_16x16x32_bf16 a[76:79], a[204:207], v[200:203], a[76:79]
v_exp_f32 v188, v188
v_mfma_f32_16x16x32_bf16 a[76:79], a[236:239], v[216:219], a[76:79]
ds_read_b128 a[180:183], v2 offset:29696
v_cvt_pk_bf16_f32 v221, v174, v175
v_mfma_f32_16x16x32_bf16 a[80:83], a[240:243], v[216:219], a[80:83]
s_waitcnt lgkmcnt(6)
v_exp_f32 v189, v189
v_mfma_f32_16x16x32_bf16 a[80:83], a[208:211], v[200:203], a[80:83]
ds_read_b128 a[184:187], v2 offset:30720
v_cvt_pk_bf16_f32 v222, v188, v189
v_mfma_f32_16x16x32_bf16 a[84:87], a[212:215], v[200:203], a[84:87]
buffer_load_dwordx4 v1, s[44:47], s72 offen offset:1024 sc1 lds
v_mfma_f32_16x16x32_bf16 a[84:87], a[244:247], v[216:219], a[84:87]
v_exp_f32 v190, v190
v_mfma_f32_16x16x32_bf16 a[88:91], a[248:251], v[216:219], a[88:91]
s_nop 0
ds_read_b128 a[188:191], v2 offset:31744
ds_read_b128 a[224:227], v2 offset:8192
v_mfma_f32_16x16x32_bf16 a[88:91], a[216:219], v[200:203], a[88:91]
v_exp_f32 v191, v191
v_mfma_f32_16x16x32_bf16 a[92:95], a[220:223], v[200:203], a[92:95]
v_exp_f32 v168, v168
v_mfma_f32_16x16x32_bf16 a[92:95], a[252:255], v[216:219], a[92:95]
ds_read_b128 a[228:231], v2 offset:9216
v_cvt_pk_bf16_f32 v223, v190, v191
v_mfma_f32_16x16x32_bf16 v[136:139], a[128:131], v[48:51], v[88:91]
v_exp_f32 v169, v169
v_mfma_f32_16x16x32_bf16 v[136:139], a[132:135], v[52:55], v[136:139]
ds_read_b128 a[232:235], v2 offset:10240
v_cvt_pk_bf16_f32 v216, v168, v169
v_mfma_f32_16x16x32_bf16 v[136:139], a[136:139], v[56:59], v[136:139]
buffer_load_dwordx4 v1, s[44:47], s72 offen offset:2048 sc1 lds
v_mfma_f32_16x16x32_bf16 v[136:139], a[140:143], v[60:63], v[136:139]
v_exp_f32 v170, v170
v_mfma_f32_16x16x32_bf16 v[152:155], a[156:159], v[60:63], v[88:91]
s_nop 0
ds_read_b128 a[236:239], v2 offset:11264
ds_read_b128 a[240:243], v2 offset:12288
v_mfma_f32_16x16x32_bf16 v[152:155], a[152:155], v[56:59], v[152:155]
v_exp_f32 v171, v171
v_mfma_f32_16x16x32_bf16 v[152:155], a[148:151], v[52:55], v[152:155]
v_exp_f32 v184, v184
v_mfma_f32_16x16x32_bf16 v[152:155], a[144:147], v[48:51], v[152:155]
ds_read_b128 a[244:247], v2 offset:13312
v_cvt_pk_bf16_f32 v217, v170, v171
v_mfma_f32_16x16x32_bf16 v[140:143], a[128:131], v[64:67], v[92:95]
v_exp_f32 v185, v185
v_mfma_f32_16x16x32_bf16 v[140:143], a[132:135], v[68:71], v[140:143]
ds_read_b128 a[248:251], v2 offset:14336
v_cvt_pk_bf16_f32 v218, v184, v185
v_mfma_f32_16x16x32_bf16 v[140:143], a[136:139], v[72:75], v[140:143]
buffer_load_dwordx4 v1, s[44:47], s72 offen offset:3072 sc1 lds
v_mfma_f32_16x16x32_bf16 v[140:143], a[140:143], v[76:79], v[140:143]
ds_read_b128 a[252:255], v2 offset:15360
v_add_u32 v2, s82, v1
v_mfma_f32_16x16x32_bf16 v[156:159], a[156:159], v[76:79], v[92:95]
s_waitcnt vmcnt(8) lgkmcnt(4)
v_exp_f32 v186, v186
v_mfma_f32_16x16x32_bf16 v[156:159], a[152:155], v[72:75], v[156:159]
s_barrier
v_exp_f32 v187, v187
v_mfma_f32_16x16x32_bf16 v[156:159], a[148:151], v[68:71], v[156:159]
s_add_u32 s83, s83, 1
v_cvt_pk_bf16_f32 v219, v186, v187
v_mfma_f32_16x16x32_bf16 v[156:159], a[144:147], v[64:67], v[156:159]
s_cbranch_scc0 LloopII
v_mfma_f32_16x16x32_bf16 v[236:239], v[120:123], v[204:207], v[236:239]
s_xor_b32 s74, s82, 0x10000
ds_read_b128 a[128:131], v2 offset:16384
ds_read_b128 a[132:135], v2 offset:17408
v_mfma_f32_16x16x32_bf16 v[236:239], v[120:123], v[220:223], v[236:239]
s_add_u32 s74, s74, s64
v_exp_f32 v136, v136
v_mfma_f32_16x16x32_bf16 a[96:99], a[192:195], v[204:207], a[96:99]
s_add_u32 s81, s81, 0x8000
v_exp_f32 v137, v137
v_mfma_f32_16x16x32_bf16 a[96:99], a[224:227], v[220:223], a[96:99]
s_add_u32 m0, s74, 0
ds_read_b128 a[136:139], v2 offset:18432
v_cvt_pk_bf16_f32 v200, v136, v137
v_mfma_f32_16x16x32_bf16 a[100:103], a[228:231], v[220:223], a[100:103]
s_add_u32 s72, s81, 0
v_exp_f32 v138, v138
v_mfma_f32_16x16x32_bf16 a[100:103], a[196:199], v[204:207], a[100:103]
buffer_load_dwordx4 v1, s[44:47], s72 offen sc1 lds
v_mfma_f32_16x16x32_bf16 a[104:107], a[200:203], v[204:207], a[104:107]
s_nop 0
ds_read_b128 a[140:143], v2 offset:19456
ds_read_b128 a[144:147], v2 offset:20480
v_mfma_f32_16x16x32_bf16 a[104:107], a[232:235], v[220:223], a[104:107]
v_exp_f32 v139, v139
v_mfma_f32_16x16x32_bf16 a[108:111], a[236:239], v[220:223], a[108:111]
v_exp_f32 v152, v152
v_mfma_f32_16x16x32_bf16 a[108:111], a[204:207], v[204:207], a[108:111]
ds_read_b128 a[148:151], v2 offset:21504
v_cvt_pk_bf16_f32 v201, v138, v139
v_mfma_f32_16x16x32_bf16 a[112:115], a[208:211], v[204:207], a[112:115]
s_waitcnt lgkmcnt(6)
v_exp_f32 v153, v153
v_mfma_f32_16x16x32_bf16 a[112:115], a[240:243], v[220:223], a[112:115]
ds_read_b128 a[152:155], v2 offset:22528
v_cvt_pk_bf16_f32 v202, v152, v153
v_mfma_f32_16x16x32_bf16 a[116:119], a[244:247], v[220:223], a[116:119]
v_exp_f32 v154, v154
v_mfma_f32_16x16x32_bf16 a[116:119], a[212:215], v[204:207], a[116:119]
buffer_load_dwordx4 v1, s[44:47], s72 offen offset:1024 sc1 lds
v_mfma_f32_16x16x32_bf16 a[120:123], a[216:219], v[204:207], a[120:123]
s_nop 0
ds_read_b128 a[156:159], v2 offset:23552
ds_read_b128 a[192:195], v2 offset:0
v_mfma_f32_16x16x32_bf16 a[120:123], a[248:251], v[220:223], a[120:123]
v_exp_f32 v155, v155
v_mfma_f32_16x16x32_bf16 a[124:127], a[252:255], v[220:223], a[124:127]
v_exp_f32 v140, v140
v_mfma_f32_16x16x32_bf16 a[124:127], a[220:223], v[204:207], a[124:127]
ds_read_b128 a[196:199], v2 offset:1024
v_cvt_pk_bf16_f32 v203, v154, v155
v_mfma_f32_16x16x32_bf16 v[172:175], a[160:163], v[64:67], v[92:95]
v_exp_f32 v141, v141
v_mfma_f32_16x16x32_bf16 v[172:175], a[164:167], v[68:71], v[172:175]
ds_read_b128 a[200:203], v2 offset:2048
v_cvt_pk_bf16_f32 v204, v140, v141
v_mfma_f32_16x16x32_bf16 v[172:175], a[168:171], v[72:75], v[172:175]
v_exp_f32 v142, v142
v_mfma_f32_16x16x32_bf16 v[172:175], a[172:175], v[76:79], v[172:175]
buffer_load_dwordx4 v1, s[44:47], s72 offen offset:2048 sc1 lds
v_mfma_f32_16x16x32_bf16 v[188:191], a[188:191], v[76:79], v[92:95]
ds_read_b128 a[204:207], v2 offset:3072
v_mfma_f32_16x16x32_bf16 v[188:191], a[184:187], v[72:75], v[188:191]
v_exp_f32 v143, v143
v_mfma_f32_16x16x32_bf16 v[188:191], a[180:183], v[68:71], v[188:191]
ds_read_b128 a[208:211], v2 offset:4096
v_cvt_pk_bf16_f32 v205, v142, v143
v_mfma_f32_16x16x32_bf16 v[188:191], a[176:179], v[64:67], v[188:191]
Lstub6:
s_cbranch_execz Lstub10
v_exp_f32 v156, v156
v_mfma_f32_16x16x32_bf16 v[168:171], a[160:163], v[48:51], v[88:91]
ds_read_b128 a[212:215], v2 offset:5120
v_mfma_f32_16x16x32_bf16 v[168:171], a[164:167], v[52:55], v[168:171]
v_exp_f32 v157, v157
v_mfma_f32_16x16x32_bf16 v[168:171], a[168:171], v[56:59], v[168:171]
ds_read_b128 a[216:219], v2 offset:6144
v_cvt_pk_bf16_f32 v206, v156, v157
v_mfma_f32_16x16x32_bf16 v[168:171], a[172:175], v[60:63], v[168:171]
buffer_load_dwordx4 v1, s[44:47], s72 offen offset:3072 sc1 lds
v_mfma_f32_16x16x32_bf16 v[184:187], a[188:191], v[60:63], v[88:91]
v_exp_f32 v158, v158
v_mfma_f32_16x16x32_bf16 v[184:187], a[184:187], v[56:59], v[184:187]
ds_read_b128 a[220:223], v2 offset:7168
v_mfma_f32_16x16x32_bf16 v[184:187], a[180:183], v[52:55], v[184:187]
s_waitcnt lgkmcnt(4)
v_exp_f32 v159, v159
v_mfma_f32_16x16x32_bf16 v[184:187], a[176:179], v[48:51], v[184:187]
s_barrier
v_cvt_pk_bf16_f32 v207, v158, v159
s_lshr_b32 s69, s93, 4
s_and_b32 s69, s69, 0x7f00
s_add_u32 s69, s69, LHT4-Lpc0
v_lshrrev_b32 v3, 5, v0
v_lshlrev_b32 v3, 7, v3
v_add_u32 v3, s69, v3
v_min_u32 v3, Lcode_end-Lpc0, v3
global_load_dword v4, v3, s[98:99]
v_mfma_f32_16x16x32_bf16 v[232:235], v[120:123], v[216:219], v[232:235]
s_add_u32 s82, s82, 0x8000
ds_read_b128 a[160:163], v2 offset:24576
ds_read_b128 a[164:167], v2 offset:25600
v_mfma_f32_16x16x32_bf16 v[232:235], v[120:123], v[200:203], v[232:235]
s_and_b32 s82, s82, 0x1ffff
v_exp_f32 v172, v172
v_mfma_f32_16x16x32_bf16 a[64:67], a[224:227], v[216:219], a[64:67]
s_add_u32 s66, s58, 3
v_exp_f32 v173, v173
v_mfma_f32_16x16x32_bf16 a[64:67], a[192:195], v[200:203], a[64:67]
s_and_b32 s66, s66, 3
ds_read_b128 a[168:171], v2 offset:26624
v_cvt_pk_bf16_f32 v220, v172, v173
v_mfma_f32_16x16x32_bf16 a[68:71], a[196:199], v[200:203], a[68:71]
s_mul_i32 s66, s66, 4160
v_exp_f32 v174, v174
v_mfma_f32_16x16x32_bf16 a[68:71], a[228:231], v[216:219], a[68:71]
s_add_u32 s66, s66, s92
ds_read_b128 a[172:175], v2 offset:27648
ds_read_b128 a[176:179], v2 offset:28672
v_mfma_f32_16x16x32_bf16 a[72:75], a[232:235], v[216:219], a[72:75]
s_add_u32 m0, s66, 32
v_exp_f32 v175, v175
v_mfma_f32_16x16x32_bf16 a[72:75], a[200:203], v[200:203], a[72:75]
s_add_u32 s72, s93, 0x6
buffer_load_dwordx4 v1, s[36:39], s72 offen lds
v_mfma_f32_16x16x32_bf16 a[76:79], a[204:207], v[200:203], a[76:79]
v_exp_f32 v188, v188
v_mfma_f32_16x16x32_bf16 a[76:79], a[236:239], v[216:219], a[76:79]
ds_read_b128 a[180:183], v2 offset:29696
v_cvt_pk_bf16_f32 v221, v174, v175
v_mfma_f32_16x16x32_bf16 a[80:83], a[240:243], v[216:219], a[80:83]
s_waitcnt lgkmcnt(6)
v_exp_f32 v189, v189
v_mfma_f32_16x16x32_bf16 a[80:83], a[208:211], v[200:203], a[80:83]
ds_read_b128 a[184:187], v2 offset:30720
v_cvt_pk_bf16_f32 v222, v188, v189
v_mfma_f32_16x16x32_bf16 a[84:87], a[212:215], v[200:203], a[84:87]
v_exp_f32 v190, v190
v_mfma_f32_16x16x32_bf16 a[84:87], a[244:247], v[216:219], a[84:87]
buffer_load_dwordx4 v1, s[36:39], s72 offen offset:1024 lds
v_mfma_f32_16x16x32_bf16 a[88:91], a[248:251], v[216:219], a[88:91]
s_nop 0
ds_read_b128 a[188:191], v2 offset:31744
ds_read_b128 a[224:227], v2 offset:8192
v_mfma_f32_16x16x32_bf16 a[88:91], a[216:219], v[200:203], a[88:91]
v_exp_f32 v191, v191
v_mfma_f32_16x16x32_bf16 a[92:95], a[220:223], v[200:203], a[92:95]
v_exp_f32 v168, v168
v_mfma_f32_16x16x32_bf16 a[92:95], a[252:255], v[216:219], a[92:95]
ds_read_b128 a[228:231], v2 offset:9216
v_cvt_pk_bf16_f32 v223, v190, v191
s_cmp_eq_u32 s58, 0
s_cbranch_scc1 Lta28
s_cmp_eq_u32 s58, 1
s_cbranch_scc1 Lnt29
v_mfma_f32_16x16x32_bf16 v[136:139], a[128:131], v[48:51], v[88:91]
v_exp_f32 v169, v169
v_mfma_f32_16x16x32_bf16 v[152:155], a[144:147], v[48:51], v[88:91]
ds_read_b128 a[232:235], v2 offset:10240
v_cvt_pk_bf16_f32 v216, v168, v169
s_branch Ljoin30
Lta28:
v_mfma_f32_16x16x32_bf16 v[136:139], a[128:131], v[48:51], v[104:107]
v_exp_f32 v169, v169
v_mfma_f32_16x16x32_bf16 v[152:155], a[144:147], v[48:51], v[112:115]
ds_read_b128 a[232:235], v2 offset:10240
v_cvt_pk_bf16_f32 v216, v168, v169
s_branch Ljoin30
Lnt29:
v_mfma_f32_16x16x32_bf16 v[136:139], a[128:131], v[48:51], v[88:91]
v_exp_f32 v169, v169
v_mfma_f32_16x16x32_bf16 v[152:155], a[144:147], v[48:51], v[104:107]
ds_read_b128 a[232:235], v2 offset:10240
v_cvt_pk_bf16_f32 v216, v168, v169
Ljoin30:
v_mfma_f32_16x16x32_bf16 v[136:139], a[132:135], v[52:55], v[136:139]
v_exp_f32 v170, v170
v_mfma_f32_16x16x32_bf16 v[136:139], a[136:139], v[56:59], v[136:139]
buffer_load_dwordx4 v1, s[36:39], s72 offen offset:2048 lds
v_mfma_f32_16x16x32_bf16 v[136:139], a[140:143], v[60:63], v[136:139]
ds_read_b128 a[236:239], v2 offset:11264
v_mfma_f32_16x16x32_bf16 v[152:155], a[156:159], v[60:63], v[152:155]
v_exp_f32 v171, v171
v_mfma_f32_16x16x32_bf16 v[152:155], a[152:155], v[56:59], v[152:155]
ds_read_b128 a[240:243], v2 offset:12288
v_cvt_pk_bf16_f32 v217, v170, v171
v_mfma_f32_16x16x32_bf16 v[152:155], a[148:151], v[52:55], v[152:155]
v_exp_f32 v184, v184
v_mfma_f32_16x16x32_bf16 v[140:143], a[128:131], v[64:67], v[92:95]
ds_read_b128 a[244:247], v2 offset:13312
v_mfma_f32_16x16x32_bf16 v[140:143], a[132:135], v[68:71], v[140:143]
v_exp_f32 v185, v185
v_mfma_f32_16x16x32_bf16 v[140:143], a[136:139], v[72:75], v[140:143]
ds_read_b128 a[248:251], v2 offset:14336
v_cvt_pk_bf16_f32 v218, v184, v185
v_mfma_f32_16x16x32_bf16 v[140:143], a[140:143], v[76:79], v[140:143]
buffer_load_dwordx4 v1, s[36:39], s72 offen offset:3072 lds
v_mfma_f32_16x16x32_bf16 v[156:159], a[156:159], v[76:79], v[92:95]
v_exp_f32 v186, v186
v_mfma_f32_16x16x32_bf16 v[156:159], a[152:155], v[72:75], v[156:159]
ds_read_b128 a[252:255], v2 offset:15360
v_add_u32 v2, s82, v1
v_mfma_f32_16x16x32_bf16 v[156:159], a[148:151], v[68:71], v[156:159]
s_waitcnt vmcnt(9) lgkmcnt(0)
v_exp_f32 v187, v187
v_mfma_f32_16x16x32_bf16 v[156:159], a[144:147], v[64:67], v[156:159]
s_barrier
v_cvt_pk_bf16_f32 v219, v186, v187
v_mfma_f32_16x16x32_bf16 v[236:239], v[120:123], v[204:207], v[236:239]
s_mov_b32 m0, s62
v_exp_f32 v136, v136
v_mfma_f32_16x16x32_bf16 v[236:239], v[120:123], v[220:223], v[236:239]
s_add_u32 s72, s93, 0x3000000
ds_read_b128 a[128:131], v2 offset:16384
ds_read_b128 a[132:135], v2 offset:17408
v_mfma_f32_16x16x32_bf16 a[96:99], a[192:195], v[204:207], a[96:99]
s_add_u32 s78, s59, 4
v_exp_f32 v137, v137
v_mfma_f32_16x16x32_bf16 a[96:99], a[224:227], v[220:223], a[96:99]
s_and_b32 s78, s78, 12
buffer_load_dwordx4 v1, s[44:47], s72 offen sc1 lds
v_mfma_f32_16x16x32_bf16 a[100:103], a[228:231], v[220:223], a[100:103]
s_lshl_b32 s78, s78, 1
v_exp_f32 v138, v138
v_mfma_f32_16x16x32_bf16 a[100:103], a[196:199], v[204:207], a[100:103]
s_lshr_b32 s79, 0x67234501, s78
ds_read_b128 a[136:139], v2 offset:18432
v_cvt_pk_bf16_f32 v200, v136, v137
v_mfma_f32_16x16x32_bf16 a[104:107], a[200:203], v[204:207], a[104:107]
s_and_b32 s79, s79, 7
v_exp_f32 v139, v139
v_mfma_f32_16x16x32_bf16 a[104:107], a[232:235], v[220:223], a[104:107]
s_lshl_b32 s79, s79, 18
ds_read_b128 a[140:143], v2 offset:19456
v_cvt_pk_bf16_f32 v201, v138, v139
v_mfma_f32_16x16x32_bf16 a[108:111], a[236:239], v[220:223], a[108:111]
s_add_u32 s79, s79, s94
v_exp_f32 v152, v152
v_mfma_f32_16x16x32_bf16 a[108:111], a[204:207], v[204:207], a[108:111]
s_add_u32 s12, s61, 0
ds_read_b128 a[144:147], v2 offset:20480
ds_read_b128 a[148:151], v2 offset:21504
v_mfma_f32_16x16x32_bf16 a[112:115], a[208:211], v[204:207], a[112:115]
s_waitcnt lgkmcnt(6)
buffer_load_dwordx4 v1, s[44:47], s72 offen offset:1024 sc1 lds
v_mfma_f32_16x16x32_bf16 a[112:115], a[240:243], v[220:223], a[112:115]
s_and_b32 s12, s12, 3
v_exp_f32 v153, v153
v_mfma_f32_16x16x32_bf16 a[116:119], a[244:247], v[220:223], a[116:119]
s_lshl_b32 s12, s12, 21
v_exp_f32 v154, v154
v_mfma_f32_16x16x32_bf16 a[116:119], a[212:215], v[204:207], a[116:119]
s_add_u32 s12, s12, s79
ds_read_b128 a[152:155], v2 offset:22528
v_cvt_pk_bf16_f32 v202, v152, v153
v_mfma_f32_16x16x32_bf16 a[120:123], a[216:219], v[204:207], a[120:123]
s_add_u32 s13, s61, 1
buffer_load_dwordx4 v1, s[44:47], s72 offen offset:2048 sc1 lds
v_mfma_f32_16x16x32_bf16 a[120:123], a[248:251], v[220:223], a[120:123]
s_and_b32 s13, s13, 3
v_exp_f32 v155, v155
v_mfma_f32_16x16x32_bf16 a[124:127], a[252:255], v[220:223], a[124:127]
s_lshl_b32 s13, s13, 21
ds_read_b128 a[156:159], v2 offset:23552
v_cvt_pk_bf16_f32 v203, v154, v155
v_mfma_f32_16x16x32_bf16 a[124:127], a[220:223], v[204:207], a[124:127]
s_add_u32 s13, s13, s79
v_exp_f32 v140, v140
s_cmp_eq_u32 s58, 2
s_cbranch_scc1 Lta31
s_cmp_eq_u32 s58, 3
s_cbranch_scc1 Lnt32
v_mfma_f32_16x16x32_bf16 v[168:171], a[160:163], v[48:51], v[112:115]
s_add_u32 s14, s61, 2
ds_read_b128 a[192:195], v2 offset:0
ds_read_b128 a[196:199], v2 offset:1024
v_mfma_f32_16x16x32_bf16 v[184:187], a[176:179], v[48:51], v[112:115]
s_and_b32 s14, s14, 3
v_exp_f32 v141, v141
s_branch Ljoin33
Lta31:
v_mfma_f32_16x16x32_bf16 v[168:171], a[160:163], v[48:51], v[104:107]
s_add_u32 s14, s61, 2
ds_read_b128 a[192:195], v2 offset:0
ds_read_b128 a[196:199], v2 offset:1024
v_mfma_f32_16x16x32_bf16 v[184:187], a[176:179], v[48:51], v[112:115]
s_and_b32 s14, s14, 3
v_exp_f32 v141, v141
s_branch Ljoin33
Lnt32:
v_mfma_f32_16x16x32_bf16 v[168:171], a[160:163], v[48:51], v[88:91]
s_add_u32 s14, s61, 2
ds_read_b128 a[192:195], v2 offset:0
ds_read_b128 a[196:199], v2 offset:1024
v_mfma_f32_16x16x32_bf16 v[184:187], a[176:179], v[48:51], v[104:107]
s_and_b32 s14, s14, 3
v_exp_f32 v141, v141
Ljoin33:
v_mfma_f32_16x16x32_bf16 v[172:175], a[160:163], v[64:67], v[92:95]
s_lshl_b32 s14, s14, 21
buffer_load_dwordx4 v1, s[44:47], s72 offen offset:3072 sc1 lds
v_mfma_f32_16x16x32_bf16 v[172:175], a[164:167], v[68:71], v[172:175]
s_add_u32 s66, s58, 0
v_exp_f32 v142, v142
v_mfma_f32_16x16x32_bf16 v[172:175], a[168:171], v[72:75], v[172:175]
s_and_b32 s66, s66, 3
ds_read_b128 a[200:203], v2 offset:2048
v_cvt_pk_bf16_f32 v204, v140, v141
v_mfma_f32_16x16x32_bf16 v[172:175], a[172:175], v[76:79], v[172:175]
s_mul_i32 s66, s66, 4160
v_exp_f32 v143, v143
v_mfma_f32_16x16x32_bf16 v[188:191], a[188:191], v[76:79], v[92:95]
s_add_u32 s66, s66, s92
ds_read_b128 a[204:207], v2 offset:3072
v_cvt_pk_bf16_f32 v205, v142, v143
v_mfma_f32_16x16x32_bf16 v[188:191], a[184:187], v[72:75], v[188:191]
s_add_u32 m0, s66, 16672
v_exp_f32 v156, v156
v_mfma_f32_16x16x32_bf16 v[188:191], a[180:183], v[68:71], v[188:191]
s_add_u32 s72, s93, 0x0
ds_read_b128 a[208:211], v2 offset:4096
ds_read_b128 a[212:215], v2 offset:5120
v_mfma_f32_16x16x32_bf16 v[188:191], a[176:179], v[64:67], v[188:191]
s_add_u32 s14, s14, s79
buffer_load_dwordx4 v1, s[36:39], s72 offen lds
v_mfma_f32_16x16x32_bf16 v[168:171], a[164:167], v[52:55], v[168:171]
s_add_u32 s15, s61, 3
v_exp_f32 v157, v157
v_mfma_f32_16x16x32_bf16 v[168:171], a[168:171], v[56:59], v[168:171]
s_and_b32 s15, s15, 3
v_exp_f32 v158, v158
v_mfma_f32_16x16x32_bf16 v[168:171], a[172:175], v[60:63], v[168:171]
s_lshl_b32 s15, s15, 21
ds_read_b128 a[216:219], v2 offset:6144
ds_read_b128 a[220:223], v2 offset:7168
v_mfma_f32_16x16x32_bf16 v[184:187], a[188:191], v[60:63], v[184:187]
s_add_u32 s15, s15, s79
buffer_load_dwordx4 v1, s[36:39], s72 offen offset:1024 lds
v_mfma_f32_16x16x32_bf16 v[184:187], a[184:187], v[56:59], v[184:187]
v_exp_f32 v159, v159
v_mfma_f32_16x16x32_bf16 v[184:187], a[180:183], v[52:55], v[184:187]
s_waitcnt lgkmcnt(4)
v_cvt_pk_bf16_f32 v206, v156, v157
v_cvt_pk_bf16_f32 v207, v158, v159
v_mfma_f32_16x16x32_bf16 v[232:235], v[120:123], v[216:219], v[232:235]
s_add_u32 s82, s82, 0x8000
ds_read_b128 a[160:163], v2 offset:24576
ds_read_b128 a[164:167], v2 offset:25600
v_mfma_f32_16x16x32_bf16 v[232:235], v[120:123], v[200:203], v[232:235]
s_and_b32 s82, s82, 0x1ffff
v_exp_f32 v172, v172
v_mfma_f32_16x16x32_bf16 a[64:67], a[224:227], v[216:219], a[64:67]
v_exp_f32 v173, v173
v_mfma_f32_16x16x32_bf16 a[64:67], a[192:195], v[200:203], a[64:67]
s_nop 0
ds_read_b128 a[168:171], v2 offset:26624
ds_read_b128 a[172:175], v2 offset:27648
v_mfma_f32_16x16x32_bf16 a[68:71], a[196:199], v[200:203], a[68:71]
v_exp_f32 v174, v174
v_mfma_f32_16x16x32_bf16 a[68:71], a[228:231], v[216:219], a[68:71]
v_exp_f32 v175, v175
v_mfma_f32_16x16x32_bf16 a[72:75], a[232:235], v[216:219], a[72:75]
s_nop 0
ds_read_b128 a[176:179], v2 offset:28672
ds_read_b128 a[180:183], v2 offset:29696
v_mfma_f32_16x16x32_bf16 a[72:75], a[200:203], v[200:203], a[72:75]
v_exp_f32 v188, v188
v_mfma_f32_16x16x32_bf16 a[76:79], a[204:207], v[200:203], a[76:79]
s_nop 0
ds_read_b128 a[184:187], v2 offset:30720
ds_read_b128 a[188:191], v2 offset:31744
v_mfma_f32_16x16x32_bf16 a[76:79], a[236:239], v[216:219], a[76:79]
s_nop 0
ds_read_b128 a[224:227], v2 offset:8192
ds_read_b128 a[228:231], v2 offset:9216
v_mfma_f32_16x16x32_bf16 a[80:83], a[240:243], v[216:219], a[80:83]
s_waitcnt lgkmcnt(10)
ds_read_b128 a[232:235], v2 offset:10240
ds_read_b128 a[236:239], v2 offset:11264
v_mfma_f32_16x16x32_bf16 a[80:83], a[208:211], v[200:203], a[80:83]
ds_read_b128 a[240:243], v2 offset:12288
v_cvt_pk_bf16_f32 v220, v172, v173
v_mfma_f32_16x16x32_bf16 a[84:87], a[212:215], v[200:203], a[84:87]
buffer_load_dwordx4 v1, s[36:39], s72 offen offset:2048 lds
v_mfma_f32_16x16x32_bf16 a[84:87], a[244:247], v[216:219], a[84:87]
v_exp_f32 v189, v189
v_mfma_f32_16x16x32_bf16 a[88:91], a[248:251], v[216:219], a[88:91]
v_exp_f32 v190, v190
v_mfma_f32_16x16x32_bf16 a[88:91], a[216:219], v[200:203], a[88:91]
s_nop 0
ds_read_b128 a[244:247], v2 offset:13312
ds_read_b128 a[248:251], v2 offset:14336
v_mfma_f32_16x16x32_bf16 a[92:95], a[220:223], v[200:203], a[92:95]
v_cvt_pk_bf16_f32 v221, v174, v175
v_cvt_pk_bf16_f32 v222, v188, v189
v_mfma_f32_16x16x32_bf16 a[92:95], a[252:255], v[216:219], a[92:95]
v_exp_f32 v191, v191
s_cmp_eq_u32 s58, 0
s_cbranch_scc1 Lta34
s_cmp_eq_u32 s58, 1
s_cbranch_scc1 Lnt35
v_mfma_f32_16x16x32_bf16 v[140:143], a[128:131], v[64:67], v[92:95]
v_exp_f32 v168, v168
v_mfma_f32_16x16x32_bf16 v[156:159], a[144:147], v[64:67], v[92:95]
v_exp_f32 v169, v169
s_branch Ljoin36
Lta34:
v_mfma_f32_16x16x32_bf16 v[140:143], a[128:131], v[64:67], v[108:111]
v_exp_f32 v168, v168
v_mfma_f32_16x16x32_bf16 v[156:159], a[144:147], v[64:67], v[112:115]
v_exp_f32 v169, v169
s_branch Ljoin36
Lnt35:
v_mfma_f32_16x16x32_bf16 v[140:143], a[128:131], v[64:67], v[92:95]
v_exp_f32 v168, v168
v_mfma_f32_16x16x32_bf16 v[156:159], a[144:147], v[64:67], v[108:111]
v_exp_f32 v169, v169
Ljoin36:
v_mfma_f32_16x16x32_bf16 v[140:143], a[132:135], v[68:71], v[140:143]
v_exp_f32 v170, v170
v_mfma_f32_16x16x32_bf16 v[140:143], a[136:139], v[72:75], v[140:143]
ds_read_b128 a[252:255], v2 offset:15360
v_cvt_pk_bf16_f32 v223, v190, v191
v_mfma_f32_16x16x32_bf16 v[140:143], a[140:143], v[76:79], v[140:143]
v_exp_f32 v171, v171
v_mfma_f32_16x16x32_bf16 v[156:159], a[156:159], v[76:79], v[156:159]
buffer_load_dwordx4 v1, s[36:39], s72 offen offset:3072 lds
v_mfma_f32_16x16x32_bf16 v[156:159], a[152:155], v[72:75], v[156:159]
s_waitcnt vmcnt(13) lgkmcnt(4)
v_exp_f32 v184, v184
v_mfma_f32_16x16x32_bf16 v[156:159], a[148:151], v[68:71], v[156:159]
s_barrier
v_cvt_pk_bf16_f32 v216, v168, v169
v_cvt_pk_bf16_f32 v217, v170, v171
v_add_u32 v2, s82, v1
v_exp_f32 v185, v185
v_exp_f32 v186, v186
v_cvt_pk_bf16_f32 v218, v184, v185
v_exp_f32 v187, v187
s_nop 0
v_cvt_pk_bf16_f32 v219, v186, v187
v_mfma_f32_16x16x32_bf16 v[236:239], v[120:123], v[204:207], v[236:239]
s_add_u32 s66, s58, 2
v_exp_f32 v140, v140
v_mfma_f32_16x16x32_bf16 v[236:239], v[120:123], v[220:223], v[236:239]
s_and_b32 s66, s66, 3
v_exp_f32 v141, v141
v_mfma_f32_16x16x32_bf16 a[96:99], a[192:195], v[204:207], a[96:99]
s_mul_i32 s66, s66, 4160
ds_read_b128 a[192:195], v2 offset:0
v_mfma_f32_16x16x32_bf16 a[96:99], a[224:227], v[220:223], a[96:99]
s_add_u32 s66, s66, s92
v_exp_f32 v142, v142
v_mfma_f32_16x16x32_bf16 a[100:103], a[228:231], v[220:223], a[100:103]
s_add_u32 m0, s66, 33312
v_exp_f32 v143, v143
v_mfma_f32_16x16x32_bf16 a[100:103], a[196:199], v[204:207], a[100:103]
s_add_u32 s72, s93, 0x4
buffer_load_dwordx4 v1, s[36:39], s72 offen lds
v_mfma_f32_16x16x32_bf16 a[104:107], a[200:203], v[204:207], a[104:107]
ds_read_b128 a[196:199], v2 offset:1024
v_mfma_f32_16x16x32_bf16 a[104:107], a[232:235], v[220:223], a[104:107]
buffer_load_dwordx4 v1, s[36:39], s72 offen offset:1024 lds
v_mfma_f32_16x16x32_bf16 a[108:111], a[236:239], v[220:223], a[108:111]
ds_read_b128 a[200:203], v2 offset:2048
v_mfma_f32_16x16x32_bf16 a[108:111], a[204:207], v[204:207], a[108:111]
buffer_load_dwordx4 v1, s[36:39], s72 offen offset:2048 lds
v_mfma_f32_16x16x32_bf16 a[112:115], a[208:211], v[204:207], a[112:115]
s_waitcnt lgkmcnt(3)
ds_read_b128 a[204:207], v2 offset:3072
v_mfma_f32_16x16x32_bf16 a[112:115], a[240:243], v[220:223], a[112:115]
buffer_load_dwordx4 v1, s[36:39], s72 offen offset:3072 lds
v_mfma_f32_16x16x32_bf16 a[116:119], a[244:247], v[220:223], a[116:119]
v_exp_f32 v156, v156
v_mfma_f32_16x16x32_bf16 a[116:119], a[212:215], v[204:207], a[116:119]
ds_read_b128 a[208:211], v2 offset:4096
v_mfma_f32_16x16x32_bf16 a[120:123], a[216:219], v[204:207], a[120:123]
buffer_load_dwordx4 v[80:83], v15, s[4:7], s80 offen
v_mfma_f32_16x16x32_bf16 a[120:123], a[248:251], v[220:223], a[120:123]
s_add_u32 s80, s80, 0x4000
v_exp_f32 v157, v157
v_mfma_f32_16x16x32_bf16 a[124:127], a[252:255], v[220:223], a[124:127]
ds_read_b128 a[212:215], v2 offset:5120
v_mfma_f32_16x16x32_bf16 a[124:127], a[220:223], v[204:207], a[124:127]
ds_read_b128 a[216:219], v2 offset:6144
v_cvt_pk_bf16_f32 v204, v140, v141
s_cmp_eq_u32 s58, 2
s_cbranch_scc1 Lta37
s_cmp_eq_u32 s58, 3
s_cbranch_scc1 Lnt38
v_mfma_f32_16x16x32_bf16 v[172:175], a[160:163], v[64:67], v[112:115]
buffer_load_dwordx4 v[84:87], v15, s[4:7], s80 offen
v_mfma_f32_16x16x32_bf16 v[188:191], a[176:179], v[64:67], v[112:115]
s_add_u32 s80, s80, 0x4000
v_exp_f32 v158, v158
s_branch Ljoin39
Lta37:
v_mfma_f32_16x16x32_bf16 v[172:175], a[160:163], v[64:67], v[108:111]
buffer_load_dwordx4 v[84:87], v15, s[4:7], s80 offen
v_mfma_f32_16x16x32_bf16 v[188:191], a[176:179], v[64:67], v[112:115]
s_add_u32 s80, s80, 0x4000
v_exp_f32 v158, v158
s_branch Ljoin39
Lnt38:
v_mfma_f32_16x16x32_bf16 v[172:175], a[160:163], v[64:67], v[92:95]
buffer_load_dwordx4 v[84:87], v15, s[4:7], s80 offen
v_mfma_f32_16x16x32_bf16 v[188:191], a[176:179], v[64:67], v[108:111]
s_add_u32 s80, s80, 0x4000
v_exp_f32 v158, v158
Ljoin39:
v_mfma_f32_16x16x32_bf16 v[172:175], a[164:167], v[68:71], v[172:175]
ds_read_b128 a[220:223], v2 offset:7168
v_cvt_pk_bf16_f32 v205, v142, v143
v_mfma_f32_16x16x32_bf16 v[172:175], a[168:171], v[72:75], v[172:175]
buffer_load_dwordx4 v[96:99], v15, s[4:7], s80 offen
v_mfma_f32_16x16x32_bf16 v[172:175], a[172:175], v[76:79], v[172:175]
s_add_u32 s80, s80, 0x4000
v_exp_f32 v159, v159
v_mfma_f32_16x16x32_bf16 v[188:191], a[188:191], v[76:79], v[188:191]
buffer_load_dwordx4 v[100:103], v15, s[4:7], s80 offen
v_mfma_f32_16x16x32_bf16 v[188:191], a[184:187], v[72:75], v[188:191]
v_cvt_pk_bf16_f32 v206, v156, v157
v_cvt_pk_bf16_f32 v207, v158, v159
v_mfma_f32_16x16x32_bf16 v[188:191], a[180:183], v[68:71], v[188:191]
s_waitcnt lgkmcnt(4)
v_mfma_f32_16x16x32_bf16 v[232:235], v[120:123], v[216:219], v[232:235]
s_add_u32 s82, s82, 0x8000
v_exp_f32 v172, v172
v_mfma_f32_16x16x32_bf16 a[64:67], a[224:227], v[216:219], a[64:67]
s_and_b32 s82, s82, 0x1ffff
ds_read_b128 a[224:227], v2 offset:8192
v_mfma_f32_16x16x32_bf16 a[68:71], a[228:231], v[216:219], a[68:71]
ds_read_b128 a[228:231], v2 offset:9216
v_mfma_f32_16x16x32_bf16 a[72:75], a[232:235], v[216:219], a[72:75]
v_exp_f32 v173, v173
v_mfma_f32_16x16x32_bf16 a[76:79], a[236:239], v[216:219], a[76:79]
s_nop 0
ds_read_b128 a[232:235], v2 offset:10240
ds_read_b128 a[236:239], v2 offset:11264
v_mfma_f32_16x16x32_bf16 a[80:83], a[240:243], v[216:219], a[80:83]
ds_read_b128 a[240:243], v2 offset:12288
v_cvt_pk_bf16_f32 v220, v172, v173
v_mfma_f32_16x16x32_bf16 a[84:87], a[244:247], v[216:219], a[84:87]
ds_read_b128 a[244:247], v2 offset:13312
v_mfma_f32_16x16x32_bf16 a[88:91], a[248:251], v[216:219], a[88:91]
v_exp_f32 v174, v174
v_mfma_f32_16x16x32_bf16 a[92:95], a[252:255], v[216:219], a[92:95]
v_exp_f32 v175, v175
ds_read_b128 a[248:251], v2 offset:14336
ds_read_b128 a[252:255], v2 offset:15360
v_add_u32 v2, s82, v1
v_exp_f32 v188, v188
v_cvt_pk_bf16_f32 v221, v174, v175
v_exp_f32 v189, v189
v_exp_f32 v190, v190
v_cvt_pk_bf16_f32 v222, v188, v189
v_exp_f32 v191, v191
s_nop 0
v_cvt_pk_bf16_f32 v223, v190, v191
s_waitcnt vmcnt(4) lgkmcnt(0)
s_barrier
LHT4:
Lstub7:
s_cbranch_execz Lstub11
v_mfma_f32_16x16x32_bf16 v[236:239], v[120:123], v[204:207], v[236:239]
ds_write_b64 v5, v[12:13]
v_mov_b32 v240, 0
v_mfma_f32_16x16x32_bf16 v[236:239], v[120:123], v[220:223], v[236:239]
v_mov_b32 v241, 0
v_mfma_f32_16x16x32_bf16 a[96:99], a[192:195], v[204:207], a[96:99]
s_nop 0
ds_write_b64 v14, v[240:241]
ds_read_b64 a[128:129], v6 offset:0
v_mfma_f32_16x16x32_bf16 a[96:99], a[224:227], v[220:223], a[96:99]
s_nop 0
ds_read_b64 a[130:131], v6 offset:8
ds_read_b128 a[192:195], v7 offset:3584
v_mfma_f32_16x16x32_bf16 a[100:103], a[228:231], v[220:223], a[100:103]
s_nop 0
ds_read_b64 a[132:133], v6 offset:512
ds_read_b64 a[134:135], v6 offset:520
v_mfma_f32_16x16x32_bf16 a[100:103], a[196:199], v[204:207], a[100:103]
s_nop 0
ds_read_b128 a[196:199], v7 offset:3072
ds_read_b64 a[136:137], v6 offset:1024
v_mfma_f32_16x16x32_bf16 a[104:107], a[200:203], v[204:207], a[104:107]
s_nop 0
ds_read_b64 a[138:139], v6 offset:1032
ds_read_b128 a[200:203], v7 offset:2560
v_mfma_f32_16x16x32_bf16 a[104:107], a[232:235], v[220:223], a[104:107]
v_mfma_f32_16x16x32_bf16 a[108:111], a[236:239], v[220:223], a[108:111]
s_nop 0
ds_read_b64 a[140:141], v6 offset:1536
ds_read_b64 a[142:143], v6 offset:1544
v_mfma_f32_16x16x32_bf16 a[108:111], a[204:207], v[204:207], a[108:111]
s_nop 0
ds_read_b128 a[204:207], v7 offset:2048
ds_read_b64 a[144:145], v6 offset:2048
v_mfma_f32_16x16x32_bf16 a[112:115], a[208:211], v[204:207], a[112:115]
s_lshl_b32 s73, s52, 12
ds_read_b64 a[146:147], v6 offset:2056
ds_read_b128 a[208:211], v7 offset:1536
v_mfma_f32_16x16x32_bf16 a[112:115], a[240:243], v[220:223], a[112:115]
s_add_u32 s73, s73, 0x2000000
v_mfma_f32_16x16x32_bf16 a[116:119], a[244:247], v[220:223], a[116:119]
s_lshl_b32 s70, s68, 2
ds_read_b64 a[148:149], v6 offset:2560
ds_read_b64 a[150:151], v6 offset:2568
v_mfma_f32_16x16x32_bf16 a[116:119], a[212:215], v[204:207], a[116:119]
s_add_u32 s70, s70, s73
ds_read_b128 a[212:215], v7 offset:1024
ds_read_b64 a[152:153], v6 offset:3072
v_mfma_f32_16x16x32_bf16 a[120:123], a[216:219], v[204:207], a[120:123]
s_nop 0
ds_read_b64 a[154:155], v6 offset:3080
ds_read_b128 a[216:219], v7 offset:512
v_mfma_f32_16x16x32_bf16 a[120:123], a[248:251], v[220:223], a[120:123]
v_mfma_f32_16x16x32_bf16 a[124:127], a[252:255], v[220:223], a[124:127]
s_xor_b32 s71, s12, 0x80
ds_read_b64 a[156:157], v6 offset:3584
ds_read_b64 a[158:159], v6 offset:3592
v_mfma_f32_16x16x32_bf16 a[124:127], a[220:223], v[204:207], a[124:127]
s_add_u32 m0, s77, 0
ds_read_b128 a[220:223], v7 offset:0
s_waitcnt lgkmcnt(0)
v_mfma_f32_16x16x32_bf16 v[128:131], v[8:11], a[192:195], 0
s_add_u32 s72, s71, 0
buffer_load_dwordx4 v15, s[24:27], s72 offen lds
v_mfma_f32_16x16x32_bf16 v[128:131], a[128:131], a[192:195], v[128:131]
v_mfma_f32_16x16x32_bf16 v[132:135], v[8:11], a[196:199], 0
s_nop 0
ds_read_b128 a[224:227], v7 offset:3648
ds_read_b64 a[160:161], v6 offset:64
v_mfma_f32_16x16x32_bf16 v[132:135], a[128:131], a[196:199], v[132:135]
v_accvgpr_read_b32 v240, a64
v_accvgpr_read_b32 v241, a65
v_accvgpr_read_b32 v242, a66
v_mfma_f32_16x16x32_bf16 v[132:135], a[132:135], a[192:195], v[132:135]
s_add_u32 s72, s71, 15360
buffer_load_dwordx4 v15, s[24:27], s72 offen offset:1024 lds
v_accvgpr_read_b32 v243, a67
v_mfma_f32_16x16x32_bf16 v[136:139], v[8:11], a[200:203], 0
s_nop 0
ds_read_b64 a[162:163], v6 offset:72
ds_read_b128 a[228:231], v7 offset:3136
v_mfma_f32_16x16x32_bf16 v[136:139], a[128:131], a[200:203], v[136:139]
s_lshl_b32 s95, s75, 20
v_rcp_f32 v232, v232
v_mfma_f32_16x16x32_bf16 v[136:139], a[132:135], a[196:199], v[136:139]
s_lshl_b32 s74, s58, 18
v_rcp_f32 v236, v236
v_accvgpr_read_b32 v244, a68
v_mfma_f32_16x16x32_bf16 v[136:139], a[136:139], a[192:195], v[136:139]
s_add_u32 s95, s95, s74
ds_read_b64 a[164:165], v6 offset:576
ds_read_b64 a[166:167], v6 offset:584
v_accvgpr_read_b32 v245, a69
v_mfma_f32_16x16x32_bf16 v[140:143], v[8:11], a[204:207], 0
s_add_u32 s72, s71, 30720
buffer_load_dwordx4 v15, s[24:27], s72 offen offset:2048 lds
v_accvgpr_read_b32 v246, a70
v_mfma_f32_16x16x32_bf16 v[140:143], a[128:131], a[204:207], v[140:143]
s_add_u32 s95, s95, 0x2000000
v_accvgpr_read_b32 v247, a71
v_mul_f32 v240, v240, v232
v_mul_f32 v241, v241, v232
v_mfma_f32_16x16x32_bf16 v[140:143], a[132:135], a[200:203], v[140:143]
s_sub_u32 s74, 15, s75
ds_read_b128 a[232:235], v7 offset:2624
ds_read_b64 a[168:169], v6 offset:1088
v_mul_f32 v242, v242, v232
v_mfma_f32_16x16x32_bf16 v[140:143], a[136:139], a[196:199], v[140:143]
s_add_u32 s72, s71, 46080
buffer_load_dwordx4 v15, s[24:27], s72 offen offset:3072 lds
v_mul_f32 v243, v243, v232
v_mfma_f32_16x16x32_bf16 v[140:143], a[140:143], a[192:195], v[140:143]
s_min_u32 s74, s74, s75
v_mul_f32 v244, v244, v232
v_mul_f32 v245, v245, v232
v_mul_f32 v246, v246, v232
v_mfma_f32_16x16x32_bf16 v[144:147], v[8:11], a[208:211], 0
s_lshl_b32 s74, s74, 7
ds_read_b64 a[170:171], v6 offset:1096
ds_read_b128 a[236:239], v7 offset:2112
v_mul_f32 v247, v247, v232
v_mfma_f32_16x16x32_bf16 v[144:147], a[128:131], a[208:211], v[144:147]
s_add_u32 s74, s74, 0x3810000
v_cvt_pk_bf16_f32 v240, v240, v241
v_cvt_pk_bf16_f32 v241, v242, v243
v_cvt_pk_bf16_f32 v242, v244, v245
v_mfma_f32_16x16x32_bf16 v[144:147], a[132:135], a[204:207], v[144:147]
s_xor_b32 s85, s77, 0x10000
v_cvt_pk_bf16_f32 v243, v246, v247
v_mfma_f32_16x16x32_bf16 v[144:147], a[136:139], a[200:203], v[144:147]
s_nop 0
ds_read_b64 a[172:173], v6 offset:1600
ds_read_b64 a[174:175], v6 offset:1608
v_mfma_f32_16x16x32_bf16 v[144:147], a[140:143], a[196:199], v[144:147]
Lstub8:
s_cbranch_execz Lret
buffer_store_dwordx4 v[240:243], v1, s[44:47], s70 offen sc1
v_mfma_f32_16x16x32_bf16 v[144:147], a[144:147], a[192:195], v[144:147]
v_accvgpr_read_b32 v248, a72
v_accvgpr_read_b32 v249, a73
v_accvgpr_read_b32 v250, a74
v_mfma_f32_16x16x32_bf16 v[148:151], v[8:11], a[212:215], 0
s_nop 0
ds_read_b128 a[240:243], v7 offset:1600
ds_read_b64 a[176:177], v6 offset:2112
v_accvgpr_read_b32 v251, a75
v_mfma_f32_16x16x32_bf16 v[148:151], a[128:131], a[212:215], v[148:151]
v_accvgpr_read_b32 v252, a76
v_accvgpr_read_b32 v253, a77
v_accvgpr_read_b32 v254, a78
v_mfma_f32_16x16x32_bf16 v[148:151], a[132:135], a[208:211], v[148:151]
v_accvgpr_read_b32 v255, a79
v_mul_f32 v248, v248, v232
v_mul_f32 v249, v249, v232
v_mfma_f32_16x16x32_bf16 v[148:151], a[136:139], a[204:207], v[148:151]
s_nop 0
ds_read_b64 a[178:179], v6 offset:2120
ds_read_b128 a[244:247], v7 offset:1088
v_mul_f32 v250, v250, v232
v_mfma_f32_16x16x32_bf16 v[148:151], a[140:143], a[200:203], v[148:151]
v_mul_f32 v251, v251, v232
v_mul_f32 v252, v252, v232
v_mul_f32 v253, v253, v232
v_mfma_f32_16x16x32_bf16 v[148:151], a[144:147], a[196:199], v[148:151]
v_mul_f32 v254, v254, v232
v_mul_f32 v255, v255, v232
v_cvt_pk_bf16_f32 v248, v248, v249
v_mfma_f32_16x16x32_bf16 v[148:151], a[148:151], a[192:195], v[148:151]
s_nop 0
ds_read_b64 a[180:181], v6 offset:2624
ds_read_b64 a[182:183], v6 offset:2632
v_cvt_pk_bf16_f32 v249, v250, v251
v_mfma_f32_16x16x32_bf16 v[152:155], v[8:11], a[216:219], 0
v_cvt_pk_bf16_f32 v250, v252, v253
v_cvt_pk_bf16_f32 v251, v254, v255
v_mfma_f32_16x16x32_bf16 v[152:155], a[128:131], a[216:219], v[152:155]
buffer_store_dwordx4 v[248:251], v1, s[44:47], s70 offen offset:1024 sc1
v_mfma_f32_16x16x32_bf16 v[152:155], a[132:135], a[212:215], v[152:155]
s_nop 0
ds_read_b128 a[248:251], v7 offset:576
ds_read_b64 a[184:185], v6 offset:3136
v_accvgpr_read_b32 v240, a80
v_mfma_f32_16x16x32_bf16 v[152:155], a[136:139], a[208:211], v[152:155]
v_accvgpr_read_b32 v241, a81
v_accvgpr_read_b32 v242, a82
v_accvgpr_read_b32 v243, a83
v_mfma_f32_16x16x32_bf16 v[152:155], a[140:143], a[204:207], v[152:155]
v_accvgpr_read_b32 v244, a84
v_accvgpr_read_b32 v245, a85
v_accvgpr_read_b32 v246, a86
v_mfma_f32_16x16x32_bf16 v[152:155], a[144:147], a[200:203], v[152:155]
s_nop 0
ds_read_b64 a[186:187], v6 offset:3144
ds_read_b128 a[252:255], v7 offset:64
v_accvgpr_read_b32 v247, a87
v_mfma_f32_16x16x32_bf16 v[152:155], a[148:151], a[196:199], v[152:155]
v_mul_f32 v240, v240, v232
v_mul_f32 v241, v241, v232
v_mul_f32 v242, v242, v232
v_mfma_f32_16x16x32_bf16 v[152:155], a[152:155], a[192:195], v[152:155]
v_mul_f32 v243, v243, v232
v_mul_f32 v244, v244, v232
v_mul_f32 v245, v245, v232
v_mfma_f32_16x16x32_bf16 v[156:159], v[8:11], a[220:223], 0
s_nop 0
ds_read_b64 a[188:189], v6 offset:3648
ds_read_b64 a[190:191], v6 offset:3656
v_mul_f32 v246, v246, v232
v_mfma_f32_16x16x32_bf16 v[156:159], a[128:131], a[220:223], v[156:159]
v_mul_f32 v247, v247, v232
v_cvt_pk_bf16_f32 v240, v240, v241
v_cvt_pk_bf16_f32 v241, v242, v243
v_mfma_f32_16x16x32_bf16 v[156:159], a[132:135], a[216:219], v[156:159]
v_cvt_pk_bf16_f32 v242, v244, v245
v_cvt_pk_bf16_f32 v243, v246, v247
v_mfma_f32_16x16x32_bf16 v[156:159], a[136:139], a[212:215], v[156:159]
buffer_store_dwordx4 v[240:243], v1, s[44:47], s70 offen offset:2048 sc1
v_mfma_f32_16x16x32_bf16 v[156:159], a[140:143], a[208:211], v[156:159]
v_accvgpr_read_b32 v248, a88
v_accvgpr_read_b32 v249, a89
v_accvgpr_read_b32 v250, a90
v_mfma_f32_16x16x32_bf16 v[156:159], a[144:147], a[204:207], v[156:159]
v_accvgpr_read_b32 v251, a91
v_accvgpr_read_b32 v252, a92
v_accvgpr_read_b32 v253, a93
v_mfma_f32_16x16x32_bf16 v[156:159], a[148:151], a[200:203], v[156:159]
v_accvgpr_read_b32 v254, a94
v_accvgpr_read_b32 v255, a95
v_mul_f32 v248, v248, v232
v_mfma_f32_16x16x32_bf16 v[156:159], a[152:155], a[196:199], v[156:159]
v_mul_f32 v249, v249, v232
v_mul_f32 v250, v250, v232
v_mul_f32 v251, v251, v232
v_mfma_f32_16x16x32_bf16 v[156:159], a[156:159], a[192:195], v[156:159]
s_waitcnt lgkmcnt(0)
v_mul_f32 v252, v252, v232
v_mul_f32 v253, v253, v232
v_mul_f32 v254, v254, v232
v_mfma_f32_16x16x32_bf16 v[128:131], a[160:163], a[224:227], v[128:131]
s_nop 0
ds_read_b128 a[192:195], v7 offset:3712
ds_read_b64 a[128:129], v6 offset:128
v_mul_f32 v255, v255, v232
v_mfma_f32_16x16x32_bf16 v[132:135], a[164:167], a[224:227], v[132:135]
v_cvt_pk_bf16_f32 v248, v248, v249
v_cvt_pk_bf16_f32 v249, v250, v251
v_cvt_pk_bf16_f32 v250, v252, v253
v_mfma_f32_16x16x32_bf16 v[132:135], a[160:163], a[228:231], v[132:135]
s_nop 0
ds_read_b64 a[130:131], v6 offset:136
ds_read_b128 a[196:199], v7 offset:3200
v_cvt_pk_bf16_f32 v251, v254, v255
v_mfma_f32_16x16x32_bf16 v[136:139], a[160:163], a[232:235], v[136:139]
buffer_store_dwordx4 v[248:251], v1, s[44:47], s70 offen offset:3072 sc1
v_mfma_f32_16x16x32_bf16 v[136:139], a[164:167], a[228:231], v[136:139]
s_add_u32 s70, s70, 0x80000
v_accvgpr_read_b32 v240, a96
v_accvgpr_read_b32 v241, a97
v_accvgpr_read_b32 v242, a98
v_mfma_f32_16x16x32_bf16 v[136:139], a[168:171], a[224:227], v[136:139]
s_nop 0
ds_read_b64 a[132:133], v6 offset:640
ds_read_b64 a[134:135], v6 offset:648
v_accvgpr_read_b32 v243, a99
v_mfma_f32_16x16x32_bf16 v[140:143], a[172:175], a[224:227], v[140:143]
v_accvgpr_read_b32 v244, a100
v_accvgpr_read_b32 v245, a101
v_accvgpr_read_b32 v246, a102
v_mfma_f32_16x16x32_bf16 v[140:143], a[168:171], a[228:231], v[140:143]
s_nop 0
ds_read_b128 a[200:203], v7 offset:2688
ds_read_b64 a[136:137], v6 offset:1152
v_accvgpr_read_b32 v247, a103
v_mfma_f32_16x16x32_bf16 v[140:143], a[164:167], a[232:235], v[140:143]
v_mul_f32 v240, v240, v236
v_mul_f32 v241, v241, v236
v_mul_f32 v242, v242, v236
v_mfma_f32_16x16x32_bf16 v[140:143], a[160:163], a[236:239], v[140:143]
v_mul_f32 v243, v243, v236
v_mul_f32 v244, v244, v236
v_mul_f32 v245, v245, v236
v_mfma_f32_16x16x32_bf16 v[144:147], a[160:163], a[240:243], v[144:147]
s_nop 0
ds_read_b64 a[138:139], v6 offset:1160
ds_read_b128 a[204:207], v7 offset:2176
v_mul_f32 v246, v246, v236
v_mfma_f32_16x16x32_bf16 v[144:147], a[164:167], a[236:239], v[144:147]
v_mul_f32 v247, v247, v236
v_cvt_pk_bf16_f32 v240, v240, v241
v_cvt_pk_bf16_f32 v241, v242, v243
v_mfma_f32_16x16x32_bf16 v[144:147], a[168:171], a[232:235], v[144:147]
s_nop 0
ds_read_b64 a[140:141], v6 offset:1664
ds_read_b64 a[142:143], v6 offset:1672
v_cvt_pk_bf16_f32 v242, v244, v245
v_mfma_f32_16x16x32_bf16 v[144:147], a[172:175], a[228:231], v[144:147]
v_cvt_pk_bf16_f32 v243, v246, v247
v_mfma_f32_16x16x32_bf16 v[144:147], a[176:179], a[224:227], v[144:147]
buffer_store_dwordx4 v[240:243], v1, s[44:47], s70 offen sc1
v_mfma_f32_16x16x32_bf16 v[148:151], a[180:183], a[224:227], v[148:151]
s_nop 0
ds_read_b128 a[208:211], v7 offset:1664
ds_read_b64 a[144:145], v6 offset:2176
v_accvgpr_read_b32 v248, a104
v_mfma_f32_16x16x32_bf16 v[148:151], a[176:179], a[228:231], v[148:151]
v_accvgpr_read_b32 v249, a105
v_accvgpr_read_b32 v250, a106
v_accvgpr_read_b32 v251, a107
v_mfma_f32_16x16x32_bf16 v[148:151], a[172:175], a[232:235], v[148:151]
v_accvgpr_read_b32 v252, a108
v_accvgpr_read_b32 v253, a109
v_accvgpr_read_b32 v254, a110
v_mfma_f32_16x16x32_bf16 v[148:151], a[168:171], a[236:239], v[148:151]
s_nop 0
ds_read_b64 a[146:147], v6 offset:2184
ds_read_b128 a[212:215], v7 offset:1152
v_accvgpr_read_b32 v255, a111
v_mfma_f32_16x16x32_bf16 v[148:151], a[164:167], a[240:243], v[148:151]
v_mul_f32 v248, v248, v236
v_mul_f32 v249, v249, v236
v_mul_f32 v250, v250, v236
v_mfma_f32_16x16x32_bf16 v[148:151], a[160:163], a[244:247], v[148:151]
s_nop 0
ds_read_b64 a[148:149], v6 offset:2688
ds_read_b64 a[150:151], v6 offset:2696
v_mul_f32 v251, v251, v236
v_mfma_f32_16x16x32_bf16 v[152:155], a[160:163], a[248:251], v[152:155]
v_mul_f32 v252, v252, v236
v_mul_f32 v253, v253, v236
v_mul_f32 v254, v254, v236
v_mfma_f32_16x16x32_bf16 v[152:155], a[164:167], a[244:247], v[152:155]
v_mul_f32 v255, v255, v236
v_cvt_pk_bf16_f32 v248, v248, v249
v_cvt_pk_bf16_f32 v249, v250, v251
v_mfma_f32_16x16x32_bf16 v[152:155], a[168:171], a[240:243], v[152:155]
s_nop 0
ds_read_b128 a[216:219], v7 offset:640
ds_read_b64 a[152:153], v6 offset:3200
v_cvt_pk_bf16_f32 v250, v252, v253
v_mfma_f32_16x16x32_bf16 v[152:155], a[172:175], a[236:239], v[152:155]
v_cvt_pk_bf16_f32 v251, v254, v255
v_mfma_f32_16x16x32_bf16 v[152:155], a[176:179], a[232:235], v[152:155]
s_nop 0
ds_read_b64 a[154:155], v6 offset:3208
ds_read_b128 a[220:223], v7 offset:128
v_mfma_f32_16x16x32_bf16 v[152:155], a[180:183], a[228:231], v[152:155]
buffer_store_dwordx4 v[248:251], v1, s[44:47], s70 offen offset:1024 sc1
v_mfma_f32_16x16x32_bf16 v[152:155], a[184:187], a[224:227], v[152:155]
v_accvgpr_read_b32 v240, a112
v_accvgpr_read_b32 v241, a113
v_accvgpr_read_b32 v242, a114
v_mfma_f32_16x16x32_bf16 v[156:159], a[188:191], a[224:227], v[156:159]
s_nop 0
ds_read_b64 a[156:157], v6 offset:3712
ds_read_b64 a[158:159], v6 offset:3720
v_accvgpr_read_b32 v243, a115
v_mfma_f32_16x16x32_bf16 v[156:159], a[184:187], a[228:231], v[156:159]
v_accvgpr_read_b32 v244, a116
v_accvgpr_read_b32 v245, a117
v_accvgpr_read_b32 v246, a118
v_mfma_f32_16x16x32_bf16 v[156:159], a[180:183], a[232:235], v[156:159]
v_accvgpr_read_b32 v247, a119
v_mul_f32 v240, v240, v236
v_mul_f32 v241, v241, v236
v_mfma_f32_16x16x32_bf16 v[156:159], a[176:179], a[236:239], v[156:159]
v_mul_f32 v242, v242, v236
v_mul_f32 v243, v243, v236
v_mul_f32 v244, v244, v236
v_mfma_f32_16x16x32_bf16 v[156:159], a[172:175], a[240:243], v[156:159]
v_mul_f32 v245, v245, v236
v_mul_f32 v246, v246, v236
v_mul_f32 v247, v247, v236
v_mfma_f32_16x16x32_bf16 v[156:159], a[168:171], a[244:247], v[156:159]
v_cvt_pk_bf16_f32 v240, v240, v241
v_cvt_pk_bf16_f32 v241, v242, v243
v_cvt_pk_bf16_f32 v242, v244, v245
v_mfma_f32_16x16x32_bf16 v[156:159], a[164:167], a[248:251], v[156:159]
v_cvt_pk_bf16_f32 v243, v246, v247
v_mfma_f32_16x16x32_bf16 v[156:159], a[160:163], a[252:255], v[156:159]
s_waitcnt lgkmcnt(0)
buffer_store_dwordx4 v[240:243], v1, s[44:47], s70 offen offset:2048 sc1
v_mfma_f32_16x16x32_bf16 v[128:131], a[128:131], a[192:195], v[128:131]
s_nop 0
ds_read_b128 a[224:227], v7 offset:3776
ds_read_b64 a[160:161], v6 offset:192
v_accvgpr_read_b32 v248, a120
v_mfma_f32_16x16x32_bf16 v[132:135], a[132:135], a[192:195], v[132:135]
v_accvgpr_read_b32 v249, a121
v_accvgpr_read_b32 v250, a122
v_accvgpr_read_b32 v251, a123
v_mfma_f32_16x16x32_bf16 v[132:135], a[128:131], a[196:199], v[132:135]
s_nop 0
ds_read_b64 a[162:163], v6 offset:200
ds_read_b128 a[228:231], v7 offset:3264
v_accvgpr_read_b32 v252, a124
v_mfma_f32_16x16x32_bf16 v[136:139], a[128:131], a[200:203], v[136:139]
v_accvgpr_read_b32 v253, a125
v_accvgpr_read_b32 v254, a126
v_accvgpr_read_b32 v255, a127
v_mfma_f32_16x16x32_bf16 v[136:139], a[132:135], a[196:199], v[136:139]
v_mul_f32 v248, v248, v236
v_mul_f32 v249, v249, v236
v_mul_f32 v250, v250, v236
v_mfma_f32_16x16x32_bf16 v[136:139], a[136:139], a[192:195], v[136:139]
s_nop 0
ds_read_b64 a[164:165], v6 offset:704
ds_read_b64 a[166:167], v6 offset:712
v_mul_f32 v251, v251, v236
v_mfma_f32_16x16x32_bf16 v[140:143], a[140:143], a[192:195], v[140:143]
v_mul_f32 v252, v252, v236
v_mul_f32 v253, v253, v236
v_mul_f32 v254, v254, v236
v_mfma_f32_16x16x32_bf16 v[140:143], a[136:139], a[196:199], v[140:143]
s_nop 0
ds_read_b128 a[232:235], v7 offset:2752
ds_read_b64 a[168:169], v6 offset:1216
v_mul_f32 v255, v255, v236
v_mfma_f32_16x16x32_bf16 v[140:143], a[132:135], a[200:203], v[140:143]
v_cvt_pk_bf16_f32 v248, v248, v249
v_cvt_pk_bf16_f32 v249, v250, v251
v_cvt_pk_bf16_f32 v250, v252, v253
v_mfma_f32_16x16x32_bf16 v[140:143], a[128:131], a[204:207], v[140:143]
v_cvt_pk_bf16_f32 v251, v254, v255
v_mfma_f32_16x16x32_bf16 v[144:147], a[128:131], a[208:211], v[144:147]
s_nop 0
ds_read_b64 a[170:171], v6 offset:1224
ds_read_b128 a[236:239], v7 offset:2240
v_mfma_f32_16x16x32_bf16 v[144:147], a[132:135], a[204:207], v[144:147]
buffer_store_dwordx4 v[248:251], v1, s[44:47], s70 offen offset:3072 sc1
v_mfma_f32_16x16x32_bf16 v[144:147], a[136:139], a[200:203], v[144:147]
s_mov_b32 s73, 0x6f800000
ds_read_b64 a[172:173], v6 offset:1728
ds_read_b64 a[174:175], v6 offset:1736
v_add_f32 v227, v226, v230
v_mfma_f32_16x16x32_bf16 v[144:147], a[140:143], a[196:199], v[144:147]
v_add_f32 v231, v234, v238
v_add_f32 v227, v227, v231
v_cmp_nlt_f32 vcc, v227, s73
v_mfma_f32_16x16x32_bf16 v[144:147], a[144:147], a[192:195], v[144:147]
s_lshl_b32 s73, s58, 2
v_mfma_f32_16x16x32_bf16 v[148:151], a[148:151], a[192:195], v[148:151]
s_add_u32 s73, s73, 163328
ds_read_b128 a[240:243], v7 offset:1728
ds_read_b64 a[176:177], v6 offset:2240
v_mov_b32 v231, s73
v_mfma_f32_16x16x32_bf16 v[148:151], a[144:147], a[196:199], v[148:151]
s_or_b32 s73, vcc_lo, vcc_hi
v_mfma_f32_16x16x32_bf16 v[148:151], a[140:143], a[200:203], v[148:151]
s_min_u32 s73, s73, 1
v_mov_b32 v227, s73
v_mfma_f32_16x16x32_bf16 v[148:151], a[136:139], a[204:207], v[148:151]
s_nop 0
ds_read_b64 a[178:179], v6 offset:2248
ds_read_b128 a[244:247], v7 offset:1216
ds_write_b32 v231, v227
v_mfma_f32_16x16x32_bf16 v[148:151], a[132:135], a[208:211], v[148:151]
v_mfma_f32_16x16x32_bf16 v[148:151], a[128:131], a[212:215], v[148:151]
s_nop 0
ds_read_b64 a[180:181], v6 offset:2752
ds_read_b64 a[182:183], v6 offset:2760
v_mfma_f32_16x16x32_bf16 v[152:155], a[128:131], a[216:219], v[152:155]
v_mfma_f32_16x16x32_bf16 v[152:155], a[132:135], a[212:215], v[152:155]
v_mfma_f32_16x16x32_bf16 v[152:155], a[136:139], a[208:211], v[152:155]
s_nop 0
ds_read_b128 a[248:251], v7 offset:704
ds_read_b64 a[184:185], v6 offset:3264
v_mfma_f32_16x16x32_bf16 v[152:155], a[140:143], a[204:207], v[152:155]
v_mfma_f32_16x16x32_bf16 v[152:155], a[144:147], a[200:203], v[152:155]
s_nop 0
ds_read_b64 a[186:187], v6 offset:3272
ds_read_b128 a[252:255], v7 offset:192
v_mfma_f32_16x16x32_bf16 v[152:155], a[148:151], a[196:199], v[152:155]
v_mfma_f32_16x16x32_bf16 v[152:155], a[152:155], a[192:195], v[152:155]
v_mfma_f32_16x16x32_bf16 v[156:159], a[156:159], a[192:195], v[156:159]
s_nop 0
ds_read_b64 a[188:189], v6 offset:3776
ds_read_b64 a[190:191], v6 offset:3784
v_mfma_f32_16x16x32_bf16 v[156:159], a[152:155], a[196:199], v[156:159]
v_mfma_f32_16x16x32_bf16 v[156:159], a[148:151], a[200:203], v[156:159]
v_mfma_f32_16x16x32_bf16 v[156:159], a[144:147], a[204:207], v[156:159]
v_mfma_f32_16x16x32_bf16 v[156:159], a[140:143], a[208:211], v[156:159]
v_mfma_f32_16x16x32_bf16 v[156:159], a[136:139], a[212:215], v[156:159]
v_mfma_f32_16x16x32_bf16 v[156:159], a[132:135], a[216:219], v[156:159]
v_mfma_f32_16x16x32_bf16 v[156:159], a[128:131], a[220:223], v[156:159]
s_waitcnt lgkmcnt(0)
v_mfma_f32_16x16x32_bf16 v[128:131], a[160:163], a[224:227], v[128:131]
s_nop 0
ds_read_b128 a[192:195], v7 offset:3840
ds_read_b64 a[128:129], v6 offset:256
v_mfma_f32_16x16x32_bf16 v[132:135], a[164:167], a[224:227], v[132:135]
v_mfma_f32_16x16x32_bf16 v[132:135], a[160:163], a[228:231], v[132:135]
s_nop 0
ds_read_b64 a[130:131], v6 offset:264
ds_read_b128 a[196:199], v7 offset:3328
v_mfma_f32_16x16x32_bf16 v[136:139], a[160:163], a[232:235], v[136:139]
v_mfma_f32_16x16x32_bf16 v[136:139], a[164:167], a[228:231], v[136:139]
v_mfma_f32_16x16x32_bf16 v[136:139], a[168:171], a[224:227], v[136:139]
s_nop 0
ds_read_b64 a[132:133], v6 offset:768
ds_read_b64 a[134:135], v6 offset:776
v_mfma_f32_16x16x32_bf16 v[140:143], a[172:175], a[224:227], v[140:143]
v_mfma_f32_16x16x32_bf16 v[140:143], a[168:171], a[228:231], v[140:143]
s_nop 0
ds_read_b128 a[200:203], v7 offset:2816
ds_read_b64 a[136:137], v6 offset:1280
v_mfma_f32_16x16x32_bf16 v[140:143], a[164:167], a[232:235], v[140:143]
v_mfma_f32_16x16x32_bf16 v[140:143], a[160:163], a[236:239], v[140:143]
v_mfma_f32_16x16x32_bf16 v[144:147], a[160:163], a[240:243], v[144:147]
s_nop 0
ds_read_b64 a[138:139], v6 offset:1288
ds_read_b128 a[204:207], v7 offset:2304
v_mfma_f32_16x16x32_bf16 v[144:147], a[164:167], a[236:239], v[144:147]
s_nop 3
s_mov_b64 exec, 0
s_cmp_eq_u32 s58, 0
s_cbranch_scc1 Lstube0
s_cmp_eq_u32 s58, 1
s_cbranch_scc1 Lstube1
s_cmp_eq_u32 s58, 2
s_cbranch_scc1 Lstube2
s_branch Lstube3
Lrete:
s_mov_b64 exec, -1
s_nop 3
v_mfma_f32_16x16x32_bf16 v[144:147], a[168:171], a[232:235], v[144:147]
s_waitcnt vmcnt(0) lgkmcnt(15)
ds_read_b64 a[140:141], v6 offset:1792
ds_read_b64 a[142:143], v6 offset:1800
v_mfma_f32_16x16x32_bf16 v[144:147], a[172:175], a[228:231], v[144:147]
s_barrier
v_mov_b32 v244, 163328
v_mfma_f32_16x16x32_bf16 v[144:147], a[176:179], a[224:227], v[144:147]
s_xor_b32 s71, s12, 0x100
ds_read_b128 v[240:243], v244
v_mfma_f32_16x16x32_bf16 v[148:151], a[180:183], a[224:227], v[148:151]
s_add_u32 m0, s77, 16384
ds_read_b128 a[208:211], v7 offset:1792
ds_read_b64 a[144:145], v6 offset:2304
v_mfma_f32_16x16x32_bf16 v[148:151], a[176:179], a[228:231], v[148:151]
s_add_u32 s72, s71, 0
buffer_load_dwordx4 v15, s[24:27], s72 offen lds
v_mfma_f32_16x16x32_bf16 v[148:151], a[172:175], a[232:235], v[148:151]
v_mfma_f32_16x16x32_bf16 v[148:151], a[168:171], a[236:239], v[148:151]
s_nop 0
ds_read_b64 a[146:147], v6 offset:2312
ds_read_b128 a[212:215], v7 offset:1280
v_mfma_f32_16x16x32_bf16 v[148:151], a[164:167], a[240:243], v[148:151]
s_add_u32 s72, s71, 15360
buffer_load_dwordx4 v15, s[24:27], s72 offen offset:1024 lds
v_mfma_f32_16x16x32_bf16 v[148:151], a[160:163], a[244:247], v[148:151]
s_waitcnt lgkmcnt(4)
ds_read_b64 a[148:149], v6 offset:2816
ds_read_b64 a[150:151], v6 offset:2824
v_mfma_f32_16x16x32_bf16 v[152:155], a[160:163], a[248:251], v[152:155]
v_or3_b32 v240, v240, v241, v242
v_or_b32 v240, v240, v243
v_mfma_f32_16x16x32_bf16 v[152:155], a[164:167], a[244:247], v[152:155]
v_cmp_lt_u32 vcc, s86, v240
s_cbranch_vccnz Lslow
v_mfma_f32_16x16x32_bf16 v[152:155], a[168:171], a[240:243], v[152:155]
s_nop 0
ds_read_b128 a[216:219], v7 offset:768
ds_read_b64 a[152:153], v6 offset:3328
v_mfma_f32_16x16x32_bf16 v[152:155], a[172:175], a[236:239], v[152:155]
v_or_b32 v240, s58, v0
v_mov_b32 v241, 2
v_mfma_f32_16x16x32_bf16 v[152:155], a[176:179], a[232:235], v[152:155]
s_add_u32 s72, s71, 30720
ds_read_b64 a[154:155], v6 offset:3336
ds_read_b128 a[220:223], v7 offset:256
v_mfma_f32_16x16x32_bf16 v[152:155], a[180:183], a[228:231], v[152:155]
buffer_load_dwordx4 v15, s[24:27], s72 offen offset:2048 lds
v_mfma_f32_16x16x32_bf16 v[152:155], a[184:187], a[224:227], v[152:155]
v_min_u32 v240, 1, v240
v_lshlrev_b32 v240, 30, v240
v_mfma_f32_16x16x32_bf16 v[156:159], a[188:191], a[224:227], v[156:159]
s_nop 0
ds_read_b64 a[156:157], v6 offset:3840
ds_read_b64 a[158:159], v6 offset:3848
v_mfma_f32_16x16x32_bf16 v[156:159], a[184:187], a[228:231], v[156:159]
buffer_store_dword v241, v240, s[44:47], s91 offen sc1
v_mfma_f32_16x16x32_bf16 v[156:159], a[180:183], a[232:235], v[156:159]
s_add_u32 s80, s93, 0x3400000
v_and_b32 v166, 7, v0
v_lshlrev_b32 v166, 4, v166
v_mfma_f32_16x16x32_bf16 v[156:159], a[176:179], a[236:239], v[156:159]
s_add_u32 s72, s71, 46080
buffer_load_dwordx4 v15, s[24:27], s72 offen offset:3072 lds
v_mfma_f32_16x16x32_bf16 v[156:159], a[172:175], a[240:243], v[156:159]
v_bfe_u32 v112, v0, 3, 1
v_lshl_add_u32 v166, v112, 8, v166
v_mfma_f32_16x16x32_bf16 v[156:159], a[168:171], a[244:247], v[156:159]
v_bfe_u32 v112, v0, 4, 1
v_lshl_add_u32 v166, v112, 7, v166
v_mfma_f32_16x16x32_bf16 v[156:159], a[164:167], a[248:251], v[156:159]
v_lshrrev_b32 v2, 4, v0
v_lshlrev_b32 v2, 10, v2
v_mfma_f32_16x16x32_bf16 v[156:159], a[160:163], a[252:255], v[156:159]
s_waitcnt lgkmcnt(0)
v_lshrrev_b32 v112, 5, v0
v_lshl_add_u32 v166, v112, 9, v166
v_mfma_f32_16x16x32_bf16 v[128:131], a[128:131], a[192:195], v[128:131]
s_xor_b32 s82, s78, 0
ds_read_b128 a[224:227], v7 offset:3904
ds_read_b64 a[160:161], v6 offset:320
v_mfma_f32_16x16x32_bf16 v[132:135], a[132:135], a[192:195], v[132:135]
s_xor_b32 s71, s12, 0x180
v_and_b32 v112, 15, v0
v_lshrrev_b32 v113, 2, v0
v_mfma_f32_16x16x32_bf16 v[132:135], a[128:131], a[196:199], v[132:135]
s_add_u32 m0, s77, 32768
ds_read_b64 a[162:163], v6 offset:328
ds_read_b128 a[228:231], v7 offset:3392
v_mfma_f32_16x16x32_bf16 v[136:139], a[128:131], a[200:203], v[136:139]
s_add_u32 s72, s71, 0
buffer_load_dwordx4 v15, s[24:27], s72 offen lds
v_mfma_f32_16x16x32_bf16 v[136:139], a[132:135], a[196:199], v[136:139]
s_lshl_b32 s82, s82, 10
v_bfe_u32 v114, v0, 3, 2
v_and_b32 v115, 3, v0
v_mfma_f32_16x16x32_bf16 v[136:139], a[136:139], a[192:195], v[136:139]
s_add_u32 s82, s82, s74
ds_read_b64 a[164:165], v6 offset:832
ds_read_b64 a[166:167], v6 offset:840
v_mfma_f32_16x16x32_bf16 v[140:143], a[140:143], a[192:195], v[140:143]
buffer_load_dword v3, v2, s[44:47], s82 offen sc1
v_mfma_f32_16x16x32_bf16 v[140:143], a[136:139], a[196:199], v[140:143]
s_add_u32 s72, s71, 15360
ds_read_b128 a[232:235], v7 offset:2880
ds_read_b64 a[168:169], v6 offset:1344
v_mfma_f32_16x16x32_bf16 v[140:143], a[132:135], a[200:203], v[140:143]
buffer_load_dwordx4 v15, s[24:27], s72 offen offset:1024 lds
v_mfma_f32_16x16x32_bf16 v[140:143], a[128:131], a[204:207], v[140:143]
v_lshlrev_b32 v8, 7, v113
v_lshl_add_u32 v8, v114, 5, v8
v_mfma_f32_16x16x32_bf16 v[144:147], a[128:131], a[208:211], v[144:147]
s_nop 0
ds_read_b64 a[170:171], v6 offset:1352
ds_read_b128 a[236:239], v7 offset:2368
v_mfma_f32_16x16x32_bf16 v[144:147], a[132:135], a[204:207], v[144:147]
v_lshl_add_u32 v8, v115, 3, v8
v_add_u32 v8, s77, v8
v_mfma_f32_16x16x32_bf16 v[144:147], a[136:139], a[200:203], v[144:147]
s_nop 0
ds_read_b64 a[172:173], v6 offset:1856
ds_read_b64 a[174:175], v6 offset:1864
v_mfma_f32_16x16x32_bf16 v[144:147], a[140:143], a[196:199], v[144:147]
s_add_u32 s72, s71, 30720
buffer_load_dwordx4 v15, s[24:27], s72 offen offset:2048 lds
v_mfma_f32_16x16x32_bf16 v[144:147], a[144:147], a[192:195], v[144:147]
v_subrev_u32 v8, s64, v8
v_xor_b32 v9, 32, v8
v_mfma_f32_16x16x32_bf16 v[148:151], a[148:151], a[192:195], v[148:151]
s_nop 0
ds_read_b128 a[240:243], v7 offset:1856
ds_read_b64 a[176:177], v6 offset:2368
v_mfma_f32_16x16x32_bf16 v[148:151], a[144:147], a[196:199], v[148:151]
v_xor_b32 v10, 64, v8
v_xor_b32 v11, 0x60, v8
v_mfma_f32_16x16x32_bf16 v[148:151], a[140:143], a[200:203], v[148:151]
v_lshlrev_b32 v5, 8, v113
v_and_b32 v114, 1, v0
v_mfma_f32_16x16x32_bf16 v[148:151], a[136:139], a[204:207], v[148:151]
s_nop 0
ds_read_b64 a[178:179], v6 offset:2376
ds_read_b128 a[244:247], v7 offset:1344
v_mfma_f32_16x16x32_bf16 v[148:151], a[132:135], a[208:211], v[148:151]
s_add_u32 s72, s71, 46080
buffer_load_dwordx4 v15, s[24:27], s72 offen offset:3072 lds
v_mfma_f32_16x16x32_bf16 v[148:151], a[128:131], a[212:215], v[148:151]
s_nop 0
ds_read_b64 a[180:181], v6 offset:2880
ds_read_b64 a[182:183], v6 offset:2888
v_mfma_f32_16x16x32_bf16 v[152:155], a[128:131], a[216:219], v[152:155]
v_lshl_add_u32 v5, v114, 7, v5
v_bfe_u32 v114, v0, 1, 1
v_mfma_f32_16x16x32_bf16 v[152:155], a[132:135], a[212:215], v[152:155]
v_lshl_add_u32 v5, v114, 3, v5
v_lshlrev_b32 v114, 1, s58
v_mfma_f32_16x16x32_bf16 v[152:155], a[136:139], a[208:211], v[152:155]
s_nop 0
ds_read_b128 a[248:251], v7 offset:832
ds_read_b64 a[184:185], v6 offset:3392
v_mfma_f32_16x16x32_bf16 v[152:155], a[140:143], a[204:207], v[152:155]
v_xor_b32 v114, v114, v113
v_and_b32 v114, 7, v114
v_mfma_f32_16x16x32_bf16 v[152:155], a[144:147], a[200:203], v[152:155]
s_xor_b32 s71, s13, 0x80
ds_read_b64 a[186:187], v6 offset:3400
ds_read_b128 a[252:255], v7 offset:320
v_mfma_f32_16x16x32_bf16 v[152:155], a[148:151], a[196:199], v[152:155]
s_add_u32 m0, s77, 49152
v_lshl_add_u32 v5, v114, 4, v5
v_add_u32 v5, 147456, v5
v_mfma_f32_16x16x32_bf16 v[152:155], a[152:155], a[192:195], v[152:155]
s_add_u32 s72, s71, 0
buffer_load_dwordx4 v15, s[24:27], s72 offen lds
v_mfma_f32_16x16x32_bf16 v[156:159], a[156:159], a[192:195], v[156:159]
s_nop 0
ds_read_b64 a[188:189], v6 offset:3904
ds_read_b64 a[190:191], v6 offset:3912
v_mfma_f32_16x16x32_bf16 v[156:159], a[152:155], a[196:199], v[156:159]
v_bfe_u32 v114, v0, 1, 2
v_lshrrev_b32 v115, 4, v0
v_mfma_f32_16x16x32_bf16 v[156:159], a[148:151], a[200:203], v[156:159]
v_lshlrev_b32 v116, 7, v112
v_lshl_add_u32 v116, v114, 5, v116
v_mfma_f32_16x16x32_bf16 v[156:159], a[144:147], a[204:207], v[156:159]
s_add_u32 s72, s71, 15360
buffer_load_dwordx4 v15, s[24:27], s72 offen offset:1024 lds
v_mfma_f32_16x16x32_bf16 v[156:159], a[140:143], a[208:211], v[156:159]
v_lshl_add_u32 v116, v115, 3, v116
v_add_u32 v116, s64, v116
v_mfma_f32_16x16x32_bf16 v[156:159], a[136:139], a[212:215], v[156:159]
v_add_u32 v116, 131072, v116
v_xor_b32 v117, 32, v116
v_mfma_f32_16x16x32_bf16 v[156:159], a[132:135], a[216:219], v[156:159]
v_xor_b32 v118, 64, v116
v_xor_b32 v119, 0x60, v116
v_mfma_f32_16x16x32_bf16 v[156:159], a[128:131], a[220:223], v[156:159]
s_waitcnt lgkmcnt(0)
v_mfma_f32_16x16x32_bf16 v[128:131], a[160:163], a[224:227], v[128:131]
s_nop 0
ds_read_b128 a[192:195], v7 offset:3968
ds_read_b64 a[128:129], v6 offset:384
v_mfma_f32_16x16x32_bf16 v[132:135], a[164:167], a[224:227], v[132:135]
s_add_u32 s72, s71, 30720
buffer_load_dwordx4 v15, s[24:27], s72 offen offset:2048 lds
v_mfma_f32_16x16x32_bf16 v[132:135], a[160:163], a[228:231], v[132:135]
s_nop 0
ds_read_b64 a[130:131], v6 offset:392
ds_read_b128 a[196:199], v7 offset:3456
v_mfma_f32_16x16x32_bf16 v[136:139], a[160:163], a[232:235], v[136:139]
Lstub9:
s_cbranch_execz Lret
v_mfma_f32_16x16x32_bf16 v[136:139], a[164:167], a[228:231], v[136:139]
v_mfma_f32_16x16x32_bf16 v[136:139], a[168:171], a[224:227], v[136:139]
s_nop 0
ds_read_b64 a[132:133], v6 offset:896
ds_read_b64 a[134:135], v6 offset:904
v_mfma_f32_16x16x32_bf16 v[140:143], a[172:175], a[224:227], v[140:143]
v_mfma_f32_16x16x32_bf16 v[140:143], a[168:171], a[228:231], v[140:143]
s_add_u32 s72, s71, 46080
ds_read_b128 a[200:203], v7 offset:2944
ds_read_b64 a[136:137], v6 offset:1408
v_mfma_f32_16x16x32_bf16 v[140:143], a[164:167], a[232:235], v[140:143]
buffer_load_dwordx4 v15, s[24:27], s72 offen offset:3072 lds
v_mfma_f32_16x16x32_bf16 v[140:143], a[160:163], a[236:239], v[140:143]
v_mfma_f32_16x16x32_bf16 v[144:147], a[160:163], a[240:243], v[144:147]
s_nop 0
ds_read_b64 a[138:139], v6 offset:1416
ds_read_b128 a[204:207], v7 offset:2432
v_mfma_f32_16x16x32_bf16 v[144:147], a[164:167], a[236:239], v[144:147]
v_mfma_f32_16x16x32_bf16 v[144:147], a[168:171], a[232:235], v[144:147]
s_nop 0
ds_read_b64 a[140:141], v6 offset:1920
ds_read_b64 a[142:143], v6 offset:1928
v_mfma_f32_16x16x32_bf16 v[144:147], a[172:175], a[228:231], v[144:147]
v_mfma_f32_16x16x32_bf16 v[144:147], a[176:179], a[224:227], v[144:147]
v_mfma_f32_16x16x32_bf16 v[148:151], a[180:183], a[224:227], v[148:151]
s_nop 0
ds_read_b128 a[208:211], v7 offset:1920
ds_read_b64 a[144:145], v6 offset:2432
v_mfma_f32_16x16x32_bf16 v[148:151], a[176:179], a[228:231], v[148:151]
v_mfma_f32_16x16x32_bf16 v[148:151], a[172:175], a[232:235], v[148:151]
s_waitcnt vmcnt(7)
v_cmp_gt_u32 vcc, 2, v3
s_or_b32 s81, vcc_lo, vcc_hi
s_cselect_b32 s81, 0x40000000, 0
v_or_b32 v4, s81, v1
v_mfma_f32_16x16x32_bf16 v[148:151], a[168:171], a[236:239], v[148:151]
s_nop 0
ds_read_b64 a[146:147], v6 offset:2440
ds_read_b128 a[212:215], v7 offset:1408
v_mfma_f32_16x16x32_bf16 v[148:151], a[164:167], a[240:243], v[148:151]
v_mfma_f32_16x16x32_bf16 v[148:151], a[160:163], a[244:247], v[148:151]
s_nop 0
ds_read_b64 a[148:149], v6 offset:2944
ds_read_b64 a[150:151], v6 offset:2952
v_mfma_f32_16x16x32_bf16 v[152:155], a[160:163], a[248:251], v[152:155]
v_mfma_f32_16x16x32_bf16 v[152:155], a[164:167], a[244:247], v[152:155]
s_lshr_b32 s69, s12, 18
v_mfma_f32_16x16x32_bf16 v[152:155], a[168:171], a[240:243], v[152:155]
s_lshl_b32 s69, s69, 12
ds_read_b128 a[216:219], v7 offset:896
ds_read_b64 a[152:153], v6 offset:3456
v_mfma_f32_16x16x32_bf16 v[152:155], a[172:175], a[236:239], v[152:155]
s_add_u32 s69, s69, s95
buffer_load_dwordx4 a[0:3], v4, s[44:47], s69 offen sc1
v_mfma_f32_16x16x32_bf16 v[152:155], a[176:179], a[232:235], v[152:155]
s_nop 0
ds_read_b64 a[154:155], v6 offset:3464
ds_read_b128 a[220:223], v7 offset:384
v_mfma_f32_16x16x32_bf16 v[152:155], a[180:183], a[228:231], v[152:155]
v_mfma_f32_16x16x32_bf16 v[152:155], a[184:187], a[224:227], v[152:155]
v_mfma_f32_16x16x32_bf16 v[156:159], a[188:191], a[224:227], v[156:159]
s_nop 0
ds_read_b64 a[156:157], v6 offset:3968
ds_read_b64 a[158:159], v6 offset:3976
v_mfma_f32_16x16x32_bf16 v[156:159], a[184:187], a[228:231], v[156:159]
buffer_load_dwordx4 a[4:7], v4, s[44:47], s69 offen offset:1024 sc1
v_mfma_f32_16x16x32_bf16 v[156:159], a[180:183], a[232:235], v[156:159]
v_mfma_f32_16x16x32_bf16 v[156:159], a[176:179], a[236:239], v[156:159]
v_mfma_f32_16x16x32_bf16 v[156:159], a[172:175], a[240:243], v[156:159]
v_mfma_f32_16x16x32_bf16 v[156:159], a[168:171], a[244:247], v[156:159]
buffer_load_dwordx4 a[8:11], v4, s[44:47], s69 offen offset:2048 sc1
v_mfma_f32_16x16x32_bf16 v[156:159], a[164:167], a[248:251], v[156:159]
v_mfma_f32_16x16x32_bf16 v[156:159], a[160:163], a[252:255], v[156:159]
s_waitcnt lgkmcnt(0)
v_mfma_f32_16x16x32_bf16 v[128:131], a[128:131], a[192:195], v[128:131]
s_nop 0
ds_read_b128 a[224:227], v7 offset:4032
ds_read_b64 a[160:161], v6 offset:448
v_mfma_f32_16x16x32_bf16 v[132:135], a[132:135], a[192:195], v[132:135]
v_mfma_f32_16x16x32_bf16 v[132:135], a[128:131], a[196:199], v[132:135]
s_nop 0
ds_read_b64 a[162:163], v6 offset:456
ds_read_b128 a[228:231], v7 offset:3520
v_mfma_f32_16x16x32_bf16 v[136:139], a[128:131], a[200:203], v[136:139]
buffer_load_dwordx4 a[12:15], v4, s[44:47], s69 offen offset:3072 sc1
v_mfma_f32_16x16x32_bf16 v[136:139], a[132:135], a[196:199], v[136:139]
v_mfma_f32_16x16x32_bf16 v[136:139], a[136:139], a[192:195], v[136:139]
s_nop 0
ds_read_b64 a[164:165], v6 offset:960
ds_read_b64 a[166:167], v6 offset:968
v_mfma_f32_16x16x32_bf16 v[140:143], a[140:143], a[192:195], v[140:143]
v_mfma_f32_16x16x32_bf16 v[140:143], a[136:139], a[196:199], v[140:143]
s_nop 0
ds_read_b128 a[232:235], v7 offset:3008
ds_read_b64 a[168:169], v6 offset:1472
v_mfma_f32_16x16x32_bf16 v[140:143], a[132:135], a[200:203], v[140:143]
s_add_u32 s69, s69, 0x20000
buffer_load_dwordx4 a[16:19], v4, s[44:47], s69 offen sc1
v_mfma_f32_16x16x32_bf16 v[140:143], a[128:131], a[204:207], v[140:143]
v_mfma_f32_16x16x32_bf16 v[144:147], a[128:131], a[208:211], v[144:147]
s_nop 0
ds_read_b64 a[170:171], v6 offset:1480
ds_read_b128 a[236:239], v7 offset:2496
v_mfma_f32_16x16x32_bf16 v[144:147], a[132:135], a[204:207], v[144:147]
v_mfma_f32_16x16x32_bf16 v[144:147], a[136:139], a[200:203], v[144:147]
s_nop 0
ds_read_b64 a[172:173], v6 offset:1984
ds_read_b64 a[174:175], v6 offset:1992
v_mfma_f32_16x16x32_bf16 v[144:147], a[140:143], a[196:199], v[144:147]
buffer_load_dwordx4 a[20:23], v4, s[44:47], s69 offen offset:1024 sc1
v_mfma_f32_16x16x32_bf16 v[144:147], a[144:147], a[192:195], v[144:147]
v_mfma_f32_16x16x32_bf16 v[148:151], a[148:151], a[192:195], v[148:151]
s_nop 0
ds_read_b128 a[240:243], v7 offset:1984
ds_read_b64 a[176:177], v6 offset:2496
v_mfma_f32_16x16x32_bf16 v[148:151], a[144:147], a[196:199], v[148:151]
v_mfma_f32_16x16x32_bf16 v[148:151], a[140:143], a[200:203], v[148:151]
v_mfma_f32_16x16x32_bf16 v[148:151], a[136:139], a[204:207], v[148:151]
s_nop 0
ds_read_b64 a[178:179], v6 offset:2504
ds_read_b128 a[244:247], v7 offset:1472
v_mfma_f32_16x16x32_bf16 v[148:151], a[132:135], a[208:211], v[148:151]
buffer_load_dwordx4 a[24:27], v4, s[44:47], s69 offen offset:2048 sc1
v_mfma_f32_16x16x32_bf16 v[148:151], a[128:131], a[212:215], v[148:151]
s_nop 0
ds_read_b64 a[180:181], v6 offset:3008
ds_read_b64 a[182:183], v6 offset:3016
v_mfma_f32_16x16x32_bf16 v[152:155], a[128:131], a[216:219], v[152:155]
v_mfma_f32_16x16x32_bf16 v[152:155], a[132:135], a[212:215], v[152:155]
v_mfma_f32_16x16x32_bf16 v[152:155], a[136:139], a[208:211], v[152:155]
s_nop 0
ds_read_b128 a[248:251], v7 offset:960
ds_read_b64 a[184:185], v6 offset:3520
v_mfma_f32_16x16x32_bf16 v[152:155], a[140:143], a[204:207], v[152:155]
buffer_load_dwordx4 a[28:31], v4, s[44:47], s69 offen offset:3072 sc1
v_mfma_f32_16x16x32_bf16 v[152:155], a[144:147], a[200:203], v[152:155]
s_nop 0
ds_read_b64 a[186:187], v6 offset:3528
ds_read_b128 a[252:255], v7 offset:448
v_mfma_f32_16x16x32_bf16 v[152:155], a[148:151], a[196:199], v[152:155]
v_mfma_f32_16x16x32_bf16 v[152:155], a[152:155], a[192:195], v[152:155]
s_lshr_b32 s69, s13, 18
v_mfma_f32_16x16x32_bf16 v[156:159], a[156:159], a[192:195], v[156:159]
s_lshl_b32 s69, s69, 12
ds_read_b64 a[188:189], v6 offset:4032
ds_read_b64 a[190:191], v6 offset:4040
v_mfma_f32_16x16x32_bf16 v[156:159], a[152:155], a[196:199], v[156:159]
s_add_u32 s69, s69, s95
buffer_load_dwordx4 a[32:35], v4, s[44:47], s69 offen sc1
v_mfma_f32_16x16x32_bf16 v[156:159], a[148:151], a[200:203], v[156:159]
v_mfma_f32_16x16x32_bf16 v[156:159], a[144:147], a[204:207], v[156:159]
v_mfma_f32_16x16x32_bf16 v[156:159], a[140:143], a[208:211], v[156:159]
v_mfma_f32_16x16x32_bf16 v[156:159], a[136:139], a[212:215], v[156:159]
buffer_load_dwordx4 a[36:39], v4, s[44:47], s69 offen offset:1024 sc1
v_mfma_f32_16x16x32_bf16 v[156:159], a[132:135], a[216:219], v[156:159]
v_mfma_f32_16x16x32_bf16 v[156:159], a[128:131], a[220:223], v[156:159]
s_waitcnt lgkmcnt(0)
v_mfma_f32_16x16x32_bf16 v[128:131], a[160:163], a[224:227], v[128:131]
s_nop 0
ds_read_b64_tr_b16 v[192:193], v8 offset:0
ds_read_b64_tr_b16 v[194:195], v8 offset:2048
v_mfma_f32_16x16x32_bf16 v[132:135], a[164:167], a[224:227], v[132:135]
v_mfma_f32_16x16x32_bf16 v[132:135], a[160:163], a[228:231], v[132:135]
s_nop 0
ds_read_b64_tr_b16 v[196:197], v9 offset:0
ds_read_b64_tr_b16 v[198:199], v9 offset:2048
v_mfma_f32_16x16x32_bf16 v[136:139], a[160:163], a[232:235], v[136:139]
buffer_load_dwordx4 a[40:43], v4, s[44:47], s69 offen offset:2048 sc1
v_mfma_f32_16x16x32_bf16 v[136:139], a[164:167], a[228:231], v[136:139]
s_nop 0
ds_read_b64_tr_b16 v[200:201], v10 offset:0
ds_read_b64_tr_b16 v[202:203], v10 offset:2048
v_mfma_f32_16x16x32_bf16 v[136:139], a[168:171], a[224:227], v[136:139]
v_mfma_f32_16x16x32_bf16 v[140:143], a[172:175], a[224:227], v[140:143]
s_nop 0
ds_read_b64_tr_b16 v[204:205], v11 offset:0
ds_read_b64_tr_b16 v[206:207], v11 offset:2048
v_mfma_f32_16x16x32_bf16 v[140:143], a[168:171], a[228:231], v[140:143]
v_cvt_pk_bf16_f32 v128, v128, v129
v_cvt_pk_bf16_f32 v129, v130, v131
v_cvt_pk_bf16_f32 v130, v132, v133
v_mfma_f32_16x16x32_bf16 v[140:143], a[164:167], a[232:235], v[140:143]
s_nop 0
ds_read_b64_tr_b16 v[208:209], v8 offset:4096
ds_read_b64_tr_b16 v[210:211], v8 offset:6144
v_cvt_pk_bf16_f32 v131, v134, v135
v_mfma_f32_16x16x32_bf16 v[140:143], a[160:163], a[236:239], v[140:143]
s_nop 0
buffer_load_dwordx4 a[44:47], v4, s[44:47], s69 offen offset:3072 sc1
v_permlane32_swap_b32 v128, v130
v_mfma_f32_16x16x32_bf16 v[144:147], a[160:163], a[240:243], v[144:147]
s_nop 0
ds_read_b64_tr_b16 v[212:213], v9 offset:4096
ds_read_b64_tr_b16 v[214:215], v9 offset:6144
v_permlane32_swap_b32 v129, v131
v_mfma_f32_16x16x32_bf16 v[144:147], a[164:167], a[236:239], v[144:147]
buffer_store_dwordx4 v[128:131], v166, s[44:47], s80 offen sc1
v_mfma_f32_16x16x32_bf16 v[144:147], a[168:171], a[232:235], v[144:147]
s_nop 0
ds_read_b64_tr_b16 v[216:217], v10 offset:4096
ds_read_b64_tr_b16 v[218:219], v10 offset:6144
v_mfma_f32_16x16x32_bf16 v[144:147], a[172:175], a[228:231], v[144:147]
s_add_u32 s69, s69, 0x20000
buffer_load_dwordx4 a[48:51], v4, s[44:47], s69 offen sc1
v_mfma_f32_16x16x32_bf16 v[144:147], a[176:179], a[224:227], v[144:147]
s_nop 0
ds_read_b64_tr_b16 v[220:221], v11 offset:4096
ds_read_b64_tr_b16 v[222:223], v11 offset:6144
v_cvt_pk_bf16_f32 v136, v136, v137
v_mfma_f32_16x16x32_bf16 v[148:151], a[180:183], a[224:227], v[148:151]
v_cvt_pk_bf16_f32 v137, v138, v139
v_cvt_pk_bf16_f32 v138, v140, v141
v_cvt_pk_bf16_f32 v139, v142, v143
v_mfma_f32_16x16x32_bf16 v[148:151], a[176:179], a[228:231], v[148:151]
s_nop 0
ds_read_b64_tr_b16 v[224:225], v8 offset:8192
ds_read_b64_tr_b16 v[226:227], v8 offset:10240
v_permlane32_swap_b32 v136, v138
v_mfma_f32_16x16x32_bf16 v[148:151], a[172:175], a[232:235], v[148:151]
v_permlane32_swap_b32 v137, v139
v_mfma_f32_16x16x32_bf16 v[148:151], a[168:171], a[236:239], v[148:151]
s_nop 0
ds_read_b64_tr_b16 v[228:229], v9 offset:8192
ds_read_b64_tr_b16 v[230:231], v9 offset:10240
v_mfma_f32_16x16x32_bf16 v[148:151], a[164:167], a[240:243], v[148:151]
buffer_load_dwordx4 a[52:55], v4, s[44:47], s69 offen offset:1024 sc1
v_mfma_f32_16x16x32_bf16 v[148:151], a[160:163], a[244:247], v[148:151]
s_nop 0
ds_read_b64_tr_b16 v[232:233], v10 offset:8192
ds_read_b64_tr_b16 v[234:235], v10 offset:10240
v_mfma_f32_16x16x32_bf16 v[152:155], a[160:163], a[248:251], v[152:155]
buffer_store_dwordx4 v[136:139], v166, s[44:47], s80 offen offset:1024 sc1
v_mfma_f32_16x16x32_bf16 v[152:155], a[164:167], a[244:247], v[152:155]
s_nop 0
ds_read_b64_tr_b16 v[236:237], v11 offset:8192
ds_read_b64_tr_b16 v[238:239], v11 offset:10240
v_mfma_f32_16x16x32_bf16 v[152:155], a[168:171], a[240:243], v[152:155]
buffer_load_dwordx4 a[56:59], v4, s[44:47], s69 offen offset:2048 sc1
v_mfma_f32_16x16x32_bf16 v[152:155], a[172:175], a[236:239], v[152:155]
s_nop 0
ds_read_b64_tr_b16 v[240:241], v8 offset:12288
ds_read_b64_tr_b16 v[242:243], v8 offset:14336
v_mfma_f32_16x16x32_bf16 v[152:155], a[176:179], a[232:235], v[152:155]
v_cvt_pk_bf16_f32 v144, v144, v145
v_cvt_pk_bf16_f32 v145, v146, v147
v_cvt_pk_bf16_f32 v146, v148, v149
v_mfma_f32_16x16x32_bf16 v[152:155], a[180:183], a[228:231], v[152:155]
s_nop 0
ds_read_b64_tr_b16 v[244:245], v9 offset:12288
ds_read_b64_tr_b16 v[246:247], v9 offset:14336
v_cvt_pk_bf16_f32 v147, v150, v151
v_mfma_f32_16x16x32_bf16 v[152:155], a[184:187], a[224:227], v[152:155]
v_permlane32_swap_b32 v144, v146
v_permlane32_swap_b32 v145, v147
v_mfma_f32_16x16x32_bf16 v[156:159], a[188:191], a[224:227], v[156:159]
s_nop 0
ds_read_b64_tr_b16 v[248:249], v10 offset:12288
ds_read_b64_tr_b16 v[250:251], v10 offset:14336
v_mfma_f32_16x16x32_bf16 v[156:159], a[184:187], a[228:231], v[156:159]
buffer_load_dwordx4 a[60:63], v4, s[44:47], s69 offen offset:3072 sc1
v_mfma_f32_16x16x32_bf16 v[156:159], a[180:183], a[232:235], v[156:159]
s_nop 0
ds_read_b64_tr_b16 v[252:253], v11 offset:12288
ds_read_b64_tr_b16 v[254:255], v11 offset:14336
v_mfma_f32_16x16x32_bf16 v[156:159], a[176:179], a[236:239], v[156:159]
buffer_store_dwordx4 v[144:147], v166, s[44:47], s80 offen offset:2048 sc1
v_mfma_f32_16x16x32_bf16 v[156:159], a[172:175], a[240:243], v[156:159]
v_mfma_f32_16x16x32_bf16 v[156:159], a[168:171], a[244:247], v[156:159]
v_mfma_f32_16x16x32_bf16 v[156:159], a[164:167], a[248:251], v[156:159]
v_mfma_f32_16x16x32_bf16 v[156:159], a[160:163], a[252:255], v[156:159]
v_cvt_pk_bf16_f32 v152, v152, v153
v_cvt_pk_bf16_f32 v153, v154, v155
s_nop 5
v_cvt_pk_bf16_f32 v154, v156, v157
v_cvt_pk_bf16_f32 v155, v158, v159
s_nop 0
v_permlane32_swap_b32 v152, v154
v_permlane32_swap_b32 v153, v155
buffer_store_dwordx4 v[152:155], v166, s[44:47], s80 offen offset:3072 sc1
s_waitcnt vmcnt(12) lgkmcnt(0)
s_cmp_lg_u32 s81, 0
s_cbranch_scc1 Lredo0
Lredo0b:
s_barrier
v_mfma_f32_16x16x32_bf16 v[16:19], v[192:195], a[0:3], 0
s_nop 0
ds_read_b64_tr_b16 v[128:129], v8 offset:16384
ds_read_b64_tr_b16 v[130:131], v8 offset:18432
v_mfma_f32_16x16x32_bf16 v[16:19], v[208:211], a[4:7], v[16:19]
s_xor_b32 s71, s13, 0x100
ds_read_b64_tr_b16 v[132:133], v9 offset:16384
ds_read_b64_tr_b16 v[134:135], v9 offset:18432
v_mfma_f32_16x16x32_bf16 v[16:19], v[224:227], a[8:11], v[16:19]
s_add_u32 m0, s85, 0
ds_read_b64_tr_b16 v[136:137], v10 offset:16384
ds_read_b64_tr_b16 v[138:139], v10 offset:18432
v_mfma_f32_16x16x32_bf16 v[16:19], v[240:243], a[12:15], v[16:19]
s_add_u32 s72, s71, 0
buffer_load_dwordx4 v15, s[24:27], s72 offen lds
v_mfma_f32_16x16x32_bf16 v[32:35], v[240:243], a[28:31], 0
s_lshr_b32 s69, s14, 18
ds_read_b64_tr_b16 v[140:141], v11 offset:16384
ds_read_b64_tr_b16 v[142:143], v11 offset:18432
v_mfma_f32_16x16x32_bf16 v[32:35], v[224:227], a[24:27], v[32:35]
s_lshl_b32 s69, s69, 12
v_add_u32 v4, s64, v1
v_add_u32 v4, 131072, v4
v_mfma_f32_16x16x32_bf16 v[32:35], v[208:211], a[20:23], v[32:35]
s_add_u32 s69, s69, s95
buffer_load_dwordx4 a[64:67], v1, s[44:47], s69 offen sc1
v_mfma_f32_16x16x32_bf16 v[32:35], v[192:195], a[16:19], v[32:35]
s_lshl_b32 s70, s75, 18
ds_read_b64_tr_b16 v[144:145], v8 offset:20480
ds_read_b64_tr_b16 v[146:147], v8 offset:22528
v_mfma_f32_16x16x32_bf16 v[36:39], v[196:199], a[16:19], 0
s_add_u32 s72, s71, 15360
buffer_load_dwordx4 v15, s[24:27], s72 offen offset:1024 lds
v_mfma_f32_16x16x32_bf16 v[36:39], v[212:215], a[20:23], v[36:39]
s_add_u32 s70, s70, s94
ds_read_b64_tr_b16 v[148:149], v9 offset:20480
ds_read_b64_tr_b16 v[150:151], v9 offset:22528
v_mfma_f32_16x16x32_bf16 v[36:39], v[228:231], a[24:27], v[36:39]
s_nop 0
ds_read_b64_tr_b16 v[152:153], v10 offset:20480
ds_read_b64_tr_b16 v[154:155], v10 offset:22528
v_mfma_f32_16x16x32_bf16 v[36:39], v[244:247], a[28:31], v[36:39]
s_nop 0
ds_read_b64_tr_b16 v[156:157], v11 offset:20480
ds_read_b64_tr_b16 v[158:159], v11 offset:22528
v_mfma_f32_16x16x32_bf16 v[20:23], v[244:247], a[12:15], 0
ds_write_b128 v4, v[80:83] offset:0
v_mfma_f32_16x16x32_bf16 v[20:23], v[228:231], a[8:11], v[20:23]
s_nop 0
ds_read_b64_tr_b16 v[160:161], v8 offset:24576
ds_read_b64_tr_b16 v[162:163], v8 offset:26624
v_mfma_f32_16x16x32_bf16 v[20:23], v[212:215], a[4:7], v[20:23]
s_add_u32 s72, s71, 30720
buffer_load_dwordx4 v15, s[24:27], s72 offen offset:2048 lds
v_mfma_f32_16x16x32_bf16 v[20:23], v[196:199], a[0:3], v[20:23]
buffer_load_dwordx4 a[68:71], v1, s[44:47], s69 offen offset:1024 sc1
v_mfma_f32_16x16x32_bf16 v[24:27], v[200:203], a[0:3], 0
s_nop 0
ds_read_b64_tr_b16 v[164:165], v9 offset:24576
ds_read_b64_tr_b16 v[166:167], v9 offset:26624
v_mfma_f32_16x16x32_bf16 v[24:27], v[216:219], a[4:7], v[24:27]
s_nop 0
ds_read_b64_tr_b16 v[168:169], v10 offset:24576
ds_read_b64_tr_b16 v[170:171], v10 offset:26624
v_mfma_f32_16x16x32_bf16 v[24:27], v[232:235], a[8:11], v[24:27]
s_nop 0
ds_read_b64_tr_b16 v[172:173], v11 offset:24576
ds_read_b64_tr_b16 v[174:175], v11 offset:26624
v_mfma_f32_16x16x32_bf16 v[24:27], v[248:251], a[12:15], v[24:27]
ds_write_b128 v4, v[84:87] offset:1024
v_mfma_f32_16x16x32_bf16 v[40:43], v[248:251], a[28:31], 0
s_add_u32 s72, s71, 46080
buffer_load_dwordx4 v15, s[24:27], s72 offen offset:3072 lds
v_mfma_f32_16x16x32_bf16 v[40:43], v[232:235], a[24:27], v[40:43]
s_nop 0
ds_read_b64_tr_b16 v[176:177], v8 offset:28672
ds_read_b64_tr_b16 v[178:179], v8 offset:30720
v_mfma_f32_16x16x32_bf16 v[40:43], v[216:219], a[20:23], v[40:43]
s_nop 0
ds_read_b64_tr_b16 v[180:181], v9 offset:28672
ds_read_b64_tr_b16 v[182:183], v9 offset:30720
v_mfma_f32_16x16x32_bf16 v[40:43], v[200:203], a[16:19], v[40:43]
s_nop 0
ds_read_b64_tr_b16 v[184:185], v10 offset:28672
ds_read_b64_tr_b16 v[186:187], v10 offset:30720
v_mfma_f32_16x16x32_bf16 v[44:47], v[204:207], a[16:19], 0
s_nop 0
ds_read_b64_tr_b16 v[188:189], v11 offset:28672
ds_read_b64_tr_b16 v[190:191], v11 offset:30720
v_mfma_f32_16x16x32_bf16 v[44:47], v[220:223], a[20:23], v[44:47]
buffer_load_dwordx4 a[72:75], v1, s[44:47], s69 offen offset:2048 sc1
v_mfma_f32_16x16x32_bf16 v[44:47], v[236:239], a[24:27], v[44:47]
ds_write_b128 v4, v[96:99] offset:2048
v_mfma_f32_16x16x32_bf16 v[44:47], v[252:255], a[28:31], v[44:47]
s_xor_b32 s71, s13, 0x180
v_mfma_f32_16x16x32_bf16 v[28:31], v[252:255], a[12:15], 0
s_add_u32 m0, s85, 16384
ds_write_b128 v4, v[100:103] offset:3072
v_mfma_f32_16x16x32_bf16 v[28:31], v[236:239], a[8:11], v[28:31]
s_add_u32 s72, s71, 0
v_mfma_f32_16x16x32_bf16 v[28:31], v[220:223], a[4:7], v[28:31]
s_waitcnt vmcnt(31) lgkmcnt(0)
buffer_load_dwordx4 v15, s[24:27], s72 offen lds
v_mfma_f32_16x16x32_bf16 v[28:31], v[204:207], a[0:3], v[28:31]
s_barrier
v_mfma_f32_16x16x32_bf16 v[48:51], v[128:131], a[0:3], 0
s_nop 0
ds_read_b64_tr_b16 v[192:193], v8 offset:32768
ds_read_b64_tr_b16 v[194:195], v8 offset:34816
v_mfma_f32_16x16x32_bf16 v[48:51], v[144:147], a[4:7], v[48:51]
s_nop 0
ds_read_b64_tr_b16 v[196:197], v9 offset:32768
ds_read_b64_tr_b16 v[198:199], v9 offset:34816
v_mfma_f32_16x16x32_bf16 v[48:51], v[160:163], a[8:11], v[48:51]
s_nop 0
ds_read_b64_tr_b16 v[200:201], v10 offset:32768
ds_read_b64_tr_b16 v[202:203], v10 offset:34816
v_mfma_f32_16x16x32_bf16 v[48:51], v[176:179], a[12:15], v[48:51]
s_add_u32 s72, s71, 15360
buffer_load_dwordx4 v15, s[24:27], s72 offen offset:1024 lds
v_mfma_f32_16x16x32_bf16 v[64:67], v[176:179], a[28:31], 0
buffer_load_dwordx4 a[76:79], v1, s[44:47], s69 offen offset:3072 sc1
v_mfma_f32_16x16x32_bf16 v[64:67], v[160:163], a[24:27], v[64:67]
s_nop 0
ds_read_b64_tr_b16 v[204:205], v11 offset:32768
ds_read_b64_tr_b16 v[206:207], v11 offset:34816
v_mfma_f32_16x16x32_bf16 v[64:67], v[144:147], a[20:23], v[64:67]
v_mfma_f32_16x16x32_bf16 v[64:67], v[128:131], a[16:19], v[64:67]
s_nop 0
ds_read_b64_tr_b16 v[208:209], v8 offset:36864
ds_read_b64_tr_b16 v[210:211], v8 offset:38912
v_mfma_f32_16x16x32_bf16 v[68:71], v[132:135], a[16:19], 0
s_nop 0
ds_read_b64_tr_b16 v[212:213], v9 offset:36864
ds_read_b64_tr_b16 v[214:215], v9 offset:38912
v_mfma_f32_16x16x32_bf16 v[68:71], v[148:151], a[20:23], v[68:71]
s_add_u32 s72, s71, 30720
buffer_load_dwordx4 v15, s[24:27], s72 offen offset:2048 lds
v_mfma_f32_16x16x32_bf16 v[68:71], v[164:167], a[24:27], v[68:71]
s_nop 0
ds_read_b64_tr_b16 v[216:217], v10 offset:36864
ds_read_b64_tr_b16 v[218:219], v10 offset:38912
v_mfma_f32_16x16x32_bf16 v[68:71], v[180:183], a[28:31], v[68:71]
s_nop 0
ds_read_b64_tr_b16 v[220:221], v11 offset:36864
ds_read_b64_tr_b16 v[222:223], v11 offset:38912
v_mfma_f32_16x16x32_bf16 v[52:55], v[180:183], a[12:15], 0
v_mfma_f32_16x16x32_bf16 v[52:55], v[164:167], a[8:11], v[52:55]
s_add_u32 s69, s69, 0x20000
buffer_load_dwordx4 a[80:83], v1, s[44:47], s69 offen sc1
v_mfma_f32_16x16x32_bf16 v[52:55], v[148:151], a[4:7], v[52:55]
s_nop 0
ds_read_b64_tr_b16 v[224:225], v8 offset:40960
ds_read_b64_tr_b16 v[226:227], v8 offset:43008
v_mfma_f32_16x16x32_bf16 v[52:55], v[132:135], a[0:3], v[52:55]
s_add_u32 s72, s71, 46080
buffer_load_dwordx4 v15, s[24:27], s72 offen offset:3072 lds
v_mfma_f32_16x16x32_bf16 v[56:59], v[136:139], a[0:3], 0
s_nop 0
ds_read_b64_tr_b16 v[228:229], v9 offset:40960
ds_read_b64_tr_b16 v[230:231], v9 offset:43008
v_mfma_f32_16x16x32_bf16 v[56:59], v[152:155], a[4:7], v[56:59]
s_nop 0
ds_read_b64_tr_b16 v[232:233], v10 offset:40960
ds_read_b64_tr_b16 v[234:235], v10 offset:43008
v_mfma_f32_16x16x32_bf16 v[56:59], v[168:171], a[8:11], v[56:59]
s_nop 0
ds_read_b64_tr_b16 v[236:237], v11 offset:40960
ds_read_b64_tr_b16 v[238:239], v11 offset:43008
v_mfma_f32_16x16x32_bf16 v[56:59], v[184:187], a[12:15], v[56:59]
v_mfma_f32_16x16x32_bf16 v[72:75], v[184:187], a[28:31], 0
s_nop 0
ds_read_b64_tr_b16 v[240:241], v8 offset:45056
ds_read_b64_tr_b16 v[242:243], v8 offset:47104
v_mfma_f32_16x16x32_bf16 v[72:75], v[168:171], a[24:27], v[72:75]
s_nop 0
ds_read_b64_tr_b16 v[244:245], v9 offset:45056
ds_read_b64_tr_b16 v[246:247], v9 offset:47104
v_mfma_f32_16x16x32_bf16 v[72:75], v[152:155], a[20:23], v[72:75]
s_nop 0
ds_read_b64_tr_b16 v[248:249], v10 offset:45056
ds_read_b64_tr_b16 v[250:251], v10 offset:47104
v_mfma_f32_16x16x32_bf16 v[72:75], v[136:139], a[16:19], v[72:75]
s_xor_b32 s71, s14, 0x80
buffer_load_dwordx4 a[84:87], v1, s[44:47], s69 offen offset:1024 sc1
v_mfma_f32_16x16x32_bf16 v[76:79], v[140:143], a[16:19], 0
s_add_u32 m0, s85, 32768
ds_read_b64_tr_b16 v[252:253], v11 offset:45056
ds_read_b64_tr_b16 v[254:255], v11 offset:47104
v_mfma_f32_16x16x32_bf16 v[76:79], v[156:159], a[20:23], v[76:79]
s_add_u32 s72, s71, 0
buffer_load_dwordx4 v15, s[24:27], s72 offen lds
v_mfma_f32_16x16x32_bf16 v[76:79], v[172:175], a[24:27], v[76:79]
v_mfma_f32_16x16x32_bf16 v[76:79], v[188:191], a[28:31], v[76:79]
v_mfma_f32_16x16x32_bf16 v[60:63], v[188:191], a[12:15], 0
v_mfma_f32_16x16x32_bf16 v[60:63], v[172:175], a[8:11], v[60:63]
s_add_u32 s72, s71, 15360
v_mfma_f32_16x16x32_bf16 v[60:63], v[156:159], a[4:7], v[60:63]
s_waitcnt vmcnt(35) lgkmcnt(0)
v_mfma_f32_16x16x32_bf16 v[60:63], v[140:143], a[0:3], v[60:63]
s_barrier
buffer_load_dwordx4 v15, s[24:27], s72 offen offset:1024 lds
v_mfma_f32_16x16x32_bf16 v[80:83], v[192:195], a[0:3], 0
s_nop 0
ds_read_b64_tr_b16 v[128:129], v8 offset:49152
ds_read_b64_tr_b16 v[130:131], v8 offset:51200
v_mfma_f32_16x16x32_bf16 v[80:83], v[208:211], a[4:7], v[80:83]
buffer_load_dwordx4 a[88:91], v1, s[44:47], s69 offen offset:2048 sc1
v_mfma_f32_16x16x32_bf16 v[80:83], v[224:227], a[8:11], v[80:83]
s_nop 0
ds_read_b64_tr_b16 v[132:133], v9 offset:49152
ds_read_b64_tr_b16 v[134:135], v9 offset:51200
v_mfma_f32_16x16x32_bf16 v[80:83], v[240:243], a[12:15], v[80:83]
s_nop 0
ds_read_b64_tr_b16 v[136:137], v10 offset:49152
ds_read_b64_tr_b16 v[138:139], v10 offset:51200
v_mfma_f32_16x16x32_bf16 v[96:99], v[240:243], a[28:31], 0
s_nop 0
ds_read_b64_tr_b16 v[140:141], v11 offset:49152
ds_read_b64_tr_b16 v[142:143], v11 offset:51200
v_mfma_f32_16x16x32_bf16 v[96:99], v[224:227], a[24:27], v[96:99]
s_add_u32 s72, s71, 30720
buffer_load_dwordx4 v15, s[24:27], s72 offen offset:2048 lds
v_mfma_f32_16x16x32_bf16 v[96:99], v[208:211], a[20:23], v[96:99]
v_mfma_f32_16x16x32_bf16 v[96:99], v[192:195], a[16:19], v[96:99]
s_nop 0
ds_read_b64_tr_b16 v[144:145], v8 offset:53248
ds_read_b64_tr_b16 v[146:147], v8 offset:55296
v_mfma_f32_16x16x32_bf16 v[100:103], v[196:199], a[16:19], 0
s_nop 0
ds_read_b64_tr_b16 v[148:149], v9 offset:53248
ds_read_b64_tr_b16 v[150:151], v9 offset:55296
v_mfma_f32_16x16x32_bf16 v[100:103], v[212:215], a[20:23], v[100:103]
s_nop 0
ds_read_b64_tr_b16 v[152:153], v10 offset:53248
ds_read_b64_tr_b16 v[154:155], v10 offset:55296
v_mfma_f32_16x16x32_bf16 v[100:103], v[228:231], a[24:27], v[100:103]
s_nop 0
ds_read_b64_tr_b16 v[156:157], v11 offset:53248
ds_read_b64_tr_b16 v[158:159], v11 offset:55296
v_mfma_f32_16x16x32_bf16 v[100:103], v[244:247], a[28:31], v[100:103]
s_add_u32 s72, s71, 46080
buffer_load_dwordx4 v15, s[24:27], s72 offen offset:3072 lds
v_mfma_f32_16x16x32_bf16 v[84:87], v[244:247], a[12:15], 0
buffer_load_dwordx4 a[92:95], v1, s[44:47], s69 offen offset:3072 sc1
v_mfma_f32_16x16x32_bf16 v[84:87], v[228:231], a[8:11], v[84:87]
v_mfma_f32_16x16x32_bf16 v[84:87], v[212:215], a[4:7], v[84:87]
s_nop 0
ds_read_b64_tr_b16 v[160:161], v8 offset:57344
ds_read_b64_tr_b16 v[162:163], v8 offset:59392
v_mfma_f32_16x16x32_bf16 v[84:87], v[196:199], a[0:3], v[84:87]
s_nop 0
ds_read_b64_tr_b16 v[164:165], v9 offset:57344
ds_read_b64_tr_b16 v[166:167], v9 offset:59392
v_mfma_f32_16x16x32_bf16 v[88:91], v[200:203], a[0:3], 0
s_nop 0
ds_read_b64_tr_b16 v[168:169], v10 offset:57344
ds_read_b64_tr_b16 v[170:171], v10 offset:59392
v_mfma_f32_16x16x32_bf16 v[88:91], v[216:219], a[4:7], v[88:91]
s_xor_b32 s82, s78, 4
ds_read_b64_tr_b16 v[172:173], v11 offset:57344
ds_read_b64_tr_b16 v[174:175], v11 offset:59392
v_mfma_f32_16x16x32_bf16 v[88:91], v[232:235], a[8:11], v[88:91]
s_lshl_b32 s82, s82, 10
v_mfma_f32_16x16x32_bf16 v[88:91], v[248:251], a[12:15], v[88:91]
s_xor_b32 s71, s14, 0x100
ds_read_b64_tr_b16 v[176:177], v8 offset:61440
ds_read_b64_tr_b16 v[178:179], v8 offset:63488
v_mfma_f32_16x16x32_bf16 v[104:107], v[248:251], a[28:31], 0
s_add_u32 m0, s85, 49152
ds_read_b64_tr_b16 v[180:181], v9 offset:61440
ds_read_b64_tr_b16 v[182:183], v9 offset:63488
v_mfma_f32_16x16x32_bf16 v[104:107], v[232:235], a[24:27], v[104:107]
s_add_u32 s72, s71, 0
buffer_load_dwordx4 v15, s[24:27], s72 offen lds
v_mfma_f32_16x16x32_bf16 v[104:107], v[216:219], a[20:23], v[104:107]
s_add_u32 s82, s82, s74
buffer_load_dword v3, v2, s[44:47], s82 offen sc1
v_mfma_f32_16x16x32_bf16 v[104:107], v[200:203], a[16:19], v[104:107]
s_nop 0
ds_read_b64_tr_b16 v[184:185], v10 offset:61440
ds_read_b64_tr_b16 v[186:187], v10 offset:63488
v_mfma_f32_16x16x32_bf16 v[108:111], v[204:207], a[16:19], 0
s_nop 0
ds_read_b64_tr_b16 v[188:189], v11 offset:61440
ds_read_b64_tr_b16 v[190:191], v11 offset:63488
v_mfma_f32_16x16x32_bf16 v[108:111], v[220:223], a[20:23], v[108:111]
Lstube0:
s_cbranch_execz Lstube4
v_mfma_f32_16x16x32_bf16 v[108:111], v[236:239], a[24:27], v[108:111]
s_add_u32 s72, s71, 15360
buffer_load_dwordx4 v15, s[24:27], s72 offen offset:1024 lds
v_mfma_f32_16x16x32_bf16 v[108:111], v[252:255], a[28:31], v[108:111]
s_lshr_b32 s69, s15, 18
v_mfma_f32_16x16x32_bf16 v[92:95], v[252:255], a[12:15], 0
s_lshl_b32 s69, s69, 12
v_xor_b32 v8, 0x10000, v8
v_mfma_f32_16x16x32_bf16 v[92:95], v[236:239], a[8:11], v[92:95]
s_add_u32 s69, s69, s95
v_xor_b32 v9, 0x10000, v9
v_mfma_f32_16x16x32_bf16 v[92:95], v[220:223], a[4:7], v[92:95]
s_waitcnt vmcnt(17) lgkmcnt(0)
v_xor_b32 v10, 0x10000, v10
v_mfma_f32_16x16x32_bf16 v[92:95], v[204:207], a[0:3], v[92:95]
s_barrier
buffer_load_dwordx4 a[96:99], v1, s[44:47], s69 offen sc1
v_xor_b32 v11, 0x10000, v11
v_mfma_f32_16x16x32_bf16 v[16:19], v[128:131], a[32:35], v[16:19]
s_add_u32 s72, s71, 30720
buffer_load_dwordx4 v15, s[24:27], s72 offen offset:2048 lds
v_mfma_f32_16x16x32_bf16 v[16:19], v[144:147], a[36:39], v[16:19]
s_nop 0
ds_read_b64_tr_b16 v[192:193], v8 offset:0
ds_read_b64_tr_b16 v[194:195], v8 offset:2048
v_mfma_f32_16x16x32_bf16 v[16:19], v[160:163], a[40:43], v[16:19]
s_nop 0
ds_read_b64_tr_b16 v[196:197], v9 offset:0
ds_read_b64_tr_b16 v[198:199], v9 offset:2048
v_mfma_f32_16x16x32_bf16 v[16:19], v[176:179], a[44:47], v[16:19]
s_nop 0
ds_read_b64_tr_b16 v[200:201], v10 offset:0
ds_read_b64_tr_b16 v[202:203], v10 offset:2048
v_mfma_f32_16x16x32_bf16 v[32:35], v[176:179], a[60:63], v[32:35]
s_nop 0
ds_read_b64_tr_b16 v[204:205], v11 offset:0
ds_read_b64_tr_b16 v[206:207], v11 offset:2048
v_mfma_f32_16x16x32_bf16 v[32:35], v[160:163], a[56:59], v[32:35]
v_or_b32 v112, s58, v0
v_mov_b32 v113, 3
v_mfma_f32_16x16x32_bf16 v[32:35], v[144:147], a[52:55], v[32:35]
s_add_u32 s72, s71, 46080
buffer_load_dwordx4 v15, s[24:27], s72 offen offset:3072 lds
v_mfma_f32_16x16x32_bf16 v[32:35], v[128:131], a[48:51], v[32:35]
s_nop 0
ds_read_b64_tr_b16 v[208:209], v8 offset:4096
ds_read_b64_tr_b16 v[210:211], v8 offset:6144
v_mfma_f32_16x16x32_bf16 v[36:39], v[132:135], a[48:51], v[36:39]
s_nop 0
ds_read_b64_tr_b16 v[212:213], v9 offset:4096
ds_read_b64_tr_b16 v[214:215], v9 offset:6144
v_mfma_f32_16x16x32_bf16 v[36:39], v[148:151], a[52:55], v[36:39]
buffer_load_dwordx4 a[100:103], v1, s[44:47], s69 offen offset:1024 sc1
v_mfma_f32_16x16x32_bf16 v[36:39], v[164:167], a[56:59], v[36:39]
s_nop 0
ds_read_b64_tr_b16 v[216:217], v10 offset:4096
ds_read_b64_tr_b16 v[218:219], v10 offset:6144
v_mfma_f32_16x16x32_bf16 v[36:39], v[180:183], a[60:63], v[36:39]
v_min_u32 v112, 1, v112
v_lshlrev_b32 v112, 30, v112
v_mfma_f32_16x16x32_bf16 v[20:23], v[180:183], a[44:47], v[20:23]
s_nop 0
ds_read_b64_tr_b16 v[220:221], v11 offset:4096
ds_read_b64_tr_b16 v[222:223], v11 offset:6144
v_mfma_f32_16x16x32_bf16 v[20:23], v[164:167], a[40:43], v[20:23]
s_nop 0
ds_read_b64_tr_b16 v[224:225], v8 offset:8192
ds_read_b64_tr_b16 v[226:227], v8 offset:10240
v_mfma_f32_16x16x32_bf16 v[20:23], v[148:151], a[36:39], v[20:23]
s_xor_b32 s71, s14, 0x180
ds_read_b64_tr_b16 v[228:229], v9 offset:8192
ds_read_b64_tr_b16 v[230:231], v9 offset:10240
v_mfma_f32_16x16x32_bf16 v[20:23], v[132:135], a[32:35], v[20:23]
s_add_u32 m0, s77, 0
buffer_store_dword v113, v112, s[44:47], s91 offen sc1
v_mfma_f32_16x16x32_bf16 v[24:27], v[136:139], a[32:35], v[24:27]
s_add_u32 s72, s71, 0
buffer_load_dwordx4 v15, s[24:27], s72 offen lds
v_mfma_f32_16x16x32_bf16 v[24:27], v[152:155], a[36:39], v[24:27]
s_nop 0
ds_read_b64_tr_b16 v[232:233], v10 offset:8192
ds_read_b64_tr_b16 v[234:235], v10 offset:10240
v_mfma_f32_16x16x32_bf16 v[24:27], v[168:171], a[40:43], v[24:27]
s_nop 0
ds_read_b64_tr_b16 v[236:237], v11 offset:8192
ds_read_b64_tr_b16 v[238:239], v11 offset:10240
v_mfma_f32_16x16x32_bf16 v[24:27], v[184:187], a[44:47], v[24:27]
buffer_load_dwordx4 a[104:107], v1, s[44:47], s69 offen offset:2048 sc1
v_mfma_f32_16x16x32_bf16 v[40:43], v[184:187], a[60:63], v[40:43]
s_nop 0
ds_read_b64_tr_b16 v[240:241], v8 offset:12288
ds_read_b64_tr_b16 v[242:243], v8 offset:14336
v_mfma_f32_16x16x32_bf16 v[40:43], v[168:171], a[56:59], v[40:43]
v_mfma_f32_16x16x32_bf16 v[40:43], v[152:155], a[52:55], v[40:43]
s_add_u32 s72, s71, 15360
buffer_load_dwordx4 v15, s[24:27], s72 offen offset:1024 lds
v_mfma_f32_16x16x32_bf16 v[40:43], v[136:139], a[48:51], v[40:43]
s_nop 0
ds_read_b64_tr_b16 v[244:245], v9 offset:12288
ds_read_b64_tr_b16 v[246:247], v9 offset:14336
v_mfma_f32_16x16x32_bf16 v[44:47], v[140:143], a[48:51], v[44:47]
s_nop 0
ds_read_b64_tr_b16 v[248:249], v10 offset:12288
ds_read_b64_tr_b16 v[250:251], v10 offset:14336
v_mfma_f32_16x16x32_bf16 v[44:47], v[156:159], a[52:55], v[44:47]
s_nop 0
ds_read_b64_tr_b16 v[252:253], v11 offset:12288
ds_read_b64_tr_b16 v[254:255], v11 offset:14336
v_mfma_f32_16x16x32_bf16 v[44:47], v[172:175], a[56:59], v[44:47]
v_mfma_f32_16x16x32_bf16 v[44:47], v[188:191], a[60:63], v[44:47]
v_mfma_f32_16x16x32_bf16 v[28:31], v[188:191], a[44:47], v[28:31]
s_add_u32 s72, s71, 30720
buffer_load_dwordx4 v15, s[24:27], s72 offen offset:2048 lds
v_mfma_f32_16x16x32_bf16 v[28:31], v[172:175], a[40:43], v[28:31]
buffer_load_dwordx4 a[108:111], v1, s[44:47], s69 offen offset:3072 sc1
v_mfma_f32_16x16x32_bf16 v[28:31], v[156:159], a[36:39], v[28:31]
s_waitcnt vmcnt(20) lgkmcnt(0)
v_mfma_f32_16x16x32_bf16 v[28:31], v[140:143], a[32:35], v[28:31]
s_barrier
v_mfma_f32_16x16x32_bf16 v[48:51], v[192:195], a[32:35], v[48:51]
s_nop 0
ds_read_b64_tr_b16 v[128:129], v8 offset:16384
ds_read_b64_tr_b16 v[130:131], v8 offset:18432
v_mfma_f32_16x16x32_bf16 v[48:51], v[208:211], a[36:39], v[48:51]
s_nop 0
ds_read_b64_tr_b16 v[132:133], v9 offset:16384
ds_read_b64_tr_b16 v[134:135], v9 offset:18432
v_mfma_f32_16x16x32_bf16 v[48:51], v[224:227], a[40:43], v[48:51]
s_add_u32 s72, s71, 46080
buffer_load_dwordx4 v15, s[24:27], s72 offen offset:3072 lds
v_mfma_f32_16x16x32_bf16 v[48:51], v[240:243], a[44:47], v[48:51]
s_nop 0
ds_read_b64_tr_b16 v[136:137], v10 offset:16384
ds_read_b64_tr_b16 v[138:139], v10 offset:18432
v_mfma_f32_16x16x32_bf16 v[64:67], v[240:243], a[60:63], v[64:67]
s_nop 0
ds_read_b64_tr_b16 v[140:141], v11 offset:16384
ds_read_b64_tr_b16 v[142:143], v11 offset:18432
v_mfma_f32_16x16x32_bf16 v[64:67], v[224:227], a[56:59], v[64:67]
v_and_b32 v120, 15, v0
v_lshrrev_b32 v121, 4, v0
v_mfma_f32_16x16x32_bf16 v[64:67], v[208:211], a[52:55], v[64:67]
s_nop 0
ds_read_b64_tr_b16 v[144:145], v8 offset:20480
ds_read_b64_tr_b16 v[146:147], v8 offset:22528
v_mfma_f32_16x16x32_bf16 v[64:67], v[192:195], a[48:51], v[64:67]
s_add_u32 s69, s69, 0x20000
buffer_load_dwordx4 a[112:115], v1, s[44:47], s69 offen sc1
v_mfma_f32_16x16x32_bf16 v[68:71], v[196:199], a[48:51], v[68:71]
s_nop 0
ds_read_b64_tr_b16 v[148:149], v9 offset:20480
ds_read_b64_tr_b16 v[150:151], v9 offset:22528
v_mfma_f32_16x16x32_bf16 v[68:71], v[212:215], a[52:55], v[68:71]
s_nop 0
ds_read_b64_tr_b16 v[152:153], v10 offset:20480
ds_read_b64_tr_b16 v[154:155], v10 offset:22528
v_mfma_f32_16x16x32_bf16 v[68:71], v[228:231], a[56:59], v[68:71]
s_xor_b32 s71, s15, 0x80
v_lshlrev_b32 v121, 2, v121
v_sub_u32 v120, v120, v121
v_mfma_f32_16x16x32_bf16 v[68:71], v[244:247], a[60:63], v[68:71]
s_add_u32 m0, s77, 16384
ds_read_b64_tr_b16 v[156:157], v11 offset:20480
ds_read_b64_tr_b16 v[158:159], v11 offset:22528
v_mfma_f32_16x16x32_bf16 v[52:55], v[244:247], a[44:47], v[52:55]
s_add_u32 s72, s71, 0
buffer_load_dwordx4 v15, s[24:27], s72 offen lds
v_mfma_f32_16x16x32_bf16 v[52:55], v[228:231], a[40:43], v[52:55]
s_nop 0
ds_read_b64_tr_b16 v[160:161], v8 offset:24576
ds_read_b64_tr_b16 v[162:163], v8 offset:26624
v_mfma_f32_16x16x32_bf16 v[52:55], v[212:215], a[36:39], v[52:55]
s_nop 0
ds_read_b64_tr_b16 v[164:165], v9 offset:24576
ds_read_b64_tr_b16 v[166:167], v9 offset:26624
v_mfma_f32_16x16x32_bf16 v[52:55], v[196:199], a[32:35], v[52:55]
v_min_u32 v120, 4, v120
v_lshlrev_b32 v120, 3, v120
v_mfma_f32_16x16x32_bf16 v[56:59], v[200:203], a[32:35], v[56:59]
s_nop 0
ds_read_b64_tr_b16 v[168:169], v10 offset:24576
ds_read_b64_tr_b16 v[170:171], v10 offset:26624
v_mfma_f32_16x16x32_bf16 v[56:59], v[216:219], a[36:39], v[56:59]
s_add_u32 s72, s71, 15360
buffer_load_dwordx4 v15, s[24:27], s72 offen offset:1024 lds
v_mfma_f32_16x16x32_bf16 v[56:59], v[232:235], a[40:43], v[56:59]
buffer_load_dwordx4 a[116:119], v1, s[44:47], s69 offen offset:1024 sc1
v_mfma_f32_16x16x32_bf16 v[56:59], v[248:251], a[44:47], v[56:59]
s_nop 0
ds_read_b64_tr_b16 v[172:173], v11 offset:24576
ds_read_b64_tr_b16 v[174:175], v11 offset:26624
v_mfma_f32_16x16x32_bf16 v[72:75], v[248:251], a[60:63], v[72:75]
s_nop 0
ds_read_b64_tr_b16 v[176:177], v8 offset:28672
ds_read_b64_tr_b16 v[178:179], v8 offset:30720
v_mfma_f32_16x16x32_bf16 v[72:75], v[232:235], a[56:59], v[72:75]
v_mov_b32 v122, 0x3f80
v_mov_b32 v123, 0
v_mfma_f32_16x16x32_bf16 v[72:75], v[216:219], a[52:55], v[72:75]
s_nop 0
ds_read_b64_tr_b16 v[180:181], v9 offset:28672
ds_read_b64_tr_b16 v[182:183], v9 offset:30720
v_mfma_f32_16x16x32_bf16 v[72:75], v[200:203], a[48:51], v[72:75]
s_add_u32 s72, s71, 30720
buffer_load_dwordx4 v15, s[24:27], s72 offen offset:2048 lds
v_mfma_f32_16x16x32_bf16 v[76:79], v[204:207], a[48:51], v[76:79]
s_nop 0
ds_read_b64_tr_b16 v[184:185], v10 offset:28672
ds_read_b64_tr_b16 v[186:187], v10 offset:30720
v_mfma_f32_16x16x32_bf16 v[76:79], v[220:223], a[52:55], v[76:79]
s_nop 0
ds_read_b64_tr_b16 v[188:189], v11 offset:28672
ds_read_b64_tr_b16 v[190:191], v11 offset:30720
v_mfma_f32_16x16x32_bf16 v[76:79], v[236:239], a[56:59], v[76:79]
v_lshlrev_b64 v[122:123], v120, v[122:123]
v_mov_b32 v126, 0
v_mfma_f32_16x16x32_bf16 v[76:79], v[252:255], a[60:63], v[76:79]
buffer_load_dwordx4 a[120:123], v1, s[44:47], s69 offen offset:2048 sc1
v_mfma_f32_16x16x32_bf16 v[60:63], v[252:255], a[44:47], v[60:63]
v_lshlrev_b64 v[122:123], v120, v[122:123]
v_mov_b32 v127, 0
v_mfma_f32_16x16x32_bf16 v[60:63], v[236:239], a[40:43], v[60:63]
s_add_u32 s72, s71, 46080
buffer_load_dwordx4 v15, s[24:27], s72 offen offset:3072 lds
v_mfma_f32_16x16x32_bf16 v[60:63], v[220:223], a[36:39], v[60:63]
s_waitcnt vmcnt(22) lgkmcnt(0)
v_mov_b32 v120, 0
v_mov_b32 v121, 0
v_mfma_f32_16x16x32_bf16 v[60:63], v[204:207], a[32:35], v[60:63]
s_barrier
v_mov_b32 v124, v122
v_mov_b32 v125, v123
v_mfma_f32_16x16x32_bf16 v[80:83], v[128:131], a[32:35], v[80:83]
s_nop 0
ds_read_b64_tr_b16 v[192:193], v8 offset:32768
ds_read_b64_tr_b16 v[194:195], v8 offset:34816
v_mfma_f32_16x16x32_bf16 v[80:83], v[144:147], a[36:39], v[80:83]
s_nop 0
ds_read_b64_tr_b16 v[196:197], v9 offset:32768
ds_read_b64_tr_b16 v[198:199], v9 offset:34816
v_mfma_f32_16x16x32_bf16 v[80:83], v[160:163], a[40:43], v[80:83]
s_nop 0
ds_read_b64_tr_b16 v[200:201], v10 offset:32768
ds_read_b64_tr_b16 v[202:203], v10 offset:34816
v_mfma_f32_16x16x32_bf16 v[80:83], v[176:179], a[44:47], v[80:83]
s_nop 0
ds_read_b64_tr_b16 v[204:205], v11 offset:32768
ds_read_b64_tr_b16 v[206:207], v11 offset:34816
v_mfma_f32_16x16x32_bf16 v[96:99], v[176:179], a[60:63], v[96:99]
v_mfma_f32_16x16x32_bf16 v[96:99], v[160:163], a[56:59], v[96:99]
s_xor_b32 s71, s15, 0x100
buffer_load_dwordx4 a[124:127], v1, s[44:47], s69 offen offset:3072 sc1
v_mfma_f32_16x16x32_bf16 v[96:99], v[144:147], a[52:55], v[96:99]
s_add_u32 m0, s77, 32768
ds_read_b64_tr_b16 v[208:209], v8 offset:36864
ds_read_b64_tr_b16 v[210:211], v8 offset:38912
v_mfma_f32_16x16x32_bf16 v[96:99], v[128:131], a[48:51], v[96:99]
s_add_u32 s72, s71, 0
buffer_load_dwordx4 v15, s[24:27], s72 offen lds
v_mfma_f32_16x16x32_bf16 v[100:103], v[132:135], a[48:51], v[100:103]
s_nop 0
ds_read_b64_tr_b16 v[212:213], v9 offset:36864
ds_read_b64_tr_b16 v[214:215], v9 offset:38912
v_mfma_f32_16x16x32_bf16 v[100:103], v[148:151], a[52:55], v[100:103]
s_nop 0
ds_read_b64_tr_b16 v[216:217], v10 offset:36864
ds_read_b64_tr_b16 v[218:219], v10 offset:38912
v_mfma_f32_16x16x32_bf16 v[100:103], v[164:167], a[56:59], v[100:103]
s_nop 0
ds_read_b64_tr_b16 v[220:221], v11 offset:36864
ds_read_b64_tr_b16 v[222:223], v11 offset:38912
v_mfma_f32_16x16x32_bf16 v[100:103], v[180:183], a[60:63], v[100:103]
v_mfma_f32_16x16x32_bf16 v[84:87], v[180:183], a[44:47], v[84:87]
s_nop 0
ds_read_b64_tr_b16 v[224:225], v8 offset:40960
ds_read_b64_tr_b16 v[226:227], v8 offset:43008
v_mfma_f32_16x16x32_bf16 v[84:87], v[164:167], a[40:43], v[84:87]
s_add_u32 s72, s71, 15360
buffer_load_dwordx4 v15, s[24:27], s72 offen offset:1024 lds
v_mfma_f32_16x16x32_bf16 v[84:87], v[148:151], a[36:39], v[84:87]
s_nop 0
ds_read_b64_tr_b16 v[228:229], v9 offset:40960
ds_read_b64_tr_b16 v[230:231], v9 offset:43008
v_mfma_f32_16x16x32_bf16 v[84:87], v[132:135], a[32:35], v[84:87]
s_waitcnt vmcnt(22)
v_cmp_gt_u32 vcc, 2, v3
s_cbranch_vccnz Lspin106
Lback107:
s_lshr_b32 s69, s12, 18
s_lshl_b32 s69, s69, 12
s_add_u32 s69, s69, s95
s_xor_b32 s69, s69, 0x1000
buffer_load_dwordx4 a[128:131], v1, s[44:47], s69 offen sc1
v_mfma_f32_16x16x32_bf16 v[88:91], v[136:139], a[32:35], v[88:91]
s_nop 0
ds_read_b64_tr_b16 v[232:233], v10 offset:40960
ds_read_b64_tr_b16 v[234:235], v10 offset:43008
v_mfma_f32_16x16x32_bf16 v[88:91], v[152:155], a[36:39], v[88:91]
s_nop 0
ds_read_b64_tr_b16 v[236:237], v11 offset:40960
ds_read_b64_tr_b16 v[238:239], v11 offset:43008
v_mfma_f32_16x16x32_bf16 v[88:91], v[168:171], a[40:43], v[88:91]
v_mfma_f32_16x16x32_bf16 v[88:91], v[184:187], a[44:47], v[88:91]
s_add_u32 s72, s71, 30720
buffer_load_dwordx4 v15, s[24:27], s72 offen offset:2048 lds
v_mfma_f32_16x16x32_bf16 v[104:107], v[184:187], a[60:63], v[104:107]
s_nop 0
ds_read_b64_tr_b16 v[240:241], v8 offset:45056
ds_read_b64_tr_b16 v[242:243], v8 offset:47104
v_mfma_f32_16x16x32_bf16 v[104:107], v[168:171], a[56:59], v[104:107]
s_nop 0
ds_read_b64_tr_b16 v[244:245], v9 offset:45056
ds_read_b64_tr_b16 v[246:247], v9 offset:47104
v_mfma_f32_16x16x32_bf16 v[104:107], v[152:155], a[52:55], v[104:107]
s_nop 0
ds_read_b64_tr_b16 v[248:249], v10 offset:45056
ds_read_b64_tr_b16 v[250:251], v10 offset:47104
v_mfma_f32_16x16x32_bf16 v[104:107], v[136:139], a[48:51], v[104:107]
s_nop 0
ds_read_b64_tr_b16 v[252:253], v11 offset:45056
ds_read_b64_tr_b16 v[254:255], v11 offset:47104
v_mfma_f32_16x16x32_bf16 v[108:111], v[140:143], a[48:51], v[108:111]
v_mfma_f32_16x16x32_bf16 v[108:111], v[156:159], a[52:55], v[108:111]
s_add_u32 s72, s71, 46080
buffer_load_dwordx4 v15, s[24:27], s72 offen offset:3072 lds
v_mfma_f32_16x16x32_bf16 v[108:111], v[172:175], a[56:59], v[108:111]
buffer_load_dwordx4 a[132:135], v1, s[44:47], s69 offen offset:1024 sc1
v_mfma_f32_16x16x32_bf16 v[108:111], v[188:191], a[60:63], v[108:111]
v_mfma_f32_16x16x32_bf16 v[92:95], v[188:191], a[44:47], v[92:95]
v_mfma_f32_16x16x32_bf16 v[92:95], v[172:175], a[40:43], v[92:95]
v_mfma_f32_16x16x32_bf16 v[92:95], v[156:159], a[36:39], v[92:95]
s_waitcnt vmcnt(22) lgkmcnt(0)
v_mfma_f32_16x16x32_bf16 v[92:95], v[140:143], a[32:35], v[92:95]
s_barrier
v_mfma_f32_16x16x32_bf16 v[16:19], v[192:195], a[64:67], v[16:19]
s_nop 0
ds_read_b64_tr_b16 v[128:129], v8 offset:49152
ds_read_b64_tr_b16 v[130:131], v8 offset:51200
v_mfma_f32_16x16x32_bf16 v[16:19], v[208:211], a[68:71], v[16:19]
s_xor_b32 s71, s15, 0x180
ds_read_b64_tr_b16 v[132:133], v9 offset:49152
ds_read_b64_tr_b16 v[134:135], v9 offset:51200
v_mfma_f32_16x16x32_bf16 v[16:19], v[224:227], a[72:75], v[16:19]
s_add_u32 m0, s77, 49152
ds_read_b64_tr_b16 v[136:137], v10 offset:49152
ds_read_b64_tr_b16 v[138:139], v10 offset:51200
v_mfma_f32_16x16x32_bf16 v[16:19], v[240:243], a[76:79], v[16:19]
s_add_u32 s72, s71, 0
buffer_load_dwordx4 v15, s[24:27], s72 offen lds
v_mfma_f32_16x16x32_bf16 v[32:35], v[240:243], a[92:95], v[32:35]
buffer_load_dwordx4 a[136:139], v1, s[44:47], s69 offen offset:2048 sc1
v_mfma_f32_16x16x32_bf16 v[32:35], v[224:227], a[88:91], v[32:35]
s_nop 0
ds_read_b64_tr_b16 v[140:141], v11 offset:49152
ds_read_b64_tr_b16 v[142:143], v11 offset:51200
v_mfma_f32_16x16x32_bf16 v[32:35], v[208:211], a[84:87], v[32:35]
v_mfma_f32_16x16x32_bf16 v[32:35], v[192:195], a[80:83], v[32:35]
s_nop 0
ds_read_b64_tr_b16 v[144:145], v8 offset:53248
ds_read_b64_tr_b16 v[146:147], v8 offset:55296
v_mfma_f32_16x16x32_bf16 v[36:39], v[196:199], a[80:83], v[36:39]
s_add_u32 s72, s71, 15360
buffer_load_dwordx4 v15, s[24:27], s72 offen offset:1024 lds
v_mfma_f32_16x16x32_bf16 v[36:39], v[212:215], a[84:87], v[36:39]
s_nop 0
ds_read_b64_tr_b16 v[148:149], v9 offset:53248
ds_read_b64_tr_b16 v[150:151], v9 offset:55296
v_mfma_f32_16x16x32_bf16 v[36:39], v[228:231], a[88:91], v[36:39]
s_nop 0
ds_read_b64_tr_b16 v[152:153], v10 offset:53248
ds_read_b64_tr_b16 v[154:155], v10 offset:55296
v_mfma_f32_16x16x32_bf16 v[36:39], v[244:247], a[92:95], v[36:39]
s_nop 0
ds_read_b64_tr_b16 v[156:157], v11 offset:53248
ds_read_b64_tr_b16 v[158:159], v11 offset:55296
v_mfma_f32_16x16x32_bf16 v[20:23], v[244:247], a[76:79], v[20:23]
v_mfma_f32_16x16x32_bf16 v[20:23], v[228:231], a[72:75], v[20:23]
buffer_load_dwordx4 a[140:143], v1, s[44:47], s69 offen offset:3072 sc1
v_mfma_f32_16x16x32_bf16 v[20:23], v[212:215], a[68:71], v[20:23]
s_add_u32 s72, s71, 30720
buffer_load_dwordx4 v15, s[24:27], s72 offen offset:2048 lds
v_mfma_f32_16x16x32_bf16 v[20:23], v[196:199], a[64:67], v[20:23]
s_nop 0
ds_read_b64_tr_b16 v[160:161], v8 offset:57344
ds_read_b64_tr_b16 v[162:163], v8 offset:59392
v_mfma_f32_16x16x32_bf16 v[24:27], v[200:203], a[64:67], v[24:27]
s_nop 0
ds_read_b64_tr_b16 v[164:165], v9 offset:57344
ds_read_b64_tr_b16 v[166:167], v9 offset:59392
v_mfma_f32_16x16x32_bf16 v[24:27], v[216:219], a[68:71], v[24:27]
s_nop 0
ds_read_b64_tr_b16 v[168:169], v10 offset:57344
ds_read_b64_tr_b16 v[170:171], v10 offset:59392
v_mfma_f32_16x16x32_bf16 v[24:27], v[232:235], a[72:75], v[24:27]
s_nop 0
ds_read_b64_tr_b16 v[172:173], v11 offset:57344
ds_read_b64_tr_b16 v[174:175], v11 offset:59392
v_mfma_f32_16x16x32_bf16 v[24:27], v[248:251], a[76:79], v[24:27]
v_mfma_f32_16x16x32_bf16 v[40:43], v[248:251], a[92:95], v[40:43]
s_add_u32 s72, s71, 46080
buffer_load_dwordx4 v15, s[24:27], s72 offen offset:3072 lds
v_mfma_f32_16x16x32_bf16 v[40:43], v[232:235], a[88:91], v[40:43]
s_nop 0
ds_read_b64_tr_b16 v[176:177], v8 offset:61440
ds_read_b64_tr_b16 v[178:179], v8 offset:63488
v_mfma_f32_16x16x32_bf16 v[40:43], v[216:219], a[84:87], v[40:43]
s_nop 0
ds_read_b64_tr_b16 v[180:181], v9 offset:61440
ds_read_b64_tr_b16 v[182:183], v9 offset:63488
v_mfma_f32_16x16x32_bf16 v[40:43], v[200:203], a[80:83], v[40:43]
s_add_u32 s69, s69, 0x20000
buffer_load_dwordx4 a[144:147], v1, s[44:47], s69 offen sc1
v_mfma_f32_16x16x32_bf16 v[44:47], v[204:207], a[80:83], v[44:47]
s_nop 0
ds_read_b64_tr_b16 v[184:185], v10 offset:61440
ds_read_b64_tr_b16 v[186:187], v10 offset:63488
v_mfma_f32_16x16x32_bf16 v[44:47], v[220:223], a[84:87], v[44:47]
s_nop 0
ds_read_b64_tr_b16 v[188:189], v11 offset:61440
ds_read_b64_tr_b16 v[190:191], v11 offset:63488
v_mfma_f32_16x16x32_bf16 v[44:47], v[236:239], a[88:91], v[44:47]
v_mfma_f32_16x16x32_bf16 v[44:47], v[252:255], a[92:95], v[44:47]
s_xor_b32 s71, s12, 0x40080
v_mfma_f32_16x16x32_bf16 v[28:31], v[252:255], a[76:79], v[28:31]
s_add_u32 m0, s85, 0
v_xor_b32 v8, 0x10000, v8
v_mfma_f32_16x16x32_bf16 v[28:31], v[236:239], a[72:75], v[28:31]
s_add_u32 s72, s71, 0
v_xor_b32 v9, 0x10000, v9
v_mfma_f32_16x16x32_bf16 v[28:31], v[220:223], a[68:71], v[28:31]
s_waitcnt vmcnt(21) lgkmcnt(0)
buffer_load_dwordx4 v15, s[24:27], s72 offen lds
v_xor_b32 v10, 0x10000, v10
v_mfma_f32_16x16x32_bf16 v[28:31], v[204:207], a[64:67], v[28:31]
s_barrier
v_xor_b32 v11, 0x10000, v11
v_mfma_f32_16x16x32_bf16 v[48:51], v[128:131], a[64:67], v[48:51]
s_nop 0
ds_read_b64_tr_b16 v[192:193], v8 offset:0
ds_read_b64_tr_b16 v[194:195], v8 offset:2048
v_mfma_f32_16x16x32_bf16 v[48:51], v[144:147], a[68:71], v[48:51]
buffer_load_dwordx4 a[148:151], v1, s[44:47], s69 offen offset:1024 sc1
v_mfma_f32_16x16x32_bf16 v[48:51], v[160:163], a[72:75], v[48:51]
s_nop 0
ds_read_b64_tr_b16 v[196:197], v9 offset:0
ds_read_b64_tr_b16 v[198:199], v9 offset:2048
v_mfma_f32_16x16x32_bf16 v[48:51], v[176:179], a[76:79], v[48:51]
s_add_u32 s72, s71, 15360
buffer_load_dwordx4 v15, s[24:27], s72 offen offset:1024 lds
v_mfma_f32_16x16x32_bf16 v[64:67], v[176:179], a[92:95], v[64:67]
s_nop 0
ds_read_b64_tr_b16 v[200:201], v10 offset:0
ds_read_b64_tr_b16 v[202:203], v10 offset:2048
v_mfma_f32_16x16x32_bf16 v[64:67], v[160:163], a[88:91], v[64:67]
s_nop 0
ds_read_b64_tr_b16 v[204:205], v11 offset:0
ds_read_b64_tr_b16 v[206:207], v11 offset:2048
v_mfma_f32_16x16x32_bf16 v[64:67], v[144:147], a[84:87], v[64:67]
v_mfma_f32_16x16x32_bf16 v[64:67], v[128:131], a[80:83], v[64:67]
s_nop 0
ds_read_b64_tr_b16 v[208:209], v8 offset:4096
ds_read_b64_tr_b16 v[210:211], v8 offset:6144
v_mfma_f32_16x16x32_bf16 v[68:71], v[132:135], a[80:83], v[68:71]
s_nop 0
ds_read_b64_tr_b16 v[212:213], v9 offset:4096
ds_read_b64_tr_b16 v[214:215], v9 offset:6144
v_mfma_f32_16x16x32_bf16 v[68:71], v[148:151], a[84:87], v[68:71]
s_add_u32 s72, s71, 30720
buffer_load_dwordx4 v15, s[24:27], s72 offen offset:2048 lds
v_mfma_f32_16x16x32_bf16 v[68:71], v[164:167], a[88:91], v[68:71]
s_nop 0
ds_read_b64_tr_b16 v[216:217], v10 offset:4096
ds_read_b64_tr_b16 v[218:219], v10 offset:6144
v_mfma_f32_16x16x32_bf16 v[68:71], v[180:183], a[92:95], v[68:71]
buffer_load_dwordx4 a[152:155], v1, s[44:47], s69 offen offset:2048 sc1
v_mfma_f32_16x16x32_bf16 v[52:55], v[180:183], a[76:79], v[52:55]
s_nop 0
ds_read_b64_tr_b16 v[220:221], v11 offset:4096
ds_read_b64_tr_b16 v[222:223], v11 offset:6144
v_mfma_f32_16x16x32_bf16 v[52:55], v[164:167], a[72:75], v[52:55]
v_mfma_f32_16x16x32_bf16 v[52:55], v[148:151], a[68:71], v[52:55]
s_nop 0
ds_read_b64_tr_b16 v[224:225], v8 offset:8192
ds_read_b64_tr_b16 v[226:227], v8 offset:10240
v_mfma_f32_16x16x32_bf16 v[52:55], v[132:135], a[64:67], v[52:55]
s_add_u32 s72, s71, 46080
buffer_load_dwordx4 v15, s[24:27], s72 offen offset:3072 lds
v_mfma_f32_16x16x32_bf16 v[56:59], v[136:139], a[64:67], v[56:59]
s_nop 0
ds_read_b64_tr_b16 v[228:229], v9 offset:8192
ds_read_b64_tr_b16 v[230:231], v9 offset:10240
v_mfma_f32_16x16x32_bf16 v[56:59], v[152:155], a[68:71], v[56:59]
s_nop 0
ds_read_b64_tr_b16 v[232:233], v10 offset:8192
ds_read_b64_tr_b16 v[234:235], v10 offset:10240
v_mfma_f32_16x16x32_bf16 v[56:59], v[168:171], a[72:75], v[56:59]
s_nop 0
ds_read_b64_tr_b16 v[236:237], v11 offset:8192
ds_read_b64_tr_b16 v[238:239], v11 offset:10240
v_mfma_f32_16x16x32_bf16 v[56:59], v[184:187], a[76:79], v[56:59]
v_mfma_f32_16x16x32_bf16 v[72:75], v[184:187], a[92:95], v[72:75]
s_nop 0
ds_read_b64_tr_b16 v[240:241], v8 offset:12288
ds_read_b64_tr_b16 v[242:243], v8 offset:14336
v_mfma_f32_16x16x32_bf16 v[72:75], v[168:171], a[88:91], v[72:75]
buffer_load_dwordx4 a[156:159], v1, s[44:47], s69 offen offset:3072 sc1
v_mfma_f32_16x16x32_bf16 v[72:75], v[152:155], a[84:87], v[72:75]
s_lshr_b32 s69, s13, 18
ds_read_b64_tr_b16 v[244:245], v9 offset:12288
ds_read_b64_tr_b16 v[246:247], v9 offset:14336
v_mfma_f32_16x16x32_bf16 v[72:75], v[136:139], a[80:83], v[72:75]
s_xor_b32 s71, s12, 0x40100
ds_read_b64_tr_b16 v[248:249], v10 offset:12288
ds_read_b64_tr_b16 v[250:251], v10 offset:14336
v_mfma_f32_16x16x32_bf16 v[76:79], v[140:143], a[80:83], v[76:79]
s_add_u32 m0, s85, 16384
ds_read_b64_tr_b16 v[252:253], v11 offset:12288
ds_read_b64_tr_b16 v[254:255], v11 offset:14336
v_mfma_f32_16x16x32_bf16 v[76:79], v[156:159], a[84:87], v[76:79]
s_add_u32 s72, s71, 0
buffer_load_dwordx4 v15, s[24:27], s72 offen lds
v_mfma_f32_16x16x32_bf16 v[76:79], v[172:175], a[88:91], v[76:79]
s_lshl_b32 s69, s69, 12
v_mfma_f32_16x16x32_bf16 v[76:79], v[188:191], a[92:95], v[76:79]
s_add_u32 s69, s69, s95
v_mfma_f32_16x16x32_bf16 v[60:63], v[188:191], a[76:79], v[60:63]
s_xor_b32 s69, s69, 0x1000
v_mfma_f32_16x16x32_bf16 v[60:63], v[172:175], a[72:75], v[60:63]
s_add_u32 s72, s71, 15360
v_mfma_f32_16x16x32_bf16 v[60:63], v[156:159], a[68:71], v[60:63]
s_waitcnt vmcnt(16) lgkmcnt(0)
buffer_load_dwordx4 a[160:163], v1, s[44:47], s69 offen sc1
v_mfma_f32_16x16x32_bf16 v[60:63], v[140:143], a[64:67], v[60:63]
s_barrier
buffer_load_dwordx4 v15, s[24:27], s72 offen offset:1024 lds
v_mfma_f32_16x16x32_bf16 v[80:83], v[192:195], a[64:67], v[80:83]
s_and_b32 s79, s91, 0xffffcfff
v_lshlrev_b32 v13, 2, v2
buffer_load_dword v14, v13, s[44:47], s79 offen sc1
v_mfma_f32_16x16x32_bf16 v[80:83], v[208:211], a[68:71], v[80:83]
s_nop 0
ds_read_b64_tr_b16 v[128:129], v8 offset:16384
ds_read_b64_tr_b16 v[130:131], v8 offset:18432
v_mfma_f32_16x16x32_bf16 v[80:83], v[224:227], a[72:75], v[80:83]
s_nop 0
ds_read_b64_tr_b16 v[132:133], v9 offset:16384
ds_read_b64_tr_b16 v[134:135], v9 offset:18432
v_mfma_f32_16x16x32_bf16 v[80:83], v[240:243], a[76:79], v[80:83]
s_nop 0
ds_read_b64_tr_b16 v[136:137], v10 offset:16384
ds_read_b64_tr_b16 v[138:139], v10 offset:18432
v_mfma_f32_16x16x32_bf16 v[96:99], v[240:243], a[92:95], v[96:99]
s_nop 0
ds_read_b64_tr_b16 v[140:141], v11 offset:16384
ds_read_b64_tr_b16 v[142:143], v11 offset:18432
v_mfma_f32_16x16x32_bf16 v[96:99], v[224:227], a[88:91], v[96:99]
s_add_u32 s72, s71, 30720
buffer_load_dwordx4 v15, s[24:27], s72 offen offset:2048 lds
v_mfma_f32_16x16x32_bf16 v[96:99], v[208:211], a[84:87], v[96:99]
v_mfma_f32_16x16x32_bf16 v[96:99], v[192:195], a[80:83], v[96:99]
s_nop 0
ds_read_b64_tr_b16 v[144:145], v8 offset:20480
ds_read_b64_tr_b16 v[146:147], v8 offset:22528
v_mfma_f32_16x16x32_bf16 v[100:103], v[196:199], a[80:83], v[100:103]
buffer_load_dwordx4 a[164:167], v1, s[44:47], s69 offen offset:1024 sc1
v_mfma_f32_16x16x32_bf16 v[100:103], v[212:215], a[84:87], v[100:103]
s_nop 0
ds_read_b64_tr_b16 v[148:149], v9 offset:20480
ds_read_b64_tr_b16 v[150:151], v9 offset:22528
v_mfma_f32_16x16x32_bf16 v[100:103], v[228:231], a[88:91], v[100:103]
s_nop 0
ds_read_b64_tr_b16 v[152:153], v10 offset:20480
ds_read_b64_tr_b16 v[154:155], v10 offset:22528
v_mfma_f32_16x16x32_bf16 v[100:103], v[244:247], a[92:95], v[100:103]
s_add_u32 s72, s71, 46080
buffer_load_dwordx4 v15, s[24:27], s72 offen offset:3072 lds
v_mfma_f32_16x16x32_bf16 v[84:87], v[244:247], a[76:79], v[84:87]
s_nop 0
ds_read_b64_tr_b16 v[156:157], v11 offset:20480
ds_read_b64_tr_b16 v[158:159], v11 offset:22528
v_mfma_f32_16x16x32_bf16 v[84:87], v[228:231], a[72:75], v[84:87]
Lstube1:
s_cbranch_execz Lstube5
v_mfma_f32_16x16x32_bf16 v[84:87], v[212:215], a[68:71], v[84:87]
s_nop 0
ds_read_b64_tr_b16 v[160:161], v8 offset:24576
ds_read_b64_tr_b16 v[162:163], v8 offset:26624
v_mfma_f32_16x16x32_bf16 v[84:87], v[196:199], a[64:67], v[84:87]
s_nop 0
ds_read_b64_tr_b16 v[164:165], v9 offset:24576
ds_read_b64_tr_b16 v[166:167], v9 offset:26624
v_mfma_f32_16x16x32_bf16 v[88:91], v[200:203], a[64:67], v[88:91]
s_nop 0
ds_read_b64_tr_b16 v[168:169], v10 offset:24576
ds_read_b64_tr_b16 v[170:171], v10 offset:26624
v_mfma_f32_16x16x32_bf16 v[88:91], v[216:219], a[68:71], v[88:91]
s_nop 0
ds_read_b64_tr_b16 v[172:173], v11 offset:24576
ds_read_b64_tr_b16 v[174:175], v11 offset:26624
v_mfma_f32_16x16x32_bf16 v[88:91], v[232:235], a[72:75], v[88:91]
buffer_load_dwordx4 a[168:171], v1, s[44:47], s69 offen offset:2048 sc1
v_mfma_f32_16x16x32_bf16 v[88:91], v[248:251], a[76:79], v[88:91]
s_xor_b32 s71, s12, 0x40180
v_mfma_f32_16x16x32_bf16 v[104:107], v[248:251], a[92:95], v[104:107]
s_add_u32 m0, s85, 32768
ds_read_b64_tr_b16 v[176:177], v8 offset:28672
ds_read_b64_tr_b16 v[178:179], v8 offset:30720
v_mfma_f32_16x16x32_bf16 v[104:107], v[232:235], a[88:91], v[104:107]
s_add_u32 s72, s71, 0
buffer_load_dwordx4 v15, s[24:27], s72 offen lds
v_mfma_f32_16x16x32_bf16 v[104:107], v[216:219], a[84:87], v[104:107]
s_nop 0
ds_read_b64_tr_b16 v[180:181], v9 offset:28672
ds_read_b64_tr_b16 v[182:183], v9 offset:30720
v_mfma_f32_16x16x32_bf16 v[104:107], v[200:203], a[80:83], v[104:107]
s_nop 0
ds_read_b64_tr_b16 v[184:185], v10 offset:28672
ds_read_b64_tr_b16 v[186:187], v10 offset:30720
v_mfma_f32_16x16x32_bf16 v[108:111], v[204:207], a[80:83], v[108:111]
s_nop 0
ds_read_b64_tr_b16 v[188:189], v11 offset:28672
ds_read_b64_tr_b16 v[190:191], v11 offset:30720
v_mfma_f32_16x16x32_bf16 v[108:111], v[220:223], a[84:87], v[108:111]
v_mfma_f32_16x16x32_bf16 v[108:111], v[236:239], a[88:91], v[108:111]
s_add_u32 s72, s71, 15360
buffer_load_dwordx4 v15, s[24:27], s72 offen offset:1024 lds
v_mfma_f32_16x16x32_bf16 v[108:111], v[252:255], a[92:95], v[108:111]
v_mfma_f32_16x16x32_bf16 v[92:95], v[252:255], a[76:79], v[92:95]
buffer_load_dwordx4 a[172:175], v1, s[44:47], s69 offen offset:3072 sc1
v_mfma_f32_16x16x32_bf16 v[92:95], v[236:239], a[72:75], v[92:95]
v_mfma_f32_16x16x32_bf16 v[92:95], v[220:223], a[68:71], v[92:95]
s_waitcnt vmcnt(31) lgkmcnt(0)
v_mfma_f32_16x16x32_bf16 v[92:95], v[204:207], a[64:67], v[92:95]
v_mfma_f32_16x16x32_bf16 v[16:19], v[128:131], a[96:99], v[16:19]
s_add_u32 s72, s71, 30720
buffer_load_dwordx4 v15, s[24:27], s72 offen offset:2048 lds
v_mfma_f32_16x16x32_bf16 v[16:19], v[144:147], a[100:103], v[16:19]
s_nop 0
ds_read_b64_tr_b16 v[192:193], v8 offset:32768
ds_read_b64_tr_b16 v[194:195], v8 offset:34816
v_mfma_f32_16x16x32_bf16 v[16:19], v[160:163], a[104:107], v[16:19]
s_nop 0
ds_read_b64_tr_b16 v[196:197], v9 offset:32768
ds_read_b64_tr_b16 v[198:199], v9 offset:34816
v_mfma_f32_16x16x32_bf16 v[16:19], v[176:179], a[108:111], v[16:19]
s_nop 0
ds_read_b64_tr_b16 v[200:201], v10 offset:32768
ds_read_b64_tr_b16 v[202:203], v10 offset:34816
v_mfma_f32_16x16x32_bf16 v[32:35], v[176:179], a[124:127], v[32:35]
s_nop 0
ds_read_b64_tr_b16 v[204:205], v11 offset:32768
ds_read_b64_tr_b16 v[206:207], v11 offset:34816
v_mfma_f32_16x16x32_bf16 v[32:35], v[160:163], a[120:123], v[32:35]
v_mfma_f32_16x16x32_bf16 v[32:35], v[144:147], a[116:119], v[32:35]
s_add_u32 s72, s71, 46080
buffer_load_dwordx4 v15, s[24:27], s72 offen offset:3072 lds
v_mfma_f32_16x16x32_bf16 v[32:35], v[128:131], a[112:115], v[32:35]
s_add_u32 s69, s69, 0x20000
buffer_load_dwordx4 a[176:179], v1, s[44:47], s69 offen sc1
v_mfma_f32_16x16x32_bf16 v[36:39], v[132:135], a[112:115], v[36:39]
s_nop 0
ds_read_b64_tr_b16 v[208:209], v8 offset:36864
ds_read_b64_tr_b16 v[210:211], v8 offset:38912
v_mfma_f32_16x16x32_bf16 v[36:39], v[148:151], a[116:119], v[36:39]
s_nop 0
ds_read_b64_tr_b16 v[212:213], v9 offset:36864
ds_read_b64_tr_b16 v[214:215], v9 offset:38912
v_mfma_f32_16x16x32_bf16 v[36:39], v[164:167], a[120:123], v[36:39]
s_nop 0
ds_read_b64_tr_b16 v[216:217], v10 offset:36864
ds_read_b64_tr_b16 v[218:219], v10 offset:38912
v_mfma_f32_16x16x32_bf16 v[36:39], v[180:183], a[124:127], v[36:39]
s_nop 0
ds_read_b64_tr_b16 v[220:221], v11 offset:36864
ds_read_b64_tr_b16 v[222:223], v11 offset:38912
v_mfma_f32_16x16x32_bf16 v[20:23], v[180:183], a[108:111], v[20:23]
v_mfma_f32_16x16x32_bf16 v[20:23], v[164:167], a[104:107], v[20:23]
s_nop 0
ds_read_b64_tr_b16 v[224:225], v8 offset:40960
ds_read_b64_tr_b16 v[226:227], v8 offset:43008
v_mfma_f32_16x16x32_bf16 v[20:23], v[148:151], a[100:103], v[20:23]
s_xor_b32 s71, s13, 0x40080
ds_read_b64_tr_b16 v[228:229], v9 offset:40960
ds_read_b64_tr_b16 v[230:231], v9 offset:43008
v_mfma_f32_16x16x32_bf16 v[20:23], v[132:135], a[96:99], v[20:23]
s_add_u32 m0, s85, 49152
ds_read_b64_tr_b16 v[232:233], v10 offset:40960
ds_read_b64_tr_b16 v[234:235], v10 offset:43008
v_mfma_f32_16x16x32_bf16 v[24:27], v[136:139], a[96:99], v[24:27]
s_add_u32 s72, s71, 0
buffer_load_dwordx4 v15, s[24:27], s72 offen lds
v_mfma_f32_16x16x32_bf16 v[24:27], v[152:155], a[100:103], v[24:27]
buffer_load_dwordx4 a[180:183], v1, s[44:47], s69 offen offset:1024 sc1
v_mfma_f32_16x16x32_bf16 v[24:27], v[168:171], a[104:107], v[24:27]
s_nop 0
ds_read_b64_tr_b16 v[236:237], v11 offset:40960
ds_read_b64_tr_b16 v[238:239], v11 offset:43008
v_mfma_f32_16x16x32_bf16 v[24:27], v[184:187], a[108:111], v[24:27]
v_mfma_f32_16x16x32_bf16 v[40:43], v[184:187], a[124:127], v[40:43]
s_nop 0
ds_read_b64_tr_b16 v[240:241], v8 offset:45056
ds_read_b64_tr_b16 v[242:243], v8 offset:47104
v_mfma_f32_16x16x32_bf16 v[40:43], v[168:171], a[120:123], v[40:43]
s_nop 0
ds_read_b64_tr_b16 v[244:245], v9 offset:45056
ds_read_b64_tr_b16 v[246:247], v9 offset:47104
v_mfma_f32_16x16x32_bf16 v[40:43], v[152:155], a[116:119], v[40:43]
s_add_u32 s72, s71, 15360
buffer_load_dwordx4 v15, s[24:27], s72 offen offset:1024 lds
v_mfma_f32_16x16x32_bf16 v[40:43], v[136:139], a[112:115], v[40:43]
s_nop 0
ds_read_b64_tr_b16 v[248:249], v10 offset:45056
ds_read_b64_tr_b16 v[250:251], v10 offset:47104
v_mfma_f32_16x16x32_bf16 v[44:47], v[140:143], a[112:115], v[44:47]
s_nop 0
ds_read_b64_tr_b16 v[252:253], v11 offset:45056
ds_read_b64_tr_b16 v[254:255], v11 offset:47104
v_mfma_f32_16x16x32_bf16 v[44:47], v[156:159], a[116:119], v[44:47]
v_mfma_f32_16x16x32_bf16 v[44:47], v[172:175], a[120:123], v[44:47]
buffer_load_dwordx4 a[184:187], v1, s[44:47], s69 offen offset:2048 sc1
v_mfma_f32_16x16x32_bf16 v[44:47], v[188:191], a[124:127], v[44:47]
v_mfma_f32_16x16x32_bf16 v[28:31], v[188:191], a[108:111], v[28:31]
s_add_u32 s72, s71, 30720
buffer_load_dwordx4 v15, s[24:27], s72 offen offset:2048 lds
v_mfma_f32_16x16x32_bf16 v[28:31], v[172:175], a[104:107], v[28:31]
v_mfma_f32_16x16x32_bf16 v[28:31], v[156:159], a[100:103], v[28:31]
s_waitcnt vmcnt(20) lgkmcnt(0)
v_mfma_f32_16x16x32_bf16 v[28:31], v[140:143], a[96:99], v[28:31]
s_barrier
v_mfma_f32_16x16x32_bf16 v[48:51], v[192:195], a[96:99], v[48:51]
s_nop 0
ds_read_b64_tr_b16 v[128:129], v8 offset:49152
ds_read_b64_tr_b16 v[130:131], v8 offset:51200
v_mfma_f32_16x16x32_bf16 v[48:51], v[208:211], a[100:103], v[48:51]
s_nop 0
ds_read_b64_tr_b16 v[132:133], v9 offset:49152
ds_read_b64_tr_b16 v[134:135], v9 offset:51200
v_mfma_f32_16x16x32_bf16 v[48:51], v[224:227], a[104:107], v[48:51]
s_add_u32 s72, s71, 46080
buffer_load_dwordx4 v15, s[24:27], s72 offen offset:3072 lds
v_mfma_f32_16x16x32_bf16 v[48:51], v[240:243], a[108:111], v[48:51]
s_nop 0
ds_read_b64_tr_b16 v[136:137], v10 offset:49152
ds_read_b64_tr_b16 v[138:139], v10 offset:51200
v_mfma_f32_16x16x32_bf16 v[64:67], v[240:243], a[124:127], v[64:67]
buffer_load_dwordx4 a[188:191], v1, s[44:47], s69 offen offset:3072 sc1
v_mfma_f32_16x16x32_bf16 v[64:67], v[224:227], a[120:123], v[64:67]
s_nop 0
ds_read_b64_tr_b16 v[140:141], v11 offset:49152
ds_read_b64_tr_b16 v[142:143], v11 offset:51200
v_mfma_f32_16x16x32_bf16 v[64:67], v[208:211], a[116:119], v[64:67]
s_nop 0
ds_read_b64_tr_b16 v[144:145], v8 offset:53248
ds_read_b64_tr_b16 v[146:147], v8 offset:55296
v_mfma_f32_16x16x32_bf16 v[64:67], v[192:195], a[112:115], v[64:67]
s_nop 0
ds_read_b64_tr_b16 v[148:149], v9 offset:53248
ds_read_b64_tr_b16 v[150:151], v9 offset:55296
v_mfma_f32_16x16x32_bf16 v[68:71], v[196:199], a[112:115], v[68:71]
s_lshr_b32 s69, s14, 18
v_mfma_f32_16x16x32_bf16 v[68:71], v[212:215], a[116:119], v[68:71]
s_lshl_b32 s69, s69, 12
ds_read_b64_tr_b16 v[152:153], v10 offset:53248
ds_read_b64_tr_b16 v[154:155], v10 offset:55296
v_mfma_f32_16x16x32_bf16 v[68:71], v[228:231], a[120:123], v[68:71]
s_xor_b32 s71, s14, 0x40080
ds_read_b64_tr_b16 v[156:157], v11 offset:53248
ds_read_b64_tr_b16 v[158:159], v11 offset:55296
v_mfma_f32_16x16x32_bf16 v[68:71], v[244:247], a[124:127], v[68:71]
s_add_u32 m0, s77, 0
ds_read_b64_tr_b16 v[160:161], v8 offset:57344
ds_read_b64_tr_b16 v[162:163], v8 offset:59392
v_mfma_f32_16x16x32_bf16 v[52:55], v[244:247], a[108:111], v[52:55]
s_add_u32 s72, s71, 0
buffer_load_dwordx4 v15, s[24:27], s72 offen lds
v_mfma_f32_16x16x32_bf16 v[52:55], v[228:231], a[104:107], v[52:55]
s_add_u32 s69, s69, s95
ds_read_b64_tr_b16 v[164:165], v9 offset:57344
ds_read_b64_tr_b16 v[166:167], v9 offset:59392
v_mfma_f32_16x16x32_bf16 v[52:55], v[212:215], a[100:103], v[52:55]
s_xor_b32 s69, s69, 0x1000
buffer_load_dwordx4 a[192:195], v1, s[44:47], s69 offen sc1
v_mfma_f32_16x16x32_bf16 v[52:55], v[196:199], a[96:99], v[52:55]
s_nop 0
ds_read_b64_tr_b16 v[168:169], v10 offset:57344
ds_read_b64_tr_b16 v[170:171], v10 offset:59392
v_mfma_f32_16x16x32_bf16 v[56:59], v[200:203], a[96:99], v[56:59]
s_waitcnt vmcnt(19)
v_cmp_gt_u32 vcc, 2, v14
s_cbranch_vccnz Lspin112
Lback113:
v_mfma_f32_16x16x32_bf16 v[56:59], v[216:219], a[100:103], v[56:59]
s_add_u32 s72, s71, 15360
buffer_load_dwordx4 v15, s[24:27], s72 offen offset:1024 lds
v_mfma_f32_16x16x32_bf16 v[56:59], v[232:235], a[104:107], v[56:59]
v_mfma_f32_16x16x32_bf16 v[56:59], v[248:251], a[108:111], v[56:59]
s_nop 0
ds_read_b64_tr_b16 v[172:173], v11 offset:57344
ds_read_b64_tr_b16 v[174:175], v11 offset:59392
v_mfma_f32_16x16x32_bf16 v[72:75], v[248:251], a[124:127], v[72:75]
s_nop 0
ds_read_b64_tr_b16 v[176:177], v8 offset:61440
ds_read_b64_tr_b16 v[178:179], v8 offset:63488
v_mfma_f32_16x16x32_bf16 v[72:75], v[232:235], a[120:123], v[72:75]
s_nop 0
ds_read_b64_tr_b16 v[180:181], v9 offset:61440
ds_read_b64_tr_b16 v[182:183], v9 offset:63488
v_mfma_f32_16x16x32_bf16 v[72:75], v[216:219], a[116:119], v[72:75]
s_nop 0
ds_read_b64_tr_b16 v[184:185], v10 offset:61440
ds_read_b64_tr_b16 v[186:187], v10 offset:63488
v_mfma_f32_16x16x32_bf16 v[72:75], v[200:203], a[112:115], v[72:75]
s_add_u32 s72, s71, 30720
buffer_load_dwordx4 v15, s[24:27], s72 offen offset:2048 lds
v_mfma_f32_16x16x32_bf16 v[76:79], v[204:207], a[112:115], v[76:79]
buffer_load_dwordx4 a[196:199], v1, s[44:47], s69 offen offset:1024 sc1
v_mfma_f32_16x16x32_bf16 v[76:79], v[220:223], a[116:119], v[76:79]
s_nop 0
ds_read_b64_tr_b16 v[188:189], v11 offset:61440
ds_read_b64_tr_b16 v[190:191], v11 offset:63488
v_mfma_f32_16x16x32_bf16 v[76:79], v[236:239], a[120:123], v[76:79]
v_mfma_f32_16x16x32_bf16 v[76:79], v[252:255], a[124:127], v[76:79]
v_mfma_f32_16x16x32_bf16 v[60:63], v[252:255], a[108:111], v[60:63]
v_xor_b32 v8, 0x10000, v8
v_mfma_f32_16x16x32_bf16 v[60:63], v[236:239], a[104:107], v[60:63]
s_add_u32 s72, s71, 46080
buffer_load_dwordx4 v15, s[24:27], s72 offen offset:3072 lds
v_xor_b32 v9, 0x10000, v9
v_mfma_f32_16x16x32_bf16 v[60:63], v[220:223], a[100:103], v[60:63]
s_waitcnt lgkmcnt(0)
v_xor_b32 v10, 0x10000, v10
v_mfma_f32_16x16x32_bf16 v[60:63], v[204:207], a[96:99], v[60:63]
v_xor_b32 v11, 0x10000, v11
v_mfma_f32_16x16x32_bf16 v[80:83], v[128:131], a[96:99], v[80:83]
s_lshl_b32 s84, s76, 11
ds_read_b64_tr_b16 v[192:193], v8 offset:0
ds_read_b64_tr_b16 v[194:195], v8 offset:2048
v_mfma_f32_16x16x32_bf16 v[80:83], v[144:147], a[100:103], v[80:83]
s_add_u32 s84, s84, 0x3810000
ds_read_b64_tr_b16 v[196:197], v9 offset:0
ds_read_b64_tr_b16 v[198:199], v9 offset:2048
v_mfma_f32_16x16x32_bf16 v[80:83], v[160:163], a[104:107], v[80:83]
buffer_load_dwordx4 a[200:203], v1, s[44:47], s69 offen offset:2048 sc1
v_mfma_f32_16x16x32_bf16 v[80:83], v[176:179], a[108:111], v[80:83]
s_nop 0
ds_read_b64_tr_b16 v[200:201], v10 offset:0
ds_read_b64_tr_b16 v[202:203], v10 offset:2048
v_mfma_f32_16x16x32_bf16 v[96:99], v[176:179], a[124:127], v[96:99]
s_nop 0
ds_read_b64_tr_b16 v[204:205], v11 offset:0
ds_read_b64_tr_b16 v[206:207], v11 offset:2048
v_mfma_f32_16x16x32_bf16 v[96:99], v[160:163], a[120:123], v[96:99]
s_xor_b32 s71, s15, 0x40080
v_lshrrev_b32 v115, 2, v0
v_lshlrev_b32 v115, 7, v115
v_mfma_f32_16x16x32_bf16 v[96:99], v[144:147], a[116:119], v[96:99]
s_add_u32 m0, s77, 16384
ds_read_b64_tr_b16 v[208:209], v8 offset:4096
ds_read_b64_tr_b16 v[210:211], v8 offset:6144
v_mfma_f32_16x16x32_bf16 v[96:99], v[128:131], a[112:115], v[96:99]
s_add_u32 s72, s71, 0
buffer_load_dwordx4 v15, s[24:27], s72 offen lds
v_mfma_f32_16x16x32_bf16 v[100:103], v[132:135], a[112:115], v[100:103]
s_nop 0
ds_read_b64_tr_b16 v[212:213], v9 offset:4096
ds_read_b64_tr_b16 v[214:215], v9 offset:6144
v_mfma_f32_16x16x32_bf16 v[100:103], v[148:151], a[116:119], v[100:103]
s_nop 0
ds_read_b64_tr_b16 v[216:217], v10 offset:4096
ds_read_b64_tr_b16 v[218:219], v10 offset:6144
v_mfma_f32_16x16x32_bf16 v[100:103], v[164:167], a[120:123], v[100:103]
s_nop 0
ds_read_b64_tr_b16 v[220:221], v11 offset:4096
ds_read_b64_tr_b16 v[222:223], v11 offset:6144
v_mfma_f32_16x16x32_bf16 v[100:103], v[180:183], a[124:127], v[100:103]
buffer_load_dword v114, v115, s[44:47], s84 offen sc1
v_mfma_f32_16x16x32_bf16 v[84:87], v[180:183], a[108:111], v[84:87]
buffer_load_dwordx4 a[204:207], v1, s[44:47], s69 offen offset:3072 sc1
v_mfma_f32_16x16x32_bf16 v[84:87], v[164:167], a[104:107], v[84:87]
s_add_u32 s72, s71, 15360
buffer_load_dwordx4 v15, s[24:27], s72 offen offset:1024 lds
v_mfma_f32_16x16x32_bf16 v[84:87], v[148:151], a[100:103], v[84:87]
s_nop 0
ds_read_b64_tr_b16 v[224:225], v8 offset:8192
ds_read_b64_tr_b16 v[226:227], v8 offset:10240
v_mfma_f32_16x16x32_bf16 v[84:87], v[132:135], a[96:99], v[84:87]
s_nop 0
ds_read_b64_tr_b16 v[228:229], v9 offset:8192
ds_read_b64_tr_b16 v[230:231], v9 offset:10240
v_mfma_f32_16x16x32_bf16 v[88:91], v[136:139], a[96:99], v[88:91]
s_nop 0
ds_read_b64_tr_b16 v[232:233], v10 offset:8192
ds_read_b64_tr_b16 v[234:235], v10 offset:10240
v_mfma_f32_16x16x32_bf16 v[88:91], v[152:155], a[100:103], v[88:91]
s_nop 0
ds_read_b64_tr_b16 v[236:237], v11 offset:8192
ds_read_b64_tr_b16 v[238:239], v11 offset:10240
v_mfma_f32_16x16x32_bf16 v[88:91], v[168:171], a[104:107], v[88:91]
v_mfma_f32_16x16x32_bf16 v[88:91], v[184:187], a[108:111], v[88:91]
s_add_u32 s72, s71, 30720
buffer_load_dwordx4 v15, s[24:27], s72 offen offset:2048 lds
v_mfma_f32_16x16x32_bf16 v[104:107], v[184:187], a[124:127], v[104:107]
s_nop 0
ds_read_b64_tr_b16 v[240:241], v8 offset:12288
ds_read_b64_tr_b16 v[242:243], v8 offset:14336
v_mfma_f32_16x16x32_bf16 v[104:107], v[168:171], a[120:123], v[104:107]
s_nop 0
ds_read_b64_tr_b16 v[244:245], v9 offset:12288
ds_read_b64_tr_b16 v[246:247], v9 offset:14336
v_mfma_f32_16x16x32_bf16 v[104:107], v[152:155], a[116:119], v[104:107]
s_add_u32 s69, s69, 0x20000
buffer_load_dwordx4 a[208:211], v1, s[44:47], s69 offen sc1
v_mfma_f32_16x16x32_bf16 v[104:107], v[136:139], a[112:115], v[104:107]
s_nop 0
ds_read_b64_tr_b16 v[248:249], v10 offset:12288
ds_read_b64_tr_b16 v[250:251], v10 offset:14336
v_mfma_f32_16x16x32_bf16 v[108:111], v[140:143], a[112:115], v[108:111]
s_nop 0
ds_read_b64_tr_b16 v[252:253], v11 offset:12288
ds_read_b64_tr_b16 v[254:255], v11 offset:14336
v_mfma_f32_16x16x32_bf16 v[108:111], v[156:159], a[116:119], v[108:111]
s_add_u32 s72, s71, 46080
buffer_load_dwordx4 v15, s[24:27], s72 offen offset:3072 lds
v_mfma_f32_16x16x32_bf16 v[108:111], v[172:175], a[120:123], v[108:111]
v_mfma_f32_16x16x32_bf16 v[108:111], v[188:191], a[124:127], v[108:111]
v_mfma_f32_16x16x32_bf16 v[92:95], v[188:191], a[108:111], v[92:95]
v_mfma_f32_16x16x32_bf16 v[92:95], v[172:175], a[104:107], v[92:95]
v_mfma_f32_16x16x32_bf16 v[92:95], v[156:159], a[100:103], v[92:95]
s_waitcnt vmcnt(22) lgkmcnt(0)
v_mfma_f32_16x16x32_bf16 v[92:95], v[140:143], a[96:99], v[92:95]
s_barrier
v_mfma_f32_16x16x32_bf16 v[16:19], v[192:195], a[128:131], v[16:19]
buffer_load_dwordx4 a[212:215], v1, s[44:47], s69 offen offset:1024 sc1
v_mfma_f32_16x16x32_bf16 v[16:19], v[208:211], a[132:135], v[16:19]
s_xor_b32 s71, s13, 0x40100
ds_read_b64_tr_b16 v[128:129], v8 offset:16384
ds_read_b64_tr_b16 v[130:131], v8 offset:18432
v_mfma_f32_16x16x32_bf16 v[16:19], v[224:227], a[136:139], v[16:19]
s_add_u32 m0, s77, 32768
ds_read_b64_tr_b16 v[132:133], v9 offset:16384
ds_read_b64_tr_b16 v[134:135], v9 offset:18432
v_mfma_f32_16x16x32_bf16 v[16:19], v[240:243], a[140:143], v[16:19]
s_add_u32 s72, s71, 0
buffer_load_dwordx4 v15, s[24:27], s72 offen lds
v_mfma_f32_16x16x32_bf16 v[32:35], v[240:243], a[156:159], v[32:35]
s_nop 0
ds_read_b64_tr_b16 v[136:137], v10 offset:16384
ds_read_b64_tr_b16 v[138:139], v10 offset:18432
v_mfma_f32_16x16x32_bf16 v[32:35], v[224:227], a[152:155], v[32:35]
s_nop 0
ds_read_b64_tr_b16 v[140:141], v11 offset:16384
ds_read_b64_tr_b16 v[142:143], v11 offset:18432
v_mfma_f32_16x16x32_bf16 v[32:35], v[208:211], a[148:151], v[32:35]
v_mfma_f32_16x16x32_bf16 v[32:35], v[192:195], a[144:147], v[32:35]
s_nop 0
ds_read_b64_tr_b16 v[144:145], v8 offset:20480
ds_read_b64_tr_b16 v[146:147], v8 offset:22528
v_mfma_f32_16x16x32_bf16 v[36:39], v[196:199], a[144:147], v[36:39]
s_add_u32 s72, s71, 15360
buffer_load_dwordx4 v15, s[24:27], s72 offen offset:1024 lds
v_mfma_f32_16x16x32_bf16 v[36:39], v[212:215], a[148:151], v[36:39]
s_nop 0
ds_read_b64_tr_b16 v[148:149], v9 offset:20480
ds_read_b64_tr_b16 v[150:151], v9 offset:22528
v_mfma_f32_16x16x32_bf16 v[36:39], v[228:231], a[152:155], v[36:39]
buffer_load_dwordx4 a[216:219], v1, s[44:47], s69 offen offset:2048 sc1
v_mfma_f32_16x16x32_bf16 v[36:39], v[244:247], a[156:159], v[36:39]
s_nop 0
ds_read_b64_tr_b16 v[152:153], v10 offset:20480
ds_read_b64_tr_b16 v[154:155], v10 offset:22528
v_mfma_f32_16x16x32_bf16 v[20:23], v[244:247], a[140:143], v[20:23]
s_nop 0
ds_read_b64_tr_b16 v[156:157], v11 offset:20480
ds_read_b64_tr_b16 v[158:159], v11 offset:22528
v_mfma_f32_16x16x32_bf16 v[20:23], v[228:231], a[136:139], v[20:23]
v_mfma_f32_16x16x32_bf16 v[20:23], v[212:215], a[132:135], v[20:23]
s_add_u32 s72, s71, 30720
buffer_load_dwordx4 v15, s[24:27], s72 offen offset:2048 lds
v_mfma_f32_16x16x32_bf16 v[20:23], v[196:199], a[128:131], v[20:23]
s_nop 0
ds_read_b64_tr_b16 v[160:161], v8 offset:24576
ds_read_b64_tr_b16 v[162:163], v8 offset:26624
v_mfma_f32_16x16x32_bf16 v[24:27], v[200:203], a[128:131], v[24:27]
s_nop 0
ds_read_b64_tr_b16 v[164:165], v9 offset:24576
ds_read_b64_tr_b16 v[166:167], v9 offset:26624
v_mfma_f32_16x16x32_bf16 v[24:27], v[216:219], a[132:135], v[24:27]
s_nop 0
ds_read_b64_tr_b16 v[168:169], v10 offset:24576
ds_read_b64_tr_b16 v[170:171], v10 offset:26624
v_mfma_f32_16x16x32_bf16 v[24:27], v[232:235], a[136:139], v[24:27]
s_nop 0
ds_read_b64_tr_b16 v[172:173], v11 offset:24576
ds_read_b64_tr_b16 v[174:175], v11 offset:26624
v_mfma_f32_16x16x32_bf16 v[24:27], v[248:251], a[140:143], v[24:27]
v_mfma_f32_16x16x32_bf16 v[40:43], v[248:251], a[156:159], v[40:43]
s_add_u32 s72, s71, 46080
buffer_load_dwordx4 v15, s[24:27], s72 offen offset:3072 lds
v_mfma_f32_16x16x32_bf16 v[40:43], v[232:235], a[152:155], v[40:43]
buffer_load_dwordx4 a[220:223], v1, s[44:47], s69 offen offset:3072 sc1
v_mfma_f32_16x16x32_bf16 v[40:43], v[216:219], a[148:151], v[40:43]
s_nop 0
ds_read_b64_tr_b16 v[176:177], v8 offset:28672
ds_read_b64_tr_b16 v[178:179], v8 offset:30720
v_mfma_f32_16x16x32_bf16 v[40:43], v[200:203], a[144:147], v[40:43]
s_lshr_b32 s69, s15, 18
ds_read_b64_tr_b16 v[180:181], v9 offset:28672
ds_read_b64_tr_b16 v[182:183], v9 offset:30720
v_mfma_f32_16x16x32_bf16 v[44:47], v[204:207], a[144:147], v[44:47]
s_lshl_b32 s69, s69, 12
ds_read_b64_tr_b16 v[184:185], v10 offset:28672
ds_read_b64_tr_b16 v[186:187], v10 offset:30720
v_mfma_f32_16x16x32_bf16 v[44:47], v[220:223], a[148:151], v[44:47]
s_add_u32 s69, s69, s95
ds_read_b64_tr_b16 v[188:189], v11 offset:28672
ds_read_b64_tr_b16 v[190:191], v11 offset:30720
v_mfma_f32_16x16x32_bf16 v[44:47], v[236:239], a[152:155], v[44:47]
s_xor_b32 s69, s69, 0x1000
v_mfma_f32_16x16x32_bf16 v[44:47], v[252:255], a[156:159], v[44:47]
s_xor_b32 s71, s14, 0x40100
v_mfma_f32_16x16x32_bf16 v[28:31], v[252:255], a[140:143], v[28:31]
s_add_u32 m0, s77, 49152
v_mfma_f32_16x16x32_bf16 v[28:31], v[236:239], a[136:139], v[28:31]
s_add_u32 s72, s71, 0
v_mfma_f32_16x16x32_bf16 v[28:31], v[220:223], a[132:135], v[28:31]
s_waitcnt lgkmcnt(0)
buffer_load_dwordx4 v15, s[24:27], s72 offen lds
v_mfma_f32_16x16x32_bf16 v[28:31], v[204:207], a[128:131], v[28:31]
buffer_load_dwordx4 a[224:227], v1, s[44:47], s69 offen sc1
v_mfma_f32_16x16x32_bf16 v[48:51], v[128:131], a[128:131], v[48:51]
s_nop 0
ds_read_b64_tr_b16 v[192:193], v8 offset:32768
ds_read_b64_tr_b16 v[194:195], v8 offset:34816
v_mfma_f32_16x16x32_bf16 v[48:51], v[144:147], a[132:135], v[48:51]
s_nop 0
ds_read_b64_tr_b16 v[196:197], v9 offset:32768
ds_read_b64_tr_b16 v[198:199], v9 offset:34816
v_mfma_f32_16x16x32_bf16 v[48:51], v[160:163], a[136:139], v[48:51]
s_nop 0
ds_read_b64_tr_b16 v[200:201], v10 offset:32768
ds_read_b64_tr_b16 v[202:203], v10 offset:34816
v_mfma_f32_16x16x32_bf16 v[48:51], v[176:179], a[140:143], v[48:51]
s_add_u32 s72, s71, 15360
buffer_load_dwordx4 v15, s[24:27], s72 offen offset:1024 lds
v_mfma_f32_16x16x32_bf16 v[64:67], v[176:179], a[156:159], v[64:67]
s_nop 0
ds_read_b64_tr_b16 v[204:205], v11 offset:32768
ds_read_b64_tr_b16 v[206:207], v11 offset:34816
v_mfma_f32_16x16x32_bf16 v[64:67], v[160:163], a[152:155], v[64:67]
v_mfma_f32_16x16x32_bf16 v[64:67], v[144:147], a[148:151], v[64:67]
s_nop 0
ds_read_b64_tr_b16 v[208:209], v8 offset:36864
ds_read_b64_tr_b16 v[210:211], v8 offset:38912
v_mfma_f32_16x16x32_bf16 v[64:67], v[128:131], a[144:147], v[64:67]
s_nop 0
ds_read_b64_tr_b16 v[212:213], v9 offset:36864
ds_read_b64_tr_b16 v[214:215], v9 offset:38912
v_mfma_f32_16x16x32_bf16 v[68:71], v[132:135], a[144:147], v[68:71]
buffer_load_dwordx4 a[228:231], v1, s[44:47], s69 offen offset:1024 sc1
v_mfma_f32_16x16x32_bf16 v[68:71], v[148:151], a[148:151], v[68:71]
s_add_u32 s72, s71, 30720
buffer_load_dwordx4 v15, s[24:27], s72 offen offset:2048 lds
v_mfma_f32_16x16x32_bf16 v[68:71], v[164:167], a[152:155], v[68:71]
s_nop 0
ds_read_b64_tr_b16 v[216:217], v10 offset:36864
ds_read_b64_tr_b16 v[218:219], v10 offset:38912
v_mfma_f32_16x16x32_bf16 v[68:71], v[180:183], a[156:159], v[68:71]
v_mfma_f32_16x16x32_bf16 v[52:55], v[180:183], a[140:143], v[52:55]
s_nop 0
ds_read_b64_tr_b16 v[220:221], v11 offset:36864
ds_read_b64_tr_b16 v[222:223], v11 offset:38912
v_mfma_f32_16x16x32_bf16 v[52:55], v[164:167], a[136:139], v[52:55]
s_nop 0
ds_read_b64_tr_b16 v[224:225], v8 offset:40960
ds_read_b64_tr_b16 v[226:227], v8 offset:43008
v_mfma_f32_16x16x32_bf16 v[52:55], v[148:151], a[132:135], v[52:55]
s_nop 0
ds_read_b64_tr_b16 v[228:229], v9 offset:40960
ds_read_b64_tr_b16 v[230:231], v9 offset:43008
v_mfma_f32_16x16x32_bf16 v[52:55], v[132:135], a[128:131], v[52:55]
s_add_u32 s72, s71, 46080
buffer_load_dwordx4 v15, s[24:27], s72 offen offset:3072 lds
v_mfma_f32_16x16x32_bf16 v[56:59], v[136:139], a[128:131], v[56:59]
v_mfma_f32_16x16x32_bf16 v[56:59], v[152:155], a[132:135], v[56:59]
s_nop 0
ds_read_b64_tr_b16 v[232:233], v10 offset:40960
ds_read_b64_tr_b16 v[234:235], v10 offset:43008
v_mfma_f32_16x16x32_bf16 v[56:59], v[168:171], a[136:139], v[56:59]
buffer_load_dwordx4 a[232:235], v1, s[44:47], s69 offen offset:2048 sc1
v_mfma_f32_16x16x32_bf16 v[56:59], v[184:187], a[140:143], v[56:59]
s_nop 0
ds_read_b64_tr_b16 v[236:237], v11 offset:40960
ds_read_b64_tr_b16 v[238:239], v11 offset:43008
v_mfma_f32_16x16x32_bf16 v[72:75], v[184:187], a[156:159], v[72:75]
s_nop 0
ds_read_b64_tr_b16 v[240:241], v8 offset:45056
ds_read_b64_tr_b16 v[242:243], v8 offset:47104
v_mfma_f32_16x16x32_bf16 v[72:75], v[168:171], a[152:155], v[72:75]
v_mfma_f32_16x16x32_bf16 v[72:75], v[152:155], a[148:151], v[72:75]
s_nop 0
ds_read_b64_tr_b16 v[244:245], v9 offset:45056
ds_read_b64_tr_b16 v[246:247], v9 offset:47104
v_mfma_f32_16x16x32_bf16 v[72:75], v[136:139], a[144:147], v[72:75]
s_xor_b32 s71, s15, 0x40100
ds_read_b64_tr_b16 v[248:249], v10 offset:45056
ds_read_b64_tr_b16 v[250:251], v10 offset:47104
v_mfma_f32_16x16x32_bf16 v[76:79], v[140:143], a[144:147], v[76:79]
s_add_u32 m0, s85, 0
ds_read_b64_tr_b16 v[252:253], v11 offset:45056
ds_read_b64_tr_b16 v[254:255], v11 offset:47104
v_mfma_f32_16x16x32_bf16 v[76:79], v[156:159], a[148:151], v[76:79]
s_add_u32 s72, s71, 0
buffer_load_dwordx4 v15, s[24:27], s72 offen lds
v_mfma_f32_16x16x32_bf16 v[76:79], v[172:175], a[152:155], v[76:79]
v_mfma_f32_16x16x32_bf16 v[76:79], v[188:191], a[156:159], v[76:79]
v_mfma_f32_16x16x32_bf16 v[60:63], v[188:191], a[140:143], v[60:63]
buffer_load_dwordx4 a[236:239], v1, s[44:47], s69 offen offset:3072 sc1
v_mfma_f32_16x16x32_bf16 v[60:63], v[172:175], a[136:139], v[60:63]
s_add_u32 s72, s71, 15360
v_mfma_f32_16x16x32_bf16 v[60:63], v[156:159], a[132:135], v[60:63]
s_waitcnt vmcnt(24) lgkmcnt(0)
v_mfma_f32_16x16x32_bf16 v[60:63], v[140:143], a[128:131], v[60:63]
s_barrier
buffer_load_dwordx4 v15, s[24:27], s72 offen offset:1024 lds
v_mfma_f32_16x16x32_bf16 v[80:83], v[192:195], a[128:131], v[80:83]
s_nop 0
ds_read_b64_tr_b16 v[128:129], v8 offset:49152
ds_read_b64_tr_b16 v[130:131], v8 offset:51200
v_mfma_f32_16x16x32_bf16 v[80:83], v[208:211], a[132:135], v[80:83]
s_nop 0
ds_read_b64_tr_b16 v[132:133], v9 offset:49152
ds_read_b64_tr_b16 v[134:135], v9 offset:51200
v_mfma_f32_16x16x32_bf16 v[80:83], v[224:227], a[136:139], v[80:83]
s_nop 0
ds_read_b64_tr_b16 v[136:137], v10 offset:49152
ds_read_b64_tr_b16 v[138:139], v10 offset:51200
s_waitcnt vmcnt(22)
v_cmp_gt_u32 vcc, 3, v114
s_cbranch_vccnz Lspin109
Lback110:
v_mfma_f32_16x16x32_bf16 v[80:83], v[240:243], a[140:143], v[80:83]
s_lshl_b32 s73, s76, 18
ds_read_b64_tr_b16 v[140:141], v11 offset:49152
ds_read_b64_tr_b16 v[142:143], v11 offset:51200
v_mfma_f32_16x16x32_bf16 v[96:99], v[240:243], a[156:159], v[96:99]
s_lshl_b32 s84, s58, 16
v_mfma_f32_16x16x32_bf16 v[96:99], v[224:227], a[152:155], v[96:99]
s_add_u32 s72, s71, 30720
buffer_load_dwordx4 v15, s[24:27], s72 offen offset:2048 lds
v_mfma_f32_16x16x32_bf16 v[96:99], v[208:211], a[148:151], v[96:99]
s_add_u32 s69, s69, 0x20000
Lstube2:
s_cbranch_execz Lrete
buffer_load_dwordx4 a[240:243], v1, s[44:47], s69 offen sc1
v_mfma_f32_16x16x32_bf16 v[96:99], v[192:195], a[144:147], v[96:99]
s_add_u32 s73, s73, s84
ds_read_b64_tr_b16 v[144:145], v8 offset:53248
ds_read_b64_tr_b16 v[146:147], v8 offset:55296
v_mfma_f32_16x16x32_bf16 v[100:103], v[196:199], a[144:147], v[100:103]
s_lshl_b32 s84, s75, 8
ds_read_b64_tr_b16 v[148:149], v9 offset:53248
ds_read_b64_tr_b16 v[150:151], v9 offset:55296
v_mfma_f32_16x16x32_bf16 v[100:103], v[212:215], a[148:151], v[100:103]
s_add_u32 s73, s73, s84
ds_read_b64_tr_b16 v[152:153], v10 offset:53248
ds_read_b64_tr_b16 v[154:155], v10 offset:55296
v_mfma_f32_16x16x32_bf16 v[100:103], v[228:231], a[152:155], v[100:103]
s_add_u32 s73, s73, 0x3400000
v_lshrrev_b32 v112, 4, v0
v_and_b32 v113, 15, v0
v_mfma_f32_16x16x32_bf16 v[100:103], v[244:247], a[156:159], v[100:103]
s_add_u32 s72, s71, 46080
buffer_load_dwordx4 v15, s[24:27], s72 offen offset:3072 lds
v_mfma_f32_16x16x32_bf16 v[84:87], v[244:247], a[140:143], v[84:87]
s_nop 0
ds_read_b64_tr_b16 v[156:157], v11 offset:53248
ds_read_b64_tr_b16 v[158:159], v11 offset:55296
v_mfma_f32_16x16x32_bf16 v[84:87], v[228:231], a[136:139], v[84:87]
s_nop 0
ds_read_b64_tr_b16 v[160:161], v8 offset:57344
ds_read_b64_tr_b16 v[162:163], v8 offset:59392
v_mfma_f32_16x16x32_bf16 v[84:87], v[212:215], a[132:135], v[84:87]
s_nop 0
ds_read_b64_tr_b16 v[164:165], v9 offset:57344
ds_read_b64_tr_b16 v[166:167], v9 offset:59392
v_mfma_f32_16x16x32_bf16 v[84:87], v[196:199], a[128:131], v[84:87]
v_xor_b32 v12, v113, v112
v_lshlrev_b32 v12, 4, v12
v_mfma_f32_16x16x32_bf16 v[88:91], v[200:203], a[128:131], v[88:91]
buffer_load_dwordx4 a[244:247], v1, s[44:47], s69 offen offset:1024 sc1
v_mfma_f32_16x16x32_bf16 v[88:91], v[216:219], a[132:135], v[88:91]
s_nop 0
ds_read_b64_tr_b16 v[168:169], v10 offset:57344
ds_read_b64_tr_b16 v[170:171], v10 offset:59392
v_mfma_f32_16x16x32_bf16 v[88:91], v[232:235], a[136:139], v[88:91]
s_nop 0
ds_read_b64_tr_b16 v[172:173], v11 offset:57344
ds_read_b64_tr_b16 v[174:175], v11 offset:59392
v_mfma_f32_16x16x32_bf16 v[88:91], v[248:251], a[140:143], v[88:91]
s_xor_b32 s71, s13, 0x40180
ds_read_b64_tr_b16 v[176:177], v8 offset:61440
ds_read_b64_tr_b16 v[178:179], v8 offset:63488
v_mfma_f32_16x16x32_bf16 v[104:107], v[248:251], a[156:159], v[104:107]
s_add_u32 m0, s85, 16384
v_lshl_add_u32 v112, v112, 12, v12
v_xor_b32 v12, 64, v112
v_mfma_f32_16x16x32_bf16 v[104:107], v[232:235], a[152:155], v[104:107]
s_add_u32 s72, s71, 0
buffer_load_dwordx4 v15, s[24:27], s72 offen lds
v_mfma_f32_16x16x32_bf16 v[104:107], v[216:219], a[148:151], v[104:107]
s_nop 0
ds_read_b64_tr_b16 v[180:181], v9 offset:61440
ds_read_b64_tr_b16 v[182:183], v9 offset:63488
v_mfma_f32_16x16x32_bf16 v[104:107], v[200:203], a[144:147], v[104:107]
s_nop 0
ds_read_b64_tr_b16 v[184:185], v10 offset:61440
ds_read_b64_tr_b16 v[186:187], v10 offset:63488
v_mfma_f32_16x16x32_bf16 v[108:111], v[204:207], a[144:147], v[108:111]
s_nop 0
ds_read_b64_tr_b16 v[188:189], v11 offset:61440
ds_read_b64_tr_b16 v[190:191], v11 offset:63488
v_mfma_f32_16x16x32_bf16 v[108:111], v[220:223], a[148:151], v[108:111]
v_lshlrev_b32 v113, 2, v113
v_mfma_f32_16x16x32_bf16 v[108:111], v[236:239], a[152:155], v[108:111]
s_add_u32 s72, s71, 15360
buffer_load_dwordx4 v15, s[24:27], s72 offen offset:1024 lds
v_mfma_f32_16x16x32_bf16 v[108:111], v[252:255], a[156:159], v[108:111]
buffer_load_dwordx4 a[248:251], v1, s[44:47], s69 offen offset:2048 sc1
v_mfma_f32_16x16x32_bf16 v[92:95], v[252:255], a[140:143], v[92:95]
v_xor_b32 v8, 0x10000, v8
v_mfma_f32_16x16x32_bf16 v[92:95], v[236:239], a[136:139], v[92:95]
v_xor_b32 v9, 0x10000, v9
v_mfma_f32_16x16x32_bf16 v[92:95], v[220:223], a[132:135], v[92:95]
s_waitcnt vmcnt(38) lgkmcnt(0)
v_xor_b32 v10, 0x10000, v10
v_mfma_f32_16x16x32_bf16 v[92:95], v[204:207], a[128:131], v[92:95]
v_xor_b32 v11, 0x10000, v11
v_mfma_f32_16x16x32_bf16 v[16:19], v[128:131], a[160:163], v[16:19]
s_add_u32 s72, s71, 30720
buffer_load_dwordx4 v15, s[24:27], s72 offen offset:2048 lds
v_mfma_f32_16x16x32_bf16 v[16:19], v[144:147], a[164:167], v[16:19]
s_nop 0
ds_read_b64_tr_b16 v[192:193], v8 offset:0
ds_read_b64_tr_b16 v[194:195], v8 offset:2048
v_mfma_f32_16x16x32_bf16 v[16:19], v[160:163], a[168:171], v[16:19]
s_nop 0
ds_read_b64_tr_b16 v[196:197], v9 offset:0
ds_read_b64_tr_b16 v[198:199], v9 offset:2048
v_mfma_f32_16x16x32_bf16 v[16:19], v[176:179], a[172:175], v[16:19]
s_nop 0
ds_read_b64_tr_b16 v[200:201], v10 offset:0
ds_read_b64_tr_b16 v[202:203], v10 offset:2048
v_mfma_f32_16x16x32_bf16 v[32:35], v[176:179], a[188:191], v[32:35]
buffer_load_dwordx4 a[252:255], v1, s[44:47], s69 offen offset:3072 sc1
v_mfma_f32_16x16x32_bf16 v[32:35], v[160:163], a[184:187], v[32:35]
v_mfma_f32_16x16x32_bf16 v[32:35], v[144:147], a[180:183], v[32:35]
s_add_u32 s72, s71, 46080
buffer_load_dwordx4 v15, s[24:27], s72 offen offset:3072 lds
v_mfma_f32_16x16x32_bf16 v[32:35], v[128:131], a[176:179], v[32:35]
s_nop 0
ds_read_b64_tr_b16 v[204:205], v11 offset:0
ds_read_b64_tr_b16 v[206:207], v11 offset:2048
v_mfma_f32_16x16x32_bf16 v[36:39], v[132:135], a[176:179], v[36:39]
s_nop 0
ds_read_b64_tr_b16 v[208:209], v8 offset:4096
ds_read_b64_tr_b16 v[210:211], v8 offset:6144
v_mfma_f32_16x16x32_bf16 v[36:39], v[148:151], a[180:183], v[36:39]
s_nop 0
ds_read_b64_tr_b16 v[212:213], v9 offset:4096
ds_read_b64_tr_b16 v[214:215], v9 offset:6144
v_mfma_f32_16x16x32_bf16 v[36:39], v[164:167], a[184:187], v[36:39]
v_mfma_f32_16x16x32_bf16 v[36:39], v[180:183], a[188:191], v[36:39]
s_nop 0
ds_read_b64_tr_b16 v[216:217], v10 offset:4096
ds_read_b64_tr_b16 v[218:219], v10 offset:6144
v_mfma_f32_16x16x32_bf16 v[20:23], v[180:183], a[172:175], v[20:23]
s_nop 0
ds_read_b64_tr_b16 v[220:221], v11 offset:4096
ds_read_b64_tr_b16 v[222:223], v11 offset:6144
v_mfma_f32_16x16x32_bf16 v[20:23], v[164:167], a[168:171], v[20:23]
v_mfma_f32_16x16x32_bf16 v[20:23], v[148:151], a[164:167], v[20:23]
s_xor_b32 s71, s14, 0x40180
ds_read_b64_tr_b16 v[224:225], v8 offset:8192
ds_read_b64_tr_b16 v[226:227], v8 offset:10240
v_mfma_f32_16x16x32_bf16 v[20:23], v[132:135], a[160:163], v[20:23]
s_add_u32 m0, s85, 32768
ds_read_b64_tr_b16 v[228:229], v9 offset:8192
ds_read_b64_tr_b16 v[230:231], v9 offset:10240
v_mfma_f32_16x16x32_bf16 v[24:27], v[136:139], a[160:163], v[24:27]
s_add_u32 s72, s71, 0
buffer_load_dwordx4 v15, s[24:27], s72 offen lds
v_mfma_f32_16x16x32_bf16 v[24:27], v[152:155], a[164:167], v[24:27]
s_nop 0
ds_read_b64_tr_b16 v[232:233], v10 offset:8192
ds_read_b64_tr_b16 v[234:235], v10 offset:10240
v_mfma_f32_16x16x32_bf16 v[24:27], v[168:171], a[168:171], v[24:27]
v_mfma_f32_16x16x32_bf16 v[24:27], v[184:187], a[172:175], v[24:27]
s_nop 0
ds_read_b64_tr_b16 v[236:237], v11 offset:8192
ds_read_b64_tr_b16 v[238:239], v11 offset:10240
v_mfma_f32_16x16x32_bf16 v[40:43], v[184:187], a[188:191], v[40:43]
s_nop 0
ds_read_b64_tr_b16 v[240:241], v8 offset:12288
ds_read_b64_tr_b16 v[242:243], v8 offset:14336
v_mfma_f32_16x16x32_bf16 v[40:43], v[168:171], a[184:187], v[40:43]
s_nop 0
ds_read_b64_tr_b16 v[244:245], v9 offset:12288
ds_read_b64_tr_b16 v[246:247], v9 offset:14336
v_mfma_f32_16x16x32_bf16 v[40:43], v[152:155], a[180:183], v[40:43]
s_add_u32 s72, s71, 15360
buffer_load_dwordx4 v15, s[24:27], s72 offen offset:1024 lds
v_mfma_f32_16x16x32_bf16 v[40:43], v[136:139], a[176:179], v[40:43]
v_mfma_f32_16x16x32_bf16 v[44:47], v[140:143], a[176:179], v[44:47]
s_nop 0
ds_read_b64_tr_b16 v[248:249], v10 offset:12288
ds_read_b64_tr_b16 v[250:251], v10 offset:14336
v_mfma_f32_16x16x32_bf16 v[44:47], v[156:159], a[180:183], v[44:47]
s_nop 0
ds_read_b64_tr_b16 v[252:253], v11 offset:12288
ds_read_b64_tr_b16 v[254:255], v11 offset:14336
v_mfma_f32_16x16x32_bf16 v[44:47], v[172:175], a[184:187], v[44:47]
v_mfma_f32_16x16x32_bf16 v[44:47], v[188:191], a[188:191], v[44:47]
v_mfma_f32_16x16x32_bf16 v[28:31], v[188:191], a[172:175], v[28:31]
s_add_u32 s72, s71, 30720
buffer_load_dwordx4 v15, s[24:27], s72 offen offset:2048 lds
v_mfma_f32_16x16x32_bf16 v[28:31], v[172:175], a[168:171], v[28:31]
v_mfma_f32_16x16x32_bf16 v[28:31], v[156:159], a[164:167], v[28:31]
s_waitcnt vmcnt(23) lgkmcnt(0)
v_mfma_f32_16x16x32_bf16 v[28:31], v[140:143], a[160:163], v[28:31]
s_barrier
v_mfma_f32_16x16x32_bf16 v[16:19], v[192:195], a[192:195], v[16:19]
s_nop 0
ds_read_b64_tr_b16 v[128:129], v8 offset:16384
ds_read_b64_tr_b16 v[130:131], v8 offset:18432
v_mfma_f32_16x16x32_bf16 v[16:19], v[208:211], a[196:199], v[16:19]
s_nop 0
ds_read_b64_tr_b16 v[132:133], v9 offset:16384
ds_read_b64_tr_b16 v[134:135], v9 offset:18432
v_mfma_f32_16x16x32_bf16 v[16:19], v[224:227], a[200:203], v[16:19]
s_add_u32 s72, s71, 46080
buffer_load_dwordx4 v15, s[24:27], s72 offen offset:3072 lds
v_mfma_f32_16x16x32_bf16 v[16:19], v[240:243], a[204:207], v[16:19]
s_nop 0
ds_read_b64_tr_b16 v[136:137], v10 offset:16384
ds_read_b64_tr_b16 v[138:139], v10 offset:18432
v_mfma_f32_16x16x32_bf16 v[32:35], v[240:243], a[220:223], v[32:35]
s_nop 0
ds_read_b64_tr_b16 v[140:141], v11 offset:16384
ds_read_b64_tr_b16 v[142:143], v11 offset:18432
v_mfma_f32_16x16x32_bf16 v[32:35], v[224:227], a[216:219], v[32:35]
v_mfma_f32_16x16x32_bf16 v[32:35], v[208:211], a[212:215], v[32:35]
s_nop 0
ds_read_b64_tr_b16 v[144:145], v8 offset:20480
ds_read_b64_tr_b16 v[146:147], v8 offset:22528
v_mfma_f32_16x16x32_bf16 v[32:35], v[192:195], a[208:211], v[32:35]
s_nop 0
ds_read_b64_tr_b16 v[148:149], v9 offset:20480
ds_read_b64_tr_b16 v[150:151], v9 offset:22528
v_mfma_f32_16x16x32_bf16 v[36:39], v[196:199], a[208:211], v[36:39]
s_nop 0
ds_read_b64_tr_b16 v[152:153], v10 offset:20480
ds_read_b64_tr_b16 v[154:155], v10 offset:22528
v_mfma_f32_16x16x32_bf16 v[36:39], v[212:215], a[212:215], v[36:39]
s_nop 0
ds_read_b64_tr_b16 v[156:157], v11 offset:20480
ds_read_b64_tr_b16 v[158:159], v11 offset:22528
v_mfma_f32_16x16x32_bf16 v[36:39], v[228:231], a[216:219], v[36:39]
v_mfma_f32_16x16x32_bf16 v[36:39], v[244:247], a[220:223], v[36:39]
s_add_u32 m0, s64, 147456
ds_read_b64_tr_b16 v[160:161], v8 offset:24576
ds_read_b64_tr_b16 v[162:163], v8 offset:26624
v_mfma_f32_16x16x32_bf16 v[20:23], v[244:247], a[204:207], v[20:23]
s_add_u32 s72, s73, 0
buffer_load_dwordx4 v112, s[44:47], s72 offen sc1 lds
v_mfma_f32_16x16x32_bf16 v[20:23], v[228:231], a[200:203], v[20:23]
s_nop 0
ds_read_b64_tr_b16 v[164:165], v9 offset:24576
ds_read_b64_tr_b16 v[166:167], v9 offset:26624
v_mfma_f32_16x16x32_bf16 v[20:23], v[212:215], a[196:199], v[20:23]
s_add_u32 s72, s73, 15360
buffer_load_dwordx4 v12, s[44:47], s72 offen offset:1024 sc1 lds
v_mfma_f32_16x16x32_bf16 v[20:23], v[196:199], a[192:195], v[20:23]
s_nop 0
ds_read_b64_tr_b16 v[168:169], v10 offset:24576
ds_read_b64_tr_b16 v[170:171], v10 offset:26624
v_mfma_f32_16x16x32_bf16 v[24:27], v[200:203], a[192:195], v[24:27]
s_nop 0
ds_read_b64_tr_b16 v[172:173], v11 offset:24576
ds_read_b64_tr_b16 v[174:175], v11 offset:26624
v_mfma_f32_16x16x32_bf16 v[24:27], v[216:219], a[196:199], v[24:27]
s_add_u32 s72, s73, 30720
buffer_load_dwordx4 v112, s[44:47], s72 offen offset:2048 sc1 lds
v_mfma_f32_16x16x32_bf16 v[24:27], v[232:235], a[200:203], v[24:27]
v_mfma_f32_16x16x32_bf16 v[24:27], v[248:251], a[204:207], v[24:27]
s_nop 0
ds_read_b64_tr_b16 v[176:177], v8 offset:28672
ds_read_b64_tr_b16 v[178:179], v8 offset:30720
v_mfma_f32_16x16x32_bf16 v[40:43], v[248:251], a[220:223], v[40:43]
s_add_u32 s72, s73, 46080
buffer_load_dwordx4 v12, s[44:47], s72 offen offset:3072 sc1 lds
v_mfma_f32_16x16x32_bf16 v[40:43], v[232:235], a[216:219], v[40:43]
s_xor_b32 s71, s15, 0x40180
ds_read_b64_tr_b16 v[180:181], v9 offset:28672
ds_read_b64_tr_b16 v[182:183], v9 offset:30720
v_mfma_f32_16x16x32_bf16 v[40:43], v[216:219], a[212:215], v[40:43]
s_add_u32 m0, s85, 49152
ds_read_b64_tr_b16 v[184:185], v10 offset:28672
ds_read_b64_tr_b16 v[186:187], v10 offset:30720
v_mfma_f32_16x16x32_bf16 v[40:43], v[200:203], a[208:211], v[40:43]
s_add_u32 s72, s71, 0
buffer_load_dwordx4 v15, s[24:27], s72 offen lds
v_mfma_f32_16x16x32_bf16 v[44:47], v[204:207], a[208:211], v[44:47]
s_nop 0
ds_read_b64_tr_b16 v[188:189], v11 offset:28672
ds_read_b64_tr_b16 v[190:191], v11 offset:30720
v_mfma_f32_16x16x32_bf16 v[44:47], v[220:223], a[212:215], v[44:47]
v_mfma_f32_16x16x32_bf16 v[44:47], v[236:239], a[216:219], v[44:47]
s_add_u32 s72, s71, 15360
buffer_load_dwordx4 v15, s[24:27], s72 offen offset:1024 lds
v_mfma_f32_16x16x32_bf16 v[44:47], v[252:255], a[220:223], v[44:47]
v_mfma_f32_16x16x32_bf16 v[28:31], v[252:255], a[204:207], v[28:31]
v_mfma_f32_16x16x32_bf16 v[28:31], v[236:239], a[200:203], v[28:31]
s_add_u32 s72, s71, 30720
buffer_load_dwordx4 v15, s[24:27], s72 offen offset:2048 lds
v_mfma_f32_16x16x32_bf16 v[28:31], v[220:223], a[196:199], v[28:31]
s_waitcnt vmcnt(12) lgkmcnt(0)
v_mfma_f32_16x16x32_bf16 v[28:31], v[204:207], a[192:195], v[28:31]
v_mfma_f32_16x16x32_bf16 v[16:19], v[128:131], a[224:227], v[16:19]
s_add_u32 s72, s71, 46080
buffer_load_dwordx4 v15, s[24:27], s72 offen offset:3072 lds
v_mfma_f32_16x16x32_bf16 v[16:19], v[144:147], a[228:231], v[16:19]
s_lshl_b32 s73, s75, 9
ds_read_b64_tr_b16 v[192:193], v8 offset:32768
ds_read_b64_tr_b16 v[194:195], v8 offset:34816
v_mfma_f32_16x16x32_bf16 v[16:19], v[160:163], a[232:235], v[16:19]
s_lshl_b32 s84, s58, 7
ds_read_b64_tr_b16 v[196:197], v9 offset:32768
ds_read_b64_tr_b16 v[198:199], v9 offset:34816
v_mfma_f32_16x16x32_bf16 v[16:19], v[176:179], a[236:239], v[16:19]
s_add_u32 s73, s73, s84
ds_read_b64_tr_b16 v[200:201], v10 offset:32768
ds_read_b64_tr_b16 v[202:203], v10 offset:34816
v_mfma_f32_16x16x32_bf16 v[20:23], v[180:183], a[236:239], v[20:23]
s_add_u32 s73, s73, 0x3800000
ds_read_b64_tr_b16 v[204:205], v11 offset:32768
ds_read_b64_tr_b16 v[206:207], v11 offset:34816
v_mfma_f32_16x16x32_bf16 v[20:23], v[164:167], a[232:235], v[20:23]
s_xor_b32 s71, s12, 0x0
buffer_load_dword v6, v113, s[44:47], s73 offen sc1
v_mfma_f32_16x16x32_bf16 v[20:23], v[148:151], a[228:231], v[20:23]
s_add_u32 m0, s77, 0
ds_read_b64_tr_b16 v[208:209], v8 offset:36864
ds_read_b64_tr_b16 v[210:211], v8 offset:38912
v_mfma_f32_16x16x32_bf16 v[20:23], v[132:135], a[224:227], v[20:23]
s_add_u32 s72, s71, 0
buffer_load_dwordx4 v15, s[24:27], s72 offen lds
v_mfma_f32_16x16x32_bf16 v[24:27], v[136:139], a[224:227], v[24:27]
s_nop 0
ds_read_b64_tr_b16 v[212:213], v9 offset:36864
ds_read_b64_tr_b16 v[214:215], v9 offset:38912
v_mfma_f32_16x16x32_bf16 v[24:27], v[152:155], a[228:231], v[24:27]
s_nop 0
ds_read_b64_tr_b16 v[216:217], v10 offset:36864
ds_read_b64_tr_b16 v[218:219], v10 offset:38912
v_mfma_f32_16x16x32_bf16 v[24:27], v[168:171], a[232:235], v[24:27]
buffer_load_dword v7, v113, s[44:47], s73 offen offset:64 sc1
v_mfma_f32_16x16x32_bf16 v[24:27], v[184:187], a[236:239], v[24:27]
s_nop 0
ds_read_b64_tr_b16 v[220:221], v11 offset:36864
ds_read_b64_tr_b16 v[222:223], v11 offset:38912
v_cvt_pk_bf16_f32 v16, v16, v17
v_mfma_f32_16x16x32_bf16 v[28:31], v[188:191], a[236:239], v[28:31]
s_nop 0
ds_read_b64_tr_b16 v[224:225], v8 offset:40960
ds_read_b64_tr_b16 v[226:227], v8 offset:43008
v_cvt_pk_bf16_f32 v17, v18, v19
v_mfma_f32_16x16x32_bf16 v[28:31], v[172:175], a[232:235], v[28:31]
s_add_u32 s72, s71, 15360
buffer_load_dwordx4 v15, s[24:27], s72 offen offset:1024 lds
v_cvt_pk_bf16_f32 v18, v20, v21
v_mfma_f32_16x16x32_bf16 v[28:31], v[156:159], a[228:231], v[28:31]
s_nop 0
ds_read_b64_tr_b16 v[228:229], v9 offset:40960
ds_read_b64_tr_b16 v[230:231], v9 offset:43008
v_cvt_pk_bf16_f32 v19, v22, v23
v_mfma_f32_16x16x32_bf16 v[28:31], v[140:143], a[224:227], v[28:31]
v_mfma_f32_16x16x32_bf16 v[32:35], v[128:131], a[240:243], v[32:35]
s_xor_b32 s80, s93, 0x80000
ds_read_b64_tr_b16 v[232:233], v10 offset:40960
ds_read_b64_tr_b16 v[234:235], v10 offset:43008
v_mfma_f32_16x16x32_bf16 v[32:35], v[144:147], a[244:247], v[32:35]
s_add_u32 s80, s80, 0x3a00000
buffer_store_dwordx4 v[16:19], v1, s[44:47], s80 offen sc1
v_mfma_f32_16x16x32_bf16 v[32:35], v[160:163], a[248:251], v[32:35]
s_nop 0
ds_read_b64_tr_b16 v[236:237], v11 offset:40960
ds_read_b64_tr_b16 v[238:239], v11 offset:43008
v_mfma_f32_16x16x32_bf16 v[32:35], v[176:179], a[252:255], v[32:35]
s_add_u32 s72, s71, 30720
buffer_load_dwordx4 v15, s[24:27], s72 offen offset:2048 lds
v_cvt_pk_bf16_f32 v20, v24, v25
v_mfma_f32_16x16x32_bf16 v[36:39], v[180:183], a[252:255], v[36:39]
s_nop 0
ds_read_b64_tr_b16 v[240:241], v8 offset:45056
ds_read_b64_tr_b16 v[242:243], v8 offset:47104
v_cvt_pk_bf16_f32 v21, v26, v27
v_mfma_f32_16x16x32_bf16 v[36:39], v[164:167], a[248:251], v[36:39]
v_cvt_pk_bf16_f32 v22, v28, v29
v_cvt_pk_bf16_f32 v23, v30, v31
v_mfma_f32_16x16x32_bf16 v[36:39], v[148:151], a[244:247], v[36:39]
s_nop 0
ds_read_b64_tr_b16 v[244:245], v9 offset:45056
ds_read_b64_tr_b16 v[246:247], v9 offset:47104
v_mfma_f32_16x16x32_bf16 v[36:39], v[132:135], a[240:243], v[36:39]
s_nop 0
ds_read_b64_tr_b16 v[248:249], v10 offset:45056
ds_read_b64_tr_b16 v[250:251], v10 offset:47104
v_mfma_f32_16x16x32_bf16 v[40:43], v[136:139], a[240:243], v[40:43]
s_nop 0
ds_read_b64_tr_b16 v[252:253], v11 offset:45056
ds_read_b64_tr_b16 v[254:255], v11 offset:47104
v_mfma_f32_16x16x32_bf16 v[40:43], v[152:155], a[244:247], v[40:43]
s_add_u32 s72, s71, 46080
buffer_load_dwordx4 v15, s[24:27], s72 offen offset:3072 lds
v_mfma_f32_16x16x32_bf16 v[40:43], v[168:171], a[248:251], v[40:43]
v_mfma_f32_16x16x32_bf16 v[40:43], v[184:187], a[252:255], v[40:43]
v_cvt_pk_bf16_f32 v24, v32, v33
v_cvt_pk_bf16_f32 v25, v34, v35
v_cvt_pk_bf16_f32 v26, v36, v37
v_mfma_f32_16x16x32_bf16 v[44:47], v[188:191], a[252:255], v[44:47]
v_cvt_pk_bf16_f32 v27, v38, v39
v_mfma_f32_16x16x32_bf16 v[44:47], v[172:175], a[248:251], v[44:47]
v_mfma_f32_16x16x32_bf16 v[44:47], v[156:159], a[244:247], v[44:47]
s_waitcnt vmcnt(26) lgkmcnt(0)
v_mfma_f32_16x16x32_bf16 v[44:47], v[140:143], a[240:243], v[44:47]
s_barrier
v_mfma_f32_16x16x32_bf16 v[48:51], v[192:195], a[160:163], v[48:51]
s_nop 0
ds_read_b64_tr_b16 v[128:129], v8 offset:49152
ds_read_b64_tr_b16 v[130:131], v8 offset:51200
v_mfma_f32_16x16x32_bf16 v[48:51], v[208:211], a[164:167], v[48:51]
s_xor_b32 s71, s13, 0x0
buffer_store_dwordx4 v[20:23], v1, s[44:47], s80 offen offset:1024 sc1
v_mfma_f32_16x16x32_bf16 v[48:51], v[224:227], a[168:171], v[48:51]
s_add_u32 m0, s77, 16384
ds_read_b64_tr_b16 v[132:133], v9 offset:49152
ds_read_b64_tr_b16 v[134:135], v9 offset:51200
v_mfma_f32_16x16x32_bf16 v[48:51], v[240:243], a[172:175], v[48:51]
s_add_u32 s72, s71, 0
buffer_load_dwordx4 v15, s[24:27], s72 offen lds
v_cvt_pk_bf16_f32 v28, v40, v41
v_mfma_f32_16x16x32_bf16 v[64:67], v[240:243], a[188:191], v[64:67]
s_nop 0
ds_read_b64_tr_b16 v[136:137], v10 offset:49152
ds_read_b64_tr_b16 v[138:139], v10 offset:51200
v_cvt_pk_bf16_f32 v29, v42, v43
v_mfma_f32_16x16x32_bf16 v[64:67], v[224:227], a[184:187], v[64:67]
s_nop 0
ds_read_b64_tr_b16 v[140:141], v11 offset:49152
ds_read_b64_tr_b16 v[142:143], v11 offset:51200
v_cvt_pk_bf16_f32 v30, v44, v45
v_mfma_f32_16x16x32_bf16 v[64:67], v[208:211], a[180:183], v[64:67]
v_cvt_pk_bf16_f32 v31, v46, v47
v_mfma_f32_16x16x32_bf16 v[64:67], v[192:195], a[176:179], v[64:67]
s_nop 0
ds_read_b64_tr_b16 v[144:145], v8 offset:53248
ds_read_b64_tr_b16 v[146:147], v8 offset:55296
v_mfma_f32_16x16x32_bf16 v[68:71], v[196:199], a[176:179], v[68:71]
s_add_u32 s72, s71, 15360
buffer_load_dwordx4 v15, s[24:27], s72 offen offset:1024 lds
v_mfma_f32_16x16x32_bf16 v[68:71], v[212:215], a[180:183], v[68:71]
s_nop 0
ds_read_b64_tr_b16 v[148:149], v9 offset:53248
ds_read_b64_tr_b16 v[150:151], v9 offset:55296
v_mfma_f32_16x16x32_bf16 v[68:71], v[228:231], a[184:187], v[68:71]
s_nop 0
ds_read_b64_tr_b16 v[152:153], v10 offset:53248
ds_read_b64_tr_b16 v[154:155], v10 offset:55296
v_mfma_f32_16x16x32_bf16 v[68:71], v[244:247], a[188:191], v[68:71]
v_mfma_f32_16x16x32_bf16 v[52:55], v[244:247], a[172:175], v[52:55]
s_nop 0
ds_read_b64_tr_b16 v[156:157], v11 offset:53248
ds_read_b64_tr_b16 v[158:159], v11 offset:55296
v_mfma_f32_16x16x32_bf16 v[52:55], v[228:231], a[168:171], v[52:55]
s_nop 0
ds_read_b64_tr_b16 v[160:161], v8 offset:57344
ds_read_b64_tr_b16 v[162:163], v8 offset:59392
v_mfma_f32_16x16x32_bf16 v[52:55], v[212:215], a[164:167], v[52:55]
s_add_u32 s72, s71, 30720
buffer_load_dwordx4 v15, s[24:27], s72 offen offset:2048 lds
v_mfma_f32_16x16x32_bf16 v[52:55], v[196:199], a[160:163], v[52:55]
s_nop 0
ds_read_b64_tr_b16 v[164:165], v9 offset:57344
ds_read_b64_tr_b16 v[166:167], v9 offset:59392
v_mfma_f32_16x16x32_bf16 v[56:59], v[200:203], a[160:163], v[56:59]
v_mfma_f32_16x16x32_bf16 v[56:59], v[216:219], a[164:167], v[56:59]
buffer_store_dwordx4 v[24:27], v1, s[44:47], s80 offen offset:2048 sc1
v_mfma_f32_16x16x32_bf16 v[56:59], v[232:235], a[168:171], v[56:59]
s_nop 0
ds_read_b64_tr_b16 v[168:169], v10 offset:57344
ds_read_b64_tr_b16 v[170:171], v10 offset:59392
v_mfma_f32_16x16x32_bf16 v[56:59], v[248:251], a[172:175], v[56:59]
s_nop 0
ds_read_b64_tr_b16 v[172:173], v11 offset:57344
ds_read_b64_tr_b16 v[174:175], v11 offset:59392
v_mfma_f32_16x16x32_bf16 v[72:75], v[248:251], a[188:191], v[72:75]
s_add_u32 s72, s71, 46080
buffer_load_dwordx4 v15, s[24:27], s72 offen offset:3072 lds
v_mfma_f32_16x16x32_bf16 v[72:75], v[232:235], a[184:187], v[72:75]
s_nop 0
ds_read_b64_tr_b16 v[176:177], v8 offset:61440
ds_read_b64_tr_b16 v[178:179], v8 offset:63488
v_mfma_f32_16x16x32_bf16 v[72:75], v[216:219], a[180:183], v[72:75]
v_mfma_f32_16x16x32_bf16 v[72:75], v[200:203], a[176:179], v[72:75]
s_nop 0
ds_read_b64_tr_b16 v[180:181], v9 offset:61440
ds_read_b64_tr_b16 v[182:183], v9 offset:63488
v_mfma_f32_16x16x32_bf16 v[76:79], v[204:207], a[176:179], v[76:79]
s_nop 0
ds_read_b64_tr_b16 v[184:185], v10 offset:61440
ds_read_b64_tr_b16 v[186:187], v10 offset:63488
v_mfma_f32_16x16x32_bf16 v[76:79], v[220:223], a[180:183], v[76:79]
s_nop 0
ds_read_b64_tr_b16 v[188:189], v11 offset:61440
ds_read_b64_tr_b16 v[190:191], v11 offset:63488
v_mfma_f32_16x16x32_bf16 v[76:79], v[236:239], a[184:187], v[76:79]
v_mfma_f32_16x16x32_bf16 v[76:79], v[252:255], a[188:191], v[76:79]
s_xor_b32 s71, s14, 0x0
v_mfma_f32_16x16x32_bf16 v[60:63], v[252:255], a[172:175], v[60:63]
s_add_u32 m0, s77, 32768
v_xor_b32 v8, 0x10000, v8
v_mfma_f32_16x16x32_bf16 v[60:63], v[236:239], a[168:171], v[60:63]
s_add_u32 s72, s71, 0
v_xor_b32 v9, 0x10000, v9
v_mfma_f32_16x16x32_bf16 v[60:63], v[220:223], a[164:167], v[60:63]
s_waitcnt lgkmcnt(0)
buffer_load_dwordx4 v15, s[24:27], s72 offen lds
v_xor_b32 v10, 0x10000, v10
v_mfma_f32_16x16x32_bf16 v[60:63], v[204:207], a[160:163], v[60:63]
v_xor_b32 v11, 0x10000, v11
v_mfma_f32_16x16x32_bf16 v[48:51], v[128:131], a[192:195], v[48:51]
s_nop 0
ds_read_b64_tr_b16 v[192:193], v8 offset:0
ds_read_b64_tr_b16 v[194:195], v8 offset:2048
v_mfma_f32_16x16x32_bf16 v[48:51], v[144:147], a[196:199], v[48:51]
buffer_store_dwordx4 v[28:31], v1, s[44:47], s80 offen offset:3072 sc1
v_mfma_f32_16x16x32_bf16 v[48:51], v[160:163], a[200:203], v[48:51]
s_nop 0
ds_read_b64_tr_b16 v[196:197], v9 offset:0
ds_read_b64_tr_b16 v[198:199], v9 offset:2048
v_mfma_f32_16x16x32_bf16 v[48:51], v[176:179], a[204:207], v[48:51]
s_add_u32 s72, s71, 15360
buffer_load_dwordx4 v15, s[24:27], s72 offen offset:1024 lds
v_mfma_f32_16x16x32_bf16 v[64:67], v[176:179], a[220:223], v[64:67]
s_nop 0
ds_read_b64_tr_b16 v[200:201], v10 offset:0
ds_read_b64_tr_b16 v[202:203], v10 offset:2048
v_mfma_f32_16x16x32_bf16 v[64:67], v[160:163], a[216:219], v[64:67]
v_mfma_f32_16x16x32_bf16 v[64:67], v[144:147], a[212:215], v[64:67]
s_nop 0
ds_read_b64_tr_b16 v[204:205], v11 offset:0
ds_read_b64_tr_b16 v[206:207], v11 offset:2048
v_mfma_f32_16x16x32_bf16 v[64:67], v[128:131], a[208:211], v[64:67]
s_nop 0
ds_read_b64_tr_b16 v[208:209], v8 offset:4096
ds_read_b64_tr_b16 v[210:211], v8 offset:6144
v_mfma_f32_16x16x32_bf16 v[68:71], v[132:135], a[208:211], v[68:71]
v_mfma_f32_16x16x32_bf16 v[68:71], v[148:151], a[212:215], v[68:71]
s_add_u32 s72, s71, 30720
buffer_load_dwordx4 v15, s[24:27], s72 offen offset:2048 lds
v_mfma_f32_16x16x32_bf16 v[68:71], v[164:167], a[216:219], v[68:71]
s_nop 0
ds_read_b64_tr_b16 v[212:213], v9 offset:4096
ds_read_b64_tr_b16 v[214:215], v9 offset:6144
v_mfma_f32_16x16x32_bf16 v[68:71], v[180:183], a[220:223], v[68:71]
s_nop 0
ds_read_b64_tr_b16 v[216:217], v10 offset:4096
ds_read_b64_tr_b16 v[218:219], v10 offset:6144
v_mfma_f32_16x16x32_bf16 v[52:55], v[180:183], a[204:207], v[52:55]
v_mfma_f32_16x16x32_bf16 v[52:55], v[164:167], a[200:203], v[52:55]
s_nop 0
ds_read_b64_tr_b16 v[220:221], v11 offset:4096
ds_read_b64_tr_b16 v[222:223], v11 offset:6144
v_mfma_f32_16x16x32_bf16 v[52:55], v[148:151], a[196:199], v[52:55]
s_nop 0
ds_read_b64_tr_b16 v[224:225], v8 offset:8192
ds_read_b64_tr_b16 v[226:227], v8 offset:10240
v_mfma_f32_16x16x32_bf16 v[52:55], v[132:135], a[192:195], v[52:55]
s_add_u32 s72, s71, 46080
buffer_load_dwordx4 v15, s[24:27], s72 offen offset:3072 lds
v_mfma_f32_16x16x32_bf16 v[56:59], v[136:139], a[192:195], v[56:59]
s_nop 0
ds_read_b64_tr_b16 v[228:229], v9 offset:8192
ds_read_b64_tr_b16 v[230:231], v9 offset:10240
v_mfma_f32_16x16x32_bf16 v[56:59], v[152:155], a[196:199], v[56:59]
v_mfma_f32_16x16x32_bf16 v[56:59], v[168:171], a[200:203], v[56:59]
s_nop 0
ds_read_b64_tr_b16 v[232:233], v10 offset:8192
ds_read_b64_tr_b16 v[234:235], v10 offset:10240
v_mfma_f32_16x16x32_bf16 v[56:59], v[184:187], a[204:207], v[56:59]
s_nop 0
ds_read_b64_tr_b16 v[236:237], v11 offset:8192
ds_read_b64_tr_b16 v[238:239], v11 offset:10240
v_mfma_f32_16x16x32_bf16 v[72:75], v[184:187], a[220:223], v[72:75]
v_mfma_f32_16x16x32_bf16 v[72:75], v[168:171], a[216:219], v[72:75]
s_nop 0
ds_read_b64_tr_b16 v[240:241], v8 offset:12288
ds_read_b64_tr_b16 v[242:243], v8 offset:14336
v_mfma_f32_16x16x32_bf16 v[72:75], v[152:155], a[212:215], v[72:75]
s_nop 0
ds_read_b64_tr_b16 v[244:245], v9 offset:12288
ds_read_b64_tr_b16 v[246:247], v9 offset:14336
v_mfma_f32_16x16x32_bf16 v[72:75], v[136:139], a[208:211], v[72:75]
Lstube3:
s_cbranch_execz Lrete
v_mfma_f32_16x16x32_bf16 v[76:79], v[140:143], a[208:211], v[76:79]
s_nop 0
ds_read_b64_tr_b16 v[248:249], v10 offset:12288
ds_read_b64_tr_b16 v[250:251], v10 offset:14336
v_mfma_f32_16x16x32_bf16 v[76:79], v[156:159], a[212:215], v[76:79]
s_nop 0
ds_read_b64_tr_b16 v[252:253], v11 offset:12288
ds_read_b64_tr_b16 v[254:255], v11 offset:14336
v_mfma_f32_16x16x32_bf16 v[76:79], v[172:175], a[216:219], v[76:79]
v_mfma_f32_16x16x32_bf16 v[76:79], v[188:191], a[220:223], v[76:79]
v_mfma_f32_16x16x32_bf16 v[60:63], v[188:191], a[204:207], v[60:63]
v_mfma_f32_16x16x32_bf16 v[60:63], v[172:175], a[200:203], v[60:63]
s_xor_b32 s71, s15, 0x0
v_mfma_f32_16x16x32_bf16 v[60:63], v[156:159], a[196:199], v[60:63]
s_waitcnt vmcnt(22) lgkmcnt(0)
v_mfma_f32_16x16x32_bf16 v[60:63], v[140:143], a[192:195], v[60:63]
s_barrier
v_mfma_f32_16x16x32_bf16 v[48:51], v[192:195], a[224:227], v[48:51]
s_add_u32 m0, s77, 49152
ds_read_b64_tr_b16 v[128:129], v8 offset:16384
ds_read_b64_tr_b16 v[130:131], v8 offset:18432
v_mfma_f32_16x16x32_bf16 v[48:51], v[208:211], a[228:231], v[48:51]
s_add_u32 s72, s71, 0
buffer_load_dwordx4 v15, s[24:27], s72 offen lds
v_mfma_f32_16x16x32_bf16 v[48:51], v[224:227], a[232:235], v[48:51]
s_nop 0
ds_read_b64_tr_b16 v[132:133], v9 offset:16384
ds_read_b64_tr_b16 v[134:135], v9 offset:18432
v_mfma_f32_16x16x32_bf16 v[48:51], v[240:243], a[236:239], v[48:51]
s_nop 0
ds_read_b64_tr_b16 v[136:137], v10 offset:16384
ds_read_b64_tr_b16 v[138:139], v10 offset:18432
v_mfma_f32_16x16x32_bf16 v[52:55], v[244:247], a[236:239], v[52:55]
s_nop 0
ds_read_b64_tr_b16 v[140:141], v11 offset:16384
ds_read_b64_tr_b16 v[142:143], v11 offset:18432
v_mfma_f32_16x16x32_bf16 v[52:55], v[228:231], a[232:235], v[52:55]
s_add_u32 s72, s71, 15360
buffer_load_dwordx4 v15, s[24:27], s72 offen offset:1024 lds
v_mfma_f32_16x16x32_bf16 v[52:55], v[212:215], a[228:231], v[52:55]
v_mfma_f32_16x16x32_bf16 v[52:55], v[196:199], a[224:227], v[52:55]
s_nop 0
ds_read_b64_tr_b16 v[144:145], v8 offset:20480
ds_read_b64_tr_b16 v[146:147], v8 offset:22528
v_mfma_f32_16x16x32_bf16 v[56:59], v[200:203], a[224:227], v[56:59]
s_nop 0
ds_read_b64_tr_b16 v[148:149], v9 offset:20480
ds_read_b64_tr_b16 v[150:151], v9 offset:22528
v_mfma_f32_16x16x32_bf16 v[56:59], v[216:219], a[228:231], v[56:59]
s_add_u32 s72, s71, 30720
buffer_load_dwordx4 v15, s[24:27], s72 offen offset:2048 lds
v_mfma_f32_16x16x32_bf16 v[56:59], v[232:235], a[232:235], v[56:59]
s_nop 0
ds_read_b64_tr_b16 v[152:153], v10 offset:20480
ds_read_b64_tr_b16 v[154:155], v10 offset:22528
v_mfma_f32_16x16x32_bf16 v[56:59], v[248:251], a[236:239], v[56:59]
s_nop 0
ds_read_b64_tr_b16 v[156:157], v11 offset:20480
ds_read_b64_tr_b16 v[158:159], v11 offset:22528
v_cvt_pk_bf16_f32 v48, v48, v49
v_mfma_f32_16x16x32_bf16 v[60:63], v[252:255], a[236:239], v[60:63]
v_cvt_pk_bf16_f32 v49, v50, v51
v_cvt_pk_bf16_f32 v50, v52, v53
v_cvt_pk_bf16_f32 v51, v54, v55
v_mfma_f32_16x16x32_bf16 v[60:63], v[236:239], a[232:235], v[60:63]
s_add_u32 s72, s71, 46080
buffer_load_dwordx4 v15, s[24:27], s72 offen offset:3072 lds
v_mfma_f32_16x16x32_bf16 v[60:63], v[220:223], a[228:231], v[60:63]
s_nop 0
ds_read_b64_tr_b16 v[160:161], v8 offset:24576
ds_read_b64_tr_b16 v[162:163], v8 offset:26624
v_mfma_f32_16x16x32_bf16 v[60:63], v[204:207], a[224:227], v[60:63]
s_nop 0
ds_read_b64_tr_b16 v[164:165], v9 offset:24576
ds_read_b64_tr_b16 v[166:167], v9 offset:26624
v_mfma_f32_16x16x32_bf16 v[64:67], v[192:195], a[240:243], v[64:67]
s_xor_b32 s80, s93, 0x100000
ds_read_b64_tr_b16 v[168:169], v10 offset:24576
ds_read_b64_tr_b16 v[170:171], v10 offset:26624
v_mfma_f32_16x16x32_bf16 v[64:67], v[208:211], a[244:247], v[64:67]
s_add_u32 s80, s80, 0x3e00000
buffer_store_dwordx4 v[48:51], v1, s[44:47], s80 offen sc1
v_mfma_f32_16x16x32_bf16 v[64:67], v[224:227], a[248:251], v[64:67]
s_nop 0
ds_read_b64_tr_b16 v[172:173], v11 offset:24576
ds_read_b64_tr_b16 v[174:175], v11 offset:26624
v_mfma_f32_16x16x32_bf16 v[64:67], v[240:243], a[252:255], v[64:67]
s_xor_b32 s71, s12, 0x40000
v_cvt_pk_bf16_f32 v52, v56, v57
v_cvt_pk_bf16_f32 v53, v58, v59
v_cvt_pk_bf16_f32 v54, v60, v61
v_mfma_f32_16x16x32_bf16 v[68:71], v[244:247], a[252:255], v[68:71]
s_add_u32 m0, s85, 0
ds_read_b64_tr_b16 v[176:177], v8 offset:28672
ds_read_b64_tr_b16 v[178:179], v8 offset:30720
v_cvt_pk_bf16_f32 v55, v62, v63
v_mfma_f32_16x16x32_bf16 v[68:71], v[228:231], a[248:251], v[68:71]
s_add_u32 s72, s71, 0
buffer_load_dwordx4 v15, s[24:27], s72 offen lds
v_mfma_f32_16x16x32_bf16 v[68:71], v[212:215], a[244:247], v[68:71]
s_nop 0
ds_read_b64_tr_b16 v[180:181], v9 offset:28672
ds_read_b64_tr_b16 v[182:183], v9 offset:30720
v_mfma_f32_16x16x32_bf16 v[68:71], v[196:199], a[240:243], v[68:71]
s_nop 0
ds_read_b64_tr_b16 v[184:185], v10 offset:28672
ds_read_b64_tr_b16 v[186:187], v10 offset:30720
v_mfma_f32_16x16x32_bf16 v[72:75], v[200:203], a[240:243], v[72:75]
s_nop 0
ds_read_b64_tr_b16 v[188:189], v11 offset:28672
ds_read_b64_tr_b16 v[190:191], v11 offset:30720
v_mfma_f32_16x16x32_bf16 v[72:75], v[216:219], a[244:247], v[72:75]
v_mfma_f32_16x16x32_bf16 v[72:75], v[232:235], a[248:251], v[72:75]
s_add_u32 s72, s71, 15360
buffer_load_dwordx4 v15, s[24:27], s72 offen offset:1024 lds
v_mfma_f32_16x16x32_bf16 v[72:75], v[248:251], a[252:255], v[72:75]
v_cvt_pk_bf16_f32 v56, v64, v65
v_cvt_pk_bf16_f32 v57, v66, v67
v_cvt_pk_bf16_f32 v58, v68, v69
v_mfma_f32_16x16x32_bf16 v[76:79], v[252:255], a[252:255], v[76:79]
v_cvt_pk_bf16_f32 v59, v70, v71
v_mfma_f32_16x16x32_bf16 v[76:79], v[236:239], a[248:251], v[76:79]
v_mfma_f32_16x16x32_bf16 v[76:79], v[220:223], a[244:247], v[76:79]
s_waitcnt lgkmcnt(0)
v_mfma_f32_16x16x32_bf16 v[76:79], v[204:207], a[240:243], v[76:79]
v_mfma_f32_16x16x32_bf16 v[80:83], v[128:131], a[160:163], v[80:83]
s_add_u32 s72, s71, 30720
buffer_load_dwordx4 v15, s[24:27], s72 offen offset:2048 lds
v_mfma_f32_16x16x32_bf16 v[80:83], v[144:147], a[164:167], v[80:83]
s_waitcnt vmcnt(23)
buffer_store_dwordx4 v[52:55], v1, s[44:47], s80 offen offset:1024 sc1
v_mfma_f32_16x16x32_bf16 v[80:83], v[160:163], a[168:171], v[80:83]
s_nop 0
ds_read_b64_tr_b16 v[192:193], v8 offset:32768
ds_read_b64_tr_b16 v[194:195], v8 offset:34816
v_mfma_f32_16x16x32_bf16 v[80:83], v[176:179], a[172:175], v[80:83]
s_nop 0
ds_read_b64_tr_b16 v[196:197], v9 offset:32768
ds_read_b64_tr_b16 v[198:199], v9 offset:34816
v_cvt_pk_bf16_f32 v60, v72, v73
v_mfma_f32_16x16x32_bf16 v[96:99], v[176:179], a[188:191], v[96:99]
s_nop 0
ds_read_b64_tr_b16 v[200:201], v10 offset:32768
ds_read_b64_tr_b16 v[202:203], v10 offset:34816
v_cvt_pk_bf16_f32 v61, v74, v75
v_mfma_f32_16x16x32_bf16 v[96:99], v[160:163], a[184:187], v[96:99]
v_cvt_pk_bf16_f32 v62, v76, v77
v_cvt_pk_bf16_f32 v63, v78, v79
v_mfma_f32_16x16x32_bf16 v[96:99], v[144:147], a[180:183], v[96:99]
s_add_u32 s72, s71, 46080
buffer_load_dwordx4 v15, s[24:27], s72 offen offset:3072 lds
v_mfma_f32_16x16x32_bf16 v[96:99], v[128:131], a[176:179], v[96:99]
s_nop 0
ds_read_b64_tr_b16 v[204:205], v11 offset:32768
ds_read_b64_tr_b16 v[206:207], v11 offset:34816
v_mfma_f32_16x16x32_bf16 v[100:103], v[132:135], a[176:179], v[100:103]
s_nop 0
ds_read_b64_tr_b16 v[208:209], v8 offset:36864
ds_read_b64_tr_b16 v[210:211], v8 offset:38912
v_mfma_f32_16x16x32_bf16 v[100:103], v[148:151], a[180:183], v[100:103]
v_sub_f32 v112, 1.0, v6
v_sub_f32 v113, 1.0, v7
v_mfma_f32_16x16x32_bf16 v[100:103], v[164:167], a[184:187], v[100:103]
s_nop 0
ds_read_b64_tr_b16 v[212:213], v9 offset:36864
ds_read_b64_tr_b16 v[214:215], v9 offset:38912
v_mfma_f32_16x16x32_bf16 v[100:103], v[180:183], a[188:191], v[100:103]
s_nop 0
ds_read_b64_tr_b16 v[216:217], v10 offset:36864
ds_read_b64_tr_b16 v[218:219], v10 offset:38912
v_mfma_f32_16x16x32_bf16 v[84:87], v[180:183], a[172:175], v[84:87]
v_mfma_f32_16x16x32_bf16 v[84:87], v[164:167], a[168:171], v[84:87]
s_nop 0
ds_read_b64_tr_b16 v[220:221], v11 offset:36864
ds_read_b64_tr_b16 v[222:223], v11 offset:38912
v_mfma_f32_16x16x32_bf16 v[84:87], v[148:151], a[164:167], v[84:87]
s_nop 0
ds_read_b64_tr_b16 v[224:225], v8 offset:40960
ds_read_b64_tr_b16 v[226:227], v8 offset:43008
v_mfma_f32_16x16x32_bf16 v[84:87], v[132:135], a[160:163], v[84:87]
s_nop 0
ds_read_b64_tr_b16 v[228:229], v9 offset:40960
ds_read_b64_tr_b16 v[230:231], v9 offset:43008
v_mfma_f32_16x16x32_bf16 v[88:91], v[136:139], a[160:163], v[88:91]
v_mfma_f32_16x16x32_bf16 v[88:91], v[152:155], a[164:167], v[88:91]
buffer_store_dwordx4 v[56:59], v1, s[44:47], s80 offen offset:2048 sc1
v_mfma_f32_16x16x32_bf16 v[88:91], v[168:171], a[168:171], v[88:91]
s_nop 0
ds_read_b64_tr_b16 v[232:233], v10 offset:40960
ds_read_b64_tr_b16 v[234:235], v10 offset:43008
v_mfma_f32_16x16x32_bf16 v[88:91], v[184:187], a[172:175], v[88:91]
s_nop 0
ds_read_b64_tr_b16 v[236:237], v11 offset:40960
ds_read_b64_tr_b16 v[238:239], v11 offset:43008
v_mfma_f32_16x16x32_bf16 v[104:107], v[184:187], a[188:191], v[104:107]
v_mfma_f32_16x16x32_bf16 v[104:107], v[168:171], a[184:187], v[104:107]
s_nop 0
ds_read_b64_tr_b16 v[240:241], v8 offset:45056
ds_read_b64_tr_b16 v[242:243], v8 offset:47104
v_mfma_f32_16x16x32_bf16 v[104:107], v[152:155], a[180:183], v[104:107]
s_nop 0
ds_read_b64_tr_b16 v[244:245], v9 offset:45056
ds_read_b64_tr_b16 v[246:247], v9 offset:47104
v_mfma_f32_16x16x32_bf16 v[104:107], v[136:139], a[176:179], v[104:107]
v_mfma_f32_16x16x32_bf16 v[108:111], v[140:143], a[176:179], v[108:111]
s_nop 0
ds_read_b64_tr_b16 v[248:249], v10 offset:45056
ds_read_b64_tr_b16 v[250:251], v10 offset:47104
v_mfma_f32_16x16x32_bf16 v[108:111], v[156:159], a[180:183], v[108:111]
s_nop 0
ds_read_b64_tr_b16 v[252:253], v11 offset:45056
ds_read_b64_tr_b16 v[254:255], v11 offset:47104
v_mfma_f32_16x16x32_bf16 v[108:111], v[172:175], a[184:187], v[108:111]
v_mfma_f32_16x16x32_bf16 v[108:111], v[188:191], a[188:191], v[108:111]
v_mfma_f32_16x16x32_bf16 v[92:95], v[188:191], a[172:175], v[92:95]
v_mfma_f32_16x16x32_bf16 v[92:95], v[172:175], a[168:171], v[92:95]
s_xor_b32 s71, s13, 0x40000
v_mfma_f32_16x16x32_bf16 v[92:95], v[156:159], a[164:167], v[92:95]
s_waitcnt vmcnt(22) lgkmcnt(0)
v_mfma_f32_16x16x32_bf16 v[92:95], v[140:143], a[160:163], v[92:95]
s_barrier
v_mfma_f32_16x16x32_bf16 v[80:83], v[192:195], a[192:195], v[80:83]
s_add_u32 m0, s85, 16384
ds_read_b64_tr_b16 v[128:129], v8 offset:49152
ds_read_b64_tr_b16 v[130:131], v8 offset:51200
v_mfma_f32_16x16x32_bf16 v[80:83], v[208:211], a[196:199], v[80:83]
s_add_u32 s72, s71, 0
buffer_load_dwordx4 v15, s[24:27], s72 offen lds
v_mfma_f32_16x16x32_bf16 v[80:83], v[224:227], a[200:203], v[80:83]
buffer_store_dwordx4 v[60:63], v1, s[44:47], s80 offen offset:3072 sc1
v_mfma_f32_16x16x32_bf16 v[80:83], v[240:243], a[204:207], v[80:83]
s_nop 0
ds_read_b64_tr_b16 v[132:133], v9 offset:49152
ds_read_b64_tr_b16 v[134:135], v9 offset:51200
v_mfma_f32_16x16x32_bf16 v[96:99], v[240:243], a[220:223], v[96:99]
s_add_u32 s72, s71, 15360
buffer_load_dwordx4 v15, s[24:27], s72 offen offset:1024 lds
v_mfma_f32_16x16x32_bf16 v[96:99], v[224:227], a[216:219], v[96:99]
s_nop 0
ds_read_b64_tr_b16 v[136:137], v10 offset:49152
ds_read_b64_tr_b16 v[138:139], v10 offset:51200
v_mfma_f32_16x16x32_bf16 v[96:99], v[208:211], a[212:215], v[96:99]
s_nop 0
ds_read_b64_tr_b16 v[140:141], v11 offset:49152
ds_read_b64_tr_b16 v[142:143], v11 offset:51200
v_mfma_f32_16x16x32_bf16 v[96:99], v[192:195], a[208:211], v[96:99]
s_add_u32 s72, s71, 30720
buffer_load_dwordx4 v15, s[24:27], s72 offen offset:2048 lds
v_mfma_f32_16x16x32_bf16 v[100:103], v[196:199], a[208:211], v[100:103]
s_nop 0
ds_read_b64_tr_b16 v[144:145], v8 offset:53248
ds_read_b64_tr_b16 v[146:147], v8 offset:55296
v_mfma_f32_16x16x32_bf16 v[100:103], v[212:215], a[212:215], v[100:103]
s_nop 0
ds_read_b64_tr_b16 v[148:149], v9 offset:53248
ds_read_b64_tr_b16 v[150:151], v9 offset:55296
v_mfma_f32_16x16x32_bf16 v[100:103], v[228:231], a[216:219], v[100:103]
s_add_u32 s72, s71, 46080
buffer_load_dwordx4 v15, s[24:27], s72 offen offset:3072 lds
v_mfma_f32_16x16x32_bf16 v[100:103], v[244:247], a[220:223], v[100:103]
s_xor_b32 s71, s14, 0x40000
ds_read_b64 v[48:49], v116 offset:0
ds_read_b64_tr_b16 v[64:65], v5 offset:0
v_mfma_f32_16x16x32_bf16 v[84:87], v[244:247], a[204:207], v[84:87]
s_add_u32 m0, s85, 32768
s_add_u32 s72, s71, 0
buffer_load_dwordx4 v15, s[24:27], s72 offen lds
v_mfma_f32_16x16x32_bf16 v[84:87], v[228:231], a[200:203], v[84:87]
s_nop 0
ds_read_b64_tr_b16 v[152:153], v10 offset:53248
ds_read_b64_tr_b16 v[154:155], v10 offset:55296
v_mfma_f32_16x16x32_bf16 v[84:87], v[212:215], a[196:199], v[84:87]
s_nop 0
ds_read_b64_tr_b16 v[156:157], v11 offset:53248
ds_read_b64_tr_b16 v[158:159], v11 offset:55296
v_mfma_f32_16x16x32_bf16 v[84:87], v[196:199], a[192:195], v[84:87]
s_nop 0
ds_read_b64_tr_b16 v[160:161], v8 offset:57344
ds_read_b64_tr_b16 v[162:163], v8 offset:59392
v_mfma_f32_16x16x32_bf16 v[88:91], v[200:203], a[192:195], v[88:91]
s_nop 0
ds_read_b64_tr_b16 v[164:165], v9 offset:57344
ds_read_b64_tr_b16 v[166:167], v9 offset:59392
v_mfma_f32_16x16x32_bf16 v[88:91], v[216:219], a[196:199], v[88:91]
s_add_u32 s72, s71, 15360
buffer_load_dwordx4 v15, s[24:27], s72 offen offset:1024 lds
v_mfma_f32_16x16x32_bf16 v[88:91], v[232:235], a[200:203], v[88:91]
s_nop 0
ds_read_b64_tr_b16 v[168:169], v10 offset:57344
ds_read_b64_tr_b16 v[170:171], v10 offset:59392
v_mfma_f32_16x16x32_bf16 v[88:91], v[248:251], a[204:207], v[88:91]
s_nop 0
ds_read_b64 v[50:51], v117 offset:0
ds_read_b64_tr_b16 v[66:67], v5 offset:4096
v_mfma_f32_16x16x32_bf16 v[104:107], v[248:251], a[220:223], v[104:107]
s_nop 0
ds_read_b64_tr_b16 v[172:173], v11 offset:57344
ds_read_b64_tr_b16 v[174:175], v11 offset:59392
v_mfma_f32_16x16x32_bf16 v[104:107], v[232:235], a[216:219], v[104:107]
s_nop 0
ds_read_b64_tr_b16 v[176:177], v8 offset:61440
ds_read_b64_tr_b16 v[178:179], v8 offset:63488
v_mfma_f32_16x16x32_bf16 v[104:107], v[216:219], a[212:215], v[104:107]
s_nop 0
ds_read_b64_tr_b16 v[180:181], v9 offset:61440
ds_read_b64_tr_b16 v[182:183], v9 offset:63488
v_mfma_f32_16x16x32_bf16 v[104:107], v[200:203], a[208:211], v[104:107]
s_add_u32 s72, s71, 30720
buffer_load_dwordx4 v15, s[24:27], s72 offen offset:2048 lds
v_mfma_f32_16x16x32_bf16 v[108:111], v[204:207], a[208:211], v[108:111]
s_nop 0
ds_read_b64_tr_b16 v[184:185], v10 offset:61440
ds_read_b64_tr_b16 v[186:187], v10 offset:63488
v_mfma_f32_16x16x32_bf16 v[108:111], v[220:223], a[212:215], v[108:111]
s_nop 0
ds_read_b64_tr_b16 v[188:189], v11 offset:61440
ds_read_b64_tr_b16 v[190:191], v11 offset:63488
v_mfma_f32_16x16x32_bf16 v[108:111], v[236:239], a[216:219], v[108:111]
s_nop 0
ds_read_b64 v[52:53], v118 offset:0
ds_read_b64_tr_b16 v[68:69], v5 offset:8192
v_mfma_f32_16x16x32_bf16 v[108:111], v[252:255], a[220:223], v[108:111]
s_nop 0
ds_read_b64 v[54:55], v119 offset:0
ds_read_b64_tr_b16 v[70:71], v5 offset:12288
v_mfma_f32_16x16x32_bf16 v[92:95], v[252:255], a[204:207], v[92:95]
v_xor_b32 v8, 0x10000, v8
v_xor_b32 v5, 16, v5
v_mfma_f32_16x16x32_bf16 v[92:95], v[236:239], a[200:203], v[92:95]
s_add_u32 s72, s71, 46080
buffer_load_dwordx4 v15, s[24:27], s72 offen offset:3072 lds
v_xor_b32 v9, 0x10000, v9
v_mfma_f32_16x16x32_bf16 v[92:95], v[220:223], a[196:199], v[92:95]
s_waitcnt lgkmcnt(0)
ds_read_b64 v[56:57], v116 offset:2048
v_xor_b32 v10, 0x10000, v10
v_mfma_f32_16x16x32_bf16 v[92:95], v[204:207], a[192:195], v[92:95]
ds_read_b64_tr_b16 v[72:73], v5 offset:0
v_xor_b32 v11, 0x10000, v11
v_mfma_f32_16x16x32_bf16 v[80:83], v[128:131], a[224:227], v[80:83]
s_nop 0
ds_read_b64_tr_b16 v[192:193], v8 offset:0
ds_read_b64_tr_b16 v[194:195], v8 offset:2048
v_mfma_f32_16x16x32_bf16 v[80:83], v[144:147], a[228:231], v[80:83]
s_nop 0
ds_read_b64_tr_b16 v[196:197], v9 offset:0
ds_read_b64_tr_b16 v[198:199], v9 offset:2048
v_mfma_f32_16x16x32_bf16 v[80:83], v[160:163], a[232:235], v[80:83]
s_nop 0
ds_read_b64 v[58:59], v117 offset:2048
ds_read_b64_tr_b16 v[74:75], v5 offset:4096
v_mfma_f32_16x16x32_bf16 v[80:83], v[176:179], a[236:239], v[80:83]
s_nop 0
ds_read_b64_tr_b16 v[200:201], v10 offset:0
ds_read_b64_tr_b16 v[202:203], v10 offset:2048
v_mfma_f32_16x16x32_bf16 v[84:87], v[180:183], a[236:239], v[84:87]
s_nop 0
ds_read_b64_tr_b16 v[204:205], v11 offset:0
ds_read_b64_tr_b16 v[206:207], v11 offset:2048
v_mfma_f32_16x16x32_bf16 v[84:87], v[164:167], a[232:235], v[84:87]
s_nop 0
ds_read_b64 v[60:61], v118 offset:2048
ds_read_b64_tr_b16 v[76:77], v5 offset:8192
v_mfma_f32_16x16x32_bf16 v[84:87], v[148:151], a[228:231], v[84:87]
s_nop 0
ds_read_b64_tr_b16 v[208:209], v8 offset:4096
ds_read_b64_tr_b16 v[210:211], v8 offset:6144
v_mfma_f32_16x16x32_bf16 v[84:87], v[132:135], a[224:227], v[84:87]
s_nop 0
ds_read_b64 v[62:63], v119 offset:2048
ds_read_b64_tr_b16 v[78:79], v5 offset:12288
v_mfma_f32_16x16x32_bf16 v[88:91], v[136:139], a[224:227], v[88:91]
s_nop 0
ds_read_b64_tr_b16 v[212:213], v9 offset:4096
ds_read_b64_tr_b16 v[214:215], v9 offset:6144
v_mfma_f32_16x16x32_bf16 v[88:91], v[152:155], a[228:231], v[88:91]
s_nop 0
ds_read_b64_tr_b16 v[216:217], v10 offset:4096
ds_read_b64_tr_b16 v[218:219], v10 offset:6144
v_mfma_f32_16x16x32_bf16 v[88:91], v[168:171], a[232:235], v[88:91]
v_mfma_f32_16x16x32_bf16 v[88:91], v[184:187], a[236:239], v[88:91]
s_nop 0
ds_read_b64_tr_b16 v[220:221], v11 offset:4096
ds_read_b64_tr_b16 v[222:223], v11 offset:6144
v_cvt_pk_bf16_f32 v80, v80, v81
v_mfma_f32_16x16x32_bf16 v[92:95], v[188:191], a[236:239], v[92:95]
v_cvt_pk_bf16_f32 v81, v82, v83
v_cvt_pk_bf16_f32 v82, v84, v85
v_cvt_pk_bf16_f32 v83, v86, v87
v_mfma_f32_16x16x32_bf16 v[92:95], v[172:175], a[232:235], v[92:95]
s_waitcnt lgkmcnt(6)
ds_read_b64_tr_b16 v[224:225], v8 offset:8192
ds_read_b64_tr_b16 v[226:227], v8 offset:10240
v_mfma_f32_16x16x32_bf16 v[92:95], v[156:159], a[228:231], v[92:95]
s_nop 0
ds_read_b64_tr_b16 v[228:229], v9 offset:8192
ds_read_b64_tr_b16 v[230:231], v9 offset:10240
v_mfma_f32_16x16x32_bf16 v[92:95], v[140:143], a[224:227], v[92:95]
v_and_b32 v114, 0xffff0000, v48
v_lshlrev_b32 v115, 16, v64
v_mfma_f32_16x16x32_bf16 v[96:99], v[128:131], a[240:243], v[96:99]
s_xor_b32 s80, s93, 0x180000
ds_read_b64_tr_b16 v[232:233], v10 offset:8192
ds_read_b64_tr_b16 v[234:235], v10 offset:10240
v_mfma_f32_16x16x32_bf16 v[96:99], v[144:147], a[244:247], v[96:99]
s_add_u32 s80, s80, 0x4200000
buffer_store_dwordx4 v[80:83], v1, s[44:47], s80 offen sc1
v_mfma_f32_16x16x32_bf16 v[96:99], v[160:163], a[248:251], v[96:99]
s_nop 0
ds_read_b64_tr_b16 v[236:237], v11 offset:8192
ds_read_b64_tr_b16 v[238:239], v11 offset:10240
v_mfma_f32_16x16x32_bf16 v[96:99], v[176:179], a[252:255], v[96:99]
v_cvt_pk_bf16_f32 v84, v88, v89
v_cvt_pk_bf16_f32 v85, v90, v91
v_cvt_pk_bf16_f32 v86, v92, v93
v_mfma_f32_16x16x32_bf16 v[100:103], v[180:183], a[252:255], v[100:103]
s_nop 0
ds_read_b64_tr_b16 v[240:241], v8 offset:12288
ds_read_b64_tr_b16 v[242:243], v8 offset:14336
v_cvt_pk_bf16_f32 v87, v94, v95
v_mfma_f32_16x16x32_bf16 v[100:103], v[164:167], a[248:251], v[100:103]
v_lshlrev_b32 v48, 16, v48
v_and_b32 v64, 0xffff0000, v64
v_mfma_f32_16x16x32_bf16 v[100:103], v[148:151], a[244:247], v[100:103]
s_nop 0
ds_read_b64_tr_b16 v[244:245], v9 offset:12288
ds_read_b64_tr_b16 v[246:247], v9 offset:14336
v_mfma_f32_16x16x32_bf16 v[100:103], v[132:135], a[240:243], v[100:103]
s_nop 0
ds_read_b64_tr_b16 v[248:249], v10 offset:12288
ds_read_b64_tr_b16 v[250:251], v10 offset:14336
v_mfma_f32_16x16x32_bf16 v[104:107], v[136:139], a[240:243], v[104:107]
v_mul_f32 v48, v48, v112
v_mul_f32 v114, v114, v112
v_mfma_f32_16x16x32_bf16 v[104:107], v[152:155], a[244:247], v[104:107]
s_nop 0
ds_read_b64_tr_b16 v[252:253], v11 offset:12288
ds_read_b64_tr_b16 v[254:255], v11 offset:14336
v_mfma_f32_16x16x32_bf16 v[104:107], v[168:171], a[248:251], v[104:107]
v_mul_f32 v48, v48, v115
v_mul_f32 v64, v64, v114
v_mfma_f32_16x16x32_bf16 v[104:107], v[184:187], a[252:255], v[104:107]
v_cvt_pk_bf16_f32 v88, v96, v97
v_cvt_pk_bf16_f32 v89, v98, v99
v_cvt_pk_bf16_f32 v90, v100, v101
v_mfma_f32_16x16x32_bf16 v[108:111], v[188:191], a[252:255], v[108:111]
v_cvt_pk_bf16_f32 v91, v102, v103
v_and_b32 v114, 0xffff0000, v49
v_mfma_f32_16x16x32_bf16 v[108:111], v[172:175], a[248:251], v[108:111]
s_xor_b32 s71, s15, 0x40000
v_lshlrev_b32 v115, 16, v65
v_lshlrev_b32 v49, 16, v49
v_mfma_f32_16x16x32_bf16 v[108:111], v[156:159], a[244:247], v[108:111]
s_waitcnt vmcnt(21) lgkmcnt(0)
v_and_b32 v65, 0xffff0000, v65
v_mul_f32 v49, v49, v112
v_mfma_f32_16x16x32_bf16 v[108:111], v[140:143], a[240:243], v[108:111]
s_barrier
v_mul_f32 v114, v114, v112
v_mul_f32 v49, v49, v115
v_mfma_f32_16x16x32_bf16 v[16:19], v[192:195], a[0:3], 0
s_add_u32 m0, s85, 49152
ds_read_b64_tr_b16 v[128:129], v8 offset:16384
ds_read_b64_tr_b16 v[130:131], v8 offset:18432
v_mfma_f32_16x16x32_bf16 v[16:19], v[208:211], a[4:7], v[16:19]
s_add_u32 s72, s71, 0
buffer_load_dwordx4 v15, s[24:27], s72 offen lds
v_mfma_f32_16x16x32_bf16 v[16:19], v[224:227], a[8:11], v[16:19]
buffer_store_dwordx4 v[84:87], v1, s[44:47], s80 offen offset:1024 sc1
v_mfma_f32_16x16x32_bf16 v[16:19], v[240:243], a[12:15], v[16:19]
s_nop 0
ds_read_b64_tr_b16 v[132:133], v9 offset:16384
ds_read_b64_tr_b16 v[134:135], v9 offset:18432
v_cvt_pk_bf16_f32 v92, v104, v105
v_mfma_f32_16x16x32_bf16 v[32:35], v[240:243], a[28:31], 0
s_add_u32 s72, s71, 15360
buffer_load_dwordx4 v15, s[24:27], s72 offen offset:1024 lds
v_cvt_pk_bf16_f32 v93, v106, v107
v_mfma_f32_16x16x32_bf16 v[32:35], v[224:227], a[24:27], v[32:35]
s_nop 0
ds_read_b64_tr_b16 v[136:137], v10 offset:16384
ds_read_b64_tr_b16 v[138:139], v10 offset:18432
v_cvt_pk_bf16_f32 v94, v108, v109
v_mfma_f32_16x16x32_bf16 v[32:35], v[208:211], a[20:23], v[32:35]
s_nop 0
ds_read_b64_tr_b16 v[140:141], v11 offset:16384
ds_read_b64_tr_b16 v[142:143], v11 offset:18432
v_cvt_pk_bf16_f32 v95, v110, v111
v_mfma_f32_16x16x32_bf16 v[32:35], v[192:195], a[16:19], v[32:35]
s_add_u32 s72, s71, 30720
buffer_load_dwordx4 v15, s[24:27], s72 offen offset:2048 lds
v_mfma_f32_16x16x32_bf16 v[36:39], v[196:199], a[16:19], 0
v_mul_f32 v65, v65, v114
v_and_b32 v114, 0xffff0000, v50
v_mfma_f32_16x16x32_bf16 v[36:39], v[212:215], a[20:23], v[36:39]
s_nop 0
ds_read_b64_tr_b16 v[144:145], v8 offset:20480
ds_read_b64_tr_b16 v[146:147], v8 offset:22528
v_mfma_f32_16x16x32_bf16 v[36:39], v[228:231], a[24:27], v[36:39]
s_add_u32 s72, s71, 46080
buffer_load_dwordx4 v15, s[24:27], s72 offen offset:3072 lds
v_mfma_f32_16x16x32_bf16 v[36:39], v[244:247], a[28:31], v[36:39]
s_nop 0
ds_read_b64_tr_b16 v[148:149], v9 offset:20480
ds_read_b64_tr_b16 v[150:151], v9 offset:22528
v_mfma_f32_16x16x32_bf16 v[20:23], v[244:247], a[12:15], 0
s_nop 0
ds_read_b64_tr_b16 v[152:153], v10 offset:20480
ds_read_b64_tr_b16 v[154:155], v10 offset:22528
v_mfma_f32_16x16x32_bf16 v[20:23], v[228:231], a[8:11], v[20:23]
v_lshlrev_b32 v115, 16, v66
v_lshlrev_b32 v50, 16, v50
v_mfma_f32_16x16x32_bf16 v[20:23], v[212:215], a[4:7], v[20:23]
s_nop 0
ds_read_b64_tr_b16 v[156:157], v11 offset:20480
ds_read_b64_tr_b16 v[158:159], v11 offset:22528
v_mfma_f32_16x16x32_bf16 v[20:23], v[196:199], a[0:3], v[20:23]
s_nop 0
ds_read_b64_tr_b16 v[160:161], v8 offset:24576
ds_read_b64_tr_b16 v[162:163], v8 offset:26624
v_mfma_f32_16x16x32_bf16 v[24:27], v[200:203], a[0:3], 0
s_nop 0
ds_read_b64_tr_b16 v[164:165], v9 offset:24576
ds_read_b64_tr_b16 v[166:167], v9 offset:26624
v_mfma_f32_16x16x32_bf16 v[24:27], v[216:219], a[4:7], v[24:27]
v_and_b32 v66, 0xffff0000, v66
v_mul_f32 v50, v50, v112
v_mfma_f32_16x16x32_bf16 v[24:27], v[232:235], a[8:11], v[24:27]
buffer_store_dwordx4 v[88:91], v1, s[44:47], s80 offen offset:2048 sc1
v_mfma_f32_16x16x32_bf16 v[24:27], v[248:251], a[12:15], v[24:27]
s_nop 0
ds_read_b64_tr_b16 v[168:169], v10 offset:24576
ds_read_b64_tr_b16 v[170:171], v10 offset:26624
v_mfma_f32_16x16x32_bf16 v[40:43], v[248:251], a[28:31], 0
s_nop 0
ds_read_b64_tr_b16 v[172:173], v11 offset:24576
ds_read_b64_tr_b16 v[174:175], v11 offset:26624
v_mfma_f32_16x16x32_bf16 v[40:43], v[232:235], a[24:27], v[40:43]
s_nop 0
ds_read_b64_tr_b16 v[176:177], v8 offset:28672
ds_read_b64_tr_b16 v[178:179], v8 offset:30720
v_mfma_f32_16x16x32_bf16 v[40:43], v[216:219], a[20:23], v[40:43]
v_mul_f32 v114, v114, v112
v_mul_f32 v50, v50, v115
v_mfma_f32_16x16x32_bf16 v[40:43], v[200:203], a[16:19], v[40:43]
s_nop 0
ds_read_b64_tr_b16 v[180:181], v9 offset:28672
ds_read_b64_tr_b16 v[182:183], v9 offset:30720
v_mfma_f32_16x16x32_bf16 v[44:47], v[204:207], a[16:19], 0
s_nop 0
ds_read_b64_tr_b16 v[184:185], v10 offset:28672
ds_read_b64_tr_b16 v[186:187], v10 offset:30720
v_mfma_f32_16x16x32_bf16 v[44:47], v[220:223], a[20:23], v[44:47]
s_nop 0
ds_read_b64_tr_b16 v[188:189], v11 offset:28672
ds_read_b64_tr_b16 v[190:191], v11 offset:30720
v_mfma_f32_16x16x32_bf16 v[44:47], v[236:239], a[24:27], v[44:47]
v_mul_f32 v66, v66, v114
v_and_b32 v114, 0xffff0000, v51
v_mfma_f32_16x16x32_bf16 v[44:47], v[252:255], a[28:31], v[44:47]
v_lshlrev_b32 v115, 16, v67
v_lshlrev_b32 v51, 16, v51
v_mfma_f32_16x16x32_bf16 v[28:31], v[252:255], a[12:15], 0
v_and_b32 v67, 0xffff0000, v67
v_mul_f32 v51, v51, v112
v_mfma_f32_16x16x32_bf16 v[28:31], v[236:239], a[8:11], v[28:31]
v_mul_f32 v114, v114, v112
v_mul_f32 v51, v51, v115
v_mfma_f32_16x16x32_bf16 v[28:31], v[220:223], a[4:7], v[28:31]
s_waitcnt lgkmcnt(0)
v_mul_f32 v67, v67, v114
v_and_b32 v114, 0xffff0000, v52
v_mfma_f32_16x16x32_bf16 v[28:31], v[204:207], a[0:3], v[28:31]
Lstube4:
s_cbranch_execz Lrete
v_lshlrev_b32 v115, 16, v68
v_lshlrev_b32 v52, 16, v52
v_mfma_f32_16x16x32_bf16 v[16:19], v[128:131], a[32:35], v[16:19]
s_nop 0
ds_read_b64_tr_b16 v[192:193], v8 offset:32768
ds_read_b64_tr_b16 v[194:195], v8 offset:34816
v_mfma_f32_16x16x32_bf16 v[16:19], v[144:147], a[36:39], v[16:19]
s_nop 0
ds_read_b64_tr_b16 v[196:197], v9 offset:32768
ds_read_b64_tr_b16 v[198:199], v9 offset:34816
v_mfma_f32_16x16x32_bf16 v[16:19], v[160:163], a[40:43], v[16:19]
buffer_store_dwordx4 v[92:95], v1, s[44:47], s80 offen offset:3072 sc1
v_mfma_f32_16x16x32_bf16 v[16:19], v[176:179], a[44:47], v[16:19]
v_and_b32 v68, 0xffff0000, v68
v_mul_f32 v52, v52, v112
v_mfma_f32_16x16x32_bf16 v[32:35], v[176:179], a[60:63], v[32:35]
s_nop 0
ds_read_b64_tr_b16 v[200:201], v10 offset:32768
ds_read_b64_tr_b16 v[202:203], v10 offset:34816
v_mfma_f32_16x16x32_bf16 v[32:35], v[160:163], a[56:59], v[32:35]
s_nop 0
ds_read_b64_tr_b16 v[204:205], v11 offset:32768
ds_read_b64_tr_b16 v[206:207], v11 offset:34816
v_mfma_f32_16x16x32_bf16 v[32:35], v[144:147], a[52:55], v[32:35]
v_mul_f32 v114, v114, v112
v_mul_f32 v52, v52, v115
v_mfma_f32_16x16x32_bf16 v[32:35], v[128:131], a[48:51], v[32:35]
s_nop 0
ds_read_b64_tr_b16 v[208:209], v8 offset:36864
ds_read_b64_tr_b16 v[210:211], v8 offset:38912
v_mfma_f32_16x16x32_bf16 v[36:39], v[132:135], a[48:51], v[36:39]
v_mul_f32 v68, v68, v114
v_and_b32 v114, 0xffff0000, v53
v_mfma_f32_16x16x32_bf16 v[36:39], v[148:151], a[52:55], v[36:39]
s_nop 0
ds_read_b64_tr_b16 v[212:213], v9 offset:36864
ds_read_b64_tr_b16 v[214:215], v9 offset:38912
v_mfma_f32_16x16x32_bf16 v[36:39], v[164:167], a[56:59], v[36:39]
s_nop 0
ds_read_b64_tr_b16 v[216:217], v10 offset:36864
ds_read_b64_tr_b16 v[218:219], v10 offset:38912
v_mfma_f32_16x16x32_bf16 v[36:39], v[180:183], a[60:63], v[36:39]
v_lshlrev_b32 v115, 16, v69
v_lshlrev_b32 v53, 16, v53
v_mfma_f32_16x16x32_bf16 v[20:23], v[180:183], a[44:47], v[20:23]
s_nop 0
ds_read_b64_tr_b16 v[220:221], v11 offset:36864
ds_read_b64_tr_b16 v[222:223], v11 offset:38912
v_mfma_f32_16x16x32_bf16 v[20:23], v[164:167], a[40:43], v[20:23]
v_and_b32 v69, 0xffff0000, v69
v_mul_f32 v53, v53, v112
v_mfma_f32_16x16x32_bf16 v[20:23], v[148:151], a[36:39], v[20:23]
s_nop 0
ds_read_b64_tr_b16 v[224:225], v8 offset:40960
ds_read_b64_tr_b16 v[226:227], v8 offset:43008
v_mfma_f32_16x16x32_bf16 v[20:23], v[132:135], a[32:35], v[20:23]
s_nop 0
ds_read_b64_tr_b16 v[228:229], v9 offset:40960
ds_read_b64_tr_b16 v[230:231], v9 offset:43008
v_mfma_f32_16x16x32_bf16 v[24:27], v[136:139], a[32:35], v[24:27]
v_mul_f32 v114, v114, v112
v_mul_f32 v53, v53, v115
v_mfma_f32_16x16x32_bf16 v[24:27], v[152:155], a[36:39], v[24:27]
s_nop 0
ds_read_b64_tr_b16 v[232:233], v10 offset:40960
ds_read_b64_tr_b16 v[234:235], v10 offset:43008
v_mfma_f32_16x16x32_bf16 v[24:27], v[168:171], a[40:43], v[24:27]
s_nop 0
ds_read_b64_tr_b16 v[236:237], v11 offset:40960
ds_read_b64_tr_b16 v[238:239], v11 offset:43008
v_mfma_f32_16x16x32_bf16 v[24:27], v[184:187], a[44:47], v[24:27]
v_mul_f32 v69, v69, v114
v_and_b32 v114, 0xffff0000, v54
v_mfma_f32_16x16x32_bf16 v[40:43], v[184:187], a[60:63], v[40:43]
s_nop 0
ds_read_b64_tr_b16 v[240:241], v8 offset:45056
ds_read_b64_tr_b16 v[242:243], v8 offset:47104
v_mfma_f32_16x16x32_bf16 v[40:43], v[168:171], a[56:59], v[40:43]
v_lshlrev_b32 v115, 16, v70
v_lshlrev_b32 v54, 16, v54
v_mfma_f32_16x16x32_bf16 v[40:43], v[152:155], a[52:55], v[40:43]
s_nop 0
ds_read_b64_tr_b16 v[244:245], v9 offset:45056
ds_read_b64_tr_b16 v[246:247], v9 offset:47104
v_mfma_f32_16x16x32_bf16 v[40:43], v[136:139], a[48:51], v[40:43]
s_nop 0
ds_read_b64_tr_b16 v[248:249], v10 offset:45056
ds_read_b64_tr_b16 v[250:251], v10 offset:47104
v_mfma_f32_16x16x32_bf16 v[44:47], v[140:143], a[48:51], v[44:47]
v_and_b32 v70, 0xffff0000, v70
v_mul_f32 v54, v54, v112
v_mfma_f32_16x16x32_bf16 v[44:47], v[156:159], a[52:55], v[44:47]
s_nop 0
ds_read_b64_tr_b16 v[252:253], v11 offset:45056
ds_read_b64_tr_b16 v[254:255], v11 offset:47104
v_mfma_f32_16x16x32_bf16 v[44:47], v[172:175], a[56:59], v[44:47]
v_mul_f32 v114, v114, v112
v_mul_f32 v54, v54, v115
v_mfma_f32_16x16x32_bf16 v[44:47], v[188:191], a[60:63], v[44:47]
v_mul_f32 v70, v70, v114
v_and_b32 v114, 0xffff0000, v55
v_mfma_f32_16x16x32_bf16 v[28:31], v[188:191], a[44:47], v[28:31]
v_lshlrev_b32 v115, 16, v71
v_lshlrev_b32 v55, 16, v55
v_mfma_f32_16x16x32_bf16 v[28:31], v[172:175], a[40:43], v[28:31]
s_add_u32 s79, s93, 0x3a00000
v_and_b32 v71, 0xffff0000, v71
v_mul_f32 v55, v55, v112
v_mfma_f32_16x16x32_bf16 v[28:31], v[156:159], a[36:39], v[28:31]
s_waitcnt vmcnt(18) lgkmcnt(0)
buffer_load_dwordx4 v[96:99], v1, s[44:47], s79 offen sc1
v_mfma_f32_16x16x32_bf16 v[28:31], v[140:143], a[32:35], v[28:31]
s_barrier
v_mul_f32 v114, v114, v112
v_mul_f32 v55, v55, v115
v_mfma_f32_16x16x32_bf16 v[16:19], v[192:195], a[64:67], v[16:19]
s_nop 0
ds_read_b64_tr_b16 v[128:129], v8 offset:49152
ds_read_b64_tr_b16 v[130:131], v8 offset:51200
v_mfma_f32_16x16x32_bf16 v[16:19], v[208:211], a[68:71], v[16:19]
s_nop 0
ds_read_b64_tr_b16 v[132:133], v9 offset:49152
ds_read_b64_tr_b16 v[134:135], v9 offset:51200
v_mfma_f32_16x16x32_bf16 v[16:19], v[224:227], a[72:75], v[16:19]
v_mul_f32 v71, v71, v114
v_and_b32 v114, 0xffff0000, v56
v_mfma_f32_16x16x32_bf16 v[16:19], v[240:243], a[76:79], v[16:19]
buffer_load_dwordx4 v[100:103], v1, s[44:47], s79 offen offset:1024 sc1
v_mfma_f32_16x16x32_bf16 v[32:35], v[240:243], a[92:95], v[32:35]
s_nop 0
ds_read_b64_tr_b16 v[136:137], v10 offset:49152
ds_read_b64_tr_b16 v[138:139], v10 offset:51200
v_mfma_f32_16x16x32_bf16 v[32:35], v[224:227], a[88:91], v[32:35]
s_nop 0
ds_read_b64_tr_b16 v[140:141], v11 offset:49152
ds_read_b64_tr_b16 v[142:143], v11 offset:51200
v_mfma_f32_16x16x32_bf16 v[32:35], v[208:211], a[84:87], v[32:35]
v_lshlrev_b32 v115, 16, v72
v_lshlrev_b32 v56, 16, v56
v_mfma_f32_16x16x32_bf16 v[32:35], v[192:195], a[80:83], v[32:35]
s_nop 0
ds_read_b64_tr_b16 v[144:145], v8 offset:53248
ds_read_b64_tr_b16 v[146:147], v8 offset:55296
v_mfma_f32_16x16x32_bf16 v[36:39], v[196:199], a[80:83], v[36:39]
buffer_load_dwordx4 v[104:107], v1, s[44:47], s79 offen offset:2048 sc1
v_mfma_f32_16x16x32_bf16 v[36:39], v[212:215], a[84:87], v[36:39]
s_nop 0
ds_read_b64_tr_b16 v[148:149], v9 offset:53248
ds_read_b64_tr_b16 v[150:151], v9 offset:55296
v_mfma_f32_16x16x32_bf16 v[36:39], v[228:231], a[88:91], v[36:39]
v_and_b32 v72, 0xffff0000, v72
v_mul_f32 v56, v56, v113
v_mfma_f32_16x16x32_bf16 v[36:39], v[244:247], a[92:95], v[36:39]
s_nop 0
ds_read_b64_tr_b16 v[152:153], v10 offset:53248
ds_read_b64_tr_b16 v[154:155], v10 offset:55296
v_mfma_f32_16x16x32_bf16 v[20:23], v[244:247], a[76:79], v[20:23]
s_nop 0
ds_read_b64_tr_b16 v[156:157], v11 offset:53248
ds_read_b64_tr_b16 v[158:159], v11 offset:55296
v_mfma_f32_16x16x32_bf16 v[20:23], v[228:231], a[72:75], v[20:23]
buffer_load_dwordx4 v[108:111], v1, s[44:47], s79 offen offset:3072 sc1
v_mfma_f32_16x16x32_bf16 v[20:23], v[212:215], a[68:71], v[20:23]
v_mul_f32 v114, v114, v113
v_mul_f32 v56, v56, v115
v_mfma_f32_16x16x32_bf16 v[20:23], v[196:199], a[64:67], v[20:23]
s_nop 0
ds_read_b64_tr_b16 v[160:161], v8 offset:57344
ds_read_b64_tr_b16 v[162:163], v8 offset:59392
v_mfma_f32_16x16x32_bf16 v[24:27], v[200:203], a[64:67], v[24:27]
s_nop 0
ds_read_b64_tr_b16 v[164:165], v9 offset:57344
ds_read_b64_tr_b16 v[166:167], v9 offset:59392
v_mfma_f32_16x16x32_bf16 v[24:27], v[216:219], a[68:71], v[24:27]
v_mul_f32 v72, v72, v114
v_and_b32 v114, 0xffff0000, v57
v_mfma_f32_16x16x32_bf16 v[24:27], v[232:235], a[72:75], v[24:27]
s_nop 0
ds_read_b64_tr_b16 v[168:169], v10 offset:57344
ds_read_b64_tr_b16 v[170:171], v10 offset:59392
v_mfma_f32_16x16x32_bf16 v[24:27], v[248:251], a[76:79], v[24:27]
s_nop 0
ds_read_b64_tr_b16 v[172:173], v11 offset:57344
ds_read_b64_tr_b16 v[174:175], v11 offset:59392
v_mfma_f32_16x16x32_bf16 v[40:43], v[248:251], a[92:95], v[40:43]
v_lshlrev_b32 v115, 16, v73
v_lshlrev_b32 v57, 16, v57
v_mfma_f32_16x16x32_bf16 v[40:43], v[232:235], a[88:91], v[40:43]
s_nop 0
ds_read_b64_tr_b16 v[176:177], v8 offset:61440
ds_read_b64_tr_b16 v[178:179], v8 offset:63488
v_mfma_f32_16x16x32_bf16 v[40:43], v[216:219], a[84:87], v[40:43]
s_nop 0
ds_read_b64_tr_b16 v[180:181], v9 offset:61440
ds_read_b64_tr_b16 v[182:183], v9 offset:63488
v_mfma_f32_16x16x32_bf16 v[40:43], v[200:203], a[80:83], v[40:43]
v_and_b32 v73, 0xffff0000, v73
v_mul_f32 v57, v57, v113
v_mfma_f32_16x16x32_bf16 v[44:47], v[204:207], a[80:83], v[44:47]
s_nop 0
ds_read_b64_tr_b16 v[184:185], v10 offset:61440
ds_read_b64_tr_b16 v[186:187], v10 offset:63488
v_mfma_f32_16x16x32_bf16 v[44:47], v[220:223], a[84:87], v[44:47]
s_nop 0
ds_read_b64_tr_b16 v[188:189], v11 offset:61440
ds_read_b64_tr_b16 v[190:191], v11 offset:63488
v_mfma_f32_16x16x32_bf16 v[44:47], v[236:239], a[88:91], v[44:47]
v_mul_f32 v114, v114, v113
v_mul_f32 v57, v57, v115
v_mfma_f32_16x16x32_bf16 v[44:47], v[252:255], a[92:95], v[44:47]
v_mul_f32 v73, v73, v114
v_and_b32 v114, 0xffff0000, v58
v_mfma_f32_16x16x32_bf16 v[28:31], v[252:255], a[76:79], v[28:31]
v_xor_b32 v8, 0x10000, v8
v_lshlrev_b32 v115, 16, v74
v_mfma_f32_16x16x32_bf16 v[28:31], v[236:239], a[72:75], v[28:31]
v_xor_b32 v9, 0x10000, v9
v_lshlrev_b32 v58, 16, v58
v_mfma_f32_16x16x32_bf16 v[28:31], v[220:223], a[68:71], v[28:31]
s_waitcnt lgkmcnt(0)
v_xor_b32 v10, 0x10000, v10
v_and_b32 v74, 0xffff0000, v74
v_mfma_f32_16x16x32_bf16 v[28:31], v[204:207], a[64:67], v[28:31]
v_xor_b32 v11, 0x10000, v11
v_mul_f32 v58, v58, v113
v_mfma_f32_16x16x32_bf16 v[16:19], v[128:131], a[96:99], v[16:19]
s_nop 0
ds_read_b64_tr_b16 v[192:193], v8 offset:0
ds_read_b64_tr_b16 v[194:195], v8 offset:2048
v_mfma_f32_16x16x32_bf16 v[16:19], v[144:147], a[100:103], v[16:19]
s_nop 0
ds_read_b64_tr_b16 v[196:197], v9 offset:0
ds_read_b64_tr_b16 v[198:199], v9 offset:2048
v_mfma_f32_16x16x32_bf16 v[16:19], v[160:163], a[104:107], v[16:19]
v_mul_f32 v114, v114, v113
v_mul_f32 v58, v58, v115
v_mfma_f32_16x16x32_bf16 v[16:19], v[176:179], a[108:111], v[16:19]
s_nop 0
ds_read_b64_tr_b16 v[200:201], v10 offset:0
ds_read_b64_tr_b16 v[202:203], v10 offset:2048
v_mfma_f32_16x16x32_bf16 v[32:35], v[176:179], a[124:127], v[32:35]
v_mul_f32 v74, v74, v114
v_and_b32 v114, 0xffff0000, v59
v_mfma_f32_16x16x32_bf16 v[32:35], v[160:163], a[120:123], v[32:35]
s_nop 0
ds_read_b64_tr_b16 v[204:205], v11 offset:0
ds_read_b64_tr_b16 v[206:207], v11 offset:2048
v_mfma_f32_16x16x32_bf16 v[32:35], v[144:147], a[116:119], v[32:35]
s_nop 0
ds_read_b64_tr_b16 v[208:209], v8 offset:4096
ds_read_b64_tr_b16 v[210:211], v8 offset:6144
v_mfma_f32_16x16x32_bf16 v[32:35], v[128:131], a[112:115], v[32:35]
v_lshlrev_b32 v115, 16, v75
v_lshlrev_b32 v59, 16, v59
v_mfma_f32_16x16x32_bf16 v[36:39], v[132:135], a[112:115], v[36:39]
s_nop 0
ds_read_b64_tr_b16 v[212:213], v9 offset:4096
ds_read_b64_tr_b16 v[214:215], v9 offset:6144
v_mfma_f32_16x16x32_bf16 v[36:39], v[148:151], a[116:119], v[36:39]
v_and_b32 v75, 0xffff0000, v75
v_mul_f32 v59, v59, v113
v_mfma_f32_16x16x32_bf16 v[36:39], v[164:167], a[120:123], v[36:39]
s_nop 0
ds_read_b64_tr_b16 v[216:217], v10 offset:4096
ds_read_b64_tr_b16 v[218:219], v10 offset:6144
v_mfma_f32_16x16x32_bf16 v[36:39], v[180:183], a[124:127], v[36:39]
s_nop 0
ds_read_b64_tr_b16 v[220:221], v11 offset:4096
ds_read_b64_tr_b16 v[222:223], v11 offset:6144
v_mfma_f32_16x16x32_bf16 v[20:23], v[180:183], a[108:111], v[20:23]
v_mul_f32 v114, v114, v113
v_mul_f32 v59, v59, v115
v_mfma_f32_16x16x32_bf16 v[20:23], v[164:167], a[104:107], v[20:23]
s_nop 0
ds_read_b64_tr_b16 v[224:225], v8 offset:8192
ds_read_b64_tr_b16 v[226:227], v8 offset:10240
v_mfma_f32_16x16x32_bf16 v[20:23], v[148:151], a[100:103], v[20:23]
v_mul_f32 v75, v75, v114
v_and_b32 v114, 0xffff0000, v60
v_mfma_f32_16x16x32_bf16 v[20:23], v[132:135], a[96:99], v[20:23]
s_nop 0
ds_read_b64_tr_b16 v[228:229], v9 offset:8192
ds_read_b64_tr_b16 v[230:231], v9 offset:10240
v_mfma_f32_16x16x32_bf16 v[24:27], v[136:139], a[96:99], v[24:27]
s_nop 0
ds_read_b64_tr_b16 v[232:233], v10 offset:8192
ds_read_b64_tr_b16 v[234:235], v10 offset:10240
v_mfma_f32_16x16x32_bf16 v[24:27], v[152:155], a[100:103], v[24:27]
v_lshlrev_b32 v115, 16, v76
v_lshlrev_b32 v60, 16, v60
v_mfma_f32_16x16x32_bf16 v[24:27], v[168:171], a[104:107], v[24:27]
s_nop 0
ds_read_b64_tr_b16 v[236:237], v11 offset:8192
ds_read_b64_tr_b16 v[238:239], v11 offset:10240
v_mfma_f32_16x16x32_bf16 v[24:27], v[184:187], a[108:111], v[24:27]
v_and_b32 v76, 0xffff0000, v76
v_mul_f32 v60, v60, v113
v_mfma_f32_16x16x32_bf16 v[40:43], v[184:187], a[124:127], v[40:43]
s_nop 0
ds_read_b64_tr_b16 v[240:241], v8 offset:12288
ds_read_b64_tr_b16 v[242:243], v8 offset:14336
v_mfma_f32_16x16x32_bf16 v[40:43], v[168:171], a[120:123], v[40:43]
s_nop 0
ds_read_b64_tr_b16 v[244:245], v9 offset:12288
ds_read_b64_tr_b16 v[246:247], v9 offset:14336
v_mfma_f32_16x16x32_bf16 v[40:43], v[152:155], a[116:119], v[40:43]
v_mul_f32 v114, v114, v113
v_mul_f32 v60, v60, v115
v_mfma_f32_16x16x32_bf16 v[40:43], v[136:139], a[112:115], v[40:43]
s_nop 0
ds_read_b64_tr_b16 v[248:249], v10 offset:12288
ds_read_b64_tr_b16 v[250:251], v10 offset:14336
v_mfma_f32_16x16x32_bf16 v[44:47], v[140:143], a[112:115], v[44:47]
v_mul_f32 v76, v76, v114
v_and_b32 v114, 0xffff0000, v61
v_mfma_f32_16x16x32_bf16 v[44:47], v[156:159], a[116:119], v[44:47]
s_nop 0
ds_read_b64_tr_b16 v[252:253], v11 offset:12288
ds_read_b64_tr_b16 v[254:255], v11 offset:14336
v_mfma_f32_16x16x32_bf16 v[44:47], v[172:175], a[120:123], v[44:47]
v_lshlrev_b32 v115, 16, v77
v_lshlrev_b32 v61, 16, v61
v_mfma_f32_16x16x32_bf16 v[44:47], v[188:191], a[124:127], v[44:47]
s_waitcnt vmcnt(0)
v_max3_u32 v12, v96, v97, v98
v_max3_u32 v13, v99, v100, v101
v_mfma_f32_16x16x32_bf16 v[28:31], v[188:191], a[108:111], v[28:31]
v_max3_u32 v12, v12, v102, v103
v_max3_u32 v13, v13, v104, v105
v_mfma_f32_16x16x32_bf16 v[28:31], v[172:175], a[104:107], v[28:31]
v_max3_u32 v12, v12, v106, v107
v_max3_u32 v13, v13, v108, v109
v_mfma_f32_16x16x32_bf16 v[28:31], v[156:159], a[100:103], v[28:31]
s_waitcnt vmcnt(12) lgkmcnt(0)
v_max3_u32 v12, v12, v110, v111
v_and_b32 v77, 0xffff0000, v77
v_mfma_f32_16x16x32_bf16 v[28:31], v[140:143], a[96:99], v[28:31]
s_barrier
v_max_u32 v12, v12, v13
v_mul_f32 v61, v61, v113
v_mfma_f32_16x16x32_bf16 v[16:19], v[192:195], a[128:131], v[16:19]
v_cmp_le_u32 vcc, 0xff800000, v12
v_mul_f32 v114, v114, v113
v_mfma_f32_16x16x32_bf16 v[16:19], v[208:211], a[132:135], v[16:19]
s_nop 0
ds_read_b64_tr_b16 v[128:129], v8 offset:16384
ds_read_b64_tr_b16 v[130:131], v8 offset:18432
v_mfma_f32_16x16x32_bf16 v[16:19], v[224:227], a[136:139], v[16:19]
s_cbranch_vccnz Lxspin1
Lxback1:
ds_read_b64_tr_b16 v[132:133], v9 offset:16384
ds_read_b64_tr_b16 v[134:135], v9 offset:18432
v_mfma_f32_16x16x32_bf16 v[16:19], v[240:243], a[140:143], v[16:19]
v_mul_f32 v61, v61, v115
v_mul_f32 v77, v77, v114
v_mfma_f32_16x16x32_bf16 v[16:19], v[124:127], v[96:99], v[16:19]
s_nop 0
ds_read_b64_tr_b16 v[136:137], v10 offset:16384
ds_read_b64_tr_b16 v[138:139], v10 offset:18432
v_mfma_f32_16x16x32_bf16 v[32:35], v[240:243], a[156:159], v[32:35]
v_and_b32 v114, 0xffff0000, v62
v_lshlrev_b32 v115, 16, v78
v_mfma_f32_16x16x32_bf16 v[32:35], v[224:227], a[152:155], v[32:35]
s_add_u32 s82, s93, 0x3e00000
buffer_load_dwordx4 v[80:83], v1, s[44:47], s82 offen sc1
v_mfma_f32_16x16x32_bf16 v[32:35], v[208:211], a[148:151], v[32:35]
s_nop 0
ds_read_b64_tr_b16 v[140:141], v11 offset:16384
ds_read_b64_tr_b16 v[142:143], v11 offset:18432
v_mfma_f32_16x16x32_bf16 v[32:35], v[192:195], a[144:147], v[32:35]
v_lshlrev_b32 v62, 16, v62
v_and_b32 v78, 0xffff0000, v78
v_mfma_f32_16x16x32_bf16 v[32:35], v[124:127], v[104:107], v[32:35]
s_nop 0
ds_read_b64_tr_b16 v[144:145], v8 offset:20480
ds_read_b64_tr_b16 v[146:147], v8 offset:22528
v_mfma_f32_16x16x32_bf16 v[36:39], v[196:199], a[144:147], v[36:39]
v_mul_f32 v62, v62, v113
v_mul_f32 v114, v114, v113
v_mfma_f32_16x16x32_bf16 v[36:39], v[212:215], a[148:151], v[36:39]
buffer_load_dwordx4 v[84:87], v1, s[44:47], s82 offen offset:1024 sc1
v_mfma_f32_16x16x32_bf16 v[36:39], v[228:231], a[152:155], v[36:39]
s_nop 0
ds_read_b64_tr_b16 v[148:149], v9 offset:20480
ds_read_b64_tr_b16 v[150:151], v9 offset:22528
v_mfma_f32_16x16x32_bf16 v[36:39], v[244:247], a[156:159], v[36:39]
v_mul_f32 v62, v62, v115
v_mul_f32 v78, v78, v114
v_mfma_f32_16x16x32_bf16 v[36:39], v[120:123], v[104:107], v[36:39]
s_nop 0
ds_read_b64_tr_b16 v[152:153], v10 offset:20480
ds_read_b64_tr_b16 v[154:155], v10 offset:22528
v_mfma_f32_16x16x32_bf16 v[20:23], v[244:247], a[140:143], v[20:23]
v_and_b32 v114, 0xffff0000, v63
v_lshlrev_b32 v115, 16, v79
v_mfma_f32_16x16x32_bf16 v[20:23], v[228:231], a[136:139], v[20:23]
buffer_load_dwordx4 v[88:91], v1, s[44:47], s82 offen offset:2048 sc1
v_mfma_f32_16x16x32_bf16 v[20:23], v[212:215], a[132:135], v[20:23]
s_nop 0
ds_read_b64_tr_b16 v[156:157], v11 offset:20480
ds_read_b64_tr_b16 v[158:159], v11 offset:22528
v_mfma_f32_16x16x32_bf16 v[20:23], v[196:199], a[128:131], v[20:23]
v_lshlrev_b32 v63, 16, v63
v_and_b32 v79, 0xffff0000, v79
v_mfma_f32_16x16x32_bf16 v[20:23], v[120:123], v[96:99], v[20:23]
s_nop 0
ds_read_b64_tr_b16 v[160:161], v8 offset:24576
ds_read_b64_tr_b16 v[162:163], v8 offset:26624
v_mfma_f32_16x16x32_bf16 v[24:27], v[200:203], a[128:131], v[24:27]
s_nop 0
ds_read_b64_tr_b16 v[164:165], v9 offset:24576
ds_read_b64_tr_b16 v[166:167], v9 offset:26624
v_mfma_f32_16x16x32_bf16 v[24:27], v[216:219], a[132:135], v[24:27]
buffer_load_dwordx4 v[92:95], v1, s[44:47], s82 offen offset:3072 sc1
v_mfma_f32_16x16x32_bf16 v[24:27], v[232:235], a[136:139], v[24:27]
v_mul_f32 v63, v63, v113
v_mul_f32 v114, v114, v113
v_mfma_f32_16x16x32_bf16 v[24:27], v[248:251], a[140:143], v[24:27]
s_nop 0
ds_read_b64_tr_b16 v[168:169], v10 offset:24576
ds_read_b64_tr_b16 v[170:171], v10 offset:26624
v_mfma_f32_16x16x32_bf16 v[24:27], v[124:127], v[100:103], v[24:27]
v_mul_f32 v63, v63, v115
v_mul_f32 v79, v79, v114
v_mfma_f32_16x16x32_bf16 v[40:43], v[248:251], a[156:159], v[40:43]
s_nop 0
ds_read_b64_tr_b16 v[172:173], v11 offset:24576
ds_read_b64_tr_b16 v[174:175], v11 offset:26624
v_mfma_f32_16x16x32_bf16 v[40:43], v[232:235], a[152:155], v[40:43]
v_mfma_f32_16x16x32_bf16 v[40:43], v[216:219], a[148:151], v[40:43]
s_nop 0
ds_read_b64_tr_b16 v[176:177], v8 offset:28672
ds_read_b64_tr_b16 v[178:179], v8 offset:30720
v_mfma_f32_16x16x32_bf16 v[40:43], v[200:203], a[144:147], v[40:43]
v_mfma_f32_16x16x32_bf16 v[40:43], v[124:127], v[108:111], v[40:43]
s_nop 0
ds_read_b64_tr_b16 v[180:181], v9 offset:28672
ds_read_b64_tr_b16 v[182:183], v9 offset:30720
v_mfma_f32_16x16x32_bf16 v[44:47], v[204:207], a[144:147], v[44:47]
v_mfma_f32_16x16x32_bf16 v[44:47], v[220:223], a[148:151], v[44:47]
s_nop 0
ds_read_b64_tr_b16 v[184:185], v10 offset:28672
ds_read_b64_tr_b16 v[186:187], v10 offset:30720
v_mfma_f32_16x16x32_bf16 v[44:47], v[236:239], a[152:155], v[44:47]
v_mfma_f32_16x16x32_bf16 v[44:47], v[252:255], a[156:159], v[44:47]
s_nop 0
ds_read_b64_tr_b16 v[188:189], v11 offset:28672
ds_read_b64_tr_b16 v[190:191], v11 offset:30720
v_mfma_f32_16x16x32_bf16 v[44:47], v[120:123], v[108:111], v[44:47]
v_mfma_f32_16x16x32_bf16 v[28:31], v[252:255], a[140:143], v[28:31]
v_mfma_f32_16x16x32_bf16 v[28:31], v[236:239], a[136:139], v[28:31]
v_mfma_f32_16x16x32_bf16 v[28:31], v[220:223], a[132:135], v[28:31]
v_mfma_f32_16x16x32_bf16 v[28:31], v[204:207], a[128:131], v[28:31]
s_waitcnt lgkmcnt(0)
v_mfma_f32_16x16x32_bf16 v[28:31], v[120:123], v[100:103], v[28:31]
v_mfma_f32_16x16x32_bf16 v[16:19], v[128:131], a[160:163], v[16:19]
s_nop 0
ds_read_b64_tr_b16 v[192:193], v8 offset:32768
ds_read_b64_tr_b16 v[194:195], v8 offset:34816
v_mfma_f32_16x16x32_bf16 v[16:19], v[144:147], a[164:167], v[16:19]
s_nop 0
ds_read_b64_tr_b16 v[196:197], v9 offset:32768
ds_read_b64_tr_b16 v[198:199], v9 offset:34816
v_mfma_f32_16x16x32_bf16 v[16:19], v[160:163], a[168:171], v[16:19]
s_nop 0
ds_read_b64_tr_b16 v[200:201], v10 offset:32768
ds_read_b64_tr_b16 v[202:203], v10 offset:34816
v_mfma_f32_16x16x32_bf16 v[16:19], v[176:179], a[172:175], v[16:19]
v_mfma_f32_16x16x32_bf16 v[32:35], v[176:179], a[188:191], v[32:35]
s_nop 0
ds_read_b64_tr_b16 v[204:205], v11 offset:32768
ds_read_b64_tr_b16 v[206:207], v11 offset:34816
v_mfma_f32_16x16x32_bf16 v[32:35], v[160:163], a[184:187], v[32:35]
s_nop 0
ds_read_b64_tr_b16 v[208:209], v8 offset:36864
ds_read_b64_tr_b16 v[210:211], v8 offset:38912
v_mfma_f32_16x16x32_bf16 v[32:35], v[144:147], a[180:183], v[32:35]
s_add_u32 s81, s93, 0x4200000
buffer_load_dwordx4 v[96:99], v1, s[44:47], s81 offen sc1
v_mfma_f32_16x16x32_bf16 v[32:35], v[128:131], a[176:179], v[32:35]
v_mfma_f32_16x16x32_bf16 v[36:39], v[132:135], a[176:179], v[36:39]
s_nop 0
ds_read_b64_tr_b16 v[212:213], v9 offset:36864
ds_read_b64_tr_b16 v[214:215], v9 offset:38912
v_mfma_f32_16x16x32_bf16 v[36:39], v[148:151], a[180:183], v[36:39]
s_nop 0
ds_read_b64_tr_b16 v[216:217], v10 offset:36864
ds_read_b64_tr_b16 v[218:219], v10 offset:38912
v_mfma_f32_16x16x32_bf16 v[36:39], v[164:167], a[184:187], v[36:39]
v_mfma_f32_16x16x32_bf16 v[36:39], v[180:183], a[188:191], v[36:39]
buffer_load_dwordx4 v[100:103], v1, s[44:47], s81 offen offset:1024 sc1
v_mfma_f32_16x16x32_bf16 v[20:23], v[180:183], a[172:175], v[20:23]
s_nop 0
ds_read_b64_tr_b16 v[220:221], v11 offset:36864
ds_read_b64_tr_b16 v[222:223], v11 offset:38912
v_mfma_f32_16x16x32_bf16 v[20:23], v[164:167], a[168:171], v[20:23]
s_nop 0
ds_read_b64_tr_b16 v[224:225], v8 offset:40960
ds_read_b64_tr_b16 v[226:227], v8 offset:43008
v_mfma_f32_16x16x32_bf16 v[20:23], v[148:151], a[164:167], v[20:23]
s_nop 0
ds_read_b64_tr_b16 v[228:229], v9 offset:40960
ds_read_b64_tr_b16 v[230:231], v9 offset:43008
v_mfma_f32_16x16x32_bf16 v[20:23], v[132:135], a[160:163], v[20:23]
v_mfma_f32_16x16x32_bf16 v[24:27], v[136:139], a[160:163], v[24:27]
buffer_load_dwordx4 v[104:107], v1, s[44:47], s81 offen offset:2048 sc1
v_mfma_f32_16x16x32_bf16 v[24:27], v[152:155], a[164:167], v[24:27]
s_nop 0
ds_read_b64_tr_b16 v[232:233], v10 offset:40960
ds_read_b64_tr_b16 v[234:235], v10 offset:43008
v_mfma_f32_16x16x32_bf16 v[24:27], v[168:171], a[168:171], v[24:27]
s_nop 0
ds_read_b64_tr_b16 v[236:237], v11 offset:40960
ds_read_b64_tr_b16 v[238:239], v11 offset:43008
v_mfma_f32_16x16x32_bf16 v[24:27], v[184:187], a[172:175], v[24:27]
v_mfma_f32_16x16x32_bf16 v[40:43], v[184:187], a[188:191], v[40:43]
s_nop 0
ds_read_b64_tr_b16 v[240:241], v8 offset:45056
ds_read_b64_tr_b16 v[242:243], v8 offset:47104
v_mfma_f32_16x16x32_bf16 v[40:43], v[168:171], a[184:187], v[40:43]
buffer_load_dwordx4 v[108:111], v1, s[44:47], s81 offen offset:3072 sc1
v_mfma_f32_16x16x32_bf16 v[40:43], v[152:155], a[180:183], v[40:43]
s_nop 0
ds_read_b64_tr_b16 v[244:245], v9 offset:45056
ds_read_b64_tr_b16 v[246:247], v9 offset:47104
v_mfma_f32_16x16x32_bf16 v[40:43], v[136:139], a[176:179], v[40:43]
v_mfma_f32_16x16x32_bf16 v[44:47], v[140:143], a[176:179], v[44:47]
s_nop 0
ds_read_b64_tr_b16 v[248:249], v10 offset:45056
ds_read_b64_tr_b16 v[250:251], v10 offset:47104
v_mfma_f32_16x16x32_bf16 v[44:47], v[156:159], a[180:183], v[44:47]
s_nop 0
ds_read_b64_tr_b16 v[252:253], v11 offset:45056
ds_read_b64_tr_b16 v[254:255], v11 offset:47104
v_mfma_f32_16x16x32_bf16 v[44:47], v[172:175], a[184:187], v[44:47]
v_mfma_f32_16x16x32_bf16 v[44:47], v[188:191], a[188:191], v[44:47]
s_waitcnt vmcnt(4)
v_max3_u32 v12, v80, v81, v82
v_max3_u32 v13, v83, v84, v85
v_mfma_f32_16x16x32_bf16 v[28:31], v[188:191], a[172:175], v[28:31]
v_max3_u32 v12, v12, v86, v87
v_max3_u32 v13, v13, v88, v89
v_mfma_f32_16x16x32_bf16 v[28:31], v[172:175], a[168:171], v[28:31]
v_max3_u32 v12, v12, v90, v91
v_max3_u32 v13, v13, v92, v93
v_mfma_f32_16x16x32_bf16 v[28:31], v[156:159], a[164:167], v[28:31]
s_waitcnt vmcnt(14) lgkmcnt(0)
v_max3_u32 v12, v12, v94, v95
v_mfma_f32_16x16x32_bf16 v[28:31], v[140:143], a[160:163], v[28:31]
s_barrier
v_max_u32 v12, v12, v13
v_mfma_f32_16x16x32_bf16 v[16:19], v[192:195], a[192:195], v[16:19]
v_cmp_le_u32 vcc, 0xff800000, v12
v_mfma_f32_16x16x32_bf16 v[16:19], v[208:211], a[196:199], v[16:19]
s_nop 0
ds_read_b64_tr_b16 v[128:129], v8 offset:49152
ds_read_b64_tr_b16 v[130:131], v8 offset:51200
v_mfma_f32_16x16x32_bf16 v[16:19], v[224:227], a[200:203], v[16:19]
s_cbranch_vccnz Lxspin2
Lxback2:
v_mfma_f32_16x16x32_bf16 v[16:19], v[240:243], a[204:207], v[16:19]
s_nop 0
ds_read_b64_tr_b16 v[132:133], v9 offset:49152
ds_read_b64_tr_b16 v[134:135], v9 offset:51200
v_mfma_f32_16x16x32_bf16 v[16:19], v[124:127], v[80:83], v[16:19]
v_mfma_f32_16x16x32_bf16 v[32:35], v[240:243], a[220:223], v[32:35]
s_nop 0
ds_read_b64_tr_b16 v[136:137], v10 offset:49152
ds_read_b64_tr_b16 v[138:139], v10 offset:51200
v_mfma_f32_16x16x32_bf16 v[32:35], v[224:227], a[216:219], v[32:35]
v_mfma_f32_16x16x32_bf16 v[32:35], v[208:211], a[212:215], v[32:35]
s_nop 0
ds_read_b64_tr_b16 v[140:141], v11 offset:49152
ds_read_b64_tr_b16 v[142:143], v11 offset:51200
v_mfma_f32_16x16x32_bf16 v[32:35], v[192:195], a[208:211], v[32:35]
v_mfma_f32_16x16x32_bf16 v[32:35], v[124:127], v[88:91], v[32:35]
s_nop 0
ds_read_b64_tr_b16 v[144:145], v8 offset:53248
ds_read_b64_tr_b16 v[146:147], v8 offset:55296
v_mfma_f32_16x16x32_bf16 v[36:39], v[196:199], a[208:211], v[36:39]
v_mfma_f32_16x16x32_bf16 v[36:39], v[212:215], a[212:215], v[36:39]
s_nop 0
ds_read_b64_tr_b16 v[148:149], v9 offset:53248
ds_read_b64_tr_b16 v[150:151], v9 offset:55296
v_mfma_f32_16x16x32_bf16 v[36:39], v[228:231], a[216:219], v[36:39]
v_mfma_f32_16x16x32_bf16 v[36:39], v[244:247], a[220:223], v[36:39]
s_nop 0
ds_read_b64_tr_b16 v[152:153], v10 offset:53248
ds_read_b64_tr_b16 v[154:155], v10 offset:55296
v_mfma_f32_16x16x32_bf16 v[36:39], v[120:123], v[88:91], v[36:39]
v_mfma_f32_16x16x32_bf16 v[20:23], v[244:247], a[204:207], v[20:23]
s_nop 0
ds_read_b64_tr_b16 v[156:157], v11 offset:53248
ds_read_b64_tr_b16 v[158:159], v11 offset:55296
v_mfma_f32_16x16x32_bf16 v[20:23], v[228:231], a[200:203], v[20:23]
v_mfma_f32_16x16x32_bf16 v[20:23], v[212:215], a[196:199], v[20:23]
v_mfma_f32_16x16x32_bf16 v[20:23], v[196:199], a[192:195], v[20:23]
s_nop 0
ds_read_b64_tr_b16 v[160:161], v8 offset:57344
ds_read_b64_tr_b16 v[162:163], v8 offset:59392
v_mfma_f32_16x16x32_bf16 v[20:23], v[120:123], v[80:83], v[20:23]
Lstube5:
s_cbranch_execz Lrete
v_mfma_f32_16x16x32_bf16 v[24:27], v[200:203], a[192:195], v[24:27]
s_nop 0
ds_read_b64_tr_b16 v[164:165], v9 offset:57344
ds_read_b64_tr_b16 v[166:167], v9 offset:59392
v_mfma_f32_16x16x32_bf16 v[24:27], v[216:219], a[196:199], v[24:27]
v_mfma_f32_16x16x32_bf16 v[24:27], v[232:235], a[200:203], v[24:27]
s_nop 0
ds_read_b64_tr_b16 v[168:169], v10 offset:57344
ds_read_b64_tr_b16 v[170:171], v10 offset:59392
v_mfma_f32_16x16x32_bf16 v[24:27], v[248:251], a[204:207], v[24:27]
v_mfma_f32_16x16x32_bf16 v[24:27], v[124:127], v[84:87], v[24:27]
s_nop 0
ds_read_b64_tr_b16 v[172:173], v11 offset:57344
ds_read_b64_tr_b16 v[174:175], v11 offset:59392
v_mfma_f32_16x16x32_bf16 v[40:43], v[248:251], a[220:223], v[40:43]
v_mfma_f32_16x16x32_bf16 v[40:43], v[232:235], a[216:219], v[40:43]
s_nop 0
ds_read_b64_tr_b16 v[176:177], v8 offset:61440
ds_read_b64_tr_b16 v[178:179], v8 offset:63488
v_mfma_f32_16x16x32_bf16 v[40:43], v[216:219], a[212:215], v[40:43]
v_mfma_f32_16x16x32_bf16 v[40:43], v[200:203], a[208:211], v[40:43]
s_nop 0
ds_read_b64_tr_b16 v[180:181], v9 offset:61440
ds_read_b64_tr_b16 v[182:183], v9 offset:63488
v_mfma_f32_16x16x32_bf16 v[40:43], v[124:127], v[92:95], v[40:43]
v_mfma_f32_16x16x32_bf16 v[44:47], v[204:207], a[208:211], v[44:47]
s_nop 0
ds_read_b64_tr_b16 v[184:185], v10 offset:61440
ds_read_b64_tr_b16 v[186:187], v10 offset:63488
v_mfma_f32_16x16x32_bf16 v[44:47], v[220:223], a[212:215], v[44:47]
v_mfma_f32_16x16x32_bf16 v[44:47], v[236:239], a[216:219], v[44:47]
s_nop 0
ds_read_b64_tr_b16 v[188:189], v11 offset:61440
ds_read_b64_tr_b16 v[190:191], v11 offset:63488
v_mfma_f32_16x16x32_bf16 v[44:47], v[252:255], a[220:223], v[44:47]
v_mfma_f32_16x16x32_bf16 v[44:47], v[120:123], v[92:95], v[44:47]
v_mfma_f32_16x16x32_bf16 v[28:31], v[252:255], a[204:207], v[28:31]
s_waitcnt vmcnt(0)
v_max3_u32 v12, v96, v97, v98
v_max3_u32 v13, v99, v100, v101
v_mfma_f32_16x16x32_bf16 v[28:31], v[236:239], a[200:203], v[28:31]
v_max3_u32 v12, v12, v102, v103
v_max3_u32 v13, v13, v104, v105
v_mfma_f32_16x16x32_bf16 v[28:31], v[220:223], a[196:199], v[28:31]
v_max3_u32 v12, v12, v106, v107
v_max3_u32 v13, v13, v108, v109
v_mfma_f32_16x16x32_bf16 v[28:31], v[204:207], a[192:195], v[28:31]
s_waitcnt lgkmcnt(0)
v_max3_u32 v12, v12, v110, v111
v_mfma_f32_16x16x32_bf16 v[28:31], v[120:123], v[84:87], v[28:31]
v_max_u32 v12, v12, v13
v_mfma_f32_16x16x32_bf16 v[16:19], v[128:131], a[224:227], v[16:19]
v_cmp_le_u32 vcc, 0xff800000, v12
v_mfma_f32_16x16x32_bf16 v[16:19], v[144:147], a[228:231], v[16:19]
v_mfma_f32_16x16x32_bf16 v[16:19], v[160:163], a[232:235], v[16:19]
s_cbranch_vccnz Lxspin3
Lxback3:
v_mfma_f32_16x16x32_bf16 v[16:19], v[176:179], a[236:239], v[16:19]
v_mfma_f32_16x16x32_bf16 v[16:19], v[124:127], v[96:99], v[16:19]
v_mfma_f32_16x16x32_bf16 v[20:23], v[180:183], a[236:239], v[20:23]
v_mfma_f32_16x16x32_bf16 v[20:23], v[164:167], a[232:235], v[20:23]
v_mfma_f32_16x16x32_bf16 v[20:23], v[148:151], a[228:231], v[20:23]
v_mfma_f32_16x16x32_bf16 v[20:23], v[132:135], a[224:227], v[20:23]
s_nop 3
v_fma_f32 v16, v16, v6, v48
v_fma_f32 v17, v17, v6, v64
v_mfma_f32_16x16x32_bf16 v[20:23], v[120:123], v[96:99], v[20:23]
v_fma_f32 v18, v18, v6, v49
v_fma_f32 v19, v19, v6, v65
v_mfma_f32_16x16x32_bf16 v[24:27], v[136:139], a[224:227], v[24:27]
v_cvt_pk_bf16_f32 v16, v16, v17
v_cvt_pk_bf16_f32 v17, v18, v19
v_mfma_f32_16x16x32_bf16 v[24:27], v[152:155], a[228:231], v[24:27]
ds_write_b64 v116, v[16:17] offset:0
v_mfma_f32_16x16x32_bf16 v[24:27], v[168:171], a[232:235], v[24:27]
v_mfma_f32_16x16x32_bf16 v[24:27], v[184:187], a[236:239], v[24:27]
v_fma_f32 v20, v20, v6, v50
v_fma_f32 v21, v21, v6, v66
v_mfma_f32_16x16x32_bf16 v[24:27], v[124:127], v[100:103], v[24:27]
v_fma_f32 v22, v22, v6, v51
v_fma_f32 v23, v23, v6, v67
v_mfma_f32_16x16x32_bf16 v[28:31], v[188:191], a[236:239], v[28:31]
v_cvt_pk_bf16_f32 v20, v20, v21
v_cvt_pk_bf16_f32 v21, v22, v23
v_mfma_f32_16x16x32_bf16 v[28:31], v[172:175], a[232:235], v[28:31]
ds_write_b64 v117, v[20:21] offset:0
v_mfma_f32_16x16x32_bf16 v[28:31], v[156:159], a[228:231], v[28:31]
v_mfma_f32_16x16x32_bf16 v[28:31], v[140:143], a[224:227], v[28:31]
v_fma_f32 v24, v24, v6, v52
v_fma_f32 v25, v25, v6, v68
v_mfma_f32_16x16x32_bf16 v[28:31], v[120:123], v[100:103], v[28:31]
v_fma_f32 v26, v26, v6, v53
v_fma_f32 v27, v27, v6, v69
v_mfma_f32_16x16x32_bf16 v[32:35], v[128:131], a[240:243], v[32:35]
v_cvt_pk_bf16_f32 v24, v24, v25
v_cvt_pk_bf16_f32 v25, v26, v27
v_mfma_f32_16x16x32_bf16 v[32:35], v[144:147], a[244:247], v[32:35]
ds_write_b64 v118, v[24:25] offset:0
v_mfma_f32_16x16x32_bf16 v[32:35], v[160:163], a[248:251], v[32:35]
v_mfma_f32_16x16x32_bf16 v[32:35], v[176:179], a[252:255], v[32:35]
v_fma_f32 v28, v28, v6, v54
v_fma_f32 v29, v29, v6, v70
v_mfma_f32_16x16x32_bf16 v[32:35], v[124:127], v[104:107], v[32:35]
v_fma_f32 v30, v30, v6, v55
v_fma_f32 v31, v31, v6, v71
v_mfma_f32_16x16x32_bf16 v[36:39], v[180:183], a[252:255], v[36:39]
v_cvt_pk_bf16_f32 v28, v28, v29
v_cvt_pk_bf16_f32 v29, v30, v31
v_mfma_f32_16x16x32_bf16 v[36:39], v[164:167], a[248:251], v[36:39]
s_nop 0
ds_write_b64 v119, v[28:29] offset:0
ds_read_b128 v[192:195], v4 offset:0
v_mfma_f32_16x16x32_bf16 v[36:39], v[148:151], a[244:247], v[36:39]
ds_read_b128 v[196:199], v4 offset:1024
v_mfma_f32_16x16x32_bf16 v[36:39], v[132:135], a[240:243], v[36:39]
v_fma_f32 v32, v32, v7, v56
v_fma_f32 v33, v33, v7, v72
v_mfma_f32_16x16x32_bf16 v[36:39], v[120:123], v[104:107], v[36:39]
v_fma_f32 v34, v34, v7, v57
v_fma_f32 v35, v35, v7, v73
v_mfma_f32_16x16x32_bf16 v[40:43], v[136:139], a[240:243], v[40:43]
v_cvt_pk_bf16_f32 v32, v32, v33
v_cvt_pk_bf16_f32 v33, v34, v35
v_mfma_f32_16x16x32_bf16 v[40:43], v[152:155], a[244:247], v[40:43]
ds_write_b64 v116, v[32:33] offset:2048
v_mfma_f32_16x16x32_bf16 v[40:43], v[168:171], a[248:251], v[40:43]
s_waitcnt lgkmcnt(2)
buffer_store_dwordx4 v[192:195], v15, s[40:43], s70 offen sc1
v_mfma_f32_16x16x32_bf16 v[40:43], v[184:187], a[252:255], v[40:43]
s_add_u32 s70, s70, 0x4000
v_mfma_f32_16x16x32_bf16 v[40:43], v[124:127], v[108:111], v[40:43]
v_fma_f32 v36, v36, v7, v58
v_fma_f32 v37, v37, v7, v74
v_mfma_f32_16x16x32_bf16 v[44:47], v[188:191], a[252:255], v[44:47]
v_fma_f32 v38, v38, v7, v59
v_fma_f32 v39, v39, v7, v75
v_mfma_f32_16x16x32_bf16 v[44:47], v[172:175], a[248:251], v[44:47]
v_cvt_pk_bf16_f32 v36, v36, v37
v_cvt_pk_bf16_f32 v37, v38, v39
v_mfma_f32_16x16x32_bf16 v[44:47], v[156:159], a[244:247], v[44:47]
ds_write_b64 v117, v[36:37] offset:2048
v_mfma_f32_16x16x32_bf16 v[44:47], v[140:143], a[240:243], v[44:47]
v_fma_f32 v40, v40, v7, v60
v_fma_f32 v41, v41, v7, v76
v_mfma_f32_16x16x32_bf16 v[44:47], v[120:123], v[108:111], v[44:47]
v_fma_f32 v42, v42, v7, v61
v_fma_f32 v43, v43, v7, v77
v_cvt_pk_bf16_f32 v40, v40, v41
v_cvt_pk_bf16_f32 v41, v42, v43
ds_write_b64 v118, v[40:41] offset:2048
s_waitcnt lgkmcnt(3)
buffer_store_dwordx4 v[196:199], v15, s[40:43], s70 offen sc1
s_add_u32 s70, s70, 0x4000
v_fma_f32 v44, v44, v7, v62
v_fma_f32 v45, v45, v7, v78
v_fma_f32 v46, v46, v7, v63
v_fma_f32 v47, v47, v7, v79
v_cvt_pk_bf16_f32 v44, v44, v45
v_cvt_pk_bf16_f32 v45, v46, v47
ds_write_b64 v119, v[44:45] offset:2048
ds_read_b128 v[200:203], v4 offset:2048
ds_read_b128 v[204:207], v4 offset:3072
s_waitcnt lgkmcnt(1)
buffer_store_dwordx4 v[200:203], v15, s[40:43], s70 offen sc1
s_add_u32 s70, s70, 0x4000
s_waitcnt lgkmcnt(0)
buffer_store_dwordx4 v[204:207], v15, s[40:43], s70 offen sc1
s_add_u32 s70, s70, 0x4000
Lend:
s_endpgm
Lspin1:
s_mov_b32 s83, 262144
Lsl3:
s_sleep 2
buffer_load_dword v3, v2, s[48:51], 0 offen sc1
s_sub_u32 s83, s83, 1
s_cmp_eq_u32 s83, 0
s_waitcnt vmcnt(0)
s_cbranch_scc1 Lback2
v_cmp_gt_u32 vcc, 8, v3
s_cbranch_vccnz Lsl3
s_branch Lback2
Lspin4:
s_mov_b32 s83, 262144
Lsl6:
s_sleep 2
buffer_load_dword v3, v2, s[44:47], s75 offen sc1
s_sub_u32 s83, s83, 1
s_cmp_eq_u32 s83, 0
s_waitcnt vmcnt(0)
s_cbranch_scc1 Lback5
v_cmp_gt_u32 vcc, 1, v3
s_cbranch_vccnz Lsl6
s_branch Lback5
.p2align 12
s_endpgm
.p2align 7
LP0x:
Lstub10:
s_cbranch_execz Lret
s_cmp_eq_u32 s58, 2
s_cbranch_scc1 Lta10
s_cmp_eq_u32 s58, 3
s_cbranch_scc1 Lnt11
v_mfma_f32_16x16x32_bf16 v[160:163], a[160:163], v[16:19], v[112:115]
s_xor_b32 s74, s82, 0x10000
v_exp_f32 v128, v128
v_mfma_f32_16x16x32_bf16 v[176:179], a[176:179], v[16:19], v[112:115]
s_add_u32 s74, s74, s64
ds_read_b128 a[128:131], v2 offset:16384
ds_read_b128 a[132:135], v2 offset:17408
s_branch Ljoin12
Lta10:
v_mfma_f32_16x16x32_bf16 v[160:163], a[160:163], v[16:19], v[96:99]
s_xor_b32 s74, s82, 0x10000
v_exp_f32 v128, v128
v_mfma_f32_16x16x32_bf16 v[176:179], a[176:179], v[16:19], v[112:115]
s_add_u32 s74, s74, s64
ds_read_b128 a[128:131], v2 offset:16384
ds_read_b128 a[132:135], v2 offset:17408
s_branch Ljoin12
Lnt11:
v_mfma_f32_16x16x32_bf16 v[160:163], a[160:163], v[16:19], v[80:83]
s_xor_b32 s74, s82, 0x10000
v_exp_f32 v128, v128
v_mfma_f32_16x16x32_bf16 v[176:179], a[176:179], v[16:19], v[96:99]
s_add_u32 s74, s74, s64
ds_read_b128 a[128:131], v2 offset:16384
ds_read_b128 a[132:135], v2 offset:17408
Ljoin12:
v_mfma_f32_16x16x32_bf16 v[164:167], a[160:163], v[32:35], v[84:87]
s_add_u32 s81, s81, 0x8000
v_exp_f32 v129, v129
v_mfma_f32_16x16x32_bf16 v[164:167], a[164:167], v[36:39], v[164:167]
s_add_u32 m0, s74, 16384
v_exp_f32 v130, v130
v_mfma_f32_16x16x32_bf16 v[164:167], a[168:171], v[40:43], v[164:167]
s_add_u32 s72, s81, 16384
v_exp_f32 v131, v131
v_mfma_f32_16x16x32_bf16 v[164:167], a[172:175], v[44:47], v[164:167]
v_exp_f32 v144, v144
v_mfma_f32_16x16x32_bf16 v[172:175], a[172:175], v[76:79], v[92:95]
s_nop 0
ds_read_b128 a[136:139], v2 offset:18432
ds_read_b128 a[140:143], v2 offset:19456
v_mfma_f32_16x16x32_bf16 v[172:175], a[168:171], v[72:75], v[172:175]
s_nop 0
ds_read_b128 a[144:147], v2 offset:20480
ds_read_b128 a[148:151], v2 offset:21504
v_mfma_f32_16x16x32_bf16 v[172:175], a[164:167], v[68:71], v[172:175]
s_nop 0
ds_read_b128 a[152:155], v2 offset:22528
ds_read_b128 a[156:159], v2 offset:23552
v_mfma_f32_16x16x32_bf16 v[172:175], a[160:163], v[64:67], v[172:175]
s_nop 0
ds_read_b128 a[192:195], v2 offset:0
ds_read_b128 a[196:199], v2 offset:1024
v_mfma_f32_16x16x32_bf16 v[188:191], a[176:179], v[64:67], v[92:95]
s_nop 0
ds_read_b128 a[200:203], v2 offset:2048
ds_read_b128 a[204:207], v2 offset:3072
v_mfma_f32_16x16x32_bf16 v[188:191], a[180:183], v[68:71], v[188:191]
s_nop 0
ds_read_b128 a[208:211], v2 offset:4096
ds_read_b128 a[212:215], v2 offset:5120
v_mfma_f32_16x16x32_bf16 v[188:191], a[184:187], v[72:75], v[188:191]
s_nop 0
ds_read_b128 a[216:219], v2 offset:6144
ds_read_b128 a[220:223], v2 offset:7168
v_mfma_f32_16x16x32_bf16 v[188:191], a[188:191], v[76:79], v[188:191]
v_cvt_pk_bf16_f32 v192, v128, v129
v_cvt_pk_bf16_f32 v193, v130, v131
v_mfma_f32_16x16x32_bf16 v[180:183], a[188:191], v[44:47], v[84:87]
buffer_load_dwordx4 v1, s[44:47], s72 offen sc1 lds
v_mfma_f32_16x16x32_bf16 v[180:183], a[184:187], v[40:43], v[180:183]
v_exp_f32 v145, v145
v_mfma_f32_16x16x32_bf16 v[180:183], a[180:183], v[36:39], v[180:183]
v_exp_f32 v146, v146
v_mfma_f32_16x16x32_bf16 v[180:183], a[176:179], v[32:35], v[180:183]
v_exp_f32 v147, v147
v_mfma_f32_16x16x32_bf16 v[160:163], a[164:167], v[20:23], v[160:163]
v_exp_f32 v136, v136
v_mfma_f32_16x16x32_bf16 v[160:163], a[168:171], v[24:27], v[160:163]
v_cvt_pk_bf16_f32 v194, v144, v145
v_cvt_pk_bf16_f32 v195, v146, v147
v_mfma_f32_16x16x32_bf16 v[160:163], a[172:175], v[28:31], v[160:163]
v_exp_f32 v137, v137
v_mfma_f32_16x16x32_bf16 v[168:171], a[172:175], v[60:63], v[88:91]
v_exp_f32 v138, v138
v_mfma_f32_16x16x32_bf16 v[168:171], a[168:171], v[56:59], v[168:171]
v_exp_f32 v139, v139
v_mfma_f32_16x16x32_bf16 v[168:171], a[164:167], v[52:55], v[168:171]
v_exp_f32 v152, v152
v_mfma_f32_16x16x32_bf16 v[168:171], a[160:163], v[48:51], v[168:171]
v_cvt_pk_bf16_f32 v200, v136, v137
v_cvt_pk_bf16_f32 v201, v138, v139
v_mfma_f32_16x16x32_bf16 v[184:187], a[176:179], v[48:51], v[88:91]
buffer_load_dwordx4 v1, s[44:47], s72 offen offset:1024 sc1 lds
v_mfma_f32_16x16x32_bf16 v[184:187], a[180:183], v[52:55], v[184:187]
v_exp_f32 v153, v153
v_mfma_f32_16x16x32_bf16 v[184:187], a[184:187], v[56:59], v[184:187]
v_exp_f32 v154, v154
v_mfma_f32_16x16x32_bf16 v[184:187], a[188:191], v[60:63], v[184:187]
v_exp_f32 v155, v155
v_mfma_f32_16x16x32_bf16 v[176:179], a[188:191], v[28:31], v[176:179]
buffer_load_dwordx4 v1, s[44:47], s72 offen offset:2048 sc1 lds
v_mfma_f32_16x16x32_bf16 v[176:179], a[184:187], v[24:27], v[176:179]
buffer_load_dwordx4 v1, s[44:47], s72 offen offset:3072 sc1 lds
v_mfma_f32_16x16x32_bf16 v[176:179], a[180:183], v[20:23], v[176:179]
s_waitcnt lgkmcnt(4)
v_exp_f32 v132, v132
v_cvt_pk_bf16_f32 v202, v152, v153
v_cvt_pk_bf16_f32 v203, v154, v155
v_exp_f32 v133, v133
v_exp_f32 v134, v134
v_cvt_pk_bf16_f32 v196, v132, v133
v_exp_f32 v135, v135
v_exp_f32 v148, v148
v_cvt_pk_bf16_f32 v197, v134, v135
v_exp_f32 v149, v149
v_exp_f32 v150, v150
v_cvt_pk_bf16_f32 v198, v148, v149
v_exp_f32 v151, v151
v_exp_f32 v140, v140
v_cvt_pk_bf16_f32 v199, v150, v151
v_exp_f32 v141, v141
v_exp_f32 v142, v142
v_cvt_pk_bf16_f32 v204, v140, v141
v_exp_f32 v143, v143
v_exp_f32 v156, v156
v_cvt_pk_bf16_f32 v205, v142, v143
v_exp_f32 v157, v157
v_exp_f32 v158, v158
v_cvt_pk_bf16_f32 v206, v156, v157
v_exp_f32 v159, v159
s_nop 0
v_cvt_pk_bf16_f32 v207, v158, v159
v_mfma_f32_16x16x32_bf16 v[224:227], v[120:123], v[192:195], 0
s_add_u32 s82, s82, 0x8000
ds_read_b128 a[160:163], v2 offset:24576
ds_read_b128 a[164:167], v2 offset:25600
v_mfma_f32_16x16x32_bf16 v[232:235], v[120:123], v[200:203], 0
s_and_b32 s82, s82, 0x1ffff
v_exp_f32 v164, v164
v_mfma_f32_16x16x32_bf16 a[0:3], a[192:195], v[192:195], 0
s_add_u32 m0, s74, 0
v_exp_f32 v165, v165
v_mfma_f32_16x16x32_bf16 a[64:67], a[192:195], v[200:203], 0
s_add_u32 s72, s81, 0
v_exp_f32 v166, v166
v_mfma_f32_16x16x32_bf16 a[68:71], a[196:199], v[200:203], 0
buffer_load_dwordx4 v1, s[44:47], s72 offen sc1 lds
v_mfma_f32_16x16x32_bf16 a[4:7], a[196:199], v[192:195], 0
v_exp_f32 v167, v167
v_mfma_f32_16x16x32_bf16 a[8:11], a[200:203], v[192:195], 0
s_nop 0
ds_read_b128 a[168:171], v2 offset:26624
ds_read_b128 a[172:175], v2 offset:27648
v_mfma_f32_16x16x32_bf16 a[72:75], a[200:203], v[200:203], 0
v_exp_f32 v180, v180
v_mfma_f32_16x16x32_bf16 a[76:79], a[204:207], v[200:203], 0
s_nop 0
ds_read_b128 a[176:179], v2 offset:28672
ds_read_b128 a[180:183], v2 offset:29696
v_mfma_f32_16x16x32_bf16 a[12:15], a[204:207], v[192:195], 0
s_waitcnt lgkmcnt(6)
ds_read_b128 a[184:187], v2 offset:30720
ds_read_b128 a[188:191], v2 offset:31744
v_mfma_f32_16x16x32_bf16 a[16:19], a[208:211], v[192:195], 0
s_nop 0
ds_read_b128 a[224:227], v2 offset:8192
ds_read_b128 a[228:231], v2 offset:9216
v_mfma_f32_16x16x32_bf16 a[80:83], a[208:211], v[200:203], 0
s_nop 0
ds_read_b128 a[232:235], v2 offset:10240
ds_read_b128 a[236:239], v2 offset:11264
v_mfma_f32_16x16x32_bf16 a[84:87], a[212:215], v[200:203], 0
s_nop 0
ds_read_b128 a[240:243], v2 offset:12288
ds_read_b128 a[244:247], v2 offset:13312
v_mfma_f32_16x16x32_bf16 a[20:23], a[212:215], v[192:195], 0
s_nop 0
ds_read_b128 a[248:251], v2 offset:14336
ds_read_b128 a[252:255], v2 offset:15360
v_mfma_f32_16x16x32_bf16 a[24:27], a[216:219], v[192:195], 0
v_cvt_pk_bf16_f32 v212, v164, v165
v_cvt_pk_bf16_f32 v213, v166, v167
v_mfma_f32_16x16x32_bf16 a[88:91], a[216:219], v[200:203], 0
v_exp_f32 v181, v181
v_mfma_f32_16x16x32_bf16 a[92:95], a[220:223], v[200:203], 0
v_exp_f32 v182, v182
v_mfma_f32_16x16x32_bf16 a[28:31], a[220:223], v[192:195], 0
buffer_load_dwordx4 v1, s[44:47], s72 offen offset:1024 sc1 lds
s_cmp_eq_u32 s58, 0
s_cbranch_scc1 Lta13
s_cmp_eq_u32 s58, 1
s_cbranch_scc1 Lnt14
v_mfma_f32_16x16x32_bf16 v[132:135], a[128:131], v[32:35], v[84:87]
v_exp_f32 v183, v183
v_mfma_f32_16x16x32_bf16 v[148:151], a[144:147], v[32:35], v[84:87]
v_exp_f32 v172, v172
s_branch Ljoin15
Lta13:
v_mfma_f32_16x16x32_bf16 v[132:135], a[128:131], v[32:35], v[100:103]
v_exp_f32 v183, v183
v_mfma_f32_16x16x32_bf16 v[148:151], a[144:147], v[32:35], v[112:115]
v_exp_f32 v172, v172
s_branch Ljoin15
Lnt14:
v_mfma_f32_16x16x32_bf16 v[132:135], a[128:131], v[32:35], v[84:87]
v_exp_f32 v183, v183
v_mfma_f32_16x16x32_bf16 v[148:151], a[144:147], v[32:35], v[100:103]
v_exp_f32 v172, v172
Ljoin15:
v_mfma_f32_16x16x32_bf16 v[136:139], a[128:131], v[48:51], v[88:91]
v_cvt_pk_bf16_f32 v214, v180, v181
v_cvt_pk_bf16_f32 v215, v182, v183
v_mfma_f32_16x16x32_bf16 v[136:139], a[132:135], v[52:55], v[136:139]
v_exp_f32 v173, v173
v_mfma_f32_16x16x32_bf16 v[136:139], a[136:139], v[56:59], v[136:139]
buffer_load_dwordx4 v1, s[44:47], s72 offen offset:2048 sc1 lds
v_mfma_f32_16x16x32_bf16 v[136:139], a[140:143], v[60:63], v[136:139]
v_exp_f32 v174, v174
v_mfma_f32_16x16x32_bf16 v[152:155], a[156:159], v[60:63], v[88:91]
v_exp_f32 v175, v175
v_mfma_f32_16x16x32_bf16 v[152:155], a[152:155], v[56:59], v[152:155]
v_exp_f32 v188, v188
v_mfma_f32_16x16x32_bf16 v[152:155], a[148:151], v[52:55], v[152:155]
v_cvt_pk_bf16_f32 v220, v172, v173
v_cvt_pk_bf16_f32 v221, v174, v175
v_mfma_f32_16x16x32_bf16 v[152:155], a[144:147], v[48:51], v[152:155]
v_exp_f32 v189, v189
v_mfma_f32_16x16x32_bf16 v[132:135], a[132:135], v[36:39], v[132:135]
buffer_load_dwordx4 v1, s[44:47], s72 offen offset:3072 sc1 lds
v_mfma_f32_16x16x32_bf16 v[132:135], a[136:139], v[40:43], v[132:135]
s_add_u32 s66, s58, 1
v_exp_f32 v190, v190
v_mfma_f32_16x16x32_bf16 v[132:135], a[140:143], v[44:47], v[132:135]
s_and_b32 s66, s66, 3
v_exp_f32 v191, v191
v_mfma_f32_16x16x32_bf16 v[140:143], a[140:143], v[76:79], v[92:95]
s_mul_i32 s66, s66, 4160
v_exp_f32 v160, v160
v_mfma_f32_16x16x32_bf16 v[140:143], a[136:139], v[72:75], v[140:143]
s_add_u32 m0, s66, 131104
v_cvt_pk_bf16_f32 v222, v188, v189
v_cvt_pk_bf16_f32 v223, v190, v191
v_mfma_f32_16x16x32_bf16 v[140:143], a[132:135], v[68:71], v[140:143]
s_add_u32 s72, s93, 0x2
v_exp_f32 v161, v161
v_mfma_f32_16x16x32_bf16 v[140:143], a[128:131], v[64:67], v[140:143]
buffer_load_dwordx4 v1, s[36:39], s72 offen lds
v_mfma_f32_16x16x32_bf16 v[156:159], a[144:147], v[64:67], v[92:95]
v_exp_f32 v162, v162
v_mfma_f32_16x16x32_bf16 v[156:159], a[148:151], v[68:71], v[156:159]
v_exp_f32 v163, v163
v_mfma_f32_16x16x32_bf16 v[156:159], a[152:155], v[72:75], v[156:159]
buffer_load_dwordx4 v1, s[36:39], s72 offen offset:1024 lds
v_mfma_f32_16x16x32_bf16 v[156:159], a[156:159], v[76:79], v[156:159]
buffer_load_dwordx4 v1, s[36:39], s72 offen offset:2048 lds
v_mfma_f32_16x16x32_bf16 v[148:151], a[156:159], v[44:47], v[148:151]
buffer_load_dwordx4 v1, s[36:39], s72 offen offset:3072 lds
v_mfma_f32_16x16x32_bf16 v[148:151], a[152:155], v[40:43], v[148:151]
s_waitcnt vmcnt(12) lgkmcnt(4)
v_exp_f32 v176, v176
v_mfma_f32_16x16x32_bf16 v[148:151], a[148:151], v[36:39], v[148:151]
s_barrier
v_cvt_pk_bf16_f32 v208, v160, v161
v_cvt_pk_bf16_f32 v209, v162, v163
v_add_u32 v2, s82, v1
v_exp_f32 v177, v177
v_exp_f32 v178, v178
v_cvt_pk_bf16_f32 v210, v176, v177
v_exp_f32 v179, v179
v_exp_f32 v168, v168
v_cvt_pk_bf16_f32 v211, v178, v179
v_exp_f32 v169, v169
v_exp_f32 v170, v170
v_cvt_pk_bf16_f32 v216, v168, v169
v_exp_f32 v171, v171
v_exp_f32 v184, v184
v_cvt_pk_bf16_f32 v217, v170, v171
v_exp_f32 v185, v185
v_exp_f32 v186, v186
v_cvt_pk_bf16_f32 v218, v184, v185
v_exp_f32 v187, v187
s_nop 0
v_cvt_pk_bf16_f32 v219, v186, v187
s_branch LLT3
.p2align 12
s_endpgm
.p2align 7
LLT3x:
Lstub11:
s_cbranch_execz Lret
v_mfma_f32_16x16x32_bf16 v[228:231], v[120:123], v[196:199], v[228:231]
s_xor_b32 s74, s82, 0x10000
ds_read_b128 a[128:131], v2 offset:16384
v_and_b32 v240, 15, v0
v_mfma_f32_16x16x32_bf16 v[228:231], v[120:123], v[212:215], v[228:231]
s_add_u32 s74, s74, s64
v_exp_f32 v136, v136
v_mfma_f32_16x16x32_bf16 v[236:239], v[120:123], v[204:207], v[236:239]
s_add_u32 s81, s81, 0x8000
v_exp_f32 v137, v137
v_mfma_f32_16x16x32_bf16 v[236:239], v[120:123], v[220:223], v[236:239]
s_add_u32 m0, s74, 0
ds_read_b128 a[132:135], v2 offset:17408
v_cvt_pk_bf16_f32 v200, v136, v137
v_mfma_f32_16x16x32_bf16 a[32:35], a[192:195], v[196:199], a[32:35]
s_add_u32 s72, s81, 0
buffer_load_dwordx4 v1, s[44:47], s72 offen sc1 lds
v_mfma_f32_16x16x32_bf16 a[32:35], a[224:227], v[212:215], a[32:35]
s_add_u32 s69, s93, 0x3e00000
v_exp_f32 v138, v138
v_mfma_f32_16x16x32_bf16 a[96:99], a[224:227], v[220:223], a[96:99]
ds_read_b128 a[136:139], v2 offset:18432
v_lshrrev_b32 v241, 4, v0
v_mfma_f32_16x16x32_bf16 a[96:99], a[192:195], v[204:207], a[96:99]
v_exp_f32 v139, v139
v_mfma_f32_16x16x32_bf16 a[100:103], a[196:199], v[204:207], a[100:103]
buffer_store_dwordx4 v[112:115], v1, s[44:47], s69 offen sc1
v_mfma_f32_16x16x32_bf16 a[100:103], a[228:231], v[220:223], a[100:103]
v_exp_f32 v152, v152
v_mfma_f32_16x16x32_bf16 a[36:39], a[228:231], v[212:215], a[36:39]
ds_read_b128 a[140:143], v2 offset:19456
v_cvt_pk_bf16_f32 v201, v138, v139
v_mfma_f32_16x16x32_bf16 a[36:39], a[196:199], v[196:199], a[36:39]
v_exp_f32 v153, v153
v_mfma_f32_16x16x32_bf16 a[40:43], a[200:203], v[196:199], a[40:43]
buffer_load_dwordx4 v1, s[44:47], s72 offen offset:1024 sc1 lds
v_mfma_f32_16x16x32_bf16 a[40:43], a[232:235], v[212:215], a[40:43]
ds_read_b128 a[144:147], v2 offset:20480
v_cvt_pk_bf16_f32 v202, v152, v153
v_mfma_f32_16x16x32_bf16 a[104:107], a[232:235], v[220:223], a[104:107]
v_exp_f32 v154, v154
v_mfma_f32_16x16x32_bf16 a[104:107], a[200:203], v[204:207], a[104:107]
v_exp_f32 v155, v155
v_mfma_f32_16x16x32_bf16 a[108:111], a[204:207], v[204:207], a[108:111]
buffer_store_dwordx4 v[112:115], v1, s[44:47], s69 offen offset:1024 sc1
v_mfma_f32_16x16x32_bf16 a[108:111], a[236:239], v[220:223], a[108:111]
ds_read_b128 a[148:151], v2 offset:21504
v_cvt_pk_bf16_f32 v203, v154, v155
v_mfma_f32_16x16x32_bf16 a[44:47], a[236:239], v[212:215], a[44:47]
v_exp_f32 v132, v132
v_mfma_f32_16x16x32_bf16 a[44:47], a[204:207], v[196:199], a[44:47]
ds_read_b128 a[152:155], v2 offset:22528
v_add_u32 v248, 1, v240
v_mfma_f32_16x16x32_bf16 a[48:51], a[208:211], v[196:199], a[48:51]
s_waitcnt lgkmcnt(7)
v_exp_f32 v133, v133
v_mfma_f32_16x16x32_bf16 a[48:51], a[240:243], v[212:215], a[48:51]
buffer_load_dwordx4 v1, s[44:47], s72 offen offset:2048 sc1 lds
v_mfma_f32_16x16x32_bf16 a[112:115], a[240:243], v[220:223], a[112:115]
v_exp_f32 v134, v134
v_mfma_f32_16x16x32_bf16 a[112:115], a[208:211], v[204:207], a[112:115]
ds_read_b128 a[156:159], v2 offset:23552
v_and_b32 v249, 3, v248
v_mfma_f32_16x16x32_bf16 a[116:119], a[212:215], v[204:207], a[116:119]
v_exp_f32 v135, v135
v_mfma_f32_16x16x32_bf16 a[116:119], a[244:247], v[220:223], a[116:119]
buffer_store_dwordx4 v[112:115], v1, s[44:47], s69 offen offset:2048 sc1
v_mfma_f32_16x16x32_bf16 a[52:55], a[244:247], v[212:215], a[52:55]
ds_read_b128 a[192:195], v2 offset:0
v_lshrrev_b32 v248, 2, v248
v_mfma_f32_16x16x32_bf16 a[52:55], a[212:215], v[196:199], a[52:55]
v_exp_f32 v148, v148
v_mfma_f32_16x16x32_bf16 a[56:59], a[216:219], v[196:199], a[56:59]
buffer_load_dwordx4 v1, s[44:47], s72 offen offset:3072 sc1 lds
v_mfma_f32_16x16x32_bf16 a[56:59], a[248:251], v[212:215], a[56:59]
v_exp_f32 v149, v149
v_mfma_f32_16x16x32_bf16 a[120:123], a[248:251], v[220:223], a[120:123]
ds_read_b128 a[196:199], v2 offset:1024
v_mov_b32 v250, 0x20000
v_mfma_f32_16x16x32_bf16 a[120:123], a[216:219], v[204:207], a[120:123]
v_exp_f32 v150, v150
v_mfma_f32_16x16x32_bf16 a[124:127], a[220:223], v[204:207], a[124:127]
ds_read_b128 a[200:203], v2 offset:2048
v_mov_b32 v252, 0x20001
v_mfma_f32_16x16x32_bf16 a[124:127], a[252:255], v[220:223], a[124:127]
buffer_store_dwordx4 v[112:115], v1, s[44:47], s69 offen offset:3072 sc1
v_mfma_f32_16x16x32_bf16 a[60:63], a[252:255], v[212:215], a[60:63]
s_add_u32 s69, s93, 0x4200000
v_exp_f32 v151, v151
v_mfma_f32_16x16x32_bf16 a[60:63], a[220:223], v[196:199], a[60:63]
ds_read_b128 a[204:207], v2 offset:3072
v_cvt_pk_bf16_f32 v196, v132, v133
s_cmp_eq_u32 s58, 2
s_cbranch_scc1 Lta40
s_cmp_eq_u32 s58, 3
s_cbranch_scc1 Lnt41
v_mfma_f32_16x16x32_bf16 v[164:167], a[160:163], v[32:35], v[112:115]
ds_read_b128 a[208:211], v2 offset:4096
v_cvt_pk_bf16_f32 v197, v134, v135
v_mfma_f32_16x16x32_bf16 v[180:183], a[176:179], v[32:35], v[112:115]
v_exp_f32 v140, v140
s_branch Ljoin42
Lta40:
v_mfma_f32_16x16x32_bf16 v[164:167], a[160:163], v[32:35], v[100:103]
ds_read_b128 a[208:211], v2 offset:4096
v_cvt_pk_bf16_f32 v197, v134, v135
v_mfma_f32_16x16x32_bf16 v[180:183], a[176:179], v[32:35], v[112:115]
v_exp_f32 v140, v140
s_branch Ljoin42
Lnt41:
v_mfma_f32_16x16x32_bf16 v[164:167], a[160:163], v[32:35], v[84:87]
ds_read_b128 a[208:211], v2 offset:4096
v_cvt_pk_bf16_f32 v197, v134, v135
v_mfma_f32_16x16x32_bf16 v[180:183], a[176:179], v[32:35], v[100:103]
v_exp_f32 v140, v140
Ljoin42:
v_mfma_f32_16x16x32_bf16 v[164:167], a[164:167], v[36:39], v[164:167]
ds_read_b128 a[212:215], v2 offset:5120
v_cvt_pk_bf16_f32 v198, v148, v149
v_mfma_f32_16x16x32_bf16 v[164:167], a[168:171], v[40:43], v[164:167]
buffer_store_dwordx4 v[112:115], v1, s[44:47], s69 offen sc1
v_mfma_f32_16x16x32_bf16 v[164:167], a[172:175], v[44:47], v[164:167]
v_exp_f32 v141, v141
v_mfma_f32_16x16x32_bf16 v[172:175], a[172:175], v[76:79], v[92:95]
v_exp_f32 v142, v142
v_mfma_f32_16x16x32_bf16 v[172:175], a[168:171], v[72:75], v[172:175]
ds_read_b128 a[216:219], v2 offset:6144
v_cvt_pk_bf16_f32 v199, v150, v151
v_mfma_f32_16x16x32_bf16 v[172:175], a[164:167], v[68:71], v[172:175]
buffer_store_dwordx4 v[112:115], v1, s[44:47], s69 offen offset:1024 sc1
v_mfma_f32_16x16x32_bf16 v[172:175], a[160:163], v[64:67], v[172:175]
v_exp_f32 v143, v143
v_mfma_f32_16x16x32_bf16 v[188:191], a[176:179], v[64:67], v[92:95]
v_exp_f32 v156, v156
v_mfma_f32_16x16x32_bf16 v[188:191], a[180:183], v[68:71], v[188:191]
ds_read_b128 a[220:223], v2 offset:7168
v_cvt_pk_bf16_f32 v204, v140, v141
v_mfma_f32_16x16x32_bf16 v[188:191], a[184:187], v[72:75], v[188:191]
buffer_store_dwordx4 v[112:115], v1, s[44:47], s69 offen offset:2048 sc1
v_mfma_f32_16x16x32_bf16 v[188:191], a[188:191], v[76:79], v[188:191]
v_exp_f32 v157, v157
v_mfma_f32_16x16x32_bf16 v[180:183], a[188:191], v[44:47], v[180:183]
v_exp_f32 v158, v158
v_mfma_f32_16x16x32_bf16 v[180:183], a[184:187], v[40:43], v[180:183]
v_cvt_pk_bf16_f32 v205, v142, v143
v_cvt_pk_bf16_f32 v206, v156, v157
v_mfma_f32_16x16x32_bf16 v[180:183], a[180:183], v[36:39], v[180:183]
buffer_store_dwordx4 v[112:115], v1, s[44:47], s69 offen offset:3072 sc1
v_mfma_f32_16x16x32_bf16 v[168:171], a[160:163], v[48:51], v[88:91]
v_exp_f32 v159, v159
v_mfma_f32_16x16x32_bf16 v[168:171], a[164:167], v[52:55], v[168:171]
v_cvt_pk_bf16_f32 v207, v158, v159
v_lshlrev_b32 v6, 3, v249
v_mfma_f32_16x16x32_bf16 v[168:171], a[168:171], v[56:59], v[168:171]
v_lshrrev_b32 v6, v6, v252
v_and_b32 v6, 3, v6
v_mfma_f32_16x16x32_bf16 v[168:171], a[172:175], v[60:63], v[168:171]
v_cmp_ne_u32 vcc, 1, v249
v_mul_u32_u24 v6, 16640, v6
v_mfma_f32_16x16x32_bf16 v[184:187], a[188:191], v[60:63], v[88:91]
v_add_u32 v6, s92, v6
v_cndmask_b32 v6, v250, v6, vcc
v_mfma_f32_16x16x32_bf16 v[184:187], a[184:187], v[56:59], v[184:187]
v_add_u32 v253, s58, v249
v_and_b32 v253, 3, v253
v_mfma_f32_16x16x32_bf16 v[184:187], a[180:183], v[52:55], v[184:187]
s_waitcnt lgkmcnt(4)
v_mfma_f32_16x16x32_bf16 v[184:187], a[176:179], v[48:51], v[184:187]
s_barrier
s_lshr_b32 s69, s93, 4
s_and_b32 s69, s69, 0x7f00
s_add_u32 s69, s69, LHT4-Lpc0
v_lshrrev_b32 v3, 5, v0
v_lshlrev_b32 v3, 7, v3
v_add_u32 v3, s69, v3
v_min_u32 v3, Lcode_end-Lpc0, v3
global_load_dword v4, v3, s[98:99]
v_mfma_f32_16x16x32_bf16 v[224:227], v[120:123], v[208:211], v[224:227]
s_add_u32 s82, s82, 0x8000
ds_read_b128 a[160:163], v2 offset:24576
ds_read_b128 a[164:167], v2 offset:25600
v_mfma_f32_16x16x32_bf16 v[232:235], v[120:123], v[216:219], v[232:235]
s_and_b32 s82, s82, 0x1ffff
v_exp_f32 v164, v164
v_mfma_f32_16x16x32_bf16 v[232:235], v[120:123], v[200:203], v[232:235]
s_add_u32 s66, s58, 3
v_exp_f32 v165, v165
v_mfma_f32_16x16x32_bf16 a[0:3], a[224:227], v[208:211], a[0:3]
s_and_b32 s66, s66, 3
v_exp_f32 v166, v166
v_mfma_f32_16x16x32_bf16 a[64:67], a[192:195], v[200:203], a[64:67]
s_mul_i32 s66, s66, 4160
ds_read_b128 a[168:171], v2 offset:26624
v_cvt_pk_bf16_f32 v212, v164, v165
v_mfma_f32_16x16x32_bf16 a[64:67], a[224:227], v[216:219], a[64:67]
s_add_u32 s66, s66, s92
v_exp_f32 v167, v167
v_mfma_f32_16x16x32_bf16 a[68:71], a[228:231], v[216:219], a[68:71]
s_add_u32 m0, s66, 32
v_exp_f32 v180, v180
v_mfma_f32_16x16x32_bf16 a[68:71], a[196:199], v[200:203], a[68:71]
s_add_u32 s72, s93, 0x6
buffer_load_dwordx4 v1, s[36:39], s72 offen lds
v_mfma_f32_16x16x32_bf16 a[4:7], a[228:231], v[208:211], a[4:7]
ds_read_b128 a[172:175], v2 offset:27648
v_cvt_pk_bf16_f32 v213, v166, v167
v_mfma_f32_16x16x32_bf16 a[8:11], a[232:235], v[208:211], a[8:11]
v_exp_f32 v181, v181
v_mfma_f32_16x16x32_bf16 a[72:75], a[200:203], v[200:203], a[72:75]
ds_read_b128 a[176:179], v2 offset:28672
v_cvt_pk_bf16_f32 v214, v180, v181
v_mfma_f32_16x16x32_bf16 a[72:75], a[232:235], v[216:219], a[72:75]
v_exp_f32 v182, v182
v_mfma_f32_16x16x32_bf16 a[76:79], a[236:239], v[216:219], a[76:79]
v_exp_f32 v183, v183
v_mfma_f32_16x16x32_bf16 a[76:79], a[204:207], v[200:203], a[76:79]
ds_read_b128 a[180:183], v2 offset:29696
v_cvt_pk_bf16_f32 v215, v182, v183
v_mfma_f32_16x16x32_bf16 a[12:15], a[236:239], v[208:211], a[12:15]
v_exp_f32 v172, v172
v_mfma_f32_16x16x32_bf16 a[16:19], a[240:243], v[208:211], a[16:19]
s_waitcnt lgkmcnt(6)
ds_read_b128 a[184:187], v2 offset:30720
ds_read_b128 a[188:191], v2 offset:31744
v_mfma_f32_16x16x32_bf16 a[80:83], a[208:211], v[200:203], a[80:83]
v_exp_f32 v173, v173
v_mfma_f32_16x16x32_bf16 a[80:83], a[240:243], v[216:219], a[80:83]
buffer_load_dwordx4 v1, s[36:39], s72 offen offset:1024 lds
v_mfma_f32_16x16x32_bf16 a[84:87], a[244:247], v[216:219], a[84:87]
v_exp_f32 v174, v174
v_mfma_f32_16x16x32_bf16 a[84:87], a[212:215], v[200:203], a[84:87]
v_exp_f32 v175, v175
v_mfma_f32_16x16x32_bf16 a[20:23], a[244:247], v[208:211], a[20:23]
ds_read_b128 a[224:227], v2 offset:8192
v_cvt_pk_bf16_f32 v220, v172, v173
v_mfma_f32_16x16x32_bf16 a[24:27], a[248:251], v[208:211], a[24:27]
v_exp_f32 v188, v188
v_mfma_f32_16x16x32_bf16 a[88:91], a[216:219], v[200:203], a[88:91]
v_exp_f32 v189, v189
v_mfma_f32_16x16x32_bf16 a[88:91], a[248:251], v[216:219], a[88:91]
ds_read_b128 a[228:231], v2 offset:9216
v_cvt_pk_bf16_f32 v221, v174, v175
v_mfma_f32_16x16x32_bf16 a[92:95], a[252:255], v[216:219], a[92:95]
v_exp_f32 v190, v190
v_mfma_f32_16x16x32_bf16 a[92:95], a[220:223], v[200:203], a[92:95]
ds_read_b128 a[232:235], v2 offset:10240
v_cvt_pk_bf16_f32 v222, v188, v189
v_mfma_f32_16x16x32_bf16 a[28:31], a[252:255], v[208:211], a[28:31]
v_exp_f32 v191, v191
s_cmp_eq_u32 s58, 0
s_cbranch_scc1 Lta43
s_cmp_eq_u32 s58, 1
s_cbranch_scc1 Lnt44
v_mfma_f32_16x16x32_bf16 v[136:139], a[128:131], v[48:51], v[88:91]
buffer_load_dwordx4 v1, s[36:39], s72 offen offset:2048 lds
v_mfma_f32_16x16x32_bf16 v[152:155], a[144:147], v[48:51], v[88:91]
v_exp_f32 v168, v168
s_branch Ljoin45
Lta43:
v_mfma_f32_16x16x32_bf16 v[136:139], a[128:131], v[48:51], v[104:107]
buffer_load_dwordx4 v1, s[36:39], s72 offen offset:2048 lds
v_mfma_f32_16x16x32_bf16 v[152:155], a[144:147], v[48:51], v[112:115]
v_exp_f32 v168, v168
s_branch Ljoin45
Lnt44:
v_mfma_f32_16x16x32_bf16 v[136:139], a[128:131], v[48:51], v[88:91]
buffer_load_dwordx4 v1, s[36:39], s72 offen offset:2048 lds
v_mfma_f32_16x16x32_bf16 v[152:155], a[144:147], v[48:51], v[104:107]
v_exp_f32 v168, v168
Ljoin45:
v_mfma_f32_16x16x32_bf16 v[136:139], a[132:135], v[52:55], v[136:139]
ds_read_b128 a[236:239], v2 offset:11264
v_cvt_pk_bf16_f32 v223, v190, v191
v_mfma_f32_16x16x32_bf16 v[136:139], a[136:139], v[56:59], v[136:139]
v_exp_f32 v169, v169
v_mfma_f32_16x16x32_bf16 v[136:139], a[140:143], v[60:63], v[136:139]
ds_read_b128 a[240:243], v2 offset:12288
v_cvt_pk_bf16_f32 v216, v168, v169
v_mfma_f32_16x16x32_bf16 v[152:155], a[156:159], v[60:63], v[152:155]
v_exp_f32 v170, v170
v_mfma_f32_16x16x32_bf16 v[152:155], a[152:155], v[56:59], v[152:155]
v_exp_f32 v171, v171
v_mfma_f32_16x16x32_bf16 v[152:155], a[148:151], v[52:55], v[152:155]
ds_read_b128 a[244:247], v2 offset:13312
v_cvt_pk_bf16_f32 v217, v170, v171
v_mfma_f32_16x16x32_bf16 v[140:143], a[128:131], v[64:67], v[92:95]
v_exp_f32 v184, v184
v_mfma_f32_16x16x32_bf16 v[140:143], a[132:135], v[68:71], v[140:143]
ds_read_b128 a[248:251], v2 offset:14336
v_mfma_f32_16x16x32_bf16 v[140:143], a[136:139], v[72:75], v[140:143]
v_exp_f32 v185, v185
v_mfma_f32_16x16x32_bf16 v[140:143], a[140:143], v[76:79], v[140:143]
buffer_load_dwordx4 v1, s[36:39], s72 offen offset:3072 lds
v_mfma_f32_16x16x32_bf16 v[156:159], a[156:159], v[76:79], v[92:95]
ds_read_b128 a[252:255], v2 offset:15360
v_cvt_pk_bf16_f32 v218, v184, v185
v_mfma_f32_16x16x32_bf16 v[156:159], a[152:155], v[72:75], v[156:159]
v_exp_f32 v186, v186
v_mfma_f32_16x16x32_bf16 v[156:159], a[148:151], v[68:71], v[156:159]
s_waitcnt vmcnt(17) lgkmcnt(0)
v_exp_f32 v187, v187
v_mfma_f32_16x16x32_bf16 v[156:159], a[144:147], v[64:67], v[156:159]
s_barrier
v_cvt_pk_bf16_f32 v219, v186, v187
v_add_u32 v2, s82, v1
v_mfma_f32_16x16x32_bf16 v[228:231], v[120:123], v[196:199], v[228:231]
s_mov_b32 m0, s62
v_exp_f32 v136, v136
v_mfma_f32_16x16x32_bf16 v[228:231], v[120:123], v[212:215], v[228:231]
s_add_u32 s72, s93, 0x3000000
ds_read_b128 a[128:131], v2 offset:16384
v_mul_u32_u24 v253, 4160, v253
v_mfma_f32_16x16x32_bf16 v[236:239], v[120:123], v[204:207], v[236:239]
buffer_load_dwordx4 v1, s[44:47], s72 offen sc1 lds
v_mfma_f32_16x16x32_bf16 v[236:239], v[120:123], v[220:223], v[236:239]
v_exp_f32 v137, v137
v_mfma_f32_16x16x32_bf16 a[32:35], a[192:195], v[196:199], a[32:35]
ds_read_b128 a[132:135], v2 offset:17408
v_cvt_pk_bf16_f32 v200, v136, v137
v_mfma_f32_16x16x32_bf16 a[32:35], a[224:227], v[212:215], a[32:35]
v_exp_f32 v138, v138
v_mfma_f32_16x16x32_bf16 a[96:99], a[224:227], v[220:223], a[96:99]
ds_read_b128 a[136:139], v2 offset:18432
v_add_u32 v6, v6, v253
v_mfma_f32_16x16x32_bf16 a[96:99], a[192:195], v[204:207], a[96:99]
buffer_load_dwordx4 v1, s[44:47], s72 offen offset:1024 sc1 lds
v_mfma_f32_16x16x32_bf16 a[100:103], a[196:199], v[204:207], a[100:103]
v_exp_f32 v139, v139
v_mfma_f32_16x16x32_bf16 a[100:103], a[228:231], v[220:223], a[100:103]
ds_read_b128 a[140:143], v2 offset:19456
v_cvt_pk_bf16_f32 v201, v138, v139
v_mfma_f32_16x16x32_bf16 a[36:39], a[228:231], v[212:215], a[36:39]
v_exp_f32 v152, v152
v_mfma_f32_16x16x32_bf16 a[36:39], a[196:199], v[196:199], a[36:39]
ds_read_b128 a[144:147], v2 offset:20480
v_bfe_u32 v251, v0, 2, 2
v_mfma_f32_16x16x32_bf16 a[40:43], a[200:203], v[196:199], a[40:43]
buffer_load_dwordx4 v1, s[44:47], s72 offen offset:2048 sc1 lds
v_mfma_f32_16x16x32_bf16 a[40:43], a[232:235], v[212:215], a[40:43]
v_exp_f32 v153, v153
v_mfma_f32_16x16x32_bf16 a[104:107], a[232:235], v[220:223], a[104:107]
ds_read_b128 a[148:151], v2 offset:21504
v_cvt_pk_bf16_f32 v202, v152, v153
v_mfma_f32_16x16x32_bf16 a[104:107], a[200:203], v[204:207], a[104:107]
buffer_load_dwordx4 v1, s[44:47], s72 offen offset:3072 sc1 lds
v_mfma_f32_16x16x32_bf16 a[108:111], a[204:207], v[204:207], a[108:111]
s_add_u32 s66, s58, 0
v_exp_f32 v154, v154
v_mfma_f32_16x16x32_bf16 a[108:111], a[236:239], v[220:223], a[108:111]
s_and_b32 s66, s66, 3
ds_read_b128 a[152:155], v2 offset:22528
v_lshl_add_u32 v6, v248, 3, v6
v_mfma_f32_16x16x32_bf16 a[44:47], a[236:239], v[212:215], a[44:47]
s_mul_i32 s66, s66, 4160
v_exp_f32 v155, v155
v_mfma_f32_16x16x32_bf16 a[44:47], a[204:207], v[196:199], a[44:47]
s_add_u32 s66, s66, s92
ds_read_b128 a[156:159], v2 offset:23552
v_cvt_pk_bf16_f32 v203, v154, v155
v_mfma_f32_16x16x32_bf16 a[48:51], a[208:211], v[196:199], a[48:51]
s_waitcnt lgkmcnt(8)
v_exp_f32 v140, v140
v_mfma_f32_16x16x32_bf16 a[48:51], a[240:243], v[212:215], a[48:51]
s_add_u32 m0, s66, 16672
ds_read_b128 a[192:195], v2 offset:0
v_lshl_add_u32 v6, v241, 4, v6
v_mfma_f32_16x16x32_bf16 a[112:115], a[240:243], v[220:223], a[112:115]
s_add_u32 s72, s93, 0x0
buffer_load_dwordx4 v1, s[36:39], s72 offen lds
v_mfma_f32_16x16x32_bf16 a[112:115], a[208:211], v[204:207], a[112:115]
buffer_load_dwordx4 v1, s[36:39], s72 offen offset:1024 lds
v_mfma_f32_16x16x32_bf16 a[116:119], a[212:215], v[204:207], a[116:119]
v_exp_f32 v141, v141
v_mfma_f32_16x16x32_bf16 a[116:119], a[244:247], v[220:223], a[116:119]
ds_read_b128 a[196:199], v2 offset:1024
v_lshlrev_b32 v5, 3, v251
v_mfma_f32_16x16x32_bf16 a[52:55], a[244:247], v[212:215], a[52:55]
v_exp_f32 v142, v142
v_mfma_f32_16x16x32_bf16 a[52:55], a[212:215], v[196:199], a[52:55]
ds_read_b128 a[200:203], v2 offset:2048
v_lshrrev_b32 v5, v5, v252
v_mfma_f32_16x16x32_bf16 a[56:59], a[216:219], v[196:199], a[56:59]
buffer_load_dwordx4 v1, s[36:39], s72 offen offset:2048 lds
v_mfma_f32_16x16x32_bf16 a[56:59], a[248:251], v[212:215], a[56:59]
v_exp_f32 v143, v143
v_mfma_f32_16x16x32_bf16 a[120:123], a[248:251], v[220:223], a[120:123]
ds_read_b128 a[204:207], v2 offset:3072
v_and_b32 v5, 3, v5
v_mfma_f32_16x16x32_bf16 a[120:123], a[216:219], v[204:207], a[120:123]
v_exp_f32 v156, v156
v_mfma_f32_16x16x32_bf16 a[124:127], a[220:223], v[204:207], a[124:127]
ds_read_b128 a[208:211], v2 offset:4096
v_cmp_ne_u32 vcc, 1, v251
v_mfma_f32_16x16x32_bf16 a[124:127], a[252:255], v[220:223], a[124:127]
buffer_load_dwordx4 v1, s[36:39], s72 offen offset:3072 lds
v_mfma_f32_16x16x32_bf16 a[60:63], a[252:255], v[212:215], a[60:63]
s_add_u32 s66, s58, 2
v_exp_f32 v157, v157
v_mfma_f32_16x16x32_bf16 a[60:63], a[220:223], v[196:199], a[60:63]
s_and_b32 s66, s66, 3
ds_read_b128 a[212:215], v2 offset:5120
v_cvt_pk_bf16_f32 v204, v140, v141
s_cmp_eq_u32 s58, 2
s_cbranch_scc1 Lta46
s_cmp_eq_u32 s58, 3
s_cbranch_scc1 Lnt47
v_mfma_f32_16x16x32_bf16 v[168:171], a[160:163], v[48:51], v[112:115]
s_mul_i32 s66, s66, 4160
v_exp_f32 v158, v158
v_mfma_f32_16x16x32_bf16 v[184:187], a[176:179], v[48:51], v[112:115]
s_add_u32 s66, s66, s92
ds_read_b128 a[216:219], v2 offset:6144
v_cvt_pk_bf16_f32 v205, v142, v143
s_branch Ljoin48
Lta46:
v_mfma_f32_16x16x32_bf16 v[168:171], a[160:163], v[48:51], v[104:107]
s_mul_i32 s66, s66, 4160
v_exp_f32 v158, v158
v_mfma_f32_16x16x32_bf16 v[184:187], a[176:179], v[48:51], v[112:115]
s_add_u32 s66, s66, s92
ds_read_b128 a[216:219], v2 offset:6144
v_cvt_pk_bf16_f32 v205, v142, v143
s_branch Ljoin48
Lnt47:
v_mfma_f32_16x16x32_bf16 v[168:171], a[160:163], v[48:51], v[88:91]
s_mul_i32 s66, s66, 4160
v_exp_f32 v158, v158
v_mfma_f32_16x16x32_bf16 v[184:187], a[176:179], v[48:51], v[104:107]
s_add_u32 s66, s66, s92
ds_read_b128 a[216:219], v2 offset:6144
v_cvt_pk_bf16_f32 v205, v142, v143
Ljoin48:
v_mfma_f32_16x16x32_bf16 v[172:175], a[160:163], v[64:67], v[92:95]
s_add_u32 m0, s66, 33312
v_exp_f32 v159, v159
v_mfma_f32_16x16x32_bf16 v[172:175], a[164:167], v[68:71], v[172:175]
s_add_u32 s72, s93, 0x4
buffer_load_dwordx4 v1, s[36:39], s72 offen lds
v_mfma_f32_16x16x32_bf16 v[172:175], a[168:171], v[72:75], v[172:175]
ds_read_b128 a[220:223], v2 offset:7168
v_cvt_pk_bf16_f32 v206, v156, v157
v_mfma_f32_16x16x32_bf16 v[172:175], a[172:175], v[76:79], v[172:175]
buffer_load_dwordx4 v1, s[36:39], s72 offen offset:1024 lds
v_mfma_f32_16x16x32_bf16 v[188:191], a[188:191], v[76:79], v[92:95]
v_cvt_pk_bf16_f32 v207, v158, v159
v_mul_u32_u24 v5, 16640, v5
v_mfma_f32_16x16x32_bf16 v[188:191], a[184:187], v[72:75], v[188:191]
v_add_u32 v5, s92, v5
v_cndmask_b32 v5, v250, v5, vcc
v_mfma_f32_16x16x32_bf16 v[188:191], a[180:183], v[68:71], v[188:191]
v_add_u32 v253, s58, v251
v_and_b32 v253, 3, v253
v_mfma_f32_16x16x32_bf16 v[188:191], a[176:179], v[64:67], v[188:191]
v_mul_u32_u24 v253, 4160, v253
v_add_u32 v5, v5, v253
v_mfma_f32_16x16x32_bf16 v[168:171], a[164:167], v[52:55], v[168:171]
s_add_u32 s73, s62, 480
v_lshlrev_b32 v248, 5, v240
v_sub_u32 v248, s73, v248
v_mfma_f32_16x16x32_bf16 v[168:171], a[168:171], v[56:59], v[168:171]
v_lshl_add_u32 v7, v241, 4, v248
v_mfma_f32_16x16x32_bf16 v[168:171], a[172:175], v[60:63], v[168:171]
s_and_b32 s73, s58, 1
v_mfma_f32_16x16x32_bf16 v[184:187], a[188:191], v[60:63], v[184:187]
s_lshl_b32 s73, s73, 4
v_mfma_f32_16x16x32_bf16 v[184:187], a[184:187], v[56:59], v[184:187]
s_lshr_b32 s73, s90, s73
v_mfma_f32_16x16x32_bf16 v[184:187], a[180:183], v[52:55], v[184:187]
s_waitcnt lgkmcnt(4)
s_and_b32 s73, s73, 0xffff
v_lshl_add_u32 v248, v241, 3, v240
v_sub_u32 v248, 15, v248
v_and_b32 v249, 1, v248
v_lshlrev_b32 v249, 4, v249
v_lshlrev_b32 v249, v249, s73
v_lshrrev_b32 v248, 1, v248
v_and_b32 v241, 3, v0
v_cmp_eq_u32 vcc, 0, v248
v_lshl_add_u32 v5, v241, 3, v5
s_nop 0
v_cndmask_b32 v8, 0, v249, vcc
v_cmp_eq_u32 vcc, 1, v248
v_lshlrev_b32 v240, 4, v251
s_nop 0
v_cndmask_b32 v9, 0, v249, vcc
v_cmp_eq_u32 vcc, 2, v248
v_sub_u32 v240, 48, v240
v_lshlrev_b64 v[12:13], 16, s[88:89]
v_cndmask_b32 v10, 0, v249, vcc
v_cmp_eq_u32 vcc, 3, v248
v_lshlrev_b64 v[12:13], v240, v[12:13]
s_nop 0
v_cndmask_b32 v11, 0, v249, vcc
v_cmp_eq_u32 vcc, 3, v241
s_add_u32 s73, s62, 4096
v_lshl_add_u32 v14, v0, 3, s73
v_cndmask_b32 v12, 0, v12, vcc
v_cndmask_b32 v13, 0, v13, vcc
v_lshrrev_b32 v15, 4, v0
v_lshlrev_b32 v15, 1, v15
v_and_b32 v240, 7, v0
v_xor_b32 v15, v15, v240
v_lshlrev_b32 v15, 4, v15
v_lshrrev_b32 v240, 3, v0
v_lshl_add_u32 v15, v240, 11, v15
s_lshr_b32 s75, s59, 1
s_and_b32 s75, s75, 8
s_add_u32 s75, s75, s60
s_lshl_b32 s76, s65, 2
s_lshr_b32 s80, s59, 2
s_and_b32 s80, s80, 3
s_add_u32 s76, s76, s80
s_lshl_b32 s94, s58, 16
s_lshl_b32 s80, s76, 7
s_add_u32 s94, s94, s80
s_lshl_b32 s80, s75, 18
s_add_u32 s80, s80, s94
v_rcp_f32 v224, v224
v_rcp_f32 v228, v228
s_lshl_b32 s73, s52, 12
s_add_u32 s73, s73, 0x2000000
s_lshl_b32 s70, s67, 2
s_add_u32 s70, s70, s73
v_mov_b32 v225, v224
v_accvgpr_read_b32 v240, a0
v_accvgpr_read_b32 v241, a1
v_accvgpr_read_b32 v242, a2
v_accvgpr_read_b32 v243, a3
v_accvgpr_read_b32 v244, a4
v_accvgpr_read_b32 v245, a5
v_accvgpr_read_b32 v246, a6
v_accvgpr_read_b32 v247, a7
v_pk_mul_f32 v[240:241], v[240:241], v[224:225]
v_pk_mul_f32 v[242:243], v[242:243], v[224:225]
v_pk_mul_f32 v[244:245], v[244:245], v[224:225]
v_pk_mul_f32 v[246:247], v[246:247], v[224:225]
buffer_load_dwordx4 v1, s[36:39], s72 offen offset:2048 lds
v_cvt_pk_bf16_f32 v128, v240, v241
v_cvt_pk_bf16_f32 v129, v242, v243
v_cvt_pk_bf16_f32 v130, v244, v245
v_cvt_pk_bf16_f32 v131, v246, v247
v_accvgpr_read_b32 v248, a8
v_accvgpr_read_b32 v249, a9
v_accvgpr_read_b32 v250, a10
v_accvgpr_read_b32 v251, a11
v_accvgpr_read_b32 v252, a12
v_accvgpr_read_b32 v253, a13
v_accvgpr_read_b32 v254, a14
v_accvgpr_read_b32 v255, a15
v_pk_mul_f32 v[248:249], v[248:249], v[224:225]
v_pk_mul_f32 v[250:251], v[250:251], v[224:225]
v_pk_mul_f32 v[252:253], v[252:253], v[224:225]
v_pk_mul_f32 v[254:255], v[254:255], v[224:225]
v_cvt_pk_bf16_f32 v144, v248, v249
v_cvt_pk_bf16_f32 v145, v250, v251
buffer_load_dwordx4 v1, s[36:39], s72 offen offset:3072 lds
v_cvt_pk_bf16_f32 v146, v252, v253
v_cvt_pk_bf16_f32 v147, v254, v255
v_accvgpr_read_b32 v240, a16
v_accvgpr_read_b32 v241, a17
v_accvgpr_read_b32 v242, a18
v_accvgpr_read_b32 v243, a19
v_accvgpr_read_b32 v244, a20
v_accvgpr_read_b32 v245, a21
v_accvgpr_read_b32 v246, a22
v_accvgpr_read_b32 v247, a23
v_pk_mul_f32 v[240:241], v[240:241], v[224:225]
v_pk_mul_f32 v[242:243], v[242:243], v[224:225]
v_pk_mul_f32 v[244:245], v[244:245], v[224:225]
v_pk_mul_f32 v[246:247], v[246:247], v[224:225]
v_cvt_pk_bf16_f32 v160, v240, v241
v_cvt_pk_bf16_f32 v161, v242, v243
v_cvt_pk_bf16_f32 v162, v244, v245
v_cvt_pk_bf16_f32 v163, v246, v247
buffer_load_dwordx4 v[80:83], v15, s[4:7], s80 offen
v_accvgpr_read_b32 v248, a24
v_accvgpr_read_b32 v249, a25
v_accvgpr_read_b32 v250, a26
v_accvgpr_read_b32 v251, a27
v_accvgpr_read_b32 v252, a28
v_accvgpr_read_b32 v253, a29
v_accvgpr_read_b32 v254, a30
v_accvgpr_read_b32 v255, a31
v_pk_mul_f32 v[248:249], v[248:249], v[224:225]
v_pk_mul_f32 v[250:251], v[250:251], v[224:225]
v_pk_mul_f32 v[252:253], v[252:253], v[224:225]
v_pk_mul_f32 v[254:255], v[254:255], v[224:225]
v_cvt_pk_bf16_f32 v176, v248, v249
v_cvt_pk_bf16_f32 v177, v250, v251
v_cvt_pk_bf16_f32 v178, v252, v253
v_cvt_pk_bf16_f32 v179, v254, v255
v_mov_b32 v229, v228
v_accvgpr_read_b32 v240, a32
s_add_u32 s80, s80, 0x4000
buffer_load_dwordx4 v[84:87], v15, s[4:7], s80 offen
v_accvgpr_read_b32 v241, a33
v_accvgpr_read_b32 v242, a34
v_accvgpr_read_b32 v243, a35
v_accvgpr_read_b32 v244, a36
v_accvgpr_read_b32 v245, a37
v_accvgpr_read_b32 v246, a38
v_accvgpr_read_b32 v247, a39
v_pk_mul_f32 v[240:241], v[240:241], v[228:229]
v_pk_mul_f32 v[242:243], v[242:243], v[228:229]
v_pk_mul_f32 v[244:245], v[244:245], v[228:229]
v_pk_mul_f32 v[246:247], v[246:247], v[228:229]
v_cvt_pk_bf16_f32 v132, v240, v241
v_cvt_pk_bf16_f32 v133, v242, v243
v_cvt_pk_bf16_f32 v134, v244, v245
v_cvt_pk_bf16_f32 v135, v246, v247
v_accvgpr_read_b32 v248, a40
v_accvgpr_read_b32 v249, a41
v_accvgpr_read_b32 v250, a42
s_add_u32 s80, s80, 0x4000
buffer_load_dwordx4 v[96:99], v15, s[4:7], s80 offen
v_accvgpr_read_b32 v251, a43
v_accvgpr_read_b32 v252, a44
v_accvgpr_read_b32 v253, a45
v_accvgpr_read_b32 v254, a46
v_accvgpr_read_b32 v255, a47
v_pk_mul_f32 v[248:249], v[248:249], v[228:229]
v_pk_mul_f32 v[250:251], v[250:251], v[228:229]
v_pk_mul_f32 v[252:253], v[252:253], v[228:229]
v_pk_mul_f32 v[254:255], v[254:255], v[228:229]
v_cvt_pk_bf16_f32 v148, v248, v249
v_cvt_pk_bf16_f32 v149, v250, v251
v_cvt_pk_bf16_f32 v150, v252, v253
v_cvt_pk_bf16_f32 v151, v254, v255
v_accvgpr_read_b32 v240, a48
v_accvgpr_read_b32 v241, a49
v_accvgpr_read_b32 v242, a50
v_accvgpr_read_b32 v243, a51
v_accvgpr_read_b32 v244, a52
s_add_u32 s80, s80, 0x4000
buffer_load_dwordx4 v[100:103], v15, s[4:7], s80 offen
v_accvgpr_read_b32 v245, a53
v_accvgpr_read_b32 v246, a54
v_accvgpr_read_b32 v247, a55
v_pk_mul_f32 v[240:241], v[240:241], v[228:229]
v_pk_mul_f32 v[242:243], v[242:243], v[228:229]
v_pk_mul_f32 v[244:245], v[244:245], v[228:229]
v_pk_mul_f32 v[246:247], v[246:247], v[228:229]
v_cvt_pk_bf16_f32 v164, v240, v241
v_cvt_pk_bf16_f32 v165, v242, v243
v_cvt_pk_bf16_f32 v166, v244, v245
v_cvt_pk_bf16_f32 v167, v246, v247
v_accvgpr_read_b32 v248, a56
v_accvgpr_read_b32 v249, a57
v_accvgpr_read_b32 v250, a58
v_accvgpr_read_b32 v251, a59
v_accvgpr_read_b32 v252, a60
v_accvgpr_read_b32 v253, a61
v_accvgpr_read_b32 v254, a62
v_accvgpr_read_b32 v255, a63
v_pk_mul_f32 v[248:249], v[248:249], v[228:229]
v_pk_mul_f32 v[250:251], v[250:251], v[228:229]
v_pk_mul_f32 v[252:253], v[252:253], v[228:229]
v_pk_mul_f32 v[254:255], v[254:255], v[228:229]
v_cvt_pk_bf16_f32 v180, v248, v249
v_cvt_pk_bf16_f32 v181, v250, v251
v_cvt_pk_bf16_f32 v182, v252, v253
v_cvt_pk_bf16_f32 v183, v254, v255
v_mfma_f32_16x16x32_bf16 v[232:235], v[120:123], v[216:219], v[232:235]
s_add_u32 s82, s82, 0x8000
ds_read_b128 a[160:163], v2 offset:24576
ds_read_b128 a[164:167], v2 offset:25600
v_mfma_f32_16x16x32_bf16 v[232:235], v[120:123], v[200:203], v[232:235]
s_and_b32 s82, s82, 0x1ffff
v_exp_f32 v172, v172
v_mfma_f32_16x16x32_bf16 a[64:67], a[224:227], v[216:219], a[64:67]
v_exp_f32 v173, v173
v_mfma_f32_16x16x32_bf16 a[64:67], a[192:195], v[200:203], a[64:67]
s_nop 0
ds_read_b128 a[168:171], v2 offset:26624
ds_read_b128 a[172:175], v2 offset:27648
v_mfma_f32_16x16x32_bf16 a[68:71], a[196:199], v[200:203], a[68:71]
v_exp_f32 v174, v174
v_mfma_f32_16x16x32_bf16 a[68:71], a[228:231], v[216:219], a[68:71]
v_exp_f32 v175, v175
v_mfma_f32_16x16x32_bf16 a[72:75], a[232:235], v[216:219], a[72:75]
buffer_store_dwordx4 v[128:131], v1, s[44:47], s70 offen sc1
v_mfma_f32_16x16x32_bf16 a[72:75], a[200:203], v[200:203], a[72:75]
s_nop 0
ds_read_b128 a[176:179], v2 offset:28672
ds_read_b128 a[180:183], v2 offset:29696
v_mfma_f32_16x16x32_bf16 a[76:79], a[204:207], v[200:203], a[76:79]
v_exp_f32 v188, v188
v_mfma_f32_16x16x32_bf16 a[76:79], a[236:239], v[216:219], a[76:79]
s_nop 0
ds_read_b128 a[184:187], v2 offset:30720
ds_read_b128 a[188:191], v2 offset:31744
v_mfma_f32_16x16x32_bf16 a[80:83], a[240:243], v[216:219], a[80:83]
s_waitcnt lgkmcnt(8)
ds_read_b128 a[224:227], v2 offset:8192
ds_read_b128 a[228:231], v2 offset:9216
v_mfma_f32_16x16x32_bf16 a[80:83], a[208:211], v[200:203], a[80:83]
s_nop 0
ds_read_b128 a[232:235], v2 offset:10240
ds_read_b128 a[236:239], v2 offset:11264
v_mfma_f32_16x16x32_bf16 a[84:87], a[212:215], v[200:203], a[84:87]
ds_read_b128 a[240:243], v2 offset:12288
v_cvt_pk_bf16_f32 v220, v172, v173
v_mfma_f32_16x16x32_bf16 a[84:87], a[244:247], v[216:219], a[84:87]
v_exp_f32 v189, v189
v_mfma_f32_16x16x32_bf16 a[88:91], a[248:251], v[216:219], a[88:91]
v_exp_f32 v190, v190
v_mfma_f32_16x16x32_bf16 a[88:91], a[216:219], v[200:203], a[88:91]
s_nop 0
ds_read_b128 a[244:247], v2 offset:13312
ds_read_b128 a[248:251], v2 offset:14336
v_mfma_f32_16x16x32_bf16 a[92:95], a[220:223], v[200:203], a[92:95]
v_cvt_pk_bf16_f32 v221, v174, v175
v_cvt_pk_bf16_f32 v222, v188, v189
v_mfma_f32_16x16x32_bf16 a[92:95], a[252:255], v[216:219], a[92:95]
v_exp_f32 v191, v191
s_cmp_eq_u32 s58, 0
s_cbranch_scc1 Lta49
s_cmp_eq_u32 s58, 1
s_cbranch_scc1 Lnt50
v_mfma_f32_16x16x32_bf16 v[140:143], a[128:131], v[64:67], v[92:95]
v_exp_f32 v168, v168
v_mfma_f32_16x16x32_bf16 v[156:159], a[144:147], v[64:67], v[92:95]
buffer_store_dwordx4 v[144:147], v1, s[44:47], s70 offen offset:1024 sc1
s_branch Ljoin51
Lta49:
v_mfma_f32_16x16x32_bf16 v[140:143], a[128:131], v[64:67], v[108:111]
v_exp_f32 v168, v168
v_mfma_f32_16x16x32_bf16 v[156:159], a[144:147], v[64:67], v[112:115]
buffer_store_dwordx4 v[144:147], v1, s[44:47], s70 offen offset:1024 sc1
s_branch Ljoin51
Lnt50:
v_mfma_f32_16x16x32_bf16 v[140:143], a[128:131], v[64:67], v[92:95]
v_exp_f32 v168, v168
v_mfma_f32_16x16x32_bf16 v[156:159], a[144:147], v[64:67], v[108:111]
buffer_store_dwordx4 v[144:147], v1, s[44:47], s70 offen offset:1024 sc1
Ljoin51:
v_mfma_f32_16x16x32_bf16 v[140:143], a[132:135], v[68:71], v[140:143]
v_exp_f32 v169, v169
v_mfma_f32_16x16x32_bf16 v[140:143], a[136:139], v[72:75], v[140:143]
v_exp_f32 v170, v170
v_mfma_f32_16x16x32_bf16 v[140:143], a[140:143], v[76:79], v[140:143]
buffer_store_dwordx4 v[160:163], v1, s[44:47], s70 offen offset:2048 sc1
v_mfma_f32_16x16x32_bf16 v[156:159], a[156:159], v[76:79], v[156:159]
ds_read_b128 a[252:255], v2 offset:15360
v_cvt_pk_bf16_f32 v223, v190, v191
v_mfma_f32_16x16x32_bf16 v[156:159], a[152:155], v[72:75], v[156:159]
s_waitcnt vmcnt(24) lgkmcnt(4)
v_exp_f32 v171, v171
v_mfma_f32_16x16x32_bf16 v[156:159], a[148:151], v[68:71], v[156:159]
s_barrier
v_exp_f32 v184, v184
v_add_u32 v2, s82, v1
v_cvt_pk_bf16_f32 v216, v168, v169
v_cvt_pk_bf16_f32 v217, v170, v171
v_exp_f32 v185, v185
v_exp_f32 v186, v186
v_cvt_pk_bf16_f32 v218, v184, v185
v_exp_f32 v187, v187
s_nop 0
v_cvt_pk_bf16_f32 v219, v186, v187
v_mfma_f32_16x16x32_bf16 v[236:239], v[120:123], v[204:207], v[236:239]
s_add_u32 s78, s59, 4
v_exp_f32 v140, v140
v_mfma_f32_16x16x32_bf16 v[236:239], v[120:123], v[220:223], v[236:239]
s_and_b32 s78, s78, 12
v_exp_f32 v141, v141
v_mfma_f32_16x16x32_bf16 a[96:99], a[192:195], v[204:207], a[96:99]
s_lshl_b32 s78, s78, 1
ds_read_b128 a[192:195], v2 offset:0
v_mfma_f32_16x16x32_bf16 a[96:99], a[224:227], v[220:223], a[96:99]
s_lshr_b32 s79, 0x67234501, s78
buffer_store_dwordx4 v[176:179], v1, s[44:47], s70 offen offset:3072 sc1
v_mfma_f32_16x16x32_bf16 a[100:103], a[228:231], v[220:223], a[100:103]
s_add_u32 s70, s70, 0x80000
v_exp_f32 v142, v142
v_mfma_f32_16x16x32_bf16 a[100:103], a[196:199], v[204:207], a[100:103]
s_and_b32 s79, s79, 7
ds_read_b128 a[196:199], v2 offset:1024
v_mfma_f32_16x16x32_bf16 a[104:107], a[200:203], v[204:207], a[104:107]
s_lshl_b32 s79, s79, 18
ds_read_b128 a[200:203], v2 offset:2048
v_mfma_f32_16x16x32_bf16 a[104:107], a[232:235], v[220:223], a[104:107]
s_add_u32 s79, s79, s94
v_exp_f32 v143, v143
v_mfma_f32_16x16x32_bf16 a[108:111], a[236:239], v[220:223], a[108:111]
s_add_u32 s12, s61, 0
v_exp_f32 v156, v156
v_mfma_f32_16x16x32_bf16 a[108:111], a[204:207], v[204:207], a[108:111]
s_and_b32 s12, s12, 3
ds_read_b128 a[204:207], v2 offset:3072
v_mfma_f32_16x16x32_bf16 a[112:115], a[208:211], v[204:207], a[112:115]
s_waitcnt lgkmcnt(4)
ds_read_b128 a[208:211], v2 offset:4096
v_mfma_f32_16x16x32_bf16 a[112:115], a[240:243], v[220:223], a[112:115]
s_lshl_b32 s12, s12, 21
buffer_store_dwordx4 v[132:135], v1, s[44:47], s70 offen sc1
v_mfma_f32_16x16x32_bf16 a[116:119], a[244:247], v[220:223], a[116:119]
s_add_u32 s12, s12, s79
v_exp_f32 v157, v157
v_mfma_f32_16x16x32_bf16 a[116:119], a[212:215], v[204:207], a[116:119]
s_add_u32 s13, s61, 1
ds_read_b128 a[212:215], v2 offset:5120
v_mfma_f32_16x16x32_bf16 a[120:123], a[216:219], v[204:207], a[120:123]
s_and_b32 s13, s13, 3
v_exp_f32 v158, v158
v_mfma_f32_16x16x32_bf16 a[120:123], a[248:251], v[220:223], a[120:123]
s_lshl_b32 s13, s13, 21
ds_read_b128 a[216:219], v2 offset:6144
v_mfma_f32_16x16x32_bf16 a[124:127], a[252:255], v[220:223], a[124:127]
s_add_u32 s13, s13, s79
buffer_store_dwordx4 v[148:151], v1, s[44:47], s70 offen offset:1024 sc1
v_mfma_f32_16x16x32_bf16 a[124:127], a[220:223], v[204:207], a[124:127]
s_add_u32 s14, s61, 2
ds_read_b128 a[220:223], v2 offset:7168
v_cvt_pk_bf16_f32 v204, v140, v141
s_cmp_eq_u32 s58, 2
s_cbranch_scc1 Lta52
s_cmp_eq_u32 s58, 3
s_cbranch_scc1 Lnt53
v_mfma_f32_16x16x32_bf16 v[172:175], a[160:163], v[64:67], v[112:115]
s_and_b32 s14, s14, 3
v_cvt_pk_bf16_f32 v205, v142, v143
v_cvt_pk_bf16_f32 v206, v156, v157
v_mfma_f32_16x16x32_bf16 v[188:191], a[176:179], v[64:67], v[112:115]
s_lshl_b32 s14, s14, 21
v_exp_f32 v159, v159
s_branch Ljoin54
Lta52:
v_mfma_f32_16x16x32_bf16 v[172:175], a[160:163], v[64:67], v[108:111]
s_and_b32 s14, s14, 3
v_cvt_pk_bf16_f32 v205, v142, v143
v_cvt_pk_bf16_f32 v206, v156, v157
v_mfma_f32_16x16x32_bf16 v[188:191], a[176:179], v[64:67], v[112:115]
s_lshl_b32 s14, s14, 21
v_exp_f32 v159, v159
s_branch Ljoin54
Lnt53:
v_mfma_f32_16x16x32_bf16 v[172:175], a[160:163], v[64:67], v[92:95]
s_and_b32 s14, s14, 3
v_cvt_pk_bf16_f32 v205, v142, v143
v_cvt_pk_bf16_f32 v206, v156, v157
v_mfma_f32_16x16x32_bf16 v[188:191], a[176:179], v[64:67], v[108:111]
s_lshl_b32 s14, s14, 21
v_exp_f32 v159, v159
Ljoin54:
v_mfma_f32_16x16x32_bf16 v[172:175], a[164:167], v[68:71], v[172:175]
s_add_u32 s14, s14, s79
v_cvt_pk_bf16_f32 v207, v158, v159
v_mfma_f32_16x16x32_bf16 v[172:175], a[168:171], v[72:75], v[172:175]
s_add_u32 s15, s61, 3
v_mfma_f32_16x16x32_bf16 v[172:175], a[172:175], v[76:79], v[172:175]
s_and_b32 s15, s15, 3
v_mfma_f32_16x16x32_bf16 v[188:191], a[188:191], v[76:79], v[188:191]
s_lshl_b32 s15, s15, 21
v_mfma_f32_16x16x32_bf16 v[188:191], a[184:187], v[72:75], v[188:191]
s_add_u32 s15, s15, s79
v_mfma_f32_16x16x32_bf16 v[188:191], a[180:183], v[68:71], v[188:191]
s_waitcnt lgkmcnt(4)
v_mfma_f32_16x16x32_bf16 v[232:235], v[120:123], v[216:219], v[232:235]
s_add_u32 s82, s82, 0x8000
v_exp_f32 v172, v172
v_mfma_f32_16x16x32_bf16 a[64:67], a[224:227], v[216:219], a[64:67]
s_and_b32 s82, s82, 0x1ffff
ds_read_b128 a[224:227], v2 offset:8192
v_mfma_f32_16x16x32_bf16 a[68:71], a[228:231], v[216:219], a[68:71]
ds_read_b128 a[228:231], v2 offset:9216
v_mfma_f32_16x16x32_bf16 a[72:75], a[232:235], v[216:219], a[72:75]
ds_read_b128 a[232:235], v2 offset:10240
v_mfma_f32_16x16x32_bf16 a[76:79], a[236:239], v[216:219], a[76:79]
buffer_store_dwordx4 v[164:167], v1, s[44:47], s70 offen offset:2048 sc1
v_mfma_f32_16x16x32_bf16 a[80:83], a[240:243], v[216:219], a[80:83]
s_nop 0
ds_read_b128 a[236:239], v2 offset:11264
ds_read_b128 a[240:243], v2 offset:12288
v_mfma_f32_16x16x32_bf16 a[84:87], a[244:247], v[216:219], a[84:87]
ds_read_b128 a[244:247], v2 offset:13312
v_mfma_f32_16x16x32_bf16 a[88:91], a[248:251], v[216:219], a[88:91]
v_exp_f32 v173, v173
v_mfma_f32_16x16x32_bf16 a[92:95], a[252:255], v[216:219], a[92:95]
v_exp_f32 v174, v174
ds_read_b128 a[248:251], v2 offset:14336
ds_read_b128 a[252:255], v2 offset:15360
v_add_u32 v2, s82, v1
buffer_store_dwordx4 v[180:183], v1, s[44:47], s70 offen offset:3072 sc1
v_cvt_pk_bf16_f32 v220, v172, v173
v_exp_f32 v175, v175
v_exp_f32 v188, v188
v_cvt_pk_bf16_f32 v221, v174, v175
v_exp_f32 v189, v189
v_exp_f32 v190, v190
v_cvt_pk_bf16_f32 v222, v188, v189
v_exp_f32 v191, v191
s_nop 0
v_cvt_pk_bf16_f32 v223, v190, v191
s_waitcnt vmcnt(8) lgkmcnt(0)
s_barrier
s_branch LHT4
Lslow:
s_waitcnt vmcnt(0) lgkmcnt(0)
s_barrier
s_mov_b32 s86, 1
s_lshl_b32 s81, s59, 20
s_add_u32 s81, s81, s64
s_sub_u32 s81, s81, 0x4000
s_mov_b32 s83, 0
s_lshl_b32 s75, s60, 3
s_sub_u32 s76, 128, s75
s_add_u32 s74, s75, s58
s_sub_u32 s75, s76, 8
s_add_u32 s75, s75, s58
v_mov_b32 v2, v1
v_lshrrev_b32 v240, 4, v0
v_and_b32 v241, 15, v0
v_lshlrev_b32 v240, 2, v240
v_sub_u32 v240, v241, v240
v_mov_b32 v112, 0xff800000
v_mov_b32 v113, 0xff800000
v_mov_b32 v114, 0xff800000
v_mov_b32 v115, 0xff800000
v_cmp_gt_i32 vcc, 0, v240
v_mov_b32 v120, 0x3f803f80
s_nop 0
v_cndmask_b32 v116, 0, v112, vcc
v_cmp_gt_i32 vcc, 1, v240
v_mov_b32 v121, 0x3f803f80
s_nop 0
v_cndmask_b32 v117, 0, v112, vcc
v_cmp_gt_i32 vcc, 2, v240
v_mov_b32 v122, 0x3f803f80
s_nop 0
v_cndmask_b32 v118, 0, v112, vcc
v_cmp_gt_i32 vcc, 3, v240
v_mov_b32 v123, 0x3f803f80
s_nop 0
v_cndmask_b32 v119, 0, v112, vcc
Lslow1:
s_add_u32 m0, s64, 16384
s_add_u32 s72, s81, 16384
buffer_load_dwordx4 v1, s[44:47], s72 offen sc1 lds
buffer_load_dwordx4 v1, s[44:47], s72 offen offset:1024 sc1 lds
buffer_load_dwordx4 v1, s[44:47], s72 offen offset:2048 sc1 lds
buffer_load_dwordx4 v1, s[44:47], s72 offen offset:3072 sc1 lds
s_add_u32 s81, s81, 0x8000
s_waitcnt vmcnt(0)
s_barrier
ds_read_b128 a[128:131], v2 offset:16384
ds_read_b128 a[132:135], v2 offset:17408
ds_read_b128 a[136:139], v2 offset:18432
ds_read_b128 a[140:143], v2 offset:19456
ds_read_b128 a[144:147], v2 offset:20480
ds_read_b128 a[148:151], v2 offset:21504
ds_read_b128 a[152:155], v2 offset:22528
ds_read_b128 a[156:159], v2 offset:23552
s_waitcnt lgkmcnt(0)
s_add_u32 s73, s74, 0
s_cmp_lt_u32 s73, s83
s_cbranch_scc1 Lsa55
s_cmp_eq_u32 s73, s83
s_cbranch_scc1 Lst56
v_mfma_f32_16x16x32_bf16 v[128:131], a[128:131], v[16:19], 0
s_branch Lsj57
Lst56:
v_mfma_f32_16x16x32_bf16 v[128:131], a[128:131], v[16:19], v[116:119]
Lsj57:
v_mfma_f32_16x16x32_bf16 v[128:131], a[132:135], v[20:23], v[128:131]
v_mfma_f32_16x16x32_bf16 v[128:131], a[136:139], v[24:27], v[128:131]
v_mfma_f32_16x16x32_bf16 v[128:131], a[140:143], v[28:31], v[128:131]
s_nop 7
v_max3_f32 v124, v124, v128, v129
v_max3_f32 v124, v124, v130, v131
Lsa55:
s_add_u32 s73, s74, 4
s_cmp_lt_u32 s73, s83
s_cbranch_scc1 Lsa58
s_cmp_eq_u32 s73, s83
s_cbranch_scc1 Lst59
v_mfma_f32_16x16x32_bf16 v[132:135], a[128:131], v[32:35], 0
s_branch Lsj60
Lst59:
v_mfma_f32_16x16x32_bf16 v[132:135], a[128:131], v[32:35], v[116:119]
Lsj60:
v_mfma_f32_16x16x32_bf16 v[132:135], a[132:135], v[36:39], v[132:135]
v_mfma_f32_16x16x32_bf16 v[132:135], a[136:139], v[40:43], v[132:135]
v_mfma_f32_16x16x32_bf16 v[132:135], a[140:143], v[44:47], v[132:135]
s_nop 7
v_max3_f32 v125, v125, v132, v133
v_max3_f32 v125, v125, v134, v135
Lsa58:
s_add_u32 s73, s75, 0
s_cmp_lt_u32 s73, s83
s_cbranch_scc1 Lsa61
s_cmp_eq_u32 s73, s83
s_cbranch_scc1 Lst62
v_mfma_f32_16x16x32_bf16 v[136:139], a[128:131], v[48:51], 0
s_branch Lsj63
Lst62:
v_mfma_f32_16x16x32_bf16 v[136:139], a[128:131], v[48:51], v[116:119]
Lsj63:
v_mfma_f32_16x16x32_bf16 v[136:139], a[132:135], v[52:55], v[136:139]
v_mfma_f32_16x16x32_bf16 v[136:139], a[136:139], v[56:59], v[136:139]
v_mfma_f32_16x16x32_bf16 v[136:139], a[140:143], v[60:63], v[136:139]
s_nop 7
v_max3_f32 v126, v126, v136, v137
v_max3_f32 v126, v126, v138, v139
Lsa61:
s_add_u32 s73, s75, 4
s_cmp_lt_u32 s73, s83
s_cbranch_scc1 Lsa64
s_cmp_eq_u32 s73, s83
s_cbranch_scc1 Lst65
v_mfma_f32_16x16x32_bf16 v[140:143], a[128:131], v[64:67], 0
s_branch Lsj66
Lst65:
v_mfma_f32_16x16x32_bf16 v[140:143], a[128:131], v[64:67], v[116:119]
Lsj66:
v_mfma_f32_16x16x32_bf16 v[140:143], a[132:135], v[68:71], v[140:143]
v_mfma_f32_16x16x32_bf16 v[140:143], a[136:139], v[72:75], v[140:143]
v_mfma_f32_16x16x32_bf16 v[140:143], a[140:143], v[76:79], v[140:143]
s_nop 7
v_max3_f32 v127, v127, v140, v141
v_max3_f32 v127, v127, v142, v143
Lsa64:
s_add_u32 s83, s83, 1
s_add_u32 s73, s74, 0
s_cmp_lt_u32 s73, s83
s_cbranch_scc1 Lsa67
s_cmp_eq_u32 s73, s83
s_cbranch_scc1 Lst68
v_mfma_f32_16x16x32_bf16 v[144:147], a[144:147], v[16:19], 0
s_branch Lsj69
Lst68:
v_mfma_f32_16x16x32_bf16 v[144:147], a[144:147], v[16:19], v[116:119]
Lsj69:
v_mfma_f32_16x16x32_bf16 v[144:147], a[148:151], v[20:23], v[144:147]
v_mfma_f32_16x16x32_bf16 v[144:147], a[152:155], v[24:27], v[144:147]
v_mfma_f32_16x16x32_bf16 v[144:147], a[156:159], v[28:31], v[144:147]
s_nop 7
v_max3_f32 v124, v124, v144, v145
v_max3_f32 v124, v124, v146, v147
Lsa67:
s_add_u32 s73, s74, 4
s_cmp_lt_u32 s73, s83
s_cbranch_scc1 Lsa70
s_cmp_eq_u32 s73, s83
s_cbranch_scc1 Lst71
v_mfma_f32_16x16x32_bf16 v[148:151], a[144:147], v[32:35], 0
s_branch Lsj72
Lst71:
v_mfma_f32_16x16x32_bf16 v[148:151], a[144:147], v[32:35], v[116:119]
Lsj72:
v_mfma_f32_16x16x32_bf16 v[148:151], a[148:151], v[36:39], v[148:151]
v_mfma_f32_16x16x32_bf16 v[148:151], a[152:155], v[40:43], v[148:151]
v_mfma_f32_16x16x32_bf16 v[148:151], a[156:159], v[44:47], v[148:151]
s_nop 7
v_max3_f32 v125, v125, v148, v149
v_max3_f32 v125, v125, v150, v151
Lsa70:
s_add_u32 s73, s75, 0
s_cmp_lt_u32 s73, s83
s_cbranch_scc1 Lsa73
s_cmp_eq_u32 s73, s83
s_cbranch_scc1 Lst74
v_mfma_f32_16x16x32_bf16 v[152:155], a[144:147], v[48:51], 0
s_branch Lsj75
Lst74:
v_mfma_f32_16x16x32_bf16 v[152:155], a[144:147], v[48:51], v[116:119]
Lsj75:
v_mfma_f32_16x16x32_bf16 v[152:155], a[148:151], v[52:55], v[152:155]
v_mfma_f32_16x16x32_bf16 v[152:155], a[152:155], v[56:59], v[152:155]
v_mfma_f32_16x16x32_bf16 v[152:155], a[156:159], v[60:63], v[152:155]
s_nop 7
v_max3_f32 v126, v126, v152, v153
v_max3_f32 v126, v126, v154, v155
Lsa73:
s_add_u32 s73, s75, 4
s_cmp_lt_u32 s73, s83
s_cbranch_scc1 Lsa76
s_cmp_eq_u32 s73, s83
s_cbranch_scc1 Lst77
v_mfma_f32_16x16x32_bf16 v[156:159], a[144:147], v[64:67], 0
s_branch Lsj78
Lst77:
v_mfma_f32_16x16x32_bf16 v[156:159], a[144:147], v[64:67], v[116:119]
Lsj78:
v_mfma_f32_16x16x32_bf16 v[156:159], a[148:151], v[68:71], v[156:159]
v_mfma_f32_16x16x32_bf16 v[156:159], a[152:155], v[72:75], v[156:159]
v_mfma_f32_16x16x32_bf16 v[156:159], a[156:159], v[76:79], v[156:159]
s_nop 7
v_max3_f32 v127, v127, v156, v157
v_max3_f32 v127, v127, v158, v159
Lsa76:
s_add_u32 s83, s83, 1
ds_read_b128 a[128:131], v2 offset:24576
ds_read_b128 a[132:135], v2 offset:25600
ds_read_b128 a[136:139], v2 offset:26624
ds_read_b128 a[140:143], v2 offset:27648
ds_read_b128 a[144:147], v2 offset:28672
ds_read_b128 a[148:151], v2 offset:29696
ds_read_b128 a[152:155], v2 offset:30720
ds_read_b128 a[156:159], v2 offset:31744
s_waitcnt lgkmcnt(0)
s_add_u32 s73, s74, 0
s_cmp_lt_u32 s73, s83
s_cbranch_scc1 Lsa79
s_cmp_eq_u32 s73, s83
s_cbranch_scc1 Lst80
v_mfma_f32_16x16x32_bf16 v[128:131], a[128:131], v[16:19], 0
s_branch Lsj81
Lst80:
v_mfma_f32_16x16x32_bf16 v[128:131], a[128:131], v[16:19], v[116:119]
Lsj81:
v_mfma_f32_16x16x32_bf16 v[128:131], a[132:135], v[20:23], v[128:131]
v_mfma_f32_16x16x32_bf16 v[128:131], a[136:139], v[24:27], v[128:131]
v_mfma_f32_16x16x32_bf16 v[128:131], a[140:143], v[28:31], v[128:131]
s_nop 7
v_max3_f32 v124, v124, v128, v129
v_max3_f32 v124, v124, v130, v131
Lsa79:
s_add_u32 s73, s74, 4
s_cmp_lt_u32 s73, s83
s_cbranch_scc1 Lsa82
s_cmp_eq_u32 s73, s83
s_cbranch_scc1 Lst83
v_mfma_f32_16x16x32_bf16 v[132:135], a[128:131], v[32:35], 0
s_branch Lsj84
Lst83:
v_mfma_f32_16x16x32_bf16 v[132:135], a[128:131], v[32:35], v[116:119]
Lsj84:
v_mfma_f32_16x16x32_bf16 v[132:135], a[132:135], v[36:39], v[132:135]
v_mfma_f32_16x16x32_bf16 v[132:135], a[136:139], v[40:43], v[132:135]
v_mfma_f32_16x16x32_bf16 v[132:135], a[140:143], v[44:47], v[132:135]
s_nop 7
v_max3_f32 v125, v125, v132, v133
v_max3_f32 v125, v125, v134, v135
Lsa82:
s_add_u32 s73, s75, 0
s_cmp_lt_u32 s73, s83
s_cbranch_scc1 Lsa85
s_cmp_eq_u32 s73, s83
s_cbranch_scc1 Lst86
v_mfma_f32_16x16x32_bf16 v[136:139], a[128:131], v[48:51], 0
s_branch Lsj87
Lst86:
v_mfma_f32_16x16x32_bf16 v[136:139], a[128:131], v[48:51], v[116:119]
Lsj87:
v_mfma_f32_16x16x32_bf16 v[136:139], a[132:135], v[52:55], v[136:139]
v_mfma_f32_16x16x32_bf16 v[136:139], a[136:139], v[56:59], v[136:139]
v_mfma_f32_16x16x32_bf16 v[136:139], a[140:143], v[60:63], v[136:139]
s_nop 7
v_max3_f32 v126, v126, v136, v137
v_max3_f32 v126, v126, v138, v139
Lsa85:
s_add_u32 s73, s75, 4
s_cmp_lt_u32 s73, s83
s_cbranch_scc1 Lsa88
s_cmp_eq_u32 s73, s83
s_cbranch_scc1 Lst89
v_mfma_f32_16x16x32_bf16 v[140:143], a[128:131], v[64:67], 0
s_branch Lsj90
Lst89:
v_mfma_f32_16x16x32_bf16 v[140:143], a[128:131], v[64:67], v[116:119]
Lsj90:
v_mfma_f32_16x16x32_bf16 v[140:143], a[132:135], v[68:71], v[140:143]
v_mfma_f32_16x16x32_bf16 v[140:143], a[136:139], v[72:75], v[140:143]
v_mfma_f32_16x16x32_bf16 v[140:143], a[140:143], v[76:79], v[140:143]
s_nop 7
v_max3_f32 v127, v127, v140, v141
v_max3_f32 v127, v127, v142, v143
Lsa88:
s_add_u32 s83, s83, 1
s_add_u32 s73, s74, 0
s_cmp_lt_u32 s73, s83
s_cbranch_scc1 Lsa91
s_cmp_eq_u32 s73, s83
s_cbranch_scc1 Lst92
v_mfma_f32_16x16x32_bf16 v[144:147], a[144:147], v[16:19], 0
s_branch Lsj93
Lst92:
v_mfma_f32_16x16x32_bf16 v[144:147], a[144:147], v[16:19], v[116:119]
Lsj93:
v_mfma_f32_16x16x32_bf16 v[144:147], a[148:151], v[20:23], v[144:147]
v_mfma_f32_16x16x32_bf16 v[144:147], a[152:155], v[24:27], v[144:147]
v_mfma_f32_16x16x32_bf16 v[144:147], a[156:159], v[28:31], v[144:147]
s_nop 7
v_max3_f32 v124, v124, v144, v145
v_max3_f32 v124, v124, v146, v147
Lsa91:
s_add_u32 s73, s74, 4
s_cmp_lt_u32 s73, s83
s_cbranch_scc1 Lsa94
s_cmp_eq_u32 s73, s83
s_cbranch_scc1 Lst95
v_mfma_f32_16x16x32_bf16 v[148:151], a[144:147], v[32:35], 0
s_branch Lsj96
Lst95:
v_mfma_f32_16x16x32_bf16 v[148:151], a[144:147], v[32:35], v[116:119]
Lsj96:
v_mfma_f32_16x16x32_bf16 v[148:151], a[148:151], v[36:39], v[148:151]
v_mfma_f32_16x16x32_bf16 v[148:151], a[152:155], v[40:43], v[148:151]
v_mfma_f32_16x16x32_bf16 v[148:151], a[156:159], v[44:47], v[148:151]
s_nop 7
v_max3_f32 v125, v125, v148, v149
v_max3_f32 v125, v125, v150, v151
Lsa94:
s_add_u32 s73, s75, 0
s_cmp_lt_u32 s73, s83
s_cbranch_scc1 Lsa97
s_cmp_eq_u32 s73, s83
s_cbranch_scc1 Lst98
v_mfma_f32_16x16x32_bf16 v[152:155], a[144:147], v[48:51], 0
s_branch Lsj99
Lst98:
v_mfma_f32_16x16x32_bf16 v[152:155], a[144:147], v[48:51], v[116:119]
Lsj99:
v_mfma_f32_16x16x32_bf16 v[152:155], a[148:151], v[52:55], v[152:155]
v_mfma_f32_16x16x32_bf16 v[152:155], a[152:155], v[56:59], v[152:155]
v_mfma_f32_16x16x32_bf16 v[152:155], a[156:159], v[60:63], v[152:155]
s_nop 7
v_max3_f32 v126, v126, v152, v153
v_max3_f32 v126, v126, v154, v155
Lsa97:
s_add_u32 s73, s75, 4
s_cmp_lt_u32 s73, s83
s_cbranch_scc1 Lsa100
s_cmp_eq_u32 s73, s83
s_cbranch_scc1 Lst101
v_mfma_f32_16x16x32_bf16 v[156:159], a[144:147], v[64:67], 0
s_branch Lsj102
Lst101:
v_mfma_f32_16x16x32_bf16 v[156:159], a[144:147], v[64:67], v[116:119]
Lsj102:
v_mfma_f32_16x16x32_bf16 v[156:159], a[148:151], v[68:71], v[156:159]
v_mfma_f32_16x16x32_bf16 v[156:159], a[152:155], v[72:75], v[156:159]
v_mfma_f32_16x16x32_bf16 v[156:159], a[156:159], v[76:79], v[156:159]
s_nop 7
v_max3_f32 v127, v127, v156, v157
v_max3_f32 v127, v127, v158, v159
Lsa100:
s_add_u32 s83, s83, 1
s_barrier
s_cmp_lt_u32 s83, s76
s_cbranch_scc1 Lslow1
s_lshl_b32 s81, s59, 20
s_add_u32 s81, s81, s64
s_sub_u32 s81, s81, 0x4000
s_add_u32 m0, s64, 49152
s_add_u32 s72, s81, 16384
buffer_load_dwordx4 v1, s[44:47], s72 offen sc1 lds
buffer_load_dwordx4 v1, s[44:47], s72 offen offset:1024 sc1 lds
buffer_load_dwordx4 v1, s[44:47], s72 offen offset:2048 sc1 lds
buffer_load_dwordx4 v1, s[44:47], s72 offen offset:3072 sc1 lds
s_add_u32 s81, s81, 0x8000
s_add_u32 m0, s64, 81920
s_add_u32 s72, s81, 16384
buffer_load_dwordx4 v1, s[44:47], s72 offen sc1 lds
buffer_load_dwordx4 v1, s[44:47], s72 offen offset:1024 sc1 lds
buffer_load_dwordx4 v1, s[44:47], s72 offen offset:2048 sc1 lds
buffer_load_dwordx4 v1, s[44:47], s72 offen offset:3072 sc1 lds
s_add_u32 m0, s64, 65536
s_add_u32 s72, s81, 0
buffer_load_dwordx4 v1, s[44:47], s72 offen sc1 lds
buffer_load_dwordx4 v1, s[44:47], s72 offen offset:1024 sc1 lds
buffer_load_dwordx4 v1, s[44:47], s72 offen offset:2048 sc1 lds
buffer_load_dwordx4 v1, s[44:47], s72 offen offset:3072 sc1 lds
s_add_u32 s81, s81, 0x8000
s_add_u32 m0, s64, 114688
s_add_u32 s72, s81, 16384
buffer_load_dwordx4 v1, s[44:47], s72 offen sc1 lds
buffer_load_dwordx4 v1, s[44:47], s72 offen offset:1024 sc1 lds
buffer_load_dwordx4 v1, s[44:47], s72 offen offset:2048 sc1 lds
buffer_load_dwordx4 v1, s[44:47], s72 offen offset:3072 sc1 lds
s_add_u32 m0, s64, 98304
s_add_u32 s72, s81, 0
buffer_load_dwordx4 v1, s[44:47], s72 offen sc1 lds
buffer_load_dwordx4 v1, s[44:47], s72 offen offset:1024 sc1 lds
buffer_load_dwordx4 v1, s[44:47], s72 offen offset:2048 sc1 lds
buffer_load_dwordx4 v1, s[44:47], s72 offen offset:3072 sc1 lds
v_add_u32 v2, 0x8000, v1
v_lshrrev_b32 v3, 1, v0
v_lshlrev_b32 v3, 7, v3
s_waitcnt vmcnt(0)
s_barrier
v_accvgpr_write_b32 a32, 0
v_accvgpr_write_b32 a33, 0
v_accvgpr_write_b32 a34, 0
v_accvgpr_write_b32 a35, 0
v_accvgpr_write_b32 a36, 0
v_accvgpr_write_b32 a37, 0
v_accvgpr_write_b32 a38, 0
v_accvgpr_write_b32 a39, 0
v_accvgpr_write_b32 a40, 0
v_accvgpr_write_b32 a41, 0
v_accvgpr_write_b32 a42, 0
v_accvgpr_write_b32 a43, 0
v_accvgpr_write_b32 a44, 0
v_accvgpr_write_b32 a45, 0
v_accvgpr_write_b32 a46, 0
v_accvgpr_write_b32 a47, 0
v_accvgpr_write_b32 a48, 0
v_accvgpr_write_b32 a49, 0
v_accvgpr_write_b32 a50, 0
v_accvgpr_write_b32 a51, 0
v_accvgpr_write_b32 a52, 0
v_accvgpr_write_b32 a53, 0
v_accvgpr_write_b32 a54, 0
v_accvgpr_write_b32 a55, 0
v_accvgpr_write_b32 a56, 0
v_accvgpr_write_b32 a57, 0
v_accvgpr_write_b32 a58, 0
v_accvgpr_write_b32 a59, 0
v_accvgpr_write_b32 a60, 0
v_accvgpr_write_b32 a61, 0
v_accvgpr_write_b32 a62, 0
v_accvgpr_write_b32 a63, 0
v_accvgpr_write_b32 a96, 0
v_accvgpr_write_b32 a97, 0
v_accvgpr_write_b32 a98, 0
v_accvgpr_write_b32 a99, 0
v_accvgpr_write_b32 a100, 0
v_accvgpr_write_b32 a101, 0
v_accvgpr_write_b32 a102, 0
v_accvgpr_write_b32 a103, 0
v_accvgpr_write_b32 a104, 0
v_accvgpr_write_b32 a105, 0
v_accvgpr_write_b32 a106, 0
v_accvgpr_write_b32 a107, 0
v_accvgpr_write_b32 a108, 0
v_accvgpr_write_b32 a109, 0
v_accvgpr_write_b32 a110, 0
v_accvgpr_write_b32 a111, 0
v_accvgpr_write_b32 a112, 0
v_accvgpr_write_b32 a113, 0
v_accvgpr_write_b32 a114, 0
v_accvgpr_write_b32 a115, 0
v_accvgpr_write_b32 a116, 0
v_accvgpr_write_b32 a117, 0
v_accvgpr_write_b32 a118, 0
v_accvgpr_write_b32 a119, 0
v_accvgpr_write_b32 a120, 0
v_accvgpr_write_b32 a121, 0
v_accvgpr_write_b32 a122, 0
v_accvgpr_write_b32 a123, 0
v_accvgpr_write_b32 a124, 0
v_accvgpr_write_b32 a125, 0
v_accvgpr_write_b32 a126, 0
v_accvgpr_write_b32 a127, 0
ds_read_b128 a[128:131], v2 offset:16384
ds_read_b128 a[132:135], v2 offset:17408
ds_read_b128 a[136:139], v2 offset:18432
ds_read_b128 a[140:143], v2 offset:19456
ds_read_b128 a[144:147], v2 offset:20480
ds_read_b128 a[148:151], v2 offset:21504
ds_read_b128 a[152:155], v2 offset:22528
ds_read_b128 a[156:159], v2 offset:23552
s_branch Lattn
Lspin103:
s_mov_b32 s83, 262144
Lsl105:
s_sleep 2
buffer_load_dword v3, v2, s[44:47], s82 offen sc1
s_sub_u32 s83, s83, 1
s_cmp_eq_u32 s83, 0
s_waitcnt vmcnt(0)
s_cbranch_scc1 Lback104
v_cmp_gt_u32 vcc, 2, v3
s_cbranch_vccnz Lsl105
s_branch Lback104
Lspin106:
s_mov_b32 s83, 262144
Lsl108:
s_sleep 2
buffer_load_dword v3, v2, s[44:47], s82 offen sc1
s_sub_u32 s83, s83, 1
s_cmp_eq_u32 s83, 0
s_waitcnt vmcnt(0)
s_cbranch_scc1 Lback107
v_cmp_gt_u32 vcc, 2, v3
s_cbranch_vccnz Lsl108
s_branch Lback107
Lredo0:
s_xor_b32 s82, s78, 0
s_lshl_b32 s82, s82, 10
s_add_u32 s82, s82, s74
buffer_load_dword v3, v2, s[44:47], s82 offen sc1
s_waitcnt vmcnt(0)
v_cmp_gt_u32 vcc, 2, v3
s_cbranch_vccnz Lspin103
Lback104:
s_lshr_b32 s69, s12, 18
s_lshl_b32 s69, s69, 12
s_add_u32 s69, s69, s95
buffer_load_dwordx4 a[0:3], v1, s[44:47], s69 offen sc1
buffer_load_dwordx4 a[4:7], v1, s[44:47], s69 offen offset:1024 sc1
buffer_load_dwordx4 a[8:11], v1, s[44:47], s69 offen offset:2048 sc1
buffer_load_dwordx4 a[12:15], v1, s[44:47], s69 offen offset:3072 sc1
s_add_u32 s69, s69, 0x20000
buffer_load_dwordx4 a[16:19], v1, s[44:47], s69 offen sc1
buffer_load_dwordx4 a[20:23], v1, s[44:47], s69 offen offset:1024 sc1
buffer_load_dwordx4 a[24:27], v1, s[44:47], s69 offen offset:2048 sc1
buffer_load_dwordx4 a[28:31], v1, s[44:47], s69 offen offset:3072 sc1
s_lshr_b32 s69, s13, 18
s_lshl_b32 s69, s69, 12
s_add_u32 s69, s69, s95
buffer_load_dwordx4 a[32:35], v1, s[44:47], s69 offen sc1
buffer_load_dwordx4 a[36:39], v1, s[44:47], s69 offen offset:1024 sc1
buffer_load_dwordx4 a[40:43], v1, s[44:47], s69 offen offset:2048 sc1
buffer_load_dwordx4 a[44:47], v1, s[44:47], s69 offen offset:3072 sc1
s_add_u32 s69, s69, 0x20000
buffer_load_dwordx4 a[48:51], v1, s[44:47], s69 offen sc1
buffer_load_dwordx4 a[52:55], v1, s[44:47], s69 offen offset:1024 sc1
buffer_load_dwordx4 a[56:59], v1, s[44:47], s69 offen offset:2048 sc1
buffer_load_dwordx4 a[60:63], v1, s[44:47], s69 offen offset:3072 sc1
s_waitcnt vmcnt(8)
s_branch Lredo0b
Lspin109:
s_mov_b32 s83, 262144
Lsl111:
s_sleep 2
buffer_load_dword v114, v115, s[44:47], s84 offen sc1
s_sub_u32 s83, s83, 1
s_cmp_eq_u32 s83, 0
s_waitcnt vmcnt(0)
s_cbranch_scc1 Lback110
v_cmp_gt_u32 vcc, 3, v114
s_cbranch_vccnz Lsl111
s_branch Lback110
Lspin112:
s_mov_b32 s83, 262144
Lsl114:
s_sleep 2
buffer_load_dword v14, v13, s[44:47], s79 offen sc1
s_sub_u32 s83, s83, 1
s_cmp_eq_u32 s83, 0
s_waitcnt vmcnt(0)
s_cbranch_scc1 Lback113
v_cmp_gt_u32 vcc, 2, v14
s_cbranch_vccnz Lsl114
s_branch Lback113
Lxspin1:
s_mov_b32 s83, 262144
Lxsl1:
buffer_load_dwordx4 v[96:99], v1, s[44:47], s79 offen sc1
buffer_load_dwordx4 v[100:103], v1, s[44:47], s79 offen offset:1024 sc1
buffer_load_dwordx4 v[104:107], v1, s[44:47], s79 offen offset:2048 sc1
buffer_load_dwordx4 v[108:111], v1, s[44:47], s79 offen offset:3072 sc1
s_sub_u32 s83, s83, 1
s_cmp_eq_u32 s83, 0
s_waitcnt vmcnt(0)
s_cbranch_scc1 Lxback1
v_max3_u32 v12, v96, v97, v98
v_max3_u32 v13, v99, v100, v101
v_max3_u32 v12, v12, v102, v103
v_max3_u32 v13, v13, v104, v105
v_max3_u32 v12, v12, v106, v107
v_max3_u32 v13, v13, v108, v109
v_max3_u32 v12, v12, v110, v111
v_max_u32 v12, v12, v13
v_cmp_le_u32 vcc, 0xff800000, v12
s_cbranch_vccnz Lxsl1
s_branch Lxback1
Lxspin2:
s_mov_b32 s83, 262144
Lxsl2:
buffer_load_dwordx4 v[80:83], v1, s[44:47], s82 offen sc1
buffer_load_dwordx4 v[84:87], v1, s[44:47], s82 offen offset:1024 sc1
buffer_load_dwordx4 v[88:91], v1, s[44:47], s82 offen offset:2048 sc1
buffer_load_dwordx4 v[92:95], v1, s[44:47], s82 offen offset:3072 sc1
s_sub_u32 s83, s83, 1
s_cmp_eq_u32 s83, 0
s_waitcnt vmcnt(0)
s_cbranch_scc1 Lxback2
v_max3_u32 v12, v80, v81, v82
v_max3_u32 v13, v83, v84, v85
v_max3_u32 v12, v12, v86, v87
v_max3_u32 v13, v13, v88, v89
v_max3_u32 v12, v12, v90, v91
v_max3_u32 v13, v13, v92, v93
v_max3_u32 v12, v12, v94, v95
v_max_u32 v12, v12, v13
v_cmp_le_u32 vcc, 0xff800000, v12
s_cbranch_vccnz Lxsl2
s_branch Lxback2
Lxspin3:
s_mov_b32 s83, 262144
Lxsl3:
buffer_load_dwordx4 v[96:99], v1, s[44:47], s81 offen sc1
buffer_load_dwordx4 v[100:103], v1, s[44:47], s81 offen offset:1024 sc1
buffer_load_dwordx4 v[104:107], v1, s[44:47], s81 offen offset:2048 sc1
buffer_load_dwordx4 v[108:111], v1, s[44:47], s81 offen offset:3072 sc1
s_sub_u32 s83, s83, 1
s_cmp_eq_u32 s83, 0
s_waitcnt vmcnt(0)
s_cbranch_scc1 Lxback3
v_max3_u32 v12, v96, v97, v98
v_max3_u32 v13, v99, v100, v101
v_max3_u32 v12, v12, v102, v103
v_max3_u32 v13, v13, v104, v105
v_max3_u32 v12, v12, v106, v107
v_max3_u32 v13, v13, v108, v109
v_max3_u32 v12, v12, v110, v111
v_max_u32 v12, v12, v13
v_cmp_le_u32 vcc, 0xff800000, v12
s_cbranch_vccnz Lxsl3
s_branch Lxback3
Lcode_end:
s_endpgm
.section .rodata,"a"
.p2align 6
.amdhsa_kernel gated_mix__compressed_kv_cla__ssm_conv_h3__prompt_kernel
  .amdhsa_next_free_vgpr 512
  .amdhsa_next_free_sgpr 102
  .amdhsa_accum_offset 256
  .amdhsa_group_segment_fixed_size 0
  .amdhsa_kernarg_size 128
  .amdhsa_user_sgpr_count 2
  .amdhsa_user_sgpr_kernarg_segment_ptr 1
  .amdhsa_system_sgpr_workgroup_id_x 1
  .amdhsa_float_denorm_mode_32 3
.end_amdhsa_kernel
```

```asm
; @launch grid=(256,1,1) block=(256,1,1) lds=163840
.amdgcn_target "amdgcn-amd-amdhsa--gfx950"
.text
.globl gated_mix__compressed_kv_cla__ssm_conv_h3__prompt_kernel
.p2align 8
.type gated_mix__compressed_kv_cla__ssm_conv_h3__prompt_kernel,@function
gated_mix__compressed_kv_cla__ssm_conv_h3__prompt_kernel:
s_cmp_ge_u32 s2, 256
s_cbranch_scc1 Lend
s_load_dwordx2 s[8:9], s[0:1], 8
s_load_dwordx2 s[16:17], s[0:1], 24
s_load_dwordx2 s[20:21], s[0:1], 32
s_load_dwordx2 s[4:5], s[0:1], 0
s_load_dwordx2 s[12:13], s[0:1], 16
s_load_dwordx2 s[24:25], s[0:1], 40
s_load_dwordx2 s[28:29], s[0:1], 56
s_load_dwordx2 s[32:33], s[0:1], 64
s_load_dwordx2 s[52:53], s[0:1], 72
s_load_dwordx2 s[36:37], s[0:1], 80
s_load_dwordx2 s[54:55], s[0:1], 88
s_load_dwordx2 s[56:57], s[0:1], 96
s_load_dwordx2 s[40:41], s[0:1], 104
s_load_dwordx2 s[48:49], s[0:1], 112
s_load_dwordx2 s[44:45], s[0:1], 120
s_getpc_b64 s[98:99]
Lpc0:
s_lshr_b32 s75, s2, 3
v_mul_u32_u24 v26, 18, v0
s_mul_i32 s73, s75, 4608
v_and_b32 v26, 0x1f80, v26
v_add_u32 v26, s73, v26
v_min_u32 v26, Lcode_end-Lpc0, v26
global_load_dword v31, v26, s[98:99]
v_lshrrev_b32 v26, 6, v0
v_and_b32 v0, 63, v0
s_and_b32 s73, s2, 7
v_readfirstlane_b32 s58, v26
s_lshr_b32 s65, s75, 3
s_and_b32 s60, s75, 7
s_lshl_b32 s59, s73, 2
s_add_u32 s59, s59, s65
s_lshl_b32 s61, s65, 1
s_lshl_b32 s63, s58, 13
s_lshl_b32 s64, s58, 12
s_lshl_b32 s67, s60, 18
s_lshl_b32 s76, s58, 16
s_add_u32 s84, s67, s76
s_lshl_b32 s66, s58, 17
s_lshl_b32 s73, s73, 2
s_lshr_b32 s73, 0x67234501, s73
s_and_b32 s73, s73, 7
s_lshl_b32 s74, s65, 3
s_add_u32 s73, s73, s74
s_lshl_b32 s73, s73, 8
s_add_u32 s66, s66, s73
v_lshrrev_b32 v26, 4, v0
v_and_b32 v27, 7, v0
v_xor_b32 v27, v27, v26
v_lshlrev_b32 v27, 4, v27
v_lshrrev_b32 v28, 3, v0
v_lshl_add_u32 v2, v28, 10, v27
v_xor_b32 v3, 64, v2
v_and_b32 v29, 15, v0
v_lshlrev_b32 v30, 1, v26
v_xor_b32 v30, v30, v29
v_lshlrev_b32 v30, 4, v30
v_lshl_add_u32 v6, v26, 13, v30
v_xor_b32 v7, 0x80, v6
s_mov_b32 s10, 0x200000
s_mov_b32 s11, 0x20000
s_mov_b32 s18, 0x400000
s_mov_b32 s19, 0x20000
s_mov_b32 s22, 0x400000
s_mov_b32 s23, 0x20000
s_lshl_b32 s73, s2, 2
s_add_u32 s73, s73, s58
s_lshl_b32 s73, s73, 11
v_lshrrev_b32 v124, 2, v0
v_lshlrev_b32 v124, 7, v124
v_add_u32 v124, s73, v124
s_lshr_b32 s73, s2, 3
s_lshl_b32 s73, s73, 2
s_add_u32 s73, s73, s58
s_lshl_b32 s73, s73, 13
s_and_b32 s74, s66, 0x700
s_add_u32 s73, s73, s74
v_lshrrev_b32 v125, 4, v0
v_lshlrev_b32 v125, 11, v125
v_bfe_u32 v126, v0, 3, 1
v_lshl_add_u32 v125, v126, 7, v125
v_add_u32 v125, s73, v125
s_waitcnt lgkmcnt(0)
s_and_b32 s73, s65, 1
s_xor_b32 s73, s73, 0
s_lshl_b32 s69, s73, 7
s_add_u32 s69, s69, s84
s_lshl_b32 s71, s73, 19
s_add_u32 s71, s71, s66
s_add_u32 m0, s63, 65536
s_add_u32 s72, s69, 0
buffer_load_dwordx4 v2, s[8:11], s72 offen lds
s_add_u32 s72, s69, 7168
buffer_load_dwordx4 v3, s[8:11], s72 offen offset:1024 lds
s_add_u32 s72, s69, 14336
buffer_load_dwordx4 v2, s[8:11], s72 offen offset:2048 lds
s_add_u32 s72, s69, 21504
buffer_load_dwordx4 v3, s[8:11], s72 offen offset:3072 lds
s_add_u32 m0, s64, 0
s_add_u32 s72, s71, 0
buffer_load_dwordx4 v6, s[16:19], s72 offen lds
s_add_u32 s72, s71, 31744
buffer_load_dwordx4 v6, s[16:19], s72 offen offset:1024 lds
s_add_u32 s72, s71, 63488
buffer_load_dwordx4 v7, s[16:19], s72 offen offset:2048 lds
s_add_u32 s72, s71, 95232
buffer_load_dwordx4 v7, s[16:19], s72 offen offset:3072 lds
s_add_u32 m0, s63, 69632
s_add_u32 s72, s69, 32768
buffer_load_dwordx4 v2, s[8:11], s72 offen lds
s_add_u32 s72, s69, 39936
buffer_load_dwordx4 v3, s[8:11], s72 offen offset:1024 lds
s_add_u32 s72, s69, 47104
buffer_load_dwordx4 v2, s[8:11], s72 offen offset:2048 lds
s_add_u32 s72, s69, 54272
buffer_load_dwordx4 v3, s[8:11], s72 offen offset:3072 lds
s_add_u32 m0, s64, 16384
s_add_u32 s72, s71, 0
buffer_load_dwordx4 v6, s[20:23], s72 offen lds
s_add_u32 s72, s71, 31744
buffer_load_dwordx4 v6, s[20:23], s72 offen offset:1024 lds
s_add_u32 s72, s71, 63488
buffer_load_dwordx4 v7, s[20:23], s72 offen offset:2048 lds
s_add_u32 s72, s71, 95232
buffer_load_dwordx4 v7, s[20:23], s72 offen offset:3072 lds
s_mov_b32 s80, 0x0
buffer_load_dword v126, v125, s[16:19], s80 offen
buffer_load_dword v126, v125, s[20:23], s80 offen
buffer_load_dword v126, v124, s[8:11], 0 offen
s_and_b32 s73, s65, 1
s_xor_b32 s73, s73, 1
s_lshl_b32 s69, s73, 7
s_add_u32 s69, s69, s84
s_lshl_b32 s71, s73, 19
s_add_u32 s71, s71, s66
s_add_u32 m0, s63, 98304
s_add_u32 s72, s69, 0
buffer_load_dwordx4 v2, s[8:11], s72 offen lds
s_add_u32 s72, s69, 7168
buffer_load_dwordx4 v3, s[8:11], s72 offen offset:1024 lds
s_add_u32 s72, s69, 14336
buffer_load_dwordx4 v2, s[8:11], s72 offen offset:2048 lds
s_add_u32 s72, s69, 21504
buffer_load_dwordx4 v3, s[8:11], s72 offen offset:3072 lds
s_branch Lmain
.p2align 12
Lmain:
s_mov_b32 s6, 0x400000
s_mov_b32 s7, 0x20000
s_mov_b32 s14, 0x800000
s_mov_b32 s15, 0x20000
s_mov_b32 s26, 0x800000
s_mov_b32 s27, 0x20000
s_mov_b32 s30, 0x400000
s_mov_b32 s31, 0x20000
s_mov_b32 s34, 0x400000
s_mov_b32 s35, 0x20000
s_mov_b32 s38, 0x400000
s_mov_b32 s39, 0x20000
s_mov_b32 s42, 0x400000
s_mov_b32 s43, 0x20000
s_mov_b32 s46, 0x5800000
s_mov_b32 s47, 0x20000
s_mov_b32 s50, 0x100
s_mov_b32 s51, 0x20000
v_lshl_add_u32 v4, v28, 11, v27
v_xor_b32 v5, 64, v4
v_lshlrev_b32 v1, 4, v0
s_sub_u32 s74, 15, s60
s_lshl_b32 s68, s74, 18
s_lshl_b32 s76, s58, 15
s_add_u32 s68, s68, s76
s_add_u32 s67, s67, s76
s_and_b32 s62, s60, 3
s_sub_u32 s62, 16, s62
s_lshl_b32 s91, s59, 3
s_add_u32 s91, s91, s60
s_lshl_b32 s93, s91, 2
s_add_u32 s93, s93, s58
s_lshl_b32 s91, s91, 7
s_add_u32 s91, s91, 0x3810000
s_lshl_b32 s75, s93, 1
s_and_b32 s75, s75, 0xffc
s_lshl_b32 s93, s93, 12
s_load_dwordx2 s[88:89], s[36:37], s93
s_load_dword s90, s[54:55], s75
v_lshrrev_b32 v29, 3, v0
v_or_b32 v29, s58, v29
v_min_u32 v29, 1, v29
v_lshlrev_b32 v29, 28, v29
v_add_lshl_u32 v29, v29, v0, 2
v_mov_b32 v30, 0
buffer_store_dword v30, v29, s[44:47], s91 offen sc1
s_xor_b32 s73, s2, 5
s_and_b32 s73, s73, 15
s_lshr_b32 s74, s2, 4
s_lshl_b32 s74, s74, 7
s_lshl_b32 s75, s58, 5
s_add_u32 s74, s74, s75
s_mov_b32 s75, 131072
v_lshrrev_b32 v29, 5, v0
v_lshlrev_b32 v29, 4, v29
v_add_u32 v29, s74, v29
v_and_b32 v30, 31, v0
s_lshl_b32 s73, s73, 5
v_add_u32 v30, s73, v30
v_lshlrev_b32 v26, 11, v29
v_lshl_add_u32 v26, v30, 2, v26
v_subrev_u32 v27, 0x1800, v26
s_lshl_b32 s82, s74, 11
s_lshl_b32 s73, s73, 2
s_add_u32 s82, s82, s73
v_lshrrev_b32 v26, 3, v0
v_and_b32 v32, 7, v0
v_lshlrev_b32 v32, 4, v32
v_lshl_add_u32 v26, v26, 11, v32
v_lshrrev_b32 v98, 5, v0
v_lshlrev_b32 v98, 11, v98
v_and_b32 v32, 31, v0
v_lshl_add_u32 v98, v32, 2, v98
v_add_u32 v98, s63, v98
v_add_u32 v98, s75, v98
v_and_b32 v29, 0x7f, v29
v_sub_u32 v29, 0x70, v29
v_lshlrev_b32 v29, 1, v29
v_and_b32 v32, 7, v0
v_mul_u32_u24 v32, 544, v32
v_add3_u32 v28, v32, v29, s75
v_bfe_u32 v32, v0, 3, 2
v_lshl_add_u32 v28, v32, 13, v28
v_lshlrev_b32 v30, 4, v30
s_lshl_b32 s73, s2, 14
s_lshl_b32 s74, s58, 12
s_add_u32 s76, s73, s74
v_and_b32 v29, 15, v0
v_lshrrev_b32 v32, 4, v0
v_lshrrev_b32 v24, 1, v29
v_xor_b32 v24, v24, v32
v_lshlrev_b32 v24, 4, v24
v_lshl_add_u32 v24, v29, 7, v24
s_add_u32 s73, s63, 131072
v_add_u32 v16, s73, v24
v_xor_b32 v17, 64, v16
v_subrev_u32 v18, 0x10000, v16
v_subrev_u32 v19, 0x10000, v17
s_lshr_b32 s73, s58, 1
s_lshl_b32 s74, s73, 14
s_add_u32 s74, s74, 0x10000
v_add_u32 v24, s74, v24
v_xor_b32 v25, 64, v24
v_lshrrev_b32 v8, 2, v29
v_and_b32 v9, 1, v32
v_lshl_add_u32 v9, v9, 2, v8
v_lshl_add_u32 v8, v32, 3, v8
v_lshlrev_b32 v8, 8, v8
v_lshl_add_u32 v8, v9, 5, v8
v_and_b32 v29, 3, v0
v_lshl_add_u32 v8, v29, 3, v8
s_and_b32 s74, s58, 1
s_lshl_b32 s75, s74, 7
v_xor_b32 v20, s75, v8
v_xor_b32 v9, 32, v8
v_xor_b32 v10, 64, v8
v_xor_b32 v11, 96, v8
v_xor_b32 v12, 128, v8
v_xor_b32 v13, 160, v8
v_xor_b32 v14, 192, v8
v_xor_b32 v15, 224, v8
v_xor_b32 v21, 32, v20
v_xor_b32 v22, 64, v20
v_xor_b32 v23, 96, v20
s_lshl_b32 s77, s59, 20
s_add_u32 s81, s77, s64
s_sub_u32 s81, s81, 0x4000
s_lshl_b32 s75, s60, 17
s_add_u32 s77, s77, s75
s_lshl_b32 s73, s73, 16
s_add_u32 s77, s77, s73
s_lshl_b32 s75, s74, 12
s_add_u32 s78, s77, s75
s_add_u32 s78, s78, 0x4000
s_lshl_b32 s75, s74, 11
s_add_u32 s77, s77, s75
s_mov_b32 s79, 0x3e0293ee
s_waitcnt vmcnt(8)
s_barrier
ds_read_b64_tr_b16 v[224:225], v20 offset:0
ds_read_b64_tr_b16 v[226:227], v20 offset:1024
ds_read_b64_tr_b16 v[228:229], v20 offset:8192
ds_read_b64_tr_b16 v[230:231], v20 offset:9216
ds_read_b128 v[128:131], v24 offset:0
ds_read_b128 v[132:135], v25 offset:0
ds_read_b128 v[136:139], v24 offset:2048
ds_read_b128 v[140:143], v25 offset:2048
ds_read_b128 v[144:147], v24 offset:4096
ds_read_b128 v[148:151], v25 offset:4096
ds_read_b128 v[152:155], v24 offset:6144
ds_read_b128 v[156:159], v25 offset:6144
ds_read_b128 v[160:163], v24 offset:8192
ds_read_b128 v[164:167], v25 offset:8192
ds_read_b128 v[168:171], v24 offset:10240
ds_read_b128 v[172:175], v25 offset:10240
ds_read_b128 v[176:179], v24 offset:12288
ds_read_b128 v[180:183], v25 offset:12288
ds_read_b128 v[184:187], v24 offset:14336
ds_read_b128 v[188:191], v25 offset:14336
ds_read_b64_tr_b16 v[232:233], v21 offset:0
ds_read_b64_tr_b16 v[234:235], v21 offset:1024
ds_read_b64_tr_b16 v[236:237], v21 offset:8192
ds_read_b64_tr_b16 v[238:239], v21 offset:9216
s_waitcnt lgkmcnt(0)
v_mfma_f32_16x16x32_bf16 a[0:3], v[224:227], v[128:131], 0
s_add_u32 m0, s64, 32768
ds_read_b64_tr_b16 v[240:241], v22 offset:0
v_mfma_f32_16x16x32_bf16 a[0:3], v[228:231], v[132:135], a[0:3]
s_add_u32 s72, s71, 0
buffer_load_dwordx4 v6, s[16:19], s72 offen lds
v_mfma_f32_16x16x32_bf16 a[4:7], v[228:231], v[140:143], 0
s_add_u32 s72, s71, 31744
buffer_load_dwordx4 v6, s[16:19], s72 offen offset:1024 lds
v_mfma_f32_16x16x32_bf16 a[4:7], v[224:227], v[136:139], a[4:7]
ds_read_b64_tr_b16 v[242:243], v22 offset:1024
v_mfma_f32_16x16x32_bf16 a[8:11], v[224:227], v[144:147], 0
s_add_u32 s72, s71, 63488
buffer_load_dwordx4 v7, s[16:19], s72 offen offset:2048 lds
v_mfma_f32_16x16x32_bf16 a[8:11], v[228:231], v[148:151], a[8:11]
v_mfma_f32_16x16x32_bf16 a[12:15], v[228:231], v[156:159], 0
s_add_u32 s72, s71, 95232
buffer_load_dwordx4 v7, s[16:19], s72 offen offset:3072 lds
v_mfma_f32_16x16x32_bf16 a[12:15], v[224:227], v[152:155], a[12:15]
ds_read_b64_tr_b16 v[244:245], v22 offset:8192
v_mfma_f32_16x16x32_bf16 a[16:19], v[224:227], v[160:163], 0
s_add_u32 m0, s63, 102400
v_mfma_f32_16x16x32_bf16 a[16:19], v[228:231], v[164:167], a[16:19]
s_add_u32 s72, s69, 32768
buffer_load_dwordx4 v2, s[8:11], s72 offen lds
v_mfma_f32_16x16x32_bf16 a[20:23], v[228:231], v[172:175], 0
s_add_u32 s72, s69, 39936
buffer_load_dwordx4 v3, s[8:11], s72 offen offset:1024 lds
v_mfma_f32_16x16x32_bf16 a[20:23], v[224:227], v[168:171], a[20:23]
ds_read_b64_tr_b16 v[246:247], v22 offset:9216
v_mfma_f32_16x16x32_bf16 a[24:27], v[224:227], v[176:179], 0
s_add_u32 s72, s69, 47104
buffer_load_dwordx4 v2, s[8:11], s72 offen offset:2048 lds
v_mfma_f32_16x16x32_bf16 a[24:27], v[228:231], v[180:183], a[24:27]
v_mfma_f32_16x16x32_bf16 a[28:31], v[228:231], v[188:191], 0
s_add_u32 s72, s69, 54272
buffer_load_dwordx4 v3, s[8:11], s72 offen offset:3072 lds
v_mfma_f32_16x16x32_bf16 a[28:31], v[224:227], v[184:187], a[28:31]
v_mfma_f32_16x16x32_bf16 a[60:63], v[232:235], v[184:187], 0
s_add_u32 m0, s64, 49152
ds_read_b64_tr_b16 v[248:249], v23 offset:0
v_mfma_f32_16x16x32_bf16 a[60:63], v[236:239], v[188:191], a[60:63]
s_add_u32 s72, s71, 0
buffer_load_dwordx4 v6, s[20:23], s72 offen lds
v_mfma_f32_16x16x32_bf16 a[56:59], v[236:239], v[180:183], 0
s_add_u32 s72, s71, 31744
buffer_load_dwordx4 v6, s[20:23], s72 offen offset:1024 lds
v_mfma_f32_16x16x32_bf16 a[56:59], v[232:235], v[176:179], a[56:59]
v_mfma_f32_16x16x32_bf16 a[52:55], v[232:235], v[168:171], 0
s_add_u32 s72, s71, 63488
buffer_load_dwordx4 v7, s[20:23], s72 offen offset:2048 lds
v_mfma_f32_16x16x32_bf16 a[52:55], v[236:239], v[172:175], a[52:55]
ds_read_b64_tr_b16 v[250:251], v23 offset:1024
v_mfma_f32_16x16x32_bf16 a[48:51], v[236:239], v[164:167], 0
s_add_u32 s72, s71, 95232
buffer_load_dwordx4 v7, s[20:23], s72 offen offset:3072 lds
v_mfma_f32_16x16x32_bf16 a[48:51], v[232:235], v[160:163], a[48:51]
s_mov_b32 s80, 0x100000
buffer_load_dword v126, v125, s[16:19], s80 offen
v_mfma_f32_16x16x32_bf16 a[44:47], v[232:235], v[152:155], 0
buffer_load_dword v126, v125, s[20:23], s80 offen
v_mfma_f32_16x16x32_bf16 a[44:47], v[236:239], v[156:159], a[44:47]
v_mfma_f32_16x16x32_bf16 a[40:43], v[236:239], v[148:151], 0
ds_read_b64_tr_b16 v[252:253], v23 offset:8192
v_mfma_f32_16x16x32_bf16 a[40:43], v[232:235], v[144:147], a[40:43]
v_mfma_f32_16x16x32_bf16 a[36:39], v[232:235], v[136:139], 0
ds_read_b64_tr_b16 v[254:255], v23 offset:9216
v_mfma_f32_16x16x32_bf16 a[36:39], v[236:239], v[140:143], a[36:39]
v_mfma_f32_16x16x32_bf16 a[32:35], v[236:239], v[132:135], 0
v_mfma_f32_16x16x32_bf16 a[32:35], v[232:235], v[128:131], a[32:35]
s_waitcnt lgkmcnt(4)
v_mfma_f32_16x16x32_bf16 a[64:67], v[240:243], v[128:131], 0
ds_read_b64_tr_b16 v[224:225], v20 offset:16384
v_mfma_f32_16x16x32_bf16 a[64:67], v[244:247], v[132:135], a[64:67]
v_mfma_f32_16x16x32_bf16 a[68:71], v[244:247], v[140:143], 0
v_mfma_f32_16x16x32_bf16 a[68:71], v[240:243], v[136:139], a[68:71]
ds_read_b64_tr_b16 v[226:227], v20 offset:17408
v_mfma_f32_16x16x32_bf16 a[72:75], v[240:243], v[144:147], 0
v_mfma_f32_16x16x32_bf16 a[72:75], v[244:247], v[148:151], a[72:75]
v_mfma_f32_16x16x32_bf16 a[76:79], v[244:247], v[156:159], 0
v_mfma_f32_16x16x32_bf16 a[76:79], v[240:243], v[152:155], a[76:79]
ds_read_b64_tr_b16 v[228:229], v20 offset:24576
v_mfma_f32_16x16x32_bf16 a[80:83], v[240:243], v[160:163], 0
v_mfma_f32_16x16x32_bf16 a[80:83], v[244:247], v[164:167], a[80:83]
v_mfma_f32_16x16x32_bf16 a[84:87], v[244:247], v[172:175], 0
ds_read_b64_tr_b16 v[230:231], v20 offset:25600
v_mfma_f32_16x16x32_bf16 a[84:87], v[240:243], v[168:171], a[84:87]
v_mfma_f32_16x16x32_bf16 a[88:91], v[240:243], v[176:179], 0
v_mfma_f32_16x16x32_bf16 a[88:91], v[244:247], v[180:183], a[88:91]
v_mfma_f32_16x16x32_bf16 a[92:95], v[244:247], v[188:191], 0
v_mfma_f32_16x16x32_bf16 a[92:95], v[240:243], v[184:187], a[92:95]
s_waitcnt lgkmcnt(4)
v_mfma_f32_16x16x32_bf16 a[124:127], v[248:251], v[184:187], 0
ds_read_b64_tr_b16 v[232:233], v21 offset:16384
v_mfma_f32_16x16x32_bf16 a[124:127], v[252:255], v[188:191], a[124:127]
v_mfma_f32_16x16x32_bf16 a[120:123], v[252:255], v[180:183], 0
v_mfma_f32_16x16x32_bf16 a[120:123], v[248:251], v[176:179], a[120:123]
ds_read_b64_tr_b16 v[234:235], v21 offset:17408
v_mfma_f32_16x16x32_bf16 a[116:119], v[248:251], v[168:171], 0
v_mfma_f32_16x16x32_bf16 a[116:119], v[252:255], v[172:175], a[116:119]
v_mfma_f32_16x16x32_bf16 a[112:115], v[252:255], v[164:167], 0
v_mfma_f32_16x16x32_bf16 a[112:115], v[248:251], v[160:163], a[112:115]
ds_read_b64_tr_b16 v[236:237], v21 offset:24576
v_mfma_f32_16x16x32_bf16 a[108:111], v[248:251], v[152:155], 0
v_mfma_f32_16x16x32_bf16 a[108:111], v[252:255], v[156:159], a[108:111]
v_mfma_f32_16x16x32_bf16 a[104:107], v[252:255], v[148:151], 0
ds_read_b64_tr_b16 v[238:239], v21 offset:25600
v_mfma_f32_16x16x32_bf16 a[104:107], v[248:251], v[144:147], a[104:107]
v_mfma_f32_16x16x32_bf16 a[100:103], v[248:251], v[136:139], 0
v_mfma_f32_16x16x32_bf16 a[100:103], v[252:255], v[140:143], a[100:103]
v_mfma_f32_16x16x32_bf16 a[96:99], v[252:255], v[132:135], 0
v_mfma_f32_16x16x32_bf16 a[96:99], v[248:251], v[128:131], a[96:99]
s_waitcnt lgkmcnt(4)
v_mfma_f32_16x16x32_bf16 a[128:131], v[128:131], v[224:227], 0
ds_read_b64_tr_b16 v[240:241], v22 offset:16384
v_mfma_f32_16x16x32_bf16 a[128:131], v[132:135], v[228:231], a[128:131]
v_mfma_f32_16x16x32_bf16 a[132:135], v[140:143], v[228:231], 0
v_mfma_f32_16x16x32_bf16 a[132:135], v[136:139], v[224:227], a[132:135]
ds_read_b64_tr_b16 v[242:243], v22 offset:17408
v_mfma_f32_16x16x32_bf16 a[136:139], v[144:147], v[224:227], 0
v_mfma_f32_16x16x32_bf16 a[136:139], v[148:151], v[228:231], a[136:139]
v_mfma_f32_16x16x32_bf16 a[140:143], v[156:159], v[228:231], 0
v_mfma_f32_16x16x32_bf16 a[140:143], v[152:155], v[224:227], a[140:143]
ds_read_b64_tr_b16 v[244:245], v22 offset:24576
v_mfma_f32_16x16x32_bf16 a[144:147], v[160:163], v[224:227], 0
v_mfma_f32_16x16x32_bf16 a[144:147], v[164:167], v[228:231], a[144:147]
v_mfma_f32_16x16x32_bf16 a[148:151], v[172:175], v[228:231], 0
ds_read_b64_tr_b16 v[246:247], v22 offset:25600
v_mfma_f32_16x16x32_bf16 a[148:151], v[168:171], v[224:227], a[148:151]
v_mfma_f32_16x16x32_bf16 a[152:155], v[176:179], v[224:227], 0
v_mfma_f32_16x16x32_bf16 a[152:155], v[180:183], v[228:231], a[152:155]
v_mfma_f32_16x16x32_bf16 a[156:159], v[188:191], v[228:231], 0
v_mfma_f32_16x16x32_bf16 a[156:159], v[184:187], v[224:227], a[156:159]
s_waitcnt lgkmcnt(4)
v_mfma_f32_16x16x32_bf16 a[188:191], v[184:187], v[232:235], 0
ds_read_b64_tr_b16 v[248:249], v23 offset:16384
v_mfma_f32_16x16x32_bf16 a[188:191], v[188:191], v[236:239], a[188:191]
v_mfma_f32_16x16x32_bf16 a[184:187], v[180:183], v[236:239], 0
ds_read_b64_tr_b16 v[250:251], v23 offset:17408
v_mfma_f32_16x16x32_bf16 a[184:187], v[176:179], v[232:235], a[184:187]
v_mfma_f32_16x16x32_bf16 a[180:183], v[168:171], v[232:235], 0
ds_read_b64_tr_b16 v[252:253], v23 offset:24576
v_mfma_f32_16x16x32_bf16 a[180:183], v[172:175], v[236:239], a[180:183]
v_mfma_f32_16x16x32_bf16 a[176:179], v[164:167], v[236:239], 0
ds_read_b64_tr_b16 v[254:255], v23 offset:25600
v_mfma_f32_16x16x32_bf16 a[176:179], v[160:163], v[232:235], a[176:179]
v_mfma_f32_16x16x32_bf16 a[172:175], v[152:155], v[232:235], 0
v_mfma_f32_16x16x32_bf16 a[172:175], v[156:159], v[236:239], a[172:175]
v_mfma_f32_16x16x32_bf16 a[168:171], v[148:151], v[236:239], 0
v_mfma_f32_16x16x32_bf16 a[168:171], v[144:147], v[232:235], a[168:171]
v_mfma_f32_16x16x32_bf16 a[164:167], v[136:139], v[232:235], 0
v_mfma_f32_16x16x32_bf16 a[164:167], v[140:143], v[236:239], a[164:167]
v_mfma_f32_16x16x32_bf16 a[160:163], v[132:135], v[236:239], 0
s_waitcnt vmcnt(2) lgkmcnt(0)
v_mfma_f32_16x16x32_bf16 a[160:163], v[128:131], v[232:235], a[160:163]
s_barrier
v_mfma_f32_16x16x32_bf16 a[192:195], v[128:131], v[240:243], 0
s_and_b32 s73, s65, 1
ds_read_b64_tr_b16 v[224:225], v20 offset:32768
v_mfma_f32_16x16x32_bf16 a[192:195], v[132:135], v[244:247], a[192:195]
s_xor_b32 s73, s73, 2
ds_read_b64_tr_b16 v[226:227], v20 offset:33792
v_mfma_f32_16x16x32_bf16 a[196:199], v[140:143], v[244:247], 0
s_lshl_b32 s69, s73, 7
ds_read_b64_tr_b16 v[228:229], v20 offset:40960
v_mfma_f32_16x16x32_bf16 a[196:199], v[136:139], v[240:243], a[196:199]
s_add_u32 s69, s69, s84
ds_read_b64_tr_b16 v[230:231], v20 offset:41984
v_mfma_f32_16x16x32_bf16 a[200:203], v[144:147], v[240:243], 0
s_lshl_b32 s71, s73, 19
ds_read_b128 v[192:195], v24 offset:32768
v_mfma_f32_16x16x32_bf16 a[200:203], v[148:151], v[244:247], a[200:203]
s_add_u32 s71, s71, s66
ds_read_b128 v[196:199], v25 offset:32768
v_mfma_f32_16x16x32_bf16 a[204:207], v[156:159], v[244:247], 0
s_add_u32 m0, s63, 65536
v_mfma_f32_16x16x32_bf16 a[204:207], v[152:155], v[240:243], a[204:207]
s_add_u32 s72, s69, 0
buffer_load_dwordx4 v2, s[8:11], s72 offen lds
v_mfma_f32_16x16x32_bf16 a[208:211], v[160:163], v[240:243], 0
s_add_u32 s72, s69, 7168
buffer_load_dwordx4 v3, s[8:11], s72 offen offset:1024 lds
v_mfma_f32_16x16x32_bf16 a[208:211], v[164:167], v[244:247], a[208:211]
s_add_u32 s72, s69, 14336
buffer_load_dwordx4 v2, s[8:11], s72 offen offset:2048 lds
v_mfma_f32_16x16x32_bf16 a[212:215], v[172:175], v[244:247], 0
ds_read_b128 v[200:203], v24 offset:34816
v_mfma_f32_16x16x32_bf16 a[212:215], v[168:171], v[240:243], a[212:215]
ds_read_b128 v[204:207], v25 offset:34816
v_mfma_f32_16x16x32_bf16 a[216:219], v[176:179], v[240:243], 0
s_add_u32 s72, s69, 21504
buffer_load_dwordx4 v3, s[8:11], s72 offen offset:3072 lds
v_mfma_f32_16x16x32_bf16 a[216:219], v[180:183], v[244:247], a[216:219]
ds_read_b128 v[208:211], v24 offset:36864
v_mfma_f32_16x16x32_bf16 a[220:223], v[188:191], v[244:247], 0
ds_read_b128 v[212:215], v25 offset:36864
v_mfma_f32_16x16x32_bf16 a[220:223], v[184:187], v[240:243], a[220:223]
ds_read_b128 v[216:219], v24 offset:38912
v_mfma_f32_16x16x32_bf16 a[252:255], v[184:187], v[248:251], 0
ds_read_b128 v[220:223], v25 offset:38912
v_mfma_f32_16x16x32_bf16 a[252:255], v[188:191], v[252:255], a[252:255]
s_add_u32 m0, s64, 0
v_mfma_f32_16x16x32_bf16 a[248:251], v[180:183], v[252:255], 0
s_add_u32 s72, s71, 0
buffer_load_dwordx4 v6, s[16:19], s72 offen lds
v_mfma_f32_16x16x32_bf16 a[248:251], v[176:179], v[248:251], a[248:251]
ds_read_b128 v[184:187], v24 offset:40960
v_mfma_f32_16x16x32_bf16 a[244:247], v[168:171], v[248:251], 0
ds_read_b128 v[188:191], v25 offset:40960
v_mfma_f32_16x16x32_bf16 a[244:247], v[172:175], v[252:255], a[244:247]
s_add_u32 s72, s71, 31744
buffer_load_dwordx4 v6, s[16:19], s72 offen offset:1024 lds
v_mfma_f32_16x16x32_bf16 a[240:243], v[164:167], v[252:255], 0
ds_read_b128 v[176:179], v24 offset:43008
v_mfma_f32_16x16x32_bf16 a[240:243], v[160:163], v[248:251], a[240:243]
ds_read_b128 v[180:183], v25 offset:43008
v_mfma_f32_16x16x32_bf16 a[236:239], v[152:155], v[248:251], 0
ds_read_b128 v[168:171], v24 offset:45056
v_mfma_f32_16x16x32_bf16 a[236:239], v[156:159], v[252:255], a[236:239]
s_add_u32 s72, s71, 63488
buffer_load_dwordx4 v7, s[16:19], s72 offen offset:2048 lds
v_mfma_f32_16x16x32_bf16 a[232:235], v[148:151], v[252:255], 0
ds_read_b128 v[172:175], v25 offset:45056
v_mfma_f32_16x16x32_bf16 a[232:235], v[144:147], v[248:251], a[232:235]
ds_read_b128 v[160:163], v24 offset:47104
v_mfma_f32_16x16x32_bf16 a[228:231], v[136:139], v[248:251], 0
ds_read_b128 v[164:167], v25 offset:47104
v_mfma_f32_16x16x32_bf16 a[228:231], v[140:143], v[252:255], a[228:231]
v_mfma_f32_16x16x32_bf16 a[224:227], v[132:135], v[252:255], 0
s_add_u32 s72, s71, 95232
buffer_load_dwordx4 v7, s[16:19], s72 offen offset:3072 lds
v_mfma_f32_16x16x32_bf16 a[224:227], v[128:131], v[248:251], a[224:227]
s_waitcnt lgkmcnt(8)
ds_read_b64_tr_b16 v[232:233], v21 offset:32768
v_mfma_f32_16x16x32_bf16 a[0:3], v[224:227], v[192:195], a[0:3]
ds_read_b64_tr_b16 v[234:235], v21 offset:33792
v_mfma_f32_16x16x32_bf16 a[0:3], v[228:231], v[196:199], a[0:3]
ds_read_b64_tr_b16 v[240:241], v22 offset:32768
v_mfma_f32_16x16x32_bf16 a[4:7], v[228:231], v[204:207], a[4:7]
s_add_u32 m0, s63, 69632
ds_read_b64_tr_b16 v[236:237], v21 offset:40960
v_mfma_f32_16x16x32_bf16 a[4:7], v[224:227], v[200:203], a[4:7]
s_add_u32 s72, s69, 32768
buffer_load_dwordx4 v2, s[8:11], s72 offen lds
v_mfma_f32_16x16x32_bf16 a[8:11], v[224:227], v[208:211], a[8:11]
ds_read_b64_tr_b16 v[238:239], v21 offset:41984
v_mfma_f32_16x16x32_bf16 a[8:11], v[228:231], v[212:215], a[8:11]
v_mfma_f32_16x16x32_bf16 a[12:15], v[228:231], v[220:223], a[12:15]
s_add_u32 s72, s69, 39936
buffer_load_dwordx4 v3, s[8:11], s72 offen offset:1024 lds
v_mfma_f32_16x16x32_bf16 a[12:15], v[224:227], v[216:219], a[12:15]
s_waitcnt lgkmcnt(5)
ds_read_b64_tr_b16 v[242:243], v22 offset:33792
v_mfma_f32_16x16x32_bf16 a[16:19], v[224:227], v[184:187], a[16:19]
v_mfma_f32_16x16x32_bf16 a[16:19], v[228:231], v[188:191], a[16:19]
ds_read_b64_tr_b16 v[244:245], v22 offset:40960
v_mfma_f32_16x16x32_bf16 a[20:23], v[228:231], v[180:183], a[20:23]
v_mfma_f32_16x16x32_bf16 a[20:23], v[224:227], v[176:179], a[20:23]
s_add_u32 s72, s69, 47104
buffer_load_dwordx4 v2, s[8:11], s72 offen offset:2048 lds
v_mfma_f32_16x16x32_bf16 a[24:27], v[224:227], v[168:171], a[24:27]
ds_read_b64_tr_b16 v[246:247], v22 offset:41984
v_mfma_f32_16x16x32_bf16 a[24:27], v[228:231], v[172:175], a[24:27]
v_mfma_f32_16x16x32_bf16 a[28:31], v[228:231], v[164:167], a[28:31]
v_mfma_f32_16x16x32_bf16 a[28:31], v[224:227], v[160:163], a[28:31]
s_waitcnt lgkmcnt(3)
v_mfma_f32_16x16x32_bf16 a[60:63], v[232:235], v[160:163], a[60:63]
s_add_u32 s72, s69, 54272
buffer_load_dwordx4 v3, s[8:11], s72 offen offset:3072 lds
v_mfma_f32_16x16x32_bf16 a[60:63], v[236:239], v[164:167], a[60:63]
ds_read_b64_tr_b16 v[248:249], v23 offset:32768
v_mfma_f32_16x16x32_bf16 a[56:59], v[236:239], v[172:175], a[56:59]
v_mfma_f32_16x16x32_bf16 a[56:59], v[232:235], v[168:171], a[56:59]
s_add_u32 m0, s64, 16384
ds_read_b64_tr_b16 v[250:251], v23 offset:33792
v_mfma_f32_16x16x32_bf16 a[52:55], v[232:235], v[176:179], a[52:55]
s_add_u32 s72, s71, 0
buffer_load_dwordx4 v6, s[20:23], s72 offen lds
v_mfma_f32_16x16x32_bf16 a[52:55], v[236:239], v[180:183], a[52:55]
v_mfma_f32_16x16x32_bf16 a[48:51], v[236:239], v[188:191], a[48:51]
v_mfma_f32_16x16x32_bf16 a[48:51], v[232:235], v[184:187], a[48:51]
ds_read_b64_tr_b16 v[252:253], v23 offset:40960
v_mfma_f32_16x16x32_bf16 a[44:47], v[232:235], v[216:219], a[44:47]
s_add_u32 s72, s71, 31744
buffer_load_dwordx4 v6, s[20:23], s72 offen offset:1024 lds
v_mfma_f32_16x16x32_bf16 a[44:47], v[236:239], v[220:223], a[44:47]
v_mfma_f32_16x16x32_bf16 a[40:43], v[236:239], v[212:215], a[40:43]
ds_read_b64_tr_b16 v[254:255], v23 offset:41984
v_mfma_f32_16x16x32_bf16 a[40:43], v[232:235], v[208:211], a[40:43]
v_mfma_f32_16x16x32_bf16 a[36:39], v[232:235], v[200:203], a[36:39]
s_add_u32 s72, s71, 63488
buffer_load_dwordx4 v7, s[20:23], s72 offen offset:2048 lds
v_mfma_f32_16x16x32_bf16 a[36:39], v[236:239], v[204:207], a[36:39]
v_mfma_f32_16x16x32_bf16 a[32:35], v[236:239], v[196:199], a[32:35]
v_mfma_f32_16x16x32_bf16 a[32:35], v[232:235], v[192:195], a[32:35]
s_waitcnt lgkmcnt(4)
v_mfma_f32_16x16x32_bf16 a[64:67], v[240:243], v[192:195], a[64:67]
s_add_u32 s72, s71, 95232
buffer_load_dwordx4 v7, s[20:23], s72 offen offset:3072 lds
v_mfma_f32_16x16x32_bf16 a[64:67], v[244:247], v[196:199], a[64:67]
s_mov_b32 s80, 0x200000
buffer_load_dword v126, v125, s[16:19], s80 offen
v_mfma_f32_16x16x32_bf16 a[68:71], v[244:247], v[204:207], a[68:71]
buffer_load_dword v126, v125, s[20:23], s80 offen
v_mfma_f32_16x16x32_bf16 a[68:71], v[240:243], v[200:203], a[68:71]
global_load_dwordx4 v[68:71], v30, s[52:53]
v_mfma_f32_16x16x32_bf16 a[72:75], v[240:243], v[208:211], a[72:75]
buffer_load_dword v33, v27, s[28:31], 0 offen nt
v_mfma_f32_16x16x32_bf16 a[72:75], v[244:247], v[212:215], a[72:75]
buffer_load_dword v34, v27, s[28:31], 0 offen offset:2048 nt
v_mfma_f32_16x16x32_bf16 a[76:79], v[244:247], v[220:223], a[76:79]
v_add_u32 v27, 0x1000, v27
v_mfma_f32_16x16x32_bf16 a[76:79], v[240:243], v[216:219], a[76:79]
buffer_load_dword v35, v27, s[28:31], 0 offen nt
v_mfma_f32_16x16x32_bf16 a[80:83], v[240:243], v[184:187], a[80:83]
s_add_u32 m0, s63, 131072
ds_read_b64_tr_b16 v[224:225], v20 offset:49152
ds_read_b64_tr_b16 v[226:227], v20 offset:50176
v_mfma_f32_16x16x32_bf16 a[80:83], v[244:247], v[188:191], a[80:83]
s_add_u32 s80, s82, 0
buffer_load_dwordx4 v26, s[28:31], s80 offen nt lds
v_mfma_f32_16x16x32_bf16 a[84:87], v[244:247], v[180:183], a[84:87]
s_add_u32 s80, s82, 15360
buffer_load_dwordx4 v26, s[28:31], s80 offen offset:1024 nt lds
v_mfma_f32_16x16x32_bf16 a[84:87], v[240:243], v[176:179], a[84:87]
s_add_u32 s80, s82, 30720
buffer_load_dwordx4 v26, s[28:31], s80 offen offset:2048 nt lds
v_mfma_f32_16x16x32_bf16 a[88:91], v[240:243], v[168:171], a[88:91]
s_add_u32 s80, s82, 46080
buffer_load_dwordx4 v26, s[28:31], s80 offen offset:3072 nt lds
v_mfma_f32_16x16x32_bf16 a[88:91], v[244:247], v[172:175], a[88:91]
ds_read_b64_tr_b16 v[228:229], v20 offset:57344
ds_read_b64_tr_b16 v[230:231], v20 offset:58368
v_mfma_f32_16x16x32_bf16 a[92:95], v[244:247], v[164:167], a[92:95]
v_mfma_f32_16x16x32_bf16 a[92:95], v[240:243], v[160:163], a[92:95]
s_waitcnt lgkmcnt(4)
v_mfma_f32_16x16x32_bf16 a[124:127], v[248:251], v[160:163], a[124:127]
ds_read_b64_tr_b16 v[232:233], v21 offset:49152
v_mfma_f32_16x16x32_bf16 a[124:127], v[252:255], v[164:167], a[124:127]
v_mfma_f32_16x16x32_bf16 a[120:123], v[252:255], v[172:175], a[120:123]
v_mfma_f32_16x16x32_bf16 a[120:123], v[248:251], v[168:171], a[120:123]
ds_read_b64_tr_b16 v[234:235], v21 offset:50176
v_mfma_f32_16x16x32_bf16 a[116:119], v[248:251], v[176:179], a[116:119]
v_mfma_f32_16x16x32_bf16 a[116:119], v[252:255], v[180:183], a[116:119]
v_mfma_f32_16x16x32_bf16 a[112:115], v[252:255], v[188:191], a[112:115]
v_mfma_f32_16x16x32_bf16 a[112:115], v[248:251], v[184:187], a[112:115]
ds_read_b64_tr_b16 v[236:237], v21 offset:57344
v_mfma_f32_16x16x32_bf16 a[108:111], v[248:251], v[216:219], a[108:111]
v_mfma_f32_16x16x32_bf16 a[108:111], v[252:255], v[220:223], a[108:111]
v_mfma_f32_16x16x32_bf16 a[104:107], v[252:255], v[212:215], a[104:107]
ds_read_b64_tr_b16 v[238:239], v21 offset:58368
v_mfma_f32_16x16x32_bf16 a[104:107], v[248:251], v[208:211], a[104:107]
v_mfma_f32_16x16x32_bf16 a[100:103], v[248:251], v[200:203], a[100:103]
v_mfma_f32_16x16x32_bf16 a[100:103], v[252:255], v[204:207], a[100:103]
v_mfma_f32_16x16x32_bf16 a[96:99], v[252:255], v[196:199], a[96:99]
v_mfma_f32_16x16x32_bf16 a[96:99], v[248:251], v[192:195], a[96:99]
s_waitcnt lgkmcnt(4)
v_mfma_f32_16x16x32_bf16 a[128:131], v[192:195], v[224:227], a[128:131]
ds_read_b64_tr_b16 v[240:241], v22 offset:49152
v_mfma_f32_16x16x32_bf16 a[128:131], v[196:199], v[228:231], a[128:131]
v_mfma_f32_16x16x32_bf16 a[132:135], v[204:207], v[228:231], a[132:135]
v_mfma_f32_16x16x32_bf16 a[132:135], v[200:203], v[224:227], a[132:135]
ds_read_b64_tr_b16 v[242:243], v22 offset:50176
v_mfma_f32_16x16x32_bf16 a[136:139], v[208:211], v[224:227], a[136:139]
v_mfma_f32_16x16x32_bf16 a[136:139], v[212:215], v[228:231], a[136:139]
v_mfma_f32_16x16x32_bf16 a[140:143], v[220:223], v[228:231], a[140:143]
v_mfma_f32_16x16x32_bf16 a[140:143], v[216:219], v[224:227], a[140:143]
ds_read_b64_tr_b16 v[244:245], v22 offset:57344
v_mfma_f32_16x16x32_bf16 a[144:147], v[184:187], v[224:227], a[144:147]
v_mfma_f32_16x16x32_bf16 a[144:147], v[188:191], v[228:231], a[144:147]
v_mfma_f32_16x16x32_bf16 a[148:151], v[180:183], v[228:231], a[148:151]
ds_read_b64_tr_b16 v[246:247], v22 offset:58368
v_mfma_f32_16x16x32_bf16 a[148:151], v[176:179], v[224:227], a[148:151]
v_mfma_f32_16x16x32_bf16 a[152:155], v[168:171], v[224:227], a[152:155]
v_mfma_f32_16x16x32_bf16 a[152:155], v[172:175], v[228:231], a[152:155]
v_mfma_f32_16x16x32_bf16 a[156:159], v[164:167], v[228:231], a[156:159]
v_mfma_f32_16x16x32_bf16 a[156:159], v[160:163], v[224:227], a[156:159]
s_waitcnt lgkmcnt(4)
v_mfma_f32_16x16x32_bf16 a[188:191], v[160:163], v[232:235], a[188:191]
ds_read_b64_tr_b16 v[248:249], v23 offset:49152
v_mfma_f32_16x16x32_bf16 a[188:191], v[164:167], v[236:239], a[188:191]
v_mfma_f32_16x16x32_bf16 a[184:187], v[172:175], v[236:239], a[184:187]
ds_read_b64_tr_b16 v[250:251], v23 offset:50176
v_mfma_f32_16x16x32_bf16 a[184:187], v[168:171], v[232:235], a[184:187]
v_mfma_f32_16x16x32_bf16 a[180:183], v[176:179], v[232:235], a[180:183]
ds_read_b64_tr_b16 v[252:253], v23 offset:57344
v_mfma_f32_16x16x32_bf16 a[180:183], v[180:183], v[236:239], a[180:183]
v_mfma_f32_16x16x32_bf16 a[176:179], v[188:191], v[236:239], a[176:179]
ds_read_b64_tr_b16 v[254:255], v23 offset:58368
v_mfma_f32_16x16x32_bf16 a[176:179], v[184:187], v[232:235], a[176:179]
v_mfma_f32_16x16x32_bf16 a[172:175], v[216:219], v[232:235], a[172:175]
v_mfma_f32_16x16x32_bf16 a[172:175], v[220:223], v[236:239], a[172:175]
v_mfma_f32_16x16x32_bf16 a[168:171], v[212:215], v[236:239], a[168:171]
v_mfma_f32_16x16x32_bf16 a[168:171], v[208:211], v[232:235], a[168:171]
v_mfma_f32_16x16x32_bf16 a[164:167], v[200:203], v[232:235], a[164:167]
v_mfma_f32_16x16x32_bf16 a[164:167], v[204:207], v[236:239], a[164:167]
v_mfma_f32_16x16x32_bf16 a[160:163], v[196:199], v[236:239], a[160:163]
s_waitcnt vmcnt(10) lgkmcnt(0)
v_mfma_f32_16x16x32_bf16 a[160:163], v[192:195], v[232:235], a[160:163]
s_barrier
v_mfma_f32_16x16x32_bf16 a[192:195], v[192:195], v[240:243], a[192:195]
s_and_b32 s73, s65, 1
ds_read_b64_tr_b16 v[224:225], v20 offset:0
v_mfma_f32_16x16x32_bf16 a[192:195], v[196:199], v[244:247], a[192:195]
s_xor_b32 s73, s73, 3
ds_read_b64_tr_b16 v[226:227], v20 offset:1024
v_mfma_f32_16x16x32_bf16 a[196:199], v[204:207], v[244:247], a[196:199]
s_lshl_b32 s69, s73, 7
ds_read_b64_tr_b16 v[228:229], v20 offset:8192
v_mfma_f32_16x16x32_bf16 a[196:199], v[200:203], v[240:243], a[196:199]
s_add_u32 s69, s69, s84
ds_read_b64_tr_b16 v[230:231], v20 offset:9216
v_mfma_f32_16x16x32_bf16 a[200:203], v[208:211], v[240:243], a[200:203]
s_lshl_b32 s71, s73, 19
ds_read_b128 v[128:131], v24 offset:0
v_mfma_f32_16x16x32_bf16 a[200:203], v[212:215], v[244:247], a[200:203]
s_add_u32 s71, s71, s66
ds_read_b128 v[132:135], v25 offset:0
v_mfma_f32_16x16x32_bf16 a[204:207], v[220:223], v[244:247], a[204:207]
s_add_u32 m0, s63, 98304
v_mfma_f32_16x16x32_bf16 a[204:207], v[216:219], v[240:243], a[204:207]
s_add_u32 s72, s69, 0
buffer_load_dwordx4 v2, s[8:11], s72 offen lds
v_mfma_f32_16x16x32_bf16 a[208:211], v[184:187], v[240:243], a[208:211]
s_add_u32 s72, s69, 7168
buffer_load_dwordx4 v3, s[8:11], s72 offen offset:1024 lds
v_mfma_f32_16x16x32_bf16 a[208:211], v[188:191], v[244:247], a[208:211]
s_add_u32 s72, s69, 14336
buffer_load_dwordx4 v2, s[8:11], s72 offen offset:2048 lds
v_mfma_f32_16x16x32_bf16 a[212:215], v[180:183], v[244:247], a[212:215]
ds_read_b128 v[136:139], v24 offset:2048
v_mfma_f32_16x16x32_bf16 a[212:215], v[176:179], v[240:243], a[212:215]
ds_read_b128 v[140:143], v25 offset:2048
v_mfma_f32_16x16x32_bf16 a[216:219], v[168:171], v[240:243], a[216:219]
s_add_u32 s72, s69, 21504
buffer_load_dwordx4 v3, s[8:11], s72 offen offset:3072 lds
v_mfma_f32_16x16x32_bf16 a[216:219], v[172:175], v[244:247], a[216:219]
ds_read_b128 v[144:147], v24 offset:4096
v_mfma_f32_16x16x32_bf16 a[220:223], v[164:167], v[244:247], a[220:223]
ds_read_b128 v[148:151], v25 offset:4096
v_mfma_f32_16x16x32_bf16 a[220:223], v[160:163], v[240:243], a[220:223]
ds_read_b128 v[152:155], v24 offset:6144
v_mfma_f32_16x16x32_bf16 a[252:255], v[160:163], v[248:251], a[252:255]
ds_read_b128 v[156:159], v25 offset:6144
v_mfma_f32_16x16x32_bf16 a[252:255], v[164:167], v[252:255], a[252:255]
s_add_u32 m0, s64, 32768
v_mfma_f32_16x16x32_bf16 a[248:251], v[172:175], v[252:255], a[248:251]
s_add_u32 s72, s71, 0
buffer_load_dwordx4 v6, s[16:19], s72 offen lds
v_mfma_f32_16x16x32_bf16 a[248:251], v[168:171], v[248:251], a[248:251]
ds_read_b128 v[160:163], v24 offset:8192
v_mfma_f32_16x16x32_bf16 a[244:247], v[176:179], v[248:251], a[244:247]
ds_read_b128 v[164:167], v25 offset:8192
v_mfma_f32_16x16x32_bf16 a[244:247], v[180:183], v[252:255], a[244:247]
s_add_u32 s72, s71, 31744
buffer_load_dwordx4 v6, s[16:19], s72 offen offset:1024 lds
v_mfma_f32_16x16x32_bf16 a[240:243], v[188:191], v[252:255], a[240:243]
ds_read_b128 v[168:171], v24 offset:10240
v_mfma_f32_16x16x32_bf16 a[240:243], v[184:187], v[248:251], a[240:243]
ds_read_b128 v[172:175], v25 offset:10240
v_mfma_f32_16x16x32_bf16 a[236:239], v[216:219], v[248:251], a[236:239]
ds_read_b128 v[176:179], v24 offset:12288
v_mfma_f32_16x16x32_bf16 a[236:239], v[220:223], v[252:255], a[236:239]
s_add_u32 s72, s71, 63488
buffer_load_dwordx4 v7, s[16:19], s72 offen offset:2048 lds
v_mfma_f32_16x16x32_bf16 a[232:235], v[212:215], v[252:255], a[232:235]
ds_read_b128 v[180:183], v25 offset:12288
v_mfma_f32_16x16x32_bf16 a[232:235], v[208:211], v[248:251], a[232:235]
ds_read_b128 v[184:187], v24 offset:14336
v_mfma_f32_16x16x32_bf16 a[228:231], v[200:203], v[248:251], a[228:231]
ds_read_b128 v[188:191], v25 offset:14336
v_mfma_f32_16x16x32_bf16 a[228:231], v[204:207], v[252:255], a[228:231]
v_mfma_f32_16x16x32_bf16 a[224:227], v[196:199], v[252:255], a[224:227]
s_add_u32 s72, s71, 95232
buffer_load_dwordx4 v7, s[16:19], s72 offen offset:3072 lds
v_mfma_f32_16x16x32_bf16 a[224:227], v[192:195], v[248:251], a[224:227]
s_waitcnt lgkmcnt(8)
ds_read_b64_tr_b16 v[232:233], v21 offset:0
v_mfma_f32_16x16x32_bf16 a[0:3], v[224:227], v[128:131], a[0:3]
ds_read_b64_tr_b16 v[234:235], v21 offset:1024
v_mfma_f32_16x16x32_bf16 a[0:3], v[228:231], v[132:135], a[0:3]
ds_read_b64_tr_b16 v[240:241], v22 offset:0
v_mfma_f32_16x16x32_bf16 a[4:7], v[228:231], v[140:143], a[4:7]
s_add_u32 m0, s63, 102400
ds_read_b64_tr_b16 v[236:237], v21 offset:8192
v_mfma_f32_16x16x32_bf16 a[4:7], v[224:227], v[136:139], a[4:7]
s_add_u32 s72, s69, 32768
buffer_load_dwordx4 v2, s[8:11], s72 offen lds
v_mfma_f32_16x16x32_bf16 a[8:11], v[224:227], v[144:147], a[8:11]
ds_read_b64_tr_b16 v[238:239], v21 offset:9216
v_mfma_f32_16x16x32_bf16 a[8:11], v[228:231], v[148:151], a[8:11]
v_mfma_f32_16x16x32_bf16 a[12:15], v[228:231], v[156:159], a[12:15]
s_add_u32 s72, s69, 39936
buffer_load_dwordx4 v3, s[8:11], s72 offen offset:1024 lds
v_mfma_f32_16x16x32_bf16 a[12:15], v[224:227], v[152:155], a[12:15]
s_waitcnt lgkmcnt(5)
ds_read_b64_tr_b16 v[242:243], v22 offset:1024
v_mfma_f32_16x16x32_bf16 a[16:19], v[224:227], v[160:163], a[16:19]
v_mfma_f32_16x16x32_bf16 a[16:19], v[228:231], v[164:167], a[16:19]
ds_read_b64_tr_b16 v[244:245], v22 offset:8192
v_mfma_f32_16x16x32_bf16 a[20:23], v[228:231], v[172:175], a[20:23]
v_mfma_f32_16x16x32_bf16 a[20:23], v[224:227], v[168:171], a[20:23]
s_add_u32 s72, s69, 47104
buffer_load_dwordx4 v2, s[8:11], s72 offen offset:2048 lds
v_mfma_f32_16x16x32_bf16 a[24:27], v[224:227], v[176:179], a[24:27]
ds_read_b64_tr_b16 v[246:247], v22 offset:9216
v_mfma_f32_16x16x32_bf16 a[24:27], v[228:231], v[180:183], a[24:27]
v_mfma_f32_16x16x32_bf16 a[28:31], v[228:231], v[188:191], a[28:31]
v_mfma_f32_16x16x32_bf16 a[28:31], v[224:227], v[184:187], a[28:31]
s_waitcnt lgkmcnt(3)
v_mfma_f32_16x16x32_bf16 a[60:63], v[232:235], v[184:187], a[60:63]
s_add_u32 s72, s69, 54272
buffer_load_dwordx4 v3, s[8:11], s72 offen offset:3072 lds
v_mfma_f32_16x16x32_bf16 a[60:63], v[236:239], v[188:191], a[60:63]
ds_read_b64_tr_b16 v[248:249], v23 offset:0
v_mfma_f32_16x16x32_bf16 a[56:59], v[236:239], v[180:183], a[56:59]
v_mfma_f32_16x16x32_bf16 a[56:59], v[232:235], v[176:179], a[56:59]
s_add_u32 m0, s64, 49152
ds_read_b64_tr_b16 v[250:251], v23 offset:1024
v_mfma_f32_16x16x32_bf16 a[52:55], v[232:235], v[168:171], a[52:55]
s_add_u32 s72, s71, 0
buffer_load_dwordx4 v6, s[20:23], s72 offen lds
v_mfma_f32_16x16x32_bf16 a[52:55], v[236:239], v[172:175], a[52:55]
v_mfma_f32_16x16x32_bf16 a[48:51], v[236:239], v[164:167], a[48:51]
v_mfma_f32_16x16x32_bf16 a[48:51], v[232:235], v[160:163], a[48:51]
ds_read_b64_tr_b16 v[252:253], v23 offset:8192
v_mfma_f32_16x16x32_bf16 a[44:47], v[232:235], v[152:155], a[44:47]
s_add_u32 s72, s71, 31744
buffer_load_dwordx4 v6, s[20:23], s72 offen offset:1024 lds
v_mfma_f32_16x16x32_bf16 a[44:47], v[236:239], v[156:159], a[44:47]
v_mfma_f32_16x16x32_bf16 a[40:43], v[236:239], v[148:151], a[40:43]
ds_read_b64_tr_b16 v[254:255], v23 offset:9216
v_mfma_f32_16x16x32_bf16 a[40:43], v[232:235], v[144:147], a[40:43]
v_mfma_f32_16x16x32_bf16 a[36:39], v[232:235], v[136:139], a[36:39]
s_add_u32 s72, s71, 63488
buffer_load_dwordx4 v7, s[20:23], s72 offen offset:2048 lds
v_mfma_f32_16x16x32_bf16 a[36:39], v[236:239], v[140:143], a[36:39]
v_mfma_f32_16x16x32_bf16 a[32:35], v[236:239], v[132:135], a[32:35]
v_mfma_f32_16x16x32_bf16 a[32:35], v[232:235], v[128:131], a[32:35]
s_waitcnt lgkmcnt(4)
v_mfma_f32_16x16x32_bf16 a[64:67], v[240:243], v[128:131], a[64:67]
s_add_u32 s72, s71, 95232
buffer_load_dwordx4 v7, s[20:23], s72 offen offset:3072 lds
v_mfma_f32_16x16x32_bf16 a[64:67], v[244:247], v[132:135], a[64:67]
s_mov_b32 s80, 0x300000
buffer_load_dword v126, v125, s[16:19], s80 offen
v_mfma_f32_16x16x32_bf16 a[68:71], v[244:247], v[140:143], a[68:71]
buffer_load_dword v126, v125, s[20:23], s80 offen
v_mfma_f32_16x16x32_bf16 a[68:71], v[240:243], v[136:139], a[68:71]
s_add_u32 m0, s63, 135168
ds_read_b64_tr_b16 v[224:225], v20 offset:16384
v_mfma_f32_16x16x32_bf16 a[72:75], v[240:243], v[144:147], a[72:75]
s_add_u32 s80, s82, 0
buffer_load_dwordx4 v26, s[32:35], s80 offen nt lds
v_mfma_f32_16x16x32_bf16 a[72:75], v[244:247], v[148:151], a[72:75]
s_add_u32 s80, s82, 15360
buffer_load_dwordx4 v26, s[32:35], s80 offen offset:1024 nt lds
v_mfma_f32_16x16x32_bf16 a[76:79], v[244:247], v[156:159], a[76:79]
s_add_u32 s80, s82, 30720
buffer_load_dwordx4 v26, s[32:35], s80 offen offset:2048 nt lds
v_mfma_f32_16x16x32_bf16 a[76:79], v[240:243], v[152:155], a[76:79]
s_add_u32 s80, s82, 46080
buffer_load_dwordx4 v26, s[32:35], s80 offen offset:3072 nt lds
v_mfma_f32_16x16x32_bf16 a[80:83], v[240:243], v[160:163], a[80:83]
ds_read_b64_tr_b16 v[226:227], v20 offset:17408
v_mfma_f32_16x16x32_bf16 a[80:83], v[244:247], v[164:167], a[80:83]
v_mfma_f32_16x16x32_bf16 a[84:87], v[244:247], v[172:175], a[84:87]
ds_read_b64_tr_b16 v[228:229], v20 offset:24576
v_mfma_f32_16x16x32_bf16 a[84:87], v[240:243], v[168:171], a[84:87]
v_mfma_f32_16x16x32_bf16 a[88:91], v[240:243], v[176:179], a[88:91]
ds_read_b64_tr_b16 v[230:231], v20 offset:25600
v_mfma_f32_16x16x32_bf16 a[88:91], v[244:247], v[180:183], a[88:91]
v_mfma_f32_16x16x32_bf16 a[92:95], v[244:247], v[188:191], a[92:95]
v_mfma_f32_16x16x32_bf16 a[92:95], v[240:243], v[184:187], a[92:95]
s_waitcnt lgkmcnt(4)
v_mfma_f32_16x16x32_bf16 a[124:127], v[248:251], v[184:187], a[124:127]
ds_read_b64_tr_b16 v[232:233], v21 offset:16384
v_mfma_f32_16x16x32_bf16 a[124:127], v[252:255], v[188:191], a[124:127]
v_mfma_f32_16x16x32_bf16 a[120:123], v[252:255], v[180:183], a[120:123]
v_mfma_f32_16x16x32_bf16 a[120:123], v[248:251], v[176:179], a[120:123]
ds_read_b64_tr_b16 v[234:235], v21 offset:17408
v_mfma_f32_16x16x32_bf16 a[116:119], v[248:251], v[168:171], a[116:119]
v_mfma_f32_16x16x32_bf16 a[116:119], v[252:255], v[172:175], a[116:119]
v_mfma_f32_16x16x32_bf16 a[112:115], v[252:255], v[164:167], a[112:115]
v_mfma_f32_16x16x32_bf16 a[112:115], v[248:251], v[160:163], a[112:115]
ds_read_b64_tr_b16 v[236:237], v21 offset:24576
v_mfma_f32_16x16x32_bf16 a[108:111], v[248:251], v[152:155], a[108:111]
v_mfma_f32_16x16x32_bf16 a[108:111], v[252:255], v[156:159], a[108:111]
v_mfma_f32_16x16x32_bf16 a[104:107], v[252:255], v[148:151], a[104:107]
ds_read_b64_tr_b16 v[238:239], v21 offset:25600
v_mfma_f32_16x16x32_bf16 a[104:107], v[248:251], v[144:147], a[104:107]
v_mfma_f32_16x16x32_bf16 a[100:103], v[248:251], v[136:139], a[100:103]
v_mfma_f32_16x16x32_bf16 a[100:103], v[252:255], v[140:143], a[100:103]
v_mfma_f32_16x16x32_bf16 a[96:99], v[252:255], v[132:135], a[96:99]
v_mfma_f32_16x16x32_bf16 a[96:99], v[248:251], v[128:131], a[96:99]
s_waitcnt lgkmcnt(4)
v_mfma_f32_16x16x32_bf16 a[128:131], v[128:131], v[224:227], a[128:131]
ds_read_b64_tr_b16 v[240:241], v22 offset:16384
v_mfma_f32_16x16x32_bf16 a[128:131], v[132:135], v[228:231], a[128:131]
v_mfma_f32_16x16x32_bf16 a[132:135], v[140:143], v[228:231], a[132:135]
v_mfma_f32_16x16x32_bf16 a[132:135], v[136:139], v[224:227], a[132:135]
ds_read_b64_tr_b16 v[242:243], v22 offset:17408
v_mfma_f32_16x16x32_bf16 a[136:139], v[144:147], v[224:227], a[136:139]
v_mfma_f32_16x16x32_bf16 a[136:139], v[148:151], v[228:231], a[136:139]
v_mfma_f32_16x16x32_bf16 a[140:143], v[156:159], v[228:231], a[140:143]
v_mfma_f32_16x16x32_bf16 a[140:143], v[152:155], v[224:227], a[140:143]
ds_read_b64_tr_b16 v[244:245], v22 offset:24576
v_mfma_f32_16x16x32_bf16 a[144:147], v[160:163], v[224:227], a[144:147]
v_mfma_f32_16x16x32_bf16 a[144:147], v[164:167], v[228:231], a[144:147]
v_mfma_f32_16x16x32_bf16 a[148:151], v[172:175], v[228:231], a[148:151]
ds_read_b64_tr_b16 v[246:247], v22 offset:25600
v_mfma_f32_16x16x32_bf16 a[148:151], v[168:171], v[224:227], a[148:151]
v_mfma_f32_16x16x32_bf16 a[152:155], v[176:179], v[224:227], a[152:155]
v_mfma_f32_16x16x32_bf16 a[152:155], v[180:183], v[228:231], a[152:155]
v_mfma_f32_16x16x32_bf16 a[156:159], v[188:191], v[228:231], a[156:159]
v_mfma_f32_16x16x32_bf16 a[156:159], v[184:187], v[224:227], a[156:159]
s_waitcnt lgkmcnt(4)
v_mfma_f32_16x16x32_bf16 a[188:191], v[184:187], v[232:235], a[188:191]
ds_read_b64_tr_b16 v[248:249], v23 offset:16384
v_mfma_f32_16x16x32_bf16 a[188:191], v[188:191], v[236:239], a[188:191]
v_mfma_f32_16x16x32_bf16 a[184:187], v[180:183], v[236:239], a[184:187]
ds_read_b64_tr_b16 v[250:251], v23 offset:17408
v_mfma_f32_16x16x32_bf16 a[184:187], v[176:179], v[232:235], a[184:187]
v_mfma_f32_16x16x32_bf16 a[180:183], v[168:171], v[232:235], a[180:183]
ds_read_b64_tr_b16 v[252:253], v23 offset:24576
v_mfma_f32_16x16x32_bf16 a[180:183], v[172:175], v[236:239], a[180:183]
v_mfma_f32_16x16x32_bf16 a[176:179], v[164:167], v[236:239], a[176:179]
ds_read_b64_tr_b16 v[254:255], v23 offset:25600
v_mfma_f32_16x16x32_bf16 a[176:179], v[160:163], v[232:235], a[176:179]
v_mfma_f32_16x16x32_bf16 a[172:175], v[152:155], v[232:235], a[172:175]
v_mfma_f32_16x16x32_bf16 a[172:175], v[156:159], v[236:239], a[172:175]
v_mfma_f32_16x16x32_bf16 a[168:171], v[148:151], v[236:239], a[168:171]
v_mfma_f32_16x16x32_bf16 a[168:171], v[144:147], v[232:235], a[168:171]
v_mfma_f32_16x16x32_bf16 a[164:167], v[136:139], v[232:235], a[164:167]
v_mfma_f32_16x16x32_bf16 a[164:167], v[140:143], v[236:239], a[164:167]
v_mfma_f32_16x16x32_bf16 a[160:163], v[132:135], v[236:239], a[160:163]
s_waitcnt vmcnt(6) lgkmcnt(0)
v_mfma_f32_16x16x32_bf16 a[160:163], v[128:131], v[232:235], a[160:163]
s_barrier
v_mfma_f32_16x16x32_bf16 a[192:195], v[128:131], v[240:243], a[192:195]
s_and_b32 s73, s65, 1
ds_read_b64_tr_b16 v[224:225], v20 offset:32768
v_mfma_f32_16x16x32_bf16 a[192:195], v[132:135], v[244:247], a[192:195]
s_xor_b32 s73, s73, 4
ds_read_b64_tr_b16 v[226:227], v20 offset:33792
v_mfma_f32_16x16x32_bf16 a[196:199], v[140:143], v[244:247], a[196:199]
s_lshl_b32 s69, s73, 7
ds_read_b64_tr_b16 v[228:229], v20 offset:40960
v_mfma_f32_16x16x32_bf16 a[196:199], v[136:139], v[240:243], a[196:199]
s_add_u32 s69, s69, s84
ds_read_b64_tr_b16 v[230:231], v20 offset:41984
v_mfma_f32_16x16x32_bf16 a[200:203], v[144:147], v[240:243], a[200:203]
s_lshl_b32 s71, s73, 19
ds_read_b128 v[192:195], v24 offset:32768
v_mfma_f32_16x16x32_bf16 a[200:203], v[148:151], v[244:247], a[200:203]
s_add_u32 s71, s71, s66
ds_read_b128 v[196:199], v25 offset:32768
v_mfma_f32_16x16x32_bf16 a[204:207], v[156:159], v[244:247], a[204:207]
s_add_u32 m0, s63, 65536
v_mfma_f32_16x16x32_bf16 a[204:207], v[152:155], v[240:243], a[204:207]
s_add_u32 s72, s69, 0
buffer_load_dwordx4 v2, s[8:11], s72 offen lds
v_mfma_f32_16x16x32_bf16 a[208:211], v[160:163], v[240:243], a[208:211]
s_add_u32 s72, s69, 7168
buffer_load_dwordx4 v3, s[8:11], s72 offen offset:1024 lds
v_mfma_f32_16x16x32_bf16 a[208:211], v[164:167], v[244:247], a[208:211]
s_add_u32 s72, s69, 14336
buffer_load_dwordx4 v2, s[8:11], s72 offen offset:2048 lds
v_mfma_f32_16x16x32_bf16 a[212:215], v[172:175], v[244:247], a[212:215]
ds_read_b128 v[200:203], v24 offset:34816
v_mfma_f32_16x16x32_bf16 a[212:215], v[168:171], v[240:243], a[212:215]
ds_read_b128 v[204:207], v25 offset:34816
v_mfma_f32_16x16x32_bf16 a[216:219], v[176:179], v[240:243], a[216:219]
s_add_u32 s72, s69, 21504
buffer_load_dwordx4 v3, s[8:11], s72 offen offset:3072 lds
v_mfma_f32_16x16x32_bf16 a[216:219], v[180:183], v[244:247], a[216:219]
ds_read_b128 v[208:211], v24 offset:36864
v_mfma_f32_16x16x32_bf16 a[220:223], v[188:191], v[244:247], a[220:223]
ds_read_b128 v[212:215], v25 offset:36864
v_mfma_f32_16x16x32_bf16 a[220:223], v[184:187], v[240:243], a[220:223]
ds_read_b128 v[216:219], v24 offset:38912
v_mfma_f32_16x16x32_bf16 a[252:255], v[184:187], v[248:251], a[252:255]
ds_read_b128 v[220:223], v25 offset:38912
v_mfma_f32_16x16x32_bf16 a[252:255], v[188:191], v[252:255], a[252:255]
s_add_u32 m0, s64, 0
v_mfma_f32_16x16x32_bf16 a[248:251], v[180:183], v[252:255], a[248:251]
s_add_u32 s72, s71, 0
buffer_load_dwordx4 v6, s[16:19], s72 offen lds
v_mfma_f32_16x16x32_bf16 a[248:251], v[176:179], v[248:251], a[248:251]
ds_read_b128 v[184:187], v24 offset:40960
v_mfma_f32_16x16x32_bf16 a[244:247], v[168:171], v[248:251], a[244:247]
ds_read_b128 v[188:191], v25 offset:40960
v_mfma_f32_16x16x32_bf16 a[244:247], v[172:175], v[252:255], a[244:247]
s_add_u32 s72, s71, 31744
buffer_load_dwordx4 v6, s[16:19], s72 offen offset:1024 lds
v_mfma_f32_16x16x32_bf16 a[240:243], v[164:167], v[252:255], a[240:243]
ds_read_b128 v[176:179], v24 offset:43008
v_mfma_f32_16x16x32_bf16 a[240:243], v[160:163], v[248:251], a[240:243]
ds_read_b128 v[180:183], v25 offset:43008
v_mfma_f32_16x16x32_bf16 a[236:239], v[152:155], v[248:251], a[236:239]
ds_read_b128 v[168:171], v24 offset:45056
v_mfma_f32_16x16x32_bf16 a[236:239], v[156:159], v[252:255], a[236:239]
s_add_u32 s72, s71, 63488
buffer_load_dwordx4 v7, s[16:19], s72 offen offset:2048 lds
v_mfma_f32_16x16x32_bf16 a[232:235], v[148:151], v[252:255], a[232:235]
ds_read_b128 v[172:175], v25 offset:45056
v_mfma_f32_16x16x32_bf16 a[232:235], v[144:147], v[248:251], a[232:235]
ds_read_b128 v[160:163], v24 offset:47104
v_mfma_f32_16x16x32_bf16 a[228:231], v[136:139], v[248:251], a[228:231]
ds_read_b128 v[164:167], v25 offset:47104
v_mfma_f32_16x16x32_bf16 a[228:231], v[140:143], v[252:255], a[228:231]
v_mfma_f32_16x16x32_bf16 a[224:227], v[132:135], v[252:255], a[224:227]
s_add_u32 s72, s71, 95232
buffer_load_dwordx4 v7, s[16:19], s72 offen offset:3072 lds
v_mfma_f32_16x16x32_bf16 a[224:227], v[128:131], v[248:251], a[224:227]
s_waitcnt lgkmcnt(8)
ds_read_b64_tr_b16 v[232:233], v21 offset:32768
v_mfma_f32_16x16x32_bf16 a[0:3], v[224:227], v[192:195], a[0:3]
ds_read_b64_tr_b16 v[234:235], v21 offset:33792
v_mfma_f32_16x16x32_bf16 a[0:3], v[228:231], v[196:199], a[0:3]
ds_read_b64_tr_b16 v[240:241], v22 offset:32768
v_mfma_f32_16x16x32_bf16 a[4:7], v[228:231], v[204:207], a[4:7]
s_add_u32 m0, s63, 69632
ds_read_b64_tr_b16 v[236:237], v21 offset:40960
v_mfma_f32_16x16x32_bf16 a[4:7], v[224:227], v[200:203], a[4:7]
s_add_u32 s72, s69, 32768
buffer_load_dwordx4 v2, s[8:11], s72 offen lds
v_mfma_f32_16x16x32_bf16 a[8:11], v[224:227], v[208:211], a[8:11]
ds_read_b64_tr_b16 v[238:239], v21 offset:41984
v_mfma_f32_16x16x32_bf16 a[8:11], v[228:231], v[212:215], a[8:11]
v_mfma_f32_16x16x32_bf16 a[12:15], v[228:231], v[220:223], a[12:15]
s_add_u32 s72, s69, 39936
buffer_load_dwordx4 v3, s[8:11], s72 offen offset:1024 lds
v_mfma_f32_16x16x32_bf16 a[12:15], v[224:227], v[216:219], a[12:15]
s_waitcnt lgkmcnt(5)
ds_read_b64_tr_b16 v[242:243], v22 offset:33792
v_mfma_f32_16x16x32_bf16 a[16:19], v[224:227], v[184:187], a[16:19]
v_mfma_f32_16x16x32_bf16 a[16:19], v[228:231], v[188:191], a[16:19]
ds_read_b64_tr_b16 v[244:245], v22 offset:40960
v_mfma_f32_16x16x32_bf16 a[20:23], v[228:231], v[180:183], a[20:23]
v_mfma_f32_16x16x32_bf16 a[20:23], v[224:227], v[176:179], a[20:23]
s_add_u32 s72, s69, 47104
buffer_load_dwordx4 v2, s[8:11], s72 offen offset:2048 lds
v_mfma_f32_16x16x32_bf16 a[24:27], v[224:227], v[168:171], a[24:27]
ds_read_b64_tr_b16 v[246:247], v22 offset:41984
v_mfma_f32_16x16x32_bf16 a[24:27], v[228:231], v[172:175], a[24:27]
v_mfma_f32_16x16x32_bf16 a[28:31], v[228:231], v[164:167], a[28:31]
v_mfma_f32_16x16x32_bf16 a[28:31], v[224:227], v[160:163], a[28:31]
s_waitcnt lgkmcnt(3)
v_mfma_f32_16x16x32_bf16 a[60:63], v[232:235], v[160:163], a[60:63]
s_add_u32 s72, s69, 54272
buffer_load_dwordx4 v3, s[8:11], s72 offen offset:3072 lds
v_mfma_f32_16x16x32_bf16 a[60:63], v[236:239], v[164:167], a[60:63]
ds_read_b64_tr_b16 v[248:249], v23 offset:32768
v_mfma_f32_16x16x32_bf16 a[56:59], v[236:239], v[172:175], a[56:59]
v_mfma_f32_16x16x32_bf16 a[56:59], v[232:235], v[168:171], a[56:59]
s_add_u32 m0, s64, 16384
ds_read_b64_tr_b16 v[250:251], v23 offset:33792
v_mfma_f32_16x16x32_bf16 a[52:55], v[232:235], v[176:179], a[52:55]
s_add_u32 s72, s71, 0
buffer_load_dwordx4 v6, s[20:23], s72 offen lds
v_mfma_f32_16x16x32_bf16 a[52:55], v[236:239], v[180:183], a[52:55]
v_mfma_f32_16x16x32_bf16 a[48:51], v[236:239], v[188:191], a[48:51]
v_mfma_f32_16x16x32_bf16 a[48:51], v[232:235], v[184:187], a[48:51]
ds_read_b64_tr_b16 v[252:253], v23 offset:40960
v_mfma_f32_16x16x32_bf16 a[44:47], v[232:235], v[216:219], a[44:47]
s_add_u32 s72, s71, 31744
buffer_load_dwordx4 v6, s[20:23], s72 offen offset:1024 lds
v_mfma_f32_16x16x32_bf16 a[44:47], v[236:239], v[220:223], a[44:47]
v_mfma_f32_16x16x32_bf16 a[40:43], v[236:239], v[212:215], a[40:43]
ds_read_b64_tr_b16 v[254:255], v23 offset:41984
v_mfma_f32_16x16x32_bf16 a[40:43], v[232:235], v[208:211], a[40:43]
v_mfma_f32_16x16x32_bf16 a[36:39], v[232:235], v[200:203], a[36:39]
s_add_u32 s72, s71, 63488
buffer_load_dwordx4 v7, s[20:23], s72 offen offset:2048 lds
v_mfma_f32_16x16x32_bf16 a[36:39], v[236:239], v[204:207], a[36:39]
v_mfma_f32_16x16x32_bf16 a[32:35], v[236:239], v[196:199], a[32:35]
v_mfma_f32_16x16x32_bf16 a[32:35], v[232:235], v[192:195], a[32:35]
s_waitcnt lgkmcnt(4)
v_mfma_f32_16x16x32_bf16 a[64:67], v[240:243], v[192:195], a[64:67]
s_add_u32 s72, s71, 95232
buffer_load_dwordx4 v7, s[20:23], s72 offen offset:3072 lds
v_mfma_f32_16x16x32_bf16 a[64:67], v[244:247], v[196:199], a[64:67]
buffer_load_dwordx4 v[108:111], v1, s[4:7], s76 offen
v_mfma_f32_16x16x32_bf16 a[68:71], v[244:247], v[204:207], a[68:71]
buffer_load_dwordx4 v[112:115], v1, s[4:7], s76 offen offset:1024
v_mfma_f32_16x16x32_bf16 a[68:71], v[240:243], v[200:203], a[68:71]
buffer_load_dwordx4 v[116:119], v1, s[4:7], s76 offen offset:2048
v_mfma_f32_16x16x32_bf16 a[72:75], v[240:243], v[208:211], a[72:75]
buffer_load_dwordx4 v[120:123], v1, s[4:7], s76 offen offset:3072
v_mfma_f32_16x16x32_bf16 a[72:75], v[244:247], v[212:215], a[72:75]
ds_read_b64_tr_b16 v[224:225], v20 offset:49152
v_mfma_f32_16x16x32_bf16 a[76:79], v[244:247], v[220:223], a[76:79]
v_mfma_f32_16x16x32_bf16 a[76:79], v[240:243], v[216:219], a[76:79]
ds_read_b64_tr_b16 v[226:227], v20 offset:50176
v_mfma_f32_16x16x32_bf16 a[80:83], v[240:243], v[184:187], a[80:83]
v_mfma_f32_16x16x32_bf16 a[80:83], v[244:247], v[188:191], a[80:83]
ds_read_b64_tr_b16 v[228:229], v20 offset:57344
v_mfma_f32_16x16x32_bf16 a[84:87], v[244:247], v[180:183], a[84:87]
v_mfma_f32_16x16x32_bf16 a[84:87], v[240:243], v[176:179], a[84:87]
ds_read_b64_tr_b16 v[230:231], v20 offset:58368
v_mfma_f32_16x16x32_bf16 a[88:91], v[240:243], v[168:171], a[88:91]
v_mfma_f32_16x16x32_bf16 a[88:91], v[244:247], v[172:175], a[88:91]
v_mfma_f32_16x16x32_bf16 a[92:95], v[244:247], v[164:167], a[92:95]
v_mfma_f32_16x16x32_bf16 a[92:95], v[240:243], v[160:163], a[92:95]
s_waitcnt lgkmcnt(4)
v_mfma_f32_16x16x32_bf16 a[124:127], v[248:251], v[160:163], a[124:127]
ds_read_b64_tr_b16 v[232:233], v21 offset:49152
v_mfma_f32_16x16x32_bf16 a[124:127], v[252:255], v[164:167], a[124:127]
v_mfma_f32_16x16x32_bf16 a[120:123], v[252:255], v[172:175], a[120:123]
v_mfma_f32_16x16x32_bf16 a[120:123], v[248:251], v[168:171], a[120:123]
ds_read_b64_tr_b16 v[234:235], v21 offset:50176
v_mfma_f32_16x16x32_bf16 a[116:119], v[248:251], v[176:179], a[116:119]
s_waitcnt vmcnt(20)
ds_read2_b32 v[36:37], v98 offset0:0 offset1:32
ds_read2_b32 v[38:39], v98 offset0:64 offset1:96
v_mfma_f32_16x16x32_bf16 a[116:119], v[252:255], v[180:183], a[116:119]
ds_read2_b32 v[40:41], v98 offset0:128 offset1:160
ds_read2_b32 v[42:43], v98 offset0:192 offset1:224
v_mfma_f32_16x16x32_bf16 a[112:115], v[252:255], v[188:191], a[112:115]
v_add_u32 v98, 1024, v98
v_mfma_f32_16x16x32_bf16 a[112:115], v[248:251], v[184:187], a[112:115]
ds_read_b64_tr_b16 v[236:237], v21 offset:57344
ds_read2_b32 v[44:45], v98 offset0:0 offset1:32
v_mfma_f32_16x16x32_bf16 a[108:111], v[248:251], v[216:219], a[108:111]
ds_read2_b32 v[46:47], v98 offset0:64 offset1:96
ds_read2_b32 v[48:49], v98 offset0:128 offset1:160
v_mfma_f32_16x16x32_bf16 a[108:111], v[252:255], v[220:223], a[108:111]
ds_read2_b32 v[50:51], v98 offset0:192 offset1:224
v_add_u32 v98, 3072, v98
v_mfma_f32_16x16x32_bf16 a[104:107], v[252:255], v[212:215], a[104:107]
ds_read_b64_tr_b16 v[238:239], v21 offset:58368
ds_read2_b32 v[52:53], v98 offset0:0 offset1:32
v_mfma_f32_16x16x32_bf16 a[104:107], v[248:251], v[208:211], a[104:107]
ds_read2_b32 v[54:55], v98 offset0:64 offset1:96
ds_read2_b32 v[56:57], v98 offset0:128 offset1:160
v_mfma_f32_16x16x32_bf16 a[100:103], v[248:251], v[200:203], a[100:103]
ds_read2_b32 v[58:59], v98 offset0:192 offset1:224
v_add_u32 v98, 1024, v98
v_mfma_f32_16x16x32_bf16 a[100:103], v[252:255], v[204:207], a[100:103]
ds_read2_b32 v[60:61], v98 offset0:0 offset1:32
ds_read2_b32 v[62:63], v98 offset0:64 offset1:96
v_mfma_f32_16x16x32_bf16 a[96:99], v[252:255], v[196:199], a[96:99]
ds_read2_b32 v[64:65], v98 offset0:128 offset1:160
ds_read2_b32 v[66:67], v98 offset0:192 offset1:224
v_mfma_f32_16x16x32_bf16 a[96:99], v[248:251], v[192:195], a[96:99]
s_waitcnt lgkmcnt(15)
v_mfma_f32_16x16x32_bf16 a[128:131], v[192:195], v[224:227], a[128:131]
ds_read_b64_tr_b16 v[240:241], v22 offset:49152
v_mfma_f32_16x16x32_bf16 a[128:131], v[196:199], v[228:231], a[128:131]
v_mfma_f32_16x16x32_bf16 a[132:135], v[204:207], v[228:231], a[132:135]
v_mfma_f32_16x16x32_bf16 a[132:135], v[200:203], v[224:227], a[132:135]
ds_read_b64_tr_b16 v[242:243], v22 offset:50176
v_mfma_f32_16x16x32_bf16 a[136:139], v[208:211], v[224:227], a[136:139]
v_mfma_f32_16x16x32_bf16 a[136:139], v[212:215], v[228:231], a[136:139]
v_mfma_f32_16x16x32_bf16 a[140:143], v[220:223], v[228:231], a[140:143]
v_mfma_f32_16x16x32_bf16 a[140:143], v[216:219], v[224:227], a[140:143]
ds_read_b64_tr_b16 v[244:245], v22 offset:57344
v_mfma_f32_16x16x32_bf16 a[144:147], v[184:187], v[224:227], a[144:147]
v_mfma_f32_16x16x32_bf16 a[144:147], v[188:191], v[228:231], a[144:147]
v_mfma_f32_16x16x32_bf16 a[148:151], v[180:183], v[228:231], a[148:151]
ds_read_b64_tr_b16 v[246:247], v22 offset:58368
v_mfma_f32_16x16x32_bf16 a[148:151], v[176:179], v[224:227], a[148:151]
v_mfma_f32_16x16x32_bf16 a[152:155], v[168:171], v[224:227], a[152:155]
v_mfma_f32_16x16x32_bf16 a[152:155], v[172:175], v[228:231], a[152:155]
v_mfma_f32_16x16x32_bf16 a[156:159], v[164:167], v[228:231], a[156:159]
v_mfma_f32_16x16x32_bf16 a[156:159], v[160:163], v[224:227], a[156:159]
s_waitcnt lgkmcnt(12)
v_mfma_f32_16x16x32_bf16 a[188:191], v[160:163], v[232:235], a[188:191]
ds_read_b64_tr_b16 v[248:249], v23 offset:49152
v_mfma_f32_16x16x32_bf16 a[188:191], v[164:167], v[236:239], a[188:191]
v_mfma_f32_16x16x32_bf16 a[184:187], v[172:175], v[236:239], a[184:187]
ds_read_b64_tr_b16 v[250:251], v23 offset:50176
v_mfma_f32_16x16x32_bf16 a[184:187], v[168:171], v[232:235], a[184:187]
v_mfma_f32_16x16x32_bf16 a[180:183], v[176:179], v[232:235], a[180:183]
ds_read_b64_tr_b16 v[252:253], v23 offset:57344
v_mfma_f32_16x16x32_bf16 a[180:183], v[180:183], v[236:239], a[180:183]
v_mfma_f32_16x16x32_bf16 a[176:179], v[188:191], v[236:239], a[176:179]
ds_read_b64_tr_b16 v[254:255], v23 offset:58368
v_mfma_f32_16x16x32_bf16 a[176:179], v[184:187], v[232:235], a[176:179]
v_mfma_f32_16x16x32_bf16 a[172:175], v[216:219], v[232:235], a[172:175]
v_mfma_f32_16x16x32_bf16 a[172:175], v[220:223], v[236:239], a[172:175]
v_mfma_f32_16x16x32_bf16 a[168:171], v[212:215], v[236:239], a[168:171]
v_mfma_f32_16x16x32_bf16 a[168:171], v[208:211], v[232:235], a[168:171]
v_mfma_f32_16x16x32_bf16 a[164:167], v[200:203], v[232:235], a[164:167]
v_mfma_f32_16x16x32_bf16 a[164:167], v[204:207], v[236:239], a[164:167]
v_mfma_f32_16x16x32_bf16 a[160:163], v[196:199], v[236:239], a[160:163]
s_waitcnt vmcnt(4) lgkmcnt(0)
v_mfma_f32_16x16x32_bf16 a[160:163], v[192:195], v[232:235], a[160:163]
s_barrier
v_mfma_f32_16x16x32_bf16 a[192:195], v[192:195], v[240:243], a[192:195]
s_and_b32 s73, s65, 1
ds_read_b64_tr_b16 v[224:225], v20 offset:0
v_lshlrev_b32 v72, 16, v68
v_mfma_f32_16x16x32_bf16 a[192:195], v[196:199], v[244:247], a[192:195]
s_xor_b32 s73, s73, 5
ds_read_b64_tr_b16 v[226:227], v20 offset:1024
v_and_b32 v73, 0xffff0000, v68
v_mfma_f32_16x16x32_bf16 a[196:199], v[204:207], v[244:247], a[196:199]
s_lshl_b32 s69, s73, 7
ds_read_b64_tr_b16 v[228:229], v20 offset:8192
v_lshlrev_b32 v74, 16, v69
v_mfma_f32_16x16x32_bf16 a[196:199], v[200:203], v[240:243], a[196:199]
s_add_u32 s69, s69, s84
ds_read_b64_tr_b16 v[230:231], v20 offset:9216
v_and_b32 v75, 0xffff0000, v69
v_mfma_f32_16x16x32_bf16 a[200:203], v[208:211], v[240:243], a[200:203]
s_lshl_b32 s71, s73, 19
ds_read_b128 v[128:131], v24 offset:0
v_lshlrev_b32 v76, 16, v33
v_mfma_f32_16x16x32_bf16 a[200:203], v[212:215], v[244:247], a[200:203]
s_add_u32 s71, s71, s66
ds_read_b128 v[132:135], v25 offset:0
v_lshlrev_b32 v77, 16, v34
v_mfma_f32_16x16x32_bf16 a[204:207], v[220:223], v[244:247], a[204:207]
s_add_u32 m0, s63, 98304
v_lshlrev_b32 v78, 16, v35
v_lshlrev_b32 v79, 16, v36
v_mfma_f32_16x16x32_bf16 a[204:207], v[216:219], v[240:243], a[204:207]
s_add_u32 s72, s69, 0
buffer_load_dwordx4 v2, s[8:11], s72 offen lds
v_mfma_f32_16x16x32_bf16 a[208:211], v[184:187], v[240:243], a[208:211]
s_add_u32 s72, s69, 7168
buffer_load_dwordx4 v3, s[8:11], s72 offen offset:1024 lds
v_mfma_f32_16x16x32_bf16 a[208:211], v[188:191], v[244:247], a[208:211]
s_add_u32 s72, s69, 14336
buffer_load_dwordx4 v2, s[8:11], s72 offen offset:2048 lds
v_mfma_f32_16x16x32_bf16 a[212:215], v[180:183], v[244:247], a[212:215]
ds_read_b128 v[136:139], v24 offset:2048
v_lshlrev_b32 v80, 16, v37
v_mfma_f32_16x16x32_bf16 a[212:215], v[176:179], v[240:243], a[212:215]
ds_read_b128 v[140:143], v25 offset:2048
v_lshlrev_b32 v81, 16, v38
v_mfma_f32_16x16x32_bf16 a[216:219], v[168:171], v[240:243], a[216:219]
s_add_u32 s72, s69, 21504
buffer_load_dwordx4 v3, s[8:11], s72 offen offset:3072 lds
v_mfma_f32_16x16x32_bf16 a[216:219], v[172:175], v[244:247], a[216:219]
ds_read_b128 v[144:147], v24 offset:4096
v_lshlrev_b32 v82, 16, v39
v_mfma_f32_16x16x32_bf16 a[220:223], v[164:167], v[244:247], a[220:223]
ds_read_b128 v[148:151], v25 offset:4096
v_lshlrev_b32 v83, 16, v40
v_mfma_f32_16x16x32_bf16 a[220:223], v[160:163], v[240:243], a[220:223]
ds_read_b128 v[152:155], v24 offset:6144
v_lshlrev_b32 v84, 16, v41
v_mfma_f32_16x16x32_bf16 a[252:255], v[160:163], v[248:251], a[252:255]
ds_read_b128 v[156:159], v25 offset:6144
v_lshlrev_b32 v85, 16, v42
v_mfma_f32_16x16x32_bf16 a[252:255], v[164:167], v[252:255], a[252:255]
s_add_u32 m0, s64, 32768
v_lshlrev_b32 v86, 16, v43
v_lshlrev_b32 v87, 16, v44
v_mfma_f32_16x16x32_bf16 a[248:251], v[172:175], v[252:255], a[248:251]
s_add_u32 s72, s71, 0
buffer_load_dwordx4 v6, s[16:19], s72 offen lds
v_mfma_f32_16x16x32_bf16 a[248:251], v[168:171], v[248:251], a[248:251]
ds_read_b128 v[160:163], v24 offset:8192
v_lshlrev_b32 v88, 16, v45
v_mfma_f32_16x16x32_bf16 a[244:247], v[176:179], v[248:251], a[244:247]
ds_read_b128 v[164:167], v25 offset:8192
v_lshlrev_b32 v89, 16, v46
v_mfma_f32_16x16x32_bf16 a[244:247], v[180:183], v[252:255], a[244:247]
s_add_u32 s72, s71, 31744
buffer_load_dwordx4 v6, s[16:19], s72 offen offset:1024 lds
v_mfma_f32_16x16x32_bf16 a[240:243], v[188:191], v[252:255], a[240:243]
ds_read_b128 v[168:171], v24 offset:10240
v_lshlrev_b32 v90, 16, v47
v_mfma_f32_16x16x32_bf16 a[240:243], v[184:187], v[248:251], a[240:243]
ds_read_b128 v[172:175], v25 offset:10240
v_lshlrev_b32 v91, 16, v48
v_mfma_f32_16x16x32_bf16 a[236:239], v[216:219], v[248:251], a[236:239]
ds_read_b128 v[176:179], v24 offset:12288
v_lshlrev_b32 v92, 16, v49
v_mfma_f32_16x16x32_bf16 a[236:239], v[220:223], v[252:255], a[236:239]
s_add_u32 s72, s71, 63488
buffer_load_dwordx4 v7, s[16:19], s72 offen offset:2048 lds
v_mfma_f32_16x16x32_bf16 a[232:235], v[212:215], v[252:255], a[232:235]
ds_read_b128 v[180:183], v25 offset:12288
v_lshlrev_b32 v93, 16, v50
v_mfma_f32_16x16x32_bf16 a[232:235], v[208:211], v[248:251], a[232:235]
ds_read_b128 v[184:187], v24 offset:14336
v_lshlrev_b32 v94, 16, v51
v_mfma_f32_16x16x32_bf16 a[228:231], v[200:203], v[248:251], a[228:231]
ds_read_b128 v[188:191], v25 offset:14336
v_mul_f32 v95, v75, v91
v_mfma_f32_16x16x32_bf16 a[228:231], v[204:207], v[252:255], a[228:231]
v_lshlrev_b32 v97, 16, v67
v_fmac_f32 v95, v74, v92
v_mfma_f32_16x16x32_bf16 a[224:227], v[196:199], v[252:255], a[224:227]
s_add_u32 s72, s71, 95232
buffer_load_dwordx4 v7, s[16:19], s72 offen offset:3072 lds
v_mfma_f32_16x16x32_bf16 a[224:227], v[192:195], v[248:251], a[224:227]
s_waitcnt lgkmcnt(8)
ds_read_b64_tr_b16 v[232:233], v21 offset:0
v_fmac_f32 v95, v73, v93
v_mfma_f32_16x16x32_bf16 a[0:3], v[224:227], v[128:131], a[0:3]
ds_read_b64_tr_b16 v[234:235], v21 offset:1024
v_fmac_f32 v95, v72, v94
v_mfma_f32_16x16x32_bf16 a[0:3], v[228:231], v[132:135], a[0:3]
ds_read_b64_tr_b16 v[240:241], v22 offset:0
v_mul_f32 v95, v95, v97
v_mfma_f32_16x16x32_bf16 a[4:7], v[228:231], v[140:143], a[4:7]
s_add_u32 m0, s63, 102400
ds_read_b64_tr_b16 v[236:237], v21 offset:8192
v_mul_f32 v96, v75, v90
v_mfma_f32_16x16x32_bf16 a[4:7], v[224:227], v[136:139], a[4:7]
s_add_u32 s72, s69, 32768
buffer_load_dwordx4 v2, s[8:11], s72 offen lds
v_mfma_f32_16x16x32_bf16 a[8:11], v[224:227], v[144:147], a[8:11]
ds_read_b64_tr_b16 v[238:239], v21 offset:9216
v_lshlrev_b32 v97, 16, v66
v_mfma_f32_16x16x32_bf16 a[8:11], v[228:231], v[148:151], a[8:11]
v_fmac_f32 v96, v74, v91
v_fmac_f32 v96, v73, v92
v_mfma_f32_16x16x32_bf16 a[12:15], v[228:231], v[156:159], a[12:15]
s_add_u32 s72, s69, 39936
buffer_load_dwordx4 v3, s[8:11], s72 offen offset:1024 lds
v_mfma_f32_16x16x32_bf16 a[12:15], v[224:227], v[152:155], a[12:15]
s_waitcnt lgkmcnt(5)
ds_read_b64_tr_b16 v[242:243], v22 offset:1024
v_fmac_f32 v96, v72, v93
v_mfma_f32_16x16x32_bf16 a[16:19], v[224:227], v[160:163], a[16:19]
v_mul_f32 v96, v96, v97
v_cvt_pk_bf16_f32 v100, v95, v96
v_mfma_f32_16x16x32_bf16 a[16:19], v[228:231], v[164:167], a[16:19]
ds_read_b64_tr_b16 v[244:245], v22 offset:8192
v_mul_f32 v95, v75, v89
v_mfma_f32_16x16x32_bf16 a[20:23], v[228:231], v[172:175], a[20:23]
v_lshlrev_b32 v97, 16, v65
v_fmac_f32 v95, v74, v90
v_mfma_f32_16x16x32_bf16 a[20:23], v[224:227], v[168:171], a[20:23]
s_add_u32 s72, s69, 47104
buffer_load_dwordx4 v2, s[8:11], s72 offen offset:2048 lds
v_mfma_f32_16x16x32_bf16 a[24:27], v[224:227], v[176:179], a[24:27]
ds_read_b64_tr_b16 v[246:247], v22 offset:9216
v_fmac_f32 v95, v73, v91
v_mfma_f32_16x16x32_bf16 a[24:27], v[228:231], v[180:183], a[24:27]
v_fmac_f32 v95, v72, v92
v_mul_f32 v95, v95, v97
v_mfma_f32_16x16x32_bf16 a[28:31], v[228:231], v[188:191], a[28:31]
v_mul_f32 v96, v75, v88
v_lshlrev_b32 v97, 16, v64
v_mfma_f32_16x16x32_bf16 a[28:31], v[224:227], v[184:187], a[28:31]
s_waitcnt lgkmcnt(3)
v_fmac_f32 v96, v74, v89
v_fmac_f32 v96, v73, v90
v_mfma_f32_16x16x32_bf16 a[60:63], v[232:235], v[184:187], a[60:63]
s_add_u32 s72, s69, 54272
buffer_load_dwordx4 v3, s[8:11], s72 offen offset:3072 lds
v_mfma_f32_16x16x32_bf16 a[60:63], v[236:239], v[188:191], a[60:63]
ds_read_b64_tr_b16 v[248:249], v23 offset:0
v_fmac_f32 v96, v72, v91
v_mfma_f32_16x16x32_bf16 a[56:59], v[236:239], v[180:183], a[56:59]
v_mul_f32 v96, v96, v97
v_cvt_pk_bf16_f32 v101, v95, v96
v_mfma_f32_16x16x32_bf16 a[56:59], v[232:235], v[176:179], a[56:59]
s_add_u32 m0, s64, 49152
ds_read_b64_tr_b16 v[250:251], v23 offset:1024
v_mul_f32 v95, v75, v87
v_mfma_f32_16x16x32_bf16 a[52:55], v[232:235], v[168:171], a[52:55]
s_add_u32 s72, s71, 0
buffer_load_dwordx4 v6, s[20:23], s72 offen lds
v_mfma_f32_16x16x32_bf16 a[52:55], v[236:239], v[172:175], a[52:55]
v_lshlrev_b32 v97, 16, v63
v_fmac_f32 v95, v74, v88
v_mfma_f32_16x16x32_bf16 a[48:51], v[236:239], v[164:167], a[48:51]
v_fmac_f32 v95, v73, v89
v_fmac_f32 v95, v72, v90
v_mfma_f32_16x16x32_bf16 a[48:51], v[232:235], v[160:163], a[48:51]
ds_read_b64_tr_b16 v[252:253], v23 offset:8192
v_mul_f32 v95, v95, v97
v_mfma_f32_16x16x32_bf16 a[44:47], v[232:235], v[152:155], a[44:47]
s_add_u32 s72, s71, 31744
buffer_load_dwordx4 v6, s[20:23], s72 offen offset:1024 lds
v_mfma_f32_16x16x32_bf16 a[44:47], v[236:239], v[156:159], a[44:47]
v_mul_f32 v96, v75, v86
v_lshlrev_b32 v97, 16, v62
v_mfma_f32_16x16x32_bf16 a[40:43], v[236:239], v[148:151], a[40:43]
ds_read_b64_tr_b16 v[254:255], v23 offset:9216
v_fmac_f32 v96, v74, v87
v_mfma_f32_16x16x32_bf16 a[40:43], v[232:235], v[144:147], a[40:43]
v_fmac_f32 v96, v73, v88
v_fmac_f32 v96, v72, v89
v_mfma_f32_16x16x32_bf16 a[36:39], v[232:235], v[136:139], a[36:39]
s_add_u32 s72, s71, 63488
buffer_load_dwordx4 v7, s[20:23], s72 offen offset:2048 lds
v_mfma_f32_16x16x32_bf16 a[36:39], v[236:239], v[140:143], a[36:39]
v_mul_f32 v96, v96, v97
v_cvt_pk_bf16_f32 v102, v95, v96
v_mfma_f32_16x16x32_bf16 a[32:35], v[236:239], v[132:135], a[32:35]
v_mul_f32 v95, v75, v85
v_lshlrev_b32 v97, 16, v61
v_mfma_f32_16x16x32_bf16 a[32:35], v[232:235], v[128:131], a[32:35]
s_waitcnt lgkmcnt(4)
v_fmac_f32 v95, v74, v86
v_fmac_f32 v95, v73, v87
v_mfma_f32_16x16x32_bf16 a[64:67], v[240:243], v[128:131], a[64:67]
s_add_u32 s72, s71, 95232
buffer_load_dwordx4 v7, s[20:23], s72 offen offset:3072 lds
v_mfma_f32_16x16x32_bf16 a[64:67], v[244:247], v[132:135], a[64:67]
s_mov_b32 s80, 0x0
buffer_load_dword v126, v125, s[12:15], s80 offen
v_mfma_f32_16x16x32_bf16 a[68:71], v[244:247], v[140:143], a[68:71]
s_mov_b32 s80, 0x100000
buffer_load_dword v126, v125, s[12:15], s80 offen
v_mfma_f32_16x16x32_bf16 a[68:71], v[240:243], v[136:139], a[68:71]
s_mov_b32 s80, 0x200000
buffer_load_dword v126, v125, s[12:15], s80 offen
v_mfma_f32_16x16x32_bf16 a[72:75], v[240:243], v[144:147], a[72:75]
s_mov_b32 s80, 0x300000
buffer_load_dword v126, v125, s[12:15], s80 offen
v_mfma_f32_16x16x32_bf16 a[72:75], v[244:247], v[148:151], a[72:75]
ds_read_b64_tr_b16 v[224:225], v20 offset:16384
v_fmac_f32 v95, v72, v88
v_mfma_f32_16x16x32_bf16 a[76:79], v[244:247], v[156:159], a[76:79]
v_mul_f32 v95, v95, v97
v_mul_f32 v96, v75, v84
v_mfma_f32_16x16x32_bf16 a[76:79], v[240:243], v[152:155], a[76:79]
ds_read_b64_tr_b16 v[226:227], v20 offset:17408
v_lshlrev_b32 v97, 16, v60
v_mfma_f32_16x16x32_bf16 a[80:83], v[240:243], v[160:163], a[80:83]
v_fmac_f32 v96, v74, v85
v_fmac_f32 v96, v73, v86
v_mfma_f32_16x16x32_bf16 a[80:83], v[244:247], v[164:167], a[80:83]
ds_read_b64_tr_b16 v[228:229], v20 offset:24576
v_fmac_f32 v96, v72, v87
v_mfma_f32_16x16x32_bf16 a[84:87], v[244:247], v[172:175], a[84:87]
v_mul_f32 v96, v96, v97
v_cvt_pk_bf16_f32 v103, v95, v96
v_mfma_f32_16x16x32_bf16 a[84:87], v[240:243], v[168:171], a[84:87]
ds_read_b64_tr_b16 v[230:231], v20 offset:25600
ds_write_b128 v28, v[100:103] offset:0
v_mfma_f32_16x16x32_bf16 a[88:91], v[240:243], v[176:179], a[88:91]
v_mul_f32 v95, v75, v83
v_lshlrev_b32 v97, 16, v59
v_mfma_f32_16x16x32_bf16 a[88:91], v[244:247], v[180:183], a[88:91]
v_fmac_f32 v95, v74, v84
v_fmac_f32 v95, v73, v85
v_mfma_f32_16x16x32_bf16 a[92:95], v[244:247], v[188:191], a[92:95]
v_fmac_f32 v95, v72, v86
v_mul_f32 v95, v95, v97
v_mfma_f32_16x16x32_bf16 a[92:95], v[240:243], v[184:187], a[92:95]
s_waitcnt lgkmcnt(5)
v_mul_f32 v96, v75, v82
v_lshlrev_b32 v97, 16, v58
v_mfma_f32_16x16x32_bf16 a[124:127], v[248:251], v[184:187], a[124:127]
ds_read_b64_tr_b16 v[232:233], v21 offset:16384
v_fmac_f32 v96, v74, v83
v_mfma_f32_16x16x32_bf16 a[124:127], v[252:255], v[188:191], a[124:127]
v_fmac_f32 v96, v73, v84
v_fmac_f32 v96, v72, v85
v_mfma_f32_16x16x32_bf16 a[120:123], v[252:255], v[180:183], a[120:123]
v_mul_f32 v96, v96, v97
v_cvt_pk_bf16_f32 v104, v95, v96
v_mfma_f32_16x16x32_bf16 a[120:123], v[248:251], v[176:179], a[120:123]
ds_read_b64_tr_b16 v[234:235], v21 offset:17408
v_mul_f32 v95, v75, v81
v_mfma_f32_16x16x32_bf16 a[116:119], v[248:251], v[168:171], a[116:119]
v_lshlrev_b32 v97, 16, v57
v_fmac_f32 v95, v74, v82
v_mfma_f32_16x16x32_bf16 a[116:119], v[252:255], v[172:175], a[116:119]
v_fmac_f32 v95, v73, v83
v_fmac_f32 v95, v72, v84
v_mfma_f32_16x16x32_bf16 a[112:115], v[252:255], v[164:167], a[112:115]
v_mul_f32 v95, v95, v97
v_mul_f32 v96, v75, v80
v_mfma_f32_16x16x32_bf16 a[112:115], v[248:251], v[160:163], a[112:115]
ds_read_b64_tr_b16 v[236:237], v21 offset:24576
v_lshlrev_b32 v97, 16, v56
v_mfma_f32_16x16x32_bf16 a[108:111], v[248:251], v[152:155], a[108:111]
v_fmac_f32 v96, v74, v81
v_fmac_f32 v96, v73, v82
v_mfma_f32_16x16x32_bf16 a[108:111], v[252:255], v[156:159], a[108:111]
v_fmac_f32 v96, v72, v83
v_mul_f32 v96, v96, v97
v_mfma_f32_16x16x32_bf16 a[104:107], v[252:255], v[148:151], a[104:107]
ds_read_b64_tr_b16 v[238:239], v21 offset:25600
v_cvt_pk_bf16_f32 v105, v95, v96
v_mfma_f32_16x16x32_bf16 a[104:107], v[248:251], v[144:147], a[104:107]
v_mul_f32 v95, v75, v79
v_lshlrev_b32 v97, 16, v55
v_mfma_f32_16x16x32_bf16 a[100:103], v[248:251], v[136:139], a[100:103]
v_fmac_f32 v95, v74, v80
v_fmac_f32 v95, v73, v81
v_mfma_f32_16x16x32_bf16 a[100:103], v[252:255], v[140:143], a[100:103]
v_fmac_f32 v95, v72, v82
v_mul_f32 v95, v95, v97
v_mfma_f32_16x16x32_bf16 a[96:99], v[252:255], v[132:135], a[96:99]
v_mul_f32 v96, v75, v78
v_lshlrev_b32 v97, 16, v54
v_mfma_f32_16x16x32_bf16 a[96:99], v[248:251], v[128:131], a[96:99]
s_waitcnt lgkmcnt(5)
v_fmac_f32 v96, v74, v79
v_fmac_f32 v96, v73, v80
v_mfma_f32_16x16x32_bf16 a[128:131], v[128:131], v[224:227], a[128:131]
ds_read_b64_tr_b16 v[240:241], v22 offset:16384
v_fmac_f32 v96, v72, v81
v_mfma_f32_16x16x32_bf16 a[128:131], v[132:135], v[228:231], a[128:131]
v_mul_f32 v96, v96, v97
v_cvt_pk_bf16_f32 v106, v95, v96
v_mfma_f32_16x16x32_bf16 a[132:135], v[140:143], v[228:231], a[132:135]
v_mul_f32 v95, v75, v77
v_lshlrev_b32 v97, 16, v53
v_mfma_f32_16x16x32_bf16 a[132:135], v[136:139], v[224:227], a[132:135]
ds_read_b64_tr_b16 v[242:243], v22 offset:17408
v_fmac_f32 v95, v74, v78
v_mfma_f32_16x16x32_bf16 a[136:139], v[144:147], v[224:227], a[136:139]
v_fmac_f32 v95, v73, v79
v_fmac_f32 v95, v72, v80
v_mfma_f32_16x16x32_bf16 a[136:139], v[148:151], v[228:231], a[136:139]
v_mul_f32 v95, v95, v97
v_mul_f32 v96, v75, v76
v_mfma_f32_16x16x32_bf16 a[140:143], v[156:159], v[228:231], a[140:143]
v_lshlrev_b32 v97, 16, v52
v_fmac_f32 v96, v74, v77
v_mfma_f32_16x16x32_bf16 a[140:143], v[152:155], v[224:227], a[140:143]
ds_read_b64_tr_b16 v[244:245], v22 offset:24576
v_fmac_f32 v96, v73, v78
v_mfma_f32_16x16x32_bf16 a[144:147], v[160:163], v[224:227], a[144:147]
v_fmac_f32 v96, v72, v79
v_mul_f32 v96, v96, v97
v_mfma_f32_16x16x32_bf16 a[144:147], v[164:167], v[228:231], a[144:147]
v_cvt_pk_bf16_f32 v107, v95, v96
v_mfma_f32_16x16x32_bf16 a[148:151], v[172:175], v[228:231], a[148:151]
ds_read_b64_tr_b16 v[246:247], v22 offset:25600
ds_write_b128 v28, v[104:107] offset:16
v_mfma_f32_16x16x32_bf16 a[148:151], v[168:171], v[224:227], a[148:151]
global_load_dwordx4 v[84:87], v1, s[56:57]
v_mfma_f32_16x16x32_bf16 a[152:155], v[176:179], v[224:227], a[152:155]
global_load_dwordx4 v[88:91], v1, s[56:57] offset:1024
v_mfma_f32_16x16x32_bf16 a[152:155], v[180:183], v[228:231], a[152:155]
v_lshlrev_b32 v72, 16, v70
v_and_b32 v73, 0xffff0000, v70
v_mfma_f32_16x16x32_bf16 a[156:159], v[188:191], v[228:231], a[156:159]
v_lshlrev_b32 v74, 16, v71
v_and_b32 v75, 0xffff0000, v71
v_mfma_f32_16x16x32_bf16 a[156:159], v[184:187], v[224:227], a[156:159]
s_waitcnt lgkmcnt(5)
v_and_b32 v33, 0xffff0000, v33
v_and_b32 v34, 0xffff0000, v34
v_mfma_f32_16x16x32_bf16 a[188:191], v[184:187], v[232:235], a[188:191]
ds_read_b64_tr_b16 v[248:249], v23 offset:16384
v_and_b32 v35, 0xffff0000, v35
v_mfma_f32_16x16x32_bf16 a[188:191], v[188:191], v[236:239], a[188:191]
v_and_b32 v36, 0xffff0000, v36
v_and_b32 v37, 0xffff0000, v37
v_mfma_f32_16x16x32_bf16 a[184:187], v[180:183], v[236:239], a[184:187]
ds_read_b64_tr_b16 v[250:251], v23 offset:17408
v_and_b32 v38, 0xffff0000, v38
v_mfma_f32_16x16x32_bf16 a[184:187], v[176:179], v[232:235], a[184:187]
v_and_b32 v39, 0xffff0000, v39
v_and_b32 v40, 0xffff0000, v40
v_mfma_f32_16x16x32_bf16 a[180:183], v[168:171], v[232:235], a[180:183]
ds_read_b64_tr_b16 v[252:253], v23 offset:24576
v_and_b32 v41, 0xffff0000, v41
v_mfma_f32_16x16x32_bf16 a[180:183], v[172:175], v[236:239], a[180:183]
v_and_b32 v42, 0xffff0000, v42
v_and_b32 v43, 0xffff0000, v43
v_mfma_f32_16x16x32_bf16 a[176:179], v[164:167], v[236:239], a[176:179]
ds_read_b64_tr_b16 v[254:255], v23 offset:25600
v_and_b32 v44, 0xffff0000, v44
v_mfma_f32_16x16x32_bf16 a[176:179], v[160:163], v[232:235], a[176:179]
v_and_b32 v45, 0xffff0000, v45
v_and_b32 v46, 0xffff0000, v46
v_mfma_f32_16x16x32_bf16 a[172:175], v[152:155], v[232:235], a[172:175]
v_and_b32 v47, 0xffff0000, v47
v_and_b32 v48, 0xffff0000, v48
v_mfma_f32_16x16x32_bf16 a[172:175], v[156:159], v[236:239], a[172:175]
v_and_b32 v49, 0xffff0000, v49
v_and_b32 v50, 0xffff0000, v50
v_mfma_f32_16x16x32_bf16 a[168:171], v[148:151], v[236:239], a[168:171]
v_and_b32 v51, 0xffff0000, v51
v_mul_f32 v95, v75, v48
v_mfma_f32_16x16x32_bf16 a[168:171], v[144:147], v[232:235], a[168:171]
v_and_b32 v97, 0xffff0000, v67
v_fmac_f32 v95, v74, v49
v_mfma_f32_16x16x32_bf16 a[164:167], v[136:139], v[232:235], a[164:167]
v_fmac_f32 v95, v73, v50
v_fmac_f32 v95, v72, v51
v_mfma_f32_16x16x32_bf16 a[164:167], v[140:143], v[236:239], a[164:167]
v_mul_f32 v95, v95, v97
v_mul_f32 v96, v75, v47
v_mfma_f32_16x16x32_bf16 a[160:163], v[132:135], v[236:239], a[160:163]
s_waitcnt vmcnt(6) lgkmcnt(0)
v_and_b32 v97, 0xffff0000, v66
v_fmac_f32 v96, v74, v48
v_mfma_f32_16x16x32_bf16 a[160:163], v[128:131], v[232:235], a[160:163]
s_barrier
v_fmac_f32 v96, v73, v49
v_fmac_f32 v96, v72, v50
v_mfma_f32_16x16x32_bf16 a[192:195], v[128:131], v[240:243], a[192:195]
s_and_b32 s73, s65, 1
ds_read_b64_tr_b16 v[224:225], v20 offset:32768
v_mul_f32 v96, v96, v97
v_mfma_f32_16x16x32_bf16 a[192:195], v[132:135], v[244:247], a[192:195]
s_xor_b32 s73, s73, 6
ds_read_b64_tr_b16 v[226:227], v20 offset:33792
v_cvt_pk_bf16_f32 v100, v95, v96
v_mfma_f32_16x16x32_bf16 a[196:199], v[140:143], v[244:247], a[196:199]
s_lshl_b32 s69, s73, 7
ds_read_b64_tr_b16 v[228:229], v20 offset:40960
v_mul_f32 v95, v75, v46
v_mfma_f32_16x16x32_bf16 a[196:199], v[136:139], v[240:243], a[196:199]
s_add_u32 s69, s69, s84
ds_read_b64_tr_b16 v[230:231], v20 offset:41984
v_and_b32 v97, 0xffff0000, v65
v_mfma_f32_16x16x32_bf16 a[200:203], v[144:147], v[240:243], a[200:203]
s_lshl_b32 s71, s73, 19
ds_read_b128 v[192:195], v24 offset:32768
v_fmac_f32 v95, v74, v47
v_mfma_f32_16x16x32_bf16 a[200:203], v[148:151], v[244:247], a[200:203]
s_add_u32 s71, s71, s66
ds_read_b128 v[196:199], v25 offset:32768
v_fmac_f32 v95, v73, v48
v_mfma_f32_16x16x32_bf16 a[204:207], v[156:159], v[244:247], a[204:207]
s_add_u32 m0, s63, 65536
v_fmac_f32 v95, v72, v49
v_mul_f32 v95, v95, v97
v_mfma_f32_16x16x32_bf16 a[204:207], v[152:155], v[240:243], a[204:207]
s_add_u32 s72, s69, 0
buffer_load_dwordx4 v2, s[8:11], s72 offen lds
v_mfma_f32_16x16x32_bf16 a[208:211], v[160:163], v[240:243], a[208:211]
s_add_u32 s72, s69, 7168
buffer_load_dwordx4 v3, s[8:11], s72 offen offset:1024 lds
v_mfma_f32_16x16x32_bf16 a[208:211], v[164:167], v[244:247], a[208:211]
s_add_u32 s72, s69, 14336
buffer_load_dwordx4 v2, s[8:11], s72 offen offset:2048 lds
v_mfma_f32_16x16x32_bf16 a[212:215], v[172:175], v[244:247], a[212:215]
ds_read_b128 v[200:203], v24 offset:34816
v_mul_f32 v96, v75, v45
v_mfma_f32_16x16x32_bf16 a[212:215], v[168:171], v[240:243], a[212:215]
ds_read_b128 v[204:207], v25 offset:34816
v_and_b32 v97, 0xffff0000, v64
v_mfma_f32_16x16x32_bf16 a[216:219], v[176:179], v[240:243], a[216:219]
s_add_u32 s72, s69, 21504
buffer_load_dwordx4 v3, s[8:11], s72 offen offset:3072 lds
v_mfma_f32_16x16x32_bf16 a[216:219], v[180:183], v[244:247], a[216:219]
ds_read_b128 v[208:211], v24 offset:36864
v_fmac_f32 v96, v74, v46
v_mfma_f32_16x16x32_bf16 a[220:223], v[188:191], v[244:247], a[220:223]
ds_read_b128 v[212:215], v25 offset:36864
v_fmac_f32 v96, v73, v47
v_mfma_f32_16x16x32_bf16 a[220:223], v[184:187], v[240:243], a[220:223]
ds_read_b128 v[216:219], v24 offset:38912
v_fmac_f32 v96, v72, v48
v_mfma_f32_16x16x32_bf16 a[252:255], v[184:187], v[248:251], a[252:255]
ds_read_b128 v[220:223], v25 offset:38912
v_mul_f32 v96, v96, v97
v_mfma_f32_16x16x32_bf16 a[252:255], v[188:191], v[252:255], a[252:255]
s_add_u32 m0, s64, 0
v_cvt_pk_bf16_f32 v101, v95, v96
v_mul_f32 v95, v75, v44
v_mfma_f32_16x16x32_bf16 a[248:251], v[180:183], v[252:255], a[248:251]
s_add_u32 s72, s71, 0
buffer_load_dwordx4 v6, s[16:19], s72 offen lds
v_mfma_f32_16x16x32_bf16 a[248:251], v[176:179], v[248:251], a[248:251]
ds_read_b128 v[184:187], v24 offset:40960
v_and_b32 v97, 0xffff0000, v63
v_mfma_f32_16x16x32_bf16 a[244:247], v[168:171], v[248:251], a[244:247]
ds_read_b128 v[188:191], v25 offset:40960
v_fmac_f32 v95, v74, v45
v_mfma_f32_16x16x32_bf16 a[244:247], v[172:175], v[252:255], a[244:247]
s_add_u32 s72, s71, 31744
buffer_load_dwordx4 v6, s[16:19], s72 offen offset:1024 lds
v_mfma_f32_16x16x32_bf16 a[240:243], v[164:167], v[252:255], a[240:243]
ds_read_b128 v[176:179], v24 offset:43008
v_fmac_f32 v95, v73, v46
v_mfma_f32_16x16x32_bf16 a[240:243], v[160:163], v[248:251], a[240:243]
ds_read_b128 v[180:183], v25 offset:43008
v_fmac_f32 v95, v72, v47
v_mfma_f32_16x16x32_bf16 a[236:239], v[152:155], v[248:251], a[236:239]
ds_read_b128 v[168:171], v24 offset:45056
v_mul_f32 v95, v95, v97
v_mfma_f32_16x16x32_bf16 a[236:239], v[156:159], v[252:255], a[236:239]
s_add_u32 s72, s71, 63488
buffer_load_dwordx4 v7, s[16:19], s72 offen offset:2048 lds
v_mfma_f32_16x16x32_bf16 a[232:235], v[148:151], v[252:255], a[232:235]
ds_read_b128 v[172:175], v25 offset:45056
v_mul_f32 v96, v75, v43
v_mfma_f32_16x16x32_bf16 a[232:235], v[144:147], v[248:251], a[232:235]
ds_read_b128 v[160:163], v24 offset:47104
v_and_b32 v97, 0xffff0000, v62
v_mfma_f32_16x16x32_bf16 a[228:231], v[136:139], v[248:251], a[228:231]
ds_read_b128 v[164:167], v25 offset:47104
v_fmac_f32 v96, v74, v44
v_mfma_f32_16x16x32_bf16 a[228:231], v[140:143], v[252:255], a[228:231]
v_fmac_f32 v96, v73, v45
v_fmac_f32 v96, v72, v46
v_mfma_f32_16x16x32_bf16 a[224:227], v[132:135], v[252:255], a[224:227]
s_add_u32 s72, s71, 95232
buffer_load_dwordx4 v7, s[16:19], s72 offen offset:3072 lds
v_mfma_f32_16x16x32_bf16 a[224:227], v[128:131], v[248:251], a[224:227]
s_waitcnt lgkmcnt(8)
ds_read_b64_tr_b16 v[232:233], v21 offset:32768
v_mul_f32 v96, v96, v97
v_mfma_f32_16x16x32_bf16 a[0:3], v[224:227], v[192:195], a[0:3]
ds_read_b64_tr_b16 v[234:235], v21 offset:33792
v_cvt_pk_bf16_f32 v102, v95, v96
v_mfma_f32_16x16x32_bf16 a[0:3], v[228:231], v[196:199], a[0:3]
ds_read_b64_tr_b16 v[240:241], v22 offset:32768
v_mul_f32 v95, v75, v42
v_mfma_f32_16x16x32_bf16 a[4:7], v[228:231], v[204:207], a[4:7]
s_add_u32 m0, s63, 69632
ds_read_b64_tr_b16 v[236:237], v21 offset:40960
v_and_b32 v97, 0xffff0000, v61
v_mfma_f32_16x16x32_bf16 a[4:7], v[224:227], v[200:203], a[4:7]
s_add_u32 s72, s69, 32768
buffer_load_dwordx4 v2, s[8:11], s72 offen lds
v_mfma_f32_16x16x32_bf16 a[8:11], v[224:227], v[208:211], a[8:11]
ds_read_b64_tr_b16 v[238:239], v21 offset:41984
v_fmac_f32 v95, v74, v43
v_mfma_f32_16x16x32_bf16 a[8:11], v[228:231], v[212:215], a[8:11]
v_fmac_f32 v95, v73, v44
v_fmac_f32 v95, v72, v45
v_mfma_f32_16x16x32_bf16 a[12:15], v[228:231], v[220:223], a[12:15]
s_add_u32 s72, s69, 39936
buffer_load_dwordx4 v3, s[8:11], s72 offen offset:1024 lds
v_mfma_f32_16x16x32_bf16 a[12:15], v[224:227], v[216:219], a[12:15]
s_waitcnt lgkmcnt(5)
ds_read_b64_tr_b16 v[242:243], v22 offset:33792
v_mul_f32 v95, v95, v97
v_mfma_f32_16x16x32_bf16 a[16:19], v[224:227], v[184:187], a[16:19]
v_mul_f32 v96, v75, v41
v_and_b32 v97, 0xffff0000, v60
v_mfma_f32_16x16x32_bf16 a[16:19], v[228:231], v[188:191], a[16:19]
ds_read_b64_tr_b16 v[244:245], v22 offset:40960
v_fmac_f32 v96, v74, v42
v_mfma_f32_16x16x32_bf16 a[20:23], v[228:231], v[180:183], a[20:23]
v_fmac_f32 v96, v73, v43
v_fmac_f32 v96, v72, v44
v_mfma_f32_16x16x32_bf16 a[20:23], v[224:227], v[176:179], a[20:23]
s_add_u32 s72, s69, 47104
buffer_load_dwordx4 v2, s[8:11], s72 offen offset:2048 lds
v_mfma_f32_16x16x32_bf16 a[24:27], v[224:227], v[168:171], a[24:27]
ds_read_b64_tr_b16 v[246:247], v22 offset:41984
v_mul_f32 v96, v96, v97
v_mfma_f32_16x16x32_bf16 a[24:27], v[228:231], v[172:175], a[24:27]
v_cvt_pk_bf16_f32 v103, v95, v96
v_mfma_f32_16x16x32_bf16 a[28:31], v[228:231], v[164:167], a[28:31]
ds_write_b128 v28, v[100:103] offset:272
v_mul_f32 v95, v75, v40
v_mfma_f32_16x16x32_bf16 a[28:31], v[224:227], v[160:163], a[28:31]
s_waitcnt lgkmcnt(4)
v_and_b32 v97, 0xffff0000, v59
v_fmac_f32 v95, v74, v41
v_mfma_f32_16x16x32_bf16 a[60:63], v[232:235], v[160:163], a[60:63]
s_add_u32 s72, s69, 54272
buffer_load_dwordx4 v3, s[8:11], s72 offen offset:3072 lds
v_mfma_f32_16x16x32_bf16 a[60:63], v[236:239], v[164:167], a[60:63]
ds_read_b64_tr_b16 v[248:249], v23 offset:32768
v_fmac_f32 v95, v73, v42
v_mfma_f32_16x16x32_bf16 a[56:59], v[236:239], v[172:175], a[56:59]
v_fmac_f32 v95, v72, v43
v_mul_f32 v95, v95, v97
v_mfma_f32_16x16x32_bf16 a[56:59], v[232:235], v[168:171], a[56:59]
s_add_u32 m0, s64, 16384
ds_read_b64_tr_b16 v[250:251], v23 offset:33792
v_mul_f32 v96, v75, v39
v_mfma_f32_16x16x32_bf16 a[52:55], v[232:235], v[176:179], a[52:55]
s_add_u32 s72, s71, 0
buffer_load_dwordx4 v6, s[20:23], s72 offen lds
v_mfma_f32_16x16x32_bf16 a[52:55], v[236:239], v[180:183], a[52:55]
v_and_b32 v97, 0xffff0000, v58
v_fmac_f32 v96, v74, v40
v_mfma_f32_16x16x32_bf16 a[48:51], v[236:239], v[188:191], a[48:51]
v_fmac_f32 v96, v73, v41
v_fmac_f32 v96, v72, v42
v_mfma_f32_16x16x32_bf16 a[48:51], v[232:235], v[184:187], a[48:51]
ds_read_b64_tr_b16 v[252:253], v23 offset:40960
v_mul_f32 v96, v96, v97
v_mfma_f32_16x16x32_bf16 a[44:47], v[232:235], v[216:219], a[44:47]
s_add_u32 s72, s71, 31744
buffer_load_dwordx4 v6, s[20:23], s72 offen offset:1024 lds
v_mfma_f32_16x16x32_bf16 a[44:47], v[236:239], v[220:223], a[44:47]
v_cvt_pk_bf16_f32 v104, v95, v96
v_mul_f32 v95, v75, v38
v_mfma_f32_16x16x32_bf16 a[40:43], v[236:239], v[212:215], a[40:43]
ds_read_b64_tr_b16 v[254:255], v23 offset:41984
v_and_b32 v97, 0xffff0000, v57
v_mfma_f32_16x16x32_bf16 a[40:43], v[232:235], v[208:211], a[40:43]
v_fmac_f32 v95, v74, v39
v_fmac_f32 v95, v73, v40
v_mfma_f32_16x16x32_bf16 a[36:39], v[232:235], v[200:203], a[36:39]
s_add_u32 s72, s71, 63488
buffer_load_dwordx4 v7, s[20:23], s72 offen offset:2048 lds
v_mfma_f32_16x16x32_bf16 a[36:39], v[236:239], v[204:207], a[36:39]
v_fmac_f32 v95, v72, v41
v_mul_f32 v95, v95, v97
v_mfma_f32_16x16x32_bf16 a[32:35], v[236:239], v[196:199], a[32:35]
v_mul_f32 v96, v75, v37
v_and_b32 v97, 0xffff0000, v56
v_mfma_f32_16x16x32_bf16 a[32:35], v[232:235], v[192:195], a[32:35]
s_waitcnt lgkmcnt(5)
v_fmac_f32 v96, v74, v38
v_fmac_f32 v96, v73, v39
v_mfma_f32_16x16x32_bf16 a[64:67], v[240:243], v[192:195], a[64:67]
s_add_u32 s72, s71, 95232
buffer_load_dwordx4 v7, s[20:23], s72 offen offset:3072 lds
v_mfma_f32_16x16x32_bf16 a[64:67], v[244:247], v[196:199], a[64:67]
s_mov_b32 s80, 0x400000
buffer_load_dword v126, v125, s[12:15], s80 offen
v_mfma_f32_16x16x32_bf16 a[68:71], v[244:247], v[204:207], a[68:71]
s_mov_b32 s80, 0x500000
buffer_load_dword v126, v125, s[12:15], s80 offen
v_mfma_f32_16x16x32_bf16 a[68:71], v[240:243], v[200:203], a[68:71]
s_mov_b32 s80, 0x600000
buffer_load_dword v126, v125, s[12:15], s80 offen
v_mfma_f32_16x16x32_bf16 a[72:75], v[240:243], v[208:211], a[72:75]
s_mov_b32 s80, 0x700000
buffer_load_dword v126, v125, s[12:15], s80 offen
v_mfma_f32_16x16x32_bf16 a[72:75], v[244:247], v[212:215], a[72:75]
ds_read_b64_tr_b16 v[224:225], v20 offset:49152
v_fmac_f32 v96, v72, v40
v_mfma_f32_16x16x32_bf16 a[76:79], v[244:247], v[220:223], a[76:79]
v_mul_f32 v96, v96, v97
v_cvt_pk_bf16_f32 v105, v95, v96
v_mfma_f32_16x16x32_bf16 a[76:79], v[240:243], v[216:219], a[76:79]
ds_read_b64_tr_b16 v[226:227], v20 offset:50176
v_mul_f32 v95, v75, v36
v_mfma_f32_16x16x32_bf16 a[80:83], v[240:243], v[184:187], a[80:83]
v_and_b32 v97, 0xffff0000, v55
v_fmac_f32 v95, v74, v37
v_mfma_f32_16x16x32_bf16 a[80:83], v[244:247], v[188:191], a[80:83]
ds_read_b64_tr_b16 v[228:229], v20 offset:57344
v_fmac_f32 v95, v73, v38
v_mfma_f32_16x16x32_bf16 a[84:87], v[244:247], v[180:183], a[84:87]
v_fmac_f32 v95, v72, v39
v_mul_f32 v95, v95, v97
v_mfma_f32_16x16x32_bf16 a[84:87], v[240:243], v[176:179], a[84:87]
ds_read_b64_tr_b16 v[230:231], v20 offset:58368
v_mul_f32 v96, v75, v35
v_mfma_f32_16x16x32_bf16 a[88:91], v[240:243], v[168:171], a[88:91]
v_and_b32 v97, 0xffff0000, v54
v_fmac_f32 v96, v74, v36
v_mfma_f32_16x16x32_bf16 a[88:91], v[244:247], v[172:175], a[88:91]
v_fmac_f32 v96, v73, v37
v_fmac_f32 v96, v72, v38
v_mfma_f32_16x16x32_bf16 a[92:95], v[244:247], v[164:167], a[92:95]
v_mul_f32 v96, v96, v97
v_cvt_pk_bf16_f32 v106, v95, v96
v_mfma_f32_16x16x32_bf16 a[92:95], v[240:243], v[160:163], a[92:95]
s_waitcnt lgkmcnt(4)
v_mul_f32 v95, v75, v34
v_and_b32 v97, 0xffff0000, v53
v_mfma_f32_16x16x32_bf16 a[124:127], v[248:251], v[160:163], a[124:127]
ds_read_b64_tr_b16 v[232:233], v21 offset:49152
v_fmac_f32 v95, v74, v35
v_mfma_f32_16x16x32_bf16 a[124:127], v[252:255], v[164:167], a[124:127]
v_fmac_f32 v95, v73, v36
v_fmac_f32 v95, v72, v37
v_mfma_f32_16x16x32_bf16 a[120:123], v[252:255], v[172:175], a[120:123]
v_mul_f32 v95, v95, v97
v_mul_f32 v96, v75, v33
v_mfma_f32_16x16x32_bf16 a[120:123], v[248:251], v[168:171], a[120:123]
ds_read_b64_tr_b16 v[234:235], v21 offset:50176
v_and_b32 v97, 0xffff0000, v52
v_mfma_f32_16x16x32_bf16 a[116:119], v[248:251], v[176:179], a[116:119]
v_fmac_f32 v96, v74, v34
v_fmac_f32 v96, v73, v35
v_mfma_f32_16x16x32_bf16 a[116:119], v[252:255], v[180:183], a[116:119]
v_fmac_f32 v96, v72, v36
v_mul_f32 v96, v96, v97
v_mfma_f32_16x16x32_bf16 a[112:115], v[252:255], v[188:191], a[112:115]
v_cvt_pk_bf16_f32 v107, v95, v96
v_mfma_f32_16x16x32_bf16 a[112:115], v[248:251], v[184:187], a[112:115]
ds_read_b64_tr_b16 v[236:237], v21 offset:57344
ds_write_b128 v28, v[104:107] offset:288
v_mfma_f32_16x16x32_bf16 a[108:111], v[248:251], v[216:219], a[108:111]
v_mfma_f32_16x16x32_bf16 a[108:111], v[252:255], v[220:223], a[108:111]
v_mfma_f32_16x16x32_bf16 a[104:107], v[252:255], v[212:215], a[104:107]
ds_read_b64_tr_b16 v[238:239], v21 offset:58368
v_mfma_f32_16x16x32_bf16 a[104:107], v[248:251], v[208:211], a[104:107]
v_mfma_f32_16x16x32_bf16 a[100:103], v[248:251], v[200:203], a[100:103]
v_mfma_f32_16x16x32_bf16 a[100:103], v[252:255], v[204:207], a[100:103]
v_mfma_f32_16x16x32_bf16 a[96:99], v[252:255], v[196:199], a[96:99]
v_mfma_f32_16x16x32_bf16 a[96:99], v[248:251], v[192:195], a[96:99]
s_waitcnt lgkmcnt(5)
v_mfma_f32_16x16x32_bf16 a[128:131], v[192:195], v[224:227], a[128:131]
ds_read_b64_tr_b16 v[240:241], v22 offset:49152
v_mfma_f32_16x16x32_bf16 a[128:131], v[196:199], v[228:231], a[128:131]
v_mfma_f32_16x16x32_bf16 a[132:135], v[204:207], v[228:231], a[132:135]
v_mfma_f32_16x16x32_bf16 a[132:135], v[200:203], v[224:227], a[132:135]
ds_read_b64_tr_b16 v[242:243], v22 offset:50176
v_mfma_f32_16x16x32_bf16 a[136:139], v[208:211], v[224:227], a[136:139]
v_mfma_f32_16x16x32_bf16 a[136:139], v[212:215], v[228:231], a[136:139]
v_mfma_f32_16x16x32_bf16 a[140:143], v[220:223], v[228:231], a[140:143]
v_mfma_f32_16x16x32_bf16 a[140:143], v[216:219], v[224:227], a[140:143]
ds_read_b64_tr_b16 v[244:245], v22 offset:57344
v_mfma_f32_16x16x32_bf16 a[144:147], v[184:187], v[224:227], a[144:147]
v_mfma_f32_16x16x32_bf16 a[144:147], v[188:191], v[228:231], a[144:147]
v_mfma_f32_16x16x32_bf16 a[148:151], v[180:183], v[228:231], a[148:151]
ds_read_b64_tr_b16 v[246:247], v22 offset:58368
v_mfma_f32_16x16x32_bf16 a[148:151], v[176:179], v[224:227], a[148:151]
v_mfma_f32_16x16x32_bf16 a[152:155], v[168:171], v[224:227], a[152:155]
v_mfma_f32_16x16x32_bf16 a[152:155], v[172:175], v[228:231], a[152:155]
v_mfma_f32_16x16x32_bf16 a[156:159], v[164:167], v[228:231], a[156:159]
v_mfma_f32_16x16x32_bf16 a[156:159], v[160:163], v[224:227], a[156:159]
s_waitcnt lgkmcnt(4)
v_mfma_f32_16x16x32_bf16 a[188:191], v[160:163], v[232:235], a[188:191]
ds_read_b64_tr_b16 v[248:249], v23 offset:49152
v_mfma_f32_16x16x32_bf16 a[188:191], v[164:167], v[236:239], a[188:191]
v_mfma_f32_16x16x32_bf16 a[184:187], v[172:175], v[236:239], a[184:187]
ds_read_b64_tr_b16 v[250:251], v23 offset:50176
v_mfma_f32_16x16x32_bf16 a[184:187], v[168:171], v[232:235], a[184:187]
v_mfma_f32_16x16x32_bf16 a[180:183], v[176:179], v[232:235], a[180:183]
ds_read_b64_tr_b16 v[252:253], v23 offset:57344
v_mfma_f32_16x16x32_bf16 a[180:183], v[180:183], v[236:239], a[180:183]
v_mfma_f32_16x16x32_bf16 a[176:179], v[188:191], v[236:239], a[176:179]
ds_read_b64_tr_b16 v[254:255], v23 offset:58368
v_mfma_f32_16x16x32_bf16 a[176:179], v[184:187], v[232:235], a[176:179]
v_mfma_f32_16x16x32_bf16 a[172:175], v[216:219], v[232:235], a[172:175]
v_mfma_f32_16x16x32_bf16 a[172:175], v[220:223], v[236:239], a[172:175]
v_mfma_f32_16x16x32_bf16 a[168:171], v[212:215], v[236:239], a[168:171]
v_mfma_f32_16x16x32_bf16 a[168:171], v[208:211], v[232:235], a[168:171]
v_mfma_f32_16x16x32_bf16 a[164:167], v[200:203], v[232:235], a[164:167]
v_mfma_f32_16x16x32_bf16 a[164:167], v[204:207], v[236:239], a[164:167]
v_mfma_f32_16x16x32_bf16 a[160:163], v[196:199], v[236:239], a[160:163]
s_waitcnt vmcnt(4) lgkmcnt(0)
v_mfma_f32_16x16x32_bf16 a[160:163], v[192:195], v[232:235], a[160:163]
s_barrier
v_mfma_f32_16x16x32_bf16 a[192:195], v[192:195], v[240:243], a[192:195]
s_and_b32 s73, s65, 1
ds_read_b64_tr_b16 v[224:225], v20 offset:0
v_mfma_f32_16x16x32_bf16 a[192:195], v[196:199], v[244:247], a[192:195]
s_xor_b32 s73, s73, 7
ds_read_b64_tr_b16 v[226:227], v20 offset:1024
v_mfma_f32_16x16x32_bf16 a[196:199], v[204:207], v[244:247], a[196:199]
s_lshl_b32 s69, s73, 7
ds_read_b64_tr_b16 v[228:229], v20 offset:8192
v_mfma_f32_16x16x32_bf16 a[196:199], v[200:203], v[240:243], a[196:199]
s_add_u32 s69, s69, s84
ds_read_b64_tr_b16 v[230:231], v20 offset:9216
v_mfma_f32_16x16x32_bf16 a[200:203], v[208:211], v[240:243], a[200:203]
s_lshl_b32 s71, s73, 19
ds_read_b128 v[128:131], v24 offset:0
v_mfma_f32_16x16x32_bf16 a[200:203], v[212:215], v[244:247], a[200:203]
s_add_u32 s71, s71, s66
ds_read_b128 v[132:135], v25 offset:0
v_mfma_f32_16x16x32_bf16 a[204:207], v[220:223], v[244:247], a[204:207]
s_add_u32 m0, s63, 98304
v_mfma_f32_16x16x32_bf16 a[204:207], v[216:219], v[240:243], a[204:207]
s_add_u32 s72, s69, 0
buffer_load_dwordx4 v2, s[8:11], s72 offen lds
v_mfma_f32_16x16x32_bf16 a[208:211], v[184:187], v[240:243], a[208:211]
s_add_u32 s72, s69, 7168
buffer_load_dwordx4 v3, s[8:11], s72 offen offset:1024 lds
v_mfma_f32_16x16x32_bf16 a[208:211], v[188:191], v[244:247], a[208:211]
s_add_u32 s72, s69, 14336
buffer_load_dwordx4 v2, s[8:11], s72 offen offset:2048 lds
v_mfma_f32_16x16x32_bf16 a[212:215], v[180:183], v[244:247], a[212:215]
s_add_u32 s74, s63, 131072
ds_read_b128 v[136:139], v24 offset:2048
v_lshrrev_b32 v26, 4, v0
v_mfma_f32_16x16x32_bf16 a[212:215], v[176:179], v[240:243], a[212:215]
ds_read_b128 v[140:143], v25 offset:2048
v_and_b32 v27, 15, v0
v_mfma_f32_16x16x32_bf16 a[216:219], v[168:171], v[240:243], a[216:219]
s_add_u32 s72, s69, 21504
buffer_load_dwordx4 v3, s[8:11], s72 offen offset:3072 lds
v_mfma_f32_16x16x32_bf16 a[216:219], v[172:175], v[244:247], a[216:219]
ds_read_b128 v[144:147], v24 offset:4096
v_lshlrev_b32 v27, 4, v27
v_mfma_f32_16x16x32_bf16 a[220:223], v[164:167], v[244:247], a[220:223]
ds_read_b128 v[148:151], v25 offset:4096
v_mul_u32_u24 v28, 272, v26
v_mfma_f32_16x16x32_bf16 a[220:223], v[160:163], v[240:243], a[220:223]
ds_read_b128 v[152:155], v24 offset:6144
v_add3_u32 v28, v28, v27, s74
v_mfma_f32_16x16x32_bf16 a[252:255], v[160:163], v[248:251], a[252:255]
ds_read_b128 v[156:159], v25 offset:6144
v_lshl_add_u32 v26, v26, 12, v27
v_mfma_f32_16x16x32_bf16 a[252:255], v[164:167], v[252:255], a[252:255]
s_add_u32 m0, s64, 32768
ds_read_b128 v[36:39], v28 offset:0
ds_read_b128 v[40:43], v28 offset:1088
v_mfma_f32_16x16x32_bf16 a[248:251], v[172:175], v[252:255], a[248:251]
s_add_u32 s72, s71, 0
buffer_load_dwordx4 v6, s[16:19], s72 offen lds
v_mfma_f32_16x16x32_bf16 a[248:251], v[168:171], v[248:251], a[248:251]
ds_read_b128 v[160:163], v24 offset:8192
ds_read_b128 v[44:47], v28 offset:2176
v_mfma_f32_16x16x32_bf16 a[244:247], v[176:179], v[248:251], a[244:247]
ds_read_b128 v[164:167], v25 offset:8192
ds_read_b128 v[48:51], v28 offset:3264
v_mfma_f32_16x16x32_bf16 a[244:247], v[180:183], v[252:255], a[244:247]
s_add_u32 s72, s71, 31744
buffer_load_dwordx4 v6, s[16:19], s72 offen offset:1024 lds
v_mfma_f32_16x16x32_bf16 a[240:243], v[188:191], v[252:255], a[240:243]
s_xor_b32 s74, s2, 5
ds_read_b128 v[168:171], v24 offset:10240
v_mfma_f32_16x16x32_bf16 a[240:243], v[184:187], v[248:251], a[240:243]
s_and_b32 s74, s74, 15
ds_read_b128 v[172:175], v25 offset:10240
v_mfma_f32_16x16x32_bf16 a[236:239], v[216:219], v[248:251], a[236:239]
s_lshl_b32 s74, s74, 2
ds_read_b128 v[176:179], v24 offset:12288
v_mfma_f32_16x16x32_bf16 a[236:239], v[220:223], v[252:255], a[236:239]
s_add_u32 s72, s71, 63488
buffer_load_dwordx4 v7, s[16:19], s72 offen offset:2048 lds
v_mfma_f32_16x16x32_bf16 a[232:235], v[212:215], v[252:255], a[232:235]
s_add_u32 s74, s74, s58
ds_read_b128 v[180:183], v25 offset:12288
v_mfma_f32_16x16x32_bf16 a[232:235], v[208:211], v[248:251], a[232:235]
s_lshl_b32 s74, s74, 16
ds_read_b128 v[184:187], v24 offset:14336
v_mfma_f32_16x16x32_bf16 a[228:231], v[200:203], v[248:251], a[228:231]
s_lshr_b32 s75, s2, 4
ds_read_b128 v[188:191], v25 offset:14336
v_mfma_f32_16x16x32_bf16 a[228:231], v[204:207], v[252:255], a[228:231]
s_lshl_b32 s75, s75, 8
v_mfma_f32_16x16x32_bf16 a[224:227], v[196:199], v[252:255], a[224:227]
s_add_u32 s72, s71, 95232
buffer_load_dwordx4 v7, s[16:19], s72 offen offset:3072 lds
v_mfma_f32_16x16x32_bf16 a[224:227], v[192:195], v[248:251], a[224:227]
s_waitcnt lgkmcnt(12)
ds_read_b64_tr_b16 v[232:233], v21 offset:0
v_mfma_f32_16x16x32_bf16 a[0:3], v[224:227], v[128:131], a[0:3]
s_sub_u32 s74, s74, s75
ds_read_b64_tr_b16 v[234:235], v21 offset:1024
v_mfma_f32_16x16x32_bf16 a[0:3], v[228:231], v[132:135], a[0:3]
s_add_u32 s74, s74, 0x3000f00
ds_read_b64_tr_b16 v[240:241], v22 offset:0
v_mfma_f32_16x16x32_bf16 a[4:7], v[228:231], v[140:143], a[4:7]
s_add_u32 m0, s63, 102400
ds_read_b64_tr_b16 v[236:237], v21 offset:8192
v_mfma_f32_16x16x32_bf16 a[4:7], v[224:227], v[136:139], a[4:7]
s_add_u32 s72, s69, 32768
buffer_load_dwordx4 v2, s[8:11], s72 offen lds
v_mfma_f32_16x16x32_bf16 a[8:11], v[224:227], v[144:147], a[8:11]
s_waitcnt vmcnt(29)
ds_read_b64_tr_b16 v[238:239], v21 offset:9216
v_lshlrev_b32 v78, 16, v84
v_mfma_f32_16x16x32_bf16 a[8:11], v[228:231], v[148:151], a[8:11]
v_lshlrev_b32 v79, 16, v108
v_mul_f32 v76, v78, v79
v_mfma_f32_16x16x32_bf16 a[12:15], v[228:231], v[156:159], a[12:15]
s_add_u32 s72, s69, 39936
buffer_load_dwordx4 v3, s[8:11], s72 offen offset:1024 lds
v_mfma_f32_16x16x32_bf16 a[12:15], v[224:227], v[152:155], a[12:15]
s_waitcnt lgkmcnt(5)
ds_read_b64_tr_b16 v[242:243], v22 offset:1024
v_lshlrev_b32 v80, 16, v116
v_mfma_f32_16x16x32_bf16 a[16:19], v[224:227], v[160:163], a[16:19]
v_mul_f32 v77, v78, v80
v_and_b32 v78, 0xffff0000, v84
v_mfma_f32_16x16x32_bf16 a[16:19], v[228:231], v[164:167], a[16:19]
ds_read_b64_tr_b16 v[244:245], v22 offset:8192
v_and_b32 v79, 0xffff0000, v108
v_mfma_f32_16x16x32_bf16 a[20:23], v[228:231], v[172:175], a[20:23]
v_fmac_f32 v76, v78, v79
v_and_b32 v80, 0xffff0000, v116
v_mfma_f32_16x16x32_bf16 a[20:23], v[224:227], v[168:171], a[20:23]
s_add_u32 s72, s69, 47104
buffer_load_dwordx4 v2, s[8:11], s72 offen offset:2048 lds
v_mfma_f32_16x16x32_bf16 a[24:27], v[224:227], v[176:179], a[24:27]
ds_read_b64_tr_b16 v[246:247], v22 offset:9216
v_fmac_f32 v77, v78, v80
v_mfma_f32_16x16x32_bf16 a[24:27], v[228:231], v[180:183], a[24:27]
v_lshlrev_b32 v78, 16, v85
v_lshlrev_b32 v79, 16, v109
v_mfma_f32_16x16x32_bf16 a[28:31], v[228:231], v[188:191], a[28:31]
v_fmac_f32 v76, v78, v79
v_lshlrev_b32 v80, 16, v117
v_mfma_f32_16x16x32_bf16 a[28:31], v[224:227], v[184:187], a[28:31]
s_waitcnt lgkmcnt(3)
v_fmac_f32 v77, v78, v80
v_and_b32 v78, 0xffff0000, v85
v_mfma_f32_16x16x32_bf16 a[60:63], v[232:235], v[184:187], a[60:63]
s_add_u32 s72, s69, 54272
buffer_load_dwordx4 v3, s[8:11], s72 offen offset:3072 lds
v_mfma_f32_16x16x32_bf16 a[60:63], v[236:239], v[188:191], a[60:63]
ds_read_b64_tr_b16 v[248:249], v23 offset:0
v_and_b32 v79, 0xffff0000, v109
v_mfma_f32_16x16x32_bf16 a[56:59], v[236:239], v[180:183], a[56:59]
v_fmac_f32 v76, v78, v79
v_and_b32 v80, 0xffff0000, v117
v_mfma_f32_16x16x32_bf16 a[56:59], v[232:235], v[176:179], a[56:59]
s_add_u32 m0, s64, 49152
ds_read_b64_tr_b16 v[250:251], v23 offset:1024
v_fmac_f32 v77, v78, v80
v_mfma_f32_16x16x32_bf16 a[52:55], v[232:235], v[168:171], a[52:55]
s_add_u32 s72, s71, 0
buffer_load_dwordx4 v6, s[20:23], s72 offen lds
v_mfma_f32_16x16x32_bf16 a[52:55], v[236:239], v[172:175], a[52:55]
v_lshlrev_b32 v78, 16, v86
v_lshlrev_b32 v79, 16, v110
v_mfma_f32_16x16x32_bf16 a[48:51], v[236:239], v[164:167], a[48:51]
v_fmac_f32 v76, v78, v79
v_lshlrev_b32 v80, 16, v118
v_mfma_f32_16x16x32_bf16 a[48:51], v[232:235], v[160:163], a[48:51]
ds_read_b64_tr_b16 v[252:253], v23 offset:8192
v_fmac_f32 v77, v78, v80
v_mfma_f32_16x16x32_bf16 a[44:47], v[232:235], v[152:155], a[44:47]
s_add_u32 s72, s71, 31744
buffer_load_dwordx4 v6, s[20:23], s72 offen offset:1024 lds
v_mfma_f32_16x16x32_bf16 a[44:47], v[236:239], v[156:159], a[44:47]
v_and_b32 v78, 0xffff0000, v86
v_and_b32 v79, 0xffff0000, v110
v_mfma_f32_16x16x32_bf16 a[40:43], v[236:239], v[148:151], a[40:43]
ds_read_b64_tr_b16 v[254:255], v23 offset:9216
v_fmac_f32 v76, v78, v79
v_mfma_f32_16x16x32_bf16 a[40:43], v[232:235], v[144:147], a[40:43]
v_and_b32 v80, 0xffff0000, v118
v_fmac_f32 v77, v78, v80
v_mfma_f32_16x16x32_bf16 a[36:39], v[232:235], v[136:139], a[36:39]
s_add_u32 s72, s71, 63488
buffer_load_dwordx4 v7, s[20:23], s72 offen offset:2048 lds
v_mfma_f32_16x16x32_bf16 a[36:39], v[236:239], v[140:143], a[36:39]
v_lshlrev_b32 v78, 16, v87
v_lshlrev_b32 v79, 16, v111
v_mfma_f32_16x16x32_bf16 a[32:35], v[236:239], v[132:135], a[32:35]
v_fmac_f32 v76, v78, v79
v_lshlrev_b32 v80, 16, v119
v_mfma_f32_16x16x32_bf16 a[32:35], v[232:235], v[128:131], a[32:35]
s_waitcnt lgkmcnt(4)
v_fmac_f32 v77, v78, v80
v_and_b32 v78, 0xffff0000, v87
v_mfma_f32_16x16x32_bf16 a[64:67], v[240:243], v[128:131], a[64:67]
s_add_u32 s72, s71, 95232
buffer_load_dwordx4 v7, s[20:23], s72 offen offset:3072 lds
v_mfma_f32_16x16x32_bf16 a[64:67], v[244:247], v[132:135], a[64:67]
s_waitcnt lgkmcnt(15)
ds_read_b64_tr_b16 v[224:225], v20 offset:16384
v_and_b32 v79, 0xffff0000, v111
v_mfma_f32_16x16x32_bf16 a[68:71], v[244:247], v[140:143], a[68:71]
s_add_u32 s73, s62, 0
v_fmac_f32 v76, v78, v79
v_and_b32 v80, 0xffff0000, v119
v_mfma_f32_16x16x32_bf16 a[68:71], v[240:243], v[136:139], a[68:71]
s_add_u32 s70, s73, s65
ds_read_b64_tr_b16 v[226:227], v20 offset:17408
v_fmac_f32 v77, v78, v80
v_mfma_f32_16x16x32_bf16 a[72:75], v[240:243], v[144:147], a[72:75]
s_and_b32 s70, s70, 3
v_lshlrev_b32 v78, 16, v88
v_lshlrev_b32 v79, 16, v112
v_mfma_f32_16x16x32_bf16 a[72:75], v[244:247], v[148:151], a[72:75]
s_and_b32 s73, s73, 12
v_fmac_f32 v76, v78, v79
v_lshlrev_b32 v80, 16, v120
v_mfma_f32_16x16x32_bf16 a[76:79], v[244:247], v[156:159], a[76:79]
s_or_b32 s73, s73, s70
ds_read_b64_tr_b16 v[228:229], v20 offset:24576
v_fmac_f32 v77, v78, v80
v_mfma_f32_16x16x32_bf16 a[76:79], v[240:243], v[152:155], a[76:79]
s_lshl_b32 s73, s73, 7
v_and_b32 v78, 0xffff0000, v88
v_and_b32 v79, 0xffff0000, v112
v_mfma_f32_16x16x32_bf16 a[80:83], v[240:243], v[160:163], a[80:83]
s_add_u32 s69, s73, s67
ds_read_b64_tr_b16 v[230:231], v20 offset:25600
v_fmac_f32 v76, v78, v79
v_mfma_f32_16x16x32_bf16 a[80:83], v[244:247], v[164:167], a[80:83]
s_add_u32 s70, s73, s68
v_and_b32 v80, 0xffff0000, v120
v_fmac_f32 v77, v78, v80
v_mfma_f32_16x16x32_bf16 a[84:87], v[244:247], v[172:175], a[84:87]
s_add_u32 m0, s63, 131072
v_lshlrev_b32 v78, 16, v89
v_lshlrev_b32 v79, 16, v113
v_mfma_f32_16x16x32_bf16 a[84:87], v[240:243], v[168:171], a[84:87]
s_add_u32 s72, s69, 0
buffer_load_dwordx4 v4, s[4:7], s72 offen lds
v_mfma_f32_16x16x32_bf16 a[88:91], v[240:243], v[176:179], a[88:91]
s_add_u32 s72, s69, 15360
buffer_load_dwordx4 v5, s[4:7], s72 offen offset:1024 lds
v_mfma_f32_16x16x32_bf16 a[88:91], v[244:247], v[180:183], a[88:91]
s_add_u32 s72, s69, 129024
buffer_load_dwordx4 v4, s[4:7], s72 offen offset:2048 lds
v_mfma_f32_16x16x32_bf16 a[92:95], v[244:247], v[188:191], a[92:95]
s_add_u32 s72, s69, 144384
buffer_load_dwordx4 v5, s[4:7], s72 offen offset:3072 lds
v_mfma_f32_16x16x32_bf16 a[92:95], v[240:243], v[184:187], a[92:95]
s_waitcnt lgkmcnt(4)
v_fmac_f32 v76, v78, v79
v_lshlrev_b32 v80, 16, v121
v_mfma_f32_16x16x32_bf16 a[124:127], v[248:251], v[184:187], a[124:127]
ds_read_b64_tr_b16 v[232:233], v21 offset:16384
v_fmac_f32 v77, v78, v80
v_mfma_f32_16x16x32_bf16 a[124:127], v[252:255], v[188:191], a[124:127]
v_and_b32 v78, 0xffff0000, v89
v_and_b32 v79, 0xffff0000, v113
v_mfma_f32_16x16x32_bf16 a[120:123], v[252:255], v[180:183], a[120:123]
ds_read_b64_tr_b16 v[234:235], v21 offset:17408
v_fmac_f32 v76, v78, v79
v_mfma_f32_16x16x32_bf16 a[120:123], v[248:251], v[176:179], a[120:123]
s_add_u32 m0, s63, 135168
v_and_b32 v80, 0xffff0000, v121
v_fmac_f32 v77, v78, v80
v_mfma_f32_16x16x32_bf16 a[116:119], v[248:251], v[168:171], a[116:119]
s_add_u32 s72, s70, 0
buffer_load_dwordx4 v4, s[4:7], s72 offen lds
v_mfma_f32_16x16x32_bf16 a[116:119], v[252:255], v[172:175], a[116:119]
s_lshr_b32 s75, s93, 5
ds_read_b64_tr_b16 v[236:237], v21 offset:24576
v_lshlrev_b32 v78, 16, v90
v_mfma_f32_16x16x32_bf16 a[112:115], v[252:255], v[164:167], a[112:115]
s_and_b32 s75, s75, 0x3f80
v_lshlrev_b32 v79, 16, v114
v_fmac_f32 v76, v78, v79
v_mfma_f32_16x16x32_bf16 a[112:115], v[248:251], v[160:163], a[112:115]
s_add_u32 s75, s75, LcB0-Lpc0
v_lshrrev_b32 v2, 6, v0
v_lshlrev_b32 v2, 7, v2
v_mfma_f32_16x16x32_bf16 a[108:111], v[248:251], v[152:155], a[108:111]
s_add_u32 s72, s70, 15360
buffer_load_dwordx4 v5, s[4:7], s72 offen offset:1024 lds
v_mfma_f32_16x16x32_bf16 a[108:111], v[252:255], v[156:159], a[108:111]
v_add_u32 v2, s75, v2
v_min_u32 v2, Lcode_end-Lpc0, v2
v_mfma_f32_16x16x32_bf16 a[104:107], v[252:255], v[148:151], a[104:107]
global_load_dword v3, v2, s[98:99]
v_mfma_f32_16x16x32_bf16 a[104:107], v[248:251], v[144:147], a[104:107]
ds_read_b64_tr_b16 v[238:239], v21 offset:25600
v_lshlrev_b32 v80, 16, v122
v_mfma_f32_16x16x32_bf16 a[100:103], v[248:251], v[136:139], a[100:103]
s_add_u32 s72, s70, 129024
buffer_load_dwordx4 v4, s[4:7], s72 offen offset:2048 lds
v_mfma_f32_16x16x32_bf16 a[100:103], v[252:255], v[140:143], a[100:103]
v_fmac_f32 v77, v78, v80
v_and_b32 v78, 0xffff0000, v90
v_mfma_f32_16x16x32_bf16 a[96:99], v[252:255], v[132:135], a[96:99]
v_and_b32 v79, 0xffff0000, v114
v_fmac_f32 v76, v78, v79
v_mfma_f32_16x16x32_bf16 a[96:99], v[248:251], v[128:131], a[96:99]
s_waitcnt lgkmcnt(4)
v_and_b32 v80, 0xffff0000, v122
v_fmac_f32 v77, v78, v80
v_mfma_f32_16x16x32_bf16 a[128:131], v[128:131], v[224:227], a[128:131]
ds_read_b64_tr_b16 v[240:241], v22 offset:16384
v_lshlrev_b32 v78, 16, v91
v_mfma_f32_16x16x32_bf16 a[128:131], v[132:135], v[228:231], a[128:131]
s_add_u32 s72, s70, 144384
buffer_load_dwordx4 v5, s[4:7], s72 offen offset:3072 lds
v_mfma_f32_16x16x32_bf16 a[132:135], v[140:143], v[228:231], a[132:135]
v_lshlrev_b32 v79, 16, v115
v_fmac_f32 v76, v78, v79
v_mfma_f32_16x16x32_bf16 a[132:135], v[136:139], v[224:227], a[132:135]
v_lshlrev_b32 v80, 16, v123
v_fmac_f32 v77, v78, v80
v_mfma_f32_16x16x32_bf16 a[136:139], v[144:147], v[224:227], a[136:139]
ds_read_b64_tr_b16 v[242:243], v22 offset:17408
v_and_b32 v78, 0xffff0000, v91
v_mfma_f32_16x16x32_bf16 a[136:139], v[148:151], v[228:231], a[136:139]
v_and_b32 v79, 0xffff0000, v115
v_fmac_f32 v76, v78, v79
v_mfma_f32_16x16x32_bf16 a[140:143], v[156:159], v[228:231], a[140:143]
v_and_b32 v80, 0xffff0000, v123
v_fmac_f32 v77, v78, v80
v_mfma_f32_16x16x32_bf16 a[140:143], v[152:155], v[224:227], a[140:143]
ds_read_b64_tr_b16 v[244:245], v22 offset:24576
v_add_f32_dpp v76, v76, v76 row_ror:8 row_mask:0xf bank_mask:0xf
v_mfma_f32_16x16x32_bf16 a[144:147], v[160:163], v[224:227], a[144:147]
v_add_f32_dpp v77, v77, v77 row_ror:8 row_mask:0xf bank_mask:0xf
v_add_f32_dpp v76, v76, v76 row_ror:4 row_mask:0xf bank_mask:0xf
v_mfma_f32_16x16x32_bf16 a[144:147], v[164:167], v[228:231], a[144:147]
v_add_f32_dpp v77, v77, v77 row_ror:4 row_mask:0xf bank_mask:0xf
v_add_f32_dpp v76, v76, v76 row_ror:2 row_mask:0xf bank_mask:0xf
v_mfma_f32_16x16x32_bf16 a[148:151], v[172:175], v[228:231], a[148:151]
ds_read_b64_tr_b16 v[246:247], v22 offset:25600
v_add_f32_dpp v77, v77, v77 row_ror:2 row_mask:0xf bank_mask:0xf
v_mfma_f32_16x16x32_bf16 a[148:151], v[168:171], v[224:227], a[148:151]
v_add_f32_dpp v76, v76, v76 row_ror:1 row_mask:0xf bank_mask:0xf
v_add_f32_dpp v77, v77, v77 row_ror:1 row_mask:0xf bank_mask:0xf
v_mfma_f32_16x16x32_bf16 a[152:155], v[176:179], v[224:227], a[152:155]
v_mov_b32 v78, v76
v_mov_b32 v79, v77
v_mfma_f32_16x16x32_bf16 a[152:155], v[180:183], v[228:231], a[152:155]
v_permlane16_swap_b32 v76, v78
v_permlane16_swap_b32 v77, v79
v_mfma_f32_16x16x32_bf16 a[156:159], v[188:191], v[228:231], a[156:159]
v_add_f32 v76, v76, v78
v_add_f32 v77, v77, v79
v_mfma_f32_16x16x32_bf16 a[156:159], v[184:187], v[224:227], a[156:159]
s_waitcnt lgkmcnt(4)
v_mov_b32 v78, v76
v_mov_b32 v79, v77
v_mfma_f32_16x16x32_bf16 a[188:191], v[184:187], v[232:235], a[188:191]
ds_read_b64_tr_b16 v[248:249], v23 offset:16384
v_permlane32_swap_b32 v76, v78
v_mfma_f32_16x16x32_bf16 a[188:191], v[188:191], v[236:239], a[188:191]
v_permlane32_swap_b32 v77, v79
v_add_f32 v76, v76, v78
v_mfma_f32_16x16x32_bf16 a[184:187], v[180:183], v[236:239], a[184:187]
ds_read_b64_tr_b16 v[250:251], v23 offset:17408
v_add_f32 v77, v77, v79
v_mfma_f32_16x16x32_bf16 a[184:187], v[176:179], v[232:235], a[184:187]
v_mul_f32 v76, 0xbfb8aa3b, v76
v_mul_f32 v77, 0xbfb8aa3b, v77
v_mfma_f32_16x16x32_bf16 a[180:183], v[168:171], v[232:235], a[180:183]
ds_read_b64_tr_b16 v[252:253], v23 offset:24576
v_mfma_f32_16x16x32_bf16 a[180:183], v[172:175], v[236:239], a[180:183]
v_exp_f32 v76, v76
v_mfma_f32_16x16x32_bf16 a[176:179], v[164:167], v[236:239], a[176:179]
ds_read_b64_tr_b16 v[254:255], v23 offset:25600
v_mfma_f32_16x16x32_bf16 a[176:179], v[160:163], v[232:235], a[176:179]
v_exp_f32 v77, v77
v_mfma_f32_16x16x32_bf16 a[172:175], v[152:155], v[232:235], a[172:175]
v_add_f32 v76, 1.0, v76
v_add_f32 v77, 1.0, v77
v_mfma_f32_16x16x32_bf16 a[172:175], v[156:159], v[236:239], a[172:175]
v_rcp_f32 v76, v76
v_mfma_f32_16x16x32_bf16 a[168:171], v[148:151], v[236:239], a[168:171]
v_rcp_f32 v77, v77
v_mfma_f32_16x16x32_bf16 a[168:171], v[144:147], v[232:235], a[168:171]
s_lshr_b32 s80, s76, 9
v_mfma_f32_16x16x32_bf16 a[164:167], v[136:139], v[232:235], a[164:167]
s_add_u32 s80, s80, 0x3800000
v_min_u32 v78, 1, v0
v_lshlrev_b32 v78, 30, v78
v_mfma_f32_16x16x32_bf16 a[164:167], v[140:143], v[236:239], a[164:167]
buffer_store_dwordx2 v[76:77], v78, s[44:47], s80 offen sc1
v_mfma_f32_16x16x32_bf16 a[160:163], v[132:135], v[236:239], a[160:163]
s_waitcnt vmcnt(10) lgkmcnt(0)
v_mfma_f32_16x16x32_bf16 a[160:163], v[128:131], v[232:235], a[160:163]
s_barrier
v_mfma_f32_16x16x32_bf16 a[192:195], v[128:131], v[240:243], a[192:195]
s_lshl_b32 s71, s73, 12
ds_read_b64_tr_b16 v[224:225], v20 offset:32768
v_mfma_f32_16x16x32_bf16 a[192:195], v[132:135], v[244:247], a[192:195]
s_add_u32 s71, s71, s66
ds_read_b64_tr_b16 v[226:227], v20 offset:33792
v_mfma_f32_16x16x32_bf16 a[196:199], v[140:143], v[244:247], a[196:199]
s_add_u32 m0, s64, 0
v_mov_b32 v100, v20
v_mov_b32 v101, v21
v_mfma_f32_16x16x32_bf16 a[196:199], v[136:139], v[240:243], a[196:199]
s_add_u32 s72, s71, 0
buffer_load_dwordx4 v6, s[12:15], s72 offen lds
v_mfma_f32_16x16x32_bf16 a[200:203], v[144:147], v[240:243], a[200:203]
v_mov_b32 v102, v22
v_mov_b32 v103, v23
v_mfma_f32_16x16x32_bf16 a[200:203], v[148:151], v[244:247], a[200:203]
ds_read_b64_tr_b16 v[228:229], v20 offset:40960
v_mfma_f32_16x16x32_bf16 a[204:207], v[156:159], v[244:247], a[204:207]
s_add_u32 s72, s71, 31744
buffer_load_dwordx4 v6, s[12:15], s72 offen offset:1024 lds
v_mfma_f32_16x16x32_bf16 a[204:207], v[152:155], v[240:243], a[204:207]
ds_read_b64_tr_b16 v[230:231], v20 offset:41984
v_mfma_f32_16x16x32_bf16 a[208:211], v[160:163], v[240:243], a[208:211]
s_waitcnt lgkmcnt(15)
buffer_store_dwordx4 v[36:39], v26, s[44:47], s74 offen sc1
v_mfma_f32_16x16x32_bf16 a[208:211], v[164:167], v[244:247], a[208:211]
ds_read_b128 v[192:195], v24 offset:32768
v_mfma_f32_16x16x32_bf16 a[212:215], v[172:175], v[244:247], a[212:215]
ds_read_b128 v[196:199], v25 offset:32768
v_mfma_f32_16x16x32_bf16 a[212:215], v[168:171], v[240:243], a[212:215]
ds_read_b128 v[200:203], v24 offset:34816
v_mfma_f32_16x16x32_bf16 a[216:219], v[176:179], v[240:243], a[216:219]
s_add_u32 s72, s71, 63488
buffer_load_dwordx4 v7, s[12:15], s72 offen offset:2048 lds
v_mfma_f32_16x16x32_bf16 a[216:219], v[180:183], v[244:247], a[216:219]
ds_read_b128 v[204:207], v25 offset:34816
v_mfma_f32_16x16x32_bf16 a[220:223], v[188:191], v[244:247], a[220:223]
ds_read_b128 v[208:211], v24 offset:36864
v_mfma_f32_16x16x32_bf16 a[220:223], v[184:187], v[240:243], a[220:223]
ds_read_b128 v[212:215], v25 offset:36864
v_mfma_f32_16x16x32_bf16 a[252:255], v[184:187], v[248:251], a[252:255]
ds_read_b128 v[216:219], v24 offset:38912
v_mfma_f32_16x16x32_bf16 a[252:255], v[188:191], v[252:255], a[252:255]
ds_read_b128 v[220:223], v25 offset:38912
v_mfma_f32_16x16x32_bf16 a[248:251], v[180:183], v[252:255], a[248:251]
s_add_u32 s72, s71, 95232
buffer_load_dwordx4 v7, s[12:15], s72 offen offset:3072 lds
v_mfma_f32_16x16x32_bf16 a[248:251], v[176:179], v[248:251], a[248:251]
ds_read_b128 v[184:187], v24 offset:40960
v_mfma_f32_16x16x32_bf16 a[244:247], v[168:171], v[248:251], a[244:247]
ds_read_b128 v[188:191], v25 offset:40960
v_mfma_f32_16x16x32_bf16 a[244:247], v[172:175], v[252:255], a[244:247]
ds_read_b128 v[176:179], v24 offset:43008
v_mfma_f32_16x16x32_bf16 a[240:243], v[164:167], v[252:255], a[240:243]
ds_read_b128 v[180:183], v25 offset:43008
v_mfma_f32_16x16x32_bf16 a[240:243], v[160:163], v[248:251], a[240:243]
v_mfma_f32_16x16x32_bf16 a[236:239], v[152:155], v[248:251], a[236:239]
s_add_u32 s74, s74, 0x4000
buffer_store_dwordx4 v[40:43], v26, s[44:47], s74 offen sc1
v_mfma_f32_16x16x32_bf16 a[236:239], v[156:159], v[252:255], a[236:239]
s_add_u32 s73, s62, 1
ds_read_b128 v[168:171], v24 offset:45056
v_mfma_f32_16x16x32_bf16 a[232:235], v[148:151], v[252:255], a[232:235]
s_add_u32 s70, s73, s65
ds_read_b128 v[172:175], v25 offset:45056
v_mfma_f32_16x16x32_bf16 a[232:235], v[144:147], v[248:251], a[232:235]
s_and_b32 s70, s70, 3
ds_read_b128 v[160:163], v24 offset:47104
v_mfma_f32_16x16x32_bf16 a[228:231], v[136:139], v[248:251], a[228:231]
s_and_b32 s73, s73, 12
ds_read_b128 v[164:167], v25 offset:47104
v_mfma_f32_16x16x32_bf16 a[228:231], v[140:143], v[252:255], a[228:231]
s_or_b32 s73, s73, s70
v_mfma_f32_16x16x32_bf16 a[224:227], v[132:135], v[252:255], a[224:227]
s_lshl_b32 s73, s73, 7
ds_read_b64_tr_b16 v[232:233], v101 offset:32768
v_mfma_f32_16x16x32_bf16 a[224:227], v[128:131], v[248:251], a[224:227]
s_waitcnt lgkmcnt(9)
ds_read_b64_tr_b16 v[234:235], v101 offset:33792
v_mfma_f32_16x16x32_bf16 a[0:3], v[224:227], v[192:195], a[0:3]
s_add_u32 s69, s73, s67
ds_read_b64_tr_b16 v[236:237], v101 offset:40960
v_mfma_f32_16x16x32_bf16 a[0:3], v[228:231], v[196:199], a[0:3]
s_add_u32 s70, s73, s68
ds_read_b64_tr_b16 v[238:239], v101 offset:41984
v_mfma_f32_16x16x32_bf16 a[4:7], v[228:231], v[204:207], a[4:7]
s_add_u32 m0, s63, 65536
ds_read_b64_tr_b16 v[240:241], v102 offset:32768
v_mfma_f32_16x16x32_bf16 a[4:7], v[224:227], v[200:203], a[4:7]
s_add_u32 s72, s69, 0
buffer_load_dwordx4 v4, s[4:7], s72 offen lds
v_mfma_f32_16x16x32_bf16 a[8:11], v[224:227], v[208:211], a[8:11]
s_add_u32 s72, s69, 15360
buffer_load_dwordx4 v5, s[4:7], s72 offen offset:1024 lds
v_mfma_f32_16x16x32_bf16 a[8:11], v[228:231], v[212:215], a[8:11]
s_add_u32 s72, s69, 129024
buffer_load_dwordx4 v4, s[4:7], s72 offen offset:2048 lds
v_mfma_f32_16x16x32_bf16 a[12:15], v[228:231], v[220:223], a[12:15]
ds_read_b64_tr_b16 v[242:243], v102 offset:33792
v_mfma_f32_16x16x32_bf16 a[12:15], v[224:227], v[216:219], a[12:15]
s_waitcnt lgkmcnt(6)
v_mfma_f32_16x16x32_bf16 a[16:19], v[224:227], v[184:187], a[16:19]
s_add_u32 s74, s74, 0x4000
buffer_store_dwordx4 v[44:47], v26, s[44:47], s74 offen sc1
v_mfma_f32_16x16x32_bf16 a[16:19], v[228:231], v[188:191], a[16:19]
ds_read_b64_tr_b16 v[244:245], v102 offset:40960
v_mfma_f32_16x16x32_bf16 a[20:23], v[228:231], v[180:183], a[20:23]
v_mfma_f32_16x16x32_bf16 a[20:23], v[224:227], v[176:179], a[20:23]
ds_read_b64_tr_b16 v[246:247], v102 offset:41984
v_mfma_f32_16x16x32_bf16 a[24:27], v[224:227], v[168:171], a[24:27]
s_add_u32 s72, s69, 144384
buffer_load_dwordx4 v5, s[4:7], s72 offen offset:3072 lds
v_mfma_f32_16x16x32_bf16 a[24:27], v[228:231], v[172:175], a[24:27]
v_mfma_f32_16x16x32_bf16 a[28:31], v[228:231], v[164:167], a[28:31]
v_mfma_f32_16x16x32_bf16 a[28:31], v[224:227], v[160:163], a[28:31]
s_waitcnt lgkmcnt(4)
v_mfma_f32_16x16x32_bf16 a[60:63], v[232:235], v[160:163], a[60:63]
ds_read_b64_tr_b16 v[248:249], v103 offset:32768
v_mfma_f32_16x16x32_bf16 a[60:63], v[236:239], v[164:167], a[60:63]
v_mfma_f32_16x16x32_bf16 a[56:59], v[236:239], v[172:175], a[56:59]
s_add_u32 m0, s63, 69632
ds_read_b64_tr_b16 v[250:251], v103 offset:33792
v_mfma_f32_16x16x32_bf16 a[56:59], v[232:235], v[168:171], a[56:59]
s_add_u32 s72, s70, 0
buffer_load_dwordx4 v4, s[4:7], s72 offen lds
v_mfma_f32_16x16x32_bf16 a[52:55], v[232:235], v[176:179], a[52:55]
v_mfma_f32_16x16x32_bf16 a[52:55], v[236:239], v[180:183], a[52:55]
v_mfma_f32_16x16x32_bf16 a[48:51], v[236:239], v[188:191], a[48:51]
ds_read_b64_tr_b16 v[252:253], v103 offset:40960
v_mfma_f32_16x16x32_bf16 a[48:51], v[232:235], v[184:187], a[48:51]
v_mfma_f32_16x16x32_bf16 a[44:47], v[232:235], v[216:219], a[44:47]
s_add_u32 s72, s70, 15360
buffer_load_dwordx4 v5, s[4:7], s72 offen offset:1024 lds
v_mfma_f32_16x16x32_bf16 a[44:47], v[236:239], v[220:223], a[44:47]
s_add_u32 s74, s74, 0x4000
buffer_store_dwordx4 v[48:51], v26, s[44:47], s74 offen sc1
v_mfma_f32_16x16x32_bf16 a[40:43], v[236:239], v[212:215], a[40:43]
v_mfma_f32_16x16x32_bf16 a[40:43], v[232:235], v[208:211], a[40:43]
ds_read_b64_tr_b16 v[254:255], v103 offset:41984
v_mfma_f32_16x16x32_bf16 a[36:39], v[232:235], v[200:203], a[36:39]
v_mfma_f32_16x16x32_bf16 a[36:39], v[236:239], v[204:207], a[36:39]
v_mfma_f32_16x16x32_bf16 a[32:35], v[236:239], v[196:199], a[32:35]
v_mfma_f32_16x16x32_bf16 a[32:35], v[232:235], v[192:195], a[32:35]
s_waitcnt lgkmcnt(4)
v_mfma_f32_16x16x32_bf16 a[64:67], v[240:243], v[192:195], a[64:67]
s_add_u32 s72, s70, 129024
buffer_load_dwordx4 v4, s[4:7], s72 offen offset:2048 lds
v_mfma_f32_16x16x32_bf16 a[64:67], v[244:247], v[196:199], a[64:67]
ds_read_b64_tr_b16 v[224:225], v100 offset:49152
v_mfma_f32_16x16x32_bf16 a[68:71], v[244:247], v[204:207], a[68:71]
v_mfma_f32_16x16x32_bf16 a[68:71], v[240:243], v[200:203], a[68:71]
v_mfma_f32_16x16x32_bf16 a[72:75], v[240:243], v[208:211], a[72:75]
ds_read_b64_tr_b16 v[226:227], v100 offset:50176
v_mfma_f32_16x16x32_bf16 a[72:75], v[244:247], v[212:215], a[72:75]
s_add_u32 s72, s70, 144384
buffer_load_dwordx4 v5, s[4:7], s72 offen offset:3072 lds
v_mfma_f32_16x16x32_bf16 a[76:79], v[244:247], v[220:223], a[76:79]
v_mfma_f32_16x16x32_bf16 a[76:79], v[240:243], v[216:219], a[76:79]
v_mfma_f32_16x16x32_bf16 a[80:83], v[240:243], v[184:187], a[80:83]
ds_read_b64_tr_b16 v[228:229], v100 offset:57344
v_mfma_f32_16x16x32_bf16 a[80:83], v[244:247], v[188:191], a[80:83]
v_mfma_f32_16x16x32_bf16 a[84:87], v[244:247], v[180:183], a[84:87]
v_accvgpr_read_b32 v20, a0
v_accvgpr_read_b32 v28, a1
v_mfma_f32_16x16x32_bf16 a[84:87], v[240:243], v[176:179], a[84:87]
s_lshl_b32 s71, s73, 12
ds_read_b64_tr_b16 v[230:231], v100 offset:58368
v_accvgpr_read_b32 v21, a2
v_mfma_f32_16x16x32_bf16 a[88:91], v[240:243], v[168:171], a[88:91]
s_add_u32 s71, s71, s66
v_accvgpr_read_b32 v29, a3
v_accvgpr_read_b32 v22, a32
v_mfma_f32_16x16x32_bf16 a[88:91], v[244:247], v[172:175], a[88:91]
s_add_u32 m0, s64, 16384
v_accvgpr_read_b32 v30, a33
v_accvgpr_read_b32 v23, a34
v_mfma_f32_16x16x32_bf16 a[92:95], v[244:247], v[164:167], a[92:95]
s_add_u32 s72, s71, 0
buffer_load_dwordx4 v6, s[12:15], s72 offen lds
v_mfma_f32_16x16x32_bf16 a[92:95], v[240:243], v[160:163], a[92:95]
s_waitcnt lgkmcnt(4)
v_accvgpr_read_b32 v31, a35
v_mul_f32 v20, s79, v20
v_mfma_f32_16x16x32_bf16 a[124:127], v[248:251], v[160:163], a[124:127]
ds_read_b64_tr_b16 v[232:233], v101 offset:49152
v_mul_f32 v28, s79, v28
v_mfma_f32_16x16x32_bf16 a[124:127], v[252:255], v[164:167], a[124:127]
v_mul_f32 v21, s79, v21
v_mul_f32 v29, s79, v29
v_mfma_f32_16x16x32_bf16 a[120:123], v[252:255], v[172:175], a[120:123]
s_add_u32 s72, s71, 31744
buffer_load_dwordx4 v6, s[12:15], s72 offen offset:1024 lds
v_mfma_f32_16x16x32_bf16 a[120:123], v[248:251], v[168:171], a[120:123]
v_mul_f32 v22, s79, v22
v_mul_f32 v30, s79, v30
v_mfma_f32_16x16x32_bf16 a[116:119], v[248:251], v[176:179], a[116:119]
ds_read_b64_tr_b16 v[234:235], v101 offset:50176
v_mul_f32 v23, s79, v23
v_mfma_f32_16x16x32_bf16 a[116:119], v[252:255], v[180:183], a[116:119]
v_mul_f32 v31, s79, v31
v_cvt_pk_bf16_f32 v20, v20, v28
v_mfma_f32_16x16x32_bf16 a[112:115], v[252:255], v[188:191], a[112:115]
v_cvt_pk_bf16_f32 v21, v21, v29
v_cvt_pk_bf16_f32 v22, v22, v30
v_mfma_f32_16x16x32_bf16 a[112:115], v[248:251], v[184:187], a[112:115]
ds_read_b64_tr_b16 v[236:237], v101 offset:57344
v_cvt_pk_bf16_f32 v23, v23, v31
v_mfma_f32_16x16x32_bf16 a[108:111], v[248:251], v[216:219], a[108:111]
s_add_u32 s72, s71, 63488
buffer_load_dwordx4 v7, s[12:15], s72 offen offset:2048 lds
v_mfma_f32_16x16x32_bf16 a[108:111], v[252:255], v[220:223], a[108:111]
s_add_u32 s80, s77, 0
buffer_store_dwordx4 v[20:23], v1, s[44:47], s80 offen sc1
v_mfma_f32_16x16x32_bf16 a[104:107], v[252:255], v[212:215], a[104:107]
v_mfma_f32_16x16x32_bf16 a[104:107], v[248:251], v[208:211], a[104:107]
ds_read_b64_tr_b16 v[238:239], v101 offset:58368
v_mfma_f32_16x16x32_bf16 a[100:103], v[248:251], v[200:203], a[100:103]
v_mfma_f32_16x16x32_bf16 a[100:103], v[252:255], v[204:207], a[100:103]
v_mfma_f32_16x16x32_bf16 a[96:99], v[252:255], v[196:199], a[96:99]
s_add_u32 s72, s71, 95232
buffer_load_dwordx4 v7, s[12:15], s72 offen offset:3072 lds
v_mfma_f32_16x16x32_bf16 a[96:99], v[248:251], v[192:195], a[96:99]
s_waitcnt lgkmcnt(4)
LcB0:
v_mfma_f32_16x16x32_bf16 a[128:131], v[192:195], v[224:227], a[128:131]
ds_read_b64_tr_b16 v[240:241], v102 offset:49152
v_accvgpr_read_b32 v24, a4
v_mfma_f32_16x16x32_bf16 a[128:131], v[196:199], v[228:231], a[128:131]
v_accvgpr_read_b32 v28, a5
v_accvgpr_read_b32 v25, a6
v_mfma_f32_16x16x32_bf16 a[132:135], v[204:207], v[228:231], a[132:135]
v_accvgpr_read_b32 v29, a7
v_accvgpr_read_b32 v26, a36
v_mfma_f32_16x16x32_bf16 a[132:135], v[200:203], v[224:227], a[132:135]
ds_read_b64_tr_b16 v[242:243], v102 offset:50176
v_accvgpr_read_b32 v30, a37
v_mfma_f32_16x16x32_bf16 a[136:139], v[208:211], v[224:227], a[136:139]
v_accvgpr_read_b32 v27, a38
v_accvgpr_read_b32 v31, a39
v_mfma_f32_16x16x32_bf16 a[136:139], v[212:215], v[228:231], a[136:139]
v_mul_f32 v24, s79, v24
v_mul_f32 v28, s79, v28
v_mfma_f32_16x16x32_bf16 a[140:143], v[220:223], v[228:231], a[140:143]
v_mul_f32 v25, s79, v25
v_mul_f32 v29, s79, v29
v_mfma_f32_16x16x32_bf16 a[140:143], v[216:219], v[224:227], a[140:143]
ds_read_b64_tr_b16 v[244:245], v102 offset:57344
v_mul_f32 v26, s79, v26
v_mfma_f32_16x16x32_bf16 a[144:147], v[184:187], v[224:227], a[144:147]
v_mul_f32 v30, s79, v30
v_mul_f32 v27, s79, v27
v_mfma_f32_16x16x32_bf16 a[144:147], v[188:191], v[228:231], a[144:147]
v_mul_f32 v31, s79, v31
v_cvt_pk_bf16_f32 v24, v24, v28
v_mfma_f32_16x16x32_bf16 a[148:151], v[180:183], v[228:231], a[148:151]
ds_read_b64_tr_b16 v[246:247], v102 offset:58368
v_cvt_pk_bf16_f32 v25, v25, v29
v_mfma_f32_16x16x32_bf16 a[148:151], v[176:179], v[224:227], a[148:151]
v_cvt_pk_bf16_f32 v26, v26, v30
v_cvt_pk_bf16_f32 v27, v27, v31
v_mfma_f32_16x16x32_bf16 a[152:155], v[168:171], v[224:227], a[152:155]
s_add_u32 s80, s77, 4096
buffer_store_dwordx4 v[24:27], v1, s[44:47], s80 offen sc1
v_mfma_f32_16x16x32_bf16 a[152:155], v[172:175], v[228:231], a[152:155]
v_mfma_f32_16x16x32_bf16 a[156:159], v[164:167], v[228:231], a[156:159]
v_mfma_f32_16x16x32_bf16 a[156:159], v[160:163], v[224:227], a[156:159]
s_waitcnt lgkmcnt(4)
v_mfma_f32_16x16x32_bf16 a[188:191], v[160:163], v[232:235], a[188:191]
ds_read_b64_tr_b16 v[248:249], v103 offset:49152
v_mfma_f32_16x16x32_bf16 a[188:191], v[164:167], v[236:239], a[188:191]
v_mfma_f32_16x16x32_bf16 a[184:187], v[172:175], v[236:239], a[184:187]
ds_read_b64_tr_b16 v[250:251], v103 offset:50176
v_mfma_f32_16x16x32_bf16 a[184:187], v[168:171], v[232:235], a[184:187]
v_mfma_f32_16x16x32_bf16 a[180:183], v[176:179], v[232:235], a[180:183]
ds_read_b64_tr_b16 v[252:253], v103 offset:57344
v_mfma_f32_16x16x32_bf16 a[180:183], v[180:183], v[236:239], a[180:183]
s_add_u32 s73, s62, 2
v_mfma_f32_16x16x32_bf16 a[176:179], v[188:191], v[236:239], a[176:179]
s_add_u32 s70, s73, s65
ds_read_b64_tr_b16 v[254:255], v103 offset:58368
v_accvgpr_read_b32 v20, a8
v_mfma_f32_16x16x32_bf16 a[176:179], v[184:187], v[232:235], a[176:179]
s_and_b32 s70, s70, 3
v_accvgpr_read_b32 v28, a9
v_accvgpr_read_b32 v21, a10
v_mfma_f32_16x16x32_bf16 a[172:175], v[216:219], v[232:235], a[172:175]
s_and_b32 s73, s73, 12
v_accvgpr_read_b32 v29, a11
v_accvgpr_read_b32 v22, a40
v_mfma_f32_16x16x32_bf16 a[172:175], v[220:223], v[236:239], a[172:175]
s_or_b32 s73, s73, s70
v_accvgpr_read_b32 v30, a41
v_accvgpr_read_b32 v23, a42
v_mfma_f32_16x16x32_bf16 a[168:171], v[212:215], v[236:239], a[168:171]
s_lshl_b32 s73, s73, 7
v_accvgpr_read_b32 v31, a43
v_mul_f32 v20, s79, v20
v_mfma_f32_16x16x32_bf16 a[168:171], v[208:211], v[232:235], a[168:171]
s_add_u32 s69, s73, s67
v_mul_f32 v28, s79, v28
v_mul_f32 v21, s79, v21
v_mfma_f32_16x16x32_bf16 a[164:167], v[200:203], v[232:235], a[164:167]
s_add_u32 s70, s73, s68
v_mul_f32 v29, s79, v29
v_mul_f32 v22, s79, v22
v_mfma_f32_16x16x32_bf16 a[164:167], v[204:207], v[236:239], a[164:167]
s_add_u32 m0, s63, 98304
v_mul_f32 v30, s79, v30
v_mul_f32 v23, s79, v23
v_mfma_f32_16x16x32_bf16 a[160:163], v[196:199], v[236:239], a[160:163]
s_waitcnt vmcnt(8) lgkmcnt(0)
v_mul_f32 v31, s79, v31
v_cvt_pk_bf16_f32 v20, v20, v28
v_mfma_f32_16x16x32_bf16 a[160:163], v[192:195], v[232:235], a[160:163]
s_barrier
v_cvt_pk_bf16_f32 v21, v21, v29
v_cvt_pk_bf16_f32 v22, v22, v30
v_mfma_f32_16x16x32_bf16 a[192:195], v[192:195], v[240:243], a[192:195]
s_add_u32 s72, s69, 0
buffer_load_dwordx4 v4, s[4:7], s72 offen lds
v_mfma_f32_16x16x32_bf16 a[192:195], v[196:199], v[244:247], a[192:195]
s_lshl_b32 s74, s59, 2
ds_read_b64_tr_b16 v[64:65], v8 offset:0
v_or_b32 v106, s58, v0
v_mfma_f32_16x16x32_bf16 a[196:199], v[204:207], v[244:247], a[196:199]
ds_read_b64_tr_b16 v[66:67], v8 offset:1024
v_mov_b32 v107, 1
v_mfma_f32_16x16x32_bf16 a[196:199], v[200:203], v[240:243], a[196:199]
ds_read_b64_tr_b16 v[68:69], v8 offset:8192
v_lshlrev_b32 v106, 8, v106
v_mfma_f32_16x16x32_bf16 a[200:203], v[208:211], v[240:243], a[200:203]
ds_read_b64_tr_b16 v[70:71], v8 offset:9216
v_cvt_pk_bf16_f32 v23, v23, v31
v_mfma_f32_16x16x32_bf16 a[200:203], v[212:215], v[244:247], a[200:203]
s_add_u32 s72, s69, 15360
buffer_load_dwordx4 v5, s[4:7], s72 offen offset:1024 lds
v_mfma_f32_16x16x32_bf16 a[204:207], v[220:223], v[244:247], a[204:207]
s_add_u32 s80, s77, 8192
ds_read_b128 v[32:35], v16 offset:0
v_mfma_f32_16x16x32_bf16 a[204:207], v[216:219], v[240:243], a[204:207]
buffer_atomic_add v107, v106, s[48:51], s74 offen sc1
v_mfma_f32_16x16x32_bf16 a[208:211], v[184:187], v[240:243], a[208:211]
ds_read_b128 v[36:39], v17 offset:0
v_mfma_f32_16x16x32_bf16 a[208:211], v[188:191], v[244:247], a[208:211]
ds_read_b128 v[40:43], v16 offset:2048
v_mfma_f32_16x16x32_bf16 a[212:215], v[180:183], v[244:247], a[212:215]
s_add_u32 s72, s69, 129024
buffer_load_dwordx4 v4, s[4:7], s72 offen offset:2048 lds
v_mfma_f32_16x16x32_bf16 a[212:215], v[176:179], v[240:243], a[212:215]
ds_read_b128 v[44:47], v17 offset:2048
v_mfma_f32_16x16x32_bf16 a[216:219], v[168:171], v[240:243], a[216:219]
ds_read_b128 v[48:51], v16 offset:4096
v_accvgpr_read_b32 v24, a128
v_mfma_f32_16x16x32_bf16 a[216:219], v[172:175], v[244:247], a[216:219]
ds_read_b128 v[52:55], v17 offset:4096
v_accvgpr_read_b32 v28, a129
v_mfma_f32_16x16x32_bf16 a[220:223], v[164:167], v[244:247], a[220:223]
buffer_store_dwordx4 v[20:23], v1, s[44:47], s80 offen sc1
v_mfma_f32_16x16x32_bf16 a[220:223], v[160:163], v[240:243], a[220:223]
s_add_u32 s72, s69, 144384
buffer_load_dwordx4 v5, s[4:7], s72 offen offset:3072 lds
v_mfma_f32_16x16x32_bf16 a[252:255], v[160:163], v[248:251], a[252:255]
ds_read_b128 v[56:59], v16 offset:6144
v_accvgpr_read_b32 v25, a130
v_mfma_f32_16x16x32_bf16 a[252:255], v[164:167], v[252:255], a[252:255]
ds_read_b128 v[60:63], v17 offset:6144
v_accvgpr_read_b32 v29, a131
v_mfma_f32_16x16x32_bf16 a[248:251], v[172:175], v[252:255], a[248:251]
ds_read_b64_tr_b16 v[72:73], v9 offset:0
v_accvgpr_read_b32 v26, a132
v_mfma_f32_16x16x32_bf16 a[248:251], v[168:171], v[248:251], a[248:251]
s_add_u32 m0, s63, 102400
ds_read_b64_tr_b16 v[74:75], v9 offset:1024
v_accvgpr_read_b32 v30, a133
v_mfma_f32_16x16x32_bf16 a[244:247], v[176:179], v[248:251], a[244:247]
s_add_u32 s72, s70, 0
buffer_load_dwordx4 v4, s[4:7], s72 offen lds
v_mfma_f32_16x16x32_bf16 a[244:247], v[180:183], v[252:255], a[244:247]
ds_read_b64_tr_b16 v[76:77], v9 offset:8192
v_accvgpr_read_b32 v27, a134
v_mfma_f32_16x16x32_bf16 a[240:243], v[188:191], v[252:255], a[240:243]
v_accvgpr_read_b32 v31, a135
v_cvt_pk_bf16_f32 v24, v24, v28
v_mfma_f32_16x16x32_bf16 a[240:243], v[184:187], v[248:251], a[240:243]
ds_read_b64_tr_b16 v[78:79], v9 offset:9216
v_cvt_pk_bf16_f32 v25, v25, v29
v_mfma_f32_16x16x32_bf16 a[236:239], v[216:219], v[248:251], a[236:239]
ds_read_b64_tr_b16 v[80:81], v10 offset:0
v_cvt_pk_bf16_f32 v26, v26, v30
v_mfma_f32_16x16x32_bf16 a[236:239], v[220:223], v[252:255], a[236:239]
s_add_u32 s72, s70, 15360
buffer_load_dwordx4 v5, s[4:7], s72 offen offset:1024 lds
v_mfma_f32_16x16x32_bf16 a[232:235], v[212:215], v[252:255], a[232:235]
ds_read_b64_tr_b16 v[82:83], v10 offset:1024
v_cvt_pk_bf16_f32 v27, v27, v31
v_mfma_f32_16x16x32_bf16 a[232:235], v[208:211], v[248:251], a[232:235]
s_add_u32 s80, s78, 0
ds_read_b64_tr_b16 v[84:85], v10 offset:8192
v_mfma_f32_16x16x32_bf16 a[228:231], v[200:203], v[248:251], a[228:231]
ds_read_b64_tr_b16 v[86:87], v10 offset:9216
v_mfma_f32_16x16x32_bf16 a[228:231], v[204:207], v[252:255], a[228:231]
buffer_store_dwordx4 v[24:27], v1, s[44:47], s80 offen sc1
v_mfma_f32_16x16x32_bf16 a[224:227], v[196:199], v[252:255], a[224:227]
s_add_u32 s72, s70, 129024
buffer_load_dwordx4 v4, s[4:7], s72 offen offset:2048 lds
v_mfma_f32_16x16x32_bf16 a[224:227], v[192:195], v[248:251], a[224:227]
s_waitcnt lgkmcnt(8)
v_mfma_f32_16x16x32_bf16 v[128:131], v[64:67], v[32:35], 0
ds_read_b64_tr_b16 v[88:89], v11 offset:0
v_mfma_f32_16x16x32_bf16 v[128:131], v[68:71], v[36:39], v[128:131]
ds_read_b64_tr_b16 v[90:91], v11 offset:1024
v_mfma_f32_16x16x32_bf16 v[132:135], v[68:71], v[44:47], 0
v_accvgpr_read_b32 v20, a12
v_accvgpr_read_b32 v28, a13
v_mfma_f32_16x16x32_bf16 v[132:135], v[64:67], v[40:43], v[132:135]
s_add_u32 s72, s70, 144384
buffer_load_dwordx4 v5, s[4:7], s72 offen offset:3072 lds
v_mfma_f32_16x16x32_bf16 v[136:139], v[64:67], v[48:51], 0
s_lshl_b32 s71, s73, 12
ds_read_b64_tr_b16 v[92:93], v11 offset:8192
v_accvgpr_read_b32 v21, a14
v_mfma_f32_16x16x32_bf16 v[136:139], v[68:71], v[52:55], v[136:139]
s_add_u32 s71, s71, s66
v_accvgpr_read_b32 v29, a15
v_accvgpr_read_b32 v22, a44
v_mfma_f32_16x16x32_bf16 v[140:143], v[68:71], v[60:63], 0
s_add_u32 m0, s64, 32768
ds_read_b64_tr_b16 v[94:95], v11 offset:9216
v_accvgpr_read_b32 v30, a45
v_mfma_f32_16x16x32_bf16 v[140:143], v[64:67], v[56:59], v[140:143]
s_waitcnt lgkmcnt(8)
v_accvgpr_read_b32 v23, a46
v_accvgpr_read_b32 v31, a47
v_mfma_f32_16x16x32_bf16 v[156:159], v[72:75], v[56:59], 0
s_add_u32 s72, s71, 0
buffer_load_dwordx4 v6, s[12:15], s72 offen lds
v_mfma_f32_16x16x32_bf16 v[156:159], v[76:79], v[60:63], v[156:159]
s_add_u32 s73, s62, 3
ds_read_b64_tr_b16 v[64:65], v12 offset:0
v_mul_f32 v20, s79, v20
v_mfma_f32_16x16x32_bf16 v[152:155], v[76:79], v[52:55], 0
s_add_u32 s70, s73, s65
ds_read_b64_tr_b16 v[66:67], v12 offset:1024
v_mul_f32 v28, s79, v28
v_mfma_f32_16x16x32_bf16 v[152:155], v[72:75], v[48:51], v[152:155]
s_add_u32 s72, s71, 31744
buffer_load_dwordx4 v6, s[12:15], s72 offen offset:1024 lds
v_mfma_f32_16x16x32_bf16 v[148:151], v[72:75], v[40:43], 0
s_and_b32 s70, s70, 3
v_mul_f32 v21, s79, v21
v_mul_f32 v29, s79, v29
v_mfma_f32_16x16x32_bf16 v[148:151], v[76:79], v[44:47], v[148:151]
s_and_b32 s73, s73, 12
ds_read_b64_tr_b16 v[68:69], v12 offset:8192
v_mul_f32 v22, s79, v22
v_mfma_f32_16x16x32_bf16 v[144:147], v[76:79], v[36:39], 0
s_or_b32 s73, s73, s70
ds_read_b64_tr_b16 v[70:71], v12 offset:9216
v_mul_f32 v30, s79, v30
v_mfma_f32_16x16x32_bf16 v[144:147], v[72:75], v[32:35], v[144:147]
s_waitcnt lgkmcnt(8)
v_mul_f32 v23, s79, v23
v_mul_f32 v31, s79, v31
v_mfma_f32_16x16x32_bf16 v[160:163], v[80:83], v[32:35], 0
s_lshl_b32 s73, s73, 7
ds_read_b64_tr_b16 v[72:73], v13 offset:0
v_cvt_pk_bf16_f32 v20, v20, v28
v_mfma_f32_16x16x32_bf16 v[160:163], v[84:87], v[36:39], v[160:163]
s_add_u32 s72, s71, 63488
buffer_load_dwordx4 v7, s[12:15], s72 offen offset:2048 lds
v_mfma_f32_16x16x32_bf16 v[164:167], v[84:87], v[44:47], 0
s_add_u32 s69, s73, s67
ds_read_b64_tr_b16 v[74:75], v13 offset:1024
v_cvt_pk_bf16_f32 v21, v21, v29
v_mfma_f32_16x16x32_bf16 v[164:167], v[80:83], v[40:43], v[164:167]
s_add_u32 s70, s73, s68
v_cvt_pk_bf16_f32 v22, v22, v30
v_cvt_pk_bf16_f32 v23, v23, v31
v_mfma_f32_16x16x32_bf16 v[168:171], v[80:83], v[48:51], 0
s_waitcnt vmcnt(20)
ds_read_b64_tr_b16 v[76:77], v13 offset:8192
v_mfma_f32_16x16x32_bf16 v[168:171], v[84:87], v[52:55], v[168:171]
s_add_u32 s80, s77, 12288
ds_read_b64_tr_b16 v[78:79], v13 offset:9216
v_mfma_f32_16x16x32_bf16 v[172:175], v[84:87], v[60:63], 0
s_add_u32 s72, s71, 95232
ds_read_b128 v[96:99], v18 offset:0
v_mfma_f32_16x16x32_bf16 v[172:175], v[80:83], v[56:59], v[172:175]
s_waitcnt lgkmcnt(9)
buffer_load_dwordx4 v7, s[12:15], s72 offen offset:3072 lds
v_mfma_f32_16x16x32_bf16 v[188:191], v[88:91], v[56:59], 0
ds_read_b64_tr_b16 v[80:81], v14 offset:0
v_accvgpr_read_b32 v24, a136
v_mfma_f32_16x16x32_bf16 v[188:191], v[92:95], v[60:63], v[188:191]
ds_read_b64_tr_b16 v[82:83], v14 offset:1024
v_accvgpr_read_b32 v28, a137
v_mfma_f32_16x16x32_bf16 v[184:187], v[92:95], v[52:55], 0
ds_read_b128 v[100:103], v19 offset:0
v_accvgpr_read_b32 v25, a138
v_mfma_f32_16x16x32_bf16 v[184:187], v[88:91], v[48:51], v[184:187]
ds_read_b64_tr_b16 v[84:85], v14 offset:8192
v_accvgpr_read_b32 v29, a139
v_mfma_f32_16x16x32_bf16 v[180:183], v[88:91], v[40:43], 0
buffer_store_dwordx4 v[20:23], v1, s[44:47], s80 offen sc1
v_mfma_f32_16x16x32_bf16 v[180:183], v[92:95], v[44:47], v[180:183]
s_add_u32 m0, s63, 131072
ds_read_b64_tr_b16 v[86:87], v14 offset:9216
v_accvgpr_read_b32 v26, a140
v_mfma_f32_16x16x32_bf16 v[176:179], v[92:95], v[36:39], 0
s_add_u32 s72, s69, 0
buffer_load_dwordx4 v4, s[4:7], s72 offen lds
v_mfma_f32_16x16x32_bf16 v[176:179], v[88:91], v[32:35], v[176:179]
s_waitcnt lgkmcnt(10)
ds_read_b128 v[104:107], v18 offset:2048
v_accvgpr_read_b32 v30, a141
v_mfma_f32_16x16x32_bf16 v[192:195], v[64:67], v[32:35], 0
ds_read_b64_tr_b16 v[88:89], v15 offset:0
v_accvgpr_read_b32 v27, a142
v_mfma_f32_16x16x32_bf16 v[192:195], v[68:71], v[36:39], v[192:195]
ds_read_b64_tr_b16 v[90:91], v15 offset:1024
v_accvgpr_read_b32 v31, a143
v_mfma_f32_16x16x32_bf16 v[196:199], v[68:71], v[44:47], 0
ds_read_b64_tr_b16 v[92:93], v15 offset:8192
v_cvt_pk_bf16_f32 v24, v24, v28
v_mfma_f32_16x16x32_bf16 v[196:199], v[64:67], v[40:43], v[196:199]
s_add_u32 s72, s69, 15360
buffer_load_dwordx4 v5, s[4:7], s72 offen offset:1024 lds
v_mfma_f32_16x16x32_bf16 v[200:203], v[64:67], v[48:51], 0
ds_read_b64_tr_b16 v[94:95], v15 offset:9216
v_cvt_pk_bf16_f32 v25, v25, v29
v_mfma_f32_16x16x32_bf16 v[200:203], v[68:71], v[52:55], v[200:203]
ds_read_b128 v[108:111], v19 offset:2048
v_cvt_pk_bf16_f32 v26, v26, v30
v_mfma_f32_16x16x32_bf16 v[204:207], v[68:71], v[60:63], 0
v_cvt_pk_bf16_f32 v27, v27, v31
v_mfma_f32_16x16x32_bf16 v[204:207], v[64:67], v[56:59], v[204:207]
s_waitcnt lgkmcnt(12)
ds_read_b128 v[112:115], v18 offset:4096
v_mfma_f32_16x16x32_bf16 v[220:223], v[72:75], v[56:59], 0
s_add_u32 s72, s69, 129024
buffer_load_dwordx4 v4, s[4:7], s72 offen offset:2048 lds
v_mfma_f32_16x16x32_bf16 v[220:223], v[76:79], v[60:63], v[220:223]
s_add_u32 s80, s78, 8192
buffer_store_dwordx4 v[24:27], v1, s[44:47], s80 offen sc1
v_mfma_f32_16x16x32_bf16 v[216:219], v[76:79], v[52:55], 0
s_waitcnt vmcnt(21) lgkmcnt(2)
ds_read_b128 v[116:119], v19 offset:4096
v_mfma_f32_16x16x32_bf16 v[216:219], v[72:75], v[48:51], v[216:219]
s_barrier
ds_read_b128 v[120:123], v18 offset:6144
v_mfma_f32_16x16x32_bf16 v[212:215], v[72:75], v[40:43], 0
ds_read_b64_tr_b16 v[64:65], v8 offset:16384
ds_read_b64_tr_b16 v[66:67], v8 offset:17408
v_mfma_f32_16x16x32_bf16 v[212:215], v[76:79], v[44:47], v[212:215]
ds_read_b64_tr_b16 v[68:69], v8 offset:24576
v_mfma_f32_16x16x32_bf16 v[208:211], v[76:79], v[36:39], 0
s_add_u32 s72, s69, 144384
buffer_load_dwordx4 v5, s[4:7], s72 offen offset:3072 lds
v_mfma_f32_16x16x32_bf16 v[208:211], v[72:75], v[32:35], v[208:211]
ds_read_b64_tr_b16 v[70:71], v8 offset:25600
v_accvgpr_read_b32 v20, a16
v_mfma_f32_16x16x32_bf16 v[224:227], v[80:83], v[32:35], 0
ds_read_b64_tr_b16 v[72:73], v9 offset:16384
v_accvgpr_read_b32 v28, a17
v_mfma_f32_16x16x32_bf16 v[224:227], v[84:87], v[36:39], v[224:227]
ds_read_b64_tr_b16 v[74:75], v9 offset:17408
v_accvgpr_read_b32 v21, a18
v_mfma_f32_16x16x32_bf16 v[228:231], v[84:87], v[44:47], 0
s_add_u32 m0, s63, 135168
v_accvgpr_read_b32 v29, a19
v_accvgpr_read_b32 v22, a48
v_mfma_f32_16x16x32_bf16 v[228:231], v[80:83], v[40:43], v[228:231]
s_add_u32 s72, s70, 0
buffer_load_dwordx4 v4, s[4:7], s72 offen lds
v_mfma_f32_16x16x32_bf16 v[232:235], v[80:83], v[48:51], 0
ds_read_b64_tr_b16 v[76:77], v9 offset:24576
v_accvgpr_read_b32 v30, a49
v_mfma_f32_16x16x32_bf16 v[232:235], v[84:87], v[52:55], v[232:235]
ds_read_b128 v[124:127], v19 offset:6144
v_accvgpr_read_b32 v23, a50
v_mfma_f32_16x16x32_bf16 v[236:239], v[84:87], v[60:63], 0
ds_read_b64_tr_b16 v[78:79], v9 offset:25600
v_accvgpr_read_b32 v31, a51
v_mfma_f32_16x16x32_bf16 v[236:239], v[80:83], v[56:59], v[236:239]
v_mul_f32 v20, s79, v20
v_mul_f32 v28, s79, v28
v_mfma_f32_16x16x32_bf16 v[252:255], v[88:91], v[56:59], 0
s_add_u32 s72, s70, 15360
buffer_load_dwordx4 v5, s[4:7], s72 offen offset:1024 lds
v_mfma_f32_16x16x32_bf16 v[252:255], v[92:95], v[60:63], v[252:255]
ds_read_b64_tr_b16 v[80:81], v10 offset:16384
v_mul_f32 v21, s79, v21
v_mfma_f32_16x16x32_bf16 v[248:251], v[92:95], v[52:55], 0
ds_read_b64_tr_b16 v[82:83], v10 offset:17408
v_mul_f32 v29, s79, v29
v_mfma_f32_16x16x32_bf16 v[248:251], v[88:91], v[48:51], v[248:251]
v_mul_f32 v22, s79, v22
v_mul_f32 v30, s79, v30
v_mfma_f32_16x16x32_bf16 v[244:247], v[88:91], v[40:43], 0
ds_read_b64_tr_b16 v[84:85], v10 offset:24576
v_mul_f32 v23, s79, v23
v_mfma_f32_16x16x32_bf16 v[244:247], v[92:95], v[44:47], v[244:247]
ds_read_b64_tr_b16 v[86:87], v10 offset:25600
v_mul_f32 v31, s79, v31
v_mfma_f32_16x16x32_bf16 v[240:243], v[92:95], v[36:39], 0
s_add_u32 s72, s70, 129024
buffer_load_dwordx4 v4, s[4:7], s72 offen offset:2048 lds
v_mfma_f32_16x16x32_bf16 v[240:243], v[88:91], v[32:35], v[240:243]
s_waitcnt lgkmcnt(5)
v_cvt_pk_bf16_f32 v20, v20, v28
v_cvt_pk_bf16_f32 v21, v21, v29
v_mfma_f32_16x16x32_bf16 v[128:131], v[64:67], v[96:99], v[128:131]
ds_read_b64_tr_b16 v[88:89], v11 offset:16384
v_cvt_pk_bf16_f32 v22, v22, v30
v_mfma_f32_16x16x32_bf16 v[128:131], v[68:71], v[100:103], v[128:131]
ds_read_b64_tr_b16 v[90:91], v11 offset:17408
v_cvt_pk_bf16_f32 v23, v23, v31
v_mfma_f32_16x16x32_bf16 v[132:135], v[68:71], v[108:111], v[132:135]
s_add_u32 s80, s77, 32768
buffer_store_dwordx4 v[20:23], v1, s[44:47], s80 offen sc1
v_mfma_f32_16x16x32_bf16 v[132:135], v[64:67], v[104:107], v[132:135]
s_add_u32 s72, s70, 144384
buffer_load_dwordx4 v5, s[4:7], s72 offen offset:3072 lds
v_mfma_f32_16x16x32_bf16 v[136:139], v[64:67], v[112:115], v[136:139]
ds_read_b64_tr_b16 v[92:93], v11 offset:24576
v_accvgpr_read_b32 v24, a144
v_mfma_f32_16x16x32_bf16 v[136:139], v[68:71], v[116:119], v[136:139]
s_lshl_b32 s71, s73, 12
v_accvgpr_read_b32 v28, a145
v_accvgpr_read_b32 v25, a146
v_mfma_f32_16x16x32_bf16 v[140:143], v[68:71], v[124:127], v[140:143]
s_add_u32 s71, s71, s66
ds_read_b64_tr_b16 v[94:95], v11 offset:25600
v_accvgpr_read_b32 v29, a147
v_mfma_f32_16x16x32_bf16 v[140:143], v[64:67], v[120:123], v[140:143]
s_waitcnt lgkmcnt(8)
v_accvgpr_read_b32 v26, a148
v_accvgpr_read_b32 v30, a149
v_mfma_f32_16x16x32_bf16 v[156:159], v[72:75], v[120:123], v[156:159]
s_add_u32 m0, s64, 0
ds_read_b64_tr_b16 v[64:65], v12 offset:16384
v_accvgpr_read_b32 v27, a150
v_mfma_f32_16x16x32_bf16 v[156:159], v[76:79], v[124:127], v[156:159]
s_add_u32 s72, s71, 0
buffer_load_dwordx4 v6, s[12:15], s72 offen lds
v_mfma_f32_16x16x32_bf16 v[152:155], v[76:79], v[116:119], v[152:155]
s_add_u32 s73, s62, 4
ds_read_b64_tr_b16 v[66:67], v12 offset:17408
v_accvgpr_read_b32 v31, a151
v_mfma_f32_16x16x32_bf16 v[152:155], v[72:75], v[112:115], v[152:155]
s_add_u32 s70, s73, s65
v_cvt_pk_bf16_f32 v24, v24, v28
v_cvt_pk_bf16_f32 v25, v25, v29
v_mfma_f32_16x16x32_bf16 v[148:151], v[72:75], v[104:107], v[148:151]
s_and_b32 s70, s70, 3
ds_read_b64_tr_b16 v[68:69], v12 offset:24576
v_cvt_pk_bf16_f32 v26, v26, v30
v_mfma_f32_16x16x32_bf16 v[148:151], v[76:79], v[108:111], v[148:151]
s_and_b32 s73, s73, 12
ds_read_b64_tr_b16 v[70:71], v12 offset:25600
v_cvt_pk_bf16_f32 v27, v27, v31
v_mfma_f32_16x16x32_bf16 v[144:147], v[76:79], v[100:103], v[144:147]
s_add_u32 s72, s71, 31744
buffer_load_dwordx4 v6, s[12:15], s72 offen offset:1024 lds
v_mfma_f32_16x16x32_bf16 v[144:147], v[72:75], v[96:99], v[144:147]
s_waitcnt lgkmcnt(8)
v_mfma_f32_16x16x32_bf16 v[160:163], v[80:83], v[96:99], v[160:163]
s_or_b32 s73, s73, s70
ds_read_b64_tr_b16 v[72:73], v13 offset:16384
v_mfma_f32_16x16x32_bf16 v[160:163], v[84:87], v[100:103], v[160:163]
s_lshl_b32 s73, s73, 7
ds_read_b64_tr_b16 v[74:75], v13 offset:17408
v_mfma_f32_16x16x32_bf16 v[164:167], v[84:87], v[108:111], v[164:167]
s_add_u32 s69, s73, s67
v_mfma_f32_16x16x32_bf16 v[164:167], v[80:83], v[104:107], v[164:167]
s_add_u32 s72, s71, 63488
buffer_load_dwordx4 v7, s[12:15], s72 offen offset:2048 lds
v_mfma_f32_16x16x32_bf16 v[168:171], v[80:83], v[112:115], v[168:171]
s_waitcnt vmcnt(18)
ds_read_b64_tr_b16 v[76:77], v13 offset:24576
v_mfma_f32_16x16x32_bf16 v[168:171], v[84:87], v[116:119], v[168:171]
s_add_u32 s70, s73, s68
ds_read_b128 v[32:35], v18 offset:32768
v_mfma_f32_16x16x32_bf16 v[172:175], v[84:87], v[124:127], v[172:175]
s_add_u32 s80, s78, 32768
ds_read_b64_tr_b16 v[78:79], v13 offset:25600
v_mfma_f32_16x16x32_bf16 v[172:175], v[80:83], v[120:123], v[172:175]
s_waitcnt lgkmcnt(9)
ds_read_b128 v[36:39], v19 offset:32768
v_mfma_f32_16x16x32_bf16 v[188:191], v[88:91], v[120:123], v[188:191]
s_add_u32 s72, s71, 95232
buffer_load_dwordx4 v7, s[12:15], s72 offen offset:3072 lds
v_mfma_f32_16x16x32_bf16 v[188:191], v[92:95], v[124:127], v[188:191]
ds_read_b64_tr_b16 v[80:81], v14 offset:16384
v_mfma_f32_16x16x32_bf16 v[184:187], v[92:95], v[116:119], v[184:187]
ds_read_b64_tr_b16 v[82:83], v14 offset:17408
v_mfma_f32_16x16x32_bf16 v[184:187], v[88:91], v[112:115], v[184:187]
buffer_store_dwordx4 v[24:27], v1, s[44:47], s80 offen sc1
v_mfma_f32_16x16x32_bf16 v[180:183], v[88:91], v[104:107], v[180:183]
ds_read_b64_tr_b16 v[84:85], v14 offset:24576
v_accvgpr_read_b32 v20, a20
v_mfma_f32_16x16x32_bf16 v[180:183], v[92:95], v[108:111], v[180:183]
s_add_u32 m0, s63, 65536
ds_read_b64_tr_b16 v[86:87], v14 offset:25600
v_accvgpr_read_b32 v28, a21
v_mfma_f32_16x16x32_bf16 v[176:179], v[92:95], v[100:103], v[176:179]
s_add_u32 s72, s69, 0
buffer_load_dwordx4 v4, s[4:7], s72 offen lds
v_mfma_f32_16x16x32_bf16 v[176:179], v[88:91], v[96:99], v[176:179]
s_waitcnt lgkmcnt(10)
ds_read_b128 v[40:43], v18 offset:34816
v_accvgpr_read_b32 v21, a22
v_mfma_f32_16x16x32_bf16 v[192:195], v[64:67], v[96:99], v[192:195]
ds_read_b64_tr_b16 v[88:89], v15 offset:16384
v_accvgpr_read_b32 v29, a23
v_mfma_f32_16x16x32_bf16 v[192:195], v[68:71], v[100:103], v[192:195]
ds_read_b64_tr_b16 v[90:91], v15 offset:17408
v_accvgpr_read_b32 v22, a52
v_mfma_f32_16x16x32_bf16 v[196:199], v[68:71], v[108:111], v[196:199]
ds_read_b64_tr_b16 v[92:93], v15 offset:24576
v_accvgpr_read_b32 v30, a53
v_mfma_f32_16x16x32_bf16 v[196:199], v[64:67], v[104:107], v[196:199]
s_add_u32 s72, s69, 15360
buffer_load_dwordx4 v5, s[4:7], s72 offen offset:1024 lds
v_mfma_f32_16x16x32_bf16 v[200:203], v[64:67], v[112:115], v[200:203]
ds_read_b64_tr_b16 v[94:95], v15 offset:25600
v_accvgpr_read_b32 v23, a54
v_mfma_f32_16x16x32_bf16 v[200:203], v[68:71], v[116:119], v[200:203]
ds_read_b128 v[44:47], v19 offset:34816
v_accvgpr_read_b32 v31, a55
v_mfma_f32_16x16x32_bf16 v[204:207], v[68:71], v[124:127], v[204:207]
v_mul_f32 v20, s79, v20
v_mul_f32 v28, s79, v28
v_mfma_f32_16x16x32_bf16 v[204:207], v[64:67], v[120:123], v[204:207]
s_waitcnt lgkmcnt(11)
ds_read_b128 v[48:51], v18 offset:36864
v_mul_f32 v21, s79, v21
v_mfma_f32_16x16x32_bf16 v[220:223], v[72:75], v[120:123], v[220:223]
s_add_u32 s72, s69, 129024
buffer_load_dwordx4 v4, s[4:7], s72 offen offset:2048 lds
v_mfma_f32_16x16x32_bf16 v[220:223], v[76:79], v[124:127], v[220:223]
v_mul_f32 v29, s79, v29
v_mul_f32 v22, s79, v22
v_mfma_f32_16x16x32_bf16 v[216:219], v[76:79], v[116:119], v[216:219]
s_waitcnt vmcnt(19) lgkmcnt(2)
ds_read_b128 v[52:55], v19 offset:36864
v_mul_f32 v30, s79, v30
v_mfma_f32_16x16x32_bf16 v[216:219], v[72:75], v[112:115], v[216:219]
s_barrier
ds_read_b128 v[56:59], v18 offset:38912
v_mul_f32 v23, s79, v23
v_mfma_f32_16x16x32_bf16 v[212:215], v[72:75], v[104:107], v[212:215]
ds_read_b64_tr_b16 v[64:65], v8 offset:32768
ds_read_b64_tr_b16 v[66:67], v8 offset:33792
v_mfma_f32_16x16x32_bf16 v[212:215], v[76:79], v[108:111], v[212:215]
ds_read_b64_tr_b16 v[68:69], v8 offset:40960
v_mul_f32 v31, s79, v31
v_mfma_f32_16x16x32_bf16 v[208:211], v[76:79], v[100:103], v[208:211]
s_add_u32 s72, s69, 144384
buffer_load_dwordx4 v5, s[4:7], s72 offen offset:3072 lds
v_mfma_f32_16x16x32_bf16 v[208:211], v[72:75], v[96:99], v[208:211]
ds_read_b64_tr_b16 v[70:71], v8 offset:41984
v_cvt_pk_bf16_f32 v20, v20, v28
v_mfma_f32_16x16x32_bf16 v[224:227], v[80:83], v[96:99], v[224:227]
ds_read_b64_tr_b16 v[72:73], v9 offset:32768
v_cvt_pk_bf16_f32 v21, v21, v29
v_mfma_f32_16x16x32_bf16 v[224:227], v[84:87], v[100:103], v[224:227]
ds_read_b64_tr_b16 v[74:75], v9 offset:33792
v_cvt_pk_bf16_f32 v22, v22, v30
v_mfma_f32_16x16x32_bf16 v[228:231], v[84:87], v[108:111], v[228:231]
s_add_u32 m0, s63, 69632
v_cvt_pk_bf16_f32 v23, v23, v31
v_accvgpr_read_b32 v24, a152
v_mfma_f32_16x16x32_bf16 v[228:231], v[80:83], v[104:107], v[228:231]
s_add_u32 s72, s70, 0
buffer_load_dwordx4 v4, s[4:7], s72 offen lds
v_mfma_f32_16x16x32_bf16 v[232:235], v[80:83], v[112:115], v[232:235]
s_add_u32 s80, s77, 36864
ds_read_b64_tr_b16 v[76:77], v9 offset:40960
v_accvgpr_read_b32 v28, a153
v_mfma_f32_16x16x32_bf16 v[232:235], v[84:87], v[116:119], v[232:235]
ds_read_b128 v[60:63], v19 offset:38912
v_accvgpr_read_b32 v25, a154
v_mfma_f32_16x16x32_bf16 v[236:239], v[84:87], v[124:127], v[236:239]
ds_read_b64_tr_b16 v[78:79], v9 offset:41984
v_accvgpr_read_b32 v29, a155
v_mfma_f32_16x16x32_bf16 v[236:239], v[80:83], v[120:123], v[236:239]
buffer_store_dwordx4 v[20:23], v1, s[44:47], s80 offen sc1
v_mfma_f32_16x16x32_bf16 v[252:255], v[88:91], v[120:123], v[252:255]
s_add_u32 s72, s70, 15360
buffer_load_dwordx4 v5, s[4:7], s72 offen offset:1024 lds
v_mfma_f32_16x16x32_bf16 v[252:255], v[92:95], v[124:127], v[252:255]
ds_read_b64_tr_b16 v[80:81], v10 offset:32768
v_accvgpr_read_b32 v26, a156
v_mfma_f32_16x16x32_bf16 v[248:251], v[92:95], v[116:119], v[248:251]
ds_read_b64_tr_b16 v[82:83], v10 offset:33792
v_accvgpr_read_b32 v30, a157
v_mfma_f32_16x16x32_bf16 v[248:251], v[88:91], v[112:115], v[248:251]
v_accvgpr_read_b32 v27, a158
v_accvgpr_read_b32 v31, a159
v_mfma_f32_16x16x32_bf16 v[244:247], v[88:91], v[104:107], v[244:247]
ds_read_b64_tr_b16 v[84:85], v10 offset:40960
v_cvt_pk_bf16_f32 v24, v24, v28
v_mfma_f32_16x16x32_bf16 v[244:247], v[92:95], v[108:111], v[244:247]
ds_read_b64_tr_b16 v[86:87], v10 offset:41984
v_cvt_pk_bf16_f32 v25, v25, v29
v_mfma_f32_16x16x32_bf16 v[240:243], v[92:95], v[100:103], v[240:243]
s_add_u32 s72, s70, 129024
buffer_load_dwordx4 v4, s[4:7], s72 offen offset:2048 lds
v_mfma_f32_16x16x32_bf16 v[240:243], v[88:91], v[96:99], v[240:243]
s_waitcnt lgkmcnt(5)
v_cvt_pk_bf16_f32 v26, v26, v30
v_cvt_pk_bf16_f32 v27, v27, v31
v_mfma_f32_16x16x32_bf16 v[128:131], v[64:67], v[32:35], v[128:131]
s_add_u32 s80, s78, 40960
ds_read_b64_tr_b16 v[88:89], v11 offset:32768
v_mfma_f32_16x16x32_bf16 v[128:131], v[68:71], v[36:39], v[128:131]
ds_read_b64_tr_b16 v[90:91], v11 offset:33792
v_mfma_f32_16x16x32_bf16 v[132:135], v[68:71], v[44:47], v[132:135]
buffer_store_dwordx4 v[24:27], v1, s[44:47], s80 offen sc1
v_mfma_f32_16x16x32_bf16 v[132:135], v[64:67], v[40:43], v[132:135]
s_add_u32 s72, s70, 144384
buffer_load_dwordx4 v5, s[4:7], s72 offen offset:3072 lds
v_mfma_f32_16x16x32_bf16 v[136:139], v[64:67], v[48:51], v[136:139]
ds_read_b64_tr_b16 v[92:93], v11 offset:40960
v_mfma_f32_16x16x32_bf16 v[136:139], v[68:71], v[52:55], v[136:139]
s_lshl_b32 s71, s73, 12
v_mfma_f32_16x16x32_bf16 v[140:143], v[68:71], v[60:63], v[140:143]
s_add_u32 s71, s71, s66
ds_read_b64_tr_b16 v[94:95], v11 offset:41984
v_mfma_f32_16x16x32_bf16 v[140:143], v[64:67], v[56:59], v[140:143]
s_waitcnt lgkmcnt(8)
v_accvgpr_read_b32 v20, a24
v_accvgpr_read_b32 v28, a25
v_mfma_f32_16x16x32_bf16 v[156:159], v[72:75], v[56:59], v[156:159]
s_add_u32 m0, s64, 16384
ds_read_b64_tr_b16 v[64:65], v12 offset:32768
v_accvgpr_read_b32 v21, a26
v_mfma_f32_16x16x32_bf16 v[156:159], v[76:79], v[60:63], v[156:159]
s_add_u32 s72, s71, 0
buffer_load_dwordx4 v6, s[12:15], s72 offen lds
v_mfma_f32_16x16x32_bf16 v[152:155], v[76:79], v[52:55], v[152:155]
s_add_u32 s73, s62, 5
ds_read_b64_tr_b16 v[66:67], v12 offset:33792
v_accvgpr_read_b32 v29, a27
v_mfma_f32_16x16x32_bf16 v[152:155], v[72:75], v[48:51], v[152:155]
s_add_u32 s70, s73, s65
v_accvgpr_read_b32 v22, a56
v_accvgpr_read_b32 v30, a57
v_mfma_f32_16x16x32_bf16 v[148:151], v[72:75], v[40:43], v[148:151]
s_and_b32 s70, s70, 3
ds_read_b64_tr_b16 v[68:69], v12 offset:40960
v_accvgpr_read_b32 v23, a58
v_mfma_f32_16x16x32_bf16 v[148:151], v[76:79], v[44:47], v[148:151]
s_and_b32 s73, s73, 12
ds_read_b64_tr_b16 v[70:71], v12 offset:41984
v_accvgpr_read_b32 v31, a59
v_mfma_f32_16x16x32_bf16 v[144:147], v[76:79], v[36:39], v[144:147]
s_add_u32 s72, s71, 31744
buffer_load_dwordx4 v6, s[12:15], s72 offen offset:1024 lds
v_mfma_f32_16x16x32_bf16 v[144:147], v[72:75], v[32:35], v[144:147]
s_waitcnt lgkmcnt(8)
v_mul_f32 v20, s79, v20
v_mul_f32 v28, s79, v28
v_mfma_f32_16x16x32_bf16 v[160:163], v[80:83], v[32:35], v[160:163]
s_or_b32 s73, s73, s70
ds_read_b64_tr_b16 v[72:73], v13 offset:32768
v_mul_f32 v21, s79, v21
v_mfma_f32_16x16x32_bf16 v[160:163], v[84:87], v[36:39], v[160:163]
s_lshl_b32 s73, s73, 7
ds_read_b64_tr_b16 v[74:75], v13 offset:33792
v_mul_f32 v29, s79, v29
v_mfma_f32_16x16x32_bf16 v[164:167], v[84:87], v[44:47], v[164:167]
s_add_u32 s69, s73, s67
v_mul_f32 v22, s79, v22
v_mul_f32 v30, s79, v30
v_mfma_f32_16x16x32_bf16 v[164:167], v[80:83], v[40:43], v[164:167]
s_add_u32 s72, s71, 63488
buffer_load_dwordx4 v7, s[12:15], s72 offen offset:2048 lds
v_mfma_f32_16x16x32_bf16 v[168:171], v[80:83], v[48:51], v[168:171]
s_waitcnt vmcnt(18)
ds_read_b64_tr_b16 v[76:77], v13 offset:40960
v_mul_f32 v23, s79, v23
v_mfma_f32_16x16x32_bf16 v[168:171], v[84:87], v[52:55], v[168:171]
s_add_u32 s70, s73, s68
ds_read_b128 v[96:99], v16 offset:0
v_mul_f32 v31, s79, v31
v_mfma_f32_16x16x32_bf16 v[172:175], v[84:87], v[60:63], v[172:175]
ds_read_b64_tr_b16 v[78:79], v13 offset:41984
v_cvt_pk_bf16_f32 v20, v20, v28
v_mfma_f32_16x16x32_bf16 v[172:175], v[80:83], v[56:59], v[172:175]
s_waitcnt lgkmcnt(9)
ds_read_b128 v[100:103], v17 offset:0
v_cvt_pk_bf16_f32 v21, v21, v29
v_mfma_f32_16x16x32_bf16 v[188:191], v[88:91], v[56:59], v[188:191]
s_add_u32 s72, s71, 95232
buffer_load_dwordx4 v7, s[12:15], s72 offen offset:3072 lds
v_mfma_f32_16x16x32_bf16 v[188:191], v[92:95], v[60:63], v[188:191]
ds_read_b64_tr_b16 v[80:81], v14 offset:32768
v_cvt_pk_bf16_f32 v22, v22, v30
v_mfma_f32_16x16x32_bf16 v[184:187], v[92:95], v[52:55], v[184:187]
ds_read_b64_tr_b16 v[82:83], v14 offset:33792
v_cvt_pk_bf16_f32 v23, v23, v31
v_mfma_f32_16x16x32_bf16 v[184:187], v[88:91], v[48:51], v[184:187]
s_add_u32 s80, s77, 40960
buffer_store_dwordx4 v[20:23], v1, s[44:47], s80 offen sc1
v_mfma_f32_16x16x32_bf16 v[180:183], v[88:91], v[40:43], v[180:183]
ds_read_b64_tr_b16 v[84:85], v14 offset:40960
v_mfma_f32_16x16x32_bf16 v[180:183], v[92:95], v[44:47], v[180:183]
s_add_u32 m0, s63, 98304
ds_read_b64_tr_b16 v[86:87], v14 offset:41984
v_accvgpr_read_b32 v24, a160
v_mfma_f32_16x16x32_bf16 v[176:179], v[92:95], v[36:39], v[176:179]
s_add_u32 s72, s69, 0
buffer_load_dwordx4 v4, s[4:7], s72 offen lds
v_mfma_f32_16x16x32_bf16 v[176:179], v[88:91], v[32:35], v[176:179]
s_waitcnt lgkmcnt(10)
ds_read_b128 v[104:107], v16 offset:2048
v_accvgpr_read_b32 v28, a161
v_mfma_f32_16x16x32_bf16 v[192:195], v[64:67], v[32:35], v[192:195]
ds_read_b64_tr_b16 v[88:89], v15 offset:32768
v_accvgpr_read_b32 v25, a162
v_mfma_f32_16x16x32_bf16 v[192:195], v[68:71], v[36:39], v[192:195]
ds_read_b64_tr_b16 v[90:91], v15 offset:33792
v_accvgpr_read_b32 v29, a163
v_mfma_f32_16x16x32_bf16 v[196:199], v[68:71], v[44:47], v[196:199]
ds_read_b64_tr_b16 v[92:93], v15 offset:40960
v_accvgpr_read_b32 v26, a164
v_mfma_f32_16x16x32_bf16 v[196:199], v[64:67], v[40:43], v[196:199]
s_add_u32 s72, s69, 15360
buffer_load_dwordx4 v5, s[4:7], s72 offen offset:1024 lds
v_mfma_f32_16x16x32_bf16 v[200:203], v[64:67], v[48:51], v[200:203]
ds_read_b64_tr_b16 v[94:95], v15 offset:41984
v_accvgpr_read_b32 v30, a165
v_mfma_f32_16x16x32_bf16 v[200:203], v[68:71], v[52:55], v[200:203]
ds_read_b128 v[108:111], v17 offset:2048
v_accvgpr_read_b32 v27, a166
v_mfma_f32_16x16x32_bf16 v[204:207], v[68:71], v[60:63], v[204:207]
v_accvgpr_read_b32 v31, a167
v_cvt_pk_bf16_f32 v24, v24, v28
v_mfma_f32_16x16x32_bf16 v[204:207], v[64:67], v[56:59], v[204:207]
s_waitcnt lgkmcnt(11)
ds_read_b128 v[112:115], v16 offset:4096
v_cvt_pk_bf16_f32 v25, v25, v29
v_mfma_f32_16x16x32_bf16 v[220:223], v[72:75], v[56:59], v[220:223]
s_add_u32 s72, s69, 129024
buffer_load_dwordx4 v4, s[4:7], s72 offen offset:2048 lds
v_mfma_f32_16x16x32_bf16 v[220:223], v[76:79], v[60:63], v[220:223]
v_cvt_pk_bf16_f32 v26, v26, v30
v_cvt_pk_bf16_f32 v27, v27, v31
v_mfma_f32_16x16x32_bf16 v[216:219], v[76:79], v[52:55], v[216:219]
s_waitcnt vmcnt(19) lgkmcnt(2)
ds_read_b128 v[116:119], v17 offset:4096
v_mfma_f32_16x16x32_bf16 v[216:219], v[72:75], v[48:51], v[216:219]
s_barrier
ds_read_b128 v[120:123], v16 offset:6144
v_mfma_f32_16x16x32_bf16 v[212:215], v[72:75], v[40:43], v[212:215]
s_add_u32 s80, s78, 1024
ds_read_b64_tr_b16 v[64:65], v8 offset:0
ds_read_b64_tr_b16 v[66:67], v8 offset:1024
v_mfma_f32_16x16x32_bf16 v[212:215], v[76:79], v[44:47], v[212:215]
ds_read_b64_tr_b16 v[68:69], v8 offset:8192
v_mfma_f32_16x16x32_bf16 v[208:211], v[76:79], v[36:39], v[208:211]
s_add_u32 s72, s69, 144384
buffer_load_dwordx4 v5, s[4:7], s72 offen offset:3072 lds
v_mfma_f32_16x16x32_bf16 v[208:211], v[72:75], v[32:35], v[208:211]
ds_read_b64_tr_b16 v[70:71], v8 offset:9216
v_mfma_f32_16x16x32_bf16 v[224:227], v[80:83], v[32:35], v[224:227]
ds_read_b64_tr_b16 v[72:73], v9 offset:0
v_mfma_f32_16x16x32_bf16 v[224:227], v[84:87], v[36:39], v[224:227]
ds_read_b64_tr_b16 v[74:75], v9 offset:1024
v_mfma_f32_16x16x32_bf16 v[228:231], v[84:87], v[44:47], v[228:231]
s_add_u32 m0, s63, 102400
buffer_store_dwordx4 v[24:27], v1, s[44:47], s80 offen sc1
v_mfma_f32_16x16x32_bf16 v[228:231], v[80:83], v[40:43], v[228:231]
s_add_u32 s72, s70, 0
buffer_load_dwordx4 v4, s[4:7], s72 offen lds
v_mfma_f32_16x16x32_bf16 v[232:235], v[80:83], v[48:51], v[232:235]
ds_read_b64_tr_b16 v[76:77], v9 offset:8192
v_accvgpr_read_b32 v20, a28
v_mfma_f32_16x16x32_bf16 v[232:235], v[84:87], v[52:55], v[232:235]
ds_read_b128 v[124:127], v17 offset:6144
v_accvgpr_read_b32 v28, a29
v_mfma_f32_16x16x32_bf16 v[236:239], v[84:87], v[60:63], v[236:239]
ds_read_b64_tr_b16 v[78:79], v9 offset:9216
v_accvgpr_read_b32 v21, a30
v_mfma_f32_16x16x32_bf16 v[236:239], v[80:83], v[56:59], v[236:239]
v_accvgpr_read_b32 v29, a31
v_accvgpr_read_b32 v22, a60
v_mfma_f32_16x16x32_bf16 v[252:255], v[88:91], v[56:59], v[252:255]
s_add_u32 s72, s70, 15360
buffer_load_dwordx4 v5, s[4:7], s72 offen offset:1024 lds
v_mfma_f32_16x16x32_bf16 v[252:255], v[92:95], v[60:63], v[252:255]
ds_read_b64_tr_b16 v[80:81], v10 offset:0
v_accvgpr_read_b32 v30, a61
v_mfma_f32_16x16x32_bf16 v[248:251], v[92:95], v[52:55], v[248:251]
ds_read_b64_tr_b16 v[82:83], v10 offset:1024
v_accvgpr_read_b32 v23, a62
v_mfma_f32_16x16x32_bf16 v[248:251], v[88:91], v[48:51], v[248:251]
v_accvgpr_read_b32 v31, a63
v_mul_f32 v20, s79, v20
v_mfma_f32_16x16x32_bf16 v[244:247], v[88:91], v[40:43], v[244:247]
ds_read_b64_tr_b16 v[84:85], v10 offset:8192
v_mul_f32 v28, s79, v28
v_mfma_f32_16x16x32_bf16 v[244:247], v[92:95], v[44:47], v[244:247]
ds_read_b64_tr_b16 v[86:87], v10 offset:9216
v_mul_f32 v21, s79, v21
v_mfma_f32_16x16x32_bf16 v[240:243], v[92:95], v[36:39], v[240:243]
s_add_u32 s72, s70, 129024
buffer_load_dwordx4 v4, s[4:7], s72 offen offset:2048 lds
v_mfma_f32_16x16x32_bf16 v[240:243], v[88:91], v[32:35], v[240:243]
s_waitcnt lgkmcnt(5)
v_mul_f32 v29, s79, v29
v_mul_f32 v22, s79, v22
v_mfma_f32_16x16x32_bf16 v[128:131], v[64:67], v[96:99], v[128:131]
ds_read_b64_tr_b16 v[88:89], v11 offset:0
v_mul_f32 v30, s79, v30
v_mfma_f32_16x16x32_bf16 v[128:131], v[68:71], v[100:103], v[128:131]
ds_read_b64_tr_b16 v[90:91], v11 offset:1024
v_mul_f32 v23, s79, v23
v_mfma_f32_16x16x32_bf16 v[132:135], v[68:71], v[108:111], v[132:135]
v_mul_f32 v31, s79, v31
v_cvt_pk_bf16_f32 v20, v20, v28
v_mfma_f32_16x16x32_bf16 v[132:135], v[64:67], v[104:107], v[132:135]
s_add_u32 s72, s70, 144384
buffer_load_dwordx4 v5, s[4:7], s72 offen offset:3072 lds
v_mfma_f32_16x16x32_bf16 v[136:139], v[64:67], v[112:115], v[136:139]
ds_read_b64_tr_b16 v[92:93], v11 offset:8192
v_cvt_pk_bf16_f32 v21, v21, v29
v_mfma_f32_16x16x32_bf16 v[136:139], v[68:71], v[116:119], v[136:139]
s_lshl_b32 s71, s73, 12
v_cvt_pk_bf16_f32 v22, v22, v30
v_cvt_pk_bf16_f32 v23, v23, v31
v_mfma_f32_16x16x32_bf16 v[140:143], v[68:71], v[124:127], v[140:143]
s_add_u32 s71, s71, s66
ds_read_b64_tr_b16 v[94:95], v11 offset:9216
v_mfma_f32_16x16x32_bf16 v[140:143], v[64:67], v[120:123], v[140:143]
s_waitcnt lgkmcnt(8)
v_mfma_f32_16x16x32_bf16 v[156:159], v[72:75], v[120:123], v[156:159]
s_add_u32 m0, s64, 32768
ds_read_b64_tr_b16 v[64:65], v12 offset:0
v_mfma_f32_16x16x32_bf16 v[156:159], v[76:79], v[124:127], v[156:159]
s_add_u32 s72, s71, 0
buffer_load_dwordx4 v6, s[12:15], s72 offen lds
v_mfma_f32_16x16x32_bf16 v[152:155], v[76:79], v[116:119], v[152:155]
s_add_u32 s73, s62, 6
ds_read_b64_tr_b16 v[66:67], v12 offset:1024
v_accvgpr_read_b32 v24, a168
v_mfma_f32_16x16x32_bf16 v[152:155], v[72:75], v[112:115], v[152:155]
s_add_u32 s70, s73, s65
v_accvgpr_read_b32 v28, a169
v_accvgpr_read_b32 v25, a170
v_mfma_f32_16x16x32_bf16 v[148:151], v[72:75], v[104:107], v[148:151]
s_and_b32 s70, s70, 3
ds_read_b64_tr_b16 v[68:69], v12 offset:8192
v_accvgpr_read_b32 v29, a171
v_mfma_f32_16x16x32_bf16 v[148:151], v[76:79], v[108:111], v[148:151]
s_and_b32 s73, s73, 12
ds_read_b64_tr_b16 v[70:71], v12 offset:9216
v_accvgpr_read_b32 v26, a172
v_mfma_f32_16x16x32_bf16 v[144:147], v[76:79], v[100:103], v[144:147]
s_add_u32 s72, s71, 31744
buffer_load_dwordx4 v6, s[12:15], s72 offen offset:1024 lds
v_mfma_f32_16x16x32_bf16 v[144:147], v[72:75], v[96:99], v[144:147]
s_waitcnt lgkmcnt(8)
v_accvgpr_read_b32 v30, a173
v_accvgpr_read_b32 v27, a174
v_mfma_f32_16x16x32_bf16 v[160:163], v[80:83], v[96:99], v[160:163]
s_or_b32 s73, s73, s70
ds_read_b64_tr_b16 v[72:73], v13 offset:0
v_accvgpr_read_b32 v31, a175
v_mfma_f32_16x16x32_bf16 v[160:163], v[84:87], v[100:103], v[160:163]
s_lshl_b32 s73, s73, 7
ds_read_b64_tr_b16 v[74:75], v13 offset:1024
v_cvt_pk_bf16_f32 v24, v24, v28
v_mfma_f32_16x16x32_bf16 v[164:167], v[84:87], v[108:111], v[164:167]
s_add_u32 s69, s73, s67
v_cvt_pk_bf16_f32 v25, v25, v29
v_cvt_pk_bf16_f32 v26, v26, v30
v_mfma_f32_16x16x32_bf16 v[164:167], v[80:83], v[104:107], v[164:167]
s_add_u32 s72, s71, 63488
buffer_load_dwordx4 v7, s[12:15], s72 offen offset:2048 lds
v_mfma_f32_16x16x32_bf16 v[168:171], v[80:83], v[112:115], v[168:171]
s_waitcnt vmcnt(17)
ds_read_b64_tr_b16 v[76:77], v13 offset:8192
v_cvt_pk_bf16_f32 v27, v27, v31
v_mfma_f32_16x16x32_bf16 v[168:171], v[84:87], v[116:119], v[168:171]
s_add_u32 s70, s73, s68
ds_read_b128 v[32:35], v18 offset:0
v_mfma_f32_16x16x32_bf16 v[172:175], v[84:87], v[124:127], v[172:175]
s_add_u32 s80, s77, 45056
ds_read_b64_tr_b16 v[78:79], v13 offset:9216
v_mfma_f32_16x16x32_bf16 v[172:175], v[80:83], v[120:123], v[172:175]
s_waitcnt lgkmcnt(9)
ds_read_b128 v[36:39], v19 offset:0
v_mfma_f32_16x16x32_bf16 v[188:191], v[88:91], v[120:123], v[188:191]
s_add_u32 s72, s71, 95232
buffer_load_dwordx4 v7, s[12:15], s72 offen offset:3072 lds
v_mfma_f32_16x16x32_bf16 v[188:191], v[92:95], v[124:127], v[188:191]
ds_read_b64_tr_b16 v[80:81], v14 offset:0
v_mfma_f32_16x16x32_bf16 v[184:187], v[92:95], v[116:119], v[184:187]
ds_read_b64_tr_b16 v[82:83], v14 offset:1024
v_mfma_f32_16x16x32_bf16 v[184:187], v[88:91], v[112:115], v[184:187]
buffer_store_dwordx4 v[20:23], v1, s[44:47], s80 offen sc1
v_mfma_f32_16x16x32_bf16 v[180:183], v[88:91], v[104:107], v[180:183]
s_add_u32 s80, s78, 9216
ds_read_b64_tr_b16 v[84:85], v14 offset:8192
v_mfma_f32_16x16x32_bf16 v[180:183], v[92:95], v[108:111], v[180:183]
s_add_u32 m0, s63, 131072
ds_read_b64_tr_b16 v[86:87], v14 offset:9216
v_mfma_f32_16x16x32_bf16 v[176:179], v[92:95], v[100:103], v[176:179]
s_add_u32 s72, s69, 0
buffer_load_dwordx4 v4, s[4:7], s72 offen lds
v_mfma_f32_16x16x32_bf16 v[176:179], v[88:91], v[96:99], v[176:179]
s_waitcnt lgkmcnt(10)
ds_read_b128 v[40:43], v18 offset:2048
v_accvgpr_read_b32 v20, a64
v_mfma_f32_16x16x32_bf16 v[192:195], v[64:67], v[96:99], v[192:195]
ds_read_b64_tr_b16 v[88:89], v15 offset:0
v_accvgpr_read_b32 v28, a65
v_mfma_f32_16x16x32_bf16 v[192:195], v[68:71], v[100:103], v[192:195]
ds_read_b64_tr_b16 v[90:91], v15 offset:1024
v_accvgpr_read_b32 v21, a66
v_mfma_f32_16x16x32_bf16 v[196:199], v[68:71], v[108:111], v[196:199]
ds_read_b64_tr_b16 v[92:93], v15 offset:8192
v_accvgpr_read_b32 v29, a67
v_mfma_f32_16x16x32_bf16 v[196:199], v[64:67], v[104:107], v[196:199]
s_add_u32 s72, s69, 15360
buffer_load_dwordx4 v5, s[4:7], s72 offen offset:1024 lds
v_mfma_f32_16x16x32_bf16 v[200:203], v[64:67], v[112:115], v[200:203]
ds_read_b64_tr_b16 v[94:95], v15 offset:9216
v_accvgpr_read_b32 v22, a96
v_mfma_f32_16x16x32_bf16 v[200:203], v[68:71], v[116:119], v[200:203]
ds_read_b128 v[44:47], v19 offset:2048
v_accvgpr_read_b32 v30, a97
v_mfma_f32_16x16x32_bf16 v[204:207], v[68:71], v[124:127], v[204:207]
buffer_store_dwordx4 v[24:27], v1, s[44:47], s80 offen sc1
v_mfma_f32_16x16x32_bf16 v[204:207], v[64:67], v[120:123], v[204:207]
s_waitcnt lgkmcnt(11)
ds_read_b128 v[48:51], v18 offset:4096
v_accvgpr_read_b32 v23, a98
v_mfma_f32_16x16x32_bf16 v[220:223], v[72:75], v[120:123], v[220:223]
s_add_u32 s72, s69, 129024
buffer_load_dwordx4 v4, s[4:7], s72 offen offset:2048 lds
v_mfma_f32_16x16x32_bf16 v[220:223], v[76:79], v[124:127], v[220:223]
v_accvgpr_read_b32 v31, a99
v_mul_f32 v20, s79, v20
v_mfma_f32_16x16x32_bf16 v[216:219], v[76:79], v[116:119], v[216:219]
s_waitcnt vmcnt(19) lgkmcnt(2)
ds_read_b128 v[52:55], v19 offset:4096
v_mul_f32 v28, s79, v28
v_mfma_f32_16x16x32_bf16 v[216:219], v[72:75], v[112:115], v[216:219]
s_barrier
ds_read_b128 v[56:59], v18 offset:6144
v_mul_f32 v21, s79, v21
v_mfma_f32_16x16x32_bf16 v[212:215], v[72:75], v[104:107], v[212:215]
ds_read_b64_tr_b16 v[64:65], v8 offset:16384
ds_read_b64_tr_b16 v[66:67], v8 offset:17408
v_mfma_f32_16x16x32_bf16 v[212:215], v[76:79], v[108:111], v[212:215]
ds_read_b64_tr_b16 v[68:69], v8 offset:24576
v_mul_f32 v29, s79, v29
v_mfma_f32_16x16x32_bf16 v[208:211], v[76:79], v[100:103], v[208:211]
s_add_u32 s72, s69, 144384
buffer_load_dwordx4 v5, s[4:7], s72 offen offset:3072 lds
v_mfma_f32_16x16x32_bf16 v[208:211], v[72:75], v[96:99], v[208:211]
ds_read_b64_tr_b16 v[70:71], v8 offset:25600
v_mul_f32 v22, s79, v22
v_mfma_f32_16x16x32_bf16 v[224:227], v[80:83], v[96:99], v[224:227]
ds_read_b64_tr_b16 v[72:73], v9 offset:16384
v_mul_f32 v30, s79, v30
v_mfma_f32_16x16x32_bf16 v[224:227], v[84:87], v[100:103], v[224:227]
ds_read_b64_tr_b16 v[74:75], v9 offset:17408
v_mul_f32 v23, s79, v23
v_mfma_f32_16x16x32_bf16 v[228:231], v[84:87], v[108:111], v[228:231]
s_add_u32 m0, s63, 135168
v_mul_f32 v31, s79, v31
v_cvt_pk_bf16_f32 v20, v20, v28
v_mfma_f32_16x16x32_bf16 v[228:231], v[80:83], v[104:107], v[228:231]
s_add_u32 s72, s70, 0
buffer_load_dwordx4 v4, s[4:7], s72 offen lds
v_mfma_f32_16x16x32_bf16 v[232:235], v[80:83], v[112:115], v[232:235]
ds_read_b64_tr_b16 v[76:77], v9 offset:24576
v_cvt_pk_bf16_f32 v21, v21, v29
v_mfma_f32_16x16x32_bf16 v[232:235], v[84:87], v[116:119], v[232:235]
ds_read_b128 v[60:63], v19 offset:6144
v_cvt_pk_bf16_f32 v22, v22, v30
v_mfma_f32_16x16x32_bf16 v[236:239], v[84:87], v[124:127], v[236:239]
ds_read_b64_tr_b16 v[78:79], v9 offset:25600
v_cvt_pk_bf16_f32 v23, v23, v31
v_mfma_f32_16x16x32_bf16 v[236:239], v[80:83], v[120:123], v[236:239]
s_add_u32 s80, s77, 1024
buffer_store_dwordx4 v[20:23], v1, s[44:47], s80 offen sc1
v_mfma_f32_16x16x32_bf16 v[252:255], v[88:91], v[120:123], v[252:255]
s_add_u32 s72, s70, 15360
buffer_load_dwordx4 v5, s[4:7], s72 offen offset:1024 lds
v_mfma_f32_16x16x32_bf16 v[252:255], v[92:95], v[124:127], v[252:255]
ds_read_b64_tr_b16 v[80:81], v10 offset:16384
v_accvgpr_read_b32 v24, a176
v_mfma_f32_16x16x32_bf16 v[248:251], v[92:95], v[116:119], v[248:251]
ds_read_b64_tr_b16 v[82:83], v10 offset:17408
v_accvgpr_read_b32 v28, a177
v_mfma_f32_16x16x32_bf16 v[248:251], v[88:91], v[112:115], v[248:251]
v_accvgpr_read_b32 v25, a178
v_accvgpr_read_b32 v29, a179
v_mfma_f32_16x16x32_bf16 v[244:247], v[88:91], v[104:107], v[244:247]
ds_read_b64_tr_b16 v[84:85], v10 offset:24576
v_accvgpr_read_b32 v26, a180
v_mfma_f32_16x16x32_bf16 v[244:247], v[92:95], v[108:111], v[244:247]
ds_read_b64_tr_b16 v[86:87], v10 offset:25600
v_accvgpr_read_b32 v30, a181
v_mfma_f32_16x16x32_bf16 v[240:243], v[92:95], v[100:103], v[240:243]
s_add_u32 s72, s70, 129024
buffer_load_dwordx4 v4, s[4:7], s72 offen offset:2048 lds
v_mfma_f32_16x16x32_bf16 v[240:243], v[88:91], v[96:99], v[240:243]
s_waitcnt lgkmcnt(5)
v_accvgpr_read_b32 v27, a182
v_accvgpr_read_b32 v31, a183
v_mfma_f32_16x16x32_bf16 v[128:131], v[64:67], v[32:35], v[128:131]
ds_read_b64_tr_b16 v[88:89], v11 offset:16384
v_cvt_pk_bf16_f32 v24, v24, v28
v_mfma_f32_16x16x32_bf16 v[128:131], v[68:71], v[36:39], v[128:131]
ds_read_b64_tr_b16 v[90:91], v11 offset:17408
v_cvt_pk_bf16_f32 v25, v25, v29
v_mfma_f32_16x16x32_bf16 v[132:135], v[68:71], v[44:47], v[132:135]
v_cvt_pk_bf16_f32 v26, v26, v30
v_cvt_pk_bf16_f32 v27, v27, v31
v_mfma_f32_16x16x32_bf16 v[132:135], v[64:67], v[40:43], v[132:135]
s_add_u32 s72, s70, 144384
buffer_load_dwordx4 v5, s[4:7], s72 offen offset:3072 lds
v_mfma_f32_16x16x32_bf16 v[136:139], v[64:67], v[48:51], v[136:139]
s_add_u32 s80, s78, 33792
ds_read_b64_tr_b16 v[92:93], v11 offset:24576
v_mfma_f32_16x16x32_bf16 v[136:139], v[68:71], v[52:55], v[136:139]
s_lshl_b32 s71, s73, 12
buffer_store_dwordx4 v[24:27], v1, s[44:47], s80 offen sc1
v_mfma_f32_16x16x32_bf16 v[140:143], v[68:71], v[60:63], v[140:143]
s_add_u32 s71, s71, s66
ds_read_b64_tr_b16 v[94:95], v11 offset:25600
v_mfma_f32_16x16x32_bf16 v[140:143], v[64:67], v[56:59], v[140:143]
s_waitcnt lgkmcnt(8)
v_mfma_f32_16x16x32_bf16 v[156:159], v[72:75], v[56:59], v[156:159]
s_add_u32 m0, s64, 0
ds_read_b64_tr_b16 v[64:65], v12 offset:16384
v_mfma_f32_16x16x32_bf16 v[156:159], v[76:79], v[60:63], v[156:159]
s_add_u32 s72, s71, 0
buffer_load_dwordx4 v6, s[12:15], s72 offen lds
v_mfma_f32_16x16x32_bf16 v[152:155], v[76:79], v[52:55], v[152:155]
s_add_u32 s73, s62, 7
ds_read_b64_tr_b16 v[66:67], v12 offset:17408
v_mfma_f32_16x16x32_bf16 v[152:155], v[72:75], v[48:51], v[152:155]
s_add_u32 s70, s73, s65
v_mfma_f32_16x16x32_bf16 v[148:151], v[72:75], v[40:43], v[148:151]
s_and_b32 s70, s70, 3
ds_read_b64_tr_b16 v[68:69], v12 offset:24576
v_accvgpr_read_b32 v20, a68
v_mfma_f32_16x16x32_bf16 v[148:151], v[76:79], v[44:47], v[148:151]
s_and_b32 s73, s73, 12
ds_read_b64_tr_b16 v[70:71], v12 offset:25600
v_accvgpr_read_b32 v28, a69
v_mfma_f32_16x16x32_bf16 v[144:147], v[76:79], v[36:39], v[144:147]
s_add_u32 s72, s71, 31744
buffer_load_dwordx4 v6, s[12:15], s72 offen offset:1024 lds
v_mfma_f32_16x16x32_bf16 v[144:147], v[72:75], v[32:35], v[144:147]
s_waitcnt lgkmcnt(8)
v_accvgpr_read_b32 v21, a70
v_accvgpr_read_b32 v29, a71
v_mfma_f32_16x16x32_bf16 v[160:163], v[80:83], v[32:35], v[160:163]
s_or_b32 s73, s73, s70
ds_read_b64_tr_b16 v[72:73], v13 offset:16384
v_accvgpr_read_b32 v22, a100
v_mfma_f32_16x16x32_bf16 v[160:163], v[84:87], v[36:39], v[160:163]
s_lshl_b32 s73, s73, 7
ds_read_b64_tr_b16 v[74:75], v13 offset:17408
v_accvgpr_read_b32 v30, a101
v_mfma_f32_16x16x32_bf16 v[164:167], v[84:87], v[44:47], v[164:167]
s_add_u32 s69, s73, s67
v_accvgpr_read_b32 v23, a102
v_accvgpr_read_b32 v31, a103
v_mfma_f32_16x16x32_bf16 v[164:167], v[80:83], v[40:43], v[164:167]
s_add_u32 s72, s71, 63488
buffer_load_dwordx4 v7, s[12:15], s72 offen offset:2048 lds
v_mfma_f32_16x16x32_bf16 v[168:171], v[80:83], v[48:51], v[168:171]
s_waitcnt vmcnt(19)
ds_read_b64_tr_b16 v[76:77], v13 offset:24576
v_mul_f32 v20, s79, v20
v_mfma_f32_16x16x32_bf16 v[168:171], v[84:87], v[52:55], v[168:171]
s_add_u32 s70, s73, s68
ds_read_b128 v[96:99], v18 offset:32768
v_mul_f32 v28, s79, v28
v_mfma_f32_16x16x32_bf16 v[172:175], v[84:87], v[60:63], v[172:175]
ds_read_b64_tr_b16 v[78:79], v13 offset:25600
v_mul_f32 v21, s79, v21
v_mfma_f32_16x16x32_bf16 v[172:175], v[80:83], v[56:59], v[172:175]
s_waitcnt lgkmcnt(9)
ds_read_b128 v[100:103], v19 offset:32768
v_mul_f32 v29, s79, v29
v_mfma_f32_16x16x32_bf16 v[188:191], v[88:91], v[56:59], v[188:191]
s_add_u32 s72, s71, 95232
buffer_load_dwordx4 v7, s[12:15], s72 offen offset:3072 lds
v_mfma_f32_16x16x32_bf16 v[188:191], v[92:95], v[60:63], v[188:191]
ds_read_b64_tr_b16 v[80:81], v14 offset:16384
v_mul_f32 v22, s79, v22
v_mfma_f32_16x16x32_bf16 v[184:187], v[92:95], v[52:55], v[184:187]
ds_read_b64_tr_b16 v[82:83], v14 offset:17408
v_mul_f32 v30, s79, v30
v_mfma_f32_16x16x32_bf16 v[184:187], v[88:91], v[48:51], v[184:187]
v_mul_f32 v23, s79, v23
v_mul_f32 v31, s79, v31
v_mfma_f32_16x16x32_bf16 v[180:183], v[88:91], v[40:43], v[180:183]
ds_read_b64_tr_b16 v[84:85], v14 offset:24576
v_cvt_pk_bf16_f32 v20, v20, v28
v_mfma_f32_16x16x32_bf16 v[180:183], v[92:95], v[44:47], v[180:183]
s_add_u32 m0, s63, 65536
ds_read_b64_tr_b16 v[86:87], v14 offset:25600
v_cvt_pk_bf16_f32 v21, v21, v29
v_mfma_f32_16x16x32_bf16 v[176:179], v[92:95], v[36:39], v[176:179]
s_add_u32 s72, s69, 0
buffer_load_dwordx4 v4, s[4:7], s72 offen lds
v_mfma_f32_16x16x32_bf16 v[176:179], v[88:91], v[32:35], v[176:179]
s_waitcnt lgkmcnt(10)
ds_read_b128 v[104:107], v18 offset:34816
v_cvt_pk_bf16_f32 v22, v22, v30
v_mfma_f32_16x16x32_bf16 v[192:195], v[64:67], v[32:35], v[192:195]
ds_read_b64_tr_b16 v[88:89], v15 offset:16384
v_cvt_pk_bf16_f32 v23, v23, v31
v_mfma_f32_16x16x32_bf16 v[192:195], v[68:71], v[36:39], v[192:195]
s_add_u32 s80, s77, 5120
ds_read_b64_tr_b16 v[90:91], v15 offset:17408
v_mfma_f32_16x16x32_bf16 v[196:199], v[68:71], v[44:47], v[196:199]
ds_read_b64_tr_b16 v[92:93], v15 offset:24576
v_accvgpr_read_b32 v24, a184
v_mfma_f32_16x16x32_bf16 v[196:199], v[64:67], v[40:43], v[196:199]
s_add_u32 s72, s69, 15360
buffer_load_dwordx4 v5, s[4:7], s72 offen offset:1024 lds
v_mfma_f32_16x16x32_bf16 v[200:203], v[64:67], v[48:51], v[200:203]
ds_read_b64_tr_b16 v[94:95], v15 offset:25600
v_accvgpr_read_b32 v28, a185
v_mfma_f32_16x16x32_bf16 v[200:203], v[68:71], v[52:55], v[200:203]
ds_read_b128 v[108:111], v19 offset:34816
v_accvgpr_read_b32 v25, a186
v_mfma_f32_16x16x32_bf16 v[204:207], v[68:71], v[60:63], v[204:207]
buffer_store_dwordx4 v[20:23], v1, s[44:47], s80 offen sc1
v_mfma_f32_16x16x32_bf16 v[204:207], v[64:67], v[56:59], v[204:207]
s_waitcnt lgkmcnt(11)
ds_read_b128 v[112:115], v18 offset:36864
v_accvgpr_read_b32 v29, a187
v_mfma_f32_16x16x32_bf16 v[220:223], v[72:75], v[56:59], v[220:223]
s_add_u32 s72, s69, 129024
buffer_load_dwordx4 v4, s[4:7], s72 offen offset:2048 lds
v_mfma_f32_16x16x32_bf16 v[220:223], v[76:79], v[60:63], v[220:223]
v_accvgpr_read_b32 v26, a188
v_accvgpr_read_b32 v30, a189
v_mfma_f32_16x16x32_bf16 v[216:219], v[76:79], v[52:55], v[216:219]
s_waitcnt vmcnt(20) lgkmcnt(2)
ds_read_b128 v[116:119], v19 offset:36864
v_accvgpr_read_b32 v27, a190
v_mfma_f32_16x16x32_bf16 v[216:219], v[72:75], v[48:51], v[216:219]
s_barrier
ds_read_b128 v[120:123], v18 offset:38912
v_accvgpr_read_b32 v31, a191
v_mfma_f32_16x16x32_bf16 v[212:215], v[72:75], v[40:43], v[212:215]
ds_read_b64_tr_b16 v[64:65], v8 offset:32768
ds_read_b64_tr_b16 v[66:67], v8 offset:33792
v_mfma_f32_16x16x32_bf16 v[212:215], v[76:79], v[44:47], v[212:215]
ds_read_b64_tr_b16 v[68:69], v8 offset:40960
v_cvt_pk_bf16_f32 v24, v24, v28
v_mfma_f32_16x16x32_bf16 v[208:211], v[76:79], v[36:39], v[208:211]
s_add_u32 s72, s69, 144384
buffer_load_dwordx4 v5, s[4:7], s72 offen offset:3072 lds
v_mfma_f32_16x16x32_bf16 v[208:211], v[72:75], v[32:35], v[208:211]
ds_read_b64_tr_b16 v[70:71], v8 offset:41984
v_cvt_pk_bf16_f32 v25, v25, v29
v_mfma_f32_16x16x32_bf16 v[224:227], v[80:83], v[32:35], v[224:227]
ds_read_b64_tr_b16 v[72:73], v9 offset:32768
v_cvt_pk_bf16_f32 v26, v26, v30
v_mfma_f32_16x16x32_bf16 v[224:227], v[84:87], v[36:39], v[224:227]
ds_read_b64_tr_b16 v[74:75], v9 offset:33792
v_cvt_pk_bf16_f32 v27, v27, v31
v_mfma_f32_16x16x32_bf16 v[228:231], v[84:87], v[44:47], v[228:231]
s_add_u32 m0, s63, 69632
v_mfma_f32_16x16x32_bf16 v[228:231], v[80:83], v[40:43], v[228:231]
s_add_u32 s72, s70, 0
buffer_load_dwordx4 v4, s[4:7], s72 offen lds
v_mfma_f32_16x16x32_bf16 v[232:235], v[80:83], v[48:51], v[232:235]
s_add_u32 s80, s78, 41984
ds_read_b64_tr_b16 v[76:77], v9 offset:40960
v_mfma_f32_16x16x32_bf16 v[232:235], v[84:87], v[52:55], v[232:235]
ds_read_b128 v[124:127], v19 offset:38912
v_mfma_f32_16x16x32_bf16 v[236:239], v[84:87], v[60:63], v[236:239]
ds_read_b64_tr_b16 v[78:79], v9 offset:41984
v_mfma_f32_16x16x32_bf16 v[236:239], v[80:83], v[56:59], v[236:239]
buffer_store_dwordx4 v[24:27], v1, s[44:47], s80 offen sc1
v_mfma_f32_16x16x32_bf16 v[252:255], v[88:91], v[56:59], v[252:255]
s_add_u32 s72, s70, 15360
buffer_load_dwordx4 v5, s[4:7], s72 offen offset:1024 lds
v_mfma_f32_16x16x32_bf16 v[252:255], v[92:95], v[60:63], v[252:255]
ds_read_b64_tr_b16 v[80:81], v10 offset:32768
v_accvgpr_read_b32 v20, a72
v_mfma_f32_16x16x32_bf16 v[248:251], v[92:95], v[52:55], v[248:251]
ds_read_b64_tr_b16 v[82:83], v10 offset:33792
v_accvgpr_read_b32 v28, a73
v_mfma_f32_16x16x32_bf16 v[248:251], v[88:91], v[48:51], v[248:251]
v_accvgpr_read_b32 v21, a74
v_accvgpr_read_b32 v29, a75
v_mfma_f32_16x16x32_bf16 v[244:247], v[88:91], v[40:43], v[244:247]
ds_read_b64_tr_b16 v[84:85], v10 offset:40960
v_accvgpr_read_b32 v22, a104
v_mfma_f32_16x16x32_bf16 v[244:247], v[92:95], v[44:47], v[244:247]
ds_read_b64_tr_b16 v[86:87], v10 offset:41984
v_accvgpr_read_b32 v30, a105
v_mfma_f32_16x16x32_bf16 v[240:243], v[92:95], v[36:39], v[240:243]
s_add_u32 s72, s70, 129024
buffer_load_dwordx4 v4, s[4:7], s72 offen offset:2048 lds
v_mfma_f32_16x16x32_bf16 v[240:243], v[88:91], v[32:35], v[240:243]
s_waitcnt lgkmcnt(5)
v_accvgpr_read_b32 v23, a106
v_accvgpr_read_b32 v31, a107
v_mfma_f32_16x16x32_bf16 v[128:131], v[64:67], v[96:99], v[128:131]
s_lshr_b32 s75, s93, 4
ds_read_b64_tr_b16 v[88:89], v11 offset:32768
v_mul_f32 v20, s79, v20
v_mfma_f32_16x16x32_bf16 v[128:131], v[68:71], v[100:103], v[128:131]
s_and_b32 s75, s75, 0x7f00
ds_read_b64_tr_b16 v[90:91], v11 offset:33792
v_mul_f32 v28, s79, v28
v_mfma_f32_16x16x32_bf16 v[132:135], v[68:71], v[108:111], v[132:135]
s_add_u32 s75, s75, LcB1-Lpc0
v_lshrrev_b32 v2, 5, v0
v_lshlrev_b32 v2, 7, v2
v_mfma_f32_16x16x32_bf16 v[132:135], v[64:67], v[104:107], v[132:135]
s_add_u32 s72, s70, 144384
buffer_load_dwordx4 v5, s[4:7], s72 offen offset:3072 lds
v_mfma_f32_16x16x32_bf16 v[136:139], v[64:67], v[112:115], v[136:139]
v_add_u32 v2, s75, v2
v_min_u32 v2, Lcode_end-Lpc0, v2
v_mfma_f32_16x16x32_bf16 v[136:139], v[68:71], v[116:119], v[136:139]
s_lshl_b32 s71, s73, 12
global_load_dword v3, v2, s[98:99]
v_mfma_f32_16x16x32_bf16 v[140:143], v[68:71], v[124:127], v[140:143]
s_add_u32 s71, s71, s66
ds_read_b64_tr_b16 v[92:93], v11 offset:40960
v_mul_f32 v21, s79, v21
v_mfma_f32_16x16x32_bf16 v[140:143], v[64:67], v[120:123], v[140:143]
s_waitcnt lgkmcnt(7)
ds_read_b64_tr_b16 v[94:95], v11 offset:41984
v_mul_f32 v29, s79, v29
v_mfma_f32_16x16x32_bf16 v[156:159], v[72:75], v[120:123], v[156:159]
s_add_u32 m0, s64, 16384
ds_read_b64_tr_b16 v[64:65], v12 offset:32768
v_mul_f32 v22, s79, v22
v_mfma_f32_16x16x32_bf16 v[156:159], v[76:79], v[124:127], v[156:159]
s_add_u32 s72, s71, 0
buffer_load_dwordx4 v6, s[12:15], s72 offen lds
v_mfma_f32_16x16x32_bf16 v[152:155], v[76:79], v[116:119], v[152:155]
s_add_u32 s73, s62, 8
ds_read_b64_tr_b16 v[66:67], v12 offset:33792
v_mul_f32 v30, s79, v30
v_mfma_f32_16x16x32_bf16 v[152:155], v[72:75], v[112:115], v[152:155]
s_add_u32 s70, s73, s65
v_mul_f32 v23, s79, v23
v_mul_f32 v31, s79, v31
v_mfma_f32_16x16x32_bf16 v[148:151], v[72:75], v[104:107], v[148:151]
s_and_b32 s70, s70, 3
ds_read_b64_tr_b16 v[68:69], v12 offset:40960
v_cvt_pk_bf16_f32 v20, v20, v28
v_mfma_f32_16x16x32_bf16 v[148:151], v[76:79], v[108:111], v[148:151]
s_and_b32 s73, s73, 12
ds_read_b64_tr_b16 v[70:71], v12 offset:41984
v_cvt_pk_bf16_f32 v21, v21, v29
v_mfma_f32_16x16x32_bf16 v[144:147], v[76:79], v[100:103], v[144:147]
s_add_u32 s72, s71, 31744
buffer_load_dwordx4 v6, s[12:15], s72 offen offset:1024 lds
v_mfma_f32_16x16x32_bf16 v[144:147], v[72:75], v[96:99], v[144:147]
s_waitcnt lgkmcnt(8)
v_cvt_pk_bf16_f32 v22, v22, v30
v_cvt_pk_bf16_f32 v23, v23, v31
v_mfma_f32_16x16x32_bf16 v[160:163], v[80:83], v[96:99], v[160:163]
s_or_b32 s73, s73, s70
ds_read_b64_tr_b16 v[72:73], v13 offset:32768
v_accvgpr_read_b32 v24, a192
v_mfma_f32_16x16x32_bf16 v[160:163], v[84:87], v[100:103], v[160:163]
s_lshl_b32 s73, s73, 7
ds_read_b64_tr_b16 v[74:75], v13 offset:33792
v_accvgpr_read_b32 v28, a193
v_mfma_f32_16x16x32_bf16 v[164:167], v[84:87], v[108:111], v[164:167]
s_add_u32 s69, s73, s67
v_accvgpr_read_b32 v25, a194
v_accvgpr_read_b32 v29, a195
v_mfma_f32_16x16x32_bf16 v[164:167], v[80:83], v[104:107], v[164:167]
s_add_u32 s72, s71, 63488
buffer_load_dwordx4 v7, s[12:15], s72 offen offset:2048 lds
v_mfma_f32_16x16x32_bf16 v[168:171], v[80:83], v[112:115], v[168:171]
s_waitcnt vmcnt(19)
ds_read_b64_tr_b16 v[76:77], v13 offset:40960
v_accvgpr_read_b32 v26, a196
v_mfma_f32_16x16x32_bf16 v[168:171], v[84:87], v[116:119], v[168:171]
s_add_u32 s70, s73, s68
ds_read_b128 v[32:35], v16 offset:0
v_accvgpr_read_b32 v30, a197
v_mfma_f32_16x16x32_bf16 v[172:175], v[84:87], v[124:127], v[172:175]
s_add_u32 s80, s77, 9216
ds_read_b64_tr_b16 v[78:79], v13 offset:41984
v_accvgpr_read_b32 v27, a198
v_mfma_f32_16x16x32_bf16 v[172:175], v[80:83], v[120:123], v[172:175]
s_waitcnt lgkmcnt(9)
ds_read_b128 v[36:39], v17 offset:0
v_accvgpr_read_b32 v31, a199
v_mfma_f32_16x16x32_bf16 v[188:191], v[88:91], v[120:123], v[188:191]
s_add_u32 s72, s71, 95232
buffer_load_dwordx4 v7, s[12:15], s72 offen offset:3072 lds
v_mfma_f32_16x16x32_bf16 v[188:191], v[92:95], v[124:127], v[188:191]
ds_read_b64_tr_b16 v[80:81], v14 offset:32768
v_cvt_pk_bf16_f32 v24, v24, v28
v_mfma_f32_16x16x32_bf16 v[184:187], v[92:95], v[116:119], v[184:187]
ds_read_b64_tr_b16 v[82:83], v14 offset:33792
v_cvt_pk_bf16_f32 v25, v25, v29
v_mfma_f32_16x16x32_bf16 v[184:187], v[88:91], v[112:115], v[184:187]
buffer_store_dwordx4 v[20:23], v1, s[44:47], s80 offen sc1
v_mfma_f32_16x16x32_bf16 v[180:183], v[88:91], v[104:107], v[180:183]
ds_read_b64_tr_b16 v[84:85], v14 offset:40960
v_cvt_pk_bf16_f32 v26, v26, v30
v_mfma_f32_16x16x32_bf16 v[180:183], v[92:95], v[108:111], v[180:183]
s_add_u32 m0, s63, 98304
ds_read_b64_tr_b16 v[86:87], v14 offset:41984
v_cvt_pk_bf16_f32 v27, v27, v31
v_mfma_f32_16x16x32_bf16 v[176:179], v[92:95], v[100:103], v[176:179]
s_add_u32 s72, s69, 0
buffer_load_dwordx4 v4, s[4:7], s72 offen lds
v_mfma_f32_16x16x32_bf16 v[176:179], v[88:91], v[96:99], v[176:179]
s_waitcnt lgkmcnt(10)
ds_read_b128 v[40:43], v16 offset:2048
v_mfma_f32_16x16x32_bf16 v[192:195], v[64:67], v[96:99], v[192:195]
s_add_u32 s80, s78, 2048
ds_read_b64_tr_b16 v[88:89], v15 offset:32768
v_mfma_f32_16x16x32_bf16 v[192:195], v[68:71], v[100:103], v[192:195]
ds_read_b64_tr_b16 v[90:91], v15 offset:33792
v_mfma_f32_16x16x32_bf16 v[196:199], v[68:71], v[108:111], v[196:199]
ds_read_b64_tr_b16 v[92:93], v15 offset:40960
v_mfma_f32_16x16x32_bf16 v[196:199], v[64:67], v[104:107], v[196:199]
s_add_u32 s72, s69, 15360
buffer_load_dwordx4 v5, s[4:7], s72 offen offset:1024 lds
v_mfma_f32_16x16x32_bf16 v[200:203], v[64:67], v[112:115], v[200:203]
ds_read_b64_tr_b16 v[94:95], v15 offset:41984
v_accvgpr_read_b32 v20, a76
v_mfma_f32_16x16x32_bf16 v[200:203], v[68:71], v[116:119], v[200:203]
ds_read_b128 v[44:47], v17 offset:2048
v_accvgpr_read_b32 v28, a77
v_mfma_f32_16x16x32_bf16 v[204:207], v[68:71], v[124:127], v[204:207]
buffer_store_dwordx4 v[24:27], v1, s[44:47], s80 offen sc1
v_mfma_f32_16x16x32_bf16 v[204:207], v[64:67], v[120:123], v[204:207]
s_waitcnt lgkmcnt(11)
ds_read_b128 v[48:51], v16 offset:4096
v_accvgpr_read_b32 v21, a78
v_mfma_f32_16x16x32_bf16 v[220:223], v[72:75], v[120:123], v[220:223]
s_add_u32 s72, s69, 129024
buffer_load_dwordx4 v4, s[4:7], s72 offen offset:2048 lds
v_mfma_f32_16x16x32_bf16 v[220:223], v[76:79], v[124:127], v[220:223]
v_accvgpr_read_b32 v29, a79
v_accvgpr_read_b32 v22, a108
v_mfma_f32_16x16x32_bf16 v[216:219], v[76:79], v[116:119], v[216:219]
s_waitcnt vmcnt(20) lgkmcnt(2)
ds_read_b128 v[52:55], v17 offset:4096
v_accvgpr_read_b32 v30, a109
v_mfma_f32_16x16x32_bf16 v[216:219], v[72:75], v[112:115], v[216:219]
s_barrier
ds_read_b128 v[56:59], v16 offset:6144
v_accvgpr_read_b32 v23, a110
v_mfma_f32_16x16x32_bf16 v[212:215], v[72:75], v[104:107], v[212:215]
ds_read_b64_tr_b16 v[64:65], v8 offset:0
ds_read_b64_tr_b16 v[66:67], v8 offset:1024
v_mfma_f32_16x16x32_bf16 v[212:215], v[76:79], v[108:111], v[212:215]
ds_read_b64_tr_b16 v[68:69], v8 offset:8192
v_accvgpr_read_b32 v31, a111
v_mfma_f32_16x16x32_bf16 v[208:211], v[76:79], v[100:103], v[208:211]
s_add_u32 s72, s69, 144384
buffer_load_dwordx4 v5, s[4:7], s72 offen offset:3072 lds
v_mfma_f32_16x16x32_bf16 v[208:211], v[72:75], v[96:99], v[208:211]
ds_read_b64_tr_b16 v[70:71], v8 offset:9216
v_mul_f32 v20, s79, v20
v_mfma_f32_16x16x32_bf16 v[224:227], v[80:83], v[96:99], v[224:227]
ds_read_b64_tr_b16 v[72:73], v9 offset:0
v_mul_f32 v28, s79, v28
v_mfma_f32_16x16x32_bf16 v[224:227], v[84:87], v[100:103], v[224:227]
ds_read_b64_tr_b16 v[74:75], v9 offset:1024
v_mul_f32 v21, s79, v21
v_mfma_f32_16x16x32_bf16 v[228:231], v[84:87], v[108:111], v[228:231]
s_add_u32 m0, s63, 102400
v_mul_f32 v29, s79, v29
v_mul_f32 v22, s79, v22
v_mfma_f32_16x16x32_bf16 v[228:231], v[80:83], v[104:107], v[228:231]
s_add_u32 s72, s70, 0
buffer_load_dwordx4 v4, s[4:7], s72 offen lds
v_mfma_f32_16x16x32_bf16 v[232:235], v[80:83], v[112:115], v[232:235]
ds_read_b64_tr_b16 v[76:77], v9 offset:8192
v_mul_f32 v30, s79, v30
v_mfma_f32_16x16x32_bf16 v[232:235], v[84:87], v[116:119], v[232:235]
ds_read_b128 v[60:63], v17 offset:6144
v_mul_f32 v23, s79, v23
v_mfma_f32_16x16x32_bf16 v[236:239], v[84:87], v[124:127], v[236:239]
ds_read_b64_tr_b16 v[78:79], v9 offset:9216
v_mul_f32 v31, s79, v31
v_mfma_f32_16x16x32_bf16 v[236:239], v[80:83], v[120:123], v[236:239]
v_cvt_pk_bf16_f32 v20, v20, v28
v_cvt_pk_bf16_f32 v21, v21, v29
v_mfma_f32_16x16x32_bf16 v[252:255], v[88:91], v[120:123], v[252:255]
s_add_u32 s72, s70, 15360
buffer_load_dwordx4 v5, s[4:7], s72 offen offset:1024 lds
v_mfma_f32_16x16x32_bf16 v[252:255], v[92:95], v[124:127], v[252:255]
ds_read_b64_tr_b16 v[80:81], v10 offset:0
v_cvt_pk_bf16_f32 v22, v22, v30
v_mfma_f32_16x16x32_bf16 v[248:251], v[92:95], v[116:119], v[248:251]
ds_read_b64_tr_b16 v[82:83], v10 offset:1024
v_cvt_pk_bf16_f32 v23, v23, v31
v_mfma_f32_16x16x32_bf16 v[248:251], v[88:91], v[112:115], v[248:251]
s_add_u32 s80, s77, 13312
buffer_store_dwordx4 v[20:23], v1, s[44:47], s80 offen sc1
v_mfma_f32_16x16x32_bf16 v[244:247], v[88:91], v[104:107], v[244:247]
ds_read_b64_tr_b16 v[84:85], v10 offset:8192
v_accvgpr_read_b32 v24, a200
v_mfma_f32_16x16x32_bf16 v[244:247], v[92:95], v[108:111], v[244:247]
ds_read_b64_tr_b16 v[86:87], v10 offset:9216
v_accvgpr_read_b32 v28, a201
v_mfma_f32_16x16x32_bf16 v[240:243], v[92:95], v[100:103], v[240:243]
s_add_u32 s72, s70, 129024
buffer_load_dwordx4 v4, s[4:7], s72 offen offset:2048 lds
v_mfma_f32_16x16x32_bf16 v[240:243], v[88:91], v[96:99], v[240:243]
s_waitcnt lgkmcnt(5)
v_accvgpr_read_b32 v25, a202
v_accvgpr_read_b32 v29, a203
v_mfma_f32_16x16x32_bf16 v[128:131], v[64:67], v[32:35], v[128:131]
ds_read_b64_tr_b16 v[88:89], v11 offset:0
v_accvgpr_read_b32 v26, a204
v_mfma_f32_16x16x32_bf16 v[128:131], v[68:71], v[36:39], v[128:131]
ds_read_b64_tr_b16 v[90:91], v11 offset:1024
v_accvgpr_read_b32 v30, a205
v_mfma_f32_16x16x32_bf16 v[132:135], v[68:71], v[44:47], v[132:135]
v_accvgpr_read_b32 v27, a206
v_accvgpr_read_b32 v31, a207
v_mfma_f32_16x16x32_bf16 v[132:135], v[64:67], v[40:43], v[132:135]
s_add_u32 s72, s70, 144384
buffer_load_dwordx4 v5, s[4:7], s72 offen offset:3072 lds
v_mfma_f32_16x16x32_bf16 v[136:139], v[64:67], v[48:51], v[136:139]
ds_read_b64_tr_b16 v[92:93], v11 offset:8192
v_cvt_pk_bf16_f32 v24, v24, v28
v_mfma_f32_16x16x32_bf16 v[136:139], v[68:71], v[52:55], v[136:139]
s_lshl_b32 s71, s73, 12
v_cvt_pk_bf16_f32 v25, v25, v29
v_cvt_pk_bf16_f32 v26, v26, v30
v_mfma_f32_16x16x32_bf16 v[140:143], v[68:71], v[60:63], v[140:143]
s_add_u32 s71, s71, s66
ds_read_b64_tr_b16 v[94:95], v11 offset:9216
v_cvt_pk_bf16_f32 v27, v27, v31
v_mfma_f32_16x16x32_bf16 v[140:143], v[64:67], v[56:59], v[140:143]
s_waitcnt lgkmcnt(8)
v_mfma_f32_16x16x32_bf16 v[156:159], v[72:75], v[56:59], v[156:159]
s_add_u32 m0, s64, 32768
ds_read_b64_tr_b16 v[64:65], v12 offset:0
v_mfma_f32_16x16x32_bf16 v[156:159], v[76:79], v[60:63], v[156:159]
s_add_u32 s72, s71, 0
buffer_load_dwordx4 v6, s[12:15], s72 offen lds
v_mfma_f32_16x16x32_bf16 v[152:155], v[76:79], v[52:55], v[152:155]
s_add_u32 s73, s62, 9
ds_read_b64_tr_b16 v[66:67], v12 offset:1024
v_mfma_f32_16x16x32_bf16 v[152:155], v[72:75], v[48:51], v[152:155]
s_add_u32 s70, s73, s65
v_mfma_f32_16x16x32_bf16 v[148:151], v[72:75], v[40:43], v[148:151]
s_and_b32 s70, s70, 3
ds_read_b64_tr_b16 v[68:69], v12 offset:8192
v_mfma_f32_16x16x32_bf16 v[148:151], v[76:79], v[44:47], v[148:151]
s_and_b32 s73, s73, 12
ds_read_b64_tr_b16 v[70:71], v12 offset:9216
v_mfma_f32_16x16x32_bf16 v[144:147], v[76:79], v[36:39], v[144:147]
s_add_u32 s72, s71, 31744
buffer_load_dwordx4 v6, s[12:15], s72 offen offset:1024 lds
v_mfma_f32_16x16x32_bf16 v[144:147], v[72:75], v[32:35], v[144:147]
s_waitcnt lgkmcnt(8)
v_mfma_f32_16x16x32_bf16 v[160:163], v[80:83], v[32:35], v[160:163]
s_or_b32 s73, s73, s70
ds_read_b64_tr_b16 v[72:73], v13 offset:0
v_accvgpr_read_b32 v20, a80
v_mfma_f32_16x16x32_bf16 v[160:163], v[84:87], v[36:39], v[160:163]
s_lshl_b32 s73, s73, 7
ds_read_b64_tr_b16 v[74:75], v13 offset:1024
v_accvgpr_read_b32 v28, a81
v_mfma_f32_16x16x32_bf16 v[164:167], v[84:87], v[44:47], v[164:167]
s_add_u32 s69, s73, s67
v_accvgpr_read_b32 v21, a82
v_accvgpr_read_b32 v29, a83
v_mfma_f32_16x16x32_bf16 v[164:167], v[80:83], v[40:43], v[164:167]
s_add_u32 s72, s71, 63488
buffer_load_dwordx4 v7, s[12:15], s72 offen offset:2048 lds
v_mfma_f32_16x16x32_bf16 v[168:171], v[80:83], v[48:51], v[168:171]
s_waitcnt vmcnt(19)
ds_read_b64_tr_b16 v[76:77], v13 offset:8192
v_accvgpr_read_b32 v22, a112
v_mfma_f32_16x16x32_bf16 v[168:171], v[84:87], v[52:55], v[168:171]
s_add_u32 s70, s73, s68
ds_read_b128 v[96:99], v18 offset:0
v_accvgpr_read_b32 v30, a113
v_mfma_f32_16x16x32_bf16 v[172:175], v[84:87], v[60:63], v[172:175]
s_add_u32 s80, s78, 10240
ds_read_b64_tr_b16 v[78:79], v13 offset:9216
v_accvgpr_read_b32 v23, a114
v_mfma_f32_16x16x32_bf16 v[172:175], v[80:83], v[56:59], v[172:175]
s_waitcnt lgkmcnt(9)
ds_read_b128 v[100:103], v19 offset:0
v_accvgpr_read_b32 v31, a115
v_mfma_f32_16x16x32_bf16 v[188:191], v[88:91], v[56:59], v[188:191]
s_add_u32 s72, s71, 95232
buffer_load_dwordx4 v7, s[12:15], s72 offen offset:3072 lds
v_mfma_f32_16x16x32_bf16 v[188:191], v[92:95], v[60:63], v[188:191]
ds_read_b64_tr_b16 v[80:81], v14 offset:0
v_mul_f32 v20, s79, v20
v_mfma_f32_16x16x32_bf16 v[184:187], v[92:95], v[52:55], v[184:187]
ds_read_b64_tr_b16 v[82:83], v14 offset:1024
v_mul_f32 v28, s79, v28
v_mfma_f32_16x16x32_bf16 v[184:187], v[88:91], v[48:51], v[184:187]
buffer_store_dwordx4 v[24:27], v1, s[44:47], s80 offen sc1
v_mfma_f32_16x16x32_bf16 v[180:183], v[88:91], v[40:43], v[180:183]
ds_read_b64_tr_b16 v[84:85], v14 offset:8192
v_mul_f32 v21, s79, v21
v_mfma_f32_16x16x32_bf16 v[180:183], v[92:95], v[44:47], v[180:183]
s_add_u32 m0, s63, 131072
ds_read_b64_tr_b16 v[86:87], v14 offset:9216
v_mul_f32 v29, s79, v29
v_mfma_f32_16x16x32_bf16 v[176:179], v[92:95], v[36:39], v[176:179]
s_add_u32 s72, s69, 0
buffer_load_dwordx4 v4, s[4:7], s72 offen lds
v_mfma_f32_16x16x32_bf16 v[176:179], v[88:91], v[32:35], v[176:179]
s_waitcnt lgkmcnt(10)
ds_read_b128 v[104:107], v18 offset:2048
v_mul_f32 v22, s79, v22
v_mfma_f32_16x16x32_bf16 v[192:195], v[64:67], v[32:35], v[192:195]
ds_read_b64_tr_b16 v[88:89], v15 offset:0
v_mul_f32 v30, s79, v30
v_mfma_f32_16x16x32_bf16 v[192:195], v[68:71], v[36:39], v[192:195]
ds_read_b64_tr_b16 v[90:91], v15 offset:1024
v_mul_f32 v23, s79, v23
v_mfma_f32_16x16x32_bf16 v[196:199], v[68:71], v[44:47], v[196:199]
ds_read_b64_tr_b16 v[92:93], v15 offset:8192
v_mul_f32 v31, s79, v31
v_mfma_f32_16x16x32_bf16 v[196:199], v[64:67], v[40:43], v[196:199]
s_add_u32 s72, s69, 15360
buffer_load_dwordx4 v5, s[4:7], s72 offen offset:1024 lds
v_mfma_f32_16x16x32_bf16 v[200:203], v[64:67], v[48:51], v[200:203]
ds_read_b64_tr_b16 v[94:95], v15 offset:9216
v_cvt_pk_bf16_f32 v20, v20, v28
v_mfma_f32_16x16x32_bf16 v[200:203], v[68:71], v[52:55], v[200:203]
ds_read_b128 v[108:111], v19 offset:2048
v_cvt_pk_bf16_f32 v21, v21, v29
v_mfma_f32_16x16x32_bf16 v[204:207], v[68:71], v[60:63], v[204:207]
v_cvt_pk_bf16_f32 v22, v22, v30
v_cvt_pk_bf16_f32 v23, v23, v31
v_mfma_f32_16x16x32_bf16 v[204:207], v[64:67], v[56:59], v[204:207]
s_waitcnt lgkmcnt(11)
ds_read_b128 v[112:115], v18 offset:4096
v_accvgpr_read_b32 v24, a208
v_mfma_f32_16x16x32_bf16 v[220:223], v[72:75], v[56:59], v[220:223]
s_add_u32 s72, s69, 129024
buffer_load_dwordx4 v4, s[4:7], s72 offen offset:2048 lds
v_mfma_f32_16x16x32_bf16 v[220:223], v[76:79], v[60:63], v[220:223]
s_add_u32 s80, s77, 33792
s_nop 3
s_mov_b64 exec, 0
s_cmp_eq_u32 s58, 0
s_cbranch_scc1 Lstub0
s_cmp_eq_u32 s58, 1
s_cbranch_scc1 Lstub1
s_cmp_eq_u32 s58, 2
s_cbranch_scc1 Lstub2
s_branch Lstub3
Lret:
s_mov_b64 exec, -1
s_nop 3
v_mfma_f32_16x16x32_bf16 v[216:219], v[76:79], v[52:55], v[216:219]
s_waitcnt vmcnt(19) lgkmcnt(2)
ds_read_b128 v[116:119], v19 offset:4096
v_accvgpr_read_b32 v28, a209
v_mfma_f32_16x16x32_bf16 v[216:219], v[72:75], v[48:51], v[216:219]
s_barrier
buffer_store_dwordx4 v[20:23], v1, s[44:47], s80 offen sc1
v_mfma_f32_16x16x32_bf16 v[212:215], v[72:75], v[40:43], v[212:215]
ds_read_b64_tr_b16 v[64:65], v8 offset:16384
ds_read_b64_tr_b16 v[66:67], v8 offset:17408
v_mfma_f32_16x16x32_bf16 v[212:215], v[76:79], v[44:47], v[212:215]
ds_read_b64_tr_b16 v[68:69], v8 offset:24576
v_accvgpr_read_b32 v25, a210
v_mfma_f32_16x16x32_bf16 v[208:211], v[76:79], v[36:39], v[208:211]
s_add_u32 s72, s69, 144384
buffer_load_dwordx4 v5, s[4:7], s72 offen offset:3072 lds
v_mfma_f32_16x16x32_bf16 v[208:211], v[72:75], v[32:35], v[208:211]
ds_read_b64_tr_b16 v[70:71], v8 offset:25600
v_accvgpr_read_b32 v29, a211
v_mfma_f32_16x16x32_bf16 v[224:227], v[80:83], v[32:35], v[224:227]
ds_read_b64_tr_b16 v[72:73], v9 offset:16384
v_accvgpr_read_b32 v26, a212
v_mfma_f32_16x16x32_bf16 v[224:227], v[84:87], v[36:39], v[224:227]
ds_read_b64_tr_b16 v[74:75], v9 offset:17408
v_accvgpr_read_b32 v30, a213
v_mfma_f32_16x16x32_bf16 v[228:231], v[84:87], v[44:47], v[228:231]
s_add_u32 m0, s63, 135168
ds_read_b128 v[120:123], v18 offset:6144
v_accvgpr_read_b32 v27, a214
v_mfma_f32_16x16x32_bf16 v[228:231], v[80:83], v[40:43], v[228:231]
s_add_u32 s72, s70, 0
buffer_load_dwordx4 v4, s[4:7], s72 offen lds
v_mfma_f32_16x16x32_bf16 v[232:235], v[80:83], v[48:51], v[232:235]
ds_read_b64_tr_b16 v[76:77], v9 offset:24576
v_accvgpr_read_b32 v31, a215
v_mfma_f32_16x16x32_bf16 v[232:235], v[84:87], v[52:55], v[232:235]
ds_read_b128 v[124:127], v19 offset:6144
v_cvt_pk_bf16_f32 v24, v24, v28
v_mfma_f32_16x16x32_bf16 v[236:239], v[84:87], v[60:63], v[236:239]
ds_read_b64_tr_b16 v[78:79], v9 offset:25600
v_cvt_pk_bf16_f32 v25, v25, v29
v_mfma_f32_16x16x32_bf16 v[236:239], v[80:83], v[56:59], v[236:239]
v_cvt_pk_bf16_f32 v26, v26, v30
v_cvt_pk_bf16_f32 v27, v27, v31
v_mfma_f32_16x16x32_bf16 v[252:255], v[88:91], v[56:59], v[252:255]
s_add_u32 s72, s70, 15360
buffer_load_dwordx4 v5, s[4:7], s72 offen offset:1024 lds
v_mfma_f32_16x16x32_bf16 v[252:255], v[92:95], v[60:63], v[252:255]
s_add_u32 s80, s78, 34816
ds_read_b64_tr_b16 v[80:81], v10 offset:16384
v_mfma_f32_16x16x32_bf16 v[248:251], v[92:95], v[52:55], v[248:251]
ds_read_b64_tr_b16 v[82:83], v10 offset:17408
v_mfma_f32_16x16x32_bf16 v[248:251], v[88:91], v[48:51], v[248:251]
buffer_store_dwordx4 v[24:27], v1, s[44:47], s80 offen sc1
v_mfma_f32_16x16x32_bf16 v[244:247], v[88:91], v[40:43], v[244:247]
ds_read_b64_tr_b16 v[84:85], v10 offset:24576
v_mfma_f32_16x16x32_bf16 v[244:247], v[92:95], v[44:47], v[244:247]
ds_read_b64_tr_b16 v[86:87], v10 offset:25600
v_accvgpr_read_b32 v20, a84
v_mfma_f32_16x16x32_bf16 v[240:243], v[92:95], v[36:39], v[240:243]
s_add_u32 s72, s70, 129024
buffer_load_dwordx4 v4, s[4:7], s72 offen offset:2048 lds
v_mfma_f32_16x16x32_bf16 v[240:243], v[88:91], v[32:35], v[240:243]
s_waitcnt lgkmcnt(5)
v_accvgpr_read_b32 v28, a85
v_accvgpr_read_b32 v21, a86
v_mfma_f32_16x16x32_bf16 v[128:131], v[64:67], v[96:99], v[128:131]
ds_read_b64_tr_b16 v[88:89], v11 offset:16384
v_accvgpr_read_b32 v29, a87
v_mfma_f32_16x16x32_bf16 v[128:131], v[68:71], v[100:103], v[128:131]
ds_read_b64_tr_b16 v[90:91], v11 offset:17408
v_accvgpr_read_b32 v22, a116
v_mfma_f32_16x16x32_bf16 v[132:135], v[68:71], v[108:111], v[132:135]
v_accvgpr_read_b32 v30, a117
v_accvgpr_read_b32 v23, a118
v_mfma_f32_16x16x32_bf16 v[132:135], v[64:67], v[104:107], v[132:135]
s_add_u32 s72, s70, 144384
buffer_load_dwordx4 v5, s[4:7], s72 offen offset:3072 lds
v_mfma_f32_16x16x32_bf16 v[136:139], v[64:67], v[112:115], v[136:139]
ds_read_b64_tr_b16 v[92:93], v11 offset:24576
v_accvgpr_read_b32 v31, a119
v_mfma_f32_16x16x32_bf16 v[136:139], v[68:71], v[116:119], v[136:139]
s_lshl_b32 s71, s73, 12
v_mul_f32 v20, s79, v20
v_mul_f32 v28, s79, v28
v_mfma_f32_16x16x32_bf16 v[140:143], v[68:71], v[124:127], v[140:143]
s_add_u32 s71, s71, s66
ds_read_b64_tr_b16 v[94:95], v11 offset:25600
v_mul_f32 v21, s79, v21
v_mfma_f32_16x16x32_bf16 v[140:143], v[64:67], v[120:123], v[140:143]
s_waitcnt lgkmcnt(8)
v_mul_f32 v29, s79, v29
v_mul_f32 v22, s79, v22
v_mfma_f32_16x16x32_bf16 v[156:159], v[72:75], v[120:123], v[156:159]
s_add_u32 m0, s64, 0
ds_read_b64_tr_b16 v[64:65], v12 offset:16384
v_mul_f32 v30, s79, v30
v_mfma_f32_16x16x32_bf16 v[156:159], v[76:79], v[124:127], v[156:159]
s_add_u32 s72, s71, 0
buffer_load_dwordx4 v6, s[12:15], s72 offen lds
v_mfma_f32_16x16x32_bf16 v[152:155], v[76:79], v[116:119], v[152:155]
s_add_u32 s73, s62, 10
ds_read_b64_tr_b16 v[66:67], v12 offset:17408
v_mul_f32 v23, s79, v23
v_mfma_f32_16x16x32_bf16 v[152:155], v[72:75], v[112:115], v[152:155]
s_add_u32 s70, s73, s65
v_mul_f32 v31, s79, v31
v_cvt_pk_bf16_f32 v20, v20, v28
v_mfma_f32_16x16x32_bf16 v[148:151], v[72:75], v[104:107], v[148:151]
s_and_b32 s70, s70, 3
ds_read_b64_tr_b16 v[68:69], v12 offset:24576
v_cvt_pk_bf16_f32 v21, v21, v29
v_mfma_f32_16x16x32_bf16 v[148:151], v[76:79], v[108:111], v[148:151]
s_and_b32 s73, s73, 12
ds_read_b64_tr_b16 v[70:71], v12 offset:25600
v_cvt_pk_bf16_f32 v22, v22, v30
v_mfma_f32_16x16x32_bf16 v[144:147], v[76:79], v[100:103], v[144:147]
s_add_u32 s72, s71, 31744
buffer_load_dwordx4 v6, s[12:15], s72 offen offset:1024 lds
v_mfma_f32_16x16x32_bf16 v[144:147], v[72:75], v[96:99], v[144:147]
s_waitcnt lgkmcnt(8)
v_cvt_pk_bf16_f32 v23, v23, v31
v_mfma_f32_16x16x32_bf16 v[160:163], v[80:83], v[96:99], v[160:163]
s_or_b32 s73, s73, s70
ds_read_b64_tr_b16 v[72:73], v13 offset:16384
v_mfma_f32_16x16x32_bf16 v[160:163], v[84:87], v[100:103], v[160:163]
s_lshl_b32 s73, s73, 7
ds_read_b64_tr_b16 v[74:75], v13 offset:17408
v_mfma_f32_16x16x32_bf16 v[164:167], v[84:87], v[108:111], v[164:167]
s_add_u32 s69, s73, s67
v_mfma_f32_16x16x32_bf16 v[164:167], v[80:83], v[104:107], v[164:167]
s_add_u32 s72, s71, 63488
buffer_load_dwordx4 v7, s[12:15], s72 offen offset:2048 lds
v_mfma_f32_16x16x32_bf16 v[168:171], v[80:83], v[112:115], v[168:171]
s_waitcnt vmcnt(18)
ds_read_b64_tr_b16 v[76:77], v13 offset:24576
v_accvgpr_read_b32 v24, a216
v_mfma_f32_16x16x32_bf16 v[168:171], v[84:87], v[116:119], v[168:171]
s_add_u32 s70, s73, s68
ds_read_b128 v[32:35], v18 offset:32768
v_accvgpr_read_b32 v28, a217
v_mfma_f32_16x16x32_bf16 v[172:175], v[84:87], v[124:127], v[172:175]
s_add_u32 s80, s77, 37888
ds_read_b64_tr_b16 v[78:79], v13 offset:25600
v_accvgpr_read_b32 v25, a218
v_mfma_f32_16x16x32_bf16 v[172:175], v[80:83], v[120:123], v[172:175]
s_waitcnt lgkmcnt(9)
ds_read_b128 v[36:39], v19 offset:32768
v_accvgpr_read_b32 v29, a219
v_mfma_f32_16x16x32_bf16 v[188:191], v[88:91], v[120:123], v[188:191]
s_add_u32 s72, s71, 95232
buffer_load_dwordx4 v7, s[12:15], s72 offen offset:3072 lds
v_mfma_f32_16x16x32_bf16 v[188:191], v[92:95], v[124:127], v[188:191]
ds_read_b64_tr_b16 v[80:81], v14 offset:16384
v_accvgpr_read_b32 v26, a220
v_mfma_f32_16x16x32_bf16 v[184:187], v[92:95], v[116:119], v[184:187]
ds_read_b64_tr_b16 v[82:83], v14 offset:17408
v_accvgpr_read_b32 v30, a221
v_mfma_f32_16x16x32_bf16 v[184:187], v[88:91], v[112:115], v[184:187]
buffer_store_dwordx4 v[20:23], v1, s[44:47], s80 offen sc1
v_mfma_f32_16x16x32_bf16 v[180:183], v[88:91], v[104:107], v[180:183]
ds_read_b64_tr_b16 v[84:85], v14 offset:24576
v_accvgpr_read_b32 v27, a222
v_mfma_f32_16x16x32_bf16 v[180:183], v[92:95], v[108:111], v[180:183]
s_add_u32 m0, s63, 65536
ds_read_b64_tr_b16 v[86:87], v14 offset:25600
v_accvgpr_read_b32 v31, a223
v_mfma_f32_16x16x32_bf16 v[176:179], v[92:95], v[100:103], v[176:179]
s_add_u32 s72, s69, 0
buffer_load_dwordx4 v4, s[4:7], s72 offen lds
v_mfma_f32_16x16x32_bf16 v[176:179], v[88:91], v[96:99], v[176:179]
s_waitcnt lgkmcnt(10)
ds_read_b128 v[40:43], v18 offset:34816
v_cvt_pk_bf16_f32 v24, v24, v28
v_mfma_f32_16x16x32_bf16 v[192:195], v[64:67], v[96:99], v[192:195]
ds_read_b64_tr_b16 v[88:89], v15 offset:16384
v_cvt_pk_bf16_f32 v25, v25, v29
v_mfma_f32_16x16x32_bf16 v[192:195], v[68:71], v[100:103], v[192:195]
ds_read_b64_tr_b16 v[90:91], v15 offset:17408
v_cvt_pk_bf16_f32 v26, v26, v30
v_mfma_f32_16x16x32_bf16 v[196:199], v[68:71], v[108:111], v[196:199]
ds_read_b64_tr_b16 v[92:93], v15 offset:24576
v_cvt_pk_bf16_f32 v27, v27, v31
v_mfma_f32_16x16x32_bf16 v[196:199], v[64:67], v[104:107], v[196:199]
s_add_u32 s72, s69, 15360
buffer_load_dwordx4 v5, s[4:7], s72 offen offset:1024 lds
v_mfma_f32_16x16x32_bf16 v[200:203], v[64:67], v[112:115], v[200:203]
s_add_u32 s80, s78, 43008
ds_read_b64_tr_b16 v[94:95], v15 offset:25600
v_mfma_f32_16x16x32_bf16 v[200:203], v[68:71], v[116:119], v[200:203]
ds_read_b128 v[44:47], v19 offset:34816
v_mfma_f32_16x16x32_bf16 v[204:207], v[68:71], v[124:127], v[204:207]
buffer_store_dwordx4 v[24:27], v1, s[44:47], s80 offen sc1
v_mfma_f32_16x16x32_bf16 v[204:207], v[64:67], v[120:123], v[204:207]
s_waitcnt lgkmcnt(11)
ds_read_b128 v[48:51], v18 offset:36864
v_mfma_f32_16x16x32_bf16 v[220:223], v[72:75], v[120:123], v[220:223]
s_add_u32 s72, s69, 129024
buffer_load_dwordx4 v4, s[4:7], s72 offen offset:2048 lds
v_mfma_f32_16x16x32_bf16 v[220:223], v[76:79], v[124:127], v[220:223]
v_accvgpr_read_b32 v20, a88
v_accvgpr_read_b32 v28, a89
v_mfma_f32_16x16x32_bf16 v[216:219], v[76:79], v[116:119], v[216:219]
s_waitcnt vmcnt(20) lgkmcnt(2)
ds_read_b128 v[52:55], v19 offset:36864
v_accvgpr_read_b32 v21, a90
v_mfma_f32_16x16x32_bf16 v[216:219], v[72:75], v[112:115], v[216:219]
s_barrier
ds_read_b128 v[56:59], v18 offset:38912
v_accvgpr_read_b32 v29, a91
v_mfma_f32_16x16x32_bf16 v[212:215], v[72:75], v[104:107], v[212:215]
ds_read_b64_tr_b16 v[64:65], v8 offset:32768
ds_read_b64_tr_b16 v[66:67], v8 offset:33792
v_mfma_f32_16x16x32_bf16 v[212:215], v[76:79], v[108:111], v[212:215]
ds_read_b64_tr_b16 v[68:69], v8 offset:40960
v_accvgpr_read_b32 v22, a120
v_mfma_f32_16x16x32_bf16 v[208:211], v[76:79], v[100:103], v[208:211]
s_add_u32 s72, s69, 144384
buffer_load_dwordx4 v5, s[4:7], s72 offen offset:3072 lds
v_mfma_f32_16x16x32_bf16 v[208:211], v[72:75], v[96:99], v[208:211]
ds_read_b64_tr_b16 v[70:71], v8 offset:41984
v_accvgpr_read_b32 v30, a121
v_mfma_f32_16x16x32_bf16 v[224:227], v[80:83], v[96:99], v[224:227]
ds_read_b64_tr_b16 v[72:73], v9 offset:32768
v_accvgpr_read_b32 v23, a122
v_mfma_f32_16x16x32_bf16 v[224:227], v[84:87], v[100:103], v[224:227]
ds_read_b64_tr_b16 v[74:75], v9 offset:33792
v_accvgpr_read_b32 v31, a123
v_mfma_f32_16x16x32_bf16 v[228:231], v[84:87], v[108:111], v[228:231]
s_add_u32 m0, s63, 69632
v_mul_f32 v20, s79, v20
v_mul_f32 v28, s79, v28
v_mfma_f32_16x16x32_bf16 v[228:231], v[80:83], v[104:107], v[228:231]
s_add_u32 s72, s70, 0
buffer_load_dwordx4 v4, s[4:7], s72 offen lds
v_mfma_f32_16x16x32_bf16 v[232:235], v[80:83], v[112:115], v[232:235]
ds_read_b64_tr_b16 v[76:77], v9 offset:40960
v_mul_f32 v21, s79, v21
v_mfma_f32_16x16x32_bf16 v[232:235], v[84:87], v[116:119], v[232:235]
ds_read_b128 v[60:63], v19 offset:38912
v_mul_f32 v29, s79, v29
v_mfma_f32_16x16x32_bf16 v[236:239], v[84:87], v[124:127], v[236:239]
ds_read_b64_tr_b16 v[78:79], v9 offset:41984
v_mul_f32 v22, s79, v22
v_mfma_f32_16x16x32_bf16 v[236:239], v[80:83], v[120:123], v[236:239]
v_mul_f32 v30, s79, v30
v_mul_f32 v23, s79, v23
v_mfma_f32_16x16x32_bf16 v[252:255], v[88:91], v[120:123], v[252:255]
s_add_u32 s72, s70, 15360
buffer_load_dwordx4 v5, s[4:7], s72 offen offset:1024 lds
v_mfma_f32_16x16x32_bf16 v[252:255], v[92:95], v[124:127], v[252:255]
ds_read_b64_tr_b16 v[80:81], v10 offset:32768
v_mul_f32 v31, s79, v31
v_mfma_f32_16x16x32_bf16 v[248:251], v[92:95], v[116:119], v[248:251]
ds_read_b64_tr_b16 v[82:83], v10 offset:33792
v_cvt_pk_bf16_f32 v20, v20, v28
v_mfma_f32_16x16x32_bf16 v[248:251], v[88:91], v[112:115], v[248:251]
v_cvt_pk_bf16_f32 v21, v21, v29
v_cvt_pk_bf16_f32 v22, v22, v30
v_mfma_f32_16x16x32_bf16 v[244:247], v[88:91], v[104:107], v[244:247]
ds_read_b64_tr_b16 v[84:85], v10 offset:40960
v_cvt_pk_bf16_f32 v23, v23, v31
v_mfma_f32_16x16x32_bf16 v[244:247], v[92:95], v[108:111], v[244:247]
s_add_u32 s80, s77, 41984
ds_read_b64_tr_b16 v[86:87], v10 offset:41984
v_mfma_f32_16x16x32_bf16 v[240:243], v[92:95], v[100:103], v[240:243]
s_add_u32 s72, s70, 129024
buffer_load_dwordx4 v4, s[4:7], s72 offen offset:2048 lds
v_mfma_f32_16x16x32_bf16 v[240:243], v[88:91], v[96:99], v[240:243]
s_waitcnt lgkmcnt(5)
buffer_store_dwordx4 v[20:23], v1, s[44:47], s80 offen sc1
LcB1:
v_mfma_f32_16x16x32_bf16 v[128:131], v[64:67], v[32:35], v[128:131]
ds_read_b64_tr_b16 v[88:89], v11 offset:32768
v_accvgpr_read_b32 v24, a224
v_mfma_f32_16x16x32_bf16 v[128:131], v[68:71], v[36:39], v[128:131]
ds_read_b64_tr_b16 v[90:91], v11 offset:33792
v_accvgpr_read_b32 v28, a225
v_mfma_f32_16x16x32_bf16 v[132:135], v[68:71], v[44:47], v[132:135]
v_accvgpr_read_b32 v25, a226
v_accvgpr_read_b32 v29, a227
v_mfma_f32_16x16x32_bf16 v[132:135], v[64:67], v[40:43], v[132:135]
s_add_u32 s72, s70, 144384
buffer_load_dwordx4 v5, s[4:7], s72 offen offset:3072 lds
v_mfma_f32_16x16x32_bf16 v[136:139], v[64:67], v[48:51], v[136:139]
ds_read_b64_tr_b16 v[92:93], v11 offset:40960
v_accvgpr_read_b32 v26, a228
v_mfma_f32_16x16x32_bf16 v[136:139], v[68:71], v[52:55], v[136:139]
s_lshl_b32 s71, s73, 12
v_accvgpr_read_b32 v30, a229
v_accvgpr_read_b32 v27, a230
v_mfma_f32_16x16x32_bf16 v[140:143], v[68:71], v[60:63], v[140:143]
s_add_u32 s71, s71, s66
ds_read_b64_tr_b16 v[94:95], v11 offset:41984
v_accvgpr_read_b32 v31, a231
v_mfma_f32_16x16x32_bf16 v[140:143], v[64:67], v[56:59], v[140:143]
s_waitcnt lgkmcnt(8)
v_cvt_pk_bf16_f32 v24, v24, v28
v_cvt_pk_bf16_f32 v25, v25, v29
v_mfma_f32_16x16x32_bf16 v[156:159], v[72:75], v[56:59], v[156:159]
s_add_u32 m0, s64, 16384
ds_read_b64_tr_b16 v[64:65], v12 offset:32768
v_cvt_pk_bf16_f32 v26, v26, v30
v_mfma_f32_16x16x32_bf16 v[156:159], v[76:79], v[60:63], v[156:159]
s_add_u32 s72, s71, 0
buffer_load_dwordx4 v6, s[12:15], s72 offen lds
v_mfma_f32_16x16x32_bf16 v[152:155], v[76:79], v[52:55], v[152:155]
s_add_u32 s73, s62, 11
ds_read_b64_tr_b16 v[66:67], v12 offset:33792
v_cvt_pk_bf16_f32 v27, v27, v31
v_mfma_f32_16x16x32_bf16 v[152:155], v[72:75], v[48:51], v[152:155]
s_add_u32 s70, s73, s65
v_mfma_f32_16x16x32_bf16 v[148:151], v[72:75], v[40:43], v[148:151]
s_and_b32 s70, s70, 3
ds_read_b64_tr_b16 v[68:69], v12 offset:40960
v_mfma_f32_16x16x32_bf16 v[148:151], v[76:79], v[44:47], v[148:151]
s_and_b32 s73, s73, 12
ds_read_b64_tr_b16 v[70:71], v12 offset:41984
v_mfma_f32_16x16x32_bf16 v[144:147], v[76:79], v[36:39], v[144:147]
s_add_u32 s72, s71, 31744
buffer_load_dwordx4 v6, s[12:15], s72 offen offset:1024 lds
v_mfma_f32_16x16x32_bf16 v[144:147], v[72:75], v[32:35], v[144:147]
s_waitcnt lgkmcnt(8)
v_mfma_f32_16x16x32_bf16 v[160:163], v[80:83], v[32:35], v[160:163]
s_or_b32 s73, s73, s70
ds_read_b64_tr_b16 v[72:73], v13 offset:32768
v_mfma_f32_16x16x32_bf16 v[160:163], v[84:87], v[36:39], v[160:163]
s_lshl_b32 s73, s73, 7
ds_read_b64_tr_b16 v[74:75], v13 offset:33792
v_mfma_f32_16x16x32_bf16 v[164:167], v[84:87], v[44:47], v[164:167]
s_add_u32 s69, s73, s67
v_mfma_f32_16x16x32_bf16 v[164:167], v[80:83], v[40:43], v[164:167]
s_add_u32 s72, s71, 63488
buffer_load_dwordx4 v7, s[12:15], s72 offen offset:2048 lds
v_mfma_f32_16x16x32_bf16 v[168:171], v[80:83], v[48:51], v[168:171]
s_waitcnt vmcnt(18)
ds_read_b64_tr_b16 v[76:77], v13 offset:40960
v_mfma_f32_16x16x32_bf16 v[168:171], v[84:87], v[52:55], v[168:171]
s_add_u32 s70, s73, s68
ds_read_b128 v[96:99], v16 offset:0
v_accvgpr_read_b32 v20, a92
v_mfma_f32_16x16x32_bf16 v[172:175], v[84:87], v[60:63], v[172:175]
s_add_u32 s80, s78, 3072
ds_read_b64_tr_b16 v[78:79], v13 offset:41984
v_accvgpr_read_b32 v28, a93
v_mfma_f32_16x16x32_bf16 v[172:175], v[80:83], v[56:59], v[172:175]
s_waitcnt lgkmcnt(9)
ds_read_b128 v[100:103], v17 offset:0
v_accvgpr_read_b32 v21, a94
v_mfma_f32_16x16x32_bf16 v[188:191], v[88:91], v[56:59], v[188:191]
s_add_u32 s72, s71, 95232
buffer_load_dwordx4 v7, s[12:15], s72 offen offset:3072 lds
v_mfma_f32_16x16x32_bf16 v[188:191], v[92:95], v[60:63], v[188:191]
ds_read_b64_tr_b16 v[80:81], v14 offset:32768
v_accvgpr_read_b32 v29, a95
v_mfma_f32_16x16x32_bf16 v[184:187], v[92:95], v[52:55], v[184:187]
ds_read_b64_tr_b16 v[82:83], v14 offset:33792
v_accvgpr_read_b32 v22, a124
v_mfma_f32_16x16x32_bf16 v[184:187], v[88:91], v[48:51], v[184:187]
buffer_store_dwordx4 v[24:27], v1, s[44:47], s80 offen sc1
v_mfma_f32_16x16x32_bf16 v[180:183], v[88:91], v[40:43], v[180:183]
ds_read_b64_tr_b16 v[84:85], v14 offset:40960
v_accvgpr_read_b32 v30, a125
v_mfma_f32_16x16x32_bf16 v[180:183], v[92:95], v[44:47], v[180:183]
s_add_u32 m0, s63, 98304
ds_read_b64_tr_b16 v[86:87], v14 offset:41984
v_accvgpr_read_b32 v23, a126
v_mfma_f32_16x16x32_bf16 v[176:179], v[92:95], v[36:39], v[176:179]
s_add_u32 s72, s69, 0
buffer_load_dwordx4 v4, s[4:7], s72 offen lds
v_mfma_f32_16x16x32_bf16 v[176:179], v[88:91], v[32:35], v[176:179]
s_waitcnt lgkmcnt(10)
ds_read_b128 v[104:107], v16 offset:2048
v_accvgpr_read_b32 v31, a127
v_mfma_f32_16x16x32_bf16 v[192:195], v[64:67], v[32:35], v[192:195]
ds_read_b64_tr_b16 v[88:89], v15 offset:32768
v_mul_f32 v20, s79, v20
v_mfma_f32_16x16x32_bf16 v[192:195], v[68:71], v[36:39], v[192:195]
ds_read_b64_tr_b16 v[90:91], v15 offset:33792
v_mul_f32 v28, s79, v28
v_mfma_f32_16x16x32_bf16 v[196:199], v[68:71], v[44:47], v[196:199]
ds_read_b64_tr_b16 v[92:93], v15 offset:40960
v_mul_f32 v21, s79, v21
v_mfma_f32_16x16x32_bf16 v[196:199], v[64:67], v[40:43], v[196:199]
s_add_u32 s72, s69, 15360
buffer_load_dwordx4 v5, s[4:7], s72 offen offset:1024 lds
v_mfma_f32_16x16x32_bf16 v[200:203], v[64:67], v[48:51], v[200:203]
ds_read_b64_tr_b16 v[94:95], v15 offset:41984
v_mul_f32 v29, s79, v29
v_mfma_f32_16x16x32_bf16 v[200:203], v[68:71], v[52:55], v[200:203]
ds_read_b128 v[108:111], v17 offset:2048
v_mul_f32 v22, s79, v22
v_mfma_f32_16x16x32_bf16 v[204:207], v[68:71], v[60:63], v[204:207]
v_mul_f32 v30, s79, v30
v_mul_f32 v23, s79, v23
v_mfma_f32_16x16x32_bf16 v[204:207], v[64:67], v[56:59], v[204:207]
s_waitcnt lgkmcnt(11)
ds_read_b128 v[112:115], v16 offset:4096
v_mul_f32 v31, s79, v31
v_mfma_f32_16x16x32_bf16 v[220:223], v[72:75], v[56:59], v[220:223]
s_add_u32 s72, s69, 129024
buffer_load_dwordx4 v4, s[4:7], s72 offen offset:2048 lds
v_mfma_f32_16x16x32_bf16 v[220:223], v[76:79], v[60:63], v[220:223]
v_cvt_pk_bf16_f32 v20, v20, v28
v_cvt_pk_bf16_f32 v21, v21, v29
v_mfma_f32_16x16x32_bf16 v[216:219], v[76:79], v[52:55], v[216:219]
s_waitcnt vmcnt(19) lgkmcnt(2)
ds_read_b128 v[116:119], v17 offset:4096
v_cvt_pk_bf16_f32 v22, v22, v30
v_mfma_f32_16x16x32_bf16 v[216:219], v[72:75], v[48:51], v[216:219]
s_barrier
ds_read_b128 v[120:123], v16 offset:6144
v_cvt_pk_bf16_f32 v23, v23, v31
v_mfma_f32_16x16x32_bf16 v[212:215], v[72:75], v[40:43], v[212:215]
s_add_u32 s80, s77, 46080
ds_read_b64_tr_b16 v[64:65], v8 offset:0
ds_read_b64_tr_b16 v[66:67], v8 offset:1024
v_mfma_f32_16x16x32_bf16 v[212:215], v[76:79], v[44:47], v[212:215]
ds_read_b64_tr_b16 v[68:69], v8 offset:8192
v_accvgpr_read_b32 v24, a232
v_mfma_f32_16x16x32_bf16 v[208:211], v[76:79], v[36:39], v[208:211]
s_add_u32 s72, s69, 144384
buffer_load_dwordx4 v5, s[4:7], s72 offen offset:3072 lds
v_mfma_f32_16x16x32_bf16 v[208:211], v[72:75], v[32:35], v[208:211]
ds_read_b64_tr_b16 v[70:71], v8 offset:9216
v_accvgpr_read_b32 v28, a233
v_mfma_f32_16x16x32_bf16 v[224:227], v[80:83], v[32:35], v[224:227]
ds_read_b64_tr_b16 v[72:73], v9 offset:0
v_accvgpr_read_b32 v25, a234
v_mfma_f32_16x16x32_bf16 v[224:227], v[84:87], v[36:39], v[224:227]
ds_read_b64_tr_b16 v[74:75], v9 offset:1024
v_accvgpr_read_b32 v29, a235
v_mfma_f32_16x16x32_bf16 v[228:231], v[84:87], v[44:47], v[228:231]
s_add_u32 m0, s63, 102400
buffer_store_dwordx4 v[20:23], v1, s[44:47], s80 offen sc1
v_mfma_f32_16x16x32_bf16 v[228:231], v[80:83], v[40:43], v[228:231]
s_add_u32 s72, s70, 0
buffer_load_dwordx4 v4, s[4:7], s72 offen lds
v_mfma_f32_16x16x32_bf16 v[232:235], v[80:83], v[48:51], v[232:235]
ds_read_b64_tr_b16 v[76:77], v9 offset:8192
v_accvgpr_read_b32 v26, a236
v_mfma_f32_16x16x32_bf16 v[232:235], v[84:87], v[52:55], v[232:235]
ds_read_b128 v[124:127], v17 offset:6144
v_accvgpr_read_b32 v30, a237
v_mfma_f32_16x16x32_bf16 v[236:239], v[84:87], v[60:63], v[236:239]
ds_read_b64_tr_b16 v[78:79], v9 offset:9216
v_accvgpr_read_b32 v27, a238
v_mfma_f32_16x16x32_bf16 v[236:239], v[80:83], v[56:59], v[236:239]
v_accvgpr_read_b32 v31, a239
v_cvt_pk_bf16_f32 v24, v24, v28
v_mfma_f32_16x16x32_bf16 v[252:255], v[88:91], v[56:59], v[252:255]
s_add_u32 s72, s70, 15360
buffer_load_dwordx4 v5, s[4:7], s72 offen offset:1024 lds
v_mfma_f32_16x16x32_bf16 v[252:255], v[92:95], v[60:63], v[252:255]
ds_read_b64_tr_b16 v[80:81], v10 offset:0
v_cvt_pk_bf16_f32 v25, v25, v29
v_mfma_f32_16x16x32_bf16 v[248:251], v[92:95], v[52:55], v[248:251]
ds_read_b64_tr_b16 v[82:83], v10 offset:1024
v_cvt_pk_bf16_f32 v26, v26, v30
v_mfma_f32_16x16x32_bf16 v[248:251], v[88:91], v[48:51], v[248:251]
v_cvt_pk_bf16_f32 v27, v27, v31
v_mfma_f32_16x16x32_bf16 v[244:247], v[88:91], v[40:43], v[244:247]
s_add_u32 s80, s78, 11264
ds_read_b64_tr_b16 v[84:85], v10 offset:8192
v_mfma_f32_16x16x32_bf16 v[244:247], v[92:95], v[44:47], v[244:247]
ds_read_b64_tr_b16 v[86:87], v10 offset:9216
v_mfma_f32_16x16x32_bf16 v[240:243], v[92:95], v[36:39], v[240:243]
s_add_u32 s72, s70, 129024
buffer_load_dwordx4 v4, s[4:7], s72 offen offset:2048 lds
v_mfma_f32_16x16x32_bf16 v[240:243], v[88:91], v[32:35], v[240:243]
s_waitcnt lgkmcnt(5)
buffer_store_dwordx4 v[24:27], v1, s[44:47], s80 offen sc1
v_mfma_f32_16x16x32_bf16 v[128:131], v[64:67], v[96:99], v[128:131]
ds_read_b64_tr_b16 v[88:89], v11 offset:0
v_mfma_f32_16x16x32_bf16 v[128:131], v[68:71], v[100:103], v[128:131]
ds_read_b64_tr_b16 v[90:91], v11 offset:1024
v_accvgpr_read_b32 v20, a240
v_mfma_f32_16x16x32_bf16 v[132:135], v[68:71], v[108:111], v[132:135]
v_accvgpr_read_b32 v28, a241
v_accvgpr_read_b32 v21, a242
v_mfma_f32_16x16x32_bf16 v[132:135], v[64:67], v[104:107], v[132:135]
s_add_u32 s72, s70, 144384
buffer_load_dwordx4 v5, s[4:7], s72 offen offset:3072 lds
v_mfma_f32_16x16x32_bf16 v[136:139], v[64:67], v[112:115], v[136:139]
ds_read_b64_tr_b16 v[92:93], v11 offset:8192
v_accvgpr_read_b32 v29, a243
v_mfma_f32_16x16x32_bf16 v[136:139], v[68:71], v[116:119], v[136:139]
s_lshl_b32 s71, s73, 12
v_accvgpr_read_b32 v22, a244
v_accvgpr_read_b32 v30, a245
v_mfma_f32_16x16x32_bf16 v[140:143], v[68:71], v[124:127], v[140:143]
s_add_u32 s71, s71, s66
ds_read_b64_tr_b16 v[94:95], v11 offset:9216
v_accvgpr_read_b32 v23, a246
v_mfma_f32_16x16x32_bf16 v[140:143], v[64:67], v[120:123], v[140:143]
s_waitcnt lgkmcnt(8)
v_accvgpr_read_b32 v31, a247
v_cvt_pk_bf16_f32 v20, v20, v28
v_mfma_f32_16x16x32_bf16 v[156:159], v[72:75], v[120:123], v[156:159]
s_add_u32 m0, s64, 32768
ds_read_b64_tr_b16 v[64:65], v12 offset:0
v_cvt_pk_bf16_f32 v21, v21, v29
v_mfma_f32_16x16x32_bf16 v[156:159], v[76:79], v[124:127], v[156:159]
s_add_u32 s72, s71, 0
buffer_load_dwordx4 v6, s[12:15], s72 offen lds
v_mfma_f32_16x16x32_bf16 v[152:155], v[76:79], v[116:119], v[152:155]
s_add_u32 s73, s62, 12
ds_read_b64_tr_b16 v[66:67], v12 offset:1024
v_cvt_pk_bf16_f32 v22, v22, v30
v_mfma_f32_16x16x32_bf16 v[152:155], v[72:75], v[112:115], v[152:155]
s_add_u32 s70, s73, s65
v_cvt_pk_bf16_f32 v23, v23, v31
v_mfma_f32_16x16x32_bf16 v[148:151], v[72:75], v[104:107], v[148:151]
s_and_b32 s70, s70, 3
ds_read_b64_tr_b16 v[68:69], v12 offset:8192
v_mfma_f32_16x16x32_bf16 v[148:151], v[76:79], v[108:111], v[148:151]
s_and_b32 s73, s73, 12
ds_read_b64_tr_b16 v[70:71], v12 offset:9216
v_mfma_f32_16x16x32_bf16 v[144:147], v[76:79], v[100:103], v[144:147]
s_add_u32 s72, s71, 31744
buffer_load_dwordx4 v6, s[12:15], s72 offen offset:1024 lds
v_mfma_f32_16x16x32_bf16 v[144:147], v[72:75], v[96:99], v[144:147]
s_waitcnt lgkmcnt(8)
v_mfma_f32_16x16x32_bf16 v[160:163], v[80:83], v[96:99], v[160:163]
s_or_b32 s73, s73, s70
ds_read_b64_tr_b16 v[72:73], v13 offset:0
v_mfma_f32_16x16x32_bf16 v[160:163], v[84:87], v[100:103], v[160:163]
s_lshl_b32 s73, s73, 7
ds_read_b64_tr_b16 v[74:75], v13 offset:1024
v_mfma_f32_16x16x32_bf16 v[164:167], v[84:87], v[108:111], v[164:167]
s_add_u32 s69, s73, s67
v_mfma_f32_16x16x32_bf16 v[164:167], v[80:83], v[104:107], v[164:167]
s_add_u32 s72, s71, 63488
buffer_load_dwordx4 v7, s[12:15], s72 offen offset:2048 lds
v_mfma_f32_16x16x32_bf16 v[168:171], v[80:83], v[112:115], v[168:171]
s_waitcnt vmcnt(18)
ds_read_b64_tr_b16 v[76:77], v13 offset:8192
v_mfma_f32_16x16x32_bf16 v[168:171], v[84:87], v[116:119], v[168:171]
s_add_u32 s70, s73, s68
ds_read_b128 v[32:35], v18 offset:0
v_mfma_f32_16x16x32_bf16 v[172:175], v[84:87], v[124:127], v[172:175]
s_add_u32 s80, s78, 35840
ds_read_b64_tr_b16 v[78:79], v13 offset:9216
v_mfma_f32_16x16x32_bf16 v[172:175], v[80:83], v[120:123], v[172:175]
s_waitcnt lgkmcnt(9)
ds_read_b128 v[36:39], v19 offset:0
v_accvgpr_read_b32 v24, a248
v_mfma_f32_16x16x32_bf16 v[188:191], v[88:91], v[120:123], v[188:191]
s_add_u32 s72, s71, 95232
buffer_load_dwordx4 v7, s[12:15], s72 offen offset:3072 lds
v_mfma_f32_16x16x32_bf16 v[188:191], v[92:95], v[124:127], v[188:191]
ds_read_b64_tr_b16 v[80:81], v14 offset:0
v_accvgpr_read_b32 v28, a249
v_mfma_f32_16x16x32_bf16 v[184:187], v[92:95], v[116:119], v[184:187]
ds_read_b64_tr_b16 v[82:83], v14 offset:1024
v_accvgpr_read_b32 v25, a250
v_mfma_f32_16x16x32_bf16 v[184:187], v[88:91], v[112:115], v[184:187]
buffer_store_dwordx4 v[20:23], v1, s[44:47], s80 offen sc1
v_mfma_f32_16x16x32_bf16 v[180:183], v[88:91], v[104:107], v[180:183]
ds_read_b64_tr_b16 v[84:85], v14 offset:8192
v_accvgpr_read_b32 v29, a251
v_mfma_f32_16x16x32_bf16 v[180:183], v[92:95], v[108:111], v[180:183]
s_add_u32 m0, s63, 131072
ds_read_b64_tr_b16 v[86:87], v14 offset:9216
v_accvgpr_read_b32 v26, a252
v_mfma_f32_16x16x32_bf16 v[176:179], v[92:95], v[100:103], v[176:179]
s_add_u32 s72, s69, 0
buffer_load_dwordx4 v4, s[4:7], s72 offen lds
v_mfma_f32_16x16x32_bf16 v[176:179], v[88:91], v[96:99], v[176:179]
s_waitcnt lgkmcnt(10)
ds_read_b128 v[40:43], v18 offset:2048
v_accvgpr_read_b32 v30, a253
v_mfma_f32_16x16x32_bf16 v[192:195], v[64:67], v[96:99], v[192:195]
ds_read_b64_tr_b16 v[88:89], v15 offset:0
v_accvgpr_read_b32 v27, a254
v_mfma_f32_16x16x32_bf16 v[192:195], v[68:71], v[100:103], v[192:195]
ds_read_b64_tr_b16 v[90:91], v15 offset:1024
v_accvgpr_read_b32 v31, a255
v_mfma_f32_16x16x32_bf16 v[196:199], v[68:71], v[108:111], v[196:199]
ds_read_b64_tr_b16 v[92:93], v15 offset:8192
v_cvt_pk_bf16_f32 v24, v24, v28
v_mfma_f32_16x16x32_bf16 v[196:199], v[64:67], v[104:107], v[196:199]
s_add_u32 s72, s69, 15360
buffer_load_dwordx4 v5, s[4:7], s72 offen offset:1024 lds
v_mfma_f32_16x16x32_bf16 v[200:203], v[64:67], v[112:115], v[200:203]
ds_read_b64_tr_b16 v[94:95], v15 offset:9216
v_cvt_pk_bf16_f32 v25, v25, v29
v_mfma_f32_16x16x32_bf16 v[200:203], v[68:71], v[116:119], v[200:203]
ds_read_b128 v[44:47], v19 offset:2048
v_cvt_pk_bf16_f32 v26, v26, v30
v_mfma_f32_16x16x32_bf16 v[204:207], v[68:71], v[124:127], v[204:207]
v_cvt_pk_bf16_f32 v27, v27, v31
v_mfma_f32_16x16x32_bf16 v[204:207], v[64:67], v[120:123], v[204:207]
s_waitcnt lgkmcnt(11)
ds_read_b128 v[48:51], v18 offset:4096
v_mfma_f32_16x16x32_bf16 v[220:223], v[72:75], v[120:123], v[220:223]
s_add_u32 s72, s69, 129024
buffer_load_dwordx4 v4, s[4:7], s72 offen offset:2048 lds
v_mfma_f32_16x16x32_bf16 v[220:223], v[76:79], v[124:127], v[220:223]
s_add_u32 s80, s78, 44032
ds_read_b128 v[52:55], v19 offset:4096
v_mfma_f32_16x16x32_bf16 v[216:219], v[76:79], v[116:119], v[216:219]
s_waitcnt vmcnt(19) lgkmcnt(3)
buffer_store_dwordx4 v[24:27], v1, s[44:47], s80 offen sc1
v_mfma_f32_16x16x32_bf16 v[216:219], v[72:75], v[112:115], v[216:219]
s_barrier
ds_read_b128 v[56:59], v18 offset:6144
v_mfma_f32_16x16x32_bf16 v[212:215], v[72:75], v[104:107], v[212:215]
ds_read_b64_tr_b16 v[64:65], v8 offset:16384
ds_read_b64_tr_b16 v[66:67], v8 offset:17408
v_mfma_f32_16x16x32_bf16 v[212:215], v[76:79], v[108:111], v[212:215]
ds_read_b64_tr_b16 v[68:69], v8 offset:24576
ds_read_b64_tr_b16 v[70:71], v8 offset:25600
v_mfma_f32_16x16x32_bf16 v[208:211], v[76:79], v[100:103], v[208:211]
s_add_u32 s72, s69, 144384
buffer_load_dwordx4 v5, s[4:7], s72 offen offset:3072 lds
v_mfma_f32_16x16x32_bf16 v[208:211], v[72:75], v[96:99], v[208:211]
v_and_b32 v2, 31, v0
v_lshlrev_b32 v2, 2, v2
v_mfma_f32_16x16x32_bf16 v[224:227], v[80:83], v[96:99], v[224:227]
buffer_load_dword v3, v2, s[48:51], 0 offen sc1
v_mfma_f32_16x16x32_bf16 v[224:227], v[84:87], v[100:103], v[224:227]
ds_read_b64_tr_b16 v[72:73], v9 offset:16384
v_mfma_f32_16x16x32_bf16 v[228:231], v[84:87], v[108:111], v[228:231]
s_add_u32 m0, s63, 135168
ds_read_b64_tr_b16 v[74:75], v9 offset:17408
v_mfma_f32_16x16x32_bf16 v[228:231], v[80:83], v[104:107], v[228:231]
s_add_u32 s72, s70, 0
buffer_load_dwordx4 v4, s[4:7], s72 offen lds
v_mfma_f32_16x16x32_bf16 v[232:235], v[80:83], v[112:115], v[232:235]
ds_read_b128 v[60:63], v19 offset:6144
v_mfma_f32_16x16x32_bf16 v[232:235], v[84:87], v[116:119], v[232:235]
ds_read_b64_tr_b16 v[76:77], v9 offset:24576
v_mfma_f32_16x16x32_bf16 v[236:239], v[84:87], v[124:127], v[236:239]
ds_read_b64_tr_b16 v[78:79], v9 offset:25600
v_mfma_f32_16x16x32_bf16 v[236:239], v[80:83], v[120:123], v[236:239]
v_mfma_f32_16x16x32_bf16 v[252:255], v[88:91], v[120:123], v[252:255]
s_add_u32 s72, s70, 15360
buffer_load_dwordx4 v5, s[4:7], s72 offen offset:1024 lds
v_mfma_f32_16x16x32_bf16 v[252:255], v[92:95], v[124:127], v[252:255]
ds_read_b64_tr_b16 v[80:81], v10 offset:16384
v_mfma_f32_16x16x32_bf16 v[248:251], v[92:95], v[116:119], v[248:251]
ds_read_b64_tr_b16 v[82:83], v10 offset:17408
v_mfma_f32_16x16x32_bf16 v[248:251], v[88:91], v[112:115], v[248:251]
v_mfma_f32_16x16x32_bf16 v[244:247], v[88:91], v[104:107], v[244:247]
ds_read_b64_tr_b16 v[84:85], v10 offset:24576
v_mfma_f32_16x16x32_bf16 v[244:247], v[92:95], v[108:111], v[244:247]
ds_read_b64_tr_b16 v[86:87], v10 offset:25600
v_mfma_f32_16x16x32_bf16 v[240:243], v[92:95], v[100:103], v[240:243]
s_add_u32 s72, s70, 129024
buffer_load_dwordx4 v4, s[4:7], s72 offen offset:2048 lds
v_mfma_f32_16x16x32_bf16 v[240:243], v[88:91], v[96:99], v[240:243]
s_waitcnt lgkmcnt(6)
v_mfma_f32_16x16x32_bf16 v[128:131], v[64:67], v[32:35], v[128:131]
ds_read_b64_tr_b16 v[88:89], v11 offset:16384
v_mfma_f32_16x16x32_bf16 v[128:131], v[68:71], v[36:39], v[128:131]
ds_read_b64_tr_b16 v[90:91], v11 offset:17408
v_mfma_f32_16x16x32_bf16 v[132:135], v[68:71], v[44:47], v[132:135]
v_mfma_f32_16x16x32_bf16 v[132:135], v[64:67], v[40:43], v[132:135]
s_add_u32 s72, s70, 144384
buffer_load_dwordx4 v5, s[4:7], s72 offen offset:3072 lds
v_mfma_f32_16x16x32_bf16 v[136:139], v[64:67], v[48:51], v[136:139]
ds_read_b64_tr_b16 v[92:93], v11 offset:24576
v_mfma_f32_16x16x32_bf16 v[136:139], v[68:71], v[52:55], v[136:139]
s_lshl_b32 s71, s73, 12
v_mfma_f32_16x16x32_bf16 v[140:143], v[68:71], v[60:63], v[140:143]
s_add_u32 s71, s71, s66
ds_read_b64_tr_b16 v[94:95], v11 offset:25600
v_mfma_f32_16x16x32_bf16 v[140:143], v[64:67], v[56:59], v[140:143]
s_waitcnt lgkmcnt(8)
v_mfma_f32_16x16x32_bf16 v[156:159], v[72:75], v[56:59], v[156:159]
s_add_u32 m0, s64, 0
ds_read_b64_tr_b16 v[64:65], v12 offset:16384
v_mfma_f32_16x16x32_bf16 v[156:159], v[76:79], v[60:63], v[156:159]
s_add_u32 s72, s71, 0
buffer_load_dwordx4 v6, s[12:15], s72 offen lds
v_mfma_f32_16x16x32_bf16 v[152:155], v[76:79], v[52:55], v[152:155]
s_add_u32 s73, s62, 13
ds_read_b64_tr_b16 v[66:67], v12 offset:17408
v_mfma_f32_16x16x32_bf16 v[152:155], v[72:75], v[48:51], v[152:155]
s_add_u32 s70, s73, s65
v_mfma_f32_16x16x32_bf16 v[148:151], v[72:75], v[40:43], v[148:151]
s_and_b32 s70, s70, 3
ds_read_b64_tr_b16 v[68:69], v12 offset:24576
v_mfma_f32_16x16x32_bf16 v[148:151], v[76:79], v[44:47], v[148:151]
s_and_b32 s73, s73, 12
ds_read_b64_tr_b16 v[70:71], v12 offset:25600
v_mfma_f32_16x16x32_bf16 v[144:147], v[76:79], v[36:39], v[144:147]
s_add_u32 s72, s71, 31744
buffer_load_dwordx4 v6, s[12:15], s72 offen offset:1024 lds
v_mfma_f32_16x16x32_bf16 v[144:147], v[72:75], v[32:35], v[144:147]
s_waitcnt lgkmcnt(8)
v_mfma_f32_16x16x32_bf16 v[160:163], v[80:83], v[32:35], v[160:163]
s_or_b32 s73, s73, s70
ds_read_b64_tr_b16 v[72:73], v13 offset:16384
v_mfma_f32_16x16x32_bf16 v[160:163], v[84:87], v[36:39], v[160:163]
s_lshl_b32 s73, s73, 7
ds_read_b64_tr_b16 v[74:75], v13 offset:17408
v_mfma_f32_16x16x32_bf16 v[164:167], v[84:87], v[44:47], v[164:167]
s_add_u32 s69, s73, s67
v_mfma_f32_16x16x32_bf16 v[164:167], v[80:83], v[40:43], v[164:167]
s_add_u32 s72, s71, 63488
buffer_load_dwordx4 v7, s[12:15], s72 offen offset:2048 lds
v_mfma_f32_16x16x32_bf16 v[168:171], v[80:83], v[48:51], v[168:171]
s_waitcnt vmcnt(18)
ds_read_b64_tr_b16 v[76:77], v13 offset:24576
v_mfma_f32_16x16x32_bf16 v[168:171], v[84:87], v[52:55], v[168:171]
s_add_u32 s70, s73, s68
ds_read_b128 v[96:99], v18 offset:32768
v_mfma_f32_16x16x32_bf16 v[172:175], v[84:87], v[60:63], v[172:175]
ds_read_b64_tr_b16 v[78:79], v13 offset:25600
v_mfma_f32_16x16x32_bf16 v[172:175], v[80:83], v[56:59], v[172:175]
s_waitcnt lgkmcnt(9)
ds_read_b128 v[100:103], v19 offset:32768
v_mfma_f32_16x16x32_bf16 v[188:191], v[88:91], v[56:59], v[188:191]
s_add_u32 s72, s71, 95232
buffer_load_dwordx4 v7, s[12:15], s72 offen offset:3072 lds
v_mfma_f32_16x16x32_bf16 v[188:191], v[92:95], v[60:63], v[188:191]
ds_read_b64_tr_b16 v[80:81], v14 offset:16384
v_mfma_f32_16x16x32_bf16 v[184:187], v[92:95], v[52:55], v[184:187]
ds_read_b64_tr_b16 v[82:83], v14 offset:17408
v_mfma_f32_16x16x32_bf16 v[184:187], v[88:91], v[48:51], v[184:187]
v_mfma_f32_16x16x32_bf16 v[180:183], v[88:91], v[40:43], v[180:183]
ds_read_b64_tr_b16 v[84:85], v14 offset:24576
v_mfma_f32_16x16x32_bf16 v[180:183], v[92:95], v[44:47], v[180:183]
s_add_u32 m0, s63, 65536
ds_read_b64_tr_b16 v[86:87], v14 offset:25600
v_mfma_f32_16x16x32_bf16 v[176:179], v[92:95], v[36:39], v[176:179]
s_add_u32 s72, s69, 0
buffer_load_dwordx4 v4, s[4:7], s72 offen lds
v_mfma_f32_16x16x32_bf16 v[176:179], v[88:91], v[32:35], v[176:179]
s_waitcnt lgkmcnt(10)
ds_read_b128 v[104:107], v18 offset:34816
v_mfma_f32_16x16x32_bf16 v[192:195], v[64:67], v[32:35], v[192:195]
ds_read_b64_tr_b16 v[88:89], v15 offset:16384
v_mfma_f32_16x16x32_bf16 v[192:195], v[68:71], v[36:39], v[192:195]
ds_read_b64_tr_b16 v[90:91], v15 offset:17408
v_mfma_f32_16x16x32_bf16 v[196:199], v[68:71], v[44:47], v[196:199]
ds_read_b64_tr_b16 v[92:93], v15 offset:24576
v_mfma_f32_16x16x32_bf16 v[196:199], v[64:67], v[40:43], v[196:199]
s_add_u32 s72, s69, 15360
buffer_load_dwordx4 v5, s[4:7], s72 offen offset:1024 lds
v_mfma_f32_16x16x32_bf16 v[200:203], v[64:67], v[48:51], v[200:203]
ds_read_b64_tr_b16 v[94:95], v15 offset:25600
v_mfma_f32_16x16x32_bf16 v[200:203], v[68:71], v[52:55], v[200:203]
ds_read_b128 v[108:111], v19 offset:34816
v_mfma_f32_16x16x32_bf16 v[204:207], v[68:71], v[60:63], v[204:207]
v_mfma_f32_16x16x32_bf16 v[204:207], v[64:67], v[56:59], v[204:207]
s_waitcnt lgkmcnt(11)
ds_read_b128 v[112:115], v18 offset:36864
v_mfma_f32_16x16x32_bf16 v[220:223], v[72:75], v[56:59], v[220:223]
s_add_u32 s72, s69, 129024
buffer_load_dwordx4 v4, s[4:7], s72 offen offset:2048 lds
v_mfma_f32_16x16x32_bf16 v[220:223], v[76:79], v[60:63], v[220:223]
v_mfma_f32_16x16x32_bf16 v[216:219], v[76:79], v[52:55], v[216:219]
s_waitcnt vmcnt(13) lgkmcnt(2)
ds_read_b128 v[116:119], v19 offset:36864
v_mfma_f32_16x16x32_bf16 v[216:219], v[72:75], v[48:51], v[216:219]
s_barrier
ds_read_b128 v[120:123], v18 offset:38912
v_mfma_f32_16x16x32_bf16 v[212:215], v[72:75], v[40:43], v[212:215]
ds_read_b64_tr_b16 v[64:65], v8 offset:32768
ds_read_b64_tr_b16 v[66:67], v8 offset:33792
v_mfma_f32_16x16x32_bf16 v[212:215], v[76:79], v[44:47], v[212:215]
ds_read_b64_tr_b16 v[68:69], v8 offset:40960
v_or_b32 v20, s58, v0
v_mfma_f32_16x16x32_bf16 v[208:211], v[76:79], v[36:39], v[208:211]
s_add_u32 s72, s69, 144384
buffer_load_dwordx4 v5, s[4:7], s72 offen offset:3072 lds
v_mfma_f32_16x16x32_bf16 v[208:211], v[72:75], v[32:35], v[208:211]
ds_read_b64_tr_b16 v[70:71], v8 offset:41984
v_mov_b32 v21, 1
v_mfma_f32_16x16x32_bf16 v[224:227], v[80:83], v[32:35], v[224:227]
ds_read_b64_tr_b16 v[72:73], v9 offset:32768
v_min_u32 v20, 1, v20
v_mfma_f32_16x16x32_bf16 v[224:227], v[84:87], v[36:39], v[224:227]
ds_read_b64_tr_b16 v[74:75], v9 offset:33792
v_lshlrev_b32 v20, 30, v20
v_mfma_f32_16x16x32_bf16 v[228:231], v[84:87], v[44:47], v[228:231]
s_add_u32 m0, s63, 69632
buffer_store_dword v21, v20, s[44:47], s91 offen sc1
v_mfma_f32_16x16x32_bf16 v[228:231], v[80:83], v[40:43], v[228:231]
s_add_u32 s72, s70, 0
buffer_load_dwordx4 v4, s[4:7], s72 offen lds
v_mfma_f32_16x16x32_bf16 v[232:235], v[80:83], v[48:51], v[232:235]
ds_read_b64_tr_b16 v[76:77], v9 offset:40960
v_accvgpr_write_b32 a32, 0
v_mfma_f32_16x16x32_bf16 v[232:235], v[84:87], v[52:55], v[232:235]
ds_read_b128 v[124:127], v19 offset:38912
v_accvgpr_write_b32 a33, 0
v_mfma_f32_16x16x32_bf16 v[236:239], v[84:87], v[60:63], v[236:239]
ds_read_b64_tr_b16 v[78:79], v9 offset:41984
v_accvgpr_write_b32 a34, 0
v_mfma_f32_16x16x32_bf16 v[236:239], v[80:83], v[56:59], v[236:239]
v_accvgpr_write_b32 a35, 0
v_accvgpr_write_b32 a36, 0
v_mfma_f32_16x16x32_bf16 v[252:255], v[88:91], v[56:59], v[252:255]
s_add_u32 s72, s70, 15360
buffer_load_dwordx4 v5, s[4:7], s72 offen offset:1024 lds
v_mfma_f32_16x16x32_bf16 v[252:255], v[92:95], v[60:63], v[252:255]
ds_read_b64_tr_b16 v[80:81], v10 offset:32768
v_accvgpr_write_b32 a37, 0
v_mfma_f32_16x16x32_bf16 v[248:251], v[92:95], v[52:55], v[248:251]
ds_read_b64_tr_b16 v[82:83], v10 offset:33792
v_accvgpr_write_b32 a38, 0
v_mfma_f32_16x16x32_bf16 v[248:251], v[88:91], v[48:51], v[248:251]
v_accvgpr_write_b32 a39, 0
v_accvgpr_write_b32 a40, 0
v_mfma_f32_16x16x32_bf16 v[244:247], v[88:91], v[40:43], v[244:247]
ds_read_b64_tr_b16 v[84:85], v10 offset:40960
v_accvgpr_write_b32 a41, 0
v_mfma_f32_16x16x32_bf16 v[244:247], v[92:95], v[44:47], v[244:247]
ds_read_b64_tr_b16 v[86:87], v10 offset:41984
v_accvgpr_write_b32 a42, 0
v_mfma_f32_16x16x32_bf16 v[240:243], v[92:95], v[36:39], v[240:243]
s_add_u32 s72, s70, 129024
buffer_load_dwordx4 v4, s[4:7], s72 offen offset:2048 lds
v_mfma_f32_16x16x32_bf16 v[240:243], v[88:91], v[32:35], v[240:243]
s_waitcnt lgkmcnt(5)
v_accvgpr_write_b32 a43, 0
v_accvgpr_write_b32 a44, 0
v_mfma_f32_16x16x32_bf16 v[128:131], v[64:67], v[96:99], v[128:131]
ds_read_b64_tr_b16 v[88:89], v11 offset:32768
v_accvgpr_write_b32 a45, 0
v_mfma_f32_16x16x32_bf16 v[128:131], v[68:71], v[100:103], v[128:131]
ds_read_b64_tr_b16 v[90:91], v11 offset:33792
v_accvgpr_write_b32 a46, 0
v_mfma_f32_16x16x32_bf16 v[132:135], v[68:71], v[108:111], v[132:135]
v_accvgpr_write_b32 a47, 0
v_accvgpr_write_b32 a48, 0
v_mfma_f32_16x16x32_bf16 v[132:135], v[64:67], v[104:107], v[132:135]
s_add_u32 s72, s70, 144384
buffer_load_dwordx4 v5, s[4:7], s72 offen offset:3072 lds
v_mfma_f32_16x16x32_bf16 v[136:139], v[64:67], v[112:115], v[136:139]
ds_read_b64_tr_b16 v[92:93], v11 offset:40960
v_accvgpr_write_b32 a49, 0
v_mfma_f32_16x16x32_bf16 v[136:139], v[68:71], v[116:119], v[136:139]
s_lshl_b32 s71, s73, 12
v_accvgpr_write_b32 a50, 0
v_accvgpr_write_b32 a51, 0
v_mfma_f32_16x16x32_bf16 v[140:143], v[68:71], v[124:127], v[140:143]
s_add_u32 s71, s71, s66
ds_read_b64_tr_b16 v[94:95], v11 offset:41984
v_accvgpr_write_b32 a52, 0
v_mfma_f32_16x16x32_bf16 v[140:143], v[64:67], v[120:123], v[140:143]
s_waitcnt lgkmcnt(8)
v_accvgpr_write_b32 a53, 0
v_accvgpr_write_b32 a54, 0
v_mfma_f32_16x16x32_bf16 v[156:159], v[72:75], v[120:123], v[156:159]
s_add_u32 m0, s64, 16384
ds_read_b64_tr_b16 v[64:65], v12 offset:32768
v_accvgpr_write_b32 a55, 0
v_mfma_f32_16x16x32_bf16 v[156:159], v[76:79], v[124:127], v[156:159]
s_add_u32 s72, s71, 0
buffer_load_dwordx4 v6, s[12:15], s72 offen lds
v_mfma_f32_16x16x32_bf16 v[152:155], v[76:79], v[116:119], v[152:155]
s_add_u32 s73, s62, 14
ds_read_b64_tr_b16 v[66:67], v12 offset:33792
v_accvgpr_write_b32 a56, 0
v_mfma_f32_16x16x32_bf16 v[152:155], v[72:75], v[112:115], v[152:155]
s_add_u32 s70, s73, s65
v_accvgpr_write_b32 a57, 0
v_accvgpr_write_b32 a58, 0
v_mfma_f32_16x16x32_bf16 v[148:151], v[72:75], v[104:107], v[148:151]
s_and_b32 s70, s70, 3
ds_read_b64_tr_b16 v[68:69], v12 offset:40960
v_accvgpr_write_b32 a59, 0
v_mfma_f32_16x16x32_bf16 v[148:151], v[76:79], v[108:111], v[148:151]
s_and_b32 s73, s73, 12
ds_read_b64_tr_b16 v[70:71], v12 offset:41984
v_accvgpr_write_b32 a60, 0
v_mfma_f32_16x16x32_bf16 v[144:147], v[76:79], v[100:103], v[144:147]
s_add_u32 s72, s71, 31744
buffer_load_dwordx4 v6, s[12:15], s72 offen offset:1024 lds
v_mfma_f32_16x16x32_bf16 v[144:147], v[72:75], v[96:99], v[144:147]
s_waitcnt lgkmcnt(8)
v_accvgpr_write_b32 a61, 0
v_accvgpr_write_b32 a62, 0
v_mfma_f32_16x16x32_bf16 v[160:163], v[80:83], v[96:99], v[160:163]
s_or_b32 s73, s73, s70
ds_read_b64_tr_b16 v[72:73], v13 offset:32768
v_accvgpr_write_b32 a63, 0
v_mfma_f32_16x16x32_bf16 v[160:163], v[84:87], v[100:103], v[160:163]
s_lshl_b32 s73, s73, 7
ds_read_b64_tr_b16 v[74:75], v13 offset:33792
v_accvgpr_write_b32 a96, 0
v_mfma_f32_16x16x32_bf16 v[164:167], v[84:87], v[108:111], v[164:167]
s_add_u32 s69, s73, s67
v_accvgpr_write_b32 a97, 0
v_accvgpr_write_b32 a98, 0
v_mfma_f32_16x16x32_bf16 v[164:167], v[80:83], v[104:107], v[164:167]
s_add_u32 s72, s71, 63488
buffer_load_dwordx4 v7, s[12:15], s72 offen offset:2048 lds
v_mfma_f32_16x16x32_bf16 v[168:171], v[80:83], v[112:115], v[168:171]
s_waitcnt vmcnt(16)
ds_read_b64_tr_b16 v[76:77], v13 offset:40960
v_accvgpr_write_b32 a99, 0
v_mfma_f32_16x16x32_bf16 v[168:171], v[84:87], v[116:119], v[168:171]
s_add_u32 s70, s73, s68
ds_read_b128 v[32:35], v16 offset:0
v_accvgpr_write_b32 a100, 0
v_mfma_f32_16x16x32_bf16 v[172:175], v[84:87], v[124:127], v[172:175]
ds_read_b64_tr_b16 v[78:79], v13 offset:41984
v_accvgpr_write_b32 a101, 0
v_mfma_f32_16x16x32_bf16 v[172:175], v[80:83], v[120:123], v[172:175]
s_waitcnt lgkmcnt(9)
ds_read_b128 v[36:39], v17 offset:0
v_accvgpr_write_b32 a102, 0
v_mfma_f32_16x16x32_bf16 v[188:191], v[88:91], v[120:123], v[188:191]
s_add_u32 s72, s71, 95232
buffer_load_dwordx4 v7, s[12:15], s72 offen offset:3072 lds
v_mfma_f32_16x16x32_bf16 v[188:191], v[92:95], v[124:127], v[188:191]
ds_read_b64_tr_b16 v[80:81], v14 offset:32768
v_accvgpr_write_b32 a103, 0
v_mfma_f32_16x16x32_bf16 v[184:187], v[92:95], v[116:119], v[184:187]
ds_read_b64_tr_b16 v[82:83], v14 offset:33792
v_accvgpr_write_b32 a104, 0
v_mfma_f32_16x16x32_bf16 v[184:187], v[88:91], v[112:115], v[184:187]
v_accvgpr_write_b32 a105, 0
v_accvgpr_write_b32 a106, 0
v_mfma_f32_16x16x32_bf16 v[180:183], v[88:91], v[104:107], v[180:183]
ds_read_b64_tr_b16 v[84:85], v14 offset:40960
v_accvgpr_write_b32 a107, 0
v_mfma_f32_16x16x32_bf16 v[180:183], v[92:95], v[108:111], v[180:183]
s_add_u32 m0, s63, 98304
ds_read_b64_tr_b16 v[86:87], v14 offset:41984
v_accvgpr_write_b32 a108, 0
v_mfma_f32_16x16x32_bf16 v[176:179], v[92:95], v[100:103], v[176:179]
s_add_u32 s72, s69, 0
buffer_load_dwordx4 v4, s[4:7], s72 offen lds
v_mfma_f32_16x16x32_bf16 v[176:179], v[88:91], v[96:99], v[176:179]
s_waitcnt lgkmcnt(10)
ds_read_b128 v[40:43], v16 offset:2048
v_accvgpr_write_b32 a109, 0
v_mfma_f32_16x16x32_bf16 v[192:195], v[64:67], v[96:99], v[192:195]
ds_read_b64_tr_b16 v[88:89], v15 offset:32768
v_accvgpr_write_b32 a110, 0
v_mfma_f32_16x16x32_bf16 v[192:195], v[68:71], v[100:103], v[192:195]
ds_read_b64_tr_b16 v[90:91], v15 offset:33792
v_accvgpr_write_b32 a111, 0
v_mfma_f32_16x16x32_bf16 v[196:199], v[68:71], v[108:111], v[196:199]
ds_read_b64_tr_b16 v[92:93], v15 offset:40960
v_accvgpr_write_b32 a112, 0
v_mfma_f32_16x16x32_bf16 v[196:199], v[64:67], v[104:107], v[196:199]
s_add_u32 s72, s69, 15360
buffer_load_dwordx4 v5, s[4:7], s72 offen offset:1024 lds
v_mfma_f32_16x16x32_bf16 v[200:203], v[64:67], v[112:115], v[200:203]
ds_read_b64_tr_b16 v[94:95], v15 offset:41984
v_accvgpr_write_b32 a113, 0
v_mfma_f32_16x16x32_bf16 v[200:203], v[68:71], v[116:119], v[200:203]
ds_read_b128 v[44:47], v17 offset:2048
v_accvgpr_write_b32 a114, 0
v_mfma_f32_16x16x32_bf16 v[204:207], v[68:71], v[124:127], v[204:207]
v_accvgpr_write_b32 a115, 0
v_accvgpr_write_b32 a116, 0
v_mfma_f32_16x16x32_bf16 v[204:207], v[64:67], v[120:123], v[204:207]
s_waitcnt lgkmcnt(11)
ds_read_b128 v[48:51], v16 offset:4096
v_accvgpr_write_b32 a117, 0
v_mfma_f32_16x16x32_bf16 v[220:223], v[72:75], v[120:123], v[220:223]
s_add_u32 s72, s69, 129024
buffer_load_dwordx4 v4, s[4:7], s72 offen offset:2048 lds
v_mfma_f32_16x16x32_bf16 v[220:223], v[76:79], v[124:127], v[220:223]
v_accvgpr_write_b32 a118, 0
v_accvgpr_write_b32 a119, 0
v_mfma_f32_16x16x32_bf16 v[216:219], v[76:79], v[116:119], v[216:219]
s_waitcnt vmcnt(16) lgkmcnt(2)
ds_read_b128 v[52:55], v17 offset:4096
v_accvgpr_write_b32 a120, 0
v_mfma_f32_16x16x32_bf16 v[216:219], v[72:75], v[112:115], v[216:219]
s_barrier
ds_read_b128 v[56:59], v16 offset:6144
v_accvgpr_write_b32 a121, 0
v_mfma_f32_16x16x32_bf16 v[212:215], v[72:75], v[104:107], v[212:215]
s_waitcnt vmcnt(24)
v_cmp_gt_u32 vcc, 8, v3
s_cbranch_vccnz Lspin1
Lback2:
v_mfma_f32_16x16x32_bf16 v[212:215], v[76:79], v[108:111], v[212:215]
ds_read_b64_tr_b16 v[64:65], v8 offset:0
ds_read_b64_tr_b16 v[66:67], v8 offset:1024
v_mfma_f32_16x16x32_bf16 v[208:211], v[76:79], v[100:103], v[208:211]
s_add_u32 s72, s69, 144384
buffer_load_dwordx4 v5, s[4:7], s72 offen offset:3072 lds
v_mfma_f32_16x16x32_bf16 v[208:211], v[72:75], v[96:99], v[208:211]
ds_read_b64_tr_b16 v[68:69], v8 offset:8192
ds_read_b64_tr_b16 v[70:71], v8 offset:9216
v_mfma_f32_16x16x32_bf16 v[224:227], v[80:83], v[96:99], v[224:227]
ds_read_b64_tr_b16 v[72:73], v9 offset:0
v_accvgpr_write_b32 a122, 0
v_mfma_f32_16x16x32_bf16 v[224:227], v[84:87], v[100:103], v[224:227]
ds_read_b64_tr_b16 v[74:75], v9 offset:1024
v_accvgpr_write_b32 a123, 0
v_mfma_f32_16x16x32_bf16 v[228:231], v[84:87], v[108:111], v[228:231]
s_add_u32 m0, s63, 102400
v_accvgpr_write_b32 a124, 0
v_accvgpr_write_b32 a125, 0
v_mfma_f32_16x16x32_bf16 v[228:231], v[80:83], v[104:107], v[228:231]
s_add_u32 s72, s70, 0
buffer_load_dwordx4 v4, s[4:7], s72 offen lds
v_mfma_f32_16x16x32_bf16 v[232:235], v[80:83], v[112:115], v[232:235]
ds_read_b64_tr_b16 v[76:77], v9 offset:8192
v_accvgpr_write_b32 a126, 0
v_mfma_f32_16x16x32_bf16 v[232:235], v[84:87], v[116:119], v[232:235]
ds_read_b128 v[60:63], v17 offset:6144
v_accvgpr_write_b32 a127, 0
v_mfma_f32_16x16x32_bf16 v[236:239], v[84:87], v[124:127], v[236:239]
ds_read_b64_tr_b16 v[78:79], v9 offset:9216
v_mfma_f32_16x16x32_bf16 v[236:239], v[80:83], v[120:123], v[236:239]
v_mfma_f32_16x16x32_bf16 v[252:255], v[88:91], v[120:123], v[252:255]
s_add_u32 s72, s70, 15360
buffer_load_dwordx4 v5, s[4:7], s72 offen offset:1024 lds
v_mfma_f32_16x16x32_bf16 v[252:255], v[92:95], v[124:127], v[252:255]
ds_read_b64_tr_b16 v[80:81], v10 offset:0
v_mfma_f32_16x16x32_bf16 v[248:251], v[92:95], v[116:119], v[248:251]
ds_read_b64_tr_b16 v[82:83], v10 offset:1024
v_mfma_f32_16x16x32_bf16 v[248:251], v[88:91], v[112:115], v[248:251]
v_mfma_f32_16x16x32_bf16 v[244:247], v[88:91], v[104:107], v[244:247]
ds_read_b64_tr_b16 v[84:85], v10 offset:8192
v_mfma_f32_16x16x32_bf16 v[244:247], v[92:95], v[108:111], v[244:247]
ds_read_b64_tr_b16 v[86:87], v10 offset:9216
v_mfma_f32_16x16x32_bf16 v[240:243], v[92:95], v[100:103], v[240:243]
s_add_u32 s72, s70, 129024
buffer_load_dwordx4 v4, s[4:7], s72 offen offset:2048 lds
v_mfma_f32_16x16x32_bf16 v[240:243], v[88:91], v[96:99], v[240:243]
s_waitcnt lgkmcnt(5)
v_mfma_f32_16x16x32_bf16 v[128:131], v[64:67], v[32:35], v[128:131]
ds_read_b64_tr_b16 v[88:89], v11 offset:0
v_mfma_f32_16x16x32_bf16 v[128:131], v[68:71], v[36:39], v[128:131]
ds_read_b64_tr_b16 v[90:91], v11 offset:1024
v_mfma_f32_16x16x32_bf16 v[132:135], v[68:71], v[44:47], v[132:135]
v_mfma_f32_16x16x32_bf16 v[132:135], v[64:67], v[40:43], v[132:135]
s_add_u32 s72, s70, 144384
buffer_load_dwordx4 v5, s[4:7], s72 offen offset:3072 lds
v_mfma_f32_16x16x32_bf16 v[136:139], v[64:67], v[48:51], v[136:139]
ds_read_b64_tr_b16 v[92:93], v11 offset:8192
v_mfma_f32_16x16x32_bf16 v[136:139], v[68:71], v[52:55], v[136:139]
s_lshl_b32 s71, s73, 12
v_mfma_f32_16x16x32_bf16 v[140:143], v[68:71], v[60:63], v[140:143]
s_add_u32 s71, s71, s66
ds_read_b64_tr_b16 v[94:95], v11 offset:9216
v_mfma_f32_16x16x32_bf16 v[140:143], v[64:67], v[56:59], v[140:143]
s_waitcnt lgkmcnt(8)
v_mfma_f32_16x16x32_bf16 v[156:159], v[72:75], v[56:59], v[156:159]
s_add_u32 m0, s64, 32768
ds_read_b64_tr_b16 v[64:65], v12 offset:0
v_mfma_f32_16x16x32_bf16 v[156:159], v[76:79], v[60:63], v[156:159]
s_add_u32 s72, s71, 0
buffer_load_dwordx4 v6, s[12:15], s72 offen lds
v_mfma_f32_16x16x32_bf16 v[152:155], v[76:79], v[52:55], v[152:155]
s_add_u32 s73, s62, 15
ds_read_b64_tr_b16 v[66:67], v12 offset:1024
v_mfma_f32_16x16x32_bf16 v[152:155], v[72:75], v[48:51], v[152:155]
s_add_u32 s70, s73, s65
v_mfma_f32_16x16x32_bf16 v[148:151], v[72:75], v[40:43], v[148:151]
s_and_b32 s70, s70, 3
ds_read_b64_tr_b16 v[68:69], v12 offset:8192
v_mfma_f32_16x16x32_bf16 v[148:151], v[76:79], v[44:47], v[148:151]
s_and_b32 s73, s73, 12
ds_read_b64_tr_b16 v[70:71], v12 offset:9216
v_mfma_f32_16x16x32_bf16 v[144:147], v[76:79], v[36:39], v[144:147]
s_add_u32 s72, s71, 31744
buffer_load_dwordx4 v6, s[12:15], s72 offen offset:1024 lds
v_mfma_f32_16x16x32_bf16 v[144:147], v[72:75], v[32:35], v[144:147]
s_waitcnt lgkmcnt(8)
v_mfma_f32_16x16x32_bf16 v[160:163], v[80:83], v[32:35], v[160:163]
s_or_b32 s73, s73, s70
ds_read_b64_tr_b16 v[72:73], v13 offset:0
v_mfma_f32_16x16x32_bf16 v[160:163], v[84:87], v[36:39], v[160:163]
s_lshl_b32 s73, s73, 7
ds_read_b64_tr_b16 v[74:75], v13 offset:1024
v_mfma_f32_16x16x32_bf16 v[164:167], v[84:87], v[44:47], v[164:167]
s_add_u32 s69, s73, s67
v_mfma_f32_16x16x32_bf16 v[164:167], v[80:83], v[40:43], v[164:167]
s_add_u32 s72, s71, 63488
buffer_load_dwordx4 v7, s[12:15], s72 offen offset:2048 lds
v_mfma_f32_16x16x32_bf16 v[168:171], v[80:83], v[48:51], v[168:171]
s_waitcnt vmcnt(15)
ds_read_b64_tr_b16 v[76:77], v13 offset:8192
v_mfma_f32_16x16x32_bf16 v[168:171], v[84:87], v[52:55], v[168:171]
s_add_u32 s70, s73, s68
ds_read_b128 v[96:99], v18 offset:0
v_mfma_f32_16x16x32_bf16 v[172:175], v[84:87], v[60:63], v[172:175]
ds_read_b64_tr_b16 v[78:79], v13 offset:9216
v_mfma_f32_16x16x32_bf16 v[172:175], v[80:83], v[56:59], v[172:175]
s_waitcnt lgkmcnt(9)
ds_read_b128 v[100:103], v19 offset:0
v_mfma_f32_16x16x32_bf16 v[188:191], v[88:91], v[56:59], v[188:191]
s_add_u32 s72, s71, 95232
buffer_load_dwordx4 v7, s[12:15], s72 offen offset:3072 lds
v_mfma_f32_16x16x32_bf16 v[188:191], v[92:95], v[60:63], v[188:191]
ds_read_b64_tr_b16 v[80:81], v14 offset:0
v_mfma_f32_16x16x32_bf16 v[184:187], v[92:95], v[52:55], v[184:187]
ds_read_b64_tr_b16 v[82:83], v14 offset:1024
v_mfma_f32_16x16x32_bf16 v[184:187], v[88:91], v[48:51], v[184:187]
v_mfma_f32_16x16x32_bf16 v[180:183], v[88:91], v[40:43], v[180:183]
ds_read_b64_tr_b16 v[84:85], v14 offset:8192
v_mfma_f32_16x16x32_bf16 v[180:183], v[92:95], v[44:47], v[180:183]
s_add_u32 m0, s63, 131072
ds_read_b64_tr_b16 v[86:87], v14 offset:9216
v_mfma_f32_16x16x32_bf16 v[176:179], v[92:95], v[36:39], v[176:179]
s_add_u32 s72, s69, 0
buffer_load_dwordx4 v4, s[4:7], s72 offen lds
v_mfma_f32_16x16x32_bf16 v[176:179], v[88:91], v[32:35], v[176:179]
s_waitcnt lgkmcnt(10)
ds_read_b128 v[104:107], v18 offset:2048
v_mfma_f32_16x16x32_bf16 v[192:195], v[64:67], v[32:35], v[192:195]
ds_read_b64_tr_b16 v[88:89], v15 offset:0
ds_read_b64_tr_b16 v[90:91], v15 offset:1024
v_mfma_f32_16x16x32_bf16 v[192:195], v[68:71], v[36:39], v[192:195]
ds_read_b64_tr_b16 v[92:93], v15 offset:8192
v_mfma_f32_16x16x32_bf16 v[196:199], v[68:71], v[44:47], v[196:199]
s_and_b32 s75, s91, 0xfffffc7f
v_lshrrev_b32 v2, 3, v0
v_lshlrev_b32 v2, 7, v2
v_mfma_f32_16x16x32_bf16 v[196:199], v[64:67], v[40:43], v[196:199]
s_add_u32 s72, s69, 15360
buffer_load_dwordx4 v5, s[4:7], s72 offen offset:1024 lds
v_mfma_f32_16x16x32_bf16 v[200:203], v[64:67], v[48:51], v[200:203]
buffer_load_dword v3, v2, s[44:47], s75 offen sc1
v_mfma_f32_16x16x32_bf16 v[200:203], v[68:71], v[52:55], v[200:203]
ds_read_b64_tr_b16 v[94:95], v15 offset:9216
v_mfma_f32_16x16x32_bf16 v[204:207], v[68:71], v[60:63], v[204:207]
ds_read_b128 v[108:111], v19 offset:2048
v_mfma_f32_16x16x32_bf16 v[204:207], v[64:67], v[56:59], v[204:207]
s_waitcnt lgkmcnt(11)
v_mfma_f32_16x16x32_bf16 v[220:223], v[72:75], v[56:59], v[220:223]
s_add_u32 s72, s69, 129024
buffer_load_dwordx4 v4, s[4:7], s72 offen offset:2048 lds
v_mfma_f32_16x16x32_bf16 v[220:223], v[76:79], v[60:63], v[220:223]
ds_read_b128 v[112:115], v18 offset:4096
v_mfma_f32_16x16x32_bf16 v[216:219], v[76:79], v[52:55], v[216:219]
s_waitcnt vmcnt(16) lgkmcnt(2)
ds_read_b128 v[116:119], v19 offset:4096
v_mfma_f32_16x16x32_bf16 v[216:219], v[72:75], v[48:51], v[216:219]
s_barrier
v_mfma_f32_16x16x32_bf16 v[212:215], v[72:75], v[40:43], v[212:215]
ds_read_b64_tr_b16 v[64:65], v8 offset:16384
ds_read_b64_tr_b16 v[66:67], v8 offset:17408
v_mfma_f32_16x16x32_bf16 v[212:215], v[76:79], v[44:47], v[212:215]
ds_read_b64_tr_b16 v[68:69], v8 offset:24576
v_mfma_f32_16x16x32_bf16 v[208:211], v[76:79], v[36:39], v[208:211]
s_add_u32 s72, s69, 144384
buffer_load_dwordx4 v5, s[4:7], s72 offen offset:3072 lds
v_mfma_f32_16x16x32_bf16 v[208:211], v[72:75], v[32:35], v[208:211]
ds_read_b64_tr_b16 v[70:71], v8 offset:25600
v_mfma_f32_16x16x32_bf16 v[224:227], v[80:83], v[32:35], v[224:227]
ds_read_b64_tr_b16 v[72:73], v9 offset:16384
v_mfma_f32_16x16x32_bf16 v[224:227], v[84:87], v[36:39], v[224:227]
ds_read_b64_tr_b16 v[74:75], v9 offset:17408
v_mfma_f32_16x16x32_bf16 v[228:231], v[84:87], v[44:47], v[228:231]
s_add_u32 m0, s63, 135168
ds_read_b128 v[120:123], v18 offset:6144
v_mfma_f32_16x16x32_bf16 v[228:231], v[80:83], v[40:43], v[228:231]
s_add_u32 s72, s70, 0
buffer_load_dwordx4 v4, s[4:7], s72 offen lds
v_mfma_f32_16x16x32_bf16 v[232:235], v[80:83], v[48:51], v[232:235]
ds_read_b64_tr_b16 v[76:77], v9 offset:24576
v_mfma_f32_16x16x32_bf16 v[232:235], v[84:87], v[52:55], v[232:235]
ds_read_b128 v[124:127], v19 offset:6144
v_mfma_f32_16x16x32_bf16 v[236:239], v[84:87], v[60:63], v[236:239]
ds_read_b64_tr_b16 v[78:79], v9 offset:25600
v_mfma_f32_16x16x32_bf16 v[236:239], v[80:83], v[56:59], v[236:239]
v_mfma_f32_16x16x32_bf16 v[252:255], v[88:91], v[56:59], v[252:255]
s_add_u32 s72, s70, 15360
buffer_load_dwordx4 v5, s[4:7], s72 offen offset:1024 lds
v_mfma_f32_16x16x32_bf16 v[252:255], v[92:95], v[60:63], v[252:255]
ds_read_b64_tr_b16 v[80:81], v10 offset:16384
v_mfma_f32_16x16x32_bf16 v[248:251], v[92:95], v[52:55], v[248:251]
ds_read_b64_tr_b16 v[82:83], v10 offset:17408
v_mfma_f32_16x16x32_bf16 v[248:251], v[88:91], v[48:51], v[248:251]
v_mfma_f32_16x16x32_bf16 v[244:247], v[88:91], v[40:43], v[244:247]
ds_read_b64_tr_b16 v[84:85], v10 offset:24576
v_mfma_f32_16x16x32_bf16 v[244:247], v[92:95], v[44:47], v[244:247]
ds_read_b64_tr_b16 v[86:87], v10 offset:25600
v_mfma_f32_16x16x32_bf16 v[240:243], v[92:95], v[36:39], v[240:243]
s_add_u32 s72, s70, 129024
buffer_load_dwordx4 v4, s[4:7], s72 offen offset:2048 lds
v_mfma_f32_16x16x32_bf16 v[240:243], v[88:91], v[32:35], v[240:243]
s_waitcnt lgkmcnt(5)
v_mfma_f32_16x16x32_bf16 v[128:131], v[64:67], v[96:99], v[128:131]
ds_read_b64_tr_b16 v[88:89], v11 offset:16384
v_mfma_f32_16x16x32_bf16 v[128:131], v[68:71], v[100:103], v[128:131]
ds_read_b64_tr_b16 v[90:91], v11 offset:17408
v_mfma_f32_16x16x32_bf16 v[132:135], v[68:71], v[108:111], v[132:135]
v_mfma_f32_16x16x32_bf16 v[132:135], v[64:67], v[104:107], v[132:135]
s_add_u32 s72, s70, 144384
buffer_load_dwordx4 v5, s[4:7], s72 offen offset:3072 lds
v_mfma_f32_16x16x32_bf16 v[136:139], v[64:67], v[112:115], v[136:139]
ds_read_b64_tr_b16 v[92:93], v11 offset:24576
v_mfma_f32_16x16x32_bf16 v[136:139], v[68:71], v[116:119], v[136:139]
s_lshl_b32 s71, s73, 12
v_mfma_f32_16x16x32_bf16 v[140:143], v[68:71], v[124:127], v[140:143]
s_add_u32 s71, s71, s66
ds_read_b64_tr_b16 v[94:95], v11 offset:25600
v_mfma_f32_16x16x32_bf16 v[140:143], v[64:67], v[120:123], v[140:143]
s_waitcnt lgkmcnt(8)
v_mfma_f32_16x16x32_bf16 v[156:159], v[72:75], v[120:123], v[156:159]
s_add_u32 m0, s64, 0
ds_read_b64_tr_b16 v[64:65], v12 offset:16384
v_mfma_f32_16x16x32_bf16 v[156:159], v[76:79], v[124:127], v[156:159]
s_add_u32 s72, s71, 0
buffer_load_dwordx4 v6, s[12:15], s72 offen lds
v_mfma_f32_16x16x32_bf16 v[152:155], v[76:79], v[116:119], v[152:155]
ds_read_b64_tr_b16 v[66:67], v12 offset:17408
v_mfma_f32_16x16x32_bf16 v[152:155], v[72:75], v[112:115], v[152:155]
v_mfma_f32_16x16x32_bf16 v[148:151], v[72:75], v[104:107], v[148:151]
ds_read_b64_tr_b16 v[68:69], v12 offset:24576
v_mfma_f32_16x16x32_bf16 v[148:151], v[76:79], v[108:111], v[148:151]
ds_read_b64_tr_b16 v[70:71], v12 offset:25600
v_mfma_f32_16x16x32_bf16 v[144:147], v[76:79], v[100:103], v[144:147]
s_add_u32 s72, s71, 31744
buffer_load_dwordx4 v6, s[12:15], s72 offen offset:1024 lds
v_mfma_f32_16x16x32_bf16 v[144:147], v[72:75], v[96:99], v[144:147]
s_waitcnt lgkmcnt(8)
v_mfma_f32_16x16x32_bf16 v[160:163], v[80:83], v[96:99], v[160:163]
ds_read_b64_tr_b16 v[72:73], v13 offset:16384
v_mfma_f32_16x16x32_bf16 v[160:163], v[84:87], v[100:103], v[160:163]
ds_read_b64_tr_b16 v[74:75], v13 offset:17408
v_mfma_f32_16x16x32_bf16 v[164:167], v[84:87], v[108:111], v[164:167]
v_mfma_f32_16x16x32_bf16 v[164:167], v[80:83], v[104:107], v[164:167]
s_add_u32 s72, s71, 63488
buffer_load_dwordx4 v7, s[12:15], s72 offen offset:2048 lds
v_mfma_f32_16x16x32_bf16 v[168:171], v[80:83], v[112:115], v[168:171]
s_waitcnt vmcnt(16)
ds_read_b64_tr_b16 v[76:77], v13 offset:24576
v_mfma_f32_16x16x32_bf16 v[168:171], v[84:87], v[116:119], v[168:171]
ds_read_b128 v[32:35], v18 offset:32768
v_mfma_f32_16x16x32_bf16 v[172:175], v[84:87], v[124:127], v[172:175]
ds_read_b64_tr_b16 v[78:79], v13 offset:25600
v_mfma_f32_16x16x32_bf16 v[172:175], v[80:83], v[120:123], v[172:175]
s_waitcnt lgkmcnt(9)
ds_read_b128 v[36:39], v19 offset:32768
v_mfma_f32_16x16x32_bf16 v[188:191], v[88:91], v[120:123], v[188:191]
s_add_u32 s72, s71, 95232
buffer_load_dwordx4 v7, s[12:15], s72 offen offset:3072 lds
v_mfma_f32_16x16x32_bf16 v[188:191], v[92:95], v[124:127], v[188:191]
v_accvgpr_write_b32 a0, -1
v_accvgpr_write_b32 a1, -1
v_mfma_f32_16x16x32_bf16 v[184:187], v[92:95], v[116:119], v[184:187]
v_accvgpr_write_b32 a2, -1
v_accvgpr_write_b32 a3, -1
v_mfma_f32_16x16x32_bf16 v[184:187], v[88:91], v[112:115], v[184:187]
s_add_u32 s80, s93, 0x3a00000
ds_read_b64_tr_b16 v[80:81], v14 offset:16384
v_mfma_f32_16x16x32_bf16 v[180:183], v[88:91], v[104:107], v[180:183]
ds_read_b64_tr_b16 v[82:83], v14 offset:17408
v_mfma_f32_16x16x32_bf16 v[180:183], v[92:95], v[108:111], v[180:183]
ds_read_b64_tr_b16 v[84:85], v14 offset:24576
v_mfma_f32_16x16x32_bf16 v[176:179], v[92:95], v[100:103], v[176:179]
ds_read_b64_tr_b16 v[86:87], v14 offset:25600
v_mfma_f32_16x16x32_bf16 v[176:179], v[88:91], v[96:99], v[176:179]
s_waitcnt lgkmcnt(10)
ds_read_b128 v[40:43], v18 offset:34816
v_mfma_f32_16x16x32_bf16 v[192:195], v[64:67], v[96:99], v[192:195]
s_waitcnt vmcnt(10)
v_cmp_gt_u32 vcc, 1, v3
s_cbranch_vccnz Lspin4
Lback5:
v_mfma_f32_16x16x32_bf16 v[192:195], v[68:71], v[100:103], v[192:195]
s_add_u32 m0, s64, 49152
ds_read_b64_tr_b16 v[88:89], v15 offset:16384
ds_read_b64_tr_b16 v[90:91], v15 offset:17408
v_mfma_f32_16x16x32_bf16 v[196:199], v[68:71], v[108:111], v[196:199]
s_add_u32 s72, s81, 16384
buffer_load_dwordx4 v1, s[44:47], s72 offen sc1 lds
v_mfma_f32_16x16x32_bf16 v[196:199], v[64:67], v[104:107], v[196:199]
ds_read_b64_tr_b16 v[92:93], v15 offset:24576
v_mfma_f32_16x16x32_bf16 v[200:203], v[64:67], v[112:115], v[200:203]
ds_read_b64_tr_b16 v[94:95], v15 offset:25600
v_mfma_f32_16x16x32_bf16 v[200:203], v[68:71], v[116:119], v[200:203]
buffer_load_dwordx4 v1, s[44:47], s72 offen offset:1024 sc1 lds
v_mfma_f32_16x16x32_bf16 v[204:207], v[68:71], v[124:127], v[204:207]
ds_read_b128 v[44:47], v19 offset:34816
v_mfma_f32_16x16x32_bf16 v[204:207], v[64:67], v[120:123], v[204:207]
s_waitcnt lgkmcnt(11)
v_mfma_f32_16x16x32_bf16 v[220:223], v[72:75], v[120:123], v[220:223]
ds_read_b128 v[48:51], v18 offset:36864
v_mfma_f32_16x16x32_bf16 v[220:223], v[76:79], v[124:127], v[220:223]
ds_read_b128 v[52:55], v19 offset:36864
v_mfma_f32_16x16x32_bf16 v[216:219], v[76:79], v[116:119], v[216:219]
s_waitcnt vmcnt(15) lgkmcnt(3)
buffer_load_dwordx4 v1, s[44:47], s72 offen offset:2048 sc1 lds
v_mfma_f32_16x16x32_bf16 v[216:219], v[72:75], v[112:115], v[216:219]
s_barrier
ds_read_b128 v[56:59], v18 offset:38912
v_mfma_f32_16x16x32_bf16 v[212:215], v[72:75], v[104:107], v[212:215]
ds_read_b64_tr_b16 v[64:65], v8 offset:32768
ds_read_b64_tr_b16 v[66:67], v8 offset:33792
v_mfma_f32_16x16x32_bf16 v[212:215], v[76:79], v[108:111], v[212:215]
ds_read_b64_tr_b16 v[68:69], v8 offset:40960
v_mfma_f32_16x16x32_bf16 v[208:211], v[76:79], v[100:103], v[208:211]
ds_read_b64_tr_b16 v[70:71], v8 offset:41984
v_mfma_f32_16x16x32_bf16 v[208:211], v[72:75], v[96:99], v[208:211]
buffer_load_dwordx4 v1, s[44:47], s72 offen offset:3072 sc1 lds
v_mfma_f32_16x16x32_bf16 v[224:227], v[80:83], v[96:99], v[224:227]
s_add_u32 s81, s81, 0x8000
ds_read_b64_tr_b16 v[72:73], v9 offset:32768
v_mfma_f32_16x16x32_bf16 v[224:227], v[84:87], v[100:103], v[224:227]
s_add_u32 m0, s64, 81920
ds_read_b64_tr_b16 v[74:75], v9 offset:33792
v_mfma_f32_16x16x32_bf16 v[228:231], v[84:87], v[108:111], v[228:231]
s_add_u32 s72, s81, 16384
buffer_load_dwordx4 v1, s[44:47], s72 offen sc1 lds
v_mfma_f32_16x16x32_bf16 v[228:231], v[80:83], v[104:107], v[228:231]
ds_read_b128 v[60:63], v19 offset:38912
v_mfma_f32_16x16x32_bf16 v[232:235], v[80:83], v[112:115], v[232:235]
buffer_load_dwordx4 v1, s[44:47], s72 offen offset:1024 sc1 lds
v_mfma_f32_16x16x32_bf16 v[232:235], v[84:87], v[116:119], v[232:235]
ds_read_b64_tr_b16 v[76:77], v9 offset:40960
v_mfma_f32_16x16x32_bf16 v[236:239], v[84:87], v[124:127], v[236:239]
ds_read_b64_tr_b16 v[78:79], v9 offset:41984
v_mfma_f32_16x16x32_bf16 v[236:239], v[80:83], v[120:123], v[236:239]
v_mfma_f32_16x16x32_bf16 v[252:255], v[88:91], v[120:123], v[252:255]
ds_read_b64_tr_b16 v[80:81], v10 offset:32768
v_mfma_f32_16x16x32_bf16 v[252:255], v[92:95], v[124:127], v[252:255]
buffer_load_dwordx4 v1, s[44:47], s72 offen offset:2048 sc1 lds
v_mfma_f32_16x16x32_bf16 v[248:251], v[92:95], v[116:119], v[248:251]
ds_read_b64_tr_b16 v[82:83], v10 offset:33792
v_mfma_f32_16x16x32_bf16 v[248:251], v[88:91], v[112:115], v[248:251]
v_mfma_f32_16x16x32_bf16 v[244:247], v[88:91], v[104:107], v[244:247]
ds_read_b64_tr_b16 v[84:85], v10 offset:40960
v_mfma_f32_16x16x32_bf16 v[244:247], v[92:95], v[108:111], v[244:247]
buffer_load_dwordx4 v1, s[44:47], s72 offen offset:3072 sc1 lds
v_mfma_f32_16x16x32_bf16 v[240:243], v[92:95], v[100:103], v[240:243]
ds_read_b64_tr_b16 v[86:87], v10 offset:41984
v_mfma_f32_16x16x32_bf16 v[240:243], v[88:91], v[96:99], v[240:243]
s_waitcnt lgkmcnt(6)
v_mfma_f32_16x16x32_bf16 v[128:131], v[64:67], v[32:35], v[128:131]
ds_read_b64_tr_b16 v[88:89], v11 offset:32768
v_mfma_f32_16x16x32_bf16 v[128:131], v[68:71], v[36:39], v[128:131]
ds_read_b64_tr_b16 v[90:91], v11 offset:33792
v_mfma_f32_16x16x32_bf16 v[132:135], v[68:71], v[44:47], v[132:135]
s_add_u32 m0, s64, 65536
v_mfma_f32_16x16x32_bf16 v[132:135], v[64:67], v[40:43], v[132:135]
s_add_u32 s72, s81, 0
buffer_load_dwordx4 v1, s[44:47], s72 offen sc1 lds
v_mfma_f32_16x16x32_bf16 v[136:139], v[64:67], v[48:51], v[136:139]
ds_read_b64_tr_b16 v[92:93], v11 offset:40960
v_mfma_f32_16x16x32_bf16 v[136:139], v[68:71], v[52:55], v[136:139]
ds_read_b64_tr_b16 v[94:95], v11 offset:41984
v_mfma_f32_16x16x32_bf16 v[140:143], v[68:71], v[60:63], v[140:143]
v_mfma_f32_16x16x32_bf16 v[140:143], v[64:67], v[56:59], v[140:143]
s_waitcnt lgkmcnt(8)
buffer_load_dwordx4 v1, s[44:47], s72 offen offset:1024 sc1 lds
v_mfma_f32_16x16x32_bf16 v[156:159], v[72:75], v[56:59], v[156:159]
ds_read_b64_tr_b16 v[64:65], v12 offset:32768
v_mfma_f32_16x16x32_bf16 v[156:159], v[76:79], v[60:63], v[156:159]
ds_read_b64_tr_b16 v[66:67], v12 offset:33792
v_mfma_f32_16x16x32_bf16 v[152:155], v[76:79], v[52:55], v[152:155]
v_mfma_f32_16x16x32_bf16 v[152:155], v[72:75], v[48:51], v[152:155]
buffer_load_dwordx4 v1, s[44:47], s72 offen offset:2048 sc1 lds
v_mfma_f32_16x16x32_bf16 v[148:151], v[72:75], v[40:43], v[148:151]
ds_read_b64_tr_b16 v[68:69], v12 offset:40960
v_mfma_f32_16x16x32_bf16 v[148:151], v[76:79], v[44:47], v[148:151]
v_mfma_f32_16x16x32_bf16 v[144:147], v[76:79], v[36:39], v[144:147]
ds_read_b64_tr_b16 v[70:71], v12 offset:41984
v_mfma_f32_16x16x32_bf16 v[144:147], v[72:75], v[32:35], v[144:147]
s_waitcnt lgkmcnt(8)
v_mfma_f32_16x16x32_bf16 v[160:163], v[80:83], v[32:35], v[160:163]
buffer_load_dwordx4 v1, s[44:47], s72 offen offset:3072 sc1 lds
v_mfma_f32_16x16x32_bf16 v[160:163], v[84:87], v[36:39], v[160:163]
ds_read_b64_tr_b16 v[72:73], v13 offset:32768
v_mfma_f32_16x16x32_bf16 v[164:167], v[84:87], v[44:47], v[164:167]
ds_read_b64_tr_b16 v[74:75], v13 offset:33792
v_mfma_f32_16x16x32_bf16 v[164:167], v[80:83], v[40:43], v[164:167]
v_mfma_f32_16x16x32_bf16 v[168:171], v[80:83], v[48:51], v[168:171]
s_waitcnt vmcnt(16)
ds_read_b64_tr_b16 v[76:77], v13 offset:40960
v_mfma_f32_16x16x32_bf16 v[168:171], v[84:87], v[52:55], v[168:171]
ds_read_b128 v[96:99], v16 offset:0
v_mfma_f32_16x16x32_bf16 v[172:175], v[84:87], v[60:63], v[172:175]
ds_read_b64_tr_b16 v[78:79], v13 offset:41984
v_mfma_f32_16x16x32_bf16 v[172:175], v[80:83], v[56:59], v[172:175]
s_waitcnt lgkmcnt(9)
v_mfma_f32_16x16x32_bf16 v[188:191], v[88:91], v[56:59], v[188:191]
ds_read_b64_tr_b16 v[80:81], v14 offset:32768
v_mfma_f32_16x16x32_bf16 v[188:191], v[92:95], v[60:63], v[188:191]
ds_read_b128 v[100:103], v17 offset:0
v_mfma_f32_16x16x32_bf16 v[184:187], v[92:95], v[52:55], v[184:187]
ds_read_b64_tr_b16 v[82:83], v14 offset:33792
v_mfma_f32_16x16x32_bf16 v[184:187], v[88:91], v[48:51], v[184:187]
v_mfma_f32_16x16x32_bf16 v[180:183], v[88:91], v[40:43], v[180:183]
ds_read_b64_tr_b16 v[84:85], v14 offset:40960
v_mfma_f32_16x16x32_bf16 v[180:183], v[92:95], v[44:47], v[180:183]
ds_read_b128 v[104:107], v16 offset:2048
v_mfma_f32_16x16x32_bf16 v[176:179], v[92:95], v[36:39], v[176:179]
ds_read_b64_tr_b16 v[86:87], v14 offset:41984
v_mfma_f32_16x16x32_bf16 v[176:179], v[88:91], v[32:35], v[176:179]
s_waitcnt lgkmcnt(11)
v_mfma_f32_16x16x32_bf16 v[192:195], v[64:67], v[32:35], v[192:195]
ds_read_b64_tr_b16 v[88:89], v15 offset:32768
v_mfma_f32_16x16x32_bf16 v[192:195], v[68:71], v[36:39], v[192:195]
ds_read_b64_tr_b16 v[90:91], v15 offset:33792
v_mfma_f32_16x16x32_bf16 v[196:199], v[68:71], v[44:47], v[196:199]
ds_read_b128 v[108:111], v17 offset:2048
v_mfma_f32_16x16x32_bf16 v[196:199], v[64:67], v[40:43], v[196:199]
ds_read_b64_tr_b16 v[92:93], v15 offset:40960
v_mfma_f32_16x16x32_bf16 v[200:203], v[64:67], v[48:51], v[200:203]
ds_read_b64_tr_b16 v[94:95], v15 offset:41984
v_mfma_f32_16x16x32_bf16 v[200:203], v[68:71], v[52:55], v[200:203]
v_mfma_f32_16x16x32_bf16 v[204:207], v[68:71], v[60:63], v[204:207]
ds_read_b128 v[112:115], v16 offset:4096
v_mfma_f32_16x16x32_bf16 v[204:207], v[64:67], v[56:59], v[204:207]
s_waitcnt lgkmcnt(12)
v_mfma_f32_16x16x32_bf16 v[220:223], v[72:75], v[56:59], v[220:223]
ds_read_b128 v[116:119], v17 offset:4096
v_mfma_f32_16x16x32_bf16 v[220:223], v[76:79], v[60:63], v[220:223]
v_mfma_f32_16x16x32_bf16 v[216:219], v[76:79], v[52:55], v[216:219]
s_waitcnt vmcnt(12) lgkmcnt(2)
ds_read_b128 v[120:123], v16 offset:6144
v_mfma_f32_16x16x32_bf16 v[216:219], v[72:75], v[48:51], v[216:219]
s_barrier
v_mfma_f32_16x16x32_bf16 v[212:215], v[72:75], v[40:43], v[212:215]
s_add_u32 s81, s81, 0x8000
ds_read_b64_tr_b16 v[64:65], v8 offset:0
ds_read_b64_tr_b16 v[66:67], v8 offset:1024
v_mfma_f32_16x16x32_bf16 v[212:215], v[76:79], v[44:47], v[212:215]
s_add_u32 m0, s64, 114688
ds_read_b64_tr_b16 v[68:69], v8 offset:8192
v_mfma_f32_16x16x32_bf16 v[208:211], v[76:79], v[36:39], v[208:211]
s_add_u32 s72, s81, 16384
buffer_load_dwordx4 v1, s[44:47], s72 offen sc1 lds
v_mfma_f32_16x16x32_bf16 v[208:211], v[72:75], v[32:35], v[208:211]
ds_read_b64_tr_b16 v[70:71], v8 offset:9216
v_mfma_f32_16x16x32_bf16 v[224:227], v[80:83], v[32:35], v[224:227]
buffer_load_dwordx4 v1, s[44:47], s72 offen offset:1024 sc1 lds
v_mfma_f32_16x16x32_bf16 v[224:227], v[84:87], v[36:39], v[224:227]
ds_read_b64_tr_b16 v[72:73], v9 offset:0
v_mfma_f32_16x16x32_bf16 v[228:231], v[84:87], v[44:47], v[228:231]
ds_read_b64_tr_b16 v[74:75], v9 offset:1024
v_mfma_f32_16x16x32_bf16 v[228:231], v[80:83], v[40:43], v[228:231]
ds_read_b128 v[124:127], v17 offset:6144
v_mfma_f32_16x16x32_bf16 v[232:235], v[80:83], v[48:51], v[232:235]
ds_read_b64_tr_b16 v[76:77], v9 offset:8192
v_mfma_f32_16x16x32_bf16 v[232:235], v[84:87], v[52:55], v[232:235]
buffer_store_dwordx4 a[0:3], v1, s[44:47], s80 offen sc1
v_mfma_f32_16x16x32_bf16 v[236:239], v[84:87], v[60:63], v[236:239]
ds_read_b64_tr_b16 v[78:79], v9 offset:9216
v_mfma_f32_16x16x32_bf16 v[236:239], v[80:83], v[56:59], v[236:239]
v_mfma_f32_16x16x32_bf16 v[252:255], v[88:91], v[56:59], v[252:255]
ds_read_b64_tr_b16 v[80:81], v10 offset:0
v_mfma_f32_16x16x32_bf16 v[252:255], v[92:95], v[60:63], v[252:255]
ds_read_b64_tr_b16 v[82:83], v10 offset:1024
v_mfma_f32_16x16x32_bf16 v[248:251], v[92:95], v[52:55], v[248:251]
buffer_load_dwordx4 v1, s[44:47], s72 offen offset:2048 sc1 lds
v_mfma_f32_16x16x32_bf16 v[248:251], v[88:91], v[48:51], v[248:251]
v_mfma_f32_16x16x32_bf16 v[244:247], v[88:91], v[40:43], v[244:247]
ds_read_b64_tr_b16 v[84:85], v10 offset:8192
v_mfma_f32_16x16x32_bf16 v[244:247], v[92:95], v[44:47], v[244:247]
ds_read_b64_tr_b16 v[86:87], v10 offset:9216
v_mfma_f32_16x16x32_bf16 v[240:243], v[92:95], v[36:39], v[240:243]
buffer_load_dwordx4 v1, s[44:47], s72 offen offset:3072 sc1 lds
v_mfma_f32_16x16x32_bf16 v[240:243], v[88:91], v[32:35], v[240:243]
s_waitcnt lgkmcnt(6)
v_mfma_f32_16x16x32_bf16 v[128:131], v[64:67], v[96:99], v[128:131]
ds_read_b64_tr_b16 v[88:89], v11 offset:0
v_mfma_f32_16x16x32_bf16 v[128:131], v[68:71], v[100:103], v[128:131]
ds_read_b64_tr_b16 v[90:91], v11 offset:1024
v_mfma_f32_16x16x32_bf16 v[132:135], v[68:71], v[108:111], v[132:135]
v_mfma_f32_16x16x32_bf16 v[132:135], v[64:67], v[104:107], v[132:135]
buffer_store_dwordx4 a[0:3], v1, s[44:47], s80 offen offset:1024 sc1
v_mfma_f32_16x16x32_bf16 v[136:139], v[64:67], v[112:115], v[136:139]
ds_read_b64_tr_b16 v[92:93], v11 offset:8192
v_mfma_f32_16x16x32_bf16 v[136:139], v[68:71], v[116:119], v[136:139]
v_mfma_f32_16x16x32_bf16 v[140:143], v[68:71], v[124:127], v[140:143]
ds_read_b64_tr_b16 v[94:95], v11 offset:9216
v_mfma_f32_16x16x32_bf16 v[140:143], v[64:67], v[120:123], v[140:143]
s_waitcnt lgkmcnt(8)
v_mfma_f32_16x16x32_bf16 v[156:159], v[72:75], v[120:123], v[156:159]
s_add_u32 m0, s64, 98304
ds_read_b64_tr_b16 v[64:65], v12 offset:0
v_mfma_f32_16x16x32_bf16 v[156:159], v[76:79], v[124:127], v[156:159]
s_add_u32 s72, s81, 0
buffer_load_dwordx4 v1, s[44:47], s72 offen sc1 lds
v_mfma_f32_16x16x32_bf16 v[152:155], v[76:79], v[116:119], v[152:155]
ds_read_b64_tr_b16 v[66:67], v12 offset:1024
v_mfma_f32_16x16x32_bf16 v[152:155], v[72:75], v[112:115], v[152:155]
v_mfma_f32_16x16x32_bf16 v[148:151], v[72:75], v[104:107], v[148:151]
buffer_load_dwordx4 v1, s[44:47], s72 offen offset:1024 sc1 lds
v_mfma_f32_16x16x32_bf16 v[148:151], v[76:79], v[108:111], v[148:151]
ds_read_b64_tr_b16 v[68:69], v12 offset:8192
v_mfma_f32_16x16x32_bf16 v[144:147], v[76:79], v[100:103], v[144:147]
ds_read_b64_tr_b16 v[70:71], v12 offset:9216
v_mfma_f32_16x16x32_bf16 v[144:147], v[72:75], v[96:99], v[144:147]
s_waitcnt lgkmcnt(8)
v_mfma_f32_16x16x32_bf16 v[160:163], v[80:83], v[96:99], v[160:163]
ds_read_b64_tr_b16 v[72:73], v13 offset:0
v_mfma_f32_16x16x32_bf16 v[160:163], v[84:87], v[100:103], v[160:163]
buffer_store_dwordx4 a[0:3], v1, s[44:47], s80 offen offset:2048 sc1
v_mfma_f32_16x16x32_bf16 v[164:167], v[84:87], v[108:111], v[164:167]
ds_read_b64_tr_b16 v[74:75], v13 offset:1024
v_mfma_f32_16x16x32_bf16 v[164:167], v[80:83], v[104:107], v[164:167]
v_mfma_f32_16x16x32_bf16 v[168:171], v[80:83], v[112:115], v[168:171]
ds_read_b64_tr_b16 v[76:77], v13 offset:8192
v_cvt_pk_bf16_f32 v48, v136, v137
v_mfma_f32_16x16x32_bf16 v[168:171], v[84:87], v[116:119], v[168:171]
ds_read_b64_tr_b16 v[78:79], v13 offset:9216
v_cvt_pk_bf16_f32 v49, v138, v139
v_mfma_f32_16x16x32_bf16 v[172:175], v[84:87], v[124:127], v[172:175]
buffer_load_dwordx4 v1, s[44:47], s72 offen offset:2048 sc1 lds
v_mfma_f32_16x16x32_bf16 v[172:175], v[80:83], v[120:123], v[172:175]
s_waitcnt lgkmcnt(8)
v_cvt_pk_bf16_f32 v50, v152, v153
v_cvt_pk_bf16_f32 v51, v154, v155
v_mfma_f32_16x16x32_bf16 v[188:191], v[88:91], v[120:123], v[188:191]
v_add_u32 v2, 0x8000, v1
v_cvt_pk_bf16_f32 v32, v132, v133
v_mfma_f32_16x16x32_bf16 v[188:191], v[92:95], v[124:127], v[188:191]
ds_read_b64_tr_b16 v[80:81], v14 offset:0
v_cvt_pk_bf16_f32 v33, v134, v135
v_mfma_f32_16x16x32_bf16 v[184:187], v[92:95], v[116:119], v[184:187]
buffer_load_dwordx4 v1, s[44:47], s72 offen offset:3072 sc1 lds
v_mfma_f32_16x16x32_bf16 v[184:187], v[88:91], v[112:115], v[184:187]
ds_read_b64_tr_b16 v[82:83], v14 offset:1024
v_cvt_pk_bf16_f32 v34, v148, v149
v_mfma_f32_16x16x32_bf16 v[180:183], v[88:91], v[104:107], v[180:183]
ds_read_b64_tr_b16 v[84:85], v14 offset:8192
v_cvt_pk_bf16_f32 v35, v150, v151
v_mfma_f32_16x16x32_bf16 v[180:183], v[92:95], v[108:111], v[180:183]
ds_read_b64_tr_b16 v[86:87], v14 offset:9216
v_cvt_pk_bf16_f32 v16, v128, v129
v_mfma_f32_16x16x32_bf16 v[176:179], v[92:95], v[100:103], v[176:179]
v_cvt_pk_bf16_f32 v17, v130, v131
v_cvt_pk_bf16_f32 v18, v144, v145
v_mfma_f32_16x16x32_bf16 v[176:179], v[88:91], v[96:99], v[176:179]
s_waitcnt lgkmcnt(8)
buffer_store_dwordx4 a[0:3], v1, s[44:47], s80 offen offset:3072 sc1
v_mfma_f32_16x16x32_bf16 v[192:195], v[64:67], v[96:99], v[192:195]
ds_read_b64_tr_b16 v[88:89], v15 offset:0
v_cvt_pk_bf16_f32 v19, v146, v147
v_mfma_f32_16x16x32_bf16 v[192:195], v[68:71], v[100:103], v[192:195]
ds_read_b64_tr_b16 v[90:91], v15 offset:1024
v_mfma_f32_16x16x32_bf16 v[196:199], v[68:71], v[108:111], v[196:199]
ds_read_b64_tr_b16 v[92:93], v15 offset:8192
v_mfma_f32_16x16x32_bf16 v[196:199], v[64:67], v[104:107], v[196:199]
ds_read_b64_tr_b16 v[94:95], v15 offset:9216
v_mfma_f32_16x16x32_bf16 v[200:203], v[64:67], v[112:115], v[200:203]
v_lshrrev_b32 v3, 1, v0
v_lshlrev_b32 v3, 7, v3
v_mfma_f32_16x16x32_bf16 v[200:203], v[68:71], v[116:119], v[200:203]
buffer_load_dword v4, v3, s[36:39], s93 offen
v_mfma_f32_16x16x32_bf16 v[204:207], v[68:71], v[124:127], v[204:207]
v_cvt_pk_bf16_f32 v52, v168, v169
v_cvt_pk_bf16_f32 v53, v170, v171
v_mfma_f32_16x16x32_bf16 v[204:207], v[64:67], v[120:123], v[204:207]
s_waitcnt lgkmcnt(8)
v_cvt_pk_bf16_f32 v54, v184, v185
v_cvt_pk_bf16_f32 v55, v186, v187
v_mfma_f32_16x16x32_bf16 v[220:223], v[72:75], v[120:123], v[220:223]
v_cvt_pk_bf16_f32 v36, v164, v165
v_cvt_pk_bf16_f32 v37, v166, v167
v_mfma_f32_16x16x32_bf16 v[220:223], v[76:79], v[124:127], v[220:223]
v_cvt_pk_bf16_f32 v38, v180, v181
v_cvt_pk_bf16_f32 v39, v182, v183
v_mfma_f32_16x16x32_bf16 v[216:219], v[76:79], v[116:119], v[216:219]
s_waitcnt vmcnt(21) lgkmcnt(0)
v_cvt_pk_bf16_f32 v20, v160, v161
v_cvt_pk_bf16_f32 v21, v162, v163
v_mfma_f32_16x16x32_bf16 v[216:219], v[72:75], v[112:115], v[216:219]
s_barrier
v_cvt_pk_bf16_f32 v22, v176, v177
v_cvt_pk_bf16_f32 v23, v178, v179
v_mfma_f32_16x16x32_bf16 v[212:215], v[72:75], v[104:107], v[212:215]
ds_read_b128 a[128:131], v2 offset:16384
v_cvt_pk_bf16_f32 v64, v140, v141
v_mfma_f32_16x16x32_bf16 v[212:215], v[76:79], v[108:111], v[212:215]
v_cvt_pk_bf16_f32 v65, v142, v143
v_cvt_pk_bf16_f32 v66, v156, v157
v_mfma_f32_16x16x32_bf16 v[208:211], v[76:79], v[100:103], v[208:211]
ds_read_b128 a[132:135], v2 offset:17408
v_cvt_pk_bf16_f32 v67, v158, v159
v_mfma_f32_16x16x32_bf16 v[208:211], v[72:75], v[96:99], v[208:211]
v_cvt_pk_bf16_f32 v68, v172, v173
v_cvt_pk_bf16_f32 v69, v174, v175
v_mfma_f32_16x16x32_bf16 v[224:227], v[80:83], v[96:99], v[224:227]
ds_read_b128 a[136:139], v2 offset:18432
v_cvt_pk_bf16_f32 v70, v188, v189
v_mfma_f32_16x16x32_bf16 v[224:227], v[84:87], v[100:103], v[224:227]
v_cvt_pk_bf16_f32 v71, v190, v191
v_mfma_f32_16x16x32_bf16 v[228:231], v[84:87], v[108:111], v[228:231]
ds_read_b128 a[140:143], v2 offset:19456
v_mfma_f32_16x16x32_bf16 v[228:231], v[80:83], v[104:107], v[228:231]
v_mfma_f32_16x16x32_bf16 v[232:235], v[80:83], v[112:115], v[232:235]
ds_read_b128 a[144:147], v2 offset:20480
v_cvt_pk_bf16_f32 v72, v204, v205
v_mfma_f32_16x16x32_bf16 v[232:235], v[84:87], v[116:119], v[232:235]
v_cvt_pk_bf16_f32 v73, v206, v207
v_cvt_pk_bf16_f32 v74, v220, v221
v_mfma_f32_16x16x32_bf16 v[236:239], v[84:87], v[124:127], v[236:239]
ds_read_b128 a[148:151], v2 offset:21504
v_cvt_pk_bf16_f32 v75, v222, v223
v_mfma_f32_16x16x32_bf16 v[236:239], v[80:83], v[120:123], v[236:239]
v_cvt_pk_bf16_f32 v56, v200, v201
v_cvt_pk_bf16_f32 v57, v202, v203
v_mfma_f32_16x16x32_bf16 v[252:255], v[88:91], v[120:123], v[252:255]
ds_read_b128 a[152:155], v2 offset:22528
v_cvt_pk_bf16_f32 v58, v216, v217
v_mfma_f32_16x16x32_bf16 v[252:255], v[92:95], v[124:127], v[252:255]
v_cvt_pk_bf16_f32 v59, v218, v219
v_cvt_pk_bf16_f32 v40, v196, v197
v_mfma_f32_16x16x32_bf16 v[248:251], v[92:95], v[116:119], v[248:251]
ds_read_b128 a[156:159], v2 offset:23552
v_cvt_pk_bf16_f32 v41, v198, v199
v_mfma_f32_16x16x32_bf16 v[248:251], v[88:91], v[112:115], v[248:251]
v_cvt_pk_bf16_f32 v42, v212, v213
v_cvt_pk_bf16_f32 v43, v214, v215
v_mfma_f32_16x16x32_bf16 v[244:247], v[88:91], v[104:107], v[244:247]
v_cvt_pk_bf16_f32 v24, v192, v193
v_cvt_pk_bf16_f32 v25, v194, v195
v_mfma_f32_16x16x32_bf16 v[244:247], v[92:95], v[108:111], v[244:247]
v_cvt_pk_bf16_f32 v26, v208, v209
v_cvt_pk_bf16_f32 v27, v210, v211
v_mfma_f32_16x16x32_bf16 v[240:243], v[92:95], v[100:103], v[240:243]
v_mfma_f32_16x16x32_bf16 v[240:243], v[88:91], v[96:99], v[240:243]
v_cvt_pk_bf16_f32 v76, v236, v237
v_cvt_pk_bf16_f32 v77, v238, v239
v_cvt_pk_bf16_f32 v78, v252, v253
v_cvt_pk_bf16_f32 v79, v254, v255
v_cvt_pk_bf16_f32 v60, v232, v233
v_cvt_pk_bf16_f32 v61, v234, v235
v_cvt_pk_bf16_f32 v62, v248, v249
v_cvt_pk_bf16_f32 v63, v250, v251
v_cvt_pk_bf16_f32 v44, v228, v229
v_cvt_pk_bf16_f32 v45, v230, v231
v_cvt_pk_bf16_f32 v46, v244, v245
v_cvt_pk_bf16_f32 v47, v246, v247
v_cvt_pk_bf16_f32 v28, v224, v225
v_cvt_pk_bf16_f32 v29, v226, v227
v_cvt_pk_bf16_f32 v30, v240, v241
v_cvt_pk_bf16_f32 v31, v242, v243
v_mov_b32 v124, 0xff800000
v_mov_b32 v125, 0xff800000
v_mov_b32 v126, 0xff800000
v_mov_b32 v127, 0xff800000
s_lshl_b32 s84, s60, 2
s_add_u32 s84, s84, s58
s_mov_b32 s86, 0
s_mov_b32 s53, 0
s_lshr_b32 s52, s66, 8
s_and_b32 s52, s52, 31
s_add_u32 s61, s65, s60
s_and_b32 s73, s60, 1
s_lshl_b32 s73, s73, 16
s_add_u32 s77, s73, s64
s_xor_b32 s73, s73, 0x10000
s_mov_b32 s92, s73
s_mul_i32 s62, s58, 4608
s_add_u32 s62, s62, 143104
s_add_u32 s73, s73, 49920
s_cmp_eq_u32 s58, 0
s_cselect_b32 s62, s73, s62
Lattn:
s_mov_b32 s82, 0x10000
s_waitcnt lgkmcnt(0)
v_mfma_f32_16x16x32_bf16 v[136:139], a[128:131], v[48:51], 0
ds_read_b128 a[160:163], v2 offset:24576
v_lshrrev_b32 v240, 4, v0
v_mfma_f32_16x16x32_bf16 v[136:139], a[132:135], v[52:55], v[136:139]
ds_read_b128 a[164:167], v2 offset:25600
v_and_b32 v241, 15, v0
v_mfma_f32_16x16x32_bf16 v[136:139], a[136:139], v[56:59], v[136:139]
ds_read_b128 a[168:171], v2 offset:26624
v_lshlrev_b32 v240, 2, v240
v_mfma_f32_16x16x32_bf16 v[136:139], a[140:143], v[60:63], v[136:139]
ds_read_b128 a[172:175], v2 offset:27648
v_sub_u32 v240, v241, v240
v_mfma_f32_16x16x32_bf16 v[140:143], a[140:143], v[76:79], 0
ds_read_b128 a[176:179], v2 offset:28672
v_mov_b32 v112, 0xff800000
v_mfma_f32_16x16x32_bf16 v[140:143], a[136:139], v[72:75], v[140:143]
ds_read_b128 a[180:183], v2 offset:29696
v_mov_b32 v113, 0xff800000
v_mfma_f32_16x16x32_bf16 v[140:143], a[132:135], v[68:71], v[140:143]
ds_read_b128 a[184:187], v2 offset:30720
v_mov_b32 v114, 0xff800000
v_mfma_f32_16x16x32_bf16 v[140:143], a[128:131], v[64:67], v[140:143]
ds_read_b128 a[188:191], v2 offset:31744
v_mov_b32 v115, 0xff800000
v_mfma_f32_16x16x32_bf16 v[156:159], a[144:147], v[64:67], 0
v_cmp_gt_i32 vcc, 0, v240
v_mov_b32 v120, 0x3f803f80
v_mfma_f32_16x16x32_bf16 v[156:159], a[148:151], v[68:71], v[156:159]
v_cndmask_b32 v116, 0, v112, vcc
v_cmp_gt_i32 vcc, 1, v240
v_mfma_f32_16x16x32_bf16 v[156:159], a[152:155], v[72:75], v[156:159]
v_mov_b32 v121, 0x3f803f80
v_cndmask_b32 v117, 0, v112, vcc
v_mfma_f32_16x16x32_bf16 v[156:159], a[156:159], v[76:79], v[156:159]
v_cmp_gt_i32 vcc, 2, v240
v_mov_b32 v122, 0x3f803f80
v_mfma_f32_16x16x32_bf16 v[152:155], a[156:159], v[60:63], 0
v_cndmask_b32 v118, 0, v112, vcc
v_cmp_gt_i32 vcc, 3, v240
v_mfma_f32_16x16x32_bf16 v[152:155], a[152:155], v[56:59], v[152:155]
v_mov_b32 v123, 0x3f803f80
v_cndmask_b32 v119, 0, v112, vcc
v_mfma_f32_16x16x32_bf16 v[152:155], a[148:151], v[52:55], v[152:155]
v_mov_b32 v228, 0
v_mov_b32 v229, 0
v_mfma_f32_16x16x32_bf16 v[152:155], a[144:147], v[48:51], v[152:155]
v_mov_b32 v230, 0
v_mov_b32 v231, 0
s_cmp_eq_u32 s84, 0
s_cbranch_scc1 Lta7
s_cmp_eq_u32 s84, 1
s_cbranch_scc1 Lnt8
v_mfma_f32_16x16x32_bf16 v[128:131], a[128:131], v[16:19], 0
Lstub0:
s_cbranch_execz Lstub4
v_mov_b32 v236, 0
v_mov_b32 v237, 0
v_mfma_f32_16x16x32_bf16 v[144:147], a[144:147], v[16:19], 0
v_mov_b32 v238, 0
v_mov_b32 v239, 0
s_branch Ljoin9
Lta7:
v_mfma_f32_16x16x32_bf16 v[128:131], a[128:131], v[16:19], v[116:119]
v_mov_b32 v236, 0
v_mov_b32 v237, 0
v_mfma_f32_16x16x32_bf16 v[144:147], a[144:147], v[16:19], v[112:115]
v_mov_b32 v238, 0
v_mov_b32 v239, 0
s_branch Ljoin9
Lnt8:
v_mfma_f32_16x16x32_bf16 v[128:131], a[128:131], v[16:19], 0
v_mov_b32 v236, 0
v_mov_b32 v237, 0
v_mfma_f32_16x16x32_bf16 v[144:147], a[144:147], v[16:19], v[116:119]
v_mov_b32 v238, 0
v_mov_b32 v239, 0
Ljoin9:
v_mfma_f32_16x16x32_bf16 v[128:131], a[132:135], v[20:23], v[128:131]
v_mfma_f32_16x16x32_bf16 v[128:131], a[136:139], v[24:27], v[128:131]
v_mfma_f32_16x16x32_bf16 v[128:131], a[140:143], v[28:31], v[128:131]
v_max3_f32 v240, v136, v137, v126
v_max3_f32 v242, v140, v141, v127
v_mfma_f32_16x16x32_bf16 v[132:135], a[140:143], v[44:47], 0
v_max3_f32 v240, v240, v138, v139
v_max3_f32 v242, v242, v142, v143
v_mfma_f32_16x16x32_bf16 v[132:135], a[136:139], v[40:43], v[132:135]
v_max3_f32 v240, v240, v152, v153
v_max3_f32 v242, v242, v156, v157
v_mfma_f32_16x16x32_bf16 v[132:135], a[132:135], v[36:39], v[132:135]
v_max3_f32 v240, v240, v154, v155
v_max3_f32 v242, v242, v158, v159
v_mfma_f32_16x16x32_bf16 v[132:135], a[128:131], v[32:35], v[132:135]
v_mov_b32 v241, v240
v_mov_b32 v243, v242
v_mfma_f32_16x16x32_bf16 v[148:151], a[144:147], v[32:35], 0
v_permlane16_swap_b32 v240, v241
v_permlane16_swap_b32 v242, v243
v_mfma_f32_16x16x32_bf16 v[148:151], a[148:151], v[36:39], v[148:151]
v_max_f32 v240, v240, v241
v_max_f32 v242, v242, v243
v_mfma_f32_16x16x32_bf16 v[148:151], a[152:155], v[40:43], v[148:151]
v_mov_b32 v241, v240
v_mov_b32 v243, v242
v_mfma_f32_16x16x32_bf16 v[148:151], a[156:159], v[44:47], v[148:151]
v_permlane32_swap_b32 v240, v241
v_permlane32_swap_b32 v242, v243
v_mfma_f32_16x16x32_bf16 v[144:147], a[156:159], v[28:31], v[144:147]
v_max_f32 v240, v240, v241
v_max_f32 v242, v242, v243
v_mfma_f32_16x16x32_bf16 v[144:147], a[152:155], v[24:27], v[144:147]
v_mfma_f32_16x16x32_bf16 v[144:147], a[148:151], v[20:23], v[144:147]
v_sub_f32 v88, 0, v240
v_sub_f32 v89, 0, v240
v_pk_add_f32 v[90:91], v[88:89], 0
v_pk_add_f32 v[104:105], v[116:117], v[88:89]
v_pk_add_f32 v[106:107], v[118:119], v[88:89]
v_pk_add_f32 v[136:137], v[136:137], v[88:89]
v_pk_add_f32 v[138:139], v[138:139], v[88:89]
v_pk_add_f32 v[152:153], v[152:153], v[88:89]
v_pk_add_f32 v[154:155], v[154:155], v[88:89]
v_sub_f32 v92, 0, v242
v_sub_f32 v93, 0, v242
v_pk_add_f32 v[94:95], v[92:93], 0
v_pk_add_f32 v[108:109], v[116:117], v[92:93]
v_pk_add_f32 v[110:111], v[118:119], v[92:93]
v_pk_add_f32 v[140:141], v[140:141], v[92:93]
v_pk_add_f32 v[142:143], v[142:143], v[92:93]
v_pk_add_f32 v[156:157], v[156:157], v[92:93]
v_pk_add_f32 v[158:159], v[158:159], v[92:93]
v_max3_f32 v240, v128, v129, v124
v_max3_f32 v242, v132, v133, v125
v_max3_f32 v240, v240, v130, v131
v_max3_f32 v242, v242, v134, v135
v_max3_f32 v240, v240, v144, v145
v_max3_f32 v242, v242, v148, v149
v_max3_f32 v240, v240, v146, v147
v_max3_f32 v242, v242, v150, v151
v_mov_b32 v241, v240
v_mov_b32 v243, v242
s_nop 0
v_permlane16_swap_b32 v240, v241
v_permlane16_swap_b32 v242, v243
v_max_f32 v240, v240, v241
v_max_f32 v242, v242, v243
v_mov_b32 v241, v240
v_mov_b32 v243, v242
s_nop 0
v_permlane32_swap_b32 v240, v241
v_permlane32_swap_b32 v242, v243
v_max_f32 v240, v240, v241
v_max_f32 v242, v242, v243
v_sub_f32 v80, 0, v240
v_sub_f32 v81, 0, v240
v_pk_add_f32 v[82:83], v[80:81], 0
v_pk_add_f32 v[96:97], v[116:117], v[80:81]
v_pk_add_f32 v[98:99], v[118:119], v[80:81]
v_pk_add_f32 v[128:129], v[128:129], v[80:81]
v_pk_add_f32 v[130:131], v[130:131], v[80:81]
v_pk_add_f32 v[144:145], v[144:145], v[80:81]
v_pk_add_f32 v[146:147], v[146:147], v[80:81]
v_sub_f32 v84, 0, v242
v_sub_f32 v85, 0, v242
v_pk_add_f32 v[86:87], v[84:85], 0
v_pk_add_f32 v[100:101], v[116:117], v[84:85]
v_pk_add_f32 v[102:103], v[118:119], v[84:85]
v_pk_add_f32 v[132:133], v[132:133], v[84:85]
v_pk_add_f32 v[134:135], v[134:135], v[84:85]
v_pk_add_f32 v[148:149], v[148:149], v[84:85]
v_pk_add_f32 v[150:151], v[150:151], v[84:85]
v_add_u32 v2, s82, v1
s_waitcnt vmcnt(13) lgkmcnt(0)
s_barrier
s_cmp_eq_u32 s60, 0
s_cbranch_scc1 LP0x
v_mfma_f32_16x16x32_bf16 v[164:167], a[160:163], v[32:35], v[84:87]
s_xor_b32 s74, s82, 0x10000
v_exp_f32 v128, v128
v_mfma_f32_16x16x32_bf16 v[164:167], a[164:167], v[36:39], v[164:167]
s_add_u32 s74, s74, s64
ds_read_b128 a[128:131], v2 offset:16384
ds_read_b128 a[132:135], v2 offset:17408
v_mfma_f32_16x16x32_bf16 v[164:167], a[168:171], v[40:43], v[164:167]
s_add_u32 s81, s81, 0x8000
v_exp_f32 v129, v129
v_mfma_f32_16x16x32_bf16 v[164:167], a[172:175], v[44:47], v[164:167]
s_add_u32 m0, s74, 16384
v_exp_f32 v130, v130
v_mfma_f32_16x16x32_bf16 v[172:175], a[172:175], v[76:79], v[92:95]
s_add_u32 s72, s81, 16384
v_exp_f32 v131, v131
v_mfma_f32_16x16x32_bf16 v[172:175], a[168:171], v[72:75], v[172:175]
v_exp_f32 v144, v144
v_mfma_f32_16x16x32_bf16 v[172:175], a[164:167], v[68:71], v[172:175]
s_nop 0
ds_read_b128 a[136:139], v2 offset:18432
ds_read_b128 a[140:143], v2 offset:19456
v_mfma_f32_16x16x32_bf16 v[172:175], a[160:163], v[64:67], v[172:175]
s_nop 0
ds_read_b128 a[144:147], v2 offset:20480
ds_read_b128 a[148:151], v2 offset:21504
v_mfma_f32_16x16x32_bf16 v[188:191], a[176:179], v[64:67], v[92:95]
s_nop 0
ds_read_b128 a[152:155], v2 offset:22528
ds_read_b128 a[156:159], v2 offset:23552
v_mfma_f32_16x16x32_bf16 v[188:191], a[180:183], v[68:71], v[188:191]
s_nop 0
ds_read_b128 a[192:195], v2 offset:0
ds_read_b128 a[196:199], v2 offset:1024
v_mfma_f32_16x16x32_bf16 v[188:191], a[184:187], v[72:75], v[188:191]
s_nop 0
ds_read_b128 a[200:203], v2 offset:2048
ds_read_b128 a[204:207], v2 offset:3072
v_mfma_f32_16x16x32_bf16 v[188:191], a[188:191], v[76:79], v[188:191]
s_nop 0
ds_read_b128 a[208:211], v2 offset:4096
ds_read_b128 a[212:215], v2 offset:5120
v_mfma_f32_16x16x32_bf16 v[180:183], a[188:191], v[44:47], v[84:87]
s_nop 0
ds_read_b128 a[216:219], v2 offset:6144
ds_read_b128 a[220:223], v2 offset:7168
v_mfma_f32_16x16x32_bf16 v[180:183], a[184:187], v[40:43], v[180:183]
v_cvt_pk_bf16_f32 v192, v128, v129
v_cvt_pk_bf16_f32 v193, v130, v131
v_mfma_f32_16x16x32_bf16 v[180:183], a[180:183], v[36:39], v[180:183]
buffer_load_dwordx4 v1, s[44:47], s72 offen sc1 lds
v_mfma_f32_16x16x32_bf16 v[180:183], a[176:179], v[32:35], v[180:183]
v_exp_f32 v145, v145
v_mfma_f32_16x16x32_bf16 v[160:163], a[160:163], v[16:19], v[80:83]
v_exp_f32 v146, v146
v_mfma_f32_16x16x32_bf16 v[160:163], a[164:167], v[20:23], v[160:163]
v_exp_f32 v147, v147
v_mfma_f32_16x16x32_bf16 v[160:163], a[168:171], v[24:27], v[160:163]
v_exp_f32 v136, v136
v_mfma_f32_16x16x32_bf16 v[160:163], a[172:175], v[28:31], v[160:163]
v_cvt_pk_bf16_f32 v194, v144, v145
v_cvt_pk_bf16_f32 v195, v146, v147
v_mfma_f32_16x16x32_bf16 v[168:171], a[172:175], v[60:63], v[88:91]
v_exp_f32 v137, v137
v_mfma_f32_16x16x32_bf16 v[168:171], a[168:171], v[56:59], v[168:171]
v_exp_f32 v138, v138
v_mfma_f32_16x16x32_bf16 v[168:171], a[164:167], v[52:55], v[168:171]
v_exp_f32 v139, v139
v_mfma_f32_16x16x32_bf16 v[168:171], a[160:163], v[48:51], v[168:171]
v_exp_f32 v152, v152
v_mfma_f32_16x16x32_bf16 v[184:187], a[176:179], v[48:51], v[88:91]
v_cvt_pk_bf16_f32 v200, v136, v137
v_cvt_pk_bf16_f32 v201, v138, v139
v_mfma_f32_16x16x32_bf16 v[184:187], a[180:183], v[52:55], v[184:187]
buffer_load_dwordx4 v1, s[44:47], s72 offen offset:1024 sc1 lds
v_mfma_f32_16x16x32_bf16 v[184:187], a[184:187], v[56:59], v[184:187]
v_exp_f32 v153, v153
v_mfma_f32_16x16x32_bf16 v[184:187], a[188:191], v[60:63], v[184:187]
v_exp_f32 v154, v154
v_mfma_f32_16x16x32_bf16 v[176:179], a[188:191], v[28:31], v[80:83]
v_exp_f32 v155, v155
v_mfma_f32_16x16x32_bf16 v[176:179], a[184:187], v[24:27], v[176:179]
buffer_load_dwordx4 v1, s[44:47], s72 offen offset:2048 sc1 lds
v_mfma_f32_16x16x32_bf16 v[176:179], a[180:183], v[20:23], v[176:179]
buffer_load_dwordx4 v1, s[44:47], s72 offen offset:3072 sc1 lds
v_mfma_f32_16x16x32_bf16 v[176:179], a[176:179], v[16:19], v[176:179]
s_waitcnt lgkmcnt(4)
v_exp_f32 v132, v132
v_cvt_pk_bf16_f32 v202, v152, v153
v_cvt_pk_bf16_f32 v203, v154, v155
v_exp_f32 v133, v133
v_exp_f32 v134, v134
v_cvt_pk_bf16_f32 v196, v132, v133
v_exp_f32 v135, v135
v_exp_f32 v148, v148
v_cvt_pk_bf16_f32 v197, v134, v135
v_exp_f32 v149, v149
v_exp_f32 v150, v150
v_cvt_pk_bf16_f32 v198, v148, v149
v_exp_f32 v151, v151
v_exp_f32 v140, v140
v_cvt_pk_bf16_f32 v199, v150, v151
v_exp_f32 v141, v141
v_exp_f32 v142, v142
v_cvt_pk_bf16_f32 v204, v140, v141
v_exp_f32 v143, v143
v_exp_f32 v156, v156
v_cvt_pk_bf16_f32 v205, v142, v143
v_exp_f32 v157, v157
v_exp_f32 v158, v158
v_cvt_pk_bf16_f32 v206, v156, v157
v_exp_f32 v159, v159
s_nop 0
v_cvt_pk_bf16_f32 v207, v158, v159
v_mfma_f32_16x16x32_bf16 v[224:227], v[120:123], v[192:195], 0
s_add_u32 s82, s82, 0x8000
ds_read_b128 a[160:163], v2 offset:24576
ds_read_b128 a[164:167], v2 offset:25600
v_mfma_f32_16x16x32_bf16 v[232:235], v[120:123], v[200:203], 0
s_and_b32 s82, s82, 0x1ffff
v_exp_f32 v164, v164
v_mfma_f32_16x16x32_bf16 a[0:3], a[192:195], v[192:195], 0
s_add_u32 m0, s74, 0
v_exp_f32 v165, v165
v_mfma_f32_16x16x32_bf16 a[64:67], a[192:195], v[200:203], 0
s_add_u32 s72, s81, 0
v_exp_f32 v166, v166
v_mfma_f32_16x16x32_bf16 a[68:71], a[196:199], v[200:203], 0
buffer_load_dwordx4 v1, s[44:47], s72 offen sc1 lds
v_mfma_f32_16x16x32_bf16 a[4:7], a[196:199], v[192:195], 0
v_exp_f32 v167, v167
v_mfma_f32_16x16x32_bf16 a[8:11], a[200:203], v[192:195], 0
ds_read_b128 a[168:171], v2 offset:26624
v_cvt_pk_bf16_f32 v212, v164, v165
v_mfma_f32_16x16x32_bf16 a[72:75], a[200:203], v[200:203], 0
v_exp_f32 v180, v180
v_mfma_f32_16x16x32_bf16 a[76:79], a[204:207], v[200:203], 0
v_exp_f32 v181, v181
v_mfma_f32_16x16x32_bf16 a[12:15], a[204:207], v[192:195], 0
s_waitcnt lgkmcnt(3)
ds_read_b128 a[172:175], v2 offset:27648
v_cvt_pk_bf16_f32 v213, v166, v167
v_mfma_f32_16x16x32_bf16 a[16:19], a[208:211], v[192:195], 0
v_exp_f32 v182, v182
v_mfma_f32_16x16x32_bf16 a[80:83], a[208:211], v[200:203], 0
buffer_load_dwordx4 v1, s[44:47], s72 offen offset:1024 sc1 lds
v_mfma_f32_16x16x32_bf16 a[84:87], a[212:215], v[200:203], 0
v_exp_f32 v183, v183
v_mfma_f32_16x16x32_bf16 a[20:23], a[212:215], v[192:195], 0
s_nop 0
ds_read_b128 a[176:179], v2 offset:28672
ds_read_b128 a[180:183], v2 offset:29696
v_mfma_f32_16x16x32_bf16 a[24:27], a[216:219], v[192:195], 0
v_exp_f32 v172, v172
v_mfma_f32_16x16x32_bf16 a[88:91], a[216:219], v[200:203], 0
s_nop 0
ds_read_b128 a[184:187], v2 offset:30720
ds_read_b128 a[188:191], v2 offset:31744
v_mfma_f32_16x16x32_bf16 a[92:95], a[220:223], v[200:203], 0
s_nop 0
ds_read_b128 a[224:227], v2 offset:8192
ds_read_b128 a[228:231], v2 offset:9216
v_mfma_f32_16x16x32_bf16 a[28:31], a[220:223], v[192:195], 0
s_nop 0
ds_read_b128 a[232:235], v2 offset:10240
ds_read_b128 a[236:239], v2 offset:11264
v_mfma_f32_16x16x32_bf16 v[128:131], a[128:131], v[16:19], v[80:83]
s_nop 0
ds_read_b128 a[240:243], v2 offset:12288
ds_read_b128 a[244:247], v2 offset:13312
v_mfma_f32_16x16x32_bf16 v[128:131], a[132:135], v[20:23], v[128:131]
s_nop 0
ds_read_b128 a[248:251], v2 offset:14336
ds_read_b128 a[252:255], v2 offset:15360
v_mfma_f32_16x16x32_bf16 v[128:131], a[136:139], v[24:27], v[128:131]
v_cvt_pk_bf16_f32 v214, v180, v181
v_cvt_pk_bf16_f32 v215, v182, v183
v_mfma_f32_16x16x32_bf16 v[128:131], a[140:143], v[28:31], v[128:131]
v_exp_f32 v173, v173
v_mfma_f32_16x16x32_bf16 v[136:139], a[140:143], v[60:63], v[88:91]
v_exp_f32 v174, v174
v_mfma_f32_16x16x32_bf16 v[136:139], a[136:139], v[56:59], v[136:139]
buffer_load_dwordx4 v1, s[44:47], s72 offen offset:2048 sc1 lds
v_mfma_f32_16x16x32_bf16 v[136:139], a[132:135], v[52:55], v[136:139]
v_exp_f32 v175, v175
v_mfma_f32_16x16x32_bf16 v[136:139], a[128:131], v[48:51], v[136:139]
v_exp_f32 v188, v188
v_mfma_f32_16x16x32_bf16 v[152:155], a[144:147], v[48:51], v[88:91]
v_cvt_pk_bf16_f32 v220, v172, v173
v_cvt_pk_bf16_f32 v221, v174, v175
v_mfma_f32_16x16x32_bf16 v[152:155], a[148:151], v[52:55], v[152:155]
v_exp_f32 v189, v189
v_mfma_f32_16x16x32_bf16 v[152:155], a[152:155], v[56:59], v[152:155]
v_exp_f32 v190, v190
v_mfma_f32_16x16x32_bf16 v[152:155], a[156:159], v[60:63], v[152:155]
buffer_load_dwordx4 v1, s[44:47], s72 offen offset:3072 sc1 lds
v_mfma_f32_16x16x32_bf16 v[144:147], a[156:159], v[28:31], v[80:83]
s_add_u32 s66, s58, 1
v_exp_f32 v191, v191
v_mfma_f32_16x16x32_bf16 v[144:147], a[152:155], v[24:27], v[144:147]
s_and_b32 s66, s66, 3
v_exp_f32 v160, v160
v_mfma_f32_16x16x32_bf16 v[144:147], a[148:151], v[20:23], v[144:147]
s_mul_i32 s66, s66, 4160
v_cvt_pk_bf16_f32 v222, v188, v189
v_cvt_pk_bf16_f32 v223, v190, v191
v_mfma_f32_16x16x32_bf16 v[144:147], a[144:147], v[16:19], v[144:147]
s_add_u32 m0, s66, 131104
v_exp_f32 v161, v161
v_mfma_f32_16x16x32_bf16 v[132:135], a[128:131], v[32:35], v[84:87]
s_add_u32 s72, s93, 0x2
buffer_load_dwordx4 v1, s[36:39], s72 offen lds
v_mfma_f32_16x16x32_bf16 v[132:135], a[132:135], v[36:39], v[132:135]
v_exp_f32 v162, v162
v_mfma_f32_16x16x32_bf16 v[132:135], a[136:139], v[40:43], v[132:135]
v_exp_f32 v163, v163
v_mfma_f32_16x16x32_bf16 v[132:135], a[140:143], v[44:47], v[132:135]
v_exp_f32 v176, v176
v_mfma_f32_16x16x32_bf16 v[140:143], a[140:143], v[76:79], v[92:95]
v_cvt_pk_bf16_f32 v208, v160, v161
v_cvt_pk_bf16_f32 v209, v162, v163
v_mfma_f32_16x16x32_bf16 v[140:143], a[136:139], v[72:75], v[140:143]
v_exp_f32 v177, v177
v_mfma_f32_16x16x32_bf16 v[140:143], a[132:135], v[68:71], v[140:143]
buffer_load_dwordx4 v1, s[36:39], s72 offen offset:1024 lds
v_mfma_f32_16x16x32_bf16 v[140:143], a[128:131], v[64:67], v[140:143]
v_exp_f32 v178, v178
v_mfma_f32_16x16x32_bf16 v[156:159], a[144:147], v[64:67], v[92:95]
v_exp_f32 v179, v179
v_mfma_f32_16x16x32_bf16 v[156:159], a[148:151], v[68:71], v[156:159]
v_exp_f32 v168, v168
v_mfma_f32_16x16x32_bf16 v[156:159], a[152:155], v[72:75], v[156:159]
v_cvt_pk_bf16_f32 v210, v176, v177
v_cvt_pk_bf16_f32 v211, v178, v179
v_mfma_f32_16x16x32_bf16 v[156:159], a[156:159], v[76:79], v[156:159]
v_exp_f32 v169, v169
v_mfma_f32_16x16x32_bf16 v[148:151], a[156:159], v[44:47], v[84:87]
buffer_load_dwordx4 v1, s[36:39], s72 offen offset:2048 lds
v_mfma_f32_16x16x32_bf16 v[148:151], a[152:155], v[40:43], v[148:151]
buffer_load_dwordx4 v1, s[36:39], s72 offen offset:3072 lds
v_mfma_f32_16x16x32_bf16 v[148:151], a[148:151], v[36:39], v[148:151]
s_waitcnt vmcnt(12) lgkmcnt(4)
v_exp_f32 v170, v170
v_mfma_f32_16x16x32_bf16 v[148:151], a[144:147], v[32:35], v[148:151]
s_barrier
v_exp_f32 v171, v171
v_add_u32 v2, s82, v1
v_cvt_pk_bf16_f32 v216, v168, v169
v_exp_f32 v184, v184
v_cvt_pk_bf16_f32 v217, v170, v171
v_exp_f32 v185, v185
v_exp_f32 v186, v186
v_cvt_pk_bf16_f32 v218, v184, v185
v_exp_f32 v187, v187
s_nop 0
v_cvt_pk_bf16_f32 v219, v186, v187
s_lshl_b32 s75, s59, 4
s_and_b32 s76, s84, 15
s_add_u32 s75, s75, s76
s_lshl_b32 s75, s75, 14
s_cmp_ge_u32 s60, 4
s_cselect_b32 s75, s75, 0x40001000
s_lshl_b32 s83, s60, 1
s_sub_u32 s83, 2, s83
s_cmp_eq_u32 s83, 0
s_cbranch_scc1 LLT1
.p2align 5
s_nop 0
s_nop 0
LloopI:
v_mfma_f32_16x16x32_bf16 v[228:231], v[120:123], v[196:199], v[228:231]
s_xor_b32 s74, s82, 0x10000
v_exp_f32 v128, v128
v_mfma_f32_16x16x32_bf16 v[228:231], v[120:123], v[212:215], v[228:231]
s_add_u32 s74, s74, s64
ds_read_b128 a[128:131], v2 offset:16384
v_add_u32 v15, s75, v3
v_mfma_f32_16x16x32_bf16 v[236:239], v[120:123], v[204:207], v[236:239]
s_add_u32 s81, s81, 0x8000
v_exp_f32 v129, v129
v_mfma_f32_16x16x32_bf16 v[236:239], v[120:123], v[220:223], v[236:239]
s_add_u32 m0, s74, 16384
v_exp_f32 v130, v130
v_mfma_f32_16x16x32_bf16 a[32:35], a[192:195], v[196:199], a[32:35]
s_add_u32 s72, s81, 16384
ds_read_b128 a[132:135], v2 offset:17408
v_cvt_pk_bf16_f32 v192, v128, v129
v_mfma_f32_16x16x32_bf16 a[32:35], a[224:227], v[212:215], a[32:35]
v_exp_f32 v131, v131
v_mfma_f32_16x16x32_bf16 a[96:99], a[224:227], v[220:223], a[96:99]
v_exp_f32 v144, v144
v_mfma_f32_16x16x32_bf16 a[96:99], a[192:195], v[204:207], a[96:99]
ds_read_b128 a[136:139], v2 offset:18432
v_cvt_pk_bf16_f32 v193, v130, v131
v_mfma_f32_16x16x32_bf16 a[100:103], a[196:199], v[204:207], a[100:103]
buffer_load_dwordx4 v1, s[44:47], s72 offen sc1 lds
v_mfma_f32_16x16x32_bf16 a[100:103], a[228:231], v[220:223], a[100:103]
v_exp_f32 v145, v145
v_mfma_f32_16x16x32_bf16 a[36:39], a[228:231], v[212:215], a[36:39]
v_exp_f32 v146, v146
v_mfma_f32_16x16x32_bf16 a[36:39], a[196:199], v[196:199], a[36:39]
ds_read_b128 a[140:143], v2 offset:19456
v_cvt_pk_bf16_f32 v194, v144, v145
v_mfma_f32_16x16x32_bf16 a[40:43], a[200:203], v[196:199], a[40:43]
v_exp_f32 v147, v147
v_mfma_f32_16x16x32_bf16 a[40:43], a[232:235], v[212:215], a[40:43]
v_exp_f32 v136, v136
v_mfma_f32_16x16x32_bf16 a[104:107], a[232:235], v[220:223], a[104:107]
ds_read_b128 a[144:147], v2 offset:20480
v_cvt_pk_bf16_f32 v195, v146, v147
v_mfma_f32_16x16x32_bf16 a[104:107], a[200:203], v[204:207], a[104:107]
v_exp_f32 v137, v137
v_mfma_f32_16x16x32_bf16 a[108:111], a[204:207], v[204:207], a[108:111]
v_exp_f32 v138, v138
v_mfma_f32_16x16x32_bf16 a[108:111], a[236:239], v[220:223], a[108:111]
ds_read_b128 a[148:151], v2 offset:21504
v_cvt_pk_bf16_f32 v200, v136, v137
v_mfma_f32_16x16x32_bf16 a[44:47], a[236:239], v[212:215], a[44:47]
v_exp_f32 v139, v139
v_mfma_f32_16x16x32_bf16 a[44:47], a[204:207], v[196:199], a[44:47]
v_exp_f32 v152, v152
v_mfma_f32_16x16x32_bf16 a[48:51], a[208:211], v[196:199], a[48:51]
s_waitcnt lgkmcnt(6)
ds_read_b128 a[152:155], v2 offset:22528
v_cvt_pk_bf16_f32 v201, v138, v139
v_mfma_f32_16x16x32_bf16 a[48:51], a[240:243], v[212:215], a[48:51]
buffer_load_dwordx4 v1, s[44:47], s72 offen offset:1024 sc1 lds
v_mfma_f32_16x16x32_bf16 a[112:115], a[240:243], v[220:223], a[112:115]
v_exp_f32 v153, v153
v_mfma_f32_16x16x32_bf16 a[112:115], a[208:211], v[204:207], a[112:115]
v_exp_f32 v154, v154
v_mfma_f32_16x16x32_bf16 a[116:119], a[212:215], v[204:207], a[116:119]
ds_read_b128 a[156:159], v2 offset:23552
v_cvt_pk_bf16_f32 v202, v152, v153
v_mfma_f32_16x16x32_bf16 a[116:119], a[244:247], v[220:223], a[116:119]
v_exp_f32 v155, v155
v_mfma_f32_16x16x32_bf16 a[52:55], a[244:247], v[212:215], a[52:55]
v_exp_f32 v132, v132
v_mfma_f32_16x16x32_bf16 a[52:55], a[212:215], v[196:199], a[52:55]
ds_read_b128 a[192:195], v2 offset:0
v_cvt_pk_bf16_f32 v203, v154, v155
v_mfma_f32_16x16x32_bf16 a[56:59], a[216:219], v[196:199], a[56:59]
v_exp_f32 v133, v133
v_mfma_f32_16x16x32_bf16 a[56:59], a[248:251], v[212:215], a[56:59]
v_exp_f32 v134, v134
v_mfma_f32_16x16x32_bf16 a[120:123], a[248:251], v[220:223], a[120:123]
ds_read_b128 a[196:199], v2 offset:1024
v_mfma_f32_16x16x32_bf16 a[120:123], a[216:219], v[204:207], a[120:123]
v_exp_f32 v135, v135
v_mfma_f32_16x16x32_bf16 a[124:127], a[220:223], v[204:207], a[124:127]
v_exp_f32 v148, v148
v_mfma_f32_16x16x32_bf16 a[124:127], a[252:255], v[220:223], a[124:127]
ds_read_b128 a[200:203], v2 offset:2048
v_mfma_f32_16x16x32_bf16 a[60:63], a[252:255], v[212:215], a[60:63]
buffer_load_dwordx4 v1, s[44:47], s72 offen offset:2048 sc1 lds
v_mfma_f32_16x16x32_bf16 a[60:63], a[220:223], v[196:199], a[60:63]
ds_read_b128 a[204:207], v2 offset:3072
v_cvt_pk_bf16_f32 v196, v132, v133
v_mfma_f32_16x16x32_bf16 v[164:167], a[160:163], v[32:35], v[84:87]
v_exp_f32 v149, v149
v_mfma_f32_16x16x32_bf16 v[164:167], a[164:167], v[36:39], v[164:167]
v_exp_f32 v150, v150
v_mfma_f32_16x16x32_bf16 v[164:167], a[168:171], v[40:43], v[164:167]
ds_read_b128 a[208:211], v2 offset:4096
v_cvt_pk_bf16_f32 v197, v134, v135
v_mfma_f32_16x16x32_bf16 v[164:167], a[172:175], v[44:47], v[164:167]
v_exp_f32 v151, v151
v_mfma_f32_16x16x32_bf16 v[172:175], a[172:175], v[76:79], v[92:95]
v_exp_f32 v140, v140
v_mfma_f32_16x16x32_bf16 v[172:175], a[168:171], v[72:75], v[172:175]
ds_read_b128 a[212:215], v2 offset:5120
v_cvt_pk_bf16_f32 v198, v148, v149
v_mfma_f32_16x16x32_bf16 v[172:175], a[164:167], v[68:71], v[172:175]
v_exp_f32 v141, v141
v_mfma_f32_16x16x32_bf16 v[172:175], a[160:163], v[64:67], v[172:175]
v_exp_f32 v142, v142
v_mfma_f32_16x16x32_bf16 v[188:191], a[176:179], v[64:67], v[92:95]
ds_read_b128 a[216:219], v2 offset:6144
v_cvt_pk_bf16_f32 v199, v150, v151
v_mfma_f32_16x16x32_bf16 v[188:191], a[180:183], v[68:71], v[188:191]
v_exp_f32 v143, v143
v_mfma_f32_16x16x32_bf16 v[188:191], a[184:187], v[72:75], v[188:191]
v_exp_f32 v156, v156
v_mfma_f32_16x16x32_bf16 v[188:191], a[188:191], v[76:79], v[188:191]
ds_read_b128 a[220:223], v2 offset:7168
v_cvt_pk_bf16_f32 v204, v140, v141
v_mfma_f32_16x16x32_bf16 v[180:183], a[188:191], v[44:47], v[84:87]
buffer_load_dwordx4 v1, s[44:47], s72 offen offset:3072 sc1 lds
v_mfma_f32_16x16x32_bf16 v[180:183], a[184:187], v[40:43], v[180:183]
v_exp_f32 v157, v157
v_mfma_f32_16x16x32_bf16 v[180:183], a[180:183], v[36:39], v[180:183]
v_exp_f32 v158, v158
v_mfma_f32_16x16x32_bf16 v[180:183], a[176:179], v[32:35], v[180:183]
v_cvt_pk_bf16_f32 v205, v142, v143
v_cvt_pk_bf16_f32 v206, v156, v157
v_mfma_f32_16x16x32_bf16 v[160:163], a[160:163], v[16:19], v[80:83]
v_exp_f32 v159, v159
v_mfma_f32_16x16x32_bf16 v[160:163], a[164:167], v[20:23], v[160:163]
v_cvt_pk_bf16_f32 v207, v158, v159
v_mfma_f32_16x16x32_bf16 v[160:163], a[168:171], v[24:27], v[160:163]
v_mfma_f32_16x16x32_bf16 v[160:163], a[172:175], v[28:31], v[160:163]
v_mfma_f32_16x16x32_bf16 v[168:171], a[172:175], v[60:63], v[88:91]
v_mfma_f32_16x16x32_bf16 v[168:171], a[168:171], v[56:59], v[168:171]
v_mfma_f32_16x16x32_bf16 v[168:171], a[164:167], v[52:55], v[168:171]
v_mfma_f32_16x16x32_bf16 v[168:171], a[160:163], v[48:51], v[168:171]
v_mfma_f32_16x16x32_bf16 v[184:187], a[176:179], v[48:51], v[88:91]
v_mfma_f32_16x16x32_bf16 v[184:187], a[180:183], v[52:55], v[184:187]
v_mfma_f32_16x16x32_bf16 v[184:187], a[184:187], v[56:59], v[184:187]
v_mfma_f32_16x16x32_bf16 v[184:187], a[188:191], v[60:63], v[184:187]
v_mfma_f32_16x16x32_bf16 v[176:179], a[188:191], v[28:31], v[80:83]
v_mfma_f32_16x16x32_bf16 v[176:179], a[184:187], v[24:27], v[176:179]
v_mfma_f32_16x16x32_bf16 v[176:179], a[180:183], v[20:23], v[176:179]
v_mfma_f32_16x16x32_bf16 v[176:179], a[176:179], v[16:19], v[176:179]
s_waitcnt lgkmcnt(4)
v_mfma_f32_16x16x32_bf16 v[224:227], v[120:123], v[208:211], v[224:227]
s_add_u32 s82, s82, 0x8000
ds_read_b128 a[160:163], v2 offset:24576
v_mfma_f32_16x16x32_bf16 v[224:227], v[120:123], v[192:195], v[224:227]
s_and_b32 s82, s82, 0x1ffff
v_exp_f32 v164, v164
v_mfma_f32_16x16x32_bf16 v[232:235], v[120:123], v[216:219], v[232:235]
s_add_u32 m0, s74, 0
v_exp_f32 v165, v165
v_mfma_f32_16x16x32_bf16 v[232:235], v[120:123], v[200:203], v[232:235]
s_add_u32 s72, s81, 0
ds_read_b128 a[164:167], v2 offset:25600
v_cvt_pk_bf16_f32 v212, v164, v165
v_mfma_f32_16x16x32_bf16 a[0:3], a[224:227], v[208:211], a[0:3]
v_exp_f32 v166, v166
v_mfma_f32_16x16x32_bf16 a[0:3], a[192:195], v[192:195], a[0:3]
v_exp_f32 v167, v167
v_mfma_f32_16x16x32_bf16 a[64:67], a[192:195], v[200:203], a[64:67]
buffer_load_dwordx4 v1, s[44:47], s72 offen sc1 lds
v_mfma_f32_16x16x32_bf16 a[64:67], a[224:227], v[216:219], a[64:67]
ds_read_b128 a[168:171], v2 offset:26624
v_cvt_pk_bf16_f32 v213, v166, v167
v_mfma_f32_16x16x32_bf16 a[68:71], a[228:231], v[216:219], a[68:71]
v_exp_f32 v180, v180
v_mfma_f32_16x16x32_bf16 a[68:71], a[196:199], v[200:203], a[68:71]
v_exp_f32 v181, v181
v_mfma_f32_16x16x32_bf16 a[4:7], a[196:199], v[192:195], a[4:7]
ds_read_b128 a[172:175], v2 offset:27648
v_cvt_pk_bf16_f32 v214, v180, v181
v_mfma_f32_16x16x32_bf16 a[4:7], a[228:231], v[208:211], a[4:7]
v_exp_f32 v182, v182
v_mfma_f32_16x16x32_bf16 a[8:11], a[232:235], v[208:211], a[8:11]
v_exp_f32 v183, v183
v_mfma_f32_16x16x32_bf16 a[8:11], a[200:203], v[192:195], a[8:11]
ds_read_b128 a[176:179], v2 offset:28672
v_cvt_pk_bf16_f32 v215, v182, v183
v_mfma_f32_16x16x32_bf16 a[72:75], a[200:203], v[200:203], a[72:75]
v_exp_f32 v172, v172
v_mfma_f32_16x16x32_bf16 a[72:75], a[232:235], v[216:219], a[72:75]
v_exp_f32 v173, v173
v_mfma_f32_16x16x32_bf16 a[76:79], a[236:239], v[216:219], a[76:79]
ds_read_b128 a[180:183], v2 offset:29696
v_cvt_pk_bf16_f32 v220, v172, v173
v_mfma_f32_16x16x32_bf16 a[76:79], a[204:207], v[200:203], a[76:79]
buffer_load_dwordx4 v1, s[44:47], s72 offen offset:1024 sc1 lds
v_mfma_f32_16x16x32_bf16 a[12:15], a[204:207], v[192:195], a[12:15]
v_exp_f32 v174, v174
v_mfma_f32_16x16x32_bf16 a[12:15], a[236:239], v[208:211], a[12:15]
v_exp_f32 v175, v175
v_mfma_f32_16x16x32_bf16 a[16:19], a[240:243], v[208:211], a[16:19]
s_waitcnt lgkmcnt(6)
ds_read_b128 a[184:187], v2 offset:30720
v_cvt_pk_bf16_f32 v221, v174, v175
v_mfma_f32_16x16x32_bf16 a[16:19], a[208:211], v[192:195], a[16:19]
v_exp_f32 v188, v188
v_mfma_f32_16x16x32_bf16 a[80:83], a[208:211], v[200:203], a[80:83]
v_exp_f32 v189, v189
v_mfma_f32_16x16x32_bf16 a[80:83], a[240:243], v[216:219], a[80:83]
ds_read_b128 a[188:191], v2 offset:31744
v_cvt_pk_bf16_f32 v222, v188, v189
v_mfma_f32_16x16x32_bf16 a[84:87], a[244:247], v[216:219], a[84:87]
v_exp_f32 v190, v190
v_mfma_f32_16x16x32_bf16 a[84:87], a[212:215], v[200:203], a[84:87]
v_exp_f32 v191, v191
v_mfma_f32_16x16x32_bf16 a[20:23], a[212:215], v[192:195], a[20:23]
ds_read_b128 a[224:227], v2 offset:8192
v_cvt_pk_bf16_f32 v223, v190, v191
v_mfma_f32_16x16x32_bf16 a[20:23], a[244:247], v[208:211], a[20:23]
v_exp_f32 v160, v160
v_mfma_f32_16x16x32_bf16 a[24:27], a[248:251], v[208:211], a[24:27]
buffer_load_dwordx4 v1, s[44:47], s72 offen offset:2048 sc1 lds
v_mfma_f32_16x16x32_bf16 a[24:27], a[216:219], v[192:195], a[24:27]
v_exp_f32 v161, v161
v_mfma_f32_16x16x32_bf16 a[88:91], a[216:219], v[200:203], a[88:91]
ds_read_b128 a[228:231], v2 offset:9216
v_mfma_f32_16x16x32_bf16 a[88:91], a[248:251], v[216:219], a[88:91]
v_exp_f32 v162, v162
v_mfma_f32_16x16x32_bf16 a[92:95], a[252:255], v[216:219], a[92:95]
v_exp_f32 v163, v163
v_mfma_f32_16x16x32_bf16 a[92:95], a[220:223], v[200:203], a[92:95]
ds_read_b128 a[232:235], v2 offset:10240
v_mfma_f32_16x16x32_bf16 a[28:31], a[220:223], v[192:195], a[28:31]
v_exp_f32 v176, v176
v_mfma_f32_16x16x32_bf16 a[28:31], a[252:255], v[208:211], a[28:31]
ds_read_b128 a[236:239], v2 offset:11264
v_cvt_pk_bf16_f32 v208, v160, v161
v_mfma_f32_16x16x32_bf16 v[128:131], a[128:131], v[16:19], v[80:83]
v_exp_f32 v177, v177
v_mfma_f32_16x16x32_bf16 v[128:131], a[132:135], v[20:23], v[128:131]
v_exp_f32 v178, v178
v_mfma_f32_16x16x32_bf16 v[128:131], a[136:139], v[24:27], v[128:131]
Lstub1:
s_cbranch_execz Lstub5
ds_read_b128 a[240:243], v2 offset:12288
v_cvt_pk_bf16_f32 v209, v162, v163
v_mfma_f32_16x16x32_bf16 v[128:131], a[140:143], v[28:31], v[128:131]
buffer_load_dwordx4 v1, s[44:47], s72 offen offset:3072 sc1 lds
v_mfma_f32_16x16x32_bf16 v[136:139], a[140:143], v[60:63], v[88:91]
s_add_u32 s75, s75, 0x1000
v_exp_f32 v179, v179
v_mfma_f32_16x16x32_bf16 v[136:139], a[136:139], v[56:59], v[136:139]
s_and_b32 s76, s75, 0x3000
v_exp_f32 v168, v168
v_mfma_f32_16x16x32_bf16 v[136:139], a[132:135], v[52:55], v[136:139]
s_cselect_b32 s75, s75, 0x40001000
ds_read_b128 a[244:247], v2 offset:13312
v_cvt_pk_bf16_f32 v210, v176, v177
v_mfma_f32_16x16x32_bf16 v[136:139], a[128:131], v[48:51], v[136:139]
v_exp_f32 v169, v169
v_mfma_f32_16x16x32_bf16 v[152:155], a[144:147], v[48:51], v[88:91]
v_exp_f32 v170, v170
v_mfma_f32_16x16x32_bf16 v[152:155], a[148:151], v[52:55], v[152:155]
ds_read_b128 a[248:251], v2 offset:14336
v_cvt_pk_bf16_f32 v211, v178, v179
v_mfma_f32_16x16x32_bf16 v[152:155], a[152:155], v[56:59], v[152:155]
v_exp_f32 v171, v171
v_mfma_f32_16x16x32_bf16 v[152:155], a[156:159], v[60:63], v[152:155]
v_exp_f32 v184, v184
v_mfma_f32_16x16x32_bf16 v[144:147], a[156:159], v[28:31], v[80:83]
ds_read_b128 a[252:255], v2 offset:15360
v_cvt_pk_bf16_f32 v216, v168, v169
v_mfma_f32_16x16x32_bf16 v[144:147], a[152:155], v[24:27], v[144:147]
buffer_load_dword v4, v15, s[24:27], 0 offen
v_mfma_f32_16x16x32_bf16 v[144:147], a[148:151], v[20:23], v[144:147]
v_exp_f32 v185, v185
v_mfma_f32_16x16x32_bf16 v[144:147], a[144:147], v[16:19], v[144:147]
v_exp_f32 v186, v186
v_mfma_f32_16x16x32_bf16 v[132:135], a[128:131], v[32:35], v[84:87]
v_cvt_pk_bf16_f32 v217, v170, v171
v_cvt_pk_bf16_f32 v218, v184, v185
v_mfma_f32_16x16x32_bf16 v[132:135], a[132:135], v[36:39], v[132:135]
v_exp_f32 v187, v187
v_mfma_f32_16x16x32_bf16 v[132:135], a[136:139], v[40:43], v[132:135]
v_cvt_pk_bf16_f32 v219, v186, v187
v_add_u32 v2, s82, v1
v_mfma_f32_16x16x32_bf16 v[132:135], a[140:143], v[44:47], v[132:135]
v_mfma_f32_16x16x32_bf16 v[140:143], a[140:143], v[76:79], v[92:95]
v_mfma_f32_16x16x32_bf16 v[140:143], a[136:139], v[72:75], v[140:143]
v_mfma_f32_16x16x32_bf16 v[140:143], a[132:135], v[68:71], v[140:143]
v_mfma_f32_16x16x32_bf16 v[140:143], a[128:131], v[64:67], v[140:143]
v_mfma_f32_16x16x32_bf16 v[156:159], a[144:147], v[64:67], v[92:95]
v_mfma_f32_16x16x32_bf16 v[156:159], a[148:151], v[68:71], v[156:159]
v_mfma_f32_16x16x32_bf16 v[156:159], a[152:155], v[72:75], v[156:159]
v_mfma_f32_16x16x32_bf16 v[156:159], a[156:159], v[76:79], v[156:159]
v_mfma_f32_16x16x32_bf16 v[148:151], a[156:159], v[44:47], v[84:87]
s_waitcnt vmcnt(9) lgkmcnt(4)
v_mfma_f32_16x16x32_bf16 v[148:151], a[152:155], v[40:43], v[148:151]
s_barrier
v_mfma_f32_16x16x32_bf16 v[148:151], a[148:151], v[36:39], v[148:151]
s_add_u32 s83, s83, 1
v_mfma_f32_16x16x32_bf16 v[148:151], a[144:147], v[32:35], v[148:151]
s_cbranch_scc0 LloopI
LLT1:
Lstub2:
s_cbranch_execz Lstub6
v_mfma_f32_16x16x32_bf16 v[228:231], v[120:123], v[196:199], v[228:231]
s_xor_b32 s74, s82, 0x10000
v_exp_f32 v128, v128
v_mfma_f32_16x16x32_bf16 v[228:231], v[120:123], v[212:215], v[228:231]
s_add_u32 s74, s74, s64
ds_read_b128 a[128:131], v2 offset:16384
v_mfma_f32_16x16x32_bf16 v[236:239], v[120:123], v[204:207], v[236:239]
s_add_u32 s81, s81, 0x8000
v_exp_f32 v129, v129
v_mfma_f32_16x16x32_bf16 v[236:239], v[120:123], v[220:223], v[236:239]
s_add_u32 m0, s74, 16384
v_exp_f32 v130, v130
v_mfma_f32_16x16x32_bf16 a[32:35], a[192:195], v[196:199], a[32:35]
s_add_u32 s72, s81, 16384
ds_read_b128 a[132:135], v2 offset:17408
v_cvt_pk_bf16_f32 v192, v128, v129
v_mfma_f32_16x16x32_bf16 a[32:35], a[224:227], v[212:215], a[32:35]
v_exp_f32 v131, v131
v_mfma_f32_16x16x32_bf16 a[96:99], a[224:227], v[220:223], a[96:99]
v_exp_f32 v144, v144
v_mfma_f32_16x16x32_bf16 a[96:99], a[192:195], v[204:207], a[96:99]
ds_read_b128 a[136:139], v2 offset:18432
v_cvt_pk_bf16_f32 v193, v130, v131
v_mfma_f32_16x16x32_bf16 a[100:103], a[196:199], v[204:207], a[100:103]
buffer_load_dwordx4 v1, s[44:47], s72 offen sc1 lds
v_mfma_f32_16x16x32_bf16 a[100:103], a[228:231], v[220:223], a[100:103]
v_exp_f32 v145, v145
v_mfma_f32_16x16x32_bf16 a[36:39], a[228:231], v[212:215], a[36:39]
v_exp_f32 v146, v146
v_mfma_f32_16x16x32_bf16 a[36:39], a[196:199], v[196:199], a[36:39]
ds_read_b128 a[140:143], v2 offset:19456
v_cvt_pk_bf16_f32 v194, v144, v145
v_mfma_f32_16x16x32_bf16 a[40:43], a[200:203], v[196:199], a[40:43]
v_exp_f32 v147, v147
v_mfma_f32_16x16x32_bf16 a[40:43], a[232:235], v[212:215], a[40:43]
v_exp_f32 v136, v136
v_mfma_f32_16x16x32_bf16 a[104:107], a[232:235], v[220:223], a[104:107]
ds_read_b128 a[144:147], v2 offset:20480
v_cvt_pk_bf16_f32 v195, v146, v147
v_mfma_f32_16x16x32_bf16 a[104:107], a[200:203], v[204:207], a[104:107]
v_exp_f32 v137, v137
v_mfma_f32_16x16x32_bf16 a[108:111], a[204:207], v[204:207], a[108:111]
v_exp_f32 v138, v138
v_mfma_f32_16x16x32_bf16 a[108:111], a[236:239], v[220:223], a[108:111]
ds_read_b128 a[148:151], v2 offset:21504
v_cvt_pk_bf16_f32 v200, v136, v137
v_mfma_f32_16x16x32_bf16 a[44:47], a[236:239], v[212:215], a[44:47]
v_exp_f32 v139, v139
v_mfma_f32_16x16x32_bf16 a[44:47], a[204:207], v[196:199], a[44:47]
v_exp_f32 v152, v152
v_mfma_f32_16x16x32_bf16 a[48:51], a[208:211], v[196:199], a[48:51]
s_waitcnt lgkmcnt(6)
ds_read_b128 a[152:155], v2 offset:22528
v_cvt_pk_bf16_f32 v201, v138, v139
v_mfma_f32_16x16x32_bf16 a[48:51], a[240:243], v[212:215], a[48:51]
buffer_load_dwordx4 v1, s[44:47], s72 offen offset:1024 sc1 lds
v_mfma_f32_16x16x32_bf16 a[112:115], a[240:243], v[220:223], a[112:115]
v_exp_f32 v153, v153
v_mfma_f32_16x16x32_bf16 a[112:115], a[208:211], v[204:207], a[112:115]
v_exp_f32 v154, v154
v_mfma_f32_16x16x32_bf16 a[116:119], a[212:215], v[204:207], a[116:119]
ds_read_b128 a[156:159], v2 offset:23552
v_cvt_pk_bf16_f32 v202, v152, v153
v_mfma_f32_16x16x32_bf16 a[116:119], a[244:247], v[220:223], a[116:119]
v_exp_f32 v155, v155
v_mfma_f32_16x16x32_bf16 a[52:55], a[244:247], v[212:215], a[52:55]
v_exp_f32 v132, v132
v_mfma_f32_16x16x32_bf16 a[52:55], a[212:215], v[196:199], a[52:55]
ds_read_b128 a[192:195], v2 offset:0
v_cvt_pk_bf16_f32 v203, v154, v155
v_mfma_f32_16x16x32_bf16 a[56:59], a[216:219], v[196:199], a[56:59]
v_exp_f32 v133, v133
v_mfma_f32_16x16x32_bf16 a[56:59], a[248:251], v[212:215], a[56:59]
v_exp_f32 v134, v134
v_mfma_f32_16x16x32_bf16 a[120:123], a[248:251], v[220:223], a[120:123]
ds_read_b128 a[196:199], v2 offset:1024
v_mfma_f32_16x16x32_bf16 a[120:123], a[216:219], v[204:207], a[120:123]
v_exp_f32 v135, v135
v_mfma_f32_16x16x32_bf16 a[124:127], a[220:223], v[204:207], a[124:127]
v_exp_f32 v148, v148
v_mfma_f32_16x16x32_bf16 a[124:127], a[252:255], v[220:223], a[124:127]
ds_read_b128 a[200:203], v2 offset:2048
v_mfma_f32_16x16x32_bf16 a[60:63], a[252:255], v[212:215], a[60:63]
buffer_load_dwordx4 v1, s[44:47], s72 offen offset:2048 sc1 lds
v_mfma_f32_16x16x32_bf16 a[60:63], a[220:223], v[196:199], a[60:63]
ds_read_b128 a[204:207], v2 offset:3072
v_cvt_pk_bf16_f32 v196, v132, v133
v_mfma_f32_16x16x32_bf16 v[164:167], a[160:163], v[32:35], v[84:87]
v_exp_f32 v149, v149
v_mfma_f32_16x16x32_bf16 v[164:167], a[164:167], v[36:39], v[164:167]
v_exp_f32 v150, v150
v_mfma_f32_16x16x32_bf16 v[164:167], a[168:171], v[40:43], v[164:167]
ds_read_b128 a[208:211], v2 offset:4096
v_cvt_pk_bf16_f32 v197, v134, v135
v_mfma_f32_16x16x32_bf16 v[164:167], a[172:175], v[44:47], v[164:167]
v_exp_f32 v151, v151
v_mfma_f32_16x16x32_bf16 v[172:175], a[172:175], v[76:79], v[92:95]
v_exp_f32 v140, v140
v_mfma_f32_16x16x32_bf16 v[172:175], a[168:171], v[72:75], v[172:175]
ds_read_b128 a[212:215], v2 offset:5120
v_cvt_pk_bf16_f32 v198, v148, v149
v_mfma_f32_16x16x32_bf16 v[172:175], a[164:167], v[68:71], v[172:175]
v_exp_f32 v141, v141
v_mfma_f32_16x16x32_bf16 v[172:175], a[160:163], v[64:67], v[172:175]
v_exp_f32 v142, v142
v_mfma_f32_16x16x32_bf16 v[188:191], a[176:179], v[64:67], v[92:95]
ds_read_b128 a[216:219], v2 offset:6144
v_cvt_pk_bf16_f32 v199, v150, v151
v_mfma_f32_16x16x32_bf16 v[188:191], a[180:183], v[68:71], v[188:191]
v_exp_f32 v143, v143
v_mfma_f32_16x16x32_bf16 v[188:191], a[184:187], v[72:75], v[188:191]
v_exp_f32 v156, v156
v_mfma_f32_16x16x32_bf16 v[188:191], a[188:191], v[76:79], v[188:191]
ds_read_b128 a[220:223], v2 offset:7168
v_cvt_pk_bf16_f32 v204, v140, v141
v_mfma_f32_16x16x32_bf16 v[180:183], a[188:191], v[44:47], v[84:87]
buffer_load_dwordx4 v1, s[44:47], s72 offen offset:3072 sc1 lds
v_mfma_f32_16x16x32_bf16 v[180:183], a[184:187], v[40:43], v[180:183]
v_exp_f32 v157, v157
v_mfma_f32_16x16x32_bf16 v[180:183], a[180:183], v[36:39], v[180:183]
v_exp_f32 v158, v158
v_mfma_f32_16x16x32_bf16 v[180:183], a[176:179], v[32:35], v[180:183]
v_cvt_pk_bf16_f32 v205, v142, v143
v_cvt_pk_bf16_f32 v206, v156, v157
v_mfma_f32_16x16x32_bf16 v[160:163], a[160:163], v[16:19], v[80:83]
v_exp_f32 v159, v159
v_mfma_f32_16x16x32_bf16 v[160:163], a[164:167], v[20:23], v[160:163]
v_cvt_pk_bf16_f32 v207, v158, v159
v_mfma_f32_16x16x32_bf16 v[160:163], a[168:171], v[24:27], v[160:163]
v_mfma_f32_16x16x32_bf16 v[160:163], a[172:175], v[28:31], v[160:163]
v_mfma_f32_16x16x32_bf16 v[168:171], a[172:175], v[60:63], v[88:91]
v_mfma_f32_16x16x32_bf16 v[168:171], a[168:171], v[56:59], v[168:171]
v_mfma_f32_16x16x32_bf16 v[168:171], a[164:167], v[52:55], v[168:171]
v_mfma_f32_16x16x32_bf16 v[168:171], a[160:163], v[48:51], v[168:171]
v_mfma_f32_16x16x32_bf16 v[184:187], a[176:179], v[48:51], v[88:91]
v_mfma_f32_16x16x32_bf16 v[184:187], a[180:183], v[52:55], v[184:187]
v_mfma_f32_16x16x32_bf16 v[184:187], a[184:187], v[56:59], v[184:187]
v_mfma_f32_16x16x32_bf16 v[184:187], a[188:191], v[60:63], v[184:187]
v_mfma_f32_16x16x32_bf16 v[176:179], a[188:191], v[28:31], v[80:83]
v_mfma_f32_16x16x32_bf16 v[176:179], a[184:187], v[24:27], v[176:179]
v_mfma_f32_16x16x32_bf16 v[176:179], a[180:183], v[20:23], v[176:179]
v_mfma_f32_16x16x32_bf16 v[176:179], a[176:179], v[16:19], v[176:179]
s_waitcnt lgkmcnt(4)
v_mfma_f32_16x16x32_bf16 v[224:227], v[120:123], v[208:211], v[224:227]
s_add_u32 s82, s82, 0x8000
ds_read_b128 a[160:163], v2 offset:24576
v_mfma_f32_16x16x32_bf16 v[224:227], v[120:123], v[192:195], v[224:227]
s_and_b32 s82, s82, 0x1ffff
v_exp_f32 v164, v164
v_mfma_f32_16x16x32_bf16 v[232:235], v[120:123], v[216:219], v[232:235]
s_add_u32 m0, s74, 0
v_exp_f32 v165, v165
v_mfma_f32_16x16x32_bf16 v[232:235], v[120:123], v[200:203], v[232:235]
s_add_u32 s72, s81, 0
ds_read_b128 a[164:167], v2 offset:25600
v_cvt_pk_bf16_f32 v212, v164, v165
v_mfma_f32_16x16x32_bf16 a[0:3], a[224:227], v[208:211], a[0:3]
v_exp_f32 v166, v166
v_mfma_f32_16x16x32_bf16 a[0:3], a[192:195], v[192:195], a[0:3]
v_exp_f32 v167, v167
v_mfma_f32_16x16x32_bf16 a[64:67], a[192:195], v[200:203], a[64:67]
ds_read_b128 a[168:171], v2 offset:26624
v_cvt_pk_bf16_f32 v213, v166, v167
v_mfma_f32_16x16x32_bf16 a[64:67], a[224:227], v[216:219], a[64:67]
v_exp_f32 v180, v180
v_mfma_f32_16x16x32_bf16 a[68:71], a[228:231], v[216:219], a[68:71]
buffer_load_dwordx4 v1, s[44:47], s72 offen sc1 lds
v_mfma_f32_16x16x32_bf16 a[68:71], a[196:199], v[200:203], a[68:71]
v_exp_f32 v181, v181
v_mfma_f32_16x16x32_bf16 a[4:7], a[196:199], v[192:195], a[4:7]
ds_read_b128 a[172:175], v2 offset:27648
v_cvt_pk_bf16_f32 v214, v180, v181
v_mfma_f32_16x16x32_bf16 a[4:7], a[228:231], v[208:211], a[4:7]
v_exp_f32 v182, v182
v_mfma_f32_16x16x32_bf16 a[8:11], a[232:235], v[208:211], a[8:11]
v_exp_f32 v183, v183
v_mfma_f32_16x16x32_bf16 a[8:11], a[200:203], v[192:195], a[8:11]
ds_read_b128 a[176:179], v2 offset:28672
v_cvt_pk_bf16_f32 v215, v182, v183
v_mfma_f32_16x16x32_bf16 a[72:75], a[200:203], v[200:203], a[72:75]
v_exp_f32 v172, v172
v_mfma_f32_16x16x32_bf16 a[72:75], a[232:235], v[216:219], a[72:75]
v_exp_f32 v173, v173
v_mfma_f32_16x16x32_bf16 a[76:79], a[236:239], v[216:219], a[76:79]
ds_read_b128 a[180:183], v2 offset:29696
v_cvt_pk_bf16_f32 v220, v172, v173
v_mfma_f32_16x16x32_bf16 a[76:79], a[204:207], v[200:203], a[76:79]
v_exp_f32 v174, v174
v_mfma_f32_16x16x32_bf16 a[12:15], a[204:207], v[192:195], a[12:15]
v_exp_f32 v175, v175
v_mfma_f32_16x16x32_bf16 a[12:15], a[236:239], v[208:211], a[12:15]
ds_read_b128 a[184:187], v2 offset:30720
v_cvt_pk_bf16_f32 v221, v174, v175
v_mfma_f32_16x16x32_bf16 a[16:19], a[240:243], v[208:211], a[16:19]
s_waitcnt lgkmcnt(7)
v_exp_f32 v188, v188
v_mfma_f32_16x16x32_bf16 a[16:19], a[208:211], v[192:195], a[16:19]
buffer_load_dwordx4 v1, s[44:47], s72 offen offset:1024 sc1 lds
v_mfma_f32_16x16x32_bf16 a[80:83], a[208:211], v[200:203], a[80:83]
v_exp_f32 v189, v189
v_mfma_f32_16x16x32_bf16 a[80:83], a[240:243], v[216:219], a[80:83]
ds_read_b128 a[188:191], v2 offset:31744
v_cvt_pk_bf16_f32 v222, v188, v189
v_mfma_f32_16x16x32_bf16 a[84:87], a[244:247], v[216:219], a[84:87]
v_exp_f32 v190, v190
v_mfma_f32_16x16x32_bf16 a[84:87], a[212:215], v[200:203], a[84:87]
v_exp_f32 v191, v191
v_mfma_f32_16x16x32_bf16 a[20:23], a[212:215], v[192:195], a[20:23]
ds_read_b128 a[224:227], v2 offset:8192
v_cvt_pk_bf16_f32 v223, v190, v191
v_mfma_f32_16x16x32_bf16 a[20:23], a[244:247], v[208:211], a[20:23]
v_exp_f32 v160, v160
v_mfma_f32_16x16x32_bf16 a[24:27], a[248:251], v[208:211], a[24:27]
v_exp_f32 v161, v161
v_mfma_f32_16x16x32_bf16 a[24:27], a[216:219], v[192:195], a[24:27]
ds_read_b128 a[228:231], v2 offset:9216
v_mfma_f32_16x16x32_bf16 a[88:91], a[216:219], v[200:203], a[88:91]
v_exp_f32 v162, v162
v_mfma_f32_16x16x32_bf16 a[88:91], a[248:251], v[216:219], a[88:91]
v_exp_f32 v163, v163
v_mfma_f32_16x16x32_bf16 a[92:95], a[252:255], v[216:219], a[92:95]
ds_read_b128 a[232:235], v2 offset:10240
v_mfma_f32_16x16x32_bf16 a[92:95], a[220:223], v[200:203], a[92:95]
v_exp_f32 v176, v176
v_mfma_f32_16x16x32_bf16 a[28:31], a[220:223], v[192:195], a[28:31]
buffer_load_dwordx4 v1, s[44:47], s72 offen offset:2048 sc1 lds
v_mfma_f32_16x16x32_bf16 a[28:31], a[252:255], v[208:211], a[28:31]
ds_read_b128 a[236:239], v2 offset:11264
v_cvt_pk_bf16_f32 v208, v160, v161
s_cmp_eq_u32 s58, 0
s_cbranch_scc1 Lta16
s_cmp_eq_u32 s58, 1
s_cbranch_scc1 Lnt17
v_mfma_f32_16x16x32_bf16 v[128:131], a[128:131], v[16:19], v[80:83]
v_exp_f32 v177, v177
v_mfma_f32_16x16x32_bf16 v[144:147], a[144:147], v[16:19], v[80:83]
v_exp_f32 v178, v178
s_branch Ljoin18
Lta16:
v_mfma_f32_16x16x32_bf16 v[128:131], a[128:131], v[16:19], v[96:99]
v_exp_f32 v177, v177
v_mfma_f32_16x16x32_bf16 v[144:147], a[144:147], v[16:19], v[112:115]
v_exp_f32 v178, v178
s_branch Ljoin18
Lnt17:
v_mfma_f32_16x16x32_bf16 v[128:131], a[128:131], v[16:19], v[80:83]
v_exp_f32 v177, v177
v_mfma_f32_16x16x32_bf16 v[144:147], a[144:147], v[16:19], v[96:99]
v_exp_f32 v178, v178
Ljoin18:
v_mfma_f32_16x16x32_bf16 v[128:131], a[132:135], v[20:23], v[128:131]
ds_read_b128 a[240:243], v2 offset:12288
v_cvt_pk_bf16_f32 v209, v162, v163
v_mfma_f32_16x16x32_bf16 v[128:131], a[136:139], v[24:27], v[128:131]
v_exp_f32 v179, v179
v_mfma_f32_16x16x32_bf16 v[128:131], a[140:143], v[28:31], v[128:131]
v_exp_f32 v168, v168
v_mfma_f32_16x16x32_bf16 v[136:139], a[140:143], v[60:63], v[88:91]
ds_read_b128 a[244:247], v2 offset:13312
v_cvt_pk_bf16_f32 v210, v176, v177
v_mfma_f32_16x16x32_bf16 v[136:139], a[136:139], v[56:59], v[136:139]
v_exp_f32 v169, v169
v_mfma_f32_16x16x32_bf16 v[136:139], a[132:135], v[52:55], v[136:139]
v_exp_f32 v170, v170
v_mfma_f32_16x16x32_bf16 v[136:139], a[128:131], v[48:51], v[136:139]
ds_read_b128 a[248:251], v2 offset:14336
v_cvt_pk_bf16_f32 v211, v178, v179
v_mfma_f32_16x16x32_bf16 v[152:155], a[144:147], v[48:51], v[88:91]
v_exp_f32 v171, v171
v_mfma_f32_16x16x32_bf16 v[152:155], a[148:151], v[52:55], v[152:155]
v_exp_f32 v184, v184
v_mfma_f32_16x16x32_bf16 v[152:155], a[152:155], v[56:59], v[152:155]
ds_read_b128 a[252:255], v2 offset:15360
v_cvt_pk_bf16_f32 v216, v168, v169
v_mfma_f32_16x16x32_bf16 v[152:155], a[156:159], v[60:63], v[152:155]
buffer_load_dwordx4 v1, s[44:47], s72 offen offset:3072 sc1 lds
v_mfma_f32_16x16x32_bf16 v[144:147], a[156:159], v[28:31], v[144:147]
v_exp_f32 v185, v185
v_mfma_f32_16x16x32_bf16 v[144:147], a[152:155], v[24:27], v[144:147]
v_exp_f32 v186, v186
v_mfma_f32_16x16x32_bf16 v[144:147], a[148:151], v[20:23], v[144:147]
v_cvt_pk_bf16_f32 v217, v170, v171
v_cvt_pk_bf16_f32 v218, v184, v185
v_mfma_f32_16x16x32_bf16 v[132:135], a[128:131], v[32:35], v[84:87]
v_exp_f32 v187, v187
v_mfma_f32_16x16x32_bf16 v[132:135], a[132:135], v[36:39], v[132:135]
v_cvt_pk_bf16_f32 v219, v186, v187
v_add_u32 v2, s82, v1
v_mfma_f32_16x16x32_bf16 v[132:135], a[136:139], v[40:43], v[132:135]
v_mfma_f32_16x16x32_bf16 v[132:135], a[140:143], v[44:47], v[132:135]
v_mfma_f32_16x16x32_bf16 v[140:143], a[140:143], v[76:79], v[92:95]
v_mfma_f32_16x16x32_bf16 v[140:143], a[136:139], v[72:75], v[140:143]
v_mfma_f32_16x16x32_bf16 v[140:143], a[132:135], v[68:71], v[140:143]
v_mfma_f32_16x16x32_bf16 v[140:143], a[128:131], v[64:67], v[140:143]
v_mfma_f32_16x16x32_bf16 v[156:159], a[144:147], v[64:67], v[92:95]
v_mfma_f32_16x16x32_bf16 v[156:159], a[148:151], v[68:71], v[156:159]
v_mfma_f32_16x16x32_bf16 v[156:159], a[152:155], v[72:75], v[156:159]
v_mfma_f32_16x16x32_bf16 v[156:159], a[156:159], v[76:79], v[156:159]
v_mfma_f32_16x16x32_bf16 v[148:151], a[156:159], v[44:47], v[84:87]
v_mfma_f32_16x16x32_bf16 v[148:151], a[152:155], v[40:43], v[148:151]
v_mfma_f32_16x16x32_bf16 v[148:151], a[148:151], v[36:39], v[148:151]
s_waitcnt vmcnt(8) lgkmcnt(4)
v_mfma_f32_16x16x32_bf16 v[148:151], a[144:147], v[32:35], v[148:151]
s_barrier
v_mfma_f32_16x16x32_bf16 v[228:231], v[120:123], v[196:199], v[228:231]
s_xor_b32 s74, s82, 0x10000
v_exp_f32 v128, v128
v_mfma_f32_16x16x32_bf16 v[228:231], v[120:123], v[212:215], v[228:231]
s_add_u32 s74, s74, s64
ds_read_b128 a[128:131], v2 offset:16384
v_mfma_f32_16x16x32_bf16 v[236:239], v[120:123], v[204:207], v[236:239]
s_add_u32 s81, s81, 0x8000
v_exp_f32 v129, v129
v_mfma_f32_16x16x32_bf16 v[236:239], v[120:123], v[220:223], v[236:239]
s_add_u32 m0, s74, 16384
v_exp_f32 v130, v130
v_mfma_f32_16x16x32_bf16 a[32:35], a[192:195], v[196:199], a[32:35]
s_add_u32 s72, s81, 16384
ds_read_b128 a[132:135], v2 offset:17408
v_cvt_pk_bf16_f32 v192, v128, v129
v_mfma_f32_16x16x32_bf16 a[32:35], a[224:227], v[212:215], a[32:35]
v_exp_f32 v131, v131
v_mfma_f32_16x16x32_bf16 a[96:99], a[224:227], v[220:223], a[96:99]
v_exp_f32 v144, v144
v_mfma_f32_16x16x32_bf16 a[96:99], a[192:195], v[204:207], a[96:99]
ds_read_b128 a[136:139], v2 offset:18432
v_cvt_pk_bf16_f32 v193, v130, v131
v_mfma_f32_16x16x32_bf16 a[100:103], a[196:199], v[204:207], a[100:103]
buffer_load_dwordx4 v1, s[44:47], s72 offen sc1 lds
v_mfma_f32_16x16x32_bf16 a[100:103], a[228:231], v[220:223], a[100:103]
v_exp_f32 v145, v145
v_mfma_f32_16x16x32_bf16 a[36:39], a[228:231], v[212:215], a[36:39]
v_exp_f32 v146, v146
v_mfma_f32_16x16x32_bf16 a[36:39], a[196:199], v[196:199], a[36:39]
ds_read_b128 a[140:143], v2 offset:19456
v_cvt_pk_bf16_f32 v194, v144, v145
v_mfma_f32_16x16x32_bf16 a[40:43], a[200:203], v[196:199], a[40:43]
v_exp_f32 v147, v147
v_mfma_f32_16x16x32_bf16 a[40:43], a[232:235], v[212:215], a[40:43]
v_exp_f32 v136, v136
v_mfma_f32_16x16x32_bf16 a[104:107], a[232:235], v[220:223], a[104:107]
ds_read_b128 a[144:147], v2 offset:20480
v_cvt_pk_bf16_f32 v195, v146, v147
v_mfma_f32_16x16x32_bf16 a[104:107], a[200:203], v[204:207], a[104:107]
v_exp_f32 v137, v137
v_mfma_f32_16x16x32_bf16 a[108:111], a[204:207], v[204:207], a[108:111]
v_exp_f32 v138, v138
v_mfma_f32_16x16x32_bf16 a[108:111], a[236:239], v[220:223], a[108:111]
ds_read_b128 a[148:151], v2 offset:21504
v_cvt_pk_bf16_f32 v200, v136, v137
v_mfma_f32_16x16x32_bf16 a[44:47], a[236:239], v[212:215], a[44:47]
v_exp_f32 v139, v139
v_mfma_f32_16x16x32_bf16 a[44:47], a[204:207], v[196:199], a[44:47]
v_exp_f32 v152, v152
v_mfma_f32_16x16x32_bf16 a[48:51], a[208:211], v[196:199], a[48:51]
s_waitcnt lgkmcnt(6)
ds_read_b128 a[152:155], v2 offset:22528
v_cvt_pk_bf16_f32 v201, v138, v139
v_mfma_f32_16x16x32_bf16 a[48:51], a[240:243], v[212:215], a[48:51]
buffer_load_dwordx4 v1, s[44:47], s72 offen offset:1024 sc1 lds
v_mfma_f32_16x16x32_bf16 a[112:115], a[240:243], v[220:223], a[112:115]
v_exp_f32 v153, v153
v_mfma_f32_16x16x32_bf16 a[112:115], a[208:211], v[204:207], a[112:115]
v_exp_f32 v154, v154
v_mfma_f32_16x16x32_bf16 a[116:119], a[212:215], v[204:207], a[116:119]
ds_read_b128 a[156:159], v2 offset:23552
v_cvt_pk_bf16_f32 v202, v152, v153
v_mfma_f32_16x16x32_bf16 a[116:119], a[244:247], v[220:223], a[116:119]
v_exp_f32 v155, v155
v_mfma_f32_16x16x32_bf16 a[52:55], a[244:247], v[212:215], a[52:55]
v_exp_f32 v132, v132
v_mfma_f32_16x16x32_bf16 a[52:55], a[212:215], v[196:199], a[52:55]
ds_read_b128 a[192:195], v2 offset:0
v_cvt_pk_bf16_f32 v203, v154, v155
v_mfma_f32_16x16x32_bf16 a[56:59], a[216:219], v[196:199], a[56:59]
v_exp_f32 v133, v133
v_mfma_f32_16x16x32_bf16 a[56:59], a[248:251], v[212:215], a[56:59]
v_exp_f32 v134, v134
v_mfma_f32_16x16x32_bf16 a[120:123], a[248:251], v[220:223], a[120:123]
ds_read_b128 a[196:199], v2 offset:1024
v_mfma_f32_16x16x32_bf16 a[120:123], a[216:219], v[204:207], a[120:123]
v_exp_f32 v135, v135
v_mfma_f32_16x16x32_bf16 a[124:127], a[220:223], v[204:207], a[124:127]
v_exp_f32 v148, v148
v_mfma_f32_16x16x32_bf16 a[124:127], a[252:255], v[220:223], a[124:127]
ds_read_b128 a[200:203], v2 offset:2048
v_mfma_f32_16x16x32_bf16 a[60:63], a[252:255], v[212:215], a[60:63]
buffer_load_dwordx4 v1, s[44:47], s72 offen offset:2048 sc1 lds
v_mfma_f32_16x16x32_bf16 a[60:63], a[220:223], v[196:199], a[60:63]
ds_read_b128 a[204:207], v2 offset:3072
v_cvt_pk_bf16_f32 v196, v132, v133
s_cmp_eq_u32 s58, 2
s_cbranch_scc1 Lta19
s_cmp_eq_u32 s58, 3
s_cbranch_scc1 Lnt20
v_mfma_f32_16x16x32_bf16 v[160:163], a[160:163], v[16:19], v[112:115]
v_exp_f32 v149, v149
v_mfma_f32_16x16x32_bf16 v[176:179], a[176:179], v[16:19], v[112:115]
v_exp_f32 v150, v150
s_branch Ljoin21
Lta19:
v_mfma_f32_16x16x32_bf16 v[160:163], a[160:163], v[16:19], v[96:99]
v_exp_f32 v149, v149
v_mfma_f32_16x16x32_bf16 v[176:179], a[176:179], v[16:19], v[112:115]
v_exp_f32 v150, v150
s_branch Ljoin21
Lnt20:
v_mfma_f32_16x16x32_bf16 v[160:163], a[160:163], v[16:19], v[80:83]
v_exp_f32 v149, v149
v_mfma_f32_16x16x32_bf16 v[176:179], a[176:179], v[16:19], v[96:99]
v_exp_f32 v150, v150
Ljoin21:
v_mfma_f32_16x16x32_bf16 v[164:167], a[160:163], v[32:35], v[84:87]
ds_read_b128 a[208:211], v2 offset:4096
v_cvt_pk_bf16_f32 v197, v134, v135
v_mfma_f32_16x16x32_bf16 v[164:167], a[164:167], v[36:39], v[164:167]
v_exp_f32 v151, v151
v_mfma_f32_16x16x32_bf16 v[164:167], a[168:171], v[40:43], v[164:167]
v_exp_f32 v140, v140
v_mfma_f32_16x16x32_bf16 v[164:167], a[172:175], v[44:47], v[164:167]
ds_read_b128 a[212:215], v2 offset:5120
v_cvt_pk_bf16_f32 v198, v148, v149
v_mfma_f32_16x16x32_bf16 v[172:175], a[172:175], v[76:79], v[92:95]
v_exp_f32 v141, v141
v_mfma_f32_16x16x32_bf16 v[172:175], a[168:171], v[72:75], v[172:175]
v_exp_f32 v142, v142
v_mfma_f32_16x16x32_bf16 v[172:175], a[164:167], v[68:71], v[172:175]
ds_read_b128 a[216:219], v2 offset:6144
v_cvt_pk_bf16_f32 v199, v150, v151
v_mfma_f32_16x16x32_bf16 v[172:175], a[160:163], v[64:67], v[172:175]
v_exp_f32 v143, v143
v_mfma_f32_16x16x32_bf16 v[188:191], a[176:179], v[64:67], v[92:95]
v_exp_f32 v156, v156
v_mfma_f32_16x16x32_bf16 v[188:191], a[180:183], v[68:71], v[188:191]
ds_read_b128 a[220:223], v2 offset:7168
v_cvt_pk_bf16_f32 v204, v140, v141
v_mfma_f32_16x16x32_bf16 v[188:191], a[184:187], v[72:75], v[188:191]
buffer_load_dwordx4 v1, s[44:47], s72 offen offset:3072 sc1 lds
v_mfma_f32_16x16x32_bf16 v[188:191], a[188:191], v[76:79], v[188:191]
v_exp_f32 v157, v157
v_mfma_f32_16x16x32_bf16 v[180:183], a[188:191], v[44:47], v[84:87]
v_exp_f32 v158, v158
v_mfma_f32_16x16x32_bf16 v[180:183], a[184:187], v[40:43], v[180:183]
v_cvt_pk_bf16_f32 v205, v142, v143
v_cvt_pk_bf16_f32 v206, v156, v157
v_mfma_f32_16x16x32_bf16 v[180:183], a[180:183], v[36:39], v[180:183]
v_exp_f32 v159, v159
v_mfma_f32_16x16x32_bf16 v[180:183], a[176:179], v[32:35], v[180:183]
v_cvt_pk_bf16_f32 v207, v158, v159
v_mfma_f32_16x16x32_bf16 v[160:163], a[164:167], v[20:23], v[160:163]
v_mfma_f32_16x16x32_bf16 v[160:163], a[168:171], v[24:27], v[160:163]
v_mfma_f32_16x16x32_bf16 v[160:163], a[172:175], v[28:31], v[160:163]
v_mfma_f32_16x16x32_bf16 v[168:171], a[172:175], v[60:63], v[88:91]
v_mfma_f32_16x16x32_bf16 v[168:171], a[168:171], v[56:59], v[168:171]
v_mfma_f32_16x16x32_bf16 v[168:171], a[164:167], v[52:55], v[168:171]
v_mfma_f32_16x16x32_bf16 v[168:171], a[160:163], v[48:51], v[168:171]
v_mfma_f32_16x16x32_bf16 v[184:187], a[176:179], v[48:51], v[88:91]
v_mfma_f32_16x16x32_bf16 v[184:187], a[180:183], v[52:55], v[184:187]
v_mfma_f32_16x16x32_bf16 v[184:187], a[184:187], v[56:59], v[184:187]
v_mfma_f32_16x16x32_bf16 v[184:187], a[188:191], v[60:63], v[184:187]
v_mfma_f32_16x16x32_bf16 v[176:179], a[188:191], v[28:31], v[176:179]
v_mfma_f32_16x16x32_bf16 v[176:179], a[184:187], v[24:27], v[176:179]
v_mfma_f32_16x16x32_bf16 v[176:179], a[180:183], v[20:23], v[176:179]
s_waitcnt lgkmcnt(4)
v_mfma_f32_16x16x32_bf16 v[224:227], v[120:123], v[208:211], v[224:227]
s_add_u32 s82, s82, 0x8000
ds_read_b128 a[160:163], v2 offset:24576
v_mfma_f32_16x16x32_bf16 v[224:227], v[120:123], v[192:195], v[224:227]
s_and_b32 s82, s82, 0x1ffff
v_exp_f32 v164, v164
v_mfma_f32_16x16x32_bf16 v[232:235], v[120:123], v[216:219], v[232:235]
s_add_u32 m0, s74, 0
v_exp_f32 v165, v165
v_mfma_f32_16x16x32_bf16 v[232:235], v[120:123], v[200:203], v[232:235]
s_add_u32 s72, s81, 0
ds_read_b128 a[164:167], v2 offset:25600
v_cvt_pk_bf16_f32 v212, v164, v165
v_mfma_f32_16x16x32_bf16 a[0:3], a[224:227], v[208:211], a[0:3]
v_exp_f32 v166, v166
v_mfma_f32_16x16x32_bf16 a[0:3], a[192:195], v[192:195], a[0:3]
v_exp_f32 v167, v167
v_mfma_f32_16x16x32_bf16 a[64:67], a[192:195], v[200:203], a[64:67]
ds_read_b128 a[168:171], v2 offset:26624
v_cvt_pk_bf16_f32 v213, v166, v167
v_mfma_f32_16x16x32_bf16 a[64:67], a[224:227], v[216:219], a[64:67]
v_exp_f32 v180, v180
v_mfma_f32_16x16x32_bf16 a[68:71], a[228:231], v[216:219], a[68:71]
buffer_load_dwordx4 v1, s[44:47], s72 offen sc1 lds
v_mfma_f32_16x16x32_bf16 a[68:71], a[196:199], v[200:203], a[68:71]
v_exp_f32 v181, v181
v_mfma_f32_16x16x32_bf16 a[4:7], a[196:199], v[192:195], a[4:7]
ds_read_b128 a[172:175], v2 offset:27648
v_cvt_pk_bf16_f32 v214, v180, v181
v_mfma_f32_16x16x32_bf16 a[4:7], a[228:231], v[208:211], a[4:7]
v_exp_f32 v182, v182
v_mfma_f32_16x16x32_bf16 a[8:11], a[232:235], v[208:211], a[8:11]
v_exp_f32 v183, v183
v_mfma_f32_16x16x32_bf16 a[8:11], a[200:203], v[192:195], a[8:11]
ds_read_b128 a[176:179], v2 offset:28672
v_cvt_pk_bf16_f32 v215, v182, v183
v_mfma_f32_16x16x32_bf16 a[72:75], a[200:203], v[200:203], a[72:75]
v_exp_f32 v172, v172
v_mfma_f32_16x16x32_bf16 a[72:75], a[232:235], v[216:219], a[72:75]
v_exp_f32 v173, v173
v_mfma_f32_16x16x32_bf16 a[76:79], a[236:239], v[216:219], a[76:79]
ds_read_b128 a[180:183], v2 offset:29696
v_cvt_pk_bf16_f32 v220, v172, v173
v_mfma_f32_16x16x32_bf16 a[76:79], a[204:207], v[200:203], a[76:79]
v_exp_f32 v174, v174
v_mfma_f32_16x16x32_bf16 a[12:15], a[204:207], v[192:195], a[12:15]
v_exp_f32 v175, v175
v_mfma_f32_16x16x32_bf16 a[12:15], a[236:239], v[208:211], a[12:15]
ds_read_b128 a[184:187], v2 offset:30720
v_cvt_pk_bf16_f32 v221, v174, v175
v_mfma_f32_16x16x32_bf16 a[16:19], a[240:243], v[208:211], a[16:19]
s_waitcnt lgkmcnt(7)
v_exp_f32 v188, v188
v_mfma_f32_16x16x32_bf16 a[16:19], a[208:211], v[192:195], a[16:19]
buffer_load_dwordx4 v1, s[44:47], s72 offen offset:1024 sc1 lds
v_mfma_f32_16x16x32_bf16 a[80:83], a[208:211], v[200:203], a[80:83]
v_exp_f32 v189, v189
v_mfma_f32_16x16x32_bf16 a[80:83], a[240:243], v[216:219], a[80:83]
ds_read_b128 a[188:191], v2 offset:31744
v_cvt_pk_bf16_f32 v222, v188, v189
v_mfma_f32_16x16x32_bf16 a[84:87], a[244:247], v[216:219], a[84:87]
v_exp_f32 v190, v190
v_mfma_f32_16x16x32_bf16 a[84:87], a[212:215], v[200:203], a[84:87]
v_exp_f32 v191, v191
v_mfma_f32_16x16x32_bf16 a[20:23], a[212:215], v[192:195], a[20:23]
ds_read_b128 a[224:227], v2 offset:8192
v_cvt_pk_bf16_f32 v223, v190, v191
v_mfma_f32_16x16x32_bf16 a[20:23], a[244:247], v[208:211], a[20:23]
v_exp_f32 v160, v160
v_mfma_f32_16x16x32_bf16 a[24:27], a[248:251], v[208:211], a[24:27]
v_exp_f32 v161, v161
v_mfma_f32_16x16x32_bf16 a[24:27], a[216:219], v[192:195], a[24:27]
ds_read_b128 a[228:231], v2 offset:9216
v_mfma_f32_16x16x32_bf16 a[88:91], a[216:219], v[200:203], a[88:91]
v_exp_f32 v162, v162
v_mfma_f32_16x16x32_bf16 a[88:91], a[248:251], v[216:219], a[88:91]
Lstub3:
s_cbranch_execz Lstub7
v_exp_f32 v163, v163
v_mfma_f32_16x16x32_bf16 a[92:95], a[252:255], v[216:219], a[92:95]
ds_read_b128 a[232:235], v2 offset:10240
v_mfma_f32_16x16x32_bf16 a[92:95], a[220:223], v[200:203], a[92:95]
v_exp_f32 v176, v176
v_mfma_f32_16x16x32_bf16 a[28:31], a[220:223], v[192:195], a[28:31]
buffer_load_dwordx4 v1, s[44:47], s72 offen offset:2048 sc1 lds
v_mfma_f32_16x16x32_bf16 a[28:31], a[252:255], v[208:211], a[28:31]
ds_read_b128 a[236:239], v2 offset:11264
v_cvt_pk_bf16_f32 v208, v160, v161
s_cmp_eq_u32 s58, 0
s_cbranch_scc1 Lta22
s_cmp_eq_u32 s58, 1
s_cbranch_scc1 Lnt23
v_mfma_f32_16x16x32_bf16 v[132:135], a[128:131], v[32:35], v[84:87]
v_exp_f32 v177, v177
v_mfma_f32_16x16x32_bf16 v[148:151], a[144:147], v[32:35], v[84:87]
v_exp_f32 v178, v178
s_branch Ljoin24
Lta22:
v_mfma_f32_16x16x32_bf16 v[132:135], a[128:131], v[32:35], v[100:103]
v_exp_f32 v177, v177
v_mfma_f32_16x16x32_bf16 v[148:151], a[144:147], v[32:35], v[112:115]
v_exp_f32 v178, v178
s_branch Ljoin24
Lnt23:
v_mfma_f32_16x16x32_bf16 v[132:135], a[128:131], v[32:35], v[84:87]
v_exp_f32 v177, v177
v_mfma_f32_16x16x32_bf16 v[148:151], a[144:147], v[32:35], v[100:103]
v_exp_f32 v178, v178
Ljoin24:
v_mfma_f32_16x16x32_bf16 v[136:139], a[128:131], v[48:51], v[88:91]
ds_read_b128 a[240:243], v2 offset:12288
v_cvt_pk_bf16_f32 v209, v162, v163
v_mfma_f32_16x16x32_bf16 v[136:139], a[132:135], v[52:55], v[136:139]
v_exp_f32 v179, v179
v_mfma_f32_16x16x32_bf16 v[136:139], a[136:139], v[56:59], v[136:139]
v_exp_f32 v168, v168
v_mfma_f32_16x16x32_bf16 v[136:139], a[140:143], v[60:63], v[136:139]
ds_read_b128 a[244:247], v2 offset:13312
v_cvt_pk_bf16_f32 v210, v176, v177
v_mfma_f32_16x16x32_bf16 v[152:155], a[156:159], v[60:63], v[88:91]
v_exp_f32 v169, v169
v_mfma_f32_16x16x32_bf16 v[152:155], a[152:155], v[56:59], v[152:155]
v_exp_f32 v170, v170
v_mfma_f32_16x16x32_bf16 v[152:155], a[148:151], v[52:55], v[152:155]
ds_read_b128 a[248:251], v2 offset:14336
v_cvt_pk_bf16_f32 v211, v178, v179
v_mfma_f32_16x16x32_bf16 v[152:155], a[144:147], v[48:51], v[152:155]
v_exp_f32 v171, v171
v_mfma_f32_16x16x32_bf16 v[132:135], a[132:135], v[36:39], v[132:135]
v_exp_f32 v184, v184
v_mfma_f32_16x16x32_bf16 v[132:135], a[136:139], v[40:43], v[132:135]
ds_read_b128 a[252:255], v2 offset:15360
v_cvt_pk_bf16_f32 v216, v168, v169
v_mfma_f32_16x16x32_bf16 v[132:135], a[140:143], v[44:47], v[132:135]
buffer_load_dwordx4 v1, s[44:47], s72 offen offset:3072 sc1 lds
v_mfma_f32_16x16x32_bf16 v[140:143], a[140:143], v[76:79], v[92:95]
v_exp_f32 v185, v185
v_mfma_f32_16x16x32_bf16 v[140:143], a[136:139], v[72:75], v[140:143]
v_exp_f32 v186, v186
v_mfma_f32_16x16x32_bf16 v[140:143], a[132:135], v[68:71], v[140:143]
v_cvt_pk_bf16_f32 v217, v170, v171
v_cvt_pk_bf16_f32 v218, v184, v185
v_mfma_f32_16x16x32_bf16 v[140:143], a[128:131], v[64:67], v[140:143]
v_exp_f32 v187, v187
v_mfma_f32_16x16x32_bf16 v[156:159], a[144:147], v[64:67], v[92:95]
v_cvt_pk_bf16_f32 v219, v186, v187
v_add_u32 v2, s82, v1
v_mfma_f32_16x16x32_bf16 v[156:159], a[148:151], v[68:71], v[156:159]
v_mfma_f32_16x16x32_bf16 v[156:159], a[152:155], v[72:75], v[156:159]
v_mfma_f32_16x16x32_bf16 v[156:159], a[156:159], v[76:79], v[156:159]
v_mfma_f32_16x16x32_bf16 v[148:151], a[156:159], v[44:47], v[148:151]
v_mfma_f32_16x16x32_bf16 v[148:151], a[152:155], v[40:43], v[148:151]
s_waitcnt vmcnt(8) lgkmcnt(4)
v_mfma_f32_16x16x32_bf16 v[148:151], a[148:151], v[36:39], v[148:151]
s_barrier
s_cmp_eq_u32 s60, 7
s_cbranch_scc1 LLT3x
LLT3:
Lstub4:
s_cbranch_execz Lstub8
v_mfma_f32_16x16x32_bf16 v[228:231], v[120:123], v[196:199], v[228:231]
s_xor_b32 s74, s82, 0x10000
v_exp_f32 v136, v136
v_mfma_f32_16x16x32_bf16 v[228:231], v[120:123], v[212:215], v[228:231]
s_add_u32 s74, s74, s64
ds_read_b128 a[128:131], v2 offset:16384
v_and_b32 v240, 15, v0
v_mfma_f32_16x16x32_bf16 v[236:239], v[120:123], v[204:207], v[236:239]
s_add_u32 s81, s81, 0x8000
v_exp_f32 v137, v137
v_mfma_f32_16x16x32_bf16 v[236:239], v[120:123], v[220:223], v[236:239]
s_add_u32 m0, s74, 16384
ds_read_b128 a[132:135], v2 offset:17408
v_cvt_pk_bf16_f32 v200, v136, v137
v_mfma_f32_16x16x32_bf16 a[32:35], a[192:195], v[196:199], a[32:35]
s_add_u32 s72, s81, 16384
buffer_load_dwordx4 v1, s[44:47], s72 offen sc1 lds
v_mfma_f32_16x16x32_bf16 a[32:35], a[224:227], v[212:215], a[32:35]
s_add_u32 s69, s93, 0x3e00000
v_exp_f32 v138, v138
v_mfma_f32_16x16x32_bf16 a[96:99], a[224:227], v[220:223], a[96:99]
v_exp_f32 v139, v139
v_mfma_f32_16x16x32_bf16 a[96:99], a[192:195], v[204:207], a[96:99]
ds_read_b128 a[136:139], v2 offset:18432
v_cvt_pk_bf16_f32 v201, v138, v139
v_mfma_f32_16x16x32_bf16 a[100:103], a[196:199], v[204:207], a[100:103]
v_exp_f32 v152, v152
v_mfma_f32_16x16x32_bf16 a[100:103], a[228:231], v[220:223], a[100:103]
ds_read_b128 a[140:143], v2 offset:19456
v_lshrrev_b32 v241, 4, v0
v_mfma_f32_16x16x32_bf16 a[36:39], a[228:231], v[212:215], a[36:39]
buffer_store_dwordx4 v[112:115], v1, s[44:47], s69 offen sc1
v_mfma_f32_16x16x32_bf16 a[36:39], a[196:199], v[196:199], a[36:39]
v_exp_f32 v153, v153
v_mfma_f32_16x16x32_bf16 a[40:43], a[200:203], v[196:199], a[40:43]
v_exp_f32 v154, v154
v_mfma_f32_16x16x32_bf16 a[40:43], a[232:235], v[212:215], a[40:43]
ds_read_b128 a[144:147], v2 offset:20480
v_cvt_pk_bf16_f32 v202, v152, v153
v_mfma_f32_16x16x32_bf16 a[104:107], a[232:235], v[220:223], a[104:107]
v_exp_f32 v155, v155
v_mfma_f32_16x16x32_bf16 a[104:107], a[200:203], v[204:207], a[104:107]
ds_read_b128 a[148:151], v2 offset:21504
v_cvt_pk_bf16_f32 v203, v154, v155
v_mfma_f32_16x16x32_bf16 a[108:111], a[204:207], v[204:207], a[108:111]
buffer_load_dwordx4 v1, s[44:47], s72 offen offset:1024 sc1 lds
v_mfma_f32_16x16x32_bf16 a[108:111], a[236:239], v[220:223], a[108:111]
v_exp_f32 v132, v132
v_mfma_f32_16x16x32_bf16 a[44:47], a[236:239], v[212:215], a[44:47]
v_exp_f32 v133, v133
v_mfma_f32_16x16x32_bf16 a[44:47], a[204:207], v[196:199], a[44:47]
ds_read_b128 a[152:155], v2 offset:22528
v_add_u32 v248, 1, v240
v_mfma_f32_16x16x32_bf16 a[48:51], a[208:211], v[196:199], a[48:51]
s_waitcnt lgkmcnt(7)
v_exp_f32 v134, v134
v_mfma_f32_16x16x32_bf16 a[48:51], a[240:243], v[212:215], a[48:51]
ds_read_b128 a[156:159], v2 offset:23552
v_and_b32 v249, 3, v248
v_mfma_f32_16x16x32_bf16 a[112:115], a[240:243], v[220:223], a[112:115]
buffer_store_dwordx4 v[112:115], v1, s[44:47], s69 offen offset:1024 sc1
v_mfma_f32_16x16x32_bf16 a[112:115], a[208:211], v[204:207], a[112:115]
v_exp_f32 v135, v135
v_mfma_f32_16x16x32_bf16 a[116:119], a[212:215], v[204:207], a[116:119]
v_exp_f32 v148, v148
v_mfma_f32_16x16x32_bf16 a[116:119], a[244:247], v[220:223], a[116:119]
ds_read_b128 a[192:195], v2 offset:0
v_lshrrev_b32 v248, 2, v248
v_mfma_f32_16x16x32_bf16 a[52:55], a[244:247], v[212:215], a[52:55]
v_exp_f32 v149, v149
v_mfma_f32_16x16x32_bf16 a[52:55], a[212:215], v[196:199], a[52:55]
ds_read_b128 a[196:199], v2 offset:1024
v_mov_b32 v250, 0x20000
v_mfma_f32_16x16x32_bf16 a[56:59], a[216:219], v[196:199], a[56:59]
buffer_load_dwordx4 v1, s[44:47], s72 offen offset:2048 sc1 lds
v_mfma_f32_16x16x32_bf16 a[56:59], a[248:251], v[212:215], a[56:59]
v_exp_f32 v150, v150
v_mfma_f32_16x16x32_bf16 a[120:123], a[248:251], v[220:223], a[120:123]
v_exp_f32 v151, v151
v_mfma_f32_16x16x32_bf16 a[120:123], a[216:219], v[204:207], a[120:123]
ds_read_b128 a[200:203], v2 offset:2048
v_mov_b32 v252, 0x20001
v_mfma_f32_16x16x32_bf16 a[124:127], a[220:223], v[204:207], a[124:127]
v_exp_f32 v140, v140
v_mfma_f32_16x16x32_bf16 a[124:127], a[252:255], v[220:223], a[124:127]
ds_read_b128 a[204:207], v2 offset:3072
v_lshlrev_b32 v6, 3, v249
v_mfma_f32_16x16x32_bf16 a[60:63], a[252:255], v[212:215], a[60:63]
buffer_store_dwordx4 v[112:115], v1, s[44:47], s69 offen offset:2048 sc1
v_mfma_f32_16x16x32_bf16 a[60:63], a[220:223], v[196:199], a[60:63]
ds_read_b128 a[208:211], v2 offset:4096
v_cvt_pk_bf16_f32 v196, v132, v133
s_cmp_eq_u32 s58, 2
s_cbranch_scc1 Lta25
s_cmp_eq_u32 s58, 3
s_cbranch_scc1 Lnt26
v_mfma_f32_16x16x32_bf16 v[164:167], a[160:163], v[32:35], v[112:115]
ds_read_b128 a[212:215], v2 offset:5120
v_cvt_pk_bf16_f32 v197, v134, v135
v_mfma_f32_16x16x32_bf16 v[180:183], a[176:179], v[32:35], v[112:115]
ds_read_b128 a[216:219], v2 offset:6144
v_cvt_pk_bf16_f32 v198, v148, v149
s_branch Ljoin27
Lta25:
v_mfma_f32_16x16x32_bf16 v[164:167], a[160:163], v[32:35], v[100:103]
ds_read_b128 a[212:215], v2 offset:5120
v_cvt_pk_bf16_f32 v197, v134, v135
v_mfma_f32_16x16x32_bf16 v[180:183], a[176:179], v[32:35], v[112:115]
ds_read_b128 a[216:219], v2 offset:6144
v_cvt_pk_bf16_f32 v198, v148, v149
s_branch Ljoin27
Lnt26:
v_mfma_f32_16x16x32_bf16 v[164:167], a[160:163], v[32:35], v[84:87]
ds_read_b128 a[212:215], v2 offset:5120
v_cvt_pk_bf16_f32 v197, v134, v135
v_mfma_f32_16x16x32_bf16 v[180:183], a[176:179], v[32:35], v[100:103]
ds_read_b128 a[216:219], v2 offset:6144
v_cvt_pk_bf16_f32 v198, v148, v149
Ljoin27:
v_mfma_f32_16x16x32_bf16 v[164:167], a[164:167], v[36:39], v[164:167]
v_exp_f32 v141, v141
v_mfma_f32_16x16x32_bf16 v[164:167], a[168:171], v[40:43], v[164:167]
v_exp_f32 v142, v142
v_mfma_f32_16x16x32_bf16 v[164:167], a[172:175], v[44:47], v[164:167]
ds_read_b128 a[220:223], v2 offset:7168
v_cvt_pk_bf16_f32 v199, v150, v151
v_mfma_f32_16x16x32_bf16 v[172:175], a[172:175], v[76:79], v[92:95]
v_exp_f32 v143, v143
v_mfma_f32_16x16x32_bf16 v[172:175], a[168:171], v[72:75], v[172:175]
buffer_load_dwordx4 v1, s[44:47], s72 offen offset:3072 sc1 lds
v_mfma_f32_16x16x32_bf16 v[172:175], a[164:167], v[68:71], v[172:175]
v_exp_f32 v156, v156
v_mfma_f32_16x16x32_bf16 v[172:175], a[160:163], v[64:67], v[172:175]
v_cvt_pk_bf16_f32 v204, v140, v141
v_cvt_pk_bf16_f32 v205, v142, v143
v_mfma_f32_16x16x32_bf16 v[188:191], a[176:179], v[64:67], v[92:95]
v_exp_f32 v157, v157
v_mfma_f32_16x16x32_bf16 v[188:191], a[180:183], v[68:71], v[188:191]
v_exp_f32 v158, v158
v_mfma_f32_16x16x32_bf16 v[188:191], a[184:187], v[72:75], v[188:191]
buffer_store_dwordx4 v[112:115], v1, s[44:47], s69 offen offset:3072 sc1
v_mfma_f32_16x16x32_bf16 v[188:191], a[188:191], v[76:79], v[188:191]
v_exp_f32 v159, v159
v_mfma_f32_16x16x32_bf16 v[180:183], a[188:191], v[44:47], v[180:183]
v_cvt_pk_bf16_f32 v206, v156, v157
v_cvt_pk_bf16_f32 v207, v158, v159
v_mfma_f32_16x16x32_bf16 v[180:183], a[184:187], v[40:43], v[180:183]
v_lshrrev_b32 v6, v6, v252
v_and_b32 v6, 3, v6
v_mfma_f32_16x16x32_bf16 v[180:183], a[180:183], v[36:39], v[180:183]
v_cmp_ne_u32 vcc, 1, v249
v_mul_u32_u24 v6, 16640, v6
v_mfma_f32_16x16x32_bf16 v[168:171], a[160:163], v[48:51], v[88:91]
v_add_u32 v6, s92, v6
v_cndmask_b32 v6, v250, v6, vcc
v_mfma_f32_16x16x32_bf16 v[168:171], a[164:167], v[52:55], v[168:171]
v_add_u32 v253, s58, v249
v_and_b32 v253, 3, v253
v_mfma_f32_16x16x32_bf16 v[168:171], a[168:171], v[56:59], v[168:171]
v_mul_u32_u24 v253, 4160, v253
v_add_u32 v6, v6, v253
v_mfma_f32_16x16x32_bf16 v[168:171], a[172:175], v[60:63], v[168:171]
v_bfe_u32 v251, v0, 2, 2
v_lshl_add_u32 v6, v248, 3, v6
v_mfma_f32_16x16x32_bf16 v[184:187], a[188:191], v[60:63], v[88:91]
v_lshl_add_u32 v6, v241, 4, v6
v_lshlrev_b32 v5, 3, v251
v_mfma_f32_16x16x32_bf16 v[184:187], a[184:187], v[56:59], v[184:187]
v_lshrrev_b32 v5, v5, v252
v_and_b32 v5, 3, v5
v_mfma_f32_16x16x32_bf16 v[184:187], a[180:183], v[52:55], v[184:187]
v_cmp_ne_u32 vcc, 1, v251
v_mul_u32_u24 v5, 16640, v5
v_mfma_f32_16x16x32_bf16 v[184:187], a[176:179], v[48:51], v[184:187]
s_waitcnt lgkmcnt(4)
v_mfma_f32_16x16x32_bf16 v[224:227], v[120:123], v[208:211], v[224:227]
s_add_u32 s82, s82, 0x8000
ds_read_b128 a[160:163], v2 offset:24576
ds_read_b128 a[164:167], v2 offset:25600
v_mfma_f32_16x16x32_bf16 v[232:235], v[120:123], v[216:219], v[232:235]
s_and_b32 s82, s82, 0x1ffff
v_exp_f32 v164, v164
v_mfma_f32_16x16x32_bf16 v[232:235], v[120:123], v[200:203], v[232:235]
s_add_u32 m0, s74, 0
v_exp_f32 v165, v165
v_mfma_f32_16x16x32_bf16 a[0:3], a[224:227], v[208:211], a[0:3]
s_add_u32 s72, s81, 0
v_exp_f32 v166, v166
v_mfma_f32_16x16x32_bf16 a[64:67], a[192:195], v[200:203], a[64:67]
ds_read_b128 a[168:171], v2 offset:26624
v_cvt_pk_bf16_f32 v212, v164, v165
v_mfma_f32_16x16x32_bf16 a[64:67], a[224:227], v[216:219], a[64:67]
v_exp_f32 v167, v167
v_mfma_f32_16x16x32_bf16 a[68:71], a[228:231], v[216:219], a[68:71]
buffer_load_dwordx4 v1, s[44:47], s72 offen sc1 lds
v_mfma_f32_16x16x32_bf16 a[68:71], a[196:199], v[200:203], a[68:71]
v_exp_f32 v180, v180
v_mfma_f32_16x16x32_bf16 a[4:7], a[228:231], v[208:211], a[4:7]
ds_read_b128 a[172:175], v2 offset:27648
v_cvt_pk_bf16_f32 v213, v166, v167
v_mfma_f32_16x16x32_bf16 a[8:11], a[232:235], v[208:211], a[8:11]
v_exp_f32 v181, v181
v_mfma_f32_16x16x32_bf16 a[72:75], a[200:203], v[200:203], a[72:75]
ds_read_b128 a[176:179], v2 offset:28672
v_cvt_pk_bf16_f32 v214, v180, v181
v_mfma_f32_16x16x32_bf16 a[72:75], a[232:235], v[216:219], a[72:75]
v_exp_f32 v182, v182
v_mfma_f32_16x16x32_bf16 a[76:79], a[236:239], v[216:219], a[76:79]
v_exp_f32 v183, v183
v_mfma_f32_16x16x32_bf16 a[76:79], a[204:207], v[200:203], a[76:79]
ds_read_b128 a[180:183], v2 offset:29696
v_cvt_pk_bf16_f32 v215, v182, v183
v_mfma_f32_16x16x32_bf16 a[12:15], a[236:239], v[208:211], a[12:15]
v_exp_f32 v172, v172
v_mfma_f32_16x16x32_bf16 a[16:19], a[240:243], v[208:211], a[16:19]
s_waitcnt lgkmcnt(6)
ds_read_b128 a[184:187], v2 offset:30720
ds_read_b128 a[188:191], v2 offset:31744
v_mfma_f32_16x16x32_bf16 a[80:83], a[208:211], v[200:203], a[80:83]
v_exp_f32 v173, v173
v_mfma_f32_16x16x32_bf16 a[80:83], a[240:243], v[216:219], a[80:83]
buffer_load_dwordx4 v1, s[44:47], s72 offen offset:1024 sc1 lds
v_mfma_f32_16x16x32_bf16 a[84:87], a[244:247], v[216:219], a[84:87]
v_exp_f32 v174, v174
v_mfma_f32_16x16x32_bf16 a[84:87], a[212:215], v[200:203], a[84:87]
v_exp_f32 v175, v175
v_mfma_f32_16x16x32_bf16 a[20:23], a[244:247], v[208:211], a[20:23]
ds_read_b128 a[224:227], v2 offset:8192
v_cvt_pk_bf16_f32 v220, v172, v173
v_mfma_f32_16x16x32_bf16 a[24:27], a[248:251], v[208:211], a[24:27]
v_exp_f32 v188, v188
v_mfma_f32_16x16x32_bf16 a[88:91], a[216:219], v[200:203], a[88:91]
v_exp_f32 v189, v189
v_mfma_f32_16x16x32_bf16 a[88:91], a[248:251], v[216:219], a[88:91]
ds_read_b128 a[228:231], v2 offset:9216
v_cvt_pk_bf16_f32 v221, v174, v175
v_mfma_f32_16x16x32_bf16 a[92:95], a[252:255], v[216:219], a[92:95]
v_exp_f32 v190, v190
v_mfma_f32_16x16x32_bf16 a[92:95], a[220:223], v[200:203], a[92:95]
ds_read_b128 a[232:235], v2 offset:10240
v_cvt_pk_bf16_f32 v222, v188, v189
v_mfma_f32_16x16x32_bf16 a[28:31], a[252:255], v[208:211], a[28:31]
v_exp_f32 v191, v191
v_mfma_f32_16x16x32_bf16 v[136:139], a[128:131], v[48:51], v[88:91]
buffer_load_dwordx4 v1, s[44:47], s72 offen offset:2048 sc1 lds
v_mfma_f32_16x16x32_bf16 v[136:139], a[132:135], v[52:55], v[136:139]
v_exp_f32 v168, v168
v_mfma_f32_16x16x32_bf16 v[136:139], a[136:139], v[56:59], v[136:139]
ds_read_b128 a[236:239], v2 offset:11264
v_cvt_pk_bf16_f32 v223, v190, v191
v_mfma_f32_16x16x32_bf16 v[136:139], a[140:143], v[60:63], v[136:139]
v_exp_f32 v169, v169
v_mfma_f32_16x16x32_bf16 v[152:155], a[156:159], v[60:63], v[88:91]
ds_read_b128 a[240:243], v2 offset:12288
v_cvt_pk_bf16_f32 v216, v168, v169
v_mfma_f32_16x16x32_bf16 v[152:155], a[152:155], v[56:59], v[152:155]
v_exp_f32 v170, v170
v_mfma_f32_16x16x32_bf16 v[152:155], a[148:151], v[52:55], v[152:155]
v_exp_f32 v171, v171
v_mfma_f32_16x16x32_bf16 v[152:155], a[144:147], v[48:51], v[152:155]
ds_read_b128 a[244:247], v2 offset:13312
v_cvt_pk_bf16_f32 v217, v170, v171
v_mfma_f32_16x16x32_bf16 v[140:143], a[128:131], v[64:67], v[92:95]
v_exp_f32 v184, v184
v_mfma_f32_16x16x32_bf16 v[140:143], a[132:135], v[68:71], v[140:143]
ds_read_b128 a[248:251], v2 offset:14336
v_mfma_f32_16x16x32_bf16 v[140:143], a[136:139], v[72:75], v[140:143]
v_exp_f32 v185, v185
v_mfma_f32_16x16x32_bf16 v[140:143], a[140:143], v[76:79], v[140:143]
buffer_load_dwordx4 v1, s[44:47], s72 offen offset:3072 sc1 lds
v_mfma_f32_16x16x32_bf16 v[156:159], a[156:159], v[76:79], v[92:95]
ds_read_b128 a[252:255], v2 offset:15360
v_cvt_pk_bf16_f32 v218, v184, v185
v_mfma_f32_16x16x32_bf16 v[156:159], a[152:155], v[72:75], v[156:159]
v_exp_f32 v186, v186
v_mfma_f32_16x16x32_bf16 v[156:159], a[148:151], v[68:71], v[156:159]
s_waitcnt vmcnt(12) lgkmcnt(4)
v_exp_f32 v187, v187
v_mfma_f32_16x16x32_bf16 v[156:159], a[144:147], v[64:67], v[156:159]
s_barrier
v_cvt_pk_bf16_f32 v219, v186, v187
v_add_u32 v2, s82, v1
v_mfma_f32_16x16x32_bf16 v[228:231], v[120:123], v[196:199], v[228:231]
s_xor_b32 s74, s82, 0x10000
v_exp_f32 v136, v136
v_mfma_f32_16x16x32_bf16 v[228:231], v[120:123], v[212:215], v[228:231]
s_add_u32 s74, s74, s64
ds_read_b128 a[128:131], v2 offset:16384
v_add_u32 v5, s92, v5
v_mfma_f32_16x16x32_bf16 v[236:239], v[120:123], v[204:207], v[236:239]
s_add_u32 s81, s81, 0x8000
v_exp_f32 v137, v137
v_mfma_f32_16x16x32_bf16 v[236:239], v[120:123], v[220:223], v[236:239]
s_add_u32 m0, s74, 16384
ds_read_b128 a[132:135], v2 offset:17408
v_cvt_pk_bf16_f32 v200, v136, v137
v_mfma_f32_16x16x32_bf16 a[32:35], a[192:195], v[196:199], a[32:35]
s_add_u32 s72, s81, 16384
buffer_load_dwordx4 v1, s[44:47], s72 offen sc1 lds
v_mfma_f32_16x16x32_bf16 a[32:35], a[224:227], v[212:215], a[32:35]
s_add_u32 s69, s93, 0x4200000
v_exp_f32 v138, v138
v_mfma_f32_16x16x32_bf16 a[96:99], a[224:227], v[220:223], a[96:99]
ds_read_b128 a[136:139], v2 offset:18432
v_cndmask_b32 v5, v250, v5, vcc
v_mfma_f32_16x16x32_bf16 a[96:99], a[192:195], v[204:207], a[96:99]
v_exp_f32 v139, v139
v_mfma_f32_16x16x32_bf16 a[100:103], a[196:199], v[204:207], a[100:103]
ds_read_b128 a[140:143], v2 offset:19456
v_cvt_pk_bf16_f32 v201, v138, v139
v_mfma_f32_16x16x32_bf16 a[100:103], a[228:231], v[220:223], a[100:103]
buffer_store_dwordx4 v[112:115], v1, s[44:47], s69 offen sc1
v_mfma_f32_16x16x32_bf16 a[36:39], a[228:231], v[212:215], a[36:39]
v_exp_f32 v152, v152
v_mfma_f32_16x16x32_bf16 a[36:39], a[196:199], v[196:199], a[36:39]
ds_read_b128 a[144:147], v2 offset:20480
v_add_u32 v253, s58, v251
v_mfma_f32_16x16x32_bf16 a[40:43], a[200:203], v[196:199], a[40:43]
v_exp_f32 v153, v153
v_mfma_f32_16x16x32_bf16 a[40:43], a[232:235], v[212:215], a[40:43]
ds_read_b128 a[148:151], v2 offset:21504
v_cvt_pk_bf16_f32 v202, v152, v153
v_mfma_f32_16x16x32_bf16 a[104:107], a[232:235], v[220:223], a[104:107]
buffer_load_dwordx4 v1, s[44:47], s72 offen offset:1024 sc1 lds
v_mfma_f32_16x16x32_bf16 a[104:107], a[200:203], v[204:207], a[104:107]
v_exp_f32 v154, v154
v_mfma_f32_16x16x32_bf16 a[108:111], a[204:207], v[204:207], a[108:111]
ds_read_b128 a[152:155], v2 offset:22528
v_and_b32 v253, 3, v253
v_mfma_f32_16x16x32_bf16 a[108:111], a[236:239], v[220:223], a[108:111]
v_exp_f32 v155, v155
v_mfma_f32_16x16x32_bf16 a[44:47], a[236:239], v[212:215], a[44:47]
ds_read_b128 a[156:159], v2 offset:23552
v_cvt_pk_bf16_f32 v203, v154, v155
v_mfma_f32_16x16x32_bf16 a[44:47], a[204:207], v[196:199], a[44:47]
buffer_store_dwordx4 v[112:115], v1, s[44:47], s69 offen offset:1024 sc1
v_mfma_f32_16x16x32_bf16 a[48:51], a[208:211], v[196:199], a[48:51]
s_waitcnt lgkmcnt(8)
v_exp_f32 v140, v140
v_mfma_f32_16x16x32_bf16 a[48:51], a[240:243], v[212:215], a[48:51]
ds_read_b128 a[192:195], v2 offset:0
v_mul_u32_u24 v253, 4160, v253
v_mfma_f32_16x16x32_bf16 a[112:115], a[240:243], v[220:223], a[112:115]
v_exp_f32 v141, v141
v_mfma_f32_16x16x32_bf16 a[112:115], a[208:211], v[204:207], a[112:115]
ds_read_b128 a[196:199], v2 offset:1024
v_add_u32 v5, v5, v253
v_mfma_f32_16x16x32_bf16 a[116:119], a[212:215], v[204:207], a[116:119]
s_add_u32 s73, s62, 480
buffer_load_dwordx4 v1, s[44:47], s72 offen offset:2048 sc1 lds
v_mfma_f32_16x16x32_bf16 a[116:119], a[244:247], v[220:223], a[116:119]
v_exp_f32 v142, v142
v_mfma_f32_16x16x32_bf16 a[52:55], a[244:247], v[212:215], a[52:55]
ds_read_b128 a[200:203], v2 offset:2048
v_lshlrev_b32 v248, 5, v240
v_mfma_f32_16x16x32_bf16 a[52:55], a[212:215], v[196:199], a[52:55]
v_exp_f32 v143, v143
v_mfma_f32_16x16x32_bf16 a[56:59], a[216:219], v[196:199], a[56:59]
ds_read_b128 a[204:207], v2 offset:3072
v_sub_u32 v248, s73, v248
v_mfma_f32_16x16x32_bf16 a[56:59], a[248:251], v[212:215], a[56:59]
buffer_store_dwordx4 v[112:115], v1, s[44:47], s69 offen offset:2048 sc1
v_mfma_f32_16x16x32_bf16 a[120:123], a[248:251], v[220:223], a[120:123]
v_exp_f32 v156, v156
v_mfma_f32_16x16x32_bf16 a[120:123], a[216:219], v[204:207], a[120:123]
ds_read_b128 a[208:211], v2 offset:4096
v_lshl_add_u32 v7, v241, 4, v248
v_mfma_f32_16x16x32_bf16 a[124:127], a[220:223], v[204:207], a[124:127]
s_and_b32 s73, s58, 1
v_exp_f32 v157, v157
v_mfma_f32_16x16x32_bf16 a[124:127], a[252:255], v[220:223], a[124:127]
s_lshl_b32 s73, s73, 4
ds_read_b128 a[212:215], v2 offset:5120
v_mfma_f32_16x16x32_bf16 a[60:63], a[252:255], v[212:215], a[60:63]
s_lshr_b32 s73, s90, s73
buffer_load_dwordx4 v1, s[44:47], s72 offen offset:3072 sc1 lds
v_mfma_f32_16x16x32_bf16 a[60:63], a[220:223], v[196:199], a[60:63]
s_and_b32 s73, s73, 0xffff
ds_read_b128 a[216:219], v2 offset:6144
v_cvt_pk_bf16_f32 v204, v140, v141
v_mfma_f32_16x16x32_bf16 v[172:175], a[160:163], v[64:67], v[92:95]
v_exp_f32 v158, v158
v_mfma_f32_16x16x32_bf16 v[172:175], a[164:167], v[68:71], v[172:175]
ds_read_b128 a[220:223], v2 offset:7168
v_cvt_pk_bf16_f32 v205, v142, v143
v_mfma_f32_16x16x32_bf16 v[172:175], a[168:171], v[72:75], v[172:175]
v_exp_f32 v159, v159
v_mfma_f32_16x16x32_bf16 v[172:175], a[172:175], v[76:79], v[172:175]
buffer_store_dwordx4 v[112:115], v1, s[44:47], s69 offen offset:3072 sc1
v_mfma_f32_16x16x32_bf16 v[188:191], a[188:191], v[76:79], v[92:95]
v_cvt_pk_bf16_f32 v206, v156, v157
v_cvt_pk_bf16_f32 v207, v158, v159
v_mfma_f32_16x16x32_bf16 v[188:191], a[184:187], v[72:75], v[188:191]
v_lshl_add_u32 v248, v241, 3, v240
v_sub_u32 v248, 15, v248
v_mfma_f32_16x16x32_bf16 v[188:191], a[180:183], v[68:71], v[188:191]
v_and_b32 v249, 1, v248
v_lshlrev_b32 v249, 4, v249
v_mfma_f32_16x16x32_bf16 v[188:191], a[176:179], v[64:67], v[188:191]
v_lshlrev_b32 v249, v249, s73
v_lshrrev_b32 v248, 1, v248
v_mfma_f32_16x16x32_bf16 v[168:171], a[160:163], v[48:51], v[88:91]
v_and_b32 v241, 3, v0
v_cmp_eq_u32 vcc, 0, v248
v_mfma_f32_16x16x32_bf16 v[168:171], a[164:167], v[52:55], v[168:171]
v_lshl_add_u32 v5, v241, 3, v5
v_cndmask_b32 v8, 0, v249, vcc
v_mfma_f32_16x16x32_bf16 v[168:171], a[168:171], v[56:59], v[168:171]
v_cmp_eq_u32 vcc, 1, v248
v_lshlrev_b32 v240, 4, v251
v_mfma_f32_16x16x32_bf16 v[168:171], a[172:175], v[60:63], v[168:171]
v_cndmask_b32 v9, 0, v249, vcc
v_cmp_eq_u32 vcc, 2, v248
v_mfma_f32_16x16x32_bf16 v[184:187], a[188:191], v[60:63], v[88:91]
v_sub_u32 v240, 48, v240
v_lshlrev_b64 v[12:13], 16, s[88:89]
v_mfma_f32_16x16x32_bf16 v[184:187], a[184:187], v[56:59], v[184:187]
v_cndmask_b32 v10, 0, v249, vcc
v_cmp_eq_u32 vcc, 3, v248
v_mfma_f32_16x16x32_bf16 v[184:187], a[180:183], v[52:55], v[184:187]
v_lshlrev_b64 v[12:13], v240, v[12:13]
v_cndmask_b32 v11, 0, v249, vcc
v_mfma_f32_16x16x32_bf16 v[184:187], a[176:179], v[48:51], v[184:187]
s_waitcnt lgkmcnt(4)
v_cmp_eq_u32 vcc, 3, v241
s_add_u32 s73, s62, 4096
v_lshl_add_u32 v14, v0, 3, s73
v_cndmask_b32 v12, 0, v12, vcc
v_cndmask_b32 v13, 0, v13, vcc
v_lshrrev_b32 v15, 4, v0
v_lshlrev_b32 v15, 1, v15
v_and_b32 v240, 7, v0
v_xor_b32 v15, v15, v240
v_lshlrev_b32 v15, 4, v15
v_lshrrev_b32 v240, 3, v0
v_lshl_add_u32 v15, v240, 11, v15
s_lshl_b32 s75, s59, 1
s_andn2_b32 s75, 8, s75
s_add_u32 s75, s75, s60
s_lshl_b32 s76, s65, 2
s_lshr_b32 s80, s59, 3
s_add_u32 s76, s76, s80
s_lshl_b32 s94, s58, 16
s_lshl_b32 s80, s76, 7
s_add_u32 s94, s94, s80
s_lshl_b32 s80, s75, 18
s_add_u32 s80, s80, s94
v_rcp_f32 v224, v224
v_rcp_f32 v228, v228
s_lshl_b32 s73, s52, 12
s_add_u32 s73, s73, 0x2000000
s_lshl_b32 s70, s67, 2
s_add_u32 s70, s70, s73
v_or_b32 v3, s53, v1
v_mov_b32 v225, v224
v_accvgpr_read_b32 v240, a0
v_accvgpr_read_b32 v241, a1
v_accvgpr_read_b32 v242, a2
v_accvgpr_read_b32 v243, a3
v_accvgpr_read_b32 v244, a4
v_accvgpr_read_b32 v245, a5
v_accvgpr_read_b32 v246, a6
v_accvgpr_read_b32 v247, a7
v_pk_mul_f32 v[240:241], v[240:241], v[224:225]
v_pk_mul_f32 v[242:243], v[242:243], v[224:225]
v_pk_mul_f32 v[244:245], v[244:245], v[224:225]
v_pk_mul_f32 v[246:247], v[246:247], v[224:225]
v_cvt_pk_bf16_f32 v128, v240, v241
v_cvt_pk_bf16_f32 v129, v242, v243
v_cvt_pk_bf16_f32 v130, v244, v245
v_cvt_pk_bf16_f32 v131, v246, v247
v_accvgpr_read_b32 v248, a8
v_accvgpr_read_b32 v249, a9
v_accvgpr_read_b32 v250, a10
v_accvgpr_read_b32 v251, a11
v_accvgpr_read_b32 v252, a12
v_accvgpr_read_b32 v253, a13
v_accvgpr_read_b32 v254, a14
v_accvgpr_read_b32 v255, a15
v_pk_mul_f32 v[248:249], v[248:249], v[224:225]
v_pk_mul_f32 v[250:251], v[250:251], v[224:225]
v_pk_mul_f32 v[252:253], v[252:253], v[224:225]
v_pk_mul_f32 v[254:255], v[254:255], v[224:225]
v_cvt_pk_bf16_f32 v144, v248, v249
v_cvt_pk_bf16_f32 v145, v250, v251
v_cvt_pk_bf16_f32 v146, v252, v253
v_cvt_pk_bf16_f32 v147, v254, v255
v_accvgpr_read_b32 v240, a16
v_accvgpr_read_b32 v241, a17
v_accvgpr_read_b32 v242, a18
v_accvgpr_read_b32 v243, a19
v_accvgpr_read_b32 v244, a20
v_accvgpr_read_b32 v245, a21
v_accvgpr_read_b32 v246, a22
v_accvgpr_read_b32 v247, a23
v_pk_mul_f32 v[240:241], v[240:241], v[224:225]
v_pk_mul_f32 v[242:243], v[242:243], v[224:225]
v_pk_mul_f32 v[244:245], v[244:245], v[224:225]
v_pk_mul_f32 v[246:247], v[246:247], v[224:225]
v_cvt_pk_bf16_f32 v160, v240, v241
v_cvt_pk_bf16_f32 v161, v242, v243
v_cvt_pk_bf16_f32 v162, v244, v245
v_cvt_pk_bf16_f32 v163, v246, v247
v_accvgpr_read_b32 v248, a24
v_accvgpr_read_b32 v249, a25
v_accvgpr_read_b32 v250, a26
v_accvgpr_read_b32 v251, a27
v_accvgpr_read_b32 v252, a28
v_accvgpr_read_b32 v253, a29
v_accvgpr_read_b32 v254, a30
v_accvgpr_read_b32 v255, a31
v_pk_mul_f32 v[248:249], v[248:249], v[224:225]
v_pk_mul_f32 v[250:251], v[250:251], v[224:225]
v_pk_mul_f32 v[252:253], v[252:253], v[224:225]
v_pk_mul_f32 v[254:255], v[254:255], v[224:225]
v_cvt_pk_bf16_f32 v176, v248, v249
v_cvt_pk_bf16_f32 v177, v250, v251
v_cvt_pk_bf16_f32 v178, v252, v253
v_cvt_pk_bf16_f32 v179, v254, v255
v_mov_b32 v229, v228
v_accvgpr_read_b32 v240, a32
v_accvgpr_read_b32 v241, a33
v_accvgpr_read_b32 v242, a34
v_accvgpr_read_b32 v243, a35
v_accvgpr_read_b32 v244, a36
v_accvgpr_read_b32 v245, a37
v_accvgpr_read_b32 v246, a38
v_accvgpr_read_b32 v247, a39
v_pk_mul_f32 v[240:241], v[240:241], v[228:229]
v_pk_mul_f32 v[242:243], v[242:243], v[228:229]
v_pk_mul_f32 v[244:245], v[244:245], v[228:229]
v_pk_mul_f32 v[246:247], v[246:247], v[228:229]
v_cvt_pk_bf16_f32 v132, v240, v241
Lstub5:
s_cbranch_execz Lstub9
v_cvt_pk_bf16_f32 v133, v242, v243
v_cvt_pk_bf16_f32 v134, v244, v245
v_cvt_pk_bf16_f32 v135, v246, v247
v_accvgpr_read_b32 v248, a40
v_accvgpr_read_b32 v249, a41
v_accvgpr_read_b32 v250, a42
v_accvgpr_read_b32 v251, a43
v_accvgpr_read_b32 v252, a44
v_accvgpr_read_b32 v253, a45
v_accvgpr_read_b32 v254, a46
v_accvgpr_read_b32 v255, a47
v_pk_mul_f32 v[248:249], v[248:249], v[228:229]
v_pk_mul_f32 v[250:251], v[250:251], v[228:229]
v_pk_mul_f32 v[252:253], v[252:253], v[228:229]
v_pk_mul_f32 v[254:255], v[254:255], v[228:229]
v_cvt_pk_bf16_f32 v148, v248, v249
v_cvt_pk_bf16_f32 v149, v250, v251
v_cvt_pk_bf16_f32 v150, v252, v253
v_cvt_pk_bf16_f32 v151, v254, v255
v_accvgpr_read_b32 v240, a48
v_accvgpr_read_b32 v241, a49
v_accvgpr_read_b32 v242, a50
v_accvgpr_read_b32 v243, a51
v_accvgpr_read_b32 v244, a52
v_accvgpr_read_b32 v245, a53
v_accvgpr_read_b32 v246, a54
v_accvgpr_read_b32 v247, a55
v_pk_mul_f32 v[240:241], v[240:241], v[228:229]
v_pk_mul_f32 v[242:243], v[242:243], v[228:229]
v_pk_mul_f32 v[244:245], v[244:245], v[228:229]
v_pk_mul_f32 v[246:247], v[246:247], v[228:229]
v_cvt_pk_bf16_f32 v164, v240, v241
v_cvt_pk_bf16_f32 v165, v242, v243
v_cvt_pk_bf16_f32 v166, v244, v245
v_cvt_pk_bf16_f32 v167, v246, v247
v_accvgpr_read_b32 v248, a56
v_accvgpr_read_b32 v249, a57
v_accvgpr_read_b32 v250, a58
v_accvgpr_read_b32 v251, a59
v_accvgpr_read_b32 v252, a60
v_accvgpr_read_b32 v253, a61
v_accvgpr_read_b32 v254, a62
v_accvgpr_read_b32 v255, a63
v_pk_mul_f32 v[248:249], v[248:249], v[228:229]
v_pk_mul_f32 v[250:251], v[250:251], v[228:229]
v_pk_mul_f32 v[252:253], v[252:253], v[228:229]
v_pk_mul_f32 v[254:255], v[254:255], v[228:229]
v_cvt_pk_bf16_f32 v180, v248, v249
v_cvt_pk_bf16_f32 v181, v250, v251
v_cvt_pk_bf16_f32 v182, v252, v253
v_cvt_pk_bf16_f32 v183, v254, v255
v_mfma_f32_16x16x32_bf16 v[232:235], v[120:123], v[216:219], v[232:235]
s_add_u32 s82, s82, 0x8000
ds_read_b128 a[160:163], v2 offset:24576
ds_read_b128 a[164:167], v2 offset:25600
v_mfma_f32_16x16x32_bf16 v[232:235], v[120:123], v[200:203], v[232:235]
s_and_b32 s82, s82, 0x1ffff
v_exp_f32 v172, v172
v_mfma_f32_16x16x32_bf16 a[64:67], a[224:227], v[216:219], a[64:67]
s_add_u32 m0, s74, 0
v_exp_f32 v173, v173
v_mfma_f32_16x16x32_bf16 a[64:67], a[192:195], v[200:203], a[64:67]
s_add_u32 s72, s81, 0
buffer_load_dwordx4 v1, s[44:47], s72 offen sc1 lds
v_mfma_f32_16x16x32_bf16 a[68:71], a[196:199], v[200:203], a[68:71]
ds_read_b128 a[168:171], v2 offset:26624
v_cvt_pk_bf16_f32 v220, v172, v173
v_mfma_f32_16x16x32_bf16 a[68:71], a[228:231], v[216:219], a[68:71]
v_exp_f32 v174, v174
v_mfma_f32_16x16x32_bf16 a[72:75], a[232:235], v[216:219], a[72:75]
s_nop 0
ds_read_b128 a[172:175], v2 offset:27648
ds_read_b128 a[176:179], v2 offset:28672
v_mfma_f32_16x16x32_bf16 a[72:75], a[200:203], v[200:203], a[72:75]
v_exp_f32 v175, v175
v_mfma_f32_16x16x32_bf16 a[76:79], a[204:207], v[200:203], a[76:79]
v_exp_f32 v188, v188
v_mfma_f32_16x16x32_bf16 a[76:79], a[236:239], v[216:219], a[76:79]
buffer_store_dwordx4 v[128:131], v3, s[44:47], s70 offen sc1
v_mfma_f32_16x16x32_bf16 a[80:83], a[240:243], v[216:219], a[80:83]
s_waitcnt lgkmcnt(5)
ds_read_b128 a[180:183], v2 offset:29696
v_cvt_pk_bf16_f32 v221, v174, v175
v_mfma_f32_16x16x32_bf16 a[80:83], a[208:211], v[200:203], a[80:83]
v_exp_f32 v189, v189
v_mfma_f32_16x16x32_bf16 a[84:87], a[212:215], v[200:203], a[84:87]
ds_read_b128 a[184:187], v2 offset:30720
v_cvt_pk_bf16_f32 v222, v188, v189
v_mfma_f32_16x16x32_bf16 a[84:87], a[244:247], v[216:219], a[84:87]
v_exp_f32 v190, v190
v_mfma_f32_16x16x32_bf16 a[88:91], a[248:251], v[216:219], a[88:91]
buffer_load_dwordx4 v1, s[44:47], s72 offen offset:1024 sc1 lds
v_mfma_f32_16x16x32_bf16 a[88:91], a[216:219], v[200:203], a[88:91]
s_nop 0
ds_read_b128 a[188:191], v2 offset:31744
ds_read_b128 a[224:227], v2 offset:8192
v_mfma_f32_16x16x32_bf16 a[92:95], a[220:223], v[200:203], a[92:95]
v_exp_f32 v191, v191
v_mfma_f32_16x16x32_bf16 a[92:95], a[252:255], v[216:219], a[92:95]
v_exp_f32 v168, v168
v_mfma_f32_16x16x32_bf16 v[136:139], a[128:131], v[48:51], v[88:91]
ds_read_b128 a[228:231], v2 offset:9216
v_cvt_pk_bf16_f32 v223, v190, v191
v_mfma_f32_16x16x32_bf16 v[136:139], a[132:135], v[52:55], v[136:139]
v_exp_f32 v169, v169
v_mfma_f32_16x16x32_bf16 v[136:139], a[136:139], v[56:59], v[136:139]
buffer_store_dwordx4 v[144:147], v3, s[44:47], s70 offen offset:1024 sc1
v_mfma_f32_16x16x32_bf16 v[136:139], a[140:143], v[60:63], v[136:139]
ds_read_b128 a[232:235], v2 offset:10240
v_cvt_pk_bf16_f32 v216, v168, v169
v_mfma_f32_16x16x32_bf16 v[152:155], a[156:159], v[60:63], v[88:91]
v_exp_f32 v170, v170
v_mfma_f32_16x16x32_bf16 v[152:155], a[152:155], v[56:59], v[152:155]
s_nop 0
ds_read_b128 a[236:239], v2 offset:11264
ds_read_b128 a[240:243], v2 offset:12288
v_mfma_f32_16x16x32_bf16 v[152:155], a[148:151], v[52:55], v[152:155]
v_exp_f32 v171, v171
v_mfma_f32_16x16x32_bf16 v[152:155], a[144:147], v[48:51], v[152:155]
buffer_load_dwordx4 v1, s[44:47], s72 offen offset:2048 sc1 lds
v_mfma_f32_16x16x32_bf16 v[140:143], a[128:131], v[64:67], v[92:95]
v_exp_f32 v184, v184
v_mfma_f32_16x16x32_bf16 v[140:143], a[132:135], v[68:71], v[140:143]
ds_read_b128 a[244:247], v2 offset:13312
v_cvt_pk_bf16_f32 v217, v170, v171
v_mfma_f32_16x16x32_bf16 v[140:143], a[136:139], v[72:75], v[140:143]
v_exp_f32 v185, v185
v_mfma_f32_16x16x32_bf16 v[140:143], a[140:143], v[76:79], v[140:143]
s_nop 0
ds_read_b128 a[248:251], v2 offset:14336
ds_read_b128 a[252:255], v2 offset:15360
v_mfma_f32_16x16x32_bf16 v[156:159], a[156:159], v[76:79], v[92:95]
v_exp_f32 v186, v186
v_mfma_f32_16x16x32_bf16 v[156:159], a[152:155], v[72:75], v[156:159]
buffer_load_dwordx4 v1, s[44:47], s72 offen offset:3072 sc1 lds
v_mfma_f32_16x16x32_bf16 v[156:159], a[148:151], v[68:71], v[156:159]
s_waitcnt vmcnt(14) lgkmcnt(4)
v_exp_f32 v187, v187
v_mfma_f32_16x16x32_bf16 v[156:159], a[144:147], v[64:67], v[156:159]
s_barrier
v_cvt_pk_bf16_f32 v218, v184, v185
v_cvt_pk_bf16_f32 v219, v186, v187
v_add_u32 v2, s82, v1
v_mfma_f32_16x16x32_bf16 v[236:239], v[120:123], v[204:207], v[236:239]
s_xor_b32 s74, s82, 0x10000
v_exp_f32 v136, v136
v_mfma_f32_16x16x32_bf16 v[236:239], v[120:123], v[220:223], v[236:239]
s_add_u32 s74, s74, s64
ds_read_b128 a[128:131], v2 offset:16384
ds_read_b128 a[132:135], v2 offset:17408
v_mfma_f32_16x16x32_bf16 a[96:99], a[192:195], v[204:207], a[96:99]
s_add_u32 s81, s81, 0x8000
v_exp_f32 v137, v137
v_mfma_f32_16x16x32_bf16 a[96:99], a[224:227], v[220:223], a[96:99]
s_add_u32 m0, s74, 16384
v_exp_f32 v138, v138
v_mfma_f32_16x16x32_bf16 a[100:103], a[228:231], v[220:223], a[100:103]
s_add_u32 s72, s81, 16384
buffer_load_dwordx4 v1, s[44:47], s72 offen sc1 lds
v_mfma_f32_16x16x32_bf16 a[100:103], a[196:199], v[204:207], a[100:103]
ds_read_b128 a[136:139], v2 offset:18432
v_cvt_pk_bf16_f32 v200, v136, v137
v_mfma_f32_16x16x32_bf16 a[104:107], a[200:203], v[204:207], a[104:107]
v_exp_f32 v139, v139
v_mfma_f32_16x16x32_bf16 a[104:107], a[232:235], v[220:223], a[104:107]
ds_read_b128 a[140:143], v2 offset:19456
v_cvt_pk_bf16_f32 v201, v138, v139
v_mfma_f32_16x16x32_bf16 a[108:111], a[236:239], v[220:223], a[108:111]
buffer_store_dwordx4 v[160:163], v3, s[44:47], s70 offen offset:2048 sc1
v_mfma_f32_16x16x32_bf16 a[108:111], a[204:207], v[204:207], a[108:111]
v_exp_f32 v152, v152
v_mfma_f32_16x16x32_bf16 a[112:115], a[208:211], v[204:207], a[112:115]
s_waitcnt lgkmcnt(4)
ds_read_b128 a[144:147], v2 offset:20480
ds_read_b128 a[148:151], v2 offset:21504
v_mfma_f32_16x16x32_bf16 a[112:115], a[240:243], v[220:223], a[112:115]
v_exp_f32 v153, v153
v_mfma_f32_16x16x32_bf16 a[116:119], a[244:247], v[220:223], a[116:119]
buffer_load_dwordx4 v1, s[44:47], s72 offen offset:1024 sc1 lds
v_mfma_f32_16x16x32_bf16 a[116:119], a[212:215], v[204:207], a[116:119]
v_exp_f32 v154, v154
v_mfma_f32_16x16x32_bf16 a[120:123], a[216:219], v[204:207], a[120:123]
ds_read_b128 a[152:155], v2 offset:22528
v_cvt_pk_bf16_f32 v202, v152, v153
v_mfma_f32_16x16x32_bf16 a[120:123], a[248:251], v[220:223], a[120:123]
v_exp_f32 v155, v155
v_mfma_f32_16x16x32_bf16 a[124:127], a[252:255], v[220:223], a[124:127]
ds_read_b128 a[156:159], v2 offset:23552
v_cvt_pk_bf16_f32 v203, v154, v155
v_mfma_f32_16x16x32_bf16 a[124:127], a[220:223], v[204:207], a[124:127]
v_exp_f32 v140, v140
v_mfma_f32_16x16x32_bf16 v[172:175], a[160:163], v[64:67], v[92:95]
s_nop 0
ds_read_b128 a[192:195], v2 offset:0
ds_read_b128 a[196:199], v2 offset:1024
v_mfma_f32_16x16x32_bf16 v[172:175], a[164:167], v[68:71], v[172:175]
buffer_store_dwordx4 v[176:179], v3, s[44:47], s70 offen offset:3072 sc1
v_mfma_f32_16x16x32_bf16 v[172:175], a[168:171], v[72:75], v[172:175]
v_exp_f32 v141, v141
v_mfma_f32_16x16x32_bf16 v[172:175], a[172:175], v[76:79], v[172:175]
v_exp_f32 v142, v142
v_mfma_f32_16x16x32_bf16 v[188:191], a[188:191], v[76:79], v[92:95]
s_nop 0
ds_read_b128 a[200:203], v2 offset:2048
ds_read_b128 a[204:207], v2 offset:3072
v_mfma_f32_16x16x32_bf16 v[188:191], a[184:187], v[72:75], v[188:191]
buffer_load_dwordx4 v1, s[44:47], s72 offen offset:2048 sc1 lds
v_mfma_f32_16x16x32_bf16 v[188:191], a[180:183], v[68:71], v[188:191]
s_add_u32 s70, s70, 0x80000
v_exp_f32 v143, v143
v_mfma_f32_16x16x32_bf16 v[188:191], a[176:179], v[64:67], v[188:191]
v_exp_f32 v156, v156
v_mfma_f32_16x16x32_bf16 v[168:171], a[160:163], v[48:51], v[88:91]
s_nop 0
ds_read_b128 a[208:211], v2 offset:4096
ds_read_b128 a[212:215], v2 offset:5120
v_mfma_f32_16x16x32_bf16 v[168:171], a[164:167], v[52:55], v[168:171]
s_nop 0
ds_read_b128 a[216:219], v2 offset:6144
ds_read_b128 a[220:223], v2 offset:7168
v_mfma_f32_16x16x32_bf16 v[168:171], a[168:171], v[56:59], v[168:171]
v_cvt_pk_bf16_f32 v204, v140, v141
v_cvt_pk_bf16_f32 v205, v142, v143
v_mfma_f32_16x16x32_bf16 v[168:171], a[172:175], v[60:63], v[168:171]
buffer_store_dwordx4 v[132:135], v3, s[44:47], s70 offen sc1
v_mfma_f32_16x16x32_bf16 v[184:187], a[188:191], v[60:63], v[88:91]
v_exp_f32 v157, v157
v_mfma_f32_16x16x32_bf16 v[184:187], a[184:187], v[56:59], v[184:187]
v_exp_f32 v158, v158
v_mfma_f32_16x16x32_bf16 v[184:187], a[180:183], v[52:55], v[184:187]
buffer_load_dwordx4 v1, s[44:47], s72 offen offset:3072 sc1 lds
v_mfma_f32_16x16x32_bf16 v[184:187], a[176:179], v[48:51], v[184:187]
s_waitcnt lgkmcnt(4)
v_exp_f32 v159, v159
v_cvt_pk_bf16_f32 v206, v156, v157
v_cvt_pk_bf16_f32 v207, v158, v159
v_mfma_f32_16x16x32_bf16 v[232:235], v[120:123], v[216:219], v[232:235]
s_add_u32 s82, s82, 0x8000
ds_read_b128 a[160:163], v2 offset:24576
ds_read_b128 a[164:167], v2 offset:25600
v_mfma_f32_16x16x32_bf16 v[232:235], v[120:123], v[200:203], v[232:235]
s_and_b32 s82, s82, 0x1ffff
v_exp_f32 v172, v172
v_mfma_f32_16x16x32_bf16 a[64:67], a[224:227], v[216:219], a[64:67]
s_add_u32 m0, s74, 0
v_exp_f32 v173, v173
v_mfma_f32_16x16x32_bf16 a[64:67], a[192:195], v[200:203], a[64:67]
s_add_u32 s72, s81, 0
buffer_load_dwordx4 v1, s[44:47], s72 offen sc1 lds
v_mfma_f32_16x16x32_bf16 a[68:71], a[196:199], v[200:203], a[68:71]
ds_read_b128 a[168:171], v2 offset:26624
v_cvt_pk_bf16_f32 v220, v172, v173
v_mfma_f32_16x16x32_bf16 a[68:71], a[228:231], v[216:219], a[68:71]
v_exp_f32 v174, v174
v_mfma_f32_16x16x32_bf16 a[72:75], a[232:235], v[216:219], a[72:75]
s_nop 0
ds_read_b128 a[172:175], v2 offset:27648
ds_read_b128 a[176:179], v2 offset:28672
v_mfma_f32_16x16x32_bf16 a[72:75], a[200:203], v[200:203], a[72:75]
v_exp_f32 v175, v175
v_mfma_f32_16x16x32_bf16 a[76:79], a[204:207], v[200:203], a[76:79]
buffer_store_dwordx4 v[148:151], v3, s[44:47], s70 offen offset:1024 sc1
v_mfma_f32_16x16x32_bf16 a[76:79], a[236:239], v[216:219], a[76:79]
v_exp_f32 v188, v188
v_mfma_f32_16x16x32_bf16 a[80:83], a[240:243], v[216:219], a[80:83]
s_waitcnt lgkmcnt(5)
ds_read_b128 a[180:183], v2 offset:29696
v_cvt_pk_bf16_f32 v221, v174, v175
v_mfma_f32_16x16x32_bf16 a[80:83], a[208:211], v[200:203], a[80:83]
v_exp_f32 v189, v189
v_mfma_f32_16x16x32_bf16 a[84:87], a[212:215], v[200:203], a[84:87]
buffer_load_dwordx4 v1, s[44:47], s72 offen offset:1024 sc1 lds
v_mfma_f32_16x16x32_bf16 a[84:87], a[244:247], v[216:219], a[84:87]
ds_read_b128 a[184:187], v2 offset:30720
v_cvt_pk_bf16_f32 v222, v188, v189
v_mfma_f32_16x16x32_bf16 a[88:91], a[248:251], v[216:219], a[88:91]
v_exp_f32 v190, v190
v_mfma_f32_16x16x32_bf16 a[88:91], a[216:219], v[200:203], a[88:91]
s_nop 0
ds_read_b128 a[188:191], v2 offset:31744
ds_read_b128 a[224:227], v2 offset:8192
v_mfma_f32_16x16x32_bf16 a[92:95], a[220:223], v[200:203], a[92:95]
v_exp_f32 v191, v191
v_mfma_f32_16x16x32_bf16 a[92:95], a[252:255], v[216:219], a[92:95]
buffer_store_dwordx4 v[164:167], v3, s[44:47], s70 offen offset:2048 sc1
v_mfma_f32_16x16x32_bf16 v[136:139], a[128:131], v[48:51], v[88:91]
v_exp_f32 v168, v168
v_mfma_f32_16x16x32_bf16 v[136:139], a[132:135], v[52:55], v[136:139]
ds_read_b128 a[228:231], v2 offset:9216
v_cvt_pk_bf16_f32 v223, v190, v191
v_mfma_f32_16x16x32_bf16 v[136:139], a[136:139], v[56:59], v[136:139]
v_exp_f32 v169, v169
v_mfma_f32_16x16x32_bf16 v[136:139], a[140:143], v[60:63], v[136:139]
s_nop 0
ds_read_b128 a[232:235], v2 offset:10240
ds_read_b128 a[236:239], v2 offset:11264
v_mfma_f32_16x16x32_bf16 v[152:155], a[156:159], v[60:63], v[88:91]
v_exp_f32 v170, v170
v_mfma_f32_16x16x32_bf16 v[152:155], a[152:155], v[56:59], v[152:155]
buffer_load_dwordx4 v1, s[44:47], s72 offen offset:2048 sc1 lds
v_mfma_f32_16x16x32_bf16 v[152:155], a[148:151], v[52:55], v[152:155]
v_exp_f32 v171, v171
v_mfma_f32_16x16x32_bf16 v[152:155], a[144:147], v[48:51], v[152:155]
s_nop 0
ds_read_b128 a[240:243], v2 offset:12288
ds_read_b128 a[244:247], v2 offset:13312
v_mfma_f32_16x16x32_bf16 v[140:143], a[128:131], v[64:67], v[92:95]
v_exp_f32 v184, v184
v_mfma_f32_16x16x32_bf16 v[140:143], a[132:135], v[68:71], v[140:143]
s_nop 0
ds_read_b128 a[248:251], v2 offset:14336
ds_read_b128 a[252:255], v2 offset:15360
v_mfma_f32_16x16x32_bf16 v[140:143], a[136:139], v[72:75], v[140:143]
v_cvt_pk_bf16_f32 v216, v168, v169
v_cvt_pk_bf16_f32 v217, v170, v171
v_mfma_f32_16x16x32_bf16 v[140:143], a[140:143], v[76:79], v[140:143]
buffer_store_dwordx4 v[180:183], v3, s[44:47], s70 offen offset:3072 sc1
v_mfma_f32_16x16x32_bf16 v[156:159], a[156:159], v[76:79], v[92:95]
v_exp_f32 v185, v185
v_mfma_f32_16x16x32_bf16 v[156:159], a[152:155], v[72:75], v[156:159]
buffer_load_dwordx4 v1, s[44:47], s72 offen offset:3072 sc1 lds
v_mfma_f32_16x16x32_bf16 v[156:159], a[148:151], v[68:71], v[156:159]
s_waitcnt vmcnt(14) lgkmcnt(4)
v_exp_f32 v186, v186
v_mfma_f32_16x16x32_bf16 v[156:159], a[144:147], v[64:67], v[156:159]
s_barrier
v_exp_f32 v187, v187
v_add_u32 v2, s82, v1
v_cvt_pk_bf16_f32 v218, v184, v185
v_cvt_pk_bf16_f32 v219, v186, v187
s_lshl_b32 s83, s60, 2
s_sub_u32 s83, s83, 25
.p2align 5
s_nop 0
s_nop 0
LloopII:
v_mfma_f32_16x16x32_bf16 v[236:239], v[120:123], v[204:207], v[236:239]
s_xor_b32 s74, s82, 0x10000
v_exp_f32 v136, v136
v_mfma_f32_16x16x32_bf16 v[236:239], v[120:123], v[220:223], v[236:239]
s_add_u32 s74, s74, s64
ds_read_b128 a[128:131], v2 offset:16384
ds_read_b128 a[132:135], v2 offset:17408
v_mfma_f32_16x16x32_bf16 a[96:99], a[192:195], v[204:207], a[96:99]
s_add_u32 s81, s81, 0x8000
v_exp_f32 v137, v137
v_mfma_f32_16x16x32_bf16 a[96:99], a[224:227], v[220:223], a[96:99]
s_add_u32 m0, s74, 16384
v_exp_f32 v138, v138
v_mfma_f32_16x16x32_bf16 a[100:103], a[228:231], v[220:223], a[100:103]
s_add_u32 s72, s81, 16384
ds_read_b128 a[136:139], v2 offset:18432
v_cvt_pk_bf16_f32 v200, v136, v137
v_mfma_f32_16x16x32_bf16 a[100:103], a[196:199], v[204:207], a[100:103]
buffer_load_dwordx4 v1, s[44:47], s72 offen sc1 lds
v_mfma_f32_16x16x32_bf16 a[104:107], a[200:203], v[204:207], a[104:107]
v_exp_f32 v139, v139
v_mfma_f32_16x16x32_bf16 a[104:107], a[232:235], v[220:223], a[104:107]
ds_read_b128 a[140:143], v2 offset:19456
v_cvt_pk_bf16_f32 v201, v138, v139
v_mfma_f32_16x16x32_bf16 a[108:111], a[236:239], v[220:223], a[108:111]
v_exp_f32 v152, v152
v_mfma_f32_16x16x32_bf16 a[108:111], a[204:207], v[204:207], a[108:111]
s_nop 0
ds_read_b128 a[144:147], v2 offset:20480
ds_read_b128 a[148:151], v2 offset:21504
v_mfma_f32_16x16x32_bf16 a[112:115], a[208:211], v[204:207], a[112:115]
s_waitcnt lgkmcnt(6)
v_exp_f32 v153, v153
v_mfma_f32_16x16x32_bf16 a[112:115], a[240:243], v[220:223], a[112:115]
v_exp_f32 v154, v154
v_mfma_f32_16x16x32_bf16 a[116:119], a[244:247], v[220:223], a[116:119]
ds_read_b128 a[152:155], v2 offset:22528
v_cvt_pk_bf16_f32 v202, v152, v153
v_mfma_f32_16x16x32_bf16 a[116:119], a[212:215], v[204:207], a[116:119]
buffer_load_dwordx4 v1, s[44:47], s72 offen offset:1024 sc1 lds
v_mfma_f32_16x16x32_bf16 a[120:123], a[216:219], v[204:207], a[120:123]
v_exp_f32 v155, v155
v_mfma_f32_16x16x32_bf16 a[120:123], a[248:251], v[220:223], a[120:123]
ds_read_b128 a[156:159], v2 offset:23552
v_cvt_pk_bf16_f32 v203, v154, v155
v_mfma_f32_16x16x32_bf16 a[124:127], a[252:255], v[220:223], a[124:127]
v_exp_f32 v140, v140
v_mfma_f32_16x16x32_bf16 a[124:127], a[220:223], v[204:207], a[124:127]
s_nop 0
ds_read_b128 a[192:195], v2 offset:0
ds_read_b128 a[196:199], v2 offset:1024
v_mfma_f32_16x16x32_bf16 v[172:175], a[160:163], v[64:67], v[92:95]
v_exp_f32 v141, v141
v_mfma_f32_16x16x32_bf16 v[172:175], a[164:167], v[68:71], v[172:175]
v_exp_f32 v142, v142
v_mfma_f32_16x16x32_bf16 v[172:175], a[168:171], v[72:75], v[172:175]
ds_read_b128 a[200:203], v2 offset:2048
v_cvt_pk_bf16_f32 v204, v140, v141
v_mfma_f32_16x16x32_bf16 v[172:175], a[172:175], v[76:79], v[172:175]
buffer_load_dwordx4 v1, s[44:47], s72 offen offset:2048 sc1 lds
v_mfma_f32_16x16x32_bf16 v[188:191], a[188:191], v[76:79], v[92:95]
v_exp_f32 v143, v143
v_mfma_f32_16x16x32_bf16 v[188:191], a[184:187], v[72:75], v[188:191]
ds_read_b128 a[204:207], v2 offset:3072
v_cvt_pk_bf16_f32 v205, v142, v143
v_mfma_f32_16x16x32_bf16 v[188:191], a[180:183], v[68:71], v[188:191]
v_exp_f32 v156, v156
v_mfma_f32_16x16x32_bf16 v[188:191], a[176:179], v[64:67], v[188:191]
ds_read_b128 a[208:211], v2 offset:4096
v_mfma_f32_16x16x32_bf16 v[168:171], a[160:163], v[48:51], v[88:91]
v_exp_f32 v157, v157
v_mfma_f32_16x16x32_bf16 v[168:171], a[164:167], v[52:55], v[168:171]
ds_read_b128 a[212:215], v2 offset:5120
v_cvt_pk_bf16_f32 v206, v156, v157
v_mfma_f32_16x16x32_bf16 v[168:171], a[168:171], v[56:59], v[168:171]
v_exp_f32 v158, v158
v_mfma_f32_16x16x32_bf16 v[168:171], a[172:175], v[60:63], v[168:171]
ds_read_b128 a[216:219], v2 offset:6144
v_mfma_f32_16x16x32_bf16 v[184:187], a[188:191], v[60:63], v[88:91]
buffer_load_dwordx4 v1, s[44:47], s72 offen offset:3072 sc1 lds
v_mfma_f32_16x16x32_bf16 v[184:187], a[184:187], v[56:59], v[184:187]
v_exp_f32 v159, v159
v_mfma_f32_16x16x32_bf16 v[184:187], a[180:183], v[52:55], v[184:187]
ds_read_b128 a[220:223], v2 offset:7168
v_cvt_pk_bf16_f32 v207, v158, v159
v_mfma_f32_16x16x32_bf16 v[184:187], a[176:179], v[48:51], v[184:187]
s_waitcnt lgkmcnt(4)
v_mfma_f32_16x16x32_bf16 v[232:235], v[120:123], v[216:219], v[232:235]
s_add_u32 s82, s82, 0x8000
ds_read_b128 a[160:163], v2 offset:24576
ds_read_b128 a[164:167], v2 offset:25600
v_mfma_f32_16x16x32_bf16 v[232:235], v[120:123], v[200:203], v[232:235]
s_and_b32 s82, s82, 0x1ffff
v_exp_f32 v172, v172
v_mfma_f32_16x16x32_bf16 a[64:67], a[224:227], v[216:219], a[64:67]
s_add_u32 m0, s74, 0
v_exp_f32 v173, v173
v_mfma_f32_16x16x32_bf16 a[64:67], a[192:195], v[200:203], a[64:67]
s_add_u32 s72, s81, 0
ds_read_b128 a[168:171], v2 offset:26624
v_cvt_pk_bf16_f32 v220, v172, v173
v_mfma_f32_16x16x32_bf16 a[68:71], a[196:199], v[200:203], a[68:71]
v_exp_f32 v174, v174
v_mfma_f32_16x16x32_bf16 a[68:71], a[228:231], v[216:219], a[68:71]
buffer_load_dwordx4 v1, s[44:47], s72 offen sc1 lds
v_mfma_f32_16x16x32_bf16 a[72:75], a[232:235], v[216:219], a[72:75]
s_nop 0
ds_read_b128 a[172:175], v2 offset:27648
ds_read_b128 a[176:179], v2 offset:28672
v_mfma_f32_16x16x32_bf16 a[72:75], a[200:203], v[200:203], a[72:75]
v_exp_f32 v175, v175
v_mfma_f32_16x16x32_bf16 a[76:79], a[204:207], v[200:203], a[76:79]
v_exp_f32 v188, v188
v_mfma_f32_16x16x32_bf16 a[76:79], a[236:239], v[216:219], a[76:79]
ds_read_b128 a[180:183], v2 offset:29696
v_cvt_pk_bf16_f32 v221, v174, v175
v_mfma_f32_16x16x32_bf16 a[80:83], a[240:243], v[216:219], a[80:83]
s_waitcnt lgkmcnt(6)
v_exp_f32 v189, v189
v_mfma_f32_16x16x32_bf16 a[80:83], a[208:211], v[200:203], a[80:83]
ds_read_b128 a[184:187], v2 offset:30720
v_cvt_pk_bf16_f32 v222, v188, v189
v_mfma_f32_16x16x32_bf16 a[84:87], a[212:215], v[200:203], a[84:87]
buffer_load_dwordx4 v1, s[44:47], s72 offen offset:1024 sc1 lds
v_mfma_f32_16x16x32_bf16 a[84:87], a[244:247], v[216:219], a[84:87]
v_exp_f32 v190, v190
v_mfma_f32_16x16x32_bf16 a[88:91], a[248:251], v[216:219], a[88:91]
s_nop 0
ds_read_b128 a[188:191], v2 offset:31744
ds_read_b128 a[224:227], v2 offset:8192
v_mfma_f32_16x16x32_bf16 a[88:91], a[216:219], v[200:203], a[88:91]
v_exp_f32 v191, v191
v_mfma_f32_16x16x32_bf16 a[92:95], a[220:223], v[200:203], a[92:95]
v_exp_f32 v168, v168
v_mfma_f32_16x16x32_bf16 a[92:95], a[252:255], v[216:219], a[92:95]
ds_read_b128 a[228:231], v2 offset:9216
v_cvt_pk_bf16_f32 v223, v190, v191
v_mfma_f32_16x16x32_bf16 v[136:139], a[128:131], v[48:51], v[88:91]
v_exp_f32 v169, v169
v_mfma_f32_16x16x32_bf16 v[136:139], a[132:135], v[52:55], v[136:139]
ds_read_b128 a[232:235], v2 offset:10240
v_cvt_pk_bf16_f32 v216, v168, v169
v_mfma_f32_16x16x32_bf16 v[136:139], a[136:139], v[56:59], v[136:139]
buffer_load_dwordx4 v1, s[44:47], s72 offen offset:2048 sc1 lds
v_mfma_f32_16x16x32_bf16 v[136:139], a[140:143], v[60:63], v[136:139]
v_exp_f32 v170, v170
v_mfma_f32_16x16x32_bf16 v[152:155], a[156:159], v[60:63], v[88:91]
s_nop 0
ds_read_b128 a[236:239], v2 offset:11264
ds_read_b128 a[240:243], v2 offset:12288
v_mfma_f32_16x16x32_bf16 v[152:155], a[152:155], v[56:59], v[152:155]
v_exp_f32 v171, v171
v_mfma_f32_16x16x32_bf16 v[152:155], a[148:151], v[52:55], v[152:155]
v_exp_f32 v184, v184
v_mfma_f32_16x16x32_bf16 v[152:155], a[144:147], v[48:51], v[152:155]
ds_read_b128 a[244:247], v2 offset:13312
v_cvt_pk_bf16_f32 v217, v170, v171
v_mfma_f32_16x16x32_bf16 v[140:143], a[128:131], v[64:67], v[92:95]
v_exp_f32 v185, v185
v_mfma_f32_16x16x32_bf16 v[140:143], a[132:135], v[68:71], v[140:143]
ds_read_b128 a[248:251], v2 offset:14336
v_cvt_pk_bf16_f32 v218, v184, v185
v_mfma_f32_16x16x32_bf16 v[140:143], a[136:139], v[72:75], v[140:143]
buffer_load_dwordx4 v1, s[44:47], s72 offen offset:3072 sc1 lds
v_mfma_f32_16x16x32_bf16 v[140:143], a[140:143], v[76:79], v[140:143]
ds_read_b128 a[252:255], v2 offset:15360
v_add_u32 v2, s82, v1
v_mfma_f32_16x16x32_bf16 v[156:159], a[156:159], v[76:79], v[92:95]
s_waitcnt vmcnt(8) lgkmcnt(4)
v_exp_f32 v186, v186
v_mfma_f32_16x16x32_bf16 v[156:159], a[152:155], v[72:75], v[156:159]
s_barrier
v_exp_f32 v187, v187
v_mfma_f32_16x16x32_bf16 v[156:159], a[148:151], v[68:71], v[156:159]
s_add_u32 s83, s83, 1
v_cvt_pk_bf16_f32 v219, v186, v187
v_mfma_f32_16x16x32_bf16 v[156:159], a[144:147], v[64:67], v[156:159]
s_cbranch_scc0 LloopII
v_mfma_f32_16x16x32_bf16 v[236:239], v[120:123], v[204:207], v[236:239]
s_xor_b32 s74, s82, 0x10000
ds_read_b128 a[128:131], v2 offset:16384
ds_read_b128 a[132:135], v2 offset:17408
v_mfma_f32_16x16x32_bf16 v[236:239], v[120:123], v[220:223], v[236:239]
s_add_u32 s74, s74, s64
v_exp_f32 v136, v136
v_mfma_f32_16x16x32_bf16 a[96:99], a[192:195], v[204:207], a[96:99]
s_add_u32 s81, s81, 0x8000
v_exp_f32 v137, v137
v_mfma_f32_16x16x32_bf16 a[96:99], a[224:227], v[220:223], a[96:99]
s_add_u32 m0, s74, 0
ds_read_b128 a[136:139], v2 offset:18432
v_cvt_pk_bf16_f32 v200, v136, v137
v_mfma_f32_16x16x32_bf16 a[100:103], a[228:231], v[220:223], a[100:103]
s_add_u32 s72, s81, 0
v_exp_f32 v138, v138
v_mfma_f32_16x16x32_bf16 a[100:103], a[196:199], v[204:207], a[100:103]
buffer_load_dwordx4 v1, s[44:47], s72 offen sc1 lds
v_mfma_f32_16x16x32_bf16 a[104:107], a[200:203], v[204:207], a[104:107]
s_nop 0
ds_read_b128 a[140:143], v2 offset:19456
ds_read_b128 a[144:147], v2 offset:20480
v_mfma_f32_16x16x32_bf16 a[104:107], a[232:235], v[220:223], a[104:107]
v_exp_f32 v139, v139
v_mfma_f32_16x16x32_bf16 a[108:111], a[236:239], v[220:223], a[108:111]
v_exp_f32 v152, v152
v_mfma_f32_16x16x32_bf16 a[108:111], a[204:207], v[204:207], a[108:111]
ds_read_b128 a[148:151], v2 offset:21504
v_cvt_pk_bf16_f32 v201, v138, v139
v_mfma_f32_16x16x32_bf16 a[112:115], a[208:211], v[204:207], a[112:115]
s_waitcnt lgkmcnt(6)
v_exp_f32 v153, v153
v_mfma_f32_16x16x32_bf16 a[112:115], a[240:243], v[220:223], a[112:115]
ds_read_b128 a[152:155], v2 offset:22528
v_cvt_pk_bf16_f32 v202, v152, v153
v_mfma_f32_16x16x32_bf16 a[116:119], a[244:247], v[220:223], a[116:119]
v_exp_f32 v154, v154
v_mfma_f32_16x16x32_bf16 a[116:119], a[212:215], v[204:207], a[116:119]
buffer_load_dwordx4 v1, s[44:47], s72 offen offset:1024 sc1 lds
v_mfma_f32_16x16x32_bf16 a[120:123], a[216:219], v[204:207], a[120:123]
s_nop 0
ds_read_b128 a[156:159], v2 offset:23552
ds_read_b128 a[192:195], v2 offset:0
v_mfma_f32_16x16x32_bf16 a[120:123], a[248:251], v[220:223], a[120:123]
v_exp_f32 v155, v155
v_mfma_f32_16x16x32_bf16 a[124:127], a[252:255], v[220:223], a[124:127]
v_exp_f32 v140, v140
v_mfma_f32_16x16x32_bf16 a[124:127], a[220:223], v[204:207], a[124:127]
ds_read_b128 a[196:199], v2 offset:1024
v_cvt_pk_bf16_f32 v203, v154, v155
v_mfma_f32_16x16x32_bf16 v[172:175], a[160:163], v[64:67], v[92:95]
v_exp_f32 v141, v141
v_mfma_f32_16x16x32_bf16 v[172:175], a[164:167], v[68:71], v[172:175]
ds_read_b128 a[200:203], v2 offset:2048
v_cvt_pk_bf16_f32 v204, v140, v141
v_mfma_f32_16x16x32_bf16 v[172:175], a[168:171], v[72:75], v[172:175]
v_exp_f32 v142, v142
v_mfma_f32_16x16x32_bf16 v[172:175], a[172:175], v[76:79], v[172:175]
buffer_load_dwordx4 v1, s[44:47], s72 offen offset:2048 sc1 lds
v_mfma_f32_16x16x32_bf16 v[188:191], a[188:191], v[76:79], v[92:95]
ds_read_b128 a[204:207], v2 offset:3072
v_mfma_f32_16x16x32_bf16 v[188:191], a[184:187], v[72:75], v[188:191]
v_exp_f32 v143, v143
v_mfma_f32_16x16x32_bf16 v[188:191], a[180:183], v[68:71], v[188:191]
ds_read_b128 a[208:211], v2 offset:4096
v_cvt_pk_bf16_f32 v205, v142, v143
v_mfma_f32_16x16x32_bf16 v[188:191], a[176:179], v[64:67], v[188:191]
Lstub6:
s_cbranch_execz Lstub10
v_exp_f32 v156, v156
v_mfma_f32_16x16x32_bf16 v[168:171], a[160:163], v[48:51], v[88:91]
ds_read_b128 a[212:215], v2 offset:5120
v_mfma_f32_16x16x32_bf16 v[168:171], a[164:167], v[52:55], v[168:171]
v_exp_f32 v157, v157
v_mfma_f32_16x16x32_bf16 v[168:171], a[168:171], v[56:59], v[168:171]
ds_read_b128 a[216:219], v2 offset:6144
v_cvt_pk_bf16_f32 v206, v156, v157
v_mfma_f32_16x16x32_bf16 v[168:171], a[172:175], v[60:63], v[168:171]
buffer_load_dwordx4 v1, s[44:47], s72 offen offset:3072 sc1 lds
v_mfma_f32_16x16x32_bf16 v[184:187], a[188:191], v[60:63], v[88:91]
v_exp_f32 v158, v158
v_mfma_f32_16x16x32_bf16 v[184:187], a[184:187], v[56:59], v[184:187]
ds_read_b128 a[220:223], v2 offset:7168
v_mfma_f32_16x16x32_bf16 v[184:187], a[180:183], v[52:55], v[184:187]
s_waitcnt lgkmcnt(4)
v_exp_f32 v159, v159
v_mfma_f32_16x16x32_bf16 v[184:187], a[176:179], v[48:51], v[184:187]
s_barrier
v_cvt_pk_bf16_f32 v207, v158, v159
s_lshr_b32 s69, s93, 4
s_and_b32 s69, s69, 0x7f00
s_add_u32 s69, s69, LHT4-Lpc0
v_lshrrev_b32 v3, 5, v0
v_lshlrev_b32 v3, 7, v3
v_add_u32 v3, s69, v3
v_min_u32 v3, Lcode_end-Lpc0, v3
global_load_dword v4, v3, s[98:99]
v_mfma_f32_16x16x32_bf16 v[232:235], v[120:123], v[216:219], v[232:235]
s_add_u32 s82, s82, 0x8000
ds_read_b128 a[160:163], v2 offset:24576
ds_read_b128 a[164:167], v2 offset:25600
v_mfma_f32_16x16x32_bf16 v[232:235], v[120:123], v[200:203], v[232:235]
s_and_b32 s82, s82, 0x1ffff
v_exp_f32 v172, v172
v_mfma_f32_16x16x32_bf16 a[64:67], a[224:227], v[216:219], a[64:67]
s_add_u32 s66, s58, 3
v_exp_f32 v173, v173
v_mfma_f32_16x16x32_bf16 a[64:67], a[192:195], v[200:203], a[64:67]
s_and_b32 s66, s66, 3
ds_read_b128 a[168:171], v2 offset:26624
v_cvt_pk_bf16_f32 v220, v172, v173
v_mfma_f32_16x16x32_bf16 a[68:71], a[196:199], v[200:203], a[68:71]
s_mul_i32 s66, s66, 4160
v_exp_f32 v174, v174
v_mfma_f32_16x16x32_bf16 a[68:71], a[228:231], v[216:219], a[68:71]
s_add_u32 s66, s66, s92
ds_read_b128 a[172:175], v2 offset:27648
ds_read_b128 a[176:179], v2 offset:28672
v_mfma_f32_16x16x32_bf16 a[72:75], a[232:235], v[216:219], a[72:75]
s_add_u32 m0, s66, 32
v_exp_f32 v175, v175
v_mfma_f32_16x16x32_bf16 a[72:75], a[200:203], v[200:203], a[72:75]
s_add_u32 s72, s93, 0x6
buffer_load_dwordx4 v1, s[36:39], s72 offen lds
v_mfma_f32_16x16x32_bf16 a[76:79], a[204:207], v[200:203], a[76:79]
v_exp_f32 v188, v188
v_mfma_f32_16x16x32_bf16 a[76:79], a[236:239], v[216:219], a[76:79]
ds_read_b128 a[180:183], v2 offset:29696
v_cvt_pk_bf16_f32 v221, v174, v175
v_mfma_f32_16x16x32_bf16 a[80:83], a[240:243], v[216:219], a[80:83]
s_waitcnt lgkmcnt(6)
v_exp_f32 v189, v189
v_mfma_f32_16x16x32_bf16 a[80:83], a[208:211], v[200:203], a[80:83]
ds_read_b128 a[184:187], v2 offset:30720
v_cvt_pk_bf16_f32 v222, v188, v189
v_mfma_f32_16x16x32_bf16 a[84:87], a[212:215], v[200:203], a[84:87]
v_exp_f32 v190, v190
v_mfma_f32_16x16x32_bf16 a[84:87], a[244:247], v[216:219], a[84:87]
buffer_load_dwordx4 v1, s[36:39], s72 offen offset:1024 lds
v_mfma_f32_16x16x32_bf16 a[88:91], a[248:251], v[216:219], a[88:91]
s_nop 0
ds_read_b128 a[188:191], v2 offset:31744
ds_read_b128 a[224:227], v2 offset:8192
v_mfma_f32_16x16x32_bf16 a[88:91], a[216:219], v[200:203], a[88:91]
v_exp_f32 v191, v191
v_mfma_f32_16x16x32_bf16 a[92:95], a[220:223], v[200:203], a[92:95]
v_exp_f32 v168, v168
v_mfma_f32_16x16x32_bf16 a[92:95], a[252:255], v[216:219], a[92:95]
ds_read_b128 a[228:231], v2 offset:9216
v_cvt_pk_bf16_f32 v223, v190, v191
s_cmp_eq_u32 s58, 0
s_cbranch_scc1 Lta28
s_cmp_eq_u32 s58, 1
s_cbranch_scc1 Lnt29
v_mfma_f32_16x16x32_bf16 v[136:139], a[128:131], v[48:51], v[88:91]
v_exp_f32 v169, v169
v_mfma_f32_16x16x32_bf16 v[152:155], a[144:147], v[48:51], v[88:91]
ds_read_b128 a[232:235], v2 offset:10240
v_cvt_pk_bf16_f32 v216, v168, v169
s_branch Ljoin30
Lta28:
v_mfma_f32_16x16x32_bf16 v[136:139], a[128:131], v[48:51], v[104:107]
v_exp_f32 v169, v169
v_mfma_f32_16x16x32_bf16 v[152:155], a[144:147], v[48:51], v[112:115]
ds_read_b128 a[232:235], v2 offset:10240
v_cvt_pk_bf16_f32 v216, v168, v169
s_branch Ljoin30
Lnt29:
v_mfma_f32_16x16x32_bf16 v[136:139], a[128:131], v[48:51], v[88:91]
v_exp_f32 v169, v169
v_mfma_f32_16x16x32_bf16 v[152:155], a[144:147], v[48:51], v[104:107]
ds_read_b128 a[232:235], v2 offset:10240
v_cvt_pk_bf16_f32 v216, v168, v169
Ljoin30:
v_mfma_f32_16x16x32_bf16 v[136:139], a[132:135], v[52:55], v[136:139]
v_exp_f32 v170, v170
v_mfma_f32_16x16x32_bf16 v[136:139], a[136:139], v[56:59], v[136:139]
buffer_load_dwordx4 v1, s[36:39], s72 offen offset:2048 lds
v_mfma_f32_16x16x32_bf16 v[136:139], a[140:143], v[60:63], v[136:139]
ds_read_b128 a[236:239], v2 offset:11264
v_mfma_f32_16x16x32_bf16 v[152:155], a[156:159], v[60:63], v[152:155]
v_exp_f32 v171, v171
v_mfma_f32_16x16x32_bf16 v[152:155], a[152:155], v[56:59], v[152:155]
ds_read_b128 a[240:243], v2 offset:12288
v_cvt_pk_bf16_f32 v217, v170, v171
v_mfma_f32_16x16x32_bf16 v[152:155], a[148:151], v[52:55], v[152:155]
v_exp_f32 v184, v184
v_mfma_f32_16x16x32_bf16 v[140:143], a[128:131], v[64:67], v[92:95]
ds_read_b128 a[244:247], v2 offset:13312
v_mfma_f32_16x16x32_bf16 v[140:143], a[132:135], v[68:71], v[140:143]
v_exp_f32 v185, v185
v_mfma_f32_16x16x32_bf16 v[140:143], a[136:139], v[72:75], v[140:143]
ds_read_b128 a[248:251], v2 offset:14336
v_cvt_pk_bf16_f32 v218, v184, v185
v_mfma_f32_16x16x32_bf16 v[140:143], a[140:143], v[76:79], v[140:143]
buffer_load_dwordx4 v1, s[36:39], s72 offen offset:3072 lds
v_mfma_f32_16x16x32_bf16 v[156:159], a[156:159], v[76:79], v[92:95]
v_exp_f32 v186, v186
v_mfma_f32_16x16x32_bf16 v[156:159], a[152:155], v[72:75], v[156:159]
ds_read_b128 a[252:255], v2 offset:15360
v_add_u32 v2, s82, v1
v_mfma_f32_16x16x32_bf16 v[156:159], a[148:151], v[68:71], v[156:159]
s_waitcnt vmcnt(9) lgkmcnt(0)
v_exp_f32 v187, v187
v_mfma_f32_16x16x32_bf16 v[156:159], a[144:147], v[64:67], v[156:159]
s_barrier
v_cvt_pk_bf16_f32 v219, v186, v187
v_mfma_f32_16x16x32_bf16 v[236:239], v[120:123], v[204:207], v[236:239]
s_mov_b32 m0, s62
v_exp_f32 v136, v136
v_mfma_f32_16x16x32_bf16 v[236:239], v[120:123], v[220:223], v[236:239]
s_add_u32 s72, s93, 0x3000000
ds_read_b128 a[128:131], v2 offset:16384
ds_read_b128 a[132:135], v2 offset:17408
v_mfma_f32_16x16x32_bf16 a[96:99], a[192:195], v[204:207], a[96:99]
s_add_u32 s78, s59, 8
v_exp_f32 v137, v137
v_mfma_f32_16x16x32_bf16 a[96:99], a[224:227], v[220:223], a[96:99]
s_and_b32 s78, s78, 24
buffer_load_dwordx4 v1, s[44:47], s72 offen sc1 lds
v_mfma_f32_16x16x32_bf16 a[100:103], a[228:231], v[220:223], a[100:103]
s_lshr_b32 s79, 0x67234501, s78
v_exp_f32 v138, v138
v_mfma_f32_16x16x32_bf16 a[100:103], a[196:199], v[204:207], a[100:103]
s_and_b32 s79, s79, 7
ds_read_b128 a[136:139], v2 offset:18432
v_cvt_pk_bf16_f32 v200, v136, v137
v_mfma_f32_16x16x32_bf16 a[104:107], a[200:203], v[204:207], a[104:107]
s_lshl_b32 s79, s79, 18
v_exp_f32 v139, v139
v_mfma_f32_16x16x32_bf16 a[104:107], a[232:235], v[220:223], a[104:107]
s_add_u32 s79, s79, s94
ds_read_b128 a[140:143], v2 offset:19456
v_cvt_pk_bf16_f32 v201, v138, v139
v_mfma_f32_16x16x32_bf16 a[108:111], a[236:239], v[220:223], a[108:111]
s_add_u32 s12, s61, 0
v_exp_f32 v152, v152
v_mfma_f32_16x16x32_bf16 a[108:111], a[204:207], v[204:207], a[108:111]
s_and_b32 s12, s12, 3
ds_read_b128 a[144:147], v2 offset:20480
ds_read_b128 a[148:151], v2 offset:21504
v_mfma_f32_16x16x32_bf16 a[112:115], a[208:211], v[204:207], a[112:115]
s_waitcnt lgkmcnt(6)
buffer_load_dwordx4 v1, s[44:47], s72 offen offset:1024 sc1 lds
v_mfma_f32_16x16x32_bf16 a[112:115], a[240:243], v[220:223], a[112:115]
s_lshl_b32 s12, s12, 21
v_exp_f32 v153, v153
v_mfma_f32_16x16x32_bf16 a[116:119], a[244:247], v[220:223], a[116:119]
s_add_u32 s12, s12, s79
v_exp_f32 v154, v154
v_mfma_f32_16x16x32_bf16 a[116:119], a[212:215], v[204:207], a[116:119]
s_add_u32 s13, s61, 1
ds_read_b128 a[152:155], v2 offset:22528
v_cvt_pk_bf16_f32 v202, v152, v153
v_mfma_f32_16x16x32_bf16 a[120:123], a[216:219], v[204:207], a[120:123]
s_and_b32 s13, s13, 3
buffer_load_dwordx4 v1, s[44:47], s72 offen offset:2048 sc1 lds
v_mfma_f32_16x16x32_bf16 a[120:123], a[248:251], v[220:223], a[120:123]
s_lshl_b32 s13, s13, 21
v_exp_f32 v155, v155
v_mfma_f32_16x16x32_bf16 a[124:127], a[252:255], v[220:223], a[124:127]
s_add_u32 s13, s13, s79
ds_read_b128 a[156:159], v2 offset:23552
v_cvt_pk_bf16_f32 v203, v154, v155
v_mfma_f32_16x16x32_bf16 a[124:127], a[220:223], v[204:207], a[124:127]
s_add_u32 s14, s61, 2
v_exp_f32 v140, v140
s_cmp_eq_u32 s58, 2
s_cbranch_scc1 Lta31
s_cmp_eq_u32 s58, 3
s_cbranch_scc1 Lnt32
v_mfma_f32_16x16x32_bf16 v[168:171], a[160:163], v[48:51], v[112:115]
s_and_b32 s14, s14, 3
ds_read_b128 a[192:195], v2 offset:0
ds_read_b128 a[196:199], v2 offset:1024
v_mfma_f32_16x16x32_bf16 v[184:187], a[176:179], v[48:51], v[112:115]
s_lshl_b32 s14, s14, 21
v_exp_f32 v141, v141
s_branch Ljoin33
Lta31:
v_mfma_f32_16x16x32_bf16 v[168:171], a[160:163], v[48:51], v[104:107]
s_and_b32 s14, s14, 3
ds_read_b128 a[192:195], v2 offset:0
ds_read_b128 a[196:199], v2 offset:1024
v_mfma_f32_16x16x32_bf16 v[184:187], a[176:179], v[48:51], v[112:115]
s_lshl_b32 s14, s14, 21
v_exp_f32 v141, v141
s_branch Ljoin33
Lnt32:
v_mfma_f32_16x16x32_bf16 v[168:171], a[160:163], v[48:51], v[88:91]
s_and_b32 s14, s14, 3
ds_read_b128 a[192:195], v2 offset:0
ds_read_b128 a[196:199], v2 offset:1024
v_mfma_f32_16x16x32_bf16 v[184:187], a[176:179], v[48:51], v[104:107]
s_lshl_b32 s14, s14, 21
v_exp_f32 v141, v141
Ljoin33:
v_mfma_f32_16x16x32_bf16 v[172:175], a[160:163], v[64:67], v[92:95]
s_add_u32 s14, s14, s79
buffer_load_dwordx4 v1, s[44:47], s72 offen offset:3072 sc1 lds
v_mfma_f32_16x16x32_bf16 v[172:175], a[164:167], v[68:71], v[172:175]
s_add_u32 s66, s58, 0
v_exp_f32 v142, v142
v_mfma_f32_16x16x32_bf16 v[172:175], a[168:171], v[72:75], v[172:175]
s_and_b32 s66, s66, 3
ds_read_b128 a[200:203], v2 offset:2048
v_cvt_pk_bf16_f32 v204, v140, v141
v_mfma_f32_16x16x32_bf16 v[172:175], a[172:175], v[76:79], v[172:175]
s_mul_i32 s66, s66, 4160
v_exp_f32 v143, v143
v_mfma_f32_16x16x32_bf16 v[188:191], a[188:191], v[76:79], v[92:95]
s_add_u32 s66, s66, s92
ds_read_b128 a[204:207], v2 offset:3072
v_cvt_pk_bf16_f32 v205, v142, v143
v_mfma_f32_16x16x32_bf16 v[188:191], a[184:187], v[72:75], v[188:191]
s_add_u32 m0, s66, 16672
v_exp_f32 v156, v156
v_mfma_f32_16x16x32_bf16 v[188:191], a[180:183], v[68:71], v[188:191]
s_add_u32 s72, s93, 0x0
ds_read_b128 a[208:211], v2 offset:4096
ds_read_b128 a[212:215], v2 offset:5120
v_mfma_f32_16x16x32_bf16 v[188:191], a[176:179], v[64:67], v[188:191]
s_add_u32 s15, s61, 3
buffer_load_dwordx4 v1, s[36:39], s72 offen lds
v_mfma_f32_16x16x32_bf16 v[168:171], a[164:167], v[52:55], v[168:171]
s_and_b32 s15, s15, 3
v_exp_f32 v157, v157
v_mfma_f32_16x16x32_bf16 v[168:171], a[168:171], v[56:59], v[168:171]
s_lshl_b32 s15, s15, 21
v_exp_f32 v158, v158
v_mfma_f32_16x16x32_bf16 v[168:171], a[172:175], v[60:63], v[168:171]
s_add_u32 s15, s15, s79
ds_read_b128 a[216:219], v2 offset:6144
ds_read_b128 a[220:223], v2 offset:7168
v_mfma_f32_16x16x32_bf16 v[184:187], a[188:191], v[60:63], v[184:187]
buffer_load_dwordx4 v1, s[36:39], s72 offen offset:1024 lds
v_mfma_f32_16x16x32_bf16 v[184:187], a[184:187], v[56:59], v[184:187]
v_exp_f32 v159, v159
v_mfma_f32_16x16x32_bf16 v[184:187], a[180:183], v[52:55], v[184:187]
s_waitcnt lgkmcnt(4)
v_cvt_pk_bf16_f32 v206, v156, v157
v_cvt_pk_bf16_f32 v207, v158, v159
v_mfma_f32_16x16x32_bf16 v[232:235], v[120:123], v[216:219], v[232:235]
s_add_u32 s82, s82, 0x8000
ds_read_b128 a[160:163], v2 offset:24576
ds_read_b128 a[164:167], v2 offset:25600
v_mfma_f32_16x16x32_bf16 v[232:235], v[120:123], v[200:203], v[232:235]
s_and_b32 s82, s82, 0x1ffff
v_exp_f32 v172, v172
v_mfma_f32_16x16x32_bf16 a[64:67], a[224:227], v[216:219], a[64:67]
v_exp_f32 v173, v173
v_mfma_f32_16x16x32_bf16 a[64:67], a[192:195], v[200:203], a[64:67]
s_nop 0
ds_read_b128 a[168:171], v2 offset:26624
ds_read_b128 a[172:175], v2 offset:27648
v_mfma_f32_16x16x32_bf16 a[68:71], a[196:199], v[200:203], a[68:71]
v_exp_f32 v174, v174
v_mfma_f32_16x16x32_bf16 a[68:71], a[228:231], v[216:219], a[68:71]
v_exp_f32 v175, v175
v_mfma_f32_16x16x32_bf16 a[72:75], a[232:235], v[216:219], a[72:75]
s_nop 0
ds_read_b128 a[176:179], v2 offset:28672
ds_read_b128 a[180:183], v2 offset:29696
v_mfma_f32_16x16x32_bf16 a[72:75], a[200:203], v[200:203], a[72:75]
v_exp_f32 v188, v188
v_mfma_f32_16x16x32_bf16 a[76:79], a[204:207], v[200:203], a[76:79]
s_nop 0
ds_read_b128 a[184:187], v2 offset:30720
ds_read_b128 a[188:191], v2 offset:31744
v_mfma_f32_16x16x32_bf16 a[76:79], a[236:239], v[216:219], a[76:79]
s_nop 0
ds_read_b128 a[224:227], v2 offset:8192
ds_read_b128 a[228:231], v2 offset:9216
v_mfma_f32_16x16x32_bf16 a[80:83], a[240:243], v[216:219], a[80:83]
s_waitcnt lgkmcnt(10)
ds_read_b128 a[232:235], v2 offset:10240
ds_read_b128 a[236:239], v2 offset:11264
v_mfma_f32_16x16x32_bf16 a[80:83], a[208:211], v[200:203], a[80:83]
ds_read_b128 a[240:243], v2 offset:12288
v_cvt_pk_bf16_f32 v220, v172, v173
v_mfma_f32_16x16x32_bf16 a[84:87], a[212:215], v[200:203], a[84:87]
buffer_load_dwordx4 v1, s[36:39], s72 offen offset:2048 lds
v_mfma_f32_16x16x32_bf16 a[84:87], a[244:247], v[216:219], a[84:87]
v_exp_f32 v189, v189
v_mfma_f32_16x16x32_bf16 a[88:91], a[248:251], v[216:219], a[88:91]
v_exp_f32 v190, v190
v_mfma_f32_16x16x32_bf16 a[88:91], a[216:219], v[200:203], a[88:91]
s_nop 0
ds_read_b128 a[244:247], v2 offset:13312
ds_read_b128 a[248:251], v2 offset:14336
v_mfma_f32_16x16x32_bf16 a[92:95], a[220:223], v[200:203], a[92:95]
v_cvt_pk_bf16_f32 v221, v174, v175
v_cvt_pk_bf16_f32 v222, v188, v189
v_mfma_f32_16x16x32_bf16 a[92:95], a[252:255], v[216:219], a[92:95]
v_exp_f32 v191, v191
s_cmp_eq_u32 s58, 0
s_cbranch_scc1 Lta34
s_cmp_eq_u32 s58, 1
s_cbranch_scc1 Lnt35
v_mfma_f32_16x16x32_bf16 v[140:143], a[128:131], v[64:67], v[92:95]
v_exp_f32 v168, v168
v_mfma_f32_16x16x32_bf16 v[156:159], a[144:147], v[64:67], v[92:95]
v_exp_f32 v169, v169
s_branch Ljoin36
Lta34:
v_mfma_f32_16x16x32_bf16 v[140:143], a[128:131], v[64:67], v[108:111]
v_exp_f32 v168, v168
v_mfma_f32_16x16x32_bf16 v[156:159], a[144:147], v[64:67], v[112:115]
v_exp_f32 v169, v169
s_branch Ljoin36
Lnt35:
v_mfma_f32_16x16x32_bf16 v[140:143], a[128:131], v[64:67], v[92:95]
v_exp_f32 v168, v168
v_mfma_f32_16x16x32_bf16 v[156:159], a[144:147], v[64:67], v[108:111]
v_exp_f32 v169, v169
Ljoin36:
v_mfma_f32_16x16x32_bf16 v[140:143], a[132:135], v[68:71], v[140:143]
v_exp_f32 v170, v170
v_mfma_f32_16x16x32_bf16 v[140:143], a[136:139], v[72:75], v[140:143]
ds_read_b128 a[252:255], v2 offset:15360
v_cvt_pk_bf16_f32 v223, v190, v191
v_mfma_f32_16x16x32_bf16 v[140:143], a[140:143], v[76:79], v[140:143]
v_exp_f32 v171, v171
v_mfma_f32_16x16x32_bf16 v[156:159], a[156:159], v[76:79], v[156:159]
buffer_load_dwordx4 v1, s[36:39], s72 offen offset:3072 lds
v_mfma_f32_16x16x32_bf16 v[156:159], a[152:155], v[72:75], v[156:159]
s_waitcnt vmcnt(13) lgkmcnt(4)
v_exp_f32 v184, v184
v_mfma_f32_16x16x32_bf16 v[156:159], a[148:151], v[68:71], v[156:159]
s_barrier
v_cvt_pk_bf16_f32 v216, v168, v169
v_cvt_pk_bf16_f32 v217, v170, v171
v_add_u32 v2, s82, v1
v_exp_f32 v185, v185
v_exp_f32 v186, v186
v_cvt_pk_bf16_f32 v218, v184, v185
v_exp_f32 v187, v187
s_nop 0
v_cvt_pk_bf16_f32 v219, v186, v187
v_mfma_f32_16x16x32_bf16 v[236:239], v[120:123], v[204:207], v[236:239]
s_add_u32 s66, s58, 2
v_exp_f32 v140, v140
v_mfma_f32_16x16x32_bf16 v[236:239], v[120:123], v[220:223], v[236:239]
s_and_b32 s66, s66, 3
v_exp_f32 v141, v141
v_mfma_f32_16x16x32_bf16 a[96:99], a[192:195], v[204:207], a[96:99]
s_mul_i32 s66, s66, 4160
ds_read_b128 a[192:195], v2 offset:0
v_mfma_f32_16x16x32_bf16 a[96:99], a[224:227], v[220:223], a[96:99]
s_add_u32 s66, s66, s92
v_exp_f32 v142, v142
v_mfma_f32_16x16x32_bf16 a[100:103], a[228:231], v[220:223], a[100:103]
s_add_u32 m0, s66, 33312
v_exp_f32 v143, v143
v_mfma_f32_16x16x32_bf16 a[100:103], a[196:199], v[204:207], a[100:103]
s_add_u32 s72, s93, 0x4
buffer_load_dwordx4 v1, s[36:39], s72 offen lds
v_mfma_f32_16x16x32_bf16 a[104:107], a[200:203], v[204:207], a[104:107]
ds_read_b128 a[196:199], v2 offset:1024
v_mfma_f32_16x16x32_bf16 a[104:107], a[232:235], v[220:223], a[104:107]
buffer_load_dwordx4 v1, s[36:39], s72 offen offset:1024 lds
v_mfma_f32_16x16x32_bf16 a[108:111], a[236:239], v[220:223], a[108:111]
ds_read_b128 a[200:203], v2 offset:2048
v_mfma_f32_16x16x32_bf16 a[108:111], a[204:207], v[204:207], a[108:111]
buffer_load_dwordx4 v1, s[36:39], s72 offen offset:2048 lds
v_mfma_f32_16x16x32_bf16 a[112:115], a[208:211], v[204:207], a[112:115]
s_waitcnt lgkmcnt(3)
ds_read_b128 a[204:207], v2 offset:3072
v_mfma_f32_16x16x32_bf16 a[112:115], a[240:243], v[220:223], a[112:115]
buffer_load_dwordx4 v1, s[36:39], s72 offen offset:3072 lds
v_mfma_f32_16x16x32_bf16 a[116:119], a[244:247], v[220:223], a[116:119]
v_exp_f32 v156, v156
v_mfma_f32_16x16x32_bf16 a[116:119], a[212:215], v[204:207], a[116:119]
ds_read_b128 a[208:211], v2 offset:4096
v_mfma_f32_16x16x32_bf16 a[120:123], a[216:219], v[204:207], a[120:123]
buffer_load_dwordx4 v[80:83], v15, s[4:7], s80 offen
v_mfma_f32_16x16x32_bf16 a[120:123], a[248:251], v[220:223], a[120:123]
s_add_u32 s80, s80, 0x4000
v_exp_f32 v157, v157
v_mfma_f32_16x16x32_bf16 a[124:127], a[252:255], v[220:223], a[124:127]
ds_read_b128 a[212:215], v2 offset:5120
v_mfma_f32_16x16x32_bf16 a[124:127], a[220:223], v[204:207], a[124:127]
ds_read_b128 a[216:219], v2 offset:6144
v_cvt_pk_bf16_f32 v204, v140, v141
s_cmp_eq_u32 s58, 2
s_cbranch_scc1 Lta37
s_cmp_eq_u32 s58, 3
s_cbranch_scc1 Lnt38
v_mfma_f32_16x16x32_bf16 v[172:175], a[160:163], v[64:67], v[112:115]
buffer_load_dwordx4 v[84:87], v15, s[4:7], s80 offen
v_mfma_f32_16x16x32_bf16 v[188:191], a[176:179], v[64:67], v[112:115]
s_add_u32 s80, s80, 0x4000
v_exp_f32 v158, v158
s_branch Ljoin39
Lta37:
v_mfma_f32_16x16x32_bf16 v[172:175], a[160:163], v[64:67], v[108:111]
buffer_load_dwordx4 v[84:87], v15, s[4:7], s80 offen
v_mfma_f32_16x16x32_bf16 v[188:191], a[176:179], v[64:67], v[112:115]
s_add_u32 s80, s80, 0x4000
v_exp_f32 v158, v158
s_branch Ljoin39
Lnt38:
v_mfma_f32_16x16x32_bf16 v[172:175], a[160:163], v[64:67], v[92:95]
buffer_load_dwordx4 v[84:87], v15, s[4:7], s80 offen
v_mfma_f32_16x16x32_bf16 v[188:191], a[176:179], v[64:67], v[108:111]
s_add_u32 s80, s80, 0x4000
v_exp_f32 v158, v158
Ljoin39:
v_mfma_f32_16x16x32_bf16 v[172:175], a[164:167], v[68:71], v[172:175]
ds_read_b128 a[220:223], v2 offset:7168
v_cvt_pk_bf16_f32 v205, v142, v143
v_mfma_f32_16x16x32_bf16 v[172:175], a[168:171], v[72:75], v[172:175]
buffer_load_dwordx4 v[96:99], v15, s[4:7], s80 offen
v_mfma_f32_16x16x32_bf16 v[172:175], a[172:175], v[76:79], v[172:175]
s_add_u32 s80, s80, 0x4000
v_exp_f32 v159, v159
v_mfma_f32_16x16x32_bf16 v[188:191], a[188:191], v[76:79], v[188:191]
buffer_load_dwordx4 v[100:103], v15, s[4:7], s80 offen
v_mfma_f32_16x16x32_bf16 v[188:191], a[184:187], v[72:75], v[188:191]
v_cvt_pk_bf16_f32 v206, v156, v157
v_cvt_pk_bf16_f32 v207, v158, v159
v_mfma_f32_16x16x32_bf16 v[188:191], a[180:183], v[68:71], v[188:191]
s_waitcnt lgkmcnt(4)
v_mfma_f32_16x16x32_bf16 v[232:235], v[120:123], v[216:219], v[232:235]
s_add_u32 s82, s82, 0x8000
v_exp_f32 v172, v172
v_mfma_f32_16x16x32_bf16 a[64:67], a[224:227], v[216:219], a[64:67]
s_and_b32 s82, s82, 0x1ffff
ds_read_b128 a[224:227], v2 offset:8192
v_mfma_f32_16x16x32_bf16 a[68:71], a[228:231], v[216:219], a[68:71]
ds_read_b128 a[228:231], v2 offset:9216
v_mfma_f32_16x16x32_bf16 a[72:75], a[232:235], v[216:219], a[72:75]
v_exp_f32 v173, v173
v_mfma_f32_16x16x32_bf16 a[76:79], a[236:239], v[216:219], a[76:79]
s_nop 0
ds_read_b128 a[232:235], v2 offset:10240
ds_read_b128 a[236:239], v2 offset:11264
v_mfma_f32_16x16x32_bf16 a[80:83], a[240:243], v[216:219], a[80:83]
ds_read_b128 a[240:243], v2 offset:12288
v_cvt_pk_bf16_f32 v220, v172, v173
v_mfma_f32_16x16x32_bf16 a[84:87], a[244:247], v[216:219], a[84:87]
ds_read_b128 a[244:247], v2 offset:13312
v_mfma_f32_16x16x32_bf16 a[88:91], a[248:251], v[216:219], a[88:91]
v_exp_f32 v174, v174
v_mfma_f32_16x16x32_bf16 a[92:95], a[252:255], v[216:219], a[92:95]
v_exp_f32 v175, v175
ds_read_b128 a[248:251], v2 offset:14336
ds_read_b128 a[252:255], v2 offset:15360
v_add_u32 v2, s82, v1
v_exp_f32 v188, v188
v_cvt_pk_bf16_f32 v221, v174, v175
v_exp_f32 v189, v189
v_exp_f32 v190, v190
v_cvt_pk_bf16_f32 v222, v188, v189
v_exp_f32 v191, v191
s_nop 0
v_cvt_pk_bf16_f32 v223, v190, v191
s_waitcnt vmcnt(4) lgkmcnt(0)
s_barrier
LHT4:
Lstub7:
s_cbranch_execz Lstub11
v_mfma_f32_16x16x32_bf16 v[236:239], v[120:123], v[204:207], v[236:239]
ds_write_b64 v5, v[12:13]
v_mov_b32 v240, 0
v_mfma_f32_16x16x32_bf16 v[236:239], v[120:123], v[220:223], v[236:239]
v_mov_b32 v241, 0
v_mfma_f32_16x16x32_bf16 a[96:99], a[192:195], v[204:207], a[96:99]
s_nop 0
ds_write_b64 v14, v[240:241]
ds_read_b64 a[128:129], v6 offset:0
v_mfma_f32_16x16x32_bf16 a[96:99], a[224:227], v[220:223], a[96:99]
s_nop 0
ds_read_b64 a[130:131], v6 offset:8
ds_read_b128 a[192:195], v7 offset:3584
v_mfma_f32_16x16x32_bf16 a[100:103], a[228:231], v[220:223], a[100:103]
s_nop 0
ds_read_b64 a[132:133], v6 offset:512
ds_read_b64 a[134:135], v6 offset:520
v_mfma_f32_16x16x32_bf16 a[100:103], a[196:199], v[204:207], a[100:103]
s_nop 0
ds_read_b128 a[196:199], v7 offset:3072
ds_read_b64 a[136:137], v6 offset:1024
v_mfma_f32_16x16x32_bf16 a[104:107], a[200:203], v[204:207], a[104:107]
s_nop 0
ds_read_b64 a[138:139], v6 offset:1032
ds_read_b128 a[200:203], v7 offset:2560
v_mfma_f32_16x16x32_bf16 a[104:107], a[232:235], v[220:223], a[104:107]
v_add_f32 v12, v226, v230
v_min_u32 v13, 1, v0
v_mfma_f32_16x16x32_bf16 a[108:111], a[236:239], v[220:223], a[108:111]
s_nop 0
ds_read_b64 a[140:141], v6 offset:1536
ds_read_b64 a[142:143], v6 offset:1544
v_mfma_f32_16x16x32_bf16 a[108:111], a[204:207], v[204:207], a[108:111]
s_nop 0
ds_read_b128 a[204:207], v7 offset:2048
ds_read_b64 a[144:145], v6 offset:2048
v_mfma_f32_16x16x32_bf16 a[112:115], a[208:211], v[204:207], a[112:115]
s_lshl_b32 s73, s52, 12
ds_read_b64 a[146:147], v6 offset:2056
ds_read_b128 a[208:211], v7 offset:1536
v_mfma_f32_16x16x32_bf16 a[112:115], a[240:243], v[220:223], a[112:115]
s_add_u32 s73, s73, 0x2000000
v_lshlrev_b32 v13, 30, v13
v_mov_b32 v14, 2
v_mfma_f32_16x16x32_bf16 a[116:119], a[244:247], v[220:223], a[116:119]
s_lshl_b32 s70, s68, 2
ds_read_b64 a[148:149], v6 offset:2560
ds_read_b64 a[150:151], v6 offset:2568
v_mfma_f32_16x16x32_bf16 a[116:119], a[212:215], v[204:207], a[116:119]
s_add_u32 s70, s70, s73
ds_read_b128 a[212:215], v7 offset:1024
ds_read_b64 a[152:153], v6 offset:3072
v_mfma_f32_16x16x32_bf16 a[120:123], a[216:219], v[204:207], a[120:123]
s_nop 0
ds_read_b64 a[154:155], v6 offset:3080
ds_read_b128 a[216:219], v7 offset:512
v_mfma_f32_16x16x32_bf16 a[120:123], a[248:251], v[220:223], a[120:123]
v_mfma_f32_16x16x32_bf16 a[124:127], a[252:255], v[220:223], a[124:127]
s_xor_b32 s71, s12, 0x80
ds_read_b64 a[156:157], v6 offset:3584
ds_read_b64 a[158:159], v6 offset:3592
v_mfma_f32_16x16x32_bf16 a[124:127], a[220:223], v[204:207], a[124:127]
s_add_u32 m0, s77, 0
ds_read_b128 a[220:223], v7 offset:0
s_waitcnt lgkmcnt(0)
v_mfma_f32_16x16x32_bf16 v[128:131], v[8:11], a[192:195], 0
s_add_u32 s72, s71, 0
buffer_load_dwordx4 v15, s[24:27], s72 offen lds
v_mfma_f32_16x16x32_bf16 v[128:131], a[128:131], a[192:195], v[128:131]
v_mfma_f32_16x16x32_bf16 v[132:135], v[8:11], a[196:199], 0
s_nop 0
ds_read_b128 a[224:227], v7 offset:3648
ds_read_b64 a[160:161], v6 offset:64
v_mfma_f32_16x16x32_bf16 v[132:135], a[128:131], a[196:199], v[132:135]
v_accvgpr_read_b32 v240, a64
v_accvgpr_read_b32 v241, a65
v_accvgpr_read_b32 v242, a66
v_mfma_f32_16x16x32_bf16 v[132:135], a[132:135], a[192:195], v[132:135]
s_add_u32 s72, s71, 15360
buffer_load_dwordx4 v15, s[24:27], s72 offen offset:1024 lds
v_accvgpr_read_b32 v243, a67
v_mfma_f32_16x16x32_bf16 v[136:139], v[8:11], a[200:203], 0
s_nop 0
ds_read_b64 a[162:163], v6 offset:72
ds_read_b128 a[228:231], v7 offset:3136
v_mfma_f32_16x16x32_bf16 v[136:139], a[128:131], a[200:203], v[136:139]
s_lshl_b32 s95, s75, 20
v_rcp_f32 v232, v232
v_mfma_f32_16x16x32_bf16 v[136:139], a[132:135], a[196:199], v[136:139]
s_lshl_b32 s74, s58, 18
v_rcp_f32 v236, v236
v_accvgpr_read_b32 v244, a68
v_mfma_f32_16x16x32_bf16 v[136:139], a[136:139], a[192:195], v[136:139]
s_add_u32 s95, s95, s74
ds_read_b64 a[164:165], v6 offset:576
ds_read_b64 a[166:167], v6 offset:584
v_accvgpr_read_b32 v245, a69
v_mfma_f32_16x16x32_bf16 v[140:143], v[8:11], a[204:207], 0
s_add_u32 s72, s71, 30720
buffer_load_dwordx4 v15, s[24:27], s72 offen offset:2048 lds
v_accvgpr_read_b32 v246, a70
v_mfma_f32_16x16x32_bf16 v[140:143], a[128:131], a[204:207], v[140:143]
s_add_u32 s95, s95, 0x2000000
v_accvgpr_read_b32 v247, a71
v_mul_f32 v240, v240, v232
v_mul_f32 v241, v241, v232
v_mfma_f32_16x16x32_bf16 v[140:143], a[132:135], a[200:203], v[140:143]
s_sub_u32 s74, 15, s75
ds_read_b128 a[232:235], v7 offset:2624
ds_read_b64 a[168:169], v6 offset:1088
v_mul_f32 v242, v242, v232
v_mfma_f32_16x16x32_bf16 v[140:143], a[136:139], a[196:199], v[140:143]
s_add_u32 s72, s71, 46080
buffer_load_dwordx4 v15, s[24:27], s72 offen offset:3072 lds
v_mul_f32 v243, v243, v232
v_mfma_f32_16x16x32_bf16 v[140:143], a[140:143], a[192:195], v[140:143]
s_min_u32 s74, s74, s75
v_mul_f32 v244, v244, v232
v_mul_f32 v245, v245, v232
v_mul_f32 v246, v246, v232
v_mfma_f32_16x16x32_bf16 v[144:147], v[8:11], a[208:211], 0
s_lshl_b32 s74, s74, 7
ds_read_b64 a[170:171], v6 offset:1096
ds_read_b128 a[236:239], v7 offset:2112
v_mul_f32 v247, v247, v232
v_mfma_f32_16x16x32_bf16 v[144:147], a[128:131], a[208:211], v[144:147]
s_add_u32 s74, s74, 0x3810000
v_cvt_pk_bf16_f32 v240, v240, v241
v_cvt_pk_bf16_f32 v241, v242, v243
v_cvt_pk_bf16_f32 v242, v244, v245
v_mfma_f32_16x16x32_bf16 v[144:147], a[132:135], a[204:207], v[144:147]
s_xor_b32 s85, s77, 0x10000
v_cvt_pk_bf16_f32 v243, v246, v247
v_mfma_f32_16x16x32_bf16 v[144:147], a[136:139], a[200:203], v[144:147]
s_nop 0
ds_read_b64 a[172:173], v6 offset:1600
ds_read_b64 a[174:175], v6 offset:1608
v_mfma_f32_16x16x32_bf16 v[144:147], a[140:143], a[196:199], v[144:147]
Lstub8:
s_cbranch_execz Lret
buffer_store_dwordx4 v[240:243], v1, s[44:47], s70 offen sc1
v_mfma_f32_16x16x32_bf16 v[144:147], a[144:147], a[192:195], v[144:147]
v_accvgpr_read_b32 v248, a72
v_accvgpr_read_b32 v249, a73
v_accvgpr_read_b32 v250, a74
v_mfma_f32_16x16x32_bf16 v[148:151], v[8:11], a[212:215], 0
s_nop 0
ds_read_b128 a[240:243], v7 offset:1600
ds_read_b64 a[176:177], v6 offset:2112
v_accvgpr_read_b32 v251, a75
v_mfma_f32_16x16x32_bf16 v[148:151], a[128:131], a[212:215], v[148:151]
v_accvgpr_read_b32 v252, a76
v_accvgpr_read_b32 v253, a77
v_accvgpr_read_b32 v254, a78
v_mfma_f32_16x16x32_bf16 v[148:151], a[132:135], a[208:211], v[148:151]
v_accvgpr_read_b32 v255, a79
v_mul_f32 v248, v248, v232
v_mul_f32 v249, v249, v232
v_mfma_f32_16x16x32_bf16 v[148:151], a[136:139], a[204:207], v[148:151]
s_nop 0
ds_read_b64 a[178:179], v6 offset:2120
ds_read_b128 a[244:247], v7 offset:1088
v_mul_f32 v250, v250, v232
v_mfma_f32_16x16x32_bf16 v[148:151], a[140:143], a[200:203], v[148:151]
v_cmp_ngt_f32 vcc, 0x6f800000, v12
s_or_b32 s83, vcc_lo, vcc_hi
s_cselect_b32 s83, s86, 1
s_lshl_b32 s53, s83, 30
s_xor_b32 s83, s53, 0x40000000
v_or_b32 v13, s83, v13
s_lshl_b32 s83, s58, 2
s_add_u32 s83, s83, s91
s_waitcnt vmcnt(5)
buffer_store_dword v14, v13, s[44:47], s83 offen offset:4 sc1
v_mfma_f32_16x16x32_bf16 v[148:151], a[144:147], a[196:199], v[148:151]
v_mul_f32 v251, v251, v232
v_mul_f32 v252, v252, v232
v_mul_f32 v253, v253, v232
v_mfma_f32_16x16x32_bf16 v[148:151], a[148:151], a[192:195], v[148:151]
s_nop 0
ds_read_b64 a[180:181], v6 offset:2624
ds_read_b64 a[182:183], v6 offset:2632
v_mul_f32 v254, v254, v232
v_mfma_f32_16x16x32_bf16 v[152:155], v[8:11], a[216:219], 0
v_mul_f32 v255, v255, v232
v_cvt_pk_bf16_f32 v248, v248, v249
v_cvt_pk_bf16_f32 v249, v250, v251
v_mfma_f32_16x16x32_bf16 v[152:155], a[128:131], a[216:219], v[152:155]
v_cvt_pk_bf16_f32 v250, v252, v253
v_cvt_pk_bf16_f32 v251, v254, v255
v_mfma_f32_16x16x32_bf16 v[152:155], a[132:135], a[212:215], v[152:155]
s_nop 0
ds_read_b128 a[248:251], v7 offset:576
ds_read_b64 a[184:185], v6 offset:3136
v_mfma_f32_16x16x32_bf16 v[152:155], a[136:139], a[208:211], v[152:155]
buffer_store_dwordx4 v[248:251], v1, s[44:47], s70 offen offset:1024 sc1
v_mfma_f32_16x16x32_bf16 v[152:155], a[140:143], a[204:207], v[152:155]
v_accvgpr_read_b32 v240, a80
v_accvgpr_read_b32 v241, a81
v_accvgpr_read_b32 v242, a82
v_mfma_f32_16x16x32_bf16 v[152:155], a[144:147], a[200:203], v[152:155]
s_nop 0
ds_read_b64 a[186:187], v6 offset:3144
ds_read_b128 a[252:255], v7 offset:64
v_accvgpr_read_b32 v243, a83
v_mfma_f32_16x16x32_bf16 v[152:155], a[148:151], a[196:199], v[152:155]
v_accvgpr_read_b32 v244, a84
v_accvgpr_read_b32 v245, a85
v_accvgpr_read_b32 v246, a86
v_mfma_f32_16x16x32_bf16 v[152:155], a[152:155], a[192:195], v[152:155]
v_accvgpr_read_b32 v247, a87
v_mul_f32 v240, v240, v232
v_mul_f32 v241, v241, v232
v_mfma_f32_16x16x32_bf16 v[156:159], v[8:11], a[220:223], 0
s_nop 0
ds_read_b64 a[188:189], v6 offset:3648
ds_read_b64 a[190:191], v6 offset:3656
v_mul_f32 v242, v242, v232
v_mfma_f32_16x16x32_bf16 v[156:159], a[128:131], a[220:223], v[156:159]
v_mul_f32 v243, v243, v232
v_mul_f32 v244, v244, v232
v_mul_f32 v245, v245, v232
v_mfma_f32_16x16x32_bf16 v[156:159], a[132:135], a[216:219], v[156:159]
v_mul_f32 v246, v246, v232
v_mul_f32 v247, v247, v232
v_cvt_pk_bf16_f32 v240, v240, v241
v_mfma_f32_16x16x32_bf16 v[156:159], a[136:139], a[212:215], v[156:159]
v_cvt_pk_bf16_f32 v241, v242, v243
v_cvt_pk_bf16_f32 v242, v244, v245
v_cvt_pk_bf16_f32 v243, v246, v247
v_mfma_f32_16x16x32_bf16 v[156:159], a[140:143], a[208:211], v[156:159]
buffer_store_dwordx4 v[240:243], v1, s[44:47], s70 offen offset:2048 sc1
v_mfma_f32_16x16x32_bf16 v[156:159], a[144:147], a[204:207], v[156:159]
v_accvgpr_read_b32 v248, a88
v_accvgpr_read_b32 v249, a89
v_accvgpr_read_b32 v250, a90
v_mfma_f32_16x16x32_bf16 v[156:159], a[148:151], a[200:203], v[156:159]
v_accvgpr_read_b32 v251, a91
v_accvgpr_read_b32 v252, a92
v_accvgpr_read_b32 v253, a93
v_mfma_f32_16x16x32_bf16 v[156:159], a[152:155], a[196:199], v[156:159]
v_accvgpr_read_b32 v254, a94
v_accvgpr_read_b32 v255, a95
v_mul_f32 v248, v248, v232
v_mfma_f32_16x16x32_bf16 v[156:159], a[156:159], a[192:195], v[156:159]
s_waitcnt lgkmcnt(0)
v_mul_f32 v249, v249, v232
v_mul_f32 v250, v250, v232
v_mul_f32 v251, v251, v232
v_mfma_f32_16x16x32_bf16 v[128:131], a[160:163], a[224:227], v[128:131]
s_nop 0
ds_read_b128 a[192:195], v7 offset:3712
ds_read_b64 a[128:129], v6 offset:128
v_mul_f32 v252, v252, v232
v_mfma_f32_16x16x32_bf16 v[132:135], a[164:167], a[224:227], v[132:135]
v_mul_f32 v253, v253, v232
v_mul_f32 v254, v254, v232
v_mul_f32 v255, v255, v232
v_mfma_f32_16x16x32_bf16 v[132:135], a[160:163], a[228:231], v[132:135]
s_nop 0
ds_read_b64 a[130:131], v6 offset:136
ds_read_b128 a[196:199], v7 offset:3200
v_cvt_pk_bf16_f32 v248, v248, v249
v_mfma_f32_16x16x32_bf16 v[136:139], a[160:163], a[232:235], v[136:139]
v_cvt_pk_bf16_f32 v249, v250, v251
v_cvt_pk_bf16_f32 v250, v252, v253
v_cvt_pk_bf16_f32 v251, v254, v255
v_mfma_f32_16x16x32_bf16 v[136:139], a[164:167], a[228:231], v[136:139]
buffer_store_dwordx4 v[248:251], v1, s[44:47], s70 offen offset:3072 sc1
v_mfma_f32_16x16x32_bf16 v[136:139], a[168:171], a[224:227], v[136:139]
s_add_u32 s70, s70, 0x80000
ds_read_b64 a[132:133], v6 offset:640
ds_read_b64 a[134:135], v6 offset:648
v_accvgpr_read_b32 v240, a96
v_mfma_f32_16x16x32_bf16 v[140:143], a[172:175], a[224:227], v[140:143]
v_accvgpr_read_b32 v241, a97
v_accvgpr_read_b32 v242, a98
v_accvgpr_read_b32 v243, a99
v_mfma_f32_16x16x32_bf16 v[140:143], a[168:171], a[228:231], v[140:143]
s_nop 0
ds_read_b128 a[200:203], v7 offset:2688
ds_read_b64 a[136:137], v6 offset:1152
v_accvgpr_read_b32 v244, a100
v_mfma_f32_16x16x32_bf16 v[140:143], a[164:167], a[232:235], v[140:143]
v_accvgpr_read_b32 v245, a101
v_accvgpr_read_b32 v246, a102
v_accvgpr_read_b32 v247, a103
v_mfma_f32_16x16x32_bf16 v[140:143], a[160:163], a[236:239], v[140:143]
v_mul_f32 v240, v240, v236
v_mul_f32 v241, v241, v236
v_mul_f32 v242, v242, v236
v_mfma_f32_16x16x32_bf16 v[144:147], a[160:163], a[240:243], v[144:147]
s_nop 0
ds_read_b64 a[138:139], v6 offset:1160
ds_read_b128 a[204:207], v7 offset:2176
v_mul_f32 v243, v243, v236
v_mfma_f32_16x16x32_bf16 v[144:147], a[164:167], a[236:239], v[144:147]
v_mul_f32 v244, v244, v236
v_mul_f32 v245, v245, v236
v_mul_f32 v246, v246, v236
v_mfma_f32_16x16x32_bf16 v[144:147], a[168:171], a[232:235], v[144:147]
s_nop 0
ds_read_b64 a[140:141], v6 offset:1664
ds_read_b64 a[142:143], v6 offset:1672
v_mul_f32 v247, v247, v236
v_mfma_f32_16x16x32_bf16 v[144:147], a[172:175], a[228:231], v[144:147]
v_cvt_pk_bf16_f32 v240, v240, v241
v_cvt_pk_bf16_f32 v241, v242, v243
v_cvt_pk_bf16_f32 v242, v244, v245
v_mfma_f32_16x16x32_bf16 v[144:147], a[176:179], a[224:227], v[144:147]
v_cvt_pk_bf16_f32 v243, v246, v247
v_mfma_f32_16x16x32_bf16 v[148:151], a[180:183], a[224:227], v[148:151]
s_nop 0
ds_read_b128 a[208:211], v7 offset:1664
ds_read_b64 a[144:145], v6 offset:2176
v_mfma_f32_16x16x32_bf16 v[148:151], a[176:179], a[228:231], v[148:151]
buffer_store_dwordx4 v[240:243], v1, s[44:47], s70 offen sc1
v_mfma_f32_16x16x32_bf16 v[148:151], a[172:175], a[232:235], v[148:151]
v_accvgpr_read_b32 v248, a104
v_accvgpr_read_b32 v249, a105
v_accvgpr_read_b32 v250, a106
v_mfma_f32_16x16x32_bf16 v[148:151], a[168:171], a[236:239], v[148:151]
s_nop 0
ds_read_b64 a[146:147], v6 offset:2184
ds_read_b128 a[212:215], v7 offset:1152
v_accvgpr_read_b32 v251, a107
v_mfma_f32_16x16x32_bf16 v[148:151], a[164:167], a[240:243], v[148:151]
v_accvgpr_read_b32 v252, a108
v_accvgpr_read_b32 v253, a109
v_accvgpr_read_b32 v254, a110
v_mfma_f32_16x16x32_bf16 v[148:151], a[160:163], a[244:247], v[148:151]
s_nop 0
ds_read_b64 a[148:149], v6 offset:2688
ds_read_b64 a[150:151], v6 offset:2696
v_accvgpr_read_b32 v255, a111
v_mfma_f32_16x16x32_bf16 v[152:155], a[160:163], a[248:251], v[152:155]
v_mul_f32 v248, v248, v236
v_mul_f32 v249, v249, v236
v_mul_f32 v250, v250, v236
v_mfma_f32_16x16x32_bf16 v[152:155], a[164:167], a[244:247], v[152:155]
v_mul_f32 v251, v251, v236
v_mul_f32 v252, v252, v236
v_mul_f32 v253, v253, v236
v_mfma_f32_16x16x32_bf16 v[152:155], a[168:171], a[240:243], v[152:155]
s_nop 0
ds_read_b128 a[216:219], v7 offset:640
ds_read_b64 a[152:153], v6 offset:3200
v_mul_f32 v254, v254, v236
v_mfma_f32_16x16x32_bf16 v[152:155], a[172:175], a[236:239], v[152:155]
v_mul_f32 v255, v255, v236
v_cvt_pk_bf16_f32 v248, v248, v249
v_cvt_pk_bf16_f32 v249, v250, v251
v_mfma_f32_16x16x32_bf16 v[152:155], a[176:179], a[232:235], v[152:155]
s_nop 0
ds_read_b64 a[154:155], v6 offset:3208
ds_read_b128 a[220:223], v7 offset:128
v_cvt_pk_bf16_f32 v250, v252, v253
v_mfma_f32_16x16x32_bf16 v[152:155], a[180:183], a[228:231], v[152:155]
v_cvt_pk_bf16_f32 v251, v254, v255
v_mfma_f32_16x16x32_bf16 v[152:155], a[184:187], a[224:227], v[152:155]
buffer_store_dwordx4 v[248:251], v1, s[44:47], s70 offen offset:1024 sc1
v_mfma_f32_16x16x32_bf16 v[156:159], a[188:191], a[224:227], v[156:159]
s_nop 0
ds_read_b64 a[156:157], v6 offset:3712
ds_read_b64 a[158:159], v6 offset:3720
v_accvgpr_read_b32 v240, a112
v_mfma_f32_16x16x32_bf16 v[156:159], a[184:187], a[228:231], v[156:159]
v_accvgpr_read_b32 v241, a113
v_accvgpr_read_b32 v242, a114
v_accvgpr_read_b32 v243, a115
v_mfma_f32_16x16x32_bf16 v[156:159], a[180:183], a[232:235], v[156:159]
v_accvgpr_read_b32 v244, a116
v_accvgpr_read_b32 v245, a117
v_accvgpr_read_b32 v246, a118
v_mfma_f32_16x16x32_bf16 v[156:159], a[176:179], a[236:239], v[156:159]
v_accvgpr_read_b32 v247, a119
v_mul_f32 v240, v240, v236
v_mul_f32 v241, v241, v236
v_mfma_f32_16x16x32_bf16 v[156:159], a[172:175], a[240:243], v[156:159]
v_mul_f32 v242, v242, v236
v_mul_f32 v243, v243, v236
v_mul_f32 v244, v244, v236
v_mfma_f32_16x16x32_bf16 v[156:159], a[168:171], a[244:247], v[156:159]
v_mul_f32 v245, v245, v236
v_mul_f32 v246, v246, v236
v_mul_f32 v247, v247, v236
v_mfma_f32_16x16x32_bf16 v[156:159], a[164:167], a[248:251], v[156:159]
v_cvt_pk_bf16_f32 v240, v240, v241
v_cvt_pk_bf16_f32 v241, v242, v243
v_cvt_pk_bf16_f32 v242, v244, v245
v_mfma_f32_16x16x32_bf16 v[156:159], a[160:163], a[252:255], v[156:159]
s_waitcnt lgkmcnt(0)
v_cvt_pk_bf16_f32 v243, v246, v247
v_mfma_f32_16x16x32_bf16 v[128:131], a[128:131], a[192:195], v[128:131]
s_nop 0
ds_read_b128 a[224:227], v7 offset:3776
ds_read_b64 a[160:161], v6 offset:192
v_mfma_f32_16x16x32_bf16 v[132:135], a[132:135], a[192:195], v[132:135]
buffer_store_dwordx4 v[240:243], v1, s[44:47], s70 offen offset:2048 sc1
v_mfma_f32_16x16x32_bf16 v[132:135], a[128:131], a[196:199], v[132:135]
s_nop 0
ds_read_b64 a[162:163], v6 offset:200
ds_read_b128 a[228:231], v7 offset:3264
v_accvgpr_read_b32 v248, a120
v_mfma_f32_16x16x32_bf16 v[136:139], a[128:131], a[200:203], v[136:139]
v_accvgpr_read_b32 v249, a121
v_accvgpr_read_b32 v250, a122
v_accvgpr_read_b32 v251, a123
v_mfma_f32_16x16x32_bf16 v[136:139], a[132:135], a[196:199], v[136:139]
v_accvgpr_read_b32 v252, a124
v_accvgpr_read_b32 v253, a125
v_accvgpr_read_b32 v254, a126
v_mfma_f32_16x16x32_bf16 v[136:139], a[136:139], a[192:195], v[136:139]
s_nop 0
ds_read_b64 a[164:165], v6 offset:704
ds_read_b64 a[166:167], v6 offset:712
v_accvgpr_read_b32 v255, a127
v_mfma_f32_16x16x32_bf16 v[140:143], a[140:143], a[192:195], v[140:143]
v_mul_f32 v248, v248, v236
v_mul_f32 v249, v249, v236
v_mul_f32 v250, v250, v236
v_mfma_f32_16x16x32_bf16 v[140:143], a[136:139], a[196:199], v[140:143]
s_nop 0
ds_read_b128 a[232:235], v7 offset:2752
ds_read_b64 a[168:169], v6 offset:1216
v_mul_f32 v251, v251, v236
v_mfma_f32_16x16x32_bf16 v[140:143], a[132:135], a[200:203], v[140:143]
v_mul_f32 v252, v252, v236
v_mul_f32 v253, v253, v236
v_mul_f32 v254, v254, v236
v_mfma_f32_16x16x32_bf16 v[140:143], a[128:131], a[204:207], v[140:143]
v_mul_f32 v255, v255, v236
v_cvt_pk_bf16_f32 v248, v248, v249
v_cvt_pk_bf16_f32 v249, v250, v251
v_mfma_f32_16x16x32_bf16 v[144:147], a[128:131], a[208:211], v[144:147]
s_nop 0
ds_read_b64 a[170:171], v6 offset:1224
ds_read_b128 a[236:239], v7 offset:2240
v_cvt_pk_bf16_f32 v250, v252, v253
v_mfma_f32_16x16x32_bf16 v[144:147], a[132:135], a[204:207], v[144:147]
v_cvt_pk_bf16_f32 v251, v254, v255
v_mfma_f32_16x16x32_bf16 v[144:147], a[136:139], a[200:203], v[144:147]
s_nop 0
ds_read_b64 a[172:173], v6 offset:1728
ds_read_b64 a[174:175], v6 offset:1736
v_mfma_f32_16x16x32_bf16 v[144:147], a[140:143], a[196:199], v[144:147]
buffer_store_dwordx4 v[248:251], v1, s[44:47], s70 offen offset:3072 sc1
v_mfma_f32_16x16x32_bf16 v[144:147], a[144:147], a[192:195], v[144:147]
s_mov_b32 s73, 0x6f800000
v_add_f32 v227, v226, v230
v_add_f32 v231, v234, v238
v_add_f32 v227, v227, v231
v_mfma_f32_16x16x32_bf16 v[148:151], a[148:151], a[192:195], v[148:151]
s_nop 0
ds_read_b128 a[240:243], v7 offset:1728
ds_read_b64 a[176:177], v6 offset:2240
v_cmp_nlt_f32 vcc, v227, s73
v_mfma_f32_16x16x32_bf16 v[148:151], a[144:147], a[196:199], v[148:151]
s_lshl_b32 s73, s58, 2
v_mfma_f32_16x16x32_bf16 v[148:151], a[140:143], a[200:203], v[148:151]
s_add_u32 s73, s73, 163328
v_mov_b32 v231, s73
v_mfma_f32_16x16x32_bf16 v[148:151], a[136:139], a[204:207], v[148:151]
s_or_b32 s73, vcc_lo, vcc_hi
ds_read_b64 a[178:179], v6 offset:2248
ds_read_b128 a[244:247], v7 offset:1216
v_mfma_f32_16x16x32_bf16 v[148:151], a[132:135], a[208:211], v[148:151]
s_min_u32 s73, s73, 1
v_mov_b32 v227, s73
v_mfma_f32_16x16x32_bf16 v[148:151], a[128:131], a[212:215], v[148:151]
s_nop 0
ds_read_b64 a[180:181], v6 offset:2752
ds_read_b64 a[182:183], v6 offset:2760
ds_write_b32 v231, v227
v_mfma_f32_16x16x32_bf16 v[152:155], a[128:131], a[216:219], v[152:155]
v_mfma_f32_16x16x32_bf16 v[152:155], a[132:135], a[212:215], v[152:155]
v_mfma_f32_16x16x32_bf16 v[152:155], a[136:139], a[208:211], v[152:155]
s_nop 0
ds_read_b128 a[248:251], v7 offset:704
ds_read_b64 a[184:185], v6 offset:3264
v_mfma_f32_16x16x32_bf16 v[152:155], a[140:143], a[204:207], v[152:155]
v_mfma_f32_16x16x32_bf16 v[152:155], a[144:147], a[200:203], v[152:155]
s_nop 0
ds_read_b64 a[186:187], v6 offset:3272
ds_read_b128 a[252:255], v7 offset:192
v_mfma_f32_16x16x32_bf16 v[152:155], a[148:151], a[196:199], v[152:155]
v_mfma_f32_16x16x32_bf16 v[152:155], a[152:155], a[192:195], v[152:155]
v_mfma_f32_16x16x32_bf16 v[156:159], a[156:159], a[192:195], v[156:159]
s_nop 0
ds_read_b64 a[188:189], v6 offset:3776
ds_read_b64 a[190:191], v6 offset:3784
v_mfma_f32_16x16x32_bf16 v[156:159], a[152:155], a[196:199], v[156:159]
v_mfma_f32_16x16x32_bf16 v[156:159], a[148:151], a[200:203], v[156:159]
v_mfma_f32_16x16x32_bf16 v[156:159], a[144:147], a[204:207], v[156:159]
v_mfma_f32_16x16x32_bf16 v[156:159], a[140:143], a[208:211], v[156:159]
v_mfma_f32_16x16x32_bf16 v[156:159], a[136:139], a[212:215], v[156:159]
v_mfma_f32_16x16x32_bf16 v[156:159], a[132:135], a[216:219], v[156:159]
v_mfma_f32_16x16x32_bf16 v[156:159], a[128:131], a[220:223], v[156:159]
s_waitcnt lgkmcnt(0)
v_mfma_f32_16x16x32_bf16 v[128:131], a[160:163], a[224:227], v[128:131]
s_nop 0
ds_read_b128 a[192:195], v7 offset:3840
ds_read_b64 a[128:129], v6 offset:256
v_mfma_f32_16x16x32_bf16 v[132:135], a[164:167], a[224:227], v[132:135]
v_mfma_f32_16x16x32_bf16 v[132:135], a[160:163], a[228:231], v[132:135]
s_nop 0
ds_read_b64 a[130:131], v6 offset:264
ds_read_b128 a[196:199], v7 offset:3328
v_mfma_f32_16x16x32_bf16 v[136:139], a[160:163], a[232:235], v[136:139]
v_mfma_f32_16x16x32_bf16 v[136:139], a[164:167], a[228:231], v[136:139]
v_mfma_f32_16x16x32_bf16 v[136:139], a[168:171], a[224:227], v[136:139]
s_nop 0
ds_read_b64 a[132:133], v6 offset:768
ds_read_b64 a[134:135], v6 offset:776
v_mfma_f32_16x16x32_bf16 v[140:143], a[172:175], a[224:227], v[140:143]
v_mfma_f32_16x16x32_bf16 v[140:143], a[168:171], a[228:231], v[140:143]
s_nop 0
ds_read_b128 a[200:203], v7 offset:2816
ds_read_b64 a[136:137], v6 offset:1280
v_mfma_f32_16x16x32_bf16 v[140:143], a[164:167], a[232:235], v[140:143]
v_mfma_f32_16x16x32_bf16 v[140:143], a[160:163], a[236:239], v[140:143]
v_mfma_f32_16x16x32_bf16 v[144:147], a[160:163], a[240:243], v[144:147]
s_nop 0
ds_read_b64 a[138:139], v6 offset:1288
ds_read_b128 a[204:207], v7 offset:2304
v_mfma_f32_16x16x32_bf16 v[144:147], a[164:167], a[236:239], v[144:147]
v_mfma_f32_16x16x32_bf16 v[144:147], a[168:171], a[232:235], v[144:147]
s_nop 0
ds_read_b64 a[140:141], v6 offset:1792
ds_read_b64 a[142:143], v6 offset:1800
v_mfma_f32_16x16x32_bf16 v[144:147], a[172:175], a[228:231], v[144:147]
v_mfma_f32_16x16x32_bf16 v[144:147], a[176:179], a[224:227], v[144:147]
s_xor_b32 s71, s12, 0x100
v_mfma_f32_16x16x32_bf16 v[148:151], a[180:183], a[224:227], v[148:151]
s_add_u32 m0, s77, 16384
ds_read_b128 a[208:211], v7 offset:1792
ds_read_b64 a[144:145], v6 offset:2304
v_mfma_f32_16x16x32_bf16 v[148:151], a[176:179], a[228:231], v[148:151]
s_add_u32 s72, s71, 0
buffer_load_dwordx4 v15, s[24:27], s72 offen lds
s_nop 3
s_mov_b64 exec, 0
s_cmp_eq_u32 s58, 0
s_cbranch_scc1 Lstube0
s_cmp_eq_u32 s58, 1
s_cbranch_scc1 Lstube1
s_cmp_eq_u32 s58, 2
s_cbranch_scc1 Lstube2
s_branch Lstube3
Lrete:
s_mov_b64 exec, -1
s_nop 3
v_mfma_f32_16x16x32_bf16 v[148:151], a[172:175], a[232:235], v[148:151]
s_waitcnt vmcnt(1) lgkmcnt(15)
v_mfma_f32_16x16x32_bf16 v[148:151], a[168:171], a[236:239], v[148:151]
s_barrier
ds_read_b64 a[146:147], v6 offset:2312
ds_read_b128 a[212:215], v7 offset:1280
v_mfma_f32_16x16x32_bf16 v[148:151], a[164:167], a[240:243], v[148:151]
s_add_u32 s72, s71, 15360
buffer_load_dwordx4 v15, s[24:27], s72 offen offset:1024 lds
v_mfma_f32_16x16x32_bf16 v[148:151], a[160:163], a[244:247], v[148:151]
s_nop 0
ds_read_b64 a[148:149], v6 offset:2816
ds_read_b64 a[150:151], v6 offset:2824
v_mfma_f32_16x16x32_bf16 v[152:155], a[160:163], a[248:251], v[152:155]
v_mov_b32 v244, 163328
v_mfma_f32_16x16x32_bf16 v[152:155], a[164:167], a[244:247], v[152:155]
ds_read_b128 v[240:243], v244
v_mfma_f32_16x16x32_bf16 v[152:155], a[168:171], a[240:243], v[152:155]
s_nop 0
ds_read_b128 a[216:219], v7 offset:768
ds_read_b64 a[152:153], v6 offset:3328
v_mfma_f32_16x16x32_bf16 v[152:155], a[172:175], a[236:239], v[152:155]
v_mfma_f32_16x16x32_bf16 v[152:155], a[176:179], a[232:235], v[152:155]
s_add_u32 s72, s71, 30720
ds_read_b64 a[154:155], v6 offset:3336
ds_read_b128 a[220:223], v7 offset:256
v_mfma_f32_16x16x32_bf16 v[152:155], a[180:183], a[228:231], v[152:155]
buffer_load_dwordx4 v15, s[24:27], s72 offen offset:2048 lds
v_mfma_f32_16x16x32_bf16 v[152:155], a[184:187], a[224:227], v[152:155]
s_waitcnt lgkmcnt(4)
v_or3_b32 v240, v240, v241, v242
v_or_b32 v240, v240, v243
v_mfma_f32_16x16x32_bf16 v[156:159], a[188:191], a[224:227], v[156:159]
s_nop 0
ds_read_b64 a[156:157], v6 offset:3840
ds_read_b64 a[158:159], v6 offset:3848
v_cmp_lt_u32 vcc, s86, v240
s_cbranch_vccnz Lslow
v_mfma_f32_16x16x32_bf16 v[156:159], a[184:187], a[228:231], v[156:159]
v_or_b32 v240, s58, v0
v_mov_b32 v241, 2
v_mfma_f32_16x16x32_bf16 v[156:159], a[180:183], a[232:235], v[156:159]
v_min_u32 v240, 1, v240
v_lshlrev_b32 v240, 30, v240
v_mfma_f32_16x16x32_bf16 v[156:159], a[176:179], a[236:239], v[156:159]
s_add_u32 s72, s71, 46080
buffer_load_dwordx4 v15, s[24:27], s72 offen offset:3072 lds
v_mfma_f32_16x16x32_bf16 v[156:159], a[172:175], a[240:243], v[156:159]
buffer_store_dword v241, v240, s[44:47], s91 offen sc1
v_mfma_f32_16x16x32_bf16 v[156:159], a[168:171], a[244:247], v[156:159]
s_add_u32 s80, s93, 0x3400000
v_and_b32 v166, 7, v0
v_lshlrev_b32 v166, 4, v166
v_mfma_f32_16x16x32_bf16 v[156:159], a[164:167], a[248:251], v[156:159]
s_and_b32 s81, s59, 4
v_and_b32 v3, 3, v0
v_add_u32 v3, 1, v3
v_mfma_f32_16x16x32_bf16 v[156:159], a[160:163], a[252:255], v[156:159]
s_waitcnt lgkmcnt(0)
v_mul_u32_u24 v3, s81, v3
v_lshrrev_b32 v2, 4, v0
v_mfma_f32_16x16x32_bf16 v[128:131], a[128:131], a[192:195], v[128:131]
s_nop 0
ds_read_b128 a[224:227], v7 offset:3904
ds_read_b64 a[160:161], v6 offset:320
v_mfma_f32_16x16x32_bf16 v[132:135], a[132:135], a[192:195], v[132:135]
s_xor_b32 s71, s12, 0x180
v_lshl_add_u32 v2, v2, 10, v3
v_bfe_u32 v112, v0, 3, 1
v_mfma_f32_16x16x32_bf16 v[132:135], a[128:131], a[196:199], v[132:135]
s_add_u32 m0, s77, 32768
ds_read_b64 a[162:163], v6 offset:328
ds_read_b128 a[228:231], v7 offset:3392
v_mfma_f32_16x16x32_bf16 v[136:139], a[128:131], a[200:203], v[136:139]
s_add_u32 s72, s71, 0
buffer_load_dwordx4 v15, s[24:27], s72 offen lds
v_mfma_f32_16x16x32_bf16 v[136:139], a[132:135], a[196:199], v[136:139]
s_xor_b32 s82, s78, 0
v_lshl_add_u32 v166, v112, 8, v166
v_bfe_u32 v112, v0, 4, 1
v_mfma_f32_16x16x32_bf16 v[136:139], a[136:139], a[192:195], v[136:139]
s_lshl_b32 s82, s82, 10
ds_read_b64 a[164:165], v6 offset:832
ds_read_b64 a[166:167], v6 offset:840
v_mfma_f32_16x16x32_bf16 v[140:143], a[140:143], a[192:195], v[140:143]
s_add_u32 s82, s82, s74
buffer_load_dword v3, v2, s[44:47], s82 offen sc1
v_mfma_f32_16x16x32_bf16 v[140:143], a[136:139], a[196:199], v[140:143]
s_add_u32 s72, s71, 15360
ds_read_b128 a[232:235], v7 offset:2880
ds_read_b64 a[168:169], v6 offset:1344
v_mfma_f32_16x16x32_bf16 v[140:143], a[132:135], a[200:203], v[140:143]
buffer_load_dwordx4 v15, s[24:27], s72 offen offset:1024 lds
v_mfma_f32_16x16x32_bf16 v[140:143], a[128:131], a[204:207], v[140:143]
v_lshl_add_u32 v166, v112, 7, v166
v_lshrrev_b32 v112, 5, v0
v_mfma_f32_16x16x32_bf16 v[144:147], a[128:131], a[208:211], v[144:147]
s_nop 0
ds_read_b64 a[170:171], v6 offset:1352
ds_read_b128 a[236:239], v7 offset:2368
v_mfma_f32_16x16x32_bf16 v[144:147], a[132:135], a[204:207], v[144:147]
v_lshl_add_u32 v166, v112, 9, v166
v_and_b32 v112, 15, v0
v_mfma_f32_16x16x32_bf16 v[144:147], a[136:139], a[200:203], v[144:147]
s_nop 0
ds_read_b64 a[172:173], v6 offset:1856
ds_read_b64 a[174:175], v6 offset:1864
v_mfma_f32_16x16x32_bf16 v[144:147], a[140:143], a[196:199], v[144:147]
s_add_u32 s72, s71, 30720
buffer_load_dwordx4 v15, s[24:27], s72 offen offset:2048 lds
v_mfma_f32_16x16x32_bf16 v[144:147], a[144:147], a[192:195], v[144:147]
v_lshrrev_b32 v113, 2, v0
v_bfe_u32 v114, v0, 3, 2
v_mfma_f32_16x16x32_bf16 v[148:151], a[148:151], a[192:195], v[148:151]
s_nop 0
ds_read_b128 a[240:243], v7 offset:1856
ds_read_b64 a[176:177], v6 offset:2368
v_mfma_f32_16x16x32_bf16 v[148:151], a[144:147], a[196:199], v[148:151]
v_and_b32 v115, 3, v0
v_lshlrev_b32 v8, 7, v113
v_mfma_f32_16x16x32_bf16 v[148:151], a[140:143], a[200:203], v[148:151]
v_lshl_add_u32 v8, v114, 5, v8
v_lshl_add_u32 v8, v115, 3, v8
v_mfma_f32_16x16x32_bf16 v[148:151], a[136:139], a[204:207], v[148:151]
s_nop 0
ds_read_b64 a[178:179], v6 offset:2376
ds_read_b128 a[244:247], v7 offset:1344
v_mfma_f32_16x16x32_bf16 v[148:151], a[132:135], a[208:211], v[148:151]
s_add_u32 s72, s71, 46080
buffer_load_dwordx4 v15, s[24:27], s72 offen offset:3072 lds
v_mfma_f32_16x16x32_bf16 v[148:151], a[128:131], a[212:215], v[148:151]
s_nop 0
ds_read_b64 a[180:181], v6 offset:2880
ds_read_b64 a[182:183], v6 offset:2888
v_mfma_f32_16x16x32_bf16 v[152:155], a[128:131], a[216:219], v[152:155]
v_add_u32 v8, s77, v8
v_subrev_u32 v8, s64, v8
v_mfma_f32_16x16x32_bf16 v[152:155], a[132:135], a[212:215], v[152:155]
v_xor_b32 v9, 32, v8
v_xor_b32 v10, 64, v8
v_mfma_f32_16x16x32_bf16 v[152:155], a[136:139], a[208:211], v[152:155]
s_nop 0
ds_read_b128 a[248:251], v7 offset:832
ds_read_b64 a[184:185], v6 offset:3392
v_mfma_f32_16x16x32_bf16 v[152:155], a[140:143], a[204:207], v[152:155]
v_xor_b32 v11, 0x60, v8
v_lshlrev_b32 v5, 8, v113
v_mfma_f32_16x16x32_bf16 v[152:155], a[144:147], a[200:203], v[152:155]
s_xor_b32 s71, s13, 0x80
ds_read_b64 a[186:187], v6 offset:3400
ds_read_b128 a[252:255], v7 offset:320
v_mfma_f32_16x16x32_bf16 v[152:155], a[148:151], a[196:199], v[152:155]
s_add_u32 m0, s77, 49152
v_and_b32 v114, 1, v0
v_lshl_add_u32 v5, v114, 7, v5
v_mfma_f32_16x16x32_bf16 v[152:155], a[152:155], a[192:195], v[152:155]
s_add_u32 s72, s71, 0
buffer_load_dwordx4 v15, s[24:27], s72 offen lds
v_mfma_f32_16x16x32_bf16 v[156:159], a[156:159], a[192:195], v[156:159]
s_nop 0
ds_read_b64 a[188:189], v6 offset:3904
ds_read_b64 a[190:191], v6 offset:3912
v_mfma_f32_16x16x32_bf16 v[156:159], a[152:155], a[196:199], v[156:159]
v_bfe_u32 v114, v0, 1, 1
v_lshl_add_u32 v5, v114, 3, v5
v_mfma_f32_16x16x32_bf16 v[156:159], a[148:151], a[200:203], v[156:159]
v_lshlrev_b32 v114, 1, s58
v_xor_b32 v114, v114, v113
v_mfma_f32_16x16x32_bf16 v[156:159], a[144:147], a[204:207], v[156:159]
s_add_u32 s72, s71, 15360
buffer_load_dwordx4 v15, s[24:27], s72 offen offset:1024 lds
v_mfma_f32_16x16x32_bf16 v[156:159], a[140:143], a[208:211], v[156:159]
v_and_b32 v114, 7, v114
v_lshl_add_u32 v5, v114, 4, v5
v_mfma_f32_16x16x32_bf16 v[156:159], a[136:139], a[212:215], v[156:159]
v_add_u32 v5, 147456, v5
v_bfe_u32 v114, v0, 1, 2
v_mfma_f32_16x16x32_bf16 v[156:159], a[132:135], a[216:219], v[156:159]
v_lshrrev_b32 v115, 4, v0
v_lshlrev_b32 v116, 7, v112
v_mfma_f32_16x16x32_bf16 v[156:159], a[128:131], a[220:223], v[156:159]
s_waitcnt lgkmcnt(0)
v_lshl_add_u32 v116, v114, 5, v116
v_lshl_add_u32 v116, v115, 3, v116
v_mfma_f32_16x16x32_bf16 v[128:131], a[160:163], a[224:227], v[128:131]
s_nop 0
ds_read_b128 a[192:195], v7 offset:3968
ds_read_b64 a[128:129], v6 offset:384
v_mfma_f32_16x16x32_bf16 v[132:135], a[164:167], a[224:227], v[132:135]
s_add_u32 s72, s71, 30720
Lstub9:
s_cbranch_execz Lret
buffer_load_dwordx4 v15, s[24:27], s72 offen offset:2048 lds
v_mfma_f32_16x16x32_bf16 v[132:135], a[160:163], a[228:231], v[132:135]
s_nop 0
ds_read_b64 a[130:131], v6 offset:392
ds_read_b128 a[196:199], v7 offset:3456
v_mfma_f32_16x16x32_bf16 v[136:139], a[160:163], a[232:235], v[136:139]
v_add_u32 v116, s64, v116
v_add_u32 v116, 131072, v116
v_mfma_f32_16x16x32_bf16 v[136:139], a[164:167], a[228:231], v[136:139]
v_xor_b32 v117, 32, v116
v_xor_b32 v118, 64, v116
v_mfma_f32_16x16x32_bf16 v[136:139], a[168:171], a[224:227], v[136:139]
s_nop 0
ds_read_b64 a[132:133], v6 offset:896
ds_read_b64 a[134:135], v6 offset:904
v_mfma_f32_16x16x32_bf16 v[140:143], a[172:175], a[224:227], v[140:143]
v_xor_b32 v119, 0x60, v116
v_mfma_f32_16x16x32_bf16 v[140:143], a[168:171], a[228:231], v[140:143]
s_add_u32 s72, s71, 46080
ds_read_b128 a[200:203], v7 offset:2944
ds_read_b64 a[136:137], v6 offset:1408
v_mfma_f32_16x16x32_bf16 v[140:143], a[164:167], a[232:235], v[140:143]
buffer_load_dwordx4 v15, s[24:27], s72 offen offset:3072 lds
v_mfma_f32_16x16x32_bf16 v[140:143], a[160:163], a[236:239], v[140:143]
v_mfma_f32_16x16x32_bf16 v[144:147], a[160:163], a[240:243], v[144:147]
s_nop 0
ds_read_b64 a[138:139], v6 offset:1416
ds_read_b128 a[204:207], v7 offset:2432
v_mfma_f32_16x16x32_bf16 v[144:147], a[164:167], a[236:239], v[144:147]
v_mfma_f32_16x16x32_bf16 v[144:147], a[168:171], a[232:235], v[144:147]
s_nop 0
ds_read_b64 a[140:141], v6 offset:1920
ds_read_b64 a[142:143], v6 offset:1928
v_mfma_f32_16x16x32_bf16 v[144:147], a[172:175], a[228:231], v[144:147]
v_mfma_f32_16x16x32_bf16 v[144:147], a[176:179], a[224:227], v[144:147]
v_mfma_f32_16x16x32_bf16 v[148:151], a[180:183], a[224:227], v[148:151]
s_nop 0
ds_read_b128 a[208:211], v7 offset:1920
ds_read_b64 a[144:145], v6 offset:2432
v_mfma_f32_16x16x32_bf16 v[148:151], a[176:179], a[228:231], v[148:151]
v_mfma_f32_16x16x32_bf16 v[148:151], a[172:175], a[232:235], v[148:151]
s_waitcnt vmcnt(7)
v_cmp_gt_u32 vcc, 2, v3
s_or_b32 s81, vcc_lo, vcc_hi
s_cselect_b32 s81, 0x40000000, 0
v_or_b32 v4, s81, v1
v_mfma_f32_16x16x32_bf16 v[148:151], a[168:171], a[236:239], v[148:151]
s_nop 0
ds_read_b64 a[146:147], v6 offset:2440
ds_read_b128 a[212:215], v7 offset:1408
v_mfma_f32_16x16x32_bf16 v[148:151], a[164:167], a[240:243], v[148:151]
v_mfma_f32_16x16x32_bf16 v[148:151], a[160:163], a[244:247], v[148:151]
s_nop 0
ds_read_b64 a[148:149], v6 offset:2944
ds_read_b64 a[150:151], v6 offset:2952
v_mfma_f32_16x16x32_bf16 v[152:155], a[160:163], a[248:251], v[152:155]
v_mfma_f32_16x16x32_bf16 v[152:155], a[164:167], a[244:247], v[152:155]
s_lshr_b32 s69, s12, 18
v_mfma_f32_16x16x32_bf16 v[152:155], a[168:171], a[240:243], v[152:155]
s_lshl_b32 s69, s69, 12
ds_read_b128 a[216:219], v7 offset:896
ds_read_b64 a[152:153], v6 offset:3456
v_mfma_f32_16x16x32_bf16 v[152:155], a[172:175], a[236:239], v[152:155]
s_add_u32 s69, s69, s95
buffer_load_dwordx4 a[0:3], v4, s[44:47], s69 offen sc1
v_mfma_f32_16x16x32_bf16 v[152:155], a[176:179], a[232:235], v[152:155]
s_nop 0
ds_read_b64 a[154:155], v6 offset:3464
ds_read_b128 a[220:223], v7 offset:384
v_mfma_f32_16x16x32_bf16 v[152:155], a[180:183], a[228:231], v[152:155]
v_mfma_f32_16x16x32_bf16 v[152:155], a[184:187], a[224:227], v[152:155]
v_mfma_f32_16x16x32_bf16 v[156:159], a[188:191], a[224:227], v[156:159]
s_nop 0
ds_read_b64 a[156:157], v6 offset:3968
ds_read_b64 a[158:159], v6 offset:3976
v_mfma_f32_16x16x32_bf16 v[156:159], a[184:187], a[228:231], v[156:159]
buffer_load_dwordx4 a[4:7], v4, s[44:47], s69 offen offset:1024 sc1
v_mfma_f32_16x16x32_bf16 v[156:159], a[180:183], a[232:235], v[156:159]
v_mfma_f32_16x16x32_bf16 v[156:159], a[176:179], a[236:239], v[156:159]
v_mfma_f32_16x16x32_bf16 v[156:159], a[172:175], a[240:243], v[156:159]
v_mfma_f32_16x16x32_bf16 v[156:159], a[168:171], a[244:247], v[156:159]
buffer_load_dwordx4 a[8:11], v4, s[44:47], s69 offen offset:2048 sc1
v_mfma_f32_16x16x32_bf16 v[156:159], a[164:167], a[248:251], v[156:159]
v_mfma_f32_16x16x32_bf16 v[156:159], a[160:163], a[252:255], v[156:159]
s_waitcnt lgkmcnt(0)
v_mfma_f32_16x16x32_bf16 v[128:131], a[128:131], a[192:195], v[128:131]
s_nop 0
ds_read_b128 a[224:227], v7 offset:4032
ds_read_b64 a[160:161], v6 offset:448
v_mfma_f32_16x16x32_bf16 v[132:135], a[132:135], a[192:195], v[132:135]
v_mfma_f32_16x16x32_bf16 v[132:135], a[128:131], a[196:199], v[132:135]
s_nop 0
ds_read_b64 a[162:163], v6 offset:456
ds_read_b128 a[228:231], v7 offset:3520
v_mfma_f32_16x16x32_bf16 v[136:139], a[128:131], a[200:203], v[136:139]
buffer_load_dwordx4 a[12:15], v4, s[44:47], s69 offen offset:3072 sc1
v_mfma_f32_16x16x32_bf16 v[136:139], a[132:135], a[196:199], v[136:139]
v_mfma_f32_16x16x32_bf16 v[136:139], a[136:139], a[192:195], v[136:139]
s_nop 0
ds_read_b64 a[164:165], v6 offset:960
ds_read_b64 a[166:167], v6 offset:968
v_mfma_f32_16x16x32_bf16 v[140:143], a[140:143], a[192:195], v[140:143]
v_mfma_f32_16x16x32_bf16 v[140:143], a[136:139], a[196:199], v[140:143]
s_nop 0
ds_read_b128 a[232:235], v7 offset:3008
ds_read_b64 a[168:169], v6 offset:1472
v_mfma_f32_16x16x32_bf16 v[140:143], a[132:135], a[200:203], v[140:143]
s_add_u32 s69, s69, 0x20000
buffer_load_dwordx4 a[16:19], v4, s[44:47], s69 offen sc1
v_mfma_f32_16x16x32_bf16 v[140:143], a[128:131], a[204:207], v[140:143]
v_mfma_f32_16x16x32_bf16 v[144:147], a[128:131], a[208:211], v[144:147]
s_nop 0
ds_read_b64 a[170:171], v6 offset:1480
ds_read_b128 a[236:239], v7 offset:2496
v_mfma_f32_16x16x32_bf16 v[144:147], a[132:135], a[204:207], v[144:147]
v_mfma_f32_16x16x32_bf16 v[144:147], a[136:139], a[200:203], v[144:147]
s_nop 0
ds_read_b64 a[172:173], v6 offset:1984
ds_read_b64 a[174:175], v6 offset:1992
v_mfma_f32_16x16x32_bf16 v[144:147], a[140:143], a[196:199], v[144:147]
buffer_load_dwordx4 a[20:23], v4, s[44:47], s69 offen offset:1024 sc1
v_mfma_f32_16x16x32_bf16 v[144:147], a[144:147], a[192:195], v[144:147]
v_mfma_f32_16x16x32_bf16 v[148:151], a[148:151], a[192:195], v[148:151]
s_nop 0
ds_read_b128 a[240:243], v7 offset:1984
ds_read_b64 a[176:177], v6 offset:2496
v_mfma_f32_16x16x32_bf16 v[148:151], a[144:147], a[196:199], v[148:151]
v_mfma_f32_16x16x32_bf16 v[148:151], a[140:143], a[200:203], v[148:151]
v_mfma_f32_16x16x32_bf16 v[148:151], a[136:139], a[204:207], v[148:151]
s_nop 0
ds_read_b64 a[178:179], v6 offset:2504
ds_read_b128 a[244:247], v7 offset:1472
v_mfma_f32_16x16x32_bf16 v[148:151], a[132:135], a[208:211], v[148:151]
buffer_load_dwordx4 a[24:27], v4, s[44:47], s69 offen offset:2048 sc1
v_mfma_f32_16x16x32_bf16 v[148:151], a[128:131], a[212:215], v[148:151]
s_nop 0
ds_read_b64 a[180:181], v6 offset:3008
ds_read_b64 a[182:183], v6 offset:3016
v_mfma_f32_16x16x32_bf16 v[152:155], a[128:131], a[216:219], v[152:155]
v_mfma_f32_16x16x32_bf16 v[152:155], a[132:135], a[212:215], v[152:155]
v_mfma_f32_16x16x32_bf16 v[152:155], a[136:139], a[208:211], v[152:155]
s_nop 0
ds_read_b128 a[248:251], v7 offset:960
ds_read_b64 a[184:185], v6 offset:3520
v_mfma_f32_16x16x32_bf16 v[152:155], a[140:143], a[204:207], v[152:155]
buffer_load_dwordx4 a[28:31], v4, s[44:47], s69 offen offset:3072 sc1
v_mfma_f32_16x16x32_bf16 v[152:155], a[144:147], a[200:203], v[152:155]
s_nop 0
ds_read_b64 a[186:187], v6 offset:3528
ds_read_b128 a[252:255], v7 offset:448
v_mfma_f32_16x16x32_bf16 v[152:155], a[148:151], a[196:199], v[152:155]
v_mfma_f32_16x16x32_bf16 v[152:155], a[152:155], a[192:195], v[152:155]
s_lshr_b32 s69, s13, 18
v_mfma_f32_16x16x32_bf16 v[156:159], a[156:159], a[192:195], v[156:159]
s_lshl_b32 s69, s69, 12
ds_read_b64 a[188:189], v6 offset:4032
ds_read_b64 a[190:191], v6 offset:4040
v_mfma_f32_16x16x32_bf16 v[156:159], a[152:155], a[196:199], v[156:159]
s_add_u32 s69, s69, s95
buffer_load_dwordx4 a[32:35], v4, s[44:47], s69 offen sc1
v_mfma_f32_16x16x32_bf16 v[156:159], a[148:151], a[200:203], v[156:159]
v_mfma_f32_16x16x32_bf16 v[156:159], a[144:147], a[204:207], v[156:159]
v_mfma_f32_16x16x32_bf16 v[156:159], a[140:143], a[208:211], v[156:159]
v_mfma_f32_16x16x32_bf16 v[156:159], a[136:139], a[212:215], v[156:159]
buffer_load_dwordx4 a[36:39], v4, s[44:47], s69 offen offset:1024 sc1
v_mfma_f32_16x16x32_bf16 v[156:159], a[132:135], a[216:219], v[156:159]
v_mfma_f32_16x16x32_bf16 v[156:159], a[128:131], a[220:223], v[156:159]
s_waitcnt lgkmcnt(0)
v_mfma_f32_16x16x32_bf16 v[128:131], a[160:163], a[224:227], v[128:131]
s_nop 0
ds_read_b64_tr_b16 v[192:193], v8 offset:0
ds_read_b64_tr_b16 v[194:195], v8 offset:2048
v_mfma_f32_16x16x32_bf16 v[132:135], a[164:167], a[224:227], v[132:135]
v_mfma_f32_16x16x32_bf16 v[132:135], a[160:163], a[228:231], v[132:135]
s_nop 0
ds_read_b64_tr_b16 v[196:197], v9 offset:0
ds_read_b64_tr_b16 v[198:199], v9 offset:2048
v_mfma_f32_16x16x32_bf16 v[136:139], a[160:163], a[232:235], v[136:139]
buffer_load_dwordx4 a[40:43], v4, s[44:47], s69 offen offset:2048 sc1
v_mfma_f32_16x16x32_bf16 v[136:139], a[164:167], a[228:231], v[136:139]
s_nop 0
ds_read_b64_tr_b16 v[200:201], v10 offset:0
ds_read_b64_tr_b16 v[202:203], v10 offset:2048
v_mfma_f32_16x16x32_bf16 v[136:139], a[168:171], a[224:227], v[136:139]
v_mfma_f32_16x16x32_bf16 v[140:143], a[172:175], a[224:227], v[140:143]
s_nop 0
ds_read_b64_tr_b16 v[204:205], v11 offset:0
ds_read_b64_tr_b16 v[206:207], v11 offset:2048
v_mfma_f32_16x16x32_bf16 v[140:143], a[168:171], a[228:231], v[140:143]
v_cvt_pk_bf16_f32 v128, v128, v129
v_cvt_pk_bf16_f32 v129, v130, v131
v_cvt_pk_bf16_f32 v130, v132, v133
v_mfma_f32_16x16x32_bf16 v[140:143], a[164:167], a[232:235], v[140:143]
s_nop 0
ds_read_b64_tr_b16 v[208:209], v8 offset:4096
ds_read_b64_tr_b16 v[210:211], v8 offset:6144
v_cvt_pk_bf16_f32 v131, v134, v135
v_mfma_f32_16x16x32_bf16 v[140:143], a[160:163], a[236:239], v[140:143]
s_nop 0
buffer_load_dwordx4 a[44:47], v4, s[44:47], s69 offen offset:3072 sc1
v_permlane32_swap_b32 v128, v130
v_mfma_f32_16x16x32_bf16 v[144:147], a[160:163], a[240:243], v[144:147]
s_nop 0
ds_read_b64_tr_b16 v[212:213], v9 offset:4096
ds_read_b64_tr_b16 v[214:215], v9 offset:6144
v_permlane32_swap_b32 v129, v131
v_mfma_f32_16x16x32_bf16 v[144:147], a[164:167], a[236:239], v[144:147]
buffer_store_dwordx4 v[128:131], v166, s[44:47], s80 offen sc1
v_mfma_f32_16x16x32_bf16 v[144:147], a[168:171], a[232:235], v[144:147]
s_nop 0
ds_read_b64_tr_b16 v[216:217], v10 offset:4096
ds_read_b64_tr_b16 v[218:219], v10 offset:6144
v_mfma_f32_16x16x32_bf16 v[144:147], a[172:175], a[228:231], v[144:147]
s_add_u32 s69, s69, 0x20000
buffer_load_dwordx4 a[48:51], v4, s[44:47], s69 offen sc1
v_mfma_f32_16x16x32_bf16 v[144:147], a[176:179], a[224:227], v[144:147]
s_nop 0
ds_read_b64_tr_b16 v[220:221], v11 offset:4096
ds_read_b64_tr_b16 v[222:223], v11 offset:6144
v_cvt_pk_bf16_f32 v136, v136, v137
v_mfma_f32_16x16x32_bf16 v[148:151], a[180:183], a[224:227], v[148:151]
v_cvt_pk_bf16_f32 v137, v138, v139
v_cvt_pk_bf16_f32 v138, v140, v141
v_cvt_pk_bf16_f32 v139, v142, v143
v_mfma_f32_16x16x32_bf16 v[148:151], a[176:179], a[228:231], v[148:151]
s_nop 0
ds_read_b64_tr_b16 v[224:225], v8 offset:8192
ds_read_b64_tr_b16 v[226:227], v8 offset:10240
v_permlane32_swap_b32 v136, v138
v_mfma_f32_16x16x32_bf16 v[148:151], a[172:175], a[232:235], v[148:151]
v_permlane32_swap_b32 v137, v139
v_mfma_f32_16x16x32_bf16 v[148:151], a[168:171], a[236:239], v[148:151]
s_nop 0
ds_read_b64_tr_b16 v[228:229], v9 offset:8192
ds_read_b64_tr_b16 v[230:231], v9 offset:10240
v_mfma_f32_16x16x32_bf16 v[148:151], a[164:167], a[240:243], v[148:151]
buffer_load_dwordx4 a[52:55], v4, s[44:47], s69 offen offset:1024 sc1
v_mfma_f32_16x16x32_bf16 v[148:151], a[160:163], a[244:247], v[148:151]
s_nop 0
ds_read_b64_tr_b16 v[232:233], v10 offset:8192
ds_read_b64_tr_b16 v[234:235], v10 offset:10240
v_mfma_f32_16x16x32_bf16 v[152:155], a[160:163], a[248:251], v[152:155]
buffer_store_dwordx4 v[136:139], v166, s[44:47], s80 offen offset:1024 sc1
v_mfma_f32_16x16x32_bf16 v[152:155], a[164:167], a[244:247], v[152:155]
s_nop 0
ds_read_b64_tr_b16 v[236:237], v11 offset:8192
ds_read_b64_tr_b16 v[238:239], v11 offset:10240
v_mfma_f32_16x16x32_bf16 v[152:155], a[168:171], a[240:243], v[152:155]
buffer_load_dwordx4 a[56:59], v4, s[44:47], s69 offen offset:2048 sc1
v_mfma_f32_16x16x32_bf16 v[152:155], a[172:175], a[236:239], v[152:155]
s_nop 0
ds_read_b64_tr_b16 v[240:241], v8 offset:12288
ds_read_b64_tr_b16 v[242:243], v8 offset:14336
v_mfma_f32_16x16x32_bf16 v[152:155], a[176:179], a[232:235], v[152:155]
v_cvt_pk_bf16_f32 v144, v144, v145
v_cvt_pk_bf16_f32 v145, v146, v147
v_cvt_pk_bf16_f32 v146, v148, v149
v_mfma_f32_16x16x32_bf16 v[152:155], a[180:183], a[228:231], v[152:155]
s_nop 0
ds_read_b64_tr_b16 v[244:245], v9 offset:12288
ds_read_b64_tr_b16 v[246:247], v9 offset:14336
v_cvt_pk_bf16_f32 v147, v150, v151
v_mfma_f32_16x16x32_bf16 v[152:155], a[184:187], a[224:227], v[152:155]
v_permlane32_swap_b32 v144, v146
v_permlane32_swap_b32 v145, v147
v_mfma_f32_16x16x32_bf16 v[156:159], a[188:191], a[224:227], v[156:159]
s_nop 0
ds_read_b64_tr_b16 v[248:249], v10 offset:12288
ds_read_b64_tr_b16 v[250:251], v10 offset:14336
v_mfma_f32_16x16x32_bf16 v[156:159], a[184:187], a[228:231], v[156:159]
buffer_load_dwordx4 a[60:63], v4, s[44:47], s69 offen offset:3072 sc1
v_mfma_f32_16x16x32_bf16 v[156:159], a[180:183], a[232:235], v[156:159]
s_nop 0
ds_read_b64_tr_b16 v[252:253], v11 offset:12288
ds_read_b64_tr_b16 v[254:255], v11 offset:14336
v_mfma_f32_16x16x32_bf16 v[156:159], a[176:179], a[236:239], v[156:159]
buffer_store_dwordx4 v[144:147], v166, s[44:47], s80 offen offset:2048 sc1
v_mfma_f32_16x16x32_bf16 v[156:159], a[172:175], a[240:243], v[156:159]
v_mfma_f32_16x16x32_bf16 v[156:159], a[168:171], a[244:247], v[156:159]
v_mfma_f32_16x16x32_bf16 v[156:159], a[164:167], a[248:251], v[156:159]
v_mfma_f32_16x16x32_bf16 v[156:159], a[160:163], a[252:255], v[156:159]
v_cvt_pk_bf16_f32 v152, v152, v153
v_cvt_pk_bf16_f32 v153, v154, v155
s_nop 5
v_cvt_pk_bf16_f32 v154, v156, v157
v_cvt_pk_bf16_f32 v155, v158, v159
s_nop 0
v_permlane32_swap_b32 v152, v154
v_permlane32_swap_b32 v153, v155
buffer_store_dwordx4 v[152:155], v166, s[44:47], s80 offen offset:3072 sc1
s_waitcnt vmcnt(12) lgkmcnt(0)
s_cmp_lg_u32 s81, 0
s_cbranch_scc1 Lredo0
Lredo0b:
s_barrier
LEe:
v_mfma_f32_16x16x32_bf16 v[16:19], v[192:195], a[0:3], 0
s_nop 0
ds_read_b64_tr_b16 v[128:129], v8 offset:16384
ds_read_b64_tr_b16 v[130:131], v8 offset:18432
v_mfma_f32_16x16x32_bf16 v[16:19], v[208:211], a[4:7], v[16:19]
s_xor_b32 s71, s13, 0x100
ds_read_b64_tr_b16 v[132:133], v9 offset:16384
ds_read_b64_tr_b16 v[134:135], v9 offset:18432
v_mfma_f32_16x16x32_bf16 v[16:19], v[224:227], a[8:11], v[16:19]
s_add_u32 m0, s85, 0
ds_read_b64_tr_b16 v[136:137], v10 offset:16384
ds_read_b64_tr_b16 v[138:139], v10 offset:18432
v_mfma_f32_16x16x32_bf16 v[16:19], v[240:243], a[12:15], v[16:19]
s_add_u32 s72, s71, 0
buffer_load_dwordx4 v15, s[24:27], s72 offen lds
v_mfma_f32_16x16x32_bf16 v[32:35], v[240:243], a[28:31], 0
s_lshr_b32 s69, s14, 18
ds_read_b64_tr_b16 v[140:141], v11 offset:16384
ds_read_b64_tr_b16 v[142:143], v11 offset:18432
v_mfma_f32_16x16x32_bf16 v[32:35], v[224:227], a[24:27], v[32:35]
s_lshl_b32 s69, s69, 12
v_add_u32 v4, s64, v1
v_add_u32 v4, 131072, v4
v_mfma_f32_16x16x32_bf16 v[32:35], v[208:211], a[20:23], v[32:35]
s_add_u32 s69, s69, s95
buffer_load_dwordx4 a[64:67], v1, s[44:47], s69 offen sc1
v_mfma_f32_16x16x32_bf16 v[32:35], v[192:195], a[16:19], v[32:35]
s_lshl_b32 s70, s75, 18
ds_read_b64_tr_b16 v[144:145], v8 offset:20480
ds_read_b64_tr_b16 v[146:147], v8 offset:22528
v_mfma_f32_16x16x32_bf16 v[36:39], v[196:199], a[16:19], 0
s_add_u32 s72, s71, 15360
buffer_load_dwordx4 v15, s[24:27], s72 offen offset:1024 lds
v_mfma_f32_16x16x32_bf16 v[36:39], v[212:215], a[20:23], v[36:39]
s_add_u32 s70, s70, s94
ds_read_b64_tr_b16 v[148:149], v9 offset:20480
ds_read_b64_tr_b16 v[150:151], v9 offset:22528
v_mfma_f32_16x16x32_bf16 v[36:39], v[228:231], a[24:27], v[36:39]
s_nop 0
ds_read_b64_tr_b16 v[152:153], v10 offset:20480
ds_read_b64_tr_b16 v[154:155], v10 offset:22528
v_mfma_f32_16x16x32_bf16 v[36:39], v[244:247], a[28:31], v[36:39]
s_nop 0
ds_read_b64_tr_b16 v[156:157], v11 offset:20480
ds_read_b64_tr_b16 v[158:159], v11 offset:22528
v_mfma_f32_16x16x32_bf16 v[20:23], v[244:247], a[12:15], 0
ds_write_b128 v4, v[80:83] offset:0
v_mfma_f32_16x16x32_bf16 v[20:23], v[228:231], a[8:11], v[20:23]
s_nop 0
ds_read_b64_tr_b16 v[160:161], v8 offset:24576
ds_read_b64_tr_b16 v[162:163], v8 offset:26624
v_mfma_f32_16x16x32_bf16 v[20:23], v[212:215], a[4:7], v[20:23]
s_add_u32 s72, s71, 30720
buffer_load_dwordx4 v15, s[24:27], s72 offen offset:2048 lds
v_mfma_f32_16x16x32_bf16 v[20:23], v[196:199], a[0:3], v[20:23]
buffer_load_dwordx4 a[68:71], v1, s[44:47], s69 offen offset:1024 sc1
v_mfma_f32_16x16x32_bf16 v[24:27], v[200:203], a[0:3], 0
s_nop 0
ds_read_b64_tr_b16 v[164:165], v9 offset:24576
ds_read_b64_tr_b16 v[166:167], v9 offset:26624
v_mfma_f32_16x16x32_bf16 v[24:27], v[216:219], a[4:7], v[24:27]
s_nop 0
ds_read_b64_tr_b16 v[168:169], v10 offset:24576
ds_read_b64_tr_b16 v[170:171], v10 offset:26624
v_mfma_f32_16x16x32_bf16 v[24:27], v[232:235], a[8:11], v[24:27]
s_nop 0
ds_read_b64_tr_b16 v[172:173], v11 offset:24576
ds_read_b64_tr_b16 v[174:175], v11 offset:26624
v_mfma_f32_16x16x32_bf16 v[24:27], v[248:251], a[12:15], v[24:27]
ds_write_b128 v4, v[84:87] offset:1024
v_mfma_f32_16x16x32_bf16 v[40:43], v[248:251], a[28:31], 0
s_add_u32 s72, s71, 46080
buffer_load_dwordx4 v15, s[24:27], s72 offen offset:3072 lds
v_mfma_f32_16x16x32_bf16 v[40:43], v[232:235], a[24:27], v[40:43]
s_nop 0
ds_read_b64_tr_b16 v[176:177], v8 offset:28672
ds_read_b64_tr_b16 v[178:179], v8 offset:30720
v_mfma_f32_16x16x32_bf16 v[40:43], v[216:219], a[20:23], v[40:43]
s_nop 0
ds_read_b64_tr_b16 v[180:181], v9 offset:28672
ds_read_b64_tr_b16 v[182:183], v9 offset:30720
v_mfma_f32_16x16x32_bf16 v[40:43], v[200:203], a[16:19], v[40:43]
s_nop 0
ds_read_b64_tr_b16 v[184:185], v10 offset:28672
ds_read_b64_tr_b16 v[186:187], v10 offset:30720
v_mfma_f32_16x16x32_bf16 v[44:47], v[204:207], a[16:19], 0
s_nop 0
ds_read_b64_tr_b16 v[188:189], v11 offset:28672
ds_read_b64_tr_b16 v[190:191], v11 offset:30720
v_mfma_f32_16x16x32_bf16 v[44:47], v[220:223], a[20:23], v[44:47]
buffer_load_dwordx4 a[72:75], v1, s[44:47], s69 offen offset:2048 sc1
v_mfma_f32_16x16x32_bf16 v[44:47], v[236:239], a[24:27], v[44:47]
ds_write_b128 v4, v[96:99] offset:2048
v_mfma_f32_16x16x32_bf16 v[44:47], v[252:255], a[28:31], v[44:47]
s_xor_b32 s71, s13, 0x180
v_mfma_f32_16x16x32_bf16 v[28:31], v[252:255], a[12:15], 0
s_add_u32 m0, s85, 16384
ds_write_b128 v4, v[100:103] offset:3072
v_mfma_f32_16x16x32_bf16 v[28:31], v[236:239], a[8:11], v[28:31]
s_add_u32 s72, s71, 0
v_mfma_f32_16x16x32_bf16 v[28:31], v[220:223], a[4:7], v[28:31]
s_waitcnt vmcnt(31) lgkmcnt(0)
buffer_load_dwordx4 v15, s[24:27], s72 offen lds
v_mfma_f32_16x16x32_bf16 v[28:31], v[204:207], a[0:3], v[28:31]
s_barrier
v_mfma_f32_16x16x32_bf16 v[48:51], v[128:131], a[0:3], 0
s_nop 0
ds_read_b64_tr_b16 v[192:193], v8 offset:32768
ds_read_b64_tr_b16 v[194:195], v8 offset:34816
v_mfma_f32_16x16x32_bf16 v[48:51], v[144:147], a[4:7], v[48:51]
s_nop 0
ds_read_b64_tr_b16 v[196:197], v9 offset:32768
ds_read_b64_tr_b16 v[198:199], v9 offset:34816
v_mfma_f32_16x16x32_bf16 v[48:51], v[160:163], a[8:11], v[48:51]
s_nop 0
ds_read_b64_tr_b16 v[200:201], v10 offset:32768
ds_read_b64_tr_b16 v[202:203], v10 offset:34816
v_mfma_f32_16x16x32_bf16 v[48:51], v[176:179], a[12:15], v[48:51]
s_add_u32 s72, s71, 15360
buffer_load_dwordx4 v15, s[24:27], s72 offen offset:1024 lds
v_mfma_f32_16x16x32_bf16 v[64:67], v[176:179], a[28:31], 0
buffer_load_dwordx4 a[76:79], v1, s[44:47], s69 offen offset:3072 sc1
v_mfma_f32_16x16x32_bf16 v[64:67], v[160:163], a[24:27], v[64:67]
s_nop 0
ds_read_b64_tr_b16 v[204:205], v11 offset:32768
ds_read_b64_tr_b16 v[206:207], v11 offset:34816
v_mfma_f32_16x16x32_bf16 v[64:67], v[144:147], a[20:23], v[64:67]
v_mfma_f32_16x16x32_bf16 v[64:67], v[128:131], a[16:19], v[64:67]
s_nop 0
ds_read_b64_tr_b16 v[208:209], v8 offset:36864
ds_read_b64_tr_b16 v[210:211], v8 offset:38912
v_mfma_f32_16x16x32_bf16 v[68:71], v[132:135], a[16:19], 0
s_nop 0
ds_read_b64_tr_b16 v[212:213], v9 offset:36864
ds_read_b64_tr_b16 v[214:215], v9 offset:38912
v_mfma_f32_16x16x32_bf16 v[68:71], v[148:151], a[20:23], v[68:71]
s_add_u32 s72, s71, 30720
buffer_load_dwordx4 v15, s[24:27], s72 offen offset:2048 lds
v_mfma_f32_16x16x32_bf16 v[68:71], v[164:167], a[24:27], v[68:71]
s_nop 0
ds_read_b64_tr_b16 v[216:217], v10 offset:36864
ds_read_b64_tr_b16 v[218:219], v10 offset:38912
v_mfma_f32_16x16x32_bf16 v[68:71], v[180:183], a[28:31], v[68:71]
s_nop 0
ds_read_b64_tr_b16 v[220:221], v11 offset:36864
ds_read_b64_tr_b16 v[222:223], v11 offset:38912
v_mfma_f32_16x16x32_bf16 v[52:55], v[180:183], a[12:15], 0
v_mfma_f32_16x16x32_bf16 v[52:55], v[164:167], a[8:11], v[52:55]
s_add_u32 s69, s69, 0x20000
buffer_load_dwordx4 a[80:83], v1, s[44:47], s69 offen sc1
v_mfma_f32_16x16x32_bf16 v[52:55], v[148:151], a[4:7], v[52:55]
s_nop 0
ds_read_b64_tr_b16 v[224:225], v8 offset:40960
ds_read_b64_tr_b16 v[226:227], v8 offset:43008
v_mfma_f32_16x16x32_bf16 v[52:55], v[132:135], a[0:3], v[52:55]
s_add_u32 s72, s71, 46080
buffer_load_dwordx4 v15, s[24:27], s72 offen offset:3072 lds
v_mfma_f32_16x16x32_bf16 v[56:59], v[136:139], a[0:3], 0
s_nop 0
ds_read_b64_tr_b16 v[228:229], v9 offset:40960
ds_read_b64_tr_b16 v[230:231], v9 offset:43008
v_mfma_f32_16x16x32_bf16 v[56:59], v[152:155], a[4:7], v[56:59]
s_nop 0
ds_read_b64_tr_b16 v[232:233], v10 offset:40960
ds_read_b64_tr_b16 v[234:235], v10 offset:43008
v_mfma_f32_16x16x32_bf16 v[56:59], v[168:171], a[8:11], v[56:59]
s_nop 0
ds_read_b64_tr_b16 v[236:237], v11 offset:40960
ds_read_b64_tr_b16 v[238:239], v11 offset:43008
v_mfma_f32_16x16x32_bf16 v[56:59], v[184:187], a[12:15], v[56:59]
v_mfma_f32_16x16x32_bf16 v[72:75], v[184:187], a[28:31], 0
s_nop 0
ds_read_b64_tr_b16 v[240:241], v8 offset:45056
ds_read_b64_tr_b16 v[242:243], v8 offset:47104
v_mfma_f32_16x16x32_bf16 v[72:75], v[168:171], a[24:27], v[72:75]
s_nop 0
ds_read_b64_tr_b16 v[244:245], v9 offset:45056
ds_read_b64_tr_b16 v[246:247], v9 offset:47104
v_mfma_f32_16x16x32_bf16 v[72:75], v[152:155], a[20:23], v[72:75]
s_nop 0
ds_read_b64_tr_b16 v[248:249], v10 offset:45056
ds_read_b64_tr_b16 v[250:251], v10 offset:47104
v_mfma_f32_16x16x32_bf16 v[72:75], v[136:139], a[16:19], v[72:75]
s_xor_b32 s71, s14, 0x80
buffer_load_dwordx4 a[84:87], v1, s[44:47], s69 offen offset:1024 sc1
v_mfma_f32_16x16x32_bf16 v[76:79], v[140:143], a[16:19], 0
s_add_u32 m0, s85, 32768
ds_read_b64_tr_b16 v[252:253], v11 offset:45056
ds_read_b64_tr_b16 v[254:255], v11 offset:47104
v_mfma_f32_16x16x32_bf16 v[76:79], v[156:159], a[20:23], v[76:79]
s_add_u32 s72, s71, 0
buffer_load_dwordx4 v15, s[24:27], s72 offen lds
v_mfma_f32_16x16x32_bf16 v[76:79], v[172:175], a[24:27], v[76:79]
v_mfma_f32_16x16x32_bf16 v[76:79], v[188:191], a[28:31], v[76:79]
v_mfma_f32_16x16x32_bf16 v[60:63], v[188:191], a[12:15], 0
v_mfma_f32_16x16x32_bf16 v[60:63], v[172:175], a[8:11], v[60:63]
s_add_u32 s72, s71, 15360
v_mfma_f32_16x16x32_bf16 v[60:63], v[156:159], a[4:7], v[60:63]
s_waitcnt vmcnt(35) lgkmcnt(0)
v_mfma_f32_16x16x32_bf16 v[60:63], v[140:143], a[0:3], v[60:63]
s_barrier
buffer_load_dwordx4 v15, s[24:27], s72 offen offset:1024 lds
v_mfma_f32_16x16x32_bf16 v[80:83], v[192:195], a[0:3], 0
s_nop 0
ds_read_b64_tr_b16 v[128:129], v8 offset:49152
ds_read_b64_tr_b16 v[130:131], v8 offset:51200
v_mfma_f32_16x16x32_bf16 v[80:83], v[208:211], a[4:7], v[80:83]
buffer_load_dwordx4 a[88:91], v1, s[44:47], s69 offen offset:2048 sc1
v_mfma_f32_16x16x32_bf16 v[80:83], v[224:227], a[8:11], v[80:83]
s_nop 0
ds_read_b64_tr_b16 v[132:133], v9 offset:49152
ds_read_b64_tr_b16 v[134:135], v9 offset:51200
v_mfma_f32_16x16x32_bf16 v[80:83], v[240:243], a[12:15], v[80:83]
s_nop 0
ds_read_b64_tr_b16 v[136:137], v10 offset:49152
ds_read_b64_tr_b16 v[138:139], v10 offset:51200
v_mfma_f32_16x16x32_bf16 v[96:99], v[240:243], a[28:31], 0
s_nop 0
ds_read_b64_tr_b16 v[140:141], v11 offset:49152
ds_read_b64_tr_b16 v[142:143], v11 offset:51200
v_mfma_f32_16x16x32_bf16 v[96:99], v[224:227], a[24:27], v[96:99]
s_add_u32 s72, s71, 30720
buffer_load_dwordx4 v15, s[24:27], s72 offen offset:2048 lds
v_mfma_f32_16x16x32_bf16 v[96:99], v[208:211], a[20:23], v[96:99]
v_mfma_f32_16x16x32_bf16 v[96:99], v[192:195], a[16:19], v[96:99]
s_nop 0
ds_read_b64_tr_b16 v[144:145], v8 offset:53248
ds_read_b64_tr_b16 v[146:147], v8 offset:55296
v_mfma_f32_16x16x32_bf16 v[100:103], v[196:199], a[16:19], 0
s_nop 0
ds_read_b64_tr_b16 v[148:149], v9 offset:53248
ds_read_b64_tr_b16 v[150:151], v9 offset:55296
v_mfma_f32_16x16x32_bf16 v[100:103], v[212:215], a[20:23], v[100:103]
s_nop 0
ds_read_b64_tr_b16 v[152:153], v10 offset:53248
ds_read_b64_tr_b16 v[154:155], v10 offset:55296
v_mfma_f32_16x16x32_bf16 v[100:103], v[228:231], a[24:27], v[100:103]
s_nop 0
ds_read_b64_tr_b16 v[156:157], v11 offset:53248
ds_read_b64_tr_b16 v[158:159], v11 offset:55296
v_mfma_f32_16x16x32_bf16 v[100:103], v[244:247], a[28:31], v[100:103]
s_add_u32 s72, s71, 46080
buffer_load_dwordx4 v15, s[24:27], s72 offen offset:3072 lds
v_mfma_f32_16x16x32_bf16 v[84:87], v[244:247], a[12:15], 0
buffer_load_dwordx4 a[92:95], v1, s[44:47], s69 offen offset:3072 sc1
v_mfma_f32_16x16x32_bf16 v[84:87], v[228:231], a[8:11], v[84:87]
v_mfma_f32_16x16x32_bf16 v[84:87], v[212:215], a[4:7], v[84:87]
s_nop 0
ds_read_b64_tr_b16 v[160:161], v8 offset:57344
ds_read_b64_tr_b16 v[162:163], v8 offset:59392
v_mfma_f32_16x16x32_bf16 v[84:87], v[196:199], a[0:3], v[84:87]
s_nop 0
ds_read_b64_tr_b16 v[164:165], v9 offset:57344
ds_read_b64_tr_b16 v[166:167], v9 offset:59392
v_mfma_f32_16x16x32_bf16 v[88:91], v[200:203], a[0:3], 0
s_nop 0
ds_read_b64_tr_b16 v[168:169], v10 offset:57344
ds_read_b64_tr_b16 v[170:171], v10 offset:59392
v_mfma_f32_16x16x32_bf16 v[88:91], v[216:219], a[4:7], v[88:91]
s_xor_b32 s82, s78, 4
ds_read_b64_tr_b16 v[172:173], v11 offset:57344
ds_read_b64_tr_b16 v[174:175], v11 offset:59392
v_mfma_f32_16x16x32_bf16 v[88:91], v[232:235], a[8:11], v[88:91]
s_lshl_b32 s82, s82, 10
v_mfma_f32_16x16x32_bf16 v[88:91], v[248:251], a[12:15], v[88:91]
s_xor_b32 s71, s14, 0x100
ds_read_b64_tr_b16 v[176:177], v8 offset:61440
ds_read_b64_tr_b16 v[178:179], v8 offset:63488
v_mfma_f32_16x16x32_bf16 v[104:107], v[248:251], a[28:31], 0
s_add_u32 m0, s85, 49152
ds_read_b64_tr_b16 v[180:181], v9 offset:61440
ds_read_b64_tr_b16 v[182:183], v9 offset:63488
v_mfma_f32_16x16x32_bf16 v[104:107], v[232:235], a[24:27], v[104:107]
s_add_u32 s72, s71, 0
buffer_load_dwordx4 v15, s[24:27], s72 offen lds
v_mfma_f32_16x16x32_bf16 v[104:107], v[216:219], a[20:23], v[104:107]
s_add_u32 s82, s82, s74
buffer_load_dword v3, v2, s[44:47], s82 offen sc1
Lstube0:
s_cbranch_execz Lstube4
v_mfma_f32_16x16x32_bf16 v[104:107], v[200:203], a[16:19], v[104:107]
s_nop 0
ds_read_b64_tr_b16 v[184:185], v10 offset:61440
ds_read_b64_tr_b16 v[186:187], v10 offset:63488
v_mfma_f32_16x16x32_bf16 v[108:111], v[204:207], a[16:19], 0
s_nop 0
ds_read_b64_tr_b16 v[188:189], v11 offset:61440
ds_read_b64_tr_b16 v[190:191], v11 offset:63488
v_mfma_f32_16x16x32_bf16 v[108:111], v[220:223], a[20:23], v[108:111]
v_mfma_f32_16x16x32_bf16 v[108:111], v[236:239], a[24:27], v[108:111]
s_add_u32 s72, s71, 15360
buffer_load_dwordx4 v15, s[24:27], s72 offen offset:1024 lds
v_mfma_f32_16x16x32_bf16 v[108:111], v[252:255], a[28:31], v[108:111]
s_lshr_b32 s69, s15, 18
v_mfma_f32_16x16x32_bf16 v[92:95], v[252:255], a[12:15], 0
s_lshl_b32 s69, s69, 12
v_xor_b32 v8, 0x10000, v8
v_mfma_f32_16x16x32_bf16 v[92:95], v[236:239], a[8:11], v[92:95]
s_add_u32 s69, s69, s95
v_xor_b32 v9, 0x10000, v9
v_mfma_f32_16x16x32_bf16 v[92:95], v[220:223], a[4:7], v[92:95]
s_waitcnt vmcnt(17) lgkmcnt(0)
v_xor_b32 v10, 0x10000, v10
v_mfma_f32_16x16x32_bf16 v[92:95], v[204:207], a[0:3], v[92:95]
s_barrier
buffer_load_dwordx4 a[96:99], v1, s[44:47], s69 offen sc1
v_xor_b32 v11, 0x10000, v11
v_mfma_f32_16x16x32_bf16 v[16:19], v[128:131], a[32:35], v[16:19]
s_add_u32 s72, s71, 30720
buffer_load_dwordx4 v15, s[24:27], s72 offen offset:2048 lds
v_mfma_f32_16x16x32_bf16 v[16:19], v[144:147], a[36:39], v[16:19]
s_nop 0
ds_read_b64_tr_b16 v[192:193], v8 offset:0
ds_read_b64_tr_b16 v[194:195], v8 offset:2048
v_mfma_f32_16x16x32_bf16 v[16:19], v[160:163], a[40:43], v[16:19]
s_nop 0
ds_read_b64_tr_b16 v[196:197], v9 offset:0
ds_read_b64_tr_b16 v[198:199], v9 offset:2048
v_mfma_f32_16x16x32_bf16 v[16:19], v[176:179], a[44:47], v[16:19]
s_nop 0
ds_read_b64_tr_b16 v[200:201], v10 offset:0
ds_read_b64_tr_b16 v[202:203], v10 offset:2048
v_mfma_f32_16x16x32_bf16 v[32:35], v[176:179], a[60:63], v[32:35]
s_nop 0
ds_read_b64_tr_b16 v[204:205], v11 offset:0
ds_read_b64_tr_b16 v[206:207], v11 offset:2048
v_mfma_f32_16x16x32_bf16 v[32:35], v[160:163], a[56:59], v[32:35]
v_or_b32 v112, s58, v0
v_mov_b32 v113, 3
v_mfma_f32_16x16x32_bf16 v[32:35], v[144:147], a[52:55], v[32:35]
s_add_u32 s72, s71, 46080
buffer_load_dwordx4 v15, s[24:27], s72 offen offset:3072 lds
v_mfma_f32_16x16x32_bf16 v[32:35], v[128:131], a[48:51], v[32:35]
s_nop 0
ds_read_b64_tr_b16 v[208:209], v8 offset:4096
ds_read_b64_tr_b16 v[210:211], v8 offset:6144
v_mfma_f32_16x16x32_bf16 v[36:39], v[132:135], a[48:51], v[36:39]
s_nop 0
ds_read_b64_tr_b16 v[212:213], v9 offset:4096
ds_read_b64_tr_b16 v[214:215], v9 offset:6144
v_mfma_f32_16x16x32_bf16 v[36:39], v[148:151], a[52:55], v[36:39]
buffer_load_dwordx4 a[100:103], v1, s[44:47], s69 offen offset:1024 sc1
v_mfma_f32_16x16x32_bf16 v[36:39], v[164:167], a[56:59], v[36:39]
s_nop 0
ds_read_b64_tr_b16 v[216:217], v10 offset:4096
ds_read_b64_tr_b16 v[218:219], v10 offset:6144
v_mfma_f32_16x16x32_bf16 v[36:39], v[180:183], a[60:63], v[36:39]
v_min_u32 v112, 1, v112
v_lshlrev_b32 v112, 30, v112
v_mfma_f32_16x16x32_bf16 v[20:23], v[180:183], a[44:47], v[20:23]
s_nop 0
ds_read_b64_tr_b16 v[220:221], v11 offset:4096
ds_read_b64_tr_b16 v[222:223], v11 offset:6144
v_mfma_f32_16x16x32_bf16 v[20:23], v[164:167], a[40:43], v[20:23]
s_nop 0
ds_read_b64_tr_b16 v[224:225], v8 offset:8192
ds_read_b64_tr_b16 v[226:227], v8 offset:10240
v_mfma_f32_16x16x32_bf16 v[20:23], v[148:151], a[36:39], v[20:23]
s_xor_b32 s71, s14, 0x180
ds_read_b64_tr_b16 v[228:229], v9 offset:8192
ds_read_b64_tr_b16 v[230:231], v9 offset:10240
v_mfma_f32_16x16x32_bf16 v[20:23], v[132:135], a[32:35], v[20:23]
s_add_u32 m0, s77, 0
buffer_store_dword v113, v112, s[44:47], s91 offen sc1
v_mfma_f32_16x16x32_bf16 v[24:27], v[136:139], a[32:35], v[24:27]
s_add_u32 s72, s71, 0
buffer_load_dwordx4 v15, s[24:27], s72 offen lds
v_mfma_f32_16x16x32_bf16 v[24:27], v[152:155], a[36:39], v[24:27]
s_nop 0
ds_read_b64_tr_b16 v[232:233], v10 offset:8192
ds_read_b64_tr_b16 v[234:235], v10 offset:10240
v_mfma_f32_16x16x32_bf16 v[24:27], v[168:171], a[40:43], v[24:27]
s_nop 0
ds_read_b64_tr_b16 v[236:237], v11 offset:8192
ds_read_b64_tr_b16 v[238:239], v11 offset:10240
v_mfma_f32_16x16x32_bf16 v[24:27], v[184:187], a[44:47], v[24:27]
buffer_load_dwordx4 a[104:107], v1, s[44:47], s69 offen offset:2048 sc1
v_mfma_f32_16x16x32_bf16 v[40:43], v[184:187], a[60:63], v[40:43]
s_nop 0
ds_read_b64_tr_b16 v[240:241], v8 offset:12288
ds_read_b64_tr_b16 v[242:243], v8 offset:14336
v_mfma_f32_16x16x32_bf16 v[40:43], v[168:171], a[56:59], v[40:43]
v_mfma_f32_16x16x32_bf16 v[40:43], v[152:155], a[52:55], v[40:43]
s_add_u32 s72, s71, 15360
buffer_load_dwordx4 v15, s[24:27], s72 offen offset:1024 lds
v_mfma_f32_16x16x32_bf16 v[40:43], v[136:139], a[48:51], v[40:43]
s_nop 0
ds_read_b64_tr_b16 v[244:245], v9 offset:12288
ds_read_b64_tr_b16 v[246:247], v9 offset:14336
v_mfma_f32_16x16x32_bf16 v[44:47], v[140:143], a[48:51], v[44:47]
s_nop 0
ds_read_b64_tr_b16 v[248:249], v10 offset:12288
ds_read_b64_tr_b16 v[250:251], v10 offset:14336
v_mfma_f32_16x16x32_bf16 v[44:47], v[156:159], a[52:55], v[44:47]
s_nop 0
ds_read_b64_tr_b16 v[252:253], v11 offset:12288
ds_read_b64_tr_b16 v[254:255], v11 offset:14336
v_mfma_f32_16x16x32_bf16 v[44:47], v[172:175], a[56:59], v[44:47]
v_mfma_f32_16x16x32_bf16 v[44:47], v[188:191], a[60:63], v[44:47]
v_mfma_f32_16x16x32_bf16 v[28:31], v[188:191], a[44:47], v[28:31]
s_add_u32 s72, s71, 30720
buffer_load_dwordx4 v15, s[24:27], s72 offen offset:2048 lds
v_mfma_f32_16x16x32_bf16 v[28:31], v[172:175], a[40:43], v[28:31]
buffer_load_dwordx4 a[108:111], v1, s[44:47], s69 offen offset:3072 sc1
v_mfma_f32_16x16x32_bf16 v[28:31], v[156:159], a[36:39], v[28:31]
s_waitcnt vmcnt(20) lgkmcnt(0)
v_mfma_f32_16x16x32_bf16 v[28:31], v[140:143], a[32:35], v[28:31]
s_barrier
v_mfma_f32_16x16x32_bf16 v[48:51], v[192:195], a[32:35], v[48:51]
s_nop 0
ds_read_b64_tr_b16 v[128:129], v8 offset:16384
ds_read_b64_tr_b16 v[130:131], v8 offset:18432
v_mfma_f32_16x16x32_bf16 v[48:51], v[208:211], a[36:39], v[48:51]
s_nop 0
ds_read_b64_tr_b16 v[132:133], v9 offset:16384
ds_read_b64_tr_b16 v[134:135], v9 offset:18432
v_mfma_f32_16x16x32_bf16 v[48:51], v[224:227], a[40:43], v[48:51]
s_add_u32 s72, s71, 46080
buffer_load_dwordx4 v15, s[24:27], s72 offen offset:3072 lds
v_mfma_f32_16x16x32_bf16 v[48:51], v[240:243], a[44:47], v[48:51]
s_nop 0
ds_read_b64_tr_b16 v[136:137], v10 offset:16384
ds_read_b64_tr_b16 v[138:139], v10 offset:18432
v_mfma_f32_16x16x32_bf16 v[64:67], v[240:243], a[60:63], v[64:67]
s_nop 0
ds_read_b64_tr_b16 v[140:141], v11 offset:16384
ds_read_b64_tr_b16 v[142:143], v11 offset:18432
v_mfma_f32_16x16x32_bf16 v[64:67], v[224:227], a[56:59], v[64:67]
v_and_b32 v120, 15, v0
v_lshrrev_b32 v121, 4, v0
v_mfma_f32_16x16x32_bf16 v[64:67], v[208:211], a[52:55], v[64:67]
s_nop 0
ds_read_b64_tr_b16 v[144:145], v8 offset:20480
ds_read_b64_tr_b16 v[146:147], v8 offset:22528
v_mfma_f32_16x16x32_bf16 v[64:67], v[192:195], a[48:51], v[64:67]
s_add_u32 s69, s69, 0x20000
buffer_load_dwordx4 a[112:115], v1, s[44:47], s69 offen sc1
v_mfma_f32_16x16x32_bf16 v[68:71], v[196:199], a[48:51], v[68:71]
s_nop 0
ds_read_b64_tr_b16 v[148:149], v9 offset:20480
ds_read_b64_tr_b16 v[150:151], v9 offset:22528
v_mfma_f32_16x16x32_bf16 v[68:71], v[212:215], a[52:55], v[68:71]
s_nop 0
ds_read_b64_tr_b16 v[152:153], v10 offset:20480
ds_read_b64_tr_b16 v[154:155], v10 offset:22528
v_mfma_f32_16x16x32_bf16 v[68:71], v[228:231], a[56:59], v[68:71]
s_xor_b32 s71, s15, 0x80
v_lshlrev_b32 v121, 2, v121
v_sub_u32 v120, v120, v121
v_mfma_f32_16x16x32_bf16 v[68:71], v[244:247], a[60:63], v[68:71]
s_add_u32 m0, s77, 16384
ds_read_b64_tr_b16 v[156:157], v11 offset:20480
ds_read_b64_tr_b16 v[158:159], v11 offset:22528
v_mfma_f32_16x16x32_bf16 v[52:55], v[244:247], a[44:47], v[52:55]
s_add_u32 s72, s71, 0
buffer_load_dwordx4 v15, s[24:27], s72 offen lds
v_mfma_f32_16x16x32_bf16 v[52:55], v[228:231], a[40:43], v[52:55]
s_nop 0
ds_read_b64_tr_b16 v[160:161], v8 offset:24576
ds_read_b64_tr_b16 v[162:163], v8 offset:26624
v_mfma_f32_16x16x32_bf16 v[52:55], v[212:215], a[36:39], v[52:55]
s_nop 0
ds_read_b64_tr_b16 v[164:165], v9 offset:24576
ds_read_b64_tr_b16 v[166:167], v9 offset:26624
v_mfma_f32_16x16x32_bf16 v[52:55], v[196:199], a[32:35], v[52:55]
v_min_u32 v120, 4, v120
v_lshlrev_b32 v120, 3, v120
v_mfma_f32_16x16x32_bf16 v[56:59], v[200:203], a[32:35], v[56:59]
s_nop 0
ds_read_b64_tr_b16 v[168:169], v10 offset:24576
ds_read_b64_tr_b16 v[170:171], v10 offset:26624
v_mfma_f32_16x16x32_bf16 v[56:59], v[216:219], a[36:39], v[56:59]
s_add_u32 s72, s71, 15360
buffer_load_dwordx4 v15, s[24:27], s72 offen offset:1024 lds
v_mfma_f32_16x16x32_bf16 v[56:59], v[232:235], a[40:43], v[56:59]
buffer_load_dwordx4 a[116:119], v1, s[44:47], s69 offen offset:1024 sc1
v_mfma_f32_16x16x32_bf16 v[56:59], v[248:251], a[44:47], v[56:59]
s_nop 0
ds_read_b64_tr_b16 v[172:173], v11 offset:24576
ds_read_b64_tr_b16 v[174:175], v11 offset:26624
v_mfma_f32_16x16x32_bf16 v[72:75], v[248:251], a[60:63], v[72:75]
s_nop 0
ds_read_b64_tr_b16 v[176:177], v8 offset:28672
ds_read_b64_tr_b16 v[178:179], v8 offset:30720
v_mfma_f32_16x16x32_bf16 v[72:75], v[232:235], a[56:59], v[72:75]
v_mov_b32 v122, 0x3f80
v_mov_b32 v123, 0
v_mfma_f32_16x16x32_bf16 v[72:75], v[216:219], a[52:55], v[72:75]
s_nop 0
ds_read_b64_tr_b16 v[180:181], v9 offset:28672
ds_read_b64_tr_b16 v[182:183], v9 offset:30720
v_mfma_f32_16x16x32_bf16 v[72:75], v[200:203], a[48:51], v[72:75]
s_add_u32 s72, s71, 30720
buffer_load_dwordx4 v15, s[24:27], s72 offen offset:2048 lds
v_mfma_f32_16x16x32_bf16 v[76:79], v[204:207], a[48:51], v[76:79]
s_nop 0
ds_read_b64_tr_b16 v[184:185], v10 offset:28672
ds_read_b64_tr_b16 v[186:187], v10 offset:30720
v_mfma_f32_16x16x32_bf16 v[76:79], v[220:223], a[52:55], v[76:79]
s_nop 0
ds_read_b64_tr_b16 v[188:189], v11 offset:28672
ds_read_b64_tr_b16 v[190:191], v11 offset:30720
v_mfma_f32_16x16x32_bf16 v[76:79], v[236:239], a[56:59], v[76:79]
v_lshlrev_b64 v[122:123], v120, v[122:123]
v_mov_b32 v126, 0
v_mfma_f32_16x16x32_bf16 v[76:79], v[252:255], a[60:63], v[76:79]
buffer_load_dwordx4 a[120:123], v1, s[44:47], s69 offen offset:2048 sc1
v_mfma_f32_16x16x32_bf16 v[60:63], v[252:255], a[44:47], v[60:63]
v_lshlrev_b64 v[122:123], v120, v[122:123]
v_mov_b32 v127, 0
v_mfma_f32_16x16x32_bf16 v[60:63], v[236:239], a[40:43], v[60:63]
s_add_u32 s72, s71, 46080
buffer_load_dwordx4 v15, s[24:27], s72 offen offset:3072 lds
v_mfma_f32_16x16x32_bf16 v[60:63], v[220:223], a[36:39], v[60:63]
s_waitcnt vmcnt(22) lgkmcnt(0)
v_mov_b32 v120, 0
v_mov_b32 v121, 0
v_mfma_f32_16x16x32_bf16 v[60:63], v[204:207], a[32:35], v[60:63]
s_barrier
v_mov_b32 v124, v122
v_mov_b32 v125, v123
v_mfma_f32_16x16x32_bf16 v[80:83], v[128:131], a[32:35], v[80:83]
s_nop 0
ds_read_b64_tr_b16 v[192:193], v8 offset:32768
ds_read_b64_tr_b16 v[194:195], v8 offset:34816
v_mfma_f32_16x16x32_bf16 v[80:83], v[144:147], a[36:39], v[80:83]
s_nop 0
ds_read_b64_tr_b16 v[196:197], v9 offset:32768
ds_read_b64_tr_b16 v[198:199], v9 offset:34816
v_mfma_f32_16x16x32_bf16 v[80:83], v[160:163], a[40:43], v[80:83]
s_nop 0
ds_read_b64_tr_b16 v[200:201], v10 offset:32768
ds_read_b64_tr_b16 v[202:203], v10 offset:34816
v_mfma_f32_16x16x32_bf16 v[80:83], v[176:179], a[44:47], v[80:83]
s_nop 0
ds_read_b64_tr_b16 v[204:205], v11 offset:32768
ds_read_b64_tr_b16 v[206:207], v11 offset:34816
v_mfma_f32_16x16x32_bf16 v[96:99], v[176:179], a[60:63], v[96:99]
v_mfma_f32_16x16x32_bf16 v[96:99], v[160:163], a[56:59], v[96:99]
s_xor_b32 s71, s15, 0x100
buffer_load_dwordx4 a[124:127], v1, s[44:47], s69 offen offset:3072 sc1
v_mfma_f32_16x16x32_bf16 v[96:99], v[144:147], a[52:55], v[96:99]
s_add_u32 m0, s77, 32768
ds_read_b64_tr_b16 v[208:209], v8 offset:36864
ds_read_b64_tr_b16 v[210:211], v8 offset:38912
v_mfma_f32_16x16x32_bf16 v[96:99], v[128:131], a[48:51], v[96:99]
s_add_u32 s72, s71, 0
buffer_load_dwordx4 v15, s[24:27], s72 offen lds
v_mfma_f32_16x16x32_bf16 v[100:103], v[132:135], a[48:51], v[100:103]
s_nop 0
ds_read_b64_tr_b16 v[212:213], v9 offset:36864
ds_read_b64_tr_b16 v[214:215], v9 offset:38912
v_mfma_f32_16x16x32_bf16 v[100:103], v[148:151], a[52:55], v[100:103]
s_nop 0
ds_read_b64_tr_b16 v[216:217], v10 offset:36864
ds_read_b64_tr_b16 v[218:219], v10 offset:38912
v_mfma_f32_16x16x32_bf16 v[100:103], v[164:167], a[56:59], v[100:103]
s_nop 0
ds_read_b64_tr_b16 v[220:221], v11 offset:36864
ds_read_b64_tr_b16 v[222:223], v11 offset:38912
v_mfma_f32_16x16x32_bf16 v[100:103], v[180:183], a[60:63], v[100:103]
v_mfma_f32_16x16x32_bf16 v[84:87], v[180:183], a[44:47], v[84:87]
s_nop 0
ds_read_b64_tr_b16 v[224:225], v8 offset:40960
ds_read_b64_tr_b16 v[226:227], v8 offset:43008
v_mfma_f32_16x16x32_bf16 v[84:87], v[164:167], a[40:43], v[84:87]
s_add_u32 s72, s71, 15360
buffer_load_dwordx4 v15, s[24:27], s72 offen offset:1024 lds
v_mfma_f32_16x16x32_bf16 v[84:87], v[148:151], a[36:39], v[84:87]
s_nop 0
ds_read_b64_tr_b16 v[228:229], v9 offset:40960
ds_read_b64_tr_b16 v[230:231], v9 offset:43008
v_mfma_f32_16x16x32_bf16 v[84:87], v[132:135], a[32:35], v[84:87]
s_waitcnt vmcnt(22)
v_cmp_gt_u32 vcc, 2, v3
s_cbranch_vccnz Lspin106
Lback107:
s_lshr_b32 s69, s12, 18
s_lshl_b32 s69, s69, 12
s_add_u32 s69, s69, s95
s_xor_b32 s69, s69, 0x1000
buffer_load_dwordx4 a[128:131], v1, s[44:47], s69 offen sc1
v_mfma_f32_16x16x32_bf16 v[88:91], v[136:139], a[32:35], v[88:91]
s_nop 0
ds_read_b64_tr_b16 v[232:233], v10 offset:40960
ds_read_b64_tr_b16 v[234:235], v10 offset:43008
v_mfma_f32_16x16x32_bf16 v[88:91], v[152:155], a[36:39], v[88:91]
s_nop 0
ds_read_b64_tr_b16 v[236:237], v11 offset:40960
ds_read_b64_tr_b16 v[238:239], v11 offset:43008
v_mfma_f32_16x16x32_bf16 v[88:91], v[168:171], a[40:43], v[88:91]
v_mfma_f32_16x16x32_bf16 v[88:91], v[184:187], a[44:47], v[88:91]
s_add_u32 s72, s71, 30720
buffer_load_dwordx4 v15, s[24:27], s72 offen offset:2048 lds
v_mfma_f32_16x16x32_bf16 v[104:107], v[184:187], a[60:63], v[104:107]
s_nop 0
ds_read_b64_tr_b16 v[240:241], v8 offset:45056
ds_read_b64_tr_b16 v[242:243], v8 offset:47104
v_mfma_f32_16x16x32_bf16 v[104:107], v[168:171], a[56:59], v[104:107]
s_nop 0
ds_read_b64_tr_b16 v[244:245], v9 offset:45056
ds_read_b64_tr_b16 v[246:247], v9 offset:47104
v_mfma_f32_16x16x32_bf16 v[104:107], v[152:155], a[52:55], v[104:107]
s_nop 0
ds_read_b64_tr_b16 v[248:249], v10 offset:45056
ds_read_b64_tr_b16 v[250:251], v10 offset:47104
v_mfma_f32_16x16x32_bf16 v[104:107], v[136:139], a[48:51], v[104:107]
s_nop 0
ds_read_b64_tr_b16 v[252:253], v11 offset:45056
ds_read_b64_tr_b16 v[254:255], v11 offset:47104
v_mfma_f32_16x16x32_bf16 v[108:111], v[140:143], a[48:51], v[108:111]
v_mfma_f32_16x16x32_bf16 v[108:111], v[156:159], a[52:55], v[108:111]
s_add_u32 s72, s71, 46080
buffer_load_dwordx4 v15, s[24:27], s72 offen offset:3072 lds
v_mfma_f32_16x16x32_bf16 v[108:111], v[172:175], a[56:59], v[108:111]
buffer_load_dwordx4 a[132:135], v1, s[44:47], s69 offen offset:1024 sc1
v_mfma_f32_16x16x32_bf16 v[108:111], v[188:191], a[60:63], v[108:111]
v_mfma_f32_16x16x32_bf16 v[92:95], v[188:191], a[44:47], v[92:95]
v_mfma_f32_16x16x32_bf16 v[92:95], v[172:175], a[40:43], v[92:95]
v_mfma_f32_16x16x32_bf16 v[92:95], v[156:159], a[36:39], v[92:95]
s_waitcnt vmcnt(22) lgkmcnt(0)
v_mfma_f32_16x16x32_bf16 v[92:95], v[140:143], a[32:35], v[92:95]
s_barrier
v_mfma_f32_16x16x32_bf16 v[16:19], v[192:195], a[64:67], v[16:19]
s_nop 0
ds_read_b64_tr_b16 v[128:129], v8 offset:49152
ds_read_b64_tr_b16 v[130:131], v8 offset:51200
v_mfma_f32_16x16x32_bf16 v[16:19], v[208:211], a[68:71], v[16:19]
s_xor_b32 s71, s15, 0x180
ds_read_b64_tr_b16 v[132:133], v9 offset:49152
ds_read_b64_tr_b16 v[134:135], v9 offset:51200
v_mfma_f32_16x16x32_bf16 v[16:19], v[224:227], a[72:75], v[16:19]
s_add_u32 m0, s77, 49152
ds_read_b64_tr_b16 v[136:137], v10 offset:49152
ds_read_b64_tr_b16 v[138:139], v10 offset:51200
v_mfma_f32_16x16x32_bf16 v[16:19], v[240:243], a[76:79], v[16:19]
s_add_u32 s72, s71, 0
buffer_load_dwordx4 v15, s[24:27], s72 offen lds
v_mfma_f32_16x16x32_bf16 v[32:35], v[240:243], a[92:95], v[32:35]
buffer_load_dwordx4 a[136:139], v1, s[44:47], s69 offen offset:2048 sc1
v_mfma_f32_16x16x32_bf16 v[32:35], v[224:227], a[88:91], v[32:35]
s_nop 0
ds_read_b64_tr_b16 v[140:141], v11 offset:49152
ds_read_b64_tr_b16 v[142:143], v11 offset:51200
v_mfma_f32_16x16x32_bf16 v[32:35], v[208:211], a[84:87], v[32:35]
v_mfma_f32_16x16x32_bf16 v[32:35], v[192:195], a[80:83], v[32:35]
s_nop 0
ds_read_b64_tr_b16 v[144:145], v8 offset:53248
ds_read_b64_tr_b16 v[146:147], v8 offset:55296
v_mfma_f32_16x16x32_bf16 v[36:39], v[196:199], a[80:83], v[36:39]
s_add_u32 s72, s71, 15360
buffer_load_dwordx4 v15, s[24:27], s72 offen offset:1024 lds
v_mfma_f32_16x16x32_bf16 v[36:39], v[212:215], a[84:87], v[36:39]
s_nop 0
ds_read_b64_tr_b16 v[148:149], v9 offset:53248
ds_read_b64_tr_b16 v[150:151], v9 offset:55296
v_mfma_f32_16x16x32_bf16 v[36:39], v[228:231], a[88:91], v[36:39]
s_nop 0
ds_read_b64_tr_b16 v[152:153], v10 offset:53248
ds_read_b64_tr_b16 v[154:155], v10 offset:55296
v_mfma_f32_16x16x32_bf16 v[36:39], v[244:247], a[92:95], v[36:39]
s_nop 0
ds_read_b64_tr_b16 v[156:157], v11 offset:53248
ds_read_b64_tr_b16 v[158:159], v11 offset:55296
v_mfma_f32_16x16x32_bf16 v[20:23], v[244:247], a[76:79], v[20:23]
v_mfma_f32_16x16x32_bf16 v[20:23], v[228:231], a[72:75], v[20:23]
buffer_load_dwordx4 a[140:143], v1, s[44:47], s69 offen offset:3072 sc1
v_mfma_f32_16x16x32_bf16 v[20:23], v[212:215], a[68:71], v[20:23]
s_add_u32 s72, s71, 30720
buffer_load_dwordx4 v15, s[24:27], s72 offen offset:2048 lds
v_mfma_f32_16x16x32_bf16 v[20:23], v[196:199], a[64:67], v[20:23]
s_nop 0
ds_read_b64_tr_b16 v[160:161], v8 offset:57344
ds_read_b64_tr_b16 v[162:163], v8 offset:59392
v_mfma_f32_16x16x32_bf16 v[24:27], v[200:203], a[64:67], v[24:27]
s_nop 0
ds_read_b64_tr_b16 v[164:165], v9 offset:57344
ds_read_b64_tr_b16 v[166:167], v9 offset:59392
v_mfma_f32_16x16x32_bf16 v[24:27], v[216:219], a[68:71], v[24:27]
s_nop 0
ds_read_b64_tr_b16 v[168:169], v10 offset:57344
ds_read_b64_tr_b16 v[170:171], v10 offset:59392
v_mfma_f32_16x16x32_bf16 v[24:27], v[232:235], a[72:75], v[24:27]
s_nop 0
ds_read_b64_tr_b16 v[172:173], v11 offset:57344
ds_read_b64_tr_b16 v[174:175], v11 offset:59392
v_mfma_f32_16x16x32_bf16 v[24:27], v[248:251], a[76:79], v[24:27]
v_mfma_f32_16x16x32_bf16 v[40:43], v[248:251], a[92:95], v[40:43]
s_add_u32 s72, s71, 46080
buffer_load_dwordx4 v15, s[24:27], s72 offen offset:3072 lds
v_mfma_f32_16x16x32_bf16 v[40:43], v[232:235], a[88:91], v[40:43]
s_nop 0
ds_read_b64_tr_b16 v[176:177], v8 offset:61440
ds_read_b64_tr_b16 v[178:179], v8 offset:63488
v_mfma_f32_16x16x32_bf16 v[40:43], v[216:219], a[84:87], v[40:43]
s_nop 0
ds_read_b64_tr_b16 v[180:181], v9 offset:61440
ds_read_b64_tr_b16 v[182:183], v9 offset:63488
v_mfma_f32_16x16x32_bf16 v[40:43], v[200:203], a[80:83], v[40:43]
s_add_u32 s69, s69, 0x20000
buffer_load_dwordx4 a[144:147], v1, s[44:47], s69 offen sc1
v_mfma_f32_16x16x32_bf16 v[44:47], v[204:207], a[80:83], v[44:47]
s_nop 0
ds_read_b64_tr_b16 v[184:185], v10 offset:61440
ds_read_b64_tr_b16 v[186:187], v10 offset:63488
v_mfma_f32_16x16x32_bf16 v[44:47], v[220:223], a[84:87], v[44:47]
s_nop 0
ds_read_b64_tr_b16 v[188:189], v11 offset:61440
ds_read_b64_tr_b16 v[190:191], v11 offset:63488
v_mfma_f32_16x16x32_bf16 v[44:47], v[236:239], a[88:91], v[44:47]
v_mfma_f32_16x16x32_bf16 v[44:47], v[252:255], a[92:95], v[44:47]
s_xor_b32 s71, s12, 0x40080
v_mfma_f32_16x16x32_bf16 v[28:31], v[252:255], a[76:79], v[28:31]
s_add_u32 m0, s85, 0
v_xor_b32 v8, 0x10000, v8
v_mfma_f32_16x16x32_bf16 v[28:31], v[236:239], a[72:75], v[28:31]
s_add_u32 s72, s71, 0
v_xor_b32 v9, 0x10000, v9
v_mfma_f32_16x16x32_bf16 v[28:31], v[220:223], a[68:71], v[28:31]
s_waitcnt vmcnt(21) lgkmcnt(0)
buffer_load_dwordx4 v15, s[24:27], s72 offen lds
v_xor_b32 v10, 0x10000, v10
v_mfma_f32_16x16x32_bf16 v[28:31], v[204:207], a[64:67], v[28:31]
s_barrier
v_xor_b32 v11, 0x10000, v11
v_mfma_f32_16x16x32_bf16 v[48:51], v[128:131], a[64:67], v[48:51]
s_nop 0
ds_read_b64_tr_b16 v[192:193], v8 offset:0
ds_read_b64_tr_b16 v[194:195], v8 offset:2048
v_mfma_f32_16x16x32_bf16 v[48:51], v[144:147], a[68:71], v[48:51]
buffer_load_dwordx4 a[148:151], v1, s[44:47], s69 offen offset:1024 sc1
v_mfma_f32_16x16x32_bf16 v[48:51], v[160:163], a[72:75], v[48:51]
s_nop 0
ds_read_b64_tr_b16 v[196:197], v9 offset:0
ds_read_b64_tr_b16 v[198:199], v9 offset:2048
v_mfma_f32_16x16x32_bf16 v[48:51], v[176:179], a[76:79], v[48:51]
s_add_u32 s72, s71, 15360
buffer_load_dwordx4 v15, s[24:27], s72 offen offset:1024 lds
v_mfma_f32_16x16x32_bf16 v[64:67], v[176:179], a[92:95], v[64:67]
s_nop 0
ds_read_b64_tr_b16 v[200:201], v10 offset:0
ds_read_b64_tr_b16 v[202:203], v10 offset:2048
v_mfma_f32_16x16x32_bf16 v[64:67], v[160:163], a[88:91], v[64:67]
s_nop 0
ds_read_b64_tr_b16 v[204:205], v11 offset:0
ds_read_b64_tr_b16 v[206:207], v11 offset:2048
v_mfma_f32_16x16x32_bf16 v[64:67], v[144:147], a[84:87], v[64:67]
v_mfma_f32_16x16x32_bf16 v[64:67], v[128:131], a[80:83], v[64:67]
s_nop 0
ds_read_b64_tr_b16 v[208:209], v8 offset:4096
ds_read_b64_tr_b16 v[210:211], v8 offset:6144
v_mfma_f32_16x16x32_bf16 v[68:71], v[132:135], a[80:83], v[68:71]
s_nop 0
ds_read_b64_tr_b16 v[212:213], v9 offset:4096
ds_read_b64_tr_b16 v[214:215], v9 offset:6144
v_mfma_f32_16x16x32_bf16 v[68:71], v[148:151], a[84:87], v[68:71]
s_add_u32 s72, s71, 30720
buffer_load_dwordx4 v15, s[24:27], s72 offen offset:2048 lds
v_mfma_f32_16x16x32_bf16 v[68:71], v[164:167], a[88:91], v[68:71]
s_nop 0
ds_read_b64_tr_b16 v[216:217], v10 offset:4096
ds_read_b64_tr_b16 v[218:219], v10 offset:6144
v_mfma_f32_16x16x32_bf16 v[68:71], v[180:183], a[92:95], v[68:71]
buffer_load_dwordx4 a[152:155], v1, s[44:47], s69 offen offset:2048 sc1
v_mfma_f32_16x16x32_bf16 v[52:55], v[180:183], a[76:79], v[52:55]
s_nop 0
ds_read_b64_tr_b16 v[220:221], v11 offset:4096
ds_read_b64_tr_b16 v[222:223], v11 offset:6144
v_mfma_f32_16x16x32_bf16 v[52:55], v[164:167], a[72:75], v[52:55]
v_mfma_f32_16x16x32_bf16 v[52:55], v[148:151], a[68:71], v[52:55]
s_nop 0
ds_read_b64_tr_b16 v[224:225], v8 offset:8192
ds_read_b64_tr_b16 v[226:227], v8 offset:10240
v_mfma_f32_16x16x32_bf16 v[52:55], v[132:135], a[64:67], v[52:55]
s_add_u32 s72, s71, 46080
buffer_load_dwordx4 v15, s[24:27], s72 offen offset:3072 lds
v_mfma_f32_16x16x32_bf16 v[56:59], v[136:139], a[64:67], v[56:59]
s_nop 0
ds_read_b64_tr_b16 v[228:229], v9 offset:8192
ds_read_b64_tr_b16 v[230:231], v9 offset:10240
v_mfma_f32_16x16x32_bf16 v[56:59], v[152:155], a[68:71], v[56:59]
s_nop 0
ds_read_b64_tr_b16 v[232:233], v10 offset:8192
ds_read_b64_tr_b16 v[234:235], v10 offset:10240
v_mfma_f32_16x16x32_bf16 v[56:59], v[168:171], a[72:75], v[56:59]
s_nop 0
ds_read_b64_tr_b16 v[236:237], v11 offset:8192
ds_read_b64_tr_b16 v[238:239], v11 offset:10240
v_mfma_f32_16x16x32_bf16 v[56:59], v[184:187], a[76:79], v[56:59]
v_mfma_f32_16x16x32_bf16 v[72:75], v[184:187], a[92:95], v[72:75]
s_nop 0
ds_read_b64_tr_b16 v[240:241], v8 offset:12288
ds_read_b64_tr_b16 v[242:243], v8 offset:14336
v_mfma_f32_16x16x32_bf16 v[72:75], v[168:171], a[88:91], v[72:75]
buffer_load_dwordx4 a[156:159], v1, s[44:47], s69 offen offset:3072 sc1
v_mfma_f32_16x16x32_bf16 v[72:75], v[152:155], a[84:87], v[72:75]
s_lshr_b32 s69, s13, 18
ds_read_b64_tr_b16 v[244:245], v9 offset:12288
ds_read_b64_tr_b16 v[246:247], v9 offset:14336
v_mfma_f32_16x16x32_bf16 v[72:75], v[136:139], a[80:83], v[72:75]
s_xor_b32 s71, s12, 0x40100
ds_read_b64_tr_b16 v[248:249], v10 offset:12288
ds_read_b64_tr_b16 v[250:251], v10 offset:14336
v_mfma_f32_16x16x32_bf16 v[76:79], v[140:143], a[80:83], v[76:79]
s_add_u32 m0, s85, 16384
ds_read_b64_tr_b16 v[252:253], v11 offset:12288
ds_read_b64_tr_b16 v[254:255], v11 offset:14336
v_mfma_f32_16x16x32_bf16 v[76:79], v[156:159], a[84:87], v[76:79]
s_add_u32 s72, s71, 0
buffer_load_dwordx4 v15, s[24:27], s72 offen lds
v_mfma_f32_16x16x32_bf16 v[76:79], v[172:175], a[88:91], v[76:79]
s_lshl_b32 s69, s69, 12
v_mfma_f32_16x16x32_bf16 v[76:79], v[188:191], a[92:95], v[76:79]
s_add_u32 s69, s69, s95
v_mfma_f32_16x16x32_bf16 v[60:63], v[188:191], a[76:79], v[60:63]
s_xor_b32 s69, s69, 0x1000
v_mfma_f32_16x16x32_bf16 v[60:63], v[172:175], a[72:75], v[60:63]
s_add_u32 s72, s71, 15360
v_mfma_f32_16x16x32_bf16 v[60:63], v[156:159], a[68:71], v[60:63]
s_waitcnt vmcnt(16) lgkmcnt(0)
buffer_load_dwordx4 a[160:163], v1, s[44:47], s69 offen sc1
v_mfma_f32_16x16x32_bf16 v[60:63], v[140:143], a[64:67], v[60:63]
s_barrier
buffer_load_dwordx4 v15, s[24:27], s72 offen offset:1024 lds
v_mfma_f32_16x16x32_bf16 v[80:83], v[192:195], a[64:67], v[80:83]
s_and_b32 s79, s91, 0xffff9fff
v_lshrrev_b32 v13, 4, v0
v_lshlrev_b32 v13, 13, v13
buffer_load_dword v14, v13, s[44:47], s79 offen sc1
v_mfma_f32_16x16x32_bf16 v[80:83], v[208:211], a[68:71], v[80:83]
s_nop 0
ds_read_b64_tr_b16 v[128:129], v8 offset:16384
ds_read_b64_tr_b16 v[130:131], v8 offset:18432
v_mfma_f32_16x16x32_bf16 v[80:83], v[224:227], a[72:75], v[80:83]
s_nop 0
ds_read_b64_tr_b16 v[132:133], v9 offset:16384
ds_read_b64_tr_b16 v[134:135], v9 offset:18432
v_mfma_f32_16x16x32_bf16 v[80:83], v[240:243], a[76:79], v[80:83]
s_nop 0
ds_read_b64_tr_b16 v[136:137], v10 offset:16384
ds_read_b64_tr_b16 v[138:139], v10 offset:18432
v_mfma_f32_16x16x32_bf16 v[96:99], v[240:243], a[92:95], v[96:99]
s_nop 0
ds_read_b64_tr_b16 v[140:141], v11 offset:16384
ds_read_b64_tr_b16 v[142:143], v11 offset:18432
v_mfma_f32_16x16x32_bf16 v[96:99], v[224:227], a[88:91], v[96:99]
s_add_u32 s72, s71, 30720
buffer_load_dwordx4 v15, s[24:27], s72 offen offset:2048 lds
v_mfma_f32_16x16x32_bf16 v[96:99], v[208:211], a[84:87], v[96:99]
v_mfma_f32_16x16x32_bf16 v[96:99], v[192:195], a[80:83], v[96:99]
s_nop 0
ds_read_b64_tr_b16 v[144:145], v8 offset:20480
ds_read_b64_tr_b16 v[146:147], v8 offset:22528
v_mfma_f32_16x16x32_bf16 v[100:103], v[196:199], a[80:83], v[100:103]
Lstube1:
s_cbranch_execz Lstube5
buffer_load_dwordx4 a[164:167], v1, s[44:47], s69 offen offset:1024 sc1
v_mfma_f32_16x16x32_bf16 v[100:103], v[212:215], a[84:87], v[100:103]
s_nop 0
ds_read_b64_tr_b16 v[148:149], v9 offset:20480
ds_read_b64_tr_b16 v[150:151], v9 offset:22528
v_mfma_f32_16x16x32_bf16 v[100:103], v[228:231], a[88:91], v[100:103]
s_nop 0
ds_read_b64_tr_b16 v[152:153], v10 offset:20480
ds_read_b64_tr_b16 v[154:155], v10 offset:22528
v_mfma_f32_16x16x32_bf16 v[100:103], v[244:247], a[92:95], v[100:103]
s_add_u32 s72, s71, 46080
buffer_load_dwordx4 v15, s[24:27], s72 offen offset:3072 lds
v_mfma_f32_16x16x32_bf16 v[84:87], v[244:247], a[76:79], v[84:87]
s_nop 0
ds_read_b64_tr_b16 v[156:157], v11 offset:20480
ds_read_b64_tr_b16 v[158:159], v11 offset:22528
v_mfma_f32_16x16x32_bf16 v[84:87], v[228:231], a[72:75], v[84:87]
v_mfma_f32_16x16x32_bf16 v[84:87], v[212:215], a[68:71], v[84:87]
s_nop 0
ds_read_b64_tr_b16 v[160:161], v8 offset:24576
ds_read_b64_tr_b16 v[162:163], v8 offset:26624
v_mfma_f32_16x16x32_bf16 v[84:87], v[196:199], a[64:67], v[84:87]
s_nop 0
ds_read_b64_tr_b16 v[164:165], v9 offset:24576
ds_read_b64_tr_b16 v[166:167], v9 offset:26624
v_mfma_f32_16x16x32_bf16 v[88:91], v[200:203], a[64:67], v[88:91]
s_nop 0
ds_read_b64_tr_b16 v[168:169], v10 offset:24576
ds_read_b64_tr_b16 v[170:171], v10 offset:26624
v_mfma_f32_16x16x32_bf16 v[88:91], v[216:219], a[68:71], v[88:91]
s_nop 0
ds_read_b64_tr_b16 v[172:173], v11 offset:24576
ds_read_b64_tr_b16 v[174:175], v11 offset:26624
v_mfma_f32_16x16x32_bf16 v[88:91], v[232:235], a[72:75], v[88:91]
buffer_load_dwordx4 a[168:171], v1, s[44:47], s69 offen offset:2048 sc1
v_mfma_f32_16x16x32_bf16 v[88:91], v[248:251], a[76:79], v[88:91]
s_xor_b32 s71, s12, 0x40180
v_mfma_f32_16x16x32_bf16 v[104:107], v[248:251], a[92:95], v[104:107]
s_add_u32 m0, s85, 32768
ds_read_b64_tr_b16 v[176:177], v8 offset:28672
ds_read_b64_tr_b16 v[178:179], v8 offset:30720
v_mfma_f32_16x16x32_bf16 v[104:107], v[232:235], a[88:91], v[104:107]
s_add_u32 s72, s71, 0
buffer_load_dwordx4 v15, s[24:27], s72 offen lds
v_mfma_f32_16x16x32_bf16 v[104:107], v[216:219], a[84:87], v[104:107]
s_nop 0
ds_read_b64_tr_b16 v[180:181], v9 offset:28672
ds_read_b64_tr_b16 v[182:183], v9 offset:30720
v_mfma_f32_16x16x32_bf16 v[104:107], v[200:203], a[80:83], v[104:107]
s_nop 0
ds_read_b64_tr_b16 v[184:185], v10 offset:28672
ds_read_b64_tr_b16 v[186:187], v10 offset:30720
v_mfma_f32_16x16x32_bf16 v[108:111], v[204:207], a[80:83], v[108:111]
s_nop 0
ds_read_b64_tr_b16 v[188:189], v11 offset:28672
ds_read_b64_tr_b16 v[190:191], v11 offset:30720
v_mfma_f32_16x16x32_bf16 v[108:111], v[220:223], a[84:87], v[108:111]
v_mfma_f32_16x16x32_bf16 v[108:111], v[236:239], a[88:91], v[108:111]
s_add_u32 s72, s71, 15360
buffer_load_dwordx4 v15, s[24:27], s72 offen offset:1024 lds
v_mfma_f32_16x16x32_bf16 v[108:111], v[252:255], a[92:95], v[108:111]
v_mfma_f32_16x16x32_bf16 v[92:95], v[252:255], a[76:79], v[92:95]
buffer_load_dwordx4 a[172:175], v1, s[44:47], s69 offen offset:3072 sc1
v_mfma_f32_16x16x32_bf16 v[92:95], v[236:239], a[72:75], v[92:95]
v_mfma_f32_16x16x32_bf16 v[92:95], v[220:223], a[68:71], v[92:95]
s_waitcnt vmcnt(31) lgkmcnt(0)
v_mfma_f32_16x16x32_bf16 v[92:95], v[204:207], a[64:67], v[92:95]
v_mfma_f32_16x16x32_bf16 v[16:19], v[128:131], a[96:99], v[16:19]
s_add_u32 s72, s71, 30720
buffer_load_dwordx4 v15, s[24:27], s72 offen offset:2048 lds
v_mfma_f32_16x16x32_bf16 v[16:19], v[144:147], a[100:103], v[16:19]
s_nop 0
ds_read_b64_tr_b16 v[192:193], v8 offset:32768
ds_read_b64_tr_b16 v[194:195], v8 offset:34816
v_mfma_f32_16x16x32_bf16 v[16:19], v[160:163], a[104:107], v[16:19]
s_nop 0
ds_read_b64_tr_b16 v[196:197], v9 offset:32768
ds_read_b64_tr_b16 v[198:199], v9 offset:34816
v_mfma_f32_16x16x32_bf16 v[16:19], v[176:179], a[108:111], v[16:19]
s_nop 0
ds_read_b64_tr_b16 v[200:201], v10 offset:32768
ds_read_b64_tr_b16 v[202:203], v10 offset:34816
v_mfma_f32_16x16x32_bf16 v[32:35], v[176:179], a[124:127], v[32:35]
s_nop 0
ds_read_b64_tr_b16 v[204:205], v11 offset:32768
ds_read_b64_tr_b16 v[206:207], v11 offset:34816
v_mfma_f32_16x16x32_bf16 v[32:35], v[160:163], a[120:123], v[32:35]
v_mfma_f32_16x16x32_bf16 v[32:35], v[144:147], a[116:119], v[32:35]
s_add_u32 s72, s71, 46080
buffer_load_dwordx4 v15, s[24:27], s72 offen offset:3072 lds
v_mfma_f32_16x16x32_bf16 v[32:35], v[128:131], a[112:115], v[32:35]
s_add_u32 s69, s69, 0x20000
buffer_load_dwordx4 a[176:179], v1, s[44:47], s69 offen sc1
v_mfma_f32_16x16x32_bf16 v[36:39], v[132:135], a[112:115], v[36:39]
s_nop 0
ds_read_b64_tr_b16 v[208:209], v8 offset:36864
ds_read_b64_tr_b16 v[210:211], v8 offset:38912
v_mfma_f32_16x16x32_bf16 v[36:39], v[148:151], a[116:119], v[36:39]
s_nop 0
ds_read_b64_tr_b16 v[212:213], v9 offset:36864
ds_read_b64_tr_b16 v[214:215], v9 offset:38912
v_mfma_f32_16x16x32_bf16 v[36:39], v[164:167], a[120:123], v[36:39]
s_nop 0
ds_read_b64_tr_b16 v[216:217], v10 offset:36864
ds_read_b64_tr_b16 v[218:219], v10 offset:38912
v_mfma_f32_16x16x32_bf16 v[36:39], v[180:183], a[124:127], v[36:39]
s_nop 0
ds_read_b64_tr_b16 v[220:221], v11 offset:36864
ds_read_b64_tr_b16 v[222:223], v11 offset:38912
v_mfma_f32_16x16x32_bf16 v[20:23], v[180:183], a[108:111], v[20:23]
v_mfma_f32_16x16x32_bf16 v[20:23], v[164:167], a[104:107], v[20:23]
s_nop 0
ds_read_b64_tr_b16 v[224:225], v8 offset:40960
ds_read_b64_tr_b16 v[226:227], v8 offset:43008
v_mfma_f32_16x16x32_bf16 v[20:23], v[148:151], a[100:103], v[20:23]
s_xor_b32 s71, s13, 0x40080
ds_read_b64_tr_b16 v[228:229], v9 offset:40960
ds_read_b64_tr_b16 v[230:231], v9 offset:43008
v_mfma_f32_16x16x32_bf16 v[20:23], v[132:135], a[96:99], v[20:23]
s_add_u32 m0, s85, 49152
ds_read_b64_tr_b16 v[232:233], v10 offset:40960
ds_read_b64_tr_b16 v[234:235], v10 offset:43008
v_mfma_f32_16x16x32_bf16 v[24:27], v[136:139], a[96:99], v[24:27]
s_add_u32 s72, s71, 0
buffer_load_dwordx4 v15, s[24:27], s72 offen lds
v_mfma_f32_16x16x32_bf16 v[24:27], v[152:155], a[100:103], v[24:27]
buffer_load_dwordx4 a[180:183], v1, s[44:47], s69 offen offset:1024 sc1
v_mfma_f32_16x16x32_bf16 v[24:27], v[168:171], a[104:107], v[24:27]
s_nop 0
ds_read_b64_tr_b16 v[236:237], v11 offset:40960
ds_read_b64_tr_b16 v[238:239], v11 offset:43008
v_mfma_f32_16x16x32_bf16 v[24:27], v[184:187], a[108:111], v[24:27]
v_mfma_f32_16x16x32_bf16 v[40:43], v[184:187], a[124:127], v[40:43]
s_nop 0
ds_read_b64_tr_b16 v[240:241], v8 offset:45056
ds_read_b64_tr_b16 v[242:243], v8 offset:47104
v_mfma_f32_16x16x32_bf16 v[40:43], v[168:171], a[120:123], v[40:43]
s_nop 0
ds_read_b64_tr_b16 v[244:245], v9 offset:45056
ds_read_b64_tr_b16 v[246:247], v9 offset:47104
v_mfma_f32_16x16x32_bf16 v[40:43], v[152:155], a[116:119], v[40:43]
s_add_u32 s72, s71, 15360
buffer_load_dwordx4 v15, s[24:27], s72 offen offset:1024 lds
v_mfma_f32_16x16x32_bf16 v[40:43], v[136:139], a[112:115], v[40:43]
s_nop 0
ds_read_b64_tr_b16 v[248:249], v10 offset:45056
ds_read_b64_tr_b16 v[250:251], v10 offset:47104
v_mfma_f32_16x16x32_bf16 v[44:47], v[140:143], a[112:115], v[44:47]
s_nop 0
ds_read_b64_tr_b16 v[252:253], v11 offset:45056
ds_read_b64_tr_b16 v[254:255], v11 offset:47104
v_mfma_f32_16x16x32_bf16 v[44:47], v[156:159], a[116:119], v[44:47]
v_mfma_f32_16x16x32_bf16 v[44:47], v[172:175], a[120:123], v[44:47]
buffer_load_dwordx4 a[184:187], v1, s[44:47], s69 offen offset:2048 sc1
v_mfma_f32_16x16x32_bf16 v[44:47], v[188:191], a[124:127], v[44:47]
v_mfma_f32_16x16x32_bf16 v[28:31], v[188:191], a[108:111], v[28:31]
s_add_u32 s72, s71, 30720
buffer_load_dwordx4 v15, s[24:27], s72 offen offset:2048 lds
v_mfma_f32_16x16x32_bf16 v[28:31], v[172:175], a[104:107], v[28:31]
v_mfma_f32_16x16x32_bf16 v[28:31], v[156:159], a[100:103], v[28:31]
s_waitcnt vmcnt(20) lgkmcnt(0)
v_mfma_f32_16x16x32_bf16 v[28:31], v[140:143], a[96:99], v[28:31]
s_barrier
v_mfma_f32_16x16x32_bf16 v[48:51], v[192:195], a[96:99], v[48:51]
s_nop 0
ds_read_b64_tr_b16 v[128:129], v8 offset:49152
ds_read_b64_tr_b16 v[130:131], v8 offset:51200
v_mfma_f32_16x16x32_bf16 v[48:51], v[208:211], a[100:103], v[48:51]
s_nop 0
ds_read_b64_tr_b16 v[132:133], v9 offset:49152
ds_read_b64_tr_b16 v[134:135], v9 offset:51200
v_mfma_f32_16x16x32_bf16 v[48:51], v[224:227], a[104:107], v[48:51]
s_add_u32 s72, s71, 46080
buffer_load_dwordx4 v15, s[24:27], s72 offen offset:3072 lds
v_mfma_f32_16x16x32_bf16 v[48:51], v[240:243], a[108:111], v[48:51]
s_nop 0
ds_read_b64_tr_b16 v[136:137], v10 offset:49152
ds_read_b64_tr_b16 v[138:139], v10 offset:51200
v_mfma_f32_16x16x32_bf16 v[64:67], v[240:243], a[124:127], v[64:67]
buffer_load_dwordx4 a[188:191], v1, s[44:47], s69 offen offset:3072 sc1
v_mfma_f32_16x16x32_bf16 v[64:67], v[224:227], a[120:123], v[64:67]
s_nop 0
ds_read_b64_tr_b16 v[140:141], v11 offset:49152
ds_read_b64_tr_b16 v[142:143], v11 offset:51200
v_mfma_f32_16x16x32_bf16 v[64:67], v[208:211], a[116:119], v[64:67]
s_nop 0
ds_read_b64_tr_b16 v[144:145], v8 offset:53248
ds_read_b64_tr_b16 v[146:147], v8 offset:55296
v_mfma_f32_16x16x32_bf16 v[64:67], v[192:195], a[112:115], v[64:67]
s_nop 0
ds_read_b64_tr_b16 v[148:149], v9 offset:53248
ds_read_b64_tr_b16 v[150:151], v9 offset:55296
v_mfma_f32_16x16x32_bf16 v[68:71], v[196:199], a[112:115], v[68:71]
s_lshr_b32 s69, s14, 18
v_mfma_f32_16x16x32_bf16 v[68:71], v[212:215], a[116:119], v[68:71]
s_lshl_b32 s69, s69, 12
ds_read_b64_tr_b16 v[152:153], v10 offset:53248
ds_read_b64_tr_b16 v[154:155], v10 offset:55296
v_mfma_f32_16x16x32_bf16 v[68:71], v[228:231], a[120:123], v[68:71]
s_xor_b32 s71, s14, 0x40080
ds_read_b64_tr_b16 v[156:157], v11 offset:53248
ds_read_b64_tr_b16 v[158:159], v11 offset:55296
v_mfma_f32_16x16x32_bf16 v[68:71], v[244:247], a[124:127], v[68:71]
s_add_u32 m0, s77, 0
ds_read_b64_tr_b16 v[160:161], v8 offset:57344
ds_read_b64_tr_b16 v[162:163], v8 offset:59392
v_mfma_f32_16x16x32_bf16 v[52:55], v[244:247], a[108:111], v[52:55]
s_add_u32 s72, s71, 0
buffer_load_dwordx4 v15, s[24:27], s72 offen lds
v_mfma_f32_16x16x32_bf16 v[52:55], v[228:231], a[104:107], v[52:55]
s_add_u32 s69, s69, s95
ds_read_b64_tr_b16 v[164:165], v9 offset:57344
ds_read_b64_tr_b16 v[166:167], v9 offset:59392
v_mfma_f32_16x16x32_bf16 v[52:55], v[212:215], a[100:103], v[52:55]
s_xor_b32 s69, s69, 0x1000
buffer_load_dwordx4 a[192:195], v1, s[44:47], s69 offen sc1
v_mfma_f32_16x16x32_bf16 v[52:55], v[196:199], a[96:99], v[52:55]
s_nop 0
ds_read_b64_tr_b16 v[168:169], v10 offset:57344
ds_read_b64_tr_b16 v[170:171], v10 offset:59392
v_mfma_f32_16x16x32_bf16 v[56:59], v[200:203], a[96:99], v[56:59]
s_waitcnt vmcnt(19)
v_cmp_gt_u32 vcc, 2, v14
s_cbranch_vccnz Lspin112
Lback113:
v_mfma_f32_16x16x32_bf16 v[56:59], v[216:219], a[100:103], v[56:59]
s_add_u32 s72, s71, 15360
buffer_load_dwordx4 v15, s[24:27], s72 offen offset:1024 lds
v_mfma_f32_16x16x32_bf16 v[56:59], v[232:235], a[104:107], v[56:59]
v_mfma_f32_16x16x32_bf16 v[56:59], v[248:251], a[108:111], v[56:59]
s_nop 0
ds_read_b64_tr_b16 v[172:173], v11 offset:57344
ds_read_b64_tr_b16 v[174:175], v11 offset:59392
v_mfma_f32_16x16x32_bf16 v[72:75], v[248:251], a[124:127], v[72:75]
s_nop 0
ds_read_b64_tr_b16 v[176:177], v8 offset:61440
ds_read_b64_tr_b16 v[178:179], v8 offset:63488
v_mfma_f32_16x16x32_bf16 v[72:75], v[232:235], a[120:123], v[72:75]
s_nop 0
ds_read_b64_tr_b16 v[180:181], v9 offset:61440
ds_read_b64_tr_b16 v[182:183], v9 offset:63488
v_mfma_f32_16x16x32_bf16 v[72:75], v[216:219], a[116:119], v[72:75]
s_nop 0
ds_read_b64_tr_b16 v[184:185], v10 offset:61440
ds_read_b64_tr_b16 v[186:187], v10 offset:63488
v_mfma_f32_16x16x32_bf16 v[72:75], v[200:203], a[112:115], v[72:75]
s_add_u32 s72, s71, 30720
buffer_load_dwordx4 v15, s[24:27], s72 offen offset:2048 lds
v_mfma_f32_16x16x32_bf16 v[76:79], v[204:207], a[112:115], v[76:79]
buffer_load_dwordx4 a[196:199], v1, s[44:47], s69 offen offset:1024 sc1
v_mfma_f32_16x16x32_bf16 v[76:79], v[220:223], a[116:119], v[76:79]
s_nop 0
ds_read_b64_tr_b16 v[188:189], v11 offset:61440
ds_read_b64_tr_b16 v[190:191], v11 offset:63488
v_mfma_f32_16x16x32_bf16 v[76:79], v[236:239], a[120:123], v[76:79]
v_mfma_f32_16x16x32_bf16 v[76:79], v[252:255], a[124:127], v[76:79]
v_mfma_f32_16x16x32_bf16 v[60:63], v[252:255], a[108:111], v[60:63]
v_xor_b32 v8, 0x10000, v8
v_mfma_f32_16x16x32_bf16 v[60:63], v[236:239], a[104:107], v[60:63]
s_add_u32 s72, s71, 46080
buffer_load_dwordx4 v15, s[24:27], s72 offen offset:3072 lds
v_xor_b32 v9, 0x10000, v9
v_mfma_f32_16x16x32_bf16 v[60:63], v[220:223], a[100:103], v[60:63]
s_waitcnt lgkmcnt(0)
v_xor_b32 v10, 0x10000, v10
v_mfma_f32_16x16x32_bf16 v[60:63], v[204:207], a[96:99], v[60:63]
v_xor_b32 v11, 0x10000, v11
v_mfma_f32_16x16x32_bf16 v[80:83], v[128:131], a[96:99], v[80:83]
s_lshl_b32 s84, s76, 11
ds_read_b64_tr_b16 v[192:193], v8 offset:0
ds_read_b64_tr_b16 v[194:195], v8 offset:2048
v_mfma_f32_16x16x32_bf16 v[80:83], v[144:147], a[100:103], v[80:83]
s_add_u32 s84, s84, 0x3810000
ds_read_b64_tr_b16 v[196:197], v9 offset:0
ds_read_b64_tr_b16 v[198:199], v9 offset:2048
v_mfma_f32_16x16x32_bf16 v[80:83], v[160:163], a[104:107], v[80:83]
buffer_load_dwordx4 a[200:203], v1, s[44:47], s69 offen offset:2048 sc1
v_mfma_f32_16x16x32_bf16 v[80:83], v[176:179], a[108:111], v[80:83]
s_nop 0
ds_read_b64_tr_b16 v[200:201], v10 offset:0
ds_read_b64_tr_b16 v[202:203], v10 offset:2048
v_mfma_f32_16x16x32_bf16 v[96:99], v[176:179], a[124:127], v[96:99]
s_nop 0
ds_read_b64_tr_b16 v[204:205], v11 offset:0
ds_read_b64_tr_b16 v[206:207], v11 offset:2048
v_mfma_f32_16x16x32_bf16 v[96:99], v[160:163], a[120:123], v[96:99]
s_xor_b32 s71, s15, 0x40080
v_lshrrev_b32 v115, 2, v0
v_lshlrev_b32 v115, 7, v115
v_mfma_f32_16x16x32_bf16 v[96:99], v[144:147], a[116:119], v[96:99]
s_add_u32 m0, s77, 16384
ds_read_b64_tr_b16 v[208:209], v8 offset:4096
ds_read_b64_tr_b16 v[210:211], v8 offset:6144
v_mfma_f32_16x16x32_bf16 v[96:99], v[128:131], a[112:115], v[96:99]
s_add_u32 s72, s71, 0
buffer_load_dwordx4 v15, s[24:27], s72 offen lds
v_mfma_f32_16x16x32_bf16 v[100:103], v[132:135], a[112:115], v[100:103]
s_nop 0
ds_read_b64_tr_b16 v[212:213], v9 offset:4096
ds_read_b64_tr_b16 v[214:215], v9 offset:6144
v_mfma_f32_16x16x32_bf16 v[100:103], v[148:151], a[116:119], v[100:103]
s_nop 0
ds_read_b64_tr_b16 v[216:217], v10 offset:4096
ds_read_b64_tr_b16 v[218:219], v10 offset:6144
v_mfma_f32_16x16x32_bf16 v[100:103], v[164:167], a[120:123], v[100:103]
s_nop 0
ds_read_b64_tr_b16 v[220:221], v11 offset:4096
ds_read_b64_tr_b16 v[222:223], v11 offset:6144
v_mfma_f32_16x16x32_bf16 v[100:103], v[180:183], a[124:127], v[100:103]
buffer_load_dword v114, v115, s[44:47], s84 offen sc1
v_mfma_f32_16x16x32_bf16 v[84:87], v[180:183], a[108:111], v[84:87]
buffer_load_dwordx4 a[204:207], v1, s[44:47], s69 offen offset:3072 sc1
v_mfma_f32_16x16x32_bf16 v[84:87], v[164:167], a[104:107], v[84:87]
s_add_u32 s72, s71, 15360
buffer_load_dwordx4 v15, s[24:27], s72 offen offset:1024 lds
v_mfma_f32_16x16x32_bf16 v[84:87], v[148:151], a[100:103], v[84:87]
s_nop 0
ds_read_b64_tr_b16 v[224:225], v8 offset:8192
ds_read_b64_tr_b16 v[226:227], v8 offset:10240
v_mfma_f32_16x16x32_bf16 v[84:87], v[132:135], a[96:99], v[84:87]
s_nop 0
ds_read_b64_tr_b16 v[228:229], v9 offset:8192
ds_read_b64_tr_b16 v[230:231], v9 offset:10240
v_mfma_f32_16x16x32_bf16 v[88:91], v[136:139], a[96:99], v[88:91]
s_nop 0
ds_read_b64_tr_b16 v[232:233], v10 offset:8192
ds_read_b64_tr_b16 v[234:235], v10 offset:10240
v_mfma_f32_16x16x32_bf16 v[88:91], v[152:155], a[100:103], v[88:91]
s_nop 0
ds_read_b64_tr_b16 v[236:237], v11 offset:8192
ds_read_b64_tr_b16 v[238:239], v11 offset:10240
v_mfma_f32_16x16x32_bf16 v[88:91], v[168:171], a[104:107], v[88:91]
v_mfma_f32_16x16x32_bf16 v[88:91], v[184:187], a[108:111], v[88:91]
s_add_u32 s72, s71, 30720
buffer_load_dwordx4 v15, s[24:27], s72 offen offset:2048 lds
v_mfma_f32_16x16x32_bf16 v[104:107], v[184:187], a[124:127], v[104:107]
s_nop 0
ds_read_b64_tr_b16 v[240:241], v8 offset:12288
ds_read_b64_tr_b16 v[242:243], v8 offset:14336
v_mfma_f32_16x16x32_bf16 v[104:107], v[168:171], a[120:123], v[104:107]
s_nop 0
ds_read_b64_tr_b16 v[244:245], v9 offset:12288
ds_read_b64_tr_b16 v[246:247], v9 offset:14336
v_mfma_f32_16x16x32_bf16 v[104:107], v[152:155], a[116:119], v[104:107]
s_add_u32 s69, s69, 0x20000
buffer_load_dwordx4 a[208:211], v1, s[44:47], s69 offen sc1
v_mfma_f32_16x16x32_bf16 v[104:107], v[136:139], a[112:115], v[104:107]
s_nop 0
ds_read_b64_tr_b16 v[248:249], v10 offset:12288
ds_read_b64_tr_b16 v[250:251], v10 offset:14336
v_mfma_f32_16x16x32_bf16 v[108:111], v[140:143], a[112:115], v[108:111]
s_nop 0
ds_read_b64_tr_b16 v[252:253], v11 offset:12288
ds_read_b64_tr_b16 v[254:255], v11 offset:14336
v_mfma_f32_16x16x32_bf16 v[108:111], v[156:159], a[116:119], v[108:111]
s_add_u32 s72, s71, 46080
buffer_load_dwordx4 v15, s[24:27], s72 offen offset:3072 lds
v_mfma_f32_16x16x32_bf16 v[108:111], v[172:175], a[120:123], v[108:111]
v_mfma_f32_16x16x32_bf16 v[108:111], v[188:191], a[124:127], v[108:111]
v_mfma_f32_16x16x32_bf16 v[92:95], v[188:191], a[108:111], v[92:95]
v_mfma_f32_16x16x32_bf16 v[92:95], v[172:175], a[104:107], v[92:95]
v_mfma_f32_16x16x32_bf16 v[92:95], v[156:159], a[100:103], v[92:95]
s_waitcnt vmcnt(22) lgkmcnt(0)
v_mfma_f32_16x16x32_bf16 v[92:95], v[140:143], a[96:99], v[92:95]
s_barrier
v_mfma_f32_16x16x32_bf16 v[16:19], v[192:195], a[128:131], v[16:19]
buffer_load_dwordx4 a[212:215], v1, s[44:47], s69 offen offset:1024 sc1
v_mfma_f32_16x16x32_bf16 v[16:19], v[208:211], a[132:135], v[16:19]
s_xor_b32 s71, s13, 0x40100
ds_read_b64_tr_b16 v[128:129], v8 offset:16384
ds_read_b64_tr_b16 v[130:131], v8 offset:18432
v_mfma_f32_16x16x32_bf16 v[16:19], v[224:227], a[136:139], v[16:19]
s_add_u32 m0, s77, 32768
ds_read_b64_tr_b16 v[132:133], v9 offset:16384
ds_read_b64_tr_b16 v[134:135], v9 offset:18432
v_mfma_f32_16x16x32_bf16 v[16:19], v[240:243], a[140:143], v[16:19]
s_add_u32 s72, s71, 0
buffer_load_dwordx4 v15, s[24:27], s72 offen lds
v_mfma_f32_16x16x32_bf16 v[32:35], v[240:243], a[156:159], v[32:35]
s_nop 0
ds_read_b64_tr_b16 v[136:137], v10 offset:16384
ds_read_b64_tr_b16 v[138:139], v10 offset:18432
v_mfma_f32_16x16x32_bf16 v[32:35], v[224:227], a[152:155], v[32:35]
s_nop 0
ds_read_b64_tr_b16 v[140:141], v11 offset:16384
ds_read_b64_tr_b16 v[142:143], v11 offset:18432
v_mfma_f32_16x16x32_bf16 v[32:35], v[208:211], a[148:151], v[32:35]
v_mfma_f32_16x16x32_bf16 v[32:35], v[192:195], a[144:147], v[32:35]
s_nop 0
ds_read_b64_tr_b16 v[144:145], v8 offset:20480
ds_read_b64_tr_b16 v[146:147], v8 offset:22528
v_mfma_f32_16x16x32_bf16 v[36:39], v[196:199], a[144:147], v[36:39]
s_add_u32 s72, s71, 15360
buffer_load_dwordx4 v15, s[24:27], s72 offen offset:1024 lds
v_mfma_f32_16x16x32_bf16 v[36:39], v[212:215], a[148:151], v[36:39]
s_nop 0
ds_read_b64_tr_b16 v[148:149], v9 offset:20480
ds_read_b64_tr_b16 v[150:151], v9 offset:22528
v_mfma_f32_16x16x32_bf16 v[36:39], v[228:231], a[152:155], v[36:39]
buffer_load_dwordx4 a[216:219], v1, s[44:47], s69 offen offset:2048 sc1
v_mfma_f32_16x16x32_bf16 v[36:39], v[244:247], a[156:159], v[36:39]
s_nop 0
ds_read_b64_tr_b16 v[152:153], v10 offset:20480
ds_read_b64_tr_b16 v[154:155], v10 offset:22528
v_mfma_f32_16x16x32_bf16 v[20:23], v[244:247], a[140:143], v[20:23]
s_nop 0
ds_read_b64_tr_b16 v[156:157], v11 offset:20480
ds_read_b64_tr_b16 v[158:159], v11 offset:22528
v_mfma_f32_16x16x32_bf16 v[20:23], v[228:231], a[136:139], v[20:23]
v_mfma_f32_16x16x32_bf16 v[20:23], v[212:215], a[132:135], v[20:23]
s_add_u32 s72, s71, 30720
buffer_load_dwordx4 v15, s[24:27], s72 offen offset:2048 lds
v_mfma_f32_16x16x32_bf16 v[20:23], v[196:199], a[128:131], v[20:23]
s_nop 0
ds_read_b64_tr_b16 v[160:161], v8 offset:24576
ds_read_b64_tr_b16 v[162:163], v8 offset:26624
v_mfma_f32_16x16x32_bf16 v[24:27], v[200:203], a[128:131], v[24:27]
s_nop 0
ds_read_b64_tr_b16 v[164:165], v9 offset:24576
ds_read_b64_tr_b16 v[166:167], v9 offset:26624
v_mfma_f32_16x16x32_bf16 v[24:27], v[216:219], a[132:135], v[24:27]
s_nop 0
ds_read_b64_tr_b16 v[168:169], v10 offset:24576
ds_read_b64_tr_b16 v[170:171], v10 offset:26624
v_mfma_f32_16x16x32_bf16 v[24:27], v[232:235], a[136:139], v[24:27]
s_nop 0
ds_read_b64_tr_b16 v[172:173], v11 offset:24576
ds_read_b64_tr_b16 v[174:175], v11 offset:26624
v_mfma_f32_16x16x32_bf16 v[24:27], v[248:251], a[140:143], v[24:27]
v_mfma_f32_16x16x32_bf16 v[40:43], v[248:251], a[156:159], v[40:43]
s_add_u32 s72, s71, 46080
buffer_load_dwordx4 v15, s[24:27], s72 offen offset:3072 lds
v_mfma_f32_16x16x32_bf16 v[40:43], v[232:235], a[152:155], v[40:43]
buffer_load_dwordx4 a[220:223], v1, s[44:47], s69 offen offset:3072 sc1
v_mfma_f32_16x16x32_bf16 v[40:43], v[216:219], a[148:151], v[40:43]
s_nop 0
ds_read_b64_tr_b16 v[176:177], v8 offset:28672
ds_read_b64_tr_b16 v[178:179], v8 offset:30720
v_mfma_f32_16x16x32_bf16 v[40:43], v[200:203], a[144:147], v[40:43]
s_lshr_b32 s69, s15, 18
ds_read_b64_tr_b16 v[180:181], v9 offset:28672
ds_read_b64_tr_b16 v[182:183], v9 offset:30720
v_mfma_f32_16x16x32_bf16 v[44:47], v[204:207], a[144:147], v[44:47]
s_lshl_b32 s69, s69, 12
ds_read_b64_tr_b16 v[184:185], v10 offset:28672
ds_read_b64_tr_b16 v[186:187], v10 offset:30720
v_mfma_f32_16x16x32_bf16 v[44:47], v[220:223], a[148:151], v[44:47]
s_add_u32 s69, s69, s95
ds_read_b64_tr_b16 v[188:189], v11 offset:28672
ds_read_b64_tr_b16 v[190:191], v11 offset:30720
v_mfma_f32_16x16x32_bf16 v[44:47], v[236:239], a[152:155], v[44:47]
s_xor_b32 s69, s69, 0x1000
v_mfma_f32_16x16x32_bf16 v[44:47], v[252:255], a[156:159], v[44:47]
s_xor_b32 s71, s14, 0x40100
v_mfma_f32_16x16x32_bf16 v[28:31], v[252:255], a[140:143], v[28:31]
s_add_u32 m0, s77, 49152
v_mfma_f32_16x16x32_bf16 v[28:31], v[236:239], a[136:139], v[28:31]
s_add_u32 s72, s71, 0
v_mfma_f32_16x16x32_bf16 v[28:31], v[220:223], a[132:135], v[28:31]
s_waitcnt lgkmcnt(0)
buffer_load_dwordx4 v15, s[24:27], s72 offen lds
v_mfma_f32_16x16x32_bf16 v[28:31], v[204:207], a[128:131], v[28:31]
buffer_load_dwordx4 a[224:227], v1, s[44:47], s69 offen sc1
v_mfma_f32_16x16x32_bf16 v[48:51], v[128:131], a[128:131], v[48:51]
s_nop 0
ds_read_b64_tr_b16 v[192:193], v8 offset:32768
ds_read_b64_tr_b16 v[194:195], v8 offset:34816
v_mfma_f32_16x16x32_bf16 v[48:51], v[144:147], a[132:135], v[48:51]
s_nop 0
ds_read_b64_tr_b16 v[196:197], v9 offset:32768
ds_read_b64_tr_b16 v[198:199], v9 offset:34816
v_mfma_f32_16x16x32_bf16 v[48:51], v[160:163], a[136:139], v[48:51]
s_nop 0
ds_read_b64_tr_b16 v[200:201], v10 offset:32768
ds_read_b64_tr_b16 v[202:203], v10 offset:34816
v_mfma_f32_16x16x32_bf16 v[48:51], v[176:179], a[140:143], v[48:51]
s_add_u32 s72, s71, 15360
buffer_load_dwordx4 v15, s[24:27], s72 offen offset:1024 lds
v_mfma_f32_16x16x32_bf16 v[64:67], v[176:179], a[156:159], v[64:67]
s_nop 0
ds_read_b64_tr_b16 v[204:205], v11 offset:32768
ds_read_b64_tr_b16 v[206:207], v11 offset:34816
v_mfma_f32_16x16x32_bf16 v[64:67], v[160:163], a[152:155], v[64:67]
v_mfma_f32_16x16x32_bf16 v[64:67], v[144:147], a[148:151], v[64:67]
s_nop 0
ds_read_b64_tr_b16 v[208:209], v8 offset:36864
ds_read_b64_tr_b16 v[210:211], v8 offset:38912
v_mfma_f32_16x16x32_bf16 v[64:67], v[128:131], a[144:147], v[64:67]
s_nop 0
ds_read_b64_tr_b16 v[212:213], v9 offset:36864
ds_read_b64_tr_b16 v[214:215], v9 offset:38912
v_mfma_f32_16x16x32_bf16 v[68:71], v[132:135], a[144:147], v[68:71]
buffer_load_dwordx4 a[228:231], v1, s[44:47], s69 offen offset:1024 sc1
v_mfma_f32_16x16x32_bf16 v[68:71], v[148:151], a[148:151], v[68:71]
s_add_u32 s72, s71, 30720
buffer_load_dwordx4 v15, s[24:27], s72 offen offset:2048 lds
v_mfma_f32_16x16x32_bf16 v[68:71], v[164:167], a[152:155], v[68:71]
s_nop 0
ds_read_b64_tr_b16 v[216:217], v10 offset:36864
ds_read_b64_tr_b16 v[218:219], v10 offset:38912
v_mfma_f32_16x16x32_bf16 v[68:71], v[180:183], a[156:159], v[68:71]
v_mfma_f32_16x16x32_bf16 v[52:55], v[180:183], a[140:143], v[52:55]
s_nop 0
ds_read_b64_tr_b16 v[220:221], v11 offset:36864
ds_read_b64_tr_b16 v[222:223], v11 offset:38912
v_mfma_f32_16x16x32_bf16 v[52:55], v[164:167], a[136:139], v[52:55]
s_nop 0
ds_read_b64_tr_b16 v[224:225], v8 offset:40960
ds_read_b64_tr_b16 v[226:227], v8 offset:43008
v_mfma_f32_16x16x32_bf16 v[52:55], v[148:151], a[132:135], v[52:55]
s_nop 0
ds_read_b64_tr_b16 v[228:229], v9 offset:40960
ds_read_b64_tr_b16 v[230:231], v9 offset:43008
v_mfma_f32_16x16x32_bf16 v[52:55], v[132:135], a[128:131], v[52:55]
s_add_u32 s72, s71, 46080
buffer_load_dwordx4 v15, s[24:27], s72 offen offset:3072 lds
v_mfma_f32_16x16x32_bf16 v[56:59], v[136:139], a[128:131], v[56:59]
v_mfma_f32_16x16x32_bf16 v[56:59], v[152:155], a[132:135], v[56:59]
s_nop 0
ds_read_b64_tr_b16 v[232:233], v10 offset:40960
ds_read_b64_tr_b16 v[234:235], v10 offset:43008
v_mfma_f32_16x16x32_bf16 v[56:59], v[168:171], a[136:139], v[56:59]
buffer_load_dwordx4 a[232:235], v1, s[44:47], s69 offen offset:2048 sc1
v_mfma_f32_16x16x32_bf16 v[56:59], v[184:187], a[140:143], v[56:59]
s_nop 0
ds_read_b64_tr_b16 v[236:237], v11 offset:40960
ds_read_b64_tr_b16 v[238:239], v11 offset:43008
v_mfma_f32_16x16x32_bf16 v[72:75], v[184:187], a[156:159], v[72:75]
s_nop 0
ds_read_b64_tr_b16 v[240:241], v8 offset:45056
ds_read_b64_tr_b16 v[242:243], v8 offset:47104
v_mfma_f32_16x16x32_bf16 v[72:75], v[168:171], a[152:155], v[72:75]
v_mfma_f32_16x16x32_bf16 v[72:75], v[152:155], a[148:151], v[72:75]
s_nop 0
ds_read_b64_tr_b16 v[244:245], v9 offset:45056
ds_read_b64_tr_b16 v[246:247], v9 offset:47104
v_mfma_f32_16x16x32_bf16 v[72:75], v[136:139], a[144:147], v[72:75]
s_xor_b32 s71, s15, 0x40100
ds_read_b64_tr_b16 v[248:249], v10 offset:45056
ds_read_b64_tr_b16 v[250:251], v10 offset:47104
v_mfma_f32_16x16x32_bf16 v[76:79], v[140:143], a[144:147], v[76:79]
s_add_u32 m0, s85, 0
ds_read_b64_tr_b16 v[252:253], v11 offset:45056
ds_read_b64_tr_b16 v[254:255], v11 offset:47104
v_mfma_f32_16x16x32_bf16 v[76:79], v[156:159], a[148:151], v[76:79]
s_add_u32 s72, s71, 0
buffer_load_dwordx4 v15, s[24:27], s72 offen lds
v_mfma_f32_16x16x32_bf16 v[76:79], v[172:175], a[152:155], v[76:79]
v_mfma_f32_16x16x32_bf16 v[76:79], v[188:191], a[156:159], v[76:79]
v_mfma_f32_16x16x32_bf16 v[60:63], v[188:191], a[140:143], v[60:63]
buffer_load_dwordx4 a[236:239], v1, s[44:47], s69 offen offset:3072 sc1
v_mfma_f32_16x16x32_bf16 v[60:63], v[172:175], a[136:139], v[60:63]
s_add_u32 s72, s71, 15360
v_mfma_f32_16x16x32_bf16 v[60:63], v[156:159], a[132:135], v[60:63]
s_waitcnt vmcnt(24) lgkmcnt(0)
v_mfma_f32_16x16x32_bf16 v[60:63], v[140:143], a[128:131], v[60:63]
s_barrier
buffer_load_dwordx4 v15, s[24:27], s72 offen offset:1024 lds
v_mfma_f32_16x16x32_bf16 v[80:83], v[192:195], a[128:131], v[80:83]
s_nop 0
ds_read_b64_tr_b16 v[128:129], v8 offset:49152
ds_read_b64_tr_b16 v[130:131], v8 offset:51200
v_mfma_f32_16x16x32_bf16 v[80:83], v[208:211], a[132:135], v[80:83]
s_nop 0
ds_read_b64_tr_b16 v[132:133], v9 offset:49152
ds_read_b64_tr_b16 v[134:135], v9 offset:51200
v_mfma_f32_16x16x32_bf16 v[80:83], v[224:227], a[136:139], v[80:83]
s_nop 0
ds_read_b64_tr_b16 v[136:137], v10 offset:49152
ds_read_b64_tr_b16 v[138:139], v10 offset:51200
Lstube2:
s_cbranch_execz Lrete
s_waitcnt vmcnt(22)
v_cmp_gt_u32 vcc, 3, v114
s_cbranch_vccnz Lspin109
Lback110:
v_mfma_f32_16x16x32_bf16 v[80:83], v[240:243], a[140:143], v[80:83]
s_lshl_b32 s73, s76, 18
ds_read_b64_tr_b16 v[140:141], v11 offset:49152
ds_read_b64_tr_b16 v[142:143], v11 offset:51200
v_mfma_f32_16x16x32_bf16 v[96:99], v[240:243], a[156:159], v[96:99]
s_lshl_b32 s84, s58, 16
v_mfma_f32_16x16x32_bf16 v[96:99], v[224:227], a[152:155], v[96:99]
s_add_u32 s72, s71, 30720
buffer_load_dwordx4 v15, s[24:27], s72 offen offset:2048 lds
v_mfma_f32_16x16x32_bf16 v[96:99], v[208:211], a[148:151], v[96:99]
s_add_u32 s69, s69, 0x20000
buffer_load_dwordx4 a[240:243], v1, s[44:47], s69 offen sc1
v_mfma_f32_16x16x32_bf16 v[96:99], v[192:195], a[144:147], v[96:99]
s_add_u32 s73, s73, s84
ds_read_b64_tr_b16 v[144:145], v8 offset:53248
ds_read_b64_tr_b16 v[146:147], v8 offset:55296
v_mfma_f32_16x16x32_bf16 v[100:103], v[196:199], a[144:147], v[100:103]
s_lshl_b32 s84, s75, 8
ds_read_b64_tr_b16 v[148:149], v9 offset:53248
ds_read_b64_tr_b16 v[150:151], v9 offset:55296
v_mfma_f32_16x16x32_bf16 v[100:103], v[212:215], a[148:151], v[100:103]
s_add_u32 s73, s73, s84
ds_read_b64_tr_b16 v[152:153], v10 offset:53248
ds_read_b64_tr_b16 v[154:155], v10 offset:55296
v_mfma_f32_16x16x32_bf16 v[100:103], v[228:231], a[152:155], v[100:103]
s_add_u32 s73, s73, 0x3400000
v_lshrrev_b32 v112, 4, v0
v_and_b32 v113, 15, v0
v_mfma_f32_16x16x32_bf16 v[100:103], v[244:247], a[156:159], v[100:103]
s_add_u32 s72, s71, 46080
buffer_load_dwordx4 v15, s[24:27], s72 offen offset:3072 lds
v_mfma_f32_16x16x32_bf16 v[84:87], v[244:247], a[140:143], v[84:87]
s_nop 0
ds_read_b64_tr_b16 v[156:157], v11 offset:53248
ds_read_b64_tr_b16 v[158:159], v11 offset:55296
v_mfma_f32_16x16x32_bf16 v[84:87], v[228:231], a[136:139], v[84:87]
s_nop 0
ds_read_b64_tr_b16 v[160:161], v8 offset:57344
ds_read_b64_tr_b16 v[162:163], v8 offset:59392
v_mfma_f32_16x16x32_bf16 v[84:87], v[212:215], a[132:135], v[84:87]
s_nop 0
ds_read_b64_tr_b16 v[164:165], v9 offset:57344
ds_read_b64_tr_b16 v[166:167], v9 offset:59392
v_mfma_f32_16x16x32_bf16 v[84:87], v[196:199], a[128:131], v[84:87]
v_xor_b32 v12, v113, v112
v_lshlrev_b32 v12, 4, v12
v_mfma_f32_16x16x32_bf16 v[88:91], v[200:203], a[128:131], v[88:91]
buffer_load_dwordx4 a[244:247], v1, s[44:47], s69 offen offset:1024 sc1
v_mfma_f32_16x16x32_bf16 v[88:91], v[216:219], a[132:135], v[88:91]
s_nop 0
ds_read_b64_tr_b16 v[168:169], v10 offset:57344
ds_read_b64_tr_b16 v[170:171], v10 offset:59392
v_mfma_f32_16x16x32_bf16 v[88:91], v[232:235], a[136:139], v[88:91]
s_nop 0
ds_read_b64_tr_b16 v[172:173], v11 offset:57344
ds_read_b64_tr_b16 v[174:175], v11 offset:59392
v_mfma_f32_16x16x32_bf16 v[88:91], v[248:251], a[140:143], v[88:91]
s_xor_b32 s71, s13, 0x40180
ds_read_b64_tr_b16 v[176:177], v8 offset:61440
ds_read_b64_tr_b16 v[178:179], v8 offset:63488
v_mfma_f32_16x16x32_bf16 v[104:107], v[248:251], a[156:159], v[104:107]
s_add_u32 m0, s85, 16384
v_lshl_add_u32 v112, v112, 12, v12
v_xor_b32 v12, 64, v112
v_mfma_f32_16x16x32_bf16 v[104:107], v[232:235], a[152:155], v[104:107]
s_add_u32 s72, s71, 0
buffer_load_dwordx4 v15, s[24:27], s72 offen lds
v_mfma_f32_16x16x32_bf16 v[104:107], v[216:219], a[148:151], v[104:107]
s_nop 0
ds_read_b64_tr_b16 v[180:181], v9 offset:61440
ds_read_b64_tr_b16 v[182:183], v9 offset:63488
v_mfma_f32_16x16x32_bf16 v[104:107], v[200:203], a[144:147], v[104:107]
s_nop 0
ds_read_b64_tr_b16 v[184:185], v10 offset:61440
ds_read_b64_tr_b16 v[186:187], v10 offset:63488
v_mfma_f32_16x16x32_bf16 v[108:111], v[204:207], a[144:147], v[108:111]
s_nop 0
ds_read_b64_tr_b16 v[188:189], v11 offset:61440
ds_read_b64_tr_b16 v[190:191], v11 offset:63488
v_mfma_f32_16x16x32_bf16 v[108:111], v[220:223], a[148:151], v[108:111]
v_lshlrev_b32 v113, 2, v113
v_mfma_f32_16x16x32_bf16 v[108:111], v[236:239], a[152:155], v[108:111]
s_add_u32 s72, s71, 15360
buffer_load_dwordx4 v15, s[24:27], s72 offen offset:1024 lds
v_mfma_f32_16x16x32_bf16 v[108:111], v[252:255], a[156:159], v[108:111]
buffer_load_dwordx4 a[248:251], v1, s[44:47], s69 offen offset:2048 sc1
v_mfma_f32_16x16x32_bf16 v[92:95], v[252:255], a[140:143], v[92:95]
v_xor_b32 v8, 0x10000, v8
v_mfma_f32_16x16x32_bf16 v[92:95], v[236:239], a[136:139], v[92:95]
v_xor_b32 v9, 0x10000, v9
v_mfma_f32_16x16x32_bf16 v[92:95], v[220:223], a[132:135], v[92:95]
s_waitcnt vmcnt(38) lgkmcnt(0)
v_xor_b32 v10, 0x10000, v10
v_mfma_f32_16x16x32_bf16 v[92:95], v[204:207], a[128:131], v[92:95]
v_xor_b32 v11, 0x10000, v11
v_mfma_f32_16x16x32_bf16 v[16:19], v[128:131], a[160:163], v[16:19]
s_add_u32 s72, s71, 30720
buffer_load_dwordx4 v15, s[24:27], s72 offen offset:2048 lds
v_mfma_f32_16x16x32_bf16 v[16:19], v[144:147], a[164:167], v[16:19]
s_nop 0
ds_read_b64_tr_b16 v[192:193], v8 offset:0
ds_read_b64_tr_b16 v[194:195], v8 offset:2048
v_mfma_f32_16x16x32_bf16 v[16:19], v[160:163], a[168:171], v[16:19]
s_nop 0
ds_read_b64_tr_b16 v[196:197], v9 offset:0
ds_read_b64_tr_b16 v[198:199], v9 offset:2048
v_mfma_f32_16x16x32_bf16 v[16:19], v[176:179], a[172:175], v[16:19]
s_nop 0
ds_read_b64_tr_b16 v[200:201], v10 offset:0
ds_read_b64_tr_b16 v[202:203], v10 offset:2048
v_mfma_f32_16x16x32_bf16 v[32:35], v[176:179], a[188:191], v[32:35]
buffer_load_dwordx4 a[252:255], v1, s[44:47], s69 offen offset:3072 sc1
v_mfma_f32_16x16x32_bf16 v[32:35], v[160:163], a[184:187], v[32:35]
v_mfma_f32_16x16x32_bf16 v[32:35], v[144:147], a[180:183], v[32:35]
s_add_u32 s72, s71, 46080
buffer_load_dwordx4 v15, s[24:27], s72 offen offset:3072 lds
v_mfma_f32_16x16x32_bf16 v[32:35], v[128:131], a[176:179], v[32:35]
s_nop 0
ds_read_b64_tr_b16 v[204:205], v11 offset:0
ds_read_b64_tr_b16 v[206:207], v11 offset:2048
v_mfma_f32_16x16x32_bf16 v[36:39], v[132:135], a[176:179], v[36:39]
s_nop 0
ds_read_b64_tr_b16 v[208:209], v8 offset:4096
ds_read_b64_tr_b16 v[210:211], v8 offset:6144
v_mfma_f32_16x16x32_bf16 v[36:39], v[148:151], a[180:183], v[36:39]
s_nop 0
ds_read_b64_tr_b16 v[212:213], v9 offset:4096
ds_read_b64_tr_b16 v[214:215], v9 offset:6144
v_mfma_f32_16x16x32_bf16 v[36:39], v[164:167], a[184:187], v[36:39]
v_mfma_f32_16x16x32_bf16 v[36:39], v[180:183], a[188:191], v[36:39]
s_nop 0
ds_read_b64_tr_b16 v[216:217], v10 offset:4096
ds_read_b64_tr_b16 v[218:219], v10 offset:6144
v_mfma_f32_16x16x32_bf16 v[20:23], v[180:183], a[172:175], v[20:23]
s_nop 0
ds_read_b64_tr_b16 v[220:221], v11 offset:4096
ds_read_b64_tr_b16 v[222:223], v11 offset:6144
v_mfma_f32_16x16x32_bf16 v[20:23], v[164:167], a[168:171], v[20:23]
v_mfma_f32_16x16x32_bf16 v[20:23], v[148:151], a[164:167], v[20:23]
s_xor_b32 s71, s14, 0x40180
ds_read_b64_tr_b16 v[224:225], v8 offset:8192
ds_read_b64_tr_b16 v[226:227], v8 offset:10240
v_mfma_f32_16x16x32_bf16 v[20:23], v[132:135], a[160:163], v[20:23]
s_add_u32 m0, s85, 32768
ds_read_b64_tr_b16 v[228:229], v9 offset:8192
ds_read_b64_tr_b16 v[230:231], v9 offset:10240
v_mfma_f32_16x16x32_bf16 v[24:27], v[136:139], a[160:163], v[24:27]
s_add_u32 s72, s71, 0
buffer_load_dwordx4 v15, s[24:27], s72 offen lds
v_mfma_f32_16x16x32_bf16 v[24:27], v[152:155], a[164:167], v[24:27]
s_nop 0
ds_read_b64_tr_b16 v[232:233], v10 offset:8192
ds_read_b64_tr_b16 v[234:235], v10 offset:10240
v_mfma_f32_16x16x32_bf16 v[24:27], v[168:171], a[168:171], v[24:27]
v_mfma_f32_16x16x32_bf16 v[24:27], v[184:187], a[172:175], v[24:27]
s_nop 0
ds_read_b64_tr_b16 v[236:237], v11 offset:8192
ds_read_b64_tr_b16 v[238:239], v11 offset:10240
v_mfma_f32_16x16x32_bf16 v[40:43], v[184:187], a[188:191], v[40:43]
s_nop 0
ds_read_b64_tr_b16 v[240:241], v8 offset:12288
ds_read_b64_tr_b16 v[242:243], v8 offset:14336
v_mfma_f32_16x16x32_bf16 v[40:43], v[168:171], a[184:187], v[40:43]
s_nop 0
ds_read_b64_tr_b16 v[244:245], v9 offset:12288
ds_read_b64_tr_b16 v[246:247], v9 offset:14336
v_mfma_f32_16x16x32_bf16 v[40:43], v[152:155], a[180:183], v[40:43]
s_add_u32 s72, s71, 15360
buffer_load_dwordx4 v15, s[24:27], s72 offen offset:1024 lds
v_mfma_f32_16x16x32_bf16 v[40:43], v[136:139], a[176:179], v[40:43]
v_mfma_f32_16x16x32_bf16 v[44:47], v[140:143], a[176:179], v[44:47]
s_nop 0
ds_read_b64_tr_b16 v[248:249], v10 offset:12288
ds_read_b64_tr_b16 v[250:251], v10 offset:14336
v_mfma_f32_16x16x32_bf16 v[44:47], v[156:159], a[180:183], v[44:47]
s_nop 0
ds_read_b64_tr_b16 v[252:253], v11 offset:12288
ds_read_b64_tr_b16 v[254:255], v11 offset:14336
v_mfma_f32_16x16x32_bf16 v[44:47], v[172:175], a[184:187], v[44:47]
v_mfma_f32_16x16x32_bf16 v[44:47], v[188:191], a[188:191], v[44:47]
v_mfma_f32_16x16x32_bf16 v[28:31], v[188:191], a[172:175], v[28:31]
s_add_u32 s72, s71, 30720
buffer_load_dwordx4 v15, s[24:27], s72 offen offset:2048 lds
v_mfma_f32_16x16x32_bf16 v[28:31], v[172:175], a[168:171], v[28:31]
v_mfma_f32_16x16x32_bf16 v[28:31], v[156:159], a[164:167], v[28:31]
s_waitcnt vmcnt(23) lgkmcnt(0)
v_mfma_f32_16x16x32_bf16 v[28:31], v[140:143], a[160:163], v[28:31]
s_barrier
v_mfma_f32_16x16x32_bf16 v[16:19], v[192:195], a[192:195], v[16:19]
s_nop 0
ds_read_b64_tr_b16 v[128:129], v8 offset:16384
ds_read_b64_tr_b16 v[130:131], v8 offset:18432
v_mfma_f32_16x16x32_bf16 v[16:19], v[208:211], a[196:199], v[16:19]
s_nop 0
ds_read_b64_tr_b16 v[132:133], v9 offset:16384
ds_read_b64_tr_b16 v[134:135], v9 offset:18432
v_mfma_f32_16x16x32_bf16 v[16:19], v[224:227], a[200:203], v[16:19]
s_add_u32 s72, s71, 46080
buffer_load_dwordx4 v15, s[24:27], s72 offen offset:3072 lds
v_mfma_f32_16x16x32_bf16 v[16:19], v[240:243], a[204:207], v[16:19]
s_nop 0
ds_read_b64_tr_b16 v[136:137], v10 offset:16384
ds_read_b64_tr_b16 v[138:139], v10 offset:18432
v_mfma_f32_16x16x32_bf16 v[32:35], v[240:243], a[220:223], v[32:35]
s_nop 0
ds_read_b64_tr_b16 v[140:141], v11 offset:16384
ds_read_b64_tr_b16 v[142:143], v11 offset:18432
v_mfma_f32_16x16x32_bf16 v[32:35], v[224:227], a[216:219], v[32:35]
v_mfma_f32_16x16x32_bf16 v[32:35], v[208:211], a[212:215], v[32:35]
s_nop 0
ds_read_b64_tr_b16 v[144:145], v8 offset:20480
ds_read_b64_tr_b16 v[146:147], v8 offset:22528
v_mfma_f32_16x16x32_bf16 v[32:35], v[192:195], a[208:211], v[32:35]
s_nop 0
ds_read_b64_tr_b16 v[148:149], v9 offset:20480
ds_read_b64_tr_b16 v[150:151], v9 offset:22528
v_mfma_f32_16x16x32_bf16 v[36:39], v[196:199], a[208:211], v[36:39]
s_nop 0
ds_read_b64_tr_b16 v[152:153], v10 offset:20480
ds_read_b64_tr_b16 v[154:155], v10 offset:22528
v_mfma_f32_16x16x32_bf16 v[36:39], v[212:215], a[212:215], v[36:39]
s_nop 0
ds_read_b64_tr_b16 v[156:157], v11 offset:20480
ds_read_b64_tr_b16 v[158:159], v11 offset:22528
v_mfma_f32_16x16x32_bf16 v[36:39], v[228:231], a[216:219], v[36:39]
v_mfma_f32_16x16x32_bf16 v[36:39], v[244:247], a[220:223], v[36:39]
s_add_u32 m0, s64, 147456
ds_read_b64_tr_b16 v[160:161], v8 offset:24576
ds_read_b64_tr_b16 v[162:163], v8 offset:26624
v_mfma_f32_16x16x32_bf16 v[20:23], v[244:247], a[204:207], v[20:23]
s_add_u32 s72, s73, 0
buffer_load_dwordx4 v112, s[44:47], s72 offen sc1 lds
v_mfma_f32_16x16x32_bf16 v[20:23], v[228:231], a[200:203], v[20:23]
s_nop 0
ds_read_b64_tr_b16 v[164:165], v9 offset:24576
ds_read_b64_tr_b16 v[166:167], v9 offset:26624
v_mfma_f32_16x16x32_bf16 v[20:23], v[212:215], a[196:199], v[20:23]
s_add_u32 s72, s73, 15360
buffer_load_dwordx4 v12, s[44:47], s72 offen offset:1024 sc1 lds
v_mfma_f32_16x16x32_bf16 v[20:23], v[196:199], a[192:195], v[20:23]
s_nop 0
ds_read_b64_tr_b16 v[168:169], v10 offset:24576
ds_read_b64_tr_b16 v[170:171], v10 offset:26624
v_mfma_f32_16x16x32_bf16 v[24:27], v[200:203], a[192:195], v[24:27]
s_nop 0
ds_read_b64_tr_b16 v[172:173], v11 offset:24576
ds_read_b64_tr_b16 v[174:175], v11 offset:26624
v_mfma_f32_16x16x32_bf16 v[24:27], v[216:219], a[196:199], v[24:27]
s_add_u32 s72, s73, 30720
buffer_load_dwordx4 v112, s[44:47], s72 offen offset:2048 sc1 lds
v_mfma_f32_16x16x32_bf16 v[24:27], v[232:235], a[200:203], v[24:27]
v_mfma_f32_16x16x32_bf16 v[24:27], v[248:251], a[204:207], v[24:27]
s_nop 0
ds_read_b64_tr_b16 v[176:177], v8 offset:28672
ds_read_b64_tr_b16 v[178:179], v8 offset:30720
v_mfma_f32_16x16x32_bf16 v[40:43], v[248:251], a[220:223], v[40:43]
s_add_u32 s72, s73, 46080
buffer_load_dwordx4 v12, s[44:47], s72 offen offset:3072 sc1 lds
v_mfma_f32_16x16x32_bf16 v[40:43], v[232:235], a[216:219], v[40:43]
s_xor_b32 s71, s15, 0x40180
ds_read_b64_tr_b16 v[180:181], v9 offset:28672
ds_read_b64_tr_b16 v[182:183], v9 offset:30720
v_mfma_f32_16x16x32_bf16 v[40:43], v[216:219], a[212:215], v[40:43]
s_add_u32 m0, s85, 49152
ds_read_b64_tr_b16 v[184:185], v10 offset:28672
ds_read_b64_tr_b16 v[186:187], v10 offset:30720
v_mfma_f32_16x16x32_bf16 v[40:43], v[200:203], a[208:211], v[40:43]
s_add_u32 s72, s71, 0
buffer_load_dwordx4 v15, s[24:27], s72 offen lds
v_mfma_f32_16x16x32_bf16 v[44:47], v[204:207], a[208:211], v[44:47]
s_nop 0
ds_read_b64_tr_b16 v[188:189], v11 offset:28672
ds_read_b64_tr_b16 v[190:191], v11 offset:30720
v_mfma_f32_16x16x32_bf16 v[44:47], v[220:223], a[212:215], v[44:47]
v_mfma_f32_16x16x32_bf16 v[44:47], v[236:239], a[216:219], v[44:47]
s_add_u32 s72, s71, 15360
buffer_load_dwordx4 v15, s[24:27], s72 offen offset:1024 lds
v_mfma_f32_16x16x32_bf16 v[44:47], v[252:255], a[220:223], v[44:47]
v_mfma_f32_16x16x32_bf16 v[28:31], v[252:255], a[204:207], v[28:31]
v_mfma_f32_16x16x32_bf16 v[28:31], v[236:239], a[200:203], v[28:31]
s_add_u32 s72, s71, 30720
buffer_load_dwordx4 v15, s[24:27], s72 offen offset:2048 lds
v_mfma_f32_16x16x32_bf16 v[28:31], v[220:223], a[196:199], v[28:31]
s_waitcnt vmcnt(12) lgkmcnt(0)
v_mfma_f32_16x16x32_bf16 v[28:31], v[204:207], a[192:195], v[28:31]
v_mfma_f32_16x16x32_bf16 v[16:19], v[128:131], a[224:227], v[16:19]
s_add_u32 s72, s71, 46080
buffer_load_dwordx4 v15, s[24:27], s72 offen offset:3072 lds
v_mfma_f32_16x16x32_bf16 v[16:19], v[144:147], a[228:231], v[16:19]
s_lshl_b32 s73, s75, 9
ds_read_b64_tr_b16 v[192:193], v8 offset:32768
ds_read_b64_tr_b16 v[194:195], v8 offset:34816
v_mfma_f32_16x16x32_bf16 v[16:19], v[160:163], a[232:235], v[16:19]
s_lshl_b32 s84, s58, 7
ds_read_b64_tr_b16 v[196:197], v9 offset:32768
ds_read_b64_tr_b16 v[198:199], v9 offset:34816
v_mfma_f32_16x16x32_bf16 v[16:19], v[176:179], a[236:239], v[16:19]
s_add_u32 s73, s73, s84
ds_read_b64_tr_b16 v[200:201], v10 offset:32768
ds_read_b64_tr_b16 v[202:203], v10 offset:34816
v_mfma_f32_16x16x32_bf16 v[20:23], v[180:183], a[236:239], v[20:23]
s_add_u32 s73, s73, 0x3800000
ds_read_b64_tr_b16 v[204:205], v11 offset:32768
ds_read_b64_tr_b16 v[206:207], v11 offset:34816
v_mfma_f32_16x16x32_bf16 v[20:23], v[164:167], a[232:235], v[20:23]
s_xor_b32 s71, s12, 0x0
buffer_load_dword v6, v113, s[44:47], s73 offen sc1
v_mfma_f32_16x16x32_bf16 v[20:23], v[148:151], a[228:231], v[20:23]
s_add_u32 m0, s77, 0
ds_read_b64_tr_b16 v[208:209], v8 offset:36864
ds_read_b64_tr_b16 v[210:211], v8 offset:38912
v_mfma_f32_16x16x32_bf16 v[20:23], v[132:135], a[224:227], v[20:23]
s_add_u32 s72, s71, 0
buffer_load_dwordx4 v15, s[24:27], s72 offen lds
v_mfma_f32_16x16x32_bf16 v[24:27], v[136:139], a[224:227], v[24:27]
s_nop 0
ds_read_b64_tr_b16 v[212:213], v9 offset:36864
ds_read_b64_tr_b16 v[214:215], v9 offset:38912
v_mfma_f32_16x16x32_bf16 v[24:27], v[152:155], a[228:231], v[24:27]
s_nop 0
ds_read_b64_tr_b16 v[216:217], v10 offset:36864
ds_read_b64_tr_b16 v[218:219], v10 offset:38912
v_mfma_f32_16x16x32_bf16 v[24:27], v[168:171], a[232:235], v[24:27]
buffer_load_dword v7, v113, s[44:47], s73 offen offset:64 sc1
v_mfma_f32_16x16x32_bf16 v[24:27], v[184:187], a[236:239], v[24:27]
s_nop 0
ds_read_b64_tr_b16 v[220:221], v11 offset:36864
ds_read_b64_tr_b16 v[222:223], v11 offset:38912
v_cvt_pk_bf16_f32 v16, v16, v17
v_mfma_f32_16x16x32_bf16 v[28:31], v[188:191], a[236:239], v[28:31]
s_nop 0
ds_read_b64_tr_b16 v[224:225], v8 offset:40960
ds_read_b64_tr_b16 v[226:227], v8 offset:43008
v_cvt_pk_bf16_f32 v17, v18, v19
v_mfma_f32_16x16x32_bf16 v[28:31], v[172:175], a[232:235], v[28:31]
s_add_u32 s72, s71, 15360
buffer_load_dwordx4 v15, s[24:27], s72 offen offset:1024 lds
v_cvt_pk_bf16_f32 v18, v20, v21
v_mfma_f32_16x16x32_bf16 v[28:31], v[156:159], a[228:231], v[28:31]
s_nop 0
ds_read_b64_tr_b16 v[228:229], v9 offset:40960
ds_read_b64_tr_b16 v[230:231], v9 offset:43008
v_cvt_pk_bf16_f32 v19, v22, v23
v_mfma_f32_16x16x32_bf16 v[28:31], v[140:143], a[224:227], v[28:31]
v_mfma_f32_16x16x32_bf16 v[32:35], v[128:131], a[240:243], v[32:35]
s_xor_b32 s80, s93, 0x100000
ds_read_b64_tr_b16 v[232:233], v10 offset:40960
ds_read_b64_tr_b16 v[234:235], v10 offset:43008
v_mfma_f32_16x16x32_bf16 v[32:35], v[144:147], a[244:247], v[32:35]
s_add_u32 s80, s80, 0x3a00000
buffer_store_dwordx4 v[16:19], v1, s[44:47], s80 offen sc1
v_mfma_f32_16x16x32_bf16 v[32:35], v[160:163], a[248:251], v[32:35]
s_nop 0
ds_read_b64_tr_b16 v[236:237], v11 offset:40960
ds_read_b64_tr_b16 v[238:239], v11 offset:43008
v_mfma_f32_16x16x32_bf16 v[32:35], v[176:179], a[252:255], v[32:35]
s_add_u32 s72, s71, 30720
buffer_load_dwordx4 v15, s[24:27], s72 offen offset:2048 lds
v_cvt_pk_bf16_f32 v20, v24, v25
v_mfma_f32_16x16x32_bf16 v[36:39], v[180:183], a[252:255], v[36:39]
s_nop 0
ds_read_b64_tr_b16 v[240:241], v8 offset:45056
ds_read_b64_tr_b16 v[242:243], v8 offset:47104
v_cvt_pk_bf16_f32 v21, v26, v27
v_mfma_f32_16x16x32_bf16 v[36:39], v[164:167], a[248:251], v[36:39]
v_cvt_pk_bf16_f32 v22, v28, v29
v_cvt_pk_bf16_f32 v23, v30, v31
v_mfma_f32_16x16x32_bf16 v[36:39], v[148:151], a[244:247], v[36:39]
s_nop 0
ds_read_b64_tr_b16 v[244:245], v9 offset:45056
ds_read_b64_tr_b16 v[246:247], v9 offset:47104
v_mfma_f32_16x16x32_bf16 v[36:39], v[132:135], a[240:243], v[36:39]
s_nop 0
ds_read_b64_tr_b16 v[248:249], v10 offset:45056
ds_read_b64_tr_b16 v[250:251], v10 offset:47104
v_mfma_f32_16x16x32_bf16 v[40:43], v[136:139], a[240:243], v[40:43]
s_nop 0
ds_read_b64_tr_b16 v[252:253], v11 offset:45056
ds_read_b64_tr_b16 v[254:255], v11 offset:47104
v_mfma_f32_16x16x32_bf16 v[40:43], v[152:155], a[244:247], v[40:43]
s_add_u32 s72, s71, 46080
buffer_load_dwordx4 v15, s[24:27], s72 offen offset:3072 lds
v_mfma_f32_16x16x32_bf16 v[40:43], v[168:171], a[248:251], v[40:43]
v_mfma_f32_16x16x32_bf16 v[40:43], v[184:187], a[252:255], v[40:43]
v_cvt_pk_bf16_f32 v24, v32, v33
v_cvt_pk_bf16_f32 v25, v34, v35
v_cvt_pk_bf16_f32 v26, v36, v37
v_mfma_f32_16x16x32_bf16 v[44:47], v[188:191], a[252:255], v[44:47]
v_cvt_pk_bf16_f32 v27, v38, v39
v_mfma_f32_16x16x32_bf16 v[44:47], v[172:175], a[248:251], v[44:47]
v_mfma_f32_16x16x32_bf16 v[44:47], v[156:159], a[244:247], v[44:47]
s_waitcnt vmcnt(26) lgkmcnt(0)
v_mfma_f32_16x16x32_bf16 v[44:47], v[140:143], a[240:243], v[44:47]
s_barrier
v_mfma_f32_16x16x32_bf16 v[48:51], v[192:195], a[160:163], v[48:51]
s_nop 0
ds_read_b64_tr_b16 v[128:129], v8 offset:49152
ds_read_b64_tr_b16 v[130:131], v8 offset:51200
v_mfma_f32_16x16x32_bf16 v[48:51], v[208:211], a[164:167], v[48:51]
s_xor_b32 s71, s13, 0x0
buffer_store_dwordx4 v[20:23], v1, s[44:47], s80 offen offset:1024 sc1
v_mfma_f32_16x16x32_bf16 v[48:51], v[224:227], a[168:171], v[48:51]
s_add_u32 m0, s77, 16384
ds_read_b64_tr_b16 v[132:133], v9 offset:49152
ds_read_b64_tr_b16 v[134:135], v9 offset:51200
v_mfma_f32_16x16x32_bf16 v[48:51], v[240:243], a[172:175], v[48:51]
s_add_u32 s72, s71, 0
buffer_load_dwordx4 v15, s[24:27], s72 offen lds
v_cvt_pk_bf16_f32 v28, v40, v41
v_mfma_f32_16x16x32_bf16 v[64:67], v[240:243], a[188:191], v[64:67]
s_nop 0
ds_read_b64_tr_b16 v[136:137], v10 offset:49152
ds_read_b64_tr_b16 v[138:139], v10 offset:51200
v_cvt_pk_bf16_f32 v29, v42, v43
v_mfma_f32_16x16x32_bf16 v[64:67], v[224:227], a[184:187], v[64:67]
s_nop 0
ds_read_b64_tr_b16 v[140:141], v11 offset:49152
ds_read_b64_tr_b16 v[142:143], v11 offset:51200
v_cvt_pk_bf16_f32 v30, v44, v45
v_mfma_f32_16x16x32_bf16 v[64:67], v[208:211], a[180:183], v[64:67]
v_cvt_pk_bf16_f32 v31, v46, v47
v_mfma_f32_16x16x32_bf16 v[64:67], v[192:195], a[176:179], v[64:67]
s_nop 0
ds_read_b64_tr_b16 v[144:145], v8 offset:53248
ds_read_b64_tr_b16 v[146:147], v8 offset:55296
v_mfma_f32_16x16x32_bf16 v[68:71], v[196:199], a[176:179], v[68:71]
s_add_u32 s72, s71, 15360
buffer_load_dwordx4 v15, s[24:27], s72 offen offset:1024 lds
v_mfma_f32_16x16x32_bf16 v[68:71], v[212:215], a[180:183], v[68:71]
s_nop 0
ds_read_b64_tr_b16 v[148:149], v9 offset:53248
ds_read_b64_tr_b16 v[150:151], v9 offset:55296
v_mfma_f32_16x16x32_bf16 v[68:71], v[228:231], a[184:187], v[68:71]
s_nop 0
ds_read_b64_tr_b16 v[152:153], v10 offset:53248
ds_read_b64_tr_b16 v[154:155], v10 offset:55296
v_mfma_f32_16x16x32_bf16 v[68:71], v[244:247], a[188:191], v[68:71]
v_mfma_f32_16x16x32_bf16 v[52:55], v[244:247], a[172:175], v[52:55]
s_nop 0
ds_read_b64_tr_b16 v[156:157], v11 offset:53248
ds_read_b64_tr_b16 v[158:159], v11 offset:55296
v_mfma_f32_16x16x32_bf16 v[52:55], v[228:231], a[168:171], v[52:55]
s_nop 0
ds_read_b64_tr_b16 v[160:161], v8 offset:57344
ds_read_b64_tr_b16 v[162:163], v8 offset:59392
v_mfma_f32_16x16x32_bf16 v[52:55], v[212:215], a[164:167], v[52:55]
s_add_u32 s72, s71, 30720
buffer_load_dwordx4 v15, s[24:27], s72 offen offset:2048 lds
v_mfma_f32_16x16x32_bf16 v[52:55], v[196:199], a[160:163], v[52:55]
s_nop 0
ds_read_b64_tr_b16 v[164:165], v9 offset:57344
ds_read_b64_tr_b16 v[166:167], v9 offset:59392
v_mfma_f32_16x16x32_bf16 v[56:59], v[200:203], a[160:163], v[56:59]
v_mfma_f32_16x16x32_bf16 v[56:59], v[216:219], a[164:167], v[56:59]
buffer_store_dwordx4 v[24:27], v1, s[44:47], s80 offen offset:2048 sc1
v_mfma_f32_16x16x32_bf16 v[56:59], v[232:235], a[168:171], v[56:59]
s_nop 0
ds_read_b64_tr_b16 v[168:169], v10 offset:57344
ds_read_b64_tr_b16 v[170:171], v10 offset:59392
v_mfma_f32_16x16x32_bf16 v[56:59], v[248:251], a[172:175], v[56:59]
s_nop 0
ds_read_b64_tr_b16 v[172:173], v11 offset:57344
ds_read_b64_tr_b16 v[174:175], v11 offset:59392
v_mfma_f32_16x16x32_bf16 v[72:75], v[248:251], a[188:191], v[72:75]
s_add_u32 s72, s71, 46080
buffer_load_dwordx4 v15, s[24:27], s72 offen offset:3072 lds
v_mfma_f32_16x16x32_bf16 v[72:75], v[232:235], a[184:187], v[72:75]
s_nop 0
ds_read_b64_tr_b16 v[176:177], v8 offset:61440
ds_read_b64_tr_b16 v[178:179], v8 offset:63488
v_mfma_f32_16x16x32_bf16 v[72:75], v[216:219], a[180:183], v[72:75]
v_mfma_f32_16x16x32_bf16 v[72:75], v[200:203], a[176:179], v[72:75]
s_nop 0
ds_read_b64_tr_b16 v[180:181], v9 offset:61440
ds_read_b64_tr_b16 v[182:183], v9 offset:63488
v_mfma_f32_16x16x32_bf16 v[76:79], v[204:207], a[176:179], v[76:79]
s_nop 0
ds_read_b64_tr_b16 v[184:185], v10 offset:61440
ds_read_b64_tr_b16 v[186:187], v10 offset:63488
v_mfma_f32_16x16x32_bf16 v[76:79], v[220:223], a[180:183], v[76:79]
s_nop 0
ds_read_b64_tr_b16 v[188:189], v11 offset:61440
ds_read_b64_tr_b16 v[190:191], v11 offset:63488
v_mfma_f32_16x16x32_bf16 v[76:79], v[236:239], a[184:187], v[76:79]
v_mfma_f32_16x16x32_bf16 v[76:79], v[252:255], a[188:191], v[76:79]
s_xor_b32 s71, s14, 0x0
v_mfma_f32_16x16x32_bf16 v[60:63], v[252:255], a[172:175], v[60:63]
s_add_u32 m0, s77, 32768
v_xor_b32 v8, 0x10000, v8
v_mfma_f32_16x16x32_bf16 v[60:63], v[236:239], a[168:171], v[60:63]
s_add_u32 s72, s71, 0
v_xor_b32 v9, 0x10000, v9
v_mfma_f32_16x16x32_bf16 v[60:63], v[220:223], a[164:167], v[60:63]
s_waitcnt lgkmcnt(0)
buffer_load_dwordx4 v15, s[24:27], s72 offen lds
v_xor_b32 v10, 0x10000, v10
v_mfma_f32_16x16x32_bf16 v[60:63], v[204:207], a[160:163], v[60:63]
v_xor_b32 v11, 0x10000, v11
v_mfma_f32_16x16x32_bf16 v[48:51], v[128:131], a[192:195], v[48:51]
s_nop 0
ds_read_b64_tr_b16 v[192:193], v8 offset:0
ds_read_b64_tr_b16 v[194:195], v8 offset:2048
v_mfma_f32_16x16x32_bf16 v[48:51], v[144:147], a[196:199], v[48:51]
buffer_store_dwordx4 v[28:31], v1, s[44:47], s80 offen offset:3072 sc1
v_mfma_f32_16x16x32_bf16 v[48:51], v[160:163], a[200:203], v[48:51]
s_nop 0
ds_read_b64_tr_b16 v[196:197], v9 offset:0
ds_read_b64_tr_b16 v[198:199], v9 offset:2048
v_mfma_f32_16x16x32_bf16 v[48:51], v[176:179], a[204:207], v[48:51]
s_add_u32 s72, s71, 15360
buffer_load_dwordx4 v15, s[24:27], s72 offen offset:1024 lds
v_mfma_f32_16x16x32_bf16 v[64:67], v[176:179], a[220:223], v[64:67]
s_nop 0
ds_read_b64_tr_b16 v[200:201], v10 offset:0
ds_read_b64_tr_b16 v[202:203], v10 offset:2048
v_mfma_f32_16x16x32_bf16 v[64:67], v[160:163], a[216:219], v[64:67]
v_mfma_f32_16x16x32_bf16 v[64:67], v[144:147], a[212:215], v[64:67]
s_nop 0
ds_read_b64_tr_b16 v[204:205], v11 offset:0
ds_read_b64_tr_b16 v[206:207], v11 offset:2048
v_mfma_f32_16x16x32_bf16 v[64:67], v[128:131], a[208:211], v[64:67]
s_nop 0
ds_read_b64_tr_b16 v[208:209], v8 offset:4096
ds_read_b64_tr_b16 v[210:211], v8 offset:6144
v_mfma_f32_16x16x32_bf16 v[68:71], v[132:135], a[208:211], v[68:71]
v_mfma_f32_16x16x32_bf16 v[68:71], v[148:151], a[212:215], v[68:71]
s_add_u32 s72, s71, 30720
buffer_load_dwordx4 v15, s[24:27], s72 offen offset:2048 lds
v_mfma_f32_16x16x32_bf16 v[68:71], v[164:167], a[216:219], v[68:71]
s_nop 0
ds_read_b64_tr_b16 v[212:213], v9 offset:4096
ds_read_b64_tr_b16 v[214:215], v9 offset:6144
v_mfma_f32_16x16x32_bf16 v[68:71], v[180:183], a[220:223], v[68:71]
s_nop 0
ds_read_b64_tr_b16 v[216:217], v10 offset:4096
ds_read_b64_tr_b16 v[218:219], v10 offset:6144
v_mfma_f32_16x16x32_bf16 v[52:55], v[180:183], a[204:207], v[52:55]
v_mfma_f32_16x16x32_bf16 v[52:55], v[164:167], a[200:203], v[52:55]
s_nop 0
ds_read_b64_tr_b16 v[220:221], v11 offset:4096
ds_read_b64_tr_b16 v[222:223], v11 offset:6144
v_mfma_f32_16x16x32_bf16 v[52:55], v[148:151], a[196:199], v[52:55]
s_nop 0
ds_read_b64_tr_b16 v[224:225], v8 offset:8192
ds_read_b64_tr_b16 v[226:227], v8 offset:10240
v_mfma_f32_16x16x32_bf16 v[52:55], v[132:135], a[192:195], v[52:55]
s_add_u32 s72, s71, 46080
buffer_load_dwordx4 v15, s[24:27], s72 offen offset:3072 lds
v_mfma_f32_16x16x32_bf16 v[56:59], v[136:139], a[192:195], v[56:59]
s_nop 0
ds_read_b64_tr_b16 v[228:229], v9 offset:8192
ds_read_b64_tr_b16 v[230:231], v9 offset:10240
v_mfma_f32_16x16x32_bf16 v[56:59], v[152:155], a[196:199], v[56:59]
v_mfma_f32_16x16x32_bf16 v[56:59], v[168:171], a[200:203], v[56:59]
s_nop 0
ds_read_b64_tr_b16 v[232:233], v10 offset:8192
ds_read_b64_tr_b16 v[234:235], v10 offset:10240
v_mfma_f32_16x16x32_bf16 v[56:59], v[184:187], a[204:207], v[56:59]
s_nop 0
ds_read_b64_tr_b16 v[236:237], v11 offset:8192
ds_read_b64_tr_b16 v[238:239], v11 offset:10240
v_mfma_f32_16x16x32_bf16 v[72:75], v[184:187], a[220:223], v[72:75]
Lstube3:
s_cbranch_execz Lrete
v_mfma_f32_16x16x32_bf16 v[72:75], v[168:171], a[216:219], v[72:75]
s_nop 0
ds_read_b64_tr_b16 v[240:241], v8 offset:12288
ds_read_b64_tr_b16 v[242:243], v8 offset:14336
v_mfma_f32_16x16x32_bf16 v[72:75], v[152:155], a[212:215], v[72:75]
s_nop 0
ds_read_b64_tr_b16 v[244:245], v9 offset:12288
ds_read_b64_tr_b16 v[246:247], v9 offset:14336
v_mfma_f32_16x16x32_bf16 v[72:75], v[136:139], a[208:211], v[72:75]
v_mfma_f32_16x16x32_bf16 v[76:79], v[140:143], a[208:211], v[76:79]
s_nop 0
ds_read_b64_tr_b16 v[248:249], v10 offset:12288
ds_read_b64_tr_b16 v[250:251], v10 offset:14336
v_mfma_f32_16x16x32_bf16 v[76:79], v[156:159], a[212:215], v[76:79]
s_nop 0
ds_read_b64_tr_b16 v[252:253], v11 offset:12288
ds_read_b64_tr_b16 v[254:255], v11 offset:14336
v_mfma_f32_16x16x32_bf16 v[76:79], v[172:175], a[216:219], v[76:79]
v_mfma_f32_16x16x32_bf16 v[76:79], v[188:191], a[220:223], v[76:79]
v_mfma_f32_16x16x32_bf16 v[60:63], v[188:191], a[204:207], v[60:63]
v_mfma_f32_16x16x32_bf16 v[60:63], v[172:175], a[200:203], v[60:63]
s_xor_b32 s71, s15, 0x0
v_mfma_f32_16x16x32_bf16 v[60:63], v[156:159], a[196:199], v[60:63]
s_waitcnt vmcnt(22) lgkmcnt(0)
v_mfma_f32_16x16x32_bf16 v[60:63], v[140:143], a[192:195], v[60:63]
s_barrier
v_mfma_f32_16x16x32_bf16 v[48:51], v[192:195], a[224:227], v[48:51]
s_add_u32 m0, s77, 49152
ds_read_b64_tr_b16 v[128:129], v8 offset:16384
ds_read_b64_tr_b16 v[130:131], v8 offset:18432
v_mfma_f32_16x16x32_bf16 v[48:51], v[208:211], a[228:231], v[48:51]
s_add_u32 s72, s71, 0
buffer_load_dwordx4 v15, s[24:27], s72 offen lds
v_mfma_f32_16x16x32_bf16 v[48:51], v[224:227], a[232:235], v[48:51]
s_nop 0
ds_read_b64_tr_b16 v[132:133], v9 offset:16384
ds_read_b64_tr_b16 v[134:135], v9 offset:18432
v_mfma_f32_16x16x32_bf16 v[48:51], v[240:243], a[236:239], v[48:51]
s_nop 0
ds_read_b64_tr_b16 v[136:137], v10 offset:16384
ds_read_b64_tr_b16 v[138:139], v10 offset:18432
v_mfma_f32_16x16x32_bf16 v[52:55], v[244:247], a[236:239], v[52:55]
s_nop 0
ds_read_b64_tr_b16 v[140:141], v11 offset:16384
ds_read_b64_tr_b16 v[142:143], v11 offset:18432
v_mfma_f32_16x16x32_bf16 v[52:55], v[228:231], a[232:235], v[52:55]
s_add_u32 s72, s71, 15360
buffer_load_dwordx4 v15, s[24:27], s72 offen offset:1024 lds
v_mfma_f32_16x16x32_bf16 v[52:55], v[212:215], a[228:231], v[52:55]
v_mfma_f32_16x16x32_bf16 v[52:55], v[196:199], a[224:227], v[52:55]
s_nop 0
ds_read_b64_tr_b16 v[144:145], v8 offset:20480
ds_read_b64_tr_b16 v[146:147], v8 offset:22528
v_mfma_f32_16x16x32_bf16 v[56:59], v[200:203], a[224:227], v[56:59]
s_nop 0
ds_read_b64_tr_b16 v[148:149], v9 offset:20480
ds_read_b64_tr_b16 v[150:151], v9 offset:22528
v_mfma_f32_16x16x32_bf16 v[56:59], v[216:219], a[228:231], v[56:59]
s_add_u32 s72, s71, 30720
buffer_load_dwordx4 v15, s[24:27], s72 offen offset:2048 lds
v_mfma_f32_16x16x32_bf16 v[56:59], v[232:235], a[232:235], v[56:59]
s_nop 0
ds_read_b64_tr_b16 v[152:153], v10 offset:20480
ds_read_b64_tr_b16 v[154:155], v10 offset:22528
v_mfma_f32_16x16x32_bf16 v[56:59], v[248:251], a[236:239], v[56:59]
s_nop 0
ds_read_b64_tr_b16 v[156:157], v11 offset:20480
ds_read_b64_tr_b16 v[158:159], v11 offset:22528
v_cvt_pk_bf16_f32 v48, v48, v49
v_mfma_f32_16x16x32_bf16 v[60:63], v[252:255], a[236:239], v[60:63]
v_cvt_pk_bf16_f32 v49, v50, v51
v_cvt_pk_bf16_f32 v50, v52, v53
v_cvt_pk_bf16_f32 v51, v54, v55
v_mfma_f32_16x16x32_bf16 v[60:63], v[236:239], a[232:235], v[60:63]
s_add_u32 s72, s71, 46080
buffer_load_dwordx4 v15, s[24:27], s72 offen offset:3072 lds
v_mfma_f32_16x16x32_bf16 v[60:63], v[220:223], a[228:231], v[60:63]
s_nop 0
ds_read_b64_tr_b16 v[160:161], v8 offset:24576
ds_read_b64_tr_b16 v[162:163], v8 offset:26624
v_mfma_f32_16x16x32_bf16 v[60:63], v[204:207], a[224:227], v[60:63]
s_nop 0
ds_read_b64_tr_b16 v[164:165], v9 offset:24576
ds_read_b64_tr_b16 v[166:167], v9 offset:26624
v_mfma_f32_16x16x32_bf16 v[64:67], v[192:195], a[240:243], v[64:67]
s_xor_b32 s80, s93, 0x200000
ds_read_b64_tr_b16 v[168:169], v10 offset:24576
ds_read_b64_tr_b16 v[170:171], v10 offset:26624
v_mfma_f32_16x16x32_bf16 v[64:67], v[208:211], a[244:247], v[64:67]
s_add_u32 s80, s80, 0x3e00000
buffer_store_dwordx4 v[48:51], v1, s[44:47], s80 offen sc1
v_mfma_f32_16x16x32_bf16 v[64:67], v[224:227], a[248:251], v[64:67]
s_nop 0
ds_read_b64_tr_b16 v[172:173], v11 offset:24576
ds_read_b64_tr_b16 v[174:175], v11 offset:26624
v_mfma_f32_16x16x32_bf16 v[64:67], v[240:243], a[252:255], v[64:67]
s_xor_b32 s71, s12, 0x40000
v_cvt_pk_bf16_f32 v52, v56, v57
v_cvt_pk_bf16_f32 v53, v58, v59
v_cvt_pk_bf16_f32 v54, v60, v61
v_mfma_f32_16x16x32_bf16 v[68:71], v[244:247], a[252:255], v[68:71]
s_add_u32 m0, s85, 0
ds_read_b64_tr_b16 v[176:177], v8 offset:28672
ds_read_b64_tr_b16 v[178:179], v8 offset:30720
v_cvt_pk_bf16_f32 v55, v62, v63
v_mfma_f32_16x16x32_bf16 v[68:71], v[228:231], a[248:251], v[68:71]
s_add_u32 s72, s71, 0
buffer_load_dwordx4 v15, s[24:27], s72 offen lds
v_mfma_f32_16x16x32_bf16 v[68:71], v[212:215], a[244:247], v[68:71]
s_nop 0
ds_read_b64_tr_b16 v[180:181], v9 offset:28672
ds_read_b64_tr_b16 v[182:183], v9 offset:30720
v_mfma_f32_16x16x32_bf16 v[68:71], v[196:199], a[240:243], v[68:71]
s_nop 0
ds_read_b64_tr_b16 v[184:185], v10 offset:28672
ds_read_b64_tr_b16 v[186:187], v10 offset:30720
v_mfma_f32_16x16x32_bf16 v[72:75], v[200:203], a[240:243], v[72:75]
s_nop 0
ds_read_b64_tr_b16 v[188:189], v11 offset:28672
ds_read_b64_tr_b16 v[190:191], v11 offset:30720
v_mfma_f32_16x16x32_bf16 v[72:75], v[216:219], a[244:247], v[72:75]
v_mfma_f32_16x16x32_bf16 v[72:75], v[232:235], a[248:251], v[72:75]
s_add_u32 s72, s71, 15360
buffer_load_dwordx4 v15, s[24:27], s72 offen offset:1024 lds
v_mfma_f32_16x16x32_bf16 v[72:75], v[248:251], a[252:255], v[72:75]
v_cvt_pk_bf16_f32 v56, v64, v65
v_cvt_pk_bf16_f32 v57, v66, v67
v_cvt_pk_bf16_f32 v58, v68, v69
v_mfma_f32_16x16x32_bf16 v[76:79], v[252:255], a[252:255], v[76:79]
v_cvt_pk_bf16_f32 v59, v70, v71
v_mfma_f32_16x16x32_bf16 v[76:79], v[236:239], a[248:251], v[76:79]
v_mfma_f32_16x16x32_bf16 v[76:79], v[220:223], a[244:247], v[76:79]
s_waitcnt lgkmcnt(0)
v_mfma_f32_16x16x32_bf16 v[76:79], v[204:207], a[240:243], v[76:79]
v_mfma_f32_16x16x32_bf16 v[80:83], v[128:131], a[160:163], v[80:83]
s_add_u32 s72, s71, 30720
buffer_load_dwordx4 v15, s[24:27], s72 offen offset:2048 lds
v_mfma_f32_16x16x32_bf16 v[80:83], v[144:147], a[164:167], v[80:83]
s_waitcnt vmcnt(23)
buffer_store_dwordx4 v[52:55], v1, s[44:47], s80 offen offset:1024 sc1
v_mfma_f32_16x16x32_bf16 v[80:83], v[160:163], a[168:171], v[80:83]
s_nop 0
ds_read_b64_tr_b16 v[192:193], v8 offset:32768
ds_read_b64_tr_b16 v[194:195], v8 offset:34816
v_mfma_f32_16x16x32_bf16 v[80:83], v[176:179], a[172:175], v[80:83]
s_nop 0
ds_read_b64_tr_b16 v[196:197], v9 offset:32768
ds_read_b64_tr_b16 v[198:199], v9 offset:34816
v_cvt_pk_bf16_f32 v60, v72, v73
v_mfma_f32_16x16x32_bf16 v[96:99], v[176:179], a[188:191], v[96:99]
s_nop 0
ds_read_b64_tr_b16 v[200:201], v10 offset:32768
ds_read_b64_tr_b16 v[202:203], v10 offset:34816
v_cvt_pk_bf16_f32 v61, v74, v75
v_mfma_f32_16x16x32_bf16 v[96:99], v[160:163], a[184:187], v[96:99]
v_cvt_pk_bf16_f32 v62, v76, v77
v_cvt_pk_bf16_f32 v63, v78, v79
v_mfma_f32_16x16x32_bf16 v[96:99], v[144:147], a[180:183], v[96:99]
s_add_u32 s72, s71, 46080
buffer_load_dwordx4 v15, s[24:27], s72 offen offset:3072 lds
v_mfma_f32_16x16x32_bf16 v[96:99], v[128:131], a[176:179], v[96:99]
s_nop 0
ds_read_b64_tr_b16 v[204:205], v11 offset:32768
ds_read_b64_tr_b16 v[206:207], v11 offset:34816
v_mfma_f32_16x16x32_bf16 v[100:103], v[132:135], a[176:179], v[100:103]
s_nop 0
ds_read_b64_tr_b16 v[208:209], v8 offset:36864
ds_read_b64_tr_b16 v[210:211], v8 offset:38912
v_mfma_f32_16x16x32_bf16 v[100:103], v[148:151], a[180:183], v[100:103]
v_sub_f32 v112, 1.0, v6
v_sub_f32 v113, 1.0, v7
v_mfma_f32_16x16x32_bf16 v[100:103], v[164:167], a[184:187], v[100:103]
s_nop 0
ds_read_b64_tr_b16 v[212:213], v9 offset:36864
ds_read_b64_tr_b16 v[214:215], v9 offset:38912
v_mfma_f32_16x16x32_bf16 v[100:103], v[180:183], a[188:191], v[100:103]
s_nop 0
ds_read_b64_tr_b16 v[216:217], v10 offset:36864
ds_read_b64_tr_b16 v[218:219], v10 offset:38912
v_mfma_f32_16x16x32_bf16 v[84:87], v[180:183], a[172:175], v[84:87]
v_mfma_f32_16x16x32_bf16 v[84:87], v[164:167], a[168:171], v[84:87]
s_nop 0
ds_read_b64_tr_b16 v[220:221], v11 offset:36864
ds_read_b64_tr_b16 v[222:223], v11 offset:38912
v_mfma_f32_16x16x32_bf16 v[84:87], v[148:151], a[164:167], v[84:87]
s_nop 0
ds_read_b64_tr_b16 v[224:225], v8 offset:40960
ds_read_b64_tr_b16 v[226:227], v8 offset:43008
v_mfma_f32_16x16x32_bf16 v[84:87], v[132:135], a[160:163], v[84:87]
s_nop 0
ds_read_b64_tr_b16 v[228:229], v9 offset:40960
ds_read_b64_tr_b16 v[230:231], v9 offset:43008
v_mfma_f32_16x16x32_bf16 v[88:91], v[136:139], a[160:163], v[88:91]
v_mfma_f32_16x16x32_bf16 v[88:91], v[152:155], a[164:167], v[88:91]
buffer_store_dwordx4 v[56:59], v1, s[44:47], s80 offen offset:2048 sc1
v_mfma_f32_16x16x32_bf16 v[88:91], v[168:171], a[168:171], v[88:91]
s_nop 0
ds_read_b64_tr_b16 v[232:233], v10 offset:40960
ds_read_b64_tr_b16 v[234:235], v10 offset:43008
v_mfma_f32_16x16x32_bf16 v[88:91], v[184:187], a[172:175], v[88:91]
s_nop 0
ds_read_b64_tr_b16 v[236:237], v11 offset:40960
ds_read_b64_tr_b16 v[238:239], v11 offset:43008
v_mfma_f32_16x16x32_bf16 v[104:107], v[184:187], a[188:191], v[104:107]
v_mfma_f32_16x16x32_bf16 v[104:107], v[168:171], a[184:187], v[104:107]
s_nop 0
ds_read_b64_tr_b16 v[240:241], v8 offset:45056
ds_read_b64_tr_b16 v[242:243], v8 offset:47104
v_mfma_f32_16x16x32_bf16 v[104:107], v[152:155], a[180:183], v[104:107]
s_nop 0
ds_read_b64_tr_b16 v[244:245], v9 offset:45056
ds_read_b64_tr_b16 v[246:247], v9 offset:47104
v_mfma_f32_16x16x32_bf16 v[104:107], v[136:139], a[176:179], v[104:107]
v_mfma_f32_16x16x32_bf16 v[108:111], v[140:143], a[176:179], v[108:111]
s_nop 0
ds_read_b64_tr_b16 v[248:249], v10 offset:45056
ds_read_b64_tr_b16 v[250:251], v10 offset:47104
v_mfma_f32_16x16x32_bf16 v[108:111], v[156:159], a[180:183], v[108:111]
s_nop 0
ds_read_b64_tr_b16 v[252:253], v11 offset:45056
ds_read_b64_tr_b16 v[254:255], v11 offset:47104
v_mfma_f32_16x16x32_bf16 v[108:111], v[172:175], a[184:187], v[108:111]
v_mfma_f32_16x16x32_bf16 v[108:111], v[188:191], a[188:191], v[108:111]
v_mfma_f32_16x16x32_bf16 v[92:95], v[188:191], a[172:175], v[92:95]
v_mfma_f32_16x16x32_bf16 v[92:95], v[172:175], a[168:171], v[92:95]
s_xor_b32 s71, s13, 0x40000
v_mfma_f32_16x16x32_bf16 v[92:95], v[156:159], a[164:167], v[92:95]
s_waitcnt vmcnt(22) lgkmcnt(0)
v_mfma_f32_16x16x32_bf16 v[92:95], v[140:143], a[160:163], v[92:95]
s_barrier
v_mfma_f32_16x16x32_bf16 v[80:83], v[192:195], a[192:195], v[80:83]
s_add_u32 m0, s85, 16384
ds_read_b64_tr_b16 v[128:129], v8 offset:49152
ds_read_b64_tr_b16 v[130:131], v8 offset:51200
v_mfma_f32_16x16x32_bf16 v[80:83], v[208:211], a[196:199], v[80:83]
s_add_u32 s72, s71, 0
buffer_load_dwordx4 v15, s[24:27], s72 offen lds
v_mfma_f32_16x16x32_bf16 v[80:83], v[224:227], a[200:203], v[80:83]
buffer_store_dwordx4 v[60:63], v1, s[44:47], s80 offen offset:3072 sc1
v_mfma_f32_16x16x32_bf16 v[80:83], v[240:243], a[204:207], v[80:83]
s_nop 0
ds_read_b64_tr_b16 v[132:133], v9 offset:49152
ds_read_b64_tr_b16 v[134:135], v9 offset:51200
v_mfma_f32_16x16x32_bf16 v[96:99], v[240:243], a[220:223], v[96:99]
s_add_u32 s72, s71, 15360
buffer_load_dwordx4 v15, s[24:27], s72 offen offset:1024 lds
v_mfma_f32_16x16x32_bf16 v[96:99], v[224:227], a[216:219], v[96:99]
s_nop 0
ds_read_b64_tr_b16 v[136:137], v10 offset:49152
ds_read_b64_tr_b16 v[138:139], v10 offset:51200
v_mfma_f32_16x16x32_bf16 v[96:99], v[208:211], a[212:215], v[96:99]
s_nop 0
ds_read_b64_tr_b16 v[140:141], v11 offset:49152
ds_read_b64_tr_b16 v[142:143], v11 offset:51200
v_mfma_f32_16x16x32_bf16 v[96:99], v[192:195], a[208:211], v[96:99]
s_add_u32 s72, s71, 30720
buffer_load_dwordx4 v15, s[24:27], s72 offen offset:2048 lds
v_mfma_f32_16x16x32_bf16 v[100:103], v[196:199], a[208:211], v[100:103]
s_nop 0
ds_read_b64_tr_b16 v[144:145], v8 offset:53248
ds_read_b64_tr_b16 v[146:147], v8 offset:55296
v_mfma_f32_16x16x32_bf16 v[100:103], v[212:215], a[212:215], v[100:103]
s_nop 0
ds_read_b64_tr_b16 v[148:149], v9 offset:53248
ds_read_b64_tr_b16 v[150:151], v9 offset:55296
v_mfma_f32_16x16x32_bf16 v[100:103], v[228:231], a[216:219], v[100:103]
s_add_u32 s72, s71, 46080
buffer_load_dwordx4 v15, s[24:27], s72 offen offset:3072 lds
v_mfma_f32_16x16x32_bf16 v[100:103], v[244:247], a[220:223], v[100:103]
s_xor_b32 s71, s14, 0x40000
ds_read_b64 v[48:49], v116 offset:0
ds_read_b64_tr_b16 v[64:65], v5 offset:0
v_mfma_f32_16x16x32_bf16 v[84:87], v[244:247], a[204:207], v[84:87]
s_add_u32 m0, s85, 32768
s_add_u32 s72, s71, 0
buffer_load_dwordx4 v15, s[24:27], s72 offen lds
v_mfma_f32_16x16x32_bf16 v[84:87], v[228:231], a[200:203], v[84:87]
s_nop 0
ds_read_b64_tr_b16 v[152:153], v10 offset:53248
ds_read_b64_tr_b16 v[154:155], v10 offset:55296
v_mfma_f32_16x16x32_bf16 v[84:87], v[212:215], a[196:199], v[84:87]
s_nop 0
ds_read_b64_tr_b16 v[156:157], v11 offset:53248
ds_read_b64_tr_b16 v[158:159], v11 offset:55296
v_mfma_f32_16x16x32_bf16 v[84:87], v[196:199], a[192:195], v[84:87]
s_nop 0
ds_read_b64_tr_b16 v[160:161], v8 offset:57344
ds_read_b64_tr_b16 v[162:163], v8 offset:59392
v_mfma_f32_16x16x32_bf16 v[88:91], v[200:203], a[192:195], v[88:91]
s_nop 0
ds_read_b64_tr_b16 v[164:165], v9 offset:57344
ds_read_b64_tr_b16 v[166:167], v9 offset:59392
v_mfma_f32_16x16x32_bf16 v[88:91], v[216:219], a[196:199], v[88:91]
s_add_u32 s72, s71, 15360
buffer_load_dwordx4 v15, s[24:27], s72 offen offset:1024 lds
v_mfma_f32_16x16x32_bf16 v[88:91], v[232:235], a[200:203], v[88:91]
s_nop 0
ds_read_b64_tr_b16 v[168:169], v10 offset:57344
ds_read_b64_tr_b16 v[170:171], v10 offset:59392
v_mfma_f32_16x16x32_bf16 v[88:91], v[248:251], a[204:207], v[88:91]
s_nop 0
ds_read_b64 v[50:51], v117 offset:0
ds_read_b64_tr_b16 v[66:67], v5 offset:4096
v_mfma_f32_16x16x32_bf16 v[104:107], v[248:251], a[220:223], v[104:107]
s_nop 0
ds_read_b64_tr_b16 v[172:173], v11 offset:57344
ds_read_b64_tr_b16 v[174:175], v11 offset:59392
v_mfma_f32_16x16x32_bf16 v[104:107], v[232:235], a[216:219], v[104:107]
s_nop 0
ds_read_b64_tr_b16 v[176:177], v8 offset:61440
ds_read_b64_tr_b16 v[178:179], v8 offset:63488
v_mfma_f32_16x16x32_bf16 v[104:107], v[216:219], a[212:215], v[104:107]
s_nop 0
ds_read_b64_tr_b16 v[180:181], v9 offset:61440
ds_read_b64_tr_b16 v[182:183], v9 offset:63488
v_mfma_f32_16x16x32_bf16 v[104:107], v[200:203], a[208:211], v[104:107]
s_add_u32 s72, s71, 30720
buffer_load_dwordx4 v15, s[24:27], s72 offen offset:2048 lds
v_mfma_f32_16x16x32_bf16 v[108:111], v[204:207], a[208:211], v[108:111]
s_nop 0
ds_read_b64_tr_b16 v[184:185], v10 offset:61440
ds_read_b64_tr_b16 v[186:187], v10 offset:63488
v_mfma_f32_16x16x32_bf16 v[108:111], v[220:223], a[212:215], v[108:111]
s_nop 0
ds_read_b64_tr_b16 v[188:189], v11 offset:61440
ds_read_b64_tr_b16 v[190:191], v11 offset:63488
v_mfma_f32_16x16x32_bf16 v[108:111], v[236:239], a[216:219], v[108:111]
s_nop 0
ds_read_b64 v[52:53], v118 offset:0
ds_read_b64_tr_b16 v[68:69], v5 offset:8192
v_mfma_f32_16x16x32_bf16 v[108:111], v[252:255], a[220:223], v[108:111]
s_nop 0
ds_read_b64 v[54:55], v119 offset:0
ds_read_b64_tr_b16 v[70:71], v5 offset:12288
v_mfma_f32_16x16x32_bf16 v[92:95], v[252:255], a[204:207], v[92:95]
v_xor_b32 v8, 0x10000, v8
v_xor_b32 v5, 16, v5
v_mfma_f32_16x16x32_bf16 v[92:95], v[236:239], a[200:203], v[92:95]
s_add_u32 s72, s71, 46080
buffer_load_dwordx4 v15, s[24:27], s72 offen offset:3072 lds
v_xor_b32 v9, 0x10000, v9
v_mfma_f32_16x16x32_bf16 v[92:95], v[220:223], a[196:199], v[92:95]
s_waitcnt lgkmcnt(0)
ds_read_b64 v[56:57], v116 offset:2048
v_xor_b32 v10, 0x10000, v10
v_mfma_f32_16x16x32_bf16 v[92:95], v[204:207], a[192:195], v[92:95]
ds_read_b64_tr_b16 v[72:73], v5 offset:0
v_xor_b32 v11, 0x10000, v11
v_mfma_f32_16x16x32_bf16 v[80:83], v[128:131], a[224:227], v[80:83]
s_nop 0
ds_read_b64_tr_b16 v[192:193], v8 offset:0
ds_read_b64_tr_b16 v[194:195], v8 offset:2048
v_mfma_f32_16x16x32_bf16 v[80:83], v[144:147], a[228:231], v[80:83]
s_nop 0
ds_read_b64_tr_b16 v[196:197], v9 offset:0
ds_read_b64_tr_b16 v[198:199], v9 offset:2048
v_mfma_f32_16x16x32_bf16 v[80:83], v[160:163], a[232:235], v[80:83]
s_nop 0
ds_read_b64 v[58:59], v117 offset:2048
ds_read_b64_tr_b16 v[74:75], v5 offset:4096
v_mfma_f32_16x16x32_bf16 v[80:83], v[176:179], a[236:239], v[80:83]
s_nop 0
ds_read_b64_tr_b16 v[200:201], v10 offset:0
ds_read_b64_tr_b16 v[202:203], v10 offset:2048
v_mfma_f32_16x16x32_bf16 v[84:87], v[180:183], a[236:239], v[84:87]
s_nop 0
ds_read_b64_tr_b16 v[204:205], v11 offset:0
ds_read_b64_tr_b16 v[206:207], v11 offset:2048
v_mfma_f32_16x16x32_bf16 v[84:87], v[164:167], a[232:235], v[84:87]
s_nop 0
ds_read_b64 v[60:61], v118 offset:2048
ds_read_b64_tr_b16 v[76:77], v5 offset:8192
v_mfma_f32_16x16x32_bf16 v[84:87], v[148:151], a[228:231], v[84:87]
s_nop 0
ds_read_b64_tr_b16 v[208:209], v8 offset:4096
ds_read_b64_tr_b16 v[210:211], v8 offset:6144
v_mfma_f32_16x16x32_bf16 v[84:87], v[132:135], a[224:227], v[84:87]
s_nop 0
ds_read_b64 v[62:63], v119 offset:2048
ds_read_b64_tr_b16 v[78:79], v5 offset:12288
v_mfma_f32_16x16x32_bf16 v[88:91], v[136:139], a[224:227], v[88:91]
s_nop 0
ds_read_b64_tr_b16 v[212:213], v9 offset:4096
ds_read_b64_tr_b16 v[214:215], v9 offset:6144
v_mfma_f32_16x16x32_bf16 v[88:91], v[152:155], a[228:231], v[88:91]
s_nop 0
ds_read_b64_tr_b16 v[216:217], v10 offset:4096
ds_read_b64_tr_b16 v[218:219], v10 offset:6144
v_mfma_f32_16x16x32_bf16 v[88:91], v[168:171], a[232:235], v[88:91]
v_mfma_f32_16x16x32_bf16 v[88:91], v[184:187], a[236:239], v[88:91]
s_nop 0
ds_read_b64_tr_b16 v[220:221], v11 offset:4096
ds_read_b64_tr_b16 v[222:223], v11 offset:6144
v_cvt_pk_bf16_f32 v80, v80, v81
v_mfma_f32_16x16x32_bf16 v[92:95], v[188:191], a[236:239], v[92:95]
v_cvt_pk_bf16_f32 v81, v82, v83
v_cvt_pk_bf16_f32 v82, v84, v85
v_cvt_pk_bf16_f32 v83, v86, v87
v_mfma_f32_16x16x32_bf16 v[92:95], v[172:175], a[232:235], v[92:95]
s_waitcnt lgkmcnt(6)
ds_read_b64_tr_b16 v[224:225], v8 offset:8192
ds_read_b64_tr_b16 v[226:227], v8 offset:10240
v_mfma_f32_16x16x32_bf16 v[92:95], v[156:159], a[228:231], v[92:95]
s_nop 0
ds_read_b64_tr_b16 v[228:229], v9 offset:8192
ds_read_b64_tr_b16 v[230:231], v9 offset:10240
v_mfma_f32_16x16x32_bf16 v[92:95], v[140:143], a[224:227], v[92:95]
v_and_b32 v114, 0xffff0000, v48
v_lshlrev_b32 v115, 16, v64
v_mfma_f32_16x16x32_bf16 v[96:99], v[128:131], a[240:243], v[96:99]
s_xor_b32 s80, s93, 0x300000
ds_read_b64_tr_b16 v[232:233], v10 offset:8192
ds_read_b64_tr_b16 v[234:235], v10 offset:10240
v_mfma_f32_16x16x32_bf16 v[96:99], v[144:147], a[244:247], v[96:99]
s_add_u32 s80, s80, 0x4200000
buffer_store_dwordx4 v[80:83], v1, s[44:47], s80 offen sc1
v_mfma_f32_16x16x32_bf16 v[96:99], v[160:163], a[248:251], v[96:99]
s_nop 0
ds_read_b64_tr_b16 v[236:237], v11 offset:8192
ds_read_b64_tr_b16 v[238:239], v11 offset:10240
v_mfma_f32_16x16x32_bf16 v[96:99], v[176:179], a[252:255], v[96:99]
v_cvt_pk_bf16_f32 v84, v88, v89
v_cvt_pk_bf16_f32 v85, v90, v91
v_cvt_pk_bf16_f32 v86, v92, v93
v_mfma_f32_16x16x32_bf16 v[100:103], v[180:183], a[252:255], v[100:103]
s_nop 0
ds_read_b64_tr_b16 v[240:241], v8 offset:12288
ds_read_b64_tr_b16 v[242:243], v8 offset:14336
v_cvt_pk_bf16_f32 v87, v94, v95
v_mfma_f32_16x16x32_bf16 v[100:103], v[164:167], a[248:251], v[100:103]
v_lshlrev_b32 v48, 16, v48
v_and_b32 v64, 0xffff0000, v64
v_mfma_f32_16x16x32_bf16 v[100:103], v[148:151], a[244:247], v[100:103]
s_nop 0
ds_read_b64_tr_b16 v[244:245], v9 offset:12288
ds_read_b64_tr_b16 v[246:247], v9 offset:14336
v_mfma_f32_16x16x32_bf16 v[100:103], v[132:135], a[240:243], v[100:103]
s_nop 0
ds_read_b64_tr_b16 v[248:249], v10 offset:12288
ds_read_b64_tr_b16 v[250:251], v10 offset:14336
v_mfma_f32_16x16x32_bf16 v[104:107], v[136:139], a[240:243], v[104:107]
v_mul_f32 v48, v48, v112
v_mul_f32 v114, v114, v112
v_mfma_f32_16x16x32_bf16 v[104:107], v[152:155], a[244:247], v[104:107]
s_nop 0
ds_read_b64_tr_b16 v[252:253], v11 offset:12288
ds_read_b64_tr_b16 v[254:255], v11 offset:14336
v_mfma_f32_16x16x32_bf16 v[104:107], v[168:171], a[248:251], v[104:107]
v_mul_f32 v48, v48, v115
v_mul_f32 v64, v64, v114
v_mfma_f32_16x16x32_bf16 v[104:107], v[184:187], a[252:255], v[104:107]
v_cvt_pk_bf16_f32 v88, v96, v97
v_cvt_pk_bf16_f32 v89, v98, v99
v_cvt_pk_bf16_f32 v90, v100, v101
v_mfma_f32_16x16x32_bf16 v[108:111], v[188:191], a[252:255], v[108:111]
v_cvt_pk_bf16_f32 v91, v102, v103
v_and_b32 v114, 0xffff0000, v49
v_mfma_f32_16x16x32_bf16 v[108:111], v[172:175], a[248:251], v[108:111]
s_xor_b32 s71, s15, 0x40000
v_lshlrev_b32 v115, 16, v65
v_lshlrev_b32 v49, 16, v49
v_mfma_f32_16x16x32_bf16 v[108:111], v[156:159], a[244:247], v[108:111]
s_waitcnt vmcnt(21) lgkmcnt(0)
v_and_b32 v65, 0xffff0000, v65
v_mul_f32 v49, v49, v112
v_mfma_f32_16x16x32_bf16 v[108:111], v[140:143], a[240:243], v[108:111]
s_barrier
v_mul_f32 v114, v114, v112
v_mul_f32 v49, v49, v115
v_mfma_f32_16x16x32_bf16 v[16:19], v[192:195], a[0:3], 0
s_add_u32 m0, s85, 49152
ds_read_b64_tr_b16 v[128:129], v8 offset:16384
ds_read_b64_tr_b16 v[130:131], v8 offset:18432
v_mfma_f32_16x16x32_bf16 v[16:19], v[208:211], a[4:7], v[16:19]
s_add_u32 s72, s71, 0
buffer_load_dwordx4 v15, s[24:27], s72 offen lds
v_mfma_f32_16x16x32_bf16 v[16:19], v[224:227], a[8:11], v[16:19]
buffer_store_dwordx4 v[84:87], v1, s[44:47], s80 offen offset:1024 sc1
v_mfma_f32_16x16x32_bf16 v[16:19], v[240:243], a[12:15], v[16:19]
s_nop 0
ds_read_b64_tr_b16 v[132:133], v9 offset:16384
ds_read_b64_tr_b16 v[134:135], v9 offset:18432
v_cvt_pk_bf16_f32 v92, v104, v105
v_mfma_f32_16x16x32_bf16 v[32:35], v[240:243], a[28:31], 0
s_add_u32 s72, s71, 15360
buffer_load_dwordx4 v15, s[24:27], s72 offen offset:1024 lds
v_cvt_pk_bf16_f32 v93, v106, v107
v_mfma_f32_16x16x32_bf16 v[32:35], v[224:227], a[24:27], v[32:35]
s_nop 0
ds_read_b64_tr_b16 v[136:137], v10 offset:16384
ds_read_b64_tr_b16 v[138:139], v10 offset:18432
v_cvt_pk_bf16_f32 v94, v108, v109
v_mfma_f32_16x16x32_bf16 v[32:35], v[208:211], a[20:23], v[32:35]
s_nop 0
ds_read_b64_tr_b16 v[140:141], v11 offset:16384
ds_read_b64_tr_b16 v[142:143], v11 offset:18432
v_cvt_pk_bf16_f32 v95, v110, v111
v_mfma_f32_16x16x32_bf16 v[32:35], v[192:195], a[16:19], v[32:35]
s_add_u32 s72, s71, 30720
buffer_load_dwordx4 v15, s[24:27], s72 offen offset:2048 lds
v_mfma_f32_16x16x32_bf16 v[36:39], v[196:199], a[16:19], 0
v_mul_f32 v65, v65, v114
v_and_b32 v114, 0xffff0000, v50
v_mfma_f32_16x16x32_bf16 v[36:39], v[212:215], a[20:23], v[36:39]
s_nop 0
ds_read_b64_tr_b16 v[144:145], v8 offset:20480
ds_read_b64_tr_b16 v[146:147], v8 offset:22528
v_mfma_f32_16x16x32_bf16 v[36:39], v[228:231], a[24:27], v[36:39]
s_add_u32 s72, s71, 46080
buffer_load_dwordx4 v15, s[24:27], s72 offen offset:3072 lds
v_mfma_f32_16x16x32_bf16 v[36:39], v[244:247], a[28:31], v[36:39]
s_nop 0
ds_read_b64_tr_b16 v[148:149], v9 offset:20480
ds_read_b64_tr_b16 v[150:151], v9 offset:22528
v_mfma_f32_16x16x32_bf16 v[20:23], v[244:247], a[12:15], 0
s_nop 0
ds_read_b64_tr_b16 v[152:153], v10 offset:20480
ds_read_b64_tr_b16 v[154:155], v10 offset:22528
v_mfma_f32_16x16x32_bf16 v[20:23], v[228:231], a[8:11], v[20:23]
v_lshlrev_b32 v115, 16, v66
v_lshlrev_b32 v50, 16, v50
v_mfma_f32_16x16x32_bf16 v[20:23], v[212:215], a[4:7], v[20:23]
s_nop 0
ds_read_b64_tr_b16 v[156:157], v11 offset:20480
ds_read_b64_tr_b16 v[158:159], v11 offset:22528
v_mfma_f32_16x16x32_bf16 v[20:23], v[196:199], a[0:3], v[20:23]
s_nop 0
ds_read_b64_tr_b16 v[160:161], v8 offset:24576
ds_read_b64_tr_b16 v[162:163], v8 offset:26624
v_mfma_f32_16x16x32_bf16 v[24:27], v[200:203], a[0:3], 0
s_nop 0
ds_read_b64_tr_b16 v[164:165], v9 offset:24576
ds_read_b64_tr_b16 v[166:167], v9 offset:26624
v_mfma_f32_16x16x32_bf16 v[24:27], v[216:219], a[4:7], v[24:27]
v_and_b32 v66, 0xffff0000, v66
v_mul_f32 v50, v50, v112
v_mfma_f32_16x16x32_bf16 v[24:27], v[232:235], a[8:11], v[24:27]
buffer_store_dwordx4 v[88:91], v1, s[44:47], s80 offen offset:2048 sc1
v_mfma_f32_16x16x32_bf16 v[24:27], v[248:251], a[12:15], v[24:27]
s_nop 0
ds_read_b64_tr_b16 v[168:169], v10 offset:24576
ds_read_b64_tr_b16 v[170:171], v10 offset:26624
v_mfma_f32_16x16x32_bf16 v[40:43], v[248:251], a[28:31], 0
s_nop 0
ds_read_b64_tr_b16 v[172:173], v11 offset:24576
ds_read_b64_tr_b16 v[174:175], v11 offset:26624
v_mfma_f32_16x16x32_bf16 v[40:43], v[232:235], a[24:27], v[40:43]
s_nop 0
ds_read_b64_tr_b16 v[176:177], v8 offset:28672
ds_read_b64_tr_b16 v[178:179], v8 offset:30720
v_mfma_f32_16x16x32_bf16 v[40:43], v[216:219], a[20:23], v[40:43]
v_mul_f32 v114, v114, v112
v_mul_f32 v50, v50, v115
v_mfma_f32_16x16x32_bf16 v[40:43], v[200:203], a[16:19], v[40:43]
s_nop 0
ds_read_b64_tr_b16 v[180:181], v9 offset:28672
ds_read_b64_tr_b16 v[182:183], v9 offset:30720
v_mfma_f32_16x16x32_bf16 v[44:47], v[204:207], a[16:19], 0
s_nop 0
ds_read_b64_tr_b16 v[184:185], v10 offset:28672
ds_read_b64_tr_b16 v[186:187], v10 offset:30720
v_mfma_f32_16x16x32_bf16 v[44:47], v[220:223], a[20:23], v[44:47]
s_nop 0
ds_read_b64_tr_b16 v[188:189], v11 offset:28672
ds_read_b64_tr_b16 v[190:191], v11 offset:30720
v_mfma_f32_16x16x32_bf16 v[44:47], v[236:239], a[24:27], v[44:47]
Lstube4:
s_cbranch_execz Lrete
v_mul_f32 v66, v66, v114
v_and_b32 v114, 0xffff0000, v51
v_mfma_f32_16x16x32_bf16 v[44:47], v[252:255], a[28:31], v[44:47]
v_lshlrev_b32 v115, 16, v67
v_lshlrev_b32 v51, 16, v51
v_mfma_f32_16x16x32_bf16 v[28:31], v[252:255], a[12:15], 0
v_and_b32 v67, 0xffff0000, v67
v_mul_f32 v51, v51, v112
v_mfma_f32_16x16x32_bf16 v[28:31], v[236:239], a[8:11], v[28:31]
v_mul_f32 v114, v114, v112
v_mul_f32 v51, v51, v115
v_mfma_f32_16x16x32_bf16 v[28:31], v[220:223], a[4:7], v[28:31]
s_waitcnt lgkmcnt(0)
v_mul_f32 v67, v67, v114
v_and_b32 v114, 0xffff0000, v52
v_mfma_f32_16x16x32_bf16 v[28:31], v[204:207], a[0:3], v[28:31]
v_lshlrev_b32 v115, 16, v68
v_lshlrev_b32 v52, 16, v52
v_mfma_f32_16x16x32_bf16 v[16:19], v[128:131], a[32:35], v[16:19]
s_nop 0
ds_read_b64_tr_b16 v[192:193], v8 offset:32768
ds_read_b64_tr_b16 v[194:195], v8 offset:34816
v_mfma_f32_16x16x32_bf16 v[16:19], v[144:147], a[36:39], v[16:19]
s_nop 0
ds_read_b64_tr_b16 v[196:197], v9 offset:32768
ds_read_b64_tr_b16 v[198:199], v9 offset:34816
v_mfma_f32_16x16x32_bf16 v[16:19], v[160:163], a[40:43], v[16:19]
buffer_store_dwordx4 v[92:95], v1, s[44:47], s80 offen offset:3072 sc1
v_mfma_f32_16x16x32_bf16 v[16:19], v[176:179], a[44:47], v[16:19]
v_and_b32 v68, 0xffff0000, v68
v_mul_f32 v52, v52, v112
v_mfma_f32_16x16x32_bf16 v[32:35], v[176:179], a[60:63], v[32:35]
s_nop 0
ds_read_b64_tr_b16 v[200:201], v10 offset:32768
ds_read_b64_tr_b16 v[202:203], v10 offset:34816
v_mfma_f32_16x16x32_bf16 v[32:35], v[160:163], a[56:59], v[32:35]
s_nop 0
ds_read_b64_tr_b16 v[204:205], v11 offset:32768
ds_read_b64_tr_b16 v[206:207], v11 offset:34816
v_mfma_f32_16x16x32_bf16 v[32:35], v[144:147], a[52:55], v[32:35]
v_mul_f32 v114, v114, v112
v_mul_f32 v52, v52, v115
v_mfma_f32_16x16x32_bf16 v[32:35], v[128:131], a[48:51], v[32:35]
s_nop 0
ds_read_b64_tr_b16 v[208:209], v8 offset:36864
ds_read_b64_tr_b16 v[210:211], v8 offset:38912
v_mfma_f32_16x16x32_bf16 v[36:39], v[132:135], a[48:51], v[36:39]
v_mul_f32 v68, v68, v114
v_and_b32 v114, 0xffff0000, v53
v_mfma_f32_16x16x32_bf16 v[36:39], v[148:151], a[52:55], v[36:39]
s_nop 0
ds_read_b64_tr_b16 v[212:213], v9 offset:36864
ds_read_b64_tr_b16 v[214:215], v9 offset:38912
v_mfma_f32_16x16x32_bf16 v[36:39], v[164:167], a[56:59], v[36:39]
s_nop 0
ds_read_b64_tr_b16 v[216:217], v10 offset:36864
ds_read_b64_tr_b16 v[218:219], v10 offset:38912
v_mfma_f32_16x16x32_bf16 v[36:39], v[180:183], a[60:63], v[36:39]
v_lshlrev_b32 v115, 16, v69
v_lshlrev_b32 v53, 16, v53
v_mfma_f32_16x16x32_bf16 v[20:23], v[180:183], a[44:47], v[20:23]
s_nop 0
ds_read_b64_tr_b16 v[220:221], v11 offset:36864
ds_read_b64_tr_b16 v[222:223], v11 offset:38912
v_mfma_f32_16x16x32_bf16 v[20:23], v[164:167], a[40:43], v[20:23]
v_and_b32 v69, 0xffff0000, v69
v_mul_f32 v53, v53, v112
v_mfma_f32_16x16x32_bf16 v[20:23], v[148:151], a[36:39], v[20:23]
s_nop 0
ds_read_b64_tr_b16 v[224:225], v8 offset:40960
ds_read_b64_tr_b16 v[226:227], v8 offset:43008
v_mfma_f32_16x16x32_bf16 v[20:23], v[132:135], a[32:35], v[20:23]
s_nop 0
ds_read_b64_tr_b16 v[228:229], v9 offset:40960
ds_read_b64_tr_b16 v[230:231], v9 offset:43008
v_mfma_f32_16x16x32_bf16 v[24:27], v[136:139], a[32:35], v[24:27]
v_mul_f32 v114, v114, v112
v_mul_f32 v53, v53, v115
v_mfma_f32_16x16x32_bf16 v[24:27], v[152:155], a[36:39], v[24:27]
s_nop 0
ds_read_b64_tr_b16 v[232:233], v10 offset:40960
ds_read_b64_tr_b16 v[234:235], v10 offset:43008
v_mfma_f32_16x16x32_bf16 v[24:27], v[168:171], a[40:43], v[24:27]
s_nop 0
ds_read_b64_tr_b16 v[236:237], v11 offset:40960
ds_read_b64_tr_b16 v[238:239], v11 offset:43008
v_mfma_f32_16x16x32_bf16 v[24:27], v[184:187], a[44:47], v[24:27]
v_mul_f32 v69, v69, v114
v_and_b32 v114, 0xffff0000, v54
v_mfma_f32_16x16x32_bf16 v[40:43], v[184:187], a[60:63], v[40:43]
s_nop 0
ds_read_b64_tr_b16 v[240:241], v8 offset:45056
ds_read_b64_tr_b16 v[242:243], v8 offset:47104
v_mfma_f32_16x16x32_bf16 v[40:43], v[168:171], a[56:59], v[40:43]
v_lshlrev_b32 v115, 16, v70
v_lshlrev_b32 v54, 16, v54
v_mfma_f32_16x16x32_bf16 v[40:43], v[152:155], a[52:55], v[40:43]
s_nop 0
ds_read_b64_tr_b16 v[244:245], v9 offset:45056
ds_read_b64_tr_b16 v[246:247], v9 offset:47104
v_mfma_f32_16x16x32_bf16 v[40:43], v[136:139], a[48:51], v[40:43]
s_nop 0
ds_read_b64_tr_b16 v[248:249], v10 offset:45056
ds_read_b64_tr_b16 v[250:251], v10 offset:47104
v_mfma_f32_16x16x32_bf16 v[44:47], v[140:143], a[48:51], v[44:47]
v_and_b32 v70, 0xffff0000, v70
v_mul_f32 v54, v54, v112
v_mfma_f32_16x16x32_bf16 v[44:47], v[156:159], a[52:55], v[44:47]
s_nop 0
ds_read_b64_tr_b16 v[252:253], v11 offset:45056
ds_read_b64_tr_b16 v[254:255], v11 offset:47104
v_mfma_f32_16x16x32_bf16 v[44:47], v[172:175], a[56:59], v[44:47]
v_mul_f32 v114, v114, v112
v_mul_f32 v54, v54, v115
v_mfma_f32_16x16x32_bf16 v[44:47], v[188:191], a[60:63], v[44:47]
v_mul_f32 v70, v70, v114
v_and_b32 v114, 0xffff0000, v55
v_mfma_f32_16x16x32_bf16 v[28:31], v[188:191], a[44:47], v[28:31]
v_lshlrev_b32 v115, 16, v71
v_lshlrev_b32 v55, 16, v55
v_mfma_f32_16x16x32_bf16 v[28:31], v[172:175], a[40:43], v[28:31]
s_add_u32 s79, s93, 0x3a00000
v_and_b32 v71, 0xffff0000, v71
v_mul_f32 v55, v55, v112
v_mfma_f32_16x16x32_bf16 v[28:31], v[156:159], a[36:39], v[28:31]
s_waitcnt vmcnt(18) lgkmcnt(0)
buffer_load_dwordx4 v[96:99], v1, s[44:47], s79 offen sc1
v_mfma_f32_16x16x32_bf16 v[28:31], v[140:143], a[32:35], v[28:31]
s_barrier
v_mul_f32 v114, v114, v112
v_mul_f32 v55, v55, v115
v_mfma_f32_16x16x32_bf16 v[16:19], v[192:195], a[64:67], v[16:19]
s_nop 0
ds_read_b64_tr_b16 v[128:129], v8 offset:49152
ds_read_b64_tr_b16 v[130:131], v8 offset:51200
v_mfma_f32_16x16x32_bf16 v[16:19], v[208:211], a[68:71], v[16:19]
s_nop 0
ds_read_b64_tr_b16 v[132:133], v9 offset:49152
ds_read_b64_tr_b16 v[134:135], v9 offset:51200
v_mfma_f32_16x16x32_bf16 v[16:19], v[224:227], a[72:75], v[16:19]
v_mul_f32 v71, v71, v114
v_and_b32 v114, 0xffff0000, v56
v_mfma_f32_16x16x32_bf16 v[16:19], v[240:243], a[76:79], v[16:19]
buffer_load_dwordx4 v[100:103], v1, s[44:47], s79 offen offset:1024 sc1
v_mfma_f32_16x16x32_bf16 v[32:35], v[240:243], a[92:95], v[32:35]
s_nop 0
ds_read_b64_tr_b16 v[136:137], v10 offset:49152
ds_read_b64_tr_b16 v[138:139], v10 offset:51200
v_mfma_f32_16x16x32_bf16 v[32:35], v[224:227], a[88:91], v[32:35]
s_nop 0
ds_read_b64_tr_b16 v[140:141], v11 offset:49152
ds_read_b64_tr_b16 v[142:143], v11 offset:51200
v_mfma_f32_16x16x32_bf16 v[32:35], v[208:211], a[84:87], v[32:35]
v_lshlrev_b32 v115, 16, v72
v_lshlrev_b32 v56, 16, v56
v_mfma_f32_16x16x32_bf16 v[32:35], v[192:195], a[80:83], v[32:35]
s_nop 0
ds_read_b64_tr_b16 v[144:145], v8 offset:53248
ds_read_b64_tr_b16 v[146:147], v8 offset:55296
v_mfma_f32_16x16x32_bf16 v[36:39], v[196:199], a[80:83], v[36:39]
buffer_load_dwordx4 v[104:107], v1, s[44:47], s79 offen offset:2048 sc1
v_mfma_f32_16x16x32_bf16 v[36:39], v[212:215], a[84:87], v[36:39]
s_nop 0
ds_read_b64_tr_b16 v[148:149], v9 offset:53248
ds_read_b64_tr_b16 v[150:151], v9 offset:55296
v_mfma_f32_16x16x32_bf16 v[36:39], v[228:231], a[88:91], v[36:39]
v_and_b32 v72, 0xffff0000, v72
v_mul_f32 v56, v56, v113
v_mfma_f32_16x16x32_bf16 v[36:39], v[244:247], a[92:95], v[36:39]
s_nop 0
ds_read_b64_tr_b16 v[152:153], v10 offset:53248
ds_read_b64_tr_b16 v[154:155], v10 offset:55296
v_mfma_f32_16x16x32_bf16 v[20:23], v[244:247], a[76:79], v[20:23]
s_nop 0
ds_read_b64_tr_b16 v[156:157], v11 offset:53248
ds_read_b64_tr_b16 v[158:159], v11 offset:55296
v_mfma_f32_16x16x32_bf16 v[20:23], v[228:231], a[72:75], v[20:23]
buffer_load_dwordx4 v[108:111], v1, s[44:47], s79 offen offset:3072 sc1
v_mfma_f32_16x16x32_bf16 v[20:23], v[212:215], a[68:71], v[20:23]
v_mul_f32 v114, v114, v113
v_mul_f32 v56, v56, v115
v_mfma_f32_16x16x32_bf16 v[20:23], v[196:199], a[64:67], v[20:23]
s_nop 0
ds_read_b64_tr_b16 v[160:161], v8 offset:57344
ds_read_b64_tr_b16 v[162:163], v8 offset:59392
v_mfma_f32_16x16x32_bf16 v[24:27], v[200:203], a[64:67], v[24:27]
s_nop 0
ds_read_b64_tr_b16 v[164:165], v9 offset:57344
ds_read_b64_tr_b16 v[166:167], v9 offset:59392
v_mfma_f32_16x16x32_bf16 v[24:27], v[216:219], a[68:71], v[24:27]
v_mul_f32 v72, v72, v114
v_and_b32 v114, 0xffff0000, v57
v_mfma_f32_16x16x32_bf16 v[24:27], v[232:235], a[72:75], v[24:27]
s_nop 0
ds_read_b64_tr_b16 v[168:169], v10 offset:57344
ds_read_b64_tr_b16 v[170:171], v10 offset:59392
v_mfma_f32_16x16x32_bf16 v[24:27], v[248:251], a[76:79], v[24:27]
s_nop 0
ds_read_b64_tr_b16 v[172:173], v11 offset:57344
ds_read_b64_tr_b16 v[174:175], v11 offset:59392
v_mfma_f32_16x16x32_bf16 v[40:43], v[248:251], a[92:95], v[40:43]
v_lshlrev_b32 v115, 16, v73
v_lshlrev_b32 v57, 16, v57
v_mfma_f32_16x16x32_bf16 v[40:43], v[232:235], a[88:91], v[40:43]
s_nop 0
ds_read_b64_tr_b16 v[176:177], v8 offset:61440
ds_read_b64_tr_b16 v[178:179], v8 offset:63488
v_mfma_f32_16x16x32_bf16 v[40:43], v[216:219], a[84:87], v[40:43]
s_nop 0
ds_read_b64_tr_b16 v[180:181], v9 offset:61440
ds_read_b64_tr_b16 v[182:183], v9 offset:63488
v_mfma_f32_16x16x32_bf16 v[40:43], v[200:203], a[80:83], v[40:43]
v_and_b32 v73, 0xffff0000, v73
v_mul_f32 v57, v57, v113
v_mfma_f32_16x16x32_bf16 v[44:47], v[204:207], a[80:83], v[44:47]
s_nop 0
ds_read_b64_tr_b16 v[184:185], v10 offset:61440
ds_read_b64_tr_b16 v[186:187], v10 offset:63488
v_mfma_f32_16x16x32_bf16 v[44:47], v[220:223], a[84:87], v[44:47]
s_nop 0
ds_read_b64_tr_b16 v[188:189], v11 offset:61440
ds_read_b64_tr_b16 v[190:191], v11 offset:63488
v_mfma_f32_16x16x32_bf16 v[44:47], v[236:239], a[88:91], v[44:47]
v_mul_f32 v114, v114, v113
v_mul_f32 v57, v57, v115
v_mfma_f32_16x16x32_bf16 v[44:47], v[252:255], a[92:95], v[44:47]
v_mul_f32 v73, v73, v114
v_and_b32 v114, 0xffff0000, v58
v_mfma_f32_16x16x32_bf16 v[28:31], v[252:255], a[76:79], v[28:31]
v_xor_b32 v8, 0x10000, v8
v_lshlrev_b32 v115, 16, v74
v_mfma_f32_16x16x32_bf16 v[28:31], v[236:239], a[72:75], v[28:31]
v_xor_b32 v9, 0x10000, v9
v_lshlrev_b32 v58, 16, v58
v_mfma_f32_16x16x32_bf16 v[28:31], v[220:223], a[68:71], v[28:31]
s_waitcnt lgkmcnt(0)
v_xor_b32 v10, 0x10000, v10
v_and_b32 v74, 0xffff0000, v74
v_mfma_f32_16x16x32_bf16 v[28:31], v[204:207], a[64:67], v[28:31]
v_xor_b32 v11, 0x10000, v11
v_mul_f32 v58, v58, v113
v_mfma_f32_16x16x32_bf16 v[16:19], v[128:131], a[96:99], v[16:19]
s_nop 0
ds_read_b64_tr_b16 v[192:193], v8 offset:0
ds_read_b64_tr_b16 v[194:195], v8 offset:2048
v_mfma_f32_16x16x32_bf16 v[16:19], v[144:147], a[100:103], v[16:19]
s_nop 0
ds_read_b64_tr_b16 v[196:197], v9 offset:0
ds_read_b64_tr_b16 v[198:199], v9 offset:2048
v_mfma_f32_16x16x32_bf16 v[16:19], v[160:163], a[104:107], v[16:19]
v_mul_f32 v114, v114, v113
v_mul_f32 v58, v58, v115
v_mfma_f32_16x16x32_bf16 v[16:19], v[176:179], a[108:111], v[16:19]
s_nop 0
ds_read_b64_tr_b16 v[200:201], v10 offset:0
ds_read_b64_tr_b16 v[202:203], v10 offset:2048
v_mfma_f32_16x16x32_bf16 v[32:35], v[176:179], a[124:127], v[32:35]
v_mul_f32 v74, v74, v114
v_and_b32 v114, 0xffff0000, v59
v_mfma_f32_16x16x32_bf16 v[32:35], v[160:163], a[120:123], v[32:35]
s_nop 0
ds_read_b64_tr_b16 v[204:205], v11 offset:0
ds_read_b64_tr_b16 v[206:207], v11 offset:2048
v_mfma_f32_16x16x32_bf16 v[32:35], v[144:147], a[116:119], v[32:35]
s_nop 0
ds_read_b64_tr_b16 v[208:209], v8 offset:4096
ds_read_b64_tr_b16 v[210:211], v8 offset:6144
v_mfma_f32_16x16x32_bf16 v[32:35], v[128:131], a[112:115], v[32:35]
v_lshlrev_b32 v115, 16, v75
v_lshlrev_b32 v59, 16, v59
v_mfma_f32_16x16x32_bf16 v[36:39], v[132:135], a[112:115], v[36:39]
s_nop 0
ds_read_b64_tr_b16 v[212:213], v9 offset:4096
ds_read_b64_tr_b16 v[214:215], v9 offset:6144
v_mfma_f32_16x16x32_bf16 v[36:39], v[148:151], a[116:119], v[36:39]
v_and_b32 v75, 0xffff0000, v75
v_mul_f32 v59, v59, v113
v_mfma_f32_16x16x32_bf16 v[36:39], v[164:167], a[120:123], v[36:39]
s_nop 0
ds_read_b64_tr_b16 v[216:217], v10 offset:4096
ds_read_b64_tr_b16 v[218:219], v10 offset:6144
v_mfma_f32_16x16x32_bf16 v[36:39], v[180:183], a[124:127], v[36:39]
s_nop 0
ds_read_b64_tr_b16 v[220:221], v11 offset:4096
ds_read_b64_tr_b16 v[222:223], v11 offset:6144
v_mfma_f32_16x16x32_bf16 v[20:23], v[180:183], a[108:111], v[20:23]
v_mul_f32 v114, v114, v113
v_mul_f32 v59, v59, v115
v_mfma_f32_16x16x32_bf16 v[20:23], v[164:167], a[104:107], v[20:23]
s_nop 0
ds_read_b64_tr_b16 v[224:225], v8 offset:8192
ds_read_b64_tr_b16 v[226:227], v8 offset:10240
v_mfma_f32_16x16x32_bf16 v[20:23], v[148:151], a[100:103], v[20:23]
v_mul_f32 v75, v75, v114
v_and_b32 v114, 0xffff0000, v60
v_mfma_f32_16x16x32_bf16 v[20:23], v[132:135], a[96:99], v[20:23]
s_nop 0
ds_read_b64_tr_b16 v[228:229], v9 offset:8192
ds_read_b64_tr_b16 v[230:231], v9 offset:10240
v_mfma_f32_16x16x32_bf16 v[24:27], v[136:139], a[96:99], v[24:27]
s_nop 0
ds_read_b64_tr_b16 v[232:233], v10 offset:8192
ds_read_b64_tr_b16 v[234:235], v10 offset:10240
v_mfma_f32_16x16x32_bf16 v[24:27], v[152:155], a[100:103], v[24:27]
v_lshlrev_b32 v115, 16, v76
v_lshlrev_b32 v60, 16, v60
v_mfma_f32_16x16x32_bf16 v[24:27], v[168:171], a[104:107], v[24:27]
s_nop 0
ds_read_b64_tr_b16 v[236:237], v11 offset:8192
ds_read_b64_tr_b16 v[238:239], v11 offset:10240
v_mfma_f32_16x16x32_bf16 v[24:27], v[184:187], a[108:111], v[24:27]
v_and_b32 v76, 0xffff0000, v76
v_mul_f32 v60, v60, v113
v_mfma_f32_16x16x32_bf16 v[40:43], v[184:187], a[124:127], v[40:43]
s_nop 0
ds_read_b64_tr_b16 v[240:241], v8 offset:12288
ds_read_b64_tr_b16 v[242:243], v8 offset:14336
v_mfma_f32_16x16x32_bf16 v[40:43], v[168:171], a[120:123], v[40:43]
s_nop 0
ds_read_b64_tr_b16 v[244:245], v9 offset:12288
ds_read_b64_tr_b16 v[246:247], v9 offset:14336
v_mfma_f32_16x16x32_bf16 v[40:43], v[152:155], a[116:119], v[40:43]
v_mul_f32 v114, v114, v113
v_mul_f32 v60, v60, v115
v_mfma_f32_16x16x32_bf16 v[40:43], v[136:139], a[112:115], v[40:43]
s_nop 0
ds_read_b64_tr_b16 v[248:249], v10 offset:12288
ds_read_b64_tr_b16 v[250:251], v10 offset:14336
v_mfma_f32_16x16x32_bf16 v[44:47], v[140:143], a[112:115], v[44:47]
v_mul_f32 v76, v76, v114
v_and_b32 v114, 0xffff0000, v61
v_mfma_f32_16x16x32_bf16 v[44:47], v[156:159], a[116:119], v[44:47]
s_nop 0
ds_read_b64_tr_b16 v[252:253], v11 offset:12288
ds_read_b64_tr_b16 v[254:255], v11 offset:14336
v_mfma_f32_16x16x32_bf16 v[44:47], v[172:175], a[120:123], v[44:47]
v_lshlrev_b32 v115, 16, v77
v_lshlrev_b32 v61, 16, v61
v_mfma_f32_16x16x32_bf16 v[44:47], v[188:191], a[124:127], v[44:47]
s_waitcnt vmcnt(0)
v_max3_u32 v12, v96, v97, v98
v_max3_u32 v13, v99, v100, v101
v_mfma_f32_16x16x32_bf16 v[28:31], v[188:191], a[108:111], v[28:31]
v_max3_u32 v12, v12, v102, v103
v_max3_u32 v13, v13, v104, v105
v_mfma_f32_16x16x32_bf16 v[28:31], v[172:175], a[104:107], v[28:31]
v_max3_u32 v12, v12, v106, v107
v_max3_u32 v13, v13, v108, v109
v_mfma_f32_16x16x32_bf16 v[28:31], v[156:159], a[100:103], v[28:31]
s_waitcnt vmcnt(12) lgkmcnt(0)
v_max3_u32 v12, v12, v110, v111
v_and_b32 v77, 0xffff0000, v77
v_mfma_f32_16x16x32_bf16 v[28:31], v[140:143], a[96:99], v[28:31]
s_barrier
v_max_u32 v12, v12, v13
v_mul_f32 v61, v61, v113
v_mfma_f32_16x16x32_bf16 v[16:19], v[192:195], a[128:131], v[16:19]
v_cmp_le_u32 vcc, 0xff800000, v12
v_mul_f32 v114, v114, v113
v_mfma_f32_16x16x32_bf16 v[16:19], v[208:211], a[132:135], v[16:19]
s_nop 0
ds_read_b64_tr_b16 v[128:129], v8 offset:16384
ds_read_b64_tr_b16 v[130:131], v8 offset:18432
v_mfma_f32_16x16x32_bf16 v[16:19], v[224:227], a[136:139], v[16:19]
s_cbranch_vccnz Lxspin1
Lxback1:
ds_read_b64_tr_b16 v[132:133], v9 offset:16384
ds_read_b64_tr_b16 v[134:135], v9 offset:18432
v_mfma_f32_16x16x32_bf16 v[16:19], v[240:243], a[140:143], v[16:19]
v_mul_f32 v61, v61, v115
v_mul_f32 v77, v77, v114
v_mfma_f32_16x16x32_bf16 v[16:19], v[124:127], v[96:99], v[16:19]
s_nop 0
ds_read_b64_tr_b16 v[136:137], v10 offset:16384
ds_read_b64_tr_b16 v[138:139], v10 offset:18432
v_mfma_f32_16x16x32_bf16 v[32:35], v[240:243], a[156:159], v[32:35]
v_and_b32 v114, 0xffff0000, v62
v_lshlrev_b32 v115, 16, v78
v_mfma_f32_16x16x32_bf16 v[32:35], v[224:227], a[152:155], v[32:35]
s_add_u32 s82, s93, 0x3e00000
buffer_load_dwordx4 v[80:83], v1, s[44:47], s82 offen sc1
v_mfma_f32_16x16x32_bf16 v[32:35], v[208:211], a[148:151], v[32:35]
s_nop 0
ds_read_b64_tr_b16 v[140:141], v11 offset:16384
ds_read_b64_tr_b16 v[142:143], v11 offset:18432
v_mfma_f32_16x16x32_bf16 v[32:35], v[192:195], a[144:147], v[32:35]
v_lshlrev_b32 v62, 16, v62
v_and_b32 v78, 0xffff0000, v78
v_mfma_f32_16x16x32_bf16 v[32:35], v[124:127], v[104:107], v[32:35]
s_nop 0
ds_read_b64_tr_b16 v[144:145], v8 offset:20480
ds_read_b64_tr_b16 v[146:147], v8 offset:22528
v_mfma_f32_16x16x32_bf16 v[36:39], v[196:199], a[144:147], v[36:39]
v_mul_f32 v62, v62, v113
v_mul_f32 v114, v114, v113
v_mfma_f32_16x16x32_bf16 v[36:39], v[212:215], a[148:151], v[36:39]
buffer_load_dwordx4 v[84:87], v1, s[44:47], s82 offen offset:1024 sc1
v_mfma_f32_16x16x32_bf16 v[36:39], v[228:231], a[152:155], v[36:39]
s_nop 0
ds_read_b64_tr_b16 v[148:149], v9 offset:20480
ds_read_b64_tr_b16 v[150:151], v9 offset:22528
v_mfma_f32_16x16x32_bf16 v[36:39], v[244:247], a[156:159], v[36:39]
v_mul_f32 v62, v62, v115
v_mul_f32 v78, v78, v114
v_mfma_f32_16x16x32_bf16 v[36:39], v[120:123], v[104:107], v[36:39]
s_nop 0
ds_read_b64_tr_b16 v[152:153], v10 offset:20480
ds_read_b64_tr_b16 v[154:155], v10 offset:22528
v_mfma_f32_16x16x32_bf16 v[20:23], v[244:247], a[140:143], v[20:23]
v_and_b32 v114, 0xffff0000, v63
v_lshlrev_b32 v115, 16, v79
v_mfma_f32_16x16x32_bf16 v[20:23], v[228:231], a[136:139], v[20:23]
buffer_load_dwordx4 v[88:91], v1, s[44:47], s82 offen offset:2048 sc1
v_mfma_f32_16x16x32_bf16 v[20:23], v[212:215], a[132:135], v[20:23]
s_nop 0
ds_read_b64_tr_b16 v[156:157], v11 offset:20480
ds_read_b64_tr_b16 v[158:159], v11 offset:22528
v_mfma_f32_16x16x32_bf16 v[20:23], v[196:199], a[128:131], v[20:23]
v_lshlrev_b32 v63, 16, v63
v_and_b32 v79, 0xffff0000, v79
v_mfma_f32_16x16x32_bf16 v[20:23], v[120:123], v[96:99], v[20:23]
s_nop 0
ds_read_b64_tr_b16 v[160:161], v8 offset:24576
ds_read_b64_tr_b16 v[162:163], v8 offset:26624
v_mfma_f32_16x16x32_bf16 v[24:27], v[200:203], a[128:131], v[24:27]
s_nop 0
ds_read_b64_tr_b16 v[164:165], v9 offset:24576
ds_read_b64_tr_b16 v[166:167], v9 offset:26624
v_mfma_f32_16x16x32_bf16 v[24:27], v[216:219], a[132:135], v[24:27]
buffer_load_dwordx4 v[92:95], v1, s[44:47], s82 offen offset:3072 sc1
v_mfma_f32_16x16x32_bf16 v[24:27], v[232:235], a[136:139], v[24:27]
v_mul_f32 v63, v63, v113
v_mul_f32 v114, v114, v113
v_mfma_f32_16x16x32_bf16 v[24:27], v[248:251], a[140:143], v[24:27]
s_nop 0
ds_read_b64_tr_b16 v[168:169], v10 offset:24576
ds_read_b64_tr_b16 v[170:171], v10 offset:26624
v_mfma_f32_16x16x32_bf16 v[24:27], v[124:127], v[100:103], v[24:27]
v_mul_f32 v63, v63, v115
v_mul_f32 v79, v79, v114
v_mfma_f32_16x16x32_bf16 v[40:43], v[248:251], a[156:159], v[40:43]
s_nop 0
ds_read_b64_tr_b16 v[172:173], v11 offset:24576
ds_read_b64_tr_b16 v[174:175], v11 offset:26624
v_mfma_f32_16x16x32_bf16 v[40:43], v[232:235], a[152:155], v[40:43]
v_mfma_f32_16x16x32_bf16 v[40:43], v[216:219], a[148:151], v[40:43]
s_nop 0
ds_read_b64_tr_b16 v[176:177], v8 offset:28672
ds_read_b64_tr_b16 v[178:179], v8 offset:30720
v_mfma_f32_16x16x32_bf16 v[40:43], v[200:203], a[144:147], v[40:43]
v_mfma_f32_16x16x32_bf16 v[40:43], v[124:127], v[108:111], v[40:43]
s_nop 0
ds_read_b64_tr_b16 v[180:181], v9 offset:28672
ds_read_b64_tr_b16 v[182:183], v9 offset:30720
v_mfma_f32_16x16x32_bf16 v[44:47], v[204:207], a[144:147], v[44:47]
v_mfma_f32_16x16x32_bf16 v[44:47], v[220:223], a[148:151], v[44:47]
s_nop 0
ds_read_b64_tr_b16 v[184:185], v10 offset:28672
ds_read_b64_tr_b16 v[186:187], v10 offset:30720
v_mfma_f32_16x16x32_bf16 v[44:47], v[236:239], a[152:155], v[44:47]
v_mfma_f32_16x16x32_bf16 v[44:47], v[252:255], a[156:159], v[44:47]
s_nop 0
ds_read_b64_tr_b16 v[188:189], v11 offset:28672
ds_read_b64_tr_b16 v[190:191], v11 offset:30720
v_mfma_f32_16x16x32_bf16 v[44:47], v[120:123], v[108:111], v[44:47]
v_mfma_f32_16x16x32_bf16 v[28:31], v[252:255], a[140:143], v[28:31]
v_mfma_f32_16x16x32_bf16 v[28:31], v[236:239], a[136:139], v[28:31]
v_mfma_f32_16x16x32_bf16 v[28:31], v[220:223], a[132:135], v[28:31]
v_mfma_f32_16x16x32_bf16 v[28:31], v[204:207], a[128:131], v[28:31]
s_waitcnt lgkmcnt(0)
v_mfma_f32_16x16x32_bf16 v[28:31], v[120:123], v[100:103], v[28:31]
v_mfma_f32_16x16x32_bf16 v[16:19], v[128:131], a[160:163], v[16:19]
s_nop 0
ds_read_b64_tr_b16 v[192:193], v8 offset:32768
ds_read_b64_tr_b16 v[194:195], v8 offset:34816
v_mfma_f32_16x16x32_bf16 v[16:19], v[144:147], a[164:167], v[16:19]
s_nop 0
ds_read_b64_tr_b16 v[196:197], v9 offset:32768
ds_read_b64_tr_b16 v[198:199], v9 offset:34816
v_mfma_f32_16x16x32_bf16 v[16:19], v[160:163], a[168:171], v[16:19]
s_nop 0
ds_read_b64_tr_b16 v[200:201], v10 offset:32768
ds_read_b64_tr_b16 v[202:203], v10 offset:34816
v_mfma_f32_16x16x32_bf16 v[16:19], v[176:179], a[172:175], v[16:19]
v_mfma_f32_16x16x32_bf16 v[32:35], v[176:179], a[188:191], v[32:35]
s_nop 0
ds_read_b64_tr_b16 v[204:205], v11 offset:32768
ds_read_b64_tr_b16 v[206:207], v11 offset:34816
v_mfma_f32_16x16x32_bf16 v[32:35], v[160:163], a[184:187], v[32:35]
s_nop 0
ds_read_b64_tr_b16 v[208:209], v8 offset:36864
ds_read_b64_tr_b16 v[210:211], v8 offset:38912
v_mfma_f32_16x16x32_bf16 v[32:35], v[144:147], a[180:183], v[32:35]
s_add_u32 s81, s93, 0x4200000
buffer_load_dwordx4 v[96:99], v1, s[44:47], s81 offen sc1
v_mfma_f32_16x16x32_bf16 v[32:35], v[128:131], a[176:179], v[32:35]
v_mfma_f32_16x16x32_bf16 v[36:39], v[132:135], a[176:179], v[36:39]
s_nop 0
ds_read_b64_tr_b16 v[212:213], v9 offset:36864
ds_read_b64_tr_b16 v[214:215], v9 offset:38912
v_mfma_f32_16x16x32_bf16 v[36:39], v[148:151], a[180:183], v[36:39]
s_nop 0
ds_read_b64_tr_b16 v[216:217], v10 offset:36864
ds_read_b64_tr_b16 v[218:219], v10 offset:38912
v_mfma_f32_16x16x32_bf16 v[36:39], v[164:167], a[184:187], v[36:39]
v_mfma_f32_16x16x32_bf16 v[36:39], v[180:183], a[188:191], v[36:39]
buffer_load_dwordx4 v[100:103], v1, s[44:47], s81 offen offset:1024 sc1
v_mfma_f32_16x16x32_bf16 v[20:23], v[180:183], a[172:175], v[20:23]
s_nop 0
ds_read_b64_tr_b16 v[220:221], v11 offset:36864
ds_read_b64_tr_b16 v[222:223], v11 offset:38912
v_mfma_f32_16x16x32_bf16 v[20:23], v[164:167], a[168:171], v[20:23]
s_nop 0
ds_read_b64_tr_b16 v[224:225], v8 offset:40960
ds_read_b64_tr_b16 v[226:227], v8 offset:43008
v_mfma_f32_16x16x32_bf16 v[20:23], v[148:151], a[164:167], v[20:23]
s_nop 0
ds_read_b64_tr_b16 v[228:229], v9 offset:40960
ds_read_b64_tr_b16 v[230:231], v9 offset:43008
v_mfma_f32_16x16x32_bf16 v[20:23], v[132:135], a[160:163], v[20:23]
v_mfma_f32_16x16x32_bf16 v[24:27], v[136:139], a[160:163], v[24:27]
buffer_load_dwordx4 v[104:107], v1, s[44:47], s81 offen offset:2048 sc1
v_mfma_f32_16x16x32_bf16 v[24:27], v[152:155], a[164:167], v[24:27]
s_nop 0
ds_read_b64_tr_b16 v[232:233], v10 offset:40960
ds_read_b64_tr_b16 v[234:235], v10 offset:43008
v_mfma_f32_16x16x32_bf16 v[24:27], v[168:171], a[168:171], v[24:27]
s_nop 0
ds_read_b64_tr_b16 v[236:237], v11 offset:40960
ds_read_b64_tr_b16 v[238:239], v11 offset:43008
v_mfma_f32_16x16x32_bf16 v[24:27], v[184:187], a[172:175], v[24:27]
v_mfma_f32_16x16x32_bf16 v[40:43], v[184:187], a[188:191], v[40:43]
s_nop 0
ds_read_b64_tr_b16 v[240:241], v8 offset:45056
ds_read_b64_tr_b16 v[242:243], v8 offset:47104
v_mfma_f32_16x16x32_bf16 v[40:43], v[168:171], a[184:187], v[40:43]
buffer_load_dwordx4 v[108:111], v1, s[44:47], s81 offen offset:3072 sc1
v_mfma_f32_16x16x32_bf16 v[40:43], v[152:155], a[180:183], v[40:43]
s_nop 0
ds_read_b64_tr_b16 v[244:245], v9 offset:45056
ds_read_b64_tr_b16 v[246:247], v9 offset:47104
v_mfma_f32_16x16x32_bf16 v[40:43], v[136:139], a[176:179], v[40:43]
v_mfma_f32_16x16x32_bf16 v[44:47], v[140:143], a[176:179], v[44:47]
s_nop 0
ds_read_b64_tr_b16 v[248:249], v10 offset:45056
ds_read_b64_tr_b16 v[250:251], v10 offset:47104
v_mfma_f32_16x16x32_bf16 v[44:47], v[156:159], a[180:183], v[44:47]
s_nop 0
ds_read_b64_tr_b16 v[252:253], v11 offset:45056
ds_read_b64_tr_b16 v[254:255], v11 offset:47104
v_mfma_f32_16x16x32_bf16 v[44:47], v[172:175], a[184:187], v[44:47]
v_mfma_f32_16x16x32_bf16 v[44:47], v[188:191], a[188:191], v[44:47]
s_waitcnt vmcnt(4)
v_max3_u32 v12, v80, v81, v82
v_max3_u32 v13, v83, v84, v85
v_mfma_f32_16x16x32_bf16 v[28:31], v[188:191], a[172:175], v[28:31]
v_max3_u32 v12, v12, v86, v87
v_max3_u32 v13, v13, v88, v89
v_mfma_f32_16x16x32_bf16 v[28:31], v[172:175], a[168:171], v[28:31]
v_max3_u32 v12, v12, v90, v91
v_max3_u32 v13, v13, v92, v93
v_mfma_f32_16x16x32_bf16 v[28:31], v[156:159], a[164:167], v[28:31]
s_waitcnt vmcnt(14) lgkmcnt(0)
v_max3_u32 v12, v12, v94, v95
v_mfma_f32_16x16x32_bf16 v[28:31], v[140:143], a[160:163], v[28:31]
s_barrier
v_max_u32 v12, v12, v13
v_mfma_f32_16x16x32_bf16 v[16:19], v[192:195], a[192:195], v[16:19]
v_cmp_le_u32 vcc, 0xff800000, v12
v_mfma_f32_16x16x32_bf16 v[16:19], v[208:211], a[196:199], v[16:19]
s_nop 0
ds_read_b64_tr_b16 v[128:129], v8 offset:49152
ds_read_b64_tr_b16 v[130:131], v8 offset:51200
v_mfma_f32_16x16x32_bf16 v[16:19], v[224:227], a[200:203], v[16:19]
s_cbranch_vccnz Lxspin2
Lxback2:
v_mfma_f32_16x16x32_bf16 v[16:19], v[240:243], a[204:207], v[16:19]
s_nop 0
ds_read_b64_tr_b16 v[132:133], v9 offset:49152
ds_read_b64_tr_b16 v[134:135], v9 offset:51200
v_mfma_f32_16x16x32_bf16 v[16:19], v[124:127], v[80:83], v[16:19]
v_mfma_f32_16x16x32_bf16 v[32:35], v[240:243], a[220:223], v[32:35]
s_nop 0
ds_read_b64_tr_b16 v[136:137], v10 offset:49152
ds_read_b64_tr_b16 v[138:139], v10 offset:51200
v_mfma_f32_16x16x32_bf16 v[32:35], v[224:227], a[216:219], v[32:35]
v_mfma_f32_16x16x32_bf16 v[32:35], v[208:211], a[212:215], v[32:35]
s_nop 0
ds_read_b64_tr_b16 v[140:141], v11 offset:49152
ds_read_b64_tr_b16 v[142:143], v11 offset:51200
v_mfma_f32_16x16x32_bf16 v[32:35], v[192:195], a[208:211], v[32:35]
v_mfma_f32_16x16x32_bf16 v[32:35], v[124:127], v[88:91], v[32:35]
s_nop 0
ds_read_b64_tr_b16 v[144:145], v8 offset:53248
ds_read_b64_tr_b16 v[146:147], v8 offset:55296
v_mfma_f32_16x16x32_bf16 v[36:39], v[196:199], a[208:211], v[36:39]
v_mfma_f32_16x16x32_bf16 v[36:39], v[212:215], a[212:215], v[36:39]
s_nop 0
ds_read_b64_tr_b16 v[148:149], v9 offset:53248
ds_read_b64_tr_b16 v[150:151], v9 offset:55296
v_mfma_f32_16x16x32_bf16 v[36:39], v[228:231], a[216:219], v[36:39]
v_mfma_f32_16x16x32_bf16 v[36:39], v[244:247], a[220:223], v[36:39]
s_nop 0
ds_read_b64_tr_b16 v[152:153], v10 offset:53248
ds_read_b64_tr_b16 v[154:155], v10 offset:55296
v_mfma_f32_16x16x32_bf16 v[36:39], v[120:123], v[88:91], v[36:39]
Lstube5:
s_cbranch_execz Lrete
v_mfma_f32_16x16x32_bf16 v[20:23], v[244:247], a[204:207], v[20:23]
s_nop 0
ds_read_b64_tr_b16 v[156:157], v11 offset:53248
ds_read_b64_tr_b16 v[158:159], v11 offset:55296
v_mfma_f32_16x16x32_bf16 v[20:23], v[228:231], a[200:203], v[20:23]
v_mfma_f32_16x16x32_bf16 v[20:23], v[212:215], a[196:199], v[20:23]
v_mfma_f32_16x16x32_bf16 v[20:23], v[196:199], a[192:195], v[20:23]
s_nop 0
ds_read_b64_tr_b16 v[160:161], v8 offset:57344
ds_read_b64_tr_b16 v[162:163], v8 offset:59392
v_mfma_f32_16x16x32_bf16 v[20:23], v[120:123], v[80:83], v[20:23]
v_mfma_f32_16x16x32_bf16 v[24:27], v[200:203], a[192:195], v[24:27]
s_nop 0
ds_read_b64_tr_b16 v[164:165], v9 offset:57344
ds_read_b64_tr_b16 v[166:167], v9 offset:59392
v_mfma_f32_16x16x32_bf16 v[24:27], v[216:219], a[196:199], v[24:27]
v_mfma_f32_16x16x32_bf16 v[24:27], v[232:235], a[200:203], v[24:27]
s_nop 0
ds_read_b64_tr_b16 v[168:169], v10 offset:57344
ds_read_b64_tr_b16 v[170:171], v10 offset:59392
v_mfma_f32_16x16x32_bf16 v[24:27], v[248:251], a[204:207], v[24:27]
v_mfma_f32_16x16x32_bf16 v[24:27], v[124:127], v[84:87], v[24:27]
s_nop 0
ds_read_b64_tr_b16 v[172:173], v11 offset:57344
ds_read_b64_tr_b16 v[174:175], v11 offset:59392
v_mfma_f32_16x16x32_bf16 v[40:43], v[248:251], a[220:223], v[40:43]
v_mfma_f32_16x16x32_bf16 v[40:43], v[232:235], a[216:219], v[40:43]
s_nop 0
ds_read_b64_tr_b16 v[176:177], v8 offset:61440
ds_read_b64_tr_b16 v[178:179], v8 offset:63488
v_mfma_f32_16x16x32_bf16 v[40:43], v[216:219], a[212:215], v[40:43]
v_mfma_f32_16x16x32_bf16 v[40:43], v[200:203], a[208:211], v[40:43]
s_nop 0
ds_read_b64_tr_b16 v[180:181], v9 offset:61440
ds_read_b64_tr_b16 v[182:183], v9 offset:63488
v_mfma_f32_16x16x32_bf16 v[40:43], v[124:127], v[92:95], v[40:43]
v_mfma_f32_16x16x32_bf16 v[44:47], v[204:207], a[208:211], v[44:47]
s_nop 0
ds_read_b64_tr_b16 v[184:185], v10 offset:61440
ds_read_b64_tr_b16 v[186:187], v10 offset:63488
v_mfma_f32_16x16x32_bf16 v[44:47], v[220:223], a[212:215], v[44:47]
v_mfma_f32_16x16x32_bf16 v[44:47], v[236:239], a[216:219], v[44:47]
s_nop 0
ds_read_b64_tr_b16 v[188:189], v11 offset:61440
ds_read_b64_tr_b16 v[190:191], v11 offset:63488
v_mfma_f32_16x16x32_bf16 v[44:47], v[252:255], a[220:223], v[44:47]
v_mfma_f32_16x16x32_bf16 v[44:47], v[120:123], v[92:95], v[44:47]
v_mfma_f32_16x16x32_bf16 v[28:31], v[252:255], a[204:207], v[28:31]
s_waitcnt vmcnt(0)
v_max3_u32 v12, v96, v97, v98
v_max3_u32 v13, v99, v100, v101
v_mfma_f32_16x16x32_bf16 v[28:31], v[236:239], a[200:203], v[28:31]
v_max3_u32 v12, v12, v102, v103
v_max3_u32 v13, v13, v104, v105
v_mfma_f32_16x16x32_bf16 v[28:31], v[220:223], a[196:199], v[28:31]
v_max3_u32 v12, v12, v106, v107
v_max3_u32 v13, v13, v108, v109
v_mfma_f32_16x16x32_bf16 v[28:31], v[204:207], a[192:195], v[28:31]
s_waitcnt lgkmcnt(0)
v_max3_u32 v12, v12, v110, v111
v_mfma_f32_16x16x32_bf16 v[28:31], v[120:123], v[84:87], v[28:31]
v_max_u32 v12, v12, v13
v_mfma_f32_16x16x32_bf16 v[16:19], v[128:131], a[224:227], v[16:19]
v_cmp_le_u32 vcc, 0xff800000, v12
v_mfma_f32_16x16x32_bf16 v[16:19], v[144:147], a[228:231], v[16:19]
v_mfma_f32_16x16x32_bf16 v[16:19], v[160:163], a[232:235], v[16:19]
s_cbranch_vccnz Lxspin3
Lxback3:
v_mfma_f32_16x16x32_bf16 v[16:19], v[176:179], a[236:239], v[16:19]
v_mfma_f32_16x16x32_bf16 v[16:19], v[124:127], v[96:99], v[16:19]
v_mfma_f32_16x16x32_bf16 v[20:23], v[180:183], a[236:239], v[20:23]
v_mfma_f32_16x16x32_bf16 v[20:23], v[164:167], a[232:235], v[20:23]
v_mfma_f32_16x16x32_bf16 v[20:23], v[148:151], a[228:231], v[20:23]
v_mfma_f32_16x16x32_bf16 v[20:23], v[132:135], a[224:227], v[20:23]
s_nop 3
v_fma_f32 v16, v16, v6, v48
v_fma_f32 v17, v17, v6, v64
v_mfma_f32_16x16x32_bf16 v[20:23], v[120:123], v[96:99], v[20:23]
v_fma_f32 v18, v18, v6, v49
v_fma_f32 v19, v19, v6, v65
v_mfma_f32_16x16x32_bf16 v[24:27], v[136:139], a[224:227], v[24:27]
v_cvt_pk_bf16_f32 v16, v16, v17
v_cvt_pk_bf16_f32 v17, v18, v19
v_mfma_f32_16x16x32_bf16 v[24:27], v[152:155], a[228:231], v[24:27]
ds_write_b64 v116, v[16:17] offset:0
v_mfma_f32_16x16x32_bf16 v[24:27], v[168:171], a[232:235], v[24:27]
v_mfma_f32_16x16x32_bf16 v[24:27], v[184:187], a[236:239], v[24:27]
v_fma_f32 v20, v20, v6, v50
v_fma_f32 v21, v21, v6, v66
v_mfma_f32_16x16x32_bf16 v[24:27], v[124:127], v[100:103], v[24:27]
v_fma_f32 v22, v22, v6, v51
v_fma_f32 v23, v23, v6, v67
v_mfma_f32_16x16x32_bf16 v[28:31], v[188:191], a[236:239], v[28:31]
v_cvt_pk_bf16_f32 v20, v20, v21
v_cvt_pk_bf16_f32 v21, v22, v23
v_mfma_f32_16x16x32_bf16 v[28:31], v[172:175], a[232:235], v[28:31]
ds_write_b64 v117, v[20:21] offset:0
v_mfma_f32_16x16x32_bf16 v[28:31], v[156:159], a[228:231], v[28:31]
v_mfma_f32_16x16x32_bf16 v[28:31], v[140:143], a[224:227], v[28:31]
v_fma_f32 v24, v24, v6, v52
v_fma_f32 v25, v25, v6, v68
v_mfma_f32_16x16x32_bf16 v[28:31], v[120:123], v[100:103], v[28:31]
v_fma_f32 v26, v26, v6, v53
v_fma_f32 v27, v27, v6, v69
v_mfma_f32_16x16x32_bf16 v[32:35], v[128:131], a[240:243], v[32:35]
v_cvt_pk_bf16_f32 v24, v24, v25
v_cvt_pk_bf16_f32 v25, v26, v27
v_mfma_f32_16x16x32_bf16 v[32:35], v[144:147], a[244:247], v[32:35]
ds_write_b64 v118, v[24:25] offset:0
v_mfma_f32_16x16x32_bf16 v[32:35], v[160:163], a[248:251], v[32:35]
v_mfma_f32_16x16x32_bf16 v[32:35], v[176:179], a[252:255], v[32:35]
v_fma_f32 v28, v28, v6, v54
v_fma_f32 v29, v29, v6, v70
v_mfma_f32_16x16x32_bf16 v[32:35], v[124:127], v[104:107], v[32:35]
v_fma_f32 v30, v30, v6, v55
v_fma_f32 v31, v31, v6, v71
v_mfma_f32_16x16x32_bf16 v[36:39], v[180:183], a[252:255], v[36:39]
v_cvt_pk_bf16_f32 v28, v28, v29
v_cvt_pk_bf16_f32 v29, v30, v31
v_mfma_f32_16x16x32_bf16 v[36:39], v[164:167], a[248:251], v[36:39]
s_nop 0
ds_write_b64 v119, v[28:29] offset:0
ds_read_b128 v[192:195], v4 offset:0
v_mfma_f32_16x16x32_bf16 v[36:39], v[148:151], a[244:247], v[36:39]
ds_read_b128 v[196:199], v4 offset:1024
v_mfma_f32_16x16x32_bf16 v[36:39], v[132:135], a[240:243], v[36:39]
v_fma_f32 v32, v32, v7, v56
v_fma_f32 v33, v33, v7, v72
v_mfma_f32_16x16x32_bf16 v[36:39], v[120:123], v[104:107], v[36:39]
v_fma_f32 v34, v34, v7, v57
v_fma_f32 v35, v35, v7, v73
v_mfma_f32_16x16x32_bf16 v[40:43], v[136:139], a[240:243], v[40:43]
v_cvt_pk_bf16_f32 v32, v32, v33
v_cvt_pk_bf16_f32 v33, v34, v35
v_mfma_f32_16x16x32_bf16 v[40:43], v[152:155], a[244:247], v[40:43]
ds_write_b64 v116, v[32:33] offset:2048
v_mfma_f32_16x16x32_bf16 v[40:43], v[168:171], a[248:251], v[40:43]
s_waitcnt lgkmcnt(2)
buffer_store_dwordx4 v[192:195], v15, s[40:43], s70 offen sc1
v_mfma_f32_16x16x32_bf16 v[40:43], v[184:187], a[252:255], v[40:43]
s_add_u32 s70, s70, 0x4000
v_mfma_f32_16x16x32_bf16 v[40:43], v[124:127], v[108:111], v[40:43]
v_fma_f32 v36, v36, v7, v58
v_fma_f32 v37, v37, v7, v74
v_mfma_f32_16x16x32_bf16 v[44:47], v[188:191], a[252:255], v[44:47]
v_fma_f32 v38, v38, v7, v59
v_fma_f32 v39, v39, v7, v75
v_mfma_f32_16x16x32_bf16 v[44:47], v[172:175], a[248:251], v[44:47]
v_cvt_pk_bf16_f32 v36, v36, v37
v_cvt_pk_bf16_f32 v37, v38, v39
v_mfma_f32_16x16x32_bf16 v[44:47], v[156:159], a[244:247], v[44:47]
ds_write_b64 v117, v[36:37] offset:2048
v_mfma_f32_16x16x32_bf16 v[44:47], v[140:143], a[240:243], v[44:47]
v_fma_f32 v40, v40, v7, v60
v_fma_f32 v41, v41, v7, v76
v_mfma_f32_16x16x32_bf16 v[44:47], v[120:123], v[108:111], v[44:47]
v_fma_f32 v42, v42, v7, v61
v_fma_f32 v43, v43, v7, v77
v_cvt_pk_bf16_f32 v40, v40, v41
v_cvt_pk_bf16_f32 v41, v42, v43
ds_write_b64 v118, v[40:41] offset:2048
s_waitcnt lgkmcnt(3)
buffer_store_dwordx4 v[196:199], v15, s[40:43], s70 offen sc1
s_add_u32 s70, s70, 0x4000
v_fma_f32 v44, v44, v7, v62
v_fma_f32 v45, v45, v7, v78
v_fma_f32 v46, v46, v7, v63
v_fma_f32 v47, v47, v7, v79
v_cvt_pk_bf16_f32 v44, v44, v45
v_cvt_pk_bf16_f32 v45, v46, v47
ds_write_b64 v119, v[44:45] offset:2048
ds_read_b128 v[200:203], v4 offset:2048
ds_read_b128 v[204:207], v4 offset:3072
s_waitcnt lgkmcnt(1)
buffer_store_dwordx4 v[200:203], v15, s[40:43], s70 offen sc1
s_add_u32 s70, s70, 0x4000
s_waitcnt lgkmcnt(0)
buffer_store_dwordx4 v[204:207], v15, s[40:43], s70 offen sc1
s_add_u32 s70, s70, 0x4000
Lend:
s_endpgm
Lspin1:
s_mov_b32 s83, 262144
Lsl3:
s_sleep 2
buffer_load_dword v3, v2, s[48:51], 0 offen sc1
s_sub_u32 s83, s83, 1
s_cmp_eq_u32 s83, 0
s_waitcnt vmcnt(0)
s_cbranch_scc1 Lback2
v_cmp_gt_u32 vcc, 8, v3
s_cbranch_vccnz Lsl3
s_branch Lback2
Lspin4:
s_mov_b32 s83, 262144
Lsl6:
s_sleep 2
buffer_load_dword v3, v2, s[44:47], s75 offen sc1
s_sub_u32 s83, s83, 1
s_cmp_eq_u32 s83, 0
s_waitcnt vmcnt(0)
s_cbranch_scc1 Lback5
v_cmp_gt_u32 vcc, 1, v3
s_cbranch_vccnz Lsl6
s_branch Lback5
.p2align 12
s_endpgm
.p2align 7
LP0x:
Lstub10:
s_cbranch_execz Lret
s_cmp_eq_u32 s58, 2
s_cbranch_scc1 Lta10
s_cmp_eq_u32 s58, 3
s_cbranch_scc1 Lnt11
v_mfma_f32_16x16x32_bf16 v[160:163], a[160:163], v[16:19], v[112:115]
s_xor_b32 s74, s82, 0x10000
v_exp_f32 v128, v128
v_mfma_f32_16x16x32_bf16 v[176:179], a[176:179], v[16:19], v[112:115]
s_add_u32 s74, s74, s64
ds_read_b128 a[128:131], v2 offset:16384
ds_read_b128 a[132:135], v2 offset:17408
s_branch Ljoin12
Lta10:
v_mfma_f32_16x16x32_bf16 v[160:163], a[160:163], v[16:19], v[96:99]
s_xor_b32 s74, s82, 0x10000
v_exp_f32 v128, v128
v_mfma_f32_16x16x32_bf16 v[176:179], a[176:179], v[16:19], v[112:115]
s_add_u32 s74, s74, s64
ds_read_b128 a[128:131], v2 offset:16384
ds_read_b128 a[132:135], v2 offset:17408
s_branch Ljoin12
Lnt11:
v_mfma_f32_16x16x32_bf16 v[160:163], a[160:163], v[16:19], v[80:83]
s_xor_b32 s74, s82, 0x10000
v_exp_f32 v128, v128
v_mfma_f32_16x16x32_bf16 v[176:179], a[176:179], v[16:19], v[96:99]
s_add_u32 s74, s74, s64
ds_read_b128 a[128:131], v2 offset:16384
ds_read_b128 a[132:135], v2 offset:17408
Ljoin12:
v_mfma_f32_16x16x32_bf16 v[164:167], a[160:163], v[32:35], v[84:87]
s_add_u32 s81, s81, 0x8000
v_exp_f32 v129, v129
v_mfma_f32_16x16x32_bf16 v[164:167], a[164:167], v[36:39], v[164:167]
s_add_u32 m0, s74, 16384
v_exp_f32 v130, v130
v_mfma_f32_16x16x32_bf16 v[164:167], a[168:171], v[40:43], v[164:167]
s_add_u32 s72, s81, 16384
v_exp_f32 v131, v131
v_mfma_f32_16x16x32_bf16 v[164:167], a[172:175], v[44:47], v[164:167]
v_exp_f32 v144, v144
v_mfma_f32_16x16x32_bf16 v[172:175], a[172:175], v[76:79], v[92:95]
s_nop 0
ds_read_b128 a[136:139], v2 offset:18432
ds_read_b128 a[140:143], v2 offset:19456
v_mfma_f32_16x16x32_bf16 v[172:175], a[168:171], v[72:75], v[172:175]
s_nop 0
ds_read_b128 a[144:147], v2 offset:20480
ds_read_b128 a[148:151], v2 offset:21504
v_mfma_f32_16x16x32_bf16 v[172:175], a[164:167], v[68:71], v[172:175]
s_nop 0
ds_read_b128 a[152:155], v2 offset:22528
ds_read_b128 a[156:159], v2 offset:23552
v_mfma_f32_16x16x32_bf16 v[172:175], a[160:163], v[64:67], v[172:175]
s_nop 0
ds_read_b128 a[192:195], v2 offset:0
ds_read_b128 a[196:199], v2 offset:1024
v_mfma_f32_16x16x32_bf16 v[188:191], a[176:179], v[64:67], v[92:95]
s_nop 0
ds_read_b128 a[200:203], v2 offset:2048
ds_read_b128 a[204:207], v2 offset:3072
v_mfma_f32_16x16x32_bf16 v[188:191], a[180:183], v[68:71], v[188:191]
s_nop 0
ds_read_b128 a[208:211], v2 offset:4096
ds_read_b128 a[212:215], v2 offset:5120
v_mfma_f32_16x16x32_bf16 v[188:191], a[184:187], v[72:75], v[188:191]
s_nop 0
ds_read_b128 a[216:219], v2 offset:6144
ds_read_b128 a[220:223], v2 offset:7168
v_mfma_f32_16x16x32_bf16 v[188:191], a[188:191], v[76:79], v[188:191]
v_cvt_pk_bf16_f32 v192, v128, v129
v_cvt_pk_bf16_f32 v193, v130, v131
v_mfma_f32_16x16x32_bf16 v[180:183], a[188:191], v[44:47], v[84:87]
buffer_load_dwordx4 v1, s[44:47], s72 offen sc1 lds
v_mfma_f32_16x16x32_bf16 v[180:183], a[184:187], v[40:43], v[180:183]
v_exp_f32 v145, v145
v_mfma_f32_16x16x32_bf16 v[180:183], a[180:183], v[36:39], v[180:183]
v_exp_f32 v146, v146
v_mfma_f32_16x16x32_bf16 v[180:183], a[176:179], v[32:35], v[180:183]
v_exp_f32 v147, v147
v_mfma_f32_16x16x32_bf16 v[160:163], a[164:167], v[20:23], v[160:163]
v_exp_f32 v136, v136
v_mfma_f32_16x16x32_bf16 v[160:163], a[168:171], v[24:27], v[160:163]
v_cvt_pk_bf16_f32 v194, v144, v145
v_cvt_pk_bf16_f32 v195, v146, v147
v_mfma_f32_16x16x32_bf16 v[160:163], a[172:175], v[28:31], v[160:163]
v_exp_f32 v137, v137
v_mfma_f32_16x16x32_bf16 v[168:171], a[172:175], v[60:63], v[88:91]
v_exp_f32 v138, v138
v_mfma_f32_16x16x32_bf16 v[168:171], a[168:171], v[56:59], v[168:171]
v_exp_f32 v139, v139
v_mfma_f32_16x16x32_bf16 v[168:171], a[164:167], v[52:55], v[168:171]
v_exp_f32 v152, v152
v_mfma_f32_16x16x32_bf16 v[168:171], a[160:163], v[48:51], v[168:171]
v_cvt_pk_bf16_f32 v200, v136, v137
v_cvt_pk_bf16_f32 v201, v138, v139
v_mfma_f32_16x16x32_bf16 v[184:187], a[176:179], v[48:51], v[88:91]
buffer_load_dwordx4 v1, s[44:47], s72 offen offset:1024 sc1 lds
v_mfma_f32_16x16x32_bf16 v[184:187], a[180:183], v[52:55], v[184:187]
v_exp_f32 v153, v153
v_mfma_f32_16x16x32_bf16 v[184:187], a[184:187], v[56:59], v[184:187]
v_exp_f32 v154, v154
v_mfma_f32_16x16x32_bf16 v[184:187], a[188:191], v[60:63], v[184:187]
v_exp_f32 v155, v155
v_mfma_f32_16x16x32_bf16 v[176:179], a[188:191], v[28:31], v[176:179]
buffer_load_dwordx4 v1, s[44:47], s72 offen offset:2048 sc1 lds
v_mfma_f32_16x16x32_bf16 v[176:179], a[184:187], v[24:27], v[176:179]
buffer_load_dwordx4 v1, s[44:47], s72 offen offset:3072 sc1 lds
v_mfma_f32_16x16x32_bf16 v[176:179], a[180:183], v[20:23], v[176:179]
s_waitcnt lgkmcnt(4)
v_exp_f32 v132, v132
v_cvt_pk_bf16_f32 v202, v152, v153
v_cvt_pk_bf16_f32 v203, v154, v155
v_exp_f32 v133, v133
v_exp_f32 v134, v134
v_cvt_pk_bf16_f32 v196, v132, v133
v_exp_f32 v135, v135
v_exp_f32 v148, v148
v_cvt_pk_bf16_f32 v197, v134, v135
v_exp_f32 v149, v149
v_exp_f32 v150, v150
v_cvt_pk_bf16_f32 v198, v148, v149
v_exp_f32 v151, v151
v_exp_f32 v140, v140
v_cvt_pk_bf16_f32 v199, v150, v151
v_exp_f32 v141, v141
v_exp_f32 v142, v142
v_cvt_pk_bf16_f32 v204, v140, v141
v_exp_f32 v143, v143
v_exp_f32 v156, v156
v_cvt_pk_bf16_f32 v205, v142, v143
v_exp_f32 v157, v157
v_exp_f32 v158, v158
v_cvt_pk_bf16_f32 v206, v156, v157
v_exp_f32 v159, v159
s_nop 0
v_cvt_pk_bf16_f32 v207, v158, v159
v_mfma_f32_16x16x32_bf16 v[224:227], v[120:123], v[192:195], 0
s_add_u32 s82, s82, 0x8000
ds_read_b128 a[160:163], v2 offset:24576
ds_read_b128 a[164:167], v2 offset:25600
v_mfma_f32_16x16x32_bf16 v[232:235], v[120:123], v[200:203], 0
s_and_b32 s82, s82, 0x1ffff
v_exp_f32 v164, v164
v_mfma_f32_16x16x32_bf16 a[0:3], a[192:195], v[192:195], 0
s_add_u32 m0, s74, 0
v_exp_f32 v165, v165
v_mfma_f32_16x16x32_bf16 a[64:67], a[192:195], v[200:203], 0
s_add_u32 s72, s81, 0
v_exp_f32 v166, v166
v_mfma_f32_16x16x32_bf16 a[68:71], a[196:199], v[200:203], 0
buffer_load_dwordx4 v1, s[44:47], s72 offen sc1 lds
v_mfma_f32_16x16x32_bf16 a[4:7], a[196:199], v[192:195], 0
v_exp_f32 v167, v167
v_mfma_f32_16x16x32_bf16 a[8:11], a[200:203], v[192:195], 0
s_nop 0
ds_read_b128 a[168:171], v2 offset:26624
ds_read_b128 a[172:175], v2 offset:27648
v_mfma_f32_16x16x32_bf16 a[72:75], a[200:203], v[200:203], 0
v_exp_f32 v180, v180
v_mfma_f32_16x16x32_bf16 a[76:79], a[204:207], v[200:203], 0
s_nop 0
ds_read_b128 a[176:179], v2 offset:28672
ds_read_b128 a[180:183], v2 offset:29696
v_mfma_f32_16x16x32_bf16 a[12:15], a[204:207], v[192:195], 0
s_waitcnt lgkmcnt(6)
ds_read_b128 a[184:187], v2 offset:30720
ds_read_b128 a[188:191], v2 offset:31744
v_mfma_f32_16x16x32_bf16 a[16:19], a[208:211], v[192:195], 0
s_nop 0
ds_read_b128 a[224:227], v2 offset:8192
ds_read_b128 a[228:231], v2 offset:9216
v_mfma_f32_16x16x32_bf16 a[80:83], a[208:211], v[200:203], 0
s_nop 0
ds_read_b128 a[232:235], v2 offset:10240
ds_read_b128 a[236:239], v2 offset:11264
v_mfma_f32_16x16x32_bf16 a[84:87], a[212:215], v[200:203], 0
s_nop 0
ds_read_b128 a[240:243], v2 offset:12288
ds_read_b128 a[244:247], v2 offset:13312
v_mfma_f32_16x16x32_bf16 a[20:23], a[212:215], v[192:195], 0
s_nop 0
ds_read_b128 a[248:251], v2 offset:14336
ds_read_b128 a[252:255], v2 offset:15360
v_mfma_f32_16x16x32_bf16 a[24:27], a[216:219], v[192:195], 0
v_cvt_pk_bf16_f32 v212, v164, v165
v_cvt_pk_bf16_f32 v213, v166, v167
v_mfma_f32_16x16x32_bf16 a[88:91], a[216:219], v[200:203], 0
v_exp_f32 v181, v181
v_mfma_f32_16x16x32_bf16 a[92:95], a[220:223], v[200:203], 0
v_exp_f32 v182, v182
v_mfma_f32_16x16x32_bf16 a[28:31], a[220:223], v[192:195], 0
buffer_load_dwordx4 v1, s[44:47], s72 offen offset:1024 sc1 lds
s_cmp_eq_u32 s58, 0
s_cbranch_scc1 Lta13
s_cmp_eq_u32 s58, 1
s_cbranch_scc1 Lnt14
v_mfma_f32_16x16x32_bf16 v[132:135], a[128:131], v[32:35], v[84:87]
v_exp_f32 v183, v183
v_mfma_f32_16x16x32_bf16 v[148:151], a[144:147], v[32:35], v[84:87]
v_exp_f32 v172, v172
s_branch Ljoin15
Lta13:
v_mfma_f32_16x16x32_bf16 v[132:135], a[128:131], v[32:35], v[100:103]
v_exp_f32 v183, v183
v_mfma_f32_16x16x32_bf16 v[148:151], a[144:147], v[32:35], v[112:115]
v_exp_f32 v172, v172
s_branch Ljoin15
Lnt14:
v_mfma_f32_16x16x32_bf16 v[132:135], a[128:131], v[32:35], v[84:87]
v_exp_f32 v183, v183
v_mfma_f32_16x16x32_bf16 v[148:151], a[144:147], v[32:35], v[100:103]
v_exp_f32 v172, v172
Ljoin15:
v_mfma_f32_16x16x32_bf16 v[136:139], a[128:131], v[48:51], v[88:91]
v_cvt_pk_bf16_f32 v214, v180, v181
v_cvt_pk_bf16_f32 v215, v182, v183
v_mfma_f32_16x16x32_bf16 v[136:139], a[132:135], v[52:55], v[136:139]
v_exp_f32 v173, v173
v_mfma_f32_16x16x32_bf16 v[136:139], a[136:139], v[56:59], v[136:139]
buffer_load_dwordx4 v1, s[44:47], s72 offen offset:2048 sc1 lds
v_mfma_f32_16x16x32_bf16 v[136:139], a[140:143], v[60:63], v[136:139]
v_exp_f32 v174, v174
v_mfma_f32_16x16x32_bf16 v[152:155], a[156:159], v[60:63], v[88:91]
v_exp_f32 v175, v175
v_mfma_f32_16x16x32_bf16 v[152:155], a[152:155], v[56:59], v[152:155]
v_exp_f32 v188, v188
v_mfma_f32_16x16x32_bf16 v[152:155], a[148:151], v[52:55], v[152:155]
v_cvt_pk_bf16_f32 v220, v172, v173
v_cvt_pk_bf16_f32 v221, v174, v175
v_mfma_f32_16x16x32_bf16 v[152:155], a[144:147], v[48:51], v[152:155]
v_exp_f32 v189, v189
v_mfma_f32_16x16x32_bf16 v[132:135], a[132:135], v[36:39], v[132:135]
buffer_load_dwordx4 v1, s[44:47], s72 offen offset:3072 sc1 lds
v_mfma_f32_16x16x32_bf16 v[132:135], a[136:139], v[40:43], v[132:135]
s_add_u32 s66, s58, 1
v_exp_f32 v190, v190
v_mfma_f32_16x16x32_bf16 v[132:135], a[140:143], v[44:47], v[132:135]
s_and_b32 s66, s66, 3
v_exp_f32 v191, v191
v_mfma_f32_16x16x32_bf16 v[140:143], a[140:143], v[76:79], v[92:95]
s_mul_i32 s66, s66, 4160
v_exp_f32 v160, v160
v_mfma_f32_16x16x32_bf16 v[140:143], a[136:139], v[72:75], v[140:143]
s_add_u32 m0, s66, 131104
v_cvt_pk_bf16_f32 v222, v188, v189
v_cvt_pk_bf16_f32 v223, v190, v191
v_mfma_f32_16x16x32_bf16 v[140:143], a[132:135], v[68:71], v[140:143]
s_add_u32 s72, s93, 0x2
v_exp_f32 v161, v161
v_mfma_f32_16x16x32_bf16 v[140:143], a[128:131], v[64:67], v[140:143]
buffer_load_dwordx4 v1, s[36:39], s72 offen lds
v_mfma_f32_16x16x32_bf16 v[156:159], a[144:147], v[64:67], v[92:95]
v_exp_f32 v162, v162
v_mfma_f32_16x16x32_bf16 v[156:159], a[148:151], v[68:71], v[156:159]
v_exp_f32 v163, v163
v_mfma_f32_16x16x32_bf16 v[156:159], a[152:155], v[72:75], v[156:159]
buffer_load_dwordx4 v1, s[36:39], s72 offen offset:1024 lds
v_mfma_f32_16x16x32_bf16 v[156:159], a[156:159], v[76:79], v[156:159]
buffer_load_dwordx4 v1, s[36:39], s72 offen offset:2048 lds
v_mfma_f32_16x16x32_bf16 v[148:151], a[156:159], v[44:47], v[148:151]
buffer_load_dwordx4 v1, s[36:39], s72 offen offset:3072 lds
v_mfma_f32_16x16x32_bf16 v[148:151], a[152:155], v[40:43], v[148:151]
s_waitcnt vmcnt(12) lgkmcnt(4)
v_exp_f32 v176, v176
v_mfma_f32_16x16x32_bf16 v[148:151], a[148:151], v[36:39], v[148:151]
s_barrier
v_cvt_pk_bf16_f32 v208, v160, v161
v_cvt_pk_bf16_f32 v209, v162, v163
v_add_u32 v2, s82, v1
v_exp_f32 v177, v177
v_exp_f32 v178, v178
v_cvt_pk_bf16_f32 v210, v176, v177
v_exp_f32 v179, v179
v_exp_f32 v168, v168
v_cvt_pk_bf16_f32 v211, v178, v179
v_exp_f32 v169, v169
v_exp_f32 v170, v170
v_cvt_pk_bf16_f32 v216, v168, v169
v_exp_f32 v171, v171
v_exp_f32 v184, v184
v_cvt_pk_bf16_f32 v217, v170, v171
v_exp_f32 v185, v185
v_exp_f32 v186, v186
v_cvt_pk_bf16_f32 v218, v184, v185
v_exp_f32 v187, v187
s_nop 0
v_cvt_pk_bf16_f32 v219, v186, v187
s_branch LLT3
.p2align 12
s_endpgm
.p2align 7
LLT3x:
Lstub11:
s_cbranch_execz Lret
v_mfma_f32_16x16x32_bf16 v[228:231], v[120:123], v[196:199], v[228:231]
s_xor_b32 s74, s82, 0x10000
ds_read_b128 a[128:131], v2 offset:16384
v_and_b32 v240, 15, v0
v_mfma_f32_16x16x32_bf16 v[228:231], v[120:123], v[212:215], v[228:231]
s_add_u32 s74, s74, s64
v_exp_f32 v136, v136
v_mfma_f32_16x16x32_bf16 v[236:239], v[120:123], v[204:207], v[236:239]
s_add_u32 s81, s81, 0x8000
v_exp_f32 v137, v137
v_mfma_f32_16x16x32_bf16 v[236:239], v[120:123], v[220:223], v[236:239]
s_add_u32 m0, s74, 0
ds_read_b128 a[132:135], v2 offset:17408
v_cvt_pk_bf16_f32 v200, v136, v137
v_mfma_f32_16x16x32_bf16 a[32:35], a[192:195], v[196:199], a[32:35]
s_add_u32 s72, s81, 0
buffer_load_dwordx4 v1, s[44:47], s72 offen sc1 lds
v_mfma_f32_16x16x32_bf16 a[32:35], a[224:227], v[212:215], a[32:35]
s_add_u32 s69, s93, 0x3e00000
v_exp_f32 v138, v138
v_mfma_f32_16x16x32_bf16 a[96:99], a[224:227], v[220:223], a[96:99]
ds_read_b128 a[136:139], v2 offset:18432
v_lshrrev_b32 v241, 4, v0
v_mfma_f32_16x16x32_bf16 a[96:99], a[192:195], v[204:207], a[96:99]
v_exp_f32 v139, v139
v_mfma_f32_16x16x32_bf16 a[100:103], a[196:199], v[204:207], a[100:103]
buffer_store_dwordx4 v[112:115], v1, s[44:47], s69 offen sc1
v_mfma_f32_16x16x32_bf16 a[100:103], a[228:231], v[220:223], a[100:103]
v_exp_f32 v152, v152
v_mfma_f32_16x16x32_bf16 a[36:39], a[228:231], v[212:215], a[36:39]
ds_read_b128 a[140:143], v2 offset:19456
v_cvt_pk_bf16_f32 v201, v138, v139
v_mfma_f32_16x16x32_bf16 a[36:39], a[196:199], v[196:199], a[36:39]
v_exp_f32 v153, v153
v_mfma_f32_16x16x32_bf16 a[40:43], a[200:203], v[196:199], a[40:43]
buffer_load_dwordx4 v1, s[44:47], s72 offen offset:1024 sc1 lds
v_mfma_f32_16x16x32_bf16 a[40:43], a[232:235], v[212:215], a[40:43]
ds_read_b128 a[144:147], v2 offset:20480
v_cvt_pk_bf16_f32 v202, v152, v153
v_mfma_f32_16x16x32_bf16 a[104:107], a[232:235], v[220:223], a[104:107]
v_exp_f32 v154, v154
v_mfma_f32_16x16x32_bf16 a[104:107], a[200:203], v[204:207], a[104:107]
v_exp_f32 v155, v155
v_mfma_f32_16x16x32_bf16 a[108:111], a[204:207], v[204:207], a[108:111]
buffer_store_dwordx4 v[112:115], v1, s[44:47], s69 offen offset:1024 sc1
v_mfma_f32_16x16x32_bf16 a[108:111], a[236:239], v[220:223], a[108:111]
ds_read_b128 a[148:151], v2 offset:21504
v_cvt_pk_bf16_f32 v203, v154, v155
v_mfma_f32_16x16x32_bf16 a[44:47], a[236:239], v[212:215], a[44:47]
v_exp_f32 v132, v132
v_mfma_f32_16x16x32_bf16 a[44:47], a[204:207], v[196:199], a[44:47]
ds_read_b128 a[152:155], v2 offset:22528
v_add_u32 v248, 1, v240
v_mfma_f32_16x16x32_bf16 a[48:51], a[208:211], v[196:199], a[48:51]
s_waitcnt lgkmcnt(7)
v_exp_f32 v133, v133
v_mfma_f32_16x16x32_bf16 a[48:51], a[240:243], v[212:215], a[48:51]
buffer_load_dwordx4 v1, s[44:47], s72 offen offset:2048 sc1 lds
v_mfma_f32_16x16x32_bf16 a[112:115], a[240:243], v[220:223], a[112:115]
v_exp_f32 v134, v134
v_mfma_f32_16x16x32_bf16 a[112:115], a[208:211], v[204:207], a[112:115]
ds_read_b128 a[156:159], v2 offset:23552
v_and_b32 v249, 3, v248
v_mfma_f32_16x16x32_bf16 a[116:119], a[212:215], v[204:207], a[116:119]
v_exp_f32 v135, v135
v_mfma_f32_16x16x32_bf16 a[116:119], a[244:247], v[220:223], a[116:119]
buffer_store_dwordx4 v[112:115], v1, s[44:47], s69 offen offset:2048 sc1
v_mfma_f32_16x16x32_bf16 a[52:55], a[244:247], v[212:215], a[52:55]
ds_read_b128 a[192:195], v2 offset:0
v_lshrrev_b32 v248, 2, v248
v_mfma_f32_16x16x32_bf16 a[52:55], a[212:215], v[196:199], a[52:55]
v_exp_f32 v148, v148
v_mfma_f32_16x16x32_bf16 a[56:59], a[216:219], v[196:199], a[56:59]
buffer_load_dwordx4 v1, s[44:47], s72 offen offset:3072 sc1 lds
v_mfma_f32_16x16x32_bf16 a[56:59], a[248:251], v[212:215], a[56:59]
v_exp_f32 v149, v149
v_mfma_f32_16x16x32_bf16 a[120:123], a[248:251], v[220:223], a[120:123]
ds_read_b128 a[196:199], v2 offset:1024
v_mov_b32 v250, 0x20000
v_mfma_f32_16x16x32_bf16 a[120:123], a[216:219], v[204:207], a[120:123]
v_exp_f32 v150, v150
v_mfma_f32_16x16x32_bf16 a[124:127], a[220:223], v[204:207], a[124:127]
ds_read_b128 a[200:203], v2 offset:2048
v_mov_b32 v252, 0x20001
v_mfma_f32_16x16x32_bf16 a[124:127], a[252:255], v[220:223], a[124:127]
buffer_store_dwordx4 v[112:115], v1, s[44:47], s69 offen offset:3072 sc1
v_mfma_f32_16x16x32_bf16 a[60:63], a[252:255], v[212:215], a[60:63]
s_add_u32 s69, s93, 0x4200000
v_exp_f32 v151, v151
v_mfma_f32_16x16x32_bf16 a[60:63], a[220:223], v[196:199], a[60:63]
ds_read_b128 a[204:207], v2 offset:3072
v_cvt_pk_bf16_f32 v196, v132, v133
s_cmp_eq_u32 s58, 2
s_cbranch_scc1 Lta40
s_cmp_eq_u32 s58, 3
s_cbranch_scc1 Lnt41
v_mfma_f32_16x16x32_bf16 v[164:167], a[160:163], v[32:35], v[112:115]
ds_read_b128 a[208:211], v2 offset:4096
v_cvt_pk_bf16_f32 v197, v134, v135
v_mfma_f32_16x16x32_bf16 v[180:183], a[176:179], v[32:35], v[112:115]
v_exp_f32 v140, v140
s_branch Ljoin42
Lta40:
v_mfma_f32_16x16x32_bf16 v[164:167], a[160:163], v[32:35], v[100:103]
ds_read_b128 a[208:211], v2 offset:4096
v_cvt_pk_bf16_f32 v197, v134, v135
v_mfma_f32_16x16x32_bf16 v[180:183], a[176:179], v[32:35], v[112:115]
v_exp_f32 v140, v140
s_branch Ljoin42
Lnt41:
v_mfma_f32_16x16x32_bf16 v[164:167], a[160:163], v[32:35], v[84:87]
ds_read_b128 a[208:211], v2 offset:4096
v_cvt_pk_bf16_f32 v197, v134, v135
v_mfma_f32_16x16x32_bf16 v[180:183], a[176:179], v[32:35], v[100:103]
v_exp_f32 v140, v140
Ljoin42:
v_mfma_f32_16x16x32_bf16 v[164:167], a[164:167], v[36:39], v[164:167]
ds_read_b128 a[212:215], v2 offset:5120
v_cvt_pk_bf16_f32 v198, v148, v149
v_mfma_f32_16x16x32_bf16 v[164:167], a[168:171], v[40:43], v[164:167]
buffer_store_dwordx4 v[112:115], v1, s[44:47], s69 offen sc1
v_mfma_f32_16x16x32_bf16 v[164:167], a[172:175], v[44:47], v[164:167]
v_exp_f32 v141, v141
v_mfma_f32_16x16x32_bf16 v[172:175], a[172:175], v[76:79], v[92:95]
v_exp_f32 v142, v142
v_mfma_f32_16x16x32_bf16 v[172:175], a[168:171], v[72:75], v[172:175]
ds_read_b128 a[216:219], v2 offset:6144
v_cvt_pk_bf16_f32 v199, v150, v151
v_mfma_f32_16x16x32_bf16 v[172:175], a[164:167], v[68:71], v[172:175]
buffer_store_dwordx4 v[112:115], v1, s[44:47], s69 offen offset:1024 sc1
v_mfma_f32_16x16x32_bf16 v[172:175], a[160:163], v[64:67], v[172:175]
v_exp_f32 v143, v143
v_mfma_f32_16x16x32_bf16 v[188:191], a[176:179], v[64:67], v[92:95]
v_exp_f32 v156, v156
v_mfma_f32_16x16x32_bf16 v[188:191], a[180:183], v[68:71], v[188:191]
ds_read_b128 a[220:223], v2 offset:7168
v_cvt_pk_bf16_f32 v204, v140, v141
v_mfma_f32_16x16x32_bf16 v[188:191], a[184:187], v[72:75], v[188:191]
buffer_store_dwordx4 v[112:115], v1, s[44:47], s69 offen offset:2048 sc1
v_mfma_f32_16x16x32_bf16 v[188:191], a[188:191], v[76:79], v[188:191]
v_exp_f32 v157, v157
v_mfma_f32_16x16x32_bf16 v[180:183], a[188:191], v[44:47], v[180:183]
v_exp_f32 v158, v158
v_mfma_f32_16x16x32_bf16 v[180:183], a[184:187], v[40:43], v[180:183]
v_cvt_pk_bf16_f32 v205, v142, v143
v_cvt_pk_bf16_f32 v206, v156, v157
v_mfma_f32_16x16x32_bf16 v[180:183], a[180:183], v[36:39], v[180:183]
buffer_store_dwordx4 v[112:115], v1, s[44:47], s69 offen offset:3072 sc1
v_mfma_f32_16x16x32_bf16 v[168:171], a[160:163], v[48:51], v[88:91]
v_exp_f32 v159, v159
v_mfma_f32_16x16x32_bf16 v[168:171], a[164:167], v[52:55], v[168:171]
v_cvt_pk_bf16_f32 v207, v158, v159
v_lshlrev_b32 v6, 3, v249
v_mfma_f32_16x16x32_bf16 v[168:171], a[168:171], v[56:59], v[168:171]
v_lshrrev_b32 v6, v6, v252
v_and_b32 v6, 3, v6
v_mfma_f32_16x16x32_bf16 v[168:171], a[172:175], v[60:63], v[168:171]
v_cmp_ne_u32 vcc, 1, v249
v_mul_u32_u24 v6, 16640, v6
v_mfma_f32_16x16x32_bf16 v[184:187], a[188:191], v[60:63], v[88:91]
v_add_u32 v6, s92, v6
v_cndmask_b32 v6, v250, v6, vcc
v_mfma_f32_16x16x32_bf16 v[184:187], a[184:187], v[56:59], v[184:187]
v_add_u32 v253, s58, v249
v_and_b32 v253, 3, v253
v_mfma_f32_16x16x32_bf16 v[184:187], a[180:183], v[52:55], v[184:187]
s_waitcnt lgkmcnt(4)
v_mfma_f32_16x16x32_bf16 v[184:187], a[176:179], v[48:51], v[184:187]
s_barrier
s_lshr_b32 s69, s93, 4
s_and_b32 s69, s69, 0x7f00
s_add_u32 s69, s69, LHT4-Lpc0
v_lshrrev_b32 v3, 5, v0
v_lshlrev_b32 v3, 7, v3
v_add_u32 v3, s69, v3
v_min_u32 v3, Lcode_end-Lpc0, v3
global_load_dword v4, v3, s[98:99]
v_mfma_f32_16x16x32_bf16 v[224:227], v[120:123], v[208:211], v[224:227]
s_add_u32 s82, s82, 0x8000
ds_read_b128 a[160:163], v2 offset:24576
ds_read_b128 a[164:167], v2 offset:25600
v_mfma_f32_16x16x32_bf16 v[232:235], v[120:123], v[216:219], v[232:235]
s_and_b32 s82, s82, 0x1ffff
v_exp_f32 v164, v164
v_mfma_f32_16x16x32_bf16 v[232:235], v[120:123], v[200:203], v[232:235]
s_add_u32 s66, s58, 3
v_exp_f32 v165, v165
v_mfma_f32_16x16x32_bf16 a[0:3], a[224:227], v[208:211], a[0:3]
s_and_b32 s66, s66, 3
v_exp_f32 v166, v166
v_mfma_f32_16x16x32_bf16 a[64:67], a[192:195], v[200:203], a[64:67]
s_mul_i32 s66, s66, 4160
ds_read_b128 a[168:171], v2 offset:26624
v_cvt_pk_bf16_f32 v212, v164, v165
v_mfma_f32_16x16x32_bf16 a[64:67], a[224:227], v[216:219], a[64:67]
s_add_u32 s66, s66, s92
v_exp_f32 v167, v167
v_mfma_f32_16x16x32_bf16 a[68:71], a[228:231], v[216:219], a[68:71]
s_add_u32 m0, s66, 32
v_exp_f32 v180, v180
v_mfma_f32_16x16x32_bf16 a[68:71], a[196:199], v[200:203], a[68:71]
s_add_u32 s72, s93, 0x6
buffer_load_dwordx4 v1, s[36:39], s72 offen lds
v_mfma_f32_16x16x32_bf16 a[4:7], a[228:231], v[208:211], a[4:7]
ds_read_b128 a[172:175], v2 offset:27648
v_cvt_pk_bf16_f32 v213, v166, v167
v_mfma_f32_16x16x32_bf16 a[8:11], a[232:235], v[208:211], a[8:11]
v_exp_f32 v181, v181
v_mfma_f32_16x16x32_bf16 a[72:75], a[200:203], v[200:203], a[72:75]
ds_read_b128 a[176:179], v2 offset:28672
v_cvt_pk_bf16_f32 v214, v180, v181
v_mfma_f32_16x16x32_bf16 a[72:75], a[232:235], v[216:219], a[72:75]
v_exp_f32 v182, v182
v_mfma_f32_16x16x32_bf16 a[76:79], a[236:239], v[216:219], a[76:79]
v_exp_f32 v183, v183
v_mfma_f32_16x16x32_bf16 a[76:79], a[204:207], v[200:203], a[76:79]
ds_read_b128 a[180:183], v2 offset:29696
v_cvt_pk_bf16_f32 v215, v182, v183
v_mfma_f32_16x16x32_bf16 a[12:15], a[236:239], v[208:211], a[12:15]
v_exp_f32 v172, v172
v_mfma_f32_16x16x32_bf16 a[16:19], a[240:243], v[208:211], a[16:19]
s_waitcnt lgkmcnt(6)
ds_read_b128 a[184:187], v2 offset:30720
ds_read_b128 a[188:191], v2 offset:31744
v_mfma_f32_16x16x32_bf16 a[80:83], a[208:211], v[200:203], a[80:83]
v_exp_f32 v173, v173
v_mfma_f32_16x16x32_bf16 a[80:83], a[240:243], v[216:219], a[80:83]
buffer_load_dwordx4 v1, s[36:39], s72 offen offset:1024 lds
v_mfma_f32_16x16x32_bf16 a[84:87], a[244:247], v[216:219], a[84:87]
v_exp_f32 v174, v174
v_mfma_f32_16x16x32_bf16 a[84:87], a[212:215], v[200:203], a[84:87]
v_exp_f32 v175, v175
v_mfma_f32_16x16x32_bf16 a[20:23], a[244:247], v[208:211], a[20:23]
ds_read_b128 a[224:227], v2 offset:8192
v_cvt_pk_bf16_f32 v220, v172, v173
v_mfma_f32_16x16x32_bf16 a[24:27], a[248:251], v[208:211], a[24:27]
v_exp_f32 v188, v188
v_mfma_f32_16x16x32_bf16 a[88:91], a[216:219], v[200:203], a[88:91]
v_exp_f32 v189, v189
v_mfma_f32_16x16x32_bf16 a[88:91], a[248:251], v[216:219], a[88:91]
ds_read_b128 a[228:231], v2 offset:9216
v_cvt_pk_bf16_f32 v221, v174, v175
v_mfma_f32_16x16x32_bf16 a[92:95], a[252:255], v[216:219], a[92:95]
v_exp_f32 v190, v190
v_mfma_f32_16x16x32_bf16 a[92:95], a[220:223], v[200:203], a[92:95]
ds_read_b128 a[232:235], v2 offset:10240
v_cvt_pk_bf16_f32 v222, v188, v189
v_mfma_f32_16x16x32_bf16 a[28:31], a[252:255], v[208:211], a[28:31]
v_exp_f32 v191, v191
s_cmp_eq_u32 s58, 0
s_cbranch_scc1 Lta43
s_cmp_eq_u32 s58, 1
s_cbranch_scc1 Lnt44
v_mfma_f32_16x16x32_bf16 v[136:139], a[128:131], v[48:51], v[88:91]
buffer_load_dwordx4 v1, s[36:39], s72 offen offset:2048 lds
v_mfma_f32_16x16x32_bf16 v[152:155], a[144:147], v[48:51], v[88:91]
v_exp_f32 v168, v168
s_branch Ljoin45
Lta43:
v_mfma_f32_16x16x32_bf16 v[136:139], a[128:131], v[48:51], v[104:107]
buffer_load_dwordx4 v1, s[36:39], s72 offen offset:2048 lds
v_mfma_f32_16x16x32_bf16 v[152:155], a[144:147], v[48:51], v[112:115]
v_exp_f32 v168, v168
s_branch Ljoin45
Lnt44:
v_mfma_f32_16x16x32_bf16 v[136:139], a[128:131], v[48:51], v[88:91]
buffer_load_dwordx4 v1, s[36:39], s72 offen offset:2048 lds
v_mfma_f32_16x16x32_bf16 v[152:155], a[144:147], v[48:51], v[104:107]
v_exp_f32 v168, v168
Ljoin45:
v_mfma_f32_16x16x32_bf16 v[136:139], a[132:135], v[52:55], v[136:139]
ds_read_b128 a[236:239], v2 offset:11264
v_cvt_pk_bf16_f32 v223, v190, v191
v_mfma_f32_16x16x32_bf16 v[136:139], a[136:139], v[56:59], v[136:139]
v_exp_f32 v169, v169
v_mfma_f32_16x16x32_bf16 v[136:139], a[140:143], v[60:63], v[136:139]
ds_read_b128 a[240:243], v2 offset:12288
v_cvt_pk_bf16_f32 v216, v168, v169
v_mfma_f32_16x16x32_bf16 v[152:155], a[156:159], v[60:63], v[152:155]
v_exp_f32 v170, v170
v_mfma_f32_16x16x32_bf16 v[152:155], a[152:155], v[56:59], v[152:155]
v_exp_f32 v171, v171
v_mfma_f32_16x16x32_bf16 v[152:155], a[148:151], v[52:55], v[152:155]
ds_read_b128 a[244:247], v2 offset:13312
v_cvt_pk_bf16_f32 v217, v170, v171
v_mfma_f32_16x16x32_bf16 v[140:143], a[128:131], v[64:67], v[92:95]
v_exp_f32 v184, v184
v_mfma_f32_16x16x32_bf16 v[140:143], a[132:135], v[68:71], v[140:143]
ds_read_b128 a[248:251], v2 offset:14336
v_mfma_f32_16x16x32_bf16 v[140:143], a[136:139], v[72:75], v[140:143]
v_exp_f32 v185, v185
v_mfma_f32_16x16x32_bf16 v[140:143], a[140:143], v[76:79], v[140:143]
buffer_load_dwordx4 v1, s[36:39], s72 offen offset:3072 lds
v_mfma_f32_16x16x32_bf16 v[156:159], a[156:159], v[76:79], v[92:95]
ds_read_b128 a[252:255], v2 offset:15360
v_cvt_pk_bf16_f32 v218, v184, v185
v_mfma_f32_16x16x32_bf16 v[156:159], a[152:155], v[72:75], v[156:159]
v_exp_f32 v186, v186
v_mfma_f32_16x16x32_bf16 v[156:159], a[148:151], v[68:71], v[156:159]
s_waitcnt vmcnt(17) lgkmcnt(0)
v_exp_f32 v187, v187
v_mfma_f32_16x16x32_bf16 v[156:159], a[144:147], v[64:67], v[156:159]
s_barrier
v_cvt_pk_bf16_f32 v219, v186, v187
v_add_u32 v2, s82, v1
v_mfma_f32_16x16x32_bf16 v[228:231], v[120:123], v[196:199], v[228:231]
s_mov_b32 m0, s62
v_exp_f32 v136, v136
v_mfma_f32_16x16x32_bf16 v[228:231], v[120:123], v[212:215], v[228:231]
s_add_u32 s72, s93, 0x3000000
ds_read_b128 a[128:131], v2 offset:16384
v_mul_u32_u24 v253, 4160, v253
v_mfma_f32_16x16x32_bf16 v[236:239], v[120:123], v[204:207], v[236:239]
buffer_load_dwordx4 v1, s[44:47], s72 offen sc1 lds
v_mfma_f32_16x16x32_bf16 v[236:239], v[120:123], v[220:223], v[236:239]
v_exp_f32 v137, v137
v_mfma_f32_16x16x32_bf16 a[32:35], a[192:195], v[196:199], a[32:35]
ds_read_b128 a[132:135], v2 offset:17408
v_cvt_pk_bf16_f32 v200, v136, v137
v_mfma_f32_16x16x32_bf16 a[32:35], a[224:227], v[212:215], a[32:35]
v_exp_f32 v138, v138
v_mfma_f32_16x16x32_bf16 a[96:99], a[224:227], v[220:223], a[96:99]
ds_read_b128 a[136:139], v2 offset:18432
v_add_u32 v6, v6, v253
v_mfma_f32_16x16x32_bf16 a[96:99], a[192:195], v[204:207], a[96:99]
buffer_load_dwordx4 v1, s[44:47], s72 offen offset:1024 sc1 lds
v_mfma_f32_16x16x32_bf16 a[100:103], a[196:199], v[204:207], a[100:103]
v_exp_f32 v139, v139
v_mfma_f32_16x16x32_bf16 a[100:103], a[228:231], v[220:223], a[100:103]
ds_read_b128 a[140:143], v2 offset:19456
v_cvt_pk_bf16_f32 v201, v138, v139
v_mfma_f32_16x16x32_bf16 a[36:39], a[228:231], v[212:215], a[36:39]
v_exp_f32 v152, v152
v_mfma_f32_16x16x32_bf16 a[36:39], a[196:199], v[196:199], a[36:39]
ds_read_b128 a[144:147], v2 offset:20480
v_bfe_u32 v251, v0, 2, 2
v_mfma_f32_16x16x32_bf16 a[40:43], a[200:203], v[196:199], a[40:43]
buffer_load_dwordx4 v1, s[44:47], s72 offen offset:2048 sc1 lds
v_mfma_f32_16x16x32_bf16 a[40:43], a[232:235], v[212:215], a[40:43]
v_exp_f32 v153, v153
v_mfma_f32_16x16x32_bf16 a[104:107], a[232:235], v[220:223], a[104:107]
ds_read_b128 a[148:151], v2 offset:21504
v_cvt_pk_bf16_f32 v202, v152, v153
v_mfma_f32_16x16x32_bf16 a[104:107], a[200:203], v[204:207], a[104:107]
buffer_load_dwordx4 v1, s[44:47], s72 offen offset:3072 sc1 lds
v_mfma_f32_16x16x32_bf16 a[108:111], a[204:207], v[204:207], a[108:111]
s_add_u32 s66, s58, 0
v_exp_f32 v154, v154
v_mfma_f32_16x16x32_bf16 a[108:111], a[236:239], v[220:223], a[108:111]
s_and_b32 s66, s66, 3
ds_read_b128 a[152:155], v2 offset:22528
v_lshl_add_u32 v6, v248, 3, v6
v_mfma_f32_16x16x32_bf16 a[44:47], a[236:239], v[212:215], a[44:47]
s_mul_i32 s66, s66, 4160
v_exp_f32 v155, v155
v_mfma_f32_16x16x32_bf16 a[44:47], a[204:207], v[196:199], a[44:47]
s_add_u32 s66, s66, s92
ds_read_b128 a[156:159], v2 offset:23552
v_cvt_pk_bf16_f32 v203, v154, v155
v_mfma_f32_16x16x32_bf16 a[48:51], a[208:211], v[196:199], a[48:51]
s_waitcnt lgkmcnt(8)
v_exp_f32 v140, v140
v_mfma_f32_16x16x32_bf16 a[48:51], a[240:243], v[212:215], a[48:51]
s_add_u32 m0, s66, 16672
ds_read_b128 a[192:195], v2 offset:0
v_lshl_add_u32 v6, v241, 4, v6
v_mfma_f32_16x16x32_bf16 a[112:115], a[240:243], v[220:223], a[112:115]
s_add_u32 s72, s93, 0x0
buffer_load_dwordx4 v1, s[36:39], s72 offen lds
v_mfma_f32_16x16x32_bf16 a[112:115], a[208:211], v[204:207], a[112:115]
buffer_load_dwordx4 v1, s[36:39], s72 offen offset:1024 lds
v_mfma_f32_16x16x32_bf16 a[116:119], a[212:215], v[204:207], a[116:119]
v_exp_f32 v141, v141
v_mfma_f32_16x16x32_bf16 a[116:119], a[244:247], v[220:223], a[116:119]
ds_read_b128 a[196:199], v2 offset:1024
v_lshlrev_b32 v5, 3, v251
v_mfma_f32_16x16x32_bf16 a[52:55], a[244:247], v[212:215], a[52:55]
v_exp_f32 v142, v142
v_mfma_f32_16x16x32_bf16 a[52:55], a[212:215], v[196:199], a[52:55]
ds_read_b128 a[200:203], v2 offset:2048
v_lshrrev_b32 v5, v5, v252
v_mfma_f32_16x16x32_bf16 a[56:59], a[216:219], v[196:199], a[56:59]
buffer_load_dwordx4 v1, s[36:39], s72 offen offset:2048 lds
v_mfma_f32_16x16x32_bf16 a[56:59], a[248:251], v[212:215], a[56:59]
v_exp_f32 v143, v143
v_mfma_f32_16x16x32_bf16 a[120:123], a[248:251], v[220:223], a[120:123]
ds_read_b128 a[204:207], v2 offset:3072
v_and_b32 v5, 3, v5
v_mfma_f32_16x16x32_bf16 a[120:123], a[216:219], v[204:207], a[120:123]
v_exp_f32 v156, v156
v_mfma_f32_16x16x32_bf16 a[124:127], a[220:223], v[204:207], a[124:127]
ds_read_b128 a[208:211], v2 offset:4096
v_cmp_ne_u32 vcc, 1, v251
v_mfma_f32_16x16x32_bf16 a[124:127], a[252:255], v[220:223], a[124:127]
buffer_load_dwordx4 v1, s[36:39], s72 offen offset:3072 lds
v_mfma_f32_16x16x32_bf16 a[60:63], a[252:255], v[212:215], a[60:63]
s_add_u32 s66, s58, 2
v_exp_f32 v157, v157
v_mfma_f32_16x16x32_bf16 a[60:63], a[220:223], v[196:199], a[60:63]
s_and_b32 s66, s66, 3
ds_read_b128 a[212:215], v2 offset:5120
v_cvt_pk_bf16_f32 v204, v140, v141
s_cmp_eq_u32 s58, 2
s_cbranch_scc1 Lta46
s_cmp_eq_u32 s58, 3
s_cbranch_scc1 Lnt47
v_mfma_f32_16x16x32_bf16 v[168:171], a[160:163], v[48:51], v[112:115]
s_mul_i32 s66, s66, 4160
v_exp_f32 v158, v158
v_mfma_f32_16x16x32_bf16 v[184:187], a[176:179], v[48:51], v[112:115]
s_add_u32 s66, s66, s92
ds_read_b128 a[216:219], v2 offset:6144
v_cvt_pk_bf16_f32 v205, v142, v143
s_branch Ljoin48
Lta46:
v_mfma_f32_16x16x32_bf16 v[168:171], a[160:163], v[48:51], v[104:107]
s_mul_i32 s66, s66, 4160
v_exp_f32 v158, v158
v_mfma_f32_16x16x32_bf16 v[184:187], a[176:179], v[48:51], v[112:115]
s_add_u32 s66, s66, s92
ds_read_b128 a[216:219], v2 offset:6144
v_cvt_pk_bf16_f32 v205, v142, v143
s_branch Ljoin48
Lnt47:
v_mfma_f32_16x16x32_bf16 v[168:171], a[160:163], v[48:51], v[88:91]
s_mul_i32 s66, s66, 4160
v_exp_f32 v158, v158
v_mfma_f32_16x16x32_bf16 v[184:187], a[176:179], v[48:51], v[104:107]
s_add_u32 s66, s66, s92
ds_read_b128 a[216:219], v2 offset:6144
v_cvt_pk_bf16_f32 v205, v142, v143
Ljoin48:
v_mfma_f32_16x16x32_bf16 v[172:175], a[160:163], v[64:67], v[92:95]
s_add_u32 m0, s66, 33312
v_exp_f32 v159, v159
v_mfma_f32_16x16x32_bf16 v[172:175], a[164:167], v[68:71], v[172:175]
s_add_u32 s72, s93, 0x4
buffer_load_dwordx4 v1, s[36:39], s72 offen lds
v_mfma_f32_16x16x32_bf16 v[172:175], a[168:171], v[72:75], v[172:175]
ds_read_b128 a[220:223], v2 offset:7168
v_cvt_pk_bf16_f32 v206, v156, v157
v_mfma_f32_16x16x32_bf16 v[172:175], a[172:175], v[76:79], v[172:175]
buffer_load_dwordx4 v1, s[36:39], s72 offen offset:1024 lds
v_mfma_f32_16x16x32_bf16 v[188:191], a[188:191], v[76:79], v[92:95]
v_cvt_pk_bf16_f32 v207, v158, v159
v_mul_u32_u24 v5, 16640, v5
v_mfma_f32_16x16x32_bf16 v[188:191], a[184:187], v[72:75], v[188:191]
v_add_u32 v5, s92, v5
v_cndmask_b32 v5, v250, v5, vcc
v_mfma_f32_16x16x32_bf16 v[188:191], a[180:183], v[68:71], v[188:191]
v_add_u32 v253, s58, v251
v_and_b32 v253, 3, v253
v_mfma_f32_16x16x32_bf16 v[188:191], a[176:179], v[64:67], v[188:191]
v_mul_u32_u24 v253, 4160, v253
v_add_u32 v5, v5, v253
v_mfma_f32_16x16x32_bf16 v[168:171], a[164:167], v[52:55], v[168:171]
s_add_u32 s73, s62, 480
v_lshlrev_b32 v248, 5, v240
v_sub_u32 v248, s73, v248
v_mfma_f32_16x16x32_bf16 v[168:171], a[168:171], v[56:59], v[168:171]
v_lshl_add_u32 v7, v241, 4, v248
v_mfma_f32_16x16x32_bf16 v[168:171], a[172:175], v[60:63], v[168:171]
s_and_b32 s73, s58, 1
v_mfma_f32_16x16x32_bf16 v[184:187], a[188:191], v[60:63], v[184:187]
s_lshl_b32 s73, s73, 4
v_mfma_f32_16x16x32_bf16 v[184:187], a[184:187], v[56:59], v[184:187]
s_lshr_b32 s73, s90, s73
v_mfma_f32_16x16x32_bf16 v[184:187], a[180:183], v[52:55], v[184:187]
s_waitcnt lgkmcnt(4)
s_and_b32 s73, s73, 0xffff
v_lshl_add_u32 v248, v241, 3, v240
v_sub_u32 v248, 15, v248
v_and_b32 v249, 1, v248
v_lshlrev_b32 v249, 4, v249
v_lshlrev_b32 v249, v249, s73
v_lshrrev_b32 v248, 1, v248
v_and_b32 v241, 3, v0
v_cmp_eq_u32 vcc, 0, v248
v_lshl_add_u32 v5, v241, 3, v5
s_nop 0
v_cndmask_b32 v8, 0, v249, vcc
v_cmp_eq_u32 vcc, 1, v248
v_lshlrev_b32 v240, 4, v251
s_nop 0
v_cndmask_b32 v9, 0, v249, vcc
v_cmp_eq_u32 vcc, 2, v248
v_sub_u32 v240, 48, v240
v_lshlrev_b64 v[12:13], 16, s[88:89]
v_cndmask_b32 v10, 0, v249, vcc
v_cmp_eq_u32 vcc, 3, v248
v_lshlrev_b64 v[12:13], v240, v[12:13]
s_nop 0
v_cndmask_b32 v11, 0, v249, vcc
v_cmp_eq_u32 vcc, 3, v241
s_add_u32 s73, s62, 4096
v_lshl_add_u32 v14, v0, 3, s73
v_cndmask_b32 v12, 0, v12, vcc
v_cndmask_b32 v13, 0, v13, vcc
v_lshrrev_b32 v15, 4, v0
v_lshlrev_b32 v15, 1, v15
v_and_b32 v240, 7, v0
v_xor_b32 v15, v15, v240
v_lshlrev_b32 v15, 4, v15
v_lshrrev_b32 v240, 3, v0
v_lshl_add_u32 v15, v240, 11, v15
s_lshl_b32 s75, s59, 1
s_andn2_b32 s75, 8, s75
s_add_u32 s75, s75, s60
s_lshl_b32 s76, s65, 2
s_lshr_b32 s80, s59, 3
s_add_u32 s76, s76, s80
s_lshl_b32 s94, s58, 16
s_lshl_b32 s80, s76, 7
s_add_u32 s94, s94, s80
s_lshl_b32 s80, s75, 18
s_add_u32 s80, s80, s94
v_rcp_f32 v224, v224
v_rcp_f32 v228, v228
s_lshl_b32 s73, s52, 12
s_add_u32 s73, s73, 0x2000000
s_lshl_b32 s70, s67, 2
s_add_u32 s70, s70, s73
v_or_b32 v3, s53, v1
v_mov_b32 v225, v224
v_accvgpr_read_b32 v240, a0
v_accvgpr_read_b32 v241, a1
v_accvgpr_read_b32 v242, a2
v_accvgpr_read_b32 v243, a3
v_accvgpr_read_b32 v244, a4
v_accvgpr_read_b32 v245, a5
v_accvgpr_read_b32 v246, a6
v_accvgpr_read_b32 v247, a7
v_pk_mul_f32 v[240:241], v[240:241], v[224:225]
v_pk_mul_f32 v[242:243], v[242:243], v[224:225]
v_pk_mul_f32 v[244:245], v[244:245], v[224:225]
buffer_load_dwordx4 v1, s[36:39], s72 offen offset:2048 lds
v_pk_mul_f32 v[246:247], v[246:247], v[224:225]
v_cvt_pk_bf16_f32 v128, v240, v241
v_cvt_pk_bf16_f32 v129, v242, v243
v_cvt_pk_bf16_f32 v130, v244, v245
v_cvt_pk_bf16_f32 v131, v246, v247
v_accvgpr_read_b32 v248, a8
v_accvgpr_read_b32 v249, a9
v_accvgpr_read_b32 v250, a10
v_accvgpr_read_b32 v251, a11
v_accvgpr_read_b32 v252, a12
v_accvgpr_read_b32 v253, a13
v_accvgpr_read_b32 v254, a14
v_accvgpr_read_b32 v255, a15
v_pk_mul_f32 v[248:249], v[248:249], v[224:225]
v_pk_mul_f32 v[250:251], v[250:251], v[224:225]
v_pk_mul_f32 v[252:253], v[252:253], v[224:225]
v_pk_mul_f32 v[254:255], v[254:255], v[224:225]
v_cvt_pk_bf16_f32 v144, v248, v249
buffer_load_dwordx4 v1, s[36:39], s72 offen offset:3072 lds
v_cvt_pk_bf16_f32 v145, v250, v251
v_cvt_pk_bf16_f32 v146, v252, v253
v_cvt_pk_bf16_f32 v147, v254, v255
v_accvgpr_read_b32 v240, a16
v_accvgpr_read_b32 v241, a17
v_accvgpr_read_b32 v242, a18
v_accvgpr_read_b32 v243, a19
v_accvgpr_read_b32 v244, a20
v_accvgpr_read_b32 v245, a21
v_accvgpr_read_b32 v246, a22
v_accvgpr_read_b32 v247, a23
v_pk_mul_f32 v[240:241], v[240:241], v[224:225]
v_pk_mul_f32 v[242:243], v[242:243], v[224:225]
v_pk_mul_f32 v[244:245], v[244:245], v[224:225]
v_pk_mul_f32 v[246:247], v[246:247], v[224:225]
v_cvt_pk_bf16_f32 v160, v240, v241
v_cvt_pk_bf16_f32 v161, v242, v243
v_cvt_pk_bf16_f32 v162, v244, v245
buffer_load_dwordx4 v[80:83], v15, s[4:7], s80 offen
v_cvt_pk_bf16_f32 v163, v246, v247
v_accvgpr_read_b32 v248, a24
v_accvgpr_read_b32 v249, a25
v_accvgpr_read_b32 v250, a26
v_accvgpr_read_b32 v251, a27
v_accvgpr_read_b32 v252, a28
v_accvgpr_read_b32 v253, a29
v_accvgpr_read_b32 v254, a30
v_accvgpr_read_b32 v255, a31
v_pk_mul_f32 v[248:249], v[248:249], v[224:225]
v_pk_mul_f32 v[250:251], v[250:251], v[224:225]
v_pk_mul_f32 v[252:253], v[252:253], v[224:225]
v_pk_mul_f32 v[254:255], v[254:255], v[224:225]
v_cvt_pk_bf16_f32 v176, v248, v249
v_cvt_pk_bf16_f32 v177, v250, v251
v_cvt_pk_bf16_f32 v178, v252, v253
v_cvt_pk_bf16_f32 v179, v254, v255
v_mov_b32 v229, v228
v_accvgpr_read_b32 v240, a32
s_add_u32 s80, s80, 0x4000
buffer_load_dwordx4 v[84:87], v15, s[4:7], s80 offen
v_accvgpr_read_b32 v241, a33
v_accvgpr_read_b32 v242, a34
v_accvgpr_read_b32 v243, a35
v_accvgpr_read_b32 v244, a36
v_accvgpr_read_b32 v245, a37
v_accvgpr_read_b32 v246, a38
v_accvgpr_read_b32 v247, a39
v_pk_mul_f32 v[240:241], v[240:241], v[228:229]
v_pk_mul_f32 v[242:243], v[242:243], v[228:229]
v_pk_mul_f32 v[244:245], v[244:245], v[228:229]
v_pk_mul_f32 v[246:247], v[246:247], v[228:229]
v_cvt_pk_bf16_f32 v132, v240, v241
v_cvt_pk_bf16_f32 v133, v242, v243
v_cvt_pk_bf16_f32 v134, v244, v245
v_cvt_pk_bf16_f32 v135, v246, v247
v_accvgpr_read_b32 v248, a40
v_accvgpr_read_b32 v249, a41
v_accvgpr_read_b32 v250, a42
s_add_u32 s80, s80, 0x4000
buffer_load_dwordx4 v[96:99], v15, s[4:7], s80 offen
v_accvgpr_read_b32 v251, a43
v_accvgpr_read_b32 v252, a44
v_accvgpr_read_b32 v253, a45
v_accvgpr_read_b32 v254, a46
v_accvgpr_read_b32 v255, a47
v_pk_mul_f32 v[248:249], v[248:249], v[228:229]
v_pk_mul_f32 v[250:251], v[250:251], v[228:229]
v_pk_mul_f32 v[252:253], v[252:253], v[228:229]
v_pk_mul_f32 v[254:255], v[254:255], v[228:229]
v_cvt_pk_bf16_f32 v148, v248, v249
v_cvt_pk_bf16_f32 v149, v250, v251
v_cvt_pk_bf16_f32 v150, v252, v253
v_cvt_pk_bf16_f32 v151, v254, v255
v_accvgpr_read_b32 v240, a48
v_accvgpr_read_b32 v241, a49
v_accvgpr_read_b32 v242, a50
v_accvgpr_read_b32 v243, a51
v_accvgpr_read_b32 v244, a52
s_add_u32 s80, s80, 0x4000
buffer_load_dwordx4 v[100:103], v15, s[4:7], s80 offen
v_accvgpr_read_b32 v245, a53
v_accvgpr_read_b32 v246, a54
v_accvgpr_read_b32 v247, a55
v_pk_mul_f32 v[240:241], v[240:241], v[228:229]
v_pk_mul_f32 v[242:243], v[242:243], v[228:229]
v_pk_mul_f32 v[244:245], v[244:245], v[228:229]
v_pk_mul_f32 v[246:247], v[246:247], v[228:229]
v_cvt_pk_bf16_f32 v164, v240, v241
v_cvt_pk_bf16_f32 v165, v242, v243
v_cvt_pk_bf16_f32 v166, v244, v245
v_cvt_pk_bf16_f32 v167, v246, v247
v_accvgpr_read_b32 v248, a56
v_accvgpr_read_b32 v249, a57
v_accvgpr_read_b32 v250, a58
v_accvgpr_read_b32 v251, a59
v_accvgpr_read_b32 v252, a60
v_accvgpr_read_b32 v253, a61
v_accvgpr_read_b32 v254, a62
v_accvgpr_read_b32 v255, a63
v_pk_mul_f32 v[248:249], v[248:249], v[228:229]
v_pk_mul_f32 v[250:251], v[250:251], v[228:229]
v_pk_mul_f32 v[252:253], v[252:253], v[228:229]
v_pk_mul_f32 v[254:255], v[254:255], v[228:229]
v_cvt_pk_bf16_f32 v180, v248, v249
v_cvt_pk_bf16_f32 v181, v250, v251
v_cvt_pk_bf16_f32 v182, v252, v253
v_cvt_pk_bf16_f32 v183, v254, v255
v_mfma_f32_16x16x32_bf16 v[232:235], v[120:123], v[216:219], v[232:235]
s_add_u32 s82, s82, 0x8000
ds_read_b128 a[160:163], v2 offset:24576
ds_read_b128 a[164:167], v2 offset:25600
v_mfma_f32_16x16x32_bf16 v[232:235], v[120:123], v[200:203], v[232:235]
s_and_b32 s82, s82, 0x1ffff
v_exp_f32 v172, v172
v_mfma_f32_16x16x32_bf16 a[64:67], a[224:227], v[216:219], a[64:67]
v_exp_f32 v173, v173
v_mfma_f32_16x16x32_bf16 a[64:67], a[192:195], v[200:203], a[64:67]
s_nop 0
ds_read_b128 a[168:171], v2 offset:26624
ds_read_b128 a[172:175], v2 offset:27648
v_mfma_f32_16x16x32_bf16 a[68:71], a[196:199], v[200:203], a[68:71]
v_exp_f32 v174, v174
v_mfma_f32_16x16x32_bf16 a[68:71], a[228:231], v[216:219], a[68:71]
v_exp_f32 v175, v175
v_mfma_f32_16x16x32_bf16 a[72:75], a[232:235], v[216:219], a[72:75]
buffer_store_dwordx4 v[128:131], v3, s[44:47], s70 offen sc1
v_mfma_f32_16x16x32_bf16 a[72:75], a[200:203], v[200:203], a[72:75]
s_nop 0
ds_read_b128 a[176:179], v2 offset:28672
ds_read_b128 a[180:183], v2 offset:29696
v_mfma_f32_16x16x32_bf16 a[76:79], a[204:207], v[200:203], a[76:79]
v_exp_f32 v188, v188
v_mfma_f32_16x16x32_bf16 a[76:79], a[236:239], v[216:219], a[76:79]
s_nop 0
ds_read_b128 a[184:187], v2 offset:30720
ds_read_b128 a[188:191], v2 offset:31744
v_mfma_f32_16x16x32_bf16 a[80:83], a[240:243], v[216:219], a[80:83]
s_waitcnt lgkmcnt(8)
ds_read_b128 a[224:227], v2 offset:8192
ds_read_b128 a[228:231], v2 offset:9216
v_mfma_f32_16x16x32_bf16 a[80:83], a[208:211], v[200:203], a[80:83]
s_nop 0
ds_read_b128 a[232:235], v2 offset:10240
ds_read_b128 a[236:239], v2 offset:11264
v_mfma_f32_16x16x32_bf16 a[84:87], a[212:215], v[200:203], a[84:87]
ds_read_b128 a[240:243], v2 offset:12288
v_cvt_pk_bf16_f32 v220, v172, v173
v_mfma_f32_16x16x32_bf16 a[84:87], a[244:247], v[216:219], a[84:87]
v_exp_f32 v189, v189
v_mfma_f32_16x16x32_bf16 a[88:91], a[248:251], v[216:219], a[88:91]
v_exp_f32 v190, v190
v_mfma_f32_16x16x32_bf16 a[88:91], a[216:219], v[200:203], a[88:91]
s_nop 0
ds_read_b128 a[244:247], v2 offset:13312
ds_read_b128 a[248:251], v2 offset:14336
v_mfma_f32_16x16x32_bf16 a[92:95], a[220:223], v[200:203], a[92:95]
v_cvt_pk_bf16_f32 v221, v174, v175
v_cvt_pk_bf16_f32 v222, v188, v189
v_mfma_f32_16x16x32_bf16 a[92:95], a[252:255], v[216:219], a[92:95]
v_exp_f32 v191, v191
s_cmp_eq_u32 s58, 0
s_cbranch_scc1 Lta49
s_cmp_eq_u32 s58, 1
s_cbranch_scc1 Lnt50
v_mfma_f32_16x16x32_bf16 v[140:143], a[128:131], v[64:67], v[92:95]
v_exp_f32 v168, v168
v_mfma_f32_16x16x32_bf16 v[156:159], a[144:147], v[64:67], v[92:95]
buffer_store_dwordx4 v[144:147], v3, s[44:47], s70 offen offset:1024 sc1
s_branch Ljoin51
Lta49:
v_mfma_f32_16x16x32_bf16 v[140:143], a[128:131], v[64:67], v[108:111]
v_exp_f32 v168, v168
v_mfma_f32_16x16x32_bf16 v[156:159], a[144:147], v[64:67], v[112:115]
buffer_store_dwordx4 v[144:147], v3, s[44:47], s70 offen offset:1024 sc1
s_branch Ljoin51
Lnt50:
v_mfma_f32_16x16x32_bf16 v[140:143], a[128:131], v[64:67], v[92:95]
v_exp_f32 v168, v168
v_mfma_f32_16x16x32_bf16 v[156:159], a[144:147], v[64:67], v[108:111]
buffer_store_dwordx4 v[144:147], v3, s[44:47], s70 offen offset:1024 sc1
Ljoin51:
v_mfma_f32_16x16x32_bf16 v[140:143], a[132:135], v[68:71], v[140:143]
v_exp_f32 v169, v169
v_mfma_f32_16x16x32_bf16 v[140:143], a[136:139], v[72:75], v[140:143]
v_exp_f32 v170, v170
v_mfma_f32_16x16x32_bf16 v[140:143], a[140:143], v[76:79], v[140:143]
buffer_store_dwordx4 v[160:163], v3, s[44:47], s70 offen offset:2048 sc1
v_mfma_f32_16x16x32_bf16 v[156:159], a[156:159], v[76:79], v[156:159]
ds_read_b128 a[252:255], v2 offset:15360
v_cvt_pk_bf16_f32 v223, v190, v191
v_mfma_f32_16x16x32_bf16 v[156:159], a[152:155], v[72:75], v[156:159]
s_waitcnt vmcnt(24) lgkmcnt(4)
v_exp_f32 v171, v171
v_mfma_f32_16x16x32_bf16 v[156:159], a[148:151], v[68:71], v[156:159]
s_barrier
v_exp_f32 v184, v184
v_add_u32 v2, s82, v1
v_cvt_pk_bf16_f32 v216, v168, v169
v_cvt_pk_bf16_f32 v217, v170, v171
v_exp_f32 v185, v185
v_exp_f32 v186, v186
v_cvt_pk_bf16_f32 v218, v184, v185
v_exp_f32 v187, v187
s_nop 0
v_cvt_pk_bf16_f32 v219, v186, v187
v_mfma_f32_16x16x32_bf16 v[236:239], v[120:123], v[204:207], v[236:239]
s_add_u32 s78, s59, 8
v_exp_f32 v140, v140
v_mfma_f32_16x16x32_bf16 v[236:239], v[120:123], v[220:223], v[236:239]
s_and_b32 s78, s78, 24
v_exp_f32 v141, v141
v_mfma_f32_16x16x32_bf16 a[96:99], a[192:195], v[204:207], a[96:99]
s_lshr_b32 s79, 0x67234501, s78
ds_read_b128 a[192:195], v2 offset:0
v_mfma_f32_16x16x32_bf16 a[96:99], a[224:227], v[220:223], a[96:99]
s_and_b32 s79, s79, 7
buffer_store_dwordx4 v[176:179], v3, s[44:47], s70 offen offset:3072 sc1
v_mfma_f32_16x16x32_bf16 a[100:103], a[228:231], v[220:223], a[100:103]
s_add_u32 s70, s70, 0x80000
v_exp_f32 v142, v142
v_mfma_f32_16x16x32_bf16 a[100:103], a[196:199], v[204:207], a[100:103]
s_lshl_b32 s79, s79, 18
ds_read_b128 a[196:199], v2 offset:1024
v_mfma_f32_16x16x32_bf16 a[104:107], a[200:203], v[204:207], a[104:107]
s_add_u32 s79, s79, s94
ds_read_b128 a[200:203], v2 offset:2048
v_mfma_f32_16x16x32_bf16 a[104:107], a[232:235], v[220:223], a[104:107]
s_add_u32 s12, s61, 0
v_exp_f32 v143, v143
v_mfma_f32_16x16x32_bf16 a[108:111], a[236:239], v[220:223], a[108:111]
s_and_b32 s12, s12, 3
v_exp_f32 v156, v156
v_mfma_f32_16x16x32_bf16 a[108:111], a[204:207], v[204:207], a[108:111]
s_lshl_b32 s12, s12, 21
ds_read_b128 a[204:207], v2 offset:3072
v_mfma_f32_16x16x32_bf16 a[112:115], a[208:211], v[204:207], a[112:115]
s_waitcnt lgkmcnt(4)
ds_read_b128 a[208:211], v2 offset:4096
v_mfma_f32_16x16x32_bf16 a[112:115], a[240:243], v[220:223], a[112:115]
s_add_u32 s12, s12, s79
buffer_store_dwordx4 v[132:135], v3, s[44:47], s70 offen sc1
v_mfma_f32_16x16x32_bf16 a[116:119], a[244:247], v[220:223], a[116:119]
s_add_u32 s13, s61, 1
v_exp_f32 v157, v157
v_mfma_f32_16x16x32_bf16 a[116:119], a[212:215], v[204:207], a[116:119]
s_and_b32 s13, s13, 3
ds_read_b128 a[212:215], v2 offset:5120
v_mfma_f32_16x16x32_bf16 a[120:123], a[216:219], v[204:207], a[120:123]
s_lshl_b32 s13, s13, 21
v_exp_f32 v158, v158
v_mfma_f32_16x16x32_bf16 a[120:123], a[248:251], v[220:223], a[120:123]
s_add_u32 s13, s13, s79
ds_read_b128 a[216:219], v2 offset:6144
v_mfma_f32_16x16x32_bf16 a[124:127], a[252:255], v[220:223], a[124:127]
s_add_u32 s14, s61, 2
buffer_store_dwordx4 v[148:151], v3, s[44:47], s70 offen offset:1024 sc1
v_mfma_f32_16x16x32_bf16 a[124:127], a[220:223], v[204:207], a[124:127]
s_and_b32 s14, s14, 3
ds_read_b128 a[220:223], v2 offset:7168
v_cvt_pk_bf16_f32 v204, v140, v141
s_cmp_eq_u32 s58, 2
s_cbranch_scc1 Lta52
s_cmp_eq_u32 s58, 3
s_cbranch_scc1 Lnt53
v_mfma_f32_16x16x32_bf16 v[172:175], a[160:163], v[64:67], v[112:115]
s_lshl_b32 s14, s14, 21
v_cvt_pk_bf16_f32 v205, v142, v143
v_cvt_pk_bf16_f32 v206, v156, v157
v_mfma_f32_16x16x32_bf16 v[188:191], a[176:179], v[64:67], v[112:115]
s_add_u32 s14, s14, s79
v_exp_f32 v159, v159
s_branch Ljoin54
Lta52:
v_mfma_f32_16x16x32_bf16 v[172:175], a[160:163], v[64:67], v[108:111]
s_lshl_b32 s14, s14, 21
v_cvt_pk_bf16_f32 v205, v142, v143
v_cvt_pk_bf16_f32 v206, v156, v157
v_mfma_f32_16x16x32_bf16 v[188:191], a[176:179], v[64:67], v[112:115]
s_add_u32 s14, s14, s79
v_exp_f32 v159, v159
s_branch Ljoin54
Lnt53:
v_mfma_f32_16x16x32_bf16 v[172:175], a[160:163], v[64:67], v[92:95]
s_lshl_b32 s14, s14, 21
v_cvt_pk_bf16_f32 v205, v142, v143
v_cvt_pk_bf16_f32 v206, v156, v157
v_mfma_f32_16x16x32_bf16 v[188:191], a[176:179], v[64:67], v[108:111]
s_add_u32 s14, s14, s79
v_exp_f32 v159, v159
Ljoin54:
v_mfma_f32_16x16x32_bf16 v[172:175], a[164:167], v[68:71], v[172:175]
s_add_u32 s15, s61, 3
v_cvt_pk_bf16_f32 v207, v158, v159
v_mfma_f32_16x16x32_bf16 v[172:175], a[168:171], v[72:75], v[172:175]
s_and_b32 s15, s15, 3
v_mfma_f32_16x16x32_bf16 v[172:175], a[172:175], v[76:79], v[172:175]
s_lshl_b32 s15, s15, 21
v_mfma_f32_16x16x32_bf16 v[188:191], a[188:191], v[76:79], v[188:191]
s_add_u32 s15, s15, s79
v_mfma_f32_16x16x32_bf16 v[188:191], a[184:187], v[72:75], v[188:191]
v_mfma_f32_16x16x32_bf16 v[188:191], a[180:183], v[68:71], v[188:191]
s_waitcnt lgkmcnt(4)
v_mfma_f32_16x16x32_bf16 v[232:235], v[120:123], v[216:219], v[232:235]
s_add_u32 s82, s82, 0x8000
v_exp_f32 v172, v172
v_mfma_f32_16x16x32_bf16 a[64:67], a[224:227], v[216:219], a[64:67]
s_and_b32 s82, s82, 0x1ffff
ds_read_b128 a[224:227], v2 offset:8192
v_mfma_f32_16x16x32_bf16 a[68:71], a[228:231], v[216:219], a[68:71]
ds_read_b128 a[228:231], v2 offset:9216
v_mfma_f32_16x16x32_bf16 a[72:75], a[232:235], v[216:219], a[72:75]
ds_read_b128 a[232:235], v2 offset:10240
v_mfma_f32_16x16x32_bf16 a[76:79], a[236:239], v[216:219], a[76:79]
buffer_store_dwordx4 v[164:167], v3, s[44:47], s70 offen offset:2048 sc1
v_mfma_f32_16x16x32_bf16 a[80:83], a[240:243], v[216:219], a[80:83]
s_nop 0
ds_read_b128 a[236:239], v2 offset:11264
ds_read_b128 a[240:243], v2 offset:12288
v_mfma_f32_16x16x32_bf16 a[84:87], a[244:247], v[216:219], a[84:87]
ds_read_b128 a[244:247], v2 offset:13312
v_mfma_f32_16x16x32_bf16 a[88:91], a[248:251], v[216:219], a[88:91]
v_exp_f32 v173, v173
v_mfma_f32_16x16x32_bf16 a[92:95], a[252:255], v[216:219], a[92:95]
v_exp_f32 v174, v174
ds_read_b128 a[248:251], v2 offset:14336
ds_read_b128 a[252:255], v2 offset:15360
v_add_u32 v2, s82, v1
buffer_store_dwordx4 v[180:183], v3, s[44:47], s70 offen offset:3072 sc1
v_cvt_pk_bf16_f32 v220, v172, v173
v_exp_f32 v175, v175
v_exp_f32 v188, v188
v_cvt_pk_bf16_f32 v221, v174, v175
v_exp_f32 v189, v189
v_exp_f32 v190, v190
v_cvt_pk_bf16_f32 v222, v188, v189
v_exp_f32 v191, v191
s_nop 0
v_cvt_pk_bf16_f32 v223, v190, v191
s_waitcnt vmcnt(8) lgkmcnt(0)
s_barrier
s_branch LHT4
Lslow:
s_waitcnt vmcnt(0) lgkmcnt(0)
s_barrier
s_mov_b32 s86, 1
s_lshl_b32 s81, s59, 20
s_add_u32 s81, s81, s64
s_sub_u32 s81, s81, 0x4000
s_mov_b32 s83, 0
s_lshl_b32 s75, s60, 3
s_sub_u32 s76, 128, s75
s_add_u32 s74, s75, s58
s_sub_u32 s75, s76, 8
s_add_u32 s75, s75, s58
v_mov_b32 v2, v1
v_lshrrev_b32 v240, 4, v0
v_and_b32 v241, 15, v0
v_lshlrev_b32 v240, 2, v240
v_sub_u32 v240, v241, v240
v_mov_b32 v112, 0xff800000
v_mov_b32 v113, 0xff800000
v_mov_b32 v114, 0xff800000
v_mov_b32 v115, 0xff800000
v_cmp_gt_i32 vcc, 0, v240
v_mov_b32 v120, 0x3f803f80
s_nop 0
v_cndmask_b32 v116, 0, v112, vcc
v_cmp_gt_i32 vcc, 1, v240
v_mov_b32 v121, 0x3f803f80
s_nop 0
v_cndmask_b32 v117, 0, v112, vcc
v_cmp_gt_i32 vcc, 2, v240
v_mov_b32 v122, 0x3f803f80
s_nop 0
v_cndmask_b32 v118, 0, v112, vcc
v_cmp_gt_i32 vcc, 3, v240
v_mov_b32 v123, 0x3f803f80
s_nop 0
v_cndmask_b32 v119, 0, v112, vcc
Lslow1:
s_add_u32 m0, s64, 16384
s_add_u32 s72, s81, 16384
buffer_load_dwordx4 v1, s[44:47], s72 offen sc1 lds
buffer_load_dwordx4 v1, s[44:47], s72 offen offset:1024 sc1 lds
buffer_load_dwordx4 v1, s[44:47], s72 offen offset:2048 sc1 lds
buffer_load_dwordx4 v1, s[44:47], s72 offen offset:3072 sc1 lds
s_add_u32 s81, s81, 0x8000
s_waitcnt vmcnt(0)
s_barrier
ds_read_b128 a[128:131], v2 offset:16384
ds_read_b128 a[132:135], v2 offset:17408
ds_read_b128 a[136:139], v2 offset:18432
ds_read_b128 a[140:143], v2 offset:19456
ds_read_b128 a[144:147], v2 offset:20480
ds_read_b128 a[148:151], v2 offset:21504
ds_read_b128 a[152:155], v2 offset:22528
ds_read_b128 a[156:159], v2 offset:23552
s_waitcnt lgkmcnt(0)
s_add_u32 s73, s74, 0
s_cmp_lt_u32 s73, s83
s_cbranch_scc1 Lsa55
s_cmp_eq_u32 s73, s83
s_cbranch_scc1 Lst56
v_mfma_f32_16x16x32_bf16 v[128:131], a[128:131], v[16:19], 0
s_branch Lsj57
Lst56:
v_mfma_f32_16x16x32_bf16 v[128:131], a[128:131], v[16:19], v[116:119]
Lsj57:
v_mfma_f32_16x16x32_bf16 v[128:131], a[132:135], v[20:23], v[128:131]
v_mfma_f32_16x16x32_bf16 v[128:131], a[136:139], v[24:27], v[128:131]
v_mfma_f32_16x16x32_bf16 v[128:131], a[140:143], v[28:31], v[128:131]
s_nop 7
v_max3_f32 v124, v124, v128, v129
v_max3_f32 v124, v124, v130, v131
Lsa55:
s_add_u32 s73, s74, 4
s_cmp_lt_u32 s73, s83
s_cbranch_scc1 Lsa58
s_cmp_eq_u32 s73, s83
s_cbranch_scc1 Lst59
v_mfma_f32_16x16x32_bf16 v[132:135], a[128:131], v[32:35], 0
s_branch Lsj60
Lst59:
v_mfma_f32_16x16x32_bf16 v[132:135], a[128:131], v[32:35], v[116:119]
Lsj60:
v_mfma_f32_16x16x32_bf16 v[132:135], a[132:135], v[36:39], v[132:135]
v_mfma_f32_16x16x32_bf16 v[132:135], a[136:139], v[40:43], v[132:135]
v_mfma_f32_16x16x32_bf16 v[132:135], a[140:143], v[44:47], v[132:135]
s_nop 7
v_max3_f32 v125, v125, v132, v133
v_max3_f32 v125, v125, v134, v135
Lsa58:
s_add_u32 s73, s75, 0
s_cmp_lt_u32 s73, s83
s_cbranch_scc1 Lsa61
s_cmp_eq_u32 s73, s83
s_cbranch_scc1 Lst62
v_mfma_f32_16x16x32_bf16 v[136:139], a[128:131], v[48:51], 0
s_branch Lsj63
Lst62:
v_mfma_f32_16x16x32_bf16 v[136:139], a[128:131], v[48:51], v[116:119]
Lsj63:
v_mfma_f32_16x16x32_bf16 v[136:139], a[132:135], v[52:55], v[136:139]
v_mfma_f32_16x16x32_bf16 v[136:139], a[136:139], v[56:59], v[136:139]
v_mfma_f32_16x16x32_bf16 v[136:139], a[140:143], v[60:63], v[136:139]
s_nop 7
v_max3_f32 v126, v126, v136, v137
v_max3_f32 v126, v126, v138, v139
Lsa61:
s_add_u32 s73, s75, 4
s_cmp_lt_u32 s73, s83
s_cbranch_scc1 Lsa64
s_cmp_eq_u32 s73, s83
s_cbranch_scc1 Lst65
v_mfma_f32_16x16x32_bf16 v[140:143], a[128:131], v[64:67], 0
s_branch Lsj66
Lst65:
v_mfma_f32_16x16x32_bf16 v[140:143], a[128:131], v[64:67], v[116:119]
Lsj66:
v_mfma_f32_16x16x32_bf16 v[140:143], a[132:135], v[68:71], v[140:143]
v_mfma_f32_16x16x32_bf16 v[140:143], a[136:139], v[72:75], v[140:143]
v_mfma_f32_16x16x32_bf16 v[140:143], a[140:143], v[76:79], v[140:143]
s_nop 7
v_max3_f32 v127, v127, v140, v141
v_max3_f32 v127, v127, v142, v143
Lsa64:
s_add_u32 s83, s83, 1
s_add_u32 s73, s74, 0
s_cmp_lt_u32 s73, s83
s_cbranch_scc1 Lsa67
s_cmp_eq_u32 s73, s83
s_cbranch_scc1 Lst68
v_mfma_f32_16x16x32_bf16 v[144:147], a[144:147], v[16:19], 0
s_branch Lsj69
Lst68:
v_mfma_f32_16x16x32_bf16 v[144:147], a[144:147], v[16:19], v[116:119]
Lsj69:
v_mfma_f32_16x16x32_bf16 v[144:147], a[148:151], v[20:23], v[144:147]
v_mfma_f32_16x16x32_bf16 v[144:147], a[152:155], v[24:27], v[144:147]
v_mfma_f32_16x16x32_bf16 v[144:147], a[156:159], v[28:31], v[144:147]
s_nop 7
v_max3_f32 v124, v124, v144, v145
v_max3_f32 v124, v124, v146, v147
Lsa67:
s_add_u32 s73, s74, 4
s_cmp_lt_u32 s73, s83
s_cbranch_scc1 Lsa70
s_cmp_eq_u32 s73, s83
s_cbranch_scc1 Lst71
v_mfma_f32_16x16x32_bf16 v[148:151], a[144:147], v[32:35], 0
s_branch Lsj72
Lst71:
v_mfma_f32_16x16x32_bf16 v[148:151], a[144:147], v[32:35], v[116:119]
Lsj72:
v_mfma_f32_16x16x32_bf16 v[148:151], a[148:151], v[36:39], v[148:151]
v_mfma_f32_16x16x32_bf16 v[148:151], a[152:155], v[40:43], v[148:151]
v_mfma_f32_16x16x32_bf16 v[148:151], a[156:159], v[44:47], v[148:151]
s_nop 7
v_max3_f32 v125, v125, v148, v149
v_max3_f32 v125, v125, v150, v151
Lsa70:
s_add_u32 s73, s75, 0
s_cmp_lt_u32 s73, s83
s_cbranch_scc1 Lsa73
s_cmp_eq_u32 s73, s83
s_cbranch_scc1 Lst74
v_mfma_f32_16x16x32_bf16 v[152:155], a[144:147], v[48:51], 0
s_branch Lsj75
Lst74:
v_mfma_f32_16x16x32_bf16 v[152:155], a[144:147], v[48:51], v[116:119]
Lsj75:
v_mfma_f32_16x16x32_bf16 v[152:155], a[148:151], v[52:55], v[152:155]
v_mfma_f32_16x16x32_bf16 v[152:155], a[152:155], v[56:59], v[152:155]
v_mfma_f32_16x16x32_bf16 v[152:155], a[156:159], v[60:63], v[152:155]
s_nop 7
v_max3_f32 v126, v126, v152, v153
v_max3_f32 v126, v126, v154, v155
Lsa73:
s_add_u32 s73, s75, 4
s_cmp_lt_u32 s73, s83
s_cbranch_scc1 Lsa76
s_cmp_eq_u32 s73, s83
s_cbranch_scc1 Lst77
v_mfma_f32_16x16x32_bf16 v[156:159], a[144:147], v[64:67], 0
s_branch Lsj78
Lst77:
v_mfma_f32_16x16x32_bf16 v[156:159], a[144:147], v[64:67], v[116:119]
Lsj78:
v_mfma_f32_16x16x32_bf16 v[156:159], a[148:151], v[68:71], v[156:159]
v_mfma_f32_16x16x32_bf16 v[156:159], a[152:155], v[72:75], v[156:159]
v_mfma_f32_16x16x32_bf16 v[156:159], a[156:159], v[76:79], v[156:159]
s_nop 7
v_max3_f32 v127, v127, v156, v157
v_max3_f32 v127, v127, v158, v159
Lsa76:
s_add_u32 s83, s83, 1
ds_read_b128 a[128:131], v2 offset:24576
ds_read_b128 a[132:135], v2 offset:25600
ds_read_b128 a[136:139], v2 offset:26624
ds_read_b128 a[140:143], v2 offset:27648
ds_read_b128 a[144:147], v2 offset:28672
ds_read_b128 a[148:151], v2 offset:29696
ds_read_b128 a[152:155], v2 offset:30720
ds_read_b128 a[156:159], v2 offset:31744
s_waitcnt lgkmcnt(0)
s_add_u32 s73, s74, 0
s_cmp_lt_u32 s73, s83
s_cbranch_scc1 Lsa79
s_cmp_eq_u32 s73, s83
s_cbranch_scc1 Lst80
v_mfma_f32_16x16x32_bf16 v[128:131], a[128:131], v[16:19], 0
s_branch Lsj81
Lst80:
v_mfma_f32_16x16x32_bf16 v[128:131], a[128:131], v[16:19], v[116:119]
Lsj81:
v_mfma_f32_16x16x32_bf16 v[128:131], a[132:135], v[20:23], v[128:131]
v_mfma_f32_16x16x32_bf16 v[128:131], a[136:139], v[24:27], v[128:131]
v_mfma_f32_16x16x32_bf16 v[128:131], a[140:143], v[28:31], v[128:131]
s_nop 7
v_max3_f32 v124, v124, v128, v129
v_max3_f32 v124, v124, v130, v131
Lsa79:
s_add_u32 s73, s74, 4
s_cmp_lt_u32 s73, s83
s_cbranch_scc1 Lsa82
s_cmp_eq_u32 s73, s83
s_cbranch_scc1 Lst83
v_mfma_f32_16x16x32_bf16 v[132:135], a[128:131], v[32:35], 0
s_branch Lsj84
Lst83:
v_mfma_f32_16x16x32_bf16 v[132:135], a[128:131], v[32:35], v[116:119]
Lsj84:
v_mfma_f32_16x16x32_bf16 v[132:135], a[132:135], v[36:39], v[132:135]
v_mfma_f32_16x16x32_bf16 v[132:135], a[136:139], v[40:43], v[132:135]
v_mfma_f32_16x16x32_bf16 v[132:135], a[140:143], v[44:47], v[132:135]
s_nop 7
v_max3_f32 v125, v125, v132, v133
v_max3_f32 v125, v125, v134, v135
Lsa82:
s_add_u32 s73, s75, 0
s_cmp_lt_u32 s73, s83
s_cbranch_scc1 Lsa85
s_cmp_eq_u32 s73, s83
s_cbranch_scc1 Lst86
v_mfma_f32_16x16x32_bf16 v[136:139], a[128:131], v[48:51], 0
s_branch Lsj87
Lst86:
v_mfma_f32_16x16x32_bf16 v[136:139], a[128:131], v[48:51], v[116:119]
Lsj87:
v_mfma_f32_16x16x32_bf16 v[136:139], a[132:135], v[52:55], v[136:139]
v_mfma_f32_16x16x32_bf16 v[136:139], a[136:139], v[56:59], v[136:139]
v_mfma_f32_16x16x32_bf16 v[136:139], a[140:143], v[60:63], v[136:139]
s_nop 7
v_max3_f32 v126, v126, v136, v137
v_max3_f32 v126, v126, v138, v139
Lsa85:
s_add_u32 s73, s75, 4
s_cmp_lt_u32 s73, s83
s_cbranch_scc1 Lsa88
s_cmp_eq_u32 s73, s83
s_cbranch_scc1 Lst89
v_mfma_f32_16x16x32_bf16 v[140:143], a[128:131], v[64:67], 0
s_branch Lsj90
Lst89:
v_mfma_f32_16x16x32_bf16 v[140:143], a[128:131], v[64:67], v[116:119]
Lsj90:
v_mfma_f32_16x16x32_bf16 v[140:143], a[132:135], v[68:71], v[140:143]
v_mfma_f32_16x16x32_bf16 v[140:143], a[136:139], v[72:75], v[140:143]
v_mfma_f32_16x16x32_bf16 v[140:143], a[140:143], v[76:79], v[140:143]
s_nop 7
v_max3_f32 v127, v127, v140, v141
v_max3_f32 v127, v127, v142, v143
Lsa88:
s_add_u32 s83, s83, 1
s_add_u32 s73, s74, 0
s_cmp_lt_u32 s73, s83
s_cbranch_scc1 Lsa91
s_cmp_eq_u32 s73, s83
s_cbranch_scc1 Lst92
v_mfma_f32_16x16x32_bf16 v[144:147], a[144:147], v[16:19], 0
s_branch Lsj93
Lst92:
v_mfma_f32_16x16x32_bf16 v[144:147], a[144:147], v[16:19], v[116:119]
Lsj93:
v_mfma_f32_16x16x32_bf16 v[144:147], a[148:151], v[20:23], v[144:147]
v_mfma_f32_16x16x32_bf16 v[144:147], a[152:155], v[24:27], v[144:147]
v_mfma_f32_16x16x32_bf16 v[144:147], a[156:159], v[28:31], v[144:147]
s_nop 7
v_max3_f32 v124, v124, v144, v145
v_max3_f32 v124, v124, v146, v147
Lsa91:
s_add_u32 s73, s74, 4
s_cmp_lt_u32 s73, s83
s_cbranch_scc1 Lsa94
s_cmp_eq_u32 s73, s83
s_cbranch_scc1 Lst95
v_mfma_f32_16x16x32_bf16 v[148:151], a[144:147], v[32:35], 0
s_branch Lsj96
Lst95:
v_mfma_f32_16x16x32_bf16 v[148:151], a[144:147], v[32:35], v[116:119]
Lsj96:
v_mfma_f32_16x16x32_bf16 v[148:151], a[148:151], v[36:39], v[148:151]
v_mfma_f32_16x16x32_bf16 v[148:151], a[152:155], v[40:43], v[148:151]
v_mfma_f32_16x16x32_bf16 v[148:151], a[156:159], v[44:47], v[148:151]
s_nop 7
v_max3_f32 v125, v125, v148, v149
v_max3_f32 v125, v125, v150, v151
Lsa94:
s_add_u32 s73, s75, 0
s_cmp_lt_u32 s73, s83
s_cbranch_scc1 Lsa97
s_cmp_eq_u32 s73, s83
s_cbranch_scc1 Lst98
v_mfma_f32_16x16x32_bf16 v[152:155], a[144:147], v[48:51], 0
s_branch Lsj99
Lst98:
v_mfma_f32_16x16x32_bf16 v[152:155], a[144:147], v[48:51], v[116:119]
Lsj99:
v_mfma_f32_16x16x32_bf16 v[152:155], a[148:151], v[52:55], v[152:155]
v_mfma_f32_16x16x32_bf16 v[152:155], a[152:155], v[56:59], v[152:155]
v_mfma_f32_16x16x32_bf16 v[152:155], a[156:159], v[60:63], v[152:155]
s_nop 7
v_max3_f32 v126, v126, v152, v153
v_max3_f32 v126, v126, v154, v155
Lsa97:
s_add_u32 s73, s75, 4
s_cmp_lt_u32 s73, s83
s_cbranch_scc1 Lsa100
s_cmp_eq_u32 s73, s83
s_cbranch_scc1 Lst101
v_mfma_f32_16x16x32_bf16 v[156:159], a[144:147], v[64:67], 0
s_branch Lsj102
Lst101:
v_mfma_f32_16x16x32_bf16 v[156:159], a[144:147], v[64:67], v[116:119]
Lsj102:
v_mfma_f32_16x16x32_bf16 v[156:159], a[148:151], v[68:71], v[156:159]
v_mfma_f32_16x16x32_bf16 v[156:159], a[152:155], v[72:75], v[156:159]
v_mfma_f32_16x16x32_bf16 v[156:159], a[156:159], v[76:79], v[156:159]
s_nop 7
v_max3_f32 v127, v127, v156, v157
v_max3_f32 v127, v127, v158, v159
Lsa100:
s_add_u32 s83, s83, 1
s_barrier
s_cmp_lt_u32 s83, s76
s_cbranch_scc1 Lslow1
s_lshl_b32 s81, s59, 20
s_add_u32 s81, s81, s64
s_sub_u32 s81, s81, 0x4000
s_add_u32 m0, s64, 49152
s_add_u32 s72, s81, 16384
buffer_load_dwordx4 v1, s[44:47], s72 offen sc1 lds
buffer_load_dwordx4 v1, s[44:47], s72 offen offset:1024 sc1 lds
buffer_load_dwordx4 v1, s[44:47], s72 offen offset:2048 sc1 lds
buffer_load_dwordx4 v1, s[44:47], s72 offen offset:3072 sc1 lds
s_add_u32 s81, s81, 0x8000
s_add_u32 m0, s64, 81920
s_add_u32 s72, s81, 16384
buffer_load_dwordx4 v1, s[44:47], s72 offen sc1 lds
buffer_load_dwordx4 v1, s[44:47], s72 offen offset:1024 sc1 lds
buffer_load_dwordx4 v1, s[44:47], s72 offen offset:2048 sc1 lds
buffer_load_dwordx4 v1, s[44:47], s72 offen offset:3072 sc1 lds
s_add_u32 m0, s64, 65536
s_add_u32 s72, s81, 0
buffer_load_dwordx4 v1, s[44:47], s72 offen sc1 lds
buffer_load_dwordx4 v1, s[44:47], s72 offen offset:1024 sc1 lds
buffer_load_dwordx4 v1, s[44:47], s72 offen offset:2048 sc1 lds
buffer_load_dwordx4 v1, s[44:47], s72 offen offset:3072 sc1 lds
s_add_u32 s81, s81, 0x8000
s_add_u32 m0, s64, 114688
s_add_u32 s72, s81, 16384
buffer_load_dwordx4 v1, s[44:47], s72 offen sc1 lds
buffer_load_dwordx4 v1, s[44:47], s72 offen offset:1024 sc1 lds
buffer_load_dwordx4 v1, s[44:47], s72 offen offset:2048 sc1 lds
buffer_load_dwordx4 v1, s[44:47], s72 offen offset:3072 sc1 lds
s_add_u32 m0, s64, 98304
s_add_u32 s72, s81, 0
buffer_load_dwordx4 v1, s[44:47], s72 offen sc1 lds
buffer_load_dwordx4 v1, s[44:47], s72 offen offset:1024 sc1 lds
buffer_load_dwordx4 v1, s[44:47], s72 offen offset:2048 sc1 lds
buffer_load_dwordx4 v1, s[44:47], s72 offen offset:3072 sc1 lds
v_add_u32 v2, 0x8000, v1
v_lshrrev_b32 v3, 1, v0
v_lshlrev_b32 v3, 7, v3
s_waitcnt vmcnt(0)
s_barrier
v_accvgpr_write_b32 a32, 0
v_accvgpr_write_b32 a33, 0
v_accvgpr_write_b32 a34, 0
v_accvgpr_write_b32 a35, 0
v_accvgpr_write_b32 a36, 0
v_accvgpr_write_b32 a37, 0
v_accvgpr_write_b32 a38, 0
v_accvgpr_write_b32 a39, 0
v_accvgpr_write_b32 a40, 0
v_accvgpr_write_b32 a41, 0
v_accvgpr_write_b32 a42, 0
v_accvgpr_write_b32 a43, 0
v_accvgpr_write_b32 a44, 0
v_accvgpr_write_b32 a45, 0
v_accvgpr_write_b32 a46, 0
v_accvgpr_write_b32 a47, 0
v_accvgpr_write_b32 a48, 0
v_accvgpr_write_b32 a49, 0
v_accvgpr_write_b32 a50, 0
v_accvgpr_write_b32 a51, 0
v_accvgpr_write_b32 a52, 0
v_accvgpr_write_b32 a53, 0
v_accvgpr_write_b32 a54, 0
v_accvgpr_write_b32 a55, 0
v_accvgpr_write_b32 a56, 0
v_accvgpr_write_b32 a57, 0
v_accvgpr_write_b32 a58, 0
v_accvgpr_write_b32 a59, 0
v_accvgpr_write_b32 a60, 0
v_accvgpr_write_b32 a61, 0
v_accvgpr_write_b32 a62, 0
v_accvgpr_write_b32 a63, 0
v_accvgpr_write_b32 a96, 0
v_accvgpr_write_b32 a97, 0
v_accvgpr_write_b32 a98, 0
v_accvgpr_write_b32 a99, 0
v_accvgpr_write_b32 a100, 0
v_accvgpr_write_b32 a101, 0
v_accvgpr_write_b32 a102, 0
v_accvgpr_write_b32 a103, 0
v_accvgpr_write_b32 a104, 0
v_accvgpr_write_b32 a105, 0
v_accvgpr_write_b32 a106, 0
v_accvgpr_write_b32 a107, 0
v_accvgpr_write_b32 a108, 0
v_accvgpr_write_b32 a109, 0
v_accvgpr_write_b32 a110, 0
v_accvgpr_write_b32 a111, 0
v_accvgpr_write_b32 a112, 0
v_accvgpr_write_b32 a113, 0
v_accvgpr_write_b32 a114, 0
v_accvgpr_write_b32 a115, 0
v_accvgpr_write_b32 a116, 0
v_accvgpr_write_b32 a117, 0
v_accvgpr_write_b32 a118, 0
v_accvgpr_write_b32 a119, 0
v_accvgpr_write_b32 a120, 0
v_accvgpr_write_b32 a121, 0
v_accvgpr_write_b32 a122, 0
v_accvgpr_write_b32 a123, 0
v_accvgpr_write_b32 a124, 0
v_accvgpr_write_b32 a125, 0
v_accvgpr_write_b32 a126, 0
v_accvgpr_write_b32 a127, 0
ds_read_b128 a[128:131], v2 offset:16384
ds_read_b128 a[132:135], v2 offset:17408
ds_read_b128 a[136:139], v2 offset:18432
ds_read_b128 a[140:143], v2 offset:19456
ds_read_b128 a[144:147], v2 offset:20480
ds_read_b128 a[148:151], v2 offset:21504
ds_read_b128 a[152:155], v2 offset:22528
ds_read_b128 a[156:159], v2 offset:23552
s_branch Lattn
Lspin103:
s_mov_b32 s83, 262144
Lsl105:
s_sleep 2
buffer_load_dword v3, v2, s[44:47], s82 offen sc1
s_sub_u32 s83, s83, 1
s_cmp_eq_u32 s83, 0
s_waitcnt vmcnt(0)
s_cbranch_scc1 Lback104
v_cmp_gt_u32 vcc, 2, v3
s_cbranch_vccnz Lsl105
s_branch Lback104
Lspin106:
s_mov_b32 s83, 262144
Lsl108:
s_sleep 2
buffer_load_dword v3, v2, s[44:47], s82 offen sc1
s_sub_u32 s83, s83, 1
s_cmp_eq_u32 s83, 0
s_waitcnt vmcnt(0)
s_cbranch_scc1 Lback107
v_cmp_gt_u32 vcc, 2, v3
s_cbranch_vccnz Lsl108
s_branch Lback107
Lredo0:
s_xor_b32 s82, s78, 0
s_lshl_b32 s82, s82, 10
s_add_u32 s82, s82, s74
buffer_load_dword v3, v2, s[44:47], s82 offen sc1
s_waitcnt vmcnt(0)
v_cmp_gt_u32 vcc, 2, v3
s_cbranch_vccnz Lspin103
Lback104:
s_lshr_b32 s69, s12, 18
s_lshl_b32 s69, s69, 12
s_add_u32 s69, s69, s95
buffer_load_dwordx4 a[0:3], v1, s[44:47], s69 offen sc1
buffer_load_dwordx4 a[4:7], v1, s[44:47], s69 offen offset:1024 sc1
buffer_load_dwordx4 a[8:11], v1, s[44:47], s69 offen offset:2048 sc1
buffer_load_dwordx4 a[12:15], v1, s[44:47], s69 offen offset:3072 sc1
s_add_u32 s69, s69, 0x20000
buffer_load_dwordx4 a[16:19], v1, s[44:47], s69 offen sc1
buffer_load_dwordx4 a[20:23], v1, s[44:47], s69 offen offset:1024 sc1
buffer_load_dwordx4 a[24:27], v1, s[44:47], s69 offen offset:2048 sc1
buffer_load_dwordx4 a[28:31], v1, s[44:47], s69 offen offset:3072 sc1
s_lshr_b32 s69, s13, 18
s_lshl_b32 s69, s69, 12
s_add_u32 s69, s69, s95
buffer_load_dwordx4 a[32:35], v1, s[44:47], s69 offen sc1
buffer_load_dwordx4 a[36:39], v1, s[44:47], s69 offen offset:1024 sc1
buffer_load_dwordx4 a[40:43], v1, s[44:47], s69 offen offset:2048 sc1
buffer_load_dwordx4 a[44:47], v1, s[44:47], s69 offen offset:3072 sc1
s_add_u32 s69, s69, 0x20000
buffer_load_dwordx4 a[48:51], v1, s[44:47], s69 offen sc1
buffer_load_dwordx4 a[52:55], v1, s[44:47], s69 offen offset:1024 sc1
buffer_load_dwordx4 a[56:59], v1, s[44:47], s69 offen offset:2048 sc1
buffer_load_dwordx4 a[60:63], v1, s[44:47], s69 offen offset:3072 sc1
s_waitcnt vmcnt(8)
s_branch Lredo0b
Lspin109:
s_mov_b32 s83, 262144
Lsl111:
s_sleep 2
buffer_load_dword v114, v115, s[44:47], s84 offen sc1
s_sub_u32 s83, s83, 1
s_cmp_eq_u32 s83, 0
s_waitcnt vmcnt(0)
s_cbranch_scc1 Lback110
v_cmp_gt_u32 vcc, 3, v114
s_cbranch_vccnz Lsl111
s_branch Lback110
Lspin112:
s_mov_b32 s83, 262144
Lsl114:
s_sleep 2
buffer_load_dword v14, v13, s[44:47], s79 offen sc1
s_sub_u32 s83, s83, 1
s_cmp_eq_u32 s83, 0
s_waitcnt vmcnt(0)
s_cbranch_scc1 Lback113
v_cmp_gt_u32 vcc, 2, v14
s_cbranch_vccnz Lsl114
s_branch Lback113
Lxspin1:
s_mov_b32 s83, 262144
Lxsl1:
buffer_load_dwordx4 v[96:99], v1, s[44:47], s79 offen sc1
buffer_load_dwordx4 v[100:103], v1, s[44:47], s79 offen offset:1024 sc1
buffer_load_dwordx4 v[104:107], v1, s[44:47], s79 offen offset:2048 sc1
buffer_load_dwordx4 v[108:111], v1, s[44:47], s79 offen offset:3072 sc1
s_sub_u32 s83, s83, 1
s_cmp_eq_u32 s83, 0
s_waitcnt vmcnt(0)
s_cbranch_scc1 Lxback1
v_max3_u32 v12, v96, v97, v98
v_max3_u32 v13, v99, v100, v101
v_max3_u32 v12, v12, v102, v103
v_max3_u32 v13, v13, v104, v105
v_max3_u32 v12, v12, v106, v107
v_max3_u32 v13, v13, v108, v109
v_max3_u32 v12, v12, v110, v111
v_max_u32 v12, v12, v13
v_cmp_le_u32 vcc, 0xff800000, v12
s_cbranch_vccnz Lxsl1
s_branch Lxback1
Lxspin2:
s_mov_b32 s83, 262144
Lxsl2:
buffer_load_dwordx4 v[80:83], v1, s[44:47], s82 offen sc1
buffer_load_dwordx4 v[84:87], v1, s[44:47], s82 offen offset:1024 sc1
buffer_load_dwordx4 v[88:91], v1, s[44:47], s82 offen offset:2048 sc1
buffer_load_dwordx4 v[92:95], v1, s[44:47], s82 offen offset:3072 sc1
s_sub_u32 s83, s83, 1
s_cmp_eq_u32 s83, 0
s_waitcnt vmcnt(0)
s_cbranch_scc1 Lxback2
v_max3_u32 v12, v80, v81, v82
v_max3_u32 v13, v83, v84, v85
v_max3_u32 v12, v12, v86, v87
v_max3_u32 v13, v13, v88, v89
v_max3_u32 v12, v12, v90, v91
v_max3_u32 v13, v13, v92, v93
v_max3_u32 v12, v12, v94, v95
v_max_u32 v12, v12, v13
v_cmp_le_u32 vcc, 0xff800000, v12
s_cbranch_vccnz Lxsl2
s_branch Lxback2
Lxspin3:
s_mov_b32 s83, 262144
Lxsl3:
buffer_load_dwordx4 v[96:99], v1, s[44:47], s81 offen sc1
buffer_load_dwordx4 v[100:103], v1, s[44:47], s81 offen offset:1024 sc1
buffer_load_dwordx4 v[104:107], v1, s[44:47], s81 offen offset:2048 sc1
buffer_load_dwordx4 v[108:111], v1, s[44:47], s81 offen offset:3072 sc1
s_sub_u32 s83, s83, 1
s_cmp_eq_u32 s83, 0
s_waitcnt vmcnt(0)
s_cbranch_scc1 Lxback3
v_max3_u32 v12, v96, v97, v98
v_max3_u32 v13, v99, v100, v101
v_max3_u32 v12, v12, v102, v103
v_max3_u32 v13, v13, v104, v105
v_max3_u32 v12, v12, v106, v107
v_max3_u32 v13, v13, v108, v109
v_max3_u32 v12, v12, v110, v111
v_max_u32 v12, v12, v13
v_cmp_le_u32 vcc, 0xff800000, v12
s_cbranch_vccnz Lxsl3
s_branch Lxback3
Lcode_end:
s_endpgm
.section .rodata,"a"
.p2align 6
.amdhsa_kernel gated_mix__compressed_kv_cla__ssm_conv_h3__prompt_kernel
  .amdhsa_next_free_vgpr 512
  .amdhsa_next_free_sgpr 102
  .amdhsa_accum_offset 256
  .amdhsa_group_segment_fixed_size 0
  .amdhsa_kernarg_size 128
  .amdhsa_user_sgpr_count 2
  .amdhsa_user_sgpr_kernarg_segment_ptr 1
  .amdhsa_system_sgpr_workgroup_id_x 1
  .amdhsa_float_denorm_mode_32 3
.end_amdhsa_kernel
```

```asm
; @launch grid=(256,1,1) block=(256,1,1) lds=163840
.amdgcn_target "amdgcn-amd-amdhsa--gfx950"
.text
.globl gated_mix__compressed_kv_cla__ssm_conv_h3__prompt_kernel
.p2align 8
.type gated_mix__compressed_kv_cla__ssm_conv_h3__prompt_kernel,@function
gated_mix__compressed_kv_cla__ssm_conv_h3__prompt_kernel:
s_cmp_ge_u32 s2, 256
s_cbranch_scc1 Lend
s_load_dwordx2 s[8:9], s[0:1], 8
s_load_dwordx2 s[16:17], s[0:1], 24
s_load_dwordx2 s[20:21], s[0:1], 32
s_load_dwordx2 s[4:5], s[0:1], 0
s_load_dwordx2 s[12:13], s[0:1], 16
s_load_dwordx2 s[24:25], s[0:1], 40
s_load_dwordx2 s[28:29], s[0:1], 56
s_load_dwordx2 s[32:33], s[0:1], 64
s_load_dwordx2 s[52:53], s[0:1], 72
s_load_dwordx2 s[36:37], s[0:1], 80
s_load_dwordx2 s[54:55], s[0:1], 88
s_load_dwordx2 s[56:57], s[0:1], 96
s_load_dwordx2 s[40:41], s[0:1], 104
s_load_dwordx2 s[48:49], s[0:1], 112
s_load_dwordx2 s[44:45], s[0:1], 120
s_getpc_b64 s[98:99]
Lpc0:
s_lshr_b32 s75, s2, 3
v_mul_u32_u24 v26, 18, v0
s_mul_i32 s73, s75, 4608
v_and_b32 v26, 0x1f80, v26
v_add_u32 v26, s73, v26
v_min_u32 v26, Lcode_end-Lpc0, v26
global_load_dword v31, v26, s[98:99]
v_lshrrev_b32 v26, 6, v0
v_and_b32 v0, 63, v0
s_and_b32 s73, s2, 7
v_readfirstlane_b32 s58, v26
s_lshr_b32 s65, s75, 3
s_and_b32 s60, s75, 7
s_lshl_b32 s59, s73, 2
s_add_u32 s59, s59, s65
s_lshl_b32 s61, s65, 1
s_lshl_b32 s63, s58, 13
s_lshl_b32 s64, s58, 12
s_lshl_b32 s67, s60, 18
s_lshl_b32 s76, s58, 16
s_add_u32 s84, s67, s76
s_lshl_b32 s66, s58, 17
s_lshl_b32 s73, s73, 2
s_lshr_b32 s73, 0x67234501, s73
s_and_b32 s73, s73, 7
s_lshl_b32 s74, s65, 3
s_add_u32 s73, s73, s74
s_lshl_b32 s73, s73, 8
s_add_u32 s66, s66, s73
v_lshrrev_b32 v26, 4, v0
v_and_b32 v27, 7, v0
v_xor_b32 v27, v27, v26
v_lshlrev_b32 v27, 4, v27
v_lshrrev_b32 v28, 3, v0
v_lshl_add_u32 v2, v28, 10, v27
v_xor_b32 v3, 64, v2
v_and_b32 v29, 15, v0
v_lshlrev_b32 v30, 1, v26
v_xor_b32 v30, v30, v29
v_lshlrev_b32 v30, 4, v30
v_lshl_add_u32 v6, v26, 13, v30
v_xor_b32 v7, 0x80, v6
s_mov_b32 s10, 0x200000
s_mov_b32 s11, 0x20000
s_mov_b32 s18, 0x400000
s_mov_b32 s19, 0x20000
s_mov_b32 s22, 0x400000
s_mov_b32 s23, 0x20000
s_lshl_b32 s73, s2, 2
s_add_u32 s73, s73, s58
s_lshl_b32 s73, s73, 11
v_lshrrev_b32 v124, 2, v0
v_lshlrev_b32 v124, 7, v124
v_add_u32 v124, s73, v124
s_lshr_b32 s73, s2, 3
s_lshl_b32 s73, s73, 2
s_add_u32 s73, s73, s58
s_lshl_b32 s73, s73, 13
s_and_b32 s74, s66, 0x700
s_add_u32 s73, s73, s74
v_lshrrev_b32 v125, 4, v0
v_lshlrev_b32 v125, 11, v125
v_bfe_u32 v126, v0, 3, 1
v_lshl_add_u32 v125, v126, 7, v125
v_add_u32 v125, s73, v125
s_waitcnt lgkmcnt(0)
s_and_b32 s73, s65, 1
s_xor_b32 s73, s73, 0
s_lshl_b32 s69, s73, 7
s_add_u32 s69, s69, s84
s_lshl_b32 s71, s73, 19
s_add_u32 s71, s71, s66
s_add_u32 m0, s63, 65536
s_add_u32 s72, s69, 0
buffer_load_dwordx4 v2, s[8:11], s72 offen lds
s_add_u32 s72, s69, 7168
buffer_load_dwordx4 v3, s[8:11], s72 offen offset:1024 lds
s_add_u32 s72, s69, 14336
buffer_load_dwordx4 v2, s[8:11], s72 offen offset:2048 lds
s_add_u32 s72, s69, 21504
buffer_load_dwordx4 v3, s[8:11], s72 offen offset:3072 lds
s_add_u32 m0, s64, 0
s_add_u32 s72, s71, 0
buffer_load_dwordx4 v6, s[16:19], s72 offen lds
s_add_u32 s72, s71, 31744
buffer_load_dwordx4 v6, s[16:19], s72 offen offset:1024 lds
s_add_u32 s72, s71, 63488
buffer_load_dwordx4 v7, s[16:19], s72 offen offset:2048 lds
s_add_u32 s72, s71, 95232
buffer_load_dwordx4 v7, s[16:19], s72 offen offset:3072 lds
s_add_u32 m0, s63, 69632
s_add_u32 s72, s69, 32768
buffer_load_dwordx4 v2, s[8:11], s72 offen lds
s_add_u32 s72, s69, 39936
buffer_load_dwordx4 v3, s[8:11], s72 offen offset:1024 lds
s_add_u32 s72, s69, 47104
buffer_load_dwordx4 v2, s[8:11], s72 offen offset:2048 lds
s_add_u32 s72, s69, 54272
buffer_load_dwordx4 v3, s[8:11], s72 offen offset:3072 lds
s_add_u32 m0, s64, 16384
s_add_u32 s72, s71, 0
buffer_load_dwordx4 v6, s[20:23], s72 offen lds
s_add_u32 s72, s71, 31744
buffer_load_dwordx4 v6, s[20:23], s72 offen offset:1024 lds
s_add_u32 s72, s71, 63488
buffer_load_dwordx4 v7, s[20:23], s72 offen offset:2048 lds
s_add_u32 s72, s71, 95232
buffer_load_dwordx4 v7, s[20:23], s72 offen offset:3072 lds
s_mov_b32 s80, 0x0
buffer_load_dword v126, v125, s[16:19], s80 offen
buffer_load_dword v126, v125, s[20:23], s80 offen
buffer_load_dword v126, v124, s[8:11], 0 offen
s_and_b32 s73, s65, 1
s_xor_b32 s73, s73, 1
s_lshl_b32 s69, s73, 7
s_add_u32 s69, s69, s84
s_lshl_b32 s71, s73, 19
s_add_u32 s71, s71, s66
s_add_u32 m0, s63, 98304
s_add_u32 s72, s69, 0
buffer_load_dwordx4 v2, s[8:11], s72 offen lds
s_add_u32 s72, s69, 7168
buffer_load_dwordx4 v3, s[8:11], s72 offen offset:1024 lds
s_add_u32 s72, s69, 14336
buffer_load_dwordx4 v2, s[8:11], s72 offen offset:2048 lds
s_add_u32 s72, s69, 21504
buffer_load_dwordx4 v3, s[8:11], s72 offen offset:3072 lds
s_branch Lmain
.p2align 12
Lmain:
s_mov_b32 s6, 0x400000
s_mov_b32 s7, 0x20000
s_mov_b32 s14, 0x800000
s_mov_b32 s15, 0x20000
s_mov_b32 s26, 0x800000
s_mov_b32 s27, 0x20000
s_mov_b32 s30, 0x400000
s_mov_b32 s31, 0x20000
s_mov_b32 s34, 0x400000
s_mov_b32 s35, 0x20000
s_mov_b32 s38, 0x400000
s_mov_b32 s39, 0x20000
s_mov_b32 s42, 0x400000
s_mov_b32 s43, 0x20000
s_mov_b32 s46, 0x5800000
s_mov_b32 s47, 0x20000
s_mov_b32 s50, 0x100
s_mov_b32 s51, 0x20000
v_lshl_add_u32 v4, v28, 11, v27
v_xor_b32 v5, 64, v4
v_lshlrev_b32 v1, 4, v0
s_sub_u32 s74, 15, s60
s_lshl_b32 s68, s74, 18
s_lshl_b32 s76, s58, 15
s_add_u32 s68, s68, s76
s_add_u32 s67, s67, s76
s_and_b32 s62, s60, 3
s_sub_u32 s62, 16, s62
s_lshl_b32 s91, s59, 3
s_add_u32 s91, s91, s60
s_lshl_b32 s93, s91, 2
s_add_u32 s93, s93, s58
s_lshl_b32 s91, s91, 7
s_add_u32 s91, s91, 0x3810000
s_lshl_b32 s75, s93, 1
s_and_b32 s75, s75, 0xffc
s_lshl_b32 s93, s93, 12
s_load_dwordx2 s[88:89], s[36:37], s93
s_load_dword s90, s[54:55], s75
v_lshrrev_b32 v29, 3, v0
v_or_b32 v29, s58, v29
v_min_u32 v29, 1, v29
v_lshlrev_b32 v29, 28, v29
v_add_lshl_u32 v29, v29, v0, 2
v_mov_b32 v30, 0
buffer_store_dword v30, v29, s[44:47], s91 offen sc1
s_xor_b32 s73, s2, 5
s_and_b32 s73, s73, 15
s_lshr_b32 s74, s2, 4
s_lshl_b32 s74, s74, 7
s_lshl_b32 s75, s58, 5
s_add_u32 s74, s74, s75
s_mov_b32 s75, 131072
v_lshrrev_b32 v29, 5, v0
v_lshlrev_b32 v29, 4, v29
v_add_u32 v29, s74, v29
v_and_b32 v30, 31, v0
s_lshl_b32 s73, s73, 5
v_add_u32 v30, s73, v30
v_lshlrev_b32 v26, 11, v29
v_lshl_add_u32 v26, v30, 2, v26
v_subrev_u32 v27, 0x1800, v26
s_lshl_b32 s82, s74, 11
s_lshl_b32 s73, s73, 2
s_add_u32 s82, s82, s73
v_lshrrev_b32 v26, 3, v0
v_and_b32 v32, 7, v0
v_lshlrev_b32 v32, 4, v32
v_lshl_add_u32 v26, v26, 11, v32
v_lshrrev_b32 v98, 5, v0
v_lshlrev_b32 v98, 11, v98
v_and_b32 v32, 31, v0
v_lshl_add_u32 v98, v32, 2, v98
v_add_u32 v98, s63, v98
v_add_u32 v98, s75, v98
v_and_b32 v29, 0x7f, v29
v_sub_u32 v29, 0x70, v29
v_lshlrev_b32 v29, 1, v29
v_and_b32 v32, 7, v0
v_mul_u32_u24 v32, 544, v32
v_add3_u32 v28, v32, v29, s75
v_bfe_u32 v32, v0, 3, 2
v_lshl_add_u32 v28, v32, 13, v28
v_lshlrev_b32 v30, 4, v30
s_lshl_b32 s73, s2, 14
s_lshl_b32 s74, s58, 12
s_add_u32 s76, s73, s74
v_and_b32 v29, 15, v0
v_lshrrev_b32 v32, 4, v0
v_lshrrev_b32 v24, 1, v29
v_xor_b32 v24, v24, v32
v_lshlrev_b32 v24, 4, v24
v_lshl_add_u32 v24, v29, 7, v24
s_add_u32 s73, s63, 131072
v_add_u32 v16, s73, v24
v_xor_b32 v17, 64, v16
v_subrev_u32 v18, 0x10000, v16
v_subrev_u32 v19, 0x10000, v17
s_lshr_b32 s73, s58, 1
s_lshl_b32 s74, s73, 14
s_add_u32 s74, s74, 0x10000
v_add_u32 v24, s74, v24
v_xor_b32 v25, 64, v24
v_lshrrev_b32 v8, 2, v29
v_and_b32 v9, 1, v32
v_lshl_add_u32 v9, v9, 2, v8
v_lshl_add_u32 v8, v32, 3, v8
v_lshlrev_b32 v8, 8, v8
v_lshl_add_u32 v8, v9, 5, v8
v_and_b32 v29, 3, v0
v_lshl_add_u32 v8, v29, 3, v8
s_and_b32 s74, s58, 1
s_lshl_b32 s75, s74, 7
v_xor_b32 v20, s75, v8
v_xor_b32 v9, 32, v8
v_xor_b32 v10, 64, v8
v_xor_b32 v11, 96, v8
v_xor_b32 v12, 128, v8
v_xor_b32 v13, 160, v8
v_xor_b32 v14, 192, v8
v_xor_b32 v15, 224, v8
v_xor_b32 v21, 32, v20
v_xor_b32 v22, 64, v20
v_xor_b32 v23, 96, v20
s_lshl_b32 s77, s59, 20
s_add_u32 s81, s77, s64
s_sub_u32 s81, s81, 0x4000
s_lshl_b32 s75, s60, 17
s_add_u32 s77, s77, s75
s_lshl_b32 s73, s73, 16
s_add_u32 s77, s77, s73
s_lshl_b32 s75, s74, 12
s_add_u32 s78, s77, s75
s_add_u32 s78, s78, 0x4000
s_lshl_b32 s75, s74, 11
s_add_u32 s77, s77, s75
s_mov_b32 s79, 0x3e0293ee
s_waitcnt vmcnt(8)
s_barrier
ds_read_b64_tr_b16 v[224:225], v20 offset:0
ds_read_b64_tr_b16 v[226:227], v20 offset:1024
ds_read_b64_tr_b16 v[228:229], v20 offset:8192
ds_read_b64_tr_b16 v[230:231], v20 offset:9216
ds_read_b128 v[128:131], v24 offset:0
ds_read_b128 v[132:135], v25 offset:0
ds_read_b128 v[136:139], v24 offset:2048
ds_read_b128 v[140:143], v25 offset:2048
ds_read_b128 v[144:147], v24 offset:4096
ds_read_b128 v[148:151], v25 offset:4096
ds_read_b128 v[152:155], v24 offset:6144
ds_read_b128 v[156:159], v25 offset:6144
ds_read_b128 v[160:163], v24 offset:8192
ds_read_b128 v[164:167], v25 offset:8192
ds_read_b128 v[168:171], v24 offset:10240
ds_read_b128 v[172:175], v25 offset:10240
ds_read_b128 v[176:179], v24 offset:12288
ds_read_b128 v[180:183], v25 offset:12288
ds_read_b128 v[184:187], v24 offset:14336
ds_read_b128 v[188:191], v25 offset:14336
ds_read_b64_tr_b16 v[232:233], v21 offset:0
ds_read_b64_tr_b16 v[234:235], v21 offset:1024
ds_read_b64_tr_b16 v[236:237], v21 offset:8192
ds_read_b64_tr_b16 v[238:239], v21 offset:9216
s_waitcnt lgkmcnt(0)
v_mfma_f32_16x16x32_bf16 a[0:3], v[224:227], v[128:131], 0
s_add_u32 m0, s64, 32768
ds_read_b64_tr_b16 v[240:241], v22 offset:0
v_mfma_f32_16x16x32_bf16 a[0:3], v[228:231], v[132:135], a[0:3]
s_add_u32 s72, s71, 0
buffer_load_dwordx4 v6, s[16:19], s72 offen lds
v_mfma_f32_16x16x32_bf16 a[4:7], v[228:231], v[140:143], 0
s_add_u32 s72, s71, 31744
buffer_load_dwordx4 v6, s[16:19], s72 offen offset:1024 lds
v_mfma_f32_16x16x32_bf16 a[4:7], v[224:227], v[136:139], a[4:7]
ds_read_b64_tr_b16 v[242:243], v22 offset:1024
v_mfma_f32_16x16x32_bf16 a[8:11], v[224:227], v[144:147], 0
s_add_u32 s72, s71, 63488
buffer_load_dwordx4 v7, s[16:19], s72 offen offset:2048 lds
v_mfma_f32_16x16x32_bf16 a[8:11], v[228:231], v[148:151], a[8:11]
v_mfma_f32_16x16x32_bf16 a[12:15], v[228:231], v[156:159], 0
s_add_u32 s72, s71, 95232
buffer_load_dwordx4 v7, s[16:19], s72 offen offset:3072 lds
v_mfma_f32_16x16x32_bf16 a[12:15], v[224:227], v[152:155], a[12:15]
ds_read_b64_tr_b16 v[244:245], v22 offset:8192
v_mfma_f32_16x16x32_bf16 a[16:19], v[224:227], v[160:163], 0
s_add_u32 m0, s63, 102400
v_mfma_f32_16x16x32_bf16 a[16:19], v[228:231], v[164:167], a[16:19]
s_add_u32 s72, s69, 32768
buffer_load_dwordx4 v2, s[8:11], s72 offen lds
v_mfma_f32_16x16x32_bf16 a[20:23], v[228:231], v[172:175], 0
s_add_u32 s72, s69, 39936
buffer_load_dwordx4 v3, s[8:11], s72 offen offset:1024 lds
v_mfma_f32_16x16x32_bf16 a[20:23], v[224:227], v[168:171], a[20:23]
ds_read_b64_tr_b16 v[246:247], v22 offset:9216
v_mfma_f32_16x16x32_bf16 a[24:27], v[224:227], v[176:179], 0
s_add_u32 s72, s69, 47104
buffer_load_dwordx4 v2, s[8:11], s72 offen offset:2048 lds
v_mfma_f32_16x16x32_bf16 a[24:27], v[228:231], v[180:183], a[24:27]
v_mfma_f32_16x16x32_bf16 a[28:31], v[228:231], v[188:191], 0
s_add_u32 s72, s69, 54272
buffer_load_dwordx4 v3, s[8:11], s72 offen offset:3072 lds
v_mfma_f32_16x16x32_bf16 a[28:31], v[224:227], v[184:187], a[28:31]
v_mfma_f32_16x16x32_bf16 a[60:63], v[232:235], v[184:187], 0
s_add_u32 m0, s64, 49152
ds_read_b64_tr_b16 v[248:249], v23 offset:0
v_mfma_f32_16x16x32_bf16 a[60:63], v[236:239], v[188:191], a[60:63]
s_add_u32 s72, s71, 0
buffer_load_dwordx4 v6, s[20:23], s72 offen lds
v_mfma_f32_16x16x32_bf16 a[56:59], v[236:239], v[180:183], 0
s_add_u32 s72, s71, 31744
buffer_load_dwordx4 v6, s[20:23], s72 offen offset:1024 lds
v_mfma_f32_16x16x32_bf16 a[56:59], v[232:235], v[176:179], a[56:59]
v_mfma_f32_16x16x32_bf16 a[52:55], v[232:235], v[168:171], 0
s_add_u32 s72, s71, 63488
buffer_load_dwordx4 v7, s[20:23], s72 offen offset:2048 lds
v_mfma_f32_16x16x32_bf16 a[52:55], v[236:239], v[172:175], a[52:55]
ds_read_b64_tr_b16 v[250:251], v23 offset:1024
v_mfma_f32_16x16x32_bf16 a[48:51], v[236:239], v[164:167], 0
s_add_u32 s72, s71, 95232
buffer_load_dwordx4 v7, s[20:23], s72 offen offset:3072 lds
v_mfma_f32_16x16x32_bf16 a[48:51], v[232:235], v[160:163], a[48:51]
s_mov_b32 s80, 0x100000
buffer_load_dword v126, v125, s[16:19], s80 offen
v_mfma_f32_16x16x32_bf16 a[44:47], v[232:235], v[152:155], 0
buffer_load_dword v126, v125, s[20:23], s80 offen
v_mfma_f32_16x16x32_bf16 a[44:47], v[236:239], v[156:159], a[44:47]
v_mfma_f32_16x16x32_bf16 a[40:43], v[236:239], v[148:151], 0
ds_read_b64_tr_b16 v[252:253], v23 offset:8192
v_mfma_f32_16x16x32_bf16 a[40:43], v[232:235], v[144:147], a[40:43]
v_mfma_f32_16x16x32_bf16 a[36:39], v[232:235], v[136:139], 0
ds_read_b64_tr_b16 v[254:255], v23 offset:9216
v_mfma_f32_16x16x32_bf16 a[36:39], v[236:239], v[140:143], a[36:39]
v_mfma_f32_16x16x32_bf16 a[32:35], v[236:239], v[132:135], 0
v_mfma_f32_16x16x32_bf16 a[32:35], v[232:235], v[128:131], a[32:35]
s_waitcnt lgkmcnt(4)
v_mfma_f32_16x16x32_bf16 a[64:67], v[240:243], v[128:131], 0
ds_read_b64_tr_b16 v[224:225], v20 offset:16384
v_mfma_f32_16x16x32_bf16 a[64:67], v[244:247], v[132:135], a[64:67]
v_mfma_f32_16x16x32_bf16 a[68:71], v[244:247], v[140:143], 0
v_mfma_f32_16x16x32_bf16 a[68:71], v[240:243], v[136:139], a[68:71]
ds_read_b64_tr_b16 v[226:227], v20 offset:17408
v_mfma_f32_16x16x32_bf16 a[72:75], v[240:243], v[144:147], 0
v_mfma_f32_16x16x32_bf16 a[72:75], v[244:247], v[148:151], a[72:75]
v_mfma_f32_16x16x32_bf16 a[76:79], v[244:247], v[156:159], 0
v_mfma_f32_16x16x32_bf16 a[76:79], v[240:243], v[152:155], a[76:79]
ds_read_b64_tr_b16 v[228:229], v20 offset:24576
v_mfma_f32_16x16x32_bf16 a[80:83], v[240:243], v[160:163], 0
v_mfma_f32_16x16x32_bf16 a[80:83], v[244:247], v[164:167], a[80:83]
v_mfma_f32_16x16x32_bf16 a[84:87], v[244:247], v[172:175], 0
ds_read_b64_tr_b16 v[230:231], v20 offset:25600
v_mfma_f32_16x16x32_bf16 a[84:87], v[240:243], v[168:171], a[84:87]
v_mfma_f32_16x16x32_bf16 a[88:91], v[240:243], v[176:179], 0
v_mfma_f32_16x16x32_bf16 a[88:91], v[244:247], v[180:183], a[88:91]
v_mfma_f32_16x16x32_bf16 a[92:95], v[244:247], v[188:191], 0
v_mfma_f32_16x16x32_bf16 a[92:95], v[240:243], v[184:187], a[92:95]
s_waitcnt lgkmcnt(4)
v_mfma_f32_16x16x32_bf16 a[124:127], v[248:251], v[184:187], 0
ds_read_b64_tr_b16 v[232:233], v21 offset:16384
v_mfma_f32_16x16x32_bf16 a[124:127], v[252:255], v[188:191], a[124:127]
v_mfma_f32_16x16x32_bf16 a[120:123], v[252:255], v[180:183], 0
v_mfma_f32_16x16x32_bf16 a[120:123], v[248:251], v[176:179], a[120:123]
ds_read_b64_tr_b16 v[234:235], v21 offset:17408
v_mfma_f32_16x16x32_bf16 a[116:119], v[248:251], v[168:171], 0
v_mfma_f32_16x16x32_bf16 a[116:119], v[252:255], v[172:175], a[116:119]
v_mfma_f32_16x16x32_bf16 a[112:115], v[252:255], v[164:167], 0
v_mfma_f32_16x16x32_bf16 a[112:115], v[248:251], v[160:163], a[112:115]
ds_read_b64_tr_b16 v[236:237], v21 offset:24576
v_mfma_f32_16x16x32_bf16 a[108:111], v[248:251], v[152:155], 0
v_mfma_f32_16x16x32_bf16 a[108:111], v[252:255], v[156:159], a[108:111]
v_mfma_f32_16x16x32_bf16 a[104:107], v[252:255], v[148:151], 0
ds_read_b64_tr_b16 v[238:239], v21 offset:25600
v_mfma_f32_16x16x32_bf16 a[104:107], v[248:251], v[144:147], a[104:107]
v_mfma_f32_16x16x32_bf16 a[100:103], v[248:251], v[136:139], 0
v_mfma_f32_16x16x32_bf16 a[100:103], v[252:255], v[140:143], a[100:103]
v_mfma_f32_16x16x32_bf16 a[96:99], v[252:255], v[132:135], 0
v_mfma_f32_16x16x32_bf16 a[96:99], v[248:251], v[128:131], a[96:99]
s_waitcnt lgkmcnt(4)
v_mfma_f32_16x16x32_bf16 a[128:131], v[128:131], v[224:227], 0
ds_read_b64_tr_b16 v[240:241], v22 offset:16384
v_mfma_f32_16x16x32_bf16 a[128:131], v[132:135], v[228:231], a[128:131]
v_mfma_f32_16x16x32_bf16 a[132:135], v[140:143], v[228:231], 0
v_mfma_f32_16x16x32_bf16 a[132:135], v[136:139], v[224:227], a[132:135]
ds_read_b64_tr_b16 v[242:243], v22 offset:17408
v_mfma_f32_16x16x32_bf16 a[136:139], v[144:147], v[224:227], 0
v_mfma_f32_16x16x32_bf16 a[136:139], v[148:151], v[228:231], a[136:139]
v_mfma_f32_16x16x32_bf16 a[140:143], v[156:159], v[228:231], 0
v_mfma_f32_16x16x32_bf16 a[140:143], v[152:155], v[224:227], a[140:143]
ds_read_b64_tr_b16 v[244:245], v22 offset:24576
v_mfma_f32_16x16x32_bf16 a[144:147], v[160:163], v[224:227], 0
v_mfma_f32_16x16x32_bf16 a[144:147], v[164:167], v[228:231], a[144:147]
v_mfma_f32_16x16x32_bf16 a[148:151], v[172:175], v[228:231], 0
ds_read_b64_tr_b16 v[246:247], v22 offset:25600
v_mfma_f32_16x16x32_bf16 a[148:151], v[168:171], v[224:227], a[148:151]
v_mfma_f32_16x16x32_bf16 a[152:155], v[176:179], v[224:227], 0
v_mfma_f32_16x16x32_bf16 a[152:155], v[180:183], v[228:231], a[152:155]
v_mfma_f32_16x16x32_bf16 a[156:159], v[188:191], v[228:231], 0
v_mfma_f32_16x16x32_bf16 a[156:159], v[184:187], v[224:227], a[156:159]
s_waitcnt lgkmcnt(4)
v_mfma_f32_16x16x32_bf16 a[188:191], v[184:187], v[232:235], 0
ds_read_b64_tr_b16 v[248:249], v23 offset:16384
v_mfma_f32_16x16x32_bf16 a[188:191], v[188:191], v[236:239], a[188:191]
v_mfma_f32_16x16x32_bf16 a[184:187], v[180:183], v[236:239], 0
ds_read_b64_tr_b16 v[250:251], v23 offset:17408
v_mfma_f32_16x16x32_bf16 a[184:187], v[176:179], v[232:235], a[184:187]
v_mfma_f32_16x16x32_bf16 a[180:183], v[168:171], v[232:235], 0
ds_read_b64_tr_b16 v[252:253], v23 offset:24576
v_mfma_f32_16x16x32_bf16 a[180:183], v[172:175], v[236:239], a[180:183]
v_mfma_f32_16x16x32_bf16 a[176:179], v[164:167], v[236:239], 0
ds_read_b64_tr_b16 v[254:255], v23 offset:25600
v_mfma_f32_16x16x32_bf16 a[176:179], v[160:163], v[232:235], a[176:179]
v_mfma_f32_16x16x32_bf16 a[172:175], v[152:155], v[232:235], 0
v_mfma_f32_16x16x32_bf16 a[172:175], v[156:159], v[236:239], a[172:175]
v_mfma_f32_16x16x32_bf16 a[168:171], v[148:151], v[236:239], 0
v_mfma_f32_16x16x32_bf16 a[168:171], v[144:147], v[232:235], a[168:171]
v_mfma_f32_16x16x32_bf16 a[164:167], v[136:139], v[232:235], 0
v_mfma_f32_16x16x32_bf16 a[164:167], v[140:143], v[236:239], a[164:167]
v_mfma_f32_16x16x32_bf16 a[160:163], v[132:135], v[236:239], 0
s_waitcnt vmcnt(2) lgkmcnt(0)
v_mfma_f32_16x16x32_bf16 a[160:163], v[128:131], v[232:235], a[160:163]
s_barrier
v_mfma_f32_16x16x32_bf16 a[192:195], v[128:131], v[240:243], 0
s_and_b32 s73, s65, 1
ds_read_b64_tr_b16 v[224:225], v20 offset:32768
v_mfma_f32_16x16x32_bf16 a[192:195], v[132:135], v[244:247], a[192:195]
s_xor_b32 s73, s73, 2
ds_read_b64_tr_b16 v[226:227], v20 offset:33792
v_mfma_f32_16x16x32_bf16 a[196:199], v[140:143], v[244:247], 0
s_lshl_b32 s69, s73, 7
ds_read_b64_tr_b16 v[228:229], v20 offset:40960
v_mfma_f32_16x16x32_bf16 a[196:199], v[136:139], v[240:243], a[196:199]
s_add_u32 s69, s69, s84
ds_read_b64_tr_b16 v[230:231], v20 offset:41984
v_mfma_f32_16x16x32_bf16 a[200:203], v[144:147], v[240:243], 0
s_lshl_b32 s71, s73, 19
ds_read_b128 v[192:195], v24 offset:32768
v_mfma_f32_16x16x32_bf16 a[200:203], v[148:151], v[244:247], a[200:203]
s_add_u32 s71, s71, s66
ds_read_b128 v[196:199], v25 offset:32768
v_mfma_f32_16x16x32_bf16 a[204:207], v[156:159], v[244:247], 0
s_add_u32 m0, s63, 65536
v_mfma_f32_16x16x32_bf16 a[204:207], v[152:155], v[240:243], a[204:207]
s_add_u32 s72, s69, 0
buffer_load_dwordx4 v2, s[8:11], s72 offen lds
v_mfma_f32_16x16x32_bf16 a[208:211], v[160:163], v[240:243], 0
s_add_u32 s72, s69, 7168
buffer_load_dwordx4 v3, s[8:11], s72 offen offset:1024 lds
v_mfma_f32_16x16x32_bf16 a[208:211], v[164:167], v[244:247], a[208:211]
s_add_u32 s72, s69, 14336
buffer_load_dwordx4 v2, s[8:11], s72 offen offset:2048 lds
v_mfma_f32_16x16x32_bf16 a[212:215], v[172:175], v[244:247], 0
ds_read_b128 v[200:203], v24 offset:34816
v_mfma_f32_16x16x32_bf16 a[212:215], v[168:171], v[240:243], a[212:215]
ds_read_b128 v[204:207], v25 offset:34816
v_mfma_f32_16x16x32_bf16 a[216:219], v[176:179], v[240:243], 0
s_add_u32 s72, s69, 21504
buffer_load_dwordx4 v3, s[8:11], s72 offen offset:3072 lds
v_mfma_f32_16x16x32_bf16 a[216:219], v[180:183], v[244:247], a[216:219]
ds_read_b128 v[208:211], v24 offset:36864
v_mfma_f32_16x16x32_bf16 a[220:223], v[188:191], v[244:247], 0
ds_read_b128 v[212:215], v25 offset:36864
v_mfma_f32_16x16x32_bf16 a[220:223], v[184:187], v[240:243], a[220:223]
ds_read_b128 v[216:219], v24 offset:38912
v_mfma_f32_16x16x32_bf16 a[252:255], v[184:187], v[248:251], 0
ds_read_b128 v[220:223], v25 offset:38912
v_mfma_f32_16x16x32_bf16 a[252:255], v[188:191], v[252:255], a[252:255]
s_add_u32 m0, s64, 0
v_mfma_f32_16x16x32_bf16 a[248:251], v[180:183], v[252:255], 0
s_add_u32 s72, s71, 0
buffer_load_dwordx4 v6, s[16:19], s72 offen lds
v_mfma_f32_16x16x32_bf16 a[248:251], v[176:179], v[248:251], a[248:251]
ds_read_b128 v[184:187], v24 offset:40960
v_mfma_f32_16x16x32_bf16 a[244:247], v[168:171], v[248:251], 0
ds_read_b128 v[188:191], v25 offset:40960
v_mfma_f32_16x16x32_bf16 a[244:247], v[172:175], v[252:255], a[244:247]
s_add_u32 s72, s71, 31744
buffer_load_dwordx4 v6, s[16:19], s72 offen offset:1024 lds
v_mfma_f32_16x16x32_bf16 a[240:243], v[164:167], v[252:255], 0
ds_read_b128 v[176:179], v24 offset:43008
v_mfma_f32_16x16x32_bf16 a[240:243], v[160:163], v[248:251], a[240:243]
ds_read_b128 v[180:183], v25 offset:43008
v_mfma_f32_16x16x32_bf16 a[236:239], v[152:155], v[248:251], 0
ds_read_b128 v[168:171], v24 offset:45056
v_mfma_f32_16x16x32_bf16 a[236:239], v[156:159], v[252:255], a[236:239]
s_add_u32 s72, s71, 63488
buffer_load_dwordx4 v7, s[16:19], s72 offen offset:2048 lds
v_mfma_f32_16x16x32_bf16 a[232:235], v[148:151], v[252:255], 0
ds_read_b128 v[172:175], v25 offset:45056
v_mfma_f32_16x16x32_bf16 a[232:235], v[144:147], v[248:251], a[232:235]
ds_read_b128 v[160:163], v24 offset:47104
v_mfma_f32_16x16x32_bf16 a[228:231], v[136:139], v[248:251], 0
ds_read_b128 v[164:167], v25 offset:47104
v_mfma_f32_16x16x32_bf16 a[228:231], v[140:143], v[252:255], a[228:231]
v_mfma_f32_16x16x32_bf16 a[224:227], v[132:135], v[252:255], 0
s_add_u32 s72, s71, 95232
buffer_load_dwordx4 v7, s[16:19], s72 offen offset:3072 lds
v_mfma_f32_16x16x32_bf16 a[224:227], v[128:131], v[248:251], a[224:227]
s_waitcnt lgkmcnt(8)
ds_read_b64_tr_b16 v[232:233], v21 offset:32768
v_mfma_f32_16x16x32_bf16 a[0:3], v[224:227], v[192:195], a[0:3]
ds_read_b64_tr_b16 v[234:235], v21 offset:33792
v_mfma_f32_16x16x32_bf16 a[0:3], v[228:231], v[196:199], a[0:3]
ds_read_b64_tr_b16 v[240:241], v22 offset:32768
v_mfma_f32_16x16x32_bf16 a[4:7], v[228:231], v[204:207], a[4:7]
s_add_u32 m0, s63, 69632
ds_read_b64_tr_b16 v[236:237], v21 offset:40960
v_mfma_f32_16x16x32_bf16 a[4:7], v[224:227], v[200:203], a[4:7]
s_add_u32 s72, s69, 32768
buffer_load_dwordx4 v2, s[8:11], s72 offen lds
v_mfma_f32_16x16x32_bf16 a[8:11], v[224:227], v[208:211], a[8:11]
ds_read_b64_tr_b16 v[238:239], v21 offset:41984
v_mfma_f32_16x16x32_bf16 a[8:11], v[228:231], v[212:215], a[8:11]
v_mfma_f32_16x16x32_bf16 a[12:15], v[228:231], v[220:223], a[12:15]
s_add_u32 s72, s69, 39936
buffer_load_dwordx4 v3, s[8:11], s72 offen offset:1024 lds
v_mfma_f32_16x16x32_bf16 a[12:15], v[224:227], v[216:219], a[12:15]
s_waitcnt lgkmcnt(5)
ds_read_b64_tr_b16 v[242:243], v22 offset:33792
v_mfma_f32_16x16x32_bf16 a[16:19], v[224:227], v[184:187], a[16:19]
v_mfma_f32_16x16x32_bf16 a[16:19], v[228:231], v[188:191], a[16:19]
ds_read_b64_tr_b16 v[244:245], v22 offset:40960
v_mfma_f32_16x16x32_bf16 a[20:23], v[228:231], v[180:183], a[20:23]
v_mfma_f32_16x16x32_bf16 a[20:23], v[224:227], v[176:179], a[20:23]
s_add_u32 s72, s69, 47104
buffer_load_dwordx4 v2, s[8:11], s72 offen offset:2048 lds
v_mfma_f32_16x16x32_bf16 a[24:27], v[224:227], v[168:171], a[24:27]
ds_read_b64_tr_b16 v[246:247], v22 offset:41984
v_mfma_f32_16x16x32_bf16 a[24:27], v[228:231], v[172:175], a[24:27]
v_mfma_f32_16x16x32_bf16 a[28:31], v[228:231], v[164:167], a[28:31]
v_mfma_f32_16x16x32_bf16 a[28:31], v[224:227], v[160:163], a[28:31]
s_waitcnt lgkmcnt(3)
v_mfma_f32_16x16x32_bf16 a[60:63], v[232:235], v[160:163], a[60:63]
s_add_u32 s72, s69, 54272
buffer_load_dwordx4 v3, s[8:11], s72 offen offset:3072 lds
v_mfma_f32_16x16x32_bf16 a[60:63], v[236:239], v[164:167], a[60:63]
ds_read_b64_tr_b16 v[248:249], v23 offset:32768
v_mfma_f32_16x16x32_bf16 a[56:59], v[236:239], v[172:175], a[56:59]
v_mfma_f32_16x16x32_bf16 a[56:59], v[232:235], v[168:171], a[56:59]
s_add_u32 m0, s64, 16384
ds_read_b64_tr_b16 v[250:251], v23 offset:33792
v_mfma_f32_16x16x32_bf16 a[52:55], v[232:235], v[176:179], a[52:55]
s_add_u32 s72, s71, 0
buffer_load_dwordx4 v6, s[20:23], s72 offen lds
v_mfma_f32_16x16x32_bf16 a[52:55], v[236:239], v[180:183], a[52:55]
v_mfma_f32_16x16x32_bf16 a[48:51], v[236:239], v[188:191], a[48:51]
v_mfma_f32_16x16x32_bf16 a[48:51], v[232:235], v[184:187], a[48:51]
ds_read_b64_tr_b16 v[252:253], v23 offset:40960
v_mfma_f32_16x16x32_bf16 a[44:47], v[232:235], v[216:219], a[44:47]
s_add_u32 s72, s71, 31744
buffer_load_dwordx4 v6, s[20:23], s72 offen offset:1024 lds
v_mfma_f32_16x16x32_bf16 a[44:47], v[236:239], v[220:223], a[44:47]
v_mfma_f32_16x16x32_bf16 a[40:43], v[236:239], v[212:215], a[40:43]
ds_read_b64_tr_b16 v[254:255], v23 offset:41984
v_mfma_f32_16x16x32_bf16 a[40:43], v[232:235], v[208:211], a[40:43]
v_mfma_f32_16x16x32_bf16 a[36:39], v[232:235], v[200:203], a[36:39]
s_add_u32 s72, s71, 63488
buffer_load_dwordx4 v7, s[20:23], s72 offen offset:2048 lds
v_mfma_f32_16x16x32_bf16 a[36:39], v[236:239], v[204:207], a[36:39]
v_mfma_f32_16x16x32_bf16 a[32:35], v[236:239], v[196:199], a[32:35]
v_mfma_f32_16x16x32_bf16 a[32:35], v[232:235], v[192:195], a[32:35]
s_waitcnt lgkmcnt(4)
v_mfma_f32_16x16x32_bf16 a[64:67], v[240:243], v[192:195], a[64:67]
s_add_u32 s72, s71, 95232
buffer_load_dwordx4 v7, s[20:23], s72 offen offset:3072 lds
v_mfma_f32_16x16x32_bf16 a[64:67], v[244:247], v[196:199], a[64:67]
s_mov_b32 s80, 0x200000
buffer_load_dword v126, v125, s[16:19], s80 offen
v_mfma_f32_16x16x32_bf16 a[68:71], v[244:247], v[204:207], a[68:71]
buffer_load_dword v126, v125, s[20:23], s80 offen
v_mfma_f32_16x16x32_bf16 a[68:71], v[240:243], v[200:203], a[68:71]
global_load_dwordx4 v[68:71], v30, s[52:53]
v_mfma_f32_16x16x32_bf16 a[72:75], v[240:243], v[208:211], a[72:75]
buffer_load_dword v33, v27, s[28:31], 0 offen nt
v_mfma_f32_16x16x32_bf16 a[72:75], v[244:247], v[212:215], a[72:75]
buffer_load_dword v34, v27, s[28:31], 0 offen offset:2048 nt
v_mfma_f32_16x16x32_bf16 a[76:79], v[244:247], v[220:223], a[76:79]
v_add_u32 v27, 0x1000, v27
v_mfma_f32_16x16x32_bf16 a[76:79], v[240:243], v[216:219], a[76:79]
buffer_load_dword v35, v27, s[28:31], 0 offen nt
v_mfma_f32_16x16x32_bf16 a[80:83], v[240:243], v[184:187], a[80:83]
s_add_u32 m0, s63, 131072
ds_read_b64_tr_b16 v[224:225], v20 offset:49152
ds_read_b64_tr_b16 v[226:227], v20 offset:50176
v_mfma_f32_16x16x32_bf16 a[80:83], v[244:247], v[188:191], a[80:83]
s_add_u32 s80, s82, 0
buffer_load_dwordx4 v26, s[28:31], s80 offen nt lds
v_mfma_f32_16x16x32_bf16 a[84:87], v[244:247], v[180:183], a[84:87]
s_add_u32 s80, s82, 15360
buffer_load_dwordx4 v26, s[28:31], s80 offen offset:1024 nt lds
v_mfma_f32_16x16x32_bf16 a[84:87], v[240:243], v[176:179], a[84:87]
s_add_u32 s80, s82, 30720
buffer_load_dwordx4 v26, s[28:31], s80 offen offset:2048 nt lds
v_mfma_f32_16x16x32_bf16 a[88:91], v[240:243], v[168:171], a[88:91]
s_add_u32 s80, s82, 46080
buffer_load_dwordx4 v26, s[28:31], s80 offen offset:3072 nt lds
v_mfma_f32_16x16x32_bf16 a[88:91], v[244:247], v[172:175], a[88:91]
ds_read_b64_tr_b16 v[228:229], v20 offset:57344
ds_read_b64_tr_b16 v[230:231], v20 offset:58368
v_mfma_f32_16x16x32_bf16 a[92:95], v[244:247], v[164:167], a[92:95]
v_mfma_f32_16x16x32_bf16 a[92:95], v[240:243], v[160:163], a[92:95]
s_waitcnt lgkmcnt(4)
v_mfma_f32_16x16x32_bf16 a[124:127], v[248:251], v[160:163], a[124:127]
ds_read_b64_tr_b16 v[232:233], v21 offset:49152
v_mfma_f32_16x16x32_bf16 a[124:127], v[252:255], v[164:167], a[124:127]
v_mfma_f32_16x16x32_bf16 a[120:123], v[252:255], v[172:175], a[120:123]
v_mfma_f32_16x16x32_bf16 a[120:123], v[248:251], v[168:171], a[120:123]
ds_read_b64_tr_b16 v[234:235], v21 offset:50176
v_mfma_f32_16x16x32_bf16 a[116:119], v[248:251], v[176:179], a[116:119]
v_mfma_f32_16x16x32_bf16 a[116:119], v[252:255], v[180:183], a[116:119]
v_mfma_f32_16x16x32_bf16 a[112:115], v[252:255], v[188:191], a[112:115]
v_mfma_f32_16x16x32_bf16 a[112:115], v[248:251], v[184:187], a[112:115]
ds_read_b64_tr_b16 v[236:237], v21 offset:57344
v_mfma_f32_16x16x32_bf16 a[108:111], v[248:251], v[216:219], a[108:111]
v_mfma_f32_16x16x32_bf16 a[108:111], v[252:255], v[220:223], a[108:111]
v_mfma_f32_16x16x32_bf16 a[104:107], v[252:255], v[212:215], a[104:107]
ds_read_b64_tr_b16 v[238:239], v21 offset:58368
v_mfma_f32_16x16x32_bf16 a[104:107], v[248:251], v[208:211], a[104:107]
v_mfma_f32_16x16x32_bf16 a[100:103], v[248:251], v[200:203], a[100:103]
v_mfma_f32_16x16x32_bf16 a[100:103], v[252:255], v[204:207], a[100:103]
v_mfma_f32_16x16x32_bf16 a[96:99], v[252:255], v[196:199], a[96:99]
v_mfma_f32_16x16x32_bf16 a[96:99], v[248:251], v[192:195], a[96:99]
s_waitcnt lgkmcnt(4)
v_mfma_f32_16x16x32_bf16 a[128:131], v[192:195], v[224:227], a[128:131]
ds_read_b64_tr_b16 v[240:241], v22 offset:49152
v_mfma_f32_16x16x32_bf16 a[128:131], v[196:199], v[228:231], a[128:131]
v_mfma_f32_16x16x32_bf16 a[132:135], v[204:207], v[228:231], a[132:135]
v_mfma_f32_16x16x32_bf16 a[132:135], v[200:203], v[224:227], a[132:135]
ds_read_b64_tr_b16 v[242:243], v22 offset:50176
v_mfma_f32_16x16x32_bf16 a[136:139], v[208:211], v[224:227], a[136:139]
v_mfma_f32_16x16x32_bf16 a[136:139], v[212:215], v[228:231], a[136:139]
v_mfma_f32_16x16x32_bf16 a[140:143], v[220:223], v[228:231], a[140:143]
v_mfma_f32_16x16x32_bf16 a[140:143], v[216:219], v[224:227], a[140:143]
ds_read_b64_tr_b16 v[244:245], v22 offset:57344
v_mfma_f32_16x16x32_bf16 a[144:147], v[184:187], v[224:227], a[144:147]
v_mfma_f32_16x16x32_bf16 a[144:147], v[188:191], v[228:231], a[144:147]
v_mfma_f32_16x16x32_bf16 a[148:151], v[180:183], v[228:231], a[148:151]
ds_read_b64_tr_b16 v[246:247], v22 offset:58368
v_mfma_f32_16x16x32_bf16 a[148:151], v[176:179], v[224:227], a[148:151]
v_mfma_f32_16x16x32_bf16 a[152:155], v[168:171], v[224:227], a[152:155]
v_mfma_f32_16x16x32_bf16 a[152:155], v[172:175], v[228:231], a[152:155]
v_mfma_f32_16x16x32_bf16 a[156:159], v[164:167], v[228:231], a[156:159]
v_mfma_f32_16x16x32_bf16 a[156:159], v[160:163], v[224:227], a[156:159]
s_waitcnt lgkmcnt(4)
v_mfma_f32_16x16x32_bf16 a[188:191], v[160:163], v[232:235], a[188:191]
ds_read_b64_tr_b16 v[248:249], v23 offset:49152
v_mfma_f32_16x16x32_bf16 a[188:191], v[164:167], v[236:239], a[188:191]
v_mfma_f32_16x16x32_bf16 a[184:187], v[172:175], v[236:239], a[184:187]
ds_read_b64_tr_b16 v[250:251], v23 offset:50176
v_mfma_f32_16x16x32_bf16 a[184:187], v[168:171], v[232:235], a[184:187]
v_mfma_f32_16x16x32_bf16 a[180:183], v[176:179], v[232:235], a[180:183]
ds_read_b64_tr_b16 v[252:253], v23 offset:57344
v_mfma_f32_16x16x32_bf16 a[180:183], v[180:183], v[236:239], a[180:183]
v_mfma_f32_16x16x32_bf16 a[176:179], v[188:191], v[236:239], a[176:179]
ds_read_b64_tr_b16 v[254:255], v23 offset:58368
v_mfma_f32_16x16x32_bf16 a[176:179], v[184:187], v[232:235], a[176:179]
v_mfma_f32_16x16x32_bf16 a[172:175], v[216:219], v[232:235], a[172:175]
v_mfma_f32_16x16x32_bf16 a[172:175], v[220:223], v[236:239], a[172:175]
v_mfma_f32_16x16x32_bf16 a[168:171], v[212:215], v[236:239], a[168:171]
v_mfma_f32_16x16x32_bf16 a[168:171], v[208:211], v[232:235], a[168:171]
v_mfma_f32_16x16x32_bf16 a[164:167], v[200:203], v[232:235], a[164:167]
v_mfma_f32_16x16x32_bf16 a[164:167], v[204:207], v[236:239], a[164:167]
v_mfma_f32_16x16x32_bf16 a[160:163], v[196:199], v[236:239], a[160:163]
s_waitcnt vmcnt(10) lgkmcnt(0)
v_mfma_f32_16x16x32_bf16 a[160:163], v[192:195], v[232:235], a[160:163]
s_barrier
v_mfma_f32_16x16x32_bf16 a[192:195], v[192:195], v[240:243], a[192:195]
s_and_b32 s73, s65, 1
ds_read_b64_tr_b16 v[224:225], v20 offset:0
v_mfma_f32_16x16x32_bf16 a[192:195], v[196:199], v[244:247], a[192:195]
s_xor_b32 s73, s73, 3
ds_read_b64_tr_b16 v[226:227], v20 offset:1024
v_mfma_f32_16x16x32_bf16 a[196:199], v[204:207], v[244:247], a[196:199]
s_lshl_b32 s69, s73, 7
ds_read_b64_tr_b16 v[228:229], v20 offset:8192
v_mfma_f32_16x16x32_bf16 a[196:199], v[200:203], v[240:243], a[196:199]
s_add_u32 s69, s69, s84
ds_read_b64_tr_b16 v[230:231], v20 offset:9216
v_mfma_f32_16x16x32_bf16 a[200:203], v[208:211], v[240:243], a[200:203]
s_lshl_b32 s71, s73, 19
ds_read_b128 v[128:131], v24 offset:0
v_mfma_f32_16x16x32_bf16 a[200:203], v[212:215], v[244:247], a[200:203]
s_add_u32 s71, s71, s66
ds_read_b128 v[132:135], v25 offset:0
v_mfma_f32_16x16x32_bf16 a[204:207], v[220:223], v[244:247], a[204:207]
s_add_u32 m0, s63, 98304
v_mfma_f32_16x16x32_bf16 a[204:207], v[216:219], v[240:243], a[204:207]
s_add_u32 s72, s69, 0
buffer_load_dwordx4 v2, s[8:11], s72 offen lds
v_mfma_f32_16x16x32_bf16 a[208:211], v[184:187], v[240:243], a[208:211]
s_add_u32 s72, s69, 7168
buffer_load_dwordx4 v3, s[8:11], s72 offen offset:1024 lds
v_mfma_f32_16x16x32_bf16 a[208:211], v[188:191], v[244:247], a[208:211]
s_add_u32 s72, s69, 14336
buffer_load_dwordx4 v2, s[8:11], s72 offen offset:2048 lds
v_mfma_f32_16x16x32_bf16 a[212:215], v[180:183], v[244:247], a[212:215]
ds_read_b128 v[136:139], v24 offset:2048
v_mfma_f32_16x16x32_bf16 a[212:215], v[176:179], v[240:243], a[212:215]
ds_read_b128 v[140:143], v25 offset:2048
v_mfma_f32_16x16x32_bf16 a[216:219], v[168:171], v[240:243], a[216:219]
s_add_u32 s72, s69, 21504
buffer_load_dwordx4 v3, s[8:11], s72 offen offset:3072 lds
v_mfma_f32_16x16x32_bf16 a[216:219], v[172:175], v[244:247], a[216:219]
ds_read_b128 v[144:147], v24 offset:4096
v_mfma_f32_16x16x32_bf16 a[220:223], v[164:167], v[244:247], a[220:223]
ds_read_b128 v[148:151], v25 offset:4096
v_mfma_f32_16x16x32_bf16 a[220:223], v[160:163], v[240:243], a[220:223]
ds_read_b128 v[152:155], v24 offset:6144
v_mfma_f32_16x16x32_bf16 a[252:255], v[160:163], v[248:251], a[252:255]
ds_read_b128 v[156:159], v25 offset:6144
v_mfma_f32_16x16x32_bf16 a[252:255], v[164:167], v[252:255], a[252:255]
s_add_u32 m0, s64, 32768
v_mfma_f32_16x16x32_bf16 a[248:251], v[172:175], v[252:255], a[248:251]
s_add_u32 s72, s71, 0
buffer_load_dwordx4 v6, s[16:19], s72 offen lds
v_mfma_f32_16x16x32_bf16 a[248:251], v[168:171], v[248:251], a[248:251]
ds_read_b128 v[160:163], v24 offset:8192
v_mfma_f32_16x16x32_bf16 a[244:247], v[176:179], v[248:251], a[244:247]
ds_read_b128 v[164:167], v25 offset:8192
v_mfma_f32_16x16x32_bf16 a[244:247], v[180:183], v[252:255], a[244:247]
s_add_u32 s72, s71, 31744
buffer_load_dwordx4 v6, s[16:19], s72 offen offset:1024 lds
v_mfma_f32_16x16x32_bf16 a[240:243], v[188:191], v[252:255], a[240:243]
ds_read_b128 v[168:171], v24 offset:10240
v_mfma_f32_16x16x32_bf16 a[240:243], v[184:187], v[248:251], a[240:243]
ds_read_b128 v[172:175], v25 offset:10240
v_mfma_f32_16x16x32_bf16 a[236:239], v[216:219], v[248:251], a[236:239]
ds_read_b128 v[176:179], v24 offset:12288
v_mfma_f32_16x16x32_bf16 a[236:239], v[220:223], v[252:255], a[236:239]
s_add_u32 s72, s71, 63488
buffer_load_dwordx4 v7, s[16:19], s72 offen offset:2048 lds
v_mfma_f32_16x16x32_bf16 a[232:235], v[212:215], v[252:255], a[232:235]
ds_read_b128 v[180:183], v25 offset:12288
v_mfma_f32_16x16x32_bf16 a[232:235], v[208:211], v[248:251], a[232:235]
ds_read_b128 v[184:187], v24 offset:14336
v_mfma_f32_16x16x32_bf16 a[228:231], v[200:203], v[248:251], a[228:231]
ds_read_b128 v[188:191], v25 offset:14336
v_mfma_f32_16x16x32_bf16 a[228:231], v[204:207], v[252:255], a[228:231]
v_mfma_f32_16x16x32_bf16 a[224:227], v[196:199], v[252:255], a[224:227]
s_add_u32 s72, s71, 95232
buffer_load_dwordx4 v7, s[16:19], s72 offen offset:3072 lds
v_mfma_f32_16x16x32_bf16 a[224:227], v[192:195], v[248:251], a[224:227]
s_waitcnt lgkmcnt(8)
ds_read_b64_tr_b16 v[232:233], v21 offset:0
v_mfma_f32_16x16x32_bf16 a[0:3], v[224:227], v[128:131], a[0:3]
ds_read_b64_tr_b16 v[234:235], v21 offset:1024
v_mfma_f32_16x16x32_bf16 a[0:3], v[228:231], v[132:135], a[0:3]
ds_read_b64_tr_b16 v[240:241], v22 offset:0
v_mfma_f32_16x16x32_bf16 a[4:7], v[228:231], v[140:143], a[4:7]
s_add_u32 m0, s63, 102400
ds_read_b64_tr_b16 v[236:237], v21 offset:8192
v_mfma_f32_16x16x32_bf16 a[4:7], v[224:227], v[136:139], a[4:7]
s_add_u32 s72, s69, 32768
buffer_load_dwordx4 v2, s[8:11], s72 offen lds
v_mfma_f32_16x16x32_bf16 a[8:11], v[224:227], v[144:147], a[8:11]
ds_read_b64_tr_b16 v[238:239], v21 offset:9216
v_mfma_f32_16x16x32_bf16 a[8:11], v[228:231], v[148:151], a[8:11]
v_mfma_f32_16x16x32_bf16 a[12:15], v[228:231], v[156:159], a[12:15]
s_add_u32 s72, s69, 39936
buffer_load_dwordx4 v3, s[8:11], s72 offen offset:1024 lds
v_mfma_f32_16x16x32_bf16 a[12:15], v[224:227], v[152:155], a[12:15]
s_waitcnt lgkmcnt(5)
ds_read_b64_tr_b16 v[242:243], v22 offset:1024
v_mfma_f32_16x16x32_bf16 a[16:19], v[224:227], v[160:163], a[16:19]
v_mfma_f32_16x16x32_bf16 a[16:19], v[228:231], v[164:167], a[16:19]
ds_read_b64_tr_b16 v[244:245], v22 offset:8192
v_mfma_f32_16x16x32_bf16 a[20:23], v[228:231], v[172:175], a[20:23]
v_mfma_f32_16x16x32_bf16 a[20:23], v[224:227], v[168:171], a[20:23]
s_add_u32 s72, s69, 47104
buffer_load_dwordx4 v2, s[8:11], s72 offen offset:2048 lds
v_mfma_f32_16x16x32_bf16 a[24:27], v[224:227], v[176:179], a[24:27]
ds_read_b64_tr_b16 v[246:247], v22 offset:9216
v_mfma_f32_16x16x32_bf16 a[24:27], v[228:231], v[180:183], a[24:27]
v_mfma_f32_16x16x32_bf16 a[28:31], v[228:231], v[188:191], a[28:31]
v_mfma_f32_16x16x32_bf16 a[28:31], v[224:227], v[184:187], a[28:31]
s_waitcnt lgkmcnt(3)
v_mfma_f32_16x16x32_bf16 a[60:63], v[232:235], v[184:187], a[60:63]
s_add_u32 s72, s69, 54272
buffer_load_dwordx4 v3, s[8:11], s72 offen offset:3072 lds
v_mfma_f32_16x16x32_bf16 a[60:63], v[236:239], v[188:191], a[60:63]
ds_read_b64_tr_b16 v[248:249], v23 offset:0
v_mfma_f32_16x16x32_bf16 a[56:59], v[236:239], v[180:183], a[56:59]
v_mfma_f32_16x16x32_bf16 a[56:59], v[232:235], v[176:179], a[56:59]
s_add_u32 m0, s64, 49152
ds_read_b64_tr_b16 v[250:251], v23 offset:1024
v_mfma_f32_16x16x32_bf16 a[52:55], v[232:235], v[168:171], a[52:55]
s_add_u32 s72, s71, 0
buffer_load_dwordx4 v6, s[20:23], s72 offen lds
v_mfma_f32_16x16x32_bf16 a[52:55], v[236:239], v[172:175], a[52:55]
v_mfma_f32_16x16x32_bf16 a[48:51], v[236:239], v[164:167], a[48:51]
v_mfma_f32_16x16x32_bf16 a[48:51], v[232:235], v[160:163], a[48:51]
ds_read_b64_tr_b16 v[252:253], v23 offset:8192
v_mfma_f32_16x16x32_bf16 a[44:47], v[232:235], v[152:155], a[44:47]
s_add_u32 s72, s71, 31744
buffer_load_dwordx4 v6, s[20:23], s72 offen offset:1024 lds
v_mfma_f32_16x16x32_bf16 a[44:47], v[236:239], v[156:159], a[44:47]
v_mfma_f32_16x16x32_bf16 a[40:43], v[236:239], v[148:151], a[40:43]
ds_read_b64_tr_b16 v[254:255], v23 offset:9216
v_mfma_f32_16x16x32_bf16 a[40:43], v[232:235], v[144:147], a[40:43]
v_mfma_f32_16x16x32_bf16 a[36:39], v[232:235], v[136:139], a[36:39]
s_add_u32 s72, s71, 63488
buffer_load_dwordx4 v7, s[20:23], s72 offen offset:2048 lds
v_mfma_f32_16x16x32_bf16 a[36:39], v[236:239], v[140:143], a[36:39]
v_mfma_f32_16x16x32_bf16 a[32:35], v[236:239], v[132:135], a[32:35]
v_mfma_f32_16x16x32_bf16 a[32:35], v[232:235], v[128:131], a[32:35]
s_waitcnt lgkmcnt(4)
v_mfma_f32_16x16x32_bf16 a[64:67], v[240:243], v[128:131], a[64:67]
s_add_u32 s72, s71, 95232
buffer_load_dwordx4 v7, s[20:23], s72 offen offset:3072 lds
v_mfma_f32_16x16x32_bf16 a[64:67], v[244:247], v[132:135], a[64:67]
s_mov_b32 s80, 0x300000
buffer_load_dword v126, v125, s[16:19], s80 offen
v_mfma_f32_16x16x32_bf16 a[68:71], v[244:247], v[140:143], a[68:71]
buffer_load_dword v126, v125, s[20:23], s80 offen
v_mfma_f32_16x16x32_bf16 a[68:71], v[240:243], v[136:139], a[68:71]
s_add_u32 m0, s63, 135168
ds_read_b64_tr_b16 v[224:225], v20 offset:16384
v_mfma_f32_16x16x32_bf16 a[72:75], v[240:243], v[144:147], a[72:75]
s_add_u32 s80, s82, 0
buffer_load_dwordx4 v26, s[32:35], s80 offen nt lds
v_mfma_f32_16x16x32_bf16 a[72:75], v[244:247], v[148:151], a[72:75]
s_add_u32 s80, s82, 15360
buffer_load_dwordx4 v26, s[32:35], s80 offen offset:1024 nt lds
v_mfma_f32_16x16x32_bf16 a[76:79], v[244:247], v[156:159], a[76:79]
s_add_u32 s80, s82, 30720
buffer_load_dwordx4 v26, s[32:35], s80 offen offset:2048 nt lds
v_mfma_f32_16x16x32_bf16 a[76:79], v[240:243], v[152:155], a[76:79]
s_add_u32 s80, s82, 46080
buffer_load_dwordx4 v26, s[32:35], s80 offen offset:3072 nt lds
v_mfma_f32_16x16x32_bf16 a[80:83], v[240:243], v[160:163], a[80:83]
ds_read_b64_tr_b16 v[226:227], v20 offset:17408
v_mfma_f32_16x16x32_bf16 a[80:83], v[244:247], v[164:167], a[80:83]
v_mfma_f32_16x16x32_bf16 a[84:87], v[244:247], v[172:175], a[84:87]
ds_read_b64_tr_b16 v[228:229], v20 offset:24576
v_mfma_f32_16x16x32_bf16 a[84:87], v[240:243], v[168:171], a[84:87]
v_mfma_f32_16x16x32_bf16 a[88:91], v[240:243], v[176:179], a[88:91]
ds_read_b64_tr_b16 v[230:231], v20 offset:25600
v_mfma_f32_16x16x32_bf16 a[88:91], v[244:247], v[180:183], a[88:91]
v_mfma_f32_16x16x32_bf16 a[92:95], v[244:247], v[188:191], a[92:95]
v_mfma_f32_16x16x32_bf16 a[92:95], v[240:243], v[184:187], a[92:95]
s_waitcnt lgkmcnt(4)
v_mfma_f32_16x16x32_bf16 a[124:127], v[248:251], v[184:187], a[124:127]
ds_read_b64_tr_b16 v[232:233], v21 offset:16384
v_mfma_f32_16x16x32_bf16 a[124:127], v[252:255], v[188:191], a[124:127]
v_mfma_f32_16x16x32_bf16 a[120:123], v[252:255], v[180:183], a[120:123]
v_mfma_f32_16x16x32_bf16 a[120:123], v[248:251], v[176:179], a[120:123]
ds_read_b64_tr_b16 v[234:235], v21 offset:17408
v_mfma_f32_16x16x32_bf16 a[116:119], v[248:251], v[168:171], a[116:119]
v_mfma_f32_16x16x32_bf16 a[116:119], v[252:255], v[172:175], a[116:119]
v_mfma_f32_16x16x32_bf16 a[112:115], v[252:255], v[164:167], a[112:115]
v_mfma_f32_16x16x32_bf16 a[112:115], v[248:251], v[160:163], a[112:115]
ds_read_b64_tr_b16 v[236:237], v21 offset:24576
v_mfma_f32_16x16x32_bf16 a[108:111], v[248:251], v[152:155], a[108:111]
v_mfma_f32_16x16x32_bf16 a[108:111], v[252:255], v[156:159], a[108:111]
v_mfma_f32_16x16x32_bf16 a[104:107], v[252:255], v[148:151], a[104:107]
ds_read_b64_tr_b16 v[238:239], v21 offset:25600
v_mfma_f32_16x16x32_bf16 a[104:107], v[248:251], v[144:147], a[104:107]
v_mfma_f32_16x16x32_bf16 a[100:103], v[248:251], v[136:139], a[100:103]
v_mfma_f32_16x16x32_bf16 a[100:103], v[252:255], v[140:143], a[100:103]
v_mfma_f32_16x16x32_bf16 a[96:99], v[252:255], v[132:135], a[96:99]
v_mfma_f32_16x16x32_bf16 a[96:99], v[248:251], v[128:131], a[96:99]
s_waitcnt lgkmcnt(4)
v_mfma_f32_16x16x32_bf16 a[128:131], v[128:131], v[224:227], a[128:131]
ds_read_b64_tr_b16 v[240:241], v22 offset:16384
v_mfma_f32_16x16x32_bf16 a[128:131], v[132:135], v[228:231], a[128:131]
v_mfma_f32_16x16x32_bf16 a[132:135], v[140:143], v[228:231], a[132:135]
v_mfma_f32_16x16x32_bf16 a[132:135], v[136:139], v[224:227], a[132:135]
ds_read_b64_tr_b16 v[242:243], v22 offset:17408
v_mfma_f32_16x16x32_bf16 a[136:139], v[144:147], v[224:227], a[136:139]
v_mfma_f32_16x16x32_bf16 a[136:139], v[148:151], v[228:231], a[136:139]
v_mfma_f32_16x16x32_bf16 a[140:143], v[156:159], v[228:231], a[140:143]
v_mfma_f32_16x16x32_bf16 a[140:143], v[152:155], v[224:227], a[140:143]
ds_read_b64_tr_b16 v[244:245], v22 offset:24576
v_mfma_f32_16x16x32_bf16 a[144:147], v[160:163], v[224:227], a[144:147]
v_mfma_f32_16x16x32_bf16 a[144:147], v[164:167], v[228:231], a[144:147]
v_mfma_f32_16x16x32_bf16 a[148:151], v[172:175], v[228:231], a[148:151]
ds_read_b64_tr_b16 v[246:247], v22 offset:25600
v_mfma_f32_16x16x32_bf16 a[148:151], v[168:171], v[224:227], a[148:151]
v_mfma_f32_16x16x32_bf16 a[152:155], v[176:179], v[224:227], a[152:155]
v_mfma_f32_16x16x32_bf16 a[152:155], v[180:183], v[228:231], a[152:155]
v_mfma_f32_16x16x32_bf16 a[156:159], v[188:191], v[228:231], a[156:159]
v_mfma_f32_16x16x32_bf16 a[156:159], v[184:187], v[224:227], a[156:159]
s_waitcnt lgkmcnt(4)
v_mfma_f32_16x16x32_bf16 a[188:191], v[184:187], v[232:235], a[188:191]
ds_read_b64_tr_b16 v[248:249], v23 offset:16384
v_mfma_f32_16x16x32_bf16 a[188:191], v[188:191], v[236:239], a[188:191]
v_mfma_f32_16x16x32_bf16 a[184:187], v[180:183], v[236:239], a[184:187]
ds_read_b64_tr_b16 v[250:251], v23 offset:17408
v_mfma_f32_16x16x32_bf16 a[184:187], v[176:179], v[232:235], a[184:187]
v_mfma_f32_16x16x32_bf16 a[180:183], v[168:171], v[232:235], a[180:183]
ds_read_b64_tr_b16 v[252:253], v23 offset:24576
v_mfma_f32_16x16x32_bf16 a[180:183], v[172:175], v[236:239], a[180:183]
v_mfma_f32_16x16x32_bf16 a[176:179], v[164:167], v[236:239], a[176:179]
ds_read_b64_tr_b16 v[254:255], v23 offset:25600
v_mfma_f32_16x16x32_bf16 a[176:179], v[160:163], v[232:235], a[176:179]
v_mfma_f32_16x16x32_bf16 a[172:175], v[152:155], v[232:235], a[172:175]
v_mfma_f32_16x16x32_bf16 a[172:175], v[156:159], v[236:239], a[172:175]
v_mfma_f32_16x16x32_bf16 a[168:171], v[148:151], v[236:239], a[168:171]
v_mfma_f32_16x16x32_bf16 a[168:171], v[144:147], v[232:235], a[168:171]
v_mfma_f32_16x16x32_bf16 a[164:167], v[136:139], v[232:235], a[164:167]
v_mfma_f32_16x16x32_bf16 a[164:167], v[140:143], v[236:239], a[164:167]
v_mfma_f32_16x16x32_bf16 a[160:163], v[132:135], v[236:239], a[160:163]
s_waitcnt vmcnt(6) lgkmcnt(0)
v_mfma_f32_16x16x32_bf16 a[160:163], v[128:131], v[232:235], a[160:163]
s_barrier
v_mfma_f32_16x16x32_bf16 a[192:195], v[128:131], v[240:243], a[192:195]
s_and_b32 s73, s65, 1
ds_read_b64_tr_b16 v[224:225], v20 offset:32768
v_mfma_f32_16x16x32_bf16 a[192:195], v[132:135], v[244:247], a[192:195]
s_xor_b32 s73, s73, 4
ds_read_b64_tr_b16 v[226:227], v20 offset:33792
v_mfma_f32_16x16x32_bf16 a[196:199], v[140:143], v[244:247], a[196:199]
s_lshl_b32 s69, s73, 7
ds_read_b64_tr_b16 v[228:229], v20 offset:40960
v_mfma_f32_16x16x32_bf16 a[196:199], v[136:139], v[240:243], a[196:199]
s_add_u32 s69, s69, s84
ds_read_b64_tr_b16 v[230:231], v20 offset:41984
v_mfma_f32_16x16x32_bf16 a[200:203], v[144:147], v[240:243], a[200:203]
s_lshl_b32 s71, s73, 19
ds_read_b128 v[192:195], v24 offset:32768
v_mfma_f32_16x16x32_bf16 a[200:203], v[148:151], v[244:247], a[200:203]
s_add_u32 s71, s71, s66
ds_read_b128 v[196:199], v25 offset:32768
v_mfma_f32_16x16x32_bf16 a[204:207], v[156:159], v[244:247], a[204:207]
s_add_u32 m0, s63, 65536
v_mfma_f32_16x16x32_bf16 a[204:207], v[152:155], v[240:243], a[204:207]
s_add_u32 s72, s69, 0
buffer_load_dwordx4 v2, s[8:11], s72 offen lds
v_mfma_f32_16x16x32_bf16 a[208:211], v[160:163], v[240:243], a[208:211]
s_add_u32 s72, s69, 7168
buffer_load_dwordx4 v3, s[8:11], s72 offen offset:1024 lds
v_mfma_f32_16x16x32_bf16 a[208:211], v[164:167], v[244:247], a[208:211]
s_add_u32 s72, s69, 14336
buffer_load_dwordx4 v2, s[8:11], s72 offen offset:2048 lds
v_mfma_f32_16x16x32_bf16 a[212:215], v[172:175], v[244:247], a[212:215]
ds_read_b128 v[200:203], v24 offset:34816
v_mfma_f32_16x16x32_bf16 a[212:215], v[168:171], v[240:243], a[212:215]
ds_read_b128 v[204:207], v25 offset:34816
v_mfma_f32_16x16x32_bf16 a[216:219], v[176:179], v[240:243], a[216:219]
s_add_u32 s72, s69, 21504
buffer_load_dwordx4 v3, s[8:11], s72 offen offset:3072 lds
v_mfma_f32_16x16x32_bf16 a[216:219], v[180:183], v[244:247], a[216:219]
ds_read_b128 v[208:211], v24 offset:36864
v_mfma_f32_16x16x32_bf16 a[220:223], v[188:191], v[244:247], a[220:223]
ds_read_b128 v[212:215], v25 offset:36864
v_mfma_f32_16x16x32_bf16 a[220:223], v[184:187], v[240:243], a[220:223]
ds_read_b128 v[216:219], v24 offset:38912
v_mfma_f32_16x16x32_bf16 a[252:255], v[184:187], v[248:251], a[252:255]
ds_read_b128 v[220:223], v25 offset:38912
v_mfma_f32_16x16x32_bf16 a[252:255], v[188:191], v[252:255], a[252:255]
s_add_u32 m0, s64, 0
v_mfma_f32_16x16x32_bf16 a[248:251], v[180:183], v[252:255], a[248:251]
s_add_u32 s72, s71, 0
buffer_load_dwordx4 v6, s[16:19], s72 offen lds
v_mfma_f32_16x16x32_bf16 a[248:251], v[176:179], v[248:251], a[248:251]
ds_read_b128 v[184:187], v24 offset:40960
v_mfma_f32_16x16x32_bf16 a[244:247], v[168:171], v[248:251], a[244:247]
ds_read_b128 v[188:191], v25 offset:40960
v_mfma_f32_16x16x32_bf16 a[244:247], v[172:175], v[252:255], a[244:247]
s_add_u32 s72, s71, 31744
buffer_load_dwordx4 v6, s[16:19], s72 offen offset:1024 lds
v_mfma_f32_16x16x32_bf16 a[240:243], v[164:167], v[252:255], a[240:243]
ds_read_b128 v[176:179], v24 offset:43008
v_mfma_f32_16x16x32_bf16 a[240:243], v[160:163], v[248:251], a[240:243]
ds_read_b128 v[180:183], v25 offset:43008
v_mfma_f32_16x16x32_bf16 a[236:239], v[152:155], v[248:251], a[236:239]
ds_read_b128 v[168:171], v24 offset:45056
v_mfma_f32_16x16x32_bf16 a[236:239], v[156:159], v[252:255], a[236:239]
s_add_u32 s72, s71, 63488
buffer_load_dwordx4 v7, s[16:19], s72 offen offset:2048 lds
v_mfma_f32_16x16x32_bf16 a[232:235], v[148:151], v[252:255], a[232:235]
ds_read_b128 v[172:175], v25 offset:45056
v_mfma_f32_16x16x32_bf16 a[232:235], v[144:147], v[248:251], a[232:235]
ds_read_b128 v[160:163], v24 offset:47104
v_mfma_f32_16x16x32_bf16 a[228:231], v[136:139], v[248:251], a[228:231]
ds_read_b128 v[164:167], v25 offset:47104
v_mfma_f32_16x16x32_bf16 a[228:231], v[140:143], v[252:255], a[228:231]
v_mfma_f32_16x16x32_bf16 a[224:227], v[132:135], v[252:255], a[224:227]
s_add_u32 s72, s71, 95232
buffer_load_dwordx4 v7, s[16:19], s72 offen offset:3072 lds
v_mfma_f32_16x16x32_bf16 a[224:227], v[128:131], v[248:251], a[224:227]
s_waitcnt lgkmcnt(8)
ds_read_b64_tr_b16 v[232:233], v21 offset:32768
v_mfma_f32_16x16x32_bf16 a[0:3], v[224:227], v[192:195], a[0:3]
ds_read_b64_tr_b16 v[234:235], v21 offset:33792
v_mfma_f32_16x16x32_bf16 a[0:3], v[228:231], v[196:199], a[0:3]
ds_read_b64_tr_b16 v[240:241], v22 offset:32768
v_mfma_f32_16x16x32_bf16 a[4:7], v[228:231], v[204:207], a[4:7]
s_add_u32 m0, s63, 69632
ds_read_b64_tr_b16 v[236:237], v21 offset:40960
v_mfma_f32_16x16x32_bf16 a[4:7], v[224:227], v[200:203], a[4:7]
s_add_u32 s72, s69, 32768
buffer_load_dwordx4 v2, s[8:11], s72 offen lds
v_mfma_f32_16x16x32_bf16 a[8:11], v[224:227], v[208:211], a[8:11]
ds_read_b64_tr_b16 v[238:239], v21 offset:41984
v_mfma_f32_16x16x32_bf16 a[8:11], v[228:231], v[212:215], a[8:11]
v_mfma_f32_16x16x32_bf16 a[12:15], v[228:231], v[220:223], a[12:15]
s_add_u32 s72, s69, 39936
buffer_load_dwordx4 v3, s[8:11], s72 offen offset:1024 lds
v_mfma_f32_16x16x32_bf16 a[12:15], v[224:227], v[216:219], a[12:15]
s_waitcnt lgkmcnt(5)
ds_read_b64_tr_b16 v[242:243], v22 offset:33792
v_mfma_f32_16x16x32_bf16 a[16:19], v[224:227], v[184:187], a[16:19]
v_mfma_f32_16x16x32_bf16 a[16:19], v[228:231], v[188:191], a[16:19]
ds_read_b64_tr_b16 v[244:245], v22 offset:40960
v_mfma_f32_16x16x32_bf16 a[20:23], v[228:231], v[180:183], a[20:23]
v_mfma_f32_16x16x32_bf16 a[20:23], v[224:227], v[176:179], a[20:23]
s_add_u32 s72, s69, 47104
buffer_load_dwordx4 v2, s[8:11], s72 offen offset:2048 lds
v_mfma_f32_16x16x32_bf16 a[24:27], v[224:227], v[168:171], a[24:27]
ds_read_b64_tr_b16 v[246:247], v22 offset:41984
v_mfma_f32_16x16x32_bf16 a[24:27], v[228:231], v[172:175], a[24:27]
v_mfma_f32_16x16x32_bf16 a[28:31], v[228:231], v[164:167], a[28:31]
v_mfma_f32_16x16x32_bf16 a[28:31], v[224:227], v[160:163], a[28:31]
s_waitcnt lgkmcnt(3)
v_mfma_f32_16x16x32_bf16 a[60:63], v[232:235], v[160:163], a[60:63]
s_add_u32 s72, s69, 54272
buffer_load_dwordx4 v3, s[8:11], s72 offen offset:3072 lds
v_mfma_f32_16x16x32_bf16 a[60:63], v[236:239], v[164:167], a[60:63]
ds_read_b64_tr_b16 v[248:249], v23 offset:32768
v_mfma_f32_16x16x32_bf16 a[56:59], v[236:239], v[172:175], a[56:59]
v_mfma_f32_16x16x32_bf16 a[56:59], v[232:235], v[168:171], a[56:59]
s_add_u32 m0, s64, 16384
ds_read_b64_tr_b16 v[250:251], v23 offset:33792
v_mfma_f32_16x16x32_bf16 a[52:55], v[232:235], v[176:179], a[52:55]
s_add_u32 s72, s71, 0
buffer_load_dwordx4 v6, s[20:23], s72 offen lds
v_mfma_f32_16x16x32_bf16 a[52:55], v[236:239], v[180:183], a[52:55]
v_mfma_f32_16x16x32_bf16 a[48:51], v[236:239], v[188:191], a[48:51]
v_mfma_f32_16x16x32_bf16 a[48:51], v[232:235], v[184:187], a[48:51]
ds_read_b64_tr_b16 v[252:253], v23 offset:40960
v_mfma_f32_16x16x32_bf16 a[44:47], v[232:235], v[216:219], a[44:47]
s_add_u32 s72, s71, 31744
buffer_load_dwordx4 v6, s[20:23], s72 offen offset:1024 lds
v_mfma_f32_16x16x32_bf16 a[44:47], v[236:239], v[220:223], a[44:47]
v_mfma_f32_16x16x32_bf16 a[40:43], v[236:239], v[212:215], a[40:43]
ds_read_b64_tr_b16 v[254:255], v23 offset:41984
v_mfma_f32_16x16x32_bf16 a[40:43], v[232:235], v[208:211], a[40:43]
v_mfma_f32_16x16x32_bf16 a[36:39], v[232:235], v[200:203], a[36:39]
s_add_u32 s72, s71, 63488
buffer_load_dwordx4 v7, s[20:23], s72 offen offset:2048 lds
v_mfma_f32_16x16x32_bf16 a[36:39], v[236:239], v[204:207], a[36:39]
v_mfma_f32_16x16x32_bf16 a[32:35], v[236:239], v[196:199], a[32:35]
v_mfma_f32_16x16x32_bf16 a[32:35], v[232:235], v[192:195], a[32:35]
s_waitcnt lgkmcnt(4)
v_mfma_f32_16x16x32_bf16 a[64:67], v[240:243], v[192:195], a[64:67]
s_add_u32 s72, s71, 95232
buffer_load_dwordx4 v7, s[20:23], s72 offen offset:3072 lds
v_mfma_f32_16x16x32_bf16 a[64:67], v[244:247], v[196:199], a[64:67]
buffer_load_dwordx4 v[108:111], v1, s[4:7], s76 offen
v_mfma_f32_16x16x32_bf16 a[68:71], v[244:247], v[204:207], a[68:71]
buffer_load_dwordx4 v[112:115], v1, s[4:7], s76 offen offset:1024
v_mfma_f32_16x16x32_bf16 a[68:71], v[240:243], v[200:203], a[68:71]
buffer_load_dwordx4 v[116:119], v1, s[4:7], s76 offen offset:2048
v_mfma_f32_16x16x32_bf16 a[72:75], v[240:243], v[208:211], a[72:75]
buffer_load_dwordx4 v[120:123], v1, s[4:7], s76 offen offset:3072
v_mfma_f32_16x16x32_bf16 a[72:75], v[244:247], v[212:215], a[72:75]
ds_read_b64_tr_b16 v[224:225], v20 offset:49152
v_mfma_f32_16x16x32_bf16 a[76:79], v[244:247], v[220:223], a[76:79]
v_mfma_f32_16x16x32_bf16 a[76:79], v[240:243], v[216:219], a[76:79]
ds_read_b64_tr_b16 v[226:227], v20 offset:50176
v_mfma_f32_16x16x32_bf16 a[80:83], v[240:243], v[184:187], a[80:83]
v_mfma_f32_16x16x32_bf16 a[80:83], v[244:247], v[188:191], a[80:83]
ds_read_b64_tr_b16 v[228:229], v20 offset:57344
v_mfma_f32_16x16x32_bf16 a[84:87], v[244:247], v[180:183], a[84:87]
v_mfma_f32_16x16x32_bf16 a[84:87], v[240:243], v[176:179], a[84:87]
ds_read_b64_tr_b16 v[230:231], v20 offset:58368
v_mfma_f32_16x16x32_bf16 a[88:91], v[240:243], v[168:171], a[88:91]
v_mfma_f32_16x16x32_bf16 a[88:91], v[244:247], v[172:175], a[88:91]
v_mfma_f32_16x16x32_bf16 a[92:95], v[244:247], v[164:167], a[92:95]
v_mfma_f32_16x16x32_bf16 a[92:95], v[240:243], v[160:163], a[92:95]
s_waitcnt lgkmcnt(4)
v_mfma_f32_16x16x32_bf16 a[124:127], v[248:251], v[160:163], a[124:127]
ds_read_b64_tr_b16 v[232:233], v21 offset:49152
v_mfma_f32_16x16x32_bf16 a[124:127], v[252:255], v[164:167], a[124:127]
v_mfma_f32_16x16x32_bf16 a[120:123], v[252:255], v[172:175], a[120:123]
v_mfma_f32_16x16x32_bf16 a[120:123], v[248:251], v[168:171], a[120:123]
ds_read_b64_tr_b16 v[234:235], v21 offset:50176
v_mfma_f32_16x16x32_bf16 a[116:119], v[248:251], v[176:179], a[116:119]
s_waitcnt vmcnt(20)
ds_read2_b32 v[36:37], v98 offset0:0 offset1:32
ds_read2_b32 v[38:39], v98 offset0:64 offset1:96
v_mfma_f32_16x16x32_bf16 a[116:119], v[252:255], v[180:183], a[116:119]
ds_read2_b32 v[40:41], v98 offset0:128 offset1:160
ds_read2_b32 v[42:43], v98 offset0:192 offset1:224
v_mfma_f32_16x16x32_bf16 a[112:115], v[252:255], v[188:191], a[112:115]
v_add_u32 v98, 1024, v98
v_mfma_f32_16x16x32_bf16 a[112:115], v[248:251], v[184:187], a[112:115]
ds_read_b64_tr_b16 v[236:237], v21 offset:57344
ds_read2_b32 v[44:45], v98 offset0:0 offset1:32
v_mfma_f32_16x16x32_bf16 a[108:111], v[248:251], v[216:219], a[108:111]
ds_read2_b32 v[46:47], v98 offset0:64 offset1:96
ds_read2_b32 v[48:49], v98 offset0:128 offset1:160
v_mfma_f32_16x16x32_bf16 a[108:111], v[252:255], v[220:223], a[108:111]
ds_read2_b32 v[50:51], v98 offset0:192 offset1:224
v_add_u32 v98, 3072, v98
v_mfma_f32_16x16x32_bf16 a[104:107], v[252:255], v[212:215], a[104:107]
ds_read_b64_tr_b16 v[238:239], v21 offset:58368
ds_read2_b32 v[52:53], v98 offset0:0 offset1:32
v_mfma_f32_16x16x32_bf16 a[104:107], v[248:251], v[208:211], a[104:107]
ds_read2_b32 v[54:55], v98 offset0:64 offset1:96
ds_read2_b32 v[56:57], v98 offset0:128 offset1:160
v_mfma_f32_16x16x32_bf16 a[100:103], v[248:251], v[200:203], a[100:103]
ds_read2_b32 v[58:59], v98 offset0:192 offset1:224
v_add_u32 v98, 1024, v98
v_mfma_f32_16x16x32_bf16 a[100:103], v[252:255], v[204:207], a[100:103]
ds_read2_b32 v[60:61], v98 offset0:0 offset1:32
ds_read2_b32 v[62:63], v98 offset0:64 offset1:96
v_mfma_f32_16x16x32_bf16 a[96:99], v[252:255], v[196:199], a[96:99]
ds_read2_b32 v[64:65], v98 offset0:128 offset1:160
ds_read2_b32 v[66:67], v98 offset0:192 offset1:224
v_mfma_f32_16x16x32_bf16 a[96:99], v[248:251], v[192:195], a[96:99]
s_waitcnt lgkmcnt(15)
v_mfma_f32_16x16x32_bf16 a[128:131], v[192:195], v[224:227], a[128:131]
ds_read_b64_tr_b16 v[240:241], v22 offset:49152
v_mfma_f32_16x16x32_bf16 a[128:131], v[196:199], v[228:231], a[128:131]
v_mfma_f32_16x16x32_bf16 a[132:135], v[204:207], v[228:231], a[132:135]
v_mfma_f32_16x16x32_bf16 a[132:135], v[200:203], v[224:227], a[132:135]
ds_read_b64_tr_b16 v[242:243], v22 offset:50176
v_mfma_f32_16x16x32_bf16 a[136:139], v[208:211], v[224:227], a[136:139]
v_mfma_f32_16x16x32_bf16 a[136:139], v[212:215], v[228:231], a[136:139]
v_mfma_f32_16x16x32_bf16 a[140:143], v[220:223], v[228:231], a[140:143]
v_mfma_f32_16x16x32_bf16 a[140:143], v[216:219], v[224:227], a[140:143]
ds_read_b64_tr_b16 v[244:245], v22 offset:57344
v_mfma_f32_16x16x32_bf16 a[144:147], v[184:187], v[224:227], a[144:147]
v_mfma_f32_16x16x32_bf16 a[144:147], v[188:191], v[228:231], a[144:147]
v_mfma_f32_16x16x32_bf16 a[148:151], v[180:183], v[228:231], a[148:151]
ds_read_b64_tr_b16 v[246:247], v22 offset:58368
v_mfma_f32_16x16x32_bf16 a[148:151], v[176:179], v[224:227], a[148:151]
v_mfma_f32_16x16x32_bf16 a[152:155], v[168:171], v[224:227], a[152:155]
v_mfma_f32_16x16x32_bf16 a[152:155], v[172:175], v[228:231], a[152:155]
v_mfma_f32_16x16x32_bf16 a[156:159], v[164:167], v[228:231], a[156:159]
v_mfma_f32_16x16x32_bf16 a[156:159], v[160:163], v[224:227], a[156:159]
s_waitcnt lgkmcnt(12)
v_mfma_f32_16x16x32_bf16 a[188:191], v[160:163], v[232:235], a[188:191]
ds_read_b64_tr_b16 v[248:249], v23 offset:49152
v_mfma_f32_16x16x32_bf16 a[188:191], v[164:167], v[236:239], a[188:191]
v_mfma_f32_16x16x32_bf16 a[184:187], v[172:175], v[236:239], a[184:187]
ds_read_b64_tr_b16 v[250:251], v23 offset:50176
v_mfma_f32_16x16x32_bf16 a[184:187], v[168:171], v[232:235], a[184:187]
v_mfma_f32_16x16x32_bf16 a[180:183], v[176:179], v[232:235], a[180:183]
ds_read_b64_tr_b16 v[252:253], v23 offset:57344
v_mfma_f32_16x16x32_bf16 a[180:183], v[180:183], v[236:239], a[180:183]
v_mfma_f32_16x16x32_bf16 a[176:179], v[188:191], v[236:239], a[176:179]
ds_read_b64_tr_b16 v[254:255], v23 offset:58368
v_mfma_f32_16x16x32_bf16 a[176:179], v[184:187], v[232:235], a[176:179]
v_mfma_f32_16x16x32_bf16 a[172:175], v[216:219], v[232:235], a[172:175]
v_mfma_f32_16x16x32_bf16 a[172:175], v[220:223], v[236:239], a[172:175]
v_mfma_f32_16x16x32_bf16 a[168:171], v[212:215], v[236:239], a[168:171]
v_mfma_f32_16x16x32_bf16 a[168:171], v[208:211], v[232:235], a[168:171]
v_mfma_f32_16x16x32_bf16 a[164:167], v[200:203], v[232:235], a[164:167]
v_mfma_f32_16x16x32_bf16 a[164:167], v[204:207], v[236:239], a[164:167]
v_mfma_f32_16x16x32_bf16 a[160:163], v[196:199], v[236:239], a[160:163]
s_waitcnt vmcnt(4) lgkmcnt(0)
v_mfma_f32_16x16x32_bf16 a[160:163], v[192:195], v[232:235], a[160:163]
s_barrier
v_mfma_f32_16x16x32_bf16 a[192:195], v[192:195], v[240:243], a[192:195]
s_and_b32 s73, s65, 1
ds_read_b64_tr_b16 v[224:225], v20 offset:0
v_lshlrev_b32 v72, 16, v68
v_mfma_f32_16x16x32_bf16 a[192:195], v[196:199], v[244:247], a[192:195]
s_xor_b32 s73, s73, 5
ds_read_b64_tr_b16 v[226:227], v20 offset:1024
v_and_b32 v73, 0xffff0000, v68
v_mfma_f32_16x16x32_bf16 a[196:199], v[204:207], v[244:247], a[196:199]
s_lshl_b32 s69, s73, 7
ds_read_b64_tr_b16 v[228:229], v20 offset:8192
v_lshlrev_b32 v74, 16, v69
v_mfma_f32_16x16x32_bf16 a[196:199], v[200:203], v[240:243], a[196:199]
s_add_u32 s69, s69, s84
ds_read_b64_tr_b16 v[230:231], v20 offset:9216
v_and_b32 v75, 0xffff0000, v69
v_mfma_f32_16x16x32_bf16 a[200:203], v[208:211], v[240:243], a[200:203]
s_lshl_b32 s71, s73, 19
ds_read_b128 v[128:131], v24 offset:0
v_lshlrev_b32 v76, 16, v33
v_mfma_f32_16x16x32_bf16 a[200:203], v[212:215], v[244:247], a[200:203]
s_add_u32 s71, s71, s66
ds_read_b128 v[132:135], v25 offset:0
v_lshlrev_b32 v77, 16, v34
v_mfma_f32_16x16x32_bf16 a[204:207], v[220:223], v[244:247], a[204:207]
s_add_u32 m0, s63, 98304
v_lshlrev_b32 v78, 16, v35
v_lshlrev_b32 v79, 16, v36
v_mfma_f32_16x16x32_bf16 a[204:207], v[216:219], v[240:243], a[204:207]
s_add_u32 s72, s69, 0
buffer_load_dwordx4 v2, s[8:11], s72 offen lds
v_mfma_f32_16x16x32_bf16 a[208:211], v[184:187], v[240:243], a[208:211]
s_add_u32 s72, s69, 7168
buffer_load_dwordx4 v3, s[8:11], s72 offen offset:1024 lds
v_mfma_f32_16x16x32_bf16 a[208:211], v[188:191], v[244:247], a[208:211]
s_add_u32 s72, s69, 14336
buffer_load_dwordx4 v2, s[8:11], s72 offen offset:2048 lds
v_mfma_f32_16x16x32_bf16 a[212:215], v[180:183], v[244:247], a[212:215]
ds_read_b128 v[136:139], v24 offset:2048
v_lshlrev_b32 v80, 16, v37
v_mfma_f32_16x16x32_bf16 a[212:215], v[176:179], v[240:243], a[212:215]
ds_read_b128 v[140:143], v25 offset:2048
v_lshlrev_b32 v81, 16, v38
v_mfma_f32_16x16x32_bf16 a[216:219], v[168:171], v[240:243], a[216:219]
s_add_u32 s72, s69, 21504
buffer_load_dwordx4 v3, s[8:11], s72 offen offset:3072 lds
v_mfma_f32_16x16x32_bf16 a[216:219], v[172:175], v[244:247], a[216:219]
ds_read_b128 v[144:147], v24 offset:4096
v_lshlrev_b32 v82, 16, v39
v_mfma_f32_16x16x32_bf16 a[220:223], v[164:167], v[244:247], a[220:223]
ds_read_b128 v[148:151], v25 offset:4096
v_lshlrev_b32 v83, 16, v40
v_mfma_f32_16x16x32_bf16 a[220:223], v[160:163], v[240:243], a[220:223]
ds_read_b128 v[152:155], v24 offset:6144
v_lshlrev_b32 v84, 16, v41
v_mfma_f32_16x16x32_bf16 a[252:255], v[160:163], v[248:251], a[252:255]
ds_read_b128 v[156:159], v25 offset:6144
v_lshlrev_b32 v85, 16, v42
v_mfma_f32_16x16x32_bf16 a[252:255], v[164:167], v[252:255], a[252:255]
s_add_u32 m0, s64, 32768
v_lshlrev_b32 v86, 16, v43
v_lshlrev_b32 v87, 16, v44
v_mfma_f32_16x16x32_bf16 a[248:251], v[172:175], v[252:255], a[248:251]
s_add_u32 s72, s71, 0
buffer_load_dwordx4 v6, s[16:19], s72 offen lds
v_mfma_f32_16x16x32_bf16 a[248:251], v[168:171], v[248:251], a[248:251]
ds_read_b128 v[160:163], v24 offset:8192
v_lshlrev_b32 v88, 16, v45
v_mfma_f32_16x16x32_bf16 a[244:247], v[176:179], v[248:251], a[244:247]
ds_read_b128 v[164:167], v25 offset:8192
v_lshlrev_b32 v89, 16, v46
v_mfma_f32_16x16x32_bf16 a[244:247], v[180:183], v[252:255], a[244:247]
s_add_u32 s72, s71, 31744
buffer_load_dwordx4 v6, s[16:19], s72 offen offset:1024 lds
v_mfma_f32_16x16x32_bf16 a[240:243], v[188:191], v[252:255], a[240:243]
ds_read_b128 v[168:171], v24 offset:10240
v_lshlrev_b32 v90, 16, v47
v_mfma_f32_16x16x32_bf16 a[240:243], v[184:187], v[248:251], a[240:243]
ds_read_b128 v[172:175], v25 offset:10240
v_lshlrev_b32 v91, 16, v48
v_mfma_f32_16x16x32_bf16 a[236:239], v[216:219], v[248:251], a[236:239]
ds_read_b128 v[176:179], v24 offset:12288
v_lshlrev_b32 v92, 16, v49
v_mfma_f32_16x16x32_bf16 a[236:239], v[220:223], v[252:255], a[236:239]
s_add_u32 s72, s71, 63488
buffer_load_dwordx4 v7, s[16:19], s72 offen offset:2048 lds
v_mfma_f32_16x16x32_bf16 a[232:235], v[212:215], v[252:255], a[232:235]
ds_read_b128 v[180:183], v25 offset:12288
v_lshlrev_b32 v93, 16, v50
v_mfma_f32_16x16x32_bf16 a[232:235], v[208:211], v[248:251], a[232:235]
ds_read_b128 v[184:187], v24 offset:14336
v_lshlrev_b32 v94, 16, v51
v_mfma_f32_16x16x32_bf16 a[228:231], v[200:203], v[248:251], a[228:231]
ds_read_b128 v[188:191], v25 offset:14336
v_mul_f32 v95, v75, v91
v_mfma_f32_16x16x32_bf16 a[228:231], v[204:207], v[252:255], a[228:231]
v_lshlrev_b32 v97, 16, v67
v_fmac_f32 v95, v74, v92
v_mfma_f32_16x16x32_bf16 a[224:227], v[196:199], v[252:255], a[224:227]
s_add_u32 s72, s71, 95232
buffer_load_dwordx4 v7, s[16:19], s72 offen offset:3072 lds
v_mfma_f32_16x16x32_bf16 a[224:227], v[192:195], v[248:251], a[224:227]
s_waitcnt lgkmcnt(8)
ds_read_b64_tr_b16 v[232:233], v21 offset:0
v_fmac_f32 v95, v73, v93
v_mfma_f32_16x16x32_bf16 a[0:3], v[224:227], v[128:131], a[0:3]
ds_read_b64_tr_b16 v[234:235], v21 offset:1024
v_fmac_f32 v95, v72, v94
v_mfma_f32_16x16x32_bf16 a[0:3], v[228:231], v[132:135], a[0:3]
ds_read_b64_tr_b16 v[240:241], v22 offset:0
v_mul_f32 v95, v95, v97
v_mfma_f32_16x16x32_bf16 a[4:7], v[228:231], v[140:143], a[4:7]
s_add_u32 m0, s63, 102400
ds_read_b64_tr_b16 v[236:237], v21 offset:8192
v_mul_f32 v96, v75, v90
v_mfma_f32_16x16x32_bf16 a[4:7], v[224:227], v[136:139], a[4:7]
s_add_u32 s72, s69, 32768
buffer_load_dwordx4 v2, s[8:11], s72 offen lds
v_mfma_f32_16x16x32_bf16 a[8:11], v[224:227], v[144:147], a[8:11]
ds_read_b64_tr_b16 v[238:239], v21 offset:9216
v_lshlrev_b32 v97, 16, v66
v_mfma_f32_16x16x32_bf16 a[8:11], v[228:231], v[148:151], a[8:11]
v_fmac_f32 v96, v74, v91
v_fmac_f32 v96, v73, v92
v_mfma_f32_16x16x32_bf16 a[12:15], v[228:231], v[156:159], a[12:15]
s_add_u32 s72, s69, 39936
buffer_load_dwordx4 v3, s[8:11], s72 offen offset:1024 lds
v_mfma_f32_16x16x32_bf16 a[12:15], v[224:227], v[152:155], a[12:15]
s_waitcnt lgkmcnt(5)
ds_read_b64_tr_b16 v[242:243], v22 offset:1024
v_fmac_f32 v96, v72, v93
v_mfma_f32_16x16x32_bf16 a[16:19], v[224:227], v[160:163], a[16:19]
v_mul_f32 v96, v96, v97
v_cvt_pk_bf16_f32 v100, v95, v96
v_mfma_f32_16x16x32_bf16 a[16:19], v[228:231], v[164:167], a[16:19]
ds_read_b64_tr_b16 v[244:245], v22 offset:8192
v_mul_f32 v95, v75, v89
v_mfma_f32_16x16x32_bf16 a[20:23], v[228:231], v[172:175], a[20:23]
v_lshlrev_b32 v97, 16, v65
v_fmac_f32 v95, v74, v90
v_mfma_f32_16x16x32_bf16 a[20:23], v[224:227], v[168:171], a[20:23]
s_add_u32 s72, s69, 47104
buffer_load_dwordx4 v2, s[8:11], s72 offen offset:2048 lds
v_mfma_f32_16x16x32_bf16 a[24:27], v[224:227], v[176:179], a[24:27]
ds_read_b64_tr_b16 v[246:247], v22 offset:9216
v_fmac_f32 v95, v73, v91
v_mfma_f32_16x16x32_bf16 a[24:27], v[228:231], v[180:183], a[24:27]
v_fmac_f32 v95, v72, v92
v_mul_f32 v95, v95, v97
v_mfma_f32_16x16x32_bf16 a[28:31], v[228:231], v[188:191], a[28:31]
v_mul_f32 v96, v75, v88
v_lshlrev_b32 v97, 16, v64
v_mfma_f32_16x16x32_bf16 a[28:31], v[224:227], v[184:187], a[28:31]
s_waitcnt lgkmcnt(3)
v_fmac_f32 v96, v74, v89
v_fmac_f32 v96, v73, v90
v_mfma_f32_16x16x32_bf16 a[60:63], v[232:235], v[184:187], a[60:63]
s_add_u32 s72, s69, 54272
buffer_load_dwordx4 v3, s[8:11], s72 offen offset:3072 lds
v_mfma_f32_16x16x32_bf16 a[60:63], v[236:239], v[188:191], a[60:63]
ds_read_b64_tr_b16 v[248:249], v23 offset:0
v_fmac_f32 v96, v72, v91
v_mfma_f32_16x16x32_bf16 a[56:59], v[236:239], v[180:183], a[56:59]
v_mul_f32 v96, v96, v97
v_cvt_pk_bf16_f32 v101, v95, v96
v_mfma_f32_16x16x32_bf16 a[56:59], v[232:235], v[176:179], a[56:59]
s_add_u32 m0, s64, 49152
ds_read_b64_tr_b16 v[250:251], v23 offset:1024
v_mul_f32 v95, v75, v87
v_mfma_f32_16x16x32_bf16 a[52:55], v[232:235], v[168:171], a[52:55]
s_add_u32 s72, s71, 0
buffer_load_dwordx4 v6, s[20:23], s72 offen lds
v_mfma_f32_16x16x32_bf16 a[52:55], v[236:239], v[172:175], a[52:55]
v_lshlrev_b32 v97, 16, v63
v_fmac_f32 v95, v74, v88
v_mfma_f32_16x16x32_bf16 a[48:51], v[236:239], v[164:167], a[48:51]
v_fmac_f32 v95, v73, v89
v_fmac_f32 v95, v72, v90
v_mfma_f32_16x16x32_bf16 a[48:51], v[232:235], v[160:163], a[48:51]
ds_read_b64_tr_b16 v[252:253], v23 offset:8192
v_mul_f32 v95, v95, v97
v_mfma_f32_16x16x32_bf16 a[44:47], v[232:235], v[152:155], a[44:47]
s_add_u32 s72, s71, 31744
buffer_load_dwordx4 v6, s[20:23], s72 offen offset:1024 lds
v_mfma_f32_16x16x32_bf16 a[44:47], v[236:239], v[156:159], a[44:47]
v_mul_f32 v96, v75, v86
v_lshlrev_b32 v97, 16, v62
v_mfma_f32_16x16x32_bf16 a[40:43], v[236:239], v[148:151], a[40:43]
ds_read_b64_tr_b16 v[254:255], v23 offset:9216
v_fmac_f32 v96, v74, v87
v_mfma_f32_16x16x32_bf16 a[40:43], v[232:235], v[144:147], a[40:43]
v_fmac_f32 v96, v73, v88
v_fmac_f32 v96, v72, v89
v_mfma_f32_16x16x32_bf16 a[36:39], v[232:235], v[136:139], a[36:39]
s_add_u32 s72, s71, 63488
buffer_load_dwordx4 v7, s[20:23], s72 offen offset:2048 lds
v_mfma_f32_16x16x32_bf16 a[36:39], v[236:239], v[140:143], a[36:39]
v_mul_f32 v96, v96, v97
v_cvt_pk_bf16_f32 v102, v95, v96
v_mfma_f32_16x16x32_bf16 a[32:35], v[236:239], v[132:135], a[32:35]
v_mul_f32 v95, v75, v85
v_lshlrev_b32 v97, 16, v61
v_mfma_f32_16x16x32_bf16 a[32:35], v[232:235], v[128:131], a[32:35]
s_waitcnt lgkmcnt(4)
v_fmac_f32 v95, v74, v86
v_fmac_f32 v95, v73, v87
v_mfma_f32_16x16x32_bf16 a[64:67], v[240:243], v[128:131], a[64:67]
s_add_u32 s72, s71, 95232
buffer_load_dwordx4 v7, s[20:23], s72 offen offset:3072 lds
v_mfma_f32_16x16x32_bf16 a[64:67], v[244:247], v[132:135], a[64:67]
s_mov_b32 s80, 0x0
buffer_load_dword v126, v125, s[12:15], s80 offen
v_mfma_f32_16x16x32_bf16 a[68:71], v[244:247], v[140:143], a[68:71]
s_mov_b32 s80, 0x100000
buffer_load_dword v126, v125, s[12:15], s80 offen
v_mfma_f32_16x16x32_bf16 a[68:71], v[240:243], v[136:139], a[68:71]
s_mov_b32 s80, 0x200000
buffer_load_dword v126, v125, s[12:15], s80 offen
v_mfma_f32_16x16x32_bf16 a[72:75], v[240:243], v[144:147], a[72:75]
s_mov_b32 s80, 0x300000
buffer_load_dword v126, v125, s[12:15], s80 offen
v_mfma_f32_16x16x32_bf16 a[72:75], v[244:247], v[148:151], a[72:75]
ds_read_b64_tr_b16 v[224:225], v20 offset:16384
v_fmac_f32 v95, v72, v88
v_mfma_f32_16x16x32_bf16 a[76:79], v[244:247], v[156:159], a[76:79]
v_mul_f32 v95, v95, v97
v_mul_f32 v96, v75, v84
v_mfma_f32_16x16x32_bf16 a[76:79], v[240:243], v[152:155], a[76:79]
ds_read_b64_tr_b16 v[226:227], v20 offset:17408
v_lshlrev_b32 v97, 16, v60
v_mfma_f32_16x16x32_bf16 a[80:83], v[240:243], v[160:163], a[80:83]
v_fmac_f32 v96, v74, v85
v_fmac_f32 v96, v73, v86
v_mfma_f32_16x16x32_bf16 a[80:83], v[244:247], v[164:167], a[80:83]
ds_read_b64_tr_b16 v[228:229], v20 offset:24576
v_fmac_f32 v96, v72, v87
v_mfma_f32_16x16x32_bf16 a[84:87], v[244:247], v[172:175], a[84:87]
v_mul_f32 v96, v96, v97
v_cvt_pk_bf16_f32 v103, v95, v96
v_mfma_f32_16x16x32_bf16 a[84:87], v[240:243], v[168:171], a[84:87]
ds_read_b64_tr_b16 v[230:231], v20 offset:25600
ds_write_b128 v28, v[100:103] offset:0
v_mfma_f32_16x16x32_bf16 a[88:91], v[240:243], v[176:179], a[88:91]
v_mul_f32 v95, v75, v83
v_lshlrev_b32 v97, 16, v59
v_mfma_f32_16x16x32_bf16 a[88:91], v[244:247], v[180:183], a[88:91]
v_fmac_f32 v95, v74, v84
v_fmac_f32 v95, v73, v85
v_mfma_f32_16x16x32_bf16 a[92:95], v[244:247], v[188:191], a[92:95]
v_fmac_f32 v95, v72, v86
v_mul_f32 v95, v95, v97
v_mfma_f32_16x16x32_bf16 a[92:95], v[240:243], v[184:187], a[92:95]
s_waitcnt lgkmcnt(5)
v_mul_f32 v96, v75, v82
v_lshlrev_b32 v97, 16, v58
v_mfma_f32_16x16x32_bf16 a[124:127], v[248:251], v[184:187], a[124:127]
ds_read_b64_tr_b16 v[232:233], v21 offset:16384
v_fmac_f32 v96, v74, v83
v_mfma_f32_16x16x32_bf16 a[124:127], v[252:255], v[188:191], a[124:127]
v_fmac_f32 v96, v73, v84
v_fmac_f32 v96, v72, v85
v_mfma_f32_16x16x32_bf16 a[120:123], v[252:255], v[180:183], a[120:123]
v_mul_f32 v96, v96, v97
v_cvt_pk_bf16_f32 v104, v95, v96
v_mfma_f32_16x16x32_bf16 a[120:123], v[248:251], v[176:179], a[120:123]
ds_read_b64_tr_b16 v[234:235], v21 offset:17408
v_mul_f32 v95, v75, v81
v_mfma_f32_16x16x32_bf16 a[116:119], v[248:251], v[168:171], a[116:119]
v_lshlrev_b32 v97, 16, v57
v_fmac_f32 v95, v74, v82
v_mfma_f32_16x16x32_bf16 a[116:119], v[252:255], v[172:175], a[116:119]
v_fmac_f32 v95, v73, v83
v_fmac_f32 v95, v72, v84
v_mfma_f32_16x16x32_bf16 a[112:115], v[252:255], v[164:167], a[112:115]
v_mul_f32 v95, v95, v97
v_mul_f32 v96, v75, v80
v_mfma_f32_16x16x32_bf16 a[112:115], v[248:251], v[160:163], a[112:115]
ds_read_b64_tr_b16 v[236:237], v21 offset:24576
v_lshlrev_b32 v97, 16, v56
v_mfma_f32_16x16x32_bf16 a[108:111], v[248:251], v[152:155], a[108:111]
v_fmac_f32 v96, v74, v81
v_fmac_f32 v96, v73, v82
v_mfma_f32_16x16x32_bf16 a[108:111], v[252:255], v[156:159], a[108:111]
v_fmac_f32 v96, v72, v83
v_mul_f32 v96, v96, v97
v_mfma_f32_16x16x32_bf16 a[104:107], v[252:255], v[148:151], a[104:107]
ds_read_b64_tr_b16 v[238:239], v21 offset:25600
v_cvt_pk_bf16_f32 v105, v95, v96
v_mfma_f32_16x16x32_bf16 a[104:107], v[248:251], v[144:147], a[104:107]
v_mul_f32 v95, v75, v79
v_lshlrev_b32 v97, 16, v55
v_mfma_f32_16x16x32_bf16 a[100:103], v[248:251], v[136:139], a[100:103]
v_fmac_f32 v95, v74, v80
v_fmac_f32 v95, v73, v81
v_mfma_f32_16x16x32_bf16 a[100:103], v[252:255], v[140:143], a[100:103]
v_fmac_f32 v95, v72, v82
v_mul_f32 v95, v95, v97
v_mfma_f32_16x16x32_bf16 a[96:99], v[252:255], v[132:135], a[96:99]
v_mul_f32 v96, v75, v78
v_lshlrev_b32 v97, 16, v54
v_mfma_f32_16x16x32_bf16 a[96:99], v[248:251], v[128:131], a[96:99]
s_waitcnt lgkmcnt(5)
v_fmac_f32 v96, v74, v79
v_fmac_f32 v96, v73, v80
v_mfma_f32_16x16x32_bf16 a[128:131], v[128:131], v[224:227], a[128:131]
ds_read_b64_tr_b16 v[240:241], v22 offset:16384
v_fmac_f32 v96, v72, v81
v_mfma_f32_16x16x32_bf16 a[128:131], v[132:135], v[228:231], a[128:131]
v_mul_f32 v96, v96, v97
v_cvt_pk_bf16_f32 v106, v95, v96
v_mfma_f32_16x16x32_bf16 a[132:135], v[140:143], v[228:231], a[132:135]
v_mul_f32 v95, v75, v77
v_lshlrev_b32 v97, 16, v53
v_mfma_f32_16x16x32_bf16 a[132:135], v[136:139], v[224:227], a[132:135]
ds_read_b64_tr_b16 v[242:243], v22 offset:17408
v_fmac_f32 v95, v74, v78
v_mfma_f32_16x16x32_bf16 a[136:139], v[144:147], v[224:227], a[136:139]
v_fmac_f32 v95, v73, v79
v_fmac_f32 v95, v72, v80
v_mfma_f32_16x16x32_bf16 a[136:139], v[148:151], v[228:231], a[136:139]
v_mul_f32 v95, v95, v97
v_mul_f32 v96, v75, v76
v_mfma_f32_16x16x32_bf16 a[140:143], v[156:159], v[228:231], a[140:143]
v_lshlrev_b32 v97, 16, v52
v_fmac_f32 v96, v74, v77
v_mfma_f32_16x16x32_bf16 a[140:143], v[152:155], v[224:227], a[140:143]
ds_read_b64_tr_b16 v[244:245], v22 offset:24576
v_fmac_f32 v96, v73, v78
v_mfma_f32_16x16x32_bf16 a[144:147], v[160:163], v[224:227], a[144:147]
v_fmac_f32 v96, v72, v79
v_mul_f32 v96, v96, v97
v_mfma_f32_16x16x32_bf16 a[144:147], v[164:167], v[228:231], a[144:147]
v_cvt_pk_bf16_f32 v107, v95, v96
v_mfma_f32_16x16x32_bf16 a[148:151], v[172:175], v[228:231], a[148:151]
ds_read_b64_tr_b16 v[246:247], v22 offset:25600
ds_write_b128 v28, v[104:107] offset:16
v_mfma_f32_16x16x32_bf16 a[148:151], v[168:171], v[224:227], a[148:151]
global_load_dwordx4 v[84:87], v1, s[56:57]
v_mfma_f32_16x16x32_bf16 a[152:155], v[176:179], v[224:227], a[152:155]
global_load_dwordx4 v[88:91], v1, s[56:57] offset:1024
v_mfma_f32_16x16x32_bf16 a[152:155], v[180:183], v[228:231], a[152:155]
v_lshlrev_b32 v72, 16, v70
v_and_b32 v73, 0xffff0000, v70
v_mfma_f32_16x16x32_bf16 a[156:159], v[188:191], v[228:231], a[156:159]
v_lshlrev_b32 v74, 16, v71
v_and_b32 v75, 0xffff0000, v71
v_mfma_f32_16x16x32_bf16 a[156:159], v[184:187], v[224:227], a[156:159]
s_waitcnt lgkmcnt(5)
v_and_b32 v33, 0xffff0000, v33
v_and_b32 v34, 0xffff0000, v34
v_mfma_f32_16x16x32_bf16 a[188:191], v[184:187], v[232:235], a[188:191]
ds_read_b64_tr_b16 v[248:249], v23 offset:16384
v_and_b32 v35, 0xffff0000, v35
v_mfma_f32_16x16x32_bf16 a[188:191], v[188:191], v[236:239], a[188:191]
v_and_b32 v36, 0xffff0000, v36
v_and_b32 v37, 0xffff0000, v37
v_mfma_f32_16x16x32_bf16 a[184:187], v[180:183], v[236:239], a[184:187]
ds_read_b64_tr_b16 v[250:251], v23 offset:17408
v_and_b32 v38, 0xffff0000, v38
v_mfma_f32_16x16x32_bf16 a[184:187], v[176:179], v[232:235], a[184:187]
v_and_b32 v39, 0xffff0000, v39
v_and_b32 v40, 0xffff0000, v40
v_mfma_f32_16x16x32_bf16 a[180:183], v[168:171], v[232:235], a[180:183]
ds_read_b64_tr_b16 v[252:253], v23 offset:24576
v_and_b32 v41, 0xffff0000, v41
v_mfma_f32_16x16x32_bf16 a[180:183], v[172:175], v[236:239], a[180:183]
v_and_b32 v42, 0xffff0000, v42
v_and_b32 v43, 0xffff0000, v43
v_mfma_f32_16x16x32_bf16 a[176:179], v[164:167], v[236:239], a[176:179]
ds_read_b64_tr_b16 v[254:255], v23 offset:25600
v_and_b32 v44, 0xffff0000, v44
v_mfma_f32_16x16x32_bf16 a[176:179], v[160:163], v[232:235], a[176:179]
v_and_b32 v45, 0xffff0000, v45
v_and_b32 v46, 0xffff0000, v46
v_mfma_f32_16x16x32_bf16 a[172:175], v[152:155], v[232:235], a[172:175]
v_and_b32 v47, 0xffff0000, v47
v_and_b32 v48, 0xffff0000, v48
v_mfma_f32_16x16x32_bf16 a[172:175], v[156:159], v[236:239], a[172:175]
v_and_b32 v49, 0xffff0000, v49
v_and_b32 v50, 0xffff0000, v50
v_mfma_f32_16x16x32_bf16 a[168:171], v[148:151], v[236:239], a[168:171]
v_and_b32 v51, 0xffff0000, v51
v_mul_f32 v95, v75, v48
v_mfma_f32_16x16x32_bf16 a[168:171], v[144:147], v[232:235], a[168:171]
v_and_b32 v97, 0xffff0000, v67
v_fmac_f32 v95, v74, v49
v_mfma_f32_16x16x32_bf16 a[164:167], v[136:139], v[232:235], a[164:167]
v_fmac_f32 v95, v73, v50
v_fmac_f32 v95, v72, v51
v_mfma_f32_16x16x32_bf16 a[164:167], v[140:143], v[236:239], a[164:167]
v_mul_f32 v95, v95, v97
v_mul_f32 v96, v75, v47
v_mfma_f32_16x16x32_bf16 a[160:163], v[132:135], v[236:239], a[160:163]
s_waitcnt vmcnt(6) lgkmcnt(0)
v_and_b32 v97, 0xffff0000, v66
v_fmac_f32 v96, v74, v48
v_mfma_f32_16x16x32_bf16 a[160:163], v[128:131], v[232:235], a[160:163]
s_barrier
v_fmac_f32 v96, v73, v49
v_fmac_f32 v96, v72, v50
v_mfma_f32_16x16x32_bf16 a[192:195], v[128:131], v[240:243], a[192:195]
s_and_b32 s73, s65, 1
ds_read_b64_tr_b16 v[224:225], v20 offset:32768
v_mul_f32 v96, v96, v97
v_mfma_f32_16x16x32_bf16 a[192:195], v[132:135], v[244:247], a[192:195]
s_xor_b32 s73, s73, 6
ds_read_b64_tr_b16 v[226:227], v20 offset:33792
v_cvt_pk_bf16_f32 v100, v95, v96
v_mfma_f32_16x16x32_bf16 a[196:199], v[140:143], v[244:247], a[196:199]
s_lshl_b32 s69, s73, 7
ds_read_b64_tr_b16 v[228:229], v20 offset:40960
v_mul_f32 v95, v75, v46
v_mfma_f32_16x16x32_bf16 a[196:199], v[136:139], v[240:243], a[196:199]
s_add_u32 s69, s69, s84
ds_read_b64_tr_b16 v[230:231], v20 offset:41984
v_and_b32 v97, 0xffff0000, v65
v_mfma_f32_16x16x32_bf16 a[200:203], v[144:147], v[240:243], a[200:203]
s_lshl_b32 s71, s73, 19
ds_read_b128 v[192:195], v24 offset:32768
v_fmac_f32 v95, v74, v47
v_mfma_f32_16x16x32_bf16 a[200:203], v[148:151], v[244:247], a[200:203]
s_add_u32 s71, s71, s66
ds_read_b128 v[196:199], v25 offset:32768
v_fmac_f32 v95, v73, v48
v_mfma_f32_16x16x32_bf16 a[204:207], v[156:159], v[244:247], a[204:207]
s_add_u32 m0, s63, 65536
v_fmac_f32 v95, v72, v49
v_mul_f32 v95, v95, v97
v_mfma_f32_16x16x32_bf16 a[204:207], v[152:155], v[240:243], a[204:207]
s_add_u32 s72, s69, 0
buffer_load_dwordx4 v2, s[8:11], s72 offen lds
v_mfma_f32_16x16x32_bf16 a[208:211], v[160:163], v[240:243], a[208:211]
s_add_u32 s72, s69, 7168
buffer_load_dwordx4 v3, s[8:11], s72 offen offset:1024 lds
v_mfma_f32_16x16x32_bf16 a[208:211], v[164:167], v[244:247], a[208:211]
s_add_u32 s72, s69, 14336
buffer_load_dwordx4 v2, s[8:11], s72 offen offset:2048 lds
v_mfma_f32_16x16x32_bf16 a[212:215], v[172:175], v[244:247], a[212:215]
ds_read_b128 v[200:203], v24 offset:34816
v_mul_f32 v96, v75, v45
v_mfma_f32_16x16x32_bf16 a[212:215], v[168:171], v[240:243], a[212:215]
ds_read_b128 v[204:207], v25 offset:34816
v_and_b32 v97, 0xffff0000, v64
v_mfma_f32_16x16x32_bf16 a[216:219], v[176:179], v[240:243], a[216:219]
s_add_u32 s72, s69, 21504
buffer_load_dwordx4 v3, s[8:11], s72 offen offset:3072 lds
v_mfma_f32_16x16x32_bf16 a[216:219], v[180:183], v[244:247], a[216:219]
ds_read_b128 v[208:211], v24 offset:36864
v_fmac_f32 v96, v74, v46
v_mfma_f32_16x16x32_bf16 a[220:223], v[188:191], v[244:247], a[220:223]
ds_read_b128 v[212:215], v25 offset:36864
v_fmac_f32 v96, v73, v47
v_mfma_f32_16x16x32_bf16 a[220:223], v[184:187], v[240:243], a[220:223]
ds_read_b128 v[216:219], v24 offset:38912
v_fmac_f32 v96, v72, v48
v_mfma_f32_16x16x32_bf16 a[252:255], v[184:187], v[248:251], a[252:255]
ds_read_b128 v[220:223], v25 offset:38912
v_mul_f32 v96, v96, v97
v_mfma_f32_16x16x32_bf16 a[252:255], v[188:191], v[252:255], a[252:255]
s_add_u32 m0, s64, 0
v_cvt_pk_bf16_f32 v101, v95, v96
v_mul_f32 v95, v75, v44
v_mfma_f32_16x16x32_bf16 a[248:251], v[180:183], v[252:255], a[248:251]
s_add_u32 s72, s71, 0
buffer_load_dwordx4 v6, s[16:19], s72 offen lds
v_mfma_f32_16x16x32_bf16 a[248:251], v[176:179], v[248:251], a[248:251]
ds_read_b128 v[184:187], v24 offset:40960
v_and_b32 v97, 0xffff0000, v63
v_mfma_f32_16x16x32_bf16 a[244:247], v[168:171], v[248:251], a[244:247]
ds_read_b128 v[188:191], v25 offset:40960
v_fmac_f32 v95, v74, v45
v_mfma_f32_16x16x32_bf16 a[244:247], v[172:175], v[252:255], a[244:247]
s_add_u32 s72, s71, 31744
buffer_load_dwordx4 v6, s[16:19], s72 offen offset:1024 lds
v_mfma_f32_16x16x32_bf16 a[240:243], v[164:167], v[252:255], a[240:243]
ds_read_b128 v[176:179], v24 offset:43008
v_fmac_f32 v95, v73, v46
v_mfma_f32_16x16x32_bf16 a[240:243], v[160:163], v[248:251], a[240:243]
ds_read_b128 v[180:183], v25 offset:43008
v_fmac_f32 v95, v72, v47
v_mfma_f32_16x16x32_bf16 a[236:239], v[152:155], v[248:251], a[236:239]
ds_read_b128 v[168:171], v24 offset:45056
v_mul_f32 v95, v95, v97
v_mfma_f32_16x16x32_bf16 a[236:239], v[156:159], v[252:255], a[236:239]
s_add_u32 s72, s71, 63488
buffer_load_dwordx4 v7, s[16:19], s72 offen offset:2048 lds
v_mfma_f32_16x16x32_bf16 a[232:235], v[148:151], v[252:255], a[232:235]
ds_read_b128 v[172:175], v25 offset:45056
v_mul_f32 v96, v75, v43
v_mfma_f32_16x16x32_bf16 a[232:235], v[144:147], v[248:251], a[232:235]
ds_read_b128 v[160:163], v24 offset:47104
v_and_b32 v97, 0xffff0000, v62
v_mfma_f32_16x16x32_bf16 a[228:231], v[136:139], v[248:251], a[228:231]
ds_read_b128 v[164:167], v25 offset:47104
v_fmac_f32 v96, v74, v44
v_mfma_f32_16x16x32_bf16 a[228:231], v[140:143], v[252:255], a[228:231]
v_fmac_f32 v96, v73, v45
v_fmac_f32 v96, v72, v46
v_mfma_f32_16x16x32_bf16 a[224:227], v[132:135], v[252:255], a[224:227]
s_add_u32 s72, s71, 95232
buffer_load_dwordx4 v7, s[16:19], s72 offen offset:3072 lds
v_mfma_f32_16x16x32_bf16 a[224:227], v[128:131], v[248:251], a[224:227]
s_waitcnt lgkmcnt(8)
ds_read_b64_tr_b16 v[232:233], v21 offset:32768
v_mul_f32 v96, v96, v97
v_mfma_f32_16x16x32_bf16 a[0:3], v[224:227], v[192:195], a[0:3]
ds_read_b64_tr_b16 v[234:235], v21 offset:33792
v_cvt_pk_bf16_f32 v102, v95, v96
v_mfma_f32_16x16x32_bf16 a[0:3], v[228:231], v[196:199], a[0:3]
ds_read_b64_tr_b16 v[240:241], v22 offset:32768
v_mul_f32 v95, v75, v42
v_mfma_f32_16x16x32_bf16 a[4:7], v[228:231], v[204:207], a[4:7]
s_add_u32 m0, s63, 69632
ds_read_b64_tr_b16 v[236:237], v21 offset:40960
v_and_b32 v97, 0xffff0000, v61
v_mfma_f32_16x16x32_bf16 a[4:7], v[224:227], v[200:203], a[4:7]
s_add_u32 s72, s69, 32768
buffer_load_dwordx4 v2, s[8:11], s72 offen lds
v_mfma_f32_16x16x32_bf16 a[8:11], v[224:227], v[208:211], a[8:11]
ds_read_b64_tr_b16 v[238:239], v21 offset:41984
v_fmac_f32 v95, v74, v43
v_mfma_f32_16x16x32_bf16 a[8:11], v[228:231], v[212:215], a[8:11]
v_fmac_f32 v95, v73, v44
v_fmac_f32 v95, v72, v45
v_mfma_f32_16x16x32_bf16 a[12:15], v[228:231], v[220:223], a[12:15]
s_add_u32 s72, s69, 39936
buffer_load_dwordx4 v3, s[8:11], s72 offen offset:1024 lds
v_mfma_f32_16x16x32_bf16 a[12:15], v[224:227], v[216:219], a[12:15]
s_waitcnt lgkmcnt(5)
ds_read_b64_tr_b16 v[242:243], v22 offset:33792
v_mul_f32 v95, v95, v97
v_mfma_f32_16x16x32_bf16 a[16:19], v[224:227], v[184:187], a[16:19]
v_mul_f32 v96, v75, v41
v_and_b32 v97, 0xffff0000, v60
v_mfma_f32_16x16x32_bf16 a[16:19], v[228:231], v[188:191], a[16:19]
ds_read_b64_tr_b16 v[244:245], v22 offset:40960
v_fmac_f32 v96, v74, v42
v_mfma_f32_16x16x32_bf16 a[20:23], v[228:231], v[180:183], a[20:23]
v_fmac_f32 v96, v73, v43
v_fmac_f32 v96, v72, v44
v_mfma_f32_16x16x32_bf16 a[20:23], v[224:227], v[176:179], a[20:23]
s_add_u32 s72, s69, 47104
buffer_load_dwordx4 v2, s[8:11], s72 offen offset:2048 lds
v_mfma_f32_16x16x32_bf16 a[24:27], v[224:227], v[168:171], a[24:27]
ds_read_b64_tr_b16 v[246:247], v22 offset:41984
v_mul_f32 v96, v96, v97
v_mfma_f32_16x16x32_bf16 a[24:27], v[228:231], v[172:175], a[24:27]
v_cvt_pk_bf16_f32 v103, v95, v96
v_mfma_f32_16x16x32_bf16 a[28:31], v[228:231], v[164:167], a[28:31]
ds_write_b128 v28, v[100:103] offset:272
v_mul_f32 v95, v75, v40
v_mfma_f32_16x16x32_bf16 a[28:31], v[224:227], v[160:163], a[28:31]
s_waitcnt lgkmcnt(4)
v_and_b32 v97, 0xffff0000, v59
v_fmac_f32 v95, v74, v41
v_mfma_f32_16x16x32_bf16 a[60:63], v[232:235], v[160:163], a[60:63]
s_add_u32 s72, s69, 54272
buffer_load_dwordx4 v3, s[8:11], s72 offen offset:3072 lds
v_mfma_f32_16x16x32_bf16 a[60:63], v[236:239], v[164:167], a[60:63]
ds_read_b64_tr_b16 v[248:249], v23 offset:32768
v_fmac_f32 v95, v73, v42
v_mfma_f32_16x16x32_bf16 a[56:59], v[236:239], v[172:175], a[56:59]
v_fmac_f32 v95, v72, v43
v_mul_f32 v95, v95, v97
v_mfma_f32_16x16x32_bf16 a[56:59], v[232:235], v[168:171], a[56:59]
s_add_u32 m0, s64, 16384
ds_read_b64_tr_b16 v[250:251], v23 offset:33792
v_mul_f32 v96, v75, v39
v_mfma_f32_16x16x32_bf16 a[52:55], v[232:235], v[176:179], a[52:55]
s_add_u32 s72, s71, 0
buffer_load_dwordx4 v6, s[20:23], s72 offen lds
v_mfma_f32_16x16x32_bf16 a[52:55], v[236:239], v[180:183], a[52:55]
v_and_b32 v97, 0xffff0000, v58
v_fmac_f32 v96, v74, v40
v_mfma_f32_16x16x32_bf16 a[48:51], v[236:239], v[188:191], a[48:51]
v_fmac_f32 v96, v73, v41
v_fmac_f32 v96, v72, v42
v_mfma_f32_16x16x32_bf16 a[48:51], v[232:235], v[184:187], a[48:51]
ds_read_b64_tr_b16 v[252:253], v23 offset:40960
v_mul_f32 v96, v96, v97
v_mfma_f32_16x16x32_bf16 a[44:47], v[232:235], v[216:219], a[44:47]
s_add_u32 s72, s71, 31744
buffer_load_dwordx4 v6, s[20:23], s72 offen offset:1024 lds
v_mfma_f32_16x16x32_bf16 a[44:47], v[236:239], v[220:223], a[44:47]
v_cvt_pk_bf16_f32 v104, v95, v96
v_mul_f32 v95, v75, v38
v_mfma_f32_16x16x32_bf16 a[40:43], v[236:239], v[212:215], a[40:43]
ds_read_b64_tr_b16 v[254:255], v23 offset:41984
v_and_b32 v97, 0xffff0000, v57
v_mfma_f32_16x16x32_bf16 a[40:43], v[232:235], v[208:211], a[40:43]
v_fmac_f32 v95, v74, v39
v_fmac_f32 v95, v73, v40
v_mfma_f32_16x16x32_bf16 a[36:39], v[232:235], v[200:203], a[36:39]
s_add_u32 s72, s71, 63488
buffer_load_dwordx4 v7, s[20:23], s72 offen offset:2048 lds
v_mfma_f32_16x16x32_bf16 a[36:39], v[236:239], v[204:207], a[36:39]
v_fmac_f32 v95, v72, v41
v_mul_f32 v95, v95, v97
v_mfma_f32_16x16x32_bf16 a[32:35], v[236:239], v[196:199], a[32:35]
v_mul_f32 v96, v75, v37
v_and_b32 v97, 0xffff0000, v56
v_mfma_f32_16x16x32_bf16 a[32:35], v[232:235], v[192:195], a[32:35]
s_waitcnt lgkmcnt(5)
v_fmac_f32 v96, v74, v38
v_fmac_f32 v96, v73, v39
v_mfma_f32_16x16x32_bf16 a[64:67], v[240:243], v[192:195], a[64:67]
s_add_u32 s72, s71, 95232
buffer_load_dwordx4 v7, s[20:23], s72 offen offset:3072 lds
v_mfma_f32_16x16x32_bf16 a[64:67], v[244:247], v[196:199], a[64:67]
s_mov_b32 s80, 0x400000
buffer_load_dword v126, v125, s[12:15], s80 offen
v_mfma_f32_16x16x32_bf16 a[68:71], v[244:247], v[204:207], a[68:71]
s_mov_b32 s80, 0x500000
buffer_load_dword v126, v125, s[12:15], s80 offen
v_mfma_f32_16x16x32_bf16 a[68:71], v[240:243], v[200:203], a[68:71]
s_mov_b32 s80, 0x600000
buffer_load_dword v126, v125, s[12:15], s80 offen
v_mfma_f32_16x16x32_bf16 a[72:75], v[240:243], v[208:211], a[72:75]
s_mov_b32 s80, 0x700000
buffer_load_dword v126, v125, s[12:15], s80 offen
v_mfma_f32_16x16x32_bf16 a[72:75], v[244:247], v[212:215], a[72:75]
ds_read_b64_tr_b16 v[224:225], v20 offset:49152
v_fmac_f32 v96, v72, v40
v_mfma_f32_16x16x32_bf16 a[76:79], v[244:247], v[220:223], a[76:79]
v_mul_f32 v96, v96, v97
v_cvt_pk_bf16_f32 v105, v95, v96
v_mfma_f32_16x16x32_bf16 a[76:79], v[240:243], v[216:219], a[76:79]
ds_read_b64_tr_b16 v[226:227], v20 offset:50176
v_mul_f32 v95, v75, v36
v_mfma_f32_16x16x32_bf16 a[80:83], v[240:243], v[184:187], a[80:83]
v_and_b32 v97, 0xffff0000, v55
v_fmac_f32 v95, v74, v37
v_mfma_f32_16x16x32_bf16 a[80:83], v[244:247], v[188:191], a[80:83]
ds_read_b64_tr_b16 v[228:229], v20 offset:57344
v_fmac_f32 v95, v73, v38
v_mfma_f32_16x16x32_bf16 a[84:87], v[244:247], v[180:183], a[84:87]
v_fmac_f32 v95, v72, v39
v_mul_f32 v95, v95, v97
v_mfma_f32_16x16x32_bf16 a[84:87], v[240:243], v[176:179], a[84:87]
ds_read_b64_tr_b16 v[230:231], v20 offset:58368
v_mul_f32 v96, v75, v35
v_mfma_f32_16x16x32_bf16 a[88:91], v[240:243], v[168:171], a[88:91]
v_and_b32 v97, 0xffff0000, v54
v_fmac_f32 v96, v74, v36
v_mfma_f32_16x16x32_bf16 a[88:91], v[244:247], v[172:175], a[88:91]
v_fmac_f32 v96, v73, v37
v_fmac_f32 v96, v72, v38
v_mfma_f32_16x16x32_bf16 a[92:95], v[244:247], v[164:167], a[92:95]
v_mul_f32 v96, v96, v97
v_cvt_pk_bf16_f32 v106, v95, v96
v_mfma_f32_16x16x32_bf16 a[92:95], v[240:243], v[160:163], a[92:95]
s_waitcnt lgkmcnt(4)
v_mul_f32 v95, v75, v34
v_and_b32 v97, 0xffff0000, v53
v_mfma_f32_16x16x32_bf16 a[124:127], v[248:251], v[160:163], a[124:127]
ds_read_b64_tr_b16 v[232:233], v21 offset:49152
v_fmac_f32 v95, v74, v35
v_mfma_f32_16x16x32_bf16 a[124:127], v[252:255], v[164:167], a[124:127]
v_fmac_f32 v95, v73, v36
v_fmac_f32 v95, v72, v37
v_mfma_f32_16x16x32_bf16 a[120:123], v[252:255], v[172:175], a[120:123]
v_mul_f32 v95, v95, v97
v_mul_f32 v96, v75, v33
v_mfma_f32_16x16x32_bf16 a[120:123], v[248:251], v[168:171], a[120:123]
ds_read_b64_tr_b16 v[234:235], v21 offset:50176
v_and_b32 v97, 0xffff0000, v52
v_mfma_f32_16x16x32_bf16 a[116:119], v[248:251], v[176:179], a[116:119]
v_fmac_f32 v96, v74, v34
v_fmac_f32 v96, v73, v35
v_mfma_f32_16x16x32_bf16 a[116:119], v[252:255], v[180:183], a[116:119]
v_fmac_f32 v96, v72, v36
v_mul_f32 v96, v96, v97
v_mfma_f32_16x16x32_bf16 a[112:115], v[252:255], v[188:191], a[112:115]
v_cvt_pk_bf16_f32 v107, v95, v96
v_mfma_f32_16x16x32_bf16 a[112:115], v[248:251], v[184:187], a[112:115]
ds_read_b64_tr_b16 v[236:237], v21 offset:57344
ds_write_b128 v28, v[104:107] offset:288
v_mfma_f32_16x16x32_bf16 a[108:111], v[248:251], v[216:219], a[108:111]
v_mfma_f32_16x16x32_bf16 a[108:111], v[252:255], v[220:223], a[108:111]
v_mfma_f32_16x16x32_bf16 a[104:107], v[252:255], v[212:215], a[104:107]
ds_read_b64_tr_b16 v[238:239], v21 offset:58368
v_mfma_f32_16x16x32_bf16 a[104:107], v[248:251], v[208:211], a[104:107]
v_mfma_f32_16x16x32_bf16 a[100:103], v[248:251], v[200:203], a[100:103]
v_mfma_f32_16x16x32_bf16 a[100:103], v[252:255], v[204:207], a[100:103]
v_mfma_f32_16x16x32_bf16 a[96:99], v[252:255], v[196:199], a[96:99]
v_mfma_f32_16x16x32_bf16 a[96:99], v[248:251], v[192:195], a[96:99]
s_waitcnt lgkmcnt(5)
v_mfma_f32_16x16x32_bf16 a[128:131], v[192:195], v[224:227], a[128:131]
ds_read_b64_tr_b16 v[240:241], v22 offset:49152
v_mfma_f32_16x16x32_bf16 a[128:131], v[196:199], v[228:231], a[128:131]
v_mfma_f32_16x16x32_bf16 a[132:135], v[204:207], v[228:231], a[132:135]
v_mfma_f32_16x16x32_bf16 a[132:135], v[200:203], v[224:227], a[132:135]
ds_read_b64_tr_b16 v[242:243], v22 offset:50176
v_mfma_f32_16x16x32_bf16 a[136:139], v[208:211], v[224:227], a[136:139]
v_mfma_f32_16x16x32_bf16 a[136:139], v[212:215], v[228:231], a[136:139]
v_mfma_f32_16x16x32_bf16 a[140:143], v[220:223], v[228:231], a[140:143]
v_mfma_f32_16x16x32_bf16 a[140:143], v[216:219], v[224:227], a[140:143]
ds_read_b64_tr_b16 v[244:245], v22 offset:57344
v_mfma_f32_16x16x32_bf16 a[144:147], v[184:187], v[224:227], a[144:147]
v_mfma_f32_16x16x32_bf16 a[144:147], v[188:191], v[228:231], a[144:147]
v_mfma_f32_16x16x32_bf16 a[148:151], v[180:183], v[228:231], a[148:151]
ds_read_b64_tr_b16 v[246:247], v22 offset:58368
v_mfma_f32_16x16x32_bf16 a[148:151], v[176:179], v[224:227], a[148:151]
v_mfma_f32_16x16x32_bf16 a[152:155], v[168:171], v[224:227], a[152:155]
v_mfma_f32_16x16x32_bf16 a[152:155], v[172:175], v[228:231], a[152:155]
v_mfma_f32_16x16x32_bf16 a[156:159], v[164:167], v[228:231], a[156:159]
v_mfma_f32_16x16x32_bf16 a[156:159], v[160:163], v[224:227], a[156:159]
s_waitcnt lgkmcnt(4)
v_mfma_f32_16x16x32_bf16 a[188:191], v[160:163], v[232:235], a[188:191]
ds_read_b64_tr_b16 v[248:249], v23 offset:49152
v_mfma_f32_16x16x32_bf16 a[188:191], v[164:167], v[236:239], a[188:191]
v_mfma_f32_16x16x32_bf16 a[184:187], v[172:175], v[236:239], a[184:187]
ds_read_b64_tr_b16 v[250:251], v23 offset:50176
v_mfma_f32_16x16x32_bf16 a[184:187], v[168:171], v[232:235], a[184:187]
v_mfma_f32_16x16x32_bf16 a[180:183], v[176:179], v[232:235], a[180:183]
ds_read_b64_tr_b16 v[252:253], v23 offset:57344
v_mfma_f32_16x16x32_bf16 a[180:183], v[180:183], v[236:239], a[180:183]
v_mfma_f32_16x16x32_bf16 a[176:179], v[188:191], v[236:239], a[176:179]
ds_read_b64_tr_b16 v[254:255], v23 offset:58368
v_mfma_f32_16x16x32_bf16 a[176:179], v[184:187], v[232:235], a[176:179]
v_mfma_f32_16x16x32_bf16 a[172:175], v[216:219], v[232:235], a[172:175]
v_mfma_f32_16x16x32_bf16 a[172:175], v[220:223], v[236:239], a[172:175]
v_mfma_f32_16x16x32_bf16 a[168:171], v[212:215], v[236:239], a[168:171]
v_mfma_f32_16x16x32_bf16 a[168:171], v[208:211], v[232:235], a[168:171]
v_mfma_f32_16x16x32_bf16 a[164:167], v[200:203], v[232:235], a[164:167]
v_mfma_f32_16x16x32_bf16 a[164:167], v[204:207], v[236:239], a[164:167]
v_mfma_f32_16x16x32_bf16 a[160:163], v[196:199], v[236:239], a[160:163]
s_waitcnt vmcnt(4) lgkmcnt(0)
v_mfma_f32_16x16x32_bf16 a[160:163], v[192:195], v[232:235], a[160:163]
s_barrier
v_mfma_f32_16x16x32_bf16 a[192:195], v[192:195], v[240:243], a[192:195]
s_and_b32 s73, s65, 1
ds_read_b64_tr_b16 v[224:225], v20 offset:0
v_mfma_f32_16x16x32_bf16 a[192:195], v[196:199], v[244:247], a[192:195]
s_xor_b32 s73, s73, 7
ds_read_b64_tr_b16 v[226:227], v20 offset:1024
v_mfma_f32_16x16x32_bf16 a[196:199], v[204:207], v[244:247], a[196:199]
s_lshl_b32 s69, s73, 7
ds_read_b64_tr_b16 v[228:229], v20 offset:8192
v_mfma_f32_16x16x32_bf16 a[196:199], v[200:203], v[240:243], a[196:199]
s_add_u32 s69, s69, s84
ds_read_b64_tr_b16 v[230:231], v20 offset:9216
v_mfma_f32_16x16x32_bf16 a[200:203], v[208:211], v[240:243], a[200:203]
s_lshl_b32 s71, s73, 19
ds_read_b128 v[128:131], v24 offset:0
v_mfma_f32_16x16x32_bf16 a[200:203], v[212:215], v[244:247], a[200:203]
s_add_u32 s71, s71, s66
ds_read_b128 v[132:135], v25 offset:0
v_mfma_f32_16x16x32_bf16 a[204:207], v[220:223], v[244:247], a[204:207]
s_add_u32 m0, s63, 98304
v_mfma_f32_16x16x32_bf16 a[204:207], v[216:219], v[240:243], a[204:207]
s_add_u32 s72, s69, 0
buffer_load_dwordx4 v2, s[8:11], s72 offen lds
v_mfma_f32_16x16x32_bf16 a[208:211], v[184:187], v[240:243], a[208:211]
s_add_u32 s72, s69, 7168
buffer_load_dwordx4 v3, s[8:11], s72 offen offset:1024 lds
v_mfma_f32_16x16x32_bf16 a[208:211], v[188:191], v[244:247], a[208:211]
s_add_u32 s72, s69, 14336
buffer_load_dwordx4 v2, s[8:11], s72 offen offset:2048 lds
v_mfma_f32_16x16x32_bf16 a[212:215], v[180:183], v[244:247], a[212:215]
s_add_u32 s74, s63, 131072
ds_read_b128 v[136:139], v24 offset:2048
v_lshrrev_b32 v26, 4, v0
v_mfma_f32_16x16x32_bf16 a[212:215], v[176:179], v[240:243], a[212:215]
ds_read_b128 v[140:143], v25 offset:2048
v_and_b32 v27, 15, v0
v_mfma_f32_16x16x32_bf16 a[216:219], v[168:171], v[240:243], a[216:219]
s_add_u32 s72, s69, 21504
buffer_load_dwordx4 v3, s[8:11], s72 offen offset:3072 lds
v_mfma_f32_16x16x32_bf16 a[216:219], v[172:175], v[244:247], a[216:219]
ds_read_b128 v[144:147], v24 offset:4096
v_lshlrev_b32 v27, 4, v27
v_mfma_f32_16x16x32_bf16 a[220:223], v[164:167], v[244:247], a[220:223]
ds_read_b128 v[148:151], v25 offset:4096
v_mul_u32_u24 v28, 272, v26
v_mfma_f32_16x16x32_bf16 a[220:223], v[160:163], v[240:243], a[220:223]
ds_read_b128 v[152:155], v24 offset:6144
v_add3_u32 v28, v28, v27, s74
v_mfma_f32_16x16x32_bf16 a[252:255], v[160:163], v[248:251], a[252:255]
ds_read_b128 v[156:159], v25 offset:6144
v_lshl_add_u32 v26, v26, 12, v27
v_mfma_f32_16x16x32_bf16 a[252:255], v[164:167], v[252:255], a[252:255]
s_add_u32 m0, s64, 32768
ds_read_b128 v[36:39], v28 offset:0
ds_read_b128 v[40:43], v28 offset:1088
v_mfma_f32_16x16x32_bf16 a[248:251], v[172:175], v[252:255], a[248:251]
s_add_u32 s72, s71, 0
buffer_load_dwordx4 v6, s[16:19], s72 offen lds
v_mfma_f32_16x16x32_bf16 a[248:251], v[168:171], v[248:251], a[248:251]
ds_read_b128 v[160:163], v24 offset:8192
ds_read_b128 v[44:47], v28 offset:2176
v_mfma_f32_16x16x32_bf16 a[244:247], v[176:179], v[248:251], a[244:247]
ds_read_b128 v[164:167], v25 offset:8192
ds_read_b128 v[48:51], v28 offset:3264
v_mfma_f32_16x16x32_bf16 a[244:247], v[180:183], v[252:255], a[244:247]
s_add_u32 s72, s71, 31744
buffer_load_dwordx4 v6, s[16:19], s72 offen offset:1024 lds
v_mfma_f32_16x16x32_bf16 a[240:243], v[188:191], v[252:255], a[240:243]
s_xor_b32 s74, s2, 5
ds_read_b128 v[168:171], v24 offset:10240
v_mfma_f32_16x16x32_bf16 a[240:243], v[184:187], v[248:251], a[240:243]
s_and_b32 s74, s74, 15
ds_read_b128 v[172:175], v25 offset:10240
v_mfma_f32_16x16x32_bf16 a[236:239], v[216:219], v[248:251], a[236:239]
s_lshl_b32 s74, s74, 2
ds_read_b128 v[176:179], v24 offset:12288
v_mfma_f32_16x16x32_bf16 a[236:239], v[220:223], v[252:255], a[236:239]
s_add_u32 s72, s71, 63488
buffer_load_dwordx4 v7, s[16:19], s72 offen offset:2048 lds
v_mfma_f32_16x16x32_bf16 a[232:235], v[212:215], v[252:255], a[232:235]
s_add_u32 s74, s74, s58
ds_read_b128 v[180:183], v25 offset:12288
v_mfma_f32_16x16x32_bf16 a[232:235], v[208:211], v[248:251], a[232:235]
s_lshl_b32 s74, s74, 16
ds_read_b128 v[184:187], v24 offset:14336
v_mfma_f32_16x16x32_bf16 a[228:231], v[200:203], v[248:251], a[228:231]
s_lshr_b32 s75, s2, 4
ds_read_b128 v[188:191], v25 offset:14336
v_mfma_f32_16x16x32_bf16 a[228:231], v[204:207], v[252:255], a[228:231]
s_lshl_b32 s75, s75, 8
v_mfma_f32_16x16x32_bf16 a[224:227], v[196:199], v[252:255], a[224:227]
s_add_u32 s72, s71, 95232
buffer_load_dwordx4 v7, s[16:19], s72 offen offset:3072 lds
v_mfma_f32_16x16x32_bf16 a[224:227], v[192:195], v[248:251], a[224:227]
s_waitcnt lgkmcnt(12)
ds_read_b64_tr_b16 v[232:233], v21 offset:0
v_mfma_f32_16x16x32_bf16 a[0:3], v[224:227], v[128:131], a[0:3]
s_sub_u32 s74, s74, s75
ds_read_b64_tr_b16 v[234:235], v21 offset:1024
v_mfma_f32_16x16x32_bf16 a[0:3], v[228:231], v[132:135], a[0:3]
s_add_u32 s74, s74, 0x3000f00
ds_read_b64_tr_b16 v[240:241], v22 offset:0
v_mfma_f32_16x16x32_bf16 a[4:7], v[228:231], v[140:143], a[4:7]
s_add_u32 m0, s63, 102400
ds_read_b64_tr_b16 v[236:237], v21 offset:8192
v_mfma_f32_16x16x32_bf16 a[4:7], v[224:227], v[136:139], a[4:7]
s_add_u32 s72, s69, 32768
buffer_load_dwordx4 v2, s[8:11], s72 offen lds
v_mfma_f32_16x16x32_bf16 a[8:11], v[224:227], v[144:147], a[8:11]
s_waitcnt vmcnt(29)
ds_read_b64_tr_b16 v[238:239], v21 offset:9216
v_lshlrev_b32 v78, 16, v84
v_mfma_f32_16x16x32_bf16 a[8:11], v[228:231], v[148:151], a[8:11]
v_lshlrev_b32 v79, 16, v108
v_mul_f32 v76, v78, v79
v_mfma_f32_16x16x32_bf16 a[12:15], v[228:231], v[156:159], a[12:15]
s_add_u32 s72, s69, 39936
buffer_load_dwordx4 v3, s[8:11], s72 offen offset:1024 lds
v_mfma_f32_16x16x32_bf16 a[12:15], v[224:227], v[152:155], a[12:15]
s_waitcnt lgkmcnt(5)
ds_read_b64_tr_b16 v[242:243], v22 offset:1024
v_lshlrev_b32 v80, 16, v116
v_mfma_f32_16x16x32_bf16 a[16:19], v[224:227], v[160:163], a[16:19]
v_mul_f32 v77, v78, v80
v_and_b32 v78, 0xffff0000, v84
v_mfma_f32_16x16x32_bf16 a[16:19], v[228:231], v[164:167], a[16:19]
ds_read_b64_tr_b16 v[244:245], v22 offset:8192
v_and_b32 v79, 0xffff0000, v108
v_mfma_f32_16x16x32_bf16 a[20:23], v[228:231], v[172:175], a[20:23]
v_fmac_f32 v76, v78, v79
v_and_b32 v80, 0xffff0000, v116
v_mfma_f32_16x16x32_bf16 a[20:23], v[224:227], v[168:171], a[20:23]
s_add_u32 s72, s69, 47104
buffer_load_dwordx4 v2, s[8:11], s72 offen offset:2048 lds
v_mfma_f32_16x16x32_bf16 a[24:27], v[224:227], v[176:179], a[24:27]
ds_read_b64_tr_b16 v[246:247], v22 offset:9216
v_fmac_f32 v77, v78, v80
v_mfma_f32_16x16x32_bf16 a[24:27], v[228:231], v[180:183], a[24:27]
v_lshlrev_b32 v78, 16, v85
v_lshlrev_b32 v79, 16, v109
v_mfma_f32_16x16x32_bf16 a[28:31], v[228:231], v[188:191], a[28:31]
v_fmac_f32 v76, v78, v79
v_lshlrev_b32 v80, 16, v117
v_mfma_f32_16x16x32_bf16 a[28:31], v[224:227], v[184:187], a[28:31]
s_waitcnt lgkmcnt(3)
v_fmac_f32 v77, v78, v80
v_and_b32 v78, 0xffff0000, v85
v_mfma_f32_16x16x32_bf16 a[60:63], v[232:235], v[184:187], a[60:63]
s_add_u32 s72, s69, 54272
buffer_load_dwordx4 v3, s[8:11], s72 offen offset:3072 lds
v_mfma_f32_16x16x32_bf16 a[60:63], v[236:239], v[188:191], a[60:63]
ds_read_b64_tr_b16 v[248:249], v23 offset:0
v_and_b32 v79, 0xffff0000, v109
v_mfma_f32_16x16x32_bf16 a[56:59], v[236:239], v[180:183], a[56:59]
v_fmac_f32 v76, v78, v79
v_and_b32 v80, 0xffff0000, v117
v_mfma_f32_16x16x32_bf16 a[56:59], v[232:235], v[176:179], a[56:59]
s_add_u32 m0, s64, 49152
ds_read_b64_tr_b16 v[250:251], v23 offset:1024
v_fmac_f32 v77, v78, v80
v_mfma_f32_16x16x32_bf16 a[52:55], v[232:235], v[168:171], a[52:55]
s_add_u32 s72, s71, 0
buffer_load_dwordx4 v6, s[20:23], s72 offen lds
v_mfma_f32_16x16x32_bf16 a[52:55], v[236:239], v[172:175], a[52:55]
v_lshlrev_b32 v78, 16, v86
v_lshlrev_b32 v79, 16, v110
v_mfma_f32_16x16x32_bf16 a[48:51], v[236:239], v[164:167], a[48:51]
v_fmac_f32 v76, v78, v79
v_lshlrev_b32 v80, 16, v118
v_mfma_f32_16x16x32_bf16 a[48:51], v[232:235], v[160:163], a[48:51]
ds_read_b64_tr_b16 v[252:253], v23 offset:8192
v_fmac_f32 v77, v78, v80
v_mfma_f32_16x16x32_bf16 a[44:47], v[232:235], v[152:155], a[44:47]
s_add_u32 s72, s71, 31744
buffer_load_dwordx4 v6, s[20:23], s72 offen offset:1024 lds
v_mfma_f32_16x16x32_bf16 a[44:47], v[236:239], v[156:159], a[44:47]
v_and_b32 v78, 0xffff0000, v86
v_and_b32 v79, 0xffff0000, v110
v_mfma_f32_16x16x32_bf16 a[40:43], v[236:239], v[148:151], a[40:43]
ds_read_b64_tr_b16 v[254:255], v23 offset:9216
v_fmac_f32 v76, v78, v79
v_mfma_f32_16x16x32_bf16 a[40:43], v[232:235], v[144:147], a[40:43]
v_and_b32 v80, 0xffff0000, v118
v_fmac_f32 v77, v78, v80
v_mfma_f32_16x16x32_bf16 a[36:39], v[232:235], v[136:139], a[36:39]
s_add_u32 s72, s71, 63488
buffer_load_dwordx4 v7, s[20:23], s72 offen offset:2048 lds
v_mfma_f32_16x16x32_bf16 a[36:39], v[236:239], v[140:143], a[36:39]
v_lshlrev_b32 v78, 16, v87
v_lshlrev_b32 v79, 16, v111
v_mfma_f32_16x16x32_bf16 a[32:35], v[236:239], v[132:135], a[32:35]
v_fmac_f32 v76, v78, v79
v_lshlrev_b32 v80, 16, v119
v_mfma_f32_16x16x32_bf16 a[32:35], v[232:235], v[128:131], a[32:35]
s_waitcnt lgkmcnt(4)
v_fmac_f32 v77, v78, v80
v_and_b32 v78, 0xffff0000, v87
v_mfma_f32_16x16x32_bf16 a[64:67], v[240:243], v[128:131], a[64:67]
s_add_u32 s72, s71, 95232
buffer_load_dwordx4 v7, s[20:23], s72 offen offset:3072 lds
v_mfma_f32_16x16x32_bf16 a[64:67], v[244:247], v[132:135], a[64:67]
s_waitcnt lgkmcnt(15)
ds_read_b64_tr_b16 v[224:225], v20 offset:16384
v_and_b32 v79, 0xffff0000, v111
v_mfma_f32_16x16x32_bf16 a[68:71], v[244:247], v[140:143], a[68:71]
s_add_u32 s73, s62, 0
v_fmac_f32 v76, v78, v79
v_and_b32 v80, 0xffff0000, v119
v_mfma_f32_16x16x32_bf16 a[68:71], v[240:243], v[136:139], a[68:71]
s_add_u32 s70, s73, s65
ds_read_b64_tr_b16 v[226:227], v20 offset:17408
v_fmac_f32 v77, v78, v80
v_mfma_f32_16x16x32_bf16 a[72:75], v[240:243], v[144:147], a[72:75]
s_and_b32 s70, s70, 3
v_lshlrev_b32 v78, 16, v88
v_lshlrev_b32 v79, 16, v112
v_mfma_f32_16x16x32_bf16 a[72:75], v[244:247], v[148:151], a[72:75]
s_and_b32 s73, s73, 12
v_fmac_f32 v76, v78, v79
v_lshlrev_b32 v80, 16, v120
v_mfma_f32_16x16x32_bf16 a[76:79], v[244:247], v[156:159], a[76:79]
s_or_b32 s73, s73, s70
ds_read_b64_tr_b16 v[228:229], v20 offset:24576
v_fmac_f32 v77, v78, v80
v_mfma_f32_16x16x32_bf16 a[76:79], v[240:243], v[152:155], a[76:79]
s_lshl_b32 s73, s73, 7
v_and_b32 v78, 0xffff0000, v88
v_and_b32 v79, 0xffff0000, v112
v_mfma_f32_16x16x32_bf16 a[80:83], v[240:243], v[160:163], a[80:83]
s_add_u32 s69, s73, s67
ds_read_b64_tr_b16 v[230:231], v20 offset:25600
v_fmac_f32 v76, v78, v79
v_mfma_f32_16x16x32_bf16 a[80:83], v[244:247], v[164:167], a[80:83]
s_add_u32 s70, s73, s68
v_and_b32 v80, 0xffff0000, v120
v_fmac_f32 v77, v78, v80
v_mfma_f32_16x16x32_bf16 a[84:87], v[244:247], v[172:175], a[84:87]
s_add_u32 m0, s63, 131072
v_lshlrev_b32 v78, 16, v89
v_lshlrev_b32 v79, 16, v113
v_mfma_f32_16x16x32_bf16 a[84:87], v[240:243], v[168:171], a[84:87]
s_add_u32 s72, s69, 0
buffer_load_dwordx4 v4, s[4:7], s72 offen lds
v_mfma_f32_16x16x32_bf16 a[88:91], v[240:243], v[176:179], a[88:91]
s_add_u32 s72, s69, 15360
buffer_load_dwordx4 v5, s[4:7], s72 offen offset:1024 lds
v_mfma_f32_16x16x32_bf16 a[88:91], v[244:247], v[180:183], a[88:91]
s_add_u32 s72, s69, 129024
buffer_load_dwordx4 v4, s[4:7], s72 offen offset:2048 lds
v_mfma_f32_16x16x32_bf16 a[92:95], v[244:247], v[188:191], a[92:95]
s_add_u32 s72, s69, 144384
buffer_load_dwordx4 v5, s[4:7], s72 offen offset:3072 lds
v_mfma_f32_16x16x32_bf16 a[92:95], v[240:243], v[184:187], a[92:95]
s_waitcnt lgkmcnt(4)
v_fmac_f32 v76, v78, v79
v_lshlrev_b32 v80, 16, v121
v_mfma_f32_16x16x32_bf16 a[124:127], v[248:251], v[184:187], a[124:127]
ds_read_b64_tr_b16 v[232:233], v21 offset:16384
v_fmac_f32 v77, v78, v80
v_mfma_f32_16x16x32_bf16 a[124:127], v[252:255], v[188:191], a[124:127]
v_and_b32 v78, 0xffff0000, v89
v_and_b32 v79, 0xffff0000, v113
v_mfma_f32_16x16x32_bf16 a[120:123], v[252:255], v[180:183], a[120:123]
ds_read_b64_tr_b16 v[234:235], v21 offset:17408
v_fmac_f32 v76, v78, v79
v_mfma_f32_16x16x32_bf16 a[120:123], v[248:251], v[176:179], a[120:123]
s_add_u32 m0, s63, 135168
v_and_b32 v80, 0xffff0000, v121
v_fmac_f32 v77, v78, v80
v_mfma_f32_16x16x32_bf16 a[116:119], v[248:251], v[168:171], a[116:119]
s_add_u32 s72, s70, 0
buffer_load_dwordx4 v4, s[4:7], s72 offen lds
v_mfma_f32_16x16x32_bf16 a[116:119], v[252:255], v[172:175], a[116:119]
s_lshr_b32 s75, s93, 5
ds_read_b64_tr_b16 v[236:237], v21 offset:24576
v_lshlrev_b32 v78, 16, v90
v_mfma_f32_16x16x32_bf16 a[112:115], v[252:255], v[164:167], a[112:115]
s_and_b32 s75, s75, 0x3f80
v_lshlrev_b32 v79, 16, v114
v_fmac_f32 v76, v78, v79
v_mfma_f32_16x16x32_bf16 a[112:115], v[248:251], v[160:163], a[112:115]
s_add_u32 s75, s75, LcB0-Lpc0
v_lshrrev_b32 v2, 6, v0
v_lshlrev_b32 v2, 7, v2
v_mfma_f32_16x16x32_bf16 a[108:111], v[248:251], v[152:155], a[108:111]
s_add_u32 s72, s70, 15360
buffer_load_dwordx4 v5, s[4:7], s72 offen offset:1024 lds
v_mfma_f32_16x16x32_bf16 a[108:111], v[252:255], v[156:159], a[108:111]
v_add_u32 v2, s75, v2
v_min_u32 v2, Lcode_end-Lpc0, v2
v_mfma_f32_16x16x32_bf16 a[104:107], v[252:255], v[148:151], a[104:107]
global_load_dword v3, v2, s[98:99]
v_mfma_f32_16x16x32_bf16 a[104:107], v[248:251], v[144:147], a[104:107]
ds_read_b64_tr_b16 v[238:239], v21 offset:25600
v_lshlrev_b32 v80, 16, v122
v_mfma_f32_16x16x32_bf16 a[100:103], v[248:251], v[136:139], a[100:103]
s_add_u32 s72, s70, 129024
buffer_load_dwordx4 v4, s[4:7], s72 offen offset:2048 lds
v_mfma_f32_16x16x32_bf16 a[100:103], v[252:255], v[140:143], a[100:103]
v_fmac_f32 v77, v78, v80
v_and_b32 v78, 0xffff0000, v90
v_mfma_f32_16x16x32_bf16 a[96:99], v[252:255], v[132:135], a[96:99]
v_and_b32 v79, 0xffff0000, v114
v_fmac_f32 v76, v78, v79
v_mfma_f32_16x16x32_bf16 a[96:99], v[248:251], v[128:131], a[96:99]
s_waitcnt lgkmcnt(4)
v_and_b32 v80, 0xffff0000, v122
v_fmac_f32 v77, v78, v80
v_mfma_f32_16x16x32_bf16 a[128:131], v[128:131], v[224:227], a[128:131]
ds_read_b64_tr_b16 v[240:241], v22 offset:16384
v_lshlrev_b32 v78, 16, v91
v_mfma_f32_16x16x32_bf16 a[128:131], v[132:135], v[228:231], a[128:131]
s_add_u32 s72, s70, 144384
buffer_load_dwordx4 v5, s[4:7], s72 offen offset:3072 lds
v_mfma_f32_16x16x32_bf16 a[132:135], v[140:143], v[228:231], a[132:135]
v_lshlrev_b32 v79, 16, v115
v_fmac_f32 v76, v78, v79
v_mfma_f32_16x16x32_bf16 a[132:135], v[136:139], v[224:227], a[132:135]
v_lshlrev_b32 v80, 16, v123
v_fmac_f32 v77, v78, v80
v_mfma_f32_16x16x32_bf16 a[136:139], v[144:147], v[224:227], a[136:139]
ds_read_b64_tr_b16 v[242:243], v22 offset:17408
v_and_b32 v78, 0xffff0000, v91
v_mfma_f32_16x16x32_bf16 a[136:139], v[148:151], v[228:231], a[136:139]
v_and_b32 v79, 0xffff0000, v115
v_fmac_f32 v76, v78, v79
v_mfma_f32_16x16x32_bf16 a[140:143], v[156:159], v[228:231], a[140:143]
v_and_b32 v80, 0xffff0000, v123
v_fmac_f32 v77, v78, v80
v_mfma_f32_16x16x32_bf16 a[140:143], v[152:155], v[224:227], a[140:143]
ds_read_b64_tr_b16 v[244:245], v22 offset:24576
v_add_f32_dpp v76, v76, v76 row_ror:8 row_mask:0xf bank_mask:0xf
v_mfma_f32_16x16x32_bf16 a[144:147], v[160:163], v[224:227], a[144:147]
v_add_f32_dpp v77, v77, v77 row_ror:8 row_mask:0xf bank_mask:0xf
v_add_f32_dpp v76, v76, v76 row_ror:4 row_mask:0xf bank_mask:0xf
v_mfma_f32_16x16x32_bf16 a[144:147], v[164:167], v[228:231], a[144:147]
v_add_f32_dpp v77, v77, v77 row_ror:4 row_mask:0xf bank_mask:0xf
v_add_f32_dpp v76, v76, v76 row_ror:2 row_mask:0xf bank_mask:0xf
v_mfma_f32_16x16x32_bf16 a[148:151], v[172:175], v[228:231], a[148:151]
ds_read_b64_tr_b16 v[246:247], v22 offset:25600
v_add_f32_dpp v77, v77, v77 row_ror:2 row_mask:0xf bank_mask:0xf
v_mfma_f32_16x16x32_bf16 a[148:151], v[168:171], v[224:227], a[148:151]
v_add_f32_dpp v76, v76, v76 row_ror:1 row_mask:0xf bank_mask:0xf
v_add_f32_dpp v77, v77, v77 row_ror:1 row_mask:0xf bank_mask:0xf
v_mfma_f32_16x16x32_bf16 a[152:155], v[176:179], v[224:227], a[152:155]
v_mov_b32 v78, v76
v_mov_b32 v79, v77
v_mfma_f32_16x16x32_bf16 a[152:155], v[180:183], v[228:231], a[152:155]
v_permlane16_swap_b32 v76, v78
v_permlane16_swap_b32 v77, v79
v_mfma_f32_16x16x32_bf16 a[156:159], v[188:191], v[228:231], a[156:159]
v_add_f32 v76, v76, v78
v_add_f32 v77, v77, v79
v_mfma_f32_16x16x32_bf16 a[156:159], v[184:187], v[224:227], a[156:159]
s_waitcnt lgkmcnt(4)
v_mov_b32 v78, v76
v_mov_b32 v79, v77
v_mfma_f32_16x16x32_bf16 a[188:191], v[184:187], v[232:235], a[188:191]
ds_read_b64_tr_b16 v[248:249], v23 offset:16384
v_permlane32_swap_b32 v76, v78
v_mfma_f32_16x16x32_bf16 a[188:191], v[188:191], v[236:239], a[188:191]
v_permlane32_swap_b32 v77, v79
v_add_f32 v76, v76, v78
v_mfma_f32_16x16x32_bf16 a[184:187], v[180:183], v[236:239], a[184:187]
ds_read_b64_tr_b16 v[250:251], v23 offset:17408
v_add_f32 v77, v77, v79
v_mfma_f32_16x16x32_bf16 a[184:187], v[176:179], v[232:235], a[184:187]
v_mul_f32 v76, 0xbfb8aa3b, v76
v_mul_f32 v77, 0xbfb8aa3b, v77
v_mfma_f32_16x16x32_bf16 a[180:183], v[168:171], v[232:235], a[180:183]
ds_read_b64_tr_b16 v[252:253], v23 offset:24576
v_mfma_f32_16x16x32_bf16 a[180:183], v[172:175], v[236:239], a[180:183]
v_exp_f32 v76, v76
v_mfma_f32_16x16x32_bf16 a[176:179], v[164:167], v[236:239], a[176:179]
ds_read_b64_tr_b16 v[254:255], v23 offset:25600
v_mfma_f32_16x16x32_bf16 a[176:179], v[160:163], v[232:235], a[176:179]
v_exp_f32 v77, v77
v_mfma_f32_16x16x32_bf16 a[172:175], v[152:155], v[232:235], a[172:175]
v_add_f32 v76, 1.0, v76
v_add_f32 v77, 1.0, v77
v_mfma_f32_16x16x32_bf16 a[172:175], v[156:159], v[236:239], a[172:175]
v_rcp_f32 v76, v76
v_mfma_f32_16x16x32_bf16 a[168:171], v[148:151], v[236:239], a[168:171]
v_rcp_f32 v77, v77
v_mfma_f32_16x16x32_bf16 a[168:171], v[144:147], v[232:235], a[168:171]
s_lshr_b32 s80, s76, 9
v_mfma_f32_16x16x32_bf16 a[164:167], v[136:139], v[232:235], a[164:167]
s_add_u32 s80, s80, 0x3800000
v_min_u32 v78, 1, v0
v_lshlrev_b32 v78, 30, v78
v_mfma_f32_16x16x32_bf16 a[164:167], v[140:143], v[236:239], a[164:167]
buffer_store_dwordx2 v[76:77], v78, s[44:47], s80 offen sc1
v_mfma_f32_16x16x32_bf16 a[160:163], v[132:135], v[236:239], a[160:163]
s_waitcnt vmcnt(10) lgkmcnt(0)
v_mfma_f32_16x16x32_bf16 a[160:163], v[128:131], v[232:235], a[160:163]
s_barrier
v_mfma_f32_16x16x32_bf16 a[192:195], v[128:131], v[240:243], a[192:195]
s_lshl_b32 s71, s73, 12
ds_read_b64_tr_b16 v[224:225], v20 offset:32768
v_mfma_f32_16x16x32_bf16 a[192:195], v[132:135], v[244:247], a[192:195]
s_add_u32 s71, s71, s66
ds_read_b64_tr_b16 v[226:227], v20 offset:33792
v_mfma_f32_16x16x32_bf16 a[196:199], v[140:143], v[244:247], a[196:199]
s_add_u32 m0, s64, 0
v_mov_b32 v100, v20
v_mov_b32 v101, v21
v_mfma_f32_16x16x32_bf16 a[196:199], v[136:139], v[240:243], a[196:199]
s_add_u32 s72, s71, 0
buffer_load_dwordx4 v6, s[12:15], s72 offen lds
v_mfma_f32_16x16x32_bf16 a[200:203], v[144:147], v[240:243], a[200:203]
v_mov_b32 v102, v22
v_mov_b32 v103, v23
v_mfma_f32_16x16x32_bf16 a[200:203], v[148:151], v[244:247], a[200:203]
ds_read_b64_tr_b16 v[228:229], v20 offset:40960
v_mfma_f32_16x16x32_bf16 a[204:207], v[156:159], v[244:247], a[204:207]
s_add_u32 s72, s71, 31744
buffer_load_dwordx4 v6, s[12:15], s72 offen offset:1024 lds
v_mfma_f32_16x16x32_bf16 a[204:207], v[152:155], v[240:243], a[204:207]
ds_read_b64_tr_b16 v[230:231], v20 offset:41984
v_mfma_f32_16x16x32_bf16 a[208:211], v[160:163], v[240:243], a[208:211]
s_waitcnt lgkmcnt(15)
buffer_store_dwordx4 v[36:39], v26, s[44:47], s74 offen sc1
v_mfma_f32_16x16x32_bf16 a[208:211], v[164:167], v[244:247], a[208:211]
ds_read_b128 v[192:195], v24 offset:32768
v_mfma_f32_16x16x32_bf16 a[212:215], v[172:175], v[244:247], a[212:215]
ds_read_b128 v[196:199], v25 offset:32768
v_mfma_f32_16x16x32_bf16 a[212:215], v[168:171], v[240:243], a[212:215]
ds_read_b128 v[200:203], v24 offset:34816
v_mfma_f32_16x16x32_bf16 a[216:219], v[176:179], v[240:243], a[216:219]
s_add_u32 s72, s71, 63488
buffer_load_dwordx4 v7, s[12:15], s72 offen offset:2048 lds
v_mfma_f32_16x16x32_bf16 a[216:219], v[180:183], v[244:247], a[216:219]
ds_read_b128 v[204:207], v25 offset:34816
v_mfma_f32_16x16x32_bf16 a[220:223], v[188:191], v[244:247], a[220:223]
ds_read_b128 v[208:211], v24 offset:36864
v_mfma_f32_16x16x32_bf16 a[220:223], v[184:187], v[240:243], a[220:223]
ds_read_b128 v[212:215], v25 offset:36864
v_mfma_f32_16x16x32_bf16 a[252:255], v[184:187], v[248:251], a[252:255]
ds_read_b128 v[216:219], v24 offset:38912
v_mfma_f32_16x16x32_bf16 a[252:255], v[188:191], v[252:255], a[252:255]
ds_read_b128 v[220:223], v25 offset:38912
v_mfma_f32_16x16x32_bf16 a[248:251], v[180:183], v[252:255], a[248:251]
s_add_u32 s72, s71, 95232
buffer_load_dwordx4 v7, s[12:15], s72 offen offset:3072 lds
v_mfma_f32_16x16x32_bf16 a[248:251], v[176:179], v[248:251], a[248:251]
ds_read_b128 v[184:187], v24 offset:40960
v_mfma_f32_16x16x32_bf16 a[244:247], v[168:171], v[248:251], a[244:247]
ds_read_b128 v[188:191], v25 offset:40960
v_mfma_f32_16x16x32_bf16 a[244:247], v[172:175], v[252:255], a[244:247]
ds_read_b128 v[176:179], v24 offset:43008
v_mfma_f32_16x16x32_bf16 a[240:243], v[164:167], v[252:255], a[240:243]
ds_read_b128 v[180:183], v25 offset:43008
v_mfma_f32_16x16x32_bf16 a[240:243], v[160:163], v[248:251], a[240:243]
v_mfma_f32_16x16x32_bf16 a[236:239], v[152:155], v[248:251], a[236:239]
s_add_u32 s74, s74, 0x4000
buffer_store_dwordx4 v[40:43], v26, s[44:47], s74 offen sc1
v_mfma_f32_16x16x32_bf16 a[236:239], v[156:159], v[252:255], a[236:239]
s_add_u32 s73, s62, 1
ds_read_b128 v[168:171], v24 offset:45056
v_mfma_f32_16x16x32_bf16 a[232:235], v[148:151], v[252:255], a[232:235]
s_add_u32 s70, s73, s65
ds_read_b128 v[172:175], v25 offset:45056
v_mfma_f32_16x16x32_bf16 a[232:235], v[144:147], v[248:251], a[232:235]
s_and_b32 s70, s70, 3
ds_read_b128 v[160:163], v24 offset:47104
v_mfma_f32_16x16x32_bf16 a[228:231], v[136:139], v[248:251], a[228:231]
s_and_b32 s73, s73, 12
ds_read_b128 v[164:167], v25 offset:47104
v_mfma_f32_16x16x32_bf16 a[228:231], v[140:143], v[252:255], a[228:231]
s_or_b32 s73, s73, s70
v_mfma_f32_16x16x32_bf16 a[224:227], v[132:135], v[252:255], a[224:227]
s_lshl_b32 s73, s73, 7
ds_read_b64_tr_b16 v[232:233], v101 offset:32768
v_mfma_f32_16x16x32_bf16 a[224:227], v[128:131], v[248:251], a[224:227]
s_waitcnt lgkmcnt(9)
ds_read_b64_tr_b16 v[234:235], v101 offset:33792
v_mfma_f32_16x16x32_bf16 a[0:3], v[224:227], v[192:195], a[0:3]
s_add_u32 s69, s73, s67
ds_read_b64_tr_b16 v[236:237], v101 offset:40960
v_mfma_f32_16x16x32_bf16 a[0:3], v[228:231], v[196:199], a[0:3]
s_add_u32 s70, s73, s68
ds_read_b64_tr_b16 v[238:239], v101 offset:41984
v_mfma_f32_16x16x32_bf16 a[4:7], v[228:231], v[204:207], a[4:7]
s_add_u32 m0, s63, 65536
ds_read_b64_tr_b16 v[240:241], v102 offset:32768
v_mfma_f32_16x16x32_bf16 a[4:7], v[224:227], v[200:203], a[4:7]
s_add_u32 s72, s69, 0
buffer_load_dwordx4 v4, s[4:7], s72 offen lds
v_mfma_f32_16x16x32_bf16 a[8:11], v[224:227], v[208:211], a[8:11]
s_add_u32 s72, s69, 15360
buffer_load_dwordx4 v5, s[4:7], s72 offen offset:1024 lds
v_mfma_f32_16x16x32_bf16 a[8:11], v[228:231], v[212:215], a[8:11]
s_add_u32 s72, s69, 129024
buffer_load_dwordx4 v4, s[4:7], s72 offen offset:2048 lds
v_mfma_f32_16x16x32_bf16 a[12:15], v[228:231], v[220:223], a[12:15]
ds_read_b64_tr_b16 v[242:243], v102 offset:33792
v_mfma_f32_16x16x32_bf16 a[12:15], v[224:227], v[216:219], a[12:15]
s_waitcnt lgkmcnt(6)
v_mfma_f32_16x16x32_bf16 a[16:19], v[224:227], v[184:187], a[16:19]
s_add_u32 s74, s74, 0x4000
buffer_store_dwordx4 v[44:47], v26, s[44:47], s74 offen sc1
v_mfma_f32_16x16x32_bf16 a[16:19], v[228:231], v[188:191], a[16:19]
ds_read_b64_tr_b16 v[244:245], v102 offset:40960
v_mfma_f32_16x16x32_bf16 a[20:23], v[228:231], v[180:183], a[20:23]
v_mfma_f32_16x16x32_bf16 a[20:23], v[224:227], v[176:179], a[20:23]
ds_read_b64_tr_b16 v[246:247], v102 offset:41984
v_mfma_f32_16x16x32_bf16 a[24:27], v[224:227], v[168:171], a[24:27]
s_add_u32 s72, s69, 144384
buffer_load_dwordx4 v5, s[4:7], s72 offen offset:3072 lds
v_mfma_f32_16x16x32_bf16 a[24:27], v[228:231], v[172:175], a[24:27]
v_mfma_f32_16x16x32_bf16 a[28:31], v[228:231], v[164:167], a[28:31]
v_mfma_f32_16x16x32_bf16 a[28:31], v[224:227], v[160:163], a[28:31]
s_waitcnt lgkmcnt(4)
v_mfma_f32_16x16x32_bf16 a[60:63], v[232:235], v[160:163], a[60:63]
ds_read_b64_tr_b16 v[248:249], v103 offset:32768
v_mfma_f32_16x16x32_bf16 a[60:63], v[236:239], v[164:167], a[60:63]
v_mfma_f32_16x16x32_bf16 a[56:59], v[236:239], v[172:175], a[56:59]
s_add_u32 m0, s63, 69632
ds_read_b64_tr_b16 v[250:251], v103 offset:33792
v_mfma_f32_16x16x32_bf16 a[56:59], v[232:235], v[168:171], a[56:59]
s_add_u32 s72, s70, 0
buffer_load_dwordx4 v4, s[4:7], s72 offen lds
v_mfma_f32_16x16x32_bf16 a[52:55], v[232:235], v[176:179], a[52:55]
v_mfma_f32_16x16x32_bf16 a[52:55], v[236:239], v[180:183], a[52:55]
v_mfma_f32_16x16x32_bf16 a[48:51], v[236:239], v[188:191], a[48:51]
ds_read_b64_tr_b16 v[252:253], v103 offset:40960
v_mfma_f32_16x16x32_bf16 a[48:51], v[232:235], v[184:187], a[48:51]
v_mfma_f32_16x16x32_bf16 a[44:47], v[232:235], v[216:219], a[44:47]
s_add_u32 s72, s70, 15360
buffer_load_dwordx4 v5, s[4:7], s72 offen offset:1024 lds
v_mfma_f32_16x16x32_bf16 a[44:47], v[236:239], v[220:223], a[44:47]
s_add_u32 s74, s74, 0x4000
buffer_store_dwordx4 v[48:51], v26, s[44:47], s74 offen sc1
v_mfma_f32_16x16x32_bf16 a[40:43], v[236:239], v[212:215], a[40:43]
v_mfma_f32_16x16x32_bf16 a[40:43], v[232:235], v[208:211], a[40:43]
ds_read_b64_tr_b16 v[254:255], v103 offset:41984
v_mfma_f32_16x16x32_bf16 a[36:39], v[232:235], v[200:203], a[36:39]
v_mfma_f32_16x16x32_bf16 a[36:39], v[236:239], v[204:207], a[36:39]
v_mfma_f32_16x16x32_bf16 a[32:35], v[236:239], v[196:199], a[32:35]
v_mfma_f32_16x16x32_bf16 a[32:35], v[232:235], v[192:195], a[32:35]
s_waitcnt lgkmcnt(4)
v_mfma_f32_16x16x32_bf16 a[64:67], v[240:243], v[192:195], a[64:67]
s_add_u32 s72, s70, 129024
buffer_load_dwordx4 v4, s[4:7], s72 offen offset:2048 lds
v_mfma_f32_16x16x32_bf16 a[64:67], v[244:247], v[196:199], a[64:67]
ds_read_b64_tr_b16 v[224:225], v100 offset:49152
v_mfma_f32_16x16x32_bf16 a[68:71], v[244:247], v[204:207], a[68:71]
v_mfma_f32_16x16x32_bf16 a[68:71], v[240:243], v[200:203], a[68:71]
v_mfma_f32_16x16x32_bf16 a[72:75], v[240:243], v[208:211], a[72:75]
ds_read_b64_tr_b16 v[226:227], v100 offset:50176
v_mfma_f32_16x16x32_bf16 a[72:75], v[244:247], v[212:215], a[72:75]
s_add_u32 s72, s70, 144384
buffer_load_dwordx4 v5, s[4:7], s72 offen offset:3072 lds
v_mfma_f32_16x16x32_bf16 a[76:79], v[244:247], v[220:223], a[76:79]
v_mfma_f32_16x16x32_bf16 a[76:79], v[240:243], v[216:219], a[76:79]
v_mfma_f32_16x16x32_bf16 a[80:83], v[240:243], v[184:187], a[80:83]
ds_read_b64_tr_b16 v[228:229], v100 offset:57344
v_mfma_f32_16x16x32_bf16 a[80:83], v[244:247], v[188:191], a[80:83]
v_mfma_f32_16x16x32_bf16 a[84:87], v[244:247], v[180:183], a[84:87]
v_accvgpr_read_b32 v20, a0
v_accvgpr_read_b32 v28, a1
v_mfma_f32_16x16x32_bf16 a[84:87], v[240:243], v[176:179], a[84:87]
s_lshl_b32 s71, s73, 12
ds_read_b64_tr_b16 v[230:231], v100 offset:58368
v_accvgpr_read_b32 v21, a2
v_mfma_f32_16x16x32_bf16 a[88:91], v[240:243], v[168:171], a[88:91]
s_add_u32 s71, s71, s66
v_accvgpr_read_b32 v29, a3
v_accvgpr_read_b32 v22, a32
v_mfma_f32_16x16x32_bf16 a[88:91], v[244:247], v[172:175], a[88:91]
s_add_u32 m0, s64, 16384
v_accvgpr_read_b32 v30, a33
v_accvgpr_read_b32 v23, a34
v_mfma_f32_16x16x32_bf16 a[92:95], v[244:247], v[164:167], a[92:95]
s_add_u32 s72, s71, 0
buffer_load_dwordx4 v6, s[12:15], s72 offen lds
v_mfma_f32_16x16x32_bf16 a[92:95], v[240:243], v[160:163], a[92:95]
s_waitcnt lgkmcnt(4)
v_accvgpr_read_b32 v31, a35
v_mul_f32 v20, s79, v20
v_mfma_f32_16x16x32_bf16 a[124:127], v[248:251], v[160:163], a[124:127]
ds_read_b64_tr_b16 v[232:233], v101 offset:49152
v_mul_f32 v28, s79, v28
v_mfma_f32_16x16x32_bf16 a[124:127], v[252:255], v[164:167], a[124:127]
v_mul_f32 v21, s79, v21
v_mul_f32 v29, s79, v29
v_mfma_f32_16x16x32_bf16 a[120:123], v[252:255], v[172:175], a[120:123]
s_add_u32 s72, s71, 31744
buffer_load_dwordx4 v6, s[12:15], s72 offen offset:1024 lds
v_mfma_f32_16x16x32_bf16 a[120:123], v[248:251], v[168:171], a[120:123]
v_mul_f32 v22, s79, v22
v_mul_f32 v30, s79, v30
v_mfma_f32_16x16x32_bf16 a[116:119], v[248:251], v[176:179], a[116:119]
ds_read_b64_tr_b16 v[234:235], v101 offset:50176
v_mul_f32 v23, s79, v23
v_mfma_f32_16x16x32_bf16 a[116:119], v[252:255], v[180:183], a[116:119]
v_mul_f32 v31, s79, v31
v_cvt_pk_bf16_f32 v20, v20, v28
v_mfma_f32_16x16x32_bf16 a[112:115], v[252:255], v[188:191], a[112:115]
v_cvt_pk_bf16_f32 v21, v21, v29
v_cvt_pk_bf16_f32 v22, v22, v30
v_mfma_f32_16x16x32_bf16 a[112:115], v[248:251], v[184:187], a[112:115]
ds_read_b64_tr_b16 v[236:237], v101 offset:57344
v_cvt_pk_bf16_f32 v23, v23, v31
v_mfma_f32_16x16x32_bf16 a[108:111], v[248:251], v[216:219], a[108:111]
s_add_u32 s72, s71, 63488
buffer_load_dwordx4 v7, s[12:15], s72 offen offset:2048 lds
v_mfma_f32_16x16x32_bf16 a[108:111], v[252:255], v[220:223], a[108:111]
s_add_u32 s80, s77, 0
buffer_store_dwordx4 v[20:23], v1, s[44:47], s80 offen sc1
v_mfma_f32_16x16x32_bf16 a[104:107], v[252:255], v[212:215], a[104:107]
v_mfma_f32_16x16x32_bf16 a[104:107], v[248:251], v[208:211], a[104:107]
ds_read_b64_tr_b16 v[238:239], v101 offset:58368
v_mfma_f32_16x16x32_bf16 a[100:103], v[248:251], v[200:203], a[100:103]
v_mfma_f32_16x16x32_bf16 a[100:103], v[252:255], v[204:207], a[100:103]
v_mfma_f32_16x16x32_bf16 a[96:99], v[252:255], v[196:199], a[96:99]
s_add_u32 s72, s71, 95232
buffer_load_dwordx4 v7, s[12:15], s72 offen offset:3072 lds
v_mfma_f32_16x16x32_bf16 a[96:99], v[248:251], v[192:195], a[96:99]
s_waitcnt lgkmcnt(4)
LcB0:
v_mfma_f32_16x16x32_bf16 a[128:131], v[192:195], v[224:227], a[128:131]
ds_read_b64_tr_b16 v[240:241], v102 offset:49152
v_accvgpr_read_b32 v24, a4
v_mfma_f32_16x16x32_bf16 a[128:131], v[196:199], v[228:231], a[128:131]
v_accvgpr_read_b32 v28, a5
v_accvgpr_read_b32 v25, a6
v_mfma_f32_16x16x32_bf16 a[132:135], v[204:207], v[228:231], a[132:135]
v_accvgpr_read_b32 v29, a7
v_accvgpr_read_b32 v26, a36
v_mfma_f32_16x16x32_bf16 a[132:135], v[200:203], v[224:227], a[132:135]
ds_read_b64_tr_b16 v[242:243], v102 offset:50176
v_accvgpr_read_b32 v30, a37
v_mfma_f32_16x16x32_bf16 a[136:139], v[208:211], v[224:227], a[136:139]
v_accvgpr_read_b32 v27, a38
v_accvgpr_read_b32 v31, a39
v_mfma_f32_16x16x32_bf16 a[136:139], v[212:215], v[228:231], a[136:139]
v_mul_f32 v24, s79, v24
v_mul_f32 v28, s79, v28
v_mfma_f32_16x16x32_bf16 a[140:143], v[220:223], v[228:231], a[140:143]
v_mul_f32 v25, s79, v25
v_mul_f32 v29, s79, v29
v_mfma_f32_16x16x32_bf16 a[140:143], v[216:219], v[224:227], a[140:143]
ds_read_b64_tr_b16 v[244:245], v102 offset:57344
v_mul_f32 v26, s79, v26
v_mfma_f32_16x16x32_bf16 a[144:147], v[184:187], v[224:227], a[144:147]
v_mul_f32 v30, s79, v30
v_mul_f32 v27, s79, v27
v_mfma_f32_16x16x32_bf16 a[144:147], v[188:191], v[228:231], a[144:147]
v_mul_f32 v31, s79, v31
v_cvt_pk_bf16_f32 v24, v24, v28
v_mfma_f32_16x16x32_bf16 a[148:151], v[180:183], v[228:231], a[148:151]
ds_read_b64_tr_b16 v[246:247], v102 offset:58368
v_cvt_pk_bf16_f32 v25, v25, v29
v_mfma_f32_16x16x32_bf16 a[148:151], v[176:179], v[224:227], a[148:151]
v_cvt_pk_bf16_f32 v26, v26, v30
v_cvt_pk_bf16_f32 v27, v27, v31
v_mfma_f32_16x16x32_bf16 a[152:155], v[168:171], v[224:227], a[152:155]
s_add_u32 s80, s77, 4096
buffer_store_dwordx4 v[24:27], v1, s[44:47], s80 offen sc1
v_mfma_f32_16x16x32_bf16 a[152:155], v[172:175], v[228:231], a[152:155]
v_mfma_f32_16x16x32_bf16 a[156:159], v[164:167], v[228:231], a[156:159]
v_mfma_f32_16x16x32_bf16 a[156:159], v[160:163], v[224:227], a[156:159]
s_waitcnt lgkmcnt(4)
v_mfma_f32_16x16x32_bf16 a[188:191], v[160:163], v[232:235], a[188:191]
ds_read_b64_tr_b16 v[248:249], v103 offset:49152
v_mfma_f32_16x16x32_bf16 a[188:191], v[164:167], v[236:239], a[188:191]
v_mfma_f32_16x16x32_bf16 a[184:187], v[172:175], v[236:239], a[184:187]
ds_read_b64_tr_b16 v[250:251], v103 offset:50176
v_mfma_f32_16x16x32_bf16 a[184:187], v[168:171], v[232:235], a[184:187]
v_mfma_f32_16x16x32_bf16 a[180:183], v[176:179], v[232:235], a[180:183]
ds_read_b64_tr_b16 v[252:253], v103 offset:57344
v_mfma_f32_16x16x32_bf16 a[180:183], v[180:183], v[236:239], a[180:183]
s_add_u32 s73, s62, 2
v_mfma_f32_16x16x32_bf16 a[176:179], v[188:191], v[236:239], a[176:179]
s_add_u32 s70, s73, s65
ds_read_b64_tr_b16 v[254:255], v103 offset:58368
v_accvgpr_read_b32 v20, a8
v_mfma_f32_16x16x32_bf16 a[176:179], v[184:187], v[232:235], a[176:179]
s_and_b32 s70, s70, 3
v_accvgpr_read_b32 v28, a9
v_accvgpr_read_b32 v21, a10
v_mfma_f32_16x16x32_bf16 a[172:175], v[216:219], v[232:235], a[172:175]
s_and_b32 s73, s73, 12
v_accvgpr_read_b32 v29, a11
v_accvgpr_read_b32 v22, a40
v_mfma_f32_16x16x32_bf16 a[172:175], v[220:223], v[236:239], a[172:175]
s_or_b32 s73, s73, s70
v_accvgpr_read_b32 v30, a41
v_accvgpr_read_b32 v23, a42
v_mfma_f32_16x16x32_bf16 a[168:171], v[212:215], v[236:239], a[168:171]
s_lshl_b32 s73, s73, 7
v_accvgpr_read_b32 v31, a43
v_mul_f32 v20, s79, v20
v_mfma_f32_16x16x32_bf16 a[168:171], v[208:211], v[232:235], a[168:171]
s_add_u32 s69, s73, s67
v_mul_f32 v28, s79, v28
v_mul_f32 v21, s79, v21
v_mfma_f32_16x16x32_bf16 a[164:167], v[200:203], v[232:235], a[164:167]
s_add_u32 s70, s73, s68
v_mul_f32 v29, s79, v29
v_mul_f32 v22, s79, v22
v_mfma_f32_16x16x32_bf16 a[164:167], v[204:207], v[236:239], a[164:167]
s_add_u32 m0, s63, 98304
v_mul_f32 v30, s79, v30
v_mul_f32 v23, s79, v23
v_mfma_f32_16x16x32_bf16 a[160:163], v[196:199], v[236:239], a[160:163]
s_waitcnt vmcnt(8) lgkmcnt(0)
v_mul_f32 v31, s79, v31
v_cvt_pk_bf16_f32 v20, v20, v28
v_mfma_f32_16x16x32_bf16 a[160:163], v[192:195], v[232:235], a[160:163]
s_barrier
v_cvt_pk_bf16_f32 v21, v21, v29
v_cvt_pk_bf16_f32 v22, v22, v30
v_mfma_f32_16x16x32_bf16 a[192:195], v[192:195], v[240:243], a[192:195]
s_add_u32 s72, s69, 0
buffer_load_dwordx4 v4, s[4:7], s72 offen lds
v_mfma_f32_16x16x32_bf16 a[192:195], v[196:199], v[244:247], a[192:195]
s_lshl_b32 s74, s59, 2
ds_read_b64_tr_b16 v[64:65], v8 offset:0
v_or_b32 v106, s58, v0
v_mfma_f32_16x16x32_bf16 a[196:199], v[204:207], v[244:247], a[196:199]
ds_read_b64_tr_b16 v[66:67], v8 offset:1024
v_mov_b32 v107, 1
v_mfma_f32_16x16x32_bf16 a[196:199], v[200:203], v[240:243], a[196:199]
ds_read_b64_tr_b16 v[68:69], v8 offset:8192
v_lshlrev_b32 v106, 8, v106
v_mfma_f32_16x16x32_bf16 a[200:203], v[208:211], v[240:243], a[200:203]
ds_read_b64_tr_b16 v[70:71], v8 offset:9216
v_cvt_pk_bf16_f32 v23, v23, v31
v_mfma_f32_16x16x32_bf16 a[200:203], v[212:215], v[244:247], a[200:203]
s_add_u32 s72, s69, 15360
buffer_load_dwordx4 v5, s[4:7], s72 offen offset:1024 lds
v_mfma_f32_16x16x32_bf16 a[204:207], v[220:223], v[244:247], a[204:207]
s_add_u32 s80, s77, 8192
ds_read_b128 v[32:35], v16 offset:0
v_mfma_f32_16x16x32_bf16 a[204:207], v[216:219], v[240:243], a[204:207]
buffer_atomic_add v107, v106, s[48:51], s74 offen sc1
v_mfma_f32_16x16x32_bf16 a[208:211], v[184:187], v[240:243], a[208:211]
ds_read_b128 v[36:39], v17 offset:0
v_mfma_f32_16x16x32_bf16 a[208:211], v[188:191], v[244:247], a[208:211]
ds_read_b128 v[40:43], v16 offset:2048
v_mfma_f32_16x16x32_bf16 a[212:215], v[180:183], v[244:247], a[212:215]
s_add_u32 s72, s69, 129024
buffer_load_dwordx4 v4, s[4:7], s72 offen offset:2048 lds
v_mfma_f32_16x16x32_bf16 a[212:215], v[176:179], v[240:243], a[212:215]
ds_read_b128 v[44:47], v17 offset:2048
v_mfma_f32_16x16x32_bf16 a[216:219], v[168:171], v[240:243], a[216:219]
ds_read_b128 v[48:51], v16 offset:4096
v_accvgpr_read_b32 v24, a128
v_mfma_f32_16x16x32_bf16 a[216:219], v[172:175], v[244:247], a[216:219]
ds_read_b128 v[52:55], v17 offset:4096
v_accvgpr_read_b32 v28, a129
v_mfma_f32_16x16x32_bf16 a[220:223], v[164:167], v[244:247], a[220:223]
buffer_store_dwordx4 v[20:23], v1, s[44:47], s80 offen sc1
v_mfma_f32_16x16x32_bf16 a[220:223], v[160:163], v[240:243], a[220:223]
s_add_u32 s72, s69, 144384
buffer_load_dwordx4 v5, s[4:7], s72 offen offset:3072 lds
v_mfma_f32_16x16x32_bf16 a[252:255], v[160:163], v[248:251], a[252:255]
ds_read_b128 v[56:59], v16 offset:6144
v_accvgpr_read_b32 v25, a130
v_mfma_f32_16x16x32_bf16 a[252:255], v[164:167], v[252:255], a[252:255]
ds_read_b128 v[60:63], v17 offset:6144
v_accvgpr_read_b32 v29, a131
v_mfma_f32_16x16x32_bf16 a[248:251], v[172:175], v[252:255], a[248:251]
ds_read_b64_tr_b16 v[72:73], v9 offset:0
v_accvgpr_read_b32 v26, a132
v_mfma_f32_16x16x32_bf16 a[248:251], v[168:171], v[248:251], a[248:251]
s_add_u32 m0, s63, 102400
ds_read_b64_tr_b16 v[74:75], v9 offset:1024
v_accvgpr_read_b32 v30, a133
v_mfma_f32_16x16x32_bf16 a[244:247], v[176:179], v[248:251], a[244:247]
s_add_u32 s72, s70, 0
buffer_load_dwordx4 v4, s[4:7], s72 offen lds
v_mfma_f32_16x16x32_bf16 a[244:247], v[180:183], v[252:255], a[244:247]
ds_read_b64_tr_b16 v[76:77], v9 offset:8192
v_accvgpr_read_b32 v27, a134
v_mfma_f32_16x16x32_bf16 a[240:243], v[188:191], v[252:255], a[240:243]
v_accvgpr_read_b32 v31, a135
v_cvt_pk_bf16_f32 v24, v24, v28
v_mfma_f32_16x16x32_bf16 a[240:243], v[184:187], v[248:251], a[240:243]
ds_read_b64_tr_b16 v[78:79], v9 offset:9216
v_cvt_pk_bf16_f32 v25, v25, v29
v_mfma_f32_16x16x32_bf16 a[236:239], v[216:219], v[248:251], a[236:239]
ds_read_b64_tr_b16 v[80:81], v10 offset:0
v_cvt_pk_bf16_f32 v26, v26, v30
v_mfma_f32_16x16x32_bf16 a[236:239], v[220:223], v[252:255], a[236:239]
s_add_u32 s72, s70, 15360
buffer_load_dwordx4 v5, s[4:7], s72 offen offset:1024 lds
v_mfma_f32_16x16x32_bf16 a[232:235], v[212:215], v[252:255], a[232:235]
ds_read_b64_tr_b16 v[82:83], v10 offset:1024
v_cvt_pk_bf16_f32 v27, v27, v31
v_mfma_f32_16x16x32_bf16 a[232:235], v[208:211], v[248:251], a[232:235]
s_add_u32 s80, s78, 0
ds_read_b64_tr_b16 v[84:85], v10 offset:8192
v_mfma_f32_16x16x32_bf16 a[228:231], v[200:203], v[248:251], a[228:231]
ds_read_b64_tr_b16 v[86:87], v10 offset:9216
v_mfma_f32_16x16x32_bf16 a[228:231], v[204:207], v[252:255], a[228:231]
buffer_store_dwordx4 v[24:27], v1, s[44:47], s80 offen sc1
v_mfma_f32_16x16x32_bf16 a[224:227], v[196:199], v[252:255], a[224:227]
s_add_u32 s72, s70, 129024
buffer_load_dwordx4 v4, s[4:7], s72 offen offset:2048 lds
v_mfma_f32_16x16x32_bf16 a[224:227], v[192:195], v[248:251], a[224:227]
s_waitcnt lgkmcnt(8)
v_mfma_f32_16x16x32_bf16 v[128:131], v[64:67], v[32:35], 0
ds_read_b64_tr_b16 v[88:89], v11 offset:0
v_mfma_f32_16x16x32_bf16 v[128:131], v[68:71], v[36:39], v[128:131]
ds_read_b64_tr_b16 v[90:91], v11 offset:1024
v_mfma_f32_16x16x32_bf16 v[132:135], v[68:71], v[44:47], 0
v_accvgpr_read_b32 v20, a12
v_accvgpr_read_b32 v28, a13
v_mfma_f32_16x16x32_bf16 v[132:135], v[64:67], v[40:43], v[132:135]
s_add_u32 s72, s70, 144384
buffer_load_dwordx4 v5, s[4:7], s72 offen offset:3072 lds
v_mfma_f32_16x16x32_bf16 v[136:139], v[64:67], v[48:51], 0
s_lshl_b32 s71, s73, 12
ds_read_b64_tr_b16 v[92:93], v11 offset:8192
v_accvgpr_read_b32 v21, a14
v_mfma_f32_16x16x32_bf16 v[136:139], v[68:71], v[52:55], v[136:139]
s_add_u32 s71, s71, s66
v_accvgpr_read_b32 v29, a15
v_accvgpr_read_b32 v22, a44
v_mfma_f32_16x16x32_bf16 v[140:143], v[68:71], v[60:63], 0
s_add_u32 m0, s64, 32768
ds_read_b64_tr_b16 v[94:95], v11 offset:9216
v_accvgpr_read_b32 v30, a45
v_mfma_f32_16x16x32_bf16 v[140:143], v[64:67], v[56:59], v[140:143]
s_waitcnt lgkmcnt(8)
v_accvgpr_read_b32 v23, a46
v_accvgpr_read_b32 v31, a47
v_mfma_f32_16x16x32_bf16 v[156:159], v[72:75], v[56:59], 0
s_add_u32 s72, s71, 0
buffer_load_dwordx4 v6, s[12:15], s72 offen lds
v_mfma_f32_16x16x32_bf16 v[156:159], v[76:79], v[60:63], v[156:159]
s_add_u32 s73, s62, 3
ds_read_b64_tr_b16 v[64:65], v12 offset:0
v_mul_f32 v20, s79, v20
v_mfma_f32_16x16x32_bf16 v[152:155], v[76:79], v[52:55], 0
s_add_u32 s70, s73, s65
ds_read_b64_tr_b16 v[66:67], v12 offset:1024
v_mul_f32 v28, s79, v28
v_mfma_f32_16x16x32_bf16 v[152:155], v[72:75], v[48:51], v[152:155]
s_add_u32 s72, s71, 31744
buffer_load_dwordx4 v6, s[12:15], s72 offen offset:1024 lds
v_mfma_f32_16x16x32_bf16 v[148:151], v[72:75], v[40:43], 0
s_and_b32 s70, s70, 3
v_mul_f32 v21, s79, v21
v_mul_f32 v29, s79, v29
v_mfma_f32_16x16x32_bf16 v[148:151], v[76:79], v[44:47], v[148:151]
s_and_b32 s73, s73, 12
ds_read_b64_tr_b16 v[68:69], v12 offset:8192
v_mul_f32 v22, s79, v22
v_mfma_f32_16x16x32_bf16 v[144:147], v[76:79], v[36:39], 0
s_or_b32 s73, s73, s70
ds_read_b64_tr_b16 v[70:71], v12 offset:9216
v_mul_f32 v30, s79, v30
v_mfma_f32_16x16x32_bf16 v[144:147], v[72:75], v[32:35], v[144:147]
s_waitcnt lgkmcnt(8)
v_mul_f32 v23, s79, v23
v_mul_f32 v31, s79, v31
v_mfma_f32_16x16x32_bf16 v[160:163], v[80:83], v[32:35], 0
s_lshl_b32 s73, s73, 7
ds_read_b64_tr_b16 v[72:73], v13 offset:0
v_cvt_pk_bf16_f32 v20, v20, v28
v_mfma_f32_16x16x32_bf16 v[160:163], v[84:87], v[36:39], v[160:163]
s_add_u32 s72, s71, 63488
buffer_load_dwordx4 v7, s[12:15], s72 offen offset:2048 lds
v_mfma_f32_16x16x32_bf16 v[164:167], v[84:87], v[44:47], 0
s_add_u32 s69, s73, s67
ds_read_b64_tr_b16 v[74:75], v13 offset:1024
v_cvt_pk_bf16_f32 v21, v21, v29
v_mfma_f32_16x16x32_bf16 v[164:167], v[80:83], v[40:43], v[164:167]
s_add_u32 s70, s73, s68
v_cvt_pk_bf16_f32 v22, v22, v30
v_cvt_pk_bf16_f32 v23, v23, v31
v_mfma_f32_16x16x32_bf16 v[168:171], v[80:83], v[48:51], 0
s_waitcnt vmcnt(20)
ds_read_b64_tr_b16 v[76:77], v13 offset:8192
v_mfma_f32_16x16x32_bf16 v[168:171], v[84:87], v[52:55], v[168:171]
s_add_u32 s80, s77, 12288
ds_read_b64_tr_b16 v[78:79], v13 offset:9216
v_mfma_f32_16x16x32_bf16 v[172:175], v[84:87], v[60:63], 0
s_add_u32 s72, s71, 95232
ds_read_b128 v[96:99], v18 offset:0
v_mfma_f32_16x16x32_bf16 v[172:175], v[80:83], v[56:59], v[172:175]
s_waitcnt lgkmcnt(9)
buffer_load_dwordx4 v7, s[12:15], s72 offen offset:3072 lds
v_mfma_f32_16x16x32_bf16 v[188:191], v[88:91], v[56:59], 0
ds_read_b64_tr_b16 v[80:81], v14 offset:0
v_accvgpr_read_b32 v24, a136
v_mfma_f32_16x16x32_bf16 v[188:191], v[92:95], v[60:63], v[188:191]
ds_read_b64_tr_b16 v[82:83], v14 offset:1024
v_accvgpr_read_b32 v28, a137
v_mfma_f32_16x16x32_bf16 v[184:187], v[92:95], v[52:55], 0
ds_read_b128 v[100:103], v19 offset:0
v_accvgpr_read_b32 v25, a138
v_mfma_f32_16x16x32_bf16 v[184:187], v[88:91], v[48:51], v[184:187]
ds_read_b64_tr_b16 v[84:85], v14 offset:8192
v_accvgpr_read_b32 v29, a139
v_mfma_f32_16x16x32_bf16 v[180:183], v[88:91], v[40:43], 0
buffer_store_dwordx4 v[20:23], v1, s[44:47], s80 offen sc1
v_mfma_f32_16x16x32_bf16 v[180:183], v[92:95], v[44:47], v[180:183]
s_add_u32 m0, s63, 131072
ds_read_b64_tr_b16 v[86:87], v14 offset:9216
v_accvgpr_read_b32 v26, a140
v_mfma_f32_16x16x32_bf16 v[176:179], v[92:95], v[36:39], 0
s_add_u32 s72, s69, 0
buffer_load_dwordx4 v4, s[4:7], s72 offen lds
v_mfma_f32_16x16x32_bf16 v[176:179], v[88:91], v[32:35], v[176:179]
s_waitcnt lgkmcnt(10)
ds_read_b128 v[104:107], v18 offset:2048
v_accvgpr_read_b32 v30, a141
v_mfma_f32_16x16x32_bf16 v[192:195], v[64:67], v[32:35], 0
ds_read_b64_tr_b16 v[88:89], v15 offset:0
v_accvgpr_read_b32 v27, a142
v_mfma_f32_16x16x32_bf16 v[192:195], v[68:71], v[36:39], v[192:195]
ds_read_b64_tr_b16 v[90:91], v15 offset:1024
v_accvgpr_read_b32 v31, a143
v_mfma_f32_16x16x32_bf16 v[196:199], v[68:71], v[44:47], 0
ds_read_b64_tr_b16 v[92:93], v15 offset:8192
v_cvt_pk_bf16_f32 v24, v24, v28
v_mfma_f32_16x16x32_bf16 v[196:199], v[64:67], v[40:43], v[196:199]
s_add_u32 s72, s69, 15360
buffer_load_dwordx4 v5, s[4:7], s72 offen offset:1024 lds
v_mfma_f32_16x16x32_bf16 v[200:203], v[64:67], v[48:51], 0
ds_read_b64_tr_b16 v[94:95], v15 offset:9216
v_cvt_pk_bf16_f32 v25, v25, v29
v_mfma_f32_16x16x32_bf16 v[200:203], v[68:71], v[52:55], v[200:203]
ds_read_b128 v[108:111], v19 offset:2048
v_cvt_pk_bf16_f32 v26, v26, v30
v_mfma_f32_16x16x32_bf16 v[204:207], v[68:71], v[60:63], 0
v_cvt_pk_bf16_f32 v27, v27, v31
v_mfma_f32_16x16x32_bf16 v[204:207], v[64:67], v[56:59], v[204:207]
s_waitcnt lgkmcnt(12)
ds_read_b128 v[112:115], v18 offset:4096
v_mfma_f32_16x16x32_bf16 v[220:223], v[72:75], v[56:59], 0
s_add_u32 s72, s69, 129024
buffer_load_dwordx4 v4, s[4:7], s72 offen offset:2048 lds
v_mfma_f32_16x16x32_bf16 v[220:223], v[76:79], v[60:63], v[220:223]
s_add_u32 s80, s78, 8192
buffer_store_dwordx4 v[24:27], v1, s[44:47], s80 offen sc1
v_mfma_f32_16x16x32_bf16 v[216:219], v[76:79], v[52:55], 0
s_waitcnt vmcnt(21) lgkmcnt(2)
ds_read_b128 v[116:119], v19 offset:4096
v_mfma_f32_16x16x32_bf16 v[216:219], v[72:75], v[48:51], v[216:219]
s_barrier
ds_read_b128 v[120:123], v18 offset:6144
v_mfma_f32_16x16x32_bf16 v[212:215], v[72:75], v[40:43], 0
ds_read_b64_tr_b16 v[64:65], v8 offset:16384
ds_read_b64_tr_b16 v[66:67], v8 offset:17408
v_mfma_f32_16x16x32_bf16 v[212:215], v[76:79], v[44:47], v[212:215]
ds_read_b64_tr_b16 v[68:69], v8 offset:24576
v_mfma_f32_16x16x32_bf16 v[208:211], v[76:79], v[36:39], 0
s_add_u32 s72, s69, 144384
buffer_load_dwordx4 v5, s[4:7], s72 offen offset:3072 lds
v_mfma_f32_16x16x32_bf16 v[208:211], v[72:75], v[32:35], v[208:211]
ds_read_b64_tr_b16 v[70:71], v8 offset:25600
v_accvgpr_read_b32 v20, a16
v_mfma_f32_16x16x32_bf16 v[224:227], v[80:83], v[32:35], 0
ds_read_b64_tr_b16 v[72:73], v9 offset:16384
v_accvgpr_read_b32 v28, a17
v_mfma_f32_16x16x32_bf16 v[224:227], v[84:87], v[36:39], v[224:227]
ds_read_b64_tr_b16 v[74:75], v9 offset:17408
v_accvgpr_read_b32 v21, a18
v_mfma_f32_16x16x32_bf16 v[228:231], v[84:87], v[44:47], 0
s_add_u32 m0, s63, 135168
v_accvgpr_read_b32 v29, a19
v_accvgpr_read_b32 v22, a48
v_mfma_f32_16x16x32_bf16 v[228:231], v[80:83], v[40:43], v[228:231]
s_add_u32 s72, s70, 0
buffer_load_dwordx4 v4, s[4:7], s72 offen lds
v_mfma_f32_16x16x32_bf16 v[232:235], v[80:83], v[48:51], 0
ds_read_b64_tr_b16 v[76:77], v9 offset:24576
v_accvgpr_read_b32 v30, a49
v_mfma_f32_16x16x32_bf16 v[232:235], v[84:87], v[52:55], v[232:235]
ds_read_b128 v[124:127], v19 offset:6144
v_accvgpr_read_b32 v23, a50
v_mfma_f32_16x16x32_bf16 v[236:239], v[84:87], v[60:63], 0
ds_read_b64_tr_b16 v[78:79], v9 offset:25600
v_accvgpr_read_b32 v31, a51
v_mfma_f32_16x16x32_bf16 v[236:239], v[80:83], v[56:59], v[236:239]
v_mul_f32 v20, s79, v20
v_mul_f32 v28, s79, v28
v_mfma_f32_16x16x32_bf16 v[252:255], v[88:91], v[56:59], 0
s_add_u32 s72, s70, 15360
buffer_load_dwordx4 v5, s[4:7], s72 offen offset:1024 lds
v_mfma_f32_16x16x32_bf16 v[252:255], v[92:95], v[60:63], v[252:255]
ds_read_b64_tr_b16 v[80:81], v10 offset:16384
v_mul_f32 v21, s79, v21
v_mfma_f32_16x16x32_bf16 v[248:251], v[92:95], v[52:55], 0
ds_read_b64_tr_b16 v[82:83], v10 offset:17408
v_mul_f32 v29, s79, v29
v_mfma_f32_16x16x32_bf16 v[248:251], v[88:91], v[48:51], v[248:251]
v_mul_f32 v22, s79, v22
v_mul_f32 v30, s79, v30
v_mfma_f32_16x16x32_bf16 v[244:247], v[88:91], v[40:43], 0
ds_read_b64_tr_b16 v[84:85], v10 offset:24576
v_mul_f32 v23, s79, v23
v_mfma_f32_16x16x32_bf16 v[244:247], v[92:95], v[44:47], v[244:247]
ds_read_b64_tr_b16 v[86:87], v10 offset:25600
v_mul_f32 v31, s79, v31
v_mfma_f32_16x16x32_bf16 v[240:243], v[92:95], v[36:39], 0
s_add_u32 s72, s70, 129024
buffer_load_dwordx4 v4, s[4:7], s72 offen offset:2048 lds
v_mfma_f32_16x16x32_bf16 v[240:243], v[88:91], v[32:35], v[240:243]
s_waitcnt lgkmcnt(5)
v_cvt_pk_bf16_f32 v20, v20, v28
v_cvt_pk_bf16_f32 v21, v21, v29
v_mfma_f32_16x16x32_bf16 v[128:131], v[64:67], v[96:99], v[128:131]
ds_read_b64_tr_b16 v[88:89], v11 offset:16384
v_cvt_pk_bf16_f32 v22, v22, v30
v_mfma_f32_16x16x32_bf16 v[128:131], v[68:71], v[100:103], v[128:131]
ds_read_b64_tr_b16 v[90:91], v11 offset:17408
v_cvt_pk_bf16_f32 v23, v23, v31
v_mfma_f32_16x16x32_bf16 v[132:135], v[68:71], v[108:111], v[132:135]
s_add_u32 s80, s77, 32768
buffer_store_dwordx4 v[20:23], v1, s[44:47], s80 offen sc1
v_mfma_f32_16x16x32_bf16 v[132:135], v[64:67], v[104:107], v[132:135]
s_add_u32 s72, s70, 144384
buffer_load_dwordx4 v5, s[4:7], s72 offen offset:3072 lds
v_mfma_f32_16x16x32_bf16 v[136:139], v[64:67], v[112:115], v[136:139]
ds_read_b64_tr_b16 v[92:93], v11 offset:24576
v_accvgpr_read_b32 v24, a144
v_mfma_f32_16x16x32_bf16 v[136:139], v[68:71], v[116:119], v[136:139]
s_lshl_b32 s71, s73, 12
v_accvgpr_read_b32 v28, a145
v_accvgpr_read_b32 v25, a146
v_mfma_f32_16x16x32_bf16 v[140:143], v[68:71], v[124:127], v[140:143]
s_add_u32 s71, s71, s66
ds_read_b64_tr_b16 v[94:95], v11 offset:25600
v_accvgpr_read_b32 v29, a147
v_mfma_f32_16x16x32_bf16 v[140:143], v[64:67], v[120:123], v[140:143]
s_waitcnt lgkmcnt(8)
v_accvgpr_read_b32 v26, a148
v_accvgpr_read_b32 v30, a149
v_mfma_f32_16x16x32_bf16 v[156:159], v[72:75], v[120:123], v[156:159]
s_add_u32 m0, s64, 0
ds_read_b64_tr_b16 v[64:65], v12 offset:16384
v_accvgpr_read_b32 v27, a150
v_mfma_f32_16x16x32_bf16 v[156:159], v[76:79], v[124:127], v[156:159]
s_add_u32 s72, s71, 0
buffer_load_dwordx4 v6, s[12:15], s72 offen lds
v_mfma_f32_16x16x32_bf16 v[152:155], v[76:79], v[116:119], v[152:155]
s_add_u32 s73, s62, 4
ds_read_b64_tr_b16 v[66:67], v12 offset:17408
v_accvgpr_read_b32 v31, a151
v_mfma_f32_16x16x32_bf16 v[152:155], v[72:75], v[112:115], v[152:155]
s_add_u32 s70, s73, s65
v_cvt_pk_bf16_f32 v24, v24, v28
v_cvt_pk_bf16_f32 v25, v25, v29
v_mfma_f32_16x16x32_bf16 v[148:151], v[72:75], v[104:107], v[148:151]
s_and_b32 s70, s70, 3
ds_read_b64_tr_b16 v[68:69], v12 offset:24576
v_cvt_pk_bf16_f32 v26, v26, v30
v_mfma_f32_16x16x32_bf16 v[148:151], v[76:79], v[108:111], v[148:151]
s_and_b32 s73, s73, 12
ds_read_b64_tr_b16 v[70:71], v12 offset:25600
v_cvt_pk_bf16_f32 v27, v27, v31
v_mfma_f32_16x16x32_bf16 v[144:147], v[76:79], v[100:103], v[144:147]
s_add_u32 s72, s71, 31744
buffer_load_dwordx4 v6, s[12:15], s72 offen offset:1024 lds
v_mfma_f32_16x16x32_bf16 v[144:147], v[72:75], v[96:99], v[144:147]
s_waitcnt lgkmcnt(8)
v_mfma_f32_16x16x32_bf16 v[160:163], v[80:83], v[96:99], v[160:163]
s_or_b32 s73, s73, s70
ds_read_b64_tr_b16 v[72:73], v13 offset:16384
v_mfma_f32_16x16x32_bf16 v[160:163], v[84:87], v[100:103], v[160:163]
s_lshl_b32 s73, s73, 7
ds_read_b64_tr_b16 v[74:75], v13 offset:17408
v_mfma_f32_16x16x32_bf16 v[164:167], v[84:87], v[108:111], v[164:167]
s_add_u32 s69, s73, s67
v_mfma_f32_16x16x32_bf16 v[164:167], v[80:83], v[104:107], v[164:167]
s_add_u32 s72, s71, 63488
buffer_load_dwordx4 v7, s[12:15], s72 offen offset:2048 lds
v_mfma_f32_16x16x32_bf16 v[168:171], v[80:83], v[112:115], v[168:171]
s_waitcnt vmcnt(18)
ds_read_b64_tr_b16 v[76:77], v13 offset:24576
v_mfma_f32_16x16x32_bf16 v[168:171], v[84:87], v[116:119], v[168:171]
s_add_u32 s70, s73, s68
ds_read_b128 v[32:35], v18 offset:32768
v_mfma_f32_16x16x32_bf16 v[172:175], v[84:87], v[124:127], v[172:175]
s_add_u32 s80, s78, 32768
ds_read_b64_tr_b16 v[78:79], v13 offset:25600
v_mfma_f32_16x16x32_bf16 v[172:175], v[80:83], v[120:123], v[172:175]
s_waitcnt lgkmcnt(9)
ds_read_b128 v[36:39], v19 offset:32768
v_mfma_f32_16x16x32_bf16 v[188:191], v[88:91], v[120:123], v[188:191]
s_add_u32 s72, s71, 95232
buffer_load_dwordx4 v7, s[12:15], s72 offen offset:3072 lds
v_mfma_f32_16x16x32_bf16 v[188:191], v[92:95], v[124:127], v[188:191]
ds_read_b64_tr_b16 v[80:81], v14 offset:16384
v_mfma_f32_16x16x32_bf16 v[184:187], v[92:95], v[116:119], v[184:187]
ds_read_b64_tr_b16 v[82:83], v14 offset:17408
v_mfma_f32_16x16x32_bf16 v[184:187], v[88:91], v[112:115], v[184:187]
buffer_store_dwordx4 v[24:27], v1, s[44:47], s80 offen sc1
v_mfma_f32_16x16x32_bf16 v[180:183], v[88:91], v[104:107], v[180:183]
ds_read_b64_tr_b16 v[84:85], v14 offset:24576
v_accvgpr_read_b32 v20, a20
v_mfma_f32_16x16x32_bf16 v[180:183], v[92:95], v[108:111], v[180:183]
s_add_u32 m0, s63, 65536
ds_read_b64_tr_b16 v[86:87], v14 offset:25600
v_accvgpr_read_b32 v28, a21
v_mfma_f32_16x16x32_bf16 v[176:179], v[92:95], v[100:103], v[176:179]
s_add_u32 s72, s69, 0
buffer_load_dwordx4 v4, s[4:7], s72 offen lds
v_mfma_f32_16x16x32_bf16 v[176:179], v[88:91], v[96:99], v[176:179]
s_waitcnt lgkmcnt(10)
ds_read_b128 v[40:43], v18 offset:34816
v_accvgpr_read_b32 v21, a22
v_mfma_f32_16x16x32_bf16 v[192:195], v[64:67], v[96:99], v[192:195]
ds_read_b64_tr_b16 v[88:89], v15 offset:16384
v_accvgpr_read_b32 v29, a23
v_mfma_f32_16x16x32_bf16 v[192:195], v[68:71], v[100:103], v[192:195]
ds_read_b64_tr_b16 v[90:91], v15 offset:17408
v_accvgpr_read_b32 v22, a52
v_mfma_f32_16x16x32_bf16 v[196:199], v[68:71], v[108:111], v[196:199]
ds_read_b64_tr_b16 v[92:93], v15 offset:24576
v_accvgpr_read_b32 v30, a53
v_mfma_f32_16x16x32_bf16 v[196:199], v[64:67], v[104:107], v[196:199]
s_add_u32 s72, s69, 15360
buffer_load_dwordx4 v5, s[4:7], s72 offen offset:1024 lds
v_mfma_f32_16x16x32_bf16 v[200:203], v[64:67], v[112:115], v[200:203]
ds_read_b64_tr_b16 v[94:95], v15 offset:25600
v_accvgpr_read_b32 v23, a54
v_mfma_f32_16x16x32_bf16 v[200:203], v[68:71], v[116:119], v[200:203]
ds_read_b128 v[44:47], v19 offset:34816
v_accvgpr_read_b32 v31, a55
v_mfma_f32_16x16x32_bf16 v[204:207], v[68:71], v[124:127], v[204:207]
v_mul_f32 v20, s79, v20
v_mul_f32 v28, s79, v28
v_mfma_f32_16x16x32_bf16 v[204:207], v[64:67], v[120:123], v[204:207]
s_waitcnt lgkmcnt(11)
ds_read_b128 v[48:51], v18 offset:36864
v_mul_f32 v21, s79, v21
v_mfma_f32_16x16x32_bf16 v[220:223], v[72:75], v[120:123], v[220:223]
s_add_u32 s72, s69, 129024
buffer_load_dwordx4 v4, s[4:7], s72 offen offset:2048 lds
v_mfma_f32_16x16x32_bf16 v[220:223], v[76:79], v[124:127], v[220:223]
v_mul_f32 v29, s79, v29
v_mul_f32 v22, s79, v22
v_mfma_f32_16x16x32_bf16 v[216:219], v[76:79], v[116:119], v[216:219]
s_waitcnt vmcnt(19) lgkmcnt(2)
ds_read_b128 v[52:55], v19 offset:36864
v_mul_f32 v30, s79, v30
v_mfma_f32_16x16x32_bf16 v[216:219], v[72:75], v[112:115], v[216:219]
s_barrier
ds_read_b128 v[56:59], v18 offset:38912
v_mul_f32 v23, s79, v23
v_mfma_f32_16x16x32_bf16 v[212:215], v[72:75], v[104:107], v[212:215]
ds_read_b64_tr_b16 v[64:65], v8 offset:32768
ds_read_b64_tr_b16 v[66:67], v8 offset:33792
v_mfma_f32_16x16x32_bf16 v[212:215], v[76:79], v[108:111], v[212:215]
ds_read_b64_tr_b16 v[68:69], v8 offset:40960
v_mul_f32 v31, s79, v31
v_mfma_f32_16x16x32_bf16 v[208:211], v[76:79], v[100:103], v[208:211]
s_add_u32 s72, s69, 144384
buffer_load_dwordx4 v5, s[4:7], s72 offen offset:3072 lds
v_mfma_f32_16x16x32_bf16 v[208:211], v[72:75], v[96:99], v[208:211]
ds_read_b64_tr_b16 v[70:71], v8 offset:41984
v_cvt_pk_bf16_f32 v20, v20, v28
v_mfma_f32_16x16x32_bf16 v[224:227], v[80:83], v[96:99], v[224:227]
ds_read_b64_tr_b16 v[72:73], v9 offset:32768
v_cvt_pk_bf16_f32 v21, v21, v29
v_mfma_f32_16x16x32_bf16 v[224:227], v[84:87], v[100:103], v[224:227]
ds_read_b64_tr_b16 v[74:75], v9 offset:33792
v_cvt_pk_bf16_f32 v22, v22, v30
v_mfma_f32_16x16x32_bf16 v[228:231], v[84:87], v[108:111], v[228:231]
s_add_u32 m0, s63, 69632
v_cvt_pk_bf16_f32 v23, v23, v31
v_accvgpr_read_b32 v24, a152
v_mfma_f32_16x16x32_bf16 v[228:231], v[80:83], v[104:107], v[228:231]
s_add_u32 s72, s70, 0
buffer_load_dwordx4 v4, s[4:7], s72 offen lds
v_mfma_f32_16x16x32_bf16 v[232:235], v[80:83], v[112:115], v[232:235]
s_add_u32 s80, s77, 36864
ds_read_b64_tr_b16 v[76:77], v9 offset:40960
v_accvgpr_read_b32 v28, a153
v_mfma_f32_16x16x32_bf16 v[232:235], v[84:87], v[116:119], v[232:235]
ds_read_b128 v[60:63], v19 offset:38912
v_accvgpr_read_b32 v25, a154
v_mfma_f32_16x16x32_bf16 v[236:239], v[84:87], v[124:127], v[236:239]
ds_read_b64_tr_b16 v[78:79], v9 offset:41984
v_accvgpr_read_b32 v29, a155
v_mfma_f32_16x16x32_bf16 v[236:239], v[80:83], v[120:123], v[236:239]
buffer_store_dwordx4 v[20:23], v1, s[44:47], s80 offen sc1
v_mfma_f32_16x16x32_bf16 v[252:255], v[88:91], v[120:123], v[252:255]
s_add_u32 s72, s70, 15360
buffer_load_dwordx4 v5, s[4:7], s72 offen offset:1024 lds
v_mfma_f32_16x16x32_bf16 v[252:255], v[92:95], v[124:127], v[252:255]
ds_read_b64_tr_b16 v[80:81], v10 offset:32768
v_accvgpr_read_b32 v26, a156
v_mfma_f32_16x16x32_bf16 v[248:251], v[92:95], v[116:119], v[248:251]
ds_read_b64_tr_b16 v[82:83], v10 offset:33792
v_accvgpr_read_b32 v30, a157
v_mfma_f32_16x16x32_bf16 v[248:251], v[88:91], v[112:115], v[248:251]
v_accvgpr_read_b32 v27, a158
v_accvgpr_read_b32 v31, a159
v_mfma_f32_16x16x32_bf16 v[244:247], v[88:91], v[104:107], v[244:247]
ds_read_b64_tr_b16 v[84:85], v10 offset:40960
v_cvt_pk_bf16_f32 v24, v24, v28
v_mfma_f32_16x16x32_bf16 v[244:247], v[92:95], v[108:111], v[244:247]
ds_read_b64_tr_b16 v[86:87], v10 offset:41984
v_cvt_pk_bf16_f32 v25, v25, v29
v_mfma_f32_16x16x32_bf16 v[240:243], v[92:95], v[100:103], v[240:243]
s_add_u32 s72, s70, 129024
buffer_load_dwordx4 v4, s[4:7], s72 offen offset:2048 lds
v_mfma_f32_16x16x32_bf16 v[240:243], v[88:91], v[96:99], v[240:243]
s_waitcnt lgkmcnt(5)
v_cvt_pk_bf16_f32 v26, v26, v30
v_cvt_pk_bf16_f32 v27, v27, v31
v_mfma_f32_16x16x32_bf16 v[128:131], v[64:67], v[32:35], v[128:131]
s_add_u32 s80, s78, 40960
ds_read_b64_tr_b16 v[88:89], v11 offset:32768
v_mfma_f32_16x16x32_bf16 v[128:131], v[68:71], v[36:39], v[128:131]
ds_read_b64_tr_b16 v[90:91], v11 offset:33792
v_mfma_f32_16x16x32_bf16 v[132:135], v[68:71], v[44:47], v[132:135]
buffer_store_dwordx4 v[24:27], v1, s[44:47], s80 offen sc1
v_mfma_f32_16x16x32_bf16 v[132:135], v[64:67], v[40:43], v[132:135]
s_add_u32 s72, s70, 144384
buffer_load_dwordx4 v5, s[4:7], s72 offen offset:3072 lds
v_mfma_f32_16x16x32_bf16 v[136:139], v[64:67], v[48:51], v[136:139]
ds_read_b64_tr_b16 v[92:93], v11 offset:40960
v_mfma_f32_16x16x32_bf16 v[136:139], v[68:71], v[52:55], v[136:139]
s_lshl_b32 s71, s73, 12
v_mfma_f32_16x16x32_bf16 v[140:143], v[68:71], v[60:63], v[140:143]
s_add_u32 s71, s71, s66
ds_read_b64_tr_b16 v[94:95], v11 offset:41984
v_mfma_f32_16x16x32_bf16 v[140:143], v[64:67], v[56:59], v[140:143]
s_waitcnt lgkmcnt(8)
v_accvgpr_read_b32 v20, a24
v_accvgpr_read_b32 v28, a25
v_mfma_f32_16x16x32_bf16 v[156:159], v[72:75], v[56:59], v[156:159]
s_add_u32 m0, s64, 16384
ds_read_b64_tr_b16 v[64:65], v12 offset:32768
v_accvgpr_read_b32 v21, a26
v_mfma_f32_16x16x32_bf16 v[156:159], v[76:79], v[60:63], v[156:159]
s_add_u32 s72, s71, 0
buffer_load_dwordx4 v6, s[12:15], s72 offen lds
v_mfma_f32_16x16x32_bf16 v[152:155], v[76:79], v[52:55], v[152:155]
s_add_u32 s73, s62, 5
ds_read_b64_tr_b16 v[66:67], v12 offset:33792
v_accvgpr_read_b32 v29, a27
v_mfma_f32_16x16x32_bf16 v[152:155], v[72:75], v[48:51], v[152:155]
s_add_u32 s70, s73, s65
v_accvgpr_read_b32 v22, a56
v_accvgpr_read_b32 v30, a57
v_mfma_f32_16x16x32_bf16 v[148:151], v[72:75], v[40:43], v[148:151]
s_and_b32 s70, s70, 3
ds_read_b64_tr_b16 v[68:69], v12 offset:40960
v_accvgpr_read_b32 v23, a58
v_mfma_f32_16x16x32_bf16 v[148:151], v[76:79], v[44:47], v[148:151]
s_and_b32 s73, s73, 12
ds_read_b64_tr_b16 v[70:71], v12 offset:41984
v_accvgpr_read_b32 v31, a59
v_mfma_f32_16x16x32_bf16 v[144:147], v[76:79], v[36:39], v[144:147]
s_add_u32 s72, s71, 31744
buffer_load_dwordx4 v6, s[12:15], s72 offen offset:1024 lds
v_mfma_f32_16x16x32_bf16 v[144:147], v[72:75], v[32:35], v[144:147]
s_waitcnt lgkmcnt(8)
v_mul_f32 v20, s79, v20
v_mul_f32 v28, s79, v28
v_mfma_f32_16x16x32_bf16 v[160:163], v[80:83], v[32:35], v[160:163]
s_or_b32 s73, s73, s70
ds_read_b64_tr_b16 v[72:73], v13 offset:32768
v_mul_f32 v21, s79, v21
v_mfma_f32_16x16x32_bf16 v[160:163], v[84:87], v[36:39], v[160:163]
s_lshl_b32 s73, s73, 7
ds_read_b64_tr_b16 v[74:75], v13 offset:33792
v_mul_f32 v29, s79, v29
v_mfma_f32_16x16x32_bf16 v[164:167], v[84:87], v[44:47], v[164:167]
s_add_u32 s69, s73, s67
v_mul_f32 v22, s79, v22
v_mul_f32 v30, s79, v30
v_mfma_f32_16x16x32_bf16 v[164:167], v[80:83], v[40:43], v[164:167]
s_add_u32 s72, s71, 63488
buffer_load_dwordx4 v7, s[12:15], s72 offen offset:2048 lds
v_mfma_f32_16x16x32_bf16 v[168:171], v[80:83], v[48:51], v[168:171]
s_waitcnt vmcnt(18)
ds_read_b64_tr_b16 v[76:77], v13 offset:40960
v_mul_f32 v23, s79, v23
v_mfma_f32_16x16x32_bf16 v[168:171], v[84:87], v[52:55], v[168:171]
s_add_u32 s70, s73, s68
ds_read_b128 v[96:99], v16 offset:0
v_mul_f32 v31, s79, v31
v_mfma_f32_16x16x32_bf16 v[172:175], v[84:87], v[60:63], v[172:175]
ds_read_b64_tr_b16 v[78:79], v13 offset:41984
v_cvt_pk_bf16_f32 v20, v20, v28
v_mfma_f32_16x16x32_bf16 v[172:175], v[80:83], v[56:59], v[172:175]
s_waitcnt lgkmcnt(9)
ds_read_b128 v[100:103], v17 offset:0
v_cvt_pk_bf16_f32 v21, v21, v29
v_mfma_f32_16x16x32_bf16 v[188:191], v[88:91], v[56:59], v[188:191]
s_add_u32 s72, s71, 95232
buffer_load_dwordx4 v7, s[12:15], s72 offen offset:3072 lds
v_mfma_f32_16x16x32_bf16 v[188:191], v[92:95], v[60:63], v[188:191]
ds_read_b64_tr_b16 v[80:81], v14 offset:32768
v_cvt_pk_bf16_f32 v22, v22, v30
v_mfma_f32_16x16x32_bf16 v[184:187], v[92:95], v[52:55], v[184:187]
ds_read_b64_tr_b16 v[82:83], v14 offset:33792
v_cvt_pk_bf16_f32 v23, v23, v31
v_mfma_f32_16x16x32_bf16 v[184:187], v[88:91], v[48:51], v[184:187]
s_add_u32 s80, s77, 40960
buffer_store_dwordx4 v[20:23], v1, s[44:47], s80 offen sc1
v_mfma_f32_16x16x32_bf16 v[180:183], v[88:91], v[40:43], v[180:183]
ds_read_b64_tr_b16 v[84:85], v14 offset:40960
v_mfma_f32_16x16x32_bf16 v[180:183], v[92:95], v[44:47], v[180:183]
s_add_u32 m0, s63, 98304
ds_read_b64_tr_b16 v[86:87], v14 offset:41984
v_accvgpr_read_b32 v24, a160
v_mfma_f32_16x16x32_bf16 v[176:179], v[92:95], v[36:39], v[176:179]
s_add_u32 s72, s69, 0
buffer_load_dwordx4 v4, s[4:7], s72 offen lds
v_mfma_f32_16x16x32_bf16 v[176:179], v[88:91], v[32:35], v[176:179]
s_waitcnt lgkmcnt(10)
ds_read_b128 v[104:107], v16 offset:2048
v_accvgpr_read_b32 v28, a161
v_mfma_f32_16x16x32_bf16 v[192:195], v[64:67], v[32:35], v[192:195]
ds_read_b64_tr_b16 v[88:89], v15 offset:32768
v_accvgpr_read_b32 v25, a162
v_mfma_f32_16x16x32_bf16 v[192:195], v[68:71], v[36:39], v[192:195]
ds_read_b64_tr_b16 v[90:91], v15 offset:33792
v_accvgpr_read_b32 v29, a163
v_mfma_f32_16x16x32_bf16 v[196:199], v[68:71], v[44:47], v[196:199]
ds_read_b64_tr_b16 v[92:93], v15 offset:40960
v_accvgpr_read_b32 v26, a164
v_mfma_f32_16x16x32_bf16 v[196:199], v[64:67], v[40:43], v[196:199]
s_add_u32 s72, s69, 15360
buffer_load_dwordx4 v5, s[4:7], s72 offen offset:1024 lds
v_mfma_f32_16x16x32_bf16 v[200:203], v[64:67], v[48:51], v[200:203]
ds_read_b64_tr_b16 v[94:95], v15 offset:41984
v_accvgpr_read_b32 v30, a165
v_mfma_f32_16x16x32_bf16 v[200:203], v[68:71], v[52:55], v[200:203]
ds_read_b128 v[108:111], v17 offset:2048
v_accvgpr_read_b32 v27, a166
v_mfma_f32_16x16x32_bf16 v[204:207], v[68:71], v[60:63], v[204:207]
v_accvgpr_read_b32 v31, a167
v_cvt_pk_bf16_f32 v24, v24, v28
v_mfma_f32_16x16x32_bf16 v[204:207], v[64:67], v[56:59], v[204:207]
s_waitcnt lgkmcnt(11)
ds_read_b128 v[112:115], v16 offset:4096
v_cvt_pk_bf16_f32 v25, v25, v29
v_mfma_f32_16x16x32_bf16 v[220:223], v[72:75], v[56:59], v[220:223]
s_add_u32 s72, s69, 129024
buffer_load_dwordx4 v4, s[4:7], s72 offen offset:2048 lds
v_mfma_f32_16x16x32_bf16 v[220:223], v[76:79], v[60:63], v[220:223]
v_cvt_pk_bf16_f32 v26, v26, v30
v_cvt_pk_bf16_f32 v27, v27, v31
v_mfma_f32_16x16x32_bf16 v[216:219], v[76:79], v[52:55], v[216:219]
s_waitcnt vmcnt(19) lgkmcnt(2)
ds_read_b128 v[116:119], v17 offset:4096
v_mfma_f32_16x16x32_bf16 v[216:219], v[72:75], v[48:51], v[216:219]
s_barrier
ds_read_b128 v[120:123], v16 offset:6144
v_mfma_f32_16x16x32_bf16 v[212:215], v[72:75], v[40:43], v[212:215]
s_add_u32 s80, s78, 1024
ds_read_b64_tr_b16 v[64:65], v8 offset:0
ds_read_b64_tr_b16 v[66:67], v8 offset:1024
v_mfma_f32_16x16x32_bf16 v[212:215], v[76:79], v[44:47], v[212:215]
ds_read_b64_tr_b16 v[68:69], v8 offset:8192
v_mfma_f32_16x16x32_bf16 v[208:211], v[76:79], v[36:39], v[208:211]
s_add_u32 s72, s69, 144384
buffer_load_dwordx4 v5, s[4:7], s72 offen offset:3072 lds
v_mfma_f32_16x16x32_bf16 v[208:211], v[72:75], v[32:35], v[208:211]
ds_read_b64_tr_b16 v[70:71], v8 offset:9216
v_mfma_f32_16x16x32_bf16 v[224:227], v[80:83], v[32:35], v[224:227]
ds_read_b64_tr_b16 v[72:73], v9 offset:0
v_mfma_f32_16x16x32_bf16 v[224:227], v[84:87], v[36:39], v[224:227]
ds_read_b64_tr_b16 v[74:75], v9 offset:1024
v_mfma_f32_16x16x32_bf16 v[228:231], v[84:87], v[44:47], v[228:231]
s_add_u32 m0, s63, 102400
buffer_store_dwordx4 v[24:27], v1, s[44:47], s80 offen sc1
v_mfma_f32_16x16x32_bf16 v[228:231], v[80:83], v[40:43], v[228:231]
s_add_u32 s72, s70, 0
buffer_load_dwordx4 v4, s[4:7], s72 offen lds
v_mfma_f32_16x16x32_bf16 v[232:235], v[80:83], v[48:51], v[232:235]
ds_read_b64_tr_b16 v[76:77], v9 offset:8192
v_accvgpr_read_b32 v20, a28
v_mfma_f32_16x16x32_bf16 v[232:235], v[84:87], v[52:55], v[232:235]
ds_read_b128 v[124:127], v17 offset:6144
v_accvgpr_read_b32 v28, a29
v_mfma_f32_16x16x32_bf16 v[236:239], v[84:87], v[60:63], v[236:239]
ds_read_b64_tr_b16 v[78:79], v9 offset:9216
v_accvgpr_read_b32 v21, a30
v_mfma_f32_16x16x32_bf16 v[236:239], v[80:83], v[56:59], v[236:239]
v_accvgpr_read_b32 v29, a31
v_accvgpr_read_b32 v22, a60
v_mfma_f32_16x16x32_bf16 v[252:255], v[88:91], v[56:59], v[252:255]
s_add_u32 s72, s70, 15360
buffer_load_dwordx4 v5, s[4:7], s72 offen offset:1024 lds
v_mfma_f32_16x16x32_bf16 v[252:255], v[92:95], v[60:63], v[252:255]
ds_read_b64_tr_b16 v[80:81], v10 offset:0
v_accvgpr_read_b32 v30, a61
v_mfma_f32_16x16x32_bf16 v[248:251], v[92:95], v[52:55], v[248:251]
ds_read_b64_tr_b16 v[82:83], v10 offset:1024
v_accvgpr_read_b32 v23, a62
v_mfma_f32_16x16x32_bf16 v[248:251], v[88:91], v[48:51], v[248:251]
v_accvgpr_read_b32 v31, a63
v_mul_f32 v20, s79, v20
v_mfma_f32_16x16x32_bf16 v[244:247], v[88:91], v[40:43], v[244:247]
ds_read_b64_tr_b16 v[84:85], v10 offset:8192
v_mul_f32 v28, s79, v28
v_mfma_f32_16x16x32_bf16 v[244:247], v[92:95], v[44:47], v[244:247]
ds_read_b64_tr_b16 v[86:87], v10 offset:9216
v_mul_f32 v21, s79, v21
v_mfma_f32_16x16x32_bf16 v[240:243], v[92:95], v[36:39], v[240:243]
s_add_u32 s72, s70, 129024
buffer_load_dwordx4 v4, s[4:7], s72 offen offset:2048 lds
v_mfma_f32_16x16x32_bf16 v[240:243], v[88:91], v[32:35], v[240:243]
s_waitcnt lgkmcnt(5)
v_mul_f32 v29, s79, v29
v_mul_f32 v22, s79, v22
v_mfma_f32_16x16x32_bf16 v[128:131], v[64:67], v[96:99], v[128:131]
ds_read_b64_tr_b16 v[88:89], v11 offset:0
v_mul_f32 v30, s79, v30
v_mfma_f32_16x16x32_bf16 v[128:131], v[68:71], v[100:103], v[128:131]
ds_read_b64_tr_b16 v[90:91], v11 offset:1024
v_mul_f32 v23, s79, v23
v_mfma_f32_16x16x32_bf16 v[132:135], v[68:71], v[108:111], v[132:135]
v_mul_f32 v31, s79, v31
v_cvt_pk_bf16_f32 v20, v20, v28
v_mfma_f32_16x16x32_bf16 v[132:135], v[64:67], v[104:107], v[132:135]
s_add_u32 s72, s70, 144384
buffer_load_dwordx4 v5, s[4:7], s72 offen offset:3072 lds
v_mfma_f32_16x16x32_bf16 v[136:139], v[64:67], v[112:115], v[136:139]
ds_read_b64_tr_b16 v[92:93], v11 offset:8192
v_cvt_pk_bf16_f32 v21, v21, v29
v_mfma_f32_16x16x32_bf16 v[136:139], v[68:71], v[116:119], v[136:139]
s_lshl_b32 s71, s73, 12
v_cvt_pk_bf16_f32 v22, v22, v30
v_cvt_pk_bf16_f32 v23, v23, v31
v_mfma_f32_16x16x32_bf16 v[140:143], v[68:71], v[124:127], v[140:143]
s_add_u32 s71, s71, s66
ds_read_b64_tr_b16 v[94:95], v11 offset:9216
v_mfma_f32_16x16x32_bf16 v[140:143], v[64:67], v[120:123], v[140:143]
s_waitcnt lgkmcnt(8)
v_mfma_f32_16x16x32_bf16 v[156:159], v[72:75], v[120:123], v[156:159]
s_add_u32 m0, s64, 32768
ds_read_b64_tr_b16 v[64:65], v12 offset:0
v_mfma_f32_16x16x32_bf16 v[156:159], v[76:79], v[124:127], v[156:159]
s_add_u32 s72, s71, 0
buffer_load_dwordx4 v6, s[12:15], s72 offen lds
v_mfma_f32_16x16x32_bf16 v[152:155], v[76:79], v[116:119], v[152:155]
s_add_u32 s73, s62, 6
ds_read_b64_tr_b16 v[66:67], v12 offset:1024
v_accvgpr_read_b32 v24, a168
v_mfma_f32_16x16x32_bf16 v[152:155], v[72:75], v[112:115], v[152:155]
s_add_u32 s70, s73, s65
v_accvgpr_read_b32 v28, a169
v_accvgpr_read_b32 v25, a170
v_mfma_f32_16x16x32_bf16 v[148:151], v[72:75], v[104:107], v[148:151]
s_and_b32 s70, s70, 3
ds_read_b64_tr_b16 v[68:69], v12 offset:8192
v_accvgpr_read_b32 v29, a171
v_mfma_f32_16x16x32_bf16 v[148:151], v[76:79], v[108:111], v[148:151]
s_and_b32 s73, s73, 12
ds_read_b64_tr_b16 v[70:71], v12 offset:9216
v_accvgpr_read_b32 v26, a172
v_mfma_f32_16x16x32_bf16 v[144:147], v[76:79], v[100:103], v[144:147]
s_add_u32 s72, s71, 31744
buffer_load_dwordx4 v6, s[12:15], s72 offen offset:1024 lds
v_mfma_f32_16x16x32_bf16 v[144:147], v[72:75], v[96:99], v[144:147]
s_waitcnt lgkmcnt(8)
v_accvgpr_read_b32 v30, a173
v_accvgpr_read_b32 v27, a174
v_mfma_f32_16x16x32_bf16 v[160:163], v[80:83], v[96:99], v[160:163]
s_or_b32 s73, s73, s70
ds_read_b64_tr_b16 v[72:73], v13 offset:0
v_accvgpr_read_b32 v31, a175
v_mfma_f32_16x16x32_bf16 v[160:163], v[84:87], v[100:103], v[160:163]
s_lshl_b32 s73, s73, 7
ds_read_b64_tr_b16 v[74:75], v13 offset:1024
v_cvt_pk_bf16_f32 v24, v24, v28
v_mfma_f32_16x16x32_bf16 v[164:167], v[84:87], v[108:111], v[164:167]
s_add_u32 s69, s73, s67
v_cvt_pk_bf16_f32 v25, v25, v29
v_cvt_pk_bf16_f32 v26, v26, v30
v_mfma_f32_16x16x32_bf16 v[164:167], v[80:83], v[104:107], v[164:167]
s_add_u32 s72, s71, 63488
buffer_load_dwordx4 v7, s[12:15], s72 offen offset:2048 lds
v_mfma_f32_16x16x32_bf16 v[168:171], v[80:83], v[112:115], v[168:171]
s_waitcnt vmcnt(17)
ds_read_b64_tr_b16 v[76:77], v13 offset:8192
v_cvt_pk_bf16_f32 v27, v27, v31
v_mfma_f32_16x16x32_bf16 v[168:171], v[84:87], v[116:119], v[168:171]
s_add_u32 s70, s73, s68
ds_read_b128 v[32:35], v18 offset:0
v_mfma_f32_16x16x32_bf16 v[172:175], v[84:87], v[124:127], v[172:175]
s_add_u32 s80, s77, 45056
ds_read_b64_tr_b16 v[78:79], v13 offset:9216
v_mfma_f32_16x16x32_bf16 v[172:175], v[80:83], v[120:123], v[172:175]
s_waitcnt lgkmcnt(9)
ds_read_b128 v[36:39], v19 offset:0
v_mfma_f32_16x16x32_bf16 v[188:191], v[88:91], v[120:123], v[188:191]
s_add_u32 s72, s71, 95232
buffer_load_dwordx4 v7, s[12:15], s72 offen offset:3072 lds
v_mfma_f32_16x16x32_bf16 v[188:191], v[92:95], v[124:127], v[188:191]
ds_read_b64_tr_b16 v[80:81], v14 offset:0
v_mfma_f32_16x16x32_bf16 v[184:187], v[92:95], v[116:119], v[184:187]
ds_read_b64_tr_b16 v[82:83], v14 offset:1024
v_mfma_f32_16x16x32_bf16 v[184:187], v[88:91], v[112:115], v[184:187]
buffer_store_dwordx4 v[20:23], v1, s[44:47], s80 offen sc1
v_mfma_f32_16x16x32_bf16 v[180:183], v[88:91], v[104:107], v[180:183]
s_add_u32 s80, s78, 9216
ds_read_b64_tr_b16 v[84:85], v14 offset:8192
v_mfma_f32_16x16x32_bf16 v[180:183], v[92:95], v[108:111], v[180:183]
s_add_u32 m0, s63, 131072
ds_read_b64_tr_b16 v[86:87], v14 offset:9216
v_mfma_f32_16x16x32_bf16 v[176:179], v[92:95], v[100:103], v[176:179]
s_add_u32 s72, s69, 0
buffer_load_dwordx4 v4, s[4:7], s72 offen lds
v_mfma_f32_16x16x32_bf16 v[176:179], v[88:91], v[96:99], v[176:179]
s_waitcnt lgkmcnt(10)
ds_read_b128 v[40:43], v18 offset:2048
v_accvgpr_read_b32 v20, a64
v_mfma_f32_16x16x32_bf16 v[192:195], v[64:67], v[96:99], v[192:195]
ds_read_b64_tr_b16 v[88:89], v15 offset:0
v_accvgpr_read_b32 v28, a65
v_mfma_f32_16x16x32_bf16 v[192:195], v[68:71], v[100:103], v[192:195]
ds_read_b64_tr_b16 v[90:91], v15 offset:1024
v_accvgpr_read_b32 v21, a66
v_mfma_f32_16x16x32_bf16 v[196:199], v[68:71], v[108:111], v[196:199]
ds_read_b64_tr_b16 v[92:93], v15 offset:8192
v_accvgpr_read_b32 v29, a67
v_mfma_f32_16x16x32_bf16 v[196:199], v[64:67], v[104:107], v[196:199]
s_add_u32 s72, s69, 15360
buffer_load_dwordx4 v5, s[4:7], s72 offen offset:1024 lds
v_mfma_f32_16x16x32_bf16 v[200:203], v[64:67], v[112:115], v[200:203]
ds_read_b64_tr_b16 v[94:95], v15 offset:9216
v_accvgpr_read_b32 v22, a96
v_mfma_f32_16x16x32_bf16 v[200:203], v[68:71], v[116:119], v[200:203]
ds_read_b128 v[44:47], v19 offset:2048
v_accvgpr_read_b32 v30, a97
v_mfma_f32_16x16x32_bf16 v[204:207], v[68:71], v[124:127], v[204:207]
buffer_store_dwordx4 v[24:27], v1, s[44:47], s80 offen sc1
v_mfma_f32_16x16x32_bf16 v[204:207], v[64:67], v[120:123], v[204:207]
s_waitcnt lgkmcnt(11)
ds_read_b128 v[48:51], v18 offset:4096
v_accvgpr_read_b32 v23, a98
v_mfma_f32_16x16x32_bf16 v[220:223], v[72:75], v[120:123], v[220:223]
s_add_u32 s72, s69, 129024
buffer_load_dwordx4 v4, s[4:7], s72 offen offset:2048 lds
v_mfma_f32_16x16x32_bf16 v[220:223], v[76:79], v[124:127], v[220:223]
v_accvgpr_read_b32 v31, a99
v_mul_f32 v20, s79, v20
v_mfma_f32_16x16x32_bf16 v[216:219], v[76:79], v[116:119], v[216:219]
s_waitcnt vmcnt(19) lgkmcnt(2)
ds_read_b128 v[52:55], v19 offset:4096
v_mul_f32 v28, s79, v28
v_mfma_f32_16x16x32_bf16 v[216:219], v[72:75], v[112:115], v[216:219]
s_barrier
ds_read_b128 v[56:59], v18 offset:6144
v_mul_f32 v21, s79, v21
v_mfma_f32_16x16x32_bf16 v[212:215], v[72:75], v[104:107], v[212:215]
ds_read_b64_tr_b16 v[64:65], v8 offset:16384
ds_read_b64_tr_b16 v[66:67], v8 offset:17408
v_mfma_f32_16x16x32_bf16 v[212:215], v[76:79], v[108:111], v[212:215]
ds_read_b64_tr_b16 v[68:69], v8 offset:24576
v_mul_f32 v29, s79, v29
v_mfma_f32_16x16x32_bf16 v[208:211], v[76:79], v[100:103], v[208:211]
s_add_u32 s72, s69, 144384
buffer_load_dwordx4 v5, s[4:7], s72 offen offset:3072 lds
v_mfma_f32_16x16x32_bf16 v[208:211], v[72:75], v[96:99], v[208:211]
ds_read_b64_tr_b16 v[70:71], v8 offset:25600
v_mul_f32 v22, s79, v22
v_mfma_f32_16x16x32_bf16 v[224:227], v[80:83], v[96:99], v[224:227]
ds_read_b64_tr_b16 v[72:73], v9 offset:16384
v_mul_f32 v30, s79, v30
v_mfma_f32_16x16x32_bf16 v[224:227], v[84:87], v[100:103], v[224:227]
ds_read_b64_tr_b16 v[74:75], v9 offset:17408
v_mul_f32 v23, s79, v23
v_mfma_f32_16x16x32_bf16 v[228:231], v[84:87], v[108:111], v[228:231]
s_add_u32 m0, s63, 135168
v_mul_f32 v31, s79, v31
v_cvt_pk_bf16_f32 v20, v20, v28
v_mfma_f32_16x16x32_bf16 v[228:231], v[80:83], v[104:107], v[228:231]
s_add_u32 s72, s70, 0
buffer_load_dwordx4 v4, s[4:7], s72 offen lds
v_mfma_f32_16x16x32_bf16 v[232:235], v[80:83], v[112:115], v[232:235]
ds_read_b64_tr_b16 v[76:77], v9 offset:24576
v_cvt_pk_bf16_f32 v21, v21, v29
v_mfma_f32_16x16x32_bf16 v[232:235], v[84:87], v[116:119], v[232:235]
ds_read_b128 v[60:63], v19 offset:6144
v_cvt_pk_bf16_f32 v22, v22, v30
v_mfma_f32_16x16x32_bf16 v[236:239], v[84:87], v[124:127], v[236:239]
ds_read_b64_tr_b16 v[78:79], v9 offset:25600
v_cvt_pk_bf16_f32 v23, v23, v31
v_mfma_f32_16x16x32_bf16 v[236:239], v[80:83], v[120:123], v[236:239]
s_add_u32 s80, s77, 1024
buffer_store_dwordx4 v[20:23], v1, s[44:47], s80 offen sc1
v_mfma_f32_16x16x32_bf16 v[252:255], v[88:91], v[120:123], v[252:255]
s_add_u32 s72, s70, 15360
buffer_load_dwordx4 v5, s[4:7], s72 offen offset:1024 lds
v_mfma_f32_16x16x32_bf16 v[252:255], v[92:95], v[124:127], v[252:255]
ds_read_b64_tr_b16 v[80:81], v10 offset:16384
v_accvgpr_read_b32 v24, a176
v_mfma_f32_16x16x32_bf16 v[248:251], v[92:95], v[116:119], v[248:251]
ds_read_b64_tr_b16 v[82:83], v10 offset:17408
v_accvgpr_read_b32 v28, a177
v_mfma_f32_16x16x32_bf16 v[248:251], v[88:91], v[112:115], v[248:251]
v_accvgpr_read_b32 v25, a178
v_accvgpr_read_b32 v29, a179
v_mfma_f32_16x16x32_bf16 v[244:247], v[88:91], v[104:107], v[244:247]
ds_read_b64_tr_b16 v[84:85], v10 offset:24576
v_accvgpr_read_b32 v26, a180
v_mfma_f32_16x16x32_bf16 v[244:247], v[92:95], v[108:111], v[244:247]
ds_read_b64_tr_b16 v[86:87], v10 offset:25600
v_accvgpr_read_b32 v30, a181
v_mfma_f32_16x16x32_bf16 v[240:243], v[92:95], v[100:103], v[240:243]
s_add_u32 s72, s70, 129024
buffer_load_dwordx4 v4, s[4:7], s72 offen offset:2048 lds
v_mfma_f32_16x16x32_bf16 v[240:243], v[88:91], v[96:99], v[240:243]
s_waitcnt lgkmcnt(5)
v_accvgpr_read_b32 v27, a182
v_accvgpr_read_b32 v31, a183
v_mfma_f32_16x16x32_bf16 v[128:131], v[64:67], v[32:35], v[128:131]
ds_read_b64_tr_b16 v[88:89], v11 offset:16384
v_cvt_pk_bf16_f32 v24, v24, v28
v_mfma_f32_16x16x32_bf16 v[128:131], v[68:71], v[36:39], v[128:131]
ds_read_b64_tr_b16 v[90:91], v11 offset:17408
v_cvt_pk_bf16_f32 v25, v25, v29
v_mfma_f32_16x16x32_bf16 v[132:135], v[68:71], v[44:47], v[132:135]
v_cvt_pk_bf16_f32 v26, v26, v30
v_cvt_pk_bf16_f32 v27, v27, v31
v_mfma_f32_16x16x32_bf16 v[132:135], v[64:67], v[40:43], v[132:135]
s_add_u32 s72, s70, 144384
buffer_load_dwordx4 v5, s[4:7], s72 offen offset:3072 lds
v_mfma_f32_16x16x32_bf16 v[136:139], v[64:67], v[48:51], v[136:139]
s_add_u32 s80, s78, 33792
ds_read_b64_tr_b16 v[92:93], v11 offset:24576
v_mfma_f32_16x16x32_bf16 v[136:139], v[68:71], v[52:55], v[136:139]
s_lshl_b32 s71, s73, 12
buffer_store_dwordx4 v[24:27], v1, s[44:47], s80 offen sc1
v_mfma_f32_16x16x32_bf16 v[140:143], v[68:71], v[60:63], v[140:143]
s_add_u32 s71, s71, s66
ds_read_b64_tr_b16 v[94:95], v11 offset:25600
v_mfma_f32_16x16x32_bf16 v[140:143], v[64:67], v[56:59], v[140:143]
s_waitcnt lgkmcnt(8)
v_mfma_f32_16x16x32_bf16 v[156:159], v[72:75], v[56:59], v[156:159]
s_add_u32 m0, s64, 0
ds_read_b64_tr_b16 v[64:65], v12 offset:16384
v_mfma_f32_16x16x32_bf16 v[156:159], v[76:79], v[60:63], v[156:159]
s_add_u32 s72, s71, 0
buffer_load_dwordx4 v6, s[12:15], s72 offen lds
v_mfma_f32_16x16x32_bf16 v[152:155], v[76:79], v[52:55], v[152:155]
s_add_u32 s73, s62, 7
ds_read_b64_tr_b16 v[66:67], v12 offset:17408
v_mfma_f32_16x16x32_bf16 v[152:155], v[72:75], v[48:51], v[152:155]
s_add_u32 s70, s73, s65
v_mfma_f32_16x16x32_bf16 v[148:151], v[72:75], v[40:43], v[148:151]
s_and_b32 s70, s70, 3
ds_read_b64_tr_b16 v[68:69], v12 offset:24576
v_accvgpr_read_b32 v20, a68
v_mfma_f32_16x16x32_bf16 v[148:151], v[76:79], v[44:47], v[148:151]
s_and_b32 s73, s73, 12
ds_read_b64_tr_b16 v[70:71], v12 offset:25600
v_accvgpr_read_b32 v28, a69
v_mfma_f32_16x16x32_bf16 v[144:147], v[76:79], v[36:39], v[144:147]
s_add_u32 s72, s71, 31744
buffer_load_dwordx4 v6, s[12:15], s72 offen offset:1024 lds
v_mfma_f32_16x16x32_bf16 v[144:147], v[72:75], v[32:35], v[144:147]
s_waitcnt lgkmcnt(8)
v_accvgpr_read_b32 v21, a70
v_accvgpr_read_b32 v29, a71
v_mfma_f32_16x16x32_bf16 v[160:163], v[80:83], v[32:35], v[160:163]
s_or_b32 s73, s73, s70
ds_read_b64_tr_b16 v[72:73], v13 offset:16384
v_accvgpr_read_b32 v22, a100
v_mfma_f32_16x16x32_bf16 v[160:163], v[84:87], v[36:39], v[160:163]
s_lshl_b32 s73, s73, 7
ds_read_b64_tr_b16 v[74:75], v13 offset:17408
v_accvgpr_read_b32 v30, a101
v_mfma_f32_16x16x32_bf16 v[164:167], v[84:87], v[44:47], v[164:167]
s_add_u32 s69, s73, s67
v_accvgpr_read_b32 v23, a102
v_accvgpr_read_b32 v31, a103
v_mfma_f32_16x16x32_bf16 v[164:167], v[80:83], v[40:43], v[164:167]
s_add_u32 s72, s71, 63488
buffer_load_dwordx4 v7, s[12:15], s72 offen offset:2048 lds
v_mfma_f32_16x16x32_bf16 v[168:171], v[80:83], v[48:51], v[168:171]
s_waitcnt vmcnt(19)
ds_read_b64_tr_b16 v[76:77], v13 offset:24576
v_mul_f32 v20, s79, v20
v_mfma_f32_16x16x32_bf16 v[168:171], v[84:87], v[52:55], v[168:171]
s_add_u32 s70, s73, s68
ds_read_b128 v[96:99], v18 offset:32768
v_mul_f32 v28, s79, v28
v_mfma_f32_16x16x32_bf16 v[172:175], v[84:87], v[60:63], v[172:175]
ds_read_b64_tr_b16 v[78:79], v13 offset:25600
v_mul_f32 v21, s79, v21
v_mfma_f32_16x16x32_bf16 v[172:175], v[80:83], v[56:59], v[172:175]
s_waitcnt lgkmcnt(9)
ds_read_b128 v[100:103], v19 offset:32768
v_mul_f32 v29, s79, v29
v_mfma_f32_16x16x32_bf16 v[188:191], v[88:91], v[56:59], v[188:191]
s_add_u32 s72, s71, 95232
buffer_load_dwordx4 v7, s[12:15], s72 offen offset:3072 lds
v_mfma_f32_16x16x32_bf16 v[188:191], v[92:95], v[60:63], v[188:191]
ds_read_b64_tr_b16 v[80:81], v14 offset:16384
v_mul_f32 v22, s79, v22
v_mfma_f32_16x16x32_bf16 v[184:187], v[92:95], v[52:55], v[184:187]
ds_read_b64_tr_b16 v[82:83], v14 offset:17408
v_mul_f32 v30, s79, v30
v_mfma_f32_16x16x32_bf16 v[184:187], v[88:91], v[48:51], v[184:187]
v_mul_f32 v23, s79, v23
v_mul_f32 v31, s79, v31
v_mfma_f32_16x16x32_bf16 v[180:183], v[88:91], v[40:43], v[180:183]
ds_read_b64_tr_b16 v[84:85], v14 offset:24576
v_cvt_pk_bf16_f32 v20, v20, v28
v_mfma_f32_16x16x32_bf16 v[180:183], v[92:95], v[44:47], v[180:183]
s_add_u32 m0, s63, 65536
ds_read_b64_tr_b16 v[86:87], v14 offset:25600
v_cvt_pk_bf16_f32 v21, v21, v29
v_mfma_f32_16x16x32_bf16 v[176:179], v[92:95], v[36:39], v[176:179]
s_add_u32 s72, s69, 0
buffer_load_dwordx4 v4, s[4:7], s72 offen lds
v_mfma_f32_16x16x32_bf16 v[176:179], v[88:91], v[32:35], v[176:179]
s_waitcnt lgkmcnt(10)
ds_read_b128 v[104:107], v18 offset:34816
v_cvt_pk_bf16_f32 v22, v22, v30
v_mfma_f32_16x16x32_bf16 v[192:195], v[64:67], v[32:35], v[192:195]
ds_read_b64_tr_b16 v[88:89], v15 offset:16384
v_cvt_pk_bf16_f32 v23, v23, v31
v_mfma_f32_16x16x32_bf16 v[192:195], v[68:71], v[36:39], v[192:195]
s_add_u32 s80, s77, 5120
ds_read_b64_tr_b16 v[90:91], v15 offset:17408
v_mfma_f32_16x16x32_bf16 v[196:199], v[68:71], v[44:47], v[196:199]
ds_read_b64_tr_b16 v[92:93], v15 offset:24576
v_accvgpr_read_b32 v24, a184
v_mfma_f32_16x16x32_bf16 v[196:199], v[64:67], v[40:43], v[196:199]
s_add_u32 s72, s69, 15360
buffer_load_dwordx4 v5, s[4:7], s72 offen offset:1024 lds
v_mfma_f32_16x16x32_bf16 v[200:203], v[64:67], v[48:51], v[200:203]
ds_read_b64_tr_b16 v[94:95], v15 offset:25600
v_accvgpr_read_b32 v28, a185
v_mfma_f32_16x16x32_bf16 v[200:203], v[68:71], v[52:55], v[200:203]
ds_read_b128 v[108:111], v19 offset:34816
v_accvgpr_read_b32 v25, a186
v_mfma_f32_16x16x32_bf16 v[204:207], v[68:71], v[60:63], v[204:207]
buffer_store_dwordx4 v[20:23], v1, s[44:47], s80 offen sc1
v_mfma_f32_16x16x32_bf16 v[204:207], v[64:67], v[56:59], v[204:207]
s_waitcnt lgkmcnt(11)
ds_read_b128 v[112:115], v18 offset:36864
v_accvgpr_read_b32 v29, a187
v_mfma_f32_16x16x32_bf16 v[220:223], v[72:75], v[56:59], v[220:223]
s_add_u32 s72, s69, 129024
buffer_load_dwordx4 v4, s[4:7], s72 offen offset:2048 lds
v_mfma_f32_16x16x32_bf16 v[220:223], v[76:79], v[60:63], v[220:223]
v_accvgpr_read_b32 v26, a188
v_accvgpr_read_b32 v30, a189
v_mfma_f32_16x16x32_bf16 v[216:219], v[76:79], v[52:55], v[216:219]
s_waitcnt vmcnt(20) lgkmcnt(2)
ds_read_b128 v[116:119], v19 offset:36864
v_accvgpr_read_b32 v27, a190
v_mfma_f32_16x16x32_bf16 v[216:219], v[72:75], v[48:51], v[216:219]
s_barrier
ds_read_b128 v[120:123], v18 offset:38912
v_accvgpr_read_b32 v31, a191
v_mfma_f32_16x16x32_bf16 v[212:215], v[72:75], v[40:43], v[212:215]
ds_read_b64_tr_b16 v[64:65], v8 offset:32768
ds_read_b64_tr_b16 v[66:67], v8 offset:33792
v_mfma_f32_16x16x32_bf16 v[212:215], v[76:79], v[44:47], v[212:215]
ds_read_b64_tr_b16 v[68:69], v8 offset:40960
v_cvt_pk_bf16_f32 v24, v24, v28
v_mfma_f32_16x16x32_bf16 v[208:211], v[76:79], v[36:39], v[208:211]
s_add_u32 s72, s69, 144384
buffer_load_dwordx4 v5, s[4:7], s72 offen offset:3072 lds
v_mfma_f32_16x16x32_bf16 v[208:211], v[72:75], v[32:35], v[208:211]
ds_read_b64_tr_b16 v[70:71], v8 offset:41984
v_cvt_pk_bf16_f32 v25, v25, v29
v_mfma_f32_16x16x32_bf16 v[224:227], v[80:83], v[32:35], v[224:227]
ds_read_b64_tr_b16 v[72:73], v9 offset:32768
v_cvt_pk_bf16_f32 v26, v26, v30
v_mfma_f32_16x16x32_bf16 v[224:227], v[84:87], v[36:39], v[224:227]
ds_read_b64_tr_b16 v[74:75], v9 offset:33792
v_cvt_pk_bf16_f32 v27, v27, v31
v_mfma_f32_16x16x32_bf16 v[228:231], v[84:87], v[44:47], v[228:231]
s_add_u32 m0, s63, 69632
v_mfma_f32_16x16x32_bf16 v[228:231], v[80:83], v[40:43], v[228:231]
s_add_u32 s72, s70, 0
buffer_load_dwordx4 v4, s[4:7], s72 offen lds
v_mfma_f32_16x16x32_bf16 v[232:235], v[80:83], v[48:51], v[232:235]
s_add_u32 s80, s78, 41984
ds_read_b64_tr_b16 v[76:77], v9 offset:40960
v_mfma_f32_16x16x32_bf16 v[232:235], v[84:87], v[52:55], v[232:235]
ds_read_b128 v[124:127], v19 offset:38912
v_mfma_f32_16x16x32_bf16 v[236:239], v[84:87], v[60:63], v[236:239]
ds_read_b64_tr_b16 v[78:79], v9 offset:41984
v_mfma_f32_16x16x32_bf16 v[236:239], v[80:83], v[56:59], v[236:239]
buffer_store_dwordx4 v[24:27], v1, s[44:47], s80 offen sc1
v_mfma_f32_16x16x32_bf16 v[252:255], v[88:91], v[56:59], v[252:255]
s_add_u32 s72, s70, 15360
buffer_load_dwordx4 v5, s[4:7], s72 offen offset:1024 lds
v_mfma_f32_16x16x32_bf16 v[252:255], v[92:95], v[60:63], v[252:255]
ds_read_b64_tr_b16 v[80:81], v10 offset:32768
v_accvgpr_read_b32 v20, a72
v_mfma_f32_16x16x32_bf16 v[248:251], v[92:95], v[52:55], v[248:251]
ds_read_b64_tr_b16 v[82:83], v10 offset:33792
v_accvgpr_read_b32 v28, a73
v_mfma_f32_16x16x32_bf16 v[248:251], v[88:91], v[48:51], v[248:251]
v_accvgpr_read_b32 v21, a74
v_accvgpr_read_b32 v29, a75
v_mfma_f32_16x16x32_bf16 v[244:247], v[88:91], v[40:43], v[244:247]
ds_read_b64_tr_b16 v[84:85], v10 offset:40960
v_accvgpr_read_b32 v22, a104
v_mfma_f32_16x16x32_bf16 v[244:247], v[92:95], v[44:47], v[244:247]
ds_read_b64_tr_b16 v[86:87], v10 offset:41984
v_accvgpr_read_b32 v30, a105
v_mfma_f32_16x16x32_bf16 v[240:243], v[92:95], v[36:39], v[240:243]
s_add_u32 s72, s70, 129024
buffer_load_dwordx4 v4, s[4:7], s72 offen offset:2048 lds
v_mfma_f32_16x16x32_bf16 v[240:243], v[88:91], v[32:35], v[240:243]
s_waitcnt lgkmcnt(5)
v_accvgpr_read_b32 v23, a106
v_accvgpr_read_b32 v31, a107
v_mfma_f32_16x16x32_bf16 v[128:131], v[64:67], v[96:99], v[128:131]
s_lshr_b32 s75, s93, 4
ds_read_b64_tr_b16 v[88:89], v11 offset:32768
v_mul_f32 v20, s79, v20
v_mfma_f32_16x16x32_bf16 v[128:131], v[68:71], v[100:103], v[128:131]
s_and_b32 s75, s75, 0x7f00
ds_read_b64_tr_b16 v[90:91], v11 offset:33792
v_mul_f32 v28, s79, v28
v_mfma_f32_16x16x32_bf16 v[132:135], v[68:71], v[108:111], v[132:135]
s_add_u32 s75, s75, LcB1-Lpc0
v_lshrrev_b32 v2, 5, v0
v_lshlrev_b32 v2, 7, v2
v_mfma_f32_16x16x32_bf16 v[132:135], v[64:67], v[104:107], v[132:135]
s_add_u32 s72, s70, 144384
buffer_load_dwordx4 v5, s[4:7], s72 offen offset:3072 lds
v_mfma_f32_16x16x32_bf16 v[136:139], v[64:67], v[112:115], v[136:139]
v_add_u32 v2, s75, v2
v_min_u32 v2, Lcode_end-Lpc0, v2
v_mfma_f32_16x16x32_bf16 v[136:139], v[68:71], v[116:119], v[136:139]
s_lshl_b32 s71, s73, 12
global_load_dword v3, v2, s[98:99]
v_mfma_f32_16x16x32_bf16 v[140:143], v[68:71], v[124:127], v[140:143]
s_add_u32 s71, s71, s66
ds_read_b64_tr_b16 v[92:93], v11 offset:40960
v_mul_f32 v21, s79, v21
v_mfma_f32_16x16x32_bf16 v[140:143], v[64:67], v[120:123], v[140:143]
s_waitcnt lgkmcnt(7)
ds_read_b64_tr_b16 v[94:95], v11 offset:41984
v_mul_f32 v29, s79, v29
v_mfma_f32_16x16x32_bf16 v[156:159], v[72:75], v[120:123], v[156:159]
s_add_u32 m0, s64, 16384
ds_read_b64_tr_b16 v[64:65], v12 offset:32768
v_mul_f32 v22, s79, v22
v_mfma_f32_16x16x32_bf16 v[156:159], v[76:79], v[124:127], v[156:159]
s_add_u32 s72, s71, 0
buffer_load_dwordx4 v6, s[12:15], s72 offen lds
v_mfma_f32_16x16x32_bf16 v[152:155], v[76:79], v[116:119], v[152:155]
s_add_u32 s73, s62, 8
ds_read_b64_tr_b16 v[66:67], v12 offset:33792
v_mul_f32 v30, s79, v30
v_mfma_f32_16x16x32_bf16 v[152:155], v[72:75], v[112:115], v[152:155]
s_add_u32 s70, s73, s65
v_mul_f32 v23, s79, v23
v_mul_f32 v31, s79, v31
v_mfma_f32_16x16x32_bf16 v[148:151], v[72:75], v[104:107], v[148:151]
s_and_b32 s70, s70, 3
ds_read_b64_tr_b16 v[68:69], v12 offset:40960
v_cvt_pk_bf16_f32 v20, v20, v28
v_mfma_f32_16x16x32_bf16 v[148:151], v[76:79], v[108:111], v[148:151]
s_and_b32 s73, s73, 12
ds_read_b64_tr_b16 v[70:71], v12 offset:41984
v_cvt_pk_bf16_f32 v21, v21, v29
v_mfma_f32_16x16x32_bf16 v[144:147], v[76:79], v[100:103], v[144:147]
s_add_u32 s72, s71, 31744
buffer_load_dwordx4 v6, s[12:15], s72 offen offset:1024 lds
v_mfma_f32_16x16x32_bf16 v[144:147], v[72:75], v[96:99], v[144:147]
s_waitcnt lgkmcnt(8)
v_cvt_pk_bf16_f32 v22, v22, v30
v_cvt_pk_bf16_f32 v23, v23, v31
v_mfma_f32_16x16x32_bf16 v[160:163], v[80:83], v[96:99], v[160:163]
s_or_b32 s73, s73, s70
ds_read_b64_tr_b16 v[72:73], v13 offset:32768
v_accvgpr_read_b32 v24, a192
v_mfma_f32_16x16x32_bf16 v[160:163], v[84:87], v[100:103], v[160:163]
s_lshl_b32 s73, s73, 7
ds_read_b64_tr_b16 v[74:75], v13 offset:33792
v_accvgpr_read_b32 v28, a193
v_mfma_f32_16x16x32_bf16 v[164:167], v[84:87], v[108:111], v[164:167]
s_add_u32 s69, s73, s67
v_accvgpr_read_b32 v25, a194
v_accvgpr_read_b32 v29, a195
v_mfma_f32_16x16x32_bf16 v[164:167], v[80:83], v[104:107], v[164:167]
s_add_u32 s72, s71, 63488
buffer_load_dwordx4 v7, s[12:15], s72 offen offset:2048 lds
v_mfma_f32_16x16x32_bf16 v[168:171], v[80:83], v[112:115], v[168:171]
s_waitcnt vmcnt(19)
ds_read_b64_tr_b16 v[76:77], v13 offset:40960
v_accvgpr_read_b32 v26, a196
v_mfma_f32_16x16x32_bf16 v[168:171], v[84:87], v[116:119], v[168:171]
s_add_u32 s70, s73, s68
ds_read_b128 v[32:35], v16 offset:0
v_accvgpr_read_b32 v30, a197
v_mfma_f32_16x16x32_bf16 v[172:175], v[84:87], v[124:127], v[172:175]
s_add_u32 s80, s77, 9216
ds_read_b64_tr_b16 v[78:79], v13 offset:41984
v_accvgpr_read_b32 v27, a198
v_mfma_f32_16x16x32_bf16 v[172:175], v[80:83], v[120:123], v[172:175]
s_waitcnt lgkmcnt(9)
ds_read_b128 v[36:39], v17 offset:0
v_accvgpr_read_b32 v31, a199
v_mfma_f32_16x16x32_bf16 v[188:191], v[88:91], v[120:123], v[188:191]
s_add_u32 s72, s71, 95232
buffer_load_dwordx4 v7, s[12:15], s72 offen offset:3072 lds
v_mfma_f32_16x16x32_bf16 v[188:191], v[92:95], v[124:127], v[188:191]
ds_read_b64_tr_b16 v[80:81], v14 offset:32768
v_cvt_pk_bf16_f32 v24, v24, v28
v_mfma_f32_16x16x32_bf16 v[184:187], v[92:95], v[116:119], v[184:187]
ds_read_b64_tr_b16 v[82:83], v14 offset:33792
v_cvt_pk_bf16_f32 v25, v25, v29
v_mfma_f32_16x16x32_bf16 v[184:187], v[88:91], v[112:115], v[184:187]
buffer_store_dwordx4 v[20:23], v1, s[44:47], s80 offen sc1
v_mfma_f32_16x16x32_bf16 v[180:183], v[88:91], v[104:107], v[180:183]
ds_read_b64_tr_b16 v[84:85], v14 offset:40960
v_cvt_pk_bf16_f32 v26, v26, v30
v_mfma_f32_16x16x32_bf16 v[180:183], v[92:95], v[108:111], v[180:183]
s_add_u32 m0, s63, 98304
ds_read_b64_tr_b16 v[86:87], v14 offset:41984
v_cvt_pk_bf16_f32 v27, v27, v31
v_mfma_f32_16x16x32_bf16 v[176:179], v[92:95], v[100:103], v[176:179]
s_add_u32 s72, s69, 0
buffer_load_dwordx4 v4, s[4:7], s72 offen lds
v_mfma_f32_16x16x32_bf16 v[176:179], v[88:91], v[96:99], v[176:179]
s_waitcnt lgkmcnt(10)
ds_read_b128 v[40:43], v16 offset:2048
v_mfma_f32_16x16x32_bf16 v[192:195], v[64:67], v[96:99], v[192:195]
s_add_u32 s80, s78, 2048
ds_read_b64_tr_b16 v[88:89], v15 offset:32768
v_mfma_f32_16x16x32_bf16 v[192:195], v[68:71], v[100:103], v[192:195]
ds_read_b64_tr_b16 v[90:91], v15 offset:33792
v_mfma_f32_16x16x32_bf16 v[196:199], v[68:71], v[108:111], v[196:199]
ds_read_b64_tr_b16 v[92:93], v15 offset:40960
v_mfma_f32_16x16x32_bf16 v[196:199], v[64:67], v[104:107], v[196:199]
s_add_u32 s72, s69, 15360
buffer_load_dwordx4 v5, s[4:7], s72 offen offset:1024 lds
v_mfma_f32_16x16x32_bf16 v[200:203], v[64:67], v[112:115], v[200:203]
ds_read_b64_tr_b16 v[94:95], v15 offset:41984
v_accvgpr_read_b32 v20, a76
v_mfma_f32_16x16x32_bf16 v[200:203], v[68:71], v[116:119], v[200:203]
ds_read_b128 v[44:47], v17 offset:2048
v_accvgpr_read_b32 v28, a77
v_mfma_f32_16x16x32_bf16 v[204:207], v[68:71], v[124:127], v[204:207]
buffer_store_dwordx4 v[24:27], v1, s[44:47], s80 offen sc1
v_mfma_f32_16x16x32_bf16 v[204:207], v[64:67], v[120:123], v[204:207]
s_waitcnt lgkmcnt(11)
ds_read_b128 v[48:51], v16 offset:4096
v_accvgpr_read_b32 v21, a78
v_mfma_f32_16x16x32_bf16 v[220:223], v[72:75], v[120:123], v[220:223]
s_add_u32 s72, s69, 129024
buffer_load_dwordx4 v4, s[4:7], s72 offen offset:2048 lds
v_mfma_f32_16x16x32_bf16 v[220:223], v[76:79], v[124:127], v[220:223]
v_accvgpr_read_b32 v29, a79
v_accvgpr_read_b32 v22, a108
v_mfma_f32_16x16x32_bf16 v[216:219], v[76:79], v[116:119], v[216:219]
s_waitcnt vmcnt(20) lgkmcnt(2)
ds_read_b128 v[52:55], v17 offset:4096
v_accvgpr_read_b32 v30, a109
v_mfma_f32_16x16x32_bf16 v[216:219], v[72:75], v[112:115], v[216:219]
s_barrier
ds_read_b128 v[56:59], v16 offset:6144
v_accvgpr_read_b32 v23, a110
v_mfma_f32_16x16x32_bf16 v[212:215], v[72:75], v[104:107], v[212:215]
ds_read_b64_tr_b16 v[64:65], v8 offset:0
ds_read_b64_tr_b16 v[66:67], v8 offset:1024
v_mfma_f32_16x16x32_bf16 v[212:215], v[76:79], v[108:111], v[212:215]
ds_read_b64_tr_b16 v[68:69], v8 offset:8192
v_accvgpr_read_b32 v31, a111
v_mfma_f32_16x16x32_bf16 v[208:211], v[76:79], v[100:103], v[208:211]
s_add_u32 s72, s69, 144384
buffer_load_dwordx4 v5, s[4:7], s72 offen offset:3072 lds
v_mfma_f32_16x16x32_bf16 v[208:211], v[72:75], v[96:99], v[208:211]
ds_read_b64_tr_b16 v[70:71], v8 offset:9216
v_mul_f32 v20, s79, v20
v_mfma_f32_16x16x32_bf16 v[224:227], v[80:83], v[96:99], v[224:227]
ds_read_b64_tr_b16 v[72:73], v9 offset:0
v_mul_f32 v28, s79, v28
v_mfma_f32_16x16x32_bf16 v[224:227], v[84:87], v[100:103], v[224:227]
ds_read_b64_tr_b16 v[74:75], v9 offset:1024
v_mul_f32 v21, s79, v21
v_mfma_f32_16x16x32_bf16 v[228:231], v[84:87], v[108:111], v[228:231]
s_add_u32 m0, s63, 102400
v_mul_f32 v29, s79, v29
v_mul_f32 v22, s79, v22
v_mfma_f32_16x16x32_bf16 v[228:231], v[80:83], v[104:107], v[228:231]
s_add_u32 s72, s70, 0
buffer_load_dwordx4 v4, s[4:7], s72 offen lds
v_mfma_f32_16x16x32_bf16 v[232:235], v[80:83], v[112:115], v[232:235]
ds_read_b64_tr_b16 v[76:77], v9 offset:8192
v_mul_f32 v30, s79, v30
v_mfma_f32_16x16x32_bf16 v[232:235], v[84:87], v[116:119], v[232:235]
ds_read_b128 v[60:63], v17 offset:6144
v_mul_f32 v23, s79, v23
v_mfma_f32_16x16x32_bf16 v[236:239], v[84:87], v[124:127], v[236:239]
ds_read_b64_tr_b16 v[78:79], v9 offset:9216
v_mul_f32 v31, s79, v31
v_mfma_f32_16x16x32_bf16 v[236:239], v[80:83], v[120:123], v[236:239]
v_cvt_pk_bf16_f32 v20, v20, v28
v_cvt_pk_bf16_f32 v21, v21, v29
v_mfma_f32_16x16x32_bf16 v[252:255], v[88:91], v[120:123], v[252:255]
s_add_u32 s72, s70, 15360
buffer_load_dwordx4 v5, s[4:7], s72 offen offset:1024 lds
v_mfma_f32_16x16x32_bf16 v[252:255], v[92:95], v[124:127], v[252:255]
ds_read_b64_tr_b16 v[80:81], v10 offset:0
v_cvt_pk_bf16_f32 v22, v22, v30
v_mfma_f32_16x16x32_bf16 v[248:251], v[92:95], v[116:119], v[248:251]
ds_read_b64_tr_b16 v[82:83], v10 offset:1024
v_cvt_pk_bf16_f32 v23, v23, v31
v_mfma_f32_16x16x32_bf16 v[248:251], v[88:91], v[112:115], v[248:251]
s_add_u32 s80, s77, 13312
buffer_store_dwordx4 v[20:23], v1, s[44:47], s80 offen sc1
v_mfma_f32_16x16x32_bf16 v[244:247], v[88:91], v[104:107], v[244:247]
ds_read_b64_tr_b16 v[84:85], v10 offset:8192
v_accvgpr_read_b32 v24, a200
v_mfma_f32_16x16x32_bf16 v[244:247], v[92:95], v[108:111], v[244:247]
ds_read_b64_tr_b16 v[86:87], v10 offset:9216
v_accvgpr_read_b32 v28, a201
v_mfma_f32_16x16x32_bf16 v[240:243], v[92:95], v[100:103], v[240:243]
s_add_u32 s72, s70, 129024
buffer_load_dwordx4 v4, s[4:7], s72 offen offset:2048 lds
v_mfma_f32_16x16x32_bf16 v[240:243], v[88:91], v[96:99], v[240:243]
s_waitcnt lgkmcnt(5)
v_accvgpr_read_b32 v25, a202
v_accvgpr_read_b32 v29, a203
v_mfma_f32_16x16x32_bf16 v[128:131], v[64:67], v[32:35], v[128:131]
ds_read_b64_tr_b16 v[88:89], v11 offset:0
v_accvgpr_read_b32 v26, a204
v_mfma_f32_16x16x32_bf16 v[128:131], v[68:71], v[36:39], v[128:131]
ds_read_b64_tr_b16 v[90:91], v11 offset:1024
v_accvgpr_read_b32 v30, a205
v_mfma_f32_16x16x32_bf16 v[132:135], v[68:71], v[44:47], v[132:135]
v_accvgpr_read_b32 v27, a206
v_accvgpr_read_b32 v31, a207
v_mfma_f32_16x16x32_bf16 v[132:135], v[64:67], v[40:43], v[132:135]
s_add_u32 s72, s70, 144384
buffer_load_dwordx4 v5, s[4:7], s72 offen offset:3072 lds
v_mfma_f32_16x16x32_bf16 v[136:139], v[64:67], v[48:51], v[136:139]
ds_read_b64_tr_b16 v[92:93], v11 offset:8192
v_cvt_pk_bf16_f32 v24, v24, v28
v_mfma_f32_16x16x32_bf16 v[136:139], v[68:71], v[52:55], v[136:139]
s_lshl_b32 s71, s73, 12
v_cvt_pk_bf16_f32 v25, v25, v29
v_cvt_pk_bf16_f32 v26, v26, v30
v_mfma_f32_16x16x32_bf16 v[140:143], v[68:71], v[60:63], v[140:143]
s_add_u32 s71, s71, s66
ds_read_b64_tr_b16 v[94:95], v11 offset:9216
v_cvt_pk_bf16_f32 v27, v27, v31
v_mfma_f32_16x16x32_bf16 v[140:143], v[64:67], v[56:59], v[140:143]
s_waitcnt lgkmcnt(8)
v_mfma_f32_16x16x32_bf16 v[156:159], v[72:75], v[56:59], v[156:159]
s_add_u32 m0, s64, 32768
ds_read_b64_tr_b16 v[64:65], v12 offset:0
v_mfma_f32_16x16x32_bf16 v[156:159], v[76:79], v[60:63], v[156:159]
s_add_u32 s72, s71, 0
buffer_load_dwordx4 v6, s[12:15], s72 offen lds
v_mfma_f32_16x16x32_bf16 v[152:155], v[76:79], v[52:55], v[152:155]
s_add_u32 s73, s62, 9
ds_read_b64_tr_b16 v[66:67], v12 offset:1024
v_mfma_f32_16x16x32_bf16 v[152:155], v[72:75], v[48:51], v[152:155]
s_add_u32 s70, s73, s65
v_mfma_f32_16x16x32_bf16 v[148:151], v[72:75], v[40:43], v[148:151]
s_and_b32 s70, s70, 3
ds_read_b64_tr_b16 v[68:69], v12 offset:8192
v_mfma_f32_16x16x32_bf16 v[148:151], v[76:79], v[44:47], v[148:151]
s_and_b32 s73, s73, 12
ds_read_b64_tr_b16 v[70:71], v12 offset:9216
v_mfma_f32_16x16x32_bf16 v[144:147], v[76:79], v[36:39], v[144:147]
s_add_u32 s72, s71, 31744
buffer_load_dwordx4 v6, s[12:15], s72 offen offset:1024 lds
v_mfma_f32_16x16x32_bf16 v[144:147], v[72:75], v[32:35], v[144:147]
s_waitcnt lgkmcnt(8)
v_mfma_f32_16x16x32_bf16 v[160:163], v[80:83], v[32:35], v[160:163]
s_or_b32 s73, s73, s70
ds_read_b64_tr_b16 v[72:73], v13 offset:0
v_accvgpr_read_b32 v20, a80
v_mfma_f32_16x16x32_bf16 v[160:163], v[84:87], v[36:39], v[160:163]
s_lshl_b32 s73, s73, 7
ds_read_b64_tr_b16 v[74:75], v13 offset:1024
v_accvgpr_read_b32 v28, a81
v_mfma_f32_16x16x32_bf16 v[164:167], v[84:87], v[44:47], v[164:167]
s_add_u32 s69, s73, s67
v_accvgpr_read_b32 v21, a82
v_accvgpr_read_b32 v29, a83
v_mfma_f32_16x16x32_bf16 v[164:167], v[80:83], v[40:43], v[164:167]
s_add_u32 s72, s71, 63488
buffer_load_dwordx4 v7, s[12:15], s72 offen offset:2048 lds
v_mfma_f32_16x16x32_bf16 v[168:171], v[80:83], v[48:51], v[168:171]
s_waitcnt vmcnt(19)
ds_read_b64_tr_b16 v[76:77], v13 offset:8192
v_accvgpr_read_b32 v22, a112
v_mfma_f32_16x16x32_bf16 v[168:171], v[84:87], v[52:55], v[168:171]
s_add_u32 s70, s73, s68
ds_read_b128 v[96:99], v18 offset:0
v_accvgpr_read_b32 v30, a113
v_mfma_f32_16x16x32_bf16 v[172:175], v[84:87], v[60:63], v[172:175]
s_add_u32 s80, s78, 10240
ds_read_b64_tr_b16 v[78:79], v13 offset:9216
v_accvgpr_read_b32 v23, a114
v_mfma_f32_16x16x32_bf16 v[172:175], v[80:83], v[56:59], v[172:175]
s_waitcnt lgkmcnt(9)
ds_read_b128 v[100:103], v19 offset:0
v_accvgpr_read_b32 v31, a115
v_mfma_f32_16x16x32_bf16 v[188:191], v[88:91], v[56:59], v[188:191]
s_add_u32 s72, s71, 95232
buffer_load_dwordx4 v7, s[12:15], s72 offen offset:3072 lds
v_mfma_f32_16x16x32_bf16 v[188:191], v[92:95], v[60:63], v[188:191]
ds_read_b64_tr_b16 v[80:81], v14 offset:0
v_mul_f32 v20, s79, v20
v_mfma_f32_16x16x32_bf16 v[184:187], v[92:95], v[52:55], v[184:187]
ds_read_b64_tr_b16 v[82:83], v14 offset:1024
v_mul_f32 v28, s79, v28
v_mfma_f32_16x16x32_bf16 v[184:187], v[88:91], v[48:51], v[184:187]
buffer_store_dwordx4 v[24:27], v1, s[44:47], s80 offen sc1
v_mfma_f32_16x16x32_bf16 v[180:183], v[88:91], v[40:43], v[180:183]
ds_read_b64_tr_b16 v[84:85], v14 offset:8192
v_mul_f32 v21, s79, v21
v_mfma_f32_16x16x32_bf16 v[180:183], v[92:95], v[44:47], v[180:183]
s_add_u32 m0, s63, 131072
ds_read_b64_tr_b16 v[86:87], v14 offset:9216
v_mul_f32 v29, s79, v29
v_mfma_f32_16x16x32_bf16 v[176:179], v[92:95], v[36:39], v[176:179]
s_add_u32 s72, s69, 0
buffer_load_dwordx4 v4, s[4:7], s72 offen lds
v_mfma_f32_16x16x32_bf16 v[176:179], v[88:91], v[32:35], v[176:179]
s_waitcnt lgkmcnt(10)
ds_read_b128 v[104:107], v18 offset:2048
v_mul_f32 v22, s79, v22
v_mfma_f32_16x16x32_bf16 v[192:195], v[64:67], v[32:35], v[192:195]
ds_read_b64_tr_b16 v[88:89], v15 offset:0
v_mul_f32 v30, s79, v30
v_mfma_f32_16x16x32_bf16 v[192:195], v[68:71], v[36:39], v[192:195]
ds_read_b64_tr_b16 v[90:91], v15 offset:1024
v_mul_f32 v23, s79, v23
v_mfma_f32_16x16x32_bf16 v[196:199], v[68:71], v[44:47], v[196:199]
ds_read_b64_tr_b16 v[92:93], v15 offset:8192
v_mul_f32 v31, s79, v31
v_mfma_f32_16x16x32_bf16 v[196:199], v[64:67], v[40:43], v[196:199]
s_add_u32 s72, s69, 15360
buffer_load_dwordx4 v5, s[4:7], s72 offen offset:1024 lds
v_mfma_f32_16x16x32_bf16 v[200:203], v[64:67], v[48:51], v[200:203]
ds_read_b64_tr_b16 v[94:95], v15 offset:9216
v_cvt_pk_bf16_f32 v20, v20, v28
v_mfma_f32_16x16x32_bf16 v[200:203], v[68:71], v[52:55], v[200:203]
ds_read_b128 v[108:111], v19 offset:2048
v_cvt_pk_bf16_f32 v21, v21, v29
v_mfma_f32_16x16x32_bf16 v[204:207], v[68:71], v[60:63], v[204:207]
v_cvt_pk_bf16_f32 v22, v22, v30
v_cvt_pk_bf16_f32 v23, v23, v31
v_mfma_f32_16x16x32_bf16 v[204:207], v[64:67], v[56:59], v[204:207]
s_waitcnt lgkmcnt(11)
ds_read_b128 v[112:115], v18 offset:4096
v_accvgpr_read_b32 v24, a208
v_mfma_f32_16x16x32_bf16 v[220:223], v[72:75], v[56:59], v[220:223]
s_add_u32 s72, s69, 129024
buffer_load_dwordx4 v4, s[4:7], s72 offen offset:2048 lds
v_mfma_f32_16x16x32_bf16 v[220:223], v[76:79], v[60:63], v[220:223]
s_add_u32 s80, s77, 33792
s_nop 3
s_mov_b64 exec, 0
s_cmp_eq_u32 s58, 0
s_cbranch_scc1 Lstub0
s_cmp_eq_u32 s58, 1
s_cbranch_scc1 Lstub1
s_cmp_eq_u32 s58, 2
s_cbranch_scc1 Lstub2
s_branch Lstub3
Lret:
s_mov_b64 exec, -1
s_nop 3
v_mfma_f32_16x16x32_bf16 v[216:219], v[76:79], v[52:55], v[216:219]
s_waitcnt vmcnt(19) lgkmcnt(2)
ds_read_b128 v[116:119], v19 offset:4096
v_accvgpr_read_b32 v28, a209
v_mfma_f32_16x16x32_bf16 v[216:219], v[72:75], v[48:51], v[216:219]
s_barrier
buffer_store_dwordx4 v[20:23], v1, s[44:47], s80 offen sc1
v_mfma_f32_16x16x32_bf16 v[212:215], v[72:75], v[40:43], v[212:215]
ds_read_b64_tr_b16 v[64:65], v8 offset:16384
ds_read_b64_tr_b16 v[66:67], v8 offset:17408
v_mfma_f32_16x16x32_bf16 v[212:215], v[76:79], v[44:47], v[212:215]
ds_read_b64_tr_b16 v[68:69], v8 offset:24576
v_accvgpr_read_b32 v25, a210
v_mfma_f32_16x16x32_bf16 v[208:211], v[76:79], v[36:39], v[208:211]
s_add_u32 s72, s69, 144384
buffer_load_dwordx4 v5, s[4:7], s72 offen offset:3072 lds
v_mfma_f32_16x16x32_bf16 v[208:211], v[72:75], v[32:35], v[208:211]
ds_read_b64_tr_b16 v[70:71], v8 offset:25600
v_accvgpr_read_b32 v29, a211
v_mfma_f32_16x16x32_bf16 v[224:227], v[80:83], v[32:35], v[224:227]
ds_read_b64_tr_b16 v[72:73], v9 offset:16384
v_accvgpr_read_b32 v26, a212
v_mfma_f32_16x16x32_bf16 v[224:227], v[84:87], v[36:39], v[224:227]
ds_read_b64_tr_b16 v[74:75], v9 offset:17408
v_accvgpr_read_b32 v30, a213
v_mfma_f32_16x16x32_bf16 v[228:231], v[84:87], v[44:47], v[228:231]
s_add_u32 m0, s63, 135168
ds_read_b128 v[120:123], v18 offset:6144
v_accvgpr_read_b32 v27, a214
v_mfma_f32_16x16x32_bf16 v[228:231], v[80:83], v[40:43], v[228:231]
s_add_u32 s72, s70, 0
buffer_load_dwordx4 v4, s[4:7], s72 offen lds
v_mfma_f32_16x16x32_bf16 v[232:235], v[80:83], v[48:51], v[232:235]
ds_read_b64_tr_b16 v[76:77], v9 offset:24576
v_accvgpr_read_b32 v31, a215
v_mfma_f32_16x16x32_bf16 v[232:235], v[84:87], v[52:55], v[232:235]
ds_read_b128 v[124:127], v19 offset:6144
v_cvt_pk_bf16_f32 v24, v24, v28
v_mfma_f32_16x16x32_bf16 v[236:239], v[84:87], v[60:63], v[236:239]
ds_read_b64_tr_b16 v[78:79], v9 offset:25600
v_cvt_pk_bf16_f32 v25, v25, v29
v_mfma_f32_16x16x32_bf16 v[236:239], v[80:83], v[56:59], v[236:239]
v_cvt_pk_bf16_f32 v26, v26, v30
v_cvt_pk_bf16_f32 v27, v27, v31
v_mfma_f32_16x16x32_bf16 v[252:255], v[88:91], v[56:59], v[252:255]
s_add_u32 s72, s70, 15360
buffer_load_dwordx4 v5, s[4:7], s72 offen offset:1024 lds
v_mfma_f32_16x16x32_bf16 v[252:255], v[92:95], v[60:63], v[252:255]
s_add_u32 s80, s78, 34816
ds_read_b64_tr_b16 v[80:81], v10 offset:16384
v_mfma_f32_16x16x32_bf16 v[248:251], v[92:95], v[52:55], v[248:251]
ds_read_b64_tr_b16 v[82:83], v10 offset:17408
v_mfma_f32_16x16x32_bf16 v[248:251], v[88:91], v[48:51], v[248:251]
buffer_store_dwordx4 v[24:27], v1, s[44:47], s80 offen sc1
v_mfma_f32_16x16x32_bf16 v[244:247], v[88:91], v[40:43], v[244:247]
ds_read_b64_tr_b16 v[84:85], v10 offset:24576
v_mfma_f32_16x16x32_bf16 v[244:247], v[92:95], v[44:47], v[244:247]
ds_read_b64_tr_b16 v[86:87], v10 offset:25600
v_accvgpr_read_b32 v20, a84
v_mfma_f32_16x16x32_bf16 v[240:243], v[92:95], v[36:39], v[240:243]
s_add_u32 s72, s70, 129024
buffer_load_dwordx4 v4, s[4:7], s72 offen offset:2048 lds
v_mfma_f32_16x16x32_bf16 v[240:243], v[88:91], v[32:35], v[240:243]
s_waitcnt lgkmcnt(5)
v_accvgpr_read_b32 v28, a85
v_accvgpr_read_b32 v21, a86
v_mfma_f32_16x16x32_bf16 v[128:131], v[64:67], v[96:99], v[128:131]
ds_read_b64_tr_b16 v[88:89], v11 offset:16384
v_accvgpr_read_b32 v29, a87
v_mfma_f32_16x16x32_bf16 v[128:131], v[68:71], v[100:103], v[128:131]
ds_read_b64_tr_b16 v[90:91], v11 offset:17408
v_accvgpr_read_b32 v22, a116
v_mfma_f32_16x16x32_bf16 v[132:135], v[68:71], v[108:111], v[132:135]
v_accvgpr_read_b32 v30, a117
v_accvgpr_read_b32 v23, a118
v_mfma_f32_16x16x32_bf16 v[132:135], v[64:67], v[104:107], v[132:135]
s_add_u32 s72, s70, 144384
buffer_load_dwordx4 v5, s[4:7], s72 offen offset:3072 lds
v_mfma_f32_16x16x32_bf16 v[136:139], v[64:67], v[112:115], v[136:139]
ds_read_b64_tr_b16 v[92:93], v11 offset:24576
v_accvgpr_read_b32 v31, a119
v_mfma_f32_16x16x32_bf16 v[136:139], v[68:71], v[116:119], v[136:139]
s_lshl_b32 s71, s73, 12
v_mul_f32 v20, s79, v20
v_mul_f32 v28, s79, v28
v_mfma_f32_16x16x32_bf16 v[140:143], v[68:71], v[124:127], v[140:143]
s_add_u32 s71, s71, s66
ds_read_b64_tr_b16 v[94:95], v11 offset:25600
v_mul_f32 v21, s79, v21
v_mfma_f32_16x16x32_bf16 v[140:143], v[64:67], v[120:123], v[140:143]
s_waitcnt lgkmcnt(8)
v_mul_f32 v29, s79, v29
v_mul_f32 v22, s79, v22
v_mfma_f32_16x16x32_bf16 v[156:159], v[72:75], v[120:123], v[156:159]
s_add_u32 m0, s64, 0
ds_read_b64_tr_b16 v[64:65], v12 offset:16384
v_mul_f32 v30, s79, v30
v_mfma_f32_16x16x32_bf16 v[156:159], v[76:79], v[124:127], v[156:159]
s_add_u32 s72, s71, 0
buffer_load_dwordx4 v6, s[12:15], s72 offen lds
v_mfma_f32_16x16x32_bf16 v[152:155], v[76:79], v[116:119], v[152:155]
s_add_u32 s73, s62, 10
ds_read_b64_tr_b16 v[66:67], v12 offset:17408
v_mul_f32 v23, s79, v23
v_mfma_f32_16x16x32_bf16 v[152:155], v[72:75], v[112:115], v[152:155]
s_add_u32 s70, s73, s65
v_mul_f32 v31, s79, v31
v_cvt_pk_bf16_f32 v20, v20, v28
v_mfma_f32_16x16x32_bf16 v[148:151], v[72:75], v[104:107], v[148:151]
s_and_b32 s70, s70, 3
ds_read_b64_tr_b16 v[68:69], v12 offset:24576
v_cvt_pk_bf16_f32 v21, v21, v29
v_mfma_f32_16x16x32_bf16 v[148:151], v[76:79], v[108:111], v[148:151]
s_and_b32 s73, s73, 12
ds_read_b64_tr_b16 v[70:71], v12 offset:25600
v_cvt_pk_bf16_f32 v22, v22, v30
v_mfma_f32_16x16x32_bf16 v[144:147], v[76:79], v[100:103], v[144:147]
s_add_u32 s72, s71, 31744
buffer_load_dwordx4 v6, s[12:15], s72 offen offset:1024 lds
v_mfma_f32_16x16x32_bf16 v[144:147], v[72:75], v[96:99], v[144:147]
s_waitcnt lgkmcnt(8)
v_cvt_pk_bf16_f32 v23, v23, v31
v_mfma_f32_16x16x32_bf16 v[160:163], v[80:83], v[96:99], v[160:163]
s_or_b32 s73, s73, s70
ds_read_b64_tr_b16 v[72:73], v13 offset:16384
v_mfma_f32_16x16x32_bf16 v[160:163], v[84:87], v[100:103], v[160:163]
s_lshl_b32 s73, s73, 7
ds_read_b64_tr_b16 v[74:75], v13 offset:17408
v_mfma_f32_16x16x32_bf16 v[164:167], v[84:87], v[108:111], v[164:167]
s_add_u32 s69, s73, s67
v_mfma_f32_16x16x32_bf16 v[164:167], v[80:83], v[104:107], v[164:167]
s_add_u32 s72, s71, 63488
buffer_load_dwordx4 v7, s[12:15], s72 offen offset:2048 lds
v_mfma_f32_16x16x32_bf16 v[168:171], v[80:83], v[112:115], v[168:171]
s_waitcnt vmcnt(18)
ds_read_b64_tr_b16 v[76:77], v13 offset:24576
v_accvgpr_read_b32 v24, a216
v_mfma_f32_16x16x32_bf16 v[168:171], v[84:87], v[116:119], v[168:171]
s_add_u32 s70, s73, s68
ds_read_b128 v[32:35], v18 offset:32768
v_accvgpr_read_b32 v28, a217
v_mfma_f32_16x16x32_bf16 v[172:175], v[84:87], v[124:127], v[172:175]
s_add_u32 s80, s77, 37888
ds_read_b64_tr_b16 v[78:79], v13 offset:25600
v_accvgpr_read_b32 v25, a218
v_mfma_f32_16x16x32_bf16 v[172:175], v[80:83], v[120:123], v[172:175]
s_waitcnt lgkmcnt(9)
ds_read_b128 v[36:39], v19 offset:32768
v_accvgpr_read_b32 v29, a219
v_mfma_f32_16x16x32_bf16 v[188:191], v[88:91], v[120:123], v[188:191]
s_add_u32 s72, s71, 95232
buffer_load_dwordx4 v7, s[12:15], s72 offen offset:3072 lds
v_mfma_f32_16x16x32_bf16 v[188:191], v[92:95], v[124:127], v[188:191]
ds_read_b64_tr_b16 v[80:81], v14 offset:16384
v_accvgpr_read_b32 v26, a220
v_mfma_f32_16x16x32_bf16 v[184:187], v[92:95], v[116:119], v[184:187]
ds_read_b64_tr_b16 v[82:83], v14 offset:17408
v_accvgpr_read_b32 v30, a221
v_mfma_f32_16x16x32_bf16 v[184:187], v[88:91], v[112:115], v[184:187]
buffer_store_dwordx4 v[20:23], v1, s[44:47], s80 offen sc1
v_mfma_f32_16x16x32_bf16 v[180:183], v[88:91], v[104:107], v[180:183]
ds_read_b64_tr_b16 v[84:85], v14 offset:24576
v_accvgpr_read_b32 v27, a222
v_mfma_f32_16x16x32_bf16 v[180:183], v[92:95], v[108:111], v[180:183]
s_add_u32 m0, s63, 65536
ds_read_b64_tr_b16 v[86:87], v14 offset:25600
v_accvgpr_read_b32 v31, a223
v_mfma_f32_16x16x32_bf16 v[176:179], v[92:95], v[100:103], v[176:179]
s_add_u32 s72, s69, 0
buffer_load_dwordx4 v4, s[4:7], s72 offen lds
v_mfma_f32_16x16x32_bf16 v[176:179], v[88:91], v[96:99], v[176:179]
s_waitcnt lgkmcnt(10)
ds_read_b128 v[40:43], v18 offset:34816
v_cvt_pk_bf16_f32 v24, v24, v28
v_mfma_f32_16x16x32_bf16 v[192:195], v[64:67], v[96:99], v[192:195]
ds_read_b64_tr_b16 v[88:89], v15 offset:16384
v_cvt_pk_bf16_f32 v25, v25, v29
v_mfma_f32_16x16x32_bf16 v[192:195], v[68:71], v[100:103], v[192:195]
ds_read_b64_tr_b16 v[90:91], v15 offset:17408
v_cvt_pk_bf16_f32 v26, v26, v30
v_mfma_f32_16x16x32_bf16 v[196:199], v[68:71], v[108:111], v[196:199]
ds_read_b64_tr_b16 v[92:93], v15 offset:24576
v_cvt_pk_bf16_f32 v27, v27, v31
v_mfma_f32_16x16x32_bf16 v[196:199], v[64:67], v[104:107], v[196:199]
s_add_u32 s72, s69, 15360
buffer_load_dwordx4 v5, s[4:7], s72 offen offset:1024 lds
v_mfma_f32_16x16x32_bf16 v[200:203], v[64:67], v[112:115], v[200:203]
s_add_u32 s80, s78, 43008
ds_read_b64_tr_b16 v[94:95], v15 offset:25600
v_mfma_f32_16x16x32_bf16 v[200:203], v[68:71], v[116:119], v[200:203]
ds_read_b128 v[44:47], v19 offset:34816
v_mfma_f32_16x16x32_bf16 v[204:207], v[68:71], v[124:127], v[204:207]
buffer_store_dwordx4 v[24:27], v1, s[44:47], s80 offen sc1
v_mfma_f32_16x16x32_bf16 v[204:207], v[64:67], v[120:123], v[204:207]
s_waitcnt lgkmcnt(11)
ds_read_b128 v[48:51], v18 offset:36864
v_mfma_f32_16x16x32_bf16 v[220:223], v[72:75], v[120:123], v[220:223]
s_add_u32 s72, s69, 129024
buffer_load_dwordx4 v4, s[4:7], s72 offen offset:2048 lds
v_mfma_f32_16x16x32_bf16 v[220:223], v[76:79], v[124:127], v[220:223]
v_accvgpr_read_b32 v20, a88
v_accvgpr_read_b32 v28, a89
v_mfma_f32_16x16x32_bf16 v[216:219], v[76:79], v[116:119], v[216:219]
s_waitcnt vmcnt(20) lgkmcnt(2)
ds_read_b128 v[52:55], v19 offset:36864
v_accvgpr_read_b32 v21, a90
v_mfma_f32_16x16x32_bf16 v[216:219], v[72:75], v[112:115], v[216:219]
s_barrier
ds_read_b128 v[56:59], v18 offset:38912
v_accvgpr_read_b32 v29, a91
v_mfma_f32_16x16x32_bf16 v[212:215], v[72:75], v[104:107], v[212:215]
ds_read_b64_tr_b16 v[64:65], v8 offset:32768
ds_read_b64_tr_b16 v[66:67], v8 offset:33792
v_mfma_f32_16x16x32_bf16 v[212:215], v[76:79], v[108:111], v[212:215]
ds_read_b64_tr_b16 v[68:69], v8 offset:40960
v_accvgpr_read_b32 v22, a120
v_mfma_f32_16x16x32_bf16 v[208:211], v[76:79], v[100:103], v[208:211]
s_add_u32 s72, s69, 144384
buffer_load_dwordx4 v5, s[4:7], s72 offen offset:3072 lds
v_mfma_f32_16x16x32_bf16 v[208:211], v[72:75], v[96:99], v[208:211]
ds_read_b64_tr_b16 v[70:71], v8 offset:41984
v_accvgpr_read_b32 v30, a121
v_mfma_f32_16x16x32_bf16 v[224:227], v[80:83], v[96:99], v[224:227]
ds_read_b64_tr_b16 v[72:73], v9 offset:32768
v_accvgpr_read_b32 v23, a122
v_mfma_f32_16x16x32_bf16 v[224:227], v[84:87], v[100:103], v[224:227]
ds_read_b64_tr_b16 v[74:75], v9 offset:33792
v_accvgpr_read_b32 v31, a123
v_mfma_f32_16x16x32_bf16 v[228:231], v[84:87], v[108:111], v[228:231]
s_add_u32 m0, s63, 69632
v_mul_f32 v20, s79, v20
v_mul_f32 v28, s79, v28
v_mfma_f32_16x16x32_bf16 v[228:231], v[80:83], v[104:107], v[228:231]
s_add_u32 s72, s70, 0
buffer_load_dwordx4 v4, s[4:7], s72 offen lds
v_mfma_f32_16x16x32_bf16 v[232:235], v[80:83], v[112:115], v[232:235]
ds_read_b64_tr_b16 v[76:77], v9 offset:40960
v_mul_f32 v21, s79, v21
v_mfma_f32_16x16x32_bf16 v[232:235], v[84:87], v[116:119], v[232:235]
ds_read_b128 v[60:63], v19 offset:38912
v_mul_f32 v29, s79, v29
v_mfma_f32_16x16x32_bf16 v[236:239], v[84:87], v[124:127], v[236:239]
ds_read_b64_tr_b16 v[78:79], v9 offset:41984
v_mul_f32 v22, s79, v22
v_mfma_f32_16x16x32_bf16 v[236:239], v[80:83], v[120:123], v[236:239]
v_mul_f32 v30, s79, v30
v_mul_f32 v23, s79, v23
v_mfma_f32_16x16x32_bf16 v[252:255], v[88:91], v[120:123], v[252:255]
s_add_u32 s72, s70, 15360
buffer_load_dwordx4 v5, s[4:7], s72 offen offset:1024 lds
v_mfma_f32_16x16x32_bf16 v[252:255], v[92:95], v[124:127], v[252:255]
ds_read_b64_tr_b16 v[80:81], v10 offset:32768
v_mul_f32 v31, s79, v31
v_mfma_f32_16x16x32_bf16 v[248:251], v[92:95], v[116:119], v[248:251]
ds_read_b64_tr_b16 v[82:83], v10 offset:33792
v_cvt_pk_bf16_f32 v20, v20, v28
v_mfma_f32_16x16x32_bf16 v[248:251], v[88:91], v[112:115], v[248:251]
v_cvt_pk_bf16_f32 v21, v21, v29
v_cvt_pk_bf16_f32 v22, v22, v30
v_mfma_f32_16x16x32_bf16 v[244:247], v[88:91], v[104:107], v[244:247]
ds_read_b64_tr_b16 v[84:85], v10 offset:40960
v_cvt_pk_bf16_f32 v23, v23, v31
v_mfma_f32_16x16x32_bf16 v[244:247], v[92:95], v[108:111], v[244:247]
s_add_u32 s80, s77, 41984
ds_read_b64_tr_b16 v[86:87], v10 offset:41984
v_mfma_f32_16x16x32_bf16 v[240:243], v[92:95], v[100:103], v[240:243]
s_add_u32 s72, s70, 129024
buffer_load_dwordx4 v4, s[4:7], s72 offen offset:2048 lds
v_mfma_f32_16x16x32_bf16 v[240:243], v[88:91], v[96:99], v[240:243]
s_waitcnt lgkmcnt(5)
buffer_store_dwordx4 v[20:23], v1, s[44:47], s80 offen sc1
LcB1:
v_mfma_f32_16x16x32_bf16 v[128:131], v[64:67], v[32:35], v[128:131]
ds_read_b64_tr_b16 v[88:89], v11 offset:32768
v_accvgpr_read_b32 v24, a224
v_mfma_f32_16x16x32_bf16 v[128:131], v[68:71], v[36:39], v[128:131]
ds_read_b64_tr_b16 v[90:91], v11 offset:33792
v_accvgpr_read_b32 v28, a225
v_mfma_f32_16x16x32_bf16 v[132:135], v[68:71], v[44:47], v[132:135]
v_accvgpr_read_b32 v25, a226
v_accvgpr_read_b32 v29, a227
v_mfma_f32_16x16x32_bf16 v[132:135], v[64:67], v[40:43], v[132:135]
s_add_u32 s72, s70, 144384
buffer_load_dwordx4 v5, s[4:7], s72 offen offset:3072 lds
v_mfma_f32_16x16x32_bf16 v[136:139], v[64:67], v[48:51], v[136:139]
ds_read_b64_tr_b16 v[92:93], v11 offset:40960
v_accvgpr_read_b32 v26, a228
v_mfma_f32_16x16x32_bf16 v[136:139], v[68:71], v[52:55], v[136:139]
s_lshl_b32 s71, s73, 12
v_accvgpr_read_b32 v30, a229
v_accvgpr_read_b32 v27, a230
v_mfma_f32_16x16x32_bf16 v[140:143], v[68:71], v[60:63], v[140:143]
s_add_u32 s71, s71, s66
ds_read_b64_tr_b16 v[94:95], v11 offset:41984
v_accvgpr_read_b32 v31, a231
v_mfma_f32_16x16x32_bf16 v[140:143], v[64:67], v[56:59], v[140:143]
s_waitcnt lgkmcnt(8)
v_cvt_pk_bf16_f32 v24, v24, v28
v_cvt_pk_bf16_f32 v25, v25, v29
v_mfma_f32_16x16x32_bf16 v[156:159], v[72:75], v[56:59], v[156:159]
s_add_u32 m0, s64, 16384
ds_read_b64_tr_b16 v[64:65], v12 offset:32768
v_cvt_pk_bf16_f32 v26, v26, v30
v_mfma_f32_16x16x32_bf16 v[156:159], v[76:79], v[60:63], v[156:159]
s_add_u32 s72, s71, 0
buffer_load_dwordx4 v6, s[12:15], s72 offen lds
v_mfma_f32_16x16x32_bf16 v[152:155], v[76:79], v[52:55], v[152:155]
s_add_u32 s73, s62, 11
ds_read_b64_tr_b16 v[66:67], v12 offset:33792
v_cvt_pk_bf16_f32 v27, v27, v31
v_mfma_f32_16x16x32_bf16 v[152:155], v[72:75], v[48:51], v[152:155]
s_add_u32 s70, s73, s65
v_mfma_f32_16x16x32_bf16 v[148:151], v[72:75], v[40:43], v[148:151]
s_and_b32 s70, s70, 3
ds_read_b64_tr_b16 v[68:69], v12 offset:40960
v_mfma_f32_16x16x32_bf16 v[148:151], v[76:79], v[44:47], v[148:151]
s_and_b32 s73, s73, 12
ds_read_b64_tr_b16 v[70:71], v12 offset:41984
v_mfma_f32_16x16x32_bf16 v[144:147], v[76:79], v[36:39], v[144:147]
s_add_u32 s72, s71, 31744
buffer_load_dwordx4 v6, s[12:15], s72 offen offset:1024 lds
v_mfma_f32_16x16x32_bf16 v[144:147], v[72:75], v[32:35], v[144:147]
s_waitcnt lgkmcnt(8)
v_mfma_f32_16x16x32_bf16 v[160:163], v[80:83], v[32:35], v[160:163]
s_or_b32 s73, s73, s70
ds_read_b64_tr_b16 v[72:73], v13 offset:32768
v_mfma_f32_16x16x32_bf16 v[160:163], v[84:87], v[36:39], v[160:163]
s_lshl_b32 s73, s73, 7
ds_read_b64_tr_b16 v[74:75], v13 offset:33792
v_mfma_f32_16x16x32_bf16 v[164:167], v[84:87], v[44:47], v[164:167]
s_add_u32 s69, s73, s67
v_mfma_f32_16x16x32_bf16 v[164:167], v[80:83], v[40:43], v[164:167]
s_add_u32 s72, s71, 63488
buffer_load_dwordx4 v7, s[12:15], s72 offen offset:2048 lds
v_mfma_f32_16x16x32_bf16 v[168:171], v[80:83], v[48:51], v[168:171]
s_waitcnt vmcnt(18)
ds_read_b64_tr_b16 v[76:77], v13 offset:40960
v_mfma_f32_16x16x32_bf16 v[168:171], v[84:87], v[52:55], v[168:171]
s_add_u32 s70, s73, s68
ds_read_b128 v[96:99], v16 offset:0
v_accvgpr_read_b32 v20, a92
v_mfma_f32_16x16x32_bf16 v[172:175], v[84:87], v[60:63], v[172:175]
s_add_u32 s80, s78, 3072
ds_read_b64_tr_b16 v[78:79], v13 offset:41984
v_accvgpr_read_b32 v28, a93
v_mfma_f32_16x16x32_bf16 v[172:175], v[80:83], v[56:59], v[172:175]
s_waitcnt lgkmcnt(9)
ds_read_b128 v[100:103], v17 offset:0
v_accvgpr_read_b32 v21, a94
v_mfma_f32_16x16x32_bf16 v[188:191], v[88:91], v[56:59], v[188:191]
s_add_u32 s72, s71, 95232
buffer_load_dwordx4 v7, s[12:15], s72 offen offset:3072 lds
v_mfma_f32_16x16x32_bf16 v[188:191], v[92:95], v[60:63], v[188:191]
ds_read_b64_tr_b16 v[80:81], v14 offset:32768
v_accvgpr_read_b32 v29, a95
v_mfma_f32_16x16x32_bf16 v[184:187], v[92:95], v[52:55], v[184:187]
ds_read_b64_tr_b16 v[82:83], v14 offset:33792
v_accvgpr_read_b32 v22, a124
v_mfma_f32_16x16x32_bf16 v[184:187], v[88:91], v[48:51], v[184:187]
buffer_store_dwordx4 v[24:27], v1, s[44:47], s80 offen sc1
v_mfma_f32_16x16x32_bf16 v[180:183], v[88:91], v[40:43], v[180:183]
ds_read_b64_tr_b16 v[84:85], v14 offset:40960
v_accvgpr_read_b32 v30, a125
v_mfma_f32_16x16x32_bf16 v[180:183], v[92:95], v[44:47], v[180:183]
s_add_u32 m0, s63, 98304
ds_read_b64_tr_b16 v[86:87], v14 offset:41984
v_accvgpr_read_b32 v23, a126
v_mfma_f32_16x16x32_bf16 v[176:179], v[92:95], v[36:39], v[176:179]
s_add_u32 s72, s69, 0
buffer_load_dwordx4 v4, s[4:7], s72 offen lds
v_mfma_f32_16x16x32_bf16 v[176:179], v[88:91], v[32:35], v[176:179]
s_waitcnt lgkmcnt(10)
ds_read_b128 v[104:107], v16 offset:2048
v_accvgpr_read_b32 v31, a127
v_mfma_f32_16x16x32_bf16 v[192:195], v[64:67], v[32:35], v[192:195]
ds_read_b64_tr_b16 v[88:89], v15 offset:32768
v_mul_f32 v20, s79, v20
v_mfma_f32_16x16x32_bf16 v[192:195], v[68:71], v[36:39], v[192:195]
ds_read_b64_tr_b16 v[90:91], v15 offset:33792
v_mul_f32 v28, s79, v28
v_mfma_f32_16x16x32_bf16 v[196:199], v[68:71], v[44:47], v[196:199]
ds_read_b64_tr_b16 v[92:93], v15 offset:40960
v_mul_f32 v21, s79, v21
v_mfma_f32_16x16x32_bf16 v[196:199], v[64:67], v[40:43], v[196:199]
s_add_u32 s72, s69, 15360
buffer_load_dwordx4 v5, s[4:7], s72 offen offset:1024 lds
v_mfma_f32_16x16x32_bf16 v[200:203], v[64:67], v[48:51], v[200:203]
ds_read_b64_tr_b16 v[94:95], v15 offset:41984
v_mul_f32 v29, s79, v29
v_mfma_f32_16x16x32_bf16 v[200:203], v[68:71], v[52:55], v[200:203]
ds_read_b128 v[108:111], v17 offset:2048
v_mul_f32 v22, s79, v22
v_mfma_f32_16x16x32_bf16 v[204:207], v[68:71], v[60:63], v[204:207]
v_mul_f32 v30, s79, v30
v_mul_f32 v23, s79, v23
v_mfma_f32_16x16x32_bf16 v[204:207], v[64:67], v[56:59], v[204:207]
s_waitcnt lgkmcnt(11)
ds_read_b128 v[112:115], v16 offset:4096
v_mul_f32 v31, s79, v31
v_mfma_f32_16x16x32_bf16 v[220:223], v[72:75], v[56:59], v[220:223]
s_add_u32 s72, s69, 129024
buffer_load_dwordx4 v4, s[4:7], s72 offen offset:2048 lds
v_mfma_f32_16x16x32_bf16 v[220:223], v[76:79], v[60:63], v[220:223]
v_cvt_pk_bf16_f32 v20, v20, v28
v_cvt_pk_bf16_f32 v21, v21, v29
v_mfma_f32_16x16x32_bf16 v[216:219], v[76:79], v[52:55], v[216:219]
s_waitcnt vmcnt(19) lgkmcnt(2)
ds_read_b128 v[116:119], v17 offset:4096
v_cvt_pk_bf16_f32 v22, v22, v30
v_mfma_f32_16x16x32_bf16 v[216:219], v[72:75], v[48:51], v[216:219]
s_barrier
ds_read_b128 v[120:123], v16 offset:6144
v_cvt_pk_bf16_f32 v23, v23, v31
v_mfma_f32_16x16x32_bf16 v[212:215], v[72:75], v[40:43], v[212:215]
s_add_u32 s80, s77, 46080
ds_read_b64_tr_b16 v[64:65], v8 offset:0
ds_read_b64_tr_b16 v[66:67], v8 offset:1024
v_mfma_f32_16x16x32_bf16 v[212:215], v[76:79], v[44:47], v[212:215]
ds_read_b64_tr_b16 v[68:69], v8 offset:8192
v_accvgpr_read_b32 v24, a232
v_mfma_f32_16x16x32_bf16 v[208:211], v[76:79], v[36:39], v[208:211]
s_add_u32 s72, s69, 144384
buffer_load_dwordx4 v5, s[4:7], s72 offen offset:3072 lds
v_mfma_f32_16x16x32_bf16 v[208:211], v[72:75], v[32:35], v[208:211]
ds_read_b64_tr_b16 v[70:71], v8 offset:9216
v_accvgpr_read_b32 v28, a233
v_mfma_f32_16x16x32_bf16 v[224:227], v[80:83], v[32:35], v[224:227]
ds_read_b64_tr_b16 v[72:73], v9 offset:0
v_accvgpr_read_b32 v25, a234
v_mfma_f32_16x16x32_bf16 v[224:227], v[84:87], v[36:39], v[224:227]
ds_read_b64_tr_b16 v[74:75], v9 offset:1024
v_accvgpr_read_b32 v29, a235
v_mfma_f32_16x16x32_bf16 v[228:231], v[84:87], v[44:47], v[228:231]
s_add_u32 m0, s63, 102400
buffer_store_dwordx4 v[20:23], v1, s[44:47], s80 offen sc1
v_mfma_f32_16x16x32_bf16 v[228:231], v[80:83], v[40:43], v[228:231]
s_add_u32 s72, s70, 0
buffer_load_dwordx4 v4, s[4:7], s72 offen lds
v_mfma_f32_16x16x32_bf16 v[232:235], v[80:83], v[48:51], v[232:235]
ds_read_b64_tr_b16 v[76:77], v9 offset:8192
v_accvgpr_read_b32 v26, a236
v_mfma_f32_16x16x32_bf16 v[232:235], v[84:87], v[52:55], v[232:235]
ds_read_b128 v[124:127], v17 offset:6144
v_accvgpr_read_b32 v30, a237
v_mfma_f32_16x16x32_bf16 v[236:239], v[84:87], v[60:63], v[236:239]
ds_read_b64_tr_b16 v[78:79], v9 offset:9216
v_accvgpr_read_b32 v27, a238
v_mfma_f32_16x16x32_bf16 v[236:239], v[80:83], v[56:59], v[236:239]
v_accvgpr_read_b32 v31, a239
v_cvt_pk_bf16_f32 v24, v24, v28
v_mfma_f32_16x16x32_bf16 v[252:255], v[88:91], v[56:59], v[252:255]
s_add_u32 s72, s70, 15360
buffer_load_dwordx4 v5, s[4:7], s72 offen offset:1024 lds
v_mfma_f32_16x16x32_bf16 v[252:255], v[92:95], v[60:63], v[252:255]
ds_read_b64_tr_b16 v[80:81], v10 offset:0
v_cvt_pk_bf16_f32 v25, v25, v29
v_mfma_f32_16x16x32_bf16 v[248:251], v[92:95], v[52:55], v[248:251]
ds_read_b64_tr_b16 v[82:83], v10 offset:1024
v_cvt_pk_bf16_f32 v26, v26, v30
v_mfma_f32_16x16x32_bf16 v[248:251], v[88:91], v[48:51], v[248:251]
v_cvt_pk_bf16_f32 v27, v27, v31
v_mfma_f32_16x16x32_bf16 v[244:247], v[88:91], v[40:43], v[244:247]
s_add_u32 s80, s78, 11264
ds_read_b64_tr_b16 v[84:85], v10 offset:8192
v_mfma_f32_16x16x32_bf16 v[244:247], v[92:95], v[44:47], v[244:247]
ds_read_b64_tr_b16 v[86:87], v10 offset:9216
v_mfma_f32_16x16x32_bf16 v[240:243], v[92:95], v[36:39], v[240:243]
s_add_u32 s72, s70, 129024
buffer_load_dwordx4 v4, s[4:7], s72 offen offset:2048 lds
v_mfma_f32_16x16x32_bf16 v[240:243], v[88:91], v[32:35], v[240:243]
s_waitcnt lgkmcnt(5)
buffer_store_dwordx4 v[24:27], v1, s[44:47], s80 offen sc1
v_mfma_f32_16x16x32_bf16 v[128:131], v[64:67], v[96:99], v[128:131]
ds_read_b64_tr_b16 v[88:89], v11 offset:0
v_mfma_f32_16x16x32_bf16 v[128:131], v[68:71], v[100:103], v[128:131]
ds_read_b64_tr_b16 v[90:91], v11 offset:1024
v_accvgpr_read_b32 v20, a240
v_mfma_f32_16x16x32_bf16 v[132:135], v[68:71], v[108:111], v[132:135]
v_accvgpr_read_b32 v28, a241
v_accvgpr_read_b32 v21, a242
v_mfma_f32_16x16x32_bf16 v[132:135], v[64:67], v[104:107], v[132:135]
s_add_u32 s72, s70, 144384
buffer_load_dwordx4 v5, s[4:7], s72 offen offset:3072 lds
v_mfma_f32_16x16x32_bf16 v[136:139], v[64:67], v[112:115], v[136:139]
ds_read_b64_tr_b16 v[92:93], v11 offset:8192
v_accvgpr_read_b32 v29, a243
v_mfma_f32_16x16x32_bf16 v[136:139], v[68:71], v[116:119], v[136:139]
s_lshl_b32 s71, s73, 12
v_accvgpr_read_b32 v22, a244
v_accvgpr_read_b32 v30, a245
v_mfma_f32_16x16x32_bf16 v[140:143], v[68:71], v[124:127], v[140:143]
s_add_u32 s71, s71, s66
ds_read_b64_tr_b16 v[94:95], v11 offset:9216
v_accvgpr_read_b32 v23, a246
v_mfma_f32_16x16x32_bf16 v[140:143], v[64:67], v[120:123], v[140:143]
s_waitcnt lgkmcnt(8)
v_accvgpr_read_b32 v31, a247
v_cvt_pk_bf16_f32 v20, v20, v28
v_mfma_f32_16x16x32_bf16 v[156:159], v[72:75], v[120:123], v[156:159]
s_add_u32 m0, s64, 32768
ds_read_b64_tr_b16 v[64:65], v12 offset:0
v_cvt_pk_bf16_f32 v21, v21, v29
v_mfma_f32_16x16x32_bf16 v[156:159], v[76:79], v[124:127], v[156:159]
s_add_u32 s72, s71, 0
buffer_load_dwordx4 v6, s[12:15], s72 offen lds
v_mfma_f32_16x16x32_bf16 v[152:155], v[76:79], v[116:119], v[152:155]
s_add_u32 s73, s62, 12
ds_read_b64_tr_b16 v[66:67], v12 offset:1024
v_cvt_pk_bf16_f32 v22, v22, v30
v_mfma_f32_16x16x32_bf16 v[152:155], v[72:75], v[112:115], v[152:155]
s_add_u32 s70, s73, s65
v_cvt_pk_bf16_f32 v23, v23, v31
v_mfma_f32_16x16x32_bf16 v[148:151], v[72:75], v[104:107], v[148:151]
s_and_b32 s70, s70, 3
ds_read_b64_tr_b16 v[68:69], v12 offset:8192
v_mfma_f32_16x16x32_bf16 v[148:151], v[76:79], v[108:111], v[148:151]
s_and_b32 s73, s73, 12
ds_read_b64_tr_b16 v[70:71], v12 offset:9216
v_mfma_f32_16x16x32_bf16 v[144:147], v[76:79], v[100:103], v[144:147]
s_add_u32 s72, s71, 31744
buffer_load_dwordx4 v6, s[12:15], s72 offen offset:1024 lds
v_mfma_f32_16x16x32_bf16 v[144:147], v[72:75], v[96:99], v[144:147]
s_waitcnt lgkmcnt(8)
v_mfma_f32_16x16x32_bf16 v[160:163], v[80:83], v[96:99], v[160:163]
s_or_b32 s73, s73, s70
ds_read_b64_tr_b16 v[72:73], v13 offset:0
v_mfma_f32_16x16x32_bf16 v[160:163], v[84:87], v[100:103], v[160:163]
s_lshl_b32 s73, s73, 7
ds_read_b64_tr_b16 v[74:75], v13 offset:1024
v_mfma_f32_16x16x32_bf16 v[164:167], v[84:87], v[108:111], v[164:167]
s_add_u32 s69, s73, s67
v_mfma_f32_16x16x32_bf16 v[164:167], v[80:83], v[104:107], v[164:167]
s_add_u32 s72, s71, 63488
buffer_load_dwordx4 v7, s[12:15], s72 offen offset:2048 lds
v_mfma_f32_16x16x32_bf16 v[168:171], v[80:83], v[112:115], v[168:171]
s_waitcnt vmcnt(18)
ds_read_b64_tr_b16 v[76:77], v13 offset:8192
v_mfma_f32_16x16x32_bf16 v[168:171], v[84:87], v[116:119], v[168:171]
s_add_u32 s70, s73, s68
ds_read_b128 v[32:35], v18 offset:0
v_mfma_f32_16x16x32_bf16 v[172:175], v[84:87], v[124:127], v[172:175]
s_add_u32 s80, s78, 35840
ds_read_b64_tr_b16 v[78:79], v13 offset:9216
v_mfma_f32_16x16x32_bf16 v[172:175], v[80:83], v[120:123], v[172:175]
s_waitcnt lgkmcnt(9)
ds_read_b128 v[36:39], v19 offset:0
v_accvgpr_read_b32 v24, a248
v_mfma_f32_16x16x32_bf16 v[188:191], v[88:91], v[120:123], v[188:191]
s_add_u32 s72, s71, 95232
buffer_load_dwordx4 v7, s[12:15], s72 offen offset:3072 lds
v_mfma_f32_16x16x32_bf16 v[188:191], v[92:95], v[124:127], v[188:191]
ds_read_b64_tr_b16 v[80:81], v14 offset:0
v_accvgpr_read_b32 v28, a249
v_mfma_f32_16x16x32_bf16 v[184:187], v[92:95], v[116:119], v[184:187]
ds_read_b64_tr_b16 v[82:83], v14 offset:1024
v_accvgpr_read_b32 v25, a250
v_mfma_f32_16x16x32_bf16 v[184:187], v[88:91], v[112:115], v[184:187]
buffer_store_dwordx4 v[20:23], v1, s[44:47], s80 offen sc1
v_mfma_f32_16x16x32_bf16 v[180:183], v[88:91], v[104:107], v[180:183]
ds_read_b64_tr_b16 v[84:85], v14 offset:8192
v_accvgpr_read_b32 v29, a251
v_mfma_f32_16x16x32_bf16 v[180:183], v[92:95], v[108:111], v[180:183]
s_add_u32 m0, s63, 131072
ds_read_b64_tr_b16 v[86:87], v14 offset:9216
v_accvgpr_read_b32 v26, a252
v_mfma_f32_16x16x32_bf16 v[176:179], v[92:95], v[100:103], v[176:179]
s_add_u32 s72, s69, 0
buffer_load_dwordx4 v4, s[4:7], s72 offen lds
v_mfma_f32_16x16x32_bf16 v[176:179], v[88:91], v[96:99], v[176:179]
s_waitcnt lgkmcnt(10)
ds_read_b128 v[40:43], v18 offset:2048
v_accvgpr_read_b32 v30, a253
v_mfma_f32_16x16x32_bf16 v[192:195], v[64:67], v[96:99], v[192:195]
ds_read_b64_tr_b16 v[88:89], v15 offset:0
v_accvgpr_read_b32 v27, a254
v_mfma_f32_16x16x32_bf16 v[192:195], v[68:71], v[100:103], v[192:195]
ds_read_b64_tr_b16 v[90:91], v15 offset:1024
v_accvgpr_read_b32 v31, a255
v_mfma_f32_16x16x32_bf16 v[196:199], v[68:71], v[108:111], v[196:199]
ds_read_b64_tr_b16 v[92:93], v15 offset:8192
v_cvt_pk_bf16_f32 v24, v24, v28
v_mfma_f32_16x16x32_bf16 v[196:199], v[64:67], v[104:107], v[196:199]
s_add_u32 s72, s69, 15360
buffer_load_dwordx4 v5, s[4:7], s72 offen offset:1024 lds
v_mfma_f32_16x16x32_bf16 v[200:203], v[64:67], v[112:115], v[200:203]
ds_read_b64_tr_b16 v[94:95], v15 offset:9216
v_cvt_pk_bf16_f32 v25, v25, v29
v_mfma_f32_16x16x32_bf16 v[200:203], v[68:71], v[116:119], v[200:203]
ds_read_b128 v[44:47], v19 offset:2048
v_cvt_pk_bf16_f32 v26, v26, v30
v_mfma_f32_16x16x32_bf16 v[204:207], v[68:71], v[124:127], v[204:207]
v_cvt_pk_bf16_f32 v27, v27, v31
v_mfma_f32_16x16x32_bf16 v[204:207], v[64:67], v[120:123], v[204:207]
s_waitcnt lgkmcnt(11)
ds_read_b128 v[48:51], v18 offset:4096
v_mfma_f32_16x16x32_bf16 v[220:223], v[72:75], v[120:123], v[220:223]
s_add_u32 s72, s69, 129024
buffer_load_dwordx4 v4, s[4:7], s72 offen offset:2048 lds
v_mfma_f32_16x16x32_bf16 v[220:223], v[76:79], v[124:127], v[220:223]
s_add_u32 s80, s78, 44032
ds_read_b128 v[52:55], v19 offset:4096
v_mfma_f32_16x16x32_bf16 v[216:219], v[76:79], v[116:119], v[216:219]
s_waitcnt vmcnt(19) lgkmcnt(3)
buffer_store_dwordx4 v[24:27], v1, s[44:47], s80 offen sc1
v_mfma_f32_16x16x32_bf16 v[216:219], v[72:75], v[112:115], v[216:219]
s_barrier
ds_read_b128 v[56:59], v18 offset:6144
v_mfma_f32_16x16x32_bf16 v[212:215], v[72:75], v[104:107], v[212:215]
ds_read_b64_tr_b16 v[64:65], v8 offset:16384
ds_read_b64_tr_b16 v[66:67], v8 offset:17408
v_mfma_f32_16x16x32_bf16 v[212:215], v[76:79], v[108:111], v[212:215]
ds_read_b64_tr_b16 v[68:69], v8 offset:24576
ds_read_b64_tr_b16 v[70:71], v8 offset:25600
v_mfma_f32_16x16x32_bf16 v[208:211], v[76:79], v[100:103], v[208:211]
s_add_u32 s72, s69, 144384
buffer_load_dwordx4 v5, s[4:7], s72 offen offset:3072 lds
v_mfma_f32_16x16x32_bf16 v[208:211], v[72:75], v[96:99], v[208:211]
v_and_b32 v2, 31, v0
v_lshlrev_b32 v2, 2, v2
v_mfma_f32_16x16x32_bf16 v[224:227], v[80:83], v[96:99], v[224:227]
buffer_load_dword v3, v2, s[48:51], 0 offen sc1
v_mfma_f32_16x16x32_bf16 v[224:227], v[84:87], v[100:103], v[224:227]
ds_read_b64_tr_b16 v[72:73], v9 offset:16384
v_mfma_f32_16x16x32_bf16 v[228:231], v[84:87], v[108:111], v[228:231]
s_add_u32 m0, s63, 135168
ds_read_b64_tr_b16 v[74:75], v9 offset:17408
v_mfma_f32_16x16x32_bf16 v[228:231], v[80:83], v[104:107], v[228:231]
s_add_u32 s72, s70, 0
buffer_load_dwordx4 v4, s[4:7], s72 offen lds
v_mfma_f32_16x16x32_bf16 v[232:235], v[80:83], v[112:115], v[232:235]
ds_read_b128 v[60:63], v19 offset:6144
v_mfma_f32_16x16x32_bf16 v[232:235], v[84:87], v[116:119], v[232:235]
ds_read_b64_tr_b16 v[76:77], v9 offset:24576
v_mfma_f32_16x16x32_bf16 v[236:239], v[84:87], v[124:127], v[236:239]
ds_read_b64_tr_b16 v[78:79], v9 offset:25600
v_mfma_f32_16x16x32_bf16 v[236:239], v[80:83], v[120:123], v[236:239]
v_mfma_f32_16x16x32_bf16 v[252:255], v[88:91], v[120:123], v[252:255]
s_add_u32 s72, s70, 15360
buffer_load_dwordx4 v5, s[4:7], s72 offen offset:1024 lds
v_mfma_f32_16x16x32_bf16 v[252:255], v[92:95], v[124:127], v[252:255]
ds_read_b64_tr_b16 v[80:81], v10 offset:16384
v_mfma_f32_16x16x32_bf16 v[248:251], v[92:95], v[116:119], v[248:251]
ds_read_b64_tr_b16 v[82:83], v10 offset:17408
v_mfma_f32_16x16x32_bf16 v[248:251], v[88:91], v[112:115], v[248:251]
v_mfma_f32_16x16x32_bf16 v[244:247], v[88:91], v[104:107], v[244:247]
ds_read_b64_tr_b16 v[84:85], v10 offset:24576
v_mfma_f32_16x16x32_bf16 v[244:247], v[92:95], v[108:111], v[244:247]
ds_read_b64_tr_b16 v[86:87], v10 offset:25600
v_mfma_f32_16x16x32_bf16 v[240:243], v[92:95], v[100:103], v[240:243]
s_add_u32 s72, s70, 129024
buffer_load_dwordx4 v4, s[4:7], s72 offen offset:2048 lds
v_mfma_f32_16x16x32_bf16 v[240:243], v[88:91], v[96:99], v[240:243]
s_waitcnt lgkmcnt(6)
v_mfma_f32_16x16x32_bf16 v[128:131], v[64:67], v[32:35], v[128:131]
ds_read_b64_tr_b16 v[88:89], v11 offset:16384
v_mfma_f32_16x16x32_bf16 v[128:131], v[68:71], v[36:39], v[128:131]
ds_read_b64_tr_b16 v[90:91], v11 offset:17408
v_mfma_f32_16x16x32_bf16 v[132:135], v[68:71], v[44:47], v[132:135]
v_mfma_f32_16x16x32_bf16 v[132:135], v[64:67], v[40:43], v[132:135]
s_add_u32 s72, s70, 144384
buffer_load_dwordx4 v5, s[4:7], s72 offen offset:3072 lds
v_mfma_f32_16x16x32_bf16 v[136:139], v[64:67], v[48:51], v[136:139]
ds_read_b64_tr_b16 v[92:93], v11 offset:24576
v_mfma_f32_16x16x32_bf16 v[136:139], v[68:71], v[52:55], v[136:139]
s_lshl_b32 s71, s73, 12
v_mfma_f32_16x16x32_bf16 v[140:143], v[68:71], v[60:63], v[140:143]
s_add_u32 s71, s71, s66
ds_read_b64_tr_b16 v[94:95], v11 offset:25600
v_mfma_f32_16x16x32_bf16 v[140:143], v[64:67], v[56:59], v[140:143]
s_waitcnt lgkmcnt(8)
v_mfma_f32_16x16x32_bf16 v[156:159], v[72:75], v[56:59], v[156:159]
s_add_u32 m0, s64, 0
ds_read_b64_tr_b16 v[64:65], v12 offset:16384
v_mfma_f32_16x16x32_bf16 v[156:159], v[76:79], v[60:63], v[156:159]
s_add_u32 s72, s71, 0
buffer_load_dwordx4 v6, s[12:15], s72 offen lds
v_mfma_f32_16x16x32_bf16 v[152:155], v[76:79], v[52:55], v[152:155]
s_add_u32 s73, s62, 13
ds_read_b64_tr_b16 v[66:67], v12 offset:17408
v_mfma_f32_16x16x32_bf16 v[152:155], v[72:75], v[48:51], v[152:155]
s_add_u32 s70, s73, s65
v_mfma_f32_16x16x32_bf16 v[148:151], v[72:75], v[40:43], v[148:151]
s_and_b32 s70, s70, 3
ds_read_b64_tr_b16 v[68:69], v12 offset:24576
v_mfma_f32_16x16x32_bf16 v[148:151], v[76:79], v[44:47], v[148:151]
s_and_b32 s73, s73, 12
ds_read_b64_tr_b16 v[70:71], v12 offset:25600
v_mfma_f32_16x16x32_bf16 v[144:147], v[76:79], v[36:39], v[144:147]
s_add_u32 s72, s71, 31744
buffer_load_dwordx4 v6, s[12:15], s72 offen offset:1024 lds
v_mfma_f32_16x16x32_bf16 v[144:147], v[72:75], v[32:35], v[144:147]
s_waitcnt lgkmcnt(8)
v_mfma_f32_16x16x32_bf16 v[160:163], v[80:83], v[32:35], v[160:163]
s_or_b32 s73, s73, s70
ds_read_b64_tr_b16 v[72:73], v13 offset:16384
v_mfma_f32_16x16x32_bf16 v[160:163], v[84:87], v[36:39], v[160:163]
s_lshl_b32 s73, s73, 7
ds_read_b64_tr_b16 v[74:75], v13 offset:17408
v_mfma_f32_16x16x32_bf16 v[164:167], v[84:87], v[44:47], v[164:167]
s_add_u32 s69, s73, s67
v_mfma_f32_16x16x32_bf16 v[164:167], v[80:83], v[40:43], v[164:167]
s_add_u32 s72, s71, 63488
buffer_load_dwordx4 v7, s[12:15], s72 offen offset:2048 lds
v_mfma_f32_16x16x32_bf16 v[168:171], v[80:83], v[48:51], v[168:171]
s_waitcnt vmcnt(18)
ds_read_b64_tr_b16 v[76:77], v13 offset:24576
v_mfma_f32_16x16x32_bf16 v[168:171], v[84:87], v[52:55], v[168:171]
s_add_u32 s70, s73, s68
ds_read_b128 v[96:99], v18 offset:32768
v_mfma_f32_16x16x32_bf16 v[172:175], v[84:87], v[60:63], v[172:175]
ds_read_b64_tr_b16 v[78:79], v13 offset:25600
v_mfma_f32_16x16x32_bf16 v[172:175], v[80:83], v[56:59], v[172:175]
s_waitcnt lgkmcnt(9)
ds_read_b128 v[100:103], v19 offset:32768
v_mfma_f32_16x16x32_bf16 v[188:191], v[88:91], v[56:59], v[188:191]
s_add_u32 s72, s71, 95232
buffer_load_dwordx4 v7, s[12:15], s72 offen offset:3072 lds
v_mfma_f32_16x16x32_bf16 v[188:191], v[92:95], v[60:63], v[188:191]
ds_read_b64_tr_b16 v[80:81], v14 offset:16384
v_mfma_f32_16x16x32_bf16 v[184:187], v[92:95], v[52:55], v[184:187]
ds_read_b64_tr_b16 v[82:83], v14 offset:17408
v_mfma_f32_16x16x32_bf16 v[184:187], v[88:91], v[48:51], v[184:187]
v_mfma_f32_16x16x32_bf16 v[180:183], v[88:91], v[40:43], v[180:183]
ds_read_b64_tr_b16 v[84:85], v14 offset:24576
v_mfma_f32_16x16x32_bf16 v[180:183], v[92:95], v[44:47], v[180:183]
s_add_u32 m0, s63, 65536
ds_read_b64_tr_b16 v[86:87], v14 offset:25600
v_mfma_f32_16x16x32_bf16 v[176:179], v[92:95], v[36:39], v[176:179]
s_add_u32 s72, s69, 0
buffer_load_dwordx4 v4, s[4:7], s72 offen lds
v_mfma_f32_16x16x32_bf16 v[176:179], v[88:91], v[32:35], v[176:179]
s_waitcnt lgkmcnt(10)
ds_read_b128 v[104:107], v18 offset:34816
v_mfma_f32_16x16x32_bf16 v[192:195], v[64:67], v[32:35], v[192:195]
ds_read_b64_tr_b16 v[88:89], v15 offset:16384
v_mfma_f32_16x16x32_bf16 v[192:195], v[68:71], v[36:39], v[192:195]
ds_read_b64_tr_b16 v[90:91], v15 offset:17408
v_mfma_f32_16x16x32_bf16 v[196:199], v[68:71], v[44:47], v[196:199]
ds_read_b64_tr_b16 v[92:93], v15 offset:24576
v_mfma_f32_16x16x32_bf16 v[196:199], v[64:67], v[40:43], v[196:199]
s_add_u32 s72, s69, 15360
buffer_load_dwordx4 v5, s[4:7], s72 offen offset:1024 lds
v_mfma_f32_16x16x32_bf16 v[200:203], v[64:67], v[48:51], v[200:203]
ds_read_b64_tr_b16 v[94:95], v15 offset:25600
v_mfma_f32_16x16x32_bf16 v[200:203], v[68:71], v[52:55], v[200:203]
ds_read_b128 v[108:111], v19 offset:34816
v_mfma_f32_16x16x32_bf16 v[204:207], v[68:71], v[60:63], v[204:207]
v_mfma_f32_16x16x32_bf16 v[204:207], v[64:67], v[56:59], v[204:207]
s_waitcnt lgkmcnt(11)
ds_read_b128 v[112:115], v18 offset:36864
v_mfma_f32_16x16x32_bf16 v[220:223], v[72:75], v[56:59], v[220:223]
s_add_u32 s72, s69, 129024
buffer_load_dwordx4 v4, s[4:7], s72 offen offset:2048 lds
v_mfma_f32_16x16x32_bf16 v[220:223], v[76:79], v[60:63], v[220:223]
v_mfma_f32_16x16x32_bf16 v[216:219], v[76:79], v[52:55], v[216:219]
s_waitcnt vmcnt(13) lgkmcnt(2)
ds_read_b128 v[116:119], v19 offset:36864
v_mfma_f32_16x16x32_bf16 v[216:219], v[72:75], v[48:51], v[216:219]
s_barrier
ds_read_b128 v[120:123], v18 offset:38912
v_mfma_f32_16x16x32_bf16 v[212:215], v[72:75], v[40:43], v[212:215]
ds_read_b64_tr_b16 v[64:65], v8 offset:32768
ds_read_b64_tr_b16 v[66:67], v8 offset:33792
v_mfma_f32_16x16x32_bf16 v[212:215], v[76:79], v[44:47], v[212:215]
ds_read_b64_tr_b16 v[68:69], v8 offset:40960
v_or_b32 v20, s58, v0
v_mfma_f32_16x16x32_bf16 v[208:211], v[76:79], v[36:39], v[208:211]
s_add_u32 s72, s69, 144384
buffer_load_dwordx4 v5, s[4:7], s72 offen offset:3072 lds
v_mfma_f32_16x16x32_bf16 v[208:211], v[72:75], v[32:35], v[208:211]
ds_read_b64_tr_b16 v[70:71], v8 offset:41984
v_mov_b32 v21, 1
v_mfma_f32_16x16x32_bf16 v[224:227], v[80:83], v[32:35], v[224:227]
ds_read_b64_tr_b16 v[72:73], v9 offset:32768
v_min_u32 v20, 1, v20
v_mfma_f32_16x16x32_bf16 v[224:227], v[84:87], v[36:39], v[224:227]
ds_read_b64_tr_b16 v[74:75], v9 offset:33792
v_lshlrev_b32 v20, 30, v20
v_mfma_f32_16x16x32_bf16 v[228:231], v[84:87], v[44:47], v[228:231]
s_add_u32 m0, s63, 69632
buffer_store_dword v21, v20, s[44:47], s91 offen sc1
v_mfma_f32_16x16x32_bf16 v[228:231], v[80:83], v[40:43], v[228:231]
s_add_u32 s72, s70, 0
buffer_load_dwordx4 v4, s[4:7], s72 offen lds
v_mfma_f32_16x16x32_bf16 v[232:235], v[80:83], v[48:51], v[232:235]
ds_read_b64_tr_b16 v[76:77], v9 offset:40960
v_accvgpr_write_b32 a32, 0
v_mfma_f32_16x16x32_bf16 v[232:235], v[84:87], v[52:55], v[232:235]
ds_read_b128 v[124:127], v19 offset:38912
v_accvgpr_write_b32 a33, 0
v_mfma_f32_16x16x32_bf16 v[236:239], v[84:87], v[60:63], v[236:239]
ds_read_b64_tr_b16 v[78:79], v9 offset:41984
v_accvgpr_write_b32 a34, 0
v_mfma_f32_16x16x32_bf16 v[236:239], v[80:83], v[56:59], v[236:239]
v_accvgpr_write_b32 a35, 0
v_accvgpr_write_b32 a36, 0
v_mfma_f32_16x16x32_bf16 v[252:255], v[88:91], v[56:59], v[252:255]
s_add_u32 s72, s70, 15360
buffer_load_dwordx4 v5, s[4:7], s72 offen offset:1024 lds
v_mfma_f32_16x16x32_bf16 v[252:255], v[92:95], v[60:63], v[252:255]
ds_read_b64_tr_b16 v[80:81], v10 offset:32768
v_accvgpr_write_b32 a37, 0
v_mfma_f32_16x16x32_bf16 v[248:251], v[92:95], v[52:55], v[248:251]
ds_read_b64_tr_b16 v[82:83], v10 offset:33792
v_accvgpr_write_b32 a38, 0
v_mfma_f32_16x16x32_bf16 v[248:251], v[88:91], v[48:51], v[248:251]
v_accvgpr_write_b32 a39, 0
v_accvgpr_write_b32 a40, 0
v_mfma_f32_16x16x32_bf16 v[244:247], v[88:91], v[40:43], v[244:247]
ds_read_b64_tr_b16 v[84:85], v10 offset:40960
v_accvgpr_write_b32 a41, 0
v_mfma_f32_16x16x32_bf16 v[244:247], v[92:95], v[44:47], v[244:247]
ds_read_b64_tr_b16 v[86:87], v10 offset:41984
v_accvgpr_write_b32 a42, 0
v_mfma_f32_16x16x32_bf16 v[240:243], v[92:95], v[36:39], v[240:243]
s_add_u32 s72, s70, 129024
buffer_load_dwordx4 v4, s[4:7], s72 offen offset:2048 lds
v_mfma_f32_16x16x32_bf16 v[240:243], v[88:91], v[32:35], v[240:243]
s_waitcnt lgkmcnt(5)
v_accvgpr_write_b32 a43, 0
v_accvgpr_write_b32 a44, 0
v_mfma_f32_16x16x32_bf16 v[128:131], v[64:67], v[96:99], v[128:131]
ds_read_b64_tr_b16 v[88:89], v11 offset:32768
v_accvgpr_write_b32 a45, 0
v_mfma_f32_16x16x32_bf16 v[128:131], v[68:71], v[100:103], v[128:131]
ds_read_b64_tr_b16 v[90:91], v11 offset:33792
v_accvgpr_write_b32 a46, 0
v_mfma_f32_16x16x32_bf16 v[132:135], v[68:71], v[108:111], v[132:135]
v_accvgpr_write_b32 a47, 0
v_accvgpr_write_b32 a48, 0
v_mfma_f32_16x16x32_bf16 v[132:135], v[64:67], v[104:107], v[132:135]
s_add_u32 s72, s70, 144384
buffer_load_dwordx4 v5, s[4:7], s72 offen offset:3072 lds
v_mfma_f32_16x16x32_bf16 v[136:139], v[64:67], v[112:115], v[136:139]
ds_read_b64_tr_b16 v[92:93], v11 offset:40960
v_accvgpr_write_b32 a49, 0
v_mfma_f32_16x16x32_bf16 v[136:139], v[68:71], v[116:119], v[136:139]
s_lshl_b32 s71, s73, 12
v_accvgpr_write_b32 a50, 0
v_accvgpr_write_b32 a51, 0
v_mfma_f32_16x16x32_bf16 v[140:143], v[68:71], v[124:127], v[140:143]
s_add_u32 s71, s71, s66
ds_read_b64_tr_b16 v[94:95], v11 offset:41984
v_accvgpr_write_b32 a52, 0
v_mfma_f32_16x16x32_bf16 v[140:143], v[64:67], v[120:123], v[140:143]
s_waitcnt lgkmcnt(8)
v_accvgpr_write_b32 a53, 0
v_accvgpr_write_b32 a54, 0
v_mfma_f32_16x16x32_bf16 v[156:159], v[72:75], v[120:123], v[156:159]
s_add_u32 m0, s64, 16384
ds_read_b64_tr_b16 v[64:65], v12 offset:32768
v_accvgpr_write_b32 a55, 0
v_mfma_f32_16x16x32_bf16 v[156:159], v[76:79], v[124:127], v[156:159]
s_add_u32 s72, s71, 0
buffer_load_dwordx4 v6, s[12:15], s72 offen lds
v_mfma_f32_16x16x32_bf16 v[152:155], v[76:79], v[116:119], v[152:155]
s_add_u32 s73, s62, 14
ds_read_b64_tr_b16 v[66:67], v12 offset:33792
v_accvgpr_write_b32 a56, 0
v_mfma_f32_16x16x32_bf16 v[152:155], v[72:75], v[112:115], v[152:155]
s_add_u32 s70, s73, s65
v_accvgpr_write_b32 a57, 0
v_accvgpr_write_b32 a58, 0
v_mfma_f32_16x16x32_bf16 v[148:151], v[72:75], v[104:107], v[148:151]
s_and_b32 s70, s70, 3
ds_read_b64_tr_b16 v[68:69], v12 offset:40960
v_accvgpr_write_b32 a59, 0
v_mfma_f32_16x16x32_bf16 v[148:151], v[76:79], v[108:111], v[148:151]
s_and_b32 s73, s73, 12
ds_read_b64_tr_b16 v[70:71], v12 offset:41984
v_accvgpr_write_b32 a60, 0
v_mfma_f32_16x16x32_bf16 v[144:147], v[76:79], v[100:103], v[144:147]
s_add_u32 s72, s71, 31744
buffer_load_dwordx4 v6, s[12:15], s72 offen offset:1024 lds
v_mfma_f32_16x16x32_bf16 v[144:147], v[72:75], v[96:99], v[144:147]
s_waitcnt lgkmcnt(8)
v_accvgpr_write_b32 a61, 0
v_accvgpr_write_b32 a62, 0
v_mfma_f32_16x16x32_bf16 v[160:163], v[80:83], v[96:99], v[160:163]
s_or_b32 s73, s73, s70
ds_read_b64_tr_b16 v[72:73], v13 offset:32768
v_accvgpr_write_b32 a63, 0
v_mfma_f32_16x16x32_bf16 v[160:163], v[84:87], v[100:103], v[160:163]
s_lshl_b32 s73, s73, 7
ds_read_b64_tr_b16 v[74:75], v13 offset:33792
v_accvgpr_write_b32 a96, 0
v_mfma_f32_16x16x32_bf16 v[164:167], v[84:87], v[108:111], v[164:167]
s_add_u32 s69, s73, s67
v_accvgpr_write_b32 a97, 0
v_accvgpr_write_b32 a98, 0
v_mfma_f32_16x16x32_bf16 v[164:167], v[80:83], v[104:107], v[164:167]
s_add_u32 s72, s71, 63488
buffer_load_dwordx4 v7, s[12:15], s72 offen offset:2048 lds
v_mfma_f32_16x16x32_bf16 v[168:171], v[80:83], v[112:115], v[168:171]
s_waitcnt vmcnt(16)
ds_read_b64_tr_b16 v[76:77], v13 offset:40960
v_accvgpr_write_b32 a99, 0
v_mfma_f32_16x16x32_bf16 v[168:171], v[84:87], v[116:119], v[168:171]
s_add_u32 s70, s73, s68
ds_read_b128 v[32:35], v16 offset:0
v_accvgpr_write_b32 a100, 0
v_mfma_f32_16x16x32_bf16 v[172:175], v[84:87], v[124:127], v[172:175]
ds_read_b64_tr_b16 v[78:79], v13 offset:41984
v_accvgpr_write_b32 a101, 0
v_mfma_f32_16x16x32_bf16 v[172:175], v[80:83], v[120:123], v[172:175]
s_waitcnt lgkmcnt(9)
ds_read_b128 v[36:39], v17 offset:0
v_accvgpr_write_b32 a102, 0
v_mfma_f32_16x16x32_bf16 v[188:191], v[88:91], v[120:123], v[188:191]
s_add_u32 s72, s71, 95232
buffer_load_dwordx4 v7, s[12:15], s72 offen offset:3072 lds
v_mfma_f32_16x16x32_bf16 v[188:191], v[92:95], v[124:127], v[188:191]
ds_read_b64_tr_b16 v[80:81], v14 offset:32768
v_accvgpr_write_b32 a103, 0
v_mfma_f32_16x16x32_bf16 v[184:187], v[92:95], v[116:119], v[184:187]
ds_read_b64_tr_b16 v[82:83], v14 offset:33792
v_accvgpr_write_b32 a104, 0
v_mfma_f32_16x16x32_bf16 v[184:187], v[88:91], v[112:115], v[184:187]
v_accvgpr_write_b32 a105, 0
v_accvgpr_write_b32 a106, 0
v_mfma_f32_16x16x32_bf16 v[180:183], v[88:91], v[104:107], v[180:183]
ds_read_b64_tr_b16 v[84:85], v14 offset:40960
v_accvgpr_write_b32 a107, 0
v_mfma_f32_16x16x32_bf16 v[180:183], v[92:95], v[108:111], v[180:183]
s_add_u32 m0, s63, 98304
ds_read_b64_tr_b16 v[86:87], v14 offset:41984
v_accvgpr_write_b32 a108, 0
v_mfma_f32_16x16x32_bf16 v[176:179], v[92:95], v[100:103], v[176:179]
s_add_u32 s72, s69, 0
buffer_load_dwordx4 v4, s[4:7], s72 offen lds
v_mfma_f32_16x16x32_bf16 v[176:179], v[88:91], v[96:99], v[176:179]
s_waitcnt lgkmcnt(10)
ds_read_b128 v[40:43], v16 offset:2048
v_accvgpr_write_b32 a109, 0
v_mfma_f32_16x16x32_bf16 v[192:195], v[64:67], v[96:99], v[192:195]
ds_read_b64_tr_b16 v[88:89], v15 offset:32768
v_accvgpr_write_b32 a110, 0
v_mfma_f32_16x16x32_bf16 v[192:195], v[68:71], v[100:103], v[192:195]
ds_read_b64_tr_b16 v[90:91], v15 offset:33792
v_accvgpr_write_b32 a111, 0
v_mfma_f32_16x16x32_bf16 v[196:199], v[68:71], v[108:111], v[196:199]
ds_read_b64_tr_b16 v[92:93], v15 offset:40960
v_accvgpr_write_b32 a112, 0
v_mfma_f32_16x16x32_bf16 v[196:199], v[64:67], v[104:107], v[196:199]
s_add_u32 s72, s69, 15360
buffer_load_dwordx4 v5, s[4:7], s72 offen offset:1024 lds
v_mfma_f32_16x16x32_bf16 v[200:203], v[64:67], v[112:115], v[200:203]
ds_read_b64_tr_b16 v[94:95], v15 offset:41984
v_accvgpr_write_b32 a113, 0
v_mfma_f32_16x16x32_bf16 v[200:203], v[68:71], v[116:119], v[200:203]
ds_read_b128 v[44:47], v17 offset:2048
v_accvgpr_write_b32 a114, 0
v_mfma_f32_16x16x32_bf16 v[204:207], v[68:71], v[124:127], v[204:207]
v_accvgpr_write_b32 a115, 0
v_accvgpr_write_b32 a116, 0
v_mfma_f32_16x16x32_bf16 v[204:207], v[64:67], v[120:123], v[204:207]
s_waitcnt lgkmcnt(11)
ds_read_b128 v[48:51], v16 offset:4096
v_accvgpr_write_b32 a117, 0
v_mfma_f32_16x16x32_bf16 v[220:223], v[72:75], v[120:123], v[220:223]
s_add_u32 s72, s69, 129024
buffer_load_dwordx4 v4, s[4:7], s72 offen offset:2048 lds
v_mfma_f32_16x16x32_bf16 v[220:223], v[76:79], v[124:127], v[220:223]
v_accvgpr_write_b32 a118, 0
v_accvgpr_write_b32 a119, 0
v_mfma_f32_16x16x32_bf16 v[216:219], v[76:79], v[116:119], v[216:219]
s_waitcnt vmcnt(16) lgkmcnt(2)
ds_read_b128 v[52:55], v17 offset:4096
v_accvgpr_write_b32 a120, 0
v_mfma_f32_16x16x32_bf16 v[216:219], v[72:75], v[112:115], v[216:219]
s_barrier
ds_read_b128 v[56:59], v16 offset:6144
v_accvgpr_write_b32 a121, 0
v_mfma_f32_16x16x32_bf16 v[212:215], v[72:75], v[104:107], v[212:215]
s_waitcnt vmcnt(24)
v_cmp_gt_u32 vcc, 8, v3
s_cbranch_vccnz Lspin1
Lback2:
v_mfma_f32_16x16x32_bf16 v[212:215], v[76:79], v[108:111], v[212:215]
ds_read_b64_tr_b16 v[64:65], v8 offset:0
ds_read_b64_tr_b16 v[66:67], v8 offset:1024
v_mfma_f32_16x16x32_bf16 v[208:211], v[76:79], v[100:103], v[208:211]
s_add_u32 s72, s69, 144384
buffer_load_dwordx4 v5, s[4:7], s72 offen offset:3072 lds
v_mfma_f32_16x16x32_bf16 v[208:211], v[72:75], v[96:99], v[208:211]
ds_read_b64_tr_b16 v[68:69], v8 offset:8192
ds_read_b64_tr_b16 v[70:71], v8 offset:9216
v_mfma_f32_16x16x32_bf16 v[224:227], v[80:83], v[96:99], v[224:227]
ds_read_b64_tr_b16 v[72:73], v9 offset:0
v_accvgpr_write_b32 a122, 0
v_mfma_f32_16x16x32_bf16 v[224:227], v[84:87], v[100:103], v[224:227]
ds_read_b64_tr_b16 v[74:75], v9 offset:1024
v_accvgpr_write_b32 a123, 0
v_mfma_f32_16x16x32_bf16 v[228:231], v[84:87], v[108:111], v[228:231]
s_add_u32 m0, s63, 102400
v_accvgpr_write_b32 a124, 0
v_accvgpr_write_b32 a125, 0
v_mfma_f32_16x16x32_bf16 v[228:231], v[80:83], v[104:107], v[228:231]
s_add_u32 s72, s70, 0
buffer_load_dwordx4 v4, s[4:7], s72 offen lds
v_mfma_f32_16x16x32_bf16 v[232:235], v[80:83], v[112:115], v[232:235]
ds_read_b64_tr_b16 v[76:77], v9 offset:8192
v_accvgpr_write_b32 a126, 0
v_mfma_f32_16x16x32_bf16 v[232:235], v[84:87], v[116:119], v[232:235]
ds_read_b128 v[60:63], v17 offset:6144
v_accvgpr_write_b32 a127, 0
v_mfma_f32_16x16x32_bf16 v[236:239], v[84:87], v[124:127], v[236:239]
ds_read_b64_tr_b16 v[78:79], v9 offset:9216
v_mfma_f32_16x16x32_bf16 v[236:239], v[80:83], v[120:123], v[236:239]
v_mfma_f32_16x16x32_bf16 v[252:255], v[88:91], v[120:123], v[252:255]
s_add_u32 s72, s70, 15360
buffer_load_dwordx4 v5, s[4:7], s72 offen offset:1024 lds
v_mfma_f32_16x16x32_bf16 v[252:255], v[92:95], v[124:127], v[252:255]
ds_read_b64_tr_b16 v[80:81], v10 offset:0
v_mfma_f32_16x16x32_bf16 v[248:251], v[92:95], v[116:119], v[248:251]
ds_read_b64_tr_b16 v[82:83], v10 offset:1024
v_mfma_f32_16x16x32_bf16 v[248:251], v[88:91], v[112:115], v[248:251]
v_mfma_f32_16x16x32_bf16 v[244:247], v[88:91], v[104:107], v[244:247]
ds_read_b64_tr_b16 v[84:85], v10 offset:8192
v_mfma_f32_16x16x32_bf16 v[244:247], v[92:95], v[108:111], v[244:247]
ds_read_b64_tr_b16 v[86:87], v10 offset:9216
v_mfma_f32_16x16x32_bf16 v[240:243], v[92:95], v[100:103], v[240:243]
s_add_u32 s72, s70, 129024
buffer_load_dwordx4 v4, s[4:7], s72 offen offset:2048 lds
v_mfma_f32_16x16x32_bf16 v[240:243], v[88:91], v[96:99], v[240:243]
s_waitcnt lgkmcnt(5)
v_mfma_f32_16x16x32_bf16 v[128:131], v[64:67], v[32:35], v[128:131]
ds_read_b64_tr_b16 v[88:89], v11 offset:0
v_mfma_f32_16x16x32_bf16 v[128:131], v[68:71], v[36:39], v[128:131]
ds_read_b64_tr_b16 v[90:91], v11 offset:1024
v_mfma_f32_16x16x32_bf16 v[132:135], v[68:71], v[44:47], v[132:135]
v_mfma_f32_16x16x32_bf16 v[132:135], v[64:67], v[40:43], v[132:135]
s_add_u32 s72, s70, 144384
buffer_load_dwordx4 v5, s[4:7], s72 offen offset:3072 lds
v_mfma_f32_16x16x32_bf16 v[136:139], v[64:67], v[48:51], v[136:139]
ds_read_b64_tr_b16 v[92:93], v11 offset:8192
v_mfma_f32_16x16x32_bf16 v[136:139], v[68:71], v[52:55], v[136:139]
s_lshl_b32 s71, s73, 12
v_mfma_f32_16x16x32_bf16 v[140:143], v[68:71], v[60:63], v[140:143]
s_add_u32 s71, s71, s66
ds_read_b64_tr_b16 v[94:95], v11 offset:9216
v_mfma_f32_16x16x32_bf16 v[140:143], v[64:67], v[56:59], v[140:143]
s_waitcnt lgkmcnt(8)
v_mfma_f32_16x16x32_bf16 v[156:159], v[72:75], v[56:59], v[156:159]
s_add_u32 m0, s64, 32768
ds_read_b64_tr_b16 v[64:65], v12 offset:0
v_mfma_f32_16x16x32_bf16 v[156:159], v[76:79], v[60:63], v[156:159]
s_add_u32 s72, s71, 0
buffer_load_dwordx4 v6, s[12:15], s72 offen lds
v_mfma_f32_16x16x32_bf16 v[152:155], v[76:79], v[52:55], v[152:155]
s_add_u32 s73, s62, 15
ds_read_b64_tr_b16 v[66:67], v12 offset:1024
v_mfma_f32_16x16x32_bf16 v[152:155], v[72:75], v[48:51], v[152:155]
s_add_u32 s70, s73, s65
v_mfma_f32_16x16x32_bf16 v[148:151], v[72:75], v[40:43], v[148:151]
s_and_b32 s70, s70, 3
ds_read_b64_tr_b16 v[68:69], v12 offset:8192
v_mfma_f32_16x16x32_bf16 v[148:151], v[76:79], v[44:47], v[148:151]
s_and_b32 s73, s73, 12
ds_read_b64_tr_b16 v[70:71], v12 offset:9216
v_mfma_f32_16x16x32_bf16 v[144:147], v[76:79], v[36:39], v[144:147]
s_add_u32 s72, s71, 31744
buffer_load_dwordx4 v6, s[12:15], s72 offen offset:1024 lds
v_mfma_f32_16x16x32_bf16 v[144:147], v[72:75], v[32:35], v[144:147]
s_waitcnt lgkmcnt(8)
v_mfma_f32_16x16x32_bf16 v[160:163], v[80:83], v[32:35], v[160:163]
s_or_b32 s73, s73, s70
ds_read_b64_tr_b16 v[72:73], v13 offset:0
v_mfma_f32_16x16x32_bf16 v[160:163], v[84:87], v[36:39], v[160:163]
s_lshl_b32 s73, s73, 7
ds_read_b64_tr_b16 v[74:75], v13 offset:1024
v_mfma_f32_16x16x32_bf16 v[164:167], v[84:87], v[44:47], v[164:167]
s_add_u32 s69, s73, s67
v_mfma_f32_16x16x32_bf16 v[164:167], v[80:83], v[40:43], v[164:167]
s_add_u32 s72, s71, 63488
buffer_load_dwordx4 v7, s[12:15], s72 offen offset:2048 lds
v_mfma_f32_16x16x32_bf16 v[168:171], v[80:83], v[48:51], v[168:171]
s_waitcnt vmcnt(15)
ds_read_b64_tr_b16 v[76:77], v13 offset:8192
v_mfma_f32_16x16x32_bf16 v[168:171], v[84:87], v[52:55], v[168:171]
s_add_u32 s70, s73, s68
ds_read_b128 v[96:99], v18 offset:0
v_mfma_f32_16x16x32_bf16 v[172:175], v[84:87], v[60:63], v[172:175]
ds_read_b64_tr_b16 v[78:79], v13 offset:9216
v_mfma_f32_16x16x32_bf16 v[172:175], v[80:83], v[56:59], v[172:175]
s_waitcnt lgkmcnt(9)
ds_read_b128 v[100:103], v19 offset:0
v_mfma_f32_16x16x32_bf16 v[188:191], v[88:91], v[56:59], v[188:191]
s_add_u32 s72, s71, 95232
buffer_load_dwordx4 v7, s[12:15], s72 offen offset:3072 lds
v_mfma_f32_16x16x32_bf16 v[188:191], v[92:95], v[60:63], v[188:191]
ds_read_b64_tr_b16 v[80:81], v14 offset:0
v_mfma_f32_16x16x32_bf16 v[184:187], v[92:95], v[52:55], v[184:187]
ds_read_b64_tr_b16 v[82:83], v14 offset:1024
v_mfma_f32_16x16x32_bf16 v[184:187], v[88:91], v[48:51], v[184:187]
v_mfma_f32_16x16x32_bf16 v[180:183], v[88:91], v[40:43], v[180:183]
ds_read_b64_tr_b16 v[84:85], v14 offset:8192
v_mfma_f32_16x16x32_bf16 v[180:183], v[92:95], v[44:47], v[180:183]
s_add_u32 m0, s63, 131072
ds_read_b64_tr_b16 v[86:87], v14 offset:9216
v_mfma_f32_16x16x32_bf16 v[176:179], v[92:95], v[36:39], v[176:179]
s_add_u32 s72, s69, 0
buffer_load_dwordx4 v4, s[4:7], s72 offen lds
v_mfma_f32_16x16x32_bf16 v[176:179], v[88:91], v[32:35], v[176:179]
s_waitcnt lgkmcnt(10)
ds_read_b128 v[104:107], v18 offset:2048
v_mfma_f32_16x16x32_bf16 v[192:195], v[64:67], v[32:35], v[192:195]
ds_read_b64_tr_b16 v[88:89], v15 offset:0
ds_read_b64_tr_b16 v[90:91], v15 offset:1024
v_mfma_f32_16x16x32_bf16 v[192:195], v[68:71], v[36:39], v[192:195]
ds_read_b64_tr_b16 v[92:93], v15 offset:8192
v_mfma_f32_16x16x32_bf16 v[196:199], v[68:71], v[44:47], v[196:199]
s_and_b32 s75, s91, 0xfffffc7f
v_lshrrev_b32 v2, 3, v0
v_lshlrev_b32 v2, 7, v2
v_mfma_f32_16x16x32_bf16 v[196:199], v[64:67], v[40:43], v[196:199]
s_add_u32 s72, s69, 15360
buffer_load_dwordx4 v5, s[4:7], s72 offen offset:1024 lds
v_mfma_f32_16x16x32_bf16 v[200:203], v[64:67], v[48:51], v[200:203]
buffer_load_dword v3, v2, s[44:47], s75 offen sc1
v_mfma_f32_16x16x32_bf16 v[200:203], v[68:71], v[52:55], v[200:203]
ds_read_b64_tr_b16 v[94:95], v15 offset:9216
v_mfma_f32_16x16x32_bf16 v[204:207], v[68:71], v[60:63], v[204:207]
ds_read_b128 v[108:111], v19 offset:2048
v_mfma_f32_16x16x32_bf16 v[204:207], v[64:67], v[56:59], v[204:207]
s_waitcnt lgkmcnt(11)
v_mfma_f32_16x16x32_bf16 v[220:223], v[72:75], v[56:59], v[220:223]
s_add_u32 s72, s69, 129024
buffer_load_dwordx4 v4, s[4:7], s72 offen offset:2048 lds
v_mfma_f32_16x16x32_bf16 v[220:223], v[76:79], v[60:63], v[220:223]
ds_read_b128 v[112:115], v18 offset:4096
v_mfma_f32_16x16x32_bf16 v[216:219], v[76:79], v[52:55], v[216:219]
s_waitcnt vmcnt(16) lgkmcnt(2)
ds_read_b128 v[116:119], v19 offset:4096
v_mfma_f32_16x16x32_bf16 v[216:219], v[72:75], v[48:51], v[216:219]
s_barrier
v_mfma_f32_16x16x32_bf16 v[212:215], v[72:75], v[40:43], v[212:215]
ds_read_b64_tr_b16 v[64:65], v8 offset:16384
ds_read_b64_tr_b16 v[66:67], v8 offset:17408
v_mfma_f32_16x16x32_bf16 v[212:215], v[76:79], v[44:47], v[212:215]
ds_read_b64_tr_b16 v[68:69], v8 offset:24576
v_mfma_f32_16x16x32_bf16 v[208:211], v[76:79], v[36:39], v[208:211]
s_add_u32 s72, s69, 144384
buffer_load_dwordx4 v5, s[4:7], s72 offen offset:3072 lds
v_mfma_f32_16x16x32_bf16 v[208:211], v[72:75], v[32:35], v[208:211]
ds_read_b64_tr_b16 v[70:71], v8 offset:25600
v_mfma_f32_16x16x32_bf16 v[224:227], v[80:83], v[32:35], v[224:227]
ds_read_b64_tr_b16 v[72:73], v9 offset:16384
v_mfma_f32_16x16x32_bf16 v[224:227], v[84:87], v[36:39], v[224:227]
ds_read_b64_tr_b16 v[74:75], v9 offset:17408
v_mfma_f32_16x16x32_bf16 v[228:231], v[84:87], v[44:47], v[228:231]
s_add_u32 m0, s63, 135168
ds_read_b128 v[120:123], v18 offset:6144
v_mfma_f32_16x16x32_bf16 v[228:231], v[80:83], v[40:43], v[228:231]
s_add_u32 s72, s70, 0
buffer_load_dwordx4 v4, s[4:7], s72 offen lds
v_mfma_f32_16x16x32_bf16 v[232:235], v[80:83], v[48:51], v[232:235]
ds_read_b64_tr_b16 v[76:77], v9 offset:24576
v_mfma_f32_16x16x32_bf16 v[232:235], v[84:87], v[52:55], v[232:235]
ds_read_b128 v[124:127], v19 offset:6144
v_mfma_f32_16x16x32_bf16 v[236:239], v[84:87], v[60:63], v[236:239]
ds_read_b64_tr_b16 v[78:79], v9 offset:25600
v_mfma_f32_16x16x32_bf16 v[236:239], v[80:83], v[56:59], v[236:239]
v_mfma_f32_16x16x32_bf16 v[252:255], v[88:91], v[56:59], v[252:255]
s_add_u32 s72, s70, 15360
buffer_load_dwordx4 v5, s[4:7], s72 offen offset:1024 lds
v_mfma_f32_16x16x32_bf16 v[252:255], v[92:95], v[60:63], v[252:255]
ds_read_b64_tr_b16 v[80:81], v10 offset:16384
v_mfma_f32_16x16x32_bf16 v[248:251], v[92:95], v[52:55], v[248:251]
ds_read_b64_tr_b16 v[82:83], v10 offset:17408
v_mfma_f32_16x16x32_bf16 v[248:251], v[88:91], v[48:51], v[248:251]
v_mfma_f32_16x16x32_bf16 v[244:247], v[88:91], v[40:43], v[244:247]
ds_read_b64_tr_b16 v[84:85], v10 offset:24576
v_mfma_f32_16x16x32_bf16 v[244:247], v[92:95], v[44:47], v[244:247]
ds_read_b64_tr_b16 v[86:87], v10 offset:25600
v_mfma_f32_16x16x32_bf16 v[240:243], v[92:95], v[36:39], v[240:243]
s_add_u32 s72, s70, 129024
buffer_load_dwordx4 v4, s[4:7], s72 offen offset:2048 lds
v_mfma_f32_16x16x32_bf16 v[240:243], v[88:91], v[32:35], v[240:243]
s_waitcnt lgkmcnt(5)
v_mfma_f32_16x16x32_bf16 v[128:131], v[64:67], v[96:99], v[128:131]
ds_read_b64_tr_b16 v[88:89], v11 offset:16384
v_mfma_f32_16x16x32_bf16 v[128:131], v[68:71], v[100:103], v[128:131]
ds_read_b64_tr_b16 v[90:91], v11 offset:17408
v_mfma_f32_16x16x32_bf16 v[132:135], v[68:71], v[108:111], v[132:135]
v_mfma_f32_16x16x32_bf16 v[132:135], v[64:67], v[104:107], v[132:135]
s_add_u32 s72, s70, 144384
buffer_load_dwordx4 v5, s[4:7], s72 offen offset:3072 lds
v_mfma_f32_16x16x32_bf16 v[136:139], v[64:67], v[112:115], v[136:139]
ds_read_b64_tr_b16 v[92:93], v11 offset:24576
v_mfma_f32_16x16x32_bf16 v[136:139], v[68:71], v[116:119], v[136:139]
s_lshl_b32 s71, s73, 12
v_mfma_f32_16x16x32_bf16 v[140:143], v[68:71], v[124:127], v[140:143]
s_add_u32 s71, s71, s66
ds_read_b64_tr_b16 v[94:95], v11 offset:25600
v_mfma_f32_16x16x32_bf16 v[140:143], v[64:67], v[120:123], v[140:143]
s_waitcnt lgkmcnt(8)
v_mfma_f32_16x16x32_bf16 v[156:159], v[72:75], v[120:123], v[156:159]
s_add_u32 m0, s64, 0
ds_read_b64_tr_b16 v[64:65], v12 offset:16384
v_mfma_f32_16x16x32_bf16 v[156:159], v[76:79], v[124:127], v[156:159]
s_add_u32 s72, s71, 0
buffer_load_dwordx4 v6, s[12:15], s72 offen lds
v_mfma_f32_16x16x32_bf16 v[152:155], v[76:79], v[116:119], v[152:155]
ds_read_b64_tr_b16 v[66:67], v12 offset:17408
v_mfma_f32_16x16x32_bf16 v[152:155], v[72:75], v[112:115], v[152:155]
v_mfma_f32_16x16x32_bf16 v[148:151], v[72:75], v[104:107], v[148:151]
ds_read_b64_tr_b16 v[68:69], v12 offset:24576
v_mfma_f32_16x16x32_bf16 v[148:151], v[76:79], v[108:111], v[148:151]
ds_read_b64_tr_b16 v[70:71], v12 offset:25600
v_mfma_f32_16x16x32_bf16 v[144:147], v[76:79], v[100:103], v[144:147]
s_add_u32 s72, s71, 31744
buffer_load_dwordx4 v6, s[12:15], s72 offen offset:1024 lds
v_mfma_f32_16x16x32_bf16 v[144:147], v[72:75], v[96:99], v[144:147]
s_waitcnt lgkmcnt(8)
v_mfma_f32_16x16x32_bf16 v[160:163], v[80:83], v[96:99], v[160:163]
ds_read_b64_tr_b16 v[72:73], v13 offset:16384
v_mfma_f32_16x16x32_bf16 v[160:163], v[84:87], v[100:103], v[160:163]
ds_read_b64_tr_b16 v[74:75], v13 offset:17408
v_mfma_f32_16x16x32_bf16 v[164:167], v[84:87], v[108:111], v[164:167]
v_mfma_f32_16x16x32_bf16 v[164:167], v[80:83], v[104:107], v[164:167]
s_add_u32 s72, s71, 63488
buffer_load_dwordx4 v7, s[12:15], s72 offen offset:2048 lds
v_mfma_f32_16x16x32_bf16 v[168:171], v[80:83], v[112:115], v[168:171]
s_waitcnt vmcnt(16)
ds_read_b64_tr_b16 v[76:77], v13 offset:24576
v_mfma_f32_16x16x32_bf16 v[168:171], v[84:87], v[116:119], v[168:171]
ds_read_b128 v[32:35], v18 offset:32768
v_mfma_f32_16x16x32_bf16 v[172:175], v[84:87], v[124:127], v[172:175]
ds_read_b64_tr_b16 v[78:79], v13 offset:25600
v_mfma_f32_16x16x32_bf16 v[172:175], v[80:83], v[120:123], v[172:175]
s_waitcnt lgkmcnt(9)
ds_read_b128 v[36:39], v19 offset:32768
v_mfma_f32_16x16x32_bf16 v[188:191], v[88:91], v[120:123], v[188:191]
s_add_u32 s72, s71, 95232
buffer_load_dwordx4 v7, s[12:15], s72 offen offset:3072 lds
v_mfma_f32_16x16x32_bf16 v[188:191], v[92:95], v[124:127], v[188:191]
v_accvgpr_write_b32 a0, -1
v_accvgpr_write_b32 a1, -1
v_mfma_f32_16x16x32_bf16 v[184:187], v[92:95], v[116:119], v[184:187]
v_accvgpr_write_b32 a2, -1
v_accvgpr_write_b32 a3, -1
v_mfma_f32_16x16x32_bf16 v[184:187], v[88:91], v[112:115], v[184:187]
s_add_u32 s80, s93, 0x3a00000
ds_read_b64_tr_b16 v[80:81], v14 offset:16384
v_mfma_f32_16x16x32_bf16 v[180:183], v[88:91], v[104:107], v[180:183]
ds_read_b64_tr_b16 v[82:83], v14 offset:17408
v_mfma_f32_16x16x32_bf16 v[180:183], v[92:95], v[108:111], v[180:183]
ds_read_b64_tr_b16 v[84:85], v14 offset:24576
v_mfma_f32_16x16x32_bf16 v[176:179], v[92:95], v[100:103], v[176:179]
ds_read_b64_tr_b16 v[86:87], v14 offset:25600
v_mfma_f32_16x16x32_bf16 v[176:179], v[88:91], v[96:99], v[176:179]
s_waitcnt lgkmcnt(10)
ds_read_b128 v[40:43], v18 offset:34816
v_mfma_f32_16x16x32_bf16 v[192:195], v[64:67], v[96:99], v[192:195]
s_waitcnt vmcnt(10)
v_cmp_gt_u32 vcc, 1, v3
s_cbranch_vccnz Lspin4
Lback5:
v_mfma_f32_16x16x32_bf16 v[192:195], v[68:71], v[100:103], v[192:195]
s_add_u32 m0, s64, 49152
ds_read_b64_tr_b16 v[88:89], v15 offset:16384
ds_read_b64_tr_b16 v[90:91], v15 offset:17408
v_mfma_f32_16x16x32_bf16 v[196:199], v[68:71], v[108:111], v[196:199]
s_add_u32 s72, s81, 16384
buffer_load_dwordx4 v1, s[44:47], s72 offen sc1 lds
v_mfma_f32_16x16x32_bf16 v[196:199], v[64:67], v[104:107], v[196:199]
ds_read_b64_tr_b16 v[92:93], v15 offset:24576
v_mfma_f32_16x16x32_bf16 v[200:203], v[64:67], v[112:115], v[200:203]
ds_read_b64_tr_b16 v[94:95], v15 offset:25600
v_mfma_f32_16x16x32_bf16 v[200:203], v[68:71], v[116:119], v[200:203]
buffer_load_dwordx4 v1, s[44:47], s72 offen offset:1024 sc1 lds
v_mfma_f32_16x16x32_bf16 v[204:207], v[68:71], v[124:127], v[204:207]
ds_read_b128 v[44:47], v19 offset:34816
v_mfma_f32_16x16x32_bf16 v[204:207], v[64:67], v[120:123], v[204:207]
s_waitcnt lgkmcnt(11)
v_mfma_f32_16x16x32_bf16 v[220:223], v[72:75], v[120:123], v[220:223]
ds_read_b128 v[48:51], v18 offset:36864
v_mfma_f32_16x16x32_bf16 v[220:223], v[76:79], v[124:127], v[220:223]
ds_read_b128 v[52:55], v19 offset:36864
v_mfma_f32_16x16x32_bf16 v[216:219], v[76:79], v[116:119], v[216:219]
s_waitcnt vmcnt(15) lgkmcnt(3)
buffer_load_dwordx4 v1, s[44:47], s72 offen offset:2048 sc1 lds
v_mfma_f32_16x16x32_bf16 v[216:219], v[72:75], v[112:115], v[216:219]
s_barrier
ds_read_b128 v[56:59], v18 offset:38912
v_mfma_f32_16x16x32_bf16 v[212:215], v[72:75], v[104:107], v[212:215]
ds_read_b64_tr_b16 v[64:65], v8 offset:32768
ds_read_b64_tr_b16 v[66:67], v8 offset:33792
v_mfma_f32_16x16x32_bf16 v[212:215], v[76:79], v[108:111], v[212:215]
ds_read_b64_tr_b16 v[68:69], v8 offset:40960
v_mfma_f32_16x16x32_bf16 v[208:211], v[76:79], v[100:103], v[208:211]
ds_read_b64_tr_b16 v[70:71], v8 offset:41984
v_mfma_f32_16x16x32_bf16 v[208:211], v[72:75], v[96:99], v[208:211]
buffer_load_dwordx4 v1, s[44:47], s72 offen offset:3072 sc1 lds
v_mfma_f32_16x16x32_bf16 v[224:227], v[80:83], v[96:99], v[224:227]
s_add_u32 s81, s81, 0x8000
ds_read_b64_tr_b16 v[72:73], v9 offset:32768
v_mfma_f32_16x16x32_bf16 v[224:227], v[84:87], v[100:103], v[224:227]
s_add_u32 m0, s64, 81920
ds_read_b64_tr_b16 v[74:75], v9 offset:33792
v_mfma_f32_16x16x32_bf16 v[228:231], v[84:87], v[108:111], v[228:231]
s_add_u32 s72, s81, 16384
buffer_load_dwordx4 v1, s[44:47], s72 offen sc1 lds
v_mfma_f32_16x16x32_bf16 v[228:231], v[80:83], v[104:107], v[228:231]
ds_read_b128 v[60:63], v19 offset:38912
v_mfma_f32_16x16x32_bf16 v[232:235], v[80:83], v[112:115], v[232:235]
buffer_load_dwordx4 v1, s[44:47], s72 offen offset:1024 sc1 lds
v_mfma_f32_16x16x32_bf16 v[232:235], v[84:87], v[116:119], v[232:235]
ds_read_b64_tr_b16 v[76:77], v9 offset:40960
v_mfma_f32_16x16x32_bf16 v[236:239], v[84:87], v[124:127], v[236:239]
ds_read_b64_tr_b16 v[78:79], v9 offset:41984
v_mfma_f32_16x16x32_bf16 v[236:239], v[80:83], v[120:123], v[236:239]
v_mfma_f32_16x16x32_bf16 v[252:255], v[88:91], v[120:123], v[252:255]
ds_read_b64_tr_b16 v[80:81], v10 offset:32768
v_mfma_f32_16x16x32_bf16 v[252:255], v[92:95], v[124:127], v[252:255]
buffer_load_dwordx4 v1, s[44:47], s72 offen offset:2048 sc1 lds
v_mfma_f32_16x16x32_bf16 v[248:251], v[92:95], v[116:119], v[248:251]
ds_read_b64_tr_b16 v[82:83], v10 offset:33792
v_mfma_f32_16x16x32_bf16 v[248:251], v[88:91], v[112:115], v[248:251]
v_mfma_f32_16x16x32_bf16 v[244:247], v[88:91], v[104:107], v[244:247]
ds_read_b64_tr_b16 v[84:85], v10 offset:40960
v_mfma_f32_16x16x32_bf16 v[244:247], v[92:95], v[108:111], v[244:247]
buffer_load_dwordx4 v1, s[44:47], s72 offen offset:3072 sc1 lds
v_mfma_f32_16x16x32_bf16 v[240:243], v[92:95], v[100:103], v[240:243]
ds_read_b64_tr_b16 v[86:87], v10 offset:41984
v_mfma_f32_16x16x32_bf16 v[240:243], v[88:91], v[96:99], v[240:243]
s_waitcnt lgkmcnt(6)
v_mfma_f32_16x16x32_bf16 v[128:131], v[64:67], v[32:35], v[128:131]
ds_read_b64_tr_b16 v[88:89], v11 offset:32768
v_mfma_f32_16x16x32_bf16 v[128:131], v[68:71], v[36:39], v[128:131]
ds_read_b64_tr_b16 v[90:91], v11 offset:33792
v_mfma_f32_16x16x32_bf16 v[132:135], v[68:71], v[44:47], v[132:135]
s_add_u32 m0, s64, 65536
v_mfma_f32_16x16x32_bf16 v[132:135], v[64:67], v[40:43], v[132:135]
s_add_u32 s72, s81, 0
buffer_load_dwordx4 v1, s[44:47], s72 offen sc1 lds
v_mfma_f32_16x16x32_bf16 v[136:139], v[64:67], v[48:51], v[136:139]
ds_read_b64_tr_b16 v[92:93], v11 offset:40960
v_mfma_f32_16x16x32_bf16 v[136:139], v[68:71], v[52:55], v[136:139]
ds_read_b64_tr_b16 v[94:95], v11 offset:41984
v_mfma_f32_16x16x32_bf16 v[140:143], v[68:71], v[60:63], v[140:143]
v_mfma_f32_16x16x32_bf16 v[140:143], v[64:67], v[56:59], v[140:143]
s_waitcnt lgkmcnt(8)
buffer_load_dwordx4 v1, s[44:47], s72 offen offset:1024 sc1 lds
v_mfma_f32_16x16x32_bf16 v[156:159], v[72:75], v[56:59], v[156:159]
ds_read_b64_tr_b16 v[64:65], v12 offset:32768
v_mfma_f32_16x16x32_bf16 v[156:159], v[76:79], v[60:63], v[156:159]
ds_read_b64_tr_b16 v[66:67], v12 offset:33792
v_mfma_f32_16x16x32_bf16 v[152:155], v[76:79], v[52:55], v[152:155]
v_mfma_f32_16x16x32_bf16 v[152:155], v[72:75], v[48:51], v[152:155]
buffer_load_dwordx4 v1, s[44:47], s72 offen offset:2048 sc1 lds
v_mfma_f32_16x16x32_bf16 v[148:151], v[72:75], v[40:43], v[148:151]
ds_read_b64_tr_b16 v[68:69], v12 offset:40960
v_mfma_f32_16x16x32_bf16 v[148:151], v[76:79], v[44:47], v[148:151]
v_mfma_f32_16x16x32_bf16 v[144:147], v[76:79], v[36:39], v[144:147]
ds_read_b64_tr_b16 v[70:71], v12 offset:41984
v_mfma_f32_16x16x32_bf16 v[144:147], v[72:75], v[32:35], v[144:147]
s_waitcnt lgkmcnt(8)
v_mfma_f32_16x16x32_bf16 v[160:163], v[80:83], v[32:35], v[160:163]
buffer_load_dwordx4 v1, s[44:47], s72 offen offset:3072 sc1 lds
v_mfma_f32_16x16x32_bf16 v[160:163], v[84:87], v[36:39], v[160:163]
ds_read_b64_tr_b16 v[72:73], v13 offset:32768
v_mfma_f32_16x16x32_bf16 v[164:167], v[84:87], v[44:47], v[164:167]
ds_read_b64_tr_b16 v[74:75], v13 offset:33792
v_mfma_f32_16x16x32_bf16 v[164:167], v[80:83], v[40:43], v[164:167]
v_mfma_f32_16x16x32_bf16 v[168:171], v[80:83], v[48:51], v[168:171]
s_waitcnt vmcnt(16)
ds_read_b64_tr_b16 v[76:77], v13 offset:40960
v_mfma_f32_16x16x32_bf16 v[168:171], v[84:87], v[52:55], v[168:171]
ds_read_b128 v[96:99], v16 offset:0
v_mfma_f32_16x16x32_bf16 v[172:175], v[84:87], v[60:63], v[172:175]
ds_read_b64_tr_b16 v[78:79], v13 offset:41984
v_mfma_f32_16x16x32_bf16 v[172:175], v[80:83], v[56:59], v[172:175]
s_waitcnt lgkmcnt(9)
v_mfma_f32_16x16x32_bf16 v[188:191], v[88:91], v[56:59], v[188:191]
ds_read_b64_tr_b16 v[80:81], v14 offset:32768
v_mfma_f32_16x16x32_bf16 v[188:191], v[92:95], v[60:63], v[188:191]
ds_read_b128 v[100:103], v17 offset:0
v_mfma_f32_16x16x32_bf16 v[184:187], v[92:95], v[52:55], v[184:187]
ds_read_b64_tr_b16 v[82:83], v14 offset:33792
v_mfma_f32_16x16x32_bf16 v[184:187], v[88:91], v[48:51], v[184:187]
v_mfma_f32_16x16x32_bf16 v[180:183], v[88:91], v[40:43], v[180:183]
ds_read_b64_tr_b16 v[84:85], v14 offset:40960
v_mfma_f32_16x16x32_bf16 v[180:183], v[92:95], v[44:47], v[180:183]
ds_read_b128 v[104:107], v16 offset:2048
v_mfma_f32_16x16x32_bf16 v[176:179], v[92:95], v[36:39], v[176:179]
ds_read_b64_tr_b16 v[86:87], v14 offset:41984
v_mfma_f32_16x16x32_bf16 v[176:179], v[88:91], v[32:35], v[176:179]
s_waitcnt lgkmcnt(11)
v_mfma_f32_16x16x32_bf16 v[192:195], v[64:67], v[32:35], v[192:195]
ds_read_b64_tr_b16 v[88:89], v15 offset:32768
v_mfma_f32_16x16x32_bf16 v[192:195], v[68:71], v[36:39], v[192:195]
ds_read_b64_tr_b16 v[90:91], v15 offset:33792
v_mfma_f32_16x16x32_bf16 v[196:199], v[68:71], v[44:47], v[196:199]
ds_read_b128 v[108:111], v17 offset:2048
v_mfma_f32_16x16x32_bf16 v[196:199], v[64:67], v[40:43], v[196:199]
ds_read_b64_tr_b16 v[92:93], v15 offset:40960
v_mfma_f32_16x16x32_bf16 v[200:203], v[64:67], v[48:51], v[200:203]
ds_read_b64_tr_b16 v[94:95], v15 offset:41984
v_mfma_f32_16x16x32_bf16 v[200:203], v[68:71], v[52:55], v[200:203]
v_mfma_f32_16x16x32_bf16 v[204:207], v[68:71], v[60:63], v[204:207]
ds_read_b128 v[112:115], v16 offset:4096
v_mfma_f32_16x16x32_bf16 v[204:207], v[64:67], v[56:59], v[204:207]
s_waitcnt lgkmcnt(12)
v_mfma_f32_16x16x32_bf16 v[220:223], v[72:75], v[56:59], v[220:223]
ds_read_b128 v[116:119], v17 offset:4096
v_mfma_f32_16x16x32_bf16 v[220:223], v[76:79], v[60:63], v[220:223]
v_mfma_f32_16x16x32_bf16 v[216:219], v[76:79], v[52:55], v[216:219]
s_waitcnt vmcnt(12) lgkmcnt(2)
ds_read_b128 v[120:123], v16 offset:6144
v_mfma_f32_16x16x32_bf16 v[216:219], v[72:75], v[48:51], v[216:219]
s_barrier
v_mfma_f32_16x16x32_bf16 v[212:215], v[72:75], v[40:43], v[212:215]
s_add_u32 s81, s81, 0x8000
ds_read_b64_tr_b16 v[64:65], v8 offset:0
ds_read_b64_tr_b16 v[66:67], v8 offset:1024
v_mfma_f32_16x16x32_bf16 v[212:215], v[76:79], v[44:47], v[212:215]
s_add_u32 m0, s64, 114688
ds_read_b64_tr_b16 v[68:69], v8 offset:8192
v_mfma_f32_16x16x32_bf16 v[208:211], v[76:79], v[36:39], v[208:211]
s_add_u32 s72, s81, 16384
buffer_load_dwordx4 v1, s[44:47], s72 offen sc1 lds
v_mfma_f32_16x16x32_bf16 v[208:211], v[72:75], v[32:35], v[208:211]
ds_read_b64_tr_b16 v[70:71], v8 offset:9216
v_mfma_f32_16x16x32_bf16 v[224:227], v[80:83], v[32:35], v[224:227]
buffer_load_dwordx4 v1, s[44:47], s72 offen offset:1024 sc1 lds
v_mfma_f32_16x16x32_bf16 v[224:227], v[84:87], v[36:39], v[224:227]
ds_read_b64_tr_b16 v[72:73], v9 offset:0
v_mfma_f32_16x16x32_bf16 v[228:231], v[84:87], v[44:47], v[228:231]
ds_read_b64_tr_b16 v[74:75], v9 offset:1024
v_mfma_f32_16x16x32_bf16 v[228:231], v[80:83], v[40:43], v[228:231]
ds_read_b128 v[124:127], v17 offset:6144
v_mfma_f32_16x16x32_bf16 v[232:235], v[80:83], v[48:51], v[232:235]
ds_read_b64_tr_b16 v[76:77], v9 offset:8192
v_mfma_f32_16x16x32_bf16 v[232:235], v[84:87], v[52:55], v[232:235]
buffer_store_dwordx4 a[0:3], v1, s[44:47], s80 offen sc1
v_mfma_f32_16x16x32_bf16 v[236:239], v[84:87], v[60:63], v[236:239]
ds_read_b64_tr_b16 v[78:79], v9 offset:9216
v_mfma_f32_16x16x32_bf16 v[236:239], v[80:83], v[56:59], v[236:239]
v_mfma_f32_16x16x32_bf16 v[252:255], v[88:91], v[56:59], v[252:255]
ds_read_b64_tr_b16 v[80:81], v10 offset:0
v_mfma_f32_16x16x32_bf16 v[252:255], v[92:95], v[60:63], v[252:255]
ds_read_b64_tr_b16 v[82:83], v10 offset:1024
v_mfma_f32_16x16x32_bf16 v[248:251], v[92:95], v[52:55], v[248:251]
buffer_load_dwordx4 v1, s[44:47], s72 offen offset:2048 sc1 lds
v_mfma_f32_16x16x32_bf16 v[248:251], v[88:91], v[48:51], v[248:251]
v_mfma_f32_16x16x32_bf16 v[244:247], v[88:91], v[40:43], v[244:247]
ds_read_b64_tr_b16 v[84:85], v10 offset:8192
v_mfma_f32_16x16x32_bf16 v[244:247], v[92:95], v[44:47], v[244:247]
ds_read_b64_tr_b16 v[86:87], v10 offset:9216
v_mfma_f32_16x16x32_bf16 v[240:243], v[92:95], v[36:39], v[240:243]
buffer_load_dwordx4 v1, s[44:47], s72 offen offset:3072 sc1 lds
v_mfma_f32_16x16x32_bf16 v[240:243], v[88:91], v[32:35], v[240:243]
s_waitcnt lgkmcnt(6)
v_mfma_f32_16x16x32_bf16 v[128:131], v[64:67], v[96:99], v[128:131]
ds_read_b64_tr_b16 v[88:89], v11 offset:0
v_mfma_f32_16x16x32_bf16 v[128:131], v[68:71], v[100:103], v[128:131]
ds_read_b64_tr_b16 v[90:91], v11 offset:1024
v_mfma_f32_16x16x32_bf16 v[132:135], v[68:71], v[108:111], v[132:135]
v_mfma_f32_16x16x32_bf16 v[132:135], v[64:67], v[104:107], v[132:135]
buffer_store_dwordx4 a[0:3], v1, s[44:47], s80 offen offset:1024 sc1
v_mfma_f32_16x16x32_bf16 v[136:139], v[64:67], v[112:115], v[136:139]
ds_read_b64_tr_b16 v[92:93], v11 offset:8192
v_mfma_f32_16x16x32_bf16 v[136:139], v[68:71], v[116:119], v[136:139]
v_mfma_f32_16x16x32_bf16 v[140:143], v[68:71], v[124:127], v[140:143]
ds_read_b64_tr_b16 v[94:95], v11 offset:9216
v_mfma_f32_16x16x32_bf16 v[140:143], v[64:67], v[120:123], v[140:143]
s_waitcnt lgkmcnt(8)
v_mfma_f32_16x16x32_bf16 v[156:159], v[72:75], v[120:123], v[156:159]
s_add_u32 m0, s64, 98304
ds_read_b64_tr_b16 v[64:65], v12 offset:0
v_mfma_f32_16x16x32_bf16 v[156:159], v[76:79], v[124:127], v[156:159]
s_add_u32 s72, s81, 0
buffer_load_dwordx4 v1, s[44:47], s72 offen sc1 lds
v_mfma_f32_16x16x32_bf16 v[152:155], v[76:79], v[116:119], v[152:155]
ds_read_b64_tr_b16 v[66:67], v12 offset:1024
v_mfma_f32_16x16x32_bf16 v[152:155], v[72:75], v[112:115], v[152:155]
v_mfma_f32_16x16x32_bf16 v[148:151], v[72:75], v[104:107], v[148:151]
buffer_load_dwordx4 v1, s[44:47], s72 offen offset:1024 sc1 lds
v_mfma_f32_16x16x32_bf16 v[148:151], v[76:79], v[108:111], v[148:151]
ds_read_b64_tr_b16 v[68:69], v12 offset:8192
v_mfma_f32_16x16x32_bf16 v[144:147], v[76:79], v[100:103], v[144:147]
ds_read_b64_tr_b16 v[70:71], v12 offset:9216
v_mfma_f32_16x16x32_bf16 v[144:147], v[72:75], v[96:99], v[144:147]
s_waitcnt lgkmcnt(8)
v_mfma_f32_16x16x32_bf16 v[160:163], v[80:83], v[96:99], v[160:163]
ds_read_b64_tr_b16 v[72:73], v13 offset:0
v_mfma_f32_16x16x32_bf16 v[160:163], v[84:87], v[100:103], v[160:163]
buffer_store_dwordx4 a[0:3], v1, s[44:47], s80 offen offset:2048 sc1
v_mfma_f32_16x16x32_bf16 v[164:167], v[84:87], v[108:111], v[164:167]
ds_read_b64_tr_b16 v[74:75], v13 offset:1024
v_mfma_f32_16x16x32_bf16 v[164:167], v[80:83], v[104:107], v[164:167]
v_mfma_f32_16x16x32_bf16 v[168:171], v[80:83], v[112:115], v[168:171]
ds_read_b64_tr_b16 v[76:77], v13 offset:8192
v_cvt_pk_bf16_f32 v48, v136, v137
v_mfma_f32_16x16x32_bf16 v[168:171], v[84:87], v[116:119], v[168:171]
ds_read_b64_tr_b16 v[78:79], v13 offset:9216
v_cvt_pk_bf16_f32 v49, v138, v139
v_mfma_f32_16x16x32_bf16 v[172:175], v[84:87], v[124:127], v[172:175]
buffer_load_dwordx4 v1, s[44:47], s72 offen offset:2048 sc1 lds
v_mfma_f32_16x16x32_bf16 v[172:175], v[80:83], v[120:123], v[172:175]
s_waitcnt lgkmcnt(8)
v_cvt_pk_bf16_f32 v50, v152, v153
v_cvt_pk_bf16_f32 v51, v154, v155
v_mfma_f32_16x16x32_bf16 v[188:191], v[88:91], v[120:123], v[188:191]
v_add_u32 v2, 0x8000, v1
v_cvt_pk_bf16_f32 v32, v132, v133
v_mfma_f32_16x16x32_bf16 v[188:191], v[92:95], v[124:127], v[188:191]
ds_read_b64_tr_b16 v[80:81], v14 offset:0
v_cvt_pk_bf16_f32 v33, v134, v135
v_mfma_f32_16x16x32_bf16 v[184:187], v[92:95], v[116:119], v[184:187]
buffer_load_dwordx4 v1, s[44:47], s72 offen offset:3072 sc1 lds
v_mfma_f32_16x16x32_bf16 v[184:187], v[88:91], v[112:115], v[184:187]
ds_read_b64_tr_b16 v[82:83], v14 offset:1024
v_cvt_pk_bf16_f32 v34, v148, v149
v_mfma_f32_16x16x32_bf16 v[180:183], v[88:91], v[104:107], v[180:183]
ds_read_b64_tr_b16 v[84:85], v14 offset:8192
v_cvt_pk_bf16_f32 v35, v150, v151
v_mfma_f32_16x16x32_bf16 v[180:183], v[92:95], v[108:111], v[180:183]
ds_read_b64_tr_b16 v[86:87], v14 offset:9216
v_cvt_pk_bf16_f32 v16, v128, v129
v_mfma_f32_16x16x32_bf16 v[176:179], v[92:95], v[100:103], v[176:179]
v_cvt_pk_bf16_f32 v17, v130, v131
v_cvt_pk_bf16_f32 v18, v144, v145
v_mfma_f32_16x16x32_bf16 v[176:179], v[88:91], v[96:99], v[176:179]
s_waitcnt lgkmcnt(8)
buffer_store_dwordx4 a[0:3], v1, s[44:47], s80 offen offset:3072 sc1
v_mfma_f32_16x16x32_bf16 v[192:195], v[64:67], v[96:99], v[192:195]
ds_read_b64_tr_b16 v[88:89], v15 offset:0
v_cvt_pk_bf16_f32 v19, v146, v147
v_mfma_f32_16x16x32_bf16 v[192:195], v[68:71], v[100:103], v[192:195]
ds_read_b64_tr_b16 v[90:91], v15 offset:1024
v_mfma_f32_16x16x32_bf16 v[196:199], v[68:71], v[108:111], v[196:199]
ds_read_b64_tr_b16 v[92:93], v15 offset:8192
v_mfma_f32_16x16x32_bf16 v[196:199], v[64:67], v[104:107], v[196:199]
ds_read_b64_tr_b16 v[94:95], v15 offset:9216
v_mfma_f32_16x16x32_bf16 v[200:203], v[64:67], v[112:115], v[200:203]
v_lshrrev_b32 v3, 1, v0
v_lshlrev_b32 v3, 7, v3
v_mfma_f32_16x16x32_bf16 v[200:203], v[68:71], v[116:119], v[200:203]
buffer_load_dword v4, v3, s[36:39], s93 offen
v_mfma_f32_16x16x32_bf16 v[204:207], v[68:71], v[124:127], v[204:207]
v_cvt_pk_bf16_f32 v52, v168, v169
v_cvt_pk_bf16_f32 v53, v170, v171
v_mfma_f32_16x16x32_bf16 v[204:207], v[64:67], v[120:123], v[204:207]
s_waitcnt lgkmcnt(8)
v_cvt_pk_bf16_f32 v54, v184, v185
v_cvt_pk_bf16_f32 v55, v186, v187
v_mfma_f32_16x16x32_bf16 v[220:223], v[72:75], v[120:123], v[220:223]
v_cvt_pk_bf16_f32 v36, v164, v165
v_cvt_pk_bf16_f32 v37, v166, v167
v_mfma_f32_16x16x32_bf16 v[220:223], v[76:79], v[124:127], v[220:223]
v_cvt_pk_bf16_f32 v38, v180, v181
v_cvt_pk_bf16_f32 v39, v182, v183
v_mfma_f32_16x16x32_bf16 v[216:219], v[76:79], v[116:119], v[216:219]
s_waitcnt vmcnt(21) lgkmcnt(0)
v_cvt_pk_bf16_f32 v20, v160, v161
v_cvt_pk_bf16_f32 v21, v162, v163
v_mfma_f32_16x16x32_bf16 v[216:219], v[72:75], v[112:115], v[216:219]
s_barrier
v_cvt_pk_bf16_f32 v22, v176, v177
v_cvt_pk_bf16_f32 v23, v178, v179
v_mfma_f32_16x16x32_bf16 v[212:215], v[72:75], v[104:107], v[212:215]
ds_read_b128 a[128:131], v2 offset:16384
v_cvt_pk_bf16_f32 v64, v140, v141
v_mfma_f32_16x16x32_bf16 v[212:215], v[76:79], v[108:111], v[212:215]
v_cvt_pk_bf16_f32 v65, v142, v143
v_cvt_pk_bf16_f32 v66, v156, v157
v_mfma_f32_16x16x32_bf16 v[208:211], v[76:79], v[100:103], v[208:211]
ds_read_b128 a[132:135], v2 offset:17408
v_cvt_pk_bf16_f32 v67, v158, v159
v_mfma_f32_16x16x32_bf16 v[208:211], v[72:75], v[96:99], v[208:211]
v_cvt_pk_bf16_f32 v68, v172, v173
v_cvt_pk_bf16_f32 v69, v174, v175
v_mfma_f32_16x16x32_bf16 v[224:227], v[80:83], v[96:99], v[224:227]
ds_read_b128 a[136:139], v2 offset:18432
v_cvt_pk_bf16_f32 v70, v188, v189
v_mfma_f32_16x16x32_bf16 v[224:227], v[84:87], v[100:103], v[224:227]
v_cvt_pk_bf16_f32 v71, v190, v191
v_mfma_f32_16x16x32_bf16 v[228:231], v[84:87], v[108:111], v[228:231]
ds_read_b128 a[140:143], v2 offset:19456
v_mfma_f32_16x16x32_bf16 v[228:231], v[80:83], v[104:107], v[228:231]
v_mfma_f32_16x16x32_bf16 v[232:235], v[80:83], v[112:115], v[232:235]
ds_read_b128 a[144:147], v2 offset:20480
v_cvt_pk_bf16_f32 v72, v204, v205
v_mfma_f32_16x16x32_bf16 v[232:235], v[84:87], v[116:119], v[232:235]
v_cvt_pk_bf16_f32 v73, v206, v207
v_cvt_pk_bf16_f32 v74, v220, v221
v_mfma_f32_16x16x32_bf16 v[236:239], v[84:87], v[124:127], v[236:239]
ds_read_b128 a[148:151], v2 offset:21504
v_cvt_pk_bf16_f32 v75, v222, v223
v_mfma_f32_16x16x32_bf16 v[236:239], v[80:83], v[120:123], v[236:239]
v_cvt_pk_bf16_f32 v56, v200, v201
v_cvt_pk_bf16_f32 v57, v202, v203
v_mfma_f32_16x16x32_bf16 v[252:255], v[88:91], v[120:123], v[252:255]
ds_read_b128 a[152:155], v2 offset:22528
v_cvt_pk_bf16_f32 v58, v216, v217
v_mfma_f32_16x16x32_bf16 v[252:255], v[92:95], v[124:127], v[252:255]
v_cvt_pk_bf16_f32 v59, v218, v219
v_cvt_pk_bf16_f32 v40, v196, v197
v_mfma_f32_16x16x32_bf16 v[248:251], v[92:95], v[116:119], v[248:251]
ds_read_b128 a[156:159], v2 offset:23552
v_cvt_pk_bf16_f32 v41, v198, v199
v_mfma_f32_16x16x32_bf16 v[248:251], v[88:91], v[112:115], v[248:251]
v_cvt_pk_bf16_f32 v42, v212, v213
v_cvt_pk_bf16_f32 v43, v214, v215
v_mfma_f32_16x16x32_bf16 v[244:247], v[88:91], v[104:107], v[244:247]
v_cvt_pk_bf16_f32 v24, v192, v193
v_cvt_pk_bf16_f32 v25, v194, v195
v_mfma_f32_16x16x32_bf16 v[244:247], v[92:95], v[108:111], v[244:247]
v_cvt_pk_bf16_f32 v26, v208, v209
v_cvt_pk_bf16_f32 v27, v210, v211
v_mfma_f32_16x16x32_bf16 v[240:243], v[92:95], v[100:103], v[240:243]
v_mfma_f32_16x16x32_bf16 v[240:243], v[88:91], v[96:99], v[240:243]
v_cvt_pk_bf16_f32 v76, v236, v237
v_cvt_pk_bf16_f32 v77, v238, v239
v_cvt_pk_bf16_f32 v78, v252, v253
v_cvt_pk_bf16_f32 v79, v254, v255
v_cvt_pk_bf16_f32 v60, v232, v233
v_cvt_pk_bf16_f32 v61, v234, v235
v_cvt_pk_bf16_f32 v62, v248, v249
v_cvt_pk_bf16_f32 v63, v250, v251
v_cvt_pk_bf16_f32 v44, v228, v229
v_cvt_pk_bf16_f32 v45, v230, v231
v_cvt_pk_bf16_f32 v46, v244, v245
v_cvt_pk_bf16_f32 v47, v246, v247
v_cvt_pk_bf16_f32 v28, v224, v225
v_cvt_pk_bf16_f32 v29, v226, v227
v_cvt_pk_bf16_f32 v30, v240, v241
v_cvt_pk_bf16_f32 v31, v242, v243
v_mov_b32 v124, 0xff800000
v_mov_b32 v125, 0xff800000
v_mov_b32 v126, 0xff800000
v_mov_b32 v127, 0xff800000
s_lshl_b32 s84, s60, 2
s_add_u32 s84, s84, s58
s_mov_b32 s86, 0
s_mov_b32 s53, 0
s_lshr_b32 s52, s66, 8
s_and_b32 s52, s52, 31
s_add_u32 s61, s65, s60
s_and_b32 s73, s60, 1
s_lshl_b32 s73, s73, 16
s_add_u32 s77, s73, s64
s_xor_b32 s73, s73, 0x10000
s_mov_b32 s92, s73
s_mul_i32 s62, s58, 4608
s_add_u32 s62, s62, 143104
s_add_u32 s73, s73, 49920
s_cmp_eq_u32 s58, 0
s_cselect_b32 s62, s73, s62
Lattn:
s_mov_b32 s82, 0x10000
s_waitcnt lgkmcnt(0)
v_mfma_f32_16x16x32_bf16 v[136:139], a[128:131], v[48:51], 0
ds_read_b128 a[160:163], v2 offset:24576
v_lshrrev_b32 v240, 4, v0
v_mfma_f32_16x16x32_bf16 v[136:139], a[132:135], v[52:55], v[136:139]
ds_read_b128 a[164:167], v2 offset:25600
v_and_b32 v241, 15, v0
v_mfma_f32_16x16x32_bf16 v[136:139], a[136:139], v[56:59], v[136:139]
ds_read_b128 a[168:171], v2 offset:26624
v_lshlrev_b32 v240, 2, v240
v_mfma_f32_16x16x32_bf16 v[136:139], a[140:143], v[60:63], v[136:139]
ds_read_b128 a[172:175], v2 offset:27648
v_sub_u32 v240, v241, v240
v_mfma_f32_16x16x32_bf16 v[140:143], a[140:143], v[76:79], 0
ds_read_b128 a[176:179], v2 offset:28672
v_mov_b32 v112, 0xff800000
v_mfma_f32_16x16x32_bf16 v[140:143], a[136:139], v[72:75], v[140:143]
ds_read_b128 a[180:183], v2 offset:29696
v_mov_b32 v113, 0xff800000
v_mfma_f32_16x16x32_bf16 v[140:143], a[132:135], v[68:71], v[140:143]
ds_read_b128 a[184:187], v2 offset:30720
v_mov_b32 v114, 0xff800000
v_mfma_f32_16x16x32_bf16 v[140:143], a[128:131], v[64:67], v[140:143]
ds_read_b128 a[188:191], v2 offset:31744
v_mov_b32 v115, 0xff800000
v_mfma_f32_16x16x32_bf16 v[156:159], a[144:147], v[64:67], 0
v_cmp_gt_i32 vcc, 0, v240
v_and_b32 v120, 3, v0
v_mfma_f32_16x16x32_bf16 v[156:159], a[148:151], v[68:71], v[156:159]
v_cndmask_b32 v116, 0, v112, vcc
v_cmp_gt_i32 vcc, 1, v240
v_mfma_f32_16x16x32_bf16 v[156:159], a[152:155], v[72:75], v[156:159]
v_subrev_u32 v120, 1, v120
v_cndmask_b32 v117, 0, v112, vcc
v_mfma_f32_16x16x32_bf16 v[156:159], a[156:159], v[76:79], v[156:159]
v_cmp_gt_i32 vcc, 2, v240
v_ashrrev_i32 v120, 31, v120
v_mfma_f32_16x16x32_bf16 v[152:155], a[156:159], v[60:63], 0
v_cndmask_b32 v118, 0, v112, vcc
v_cmp_gt_i32 vcc, 3, v240
v_mfma_f32_16x16x32_bf16 v[152:155], a[152:155], v[56:59], v[152:155]
v_and_b32 v120, 0x3f803f80, v120
v_cndmask_b32 v119, 0, v112, vcc
v_mfma_f32_16x16x32_bf16 v[152:155], a[148:151], v[52:55], v[152:155]
v_mov_b32 v228, 0
v_mov_b32 v229, 0
v_mfma_f32_16x16x32_bf16 v[152:155], a[144:147], v[48:51], v[152:155]
v_mov_b32 v230, 0
v_mov_b32 v231, 0
s_cmp_eq_u32 s84, 0
s_cbranch_scc1 Lta7
s_cmp_eq_u32 s84, 1
s_cbranch_scc1 Lnt8
v_mfma_f32_16x16x32_bf16 v[128:131], a[128:131], v[16:19], 0
v_mov_b32 v236, 0
v_mov_b32 v237, 0
v_mfma_f32_16x16x32_bf16 v[144:147], a[144:147], v[16:19], 0
Lstub0:
s_cbranch_execz Lstub4
v_mov_b32 v238, 0
v_mov_b32 v239, 0
s_branch Ljoin9
Lta7:
v_mfma_f32_16x16x32_bf16 v[128:131], a[128:131], v[16:19], v[116:119]
v_mov_b32 v236, 0
v_mov_b32 v237, 0
v_mfma_f32_16x16x32_bf16 v[144:147], a[144:147], v[16:19], v[112:115]
v_mov_b32 v238, 0
v_mov_b32 v239, 0
s_branch Ljoin9
Lnt8:
v_mfma_f32_16x16x32_bf16 v[128:131], a[128:131], v[16:19], 0
v_mov_b32 v236, 0
v_mov_b32 v237, 0
v_mfma_f32_16x16x32_bf16 v[144:147], a[144:147], v[16:19], v[116:119]
v_mov_b32 v238, 0
v_mov_b32 v239, 0
Ljoin9:
v_mfma_f32_16x16x32_bf16 v[128:131], a[132:135], v[20:23], v[128:131]
v_mov_b32 v121, v120
v_mov_b32 v122, v120
v_mfma_f32_16x16x32_bf16 v[128:131], a[136:139], v[24:27], v[128:131]
v_mov_b32 v123, v120
v_mfma_f32_16x16x32_bf16 v[128:131], a[140:143], v[28:31], v[128:131]
v_max3_f32 v240, v136, v137, v126
v_max3_f32 v242, v140, v141, v127
v_mfma_f32_16x16x32_bf16 v[132:135], a[140:143], v[44:47], 0
v_max3_f32 v240, v240, v138, v139
v_max3_f32 v242, v242, v142, v143
v_mfma_f32_16x16x32_bf16 v[132:135], a[136:139], v[40:43], v[132:135]
v_max3_f32 v240, v240, v152, v153
v_max3_f32 v242, v242, v156, v157
v_mfma_f32_16x16x32_bf16 v[132:135], a[132:135], v[36:39], v[132:135]
v_max3_f32 v240, v240, v154, v155
v_max3_f32 v242, v242, v158, v159
v_mfma_f32_16x16x32_bf16 v[132:135], a[128:131], v[32:35], v[132:135]
v_mov_b32 v241, v240
v_mov_b32 v243, v242
v_mfma_f32_16x16x32_bf16 v[148:151], a[144:147], v[32:35], 0
v_permlane16_swap_b32 v240, v241
v_permlane16_swap_b32 v242, v243
v_mfma_f32_16x16x32_bf16 v[148:151], a[148:151], v[36:39], v[148:151]
v_max_f32 v240, v240, v241
v_max_f32 v242, v242, v243
v_mfma_f32_16x16x32_bf16 v[148:151], a[152:155], v[40:43], v[148:151]
v_mov_b32 v241, v240
v_mov_b32 v243, v242
v_mfma_f32_16x16x32_bf16 v[148:151], a[156:159], v[44:47], v[148:151]
v_permlane32_swap_b32 v240, v241
v_permlane32_swap_b32 v242, v243
v_mfma_f32_16x16x32_bf16 v[144:147], a[156:159], v[28:31], v[144:147]
v_max_f32 v240, v240, v241
v_max_f32 v242, v242, v243
v_mfma_f32_16x16x32_bf16 v[144:147], a[152:155], v[24:27], v[144:147]
v_mfma_f32_16x16x32_bf16 v[144:147], a[148:151], v[20:23], v[144:147]
v_sub_f32 v88, 0, v240
v_sub_f32 v89, 0, v240
v_pk_add_f32 v[90:91], v[88:89], 0
v_pk_add_f32 v[104:105], v[116:117], v[88:89]
v_pk_add_f32 v[106:107], v[118:119], v[88:89]
v_pk_add_f32 v[136:137], v[136:137], v[88:89]
v_pk_add_f32 v[138:139], v[138:139], v[88:89]
v_pk_add_f32 v[152:153], v[152:153], v[88:89]
v_pk_add_f32 v[154:155], v[154:155], v[88:89]
v_sub_f32 v92, 0, v242
v_sub_f32 v93, 0, v242
v_pk_add_f32 v[94:95], v[92:93], 0
v_pk_add_f32 v[108:109], v[116:117], v[92:93]
v_pk_add_f32 v[110:111], v[118:119], v[92:93]
v_pk_add_f32 v[140:141], v[140:141], v[92:93]
v_pk_add_f32 v[142:143], v[142:143], v[92:93]
v_pk_add_f32 v[156:157], v[156:157], v[92:93]
v_pk_add_f32 v[158:159], v[158:159], v[92:93]
v_max3_f32 v240, v128, v129, v124
v_max3_f32 v242, v132, v133, v125
v_max3_f32 v240, v240, v130, v131
v_max3_f32 v242, v242, v134, v135
v_max3_f32 v240, v240, v144, v145
v_max3_f32 v242, v242, v148, v149
v_max3_f32 v240, v240, v146, v147
v_max3_f32 v242, v242, v150, v151
v_mov_b32 v241, v240
v_mov_b32 v243, v242
s_nop 0
v_permlane16_swap_b32 v240, v241
v_permlane16_swap_b32 v242, v243
v_max_f32 v240, v240, v241
v_max_f32 v242, v242, v243
v_mov_b32 v241, v240
v_mov_b32 v243, v242
s_nop 0
v_permlane32_swap_b32 v240, v241
v_permlane32_swap_b32 v242, v243
v_max_f32 v240, v240, v241
v_max_f32 v242, v242, v243
v_sub_f32 v80, 0, v240
v_sub_f32 v81, 0, v240
v_pk_add_f32 v[82:83], v[80:81], 0
v_pk_add_f32 v[96:97], v[116:117], v[80:81]
v_pk_add_f32 v[98:99], v[118:119], v[80:81]
v_pk_add_f32 v[128:129], v[128:129], v[80:81]
v_pk_add_f32 v[130:131], v[130:131], v[80:81]
v_pk_add_f32 v[144:145], v[144:145], v[80:81]
v_pk_add_f32 v[146:147], v[146:147], v[80:81]
v_sub_f32 v84, 0, v242
v_sub_f32 v85, 0, v242
v_pk_add_f32 v[86:87], v[84:85], 0
v_pk_add_f32 v[100:101], v[116:117], v[84:85]
v_pk_add_f32 v[102:103], v[118:119], v[84:85]
v_pk_add_f32 v[132:133], v[132:133], v[84:85]
v_pk_add_f32 v[134:135], v[134:135], v[84:85]
v_pk_add_f32 v[148:149], v[148:149], v[84:85]
v_pk_add_f32 v[150:151], v[150:151], v[84:85]
v_add_u32 v2, s82, v1
s_waitcnt vmcnt(13) lgkmcnt(0)
s_barrier
s_cmp_eq_u32 s60, 0
s_cbranch_scc1 LP0x
v_mfma_f32_16x16x32_bf16 v[164:167], a[160:163], v[32:35], v[84:87]
s_xor_b32 s74, s82, 0x10000
v_exp_f32 v128, v128
v_mfma_f32_16x16x32_bf16 v[164:167], a[164:167], v[36:39], v[164:167]
s_add_u32 s74, s74, s64
ds_read_b128 a[128:131], v2 offset:16384
ds_read_b128 a[132:135], v2 offset:17408
v_mfma_f32_16x16x32_bf16 v[164:167], a[168:171], v[40:43], v[164:167]
s_add_u32 s81, s81, 0x8000
v_exp_f32 v129, v129
v_mfma_f32_16x16x32_bf16 v[164:167], a[172:175], v[44:47], v[164:167]
s_add_u32 m0, s74, 16384
v_exp_f32 v130, v130
v_mfma_f32_16x16x32_bf16 v[172:175], a[172:175], v[76:79], v[92:95]
s_add_u32 s72, s81, 16384
v_exp_f32 v131, v131
v_mfma_f32_16x16x32_bf16 v[172:175], a[168:171], v[72:75], v[172:175]
v_exp_f32 v144, v144
v_mfma_f32_16x16x32_bf16 v[172:175], a[164:167], v[68:71], v[172:175]
s_nop 0
ds_read_b128 a[136:139], v2 offset:18432
ds_read_b128 a[140:143], v2 offset:19456
v_mfma_f32_16x16x32_bf16 v[172:175], a[160:163], v[64:67], v[172:175]
s_nop 0
ds_read_b128 a[144:147], v2 offset:20480
ds_read_b128 a[148:151], v2 offset:21504
v_mfma_f32_16x16x32_bf16 v[188:191], a[176:179], v[64:67], v[92:95]
s_nop 0
ds_read_b128 a[152:155], v2 offset:22528
ds_read_b128 a[156:159], v2 offset:23552
v_mfma_f32_16x16x32_bf16 v[188:191], a[180:183], v[68:71], v[188:191]
s_nop 0
ds_read_b128 a[192:195], v2 offset:0
ds_read_b128 a[196:199], v2 offset:1024
v_mfma_f32_16x16x32_bf16 v[188:191], a[184:187], v[72:75], v[188:191]
s_nop 0
ds_read_b128 a[200:203], v2 offset:2048
ds_read_b128 a[204:207], v2 offset:3072
v_mfma_f32_16x16x32_bf16 v[188:191], a[188:191], v[76:79], v[188:191]
s_nop 0
ds_read_b128 a[208:211], v2 offset:4096
ds_read_b128 a[212:215], v2 offset:5120
v_mfma_f32_16x16x32_bf16 v[180:183], a[188:191], v[44:47], v[84:87]
s_nop 0
ds_read_b128 a[216:219], v2 offset:6144
ds_read_b128 a[220:223], v2 offset:7168
v_mfma_f32_16x16x32_bf16 v[180:183], a[184:187], v[40:43], v[180:183]
v_cvt_pk_bf16_f32 v192, v128, v129
v_cvt_pk_bf16_f32 v193, v130, v131
v_mfma_f32_16x16x32_bf16 v[180:183], a[180:183], v[36:39], v[180:183]
buffer_load_dwordx4 v1, s[44:47], s72 offen sc1 lds
v_mfma_f32_16x16x32_bf16 v[180:183], a[176:179], v[32:35], v[180:183]
v_exp_f32 v145, v145
v_mfma_f32_16x16x32_bf16 v[160:163], a[160:163], v[16:19], v[80:83]
v_exp_f32 v146, v146
v_mfma_f32_16x16x32_bf16 v[160:163], a[164:167], v[20:23], v[160:163]
v_exp_f32 v147, v147
v_mfma_f32_16x16x32_bf16 v[160:163], a[168:171], v[24:27], v[160:163]
v_exp_f32 v136, v136
v_mfma_f32_16x16x32_bf16 v[160:163], a[172:175], v[28:31], v[160:163]
v_cvt_pk_bf16_f32 v194, v144, v145
v_cvt_pk_bf16_f32 v195, v146, v147
v_mfma_f32_16x16x32_bf16 v[168:171], a[172:175], v[60:63], v[88:91]
v_exp_f32 v137, v137
v_mfma_f32_16x16x32_bf16 v[168:171], a[168:171], v[56:59], v[168:171]
v_exp_f32 v138, v138
v_mfma_f32_16x16x32_bf16 v[168:171], a[164:167], v[52:55], v[168:171]
v_exp_f32 v139, v139
v_mfma_f32_16x16x32_bf16 v[168:171], a[160:163], v[48:51], v[168:171]
v_exp_f32 v152, v152
v_mfma_f32_16x16x32_bf16 v[184:187], a[176:179], v[48:51], v[88:91]
v_cvt_pk_bf16_f32 v200, v136, v137
v_cvt_pk_bf16_f32 v201, v138, v139
v_mfma_f32_16x16x32_bf16 v[184:187], a[180:183], v[52:55], v[184:187]
buffer_load_dwordx4 v1, s[44:47], s72 offen offset:1024 sc1 lds
v_mfma_f32_16x16x32_bf16 v[184:187], a[184:187], v[56:59], v[184:187]
v_exp_f32 v153, v153
v_mfma_f32_16x16x32_bf16 v[184:187], a[188:191], v[60:63], v[184:187]
v_exp_f32 v154, v154
v_mfma_f32_16x16x32_bf16 v[176:179], a[188:191], v[28:31], v[80:83]
v_exp_f32 v155, v155
v_mfma_f32_16x16x32_bf16 v[176:179], a[184:187], v[24:27], v[176:179]
buffer_load_dwordx4 v1, s[44:47], s72 offen offset:2048 sc1 lds
v_mfma_f32_16x16x32_bf16 v[176:179], a[180:183], v[20:23], v[176:179]
buffer_load_dwordx4 v1, s[44:47], s72 offen offset:3072 sc1 lds
v_mfma_f32_16x16x32_bf16 v[176:179], a[176:179], v[16:19], v[176:179]
s_waitcnt lgkmcnt(4)
v_exp_f32 v132, v132
v_cvt_pk_bf16_f32 v202, v152, v153
v_cvt_pk_bf16_f32 v203, v154, v155
v_exp_f32 v133, v133
v_exp_f32 v134, v134
v_cvt_pk_bf16_f32 v196, v132, v133
v_exp_f32 v135, v135
v_exp_f32 v148, v148
v_cvt_pk_bf16_f32 v197, v134, v135
v_exp_f32 v149, v149
v_exp_f32 v150, v150
v_cvt_pk_bf16_f32 v198, v148, v149
v_exp_f32 v151, v151
v_exp_f32 v140, v140
v_cvt_pk_bf16_f32 v199, v150, v151
v_exp_f32 v141, v141
v_exp_f32 v142, v142
v_cvt_pk_bf16_f32 v204, v140, v141
v_exp_f32 v143, v143
v_exp_f32 v156, v156
v_cvt_pk_bf16_f32 v205, v142, v143
v_exp_f32 v157, v157
v_exp_f32 v158, v158
v_cvt_pk_bf16_f32 v206, v156, v157
v_exp_f32 v159, v159
s_nop 0
v_cvt_pk_bf16_f32 v207, v158, v159
v_mfma_f32_16x16x32_bf16 v[224:227], v[120:123], v[192:195], 0
s_add_u32 s82, s82, 0x8000
ds_read_b128 a[160:163], v2 offset:24576
ds_read_b128 a[164:167], v2 offset:25600
v_mfma_f32_16x16x32_bf16 v[232:235], v[120:123], v[200:203], 0
s_and_b32 s82, s82, 0x1ffff
v_exp_f32 v164, v164
v_mfma_f32_16x16x32_bf16 a[0:3], a[192:195], v[192:195], 0
s_add_u32 m0, s74, 0
v_exp_f32 v165, v165
v_mfma_f32_16x16x32_bf16 a[64:67], a[192:195], v[200:203], 0
s_add_u32 s72, s81, 0
v_exp_f32 v166, v166
v_mfma_f32_16x16x32_bf16 a[68:71], a[196:199], v[200:203], 0
buffer_load_dwordx4 v1, s[44:47], s72 offen sc1 lds
v_mfma_f32_16x16x32_bf16 a[4:7], a[196:199], v[192:195], 0
v_exp_f32 v167, v167
v_mfma_f32_16x16x32_bf16 a[8:11], a[200:203], v[192:195], 0
ds_read_b128 a[168:171], v2 offset:26624
v_cvt_pk_bf16_f32 v212, v164, v165
v_mfma_f32_16x16x32_bf16 a[72:75], a[200:203], v[200:203], 0
v_exp_f32 v180, v180
v_mfma_f32_16x16x32_bf16 a[76:79], a[204:207], v[200:203], 0
v_exp_f32 v181, v181
v_mfma_f32_16x16x32_bf16 a[12:15], a[204:207], v[192:195], 0
s_waitcnt lgkmcnt(3)
ds_read_b128 a[172:175], v2 offset:27648
v_cvt_pk_bf16_f32 v213, v166, v167
v_mfma_f32_16x16x32_bf16 a[16:19], a[208:211], v[192:195], 0
v_exp_f32 v182, v182
v_mfma_f32_16x16x32_bf16 a[80:83], a[208:211], v[200:203], 0
buffer_load_dwordx4 v1, s[44:47], s72 offen offset:1024 sc1 lds
v_mfma_f32_16x16x32_bf16 a[84:87], a[212:215], v[200:203], 0
v_exp_f32 v183, v183
v_mfma_f32_16x16x32_bf16 a[20:23], a[212:215], v[192:195], 0
s_nop 0
ds_read_b128 a[176:179], v2 offset:28672
ds_read_b128 a[180:183], v2 offset:29696
v_mfma_f32_16x16x32_bf16 a[24:27], a[216:219], v[192:195], 0
v_exp_f32 v172, v172
v_mfma_f32_16x16x32_bf16 a[88:91], a[216:219], v[200:203], 0
s_nop 0
ds_read_b128 a[184:187], v2 offset:30720
ds_read_b128 a[188:191], v2 offset:31744
v_mfma_f32_16x16x32_bf16 a[92:95], a[220:223], v[200:203], 0
s_nop 0
ds_read_b128 a[224:227], v2 offset:8192
ds_read_b128 a[228:231], v2 offset:9216
v_mfma_f32_16x16x32_bf16 a[28:31], a[220:223], v[192:195], 0
s_nop 0
ds_read_b128 a[232:235], v2 offset:10240
ds_read_b128 a[236:239], v2 offset:11264
v_mfma_f32_16x16x32_bf16 v[128:131], a[128:131], v[16:19], v[80:83]
s_nop 0
ds_read_b128 a[240:243], v2 offset:12288
ds_read_b128 a[244:247], v2 offset:13312
v_mfma_f32_16x16x32_bf16 v[128:131], a[132:135], v[20:23], v[128:131]
s_nop 0
ds_read_b128 a[248:251], v2 offset:14336
ds_read_b128 a[252:255], v2 offset:15360
v_mfma_f32_16x16x32_bf16 v[128:131], a[136:139], v[24:27], v[128:131]
v_cvt_pk_bf16_f32 v214, v180, v181
v_cvt_pk_bf16_f32 v215, v182, v183
v_mfma_f32_16x16x32_bf16 v[128:131], a[140:143], v[28:31], v[128:131]
v_exp_f32 v173, v173
v_mfma_f32_16x16x32_bf16 v[136:139], a[140:143], v[60:63], v[88:91]
v_exp_f32 v174, v174
v_mfma_f32_16x16x32_bf16 v[136:139], a[136:139], v[56:59], v[136:139]
buffer_load_dwordx4 v1, s[44:47], s72 offen offset:2048 sc1 lds
v_mfma_f32_16x16x32_bf16 v[136:139], a[132:135], v[52:55], v[136:139]
v_exp_f32 v175, v175
v_mfma_f32_16x16x32_bf16 v[136:139], a[128:131], v[48:51], v[136:139]
v_exp_f32 v188, v188
v_mfma_f32_16x16x32_bf16 v[152:155], a[144:147], v[48:51], v[88:91]
v_cvt_pk_bf16_f32 v220, v172, v173
v_cvt_pk_bf16_f32 v221, v174, v175
v_mfma_f32_16x16x32_bf16 v[152:155], a[148:151], v[52:55], v[152:155]
v_exp_f32 v189, v189
v_mfma_f32_16x16x32_bf16 v[152:155], a[152:155], v[56:59], v[152:155]
v_exp_f32 v190, v190
v_mfma_f32_16x16x32_bf16 v[152:155], a[156:159], v[60:63], v[152:155]
buffer_load_dwordx4 v1, s[44:47], s72 offen offset:3072 sc1 lds
v_mfma_f32_16x16x32_bf16 v[144:147], a[156:159], v[28:31], v[80:83]
s_add_u32 s66, s58, 1
v_exp_f32 v191, v191
v_mfma_f32_16x16x32_bf16 v[144:147], a[152:155], v[24:27], v[144:147]
s_and_b32 s66, s66, 3
v_exp_f32 v160, v160
v_mfma_f32_16x16x32_bf16 v[144:147], a[148:151], v[20:23], v[144:147]
s_mul_i32 s66, s66, 4160
v_cvt_pk_bf16_f32 v222, v188, v189
v_cvt_pk_bf16_f32 v223, v190, v191
v_mfma_f32_16x16x32_bf16 v[144:147], a[144:147], v[16:19], v[144:147]
s_add_u32 m0, s66, 131104
v_exp_f32 v161, v161
v_mfma_f32_16x16x32_bf16 v[132:135], a[128:131], v[32:35], v[84:87]
s_add_u32 s72, s93, 0x2
buffer_load_dwordx4 v1, s[36:39], s72 offen lds
v_mfma_f32_16x16x32_bf16 v[132:135], a[132:135], v[36:39], v[132:135]
v_exp_f32 v162, v162
v_mfma_f32_16x16x32_bf16 v[132:135], a[136:139], v[40:43], v[132:135]
v_exp_f32 v163, v163
v_mfma_f32_16x16x32_bf16 v[132:135], a[140:143], v[44:47], v[132:135]
v_exp_f32 v176, v176
v_mfma_f32_16x16x32_bf16 v[140:143], a[140:143], v[76:79], v[92:95]
v_cvt_pk_bf16_f32 v208, v160, v161
v_cvt_pk_bf16_f32 v209, v162, v163
v_mfma_f32_16x16x32_bf16 v[140:143], a[136:139], v[72:75], v[140:143]
v_exp_f32 v177, v177
v_mfma_f32_16x16x32_bf16 v[140:143], a[132:135], v[68:71], v[140:143]
buffer_load_dwordx4 v1, s[36:39], s72 offen offset:1024 lds
v_mfma_f32_16x16x32_bf16 v[140:143], a[128:131], v[64:67], v[140:143]
v_exp_f32 v178, v178
v_mfma_f32_16x16x32_bf16 v[156:159], a[144:147], v[64:67], v[92:95]
v_exp_f32 v179, v179
v_mfma_f32_16x16x32_bf16 v[156:159], a[148:151], v[68:71], v[156:159]
v_exp_f32 v168, v168
v_mfma_f32_16x16x32_bf16 v[156:159], a[152:155], v[72:75], v[156:159]
v_cvt_pk_bf16_f32 v210, v176, v177
v_cvt_pk_bf16_f32 v211, v178, v179
v_mfma_f32_16x16x32_bf16 v[156:159], a[156:159], v[76:79], v[156:159]
v_exp_f32 v169, v169
v_mfma_f32_16x16x32_bf16 v[148:151], a[156:159], v[44:47], v[84:87]
buffer_load_dwordx4 v1, s[36:39], s72 offen offset:2048 lds
v_mfma_f32_16x16x32_bf16 v[148:151], a[152:155], v[40:43], v[148:151]
buffer_load_dwordx4 v1, s[36:39], s72 offen offset:3072 lds
v_mfma_f32_16x16x32_bf16 v[148:151], a[148:151], v[36:39], v[148:151]
s_waitcnt vmcnt(12) lgkmcnt(4)
v_exp_f32 v170, v170
v_mfma_f32_16x16x32_bf16 v[148:151], a[144:147], v[32:35], v[148:151]
s_barrier
v_exp_f32 v171, v171
v_add_u32 v2, s82, v1
v_cvt_pk_bf16_f32 v216, v168, v169
v_exp_f32 v184, v184
v_cvt_pk_bf16_f32 v217, v170, v171
v_exp_f32 v185, v185
v_exp_f32 v186, v186
v_cvt_pk_bf16_f32 v218, v184, v185
v_exp_f32 v187, v187
s_nop 0
v_cvt_pk_bf16_f32 v219, v186, v187
s_lshl_b32 s75, s59, 4
s_and_b32 s76, s84, 15
s_add_u32 s75, s75, s76
s_lshl_b32 s75, s75, 14
s_cmp_ge_u32 s60, 4
s_cselect_b32 s75, s75, 0x40001000
s_lshl_b32 s83, s60, 1
s_sub_u32 s83, 2, s83
s_cmp_eq_u32 s83, 0
s_cbranch_scc1 LLT1
.p2align 5
s_nop 0
s_nop 0
LloopI:
v_mfma_f32_16x16x32_bf16 v[228:231], v[120:123], v[196:199], v[228:231]
s_xor_b32 s74, s82, 0x10000
v_exp_f32 v128, v128
v_mfma_f32_16x16x32_bf16 v[228:231], v[120:123], v[212:215], v[228:231]
s_add_u32 s74, s74, s64
ds_read_b128 a[128:131], v2 offset:16384
v_add_u32 v15, s75, v3
v_mfma_f32_16x16x32_bf16 v[236:239], v[120:123], v[204:207], v[236:239]
s_add_u32 s81, s81, 0x8000
v_exp_f32 v129, v129
v_mfma_f32_16x16x32_bf16 v[236:239], v[120:123], v[220:223], v[236:239]
s_add_u32 m0, s74, 16384
v_exp_f32 v130, v130
v_mfma_f32_16x16x32_bf16 a[32:35], a[192:195], v[196:199], a[32:35]
s_add_u32 s72, s81, 16384
ds_read_b128 a[132:135], v2 offset:17408
v_cvt_pk_bf16_f32 v192, v128, v129
v_mfma_f32_16x16x32_bf16 a[32:35], a[224:227], v[212:215], a[32:35]
v_exp_f32 v131, v131
v_mfma_f32_16x16x32_bf16 a[96:99], a[224:227], v[220:223], a[96:99]
v_exp_f32 v144, v144
v_mfma_f32_16x16x32_bf16 a[96:99], a[192:195], v[204:207], a[96:99]
ds_read_b128 a[136:139], v2 offset:18432
v_cvt_pk_bf16_f32 v193, v130, v131
v_mfma_f32_16x16x32_bf16 a[100:103], a[196:199], v[204:207], a[100:103]
buffer_load_dwordx4 v1, s[44:47], s72 offen sc1 lds
v_mfma_f32_16x16x32_bf16 a[100:103], a[228:231], v[220:223], a[100:103]
v_exp_f32 v145, v145
v_mfma_f32_16x16x32_bf16 a[36:39], a[228:231], v[212:215], a[36:39]
v_exp_f32 v146, v146
v_mfma_f32_16x16x32_bf16 a[36:39], a[196:199], v[196:199], a[36:39]
ds_read_b128 a[140:143], v2 offset:19456
v_cvt_pk_bf16_f32 v194, v144, v145
v_mfma_f32_16x16x32_bf16 a[40:43], a[200:203], v[196:199], a[40:43]
v_exp_f32 v147, v147
v_mfma_f32_16x16x32_bf16 a[40:43], a[232:235], v[212:215], a[40:43]
v_exp_f32 v136, v136
v_mfma_f32_16x16x32_bf16 a[104:107], a[232:235], v[220:223], a[104:107]
ds_read_b128 a[144:147], v2 offset:20480
v_cvt_pk_bf16_f32 v195, v146, v147
v_mfma_f32_16x16x32_bf16 a[104:107], a[200:203], v[204:207], a[104:107]
v_exp_f32 v137, v137
v_mfma_f32_16x16x32_bf16 a[108:111], a[204:207], v[204:207], a[108:111]
v_exp_f32 v138, v138
v_mfma_f32_16x16x32_bf16 a[108:111], a[236:239], v[220:223], a[108:111]
ds_read_b128 a[148:151], v2 offset:21504
v_cvt_pk_bf16_f32 v200, v136, v137
v_mfma_f32_16x16x32_bf16 a[44:47], a[236:239], v[212:215], a[44:47]
v_exp_f32 v139, v139
v_mfma_f32_16x16x32_bf16 a[44:47], a[204:207], v[196:199], a[44:47]
v_exp_f32 v152, v152
v_mfma_f32_16x16x32_bf16 a[48:51], a[208:211], v[196:199], a[48:51]
s_waitcnt lgkmcnt(6)
ds_read_b128 a[152:155], v2 offset:22528
v_cvt_pk_bf16_f32 v201, v138, v139
v_mfma_f32_16x16x32_bf16 a[48:51], a[240:243], v[212:215], a[48:51]
buffer_load_dwordx4 v1, s[44:47], s72 offen offset:1024 sc1 lds
v_mfma_f32_16x16x32_bf16 a[112:115], a[240:243], v[220:223], a[112:115]
v_exp_f32 v153, v153
v_mfma_f32_16x16x32_bf16 a[112:115], a[208:211], v[204:207], a[112:115]
v_exp_f32 v154, v154
v_mfma_f32_16x16x32_bf16 a[116:119], a[212:215], v[204:207], a[116:119]
ds_read_b128 a[156:159], v2 offset:23552
v_cvt_pk_bf16_f32 v202, v152, v153
v_mfma_f32_16x16x32_bf16 a[116:119], a[244:247], v[220:223], a[116:119]
v_exp_f32 v155, v155
v_mfma_f32_16x16x32_bf16 a[52:55], a[244:247], v[212:215], a[52:55]
v_exp_f32 v132, v132
v_mfma_f32_16x16x32_bf16 a[52:55], a[212:215], v[196:199], a[52:55]
ds_read_b128 a[192:195], v2 offset:0
v_cvt_pk_bf16_f32 v203, v154, v155
v_mfma_f32_16x16x32_bf16 a[56:59], a[216:219], v[196:199], a[56:59]
v_exp_f32 v133, v133
v_mfma_f32_16x16x32_bf16 a[56:59], a[248:251], v[212:215], a[56:59]
v_exp_f32 v134, v134
v_mfma_f32_16x16x32_bf16 a[120:123], a[248:251], v[220:223], a[120:123]
ds_read_b128 a[196:199], v2 offset:1024
v_mfma_f32_16x16x32_bf16 a[120:123], a[216:219], v[204:207], a[120:123]
v_exp_f32 v135, v135
v_mfma_f32_16x16x32_bf16 a[124:127], a[220:223], v[204:207], a[124:127]
v_exp_f32 v148, v148
v_mfma_f32_16x16x32_bf16 a[124:127], a[252:255], v[220:223], a[124:127]
ds_read_b128 a[200:203], v2 offset:2048
v_mfma_f32_16x16x32_bf16 a[60:63], a[252:255], v[212:215], a[60:63]
buffer_load_dwordx4 v1, s[44:47], s72 offen offset:2048 sc1 lds
v_mfma_f32_16x16x32_bf16 a[60:63], a[220:223], v[196:199], a[60:63]
ds_read_b128 a[204:207], v2 offset:3072
v_cvt_pk_bf16_f32 v196, v132, v133
v_mfma_f32_16x16x32_bf16 v[164:167], a[160:163], v[32:35], v[84:87]
v_exp_f32 v149, v149
v_mfma_f32_16x16x32_bf16 v[164:167], a[164:167], v[36:39], v[164:167]
v_exp_f32 v150, v150
v_mfma_f32_16x16x32_bf16 v[164:167], a[168:171], v[40:43], v[164:167]
ds_read_b128 a[208:211], v2 offset:4096
v_cvt_pk_bf16_f32 v197, v134, v135
v_mfma_f32_16x16x32_bf16 v[164:167], a[172:175], v[44:47], v[164:167]
v_exp_f32 v151, v151
v_mfma_f32_16x16x32_bf16 v[172:175], a[172:175], v[76:79], v[92:95]
v_exp_f32 v140, v140
v_mfma_f32_16x16x32_bf16 v[172:175], a[168:171], v[72:75], v[172:175]
ds_read_b128 a[212:215], v2 offset:5120
v_cvt_pk_bf16_f32 v198, v148, v149
v_mfma_f32_16x16x32_bf16 v[172:175], a[164:167], v[68:71], v[172:175]
v_exp_f32 v141, v141
v_mfma_f32_16x16x32_bf16 v[172:175], a[160:163], v[64:67], v[172:175]
v_exp_f32 v142, v142
v_mfma_f32_16x16x32_bf16 v[188:191], a[176:179], v[64:67], v[92:95]
ds_read_b128 a[216:219], v2 offset:6144
v_cvt_pk_bf16_f32 v199, v150, v151
v_mfma_f32_16x16x32_bf16 v[188:191], a[180:183], v[68:71], v[188:191]
v_exp_f32 v143, v143
v_mfma_f32_16x16x32_bf16 v[188:191], a[184:187], v[72:75], v[188:191]
v_exp_f32 v156, v156
v_mfma_f32_16x16x32_bf16 v[188:191], a[188:191], v[76:79], v[188:191]
ds_read_b128 a[220:223], v2 offset:7168
v_cvt_pk_bf16_f32 v204, v140, v141
v_mfma_f32_16x16x32_bf16 v[180:183], a[188:191], v[44:47], v[84:87]
buffer_load_dwordx4 v1, s[44:47], s72 offen offset:3072 sc1 lds
v_mfma_f32_16x16x32_bf16 v[180:183], a[184:187], v[40:43], v[180:183]
v_exp_f32 v157, v157
v_mfma_f32_16x16x32_bf16 v[180:183], a[180:183], v[36:39], v[180:183]
v_exp_f32 v158, v158
v_mfma_f32_16x16x32_bf16 v[180:183], a[176:179], v[32:35], v[180:183]
v_cvt_pk_bf16_f32 v205, v142, v143
v_cvt_pk_bf16_f32 v206, v156, v157
v_mfma_f32_16x16x32_bf16 v[160:163], a[160:163], v[16:19], v[80:83]
v_exp_f32 v159, v159
v_mfma_f32_16x16x32_bf16 v[160:163], a[164:167], v[20:23], v[160:163]
v_cvt_pk_bf16_f32 v207, v158, v159
v_mfma_f32_16x16x32_bf16 v[160:163], a[168:171], v[24:27], v[160:163]
v_mfma_f32_16x16x32_bf16 v[160:163], a[172:175], v[28:31], v[160:163]
v_mfma_f32_16x16x32_bf16 v[168:171], a[172:175], v[60:63], v[88:91]
v_mfma_f32_16x16x32_bf16 v[168:171], a[168:171], v[56:59], v[168:171]
v_mfma_f32_16x16x32_bf16 v[168:171], a[164:167], v[52:55], v[168:171]
v_mfma_f32_16x16x32_bf16 v[168:171], a[160:163], v[48:51], v[168:171]
v_mfma_f32_16x16x32_bf16 v[184:187], a[176:179], v[48:51], v[88:91]
v_mfma_f32_16x16x32_bf16 v[184:187], a[180:183], v[52:55], v[184:187]
v_mfma_f32_16x16x32_bf16 v[184:187], a[184:187], v[56:59], v[184:187]
v_mfma_f32_16x16x32_bf16 v[184:187], a[188:191], v[60:63], v[184:187]
v_mfma_f32_16x16x32_bf16 v[176:179], a[188:191], v[28:31], v[80:83]
v_mfma_f32_16x16x32_bf16 v[176:179], a[184:187], v[24:27], v[176:179]
v_mfma_f32_16x16x32_bf16 v[176:179], a[180:183], v[20:23], v[176:179]
v_mfma_f32_16x16x32_bf16 v[176:179], a[176:179], v[16:19], v[176:179]
s_waitcnt lgkmcnt(4)
v_mfma_f32_16x16x32_bf16 v[224:227], v[120:123], v[208:211], v[224:227]
s_add_u32 s82, s82, 0x8000
ds_read_b128 a[160:163], v2 offset:24576
v_mfma_f32_16x16x32_bf16 v[224:227], v[120:123], v[192:195], v[224:227]
s_and_b32 s82, s82, 0x1ffff
v_exp_f32 v164, v164
v_mfma_f32_16x16x32_bf16 v[232:235], v[120:123], v[216:219], v[232:235]
s_add_u32 m0, s74, 0
v_exp_f32 v165, v165
v_mfma_f32_16x16x32_bf16 v[232:235], v[120:123], v[200:203], v[232:235]
s_add_u32 s72, s81, 0
ds_read_b128 a[164:167], v2 offset:25600
v_cvt_pk_bf16_f32 v212, v164, v165
v_mfma_f32_16x16x32_bf16 a[0:3], a[224:227], v[208:211], a[0:3]
v_exp_f32 v166, v166
v_mfma_f32_16x16x32_bf16 a[0:3], a[192:195], v[192:195], a[0:3]
v_exp_f32 v167, v167
v_mfma_f32_16x16x32_bf16 a[64:67], a[192:195], v[200:203], a[64:67]
buffer_load_dwordx4 v1, s[44:47], s72 offen sc1 lds
v_mfma_f32_16x16x32_bf16 a[64:67], a[224:227], v[216:219], a[64:67]
ds_read_b128 a[168:171], v2 offset:26624
v_cvt_pk_bf16_f32 v213, v166, v167
v_mfma_f32_16x16x32_bf16 a[68:71], a[228:231], v[216:219], a[68:71]
v_exp_f32 v180, v180
v_mfma_f32_16x16x32_bf16 a[68:71], a[196:199], v[200:203], a[68:71]
v_exp_f32 v181, v181
v_mfma_f32_16x16x32_bf16 a[4:7], a[196:199], v[192:195], a[4:7]
ds_read_b128 a[172:175], v2 offset:27648
v_cvt_pk_bf16_f32 v214, v180, v181
v_mfma_f32_16x16x32_bf16 a[4:7], a[228:231], v[208:211], a[4:7]
v_exp_f32 v182, v182
v_mfma_f32_16x16x32_bf16 a[8:11], a[232:235], v[208:211], a[8:11]
v_exp_f32 v183, v183
v_mfma_f32_16x16x32_bf16 a[8:11], a[200:203], v[192:195], a[8:11]
ds_read_b128 a[176:179], v2 offset:28672
v_cvt_pk_bf16_f32 v215, v182, v183
v_mfma_f32_16x16x32_bf16 a[72:75], a[200:203], v[200:203], a[72:75]
v_exp_f32 v172, v172
v_mfma_f32_16x16x32_bf16 a[72:75], a[232:235], v[216:219], a[72:75]
v_exp_f32 v173, v173
v_mfma_f32_16x16x32_bf16 a[76:79], a[236:239], v[216:219], a[76:79]
ds_read_b128 a[180:183], v2 offset:29696
v_cvt_pk_bf16_f32 v220, v172, v173
v_mfma_f32_16x16x32_bf16 a[76:79], a[204:207], v[200:203], a[76:79]
buffer_load_dwordx4 v1, s[44:47], s72 offen offset:1024 sc1 lds
v_mfma_f32_16x16x32_bf16 a[12:15], a[204:207], v[192:195], a[12:15]
v_exp_f32 v174, v174
v_mfma_f32_16x16x32_bf16 a[12:15], a[236:239], v[208:211], a[12:15]
v_exp_f32 v175, v175
v_mfma_f32_16x16x32_bf16 a[16:19], a[240:243], v[208:211], a[16:19]
s_waitcnt lgkmcnt(6)
ds_read_b128 a[184:187], v2 offset:30720
v_cvt_pk_bf16_f32 v221, v174, v175
v_mfma_f32_16x16x32_bf16 a[16:19], a[208:211], v[192:195], a[16:19]
v_exp_f32 v188, v188
v_mfma_f32_16x16x32_bf16 a[80:83], a[208:211], v[200:203], a[80:83]
v_exp_f32 v189, v189
v_mfma_f32_16x16x32_bf16 a[80:83], a[240:243], v[216:219], a[80:83]
ds_read_b128 a[188:191], v2 offset:31744
v_cvt_pk_bf16_f32 v222, v188, v189
v_mfma_f32_16x16x32_bf16 a[84:87], a[244:247], v[216:219], a[84:87]
v_exp_f32 v190, v190
v_mfma_f32_16x16x32_bf16 a[84:87], a[212:215], v[200:203], a[84:87]
v_exp_f32 v191, v191
v_mfma_f32_16x16x32_bf16 a[20:23], a[212:215], v[192:195], a[20:23]
ds_read_b128 a[224:227], v2 offset:8192
v_cvt_pk_bf16_f32 v223, v190, v191
v_mfma_f32_16x16x32_bf16 a[20:23], a[244:247], v[208:211], a[20:23]
v_exp_f32 v160, v160
v_mfma_f32_16x16x32_bf16 a[24:27], a[248:251], v[208:211], a[24:27]
buffer_load_dwordx4 v1, s[44:47], s72 offen offset:2048 sc1 lds
v_mfma_f32_16x16x32_bf16 a[24:27], a[216:219], v[192:195], a[24:27]
v_exp_f32 v161, v161
v_mfma_f32_16x16x32_bf16 a[88:91], a[216:219], v[200:203], a[88:91]
ds_read_b128 a[228:231], v2 offset:9216
v_mfma_f32_16x16x32_bf16 a[88:91], a[248:251], v[216:219], a[88:91]
v_exp_f32 v162, v162
v_mfma_f32_16x16x32_bf16 a[92:95], a[252:255], v[216:219], a[92:95]
v_exp_f32 v163, v163
v_mfma_f32_16x16x32_bf16 a[92:95], a[220:223], v[200:203], a[92:95]
ds_read_b128 a[232:235], v2 offset:10240
v_mfma_f32_16x16x32_bf16 a[28:31], a[220:223], v[192:195], a[28:31]
v_exp_f32 v176, v176
v_mfma_f32_16x16x32_bf16 a[28:31], a[252:255], v[208:211], a[28:31]
ds_read_b128 a[236:239], v2 offset:11264
v_cvt_pk_bf16_f32 v208, v160, v161
v_mfma_f32_16x16x32_bf16 v[128:131], a[128:131], v[16:19], v[80:83]
v_exp_f32 v177, v177
v_mfma_f32_16x16x32_bf16 v[128:131], a[132:135], v[20:23], v[128:131]
v_exp_f32 v178, v178
v_mfma_f32_16x16x32_bf16 v[128:131], a[136:139], v[24:27], v[128:131]
Lstub1:
s_cbranch_execz Lstub5
ds_read_b128 a[240:243], v2 offset:12288
v_cvt_pk_bf16_f32 v209, v162, v163
v_mfma_f32_16x16x32_bf16 v[128:131], a[140:143], v[28:31], v[128:131]
buffer_load_dwordx4 v1, s[44:47], s72 offen offset:3072 sc1 lds
v_mfma_f32_16x16x32_bf16 v[136:139], a[140:143], v[60:63], v[88:91]
s_add_u32 s75, s75, 0x1000
v_exp_f32 v179, v179
v_mfma_f32_16x16x32_bf16 v[136:139], a[136:139], v[56:59], v[136:139]
s_and_b32 s76, s75, 0x3000
v_exp_f32 v168, v168
v_mfma_f32_16x16x32_bf16 v[136:139], a[132:135], v[52:55], v[136:139]
s_cselect_b32 s75, s75, 0x40001000
ds_read_b128 a[244:247], v2 offset:13312
v_cvt_pk_bf16_f32 v210, v176, v177
v_mfma_f32_16x16x32_bf16 v[136:139], a[128:131], v[48:51], v[136:139]
v_exp_f32 v169, v169
v_mfma_f32_16x16x32_bf16 v[152:155], a[144:147], v[48:51], v[88:91]
v_exp_f32 v170, v170
v_mfma_f32_16x16x32_bf16 v[152:155], a[148:151], v[52:55], v[152:155]
ds_read_b128 a[248:251], v2 offset:14336
v_cvt_pk_bf16_f32 v211, v178, v179
v_mfma_f32_16x16x32_bf16 v[152:155], a[152:155], v[56:59], v[152:155]
v_exp_f32 v171, v171
v_mfma_f32_16x16x32_bf16 v[152:155], a[156:159], v[60:63], v[152:155]
v_exp_f32 v184, v184
v_mfma_f32_16x16x32_bf16 v[144:147], a[156:159], v[28:31], v[80:83]
ds_read_b128 a[252:255], v2 offset:15360
v_cvt_pk_bf16_f32 v216, v168, v169
v_mfma_f32_16x16x32_bf16 v[144:147], a[152:155], v[24:27], v[144:147]
buffer_load_dword v4, v15, s[24:27], 0 offen
v_mfma_f32_16x16x32_bf16 v[144:147], a[148:151], v[20:23], v[144:147]
v_exp_f32 v185, v185
v_mfma_f32_16x16x32_bf16 v[144:147], a[144:147], v[16:19], v[144:147]
v_exp_f32 v186, v186
v_mfma_f32_16x16x32_bf16 v[132:135], a[128:131], v[32:35], v[84:87]
v_cvt_pk_bf16_f32 v217, v170, v171
v_cvt_pk_bf16_f32 v218, v184, v185
v_mfma_f32_16x16x32_bf16 v[132:135], a[132:135], v[36:39], v[132:135]
v_exp_f32 v187, v187
v_mfma_f32_16x16x32_bf16 v[132:135], a[136:139], v[40:43], v[132:135]
v_cvt_pk_bf16_f32 v219, v186, v187
v_add_u32 v2, s82, v1
v_mfma_f32_16x16x32_bf16 v[132:135], a[140:143], v[44:47], v[132:135]
v_mfma_f32_16x16x32_bf16 v[140:143], a[140:143], v[76:79], v[92:95]
v_mfma_f32_16x16x32_bf16 v[140:143], a[136:139], v[72:75], v[140:143]
v_mfma_f32_16x16x32_bf16 v[140:143], a[132:135], v[68:71], v[140:143]
v_mfma_f32_16x16x32_bf16 v[140:143], a[128:131], v[64:67], v[140:143]
v_mfma_f32_16x16x32_bf16 v[156:159], a[144:147], v[64:67], v[92:95]
v_mfma_f32_16x16x32_bf16 v[156:159], a[148:151], v[68:71], v[156:159]
v_mfma_f32_16x16x32_bf16 v[156:159], a[152:155], v[72:75], v[156:159]
v_mfma_f32_16x16x32_bf16 v[156:159], a[156:159], v[76:79], v[156:159]
v_mfma_f32_16x16x32_bf16 v[148:151], a[156:159], v[44:47], v[84:87]
s_waitcnt vmcnt(9) lgkmcnt(4)
v_mfma_f32_16x16x32_bf16 v[148:151], a[152:155], v[40:43], v[148:151]
s_barrier
v_mfma_f32_16x16x32_bf16 v[148:151], a[148:151], v[36:39], v[148:151]
s_add_u32 s83, s83, 1
v_mfma_f32_16x16x32_bf16 v[148:151], a[144:147], v[32:35], v[148:151]
s_cbranch_scc0 LloopI
LLT1:
Lstub2:
s_cbranch_execz Lstub6
v_mfma_f32_16x16x32_bf16 v[228:231], v[120:123], v[196:199], v[228:231]
s_xor_b32 s74, s82, 0x10000
v_exp_f32 v128, v128
v_mfma_f32_16x16x32_bf16 v[228:231], v[120:123], v[212:215], v[228:231]
s_add_u32 s74, s74, s64
ds_read_b128 a[128:131], v2 offset:16384
v_mfma_f32_16x16x32_bf16 v[236:239], v[120:123], v[204:207], v[236:239]
s_add_u32 s81, s81, 0x8000
v_exp_f32 v129, v129
v_mfma_f32_16x16x32_bf16 v[236:239], v[120:123], v[220:223], v[236:239]
s_add_u32 m0, s74, 16384
v_exp_f32 v130, v130
v_mfma_f32_16x16x32_bf16 a[32:35], a[192:195], v[196:199], a[32:35]
s_add_u32 s72, s81, 16384
ds_read_b128 a[132:135], v2 offset:17408
v_cvt_pk_bf16_f32 v192, v128, v129
v_mfma_f32_16x16x32_bf16 a[32:35], a[224:227], v[212:215], a[32:35]
v_exp_f32 v131, v131
v_mfma_f32_16x16x32_bf16 a[96:99], a[224:227], v[220:223], a[96:99]
v_exp_f32 v144, v144
v_mfma_f32_16x16x32_bf16 a[96:99], a[192:195], v[204:207], a[96:99]
ds_read_b128 a[136:139], v2 offset:18432
v_cvt_pk_bf16_f32 v193, v130, v131
v_mfma_f32_16x16x32_bf16 a[100:103], a[196:199], v[204:207], a[100:103]
buffer_load_dwordx4 v1, s[44:47], s72 offen sc1 lds
v_mfma_f32_16x16x32_bf16 a[100:103], a[228:231], v[220:223], a[100:103]
v_exp_f32 v145, v145
v_mfma_f32_16x16x32_bf16 a[36:39], a[228:231], v[212:215], a[36:39]
v_exp_f32 v146, v146
v_mfma_f32_16x16x32_bf16 a[36:39], a[196:199], v[196:199], a[36:39]
ds_read_b128 a[140:143], v2 offset:19456
v_cvt_pk_bf16_f32 v194, v144, v145
v_mfma_f32_16x16x32_bf16 a[40:43], a[200:203], v[196:199], a[40:43]
v_exp_f32 v147, v147
v_mfma_f32_16x16x32_bf16 a[40:43], a[232:235], v[212:215], a[40:43]
v_exp_f32 v136, v136
v_mfma_f32_16x16x32_bf16 a[104:107], a[232:235], v[220:223], a[104:107]
ds_read_b128 a[144:147], v2 offset:20480
v_cvt_pk_bf16_f32 v195, v146, v147
v_mfma_f32_16x16x32_bf16 a[104:107], a[200:203], v[204:207], a[104:107]
v_exp_f32 v137, v137
v_mfma_f32_16x16x32_bf16 a[108:111], a[204:207], v[204:207], a[108:111]
v_exp_f32 v138, v138
v_mfma_f32_16x16x32_bf16 a[108:111], a[236:239], v[220:223], a[108:111]
ds_read_b128 a[148:151], v2 offset:21504
v_cvt_pk_bf16_f32 v200, v136, v137
v_mfma_f32_16x16x32_bf16 a[44:47], a[236:239], v[212:215], a[44:47]
v_exp_f32 v139, v139
v_mfma_f32_16x16x32_bf16 a[44:47], a[204:207], v[196:199], a[44:47]
v_exp_f32 v152, v152
v_mfma_f32_16x16x32_bf16 a[48:51], a[208:211], v[196:199], a[48:51]
s_waitcnt lgkmcnt(6)
ds_read_b128 a[152:155], v2 offset:22528
v_cvt_pk_bf16_f32 v201, v138, v139
v_mfma_f32_16x16x32_bf16 a[48:51], a[240:243], v[212:215], a[48:51]
buffer_load_dwordx4 v1, s[44:47], s72 offen offset:1024 sc1 lds
v_mfma_f32_16x16x32_bf16 a[112:115], a[240:243], v[220:223], a[112:115]
v_exp_f32 v153, v153
v_mfma_f32_16x16x32_bf16 a[112:115], a[208:211], v[204:207], a[112:115]
v_exp_f32 v154, v154
v_mfma_f32_16x16x32_bf16 a[116:119], a[212:215], v[204:207], a[116:119]
ds_read_b128 a[156:159], v2 offset:23552
v_cvt_pk_bf16_f32 v202, v152, v153
v_mfma_f32_16x16x32_bf16 a[116:119], a[244:247], v[220:223], a[116:119]
v_exp_f32 v155, v155
v_mfma_f32_16x16x32_bf16 a[52:55], a[244:247], v[212:215], a[52:55]
v_exp_f32 v132, v132
v_mfma_f32_16x16x32_bf16 a[52:55], a[212:215], v[196:199], a[52:55]
ds_read_b128 a[192:195], v2 offset:0
v_cvt_pk_bf16_f32 v203, v154, v155
v_mfma_f32_16x16x32_bf16 a[56:59], a[216:219], v[196:199], a[56:59]
v_exp_f32 v133, v133
v_mfma_f32_16x16x32_bf16 a[56:59], a[248:251], v[212:215], a[56:59]
v_exp_f32 v134, v134
v_mfma_f32_16x16x32_bf16 a[120:123], a[248:251], v[220:223], a[120:123]
ds_read_b128 a[196:199], v2 offset:1024
v_mfma_f32_16x16x32_bf16 a[120:123], a[216:219], v[204:207], a[120:123]
v_exp_f32 v135, v135
v_mfma_f32_16x16x32_bf16 a[124:127], a[220:223], v[204:207], a[124:127]
v_exp_f32 v148, v148
v_mfma_f32_16x16x32_bf16 a[124:127], a[252:255], v[220:223], a[124:127]
ds_read_b128 a[200:203], v2 offset:2048
v_mfma_f32_16x16x32_bf16 a[60:63], a[252:255], v[212:215], a[60:63]
buffer_load_dwordx4 v1, s[44:47], s72 offen offset:2048 sc1 lds
v_mfma_f32_16x16x32_bf16 a[60:63], a[220:223], v[196:199], a[60:63]
ds_read_b128 a[204:207], v2 offset:3072
v_cvt_pk_bf16_f32 v196, v132, v133
v_mfma_f32_16x16x32_bf16 v[164:167], a[160:163], v[32:35], v[84:87]
v_exp_f32 v149, v149
v_mfma_f32_16x16x32_bf16 v[164:167], a[164:167], v[36:39], v[164:167]
v_exp_f32 v150, v150
v_mfma_f32_16x16x32_bf16 v[164:167], a[168:171], v[40:43], v[164:167]
ds_read_b128 a[208:211], v2 offset:4096
v_cvt_pk_bf16_f32 v197, v134, v135
v_mfma_f32_16x16x32_bf16 v[164:167], a[172:175], v[44:47], v[164:167]
v_exp_f32 v151, v151
v_mfma_f32_16x16x32_bf16 v[172:175], a[172:175], v[76:79], v[92:95]
v_exp_f32 v140, v140
v_mfma_f32_16x16x32_bf16 v[172:175], a[168:171], v[72:75], v[172:175]
ds_read_b128 a[212:215], v2 offset:5120
v_cvt_pk_bf16_f32 v198, v148, v149
v_mfma_f32_16x16x32_bf16 v[172:175], a[164:167], v[68:71], v[172:175]
v_exp_f32 v141, v141
v_mfma_f32_16x16x32_bf16 v[172:175], a[160:163], v[64:67], v[172:175]
v_exp_f32 v142, v142
v_mfma_f32_16x16x32_bf16 v[188:191], a[176:179], v[64:67], v[92:95]
ds_read_b128 a[216:219], v2 offset:6144
v_cvt_pk_bf16_f32 v199, v150, v151
v_mfma_f32_16x16x32_bf16 v[188:191], a[180:183], v[68:71], v[188:191]
v_exp_f32 v143, v143
v_mfma_f32_16x16x32_bf16 v[188:191], a[184:187], v[72:75], v[188:191]
v_exp_f32 v156, v156
v_mfma_f32_16x16x32_bf16 v[188:191], a[188:191], v[76:79], v[188:191]
ds_read_b128 a[220:223], v2 offset:7168
v_cvt_pk_bf16_f32 v204, v140, v141
v_mfma_f32_16x16x32_bf16 v[180:183], a[188:191], v[44:47], v[84:87]
buffer_load_dwordx4 v1, s[44:47], s72 offen offset:3072 sc1 lds
v_mfma_f32_16x16x32_bf16 v[180:183], a[184:187], v[40:43], v[180:183]
v_exp_f32 v157, v157
v_mfma_f32_16x16x32_bf16 v[180:183], a[180:183], v[36:39], v[180:183]
v_exp_f32 v158, v158
v_mfma_f32_16x16x32_bf16 v[180:183], a[176:179], v[32:35], v[180:183]
v_cvt_pk_bf16_f32 v205, v142, v143
v_cvt_pk_bf16_f32 v206, v156, v157
v_mfma_f32_16x16x32_bf16 v[160:163], a[160:163], v[16:19], v[80:83]
v_exp_f32 v159, v159
v_mfma_f32_16x16x32_bf16 v[160:163], a[164:167], v[20:23], v[160:163]
v_cvt_pk_bf16_f32 v207, v158, v159
v_mfma_f32_16x16x32_bf16 v[160:163], a[168:171], v[24:27], v[160:163]
v_mfma_f32_16x16x32_bf16 v[160:163], a[172:175], v[28:31], v[160:163]
v_mfma_f32_16x16x32_bf16 v[168:171], a[172:175], v[60:63], v[88:91]
v_mfma_f32_16x16x32_bf16 v[168:171], a[168:171], v[56:59], v[168:171]
v_mfma_f32_16x16x32_bf16 v[168:171], a[164:167], v[52:55], v[168:171]
v_mfma_f32_16x16x32_bf16 v[168:171], a[160:163], v[48:51], v[168:171]
v_mfma_f32_16x16x32_bf16 v[184:187], a[176:179], v[48:51], v[88:91]
v_mfma_f32_16x16x32_bf16 v[184:187], a[180:183], v[52:55], v[184:187]
v_mfma_f32_16x16x32_bf16 v[184:187], a[184:187], v[56:59], v[184:187]
v_mfma_f32_16x16x32_bf16 v[184:187], a[188:191], v[60:63], v[184:187]
v_mfma_f32_16x16x32_bf16 v[176:179], a[188:191], v[28:31], v[80:83]
v_mfma_f32_16x16x32_bf16 v[176:179], a[184:187], v[24:27], v[176:179]
v_mfma_f32_16x16x32_bf16 v[176:179], a[180:183], v[20:23], v[176:179]
v_mfma_f32_16x16x32_bf16 v[176:179], a[176:179], v[16:19], v[176:179]
s_waitcnt lgkmcnt(4)
v_mfma_f32_16x16x32_bf16 v[224:227], v[120:123], v[208:211], v[224:227]
s_add_u32 s82, s82, 0x8000
ds_read_b128 a[160:163], v2 offset:24576
v_mfma_f32_16x16x32_bf16 v[224:227], v[120:123], v[192:195], v[224:227]
s_and_b32 s82, s82, 0x1ffff
v_exp_f32 v164, v164
v_mfma_f32_16x16x32_bf16 v[232:235], v[120:123], v[216:219], v[232:235]
s_add_u32 m0, s74, 0
v_exp_f32 v165, v165
v_mfma_f32_16x16x32_bf16 v[232:235], v[120:123], v[200:203], v[232:235]
s_add_u32 s72, s81, 0
ds_read_b128 a[164:167], v2 offset:25600
v_cvt_pk_bf16_f32 v212, v164, v165
v_mfma_f32_16x16x32_bf16 a[0:3], a[224:227], v[208:211], a[0:3]
v_exp_f32 v166, v166
v_mfma_f32_16x16x32_bf16 a[0:3], a[192:195], v[192:195], a[0:3]
v_exp_f32 v167, v167
v_mfma_f32_16x16x32_bf16 a[64:67], a[192:195], v[200:203], a[64:67]
ds_read_b128 a[168:171], v2 offset:26624
v_cvt_pk_bf16_f32 v213, v166, v167
v_mfma_f32_16x16x32_bf16 a[64:67], a[224:227], v[216:219], a[64:67]
v_exp_f32 v180, v180
v_mfma_f32_16x16x32_bf16 a[68:71], a[228:231], v[216:219], a[68:71]
buffer_load_dwordx4 v1, s[44:47], s72 offen sc1 lds
v_mfma_f32_16x16x32_bf16 a[68:71], a[196:199], v[200:203], a[68:71]
v_exp_f32 v181, v181
v_mfma_f32_16x16x32_bf16 a[4:7], a[196:199], v[192:195], a[4:7]
ds_read_b128 a[172:175], v2 offset:27648
v_cvt_pk_bf16_f32 v214, v180, v181
v_mfma_f32_16x16x32_bf16 a[4:7], a[228:231], v[208:211], a[4:7]
v_exp_f32 v182, v182
v_mfma_f32_16x16x32_bf16 a[8:11], a[232:235], v[208:211], a[8:11]
v_exp_f32 v183, v183
v_mfma_f32_16x16x32_bf16 a[8:11], a[200:203], v[192:195], a[8:11]
ds_read_b128 a[176:179], v2 offset:28672
v_cvt_pk_bf16_f32 v215, v182, v183
v_mfma_f32_16x16x32_bf16 a[72:75], a[200:203], v[200:203], a[72:75]
v_exp_f32 v172, v172
v_mfma_f32_16x16x32_bf16 a[72:75], a[232:235], v[216:219], a[72:75]
v_exp_f32 v173, v173
v_mfma_f32_16x16x32_bf16 a[76:79], a[236:239], v[216:219], a[76:79]
ds_read_b128 a[180:183], v2 offset:29696
v_cvt_pk_bf16_f32 v220, v172, v173
v_mfma_f32_16x16x32_bf16 a[76:79], a[204:207], v[200:203], a[76:79]
v_exp_f32 v174, v174
v_mfma_f32_16x16x32_bf16 a[12:15], a[204:207], v[192:195], a[12:15]
v_exp_f32 v175, v175
v_mfma_f32_16x16x32_bf16 a[12:15], a[236:239], v[208:211], a[12:15]
ds_read_b128 a[184:187], v2 offset:30720
v_cvt_pk_bf16_f32 v221, v174, v175
v_mfma_f32_16x16x32_bf16 a[16:19], a[240:243], v[208:211], a[16:19]
s_waitcnt lgkmcnt(7)
v_exp_f32 v188, v188
v_mfma_f32_16x16x32_bf16 a[16:19], a[208:211], v[192:195], a[16:19]
buffer_load_dwordx4 v1, s[44:47], s72 offen offset:1024 sc1 lds
v_mfma_f32_16x16x32_bf16 a[80:83], a[208:211], v[200:203], a[80:83]
v_exp_f32 v189, v189
v_mfma_f32_16x16x32_bf16 a[80:83], a[240:243], v[216:219], a[80:83]
ds_read_b128 a[188:191], v2 offset:31744
v_cvt_pk_bf16_f32 v222, v188, v189
v_mfma_f32_16x16x32_bf16 a[84:87], a[244:247], v[216:219], a[84:87]
v_exp_f32 v190, v190
v_mfma_f32_16x16x32_bf16 a[84:87], a[212:215], v[200:203], a[84:87]
v_exp_f32 v191, v191
v_mfma_f32_16x16x32_bf16 a[20:23], a[212:215], v[192:195], a[20:23]
ds_read_b128 a[224:227], v2 offset:8192
v_cvt_pk_bf16_f32 v223, v190, v191
v_mfma_f32_16x16x32_bf16 a[20:23], a[244:247], v[208:211], a[20:23]
v_exp_f32 v160, v160
v_mfma_f32_16x16x32_bf16 a[24:27], a[248:251], v[208:211], a[24:27]
v_exp_f32 v161, v161
v_mfma_f32_16x16x32_bf16 a[24:27], a[216:219], v[192:195], a[24:27]
ds_read_b128 a[228:231], v2 offset:9216
v_mfma_f32_16x16x32_bf16 a[88:91], a[216:219], v[200:203], a[88:91]
v_exp_f32 v162, v162
v_mfma_f32_16x16x32_bf16 a[88:91], a[248:251], v[216:219], a[88:91]
v_exp_f32 v163, v163
v_mfma_f32_16x16x32_bf16 a[92:95], a[252:255], v[216:219], a[92:95]
ds_read_b128 a[232:235], v2 offset:10240
v_mfma_f32_16x16x32_bf16 a[92:95], a[220:223], v[200:203], a[92:95]
v_exp_f32 v176, v176
v_mfma_f32_16x16x32_bf16 a[28:31], a[220:223], v[192:195], a[28:31]
buffer_load_dwordx4 v1, s[44:47], s72 offen offset:2048 sc1 lds
v_mfma_f32_16x16x32_bf16 a[28:31], a[252:255], v[208:211], a[28:31]
ds_read_b128 a[236:239], v2 offset:11264
v_cvt_pk_bf16_f32 v208, v160, v161
s_cmp_eq_u32 s58, 0
s_cbranch_scc1 Lta16
s_cmp_eq_u32 s58, 1
s_cbranch_scc1 Lnt17
v_mfma_f32_16x16x32_bf16 v[128:131], a[128:131], v[16:19], v[80:83]
v_exp_f32 v177, v177
v_mfma_f32_16x16x32_bf16 v[144:147], a[144:147], v[16:19], v[80:83]
v_exp_f32 v178, v178
s_branch Ljoin18
Lta16:
v_mfma_f32_16x16x32_bf16 v[128:131], a[128:131], v[16:19], v[96:99]
v_exp_f32 v177, v177
v_mfma_f32_16x16x32_bf16 v[144:147], a[144:147], v[16:19], v[112:115]
v_exp_f32 v178, v178
s_branch Ljoin18
Lnt17:
v_mfma_f32_16x16x32_bf16 v[128:131], a[128:131], v[16:19], v[80:83]
v_exp_f32 v177, v177
v_mfma_f32_16x16x32_bf16 v[144:147], a[144:147], v[16:19], v[96:99]
v_exp_f32 v178, v178
Ljoin18:
v_mfma_f32_16x16x32_bf16 v[128:131], a[132:135], v[20:23], v[128:131]
ds_read_b128 a[240:243], v2 offset:12288
v_cvt_pk_bf16_f32 v209, v162, v163
v_mfma_f32_16x16x32_bf16 v[128:131], a[136:139], v[24:27], v[128:131]
v_exp_f32 v179, v179
v_mfma_f32_16x16x32_bf16 v[128:131], a[140:143], v[28:31], v[128:131]
v_exp_f32 v168, v168
v_mfma_f32_16x16x32_bf16 v[136:139], a[140:143], v[60:63], v[88:91]
ds_read_b128 a[244:247], v2 offset:13312
v_cvt_pk_bf16_f32 v210, v176, v177
v_mfma_f32_16x16x32_bf16 v[136:139], a[136:139], v[56:59], v[136:139]
v_exp_f32 v169, v169
v_mfma_f32_16x16x32_bf16 v[136:139], a[132:135], v[52:55], v[136:139]
v_exp_f32 v170, v170
v_mfma_f32_16x16x32_bf16 v[136:139], a[128:131], v[48:51], v[136:139]
ds_read_b128 a[248:251], v2 offset:14336
v_cvt_pk_bf16_f32 v211, v178, v179
v_mfma_f32_16x16x32_bf16 v[152:155], a[144:147], v[48:51], v[88:91]
v_exp_f32 v171, v171
v_mfma_f32_16x16x32_bf16 v[152:155], a[148:151], v[52:55], v[152:155]
v_exp_f32 v184, v184
v_mfma_f32_16x16x32_bf16 v[152:155], a[152:155], v[56:59], v[152:155]
ds_read_b128 a[252:255], v2 offset:15360
v_cvt_pk_bf16_f32 v216, v168, v169
v_mfma_f32_16x16x32_bf16 v[152:155], a[156:159], v[60:63], v[152:155]
buffer_load_dwordx4 v1, s[44:47], s72 offen offset:3072 sc1 lds
v_mfma_f32_16x16x32_bf16 v[144:147], a[156:159], v[28:31], v[144:147]
v_exp_f32 v185, v185
v_mfma_f32_16x16x32_bf16 v[144:147], a[152:155], v[24:27], v[144:147]
v_exp_f32 v186, v186
v_mfma_f32_16x16x32_bf16 v[144:147], a[148:151], v[20:23], v[144:147]
v_cvt_pk_bf16_f32 v217, v170, v171
v_cvt_pk_bf16_f32 v218, v184, v185
v_mfma_f32_16x16x32_bf16 v[132:135], a[128:131], v[32:35], v[84:87]
v_exp_f32 v187, v187
v_mfma_f32_16x16x32_bf16 v[132:135], a[132:135], v[36:39], v[132:135]
v_cvt_pk_bf16_f32 v219, v186, v187
v_add_u32 v2, s82, v1
v_mfma_f32_16x16x32_bf16 v[132:135], a[136:139], v[40:43], v[132:135]
v_mfma_f32_16x16x32_bf16 v[132:135], a[140:143], v[44:47], v[132:135]
v_mfma_f32_16x16x32_bf16 v[140:143], a[140:143], v[76:79], v[92:95]
v_mfma_f32_16x16x32_bf16 v[140:143], a[136:139], v[72:75], v[140:143]
v_mfma_f32_16x16x32_bf16 v[140:143], a[132:135], v[68:71], v[140:143]
v_mfma_f32_16x16x32_bf16 v[140:143], a[128:131], v[64:67], v[140:143]
v_mfma_f32_16x16x32_bf16 v[156:159], a[144:147], v[64:67], v[92:95]
v_mfma_f32_16x16x32_bf16 v[156:159], a[148:151], v[68:71], v[156:159]
v_mfma_f32_16x16x32_bf16 v[156:159], a[152:155], v[72:75], v[156:159]
v_mfma_f32_16x16x32_bf16 v[156:159], a[156:159], v[76:79], v[156:159]
v_mfma_f32_16x16x32_bf16 v[148:151], a[156:159], v[44:47], v[84:87]
v_mfma_f32_16x16x32_bf16 v[148:151], a[152:155], v[40:43], v[148:151]
v_mfma_f32_16x16x32_bf16 v[148:151], a[148:151], v[36:39], v[148:151]
s_waitcnt vmcnt(8) lgkmcnt(4)
v_mfma_f32_16x16x32_bf16 v[148:151], a[144:147], v[32:35], v[148:151]
s_barrier
v_mfma_f32_16x16x32_bf16 v[228:231], v[120:123], v[196:199], v[228:231]
s_xor_b32 s74, s82, 0x10000
v_exp_f32 v128, v128
v_mfma_f32_16x16x32_bf16 v[228:231], v[120:123], v[212:215], v[228:231]
s_add_u32 s74, s74, s64
ds_read_b128 a[128:131], v2 offset:16384
v_mfma_f32_16x16x32_bf16 v[236:239], v[120:123], v[204:207], v[236:239]
s_add_u32 s81, s81, 0x8000
v_exp_f32 v129, v129
v_mfma_f32_16x16x32_bf16 v[236:239], v[120:123], v[220:223], v[236:239]
s_add_u32 m0, s74, 16384
v_exp_f32 v130, v130
v_mfma_f32_16x16x32_bf16 a[32:35], a[192:195], v[196:199], a[32:35]
s_add_u32 s72, s81, 16384
ds_read_b128 a[132:135], v2 offset:17408
v_cvt_pk_bf16_f32 v192, v128, v129
v_mfma_f32_16x16x32_bf16 a[32:35], a[224:227], v[212:215], a[32:35]
v_exp_f32 v131, v131
v_mfma_f32_16x16x32_bf16 a[96:99], a[224:227], v[220:223], a[96:99]
v_exp_f32 v144, v144
v_mfma_f32_16x16x32_bf16 a[96:99], a[192:195], v[204:207], a[96:99]
ds_read_b128 a[136:139], v2 offset:18432
v_cvt_pk_bf16_f32 v193, v130, v131
v_mfma_f32_16x16x32_bf16 a[100:103], a[196:199], v[204:207], a[100:103]
buffer_load_dwordx4 v1, s[44:47], s72 offen sc1 lds
v_mfma_f32_16x16x32_bf16 a[100:103], a[228:231], v[220:223], a[100:103]
v_exp_f32 v145, v145
v_mfma_f32_16x16x32_bf16 a[36:39], a[228:231], v[212:215], a[36:39]
v_exp_f32 v146, v146
v_mfma_f32_16x16x32_bf16 a[36:39], a[196:199], v[196:199], a[36:39]
ds_read_b128 a[140:143], v2 offset:19456
v_cvt_pk_bf16_f32 v194, v144, v145
v_mfma_f32_16x16x32_bf16 a[40:43], a[200:203], v[196:199], a[40:43]
v_exp_f32 v147, v147
v_mfma_f32_16x16x32_bf16 a[40:43], a[232:235], v[212:215], a[40:43]
v_exp_f32 v136, v136
v_mfma_f32_16x16x32_bf16 a[104:107], a[232:235], v[220:223], a[104:107]
ds_read_b128 a[144:147], v2 offset:20480
v_cvt_pk_bf16_f32 v195, v146, v147
v_mfma_f32_16x16x32_bf16 a[104:107], a[200:203], v[204:207], a[104:107]
v_exp_f32 v137, v137
v_mfma_f32_16x16x32_bf16 a[108:111], a[204:207], v[204:207], a[108:111]
v_exp_f32 v138, v138
v_mfma_f32_16x16x32_bf16 a[108:111], a[236:239], v[220:223], a[108:111]
ds_read_b128 a[148:151], v2 offset:21504
v_cvt_pk_bf16_f32 v200, v136, v137
v_mfma_f32_16x16x32_bf16 a[44:47], a[236:239], v[212:215], a[44:47]
v_exp_f32 v139, v139
v_mfma_f32_16x16x32_bf16 a[44:47], a[204:207], v[196:199], a[44:47]
v_exp_f32 v152, v152
v_mfma_f32_16x16x32_bf16 a[48:51], a[208:211], v[196:199], a[48:51]
s_waitcnt lgkmcnt(6)
ds_read_b128 a[152:155], v2 offset:22528
v_cvt_pk_bf16_f32 v201, v138, v139
v_mfma_f32_16x16x32_bf16 a[48:51], a[240:243], v[212:215], a[48:51]
buffer_load_dwordx4 v1, s[44:47], s72 offen offset:1024 sc1 lds
v_mfma_f32_16x16x32_bf16 a[112:115], a[240:243], v[220:223], a[112:115]
v_exp_f32 v153, v153
v_mfma_f32_16x16x32_bf16 a[112:115], a[208:211], v[204:207], a[112:115]
v_exp_f32 v154, v154
v_mfma_f32_16x16x32_bf16 a[116:119], a[212:215], v[204:207], a[116:119]
ds_read_b128 a[156:159], v2 offset:23552
v_cvt_pk_bf16_f32 v202, v152, v153
v_mfma_f32_16x16x32_bf16 a[116:119], a[244:247], v[220:223], a[116:119]
v_exp_f32 v155, v155
v_mfma_f32_16x16x32_bf16 a[52:55], a[244:247], v[212:215], a[52:55]
v_exp_f32 v132, v132
v_mfma_f32_16x16x32_bf16 a[52:55], a[212:215], v[196:199], a[52:55]
ds_read_b128 a[192:195], v2 offset:0
v_cvt_pk_bf16_f32 v203, v154, v155
v_mfma_f32_16x16x32_bf16 a[56:59], a[216:219], v[196:199], a[56:59]
v_exp_f32 v133, v133
v_mfma_f32_16x16x32_bf16 a[56:59], a[248:251], v[212:215], a[56:59]
v_exp_f32 v134, v134
v_mfma_f32_16x16x32_bf16 a[120:123], a[248:251], v[220:223], a[120:123]
ds_read_b128 a[196:199], v2 offset:1024
v_mfma_f32_16x16x32_bf16 a[120:123], a[216:219], v[204:207], a[120:123]
v_exp_f32 v135, v135
v_mfma_f32_16x16x32_bf16 a[124:127], a[220:223], v[204:207], a[124:127]
v_exp_f32 v148, v148
v_mfma_f32_16x16x32_bf16 a[124:127], a[252:255], v[220:223], a[124:127]
ds_read_b128 a[200:203], v2 offset:2048
v_mfma_f32_16x16x32_bf16 a[60:63], a[252:255], v[212:215], a[60:63]
buffer_load_dwordx4 v1, s[44:47], s72 offen offset:2048 sc1 lds
v_mfma_f32_16x16x32_bf16 a[60:63], a[220:223], v[196:199], a[60:63]
ds_read_b128 a[204:207], v2 offset:3072
v_cvt_pk_bf16_f32 v196, v132, v133
s_cmp_eq_u32 s58, 2
s_cbranch_scc1 Lta19
s_cmp_eq_u32 s58, 3
s_cbranch_scc1 Lnt20
v_mfma_f32_16x16x32_bf16 v[160:163], a[160:163], v[16:19], v[112:115]
v_exp_f32 v149, v149
v_mfma_f32_16x16x32_bf16 v[176:179], a[176:179], v[16:19], v[112:115]
v_exp_f32 v150, v150
s_branch Ljoin21
Lta19:
v_mfma_f32_16x16x32_bf16 v[160:163], a[160:163], v[16:19], v[96:99]
v_exp_f32 v149, v149
v_mfma_f32_16x16x32_bf16 v[176:179], a[176:179], v[16:19], v[112:115]
v_exp_f32 v150, v150
s_branch Ljoin21
Lnt20:
v_mfma_f32_16x16x32_bf16 v[160:163], a[160:163], v[16:19], v[80:83]
v_exp_f32 v149, v149
v_mfma_f32_16x16x32_bf16 v[176:179], a[176:179], v[16:19], v[96:99]
v_exp_f32 v150, v150
Ljoin21:
v_mfma_f32_16x16x32_bf16 v[164:167], a[160:163], v[32:35], v[84:87]
ds_read_b128 a[208:211], v2 offset:4096
v_cvt_pk_bf16_f32 v197, v134, v135
v_mfma_f32_16x16x32_bf16 v[164:167], a[164:167], v[36:39], v[164:167]
v_exp_f32 v151, v151
v_mfma_f32_16x16x32_bf16 v[164:167], a[168:171], v[40:43], v[164:167]
v_exp_f32 v140, v140
v_mfma_f32_16x16x32_bf16 v[164:167], a[172:175], v[44:47], v[164:167]
ds_read_b128 a[212:215], v2 offset:5120
v_cvt_pk_bf16_f32 v198, v148, v149
v_mfma_f32_16x16x32_bf16 v[172:175], a[172:175], v[76:79], v[92:95]
v_exp_f32 v141, v141
v_mfma_f32_16x16x32_bf16 v[172:175], a[168:171], v[72:75], v[172:175]
v_exp_f32 v142, v142
v_mfma_f32_16x16x32_bf16 v[172:175], a[164:167], v[68:71], v[172:175]
ds_read_b128 a[216:219], v2 offset:6144
v_cvt_pk_bf16_f32 v199, v150, v151
v_mfma_f32_16x16x32_bf16 v[172:175], a[160:163], v[64:67], v[172:175]
v_exp_f32 v143, v143
v_mfma_f32_16x16x32_bf16 v[188:191], a[176:179], v[64:67], v[92:95]
v_exp_f32 v156, v156
v_mfma_f32_16x16x32_bf16 v[188:191], a[180:183], v[68:71], v[188:191]
ds_read_b128 a[220:223], v2 offset:7168
v_cvt_pk_bf16_f32 v204, v140, v141
v_mfma_f32_16x16x32_bf16 v[188:191], a[184:187], v[72:75], v[188:191]
buffer_load_dwordx4 v1, s[44:47], s72 offen offset:3072 sc1 lds
v_mfma_f32_16x16x32_bf16 v[188:191], a[188:191], v[76:79], v[188:191]
v_exp_f32 v157, v157
v_mfma_f32_16x16x32_bf16 v[180:183], a[188:191], v[44:47], v[84:87]
v_exp_f32 v158, v158
v_mfma_f32_16x16x32_bf16 v[180:183], a[184:187], v[40:43], v[180:183]
v_cvt_pk_bf16_f32 v205, v142, v143
v_cvt_pk_bf16_f32 v206, v156, v157
v_mfma_f32_16x16x32_bf16 v[180:183], a[180:183], v[36:39], v[180:183]
v_exp_f32 v159, v159
v_mfma_f32_16x16x32_bf16 v[180:183], a[176:179], v[32:35], v[180:183]
v_cvt_pk_bf16_f32 v207, v158, v159
v_mfma_f32_16x16x32_bf16 v[160:163], a[164:167], v[20:23], v[160:163]
v_mfma_f32_16x16x32_bf16 v[160:163], a[168:171], v[24:27], v[160:163]
v_mfma_f32_16x16x32_bf16 v[160:163], a[172:175], v[28:31], v[160:163]
v_mfma_f32_16x16x32_bf16 v[168:171], a[172:175], v[60:63], v[88:91]
v_mfma_f32_16x16x32_bf16 v[168:171], a[168:171], v[56:59], v[168:171]
v_mfma_f32_16x16x32_bf16 v[168:171], a[164:167], v[52:55], v[168:171]
v_mfma_f32_16x16x32_bf16 v[168:171], a[160:163], v[48:51], v[168:171]
v_mfma_f32_16x16x32_bf16 v[184:187], a[176:179], v[48:51], v[88:91]
v_mfma_f32_16x16x32_bf16 v[184:187], a[180:183], v[52:55], v[184:187]
v_mfma_f32_16x16x32_bf16 v[184:187], a[184:187], v[56:59], v[184:187]
v_mfma_f32_16x16x32_bf16 v[184:187], a[188:191], v[60:63], v[184:187]
v_mfma_f32_16x16x32_bf16 v[176:179], a[188:191], v[28:31], v[176:179]
v_mfma_f32_16x16x32_bf16 v[176:179], a[184:187], v[24:27], v[176:179]
v_mfma_f32_16x16x32_bf16 v[176:179], a[180:183], v[20:23], v[176:179]
s_waitcnt lgkmcnt(4)
v_mfma_f32_16x16x32_bf16 v[224:227], v[120:123], v[208:211], v[224:227]
s_add_u32 s82, s82, 0x8000
ds_read_b128 a[160:163], v2 offset:24576
v_mfma_f32_16x16x32_bf16 v[224:227], v[120:123], v[192:195], v[224:227]
s_and_b32 s82, s82, 0x1ffff
v_exp_f32 v164, v164
v_mfma_f32_16x16x32_bf16 v[232:235], v[120:123], v[216:219], v[232:235]
s_add_u32 m0, s74, 0
v_exp_f32 v165, v165
v_mfma_f32_16x16x32_bf16 v[232:235], v[120:123], v[200:203], v[232:235]
s_add_u32 s72, s81, 0
ds_read_b128 a[164:167], v2 offset:25600
v_cvt_pk_bf16_f32 v212, v164, v165
v_mfma_f32_16x16x32_bf16 a[0:3], a[224:227], v[208:211], a[0:3]
v_exp_f32 v166, v166
v_mfma_f32_16x16x32_bf16 a[0:3], a[192:195], v[192:195], a[0:3]
v_exp_f32 v167, v167
v_mfma_f32_16x16x32_bf16 a[64:67], a[192:195], v[200:203], a[64:67]
ds_read_b128 a[168:171], v2 offset:26624
v_cvt_pk_bf16_f32 v213, v166, v167
v_mfma_f32_16x16x32_bf16 a[64:67], a[224:227], v[216:219], a[64:67]
v_exp_f32 v180, v180
v_mfma_f32_16x16x32_bf16 a[68:71], a[228:231], v[216:219], a[68:71]
buffer_load_dwordx4 v1, s[44:47], s72 offen sc1 lds
v_mfma_f32_16x16x32_bf16 a[68:71], a[196:199], v[200:203], a[68:71]
v_exp_f32 v181, v181
v_mfma_f32_16x16x32_bf16 a[4:7], a[196:199], v[192:195], a[4:7]
ds_read_b128 a[172:175], v2 offset:27648
v_cvt_pk_bf16_f32 v214, v180, v181
v_mfma_f32_16x16x32_bf16 a[4:7], a[228:231], v[208:211], a[4:7]
v_exp_f32 v182, v182
v_mfma_f32_16x16x32_bf16 a[8:11], a[232:235], v[208:211], a[8:11]
v_exp_f32 v183, v183
v_mfma_f32_16x16x32_bf16 a[8:11], a[200:203], v[192:195], a[8:11]
ds_read_b128 a[176:179], v2 offset:28672
v_cvt_pk_bf16_f32 v215, v182, v183
v_mfma_f32_16x16x32_bf16 a[72:75], a[200:203], v[200:203], a[72:75]
v_exp_f32 v172, v172
v_mfma_f32_16x16x32_bf16 a[72:75], a[232:235], v[216:219], a[72:75]
v_exp_f32 v173, v173
v_mfma_f32_16x16x32_bf16 a[76:79], a[236:239], v[216:219], a[76:79]
ds_read_b128 a[180:183], v2 offset:29696
v_cvt_pk_bf16_f32 v220, v172, v173
v_mfma_f32_16x16x32_bf16 a[76:79], a[204:207], v[200:203], a[76:79]
v_exp_f32 v174, v174
v_mfma_f32_16x16x32_bf16 a[12:15], a[204:207], v[192:195], a[12:15]
v_exp_f32 v175, v175
v_mfma_f32_16x16x32_bf16 a[12:15], a[236:239], v[208:211], a[12:15]
ds_read_b128 a[184:187], v2 offset:30720
v_cvt_pk_bf16_f32 v221, v174, v175
v_mfma_f32_16x16x32_bf16 a[16:19], a[240:243], v[208:211], a[16:19]
s_waitcnt lgkmcnt(7)
v_exp_f32 v188, v188
v_mfma_f32_16x16x32_bf16 a[16:19], a[208:211], v[192:195], a[16:19]
buffer_load_dwordx4 v1, s[44:47], s72 offen offset:1024 sc1 lds
v_mfma_f32_16x16x32_bf16 a[80:83], a[208:211], v[200:203], a[80:83]
v_exp_f32 v189, v189
v_mfma_f32_16x16x32_bf16 a[80:83], a[240:243], v[216:219], a[80:83]
ds_read_b128 a[188:191], v2 offset:31744
v_cvt_pk_bf16_f32 v222, v188, v189
v_mfma_f32_16x16x32_bf16 a[84:87], a[244:247], v[216:219], a[84:87]
v_exp_f32 v190, v190
v_mfma_f32_16x16x32_bf16 a[84:87], a[212:215], v[200:203], a[84:87]
v_exp_f32 v191, v191
v_mfma_f32_16x16x32_bf16 a[20:23], a[212:215], v[192:195], a[20:23]
ds_read_b128 a[224:227], v2 offset:8192
v_cvt_pk_bf16_f32 v223, v190, v191
v_mfma_f32_16x16x32_bf16 a[20:23], a[244:247], v[208:211], a[20:23]
v_exp_f32 v160, v160
v_mfma_f32_16x16x32_bf16 a[24:27], a[248:251], v[208:211], a[24:27]
v_exp_f32 v161, v161
v_mfma_f32_16x16x32_bf16 a[24:27], a[216:219], v[192:195], a[24:27]
ds_read_b128 a[228:231], v2 offset:9216
v_mfma_f32_16x16x32_bf16 a[88:91], a[216:219], v[200:203], a[88:91]
v_exp_f32 v162, v162
v_mfma_f32_16x16x32_bf16 a[88:91], a[248:251], v[216:219], a[88:91]
Lstub3:
s_cbranch_execz Lstub7
v_exp_f32 v163, v163
v_mfma_f32_16x16x32_bf16 a[92:95], a[252:255], v[216:219], a[92:95]
ds_read_b128 a[232:235], v2 offset:10240
v_mfma_f32_16x16x32_bf16 a[92:95], a[220:223], v[200:203], a[92:95]
v_exp_f32 v176, v176
v_mfma_f32_16x16x32_bf16 a[28:31], a[220:223], v[192:195], a[28:31]
buffer_load_dwordx4 v1, s[44:47], s72 offen offset:2048 sc1 lds
v_mfma_f32_16x16x32_bf16 a[28:31], a[252:255], v[208:211], a[28:31]
ds_read_b128 a[236:239], v2 offset:11264
v_cvt_pk_bf16_f32 v208, v160, v161
s_cmp_eq_u32 s58, 0
s_cbranch_scc1 Lta22
s_cmp_eq_u32 s58, 1
s_cbranch_scc1 Lnt23
v_mfma_f32_16x16x32_bf16 v[132:135], a[128:131], v[32:35], v[84:87]
v_exp_f32 v177, v177
v_mfma_f32_16x16x32_bf16 v[148:151], a[144:147], v[32:35], v[84:87]
v_exp_f32 v178, v178
s_branch Ljoin24
Lta22:
v_mfma_f32_16x16x32_bf16 v[132:135], a[128:131], v[32:35], v[100:103]
v_exp_f32 v177, v177
v_mfma_f32_16x16x32_bf16 v[148:151], a[144:147], v[32:35], v[112:115]
v_exp_f32 v178, v178
s_branch Ljoin24
Lnt23:
v_mfma_f32_16x16x32_bf16 v[132:135], a[128:131], v[32:35], v[84:87]
v_exp_f32 v177, v177
v_mfma_f32_16x16x32_bf16 v[148:151], a[144:147], v[32:35], v[100:103]
v_exp_f32 v178, v178
Ljoin24:
v_mfma_f32_16x16x32_bf16 v[136:139], a[128:131], v[48:51], v[88:91]
ds_read_b128 a[240:243], v2 offset:12288
v_cvt_pk_bf16_f32 v209, v162, v163
v_mfma_f32_16x16x32_bf16 v[136:139], a[132:135], v[52:55], v[136:139]
v_exp_f32 v179, v179
v_mfma_f32_16x16x32_bf16 v[136:139], a[136:139], v[56:59], v[136:139]
v_exp_f32 v168, v168
v_mfma_f32_16x16x32_bf16 v[136:139], a[140:143], v[60:63], v[136:139]
ds_read_b128 a[244:247], v2 offset:13312
v_cvt_pk_bf16_f32 v210, v176, v177
v_mfma_f32_16x16x32_bf16 v[152:155], a[156:159], v[60:63], v[88:91]
v_exp_f32 v169, v169
v_mfma_f32_16x16x32_bf16 v[152:155], a[152:155], v[56:59], v[152:155]
v_exp_f32 v170, v170
v_mfma_f32_16x16x32_bf16 v[152:155], a[148:151], v[52:55], v[152:155]
ds_read_b128 a[248:251], v2 offset:14336
v_cvt_pk_bf16_f32 v211, v178, v179
v_mfma_f32_16x16x32_bf16 v[152:155], a[144:147], v[48:51], v[152:155]
v_exp_f32 v171, v171
v_mfma_f32_16x16x32_bf16 v[132:135], a[132:135], v[36:39], v[132:135]
v_exp_f32 v184, v184
v_mfma_f32_16x16x32_bf16 v[132:135], a[136:139], v[40:43], v[132:135]
ds_read_b128 a[252:255], v2 offset:15360
v_cvt_pk_bf16_f32 v216, v168, v169
v_mfma_f32_16x16x32_bf16 v[132:135], a[140:143], v[44:47], v[132:135]
buffer_load_dwordx4 v1, s[44:47], s72 offen offset:3072 sc1 lds
v_mfma_f32_16x16x32_bf16 v[140:143], a[140:143], v[76:79], v[92:95]
v_exp_f32 v185, v185
v_mfma_f32_16x16x32_bf16 v[140:143], a[136:139], v[72:75], v[140:143]
v_exp_f32 v186, v186
v_mfma_f32_16x16x32_bf16 v[140:143], a[132:135], v[68:71], v[140:143]
v_cvt_pk_bf16_f32 v217, v170, v171
v_cvt_pk_bf16_f32 v218, v184, v185
v_mfma_f32_16x16x32_bf16 v[140:143], a[128:131], v[64:67], v[140:143]
v_exp_f32 v187, v187
v_mfma_f32_16x16x32_bf16 v[156:159], a[144:147], v[64:67], v[92:95]
v_cvt_pk_bf16_f32 v219, v186, v187
v_add_u32 v2, s82, v1
v_mfma_f32_16x16x32_bf16 v[156:159], a[148:151], v[68:71], v[156:159]
v_mfma_f32_16x16x32_bf16 v[156:159], a[152:155], v[72:75], v[156:159]
v_mfma_f32_16x16x32_bf16 v[156:159], a[156:159], v[76:79], v[156:159]
v_mfma_f32_16x16x32_bf16 v[148:151], a[156:159], v[44:47], v[148:151]
v_mfma_f32_16x16x32_bf16 v[148:151], a[152:155], v[40:43], v[148:151]
s_waitcnt vmcnt(8) lgkmcnt(4)
v_mfma_f32_16x16x32_bf16 v[148:151], a[148:151], v[36:39], v[148:151]
s_barrier
s_cmp_eq_u32 s60, 7
s_cbranch_scc1 LLT3x
LLT3:
Lstub4:
s_cbranch_execz Lstub8
v_mfma_f32_16x16x32_bf16 v[228:231], v[120:123], v[196:199], v[228:231]
s_xor_b32 s74, s82, 0x10000
v_exp_f32 v136, v136
v_mfma_f32_16x16x32_bf16 v[228:231], v[120:123], v[212:215], v[228:231]
s_add_u32 s74, s74, s64
ds_read_b128 a[128:131], v2 offset:16384
v_and_b32 v240, 15, v0
v_mfma_f32_16x16x32_bf16 v[236:239], v[120:123], v[204:207], v[236:239]
s_add_u32 s81, s81, 0x8000
v_exp_f32 v137, v137
v_mfma_f32_16x16x32_bf16 v[236:239], v[120:123], v[220:223], v[236:239]
s_add_u32 m0, s74, 16384
ds_read_b128 a[132:135], v2 offset:17408
v_cvt_pk_bf16_f32 v200, v136, v137
v_mfma_f32_16x16x32_bf16 a[32:35], a[192:195], v[196:199], a[32:35]
s_add_u32 s72, s81, 16384
buffer_load_dwordx4 v1, s[44:47], s72 offen sc1 lds
v_mfma_f32_16x16x32_bf16 a[32:35], a[224:227], v[212:215], a[32:35]
s_add_u32 s69, s93, 0x3e00000
v_exp_f32 v138, v138
v_mfma_f32_16x16x32_bf16 a[96:99], a[224:227], v[220:223], a[96:99]
v_exp_f32 v139, v139
v_mfma_f32_16x16x32_bf16 a[96:99], a[192:195], v[204:207], a[96:99]
ds_read_b128 a[136:139], v2 offset:18432
v_cvt_pk_bf16_f32 v201, v138, v139
v_mfma_f32_16x16x32_bf16 a[100:103], a[196:199], v[204:207], a[100:103]
v_exp_f32 v152, v152
v_mfma_f32_16x16x32_bf16 a[100:103], a[228:231], v[220:223], a[100:103]
ds_read_b128 a[140:143], v2 offset:19456
v_lshrrev_b32 v241, 4, v0
v_mfma_f32_16x16x32_bf16 a[36:39], a[228:231], v[212:215], a[36:39]
buffer_store_dwordx4 v[112:115], v1, s[44:47], s69 offen sc1
v_mfma_f32_16x16x32_bf16 a[36:39], a[196:199], v[196:199], a[36:39]
v_exp_f32 v153, v153
v_mfma_f32_16x16x32_bf16 a[40:43], a[200:203], v[196:199], a[40:43]
v_exp_f32 v154, v154
v_mfma_f32_16x16x32_bf16 a[40:43], a[232:235], v[212:215], a[40:43]
ds_read_b128 a[144:147], v2 offset:20480
v_cvt_pk_bf16_f32 v202, v152, v153
v_mfma_f32_16x16x32_bf16 a[104:107], a[232:235], v[220:223], a[104:107]
v_exp_f32 v155, v155
v_mfma_f32_16x16x32_bf16 a[104:107], a[200:203], v[204:207], a[104:107]
ds_read_b128 a[148:151], v2 offset:21504
v_cvt_pk_bf16_f32 v203, v154, v155
v_mfma_f32_16x16x32_bf16 a[108:111], a[204:207], v[204:207], a[108:111]
buffer_load_dwordx4 v1, s[44:47], s72 offen offset:1024 sc1 lds
v_mfma_f32_16x16x32_bf16 a[108:111], a[236:239], v[220:223], a[108:111]
v_exp_f32 v132, v132
v_mfma_f32_16x16x32_bf16 a[44:47], a[236:239], v[212:215], a[44:47]
v_exp_f32 v133, v133
v_mfma_f32_16x16x32_bf16 a[44:47], a[204:207], v[196:199], a[44:47]
ds_read_b128 a[152:155], v2 offset:22528
v_add_u32 v248, 1, v240
v_mfma_f32_16x16x32_bf16 a[48:51], a[208:211], v[196:199], a[48:51]
s_waitcnt lgkmcnt(7)
v_exp_f32 v134, v134
v_mfma_f32_16x16x32_bf16 a[48:51], a[240:243], v[212:215], a[48:51]
ds_read_b128 a[156:159], v2 offset:23552
v_and_b32 v249, 3, v248
v_mfma_f32_16x16x32_bf16 a[112:115], a[240:243], v[220:223], a[112:115]
buffer_store_dwordx4 v[112:115], v1, s[44:47], s69 offen offset:1024 sc1
v_mfma_f32_16x16x32_bf16 a[112:115], a[208:211], v[204:207], a[112:115]
v_exp_f32 v135, v135
v_mfma_f32_16x16x32_bf16 a[116:119], a[212:215], v[204:207], a[116:119]
v_exp_f32 v148, v148
v_mfma_f32_16x16x32_bf16 a[116:119], a[244:247], v[220:223], a[116:119]
ds_read_b128 a[192:195], v2 offset:0
v_lshrrev_b32 v248, 2, v248
v_mfma_f32_16x16x32_bf16 a[52:55], a[244:247], v[212:215], a[52:55]
v_exp_f32 v149, v149
v_mfma_f32_16x16x32_bf16 a[52:55], a[212:215], v[196:199], a[52:55]
ds_read_b128 a[196:199], v2 offset:1024
v_mov_b32 v250, 0x20000
v_mfma_f32_16x16x32_bf16 a[56:59], a[216:219], v[196:199], a[56:59]
buffer_load_dwordx4 v1, s[44:47], s72 offen offset:2048 sc1 lds
v_mfma_f32_16x16x32_bf16 a[56:59], a[248:251], v[212:215], a[56:59]
v_exp_f32 v150, v150
v_mfma_f32_16x16x32_bf16 a[120:123], a[248:251], v[220:223], a[120:123]
v_exp_f32 v151, v151
v_mfma_f32_16x16x32_bf16 a[120:123], a[216:219], v[204:207], a[120:123]
ds_read_b128 a[200:203], v2 offset:2048
v_mov_b32 v252, 0x20001
v_mfma_f32_16x16x32_bf16 a[124:127], a[220:223], v[204:207], a[124:127]
v_exp_f32 v140, v140
v_mfma_f32_16x16x32_bf16 a[124:127], a[252:255], v[220:223], a[124:127]
ds_read_b128 a[204:207], v2 offset:3072
v_lshlrev_b32 v6, 3, v249
v_mfma_f32_16x16x32_bf16 a[60:63], a[252:255], v[212:215], a[60:63]
buffer_store_dwordx4 v[112:115], v1, s[44:47], s69 offen offset:2048 sc1
v_mfma_f32_16x16x32_bf16 a[60:63], a[220:223], v[196:199], a[60:63]
ds_read_b128 a[208:211], v2 offset:4096
v_cvt_pk_bf16_f32 v196, v132, v133
s_cmp_eq_u32 s58, 2
s_cbranch_scc1 Lta25
s_cmp_eq_u32 s58, 3
s_cbranch_scc1 Lnt26
v_mfma_f32_16x16x32_bf16 v[164:167], a[160:163], v[32:35], v[112:115]
ds_read_b128 a[212:215], v2 offset:5120
v_cvt_pk_bf16_f32 v197, v134, v135
v_mfma_f32_16x16x32_bf16 v[180:183], a[176:179], v[32:35], v[112:115]
ds_read_b128 a[216:219], v2 offset:6144
v_cvt_pk_bf16_f32 v198, v148, v149
s_branch Ljoin27
Lta25:
v_mfma_f32_16x16x32_bf16 v[164:167], a[160:163], v[32:35], v[100:103]
ds_read_b128 a[212:215], v2 offset:5120
v_cvt_pk_bf16_f32 v197, v134, v135
v_mfma_f32_16x16x32_bf16 v[180:183], a[176:179], v[32:35], v[112:115]
ds_read_b128 a[216:219], v2 offset:6144
v_cvt_pk_bf16_f32 v198, v148, v149
s_branch Ljoin27
Lnt26:
v_mfma_f32_16x16x32_bf16 v[164:167], a[160:163], v[32:35], v[84:87]
ds_read_b128 a[212:215], v2 offset:5120
v_cvt_pk_bf16_f32 v197, v134, v135
v_mfma_f32_16x16x32_bf16 v[180:183], a[176:179], v[32:35], v[100:103]
ds_read_b128 a[216:219], v2 offset:6144
v_cvt_pk_bf16_f32 v198, v148, v149
Ljoin27:
v_mfma_f32_16x16x32_bf16 v[164:167], a[164:167], v[36:39], v[164:167]
v_exp_f32 v141, v141
v_mfma_f32_16x16x32_bf16 v[164:167], a[168:171], v[40:43], v[164:167]
v_exp_f32 v142, v142
v_mfma_f32_16x16x32_bf16 v[164:167], a[172:175], v[44:47], v[164:167]
ds_read_b128 a[220:223], v2 offset:7168
v_cvt_pk_bf16_f32 v199, v150, v151
v_mfma_f32_16x16x32_bf16 v[172:175], a[172:175], v[76:79], v[92:95]
v_exp_f32 v143, v143
v_mfma_f32_16x16x32_bf16 v[172:175], a[168:171], v[72:75], v[172:175]
buffer_load_dwordx4 v1, s[44:47], s72 offen offset:3072 sc1 lds
v_mfma_f32_16x16x32_bf16 v[172:175], a[164:167], v[68:71], v[172:175]
v_exp_f32 v156, v156
v_mfma_f32_16x16x32_bf16 v[172:175], a[160:163], v[64:67], v[172:175]
v_cvt_pk_bf16_f32 v204, v140, v141
v_cvt_pk_bf16_f32 v205, v142, v143
v_mfma_f32_16x16x32_bf16 v[188:191], a[176:179], v[64:67], v[92:95]
v_exp_f32 v157, v157
v_mfma_f32_16x16x32_bf16 v[188:191], a[180:183], v[68:71], v[188:191]
v_exp_f32 v158, v158
v_mfma_f32_16x16x32_bf16 v[188:191], a[184:187], v[72:75], v[188:191]
buffer_store_dwordx4 v[112:115], v1, s[44:47], s69 offen offset:3072 sc1
v_mfma_f32_16x16x32_bf16 v[188:191], a[188:191], v[76:79], v[188:191]
v_exp_f32 v159, v159
v_mfma_f32_16x16x32_bf16 v[180:183], a[188:191], v[44:47], v[180:183]
v_cvt_pk_bf16_f32 v206, v156, v157
v_cvt_pk_bf16_f32 v207, v158, v159
v_mfma_f32_16x16x32_bf16 v[180:183], a[184:187], v[40:43], v[180:183]
v_lshrrev_b32 v6, v6, v252
v_and_b32 v6, 3, v6
v_mfma_f32_16x16x32_bf16 v[180:183], a[180:183], v[36:39], v[180:183]
v_cmp_ne_u32 vcc, 1, v249
v_mul_u32_u24 v6, 16640, v6
v_mfma_f32_16x16x32_bf16 v[168:171], a[160:163], v[48:51], v[88:91]
v_add_u32 v6, s92, v6
v_cndmask_b32 v6, v250, v6, vcc
v_mfma_f32_16x16x32_bf16 v[168:171], a[164:167], v[52:55], v[168:171]
v_add_u32 v253, s58, v249
v_and_b32 v253, 3, v253
v_mfma_f32_16x16x32_bf16 v[168:171], a[168:171], v[56:59], v[168:171]
v_mul_u32_u24 v253, 4160, v253
v_add_u32 v6, v6, v253
v_mfma_f32_16x16x32_bf16 v[168:171], a[172:175], v[60:63], v[168:171]
v_bfe_u32 v251, v0, 2, 2
v_lshl_add_u32 v6, v248, 3, v6
v_mfma_f32_16x16x32_bf16 v[184:187], a[188:191], v[60:63], v[88:91]
v_lshl_add_u32 v6, v241, 4, v6
v_lshlrev_b32 v5, 3, v251
v_mfma_f32_16x16x32_bf16 v[184:187], a[184:187], v[56:59], v[184:187]
v_lshrrev_b32 v5, v5, v252
v_and_b32 v5, 3, v5
v_mfma_f32_16x16x32_bf16 v[184:187], a[180:183], v[52:55], v[184:187]
v_cmp_ne_u32 vcc, 1, v251
v_mul_u32_u24 v5, 16640, v5
v_mfma_f32_16x16x32_bf16 v[184:187], a[176:179], v[48:51], v[184:187]
s_waitcnt lgkmcnt(4)
v_mfma_f32_16x16x32_bf16 v[224:227], v[120:123], v[208:211], v[224:227]
s_add_u32 s82, s82, 0x8000
ds_read_b128 a[160:163], v2 offset:24576
ds_read_b128 a[164:167], v2 offset:25600
v_mfma_f32_16x16x32_bf16 v[232:235], v[120:123], v[216:219], v[232:235]
s_and_b32 s82, s82, 0x1ffff
v_exp_f32 v164, v164
v_mfma_f32_16x16x32_bf16 v[232:235], v[120:123], v[200:203], v[232:235]
s_add_u32 m0, s74, 0
v_exp_f32 v165, v165
v_mfma_f32_16x16x32_bf16 a[0:3], a[224:227], v[208:211], a[0:3]
s_add_u32 s72, s81, 0
v_exp_f32 v166, v166
v_mfma_f32_16x16x32_bf16 a[64:67], a[192:195], v[200:203], a[64:67]
ds_read_b128 a[168:171], v2 offset:26624
v_cvt_pk_bf16_f32 v212, v164, v165
v_mfma_f32_16x16x32_bf16 a[64:67], a[224:227], v[216:219], a[64:67]
v_exp_f32 v167, v167
v_mfma_f32_16x16x32_bf16 a[68:71], a[228:231], v[216:219], a[68:71]
buffer_load_dwordx4 v1, s[44:47], s72 offen sc1 lds
v_mfma_f32_16x16x32_bf16 a[68:71], a[196:199], v[200:203], a[68:71]
v_exp_f32 v180, v180
v_mfma_f32_16x16x32_bf16 a[4:7], a[228:231], v[208:211], a[4:7]
ds_read_b128 a[172:175], v2 offset:27648
v_cvt_pk_bf16_f32 v213, v166, v167
v_mfma_f32_16x16x32_bf16 a[8:11], a[232:235], v[208:211], a[8:11]
v_exp_f32 v181, v181
v_mfma_f32_16x16x32_bf16 a[72:75], a[200:203], v[200:203], a[72:75]
ds_read_b128 a[176:179], v2 offset:28672
v_cvt_pk_bf16_f32 v214, v180, v181
v_mfma_f32_16x16x32_bf16 a[72:75], a[232:235], v[216:219], a[72:75]
v_exp_f32 v182, v182
v_mfma_f32_16x16x32_bf16 a[76:79], a[236:239], v[216:219], a[76:79]
v_exp_f32 v183, v183
v_mfma_f32_16x16x32_bf16 a[76:79], a[204:207], v[200:203], a[76:79]
ds_read_b128 a[180:183], v2 offset:29696
v_cvt_pk_bf16_f32 v215, v182, v183
v_mfma_f32_16x16x32_bf16 a[12:15], a[236:239], v[208:211], a[12:15]
v_exp_f32 v172, v172
v_mfma_f32_16x16x32_bf16 a[16:19], a[240:243], v[208:211], a[16:19]
s_waitcnt lgkmcnt(6)
ds_read_b128 a[184:187], v2 offset:30720
ds_read_b128 a[188:191], v2 offset:31744
v_mfma_f32_16x16x32_bf16 a[80:83], a[208:211], v[200:203], a[80:83]
v_exp_f32 v173, v173
v_mfma_f32_16x16x32_bf16 a[80:83], a[240:243], v[216:219], a[80:83]
buffer_load_dwordx4 v1, s[44:47], s72 offen offset:1024 sc1 lds
v_mfma_f32_16x16x32_bf16 a[84:87], a[244:247], v[216:219], a[84:87]
v_exp_f32 v174, v174
v_mfma_f32_16x16x32_bf16 a[84:87], a[212:215], v[200:203], a[84:87]
v_exp_f32 v175, v175
v_mfma_f32_16x16x32_bf16 a[20:23], a[244:247], v[208:211], a[20:23]
ds_read_b128 a[224:227], v2 offset:8192
v_cvt_pk_bf16_f32 v220, v172, v173
v_mfma_f32_16x16x32_bf16 a[24:27], a[248:251], v[208:211], a[24:27]
v_exp_f32 v188, v188
v_mfma_f32_16x16x32_bf16 a[88:91], a[216:219], v[200:203], a[88:91]
v_exp_f32 v189, v189
v_mfma_f32_16x16x32_bf16 a[88:91], a[248:251], v[216:219], a[88:91]
ds_read_b128 a[228:231], v2 offset:9216
v_cvt_pk_bf16_f32 v221, v174, v175
v_mfma_f32_16x16x32_bf16 a[92:95], a[252:255], v[216:219], a[92:95]
v_exp_f32 v190, v190
v_mfma_f32_16x16x32_bf16 a[92:95], a[220:223], v[200:203], a[92:95]
ds_read_b128 a[232:235], v2 offset:10240
v_cvt_pk_bf16_f32 v222, v188, v189
v_mfma_f32_16x16x32_bf16 a[28:31], a[252:255], v[208:211], a[28:31]
v_exp_f32 v191, v191
v_mfma_f32_16x16x32_bf16 v[136:139], a[128:131], v[48:51], v[88:91]
buffer_load_dwordx4 v1, s[44:47], s72 offen offset:2048 sc1 lds
v_mfma_f32_16x16x32_bf16 v[136:139], a[132:135], v[52:55], v[136:139]
v_exp_f32 v168, v168
v_mfma_f32_16x16x32_bf16 v[136:139], a[136:139], v[56:59], v[136:139]
ds_read_b128 a[236:239], v2 offset:11264
v_cvt_pk_bf16_f32 v223, v190, v191
v_mfma_f32_16x16x32_bf16 v[136:139], a[140:143], v[60:63], v[136:139]
v_exp_f32 v169, v169
v_mfma_f32_16x16x32_bf16 v[152:155], a[156:159], v[60:63], v[88:91]
ds_read_b128 a[240:243], v2 offset:12288
v_cvt_pk_bf16_f32 v216, v168, v169
v_mfma_f32_16x16x32_bf16 v[152:155], a[152:155], v[56:59], v[152:155]
v_exp_f32 v170, v170
v_mfma_f32_16x16x32_bf16 v[152:155], a[148:151], v[52:55], v[152:155]
v_exp_f32 v171, v171
v_mfma_f32_16x16x32_bf16 v[152:155], a[144:147], v[48:51], v[152:155]
ds_read_b128 a[244:247], v2 offset:13312
v_cvt_pk_bf16_f32 v217, v170, v171
v_mfma_f32_16x16x32_bf16 v[140:143], a[128:131], v[64:67], v[92:95]
v_exp_f32 v184, v184
v_mfma_f32_16x16x32_bf16 v[140:143], a[132:135], v[68:71], v[140:143]
ds_read_b128 a[248:251], v2 offset:14336
v_mfma_f32_16x16x32_bf16 v[140:143], a[136:139], v[72:75], v[140:143]
v_exp_f32 v185, v185
v_mfma_f32_16x16x32_bf16 v[140:143], a[140:143], v[76:79], v[140:143]
buffer_load_dwordx4 v1, s[44:47], s72 offen offset:3072 sc1 lds
v_mfma_f32_16x16x32_bf16 v[156:159], a[156:159], v[76:79], v[92:95]
ds_read_b128 a[252:255], v2 offset:15360
v_cvt_pk_bf16_f32 v218, v184, v185
v_mfma_f32_16x16x32_bf16 v[156:159], a[152:155], v[72:75], v[156:159]
v_exp_f32 v186, v186
v_mfma_f32_16x16x32_bf16 v[156:159], a[148:151], v[68:71], v[156:159]
s_waitcnt vmcnt(12) lgkmcnt(4)
v_exp_f32 v187, v187
v_mfma_f32_16x16x32_bf16 v[156:159], a[144:147], v[64:67], v[156:159]
s_barrier
v_cvt_pk_bf16_f32 v219, v186, v187
v_add_u32 v2, s82, v1
v_mfma_f32_16x16x32_bf16 v[228:231], v[120:123], v[196:199], v[228:231]
s_xor_b32 s74, s82, 0x10000
v_exp_f32 v136, v136
v_mfma_f32_16x16x32_bf16 v[228:231], v[120:123], v[212:215], v[228:231]
s_add_u32 s74, s74, s64
ds_read_b128 a[128:131], v2 offset:16384
v_add_u32 v5, s92, v5
v_mfma_f32_16x16x32_bf16 v[236:239], v[120:123], v[204:207], v[236:239]
s_add_u32 s81, s81, 0x8000
v_exp_f32 v137, v137
v_mfma_f32_16x16x32_bf16 v[236:239], v[120:123], v[220:223], v[236:239]
s_add_u32 m0, s74, 16384
ds_read_b128 a[132:135], v2 offset:17408
v_cvt_pk_bf16_f32 v200, v136, v137
v_mfma_f32_16x16x32_bf16 a[32:35], a[192:195], v[196:199], a[32:35]
s_add_u32 s72, s81, 16384
buffer_load_dwordx4 v1, s[44:47], s72 offen sc1 lds
v_mfma_f32_16x16x32_bf16 a[32:35], a[224:227], v[212:215], a[32:35]
s_add_u32 s69, s93, 0x4200000
v_exp_f32 v138, v138
v_mfma_f32_16x16x32_bf16 a[96:99], a[224:227], v[220:223], a[96:99]
ds_read_b128 a[136:139], v2 offset:18432
v_cndmask_b32 v5, v250, v5, vcc
v_mfma_f32_16x16x32_bf16 a[96:99], a[192:195], v[204:207], a[96:99]
v_exp_f32 v139, v139
v_mfma_f32_16x16x32_bf16 a[100:103], a[196:199], v[204:207], a[100:103]
ds_read_b128 a[140:143], v2 offset:19456
v_cvt_pk_bf16_f32 v201, v138, v139
v_mfma_f32_16x16x32_bf16 a[100:103], a[228:231], v[220:223], a[100:103]
buffer_store_dwordx4 v[112:115], v1, s[44:47], s69 offen sc1
v_mfma_f32_16x16x32_bf16 a[36:39], a[228:231], v[212:215], a[36:39]
v_exp_f32 v152, v152
v_mfma_f32_16x16x32_bf16 a[36:39], a[196:199], v[196:199], a[36:39]
ds_read_b128 a[144:147], v2 offset:20480
v_add_u32 v253, s58, v251
v_mfma_f32_16x16x32_bf16 a[40:43], a[200:203], v[196:199], a[40:43]
v_exp_f32 v153, v153
v_mfma_f32_16x16x32_bf16 a[40:43], a[232:235], v[212:215], a[40:43]
ds_read_b128 a[148:151], v2 offset:21504
v_cvt_pk_bf16_f32 v202, v152, v153
v_mfma_f32_16x16x32_bf16 a[104:107], a[232:235], v[220:223], a[104:107]
buffer_load_dwordx4 v1, s[44:47], s72 offen offset:1024 sc1 lds
v_mfma_f32_16x16x32_bf16 a[104:107], a[200:203], v[204:207], a[104:107]
v_exp_f32 v154, v154
v_mfma_f32_16x16x32_bf16 a[108:111], a[204:207], v[204:207], a[108:111]
ds_read_b128 a[152:155], v2 offset:22528
v_and_b32 v253, 3, v253
v_mfma_f32_16x16x32_bf16 a[108:111], a[236:239], v[220:223], a[108:111]
v_exp_f32 v155, v155
v_mfma_f32_16x16x32_bf16 a[44:47], a[236:239], v[212:215], a[44:47]
ds_read_b128 a[156:159], v2 offset:23552
v_cvt_pk_bf16_f32 v203, v154, v155
v_mfma_f32_16x16x32_bf16 a[44:47], a[204:207], v[196:199], a[44:47]
buffer_store_dwordx4 v[112:115], v1, s[44:47], s69 offen offset:1024 sc1
v_mfma_f32_16x16x32_bf16 a[48:51], a[208:211], v[196:199], a[48:51]
s_waitcnt lgkmcnt(8)
v_exp_f32 v140, v140
v_mfma_f32_16x16x32_bf16 a[48:51], a[240:243], v[212:215], a[48:51]
ds_read_b128 a[192:195], v2 offset:0
v_mul_u32_u24 v253, 4160, v253
v_mfma_f32_16x16x32_bf16 a[112:115], a[240:243], v[220:223], a[112:115]
v_exp_f32 v141, v141
v_mfma_f32_16x16x32_bf16 a[112:115], a[208:211], v[204:207], a[112:115]
ds_read_b128 a[196:199], v2 offset:1024
v_add_u32 v5, v5, v253
v_mfma_f32_16x16x32_bf16 a[116:119], a[212:215], v[204:207], a[116:119]
s_add_u32 s73, s62, 480
buffer_load_dwordx4 v1, s[44:47], s72 offen offset:2048 sc1 lds
v_mfma_f32_16x16x32_bf16 a[116:119], a[244:247], v[220:223], a[116:119]
v_exp_f32 v142, v142
v_mfma_f32_16x16x32_bf16 a[52:55], a[244:247], v[212:215], a[52:55]
ds_read_b128 a[200:203], v2 offset:2048
v_lshlrev_b32 v248, 5, v240
v_mfma_f32_16x16x32_bf16 a[52:55], a[212:215], v[196:199], a[52:55]
v_exp_f32 v143, v143
v_mfma_f32_16x16x32_bf16 a[56:59], a[216:219], v[196:199], a[56:59]
ds_read_b128 a[204:207], v2 offset:3072
v_sub_u32 v248, s73, v248
v_mfma_f32_16x16x32_bf16 a[56:59], a[248:251], v[212:215], a[56:59]
buffer_store_dwordx4 v[112:115], v1, s[44:47], s69 offen offset:2048 sc1
v_mfma_f32_16x16x32_bf16 a[120:123], a[248:251], v[220:223], a[120:123]
v_exp_f32 v156, v156
v_mfma_f32_16x16x32_bf16 a[120:123], a[216:219], v[204:207], a[120:123]
ds_read_b128 a[208:211], v2 offset:4096
v_lshl_add_u32 v7, v241, 4, v248
v_mfma_f32_16x16x32_bf16 a[124:127], a[220:223], v[204:207], a[124:127]
s_and_b32 s73, s58, 1
v_exp_f32 v157, v157
v_mfma_f32_16x16x32_bf16 a[124:127], a[252:255], v[220:223], a[124:127]
s_lshl_b32 s73, s73, 4
ds_read_b128 a[212:215], v2 offset:5120
v_mfma_f32_16x16x32_bf16 a[60:63], a[252:255], v[212:215], a[60:63]
s_lshr_b32 s73, s90, s73
buffer_load_dwordx4 v1, s[44:47], s72 offen offset:3072 sc1 lds
v_mfma_f32_16x16x32_bf16 a[60:63], a[220:223], v[196:199], a[60:63]
s_and_b32 s73, s73, 0xffff
ds_read_b128 a[216:219], v2 offset:6144
v_cvt_pk_bf16_f32 v204, v140, v141
v_mfma_f32_16x16x32_bf16 v[172:175], a[160:163], v[64:67], v[92:95]
v_exp_f32 v158, v158
v_mfma_f32_16x16x32_bf16 v[172:175], a[164:167], v[68:71], v[172:175]
ds_read_b128 a[220:223], v2 offset:7168
v_cvt_pk_bf16_f32 v205, v142, v143
v_mfma_f32_16x16x32_bf16 v[172:175], a[168:171], v[72:75], v[172:175]
v_exp_f32 v159, v159
v_mfma_f32_16x16x32_bf16 v[172:175], a[172:175], v[76:79], v[172:175]
buffer_store_dwordx4 v[112:115], v1, s[44:47], s69 offen offset:3072 sc1
v_mfma_f32_16x16x32_bf16 v[188:191], a[188:191], v[76:79], v[92:95]
v_cvt_pk_bf16_f32 v206, v156, v157
v_cvt_pk_bf16_f32 v207, v158, v159
v_mfma_f32_16x16x32_bf16 v[188:191], a[184:187], v[72:75], v[188:191]
v_lshl_add_u32 v248, v241, 3, v240
v_sub_u32 v248, 15, v248
v_mfma_f32_16x16x32_bf16 v[188:191], a[180:183], v[68:71], v[188:191]
v_and_b32 v249, 1, v248
v_lshlrev_b32 v249, 4, v249
v_mfma_f32_16x16x32_bf16 v[188:191], a[176:179], v[64:67], v[188:191]
v_lshlrev_b32 v249, v249, s73
v_lshrrev_b32 v248, 1, v248
v_mfma_f32_16x16x32_bf16 v[168:171], a[160:163], v[48:51], v[88:91]
v_and_b32 v241, 3, v0
v_cmp_eq_u32 vcc, 0, v248
v_mfma_f32_16x16x32_bf16 v[168:171], a[164:167], v[52:55], v[168:171]
v_lshl_add_u32 v5, v241, 3, v5
v_cndmask_b32 v8, 0, v249, vcc
v_mfma_f32_16x16x32_bf16 v[168:171], a[168:171], v[56:59], v[168:171]
v_cmp_eq_u32 vcc, 1, v248
v_lshlrev_b32 v240, 4, v251
v_mfma_f32_16x16x32_bf16 v[168:171], a[172:175], v[60:63], v[168:171]
v_cndmask_b32 v9, 0, v249, vcc
v_cmp_eq_u32 vcc, 2, v248
v_mfma_f32_16x16x32_bf16 v[184:187], a[188:191], v[60:63], v[88:91]
v_sub_u32 v240, 48, v240
v_lshlrev_b64 v[12:13], 16, s[88:89]
v_mfma_f32_16x16x32_bf16 v[184:187], a[184:187], v[56:59], v[184:187]
v_cndmask_b32 v10, 0, v249, vcc
v_cmp_eq_u32 vcc, 3, v248
v_mfma_f32_16x16x32_bf16 v[184:187], a[180:183], v[52:55], v[184:187]
v_lshlrev_b64 v[12:13], v240, v[12:13]
v_cndmask_b32 v11, 0, v249, vcc
v_mfma_f32_16x16x32_bf16 v[184:187], a[176:179], v[48:51], v[184:187]
s_waitcnt lgkmcnt(4)
v_cmp_eq_u32 vcc, 3, v241
s_add_u32 s73, s62, 4096
v_lshl_add_u32 v14, v0, 3, s73
v_cndmask_b32 v12, 0, v12, vcc
v_cndmask_b32 v13, 0, v13, vcc
v_lshrrev_b32 v15, 4, v0
v_lshlrev_b32 v15, 1, v15
v_and_b32 v240, 7, v0
v_xor_b32 v15, v15, v240
v_lshlrev_b32 v15, 4, v15
v_lshrrev_b32 v240, 3, v0
v_lshl_add_u32 v15, v240, 11, v15
s_lshl_b32 s75, s59, 1
s_andn2_b32 s75, 8, s75
s_add_u32 s75, s75, s60
s_lshl_b32 s76, s65, 2
s_lshr_b32 s80, s59, 3
s_add_u32 s76, s76, s80
s_lshl_b32 s94, s58, 16
s_lshl_b32 s80, s76, 7
s_add_u32 s94, s94, s80
s_lshl_b32 s80, s75, 18
s_add_u32 s80, s80, s94
v_rcp_f32 v226, v224
v_rcp_f32 v230, v228
s_lshl_b32 s73, s52, 12
s_add_u32 s73, s73, 0x2000000
s_lshl_b32 s70, s67, 2
s_add_u32 s70, s70, s73
v_or_b32 v3, s53, v1
v_mov_b32 v227, v226
v_accvgpr_read_b32 v240, a0
v_accvgpr_read_b32 v241, a1
v_accvgpr_read_b32 v242, a2
v_accvgpr_read_b32 v243, a3
v_accvgpr_read_b32 v244, a4
v_accvgpr_read_b32 v245, a5
v_accvgpr_read_b32 v246, a6
v_accvgpr_read_b32 v247, a7
v_pk_mul_f32 v[240:241], v[240:241], v[226:227]
v_pk_mul_f32 v[242:243], v[242:243], v[226:227]
v_pk_mul_f32 v[244:245], v[244:245], v[226:227]
v_pk_mul_f32 v[246:247], v[246:247], v[226:227]
v_cvt_pk_bf16_f32 v128, v240, v241
v_cvt_pk_bf16_f32 v129, v242, v243
v_cvt_pk_bf16_f32 v130, v244, v245
v_cvt_pk_bf16_f32 v131, v246, v247
v_accvgpr_read_b32 v248, a8
v_accvgpr_read_b32 v249, a9
v_accvgpr_read_b32 v250, a10
v_accvgpr_read_b32 v251, a11
v_accvgpr_read_b32 v252, a12
v_accvgpr_read_b32 v253, a13
v_accvgpr_read_b32 v254, a14
v_accvgpr_read_b32 v255, a15
v_pk_mul_f32 v[248:249], v[248:249], v[226:227]
v_pk_mul_f32 v[250:251], v[250:251], v[226:227]
v_pk_mul_f32 v[252:253], v[252:253], v[226:227]
v_pk_mul_f32 v[254:255], v[254:255], v[226:227]
v_cvt_pk_bf16_f32 v144, v248, v249
v_cvt_pk_bf16_f32 v145, v250, v251
v_cvt_pk_bf16_f32 v146, v252, v253
v_cvt_pk_bf16_f32 v147, v254, v255
v_accvgpr_read_b32 v240, a16
v_accvgpr_read_b32 v241, a17
v_accvgpr_read_b32 v242, a18
v_accvgpr_read_b32 v243, a19
v_accvgpr_read_b32 v244, a20
v_accvgpr_read_b32 v245, a21
v_accvgpr_read_b32 v246, a22
v_accvgpr_read_b32 v247, a23
v_pk_mul_f32 v[240:241], v[240:241], v[226:227]
v_pk_mul_f32 v[242:243], v[242:243], v[226:227]
v_pk_mul_f32 v[244:245], v[244:245], v[226:227]
v_pk_mul_f32 v[246:247], v[246:247], v[226:227]
v_cvt_pk_bf16_f32 v160, v240, v241
v_cvt_pk_bf16_f32 v161, v242, v243
v_cvt_pk_bf16_f32 v162, v244, v245
v_cvt_pk_bf16_f32 v163, v246, v247
v_accvgpr_read_b32 v248, a24
v_accvgpr_read_b32 v249, a25
v_accvgpr_read_b32 v250, a26
v_accvgpr_read_b32 v251, a27
v_accvgpr_read_b32 v252, a28
v_accvgpr_read_b32 v253, a29
v_accvgpr_read_b32 v254, a30
v_accvgpr_read_b32 v255, a31
v_pk_mul_f32 v[248:249], v[248:249], v[226:227]
v_pk_mul_f32 v[250:251], v[250:251], v[226:227]
v_pk_mul_f32 v[252:253], v[252:253], v[226:227]
v_pk_mul_f32 v[254:255], v[254:255], v[226:227]
v_cvt_pk_bf16_f32 v176, v248, v249
v_cvt_pk_bf16_f32 v177, v250, v251
v_cvt_pk_bf16_f32 v178, v252, v253
v_cvt_pk_bf16_f32 v179, v254, v255
v_mov_b32 v231, v230
v_accvgpr_read_b32 v240, a32
v_accvgpr_read_b32 v241, a33
v_accvgpr_read_b32 v242, a34
v_accvgpr_read_b32 v243, a35
v_accvgpr_read_b32 v244, a36
v_accvgpr_read_b32 v245, a37
v_accvgpr_read_b32 v246, a38
v_accvgpr_read_b32 v247, a39
v_pk_mul_f32 v[240:241], v[240:241], v[230:231]
v_pk_mul_f32 v[242:243], v[242:243], v[230:231]
v_pk_mul_f32 v[244:245], v[244:245], v[230:231]
v_pk_mul_f32 v[246:247], v[246:247], v[230:231]
v_cvt_pk_bf16_f32 v132, v240, v241
Lstub5:
s_cbranch_execz Lstub9
v_cvt_pk_bf16_f32 v133, v242, v243
v_cvt_pk_bf16_f32 v134, v244, v245
v_cvt_pk_bf16_f32 v135, v246, v247
v_accvgpr_read_b32 v248, a40
v_accvgpr_read_b32 v249, a41
v_accvgpr_read_b32 v250, a42
v_accvgpr_read_b32 v251, a43
v_accvgpr_read_b32 v252, a44
v_accvgpr_read_b32 v253, a45
v_accvgpr_read_b32 v254, a46
v_accvgpr_read_b32 v255, a47
v_pk_mul_f32 v[248:249], v[248:249], v[230:231]
v_pk_mul_f32 v[250:251], v[250:251], v[230:231]
v_pk_mul_f32 v[252:253], v[252:253], v[230:231]
v_pk_mul_f32 v[254:255], v[254:255], v[230:231]
v_cvt_pk_bf16_f32 v148, v248, v249
v_cvt_pk_bf16_f32 v149, v250, v251
v_cvt_pk_bf16_f32 v150, v252, v253
v_cvt_pk_bf16_f32 v151, v254, v255
v_accvgpr_read_b32 v240, a48
v_accvgpr_read_b32 v241, a49
v_accvgpr_read_b32 v242, a50
v_accvgpr_read_b32 v243, a51
v_accvgpr_read_b32 v244, a52
v_accvgpr_read_b32 v245, a53
v_accvgpr_read_b32 v246, a54
v_accvgpr_read_b32 v247, a55
v_pk_mul_f32 v[240:241], v[240:241], v[230:231]
v_pk_mul_f32 v[242:243], v[242:243], v[230:231]
v_pk_mul_f32 v[244:245], v[244:245], v[230:231]
v_pk_mul_f32 v[246:247], v[246:247], v[230:231]
v_cvt_pk_bf16_f32 v164, v240, v241
v_cvt_pk_bf16_f32 v165, v242, v243
v_cvt_pk_bf16_f32 v166, v244, v245
v_cvt_pk_bf16_f32 v167, v246, v247
v_accvgpr_read_b32 v248, a56
v_accvgpr_read_b32 v249, a57
v_accvgpr_read_b32 v250, a58
v_accvgpr_read_b32 v251, a59
v_accvgpr_read_b32 v252, a60
v_accvgpr_read_b32 v253, a61
v_accvgpr_read_b32 v254, a62
v_accvgpr_read_b32 v255, a63
v_pk_mul_f32 v[248:249], v[248:249], v[230:231]
v_pk_mul_f32 v[250:251], v[250:251], v[230:231]
v_pk_mul_f32 v[252:253], v[252:253], v[230:231]
v_pk_mul_f32 v[254:255], v[254:255], v[230:231]
v_cvt_pk_bf16_f32 v180, v248, v249
v_cvt_pk_bf16_f32 v181, v250, v251
v_cvt_pk_bf16_f32 v182, v252, v253
v_cvt_pk_bf16_f32 v183, v254, v255
v_mfma_f32_16x16x32_bf16 v[232:235], v[120:123], v[216:219], v[232:235]
s_add_u32 s82, s82, 0x8000
ds_read_b128 a[160:163], v2 offset:24576
ds_read_b128 a[164:167], v2 offset:25600
v_mfma_f32_16x16x32_bf16 v[232:235], v[120:123], v[200:203], v[232:235]
s_and_b32 s82, s82, 0x1ffff
v_exp_f32 v172, v172
v_mfma_f32_16x16x32_bf16 a[64:67], a[224:227], v[216:219], a[64:67]
s_add_u32 m0, s74, 0
v_exp_f32 v173, v173
v_mfma_f32_16x16x32_bf16 a[64:67], a[192:195], v[200:203], a[64:67]
s_add_u32 s72, s81, 0
buffer_load_dwordx4 v1, s[44:47], s72 offen sc1 lds
v_mfma_f32_16x16x32_bf16 a[68:71], a[196:199], v[200:203], a[68:71]
ds_read_b128 a[168:171], v2 offset:26624
v_cvt_pk_bf16_f32 v220, v172, v173
v_mfma_f32_16x16x32_bf16 a[68:71], a[228:231], v[216:219], a[68:71]
v_exp_f32 v174, v174
v_mfma_f32_16x16x32_bf16 a[72:75], a[232:235], v[216:219], a[72:75]
s_nop 0
ds_read_b128 a[172:175], v2 offset:27648
ds_read_b128 a[176:179], v2 offset:28672
v_mfma_f32_16x16x32_bf16 a[72:75], a[200:203], v[200:203], a[72:75]
v_exp_f32 v175, v175
v_mfma_f32_16x16x32_bf16 a[76:79], a[204:207], v[200:203], a[76:79]
v_exp_f32 v188, v188
v_mfma_f32_16x16x32_bf16 a[76:79], a[236:239], v[216:219], a[76:79]
buffer_store_dwordx4 v[128:131], v3, s[44:47], s70 offen sc1
v_mfma_f32_16x16x32_bf16 a[80:83], a[240:243], v[216:219], a[80:83]
s_waitcnt lgkmcnt(5)
ds_read_b128 a[180:183], v2 offset:29696
v_cvt_pk_bf16_f32 v221, v174, v175
v_mfma_f32_16x16x32_bf16 a[80:83], a[208:211], v[200:203], a[80:83]
v_exp_f32 v189, v189
v_mfma_f32_16x16x32_bf16 a[84:87], a[212:215], v[200:203], a[84:87]
ds_read_b128 a[184:187], v2 offset:30720
v_cvt_pk_bf16_f32 v222, v188, v189
v_mfma_f32_16x16x32_bf16 a[84:87], a[244:247], v[216:219], a[84:87]
v_exp_f32 v190, v190
v_mfma_f32_16x16x32_bf16 a[88:91], a[248:251], v[216:219], a[88:91]
buffer_load_dwordx4 v1, s[44:47], s72 offen offset:1024 sc1 lds
v_mfma_f32_16x16x32_bf16 a[88:91], a[216:219], v[200:203], a[88:91]
s_nop 0
ds_read_b128 a[188:191], v2 offset:31744
ds_read_b128 a[224:227], v2 offset:8192
v_mfma_f32_16x16x32_bf16 a[92:95], a[220:223], v[200:203], a[92:95]
v_exp_f32 v191, v191
v_mfma_f32_16x16x32_bf16 a[92:95], a[252:255], v[216:219], a[92:95]
v_exp_f32 v168, v168
v_mfma_f32_16x16x32_bf16 v[136:139], a[128:131], v[48:51], v[88:91]
ds_read_b128 a[228:231], v2 offset:9216
v_cvt_pk_bf16_f32 v223, v190, v191
v_mfma_f32_16x16x32_bf16 v[136:139], a[132:135], v[52:55], v[136:139]
v_exp_f32 v169, v169
v_mfma_f32_16x16x32_bf16 v[136:139], a[136:139], v[56:59], v[136:139]
buffer_store_dwordx4 v[144:147], v3, s[44:47], s70 offen offset:1024 sc1
v_mfma_f32_16x16x32_bf16 v[136:139], a[140:143], v[60:63], v[136:139]
ds_read_b128 a[232:235], v2 offset:10240
v_cvt_pk_bf16_f32 v216, v168, v169
v_mfma_f32_16x16x32_bf16 v[152:155], a[156:159], v[60:63], v[88:91]
v_exp_f32 v170, v170
v_mfma_f32_16x16x32_bf16 v[152:155], a[152:155], v[56:59], v[152:155]
s_nop 0
ds_read_b128 a[236:239], v2 offset:11264
ds_read_b128 a[240:243], v2 offset:12288
v_mfma_f32_16x16x32_bf16 v[152:155], a[148:151], v[52:55], v[152:155]
v_exp_f32 v171, v171
v_mfma_f32_16x16x32_bf16 v[152:155], a[144:147], v[48:51], v[152:155]
buffer_load_dwordx4 v1, s[44:47], s72 offen offset:2048 sc1 lds
v_mfma_f32_16x16x32_bf16 v[140:143], a[128:131], v[64:67], v[92:95]
v_exp_f32 v184, v184
v_mfma_f32_16x16x32_bf16 v[140:143], a[132:135], v[68:71], v[140:143]
ds_read_b128 a[244:247], v2 offset:13312
v_cvt_pk_bf16_f32 v217, v170, v171
v_mfma_f32_16x16x32_bf16 v[140:143], a[136:139], v[72:75], v[140:143]
v_exp_f32 v185, v185
v_mfma_f32_16x16x32_bf16 v[140:143], a[140:143], v[76:79], v[140:143]
s_nop 0
ds_read_b128 a[248:251], v2 offset:14336
ds_read_b128 a[252:255], v2 offset:15360
v_mfma_f32_16x16x32_bf16 v[156:159], a[156:159], v[76:79], v[92:95]
v_exp_f32 v186, v186
v_mfma_f32_16x16x32_bf16 v[156:159], a[152:155], v[72:75], v[156:159]
buffer_load_dwordx4 v1, s[44:47], s72 offen offset:3072 sc1 lds
v_mfma_f32_16x16x32_bf16 v[156:159], a[148:151], v[68:71], v[156:159]
s_waitcnt vmcnt(14) lgkmcnt(4)
v_exp_f32 v187, v187
v_mfma_f32_16x16x32_bf16 v[156:159], a[144:147], v[64:67], v[156:159]
s_barrier
v_cvt_pk_bf16_f32 v218, v184, v185
v_cvt_pk_bf16_f32 v219, v186, v187
v_add_u32 v2, s82, v1
v_mfma_f32_16x16x32_bf16 v[236:239], v[120:123], v[204:207], v[236:239]
s_xor_b32 s74, s82, 0x10000
v_exp_f32 v136, v136
v_mfma_f32_16x16x32_bf16 v[236:239], v[120:123], v[220:223], v[236:239]
s_add_u32 s74, s74, s64
ds_read_b128 a[128:131], v2 offset:16384
ds_read_b128 a[132:135], v2 offset:17408
v_mfma_f32_16x16x32_bf16 a[96:99], a[192:195], v[204:207], a[96:99]
s_add_u32 s81, s81, 0x8000
v_exp_f32 v137, v137
v_mfma_f32_16x16x32_bf16 a[96:99], a[224:227], v[220:223], a[96:99]
s_add_u32 m0, s74, 16384
v_exp_f32 v138, v138
v_mfma_f32_16x16x32_bf16 a[100:103], a[228:231], v[220:223], a[100:103]
s_add_u32 s72, s81, 16384
buffer_load_dwordx4 v1, s[44:47], s72 offen sc1 lds
v_mfma_f32_16x16x32_bf16 a[100:103], a[196:199], v[204:207], a[100:103]
ds_read_b128 a[136:139], v2 offset:18432
v_cvt_pk_bf16_f32 v200, v136, v137
v_mfma_f32_16x16x32_bf16 a[104:107], a[200:203], v[204:207], a[104:107]
v_exp_f32 v139, v139
v_mfma_f32_16x16x32_bf16 a[104:107], a[232:235], v[220:223], a[104:107]
ds_read_b128 a[140:143], v2 offset:19456
v_cvt_pk_bf16_f32 v201, v138, v139
v_mfma_f32_16x16x32_bf16 a[108:111], a[236:239], v[220:223], a[108:111]
buffer_store_dwordx4 v[160:163], v3, s[44:47], s70 offen offset:2048 sc1
v_mfma_f32_16x16x32_bf16 a[108:111], a[204:207], v[204:207], a[108:111]
v_exp_f32 v152, v152
v_mfma_f32_16x16x32_bf16 a[112:115], a[208:211], v[204:207], a[112:115]
s_waitcnt lgkmcnt(4)
ds_read_b128 a[144:147], v2 offset:20480
ds_read_b128 a[148:151], v2 offset:21504
v_mfma_f32_16x16x32_bf16 a[112:115], a[240:243], v[220:223], a[112:115]
v_exp_f32 v153, v153
v_mfma_f32_16x16x32_bf16 a[116:119], a[244:247], v[220:223], a[116:119]
buffer_load_dwordx4 v1, s[44:47], s72 offen offset:1024 sc1 lds
v_mfma_f32_16x16x32_bf16 a[116:119], a[212:215], v[204:207], a[116:119]
v_exp_f32 v154, v154
v_mfma_f32_16x16x32_bf16 a[120:123], a[216:219], v[204:207], a[120:123]
ds_read_b128 a[152:155], v2 offset:22528
v_cvt_pk_bf16_f32 v202, v152, v153
v_mfma_f32_16x16x32_bf16 a[120:123], a[248:251], v[220:223], a[120:123]
v_exp_f32 v155, v155
v_mfma_f32_16x16x32_bf16 a[124:127], a[252:255], v[220:223], a[124:127]
ds_read_b128 a[156:159], v2 offset:23552
v_cvt_pk_bf16_f32 v203, v154, v155
v_mfma_f32_16x16x32_bf16 a[124:127], a[220:223], v[204:207], a[124:127]
v_exp_f32 v140, v140
v_mfma_f32_16x16x32_bf16 v[172:175], a[160:163], v[64:67], v[92:95]
s_nop 0
ds_read_b128 a[192:195], v2 offset:0
ds_read_b128 a[196:199], v2 offset:1024
v_mfma_f32_16x16x32_bf16 v[172:175], a[164:167], v[68:71], v[172:175]
buffer_store_dwordx4 v[176:179], v3, s[44:47], s70 offen offset:3072 sc1
v_mfma_f32_16x16x32_bf16 v[172:175], a[168:171], v[72:75], v[172:175]
v_exp_f32 v141, v141
v_mfma_f32_16x16x32_bf16 v[172:175], a[172:175], v[76:79], v[172:175]
v_exp_f32 v142, v142
v_mfma_f32_16x16x32_bf16 v[188:191], a[188:191], v[76:79], v[92:95]
s_nop 0
ds_read_b128 a[200:203], v2 offset:2048
ds_read_b128 a[204:207], v2 offset:3072
v_mfma_f32_16x16x32_bf16 v[188:191], a[184:187], v[72:75], v[188:191]
buffer_load_dwordx4 v1, s[44:47], s72 offen offset:2048 sc1 lds
v_mfma_f32_16x16x32_bf16 v[188:191], a[180:183], v[68:71], v[188:191]
s_add_u32 s70, s70, 0x80000
v_exp_f32 v143, v143
v_mfma_f32_16x16x32_bf16 v[188:191], a[176:179], v[64:67], v[188:191]
v_exp_f32 v156, v156
v_mfma_f32_16x16x32_bf16 v[168:171], a[160:163], v[48:51], v[88:91]
s_nop 0
ds_read_b128 a[208:211], v2 offset:4096
ds_read_b128 a[212:215], v2 offset:5120
v_mfma_f32_16x16x32_bf16 v[168:171], a[164:167], v[52:55], v[168:171]
s_nop 0
ds_read_b128 a[216:219], v2 offset:6144
ds_read_b128 a[220:223], v2 offset:7168
v_mfma_f32_16x16x32_bf16 v[168:171], a[168:171], v[56:59], v[168:171]
v_cvt_pk_bf16_f32 v204, v140, v141
v_cvt_pk_bf16_f32 v205, v142, v143
v_mfma_f32_16x16x32_bf16 v[168:171], a[172:175], v[60:63], v[168:171]
buffer_store_dwordx4 v[132:135], v3, s[44:47], s70 offen sc1
v_mfma_f32_16x16x32_bf16 v[184:187], a[188:191], v[60:63], v[88:91]
v_exp_f32 v157, v157
v_mfma_f32_16x16x32_bf16 v[184:187], a[184:187], v[56:59], v[184:187]
v_exp_f32 v158, v158
v_mfma_f32_16x16x32_bf16 v[184:187], a[180:183], v[52:55], v[184:187]
buffer_load_dwordx4 v1, s[44:47], s72 offen offset:3072 sc1 lds
v_mfma_f32_16x16x32_bf16 v[184:187], a[176:179], v[48:51], v[184:187]
s_waitcnt lgkmcnt(4)
v_exp_f32 v159, v159
v_cvt_pk_bf16_f32 v206, v156, v157
v_cvt_pk_bf16_f32 v207, v158, v159
v_mfma_f32_16x16x32_bf16 v[232:235], v[120:123], v[216:219], v[232:235]
s_add_u32 s82, s82, 0x8000
ds_read_b128 a[160:163], v2 offset:24576
ds_read_b128 a[164:167], v2 offset:25600
v_mfma_f32_16x16x32_bf16 v[232:235], v[120:123], v[200:203], v[232:235]
s_and_b32 s82, s82, 0x1ffff
v_exp_f32 v172, v172
v_mfma_f32_16x16x32_bf16 a[64:67], a[224:227], v[216:219], a[64:67]
s_add_u32 m0, s74, 0
v_exp_f32 v173, v173
v_mfma_f32_16x16x32_bf16 a[64:67], a[192:195], v[200:203], a[64:67]
s_add_u32 s72, s81, 0
buffer_load_dwordx4 v1, s[44:47], s72 offen sc1 lds
v_mfma_f32_16x16x32_bf16 a[68:71], a[196:199], v[200:203], a[68:71]
ds_read_b128 a[168:171], v2 offset:26624
v_cvt_pk_bf16_f32 v220, v172, v173
v_mfma_f32_16x16x32_bf16 a[68:71], a[228:231], v[216:219], a[68:71]
v_exp_f32 v174, v174
v_mfma_f32_16x16x32_bf16 a[72:75], a[232:235], v[216:219], a[72:75]
s_nop 0
ds_read_b128 a[172:175], v2 offset:27648
ds_read_b128 a[176:179], v2 offset:28672
v_mfma_f32_16x16x32_bf16 a[72:75], a[200:203], v[200:203], a[72:75]
v_exp_f32 v175, v175
v_mfma_f32_16x16x32_bf16 a[76:79], a[204:207], v[200:203], a[76:79]
buffer_store_dwordx4 v[148:151], v3, s[44:47], s70 offen offset:1024 sc1
v_mfma_f32_16x16x32_bf16 a[76:79], a[236:239], v[216:219], a[76:79]
v_exp_f32 v188, v188
v_mfma_f32_16x16x32_bf16 a[80:83], a[240:243], v[216:219], a[80:83]
s_waitcnt lgkmcnt(5)
ds_read_b128 a[180:183], v2 offset:29696
v_cvt_pk_bf16_f32 v221, v174, v175
v_mfma_f32_16x16x32_bf16 a[80:83], a[208:211], v[200:203], a[80:83]
v_exp_f32 v189, v189
v_mfma_f32_16x16x32_bf16 a[84:87], a[212:215], v[200:203], a[84:87]
buffer_load_dwordx4 v1, s[44:47], s72 offen offset:1024 sc1 lds
v_mfma_f32_16x16x32_bf16 a[84:87], a[244:247], v[216:219], a[84:87]
ds_read_b128 a[184:187], v2 offset:30720
v_cvt_pk_bf16_f32 v222, v188, v189
v_mfma_f32_16x16x32_bf16 a[88:91], a[248:251], v[216:219], a[88:91]
v_exp_f32 v190, v190
v_mfma_f32_16x16x32_bf16 a[88:91], a[216:219], v[200:203], a[88:91]
s_nop 0
ds_read_b128 a[188:191], v2 offset:31744
ds_read_b128 a[224:227], v2 offset:8192
v_mfma_f32_16x16x32_bf16 a[92:95], a[220:223], v[200:203], a[92:95]
v_exp_f32 v191, v191
v_mfma_f32_16x16x32_bf16 a[92:95], a[252:255], v[216:219], a[92:95]
buffer_store_dwordx4 v[164:167], v3, s[44:47], s70 offen offset:2048 sc1
v_mfma_f32_16x16x32_bf16 v[136:139], a[128:131], v[48:51], v[88:91]
v_exp_f32 v168, v168
v_mfma_f32_16x16x32_bf16 v[136:139], a[132:135], v[52:55], v[136:139]
ds_read_b128 a[228:231], v2 offset:9216
v_cvt_pk_bf16_f32 v223, v190, v191
v_mfma_f32_16x16x32_bf16 v[136:139], a[136:139], v[56:59], v[136:139]
v_exp_f32 v169, v169
v_mfma_f32_16x16x32_bf16 v[136:139], a[140:143], v[60:63], v[136:139]
s_nop 0
ds_read_b128 a[232:235], v2 offset:10240
ds_read_b128 a[236:239], v2 offset:11264
v_mfma_f32_16x16x32_bf16 v[152:155], a[156:159], v[60:63], v[88:91]
v_exp_f32 v170, v170
v_mfma_f32_16x16x32_bf16 v[152:155], a[152:155], v[56:59], v[152:155]
buffer_load_dwordx4 v1, s[44:47], s72 offen offset:2048 sc1 lds
v_mfma_f32_16x16x32_bf16 v[152:155], a[148:151], v[52:55], v[152:155]
v_exp_f32 v171, v171
v_mfma_f32_16x16x32_bf16 v[152:155], a[144:147], v[48:51], v[152:155]
s_nop 0
ds_read_b128 a[240:243], v2 offset:12288
ds_read_b128 a[244:247], v2 offset:13312
v_mfma_f32_16x16x32_bf16 v[140:143], a[128:131], v[64:67], v[92:95]
v_exp_f32 v184, v184
v_mfma_f32_16x16x32_bf16 v[140:143], a[132:135], v[68:71], v[140:143]
s_nop 0
ds_read_b128 a[248:251], v2 offset:14336
ds_read_b128 a[252:255], v2 offset:15360
v_mfma_f32_16x16x32_bf16 v[140:143], a[136:139], v[72:75], v[140:143]
v_cvt_pk_bf16_f32 v216, v168, v169
v_cvt_pk_bf16_f32 v217, v170, v171
v_mfma_f32_16x16x32_bf16 v[140:143], a[140:143], v[76:79], v[140:143]
buffer_store_dwordx4 v[180:183], v3, s[44:47], s70 offen offset:3072 sc1
v_mfma_f32_16x16x32_bf16 v[156:159], a[156:159], v[76:79], v[92:95]
v_exp_f32 v185, v185
v_mfma_f32_16x16x32_bf16 v[156:159], a[152:155], v[72:75], v[156:159]
buffer_load_dwordx4 v1, s[44:47], s72 offen offset:3072 sc1 lds
v_mfma_f32_16x16x32_bf16 v[156:159], a[148:151], v[68:71], v[156:159]
s_waitcnt vmcnt(14) lgkmcnt(4)
v_exp_f32 v186, v186
v_mfma_f32_16x16x32_bf16 v[156:159], a[144:147], v[64:67], v[156:159]
s_barrier
v_exp_f32 v187, v187
v_add_u32 v2, s82, v1
v_cvt_pk_bf16_f32 v218, v184, v185
v_cvt_pk_bf16_f32 v219, v186, v187
s_lshl_b32 s83, s60, 2
s_sub_u32 s83, s83, 25
.p2align 5
s_nop 0
s_nop 0
LloopII:
v_mfma_f32_16x16x32_bf16 v[236:239], v[120:123], v[204:207], v[236:239]
s_xor_b32 s74, s82, 0x10000
v_exp_f32 v136, v136
v_mfma_f32_16x16x32_bf16 v[236:239], v[120:123], v[220:223], v[236:239]
s_add_u32 s74, s74, s64
ds_read_b128 a[128:131], v2 offset:16384
ds_read_b128 a[132:135], v2 offset:17408
v_mfma_f32_16x16x32_bf16 a[96:99], a[192:195], v[204:207], a[96:99]
s_add_u32 s81, s81, 0x8000
v_exp_f32 v137, v137
v_mfma_f32_16x16x32_bf16 a[96:99], a[224:227], v[220:223], a[96:99]
s_add_u32 m0, s74, 16384
v_exp_f32 v138, v138
v_mfma_f32_16x16x32_bf16 a[100:103], a[228:231], v[220:223], a[100:103]
s_add_u32 s72, s81, 16384
ds_read_b128 a[136:139], v2 offset:18432
v_cvt_pk_bf16_f32 v200, v136, v137
v_mfma_f32_16x16x32_bf16 a[100:103], a[196:199], v[204:207], a[100:103]
buffer_load_dwordx4 v1, s[44:47], s72 offen sc1 lds
v_mfma_f32_16x16x32_bf16 a[104:107], a[200:203], v[204:207], a[104:107]
v_exp_f32 v139, v139
v_mfma_f32_16x16x32_bf16 a[104:107], a[232:235], v[220:223], a[104:107]
ds_read_b128 a[140:143], v2 offset:19456
v_cvt_pk_bf16_f32 v201, v138, v139
v_mfma_f32_16x16x32_bf16 a[108:111], a[236:239], v[220:223], a[108:111]
v_exp_f32 v152, v152
v_mfma_f32_16x16x32_bf16 a[108:111], a[204:207], v[204:207], a[108:111]
s_nop 0
ds_read_b128 a[144:147], v2 offset:20480
ds_read_b128 a[148:151], v2 offset:21504
v_mfma_f32_16x16x32_bf16 a[112:115], a[208:211], v[204:207], a[112:115]
s_waitcnt lgkmcnt(6)
v_exp_f32 v153, v153
v_mfma_f32_16x16x32_bf16 a[112:115], a[240:243], v[220:223], a[112:115]
v_exp_f32 v154, v154
v_mfma_f32_16x16x32_bf16 a[116:119], a[244:247], v[220:223], a[116:119]
ds_read_b128 a[152:155], v2 offset:22528
v_cvt_pk_bf16_f32 v202, v152, v153
v_mfma_f32_16x16x32_bf16 a[116:119], a[212:215], v[204:207], a[116:119]
buffer_load_dwordx4 v1, s[44:47], s72 offen offset:1024 sc1 lds
v_mfma_f32_16x16x32_bf16 a[120:123], a[216:219], v[204:207], a[120:123]
v_exp_f32 v155, v155
v_mfma_f32_16x16x32_bf16 a[120:123], a[248:251], v[220:223], a[120:123]
ds_read_b128 a[156:159], v2 offset:23552
v_cvt_pk_bf16_f32 v203, v154, v155
v_mfma_f32_16x16x32_bf16 a[124:127], a[252:255], v[220:223], a[124:127]
v_exp_f32 v140, v140
v_mfma_f32_16x16x32_bf16 a[124:127], a[220:223], v[204:207], a[124:127]
s_nop 0
ds_read_b128 a[192:195], v2 offset:0
ds_read_b128 a[196:199], v2 offset:1024
v_mfma_f32_16x16x32_bf16 v[172:175], a[160:163], v[64:67], v[92:95]
v_exp_f32 v141, v141
v_mfma_f32_16x16x32_bf16 v[172:175], a[164:167], v[68:71], v[172:175]
v_exp_f32 v142, v142
v_mfma_f32_16x16x32_bf16 v[172:175], a[168:171], v[72:75], v[172:175]
ds_read_b128 a[200:203], v2 offset:2048
v_cvt_pk_bf16_f32 v204, v140, v141
v_mfma_f32_16x16x32_bf16 v[172:175], a[172:175], v[76:79], v[172:175]
buffer_load_dwordx4 v1, s[44:47], s72 offen offset:2048 sc1 lds
v_mfma_f32_16x16x32_bf16 v[188:191], a[188:191], v[76:79], v[92:95]
v_exp_f32 v143, v143
v_mfma_f32_16x16x32_bf16 v[188:191], a[184:187], v[72:75], v[188:191]
ds_read_b128 a[204:207], v2 offset:3072
v_cvt_pk_bf16_f32 v205, v142, v143
v_mfma_f32_16x16x32_bf16 v[188:191], a[180:183], v[68:71], v[188:191]
v_exp_f32 v156, v156
v_mfma_f32_16x16x32_bf16 v[188:191], a[176:179], v[64:67], v[188:191]
ds_read_b128 a[208:211], v2 offset:4096
v_mfma_f32_16x16x32_bf16 v[168:171], a[160:163], v[48:51], v[88:91]
v_exp_f32 v157, v157
v_mfma_f32_16x16x32_bf16 v[168:171], a[164:167], v[52:55], v[168:171]
ds_read_b128 a[212:215], v2 offset:5120
v_cvt_pk_bf16_f32 v206, v156, v157
v_mfma_f32_16x16x32_bf16 v[168:171], a[168:171], v[56:59], v[168:171]
v_exp_f32 v158, v158
v_mfma_f32_16x16x32_bf16 v[168:171], a[172:175], v[60:63], v[168:171]
ds_read_b128 a[216:219], v2 offset:6144
v_mfma_f32_16x16x32_bf16 v[184:187], a[188:191], v[60:63], v[88:91]
buffer_load_dwordx4 v1, s[44:47], s72 offen offset:3072 sc1 lds
v_mfma_f32_16x16x32_bf16 v[184:187], a[184:187], v[56:59], v[184:187]
v_exp_f32 v159, v159
v_mfma_f32_16x16x32_bf16 v[184:187], a[180:183], v[52:55], v[184:187]
ds_read_b128 a[220:223], v2 offset:7168
v_cvt_pk_bf16_f32 v207, v158, v159
v_mfma_f32_16x16x32_bf16 v[184:187], a[176:179], v[48:51], v[184:187]
s_waitcnt lgkmcnt(4)
v_mfma_f32_16x16x32_bf16 v[232:235], v[120:123], v[216:219], v[232:235]
s_add_u32 s82, s82, 0x8000
ds_read_b128 a[160:163], v2 offset:24576
ds_read_b128 a[164:167], v2 offset:25600
v_mfma_f32_16x16x32_bf16 v[232:235], v[120:123], v[200:203], v[232:235]
s_and_b32 s82, s82, 0x1ffff
v_exp_f32 v172, v172
v_mfma_f32_16x16x32_bf16 a[64:67], a[224:227], v[216:219], a[64:67]
s_add_u32 m0, s74, 0
v_exp_f32 v173, v173
v_mfma_f32_16x16x32_bf16 a[64:67], a[192:195], v[200:203], a[64:67]
s_add_u32 s72, s81, 0
ds_read_b128 a[168:171], v2 offset:26624
v_cvt_pk_bf16_f32 v220, v172, v173
v_mfma_f32_16x16x32_bf16 a[68:71], a[196:199], v[200:203], a[68:71]
v_exp_f32 v174, v174
v_mfma_f32_16x16x32_bf16 a[68:71], a[228:231], v[216:219], a[68:71]
buffer_load_dwordx4 v1, s[44:47], s72 offen sc1 lds
v_mfma_f32_16x16x32_bf16 a[72:75], a[232:235], v[216:219], a[72:75]
s_nop 0
ds_read_b128 a[172:175], v2 offset:27648
ds_read_b128 a[176:179], v2 offset:28672
v_mfma_f32_16x16x32_bf16 a[72:75], a[200:203], v[200:203], a[72:75]
v_exp_f32 v175, v175
v_mfma_f32_16x16x32_bf16 a[76:79], a[204:207], v[200:203], a[76:79]
v_exp_f32 v188, v188
v_mfma_f32_16x16x32_bf16 a[76:79], a[236:239], v[216:219], a[76:79]
ds_read_b128 a[180:183], v2 offset:29696
v_cvt_pk_bf16_f32 v221, v174, v175
v_mfma_f32_16x16x32_bf16 a[80:83], a[240:243], v[216:219], a[80:83]
s_waitcnt lgkmcnt(6)
v_exp_f32 v189, v189
v_mfma_f32_16x16x32_bf16 a[80:83], a[208:211], v[200:203], a[80:83]
ds_read_b128 a[184:187], v2 offset:30720
v_cvt_pk_bf16_f32 v222, v188, v189
v_mfma_f32_16x16x32_bf16 a[84:87], a[212:215], v[200:203], a[84:87]
buffer_load_dwordx4 v1, s[44:47], s72 offen offset:1024 sc1 lds
v_mfma_f32_16x16x32_bf16 a[84:87], a[244:247], v[216:219], a[84:87]
v_exp_f32 v190, v190
v_mfma_f32_16x16x32_bf16 a[88:91], a[248:251], v[216:219], a[88:91]
s_nop 0
ds_read_b128 a[188:191], v2 offset:31744
ds_read_b128 a[224:227], v2 offset:8192
v_mfma_f32_16x16x32_bf16 a[88:91], a[216:219], v[200:203], a[88:91]
v_exp_f32 v191, v191
v_mfma_f32_16x16x32_bf16 a[92:95], a[220:223], v[200:203], a[92:95]
v_exp_f32 v168, v168
v_mfma_f32_16x16x32_bf16 a[92:95], a[252:255], v[216:219], a[92:95]
ds_read_b128 a[228:231], v2 offset:9216
v_cvt_pk_bf16_f32 v223, v190, v191
v_mfma_f32_16x16x32_bf16 v[136:139], a[128:131], v[48:51], v[88:91]
v_exp_f32 v169, v169
v_mfma_f32_16x16x32_bf16 v[136:139], a[132:135], v[52:55], v[136:139]
ds_read_b128 a[232:235], v2 offset:10240
v_cvt_pk_bf16_f32 v216, v168, v169
v_mfma_f32_16x16x32_bf16 v[136:139], a[136:139], v[56:59], v[136:139]
buffer_load_dwordx4 v1, s[44:47], s72 offen offset:2048 sc1 lds
v_mfma_f32_16x16x32_bf16 v[136:139], a[140:143], v[60:63], v[136:139]
v_exp_f32 v170, v170
v_mfma_f32_16x16x32_bf16 v[152:155], a[156:159], v[60:63], v[88:91]
s_nop 0
ds_read_b128 a[236:239], v2 offset:11264
ds_read_b128 a[240:243], v2 offset:12288
v_mfma_f32_16x16x32_bf16 v[152:155], a[152:155], v[56:59], v[152:155]
v_exp_f32 v171, v171
v_mfma_f32_16x16x32_bf16 v[152:155], a[148:151], v[52:55], v[152:155]
v_exp_f32 v184, v184
v_mfma_f32_16x16x32_bf16 v[152:155], a[144:147], v[48:51], v[152:155]
ds_read_b128 a[244:247], v2 offset:13312
v_cvt_pk_bf16_f32 v217, v170, v171
v_mfma_f32_16x16x32_bf16 v[140:143], a[128:131], v[64:67], v[92:95]
v_exp_f32 v185, v185
v_mfma_f32_16x16x32_bf16 v[140:143], a[132:135], v[68:71], v[140:143]
ds_read_b128 a[248:251], v2 offset:14336
v_cvt_pk_bf16_f32 v218, v184, v185
v_mfma_f32_16x16x32_bf16 v[140:143], a[136:139], v[72:75], v[140:143]
buffer_load_dwordx4 v1, s[44:47], s72 offen offset:3072 sc1 lds
v_mfma_f32_16x16x32_bf16 v[140:143], a[140:143], v[76:79], v[140:143]
ds_read_b128 a[252:255], v2 offset:15360
v_add_u32 v2, s82, v1
v_mfma_f32_16x16x32_bf16 v[156:159], a[156:159], v[76:79], v[92:95]
s_waitcnt vmcnt(8) lgkmcnt(4)
v_exp_f32 v186, v186
v_mfma_f32_16x16x32_bf16 v[156:159], a[152:155], v[72:75], v[156:159]
s_barrier
v_exp_f32 v187, v187
v_mfma_f32_16x16x32_bf16 v[156:159], a[148:151], v[68:71], v[156:159]
s_add_u32 s83, s83, 1
v_cvt_pk_bf16_f32 v219, v186, v187
v_mfma_f32_16x16x32_bf16 v[156:159], a[144:147], v[64:67], v[156:159]
s_cbranch_scc0 LloopII
v_mfma_f32_16x16x32_bf16 v[236:239], v[120:123], v[204:207], v[236:239]
s_xor_b32 s74, s82, 0x10000
ds_read_b128 a[128:131], v2 offset:16384
ds_read_b128 a[132:135], v2 offset:17408
v_mfma_f32_16x16x32_bf16 v[236:239], v[120:123], v[220:223], v[236:239]
s_add_u32 s74, s74, s64
v_exp_f32 v136, v136
v_mfma_f32_16x16x32_bf16 a[96:99], a[192:195], v[204:207], a[96:99]
s_add_u32 s81, s81, 0x8000
v_exp_f32 v137, v137
v_mfma_f32_16x16x32_bf16 a[96:99], a[224:227], v[220:223], a[96:99]
s_add_u32 m0, s74, 0
ds_read_b128 a[136:139], v2 offset:18432
v_cvt_pk_bf16_f32 v200, v136, v137
v_mfma_f32_16x16x32_bf16 a[100:103], a[228:231], v[220:223], a[100:103]
s_add_u32 s72, s81, 0
v_exp_f32 v138, v138
v_mfma_f32_16x16x32_bf16 a[100:103], a[196:199], v[204:207], a[100:103]
buffer_load_dwordx4 v1, s[44:47], s72 offen sc1 lds
v_mfma_f32_16x16x32_bf16 a[104:107], a[200:203], v[204:207], a[104:107]
s_nop 0
ds_read_b128 a[140:143], v2 offset:19456
ds_read_b128 a[144:147], v2 offset:20480
v_mfma_f32_16x16x32_bf16 a[104:107], a[232:235], v[220:223], a[104:107]
v_exp_f32 v139, v139
v_mfma_f32_16x16x32_bf16 a[108:111], a[236:239], v[220:223], a[108:111]
v_exp_f32 v152, v152
v_mfma_f32_16x16x32_bf16 a[108:111], a[204:207], v[204:207], a[108:111]
ds_read_b128 a[148:151], v2 offset:21504
v_cvt_pk_bf16_f32 v201, v138, v139
v_mfma_f32_16x16x32_bf16 a[112:115], a[208:211], v[204:207], a[112:115]
s_waitcnt lgkmcnt(6)
v_exp_f32 v153, v153
v_mfma_f32_16x16x32_bf16 a[112:115], a[240:243], v[220:223], a[112:115]
ds_read_b128 a[152:155], v2 offset:22528
v_cvt_pk_bf16_f32 v202, v152, v153
v_mfma_f32_16x16x32_bf16 a[116:119], a[244:247], v[220:223], a[116:119]
v_exp_f32 v154, v154
v_mfma_f32_16x16x32_bf16 a[116:119], a[212:215], v[204:207], a[116:119]
buffer_load_dwordx4 v1, s[44:47], s72 offen offset:1024 sc1 lds
v_mfma_f32_16x16x32_bf16 a[120:123], a[216:219], v[204:207], a[120:123]
s_nop 0
ds_read_b128 a[156:159], v2 offset:23552
ds_read_b128 a[192:195], v2 offset:0
v_mfma_f32_16x16x32_bf16 a[120:123], a[248:251], v[220:223], a[120:123]
v_exp_f32 v155, v155
v_mfma_f32_16x16x32_bf16 a[124:127], a[252:255], v[220:223], a[124:127]
v_exp_f32 v140, v140
v_mfma_f32_16x16x32_bf16 a[124:127], a[220:223], v[204:207], a[124:127]
ds_read_b128 a[196:199], v2 offset:1024
v_cvt_pk_bf16_f32 v203, v154, v155
v_mfma_f32_16x16x32_bf16 v[172:175], a[160:163], v[64:67], v[92:95]
v_exp_f32 v141, v141
v_mfma_f32_16x16x32_bf16 v[172:175], a[164:167], v[68:71], v[172:175]
ds_read_b128 a[200:203], v2 offset:2048
v_cvt_pk_bf16_f32 v204, v140, v141
v_mfma_f32_16x16x32_bf16 v[172:175], a[168:171], v[72:75], v[172:175]
v_exp_f32 v142, v142
v_mfma_f32_16x16x32_bf16 v[172:175], a[172:175], v[76:79], v[172:175]
buffer_load_dwordx4 v1, s[44:47], s72 offen offset:2048 sc1 lds
v_mfma_f32_16x16x32_bf16 v[188:191], a[188:191], v[76:79], v[92:95]
ds_read_b128 a[204:207], v2 offset:3072
v_mfma_f32_16x16x32_bf16 v[188:191], a[184:187], v[72:75], v[188:191]
v_exp_f32 v143, v143
v_mfma_f32_16x16x32_bf16 v[188:191], a[180:183], v[68:71], v[188:191]
ds_read_b128 a[208:211], v2 offset:4096
v_cvt_pk_bf16_f32 v205, v142, v143
v_mfma_f32_16x16x32_bf16 v[188:191], a[176:179], v[64:67], v[188:191]
Lstub6:
s_cbranch_execz Lstub10
v_exp_f32 v156, v156
v_mfma_f32_16x16x32_bf16 v[168:171], a[160:163], v[48:51], v[88:91]
ds_read_b128 a[212:215], v2 offset:5120
v_mfma_f32_16x16x32_bf16 v[168:171], a[164:167], v[52:55], v[168:171]
v_exp_f32 v157, v157
v_mfma_f32_16x16x32_bf16 v[168:171], a[168:171], v[56:59], v[168:171]
ds_read_b128 a[216:219], v2 offset:6144
v_cvt_pk_bf16_f32 v206, v156, v157
v_mfma_f32_16x16x32_bf16 v[168:171], a[172:175], v[60:63], v[168:171]
buffer_load_dwordx4 v1, s[44:47], s72 offen offset:3072 sc1 lds
v_mfma_f32_16x16x32_bf16 v[184:187], a[188:191], v[60:63], v[88:91]
v_exp_f32 v158, v158
v_mfma_f32_16x16x32_bf16 v[184:187], a[184:187], v[56:59], v[184:187]
ds_read_b128 a[220:223], v2 offset:7168
v_mfma_f32_16x16x32_bf16 v[184:187], a[180:183], v[52:55], v[184:187]
s_waitcnt lgkmcnt(4)
v_exp_f32 v159, v159
v_mfma_f32_16x16x32_bf16 v[184:187], a[176:179], v[48:51], v[184:187]
s_barrier
v_cvt_pk_bf16_f32 v207, v158, v159
s_lshr_b32 s69, s93, 4
s_and_b32 s69, s69, 0x7f00
s_add_u32 s69, s69, LHT4-Lpc0
v_lshrrev_b32 v3, 5, v0
v_lshlrev_b32 v3, 7, v3
v_add_u32 v3, s69, v3
v_min_u32 v3, Lcode_end-Lpc0, v3
global_load_dword v4, v3, s[98:99]
v_mfma_f32_16x16x32_bf16 v[232:235], v[120:123], v[216:219], v[232:235]
s_add_u32 s82, s82, 0x8000
ds_read_b128 a[160:163], v2 offset:24576
ds_read_b128 a[164:167], v2 offset:25600
v_mfma_f32_16x16x32_bf16 v[232:235], v[120:123], v[200:203], v[232:235]
s_and_b32 s82, s82, 0x1ffff
v_exp_f32 v172, v172
v_mfma_f32_16x16x32_bf16 a[64:67], a[224:227], v[216:219], a[64:67]
s_add_u32 s66, s58, 3
v_exp_f32 v173, v173
v_mfma_f32_16x16x32_bf16 a[64:67], a[192:195], v[200:203], a[64:67]
s_and_b32 s66, s66, 3
ds_read_b128 a[168:171], v2 offset:26624
v_cvt_pk_bf16_f32 v220, v172, v173
v_mfma_f32_16x16x32_bf16 a[68:71], a[196:199], v[200:203], a[68:71]
s_mul_i32 s66, s66, 4160
v_exp_f32 v174, v174
v_mfma_f32_16x16x32_bf16 a[68:71], a[228:231], v[216:219], a[68:71]
s_add_u32 s66, s66, s92
ds_read_b128 a[172:175], v2 offset:27648
ds_read_b128 a[176:179], v2 offset:28672
v_mfma_f32_16x16x32_bf16 a[72:75], a[232:235], v[216:219], a[72:75]
s_add_u32 m0, s66, 32
v_exp_f32 v175, v175
v_mfma_f32_16x16x32_bf16 a[72:75], a[200:203], v[200:203], a[72:75]
s_add_u32 s72, s93, 0x6
buffer_load_dwordx4 v1, s[36:39], s72 offen lds
v_mfma_f32_16x16x32_bf16 a[76:79], a[204:207], v[200:203], a[76:79]
v_exp_f32 v188, v188
v_mfma_f32_16x16x32_bf16 a[76:79], a[236:239], v[216:219], a[76:79]
ds_read_b128 a[180:183], v2 offset:29696
v_cvt_pk_bf16_f32 v221, v174, v175
v_mfma_f32_16x16x32_bf16 a[80:83], a[240:243], v[216:219], a[80:83]
s_waitcnt lgkmcnt(6)
v_exp_f32 v189, v189
v_mfma_f32_16x16x32_bf16 a[80:83], a[208:211], v[200:203], a[80:83]
ds_read_b128 a[184:187], v2 offset:30720
v_cvt_pk_bf16_f32 v222, v188, v189
v_mfma_f32_16x16x32_bf16 a[84:87], a[212:215], v[200:203], a[84:87]
v_exp_f32 v190, v190
v_mfma_f32_16x16x32_bf16 a[84:87], a[244:247], v[216:219], a[84:87]
buffer_load_dwordx4 v1, s[36:39], s72 offen offset:1024 lds
v_mfma_f32_16x16x32_bf16 a[88:91], a[248:251], v[216:219], a[88:91]
s_nop 0
ds_read_b128 a[188:191], v2 offset:31744
ds_read_b128 a[224:227], v2 offset:8192
v_mfma_f32_16x16x32_bf16 a[88:91], a[216:219], v[200:203], a[88:91]
v_exp_f32 v191, v191
v_mfma_f32_16x16x32_bf16 a[92:95], a[220:223], v[200:203], a[92:95]
v_exp_f32 v168, v168
v_mfma_f32_16x16x32_bf16 a[92:95], a[252:255], v[216:219], a[92:95]
ds_read_b128 a[228:231], v2 offset:9216
v_cvt_pk_bf16_f32 v223, v190, v191
s_cmp_eq_u32 s58, 0
s_cbranch_scc1 Lta28
s_cmp_eq_u32 s58, 1
s_cbranch_scc1 Lnt29
v_mfma_f32_16x16x32_bf16 v[136:139], a[128:131], v[48:51], v[88:91]
v_exp_f32 v169, v169
v_mfma_f32_16x16x32_bf16 v[152:155], a[144:147], v[48:51], v[88:91]
ds_read_b128 a[232:235], v2 offset:10240
v_cvt_pk_bf16_f32 v216, v168, v169
s_branch Ljoin30
Lta28:
v_mfma_f32_16x16x32_bf16 v[136:139], a[128:131], v[48:51], v[104:107]
v_exp_f32 v169, v169
v_mfma_f32_16x16x32_bf16 v[152:155], a[144:147], v[48:51], v[112:115]
ds_read_b128 a[232:235], v2 offset:10240
v_cvt_pk_bf16_f32 v216, v168, v169
s_branch Ljoin30
Lnt29:
v_mfma_f32_16x16x32_bf16 v[136:139], a[128:131], v[48:51], v[88:91]
v_exp_f32 v169, v169
v_mfma_f32_16x16x32_bf16 v[152:155], a[144:147], v[48:51], v[104:107]
ds_read_b128 a[232:235], v2 offset:10240
v_cvt_pk_bf16_f32 v216, v168, v169
Ljoin30:
v_mfma_f32_16x16x32_bf16 v[136:139], a[132:135], v[52:55], v[136:139]
v_exp_f32 v170, v170
v_mfma_f32_16x16x32_bf16 v[136:139], a[136:139], v[56:59], v[136:139]
buffer_load_dwordx4 v1, s[36:39], s72 offen offset:2048 lds
v_mfma_f32_16x16x32_bf16 v[136:139], a[140:143], v[60:63], v[136:139]
ds_read_b128 a[236:239], v2 offset:11264
v_mfma_f32_16x16x32_bf16 v[152:155], a[156:159], v[60:63], v[152:155]
v_exp_f32 v171, v171
v_mfma_f32_16x16x32_bf16 v[152:155], a[152:155], v[56:59], v[152:155]
ds_read_b128 a[240:243], v2 offset:12288
v_cvt_pk_bf16_f32 v217, v170, v171
v_mfma_f32_16x16x32_bf16 v[152:155], a[148:151], v[52:55], v[152:155]
v_exp_f32 v184, v184
v_mfma_f32_16x16x32_bf16 v[140:143], a[128:131], v[64:67], v[92:95]
ds_read_b128 a[244:247], v2 offset:13312
v_mfma_f32_16x16x32_bf16 v[140:143], a[132:135], v[68:71], v[140:143]
v_exp_f32 v185, v185
v_mfma_f32_16x16x32_bf16 v[140:143], a[136:139], v[72:75], v[140:143]
ds_read_b128 a[248:251], v2 offset:14336
v_cvt_pk_bf16_f32 v218, v184, v185
v_mfma_f32_16x16x32_bf16 v[140:143], a[140:143], v[76:79], v[140:143]
buffer_load_dwordx4 v1, s[36:39], s72 offen offset:3072 lds
v_mfma_f32_16x16x32_bf16 v[156:159], a[156:159], v[76:79], v[92:95]
v_exp_f32 v186, v186
v_mfma_f32_16x16x32_bf16 v[156:159], a[152:155], v[72:75], v[156:159]
ds_read_b128 a[252:255], v2 offset:15360
v_add_u32 v2, s82, v1
v_mfma_f32_16x16x32_bf16 v[156:159], a[148:151], v[68:71], v[156:159]
s_waitcnt vmcnt(9) lgkmcnt(0)
v_exp_f32 v187, v187
v_mfma_f32_16x16x32_bf16 v[156:159], a[144:147], v[64:67], v[156:159]
s_barrier
v_cvt_pk_bf16_f32 v219, v186, v187
v_mfma_f32_16x16x32_bf16 v[236:239], v[120:123], v[204:207], v[236:239]
s_mov_b32 m0, s62
v_exp_f32 v136, v136
v_mfma_f32_16x16x32_bf16 v[236:239], v[120:123], v[220:223], v[236:239]
s_add_u32 s72, s93, 0x3000000
ds_read_b128 a[128:131], v2 offset:16384
ds_read_b128 a[132:135], v2 offset:17408
v_mfma_f32_16x16x32_bf16 a[96:99], a[192:195], v[204:207], a[96:99]
s_add_u32 s78, s59, 8
v_exp_f32 v137, v137
v_mfma_f32_16x16x32_bf16 a[96:99], a[224:227], v[220:223], a[96:99]
s_and_b32 s78, s78, 24
buffer_load_dwordx4 v1, s[44:47], s72 offen sc1 lds
v_mfma_f32_16x16x32_bf16 a[100:103], a[228:231], v[220:223], a[100:103]
s_lshr_b32 s79, 0x67234501, s78
v_exp_f32 v138, v138
v_mfma_f32_16x16x32_bf16 a[100:103], a[196:199], v[204:207], a[100:103]
s_and_b32 s79, s79, 7
ds_read_b128 a[136:139], v2 offset:18432
v_cvt_pk_bf16_f32 v200, v136, v137
v_mfma_f32_16x16x32_bf16 a[104:107], a[200:203], v[204:207], a[104:107]
s_lshl_b32 s79, s79, 18
v_exp_f32 v139, v139
v_mfma_f32_16x16x32_bf16 a[104:107], a[232:235], v[220:223], a[104:107]
s_add_u32 s79, s79, s94
ds_read_b128 a[140:143], v2 offset:19456
v_cvt_pk_bf16_f32 v201, v138, v139
v_mfma_f32_16x16x32_bf16 a[108:111], a[236:239], v[220:223], a[108:111]
s_add_u32 s12, s61, 0
v_exp_f32 v152, v152
v_mfma_f32_16x16x32_bf16 a[108:111], a[204:207], v[204:207], a[108:111]
s_and_b32 s12, s12, 3
ds_read_b128 a[144:147], v2 offset:20480
ds_read_b128 a[148:151], v2 offset:21504
v_mfma_f32_16x16x32_bf16 a[112:115], a[208:211], v[204:207], a[112:115]
s_waitcnt lgkmcnt(6)
buffer_load_dwordx4 v1, s[44:47], s72 offen offset:1024 sc1 lds
v_mfma_f32_16x16x32_bf16 a[112:115], a[240:243], v[220:223], a[112:115]
s_lshl_b32 s12, s12, 21
v_exp_f32 v153, v153
v_mfma_f32_16x16x32_bf16 a[116:119], a[244:247], v[220:223], a[116:119]
s_add_u32 s12, s12, s79
v_exp_f32 v154, v154
v_mfma_f32_16x16x32_bf16 a[116:119], a[212:215], v[204:207], a[116:119]
s_add_u32 s13, s61, 1
ds_read_b128 a[152:155], v2 offset:22528
v_cvt_pk_bf16_f32 v202, v152, v153
v_mfma_f32_16x16x32_bf16 a[120:123], a[216:219], v[204:207], a[120:123]
s_and_b32 s13, s13, 3
buffer_load_dwordx4 v1, s[44:47], s72 offen offset:2048 sc1 lds
v_mfma_f32_16x16x32_bf16 a[120:123], a[248:251], v[220:223], a[120:123]
s_lshl_b32 s13, s13, 21
v_exp_f32 v155, v155
v_mfma_f32_16x16x32_bf16 a[124:127], a[252:255], v[220:223], a[124:127]
s_add_u32 s13, s13, s79
ds_read_b128 a[156:159], v2 offset:23552
v_cvt_pk_bf16_f32 v203, v154, v155
v_mfma_f32_16x16x32_bf16 a[124:127], a[220:223], v[204:207], a[124:127]
s_add_u32 s14, s61, 2
v_exp_f32 v140, v140
s_cmp_eq_u32 s58, 2
s_cbranch_scc1 Lta31
s_cmp_eq_u32 s58, 3
s_cbranch_scc1 Lnt32
v_mfma_f32_16x16x32_bf16 v[168:171], a[160:163], v[48:51], v[112:115]
s_and_b32 s14, s14, 3
ds_read_b128 a[192:195], v2 offset:0
ds_read_b128 a[196:199], v2 offset:1024
v_mfma_f32_16x16x32_bf16 v[184:187], a[176:179], v[48:51], v[112:115]
s_lshl_b32 s14, s14, 21
v_exp_f32 v141, v141
s_branch Ljoin33
Lta31:
v_mfma_f32_16x16x32_bf16 v[168:171], a[160:163], v[48:51], v[104:107]
s_and_b32 s14, s14, 3
ds_read_b128 a[192:195], v2 offset:0
ds_read_b128 a[196:199], v2 offset:1024
v_mfma_f32_16x16x32_bf16 v[184:187], a[176:179], v[48:51], v[112:115]
s_lshl_b32 s14, s14, 21
v_exp_f32 v141, v141
s_branch Ljoin33
Lnt32:
v_mfma_f32_16x16x32_bf16 v[168:171], a[160:163], v[48:51], v[88:91]
s_and_b32 s14, s14, 3
ds_read_b128 a[192:195], v2 offset:0
ds_read_b128 a[196:199], v2 offset:1024
v_mfma_f32_16x16x32_bf16 v[184:187], a[176:179], v[48:51], v[104:107]
s_lshl_b32 s14, s14, 21
v_exp_f32 v141, v141
Ljoin33:
v_mfma_f32_16x16x32_bf16 v[172:175], a[160:163], v[64:67], v[92:95]
s_add_u32 s14, s14, s79
buffer_load_dwordx4 v1, s[44:47], s72 offen offset:3072 sc1 lds
v_mfma_f32_16x16x32_bf16 v[172:175], a[164:167], v[68:71], v[172:175]
s_add_u32 s66, s58, 0
v_exp_f32 v142, v142
v_mfma_f32_16x16x32_bf16 v[172:175], a[168:171], v[72:75], v[172:175]
s_and_b32 s66, s66, 3
ds_read_b128 a[200:203], v2 offset:2048
v_cvt_pk_bf16_f32 v204, v140, v141
v_mfma_f32_16x16x32_bf16 v[172:175], a[172:175], v[76:79], v[172:175]
s_mul_i32 s66, s66, 4160
v_exp_f32 v143, v143
v_mfma_f32_16x16x32_bf16 v[188:191], a[188:191], v[76:79], v[92:95]
s_add_u32 s66, s66, s92
ds_read_b128 a[204:207], v2 offset:3072
v_cvt_pk_bf16_f32 v205, v142, v143
v_mfma_f32_16x16x32_bf16 v[188:191], a[184:187], v[72:75], v[188:191]
s_add_u32 m0, s66, 16672
v_exp_f32 v156, v156
v_mfma_f32_16x16x32_bf16 v[188:191], a[180:183], v[68:71], v[188:191]
s_add_u32 s72, s93, 0x0
ds_read_b128 a[208:211], v2 offset:4096
ds_read_b128 a[212:215], v2 offset:5120
v_mfma_f32_16x16x32_bf16 v[188:191], a[176:179], v[64:67], v[188:191]
s_add_u32 s15, s61, 3
buffer_load_dwordx4 v1, s[36:39], s72 offen lds
v_mfma_f32_16x16x32_bf16 v[168:171], a[164:167], v[52:55], v[168:171]
s_and_b32 s15, s15, 3
v_exp_f32 v157, v157
v_mfma_f32_16x16x32_bf16 v[168:171], a[168:171], v[56:59], v[168:171]
s_lshl_b32 s15, s15, 21
v_exp_f32 v158, v158
v_mfma_f32_16x16x32_bf16 v[168:171], a[172:175], v[60:63], v[168:171]
s_add_u32 s15, s15, s79
ds_read_b128 a[216:219], v2 offset:6144
ds_read_b128 a[220:223], v2 offset:7168
v_mfma_f32_16x16x32_bf16 v[184:187], a[188:191], v[60:63], v[184:187]
buffer_load_dwordx4 v1, s[36:39], s72 offen offset:1024 lds
v_mfma_f32_16x16x32_bf16 v[184:187], a[184:187], v[56:59], v[184:187]
v_exp_f32 v159, v159
v_mfma_f32_16x16x32_bf16 v[184:187], a[180:183], v[52:55], v[184:187]
s_waitcnt lgkmcnt(4)
v_cvt_pk_bf16_f32 v206, v156, v157
v_cvt_pk_bf16_f32 v207, v158, v159
v_mfma_f32_16x16x32_bf16 v[232:235], v[120:123], v[216:219], v[232:235]
s_add_u32 s82, s82, 0x8000
ds_read_b128 a[160:163], v2 offset:24576
ds_read_b128 a[164:167], v2 offset:25600
v_mfma_f32_16x16x32_bf16 v[232:235], v[120:123], v[200:203], v[232:235]
s_and_b32 s82, s82, 0x1ffff
v_exp_f32 v172, v172
v_mfma_f32_16x16x32_bf16 a[64:67], a[224:227], v[216:219], a[64:67]
v_exp_f32 v173, v173
v_mfma_f32_16x16x32_bf16 a[64:67], a[192:195], v[200:203], a[64:67]
s_nop 0
ds_read_b128 a[168:171], v2 offset:26624
ds_read_b128 a[172:175], v2 offset:27648
v_mfma_f32_16x16x32_bf16 a[68:71], a[196:199], v[200:203], a[68:71]
v_exp_f32 v174, v174
v_mfma_f32_16x16x32_bf16 a[68:71], a[228:231], v[216:219], a[68:71]
v_exp_f32 v175, v175
v_mfma_f32_16x16x32_bf16 a[72:75], a[232:235], v[216:219], a[72:75]
s_nop 0
ds_read_b128 a[176:179], v2 offset:28672
ds_read_b128 a[180:183], v2 offset:29696
v_mfma_f32_16x16x32_bf16 a[72:75], a[200:203], v[200:203], a[72:75]
v_exp_f32 v188, v188
v_mfma_f32_16x16x32_bf16 a[76:79], a[204:207], v[200:203], a[76:79]
s_nop 0
ds_read_b128 a[184:187], v2 offset:30720
ds_read_b128 a[188:191], v2 offset:31744
v_mfma_f32_16x16x32_bf16 a[76:79], a[236:239], v[216:219], a[76:79]
s_nop 0
ds_read_b128 a[224:227], v2 offset:8192
ds_read_b128 a[228:231], v2 offset:9216
v_mfma_f32_16x16x32_bf16 a[80:83], a[240:243], v[216:219], a[80:83]
s_waitcnt lgkmcnt(10)
ds_read_b128 a[232:235], v2 offset:10240
ds_read_b128 a[236:239], v2 offset:11264
v_mfma_f32_16x16x32_bf16 a[80:83], a[208:211], v[200:203], a[80:83]
ds_read_b128 a[240:243], v2 offset:12288
v_cvt_pk_bf16_f32 v220, v172, v173
v_mfma_f32_16x16x32_bf16 a[84:87], a[212:215], v[200:203], a[84:87]
buffer_load_dwordx4 v1, s[36:39], s72 offen offset:2048 lds
v_mfma_f32_16x16x32_bf16 a[84:87], a[244:247], v[216:219], a[84:87]
v_exp_f32 v189, v189
v_mfma_f32_16x16x32_bf16 a[88:91], a[248:251], v[216:219], a[88:91]
v_exp_f32 v190, v190
v_mfma_f32_16x16x32_bf16 a[88:91], a[216:219], v[200:203], a[88:91]
s_nop 0
ds_read_b128 a[244:247], v2 offset:13312
ds_read_b128 a[248:251], v2 offset:14336
v_mfma_f32_16x16x32_bf16 a[92:95], a[220:223], v[200:203], a[92:95]
v_cvt_pk_bf16_f32 v221, v174, v175
v_cvt_pk_bf16_f32 v222, v188, v189
v_mfma_f32_16x16x32_bf16 a[92:95], a[252:255], v[216:219], a[92:95]
v_exp_f32 v191, v191
s_cmp_eq_u32 s58, 0
s_cbranch_scc1 Lta34
s_cmp_eq_u32 s58, 1
s_cbranch_scc1 Lnt35
v_mfma_f32_16x16x32_bf16 v[140:143], a[128:131], v[64:67], v[92:95]
v_exp_f32 v168, v168
v_mfma_f32_16x16x32_bf16 v[156:159], a[144:147], v[64:67], v[92:95]
v_exp_f32 v169, v169
s_branch Ljoin36
Lta34:
v_mfma_f32_16x16x32_bf16 v[140:143], a[128:131], v[64:67], v[108:111]
v_exp_f32 v168, v168
v_mfma_f32_16x16x32_bf16 v[156:159], a[144:147], v[64:67], v[112:115]
v_exp_f32 v169, v169
s_branch Ljoin36
Lnt35:
v_mfma_f32_16x16x32_bf16 v[140:143], a[128:131], v[64:67], v[92:95]
v_exp_f32 v168, v168
v_mfma_f32_16x16x32_bf16 v[156:159], a[144:147], v[64:67], v[108:111]
v_exp_f32 v169, v169
Ljoin36:
v_mfma_f32_16x16x32_bf16 v[140:143], a[132:135], v[68:71], v[140:143]
v_exp_f32 v170, v170
v_mfma_f32_16x16x32_bf16 v[140:143], a[136:139], v[72:75], v[140:143]
ds_read_b128 a[252:255], v2 offset:15360
v_cvt_pk_bf16_f32 v223, v190, v191
v_mfma_f32_16x16x32_bf16 v[140:143], a[140:143], v[76:79], v[140:143]
v_exp_f32 v171, v171
v_mfma_f32_16x16x32_bf16 v[156:159], a[156:159], v[76:79], v[156:159]
buffer_load_dwordx4 v1, s[36:39], s72 offen offset:3072 lds
v_mfma_f32_16x16x32_bf16 v[156:159], a[152:155], v[72:75], v[156:159]
s_waitcnt vmcnt(13) lgkmcnt(4)
v_exp_f32 v184, v184
v_mfma_f32_16x16x32_bf16 v[156:159], a[148:151], v[68:71], v[156:159]
s_barrier
v_cvt_pk_bf16_f32 v216, v168, v169
v_cvt_pk_bf16_f32 v217, v170, v171
v_add_u32 v2, s82, v1
v_exp_f32 v185, v185
v_exp_f32 v186, v186
v_cvt_pk_bf16_f32 v218, v184, v185
v_exp_f32 v187, v187
s_nop 0
v_cvt_pk_bf16_f32 v219, v186, v187
v_mfma_f32_16x16x32_bf16 v[236:239], v[120:123], v[204:207], v[236:239]
s_add_u32 s66, s58, 2
v_exp_f32 v140, v140
v_mfma_f32_16x16x32_bf16 v[236:239], v[120:123], v[220:223], v[236:239]
s_and_b32 s66, s66, 3
v_exp_f32 v141, v141
v_mfma_f32_16x16x32_bf16 a[96:99], a[192:195], v[204:207], a[96:99]
s_mul_i32 s66, s66, 4160
ds_read_b128 a[192:195], v2 offset:0
v_mfma_f32_16x16x32_bf16 a[96:99], a[224:227], v[220:223], a[96:99]
s_add_u32 s66, s66, s92
v_exp_f32 v142, v142
v_mfma_f32_16x16x32_bf16 a[100:103], a[228:231], v[220:223], a[100:103]
s_add_u32 m0, s66, 33312
v_exp_f32 v143, v143
v_mfma_f32_16x16x32_bf16 a[100:103], a[196:199], v[204:207], a[100:103]
s_add_u32 s72, s93, 0x4
buffer_load_dwordx4 v1, s[36:39], s72 offen lds
v_mfma_f32_16x16x32_bf16 a[104:107], a[200:203], v[204:207], a[104:107]
ds_read_b128 a[196:199], v2 offset:1024
v_mfma_f32_16x16x32_bf16 a[104:107], a[232:235], v[220:223], a[104:107]
buffer_load_dwordx4 v1, s[36:39], s72 offen offset:1024 lds
v_mfma_f32_16x16x32_bf16 a[108:111], a[236:239], v[220:223], a[108:111]
ds_read_b128 a[200:203], v2 offset:2048
v_mfma_f32_16x16x32_bf16 a[108:111], a[204:207], v[204:207], a[108:111]
buffer_load_dwordx4 v1, s[36:39], s72 offen offset:2048 lds
v_mfma_f32_16x16x32_bf16 a[112:115], a[208:211], v[204:207], a[112:115]
s_waitcnt lgkmcnt(3)
ds_read_b128 a[204:207], v2 offset:3072
v_mfma_f32_16x16x32_bf16 a[112:115], a[240:243], v[220:223], a[112:115]
buffer_load_dwordx4 v1, s[36:39], s72 offen offset:3072 lds
v_mfma_f32_16x16x32_bf16 a[116:119], a[244:247], v[220:223], a[116:119]
v_exp_f32 v156, v156
v_mfma_f32_16x16x32_bf16 a[116:119], a[212:215], v[204:207], a[116:119]
ds_read_b128 a[208:211], v2 offset:4096
v_mfma_f32_16x16x32_bf16 a[120:123], a[216:219], v[204:207], a[120:123]
buffer_load_dwordx4 v[80:83], v15, s[4:7], s80 offen
v_mfma_f32_16x16x32_bf16 a[120:123], a[248:251], v[220:223], a[120:123]
s_add_u32 s80, s80, 0x4000
v_exp_f32 v157, v157
v_mfma_f32_16x16x32_bf16 a[124:127], a[252:255], v[220:223], a[124:127]
ds_read_b128 a[212:215], v2 offset:5120
v_mfma_f32_16x16x32_bf16 a[124:127], a[220:223], v[204:207], a[124:127]
ds_read_b128 a[216:219], v2 offset:6144
v_cvt_pk_bf16_f32 v204, v140, v141
s_cmp_eq_u32 s58, 2
s_cbranch_scc1 Lta37
s_cmp_eq_u32 s58, 3
s_cbranch_scc1 Lnt38
v_mfma_f32_16x16x32_bf16 v[172:175], a[160:163], v[64:67], v[112:115]
buffer_load_dwordx4 v[84:87], v15, s[4:7], s80 offen
v_mfma_f32_16x16x32_bf16 v[188:191], a[176:179], v[64:67], v[112:115]
s_add_u32 s80, s80, 0x4000
v_exp_f32 v158, v158
s_branch Ljoin39
Lta37:
v_mfma_f32_16x16x32_bf16 v[172:175], a[160:163], v[64:67], v[108:111]
buffer_load_dwordx4 v[84:87], v15, s[4:7], s80 offen
v_mfma_f32_16x16x32_bf16 v[188:191], a[176:179], v[64:67], v[112:115]
s_add_u32 s80, s80, 0x4000
v_exp_f32 v158, v158
s_branch Ljoin39
Lnt38:
v_mfma_f32_16x16x32_bf16 v[172:175], a[160:163], v[64:67], v[92:95]
buffer_load_dwordx4 v[84:87], v15, s[4:7], s80 offen
v_mfma_f32_16x16x32_bf16 v[188:191], a[176:179], v[64:67], v[108:111]
s_add_u32 s80, s80, 0x4000
v_exp_f32 v158, v158
Ljoin39:
v_mfma_f32_16x16x32_bf16 v[172:175], a[164:167], v[68:71], v[172:175]
ds_read_b128 a[220:223], v2 offset:7168
v_cvt_pk_bf16_f32 v205, v142, v143
v_mfma_f32_16x16x32_bf16 v[172:175], a[168:171], v[72:75], v[172:175]
buffer_load_dwordx4 v[96:99], v15, s[4:7], s80 offen
v_mfma_f32_16x16x32_bf16 v[172:175], a[172:175], v[76:79], v[172:175]
s_add_u32 s80, s80, 0x4000
v_exp_f32 v159, v159
v_mfma_f32_16x16x32_bf16 v[188:191], a[188:191], v[76:79], v[188:191]
buffer_load_dwordx4 v[100:103], v15, s[4:7], s80 offen
v_mfma_f32_16x16x32_bf16 v[188:191], a[184:187], v[72:75], v[188:191]
v_cvt_pk_bf16_f32 v206, v156, v157
v_cvt_pk_bf16_f32 v207, v158, v159
v_mfma_f32_16x16x32_bf16 v[188:191], a[180:183], v[68:71], v[188:191]
s_waitcnt lgkmcnt(4)
v_mfma_f32_16x16x32_bf16 v[232:235], v[120:123], v[216:219], v[232:235]
s_add_u32 s82, s82, 0x8000
v_exp_f32 v172, v172
v_mfma_f32_16x16x32_bf16 a[64:67], a[224:227], v[216:219], a[64:67]
s_and_b32 s82, s82, 0x1ffff
ds_read_b128 a[224:227], v2 offset:8192
v_mfma_f32_16x16x32_bf16 a[68:71], a[228:231], v[216:219], a[68:71]
ds_read_b128 a[228:231], v2 offset:9216
v_mfma_f32_16x16x32_bf16 a[72:75], a[232:235], v[216:219], a[72:75]
v_exp_f32 v173, v173
v_mfma_f32_16x16x32_bf16 a[76:79], a[236:239], v[216:219], a[76:79]
s_nop 0
ds_read_b128 a[232:235], v2 offset:10240
ds_read_b128 a[236:239], v2 offset:11264
v_mfma_f32_16x16x32_bf16 a[80:83], a[240:243], v[216:219], a[80:83]
ds_read_b128 a[240:243], v2 offset:12288
v_cvt_pk_bf16_f32 v220, v172, v173
v_mfma_f32_16x16x32_bf16 a[84:87], a[244:247], v[216:219], a[84:87]
ds_read_b128 a[244:247], v2 offset:13312
v_mfma_f32_16x16x32_bf16 a[88:91], a[248:251], v[216:219], a[88:91]
v_exp_f32 v174, v174
v_mfma_f32_16x16x32_bf16 a[92:95], a[252:255], v[216:219], a[92:95]
v_exp_f32 v175, v175
ds_read_b128 a[248:251], v2 offset:14336
ds_read_b128 a[252:255], v2 offset:15360
v_add_u32 v2, s82, v1
v_exp_f32 v188, v188
v_cvt_pk_bf16_f32 v221, v174, v175
v_exp_f32 v189, v189
v_exp_f32 v190, v190
v_cvt_pk_bf16_f32 v222, v188, v189
v_exp_f32 v191, v191
s_nop 0
v_cvt_pk_bf16_f32 v223, v190, v191
s_waitcnt vmcnt(4) lgkmcnt(0)
s_barrier
LHT4:
Lstub7:
s_cbranch_execz Lstub11
v_mfma_f32_16x16x32_bf16 v[236:239], v[120:123], v[204:207], v[236:239]
ds_write_b64 v5, v[12:13]
v_mov_b32 v240, 0
v_mfma_f32_16x16x32_bf16 v[236:239], v[120:123], v[220:223], v[236:239]
v_mov_b32 v241, 0
v_mfma_f32_16x16x32_bf16 a[96:99], a[192:195], v[204:207], a[96:99]
s_nop 0
ds_write_b64 v14, v[240:241]
ds_read_b64 a[128:129], v6 offset:0
v_mfma_f32_16x16x32_bf16 a[96:99], a[224:227], v[220:223], a[96:99]
s_nop 0
ds_read_b64 a[130:131], v6 offset:8
ds_read_b128 a[192:195], v7 offset:3584
v_mfma_f32_16x16x32_bf16 a[100:103], a[228:231], v[220:223], a[100:103]
s_nop 0
ds_read_b64 a[132:133], v6 offset:512
ds_read_b64 a[134:135], v6 offset:520
v_mfma_f32_16x16x32_bf16 a[100:103], a[196:199], v[204:207], a[100:103]
s_nop 0
ds_read_b128 a[196:199], v7 offset:3072
ds_read_b64 a[136:137], v6 offset:1024
v_mfma_f32_16x16x32_bf16 a[104:107], a[200:203], v[204:207], a[104:107]
s_nop 0
ds_read_b64 a[138:139], v6 offset:1032
ds_read_b128 a[200:203], v7 offset:2560
v_mfma_f32_16x16x32_bf16 a[104:107], a[232:235], v[220:223], a[104:107]
v_add_f32 v12, v224, v228
v_min_u32 v13, 1, v0
v_mfma_f32_16x16x32_bf16 a[108:111], a[236:239], v[220:223], a[108:111]
s_nop 0
ds_read_b64 a[140:141], v6 offset:1536
ds_read_b64 a[142:143], v6 offset:1544
v_mfma_f32_16x16x32_bf16 a[108:111], a[204:207], v[204:207], a[108:111]
s_nop 0
ds_read_b128 a[204:207], v7 offset:2048
ds_read_b64 a[144:145], v6 offset:2048
v_mfma_f32_16x16x32_bf16 a[112:115], a[208:211], v[204:207], a[112:115]
s_lshl_b32 s73, s52, 12
ds_read_b64 a[146:147], v6 offset:2056
ds_read_b128 a[208:211], v7 offset:1536
v_mfma_f32_16x16x32_bf16 a[112:115], a[240:243], v[220:223], a[112:115]
s_add_u32 s73, s73, 0x2000000
v_lshlrev_b32 v13, 30, v13
v_mov_b32 v14, 2
v_mfma_f32_16x16x32_bf16 a[116:119], a[244:247], v[220:223], a[116:119]
s_lshl_b32 s70, s68, 2
ds_read_b64 a[148:149], v6 offset:2560
ds_read_b64 a[150:151], v6 offset:2568
v_mfma_f32_16x16x32_bf16 a[116:119], a[212:215], v[204:207], a[116:119]
s_add_u32 s70, s70, s73
ds_read_b128 a[212:215], v7 offset:1024
ds_read_b64 a[152:153], v6 offset:3072
v_mfma_f32_16x16x32_bf16 a[120:123], a[216:219], v[204:207], a[120:123]
s_nop 0
ds_read_b64 a[154:155], v6 offset:3080
ds_read_b128 a[216:219], v7 offset:512
v_mfma_f32_16x16x32_bf16 a[120:123], a[248:251], v[220:223], a[120:123]
v_mfma_f32_16x16x32_bf16 a[124:127], a[252:255], v[220:223], a[124:127]
s_xor_b32 s71, s12, 0x80
ds_read_b64 a[156:157], v6 offset:3584
ds_read_b64 a[158:159], v6 offset:3592
v_mfma_f32_16x16x32_bf16 a[124:127], a[220:223], v[204:207], a[124:127]
s_add_u32 m0, s77, 0
ds_read_b128 a[220:223], v7 offset:0
s_waitcnt lgkmcnt(0)
v_mfma_f32_16x16x32_bf16 v[128:131], v[8:11], a[192:195], 0
s_add_u32 s72, s71, 0
buffer_load_dwordx4 v15, s[24:27], s72 offen lds
v_mfma_f32_16x16x32_bf16 v[128:131], a[128:131], a[192:195], v[128:131]
v_mfma_f32_16x16x32_bf16 v[132:135], v[8:11], a[196:199], 0
s_nop 0
ds_read_b128 a[224:227], v7 offset:3648
ds_read_b64 a[160:161], v6 offset:64
v_mfma_f32_16x16x32_bf16 v[132:135], a[128:131], a[196:199], v[132:135]
v_accvgpr_read_b32 v240, a64
v_accvgpr_read_b32 v241, a65
v_accvgpr_read_b32 v242, a66
v_mfma_f32_16x16x32_bf16 v[132:135], a[132:135], a[192:195], v[132:135]
s_add_u32 s72, s71, 15360
buffer_load_dwordx4 v15, s[24:27], s72 offen offset:1024 lds
v_accvgpr_read_b32 v243, a67
v_mfma_f32_16x16x32_bf16 v[136:139], v[8:11], a[200:203], 0
s_nop 0
ds_read_b64 a[162:163], v6 offset:72
ds_read_b128 a[228:231], v7 offset:3136
v_mfma_f32_16x16x32_bf16 v[136:139], a[128:131], a[200:203], v[136:139]
s_lshl_b32 s95, s75, 20
v_rcp_f32 v234, v232
v_mfma_f32_16x16x32_bf16 v[136:139], a[132:135], a[196:199], v[136:139]
s_lshl_b32 s74, s58, 18
v_rcp_f32 v238, v236
v_accvgpr_read_b32 v244, a68
v_mfma_f32_16x16x32_bf16 v[136:139], a[136:139], a[192:195], v[136:139]
s_add_u32 s95, s95, s74
ds_read_b64 a[164:165], v6 offset:576
ds_read_b64 a[166:167], v6 offset:584
v_accvgpr_read_b32 v245, a69
v_mfma_f32_16x16x32_bf16 v[140:143], v[8:11], a[204:207], 0
s_add_u32 s72, s71, 30720
buffer_load_dwordx4 v15, s[24:27], s72 offen offset:2048 lds
v_accvgpr_read_b32 v246, a70
v_mfma_f32_16x16x32_bf16 v[140:143], a[128:131], a[204:207], v[140:143]
s_add_u32 s95, s95, 0x2000000
v_accvgpr_read_b32 v247, a71
v_mul_f32 v240, v240, v234
v_mul_f32 v241, v241, v234
v_mfma_f32_16x16x32_bf16 v[140:143], a[132:135], a[200:203], v[140:143]
s_sub_u32 s74, 15, s75
ds_read_b128 a[232:235], v7 offset:2624
ds_read_b64 a[168:169], v6 offset:1088
v_mul_f32 v242, v242, v234
v_mfma_f32_16x16x32_bf16 v[140:143], a[136:139], a[196:199], v[140:143]
s_add_u32 s72, s71, 46080
buffer_load_dwordx4 v15, s[24:27], s72 offen offset:3072 lds
v_mul_f32 v243, v243, v234
v_mfma_f32_16x16x32_bf16 v[140:143], a[140:143], a[192:195], v[140:143]
s_min_u32 s74, s74, s75
v_mul_f32 v244, v244, v234
v_mul_f32 v245, v245, v234
v_mul_f32 v246, v246, v234
v_mfma_f32_16x16x32_bf16 v[144:147], v[8:11], a[208:211], 0
s_lshl_b32 s74, s74, 7
ds_read_b64 a[170:171], v6 offset:1096
ds_read_b128 a[236:239], v7 offset:2112
v_mul_f32 v247, v247, v234
v_mfma_f32_16x16x32_bf16 v[144:147], a[128:131], a[208:211], v[144:147]
s_add_u32 s74, s74, 0x3810000
v_cvt_pk_bf16_f32 v240, v240, v241
v_cvt_pk_bf16_f32 v241, v242, v243
v_cvt_pk_bf16_f32 v242, v244, v245
v_mfma_f32_16x16x32_bf16 v[144:147], a[132:135], a[204:207], v[144:147]
s_xor_b32 s85, s77, 0x10000
v_cvt_pk_bf16_f32 v243, v246, v247
v_mfma_f32_16x16x32_bf16 v[144:147], a[136:139], a[200:203], v[144:147]
s_nop 0
ds_read_b64 a[172:173], v6 offset:1600
ds_read_b64 a[174:175], v6 offset:1608
v_mfma_f32_16x16x32_bf16 v[144:147], a[140:143], a[196:199], v[144:147]
Lstub8:
s_cbranch_execz Lret
buffer_store_dwordx4 v[240:243], v1, s[44:47], s70 offen sc1
v_mfma_f32_16x16x32_bf16 v[144:147], a[144:147], a[192:195], v[144:147]
v_accvgpr_read_b32 v248, a72
v_accvgpr_read_b32 v249, a73
v_accvgpr_read_b32 v250, a74
v_mfma_f32_16x16x32_bf16 v[148:151], v[8:11], a[212:215], 0
s_nop 0
ds_read_b128 a[240:243], v7 offset:1600
ds_read_b64 a[176:177], v6 offset:2112
v_accvgpr_read_b32 v251, a75
v_mfma_f32_16x16x32_bf16 v[148:151], a[128:131], a[212:215], v[148:151]
v_accvgpr_read_b32 v252, a76
v_accvgpr_read_b32 v253, a77
v_accvgpr_read_b32 v254, a78
v_mfma_f32_16x16x32_bf16 v[148:151], a[132:135], a[208:211], v[148:151]
v_accvgpr_read_b32 v255, a79
v_mul_f32 v248, v248, v234
v_mul_f32 v249, v249, v234
v_mfma_f32_16x16x32_bf16 v[148:151], a[136:139], a[204:207], v[148:151]
s_nop 0
ds_read_b64 a[178:179], v6 offset:2120
ds_read_b128 a[244:247], v7 offset:1088
v_mul_f32 v250, v250, v234
v_mfma_f32_16x16x32_bf16 v[148:151], a[140:143], a[200:203], v[148:151]
v_cmp_ngt_f32 vcc, 0x6f800000, v12
s_or_b32 s83, vcc_lo, vcc_hi
s_cselect_b32 s83, s86, 1
s_lshl_b32 s53, s83, 30
s_xor_b32 s83, s53, 0x40000000
v_or_b32 v13, s83, v13
s_lshl_b32 s83, s58, 2
s_add_u32 s83, s83, s91
s_waitcnt vmcnt(5)
buffer_store_dword v14, v13, s[44:47], s83 offen offset:4 sc1
v_mfma_f32_16x16x32_bf16 v[148:151], a[144:147], a[196:199], v[148:151]
v_mul_f32 v251, v251, v234
v_mul_f32 v252, v252, v234
v_mul_f32 v253, v253, v234
v_mfma_f32_16x16x32_bf16 v[148:151], a[148:151], a[192:195], v[148:151]
s_nop 0
ds_read_b64 a[180:181], v6 offset:2624
ds_read_b64 a[182:183], v6 offset:2632
v_mul_f32 v254, v254, v234
v_mfma_f32_16x16x32_bf16 v[152:155], v[8:11], a[216:219], 0
v_mul_f32 v255, v255, v234
v_cvt_pk_bf16_f32 v248, v248, v249
v_cvt_pk_bf16_f32 v249, v250, v251
v_mfma_f32_16x16x32_bf16 v[152:155], a[128:131], a[216:219], v[152:155]
v_cvt_pk_bf16_f32 v250, v252, v253
v_cvt_pk_bf16_f32 v251, v254, v255
v_mfma_f32_16x16x32_bf16 v[152:155], a[132:135], a[212:215], v[152:155]
s_nop 0
ds_read_b128 a[248:251], v7 offset:576
ds_read_b64 a[184:185], v6 offset:3136
v_mfma_f32_16x16x32_bf16 v[152:155], a[136:139], a[208:211], v[152:155]
buffer_store_dwordx4 v[248:251], v1, s[44:47], s70 offen offset:1024 sc1
v_mfma_f32_16x16x32_bf16 v[152:155], a[140:143], a[204:207], v[152:155]
v_accvgpr_read_b32 v240, a80
v_accvgpr_read_b32 v241, a81
v_accvgpr_read_b32 v242, a82
v_mfma_f32_16x16x32_bf16 v[152:155], a[144:147], a[200:203], v[152:155]
s_nop 0
ds_read_b64 a[186:187], v6 offset:3144
ds_read_b128 a[252:255], v7 offset:64
v_accvgpr_read_b32 v243, a83
v_mfma_f32_16x16x32_bf16 v[152:155], a[148:151], a[196:199], v[152:155]
v_accvgpr_read_b32 v244, a84
v_accvgpr_read_b32 v245, a85
v_accvgpr_read_b32 v246, a86
v_mfma_f32_16x16x32_bf16 v[152:155], a[152:155], a[192:195], v[152:155]
v_accvgpr_read_b32 v247, a87
v_mul_f32 v240, v240, v234
v_mul_f32 v241, v241, v234
v_mfma_f32_16x16x32_bf16 v[156:159], v[8:11], a[220:223], 0
s_nop 0
ds_read_b64 a[188:189], v6 offset:3648
ds_read_b64 a[190:191], v6 offset:3656
v_mul_f32 v242, v242, v234
v_mfma_f32_16x16x32_bf16 v[156:159], a[128:131], a[220:223], v[156:159]
v_mul_f32 v243, v243, v234
v_mul_f32 v244, v244, v234
v_mul_f32 v245, v245, v234
v_mfma_f32_16x16x32_bf16 v[156:159], a[132:135], a[216:219], v[156:159]
v_mul_f32 v246, v246, v234
v_mul_f32 v247, v247, v234
v_cvt_pk_bf16_f32 v240, v240, v241
v_mfma_f32_16x16x32_bf16 v[156:159], a[136:139], a[212:215], v[156:159]
v_cvt_pk_bf16_f32 v241, v242, v243
v_cvt_pk_bf16_f32 v242, v244, v245
v_cvt_pk_bf16_f32 v243, v246, v247
v_mfma_f32_16x16x32_bf16 v[156:159], a[140:143], a[208:211], v[156:159]
buffer_store_dwordx4 v[240:243], v1, s[44:47], s70 offen offset:2048 sc1
v_mfma_f32_16x16x32_bf16 v[156:159], a[144:147], a[204:207], v[156:159]
v_accvgpr_read_b32 v248, a88
v_accvgpr_read_b32 v249, a89
v_accvgpr_read_b32 v250, a90
v_mfma_f32_16x16x32_bf16 v[156:159], a[148:151], a[200:203], v[156:159]
v_accvgpr_read_b32 v251, a91
v_accvgpr_read_b32 v252, a92
v_accvgpr_read_b32 v253, a93
v_mfma_f32_16x16x32_bf16 v[156:159], a[152:155], a[196:199], v[156:159]
v_accvgpr_read_b32 v254, a94
v_accvgpr_read_b32 v255, a95
v_mul_f32 v248, v248, v234
v_mfma_f32_16x16x32_bf16 v[156:159], a[156:159], a[192:195], v[156:159]
s_waitcnt lgkmcnt(0)
v_mul_f32 v249, v249, v234
v_mul_f32 v250, v250, v234
v_mul_f32 v251, v251, v234
v_mfma_f32_16x16x32_bf16 v[128:131], a[160:163], a[224:227], v[128:131]
s_nop 0
ds_read_b128 a[192:195], v7 offset:3712
ds_read_b64 a[128:129], v6 offset:128
v_mul_f32 v252, v252, v234
v_mfma_f32_16x16x32_bf16 v[132:135], a[164:167], a[224:227], v[132:135]
v_mul_f32 v253, v253, v234
v_mul_f32 v254, v254, v234
v_mul_f32 v255, v255, v234
v_mfma_f32_16x16x32_bf16 v[132:135], a[160:163], a[228:231], v[132:135]
s_nop 0
ds_read_b64 a[130:131], v6 offset:136
ds_read_b128 a[196:199], v7 offset:3200
v_cvt_pk_bf16_f32 v248, v248, v249
v_mfma_f32_16x16x32_bf16 v[136:139], a[160:163], a[232:235], v[136:139]
v_cvt_pk_bf16_f32 v249, v250, v251
v_cvt_pk_bf16_f32 v250, v252, v253
v_cvt_pk_bf16_f32 v251, v254, v255
v_mfma_f32_16x16x32_bf16 v[136:139], a[164:167], a[228:231], v[136:139]
buffer_store_dwordx4 v[248:251], v1, s[44:47], s70 offen offset:3072 sc1
v_mfma_f32_16x16x32_bf16 v[136:139], a[168:171], a[224:227], v[136:139]
s_add_u32 s70, s70, 0x80000
ds_read_b64 a[132:133], v6 offset:640
ds_read_b64 a[134:135], v6 offset:648
v_accvgpr_read_b32 v240, a96
v_mfma_f32_16x16x32_bf16 v[140:143], a[172:175], a[224:227], v[140:143]
v_accvgpr_read_b32 v241, a97
v_accvgpr_read_b32 v242, a98
v_accvgpr_read_b32 v243, a99
v_mfma_f32_16x16x32_bf16 v[140:143], a[168:171], a[228:231], v[140:143]
s_nop 0
ds_read_b128 a[200:203], v7 offset:2688
ds_read_b64 a[136:137], v6 offset:1152
v_accvgpr_read_b32 v244, a100
v_mfma_f32_16x16x32_bf16 v[140:143], a[164:167], a[232:235], v[140:143]
v_accvgpr_read_b32 v245, a101
v_accvgpr_read_b32 v246, a102
v_accvgpr_read_b32 v247, a103
v_mfma_f32_16x16x32_bf16 v[140:143], a[160:163], a[236:239], v[140:143]
v_mul_f32 v240, v240, v238
v_mul_f32 v241, v241, v238
v_mul_f32 v242, v242, v238
v_mfma_f32_16x16x32_bf16 v[144:147], a[160:163], a[240:243], v[144:147]
s_nop 0
ds_read_b64 a[138:139], v6 offset:1160
ds_read_b128 a[204:207], v7 offset:2176
v_mul_f32 v243, v243, v238
v_mfma_f32_16x16x32_bf16 v[144:147], a[164:167], a[236:239], v[144:147]
v_mul_f32 v244, v244, v238
v_mul_f32 v245, v245, v238
v_mul_f32 v246, v246, v238
v_mfma_f32_16x16x32_bf16 v[144:147], a[168:171], a[232:235], v[144:147]
s_nop 0
ds_read_b64 a[140:141], v6 offset:1664
ds_read_b64 a[142:143], v6 offset:1672
v_mul_f32 v247, v247, v238
v_mfma_f32_16x16x32_bf16 v[144:147], a[172:175], a[228:231], v[144:147]
v_cvt_pk_bf16_f32 v240, v240, v241
v_cvt_pk_bf16_f32 v241, v242, v243
v_cvt_pk_bf16_f32 v242, v244, v245
v_mfma_f32_16x16x32_bf16 v[144:147], a[176:179], a[224:227], v[144:147]
v_cvt_pk_bf16_f32 v243, v246, v247
v_mfma_f32_16x16x32_bf16 v[148:151], a[180:183], a[224:227], v[148:151]
s_nop 0
ds_read_b128 a[208:211], v7 offset:1664
ds_read_b64 a[144:145], v6 offset:2176
v_mfma_f32_16x16x32_bf16 v[148:151], a[176:179], a[228:231], v[148:151]
buffer_store_dwordx4 v[240:243], v1, s[44:47], s70 offen sc1
v_mfma_f32_16x16x32_bf16 v[148:151], a[172:175], a[232:235], v[148:151]
v_accvgpr_read_b32 v248, a104
v_accvgpr_read_b32 v249, a105
v_accvgpr_read_b32 v250, a106
v_mfma_f32_16x16x32_bf16 v[148:151], a[168:171], a[236:239], v[148:151]
s_nop 0
ds_read_b64 a[146:147], v6 offset:2184
ds_read_b128 a[212:215], v7 offset:1152
v_accvgpr_read_b32 v251, a107
v_mfma_f32_16x16x32_bf16 v[148:151], a[164:167], a[240:243], v[148:151]
v_accvgpr_read_b32 v252, a108
v_accvgpr_read_b32 v253, a109
v_accvgpr_read_b32 v254, a110
v_mfma_f32_16x16x32_bf16 v[148:151], a[160:163], a[244:247], v[148:151]
s_nop 0
ds_read_b64 a[148:149], v6 offset:2688
ds_read_b64 a[150:151], v6 offset:2696
v_accvgpr_read_b32 v255, a111
v_mfma_f32_16x16x32_bf16 v[152:155], a[160:163], a[248:251], v[152:155]
v_mul_f32 v248, v248, v238
v_mul_f32 v249, v249, v238
v_mul_f32 v250, v250, v238
v_mfma_f32_16x16x32_bf16 v[152:155], a[164:167], a[244:247], v[152:155]
v_mul_f32 v251, v251, v238
v_mul_f32 v252, v252, v238
v_mul_f32 v253, v253, v238
v_mfma_f32_16x16x32_bf16 v[152:155], a[168:171], a[240:243], v[152:155]
s_nop 0
ds_read_b128 a[216:219], v7 offset:640
ds_read_b64 a[152:153], v6 offset:3200
v_mul_f32 v254, v254, v238
v_mfma_f32_16x16x32_bf16 v[152:155], a[172:175], a[236:239], v[152:155]
v_mul_f32 v255, v255, v238
v_cvt_pk_bf16_f32 v248, v248, v249
v_cvt_pk_bf16_f32 v249, v250, v251
v_mfma_f32_16x16x32_bf16 v[152:155], a[176:179], a[232:235], v[152:155]
s_nop 0
ds_read_b64 a[154:155], v6 offset:3208
ds_read_b128 a[220:223], v7 offset:128
v_cvt_pk_bf16_f32 v250, v252, v253
v_mfma_f32_16x16x32_bf16 v[152:155], a[180:183], a[228:231], v[152:155]
v_cvt_pk_bf16_f32 v251, v254, v255
v_mfma_f32_16x16x32_bf16 v[152:155], a[184:187], a[224:227], v[152:155]
buffer_store_dwordx4 v[248:251], v1, s[44:47], s70 offen offset:1024 sc1
v_mfma_f32_16x16x32_bf16 v[156:159], a[188:191], a[224:227], v[156:159]
s_nop 0
ds_read_b64 a[156:157], v6 offset:3712
ds_read_b64 a[158:159], v6 offset:3720
v_accvgpr_read_b32 v240, a112
v_mfma_f32_16x16x32_bf16 v[156:159], a[184:187], a[228:231], v[156:159]
v_accvgpr_read_b32 v241, a113
v_accvgpr_read_b32 v242, a114
v_accvgpr_read_b32 v243, a115
v_mfma_f32_16x16x32_bf16 v[156:159], a[180:183], a[232:235], v[156:159]
v_accvgpr_read_b32 v244, a116
v_accvgpr_read_b32 v245, a117
v_accvgpr_read_b32 v246, a118
v_mfma_f32_16x16x32_bf16 v[156:159], a[176:179], a[236:239], v[156:159]
v_accvgpr_read_b32 v247, a119
v_mul_f32 v240, v240, v238
v_mul_f32 v241, v241, v238
v_mfma_f32_16x16x32_bf16 v[156:159], a[172:175], a[240:243], v[156:159]
v_mul_f32 v242, v242, v238
v_mul_f32 v243, v243, v238
v_mul_f32 v244, v244, v238
v_mfma_f32_16x16x32_bf16 v[156:159], a[168:171], a[244:247], v[156:159]
v_mul_f32 v245, v245, v238
v_mul_f32 v246, v246, v238
v_mul_f32 v247, v247, v238
v_mfma_f32_16x16x32_bf16 v[156:159], a[164:167], a[248:251], v[156:159]
v_cvt_pk_bf16_f32 v240, v240, v241
v_cvt_pk_bf16_f32 v241, v242, v243
v_cvt_pk_bf16_f32 v242, v244, v245
v_mfma_f32_16x16x32_bf16 v[156:159], a[160:163], a[252:255], v[156:159]
s_waitcnt lgkmcnt(0)
v_cvt_pk_bf16_f32 v243, v246, v247
v_mfma_f32_16x16x32_bf16 v[128:131], a[128:131], a[192:195], v[128:131]
s_nop 0
ds_read_b128 a[224:227], v7 offset:3776
ds_read_b64 a[160:161], v6 offset:192
v_mfma_f32_16x16x32_bf16 v[132:135], a[132:135], a[192:195], v[132:135]
buffer_store_dwordx4 v[240:243], v1, s[44:47], s70 offen offset:2048 sc1
v_mfma_f32_16x16x32_bf16 v[132:135], a[128:131], a[196:199], v[132:135]
s_nop 0
ds_read_b64 a[162:163], v6 offset:200
ds_read_b128 a[228:231], v7 offset:3264
v_accvgpr_read_b32 v248, a120
v_mfma_f32_16x16x32_bf16 v[136:139], a[128:131], a[200:203], v[136:139]
v_accvgpr_read_b32 v249, a121
v_accvgpr_read_b32 v250, a122
v_accvgpr_read_b32 v251, a123
v_mfma_f32_16x16x32_bf16 v[136:139], a[132:135], a[196:199], v[136:139]
v_accvgpr_read_b32 v252, a124
v_accvgpr_read_b32 v253, a125
v_accvgpr_read_b32 v254, a126
v_mfma_f32_16x16x32_bf16 v[136:139], a[136:139], a[192:195], v[136:139]
s_nop 0
ds_read_b64 a[164:165], v6 offset:704
ds_read_b64 a[166:167], v6 offset:712
v_accvgpr_read_b32 v255, a127
v_mfma_f32_16x16x32_bf16 v[140:143], a[140:143], a[192:195], v[140:143]
v_mul_f32 v248, v248, v238
v_mul_f32 v249, v249, v238
v_mul_f32 v250, v250, v238
v_mfma_f32_16x16x32_bf16 v[140:143], a[136:139], a[196:199], v[140:143]
s_nop 0
ds_read_b128 a[232:235], v7 offset:2752
ds_read_b64 a[168:169], v6 offset:1216
v_mul_f32 v251, v251, v238
v_mfma_f32_16x16x32_bf16 v[140:143], a[132:135], a[200:203], v[140:143]
v_mul_f32 v252, v252, v238
v_mul_f32 v253, v253, v238
v_mul_f32 v254, v254, v238
v_mfma_f32_16x16x32_bf16 v[140:143], a[128:131], a[204:207], v[140:143]
v_mul_f32 v255, v255, v238
v_cvt_pk_bf16_f32 v248, v248, v249
v_cvt_pk_bf16_f32 v249, v250, v251
v_mfma_f32_16x16x32_bf16 v[144:147], a[128:131], a[208:211], v[144:147]
s_nop 0
ds_read_b64 a[170:171], v6 offset:1224
ds_read_b128 a[236:239], v7 offset:2240
v_cvt_pk_bf16_f32 v250, v252, v253
v_mfma_f32_16x16x32_bf16 v[144:147], a[132:135], a[204:207], v[144:147]
v_cvt_pk_bf16_f32 v251, v254, v255
v_mfma_f32_16x16x32_bf16 v[144:147], a[136:139], a[200:203], v[144:147]
s_nop 0
ds_read_b64 a[172:173], v6 offset:1728
ds_read_b64 a[174:175], v6 offset:1736
v_mfma_f32_16x16x32_bf16 v[144:147], a[140:143], a[196:199], v[144:147]
buffer_store_dwordx4 v[248:251], v1, s[44:47], s70 offen offset:3072 sc1
v_mfma_f32_16x16x32_bf16 v[144:147], a[144:147], a[192:195], v[144:147]
s_mov_b32 s73, 0x6f800000
v_add_f32 v227, v224, v228
v_add_f32 v231, v232, v236
v_add_f32 v227, v227, v231
v_mfma_f32_16x16x32_bf16 v[148:151], a[148:151], a[192:195], v[148:151]
s_nop 0
ds_read_b128 a[240:243], v7 offset:1728
ds_read_b64 a[176:177], v6 offset:2240
v_cmp_nlt_f32 vcc, v227, s73
v_mfma_f32_16x16x32_bf16 v[148:151], a[144:147], a[196:199], v[148:151]
s_lshl_b32 s73, s58, 2
v_mfma_f32_16x16x32_bf16 v[148:151], a[140:143], a[200:203], v[148:151]
s_add_u32 s73, s73, 163328
v_mov_b32 v231, s73
v_mfma_f32_16x16x32_bf16 v[148:151], a[136:139], a[204:207], v[148:151]
s_or_b32 s73, vcc_lo, vcc_hi
ds_read_b64 a[178:179], v6 offset:2248
ds_read_b128 a[244:247], v7 offset:1216
v_mfma_f32_16x16x32_bf16 v[148:151], a[132:135], a[208:211], v[148:151]
s_min_u32 s73, s73, 1
v_mov_b32 v227, s73
v_mfma_f32_16x16x32_bf16 v[148:151], a[128:131], a[212:215], v[148:151]
s_nop 0
ds_read_b64 a[180:181], v6 offset:2752
ds_read_b64 a[182:183], v6 offset:2760
ds_write_b32 v231, v227
v_mfma_f32_16x16x32_bf16 v[152:155], a[128:131], a[216:219], v[152:155]
v_mfma_f32_16x16x32_bf16 v[152:155], a[132:135], a[212:215], v[152:155]
v_mfma_f32_16x16x32_bf16 v[152:155], a[136:139], a[208:211], v[152:155]
s_nop 0
ds_read_b128 a[248:251], v7 offset:704
ds_read_b64 a[184:185], v6 offset:3264
v_mfma_f32_16x16x32_bf16 v[152:155], a[140:143], a[204:207], v[152:155]
v_mfma_f32_16x16x32_bf16 v[152:155], a[144:147], a[200:203], v[152:155]
s_nop 0
ds_read_b64 a[186:187], v6 offset:3272
ds_read_b128 a[252:255], v7 offset:192
v_mfma_f32_16x16x32_bf16 v[152:155], a[148:151], a[196:199], v[152:155]
v_mfma_f32_16x16x32_bf16 v[152:155], a[152:155], a[192:195], v[152:155]
v_mfma_f32_16x16x32_bf16 v[156:159], a[156:159], a[192:195], v[156:159]
s_nop 0
ds_read_b64 a[188:189], v6 offset:3776
ds_read_b64 a[190:191], v6 offset:3784
v_mfma_f32_16x16x32_bf16 v[156:159], a[152:155], a[196:199], v[156:159]
v_mfma_f32_16x16x32_bf16 v[156:159], a[148:151], a[200:203], v[156:159]
v_mfma_f32_16x16x32_bf16 v[156:159], a[144:147], a[204:207], v[156:159]
v_mfma_f32_16x16x32_bf16 v[156:159], a[140:143], a[208:211], v[156:159]
v_mfma_f32_16x16x32_bf16 v[156:159], a[136:139], a[212:215], v[156:159]
v_mfma_f32_16x16x32_bf16 v[156:159], a[132:135], a[216:219], v[156:159]
v_mfma_f32_16x16x32_bf16 v[156:159], a[128:131], a[220:223], v[156:159]
s_waitcnt lgkmcnt(0)
v_mfma_f32_16x16x32_bf16 v[128:131], a[160:163], a[224:227], v[128:131]
s_nop 0
ds_read_b128 a[192:195], v7 offset:3840
ds_read_b64 a[128:129], v6 offset:256
v_mfma_f32_16x16x32_bf16 v[132:135], a[164:167], a[224:227], v[132:135]
v_mfma_f32_16x16x32_bf16 v[132:135], a[160:163], a[228:231], v[132:135]
s_nop 0
ds_read_b64 a[130:131], v6 offset:264
ds_read_b128 a[196:199], v7 offset:3328
v_mfma_f32_16x16x32_bf16 v[136:139], a[160:163], a[232:235], v[136:139]
v_mfma_f32_16x16x32_bf16 v[136:139], a[164:167], a[228:231], v[136:139]
v_mfma_f32_16x16x32_bf16 v[136:139], a[168:171], a[224:227], v[136:139]
s_nop 0
ds_read_b64 a[132:133], v6 offset:768
ds_read_b64 a[134:135], v6 offset:776
v_mfma_f32_16x16x32_bf16 v[140:143], a[172:175], a[224:227], v[140:143]
v_mfma_f32_16x16x32_bf16 v[140:143], a[168:171], a[228:231], v[140:143]
s_nop 0
ds_read_b128 a[200:203], v7 offset:2816
ds_read_b64 a[136:137], v6 offset:1280
v_mfma_f32_16x16x32_bf16 v[140:143], a[164:167], a[232:235], v[140:143]
v_mfma_f32_16x16x32_bf16 v[140:143], a[160:163], a[236:239], v[140:143]
v_mfma_f32_16x16x32_bf16 v[144:147], a[160:163], a[240:243], v[144:147]
s_nop 0
ds_read_b64 a[138:139], v6 offset:1288
ds_read_b128 a[204:207], v7 offset:2304
v_mfma_f32_16x16x32_bf16 v[144:147], a[164:167], a[236:239], v[144:147]
v_mfma_f32_16x16x32_bf16 v[144:147], a[168:171], a[232:235], v[144:147]
s_nop 0
ds_read_b64 a[140:141], v6 offset:1792
ds_read_b64 a[142:143], v6 offset:1800
v_mfma_f32_16x16x32_bf16 v[144:147], a[172:175], a[228:231], v[144:147]
v_mfma_f32_16x16x32_bf16 v[144:147], a[176:179], a[224:227], v[144:147]
s_xor_b32 s71, s12, 0x100
v_mfma_f32_16x16x32_bf16 v[148:151], a[180:183], a[224:227], v[148:151]
s_add_u32 m0, s77, 16384
ds_read_b128 a[208:211], v7 offset:1792
ds_read_b64 a[144:145], v6 offset:2304
v_mfma_f32_16x16x32_bf16 v[148:151], a[176:179], a[228:231], v[148:151]
s_add_u32 s72, s71, 0
buffer_load_dwordx4 v15, s[24:27], s72 offen lds
s_nop 3
s_mov_b64 exec, 0
s_cmp_eq_u32 s58, 0
s_cbranch_scc1 Lstube0
s_cmp_eq_u32 s58, 1
s_cbranch_scc1 Lstube1
s_cmp_eq_u32 s58, 2
s_cbranch_scc1 Lstube2
s_branch Lstube3
Lrete:
s_mov_b64 exec, -1
s_nop 3
v_mfma_f32_16x16x32_bf16 v[148:151], a[172:175], a[232:235], v[148:151]
s_waitcnt vmcnt(1) lgkmcnt(15)
v_mfma_f32_16x16x32_bf16 v[148:151], a[168:171], a[236:239], v[148:151]
s_barrier
ds_read_b64 a[146:147], v6 offset:2312
ds_read_b128 a[212:215], v7 offset:1280
v_mfma_f32_16x16x32_bf16 v[148:151], a[164:167], a[240:243], v[148:151]
s_add_u32 s72, s71, 15360
buffer_load_dwordx4 v15, s[24:27], s72 offen offset:1024 lds
v_mfma_f32_16x16x32_bf16 v[148:151], a[160:163], a[244:247], v[148:151]
s_nop 0
ds_read_b64 a[148:149], v6 offset:2816
ds_read_b64 a[150:151], v6 offset:2824
v_mfma_f32_16x16x32_bf16 v[152:155], a[160:163], a[248:251], v[152:155]
v_mov_b32 v244, 163328
v_mfma_f32_16x16x32_bf16 v[152:155], a[164:167], a[244:247], v[152:155]
ds_read_b128 v[240:243], v244
v_mfma_f32_16x16x32_bf16 v[152:155], a[168:171], a[240:243], v[152:155]
s_nop 0
ds_read_b128 a[216:219], v7 offset:768
ds_read_b64 a[152:153], v6 offset:3328
v_mfma_f32_16x16x32_bf16 v[152:155], a[172:175], a[236:239], v[152:155]
v_mfma_f32_16x16x32_bf16 v[152:155], a[176:179], a[232:235], v[152:155]
s_add_u32 s72, s71, 30720
ds_read_b64 a[154:155], v6 offset:3336
ds_read_b128 a[220:223], v7 offset:256
v_mfma_f32_16x16x32_bf16 v[152:155], a[180:183], a[228:231], v[152:155]
buffer_load_dwordx4 v15, s[24:27], s72 offen offset:2048 lds
v_mfma_f32_16x16x32_bf16 v[152:155], a[184:187], a[224:227], v[152:155]
s_waitcnt lgkmcnt(4)
v_or3_b32 v240, v240, v241, v242
v_or_b32 v240, v240, v243
v_mfma_f32_16x16x32_bf16 v[156:159], a[188:191], a[224:227], v[156:159]
s_nop 0
ds_read_b64 a[156:157], v6 offset:3840
ds_read_b64 a[158:159], v6 offset:3848
v_cmp_lt_u32 vcc, s86, v240
s_cbranch_vccnz Lslow
v_mfma_f32_16x16x32_bf16 v[156:159], a[184:187], a[228:231], v[156:159]
v_or_b32 v240, s58, v0
v_mov_b32 v241, 2
v_mfma_f32_16x16x32_bf16 v[156:159], a[180:183], a[232:235], v[156:159]
v_min_u32 v240, 1, v240
v_lshlrev_b32 v240, 30, v240
v_mfma_f32_16x16x32_bf16 v[156:159], a[176:179], a[236:239], v[156:159]
s_add_u32 s72, s71, 46080
buffer_load_dwordx4 v15, s[24:27], s72 offen offset:3072 lds
v_mfma_f32_16x16x32_bf16 v[156:159], a[172:175], a[240:243], v[156:159]
buffer_store_dword v241, v240, s[44:47], s91 offen sc1
v_mfma_f32_16x16x32_bf16 v[156:159], a[168:171], a[244:247], v[156:159]
s_add_u32 s80, s93, 0x3400000
v_and_b32 v166, 7, v0
v_lshlrev_b32 v166, 4, v166
v_mfma_f32_16x16x32_bf16 v[156:159], a[164:167], a[248:251], v[156:159]
s_and_b32 s81, s59, 4
v_and_b32 v3, 3, v0
v_add_u32 v3, 1, v3
v_mfma_f32_16x16x32_bf16 v[156:159], a[160:163], a[252:255], v[156:159]
s_waitcnt lgkmcnt(0)
v_mul_u32_u24 v3, s81, v3
v_lshrrev_b32 v2, 4, v0
v_mfma_f32_16x16x32_bf16 v[128:131], a[128:131], a[192:195], v[128:131]
s_nop 0
ds_read_b128 a[224:227], v7 offset:3904
ds_read_b64 a[160:161], v6 offset:320
v_mfma_f32_16x16x32_bf16 v[132:135], a[132:135], a[192:195], v[132:135]
s_xor_b32 s71, s12, 0x180
v_lshl_add_u32 v2, v2, 10, v3
v_bfe_u32 v112, v0, 3, 1
v_mfma_f32_16x16x32_bf16 v[132:135], a[128:131], a[196:199], v[132:135]
s_add_u32 m0, s77, 32768
ds_read_b64 a[162:163], v6 offset:328
ds_read_b128 a[228:231], v7 offset:3392
v_mfma_f32_16x16x32_bf16 v[136:139], a[128:131], a[200:203], v[136:139]
s_add_u32 s72, s71, 0
buffer_load_dwordx4 v15, s[24:27], s72 offen lds
v_mfma_f32_16x16x32_bf16 v[136:139], a[132:135], a[196:199], v[136:139]
s_xor_b32 s82, s78, 0
v_lshl_add_u32 v166, v112, 8, v166
v_bfe_u32 v112, v0, 4, 1
v_mfma_f32_16x16x32_bf16 v[136:139], a[136:139], a[192:195], v[136:139]
s_lshl_b32 s82, s82, 10
ds_read_b64 a[164:165], v6 offset:832
ds_read_b64 a[166:167], v6 offset:840
v_mfma_f32_16x16x32_bf16 v[140:143], a[140:143], a[192:195], v[140:143]
s_add_u32 s82, s82, s74
buffer_load_dword v3, v2, s[44:47], s82 offen sc1
v_mfma_f32_16x16x32_bf16 v[140:143], a[136:139], a[196:199], v[140:143]
s_add_u32 s72, s71, 15360
ds_read_b128 a[232:235], v7 offset:2880
ds_read_b64 a[168:169], v6 offset:1344
v_mfma_f32_16x16x32_bf16 v[140:143], a[132:135], a[200:203], v[140:143]
buffer_load_dwordx4 v15, s[24:27], s72 offen offset:1024 lds
v_mfma_f32_16x16x32_bf16 v[140:143], a[128:131], a[204:207], v[140:143]
v_lshl_add_u32 v166, v112, 7, v166
v_lshrrev_b32 v112, 5, v0
v_mfma_f32_16x16x32_bf16 v[144:147], a[128:131], a[208:211], v[144:147]
s_nop 0
ds_read_b64 a[170:171], v6 offset:1352
ds_read_b128 a[236:239], v7 offset:2368
v_mfma_f32_16x16x32_bf16 v[144:147], a[132:135], a[204:207], v[144:147]
v_lshl_add_u32 v166, v112, 9, v166
v_and_b32 v112, 15, v0
v_mfma_f32_16x16x32_bf16 v[144:147], a[136:139], a[200:203], v[144:147]
s_nop 0
ds_read_b64 a[172:173], v6 offset:1856
ds_read_b64 a[174:175], v6 offset:1864
v_mfma_f32_16x16x32_bf16 v[144:147], a[140:143], a[196:199], v[144:147]
s_add_u32 s72, s71, 30720
buffer_load_dwordx4 v15, s[24:27], s72 offen offset:2048 lds
v_mfma_f32_16x16x32_bf16 v[144:147], a[144:147], a[192:195], v[144:147]
v_lshrrev_b32 v113, 2, v0
v_bfe_u32 v114, v0, 3, 2
v_mfma_f32_16x16x32_bf16 v[148:151], a[148:151], a[192:195], v[148:151]
s_nop 0
ds_read_b128 a[240:243], v7 offset:1856
ds_read_b64 a[176:177], v6 offset:2368
v_mfma_f32_16x16x32_bf16 v[148:151], a[144:147], a[196:199], v[148:151]
v_and_b32 v115, 3, v0
v_lshlrev_b32 v8, 7, v113
v_mfma_f32_16x16x32_bf16 v[148:151], a[140:143], a[200:203], v[148:151]
v_lshl_add_u32 v8, v114, 5, v8
v_lshl_add_u32 v8, v115, 3, v8
v_mfma_f32_16x16x32_bf16 v[148:151], a[136:139], a[204:207], v[148:151]
s_nop 0
ds_read_b64 a[178:179], v6 offset:2376
ds_read_b128 a[244:247], v7 offset:1344
v_mfma_f32_16x16x32_bf16 v[148:151], a[132:135], a[208:211], v[148:151]
s_add_u32 s72, s71, 46080
buffer_load_dwordx4 v15, s[24:27], s72 offen offset:3072 lds
v_mfma_f32_16x16x32_bf16 v[148:151], a[128:131], a[212:215], v[148:151]
s_nop 0
ds_read_b64 a[180:181], v6 offset:2880
ds_read_b64 a[182:183], v6 offset:2888
v_mfma_f32_16x16x32_bf16 v[152:155], a[128:131], a[216:219], v[152:155]
v_add_u32 v8, s77, v8
v_subrev_u32 v8, s64, v8
v_mfma_f32_16x16x32_bf16 v[152:155], a[132:135], a[212:215], v[152:155]
v_xor_b32 v9, 32, v8
v_xor_b32 v10, 64, v8
v_mfma_f32_16x16x32_bf16 v[152:155], a[136:139], a[208:211], v[152:155]
s_nop 0
ds_read_b128 a[248:251], v7 offset:832
ds_read_b64 a[184:185], v6 offset:3392
v_mfma_f32_16x16x32_bf16 v[152:155], a[140:143], a[204:207], v[152:155]
v_xor_b32 v11, 0x60, v8
v_lshlrev_b32 v5, 8, v113
v_mfma_f32_16x16x32_bf16 v[152:155], a[144:147], a[200:203], v[152:155]
s_xor_b32 s71, s13, 0x80
ds_read_b64 a[186:187], v6 offset:3400
ds_read_b128 a[252:255], v7 offset:320
v_mfma_f32_16x16x32_bf16 v[152:155], a[148:151], a[196:199], v[152:155]
s_add_u32 m0, s77, 49152
v_and_b32 v114, 1, v0
v_lshl_add_u32 v5, v114, 7, v5
v_mfma_f32_16x16x32_bf16 v[152:155], a[152:155], a[192:195], v[152:155]
s_add_u32 s72, s71, 0
buffer_load_dwordx4 v15, s[24:27], s72 offen lds
v_mfma_f32_16x16x32_bf16 v[156:159], a[156:159], a[192:195], v[156:159]
s_nop 0
ds_read_b64 a[188:189], v6 offset:3904
ds_read_b64 a[190:191], v6 offset:3912
v_mfma_f32_16x16x32_bf16 v[156:159], a[152:155], a[196:199], v[156:159]
v_bfe_u32 v114, v0, 1, 1
v_lshl_add_u32 v5, v114, 3, v5
v_mfma_f32_16x16x32_bf16 v[156:159], a[148:151], a[200:203], v[156:159]
v_lshlrev_b32 v114, 1, s58
v_xor_b32 v114, v114, v113
v_mfma_f32_16x16x32_bf16 v[156:159], a[144:147], a[204:207], v[156:159]
s_add_u32 s72, s71, 15360
buffer_load_dwordx4 v15, s[24:27], s72 offen offset:1024 lds
v_mfma_f32_16x16x32_bf16 v[156:159], a[140:143], a[208:211], v[156:159]
v_and_b32 v114, 7, v114
v_lshl_add_u32 v5, v114, 4, v5
v_mfma_f32_16x16x32_bf16 v[156:159], a[136:139], a[212:215], v[156:159]
v_add_u32 v5, 147456, v5
v_bfe_u32 v114, v0, 1, 2
v_mfma_f32_16x16x32_bf16 v[156:159], a[132:135], a[216:219], v[156:159]
v_lshrrev_b32 v115, 4, v0
v_lshlrev_b32 v116, 7, v112
v_mfma_f32_16x16x32_bf16 v[156:159], a[128:131], a[220:223], v[156:159]
s_waitcnt lgkmcnt(0)
v_lshl_add_u32 v116, v114, 5, v116
v_lshl_add_u32 v116, v115, 3, v116
v_mfma_f32_16x16x32_bf16 v[128:131], a[160:163], a[224:227], v[128:131]
s_nop 0
ds_read_b128 a[192:195], v7 offset:3968
ds_read_b64 a[128:129], v6 offset:384
v_mfma_f32_16x16x32_bf16 v[132:135], a[164:167], a[224:227], v[132:135]
s_add_u32 s72, s71, 30720
Lstub9:
s_cbranch_execz Lret
buffer_load_dwordx4 v15, s[24:27], s72 offen offset:2048 lds
v_mfma_f32_16x16x32_bf16 v[132:135], a[160:163], a[228:231], v[132:135]
s_nop 0
ds_read_b64 a[130:131], v6 offset:392
ds_read_b128 a[196:199], v7 offset:3456
v_mfma_f32_16x16x32_bf16 v[136:139], a[160:163], a[232:235], v[136:139]
v_add_u32 v116, s64, v116
v_add_u32 v116, 131072, v116
v_mfma_f32_16x16x32_bf16 v[136:139], a[164:167], a[228:231], v[136:139]
v_xor_b32 v117, 32, v116
v_xor_b32 v118, 64, v116
v_mfma_f32_16x16x32_bf16 v[136:139], a[168:171], a[224:227], v[136:139]
s_nop 0
ds_read_b64 a[132:133], v6 offset:896
ds_read_b64 a[134:135], v6 offset:904
v_mfma_f32_16x16x32_bf16 v[140:143], a[172:175], a[224:227], v[140:143]
v_xor_b32 v119, 0x60, v116
v_mfma_f32_16x16x32_bf16 v[140:143], a[168:171], a[228:231], v[140:143]
s_add_u32 s72, s71, 46080
ds_read_b128 a[200:203], v7 offset:2944
ds_read_b64 a[136:137], v6 offset:1408
v_mfma_f32_16x16x32_bf16 v[140:143], a[164:167], a[232:235], v[140:143]
buffer_load_dwordx4 v15, s[24:27], s72 offen offset:3072 lds
v_mfma_f32_16x16x32_bf16 v[140:143], a[160:163], a[236:239], v[140:143]
v_mfma_f32_16x16x32_bf16 v[144:147], a[160:163], a[240:243], v[144:147]
s_nop 0
ds_read_b64 a[138:139], v6 offset:1416
ds_read_b128 a[204:207], v7 offset:2432
v_mfma_f32_16x16x32_bf16 v[144:147], a[164:167], a[236:239], v[144:147]
v_mfma_f32_16x16x32_bf16 v[144:147], a[168:171], a[232:235], v[144:147]
s_nop 0
ds_read_b64 a[140:141], v6 offset:1920
ds_read_b64 a[142:143], v6 offset:1928
v_mfma_f32_16x16x32_bf16 v[144:147], a[172:175], a[228:231], v[144:147]
v_mfma_f32_16x16x32_bf16 v[144:147], a[176:179], a[224:227], v[144:147]
v_mfma_f32_16x16x32_bf16 v[148:151], a[180:183], a[224:227], v[148:151]
s_nop 0
ds_read_b128 a[208:211], v7 offset:1920
ds_read_b64 a[144:145], v6 offset:2432
v_mfma_f32_16x16x32_bf16 v[148:151], a[176:179], a[228:231], v[148:151]
v_mfma_f32_16x16x32_bf16 v[148:151], a[172:175], a[232:235], v[148:151]
s_waitcnt vmcnt(7)
v_cmp_gt_u32 vcc, 2, v3
s_or_b32 s81, vcc_lo, vcc_hi
s_cselect_b32 s81, 0x40000000, 0
v_or_b32 v4, s81, v1
v_mfma_f32_16x16x32_bf16 v[148:151], a[168:171], a[236:239], v[148:151]
s_nop 0
ds_read_b64 a[146:147], v6 offset:2440
ds_read_b128 a[212:215], v7 offset:1408
v_mfma_f32_16x16x32_bf16 v[148:151], a[164:167], a[240:243], v[148:151]
v_mfma_f32_16x16x32_bf16 v[148:151], a[160:163], a[244:247], v[148:151]
s_nop 0
ds_read_b64 a[148:149], v6 offset:2944
ds_read_b64 a[150:151], v6 offset:2952
v_mfma_f32_16x16x32_bf16 v[152:155], a[160:163], a[248:251], v[152:155]
v_mfma_f32_16x16x32_bf16 v[152:155], a[164:167], a[244:247], v[152:155]
s_lshr_b32 s69, s12, 18
v_mfma_f32_16x16x32_bf16 v[152:155], a[168:171], a[240:243], v[152:155]
s_lshl_b32 s69, s69, 12
ds_read_b128 a[216:219], v7 offset:896
ds_read_b64 a[152:153], v6 offset:3456
v_mfma_f32_16x16x32_bf16 v[152:155], a[172:175], a[236:239], v[152:155]
s_add_u32 s69, s69, s95
buffer_load_dwordx4 a[0:3], v4, s[44:47], s69 offen sc1
v_mfma_f32_16x16x32_bf16 v[152:155], a[176:179], a[232:235], v[152:155]
s_nop 0
ds_read_b64 a[154:155], v6 offset:3464
ds_read_b128 a[220:223], v7 offset:384
v_mfma_f32_16x16x32_bf16 v[152:155], a[180:183], a[228:231], v[152:155]
v_mfma_f32_16x16x32_bf16 v[152:155], a[184:187], a[224:227], v[152:155]
v_mfma_f32_16x16x32_bf16 v[156:159], a[188:191], a[224:227], v[156:159]
s_nop 0
ds_read_b64 a[156:157], v6 offset:3968
ds_read_b64 a[158:159], v6 offset:3976
v_mfma_f32_16x16x32_bf16 v[156:159], a[184:187], a[228:231], v[156:159]
buffer_load_dwordx4 a[4:7], v4, s[44:47], s69 offen offset:1024 sc1
v_mfma_f32_16x16x32_bf16 v[156:159], a[180:183], a[232:235], v[156:159]
v_mfma_f32_16x16x32_bf16 v[156:159], a[176:179], a[236:239], v[156:159]
v_mfma_f32_16x16x32_bf16 v[156:159], a[172:175], a[240:243], v[156:159]
v_mfma_f32_16x16x32_bf16 v[156:159], a[168:171], a[244:247], v[156:159]
buffer_load_dwordx4 a[8:11], v4, s[44:47], s69 offen offset:2048 sc1
v_mfma_f32_16x16x32_bf16 v[156:159], a[164:167], a[248:251], v[156:159]
v_mfma_f32_16x16x32_bf16 v[156:159], a[160:163], a[252:255], v[156:159]
s_waitcnt lgkmcnt(0)
v_mfma_f32_16x16x32_bf16 v[128:131], a[128:131], a[192:195], v[128:131]
s_nop 0
ds_read_b128 a[224:227], v7 offset:4032
ds_read_b64 a[160:161], v6 offset:448
v_mfma_f32_16x16x32_bf16 v[132:135], a[132:135], a[192:195], v[132:135]
v_mfma_f32_16x16x32_bf16 v[132:135], a[128:131], a[196:199], v[132:135]
s_nop 0
ds_read_b64 a[162:163], v6 offset:456
ds_read_b128 a[228:231], v7 offset:3520
v_mfma_f32_16x16x32_bf16 v[136:139], a[128:131], a[200:203], v[136:139]
buffer_load_dwordx4 a[12:15], v4, s[44:47], s69 offen offset:3072 sc1
v_mfma_f32_16x16x32_bf16 v[136:139], a[132:135], a[196:199], v[136:139]
v_mfma_f32_16x16x32_bf16 v[136:139], a[136:139], a[192:195], v[136:139]
s_nop 0
ds_read_b64 a[164:165], v6 offset:960
ds_read_b64 a[166:167], v6 offset:968
v_mfma_f32_16x16x32_bf16 v[140:143], a[140:143], a[192:195], v[140:143]
v_mfma_f32_16x16x32_bf16 v[140:143], a[136:139], a[196:199], v[140:143]
s_nop 0
ds_read_b128 a[232:235], v7 offset:3008
ds_read_b64 a[168:169], v6 offset:1472
v_mfma_f32_16x16x32_bf16 v[140:143], a[132:135], a[200:203], v[140:143]
s_add_u32 s69, s69, 0x20000
buffer_load_dwordx4 a[16:19], v4, s[44:47], s69 offen sc1
v_mfma_f32_16x16x32_bf16 v[140:143], a[128:131], a[204:207], v[140:143]
v_mfma_f32_16x16x32_bf16 v[144:147], a[128:131], a[208:211], v[144:147]
s_nop 0
ds_read_b64 a[170:171], v6 offset:1480
ds_read_b128 a[236:239], v7 offset:2496
v_mfma_f32_16x16x32_bf16 v[144:147], a[132:135], a[204:207], v[144:147]
v_mfma_f32_16x16x32_bf16 v[144:147], a[136:139], a[200:203], v[144:147]
s_nop 0
ds_read_b64 a[172:173], v6 offset:1984
ds_read_b64 a[174:175], v6 offset:1992
v_mfma_f32_16x16x32_bf16 v[144:147], a[140:143], a[196:199], v[144:147]
buffer_load_dwordx4 a[20:23], v4, s[44:47], s69 offen offset:1024 sc1
v_mfma_f32_16x16x32_bf16 v[144:147], a[144:147], a[192:195], v[144:147]
v_mfma_f32_16x16x32_bf16 v[148:151], a[148:151], a[192:195], v[148:151]
s_nop 0
ds_read_b128 a[240:243], v7 offset:1984
ds_read_b64 a[176:177], v6 offset:2496
v_mfma_f32_16x16x32_bf16 v[148:151], a[144:147], a[196:199], v[148:151]
v_mfma_f32_16x16x32_bf16 v[148:151], a[140:143], a[200:203], v[148:151]
v_mfma_f32_16x16x32_bf16 v[148:151], a[136:139], a[204:207], v[148:151]
s_nop 0
ds_read_b64 a[178:179], v6 offset:2504
ds_read_b128 a[244:247], v7 offset:1472
v_mfma_f32_16x16x32_bf16 v[148:151], a[132:135], a[208:211], v[148:151]
buffer_load_dwordx4 a[24:27], v4, s[44:47], s69 offen offset:2048 sc1
v_mfma_f32_16x16x32_bf16 v[148:151], a[128:131], a[212:215], v[148:151]
s_nop 0
ds_read_b64 a[180:181], v6 offset:3008
ds_read_b64 a[182:183], v6 offset:3016
v_mfma_f32_16x16x32_bf16 v[152:155], a[128:131], a[216:219], v[152:155]
v_mfma_f32_16x16x32_bf16 v[152:155], a[132:135], a[212:215], v[152:155]
v_mfma_f32_16x16x32_bf16 v[152:155], a[136:139], a[208:211], v[152:155]
s_nop 0
ds_read_b128 a[248:251], v7 offset:960
ds_read_b64 a[184:185], v6 offset:3520
v_mfma_f32_16x16x32_bf16 v[152:155], a[140:143], a[204:207], v[152:155]
buffer_load_dwordx4 a[28:31], v4, s[44:47], s69 offen offset:3072 sc1
v_mfma_f32_16x16x32_bf16 v[152:155], a[144:147], a[200:203], v[152:155]
s_nop 0
ds_read_b64 a[186:187], v6 offset:3528
ds_read_b128 a[252:255], v7 offset:448
v_mfma_f32_16x16x32_bf16 v[152:155], a[148:151], a[196:199], v[152:155]
v_mfma_f32_16x16x32_bf16 v[152:155], a[152:155], a[192:195], v[152:155]
s_lshr_b32 s69, s13, 18
v_mfma_f32_16x16x32_bf16 v[156:159], a[156:159], a[192:195], v[156:159]
s_lshl_b32 s69, s69, 12
ds_read_b64 a[188:189], v6 offset:4032
ds_read_b64 a[190:191], v6 offset:4040
v_mfma_f32_16x16x32_bf16 v[156:159], a[152:155], a[196:199], v[156:159]
s_add_u32 s69, s69, s95
buffer_load_dwordx4 a[32:35], v4, s[44:47], s69 offen sc1
v_mfma_f32_16x16x32_bf16 v[156:159], a[148:151], a[200:203], v[156:159]
v_mfma_f32_16x16x32_bf16 v[156:159], a[144:147], a[204:207], v[156:159]
v_mfma_f32_16x16x32_bf16 v[156:159], a[140:143], a[208:211], v[156:159]
v_mfma_f32_16x16x32_bf16 v[156:159], a[136:139], a[212:215], v[156:159]
buffer_load_dwordx4 a[36:39], v4, s[44:47], s69 offen offset:1024 sc1
v_mfma_f32_16x16x32_bf16 v[156:159], a[132:135], a[216:219], v[156:159]
v_mfma_f32_16x16x32_bf16 v[156:159], a[128:131], a[220:223], v[156:159]
s_waitcnt lgkmcnt(0)
v_mfma_f32_16x16x32_bf16 v[128:131], a[160:163], a[224:227], v[128:131]
s_nop 0
ds_read_b64_tr_b16 v[192:193], v8 offset:0
ds_read_b64_tr_b16 v[194:195], v8 offset:2048
v_mfma_f32_16x16x32_bf16 v[132:135], a[164:167], a[224:227], v[132:135]
v_mfma_f32_16x16x32_bf16 v[132:135], a[160:163], a[228:231], v[132:135]
s_nop 0
ds_read_b64_tr_b16 v[196:197], v9 offset:0
ds_read_b64_tr_b16 v[198:199], v9 offset:2048
v_mfma_f32_16x16x32_bf16 v[136:139], a[160:163], a[232:235], v[136:139]
buffer_load_dwordx4 a[40:43], v4, s[44:47], s69 offen offset:2048 sc1
v_mfma_f32_16x16x32_bf16 v[136:139], a[164:167], a[228:231], v[136:139]
s_nop 0
ds_read_b64_tr_b16 v[200:201], v10 offset:0
ds_read_b64_tr_b16 v[202:203], v10 offset:2048
v_mfma_f32_16x16x32_bf16 v[136:139], a[168:171], a[224:227], v[136:139]
v_mfma_f32_16x16x32_bf16 v[140:143], a[172:175], a[224:227], v[140:143]
s_nop 0
ds_read_b64_tr_b16 v[204:205], v11 offset:0
ds_read_b64_tr_b16 v[206:207], v11 offset:2048
v_mfma_f32_16x16x32_bf16 v[140:143], a[168:171], a[228:231], v[140:143]
v_cvt_pk_bf16_f32 v128, v128, v129
v_cvt_pk_bf16_f32 v129, v130, v131
v_cvt_pk_bf16_f32 v130, v132, v133
v_mfma_f32_16x16x32_bf16 v[140:143], a[164:167], a[232:235], v[140:143]
s_nop 0
ds_read_b64_tr_b16 v[208:209], v8 offset:4096
ds_read_b64_tr_b16 v[210:211], v8 offset:6144
v_cvt_pk_bf16_f32 v131, v134, v135
v_mfma_f32_16x16x32_bf16 v[140:143], a[160:163], a[236:239], v[140:143]
s_nop 0
buffer_load_dwordx4 a[44:47], v4, s[44:47], s69 offen offset:3072 sc1
v_permlane32_swap_b32 v128, v130
v_mfma_f32_16x16x32_bf16 v[144:147], a[160:163], a[240:243], v[144:147]
s_nop 0
ds_read_b64_tr_b16 v[212:213], v9 offset:4096
ds_read_b64_tr_b16 v[214:215], v9 offset:6144
v_permlane32_swap_b32 v129, v131
v_mfma_f32_16x16x32_bf16 v[144:147], a[164:167], a[236:239], v[144:147]
buffer_store_dwordx4 v[128:131], v166, s[44:47], s80 offen sc1
v_mfma_f32_16x16x32_bf16 v[144:147], a[168:171], a[232:235], v[144:147]
s_nop 0
ds_read_b64_tr_b16 v[216:217], v10 offset:4096
ds_read_b64_tr_b16 v[218:219], v10 offset:6144
v_mfma_f32_16x16x32_bf16 v[144:147], a[172:175], a[228:231], v[144:147]
s_add_u32 s69, s69, 0x20000
buffer_load_dwordx4 a[48:51], v4, s[44:47], s69 offen sc1
v_mfma_f32_16x16x32_bf16 v[144:147], a[176:179], a[224:227], v[144:147]
s_nop 0
ds_read_b64_tr_b16 v[220:221], v11 offset:4096
ds_read_b64_tr_b16 v[222:223], v11 offset:6144
v_cvt_pk_bf16_f32 v136, v136, v137
v_mfma_f32_16x16x32_bf16 v[148:151], a[180:183], a[224:227], v[148:151]
v_cvt_pk_bf16_f32 v137, v138, v139
v_cvt_pk_bf16_f32 v138, v140, v141
v_cvt_pk_bf16_f32 v139, v142, v143
v_mfma_f32_16x16x32_bf16 v[148:151], a[176:179], a[228:231], v[148:151]
s_nop 0
ds_read_b64_tr_b16 v[224:225], v8 offset:8192
ds_read_b64_tr_b16 v[226:227], v8 offset:10240
v_permlane32_swap_b32 v136, v138
v_mfma_f32_16x16x32_bf16 v[148:151], a[172:175], a[232:235], v[148:151]
v_permlane32_swap_b32 v137, v139
v_mfma_f32_16x16x32_bf16 v[148:151], a[168:171], a[236:239], v[148:151]
s_nop 0
ds_read_b64_tr_b16 v[228:229], v9 offset:8192
ds_read_b64_tr_b16 v[230:231], v9 offset:10240
v_mfma_f32_16x16x32_bf16 v[148:151], a[164:167], a[240:243], v[148:151]
buffer_load_dwordx4 a[52:55], v4, s[44:47], s69 offen offset:1024 sc1
v_mfma_f32_16x16x32_bf16 v[148:151], a[160:163], a[244:247], v[148:151]
s_nop 0
ds_read_b64_tr_b16 v[232:233], v10 offset:8192
ds_read_b64_tr_b16 v[234:235], v10 offset:10240
v_mfma_f32_16x16x32_bf16 v[152:155], a[160:163], a[248:251], v[152:155]
buffer_store_dwordx4 v[136:139], v166, s[44:47], s80 offen offset:1024 sc1
v_mfma_f32_16x16x32_bf16 v[152:155], a[164:167], a[244:247], v[152:155]
s_nop 0
ds_read_b64_tr_b16 v[236:237], v11 offset:8192
ds_read_b64_tr_b16 v[238:239], v11 offset:10240
v_mfma_f32_16x16x32_bf16 v[152:155], a[168:171], a[240:243], v[152:155]
buffer_load_dwordx4 a[56:59], v4, s[44:47], s69 offen offset:2048 sc1
v_mfma_f32_16x16x32_bf16 v[152:155], a[172:175], a[236:239], v[152:155]
s_nop 0
ds_read_b64_tr_b16 v[240:241], v8 offset:12288
ds_read_b64_tr_b16 v[242:243], v8 offset:14336
v_mfma_f32_16x16x32_bf16 v[152:155], a[176:179], a[232:235], v[152:155]
v_cvt_pk_bf16_f32 v144, v144, v145
v_cvt_pk_bf16_f32 v145, v146, v147
v_cvt_pk_bf16_f32 v146, v148, v149
v_mfma_f32_16x16x32_bf16 v[152:155], a[180:183], a[228:231], v[152:155]
s_nop 0
ds_read_b64_tr_b16 v[244:245], v9 offset:12288
ds_read_b64_tr_b16 v[246:247], v9 offset:14336
v_cvt_pk_bf16_f32 v147, v150, v151
v_mfma_f32_16x16x32_bf16 v[152:155], a[184:187], a[224:227], v[152:155]
v_permlane32_swap_b32 v144, v146
v_permlane32_swap_b32 v145, v147
v_mfma_f32_16x16x32_bf16 v[156:159], a[188:191], a[224:227], v[156:159]
s_nop 0
ds_read_b64_tr_b16 v[248:249], v10 offset:12288
ds_read_b64_tr_b16 v[250:251], v10 offset:14336
v_mfma_f32_16x16x32_bf16 v[156:159], a[184:187], a[228:231], v[156:159]
buffer_load_dwordx4 a[60:63], v4, s[44:47], s69 offen offset:3072 sc1
v_mfma_f32_16x16x32_bf16 v[156:159], a[180:183], a[232:235], v[156:159]
s_nop 0
ds_read_b64_tr_b16 v[252:253], v11 offset:12288
ds_read_b64_tr_b16 v[254:255], v11 offset:14336
v_mfma_f32_16x16x32_bf16 v[156:159], a[176:179], a[236:239], v[156:159]
buffer_store_dwordx4 v[144:147], v166, s[44:47], s80 offen offset:2048 sc1
v_mfma_f32_16x16x32_bf16 v[156:159], a[172:175], a[240:243], v[156:159]
v_mfma_f32_16x16x32_bf16 v[156:159], a[168:171], a[244:247], v[156:159]
v_mfma_f32_16x16x32_bf16 v[156:159], a[164:167], a[248:251], v[156:159]
v_mfma_f32_16x16x32_bf16 v[156:159], a[160:163], a[252:255], v[156:159]
v_cvt_pk_bf16_f32 v152, v152, v153
v_cvt_pk_bf16_f32 v153, v154, v155
s_nop 5
v_cvt_pk_bf16_f32 v154, v156, v157
v_cvt_pk_bf16_f32 v155, v158, v159
s_nop 0
v_permlane32_swap_b32 v152, v154
v_permlane32_swap_b32 v153, v155
buffer_store_dwordx4 v[152:155], v166, s[44:47], s80 offen offset:3072 sc1
s_waitcnt vmcnt(12) lgkmcnt(0)
s_cmp_lg_u32 s81, 0
s_cbranch_scc1 Lredo0
Lredo0b:
s_barrier
LEe:
v_mfma_f32_16x16x32_bf16 v[16:19], v[192:195], a[0:3], 0
s_nop 0
ds_read_b64_tr_b16 v[128:129], v8 offset:16384
ds_read_b64_tr_b16 v[130:131], v8 offset:18432
v_mfma_f32_16x16x32_bf16 v[16:19], v[208:211], a[4:7], v[16:19]
s_xor_b32 s71, s13, 0x100
ds_read_b64_tr_b16 v[132:133], v9 offset:16384
ds_read_b64_tr_b16 v[134:135], v9 offset:18432
v_mfma_f32_16x16x32_bf16 v[16:19], v[224:227], a[8:11], v[16:19]
s_add_u32 m0, s85, 0
ds_read_b64_tr_b16 v[136:137], v10 offset:16384
ds_read_b64_tr_b16 v[138:139], v10 offset:18432
v_mfma_f32_16x16x32_bf16 v[16:19], v[240:243], a[12:15], v[16:19]
s_add_u32 s72, s71, 0
buffer_load_dwordx4 v15, s[24:27], s72 offen lds
v_mfma_f32_16x16x32_bf16 v[32:35], v[240:243], a[28:31], 0
s_lshr_b32 s69, s14, 18
ds_read_b64_tr_b16 v[140:141], v11 offset:16384
ds_read_b64_tr_b16 v[142:143], v11 offset:18432
v_mfma_f32_16x16x32_bf16 v[32:35], v[224:227], a[24:27], v[32:35]
s_lshl_b32 s69, s69, 12
v_add_u32 v4, s64, v1
v_add_u32 v4, 131072, v4
v_mfma_f32_16x16x32_bf16 v[32:35], v[208:211], a[20:23], v[32:35]
s_add_u32 s69, s69, s95
buffer_load_dwordx4 a[64:67], v1, s[44:47], s69 offen sc1
v_mfma_f32_16x16x32_bf16 v[32:35], v[192:195], a[16:19], v[32:35]
s_lshl_b32 s70, s75, 18
ds_read_b64_tr_b16 v[144:145], v8 offset:20480
ds_read_b64_tr_b16 v[146:147], v8 offset:22528
v_mfma_f32_16x16x32_bf16 v[36:39], v[196:199], a[16:19], 0
s_add_u32 s72, s71, 15360
buffer_load_dwordx4 v15, s[24:27], s72 offen offset:1024 lds
v_mfma_f32_16x16x32_bf16 v[36:39], v[212:215], a[20:23], v[36:39]
s_add_u32 s70, s70, s94
ds_read_b64_tr_b16 v[148:149], v9 offset:20480
ds_read_b64_tr_b16 v[150:151], v9 offset:22528
v_mfma_f32_16x16x32_bf16 v[36:39], v[228:231], a[24:27], v[36:39]
s_nop 0
ds_read_b64_tr_b16 v[152:153], v10 offset:20480
ds_read_b64_tr_b16 v[154:155], v10 offset:22528
v_mfma_f32_16x16x32_bf16 v[36:39], v[244:247], a[28:31], v[36:39]
s_nop 0
ds_read_b64_tr_b16 v[156:157], v11 offset:20480
ds_read_b64_tr_b16 v[158:159], v11 offset:22528
v_mfma_f32_16x16x32_bf16 v[20:23], v[244:247], a[12:15], 0
ds_write_b128 v4, v[80:83] offset:0
v_mfma_f32_16x16x32_bf16 v[20:23], v[228:231], a[8:11], v[20:23]
s_nop 0
ds_read_b64_tr_b16 v[160:161], v8 offset:24576
ds_read_b64_tr_b16 v[162:163], v8 offset:26624
v_mfma_f32_16x16x32_bf16 v[20:23], v[212:215], a[4:7], v[20:23]
s_add_u32 s72, s71, 30720
buffer_load_dwordx4 v15, s[24:27], s72 offen offset:2048 lds
v_mfma_f32_16x16x32_bf16 v[20:23], v[196:199], a[0:3], v[20:23]
buffer_load_dwordx4 a[68:71], v1, s[44:47], s69 offen offset:1024 sc1
v_mfma_f32_16x16x32_bf16 v[24:27], v[200:203], a[0:3], 0
s_nop 0
ds_read_b64_tr_b16 v[164:165], v9 offset:24576
ds_read_b64_tr_b16 v[166:167], v9 offset:26624
v_mfma_f32_16x16x32_bf16 v[24:27], v[216:219], a[4:7], v[24:27]
s_nop 0
ds_read_b64_tr_b16 v[168:169], v10 offset:24576
ds_read_b64_tr_b16 v[170:171], v10 offset:26624
v_mfma_f32_16x16x32_bf16 v[24:27], v[232:235], a[8:11], v[24:27]
s_nop 0
ds_read_b64_tr_b16 v[172:173], v11 offset:24576
ds_read_b64_tr_b16 v[174:175], v11 offset:26624
v_mfma_f32_16x16x32_bf16 v[24:27], v[248:251], a[12:15], v[24:27]
ds_write_b128 v4, v[84:87] offset:1024
v_mfma_f32_16x16x32_bf16 v[40:43], v[248:251], a[28:31], 0
s_add_u32 s72, s71, 46080
buffer_load_dwordx4 v15, s[24:27], s72 offen offset:3072 lds
v_mfma_f32_16x16x32_bf16 v[40:43], v[232:235], a[24:27], v[40:43]
s_nop 0
ds_read_b64_tr_b16 v[176:177], v8 offset:28672
ds_read_b64_tr_b16 v[178:179], v8 offset:30720
v_mfma_f32_16x16x32_bf16 v[40:43], v[216:219], a[20:23], v[40:43]
s_nop 0
ds_read_b64_tr_b16 v[180:181], v9 offset:28672
ds_read_b64_tr_b16 v[182:183], v9 offset:30720
v_mfma_f32_16x16x32_bf16 v[40:43], v[200:203], a[16:19], v[40:43]
s_nop 0
ds_read_b64_tr_b16 v[184:185], v10 offset:28672
ds_read_b64_tr_b16 v[186:187], v10 offset:30720
v_mfma_f32_16x16x32_bf16 v[44:47], v[204:207], a[16:19], 0
s_nop 0
ds_read_b64_tr_b16 v[188:189], v11 offset:28672
ds_read_b64_tr_b16 v[190:191], v11 offset:30720
v_mfma_f32_16x16x32_bf16 v[44:47], v[220:223], a[20:23], v[44:47]
buffer_load_dwordx4 a[72:75], v1, s[44:47], s69 offen offset:2048 sc1
v_mfma_f32_16x16x32_bf16 v[44:47], v[236:239], a[24:27], v[44:47]
ds_write_b128 v4, v[96:99] offset:2048
v_mfma_f32_16x16x32_bf16 v[44:47], v[252:255], a[28:31], v[44:47]
s_xor_b32 s71, s13, 0x180
v_mfma_f32_16x16x32_bf16 v[28:31], v[252:255], a[12:15], 0
s_add_u32 m0, s85, 16384
ds_write_b128 v4, v[100:103] offset:3072
v_mfma_f32_16x16x32_bf16 v[28:31], v[236:239], a[8:11], v[28:31]
s_add_u32 s72, s71, 0
v_mfma_f32_16x16x32_bf16 v[28:31], v[220:223], a[4:7], v[28:31]
s_waitcnt vmcnt(31) lgkmcnt(0)
buffer_load_dwordx4 v15, s[24:27], s72 offen lds
v_mfma_f32_16x16x32_bf16 v[28:31], v[204:207], a[0:3], v[28:31]
s_barrier
v_mfma_f32_16x16x32_bf16 v[48:51], v[128:131], a[0:3], 0
s_nop 0
ds_read_b64_tr_b16 v[192:193], v8 offset:32768
ds_read_b64_tr_b16 v[194:195], v8 offset:34816
v_mfma_f32_16x16x32_bf16 v[48:51], v[144:147], a[4:7], v[48:51]
s_nop 0
ds_read_b64_tr_b16 v[196:197], v9 offset:32768
ds_read_b64_tr_b16 v[198:199], v9 offset:34816
v_mfma_f32_16x16x32_bf16 v[48:51], v[160:163], a[8:11], v[48:51]
s_nop 0
ds_read_b64_tr_b16 v[200:201], v10 offset:32768
ds_read_b64_tr_b16 v[202:203], v10 offset:34816
v_mfma_f32_16x16x32_bf16 v[48:51], v[176:179], a[12:15], v[48:51]
s_add_u32 s72, s71, 15360
buffer_load_dwordx4 v15, s[24:27], s72 offen offset:1024 lds
v_mfma_f32_16x16x32_bf16 v[64:67], v[176:179], a[28:31], 0
buffer_load_dwordx4 a[76:79], v1, s[44:47], s69 offen offset:3072 sc1
v_mfma_f32_16x16x32_bf16 v[64:67], v[160:163], a[24:27], v[64:67]
s_nop 0
ds_read_b64_tr_b16 v[204:205], v11 offset:32768
ds_read_b64_tr_b16 v[206:207], v11 offset:34816
v_mfma_f32_16x16x32_bf16 v[64:67], v[144:147], a[20:23], v[64:67]
v_mfma_f32_16x16x32_bf16 v[64:67], v[128:131], a[16:19], v[64:67]
s_nop 0
ds_read_b64_tr_b16 v[208:209], v8 offset:36864
ds_read_b64_tr_b16 v[210:211], v8 offset:38912
v_mfma_f32_16x16x32_bf16 v[68:71], v[132:135], a[16:19], 0
s_nop 0
ds_read_b64_tr_b16 v[212:213], v9 offset:36864
ds_read_b64_tr_b16 v[214:215], v9 offset:38912
v_mfma_f32_16x16x32_bf16 v[68:71], v[148:151], a[20:23], v[68:71]
s_add_u32 s72, s71, 30720
buffer_load_dwordx4 v15, s[24:27], s72 offen offset:2048 lds
v_mfma_f32_16x16x32_bf16 v[68:71], v[164:167], a[24:27], v[68:71]
s_nop 0
ds_read_b64_tr_b16 v[216:217], v10 offset:36864
ds_read_b64_tr_b16 v[218:219], v10 offset:38912
v_mfma_f32_16x16x32_bf16 v[68:71], v[180:183], a[28:31], v[68:71]
s_nop 0
ds_read_b64_tr_b16 v[220:221], v11 offset:36864
ds_read_b64_tr_b16 v[222:223], v11 offset:38912
v_mfma_f32_16x16x32_bf16 v[52:55], v[180:183], a[12:15], 0
v_mfma_f32_16x16x32_bf16 v[52:55], v[164:167], a[8:11], v[52:55]
s_add_u32 s69, s69, 0x20000
buffer_load_dwordx4 a[80:83], v1, s[44:47], s69 offen sc1
v_mfma_f32_16x16x32_bf16 v[52:55], v[148:151], a[4:7], v[52:55]
s_nop 0
ds_read_b64_tr_b16 v[224:225], v8 offset:40960
ds_read_b64_tr_b16 v[226:227], v8 offset:43008
v_mfma_f32_16x16x32_bf16 v[52:55], v[132:135], a[0:3], v[52:55]
s_add_u32 s72, s71, 46080
buffer_load_dwordx4 v15, s[24:27], s72 offen offset:3072 lds
v_mfma_f32_16x16x32_bf16 v[56:59], v[136:139], a[0:3], 0
s_nop 0
ds_read_b64_tr_b16 v[228:229], v9 offset:40960
ds_read_b64_tr_b16 v[230:231], v9 offset:43008
v_mfma_f32_16x16x32_bf16 v[56:59], v[152:155], a[4:7], v[56:59]
s_nop 0
ds_read_b64_tr_b16 v[232:233], v10 offset:40960
ds_read_b64_tr_b16 v[234:235], v10 offset:43008
v_mfma_f32_16x16x32_bf16 v[56:59], v[168:171], a[8:11], v[56:59]
s_nop 0
ds_read_b64_tr_b16 v[236:237], v11 offset:40960
ds_read_b64_tr_b16 v[238:239], v11 offset:43008
v_mfma_f32_16x16x32_bf16 v[56:59], v[184:187], a[12:15], v[56:59]
v_mfma_f32_16x16x32_bf16 v[72:75], v[184:187], a[28:31], 0
s_nop 0
ds_read_b64_tr_b16 v[240:241], v8 offset:45056
ds_read_b64_tr_b16 v[242:243], v8 offset:47104
v_mfma_f32_16x16x32_bf16 v[72:75], v[168:171], a[24:27], v[72:75]
s_nop 0
ds_read_b64_tr_b16 v[244:245], v9 offset:45056
ds_read_b64_tr_b16 v[246:247], v9 offset:47104
v_mfma_f32_16x16x32_bf16 v[72:75], v[152:155], a[20:23], v[72:75]
s_nop 0
ds_read_b64_tr_b16 v[248:249], v10 offset:45056
ds_read_b64_tr_b16 v[250:251], v10 offset:47104
v_mfma_f32_16x16x32_bf16 v[72:75], v[136:139], a[16:19], v[72:75]
s_xor_b32 s71, s14, 0x80
buffer_load_dwordx4 a[84:87], v1, s[44:47], s69 offen offset:1024 sc1
v_mfma_f32_16x16x32_bf16 v[76:79], v[140:143], a[16:19], 0
s_add_u32 m0, s85, 32768
ds_read_b64_tr_b16 v[252:253], v11 offset:45056
ds_read_b64_tr_b16 v[254:255], v11 offset:47104
v_mfma_f32_16x16x32_bf16 v[76:79], v[156:159], a[20:23], v[76:79]
s_add_u32 s72, s71, 0
buffer_load_dwordx4 v15, s[24:27], s72 offen lds
v_mfma_f32_16x16x32_bf16 v[76:79], v[172:175], a[24:27], v[76:79]
v_mfma_f32_16x16x32_bf16 v[76:79], v[188:191], a[28:31], v[76:79]
v_mfma_f32_16x16x32_bf16 v[60:63], v[188:191], a[12:15], 0
v_mfma_f32_16x16x32_bf16 v[60:63], v[172:175], a[8:11], v[60:63]
s_add_u32 s72, s71, 15360
v_mfma_f32_16x16x32_bf16 v[60:63], v[156:159], a[4:7], v[60:63]
s_waitcnt vmcnt(35) lgkmcnt(0)
v_mfma_f32_16x16x32_bf16 v[60:63], v[140:143], a[0:3], v[60:63]
s_barrier
buffer_load_dwordx4 v15, s[24:27], s72 offen offset:1024 lds
v_mfma_f32_16x16x32_bf16 v[80:83], v[192:195], a[0:3], 0
s_nop 0
ds_read_b64_tr_b16 v[128:129], v8 offset:49152
ds_read_b64_tr_b16 v[130:131], v8 offset:51200
v_mfma_f32_16x16x32_bf16 v[80:83], v[208:211], a[4:7], v[80:83]
buffer_load_dwordx4 a[88:91], v1, s[44:47], s69 offen offset:2048 sc1
v_mfma_f32_16x16x32_bf16 v[80:83], v[224:227], a[8:11], v[80:83]
s_nop 0
ds_read_b64_tr_b16 v[132:133], v9 offset:49152
ds_read_b64_tr_b16 v[134:135], v9 offset:51200
v_mfma_f32_16x16x32_bf16 v[80:83], v[240:243], a[12:15], v[80:83]
s_nop 0
ds_read_b64_tr_b16 v[136:137], v10 offset:49152
ds_read_b64_tr_b16 v[138:139], v10 offset:51200
v_mfma_f32_16x16x32_bf16 v[96:99], v[240:243], a[28:31], 0
s_nop 0
ds_read_b64_tr_b16 v[140:141], v11 offset:49152
ds_read_b64_tr_b16 v[142:143], v11 offset:51200
v_mfma_f32_16x16x32_bf16 v[96:99], v[224:227], a[24:27], v[96:99]
s_add_u32 s72, s71, 30720
buffer_load_dwordx4 v15, s[24:27], s72 offen offset:2048 lds
v_mfma_f32_16x16x32_bf16 v[96:99], v[208:211], a[20:23], v[96:99]
v_mfma_f32_16x16x32_bf16 v[96:99], v[192:195], a[16:19], v[96:99]
s_nop 0
ds_read_b64_tr_b16 v[144:145], v8 offset:53248
ds_read_b64_tr_b16 v[146:147], v8 offset:55296
v_mfma_f32_16x16x32_bf16 v[100:103], v[196:199], a[16:19], 0
s_nop 0
ds_read_b64_tr_b16 v[148:149], v9 offset:53248
ds_read_b64_tr_b16 v[150:151], v9 offset:55296
v_mfma_f32_16x16x32_bf16 v[100:103], v[212:215], a[20:23], v[100:103]
s_nop 0
ds_read_b64_tr_b16 v[152:153], v10 offset:53248
ds_read_b64_tr_b16 v[154:155], v10 offset:55296
v_mfma_f32_16x16x32_bf16 v[100:103], v[228:231], a[24:27], v[100:103]
s_nop 0
ds_read_b64_tr_b16 v[156:157], v11 offset:53248
ds_read_b64_tr_b16 v[158:159], v11 offset:55296
v_mfma_f32_16x16x32_bf16 v[100:103], v[244:247], a[28:31], v[100:103]
s_add_u32 s72, s71, 46080
buffer_load_dwordx4 v15, s[24:27], s72 offen offset:3072 lds
v_mfma_f32_16x16x32_bf16 v[84:87], v[244:247], a[12:15], 0
buffer_load_dwordx4 a[92:95], v1, s[44:47], s69 offen offset:3072 sc1
v_mfma_f32_16x16x32_bf16 v[84:87], v[228:231], a[8:11], v[84:87]
v_mfma_f32_16x16x32_bf16 v[84:87], v[212:215], a[4:7], v[84:87]
s_nop 0
ds_read_b64_tr_b16 v[160:161], v8 offset:57344
ds_read_b64_tr_b16 v[162:163], v8 offset:59392
v_mfma_f32_16x16x32_bf16 v[84:87], v[196:199], a[0:3], v[84:87]
s_nop 0
ds_read_b64_tr_b16 v[164:165], v9 offset:57344
ds_read_b64_tr_b16 v[166:167], v9 offset:59392
v_mfma_f32_16x16x32_bf16 v[88:91], v[200:203], a[0:3], 0
s_nop 0
ds_read_b64_tr_b16 v[168:169], v10 offset:57344
ds_read_b64_tr_b16 v[170:171], v10 offset:59392
v_mfma_f32_16x16x32_bf16 v[88:91], v[216:219], a[4:7], v[88:91]
s_xor_b32 s82, s78, 4
ds_read_b64_tr_b16 v[172:173], v11 offset:57344
ds_read_b64_tr_b16 v[174:175], v11 offset:59392
v_mfma_f32_16x16x32_bf16 v[88:91], v[232:235], a[8:11], v[88:91]
s_lshl_b32 s82, s82, 10
v_mfma_f32_16x16x32_bf16 v[88:91], v[248:251], a[12:15], v[88:91]
s_xor_b32 s71, s14, 0x100
ds_read_b64_tr_b16 v[176:177], v8 offset:61440
ds_read_b64_tr_b16 v[178:179], v8 offset:63488
v_mfma_f32_16x16x32_bf16 v[104:107], v[248:251], a[28:31], 0
s_add_u32 m0, s85, 49152
ds_read_b64_tr_b16 v[180:181], v9 offset:61440
ds_read_b64_tr_b16 v[182:183], v9 offset:63488
v_mfma_f32_16x16x32_bf16 v[104:107], v[232:235], a[24:27], v[104:107]
s_add_u32 s72, s71, 0
buffer_load_dwordx4 v15, s[24:27], s72 offen lds
v_mfma_f32_16x16x32_bf16 v[104:107], v[216:219], a[20:23], v[104:107]
s_add_u32 s82, s82, s74
buffer_load_dword v3, v2, s[44:47], s82 offen sc1
Lstube0:
s_cbranch_execz Lstube4
v_mfma_f32_16x16x32_bf16 v[104:107], v[200:203], a[16:19], v[104:107]
s_nop 0
ds_read_b64_tr_b16 v[184:185], v10 offset:61440
ds_read_b64_tr_b16 v[186:187], v10 offset:63488
v_mfma_f32_16x16x32_bf16 v[108:111], v[204:207], a[16:19], 0
s_nop 0
ds_read_b64_tr_b16 v[188:189], v11 offset:61440
ds_read_b64_tr_b16 v[190:191], v11 offset:63488
v_mfma_f32_16x16x32_bf16 v[108:111], v[220:223], a[20:23], v[108:111]
v_mfma_f32_16x16x32_bf16 v[108:111], v[236:239], a[24:27], v[108:111]
s_add_u32 s72, s71, 15360
buffer_load_dwordx4 v15, s[24:27], s72 offen offset:1024 lds
v_mfma_f32_16x16x32_bf16 v[108:111], v[252:255], a[28:31], v[108:111]
s_lshr_b32 s69, s15, 18
v_mfma_f32_16x16x32_bf16 v[92:95], v[252:255], a[12:15], 0
s_lshl_b32 s69, s69, 12
v_xor_b32 v8, 0x10000, v8
v_mfma_f32_16x16x32_bf16 v[92:95], v[236:239], a[8:11], v[92:95]
s_add_u32 s69, s69, s95
v_xor_b32 v9, 0x10000, v9
v_mfma_f32_16x16x32_bf16 v[92:95], v[220:223], a[4:7], v[92:95]
s_waitcnt vmcnt(17) lgkmcnt(0)
v_xor_b32 v10, 0x10000, v10
v_mfma_f32_16x16x32_bf16 v[92:95], v[204:207], a[0:3], v[92:95]
s_barrier
buffer_load_dwordx4 a[96:99], v1, s[44:47], s69 offen sc1
v_xor_b32 v11, 0x10000, v11
v_mfma_f32_16x16x32_bf16 v[16:19], v[128:131], a[32:35], v[16:19]
s_add_u32 s72, s71, 30720
buffer_load_dwordx4 v15, s[24:27], s72 offen offset:2048 lds
v_mfma_f32_16x16x32_bf16 v[16:19], v[144:147], a[36:39], v[16:19]
s_nop 0
ds_read_b64_tr_b16 v[192:193], v8 offset:0
ds_read_b64_tr_b16 v[194:195], v8 offset:2048
v_mfma_f32_16x16x32_bf16 v[16:19], v[160:163], a[40:43], v[16:19]
s_nop 0
ds_read_b64_tr_b16 v[196:197], v9 offset:0
ds_read_b64_tr_b16 v[198:199], v9 offset:2048
v_mfma_f32_16x16x32_bf16 v[16:19], v[176:179], a[44:47], v[16:19]
s_nop 0
ds_read_b64_tr_b16 v[200:201], v10 offset:0
ds_read_b64_tr_b16 v[202:203], v10 offset:2048
v_mfma_f32_16x16x32_bf16 v[32:35], v[176:179], a[60:63], v[32:35]
s_nop 0
ds_read_b64_tr_b16 v[204:205], v11 offset:0
ds_read_b64_tr_b16 v[206:207], v11 offset:2048
v_mfma_f32_16x16x32_bf16 v[32:35], v[160:163], a[56:59], v[32:35]
v_or_b32 v112, s58, v0
v_mov_b32 v113, 3
v_mfma_f32_16x16x32_bf16 v[32:35], v[144:147], a[52:55], v[32:35]
s_add_u32 s72, s71, 46080
buffer_load_dwordx4 v15, s[24:27], s72 offen offset:3072 lds
v_mfma_f32_16x16x32_bf16 v[32:35], v[128:131], a[48:51], v[32:35]
s_nop 0
ds_read_b64_tr_b16 v[208:209], v8 offset:4096
ds_read_b64_tr_b16 v[210:211], v8 offset:6144
v_mfma_f32_16x16x32_bf16 v[36:39], v[132:135], a[48:51], v[36:39]
s_nop 0
ds_read_b64_tr_b16 v[212:213], v9 offset:4096
ds_read_b64_tr_b16 v[214:215], v9 offset:6144
v_mfma_f32_16x16x32_bf16 v[36:39], v[148:151], a[52:55], v[36:39]
buffer_load_dwordx4 a[100:103], v1, s[44:47], s69 offen offset:1024 sc1
v_mfma_f32_16x16x32_bf16 v[36:39], v[164:167], a[56:59], v[36:39]
s_nop 0
ds_read_b64_tr_b16 v[216:217], v10 offset:4096
ds_read_b64_tr_b16 v[218:219], v10 offset:6144
v_mfma_f32_16x16x32_bf16 v[36:39], v[180:183], a[60:63], v[36:39]
v_min_u32 v112, 1, v112
v_lshlrev_b32 v112, 30, v112
v_mfma_f32_16x16x32_bf16 v[20:23], v[180:183], a[44:47], v[20:23]
s_nop 0
ds_read_b64_tr_b16 v[220:221], v11 offset:4096
ds_read_b64_tr_b16 v[222:223], v11 offset:6144
v_mfma_f32_16x16x32_bf16 v[20:23], v[164:167], a[40:43], v[20:23]
s_nop 0
ds_read_b64_tr_b16 v[224:225], v8 offset:8192
ds_read_b64_tr_b16 v[226:227], v8 offset:10240
v_mfma_f32_16x16x32_bf16 v[20:23], v[148:151], a[36:39], v[20:23]
s_xor_b32 s71, s14, 0x180
ds_read_b64_tr_b16 v[228:229], v9 offset:8192
ds_read_b64_tr_b16 v[230:231], v9 offset:10240
v_mfma_f32_16x16x32_bf16 v[20:23], v[132:135], a[32:35], v[20:23]
s_add_u32 m0, s77, 0
buffer_store_dword v113, v112, s[44:47], s91 offen sc1
v_mfma_f32_16x16x32_bf16 v[24:27], v[136:139], a[32:35], v[24:27]
s_add_u32 s72, s71, 0
buffer_load_dwordx4 v15, s[24:27], s72 offen lds
v_mfma_f32_16x16x32_bf16 v[24:27], v[152:155], a[36:39], v[24:27]
s_nop 0
ds_read_b64_tr_b16 v[232:233], v10 offset:8192
ds_read_b64_tr_b16 v[234:235], v10 offset:10240
v_mfma_f32_16x16x32_bf16 v[24:27], v[168:171], a[40:43], v[24:27]
s_nop 0
ds_read_b64_tr_b16 v[236:237], v11 offset:8192
ds_read_b64_tr_b16 v[238:239], v11 offset:10240
v_mfma_f32_16x16x32_bf16 v[24:27], v[184:187], a[44:47], v[24:27]
buffer_load_dwordx4 a[104:107], v1, s[44:47], s69 offen offset:2048 sc1
v_mfma_f32_16x16x32_bf16 v[40:43], v[184:187], a[60:63], v[40:43]
s_nop 0
ds_read_b64_tr_b16 v[240:241], v8 offset:12288
ds_read_b64_tr_b16 v[242:243], v8 offset:14336
v_mfma_f32_16x16x32_bf16 v[40:43], v[168:171], a[56:59], v[40:43]
v_mfma_f32_16x16x32_bf16 v[40:43], v[152:155], a[52:55], v[40:43]
s_add_u32 s72, s71, 15360
buffer_load_dwordx4 v15, s[24:27], s72 offen offset:1024 lds
v_mfma_f32_16x16x32_bf16 v[40:43], v[136:139], a[48:51], v[40:43]
s_nop 0
ds_read_b64_tr_b16 v[244:245], v9 offset:12288
ds_read_b64_tr_b16 v[246:247], v9 offset:14336
v_mfma_f32_16x16x32_bf16 v[44:47], v[140:143], a[48:51], v[44:47]
s_nop 0
ds_read_b64_tr_b16 v[248:249], v10 offset:12288
ds_read_b64_tr_b16 v[250:251], v10 offset:14336
v_mfma_f32_16x16x32_bf16 v[44:47], v[156:159], a[52:55], v[44:47]
s_nop 0
ds_read_b64_tr_b16 v[252:253], v11 offset:12288
ds_read_b64_tr_b16 v[254:255], v11 offset:14336
v_mfma_f32_16x16x32_bf16 v[44:47], v[172:175], a[56:59], v[44:47]
v_mfma_f32_16x16x32_bf16 v[44:47], v[188:191], a[60:63], v[44:47]
v_mfma_f32_16x16x32_bf16 v[28:31], v[188:191], a[44:47], v[28:31]
s_add_u32 s72, s71, 30720
buffer_load_dwordx4 v15, s[24:27], s72 offen offset:2048 lds
v_mfma_f32_16x16x32_bf16 v[28:31], v[172:175], a[40:43], v[28:31]
buffer_load_dwordx4 a[108:111], v1, s[44:47], s69 offen offset:3072 sc1
v_mfma_f32_16x16x32_bf16 v[28:31], v[156:159], a[36:39], v[28:31]
s_waitcnt vmcnt(20) lgkmcnt(0)
v_mfma_f32_16x16x32_bf16 v[28:31], v[140:143], a[32:35], v[28:31]
s_barrier
v_mfma_f32_16x16x32_bf16 v[48:51], v[192:195], a[32:35], v[48:51]
s_nop 0
ds_read_b64_tr_b16 v[128:129], v8 offset:16384
ds_read_b64_tr_b16 v[130:131], v8 offset:18432
v_mfma_f32_16x16x32_bf16 v[48:51], v[208:211], a[36:39], v[48:51]
s_nop 0
ds_read_b64_tr_b16 v[132:133], v9 offset:16384
ds_read_b64_tr_b16 v[134:135], v9 offset:18432
v_mfma_f32_16x16x32_bf16 v[48:51], v[224:227], a[40:43], v[48:51]
s_add_u32 s72, s71, 46080
buffer_load_dwordx4 v15, s[24:27], s72 offen offset:3072 lds
v_mfma_f32_16x16x32_bf16 v[48:51], v[240:243], a[44:47], v[48:51]
s_nop 0
ds_read_b64_tr_b16 v[136:137], v10 offset:16384
ds_read_b64_tr_b16 v[138:139], v10 offset:18432
v_mfma_f32_16x16x32_bf16 v[64:67], v[240:243], a[60:63], v[64:67]
s_nop 0
ds_read_b64_tr_b16 v[140:141], v11 offset:16384
ds_read_b64_tr_b16 v[142:143], v11 offset:18432
v_mfma_f32_16x16x32_bf16 v[64:67], v[224:227], a[56:59], v[64:67]
v_and_b32 v120, 15, v0
v_lshrrev_b32 v121, 4, v0
v_mfma_f32_16x16x32_bf16 v[64:67], v[208:211], a[52:55], v[64:67]
s_nop 0
ds_read_b64_tr_b16 v[144:145], v8 offset:20480
ds_read_b64_tr_b16 v[146:147], v8 offset:22528
v_mfma_f32_16x16x32_bf16 v[64:67], v[192:195], a[48:51], v[64:67]
s_add_u32 s69, s69, 0x20000
buffer_load_dwordx4 a[112:115], v1, s[44:47], s69 offen sc1
v_mfma_f32_16x16x32_bf16 v[68:71], v[196:199], a[48:51], v[68:71]
s_nop 0
ds_read_b64_tr_b16 v[148:149], v9 offset:20480
ds_read_b64_tr_b16 v[150:151], v9 offset:22528
v_mfma_f32_16x16x32_bf16 v[68:71], v[212:215], a[52:55], v[68:71]
s_nop 0
ds_read_b64_tr_b16 v[152:153], v10 offset:20480
ds_read_b64_tr_b16 v[154:155], v10 offset:22528
v_mfma_f32_16x16x32_bf16 v[68:71], v[228:231], a[56:59], v[68:71]
s_xor_b32 s71, s15, 0x80
v_lshlrev_b32 v121, 2, v121
v_sub_u32 v120, v120, v121
v_mfma_f32_16x16x32_bf16 v[68:71], v[244:247], a[60:63], v[68:71]
s_add_u32 m0, s77, 16384
ds_read_b64_tr_b16 v[156:157], v11 offset:20480
ds_read_b64_tr_b16 v[158:159], v11 offset:22528
v_mfma_f32_16x16x32_bf16 v[52:55], v[244:247], a[44:47], v[52:55]
s_add_u32 s72, s71, 0
buffer_load_dwordx4 v15, s[24:27], s72 offen lds
v_mfma_f32_16x16x32_bf16 v[52:55], v[228:231], a[40:43], v[52:55]
s_nop 0
ds_read_b64_tr_b16 v[160:161], v8 offset:24576
ds_read_b64_tr_b16 v[162:163], v8 offset:26624
v_mfma_f32_16x16x32_bf16 v[52:55], v[212:215], a[36:39], v[52:55]
s_nop 0
ds_read_b64_tr_b16 v[164:165], v9 offset:24576
ds_read_b64_tr_b16 v[166:167], v9 offset:26624
v_mfma_f32_16x16x32_bf16 v[52:55], v[196:199], a[32:35], v[52:55]
v_min_u32 v120, 4, v120
v_lshlrev_b32 v120, 3, v120
v_mfma_f32_16x16x32_bf16 v[56:59], v[200:203], a[32:35], v[56:59]
s_nop 0
ds_read_b64_tr_b16 v[168:169], v10 offset:24576
ds_read_b64_tr_b16 v[170:171], v10 offset:26624
v_mfma_f32_16x16x32_bf16 v[56:59], v[216:219], a[36:39], v[56:59]
s_add_u32 s72, s71, 15360
buffer_load_dwordx4 v15, s[24:27], s72 offen offset:1024 lds
v_mfma_f32_16x16x32_bf16 v[56:59], v[232:235], a[40:43], v[56:59]
buffer_load_dwordx4 a[116:119], v1, s[44:47], s69 offen offset:1024 sc1
v_mfma_f32_16x16x32_bf16 v[56:59], v[248:251], a[44:47], v[56:59]
s_nop 0
ds_read_b64_tr_b16 v[172:173], v11 offset:24576
ds_read_b64_tr_b16 v[174:175], v11 offset:26624
v_mfma_f32_16x16x32_bf16 v[72:75], v[248:251], a[60:63], v[72:75]
s_nop 0
ds_read_b64_tr_b16 v[176:177], v8 offset:28672
ds_read_b64_tr_b16 v[178:179], v8 offset:30720
v_mfma_f32_16x16x32_bf16 v[72:75], v[232:235], a[56:59], v[72:75]
v_mov_b32 v122, 0x3f80
v_mov_b32 v123, 0
v_mfma_f32_16x16x32_bf16 v[72:75], v[216:219], a[52:55], v[72:75]
s_nop 0
ds_read_b64_tr_b16 v[180:181], v9 offset:28672
ds_read_b64_tr_b16 v[182:183], v9 offset:30720
v_mfma_f32_16x16x32_bf16 v[72:75], v[200:203], a[48:51], v[72:75]
s_add_u32 s72, s71, 30720
buffer_load_dwordx4 v15, s[24:27], s72 offen offset:2048 lds
v_mfma_f32_16x16x32_bf16 v[76:79], v[204:207], a[48:51], v[76:79]
s_nop 0
ds_read_b64_tr_b16 v[184:185], v10 offset:28672
ds_read_b64_tr_b16 v[186:187], v10 offset:30720
v_mfma_f32_16x16x32_bf16 v[76:79], v[220:223], a[52:55], v[76:79]
s_nop 0
ds_read_b64_tr_b16 v[188:189], v11 offset:28672
ds_read_b64_tr_b16 v[190:191], v11 offset:30720
v_mfma_f32_16x16x32_bf16 v[76:79], v[236:239], a[56:59], v[76:79]
v_lshlrev_b64 v[122:123], v120, v[122:123]
v_mov_b32 v126, 0
v_mfma_f32_16x16x32_bf16 v[76:79], v[252:255], a[60:63], v[76:79]
buffer_load_dwordx4 a[120:123], v1, s[44:47], s69 offen offset:2048 sc1
v_mfma_f32_16x16x32_bf16 v[60:63], v[252:255], a[44:47], v[60:63]
v_lshlrev_b64 v[122:123], v120, v[122:123]
v_mov_b32 v127, 0
v_mfma_f32_16x16x32_bf16 v[60:63], v[236:239], a[40:43], v[60:63]
s_add_u32 s72, s71, 46080
buffer_load_dwordx4 v15, s[24:27], s72 offen offset:3072 lds
v_mfma_f32_16x16x32_bf16 v[60:63], v[220:223], a[36:39], v[60:63]
s_waitcnt vmcnt(22) lgkmcnt(0)
v_mov_b32 v120, 0
v_mov_b32 v121, 0
v_mfma_f32_16x16x32_bf16 v[60:63], v[204:207], a[32:35], v[60:63]
s_barrier
v_mov_b32 v124, v122
v_mov_b32 v125, v123
v_mfma_f32_16x16x32_bf16 v[80:83], v[128:131], a[32:35], v[80:83]
s_nop 0
ds_read_b64_tr_b16 v[192:193], v8 offset:32768
ds_read_b64_tr_b16 v[194:195], v8 offset:34816
v_mfma_f32_16x16x32_bf16 v[80:83], v[144:147], a[36:39], v[80:83]
s_nop 0
ds_read_b64_tr_b16 v[196:197], v9 offset:32768
ds_read_b64_tr_b16 v[198:199], v9 offset:34816
v_mfma_f32_16x16x32_bf16 v[80:83], v[160:163], a[40:43], v[80:83]
s_nop 0
ds_read_b64_tr_b16 v[200:201], v10 offset:32768
ds_read_b64_tr_b16 v[202:203], v10 offset:34816
v_mfma_f32_16x16x32_bf16 v[80:83], v[176:179], a[44:47], v[80:83]
s_nop 0
ds_read_b64_tr_b16 v[204:205], v11 offset:32768
ds_read_b64_tr_b16 v[206:207], v11 offset:34816
v_mfma_f32_16x16x32_bf16 v[96:99], v[176:179], a[60:63], v[96:99]
v_mfma_f32_16x16x32_bf16 v[96:99], v[160:163], a[56:59], v[96:99]
s_xor_b32 s71, s15, 0x100
buffer_load_dwordx4 a[124:127], v1, s[44:47], s69 offen offset:3072 sc1
v_mfma_f32_16x16x32_bf16 v[96:99], v[144:147], a[52:55], v[96:99]
s_add_u32 m0, s77, 32768
ds_read_b64_tr_b16 v[208:209], v8 offset:36864
ds_read_b64_tr_b16 v[210:211], v8 offset:38912
v_mfma_f32_16x16x32_bf16 v[96:99], v[128:131], a[48:51], v[96:99]
s_add_u32 s72, s71, 0
buffer_load_dwordx4 v15, s[24:27], s72 offen lds
v_mfma_f32_16x16x32_bf16 v[100:103], v[132:135], a[48:51], v[100:103]
s_nop 0
ds_read_b64_tr_b16 v[212:213], v9 offset:36864
ds_read_b64_tr_b16 v[214:215], v9 offset:38912
v_mfma_f32_16x16x32_bf16 v[100:103], v[148:151], a[52:55], v[100:103]
s_nop 0
ds_read_b64_tr_b16 v[216:217], v10 offset:36864
ds_read_b64_tr_b16 v[218:219], v10 offset:38912
v_mfma_f32_16x16x32_bf16 v[100:103], v[164:167], a[56:59], v[100:103]
s_nop 0
ds_read_b64_tr_b16 v[220:221], v11 offset:36864
ds_read_b64_tr_b16 v[222:223], v11 offset:38912
v_mfma_f32_16x16x32_bf16 v[100:103], v[180:183], a[60:63], v[100:103]
v_mfma_f32_16x16x32_bf16 v[84:87], v[180:183], a[44:47], v[84:87]
s_nop 0
ds_read_b64_tr_b16 v[224:225], v8 offset:40960
ds_read_b64_tr_b16 v[226:227], v8 offset:43008
v_mfma_f32_16x16x32_bf16 v[84:87], v[164:167], a[40:43], v[84:87]
s_add_u32 s72, s71, 15360
buffer_load_dwordx4 v15, s[24:27], s72 offen offset:1024 lds
v_mfma_f32_16x16x32_bf16 v[84:87], v[148:151], a[36:39], v[84:87]
s_nop 0
ds_read_b64_tr_b16 v[228:229], v9 offset:40960
ds_read_b64_tr_b16 v[230:231], v9 offset:43008
v_mfma_f32_16x16x32_bf16 v[84:87], v[132:135], a[32:35], v[84:87]
s_waitcnt vmcnt(22)
v_cmp_gt_u32 vcc, 2, v3
s_cbranch_vccnz Lspin106
Lback107:
s_lshr_b32 s69, s12, 18
s_lshl_b32 s69, s69, 12
s_add_u32 s69, s69, s95
s_xor_b32 s69, s69, 0x1000
buffer_load_dwordx4 a[128:131], v1, s[44:47], s69 offen sc1
v_mfma_f32_16x16x32_bf16 v[88:91], v[136:139], a[32:35], v[88:91]
s_nop 0
ds_read_b64_tr_b16 v[232:233], v10 offset:40960
ds_read_b64_tr_b16 v[234:235], v10 offset:43008
v_mfma_f32_16x16x32_bf16 v[88:91], v[152:155], a[36:39], v[88:91]
s_nop 0
ds_read_b64_tr_b16 v[236:237], v11 offset:40960
ds_read_b64_tr_b16 v[238:239], v11 offset:43008
v_mfma_f32_16x16x32_bf16 v[88:91], v[168:171], a[40:43], v[88:91]
v_mfma_f32_16x16x32_bf16 v[88:91], v[184:187], a[44:47], v[88:91]
s_add_u32 s72, s71, 30720
buffer_load_dwordx4 v15, s[24:27], s72 offen offset:2048 lds
v_mfma_f32_16x16x32_bf16 v[104:107], v[184:187], a[60:63], v[104:107]
s_nop 0
ds_read_b64_tr_b16 v[240:241], v8 offset:45056
ds_read_b64_tr_b16 v[242:243], v8 offset:47104
v_mfma_f32_16x16x32_bf16 v[104:107], v[168:171], a[56:59], v[104:107]
s_nop 0
ds_read_b64_tr_b16 v[244:245], v9 offset:45056
ds_read_b64_tr_b16 v[246:247], v9 offset:47104
v_mfma_f32_16x16x32_bf16 v[104:107], v[152:155], a[52:55], v[104:107]
s_nop 0
ds_read_b64_tr_b16 v[248:249], v10 offset:45056
ds_read_b64_tr_b16 v[250:251], v10 offset:47104
v_mfma_f32_16x16x32_bf16 v[104:107], v[136:139], a[48:51], v[104:107]
s_nop 0
ds_read_b64_tr_b16 v[252:253], v11 offset:45056
ds_read_b64_tr_b16 v[254:255], v11 offset:47104
v_mfma_f32_16x16x32_bf16 v[108:111], v[140:143], a[48:51], v[108:111]
v_mfma_f32_16x16x32_bf16 v[108:111], v[156:159], a[52:55], v[108:111]
s_add_u32 s72, s71, 46080
buffer_load_dwordx4 v15, s[24:27], s72 offen offset:3072 lds
v_mfma_f32_16x16x32_bf16 v[108:111], v[172:175], a[56:59], v[108:111]
buffer_load_dwordx4 a[132:135], v1, s[44:47], s69 offen offset:1024 sc1
v_mfma_f32_16x16x32_bf16 v[108:111], v[188:191], a[60:63], v[108:111]
v_mfma_f32_16x16x32_bf16 v[92:95], v[188:191], a[44:47], v[92:95]
v_mfma_f32_16x16x32_bf16 v[92:95], v[172:175], a[40:43], v[92:95]
v_mfma_f32_16x16x32_bf16 v[92:95], v[156:159], a[36:39], v[92:95]
s_waitcnt vmcnt(22) lgkmcnt(0)
v_mfma_f32_16x16x32_bf16 v[92:95], v[140:143], a[32:35], v[92:95]
s_barrier
v_mfma_f32_16x16x32_bf16 v[16:19], v[192:195], a[64:67], v[16:19]
s_nop 0
ds_read_b64_tr_b16 v[128:129], v8 offset:49152
ds_read_b64_tr_b16 v[130:131], v8 offset:51200
v_mfma_f32_16x16x32_bf16 v[16:19], v[208:211], a[68:71], v[16:19]
s_xor_b32 s71, s15, 0x180
ds_read_b64_tr_b16 v[132:133], v9 offset:49152
ds_read_b64_tr_b16 v[134:135], v9 offset:51200
v_mfma_f32_16x16x32_bf16 v[16:19], v[224:227], a[72:75], v[16:19]
s_add_u32 m0, s77, 49152
ds_read_b64_tr_b16 v[136:137], v10 offset:49152
ds_read_b64_tr_b16 v[138:139], v10 offset:51200
v_mfma_f32_16x16x32_bf16 v[16:19], v[240:243], a[76:79], v[16:19]
s_add_u32 s72, s71, 0
buffer_load_dwordx4 v15, s[24:27], s72 offen lds
v_mfma_f32_16x16x32_bf16 v[32:35], v[240:243], a[92:95], v[32:35]
buffer_load_dwordx4 a[136:139], v1, s[44:47], s69 offen offset:2048 sc1
v_mfma_f32_16x16x32_bf16 v[32:35], v[224:227], a[88:91], v[32:35]
s_nop 0
ds_read_b64_tr_b16 v[140:141], v11 offset:49152
ds_read_b64_tr_b16 v[142:143], v11 offset:51200
v_mfma_f32_16x16x32_bf16 v[32:35], v[208:211], a[84:87], v[32:35]
v_mfma_f32_16x16x32_bf16 v[32:35], v[192:195], a[80:83], v[32:35]
s_nop 0
ds_read_b64_tr_b16 v[144:145], v8 offset:53248
ds_read_b64_tr_b16 v[146:147], v8 offset:55296
v_mfma_f32_16x16x32_bf16 v[36:39], v[196:199], a[80:83], v[36:39]
s_add_u32 s72, s71, 15360
buffer_load_dwordx4 v15, s[24:27], s72 offen offset:1024 lds
v_mfma_f32_16x16x32_bf16 v[36:39], v[212:215], a[84:87], v[36:39]
s_nop 0
ds_read_b64_tr_b16 v[148:149], v9 offset:53248
ds_read_b64_tr_b16 v[150:151], v9 offset:55296
v_mfma_f32_16x16x32_bf16 v[36:39], v[228:231], a[88:91], v[36:39]
s_nop 0
ds_read_b64_tr_b16 v[152:153], v10 offset:53248
ds_read_b64_tr_b16 v[154:155], v10 offset:55296
v_mfma_f32_16x16x32_bf16 v[36:39], v[244:247], a[92:95], v[36:39]
s_nop 0
ds_read_b64_tr_b16 v[156:157], v11 offset:53248
ds_read_b64_tr_b16 v[158:159], v11 offset:55296
v_mfma_f32_16x16x32_bf16 v[20:23], v[244:247], a[76:79], v[20:23]
v_mfma_f32_16x16x32_bf16 v[20:23], v[228:231], a[72:75], v[20:23]
buffer_load_dwordx4 a[140:143], v1, s[44:47], s69 offen offset:3072 sc1
v_mfma_f32_16x16x32_bf16 v[20:23], v[212:215], a[68:71], v[20:23]
s_add_u32 s72, s71, 30720
buffer_load_dwordx4 v15, s[24:27], s72 offen offset:2048 lds
v_mfma_f32_16x16x32_bf16 v[20:23], v[196:199], a[64:67], v[20:23]
s_nop 0
ds_read_b64_tr_b16 v[160:161], v8 offset:57344
ds_read_b64_tr_b16 v[162:163], v8 offset:59392
v_mfma_f32_16x16x32_bf16 v[24:27], v[200:203], a[64:67], v[24:27]
s_nop 0
ds_read_b64_tr_b16 v[164:165], v9 offset:57344
ds_read_b64_tr_b16 v[166:167], v9 offset:59392
v_mfma_f32_16x16x32_bf16 v[24:27], v[216:219], a[68:71], v[24:27]
s_nop 0
ds_read_b64_tr_b16 v[168:169], v10 offset:57344
ds_read_b64_tr_b16 v[170:171], v10 offset:59392
v_mfma_f32_16x16x32_bf16 v[24:27], v[232:235], a[72:75], v[24:27]
s_nop 0
ds_read_b64_tr_b16 v[172:173], v11 offset:57344
ds_read_b64_tr_b16 v[174:175], v11 offset:59392
v_mfma_f32_16x16x32_bf16 v[24:27], v[248:251], a[76:79], v[24:27]
v_mfma_f32_16x16x32_bf16 v[40:43], v[248:251], a[92:95], v[40:43]
s_add_u32 s72, s71, 46080
buffer_load_dwordx4 v15, s[24:27], s72 offen offset:3072 lds
v_mfma_f32_16x16x32_bf16 v[40:43], v[232:235], a[88:91], v[40:43]
s_nop 0
ds_read_b64_tr_b16 v[176:177], v8 offset:61440
ds_read_b64_tr_b16 v[178:179], v8 offset:63488
v_mfma_f32_16x16x32_bf16 v[40:43], v[216:219], a[84:87], v[40:43]
s_nop 0
ds_read_b64_tr_b16 v[180:181], v9 offset:61440
ds_read_b64_tr_b16 v[182:183], v9 offset:63488
v_mfma_f32_16x16x32_bf16 v[40:43], v[200:203], a[80:83], v[40:43]
s_add_u32 s69, s69, 0x20000
buffer_load_dwordx4 a[144:147], v1, s[44:47], s69 offen sc1
v_mfma_f32_16x16x32_bf16 v[44:47], v[204:207], a[80:83], v[44:47]
s_nop 0
ds_read_b64_tr_b16 v[184:185], v10 offset:61440
ds_read_b64_tr_b16 v[186:187], v10 offset:63488
v_mfma_f32_16x16x32_bf16 v[44:47], v[220:223], a[84:87], v[44:47]
s_nop 0
ds_read_b64_tr_b16 v[188:189], v11 offset:61440
ds_read_b64_tr_b16 v[190:191], v11 offset:63488
v_mfma_f32_16x16x32_bf16 v[44:47], v[236:239], a[88:91], v[44:47]
v_mfma_f32_16x16x32_bf16 v[44:47], v[252:255], a[92:95], v[44:47]
s_xor_b32 s71, s12, 0x40080
v_mfma_f32_16x16x32_bf16 v[28:31], v[252:255], a[76:79], v[28:31]
s_add_u32 m0, s85, 0
v_xor_b32 v8, 0x10000, v8
v_mfma_f32_16x16x32_bf16 v[28:31], v[236:239], a[72:75], v[28:31]
s_add_u32 s72, s71, 0
v_xor_b32 v9, 0x10000, v9
v_mfma_f32_16x16x32_bf16 v[28:31], v[220:223], a[68:71], v[28:31]
s_waitcnt vmcnt(21) lgkmcnt(0)
buffer_load_dwordx4 v15, s[24:27], s72 offen lds
v_xor_b32 v10, 0x10000, v10
v_mfma_f32_16x16x32_bf16 v[28:31], v[204:207], a[64:67], v[28:31]
s_barrier
v_xor_b32 v11, 0x10000, v11
v_mfma_f32_16x16x32_bf16 v[48:51], v[128:131], a[64:67], v[48:51]
s_nop 0
ds_read_b64_tr_b16 v[192:193], v8 offset:0
ds_read_b64_tr_b16 v[194:195], v8 offset:2048
v_mfma_f32_16x16x32_bf16 v[48:51], v[144:147], a[68:71], v[48:51]
buffer_load_dwordx4 a[148:151], v1, s[44:47], s69 offen offset:1024 sc1
v_mfma_f32_16x16x32_bf16 v[48:51], v[160:163], a[72:75], v[48:51]
s_nop 0
ds_read_b64_tr_b16 v[196:197], v9 offset:0
ds_read_b64_tr_b16 v[198:199], v9 offset:2048
v_mfma_f32_16x16x32_bf16 v[48:51], v[176:179], a[76:79], v[48:51]
s_add_u32 s72, s71, 15360
buffer_load_dwordx4 v15, s[24:27], s72 offen offset:1024 lds
v_mfma_f32_16x16x32_bf16 v[64:67], v[176:179], a[92:95], v[64:67]
s_nop 0
ds_read_b64_tr_b16 v[200:201], v10 offset:0
ds_read_b64_tr_b16 v[202:203], v10 offset:2048
v_mfma_f32_16x16x32_bf16 v[64:67], v[160:163], a[88:91], v[64:67]
s_nop 0
ds_read_b64_tr_b16 v[204:205], v11 offset:0
ds_read_b64_tr_b16 v[206:207], v11 offset:2048
v_mfma_f32_16x16x32_bf16 v[64:67], v[144:147], a[84:87], v[64:67]
v_mfma_f32_16x16x32_bf16 v[64:67], v[128:131], a[80:83], v[64:67]
s_nop 0
ds_read_b64_tr_b16 v[208:209], v8 offset:4096
ds_read_b64_tr_b16 v[210:211], v8 offset:6144
v_mfma_f32_16x16x32_bf16 v[68:71], v[132:135], a[80:83], v[68:71]
s_nop 0
ds_read_b64_tr_b16 v[212:213], v9 offset:4096
ds_read_b64_tr_b16 v[214:215], v9 offset:6144
v_mfma_f32_16x16x32_bf16 v[68:71], v[148:151], a[84:87], v[68:71]
s_add_u32 s72, s71, 30720
buffer_load_dwordx4 v15, s[24:27], s72 offen offset:2048 lds
v_mfma_f32_16x16x32_bf16 v[68:71], v[164:167], a[88:91], v[68:71]
s_nop 0
ds_read_b64_tr_b16 v[216:217], v10 offset:4096
ds_read_b64_tr_b16 v[218:219], v10 offset:6144
v_mfma_f32_16x16x32_bf16 v[68:71], v[180:183], a[92:95], v[68:71]
buffer_load_dwordx4 a[152:155], v1, s[44:47], s69 offen offset:2048 sc1
v_mfma_f32_16x16x32_bf16 v[52:55], v[180:183], a[76:79], v[52:55]
s_nop 0
ds_read_b64_tr_b16 v[220:221], v11 offset:4096
ds_read_b64_tr_b16 v[222:223], v11 offset:6144
v_mfma_f32_16x16x32_bf16 v[52:55], v[164:167], a[72:75], v[52:55]
v_mfma_f32_16x16x32_bf16 v[52:55], v[148:151], a[68:71], v[52:55]
s_nop 0
ds_read_b64_tr_b16 v[224:225], v8 offset:8192
ds_read_b64_tr_b16 v[226:227], v8 offset:10240
v_mfma_f32_16x16x32_bf16 v[52:55], v[132:135], a[64:67], v[52:55]
s_add_u32 s72, s71, 46080
buffer_load_dwordx4 v15, s[24:27], s72 offen offset:3072 lds
v_mfma_f32_16x16x32_bf16 v[56:59], v[136:139], a[64:67], v[56:59]
s_nop 0
ds_read_b64_tr_b16 v[228:229], v9 offset:8192
ds_read_b64_tr_b16 v[230:231], v9 offset:10240
v_mfma_f32_16x16x32_bf16 v[56:59], v[152:155], a[68:71], v[56:59]
s_nop 0
ds_read_b64_tr_b16 v[232:233], v10 offset:8192
ds_read_b64_tr_b16 v[234:235], v10 offset:10240
v_mfma_f32_16x16x32_bf16 v[56:59], v[168:171], a[72:75], v[56:59]
s_nop 0
ds_read_b64_tr_b16 v[236:237], v11 offset:8192
ds_read_b64_tr_b16 v[238:239], v11 offset:10240
v_mfma_f32_16x16x32_bf16 v[56:59], v[184:187], a[76:79], v[56:59]
v_mfma_f32_16x16x32_bf16 v[72:75], v[184:187], a[92:95], v[72:75]
s_nop 0
ds_read_b64_tr_b16 v[240:241], v8 offset:12288
ds_read_b64_tr_b16 v[242:243], v8 offset:14336
v_mfma_f32_16x16x32_bf16 v[72:75], v[168:171], a[88:91], v[72:75]
buffer_load_dwordx4 a[156:159], v1, s[44:47], s69 offen offset:3072 sc1
v_mfma_f32_16x16x32_bf16 v[72:75], v[152:155], a[84:87], v[72:75]
s_lshr_b32 s69, s13, 18
ds_read_b64_tr_b16 v[244:245], v9 offset:12288
ds_read_b64_tr_b16 v[246:247], v9 offset:14336
v_mfma_f32_16x16x32_bf16 v[72:75], v[136:139], a[80:83], v[72:75]
s_xor_b32 s71, s12, 0x40100
ds_read_b64_tr_b16 v[248:249], v10 offset:12288
ds_read_b64_tr_b16 v[250:251], v10 offset:14336
v_mfma_f32_16x16x32_bf16 v[76:79], v[140:143], a[80:83], v[76:79]
s_add_u32 m0, s85, 16384
ds_read_b64_tr_b16 v[252:253], v11 offset:12288
ds_read_b64_tr_b16 v[254:255], v11 offset:14336
v_mfma_f32_16x16x32_bf16 v[76:79], v[156:159], a[84:87], v[76:79]
s_add_u32 s72, s71, 0
buffer_load_dwordx4 v15, s[24:27], s72 offen lds
v_mfma_f32_16x16x32_bf16 v[76:79], v[172:175], a[88:91], v[76:79]
s_lshl_b32 s69, s69, 12
v_mfma_f32_16x16x32_bf16 v[76:79], v[188:191], a[92:95], v[76:79]
s_add_u32 s69, s69, s95
v_mfma_f32_16x16x32_bf16 v[60:63], v[188:191], a[76:79], v[60:63]
s_xor_b32 s69, s69, 0x1000
v_mfma_f32_16x16x32_bf16 v[60:63], v[172:175], a[72:75], v[60:63]
s_add_u32 s72, s71, 15360
v_mfma_f32_16x16x32_bf16 v[60:63], v[156:159], a[68:71], v[60:63]
s_waitcnt vmcnt(16) lgkmcnt(0)
buffer_load_dwordx4 a[160:163], v1, s[44:47], s69 offen sc1
v_mfma_f32_16x16x32_bf16 v[60:63], v[140:143], a[64:67], v[60:63]
s_barrier
buffer_load_dwordx4 v15, s[24:27], s72 offen offset:1024 lds
v_mfma_f32_16x16x32_bf16 v[80:83], v[192:195], a[64:67], v[80:83]
s_and_b32 s79, s91, 0xffff9fff
v_lshrrev_b32 v13, 4, v0
v_lshlrev_b32 v13, 13, v13
buffer_load_dword v14, v13, s[44:47], s79 offen sc1
v_mfma_f32_16x16x32_bf16 v[80:83], v[208:211], a[68:71], v[80:83]
s_nop 0
ds_read_b64_tr_b16 v[128:129], v8 offset:16384
ds_read_b64_tr_b16 v[130:131], v8 offset:18432
v_mfma_f32_16x16x32_bf16 v[80:83], v[224:227], a[72:75], v[80:83]
s_nop 0
ds_read_b64_tr_b16 v[132:133], v9 offset:16384
ds_read_b64_tr_b16 v[134:135], v9 offset:18432
v_mfma_f32_16x16x32_bf16 v[80:83], v[240:243], a[76:79], v[80:83]
s_nop 0
ds_read_b64_tr_b16 v[136:137], v10 offset:16384
ds_read_b64_tr_b16 v[138:139], v10 offset:18432
v_mfma_f32_16x16x32_bf16 v[96:99], v[240:243], a[92:95], v[96:99]
s_nop 0
ds_read_b64_tr_b16 v[140:141], v11 offset:16384
ds_read_b64_tr_b16 v[142:143], v11 offset:18432
v_mfma_f32_16x16x32_bf16 v[96:99], v[224:227], a[88:91], v[96:99]
s_add_u32 s72, s71, 30720
buffer_load_dwordx4 v15, s[24:27], s72 offen offset:2048 lds
v_mfma_f32_16x16x32_bf16 v[96:99], v[208:211], a[84:87], v[96:99]
v_mfma_f32_16x16x32_bf16 v[96:99], v[192:195], a[80:83], v[96:99]
s_nop 0
ds_read_b64_tr_b16 v[144:145], v8 offset:20480
ds_read_b64_tr_b16 v[146:147], v8 offset:22528
v_mfma_f32_16x16x32_bf16 v[100:103], v[196:199], a[80:83], v[100:103]
Lstube1:
s_cbranch_execz Lstube5
buffer_load_dwordx4 a[164:167], v1, s[44:47], s69 offen offset:1024 sc1
v_mfma_f32_16x16x32_bf16 v[100:103], v[212:215], a[84:87], v[100:103]
s_nop 0
ds_read_b64_tr_b16 v[148:149], v9 offset:20480
ds_read_b64_tr_b16 v[150:151], v9 offset:22528
v_mfma_f32_16x16x32_bf16 v[100:103], v[228:231], a[88:91], v[100:103]
s_nop 0
ds_read_b64_tr_b16 v[152:153], v10 offset:20480
ds_read_b64_tr_b16 v[154:155], v10 offset:22528
v_mfma_f32_16x16x32_bf16 v[100:103], v[244:247], a[92:95], v[100:103]
s_add_u32 s72, s71, 46080
buffer_load_dwordx4 v15, s[24:27], s72 offen offset:3072 lds
v_mfma_f32_16x16x32_bf16 v[84:87], v[244:247], a[76:79], v[84:87]
s_nop 0
ds_read_b64_tr_b16 v[156:157], v11 offset:20480
ds_read_b64_tr_b16 v[158:159], v11 offset:22528
v_mfma_f32_16x16x32_bf16 v[84:87], v[228:231], a[72:75], v[84:87]
v_mfma_f32_16x16x32_bf16 v[84:87], v[212:215], a[68:71], v[84:87]
s_nop 0
ds_read_b64_tr_b16 v[160:161], v8 offset:24576
ds_read_b64_tr_b16 v[162:163], v8 offset:26624
v_mfma_f32_16x16x32_bf16 v[84:87], v[196:199], a[64:67], v[84:87]
s_nop 0
ds_read_b64_tr_b16 v[164:165], v9 offset:24576
ds_read_b64_tr_b16 v[166:167], v9 offset:26624
v_mfma_f32_16x16x32_bf16 v[88:91], v[200:203], a[64:67], v[88:91]
s_nop 0
ds_read_b64_tr_b16 v[168:169], v10 offset:24576
ds_read_b64_tr_b16 v[170:171], v10 offset:26624
v_mfma_f32_16x16x32_bf16 v[88:91], v[216:219], a[68:71], v[88:91]
s_nop 0
ds_read_b64_tr_b16 v[172:173], v11 offset:24576
ds_read_b64_tr_b16 v[174:175], v11 offset:26624
v_mfma_f32_16x16x32_bf16 v[88:91], v[232:235], a[72:75], v[88:91]
buffer_load_dwordx4 a[168:171], v1, s[44:47], s69 offen offset:2048 sc1
v_mfma_f32_16x16x32_bf16 v[88:91], v[248:251], a[76:79], v[88:91]
s_xor_b32 s71, s12, 0x40180
v_mfma_f32_16x16x32_bf16 v[104:107], v[248:251], a[92:95], v[104:107]
s_add_u32 m0, s85, 32768
ds_read_b64_tr_b16 v[176:177], v8 offset:28672
ds_read_b64_tr_b16 v[178:179], v8 offset:30720
v_mfma_f32_16x16x32_bf16 v[104:107], v[232:235], a[88:91], v[104:107]
s_add_u32 s72, s71, 0
buffer_load_dwordx4 v15, s[24:27], s72 offen lds
v_mfma_f32_16x16x32_bf16 v[104:107], v[216:219], a[84:87], v[104:107]
s_nop 0
ds_read_b64_tr_b16 v[180:181], v9 offset:28672
ds_read_b64_tr_b16 v[182:183], v9 offset:30720
v_mfma_f32_16x16x32_bf16 v[104:107], v[200:203], a[80:83], v[104:107]
s_nop 0
ds_read_b64_tr_b16 v[184:185], v10 offset:28672
ds_read_b64_tr_b16 v[186:187], v10 offset:30720
v_mfma_f32_16x16x32_bf16 v[108:111], v[204:207], a[80:83], v[108:111]
s_nop 0
ds_read_b64_tr_b16 v[188:189], v11 offset:28672
ds_read_b64_tr_b16 v[190:191], v11 offset:30720
v_mfma_f32_16x16x32_bf16 v[108:111], v[220:223], a[84:87], v[108:111]
v_mfma_f32_16x16x32_bf16 v[108:111], v[236:239], a[88:91], v[108:111]
s_add_u32 s72, s71, 15360
buffer_load_dwordx4 v15, s[24:27], s72 offen offset:1024 lds
v_mfma_f32_16x16x32_bf16 v[108:111], v[252:255], a[92:95], v[108:111]
v_mfma_f32_16x16x32_bf16 v[92:95], v[252:255], a[76:79], v[92:95]
buffer_load_dwordx4 a[172:175], v1, s[44:47], s69 offen offset:3072 sc1
v_mfma_f32_16x16x32_bf16 v[92:95], v[236:239], a[72:75], v[92:95]
v_mfma_f32_16x16x32_bf16 v[92:95], v[220:223], a[68:71], v[92:95]
s_waitcnt vmcnt(31) lgkmcnt(0)
v_mfma_f32_16x16x32_bf16 v[92:95], v[204:207], a[64:67], v[92:95]
v_mfma_f32_16x16x32_bf16 v[16:19], v[128:131], a[96:99], v[16:19]
s_add_u32 s72, s71, 30720
buffer_load_dwordx4 v15, s[24:27], s72 offen offset:2048 lds
v_mfma_f32_16x16x32_bf16 v[16:19], v[144:147], a[100:103], v[16:19]
s_nop 0
ds_read_b64_tr_b16 v[192:193], v8 offset:32768
ds_read_b64_tr_b16 v[194:195], v8 offset:34816
v_mfma_f32_16x16x32_bf16 v[16:19], v[160:163], a[104:107], v[16:19]
s_nop 0
ds_read_b64_tr_b16 v[196:197], v9 offset:32768
ds_read_b64_tr_b16 v[198:199], v9 offset:34816
v_mfma_f32_16x16x32_bf16 v[16:19], v[176:179], a[108:111], v[16:19]
s_nop 0
ds_read_b64_tr_b16 v[200:201], v10 offset:32768
ds_read_b64_tr_b16 v[202:203], v10 offset:34816
v_mfma_f32_16x16x32_bf16 v[32:35], v[176:179], a[124:127], v[32:35]
s_nop 0
ds_read_b64_tr_b16 v[204:205], v11 offset:32768
ds_read_b64_tr_b16 v[206:207], v11 offset:34816
v_mfma_f32_16x16x32_bf16 v[32:35], v[160:163], a[120:123], v[32:35]
v_mfma_f32_16x16x32_bf16 v[32:35], v[144:147], a[116:119], v[32:35]
s_add_u32 s72, s71, 46080
buffer_load_dwordx4 v15, s[24:27], s72 offen offset:3072 lds
v_mfma_f32_16x16x32_bf16 v[32:35], v[128:131], a[112:115], v[32:35]
s_add_u32 s69, s69, 0x20000
buffer_load_dwordx4 a[176:179], v1, s[44:47], s69 offen sc1
v_mfma_f32_16x16x32_bf16 v[36:39], v[132:135], a[112:115], v[36:39]
s_nop 0
ds_read_b64_tr_b16 v[208:209], v8 offset:36864
ds_read_b64_tr_b16 v[210:211], v8 offset:38912
v_mfma_f32_16x16x32_bf16 v[36:39], v[148:151], a[116:119], v[36:39]
s_nop 0
ds_read_b64_tr_b16 v[212:213], v9 offset:36864
ds_read_b64_tr_b16 v[214:215], v9 offset:38912
v_mfma_f32_16x16x32_bf16 v[36:39], v[164:167], a[120:123], v[36:39]
s_nop 0
ds_read_b64_tr_b16 v[216:217], v10 offset:36864
ds_read_b64_tr_b16 v[218:219], v10 offset:38912
v_mfma_f32_16x16x32_bf16 v[36:39], v[180:183], a[124:127], v[36:39]
s_nop 0
ds_read_b64_tr_b16 v[220:221], v11 offset:36864
ds_read_b64_tr_b16 v[222:223], v11 offset:38912
v_mfma_f32_16x16x32_bf16 v[20:23], v[180:183], a[108:111], v[20:23]
v_mfma_f32_16x16x32_bf16 v[20:23], v[164:167], a[104:107], v[20:23]
s_nop 0
ds_read_b64_tr_b16 v[224:225], v8 offset:40960
ds_read_b64_tr_b16 v[226:227], v8 offset:43008
v_mfma_f32_16x16x32_bf16 v[20:23], v[148:151], a[100:103], v[20:23]
s_xor_b32 s71, s13, 0x40080
ds_read_b64_tr_b16 v[228:229], v9 offset:40960
ds_read_b64_tr_b16 v[230:231], v9 offset:43008
v_mfma_f32_16x16x32_bf16 v[20:23], v[132:135], a[96:99], v[20:23]
s_add_u32 m0, s85, 49152
ds_read_b64_tr_b16 v[232:233], v10 offset:40960
ds_read_b64_tr_b16 v[234:235], v10 offset:43008
v_mfma_f32_16x16x32_bf16 v[24:27], v[136:139], a[96:99], v[24:27]
s_add_u32 s72, s71, 0
buffer_load_dwordx4 v15, s[24:27], s72 offen lds
v_mfma_f32_16x16x32_bf16 v[24:27], v[152:155], a[100:103], v[24:27]
buffer_load_dwordx4 a[180:183], v1, s[44:47], s69 offen offset:1024 sc1
v_mfma_f32_16x16x32_bf16 v[24:27], v[168:171], a[104:107], v[24:27]
s_nop 0
ds_read_b64_tr_b16 v[236:237], v11 offset:40960
ds_read_b64_tr_b16 v[238:239], v11 offset:43008
v_mfma_f32_16x16x32_bf16 v[24:27], v[184:187], a[108:111], v[24:27]
v_mfma_f32_16x16x32_bf16 v[40:43], v[184:187], a[124:127], v[40:43]
s_nop 0
ds_read_b64_tr_b16 v[240:241], v8 offset:45056
ds_read_b64_tr_b16 v[242:243], v8 offset:47104
v_mfma_f32_16x16x32_bf16 v[40:43], v[168:171], a[120:123], v[40:43]
s_nop 0
ds_read_b64_tr_b16 v[244:245], v9 offset:45056
ds_read_b64_tr_b16 v[246:247], v9 offset:47104
v_mfma_f32_16x16x32_bf16 v[40:43], v[152:155], a[116:119], v[40:43]
s_add_u32 s72, s71, 15360
buffer_load_dwordx4 v15, s[24:27], s72 offen offset:1024 lds
v_mfma_f32_16x16x32_bf16 v[40:43], v[136:139], a[112:115], v[40:43]
s_nop 0
ds_read_b64_tr_b16 v[248:249], v10 offset:45056
ds_read_b64_tr_b16 v[250:251], v10 offset:47104
v_mfma_f32_16x16x32_bf16 v[44:47], v[140:143], a[112:115], v[44:47]
s_nop 0
ds_read_b64_tr_b16 v[252:253], v11 offset:45056
ds_read_b64_tr_b16 v[254:255], v11 offset:47104
v_mfma_f32_16x16x32_bf16 v[44:47], v[156:159], a[116:119], v[44:47]
v_mfma_f32_16x16x32_bf16 v[44:47], v[172:175], a[120:123], v[44:47]
buffer_load_dwordx4 a[184:187], v1, s[44:47], s69 offen offset:2048 sc1
v_mfma_f32_16x16x32_bf16 v[44:47], v[188:191], a[124:127], v[44:47]
v_mfma_f32_16x16x32_bf16 v[28:31], v[188:191], a[108:111], v[28:31]
s_add_u32 s72, s71, 30720
buffer_load_dwordx4 v15, s[24:27], s72 offen offset:2048 lds
v_mfma_f32_16x16x32_bf16 v[28:31], v[172:175], a[104:107], v[28:31]
v_mfma_f32_16x16x32_bf16 v[28:31], v[156:159], a[100:103], v[28:31]
s_waitcnt vmcnt(20) lgkmcnt(0)
v_mfma_f32_16x16x32_bf16 v[28:31], v[140:143], a[96:99], v[28:31]
s_barrier
v_mfma_f32_16x16x32_bf16 v[48:51], v[192:195], a[96:99], v[48:51]
s_nop 0
ds_read_b64_tr_b16 v[128:129], v8 offset:49152
ds_read_b64_tr_b16 v[130:131], v8 offset:51200
v_mfma_f32_16x16x32_bf16 v[48:51], v[208:211], a[100:103], v[48:51]
s_nop 0
ds_read_b64_tr_b16 v[132:133], v9 offset:49152
ds_read_b64_tr_b16 v[134:135], v9 offset:51200
v_mfma_f32_16x16x32_bf16 v[48:51], v[224:227], a[104:107], v[48:51]
s_add_u32 s72, s71, 46080
buffer_load_dwordx4 v15, s[24:27], s72 offen offset:3072 lds
v_mfma_f32_16x16x32_bf16 v[48:51], v[240:243], a[108:111], v[48:51]
s_nop 0
ds_read_b64_tr_b16 v[136:137], v10 offset:49152
ds_read_b64_tr_b16 v[138:139], v10 offset:51200
v_mfma_f32_16x16x32_bf16 v[64:67], v[240:243], a[124:127], v[64:67]
buffer_load_dwordx4 a[188:191], v1, s[44:47], s69 offen offset:3072 sc1
v_mfma_f32_16x16x32_bf16 v[64:67], v[224:227], a[120:123], v[64:67]
s_nop 0
ds_read_b64_tr_b16 v[140:141], v11 offset:49152
ds_read_b64_tr_b16 v[142:143], v11 offset:51200
v_mfma_f32_16x16x32_bf16 v[64:67], v[208:211], a[116:119], v[64:67]
s_nop 0
ds_read_b64_tr_b16 v[144:145], v8 offset:53248
ds_read_b64_tr_b16 v[146:147], v8 offset:55296
v_mfma_f32_16x16x32_bf16 v[64:67], v[192:195], a[112:115], v[64:67]
s_nop 0
ds_read_b64_tr_b16 v[148:149], v9 offset:53248
ds_read_b64_tr_b16 v[150:151], v9 offset:55296
v_mfma_f32_16x16x32_bf16 v[68:71], v[196:199], a[112:115], v[68:71]
s_lshr_b32 s69, s14, 18
v_mfma_f32_16x16x32_bf16 v[68:71], v[212:215], a[116:119], v[68:71]
s_lshl_b32 s69, s69, 12
ds_read_b64_tr_b16 v[152:153], v10 offset:53248
ds_read_b64_tr_b16 v[154:155], v10 offset:55296
v_mfma_f32_16x16x32_bf16 v[68:71], v[228:231], a[120:123], v[68:71]
s_xor_b32 s71, s14, 0x40080
ds_read_b64_tr_b16 v[156:157], v11 offset:53248
ds_read_b64_tr_b16 v[158:159], v11 offset:55296
v_mfma_f32_16x16x32_bf16 v[68:71], v[244:247], a[124:127], v[68:71]
s_add_u32 m0, s77, 0
ds_read_b64_tr_b16 v[160:161], v8 offset:57344
ds_read_b64_tr_b16 v[162:163], v8 offset:59392
v_mfma_f32_16x16x32_bf16 v[52:55], v[244:247], a[108:111], v[52:55]
s_add_u32 s72, s71, 0
buffer_load_dwordx4 v15, s[24:27], s72 offen lds
v_mfma_f32_16x16x32_bf16 v[52:55], v[228:231], a[104:107], v[52:55]
s_add_u32 s69, s69, s95
ds_read_b64_tr_b16 v[164:165], v9 offset:57344
ds_read_b64_tr_b16 v[166:167], v9 offset:59392
v_mfma_f32_16x16x32_bf16 v[52:55], v[212:215], a[100:103], v[52:55]
s_xor_b32 s69, s69, 0x1000
buffer_load_dwordx4 a[192:195], v1, s[44:47], s69 offen sc1
v_mfma_f32_16x16x32_bf16 v[52:55], v[196:199], a[96:99], v[52:55]
s_nop 0
ds_read_b64_tr_b16 v[168:169], v10 offset:57344
ds_read_b64_tr_b16 v[170:171], v10 offset:59392
v_mfma_f32_16x16x32_bf16 v[56:59], v[200:203], a[96:99], v[56:59]
s_waitcnt vmcnt(19)
v_cmp_gt_u32 vcc, 2, v14
s_cbranch_vccnz Lspin112
Lback113:
v_mfma_f32_16x16x32_bf16 v[56:59], v[216:219], a[100:103], v[56:59]
s_add_u32 s72, s71, 15360
buffer_load_dwordx4 v15, s[24:27], s72 offen offset:1024 lds
v_mfma_f32_16x16x32_bf16 v[56:59], v[232:235], a[104:107], v[56:59]
v_mfma_f32_16x16x32_bf16 v[56:59], v[248:251], a[108:111], v[56:59]
s_nop 0
ds_read_b64_tr_b16 v[172:173], v11 offset:57344
ds_read_b64_tr_b16 v[174:175], v11 offset:59392
v_mfma_f32_16x16x32_bf16 v[72:75], v[248:251], a[124:127], v[72:75]
s_nop 0
ds_read_b64_tr_b16 v[176:177], v8 offset:61440
ds_read_b64_tr_b16 v[178:179], v8 offset:63488
v_mfma_f32_16x16x32_bf16 v[72:75], v[232:235], a[120:123], v[72:75]
s_nop 0
ds_read_b64_tr_b16 v[180:181], v9 offset:61440
ds_read_b64_tr_b16 v[182:183], v9 offset:63488
v_mfma_f32_16x16x32_bf16 v[72:75], v[216:219], a[116:119], v[72:75]
s_nop 0
ds_read_b64_tr_b16 v[184:185], v10 offset:61440
ds_read_b64_tr_b16 v[186:187], v10 offset:63488
v_mfma_f32_16x16x32_bf16 v[72:75], v[200:203], a[112:115], v[72:75]
s_add_u32 s72, s71, 30720
buffer_load_dwordx4 v15, s[24:27], s72 offen offset:2048 lds
v_mfma_f32_16x16x32_bf16 v[76:79], v[204:207], a[112:115], v[76:79]
buffer_load_dwordx4 a[196:199], v1, s[44:47], s69 offen offset:1024 sc1
v_mfma_f32_16x16x32_bf16 v[76:79], v[220:223], a[116:119], v[76:79]
s_nop 0
ds_read_b64_tr_b16 v[188:189], v11 offset:61440
ds_read_b64_tr_b16 v[190:191], v11 offset:63488
v_mfma_f32_16x16x32_bf16 v[76:79], v[236:239], a[120:123], v[76:79]
v_mfma_f32_16x16x32_bf16 v[76:79], v[252:255], a[124:127], v[76:79]
v_mfma_f32_16x16x32_bf16 v[60:63], v[252:255], a[108:111], v[60:63]
v_xor_b32 v8, 0x10000, v8
v_mfma_f32_16x16x32_bf16 v[60:63], v[236:239], a[104:107], v[60:63]
s_add_u32 s72, s71, 46080
buffer_load_dwordx4 v15, s[24:27], s72 offen offset:3072 lds
v_xor_b32 v9, 0x10000, v9
v_mfma_f32_16x16x32_bf16 v[60:63], v[220:223], a[100:103], v[60:63]
s_waitcnt lgkmcnt(0)
v_xor_b32 v10, 0x10000, v10
v_mfma_f32_16x16x32_bf16 v[60:63], v[204:207], a[96:99], v[60:63]
v_xor_b32 v11, 0x10000, v11
v_mfma_f32_16x16x32_bf16 v[80:83], v[128:131], a[96:99], v[80:83]
s_lshl_b32 s84, s76, 11
ds_read_b64_tr_b16 v[192:193], v8 offset:0
ds_read_b64_tr_b16 v[194:195], v8 offset:2048
v_mfma_f32_16x16x32_bf16 v[80:83], v[144:147], a[100:103], v[80:83]
s_add_u32 s84, s84, 0x3810000
ds_read_b64_tr_b16 v[196:197], v9 offset:0
ds_read_b64_tr_b16 v[198:199], v9 offset:2048
v_mfma_f32_16x16x32_bf16 v[80:83], v[160:163], a[104:107], v[80:83]
buffer_load_dwordx4 a[200:203], v1, s[44:47], s69 offen offset:2048 sc1
v_mfma_f32_16x16x32_bf16 v[80:83], v[176:179], a[108:111], v[80:83]
s_nop 0
ds_read_b64_tr_b16 v[200:201], v10 offset:0
ds_read_b64_tr_b16 v[202:203], v10 offset:2048
v_mfma_f32_16x16x32_bf16 v[96:99], v[176:179], a[124:127], v[96:99]
s_nop 0
ds_read_b64_tr_b16 v[204:205], v11 offset:0
ds_read_b64_tr_b16 v[206:207], v11 offset:2048
v_mfma_f32_16x16x32_bf16 v[96:99], v[160:163], a[120:123], v[96:99]
s_xor_b32 s71, s15, 0x40080
v_lshrrev_b32 v115, 2, v0
v_lshlrev_b32 v115, 7, v115
v_mfma_f32_16x16x32_bf16 v[96:99], v[144:147], a[116:119], v[96:99]
s_add_u32 m0, s77, 16384
ds_read_b64_tr_b16 v[208:209], v8 offset:4096
ds_read_b64_tr_b16 v[210:211], v8 offset:6144
v_mfma_f32_16x16x32_bf16 v[96:99], v[128:131], a[112:115], v[96:99]
s_add_u32 s72, s71, 0
buffer_load_dwordx4 v15, s[24:27], s72 offen lds
v_mfma_f32_16x16x32_bf16 v[100:103], v[132:135], a[112:115], v[100:103]
s_nop 0
ds_read_b64_tr_b16 v[212:213], v9 offset:4096
ds_read_b64_tr_b16 v[214:215], v9 offset:6144
v_mfma_f32_16x16x32_bf16 v[100:103], v[148:151], a[116:119], v[100:103]
s_nop 0
ds_read_b64_tr_b16 v[216:217], v10 offset:4096
ds_read_b64_tr_b16 v[218:219], v10 offset:6144
v_mfma_f32_16x16x32_bf16 v[100:103], v[164:167], a[120:123], v[100:103]
s_nop 0
ds_read_b64_tr_b16 v[220:221], v11 offset:4096
ds_read_b64_tr_b16 v[222:223], v11 offset:6144
v_mfma_f32_16x16x32_bf16 v[100:103], v[180:183], a[124:127], v[100:103]
buffer_load_dword v114, v115, s[44:47], s84 offen sc1
v_mfma_f32_16x16x32_bf16 v[84:87], v[180:183], a[108:111], v[84:87]
buffer_load_dwordx4 a[204:207], v1, s[44:47], s69 offen offset:3072 sc1
v_mfma_f32_16x16x32_bf16 v[84:87], v[164:167], a[104:107], v[84:87]
s_add_u32 s72, s71, 15360
buffer_load_dwordx4 v15, s[24:27], s72 offen offset:1024 lds
v_mfma_f32_16x16x32_bf16 v[84:87], v[148:151], a[100:103], v[84:87]
s_nop 0
ds_read_b64_tr_b16 v[224:225], v8 offset:8192
ds_read_b64_tr_b16 v[226:227], v8 offset:10240
v_mfma_f32_16x16x32_bf16 v[84:87], v[132:135], a[96:99], v[84:87]
s_nop 0
ds_read_b64_tr_b16 v[228:229], v9 offset:8192
ds_read_b64_tr_b16 v[230:231], v9 offset:10240
v_mfma_f32_16x16x32_bf16 v[88:91], v[136:139], a[96:99], v[88:91]
s_nop 0
ds_read_b64_tr_b16 v[232:233], v10 offset:8192
ds_read_b64_tr_b16 v[234:235], v10 offset:10240
v_mfma_f32_16x16x32_bf16 v[88:91], v[152:155], a[100:103], v[88:91]
s_nop 0
ds_read_b64_tr_b16 v[236:237], v11 offset:8192
ds_read_b64_tr_b16 v[238:239], v11 offset:10240
v_mfma_f32_16x16x32_bf16 v[88:91], v[168:171], a[104:107], v[88:91]
v_mfma_f32_16x16x32_bf16 v[88:91], v[184:187], a[108:111], v[88:91]
s_add_u32 s72, s71, 30720
buffer_load_dwordx4 v15, s[24:27], s72 offen offset:2048 lds
v_mfma_f32_16x16x32_bf16 v[104:107], v[184:187], a[124:127], v[104:107]
s_nop 0
ds_read_b64_tr_b16 v[240:241], v8 offset:12288
ds_read_b64_tr_b16 v[242:243], v8 offset:14336
v_mfma_f32_16x16x32_bf16 v[104:107], v[168:171], a[120:123], v[104:107]
s_nop 0
ds_read_b64_tr_b16 v[244:245], v9 offset:12288
ds_read_b64_tr_b16 v[246:247], v9 offset:14336
v_mfma_f32_16x16x32_bf16 v[104:107], v[152:155], a[116:119], v[104:107]
s_add_u32 s69, s69, 0x20000
buffer_load_dwordx4 a[208:211], v1, s[44:47], s69 offen sc1
v_mfma_f32_16x16x32_bf16 v[104:107], v[136:139], a[112:115], v[104:107]
s_nop 0
ds_read_b64_tr_b16 v[248:249], v10 offset:12288
ds_read_b64_tr_b16 v[250:251], v10 offset:14336
v_mfma_f32_16x16x32_bf16 v[108:111], v[140:143], a[112:115], v[108:111]
s_nop 0
ds_read_b64_tr_b16 v[252:253], v11 offset:12288
ds_read_b64_tr_b16 v[254:255], v11 offset:14336
v_mfma_f32_16x16x32_bf16 v[108:111], v[156:159], a[116:119], v[108:111]
s_add_u32 s72, s71, 46080
buffer_load_dwordx4 v15, s[24:27], s72 offen offset:3072 lds
v_mfma_f32_16x16x32_bf16 v[108:111], v[172:175], a[120:123], v[108:111]
v_mfma_f32_16x16x32_bf16 v[108:111], v[188:191], a[124:127], v[108:111]
v_mfma_f32_16x16x32_bf16 v[92:95], v[188:191], a[108:111], v[92:95]
v_mfma_f32_16x16x32_bf16 v[92:95], v[172:175], a[104:107], v[92:95]
v_mfma_f32_16x16x32_bf16 v[92:95], v[156:159], a[100:103], v[92:95]
s_waitcnt vmcnt(22) lgkmcnt(0)
v_mfma_f32_16x16x32_bf16 v[92:95], v[140:143], a[96:99], v[92:95]
s_barrier
v_mfma_f32_16x16x32_bf16 v[16:19], v[192:195], a[128:131], v[16:19]
buffer_load_dwordx4 a[212:215], v1, s[44:47], s69 offen offset:1024 sc1
v_mfma_f32_16x16x32_bf16 v[16:19], v[208:211], a[132:135], v[16:19]
s_xor_b32 s71, s13, 0x40100
ds_read_b64_tr_b16 v[128:129], v8 offset:16384
ds_read_b64_tr_b16 v[130:131], v8 offset:18432
v_mfma_f32_16x16x32_bf16 v[16:19], v[224:227], a[136:139], v[16:19]
s_add_u32 m0, s77, 32768
ds_read_b64_tr_b16 v[132:133], v9 offset:16384
ds_read_b64_tr_b16 v[134:135], v9 offset:18432
v_mfma_f32_16x16x32_bf16 v[16:19], v[240:243], a[140:143], v[16:19]
s_add_u32 s72, s71, 0
buffer_load_dwordx4 v15, s[24:27], s72 offen lds
v_mfma_f32_16x16x32_bf16 v[32:35], v[240:243], a[156:159], v[32:35]
s_nop 0
ds_read_b64_tr_b16 v[136:137], v10 offset:16384
ds_read_b64_tr_b16 v[138:139], v10 offset:18432
v_mfma_f32_16x16x32_bf16 v[32:35], v[224:227], a[152:155], v[32:35]
s_nop 0
ds_read_b64_tr_b16 v[140:141], v11 offset:16384
ds_read_b64_tr_b16 v[142:143], v11 offset:18432
v_mfma_f32_16x16x32_bf16 v[32:35], v[208:211], a[148:151], v[32:35]
v_mfma_f32_16x16x32_bf16 v[32:35], v[192:195], a[144:147], v[32:35]
s_nop 0
ds_read_b64_tr_b16 v[144:145], v8 offset:20480
ds_read_b64_tr_b16 v[146:147], v8 offset:22528
v_mfma_f32_16x16x32_bf16 v[36:39], v[196:199], a[144:147], v[36:39]
s_add_u32 s72, s71, 15360
buffer_load_dwordx4 v15, s[24:27], s72 offen offset:1024 lds
v_mfma_f32_16x16x32_bf16 v[36:39], v[212:215], a[148:151], v[36:39]
s_nop 0
ds_read_b64_tr_b16 v[148:149], v9 offset:20480
ds_read_b64_tr_b16 v[150:151], v9 offset:22528
v_mfma_f32_16x16x32_bf16 v[36:39], v[228:231], a[152:155], v[36:39]
buffer_load_dwordx4 a[216:219], v1, s[44:47], s69 offen offset:2048 sc1
v_mfma_f32_16x16x32_bf16 v[36:39], v[244:247], a[156:159], v[36:39]
s_nop 0
ds_read_b64_tr_b16 v[152:153], v10 offset:20480
ds_read_b64_tr_b16 v[154:155], v10 offset:22528
v_mfma_f32_16x16x32_bf16 v[20:23], v[244:247], a[140:143], v[20:23]
s_nop 0
ds_read_b64_tr_b16 v[156:157], v11 offset:20480
ds_read_b64_tr_b16 v[158:159], v11 offset:22528
v_mfma_f32_16x16x32_bf16 v[20:23], v[228:231], a[136:139], v[20:23]
v_mfma_f32_16x16x32_bf16 v[20:23], v[212:215], a[132:135], v[20:23]
s_add_u32 s72, s71, 30720
buffer_load_dwordx4 v15, s[24:27], s72 offen offset:2048 lds
v_mfma_f32_16x16x32_bf16 v[20:23], v[196:199], a[128:131], v[20:23]
s_nop 0
ds_read_b64_tr_b16 v[160:161], v8 offset:24576
ds_read_b64_tr_b16 v[162:163], v8 offset:26624
v_mfma_f32_16x16x32_bf16 v[24:27], v[200:203], a[128:131], v[24:27]
s_nop 0
ds_read_b64_tr_b16 v[164:165], v9 offset:24576
ds_read_b64_tr_b16 v[166:167], v9 offset:26624
v_mfma_f32_16x16x32_bf16 v[24:27], v[216:219], a[132:135], v[24:27]
s_nop 0
ds_read_b64_tr_b16 v[168:169], v10 offset:24576
ds_read_b64_tr_b16 v[170:171], v10 offset:26624
v_mfma_f32_16x16x32_bf16 v[24:27], v[232:235], a[136:139], v[24:27]
s_nop 0
ds_read_b64_tr_b16 v[172:173], v11 offset:24576
ds_read_b64_tr_b16 v[174:175], v11 offset:26624
v_mfma_f32_16x16x32_bf16 v[24:27], v[248:251], a[140:143], v[24:27]
v_mfma_f32_16x16x32_bf16 v[40:43], v[248:251], a[156:159], v[40:43]
s_add_u32 s72, s71, 46080
buffer_load_dwordx4 v15, s[24:27], s72 offen offset:3072 lds
v_mfma_f32_16x16x32_bf16 v[40:43], v[232:235], a[152:155], v[40:43]
buffer_load_dwordx4 a[220:223], v1, s[44:47], s69 offen offset:3072 sc1
v_mfma_f32_16x16x32_bf16 v[40:43], v[216:219], a[148:151], v[40:43]
s_nop 0
ds_read_b64_tr_b16 v[176:177], v8 offset:28672
ds_read_b64_tr_b16 v[178:179], v8 offset:30720
v_mfma_f32_16x16x32_bf16 v[40:43], v[200:203], a[144:147], v[40:43]
s_lshr_b32 s69, s15, 18
ds_read_b64_tr_b16 v[180:181], v9 offset:28672
ds_read_b64_tr_b16 v[182:183], v9 offset:30720
v_mfma_f32_16x16x32_bf16 v[44:47], v[204:207], a[144:147], v[44:47]
s_lshl_b32 s69, s69, 12
ds_read_b64_tr_b16 v[184:185], v10 offset:28672
ds_read_b64_tr_b16 v[186:187], v10 offset:30720
v_mfma_f32_16x16x32_bf16 v[44:47], v[220:223], a[148:151], v[44:47]
s_add_u32 s69, s69, s95
ds_read_b64_tr_b16 v[188:189], v11 offset:28672
ds_read_b64_tr_b16 v[190:191], v11 offset:30720
v_mfma_f32_16x16x32_bf16 v[44:47], v[236:239], a[152:155], v[44:47]
s_xor_b32 s69, s69, 0x1000
v_mfma_f32_16x16x32_bf16 v[44:47], v[252:255], a[156:159], v[44:47]
s_xor_b32 s71, s14, 0x40100
v_mfma_f32_16x16x32_bf16 v[28:31], v[252:255], a[140:143], v[28:31]
s_add_u32 m0, s77, 49152
v_mfma_f32_16x16x32_bf16 v[28:31], v[236:239], a[136:139], v[28:31]
s_add_u32 s72, s71, 0
v_mfma_f32_16x16x32_bf16 v[28:31], v[220:223], a[132:135], v[28:31]
s_waitcnt lgkmcnt(0)
buffer_load_dwordx4 v15, s[24:27], s72 offen lds
v_mfma_f32_16x16x32_bf16 v[28:31], v[204:207], a[128:131], v[28:31]
buffer_load_dwordx4 a[224:227], v1, s[44:47], s69 offen sc1
v_mfma_f32_16x16x32_bf16 v[48:51], v[128:131], a[128:131], v[48:51]
s_nop 0
ds_read_b64_tr_b16 v[192:193], v8 offset:32768
ds_read_b64_tr_b16 v[194:195], v8 offset:34816
v_mfma_f32_16x16x32_bf16 v[48:51], v[144:147], a[132:135], v[48:51]
s_nop 0
ds_read_b64_tr_b16 v[196:197], v9 offset:32768
ds_read_b64_tr_b16 v[198:199], v9 offset:34816
v_mfma_f32_16x16x32_bf16 v[48:51], v[160:163], a[136:139], v[48:51]
s_nop 0
ds_read_b64_tr_b16 v[200:201], v10 offset:32768
ds_read_b64_tr_b16 v[202:203], v10 offset:34816
v_mfma_f32_16x16x32_bf16 v[48:51], v[176:179], a[140:143], v[48:51]
s_add_u32 s72, s71, 15360
buffer_load_dwordx4 v15, s[24:27], s72 offen offset:1024 lds
v_mfma_f32_16x16x32_bf16 v[64:67], v[176:179], a[156:159], v[64:67]
s_nop 0
ds_read_b64_tr_b16 v[204:205], v11 offset:32768
ds_read_b64_tr_b16 v[206:207], v11 offset:34816
v_mfma_f32_16x16x32_bf16 v[64:67], v[160:163], a[152:155], v[64:67]
v_mfma_f32_16x16x32_bf16 v[64:67], v[144:147], a[148:151], v[64:67]
s_nop 0
ds_read_b64_tr_b16 v[208:209], v8 offset:36864
ds_read_b64_tr_b16 v[210:211], v8 offset:38912
v_mfma_f32_16x16x32_bf16 v[64:67], v[128:131], a[144:147], v[64:67]
s_nop 0
ds_read_b64_tr_b16 v[212:213], v9 offset:36864
ds_read_b64_tr_b16 v[214:215], v9 offset:38912
v_mfma_f32_16x16x32_bf16 v[68:71], v[132:135], a[144:147], v[68:71]
buffer_load_dwordx4 a[228:231], v1, s[44:47], s69 offen offset:1024 sc1
v_mfma_f32_16x16x32_bf16 v[68:71], v[148:151], a[148:151], v[68:71]
s_add_u32 s72, s71, 30720
buffer_load_dwordx4 v15, s[24:27], s72 offen offset:2048 lds
v_mfma_f32_16x16x32_bf16 v[68:71], v[164:167], a[152:155], v[68:71]
s_nop 0
ds_read_b64_tr_b16 v[216:217], v10 offset:36864
ds_read_b64_tr_b16 v[218:219], v10 offset:38912
v_mfma_f32_16x16x32_bf16 v[68:71], v[180:183], a[156:159], v[68:71]
v_mfma_f32_16x16x32_bf16 v[52:55], v[180:183], a[140:143], v[52:55]
s_nop 0
ds_read_b64_tr_b16 v[220:221], v11 offset:36864
ds_read_b64_tr_b16 v[222:223], v11 offset:38912
v_mfma_f32_16x16x32_bf16 v[52:55], v[164:167], a[136:139], v[52:55]
s_nop 0
ds_read_b64_tr_b16 v[224:225], v8 offset:40960
ds_read_b64_tr_b16 v[226:227], v8 offset:43008
v_mfma_f32_16x16x32_bf16 v[52:55], v[148:151], a[132:135], v[52:55]
s_nop 0
ds_read_b64_tr_b16 v[228:229], v9 offset:40960
ds_read_b64_tr_b16 v[230:231], v9 offset:43008
v_mfma_f32_16x16x32_bf16 v[52:55], v[132:135], a[128:131], v[52:55]
s_add_u32 s72, s71, 46080
buffer_load_dwordx4 v15, s[24:27], s72 offen offset:3072 lds
v_mfma_f32_16x16x32_bf16 v[56:59], v[136:139], a[128:131], v[56:59]
v_mfma_f32_16x16x32_bf16 v[56:59], v[152:155], a[132:135], v[56:59]
s_nop 0
ds_read_b64_tr_b16 v[232:233], v10 offset:40960
ds_read_b64_tr_b16 v[234:235], v10 offset:43008
v_mfma_f32_16x16x32_bf16 v[56:59], v[168:171], a[136:139], v[56:59]
buffer_load_dwordx4 a[232:235], v1, s[44:47], s69 offen offset:2048 sc1
v_mfma_f32_16x16x32_bf16 v[56:59], v[184:187], a[140:143], v[56:59]
s_nop 0
ds_read_b64_tr_b16 v[236:237], v11 offset:40960
ds_read_b64_tr_b16 v[238:239], v11 offset:43008
v_mfma_f32_16x16x32_bf16 v[72:75], v[184:187], a[156:159], v[72:75]
s_nop 0
ds_read_b64_tr_b16 v[240:241], v8 offset:45056
ds_read_b64_tr_b16 v[242:243], v8 offset:47104
v_mfma_f32_16x16x32_bf16 v[72:75], v[168:171], a[152:155], v[72:75]
v_mfma_f32_16x16x32_bf16 v[72:75], v[152:155], a[148:151], v[72:75]
s_nop 0
ds_read_b64_tr_b16 v[244:245], v9 offset:45056
ds_read_b64_tr_b16 v[246:247], v9 offset:47104
v_mfma_f32_16x16x32_bf16 v[72:75], v[136:139], a[144:147], v[72:75]
s_xor_b32 s71, s15, 0x40100
ds_read_b64_tr_b16 v[248:249], v10 offset:45056
ds_read_b64_tr_b16 v[250:251], v10 offset:47104
v_mfma_f32_16x16x32_bf16 v[76:79], v[140:143], a[144:147], v[76:79]
s_add_u32 m0, s85, 0
ds_read_b64_tr_b16 v[252:253], v11 offset:45056
ds_read_b64_tr_b16 v[254:255], v11 offset:47104
v_mfma_f32_16x16x32_bf16 v[76:79], v[156:159], a[148:151], v[76:79]
s_add_u32 s72, s71, 0
buffer_load_dwordx4 v15, s[24:27], s72 offen lds
v_mfma_f32_16x16x32_bf16 v[76:79], v[172:175], a[152:155], v[76:79]
v_mfma_f32_16x16x32_bf16 v[76:79], v[188:191], a[156:159], v[76:79]
v_mfma_f32_16x16x32_bf16 v[60:63], v[188:191], a[140:143], v[60:63]
buffer_load_dwordx4 a[236:239], v1, s[44:47], s69 offen offset:3072 sc1
v_mfma_f32_16x16x32_bf16 v[60:63], v[172:175], a[136:139], v[60:63]
s_add_u32 s72, s71, 15360
v_mfma_f32_16x16x32_bf16 v[60:63], v[156:159], a[132:135], v[60:63]
s_waitcnt vmcnt(24) lgkmcnt(0)
v_mfma_f32_16x16x32_bf16 v[60:63], v[140:143], a[128:131], v[60:63]
s_barrier
buffer_load_dwordx4 v15, s[24:27], s72 offen offset:1024 lds
v_mfma_f32_16x16x32_bf16 v[80:83], v[192:195], a[128:131], v[80:83]
s_nop 0
ds_read_b64_tr_b16 v[128:129], v8 offset:49152
ds_read_b64_tr_b16 v[130:131], v8 offset:51200
v_mfma_f32_16x16x32_bf16 v[80:83], v[208:211], a[132:135], v[80:83]
s_nop 0
ds_read_b64_tr_b16 v[132:133], v9 offset:49152
ds_read_b64_tr_b16 v[134:135], v9 offset:51200
v_mfma_f32_16x16x32_bf16 v[80:83], v[224:227], a[136:139], v[80:83]
s_nop 0
ds_read_b64_tr_b16 v[136:137], v10 offset:49152
ds_read_b64_tr_b16 v[138:139], v10 offset:51200
Lstube2:
s_cbranch_execz Lrete
s_waitcnt vmcnt(22)
v_cmp_gt_u32 vcc, 3, v114
s_cbranch_vccnz Lspin109
Lback110:
v_mfma_f32_16x16x32_bf16 v[80:83], v[240:243], a[140:143], v[80:83]
s_lshl_b32 s73, s76, 18
ds_read_b64_tr_b16 v[140:141], v11 offset:49152
ds_read_b64_tr_b16 v[142:143], v11 offset:51200
v_mfma_f32_16x16x32_bf16 v[96:99], v[240:243], a[156:159], v[96:99]
s_lshl_b32 s84, s58, 16
v_mfma_f32_16x16x32_bf16 v[96:99], v[224:227], a[152:155], v[96:99]
s_add_u32 s72, s71, 30720
buffer_load_dwordx4 v15, s[24:27], s72 offen offset:2048 lds
v_mfma_f32_16x16x32_bf16 v[96:99], v[208:211], a[148:151], v[96:99]
s_add_u32 s69, s69, 0x20000
buffer_load_dwordx4 a[240:243], v1, s[44:47], s69 offen sc1
v_mfma_f32_16x16x32_bf16 v[96:99], v[192:195], a[144:147], v[96:99]
s_add_u32 s73, s73, s84
ds_read_b64_tr_b16 v[144:145], v8 offset:53248
ds_read_b64_tr_b16 v[146:147], v8 offset:55296
v_mfma_f32_16x16x32_bf16 v[100:103], v[196:199], a[144:147], v[100:103]
s_lshl_b32 s84, s75, 8
ds_read_b64_tr_b16 v[148:149], v9 offset:53248
ds_read_b64_tr_b16 v[150:151], v9 offset:55296
v_mfma_f32_16x16x32_bf16 v[100:103], v[212:215], a[148:151], v[100:103]
s_add_u32 s73, s73, s84
ds_read_b64_tr_b16 v[152:153], v10 offset:53248
ds_read_b64_tr_b16 v[154:155], v10 offset:55296
v_mfma_f32_16x16x32_bf16 v[100:103], v[228:231], a[152:155], v[100:103]
s_add_u32 s73, s73, 0x3400000
v_lshrrev_b32 v112, 4, v0
v_and_b32 v113, 15, v0
v_mfma_f32_16x16x32_bf16 v[100:103], v[244:247], a[156:159], v[100:103]
s_add_u32 s72, s71, 46080
buffer_load_dwordx4 v15, s[24:27], s72 offen offset:3072 lds
v_mfma_f32_16x16x32_bf16 v[84:87], v[244:247], a[140:143], v[84:87]
s_nop 0
ds_read_b64_tr_b16 v[156:157], v11 offset:53248
ds_read_b64_tr_b16 v[158:159], v11 offset:55296
v_mfma_f32_16x16x32_bf16 v[84:87], v[228:231], a[136:139], v[84:87]
s_nop 0
ds_read_b64_tr_b16 v[160:161], v8 offset:57344
ds_read_b64_tr_b16 v[162:163], v8 offset:59392
v_mfma_f32_16x16x32_bf16 v[84:87], v[212:215], a[132:135], v[84:87]
s_nop 0
ds_read_b64_tr_b16 v[164:165], v9 offset:57344
ds_read_b64_tr_b16 v[166:167], v9 offset:59392
v_mfma_f32_16x16x32_bf16 v[84:87], v[196:199], a[128:131], v[84:87]
v_xor_b32 v12, v113, v112
v_lshlrev_b32 v12, 4, v12
v_mfma_f32_16x16x32_bf16 v[88:91], v[200:203], a[128:131], v[88:91]
buffer_load_dwordx4 a[244:247], v1, s[44:47], s69 offen offset:1024 sc1
v_mfma_f32_16x16x32_bf16 v[88:91], v[216:219], a[132:135], v[88:91]
s_nop 0
ds_read_b64_tr_b16 v[168:169], v10 offset:57344
ds_read_b64_tr_b16 v[170:171], v10 offset:59392
v_mfma_f32_16x16x32_bf16 v[88:91], v[232:235], a[136:139], v[88:91]
s_nop 0
ds_read_b64_tr_b16 v[172:173], v11 offset:57344
ds_read_b64_tr_b16 v[174:175], v11 offset:59392
v_mfma_f32_16x16x32_bf16 v[88:91], v[248:251], a[140:143], v[88:91]
s_xor_b32 s71, s13, 0x40180
ds_read_b64_tr_b16 v[176:177], v8 offset:61440
ds_read_b64_tr_b16 v[178:179], v8 offset:63488
v_mfma_f32_16x16x32_bf16 v[104:107], v[248:251], a[156:159], v[104:107]
s_add_u32 m0, s85, 16384
v_lshl_add_u32 v112, v112, 12, v12
v_xor_b32 v12, 64, v112
v_mfma_f32_16x16x32_bf16 v[104:107], v[232:235], a[152:155], v[104:107]
s_add_u32 s72, s71, 0
buffer_load_dwordx4 v15, s[24:27], s72 offen lds
v_mfma_f32_16x16x32_bf16 v[104:107], v[216:219], a[148:151], v[104:107]
s_nop 0
ds_read_b64_tr_b16 v[180:181], v9 offset:61440
ds_read_b64_tr_b16 v[182:183], v9 offset:63488
v_mfma_f32_16x16x32_bf16 v[104:107], v[200:203], a[144:147], v[104:107]
s_nop 0
ds_read_b64_tr_b16 v[184:185], v10 offset:61440
ds_read_b64_tr_b16 v[186:187], v10 offset:63488
v_mfma_f32_16x16x32_bf16 v[108:111], v[204:207], a[144:147], v[108:111]
s_nop 0
ds_read_b64_tr_b16 v[188:189], v11 offset:61440
ds_read_b64_tr_b16 v[190:191], v11 offset:63488
v_mfma_f32_16x16x32_bf16 v[108:111], v[220:223], a[148:151], v[108:111]
v_lshlrev_b32 v113, 2, v113
v_mfma_f32_16x16x32_bf16 v[108:111], v[236:239], a[152:155], v[108:111]
s_add_u32 s72, s71, 15360
buffer_load_dwordx4 v15, s[24:27], s72 offen offset:1024 lds
v_mfma_f32_16x16x32_bf16 v[108:111], v[252:255], a[156:159], v[108:111]
buffer_load_dwordx4 a[248:251], v1, s[44:47], s69 offen offset:2048 sc1
v_mfma_f32_16x16x32_bf16 v[92:95], v[252:255], a[140:143], v[92:95]
v_xor_b32 v8, 0x10000, v8
v_mfma_f32_16x16x32_bf16 v[92:95], v[236:239], a[136:139], v[92:95]
v_xor_b32 v9, 0x10000, v9
v_mfma_f32_16x16x32_bf16 v[92:95], v[220:223], a[132:135], v[92:95]
s_waitcnt vmcnt(38) lgkmcnt(0)
v_xor_b32 v10, 0x10000, v10
v_mfma_f32_16x16x32_bf16 v[92:95], v[204:207], a[128:131], v[92:95]
v_xor_b32 v11, 0x10000, v11
v_mfma_f32_16x16x32_bf16 v[16:19], v[128:131], a[160:163], v[16:19]
s_add_u32 s72, s71, 30720
buffer_load_dwordx4 v15, s[24:27], s72 offen offset:2048 lds
v_mfma_f32_16x16x32_bf16 v[16:19], v[144:147], a[164:167], v[16:19]
s_nop 0
ds_read_b64_tr_b16 v[192:193], v8 offset:0
ds_read_b64_tr_b16 v[194:195], v8 offset:2048
v_mfma_f32_16x16x32_bf16 v[16:19], v[160:163], a[168:171], v[16:19]
s_nop 0
ds_read_b64_tr_b16 v[196:197], v9 offset:0
ds_read_b64_tr_b16 v[198:199], v9 offset:2048
v_mfma_f32_16x16x32_bf16 v[16:19], v[176:179], a[172:175], v[16:19]
s_nop 0
ds_read_b64_tr_b16 v[200:201], v10 offset:0
ds_read_b64_tr_b16 v[202:203], v10 offset:2048
v_mfma_f32_16x16x32_bf16 v[32:35], v[176:179], a[188:191], v[32:35]
buffer_load_dwordx4 a[252:255], v1, s[44:47], s69 offen offset:3072 sc1
v_mfma_f32_16x16x32_bf16 v[32:35], v[160:163], a[184:187], v[32:35]
v_mfma_f32_16x16x32_bf16 v[32:35], v[144:147], a[180:183], v[32:35]
s_add_u32 s72, s71, 46080
buffer_load_dwordx4 v15, s[24:27], s72 offen offset:3072 lds
v_mfma_f32_16x16x32_bf16 v[32:35], v[128:131], a[176:179], v[32:35]
s_nop 0
ds_read_b64_tr_b16 v[204:205], v11 offset:0
ds_read_b64_tr_b16 v[206:207], v11 offset:2048
v_mfma_f32_16x16x32_bf16 v[36:39], v[132:135], a[176:179], v[36:39]
s_nop 0
ds_read_b64_tr_b16 v[208:209], v8 offset:4096
ds_read_b64_tr_b16 v[210:211], v8 offset:6144
v_mfma_f32_16x16x32_bf16 v[36:39], v[148:151], a[180:183], v[36:39]
s_nop 0
ds_read_b64_tr_b16 v[212:213], v9 offset:4096
ds_read_b64_tr_b16 v[214:215], v9 offset:6144
v_mfma_f32_16x16x32_bf16 v[36:39], v[164:167], a[184:187], v[36:39]
v_mfma_f32_16x16x32_bf16 v[36:39], v[180:183], a[188:191], v[36:39]
s_nop 0
ds_read_b64_tr_b16 v[216:217], v10 offset:4096
ds_read_b64_tr_b16 v[218:219], v10 offset:6144
v_mfma_f32_16x16x32_bf16 v[20:23], v[180:183], a[172:175], v[20:23]
s_nop 0
ds_read_b64_tr_b16 v[220:221], v11 offset:4096
ds_read_b64_tr_b16 v[222:223], v11 offset:6144
v_mfma_f32_16x16x32_bf16 v[20:23], v[164:167], a[168:171], v[20:23]
v_mfma_f32_16x16x32_bf16 v[20:23], v[148:151], a[164:167], v[20:23]
s_xor_b32 s71, s14, 0x40180
ds_read_b64_tr_b16 v[224:225], v8 offset:8192
ds_read_b64_tr_b16 v[226:227], v8 offset:10240
v_mfma_f32_16x16x32_bf16 v[20:23], v[132:135], a[160:163], v[20:23]
s_add_u32 m0, s85, 32768
ds_read_b64_tr_b16 v[228:229], v9 offset:8192
ds_read_b64_tr_b16 v[230:231], v9 offset:10240
v_mfma_f32_16x16x32_bf16 v[24:27], v[136:139], a[160:163], v[24:27]
s_add_u32 s72, s71, 0
buffer_load_dwordx4 v15, s[24:27], s72 offen lds
v_mfma_f32_16x16x32_bf16 v[24:27], v[152:155], a[164:167], v[24:27]
s_nop 0
ds_read_b64_tr_b16 v[232:233], v10 offset:8192
ds_read_b64_tr_b16 v[234:235], v10 offset:10240
v_mfma_f32_16x16x32_bf16 v[24:27], v[168:171], a[168:171], v[24:27]
v_mfma_f32_16x16x32_bf16 v[24:27], v[184:187], a[172:175], v[24:27]
s_nop 0
ds_read_b64_tr_b16 v[236:237], v11 offset:8192
ds_read_b64_tr_b16 v[238:239], v11 offset:10240
v_mfma_f32_16x16x32_bf16 v[40:43], v[184:187], a[188:191], v[40:43]
s_nop 0
ds_read_b64_tr_b16 v[240:241], v8 offset:12288
ds_read_b64_tr_b16 v[242:243], v8 offset:14336
v_mfma_f32_16x16x32_bf16 v[40:43], v[168:171], a[184:187], v[40:43]
s_nop 0
ds_read_b64_tr_b16 v[244:245], v9 offset:12288
ds_read_b64_tr_b16 v[246:247], v9 offset:14336
v_mfma_f32_16x16x32_bf16 v[40:43], v[152:155], a[180:183], v[40:43]
s_add_u32 s72, s71, 15360
buffer_load_dwordx4 v15, s[24:27], s72 offen offset:1024 lds
v_mfma_f32_16x16x32_bf16 v[40:43], v[136:139], a[176:179], v[40:43]
v_mfma_f32_16x16x32_bf16 v[44:47], v[140:143], a[176:179], v[44:47]
s_nop 0
ds_read_b64_tr_b16 v[248:249], v10 offset:12288
ds_read_b64_tr_b16 v[250:251], v10 offset:14336
v_mfma_f32_16x16x32_bf16 v[44:47], v[156:159], a[180:183], v[44:47]
s_nop 0
ds_read_b64_tr_b16 v[252:253], v11 offset:12288
ds_read_b64_tr_b16 v[254:255], v11 offset:14336
v_mfma_f32_16x16x32_bf16 v[44:47], v[172:175], a[184:187], v[44:47]
v_mfma_f32_16x16x32_bf16 v[44:47], v[188:191], a[188:191], v[44:47]
v_mfma_f32_16x16x32_bf16 v[28:31], v[188:191], a[172:175], v[28:31]
s_add_u32 s72, s71, 30720
buffer_load_dwordx4 v15, s[24:27], s72 offen offset:2048 lds
v_mfma_f32_16x16x32_bf16 v[28:31], v[172:175], a[168:171], v[28:31]
v_mfma_f32_16x16x32_bf16 v[28:31], v[156:159], a[164:167], v[28:31]
s_waitcnt vmcnt(23) lgkmcnt(0)
v_mfma_f32_16x16x32_bf16 v[28:31], v[140:143], a[160:163], v[28:31]
s_barrier
v_mfma_f32_16x16x32_bf16 v[16:19], v[192:195], a[192:195], v[16:19]
s_nop 0
ds_read_b64_tr_b16 v[128:129], v8 offset:16384
ds_read_b64_tr_b16 v[130:131], v8 offset:18432
v_mfma_f32_16x16x32_bf16 v[16:19], v[208:211], a[196:199], v[16:19]
s_nop 0
ds_read_b64_tr_b16 v[132:133], v9 offset:16384
ds_read_b64_tr_b16 v[134:135], v9 offset:18432
v_mfma_f32_16x16x32_bf16 v[16:19], v[224:227], a[200:203], v[16:19]
s_add_u32 s72, s71, 46080
buffer_load_dwordx4 v15, s[24:27], s72 offen offset:3072 lds
v_mfma_f32_16x16x32_bf16 v[16:19], v[240:243], a[204:207], v[16:19]
s_nop 0
ds_read_b64_tr_b16 v[136:137], v10 offset:16384
ds_read_b64_tr_b16 v[138:139], v10 offset:18432
v_mfma_f32_16x16x32_bf16 v[32:35], v[240:243], a[220:223], v[32:35]
s_nop 0
ds_read_b64_tr_b16 v[140:141], v11 offset:16384
ds_read_b64_tr_b16 v[142:143], v11 offset:18432
v_mfma_f32_16x16x32_bf16 v[32:35], v[224:227], a[216:219], v[32:35]
v_mfma_f32_16x16x32_bf16 v[32:35], v[208:211], a[212:215], v[32:35]
s_nop 0
ds_read_b64_tr_b16 v[144:145], v8 offset:20480
ds_read_b64_tr_b16 v[146:147], v8 offset:22528
v_mfma_f32_16x16x32_bf16 v[32:35], v[192:195], a[208:211], v[32:35]
s_nop 0
ds_read_b64_tr_b16 v[148:149], v9 offset:20480
ds_read_b64_tr_b16 v[150:151], v9 offset:22528
v_mfma_f32_16x16x32_bf16 v[36:39], v[196:199], a[208:211], v[36:39]
s_nop 0
ds_read_b64_tr_b16 v[152:153], v10 offset:20480
ds_read_b64_tr_b16 v[154:155], v10 offset:22528
v_mfma_f32_16x16x32_bf16 v[36:39], v[212:215], a[212:215], v[36:39]
s_nop 0
ds_read_b64_tr_b16 v[156:157], v11 offset:20480
ds_read_b64_tr_b16 v[158:159], v11 offset:22528
v_mfma_f32_16x16x32_bf16 v[36:39], v[228:231], a[216:219], v[36:39]
v_mfma_f32_16x16x32_bf16 v[36:39], v[244:247], a[220:223], v[36:39]
s_add_u32 m0, s64, 147456
ds_read_b64_tr_b16 v[160:161], v8 offset:24576
ds_read_b64_tr_b16 v[162:163], v8 offset:26624
v_mfma_f32_16x16x32_bf16 v[20:23], v[244:247], a[204:207], v[20:23]
s_add_u32 s72, s73, 0
buffer_load_dwordx4 v112, s[44:47], s72 offen sc1 lds
v_mfma_f32_16x16x32_bf16 v[20:23], v[228:231], a[200:203], v[20:23]
s_nop 0
ds_read_b64_tr_b16 v[164:165], v9 offset:24576
ds_read_b64_tr_b16 v[166:167], v9 offset:26624
v_mfma_f32_16x16x32_bf16 v[20:23], v[212:215], a[196:199], v[20:23]
s_add_u32 s72, s73, 15360
buffer_load_dwordx4 v12, s[44:47], s72 offen offset:1024 sc1 lds
v_mfma_f32_16x16x32_bf16 v[20:23], v[196:199], a[192:195], v[20:23]
s_nop 0
ds_read_b64_tr_b16 v[168:169], v10 offset:24576
ds_read_b64_tr_b16 v[170:171], v10 offset:26624
v_mfma_f32_16x16x32_bf16 v[24:27], v[200:203], a[192:195], v[24:27]
s_nop 0
ds_read_b64_tr_b16 v[172:173], v11 offset:24576
ds_read_b64_tr_b16 v[174:175], v11 offset:26624
v_mfma_f32_16x16x32_bf16 v[24:27], v[216:219], a[196:199], v[24:27]
s_add_u32 s72, s73, 30720
buffer_load_dwordx4 v112, s[44:47], s72 offen offset:2048 sc1 lds
v_mfma_f32_16x16x32_bf16 v[24:27], v[232:235], a[200:203], v[24:27]
v_mfma_f32_16x16x32_bf16 v[24:27], v[248:251], a[204:207], v[24:27]
s_nop 0
ds_read_b64_tr_b16 v[176:177], v8 offset:28672
ds_read_b64_tr_b16 v[178:179], v8 offset:30720
v_mfma_f32_16x16x32_bf16 v[40:43], v[248:251], a[220:223], v[40:43]
s_add_u32 s72, s73, 46080
buffer_load_dwordx4 v12, s[44:47], s72 offen offset:3072 sc1 lds
v_mfma_f32_16x16x32_bf16 v[40:43], v[232:235], a[216:219], v[40:43]
s_xor_b32 s71, s15, 0x40180
ds_read_b64_tr_b16 v[180:181], v9 offset:28672
ds_read_b64_tr_b16 v[182:183], v9 offset:30720
v_mfma_f32_16x16x32_bf16 v[40:43], v[216:219], a[212:215], v[40:43]
s_add_u32 m0, s85, 49152
ds_read_b64_tr_b16 v[184:185], v10 offset:28672
ds_read_b64_tr_b16 v[186:187], v10 offset:30720
v_mfma_f32_16x16x32_bf16 v[40:43], v[200:203], a[208:211], v[40:43]
s_add_u32 s72, s71, 0
buffer_load_dwordx4 v15, s[24:27], s72 offen lds
v_mfma_f32_16x16x32_bf16 v[44:47], v[204:207], a[208:211], v[44:47]
s_nop 0
ds_read_b64_tr_b16 v[188:189], v11 offset:28672
ds_read_b64_tr_b16 v[190:191], v11 offset:30720
v_mfma_f32_16x16x32_bf16 v[44:47], v[220:223], a[212:215], v[44:47]
v_mfma_f32_16x16x32_bf16 v[44:47], v[236:239], a[216:219], v[44:47]
s_add_u32 s72, s71, 15360
buffer_load_dwordx4 v15, s[24:27], s72 offen offset:1024 lds
v_mfma_f32_16x16x32_bf16 v[44:47], v[252:255], a[220:223], v[44:47]
v_mfma_f32_16x16x32_bf16 v[28:31], v[252:255], a[204:207], v[28:31]
v_mfma_f32_16x16x32_bf16 v[28:31], v[236:239], a[200:203], v[28:31]
s_add_u32 s72, s71, 30720
buffer_load_dwordx4 v15, s[24:27], s72 offen offset:2048 lds
v_mfma_f32_16x16x32_bf16 v[28:31], v[220:223], a[196:199], v[28:31]
s_waitcnt vmcnt(12) lgkmcnt(0)
v_mfma_f32_16x16x32_bf16 v[28:31], v[204:207], a[192:195], v[28:31]
v_mfma_f32_16x16x32_bf16 v[16:19], v[128:131], a[224:227], v[16:19]
s_add_u32 s72, s71, 46080
buffer_load_dwordx4 v15, s[24:27], s72 offen offset:3072 lds
v_mfma_f32_16x16x32_bf16 v[16:19], v[144:147], a[228:231], v[16:19]
s_lshl_b32 s73, s75, 9
ds_read_b64_tr_b16 v[192:193], v8 offset:32768
ds_read_b64_tr_b16 v[194:195], v8 offset:34816
v_mfma_f32_16x16x32_bf16 v[16:19], v[160:163], a[232:235], v[16:19]
s_lshl_b32 s84, s58, 7
ds_read_b64_tr_b16 v[196:197], v9 offset:32768
ds_read_b64_tr_b16 v[198:199], v9 offset:34816
v_mfma_f32_16x16x32_bf16 v[16:19], v[176:179], a[236:239], v[16:19]
s_add_u32 s73, s73, s84
ds_read_b64_tr_b16 v[200:201], v10 offset:32768
ds_read_b64_tr_b16 v[202:203], v10 offset:34816
v_mfma_f32_16x16x32_bf16 v[20:23], v[180:183], a[236:239], v[20:23]
s_add_u32 s73, s73, 0x3800000
ds_read_b64_tr_b16 v[204:205], v11 offset:32768
ds_read_b64_tr_b16 v[206:207], v11 offset:34816
v_mfma_f32_16x16x32_bf16 v[20:23], v[164:167], a[232:235], v[20:23]
s_xor_b32 s71, s12, 0x0
buffer_load_dword v6, v113, s[44:47], s73 offen sc1
v_mfma_f32_16x16x32_bf16 v[20:23], v[148:151], a[228:231], v[20:23]
s_add_u32 m0, s77, 0
ds_read_b64_tr_b16 v[208:209], v8 offset:36864
ds_read_b64_tr_b16 v[210:211], v8 offset:38912
v_mfma_f32_16x16x32_bf16 v[20:23], v[132:135], a[224:227], v[20:23]
s_add_u32 s72, s71, 0
buffer_load_dwordx4 v15, s[24:27], s72 offen lds
v_mfma_f32_16x16x32_bf16 v[24:27], v[136:139], a[224:227], v[24:27]
s_nop 0
ds_read_b64_tr_b16 v[212:213], v9 offset:36864
ds_read_b64_tr_b16 v[214:215], v9 offset:38912
v_mfma_f32_16x16x32_bf16 v[24:27], v[152:155], a[228:231], v[24:27]
s_nop 0
ds_read_b64_tr_b16 v[216:217], v10 offset:36864
ds_read_b64_tr_b16 v[218:219], v10 offset:38912
v_mfma_f32_16x16x32_bf16 v[24:27], v[168:171], a[232:235], v[24:27]
buffer_load_dword v7, v113, s[44:47], s73 offen offset:64 sc1
v_mfma_f32_16x16x32_bf16 v[24:27], v[184:187], a[236:239], v[24:27]
s_nop 0
ds_read_b64_tr_b16 v[220:221], v11 offset:36864
ds_read_b64_tr_b16 v[222:223], v11 offset:38912
v_cvt_pk_bf16_f32 v16, v16, v17
v_mfma_f32_16x16x32_bf16 v[28:31], v[188:191], a[236:239], v[28:31]
s_nop 0
ds_read_b64_tr_b16 v[224:225], v8 offset:40960
ds_read_b64_tr_b16 v[226:227], v8 offset:43008
v_cvt_pk_bf16_f32 v17, v18, v19
v_mfma_f32_16x16x32_bf16 v[28:31], v[172:175], a[232:235], v[28:31]
s_add_u32 s72, s71, 15360
buffer_load_dwordx4 v15, s[24:27], s72 offen offset:1024 lds
v_cvt_pk_bf16_f32 v18, v20, v21
v_mfma_f32_16x16x32_bf16 v[28:31], v[156:159], a[228:231], v[28:31]
s_nop 0
ds_read_b64_tr_b16 v[228:229], v9 offset:40960
ds_read_b64_tr_b16 v[230:231], v9 offset:43008
v_cvt_pk_bf16_f32 v19, v22, v23
v_mfma_f32_16x16x32_bf16 v[28:31], v[140:143], a[224:227], v[28:31]
v_mfma_f32_16x16x32_bf16 v[32:35], v[128:131], a[240:243], v[32:35]
s_xor_b32 s80, s93, 0x100000
ds_read_b64_tr_b16 v[232:233], v10 offset:40960
ds_read_b64_tr_b16 v[234:235], v10 offset:43008
v_mfma_f32_16x16x32_bf16 v[32:35], v[144:147], a[244:247], v[32:35]
s_add_u32 s80, s80, 0x3a00000
buffer_store_dwordx4 v[16:19], v1, s[44:47], s80 offen sc1
v_mfma_f32_16x16x32_bf16 v[32:35], v[160:163], a[248:251], v[32:35]
s_nop 0
ds_read_b64_tr_b16 v[236:237], v11 offset:40960
ds_read_b64_tr_b16 v[238:239], v11 offset:43008
v_mfma_f32_16x16x32_bf16 v[32:35], v[176:179], a[252:255], v[32:35]
s_add_u32 s72, s71, 30720
buffer_load_dwordx4 v15, s[24:27], s72 offen offset:2048 lds
v_cvt_pk_bf16_f32 v20, v24, v25
v_mfma_f32_16x16x32_bf16 v[36:39], v[180:183], a[252:255], v[36:39]
s_nop 0
ds_read_b64_tr_b16 v[240:241], v8 offset:45056
ds_read_b64_tr_b16 v[242:243], v8 offset:47104
v_cvt_pk_bf16_f32 v21, v26, v27
v_mfma_f32_16x16x32_bf16 v[36:39], v[164:167], a[248:251], v[36:39]
v_cvt_pk_bf16_f32 v22, v28, v29
v_cvt_pk_bf16_f32 v23, v30, v31
v_mfma_f32_16x16x32_bf16 v[36:39], v[148:151], a[244:247], v[36:39]
s_nop 0
ds_read_b64_tr_b16 v[244:245], v9 offset:45056
ds_read_b64_tr_b16 v[246:247], v9 offset:47104
v_mfma_f32_16x16x32_bf16 v[36:39], v[132:135], a[240:243], v[36:39]
s_nop 0
ds_read_b64_tr_b16 v[248:249], v10 offset:45056
ds_read_b64_tr_b16 v[250:251], v10 offset:47104
v_mfma_f32_16x16x32_bf16 v[40:43], v[136:139], a[240:243], v[40:43]
s_nop 0
ds_read_b64_tr_b16 v[252:253], v11 offset:45056
ds_read_b64_tr_b16 v[254:255], v11 offset:47104
v_mfma_f32_16x16x32_bf16 v[40:43], v[152:155], a[244:247], v[40:43]
s_add_u32 s72, s71, 46080
buffer_load_dwordx4 v15, s[24:27], s72 offen offset:3072 lds
v_mfma_f32_16x16x32_bf16 v[40:43], v[168:171], a[248:251], v[40:43]
v_mfma_f32_16x16x32_bf16 v[40:43], v[184:187], a[252:255], v[40:43]
v_cvt_pk_bf16_f32 v24, v32, v33
v_cvt_pk_bf16_f32 v25, v34, v35
v_cvt_pk_bf16_f32 v26, v36, v37
v_mfma_f32_16x16x32_bf16 v[44:47], v[188:191], a[252:255], v[44:47]
v_cvt_pk_bf16_f32 v27, v38, v39
v_mfma_f32_16x16x32_bf16 v[44:47], v[172:175], a[248:251], v[44:47]
v_mfma_f32_16x16x32_bf16 v[44:47], v[156:159], a[244:247], v[44:47]
s_waitcnt vmcnt(26) lgkmcnt(0)
v_mfma_f32_16x16x32_bf16 v[44:47], v[140:143], a[240:243], v[44:47]
s_barrier
v_mfma_f32_16x16x32_bf16 v[48:51], v[192:195], a[160:163], v[48:51]
s_nop 0
ds_read_b64_tr_b16 v[128:129], v8 offset:49152
ds_read_b64_tr_b16 v[130:131], v8 offset:51200
v_mfma_f32_16x16x32_bf16 v[48:51], v[208:211], a[164:167], v[48:51]
s_xor_b32 s71, s13, 0x0
buffer_store_dwordx4 v[20:23], v1, s[44:47], s80 offen offset:1024 sc1
v_mfma_f32_16x16x32_bf16 v[48:51], v[224:227], a[168:171], v[48:51]
s_add_u32 m0, s77, 16384
ds_read_b64_tr_b16 v[132:133], v9 offset:49152
ds_read_b64_tr_b16 v[134:135], v9 offset:51200
v_mfma_f32_16x16x32_bf16 v[48:51], v[240:243], a[172:175], v[48:51]
s_add_u32 s72, s71, 0
buffer_load_dwordx4 v15, s[24:27], s72 offen lds
v_cvt_pk_bf16_f32 v28, v40, v41
v_mfma_f32_16x16x32_bf16 v[64:67], v[240:243], a[188:191], v[64:67]
s_nop 0
ds_read_b64_tr_b16 v[136:137], v10 offset:49152
ds_read_b64_tr_b16 v[138:139], v10 offset:51200
v_cvt_pk_bf16_f32 v29, v42, v43
v_mfma_f32_16x16x32_bf16 v[64:67], v[224:227], a[184:187], v[64:67]
s_nop 0
ds_read_b64_tr_b16 v[140:141], v11 offset:49152
ds_read_b64_tr_b16 v[142:143], v11 offset:51200
v_cvt_pk_bf16_f32 v30, v44, v45
v_mfma_f32_16x16x32_bf16 v[64:67], v[208:211], a[180:183], v[64:67]
v_cvt_pk_bf16_f32 v31, v46, v47
v_mfma_f32_16x16x32_bf16 v[64:67], v[192:195], a[176:179], v[64:67]
s_nop 0
ds_read_b64_tr_b16 v[144:145], v8 offset:53248
ds_read_b64_tr_b16 v[146:147], v8 offset:55296
v_mfma_f32_16x16x32_bf16 v[68:71], v[196:199], a[176:179], v[68:71]
s_add_u32 s72, s71, 15360
buffer_load_dwordx4 v15, s[24:27], s72 offen offset:1024 lds
v_mfma_f32_16x16x32_bf16 v[68:71], v[212:215], a[180:183], v[68:71]
s_nop 0
ds_read_b64_tr_b16 v[148:149], v9 offset:53248
ds_read_b64_tr_b16 v[150:151], v9 offset:55296
v_mfma_f32_16x16x32_bf16 v[68:71], v[228:231], a[184:187], v[68:71]
s_nop 0
ds_read_b64_tr_b16 v[152:153], v10 offset:53248
ds_read_b64_tr_b16 v[154:155], v10 offset:55296
v_mfma_f32_16x16x32_bf16 v[68:71], v[244:247], a[188:191], v[68:71]
v_mfma_f32_16x16x32_bf16 v[52:55], v[244:247], a[172:175], v[52:55]
s_nop 0
ds_read_b64_tr_b16 v[156:157], v11 offset:53248
ds_read_b64_tr_b16 v[158:159], v11 offset:55296
v_mfma_f32_16x16x32_bf16 v[52:55], v[228:231], a[168:171], v[52:55]
s_nop 0
ds_read_b64_tr_b16 v[160:161], v8 offset:57344
ds_read_b64_tr_b16 v[162:163], v8 offset:59392
v_mfma_f32_16x16x32_bf16 v[52:55], v[212:215], a[164:167], v[52:55]
s_add_u32 s72, s71, 30720
buffer_load_dwordx4 v15, s[24:27], s72 offen offset:2048 lds
v_mfma_f32_16x16x32_bf16 v[52:55], v[196:199], a[160:163], v[52:55]
s_nop 0
ds_read_b64_tr_b16 v[164:165], v9 offset:57344
ds_read_b64_tr_b16 v[166:167], v9 offset:59392
v_mfma_f32_16x16x32_bf16 v[56:59], v[200:203], a[160:163], v[56:59]
v_mfma_f32_16x16x32_bf16 v[56:59], v[216:219], a[164:167], v[56:59]
buffer_store_dwordx4 v[24:27], v1, s[44:47], s80 offen offset:2048 sc1
v_mfma_f32_16x16x32_bf16 v[56:59], v[232:235], a[168:171], v[56:59]
s_nop 0
ds_read_b64_tr_b16 v[168:169], v10 offset:57344
ds_read_b64_tr_b16 v[170:171], v10 offset:59392
v_mfma_f32_16x16x32_bf16 v[56:59], v[248:251], a[172:175], v[56:59]
s_nop 0
ds_read_b64_tr_b16 v[172:173], v11 offset:57344
ds_read_b64_tr_b16 v[174:175], v11 offset:59392
v_mfma_f32_16x16x32_bf16 v[72:75], v[248:251], a[188:191], v[72:75]
s_add_u32 s72, s71, 46080
buffer_load_dwordx4 v15, s[24:27], s72 offen offset:3072 lds
v_mfma_f32_16x16x32_bf16 v[72:75], v[232:235], a[184:187], v[72:75]
s_nop 0
ds_read_b64_tr_b16 v[176:177], v8 offset:61440
ds_read_b64_tr_b16 v[178:179], v8 offset:63488
v_mfma_f32_16x16x32_bf16 v[72:75], v[216:219], a[180:183], v[72:75]
v_mfma_f32_16x16x32_bf16 v[72:75], v[200:203], a[176:179], v[72:75]
s_nop 0
ds_read_b64_tr_b16 v[180:181], v9 offset:61440
ds_read_b64_tr_b16 v[182:183], v9 offset:63488
v_mfma_f32_16x16x32_bf16 v[76:79], v[204:207], a[176:179], v[76:79]
s_nop 0
ds_read_b64_tr_b16 v[184:185], v10 offset:61440
ds_read_b64_tr_b16 v[186:187], v10 offset:63488
v_mfma_f32_16x16x32_bf16 v[76:79], v[220:223], a[180:183], v[76:79]
s_nop 0
ds_read_b64_tr_b16 v[188:189], v11 offset:61440
ds_read_b64_tr_b16 v[190:191], v11 offset:63488
v_mfma_f32_16x16x32_bf16 v[76:79], v[236:239], a[184:187], v[76:79]
v_mfma_f32_16x16x32_bf16 v[76:79], v[252:255], a[188:191], v[76:79]
s_xor_b32 s71, s14, 0x0
v_mfma_f32_16x16x32_bf16 v[60:63], v[252:255], a[172:175], v[60:63]
s_add_u32 m0, s77, 32768
v_xor_b32 v8, 0x10000, v8
v_mfma_f32_16x16x32_bf16 v[60:63], v[236:239], a[168:171], v[60:63]
s_add_u32 s72, s71, 0
v_xor_b32 v9, 0x10000, v9
v_mfma_f32_16x16x32_bf16 v[60:63], v[220:223], a[164:167], v[60:63]
s_waitcnt lgkmcnt(0)
buffer_load_dwordx4 v15, s[24:27], s72 offen lds
v_xor_b32 v10, 0x10000, v10
v_mfma_f32_16x16x32_bf16 v[60:63], v[204:207], a[160:163], v[60:63]
v_xor_b32 v11, 0x10000, v11
v_mfma_f32_16x16x32_bf16 v[48:51], v[128:131], a[192:195], v[48:51]
s_nop 0
ds_read_b64_tr_b16 v[192:193], v8 offset:0
ds_read_b64_tr_b16 v[194:195], v8 offset:2048
v_mfma_f32_16x16x32_bf16 v[48:51], v[144:147], a[196:199], v[48:51]
buffer_store_dwordx4 v[28:31], v1, s[44:47], s80 offen offset:3072 sc1
v_mfma_f32_16x16x32_bf16 v[48:51], v[160:163], a[200:203], v[48:51]
s_nop 0
ds_read_b64_tr_b16 v[196:197], v9 offset:0
ds_read_b64_tr_b16 v[198:199], v9 offset:2048
v_mfma_f32_16x16x32_bf16 v[48:51], v[176:179], a[204:207], v[48:51]
s_add_u32 s72, s71, 15360
buffer_load_dwordx4 v15, s[24:27], s72 offen offset:1024 lds
v_mfma_f32_16x16x32_bf16 v[64:67], v[176:179], a[220:223], v[64:67]
s_nop 0
ds_read_b64_tr_b16 v[200:201], v10 offset:0
ds_read_b64_tr_b16 v[202:203], v10 offset:2048
v_mfma_f32_16x16x32_bf16 v[64:67], v[160:163], a[216:219], v[64:67]
v_mfma_f32_16x16x32_bf16 v[64:67], v[144:147], a[212:215], v[64:67]
s_nop 0
ds_read_b64_tr_b16 v[204:205], v11 offset:0
ds_read_b64_tr_b16 v[206:207], v11 offset:2048
v_mfma_f32_16x16x32_bf16 v[64:67], v[128:131], a[208:211], v[64:67]
s_nop 0
ds_read_b64_tr_b16 v[208:209], v8 offset:4096
ds_read_b64_tr_b16 v[210:211], v8 offset:6144
v_mfma_f32_16x16x32_bf16 v[68:71], v[132:135], a[208:211], v[68:71]
v_mfma_f32_16x16x32_bf16 v[68:71], v[148:151], a[212:215], v[68:71]
s_add_u32 s72, s71, 30720
buffer_load_dwordx4 v15, s[24:27], s72 offen offset:2048 lds
v_mfma_f32_16x16x32_bf16 v[68:71], v[164:167], a[216:219], v[68:71]
s_nop 0
ds_read_b64_tr_b16 v[212:213], v9 offset:4096
ds_read_b64_tr_b16 v[214:215], v9 offset:6144
v_mfma_f32_16x16x32_bf16 v[68:71], v[180:183], a[220:223], v[68:71]
s_nop 0
ds_read_b64_tr_b16 v[216:217], v10 offset:4096
ds_read_b64_tr_b16 v[218:219], v10 offset:6144
v_mfma_f32_16x16x32_bf16 v[52:55], v[180:183], a[204:207], v[52:55]
v_mfma_f32_16x16x32_bf16 v[52:55], v[164:167], a[200:203], v[52:55]
s_nop 0
ds_read_b64_tr_b16 v[220:221], v11 offset:4096
ds_read_b64_tr_b16 v[222:223], v11 offset:6144
v_mfma_f32_16x16x32_bf16 v[52:55], v[148:151], a[196:199], v[52:55]
s_nop 0
ds_read_b64_tr_b16 v[224:225], v8 offset:8192
ds_read_b64_tr_b16 v[226:227], v8 offset:10240
v_mfma_f32_16x16x32_bf16 v[52:55], v[132:135], a[192:195], v[52:55]
s_add_u32 s72, s71, 46080
buffer_load_dwordx4 v15, s[24:27], s72 offen offset:3072 lds
v_mfma_f32_16x16x32_bf16 v[56:59], v[136:139], a[192:195], v[56:59]
s_nop 0
ds_read_b64_tr_b16 v[228:229], v9 offset:8192
ds_read_b64_tr_b16 v[230:231], v9 offset:10240
v_mfma_f32_16x16x32_bf16 v[56:59], v[152:155], a[196:199], v[56:59]
v_mfma_f32_16x16x32_bf16 v[56:59], v[168:171], a[200:203], v[56:59]
s_nop 0
ds_read_b64_tr_b16 v[232:233], v10 offset:8192
ds_read_b64_tr_b16 v[234:235], v10 offset:10240
v_mfma_f32_16x16x32_bf16 v[56:59], v[184:187], a[204:207], v[56:59]
s_nop 0
ds_read_b64_tr_b16 v[236:237], v11 offset:8192
ds_read_b64_tr_b16 v[238:239], v11 offset:10240
v_mfma_f32_16x16x32_bf16 v[72:75], v[184:187], a[220:223], v[72:75]
Lstube3:
s_cbranch_execz Lrete
v_mfma_f32_16x16x32_bf16 v[72:75], v[168:171], a[216:219], v[72:75]
s_nop 0
ds_read_b64_tr_b16 v[240:241], v8 offset:12288
ds_read_b64_tr_b16 v[242:243], v8 offset:14336
v_mfma_f32_16x16x32_bf16 v[72:75], v[152:155], a[212:215], v[72:75]
s_nop 0
ds_read_b64_tr_b16 v[244:245], v9 offset:12288
ds_read_b64_tr_b16 v[246:247], v9 offset:14336
v_mfma_f32_16x16x32_bf16 v[72:75], v[136:139], a[208:211], v[72:75]
v_mfma_f32_16x16x32_bf16 v[76:79], v[140:143], a[208:211], v[76:79]
s_nop 0
ds_read_b64_tr_b16 v[248:249], v10 offset:12288
ds_read_b64_tr_b16 v[250:251], v10 offset:14336
v_mfma_f32_16x16x32_bf16 v[76:79], v[156:159], a[212:215], v[76:79]
s_nop 0
ds_read_b64_tr_b16 v[252:253], v11 offset:12288
ds_read_b64_tr_b16 v[254:255], v11 offset:14336
v_mfma_f32_16x16x32_bf16 v[76:79], v[172:175], a[216:219], v[76:79]
v_mfma_f32_16x16x32_bf16 v[76:79], v[188:191], a[220:223], v[76:79]
v_mfma_f32_16x16x32_bf16 v[60:63], v[188:191], a[204:207], v[60:63]
v_mfma_f32_16x16x32_bf16 v[60:63], v[172:175], a[200:203], v[60:63]
s_xor_b32 s71, s15, 0x0
v_mfma_f32_16x16x32_bf16 v[60:63], v[156:159], a[196:199], v[60:63]
s_waitcnt vmcnt(22) lgkmcnt(0)
v_mfma_f32_16x16x32_bf16 v[60:63], v[140:143], a[192:195], v[60:63]
s_barrier
v_mfma_f32_16x16x32_bf16 v[48:51], v[192:195], a[224:227], v[48:51]
s_add_u32 m0, s77, 49152
ds_read_b64_tr_b16 v[128:129], v8 offset:16384
ds_read_b64_tr_b16 v[130:131], v8 offset:18432
v_mfma_f32_16x16x32_bf16 v[48:51], v[208:211], a[228:231], v[48:51]
s_add_u32 s72, s71, 0
buffer_load_dwordx4 v15, s[24:27], s72 offen lds
v_mfma_f32_16x16x32_bf16 v[48:51], v[224:227], a[232:235], v[48:51]
s_nop 0
ds_read_b64_tr_b16 v[132:133], v9 offset:16384
ds_read_b64_tr_b16 v[134:135], v9 offset:18432
v_mfma_f32_16x16x32_bf16 v[48:51], v[240:243], a[236:239], v[48:51]
s_nop 0
ds_read_b64_tr_b16 v[136:137], v10 offset:16384
ds_read_b64_tr_b16 v[138:139], v10 offset:18432
v_mfma_f32_16x16x32_bf16 v[52:55], v[244:247], a[236:239], v[52:55]
s_nop 0
ds_read_b64_tr_b16 v[140:141], v11 offset:16384
ds_read_b64_tr_b16 v[142:143], v11 offset:18432
v_mfma_f32_16x16x32_bf16 v[52:55], v[228:231], a[232:235], v[52:55]
s_add_u32 s72, s71, 15360
buffer_load_dwordx4 v15, s[24:27], s72 offen offset:1024 lds
v_mfma_f32_16x16x32_bf16 v[52:55], v[212:215], a[228:231], v[52:55]
v_mfma_f32_16x16x32_bf16 v[52:55], v[196:199], a[224:227], v[52:55]
s_nop 0
ds_read_b64_tr_b16 v[144:145], v8 offset:20480
ds_read_b64_tr_b16 v[146:147], v8 offset:22528
v_mfma_f32_16x16x32_bf16 v[56:59], v[200:203], a[224:227], v[56:59]
s_nop 0
ds_read_b64_tr_b16 v[148:149], v9 offset:20480
ds_read_b64_tr_b16 v[150:151], v9 offset:22528
v_mfma_f32_16x16x32_bf16 v[56:59], v[216:219], a[228:231], v[56:59]
s_add_u32 s72, s71, 30720
buffer_load_dwordx4 v15, s[24:27], s72 offen offset:2048 lds
v_mfma_f32_16x16x32_bf16 v[56:59], v[232:235], a[232:235], v[56:59]
s_nop 0
ds_read_b64_tr_b16 v[152:153], v10 offset:20480
ds_read_b64_tr_b16 v[154:155], v10 offset:22528
v_mfma_f32_16x16x32_bf16 v[56:59], v[248:251], a[236:239], v[56:59]
s_nop 0
ds_read_b64_tr_b16 v[156:157], v11 offset:20480
ds_read_b64_tr_b16 v[158:159], v11 offset:22528
v_cvt_pk_bf16_f32 v48, v48, v49
v_mfma_f32_16x16x32_bf16 v[60:63], v[252:255], a[236:239], v[60:63]
v_cvt_pk_bf16_f32 v49, v50, v51
v_cvt_pk_bf16_f32 v50, v52, v53
v_cvt_pk_bf16_f32 v51, v54, v55
v_mfma_f32_16x16x32_bf16 v[60:63], v[236:239], a[232:235], v[60:63]
s_add_u32 s72, s71, 46080
buffer_load_dwordx4 v15, s[24:27], s72 offen offset:3072 lds
v_mfma_f32_16x16x32_bf16 v[60:63], v[220:223], a[228:231], v[60:63]
s_nop 0
ds_read_b64_tr_b16 v[160:161], v8 offset:24576
ds_read_b64_tr_b16 v[162:163], v8 offset:26624
v_mfma_f32_16x16x32_bf16 v[60:63], v[204:207], a[224:227], v[60:63]
s_nop 0
ds_read_b64_tr_b16 v[164:165], v9 offset:24576
ds_read_b64_tr_b16 v[166:167], v9 offset:26624
v_mfma_f32_16x16x32_bf16 v[64:67], v[192:195], a[240:243], v[64:67]
s_xor_b32 s80, s93, 0x200000
ds_read_b64_tr_b16 v[168:169], v10 offset:24576
ds_read_b64_tr_b16 v[170:171], v10 offset:26624
v_mfma_f32_16x16x32_bf16 v[64:67], v[208:211], a[244:247], v[64:67]
s_add_u32 s80, s80, 0x3e00000
buffer_store_dwordx4 v[48:51], v1, s[44:47], s80 offen sc1
v_mfma_f32_16x16x32_bf16 v[64:67], v[224:227], a[248:251], v[64:67]
s_nop 0
ds_read_b64_tr_b16 v[172:173], v11 offset:24576
ds_read_b64_tr_b16 v[174:175], v11 offset:26624
v_mfma_f32_16x16x32_bf16 v[64:67], v[240:243], a[252:255], v[64:67]
s_xor_b32 s71, s12, 0x40000
v_cvt_pk_bf16_f32 v52, v56, v57
v_cvt_pk_bf16_f32 v53, v58, v59
v_cvt_pk_bf16_f32 v54, v60, v61
v_mfma_f32_16x16x32_bf16 v[68:71], v[244:247], a[252:255], v[68:71]
s_add_u32 m0, s85, 0
ds_read_b64_tr_b16 v[176:177], v8 offset:28672
ds_read_b64_tr_b16 v[178:179], v8 offset:30720
v_cvt_pk_bf16_f32 v55, v62, v63
v_mfma_f32_16x16x32_bf16 v[68:71], v[228:231], a[248:251], v[68:71]
s_add_u32 s72, s71, 0
buffer_load_dwordx4 v15, s[24:27], s72 offen lds
v_mfma_f32_16x16x32_bf16 v[68:71], v[212:215], a[244:247], v[68:71]
s_nop 0
ds_read_b64_tr_b16 v[180:181], v9 offset:28672
ds_read_b64_tr_b16 v[182:183], v9 offset:30720
v_mfma_f32_16x16x32_bf16 v[68:71], v[196:199], a[240:243], v[68:71]
s_nop 0
ds_read_b64_tr_b16 v[184:185], v10 offset:28672
ds_read_b64_tr_b16 v[186:187], v10 offset:30720
v_mfma_f32_16x16x32_bf16 v[72:75], v[200:203], a[240:243], v[72:75]
s_nop 0
ds_read_b64_tr_b16 v[188:189], v11 offset:28672
ds_read_b64_tr_b16 v[190:191], v11 offset:30720
v_mfma_f32_16x16x32_bf16 v[72:75], v[216:219], a[244:247], v[72:75]
v_mfma_f32_16x16x32_bf16 v[72:75], v[232:235], a[248:251], v[72:75]
s_add_u32 s72, s71, 15360
buffer_load_dwordx4 v15, s[24:27], s72 offen offset:1024 lds
v_mfma_f32_16x16x32_bf16 v[72:75], v[248:251], a[252:255], v[72:75]
v_cvt_pk_bf16_f32 v56, v64, v65
v_cvt_pk_bf16_f32 v57, v66, v67
v_cvt_pk_bf16_f32 v58, v68, v69
v_mfma_f32_16x16x32_bf16 v[76:79], v[252:255], a[252:255], v[76:79]
v_cvt_pk_bf16_f32 v59, v70, v71
v_mfma_f32_16x16x32_bf16 v[76:79], v[236:239], a[248:251], v[76:79]
v_mfma_f32_16x16x32_bf16 v[76:79], v[220:223], a[244:247], v[76:79]
s_waitcnt lgkmcnt(0)
v_mfma_f32_16x16x32_bf16 v[76:79], v[204:207], a[240:243], v[76:79]
v_mfma_f32_16x16x32_bf16 v[80:83], v[128:131], a[160:163], v[80:83]
s_add_u32 s72, s71, 30720
buffer_load_dwordx4 v15, s[24:27], s72 offen offset:2048 lds
v_mfma_f32_16x16x32_bf16 v[80:83], v[144:147], a[164:167], v[80:83]
s_waitcnt vmcnt(23)
buffer_store_dwordx4 v[52:55], v1, s[44:47], s80 offen offset:1024 sc1
v_mfma_f32_16x16x32_bf16 v[80:83], v[160:163], a[168:171], v[80:83]
s_nop 0
ds_read_b64_tr_b16 v[192:193], v8 offset:32768
ds_read_b64_tr_b16 v[194:195], v8 offset:34816
v_mfma_f32_16x16x32_bf16 v[80:83], v[176:179], a[172:175], v[80:83]
s_nop 0
ds_read_b64_tr_b16 v[196:197], v9 offset:32768
ds_read_b64_tr_b16 v[198:199], v9 offset:34816
v_cvt_pk_bf16_f32 v60, v72, v73
v_mfma_f32_16x16x32_bf16 v[96:99], v[176:179], a[188:191], v[96:99]
s_nop 0
ds_read_b64_tr_b16 v[200:201], v10 offset:32768
ds_read_b64_tr_b16 v[202:203], v10 offset:34816
v_cvt_pk_bf16_f32 v61, v74, v75
v_mfma_f32_16x16x32_bf16 v[96:99], v[160:163], a[184:187], v[96:99]
v_cvt_pk_bf16_f32 v62, v76, v77
v_cvt_pk_bf16_f32 v63, v78, v79
v_mfma_f32_16x16x32_bf16 v[96:99], v[144:147], a[180:183], v[96:99]
s_add_u32 s72, s71, 46080
buffer_load_dwordx4 v15, s[24:27], s72 offen offset:3072 lds
v_mfma_f32_16x16x32_bf16 v[96:99], v[128:131], a[176:179], v[96:99]
s_nop 0
ds_read_b64_tr_b16 v[204:205], v11 offset:32768
ds_read_b64_tr_b16 v[206:207], v11 offset:34816
v_mfma_f32_16x16x32_bf16 v[100:103], v[132:135], a[176:179], v[100:103]
s_nop 0
ds_read_b64_tr_b16 v[208:209], v8 offset:36864
ds_read_b64_tr_b16 v[210:211], v8 offset:38912
v_mfma_f32_16x16x32_bf16 v[100:103], v[148:151], a[180:183], v[100:103]
v_sub_f32 v112, 1.0, v6
v_sub_f32 v113, 1.0, v7
v_mfma_f32_16x16x32_bf16 v[100:103], v[164:167], a[184:187], v[100:103]
s_nop 0
ds_read_b64_tr_b16 v[212:213], v9 offset:36864
ds_read_b64_tr_b16 v[214:215], v9 offset:38912
v_mfma_f32_16x16x32_bf16 v[100:103], v[180:183], a[188:191], v[100:103]
s_nop 0
ds_read_b64_tr_b16 v[216:217], v10 offset:36864
ds_read_b64_tr_b16 v[218:219], v10 offset:38912
v_mfma_f32_16x16x32_bf16 v[84:87], v[180:183], a[172:175], v[84:87]
v_mfma_f32_16x16x32_bf16 v[84:87], v[164:167], a[168:171], v[84:87]
s_nop 0
ds_read_b64_tr_b16 v[220:221], v11 offset:36864
ds_read_b64_tr_b16 v[222:223], v11 offset:38912
v_mfma_f32_16x16x32_bf16 v[84:87], v[148:151], a[164:167], v[84:87]
s_nop 0
ds_read_b64_tr_b16 v[224:225], v8 offset:40960
ds_read_b64_tr_b16 v[226:227], v8 offset:43008
v_mfma_f32_16x16x32_bf16 v[84:87], v[132:135], a[160:163], v[84:87]
s_nop 0
ds_read_b64_tr_b16 v[228:229], v9 offset:40960
ds_read_b64_tr_b16 v[230:231], v9 offset:43008
v_mfma_f32_16x16x32_bf16 v[88:91], v[136:139], a[160:163], v[88:91]
v_mfma_f32_16x16x32_bf16 v[88:91], v[152:155], a[164:167], v[88:91]
buffer_store_dwordx4 v[56:59], v1, s[44:47], s80 offen offset:2048 sc1
v_mfma_f32_16x16x32_bf16 v[88:91], v[168:171], a[168:171], v[88:91]
s_nop 0
ds_read_b64_tr_b16 v[232:233], v10 offset:40960
ds_read_b64_tr_b16 v[234:235], v10 offset:43008
v_mfma_f32_16x16x32_bf16 v[88:91], v[184:187], a[172:175], v[88:91]
s_nop 0
ds_read_b64_tr_b16 v[236:237], v11 offset:40960
ds_read_b64_tr_b16 v[238:239], v11 offset:43008
v_mfma_f32_16x16x32_bf16 v[104:107], v[184:187], a[188:191], v[104:107]
v_mfma_f32_16x16x32_bf16 v[104:107], v[168:171], a[184:187], v[104:107]
s_nop 0
ds_read_b64_tr_b16 v[240:241], v8 offset:45056
ds_read_b64_tr_b16 v[242:243], v8 offset:47104
v_mfma_f32_16x16x32_bf16 v[104:107], v[152:155], a[180:183], v[104:107]
s_nop 0
ds_read_b64_tr_b16 v[244:245], v9 offset:45056
ds_read_b64_tr_b16 v[246:247], v9 offset:47104
v_mfma_f32_16x16x32_bf16 v[104:107], v[136:139], a[176:179], v[104:107]
v_mfma_f32_16x16x32_bf16 v[108:111], v[140:143], a[176:179], v[108:111]
s_nop 0
ds_read_b64_tr_b16 v[248:249], v10 offset:45056
ds_read_b64_tr_b16 v[250:251], v10 offset:47104
v_mfma_f32_16x16x32_bf16 v[108:111], v[156:159], a[180:183], v[108:111]
s_nop 0
ds_read_b64_tr_b16 v[252:253], v11 offset:45056
ds_read_b64_tr_b16 v[254:255], v11 offset:47104
v_mfma_f32_16x16x32_bf16 v[108:111], v[172:175], a[184:187], v[108:111]
v_mfma_f32_16x16x32_bf16 v[108:111], v[188:191], a[188:191], v[108:111]
v_mfma_f32_16x16x32_bf16 v[92:95], v[188:191], a[172:175], v[92:95]
v_mfma_f32_16x16x32_bf16 v[92:95], v[172:175], a[168:171], v[92:95]
s_xor_b32 s71, s13, 0x40000
v_mfma_f32_16x16x32_bf16 v[92:95], v[156:159], a[164:167], v[92:95]
s_waitcnt vmcnt(22) lgkmcnt(0)
v_mfma_f32_16x16x32_bf16 v[92:95], v[140:143], a[160:163], v[92:95]
s_barrier
v_mfma_f32_16x16x32_bf16 v[80:83], v[192:195], a[192:195], v[80:83]
s_add_u32 m0, s85, 16384
ds_read_b64_tr_b16 v[128:129], v8 offset:49152
ds_read_b64_tr_b16 v[130:131], v8 offset:51200
v_mfma_f32_16x16x32_bf16 v[80:83], v[208:211], a[196:199], v[80:83]
s_add_u32 s72, s71, 0
buffer_load_dwordx4 v15, s[24:27], s72 offen lds
v_mfma_f32_16x16x32_bf16 v[80:83], v[224:227], a[200:203], v[80:83]
buffer_store_dwordx4 v[60:63], v1, s[44:47], s80 offen offset:3072 sc1
v_mfma_f32_16x16x32_bf16 v[80:83], v[240:243], a[204:207], v[80:83]
s_nop 0
ds_read_b64_tr_b16 v[132:133], v9 offset:49152
ds_read_b64_tr_b16 v[134:135], v9 offset:51200
v_mfma_f32_16x16x32_bf16 v[96:99], v[240:243], a[220:223], v[96:99]
s_add_u32 s72, s71, 15360
buffer_load_dwordx4 v15, s[24:27], s72 offen offset:1024 lds
v_mfma_f32_16x16x32_bf16 v[96:99], v[224:227], a[216:219], v[96:99]
s_nop 0
ds_read_b64_tr_b16 v[136:137], v10 offset:49152
ds_read_b64_tr_b16 v[138:139], v10 offset:51200
v_mfma_f32_16x16x32_bf16 v[96:99], v[208:211], a[212:215], v[96:99]
s_nop 0
ds_read_b64_tr_b16 v[140:141], v11 offset:49152
ds_read_b64_tr_b16 v[142:143], v11 offset:51200
v_mfma_f32_16x16x32_bf16 v[96:99], v[192:195], a[208:211], v[96:99]
s_add_u32 s72, s71, 30720
buffer_load_dwordx4 v15, s[24:27], s72 offen offset:2048 lds
v_mfma_f32_16x16x32_bf16 v[100:103], v[196:199], a[208:211], v[100:103]
s_nop 0
ds_read_b64_tr_b16 v[144:145], v8 offset:53248
ds_read_b64_tr_b16 v[146:147], v8 offset:55296
v_mfma_f32_16x16x32_bf16 v[100:103], v[212:215], a[212:215], v[100:103]
s_nop 0
ds_read_b64_tr_b16 v[148:149], v9 offset:53248
ds_read_b64_tr_b16 v[150:151], v9 offset:55296
v_mfma_f32_16x16x32_bf16 v[100:103], v[228:231], a[216:219], v[100:103]
s_add_u32 s72, s71, 46080
buffer_load_dwordx4 v15, s[24:27], s72 offen offset:3072 lds
v_mfma_f32_16x16x32_bf16 v[100:103], v[244:247], a[220:223], v[100:103]
s_xor_b32 s71, s14, 0x40000
ds_read_b64 v[48:49], v116 offset:0
ds_read_b64_tr_b16 v[64:65], v5 offset:0
v_mfma_f32_16x16x32_bf16 v[84:87], v[244:247], a[204:207], v[84:87]
s_add_u32 m0, s85, 32768
s_add_u32 s72, s71, 0
buffer_load_dwordx4 v15, s[24:27], s72 offen lds
v_mfma_f32_16x16x32_bf16 v[84:87], v[228:231], a[200:203], v[84:87]
s_nop 0
ds_read_b64_tr_b16 v[152:153], v10 offset:53248
ds_read_b64_tr_b16 v[154:155], v10 offset:55296
v_mfma_f32_16x16x32_bf16 v[84:87], v[212:215], a[196:199], v[84:87]
s_nop 0
ds_read_b64_tr_b16 v[156:157], v11 offset:53248
ds_read_b64_tr_b16 v[158:159], v11 offset:55296
v_mfma_f32_16x16x32_bf16 v[84:87], v[196:199], a[192:195], v[84:87]
s_nop 0
ds_read_b64_tr_b16 v[160:161], v8 offset:57344
ds_read_b64_tr_b16 v[162:163], v8 offset:59392
v_mfma_f32_16x16x32_bf16 v[88:91], v[200:203], a[192:195], v[88:91]
s_nop 0
ds_read_b64_tr_b16 v[164:165], v9 offset:57344
ds_read_b64_tr_b16 v[166:167], v9 offset:59392
v_mfma_f32_16x16x32_bf16 v[88:91], v[216:219], a[196:199], v[88:91]
s_add_u32 s72, s71, 15360
buffer_load_dwordx4 v15, s[24:27], s72 offen offset:1024 lds
v_mfma_f32_16x16x32_bf16 v[88:91], v[232:235], a[200:203], v[88:91]
s_nop 0
ds_read_b64_tr_b16 v[168:169], v10 offset:57344
ds_read_b64_tr_b16 v[170:171], v10 offset:59392
v_mfma_f32_16x16x32_bf16 v[88:91], v[248:251], a[204:207], v[88:91]
s_nop 0
ds_read_b64 v[50:51], v117 offset:0
ds_read_b64_tr_b16 v[66:67], v5 offset:4096
v_mfma_f32_16x16x32_bf16 v[104:107], v[248:251], a[220:223], v[104:107]
s_nop 0
ds_read_b64_tr_b16 v[172:173], v11 offset:57344
ds_read_b64_tr_b16 v[174:175], v11 offset:59392
v_mfma_f32_16x16x32_bf16 v[104:107], v[232:235], a[216:219], v[104:107]
s_nop 0
ds_read_b64_tr_b16 v[176:177], v8 offset:61440
ds_read_b64_tr_b16 v[178:179], v8 offset:63488
v_mfma_f32_16x16x32_bf16 v[104:107], v[216:219], a[212:215], v[104:107]
s_nop 0
ds_read_b64_tr_b16 v[180:181], v9 offset:61440
ds_read_b64_tr_b16 v[182:183], v9 offset:63488
v_mfma_f32_16x16x32_bf16 v[104:107], v[200:203], a[208:211], v[104:107]
s_add_u32 s72, s71, 30720
buffer_load_dwordx4 v15, s[24:27], s72 offen offset:2048 lds
v_mfma_f32_16x16x32_bf16 v[108:111], v[204:207], a[208:211], v[108:111]
s_nop 0
ds_read_b64_tr_b16 v[184:185], v10 offset:61440
ds_read_b64_tr_b16 v[186:187], v10 offset:63488
v_mfma_f32_16x16x32_bf16 v[108:111], v[220:223], a[212:215], v[108:111]
s_nop 0
ds_read_b64_tr_b16 v[188:189], v11 offset:61440
ds_read_b64_tr_b16 v[190:191], v11 offset:63488
v_mfma_f32_16x16x32_bf16 v[108:111], v[236:239], a[216:219], v[108:111]
s_nop 0
ds_read_b64 v[52:53], v118 offset:0
ds_read_b64_tr_b16 v[68:69], v5 offset:8192
v_mfma_f32_16x16x32_bf16 v[108:111], v[252:255], a[220:223], v[108:111]
s_nop 0
ds_read_b64 v[54:55], v119 offset:0
ds_read_b64_tr_b16 v[70:71], v5 offset:12288
v_mfma_f32_16x16x32_bf16 v[92:95], v[252:255], a[204:207], v[92:95]
v_xor_b32 v8, 0x10000, v8
v_xor_b32 v5, 16, v5
v_mfma_f32_16x16x32_bf16 v[92:95], v[236:239], a[200:203], v[92:95]
s_add_u32 s72, s71, 46080
buffer_load_dwordx4 v15, s[24:27], s72 offen offset:3072 lds
v_xor_b32 v9, 0x10000, v9
v_mfma_f32_16x16x32_bf16 v[92:95], v[220:223], a[196:199], v[92:95]
s_waitcnt lgkmcnt(0)
ds_read_b64 v[56:57], v116 offset:2048
v_xor_b32 v10, 0x10000, v10
v_mfma_f32_16x16x32_bf16 v[92:95], v[204:207], a[192:195], v[92:95]
ds_read_b64_tr_b16 v[72:73], v5 offset:0
v_xor_b32 v11, 0x10000, v11
v_mfma_f32_16x16x32_bf16 v[80:83], v[128:131], a[224:227], v[80:83]
s_nop 0
ds_read_b64_tr_b16 v[192:193], v8 offset:0
ds_read_b64_tr_b16 v[194:195], v8 offset:2048
v_mfma_f32_16x16x32_bf16 v[80:83], v[144:147], a[228:231], v[80:83]
s_nop 0
ds_read_b64_tr_b16 v[196:197], v9 offset:0
ds_read_b64_tr_b16 v[198:199], v9 offset:2048
v_mfma_f32_16x16x32_bf16 v[80:83], v[160:163], a[232:235], v[80:83]
s_nop 0
ds_read_b64 v[58:59], v117 offset:2048
ds_read_b64_tr_b16 v[74:75], v5 offset:4096
v_mfma_f32_16x16x32_bf16 v[80:83], v[176:179], a[236:239], v[80:83]
s_nop 0
ds_read_b64_tr_b16 v[200:201], v10 offset:0
ds_read_b64_tr_b16 v[202:203], v10 offset:2048
v_mfma_f32_16x16x32_bf16 v[84:87], v[180:183], a[236:239], v[84:87]
s_nop 0
ds_read_b64_tr_b16 v[204:205], v11 offset:0
ds_read_b64_tr_b16 v[206:207], v11 offset:2048
v_mfma_f32_16x16x32_bf16 v[84:87], v[164:167], a[232:235], v[84:87]
s_nop 0
ds_read_b64 v[60:61], v118 offset:2048
ds_read_b64_tr_b16 v[76:77], v5 offset:8192
v_mfma_f32_16x16x32_bf16 v[84:87], v[148:151], a[228:231], v[84:87]
s_nop 0
ds_read_b64_tr_b16 v[208:209], v8 offset:4096
ds_read_b64_tr_b16 v[210:211], v8 offset:6144
v_mfma_f32_16x16x32_bf16 v[84:87], v[132:135], a[224:227], v[84:87]
s_nop 0
ds_read_b64 v[62:63], v119 offset:2048
ds_read_b64_tr_b16 v[78:79], v5 offset:12288
v_mfma_f32_16x16x32_bf16 v[88:91], v[136:139], a[224:227], v[88:91]
s_nop 0
ds_read_b64_tr_b16 v[212:213], v9 offset:4096
ds_read_b64_tr_b16 v[214:215], v9 offset:6144
v_mfma_f32_16x16x32_bf16 v[88:91], v[152:155], a[228:231], v[88:91]
s_nop 0
ds_read_b64_tr_b16 v[216:217], v10 offset:4096
ds_read_b64_tr_b16 v[218:219], v10 offset:6144
v_mfma_f32_16x16x32_bf16 v[88:91], v[168:171], a[232:235], v[88:91]
v_mfma_f32_16x16x32_bf16 v[88:91], v[184:187], a[236:239], v[88:91]
s_nop 0
ds_read_b64_tr_b16 v[220:221], v11 offset:4096
ds_read_b64_tr_b16 v[222:223], v11 offset:6144
v_cvt_pk_bf16_f32 v80, v80, v81
v_mfma_f32_16x16x32_bf16 v[92:95], v[188:191], a[236:239], v[92:95]
v_cvt_pk_bf16_f32 v81, v82, v83
v_cvt_pk_bf16_f32 v82, v84, v85
v_cvt_pk_bf16_f32 v83, v86, v87
v_mfma_f32_16x16x32_bf16 v[92:95], v[172:175], a[232:235], v[92:95]
s_waitcnt lgkmcnt(6)
ds_read_b64_tr_b16 v[224:225], v8 offset:8192
ds_read_b64_tr_b16 v[226:227], v8 offset:10240
v_mfma_f32_16x16x32_bf16 v[92:95], v[156:159], a[228:231], v[92:95]
s_nop 0
ds_read_b64_tr_b16 v[228:229], v9 offset:8192
ds_read_b64_tr_b16 v[230:231], v9 offset:10240
v_mfma_f32_16x16x32_bf16 v[92:95], v[140:143], a[224:227], v[92:95]
v_and_b32 v114, 0xffff0000, v48
v_lshlrev_b32 v115, 16, v64
v_mfma_f32_16x16x32_bf16 v[96:99], v[128:131], a[240:243], v[96:99]
s_xor_b32 s80, s93, 0x300000
ds_read_b64_tr_b16 v[232:233], v10 offset:8192
ds_read_b64_tr_b16 v[234:235], v10 offset:10240
v_mfma_f32_16x16x32_bf16 v[96:99], v[144:147], a[244:247], v[96:99]
s_add_u32 s80, s80, 0x4200000
buffer_store_dwordx4 v[80:83], v1, s[44:47], s80 offen sc1
v_mfma_f32_16x16x32_bf16 v[96:99], v[160:163], a[248:251], v[96:99]
s_nop 0
ds_read_b64_tr_b16 v[236:237], v11 offset:8192
ds_read_b64_tr_b16 v[238:239], v11 offset:10240
v_mfma_f32_16x16x32_bf16 v[96:99], v[176:179], a[252:255], v[96:99]
v_cvt_pk_bf16_f32 v84, v88, v89
v_cvt_pk_bf16_f32 v85, v90, v91
v_cvt_pk_bf16_f32 v86, v92, v93
v_mfma_f32_16x16x32_bf16 v[100:103], v[180:183], a[252:255], v[100:103]
s_nop 0
ds_read_b64_tr_b16 v[240:241], v8 offset:12288
ds_read_b64_tr_b16 v[242:243], v8 offset:14336
v_cvt_pk_bf16_f32 v87, v94, v95
v_mfma_f32_16x16x32_bf16 v[100:103], v[164:167], a[248:251], v[100:103]
v_lshlrev_b32 v48, 16, v48
v_and_b32 v64, 0xffff0000, v64
v_mfma_f32_16x16x32_bf16 v[100:103], v[148:151], a[244:247], v[100:103]
s_nop 0
ds_read_b64_tr_b16 v[244:245], v9 offset:12288
ds_read_b64_tr_b16 v[246:247], v9 offset:14336
v_mfma_f32_16x16x32_bf16 v[100:103], v[132:135], a[240:243], v[100:103]
s_nop 0
ds_read_b64_tr_b16 v[248:249], v10 offset:12288
ds_read_b64_tr_b16 v[250:251], v10 offset:14336
v_mfma_f32_16x16x32_bf16 v[104:107], v[136:139], a[240:243], v[104:107]
v_mul_f32 v48, v48, v112
v_mul_f32 v114, v114, v112
v_mfma_f32_16x16x32_bf16 v[104:107], v[152:155], a[244:247], v[104:107]
s_nop 0
ds_read_b64_tr_b16 v[252:253], v11 offset:12288
ds_read_b64_tr_b16 v[254:255], v11 offset:14336
v_mfma_f32_16x16x32_bf16 v[104:107], v[168:171], a[248:251], v[104:107]
v_mul_f32 v48, v48, v115
v_mul_f32 v64, v64, v114
v_mfma_f32_16x16x32_bf16 v[104:107], v[184:187], a[252:255], v[104:107]
v_cvt_pk_bf16_f32 v88, v96, v97
v_cvt_pk_bf16_f32 v89, v98, v99
v_cvt_pk_bf16_f32 v90, v100, v101
v_mfma_f32_16x16x32_bf16 v[108:111], v[188:191], a[252:255], v[108:111]
v_cvt_pk_bf16_f32 v91, v102, v103
v_and_b32 v114, 0xffff0000, v49
v_mfma_f32_16x16x32_bf16 v[108:111], v[172:175], a[248:251], v[108:111]
s_xor_b32 s71, s15, 0x40000
v_lshlrev_b32 v115, 16, v65
v_lshlrev_b32 v49, 16, v49
v_mfma_f32_16x16x32_bf16 v[108:111], v[156:159], a[244:247], v[108:111]
s_waitcnt vmcnt(21) lgkmcnt(0)
v_and_b32 v65, 0xffff0000, v65
v_mul_f32 v49, v49, v112
v_mfma_f32_16x16x32_bf16 v[108:111], v[140:143], a[240:243], v[108:111]
s_barrier
v_mul_f32 v114, v114, v112
v_mul_f32 v49, v49, v115
v_mfma_f32_16x16x32_bf16 v[16:19], v[192:195], a[0:3], 0
s_add_u32 m0, s85, 49152
ds_read_b64_tr_b16 v[128:129], v8 offset:16384
ds_read_b64_tr_b16 v[130:131], v8 offset:18432
v_mfma_f32_16x16x32_bf16 v[16:19], v[208:211], a[4:7], v[16:19]
s_add_u32 s72, s71, 0
buffer_load_dwordx4 v15, s[24:27], s72 offen lds
v_mfma_f32_16x16x32_bf16 v[16:19], v[224:227], a[8:11], v[16:19]
buffer_store_dwordx4 v[84:87], v1, s[44:47], s80 offen offset:1024 sc1
v_mfma_f32_16x16x32_bf16 v[16:19], v[240:243], a[12:15], v[16:19]
s_nop 0
ds_read_b64_tr_b16 v[132:133], v9 offset:16384
ds_read_b64_tr_b16 v[134:135], v9 offset:18432
v_cvt_pk_bf16_f32 v92, v104, v105
v_mfma_f32_16x16x32_bf16 v[32:35], v[240:243], a[28:31], 0
s_add_u32 s72, s71, 15360
buffer_load_dwordx4 v15, s[24:27], s72 offen offset:1024 lds
v_cvt_pk_bf16_f32 v93, v106, v107
v_mfma_f32_16x16x32_bf16 v[32:35], v[224:227], a[24:27], v[32:35]
s_nop 0
ds_read_b64_tr_b16 v[136:137], v10 offset:16384
ds_read_b64_tr_b16 v[138:139], v10 offset:18432
v_cvt_pk_bf16_f32 v94, v108, v109
v_mfma_f32_16x16x32_bf16 v[32:35], v[208:211], a[20:23], v[32:35]
s_nop 0
ds_read_b64_tr_b16 v[140:141], v11 offset:16384
ds_read_b64_tr_b16 v[142:143], v11 offset:18432
v_cvt_pk_bf16_f32 v95, v110, v111
v_mfma_f32_16x16x32_bf16 v[32:35], v[192:195], a[16:19], v[32:35]
s_add_u32 s72, s71, 30720
buffer_load_dwordx4 v15, s[24:27], s72 offen offset:2048 lds
v_mfma_f32_16x16x32_bf16 v[36:39], v[196:199], a[16:19], 0
v_mul_f32 v65, v65, v114
v_and_b32 v114, 0xffff0000, v50
v_mfma_f32_16x16x32_bf16 v[36:39], v[212:215], a[20:23], v[36:39]
s_nop 0
ds_read_b64_tr_b16 v[144:145], v8 offset:20480
ds_read_b64_tr_b16 v[146:147], v8 offset:22528
v_mfma_f32_16x16x32_bf16 v[36:39], v[228:231], a[24:27], v[36:39]
s_add_u32 s72, s71, 46080
buffer_load_dwordx4 v15, s[24:27], s72 offen offset:3072 lds
v_mfma_f32_16x16x32_bf16 v[36:39], v[244:247], a[28:31], v[36:39]
s_nop 0
ds_read_b64_tr_b16 v[148:149], v9 offset:20480
ds_read_b64_tr_b16 v[150:151], v9 offset:22528
v_mfma_f32_16x16x32_bf16 v[20:23], v[244:247], a[12:15], 0
s_nop 0
ds_read_b64_tr_b16 v[152:153], v10 offset:20480
ds_read_b64_tr_b16 v[154:155], v10 offset:22528
v_mfma_f32_16x16x32_bf16 v[20:23], v[228:231], a[8:11], v[20:23]
v_lshlrev_b32 v115, 16, v66
v_lshlrev_b32 v50, 16, v50
v_mfma_f32_16x16x32_bf16 v[20:23], v[212:215], a[4:7], v[20:23]
s_nop 0
ds_read_b64_tr_b16 v[156:157], v11 offset:20480
ds_read_b64_tr_b16 v[158:159], v11 offset:22528
v_mfma_f32_16x16x32_bf16 v[20:23], v[196:199], a[0:3], v[20:23]
s_nop 0
ds_read_b64_tr_b16 v[160:161], v8 offset:24576
ds_read_b64_tr_b16 v[162:163], v8 offset:26624
v_mfma_f32_16x16x32_bf16 v[24:27], v[200:203], a[0:3], 0
s_nop 0
ds_read_b64_tr_b16 v[164:165], v9 offset:24576
ds_read_b64_tr_b16 v[166:167], v9 offset:26624
v_mfma_f32_16x16x32_bf16 v[24:27], v[216:219], a[4:7], v[24:27]
v_and_b32 v66, 0xffff0000, v66
v_mul_f32 v50, v50, v112
v_mfma_f32_16x16x32_bf16 v[24:27], v[232:235], a[8:11], v[24:27]
buffer_store_dwordx4 v[88:91], v1, s[44:47], s80 offen offset:2048 sc1
v_mfma_f32_16x16x32_bf16 v[24:27], v[248:251], a[12:15], v[24:27]
s_nop 0
ds_read_b64_tr_b16 v[168:169], v10 offset:24576
ds_read_b64_tr_b16 v[170:171], v10 offset:26624
v_mfma_f32_16x16x32_bf16 v[40:43], v[248:251], a[28:31], 0
s_nop 0
ds_read_b64_tr_b16 v[172:173], v11 offset:24576
ds_read_b64_tr_b16 v[174:175], v11 offset:26624
v_mfma_f32_16x16x32_bf16 v[40:43], v[232:235], a[24:27], v[40:43]
s_nop 0
ds_read_b64_tr_b16 v[176:177], v8 offset:28672
ds_read_b64_tr_b16 v[178:179], v8 offset:30720
v_mfma_f32_16x16x32_bf16 v[40:43], v[216:219], a[20:23], v[40:43]
v_mul_f32 v114, v114, v112
v_mul_f32 v50, v50, v115
v_mfma_f32_16x16x32_bf16 v[40:43], v[200:203], a[16:19], v[40:43]
s_nop 0
ds_read_b64_tr_b16 v[180:181], v9 offset:28672
ds_read_b64_tr_b16 v[182:183], v9 offset:30720
v_mfma_f32_16x16x32_bf16 v[44:47], v[204:207], a[16:19], 0
s_nop 0
ds_read_b64_tr_b16 v[184:185], v10 offset:28672
ds_read_b64_tr_b16 v[186:187], v10 offset:30720
v_mfma_f32_16x16x32_bf16 v[44:47], v[220:223], a[20:23], v[44:47]
s_nop 0
ds_read_b64_tr_b16 v[188:189], v11 offset:28672
ds_read_b64_tr_b16 v[190:191], v11 offset:30720
v_mfma_f32_16x16x32_bf16 v[44:47], v[236:239], a[24:27], v[44:47]
Lstube4:
s_cbranch_execz Lrete
v_mul_f32 v66, v66, v114
v_and_b32 v114, 0xffff0000, v51
v_mfma_f32_16x16x32_bf16 v[44:47], v[252:255], a[28:31], v[44:47]
v_lshlrev_b32 v115, 16, v67
v_lshlrev_b32 v51, 16, v51
v_mfma_f32_16x16x32_bf16 v[28:31], v[252:255], a[12:15], 0
v_and_b32 v67, 0xffff0000, v67
v_mul_f32 v51, v51, v112
v_mfma_f32_16x16x32_bf16 v[28:31], v[236:239], a[8:11], v[28:31]
v_mul_f32 v114, v114, v112
v_mul_f32 v51, v51, v115
v_mfma_f32_16x16x32_bf16 v[28:31], v[220:223], a[4:7], v[28:31]
s_waitcnt lgkmcnt(0)
v_mul_f32 v67, v67, v114
v_and_b32 v114, 0xffff0000, v52
v_mfma_f32_16x16x32_bf16 v[28:31], v[204:207], a[0:3], v[28:31]
v_lshlrev_b32 v115, 16, v68
v_lshlrev_b32 v52, 16, v52
v_mfma_f32_16x16x32_bf16 v[16:19], v[128:131], a[32:35], v[16:19]
s_nop 0
ds_read_b64_tr_b16 v[192:193], v8 offset:32768
ds_read_b64_tr_b16 v[194:195], v8 offset:34816
v_mfma_f32_16x16x32_bf16 v[16:19], v[144:147], a[36:39], v[16:19]
s_nop 0
ds_read_b64_tr_b16 v[196:197], v9 offset:32768
ds_read_b64_tr_b16 v[198:199], v9 offset:34816
v_mfma_f32_16x16x32_bf16 v[16:19], v[160:163], a[40:43], v[16:19]
buffer_store_dwordx4 v[92:95], v1, s[44:47], s80 offen offset:3072 sc1
v_mfma_f32_16x16x32_bf16 v[16:19], v[176:179], a[44:47], v[16:19]
v_and_b32 v68, 0xffff0000, v68
v_mul_f32 v52, v52, v112
v_mfma_f32_16x16x32_bf16 v[32:35], v[176:179], a[60:63], v[32:35]
s_nop 0
ds_read_b64_tr_b16 v[200:201], v10 offset:32768
ds_read_b64_tr_b16 v[202:203], v10 offset:34816
v_mfma_f32_16x16x32_bf16 v[32:35], v[160:163], a[56:59], v[32:35]
s_nop 0
ds_read_b64_tr_b16 v[204:205], v11 offset:32768
ds_read_b64_tr_b16 v[206:207], v11 offset:34816
v_mfma_f32_16x16x32_bf16 v[32:35], v[144:147], a[52:55], v[32:35]
v_mul_f32 v114, v114, v112
v_mul_f32 v52, v52, v115
v_mfma_f32_16x16x32_bf16 v[32:35], v[128:131], a[48:51], v[32:35]
s_nop 0
ds_read_b64_tr_b16 v[208:209], v8 offset:36864
ds_read_b64_tr_b16 v[210:211], v8 offset:38912
v_mfma_f32_16x16x32_bf16 v[36:39], v[132:135], a[48:51], v[36:39]
v_mul_f32 v68, v68, v114
v_and_b32 v114, 0xffff0000, v53
v_mfma_f32_16x16x32_bf16 v[36:39], v[148:151], a[52:55], v[36:39]
s_nop 0
ds_read_b64_tr_b16 v[212:213], v9 offset:36864
ds_read_b64_tr_b16 v[214:215], v9 offset:38912
v_mfma_f32_16x16x32_bf16 v[36:39], v[164:167], a[56:59], v[36:39]
s_nop 0
ds_read_b64_tr_b16 v[216:217], v10 offset:36864
ds_read_b64_tr_b16 v[218:219], v10 offset:38912
v_mfma_f32_16x16x32_bf16 v[36:39], v[180:183], a[60:63], v[36:39]
v_lshlrev_b32 v115, 16, v69
v_lshlrev_b32 v53, 16, v53
v_mfma_f32_16x16x32_bf16 v[20:23], v[180:183], a[44:47], v[20:23]
s_nop 0
ds_read_b64_tr_b16 v[220:221], v11 offset:36864
ds_read_b64_tr_b16 v[222:223], v11 offset:38912
v_mfma_f32_16x16x32_bf16 v[20:23], v[164:167], a[40:43], v[20:23]
v_and_b32 v69, 0xffff0000, v69
v_mul_f32 v53, v53, v112
v_mfma_f32_16x16x32_bf16 v[20:23], v[148:151], a[36:39], v[20:23]
s_nop 0
ds_read_b64_tr_b16 v[224:225], v8 offset:40960
ds_read_b64_tr_b16 v[226:227], v8 offset:43008
v_mfma_f32_16x16x32_bf16 v[20:23], v[132:135], a[32:35], v[20:23]
s_nop 0
ds_read_b64_tr_b16 v[228:229], v9 offset:40960
ds_read_b64_tr_b16 v[230:231], v9 offset:43008
v_mfma_f32_16x16x32_bf16 v[24:27], v[136:139], a[32:35], v[24:27]
v_mul_f32 v114, v114, v112
v_mul_f32 v53, v53, v115
v_mfma_f32_16x16x32_bf16 v[24:27], v[152:155], a[36:39], v[24:27]
s_nop 0
ds_read_b64_tr_b16 v[232:233], v10 offset:40960
ds_read_b64_tr_b16 v[234:235], v10 offset:43008
v_mfma_f32_16x16x32_bf16 v[24:27], v[168:171], a[40:43], v[24:27]
s_nop 0
ds_read_b64_tr_b16 v[236:237], v11 offset:40960
ds_read_b64_tr_b16 v[238:239], v11 offset:43008
v_mfma_f32_16x16x32_bf16 v[24:27], v[184:187], a[44:47], v[24:27]
v_mul_f32 v69, v69, v114
v_and_b32 v114, 0xffff0000, v54
v_mfma_f32_16x16x32_bf16 v[40:43], v[184:187], a[60:63], v[40:43]
s_nop 0
ds_read_b64_tr_b16 v[240:241], v8 offset:45056
ds_read_b64_tr_b16 v[242:243], v8 offset:47104
v_mfma_f32_16x16x32_bf16 v[40:43], v[168:171], a[56:59], v[40:43]
v_lshlrev_b32 v115, 16, v70
v_lshlrev_b32 v54, 16, v54
v_mfma_f32_16x16x32_bf16 v[40:43], v[152:155], a[52:55], v[40:43]
s_nop 0
ds_read_b64_tr_b16 v[244:245], v9 offset:45056
ds_read_b64_tr_b16 v[246:247], v9 offset:47104
v_mfma_f32_16x16x32_bf16 v[40:43], v[136:139], a[48:51], v[40:43]
s_nop 0
ds_read_b64_tr_b16 v[248:249], v10 offset:45056
ds_read_b64_tr_b16 v[250:251], v10 offset:47104
v_mfma_f32_16x16x32_bf16 v[44:47], v[140:143], a[48:51], v[44:47]
v_and_b32 v70, 0xffff0000, v70
v_mul_f32 v54, v54, v112
v_mfma_f32_16x16x32_bf16 v[44:47], v[156:159], a[52:55], v[44:47]
s_nop 0
ds_read_b64_tr_b16 v[252:253], v11 offset:45056
ds_read_b64_tr_b16 v[254:255], v11 offset:47104
v_mfma_f32_16x16x32_bf16 v[44:47], v[172:175], a[56:59], v[44:47]
v_mul_f32 v114, v114, v112
v_mul_f32 v54, v54, v115
v_mfma_f32_16x16x32_bf16 v[44:47], v[188:191], a[60:63], v[44:47]
v_mul_f32 v70, v70, v114
v_and_b32 v114, 0xffff0000, v55
v_mfma_f32_16x16x32_bf16 v[28:31], v[188:191], a[44:47], v[28:31]
v_lshlrev_b32 v115, 16, v71
v_lshlrev_b32 v55, 16, v55
v_mfma_f32_16x16x32_bf16 v[28:31], v[172:175], a[40:43], v[28:31]
s_add_u32 s79, s93, 0x3a00000
v_and_b32 v71, 0xffff0000, v71
v_mul_f32 v55, v55, v112
v_mfma_f32_16x16x32_bf16 v[28:31], v[156:159], a[36:39], v[28:31]
s_waitcnt vmcnt(18) lgkmcnt(0)
buffer_load_dwordx4 v[96:99], v1, s[44:47], s79 offen sc1
v_mfma_f32_16x16x32_bf16 v[28:31], v[140:143], a[32:35], v[28:31]
s_barrier
v_mul_f32 v114, v114, v112
v_mul_f32 v55, v55, v115
v_mfma_f32_16x16x32_bf16 v[16:19], v[192:195], a[64:67], v[16:19]
s_nop 0
ds_read_b64_tr_b16 v[128:129], v8 offset:49152
ds_read_b64_tr_b16 v[130:131], v8 offset:51200
v_mfma_f32_16x16x32_bf16 v[16:19], v[208:211], a[68:71], v[16:19]
s_nop 0
ds_read_b64_tr_b16 v[132:133], v9 offset:49152
ds_read_b64_tr_b16 v[134:135], v9 offset:51200
v_mfma_f32_16x16x32_bf16 v[16:19], v[224:227], a[72:75], v[16:19]
v_mul_f32 v71, v71, v114
v_and_b32 v114, 0xffff0000, v56
v_mfma_f32_16x16x32_bf16 v[16:19], v[240:243], a[76:79], v[16:19]
buffer_load_dwordx4 v[100:103], v1, s[44:47], s79 offen offset:1024 sc1
v_mfma_f32_16x16x32_bf16 v[32:35], v[240:243], a[92:95], v[32:35]
s_nop 0
ds_read_b64_tr_b16 v[136:137], v10 offset:49152
ds_read_b64_tr_b16 v[138:139], v10 offset:51200
v_mfma_f32_16x16x32_bf16 v[32:35], v[224:227], a[88:91], v[32:35]
s_nop 0
ds_read_b64_tr_b16 v[140:141], v11 offset:49152
ds_read_b64_tr_b16 v[142:143], v11 offset:51200
v_mfma_f32_16x16x32_bf16 v[32:35], v[208:211], a[84:87], v[32:35]
v_lshlrev_b32 v115, 16, v72
v_lshlrev_b32 v56, 16, v56
v_mfma_f32_16x16x32_bf16 v[32:35], v[192:195], a[80:83], v[32:35]
s_nop 0
ds_read_b64_tr_b16 v[144:145], v8 offset:53248
ds_read_b64_tr_b16 v[146:147], v8 offset:55296
v_mfma_f32_16x16x32_bf16 v[36:39], v[196:199], a[80:83], v[36:39]
buffer_load_dwordx4 v[104:107], v1, s[44:47], s79 offen offset:2048 sc1
v_mfma_f32_16x16x32_bf16 v[36:39], v[212:215], a[84:87], v[36:39]
s_nop 0
ds_read_b64_tr_b16 v[148:149], v9 offset:53248
ds_read_b64_tr_b16 v[150:151], v9 offset:55296
v_mfma_f32_16x16x32_bf16 v[36:39], v[228:231], a[88:91], v[36:39]
v_and_b32 v72, 0xffff0000, v72
v_mul_f32 v56, v56, v113
v_mfma_f32_16x16x32_bf16 v[36:39], v[244:247], a[92:95], v[36:39]
s_nop 0
ds_read_b64_tr_b16 v[152:153], v10 offset:53248
ds_read_b64_tr_b16 v[154:155], v10 offset:55296
v_mfma_f32_16x16x32_bf16 v[20:23], v[244:247], a[76:79], v[20:23]
s_nop 0
ds_read_b64_tr_b16 v[156:157], v11 offset:53248
ds_read_b64_tr_b16 v[158:159], v11 offset:55296
v_mfma_f32_16x16x32_bf16 v[20:23], v[228:231], a[72:75], v[20:23]
buffer_load_dwordx4 v[108:111], v1, s[44:47], s79 offen offset:3072 sc1
v_mfma_f32_16x16x32_bf16 v[20:23], v[212:215], a[68:71], v[20:23]
v_mul_f32 v114, v114, v113
v_mul_f32 v56, v56, v115
v_mfma_f32_16x16x32_bf16 v[20:23], v[196:199], a[64:67], v[20:23]
s_nop 0
ds_read_b64_tr_b16 v[160:161], v8 offset:57344
ds_read_b64_tr_b16 v[162:163], v8 offset:59392
v_mfma_f32_16x16x32_bf16 v[24:27], v[200:203], a[64:67], v[24:27]
s_nop 0
ds_read_b64_tr_b16 v[164:165], v9 offset:57344
ds_read_b64_tr_b16 v[166:167], v9 offset:59392
v_mfma_f32_16x16x32_bf16 v[24:27], v[216:219], a[68:71], v[24:27]
v_mul_f32 v72, v72, v114
v_and_b32 v114, 0xffff0000, v57
v_mfma_f32_16x16x32_bf16 v[24:27], v[232:235], a[72:75], v[24:27]
s_nop 0
ds_read_b64_tr_b16 v[168:169], v10 offset:57344
ds_read_b64_tr_b16 v[170:171], v10 offset:59392
v_mfma_f32_16x16x32_bf16 v[24:27], v[248:251], a[76:79], v[24:27]
s_nop 0
ds_read_b64_tr_b16 v[172:173], v11 offset:57344
ds_read_b64_tr_b16 v[174:175], v11 offset:59392
v_mfma_f32_16x16x32_bf16 v[40:43], v[248:251], a[92:95], v[40:43]
v_lshlrev_b32 v115, 16, v73
v_lshlrev_b32 v57, 16, v57
v_mfma_f32_16x16x32_bf16 v[40:43], v[232:235], a[88:91], v[40:43]
s_nop 0
ds_read_b64_tr_b16 v[176:177], v8 offset:61440
ds_read_b64_tr_b16 v[178:179], v8 offset:63488
v_mfma_f32_16x16x32_bf16 v[40:43], v[216:219], a[84:87], v[40:43]
s_nop 0
ds_read_b64_tr_b16 v[180:181], v9 offset:61440
ds_read_b64_tr_b16 v[182:183], v9 offset:63488
v_mfma_f32_16x16x32_bf16 v[40:43], v[200:203], a[80:83], v[40:43]
v_and_b32 v73, 0xffff0000, v73
v_mul_f32 v57, v57, v113
v_mfma_f32_16x16x32_bf16 v[44:47], v[204:207], a[80:83], v[44:47]
s_nop 0
ds_read_b64_tr_b16 v[184:185], v10 offset:61440
ds_read_b64_tr_b16 v[186:187], v10 offset:63488
v_mfma_f32_16x16x32_bf16 v[44:47], v[220:223], a[84:87], v[44:47]
s_nop 0
ds_read_b64_tr_b16 v[188:189], v11 offset:61440
ds_read_b64_tr_b16 v[190:191], v11 offset:63488
v_mfma_f32_16x16x32_bf16 v[44:47], v[236:239], a[88:91], v[44:47]
v_mul_f32 v114, v114, v113
v_mul_f32 v57, v57, v115
v_mfma_f32_16x16x32_bf16 v[44:47], v[252:255], a[92:95], v[44:47]
v_mul_f32 v73, v73, v114
v_and_b32 v114, 0xffff0000, v58
v_mfma_f32_16x16x32_bf16 v[28:31], v[252:255], a[76:79], v[28:31]
v_xor_b32 v8, 0x10000, v8
v_lshlrev_b32 v115, 16, v74
v_mfma_f32_16x16x32_bf16 v[28:31], v[236:239], a[72:75], v[28:31]
v_xor_b32 v9, 0x10000, v9
v_lshlrev_b32 v58, 16, v58
v_mfma_f32_16x16x32_bf16 v[28:31], v[220:223], a[68:71], v[28:31]
s_waitcnt lgkmcnt(0)
v_xor_b32 v10, 0x10000, v10
v_and_b32 v74, 0xffff0000, v74
v_mfma_f32_16x16x32_bf16 v[28:31], v[204:207], a[64:67], v[28:31]
v_xor_b32 v11, 0x10000, v11
v_mul_f32 v58, v58, v113
v_mfma_f32_16x16x32_bf16 v[16:19], v[128:131], a[96:99], v[16:19]
s_nop 0
ds_read_b64_tr_b16 v[192:193], v8 offset:0
ds_read_b64_tr_b16 v[194:195], v8 offset:2048
v_mfma_f32_16x16x32_bf16 v[16:19], v[144:147], a[100:103], v[16:19]
s_nop 0
ds_read_b64_tr_b16 v[196:197], v9 offset:0
ds_read_b64_tr_b16 v[198:199], v9 offset:2048
v_mfma_f32_16x16x32_bf16 v[16:19], v[160:163], a[104:107], v[16:19]
v_mul_f32 v114, v114, v113
v_mul_f32 v58, v58, v115
v_mfma_f32_16x16x32_bf16 v[16:19], v[176:179], a[108:111], v[16:19]
s_nop 0
ds_read_b64_tr_b16 v[200:201], v10 offset:0
ds_read_b64_tr_b16 v[202:203], v10 offset:2048
v_mfma_f32_16x16x32_bf16 v[32:35], v[176:179], a[124:127], v[32:35]
v_mul_f32 v74, v74, v114
v_and_b32 v114, 0xffff0000, v59
v_mfma_f32_16x16x32_bf16 v[32:35], v[160:163], a[120:123], v[32:35]
s_nop 0
ds_read_b64_tr_b16 v[204:205], v11 offset:0
ds_read_b64_tr_b16 v[206:207], v11 offset:2048
v_mfma_f32_16x16x32_bf16 v[32:35], v[144:147], a[116:119], v[32:35]
s_nop 0
ds_read_b64_tr_b16 v[208:209], v8 offset:4096
ds_read_b64_tr_b16 v[210:211], v8 offset:6144
v_mfma_f32_16x16x32_bf16 v[32:35], v[128:131], a[112:115], v[32:35]
v_lshlrev_b32 v115, 16, v75
v_lshlrev_b32 v59, 16, v59
v_mfma_f32_16x16x32_bf16 v[36:39], v[132:135], a[112:115], v[36:39]
s_nop 0
ds_read_b64_tr_b16 v[212:213], v9 offset:4096
ds_read_b64_tr_b16 v[214:215], v9 offset:6144
v_mfma_f32_16x16x32_bf16 v[36:39], v[148:151], a[116:119], v[36:39]
v_and_b32 v75, 0xffff0000, v75
v_mul_f32 v59, v59, v113
v_mfma_f32_16x16x32_bf16 v[36:39], v[164:167], a[120:123], v[36:39]
s_nop 0
ds_read_b64_tr_b16 v[216:217], v10 offset:4096
ds_read_b64_tr_b16 v[218:219], v10 offset:6144
v_mfma_f32_16x16x32_bf16 v[36:39], v[180:183], a[124:127], v[36:39]
s_nop 0
ds_read_b64_tr_b16 v[220:221], v11 offset:4096
ds_read_b64_tr_b16 v[222:223], v11 offset:6144
v_mfma_f32_16x16x32_bf16 v[20:23], v[180:183], a[108:111], v[20:23]
v_mul_f32 v114, v114, v113
v_mul_f32 v59, v59, v115
v_mfma_f32_16x16x32_bf16 v[20:23], v[164:167], a[104:107], v[20:23]
s_nop 0
ds_read_b64_tr_b16 v[224:225], v8 offset:8192
ds_read_b64_tr_b16 v[226:227], v8 offset:10240
v_mfma_f32_16x16x32_bf16 v[20:23], v[148:151], a[100:103], v[20:23]
v_mul_f32 v75, v75, v114
v_and_b32 v114, 0xffff0000, v60
v_mfma_f32_16x16x32_bf16 v[20:23], v[132:135], a[96:99], v[20:23]
s_nop 0
ds_read_b64_tr_b16 v[228:229], v9 offset:8192
ds_read_b64_tr_b16 v[230:231], v9 offset:10240
v_mfma_f32_16x16x32_bf16 v[24:27], v[136:139], a[96:99], v[24:27]
s_nop 0
ds_read_b64_tr_b16 v[232:233], v10 offset:8192
ds_read_b64_tr_b16 v[234:235], v10 offset:10240
v_mfma_f32_16x16x32_bf16 v[24:27], v[152:155], a[100:103], v[24:27]
v_lshlrev_b32 v115, 16, v76
v_lshlrev_b32 v60, 16, v60
v_mfma_f32_16x16x32_bf16 v[24:27], v[168:171], a[104:107], v[24:27]
s_nop 0
ds_read_b64_tr_b16 v[236:237], v11 offset:8192
ds_read_b64_tr_b16 v[238:239], v11 offset:10240
v_mfma_f32_16x16x32_bf16 v[24:27], v[184:187], a[108:111], v[24:27]
v_and_b32 v76, 0xffff0000, v76
v_mul_f32 v60, v60, v113
v_mfma_f32_16x16x32_bf16 v[40:43], v[184:187], a[124:127], v[40:43]
s_nop 0
ds_read_b64_tr_b16 v[240:241], v8 offset:12288
ds_read_b64_tr_b16 v[242:243], v8 offset:14336
v_mfma_f32_16x16x32_bf16 v[40:43], v[168:171], a[120:123], v[40:43]
s_nop 0
ds_read_b64_tr_b16 v[244:245], v9 offset:12288
ds_read_b64_tr_b16 v[246:247], v9 offset:14336
v_mfma_f32_16x16x32_bf16 v[40:43], v[152:155], a[116:119], v[40:43]
v_mul_f32 v114, v114, v113
v_mul_f32 v60, v60, v115
v_mfma_f32_16x16x32_bf16 v[40:43], v[136:139], a[112:115], v[40:43]
s_nop 0
ds_read_b64_tr_b16 v[248:249], v10 offset:12288
ds_read_b64_tr_b16 v[250:251], v10 offset:14336
v_mfma_f32_16x16x32_bf16 v[44:47], v[140:143], a[112:115], v[44:47]
v_mul_f32 v76, v76, v114
v_and_b32 v114, 0xffff0000, v61
v_mfma_f32_16x16x32_bf16 v[44:47], v[156:159], a[116:119], v[44:47]
s_nop 0
ds_read_b64_tr_b16 v[252:253], v11 offset:12288
ds_read_b64_tr_b16 v[254:255], v11 offset:14336
v_mfma_f32_16x16x32_bf16 v[44:47], v[172:175], a[120:123], v[44:47]
v_lshlrev_b32 v115, 16, v77
v_lshlrev_b32 v61, 16, v61
v_mfma_f32_16x16x32_bf16 v[44:47], v[188:191], a[124:127], v[44:47]
s_waitcnt vmcnt(0)
v_max3_u32 v12, v96, v97, v98
v_max3_u32 v13, v99, v100, v101
v_mfma_f32_16x16x32_bf16 v[28:31], v[188:191], a[108:111], v[28:31]
v_max3_u32 v12, v12, v102, v103
v_max3_u32 v13, v13, v104, v105
v_mfma_f32_16x16x32_bf16 v[28:31], v[172:175], a[104:107], v[28:31]
v_max3_u32 v12, v12, v106, v107
v_max3_u32 v13, v13, v108, v109
v_mfma_f32_16x16x32_bf16 v[28:31], v[156:159], a[100:103], v[28:31]
s_waitcnt vmcnt(12) lgkmcnt(0)
v_max3_u32 v12, v12, v110, v111
v_and_b32 v77, 0xffff0000, v77
v_mfma_f32_16x16x32_bf16 v[28:31], v[140:143], a[96:99], v[28:31]
s_barrier
v_max_u32 v12, v12, v13
v_mul_f32 v61, v61, v113
v_mfma_f32_16x16x32_bf16 v[16:19], v[192:195], a[128:131], v[16:19]
v_cmp_le_u32 vcc, 0xff800000, v12
v_mul_f32 v114, v114, v113
v_mfma_f32_16x16x32_bf16 v[16:19], v[208:211], a[132:135], v[16:19]
s_nop 0
ds_read_b64_tr_b16 v[128:129], v8 offset:16384
ds_read_b64_tr_b16 v[130:131], v8 offset:18432
v_mfma_f32_16x16x32_bf16 v[16:19], v[224:227], a[136:139], v[16:19]
s_cbranch_vccnz Lxspin1
Lxback1:
ds_read_b64_tr_b16 v[132:133], v9 offset:16384
ds_read_b64_tr_b16 v[134:135], v9 offset:18432
v_mfma_f32_16x16x32_bf16 v[16:19], v[240:243], a[140:143], v[16:19]
v_mul_f32 v61, v61, v115
v_mul_f32 v77, v77, v114
v_mfma_f32_16x16x32_bf16 v[16:19], v[124:127], v[96:99], v[16:19]
s_nop 0
ds_read_b64_tr_b16 v[136:137], v10 offset:16384
ds_read_b64_tr_b16 v[138:139], v10 offset:18432
v_mfma_f32_16x16x32_bf16 v[32:35], v[240:243], a[156:159], v[32:35]
v_and_b32 v114, 0xffff0000, v62
v_lshlrev_b32 v115, 16, v78
v_mfma_f32_16x16x32_bf16 v[32:35], v[224:227], a[152:155], v[32:35]
s_add_u32 s82, s93, 0x3e00000
buffer_load_dwordx4 v[80:83], v1, s[44:47], s82 offen sc1
v_mfma_f32_16x16x32_bf16 v[32:35], v[208:211], a[148:151], v[32:35]
s_nop 0
ds_read_b64_tr_b16 v[140:141], v11 offset:16384
ds_read_b64_tr_b16 v[142:143], v11 offset:18432
v_mfma_f32_16x16x32_bf16 v[32:35], v[192:195], a[144:147], v[32:35]
v_lshlrev_b32 v62, 16, v62
v_and_b32 v78, 0xffff0000, v78
v_mfma_f32_16x16x32_bf16 v[32:35], v[124:127], v[104:107], v[32:35]
s_nop 0
ds_read_b64_tr_b16 v[144:145], v8 offset:20480
ds_read_b64_tr_b16 v[146:147], v8 offset:22528
v_mfma_f32_16x16x32_bf16 v[36:39], v[196:199], a[144:147], v[36:39]
v_mul_f32 v62, v62, v113
v_mul_f32 v114, v114, v113
v_mfma_f32_16x16x32_bf16 v[36:39], v[212:215], a[148:151], v[36:39]
buffer_load_dwordx4 v[84:87], v1, s[44:47], s82 offen offset:1024 sc1
v_mfma_f32_16x16x32_bf16 v[36:39], v[228:231], a[152:155], v[36:39]
s_nop 0
ds_read_b64_tr_b16 v[148:149], v9 offset:20480
ds_read_b64_tr_b16 v[150:151], v9 offset:22528
v_mfma_f32_16x16x32_bf16 v[36:39], v[244:247], a[156:159], v[36:39]
v_mul_f32 v62, v62, v115
v_mul_f32 v78, v78, v114
v_mfma_f32_16x16x32_bf16 v[36:39], v[120:123], v[104:107], v[36:39]
s_nop 0
ds_read_b64_tr_b16 v[152:153], v10 offset:20480
ds_read_b64_tr_b16 v[154:155], v10 offset:22528
v_mfma_f32_16x16x32_bf16 v[20:23], v[244:247], a[140:143], v[20:23]
v_and_b32 v114, 0xffff0000, v63
v_lshlrev_b32 v115, 16, v79
v_mfma_f32_16x16x32_bf16 v[20:23], v[228:231], a[136:139], v[20:23]
buffer_load_dwordx4 v[88:91], v1, s[44:47], s82 offen offset:2048 sc1
v_mfma_f32_16x16x32_bf16 v[20:23], v[212:215], a[132:135], v[20:23]
s_nop 0
ds_read_b64_tr_b16 v[156:157], v11 offset:20480
ds_read_b64_tr_b16 v[158:159], v11 offset:22528
v_mfma_f32_16x16x32_bf16 v[20:23], v[196:199], a[128:131], v[20:23]
v_lshlrev_b32 v63, 16, v63
v_and_b32 v79, 0xffff0000, v79
v_mfma_f32_16x16x32_bf16 v[20:23], v[120:123], v[96:99], v[20:23]
s_nop 0
ds_read_b64_tr_b16 v[160:161], v8 offset:24576
ds_read_b64_tr_b16 v[162:163], v8 offset:26624
v_mfma_f32_16x16x32_bf16 v[24:27], v[200:203], a[128:131], v[24:27]
s_nop 0
ds_read_b64_tr_b16 v[164:165], v9 offset:24576
ds_read_b64_tr_b16 v[166:167], v9 offset:26624
v_mfma_f32_16x16x32_bf16 v[24:27], v[216:219], a[132:135], v[24:27]
buffer_load_dwordx4 v[92:95], v1, s[44:47], s82 offen offset:3072 sc1
v_mfma_f32_16x16x32_bf16 v[24:27], v[232:235], a[136:139], v[24:27]
v_mul_f32 v63, v63, v113
v_mul_f32 v114, v114, v113
v_mfma_f32_16x16x32_bf16 v[24:27], v[248:251], a[140:143], v[24:27]
s_nop 0
ds_read_b64_tr_b16 v[168:169], v10 offset:24576
ds_read_b64_tr_b16 v[170:171], v10 offset:26624
v_mfma_f32_16x16x32_bf16 v[24:27], v[124:127], v[100:103], v[24:27]
v_mul_f32 v63, v63, v115
v_mul_f32 v79, v79, v114
v_mfma_f32_16x16x32_bf16 v[40:43], v[248:251], a[156:159], v[40:43]
s_nop 0
ds_read_b64_tr_b16 v[172:173], v11 offset:24576
ds_read_b64_tr_b16 v[174:175], v11 offset:26624
v_mfma_f32_16x16x32_bf16 v[40:43], v[232:235], a[152:155], v[40:43]
v_mfma_f32_16x16x32_bf16 v[40:43], v[216:219], a[148:151], v[40:43]
s_nop 0
ds_read_b64_tr_b16 v[176:177], v8 offset:28672
ds_read_b64_tr_b16 v[178:179], v8 offset:30720
v_mfma_f32_16x16x32_bf16 v[40:43], v[200:203], a[144:147], v[40:43]
v_mfma_f32_16x16x32_bf16 v[40:43], v[124:127], v[108:111], v[40:43]
s_nop 0
ds_read_b64_tr_b16 v[180:181], v9 offset:28672
ds_read_b64_tr_b16 v[182:183], v9 offset:30720
v_mfma_f32_16x16x32_bf16 v[44:47], v[204:207], a[144:147], v[44:47]
v_mfma_f32_16x16x32_bf16 v[44:47], v[220:223], a[148:151], v[44:47]
s_nop 0
ds_read_b64_tr_b16 v[184:185], v10 offset:28672
ds_read_b64_tr_b16 v[186:187], v10 offset:30720
v_mfma_f32_16x16x32_bf16 v[44:47], v[236:239], a[152:155], v[44:47]
v_mfma_f32_16x16x32_bf16 v[44:47], v[252:255], a[156:159], v[44:47]
s_nop 0
ds_read_b64_tr_b16 v[188:189], v11 offset:28672
ds_read_b64_tr_b16 v[190:191], v11 offset:30720
v_mfma_f32_16x16x32_bf16 v[44:47], v[120:123], v[108:111], v[44:47]
v_mfma_f32_16x16x32_bf16 v[28:31], v[252:255], a[140:143], v[28:31]
v_mfma_f32_16x16x32_bf16 v[28:31], v[236:239], a[136:139], v[28:31]
v_mfma_f32_16x16x32_bf16 v[28:31], v[220:223], a[132:135], v[28:31]
v_mfma_f32_16x16x32_bf16 v[28:31], v[204:207], a[128:131], v[28:31]
s_waitcnt lgkmcnt(0)
v_mfma_f32_16x16x32_bf16 v[28:31], v[120:123], v[100:103], v[28:31]
v_mfma_f32_16x16x32_bf16 v[16:19], v[128:131], a[160:163], v[16:19]
s_nop 0
ds_read_b64_tr_b16 v[192:193], v8 offset:32768
ds_read_b64_tr_b16 v[194:195], v8 offset:34816
v_mfma_f32_16x16x32_bf16 v[16:19], v[144:147], a[164:167], v[16:19]
s_nop 0
ds_read_b64_tr_b16 v[196:197], v9 offset:32768
ds_read_b64_tr_b16 v[198:199], v9 offset:34816
v_mfma_f32_16x16x32_bf16 v[16:19], v[160:163], a[168:171], v[16:19]
s_nop 0
ds_read_b64_tr_b16 v[200:201], v10 offset:32768
ds_read_b64_tr_b16 v[202:203], v10 offset:34816
v_mfma_f32_16x16x32_bf16 v[16:19], v[176:179], a[172:175], v[16:19]
v_mfma_f32_16x16x32_bf16 v[32:35], v[176:179], a[188:191], v[32:35]
s_nop 0
ds_read_b64_tr_b16 v[204:205], v11 offset:32768
ds_read_b64_tr_b16 v[206:207], v11 offset:34816
v_mfma_f32_16x16x32_bf16 v[32:35], v[160:163], a[184:187], v[32:35]
s_nop 0
ds_read_b64_tr_b16 v[208:209], v8 offset:36864
ds_read_b64_tr_b16 v[210:211], v8 offset:38912
v_mfma_f32_16x16x32_bf16 v[32:35], v[144:147], a[180:183], v[32:35]
s_add_u32 s81, s93, 0x4200000
buffer_load_dwordx4 v[96:99], v1, s[44:47], s81 offen sc1
v_mfma_f32_16x16x32_bf16 v[32:35], v[128:131], a[176:179], v[32:35]
v_mfma_f32_16x16x32_bf16 v[36:39], v[132:135], a[176:179], v[36:39]
s_nop 0
ds_read_b64_tr_b16 v[212:213], v9 offset:36864
ds_read_b64_tr_b16 v[214:215], v9 offset:38912
v_mfma_f32_16x16x32_bf16 v[36:39], v[148:151], a[180:183], v[36:39]
s_nop 0
ds_read_b64_tr_b16 v[216:217], v10 offset:36864
ds_read_b64_tr_b16 v[218:219], v10 offset:38912
v_mfma_f32_16x16x32_bf16 v[36:39], v[164:167], a[184:187], v[36:39]
v_mfma_f32_16x16x32_bf16 v[36:39], v[180:183], a[188:191], v[36:39]
buffer_load_dwordx4 v[100:103], v1, s[44:47], s81 offen offset:1024 sc1
v_mfma_f32_16x16x32_bf16 v[20:23], v[180:183], a[172:175], v[20:23]
s_nop 0
ds_read_b64_tr_b16 v[220:221], v11 offset:36864
ds_read_b64_tr_b16 v[222:223], v11 offset:38912
v_mfma_f32_16x16x32_bf16 v[20:23], v[164:167], a[168:171], v[20:23]
s_nop 0
ds_read_b64_tr_b16 v[224:225], v8 offset:40960
ds_read_b64_tr_b16 v[226:227], v8 offset:43008
v_mfma_f32_16x16x32_bf16 v[20:23], v[148:151], a[164:167], v[20:23]
s_nop 0
ds_read_b64_tr_b16 v[228:229], v9 offset:40960
ds_read_b64_tr_b16 v[230:231], v9 offset:43008
v_mfma_f32_16x16x32_bf16 v[20:23], v[132:135], a[160:163], v[20:23]
v_mfma_f32_16x16x32_bf16 v[24:27], v[136:139], a[160:163], v[24:27]
buffer_load_dwordx4 v[104:107], v1, s[44:47], s81 offen offset:2048 sc1
v_mfma_f32_16x16x32_bf16 v[24:27], v[152:155], a[164:167], v[24:27]
s_nop 0
ds_read_b64_tr_b16 v[232:233], v10 offset:40960
ds_read_b64_tr_b16 v[234:235], v10 offset:43008
v_mfma_f32_16x16x32_bf16 v[24:27], v[168:171], a[168:171], v[24:27]
s_nop 0
ds_read_b64_tr_b16 v[236:237], v11 offset:40960
ds_read_b64_tr_b16 v[238:239], v11 offset:43008
v_mfma_f32_16x16x32_bf16 v[24:27], v[184:187], a[172:175], v[24:27]
v_mfma_f32_16x16x32_bf16 v[40:43], v[184:187], a[188:191], v[40:43]
s_nop 0
ds_read_b64_tr_b16 v[240:241], v8 offset:45056
ds_read_b64_tr_b16 v[242:243], v8 offset:47104
v_mfma_f32_16x16x32_bf16 v[40:43], v[168:171], a[184:187], v[40:43]
buffer_load_dwordx4 v[108:111], v1, s[44:47], s81 offen offset:3072 sc1
v_mfma_f32_16x16x32_bf16 v[40:43], v[152:155], a[180:183], v[40:43]
s_nop 0
ds_read_b64_tr_b16 v[244:245], v9 offset:45056
ds_read_b64_tr_b16 v[246:247], v9 offset:47104
v_mfma_f32_16x16x32_bf16 v[40:43], v[136:139], a[176:179], v[40:43]
v_mfma_f32_16x16x32_bf16 v[44:47], v[140:143], a[176:179], v[44:47]
s_nop 0
ds_read_b64_tr_b16 v[248:249], v10 offset:45056
ds_read_b64_tr_b16 v[250:251], v10 offset:47104
v_mfma_f32_16x16x32_bf16 v[44:47], v[156:159], a[180:183], v[44:47]
s_nop 0
ds_read_b64_tr_b16 v[252:253], v11 offset:45056
ds_read_b64_tr_b16 v[254:255], v11 offset:47104
v_mfma_f32_16x16x32_bf16 v[44:47], v[172:175], a[184:187], v[44:47]
v_mfma_f32_16x16x32_bf16 v[44:47], v[188:191], a[188:191], v[44:47]
s_waitcnt vmcnt(4)
v_max3_u32 v12, v80, v81, v82
v_max3_u32 v13, v83, v84, v85
v_mfma_f32_16x16x32_bf16 v[28:31], v[188:191], a[172:175], v[28:31]
v_max3_u32 v12, v12, v86, v87
v_max3_u32 v13, v13, v88, v89
v_mfma_f32_16x16x32_bf16 v[28:31], v[172:175], a[168:171], v[28:31]
v_max3_u32 v12, v12, v90, v91
v_max3_u32 v13, v13, v92, v93
v_mfma_f32_16x16x32_bf16 v[28:31], v[156:159], a[164:167], v[28:31]
s_waitcnt vmcnt(14) lgkmcnt(0)
v_max3_u32 v12, v12, v94, v95
v_mfma_f32_16x16x32_bf16 v[28:31], v[140:143], a[160:163], v[28:31]
s_barrier
v_max_u32 v12, v12, v13
v_mfma_f32_16x16x32_bf16 v[16:19], v[192:195], a[192:195], v[16:19]
v_cmp_le_u32 vcc, 0xff800000, v12
v_mfma_f32_16x16x32_bf16 v[16:19], v[208:211], a[196:199], v[16:19]
s_nop 0
ds_read_b64_tr_b16 v[128:129], v8 offset:49152
ds_read_b64_tr_b16 v[130:131], v8 offset:51200
v_mfma_f32_16x16x32_bf16 v[16:19], v[224:227], a[200:203], v[16:19]
s_cbranch_vccnz Lxspin2
Lxback2:
v_mfma_f32_16x16x32_bf16 v[16:19], v[240:243], a[204:207], v[16:19]
s_nop 0
ds_read_b64_tr_b16 v[132:133], v9 offset:49152
ds_read_b64_tr_b16 v[134:135], v9 offset:51200
v_mfma_f32_16x16x32_bf16 v[16:19], v[124:127], v[80:83], v[16:19]
v_mfma_f32_16x16x32_bf16 v[32:35], v[240:243], a[220:223], v[32:35]
s_nop 0
ds_read_b64_tr_b16 v[136:137], v10 offset:49152
ds_read_b64_tr_b16 v[138:139], v10 offset:51200
v_mfma_f32_16x16x32_bf16 v[32:35], v[224:227], a[216:219], v[32:35]
v_mfma_f32_16x16x32_bf16 v[32:35], v[208:211], a[212:215], v[32:35]
s_nop 0
ds_read_b64_tr_b16 v[140:141], v11 offset:49152
ds_read_b64_tr_b16 v[142:143], v11 offset:51200
v_mfma_f32_16x16x32_bf16 v[32:35], v[192:195], a[208:211], v[32:35]
v_mfma_f32_16x16x32_bf16 v[32:35], v[124:127], v[88:91], v[32:35]
s_nop 0
ds_read_b64_tr_b16 v[144:145], v8 offset:53248
ds_read_b64_tr_b16 v[146:147], v8 offset:55296
v_mfma_f32_16x16x32_bf16 v[36:39], v[196:199], a[208:211], v[36:39]
v_mfma_f32_16x16x32_bf16 v[36:39], v[212:215], a[212:215], v[36:39]
s_nop 0
ds_read_b64_tr_b16 v[148:149], v9 offset:53248
ds_read_b64_tr_b16 v[150:151], v9 offset:55296
v_mfma_f32_16x16x32_bf16 v[36:39], v[228:231], a[216:219], v[36:39]
v_mfma_f32_16x16x32_bf16 v[36:39], v[244:247], a[220:223], v[36:39]
s_nop 0
ds_read_b64_tr_b16 v[152:153], v10 offset:53248
ds_read_b64_tr_b16 v[154:155], v10 offset:55296
v_mfma_f32_16x16x32_bf16 v[36:39], v[120:123], v[88:91], v[36:39]
Lstube5:
s_cbranch_execz Lrete
v_mfma_f32_16x16x32_bf16 v[20:23], v[244:247], a[204:207], v[20:23]
s_nop 0
ds_read_b64_tr_b16 v[156:157], v11 offset:53248
ds_read_b64_tr_b16 v[158:159], v11 offset:55296
v_mfma_f32_16x16x32_bf16 v[20:23], v[228:231], a[200:203], v[20:23]
v_mfma_f32_16x16x32_bf16 v[20:23], v[212:215], a[196:199], v[20:23]
v_mfma_f32_16x16x32_bf16 v[20:23], v[196:199], a[192:195], v[20:23]
s_nop 0
ds_read_b64_tr_b16 v[160:161], v8 offset:57344
ds_read_b64_tr_b16 v[162:163], v8 offset:59392
v_mfma_f32_16x16x32_bf16 v[20:23], v[120:123], v[80:83], v[20:23]
v_mfma_f32_16x16x32_bf16 v[24:27], v[200:203], a[192:195], v[24:27]
s_nop 0
ds_read_b64_tr_b16 v[164:165], v9 offset:57344
ds_read_b64_tr_b16 v[166:167], v9 offset:59392
v_mfma_f32_16x16x32_bf16 v[24:27], v[216:219], a[196:199], v[24:27]
v_mfma_f32_16x16x32_bf16 v[24:27], v[232:235], a[200:203], v[24:27]
s_nop 0
ds_read_b64_tr_b16 v[168:169], v10 offset:57344
ds_read_b64_tr_b16 v[170:171], v10 offset:59392
v_mfma_f32_16x16x32_bf16 v[24:27], v[248:251], a[204:207], v[24:27]
v_mfma_f32_16x16x32_bf16 v[24:27], v[124:127], v[84:87], v[24:27]
s_nop 0
ds_read_b64_tr_b16 v[172:173], v11 offset:57344
ds_read_b64_tr_b16 v[174:175], v11 offset:59392
v_mfma_f32_16x16x32_bf16 v[40:43], v[248:251], a[220:223], v[40:43]
v_mfma_f32_16x16x32_bf16 v[40:43], v[232:235], a[216:219], v[40:43]
s_nop 0
ds_read_b64_tr_b16 v[176:177], v8 offset:61440
ds_read_b64_tr_b16 v[178:179], v8 offset:63488
v_mfma_f32_16x16x32_bf16 v[40:43], v[216:219], a[212:215], v[40:43]
v_mfma_f32_16x16x32_bf16 v[40:43], v[200:203], a[208:211], v[40:43]
s_nop 0
ds_read_b64_tr_b16 v[180:181], v9 offset:61440
ds_read_b64_tr_b16 v[182:183], v9 offset:63488
v_mfma_f32_16x16x32_bf16 v[40:43], v[124:127], v[92:95], v[40:43]
v_mfma_f32_16x16x32_bf16 v[44:47], v[204:207], a[208:211], v[44:47]
s_nop 0
ds_read_b64_tr_b16 v[184:185], v10 offset:61440
ds_read_b64_tr_b16 v[186:187], v10 offset:63488
v_mfma_f32_16x16x32_bf16 v[44:47], v[220:223], a[212:215], v[44:47]
v_mfma_f32_16x16x32_bf16 v[44:47], v[236:239], a[216:219], v[44:47]
s_nop 0
ds_read_b64_tr_b16 v[188:189], v11 offset:61440
ds_read_b64_tr_b16 v[190:191], v11 offset:63488
v_mfma_f32_16x16x32_bf16 v[44:47], v[252:255], a[220:223], v[44:47]
v_mfma_f32_16x16x32_bf16 v[44:47], v[120:123], v[92:95], v[44:47]
v_mfma_f32_16x16x32_bf16 v[28:31], v[252:255], a[204:207], v[28:31]
s_waitcnt vmcnt(0)
v_max3_u32 v12, v96, v97, v98
v_max3_u32 v13, v99, v100, v101
v_mfma_f32_16x16x32_bf16 v[28:31], v[236:239], a[200:203], v[28:31]
v_max3_u32 v12, v12, v102, v103
v_max3_u32 v13, v13, v104, v105
v_mfma_f32_16x16x32_bf16 v[28:31], v[220:223], a[196:199], v[28:31]
v_max3_u32 v12, v12, v106, v107
v_max3_u32 v13, v13, v108, v109
v_mfma_f32_16x16x32_bf16 v[28:31], v[204:207], a[192:195], v[28:31]
s_waitcnt lgkmcnt(0)
v_max3_u32 v12, v12, v110, v111
v_mfma_f32_16x16x32_bf16 v[28:31], v[120:123], v[84:87], v[28:31]
v_max_u32 v12, v12, v13
v_mfma_f32_16x16x32_bf16 v[16:19], v[128:131], a[224:227], v[16:19]
v_cmp_le_u32 vcc, 0xff800000, v12
v_mfma_f32_16x16x32_bf16 v[16:19], v[144:147], a[228:231], v[16:19]
v_mfma_f32_16x16x32_bf16 v[16:19], v[160:163], a[232:235], v[16:19]
s_cbranch_vccnz Lxspin3
Lxback3:
v_mfma_f32_16x16x32_bf16 v[16:19], v[176:179], a[236:239], v[16:19]
v_mfma_f32_16x16x32_bf16 v[16:19], v[124:127], v[96:99], v[16:19]
v_mfma_f32_16x16x32_bf16 v[20:23], v[180:183], a[236:239], v[20:23]
v_mfma_f32_16x16x32_bf16 v[20:23], v[164:167], a[232:235], v[20:23]
v_mfma_f32_16x16x32_bf16 v[20:23], v[148:151], a[228:231], v[20:23]
v_mfma_f32_16x16x32_bf16 v[20:23], v[132:135], a[224:227], v[20:23]
s_nop 3
v_fma_f32 v16, v16, v6, v48
v_fma_f32 v17, v17, v6, v64
v_mfma_f32_16x16x32_bf16 v[20:23], v[120:123], v[96:99], v[20:23]
v_fma_f32 v18, v18, v6, v49
v_fma_f32 v19, v19, v6, v65
v_mfma_f32_16x16x32_bf16 v[24:27], v[136:139], a[224:227], v[24:27]
v_cvt_pk_bf16_f32 v16, v16, v17
v_cvt_pk_bf16_f32 v17, v18, v19
v_mfma_f32_16x16x32_bf16 v[24:27], v[152:155], a[228:231], v[24:27]
ds_write_b64 v116, v[16:17] offset:0
v_mfma_f32_16x16x32_bf16 v[24:27], v[168:171], a[232:235], v[24:27]
v_mfma_f32_16x16x32_bf16 v[24:27], v[184:187], a[236:239], v[24:27]
v_fma_f32 v20, v20, v6, v50
v_fma_f32 v21, v21, v6, v66
v_mfma_f32_16x16x32_bf16 v[24:27], v[124:127], v[100:103], v[24:27]
v_fma_f32 v22, v22, v6, v51
v_fma_f32 v23, v23, v6, v67
v_mfma_f32_16x16x32_bf16 v[28:31], v[188:191], a[236:239], v[28:31]
v_cvt_pk_bf16_f32 v20, v20, v21
v_cvt_pk_bf16_f32 v21, v22, v23
v_mfma_f32_16x16x32_bf16 v[28:31], v[172:175], a[232:235], v[28:31]
ds_write_b64 v117, v[20:21] offset:0
v_mfma_f32_16x16x32_bf16 v[28:31], v[156:159], a[228:231], v[28:31]
v_mfma_f32_16x16x32_bf16 v[28:31], v[140:143], a[224:227], v[28:31]
v_fma_f32 v24, v24, v6, v52
v_fma_f32 v25, v25, v6, v68
v_mfma_f32_16x16x32_bf16 v[28:31], v[120:123], v[100:103], v[28:31]
v_fma_f32 v26, v26, v6, v53
v_fma_f32 v27, v27, v6, v69
v_mfma_f32_16x16x32_bf16 v[32:35], v[128:131], a[240:243], v[32:35]
v_cvt_pk_bf16_f32 v24, v24, v25
v_cvt_pk_bf16_f32 v25, v26, v27
v_mfma_f32_16x16x32_bf16 v[32:35], v[144:147], a[244:247], v[32:35]
ds_write_b64 v118, v[24:25] offset:0
v_mfma_f32_16x16x32_bf16 v[32:35], v[160:163], a[248:251], v[32:35]
v_mfma_f32_16x16x32_bf16 v[32:35], v[176:179], a[252:255], v[32:35]
v_fma_f32 v28, v28, v6, v54
v_fma_f32 v29, v29, v6, v70
v_mfma_f32_16x16x32_bf16 v[32:35], v[124:127], v[104:107], v[32:35]
v_fma_f32 v30, v30, v6, v55
v_fma_f32 v31, v31, v6, v71
v_mfma_f32_16x16x32_bf16 v[36:39], v[180:183], a[252:255], v[36:39]
v_cvt_pk_bf16_f32 v28, v28, v29
v_cvt_pk_bf16_f32 v29, v30, v31
v_mfma_f32_16x16x32_bf16 v[36:39], v[164:167], a[248:251], v[36:39]
s_nop 0
ds_write_b64 v119, v[28:29] offset:0
ds_read_b128 v[192:195], v4 offset:0
v_mfma_f32_16x16x32_bf16 v[36:39], v[148:151], a[244:247], v[36:39]
ds_read_b128 v[196:199], v4 offset:1024
v_mfma_f32_16x16x32_bf16 v[36:39], v[132:135], a[240:243], v[36:39]
v_fma_f32 v32, v32, v7, v56
v_fma_f32 v33, v33, v7, v72
v_mfma_f32_16x16x32_bf16 v[36:39], v[120:123], v[104:107], v[36:39]
v_fma_f32 v34, v34, v7, v57
v_fma_f32 v35, v35, v7, v73
v_mfma_f32_16x16x32_bf16 v[40:43], v[136:139], a[240:243], v[40:43]
v_cvt_pk_bf16_f32 v32, v32, v33
v_cvt_pk_bf16_f32 v33, v34, v35
v_mfma_f32_16x16x32_bf16 v[40:43], v[152:155], a[244:247], v[40:43]
ds_write_b64 v116, v[32:33] offset:2048
v_mfma_f32_16x16x32_bf16 v[40:43], v[168:171], a[248:251], v[40:43]
s_waitcnt lgkmcnt(2)
buffer_store_dwordx4 v[192:195], v15, s[40:43], s70 offen sc1
v_mfma_f32_16x16x32_bf16 v[40:43], v[184:187], a[252:255], v[40:43]
s_add_u32 s70, s70, 0x4000
v_mfma_f32_16x16x32_bf16 v[40:43], v[124:127], v[108:111], v[40:43]
v_fma_f32 v36, v36, v7, v58
v_fma_f32 v37, v37, v7, v74
v_mfma_f32_16x16x32_bf16 v[44:47], v[188:191], a[252:255], v[44:47]
v_fma_f32 v38, v38, v7, v59
v_fma_f32 v39, v39, v7, v75
v_mfma_f32_16x16x32_bf16 v[44:47], v[172:175], a[248:251], v[44:47]
v_cvt_pk_bf16_f32 v36, v36, v37
v_cvt_pk_bf16_f32 v37, v38, v39
v_mfma_f32_16x16x32_bf16 v[44:47], v[156:159], a[244:247], v[44:47]
ds_write_b64 v117, v[36:37] offset:2048
v_mfma_f32_16x16x32_bf16 v[44:47], v[140:143], a[240:243], v[44:47]
v_fma_f32 v40, v40, v7, v60
v_fma_f32 v41, v41, v7, v76
v_mfma_f32_16x16x32_bf16 v[44:47], v[120:123], v[108:111], v[44:47]
v_fma_f32 v42, v42, v7, v61
v_fma_f32 v43, v43, v7, v77
v_cvt_pk_bf16_f32 v40, v40, v41
v_cvt_pk_bf16_f32 v41, v42, v43
ds_write_b64 v118, v[40:41] offset:2048
s_waitcnt lgkmcnt(3)
buffer_store_dwordx4 v[196:199], v15, s[40:43], s70 offen sc1
s_add_u32 s70, s70, 0x4000
v_fma_f32 v44, v44, v7, v62
v_fma_f32 v45, v45, v7, v78
v_fma_f32 v46, v46, v7, v63
v_fma_f32 v47, v47, v7, v79
v_cvt_pk_bf16_f32 v44, v44, v45
v_cvt_pk_bf16_f32 v45, v46, v47
ds_write_b64 v119, v[44:45] offset:2048
ds_read_b128 v[200:203], v4 offset:2048
ds_read_b128 v[204:207], v4 offset:3072
s_waitcnt lgkmcnt(1)
buffer_store_dwordx4 v[200:203], v15, s[40:43], s70 offen sc1
s_add_u32 s70, s70, 0x4000
s_waitcnt lgkmcnt(0)
buffer_store_dwordx4 v[204:207], v15, s[40:43], s70 offen sc1
s_add_u32 s70, s70, 0x4000
Lend:
s_endpgm
Lspin1:
s_mov_b32 s83, 262144
Lsl3:
s_sleep 2
buffer_load_dword v3, v2, s[48:51], 0 offen sc1
s_sub_u32 s83, s83, 1
s_cmp_eq_u32 s83, 0
s_waitcnt vmcnt(0)
s_cbranch_scc1 Lback2
v_cmp_gt_u32 vcc, 8, v3
s_cbranch_vccnz Lsl3
s_branch Lback2
Lspin4:
s_mov_b32 s83, 262144
Lsl6:
s_sleep 2
buffer_load_dword v3, v2, s[44:47], s75 offen sc1
s_sub_u32 s83, s83, 1
s_cmp_eq_u32 s83, 0
s_waitcnt vmcnt(0)
s_cbranch_scc1 Lback5
v_cmp_gt_u32 vcc, 1, v3
s_cbranch_vccnz Lsl6
s_branch Lback5
.p2align 12
s_endpgm
.p2align 7
LP0x:
Lstub10:
s_cbranch_execz Lret
s_cmp_eq_u32 s58, 2
s_cbranch_scc1 Lta10
s_cmp_eq_u32 s58, 3
s_cbranch_scc1 Lnt11
v_mfma_f32_16x16x32_bf16 v[160:163], a[160:163], v[16:19], v[112:115]
s_xor_b32 s74, s82, 0x10000
v_exp_f32 v128, v128
v_mfma_f32_16x16x32_bf16 v[176:179], a[176:179], v[16:19], v[112:115]
s_add_u32 s74, s74, s64
ds_read_b128 a[128:131], v2 offset:16384
ds_read_b128 a[132:135], v2 offset:17408
s_branch Ljoin12
Lta10:
v_mfma_f32_16x16x32_bf16 v[160:163], a[160:163], v[16:19], v[96:99]
s_xor_b32 s74, s82, 0x10000
v_exp_f32 v128, v128
v_mfma_f32_16x16x32_bf16 v[176:179], a[176:179], v[16:19], v[112:115]
s_add_u32 s74, s74, s64
ds_read_b128 a[128:131], v2 offset:16384
ds_read_b128 a[132:135], v2 offset:17408
s_branch Ljoin12
Lnt11:
v_mfma_f32_16x16x32_bf16 v[160:163], a[160:163], v[16:19], v[80:83]
s_xor_b32 s74, s82, 0x10000
v_exp_f32 v128, v128
v_mfma_f32_16x16x32_bf16 v[176:179], a[176:179], v[16:19], v[96:99]
s_add_u32 s74, s74, s64
ds_read_b128 a[128:131], v2 offset:16384
ds_read_b128 a[132:135], v2 offset:17408
Ljoin12:
v_mfma_f32_16x16x32_bf16 v[164:167], a[160:163], v[32:35], v[84:87]
s_add_u32 s81, s81, 0x8000
v_exp_f32 v129, v129
v_mfma_f32_16x16x32_bf16 v[164:167], a[164:167], v[36:39], v[164:167]
s_add_u32 m0, s74, 16384
v_exp_f32 v130, v130
v_mfma_f32_16x16x32_bf16 v[164:167], a[168:171], v[40:43], v[164:167]
s_add_u32 s72, s81, 16384
v_exp_f32 v131, v131
v_mfma_f32_16x16x32_bf16 v[164:167], a[172:175], v[44:47], v[164:167]
v_exp_f32 v144, v144
v_mfma_f32_16x16x32_bf16 v[172:175], a[172:175], v[76:79], v[92:95]
s_nop 0
ds_read_b128 a[136:139], v2 offset:18432
ds_read_b128 a[140:143], v2 offset:19456
v_mfma_f32_16x16x32_bf16 v[172:175], a[168:171], v[72:75], v[172:175]
s_nop 0
ds_read_b128 a[144:147], v2 offset:20480
ds_read_b128 a[148:151], v2 offset:21504
v_mfma_f32_16x16x32_bf16 v[172:175], a[164:167], v[68:71], v[172:175]
s_nop 0
ds_read_b128 a[152:155], v2 offset:22528
ds_read_b128 a[156:159], v2 offset:23552
v_mfma_f32_16x16x32_bf16 v[172:175], a[160:163], v[64:67], v[172:175]
s_nop 0
ds_read_b128 a[192:195], v2 offset:0
ds_read_b128 a[196:199], v2 offset:1024
v_mfma_f32_16x16x32_bf16 v[188:191], a[176:179], v[64:67], v[92:95]
s_nop 0
ds_read_b128 a[200:203], v2 offset:2048
ds_read_b128 a[204:207], v2 offset:3072
v_mfma_f32_16x16x32_bf16 v[188:191], a[180:183], v[68:71], v[188:191]
s_nop 0
ds_read_b128 a[208:211], v2 offset:4096
ds_read_b128 a[212:215], v2 offset:5120
v_mfma_f32_16x16x32_bf16 v[188:191], a[184:187], v[72:75], v[188:191]
s_nop 0
ds_read_b128 a[216:219], v2 offset:6144
ds_read_b128 a[220:223], v2 offset:7168
v_mfma_f32_16x16x32_bf16 v[188:191], a[188:191], v[76:79], v[188:191]
v_cvt_pk_bf16_f32 v192, v128, v129
v_cvt_pk_bf16_f32 v193, v130, v131
v_mfma_f32_16x16x32_bf16 v[180:183], a[188:191], v[44:47], v[84:87]
buffer_load_dwordx4 v1, s[44:47], s72 offen sc1 lds
v_mfma_f32_16x16x32_bf16 v[180:183], a[184:187], v[40:43], v[180:183]
v_exp_f32 v145, v145
v_mfma_f32_16x16x32_bf16 v[180:183], a[180:183], v[36:39], v[180:183]
v_exp_f32 v146, v146
v_mfma_f32_16x16x32_bf16 v[180:183], a[176:179], v[32:35], v[180:183]
v_exp_f32 v147, v147
v_mfma_f32_16x16x32_bf16 v[160:163], a[164:167], v[20:23], v[160:163]
v_exp_f32 v136, v136
v_mfma_f32_16x16x32_bf16 v[160:163], a[168:171], v[24:27], v[160:163]
v_cvt_pk_bf16_f32 v194, v144, v145
v_cvt_pk_bf16_f32 v195, v146, v147
v_mfma_f32_16x16x32_bf16 v[160:163], a[172:175], v[28:31], v[160:163]
v_exp_f32 v137, v137
v_mfma_f32_16x16x32_bf16 v[168:171], a[172:175], v[60:63], v[88:91]
v_exp_f32 v138, v138
v_mfma_f32_16x16x32_bf16 v[168:171], a[168:171], v[56:59], v[168:171]
v_exp_f32 v139, v139
v_mfma_f32_16x16x32_bf16 v[168:171], a[164:167], v[52:55], v[168:171]
v_exp_f32 v152, v152
v_mfma_f32_16x16x32_bf16 v[168:171], a[160:163], v[48:51], v[168:171]
v_cvt_pk_bf16_f32 v200, v136, v137
v_cvt_pk_bf16_f32 v201, v138, v139
v_mfma_f32_16x16x32_bf16 v[184:187], a[176:179], v[48:51], v[88:91]
buffer_load_dwordx4 v1, s[44:47], s72 offen offset:1024 sc1 lds
v_mfma_f32_16x16x32_bf16 v[184:187], a[180:183], v[52:55], v[184:187]
v_exp_f32 v153, v153
v_mfma_f32_16x16x32_bf16 v[184:187], a[184:187], v[56:59], v[184:187]
v_exp_f32 v154, v154
v_mfma_f32_16x16x32_bf16 v[184:187], a[188:191], v[60:63], v[184:187]
v_exp_f32 v155, v155
v_mfma_f32_16x16x32_bf16 v[176:179], a[188:191], v[28:31], v[176:179]
buffer_load_dwordx4 v1, s[44:47], s72 offen offset:2048 sc1 lds
v_mfma_f32_16x16x32_bf16 v[176:179], a[184:187], v[24:27], v[176:179]
buffer_load_dwordx4 v1, s[44:47], s72 offen offset:3072 sc1 lds
v_mfma_f32_16x16x32_bf16 v[176:179], a[180:183], v[20:23], v[176:179]
s_waitcnt lgkmcnt(4)
v_exp_f32 v132, v132
v_cvt_pk_bf16_f32 v202, v152, v153
v_cvt_pk_bf16_f32 v203, v154, v155
v_exp_f32 v133, v133
v_exp_f32 v134, v134
v_cvt_pk_bf16_f32 v196, v132, v133
v_exp_f32 v135, v135
v_exp_f32 v148, v148
v_cvt_pk_bf16_f32 v197, v134, v135
v_exp_f32 v149, v149
v_exp_f32 v150, v150
v_cvt_pk_bf16_f32 v198, v148, v149
v_exp_f32 v151, v151
v_exp_f32 v140, v140
v_cvt_pk_bf16_f32 v199, v150, v151
v_exp_f32 v141, v141
v_exp_f32 v142, v142
v_cvt_pk_bf16_f32 v204, v140, v141
v_exp_f32 v143, v143
v_exp_f32 v156, v156
v_cvt_pk_bf16_f32 v205, v142, v143
v_exp_f32 v157, v157
v_exp_f32 v158, v158
v_cvt_pk_bf16_f32 v206, v156, v157
v_exp_f32 v159, v159
s_nop 0
v_cvt_pk_bf16_f32 v207, v158, v159
v_mfma_f32_16x16x32_bf16 v[224:227], v[120:123], v[192:195], 0
s_add_u32 s82, s82, 0x8000
ds_read_b128 a[160:163], v2 offset:24576
ds_read_b128 a[164:167], v2 offset:25600
v_mfma_f32_16x16x32_bf16 v[232:235], v[120:123], v[200:203], 0
s_and_b32 s82, s82, 0x1ffff
v_exp_f32 v164, v164
v_mfma_f32_16x16x32_bf16 a[0:3], a[192:195], v[192:195], 0
s_add_u32 m0, s74, 0
v_exp_f32 v165, v165
v_mfma_f32_16x16x32_bf16 a[64:67], a[192:195], v[200:203], 0
s_add_u32 s72, s81, 0
v_exp_f32 v166, v166
v_mfma_f32_16x16x32_bf16 a[68:71], a[196:199], v[200:203], 0
buffer_load_dwordx4 v1, s[44:47], s72 offen sc1 lds
v_mfma_f32_16x16x32_bf16 a[4:7], a[196:199], v[192:195], 0
v_exp_f32 v167, v167
v_mfma_f32_16x16x32_bf16 a[8:11], a[200:203], v[192:195], 0
s_nop 0
ds_read_b128 a[168:171], v2 offset:26624
ds_read_b128 a[172:175], v2 offset:27648
v_mfma_f32_16x16x32_bf16 a[72:75], a[200:203], v[200:203], 0
v_exp_f32 v180, v180
v_mfma_f32_16x16x32_bf16 a[76:79], a[204:207], v[200:203], 0
s_nop 0
ds_read_b128 a[176:179], v2 offset:28672
ds_read_b128 a[180:183], v2 offset:29696
v_mfma_f32_16x16x32_bf16 a[12:15], a[204:207], v[192:195], 0
s_waitcnt lgkmcnt(6)
ds_read_b128 a[184:187], v2 offset:30720
ds_read_b128 a[188:191], v2 offset:31744
v_mfma_f32_16x16x32_bf16 a[16:19], a[208:211], v[192:195], 0
s_nop 0
ds_read_b128 a[224:227], v2 offset:8192
ds_read_b128 a[228:231], v2 offset:9216
v_mfma_f32_16x16x32_bf16 a[80:83], a[208:211], v[200:203], 0
s_nop 0
ds_read_b128 a[232:235], v2 offset:10240
ds_read_b128 a[236:239], v2 offset:11264
v_mfma_f32_16x16x32_bf16 a[84:87], a[212:215], v[200:203], 0
s_nop 0
ds_read_b128 a[240:243], v2 offset:12288
ds_read_b128 a[244:247], v2 offset:13312
v_mfma_f32_16x16x32_bf16 a[20:23], a[212:215], v[192:195], 0
s_nop 0
ds_read_b128 a[248:251], v2 offset:14336
ds_read_b128 a[252:255], v2 offset:15360
v_mfma_f32_16x16x32_bf16 a[24:27], a[216:219], v[192:195], 0
v_cvt_pk_bf16_f32 v212, v164, v165
v_cvt_pk_bf16_f32 v213, v166, v167
v_mfma_f32_16x16x32_bf16 a[88:91], a[216:219], v[200:203], 0
v_exp_f32 v181, v181
v_mfma_f32_16x16x32_bf16 a[92:95], a[220:223], v[200:203], 0
v_exp_f32 v182, v182
v_mfma_f32_16x16x32_bf16 a[28:31], a[220:223], v[192:195], 0
buffer_load_dwordx4 v1, s[44:47], s72 offen offset:1024 sc1 lds
s_cmp_eq_u32 s58, 0
s_cbranch_scc1 Lta13
s_cmp_eq_u32 s58, 1
s_cbranch_scc1 Lnt14
v_mfma_f32_16x16x32_bf16 v[132:135], a[128:131], v[32:35], v[84:87]
v_exp_f32 v183, v183
v_mfma_f32_16x16x32_bf16 v[148:151], a[144:147], v[32:35], v[84:87]
v_exp_f32 v172, v172
s_branch Ljoin15
Lta13:
v_mfma_f32_16x16x32_bf16 v[132:135], a[128:131], v[32:35], v[100:103]
v_exp_f32 v183, v183
v_mfma_f32_16x16x32_bf16 v[148:151], a[144:147], v[32:35], v[112:115]
v_exp_f32 v172, v172
s_branch Ljoin15
Lnt14:
v_mfma_f32_16x16x32_bf16 v[132:135], a[128:131], v[32:35], v[84:87]
v_exp_f32 v183, v183
v_mfma_f32_16x16x32_bf16 v[148:151], a[144:147], v[32:35], v[100:103]
v_exp_f32 v172, v172
Ljoin15:
v_mfma_f32_16x16x32_bf16 v[136:139], a[128:131], v[48:51], v[88:91]
v_cvt_pk_bf16_f32 v214, v180, v181
v_cvt_pk_bf16_f32 v215, v182, v183
v_mfma_f32_16x16x32_bf16 v[136:139], a[132:135], v[52:55], v[136:139]
v_exp_f32 v173, v173
v_mfma_f32_16x16x32_bf16 v[136:139], a[136:139], v[56:59], v[136:139]
buffer_load_dwordx4 v1, s[44:47], s72 offen offset:2048 sc1 lds
v_mfma_f32_16x16x32_bf16 v[136:139], a[140:143], v[60:63], v[136:139]
v_exp_f32 v174, v174
v_mfma_f32_16x16x32_bf16 v[152:155], a[156:159], v[60:63], v[88:91]
v_exp_f32 v175, v175
v_mfma_f32_16x16x32_bf16 v[152:155], a[152:155], v[56:59], v[152:155]
v_exp_f32 v188, v188
v_mfma_f32_16x16x32_bf16 v[152:155], a[148:151], v[52:55], v[152:155]
v_cvt_pk_bf16_f32 v220, v172, v173
v_cvt_pk_bf16_f32 v221, v174, v175
v_mfma_f32_16x16x32_bf16 v[152:155], a[144:147], v[48:51], v[152:155]
v_exp_f32 v189, v189
v_mfma_f32_16x16x32_bf16 v[132:135], a[132:135], v[36:39], v[132:135]
buffer_load_dwordx4 v1, s[44:47], s72 offen offset:3072 sc1 lds
v_mfma_f32_16x16x32_bf16 v[132:135], a[136:139], v[40:43], v[132:135]
s_add_u32 s66, s58, 1
v_exp_f32 v190, v190
v_mfma_f32_16x16x32_bf16 v[132:135], a[140:143], v[44:47], v[132:135]
s_and_b32 s66, s66, 3
v_exp_f32 v191, v191
v_mfma_f32_16x16x32_bf16 v[140:143], a[140:143], v[76:79], v[92:95]
s_mul_i32 s66, s66, 4160
v_exp_f32 v160, v160
v_mfma_f32_16x16x32_bf16 v[140:143], a[136:139], v[72:75], v[140:143]
s_add_u32 m0, s66, 131104
v_cvt_pk_bf16_f32 v222, v188, v189
v_cvt_pk_bf16_f32 v223, v190, v191
v_mfma_f32_16x16x32_bf16 v[140:143], a[132:135], v[68:71], v[140:143]
s_add_u32 s72, s93, 0x2
v_exp_f32 v161, v161
v_mfma_f32_16x16x32_bf16 v[140:143], a[128:131], v[64:67], v[140:143]
buffer_load_dwordx4 v1, s[36:39], s72 offen lds
v_mfma_f32_16x16x32_bf16 v[156:159], a[144:147], v[64:67], v[92:95]
v_exp_f32 v162, v162
v_mfma_f32_16x16x32_bf16 v[156:159], a[148:151], v[68:71], v[156:159]
v_exp_f32 v163, v163
v_mfma_f32_16x16x32_bf16 v[156:159], a[152:155], v[72:75], v[156:159]
buffer_load_dwordx4 v1, s[36:39], s72 offen offset:1024 lds
v_mfma_f32_16x16x32_bf16 v[156:159], a[156:159], v[76:79], v[156:159]
buffer_load_dwordx4 v1, s[36:39], s72 offen offset:2048 lds
v_mfma_f32_16x16x32_bf16 v[148:151], a[156:159], v[44:47], v[148:151]
buffer_load_dwordx4 v1, s[36:39], s72 offen offset:3072 lds
v_mfma_f32_16x16x32_bf16 v[148:151], a[152:155], v[40:43], v[148:151]
s_waitcnt vmcnt(12) lgkmcnt(4)
v_exp_f32 v176, v176
v_mfma_f32_16x16x32_bf16 v[148:151], a[148:151], v[36:39], v[148:151]
s_barrier
v_cvt_pk_bf16_f32 v208, v160, v161
v_cvt_pk_bf16_f32 v209, v162, v163
v_add_u32 v2, s82, v1
v_exp_f32 v177, v177
v_exp_f32 v178, v178
v_cvt_pk_bf16_f32 v210, v176, v177
v_exp_f32 v179, v179
v_exp_f32 v168, v168
v_cvt_pk_bf16_f32 v211, v178, v179
v_exp_f32 v169, v169
v_exp_f32 v170, v170
v_cvt_pk_bf16_f32 v216, v168, v169
v_exp_f32 v171, v171
v_exp_f32 v184, v184
v_cvt_pk_bf16_f32 v217, v170, v171
v_exp_f32 v185, v185
v_exp_f32 v186, v186
v_cvt_pk_bf16_f32 v218, v184, v185
v_exp_f32 v187, v187
s_nop 0
v_cvt_pk_bf16_f32 v219, v186, v187
s_branch LLT3
.p2align 12
s_endpgm
.p2align 7
LLT3x:
Lstub11:
s_cbranch_execz Lret
v_mfma_f32_16x16x32_bf16 v[228:231], v[120:123], v[196:199], v[228:231]
s_xor_b32 s74, s82, 0x10000
ds_read_b128 a[128:131], v2 offset:16384
v_and_b32 v240, 15, v0
v_mfma_f32_16x16x32_bf16 v[228:231], v[120:123], v[212:215], v[228:231]
s_add_u32 s74, s74, s64
v_exp_f32 v136, v136
v_mfma_f32_16x16x32_bf16 v[236:239], v[120:123], v[204:207], v[236:239]
s_add_u32 s81, s81, 0x8000
v_exp_f32 v137, v137
v_mfma_f32_16x16x32_bf16 v[236:239], v[120:123], v[220:223], v[236:239]
s_add_u32 m0, s74, 0
ds_read_b128 a[132:135], v2 offset:17408
v_cvt_pk_bf16_f32 v200, v136, v137
v_mfma_f32_16x16x32_bf16 a[32:35], a[192:195], v[196:199], a[32:35]
s_add_u32 s72, s81, 0
buffer_load_dwordx4 v1, s[44:47], s72 offen sc1 lds
v_mfma_f32_16x16x32_bf16 a[32:35], a[224:227], v[212:215], a[32:35]
s_add_u32 s69, s93, 0x3e00000
v_exp_f32 v138, v138
v_mfma_f32_16x16x32_bf16 a[96:99], a[224:227], v[220:223], a[96:99]
ds_read_b128 a[136:139], v2 offset:18432
v_lshrrev_b32 v241, 4, v0
v_mfma_f32_16x16x32_bf16 a[96:99], a[192:195], v[204:207], a[96:99]
v_exp_f32 v139, v139
v_mfma_f32_16x16x32_bf16 a[100:103], a[196:199], v[204:207], a[100:103]
buffer_store_dwordx4 v[112:115], v1, s[44:47], s69 offen sc1
v_mfma_f32_16x16x32_bf16 a[100:103], a[228:231], v[220:223], a[100:103]
v_exp_f32 v152, v152
v_mfma_f32_16x16x32_bf16 a[36:39], a[228:231], v[212:215], a[36:39]
ds_read_b128 a[140:143], v2 offset:19456
v_cvt_pk_bf16_f32 v201, v138, v139
v_mfma_f32_16x16x32_bf16 a[36:39], a[196:199], v[196:199], a[36:39]
v_exp_f32 v153, v153
v_mfma_f32_16x16x32_bf16 a[40:43], a[200:203], v[196:199], a[40:43]
buffer_load_dwordx4 v1, s[44:47], s72 offen offset:1024 sc1 lds
v_mfma_f32_16x16x32_bf16 a[40:43], a[232:235], v[212:215], a[40:43]
ds_read_b128 a[144:147], v2 offset:20480
v_cvt_pk_bf16_f32 v202, v152, v153
v_mfma_f32_16x16x32_bf16 a[104:107], a[232:235], v[220:223], a[104:107]
v_exp_f32 v154, v154
v_mfma_f32_16x16x32_bf16 a[104:107], a[200:203], v[204:207], a[104:107]
v_exp_f32 v155, v155
v_mfma_f32_16x16x32_bf16 a[108:111], a[204:207], v[204:207], a[108:111]
buffer_store_dwordx4 v[112:115], v1, s[44:47], s69 offen offset:1024 sc1
v_mfma_f32_16x16x32_bf16 a[108:111], a[236:239], v[220:223], a[108:111]
ds_read_b128 a[148:151], v2 offset:21504
v_cvt_pk_bf16_f32 v203, v154, v155
v_mfma_f32_16x16x32_bf16 a[44:47], a[236:239], v[212:215], a[44:47]
v_exp_f32 v132, v132
v_mfma_f32_16x16x32_bf16 a[44:47], a[204:207], v[196:199], a[44:47]
ds_read_b128 a[152:155], v2 offset:22528
v_add_u32 v248, 1, v240
v_mfma_f32_16x16x32_bf16 a[48:51], a[208:211], v[196:199], a[48:51]
s_waitcnt lgkmcnt(7)
v_exp_f32 v133, v133
v_mfma_f32_16x16x32_bf16 a[48:51], a[240:243], v[212:215], a[48:51]
buffer_load_dwordx4 v1, s[44:47], s72 offen offset:2048 sc1 lds
v_mfma_f32_16x16x32_bf16 a[112:115], a[240:243], v[220:223], a[112:115]
v_exp_f32 v134, v134
v_mfma_f32_16x16x32_bf16 a[112:115], a[208:211], v[204:207], a[112:115]
ds_read_b128 a[156:159], v2 offset:23552
v_and_b32 v249, 3, v248
v_mfma_f32_16x16x32_bf16 a[116:119], a[212:215], v[204:207], a[116:119]
v_exp_f32 v135, v135
v_mfma_f32_16x16x32_bf16 a[116:119], a[244:247], v[220:223], a[116:119]
buffer_store_dwordx4 v[112:115], v1, s[44:47], s69 offen offset:2048 sc1
v_mfma_f32_16x16x32_bf16 a[52:55], a[244:247], v[212:215], a[52:55]
ds_read_b128 a[192:195], v2 offset:0
v_lshrrev_b32 v248, 2, v248
v_mfma_f32_16x16x32_bf16 a[52:55], a[212:215], v[196:199], a[52:55]
v_exp_f32 v148, v148
v_mfma_f32_16x16x32_bf16 a[56:59], a[216:219], v[196:199], a[56:59]
buffer_load_dwordx4 v1, s[44:47], s72 offen offset:3072 sc1 lds
v_mfma_f32_16x16x32_bf16 a[56:59], a[248:251], v[212:215], a[56:59]
v_exp_f32 v149, v149
v_mfma_f32_16x16x32_bf16 a[120:123], a[248:251], v[220:223], a[120:123]
ds_read_b128 a[196:199], v2 offset:1024
v_mov_b32 v250, 0x20000
v_mfma_f32_16x16x32_bf16 a[120:123], a[216:219], v[204:207], a[120:123]
v_exp_f32 v150, v150
v_mfma_f32_16x16x32_bf16 a[124:127], a[220:223], v[204:207], a[124:127]
ds_read_b128 a[200:203], v2 offset:2048
v_mov_b32 v252, 0x20001
v_mfma_f32_16x16x32_bf16 a[124:127], a[252:255], v[220:223], a[124:127]
buffer_store_dwordx4 v[112:115], v1, s[44:47], s69 offen offset:3072 sc1
v_mfma_f32_16x16x32_bf16 a[60:63], a[252:255], v[212:215], a[60:63]
s_add_u32 s69, s93, 0x4200000
v_exp_f32 v151, v151
v_mfma_f32_16x16x32_bf16 a[60:63], a[220:223], v[196:199], a[60:63]
ds_read_b128 a[204:207], v2 offset:3072
v_cvt_pk_bf16_f32 v196, v132, v133
s_cmp_eq_u32 s58, 2
s_cbranch_scc1 Lta40
s_cmp_eq_u32 s58, 3
s_cbranch_scc1 Lnt41
v_mfma_f32_16x16x32_bf16 v[164:167], a[160:163], v[32:35], v[112:115]
ds_read_b128 a[208:211], v2 offset:4096
v_cvt_pk_bf16_f32 v197, v134, v135
v_mfma_f32_16x16x32_bf16 v[180:183], a[176:179], v[32:35], v[112:115]
v_exp_f32 v140, v140
s_branch Ljoin42
Lta40:
v_mfma_f32_16x16x32_bf16 v[164:167], a[160:163], v[32:35], v[100:103]
ds_read_b128 a[208:211], v2 offset:4096
v_cvt_pk_bf16_f32 v197, v134, v135
v_mfma_f32_16x16x32_bf16 v[180:183], a[176:179], v[32:35], v[112:115]
v_exp_f32 v140, v140
s_branch Ljoin42
Lnt41:
v_mfma_f32_16x16x32_bf16 v[164:167], a[160:163], v[32:35], v[84:87]
ds_read_b128 a[208:211], v2 offset:4096
v_cvt_pk_bf16_f32 v197, v134, v135
v_mfma_f32_16x16x32_bf16 v[180:183], a[176:179], v[32:35], v[100:103]
v_exp_f32 v140, v140
Ljoin42:
v_mfma_f32_16x16x32_bf16 v[164:167], a[164:167], v[36:39], v[164:167]
ds_read_b128 a[212:215], v2 offset:5120
v_cvt_pk_bf16_f32 v198, v148, v149
v_mfma_f32_16x16x32_bf16 v[164:167], a[168:171], v[40:43], v[164:167]
buffer_store_dwordx4 v[112:115], v1, s[44:47], s69 offen sc1
v_mfma_f32_16x16x32_bf16 v[164:167], a[172:175], v[44:47], v[164:167]
v_exp_f32 v141, v141
v_mfma_f32_16x16x32_bf16 v[172:175], a[172:175], v[76:79], v[92:95]
v_exp_f32 v142, v142
v_mfma_f32_16x16x32_bf16 v[172:175], a[168:171], v[72:75], v[172:175]
ds_read_b128 a[216:219], v2 offset:6144
v_cvt_pk_bf16_f32 v199, v150, v151
v_mfma_f32_16x16x32_bf16 v[172:175], a[164:167], v[68:71], v[172:175]
buffer_store_dwordx4 v[112:115], v1, s[44:47], s69 offen offset:1024 sc1
v_mfma_f32_16x16x32_bf16 v[172:175], a[160:163], v[64:67], v[172:175]
v_exp_f32 v143, v143
v_mfma_f32_16x16x32_bf16 v[188:191], a[176:179], v[64:67], v[92:95]
v_exp_f32 v156, v156
v_mfma_f32_16x16x32_bf16 v[188:191], a[180:183], v[68:71], v[188:191]
ds_read_b128 a[220:223], v2 offset:7168
v_cvt_pk_bf16_f32 v204, v140, v141
v_mfma_f32_16x16x32_bf16 v[188:191], a[184:187], v[72:75], v[188:191]
buffer_store_dwordx4 v[112:115], v1, s[44:47], s69 offen offset:2048 sc1
v_mfma_f32_16x16x32_bf16 v[188:191], a[188:191], v[76:79], v[188:191]
v_exp_f32 v157, v157
v_mfma_f32_16x16x32_bf16 v[180:183], a[188:191], v[44:47], v[180:183]
v_exp_f32 v158, v158
v_mfma_f32_16x16x32_bf16 v[180:183], a[184:187], v[40:43], v[180:183]
v_cvt_pk_bf16_f32 v205, v142, v143
v_cvt_pk_bf16_f32 v206, v156, v157
v_mfma_f32_16x16x32_bf16 v[180:183], a[180:183], v[36:39], v[180:183]
buffer_store_dwordx4 v[112:115], v1, s[44:47], s69 offen offset:3072 sc1
v_mfma_f32_16x16x32_bf16 v[168:171], a[160:163], v[48:51], v[88:91]
v_exp_f32 v159, v159
v_mfma_f32_16x16x32_bf16 v[168:171], a[164:167], v[52:55], v[168:171]
v_cvt_pk_bf16_f32 v207, v158, v159
v_lshlrev_b32 v6, 3, v249
v_mfma_f32_16x16x32_bf16 v[168:171], a[168:171], v[56:59], v[168:171]
v_lshrrev_b32 v6, v6, v252
v_and_b32 v6, 3, v6
v_mfma_f32_16x16x32_bf16 v[168:171], a[172:175], v[60:63], v[168:171]
v_cmp_ne_u32 vcc, 1, v249
v_mul_u32_u24 v6, 16640, v6
v_mfma_f32_16x16x32_bf16 v[184:187], a[188:191], v[60:63], v[88:91]
v_add_u32 v6, s92, v6
v_cndmask_b32 v6, v250, v6, vcc
v_mfma_f32_16x16x32_bf16 v[184:187], a[184:187], v[56:59], v[184:187]
v_add_u32 v253, s58, v249
v_and_b32 v253, 3, v253
v_mfma_f32_16x16x32_bf16 v[184:187], a[180:183], v[52:55], v[184:187]
s_waitcnt lgkmcnt(4)
v_mfma_f32_16x16x32_bf16 v[184:187], a[176:179], v[48:51], v[184:187]
s_barrier
s_lshr_b32 s69, s93, 4
s_and_b32 s69, s69, 0x7f00
s_add_u32 s69, s69, LHT4-Lpc0
v_lshrrev_b32 v3, 5, v0
v_lshlrev_b32 v3, 7, v3
v_add_u32 v3, s69, v3
v_min_u32 v3, Lcode_end-Lpc0, v3
global_load_dword v4, v3, s[98:99]
v_mfma_f32_16x16x32_bf16 v[224:227], v[120:123], v[208:211], v[224:227]
s_add_u32 s82, s82, 0x8000
ds_read_b128 a[160:163], v2 offset:24576
ds_read_b128 a[164:167], v2 offset:25600
v_mfma_f32_16x16x32_bf16 v[232:235], v[120:123], v[216:219], v[232:235]
s_and_b32 s82, s82, 0x1ffff
v_exp_f32 v164, v164
v_mfma_f32_16x16x32_bf16 v[232:235], v[120:123], v[200:203], v[232:235]
s_add_u32 s66, s58, 3
v_exp_f32 v165, v165
v_mfma_f32_16x16x32_bf16 a[0:3], a[224:227], v[208:211], a[0:3]
s_and_b32 s66, s66, 3
v_exp_f32 v166, v166
v_mfma_f32_16x16x32_bf16 a[64:67], a[192:195], v[200:203], a[64:67]
s_mul_i32 s66, s66, 4160
ds_read_b128 a[168:171], v2 offset:26624
v_cvt_pk_bf16_f32 v212, v164, v165
v_mfma_f32_16x16x32_bf16 a[64:67], a[224:227], v[216:219], a[64:67]
s_add_u32 s66, s66, s92
v_exp_f32 v167, v167
v_mfma_f32_16x16x32_bf16 a[68:71], a[228:231], v[216:219], a[68:71]
s_add_u32 m0, s66, 32
v_exp_f32 v180, v180
v_mfma_f32_16x16x32_bf16 a[68:71], a[196:199], v[200:203], a[68:71]
s_add_u32 s72, s93, 0x6
buffer_load_dwordx4 v1, s[36:39], s72 offen lds
v_mfma_f32_16x16x32_bf16 a[4:7], a[228:231], v[208:211], a[4:7]
ds_read_b128 a[172:175], v2 offset:27648
v_cvt_pk_bf16_f32 v213, v166, v167
v_mfma_f32_16x16x32_bf16 a[8:11], a[232:235], v[208:211], a[8:11]
v_exp_f32 v181, v181
v_mfma_f32_16x16x32_bf16 a[72:75], a[200:203], v[200:203], a[72:75]
ds_read_b128 a[176:179], v2 offset:28672
v_cvt_pk_bf16_f32 v214, v180, v181
v_mfma_f32_16x16x32_bf16 a[72:75], a[232:235], v[216:219], a[72:75]
v_exp_f32 v182, v182
v_mfma_f32_16x16x32_bf16 a[76:79], a[236:239], v[216:219], a[76:79]
v_exp_f32 v183, v183
v_mfma_f32_16x16x32_bf16 a[76:79], a[204:207], v[200:203], a[76:79]
ds_read_b128 a[180:183], v2 offset:29696
v_cvt_pk_bf16_f32 v215, v182, v183
v_mfma_f32_16x16x32_bf16 a[12:15], a[236:239], v[208:211], a[12:15]
v_exp_f32 v172, v172
v_mfma_f32_16x16x32_bf16 a[16:19], a[240:243], v[208:211], a[16:19]
s_waitcnt lgkmcnt(6)
ds_read_b128 a[184:187], v2 offset:30720
ds_read_b128 a[188:191], v2 offset:31744
v_mfma_f32_16x16x32_bf16 a[80:83], a[208:211], v[200:203], a[80:83]
v_exp_f32 v173, v173
v_mfma_f32_16x16x32_bf16 a[80:83], a[240:243], v[216:219], a[80:83]
buffer_load_dwordx4 v1, s[36:39], s72 offen offset:1024 lds
v_mfma_f32_16x16x32_bf16 a[84:87], a[244:247], v[216:219], a[84:87]
v_exp_f32 v174, v174
v_mfma_f32_16x16x32_bf16 a[84:87], a[212:215], v[200:203], a[84:87]
v_exp_f32 v175, v175
v_mfma_f32_16x16x32_bf16 a[20:23], a[244:247], v[208:211], a[20:23]
ds_read_b128 a[224:227], v2 offset:8192
v_cvt_pk_bf16_f32 v220, v172, v173
v_mfma_f32_16x16x32_bf16 a[24:27], a[248:251], v[208:211], a[24:27]
v_exp_f32 v188, v188
v_mfma_f32_16x16x32_bf16 a[88:91], a[216:219], v[200:203], a[88:91]
v_exp_f32 v189, v189
v_mfma_f32_16x16x32_bf16 a[88:91], a[248:251], v[216:219], a[88:91]
ds_read_b128 a[228:231], v2 offset:9216
v_cvt_pk_bf16_f32 v221, v174, v175
v_mfma_f32_16x16x32_bf16 a[92:95], a[252:255], v[216:219], a[92:95]
v_exp_f32 v190, v190
v_mfma_f32_16x16x32_bf16 a[92:95], a[220:223], v[200:203], a[92:95]
ds_read_b128 a[232:235], v2 offset:10240
v_cvt_pk_bf16_f32 v222, v188, v189
v_mfma_f32_16x16x32_bf16 a[28:31], a[252:255], v[208:211], a[28:31]
v_exp_f32 v191, v191
s_cmp_eq_u32 s58, 0
s_cbranch_scc1 Lta43
s_cmp_eq_u32 s58, 1
s_cbranch_scc1 Lnt44
v_mfma_f32_16x16x32_bf16 v[136:139], a[128:131], v[48:51], v[88:91]
buffer_load_dwordx4 v1, s[36:39], s72 offen offset:2048 lds
v_mfma_f32_16x16x32_bf16 v[152:155], a[144:147], v[48:51], v[88:91]
v_exp_f32 v168, v168
s_branch Ljoin45
Lta43:
v_mfma_f32_16x16x32_bf16 v[136:139], a[128:131], v[48:51], v[104:107]
buffer_load_dwordx4 v1, s[36:39], s72 offen offset:2048 lds
v_mfma_f32_16x16x32_bf16 v[152:155], a[144:147], v[48:51], v[112:115]
v_exp_f32 v168, v168
s_branch Ljoin45
Lnt44:
v_mfma_f32_16x16x32_bf16 v[136:139], a[128:131], v[48:51], v[88:91]
buffer_load_dwordx4 v1, s[36:39], s72 offen offset:2048 lds
v_mfma_f32_16x16x32_bf16 v[152:155], a[144:147], v[48:51], v[104:107]
v_exp_f32 v168, v168
Ljoin45:
v_mfma_f32_16x16x32_bf16 v[136:139], a[132:135], v[52:55], v[136:139]
ds_read_b128 a[236:239], v2 offset:11264
v_cvt_pk_bf16_f32 v223, v190, v191
v_mfma_f32_16x16x32_bf16 v[136:139], a[136:139], v[56:59], v[136:139]
v_exp_f32 v169, v169
v_mfma_f32_16x16x32_bf16 v[136:139], a[140:143], v[60:63], v[136:139]
ds_read_b128 a[240:243], v2 offset:12288
v_cvt_pk_bf16_f32 v216, v168, v169
v_mfma_f32_16x16x32_bf16 v[152:155], a[156:159], v[60:63], v[152:155]
v_exp_f32 v170, v170
v_mfma_f32_16x16x32_bf16 v[152:155], a[152:155], v[56:59], v[152:155]
v_exp_f32 v171, v171
v_mfma_f32_16x16x32_bf16 v[152:155], a[148:151], v[52:55], v[152:155]
ds_read_b128 a[244:247], v2 offset:13312
v_cvt_pk_bf16_f32 v217, v170, v171
v_mfma_f32_16x16x32_bf16 v[140:143], a[128:131], v[64:67], v[92:95]
v_exp_f32 v184, v184
v_mfma_f32_16x16x32_bf16 v[140:143], a[132:135], v[68:71], v[140:143]
ds_read_b128 a[248:251], v2 offset:14336
v_mfma_f32_16x16x32_bf16 v[140:143], a[136:139], v[72:75], v[140:143]
v_exp_f32 v185, v185
v_mfma_f32_16x16x32_bf16 v[140:143], a[140:143], v[76:79], v[140:143]
buffer_load_dwordx4 v1, s[36:39], s72 offen offset:3072 lds
v_mfma_f32_16x16x32_bf16 v[156:159], a[156:159], v[76:79], v[92:95]
ds_read_b128 a[252:255], v2 offset:15360
v_cvt_pk_bf16_f32 v218, v184, v185
v_mfma_f32_16x16x32_bf16 v[156:159], a[152:155], v[72:75], v[156:159]
v_exp_f32 v186, v186
v_mfma_f32_16x16x32_bf16 v[156:159], a[148:151], v[68:71], v[156:159]
s_waitcnt vmcnt(17) lgkmcnt(0)
v_exp_f32 v187, v187
v_mfma_f32_16x16x32_bf16 v[156:159], a[144:147], v[64:67], v[156:159]
s_barrier
v_cvt_pk_bf16_f32 v219, v186, v187
v_add_u32 v2, s82, v1
v_mfma_f32_16x16x32_bf16 v[228:231], v[120:123], v[196:199], v[228:231]
s_mov_b32 m0, s62
v_exp_f32 v136, v136
v_mfma_f32_16x16x32_bf16 v[228:231], v[120:123], v[212:215], v[228:231]
s_add_u32 s72, s93, 0x3000000
ds_read_b128 a[128:131], v2 offset:16384
v_mul_u32_u24 v253, 4160, v253
v_mfma_f32_16x16x32_bf16 v[236:239], v[120:123], v[204:207], v[236:239]
buffer_load_dwordx4 v1, s[44:47], s72 offen sc1 lds
v_mfma_f32_16x16x32_bf16 v[236:239], v[120:123], v[220:223], v[236:239]
v_exp_f32 v137, v137
v_mfma_f32_16x16x32_bf16 a[32:35], a[192:195], v[196:199], a[32:35]
ds_read_b128 a[132:135], v2 offset:17408
v_cvt_pk_bf16_f32 v200, v136, v137
v_mfma_f32_16x16x32_bf16 a[32:35], a[224:227], v[212:215], a[32:35]
v_exp_f32 v138, v138
v_mfma_f32_16x16x32_bf16 a[96:99], a[224:227], v[220:223], a[96:99]
ds_read_b128 a[136:139], v2 offset:18432
v_add_u32 v6, v6, v253
v_mfma_f32_16x16x32_bf16 a[96:99], a[192:195], v[204:207], a[96:99]
buffer_load_dwordx4 v1, s[44:47], s72 offen offset:1024 sc1 lds
v_mfma_f32_16x16x32_bf16 a[100:103], a[196:199], v[204:207], a[100:103]
v_exp_f32 v139, v139
v_mfma_f32_16x16x32_bf16 a[100:103], a[228:231], v[220:223], a[100:103]
ds_read_b128 a[140:143], v2 offset:19456
v_cvt_pk_bf16_f32 v201, v138, v139
v_mfma_f32_16x16x32_bf16 a[36:39], a[228:231], v[212:215], a[36:39]
v_exp_f32 v152, v152
v_mfma_f32_16x16x32_bf16 a[36:39], a[196:199], v[196:199], a[36:39]
ds_read_b128 a[144:147], v2 offset:20480
v_bfe_u32 v251, v0, 2, 2
v_mfma_f32_16x16x32_bf16 a[40:43], a[200:203], v[196:199], a[40:43]
buffer_load_dwordx4 v1, s[44:47], s72 offen offset:2048 sc1 lds
v_mfma_f32_16x16x32_bf16 a[40:43], a[232:235], v[212:215], a[40:43]
v_exp_f32 v153, v153
v_mfma_f32_16x16x32_bf16 a[104:107], a[232:235], v[220:223], a[104:107]
ds_read_b128 a[148:151], v2 offset:21504
v_cvt_pk_bf16_f32 v202, v152, v153
v_mfma_f32_16x16x32_bf16 a[104:107], a[200:203], v[204:207], a[104:107]
buffer_load_dwordx4 v1, s[44:47], s72 offen offset:3072 sc1 lds
v_mfma_f32_16x16x32_bf16 a[108:111], a[204:207], v[204:207], a[108:111]
s_add_u32 s66, s58, 0
v_exp_f32 v154, v154
v_mfma_f32_16x16x32_bf16 a[108:111], a[236:239], v[220:223], a[108:111]
s_and_b32 s66, s66, 3
ds_read_b128 a[152:155], v2 offset:22528
v_lshl_add_u32 v6, v248, 3, v6
v_mfma_f32_16x16x32_bf16 a[44:47], a[236:239], v[212:215], a[44:47]
s_mul_i32 s66, s66, 4160
v_exp_f32 v155, v155
v_mfma_f32_16x16x32_bf16 a[44:47], a[204:207], v[196:199], a[44:47]
s_add_u32 s66, s66, s92
ds_read_b128 a[156:159], v2 offset:23552
v_cvt_pk_bf16_f32 v203, v154, v155
v_mfma_f32_16x16x32_bf16 a[48:51], a[208:211], v[196:199], a[48:51]
s_waitcnt lgkmcnt(8)
v_exp_f32 v140, v140
v_mfma_f32_16x16x32_bf16 a[48:51], a[240:243], v[212:215], a[48:51]
s_add_u32 m0, s66, 16672
ds_read_b128 a[192:195], v2 offset:0
v_lshl_add_u32 v6, v241, 4, v6
v_mfma_f32_16x16x32_bf16 a[112:115], a[240:243], v[220:223], a[112:115]
s_add_u32 s72, s93, 0x0
buffer_load_dwordx4 v1, s[36:39], s72 offen lds
v_mfma_f32_16x16x32_bf16 a[112:115], a[208:211], v[204:207], a[112:115]
buffer_load_dwordx4 v1, s[36:39], s72 offen offset:1024 lds
v_mfma_f32_16x16x32_bf16 a[116:119], a[212:215], v[204:207], a[116:119]
v_exp_f32 v141, v141
v_mfma_f32_16x16x32_bf16 a[116:119], a[244:247], v[220:223], a[116:119]
ds_read_b128 a[196:199], v2 offset:1024
v_lshlrev_b32 v5, 3, v251
v_mfma_f32_16x16x32_bf16 a[52:55], a[244:247], v[212:215], a[52:55]
v_exp_f32 v142, v142
v_mfma_f32_16x16x32_bf16 a[52:55], a[212:215], v[196:199], a[52:55]
ds_read_b128 a[200:203], v2 offset:2048
v_lshrrev_b32 v5, v5, v252
v_mfma_f32_16x16x32_bf16 a[56:59], a[216:219], v[196:199], a[56:59]
buffer_load_dwordx4 v1, s[36:39], s72 offen offset:2048 lds
v_mfma_f32_16x16x32_bf16 a[56:59], a[248:251], v[212:215], a[56:59]
v_exp_f32 v143, v143
v_mfma_f32_16x16x32_bf16 a[120:123], a[248:251], v[220:223], a[120:123]
ds_read_b128 a[204:207], v2 offset:3072
v_and_b32 v5, 3, v5
v_mfma_f32_16x16x32_bf16 a[120:123], a[216:219], v[204:207], a[120:123]
v_exp_f32 v156, v156
v_mfma_f32_16x16x32_bf16 a[124:127], a[220:223], v[204:207], a[124:127]
ds_read_b128 a[208:211], v2 offset:4096
v_cmp_ne_u32 vcc, 1, v251
v_mfma_f32_16x16x32_bf16 a[124:127], a[252:255], v[220:223], a[124:127]
buffer_load_dwordx4 v1, s[36:39], s72 offen offset:3072 lds
v_mfma_f32_16x16x32_bf16 a[60:63], a[252:255], v[212:215], a[60:63]
s_add_u32 s66, s58, 2
v_exp_f32 v157, v157
v_mfma_f32_16x16x32_bf16 a[60:63], a[220:223], v[196:199], a[60:63]
s_and_b32 s66, s66, 3
ds_read_b128 a[212:215], v2 offset:5120
v_cvt_pk_bf16_f32 v204, v140, v141
s_cmp_eq_u32 s58, 2
s_cbranch_scc1 Lta46
s_cmp_eq_u32 s58, 3
s_cbranch_scc1 Lnt47
v_mfma_f32_16x16x32_bf16 v[168:171], a[160:163], v[48:51], v[112:115]
s_mul_i32 s66, s66, 4160
v_exp_f32 v158, v158
v_mfma_f32_16x16x32_bf16 v[184:187], a[176:179], v[48:51], v[112:115]
s_add_u32 s66, s66, s92
ds_read_b128 a[216:219], v2 offset:6144
v_cvt_pk_bf16_f32 v205, v142, v143
s_branch Ljoin48
Lta46:
v_mfma_f32_16x16x32_bf16 v[168:171], a[160:163], v[48:51], v[104:107]
s_mul_i32 s66, s66, 4160
v_exp_f32 v158, v158
v_mfma_f32_16x16x32_bf16 v[184:187], a[176:179], v[48:51], v[112:115]
s_add_u32 s66, s66, s92
ds_read_b128 a[216:219], v2 offset:6144
v_cvt_pk_bf16_f32 v205, v142, v143
s_branch Ljoin48
Lnt47:
v_mfma_f32_16x16x32_bf16 v[168:171], a[160:163], v[48:51], v[88:91]
s_mul_i32 s66, s66, 4160
v_exp_f32 v158, v158
v_mfma_f32_16x16x32_bf16 v[184:187], a[176:179], v[48:51], v[104:107]
s_add_u32 s66, s66, s92
ds_read_b128 a[216:219], v2 offset:6144
v_cvt_pk_bf16_f32 v205, v142, v143
Ljoin48:
v_mfma_f32_16x16x32_bf16 v[172:175], a[160:163], v[64:67], v[92:95]
s_add_u32 m0, s66, 33312
v_exp_f32 v159, v159
v_mfma_f32_16x16x32_bf16 v[172:175], a[164:167], v[68:71], v[172:175]
s_add_u32 s72, s93, 0x4
buffer_load_dwordx4 v1, s[36:39], s72 offen lds
v_mfma_f32_16x16x32_bf16 v[172:175], a[168:171], v[72:75], v[172:175]
ds_read_b128 a[220:223], v2 offset:7168
v_cvt_pk_bf16_f32 v206, v156, v157
v_mfma_f32_16x16x32_bf16 v[172:175], a[172:175], v[76:79], v[172:175]
buffer_load_dwordx4 v1, s[36:39], s72 offen offset:1024 lds
v_mfma_f32_16x16x32_bf16 v[188:191], a[188:191], v[76:79], v[92:95]
v_cvt_pk_bf16_f32 v207, v158, v159
v_mul_u32_u24 v5, 16640, v5
v_mfma_f32_16x16x32_bf16 v[188:191], a[184:187], v[72:75], v[188:191]
v_add_u32 v5, s92, v5
v_cndmask_b32 v5, v250, v5, vcc
v_mfma_f32_16x16x32_bf16 v[188:191], a[180:183], v[68:71], v[188:191]
v_add_u32 v253, s58, v251
v_and_b32 v253, 3, v253
v_mfma_f32_16x16x32_bf16 v[188:191], a[176:179], v[64:67], v[188:191]
v_mul_u32_u24 v253, 4160, v253
v_add_u32 v5, v5, v253
v_mfma_f32_16x16x32_bf16 v[168:171], a[164:167], v[52:55], v[168:171]
s_add_u32 s73, s62, 480
v_lshlrev_b32 v248, 5, v240
v_sub_u32 v248, s73, v248
v_mfma_f32_16x16x32_bf16 v[168:171], a[168:171], v[56:59], v[168:171]
v_lshl_add_u32 v7, v241, 4, v248
v_mfma_f32_16x16x32_bf16 v[168:171], a[172:175], v[60:63], v[168:171]
s_and_b32 s73, s58, 1
v_mfma_f32_16x16x32_bf16 v[184:187], a[188:191], v[60:63], v[184:187]
s_lshl_b32 s73, s73, 4
v_mfma_f32_16x16x32_bf16 v[184:187], a[184:187], v[56:59], v[184:187]
s_lshr_b32 s73, s90, s73
v_mfma_f32_16x16x32_bf16 v[184:187], a[180:183], v[52:55], v[184:187]
s_waitcnt lgkmcnt(4)
s_and_b32 s73, s73, 0xffff
v_lshl_add_u32 v248, v241, 3, v240
v_sub_u32 v248, 15, v248
v_and_b32 v249, 1, v248
v_lshlrev_b32 v249, 4, v249
v_lshlrev_b32 v249, v249, s73
v_lshrrev_b32 v248, 1, v248
v_and_b32 v241, 3, v0
v_cmp_eq_u32 vcc, 0, v248
v_lshl_add_u32 v5, v241, 3, v5
s_nop 0
v_cndmask_b32 v8, 0, v249, vcc
v_cmp_eq_u32 vcc, 1, v248
v_lshlrev_b32 v240, 4, v251
s_nop 0
v_cndmask_b32 v9, 0, v249, vcc
v_cmp_eq_u32 vcc, 2, v248
v_sub_u32 v240, 48, v240
v_lshlrev_b64 v[12:13], 16, s[88:89]
v_cndmask_b32 v10, 0, v249, vcc
v_cmp_eq_u32 vcc, 3, v248
v_lshlrev_b64 v[12:13], v240, v[12:13]
s_nop 0
v_cndmask_b32 v11, 0, v249, vcc
v_cmp_eq_u32 vcc, 3, v241
s_add_u32 s73, s62, 4096
v_lshl_add_u32 v14, v0, 3, s73
v_cndmask_b32 v12, 0, v12, vcc
v_cndmask_b32 v13, 0, v13, vcc
v_lshrrev_b32 v15, 4, v0
v_lshlrev_b32 v15, 1, v15
v_and_b32 v240, 7, v0
v_xor_b32 v15, v15, v240
v_lshlrev_b32 v15, 4, v15
v_lshrrev_b32 v240, 3, v0
v_lshl_add_u32 v15, v240, 11, v15
s_lshl_b32 s75, s59, 1
s_andn2_b32 s75, 8, s75
s_add_u32 s75, s75, s60
s_lshl_b32 s76, s65, 2
s_lshr_b32 s80, s59, 3
s_add_u32 s76, s76, s80
s_lshl_b32 s94, s58, 16
s_lshl_b32 s80, s76, 7
s_add_u32 s94, s94, s80
s_lshl_b32 s80, s75, 18
s_add_u32 s80, s80, s94
v_rcp_f32 v226, v224
v_rcp_f32 v230, v228
s_lshl_b32 s73, s52, 12
s_add_u32 s73, s73, 0x2000000
s_lshl_b32 s70, s67, 2
s_add_u32 s70, s70, s73
v_or_b32 v3, s53, v1
v_mov_b32 v227, v226
v_accvgpr_read_b32 v240, a0
v_accvgpr_read_b32 v241, a1
v_accvgpr_read_b32 v242, a2
v_accvgpr_read_b32 v243, a3
v_accvgpr_read_b32 v244, a4
v_accvgpr_read_b32 v245, a5
v_accvgpr_read_b32 v246, a6
v_accvgpr_read_b32 v247, a7
v_pk_mul_f32 v[240:241], v[240:241], v[226:227]
v_pk_mul_f32 v[242:243], v[242:243], v[226:227]
v_pk_mul_f32 v[244:245], v[244:245], v[226:227]
buffer_load_dwordx4 v1, s[36:39], s72 offen offset:2048 lds
v_pk_mul_f32 v[246:247], v[246:247], v[226:227]
v_cvt_pk_bf16_f32 v128, v240, v241
v_cvt_pk_bf16_f32 v129, v242, v243
v_cvt_pk_bf16_f32 v130, v244, v245
v_cvt_pk_bf16_f32 v131, v246, v247
v_accvgpr_read_b32 v248, a8
v_accvgpr_read_b32 v249, a9
v_accvgpr_read_b32 v250, a10
v_accvgpr_read_b32 v251, a11
v_accvgpr_read_b32 v252, a12
v_accvgpr_read_b32 v253, a13
v_accvgpr_read_b32 v254, a14
v_accvgpr_read_b32 v255, a15
v_pk_mul_f32 v[248:249], v[248:249], v[226:227]
v_pk_mul_f32 v[250:251], v[250:251], v[226:227]
v_pk_mul_f32 v[252:253], v[252:253], v[226:227]
v_pk_mul_f32 v[254:255], v[254:255], v[226:227]
v_cvt_pk_bf16_f32 v144, v248, v249
buffer_load_dwordx4 v1, s[36:39], s72 offen offset:3072 lds
v_cvt_pk_bf16_f32 v145, v250, v251
v_cvt_pk_bf16_f32 v146, v252, v253
v_cvt_pk_bf16_f32 v147, v254, v255
v_accvgpr_read_b32 v240, a16
v_accvgpr_read_b32 v241, a17
v_accvgpr_read_b32 v242, a18
v_accvgpr_read_b32 v243, a19
v_accvgpr_read_b32 v244, a20
v_accvgpr_read_b32 v245, a21
v_accvgpr_read_b32 v246, a22
v_accvgpr_read_b32 v247, a23
v_pk_mul_f32 v[240:241], v[240:241], v[226:227]
v_pk_mul_f32 v[242:243], v[242:243], v[226:227]
v_pk_mul_f32 v[244:245], v[244:245], v[226:227]
v_pk_mul_f32 v[246:247], v[246:247], v[226:227]
v_cvt_pk_bf16_f32 v160, v240, v241
v_cvt_pk_bf16_f32 v161, v242, v243
v_cvt_pk_bf16_f32 v162, v244, v245
buffer_load_dwordx4 v[80:83], v15, s[4:7], s80 offen
v_cvt_pk_bf16_f32 v163, v246, v247
v_accvgpr_read_b32 v248, a24
v_accvgpr_read_b32 v249, a25
v_accvgpr_read_b32 v250, a26
v_accvgpr_read_b32 v251, a27
v_accvgpr_read_b32 v252, a28
v_accvgpr_read_b32 v253, a29
v_accvgpr_read_b32 v254, a30
v_accvgpr_read_b32 v255, a31
v_pk_mul_f32 v[248:249], v[248:249], v[226:227]
v_pk_mul_f32 v[250:251], v[250:251], v[226:227]
v_pk_mul_f32 v[252:253], v[252:253], v[226:227]
v_pk_mul_f32 v[254:255], v[254:255], v[226:227]
v_cvt_pk_bf16_f32 v176, v248, v249
v_cvt_pk_bf16_f32 v177, v250, v251
v_cvt_pk_bf16_f32 v178, v252, v253
v_cvt_pk_bf16_f32 v179, v254, v255
v_mov_b32 v231, v230
v_accvgpr_read_b32 v240, a32
s_add_u32 s80, s80, 0x4000
buffer_load_dwordx4 v[84:87], v15, s[4:7], s80 offen
v_accvgpr_read_b32 v241, a33
v_accvgpr_read_b32 v242, a34
v_accvgpr_read_b32 v243, a35
v_accvgpr_read_b32 v244, a36
v_accvgpr_read_b32 v245, a37
v_accvgpr_read_b32 v246, a38
v_accvgpr_read_b32 v247, a39
v_pk_mul_f32 v[240:241], v[240:241], v[230:231]
v_pk_mul_f32 v[242:243], v[242:243], v[230:231]
v_pk_mul_f32 v[244:245], v[244:245], v[230:231]
v_pk_mul_f32 v[246:247], v[246:247], v[230:231]
v_cvt_pk_bf16_f32 v132, v240, v241
v_cvt_pk_bf16_f32 v133, v242, v243
v_cvt_pk_bf16_f32 v134, v244, v245
v_cvt_pk_bf16_f32 v135, v246, v247
v_accvgpr_read_b32 v248, a40
v_accvgpr_read_b32 v249, a41
v_accvgpr_read_b32 v250, a42
s_add_u32 s80, s80, 0x4000
buffer_load_dwordx4 v[96:99], v15, s[4:7], s80 offen
v_accvgpr_read_b32 v251, a43
v_accvgpr_read_b32 v252, a44
v_accvgpr_read_b32 v253, a45
v_accvgpr_read_b32 v254, a46
v_accvgpr_read_b32 v255, a47
v_pk_mul_f32 v[248:249], v[248:249], v[230:231]
v_pk_mul_f32 v[250:251], v[250:251], v[230:231]
v_pk_mul_f32 v[252:253], v[252:253], v[230:231]
v_pk_mul_f32 v[254:255], v[254:255], v[230:231]
v_cvt_pk_bf16_f32 v148, v248, v249
v_cvt_pk_bf16_f32 v149, v250, v251
v_cvt_pk_bf16_f32 v150, v252, v253
v_cvt_pk_bf16_f32 v151, v254, v255
v_accvgpr_read_b32 v240, a48
v_accvgpr_read_b32 v241, a49
v_accvgpr_read_b32 v242, a50
v_accvgpr_read_b32 v243, a51
v_accvgpr_read_b32 v244, a52
s_add_u32 s80, s80, 0x4000
buffer_load_dwordx4 v[100:103], v15, s[4:7], s80 offen
v_accvgpr_read_b32 v245, a53
v_accvgpr_read_b32 v246, a54
v_accvgpr_read_b32 v247, a55
v_pk_mul_f32 v[240:241], v[240:241], v[230:231]
v_pk_mul_f32 v[242:243], v[242:243], v[230:231]
v_pk_mul_f32 v[244:245], v[244:245], v[230:231]
v_pk_mul_f32 v[246:247], v[246:247], v[230:231]
v_cvt_pk_bf16_f32 v164, v240, v241
v_cvt_pk_bf16_f32 v165, v242, v243
v_cvt_pk_bf16_f32 v166, v244, v245
v_cvt_pk_bf16_f32 v167, v246, v247
v_accvgpr_read_b32 v248, a56
v_accvgpr_read_b32 v249, a57
v_accvgpr_read_b32 v250, a58
v_accvgpr_read_b32 v251, a59
v_accvgpr_read_b32 v252, a60
v_accvgpr_read_b32 v253, a61
v_accvgpr_read_b32 v254, a62
v_accvgpr_read_b32 v255, a63
v_pk_mul_f32 v[248:249], v[248:249], v[230:231]
v_pk_mul_f32 v[250:251], v[250:251], v[230:231]
v_pk_mul_f32 v[252:253], v[252:253], v[230:231]
v_pk_mul_f32 v[254:255], v[254:255], v[230:231]
v_cvt_pk_bf16_f32 v180, v248, v249
v_cvt_pk_bf16_f32 v181, v250, v251
v_cvt_pk_bf16_f32 v182, v252, v253
v_cvt_pk_bf16_f32 v183, v254, v255
v_mfma_f32_16x16x32_bf16 v[232:235], v[120:123], v[216:219], v[232:235]
s_add_u32 s82, s82, 0x8000
ds_read_b128 a[160:163], v2 offset:24576
ds_read_b128 a[164:167], v2 offset:25600
v_mfma_f32_16x16x32_bf16 v[232:235], v[120:123], v[200:203], v[232:235]
s_and_b32 s82, s82, 0x1ffff
v_exp_f32 v172, v172
v_mfma_f32_16x16x32_bf16 a[64:67], a[224:227], v[216:219], a[64:67]
v_exp_f32 v173, v173
v_mfma_f32_16x16x32_bf16 a[64:67], a[192:195], v[200:203], a[64:67]
s_nop 0
ds_read_b128 a[168:171], v2 offset:26624
ds_read_b128 a[172:175], v2 offset:27648
v_mfma_f32_16x16x32_bf16 a[68:71], a[196:199], v[200:203], a[68:71]
v_exp_f32 v174, v174
v_mfma_f32_16x16x32_bf16 a[68:71], a[228:231], v[216:219], a[68:71]
v_exp_f32 v175, v175
v_mfma_f32_16x16x32_bf16 a[72:75], a[232:235], v[216:219], a[72:75]
buffer_store_dwordx4 v[128:131], v3, s[44:47], s70 offen sc1
v_mfma_f32_16x16x32_bf16 a[72:75], a[200:203], v[200:203], a[72:75]
s_nop 0
ds_read_b128 a[176:179], v2 offset:28672
ds_read_b128 a[180:183], v2 offset:29696
v_mfma_f32_16x16x32_bf16 a[76:79], a[204:207], v[200:203], a[76:79]
v_exp_f32 v188, v188
v_mfma_f32_16x16x32_bf16 a[76:79], a[236:239], v[216:219], a[76:79]
s_nop 0
ds_read_b128 a[184:187], v2 offset:30720
ds_read_b128 a[188:191], v2 offset:31744
v_mfma_f32_16x16x32_bf16 a[80:83], a[240:243], v[216:219], a[80:83]
s_waitcnt lgkmcnt(8)
ds_read_b128 a[224:227], v2 offset:8192
ds_read_b128 a[228:231], v2 offset:9216
v_mfma_f32_16x16x32_bf16 a[80:83], a[208:211], v[200:203], a[80:83]
s_nop 0
ds_read_b128 a[232:235], v2 offset:10240
ds_read_b128 a[236:239], v2 offset:11264
v_mfma_f32_16x16x32_bf16 a[84:87], a[212:215], v[200:203], a[84:87]
ds_read_b128 a[240:243], v2 offset:12288
v_cvt_pk_bf16_f32 v220, v172, v173
v_mfma_f32_16x16x32_bf16 a[84:87], a[244:247], v[216:219], a[84:87]
v_exp_f32 v189, v189
v_mfma_f32_16x16x32_bf16 a[88:91], a[248:251], v[216:219], a[88:91]
v_exp_f32 v190, v190
v_mfma_f32_16x16x32_bf16 a[88:91], a[216:219], v[200:203], a[88:91]
s_nop 0
ds_read_b128 a[244:247], v2 offset:13312
ds_read_b128 a[248:251], v2 offset:14336
v_mfma_f32_16x16x32_bf16 a[92:95], a[220:223], v[200:203], a[92:95]
v_cvt_pk_bf16_f32 v221, v174, v175
v_cvt_pk_bf16_f32 v222, v188, v189
v_mfma_f32_16x16x32_bf16 a[92:95], a[252:255], v[216:219], a[92:95]
v_exp_f32 v191, v191
s_cmp_eq_u32 s58, 0
s_cbranch_scc1 Lta49
s_cmp_eq_u32 s58, 1
s_cbranch_scc1 Lnt50
v_mfma_f32_16x16x32_bf16 v[140:143], a[128:131], v[64:67], v[92:95]
v_exp_f32 v168, v168
v_mfma_f32_16x16x32_bf16 v[156:159], a[144:147], v[64:67], v[92:95]
buffer_store_dwordx4 v[144:147], v3, s[44:47], s70 offen offset:1024 sc1
s_branch Ljoin51
Lta49:
v_mfma_f32_16x16x32_bf16 v[140:143], a[128:131], v[64:67], v[108:111]
v_exp_f32 v168, v168
v_mfma_f32_16x16x32_bf16 v[156:159], a[144:147], v[64:67], v[112:115]
buffer_store_dwordx4 v[144:147], v3, s[44:47], s70 offen offset:1024 sc1
s_branch Ljoin51
Lnt50:
v_mfma_f32_16x16x32_bf16 v[140:143], a[128:131], v[64:67], v[92:95]
v_exp_f32 v168, v168
v_mfma_f32_16x16x32_bf16 v[156:159], a[144:147], v[64:67], v[108:111]
buffer_store_dwordx4 v[144:147], v3, s[44:47], s70 offen offset:1024 sc1
Ljoin51:
v_mfma_f32_16x16x32_bf16 v[140:143], a[132:135], v[68:71], v[140:143]
v_exp_f32 v169, v169
v_mfma_f32_16x16x32_bf16 v[140:143], a[136:139], v[72:75], v[140:143]
v_exp_f32 v170, v170
v_mfma_f32_16x16x32_bf16 v[140:143], a[140:143], v[76:79], v[140:143]
buffer_store_dwordx4 v[160:163], v3, s[44:47], s70 offen offset:2048 sc1
v_mfma_f32_16x16x32_bf16 v[156:159], a[156:159], v[76:79], v[156:159]
ds_read_b128 a[252:255], v2 offset:15360
v_cvt_pk_bf16_f32 v223, v190, v191
v_mfma_f32_16x16x32_bf16 v[156:159], a[152:155], v[72:75], v[156:159]
s_waitcnt vmcnt(24) lgkmcnt(4)
v_exp_f32 v171, v171
v_mfma_f32_16x16x32_bf16 v[156:159], a[148:151], v[68:71], v[156:159]
s_barrier
v_exp_f32 v184, v184
v_add_u32 v2, s82, v1
v_cvt_pk_bf16_f32 v216, v168, v169
v_cvt_pk_bf16_f32 v217, v170, v171
v_exp_f32 v185, v185
v_exp_f32 v186, v186
v_cvt_pk_bf16_f32 v218, v184, v185
v_exp_f32 v187, v187
s_nop 0
v_cvt_pk_bf16_f32 v219, v186, v187
v_mfma_f32_16x16x32_bf16 v[236:239], v[120:123], v[204:207], v[236:239]
s_add_u32 s78, s59, 8
v_exp_f32 v140, v140
v_mfma_f32_16x16x32_bf16 v[236:239], v[120:123], v[220:223], v[236:239]
s_and_b32 s78, s78, 24
v_exp_f32 v141, v141
v_mfma_f32_16x16x32_bf16 a[96:99], a[192:195], v[204:207], a[96:99]
s_lshr_b32 s79, 0x67234501, s78
ds_read_b128 a[192:195], v2 offset:0
v_mfma_f32_16x16x32_bf16 a[96:99], a[224:227], v[220:223], a[96:99]
s_and_b32 s79, s79, 7
buffer_store_dwordx4 v[176:179], v3, s[44:47], s70 offen offset:3072 sc1
v_mfma_f32_16x16x32_bf16 a[100:103], a[228:231], v[220:223], a[100:103]
s_add_u32 s70, s70, 0x80000
v_exp_f32 v142, v142
v_mfma_f32_16x16x32_bf16 a[100:103], a[196:199], v[204:207], a[100:103]
s_lshl_b32 s79, s79, 18
ds_read_b128 a[196:199], v2 offset:1024
v_mfma_f32_16x16x32_bf16 a[104:107], a[200:203], v[204:207], a[104:107]
s_add_u32 s79, s79, s94
ds_read_b128 a[200:203], v2 offset:2048
v_mfma_f32_16x16x32_bf16 a[104:107], a[232:235], v[220:223], a[104:107]
s_add_u32 s12, s61, 0
v_exp_f32 v143, v143
v_mfma_f32_16x16x32_bf16 a[108:111], a[236:239], v[220:223], a[108:111]
s_and_b32 s12, s12, 3
v_exp_f32 v156, v156
v_mfma_f32_16x16x32_bf16 a[108:111], a[204:207], v[204:207], a[108:111]
s_lshl_b32 s12, s12, 21
ds_read_b128 a[204:207], v2 offset:3072
v_mfma_f32_16x16x32_bf16 a[112:115], a[208:211], v[204:207], a[112:115]
s_waitcnt lgkmcnt(4)
ds_read_b128 a[208:211], v2 offset:4096
v_mfma_f32_16x16x32_bf16 a[112:115], a[240:243], v[220:223], a[112:115]
s_add_u32 s12, s12, s79
buffer_store_dwordx4 v[132:135], v3, s[44:47], s70 offen sc1
v_mfma_f32_16x16x32_bf16 a[116:119], a[244:247], v[220:223], a[116:119]
s_add_u32 s13, s61, 1
v_exp_f32 v157, v157
v_mfma_f32_16x16x32_bf16 a[116:119], a[212:215], v[204:207], a[116:119]
s_and_b32 s13, s13, 3
ds_read_b128 a[212:215], v2 offset:5120
v_mfma_f32_16x16x32_bf16 a[120:123], a[216:219], v[204:207], a[120:123]
s_lshl_b32 s13, s13, 21
v_exp_f32 v158, v158
v_mfma_f32_16x16x32_bf16 a[120:123], a[248:251], v[220:223], a[120:123]
s_add_u32 s13, s13, s79
ds_read_b128 a[216:219], v2 offset:6144
v_mfma_f32_16x16x32_bf16 a[124:127], a[252:255], v[220:223], a[124:127]
s_add_u32 s14, s61, 2
buffer_store_dwordx4 v[148:151], v3, s[44:47], s70 offen offset:1024 sc1
v_mfma_f32_16x16x32_bf16 a[124:127], a[220:223], v[204:207], a[124:127]
s_and_b32 s14, s14, 3
ds_read_b128 a[220:223], v2 offset:7168
v_cvt_pk_bf16_f32 v204, v140, v141
s_cmp_eq_u32 s58, 2
s_cbranch_scc1 Lta52
s_cmp_eq_u32 s58, 3
s_cbranch_scc1 Lnt53
v_mfma_f32_16x16x32_bf16 v[172:175], a[160:163], v[64:67], v[112:115]
s_lshl_b32 s14, s14, 21
v_cvt_pk_bf16_f32 v205, v142, v143
v_cvt_pk_bf16_f32 v206, v156, v157
v_mfma_f32_16x16x32_bf16 v[188:191], a[176:179], v[64:67], v[112:115]
s_add_u32 s14, s14, s79
v_exp_f32 v159, v159
s_branch Ljoin54
Lta52:
v_mfma_f32_16x16x32_bf16 v[172:175], a[160:163], v[64:67], v[108:111]
s_lshl_b32 s14, s14, 21
v_cvt_pk_bf16_f32 v205, v142, v143
v_cvt_pk_bf16_f32 v206, v156, v157
v_mfma_f32_16x16x32_bf16 v[188:191], a[176:179], v[64:67], v[112:115]
s_add_u32 s14, s14, s79
v_exp_f32 v159, v159
s_branch Ljoin54
Lnt53:
v_mfma_f32_16x16x32_bf16 v[172:175], a[160:163], v[64:67], v[92:95]
s_lshl_b32 s14, s14, 21
v_cvt_pk_bf16_f32 v205, v142, v143
v_cvt_pk_bf16_f32 v206, v156, v157
v_mfma_f32_16x16x32_bf16 v[188:191], a[176:179], v[64:67], v[108:111]
s_add_u32 s14, s14, s79
v_exp_f32 v159, v159
Ljoin54:
v_mfma_f32_16x16x32_bf16 v[172:175], a[164:167], v[68:71], v[172:175]
s_add_u32 s15, s61, 3
v_cvt_pk_bf16_f32 v207, v158, v159
v_mfma_f32_16x16x32_bf16 v[172:175], a[168:171], v[72:75], v[172:175]
s_and_b32 s15, s15, 3
v_mfma_f32_16x16x32_bf16 v[172:175], a[172:175], v[76:79], v[172:175]
s_lshl_b32 s15, s15, 21
v_mfma_f32_16x16x32_bf16 v[188:191], a[188:191], v[76:79], v[188:191]
s_add_u32 s15, s15, s79
v_mfma_f32_16x16x32_bf16 v[188:191], a[184:187], v[72:75], v[188:191]
v_mfma_f32_16x16x32_bf16 v[188:191], a[180:183], v[68:71], v[188:191]
s_waitcnt lgkmcnt(4)
v_mfma_f32_16x16x32_bf16 v[232:235], v[120:123], v[216:219], v[232:235]
s_add_u32 s82, s82, 0x8000
v_exp_f32 v172, v172
v_mfma_f32_16x16x32_bf16 a[64:67], a[224:227], v[216:219], a[64:67]
s_and_b32 s82, s82, 0x1ffff
ds_read_b128 a[224:227], v2 offset:8192
v_mfma_f32_16x16x32_bf16 a[68:71], a[228:231], v[216:219], a[68:71]
ds_read_b128 a[228:231], v2 offset:9216
v_mfma_f32_16x16x32_bf16 a[72:75], a[232:235], v[216:219], a[72:75]
ds_read_b128 a[232:235], v2 offset:10240
v_mfma_f32_16x16x32_bf16 a[76:79], a[236:239], v[216:219], a[76:79]
buffer_store_dwordx4 v[164:167], v3, s[44:47], s70 offen offset:2048 sc1
v_mfma_f32_16x16x32_bf16 a[80:83], a[240:243], v[216:219], a[80:83]
s_nop 0
ds_read_b128 a[236:239], v2 offset:11264
ds_read_b128 a[240:243], v2 offset:12288
v_mfma_f32_16x16x32_bf16 a[84:87], a[244:247], v[216:219], a[84:87]
ds_read_b128 a[244:247], v2 offset:13312
v_mfma_f32_16x16x32_bf16 a[88:91], a[248:251], v[216:219], a[88:91]
v_exp_f32 v173, v173
v_mfma_f32_16x16x32_bf16 a[92:95], a[252:255], v[216:219], a[92:95]
v_exp_f32 v174, v174
ds_read_b128 a[248:251], v2 offset:14336
ds_read_b128 a[252:255], v2 offset:15360
v_add_u32 v2, s82, v1
buffer_store_dwordx4 v[180:183], v3, s[44:47], s70 offen offset:3072 sc1
v_cvt_pk_bf16_f32 v220, v172, v173
v_exp_f32 v175, v175
v_exp_f32 v188, v188
v_cvt_pk_bf16_f32 v221, v174, v175
v_exp_f32 v189, v189
v_exp_f32 v190, v190
v_cvt_pk_bf16_f32 v222, v188, v189
v_exp_f32 v191, v191
s_nop 0
v_cvt_pk_bf16_f32 v223, v190, v191
s_waitcnt vmcnt(8) lgkmcnt(0)
s_barrier
s_branch LHT4
Lslow:
s_waitcnt vmcnt(0) lgkmcnt(0)
s_barrier
s_mov_b32 s86, 1
s_lshl_b32 s81, s59, 20
s_add_u32 s81, s81, s64
s_sub_u32 s81, s81, 0x4000
s_mov_b32 s83, 0
s_lshl_b32 s75, s60, 3
s_sub_u32 s76, 128, s75
s_add_u32 s74, s75, s58
s_sub_u32 s75, s76, 8
s_add_u32 s75, s75, s58
v_mov_b32 v2, v1
v_lshrrev_b32 v240, 4, v0
v_and_b32 v241, 15, v0
v_lshlrev_b32 v240, 2, v240
v_sub_u32 v240, v241, v240
v_mov_b32 v112, 0xff800000
v_mov_b32 v113, 0xff800000
v_mov_b32 v114, 0xff800000
v_mov_b32 v115, 0xff800000
v_cmp_gt_i32 vcc, 0, v240
v_and_b32 v120, 3, v0
s_nop 0
v_cndmask_b32 v116, 0, v112, vcc
v_cmp_gt_i32 vcc, 1, v240
v_subrev_u32 v120, 1, v120
s_nop 0
v_cndmask_b32 v117, 0, v112, vcc
v_cmp_gt_i32 vcc, 2, v240
v_ashrrev_i32 v120, 31, v120
s_nop 0
v_cndmask_b32 v118, 0, v112, vcc
v_cmp_gt_i32 vcc, 3, v240
v_and_b32 v120, 0x3f803f80, v120
s_nop 0
v_cndmask_b32 v119, 0, v112, vcc
Lslow1:
s_add_u32 m0, s64, 16384
s_add_u32 s72, s81, 16384
buffer_load_dwordx4 v1, s[44:47], s72 offen sc1 lds
buffer_load_dwordx4 v1, s[44:47], s72 offen offset:1024 sc1 lds
buffer_load_dwordx4 v1, s[44:47], s72 offen offset:2048 sc1 lds
buffer_load_dwordx4 v1, s[44:47], s72 offen offset:3072 sc1 lds
s_add_u32 s81, s81, 0x8000
s_waitcnt vmcnt(0)
s_barrier
ds_read_b128 a[128:131], v2 offset:16384
ds_read_b128 a[132:135], v2 offset:17408
ds_read_b128 a[136:139], v2 offset:18432
ds_read_b128 a[140:143], v2 offset:19456
ds_read_b128 a[144:147], v2 offset:20480
ds_read_b128 a[148:151], v2 offset:21504
ds_read_b128 a[152:155], v2 offset:22528
ds_read_b128 a[156:159], v2 offset:23552
s_waitcnt lgkmcnt(0)
s_add_u32 s73, s74, 0
s_cmp_lt_u32 s73, s83
s_cbranch_scc1 Lsa55
s_cmp_eq_u32 s73, s83
s_cbranch_scc1 Lst56
v_mfma_f32_16x16x32_bf16 v[128:131], a[128:131], v[16:19], 0
s_branch Lsj57
Lst56:
v_mfma_f32_16x16x32_bf16 v[128:131], a[128:131], v[16:19], v[116:119]
Lsj57:
v_mfma_f32_16x16x32_bf16 v[128:131], a[132:135], v[20:23], v[128:131]
v_mfma_f32_16x16x32_bf16 v[128:131], a[136:139], v[24:27], v[128:131]
v_mfma_f32_16x16x32_bf16 v[128:131], a[140:143], v[28:31], v[128:131]
s_nop 7
v_max3_f32 v124, v124, v128, v129
v_max3_f32 v124, v124, v130, v131
Lsa55:
s_add_u32 s73, s74, 4
s_cmp_lt_u32 s73, s83
s_cbranch_scc1 Lsa58
s_cmp_eq_u32 s73, s83
s_cbranch_scc1 Lst59
v_mfma_f32_16x16x32_bf16 v[132:135], a[128:131], v[32:35], 0
s_branch Lsj60
Lst59:
v_mfma_f32_16x16x32_bf16 v[132:135], a[128:131], v[32:35], v[116:119]
Lsj60:
v_mfma_f32_16x16x32_bf16 v[132:135], a[132:135], v[36:39], v[132:135]
v_mfma_f32_16x16x32_bf16 v[132:135], a[136:139], v[40:43], v[132:135]
v_mfma_f32_16x16x32_bf16 v[132:135], a[140:143], v[44:47], v[132:135]
s_nop 7
v_max3_f32 v125, v125, v132, v133
v_max3_f32 v125, v125, v134, v135
Lsa58:
s_add_u32 s73, s75, 0
s_cmp_lt_u32 s73, s83
s_cbranch_scc1 Lsa61
s_cmp_eq_u32 s73, s83
s_cbranch_scc1 Lst62
v_mfma_f32_16x16x32_bf16 v[136:139], a[128:131], v[48:51], 0
s_branch Lsj63
Lst62:
v_mfma_f32_16x16x32_bf16 v[136:139], a[128:131], v[48:51], v[116:119]
Lsj63:
v_mfma_f32_16x16x32_bf16 v[136:139], a[132:135], v[52:55], v[136:139]
v_mfma_f32_16x16x32_bf16 v[136:139], a[136:139], v[56:59], v[136:139]
v_mfma_f32_16x16x32_bf16 v[136:139], a[140:143], v[60:63], v[136:139]
s_nop 7
v_max3_f32 v126, v126, v136, v137
v_max3_f32 v126, v126, v138, v139
Lsa61:
s_add_u32 s73, s75, 4
s_cmp_lt_u32 s73, s83
s_cbranch_scc1 Lsa64
s_cmp_eq_u32 s73, s83
s_cbranch_scc1 Lst65
v_mfma_f32_16x16x32_bf16 v[140:143], a[128:131], v[64:67], 0
s_branch Lsj66
Lst65:
v_mfma_f32_16x16x32_bf16 v[140:143], a[128:131], v[64:67], v[116:119]
Lsj66:
v_mfma_f32_16x16x32_bf16 v[140:143], a[132:135], v[68:71], v[140:143]
v_mfma_f32_16x16x32_bf16 v[140:143], a[136:139], v[72:75], v[140:143]
v_mfma_f32_16x16x32_bf16 v[140:143], a[140:143], v[76:79], v[140:143]
s_nop 7
v_max3_f32 v127, v127, v140, v141
v_max3_f32 v127, v127, v142, v143
Lsa64:
s_add_u32 s83, s83, 1
s_add_u32 s73, s74, 0
s_cmp_lt_u32 s73, s83
s_cbranch_scc1 Lsa67
s_cmp_eq_u32 s73, s83
s_cbranch_scc1 Lst68
v_mfma_f32_16x16x32_bf16 v[144:147], a[144:147], v[16:19], 0
s_branch Lsj69
Lst68:
v_mfma_f32_16x16x32_bf16 v[144:147], a[144:147], v[16:19], v[116:119]
Lsj69:
v_mfma_f32_16x16x32_bf16 v[144:147], a[148:151], v[20:23], v[144:147]
v_mfma_f32_16x16x32_bf16 v[144:147], a[152:155], v[24:27], v[144:147]
v_mfma_f32_16x16x32_bf16 v[144:147], a[156:159], v[28:31], v[144:147]
s_nop 7
v_max3_f32 v124, v124, v144, v145
v_max3_f32 v124, v124, v146, v147
Lsa67:
s_add_u32 s73, s74, 4
s_cmp_lt_u32 s73, s83
s_cbranch_scc1 Lsa70
s_cmp_eq_u32 s73, s83
s_cbranch_scc1 Lst71
v_mfma_f32_16x16x32_bf16 v[148:151], a[144:147], v[32:35], 0
s_branch Lsj72
Lst71:
v_mfma_f32_16x16x32_bf16 v[148:151], a[144:147], v[32:35], v[116:119]
Lsj72:
v_mfma_f32_16x16x32_bf16 v[148:151], a[148:151], v[36:39], v[148:151]
v_mfma_f32_16x16x32_bf16 v[148:151], a[152:155], v[40:43], v[148:151]
v_mfma_f32_16x16x32_bf16 v[148:151], a[156:159], v[44:47], v[148:151]
s_nop 7
v_max3_f32 v125, v125, v148, v149
v_max3_f32 v125, v125, v150, v151
Lsa70:
s_add_u32 s73, s75, 0
s_cmp_lt_u32 s73, s83
s_cbranch_scc1 Lsa73
s_cmp_eq_u32 s73, s83
s_cbranch_scc1 Lst74
v_mfma_f32_16x16x32_bf16 v[152:155], a[144:147], v[48:51], 0
s_branch Lsj75
Lst74:
v_mfma_f32_16x16x32_bf16 v[152:155], a[144:147], v[48:51], v[116:119]
Lsj75:
v_mfma_f32_16x16x32_bf16 v[152:155], a[148:151], v[52:55], v[152:155]
v_mfma_f32_16x16x32_bf16 v[152:155], a[152:155], v[56:59], v[152:155]
v_mfma_f32_16x16x32_bf16 v[152:155], a[156:159], v[60:63], v[152:155]
s_nop 7
v_max3_f32 v126, v126, v152, v153
v_max3_f32 v126, v126, v154, v155
Lsa73:
s_add_u32 s73, s75, 4
s_cmp_lt_u32 s73, s83
s_cbranch_scc1 Lsa76
s_cmp_eq_u32 s73, s83
s_cbranch_scc1 Lst77
v_mfma_f32_16x16x32_bf16 v[156:159], a[144:147], v[64:67], 0
s_branch Lsj78
Lst77:
v_mfma_f32_16x16x32_bf16 v[156:159], a[144:147], v[64:67], v[116:119]
Lsj78:
v_mfma_f32_16x16x32_bf16 v[156:159], a[148:151], v[68:71], v[156:159]
v_mfma_f32_16x16x32_bf16 v[156:159], a[152:155], v[72:75], v[156:159]
v_mfma_f32_16x16x32_bf16 v[156:159], a[156:159], v[76:79], v[156:159]
s_nop 7
v_max3_f32 v127, v127, v156, v157
v_max3_f32 v127, v127, v158, v159
Lsa76:
s_add_u32 s83, s83, 1
ds_read_b128 a[128:131], v2 offset:24576
ds_read_b128 a[132:135], v2 offset:25600
ds_read_b128 a[136:139], v2 offset:26624
ds_read_b128 a[140:143], v2 offset:27648
ds_read_b128 a[144:147], v2 offset:28672
ds_read_b128 a[148:151], v2 offset:29696
ds_read_b128 a[152:155], v2 offset:30720
ds_read_b128 a[156:159], v2 offset:31744
s_waitcnt lgkmcnt(0)
s_add_u32 s73, s74, 0
s_cmp_lt_u32 s73, s83
s_cbranch_scc1 Lsa79
s_cmp_eq_u32 s73, s83
s_cbranch_scc1 Lst80
v_mfma_f32_16x16x32_bf16 v[128:131], a[128:131], v[16:19], 0
s_branch Lsj81
Lst80:
v_mfma_f32_16x16x32_bf16 v[128:131], a[128:131], v[16:19], v[116:119]
Lsj81:
v_mfma_f32_16x16x32_bf16 v[128:131], a[132:135], v[20:23], v[128:131]
v_mfma_f32_16x16x32_bf16 v[128:131], a[136:139], v[24:27], v[128:131]
v_mfma_f32_16x16x32_bf16 v[128:131], a[140:143], v[28:31], v[128:131]
s_nop 7
v_max3_f32 v124, v124, v128, v129
v_max3_f32 v124, v124, v130, v131
Lsa79:
s_add_u32 s73, s74, 4
s_cmp_lt_u32 s73, s83
s_cbranch_scc1 Lsa82
s_cmp_eq_u32 s73, s83
s_cbranch_scc1 Lst83
v_mfma_f32_16x16x32_bf16 v[132:135], a[128:131], v[32:35], 0
s_branch Lsj84
Lst83:
v_mfma_f32_16x16x32_bf16 v[132:135], a[128:131], v[32:35], v[116:119]
Lsj84:
v_mfma_f32_16x16x32_bf16 v[132:135], a[132:135], v[36:39], v[132:135]
v_mfma_f32_16x16x32_bf16 v[132:135], a[136:139], v[40:43], v[132:135]
v_mfma_f32_16x16x32_bf16 v[132:135], a[140:143], v[44:47], v[132:135]
s_nop 7
v_max3_f32 v125, v125, v132, v133
v_max3_f32 v125, v125, v134, v135
Lsa82:
s_add_u32 s73, s75, 0
s_cmp_lt_u32 s73, s83
s_cbranch_scc1 Lsa85
s_cmp_eq_u32 s73, s83
s_cbranch_scc1 Lst86
v_mfma_f32_16x16x32_bf16 v[136:139], a[128:131], v[48:51], 0
s_branch Lsj87
Lst86:
v_mfma_f32_16x16x32_bf16 v[136:139], a[128:131], v[48:51], v[116:119]
Lsj87:
v_mfma_f32_16x16x32_bf16 v[136:139], a[132:135], v[52:55], v[136:139]
v_mfma_f32_16x16x32_bf16 v[136:139], a[136:139], v[56:59], v[136:139]
v_mfma_f32_16x16x32_bf16 v[136:139], a[140:143], v[60:63], v[136:139]
s_nop 7
v_max3_f32 v126, v126, v136, v137
v_max3_f32 v126, v126, v138, v139
Lsa85:
s_add_u32 s73, s75, 4
s_cmp_lt_u32 s73, s83
s_cbranch_scc1 Lsa88
s_cmp_eq_u32 s73, s83
s_cbranch_scc1 Lst89
v_mfma_f32_16x16x32_bf16 v[140:143], a[128:131], v[64:67], 0
s_branch Lsj90
Lst89:
v_mfma_f32_16x16x32_bf16 v[140:143], a[128:131], v[64:67], v[116:119]
Lsj90:
v_mfma_f32_16x16x32_bf16 v[140:143], a[132:135], v[68:71], v[140:143]
v_mfma_f32_16x16x32_bf16 v[140:143], a[136:139], v[72:75], v[140:143]
v_mfma_f32_16x16x32_bf16 v[140:143], a[140:143], v[76:79], v[140:143]
s_nop 7
v_max3_f32 v127, v127, v140, v141
v_max3_f32 v127, v127, v142, v143
Lsa88:
s_add_u32 s83, s83, 1
s_add_u32 s73, s74, 0
s_cmp_lt_u32 s73, s83
s_cbranch_scc1 Lsa91
s_cmp_eq_u32 s73, s83
s_cbranch_scc1 Lst92
v_mfma_f32_16x16x32_bf16 v[144:147], a[144:147], v[16:19], 0
s_branch Lsj93
Lst92:
v_mfma_f32_16x16x32_bf16 v[144:147], a[144:147], v[16:19], v[116:119]
Lsj93:
v_mfma_f32_16x16x32_bf16 v[144:147], a[148:151], v[20:23], v[144:147]
v_mfma_f32_16x16x32_bf16 v[144:147], a[152:155], v[24:27], v[144:147]
v_mfma_f32_16x16x32_bf16 v[144:147], a[156:159], v[28:31], v[144:147]
s_nop 7
v_max3_f32 v124, v124, v144, v145
v_max3_f32 v124, v124, v146, v147
Lsa91:
s_add_u32 s73, s74, 4
s_cmp_lt_u32 s73, s83
s_cbranch_scc1 Lsa94
s_cmp_eq_u32 s73, s83
s_cbranch_scc1 Lst95
v_mfma_f32_16x16x32_bf16 v[148:151], a[144:147], v[32:35], 0
s_branch Lsj96
Lst95:
v_mfma_f32_16x16x32_bf16 v[148:151], a[144:147], v[32:35], v[116:119]
Lsj96:
v_mfma_f32_16x16x32_bf16 v[148:151], a[148:151], v[36:39], v[148:151]
v_mfma_f32_16x16x32_bf16 v[148:151], a[152:155], v[40:43], v[148:151]
v_mfma_f32_16x16x32_bf16 v[148:151], a[156:159], v[44:47], v[148:151]
s_nop 7
v_max3_f32 v125, v125, v148, v149
v_max3_f32 v125, v125, v150, v151
Lsa94:
s_add_u32 s73, s75, 0
s_cmp_lt_u32 s73, s83
s_cbranch_scc1 Lsa97
s_cmp_eq_u32 s73, s83
s_cbranch_scc1 Lst98
v_mfma_f32_16x16x32_bf16 v[152:155], a[144:147], v[48:51], 0
s_branch Lsj99
Lst98:
v_mfma_f32_16x16x32_bf16 v[152:155], a[144:147], v[48:51], v[116:119]
Lsj99:
v_mfma_f32_16x16x32_bf16 v[152:155], a[148:151], v[52:55], v[152:155]
v_mfma_f32_16x16x32_bf16 v[152:155], a[152:155], v[56:59], v[152:155]
v_mfma_f32_16x16x32_bf16 v[152:155], a[156:159], v[60:63], v[152:155]
s_nop 7
v_max3_f32 v126, v126, v152, v153
v_max3_f32 v126, v126, v154, v155
Lsa97:
s_add_u32 s73, s75, 4
s_cmp_lt_u32 s73, s83
s_cbranch_scc1 Lsa100
s_cmp_eq_u32 s73, s83
s_cbranch_scc1 Lst101
v_mfma_f32_16x16x32_bf16 v[156:159], a[144:147], v[64:67], 0
s_branch Lsj102
Lst101:
v_mfma_f32_16x16x32_bf16 v[156:159], a[144:147], v[64:67], v[116:119]
Lsj102:
v_mfma_f32_16x16x32_bf16 v[156:159], a[148:151], v[68:71], v[156:159]
v_mfma_f32_16x16x32_bf16 v[156:159], a[152:155], v[72:75], v[156:159]
v_mfma_f32_16x16x32_bf16 v[156:159], a[156:159], v[76:79], v[156:159]
s_nop 7
v_max3_f32 v127, v127, v156, v157
v_max3_f32 v127, v127, v158, v159
Lsa100:
s_add_u32 s83, s83, 1
s_barrier
s_cmp_lt_u32 s83, s76
s_cbranch_scc1 Lslow1
s_lshl_b32 s81, s59, 20
s_add_u32 s81, s81, s64
s_sub_u32 s81, s81, 0x4000
s_add_u32 m0, s64, 49152
s_add_u32 s72, s81, 16384
buffer_load_dwordx4 v1, s[44:47], s72 offen sc1 lds
buffer_load_dwordx4 v1, s[44:47], s72 offen offset:1024 sc1 lds
buffer_load_dwordx4 v1, s[44:47], s72 offen offset:2048 sc1 lds
buffer_load_dwordx4 v1, s[44:47], s72 offen offset:3072 sc1 lds
s_add_u32 s81, s81, 0x8000
s_add_u32 m0, s64, 81920
s_add_u32 s72, s81, 16384
buffer_load_dwordx4 v1, s[44:47], s72 offen sc1 lds
buffer_load_dwordx4 v1, s[44:47], s72 offen offset:1024 sc1 lds
buffer_load_dwordx4 v1, s[44:47], s72 offen offset:2048 sc1 lds
buffer_load_dwordx4 v1, s[44:47], s72 offen offset:3072 sc1 lds
s_add_u32 m0, s64, 65536
s_add_u32 s72, s81, 0
buffer_load_dwordx4 v1, s[44:47], s72 offen sc1 lds
buffer_load_dwordx4 v1, s[44:47], s72 offen offset:1024 sc1 lds
buffer_load_dwordx4 v1, s[44:47], s72 offen offset:2048 sc1 lds
buffer_load_dwordx4 v1, s[44:47], s72 offen offset:3072 sc1 lds
s_add_u32 s81, s81, 0x8000
s_add_u32 m0, s64, 114688
s_add_u32 s72, s81, 16384
buffer_load_dwordx4 v1, s[44:47], s72 offen sc1 lds
buffer_load_dwordx4 v1, s[44:47], s72 offen offset:1024 sc1 lds
buffer_load_dwordx4 v1, s[44:47], s72 offen offset:2048 sc1 lds
buffer_load_dwordx4 v1, s[44:47], s72 offen offset:3072 sc1 lds
s_add_u32 m0, s64, 98304
s_add_u32 s72, s81, 0
buffer_load_dwordx4 v1, s[44:47], s72 offen sc1 lds
buffer_load_dwordx4 v1, s[44:47], s72 offen offset:1024 sc1 lds
buffer_load_dwordx4 v1, s[44:47], s72 offen offset:2048 sc1 lds
buffer_load_dwordx4 v1, s[44:47], s72 offen offset:3072 sc1 lds
v_add_u32 v2, 0x8000, v1
v_lshrrev_b32 v3, 1, v0
v_lshlrev_b32 v3, 7, v3
s_waitcnt vmcnt(0)
s_barrier
v_accvgpr_write_b32 a32, 0
v_accvgpr_write_b32 a33, 0
v_accvgpr_write_b32 a34, 0
v_accvgpr_write_b32 a35, 0
v_accvgpr_write_b32 a36, 0
v_accvgpr_write_b32 a37, 0
v_accvgpr_write_b32 a38, 0
v_accvgpr_write_b32 a39, 0
v_accvgpr_write_b32 a40, 0
v_accvgpr_write_b32 a41, 0
v_accvgpr_write_b32 a42, 0
v_accvgpr_write_b32 a43, 0
v_accvgpr_write_b32 a44, 0
v_accvgpr_write_b32 a45, 0
v_accvgpr_write_b32 a46, 0
v_accvgpr_write_b32 a47, 0
v_accvgpr_write_b32 a48, 0
v_accvgpr_write_b32 a49, 0
v_accvgpr_write_b32 a50, 0
v_accvgpr_write_b32 a51, 0
v_accvgpr_write_b32 a52, 0
v_accvgpr_write_b32 a53, 0
v_accvgpr_write_b32 a54, 0
v_accvgpr_write_b32 a55, 0
v_accvgpr_write_b32 a56, 0
v_accvgpr_write_b32 a57, 0
v_accvgpr_write_b32 a58, 0
v_accvgpr_write_b32 a59, 0
v_accvgpr_write_b32 a60, 0
v_accvgpr_write_b32 a61, 0
v_accvgpr_write_b32 a62, 0
v_accvgpr_write_b32 a63, 0
v_accvgpr_write_b32 a96, 0
v_accvgpr_write_b32 a97, 0
v_accvgpr_write_b32 a98, 0
v_accvgpr_write_b32 a99, 0
v_accvgpr_write_b32 a100, 0
v_accvgpr_write_b32 a101, 0
v_accvgpr_write_b32 a102, 0
v_accvgpr_write_b32 a103, 0
v_accvgpr_write_b32 a104, 0
v_accvgpr_write_b32 a105, 0
v_accvgpr_write_b32 a106, 0
v_accvgpr_write_b32 a107, 0
v_accvgpr_write_b32 a108, 0
v_accvgpr_write_b32 a109, 0
v_accvgpr_write_b32 a110, 0
v_accvgpr_write_b32 a111, 0
v_accvgpr_write_b32 a112, 0
v_accvgpr_write_b32 a113, 0
v_accvgpr_write_b32 a114, 0
v_accvgpr_write_b32 a115, 0
v_accvgpr_write_b32 a116, 0
v_accvgpr_write_b32 a117, 0
v_accvgpr_write_b32 a118, 0
v_accvgpr_write_b32 a119, 0
v_accvgpr_write_b32 a120, 0
v_accvgpr_write_b32 a121, 0
v_accvgpr_write_b32 a122, 0
v_accvgpr_write_b32 a123, 0
v_accvgpr_write_b32 a124, 0
v_accvgpr_write_b32 a125, 0
v_accvgpr_write_b32 a126, 0
v_accvgpr_write_b32 a127, 0
ds_read_b128 a[128:131], v2 offset:16384
ds_read_b128 a[132:135], v2 offset:17408
ds_read_b128 a[136:139], v2 offset:18432
ds_read_b128 a[140:143], v2 offset:19456
ds_read_b128 a[144:147], v2 offset:20480
ds_read_b128 a[148:151], v2 offset:21504
ds_read_b128 a[152:155], v2 offset:22528
ds_read_b128 a[156:159], v2 offset:23552
s_branch Lattn
Lspin103:
s_mov_b32 s83, 262144
Lsl105:
s_sleep 2
buffer_load_dword v3, v2, s[44:47], s82 offen sc1
s_sub_u32 s83, s83, 1
s_cmp_eq_u32 s83, 0
s_waitcnt vmcnt(0)
s_cbranch_scc1 Lback104
v_cmp_gt_u32 vcc, 2, v3
s_cbranch_vccnz Lsl105
s_branch Lback104
Lspin106:
s_mov_b32 s83, 262144
Lsl108:
s_sleep 2
buffer_load_dword v3, v2, s[44:47], s82 offen sc1
s_sub_u32 s83, s83, 1
s_cmp_eq_u32 s83, 0
s_waitcnt vmcnt(0)
s_cbranch_scc1 Lback107
v_cmp_gt_u32 vcc, 2, v3
s_cbranch_vccnz Lsl108
s_branch Lback107
Lredo0:
s_xor_b32 s82, s78, 0
s_lshl_b32 s82, s82, 10
s_add_u32 s82, s82, s74
buffer_load_dword v3, v2, s[44:47], s82 offen sc1
s_waitcnt vmcnt(0)
v_cmp_gt_u32 vcc, 2, v3
s_cbranch_vccnz Lspin103
Lback104:
s_lshr_b32 s69, s12, 18
s_lshl_b32 s69, s69, 12
s_add_u32 s69, s69, s95
buffer_load_dwordx4 a[0:3], v1, s[44:47], s69 offen sc1
buffer_load_dwordx4 a[4:7], v1, s[44:47], s69 offen offset:1024 sc1
buffer_load_dwordx4 a[8:11], v1, s[44:47], s69 offen offset:2048 sc1
buffer_load_dwordx4 a[12:15], v1, s[44:47], s69 offen offset:3072 sc1
s_add_u32 s69, s69, 0x20000
buffer_load_dwordx4 a[16:19], v1, s[44:47], s69 offen sc1
buffer_load_dwordx4 a[20:23], v1, s[44:47], s69 offen offset:1024 sc1
buffer_load_dwordx4 a[24:27], v1, s[44:47], s69 offen offset:2048 sc1
buffer_load_dwordx4 a[28:31], v1, s[44:47], s69 offen offset:3072 sc1
s_lshr_b32 s69, s13, 18
s_lshl_b32 s69, s69, 12
s_add_u32 s69, s69, s95
buffer_load_dwordx4 a[32:35], v1, s[44:47], s69 offen sc1
buffer_load_dwordx4 a[36:39], v1, s[44:47], s69 offen offset:1024 sc1
buffer_load_dwordx4 a[40:43], v1, s[44:47], s69 offen offset:2048 sc1
buffer_load_dwordx4 a[44:47], v1, s[44:47], s69 offen offset:3072 sc1
s_add_u32 s69, s69, 0x20000
buffer_load_dwordx4 a[48:51], v1, s[44:47], s69 offen sc1
buffer_load_dwordx4 a[52:55], v1, s[44:47], s69 offen offset:1024 sc1
buffer_load_dwordx4 a[56:59], v1, s[44:47], s69 offen offset:2048 sc1
buffer_load_dwordx4 a[60:63], v1, s[44:47], s69 offen offset:3072 sc1
s_waitcnt vmcnt(8)
s_branch Lredo0b
Lspin109:
s_mov_b32 s83, 262144
Lsl111:
s_sleep 2
buffer_load_dword v114, v115, s[44:47], s84 offen sc1
s_sub_u32 s83, s83, 1
s_cmp_eq_u32 s83, 0
s_waitcnt vmcnt(0)
s_cbranch_scc1 Lback110
v_cmp_gt_u32 vcc, 3, v114
s_cbranch_vccnz Lsl111
s_branch Lback110
Lspin112:
s_mov_b32 s83, 262144
Lsl114:
s_sleep 2
buffer_load_dword v14, v13, s[44:47], s79 offen sc1
s_sub_u32 s83, s83, 1
s_cmp_eq_u32 s83, 0
s_waitcnt vmcnt(0)
s_cbranch_scc1 Lback113
v_cmp_gt_u32 vcc, 2, v14
s_cbranch_vccnz Lsl114
s_branch Lback113
Lxspin1:
s_mov_b32 s83, 262144
Lxsl1:
buffer_load_dwordx4 v[96:99], v1, s[44:47], s79 offen sc1
buffer_load_dwordx4 v[100:103], v1, s[44:47], s79 offen offset:1024 sc1
buffer_load_dwordx4 v[104:107], v1, s[44:47], s79 offen offset:2048 sc1
buffer_load_dwordx4 v[108:111], v1, s[44:47], s79 offen offset:3072 sc1
s_sub_u32 s83, s83, 1
s_cmp_eq_u32 s83, 0
s_waitcnt vmcnt(0)
s_cbranch_scc1 Lxback1
v_max3_u32 v12, v96, v97, v98
v_max3_u32 v13, v99, v100, v101
v_max3_u32 v12, v12, v102, v103
v_max3_u32 v13, v13, v104, v105
v_max3_u32 v12, v12, v106, v107
v_max3_u32 v13, v13, v108, v109
v_max3_u32 v12, v12, v110, v111
v_max_u32 v12, v12, v13
v_cmp_le_u32 vcc, 0xff800000, v12
s_cbranch_vccnz Lxsl1
s_branch Lxback1
Lxspin2:
s_mov_b32 s83, 262144
Lxsl2:
buffer_load_dwordx4 v[80:83], v1, s[44:47], s82 offen sc1
buffer_load_dwordx4 v[84:87], v1, s[44:47], s82 offen offset:1024 sc1
buffer_load_dwordx4 v[88:91], v1, s[44:47], s82 offen offset:2048 sc1
buffer_load_dwordx4 v[92:95], v1, s[44:47], s82 offen offset:3072 sc1
s_sub_u32 s83, s83, 1
s_cmp_eq_u32 s83, 0
s_waitcnt vmcnt(0)
s_cbranch_scc1 Lxback2
v_max3_u32 v12, v80, v81, v82
v_max3_u32 v13, v83, v84, v85
v_max3_u32 v12, v12, v86, v87
v_max3_u32 v13, v13, v88, v89
v_max3_u32 v12, v12, v90, v91
v_max3_u32 v13, v13, v92, v93
v_max3_u32 v12, v12, v94, v95
v_max_u32 v12, v12, v13
v_cmp_le_u32 vcc, 0xff800000, v12
s_cbranch_vccnz Lxsl2
s_branch Lxback2
Lxspin3:
s_mov_b32 s83, 262144
Lxsl3:
buffer_load_dwordx4 v[96:99], v1, s[44:47], s81 offen sc1
buffer_load_dwordx4 v[100:103], v1, s[44:47], s81 offen offset:1024 sc1
buffer_load_dwordx4 v[104:107], v1, s[44:47], s81 offen offset:2048 sc1
buffer_load_dwordx4 v[108:111], v1, s[44:47], s81 offen offset:3072 sc1
s_sub_u32 s83, s83, 1
s_cmp_eq_u32 s83, 0
s_waitcnt vmcnt(0)
s_cbranch_scc1 Lxback3
v_max3_u32 v12, v96, v97, v98
v_max3_u32 v13, v99, v100, v101
v_max3_u32 v12, v12, v102, v103
v_max3_u32 v13, v13, v104, v105
v_max3_u32 v12, v12, v106, v107
v_max3_u32 v13, v13, v108, v109
v_max3_u32 v12, v12, v110, v111
v_max_u32 v12, v12, v13
v_cmp_le_u32 vcc, 0xff800000, v12
s_cbranch_vccnz Lxsl3
s_branch Lxback3
Lcode_end:
s_endpgm
.section .rodata,"a"
.p2align 6
.amdhsa_kernel gated_mix__compressed_kv_cla__ssm_conv_h3__prompt_kernel
  .amdhsa_next_free_vgpr 512
  .amdhsa_next_free_sgpr 102
  .amdhsa_accum_offset 256
  .amdhsa_group_segment_fixed_size 0
  .amdhsa_kernarg_size 128
  .amdhsa_user_sgpr_count 2
  .amdhsa_user_sgpr_kernarg_segment_ptr 1
  .amdhsa_system_sgpr_workgroup_id_x 1
  .amdhsa_float_denorm_mode_32 3
.end_amdhsa_kernel
```

```asm
; @launch grid=(256,1,1) block=(256,1,1) lds=163840
.amdgcn_target "amdgcn-amd-amdhsa--gfx950"
.text
.globl gated_mix__compressed_kv_cla__ssm_conv_h3__prompt_kernel
.p2align 8
.type gated_mix__compressed_kv_cla__ssm_conv_h3__prompt_kernel,@function
gated_mix__compressed_kv_cla__ssm_conv_h3__prompt_kernel:
s_cmp_ge_u32 s2, 256
s_cbranch_scc1 Lend
s_load_dwordx2 s[8:9], s[0:1], 8
s_load_dwordx2 s[16:17], s[0:1], 24
s_load_dwordx2 s[20:21], s[0:1], 32
s_getpc_b64 s[98:99]
Lpc0:
s_lshr_b32 s75, s2, 3
v_mul_u32_u24 v26, 18, v0
s_mul_i32 s73, s75, 4608
v_and_b32 v26, 0x1f80, v26
v_add_u32 v26, s73, v26
v_min_u32 v26, Lcode_end-Lpc0, v26
global_load_dword v31, v26, s[98:99]
v_lshrrev_b32 v26, 6, v0
v_and_b32 v0, 63, v0
s_lshr_b32 s65, s75, 3
v_readfirstlane_b32 s58, v26
s_and_b32 s60, s75, 7
s_lshl_b32 s61, s65, 1
s_lshl_b32 s63, s58, 13
s_lshl_b32 s67, s60, 18
s_lshl_b32 s76, s58, 16
s_add_u32 s84, s67, s76
v_lshrrev_b32 v26, 4, v0
v_and_b32 v27, 7, v0
v_xor_b32 v27, v27, v26
v_lshlrev_b32 v27, 4, v27
v_lshrrev_b32 v28, 3, v0
v_lshl_add_u32 v2, v28, 10, v27
v_xor_b32 v3, 64, v2
s_mov_b32 s66, 0
s_mov_b32 s10, 0x200000
s_mov_b32 s11, 0x20000
s_waitcnt lgkmcnt(0)
s_and_b32 s73, s65, 1
s_xor_b32 s73, s73, 0
s_lshl_b32 s69, s73, 7
s_add_u32 s69, s69, s84
s_lshl_b32 s71, s73, 19
s_add_u32 s71, s71, s66
s_add_u32 m0, s63, 65536
s_add_u32 s72, s69, 0
buffer_load_dwordx4 v2, s[8:11], s72 offen lds
s_add_u32 s72, s69, 7168
buffer_load_dwordx4 v3, s[8:11], s72 offen offset:1024 lds
s_add_u32 s72, s69, 14336
buffer_load_dwordx4 v2, s[8:11], s72 offen offset:2048 lds
s_add_u32 s72, s69, 21504
buffer_load_dwordx4 v3, s[8:11], s72 offen offset:3072 lds
s_mov_b32 s18, 0x400000
s_mov_b32 s19, 0x20000
s_mov_b32 s22, 0x400000
s_mov_b32 s23, 0x20000
s_and_b32 s73, s2, 7
s_lshl_b32 s73, s73, 2
s_add_u32 s59, s73, s65
s_lshl_b32 s64, s58, 12
s_lshl_b32 s66, s58, 17
s_lshr_b32 s73, 0x67234501, s73
s_and_b32 s73, s73, 7
s_lshl_b32 s74, s65, 3
s_add_u32 s73, s73, s74
s_lshl_b32 s73, s73, 8
s_add_u32 s66, s66, s73
s_add_u32 s71, s71, s66
v_and_b32 v29, 15, v0
v_lshlrev_b32 v30, 1, v26
v_xor_b32 v30, v30, v29
v_lshlrev_b32 v30, 4, v30
v_lshl_add_u32 v6, v26, 13, v30
v_xor_b32 v7, 0x80, v6
s_add_u32 m0, s64, 0
s_add_u32 s72, s71, 0
buffer_load_dwordx4 v6, s[16:19], s72 offen lds
s_add_u32 s72, s71, 31744
buffer_load_dwordx4 v6, s[16:19], s72 offen offset:1024 lds
s_add_u32 s72, s71, 63488
buffer_load_dwordx4 v7, s[16:19], s72 offen offset:2048 lds
s_add_u32 s72, s71, 95232
buffer_load_dwordx4 v7, s[16:19], s72 offen offset:3072 lds
s_add_u32 m0, s63, 69632
s_add_u32 s72, s69, 32768
buffer_load_dwordx4 v2, s[8:11], s72 offen lds
s_add_u32 s72, s69, 39936
buffer_load_dwordx4 v3, s[8:11], s72 offen offset:1024 lds
s_add_u32 s72, s69, 47104
buffer_load_dwordx4 v2, s[8:11], s72 offen offset:2048 lds
s_add_u32 s72, s69, 54272
buffer_load_dwordx4 v3, s[8:11], s72 offen offset:3072 lds
s_add_u32 m0, s64, 16384
s_add_u32 s72, s71, 0
buffer_load_dwordx4 v6, s[20:23], s72 offen lds
s_add_u32 s72, s71, 31744
buffer_load_dwordx4 v6, s[20:23], s72 offen offset:1024 lds
s_add_u32 s72, s71, 63488
buffer_load_dwordx4 v7, s[20:23], s72 offen offset:2048 lds
s_add_u32 s72, s71, 95232
buffer_load_dwordx4 v7, s[20:23], s72 offen offset:3072 lds
s_load_dwordx2 s[4:5], s[0:1], 0
s_load_dwordx2 s[12:13], s[0:1], 16
s_load_dwordx2 s[24:25], s[0:1], 40
s_load_dwordx2 s[28:29], s[0:1], 56
s_load_dwordx2 s[32:33], s[0:1], 64
s_load_dwordx2 s[52:53], s[0:1], 72
s_load_dwordx2 s[36:37], s[0:1], 80
s_load_dwordx2 s[54:55], s[0:1], 88
s_load_dwordx2 s[56:57], s[0:1], 96
s_load_dwordx2 s[40:41], s[0:1], 104
s_load_dwordx2 s[48:49], s[0:1], 112
s_load_dwordx2 s[44:45], s[0:1], 120
s_lshl_b32 s73, s2, 2
s_add_u32 s73, s73, s58
s_lshl_b32 s73, s73, 11
v_lshrrev_b32 v124, 2, v0
v_lshlrev_b32 v124, 7, v124
v_add_u32 v124, s73, v124
s_lshr_b32 s73, s2, 3
s_lshl_b32 s73, s73, 2
s_add_u32 s73, s73, s58
s_lshl_b32 s73, s73, 13
s_and_b32 s74, s66, 0x700
s_add_u32 s73, s73, s74
v_lshrrev_b32 v125, 4, v0
v_lshlrev_b32 v125, 11, v125
v_bfe_u32 v126, v0, 3, 1
v_lshl_add_u32 v125, v126, 7, v125
v_add_u32 v125, s73, v125
s_mov_b32 s80, 0x0
buffer_load_dword v126, v125, s[16:19], s80 offen
buffer_load_dword v126, v125, s[20:23], s80 offen
buffer_load_dword v126, v124, s[8:11], 0 offen
s_and_b32 s73, s65, 1
s_xor_b32 s73, s73, 1
s_lshl_b32 s69, s73, 7
s_add_u32 s69, s69, s84
s_lshl_b32 s71, s73, 19
s_add_u32 s71, s71, s66
s_add_u32 m0, s63, 98304
s_add_u32 s72, s69, 0
buffer_load_dwordx4 v2, s[8:11], s72 offen lds
s_add_u32 s72, s69, 7168
buffer_load_dwordx4 v3, s[8:11], s72 offen offset:1024 lds
s_add_u32 s72, s69, 14336
buffer_load_dwordx4 v2, s[8:11], s72 offen offset:2048 lds
s_add_u32 s72, s69, 21504
buffer_load_dwordx4 v3, s[8:11], s72 offen offset:3072 lds
s_lshl_b32 s91, s59, 3
s_add_u32 s91, s91, s60
s_lshl_b32 s93, s91, 2
s_add_u32 s93, s93, s58
s_lshl_b32 s75, s93, 1
s_and_b32 s75, s75, 0xffc
s_lshl_b32 s93, s93, 12
s_waitcnt lgkmcnt(0)
s_load_dwordx2 s[88:89], s[36:37], s93
s_load_dword s90, s[54:55], s75
v_lshrrev_b32 v16, 1, v29
v_xor_b32 v16, v16, v26
v_lshlrev_b32 v16, 4, v16
v_lshl_add_u32 v16, v29, 7, v16
s_lshr_b32 s73, s58, 1
s_lshl_b32 s74, s73, 14
s_add_u32 s74, s74, 0x10000
v_add_u32 v24, s74, v16
v_xor_b32 v25, 64, v24
v_lshrrev_b32 v8, 2, v29
v_and_b32 v9, 1, v26
v_lshl_add_u32 v9, v9, 2, v8
v_lshl_add_u32 v8, v26, 3, v8
v_lshlrev_b32 v8, 8, v8
v_lshl_add_u32 v8, v9, 5, v8
v_and_b32 v29, 3, v0
v_lshl_add_u32 v8, v29, 3, v8
s_and_b32 s74, s58, 1
s_lshl_b32 s75, s74, 7
v_xor_b32 v20, s75, v8
v_xor_b32 v21, 32, v20
v_xor_b32 v22, 64, v20
v_xor_b32 v23, 96, v20
s_waitcnt vmcnt(7)
s_barrier
ds_read_b64_tr_b16 v[224:225], v20 offset:0
ds_read_b64_tr_b16 v[226:227], v20 offset:1024
ds_read_b64_tr_b16 v[228:229], v20 offset:8192
ds_read_b64_tr_b16 v[230:231], v20 offset:9216
ds_read_b128 v[128:131], v24 offset:0
ds_read_b128 v[132:135], v25 offset:0
ds_read_b128 v[136:139], v24 offset:2048
ds_read_b128 v[140:143], v25 offset:2048
ds_read_b128 v[144:147], v24 offset:4096
ds_read_b128 v[148:151], v25 offset:4096
ds_read_b128 v[152:155], v24 offset:6144
ds_read_b128 v[156:159], v25 offset:6144
ds_read_b128 v[160:163], v24 offset:8192
ds_read_b128 v[164:167], v25 offset:8192
ds_read_b128 v[168:171], v24 offset:10240
ds_read_b128 v[172:175], v25 offset:10240
ds_read_b128 v[176:179], v24 offset:12288
ds_read_b128 v[180:183], v25 offset:12288
ds_read_b128 v[184:187], v24 offset:14336
ds_read_b128 v[188:191], v25 offset:14336
ds_read_b64_tr_b16 v[232:233], v21 offset:0
ds_read_b64_tr_b16 v[234:235], v21 offset:1024
ds_read_b64_tr_b16 v[236:237], v21 offset:8192
ds_read_b64_tr_b16 v[238:239], v21 offset:9216
s_waitcnt lgkmcnt(0)
v_mfma_f32_16x16x32_bf16 a[0:3], v[224:227], v[128:131], 0
s_add_u32 m0, s64, 32768
ds_read_b64_tr_b16 v[240:241], v22 offset:0
v_mfma_f32_16x16x32_bf16 a[0:3], v[228:231], v[132:135], a[0:3]
s_add_u32 s72, s71, 0
buffer_load_dwordx4 v6, s[16:19], s72 offen lds
v_mfma_f32_16x16x32_bf16 a[4:7], v[228:231], v[140:143], 0
s_add_u32 s72, s71, 31744
buffer_load_dwordx4 v6, s[16:19], s72 offen offset:1024 lds
v_mfma_f32_16x16x32_bf16 a[4:7], v[224:227], v[136:139], a[4:7]
s_mov_b32 s6, 0x400000
ds_read_b64_tr_b16 v[242:243], v22 offset:1024
v_mfma_f32_16x16x32_bf16 a[8:11], v[224:227], v[144:147], 0
s_add_u32 s72, s71, 63488
buffer_load_dwordx4 v7, s[16:19], s72 offen offset:2048 lds
v_mfma_f32_16x16x32_bf16 a[8:11], v[228:231], v[148:151], a[8:11]
s_mov_b32 s7, 0x20000
v_mfma_f32_16x16x32_bf16 a[12:15], v[228:231], v[156:159], 0
s_add_u32 s72, s71, 95232
buffer_load_dwordx4 v7, s[16:19], s72 offen offset:3072 lds
v_mfma_f32_16x16x32_bf16 a[12:15], v[224:227], v[152:155], a[12:15]
s_mov_b32 s14, 0x800000
ds_read_b64_tr_b16 v[244:245], v22 offset:8192
v_mfma_f32_16x16x32_bf16 a[16:19], v[224:227], v[160:163], 0
s_add_u32 m0, s63, 102400
v_mfma_f32_16x16x32_bf16 a[16:19], v[228:231], v[164:167], a[16:19]
s_add_u32 s72, s69, 32768
buffer_load_dwordx4 v2, s[8:11], s72 offen lds
v_mfma_f32_16x16x32_bf16 a[20:23], v[228:231], v[172:175], 0
s_add_u32 s72, s69, 39936
buffer_load_dwordx4 v3, s[8:11], s72 offen offset:1024 lds
v_mfma_f32_16x16x32_bf16 a[20:23], v[224:227], v[168:171], a[20:23]
s_mov_b32 s15, 0x20000
ds_read_b64_tr_b16 v[246:247], v22 offset:9216
v_mfma_f32_16x16x32_bf16 a[24:27], v[224:227], v[176:179], 0
s_add_u32 s72, s69, 47104
buffer_load_dwordx4 v2, s[8:11], s72 offen offset:2048 lds
v_mfma_f32_16x16x32_bf16 a[24:27], v[228:231], v[180:183], a[24:27]
s_mov_b32 s26, 0x800000
v_mfma_f32_16x16x32_bf16 a[28:31], v[228:231], v[188:191], 0
s_add_u32 s72, s69, 54272
buffer_load_dwordx4 v3, s[8:11], s72 offen offset:3072 lds
v_mfma_f32_16x16x32_bf16 a[28:31], v[224:227], v[184:187], a[28:31]
s_mov_b32 s27, 0x20000
v_mfma_f32_16x16x32_bf16 a[60:63], v[232:235], v[184:187], 0
s_add_u32 m0, s64, 49152
ds_read_b64_tr_b16 v[248:249], v23 offset:0
v_mfma_f32_16x16x32_bf16 a[60:63], v[236:239], v[188:191], a[60:63]
s_add_u32 s72, s71, 0
buffer_load_dwordx4 v6, s[20:23], s72 offen lds
v_mfma_f32_16x16x32_bf16 a[56:59], v[236:239], v[180:183], 0
s_add_u32 s72, s71, 31744
buffer_load_dwordx4 v6, s[20:23], s72 offen offset:1024 lds
v_mfma_f32_16x16x32_bf16 a[56:59], v[232:235], v[176:179], a[56:59]
s_mov_b32 s30, 0x400000
v_mfma_f32_16x16x32_bf16 a[52:55], v[232:235], v[168:171], 0
s_add_u32 s72, s71, 63488
buffer_load_dwordx4 v7, s[20:23], s72 offen offset:2048 lds
v_mfma_f32_16x16x32_bf16 a[52:55], v[236:239], v[172:175], a[52:55]
s_mov_b32 s31, 0x20000
ds_read_b64_tr_b16 v[250:251], v23 offset:1024
v_mfma_f32_16x16x32_bf16 a[48:51], v[236:239], v[164:167], 0
s_add_u32 s72, s71, 95232
buffer_load_dwordx4 v7, s[20:23], s72 offen offset:3072 lds
v_mfma_f32_16x16x32_bf16 a[48:51], v[232:235], v[160:163], a[48:51]
s_mov_b32 s80, 0x100000
buffer_load_dword v126, v125, s[16:19], s80 offen
v_mfma_f32_16x16x32_bf16 a[44:47], v[232:235], v[152:155], 0
s_mov_b32 s34, 0x400000
buffer_load_dword v126, v125, s[20:23], s80 offen
v_mfma_f32_16x16x32_bf16 a[44:47], v[236:239], v[156:159], a[44:47]
s_mov_b32 s35, 0x20000
v_mfma_f32_16x16x32_bf16 a[40:43], v[236:239], v[148:151], 0
s_mov_b32 s38, 0x400000
ds_read_b64_tr_b16 v[252:253], v23 offset:8192
v_mfma_f32_16x16x32_bf16 a[40:43], v[232:235], v[144:147], a[40:43]
s_mov_b32 s39, 0x20000
v_mfma_f32_16x16x32_bf16 a[36:39], v[232:235], v[136:139], 0
s_mov_b32 s42, 0x400000
ds_read_b64_tr_b16 v[254:255], v23 offset:9216
v_mfma_f32_16x16x32_bf16 a[36:39], v[236:239], v[140:143], a[36:39]
s_mov_b32 s43, 0x20000
v_mfma_f32_16x16x32_bf16 a[32:35], v[236:239], v[132:135], 0
s_mov_b32 s46, 0x5800000
v_mfma_f32_16x16x32_bf16 a[32:35], v[232:235], v[128:131], a[32:35]
s_waitcnt lgkmcnt(4)
v_mfma_f32_16x16x32_bf16 a[64:67], v[240:243], v[128:131], 0
s_mov_b32 s47, 0x20000
ds_read_b64_tr_b16 v[224:225], v20 offset:16384
v_mfma_f32_16x16x32_bf16 a[64:67], v[244:247], v[132:135], a[64:67]
s_mov_b32 s50, 0x100
v_mfma_f32_16x16x32_bf16 a[68:71], v[244:247], v[140:143], 0
s_mov_b32 s51, 0x20000
v_lshl_add_u32 v4, v28, 11, v27
v_xor_b32 v5, 64, v4
v_mfma_f32_16x16x32_bf16 a[68:71], v[240:243], v[136:139], a[68:71]
ds_read_b64_tr_b16 v[226:227], v20 offset:17408
v_lshlrev_b32 v1, 4, v0
v_mfma_f32_16x16x32_bf16 a[72:75], v[240:243], v[144:147], 0
s_sub_u32 s74, 15, s60
v_mfma_f32_16x16x32_bf16 a[72:75], v[244:247], v[148:151], a[72:75]
s_lshl_b32 s68, s74, 18
v_mfma_f32_16x16x32_bf16 a[76:79], v[244:247], v[156:159], 0
s_lshl_b32 s76, s58, 15
v_mfma_f32_16x16x32_bf16 a[76:79], v[240:243], v[152:155], a[76:79]
s_add_u32 s68, s68, s76
ds_read_b64_tr_b16 v[228:229], v20 offset:24576
v_mfma_f32_16x16x32_bf16 a[80:83], v[240:243], v[160:163], 0
s_add_u32 s67, s67, s76
v_mfma_f32_16x16x32_bf16 a[80:83], v[244:247], v[164:167], a[80:83]
s_and_b32 s62, s60, 3
v_mfma_f32_16x16x32_bf16 a[84:87], v[244:247], v[172:175], 0
s_sub_u32 s62, 16, s62
ds_read_b64_tr_b16 v[230:231], v20 offset:25600
v_mfma_f32_16x16x32_bf16 a[84:87], v[240:243], v[168:171], a[84:87]
s_lshl_b32 s91, s91, 7
v_mfma_f32_16x16x32_bf16 a[88:91], v[240:243], v[176:179], 0
s_add_u32 s91, s91, 0x3810000
v_lshrrev_b32 v34, 3, v0
v_or_b32 v34, s58, v34
v_mfma_f32_16x16x32_bf16 a[88:91], v[244:247], v[180:183], a[88:91]
v_min_u32 v34, 1, v34
v_lshlrev_b32 v34, 28, v34
v_mfma_f32_16x16x32_bf16 a[92:95], v[244:247], v[188:191], 0
v_add_lshl_u32 v34, v34, v0, 2
v_mov_b32 v35, 0
v_mfma_f32_16x16x32_bf16 a[92:95], v[240:243], v[184:187], a[92:95]
s_waitcnt lgkmcnt(4)
buffer_store_dword v35, v34, s[44:47], s91 offen sc1
v_mfma_f32_16x16x32_bf16 a[124:127], v[248:251], v[184:187], 0
s_xor_b32 s83, s2, 5
ds_read_b64_tr_b16 v[232:233], v21 offset:16384
v_mfma_f32_16x16x32_bf16 a[124:127], v[252:255], v[188:191], a[124:127]
s_and_b32 s83, s83, 15
v_mfma_f32_16x16x32_bf16 a[120:123], v[252:255], v[180:183], 0
s_lshr_b32 s74, s2, 4
v_mfma_f32_16x16x32_bf16 a[120:123], v[248:251], v[176:179], a[120:123]
s_lshl_b32 s74, s74, 7
ds_read_b64_tr_b16 v[234:235], v21 offset:17408
v_mfma_f32_16x16x32_bf16 a[116:119], v[248:251], v[168:171], 0
s_lshl_b32 s75, s58, 5
v_mfma_f32_16x16x32_bf16 a[116:119], v[252:255], v[172:175], a[116:119]
s_add_u32 s74, s74, s75
v_mfma_f32_16x16x32_bf16 a[112:115], v[252:255], v[164:167], 0
s_mov_b32 s75, 131072
v_lshrrev_b32 v29, 5, v0
v_lshlrev_b32 v29, 4, v29
v_mfma_f32_16x16x32_bf16 a[112:115], v[248:251], v[160:163], a[112:115]
ds_read_b64_tr_b16 v[236:237], v21 offset:24576
v_add_u32 v29, s74, v29
v_mfma_f32_16x16x32_bf16 a[108:111], v[248:251], v[152:155], 0
v_and_b32 v30, 31, v0
v_mfma_f32_16x16x32_bf16 a[108:111], v[252:255], v[156:159], a[108:111]
s_lshl_b32 s83, s83, 5
v_add_u32 v30, s83, v30
v_lshlrev_b32 v26, 11, v29
v_mfma_f32_16x16x32_bf16 a[104:107], v[252:255], v[148:151], 0
ds_read_b64_tr_b16 v[238:239], v21 offset:25600
v_lshl_add_u32 v26, v30, 2, v26
v_mfma_f32_16x16x32_bf16 a[104:107], v[248:251], v[144:147], a[104:107]
v_subrev_u32 v27, 0x1800, v26
v_mfma_f32_16x16x32_bf16 a[100:103], v[248:251], v[136:139], 0
s_lshl_b32 s82, s74, 11
v_mfma_f32_16x16x32_bf16 a[100:103], v[252:255], v[140:143], a[100:103]
s_lshl_b32 s83, s83, 2
v_mfma_f32_16x16x32_bf16 a[96:99], v[252:255], v[132:135], 0
s_add_u32 s82, s82, s83
v_lshrrev_b32 v26, 3, v0
v_and_b32 v32, 7, v0
v_mfma_f32_16x16x32_bf16 a[96:99], v[248:251], v[128:131], a[96:99]
s_waitcnt lgkmcnt(4)
v_lshlrev_b32 v32, 4, v32
v_lshl_add_u32 v26, v26, 11, v32
v_mfma_f32_16x16x32_bf16 a[128:131], v[128:131], v[224:227], 0
ds_read_b64_tr_b16 v[240:241], v22 offset:16384
v_lshrrev_b32 v98, 5, v0
v_mfma_f32_16x16x32_bf16 a[128:131], v[132:135], v[228:231], a[128:131]
v_lshlrev_b32 v98, 11, v98
v_and_b32 v32, 31, v0
v_mfma_f32_16x16x32_bf16 a[132:135], v[140:143], v[228:231], 0
v_lshl_add_u32 v98, v32, 2, v98
v_add_u32 v98, s63, v98
v_mfma_f32_16x16x32_bf16 a[132:135], v[136:139], v[224:227], a[132:135]
ds_read_b64_tr_b16 v[242:243], v22 offset:17408
v_add_u32 v98, s75, v98
v_mfma_f32_16x16x32_bf16 a[136:139], v[144:147], v[224:227], 0
v_and_b32 v29, 0x7f, v29
v_sub_u32 v29, 0x70, v29
v_mfma_f32_16x16x32_bf16 a[136:139], v[148:151], v[228:231], a[136:139]
v_lshlrev_b32 v29, 1, v29
v_and_b32 v32, 7, v0
v_mfma_f32_16x16x32_bf16 a[140:143], v[156:159], v[228:231], 0
v_mul_u32_u24 v32, 544, v32
v_add3_u32 v28, v32, v29, s75
v_mfma_f32_16x16x32_bf16 a[140:143], v[152:155], v[224:227], a[140:143]
ds_read_b64_tr_b16 v[244:245], v22 offset:24576
v_bfe_u32 v32, v0, 3, 2
v_mfma_f32_16x16x32_bf16 a[144:147], v[160:163], v[224:227], 0
v_lshl_add_u32 v28, v32, 13, v28
v_lshlrev_b32 v30, 4, v30
v_mfma_f32_16x16x32_bf16 a[144:147], v[164:167], v[228:231], a[144:147]
s_lshl_b32 s83, s2, 14
v_mfma_f32_16x16x32_bf16 a[148:151], v[172:175], v[228:231], 0
s_lshl_b32 s74, s58, 12
ds_read_b64_tr_b16 v[246:247], v22 offset:25600
v_mfma_f32_16x16x32_bf16 a[148:151], v[168:171], v[224:227], a[148:151]
s_add_u32 s76, s83, s74
v_mfma_f32_16x16x32_bf16 a[152:155], v[176:179], v[224:227], 0
v_add_u32 v16, s63, v16
v_add_u32 v16, 131072, v16
v_mfma_f32_16x16x32_bf16 a[152:155], v[180:183], v[228:231], a[152:155]
v_xor_b32 v17, 64, v16
v_subrev_u32 v18, 0x10000, v16
v_mfma_f32_16x16x32_bf16 a[156:159], v[188:191], v[228:231], 0
v_subrev_u32 v19, 0x10000, v17
v_xor_b32 v9, 32, v8
v_mfma_f32_16x16x32_bf16 a[156:159], v[184:187], v[224:227], a[156:159]
s_waitcnt lgkmcnt(4)
v_xor_b32 v10, 64, v8
v_xor_b32 v11, 96, v8
v_mfma_f32_16x16x32_bf16 a[188:191], v[184:187], v[232:235], 0
ds_read_b64_tr_b16 v[248:249], v23 offset:16384
v_xor_b32 v12, 128, v8
v_mfma_f32_16x16x32_bf16 a[188:191], v[188:191], v[236:239], a[188:191]
v_xor_b32 v13, 160, v8
v_xor_b32 v14, 192, v8
v_mfma_f32_16x16x32_bf16 a[184:187], v[180:183], v[236:239], 0
ds_read_b64_tr_b16 v[250:251], v23 offset:17408
v_xor_b32 v15, 224, v8
v_mfma_f32_16x16x32_bf16 a[184:187], v[176:179], v[232:235], a[184:187]
s_lshl_b32 s77, s59, 20
v_mfma_f32_16x16x32_bf16 a[180:183], v[168:171], v[232:235], 0
s_add_u32 s81, s77, s64
ds_read_b64_tr_b16 v[252:253], v23 offset:24576
v_mfma_f32_16x16x32_bf16 a[180:183], v[172:175], v[236:239], a[180:183]
s_sub_u32 s81, s81, 0x4000
v_mfma_f32_16x16x32_bf16 a[176:179], v[164:167], v[236:239], 0
s_lshl_b32 s75, s60, 17
ds_read_b64_tr_b16 v[254:255], v23 offset:25600
v_mfma_f32_16x16x32_bf16 a[176:179], v[160:163], v[232:235], a[176:179]
s_add_u32 s77, s77, s75
v_mfma_f32_16x16x32_bf16 a[172:175], v[152:155], v[232:235], 0
s_lshr_b32 s75, s58, 1
v_mfma_f32_16x16x32_bf16 a[172:175], v[156:159], v[236:239], a[172:175]
s_lshl_b32 s75, s75, 16
v_mfma_f32_16x16x32_bf16 a[168:171], v[148:151], v[236:239], 0
s_add_u32 s77, s77, s75
v_mfma_f32_16x16x32_bf16 a[168:171], v[144:147], v[232:235], a[168:171]
s_and_b32 s74, s58, 1
v_mfma_f32_16x16x32_bf16 a[164:167], v[136:139], v[232:235], 0
s_lshl_b32 s75, s74, 12
s_branch Lmain
.p2align 12
Lmain:
v_mfma_f32_16x16x32_bf16 a[164:167], v[140:143], v[236:239], a[164:167]
s_add_u32 s78, s77, s75
v_mfma_f32_16x16x32_bf16 a[160:163], v[132:135], v[236:239], 0
s_waitcnt vmcnt(3) lgkmcnt(0)
v_mfma_f32_16x16x32_bf16 a[160:163], v[128:131], v[232:235], a[160:163]
s_barrier
v_mfma_f32_16x16x32_bf16 a[192:195], v[128:131], v[240:243], 0
s_and_b32 s73, s65, 1
ds_read_b64_tr_b16 v[224:225], v20 offset:32768
v_mfma_f32_16x16x32_bf16 a[192:195], v[132:135], v[244:247], a[192:195]
s_xor_b32 s73, s73, 2
ds_read_b64_tr_b16 v[226:227], v20 offset:33792
v_mfma_f32_16x16x32_bf16 a[196:199], v[140:143], v[244:247], 0
s_lshl_b32 s69, s73, 7
ds_read_b64_tr_b16 v[228:229], v20 offset:40960
v_mfma_f32_16x16x32_bf16 a[196:199], v[136:139], v[240:243], a[196:199]
s_add_u32 s69, s69, s84
ds_read_b64_tr_b16 v[230:231], v20 offset:41984
v_mfma_f32_16x16x32_bf16 a[200:203], v[144:147], v[240:243], 0
s_lshl_b32 s71, s73, 19
ds_read_b128 v[192:195], v24 offset:32768
v_mfma_f32_16x16x32_bf16 a[200:203], v[148:151], v[244:247], a[200:203]
s_add_u32 s71, s71, s66
ds_read_b128 v[196:199], v25 offset:32768
v_mfma_f32_16x16x32_bf16 a[204:207], v[156:159], v[244:247], 0
s_add_u32 m0, s63, 65536
v_mfma_f32_16x16x32_bf16 a[204:207], v[152:155], v[240:243], a[204:207]
s_add_u32 s72, s69, 0
buffer_load_dwordx4 v2, s[8:11], s72 offen lds
v_mfma_f32_16x16x32_bf16 a[208:211], v[160:163], v[240:243], 0
s_add_u32 s72, s69, 7168
buffer_load_dwordx4 v3, s[8:11], s72 offen offset:1024 lds
v_mfma_f32_16x16x32_bf16 a[208:211], v[164:167], v[244:247], a[208:211]
s_add_u32 s72, s69, 14336
buffer_load_dwordx4 v2, s[8:11], s72 offen offset:2048 lds
v_mfma_f32_16x16x32_bf16 a[212:215], v[172:175], v[244:247], 0
s_add_u32 s78, s78, 0x4000
ds_read_b128 v[200:203], v24 offset:34816
v_mfma_f32_16x16x32_bf16 a[212:215], v[168:171], v[240:243], a[212:215]
s_lshl_b32 s75, s74, 11
ds_read_b128 v[204:207], v25 offset:34816
v_mfma_f32_16x16x32_bf16 a[216:219], v[176:179], v[240:243], 0
s_add_u32 s72, s69, 21504
buffer_load_dwordx4 v3, s[8:11], s72 offen offset:3072 lds
v_mfma_f32_16x16x32_bf16 a[216:219], v[180:183], v[244:247], a[216:219]
s_add_u32 s77, s77, s75
ds_read_b128 v[208:211], v24 offset:36864
v_mfma_f32_16x16x32_bf16 a[220:223], v[188:191], v[244:247], 0
s_mov_b32 s79, 0x3e0293ee
ds_read_b128 v[212:215], v25 offset:36864
v_mfma_f32_16x16x32_bf16 a[220:223], v[184:187], v[240:243], a[220:223]
ds_read_b128 v[216:219], v24 offset:38912
v_mfma_f32_16x16x32_bf16 a[252:255], v[184:187], v[248:251], 0
ds_read_b128 v[220:223], v25 offset:38912
v_mfma_f32_16x16x32_bf16 a[252:255], v[188:191], v[252:255], a[252:255]
s_add_u32 m0, s64, 0
v_mfma_f32_16x16x32_bf16 a[248:251], v[180:183], v[252:255], 0
s_add_u32 s72, s71, 0
buffer_load_dwordx4 v6, s[16:19], s72 offen lds
v_mfma_f32_16x16x32_bf16 a[248:251], v[176:179], v[248:251], a[248:251]
ds_read_b128 v[184:187], v24 offset:40960
v_mfma_f32_16x16x32_bf16 a[244:247], v[168:171], v[248:251], 0
ds_read_b128 v[188:191], v25 offset:40960
v_mfma_f32_16x16x32_bf16 a[244:247], v[172:175], v[252:255], a[244:247]
s_add_u32 s72, s71, 31744
buffer_load_dwordx4 v6, s[16:19], s72 offen offset:1024 lds
v_mfma_f32_16x16x32_bf16 a[240:243], v[164:167], v[252:255], 0
ds_read_b128 v[176:179], v24 offset:43008
v_mfma_f32_16x16x32_bf16 a[240:243], v[160:163], v[248:251], a[240:243]
ds_read_b128 v[180:183], v25 offset:43008
v_mfma_f32_16x16x32_bf16 a[236:239], v[152:155], v[248:251], 0
ds_read_b128 v[168:171], v24 offset:45056
v_mfma_f32_16x16x32_bf16 a[236:239], v[156:159], v[252:255], a[236:239]
s_add_u32 s72, s71, 63488
buffer_load_dwordx4 v7, s[16:19], s72 offen offset:2048 lds
v_mfma_f32_16x16x32_bf16 a[232:235], v[148:151], v[252:255], 0
ds_read_b128 v[172:175], v25 offset:45056
v_mfma_f32_16x16x32_bf16 a[232:235], v[144:147], v[248:251], a[232:235]
ds_read_b128 v[160:163], v24 offset:47104
v_mfma_f32_16x16x32_bf16 a[228:231], v[136:139], v[248:251], 0
ds_read_b128 v[164:167], v25 offset:47104
v_mfma_f32_16x16x32_bf16 a[228:231], v[140:143], v[252:255], a[228:231]
v_mfma_f32_16x16x32_bf16 a[224:227], v[132:135], v[252:255], 0
s_add_u32 s72, s71, 95232
buffer_load_dwordx4 v7, s[16:19], s72 offen offset:3072 lds
v_mfma_f32_16x16x32_bf16 a[224:227], v[128:131], v[248:251], a[224:227]
s_waitcnt lgkmcnt(8)
ds_read_b64_tr_b16 v[232:233], v21 offset:32768
v_mfma_f32_16x16x32_bf16 a[0:3], v[224:227], v[192:195], a[0:3]
ds_read_b64_tr_b16 v[234:235], v21 offset:33792
v_mfma_f32_16x16x32_bf16 a[0:3], v[228:231], v[196:199], a[0:3]
ds_read_b64_tr_b16 v[240:241], v22 offset:32768
v_mfma_f32_16x16x32_bf16 a[4:7], v[228:231], v[204:207], a[4:7]
s_add_u32 m0, s63, 69632
ds_read_b64_tr_b16 v[236:237], v21 offset:40960
v_mfma_f32_16x16x32_bf16 a[4:7], v[224:227], v[200:203], a[4:7]
s_add_u32 s72, s69, 32768
buffer_load_dwordx4 v2, s[8:11], s72 offen lds
v_mfma_f32_16x16x32_bf16 a[8:11], v[224:227], v[208:211], a[8:11]
ds_read_b64_tr_b16 v[238:239], v21 offset:41984
v_mfma_f32_16x16x32_bf16 a[8:11], v[228:231], v[212:215], a[8:11]
v_mfma_f32_16x16x32_bf16 a[12:15], v[228:231], v[220:223], a[12:15]
s_add_u32 s72, s69, 39936
buffer_load_dwordx4 v3, s[8:11], s72 offen offset:1024 lds
v_mfma_f32_16x16x32_bf16 a[12:15], v[224:227], v[216:219], a[12:15]
s_waitcnt lgkmcnt(5)
ds_read_b64_tr_b16 v[242:243], v22 offset:33792
v_mfma_f32_16x16x32_bf16 a[16:19], v[224:227], v[184:187], a[16:19]
v_mfma_f32_16x16x32_bf16 a[16:19], v[228:231], v[188:191], a[16:19]
ds_read_b64_tr_b16 v[244:245], v22 offset:40960
v_mfma_f32_16x16x32_bf16 a[20:23], v[228:231], v[180:183], a[20:23]
v_mfma_f32_16x16x32_bf16 a[20:23], v[224:227], v[176:179], a[20:23]
s_add_u32 s72, s69, 47104
buffer_load_dwordx4 v2, s[8:11], s72 offen offset:2048 lds
v_mfma_f32_16x16x32_bf16 a[24:27], v[224:227], v[168:171], a[24:27]
ds_read_b64_tr_b16 v[246:247], v22 offset:41984
v_mfma_f32_16x16x32_bf16 a[24:27], v[228:231], v[172:175], a[24:27]
v_mfma_f32_16x16x32_bf16 a[28:31], v[228:231], v[164:167], a[28:31]
v_mfma_f32_16x16x32_bf16 a[28:31], v[224:227], v[160:163], a[28:31]
s_waitcnt lgkmcnt(3)
v_mfma_f32_16x16x32_bf16 a[60:63], v[232:235], v[160:163], a[60:63]
s_add_u32 s72, s69, 54272
buffer_load_dwordx4 v3, s[8:11], s72 offen offset:3072 lds
v_mfma_f32_16x16x32_bf16 a[60:63], v[236:239], v[164:167], a[60:63]
ds_read_b64_tr_b16 v[248:249], v23 offset:32768
v_mfma_f32_16x16x32_bf16 a[56:59], v[236:239], v[172:175], a[56:59]
v_mfma_f32_16x16x32_bf16 a[56:59], v[232:235], v[168:171], a[56:59]
s_add_u32 m0, s64, 16384
ds_read_b64_tr_b16 v[250:251], v23 offset:33792
v_mfma_f32_16x16x32_bf16 a[52:55], v[232:235], v[176:179], a[52:55]
s_add_u32 s72, s71, 0
buffer_load_dwordx4 v6, s[20:23], s72 offen lds
v_mfma_f32_16x16x32_bf16 a[52:55], v[236:239], v[180:183], a[52:55]
v_mfma_f32_16x16x32_bf16 a[48:51], v[236:239], v[188:191], a[48:51]
v_mfma_f32_16x16x32_bf16 a[48:51], v[232:235], v[184:187], a[48:51]
ds_read_b64_tr_b16 v[252:253], v23 offset:40960
v_mfma_f32_16x16x32_bf16 a[44:47], v[232:235], v[216:219], a[44:47]
s_add_u32 s72, s71, 31744
buffer_load_dwordx4 v6, s[20:23], s72 offen offset:1024 lds
v_mfma_f32_16x16x32_bf16 a[44:47], v[236:239], v[220:223], a[44:47]
v_mfma_f32_16x16x32_bf16 a[40:43], v[236:239], v[212:215], a[40:43]
ds_read_b64_tr_b16 v[254:255], v23 offset:41984
v_mfma_f32_16x16x32_bf16 a[40:43], v[232:235], v[208:211], a[40:43]
v_mfma_f32_16x16x32_bf16 a[36:39], v[232:235], v[200:203], a[36:39]
s_add_u32 s72, s71, 63488
buffer_load_dwordx4 v7, s[20:23], s72 offen offset:2048 lds
v_mfma_f32_16x16x32_bf16 a[36:39], v[236:239], v[204:207], a[36:39]
v_mfma_f32_16x16x32_bf16 a[32:35], v[236:239], v[196:199], a[32:35]
v_mfma_f32_16x16x32_bf16 a[32:35], v[232:235], v[192:195], a[32:35]
s_waitcnt lgkmcnt(4)
v_mfma_f32_16x16x32_bf16 a[64:67], v[240:243], v[192:195], a[64:67]
s_add_u32 s72, s71, 95232
buffer_load_dwordx4 v7, s[20:23], s72 offen offset:3072 lds
v_mfma_f32_16x16x32_bf16 a[64:67], v[244:247], v[196:199], a[64:67]
s_mov_b32 s80, 0x200000
buffer_load_dword v126, v125, s[16:19], s80 offen
v_mfma_f32_16x16x32_bf16 a[68:71], v[244:247], v[204:207], a[68:71]
buffer_load_dword v126, v125, s[20:23], s80 offen
v_mfma_f32_16x16x32_bf16 a[68:71], v[240:243], v[200:203], a[68:71]
global_load_dwordx4 v[68:71], v30, s[52:53]
v_mfma_f32_16x16x32_bf16 a[72:75], v[240:243], v[208:211], a[72:75]
buffer_load_dword v33, v27, s[28:31], 0 offen nt
v_mfma_f32_16x16x32_bf16 a[72:75], v[244:247], v[212:215], a[72:75]
buffer_load_dword v34, v27, s[28:31], 0 offen offset:2048 nt
v_mfma_f32_16x16x32_bf16 a[76:79], v[244:247], v[220:223], a[76:79]
v_add_u32 v27, 0x1000, v27
v_mfma_f32_16x16x32_bf16 a[76:79], v[240:243], v[216:219], a[76:79]
buffer_load_dword v35, v27, s[28:31], 0 offen nt
v_mfma_f32_16x16x32_bf16 a[80:83], v[240:243], v[184:187], a[80:83]
s_add_u32 m0, s63, 131072
ds_read_b64_tr_b16 v[224:225], v20 offset:49152
ds_read_b64_tr_b16 v[226:227], v20 offset:50176
v_mfma_f32_16x16x32_bf16 a[80:83], v[244:247], v[188:191], a[80:83]
s_add_u32 s80, s82, 0
buffer_load_dwordx4 v26, s[28:31], s80 offen nt lds
v_mfma_f32_16x16x32_bf16 a[84:87], v[244:247], v[180:183], a[84:87]
s_add_u32 s80, s82, 15360
buffer_load_dwordx4 v26, s[28:31], s80 offen offset:1024 nt lds
v_mfma_f32_16x16x32_bf16 a[84:87], v[240:243], v[176:179], a[84:87]
s_add_u32 s80, s82, 30720
buffer_load_dwordx4 v26, s[28:31], s80 offen offset:2048 nt lds
v_mfma_f32_16x16x32_bf16 a[88:91], v[240:243], v[168:171], a[88:91]
s_add_u32 s80, s82, 46080
buffer_load_dwordx4 v26, s[28:31], s80 offen offset:3072 nt lds
v_mfma_f32_16x16x32_bf16 a[88:91], v[244:247], v[172:175], a[88:91]
ds_read_b64_tr_b16 v[228:229], v20 offset:57344
ds_read_b64_tr_b16 v[230:231], v20 offset:58368
v_mfma_f32_16x16x32_bf16 a[92:95], v[244:247], v[164:167], a[92:95]
v_mfma_f32_16x16x32_bf16 a[92:95], v[240:243], v[160:163], a[92:95]
s_waitcnt lgkmcnt(4)
v_mfma_f32_16x16x32_bf16 a[124:127], v[248:251], v[160:163], a[124:127]
ds_read_b64_tr_b16 v[232:233], v21 offset:49152
v_mfma_f32_16x16x32_bf16 a[124:127], v[252:255], v[164:167], a[124:127]
v_mfma_f32_16x16x32_bf16 a[120:123], v[252:255], v[172:175], a[120:123]
v_mfma_f32_16x16x32_bf16 a[120:123], v[248:251], v[168:171], a[120:123]
ds_read_b64_tr_b16 v[234:235], v21 offset:50176
v_mfma_f32_16x16x32_bf16 a[116:119], v[248:251], v[176:179], a[116:119]
v_mfma_f32_16x16x32_bf16 a[116:119], v[252:255], v[180:183], a[116:119]
v_mfma_f32_16x16x32_bf16 a[112:115], v[252:255], v[188:191], a[112:115]
v_mfma_f32_16x16x32_bf16 a[112:115], v[248:251], v[184:187], a[112:115]
ds_read_b64_tr_b16 v[236:237], v21 offset:57344
v_mfma_f32_16x16x32_bf16 a[108:111], v[248:251], v[216:219], a[108:111]
v_mfma_f32_16x16x32_bf16 a[108:111], v[252:255], v[220:223], a[108:111]
v_mfma_f32_16x16x32_bf16 a[104:107], v[252:255], v[212:215], a[104:107]
ds_read_b64_tr_b16 v[238:239], v21 offset:58368
v_mfma_f32_16x16x32_bf16 a[104:107], v[248:251], v[208:211], a[104:107]
v_mfma_f32_16x16x32_bf16 a[100:103], v[248:251], v[200:203], a[100:103]
v_mfma_f32_16x16x32_bf16 a[100:103], v[252:255], v[204:207], a[100:103]
v_mfma_f32_16x16x32_bf16 a[96:99], v[252:255], v[196:199], a[96:99]
v_mfma_f32_16x16x32_bf16 a[96:99], v[248:251], v[192:195], a[96:99]
s_waitcnt lgkmcnt(4)
v_mfma_f32_16x16x32_bf16 a[128:131], v[192:195], v[224:227], a[128:131]
ds_read_b64_tr_b16 v[240:241], v22 offset:49152
v_mfma_f32_16x16x32_bf16 a[128:131], v[196:199], v[228:231], a[128:131]
v_mfma_f32_16x16x32_bf16 a[132:135], v[204:207], v[228:231], a[132:135]
v_mfma_f32_16x16x32_bf16 a[132:135], v[200:203], v[224:227], a[132:135]
ds_read_b64_tr_b16 v[242:243], v22 offset:50176
v_mfma_f32_16x16x32_bf16 a[136:139], v[208:211], v[224:227], a[136:139]
v_mfma_f32_16x16x32_bf16 a[136:139], v[212:215], v[228:231], a[136:139]
v_mfma_f32_16x16x32_bf16 a[140:143], v[220:223], v[228:231], a[140:143]
v_mfma_f32_16x16x32_bf16 a[140:143], v[216:219], v[224:227], a[140:143]
ds_read_b64_tr_b16 v[244:245], v22 offset:57344
v_mfma_f32_16x16x32_bf16 a[144:147], v[184:187], v[224:227], a[144:147]
v_mfma_f32_16x16x32_bf16 a[144:147], v[188:191], v[228:231], a[144:147]
v_mfma_f32_16x16x32_bf16 a[148:151], v[180:183], v[228:231], a[148:151]
ds_read_b64_tr_b16 v[246:247], v22 offset:58368
v_mfma_f32_16x16x32_bf16 a[148:151], v[176:179], v[224:227], a[148:151]
v_mfma_f32_16x16x32_bf16 a[152:155], v[168:171], v[224:227], a[152:155]
v_mfma_f32_16x16x32_bf16 a[152:155], v[172:175], v[228:231], a[152:155]
v_mfma_f32_16x16x32_bf16 a[156:159], v[164:167], v[228:231], a[156:159]
v_mfma_f32_16x16x32_bf16 a[156:159], v[160:163], v[224:227], a[156:159]
s_waitcnt lgkmcnt(4)
v_mfma_f32_16x16x32_bf16 a[188:191], v[160:163], v[232:235], a[188:191]
ds_read_b64_tr_b16 v[248:249], v23 offset:49152
v_mfma_f32_16x16x32_bf16 a[188:191], v[164:167], v[236:239], a[188:191]
v_mfma_f32_16x16x32_bf16 a[184:187], v[172:175], v[236:239], a[184:187]
ds_read_b64_tr_b16 v[250:251], v23 offset:50176
v_mfma_f32_16x16x32_bf16 a[184:187], v[168:171], v[232:235], a[184:187]
v_mfma_f32_16x16x32_bf16 a[180:183], v[176:179], v[232:235], a[180:183]
ds_read_b64_tr_b16 v[252:253], v23 offset:57344
v_mfma_f32_16x16x32_bf16 a[180:183], v[180:183], v[236:239], a[180:183]
v_mfma_f32_16x16x32_bf16 a[176:179], v[188:191], v[236:239], a[176:179]
ds_read_b64_tr_b16 v[254:255], v23 offset:58368
v_mfma_f32_16x16x32_bf16 a[176:179], v[184:187], v[232:235], a[176:179]
v_mfma_f32_16x16x32_bf16 a[172:175], v[216:219], v[232:235], a[172:175]
v_mfma_f32_16x16x32_bf16 a[172:175], v[220:223], v[236:239], a[172:175]
v_mfma_f32_16x16x32_bf16 a[168:171], v[212:215], v[236:239], a[168:171]
v_mfma_f32_16x16x32_bf16 a[168:171], v[208:211], v[232:235], a[168:171]
v_mfma_f32_16x16x32_bf16 a[164:167], v[200:203], v[232:235], a[164:167]
v_mfma_f32_16x16x32_bf16 a[164:167], v[204:207], v[236:239], a[164:167]
v_mfma_f32_16x16x32_bf16 a[160:163], v[196:199], v[236:239], a[160:163]
s_waitcnt vmcnt(10) lgkmcnt(0)
v_mfma_f32_16x16x32_bf16 a[160:163], v[192:195], v[232:235], a[160:163]
s_barrier
v_mfma_f32_16x16x32_bf16 a[192:195], v[192:195], v[240:243], a[192:195]
s_and_b32 s73, s65, 1
ds_read_b64_tr_b16 v[224:225], v20 offset:0
v_mfma_f32_16x16x32_bf16 a[192:195], v[196:199], v[244:247], a[192:195]
s_xor_b32 s73, s73, 3
ds_read_b64_tr_b16 v[226:227], v20 offset:1024
v_mfma_f32_16x16x32_bf16 a[196:199], v[204:207], v[244:247], a[196:199]
s_lshl_b32 s69, s73, 7
ds_read_b64_tr_b16 v[228:229], v20 offset:8192
v_mfma_f32_16x16x32_bf16 a[196:199], v[200:203], v[240:243], a[196:199]
s_add_u32 s69, s69, s84
ds_read_b64_tr_b16 v[230:231], v20 offset:9216
v_mfma_f32_16x16x32_bf16 a[200:203], v[208:211], v[240:243], a[200:203]
s_lshl_b32 s71, s73, 19
ds_read_b128 v[128:131], v24 offset:0
v_mfma_f32_16x16x32_bf16 a[200:203], v[212:215], v[244:247], a[200:203]
s_add_u32 s71, s71, s66
ds_read_b128 v[132:135], v25 offset:0
v_mfma_f32_16x16x32_bf16 a[204:207], v[220:223], v[244:247], a[204:207]
s_add_u32 m0, s63, 98304
v_mfma_f32_16x16x32_bf16 a[204:207], v[216:219], v[240:243], a[204:207]
s_add_u32 s72, s69, 0
buffer_load_dwordx4 v2, s[8:11], s72 offen lds
v_mfma_f32_16x16x32_bf16 a[208:211], v[184:187], v[240:243], a[208:211]
s_add_u32 s72, s69, 7168
buffer_load_dwordx4 v3, s[8:11], s72 offen offset:1024 lds
v_mfma_f32_16x16x32_bf16 a[208:211], v[188:191], v[244:247], a[208:211]
s_add_u32 s72, s69, 14336
buffer_load_dwordx4 v2, s[8:11], s72 offen offset:2048 lds
v_mfma_f32_16x16x32_bf16 a[212:215], v[180:183], v[244:247], a[212:215]
ds_read_b128 v[136:139], v24 offset:2048
v_mfma_f32_16x16x32_bf16 a[212:215], v[176:179], v[240:243], a[212:215]
ds_read_b128 v[140:143], v25 offset:2048
v_mfma_f32_16x16x32_bf16 a[216:219], v[168:171], v[240:243], a[216:219]
s_add_u32 s72, s69, 21504
buffer_load_dwordx4 v3, s[8:11], s72 offen offset:3072 lds
v_mfma_f32_16x16x32_bf16 a[216:219], v[172:175], v[244:247], a[216:219]
ds_read_b128 v[144:147], v24 offset:4096
v_mfma_f32_16x16x32_bf16 a[220:223], v[164:167], v[244:247], a[220:223]
ds_read_b128 v[148:151], v25 offset:4096
v_mfma_f32_16x16x32_bf16 a[220:223], v[160:163], v[240:243], a[220:223]
ds_read_b128 v[152:155], v24 offset:6144
v_mfma_f32_16x16x32_bf16 a[252:255], v[160:163], v[248:251], a[252:255]
ds_read_b128 v[156:159], v25 offset:6144
v_mfma_f32_16x16x32_bf16 a[252:255], v[164:167], v[252:255], a[252:255]
s_add_u32 m0, s64, 32768
v_mfma_f32_16x16x32_bf16 a[248:251], v[172:175], v[252:255], a[248:251]
s_add_u32 s72, s71, 0
buffer_load_dwordx4 v6, s[16:19], s72 offen lds
v_mfma_f32_16x16x32_bf16 a[248:251], v[168:171], v[248:251], a[248:251]
ds_read_b128 v[160:163], v24 offset:8192
v_mfma_f32_16x16x32_bf16 a[244:247], v[176:179], v[248:251], a[244:247]
ds_read_b128 v[164:167], v25 offset:8192
v_mfma_f32_16x16x32_bf16 a[244:247], v[180:183], v[252:255], a[244:247]
s_add_u32 s72, s71, 31744
buffer_load_dwordx4 v6, s[16:19], s72 offen offset:1024 lds
v_mfma_f32_16x16x32_bf16 a[240:243], v[188:191], v[252:255], a[240:243]
ds_read_b128 v[168:171], v24 offset:10240
v_mfma_f32_16x16x32_bf16 a[240:243], v[184:187], v[248:251], a[240:243]
ds_read_b128 v[172:175], v25 offset:10240
v_mfma_f32_16x16x32_bf16 a[236:239], v[216:219], v[248:251], a[236:239]
ds_read_b128 v[176:179], v24 offset:12288
v_mfma_f32_16x16x32_bf16 a[236:239], v[220:223], v[252:255], a[236:239]
s_add_u32 s72, s71, 63488
buffer_load_dwordx4 v7, s[16:19], s72 offen offset:2048 lds
v_mfma_f32_16x16x32_bf16 a[232:235], v[212:215], v[252:255], a[232:235]
ds_read_b128 v[180:183], v25 offset:12288
v_mfma_f32_16x16x32_bf16 a[232:235], v[208:211], v[248:251], a[232:235]
ds_read_b128 v[184:187], v24 offset:14336
v_mfma_f32_16x16x32_bf16 a[228:231], v[200:203], v[248:251], a[228:231]
ds_read_b128 v[188:191], v25 offset:14336
v_mfma_f32_16x16x32_bf16 a[228:231], v[204:207], v[252:255], a[228:231]
v_mfma_f32_16x16x32_bf16 a[224:227], v[196:199], v[252:255], a[224:227]
s_add_u32 s72, s71, 95232
buffer_load_dwordx4 v7, s[16:19], s72 offen offset:3072 lds
v_mfma_f32_16x16x32_bf16 a[224:227], v[192:195], v[248:251], a[224:227]
s_waitcnt lgkmcnt(8)
ds_read_b64_tr_b16 v[232:233], v21 offset:0
v_mfma_f32_16x16x32_bf16 a[0:3], v[224:227], v[128:131], a[0:3]
ds_read_b64_tr_b16 v[234:235], v21 offset:1024
v_mfma_f32_16x16x32_bf16 a[0:3], v[228:231], v[132:135], a[0:3]
ds_read_b64_tr_b16 v[240:241], v22 offset:0
v_mfma_f32_16x16x32_bf16 a[4:7], v[228:231], v[140:143], a[4:7]
s_add_u32 m0, s63, 102400
ds_read_b64_tr_b16 v[236:237], v21 offset:8192
v_mfma_f32_16x16x32_bf16 a[4:7], v[224:227], v[136:139], a[4:7]
s_add_u32 s72, s69, 32768
buffer_load_dwordx4 v2, s[8:11], s72 offen lds
v_mfma_f32_16x16x32_bf16 a[8:11], v[224:227], v[144:147], a[8:11]
ds_read_b64_tr_b16 v[238:239], v21 offset:9216
v_mfma_f32_16x16x32_bf16 a[8:11], v[228:231], v[148:151], a[8:11]
v_mfma_f32_16x16x32_bf16 a[12:15], v[228:231], v[156:159], a[12:15]
s_add_u32 s72, s69, 39936
buffer_load_dwordx4 v3, s[8:11], s72 offen offset:1024 lds
v_mfma_f32_16x16x32_bf16 a[12:15], v[224:227], v[152:155], a[12:15]
s_waitcnt lgkmcnt(5)
ds_read_b64_tr_b16 v[242:243], v22 offset:1024
v_mfma_f32_16x16x32_bf16 a[16:19], v[224:227], v[160:163], a[16:19]
v_mfma_f32_16x16x32_bf16 a[16:19], v[228:231], v[164:167], a[16:19]
ds_read_b64_tr_b16 v[244:245], v22 offset:8192
v_mfma_f32_16x16x32_bf16 a[20:23], v[228:231], v[172:175], a[20:23]
v_mfma_f32_16x16x32_bf16 a[20:23], v[224:227], v[168:171], a[20:23]
s_add_u32 s72, s69, 47104
buffer_load_dwordx4 v2, s[8:11], s72 offen offset:2048 lds
v_mfma_f32_16x16x32_bf16 a[24:27], v[224:227], v[176:179], a[24:27]
ds_read_b64_tr_b16 v[246:247], v22 offset:9216
v_mfma_f32_16x16x32_bf16 a[24:27], v[228:231], v[180:183], a[24:27]
v_mfma_f32_16x16x32_bf16 a[28:31], v[228:231], v[188:191], a[28:31]
v_mfma_f32_16x16x32_bf16 a[28:31], v[224:227], v[184:187], a[28:31]
s_waitcnt lgkmcnt(3)
v_mfma_f32_16x16x32_bf16 a[60:63], v[232:235], v[184:187], a[60:63]
s_add_u32 s72, s69, 54272
buffer_load_dwordx4 v3, s[8:11], s72 offen offset:3072 lds
v_mfma_f32_16x16x32_bf16 a[60:63], v[236:239], v[188:191], a[60:63]
ds_read_b64_tr_b16 v[248:249], v23 offset:0
v_mfma_f32_16x16x32_bf16 a[56:59], v[236:239], v[180:183], a[56:59]
v_mfma_f32_16x16x32_bf16 a[56:59], v[232:235], v[176:179], a[56:59]
s_add_u32 m0, s64, 49152
ds_read_b64_tr_b16 v[250:251], v23 offset:1024
v_mfma_f32_16x16x32_bf16 a[52:55], v[232:235], v[168:171], a[52:55]
s_add_u32 s72, s71, 0
buffer_load_dwordx4 v6, s[20:23], s72 offen lds
v_mfma_f32_16x16x32_bf16 a[52:55], v[236:239], v[172:175], a[52:55]
v_mfma_f32_16x16x32_bf16 a[48:51], v[236:239], v[164:167], a[48:51]
v_mfma_f32_16x16x32_bf16 a[48:51], v[232:235], v[160:163], a[48:51]
ds_read_b64_tr_b16 v[252:253], v23 offset:8192
v_mfma_f32_16x16x32_bf16 a[44:47], v[232:235], v[152:155], a[44:47]
s_add_u32 s72, s71, 31744
buffer_load_dwordx4 v6, s[20:23], s72 offen offset:1024 lds
v_mfma_f32_16x16x32_bf16 a[44:47], v[236:239], v[156:159], a[44:47]
v_mfma_f32_16x16x32_bf16 a[40:43], v[236:239], v[148:151], a[40:43]
ds_read_b64_tr_b16 v[254:255], v23 offset:9216
v_mfma_f32_16x16x32_bf16 a[40:43], v[232:235], v[144:147], a[40:43]
v_mfma_f32_16x16x32_bf16 a[36:39], v[232:235], v[136:139], a[36:39]
s_add_u32 s72, s71, 63488
buffer_load_dwordx4 v7, s[20:23], s72 offen offset:2048 lds
v_mfma_f32_16x16x32_bf16 a[36:39], v[236:239], v[140:143], a[36:39]
v_mfma_f32_16x16x32_bf16 a[32:35], v[236:239], v[132:135], a[32:35]
v_mfma_f32_16x16x32_bf16 a[32:35], v[232:235], v[128:131], a[32:35]
s_waitcnt lgkmcnt(4)
v_mfma_f32_16x16x32_bf16 a[64:67], v[240:243], v[128:131], a[64:67]
s_add_u32 s72, s71, 95232
buffer_load_dwordx4 v7, s[20:23], s72 offen offset:3072 lds
v_mfma_f32_16x16x32_bf16 a[64:67], v[244:247], v[132:135], a[64:67]
s_mov_b32 s80, 0x300000
buffer_load_dword v126, v125, s[16:19], s80 offen
v_mfma_f32_16x16x32_bf16 a[68:71], v[244:247], v[140:143], a[68:71]
buffer_load_dword v126, v125, s[20:23], s80 offen
v_mfma_f32_16x16x32_bf16 a[68:71], v[240:243], v[136:139], a[68:71]
s_add_u32 m0, s63, 135168
ds_read_b64_tr_b16 v[224:225], v20 offset:16384
v_mfma_f32_16x16x32_bf16 a[72:75], v[240:243], v[144:147], a[72:75]
s_add_u32 s80, s82, 0
buffer_load_dwordx4 v26, s[32:35], s80 offen nt lds
v_mfma_f32_16x16x32_bf16 a[72:75], v[244:247], v[148:151], a[72:75]
s_add_u32 s80, s82, 15360
buffer_load_dwordx4 v26, s[32:35], s80 offen offset:1024 nt lds
v_mfma_f32_16x16x32_bf16 a[76:79], v[244:247], v[156:159], a[76:79]
s_add_u32 s80, s82, 30720
buffer_load_dwordx4 v26, s[32:35], s80 offen offset:2048 nt lds
v_mfma_f32_16x16x32_bf16 a[76:79], v[240:243], v[152:155], a[76:79]
s_add_u32 s80, s82, 46080
buffer_load_dwordx4 v26, s[32:35], s80 offen offset:3072 nt lds
v_mfma_f32_16x16x32_bf16 a[80:83], v[240:243], v[160:163], a[80:83]
ds_read_b64_tr_b16 v[226:227], v20 offset:17408
v_mfma_f32_16x16x32_bf16 a[80:83], v[244:247], v[164:167], a[80:83]
v_mfma_f32_16x16x32_bf16 a[84:87], v[244:247], v[172:175], a[84:87]
ds_read_b64_tr_b16 v[228:229], v20 offset:24576
v_mfma_f32_16x16x32_bf16 a[84:87], v[240:243], v[168:171], a[84:87]
v_mfma_f32_16x16x32_bf16 a[88:91], v[240:243], v[176:179], a[88:91]
ds_read_b64_tr_b16 v[230:231], v20 offset:25600
v_mfma_f32_16x16x32_bf16 a[88:91], v[244:247], v[180:183], a[88:91]
v_mfma_f32_16x16x32_bf16 a[92:95], v[244:247], v[188:191], a[92:95]
v_mfma_f32_16x16x32_bf16 a[92:95], v[240:243], v[184:187], a[92:95]
s_waitcnt lgkmcnt(4)
v_mfma_f32_16x16x32_bf16 a[124:127], v[248:251], v[184:187], a[124:127]
ds_read_b64_tr_b16 v[232:233], v21 offset:16384
v_mfma_f32_16x16x32_bf16 a[124:127], v[252:255], v[188:191], a[124:127]
v_mfma_f32_16x16x32_bf16 a[120:123], v[252:255], v[180:183], a[120:123]
v_mfma_f32_16x16x32_bf16 a[120:123], v[248:251], v[176:179], a[120:123]
ds_read_b64_tr_b16 v[234:235], v21 offset:17408
v_mfma_f32_16x16x32_bf16 a[116:119], v[248:251], v[168:171], a[116:119]
v_mfma_f32_16x16x32_bf16 a[116:119], v[252:255], v[172:175], a[116:119]
v_mfma_f32_16x16x32_bf16 a[112:115], v[252:255], v[164:167], a[112:115]
v_mfma_f32_16x16x32_bf16 a[112:115], v[248:251], v[160:163], a[112:115]
ds_read_b64_tr_b16 v[236:237], v21 offset:24576
v_mfma_f32_16x16x32_bf16 a[108:111], v[248:251], v[152:155], a[108:111]
v_mfma_f32_16x16x32_bf16 a[108:111], v[252:255], v[156:159], a[108:111]
v_mfma_f32_16x16x32_bf16 a[104:107], v[252:255], v[148:151], a[104:107]
ds_read_b64_tr_b16 v[238:239], v21 offset:25600
v_mfma_f32_16x16x32_bf16 a[104:107], v[248:251], v[144:147], a[104:107]
v_mfma_f32_16x16x32_bf16 a[100:103], v[248:251], v[136:139], a[100:103]
v_mfma_f32_16x16x32_bf16 a[100:103], v[252:255], v[140:143], a[100:103]
v_mfma_f32_16x16x32_bf16 a[96:99], v[252:255], v[132:135], a[96:99]
v_mfma_f32_16x16x32_bf16 a[96:99], v[248:251], v[128:131], a[96:99]
s_waitcnt lgkmcnt(4)
v_mfma_f32_16x16x32_bf16 a[128:131], v[128:131], v[224:227], a[128:131]
ds_read_b64_tr_b16 v[240:241], v22 offset:16384
v_mfma_f32_16x16x32_bf16 a[128:131], v[132:135], v[228:231], a[128:131]
v_mfma_f32_16x16x32_bf16 a[132:135], v[140:143], v[228:231], a[132:135]
v_mfma_f32_16x16x32_bf16 a[132:135], v[136:139], v[224:227], a[132:135]
ds_read_b64_tr_b16 v[242:243], v22 offset:17408
v_mfma_f32_16x16x32_bf16 a[136:139], v[144:147], v[224:227], a[136:139]
v_mfma_f32_16x16x32_bf16 a[136:139], v[148:151], v[228:231], a[136:139]
v_mfma_f32_16x16x32_bf16 a[140:143], v[156:159], v[228:231], a[140:143]
v_mfma_f32_16x16x32_bf16 a[140:143], v[152:155], v[224:227], a[140:143]
ds_read_b64_tr_b16 v[244:245], v22 offset:24576
v_mfma_f32_16x16x32_bf16 a[144:147], v[160:163], v[224:227], a[144:147]
v_mfma_f32_16x16x32_bf16 a[144:147], v[164:167], v[228:231], a[144:147]
v_mfma_f32_16x16x32_bf16 a[148:151], v[172:175], v[228:231], a[148:151]
ds_read_b64_tr_b16 v[246:247], v22 offset:25600
v_mfma_f32_16x16x32_bf16 a[148:151], v[168:171], v[224:227], a[148:151]
v_mfma_f32_16x16x32_bf16 a[152:155], v[176:179], v[224:227], a[152:155]
v_mfma_f32_16x16x32_bf16 a[152:155], v[180:183], v[228:231], a[152:155]
v_mfma_f32_16x16x32_bf16 a[156:159], v[188:191], v[228:231], a[156:159]
v_mfma_f32_16x16x32_bf16 a[156:159], v[184:187], v[224:227], a[156:159]
s_waitcnt lgkmcnt(4)
v_mfma_f32_16x16x32_bf16 a[188:191], v[184:187], v[232:235], a[188:191]
ds_read_b64_tr_b16 v[248:249], v23 offset:16384
v_mfma_f32_16x16x32_bf16 a[188:191], v[188:191], v[236:239], a[188:191]
v_mfma_f32_16x16x32_bf16 a[184:187], v[180:183], v[236:239], a[184:187]
ds_read_b64_tr_b16 v[250:251], v23 offset:17408
v_mfma_f32_16x16x32_bf16 a[184:187], v[176:179], v[232:235], a[184:187]
v_mfma_f32_16x16x32_bf16 a[180:183], v[168:171], v[232:235], a[180:183]
ds_read_b64_tr_b16 v[252:253], v23 offset:24576
v_mfma_f32_16x16x32_bf16 a[180:183], v[172:175], v[236:239], a[180:183]
v_mfma_f32_16x16x32_bf16 a[176:179], v[164:167], v[236:239], a[176:179]
ds_read_b64_tr_b16 v[254:255], v23 offset:25600
v_mfma_f32_16x16x32_bf16 a[176:179], v[160:163], v[232:235], a[176:179]
v_mfma_f32_16x16x32_bf16 a[172:175], v[152:155], v[232:235], a[172:175]
v_mfma_f32_16x16x32_bf16 a[172:175], v[156:159], v[236:239], a[172:175]
v_mfma_f32_16x16x32_bf16 a[168:171], v[148:151], v[236:239], a[168:171]
v_mfma_f32_16x16x32_bf16 a[168:171], v[144:147], v[232:235], a[168:171]
v_mfma_f32_16x16x32_bf16 a[164:167], v[136:139], v[232:235], a[164:167]
v_mfma_f32_16x16x32_bf16 a[164:167], v[140:143], v[236:239], a[164:167]
v_mfma_f32_16x16x32_bf16 a[160:163], v[132:135], v[236:239], a[160:163]
s_waitcnt vmcnt(6) lgkmcnt(0)
v_mfma_f32_16x16x32_bf16 a[160:163], v[128:131], v[232:235], a[160:163]
s_barrier
v_mfma_f32_16x16x32_bf16 a[192:195], v[128:131], v[240:243], a[192:195]
s_and_b32 s73, s65, 1
ds_read_b64_tr_b16 v[224:225], v20 offset:32768
v_mfma_f32_16x16x32_bf16 a[192:195], v[132:135], v[244:247], a[192:195]
s_xor_b32 s73, s73, 4
ds_read_b64_tr_b16 v[226:227], v20 offset:33792
v_mfma_f32_16x16x32_bf16 a[196:199], v[140:143], v[244:247], a[196:199]
s_lshl_b32 s69, s73, 7
ds_read_b64_tr_b16 v[228:229], v20 offset:40960
v_mfma_f32_16x16x32_bf16 a[196:199], v[136:139], v[240:243], a[196:199]
s_add_u32 s69, s69, s84
ds_read_b64_tr_b16 v[230:231], v20 offset:41984
v_mfma_f32_16x16x32_bf16 a[200:203], v[144:147], v[240:243], a[200:203]
s_lshl_b32 s71, s73, 19
ds_read_b128 v[192:195], v24 offset:32768
v_mfma_f32_16x16x32_bf16 a[200:203], v[148:151], v[244:247], a[200:203]
s_add_u32 s71, s71, s66
ds_read_b128 v[196:199], v25 offset:32768
v_mfma_f32_16x16x32_bf16 a[204:207], v[156:159], v[244:247], a[204:207]
s_add_u32 m0, s63, 65536
v_mfma_f32_16x16x32_bf16 a[204:207], v[152:155], v[240:243], a[204:207]
s_add_u32 s72, s69, 0
buffer_load_dwordx4 v2, s[8:11], s72 offen lds
v_mfma_f32_16x16x32_bf16 a[208:211], v[160:163], v[240:243], a[208:211]
s_add_u32 s72, s69, 7168
buffer_load_dwordx4 v3, s[8:11], s72 offen offset:1024 lds
v_mfma_f32_16x16x32_bf16 a[208:211], v[164:167], v[244:247], a[208:211]
s_add_u32 s72, s69, 14336
buffer_load_dwordx4 v2, s[8:11], s72 offen offset:2048 lds
v_mfma_f32_16x16x32_bf16 a[212:215], v[172:175], v[244:247], a[212:215]
ds_read_b128 v[200:203], v24 offset:34816
v_mfma_f32_16x16x32_bf16 a[212:215], v[168:171], v[240:243], a[212:215]
ds_read_b128 v[204:207], v25 offset:34816
v_mfma_f32_16x16x32_bf16 a[216:219], v[176:179], v[240:243], a[216:219]
s_add_u32 s72, s69, 21504
buffer_load_dwordx4 v3, s[8:11], s72 offen offset:3072 lds
v_mfma_f32_16x16x32_bf16 a[216:219], v[180:183], v[244:247], a[216:219]
ds_read_b128 v[208:211], v24 offset:36864
v_mfma_f32_16x16x32_bf16 a[220:223], v[188:191], v[244:247], a[220:223]
ds_read_b128 v[212:215], v25 offset:36864
v_mfma_f32_16x16x32_bf16 a[220:223], v[184:187], v[240:243], a[220:223]
ds_read_b128 v[216:219], v24 offset:38912
v_mfma_f32_16x16x32_bf16 a[252:255], v[184:187], v[248:251], a[252:255]
ds_read_b128 v[220:223], v25 offset:38912
v_mfma_f32_16x16x32_bf16 a[252:255], v[188:191], v[252:255], a[252:255]
s_add_u32 m0, s64, 0
v_mfma_f32_16x16x32_bf16 a[248:251], v[180:183], v[252:255], a[248:251]
s_add_u32 s72, s71, 0
buffer_load_dwordx4 v6, s[16:19], s72 offen lds
v_mfma_f32_16x16x32_bf16 a[248:251], v[176:179], v[248:251], a[248:251]
ds_read_b128 v[184:187], v24 offset:40960
v_mfma_f32_16x16x32_bf16 a[244:247], v[168:171], v[248:251], a[244:247]
ds_read_b128 v[188:191], v25 offset:40960
v_mfma_f32_16x16x32_bf16 a[244:247], v[172:175], v[252:255], a[244:247]
s_add_u32 s72, s71, 31744
buffer_load_dwordx4 v6, s[16:19], s72 offen offset:1024 lds
v_mfma_f32_16x16x32_bf16 a[240:243], v[164:167], v[252:255], a[240:243]
ds_read_b128 v[176:179], v24 offset:43008
v_mfma_f32_16x16x32_bf16 a[240:243], v[160:163], v[248:251], a[240:243]
ds_read_b128 v[180:183], v25 offset:43008
v_mfma_f32_16x16x32_bf16 a[236:239], v[152:155], v[248:251], a[236:239]
ds_read_b128 v[168:171], v24 offset:45056
v_mfma_f32_16x16x32_bf16 a[236:239], v[156:159], v[252:255], a[236:239]
s_add_u32 s72, s71, 63488
buffer_load_dwordx4 v7, s[16:19], s72 offen offset:2048 lds
v_mfma_f32_16x16x32_bf16 a[232:235], v[148:151], v[252:255], a[232:235]
ds_read_b128 v[172:175], v25 offset:45056
v_mfma_f32_16x16x32_bf16 a[232:235], v[144:147], v[248:251], a[232:235]
ds_read_b128 v[160:163], v24 offset:47104
v_mfma_f32_16x16x32_bf16 a[228:231], v[136:139], v[248:251], a[228:231]
ds_read_b128 v[164:167], v25 offset:47104
v_mfma_f32_16x16x32_bf16 a[228:231], v[140:143], v[252:255], a[228:231]
v_mfma_f32_16x16x32_bf16 a[224:227], v[132:135], v[252:255], a[224:227]
s_add_u32 s72, s71, 95232
buffer_load_dwordx4 v7, s[16:19], s72 offen offset:3072 lds
v_mfma_f32_16x16x32_bf16 a[224:227], v[128:131], v[248:251], a[224:227]
s_waitcnt lgkmcnt(8)
ds_read_b64_tr_b16 v[232:233], v21 offset:32768
v_mfma_f32_16x16x32_bf16 a[0:3], v[224:227], v[192:195], a[0:3]
ds_read_b64_tr_b16 v[234:235], v21 offset:33792
v_mfma_f32_16x16x32_bf16 a[0:3], v[228:231], v[196:199], a[0:3]
ds_read_b64_tr_b16 v[240:241], v22 offset:32768
v_mfma_f32_16x16x32_bf16 a[4:7], v[228:231], v[204:207], a[4:7]
s_add_u32 m0, s63, 69632
ds_read_b64_tr_b16 v[236:237], v21 offset:40960
v_mfma_f32_16x16x32_bf16 a[4:7], v[224:227], v[200:203], a[4:7]
s_add_u32 s72, s69, 32768
buffer_load_dwordx4 v2, s[8:11], s72 offen lds
v_mfma_f32_16x16x32_bf16 a[8:11], v[224:227], v[208:211], a[8:11]
ds_read_b64_tr_b16 v[238:239], v21 offset:41984
v_mfma_f32_16x16x32_bf16 a[8:11], v[228:231], v[212:215], a[8:11]
v_mfma_f32_16x16x32_bf16 a[12:15], v[228:231], v[220:223], a[12:15]
s_add_u32 s72, s69, 39936
buffer_load_dwordx4 v3, s[8:11], s72 offen offset:1024 lds
v_mfma_f32_16x16x32_bf16 a[12:15], v[224:227], v[216:219], a[12:15]
s_waitcnt lgkmcnt(5)
ds_read_b64_tr_b16 v[242:243], v22 offset:33792
v_mfma_f32_16x16x32_bf16 a[16:19], v[224:227], v[184:187], a[16:19]
v_mfma_f32_16x16x32_bf16 a[16:19], v[228:231], v[188:191], a[16:19]
ds_read_b64_tr_b16 v[244:245], v22 offset:40960
v_mfma_f32_16x16x32_bf16 a[20:23], v[228:231], v[180:183], a[20:23]
v_mfma_f32_16x16x32_bf16 a[20:23], v[224:227], v[176:179], a[20:23]
s_add_u32 s72, s69, 47104
buffer_load_dwordx4 v2, s[8:11], s72 offen offset:2048 lds
v_mfma_f32_16x16x32_bf16 a[24:27], v[224:227], v[168:171], a[24:27]
ds_read_b64_tr_b16 v[246:247], v22 offset:41984
v_mfma_f32_16x16x32_bf16 a[24:27], v[228:231], v[172:175], a[24:27]
v_mfma_f32_16x16x32_bf16 a[28:31], v[228:231], v[164:167], a[28:31]
v_mfma_f32_16x16x32_bf16 a[28:31], v[224:227], v[160:163], a[28:31]
s_waitcnt lgkmcnt(3)
v_mfma_f32_16x16x32_bf16 a[60:63], v[232:235], v[160:163], a[60:63]
s_add_u32 s72, s69, 54272
buffer_load_dwordx4 v3, s[8:11], s72 offen offset:3072 lds
v_mfma_f32_16x16x32_bf16 a[60:63], v[236:239], v[164:167], a[60:63]
ds_read_b64_tr_b16 v[248:249], v23 offset:32768
v_mfma_f32_16x16x32_bf16 a[56:59], v[236:239], v[172:175], a[56:59]
v_mfma_f32_16x16x32_bf16 a[56:59], v[232:235], v[168:171], a[56:59]
s_add_u32 m0, s64, 16384
ds_read_b64_tr_b16 v[250:251], v23 offset:33792
v_mfma_f32_16x16x32_bf16 a[52:55], v[232:235], v[176:179], a[52:55]
s_add_u32 s72, s71, 0
buffer_load_dwordx4 v6, s[20:23], s72 offen lds
v_mfma_f32_16x16x32_bf16 a[52:55], v[236:239], v[180:183], a[52:55]
v_mfma_f32_16x16x32_bf16 a[48:51], v[236:239], v[188:191], a[48:51]
v_mfma_f32_16x16x32_bf16 a[48:51], v[232:235], v[184:187], a[48:51]
ds_read_b64_tr_b16 v[252:253], v23 offset:40960
v_mfma_f32_16x16x32_bf16 a[44:47], v[232:235], v[216:219], a[44:47]
s_add_u32 s72, s71, 31744
buffer_load_dwordx4 v6, s[20:23], s72 offen offset:1024 lds
v_mfma_f32_16x16x32_bf16 a[44:47], v[236:239], v[220:223], a[44:47]
v_mfma_f32_16x16x32_bf16 a[40:43], v[236:239], v[212:215], a[40:43]
ds_read_b64_tr_b16 v[254:255], v23 offset:41984
v_mfma_f32_16x16x32_bf16 a[40:43], v[232:235], v[208:211], a[40:43]
v_mfma_f32_16x16x32_bf16 a[36:39], v[232:235], v[200:203], a[36:39]
s_add_u32 s72, s71, 63488
buffer_load_dwordx4 v7, s[20:23], s72 offen offset:2048 lds
v_mfma_f32_16x16x32_bf16 a[36:39], v[236:239], v[204:207], a[36:39]
v_mfma_f32_16x16x32_bf16 a[32:35], v[236:239], v[196:199], a[32:35]
v_mfma_f32_16x16x32_bf16 a[32:35], v[232:235], v[192:195], a[32:35]
s_waitcnt lgkmcnt(4)
v_mfma_f32_16x16x32_bf16 a[64:67], v[240:243], v[192:195], a[64:67]
s_add_u32 s72, s71, 95232
buffer_load_dwordx4 v7, s[20:23], s72 offen offset:3072 lds
v_mfma_f32_16x16x32_bf16 a[64:67], v[244:247], v[196:199], a[64:67]
buffer_load_dwordx4 v[108:111], v1, s[4:7], s76 offen
v_mfma_f32_16x16x32_bf16 a[68:71], v[244:247], v[204:207], a[68:71]
buffer_load_dwordx4 v[112:115], v1, s[4:7], s76 offen offset:1024
v_mfma_f32_16x16x32_bf16 a[68:71], v[240:243], v[200:203], a[68:71]
buffer_load_dwordx4 v[116:119], v1, s[4:7], s76 offen offset:2048
v_mfma_f32_16x16x32_bf16 a[72:75], v[240:243], v[208:211], a[72:75]
buffer_load_dwordx4 v[120:123], v1, s[4:7], s76 offen offset:3072
v_mfma_f32_16x16x32_bf16 a[72:75], v[244:247], v[212:215], a[72:75]
ds_read_b64_tr_b16 v[224:225], v20 offset:49152
v_mfma_f32_16x16x32_bf16 a[76:79], v[244:247], v[220:223], a[76:79]
v_mfma_f32_16x16x32_bf16 a[76:79], v[240:243], v[216:219], a[76:79]
ds_read_b64_tr_b16 v[226:227], v20 offset:50176
v_mfma_f32_16x16x32_bf16 a[80:83], v[240:243], v[184:187], a[80:83]
v_mfma_f32_16x16x32_bf16 a[80:83], v[244:247], v[188:191], a[80:83]
ds_read_b64_tr_b16 v[228:229], v20 offset:57344
v_mfma_f32_16x16x32_bf16 a[84:87], v[244:247], v[180:183], a[84:87]
v_mfma_f32_16x16x32_bf16 a[84:87], v[240:243], v[176:179], a[84:87]
ds_read_b64_tr_b16 v[230:231], v20 offset:58368
v_mfma_f32_16x16x32_bf16 a[88:91], v[240:243], v[168:171], a[88:91]
v_mfma_f32_16x16x32_bf16 a[88:91], v[244:247], v[172:175], a[88:91]
v_mfma_f32_16x16x32_bf16 a[92:95], v[244:247], v[164:167], a[92:95]
v_mfma_f32_16x16x32_bf16 a[92:95], v[240:243], v[160:163], a[92:95]
s_waitcnt lgkmcnt(4)
v_mfma_f32_16x16x32_bf16 a[124:127], v[248:251], v[160:163], a[124:127]
ds_read_b64_tr_b16 v[232:233], v21 offset:49152
v_mfma_f32_16x16x32_bf16 a[124:127], v[252:255], v[164:167], a[124:127]
v_mfma_f32_16x16x32_bf16 a[120:123], v[252:255], v[172:175], a[120:123]
v_mfma_f32_16x16x32_bf16 a[120:123], v[248:251], v[168:171], a[120:123]
ds_read_b64_tr_b16 v[234:235], v21 offset:50176
v_mfma_f32_16x16x32_bf16 a[116:119], v[248:251], v[176:179], a[116:119]
s_waitcnt vmcnt(20)
ds_read2_b32 v[36:37], v98 offset0:0 offset1:32
ds_read2_b32 v[38:39], v98 offset0:64 offset1:96
v_mfma_f32_16x16x32_bf16 a[116:119], v[252:255], v[180:183], a[116:119]
ds_read2_b32 v[40:41], v98 offset0:128 offset1:160
ds_read2_b32 v[42:43], v98 offset0:192 offset1:224
v_mfma_f32_16x16x32_bf16 a[112:115], v[252:255], v[188:191], a[112:115]
v_add_u32 v98, 1024, v98
v_mfma_f32_16x16x32_bf16 a[112:115], v[248:251], v[184:187], a[112:115]
ds_read_b64_tr_b16 v[236:237], v21 offset:57344
ds_read2_b32 v[44:45], v98 offset0:0 offset1:32
v_mfma_f32_16x16x32_bf16 a[108:111], v[248:251], v[216:219], a[108:111]
ds_read2_b32 v[46:47], v98 offset0:64 offset1:96
ds_read2_b32 v[48:49], v98 offset0:128 offset1:160
v_mfma_f32_16x16x32_bf16 a[108:111], v[252:255], v[220:223], a[108:111]
ds_read2_b32 v[50:51], v98 offset0:192 offset1:224
v_add_u32 v98, 3072, v98
v_mfma_f32_16x16x32_bf16 a[104:107], v[252:255], v[212:215], a[104:107]
ds_read_b64_tr_b16 v[238:239], v21 offset:58368
ds_read2_b32 v[52:53], v98 offset0:0 offset1:32
v_mfma_f32_16x16x32_bf16 a[104:107], v[248:251], v[208:211], a[104:107]
ds_read2_b32 v[54:55], v98 offset0:64 offset1:96
ds_read2_b32 v[56:57], v98 offset0:128 offset1:160
v_mfma_f32_16x16x32_bf16 a[100:103], v[248:251], v[200:203], a[100:103]
ds_read2_b32 v[58:59], v98 offset0:192 offset1:224
v_add_u32 v98, 1024, v98
v_mfma_f32_16x16x32_bf16 a[100:103], v[252:255], v[204:207], a[100:103]
ds_read2_b32 v[60:61], v98 offset0:0 offset1:32
ds_read2_b32 v[62:63], v98 offset0:64 offset1:96
v_mfma_f32_16x16x32_bf16 a[96:99], v[252:255], v[196:199], a[96:99]
ds_read2_b32 v[64:65], v98 offset0:128 offset1:160
ds_read2_b32 v[66:67], v98 offset0:192 offset1:224
v_mfma_f32_16x16x32_bf16 a[96:99], v[248:251], v[192:195], a[96:99]
s_waitcnt lgkmcnt(15)
v_mfma_f32_16x16x32_bf16 a[128:131], v[192:195], v[224:227], a[128:131]
ds_read_b64_tr_b16 v[240:241], v22 offset:49152
v_mfma_f32_16x16x32_bf16 a[128:131], v[196:199], v[228:231], a[128:131]
v_mfma_f32_16x16x32_bf16 a[132:135], v[204:207], v[228:231], a[132:135]
v_mfma_f32_16x16x32_bf16 a[132:135], v[200:203], v[224:227], a[132:135]
ds_read_b64_tr_b16 v[242:243], v22 offset:50176
v_mfma_f32_16x16x32_bf16 a[136:139], v[208:211], v[224:227], a[136:139]
v_mfma_f32_16x16x32_bf16 a[136:139], v[212:215], v[228:231], a[136:139]
v_mfma_f32_16x16x32_bf16 a[140:143], v[220:223], v[228:231], a[140:143]
v_mfma_f32_16x16x32_bf16 a[140:143], v[216:219], v[224:227], a[140:143]
ds_read_b64_tr_b16 v[244:245], v22 offset:57344
v_mfma_f32_16x16x32_bf16 a[144:147], v[184:187], v[224:227], a[144:147]
v_mfma_f32_16x16x32_bf16 a[144:147], v[188:191], v[228:231], a[144:147]
v_mfma_f32_16x16x32_bf16 a[148:151], v[180:183], v[228:231], a[148:151]
ds_read_b64_tr_b16 v[246:247], v22 offset:58368
v_mfma_f32_16x16x32_bf16 a[148:151], v[176:179], v[224:227], a[148:151]
v_mfma_f32_16x16x32_bf16 a[152:155], v[168:171], v[224:227], a[152:155]
v_mfma_f32_16x16x32_bf16 a[152:155], v[172:175], v[228:231], a[152:155]
v_mfma_f32_16x16x32_bf16 a[156:159], v[164:167], v[228:231], a[156:159]
v_mfma_f32_16x16x32_bf16 a[156:159], v[160:163], v[224:227], a[156:159]
s_waitcnt lgkmcnt(12)
v_mfma_f32_16x16x32_bf16 a[188:191], v[160:163], v[232:235], a[188:191]
ds_read_b64_tr_b16 v[248:249], v23 offset:49152
v_mfma_f32_16x16x32_bf16 a[188:191], v[164:167], v[236:239], a[188:191]
v_mfma_f32_16x16x32_bf16 a[184:187], v[172:175], v[236:239], a[184:187]
ds_read_b64_tr_b16 v[250:251], v23 offset:50176
v_mfma_f32_16x16x32_bf16 a[184:187], v[168:171], v[232:235], a[184:187]
v_mfma_f32_16x16x32_bf16 a[180:183], v[176:179], v[232:235], a[180:183]
ds_read_b64_tr_b16 v[252:253], v23 offset:57344
v_mfma_f32_16x16x32_bf16 a[180:183], v[180:183], v[236:239], a[180:183]
v_mfma_f32_16x16x32_bf16 a[176:179], v[188:191], v[236:239], a[176:179]
ds_read_b64_tr_b16 v[254:255], v23 offset:58368
v_mfma_f32_16x16x32_bf16 a[176:179], v[184:187], v[232:235], a[176:179]
v_mfma_f32_16x16x32_bf16 a[172:175], v[216:219], v[232:235], a[172:175]
v_mfma_f32_16x16x32_bf16 a[172:175], v[220:223], v[236:239], a[172:175]
v_mfma_f32_16x16x32_bf16 a[168:171], v[212:215], v[236:239], a[168:171]
v_mfma_f32_16x16x32_bf16 a[168:171], v[208:211], v[232:235], a[168:171]
v_mfma_f32_16x16x32_bf16 a[164:167], v[200:203], v[232:235], a[164:167]
v_mfma_f32_16x16x32_bf16 a[164:167], v[204:207], v[236:239], a[164:167]
v_mfma_f32_16x16x32_bf16 a[160:163], v[196:199], v[236:239], a[160:163]
s_waitcnt vmcnt(4) lgkmcnt(0)
v_mfma_f32_16x16x32_bf16 a[160:163], v[192:195], v[232:235], a[160:163]
s_barrier
v_mfma_f32_16x16x32_bf16 a[192:195], v[192:195], v[240:243], a[192:195]
s_and_b32 s73, s65, 1
ds_read_b64_tr_b16 v[224:225], v20 offset:0
v_lshlrev_b32 v72, 16, v68
v_mfma_f32_16x16x32_bf16 a[192:195], v[196:199], v[244:247], a[192:195]
s_xor_b32 s73, s73, 5
ds_read_b64_tr_b16 v[226:227], v20 offset:1024
v_and_b32 v73, 0xffff0000, v68
v_mfma_f32_16x16x32_bf16 a[196:199], v[204:207], v[244:247], a[196:199]
s_lshl_b32 s69, s73, 7
ds_read_b64_tr_b16 v[228:229], v20 offset:8192
v_lshlrev_b32 v74, 16, v69
v_mfma_f32_16x16x32_bf16 a[196:199], v[200:203], v[240:243], a[196:199]
s_add_u32 s69, s69, s84
ds_read_b64_tr_b16 v[230:231], v20 offset:9216
v_and_b32 v75, 0xffff0000, v69
v_mfma_f32_16x16x32_bf16 a[200:203], v[208:211], v[240:243], a[200:203]
s_lshl_b32 s71, s73, 19
ds_read_b128 v[128:131], v24 offset:0
v_lshlrev_b32 v76, 16, v33
v_mfma_f32_16x16x32_bf16 a[200:203], v[212:215], v[244:247], a[200:203]
s_add_u32 s71, s71, s66
ds_read_b128 v[132:135], v25 offset:0
v_lshlrev_b32 v77, 16, v34
v_mfma_f32_16x16x32_bf16 a[204:207], v[220:223], v[244:247], a[204:207]
s_add_u32 m0, s63, 98304
v_lshlrev_b32 v78, 16, v35
v_lshlrev_b32 v79, 16, v36
v_mfma_f32_16x16x32_bf16 a[204:207], v[216:219], v[240:243], a[204:207]
s_add_u32 s72, s69, 0
buffer_load_dwordx4 v2, s[8:11], s72 offen lds
v_mfma_f32_16x16x32_bf16 a[208:211], v[184:187], v[240:243], a[208:211]
s_add_u32 s72, s69, 7168
buffer_load_dwordx4 v3, s[8:11], s72 offen offset:1024 lds
v_mfma_f32_16x16x32_bf16 a[208:211], v[188:191], v[244:247], a[208:211]
s_add_u32 s72, s69, 14336
buffer_load_dwordx4 v2, s[8:11], s72 offen offset:2048 lds
v_mfma_f32_16x16x32_bf16 a[212:215], v[180:183], v[244:247], a[212:215]
ds_read_b128 v[136:139], v24 offset:2048
v_lshlrev_b32 v80, 16, v37
v_mfma_f32_16x16x32_bf16 a[212:215], v[176:179], v[240:243], a[212:215]
ds_read_b128 v[140:143], v25 offset:2048
v_lshlrev_b32 v81, 16, v38
v_mfma_f32_16x16x32_bf16 a[216:219], v[168:171], v[240:243], a[216:219]
s_add_u32 s72, s69, 21504
buffer_load_dwordx4 v3, s[8:11], s72 offen offset:3072 lds
v_mfma_f32_16x16x32_bf16 a[216:219], v[172:175], v[244:247], a[216:219]
ds_read_b128 v[144:147], v24 offset:4096
v_lshlrev_b32 v82, 16, v39
v_mfma_f32_16x16x32_bf16 a[220:223], v[164:167], v[244:247], a[220:223]
ds_read_b128 v[148:151], v25 offset:4096
v_lshlrev_b32 v83, 16, v40
v_mfma_f32_16x16x32_bf16 a[220:223], v[160:163], v[240:243], a[220:223]
ds_read_b128 v[152:155], v24 offset:6144
v_lshlrev_b32 v84, 16, v41
v_mfma_f32_16x16x32_bf16 a[252:255], v[160:163], v[248:251], a[252:255]
ds_read_b128 v[156:159], v25 offset:6144
v_lshlrev_b32 v85, 16, v42
v_mfma_f32_16x16x32_bf16 a[252:255], v[164:167], v[252:255], a[252:255]
s_add_u32 m0, s64, 32768
v_lshlrev_b32 v86, 16, v43
v_lshlrev_b32 v87, 16, v44
v_mfma_f32_16x16x32_bf16 a[248:251], v[172:175], v[252:255], a[248:251]
s_add_u32 s72, s71, 0
buffer_load_dwordx4 v6, s[16:19], s72 offen lds
v_mfma_f32_16x16x32_bf16 a[248:251], v[168:171], v[248:251], a[248:251]
ds_read_b128 v[160:163], v24 offset:8192
v_lshlrev_b32 v88, 16, v45
v_mfma_f32_16x16x32_bf16 a[244:247], v[176:179], v[248:251], a[244:247]
ds_read_b128 v[164:167], v25 offset:8192
v_lshlrev_b32 v89, 16, v46
v_mfma_f32_16x16x32_bf16 a[244:247], v[180:183], v[252:255], a[244:247]
s_add_u32 s72, s71, 31744
buffer_load_dwordx4 v6, s[16:19], s72 offen offset:1024 lds
v_mfma_f32_16x16x32_bf16 a[240:243], v[188:191], v[252:255], a[240:243]
ds_read_b128 v[168:171], v24 offset:10240
v_lshlrev_b32 v90, 16, v47
v_mfma_f32_16x16x32_bf16 a[240:243], v[184:187], v[248:251], a[240:243]
ds_read_b128 v[172:175], v25 offset:10240
v_lshlrev_b32 v91, 16, v48
v_mfma_f32_16x16x32_bf16 a[236:239], v[216:219], v[248:251], a[236:239]
ds_read_b128 v[176:179], v24 offset:12288
v_lshlrev_b32 v92, 16, v49
v_mfma_f32_16x16x32_bf16 a[236:239], v[220:223], v[252:255], a[236:239]
s_add_u32 s72, s71, 63488
buffer_load_dwordx4 v7, s[16:19], s72 offen offset:2048 lds
v_mfma_f32_16x16x32_bf16 a[232:235], v[212:215], v[252:255], a[232:235]
ds_read_b128 v[180:183], v25 offset:12288
v_lshlrev_b32 v93, 16, v50
v_mfma_f32_16x16x32_bf16 a[232:235], v[208:211], v[248:251], a[232:235]
ds_read_b128 v[184:187], v24 offset:14336
v_lshlrev_b32 v94, 16, v51
v_mfma_f32_16x16x32_bf16 a[228:231], v[200:203], v[248:251], a[228:231]
ds_read_b128 v[188:191], v25 offset:14336
v_mul_f32 v95, v75, v91
v_mfma_f32_16x16x32_bf16 a[228:231], v[204:207], v[252:255], a[228:231]
v_lshlrev_b32 v97, 16, v67
v_fmac_f32 v95, v74, v92
v_mfma_f32_16x16x32_bf16 a[224:227], v[196:199], v[252:255], a[224:227]
s_add_u32 s72, s71, 95232
buffer_load_dwordx4 v7, s[16:19], s72 offen offset:3072 lds
v_mfma_f32_16x16x32_bf16 a[224:227], v[192:195], v[248:251], a[224:227]
s_waitcnt lgkmcnt(8)
ds_read_b64_tr_b16 v[232:233], v21 offset:0
v_fmac_f32 v95, v73, v93
v_mfma_f32_16x16x32_bf16 a[0:3], v[224:227], v[128:131], a[0:3]
ds_read_b64_tr_b16 v[234:235], v21 offset:1024
v_fmac_f32 v95, v72, v94
v_mfma_f32_16x16x32_bf16 a[0:3], v[228:231], v[132:135], a[0:3]
ds_read_b64_tr_b16 v[240:241], v22 offset:0
v_mul_f32 v95, v95, v97
v_mfma_f32_16x16x32_bf16 a[4:7], v[228:231], v[140:143], a[4:7]
s_add_u32 m0, s63, 102400
ds_read_b64_tr_b16 v[236:237], v21 offset:8192
v_mul_f32 v96, v75, v90
v_mfma_f32_16x16x32_bf16 a[4:7], v[224:227], v[136:139], a[4:7]
s_add_u32 s72, s69, 32768
buffer_load_dwordx4 v2, s[8:11], s72 offen lds
v_mfma_f32_16x16x32_bf16 a[8:11], v[224:227], v[144:147], a[8:11]
ds_read_b64_tr_b16 v[238:239], v21 offset:9216
v_lshlrev_b32 v97, 16, v66
v_mfma_f32_16x16x32_bf16 a[8:11], v[228:231], v[148:151], a[8:11]
v_fmac_f32 v96, v74, v91
v_fmac_f32 v96, v73, v92
v_mfma_f32_16x16x32_bf16 a[12:15], v[228:231], v[156:159], a[12:15]
s_add_u32 s72, s69, 39936
buffer_load_dwordx4 v3, s[8:11], s72 offen offset:1024 lds
v_mfma_f32_16x16x32_bf16 a[12:15], v[224:227], v[152:155], a[12:15]
s_waitcnt lgkmcnt(5)
ds_read_b64_tr_b16 v[242:243], v22 offset:1024
v_fmac_f32 v96, v72, v93
v_mfma_f32_16x16x32_bf16 a[16:19], v[224:227], v[160:163], a[16:19]
v_mul_f32 v96, v96, v97
v_cvt_pk_bf16_f32 v100, v95, v96
v_mfma_f32_16x16x32_bf16 a[16:19], v[228:231], v[164:167], a[16:19]
ds_read_b64_tr_b16 v[244:245], v22 offset:8192
v_mul_f32 v95, v75, v89
v_mfma_f32_16x16x32_bf16 a[20:23], v[228:231], v[172:175], a[20:23]
v_lshlrev_b32 v97, 16, v65
v_fmac_f32 v95, v74, v90
v_mfma_f32_16x16x32_bf16 a[20:23], v[224:227], v[168:171], a[20:23]
s_add_u32 s72, s69, 47104
buffer_load_dwordx4 v2, s[8:11], s72 offen offset:2048 lds
v_mfma_f32_16x16x32_bf16 a[24:27], v[224:227], v[176:179], a[24:27]
ds_read_b64_tr_b16 v[246:247], v22 offset:9216
v_fmac_f32 v95, v73, v91
v_mfma_f32_16x16x32_bf16 a[24:27], v[228:231], v[180:183], a[24:27]
v_fmac_f32 v95, v72, v92
v_mul_f32 v95, v95, v97
v_mfma_f32_16x16x32_bf16 a[28:31], v[228:231], v[188:191], a[28:31]
v_mul_f32 v96, v75, v88
v_lshlrev_b32 v97, 16, v64
v_mfma_f32_16x16x32_bf16 a[28:31], v[224:227], v[184:187], a[28:31]
s_waitcnt lgkmcnt(3)
v_fmac_f32 v96, v74, v89
v_fmac_f32 v96, v73, v90
v_mfma_f32_16x16x32_bf16 a[60:63], v[232:235], v[184:187], a[60:63]
s_add_u32 s72, s69, 54272
buffer_load_dwordx4 v3, s[8:11], s72 offen offset:3072 lds
v_mfma_f32_16x16x32_bf16 a[60:63], v[236:239], v[188:191], a[60:63]
ds_read_b64_tr_b16 v[248:249], v23 offset:0
v_fmac_f32 v96, v72, v91
v_mfma_f32_16x16x32_bf16 a[56:59], v[236:239], v[180:183], a[56:59]
v_mul_f32 v96, v96, v97
v_cvt_pk_bf16_f32 v101, v95, v96
v_mfma_f32_16x16x32_bf16 a[56:59], v[232:235], v[176:179], a[56:59]
s_add_u32 m0, s64, 49152
ds_read_b64_tr_b16 v[250:251], v23 offset:1024
v_mul_f32 v95, v75, v87
v_mfma_f32_16x16x32_bf16 a[52:55], v[232:235], v[168:171], a[52:55]
s_add_u32 s72, s71, 0
buffer_load_dwordx4 v6, s[20:23], s72 offen lds
v_mfma_f32_16x16x32_bf16 a[52:55], v[236:239], v[172:175], a[52:55]
v_lshlrev_b32 v97, 16, v63
v_fmac_f32 v95, v74, v88
v_mfma_f32_16x16x32_bf16 a[48:51], v[236:239], v[164:167], a[48:51]
v_fmac_f32 v95, v73, v89
v_fmac_f32 v95, v72, v90
v_mfma_f32_16x16x32_bf16 a[48:51], v[232:235], v[160:163], a[48:51]
ds_read_b64_tr_b16 v[252:253], v23 offset:8192
v_mul_f32 v95, v95, v97
v_mfma_f32_16x16x32_bf16 a[44:47], v[232:235], v[152:155], a[44:47]
s_add_u32 s72, s71, 31744
buffer_load_dwordx4 v6, s[20:23], s72 offen offset:1024 lds
v_mfma_f32_16x16x32_bf16 a[44:47], v[236:239], v[156:159], a[44:47]
v_mul_f32 v96, v75, v86
v_lshlrev_b32 v97, 16, v62
v_mfma_f32_16x16x32_bf16 a[40:43], v[236:239], v[148:151], a[40:43]
ds_read_b64_tr_b16 v[254:255], v23 offset:9216
v_fmac_f32 v96, v74, v87
v_mfma_f32_16x16x32_bf16 a[40:43], v[232:235], v[144:147], a[40:43]
v_fmac_f32 v96, v73, v88
v_fmac_f32 v96, v72, v89
v_mfma_f32_16x16x32_bf16 a[36:39], v[232:235], v[136:139], a[36:39]
s_add_u32 s72, s71, 63488
buffer_load_dwordx4 v7, s[20:23], s72 offen offset:2048 lds
v_mfma_f32_16x16x32_bf16 a[36:39], v[236:239], v[140:143], a[36:39]
v_mul_f32 v96, v96, v97
v_cvt_pk_bf16_f32 v102, v95, v96
v_mfma_f32_16x16x32_bf16 a[32:35], v[236:239], v[132:135], a[32:35]
v_mul_f32 v95, v75, v85
v_lshlrev_b32 v97, 16, v61
v_mfma_f32_16x16x32_bf16 a[32:35], v[232:235], v[128:131], a[32:35]
s_waitcnt lgkmcnt(4)
v_fmac_f32 v95, v74, v86
v_fmac_f32 v95, v73, v87
v_mfma_f32_16x16x32_bf16 a[64:67], v[240:243], v[128:131], a[64:67]
s_add_u32 s72, s71, 95232
buffer_load_dwordx4 v7, s[20:23], s72 offen offset:3072 lds
v_mfma_f32_16x16x32_bf16 a[64:67], v[244:247], v[132:135], a[64:67]
s_mov_b32 s80, 0x0
buffer_load_dword v126, v125, s[12:15], s80 offen
v_mfma_f32_16x16x32_bf16 a[68:71], v[244:247], v[140:143], a[68:71]
s_mov_b32 s80, 0x100000
buffer_load_dword v126, v125, s[12:15], s80 offen
v_mfma_f32_16x16x32_bf16 a[68:71], v[240:243], v[136:139], a[68:71]
s_mov_b32 s80, 0x200000
buffer_load_dword v126, v125, s[12:15], s80 offen
v_mfma_f32_16x16x32_bf16 a[72:75], v[240:243], v[144:147], a[72:75]
s_mov_b32 s80, 0x300000
buffer_load_dword v126, v125, s[12:15], s80 offen
v_mfma_f32_16x16x32_bf16 a[72:75], v[244:247], v[148:151], a[72:75]
ds_read_b64_tr_b16 v[224:225], v20 offset:16384
v_fmac_f32 v95, v72, v88
v_mfma_f32_16x16x32_bf16 a[76:79], v[244:247], v[156:159], a[76:79]
v_mul_f32 v95, v95, v97
v_mul_f32 v96, v75, v84
v_mfma_f32_16x16x32_bf16 a[76:79], v[240:243], v[152:155], a[76:79]
ds_read_b64_tr_b16 v[226:227], v20 offset:17408
v_lshlrev_b32 v97, 16, v60
v_mfma_f32_16x16x32_bf16 a[80:83], v[240:243], v[160:163], a[80:83]
v_fmac_f32 v96, v74, v85
v_fmac_f32 v96, v73, v86
v_mfma_f32_16x16x32_bf16 a[80:83], v[244:247], v[164:167], a[80:83]
ds_read_b64_tr_b16 v[228:229], v20 offset:24576
v_fmac_f32 v96, v72, v87
v_mfma_f32_16x16x32_bf16 a[84:87], v[244:247], v[172:175], a[84:87]
v_mul_f32 v96, v96, v97
v_cvt_pk_bf16_f32 v103, v95, v96
v_mfma_f32_16x16x32_bf16 a[84:87], v[240:243], v[168:171], a[84:87]
ds_read_b64_tr_b16 v[230:231], v20 offset:25600
ds_write_b128 v28, v[100:103] offset:0
v_mfma_f32_16x16x32_bf16 a[88:91], v[240:243], v[176:179], a[88:91]
v_mul_f32 v95, v75, v83
v_lshlrev_b32 v97, 16, v59
v_mfma_f32_16x16x32_bf16 a[88:91], v[244:247], v[180:183], a[88:91]
v_fmac_f32 v95, v74, v84
v_fmac_f32 v95, v73, v85
v_mfma_f32_16x16x32_bf16 a[92:95], v[244:247], v[188:191], a[92:95]
v_fmac_f32 v95, v72, v86
v_mul_f32 v95, v95, v97
v_mfma_f32_16x16x32_bf16 a[92:95], v[240:243], v[184:187], a[92:95]
s_waitcnt lgkmcnt(5)
v_mul_f32 v96, v75, v82
v_lshlrev_b32 v97, 16, v58
v_mfma_f32_16x16x32_bf16 a[124:127], v[248:251], v[184:187], a[124:127]
ds_read_b64_tr_b16 v[232:233], v21 offset:16384
v_fmac_f32 v96, v74, v83
v_mfma_f32_16x16x32_bf16 a[124:127], v[252:255], v[188:191], a[124:127]
v_fmac_f32 v96, v73, v84
v_fmac_f32 v96, v72, v85
v_mfma_f32_16x16x32_bf16 a[120:123], v[252:255], v[180:183], a[120:123]
v_mul_f32 v96, v96, v97
v_cvt_pk_bf16_f32 v104, v95, v96
v_mfma_f32_16x16x32_bf16 a[120:123], v[248:251], v[176:179], a[120:123]
ds_read_b64_tr_b16 v[234:235], v21 offset:17408
v_mul_f32 v95, v75, v81
v_mfma_f32_16x16x32_bf16 a[116:119], v[248:251], v[168:171], a[116:119]
v_lshlrev_b32 v97, 16, v57
v_fmac_f32 v95, v74, v82
v_mfma_f32_16x16x32_bf16 a[116:119], v[252:255], v[172:175], a[116:119]
v_fmac_f32 v95, v73, v83
v_fmac_f32 v95, v72, v84
v_mfma_f32_16x16x32_bf16 a[112:115], v[252:255], v[164:167], a[112:115]
v_mul_f32 v95, v95, v97
v_mul_f32 v96, v75, v80
v_mfma_f32_16x16x32_bf16 a[112:115], v[248:251], v[160:163], a[112:115]
ds_read_b64_tr_b16 v[236:237], v21 offset:24576
v_lshlrev_b32 v97, 16, v56
v_mfma_f32_16x16x32_bf16 a[108:111], v[248:251], v[152:155], a[108:111]
v_fmac_f32 v96, v74, v81
v_fmac_f32 v96, v73, v82
v_mfma_f32_16x16x32_bf16 a[108:111], v[252:255], v[156:159], a[108:111]
v_fmac_f32 v96, v72, v83
v_mul_f32 v96, v96, v97
v_mfma_f32_16x16x32_bf16 a[104:107], v[252:255], v[148:151], a[104:107]
ds_read_b64_tr_b16 v[238:239], v21 offset:25600
v_cvt_pk_bf16_f32 v105, v95, v96
v_mfma_f32_16x16x32_bf16 a[104:107], v[248:251], v[144:147], a[104:107]
v_mul_f32 v95, v75, v79
v_lshlrev_b32 v97, 16, v55
v_mfma_f32_16x16x32_bf16 a[100:103], v[248:251], v[136:139], a[100:103]
v_fmac_f32 v95, v74, v80
v_fmac_f32 v95, v73, v81
v_mfma_f32_16x16x32_bf16 a[100:103], v[252:255], v[140:143], a[100:103]
v_fmac_f32 v95, v72, v82
v_mul_f32 v95, v95, v97
v_mfma_f32_16x16x32_bf16 a[96:99], v[252:255], v[132:135], a[96:99]
v_mul_f32 v96, v75, v78
v_lshlrev_b32 v97, 16, v54
v_mfma_f32_16x16x32_bf16 a[96:99], v[248:251], v[128:131], a[96:99]
s_waitcnt lgkmcnt(5)
v_fmac_f32 v96, v74, v79
v_fmac_f32 v96, v73, v80
v_mfma_f32_16x16x32_bf16 a[128:131], v[128:131], v[224:227], a[128:131]
ds_read_b64_tr_b16 v[240:241], v22 offset:16384
v_fmac_f32 v96, v72, v81
v_mfma_f32_16x16x32_bf16 a[128:131], v[132:135], v[228:231], a[128:131]
v_mul_f32 v96, v96, v97
v_cvt_pk_bf16_f32 v106, v95, v96
v_mfma_f32_16x16x32_bf16 a[132:135], v[140:143], v[228:231], a[132:135]
v_mul_f32 v95, v75, v77
v_lshlrev_b32 v97, 16, v53
v_mfma_f32_16x16x32_bf16 a[132:135], v[136:139], v[224:227], a[132:135]
ds_read_b64_tr_b16 v[242:243], v22 offset:17408
v_fmac_f32 v95, v74, v78
v_mfma_f32_16x16x32_bf16 a[136:139], v[144:147], v[224:227], a[136:139]
v_fmac_f32 v95, v73, v79
v_fmac_f32 v95, v72, v80
v_mfma_f32_16x16x32_bf16 a[136:139], v[148:151], v[228:231], a[136:139]
v_mul_f32 v95, v95, v97
v_mul_f32 v96, v75, v76
v_mfma_f32_16x16x32_bf16 a[140:143], v[156:159], v[228:231], a[140:143]
v_lshlrev_b32 v97, 16, v52
v_fmac_f32 v96, v74, v77
v_mfma_f32_16x16x32_bf16 a[140:143], v[152:155], v[224:227], a[140:143]
ds_read_b64_tr_b16 v[244:245], v22 offset:24576
v_fmac_f32 v96, v73, v78
v_mfma_f32_16x16x32_bf16 a[144:147], v[160:163], v[224:227], a[144:147]
v_fmac_f32 v96, v72, v79
v_mul_f32 v96, v96, v97
v_mfma_f32_16x16x32_bf16 a[144:147], v[164:167], v[228:231], a[144:147]
v_cvt_pk_bf16_f32 v107, v95, v96
v_mfma_f32_16x16x32_bf16 a[148:151], v[172:175], v[228:231], a[148:151]
ds_read_b64_tr_b16 v[246:247], v22 offset:25600
ds_write_b128 v28, v[104:107] offset:16
v_mfma_f32_16x16x32_bf16 a[148:151], v[168:171], v[224:227], a[148:151]
global_load_dwordx4 v[84:87], v1, s[56:57]
v_mfma_f32_16x16x32_bf16 a[152:155], v[176:179], v[224:227], a[152:155]
global_load_dwordx4 v[88:91], v1, s[56:57] offset:1024
v_mfma_f32_16x16x32_bf16 a[152:155], v[180:183], v[228:231], a[152:155]
v_lshlrev_b32 v72, 16, v70
v_and_b32 v73, 0xffff0000, v70
v_mfma_f32_16x16x32_bf16 a[156:159], v[188:191], v[228:231], a[156:159]
v_lshlrev_b32 v74, 16, v71
v_and_b32 v75, 0xffff0000, v71
v_mfma_f32_16x16x32_bf16 a[156:159], v[184:187], v[224:227], a[156:159]
s_waitcnt lgkmcnt(5)
v_and_b32 v33, 0xffff0000, v33
v_and_b32 v34, 0xffff0000, v34
v_mfma_f32_16x16x32_bf16 a[188:191], v[184:187], v[232:235], a[188:191]
ds_read_b64_tr_b16 v[248:249], v23 offset:16384
v_and_b32 v35, 0xffff0000, v35
v_mfma_f32_16x16x32_bf16 a[188:191], v[188:191], v[236:239], a[188:191]
v_and_b32 v36, 0xffff0000, v36
v_and_b32 v37, 0xffff0000, v37
v_mfma_f32_16x16x32_bf16 a[184:187], v[180:183], v[236:239], a[184:187]
ds_read_b64_tr_b16 v[250:251], v23 offset:17408
v_and_b32 v38, 0xffff0000, v38
v_mfma_f32_16x16x32_bf16 a[184:187], v[176:179], v[232:235], a[184:187]
v_and_b32 v39, 0xffff0000, v39
v_and_b32 v40, 0xffff0000, v40
v_mfma_f32_16x16x32_bf16 a[180:183], v[168:171], v[232:235], a[180:183]
ds_read_b64_tr_b16 v[252:253], v23 offset:24576
v_and_b32 v41, 0xffff0000, v41
v_mfma_f32_16x16x32_bf16 a[180:183], v[172:175], v[236:239], a[180:183]
v_and_b32 v42, 0xffff0000, v42
v_and_b32 v43, 0xffff0000, v43
v_mfma_f32_16x16x32_bf16 a[176:179], v[164:167], v[236:239], a[176:179]
ds_read_b64_tr_b16 v[254:255], v23 offset:25600
v_and_b32 v44, 0xffff0000, v44
v_mfma_f32_16x16x32_bf16 a[176:179], v[160:163], v[232:235], a[176:179]
v_and_b32 v45, 0xffff0000, v45
v_and_b32 v46, 0xffff0000, v46
v_mfma_f32_16x16x32_bf16 a[172:175], v[152:155], v[232:235], a[172:175]
v_and_b32 v47, 0xffff0000, v47
v_and_b32 v48, 0xffff0000, v48
v_mfma_f32_16x16x32_bf16 a[172:175], v[156:159], v[236:239], a[172:175]
v_and_b32 v49, 0xffff0000, v49
v_and_b32 v50, 0xffff0000, v50
v_mfma_f32_16x16x32_bf16 a[168:171], v[148:151], v[236:239], a[168:171]
v_and_b32 v51, 0xffff0000, v51
v_mul_f32 v95, v75, v48
v_mfma_f32_16x16x32_bf16 a[168:171], v[144:147], v[232:235], a[168:171]
v_and_b32 v97, 0xffff0000, v67
v_fmac_f32 v95, v74, v49
v_mfma_f32_16x16x32_bf16 a[164:167], v[136:139], v[232:235], a[164:167]
v_fmac_f32 v95, v73, v50
v_fmac_f32 v95, v72, v51
v_mfma_f32_16x16x32_bf16 a[164:167], v[140:143], v[236:239], a[164:167]
v_mul_f32 v95, v95, v97
v_mul_f32 v96, v75, v47
v_mfma_f32_16x16x32_bf16 a[160:163], v[132:135], v[236:239], a[160:163]
s_waitcnt vmcnt(6) lgkmcnt(0)
v_and_b32 v97, 0xffff0000, v66
v_fmac_f32 v96, v74, v48
v_mfma_f32_16x16x32_bf16 a[160:163], v[128:131], v[232:235], a[160:163]
s_barrier
v_fmac_f32 v96, v73, v49
v_fmac_f32 v96, v72, v50
v_mfma_f32_16x16x32_bf16 a[192:195], v[128:131], v[240:243], a[192:195]
s_and_b32 s73, s65, 1
ds_read_b64_tr_b16 v[224:225], v20 offset:32768
v_mul_f32 v96, v96, v97
v_mfma_f32_16x16x32_bf16 a[192:195], v[132:135], v[244:247], a[192:195]
s_xor_b32 s73, s73, 6
ds_read_b64_tr_b16 v[226:227], v20 offset:33792
v_cvt_pk_bf16_f32 v100, v95, v96
v_mfma_f32_16x16x32_bf16 a[196:199], v[140:143], v[244:247], a[196:199]
s_lshl_b32 s69, s73, 7
ds_read_b64_tr_b16 v[228:229], v20 offset:40960
v_mul_f32 v95, v75, v46
v_mfma_f32_16x16x32_bf16 a[196:199], v[136:139], v[240:243], a[196:199]
s_add_u32 s69, s69, s84
ds_read_b64_tr_b16 v[230:231], v20 offset:41984
v_and_b32 v97, 0xffff0000, v65
v_mfma_f32_16x16x32_bf16 a[200:203], v[144:147], v[240:243], a[200:203]
s_lshl_b32 s71, s73, 19
ds_read_b128 v[192:195], v24 offset:32768
v_fmac_f32 v95, v74, v47
v_mfma_f32_16x16x32_bf16 a[200:203], v[148:151], v[244:247], a[200:203]
s_add_u32 s71, s71, s66
ds_read_b128 v[196:199], v25 offset:32768
v_fmac_f32 v95, v73, v48
v_mfma_f32_16x16x32_bf16 a[204:207], v[156:159], v[244:247], a[204:207]
s_add_u32 m0, s63, 65536
v_fmac_f32 v95, v72, v49
v_mul_f32 v95, v95, v97
v_mfma_f32_16x16x32_bf16 a[204:207], v[152:155], v[240:243], a[204:207]
s_add_u32 s72, s69, 0
buffer_load_dwordx4 v2, s[8:11], s72 offen lds
v_mfma_f32_16x16x32_bf16 a[208:211], v[160:163], v[240:243], a[208:211]
s_add_u32 s72, s69, 7168
buffer_load_dwordx4 v3, s[8:11], s72 offen offset:1024 lds
v_mfma_f32_16x16x32_bf16 a[208:211], v[164:167], v[244:247], a[208:211]
s_add_u32 s72, s69, 14336
buffer_load_dwordx4 v2, s[8:11], s72 offen offset:2048 lds
v_mfma_f32_16x16x32_bf16 a[212:215], v[172:175], v[244:247], a[212:215]
ds_read_b128 v[200:203], v24 offset:34816
v_mul_f32 v96, v75, v45
v_mfma_f32_16x16x32_bf16 a[212:215], v[168:171], v[240:243], a[212:215]
ds_read_b128 v[204:207], v25 offset:34816
v_and_b32 v97, 0xffff0000, v64
v_mfma_f32_16x16x32_bf16 a[216:219], v[176:179], v[240:243], a[216:219]
s_add_u32 s72, s69, 21504
buffer_load_dwordx4 v3, s[8:11], s72 offen offset:3072 lds
v_mfma_f32_16x16x32_bf16 a[216:219], v[180:183], v[244:247], a[216:219]
ds_read_b128 v[208:211], v24 offset:36864
v_fmac_f32 v96, v74, v46
v_mfma_f32_16x16x32_bf16 a[220:223], v[188:191], v[244:247], a[220:223]
ds_read_b128 v[212:215], v25 offset:36864
v_fmac_f32 v96, v73, v47
v_mfma_f32_16x16x32_bf16 a[220:223], v[184:187], v[240:243], a[220:223]
ds_read_b128 v[216:219], v24 offset:38912
v_fmac_f32 v96, v72, v48
v_mfma_f32_16x16x32_bf16 a[252:255], v[184:187], v[248:251], a[252:255]
ds_read_b128 v[220:223], v25 offset:38912
v_mul_f32 v96, v96, v97
v_mfma_f32_16x16x32_bf16 a[252:255], v[188:191], v[252:255], a[252:255]
s_add_u32 m0, s64, 0
v_cvt_pk_bf16_f32 v101, v95, v96
v_mul_f32 v95, v75, v44
v_mfma_f32_16x16x32_bf16 a[248:251], v[180:183], v[252:255], a[248:251]
s_add_u32 s72, s71, 0
buffer_load_dwordx4 v6, s[16:19], s72 offen lds
v_mfma_f32_16x16x32_bf16 a[248:251], v[176:179], v[248:251], a[248:251]
ds_read_b128 v[184:187], v24 offset:40960
v_and_b32 v97, 0xffff0000, v63
v_mfma_f32_16x16x32_bf16 a[244:247], v[168:171], v[248:251], a[244:247]
ds_read_b128 v[188:191], v25 offset:40960
v_fmac_f32 v95, v74, v45
v_mfma_f32_16x16x32_bf16 a[244:247], v[172:175], v[252:255], a[244:247]
s_add_u32 s72, s71, 31744
buffer_load_dwordx4 v6, s[16:19], s72 offen offset:1024 lds
v_mfma_f32_16x16x32_bf16 a[240:243], v[164:167], v[252:255], a[240:243]
ds_read_b128 v[176:179], v24 offset:43008
v_fmac_f32 v95, v73, v46
v_mfma_f32_16x16x32_bf16 a[240:243], v[160:163], v[248:251], a[240:243]
ds_read_b128 v[180:183], v25 offset:43008
v_fmac_f32 v95, v72, v47
v_mfma_f32_16x16x32_bf16 a[236:239], v[152:155], v[248:251], a[236:239]
ds_read_b128 v[168:171], v24 offset:45056
v_mul_f32 v95, v95, v97
v_mfma_f32_16x16x32_bf16 a[236:239], v[156:159], v[252:255], a[236:239]
s_add_u32 s72, s71, 63488
buffer_load_dwordx4 v7, s[16:19], s72 offen offset:2048 lds
v_mfma_f32_16x16x32_bf16 a[232:235], v[148:151], v[252:255], a[232:235]
ds_read_b128 v[172:175], v25 offset:45056
v_mul_f32 v96, v75, v43
v_mfma_f32_16x16x32_bf16 a[232:235], v[144:147], v[248:251], a[232:235]
ds_read_b128 v[160:163], v24 offset:47104
v_and_b32 v97, 0xffff0000, v62
v_mfma_f32_16x16x32_bf16 a[228:231], v[136:139], v[248:251], a[228:231]
ds_read_b128 v[164:167], v25 offset:47104
v_fmac_f32 v96, v74, v44
v_mfma_f32_16x16x32_bf16 a[228:231], v[140:143], v[252:255], a[228:231]
v_fmac_f32 v96, v73, v45
v_fmac_f32 v96, v72, v46
v_mfma_f32_16x16x32_bf16 a[224:227], v[132:135], v[252:255], a[224:227]
s_add_u32 s72, s71, 95232
buffer_load_dwordx4 v7, s[16:19], s72 offen offset:3072 lds
v_mfma_f32_16x16x32_bf16 a[224:227], v[128:131], v[248:251], a[224:227]
s_waitcnt lgkmcnt(8)
ds_read_b64_tr_b16 v[232:233], v21 offset:32768
v_mul_f32 v96, v96, v97
v_mfma_f32_16x16x32_bf16 a[0:3], v[224:227], v[192:195], a[0:3]
ds_read_b64_tr_b16 v[234:235], v21 offset:33792
v_cvt_pk_bf16_f32 v102, v95, v96
v_mfma_f32_16x16x32_bf16 a[0:3], v[228:231], v[196:199], a[0:3]
ds_read_b64_tr_b16 v[240:241], v22 offset:32768
v_mul_f32 v95, v75, v42
v_mfma_f32_16x16x32_bf16 a[4:7], v[228:231], v[204:207], a[4:7]
s_add_u32 m0, s63, 69632
ds_read_b64_tr_b16 v[236:237], v21 offset:40960
v_and_b32 v97, 0xffff0000, v61
v_mfma_f32_16x16x32_bf16 a[4:7], v[224:227], v[200:203], a[4:7]
s_add_u32 s72, s69, 32768
buffer_load_dwordx4 v2, s[8:11], s72 offen lds
v_mfma_f32_16x16x32_bf16 a[8:11], v[224:227], v[208:211], a[8:11]
ds_read_b64_tr_b16 v[238:239], v21 offset:41984
v_fmac_f32 v95, v74, v43
v_mfma_f32_16x16x32_bf16 a[8:11], v[228:231], v[212:215], a[8:11]
v_fmac_f32 v95, v73, v44
v_fmac_f32 v95, v72, v45
v_mfma_f32_16x16x32_bf16 a[12:15], v[228:231], v[220:223], a[12:15]
s_add_u32 s72, s69, 39936
buffer_load_dwordx4 v3, s[8:11], s72 offen offset:1024 lds
v_mfma_f32_16x16x32_bf16 a[12:15], v[224:227], v[216:219], a[12:15]
s_waitcnt lgkmcnt(5)
ds_read_b64_tr_b16 v[242:243], v22 offset:33792
v_mul_f32 v95, v95, v97
v_mfma_f32_16x16x32_bf16 a[16:19], v[224:227], v[184:187], a[16:19]
v_mul_f32 v96, v75, v41
v_and_b32 v97, 0xffff0000, v60
v_mfma_f32_16x16x32_bf16 a[16:19], v[228:231], v[188:191], a[16:19]
ds_read_b64_tr_b16 v[244:245], v22 offset:40960
v_fmac_f32 v96, v74, v42
v_mfma_f32_16x16x32_bf16 a[20:23], v[228:231], v[180:183], a[20:23]
v_fmac_f32 v96, v73, v43
v_fmac_f32 v96, v72, v44
v_mfma_f32_16x16x32_bf16 a[20:23], v[224:227], v[176:179], a[20:23]
s_add_u32 s72, s69, 47104
buffer_load_dwordx4 v2, s[8:11], s72 offen offset:2048 lds
v_mfma_f32_16x16x32_bf16 a[24:27], v[224:227], v[168:171], a[24:27]
ds_read_b64_tr_b16 v[246:247], v22 offset:41984
v_mul_f32 v96, v96, v97
v_mfma_f32_16x16x32_bf16 a[24:27], v[228:231], v[172:175], a[24:27]
v_cvt_pk_bf16_f32 v103, v95, v96
v_mfma_f32_16x16x32_bf16 a[28:31], v[228:231], v[164:167], a[28:31]
ds_write_b128 v28, v[100:103] offset:272
v_mul_f32 v95, v75, v40
v_mfma_f32_16x16x32_bf16 a[28:31], v[224:227], v[160:163], a[28:31]
s_waitcnt lgkmcnt(4)
v_and_b32 v97, 0xffff0000, v59
v_fmac_f32 v95, v74, v41
v_mfma_f32_16x16x32_bf16 a[60:63], v[232:235], v[160:163], a[60:63]
s_add_u32 s72, s69, 54272
buffer_load_dwordx4 v3, s[8:11], s72 offen offset:3072 lds
v_mfma_f32_16x16x32_bf16 a[60:63], v[236:239], v[164:167], a[60:63]
ds_read_b64_tr_b16 v[248:249], v23 offset:32768
v_fmac_f32 v95, v73, v42
v_mfma_f32_16x16x32_bf16 a[56:59], v[236:239], v[172:175], a[56:59]
v_fmac_f32 v95, v72, v43
v_mul_f32 v95, v95, v97
v_mfma_f32_16x16x32_bf16 a[56:59], v[232:235], v[168:171], a[56:59]
s_add_u32 m0, s64, 16384
ds_read_b64_tr_b16 v[250:251], v23 offset:33792
v_mul_f32 v96, v75, v39
v_mfma_f32_16x16x32_bf16 a[52:55], v[232:235], v[176:179], a[52:55]
s_add_u32 s72, s71, 0
buffer_load_dwordx4 v6, s[20:23], s72 offen lds
v_mfma_f32_16x16x32_bf16 a[52:55], v[236:239], v[180:183], a[52:55]
v_and_b32 v97, 0xffff0000, v58
v_fmac_f32 v96, v74, v40
v_mfma_f32_16x16x32_bf16 a[48:51], v[236:239], v[188:191], a[48:51]
v_fmac_f32 v96, v73, v41
v_fmac_f32 v96, v72, v42
v_mfma_f32_16x16x32_bf16 a[48:51], v[232:235], v[184:187], a[48:51]
ds_read_b64_tr_b16 v[252:253], v23 offset:40960
v_mul_f32 v96, v96, v97
v_mfma_f32_16x16x32_bf16 a[44:47], v[232:235], v[216:219], a[44:47]
s_add_u32 s72, s71, 31744
buffer_load_dwordx4 v6, s[20:23], s72 offen offset:1024 lds
v_mfma_f32_16x16x32_bf16 a[44:47], v[236:239], v[220:223], a[44:47]
v_cvt_pk_bf16_f32 v104, v95, v96
v_mul_f32 v95, v75, v38
v_mfma_f32_16x16x32_bf16 a[40:43], v[236:239], v[212:215], a[40:43]
ds_read_b64_tr_b16 v[254:255], v23 offset:41984
v_and_b32 v97, 0xffff0000, v57
v_mfma_f32_16x16x32_bf16 a[40:43], v[232:235], v[208:211], a[40:43]
v_fmac_f32 v95, v74, v39
v_fmac_f32 v95, v73, v40
v_mfma_f32_16x16x32_bf16 a[36:39], v[232:235], v[200:203], a[36:39]
s_add_u32 s72, s71, 63488
buffer_load_dwordx4 v7, s[20:23], s72 offen offset:2048 lds
v_mfma_f32_16x16x32_bf16 a[36:39], v[236:239], v[204:207], a[36:39]
v_fmac_f32 v95, v72, v41
v_mul_f32 v95, v95, v97
v_mfma_f32_16x16x32_bf16 a[32:35], v[236:239], v[196:199], a[32:35]
v_mul_f32 v96, v75, v37
v_and_b32 v97, 0xffff0000, v56
v_mfma_f32_16x16x32_bf16 a[32:35], v[232:235], v[192:195], a[32:35]
s_waitcnt lgkmcnt(5)
v_fmac_f32 v96, v74, v38
v_fmac_f32 v96, v73, v39
v_mfma_f32_16x16x32_bf16 a[64:67], v[240:243], v[192:195], a[64:67]
s_add_u32 s72, s71, 95232
buffer_load_dwordx4 v7, s[20:23], s72 offen offset:3072 lds
v_mfma_f32_16x16x32_bf16 a[64:67], v[244:247], v[196:199], a[64:67]
s_mov_b32 s80, 0x400000
buffer_load_dword v126, v125, s[12:15], s80 offen
v_mfma_f32_16x16x32_bf16 a[68:71], v[244:247], v[204:207], a[68:71]
s_mov_b32 s80, 0x500000
buffer_load_dword v126, v125, s[12:15], s80 offen
v_mfma_f32_16x16x32_bf16 a[68:71], v[240:243], v[200:203], a[68:71]
s_mov_b32 s80, 0x600000
buffer_load_dword v126, v125, s[12:15], s80 offen
v_mfma_f32_16x16x32_bf16 a[72:75], v[240:243], v[208:211], a[72:75]
s_mov_b32 s80, 0x700000
buffer_load_dword v126, v125, s[12:15], s80 offen
v_mfma_f32_16x16x32_bf16 a[72:75], v[244:247], v[212:215], a[72:75]
ds_read_b64_tr_b16 v[224:225], v20 offset:49152
v_fmac_f32 v96, v72, v40
v_mfma_f32_16x16x32_bf16 a[76:79], v[244:247], v[220:223], a[76:79]
v_mul_f32 v96, v96, v97
v_cvt_pk_bf16_f32 v105, v95, v96
v_mfma_f32_16x16x32_bf16 a[76:79], v[240:243], v[216:219], a[76:79]
ds_read_b64_tr_b16 v[226:227], v20 offset:50176
v_mul_f32 v95, v75, v36
v_mfma_f32_16x16x32_bf16 a[80:83], v[240:243], v[184:187], a[80:83]
v_and_b32 v97, 0xffff0000, v55
v_fmac_f32 v95, v74, v37
v_mfma_f32_16x16x32_bf16 a[80:83], v[244:247], v[188:191], a[80:83]
ds_read_b64_tr_b16 v[228:229], v20 offset:57344
v_fmac_f32 v95, v73, v38
v_mfma_f32_16x16x32_bf16 a[84:87], v[244:247], v[180:183], a[84:87]
v_fmac_f32 v95, v72, v39
v_mul_f32 v95, v95, v97
v_mfma_f32_16x16x32_bf16 a[84:87], v[240:243], v[176:179], a[84:87]
ds_read_b64_tr_b16 v[230:231], v20 offset:58368
v_mul_f32 v96, v75, v35
v_mfma_f32_16x16x32_bf16 a[88:91], v[240:243], v[168:171], a[88:91]
v_and_b32 v97, 0xffff0000, v54
v_fmac_f32 v96, v74, v36
v_mfma_f32_16x16x32_bf16 a[88:91], v[244:247], v[172:175], a[88:91]
v_fmac_f32 v96, v73, v37
v_fmac_f32 v96, v72, v38
v_mfma_f32_16x16x32_bf16 a[92:95], v[244:247], v[164:167], a[92:95]
v_mul_f32 v96, v96, v97
v_cvt_pk_bf16_f32 v106, v95, v96
v_mfma_f32_16x16x32_bf16 a[92:95], v[240:243], v[160:163], a[92:95]
s_waitcnt lgkmcnt(4)
v_mul_f32 v95, v75, v34
v_and_b32 v97, 0xffff0000, v53
v_mfma_f32_16x16x32_bf16 a[124:127], v[248:251], v[160:163], a[124:127]
ds_read_b64_tr_b16 v[232:233], v21 offset:49152
v_fmac_f32 v95, v74, v35
v_mfma_f32_16x16x32_bf16 a[124:127], v[252:255], v[164:167], a[124:127]
v_fmac_f32 v95, v73, v36
v_fmac_f32 v95, v72, v37
v_mfma_f32_16x16x32_bf16 a[120:123], v[252:255], v[172:175], a[120:123]
v_mul_f32 v95, v95, v97
v_mul_f32 v96, v75, v33
v_mfma_f32_16x16x32_bf16 a[120:123], v[248:251], v[168:171], a[120:123]
ds_read_b64_tr_b16 v[234:235], v21 offset:50176
v_and_b32 v97, 0xffff0000, v52
v_mfma_f32_16x16x32_bf16 a[116:119], v[248:251], v[176:179], a[116:119]
v_fmac_f32 v96, v74, v34
v_fmac_f32 v96, v73, v35
v_mfma_f32_16x16x32_bf16 a[116:119], v[252:255], v[180:183], a[116:119]
v_fmac_f32 v96, v72, v36
v_mul_f32 v96, v96, v97
v_mfma_f32_16x16x32_bf16 a[112:115], v[252:255], v[188:191], a[112:115]
v_cvt_pk_bf16_f32 v107, v95, v96
v_mfma_f32_16x16x32_bf16 a[112:115], v[248:251], v[184:187], a[112:115]
ds_read_b64_tr_b16 v[236:237], v21 offset:57344
ds_write_b128 v28, v[104:107] offset:288
v_mfma_f32_16x16x32_bf16 a[108:111], v[248:251], v[216:219], a[108:111]
v_mfma_f32_16x16x32_bf16 a[108:111], v[252:255], v[220:223], a[108:111]
v_mfma_f32_16x16x32_bf16 a[104:107], v[252:255], v[212:215], a[104:107]
ds_read_b64_tr_b16 v[238:239], v21 offset:58368
v_mfma_f32_16x16x32_bf16 a[104:107], v[248:251], v[208:211], a[104:107]
v_mfma_f32_16x16x32_bf16 a[100:103], v[248:251], v[200:203], a[100:103]
v_mfma_f32_16x16x32_bf16 a[100:103], v[252:255], v[204:207], a[100:103]
v_mfma_f32_16x16x32_bf16 a[96:99], v[252:255], v[196:199], a[96:99]
v_mfma_f32_16x16x32_bf16 a[96:99], v[248:251], v[192:195], a[96:99]
s_waitcnt lgkmcnt(5)
v_mfma_f32_16x16x32_bf16 a[128:131], v[192:195], v[224:227], a[128:131]
ds_read_b64_tr_b16 v[240:241], v22 offset:49152
v_mfma_f32_16x16x32_bf16 a[128:131], v[196:199], v[228:231], a[128:131]
v_mfma_f32_16x16x32_bf16 a[132:135], v[204:207], v[228:231], a[132:135]
v_mfma_f32_16x16x32_bf16 a[132:135], v[200:203], v[224:227], a[132:135]
ds_read_b64_tr_b16 v[242:243], v22 offset:50176
v_mfma_f32_16x16x32_bf16 a[136:139], v[208:211], v[224:227], a[136:139]
v_mfma_f32_16x16x32_bf16 a[136:139], v[212:215], v[228:231], a[136:139]
v_mfma_f32_16x16x32_bf16 a[140:143], v[220:223], v[228:231], a[140:143]
v_mfma_f32_16x16x32_bf16 a[140:143], v[216:219], v[224:227], a[140:143]
ds_read_b64_tr_b16 v[244:245], v22 offset:57344
v_mfma_f32_16x16x32_bf16 a[144:147], v[184:187], v[224:227], a[144:147]
v_mfma_f32_16x16x32_bf16 a[144:147], v[188:191], v[228:231], a[144:147]
v_mfma_f32_16x16x32_bf16 a[148:151], v[180:183], v[228:231], a[148:151]
ds_read_b64_tr_b16 v[246:247], v22 offset:58368
v_mfma_f32_16x16x32_bf16 a[148:151], v[176:179], v[224:227], a[148:151]
v_mfma_f32_16x16x32_bf16 a[152:155], v[168:171], v[224:227], a[152:155]
v_mfma_f32_16x16x32_bf16 a[152:155], v[172:175], v[228:231], a[152:155]
v_mfma_f32_16x16x32_bf16 a[156:159], v[164:167], v[228:231], a[156:159]
v_mfma_f32_16x16x32_bf16 a[156:159], v[160:163], v[224:227], a[156:159]
s_waitcnt lgkmcnt(4)
v_mfma_f32_16x16x32_bf16 a[188:191], v[160:163], v[232:235], a[188:191]
ds_read_b64_tr_b16 v[248:249], v23 offset:49152
v_mfma_f32_16x16x32_bf16 a[188:191], v[164:167], v[236:239], a[188:191]
v_mfma_f32_16x16x32_bf16 a[184:187], v[172:175], v[236:239], a[184:187]
ds_read_b64_tr_b16 v[250:251], v23 offset:50176
v_mfma_f32_16x16x32_bf16 a[184:187], v[168:171], v[232:235], a[184:187]
v_mfma_f32_16x16x32_bf16 a[180:183], v[176:179], v[232:235], a[180:183]
ds_read_b64_tr_b16 v[252:253], v23 offset:57344
v_mfma_f32_16x16x32_bf16 a[180:183], v[180:183], v[236:239], a[180:183]
v_mfma_f32_16x16x32_bf16 a[176:179], v[188:191], v[236:239], a[176:179]
ds_read_b64_tr_b16 v[254:255], v23 offset:58368
v_mfma_f32_16x16x32_bf16 a[176:179], v[184:187], v[232:235], a[176:179]
v_mfma_f32_16x16x32_bf16 a[172:175], v[216:219], v[232:235], a[172:175]
v_mfma_f32_16x16x32_bf16 a[172:175], v[220:223], v[236:239], a[172:175]
v_mfma_f32_16x16x32_bf16 a[168:171], v[212:215], v[236:239], a[168:171]
v_mfma_f32_16x16x32_bf16 a[168:171], v[208:211], v[232:235], a[168:171]
v_mfma_f32_16x16x32_bf16 a[164:167], v[200:203], v[232:235], a[164:167]
v_mfma_f32_16x16x32_bf16 a[164:167], v[204:207], v[236:239], a[164:167]
v_mfma_f32_16x16x32_bf16 a[160:163], v[196:199], v[236:239], a[160:163]
s_waitcnt vmcnt(4) lgkmcnt(0)
v_mfma_f32_16x16x32_bf16 a[160:163], v[192:195], v[232:235], a[160:163]
s_barrier
v_mfma_f32_16x16x32_bf16 a[192:195], v[192:195], v[240:243], a[192:195]
s_and_b32 s73, s65, 1
ds_read_b64_tr_b16 v[224:225], v20 offset:0
v_mfma_f32_16x16x32_bf16 a[192:195], v[196:199], v[244:247], a[192:195]
s_xor_b32 s73, s73, 7
ds_read_b64_tr_b16 v[226:227], v20 offset:1024
v_mfma_f32_16x16x32_bf16 a[196:199], v[204:207], v[244:247], a[196:199]
s_lshl_b32 s69, s73, 7
ds_read_b64_tr_b16 v[228:229], v20 offset:8192
v_mfma_f32_16x16x32_bf16 a[196:199], v[200:203], v[240:243], a[196:199]
s_add_u32 s69, s69, s84
ds_read_b64_tr_b16 v[230:231], v20 offset:9216
v_mfma_f32_16x16x32_bf16 a[200:203], v[208:211], v[240:243], a[200:203]
s_lshl_b32 s71, s73, 19
ds_read_b128 v[128:131], v24 offset:0
v_mfma_f32_16x16x32_bf16 a[200:203], v[212:215], v[244:247], a[200:203]
s_add_u32 s71, s71, s66
ds_read_b128 v[132:135], v25 offset:0
v_mfma_f32_16x16x32_bf16 a[204:207], v[220:223], v[244:247], a[204:207]
s_add_u32 m0, s63, 98304
v_mfma_f32_16x16x32_bf16 a[204:207], v[216:219], v[240:243], a[204:207]
s_add_u32 s72, s69, 0
buffer_load_dwordx4 v2, s[8:11], s72 offen lds
v_mfma_f32_16x16x32_bf16 a[208:211], v[184:187], v[240:243], a[208:211]
s_add_u32 s72, s69, 7168
buffer_load_dwordx4 v3, s[8:11], s72 offen offset:1024 lds
v_mfma_f32_16x16x32_bf16 a[208:211], v[188:191], v[244:247], a[208:211]
s_add_u32 s72, s69, 14336
buffer_load_dwordx4 v2, s[8:11], s72 offen offset:2048 lds
v_mfma_f32_16x16x32_bf16 a[212:215], v[180:183], v[244:247], a[212:215]
s_add_u32 s74, s63, 131072
ds_read_b128 v[136:139], v24 offset:2048
v_lshrrev_b32 v26, 4, v0
v_mfma_f32_16x16x32_bf16 a[212:215], v[176:179], v[240:243], a[212:215]
ds_read_b128 v[140:143], v25 offset:2048
v_and_b32 v27, 15, v0
v_mfma_f32_16x16x32_bf16 a[216:219], v[168:171], v[240:243], a[216:219]
s_add_u32 s72, s69, 21504
buffer_load_dwordx4 v3, s[8:11], s72 offen offset:3072 lds
v_mfma_f32_16x16x32_bf16 a[216:219], v[172:175], v[244:247], a[216:219]
ds_read_b128 v[144:147], v24 offset:4096
v_lshlrev_b32 v27, 4, v27
v_mfma_f32_16x16x32_bf16 a[220:223], v[164:167], v[244:247], a[220:223]
ds_read_b128 v[148:151], v25 offset:4096
v_mul_u32_u24 v28, 272, v26
v_mfma_f32_16x16x32_bf16 a[220:223], v[160:163], v[240:243], a[220:223]
ds_read_b128 v[152:155], v24 offset:6144
v_add3_u32 v28, v28, v27, s74
v_mfma_f32_16x16x32_bf16 a[252:255], v[160:163], v[248:251], a[252:255]
ds_read_b128 v[156:159], v25 offset:6144
v_lshl_add_u32 v26, v26, 12, v27
v_mfma_f32_16x16x32_bf16 a[252:255], v[164:167], v[252:255], a[252:255]
s_add_u32 m0, s64, 32768
ds_read_b128 v[36:39], v28 offset:0
ds_read_b128 v[40:43], v28 offset:1088
v_mfma_f32_16x16x32_bf16 a[248:251], v[172:175], v[252:255], a[248:251]
s_add_u32 s72, s71, 0
buffer_load_dwordx4 v6, s[16:19], s72 offen lds
v_mfma_f32_16x16x32_bf16 a[248:251], v[168:171], v[248:251], a[248:251]
ds_read_b128 v[160:163], v24 offset:8192
ds_read_b128 v[44:47], v28 offset:2176
v_mfma_f32_16x16x32_bf16 a[244:247], v[176:179], v[248:251], a[244:247]
ds_read_b128 v[164:167], v25 offset:8192
ds_read_b128 v[48:51], v28 offset:3264
v_mfma_f32_16x16x32_bf16 a[244:247], v[180:183], v[252:255], a[244:247]
s_add_u32 s72, s71, 31744
buffer_load_dwordx4 v6, s[16:19], s72 offen offset:1024 lds
v_mfma_f32_16x16x32_bf16 a[240:243], v[188:191], v[252:255], a[240:243]
s_xor_b32 s74, s2, 5
ds_read_b128 v[168:171], v24 offset:10240
v_mfma_f32_16x16x32_bf16 a[240:243], v[184:187], v[248:251], a[240:243]
s_and_b32 s74, s74, 15
ds_read_b128 v[172:175], v25 offset:10240
v_mfma_f32_16x16x32_bf16 a[236:239], v[216:219], v[248:251], a[236:239]
s_lshl_b32 s74, s74, 2
ds_read_b128 v[176:179], v24 offset:12288
v_mfma_f32_16x16x32_bf16 a[236:239], v[220:223], v[252:255], a[236:239]
s_add_u32 s72, s71, 63488
buffer_load_dwordx4 v7, s[16:19], s72 offen offset:2048 lds
v_mfma_f32_16x16x32_bf16 a[232:235], v[212:215], v[252:255], a[232:235]
s_add_u32 s74, s74, s58
ds_read_b128 v[180:183], v25 offset:12288
v_mfma_f32_16x16x32_bf16 a[232:235], v[208:211], v[248:251], a[232:235]
s_lshl_b32 s74, s74, 16
ds_read_b128 v[184:187], v24 offset:14336
v_mfma_f32_16x16x32_bf16 a[228:231], v[200:203], v[248:251], a[228:231]
s_lshr_b32 s75, s2, 4
ds_read_b128 v[188:191], v25 offset:14336
v_mfma_f32_16x16x32_bf16 a[228:231], v[204:207], v[252:255], a[228:231]
s_lshl_b32 s75, s75, 8
v_mfma_f32_16x16x32_bf16 a[224:227], v[196:199], v[252:255], a[224:227]
s_add_u32 s72, s71, 95232
buffer_load_dwordx4 v7, s[16:19], s72 offen offset:3072 lds
v_mfma_f32_16x16x32_bf16 a[224:227], v[192:195], v[248:251], a[224:227]
s_waitcnt lgkmcnt(12)
ds_read_b64_tr_b16 v[232:233], v21 offset:0
v_mfma_f32_16x16x32_bf16 a[0:3], v[224:227], v[128:131], a[0:3]
s_sub_u32 s74, s74, s75
ds_read_b64_tr_b16 v[234:235], v21 offset:1024
v_mfma_f32_16x16x32_bf16 a[0:3], v[228:231], v[132:135], a[0:3]
s_add_u32 s74, s74, 0x3000f00
ds_read_b64_tr_b16 v[240:241], v22 offset:0
v_mfma_f32_16x16x32_bf16 a[4:7], v[228:231], v[140:143], a[4:7]
s_add_u32 m0, s63, 102400
ds_read_b64_tr_b16 v[236:237], v21 offset:8192
v_mfma_f32_16x16x32_bf16 a[4:7], v[224:227], v[136:139], a[4:7]
s_add_u32 s72, s69, 32768
buffer_load_dwordx4 v2, s[8:11], s72 offen lds
v_mfma_f32_16x16x32_bf16 a[8:11], v[224:227], v[144:147], a[8:11]
s_waitcnt vmcnt(29)
ds_read_b64_tr_b16 v[238:239], v21 offset:9216
v_lshlrev_b32 v78, 16, v84
v_mfma_f32_16x16x32_bf16 a[8:11], v[228:231], v[148:151], a[8:11]
v_lshlrev_b32 v79, 16, v108
v_mul_f32 v76, v78, v79
v_mfma_f32_16x16x32_bf16 a[12:15], v[228:231], v[156:159], a[12:15]
s_add_u32 s72, s69, 39936
buffer_load_dwordx4 v3, s[8:11], s72 offen offset:1024 lds
v_mfma_f32_16x16x32_bf16 a[12:15], v[224:227], v[152:155], a[12:15]
s_waitcnt lgkmcnt(5)
ds_read_b64_tr_b16 v[242:243], v22 offset:1024
v_lshlrev_b32 v80, 16, v116
v_mfma_f32_16x16x32_bf16 a[16:19], v[224:227], v[160:163], a[16:19]
v_mul_f32 v77, v78, v80
v_and_b32 v78, 0xffff0000, v84
v_mfma_f32_16x16x32_bf16 a[16:19], v[228:231], v[164:167], a[16:19]
ds_read_b64_tr_b16 v[244:245], v22 offset:8192
v_and_b32 v79, 0xffff0000, v108
v_mfma_f32_16x16x32_bf16 a[20:23], v[228:231], v[172:175], a[20:23]
v_fmac_f32 v76, v78, v79
v_and_b32 v80, 0xffff0000, v116
v_mfma_f32_16x16x32_bf16 a[20:23], v[224:227], v[168:171], a[20:23]
s_add_u32 s72, s69, 47104
buffer_load_dwordx4 v2, s[8:11], s72 offen offset:2048 lds
v_mfma_f32_16x16x32_bf16 a[24:27], v[224:227], v[176:179], a[24:27]
ds_read_b64_tr_b16 v[246:247], v22 offset:9216
v_fmac_f32 v77, v78, v80
v_mfma_f32_16x16x32_bf16 a[24:27], v[228:231], v[180:183], a[24:27]
v_lshlrev_b32 v78, 16, v85
v_lshlrev_b32 v79, 16, v109
v_mfma_f32_16x16x32_bf16 a[28:31], v[228:231], v[188:191], a[28:31]
v_fmac_f32 v76, v78, v79
v_lshlrev_b32 v80, 16, v117
v_mfma_f32_16x16x32_bf16 a[28:31], v[224:227], v[184:187], a[28:31]
s_waitcnt lgkmcnt(3)
v_fmac_f32 v77, v78, v80
v_and_b32 v78, 0xffff0000, v85
v_mfma_f32_16x16x32_bf16 a[60:63], v[232:235], v[184:187], a[60:63]
s_add_u32 s72, s69, 54272
buffer_load_dwordx4 v3, s[8:11], s72 offen offset:3072 lds
v_mfma_f32_16x16x32_bf16 a[60:63], v[236:239], v[188:191], a[60:63]
ds_read_b64_tr_b16 v[248:249], v23 offset:0
v_and_b32 v79, 0xffff0000, v109
v_mfma_f32_16x16x32_bf16 a[56:59], v[236:239], v[180:183], a[56:59]
v_fmac_f32 v76, v78, v79
v_and_b32 v80, 0xffff0000, v117
v_mfma_f32_16x16x32_bf16 a[56:59], v[232:235], v[176:179], a[56:59]
s_add_u32 m0, s64, 49152
ds_read_b64_tr_b16 v[250:251], v23 offset:1024
v_fmac_f32 v77, v78, v80
v_mfma_f32_16x16x32_bf16 a[52:55], v[232:235], v[168:171], a[52:55]
s_add_u32 s72, s71, 0
buffer_load_dwordx4 v6, s[20:23], s72 offen lds
v_mfma_f32_16x16x32_bf16 a[52:55], v[236:239], v[172:175], a[52:55]
v_lshlrev_b32 v78, 16, v86
v_lshlrev_b32 v79, 16, v110
v_mfma_f32_16x16x32_bf16 a[48:51], v[236:239], v[164:167], a[48:51]
v_fmac_f32 v76, v78, v79
v_lshlrev_b32 v80, 16, v118
v_mfma_f32_16x16x32_bf16 a[48:51], v[232:235], v[160:163], a[48:51]
ds_read_b64_tr_b16 v[252:253], v23 offset:8192
v_fmac_f32 v77, v78, v80
v_mfma_f32_16x16x32_bf16 a[44:47], v[232:235], v[152:155], a[44:47]
s_add_u32 s72, s71, 31744
buffer_load_dwordx4 v6, s[20:23], s72 offen offset:1024 lds
v_mfma_f32_16x16x32_bf16 a[44:47], v[236:239], v[156:159], a[44:47]
v_and_b32 v78, 0xffff0000, v86
v_and_b32 v79, 0xffff0000, v110
v_mfma_f32_16x16x32_bf16 a[40:43], v[236:239], v[148:151], a[40:43]
ds_read_b64_tr_b16 v[254:255], v23 offset:9216
v_fmac_f32 v76, v78, v79
v_mfma_f32_16x16x32_bf16 a[40:43], v[232:235], v[144:147], a[40:43]
v_and_b32 v80, 0xffff0000, v118
v_fmac_f32 v77, v78, v80
v_mfma_f32_16x16x32_bf16 a[36:39], v[232:235], v[136:139], a[36:39]
s_add_u32 s72, s71, 63488
buffer_load_dwordx4 v7, s[20:23], s72 offen offset:2048 lds
v_mfma_f32_16x16x32_bf16 a[36:39], v[236:239], v[140:143], a[36:39]
v_lshlrev_b32 v78, 16, v87
v_lshlrev_b32 v79, 16, v111
v_mfma_f32_16x16x32_bf16 a[32:35], v[236:239], v[132:135], a[32:35]
v_fmac_f32 v76, v78, v79
v_lshlrev_b32 v80, 16, v119
v_mfma_f32_16x16x32_bf16 a[32:35], v[232:235], v[128:131], a[32:35]
s_waitcnt lgkmcnt(4)
v_fmac_f32 v77, v78, v80
v_and_b32 v78, 0xffff0000, v87
v_mfma_f32_16x16x32_bf16 a[64:67], v[240:243], v[128:131], a[64:67]
s_add_u32 s72, s71, 95232
buffer_load_dwordx4 v7, s[20:23], s72 offen offset:3072 lds
v_mfma_f32_16x16x32_bf16 a[64:67], v[244:247], v[132:135], a[64:67]
s_waitcnt lgkmcnt(15)
ds_read_b64_tr_b16 v[224:225], v20 offset:16384
v_and_b32 v79, 0xffff0000, v111
v_mfma_f32_16x16x32_bf16 a[68:71], v[244:247], v[140:143], a[68:71]
s_add_u32 s73, s62, 0
v_fmac_f32 v76, v78, v79
v_and_b32 v80, 0xffff0000, v119
v_mfma_f32_16x16x32_bf16 a[68:71], v[240:243], v[136:139], a[68:71]
s_add_u32 s70, s73, s65
ds_read_b64_tr_b16 v[226:227], v20 offset:17408
v_fmac_f32 v77, v78, v80
v_mfma_f32_16x16x32_bf16 a[72:75], v[240:243], v[144:147], a[72:75]
s_and_b32 s70, s70, 3
v_lshlrev_b32 v78, 16, v88
v_lshlrev_b32 v79, 16, v112
v_mfma_f32_16x16x32_bf16 a[72:75], v[244:247], v[148:151], a[72:75]
s_and_b32 s73, s73, 12
v_fmac_f32 v76, v78, v79
v_lshlrev_b32 v80, 16, v120
v_mfma_f32_16x16x32_bf16 a[76:79], v[244:247], v[156:159], a[76:79]
s_or_b32 s73, s73, s70
ds_read_b64_tr_b16 v[228:229], v20 offset:24576
v_fmac_f32 v77, v78, v80
v_mfma_f32_16x16x32_bf16 a[76:79], v[240:243], v[152:155], a[76:79]
s_lshl_b32 s73, s73, 7
v_and_b32 v78, 0xffff0000, v88
v_and_b32 v79, 0xffff0000, v112
v_mfma_f32_16x16x32_bf16 a[80:83], v[240:243], v[160:163], a[80:83]
s_add_u32 s69, s73, s67
ds_read_b64_tr_b16 v[230:231], v20 offset:25600
v_fmac_f32 v76, v78, v79
v_mfma_f32_16x16x32_bf16 a[80:83], v[244:247], v[164:167], a[80:83]
s_add_u32 s70, s73, s68
v_and_b32 v80, 0xffff0000, v120
v_fmac_f32 v77, v78, v80
v_mfma_f32_16x16x32_bf16 a[84:87], v[244:247], v[172:175], a[84:87]
s_add_u32 m0, s63, 131072
v_lshlrev_b32 v78, 16, v89
v_lshlrev_b32 v79, 16, v113
v_mfma_f32_16x16x32_bf16 a[84:87], v[240:243], v[168:171], a[84:87]
s_add_u32 s72, s69, 0
buffer_load_dwordx4 v4, s[4:7], s72 offen lds
v_mfma_f32_16x16x32_bf16 a[88:91], v[240:243], v[176:179], a[88:91]
s_add_u32 s72, s69, 15360
buffer_load_dwordx4 v5, s[4:7], s72 offen offset:1024 lds
v_mfma_f32_16x16x32_bf16 a[88:91], v[244:247], v[180:183], a[88:91]
s_add_u32 s72, s69, 129024
buffer_load_dwordx4 v4, s[4:7], s72 offen offset:2048 lds
v_mfma_f32_16x16x32_bf16 a[92:95], v[244:247], v[188:191], a[92:95]
s_add_u32 s72, s69, 144384
buffer_load_dwordx4 v5, s[4:7], s72 offen offset:3072 lds
v_mfma_f32_16x16x32_bf16 a[92:95], v[240:243], v[184:187], a[92:95]
s_waitcnt lgkmcnt(4)
v_fmac_f32 v76, v78, v79
v_lshlrev_b32 v80, 16, v121
v_mfma_f32_16x16x32_bf16 a[124:127], v[248:251], v[184:187], a[124:127]
ds_read_b64_tr_b16 v[232:233], v21 offset:16384
v_fmac_f32 v77, v78, v80
v_mfma_f32_16x16x32_bf16 a[124:127], v[252:255], v[188:191], a[124:127]
v_and_b32 v78, 0xffff0000, v89
v_and_b32 v79, 0xffff0000, v113
v_mfma_f32_16x16x32_bf16 a[120:123], v[252:255], v[180:183], a[120:123]
ds_read_b64_tr_b16 v[234:235], v21 offset:17408
v_fmac_f32 v76, v78, v79
v_mfma_f32_16x16x32_bf16 a[120:123], v[248:251], v[176:179], a[120:123]
s_add_u32 m0, s63, 135168
v_and_b32 v80, 0xffff0000, v121
v_fmac_f32 v77, v78, v80
v_mfma_f32_16x16x32_bf16 a[116:119], v[248:251], v[168:171], a[116:119]
s_add_u32 s72, s70, 0
buffer_load_dwordx4 v4, s[4:7], s72 offen lds
v_mfma_f32_16x16x32_bf16 a[116:119], v[252:255], v[172:175], a[116:119]
s_lshr_b32 s75, s93, 5
ds_read_b64_tr_b16 v[236:237], v21 offset:24576
v_lshlrev_b32 v78, 16, v90
v_mfma_f32_16x16x32_bf16 a[112:115], v[252:255], v[164:167], a[112:115]
s_and_b32 s75, s75, 0x3f80
v_lshlrev_b32 v79, 16, v114
v_fmac_f32 v76, v78, v79
v_mfma_f32_16x16x32_bf16 a[112:115], v[248:251], v[160:163], a[112:115]
s_add_u32 s75, s75, LcB0-Lpc0
v_lshrrev_b32 v2, 6, v0
v_lshlrev_b32 v2, 7, v2
v_mfma_f32_16x16x32_bf16 a[108:111], v[248:251], v[152:155], a[108:111]
s_add_u32 s72, s70, 15360
buffer_load_dwordx4 v5, s[4:7], s72 offen offset:1024 lds
v_mfma_f32_16x16x32_bf16 a[108:111], v[252:255], v[156:159], a[108:111]
v_add_u32 v2, s75, v2
v_min_u32 v2, Lcode_end-Lpc0, v2
v_mfma_f32_16x16x32_bf16 a[104:107], v[252:255], v[148:151], a[104:107]
global_load_dword v3, v2, s[98:99]
v_mfma_f32_16x16x32_bf16 a[104:107], v[248:251], v[144:147], a[104:107]
ds_read_b64_tr_b16 v[238:239], v21 offset:25600
v_lshlrev_b32 v80, 16, v122
v_mfma_f32_16x16x32_bf16 a[100:103], v[248:251], v[136:139], a[100:103]
s_add_u32 s72, s70, 129024
buffer_load_dwordx4 v4, s[4:7], s72 offen offset:2048 lds
v_mfma_f32_16x16x32_bf16 a[100:103], v[252:255], v[140:143], a[100:103]
v_fmac_f32 v77, v78, v80
v_and_b32 v78, 0xffff0000, v90
v_mfma_f32_16x16x32_bf16 a[96:99], v[252:255], v[132:135], a[96:99]
v_and_b32 v79, 0xffff0000, v114
v_fmac_f32 v76, v78, v79
v_mfma_f32_16x16x32_bf16 a[96:99], v[248:251], v[128:131], a[96:99]
s_waitcnt lgkmcnt(4)
v_and_b32 v80, 0xffff0000, v122
v_fmac_f32 v77, v78, v80
v_mfma_f32_16x16x32_bf16 a[128:131], v[128:131], v[224:227], a[128:131]
ds_read_b64_tr_b16 v[240:241], v22 offset:16384
v_lshlrev_b32 v78, 16, v91
v_mfma_f32_16x16x32_bf16 a[128:131], v[132:135], v[228:231], a[128:131]
s_add_u32 s72, s70, 144384
buffer_load_dwordx4 v5, s[4:7], s72 offen offset:3072 lds
v_mfma_f32_16x16x32_bf16 a[132:135], v[140:143], v[228:231], a[132:135]
v_lshlrev_b32 v79, 16, v115
v_fmac_f32 v76, v78, v79
v_mfma_f32_16x16x32_bf16 a[132:135], v[136:139], v[224:227], a[132:135]
v_lshlrev_b32 v80, 16, v123
v_fmac_f32 v77, v78, v80
v_mfma_f32_16x16x32_bf16 a[136:139], v[144:147], v[224:227], a[136:139]
ds_read_b64_tr_b16 v[242:243], v22 offset:17408
v_and_b32 v78, 0xffff0000, v91
v_mfma_f32_16x16x32_bf16 a[136:139], v[148:151], v[228:231], a[136:139]
v_and_b32 v79, 0xffff0000, v115
v_fmac_f32 v76, v78, v79
v_mfma_f32_16x16x32_bf16 a[140:143], v[156:159], v[228:231], a[140:143]
v_and_b32 v80, 0xffff0000, v123
v_fmac_f32 v77, v78, v80
v_mfma_f32_16x16x32_bf16 a[140:143], v[152:155], v[224:227], a[140:143]
ds_read_b64_tr_b16 v[244:245], v22 offset:24576
v_add_f32_dpp v76, v76, v76 row_ror:8 row_mask:0xf bank_mask:0xf
v_mfma_f32_16x16x32_bf16 a[144:147], v[160:163], v[224:227], a[144:147]
v_add_f32_dpp v77, v77, v77 row_ror:8 row_mask:0xf bank_mask:0xf
v_add_f32_dpp v76, v76, v76 row_ror:4 row_mask:0xf bank_mask:0xf
v_mfma_f32_16x16x32_bf16 a[144:147], v[164:167], v[228:231], a[144:147]
v_add_f32_dpp v77, v77, v77 row_ror:4 row_mask:0xf bank_mask:0xf
v_add_f32_dpp v76, v76, v76 row_ror:2 row_mask:0xf bank_mask:0xf
v_mfma_f32_16x16x32_bf16 a[148:151], v[172:175], v[228:231], a[148:151]
ds_read_b64_tr_b16 v[246:247], v22 offset:25600
v_add_f32_dpp v77, v77, v77 row_ror:2 row_mask:0xf bank_mask:0xf
v_mfma_f32_16x16x32_bf16 a[148:151], v[168:171], v[224:227], a[148:151]
v_add_f32_dpp v76, v76, v76 row_ror:1 row_mask:0xf bank_mask:0xf
v_add_f32_dpp v77, v77, v77 row_ror:1 row_mask:0xf bank_mask:0xf
v_mfma_f32_16x16x32_bf16 a[152:155], v[176:179], v[224:227], a[152:155]
v_mov_b32 v78, v76
v_mov_b32 v79, v77
v_mfma_f32_16x16x32_bf16 a[152:155], v[180:183], v[228:231], a[152:155]
v_permlane16_swap_b32 v76, v78
v_permlane16_swap_b32 v77, v79
v_mfma_f32_16x16x32_bf16 a[156:159], v[188:191], v[228:231], a[156:159]
v_add_f32 v76, v76, v78
v_add_f32 v77, v77, v79
v_mfma_f32_16x16x32_bf16 a[156:159], v[184:187], v[224:227], a[156:159]
s_waitcnt lgkmcnt(4)
v_mov_b32 v78, v76
v_mov_b32 v79, v77
v_mfma_f32_16x16x32_bf16 a[188:191], v[184:187], v[232:235], a[188:191]
ds_read_b64_tr_b16 v[248:249], v23 offset:16384
v_permlane32_swap_b32 v76, v78
v_mfma_f32_16x16x32_bf16 a[188:191], v[188:191], v[236:239], a[188:191]
v_permlane32_swap_b32 v77, v79
v_add_f32 v76, v76, v78
v_mfma_f32_16x16x32_bf16 a[184:187], v[180:183], v[236:239], a[184:187]
ds_read_b64_tr_b16 v[250:251], v23 offset:17408
v_add_f32 v77, v77, v79
v_mfma_f32_16x16x32_bf16 a[184:187], v[176:179], v[232:235], a[184:187]
v_mul_f32 v76, 0xbfb8aa3b, v76
v_mul_f32 v77, 0xbfb8aa3b, v77
v_mfma_f32_16x16x32_bf16 a[180:183], v[168:171], v[232:235], a[180:183]
ds_read_b64_tr_b16 v[252:253], v23 offset:24576
v_mfma_f32_16x16x32_bf16 a[180:183], v[172:175], v[236:239], a[180:183]
v_exp_f32 v76, v76
v_mfma_f32_16x16x32_bf16 a[176:179], v[164:167], v[236:239], a[176:179]
ds_read_b64_tr_b16 v[254:255], v23 offset:25600
v_mfma_f32_16x16x32_bf16 a[176:179], v[160:163], v[232:235], a[176:179]
v_exp_f32 v77, v77
v_mfma_f32_16x16x32_bf16 a[172:175], v[152:155], v[232:235], a[172:175]
v_add_f32 v76, 1.0, v76
v_add_f32 v77, 1.0, v77
v_mfma_f32_16x16x32_bf16 a[172:175], v[156:159], v[236:239], a[172:175]
v_rcp_f32 v76, v76
v_mfma_f32_16x16x32_bf16 a[168:171], v[148:151], v[236:239], a[168:171]
v_rcp_f32 v77, v77
v_mfma_f32_16x16x32_bf16 a[168:171], v[144:147], v[232:235], a[168:171]
s_lshr_b32 s80, s76, 9
v_mfma_f32_16x16x32_bf16 a[164:167], v[136:139], v[232:235], a[164:167]
s_add_u32 s80, s80, 0x3800000
v_min_u32 v78, 1, v0
v_lshlrev_b32 v78, 30, v78
v_mfma_f32_16x16x32_bf16 a[164:167], v[140:143], v[236:239], a[164:167]
buffer_store_dwordx2 v[76:77], v78, s[44:47], s80 offen sc1
v_mfma_f32_16x16x32_bf16 a[160:163], v[132:135], v[236:239], a[160:163]
s_waitcnt vmcnt(10) lgkmcnt(0)
v_mfma_f32_16x16x32_bf16 a[160:163], v[128:131], v[232:235], a[160:163]
s_barrier
v_mfma_f32_16x16x32_bf16 a[192:195], v[128:131], v[240:243], a[192:195]
s_lshl_b32 s71, s73, 12
ds_read_b64_tr_b16 v[224:225], v20 offset:32768
v_mfma_f32_16x16x32_bf16 a[192:195], v[132:135], v[244:247], a[192:195]
s_add_u32 s71, s71, s66
ds_read_b64_tr_b16 v[226:227], v20 offset:33792
v_mfma_f32_16x16x32_bf16 a[196:199], v[140:143], v[244:247], a[196:199]
s_add_u32 m0, s64, 0
v_mov_b32 v100, v20
v_mov_b32 v101, v21
v_mfma_f32_16x16x32_bf16 a[196:199], v[136:139], v[240:243], a[196:199]
s_add_u32 s72, s71, 0
buffer_load_dwordx4 v6, s[12:15], s72 offen lds
v_mfma_f32_16x16x32_bf16 a[200:203], v[144:147], v[240:243], a[200:203]
v_mov_b32 v102, v22
v_mov_b32 v103, v23
v_mfma_f32_16x16x32_bf16 a[200:203], v[148:151], v[244:247], a[200:203]
ds_read_b64_tr_b16 v[228:229], v20 offset:40960
v_mfma_f32_16x16x32_bf16 a[204:207], v[156:159], v[244:247], a[204:207]
s_add_u32 s72, s71, 31744
buffer_load_dwordx4 v6, s[12:15], s72 offen offset:1024 lds
v_mfma_f32_16x16x32_bf16 a[204:207], v[152:155], v[240:243], a[204:207]
ds_read_b64_tr_b16 v[230:231], v20 offset:41984
v_mfma_f32_16x16x32_bf16 a[208:211], v[160:163], v[240:243], a[208:211]
s_waitcnt lgkmcnt(15)
buffer_store_dwordx4 v[36:39], v26, s[44:47], s74 offen sc1
v_mfma_f32_16x16x32_bf16 a[208:211], v[164:167], v[244:247], a[208:211]
ds_read_b128 v[192:195], v24 offset:32768
v_mfma_f32_16x16x32_bf16 a[212:215], v[172:175], v[244:247], a[212:215]
ds_read_b128 v[196:199], v25 offset:32768
v_mfma_f32_16x16x32_bf16 a[212:215], v[168:171], v[240:243], a[212:215]
ds_read_b128 v[200:203], v24 offset:34816
v_mfma_f32_16x16x32_bf16 a[216:219], v[176:179], v[240:243], a[216:219]
s_add_u32 s72, s71, 63488
buffer_load_dwordx4 v7, s[12:15], s72 offen offset:2048 lds
v_mfma_f32_16x16x32_bf16 a[216:219], v[180:183], v[244:247], a[216:219]
ds_read_b128 v[204:207], v25 offset:34816
v_mfma_f32_16x16x32_bf16 a[220:223], v[188:191], v[244:247], a[220:223]
ds_read_b128 v[208:211], v24 offset:36864
v_mfma_f32_16x16x32_bf16 a[220:223], v[184:187], v[240:243], a[220:223]
ds_read_b128 v[212:215], v25 offset:36864
v_mfma_f32_16x16x32_bf16 a[252:255], v[184:187], v[248:251], a[252:255]
ds_read_b128 v[216:219], v24 offset:38912
v_mfma_f32_16x16x32_bf16 a[252:255], v[188:191], v[252:255], a[252:255]
ds_read_b128 v[220:223], v25 offset:38912
v_mfma_f32_16x16x32_bf16 a[248:251], v[180:183], v[252:255], a[248:251]
s_add_u32 s72, s71, 95232
buffer_load_dwordx4 v7, s[12:15], s72 offen offset:3072 lds
v_mfma_f32_16x16x32_bf16 a[248:251], v[176:179], v[248:251], a[248:251]
ds_read_b128 v[184:187], v24 offset:40960
v_mfma_f32_16x16x32_bf16 a[244:247], v[168:171], v[248:251], a[244:247]
ds_read_b128 v[188:191], v25 offset:40960
v_mfma_f32_16x16x32_bf16 a[244:247], v[172:175], v[252:255], a[244:247]
ds_read_b128 v[176:179], v24 offset:43008
v_mfma_f32_16x16x32_bf16 a[240:243], v[164:167], v[252:255], a[240:243]
ds_read_b128 v[180:183], v25 offset:43008
v_mfma_f32_16x16x32_bf16 a[240:243], v[160:163], v[248:251], a[240:243]
v_mfma_f32_16x16x32_bf16 a[236:239], v[152:155], v[248:251], a[236:239]
s_add_u32 s74, s74, 0x4000
buffer_store_dwordx4 v[40:43], v26, s[44:47], s74 offen sc1
v_mfma_f32_16x16x32_bf16 a[236:239], v[156:159], v[252:255], a[236:239]
s_add_u32 s73, s62, 1
ds_read_b128 v[168:171], v24 offset:45056
v_mfma_f32_16x16x32_bf16 a[232:235], v[148:151], v[252:255], a[232:235]
s_add_u32 s70, s73, s65
ds_read_b128 v[172:175], v25 offset:45056
v_mfma_f32_16x16x32_bf16 a[232:235], v[144:147], v[248:251], a[232:235]
s_and_b32 s70, s70, 3
ds_read_b128 v[160:163], v24 offset:47104
v_mfma_f32_16x16x32_bf16 a[228:231], v[136:139], v[248:251], a[228:231]
s_and_b32 s73, s73, 12
ds_read_b128 v[164:167], v25 offset:47104
v_mfma_f32_16x16x32_bf16 a[228:231], v[140:143], v[252:255], a[228:231]
s_or_b32 s73, s73, s70
v_mfma_f32_16x16x32_bf16 a[224:227], v[132:135], v[252:255], a[224:227]
s_lshl_b32 s73, s73, 7
ds_read_b64_tr_b16 v[232:233], v101 offset:32768
v_mfma_f32_16x16x32_bf16 a[224:227], v[128:131], v[248:251], a[224:227]
s_waitcnt lgkmcnt(9)
ds_read_b64_tr_b16 v[234:235], v101 offset:33792
v_mfma_f32_16x16x32_bf16 a[0:3], v[224:227], v[192:195], a[0:3]
s_add_u32 s69, s73, s67
ds_read_b64_tr_b16 v[236:237], v101 offset:40960
v_mfma_f32_16x16x32_bf16 a[0:3], v[228:231], v[196:199], a[0:3]
s_add_u32 s70, s73, s68
ds_read_b64_tr_b16 v[238:239], v101 offset:41984
v_mfma_f32_16x16x32_bf16 a[4:7], v[228:231], v[204:207], a[4:7]
s_add_u32 m0, s63, 65536
ds_read_b64_tr_b16 v[240:241], v102 offset:32768
v_mfma_f32_16x16x32_bf16 a[4:7], v[224:227], v[200:203], a[4:7]
s_add_u32 s72, s69, 0
buffer_load_dwordx4 v4, s[4:7], s72 offen lds
v_mfma_f32_16x16x32_bf16 a[8:11], v[224:227], v[208:211], a[8:11]
s_add_u32 s72, s69, 15360
buffer_load_dwordx4 v5, s[4:7], s72 offen offset:1024 lds
v_mfma_f32_16x16x32_bf16 a[8:11], v[228:231], v[212:215], a[8:11]
s_add_u32 s72, s69, 129024
buffer_load_dwordx4 v4, s[4:7], s72 offen offset:2048 lds
v_mfma_f32_16x16x32_bf16 a[12:15], v[228:231], v[220:223], a[12:15]
ds_read_b64_tr_b16 v[242:243], v102 offset:33792
v_mfma_f32_16x16x32_bf16 a[12:15], v[224:227], v[216:219], a[12:15]
s_waitcnt lgkmcnt(6)
v_mfma_f32_16x16x32_bf16 a[16:19], v[224:227], v[184:187], a[16:19]
s_add_u32 s74, s74, 0x4000
buffer_store_dwordx4 v[44:47], v26, s[44:47], s74 offen sc1
v_mfma_f32_16x16x32_bf16 a[16:19], v[228:231], v[188:191], a[16:19]
ds_read_b64_tr_b16 v[244:245], v102 offset:40960
v_mfma_f32_16x16x32_bf16 a[20:23], v[228:231], v[180:183], a[20:23]
v_mfma_f32_16x16x32_bf16 a[20:23], v[224:227], v[176:179], a[20:23]
ds_read_b64_tr_b16 v[246:247], v102 offset:41984
v_mfma_f32_16x16x32_bf16 a[24:27], v[224:227], v[168:171], a[24:27]
s_add_u32 s72, s69, 144384
buffer_load_dwordx4 v5, s[4:7], s72 offen offset:3072 lds
v_mfma_f32_16x16x32_bf16 a[24:27], v[228:231], v[172:175], a[24:27]
v_mfma_f32_16x16x32_bf16 a[28:31], v[228:231], v[164:167], a[28:31]
v_mfma_f32_16x16x32_bf16 a[28:31], v[224:227], v[160:163], a[28:31]
s_waitcnt lgkmcnt(4)
v_mfma_f32_16x16x32_bf16 a[60:63], v[232:235], v[160:163], a[60:63]
ds_read_b64_tr_b16 v[248:249], v103 offset:32768
v_mfma_f32_16x16x32_bf16 a[60:63], v[236:239], v[164:167], a[60:63]
v_mfma_f32_16x16x32_bf16 a[56:59], v[236:239], v[172:175], a[56:59]
s_add_u32 m0, s63, 69632
ds_read_b64_tr_b16 v[250:251], v103 offset:33792
v_mfma_f32_16x16x32_bf16 a[56:59], v[232:235], v[168:171], a[56:59]
s_add_u32 s72, s70, 0
buffer_load_dwordx4 v4, s[4:7], s72 offen lds
v_mfma_f32_16x16x32_bf16 a[52:55], v[232:235], v[176:179], a[52:55]
v_mfma_f32_16x16x32_bf16 a[52:55], v[236:239], v[180:183], a[52:55]
v_mfma_f32_16x16x32_bf16 a[48:51], v[236:239], v[188:191], a[48:51]
ds_read_b64_tr_b16 v[252:253], v103 offset:40960
v_mfma_f32_16x16x32_bf16 a[48:51], v[232:235], v[184:187], a[48:51]
v_mfma_f32_16x16x32_bf16 a[44:47], v[232:235], v[216:219], a[44:47]
s_add_u32 s72, s70, 15360
buffer_load_dwordx4 v5, s[4:7], s72 offen offset:1024 lds
v_mfma_f32_16x16x32_bf16 a[44:47], v[236:239], v[220:223], a[44:47]
s_add_u32 s74, s74, 0x4000
buffer_store_dwordx4 v[48:51], v26, s[44:47], s74 offen sc1
v_mfma_f32_16x16x32_bf16 a[40:43], v[236:239], v[212:215], a[40:43]
v_mfma_f32_16x16x32_bf16 a[40:43], v[232:235], v[208:211], a[40:43]
ds_read_b64_tr_b16 v[254:255], v103 offset:41984
v_mfma_f32_16x16x32_bf16 a[36:39], v[232:235], v[200:203], a[36:39]
v_mfma_f32_16x16x32_bf16 a[36:39], v[236:239], v[204:207], a[36:39]
v_mfma_f32_16x16x32_bf16 a[32:35], v[236:239], v[196:199], a[32:35]
v_mfma_f32_16x16x32_bf16 a[32:35], v[232:235], v[192:195], a[32:35]
s_waitcnt lgkmcnt(4)
v_mfma_f32_16x16x32_bf16 a[64:67], v[240:243], v[192:195], a[64:67]
s_add_u32 s72, s70, 129024
buffer_load_dwordx4 v4, s[4:7], s72 offen offset:2048 lds
v_mfma_f32_16x16x32_bf16 a[64:67], v[244:247], v[196:199], a[64:67]
ds_read_b64_tr_b16 v[224:225], v100 offset:49152
v_mfma_f32_16x16x32_bf16 a[68:71], v[244:247], v[204:207], a[68:71]
v_mfma_f32_16x16x32_bf16 a[68:71], v[240:243], v[200:203], a[68:71]
v_mfma_f32_16x16x32_bf16 a[72:75], v[240:243], v[208:211], a[72:75]
ds_read_b64_tr_b16 v[226:227], v100 offset:50176
v_mfma_f32_16x16x32_bf16 a[72:75], v[244:247], v[212:215], a[72:75]
s_add_u32 s72, s70, 144384
buffer_load_dwordx4 v5, s[4:7], s72 offen offset:3072 lds
v_mfma_f32_16x16x32_bf16 a[76:79], v[244:247], v[220:223], a[76:79]
v_mfma_f32_16x16x32_bf16 a[76:79], v[240:243], v[216:219], a[76:79]
v_mfma_f32_16x16x32_bf16 a[80:83], v[240:243], v[184:187], a[80:83]
ds_read_b64_tr_b16 v[228:229], v100 offset:57344
v_mfma_f32_16x16x32_bf16 a[80:83], v[244:247], v[188:191], a[80:83]
v_mfma_f32_16x16x32_bf16 a[84:87], v[244:247], v[180:183], a[84:87]
v_accvgpr_read_b32 v20, a0
v_accvgpr_read_b32 v28, a1
v_mfma_f32_16x16x32_bf16 a[84:87], v[240:243], v[176:179], a[84:87]
s_lshl_b32 s71, s73, 12
ds_read_b64_tr_b16 v[230:231], v100 offset:58368
v_accvgpr_read_b32 v21, a2
v_mfma_f32_16x16x32_bf16 a[88:91], v[240:243], v[168:171], a[88:91]
s_add_u32 s71, s71, s66
v_accvgpr_read_b32 v29, a3
v_accvgpr_read_b32 v22, a32
v_mfma_f32_16x16x32_bf16 a[88:91], v[244:247], v[172:175], a[88:91]
s_add_u32 m0, s64, 16384
v_accvgpr_read_b32 v30, a33
v_accvgpr_read_b32 v23, a34
v_mfma_f32_16x16x32_bf16 a[92:95], v[244:247], v[164:167], a[92:95]
s_add_u32 s72, s71, 0
buffer_load_dwordx4 v6, s[12:15], s72 offen lds
v_mfma_f32_16x16x32_bf16 a[92:95], v[240:243], v[160:163], a[92:95]
s_waitcnt lgkmcnt(4)
v_accvgpr_read_b32 v31, a35
v_mul_f32 v20, s79, v20
v_mfma_f32_16x16x32_bf16 a[124:127], v[248:251], v[160:163], a[124:127]
ds_read_b64_tr_b16 v[232:233], v101 offset:49152
v_mul_f32 v28, s79, v28
v_mfma_f32_16x16x32_bf16 a[124:127], v[252:255], v[164:167], a[124:127]
v_mul_f32 v21, s79, v21
v_mul_f32 v29, s79, v29
v_mfma_f32_16x16x32_bf16 a[120:123], v[252:255], v[172:175], a[120:123]
s_add_u32 s72, s71, 31744
buffer_load_dwordx4 v6, s[12:15], s72 offen offset:1024 lds
v_mfma_f32_16x16x32_bf16 a[120:123], v[248:251], v[168:171], a[120:123]
v_mul_f32 v22, s79, v22
v_mul_f32 v30, s79, v30
v_mfma_f32_16x16x32_bf16 a[116:119], v[248:251], v[176:179], a[116:119]
ds_read_b64_tr_b16 v[234:235], v101 offset:50176
v_mul_f32 v23, s79, v23
v_mfma_f32_16x16x32_bf16 a[116:119], v[252:255], v[180:183], a[116:119]
v_mul_f32 v31, s79, v31
v_cvt_pk_bf16_f32 v20, v20, v28
v_mfma_f32_16x16x32_bf16 a[112:115], v[252:255], v[188:191], a[112:115]
v_cvt_pk_bf16_f32 v21, v21, v29
v_cvt_pk_bf16_f32 v22, v22, v30
v_mfma_f32_16x16x32_bf16 a[112:115], v[248:251], v[184:187], a[112:115]
ds_read_b64_tr_b16 v[236:237], v101 offset:57344
v_cvt_pk_bf16_f32 v23, v23, v31
v_mfma_f32_16x16x32_bf16 a[108:111], v[248:251], v[216:219], a[108:111]
s_add_u32 s72, s71, 63488
buffer_load_dwordx4 v7, s[12:15], s72 offen offset:2048 lds
v_mfma_f32_16x16x32_bf16 a[108:111], v[252:255], v[220:223], a[108:111]
s_add_u32 s80, s77, 0
buffer_store_dwordx4 v[20:23], v1, s[44:47], s80 offen sc1
v_mfma_f32_16x16x32_bf16 a[104:107], v[252:255], v[212:215], a[104:107]
v_mfma_f32_16x16x32_bf16 a[104:107], v[248:251], v[208:211], a[104:107]
ds_read_b64_tr_b16 v[238:239], v101 offset:58368
v_mfma_f32_16x16x32_bf16 a[100:103], v[248:251], v[200:203], a[100:103]
v_mfma_f32_16x16x32_bf16 a[100:103], v[252:255], v[204:207], a[100:103]
v_mfma_f32_16x16x32_bf16 a[96:99], v[252:255], v[196:199], a[96:99]
s_add_u32 s72, s71, 95232
buffer_load_dwordx4 v7, s[12:15], s72 offen offset:3072 lds
v_mfma_f32_16x16x32_bf16 a[96:99], v[248:251], v[192:195], a[96:99]
s_waitcnt lgkmcnt(4)
LcB0:
v_mfma_f32_16x16x32_bf16 a[128:131], v[192:195], v[224:227], a[128:131]
ds_read_b64_tr_b16 v[240:241], v102 offset:49152
v_accvgpr_read_b32 v24, a4
v_mfma_f32_16x16x32_bf16 a[128:131], v[196:199], v[228:231], a[128:131]
v_accvgpr_read_b32 v28, a5
v_accvgpr_read_b32 v25, a6
v_mfma_f32_16x16x32_bf16 a[132:135], v[204:207], v[228:231], a[132:135]
v_accvgpr_read_b32 v29, a7
v_accvgpr_read_b32 v26, a36
v_mfma_f32_16x16x32_bf16 a[132:135], v[200:203], v[224:227], a[132:135]
ds_read_b64_tr_b16 v[242:243], v102 offset:50176
v_accvgpr_read_b32 v30, a37
v_mfma_f32_16x16x32_bf16 a[136:139], v[208:211], v[224:227], a[136:139]
v_accvgpr_read_b32 v27, a38
v_accvgpr_read_b32 v31, a39
v_mfma_f32_16x16x32_bf16 a[136:139], v[212:215], v[228:231], a[136:139]
v_mul_f32 v24, s79, v24
v_mul_f32 v28, s79, v28
v_mfma_f32_16x16x32_bf16 a[140:143], v[220:223], v[228:231], a[140:143]
v_mul_f32 v25, s79, v25
v_mul_f32 v29, s79, v29
v_mfma_f32_16x16x32_bf16 a[140:143], v[216:219], v[224:227], a[140:143]
ds_read_b64_tr_b16 v[244:245], v102 offset:57344
v_mul_f32 v26, s79, v26
v_mfma_f32_16x16x32_bf16 a[144:147], v[184:187], v[224:227], a[144:147]
v_mul_f32 v30, s79, v30
v_mul_f32 v27, s79, v27
v_mfma_f32_16x16x32_bf16 a[144:147], v[188:191], v[228:231], a[144:147]
v_mul_f32 v31, s79, v31
v_cvt_pk_bf16_f32 v24, v24, v28
v_mfma_f32_16x16x32_bf16 a[148:151], v[180:183], v[228:231], a[148:151]
ds_read_b64_tr_b16 v[246:247], v102 offset:58368
v_cvt_pk_bf16_f32 v25, v25, v29
v_mfma_f32_16x16x32_bf16 a[148:151], v[176:179], v[224:227], a[148:151]
v_cvt_pk_bf16_f32 v26, v26, v30
v_cvt_pk_bf16_f32 v27, v27, v31
v_mfma_f32_16x16x32_bf16 a[152:155], v[168:171], v[224:227], a[152:155]
s_add_u32 s80, s77, 4096
buffer_store_dwordx4 v[24:27], v1, s[44:47], s80 offen sc1
v_mfma_f32_16x16x32_bf16 a[152:155], v[172:175], v[228:231], a[152:155]
v_mfma_f32_16x16x32_bf16 a[156:159], v[164:167], v[228:231], a[156:159]
v_mfma_f32_16x16x32_bf16 a[156:159], v[160:163], v[224:227], a[156:159]
s_waitcnt lgkmcnt(4)
v_mfma_f32_16x16x32_bf16 a[188:191], v[160:163], v[232:235], a[188:191]
ds_read_b64_tr_b16 v[248:249], v103 offset:49152
v_mfma_f32_16x16x32_bf16 a[188:191], v[164:167], v[236:239], a[188:191]
v_mfma_f32_16x16x32_bf16 a[184:187], v[172:175], v[236:239], a[184:187]
ds_read_b64_tr_b16 v[250:251], v103 offset:50176
v_mfma_f32_16x16x32_bf16 a[184:187], v[168:171], v[232:235], a[184:187]
v_mfma_f32_16x16x32_bf16 a[180:183], v[176:179], v[232:235], a[180:183]
ds_read_b64_tr_b16 v[252:253], v103 offset:57344
v_mfma_f32_16x16x32_bf16 a[180:183], v[180:183], v[236:239], a[180:183]
s_add_u32 s73, s62, 2
v_mfma_f32_16x16x32_bf16 a[176:179], v[188:191], v[236:239], a[176:179]
s_add_u32 s70, s73, s65
ds_read_b64_tr_b16 v[254:255], v103 offset:58368
v_accvgpr_read_b32 v20, a8
v_mfma_f32_16x16x32_bf16 a[176:179], v[184:187], v[232:235], a[176:179]
s_and_b32 s70, s70, 3
v_accvgpr_read_b32 v28, a9
v_accvgpr_read_b32 v21, a10
v_mfma_f32_16x16x32_bf16 a[172:175], v[216:219], v[232:235], a[172:175]
s_and_b32 s73, s73, 12
v_accvgpr_read_b32 v29, a11
v_accvgpr_read_b32 v22, a40
v_mfma_f32_16x16x32_bf16 a[172:175], v[220:223], v[236:239], a[172:175]
s_or_b32 s73, s73, s70
v_accvgpr_read_b32 v30, a41
v_accvgpr_read_b32 v23, a42
v_mfma_f32_16x16x32_bf16 a[168:171], v[212:215], v[236:239], a[168:171]
s_lshl_b32 s73, s73, 7
v_accvgpr_read_b32 v31, a43
v_mul_f32 v20, s79, v20
v_mfma_f32_16x16x32_bf16 a[168:171], v[208:211], v[232:235], a[168:171]
s_add_u32 s69, s73, s67
v_mul_f32 v28, s79, v28
v_mul_f32 v21, s79, v21
v_mfma_f32_16x16x32_bf16 a[164:167], v[200:203], v[232:235], a[164:167]
s_add_u32 s70, s73, s68
v_mul_f32 v29, s79, v29
v_mul_f32 v22, s79, v22
v_mfma_f32_16x16x32_bf16 a[164:167], v[204:207], v[236:239], a[164:167]
s_add_u32 m0, s63, 98304
v_mul_f32 v30, s79, v30
v_mul_f32 v23, s79, v23
v_mfma_f32_16x16x32_bf16 a[160:163], v[196:199], v[236:239], a[160:163]
s_waitcnt vmcnt(8) lgkmcnt(0)
v_mul_f32 v31, s79, v31
v_cvt_pk_bf16_f32 v20, v20, v28
v_mfma_f32_16x16x32_bf16 a[160:163], v[192:195], v[232:235], a[160:163]
s_barrier
v_cvt_pk_bf16_f32 v21, v21, v29
v_cvt_pk_bf16_f32 v22, v22, v30
v_mfma_f32_16x16x32_bf16 a[192:195], v[192:195], v[240:243], a[192:195]
s_add_u32 s72, s69, 0
buffer_load_dwordx4 v4, s[4:7], s72 offen lds
v_mfma_f32_16x16x32_bf16 a[192:195], v[196:199], v[244:247], a[192:195]
s_lshl_b32 s74, s59, 2
ds_read_b64_tr_b16 v[64:65], v8 offset:0
v_or_b32 v106, s58, v0
v_mfma_f32_16x16x32_bf16 a[196:199], v[204:207], v[244:247], a[196:199]
ds_read_b64_tr_b16 v[66:67], v8 offset:1024
v_mov_b32 v107, 1
v_mfma_f32_16x16x32_bf16 a[196:199], v[200:203], v[240:243], a[196:199]
ds_read_b64_tr_b16 v[68:69], v8 offset:8192
v_lshlrev_b32 v106, 8, v106
v_mfma_f32_16x16x32_bf16 a[200:203], v[208:211], v[240:243], a[200:203]
ds_read_b64_tr_b16 v[70:71], v8 offset:9216
v_cvt_pk_bf16_f32 v23, v23, v31
v_mfma_f32_16x16x32_bf16 a[200:203], v[212:215], v[244:247], a[200:203]
s_add_u32 s72, s69, 15360
buffer_load_dwordx4 v5, s[4:7], s72 offen offset:1024 lds
v_mfma_f32_16x16x32_bf16 a[204:207], v[220:223], v[244:247], a[204:207]
s_add_u32 s80, s77, 8192
ds_read_b128 v[32:35], v16 offset:0
v_mfma_f32_16x16x32_bf16 a[204:207], v[216:219], v[240:243], a[204:207]
buffer_atomic_add v107, v106, s[48:51], s74 offen sc1
v_mfma_f32_16x16x32_bf16 a[208:211], v[184:187], v[240:243], a[208:211]
ds_read_b128 v[36:39], v17 offset:0
v_mfma_f32_16x16x32_bf16 a[208:211], v[188:191], v[244:247], a[208:211]
ds_read_b128 v[40:43], v16 offset:2048
v_mfma_f32_16x16x32_bf16 a[212:215], v[180:183], v[244:247], a[212:215]
s_add_u32 s72, s69, 129024
buffer_load_dwordx4 v4, s[4:7], s72 offen offset:2048 lds
v_mfma_f32_16x16x32_bf16 a[212:215], v[176:179], v[240:243], a[212:215]
ds_read_b128 v[44:47], v17 offset:2048
v_mfma_f32_16x16x32_bf16 a[216:219], v[168:171], v[240:243], a[216:219]
ds_read_b128 v[48:51], v16 offset:4096
v_accvgpr_read_b32 v24, a128
v_mfma_f32_16x16x32_bf16 a[216:219], v[172:175], v[244:247], a[216:219]
ds_read_b128 v[52:55], v17 offset:4096
v_accvgpr_read_b32 v28, a129
v_mfma_f32_16x16x32_bf16 a[220:223], v[164:167], v[244:247], a[220:223]
buffer_store_dwordx4 v[20:23], v1, s[44:47], s80 offen sc1
v_mfma_f32_16x16x32_bf16 a[220:223], v[160:163], v[240:243], a[220:223]
s_add_u32 s72, s69, 144384
buffer_load_dwordx4 v5, s[4:7], s72 offen offset:3072 lds
v_mfma_f32_16x16x32_bf16 a[252:255], v[160:163], v[248:251], a[252:255]
ds_read_b128 v[56:59], v16 offset:6144
v_accvgpr_read_b32 v25, a130
v_mfma_f32_16x16x32_bf16 a[252:255], v[164:167], v[252:255], a[252:255]
ds_read_b128 v[60:63], v17 offset:6144
v_accvgpr_read_b32 v29, a131
v_mfma_f32_16x16x32_bf16 a[248:251], v[172:175], v[252:255], a[248:251]
ds_read_b64_tr_b16 v[72:73], v9 offset:0
v_accvgpr_read_b32 v26, a132
v_mfma_f32_16x16x32_bf16 a[248:251], v[168:171], v[248:251], a[248:251]
s_add_u32 m0, s63, 102400
ds_read_b64_tr_b16 v[74:75], v9 offset:1024
v_accvgpr_read_b32 v30, a133
v_mfma_f32_16x16x32_bf16 a[244:247], v[176:179], v[248:251], a[244:247]
s_add_u32 s72, s70, 0
buffer_load_dwordx4 v4, s[4:7], s72 offen lds
v_mfma_f32_16x16x32_bf16 a[244:247], v[180:183], v[252:255], a[244:247]
ds_read_b64_tr_b16 v[76:77], v9 offset:8192
v_accvgpr_read_b32 v27, a134
v_mfma_f32_16x16x32_bf16 a[240:243], v[188:191], v[252:255], a[240:243]
v_accvgpr_read_b32 v31, a135
v_cvt_pk_bf16_f32 v24, v24, v28
v_mfma_f32_16x16x32_bf16 a[240:243], v[184:187], v[248:251], a[240:243]
ds_read_b64_tr_b16 v[78:79], v9 offset:9216
v_cvt_pk_bf16_f32 v25, v25, v29
v_mfma_f32_16x16x32_bf16 a[236:239], v[216:219], v[248:251], a[236:239]
ds_read_b64_tr_b16 v[80:81], v10 offset:0
v_cvt_pk_bf16_f32 v26, v26, v30
v_mfma_f32_16x16x32_bf16 a[236:239], v[220:223], v[252:255], a[236:239]
s_add_u32 s72, s70, 15360
buffer_load_dwordx4 v5, s[4:7], s72 offen offset:1024 lds
v_mfma_f32_16x16x32_bf16 a[232:235], v[212:215], v[252:255], a[232:235]
ds_read_b64_tr_b16 v[82:83], v10 offset:1024
v_cvt_pk_bf16_f32 v27, v27, v31
v_mfma_f32_16x16x32_bf16 a[232:235], v[208:211], v[248:251], a[232:235]
s_add_u32 s80, s78, 0
ds_read_b64_tr_b16 v[84:85], v10 offset:8192
v_mfma_f32_16x16x32_bf16 a[228:231], v[200:203], v[248:251], a[228:231]
ds_read_b64_tr_b16 v[86:87], v10 offset:9216
v_mfma_f32_16x16x32_bf16 a[228:231], v[204:207], v[252:255], a[228:231]
buffer_store_dwordx4 v[24:27], v1, s[44:47], s80 offen sc1
v_mfma_f32_16x16x32_bf16 a[224:227], v[196:199], v[252:255], a[224:227]
s_add_u32 s72, s70, 129024
buffer_load_dwordx4 v4, s[4:7], s72 offen offset:2048 lds
v_mfma_f32_16x16x32_bf16 a[224:227], v[192:195], v[248:251], a[224:227]
s_waitcnt lgkmcnt(8)
v_mfma_f32_16x16x32_bf16 v[128:131], v[64:67], v[32:35], 0
ds_read_b64_tr_b16 v[88:89], v11 offset:0
v_mfma_f32_16x16x32_bf16 v[128:131], v[68:71], v[36:39], v[128:131]
ds_read_b64_tr_b16 v[90:91], v11 offset:1024
v_mfma_f32_16x16x32_bf16 v[132:135], v[68:71], v[44:47], 0
v_accvgpr_read_b32 v20, a12
v_accvgpr_read_b32 v28, a13
v_mfma_f32_16x16x32_bf16 v[132:135], v[64:67], v[40:43], v[132:135]
s_add_u32 s72, s70, 144384
buffer_load_dwordx4 v5, s[4:7], s72 offen offset:3072 lds
v_mfma_f32_16x16x32_bf16 v[136:139], v[64:67], v[48:51], 0
s_lshl_b32 s71, s73, 12
ds_read_b64_tr_b16 v[92:93], v11 offset:8192
v_accvgpr_read_b32 v21, a14
v_mfma_f32_16x16x32_bf16 v[136:139], v[68:71], v[52:55], v[136:139]
s_add_u32 s71, s71, s66
v_accvgpr_read_b32 v29, a15
v_accvgpr_read_b32 v22, a44
v_mfma_f32_16x16x32_bf16 v[140:143], v[68:71], v[60:63], 0
s_add_u32 m0, s64, 32768
ds_read_b64_tr_b16 v[94:95], v11 offset:9216
v_accvgpr_read_b32 v30, a45
v_mfma_f32_16x16x32_bf16 v[140:143], v[64:67], v[56:59], v[140:143]
s_waitcnt lgkmcnt(8)
v_accvgpr_read_b32 v23, a46
v_accvgpr_read_b32 v31, a47
v_mfma_f32_16x16x32_bf16 v[156:159], v[72:75], v[56:59], 0
s_add_u32 s72, s71, 0
buffer_load_dwordx4 v6, s[12:15], s72 offen lds
v_mfma_f32_16x16x32_bf16 v[156:159], v[76:79], v[60:63], v[156:159]
s_add_u32 s73, s62, 3
ds_read_b64_tr_b16 v[64:65], v12 offset:0
v_mul_f32 v20, s79, v20
v_mfma_f32_16x16x32_bf16 v[152:155], v[76:79], v[52:55], 0
s_add_u32 s70, s73, s65
ds_read_b64_tr_b16 v[66:67], v12 offset:1024
v_mul_f32 v28, s79, v28
v_mfma_f32_16x16x32_bf16 v[152:155], v[72:75], v[48:51], v[152:155]
s_add_u32 s72, s71, 31744
buffer_load_dwordx4 v6, s[12:15], s72 offen offset:1024 lds
v_mfma_f32_16x16x32_bf16 v[148:151], v[72:75], v[40:43], 0
s_and_b32 s70, s70, 3
v_mul_f32 v21, s79, v21
v_mul_f32 v29, s79, v29
v_mfma_f32_16x16x32_bf16 v[148:151], v[76:79], v[44:47], v[148:151]
s_and_b32 s73, s73, 12
ds_read_b64_tr_b16 v[68:69], v12 offset:8192
v_mul_f32 v22, s79, v22
v_mfma_f32_16x16x32_bf16 v[144:147], v[76:79], v[36:39], 0
s_or_b32 s73, s73, s70
ds_read_b64_tr_b16 v[70:71], v12 offset:9216
v_mul_f32 v30, s79, v30
v_mfma_f32_16x16x32_bf16 v[144:147], v[72:75], v[32:35], v[144:147]
s_waitcnt lgkmcnt(8)
v_mul_f32 v23, s79, v23
v_mul_f32 v31, s79, v31
v_mfma_f32_16x16x32_bf16 v[160:163], v[80:83], v[32:35], 0
s_lshl_b32 s73, s73, 7
ds_read_b64_tr_b16 v[72:73], v13 offset:0
v_cvt_pk_bf16_f32 v20, v20, v28
v_mfma_f32_16x16x32_bf16 v[160:163], v[84:87], v[36:39], v[160:163]
s_add_u32 s72, s71, 63488
buffer_load_dwordx4 v7, s[12:15], s72 offen offset:2048 lds
v_mfma_f32_16x16x32_bf16 v[164:167], v[84:87], v[44:47], 0
s_add_u32 s69, s73, s67
ds_read_b64_tr_b16 v[74:75], v13 offset:1024
v_cvt_pk_bf16_f32 v21, v21, v29
v_mfma_f32_16x16x32_bf16 v[164:167], v[80:83], v[40:43], v[164:167]
s_add_u32 s70, s73, s68
v_cvt_pk_bf16_f32 v22, v22, v30
v_cvt_pk_bf16_f32 v23, v23, v31
v_mfma_f32_16x16x32_bf16 v[168:171], v[80:83], v[48:51], 0
s_waitcnt vmcnt(20)
ds_read_b64_tr_b16 v[76:77], v13 offset:8192
v_mfma_f32_16x16x32_bf16 v[168:171], v[84:87], v[52:55], v[168:171]
s_add_u32 s80, s77, 12288
ds_read_b64_tr_b16 v[78:79], v13 offset:9216
v_mfma_f32_16x16x32_bf16 v[172:175], v[84:87], v[60:63], 0
s_add_u32 s72, s71, 95232
ds_read_b128 v[96:99], v18 offset:0
v_mfma_f32_16x16x32_bf16 v[172:175], v[80:83], v[56:59], v[172:175]
s_waitcnt lgkmcnt(9)
buffer_load_dwordx4 v7, s[12:15], s72 offen offset:3072 lds
v_mfma_f32_16x16x32_bf16 v[188:191], v[88:91], v[56:59], 0
ds_read_b64_tr_b16 v[80:81], v14 offset:0
v_accvgpr_read_b32 v24, a136
v_mfma_f32_16x16x32_bf16 v[188:191], v[92:95], v[60:63], v[188:191]
ds_read_b64_tr_b16 v[82:83], v14 offset:1024
v_accvgpr_read_b32 v28, a137
v_mfma_f32_16x16x32_bf16 v[184:187], v[92:95], v[52:55], 0
ds_read_b128 v[100:103], v19 offset:0
v_accvgpr_read_b32 v25, a138
v_mfma_f32_16x16x32_bf16 v[184:187], v[88:91], v[48:51], v[184:187]
ds_read_b64_tr_b16 v[84:85], v14 offset:8192
v_accvgpr_read_b32 v29, a139
v_mfma_f32_16x16x32_bf16 v[180:183], v[88:91], v[40:43], 0
buffer_store_dwordx4 v[20:23], v1, s[44:47], s80 offen sc1
v_mfma_f32_16x16x32_bf16 v[180:183], v[92:95], v[44:47], v[180:183]
s_add_u32 m0, s63, 131072
ds_read_b64_tr_b16 v[86:87], v14 offset:9216
v_accvgpr_read_b32 v26, a140
v_mfma_f32_16x16x32_bf16 v[176:179], v[92:95], v[36:39], 0
s_add_u32 s72, s69, 0
buffer_load_dwordx4 v4, s[4:7], s72 offen lds
v_mfma_f32_16x16x32_bf16 v[176:179], v[88:91], v[32:35], v[176:179]
s_waitcnt lgkmcnt(10)
ds_read_b128 v[104:107], v18 offset:2048
v_accvgpr_read_b32 v30, a141
v_mfma_f32_16x16x32_bf16 v[192:195], v[64:67], v[32:35], 0
ds_read_b64_tr_b16 v[88:89], v15 offset:0
v_accvgpr_read_b32 v27, a142
v_mfma_f32_16x16x32_bf16 v[192:195], v[68:71], v[36:39], v[192:195]
ds_read_b64_tr_b16 v[90:91], v15 offset:1024
v_accvgpr_read_b32 v31, a143
v_mfma_f32_16x16x32_bf16 v[196:199], v[68:71], v[44:47], 0
ds_read_b64_tr_b16 v[92:93], v15 offset:8192
v_cvt_pk_bf16_f32 v24, v24, v28
v_mfma_f32_16x16x32_bf16 v[196:199], v[64:67], v[40:43], v[196:199]
s_add_u32 s72, s69, 15360
buffer_load_dwordx4 v5, s[4:7], s72 offen offset:1024 lds
v_mfma_f32_16x16x32_bf16 v[200:203], v[64:67], v[48:51], 0
ds_read_b64_tr_b16 v[94:95], v15 offset:9216
v_cvt_pk_bf16_f32 v25, v25, v29
v_mfma_f32_16x16x32_bf16 v[200:203], v[68:71], v[52:55], v[200:203]
ds_read_b128 v[108:111], v19 offset:2048
v_cvt_pk_bf16_f32 v26, v26, v30
v_mfma_f32_16x16x32_bf16 v[204:207], v[68:71], v[60:63], 0
v_cvt_pk_bf16_f32 v27, v27, v31
v_mfma_f32_16x16x32_bf16 v[204:207], v[64:67], v[56:59], v[204:207]
s_waitcnt lgkmcnt(12)
ds_read_b128 v[112:115], v18 offset:4096
v_mfma_f32_16x16x32_bf16 v[220:223], v[72:75], v[56:59], 0
s_add_u32 s72, s69, 129024
buffer_load_dwordx4 v4, s[4:7], s72 offen offset:2048 lds
v_mfma_f32_16x16x32_bf16 v[220:223], v[76:79], v[60:63], v[220:223]
s_add_u32 s80, s78, 8192
buffer_store_dwordx4 v[24:27], v1, s[44:47], s80 offen sc1
v_mfma_f32_16x16x32_bf16 v[216:219], v[76:79], v[52:55], 0
s_waitcnt vmcnt(21) lgkmcnt(2)
ds_read_b128 v[116:119], v19 offset:4096
v_mfma_f32_16x16x32_bf16 v[216:219], v[72:75], v[48:51], v[216:219]
s_barrier
ds_read_b128 v[120:123], v18 offset:6144
v_mfma_f32_16x16x32_bf16 v[212:215], v[72:75], v[40:43], 0
ds_read_b64_tr_b16 v[64:65], v8 offset:16384
ds_read_b64_tr_b16 v[66:67], v8 offset:17408
v_mfma_f32_16x16x32_bf16 v[212:215], v[76:79], v[44:47], v[212:215]
ds_read_b64_tr_b16 v[68:69], v8 offset:24576
v_mfma_f32_16x16x32_bf16 v[208:211], v[76:79], v[36:39], 0
s_add_u32 s72, s69, 144384
buffer_load_dwordx4 v5, s[4:7], s72 offen offset:3072 lds
v_mfma_f32_16x16x32_bf16 v[208:211], v[72:75], v[32:35], v[208:211]
ds_read_b64_tr_b16 v[70:71], v8 offset:25600
v_accvgpr_read_b32 v20, a16
v_mfma_f32_16x16x32_bf16 v[224:227], v[80:83], v[32:35], 0
ds_read_b64_tr_b16 v[72:73], v9 offset:16384
v_accvgpr_read_b32 v28, a17
v_mfma_f32_16x16x32_bf16 v[224:227], v[84:87], v[36:39], v[224:227]
ds_read_b64_tr_b16 v[74:75], v9 offset:17408
v_accvgpr_read_b32 v21, a18
v_mfma_f32_16x16x32_bf16 v[228:231], v[84:87], v[44:47], 0
s_add_u32 m0, s63, 135168
v_accvgpr_read_b32 v29, a19
v_accvgpr_read_b32 v22, a48
v_mfma_f32_16x16x32_bf16 v[228:231], v[80:83], v[40:43], v[228:231]
s_add_u32 s72, s70, 0
buffer_load_dwordx4 v4, s[4:7], s72 offen lds
v_mfma_f32_16x16x32_bf16 v[232:235], v[80:83], v[48:51], 0
ds_read_b64_tr_b16 v[76:77], v9 offset:24576
v_accvgpr_read_b32 v30, a49
v_mfma_f32_16x16x32_bf16 v[232:235], v[84:87], v[52:55], v[232:235]
ds_read_b128 v[124:127], v19 offset:6144
v_accvgpr_read_b32 v23, a50
v_mfma_f32_16x16x32_bf16 v[236:239], v[84:87], v[60:63], 0
ds_read_b64_tr_b16 v[78:79], v9 offset:25600
v_accvgpr_read_b32 v31, a51
v_mfma_f32_16x16x32_bf16 v[236:239], v[80:83], v[56:59], v[236:239]
v_mul_f32 v20, s79, v20
v_mul_f32 v28, s79, v28
v_mfma_f32_16x16x32_bf16 v[252:255], v[88:91], v[56:59], 0
s_add_u32 s72, s70, 15360
buffer_load_dwordx4 v5, s[4:7], s72 offen offset:1024 lds
v_mfma_f32_16x16x32_bf16 v[252:255], v[92:95], v[60:63], v[252:255]
ds_read_b64_tr_b16 v[80:81], v10 offset:16384
v_mul_f32 v21, s79, v21
v_mfma_f32_16x16x32_bf16 v[248:251], v[92:95], v[52:55], 0
ds_read_b64_tr_b16 v[82:83], v10 offset:17408
v_mul_f32 v29, s79, v29
v_mfma_f32_16x16x32_bf16 v[248:251], v[88:91], v[48:51], v[248:251]
v_mul_f32 v22, s79, v22
v_mul_f32 v30, s79, v30
v_mfma_f32_16x16x32_bf16 v[244:247], v[88:91], v[40:43], 0
ds_read_b64_tr_b16 v[84:85], v10 offset:24576
v_mul_f32 v23, s79, v23
v_mfma_f32_16x16x32_bf16 v[244:247], v[92:95], v[44:47], v[244:247]
ds_read_b64_tr_b16 v[86:87], v10 offset:25600
v_mul_f32 v31, s79, v31
v_mfma_f32_16x16x32_bf16 v[240:243], v[92:95], v[36:39], 0
s_add_u32 s72, s70, 129024
buffer_load_dwordx4 v4, s[4:7], s72 offen offset:2048 lds
v_mfma_f32_16x16x32_bf16 v[240:243], v[88:91], v[32:35], v[240:243]
s_waitcnt lgkmcnt(5)
v_cvt_pk_bf16_f32 v20, v20, v28
v_cvt_pk_bf16_f32 v21, v21, v29
v_mfma_f32_16x16x32_bf16 v[128:131], v[64:67], v[96:99], v[128:131]
ds_read_b64_tr_b16 v[88:89], v11 offset:16384
v_cvt_pk_bf16_f32 v22, v22, v30
v_mfma_f32_16x16x32_bf16 v[128:131], v[68:71], v[100:103], v[128:131]
ds_read_b64_tr_b16 v[90:91], v11 offset:17408
v_cvt_pk_bf16_f32 v23, v23, v31
v_mfma_f32_16x16x32_bf16 v[132:135], v[68:71], v[108:111], v[132:135]
s_add_u32 s80, s77, 32768
buffer_store_dwordx4 v[20:23], v1, s[44:47], s80 offen sc1
v_mfma_f32_16x16x32_bf16 v[132:135], v[64:67], v[104:107], v[132:135]
s_add_u32 s72, s70, 144384
buffer_load_dwordx4 v5, s[4:7], s72 offen offset:3072 lds
v_mfma_f32_16x16x32_bf16 v[136:139], v[64:67], v[112:115], v[136:139]
ds_read_b64_tr_b16 v[92:93], v11 offset:24576
v_accvgpr_read_b32 v24, a144
v_mfma_f32_16x16x32_bf16 v[136:139], v[68:71], v[116:119], v[136:139]
s_lshl_b32 s71, s73, 12
v_accvgpr_read_b32 v28, a145
v_accvgpr_read_b32 v25, a146
v_mfma_f32_16x16x32_bf16 v[140:143], v[68:71], v[124:127], v[140:143]
s_add_u32 s71, s71, s66
ds_read_b64_tr_b16 v[94:95], v11 offset:25600
v_accvgpr_read_b32 v29, a147
v_mfma_f32_16x16x32_bf16 v[140:143], v[64:67], v[120:123], v[140:143]
s_waitcnt lgkmcnt(8)
v_accvgpr_read_b32 v26, a148
v_accvgpr_read_b32 v30, a149
v_mfma_f32_16x16x32_bf16 v[156:159], v[72:75], v[120:123], v[156:159]
s_add_u32 m0, s64, 0
ds_read_b64_tr_b16 v[64:65], v12 offset:16384
v_accvgpr_read_b32 v27, a150
v_mfma_f32_16x16x32_bf16 v[156:159], v[76:79], v[124:127], v[156:159]
s_add_u32 s72, s71, 0
buffer_load_dwordx4 v6, s[12:15], s72 offen lds
v_mfma_f32_16x16x32_bf16 v[152:155], v[76:79], v[116:119], v[152:155]
s_add_u32 s73, s62, 4
ds_read_b64_tr_b16 v[66:67], v12 offset:17408
v_accvgpr_read_b32 v31, a151
v_mfma_f32_16x16x32_bf16 v[152:155], v[72:75], v[112:115], v[152:155]
s_add_u32 s70, s73, s65
v_cvt_pk_bf16_f32 v24, v24, v28
v_cvt_pk_bf16_f32 v25, v25, v29
v_mfma_f32_16x16x32_bf16 v[148:151], v[72:75], v[104:107], v[148:151]
s_and_b32 s70, s70, 3
ds_read_b64_tr_b16 v[68:69], v12 offset:24576
v_cvt_pk_bf16_f32 v26, v26, v30
v_mfma_f32_16x16x32_bf16 v[148:151], v[76:79], v[108:111], v[148:151]
s_and_b32 s73, s73, 12
ds_read_b64_tr_b16 v[70:71], v12 offset:25600
v_cvt_pk_bf16_f32 v27, v27, v31
v_mfma_f32_16x16x32_bf16 v[144:147], v[76:79], v[100:103], v[144:147]
s_add_u32 s72, s71, 31744
buffer_load_dwordx4 v6, s[12:15], s72 offen offset:1024 lds
v_mfma_f32_16x16x32_bf16 v[144:147], v[72:75], v[96:99], v[144:147]
s_waitcnt lgkmcnt(8)
v_mfma_f32_16x16x32_bf16 v[160:163], v[80:83], v[96:99], v[160:163]
s_or_b32 s73, s73, s70
ds_read_b64_tr_b16 v[72:73], v13 offset:16384
v_mfma_f32_16x16x32_bf16 v[160:163], v[84:87], v[100:103], v[160:163]
s_lshl_b32 s73, s73, 7
ds_read_b64_tr_b16 v[74:75], v13 offset:17408
v_mfma_f32_16x16x32_bf16 v[164:167], v[84:87], v[108:111], v[164:167]
s_add_u32 s69, s73, s67
v_mfma_f32_16x16x32_bf16 v[164:167], v[80:83], v[104:107], v[164:167]
s_add_u32 s72, s71, 63488
buffer_load_dwordx4 v7, s[12:15], s72 offen offset:2048 lds
v_mfma_f32_16x16x32_bf16 v[168:171], v[80:83], v[112:115], v[168:171]
s_waitcnt vmcnt(18)
ds_read_b64_tr_b16 v[76:77], v13 offset:24576
v_mfma_f32_16x16x32_bf16 v[168:171], v[84:87], v[116:119], v[168:171]
s_add_u32 s70, s73, s68
ds_read_b128 v[32:35], v18 offset:32768
v_mfma_f32_16x16x32_bf16 v[172:175], v[84:87], v[124:127], v[172:175]
s_add_u32 s80, s78, 32768
ds_read_b64_tr_b16 v[78:79], v13 offset:25600
v_mfma_f32_16x16x32_bf16 v[172:175], v[80:83], v[120:123], v[172:175]
s_waitcnt lgkmcnt(9)
ds_read_b128 v[36:39], v19 offset:32768
v_mfma_f32_16x16x32_bf16 v[188:191], v[88:91], v[120:123], v[188:191]
s_add_u32 s72, s71, 95232
buffer_load_dwordx4 v7, s[12:15], s72 offen offset:3072 lds
v_mfma_f32_16x16x32_bf16 v[188:191], v[92:95], v[124:127], v[188:191]
ds_read_b64_tr_b16 v[80:81], v14 offset:16384
v_mfma_f32_16x16x32_bf16 v[184:187], v[92:95], v[116:119], v[184:187]
ds_read_b64_tr_b16 v[82:83], v14 offset:17408
v_mfma_f32_16x16x32_bf16 v[184:187], v[88:91], v[112:115], v[184:187]
buffer_store_dwordx4 v[24:27], v1, s[44:47], s80 offen sc1
v_mfma_f32_16x16x32_bf16 v[180:183], v[88:91], v[104:107], v[180:183]
ds_read_b64_tr_b16 v[84:85], v14 offset:24576
v_accvgpr_read_b32 v20, a20
v_mfma_f32_16x16x32_bf16 v[180:183], v[92:95], v[108:111], v[180:183]
s_add_u32 m0, s63, 65536
ds_read_b64_tr_b16 v[86:87], v14 offset:25600
v_accvgpr_read_b32 v28, a21
v_mfma_f32_16x16x32_bf16 v[176:179], v[92:95], v[100:103], v[176:179]
s_add_u32 s72, s69, 0
buffer_load_dwordx4 v4, s[4:7], s72 offen lds
v_mfma_f32_16x16x32_bf16 v[176:179], v[88:91], v[96:99], v[176:179]
s_waitcnt lgkmcnt(10)
ds_read_b128 v[40:43], v18 offset:34816
v_accvgpr_read_b32 v21, a22
v_mfma_f32_16x16x32_bf16 v[192:195], v[64:67], v[96:99], v[192:195]
ds_read_b64_tr_b16 v[88:89], v15 offset:16384
v_accvgpr_read_b32 v29, a23
v_mfma_f32_16x16x32_bf16 v[192:195], v[68:71], v[100:103], v[192:195]
ds_read_b64_tr_b16 v[90:91], v15 offset:17408
v_accvgpr_read_b32 v22, a52
v_mfma_f32_16x16x32_bf16 v[196:199], v[68:71], v[108:111], v[196:199]
ds_read_b64_tr_b16 v[92:93], v15 offset:24576
v_accvgpr_read_b32 v30, a53
v_mfma_f32_16x16x32_bf16 v[196:199], v[64:67], v[104:107], v[196:199]
s_add_u32 s72, s69, 15360
buffer_load_dwordx4 v5, s[4:7], s72 offen offset:1024 lds
v_mfma_f32_16x16x32_bf16 v[200:203], v[64:67], v[112:115], v[200:203]
ds_read_b64_tr_b16 v[94:95], v15 offset:25600
v_accvgpr_read_b32 v23, a54
v_mfma_f32_16x16x32_bf16 v[200:203], v[68:71], v[116:119], v[200:203]
ds_read_b128 v[44:47], v19 offset:34816
v_accvgpr_read_b32 v31, a55
v_mfma_f32_16x16x32_bf16 v[204:207], v[68:71], v[124:127], v[204:207]
v_mul_f32 v20, s79, v20
v_mul_f32 v28, s79, v28
v_mfma_f32_16x16x32_bf16 v[204:207], v[64:67], v[120:123], v[204:207]
s_waitcnt lgkmcnt(11)
ds_read_b128 v[48:51], v18 offset:36864
v_mul_f32 v21, s79, v21
v_mfma_f32_16x16x32_bf16 v[220:223], v[72:75], v[120:123], v[220:223]
s_add_u32 s72, s69, 129024
buffer_load_dwordx4 v4, s[4:7], s72 offen offset:2048 lds
v_mfma_f32_16x16x32_bf16 v[220:223], v[76:79], v[124:127], v[220:223]
v_mul_f32 v29, s79, v29
v_mul_f32 v22, s79, v22
v_mfma_f32_16x16x32_bf16 v[216:219], v[76:79], v[116:119], v[216:219]
s_waitcnt vmcnt(19) lgkmcnt(2)
ds_read_b128 v[52:55], v19 offset:36864
v_mul_f32 v30, s79, v30
v_mfma_f32_16x16x32_bf16 v[216:219], v[72:75], v[112:115], v[216:219]
s_barrier
ds_read_b128 v[56:59], v18 offset:38912
v_mul_f32 v23, s79, v23
v_mfma_f32_16x16x32_bf16 v[212:215], v[72:75], v[104:107], v[212:215]
ds_read_b64_tr_b16 v[64:65], v8 offset:32768
ds_read_b64_tr_b16 v[66:67], v8 offset:33792
v_mfma_f32_16x16x32_bf16 v[212:215], v[76:79], v[108:111], v[212:215]
ds_read_b64_tr_b16 v[68:69], v8 offset:40960
v_mul_f32 v31, s79, v31
v_mfma_f32_16x16x32_bf16 v[208:211], v[76:79], v[100:103], v[208:211]
s_add_u32 s72, s69, 144384
buffer_load_dwordx4 v5, s[4:7], s72 offen offset:3072 lds
v_mfma_f32_16x16x32_bf16 v[208:211], v[72:75], v[96:99], v[208:211]
ds_read_b64_tr_b16 v[70:71], v8 offset:41984
v_cvt_pk_bf16_f32 v20, v20, v28
v_mfma_f32_16x16x32_bf16 v[224:227], v[80:83], v[96:99], v[224:227]
ds_read_b64_tr_b16 v[72:73], v9 offset:32768
v_cvt_pk_bf16_f32 v21, v21, v29
v_mfma_f32_16x16x32_bf16 v[224:227], v[84:87], v[100:103], v[224:227]
ds_read_b64_tr_b16 v[74:75], v9 offset:33792
v_cvt_pk_bf16_f32 v22, v22, v30
v_mfma_f32_16x16x32_bf16 v[228:231], v[84:87], v[108:111], v[228:231]
s_add_u32 m0, s63, 69632
v_cvt_pk_bf16_f32 v23, v23, v31
v_accvgpr_read_b32 v24, a152
v_mfma_f32_16x16x32_bf16 v[228:231], v[80:83], v[104:107], v[228:231]
s_add_u32 s72, s70, 0
buffer_load_dwordx4 v4, s[4:7], s72 offen lds
v_mfma_f32_16x16x32_bf16 v[232:235], v[80:83], v[112:115], v[232:235]
s_add_u32 s80, s77, 36864
ds_read_b64_tr_b16 v[76:77], v9 offset:40960
v_accvgpr_read_b32 v28, a153
v_mfma_f32_16x16x32_bf16 v[232:235], v[84:87], v[116:119], v[232:235]
ds_read_b128 v[60:63], v19 offset:38912
v_accvgpr_read_b32 v25, a154
v_mfma_f32_16x16x32_bf16 v[236:239], v[84:87], v[124:127], v[236:239]
ds_read_b64_tr_b16 v[78:79], v9 offset:41984
v_accvgpr_read_b32 v29, a155
v_mfma_f32_16x16x32_bf16 v[236:239], v[80:83], v[120:123], v[236:239]
buffer_store_dwordx4 v[20:23], v1, s[44:47], s80 offen sc1
v_mfma_f32_16x16x32_bf16 v[252:255], v[88:91], v[120:123], v[252:255]
s_add_u32 s72, s70, 15360
buffer_load_dwordx4 v5, s[4:7], s72 offen offset:1024 lds
v_mfma_f32_16x16x32_bf16 v[252:255], v[92:95], v[124:127], v[252:255]
ds_read_b64_tr_b16 v[80:81], v10 offset:32768
v_accvgpr_read_b32 v26, a156
v_mfma_f32_16x16x32_bf16 v[248:251], v[92:95], v[116:119], v[248:251]
ds_read_b64_tr_b16 v[82:83], v10 offset:33792
v_accvgpr_read_b32 v30, a157
v_mfma_f32_16x16x32_bf16 v[248:251], v[88:91], v[112:115], v[248:251]
v_accvgpr_read_b32 v27, a158
v_accvgpr_read_b32 v31, a159
v_mfma_f32_16x16x32_bf16 v[244:247], v[88:91], v[104:107], v[244:247]
ds_read_b64_tr_b16 v[84:85], v10 offset:40960
v_cvt_pk_bf16_f32 v24, v24, v28
v_mfma_f32_16x16x32_bf16 v[244:247], v[92:95], v[108:111], v[244:247]
ds_read_b64_tr_b16 v[86:87], v10 offset:41984
v_cvt_pk_bf16_f32 v25, v25, v29
v_mfma_f32_16x16x32_bf16 v[240:243], v[92:95], v[100:103], v[240:243]
s_add_u32 s72, s70, 129024
buffer_load_dwordx4 v4, s[4:7], s72 offen offset:2048 lds
v_mfma_f32_16x16x32_bf16 v[240:243], v[88:91], v[96:99], v[240:243]
s_waitcnt lgkmcnt(5)
v_cvt_pk_bf16_f32 v26, v26, v30
v_cvt_pk_bf16_f32 v27, v27, v31
v_mfma_f32_16x16x32_bf16 v[128:131], v[64:67], v[32:35], v[128:131]
s_add_u32 s80, s78, 40960
ds_read_b64_tr_b16 v[88:89], v11 offset:32768
v_mfma_f32_16x16x32_bf16 v[128:131], v[68:71], v[36:39], v[128:131]
ds_read_b64_tr_b16 v[90:91], v11 offset:33792
v_mfma_f32_16x16x32_bf16 v[132:135], v[68:71], v[44:47], v[132:135]
buffer_store_dwordx4 v[24:27], v1, s[44:47], s80 offen sc1
v_mfma_f32_16x16x32_bf16 v[132:135], v[64:67], v[40:43], v[132:135]
s_add_u32 s72, s70, 144384
buffer_load_dwordx4 v5, s[4:7], s72 offen offset:3072 lds
v_mfma_f32_16x16x32_bf16 v[136:139], v[64:67], v[48:51], v[136:139]
ds_read_b64_tr_b16 v[92:93], v11 offset:40960
v_mfma_f32_16x16x32_bf16 v[136:139], v[68:71], v[52:55], v[136:139]
s_lshl_b32 s71, s73, 12
v_mfma_f32_16x16x32_bf16 v[140:143], v[68:71], v[60:63], v[140:143]
s_add_u32 s71, s71, s66
ds_read_b64_tr_b16 v[94:95], v11 offset:41984
v_mfma_f32_16x16x32_bf16 v[140:143], v[64:67], v[56:59], v[140:143]
s_waitcnt lgkmcnt(8)
v_accvgpr_read_b32 v20, a24
v_accvgpr_read_b32 v28, a25
v_mfma_f32_16x16x32_bf16 v[156:159], v[72:75], v[56:59], v[156:159]
s_add_u32 m0, s64, 16384
ds_read_b64_tr_b16 v[64:65], v12 offset:32768
v_accvgpr_read_b32 v21, a26
v_mfma_f32_16x16x32_bf16 v[156:159], v[76:79], v[60:63], v[156:159]
s_add_u32 s72, s71, 0
buffer_load_dwordx4 v6, s[12:15], s72 offen lds
v_mfma_f32_16x16x32_bf16 v[152:155], v[76:79], v[52:55], v[152:155]
s_add_u32 s73, s62, 5
ds_read_b64_tr_b16 v[66:67], v12 offset:33792
v_accvgpr_read_b32 v29, a27
v_mfma_f32_16x16x32_bf16 v[152:155], v[72:75], v[48:51], v[152:155]
s_add_u32 s70, s73, s65
v_accvgpr_read_b32 v22, a56
v_accvgpr_read_b32 v30, a57
v_mfma_f32_16x16x32_bf16 v[148:151], v[72:75], v[40:43], v[148:151]
s_and_b32 s70, s70, 3
ds_read_b64_tr_b16 v[68:69], v12 offset:40960
v_accvgpr_read_b32 v23, a58
v_mfma_f32_16x16x32_bf16 v[148:151], v[76:79], v[44:47], v[148:151]
s_and_b32 s73, s73, 12
ds_read_b64_tr_b16 v[70:71], v12 offset:41984
v_accvgpr_read_b32 v31, a59
v_mfma_f32_16x16x32_bf16 v[144:147], v[76:79], v[36:39], v[144:147]
s_add_u32 s72, s71, 31744
buffer_load_dwordx4 v6, s[12:15], s72 offen offset:1024 lds
v_mfma_f32_16x16x32_bf16 v[144:147], v[72:75], v[32:35], v[144:147]
s_waitcnt lgkmcnt(8)
v_mul_f32 v20, s79, v20
v_mul_f32 v28, s79, v28
v_mfma_f32_16x16x32_bf16 v[160:163], v[80:83], v[32:35], v[160:163]
s_or_b32 s73, s73, s70
ds_read_b64_tr_b16 v[72:73], v13 offset:32768
v_mul_f32 v21, s79, v21
v_mfma_f32_16x16x32_bf16 v[160:163], v[84:87], v[36:39], v[160:163]
s_lshl_b32 s73, s73, 7
ds_read_b64_tr_b16 v[74:75], v13 offset:33792
v_mul_f32 v29, s79, v29
v_mfma_f32_16x16x32_bf16 v[164:167], v[84:87], v[44:47], v[164:167]
s_add_u32 s69, s73, s67
v_mul_f32 v22, s79, v22
v_mul_f32 v30, s79, v30
v_mfma_f32_16x16x32_bf16 v[164:167], v[80:83], v[40:43], v[164:167]
s_add_u32 s72, s71, 63488
buffer_load_dwordx4 v7, s[12:15], s72 offen offset:2048 lds
v_mfma_f32_16x16x32_bf16 v[168:171], v[80:83], v[48:51], v[168:171]
s_waitcnt vmcnt(18)
ds_read_b64_tr_b16 v[76:77], v13 offset:40960
v_mul_f32 v23, s79, v23
v_mfma_f32_16x16x32_bf16 v[168:171], v[84:87], v[52:55], v[168:171]
s_add_u32 s70, s73, s68
ds_read_b128 v[96:99], v16 offset:0
v_mul_f32 v31, s79, v31
v_mfma_f32_16x16x32_bf16 v[172:175], v[84:87], v[60:63], v[172:175]
ds_read_b64_tr_b16 v[78:79], v13 offset:41984
v_cvt_pk_bf16_f32 v20, v20, v28
v_mfma_f32_16x16x32_bf16 v[172:175], v[80:83], v[56:59], v[172:175]
s_waitcnt lgkmcnt(9)
ds_read_b128 v[100:103], v17 offset:0
v_cvt_pk_bf16_f32 v21, v21, v29
v_mfma_f32_16x16x32_bf16 v[188:191], v[88:91], v[56:59], v[188:191]
s_add_u32 s72, s71, 95232
buffer_load_dwordx4 v7, s[12:15], s72 offen offset:3072 lds
v_mfma_f32_16x16x32_bf16 v[188:191], v[92:95], v[60:63], v[188:191]
ds_read_b64_tr_b16 v[80:81], v14 offset:32768
v_cvt_pk_bf16_f32 v22, v22, v30
v_mfma_f32_16x16x32_bf16 v[184:187], v[92:95], v[52:55], v[184:187]
ds_read_b64_tr_b16 v[82:83], v14 offset:33792
v_cvt_pk_bf16_f32 v23, v23, v31
v_mfma_f32_16x16x32_bf16 v[184:187], v[88:91], v[48:51], v[184:187]
s_add_u32 s80, s77, 40960
buffer_store_dwordx4 v[20:23], v1, s[44:47], s80 offen sc1
v_mfma_f32_16x16x32_bf16 v[180:183], v[88:91], v[40:43], v[180:183]
ds_read_b64_tr_b16 v[84:85], v14 offset:40960
v_mfma_f32_16x16x32_bf16 v[180:183], v[92:95], v[44:47], v[180:183]
s_add_u32 m0, s63, 98304
ds_read_b64_tr_b16 v[86:87], v14 offset:41984
v_accvgpr_read_b32 v24, a160
v_mfma_f32_16x16x32_bf16 v[176:179], v[92:95], v[36:39], v[176:179]
s_add_u32 s72, s69, 0
buffer_load_dwordx4 v4, s[4:7], s72 offen lds
v_mfma_f32_16x16x32_bf16 v[176:179], v[88:91], v[32:35], v[176:179]
s_waitcnt lgkmcnt(10)
ds_read_b128 v[104:107], v16 offset:2048
v_accvgpr_read_b32 v28, a161
v_mfma_f32_16x16x32_bf16 v[192:195], v[64:67], v[32:35], v[192:195]
ds_read_b64_tr_b16 v[88:89], v15 offset:32768
v_accvgpr_read_b32 v25, a162
v_mfma_f32_16x16x32_bf16 v[192:195], v[68:71], v[36:39], v[192:195]
ds_read_b64_tr_b16 v[90:91], v15 offset:33792
v_accvgpr_read_b32 v29, a163
v_mfma_f32_16x16x32_bf16 v[196:199], v[68:71], v[44:47], v[196:199]
ds_read_b64_tr_b16 v[92:93], v15 offset:40960
v_accvgpr_read_b32 v26, a164
v_mfma_f32_16x16x32_bf16 v[196:199], v[64:67], v[40:43], v[196:199]
s_add_u32 s72, s69, 15360
buffer_load_dwordx4 v5, s[4:7], s72 offen offset:1024 lds
v_mfma_f32_16x16x32_bf16 v[200:203], v[64:67], v[48:51], v[200:203]
ds_read_b64_tr_b16 v[94:95], v15 offset:41984
v_accvgpr_read_b32 v30, a165
v_mfma_f32_16x16x32_bf16 v[200:203], v[68:71], v[52:55], v[200:203]
ds_read_b128 v[108:111], v17 offset:2048
v_accvgpr_read_b32 v27, a166
v_mfma_f32_16x16x32_bf16 v[204:207], v[68:71], v[60:63], v[204:207]
v_accvgpr_read_b32 v31, a167
v_cvt_pk_bf16_f32 v24, v24, v28
v_mfma_f32_16x16x32_bf16 v[204:207], v[64:67], v[56:59], v[204:207]
s_waitcnt lgkmcnt(11)
ds_read_b128 v[112:115], v16 offset:4096
v_cvt_pk_bf16_f32 v25, v25, v29
v_mfma_f32_16x16x32_bf16 v[220:223], v[72:75], v[56:59], v[220:223]
s_add_u32 s72, s69, 129024
buffer_load_dwordx4 v4, s[4:7], s72 offen offset:2048 lds
v_mfma_f32_16x16x32_bf16 v[220:223], v[76:79], v[60:63], v[220:223]
v_cvt_pk_bf16_f32 v26, v26, v30
v_cvt_pk_bf16_f32 v27, v27, v31
v_mfma_f32_16x16x32_bf16 v[216:219], v[76:79], v[52:55], v[216:219]
s_waitcnt vmcnt(19) lgkmcnt(2)
ds_read_b128 v[116:119], v17 offset:4096
v_mfma_f32_16x16x32_bf16 v[216:219], v[72:75], v[48:51], v[216:219]
s_barrier
ds_read_b128 v[120:123], v16 offset:6144
v_mfma_f32_16x16x32_bf16 v[212:215], v[72:75], v[40:43], v[212:215]
s_add_u32 s80, s78, 1024
ds_read_b64_tr_b16 v[64:65], v8 offset:0
ds_read_b64_tr_b16 v[66:67], v8 offset:1024
v_mfma_f32_16x16x32_bf16 v[212:215], v[76:79], v[44:47], v[212:215]
ds_read_b64_tr_b16 v[68:69], v8 offset:8192
v_mfma_f32_16x16x32_bf16 v[208:211], v[76:79], v[36:39], v[208:211]
s_add_u32 s72, s69, 144384
buffer_load_dwordx4 v5, s[4:7], s72 offen offset:3072 lds
v_mfma_f32_16x16x32_bf16 v[208:211], v[72:75], v[32:35], v[208:211]
ds_read_b64_tr_b16 v[70:71], v8 offset:9216
v_mfma_f32_16x16x32_bf16 v[224:227], v[80:83], v[32:35], v[224:227]
ds_read_b64_tr_b16 v[72:73], v9 offset:0
v_mfma_f32_16x16x32_bf16 v[224:227], v[84:87], v[36:39], v[224:227]
ds_read_b64_tr_b16 v[74:75], v9 offset:1024
v_mfma_f32_16x16x32_bf16 v[228:231], v[84:87], v[44:47], v[228:231]
s_add_u32 m0, s63, 102400
buffer_store_dwordx4 v[24:27], v1, s[44:47], s80 offen sc1
v_mfma_f32_16x16x32_bf16 v[228:231], v[80:83], v[40:43], v[228:231]
s_add_u32 s72, s70, 0
buffer_load_dwordx4 v4, s[4:7], s72 offen lds
v_mfma_f32_16x16x32_bf16 v[232:235], v[80:83], v[48:51], v[232:235]
ds_read_b64_tr_b16 v[76:77], v9 offset:8192
v_accvgpr_read_b32 v20, a28
v_mfma_f32_16x16x32_bf16 v[232:235], v[84:87], v[52:55], v[232:235]
ds_read_b128 v[124:127], v17 offset:6144
v_accvgpr_read_b32 v28, a29
v_mfma_f32_16x16x32_bf16 v[236:239], v[84:87], v[60:63], v[236:239]
ds_read_b64_tr_b16 v[78:79], v9 offset:9216
v_accvgpr_read_b32 v21, a30
v_mfma_f32_16x16x32_bf16 v[236:239], v[80:83], v[56:59], v[236:239]
v_accvgpr_read_b32 v29, a31
v_accvgpr_read_b32 v22, a60
v_mfma_f32_16x16x32_bf16 v[252:255], v[88:91], v[56:59], v[252:255]
s_add_u32 s72, s70, 15360
buffer_load_dwordx4 v5, s[4:7], s72 offen offset:1024 lds
v_mfma_f32_16x16x32_bf16 v[252:255], v[92:95], v[60:63], v[252:255]
ds_read_b64_tr_b16 v[80:81], v10 offset:0
v_accvgpr_read_b32 v30, a61
v_mfma_f32_16x16x32_bf16 v[248:251], v[92:95], v[52:55], v[248:251]
ds_read_b64_tr_b16 v[82:83], v10 offset:1024
v_accvgpr_read_b32 v23, a62
v_mfma_f32_16x16x32_bf16 v[248:251], v[88:91], v[48:51], v[248:251]
v_accvgpr_read_b32 v31, a63
v_mul_f32 v20, s79, v20
v_mfma_f32_16x16x32_bf16 v[244:247], v[88:91], v[40:43], v[244:247]
ds_read_b64_tr_b16 v[84:85], v10 offset:8192
v_mul_f32 v28, s79, v28
v_mfma_f32_16x16x32_bf16 v[244:247], v[92:95], v[44:47], v[244:247]
ds_read_b64_tr_b16 v[86:87], v10 offset:9216
v_mul_f32 v21, s79, v21
v_mfma_f32_16x16x32_bf16 v[240:243], v[92:95], v[36:39], v[240:243]
s_add_u32 s72, s70, 129024
buffer_load_dwordx4 v4, s[4:7], s72 offen offset:2048 lds
v_mfma_f32_16x16x32_bf16 v[240:243], v[88:91], v[32:35], v[240:243]
s_waitcnt lgkmcnt(5)
v_mul_f32 v29, s79, v29
v_mul_f32 v22, s79, v22
v_mfma_f32_16x16x32_bf16 v[128:131], v[64:67], v[96:99], v[128:131]
ds_read_b64_tr_b16 v[88:89], v11 offset:0
v_mul_f32 v30, s79, v30
v_mfma_f32_16x16x32_bf16 v[128:131], v[68:71], v[100:103], v[128:131]
ds_read_b64_tr_b16 v[90:91], v11 offset:1024
v_mul_f32 v23, s79, v23
v_mfma_f32_16x16x32_bf16 v[132:135], v[68:71], v[108:111], v[132:135]
v_mul_f32 v31, s79, v31
v_cvt_pk_bf16_f32 v20, v20, v28
v_mfma_f32_16x16x32_bf16 v[132:135], v[64:67], v[104:107], v[132:135]
s_add_u32 s72, s70, 144384
buffer_load_dwordx4 v5, s[4:7], s72 offen offset:3072 lds
v_mfma_f32_16x16x32_bf16 v[136:139], v[64:67], v[112:115], v[136:139]
ds_read_b64_tr_b16 v[92:93], v11 offset:8192
v_cvt_pk_bf16_f32 v21, v21, v29
v_mfma_f32_16x16x32_bf16 v[136:139], v[68:71], v[116:119], v[136:139]
s_lshl_b32 s71, s73, 12
v_cvt_pk_bf16_f32 v22, v22, v30
v_cvt_pk_bf16_f32 v23, v23, v31
v_mfma_f32_16x16x32_bf16 v[140:143], v[68:71], v[124:127], v[140:143]
s_add_u32 s71, s71, s66
ds_read_b64_tr_b16 v[94:95], v11 offset:9216
v_mfma_f32_16x16x32_bf16 v[140:143], v[64:67], v[120:123], v[140:143]
s_waitcnt lgkmcnt(8)
v_mfma_f32_16x16x32_bf16 v[156:159], v[72:75], v[120:123], v[156:159]
s_add_u32 m0, s64, 32768
ds_read_b64_tr_b16 v[64:65], v12 offset:0
v_mfma_f32_16x16x32_bf16 v[156:159], v[76:79], v[124:127], v[156:159]
s_add_u32 s72, s71, 0
buffer_load_dwordx4 v6, s[12:15], s72 offen lds
v_mfma_f32_16x16x32_bf16 v[152:155], v[76:79], v[116:119], v[152:155]
s_add_u32 s73, s62, 6
ds_read_b64_tr_b16 v[66:67], v12 offset:1024
v_accvgpr_read_b32 v24, a168
v_mfma_f32_16x16x32_bf16 v[152:155], v[72:75], v[112:115], v[152:155]
s_add_u32 s70, s73, s65
v_accvgpr_read_b32 v28, a169
v_accvgpr_read_b32 v25, a170
v_mfma_f32_16x16x32_bf16 v[148:151], v[72:75], v[104:107], v[148:151]
s_and_b32 s70, s70, 3
ds_read_b64_tr_b16 v[68:69], v12 offset:8192
v_accvgpr_read_b32 v29, a171
v_mfma_f32_16x16x32_bf16 v[148:151], v[76:79], v[108:111], v[148:151]
s_and_b32 s73, s73, 12
ds_read_b64_tr_b16 v[70:71], v12 offset:9216
v_accvgpr_read_b32 v26, a172
v_mfma_f32_16x16x32_bf16 v[144:147], v[76:79], v[100:103], v[144:147]
s_add_u32 s72, s71, 31744
buffer_load_dwordx4 v6, s[12:15], s72 offen offset:1024 lds
v_mfma_f32_16x16x32_bf16 v[144:147], v[72:75], v[96:99], v[144:147]
s_waitcnt lgkmcnt(8)
v_accvgpr_read_b32 v30, a173
v_accvgpr_read_b32 v27, a174
v_mfma_f32_16x16x32_bf16 v[160:163], v[80:83], v[96:99], v[160:163]
s_or_b32 s73, s73, s70
ds_read_b64_tr_b16 v[72:73], v13 offset:0
v_accvgpr_read_b32 v31, a175
v_mfma_f32_16x16x32_bf16 v[160:163], v[84:87], v[100:103], v[160:163]
s_lshl_b32 s73, s73, 7
ds_read_b64_tr_b16 v[74:75], v13 offset:1024
v_cvt_pk_bf16_f32 v24, v24, v28
v_mfma_f32_16x16x32_bf16 v[164:167], v[84:87], v[108:111], v[164:167]
s_add_u32 s69, s73, s67
v_cvt_pk_bf16_f32 v25, v25, v29
v_cvt_pk_bf16_f32 v26, v26, v30
v_mfma_f32_16x16x32_bf16 v[164:167], v[80:83], v[104:107], v[164:167]
s_add_u32 s72, s71, 63488
buffer_load_dwordx4 v7, s[12:15], s72 offen offset:2048 lds
v_mfma_f32_16x16x32_bf16 v[168:171], v[80:83], v[112:115], v[168:171]
s_waitcnt vmcnt(17)
ds_read_b64_tr_b16 v[76:77], v13 offset:8192
v_cvt_pk_bf16_f32 v27, v27, v31
v_mfma_f32_16x16x32_bf16 v[168:171], v[84:87], v[116:119], v[168:171]
s_add_u32 s70, s73, s68
ds_read_b128 v[32:35], v18 offset:0
v_mfma_f32_16x16x32_bf16 v[172:175], v[84:87], v[124:127], v[172:175]
s_add_u32 s80, s77, 45056
ds_read_b64_tr_b16 v[78:79], v13 offset:9216
v_mfma_f32_16x16x32_bf16 v[172:175], v[80:83], v[120:123], v[172:175]
s_waitcnt lgkmcnt(9)
ds_read_b128 v[36:39], v19 offset:0
v_mfma_f32_16x16x32_bf16 v[188:191], v[88:91], v[120:123], v[188:191]
s_add_u32 s72, s71, 95232
buffer_load_dwordx4 v7, s[12:15], s72 offen offset:3072 lds
v_mfma_f32_16x16x32_bf16 v[188:191], v[92:95], v[124:127], v[188:191]
ds_read_b64_tr_b16 v[80:81], v14 offset:0
v_mfma_f32_16x16x32_bf16 v[184:187], v[92:95], v[116:119], v[184:187]
ds_read_b64_tr_b16 v[82:83], v14 offset:1024
v_mfma_f32_16x16x32_bf16 v[184:187], v[88:91], v[112:115], v[184:187]
buffer_store_dwordx4 v[20:23], v1, s[44:47], s80 offen sc1
v_mfma_f32_16x16x32_bf16 v[180:183], v[88:91], v[104:107], v[180:183]
s_add_u32 s80, s78, 9216
ds_read_b64_tr_b16 v[84:85], v14 offset:8192
v_mfma_f32_16x16x32_bf16 v[180:183], v[92:95], v[108:111], v[180:183]
s_add_u32 m0, s63, 131072
ds_read_b64_tr_b16 v[86:87], v14 offset:9216
v_mfma_f32_16x16x32_bf16 v[176:179], v[92:95], v[100:103], v[176:179]
s_add_u32 s72, s69, 0
buffer_load_dwordx4 v4, s[4:7], s72 offen lds
v_mfma_f32_16x16x32_bf16 v[176:179], v[88:91], v[96:99], v[176:179]
s_waitcnt lgkmcnt(10)
ds_read_b128 v[40:43], v18 offset:2048
v_accvgpr_read_b32 v20, a64
v_mfma_f32_16x16x32_bf16 v[192:195], v[64:67], v[96:99], v[192:195]
ds_read_b64_tr_b16 v[88:89], v15 offset:0
v_accvgpr_read_b32 v28, a65
v_mfma_f32_16x16x32_bf16 v[192:195], v[68:71], v[100:103], v[192:195]
ds_read_b64_tr_b16 v[90:91], v15 offset:1024
v_accvgpr_read_b32 v21, a66
v_mfma_f32_16x16x32_bf16 v[196:199], v[68:71], v[108:111], v[196:199]
ds_read_b64_tr_b16 v[92:93], v15 offset:8192
v_accvgpr_read_b32 v29, a67
v_mfma_f32_16x16x32_bf16 v[196:199], v[64:67], v[104:107], v[196:199]
s_add_u32 s72, s69, 15360
buffer_load_dwordx4 v5, s[4:7], s72 offen offset:1024 lds
v_mfma_f32_16x16x32_bf16 v[200:203], v[64:67], v[112:115], v[200:203]
ds_read_b64_tr_b16 v[94:95], v15 offset:9216
v_accvgpr_read_b32 v22, a96
v_mfma_f32_16x16x32_bf16 v[200:203], v[68:71], v[116:119], v[200:203]
ds_read_b128 v[44:47], v19 offset:2048
v_accvgpr_read_b32 v30, a97
v_mfma_f32_16x16x32_bf16 v[204:207], v[68:71], v[124:127], v[204:207]
buffer_store_dwordx4 v[24:27], v1, s[44:47], s80 offen sc1
v_mfma_f32_16x16x32_bf16 v[204:207], v[64:67], v[120:123], v[204:207]
s_waitcnt lgkmcnt(11)
ds_read_b128 v[48:51], v18 offset:4096
v_accvgpr_read_b32 v23, a98
v_mfma_f32_16x16x32_bf16 v[220:223], v[72:75], v[120:123], v[220:223]
s_add_u32 s72, s69, 129024
buffer_load_dwordx4 v4, s[4:7], s72 offen offset:2048 lds
v_mfma_f32_16x16x32_bf16 v[220:223], v[76:79], v[124:127], v[220:223]
v_accvgpr_read_b32 v31, a99
v_mul_f32 v20, s79, v20
v_mfma_f32_16x16x32_bf16 v[216:219], v[76:79], v[116:119], v[216:219]
s_waitcnt vmcnt(19) lgkmcnt(2)
ds_read_b128 v[52:55], v19 offset:4096
v_mul_f32 v28, s79, v28
v_mfma_f32_16x16x32_bf16 v[216:219], v[72:75], v[112:115], v[216:219]
s_barrier
ds_read_b128 v[56:59], v18 offset:6144
v_mul_f32 v21, s79, v21
v_mfma_f32_16x16x32_bf16 v[212:215], v[72:75], v[104:107], v[212:215]
ds_read_b64_tr_b16 v[64:65], v8 offset:16384
ds_read_b64_tr_b16 v[66:67], v8 offset:17408
v_mfma_f32_16x16x32_bf16 v[212:215], v[76:79], v[108:111], v[212:215]
ds_read_b64_tr_b16 v[68:69], v8 offset:24576
v_mul_f32 v29, s79, v29
v_mfma_f32_16x16x32_bf16 v[208:211], v[76:79], v[100:103], v[208:211]
s_add_u32 s72, s69, 144384
buffer_load_dwordx4 v5, s[4:7], s72 offen offset:3072 lds
v_mfma_f32_16x16x32_bf16 v[208:211], v[72:75], v[96:99], v[208:211]
ds_read_b64_tr_b16 v[70:71], v8 offset:25600
v_mul_f32 v22, s79, v22
v_mfma_f32_16x16x32_bf16 v[224:227], v[80:83], v[96:99], v[224:227]
ds_read_b64_tr_b16 v[72:73], v9 offset:16384
v_mul_f32 v30, s79, v30
v_mfma_f32_16x16x32_bf16 v[224:227], v[84:87], v[100:103], v[224:227]
ds_read_b64_tr_b16 v[74:75], v9 offset:17408
v_mul_f32 v23, s79, v23
v_mfma_f32_16x16x32_bf16 v[228:231], v[84:87], v[108:111], v[228:231]
s_add_u32 m0, s63, 135168
v_mul_f32 v31, s79, v31
v_cvt_pk_bf16_f32 v20, v20, v28
v_mfma_f32_16x16x32_bf16 v[228:231], v[80:83], v[104:107], v[228:231]
s_add_u32 s72, s70, 0
buffer_load_dwordx4 v4, s[4:7], s72 offen lds
v_mfma_f32_16x16x32_bf16 v[232:235], v[80:83], v[112:115], v[232:235]
ds_read_b64_tr_b16 v[76:77], v9 offset:24576
v_cvt_pk_bf16_f32 v21, v21, v29
v_mfma_f32_16x16x32_bf16 v[232:235], v[84:87], v[116:119], v[232:235]
ds_read_b128 v[60:63], v19 offset:6144
v_cvt_pk_bf16_f32 v22, v22, v30
v_mfma_f32_16x16x32_bf16 v[236:239], v[84:87], v[124:127], v[236:239]
ds_read_b64_tr_b16 v[78:79], v9 offset:25600
v_cvt_pk_bf16_f32 v23, v23, v31
v_mfma_f32_16x16x32_bf16 v[236:239], v[80:83], v[120:123], v[236:239]
s_add_u32 s80, s77, 1024
buffer_store_dwordx4 v[20:23], v1, s[44:47], s80 offen sc1
v_mfma_f32_16x16x32_bf16 v[252:255], v[88:91], v[120:123], v[252:255]
s_add_u32 s72, s70, 15360
buffer_load_dwordx4 v5, s[4:7], s72 offen offset:1024 lds
v_mfma_f32_16x16x32_bf16 v[252:255], v[92:95], v[124:127], v[252:255]
ds_read_b64_tr_b16 v[80:81], v10 offset:16384
v_accvgpr_read_b32 v24, a176
v_mfma_f32_16x16x32_bf16 v[248:251], v[92:95], v[116:119], v[248:251]
ds_read_b64_tr_b16 v[82:83], v10 offset:17408
v_accvgpr_read_b32 v28, a177
v_mfma_f32_16x16x32_bf16 v[248:251], v[88:91], v[112:115], v[248:251]
v_accvgpr_read_b32 v25, a178
v_accvgpr_read_b32 v29, a179
v_mfma_f32_16x16x32_bf16 v[244:247], v[88:91], v[104:107], v[244:247]
ds_read_b64_tr_b16 v[84:85], v10 offset:24576
v_accvgpr_read_b32 v26, a180
v_mfma_f32_16x16x32_bf16 v[244:247], v[92:95], v[108:111], v[244:247]
ds_read_b64_tr_b16 v[86:87], v10 offset:25600
v_accvgpr_read_b32 v30, a181
v_mfma_f32_16x16x32_bf16 v[240:243], v[92:95], v[100:103], v[240:243]
s_add_u32 s72, s70, 129024
buffer_load_dwordx4 v4, s[4:7], s72 offen offset:2048 lds
v_mfma_f32_16x16x32_bf16 v[240:243], v[88:91], v[96:99], v[240:243]
s_waitcnt lgkmcnt(5)
v_accvgpr_read_b32 v27, a182
v_accvgpr_read_b32 v31, a183
v_mfma_f32_16x16x32_bf16 v[128:131], v[64:67], v[32:35], v[128:131]
ds_read_b64_tr_b16 v[88:89], v11 offset:16384
v_cvt_pk_bf16_f32 v24, v24, v28
v_mfma_f32_16x16x32_bf16 v[128:131], v[68:71], v[36:39], v[128:131]
ds_read_b64_tr_b16 v[90:91], v11 offset:17408
v_cvt_pk_bf16_f32 v25, v25, v29
v_mfma_f32_16x16x32_bf16 v[132:135], v[68:71], v[44:47], v[132:135]
v_cvt_pk_bf16_f32 v26, v26, v30
v_cvt_pk_bf16_f32 v27, v27, v31
v_mfma_f32_16x16x32_bf16 v[132:135], v[64:67], v[40:43], v[132:135]
s_add_u32 s72, s70, 144384
buffer_load_dwordx4 v5, s[4:7], s72 offen offset:3072 lds
v_mfma_f32_16x16x32_bf16 v[136:139], v[64:67], v[48:51], v[136:139]
s_add_u32 s80, s78, 33792
ds_read_b64_tr_b16 v[92:93], v11 offset:24576
v_mfma_f32_16x16x32_bf16 v[136:139], v[68:71], v[52:55], v[136:139]
s_lshl_b32 s71, s73, 12
buffer_store_dwordx4 v[24:27], v1, s[44:47], s80 offen sc1
v_mfma_f32_16x16x32_bf16 v[140:143], v[68:71], v[60:63], v[140:143]
s_add_u32 s71, s71, s66
ds_read_b64_tr_b16 v[94:95], v11 offset:25600
v_mfma_f32_16x16x32_bf16 v[140:143], v[64:67], v[56:59], v[140:143]
s_waitcnt lgkmcnt(8)
v_mfma_f32_16x16x32_bf16 v[156:159], v[72:75], v[56:59], v[156:159]
s_add_u32 m0, s64, 0
ds_read_b64_tr_b16 v[64:65], v12 offset:16384
v_mfma_f32_16x16x32_bf16 v[156:159], v[76:79], v[60:63], v[156:159]
s_add_u32 s72, s71, 0
buffer_load_dwordx4 v6, s[12:15], s72 offen lds
v_mfma_f32_16x16x32_bf16 v[152:155], v[76:79], v[52:55], v[152:155]
s_add_u32 s73, s62, 7
ds_read_b64_tr_b16 v[66:67], v12 offset:17408
v_mfma_f32_16x16x32_bf16 v[152:155], v[72:75], v[48:51], v[152:155]
s_add_u32 s70, s73, s65
v_mfma_f32_16x16x32_bf16 v[148:151], v[72:75], v[40:43], v[148:151]
s_and_b32 s70, s70, 3
ds_read_b64_tr_b16 v[68:69], v12 offset:24576
v_accvgpr_read_b32 v20, a68
v_mfma_f32_16x16x32_bf16 v[148:151], v[76:79], v[44:47], v[148:151]
s_and_b32 s73, s73, 12
ds_read_b64_tr_b16 v[70:71], v12 offset:25600
v_accvgpr_read_b32 v28, a69
v_mfma_f32_16x16x32_bf16 v[144:147], v[76:79], v[36:39], v[144:147]
s_add_u32 s72, s71, 31744
buffer_load_dwordx4 v6, s[12:15], s72 offen offset:1024 lds
v_mfma_f32_16x16x32_bf16 v[144:147], v[72:75], v[32:35], v[144:147]
s_waitcnt lgkmcnt(8)
v_accvgpr_read_b32 v21, a70
v_accvgpr_read_b32 v29, a71
v_mfma_f32_16x16x32_bf16 v[160:163], v[80:83], v[32:35], v[160:163]
s_or_b32 s73, s73, s70
ds_read_b64_tr_b16 v[72:73], v13 offset:16384
v_accvgpr_read_b32 v22, a100
v_mfma_f32_16x16x32_bf16 v[160:163], v[84:87], v[36:39], v[160:163]
s_lshl_b32 s73, s73, 7
ds_read_b64_tr_b16 v[74:75], v13 offset:17408
v_accvgpr_read_b32 v30, a101
v_mfma_f32_16x16x32_bf16 v[164:167], v[84:87], v[44:47], v[164:167]
s_add_u32 s69, s73, s67
v_accvgpr_read_b32 v23, a102
v_accvgpr_read_b32 v31, a103
v_mfma_f32_16x16x32_bf16 v[164:167], v[80:83], v[40:43], v[164:167]
s_add_u32 s72, s71, 63488
buffer_load_dwordx4 v7, s[12:15], s72 offen offset:2048 lds
v_mfma_f32_16x16x32_bf16 v[168:171], v[80:83], v[48:51], v[168:171]
s_waitcnt vmcnt(19)
ds_read_b64_tr_b16 v[76:77], v13 offset:24576
v_mul_f32 v20, s79, v20
v_mfma_f32_16x16x32_bf16 v[168:171], v[84:87], v[52:55], v[168:171]
s_add_u32 s70, s73, s68
ds_read_b128 v[96:99], v18 offset:32768
v_mul_f32 v28, s79, v28
v_mfma_f32_16x16x32_bf16 v[172:175], v[84:87], v[60:63], v[172:175]
ds_read_b64_tr_b16 v[78:79], v13 offset:25600
v_mul_f32 v21, s79, v21
v_mfma_f32_16x16x32_bf16 v[172:175], v[80:83], v[56:59], v[172:175]
s_waitcnt lgkmcnt(9)
ds_read_b128 v[100:103], v19 offset:32768
v_mul_f32 v29, s79, v29
v_mfma_f32_16x16x32_bf16 v[188:191], v[88:91], v[56:59], v[188:191]
s_add_u32 s72, s71, 95232
buffer_load_dwordx4 v7, s[12:15], s72 offen offset:3072 lds
v_mfma_f32_16x16x32_bf16 v[188:191], v[92:95], v[60:63], v[188:191]
ds_read_b64_tr_b16 v[80:81], v14 offset:16384
v_mul_f32 v22, s79, v22
v_mfma_f32_16x16x32_bf16 v[184:187], v[92:95], v[52:55], v[184:187]
ds_read_b64_tr_b16 v[82:83], v14 offset:17408
v_mul_f32 v30, s79, v30
v_mfma_f32_16x16x32_bf16 v[184:187], v[88:91], v[48:51], v[184:187]
v_mul_f32 v23, s79, v23
v_mul_f32 v31, s79, v31
v_mfma_f32_16x16x32_bf16 v[180:183], v[88:91], v[40:43], v[180:183]
ds_read_b64_tr_b16 v[84:85], v14 offset:24576
v_cvt_pk_bf16_f32 v20, v20, v28
v_mfma_f32_16x16x32_bf16 v[180:183], v[92:95], v[44:47], v[180:183]
s_add_u32 m0, s63, 65536
ds_read_b64_tr_b16 v[86:87], v14 offset:25600
v_cvt_pk_bf16_f32 v21, v21, v29
v_mfma_f32_16x16x32_bf16 v[176:179], v[92:95], v[36:39], v[176:179]
s_add_u32 s72, s69, 0
buffer_load_dwordx4 v4, s[4:7], s72 offen lds
v_mfma_f32_16x16x32_bf16 v[176:179], v[88:91], v[32:35], v[176:179]
s_waitcnt lgkmcnt(10)
ds_read_b128 v[104:107], v18 offset:34816
v_cvt_pk_bf16_f32 v22, v22, v30
v_mfma_f32_16x16x32_bf16 v[192:195], v[64:67], v[32:35], v[192:195]
ds_read_b64_tr_b16 v[88:89], v15 offset:16384
v_cvt_pk_bf16_f32 v23, v23, v31
v_mfma_f32_16x16x32_bf16 v[192:195], v[68:71], v[36:39], v[192:195]
s_add_u32 s80, s77, 5120
ds_read_b64_tr_b16 v[90:91], v15 offset:17408
v_mfma_f32_16x16x32_bf16 v[196:199], v[68:71], v[44:47], v[196:199]
ds_read_b64_tr_b16 v[92:93], v15 offset:24576
v_accvgpr_read_b32 v24, a184
v_mfma_f32_16x16x32_bf16 v[196:199], v[64:67], v[40:43], v[196:199]
s_add_u32 s72, s69, 15360
buffer_load_dwordx4 v5, s[4:7], s72 offen offset:1024 lds
v_mfma_f32_16x16x32_bf16 v[200:203], v[64:67], v[48:51], v[200:203]
ds_read_b64_tr_b16 v[94:95], v15 offset:25600
v_accvgpr_read_b32 v28, a185
v_mfma_f32_16x16x32_bf16 v[200:203], v[68:71], v[52:55], v[200:203]
ds_read_b128 v[108:111], v19 offset:34816
v_accvgpr_read_b32 v25, a186
v_mfma_f32_16x16x32_bf16 v[204:207], v[68:71], v[60:63], v[204:207]
buffer_store_dwordx4 v[20:23], v1, s[44:47], s80 offen sc1
v_mfma_f32_16x16x32_bf16 v[204:207], v[64:67], v[56:59], v[204:207]
s_waitcnt lgkmcnt(11)
ds_read_b128 v[112:115], v18 offset:36864
v_accvgpr_read_b32 v29, a187
v_mfma_f32_16x16x32_bf16 v[220:223], v[72:75], v[56:59], v[220:223]
s_add_u32 s72, s69, 129024
buffer_load_dwordx4 v4, s[4:7], s72 offen offset:2048 lds
v_mfma_f32_16x16x32_bf16 v[220:223], v[76:79], v[60:63], v[220:223]
v_accvgpr_read_b32 v26, a188
v_accvgpr_read_b32 v30, a189
v_mfma_f32_16x16x32_bf16 v[216:219], v[76:79], v[52:55], v[216:219]
s_waitcnt vmcnt(20) lgkmcnt(2)
ds_read_b128 v[116:119], v19 offset:36864
v_accvgpr_read_b32 v27, a190
v_mfma_f32_16x16x32_bf16 v[216:219], v[72:75], v[48:51], v[216:219]
s_barrier
ds_read_b128 v[120:123], v18 offset:38912
v_accvgpr_read_b32 v31, a191
v_mfma_f32_16x16x32_bf16 v[212:215], v[72:75], v[40:43], v[212:215]
ds_read_b64_tr_b16 v[64:65], v8 offset:32768
ds_read_b64_tr_b16 v[66:67], v8 offset:33792
v_mfma_f32_16x16x32_bf16 v[212:215], v[76:79], v[44:47], v[212:215]
ds_read_b64_tr_b16 v[68:69], v8 offset:40960
v_cvt_pk_bf16_f32 v24, v24, v28
v_mfma_f32_16x16x32_bf16 v[208:211], v[76:79], v[36:39], v[208:211]
s_add_u32 s72, s69, 144384
buffer_load_dwordx4 v5, s[4:7], s72 offen offset:3072 lds
v_mfma_f32_16x16x32_bf16 v[208:211], v[72:75], v[32:35], v[208:211]
ds_read_b64_tr_b16 v[70:71], v8 offset:41984
v_cvt_pk_bf16_f32 v25, v25, v29
v_mfma_f32_16x16x32_bf16 v[224:227], v[80:83], v[32:35], v[224:227]
ds_read_b64_tr_b16 v[72:73], v9 offset:32768
v_cvt_pk_bf16_f32 v26, v26, v30
v_mfma_f32_16x16x32_bf16 v[224:227], v[84:87], v[36:39], v[224:227]
ds_read_b64_tr_b16 v[74:75], v9 offset:33792
v_cvt_pk_bf16_f32 v27, v27, v31
v_mfma_f32_16x16x32_bf16 v[228:231], v[84:87], v[44:47], v[228:231]
s_add_u32 m0, s63, 69632
v_mfma_f32_16x16x32_bf16 v[228:231], v[80:83], v[40:43], v[228:231]
s_add_u32 s72, s70, 0
buffer_load_dwordx4 v4, s[4:7], s72 offen lds
v_mfma_f32_16x16x32_bf16 v[232:235], v[80:83], v[48:51], v[232:235]
s_add_u32 s80, s78, 41984
ds_read_b64_tr_b16 v[76:77], v9 offset:40960
v_mfma_f32_16x16x32_bf16 v[232:235], v[84:87], v[52:55], v[232:235]
ds_read_b128 v[124:127], v19 offset:38912
v_mfma_f32_16x16x32_bf16 v[236:239], v[84:87], v[60:63], v[236:239]
ds_read_b64_tr_b16 v[78:79], v9 offset:41984
v_mfma_f32_16x16x32_bf16 v[236:239], v[80:83], v[56:59], v[236:239]
buffer_store_dwordx4 v[24:27], v1, s[44:47], s80 offen sc1
v_mfma_f32_16x16x32_bf16 v[252:255], v[88:91], v[56:59], v[252:255]
s_add_u32 s72, s70, 15360
buffer_load_dwordx4 v5, s[4:7], s72 offen offset:1024 lds
v_mfma_f32_16x16x32_bf16 v[252:255], v[92:95], v[60:63], v[252:255]
ds_read_b64_tr_b16 v[80:81], v10 offset:32768
v_accvgpr_read_b32 v20, a72
v_mfma_f32_16x16x32_bf16 v[248:251], v[92:95], v[52:55], v[248:251]
ds_read_b64_tr_b16 v[82:83], v10 offset:33792
v_accvgpr_read_b32 v28, a73
v_mfma_f32_16x16x32_bf16 v[248:251], v[88:91], v[48:51], v[248:251]
v_accvgpr_read_b32 v21, a74
v_accvgpr_read_b32 v29, a75
v_mfma_f32_16x16x32_bf16 v[244:247], v[88:91], v[40:43], v[244:247]
ds_read_b64_tr_b16 v[84:85], v10 offset:40960
v_accvgpr_read_b32 v22, a104
v_mfma_f32_16x16x32_bf16 v[244:247], v[92:95], v[44:47], v[244:247]
ds_read_b64_tr_b16 v[86:87], v10 offset:41984
v_accvgpr_read_b32 v30, a105
v_mfma_f32_16x16x32_bf16 v[240:243], v[92:95], v[36:39], v[240:243]
s_add_u32 s72, s70, 129024
buffer_load_dwordx4 v4, s[4:7], s72 offen offset:2048 lds
v_mfma_f32_16x16x32_bf16 v[240:243], v[88:91], v[32:35], v[240:243]
s_waitcnt lgkmcnt(5)
v_accvgpr_read_b32 v23, a106
v_accvgpr_read_b32 v31, a107
v_mfma_f32_16x16x32_bf16 v[128:131], v[64:67], v[96:99], v[128:131]
s_lshr_b32 s75, s93, 4
ds_read_b64_tr_b16 v[88:89], v11 offset:32768
v_mul_f32 v20, s79, v20
v_mfma_f32_16x16x32_bf16 v[128:131], v[68:71], v[100:103], v[128:131]
s_and_b32 s75, s75, 0x7f00
ds_read_b64_tr_b16 v[90:91], v11 offset:33792
v_mul_f32 v28, s79, v28
v_mfma_f32_16x16x32_bf16 v[132:135], v[68:71], v[108:111], v[132:135]
s_add_u32 s75, s75, LcB1-Lpc0
v_lshrrev_b32 v2, 5, v0
v_lshlrev_b32 v2, 7, v2
v_mfma_f32_16x16x32_bf16 v[132:135], v[64:67], v[104:107], v[132:135]
s_add_u32 s72, s70, 144384
buffer_load_dwordx4 v5, s[4:7], s72 offen offset:3072 lds
v_mfma_f32_16x16x32_bf16 v[136:139], v[64:67], v[112:115], v[136:139]
v_add_u32 v2, s75, v2
v_min_u32 v2, Lcode_end-Lpc0, v2
v_mfma_f32_16x16x32_bf16 v[136:139], v[68:71], v[116:119], v[136:139]
s_lshl_b32 s71, s73, 12
global_load_dword v3, v2, s[98:99]
v_mfma_f32_16x16x32_bf16 v[140:143], v[68:71], v[124:127], v[140:143]
s_add_u32 s71, s71, s66
ds_read_b64_tr_b16 v[92:93], v11 offset:40960
v_mul_f32 v21, s79, v21
v_mfma_f32_16x16x32_bf16 v[140:143], v[64:67], v[120:123], v[140:143]
s_waitcnt lgkmcnt(7)
ds_read_b64_tr_b16 v[94:95], v11 offset:41984
v_mul_f32 v29, s79, v29
v_mfma_f32_16x16x32_bf16 v[156:159], v[72:75], v[120:123], v[156:159]
s_add_u32 m0, s64, 16384
ds_read_b64_tr_b16 v[64:65], v12 offset:32768
v_mul_f32 v22, s79, v22
v_mfma_f32_16x16x32_bf16 v[156:159], v[76:79], v[124:127], v[156:159]
s_add_u32 s72, s71, 0
buffer_load_dwordx4 v6, s[12:15], s72 offen lds
v_mfma_f32_16x16x32_bf16 v[152:155], v[76:79], v[116:119], v[152:155]
s_add_u32 s73, s62, 8
ds_read_b64_tr_b16 v[66:67], v12 offset:33792
v_mul_f32 v30, s79, v30
v_mfma_f32_16x16x32_bf16 v[152:155], v[72:75], v[112:115], v[152:155]
s_add_u32 s70, s73, s65
v_mul_f32 v23, s79, v23
v_mul_f32 v31, s79, v31
v_mfma_f32_16x16x32_bf16 v[148:151], v[72:75], v[104:107], v[148:151]
s_and_b32 s70, s70, 3
ds_read_b64_tr_b16 v[68:69], v12 offset:40960
v_cvt_pk_bf16_f32 v20, v20, v28
v_mfma_f32_16x16x32_bf16 v[148:151], v[76:79], v[108:111], v[148:151]
s_and_b32 s73, s73, 12
ds_read_b64_tr_b16 v[70:71], v12 offset:41984
v_cvt_pk_bf16_f32 v21, v21, v29
v_mfma_f32_16x16x32_bf16 v[144:147], v[76:79], v[100:103], v[144:147]
s_add_u32 s72, s71, 31744
buffer_load_dwordx4 v6, s[12:15], s72 offen offset:1024 lds
v_mfma_f32_16x16x32_bf16 v[144:147], v[72:75], v[96:99], v[144:147]
s_waitcnt lgkmcnt(8)
v_cvt_pk_bf16_f32 v22, v22, v30
v_cvt_pk_bf16_f32 v23, v23, v31
v_mfma_f32_16x16x32_bf16 v[160:163], v[80:83], v[96:99], v[160:163]
s_or_b32 s73, s73, s70
ds_read_b64_tr_b16 v[72:73], v13 offset:32768
v_accvgpr_read_b32 v24, a192
v_mfma_f32_16x16x32_bf16 v[160:163], v[84:87], v[100:103], v[160:163]
s_lshl_b32 s73, s73, 7
ds_read_b64_tr_b16 v[74:75], v13 offset:33792
v_accvgpr_read_b32 v28, a193
v_mfma_f32_16x16x32_bf16 v[164:167], v[84:87], v[108:111], v[164:167]
s_add_u32 s69, s73, s67
v_accvgpr_read_b32 v25, a194
v_accvgpr_read_b32 v29, a195
v_mfma_f32_16x16x32_bf16 v[164:167], v[80:83], v[104:107], v[164:167]
s_add_u32 s72, s71, 63488
buffer_load_dwordx4 v7, s[12:15], s72 offen offset:2048 lds
v_mfma_f32_16x16x32_bf16 v[168:171], v[80:83], v[112:115], v[168:171]
s_waitcnt vmcnt(19)
ds_read_b64_tr_b16 v[76:77], v13 offset:40960
v_accvgpr_read_b32 v26, a196
v_mfma_f32_16x16x32_bf16 v[168:171], v[84:87], v[116:119], v[168:171]
s_add_u32 s70, s73, s68
ds_read_b128 v[32:35], v16 offset:0
v_accvgpr_read_b32 v30, a197
v_mfma_f32_16x16x32_bf16 v[172:175], v[84:87], v[124:127], v[172:175]
s_add_u32 s80, s77, 9216
ds_read_b64_tr_b16 v[78:79], v13 offset:41984
v_accvgpr_read_b32 v27, a198
v_mfma_f32_16x16x32_bf16 v[172:175], v[80:83], v[120:123], v[172:175]
s_waitcnt lgkmcnt(9)
ds_read_b128 v[36:39], v17 offset:0
v_accvgpr_read_b32 v31, a199
v_mfma_f32_16x16x32_bf16 v[188:191], v[88:91], v[120:123], v[188:191]
s_add_u32 s72, s71, 95232
buffer_load_dwordx4 v7, s[12:15], s72 offen offset:3072 lds
v_mfma_f32_16x16x32_bf16 v[188:191], v[92:95], v[124:127], v[188:191]
ds_read_b64_tr_b16 v[80:81], v14 offset:32768
v_cvt_pk_bf16_f32 v24, v24, v28
v_mfma_f32_16x16x32_bf16 v[184:187], v[92:95], v[116:119], v[184:187]
ds_read_b64_tr_b16 v[82:83], v14 offset:33792
v_cvt_pk_bf16_f32 v25, v25, v29
v_mfma_f32_16x16x32_bf16 v[184:187], v[88:91], v[112:115], v[184:187]
buffer_store_dwordx4 v[20:23], v1, s[44:47], s80 offen sc1
v_mfma_f32_16x16x32_bf16 v[180:183], v[88:91], v[104:107], v[180:183]
ds_read_b64_tr_b16 v[84:85], v14 offset:40960
v_cvt_pk_bf16_f32 v26, v26, v30
v_mfma_f32_16x16x32_bf16 v[180:183], v[92:95], v[108:111], v[180:183]
s_add_u32 m0, s63, 98304
ds_read_b64_tr_b16 v[86:87], v14 offset:41984
v_cvt_pk_bf16_f32 v27, v27, v31
v_mfma_f32_16x16x32_bf16 v[176:179], v[92:95], v[100:103], v[176:179]
s_add_u32 s72, s69, 0
buffer_load_dwordx4 v4, s[4:7], s72 offen lds
v_mfma_f32_16x16x32_bf16 v[176:179], v[88:91], v[96:99], v[176:179]
s_waitcnt lgkmcnt(10)
ds_read_b128 v[40:43], v16 offset:2048
v_mfma_f32_16x16x32_bf16 v[192:195], v[64:67], v[96:99], v[192:195]
s_add_u32 s80, s78, 2048
ds_read_b64_tr_b16 v[88:89], v15 offset:32768
v_mfma_f32_16x16x32_bf16 v[192:195], v[68:71], v[100:103], v[192:195]
ds_read_b64_tr_b16 v[90:91], v15 offset:33792
v_mfma_f32_16x16x32_bf16 v[196:199], v[68:71], v[108:111], v[196:199]
ds_read_b64_tr_b16 v[92:93], v15 offset:40960
v_mfma_f32_16x16x32_bf16 v[196:199], v[64:67], v[104:107], v[196:199]
s_add_u32 s72, s69, 15360
buffer_load_dwordx4 v5, s[4:7], s72 offen offset:1024 lds
v_mfma_f32_16x16x32_bf16 v[200:203], v[64:67], v[112:115], v[200:203]
ds_read_b64_tr_b16 v[94:95], v15 offset:41984
v_accvgpr_read_b32 v20, a76
v_mfma_f32_16x16x32_bf16 v[200:203], v[68:71], v[116:119], v[200:203]
ds_read_b128 v[44:47], v17 offset:2048
v_accvgpr_read_b32 v28, a77
v_mfma_f32_16x16x32_bf16 v[204:207], v[68:71], v[124:127], v[204:207]
buffer_store_dwordx4 v[24:27], v1, s[44:47], s80 offen sc1
v_mfma_f32_16x16x32_bf16 v[204:207], v[64:67], v[120:123], v[204:207]
s_waitcnt lgkmcnt(11)
ds_read_b128 v[48:51], v16 offset:4096
v_accvgpr_read_b32 v21, a78
v_mfma_f32_16x16x32_bf16 v[220:223], v[72:75], v[120:123], v[220:223]
s_add_u32 s72, s69, 129024
buffer_load_dwordx4 v4, s[4:7], s72 offen offset:2048 lds
v_mfma_f32_16x16x32_bf16 v[220:223], v[76:79], v[124:127], v[220:223]
v_accvgpr_read_b32 v29, a79
v_accvgpr_read_b32 v22, a108
v_mfma_f32_16x16x32_bf16 v[216:219], v[76:79], v[116:119], v[216:219]
s_waitcnt vmcnt(20) lgkmcnt(2)
ds_read_b128 v[52:55], v17 offset:4096
v_accvgpr_read_b32 v30, a109
v_mfma_f32_16x16x32_bf16 v[216:219], v[72:75], v[112:115], v[216:219]
s_barrier
ds_read_b128 v[56:59], v16 offset:6144
v_accvgpr_read_b32 v23, a110
v_mfma_f32_16x16x32_bf16 v[212:215], v[72:75], v[104:107], v[212:215]
ds_read_b64_tr_b16 v[64:65], v8 offset:0
ds_read_b64_tr_b16 v[66:67], v8 offset:1024
v_mfma_f32_16x16x32_bf16 v[212:215], v[76:79], v[108:111], v[212:215]
ds_read_b64_tr_b16 v[68:69], v8 offset:8192
v_accvgpr_read_b32 v31, a111
v_mfma_f32_16x16x32_bf16 v[208:211], v[76:79], v[100:103], v[208:211]
s_add_u32 s72, s69, 144384
buffer_load_dwordx4 v5, s[4:7], s72 offen offset:3072 lds
v_mfma_f32_16x16x32_bf16 v[208:211], v[72:75], v[96:99], v[208:211]
ds_read_b64_tr_b16 v[70:71], v8 offset:9216
v_mul_f32 v20, s79, v20
v_mfma_f32_16x16x32_bf16 v[224:227], v[80:83], v[96:99], v[224:227]
ds_read_b64_tr_b16 v[72:73], v9 offset:0
v_mul_f32 v28, s79, v28
v_mfma_f32_16x16x32_bf16 v[224:227], v[84:87], v[100:103], v[224:227]
ds_read_b64_tr_b16 v[74:75], v9 offset:1024
v_mul_f32 v21, s79, v21
v_mfma_f32_16x16x32_bf16 v[228:231], v[84:87], v[108:111], v[228:231]
s_add_u32 m0, s63, 102400
v_mul_f32 v29, s79, v29
v_mul_f32 v22, s79, v22
v_mfma_f32_16x16x32_bf16 v[228:231], v[80:83], v[104:107], v[228:231]
s_add_u32 s72, s70, 0
buffer_load_dwordx4 v4, s[4:7], s72 offen lds
v_mfma_f32_16x16x32_bf16 v[232:235], v[80:83], v[112:115], v[232:235]
ds_read_b64_tr_b16 v[76:77], v9 offset:8192
v_mul_f32 v30, s79, v30
v_mfma_f32_16x16x32_bf16 v[232:235], v[84:87], v[116:119], v[232:235]
ds_read_b128 v[60:63], v17 offset:6144
v_mul_f32 v23, s79, v23
v_mfma_f32_16x16x32_bf16 v[236:239], v[84:87], v[124:127], v[236:239]
ds_read_b64_tr_b16 v[78:79], v9 offset:9216
v_mul_f32 v31, s79, v31
v_mfma_f32_16x16x32_bf16 v[236:239], v[80:83], v[120:123], v[236:239]
v_cvt_pk_bf16_f32 v20, v20, v28
v_cvt_pk_bf16_f32 v21, v21, v29
v_mfma_f32_16x16x32_bf16 v[252:255], v[88:91], v[120:123], v[252:255]
s_add_u32 s72, s70, 15360
buffer_load_dwordx4 v5, s[4:7], s72 offen offset:1024 lds
v_mfma_f32_16x16x32_bf16 v[252:255], v[92:95], v[124:127], v[252:255]
ds_read_b64_tr_b16 v[80:81], v10 offset:0
v_cvt_pk_bf16_f32 v22, v22, v30
v_mfma_f32_16x16x32_bf16 v[248:251], v[92:95], v[116:119], v[248:251]
ds_read_b64_tr_b16 v[82:83], v10 offset:1024
v_cvt_pk_bf16_f32 v23, v23, v31
v_mfma_f32_16x16x32_bf16 v[248:251], v[88:91], v[112:115], v[248:251]
s_add_u32 s80, s77, 13312
buffer_store_dwordx4 v[20:23], v1, s[44:47], s80 offen sc1
v_mfma_f32_16x16x32_bf16 v[244:247], v[88:91], v[104:107], v[244:247]
ds_read_b64_tr_b16 v[84:85], v10 offset:8192
v_accvgpr_read_b32 v24, a200
v_mfma_f32_16x16x32_bf16 v[244:247], v[92:95], v[108:111], v[244:247]
ds_read_b64_tr_b16 v[86:87], v10 offset:9216
v_accvgpr_read_b32 v28, a201
v_mfma_f32_16x16x32_bf16 v[240:243], v[92:95], v[100:103], v[240:243]
s_add_u32 s72, s70, 129024
buffer_load_dwordx4 v4, s[4:7], s72 offen offset:2048 lds
v_mfma_f32_16x16x32_bf16 v[240:243], v[88:91], v[96:99], v[240:243]
s_waitcnt lgkmcnt(5)
v_accvgpr_read_b32 v25, a202
v_accvgpr_read_b32 v29, a203
v_mfma_f32_16x16x32_bf16 v[128:131], v[64:67], v[32:35], v[128:131]
ds_read_b64_tr_b16 v[88:89], v11 offset:0
v_accvgpr_read_b32 v26, a204
v_mfma_f32_16x16x32_bf16 v[128:131], v[68:71], v[36:39], v[128:131]
ds_read_b64_tr_b16 v[90:91], v11 offset:1024
v_accvgpr_read_b32 v30, a205
v_mfma_f32_16x16x32_bf16 v[132:135], v[68:71], v[44:47], v[132:135]
v_accvgpr_read_b32 v27, a206
v_accvgpr_read_b32 v31, a207
v_mfma_f32_16x16x32_bf16 v[132:135], v[64:67], v[40:43], v[132:135]
s_add_u32 s72, s70, 144384
buffer_load_dwordx4 v5, s[4:7], s72 offen offset:3072 lds
v_mfma_f32_16x16x32_bf16 v[136:139], v[64:67], v[48:51], v[136:139]
ds_read_b64_tr_b16 v[92:93], v11 offset:8192
v_cvt_pk_bf16_f32 v24, v24, v28
v_mfma_f32_16x16x32_bf16 v[136:139], v[68:71], v[52:55], v[136:139]
s_lshl_b32 s71, s73, 12
v_cvt_pk_bf16_f32 v25, v25, v29
v_cvt_pk_bf16_f32 v26, v26, v30
v_mfma_f32_16x16x32_bf16 v[140:143], v[68:71], v[60:63], v[140:143]
s_add_u32 s71, s71, s66
ds_read_b64_tr_b16 v[94:95], v11 offset:9216
v_cvt_pk_bf16_f32 v27, v27, v31
v_mfma_f32_16x16x32_bf16 v[140:143], v[64:67], v[56:59], v[140:143]
s_waitcnt lgkmcnt(8)
v_mfma_f32_16x16x32_bf16 v[156:159], v[72:75], v[56:59], v[156:159]
s_add_u32 m0, s64, 32768
ds_read_b64_tr_b16 v[64:65], v12 offset:0
v_mfma_f32_16x16x32_bf16 v[156:159], v[76:79], v[60:63], v[156:159]
s_add_u32 s72, s71, 0
buffer_load_dwordx4 v6, s[12:15], s72 offen lds
v_mfma_f32_16x16x32_bf16 v[152:155], v[76:79], v[52:55], v[152:155]
s_add_u32 s73, s62, 9
ds_read_b64_tr_b16 v[66:67], v12 offset:1024
v_mfma_f32_16x16x32_bf16 v[152:155], v[72:75], v[48:51], v[152:155]
s_add_u32 s70, s73, s65
v_mfma_f32_16x16x32_bf16 v[148:151], v[72:75], v[40:43], v[148:151]
s_and_b32 s70, s70, 3
ds_read_b64_tr_b16 v[68:69], v12 offset:8192
v_mfma_f32_16x16x32_bf16 v[148:151], v[76:79], v[44:47], v[148:151]
s_and_b32 s73, s73, 12
ds_read_b64_tr_b16 v[70:71], v12 offset:9216
v_mfma_f32_16x16x32_bf16 v[144:147], v[76:79], v[36:39], v[144:147]
s_add_u32 s72, s71, 31744
buffer_load_dwordx4 v6, s[12:15], s72 offen offset:1024 lds
v_mfma_f32_16x16x32_bf16 v[144:147], v[72:75], v[32:35], v[144:147]
s_waitcnt lgkmcnt(8)
v_mfma_f32_16x16x32_bf16 v[160:163], v[80:83], v[32:35], v[160:163]
s_or_b32 s73, s73, s70
ds_read_b64_tr_b16 v[72:73], v13 offset:0
v_accvgpr_read_b32 v20, a80
v_mfma_f32_16x16x32_bf16 v[160:163], v[84:87], v[36:39], v[160:163]
s_lshl_b32 s73, s73, 7
ds_read_b64_tr_b16 v[74:75], v13 offset:1024
v_accvgpr_read_b32 v28, a81
v_mfma_f32_16x16x32_bf16 v[164:167], v[84:87], v[44:47], v[164:167]
s_add_u32 s69, s73, s67
v_accvgpr_read_b32 v21, a82
v_accvgpr_read_b32 v29, a83
v_mfma_f32_16x16x32_bf16 v[164:167], v[80:83], v[40:43], v[164:167]
s_add_u32 s72, s71, 63488
buffer_load_dwordx4 v7, s[12:15], s72 offen offset:2048 lds
v_mfma_f32_16x16x32_bf16 v[168:171], v[80:83], v[48:51], v[168:171]
s_waitcnt vmcnt(19)
ds_read_b64_tr_b16 v[76:77], v13 offset:8192
v_accvgpr_read_b32 v22, a112
v_mfma_f32_16x16x32_bf16 v[168:171], v[84:87], v[52:55], v[168:171]
s_add_u32 s70, s73, s68
ds_read_b128 v[96:99], v18 offset:0
v_accvgpr_read_b32 v30, a113
v_mfma_f32_16x16x32_bf16 v[172:175], v[84:87], v[60:63], v[172:175]
s_add_u32 s80, s78, 10240
ds_read_b64_tr_b16 v[78:79], v13 offset:9216
v_accvgpr_read_b32 v23, a114
v_mfma_f32_16x16x32_bf16 v[172:175], v[80:83], v[56:59], v[172:175]
s_waitcnt lgkmcnt(9)
ds_read_b128 v[100:103], v19 offset:0
v_accvgpr_read_b32 v31, a115
v_mfma_f32_16x16x32_bf16 v[188:191], v[88:91], v[56:59], v[188:191]
s_add_u32 s72, s71, 95232
buffer_load_dwordx4 v7, s[12:15], s72 offen offset:3072 lds
v_mfma_f32_16x16x32_bf16 v[188:191], v[92:95], v[60:63], v[188:191]
ds_read_b64_tr_b16 v[80:81], v14 offset:0
v_mul_f32 v20, s79, v20
v_mfma_f32_16x16x32_bf16 v[184:187], v[92:95], v[52:55], v[184:187]
ds_read_b64_tr_b16 v[82:83], v14 offset:1024
v_mul_f32 v28, s79, v28
v_mfma_f32_16x16x32_bf16 v[184:187], v[88:91], v[48:51], v[184:187]
buffer_store_dwordx4 v[24:27], v1, s[44:47], s80 offen sc1
v_mfma_f32_16x16x32_bf16 v[180:183], v[88:91], v[40:43], v[180:183]
ds_read_b64_tr_b16 v[84:85], v14 offset:8192
v_mul_f32 v21, s79, v21
v_mfma_f32_16x16x32_bf16 v[180:183], v[92:95], v[44:47], v[180:183]
s_add_u32 m0, s63, 131072
ds_read_b64_tr_b16 v[86:87], v14 offset:9216
v_mul_f32 v29, s79, v29
v_mfma_f32_16x16x32_bf16 v[176:179], v[92:95], v[36:39], v[176:179]
s_add_u32 s72, s69, 0
buffer_load_dwordx4 v4, s[4:7], s72 offen lds
v_mfma_f32_16x16x32_bf16 v[176:179], v[88:91], v[32:35], v[176:179]
s_waitcnt lgkmcnt(10)
ds_read_b128 v[104:107], v18 offset:2048
v_mul_f32 v22, s79, v22
v_mfma_f32_16x16x32_bf16 v[192:195], v[64:67], v[32:35], v[192:195]
ds_read_b64_tr_b16 v[88:89], v15 offset:0
v_mul_f32 v30, s79, v30
v_mfma_f32_16x16x32_bf16 v[192:195], v[68:71], v[36:39], v[192:195]
ds_read_b64_tr_b16 v[90:91], v15 offset:1024
v_mul_f32 v23, s79, v23
v_mfma_f32_16x16x32_bf16 v[196:199], v[68:71], v[44:47], v[196:199]
ds_read_b64_tr_b16 v[92:93], v15 offset:8192
v_mul_f32 v31, s79, v31
v_mfma_f32_16x16x32_bf16 v[196:199], v[64:67], v[40:43], v[196:199]
s_add_u32 s72, s69, 15360
buffer_load_dwordx4 v5, s[4:7], s72 offen offset:1024 lds
v_mfma_f32_16x16x32_bf16 v[200:203], v[64:67], v[48:51], v[200:203]
ds_read_b64_tr_b16 v[94:95], v15 offset:9216
v_cvt_pk_bf16_f32 v20, v20, v28
v_mfma_f32_16x16x32_bf16 v[200:203], v[68:71], v[52:55], v[200:203]
ds_read_b128 v[108:111], v19 offset:2048
v_cvt_pk_bf16_f32 v21, v21, v29
v_mfma_f32_16x16x32_bf16 v[204:207], v[68:71], v[60:63], v[204:207]
v_cvt_pk_bf16_f32 v22, v22, v30
v_cvt_pk_bf16_f32 v23, v23, v31
v_mfma_f32_16x16x32_bf16 v[204:207], v[64:67], v[56:59], v[204:207]
s_waitcnt lgkmcnt(11)
ds_read_b128 v[112:115], v18 offset:4096
v_accvgpr_read_b32 v24, a208
v_mfma_f32_16x16x32_bf16 v[220:223], v[72:75], v[56:59], v[220:223]
s_add_u32 s72, s69, 129024
buffer_load_dwordx4 v4, s[4:7], s72 offen offset:2048 lds
v_mfma_f32_16x16x32_bf16 v[220:223], v[76:79], v[60:63], v[220:223]
s_add_u32 s80, s77, 33792
s_nop 3
s_mov_b64 exec, 0
s_cmp_eq_u32 s58, 0
s_cbranch_scc1 Lstub0
s_cmp_eq_u32 s58, 1
s_cbranch_scc1 Lstub1
s_cmp_eq_u32 s58, 2
s_cbranch_scc1 Lstub2
s_branch Lstub3
Lret:
s_mov_b64 exec, -1
s_nop 3
v_mfma_f32_16x16x32_bf16 v[216:219], v[76:79], v[52:55], v[216:219]
s_waitcnt vmcnt(19) lgkmcnt(2)
ds_read_b128 v[116:119], v19 offset:4096
v_accvgpr_read_b32 v28, a209
v_mfma_f32_16x16x32_bf16 v[216:219], v[72:75], v[48:51], v[216:219]
s_barrier
buffer_store_dwordx4 v[20:23], v1, s[44:47], s80 offen sc1
v_mfma_f32_16x16x32_bf16 v[212:215], v[72:75], v[40:43], v[212:215]
ds_read_b64_tr_b16 v[64:65], v8 offset:16384
ds_read_b64_tr_b16 v[66:67], v8 offset:17408
v_mfma_f32_16x16x32_bf16 v[212:215], v[76:79], v[44:47], v[212:215]
ds_read_b64_tr_b16 v[68:69], v8 offset:24576
v_accvgpr_read_b32 v25, a210
v_mfma_f32_16x16x32_bf16 v[208:211], v[76:79], v[36:39], v[208:211]
s_add_u32 s72, s69, 144384
buffer_load_dwordx4 v5, s[4:7], s72 offen offset:3072 lds
v_mfma_f32_16x16x32_bf16 v[208:211], v[72:75], v[32:35], v[208:211]
ds_read_b64_tr_b16 v[70:71], v8 offset:25600
v_accvgpr_read_b32 v29, a211
v_mfma_f32_16x16x32_bf16 v[224:227], v[80:83], v[32:35], v[224:227]
ds_read_b64_tr_b16 v[72:73], v9 offset:16384
v_accvgpr_read_b32 v26, a212
v_mfma_f32_16x16x32_bf16 v[224:227], v[84:87], v[36:39], v[224:227]
ds_read_b64_tr_b16 v[74:75], v9 offset:17408
v_accvgpr_read_b32 v30, a213
v_mfma_f32_16x16x32_bf16 v[228:231], v[84:87], v[44:47], v[228:231]
s_add_u32 m0, s63, 135168
ds_read_b128 v[120:123], v18 offset:6144
v_accvgpr_read_b32 v27, a214
v_mfma_f32_16x16x32_bf16 v[228:231], v[80:83], v[40:43], v[228:231]
s_add_u32 s72, s70, 0
buffer_load_dwordx4 v4, s[4:7], s72 offen lds
v_mfma_f32_16x16x32_bf16 v[232:235], v[80:83], v[48:51], v[232:235]
ds_read_b64_tr_b16 v[76:77], v9 offset:24576
v_accvgpr_read_b32 v31, a215
v_mfma_f32_16x16x32_bf16 v[232:235], v[84:87], v[52:55], v[232:235]
ds_read_b128 v[124:127], v19 offset:6144
v_cvt_pk_bf16_f32 v24, v24, v28
v_mfma_f32_16x16x32_bf16 v[236:239], v[84:87], v[60:63], v[236:239]
ds_read_b64_tr_b16 v[78:79], v9 offset:25600
v_cvt_pk_bf16_f32 v25, v25, v29
v_mfma_f32_16x16x32_bf16 v[236:239], v[80:83], v[56:59], v[236:239]
v_cvt_pk_bf16_f32 v26, v26, v30
v_cvt_pk_bf16_f32 v27, v27, v31
v_mfma_f32_16x16x32_bf16 v[252:255], v[88:91], v[56:59], v[252:255]
s_add_u32 s72, s70, 15360
buffer_load_dwordx4 v5, s[4:7], s72 offen offset:1024 lds
v_mfma_f32_16x16x32_bf16 v[252:255], v[92:95], v[60:63], v[252:255]
s_add_u32 s80, s78, 34816
ds_read_b64_tr_b16 v[80:81], v10 offset:16384
v_mfma_f32_16x16x32_bf16 v[248:251], v[92:95], v[52:55], v[248:251]
ds_read_b64_tr_b16 v[82:83], v10 offset:17408
v_mfma_f32_16x16x32_bf16 v[248:251], v[88:91], v[48:51], v[248:251]
buffer_store_dwordx4 v[24:27], v1, s[44:47], s80 offen sc1
v_mfma_f32_16x16x32_bf16 v[244:247], v[88:91], v[40:43], v[244:247]
ds_read_b64_tr_b16 v[84:85], v10 offset:24576
v_mfma_f32_16x16x32_bf16 v[244:247], v[92:95], v[44:47], v[244:247]
ds_read_b64_tr_b16 v[86:87], v10 offset:25600
v_accvgpr_read_b32 v20, a84
v_mfma_f32_16x16x32_bf16 v[240:243], v[92:95], v[36:39], v[240:243]
s_add_u32 s72, s70, 129024
buffer_load_dwordx4 v4, s[4:7], s72 offen offset:2048 lds
v_mfma_f32_16x16x32_bf16 v[240:243], v[88:91], v[32:35], v[240:243]
s_waitcnt lgkmcnt(5)
v_accvgpr_read_b32 v28, a85
v_accvgpr_read_b32 v21, a86
v_mfma_f32_16x16x32_bf16 v[128:131], v[64:67], v[96:99], v[128:131]
ds_read_b64_tr_b16 v[88:89], v11 offset:16384
v_accvgpr_read_b32 v29, a87
v_mfma_f32_16x16x32_bf16 v[128:131], v[68:71], v[100:103], v[128:131]
ds_read_b64_tr_b16 v[90:91], v11 offset:17408
v_accvgpr_read_b32 v22, a116
v_mfma_f32_16x16x32_bf16 v[132:135], v[68:71], v[108:111], v[132:135]
v_accvgpr_read_b32 v30, a117
v_accvgpr_read_b32 v23, a118
v_mfma_f32_16x16x32_bf16 v[132:135], v[64:67], v[104:107], v[132:135]
s_add_u32 s72, s70, 144384
buffer_load_dwordx4 v5, s[4:7], s72 offen offset:3072 lds
v_mfma_f32_16x16x32_bf16 v[136:139], v[64:67], v[112:115], v[136:139]
ds_read_b64_tr_b16 v[92:93], v11 offset:24576
v_accvgpr_read_b32 v31, a119
v_mfma_f32_16x16x32_bf16 v[136:139], v[68:71], v[116:119], v[136:139]
s_lshl_b32 s71, s73, 12
v_mul_f32 v20, s79, v20
v_mul_f32 v28, s79, v28
v_mfma_f32_16x16x32_bf16 v[140:143], v[68:71], v[124:127], v[140:143]
s_add_u32 s71, s71, s66
ds_read_b64_tr_b16 v[94:95], v11 offset:25600
v_mul_f32 v21, s79, v21
v_mfma_f32_16x16x32_bf16 v[140:143], v[64:67], v[120:123], v[140:143]
s_waitcnt lgkmcnt(8)
v_mul_f32 v29, s79, v29
v_mul_f32 v22, s79, v22
v_mfma_f32_16x16x32_bf16 v[156:159], v[72:75], v[120:123], v[156:159]
s_add_u32 m0, s64, 0
ds_read_b64_tr_b16 v[64:65], v12 offset:16384
v_mul_f32 v30, s79, v30
v_mfma_f32_16x16x32_bf16 v[156:159], v[76:79], v[124:127], v[156:159]
s_add_u32 s72, s71, 0
buffer_load_dwordx4 v6, s[12:15], s72 offen lds
v_mfma_f32_16x16x32_bf16 v[152:155], v[76:79], v[116:119], v[152:155]
s_add_u32 s73, s62, 10
ds_read_b64_tr_b16 v[66:67], v12 offset:17408
v_mul_f32 v23, s79, v23
v_mfma_f32_16x16x32_bf16 v[152:155], v[72:75], v[112:115], v[152:155]
s_add_u32 s70, s73, s65
v_mul_f32 v31, s79, v31
v_cvt_pk_bf16_f32 v20, v20, v28
v_mfma_f32_16x16x32_bf16 v[148:151], v[72:75], v[104:107], v[148:151]
s_and_b32 s70, s70, 3
ds_read_b64_tr_b16 v[68:69], v12 offset:24576
v_cvt_pk_bf16_f32 v21, v21, v29
v_mfma_f32_16x16x32_bf16 v[148:151], v[76:79], v[108:111], v[148:151]
s_and_b32 s73, s73, 12
ds_read_b64_tr_b16 v[70:71], v12 offset:25600
v_cvt_pk_bf16_f32 v22, v22, v30
v_mfma_f32_16x16x32_bf16 v[144:147], v[76:79], v[100:103], v[144:147]
s_add_u32 s72, s71, 31744
buffer_load_dwordx4 v6, s[12:15], s72 offen offset:1024 lds
v_mfma_f32_16x16x32_bf16 v[144:147], v[72:75], v[96:99], v[144:147]
s_waitcnt lgkmcnt(8)
v_cvt_pk_bf16_f32 v23, v23, v31
v_mfma_f32_16x16x32_bf16 v[160:163], v[80:83], v[96:99], v[160:163]
s_or_b32 s73, s73, s70
ds_read_b64_tr_b16 v[72:73], v13 offset:16384
v_mfma_f32_16x16x32_bf16 v[160:163], v[84:87], v[100:103], v[160:163]
s_lshl_b32 s73, s73, 7
ds_read_b64_tr_b16 v[74:75], v13 offset:17408
v_mfma_f32_16x16x32_bf16 v[164:167], v[84:87], v[108:111], v[164:167]
s_add_u32 s69, s73, s67
v_mfma_f32_16x16x32_bf16 v[164:167], v[80:83], v[104:107], v[164:167]
s_add_u32 s72, s71, 63488
buffer_load_dwordx4 v7, s[12:15], s72 offen offset:2048 lds
v_mfma_f32_16x16x32_bf16 v[168:171], v[80:83], v[112:115], v[168:171]
s_waitcnt vmcnt(18)
ds_read_b64_tr_b16 v[76:77], v13 offset:24576
v_accvgpr_read_b32 v24, a216
v_mfma_f32_16x16x32_bf16 v[168:171], v[84:87], v[116:119], v[168:171]
s_add_u32 s70, s73, s68
ds_read_b128 v[32:35], v18 offset:32768
v_accvgpr_read_b32 v28, a217
v_mfma_f32_16x16x32_bf16 v[172:175], v[84:87], v[124:127], v[172:175]
s_add_u32 s80, s77, 37888
ds_read_b64_tr_b16 v[78:79], v13 offset:25600
v_accvgpr_read_b32 v25, a218
v_mfma_f32_16x16x32_bf16 v[172:175], v[80:83], v[120:123], v[172:175]
s_waitcnt lgkmcnt(9)
ds_read_b128 v[36:39], v19 offset:32768
v_accvgpr_read_b32 v29, a219
v_mfma_f32_16x16x32_bf16 v[188:191], v[88:91], v[120:123], v[188:191]
s_add_u32 s72, s71, 95232
buffer_load_dwordx4 v7, s[12:15], s72 offen offset:3072 lds
v_mfma_f32_16x16x32_bf16 v[188:191], v[92:95], v[124:127], v[188:191]
ds_read_b64_tr_b16 v[80:81], v14 offset:16384
v_accvgpr_read_b32 v26, a220
v_mfma_f32_16x16x32_bf16 v[184:187], v[92:95], v[116:119], v[184:187]
ds_read_b64_tr_b16 v[82:83], v14 offset:17408
v_accvgpr_read_b32 v30, a221
v_mfma_f32_16x16x32_bf16 v[184:187], v[88:91], v[112:115], v[184:187]
buffer_store_dwordx4 v[20:23], v1, s[44:47], s80 offen sc1
v_mfma_f32_16x16x32_bf16 v[180:183], v[88:91], v[104:107], v[180:183]
ds_read_b64_tr_b16 v[84:85], v14 offset:24576
v_accvgpr_read_b32 v27, a222
v_mfma_f32_16x16x32_bf16 v[180:183], v[92:95], v[108:111], v[180:183]
s_add_u32 m0, s63, 65536
ds_read_b64_tr_b16 v[86:87], v14 offset:25600
v_accvgpr_read_b32 v31, a223
v_mfma_f32_16x16x32_bf16 v[176:179], v[92:95], v[100:103], v[176:179]
s_add_u32 s72, s69, 0
buffer_load_dwordx4 v4, s[4:7], s72 offen lds
v_mfma_f32_16x16x32_bf16 v[176:179], v[88:91], v[96:99], v[176:179]
s_waitcnt lgkmcnt(10)
ds_read_b128 v[40:43], v18 offset:34816
v_cvt_pk_bf16_f32 v24, v24, v28
v_mfma_f32_16x16x32_bf16 v[192:195], v[64:67], v[96:99], v[192:195]
ds_read_b64_tr_b16 v[88:89], v15 offset:16384
v_cvt_pk_bf16_f32 v25, v25, v29
v_mfma_f32_16x16x32_bf16 v[192:195], v[68:71], v[100:103], v[192:195]
ds_read_b64_tr_b16 v[90:91], v15 offset:17408
v_cvt_pk_bf16_f32 v26, v26, v30
v_mfma_f32_16x16x32_bf16 v[196:199], v[68:71], v[108:111], v[196:199]
ds_read_b64_tr_b16 v[92:93], v15 offset:24576
v_cvt_pk_bf16_f32 v27, v27, v31
v_mfma_f32_16x16x32_bf16 v[196:199], v[64:67], v[104:107], v[196:199]
s_add_u32 s72, s69, 15360
buffer_load_dwordx4 v5, s[4:7], s72 offen offset:1024 lds
v_mfma_f32_16x16x32_bf16 v[200:203], v[64:67], v[112:115], v[200:203]
s_add_u32 s80, s78, 43008
ds_read_b64_tr_b16 v[94:95], v15 offset:25600
v_mfma_f32_16x16x32_bf16 v[200:203], v[68:71], v[116:119], v[200:203]
ds_read_b128 v[44:47], v19 offset:34816
v_mfma_f32_16x16x32_bf16 v[204:207], v[68:71], v[124:127], v[204:207]
buffer_store_dwordx4 v[24:27], v1, s[44:47], s80 offen sc1
v_mfma_f32_16x16x32_bf16 v[204:207], v[64:67], v[120:123], v[204:207]
s_waitcnt lgkmcnt(11)
ds_read_b128 v[48:51], v18 offset:36864
v_mfma_f32_16x16x32_bf16 v[220:223], v[72:75], v[120:123], v[220:223]
s_add_u32 s72, s69, 129024
buffer_load_dwordx4 v4, s[4:7], s72 offen offset:2048 lds
v_mfma_f32_16x16x32_bf16 v[220:223], v[76:79], v[124:127], v[220:223]
v_accvgpr_read_b32 v20, a88
v_accvgpr_read_b32 v28, a89
v_mfma_f32_16x16x32_bf16 v[216:219], v[76:79], v[116:119], v[216:219]
s_waitcnt vmcnt(20) lgkmcnt(2)
ds_read_b128 v[52:55], v19 offset:36864
v_accvgpr_read_b32 v21, a90
v_mfma_f32_16x16x32_bf16 v[216:219], v[72:75], v[112:115], v[216:219]
s_barrier
ds_read_b128 v[56:59], v18 offset:38912
v_accvgpr_read_b32 v29, a91
v_mfma_f32_16x16x32_bf16 v[212:215], v[72:75], v[104:107], v[212:215]
ds_read_b64_tr_b16 v[64:65], v8 offset:32768
ds_read_b64_tr_b16 v[66:67], v8 offset:33792
v_mfma_f32_16x16x32_bf16 v[212:215], v[76:79], v[108:111], v[212:215]
ds_read_b64_tr_b16 v[68:69], v8 offset:40960
v_accvgpr_read_b32 v22, a120
v_mfma_f32_16x16x32_bf16 v[208:211], v[76:79], v[100:103], v[208:211]
s_add_u32 s72, s69, 144384
buffer_load_dwordx4 v5, s[4:7], s72 offen offset:3072 lds
v_mfma_f32_16x16x32_bf16 v[208:211], v[72:75], v[96:99], v[208:211]
ds_read_b64_tr_b16 v[70:71], v8 offset:41984
v_accvgpr_read_b32 v30, a121
v_mfma_f32_16x16x32_bf16 v[224:227], v[80:83], v[96:99], v[224:227]
ds_read_b64_tr_b16 v[72:73], v9 offset:32768
v_accvgpr_read_b32 v23, a122
v_mfma_f32_16x16x32_bf16 v[224:227], v[84:87], v[100:103], v[224:227]
ds_read_b64_tr_b16 v[74:75], v9 offset:33792
v_accvgpr_read_b32 v31, a123
v_mfma_f32_16x16x32_bf16 v[228:231], v[84:87], v[108:111], v[228:231]
s_add_u32 m0, s63, 69632
v_mul_f32 v20, s79, v20
v_mul_f32 v28, s79, v28
v_mfma_f32_16x16x32_bf16 v[228:231], v[80:83], v[104:107], v[228:231]
s_add_u32 s72, s70, 0
buffer_load_dwordx4 v4, s[4:7], s72 offen lds
v_mfma_f32_16x16x32_bf16 v[232:235], v[80:83], v[112:115], v[232:235]
ds_read_b64_tr_b16 v[76:77], v9 offset:40960
v_mul_f32 v21, s79, v21
v_mfma_f32_16x16x32_bf16 v[232:235], v[84:87], v[116:119], v[232:235]
ds_read_b128 v[60:63], v19 offset:38912
v_mul_f32 v29, s79, v29
v_mfma_f32_16x16x32_bf16 v[236:239], v[84:87], v[124:127], v[236:239]
ds_read_b64_tr_b16 v[78:79], v9 offset:41984
v_mul_f32 v22, s79, v22
v_mfma_f32_16x16x32_bf16 v[236:239], v[80:83], v[120:123], v[236:239]
v_mul_f32 v30, s79, v30
v_mul_f32 v23, s79, v23
v_mfma_f32_16x16x32_bf16 v[252:255], v[88:91], v[120:123], v[252:255]
s_add_u32 s72, s70, 15360
buffer_load_dwordx4 v5, s[4:7], s72 offen offset:1024 lds
v_mfma_f32_16x16x32_bf16 v[252:255], v[92:95], v[124:127], v[252:255]
ds_read_b64_tr_b16 v[80:81], v10 offset:32768
v_mul_f32 v31, s79, v31
v_mfma_f32_16x16x32_bf16 v[248:251], v[92:95], v[116:119], v[248:251]
ds_read_b64_tr_b16 v[82:83], v10 offset:33792
v_cvt_pk_bf16_f32 v20, v20, v28
v_mfma_f32_16x16x32_bf16 v[248:251], v[88:91], v[112:115], v[248:251]
v_cvt_pk_bf16_f32 v21, v21, v29
v_cvt_pk_bf16_f32 v22, v22, v30
v_mfma_f32_16x16x32_bf16 v[244:247], v[88:91], v[104:107], v[244:247]
ds_read_b64_tr_b16 v[84:85], v10 offset:40960
v_cvt_pk_bf16_f32 v23, v23, v31
v_mfma_f32_16x16x32_bf16 v[244:247], v[92:95], v[108:111], v[244:247]
s_add_u32 s80, s77, 41984
ds_read_b64_tr_b16 v[86:87], v10 offset:41984
v_mfma_f32_16x16x32_bf16 v[240:243], v[92:95], v[100:103], v[240:243]
s_add_u32 s72, s70, 129024
buffer_load_dwordx4 v4, s[4:7], s72 offen offset:2048 lds
v_mfma_f32_16x16x32_bf16 v[240:243], v[88:91], v[96:99], v[240:243]
s_waitcnt lgkmcnt(5)
buffer_store_dwordx4 v[20:23], v1, s[44:47], s80 offen sc1
LcB1:
v_mfma_f32_16x16x32_bf16 v[128:131], v[64:67], v[32:35], v[128:131]
ds_read_b64_tr_b16 v[88:89], v11 offset:32768
v_accvgpr_read_b32 v24, a224
v_mfma_f32_16x16x32_bf16 v[128:131], v[68:71], v[36:39], v[128:131]
ds_read_b64_tr_b16 v[90:91], v11 offset:33792
v_accvgpr_read_b32 v28, a225
v_mfma_f32_16x16x32_bf16 v[132:135], v[68:71], v[44:47], v[132:135]
v_accvgpr_read_b32 v25, a226
v_accvgpr_read_b32 v29, a227
v_mfma_f32_16x16x32_bf16 v[132:135], v[64:67], v[40:43], v[132:135]
s_add_u32 s72, s70, 144384
buffer_load_dwordx4 v5, s[4:7], s72 offen offset:3072 lds
v_mfma_f32_16x16x32_bf16 v[136:139], v[64:67], v[48:51], v[136:139]
ds_read_b64_tr_b16 v[92:93], v11 offset:40960
v_accvgpr_read_b32 v26, a228
v_mfma_f32_16x16x32_bf16 v[136:139], v[68:71], v[52:55], v[136:139]
s_lshl_b32 s71, s73, 12
v_accvgpr_read_b32 v30, a229
v_accvgpr_read_b32 v27, a230
v_mfma_f32_16x16x32_bf16 v[140:143], v[68:71], v[60:63], v[140:143]
s_add_u32 s71, s71, s66
ds_read_b64_tr_b16 v[94:95], v11 offset:41984
v_accvgpr_read_b32 v31, a231
v_mfma_f32_16x16x32_bf16 v[140:143], v[64:67], v[56:59], v[140:143]
s_waitcnt lgkmcnt(8)
v_cvt_pk_bf16_f32 v24, v24, v28
v_cvt_pk_bf16_f32 v25, v25, v29
v_mfma_f32_16x16x32_bf16 v[156:159], v[72:75], v[56:59], v[156:159]
s_add_u32 m0, s64, 16384
ds_read_b64_tr_b16 v[64:65], v12 offset:32768
v_cvt_pk_bf16_f32 v26, v26, v30
v_mfma_f32_16x16x32_bf16 v[156:159], v[76:79], v[60:63], v[156:159]
s_add_u32 s72, s71, 0
buffer_load_dwordx4 v6, s[12:15], s72 offen lds
v_mfma_f32_16x16x32_bf16 v[152:155], v[76:79], v[52:55], v[152:155]
s_add_u32 s73, s62, 11
ds_read_b64_tr_b16 v[66:67], v12 offset:33792
v_cvt_pk_bf16_f32 v27, v27, v31
v_mfma_f32_16x16x32_bf16 v[152:155], v[72:75], v[48:51], v[152:155]
s_add_u32 s70, s73, s65
v_mfma_f32_16x16x32_bf16 v[148:151], v[72:75], v[40:43], v[148:151]
s_and_b32 s70, s70, 3
ds_read_b64_tr_b16 v[68:69], v12 offset:40960
v_mfma_f32_16x16x32_bf16 v[148:151], v[76:79], v[44:47], v[148:151]
s_and_b32 s73, s73, 12
ds_read_b64_tr_b16 v[70:71], v12 offset:41984
v_mfma_f32_16x16x32_bf16 v[144:147], v[76:79], v[36:39], v[144:147]
s_add_u32 s72, s71, 31744
buffer_load_dwordx4 v6, s[12:15], s72 offen offset:1024 lds
v_mfma_f32_16x16x32_bf16 v[144:147], v[72:75], v[32:35], v[144:147]
s_waitcnt lgkmcnt(8)
v_mfma_f32_16x16x32_bf16 v[160:163], v[80:83], v[32:35], v[160:163]
s_or_b32 s73, s73, s70
ds_read_b64_tr_b16 v[72:73], v13 offset:32768
v_mfma_f32_16x16x32_bf16 v[160:163], v[84:87], v[36:39], v[160:163]
s_lshl_b32 s73, s73, 7
ds_read_b64_tr_b16 v[74:75], v13 offset:33792
v_mfma_f32_16x16x32_bf16 v[164:167], v[84:87], v[44:47], v[164:167]
s_add_u32 s69, s73, s67
v_mfma_f32_16x16x32_bf16 v[164:167], v[80:83], v[40:43], v[164:167]
s_add_u32 s72, s71, 63488
buffer_load_dwordx4 v7, s[12:15], s72 offen offset:2048 lds
v_mfma_f32_16x16x32_bf16 v[168:171], v[80:83], v[48:51], v[168:171]
s_waitcnt vmcnt(18)
ds_read_b64_tr_b16 v[76:77], v13 offset:40960
v_mfma_f32_16x16x32_bf16 v[168:171], v[84:87], v[52:55], v[168:171]
s_add_u32 s70, s73, s68
ds_read_b128 v[96:99], v16 offset:0
v_accvgpr_read_b32 v20, a92
v_mfma_f32_16x16x32_bf16 v[172:175], v[84:87], v[60:63], v[172:175]
s_add_u32 s80, s78, 3072
ds_read_b64_tr_b16 v[78:79], v13 offset:41984
v_accvgpr_read_b32 v28, a93
v_mfma_f32_16x16x32_bf16 v[172:175], v[80:83], v[56:59], v[172:175]
s_waitcnt lgkmcnt(9)
ds_read_b128 v[100:103], v17 offset:0
v_accvgpr_read_b32 v21, a94
v_mfma_f32_16x16x32_bf16 v[188:191], v[88:91], v[56:59], v[188:191]
s_add_u32 s72, s71, 95232
buffer_load_dwordx4 v7, s[12:15], s72 offen offset:3072 lds
v_mfma_f32_16x16x32_bf16 v[188:191], v[92:95], v[60:63], v[188:191]
ds_read_b64_tr_b16 v[80:81], v14 offset:32768
v_accvgpr_read_b32 v29, a95
v_mfma_f32_16x16x32_bf16 v[184:187], v[92:95], v[52:55], v[184:187]
ds_read_b64_tr_b16 v[82:83], v14 offset:33792
v_accvgpr_read_b32 v22, a124
v_mfma_f32_16x16x32_bf16 v[184:187], v[88:91], v[48:51], v[184:187]
buffer_store_dwordx4 v[24:27], v1, s[44:47], s80 offen sc1
v_mfma_f32_16x16x32_bf16 v[180:183], v[88:91], v[40:43], v[180:183]
ds_read_b64_tr_b16 v[84:85], v14 offset:40960
v_accvgpr_read_b32 v30, a125
v_mfma_f32_16x16x32_bf16 v[180:183], v[92:95], v[44:47], v[180:183]
s_add_u32 m0, s63, 98304
ds_read_b64_tr_b16 v[86:87], v14 offset:41984
v_accvgpr_read_b32 v23, a126
v_mfma_f32_16x16x32_bf16 v[176:179], v[92:95], v[36:39], v[176:179]
s_add_u32 s72, s69, 0
buffer_load_dwordx4 v4, s[4:7], s72 offen lds
v_mfma_f32_16x16x32_bf16 v[176:179], v[88:91], v[32:35], v[176:179]
s_waitcnt lgkmcnt(10)
ds_read_b128 v[104:107], v16 offset:2048
v_accvgpr_read_b32 v31, a127
v_mfma_f32_16x16x32_bf16 v[192:195], v[64:67], v[32:35], v[192:195]
ds_read_b64_tr_b16 v[88:89], v15 offset:32768
v_mul_f32 v20, s79, v20
v_mfma_f32_16x16x32_bf16 v[192:195], v[68:71], v[36:39], v[192:195]
ds_read_b64_tr_b16 v[90:91], v15 offset:33792
v_mul_f32 v28, s79, v28
v_mfma_f32_16x16x32_bf16 v[196:199], v[68:71], v[44:47], v[196:199]
ds_read_b64_tr_b16 v[92:93], v15 offset:40960
v_mul_f32 v21, s79, v21
v_mfma_f32_16x16x32_bf16 v[196:199], v[64:67], v[40:43], v[196:199]
s_add_u32 s72, s69, 15360
buffer_load_dwordx4 v5, s[4:7], s72 offen offset:1024 lds
v_mfma_f32_16x16x32_bf16 v[200:203], v[64:67], v[48:51], v[200:203]
ds_read_b64_tr_b16 v[94:95], v15 offset:41984
v_mul_f32 v29, s79, v29
v_mfma_f32_16x16x32_bf16 v[200:203], v[68:71], v[52:55], v[200:203]
ds_read_b128 v[108:111], v17 offset:2048
v_mul_f32 v22, s79, v22
v_mfma_f32_16x16x32_bf16 v[204:207], v[68:71], v[60:63], v[204:207]
v_mul_f32 v30, s79, v30
v_mul_f32 v23, s79, v23
v_mfma_f32_16x16x32_bf16 v[204:207], v[64:67], v[56:59], v[204:207]
s_waitcnt lgkmcnt(11)
ds_read_b128 v[112:115], v16 offset:4096
v_mul_f32 v31, s79, v31
v_mfma_f32_16x16x32_bf16 v[220:223], v[72:75], v[56:59], v[220:223]
s_add_u32 s72, s69, 129024
buffer_load_dwordx4 v4, s[4:7], s72 offen offset:2048 lds
v_mfma_f32_16x16x32_bf16 v[220:223], v[76:79], v[60:63], v[220:223]
v_cvt_pk_bf16_f32 v20, v20, v28
v_cvt_pk_bf16_f32 v21, v21, v29
v_mfma_f32_16x16x32_bf16 v[216:219], v[76:79], v[52:55], v[216:219]
s_waitcnt vmcnt(19) lgkmcnt(2)
ds_read_b128 v[116:119], v17 offset:4096
v_cvt_pk_bf16_f32 v22, v22, v30
v_mfma_f32_16x16x32_bf16 v[216:219], v[72:75], v[48:51], v[216:219]
s_barrier
ds_read_b128 v[120:123], v16 offset:6144
v_cvt_pk_bf16_f32 v23, v23, v31
v_mfma_f32_16x16x32_bf16 v[212:215], v[72:75], v[40:43], v[212:215]
s_add_u32 s80, s77, 46080
ds_read_b64_tr_b16 v[64:65], v8 offset:0
ds_read_b64_tr_b16 v[66:67], v8 offset:1024
v_mfma_f32_16x16x32_bf16 v[212:215], v[76:79], v[44:47], v[212:215]
ds_read_b64_tr_b16 v[68:69], v8 offset:8192
v_accvgpr_read_b32 v24, a232
v_mfma_f32_16x16x32_bf16 v[208:211], v[76:79], v[36:39], v[208:211]
s_add_u32 s72, s69, 144384
buffer_load_dwordx4 v5, s[4:7], s72 offen offset:3072 lds
v_mfma_f32_16x16x32_bf16 v[208:211], v[72:75], v[32:35], v[208:211]
ds_read_b64_tr_b16 v[70:71], v8 offset:9216
v_accvgpr_read_b32 v28, a233
v_mfma_f32_16x16x32_bf16 v[224:227], v[80:83], v[32:35], v[224:227]
ds_read_b64_tr_b16 v[72:73], v9 offset:0
v_accvgpr_read_b32 v25, a234
v_mfma_f32_16x16x32_bf16 v[224:227], v[84:87], v[36:39], v[224:227]
ds_read_b64_tr_b16 v[74:75], v9 offset:1024
v_accvgpr_read_b32 v29, a235
v_mfma_f32_16x16x32_bf16 v[228:231], v[84:87], v[44:47], v[228:231]
s_add_u32 m0, s63, 102400
buffer_store_dwordx4 v[20:23], v1, s[44:47], s80 offen sc1
v_mfma_f32_16x16x32_bf16 v[228:231], v[80:83], v[40:43], v[228:231]
s_add_u32 s72, s70, 0
buffer_load_dwordx4 v4, s[4:7], s72 offen lds
v_mfma_f32_16x16x32_bf16 v[232:235], v[80:83], v[48:51], v[232:235]
ds_read_b64_tr_b16 v[76:77], v9 offset:8192
v_accvgpr_read_b32 v26, a236
v_mfma_f32_16x16x32_bf16 v[232:235], v[84:87], v[52:55], v[232:235]
ds_read_b128 v[124:127], v17 offset:6144
v_accvgpr_read_b32 v30, a237
v_mfma_f32_16x16x32_bf16 v[236:239], v[84:87], v[60:63], v[236:239]
ds_read_b64_tr_b16 v[78:79], v9 offset:9216
v_accvgpr_read_b32 v27, a238
v_mfma_f32_16x16x32_bf16 v[236:239], v[80:83], v[56:59], v[236:239]
v_accvgpr_read_b32 v31, a239
v_cvt_pk_bf16_f32 v24, v24, v28
v_mfma_f32_16x16x32_bf16 v[252:255], v[88:91], v[56:59], v[252:255]
s_add_u32 s72, s70, 15360
buffer_load_dwordx4 v5, s[4:7], s72 offen offset:1024 lds
v_mfma_f32_16x16x32_bf16 v[252:255], v[92:95], v[60:63], v[252:255]
ds_read_b64_tr_b16 v[80:81], v10 offset:0
v_cvt_pk_bf16_f32 v25, v25, v29
v_mfma_f32_16x16x32_bf16 v[248:251], v[92:95], v[52:55], v[248:251]
ds_read_b64_tr_b16 v[82:83], v10 offset:1024
v_cvt_pk_bf16_f32 v26, v26, v30
v_mfma_f32_16x16x32_bf16 v[248:251], v[88:91], v[48:51], v[248:251]
v_cvt_pk_bf16_f32 v27, v27, v31
v_mfma_f32_16x16x32_bf16 v[244:247], v[88:91], v[40:43], v[244:247]
s_add_u32 s80, s78, 11264
ds_read_b64_tr_b16 v[84:85], v10 offset:8192
v_mfma_f32_16x16x32_bf16 v[244:247], v[92:95], v[44:47], v[244:247]
ds_read_b64_tr_b16 v[86:87], v10 offset:9216
v_mfma_f32_16x16x32_bf16 v[240:243], v[92:95], v[36:39], v[240:243]
s_add_u32 s72, s70, 129024
buffer_load_dwordx4 v4, s[4:7], s72 offen offset:2048 lds
v_mfma_f32_16x16x32_bf16 v[240:243], v[88:91], v[32:35], v[240:243]
s_waitcnt lgkmcnt(5)
buffer_store_dwordx4 v[24:27], v1, s[44:47], s80 offen sc1
v_mfma_f32_16x16x32_bf16 v[128:131], v[64:67], v[96:99], v[128:131]
ds_read_b64_tr_b16 v[88:89], v11 offset:0
v_mfma_f32_16x16x32_bf16 v[128:131], v[68:71], v[100:103], v[128:131]
ds_read_b64_tr_b16 v[90:91], v11 offset:1024
v_accvgpr_read_b32 v20, a240
v_mfma_f32_16x16x32_bf16 v[132:135], v[68:71], v[108:111], v[132:135]
v_accvgpr_read_b32 v28, a241
v_accvgpr_read_b32 v21, a242
v_mfma_f32_16x16x32_bf16 v[132:135], v[64:67], v[104:107], v[132:135]
s_add_u32 s72, s70, 144384
buffer_load_dwordx4 v5, s[4:7], s72 offen offset:3072 lds
v_mfma_f32_16x16x32_bf16 v[136:139], v[64:67], v[112:115], v[136:139]
ds_read_b64_tr_b16 v[92:93], v11 offset:8192
v_accvgpr_read_b32 v29, a243
v_mfma_f32_16x16x32_bf16 v[136:139], v[68:71], v[116:119], v[136:139]
s_lshl_b32 s71, s73, 12
v_accvgpr_read_b32 v22, a244
v_accvgpr_read_b32 v30, a245
v_mfma_f32_16x16x32_bf16 v[140:143], v[68:71], v[124:127], v[140:143]
s_add_u32 s71, s71, s66
ds_read_b64_tr_b16 v[94:95], v11 offset:9216
v_accvgpr_read_b32 v23, a246
v_mfma_f32_16x16x32_bf16 v[140:143], v[64:67], v[120:123], v[140:143]
s_waitcnt lgkmcnt(8)
v_accvgpr_read_b32 v31, a247
v_cvt_pk_bf16_f32 v20, v20, v28
v_mfma_f32_16x16x32_bf16 v[156:159], v[72:75], v[120:123], v[156:159]
s_add_u32 m0, s64, 32768
ds_read_b64_tr_b16 v[64:65], v12 offset:0
v_cvt_pk_bf16_f32 v21, v21, v29
v_mfma_f32_16x16x32_bf16 v[156:159], v[76:79], v[124:127], v[156:159]
s_add_u32 s72, s71, 0
buffer_load_dwordx4 v6, s[12:15], s72 offen lds
v_mfma_f32_16x16x32_bf16 v[152:155], v[76:79], v[116:119], v[152:155]
s_add_u32 s73, s62, 12
ds_read_b64_tr_b16 v[66:67], v12 offset:1024
v_cvt_pk_bf16_f32 v22, v22, v30
v_mfma_f32_16x16x32_bf16 v[152:155], v[72:75], v[112:115], v[152:155]
s_add_u32 s70, s73, s65
v_cvt_pk_bf16_f32 v23, v23, v31
v_mfma_f32_16x16x32_bf16 v[148:151], v[72:75], v[104:107], v[148:151]
s_and_b32 s70, s70, 3
ds_read_b64_tr_b16 v[68:69], v12 offset:8192
v_mfma_f32_16x16x32_bf16 v[148:151], v[76:79], v[108:111], v[148:151]
s_and_b32 s73, s73, 12
ds_read_b64_tr_b16 v[70:71], v12 offset:9216
v_mfma_f32_16x16x32_bf16 v[144:147], v[76:79], v[100:103], v[144:147]
s_add_u32 s72, s71, 31744
buffer_load_dwordx4 v6, s[12:15], s72 offen offset:1024 lds
v_mfma_f32_16x16x32_bf16 v[144:147], v[72:75], v[96:99], v[144:147]
s_waitcnt lgkmcnt(8)
v_mfma_f32_16x16x32_bf16 v[160:163], v[80:83], v[96:99], v[160:163]
s_or_b32 s73, s73, s70
ds_read_b64_tr_b16 v[72:73], v13 offset:0
v_mfma_f32_16x16x32_bf16 v[160:163], v[84:87], v[100:103], v[160:163]
s_lshl_b32 s73, s73, 7
ds_read_b64_tr_b16 v[74:75], v13 offset:1024
v_mfma_f32_16x16x32_bf16 v[164:167], v[84:87], v[108:111], v[164:167]
s_add_u32 s69, s73, s67
v_mfma_f32_16x16x32_bf16 v[164:167], v[80:83], v[104:107], v[164:167]
s_add_u32 s72, s71, 63488
buffer_load_dwordx4 v7, s[12:15], s72 offen offset:2048 lds
v_mfma_f32_16x16x32_bf16 v[168:171], v[80:83], v[112:115], v[168:171]
s_waitcnt vmcnt(18)
ds_read_b64_tr_b16 v[76:77], v13 offset:8192
v_mfma_f32_16x16x32_bf16 v[168:171], v[84:87], v[116:119], v[168:171]
s_add_u32 s70, s73, s68
ds_read_b128 v[32:35], v18 offset:0
v_mfma_f32_16x16x32_bf16 v[172:175], v[84:87], v[124:127], v[172:175]
s_add_u32 s80, s78, 35840
ds_read_b64_tr_b16 v[78:79], v13 offset:9216
v_mfma_f32_16x16x32_bf16 v[172:175], v[80:83], v[120:123], v[172:175]
s_waitcnt lgkmcnt(9)
ds_read_b128 v[36:39], v19 offset:0
v_accvgpr_read_b32 v24, a248
v_mfma_f32_16x16x32_bf16 v[188:191], v[88:91], v[120:123], v[188:191]
s_add_u32 s72, s71, 95232
buffer_load_dwordx4 v7, s[12:15], s72 offen offset:3072 lds
v_mfma_f32_16x16x32_bf16 v[188:191], v[92:95], v[124:127], v[188:191]
ds_read_b64_tr_b16 v[80:81], v14 offset:0
v_accvgpr_read_b32 v28, a249
v_mfma_f32_16x16x32_bf16 v[184:187], v[92:95], v[116:119], v[184:187]
ds_read_b64_tr_b16 v[82:83], v14 offset:1024
v_accvgpr_read_b32 v25, a250
v_mfma_f32_16x16x32_bf16 v[184:187], v[88:91], v[112:115], v[184:187]
buffer_store_dwordx4 v[20:23], v1, s[44:47], s80 offen sc1
v_mfma_f32_16x16x32_bf16 v[180:183], v[88:91], v[104:107], v[180:183]
ds_read_b64_tr_b16 v[84:85], v14 offset:8192
v_accvgpr_read_b32 v29, a251
v_mfma_f32_16x16x32_bf16 v[180:183], v[92:95], v[108:111], v[180:183]
s_add_u32 m0, s63, 131072
ds_read_b64_tr_b16 v[86:87], v14 offset:9216
v_accvgpr_read_b32 v26, a252
v_mfma_f32_16x16x32_bf16 v[176:179], v[92:95], v[100:103], v[176:179]
s_add_u32 s72, s69, 0
buffer_load_dwordx4 v4, s[4:7], s72 offen lds
v_mfma_f32_16x16x32_bf16 v[176:179], v[88:91], v[96:99], v[176:179]
s_waitcnt lgkmcnt(10)
ds_read_b128 v[40:43], v18 offset:2048
v_accvgpr_read_b32 v30, a253
v_mfma_f32_16x16x32_bf16 v[192:195], v[64:67], v[96:99], v[192:195]
ds_read_b64_tr_b16 v[88:89], v15 offset:0
v_accvgpr_read_b32 v27, a254
v_mfma_f32_16x16x32_bf16 v[192:195], v[68:71], v[100:103], v[192:195]
ds_read_b64_tr_b16 v[90:91], v15 offset:1024
v_accvgpr_read_b32 v31, a255
v_mfma_f32_16x16x32_bf16 v[196:199], v[68:71], v[108:111], v[196:199]
ds_read_b64_tr_b16 v[92:93], v15 offset:8192
v_cvt_pk_bf16_f32 v24, v24, v28
v_mfma_f32_16x16x32_bf16 v[196:199], v[64:67], v[104:107], v[196:199]
s_add_u32 s72, s69, 15360
buffer_load_dwordx4 v5, s[4:7], s72 offen offset:1024 lds
v_mfma_f32_16x16x32_bf16 v[200:203], v[64:67], v[112:115], v[200:203]
ds_read_b64_tr_b16 v[94:95], v15 offset:9216
v_cvt_pk_bf16_f32 v25, v25, v29
v_mfma_f32_16x16x32_bf16 v[200:203], v[68:71], v[116:119], v[200:203]
ds_read_b128 v[44:47], v19 offset:2048
v_cvt_pk_bf16_f32 v26, v26, v30
v_mfma_f32_16x16x32_bf16 v[204:207], v[68:71], v[124:127], v[204:207]
v_cvt_pk_bf16_f32 v27, v27, v31
v_mfma_f32_16x16x32_bf16 v[204:207], v[64:67], v[120:123], v[204:207]
s_waitcnt lgkmcnt(11)
ds_read_b128 v[48:51], v18 offset:4096
v_mfma_f32_16x16x32_bf16 v[220:223], v[72:75], v[120:123], v[220:223]
s_add_u32 s72, s69, 129024
buffer_load_dwordx4 v4, s[4:7], s72 offen offset:2048 lds
v_mfma_f32_16x16x32_bf16 v[220:223], v[76:79], v[124:127], v[220:223]
s_add_u32 s80, s78, 44032
ds_read_b128 v[52:55], v19 offset:4096
v_mfma_f32_16x16x32_bf16 v[216:219], v[76:79], v[116:119], v[216:219]
s_waitcnt vmcnt(19) lgkmcnt(3)
buffer_store_dwordx4 v[24:27], v1, s[44:47], s80 offen sc1
v_mfma_f32_16x16x32_bf16 v[216:219], v[72:75], v[112:115], v[216:219]
s_barrier
ds_read_b128 v[56:59], v18 offset:6144
v_mfma_f32_16x16x32_bf16 v[212:215], v[72:75], v[104:107], v[212:215]
ds_read_b64_tr_b16 v[64:65], v8 offset:16384
ds_read_b64_tr_b16 v[66:67], v8 offset:17408
v_mfma_f32_16x16x32_bf16 v[212:215], v[76:79], v[108:111], v[212:215]
ds_read_b64_tr_b16 v[68:69], v8 offset:24576
ds_read_b64_tr_b16 v[70:71], v8 offset:25600
v_mfma_f32_16x16x32_bf16 v[208:211], v[76:79], v[100:103], v[208:211]
s_add_u32 s72, s69, 144384
buffer_load_dwordx4 v5, s[4:7], s72 offen offset:3072 lds
v_mfma_f32_16x16x32_bf16 v[208:211], v[72:75], v[96:99], v[208:211]
v_and_b32 v2, 31, v0
v_lshlrev_b32 v2, 2, v2
v_mfma_f32_16x16x32_bf16 v[224:227], v[80:83], v[96:99], v[224:227]
buffer_load_dword v3, v2, s[48:51], 0 offen sc1
v_mfma_f32_16x16x32_bf16 v[224:227], v[84:87], v[100:103], v[224:227]
ds_read_b64_tr_b16 v[72:73], v9 offset:16384
v_mfma_f32_16x16x32_bf16 v[228:231], v[84:87], v[108:111], v[228:231]
s_add_u32 m0, s63, 135168
ds_read_b64_tr_b16 v[74:75], v9 offset:17408
v_mfma_f32_16x16x32_bf16 v[228:231], v[80:83], v[104:107], v[228:231]
s_add_u32 s72, s70, 0
buffer_load_dwordx4 v4, s[4:7], s72 offen lds
v_mfma_f32_16x16x32_bf16 v[232:235], v[80:83], v[112:115], v[232:235]
ds_read_b128 v[60:63], v19 offset:6144
v_mfma_f32_16x16x32_bf16 v[232:235], v[84:87], v[116:119], v[232:235]
ds_read_b64_tr_b16 v[76:77], v9 offset:24576
v_mfma_f32_16x16x32_bf16 v[236:239], v[84:87], v[124:127], v[236:239]
ds_read_b64_tr_b16 v[78:79], v9 offset:25600
v_mfma_f32_16x16x32_bf16 v[236:239], v[80:83], v[120:123], v[236:239]
v_mfma_f32_16x16x32_bf16 v[252:255], v[88:91], v[120:123], v[252:255]
s_add_u32 s72, s70, 15360
buffer_load_dwordx4 v5, s[4:7], s72 offen offset:1024 lds
v_mfma_f32_16x16x32_bf16 v[252:255], v[92:95], v[124:127], v[252:255]
ds_read_b64_tr_b16 v[80:81], v10 offset:16384
v_mfma_f32_16x16x32_bf16 v[248:251], v[92:95], v[116:119], v[248:251]
ds_read_b64_tr_b16 v[82:83], v10 offset:17408
v_mfma_f32_16x16x32_bf16 v[248:251], v[88:91], v[112:115], v[248:251]
v_mfma_f32_16x16x32_bf16 v[244:247], v[88:91], v[104:107], v[244:247]
ds_read_b64_tr_b16 v[84:85], v10 offset:24576
v_mfma_f32_16x16x32_bf16 v[244:247], v[92:95], v[108:111], v[244:247]
ds_read_b64_tr_b16 v[86:87], v10 offset:25600
v_mfma_f32_16x16x32_bf16 v[240:243], v[92:95], v[100:103], v[240:243]
s_add_u32 s72, s70, 129024
buffer_load_dwordx4 v4, s[4:7], s72 offen offset:2048 lds
v_mfma_f32_16x16x32_bf16 v[240:243], v[88:91], v[96:99], v[240:243]
s_waitcnt lgkmcnt(6)
v_mfma_f32_16x16x32_bf16 v[128:131], v[64:67], v[32:35], v[128:131]
ds_read_b64_tr_b16 v[88:89], v11 offset:16384
v_mfma_f32_16x16x32_bf16 v[128:131], v[68:71], v[36:39], v[128:131]
ds_read_b64_tr_b16 v[90:91], v11 offset:17408
v_mfma_f32_16x16x32_bf16 v[132:135], v[68:71], v[44:47], v[132:135]
v_mfma_f32_16x16x32_bf16 v[132:135], v[64:67], v[40:43], v[132:135]
s_add_u32 s72, s70, 144384
buffer_load_dwordx4 v5, s[4:7], s72 offen offset:3072 lds
v_mfma_f32_16x16x32_bf16 v[136:139], v[64:67], v[48:51], v[136:139]
ds_read_b64_tr_b16 v[92:93], v11 offset:24576
v_mfma_f32_16x16x32_bf16 v[136:139], v[68:71], v[52:55], v[136:139]
s_lshl_b32 s71, s73, 12
v_mfma_f32_16x16x32_bf16 v[140:143], v[68:71], v[60:63], v[140:143]
s_add_u32 s71, s71, s66
ds_read_b64_tr_b16 v[94:95], v11 offset:25600
v_mfma_f32_16x16x32_bf16 v[140:143], v[64:67], v[56:59], v[140:143]
s_waitcnt lgkmcnt(8)
v_mfma_f32_16x16x32_bf16 v[156:159], v[72:75], v[56:59], v[156:159]
s_add_u32 m0, s64, 0
ds_read_b64_tr_b16 v[64:65], v12 offset:16384
v_mfma_f32_16x16x32_bf16 v[156:159], v[76:79], v[60:63], v[156:159]
s_add_u32 s72, s71, 0
buffer_load_dwordx4 v6, s[12:15], s72 offen lds
v_mfma_f32_16x16x32_bf16 v[152:155], v[76:79], v[52:55], v[152:155]
s_add_u32 s73, s62, 13
ds_read_b64_tr_b16 v[66:67], v12 offset:17408
v_mfma_f32_16x16x32_bf16 v[152:155], v[72:75], v[48:51], v[152:155]
s_add_u32 s70, s73, s65
v_mfma_f32_16x16x32_bf16 v[148:151], v[72:75], v[40:43], v[148:151]
s_and_b32 s70, s70, 3
ds_read_b64_tr_b16 v[68:69], v12 offset:24576
v_mfma_f32_16x16x32_bf16 v[148:151], v[76:79], v[44:47], v[148:151]
s_and_b32 s73, s73, 12
ds_read_b64_tr_b16 v[70:71], v12 offset:25600
v_mfma_f32_16x16x32_bf16 v[144:147], v[76:79], v[36:39], v[144:147]
s_add_u32 s72, s71, 31744
buffer_load_dwordx4 v6, s[12:15], s72 offen offset:1024 lds
v_mfma_f32_16x16x32_bf16 v[144:147], v[72:75], v[32:35], v[144:147]
s_waitcnt lgkmcnt(8)
v_mfma_f32_16x16x32_bf16 v[160:163], v[80:83], v[32:35], v[160:163]
s_or_b32 s73, s73, s70
ds_read_b64_tr_b16 v[72:73], v13 offset:16384
v_mfma_f32_16x16x32_bf16 v[160:163], v[84:87], v[36:39], v[160:163]
s_lshl_b32 s73, s73, 7
ds_read_b64_tr_b16 v[74:75], v13 offset:17408
v_mfma_f32_16x16x32_bf16 v[164:167], v[84:87], v[44:47], v[164:167]
s_add_u32 s69, s73, s67
v_mfma_f32_16x16x32_bf16 v[164:167], v[80:83], v[40:43], v[164:167]
s_add_u32 s72, s71, 63488
buffer_load_dwordx4 v7, s[12:15], s72 offen offset:2048 lds
v_mfma_f32_16x16x32_bf16 v[168:171], v[80:83], v[48:51], v[168:171]
s_waitcnt vmcnt(18)
ds_read_b64_tr_b16 v[76:77], v13 offset:24576
v_mfma_f32_16x16x32_bf16 v[168:171], v[84:87], v[52:55], v[168:171]
s_add_u32 s70, s73, s68
ds_read_b128 v[96:99], v18 offset:32768
v_mfma_f32_16x16x32_bf16 v[172:175], v[84:87], v[60:63], v[172:175]
ds_read_b64_tr_b16 v[78:79], v13 offset:25600
v_mfma_f32_16x16x32_bf16 v[172:175], v[80:83], v[56:59], v[172:175]
s_waitcnt lgkmcnt(9)
ds_read_b128 v[100:103], v19 offset:32768
v_mfma_f32_16x16x32_bf16 v[188:191], v[88:91], v[56:59], v[188:191]
s_add_u32 s72, s71, 95232
buffer_load_dwordx4 v7, s[12:15], s72 offen offset:3072 lds
v_mfma_f32_16x16x32_bf16 v[188:191], v[92:95], v[60:63], v[188:191]
ds_read_b64_tr_b16 v[80:81], v14 offset:16384
v_mfma_f32_16x16x32_bf16 v[184:187], v[92:95], v[52:55], v[184:187]
ds_read_b64_tr_b16 v[82:83], v14 offset:17408
v_mfma_f32_16x16x32_bf16 v[184:187], v[88:91], v[48:51], v[184:187]
v_mfma_f32_16x16x32_bf16 v[180:183], v[88:91], v[40:43], v[180:183]
ds_read_b64_tr_b16 v[84:85], v14 offset:24576
v_mfma_f32_16x16x32_bf16 v[180:183], v[92:95], v[44:47], v[180:183]
s_add_u32 m0, s63, 65536
ds_read_b64_tr_b16 v[86:87], v14 offset:25600
v_mfma_f32_16x16x32_bf16 v[176:179], v[92:95], v[36:39], v[176:179]
s_add_u32 s72, s69, 0
buffer_load_dwordx4 v4, s[4:7], s72 offen lds
v_mfma_f32_16x16x32_bf16 v[176:179], v[88:91], v[32:35], v[176:179]
s_waitcnt lgkmcnt(10)
ds_read_b128 v[104:107], v18 offset:34816
v_mfma_f32_16x16x32_bf16 v[192:195], v[64:67], v[32:35], v[192:195]
ds_read_b64_tr_b16 v[88:89], v15 offset:16384
v_mfma_f32_16x16x32_bf16 v[192:195], v[68:71], v[36:39], v[192:195]
ds_read_b64_tr_b16 v[90:91], v15 offset:17408
v_mfma_f32_16x16x32_bf16 v[196:199], v[68:71], v[44:47], v[196:199]
ds_read_b64_tr_b16 v[92:93], v15 offset:24576
v_mfma_f32_16x16x32_bf16 v[196:199], v[64:67], v[40:43], v[196:199]
s_add_u32 s72, s69, 15360
buffer_load_dwordx4 v5, s[4:7], s72 offen offset:1024 lds
v_mfma_f32_16x16x32_bf16 v[200:203], v[64:67], v[48:51], v[200:203]
ds_read_b64_tr_b16 v[94:95], v15 offset:25600
v_mfma_f32_16x16x32_bf16 v[200:203], v[68:71], v[52:55], v[200:203]
ds_read_b128 v[108:111], v19 offset:34816
v_mfma_f32_16x16x32_bf16 v[204:207], v[68:71], v[60:63], v[204:207]
v_mfma_f32_16x16x32_bf16 v[204:207], v[64:67], v[56:59], v[204:207]
s_waitcnt lgkmcnt(11)
ds_read_b128 v[112:115], v18 offset:36864
v_mfma_f32_16x16x32_bf16 v[220:223], v[72:75], v[56:59], v[220:223]
s_add_u32 s72, s69, 129024
buffer_load_dwordx4 v4, s[4:7], s72 offen offset:2048 lds
v_mfma_f32_16x16x32_bf16 v[220:223], v[76:79], v[60:63], v[220:223]
v_mfma_f32_16x16x32_bf16 v[216:219], v[76:79], v[52:55], v[216:219]
s_waitcnt vmcnt(13) lgkmcnt(2)
ds_read_b128 v[116:119], v19 offset:36864
v_mfma_f32_16x16x32_bf16 v[216:219], v[72:75], v[48:51], v[216:219]
s_barrier
ds_read_b128 v[120:123], v18 offset:38912
v_mfma_f32_16x16x32_bf16 v[212:215], v[72:75], v[40:43], v[212:215]
ds_read_b64_tr_b16 v[64:65], v8 offset:32768
ds_read_b64_tr_b16 v[66:67], v8 offset:33792
v_mfma_f32_16x16x32_bf16 v[212:215], v[76:79], v[44:47], v[212:215]
ds_read_b64_tr_b16 v[68:69], v8 offset:40960
v_or_b32 v20, s58, v0
v_mfma_f32_16x16x32_bf16 v[208:211], v[76:79], v[36:39], v[208:211]
s_add_u32 s72, s69, 144384
buffer_load_dwordx4 v5, s[4:7], s72 offen offset:3072 lds
v_mfma_f32_16x16x32_bf16 v[208:211], v[72:75], v[32:35], v[208:211]
ds_read_b64_tr_b16 v[70:71], v8 offset:41984
v_mov_b32 v21, 1
v_mfma_f32_16x16x32_bf16 v[224:227], v[80:83], v[32:35], v[224:227]
ds_read_b64_tr_b16 v[72:73], v9 offset:32768
v_min_u32 v20, 1, v20
v_mfma_f32_16x16x32_bf16 v[224:227], v[84:87], v[36:39], v[224:227]
ds_read_b64_tr_b16 v[74:75], v9 offset:33792
v_lshlrev_b32 v20, 30, v20
v_mfma_f32_16x16x32_bf16 v[228:231], v[84:87], v[44:47], v[228:231]
s_add_u32 m0, s63, 69632
buffer_store_dword v21, v20, s[44:47], s91 offen sc1
v_mfma_f32_16x16x32_bf16 v[228:231], v[80:83], v[40:43], v[228:231]
s_add_u32 s72, s70, 0
buffer_load_dwordx4 v4, s[4:7], s72 offen lds
v_mfma_f32_16x16x32_bf16 v[232:235], v[80:83], v[48:51], v[232:235]
ds_read_b64_tr_b16 v[76:77], v9 offset:40960
v_accvgpr_write_b32 a32, 0
v_mfma_f32_16x16x32_bf16 v[232:235], v[84:87], v[52:55], v[232:235]
ds_read_b128 v[124:127], v19 offset:38912
v_accvgpr_write_b32 a33, 0
v_mfma_f32_16x16x32_bf16 v[236:239], v[84:87], v[60:63], v[236:239]
ds_read_b64_tr_b16 v[78:79], v9 offset:41984
v_accvgpr_write_b32 a34, 0
v_mfma_f32_16x16x32_bf16 v[236:239], v[80:83], v[56:59], v[236:239]
v_accvgpr_write_b32 a35, 0
v_accvgpr_write_b32 a36, 0
v_mfma_f32_16x16x32_bf16 v[252:255], v[88:91], v[56:59], v[252:255]
s_add_u32 s72, s70, 15360
buffer_load_dwordx4 v5, s[4:7], s72 offen offset:1024 lds
v_mfma_f32_16x16x32_bf16 v[252:255], v[92:95], v[60:63], v[252:255]
ds_read_b64_tr_b16 v[80:81], v10 offset:32768
v_accvgpr_write_b32 a37, 0
v_mfma_f32_16x16x32_bf16 v[248:251], v[92:95], v[52:55], v[248:251]
ds_read_b64_tr_b16 v[82:83], v10 offset:33792
v_accvgpr_write_b32 a38, 0
v_mfma_f32_16x16x32_bf16 v[248:251], v[88:91], v[48:51], v[248:251]
v_accvgpr_write_b32 a39, 0
v_accvgpr_write_b32 a40, 0
v_mfma_f32_16x16x32_bf16 v[244:247], v[88:91], v[40:43], v[244:247]
ds_read_b64_tr_b16 v[84:85], v10 offset:40960
v_accvgpr_write_b32 a41, 0
v_mfma_f32_16x16x32_bf16 v[244:247], v[92:95], v[44:47], v[244:247]
ds_read_b64_tr_b16 v[86:87], v10 offset:41984
v_accvgpr_write_b32 a42, 0
v_mfma_f32_16x16x32_bf16 v[240:243], v[92:95], v[36:39], v[240:243]
s_add_u32 s72, s70, 129024
buffer_load_dwordx4 v4, s[4:7], s72 offen offset:2048 lds
v_mfma_f32_16x16x32_bf16 v[240:243], v[88:91], v[32:35], v[240:243]
s_waitcnt lgkmcnt(5)
v_accvgpr_write_b32 a43, 0
v_accvgpr_write_b32 a44, 0
v_mfma_f32_16x16x32_bf16 v[128:131], v[64:67], v[96:99], v[128:131]
ds_read_b64_tr_b16 v[88:89], v11 offset:32768
v_accvgpr_write_b32 a45, 0
v_mfma_f32_16x16x32_bf16 v[128:131], v[68:71], v[100:103], v[128:131]
ds_read_b64_tr_b16 v[90:91], v11 offset:33792
v_accvgpr_write_b32 a46, 0
v_mfma_f32_16x16x32_bf16 v[132:135], v[68:71], v[108:111], v[132:135]
v_accvgpr_write_b32 a47, 0
v_accvgpr_write_b32 a48, 0
v_mfma_f32_16x16x32_bf16 v[132:135], v[64:67], v[104:107], v[132:135]
s_add_u32 s72, s70, 144384
buffer_load_dwordx4 v5, s[4:7], s72 offen offset:3072 lds
v_mfma_f32_16x16x32_bf16 v[136:139], v[64:67], v[112:115], v[136:139]
ds_read_b64_tr_b16 v[92:93], v11 offset:40960
v_accvgpr_write_b32 a49, 0
v_mfma_f32_16x16x32_bf16 v[136:139], v[68:71], v[116:119], v[136:139]
s_lshl_b32 s71, s73, 12
v_accvgpr_write_b32 a50, 0
v_accvgpr_write_b32 a51, 0
v_mfma_f32_16x16x32_bf16 v[140:143], v[68:71], v[124:127], v[140:143]
s_add_u32 s71, s71, s66
ds_read_b64_tr_b16 v[94:95], v11 offset:41984
v_accvgpr_write_b32 a52, 0
v_mfma_f32_16x16x32_bf16 v[140:143], v[64:67], v[120:123], v[140:143]
s_waitcnt lgkmcnt(8)
v_accvgpr_write_b32 a53, 0
v_accvgpr_write_b32 a54, 0
v_mfma_f32_16x16x32_bf16 v[156:159], v[72:75], v[120:123], v[156:159]
s_add_u32 m0, s64, 16384
ds_read_b64_tr_b16 v[64:65], v12 offset:32768
v_accvgpr_write_b32 a55, 0
v_mfma_f32_16x16x32_bf16 v[156:159], v[76:79], v[124:127], v[156:159]
s_add_u32 s72, s71, 0
buffer_load_dwordx4 v6, s[12:15], s72 offen lds
v_mfma_f32_16x16x32_bf16 v[152:155], v[76:79], v[116:119], v[152:155]
s_add_u32 s73, s62, 14
ds_read_b64_tr_b16 v[66:67], v12 offset:33792
v_accvgpr_write_b32 a56, 0
v_mfma_f32_16x16x32_bf16 v[152:155], v[72:75], v[112:115], v[152:155]
s_add_u32 s70, s73, s65
v_accvgpr_write_b32 a57, 0
v_accvgpr_write_b32 a58, 0
v_mfma_f32_16x16x32_bf16 v[148:151], v[72:75], v[104:107], v[148:151]
s_and_b32 s70, s70, 3
ds_read_b64_tr_b16 v[68:69], v12 offset:40960
v_accvgpr_write_b32 a59, 0
v_mfma_f32_16x16x32_bf16 v[148:151], v[76:79], v[108:111], v[148:151]
s_and_b32 s73, s73, 12
ds_read_b64_tr_b16 v[70:71], v12 offset:41984
v_accvgpr_write_b32 a60, 0
v_mfma_f32_16x16x32_bf16 v[144:147], v[76:79], v[100:103], v[144:147]
s_add_u32 s72, s71, 31744
buffer_load_dwordx4 v6, s[12:15], s72 offen offset:1024 lds
v_mfma_f32_16x16x32_bf16 v[144:147], v[72:75], v[96:99], v[144:147]
s_waitcnt lgkmcnt(8)
v_accvgpr_write_b32 a61, 0
v_accvgpr_write_b32 a62, 0
v_mfma_f32_16x16x32_bf16 v[160:163], v[80:83], v[96:99], v[160:163]
s_or_b32 s73, s73, s70
ds_read_b64_tr_b16 v[72:73], v13 offset:32768
v_accvgpr_write_b32 a63, 0
v_mfma_f32_16x16x32_bf16 v[160:163], v[84:87], v[100:103], v[160:163]
s_lshl_b32 s73, s73, 7
ds_read_b64_tr_b16 v[74:75], v13 offset:33792
v_accvgpr_write_b32 a96, 0
v_mfma_f32_16x16x32_bf16 v[164:167], v[84:87], v[108:111], v[164:167]
s_add_u32 s69, s73, s67
v_accvgpr_write_b32 a97, 0
v_accvgpr_write_b32 a98, 0
v_mfma_f32_16x16x32_bf16 v[164:167], v[80:83], v[104:107], v[164:167]
s_add_u32 s72, s71, 63488
buffer_load_dwordx4 v7, s[12:15], s72 offen offset:2048 lds
v_mfma_f32_16x16x32_bf16 v[168:171], v[80:83], v[112:115], v[168:171]
s_waitcnt vmcnt(16)
ds_read_b64_tr_b16 v[76:77], v13 offset:40960
v_accvgpr_write_b32 a99, 0
v_mfma_f32_16x16x32_bf16 v[168:171], v[84:87], v[116:119], v[168:171]
s_add_u32 s70, s73, s68
ds_read_b128 v[32:35], v16 offset:0
v_accvgpr_write_b32 a100, 0
v_mfma_f32_16x16x32_bf16 v[172:175], v[84:87], v[124:127], v[172:175]
ds_read_b64_tr_b16 v[78:79], v13 offset:41984
v_accvgpr_write_b32 a101, 0
v_mfma_f32_16x16x32_bf16 v[172:175], v[80:83], v[120:123], v[172:175]
s_waitcnt lgkmcnt(9)
ds_read_b128 v[36:39], v17 offset:0
v_accvgpr_write_b32 a102, 0
v_mfma_f32_16x16x32_bf16 v[188:191], v[88:91], v[120:123], v[188:191]
s_add_u32 s72, s71, 95232
buffer_load_dwordx4 v7, s[12:15], s72 offen offset:3072 lds
v_mfma_f32_16x16x32_bf16 v[188:191], v[92:95], v[124:127], v[188:191]
ds_read_b64_tr_b16 v[80:81], v14 offset:32768
v_accvgpr_write_b32 a103, 0
v_mfma_f32_16x16x32_bf16 v[184:187], v[92:95], v[116:119], v[184:187]
ds_read_b64_tr_b16 v[82:83], v14 offset:33792
v_accvgpr_write_b32 a104, 0
v_mfma_f32_16x16x32_bf16 v[184:187], v[88:91], v[112:115], v[184:187]
v_accvgpr_write_b32 a105, 0
v_accvgpr_write_b32 a106, 0
v_mfma_f32_16x16x32_bf16 v[180:183], v[88:91], v[104:107], v[180:183]
ds_read_b64_tr_b16 v[84:85], v14 offset:40960
v_accvgpr_write_b32 a107, 0
v_mfma_f32_16x16x32_bf16 v[180:183], v[92:95], v[108:111], v[180:183]
s_add_u32 m0, s63, 98304
ds_read_b64_tr_b16 v[86:87], v14 offset:41984
v_accvgpr_write_b32 a108, 0
v_mfma_f32_16x16x32_bf16 v[176:179], v[92:95], v[100:103], v[176:179]
s_add_u32 s72, s69, 0
buffer_load_dwordx4 v4, s[4:7], s72 offen lds
v_mfma_f32_16x16x32_bf16 v[176:179], v[88:91], v[96:99], v[176:179]
s_waitcnt lgkmcnt(10)
ds_read_b128 v[40:43], v16 offset:2048
v_accvgpr_write_b32 a109, 0
v_mfma_f32_16x16x32_bf16 v[192:195], v[64:67], v[96:99], v[192:195]
ds_read_b64_tr_b16 v[88:89], v15 offset:32768
v_accvgpr_write_b32 a110, 0
v_mfma_f32_16x16x32_bf16 v[192:195], v[68:71], v[100:103], v[192:195]
ds_read_b64_tr_b16 v[90:91], v15 offset:33792
v_accvgpr_write_b32 a111, 0
v_mfma_f32_16x16x32_bf16 v[196:199], v[68:71], v[108:111], v[196:199]
ds_read_b64_tr_b16 v[92:93], v15 offset:40960
v_accvgpr_write_b32 a112, 0
v_mfma_f32_16x16x32_bf16 v[196:199], v[64:67], v[104:107], v[196:199]
s_add_u32 s72, s69, 15360
buffer_load_dwordx4 v5, s[4:7], s72 offen offset:1024 lds
v_mfma_f32_16x16x32_bf16 v[200:203], v[64:67], v[112:115], v[200:203]
ds_read_b64_tr_b16 v[94:95], v15 offset:41984
v_accvgpr_write_b32 a113, 0
v_mfma_f32_16x16x32_bf16 v[200:203], v[68:71], v[116:119], v[200:203]
ds_read_b128 v[44:47], v17 offset:2048
v_accvgpr_write_b32 a114, 0
v_mfma_f32_16x16x32_bf16 v[204:207], v[68:71], v[124:127], v[204:207]
v_accvgpr_write_b32 a115, 0
v_accvgpr_write_b32 a116, 0
v_mfma_f32_16x16x32_bf16 v[204:207], v[64:67], v[120:123], v[204:207]
s_waitcnt lgkmcnt(11)
ds_read_b128 v[48:51], v16 offset:4096
v_accvgpr_write_b32 a117, 0
v_mfma_f32_16x16x32_bf16 v[220:223], v[72:75], v[120:123], v[220:223]
s_add_u32 s72, s69, 129024
buffer_load_dwordx4 v4, s[4:7], s72 offen offset:2048 lds
v_mfma_f32_16x16x32_bf16 v[220:223], v[76:79], v[124:127], v[220:223]
v_accvgpr_write_b32 a118, 0
v_accvgpr_write_b32 a119, 0
v_mfma_f32_16x16x32_bf16 v[216:219], v[76:79], v[116:119], v[216:219]
s_waitcnt vmcnt(16) lgkmcnt(2)
ds_read_b128 v[52:55], v17 offset:4096
v_accvgpr_write_b32 a120, 0
v_mfma_f32_16x16x32_bf16 v[216:219], v[72:75], v[112:115], v[216:219]
s_barrier
ds_read_b128 v[56:59], v16 offset:6144
v_accvgpr_write_b32 a121, 0
v_mfma_f32_16x16x32_bf16 v[212:215], v[72:75], v[104:107], v[212:215]
s_waitcnt vmcnt(24)
v_cmp_gt_u32 vcc, 8, v3
s_cbranch_vccnz Lspin1
Lback2:
v_mfma_f32_16x16x32_bf16 v[212:215], v[76:79], v[108:111], v[212:215]
ds_read_b64_tr_b16 v[64:65], v8 offset:0
ds_read_b64_tr_b16 v[66:67], v8 offset:1024
v_mfma_f32_16x16x32_bf16 v[208:211], v[76:79], v[100:103], v[208:211]
s_add_u32 s72, s69, 144384
buffer_load_dwordx4 v5, s[4:7], s72 offen offset:3072 lds
v_mfma_f32_16x16x32_bf16 v[208:211], v[72:75], v[96:99], v[208:211]
ds_read_b64_tr_b16 v[68:69], v8 offset:8192
ds_read_b64_tr_b16 v[70:71], v8 offset:9216
v_mfma_f32_16x16x32_bf16 v[224:227], v[80:83], v[96:99], v[224:227]
ds_read_b64_tr_b16 v[72:73], v9 offset:0
v_accvgpr_write_b32 a122, 0
v_mfma_f32_16x16x32_bf16 v[224:227], v[84:87], v[100:103], v[224:227]
ds_read_b64_tr_b16 v[74:75], v9 offset:1024
v_accvgpr_write_b32 a123, 0
v_mfma_f32_16x16x32_bf16 v[228:231], v[84:87], v[108:111], v[228:231]
s_add_u32 m0, s63, 102400
v_accvgpr_write_b32 a124, 0
v_accvgpr_write_b32 a125, 0
v_mfma_f32_16x16x32_bf16 v[228:231], v[80:83], v[104:107], v[228:231]
s_add_u32 s72, s70, 0
buffer_load_dwordx4 v4, s[4:7], s72 offen lds
v_mfma_f32_16x16x32_bf16 v[232:235], v[80:83], v[112:115], v[232:235]
ds_read_b64_tr_b16 v[76:77], v9 offset:8192
v_accvgpr_write_b32 a126, 0
v_mfma_f32_16x16x32_bf16 v[232:235], v[84:87], v[116:119], v[232:235]
ds_read_b128 v[60:63], v17 offset:6144
v_accvgpr_write_b32 a127, 0
v_mfma_f32_16x16x32_bf16 v[236:239], v[84:87], v[124:127], v[236:239]
ds_read_b64_tr_b16 v[78:79], v9 offset:9216
v_mfma_f32_16x16x32_bf16 v[236:239], v[80:83], v[120:123], v[236:239]
v_mfma_f32_16x16x32_bf16 v[252:255], v[88:91], v[120:123], v[252:255]
s_add_u32 s72, s70, 15360
buffer_load_dwordx4 v5, s[4:7], s72 offen offset:1024 lds
v_mfma_f32_16x16x32_bf16 v[252:255], v[92:95], v[124:127], v[252:255]
ds_read_b64_tr_b16 v[80:81], v10 offset:0
v_mfma_f32_16x16x32_bf16 v[248:251], v[92:95], v[116:119], v[248:251]
ds_read_b64_tr_b16 v[82:83], v10 offset:1024
v_mfma_f32_16x16x32_bf16 v[248:251], v[88:91], v[112:115], v[248:251]
v_mfma_f32_16x16x32_bf16 v[244:247], v[88:91], v[104:107], v[244:247]
ds_read_b64_tr_b16 v[84:85], v10 offset:8192
v_mfma_f32_16x16x32_bf16 v[244:247], v[92:95], v[108:111], v[244:247]
ds_read_b64_tr_b16 v[86:87], v10 offset:9216
v_mfma_f32_16x16x32_bf16 v[240:243], v[92:95], v[100:103], v[240:243]
s_add_u32 s72, s70, 129024
buffer_load_dwordx4 v4, s[4:7], s72 offen offset:2048 lds
v_mfma_f32_16x16x32_bf16 v[240:243], v[88:91], v[96:99], v[240:243]
s_waitcnt lgkmcnt(5)
v_mfma_f32_16x16x32_bf16 v[128:131], v[64:67], v[32:35], v[128:131]
ds_read_b64_tr_b16 v[88:89], v11 offset:0
v_mfma_f32_16x16x32_bf16 v[128:131], v[68:71], v[36:39], v[128:131]
ds_read_b64_tr_b16 v[90:91], v11 offset:1024
v_mfma_f32_16x16x32_bf16 v[132:135], v[68:71], v[44:47], v[132:135]
v_mfma_f32_16x16x32_bf16 v[132:135], v[64:67], v[40:43], v[132:135]
s_add_u32 s72, s70, 144384
buffer_load_dwordx4 v5, s[4:7], s72 offen offset:3072 lds
v_mfma_f32_16x16x32_bf16 v[136:139], v[64:67], v[48:51], v[136:139]
ds_read_b64_tr_b16 v[92:93], v11 offset:8192
v_mfma_f32_16x16x32_bf16 v[136:139], v[68:71], v[52:55], v[136:139]
s_lshl_b32 s71, s73, 12
v_mfma_f32_16x16x32_bf16 v[140:143], v[68:71], v[60:63], v[140:143]
s_add_u32 s71, s71, s66
ds_read_b64_tr_b16 v[94:95], v11 offset:9216
v_mfma_f32_16x16x32_bf16 v[140:143], v[64:67], v[56:59], v[140:143]
s_waitcnt lgkmcnt(8)
v_mfma_f32_16x16x32_bf16 v[156:159], v[72:75], v[56:59], v[156:159]
s_add_u32 m0, s64, 32768
ds_read_b64_tr_b16 v[64:65], v12 offset:0
v_mfma_f32_16x16x32_bf16 v[156:159], v[76:79], v[60:63], v[156:159]
s_add_u32 s72, s71, 0
buffer_load_dwordx4 v6, s[12:15], s72 offen lds
v_mfma_f32_16x16x32_bf16 v[152:155], v[76:79], v[52:55], v[152:155]
s_add_u32 s73, s62, 15
ds_read_b64_tr_b16 v[66:67], v12 offset:1024
v_mfma_f32_16x16x32_bf16 v[152:155], v[72:75], v[48:51], v[152:155]
s_add_u32 s70, s73, s65
v_mfma_f32_16x16x32_bf16 v[148:151], v[72:75], v[40:43], v[148:151]
s_and_b32 s70, s70, 3
ds_read_b64_tr_b16 v[68:69], v12 offset:8192
v_mfma_f32_16x16x32_bf16 v[148:151], v[76:79], v[44:47], v[148:151]
s_and_b32 s73, s73, 12
ds_read_b64_tr_b16 v[70:71], v12 offset:9216
v_mfma_f32_16x16x32_bf16 v[144:147], v[76:79], v[36:39], v[144:147]
s_add_u32 s72, s71, 31744
buffer_load_dwordx4 v6, s[12:15], s72 offen offset:1024 lds
v_mfma_f32_16x16x32_bf16 v[144:147], v[72:75], v[32:35], v[144:147]
s_waitcnt lgkmcnt(8)
v_mfma_f32_16x16x32_bf16 v[160:163], v[80:83], v[32:35], v[160:163]
s_or_b32 s73, s73, s70
ds_read_b64_tr_b16 v[72:73], v13 offset:0
v_mfma_f32_16x16x32_bf16 v[160:163], v[84:87], v[36:39], v[160:163]
s_lshl_b32 s73, s73, 7
ds_read_b64_tr_b16 v[74:75], v13 offset:1024
v_mfma_f32_16x16x32_bf16 v[164:167], v[84:87], v[44:47], v[164:167]
s_add_u32 s69, s73, s67
v_mfma_f32_16x16x32_bf16 v[164:167], v[80:83], v[40:43], v[164:167]
s_add_u32 s72, s71, 63488
buffer_load_dwordx4 v7, s[12:15], s72 offen offset:2048 lds
v_mfma_f32_16x16x32_bf16 v[168:171], v[80:83], v[48:51], v[168:171]
s_waitcnt vmcnt(15)
ds_read_b64_tr_b16 v[76:77], v13 offset:8192
v_mfma_f32_16x16x32_bf16 v[168:171], v[84:87], v[52:55], v[168:171]
s_add_u32 s70, s73, s68
ds_read_b128 v[96:99], v18 offset:0
v_mfma_f32_16x16x32_bf16 v[172:175], v[84:87], v[60:63], v[172:175]
ds_read_b64_tr_b16 v[78:79], v13 offset:9216
v_mfma_f32_16x16x32_bf16 v[172:175], v[80:83], v[56:59], v[172:175]
s_waitcnt lgkmcnt(9)
ds_read_b128 v[100:103], v19 offset:0
v_mfma_f32_16x16x32_bf16 v[188:191], v[88:91], v[56:59], v[188:191]
s_add_u32 s72, s71, 95232
buffer_load_dwordx4 v7, s[12:15], s72 offen offset:3072 lds
v_mfma_f32_16x16x32_bf16 v[188:191], v[92:95], v[60:63], v[188:191]
ds_read_b64_tr_b16 v[80:81], v14 offset:0
v_mfma_f32_16x16x32_bf16 v[184:187], v[92:95], v[52:55], v[184:187]
ds_read_b64_tr_b16 v[82:83], v14 offset:1024
v_mfma_f32_16x16x32_bf16 v[184:187], v[88:91], v[48:51], v[184:187]
v_mfma_f32_16x16x32_bf16 v[180:183], v[88:91], v[40:43], v[180:183]
ds_read_b64_tr_b16 v[84:85], v14 offset:8192
v_mfma_f32_16x16x32_bf16 v[180:183], v[92:95], v[44:47], v[180:183]
s_add_u32 m0, s63, 131072
ds_read_b64_tr_b16 v[86:87], v14 offset:9216
v_mfma_f32_16x16x32_bf16 v[176:179], v[92:95], v[36:39], v[176:179]
s_add_u32 s72, s69, 0
buffer_load_dwordx4 v4, s[4:7], s72 offen lds
v_mfma_f32_16x16x32_bf16 v[176:179], v[88:91], v[32:35], v[176:179]
s_waitcnt lgkmcnt(10)
ds_read_b128 v[104:107], v18 offset:2048
v_mfma_f32_16x16x32_bf16 v[192:195], v[64:67], v[32:35], v[192:195]
ds_read_b64_tr_b16 v[88:89], v15 offset:0
ds_read_b64_tr_b16 v[90:91], v15 offset:1024
v_mfma_f32_16x16x32_bf16 v[192:195], v[68:71], v[36:39], v[192:195]
ds_read_b64_tr_b16 v[92:93], v15 offset:8192
v_mfma_f32_16x16x32_bf16 v[196:199], v[68:71], v[44:47], v[196:199]
s_and_b32 s75, s91, 0xfffffc7f
v_lshrrev_b32 v2, 3, v0
v_lshlrev_b32 v2, 7, v2
v_mfma_f32_16x16x32_bf16 v[196:199], v[64:67], v[40:43], v[196:199]
s_add_u32 s72, s69, 15360
buffer_load_dwordx4 v5, s[4:7], s72 offen offset:1024 lds
v_mfma_f32_16x16x32_bf16 v[200:203], v[64:67], v[48:51], v[200:203]
buffer_load_dword v3, v2, s[44:47], s75 offen sc1
v_mfma_f32_16x16x32_bf16 v[200:203], v[68:71], v[52:55], v[200:203]
ds_read_b64_tr_b16 v[94:95], v15 offset:9216
v_mfma_f32_16x16x32_bf16 v[204:207], v[68:71], v[60:63], v[204:207]
ds_read_b128 v[108:111], v19 offset:2048
v_mfma_f32_16x16x32_bf16 v[204:207], v[64:67], v[56:59], v[204:207]
s_waitcnt lgkmcnt(11)
v_mfma_f32_16x16x32_bf16 v[220:223], v[72:75], v[56:59], v[220:223]
s_add_u32 s72, s69, 129024
buffer_load_dwordx4 v4, s[4:7], s72 offen offset:2048 lds
v_mfma_f32_16x16x32_bf16 v[220:223], v[76:79], v[60:63], v[220:223]
ds_read_b128 v[112:115], v18 offset:4096
v_mfma_f32_16x16x32_bf16 v[216:219], v[76:79], v[52:55], v[216:219]
s_waitcnt vmcnt(16) lgkmcnt(2)
ds_read_b128 v[116:119], v19 offset:4096
v_mfma_f32_16x16x32_bf16 v[216:219], v[72:75], v[48:51], v[216:219]
s_barrier
v_mfma_f32_16x16x32_bf16 v[212:215], v[72:75], v[40:43], v[212:215]
ds_read_b64_tr_b16 v[64:65], v8 offset:16384
ds_read_b64_tr_b16 v[66:67], v8 offset:17408
v_mfma_f32_16x16x32_bf16 v[212:215], v[76:79], v[44:47], v[212:215]
ds_read_b64_tr_b16 v[68:69], v8 offset:24576
v_mfma_f32_16x16x32_bf16 v[208:211], v[76:79], v[36:39], v[208:211]
s_add_u32 s72, s69, 144384
buffer_load_dwordx4 v5, s[4:7], s72 offen offset:3072 lds
v_mfma_f32_16x16x32_bf16 v[208:211], v[72:75], v[32:35], v[208:211]
ds_read_b64_tr_b16 v[70:71], v8 offset:25600
v_mfma_f32_16x16x32_bf16 v[224:227], v[80:83], v[32:35], v[224:227]
ds_read_b64_tr_b16 v[72:73], v9 offset:16384
v_mfma_f32_16x16x32_bf16 v[224:227], v[84:87], v[36:39], v[224:227]
ds_read_b64_tr_b16 v[74:75], v9 offset:17408
v_mfma_f32_16x16x32_bf16 v[228:231], v[84:87], v[44:47], v[228:231]
s_add_u32 m0, s63, 135168
ds_read_b128 v[120:123], v18 offset:6144
v_mfma_f32_16x16x32_bf16 v[228:231], v[80:83], v[40:43], v[228:231]
s_add_u32 s72, s70, 0
buffer_load_dwordx4 v4, s[4:7], s72 offen lds
v_mfma_f32_16x16x32_bf16 v[232:235], v[80:83], v[48:51], v[232:235]
ds_read_b64_tr_b16 v[76:77], v9 offset:24576
v_mfma_f32_16x16x32_bf16 v[232:235], v[84:87], v[52:55], v[232:235]
ds_read_b128 v[124:127], v19 offset:6144
v_mfma_f32_16x16x32_bf16 v[236:239], v[84:87], v[60:63], v[236:239]
ds_read_b64_tr_b16 v[78:79], v9 offset:25600
v_mfma_f32_16x16x32_bf16 v[236:239], v[80:83], v[56:59], v[236:239]
v_mfma_f32_16x16x32_bf16 v[252:255], v[88:91], v[56:59], v[252:255]
s_add_u32 s72, s70, 15360
buffer_load_dwordx4 v5, s[4:7], s72 offen offset:1024 lds
v_mfma_f32_16x16x32_bf16 v[252:255], v[92:95], v[60:63], v[252:255]
ds_read_b64_tr_b16 v[80:81], v10 offset:16384
v_mfma_f32_16x16x32_bf16 v[248:251], v[92:95], v[52:55], v[248:251]
ds_read_b64_tr_b16 v[82:83], v10 offset:17408
v_mfma_f32_16x16x32_bf16 v[248:251], v[88:91], v[48:51], v[248:251]
v_mfma_f32_16x16x32_bf16 v[244:247], v[88:91], v[40:43], v[244:247]
ds_read_b64_tr_b16 v[84:85], v10 offset:24576
v_mfma_f32_16x16x32_bf16 v[244:247], v[92:95], v[44:47], v[244:247]
ds_read_b64_tr_b16 v[86:87], v10 offset:25600
v_mfma_f32_16x16x32_bf16 v[240:243], v[92:95], v[36:39], v[240:243]
s_add_u32 s72, s70, 129024
buffer_load_dwordx4 v4, s[4:7], s72 offen offset:2048 lds
v_mfma_f32_16x16x32_bf16 v[240:243], v[88:91], v[32:35], v[240:243]
s_waitcnt lgkmcnt(5)
v_mfma_f32_16x16x32_bf16 v[128:131], v[64:67], v[96:99], v[128:131]
ds_read_b64_tr_b16 v[88:89], v11 offset:16384
v_mfma_f32_16x16x32_bf16 v[128:131], v[68:71], v[100:103], v[128:131]
ds_read_b64_tr_b16 v[90:91], v11 offset:17408
v_mfma_f32_16x16x32_bf16 v[132:135], v[68:71], v[108:111], v[132:135]
v_mfma_f32_16x16x32_bf16 v[132:135], v[64:67], v[104:107], v[132:135]
s_add_u32 s72, s70, 144384
buffer_load_dwordx4 v5, s[4:7], s72 offen offset:3072 lds
v_mfma_f32_16x16x32_bf16 v[136:139], v[64:67], v[112:115], v[136:139]
ds_read_b64_tr_b16 v[92:93], v11 offset:24576
v_mfma_f32_16x16x32_bf16 v[136:139], v[68:71], v[116:119], v[136:139]
s_lshl_b32 s71, s73, 12
v_mfma_f32_16x16x32_bf16 v[140:143], v[68:71], v[124:127], v[140:143]
s_add_u32 s71, s71, s66
ds_read_b64_tr_b16 v[94:95], v11 offset:25600
v_mfma_f32_16x16x32_bf16 v[140:143], v[64:67], v[120:123], v[140:143]
s_waitcnt lgkmcnt(8)
v_mfma_f32_16x16x32_bf16 v[156:159], v[72:75], v[120:123], v[156:159]
s_add_u32 m0, s64, 0
ds_read_b64_tr_b16 v[64:65], v12 offset:16384
v_mfma_f32_16x16x32_bf16 v[156:159], v[76:79], v[124:127], v[156:159]
s_add_u32 s72, s71, 0
buffer_load_dwordx4 v6, s[12:15], s72 offen lds
v_mfma_f32_16x16x32_bf16 v[152:155], v[76:79], v[116:119], v[152:155]
ds_read_b64_tr_b16 v[66:67], v12 offset:17408
v_mfma_f32_16x16x32_bf16 v[152:155], v[72:75], v[112:115], v[152:155]
v_mfma_f32_16x16x32_bf16 v[148:151], v[72:75], v[104:107], v[148:151]
ds_read_b64_tr_b16 v[68:69], v12 offset:24576
v_mfma_f32_16x16x32_bf16 v[148:151], v[76:79], v[108:111], v[148:151]
ds_read_b64_tr_b16 v[70:71], v12 offset:25600
v_mfma_f32_16x16x32_bf16 v[144:147], v[76:79], v[100:103], v[144:147]
s_add_u32 s72, s71, 31744
buffer_load_dwordx4 v6, s[12:15], s72 offen offset:1024 lds
v_mfma_f32_16x16x32_bf16 v[144:147], v[72:75], v[96:99], v[144:147]
s_waitcnt lgkmcnt(8)
v_mfma_f32_16x16x32_bf16 v[160:163], v[80:83], v[96:99], v[160:163]
ds_read_b64_tr_b16 v[72:73], v13 offset:16384
v_mfma_f32_16x16x32_bf16 v[160:163], v[84:87], v[100:103], v[160:163]
ds_read_b64_tr_b16 v[74:75], v13 offset:17408
v_mfma_f32_16x16x32_bf16 v[164:167], v[84:87], v[108:111], v[164:167]
v_mfma_f32_16x16x32_bf16 v[164:167], v[80:83], v[104:107], v[164:167]
s_add_u32 s72, s71, 63488
buffer_load_dwordx4 v7, s[12:15], s72 offen offset:2048 lds
v_mfma_f32_16x16x32_bf16 v[168:171], v[80:83], v[112:115], v[168:171]
s_waitcnt vmcnt(16)
ds_read_b64_tr_b16 v[76:77], v13 offset:24576
v_mfma_f32_16x16x32_bf16 v[168:171], v[84:87], v[116:119], v[168:171]
ds_read_b128 v[32:35], v18 offset:32768
v_mfma_f32_16x16x32_bf16 v[172:175], v[84:87], v[124:127], v[172:175]
ds_read_b64_tr_b16 v[78:79], v13 offset:25600
v_mfma_f32_16x16x32_bf16 v[172:175], v[80:83], v[120:123], v[172:175]
s_waitcnt lgkmcnt(9)
ds_read_b128 v[36:39], v19 offset:32768
v_mfma_f32_16x16x32_bf16 v[188:191], v[88:91], v[120:123], v[188:191]
s_add_u32 s72, s71, 95232
buffer_load_dwordx4 v7, s[12:15], s72 offen offset:3072 lds
v_mfma_f32_16x16x32_bf16 v[188:191], v[92:95], v[124:127], v[188:191]
v_accvgpr_write_b32 a0, -1
v_accvgpr_write_b32 a1, -1
v_mfma_f32_16x16x32_bf16 v[184:187], v[92:95], v[116:119], v[184:187]
v_accvgpr_write_b32 a2, -1
v_accvgpr_write_b32 a3, -1
v_mfma_f32_16x16x32_bf16 v[184:187], v[88:91], v[112:115], v[184:187]
s_add_u32 s80, s93, 0x3a00000
ds_read_b64_tr_b16 v[80:81], v14 offset:16384
v_mfma_f32_16x16x32_bf16 v[180:183], v[88:91], v[104:107], v[180:183]
ds_read_b64_tr_b16 v[82:83], v14 offset:17408
v_mfma_f32_16x16x32_bf16 v[180:183], v[92:95], v[108:111], v[180:183]
ds_read_b64_tr_b16 v[84:85], v14 offset:24576
v_mfma_f32_16x16x32_bf16 v[176:179], v[92:95], v[100:103], v[176:179]
ds_read_b64_tr_b16 v[86:87], v14 offset:25600
v_mfma_f32_16x16x32_bf16 v[176:179], v[88:91], v[96:99], v[176:179]
s_waitcnt lgkmcnt(10)
ds_read_b128 v[40:43], v18 offset:34816
v_mfma_f32_16x16x32_bf16 v[192:195], v[64:67], v[96:99], v[192:195]
s_waitcnt vmcnt(10)
v_cmp_gt_u32 vcc, 1, v3
s_cbranch_vccnz Lspin4
Lback5:
v_mfma_f32_16x16x32_bf16 v[192:195], v[68:71], v[100:103], v[192:195]
s_add_u32 m0, s64, 49152
ds_read_b64_tr_b16 v[88:89], v15 offset:16384
ds_read_b64_tr_b16 v[90:91], v15 offset:17408
v_mfma_f32_16x16x32_bf16 v[196:199], v[68:71], v[108:111], v[196:199]
s_add_u32 s72, s81, 16384
buffer_load_dwordx4 v1, s[44:47], s72 offen sc1 lds
v_mfma_f32_16x16x32_bf16 v[196:199], v[64:67], v[104:107], v[196:199]
ds_read_b64_tr_b16 v[92:93], v15 offset:24576
v_mfma_f32_16x16x32_bf16 v[200:203], v[64:67], v[112:115], v[200:203]
ds_read_b64_tr_b16 v[94:95], v15 offset:25600
v_mfma_f32_16x16x32_bf16 v[200:203], v[68:71], v[116:119], v[200:203]
buffer_load_dwordx4 v1, s[44:47], s72 offen offset:1024 sc1 lds
v_mfma_f32_16x16x32_bf16 v[204:207], v[68:71], v[124:127], v[204:207]
ds_read_b128 v[44:47], v19 offset:34816
v_mfma_f32_16x16x32_bf16 v[204:207], v[64:67], v[120:123], v[204:207]
s_waitcnt lgkmcnt(11)
v_mfma_f32_16x16x32_bf16 v[220:223], v[72:75], v[120:123], v[220:223]
ds_read_b128 v[48:51], v18 offset:36864
v_mfma_f32_16x16x32_bf16 v[220:223], v[76:79], v[124:127], v[220:223]
ds_read_b128 v[52:55], v19 offset:36864
v_mfma_f32_16x16x32_bf16 v[216:219], v[76:79], v[116:119], v[216:219]
s_waitcnt vmcnt(15) lgkmcnt(3)
buffer_load_dwordx4 v1, s[44:47], s72 offen offset:2048 sc1 lds
v_mfma_f32_16x16x32_bf16 v[216:219], v[72:75], v[112:115], v[216:219]
s_barrier
ds_read_b128 v[56:59], v18 offset:38912
v_mfma_f32_16x16x32_bf16 v[212:215], v[72:75], v[104:107], v[212:215]
ds_read_b64_tr_b16 v[64:65], v8 offset:32768
ds_read_b64_tr_b16 v[66:67], v8 offset:33792
v_mfma_f32_16x16x32_bf16 v[212:215], v[76:79], v[108:111], v[212:215]
ds_read_b64_tr_b16 v[68:69], v8 offset:40960
v_mfma_f32_16x16x32_bf16 v[208:211], v[76:79], v[100:103], v[208:211]
ds_read_b64_tr_b16 v[70:71], v8 offset:41984
v_mfma_f32_16x16x32_bf16 v[208:211], v[72:75], v[96:99], v[208:211]
buffer_load_dwordx4 v1, s[44:47], s72 offen offset:3072 sc1 lds
v_mfma_f32_16x16x32_bf16 v[224:227], v[80:83], v[96:99], v[224:227]
s_add_u32 s81, s81, 0x8000
ds_read_b64_tr_b16 v[72:73], v9 offset:32768
v_mfma_f32_16x16x32_bf16 v[224:227], v[84:87], v[100:103], v[224:227]
s_add_u32 m0, s64, 81920
ds_read_b64_tr_b16 v[74:75], v9 offset:33792
v_mfma_f32_16x16x32_bf16 v[228:231], v[84:87], v[108:111], v[228:231]
s_add_u32 s72, s81, 16384
buffer_load_dwordx4 v1, s[44:47], s72 offen sc1 lds
v_mfma_f32_16x16x32_bf16 v[228:231], v[80:83], v[104:107], v[228:231]
ds_read_b128 v[60:63], v19 offset:38912
v_mfma_f32_16x16x32_bf16 v[232:235], v[80:83], v[112:115], v[232:235]
buffer_load_dwordx4 v1, s[44:47], s72 offen offset:1024 sc1 lds
v_mfma_f32_16x16x32_bf16 v[232:235], v[84:87], v[116:119], v[232:235]
ds_read_b64_tr_b16 v[76:77], v9 offset:40960
v_mfma_f32_16x16x32_bf16 v[236:239], v[84:87], v[124:127], v[236:239]
ds_read_b64_tr_b16 v[78:79], v9 offset:41984
v_mfma_f32_16x16x32_bf16 v[236:239], v[80:83], v[120:123], v[236:239]
v_mfma_f32_16x16x32_bf16 v[252:255], v[88:91], v[120:123], v[252:255]
ds_read_b64_tr_b16 v[80:81], v10 offset:32768
v_mfma_f32_16x16x32_bf16 v[252:255], v[92:95], v[124:127], v[252:255]
buffer_load_dwordx4 v1, s[44:47], s72 offen offset:2048 sc1 lds
v_mfma_f32_16x16x32_bf16 v[248:251], v[92:95], v[116:119], v[248:251]
ds_read_b64_tr_b16 v[82:83], v10 offset:33792
v_mfma_f32_16x16x32_bf16 v[248:251], v[88:91], v[112:115], v[248:251]
v_mfma_f32_16x16x32_bf16 v[244:247], v[88:91], v[104:107], v[244:247]
ds_read_b64_tr_b16 v[84:85], v10 offset:40960
v_mfma_f32_16x16x32_bf16 v[244:247], v[92:95], v[108:111], v[244:247]
buffer_load_dwordx4 v1, s[44:47], s72 offen offset:3072 sc1 lds
v_mfma_f32_16x16x32_bf16 v[240:243], v[92:95], v[100:103], v[240:243]
ds_read_b64_tr_b16 v[86:87], v10 offset:41984
v_mfma_f32_16x16x32_bf16 v[240:243], v[88:91], v[96:99], v[240:243]
s_waitcnt lgkmcnt(6)
LcS:
v_mfma_f32_16x16x32_bf16 v[128:131], v[64:67], v[32:35], v[128:131]
ds_read_b64_tr_b16 v[88:89], v11 offset:32768
v_mfma_f32_16x16x32_bf16 v[128:131], v[68:71], v[36:39], v[128:131]
ds_read_b64_tr_b16 v[90:91], v11 offset:33792
v_mfma_f32_16x16x32_bf16 v[132:135], v[68:71], v[44:47], v[132:135]
s_add_u32 m0, s64, 65536
v_mfma_f32_16x16x32_bf16 v[132:135], v[64:67], v[40:43], v[132:135]
s_add_u32 s72, s81, 0
buffer_load_dwordx4 v1, s[44:47], s72 offen sc1 lds
v_mfma_f32_16x16x32_bf16 v[136:139], v[64:67], v[48:51], v[136:139]
ds_read_b64_tr_b16 v[92:93], v11 offset:40960
v_mfma_f32_16x16x32_bf16 v[136:139], v[68:71], v[52:55], v[136:139]
ds_read_b64_tr_b16 v[94:95], v11 offset:41984
v_mfma_f32_16x16x32_bf16 v[140:143], v[68:71], v[60:63], v[140:143]
v_mfma_f32_16x16x32_bf16 v[140:143], v[64:67], v[56:59], v[140:143]
s_waitcnt lgkmcnt(8)
buffer_load_dwordx4 v1, s[44:47], s72 offen offset:1024 sc1 lds
v_mfma_f32_16x16x32_bf16 v[156:159], v[72:75], v[56:59], v[156:159]
ds_read_b64_tr_b16 v[64:65], v12 offset:32768
v_mfma_f32_16x16x32_bf16 v[156:159], v[76:79], v[60:63], v[156:159]
ds_read_b64_tr_b16 v[66:67], v12 offset:33792
v_mfma_f32_16x16x32_bf16 v[152:155], v[76:79], v[52:55], v[152:155]
v_mfma_f32_16x16x32_bf16 v[152:155], v[72:75], v[48:51], v[152:155]
buffer_load_dwordx4 v1, s[44:47], s72 offen offset:2048 sc1 lds
v_mfma_f32_16x16x32_bf16 v[148:151], v[72:75], v[40:43], v[148:151]
ds_read_b64_tr_b16 v[68:69], v12 offset:40960
v_mfma_f32_16x16x32_bf16 v[148:151], v[76:79], v[44:47], v[148:151]
v_mfma_f32_16x16x32_bf16 v[144:147], v[76:79], v[36:39], v[144:147]
ds_read_b64_tr_b16 v[70:71], v12 offset:41984
v_mfma_f32_16x16x32_bf16 v[144:147], v[72:75], v[32:35], v[144:147]
s_waitcnt lgkmcnt(8)
v_mfma_f32_16x16x32_bf16 v[160:163], v[80:83], v[32:35], v[160:163]
buffer_load_dwordx4 v1, s[44:47], s72 offen offset:3072 sc1 lds
v_mfma_f32_16x16x32_bf16 v[160:163], v[84:87], v[36:39], v[160:163]
ds_read_b64_tr_b16 v[72:73], v13 offset:32768
v_mfma_f32_16x16x32_bf16 v[164:167], v[84:87], v[44:47], v[164:167]
ds_read_b64_tr_b16 v[74:75], v13 offset:33792
v_mfma_f32_16x16x32_bf16 v[164:167], v[80:83], v[40:43], v[164:167]
v_mfma_f32_16x16x32_bf16 v[168:171], v[80:83], v[48:51], v[168:171]
s_waitcnt vmcnt(16)
ds_read_b64_tr_b16 v[76:77], v13 offset:40960
v_mfma_f32_16x16x32_bf16 v[168:171], v[84:87], v[52:55], v[168:171]
ds_read_b128 v[96:99], v16 offset:0
v_mfma_f32_16x16x32_bf16 v[172:175], v[84:87], v[60:63], v[172:175]
ds_read_b64_tr_b16 v[78:79], v13 offset:41984
v_mfma_f32_16x16x32_bf16 v[172:175], v[80:83], v[56:59], v[172:175]
s_waitcnt lgkmcnt(9)
v_mfma_f32_16x16x32_bf16 v[188:191], v[88:91], v[56:59], v[188:191]
ds_read_b64_tr_b16 v[80:81], v14 offset:32768
v_mfma_f32_16x16x32_bf16 v[188:191], v[92:95], v[60:63], v[188:191]
ds_read_b128 v[100:103], v17 offset:0
v_mfma_f32_16x16x32_bf16 v[184:187], v[92:95], v[52:55], v[184:187]
ds_read_b64_tr_b16 v[82:83], v14 offset:33792
v_mfma_f32_16x16x32_bf16 v[184:187], v[88:91], v[48:51], v[184:187]
v_mfma_f32_16x16x32_bf16 v[180:183], v[88:91], v[40:43], v[180:183]
ds_read_b64_tr_b16 v[84:85], v14 offset:40960
v_mfma_f32_16x16x32_bf16 v[180:183], v[92:95], v[44:47], v[180:183]
ds_read_b128 v[104:107], v16 offset:2048
v_mfma_f32_16x16x32_bf16 v[176:179], v[92:95], v[36:39], v[176:179]
ds_read_b64_tr_b16 v[86:87], v14 offset:41984
v_mfma_f32_16x16x32_bf16 v[176:179], v[88:91], v[32:35], v[176:179]
s_waitcnt lgkmcnt(11)
v_mfma_f32_16x16x32_bf16 v[192:195], v[64:67], v[32:35], v[192:195]
ds_read_b64_tr_b16 v[88:89], v15 offset:32768
v_mfma_f32_16x16x32_bf16 v[192:195], v[68:71], v[36:39], v[192:195]
ds_read_b64_tr_b16 v[90:91], v15 offset:33792
v_mfma_f32_16x16x32_bf16 v[196:199], v[68:71], v[44:47], v[196:199]
ds_read_b128 v[108:111], v17 offset:2048
v_mfma_f32_16x16x32_bf16 v[196:199], v[64:67], v[40:43], v[196:199]
ds_read_b64_tr_b16 v[92:93], v15 offset:40960
v_mfma_f32_16x16x32_bf16 v[200:203], v[64:67], v[48:51], v[200:203]
ds_read_b64_tr_b16 v[94:95], v15 offset:41984
v_mfma_f32_16x16x32_bf16 v[200:203], v[68:71], v[52:55], v[200:203]
v_mfma_f32_16x16x32_bf16 v[204:207], v[68:71], v[60:63], v[204:207]
ds_read_b128 v[112:115], v16 offset:4096
v_mfma_f32_16x16x32_bf16 v[204:207], v[64:67], v[56:59], v[204:207]
s_waitcnt lgkmcnt(12)
v_mfma_f32_16x16x32_bf16 v[220:223], v[72:75], v[56:59], v[220:223]
ds_read_b128 v[116:119], v17 offset:4096
v_mfma_f32_16x16x32_bf16 v[220:223], v[76:79], v[60:63], v[220:223]
v_mfma_f32_16x16x32_bf16 v[216:219], v[76:79], v[52:55], v[216:219]
s_waitcnt vmcnt(12) lgkmcnt(2)
ds_read_b128 v[120:123], v16 offset:6144
v_mfma_f32_16x16x32_bf16 v[216:219], v[72:75], v[48:51], v[216:219]
s_barrier
v_mfma_f32_16x16x32_bf16 v[212:215], v[72:75], v[40:43], v[212:215]
s_add_u32 s81, s81, 0x8000
ds_read_b64_tr_b16 v[64:65], v8 offset:0
ds_read_b64_tr_b16 v[66:67], v8 offset:1024
v_mfma_f32_16x16x32_bf16 v[212:215], v[76:79], v[44:47], v[212:215]
s_add_u32 m0, s64, 114688
ds_read_b64_tr_b16 v[68:69], v8 offset:8192
v_mfma_f32_16x16x32_bf16 v[208:211], v[76:79], v[36:39], v[208:211]
s_add_u32 s72, s81, 16384
buffer_load_dwordx4 v1, s[44:47], s72 offen sc1 lds
v_mfma_f32_16x16x32_bf16 v[208:211], v[72:75], v[32:35], v[208:211]
ds_read_b64_tr_b16 v[70:71], v8 offset:9216
v_mfma_f32_16x16x32_bf16 v[224:227], v[80:83], v[32:35], v[224:227]
buffer_load_dwordx4 v1, s[44:47], s72 offen offset:1024 sc1 lds
v_mfma_f32_16x16x32_bf16 v[224:227], v[84:87], v[36:39], v[224:227]
ds_read_b64_tr_b16 v[72:73], v9 offset:0
v_mfma_f32_16x16x32_bf16 v[228:231], v[84:87], v[44:47], v[228:231]
ds_read_b64_tr_b16 v[74:75], v9 offset:1024
v_mfma_f32_16x16x32_bf16 v[228:231], v[80:83], v[40:43], v[228:231]
ds_read_b128 v[124:127], v17 offset:6144
v_mfma_f32_16x16x32_bf16 v[232:235], v[80:83], v[48:51], v[232:235]
ds_read_b64_tr_b16 v[76:77], v9 offset:8192
v_mfma_f32_16x16x32_bf16 v[232:235], v[84:87], v[52:55], v[232:235]
buffer_store_dwordx4 a[0:3], v1, s[44:47], s80 offen sc1
v_mfma_f32_16x16x32_bf16 v[236:239], v[84:87], v[60:63], v[236:239]
Lstub0:
s_cbranch_execz Lstub4
ds_read_b64_tr_b16 v[78:79], v9 offset:9216
v_mfma_f32_16x16x32_bf16 v[236:239], v[80:83], v[56:59], v[236:239]
v_mfma_f32_16x16x32_bf16 v[252:255], v[88:91], v[56:59], v[252:255]
ds_read_b64_tr_b16 v[80:81], v10 offset:0
v_mfma_f32_16x16x32_bf16 v[252:255], v[92:95], v[60:63], v[252:255]
ds_read_b64_tr_b16 v[82:83], v10 offset:1024
v_mfma_f32_16x16x32_bf16 v[248:251], v[92:95], v[52:55], v[248:251]
buffer_load_dwordx4 v1, s[44:47], s72 offen offset:2048 sc1 lds
v_mfma_f32_16x16x32_bf16 v[248:251], v[88:91], v[48:51], v[248:251]
v_mfma_f32_16x16x32_bf16 v[244:247], v[88:91], v[40:43], v[244:247]
ds_read_b64_tr_b16 v[84:85], v10 offset:8192
v_mfma_f32_16x16x32_bf16 v[244:247], v[92:95], v[44:47], v[244:247]
ds_read_b64_tr_b16 v[86:87], v10 offset:9216
v_mfma_f32_16x16x32_bf16 v[240:243], v[92:95], v[36:39], v[240:243]
buffer_load_dwordx4 v1, s[44:47], s72 offen offset:3072 sc1 lds
v_mfma_f32_16x16x32_bf16 v[240:243], v[88:91], v[32:35], v[240:243]
s_waitcnt lgkmcnt(6)
v_mfma_f32_16x16x32_bf16 v[128:131], v[64:67], v[96:99], v[128:131]
ds_read_b64_tr_b16 v[88:89], v11 offset:0
v_mfma_f32_16x16x32_bf16 v[128:131], v[68:71], v[100:103], v[128:131]
ds_read_b64_tr_b16 v[90:91], v11 offset:1024
v_mfma_f32_16x16x32_bf16 v[132:135], v[68:71], v[108:111], v[132:135]
v_mfma_f32_16x16x32_bf16 v[132:135], v[64:67], v[104:107], v[132:135]
buffer_store_dwordx4 a[0:3], v1, s[44:47], s80 offen offset:1024 sc1
v_mfma_f32_16x16x32_bf16 v[136:139], v[64:67], v[112:115], v[136:139]
ds_read_b64_tr_b16 v[92:93], v11 offset:8192
v_mfma_f32_16x16x32_bf16 v[136:139], v[68:71], v[116:119], v[136:139]
v_mfma_f32_16x16x32_bf16 v[140:143], v[68:71], v[124:127], v[140:143]
ds_read_b64_tr_b16 v[94:95], v11 offset:9216
v_mfma_f32_16x16x32_bf16 v[140:143], v[64:67], v[120:123], v[140:143]
s_waitcnt lgkmcnt(8)
v_mfma_f32_16x16x32_bf16 v[156:159], v[72:75], v[120:123], v[156:159]
s_add_u32 m0, s64, 98304
ds_read_b64_tr_b16 v[64:65], v12 offset:0
v_mfma_f32_16x16x32_bf16 v[156:159], v[76:79], v[124:127], v[156:159]
s_add_u32 s72, s81, 0
buffer_load_dwordx4 v1, s[44:47], s72 offen sc1 lds
v_mfma_f32_16x16x32_bf16 v[152:155], v[76:79], v[116:119], v[152:155]
ds_read_b64_tr_b16 v[66:67], v12 offset:1024
v_mfma_f32_16x16x32_bf16 v[152:155], v[72:75], v[112:115], v[152:155]
v_mfma_f32_16x16x32_bf16 v[148:151], v[72:75], v[104:107], v[148:151]
buffer_load_dwordx4 v1, s[44:47], s72 offen offset:1024 sc1 lds
v_mfma_f32_16x16x32_bf16 v[148:151], v[76:79], v[108:111], v[148:151]
ds_read_b64_tr_b16 v[68:69], v12 offset:8192
v_mfma_f32_16x16x32_bf16 v[144:147], v[76:79], v[100:103], v[144:147]
ds_read_b64_tr_b16 v[70:71], v12 offset:9216
v_mfma_f32_16x16x32_bf16 v[144:147], v[72:75], v[96:99], v[144:147]
s_waitcnt lgkmcnt(8)
v_mfma_f32_16x16x32_bf16 v[160:163], v[80:83], v[96:99], v[160:163]
ds_read_b64_tr_b16 v[72:73], v13 offset:0
v_mfma_f32_16x16x32_bf16 v[160:163], v[84:87], v[100:103], v[160:163]
buffer_store_dwordx4 a[0:3], v1, s[44:47], s80 offen offset:2048 sc1
v_mfma_f32_16x16x32_bf16 v[164:167], v[84:87], v[108:111], v[164:167]
ds_read_b64_tr_b16 v[74:75], v13 offset:1024
v_mfma_f32_16x16x32_bf16 v[164:167], v[80:83], v[104:107], v[164:167]
v_mfma_f32_16x16x32_bf16 v[168:171], v[80:83], v[112:115], v[168:171]
ds_read_b64_tr_b16 v[76:77], v13 offset:8192
v_cvt_pk_bf16_f32 v48, v136, v137
v_mfma_f32_16x16x32_bf16 v[168:171], v[84:87], v[116:119], v[168:171]
ds_read_b64_tr_b16 v[78:79], v13 offset:9216
v_cvt_pk_bf16_f32 v49, v138, v139
v_mfma_f32_16x16x32_bf16 v[172:175], v[84:87], v[124:127], v[172:175]
buffer_load_dwordx4 v1, s[44:47], s72 offen offset:2048 sc1 lds
v_mfma_f32_16x16x32_bf16 v[172:175], v[80:83], v[120:123], v[172:175]
s_waitcnt lgkmcnt(8)
v_cvt_pk_bf16_f32 v50, v152, v153
v_cvt_pk_bf16_f32 v51, v154, v155
v_mfma_f32_16x16x32_bf16 v[188:191], v[88:91], v[120:123], v[188:191]
v_add_u32 v2, 0x8000, v1
v_cvt_pk_bf16_f32 v32, v132, v133
v_mfma_f32_16x16x32_bf16 v[188:191], v[92:95], v[124:127], v[188:191]
ds_read_b64_tr_b16 v[80:81], v14 offset:0
v_cvt_pk_bf16_f32 v33, v134, v135
v_mfma_f32_16x16x32_bf16 v[184:187], v[92:95], v[116:119], v[184:187]
buffer_load_dwordx4 v1, s[44:47], s72 offen offset:3072 sc1 lds
v_mfma_f32_16x16x32_bf16 v[184:187], v[88:91], v[112:115], v[184:187]
ds_read_b64_tr_b16 v[82:83], v14 offset:1024
v_cvt_pk_bf16_f32 v34, v148, v149
v_mfma_f32_16x16x32_bf16 v[180:183], v[88:91], v[104:107], v[180:183]
ds_read_b64_tr_b16 v[84:85], v14 offset:8192
v_cvt_pk_bf16_f32 v35, v150, v151
v_mfma_f32_16x16x32_bf16 v[180:183], v[92:95], v[108:111], v[180:183]
ds_read_b64_tr_b16 v[86:87], v14 offset:9216
v_cvt_pk_bf16_f32 v16, v128, v129
v_mfma_f32_16x16x32_bf16 v[176:179], v[92:95], v[100:103], v[176:179]
v_cvt_pk_bf16_f32 v17, v130, v131
v_cvt_pk_bf16_f32 v18, v144, v145
v_mfma_f32_16x16x32_bf16 v[176:179], v[88:91], v[96:99], v[176:179]
s_waitcnt lgkmcnt(8)
buffer_store_dwordx4 a[0:3], v1, s[44:47], s80 offen offset:3072 sc1
v_mfma_f32_16x16x32_bf16 v[192:195], v[64:67], v[96:99], v[192:195]
ds_read_b64_tr_b16 v[88:89], v15 offset:0
v_cvt_pk_bf16_f32 v19, v146, v147
v_mfma_f32_16x16x32_bf16 v[192:195], v[68:71], v[100:103], v[192:195]
ds_read_b64_tr_b16 v[90:91], v15 offset:1024
v_mfma_f32_16x16x32_bf16 v[196:199], v[68:71], v[108:111], v[196:199]
ds_read_b64_tr_b16 v[92:93], v15 offset:8192
v_mfma_f32_16x16x32_bf16 v[196:199], v[64:67], v[104:107], v[196:199]
ds_read_b64_tr_b16 v[94:95], v15 offset:9216
v_mfma_f32_16x16x32_bf16 v[200:203], v[64:67], v[112:115], v[200:203]
v_lshrrev_b32 v3, 1, v0
v_lshlrev_b32 v3, 7, v3
v_mfma_f32_16x16x32_bf16 v[200:203], v[68:71], v[116:119], v[200:203]
buffer_load_dword v4, v3, s[36:39], s93 offen
v_mfma_f32_16x16x32_bf16 v[204:207], v[68:71], v[124:127], v[204:207]
v_cvt_pk_bf16_f32 v52, v168, v169
v_cvt_pk_bf16_f32 v53, v170, v171
v_mfma_f32_16x16x32_bf16 v[204:207], v[64:67], v[120:123], v[204:207]
s_waitcnt lgkmcnt(8)
v_cvt_pk_bf16_f32 v54, v184, v185
v_cvt_pk_bf16_f32 v55, v186, v187
v_mfma_f32_16x16x32_bf16 v[220:223], v[72:75], v[120:123], v[220:223]
v_cvt_pk_bf16_f32 v36, v164, v165
v_cvt_pk_bf16_f32 v37, v166, v167
v_mfma_f32_16x16x32_bf16 v[220:223], v[76:79], v[124:127], v[220:223]
v_cvt_pk_bf16_f32 v38, v180, v181
v_cvt_pk_bf16_f32 v39, v182, v183
v_mfma_f32_16x16x32_bf16 v[216:219], v[76:79], v[116:119], v[216:219]
s_waitcnt vmcnt(21) lgkmcnt(0)
v_cvt_pk_bf16_f32 v20, v160, v161
v_cvt_pk_bf16_f32 v21, v162, v163
v_mfma_f32_16x16x32_bf16 v[216:219], v[72:75], v[112:115], v[216:219]
s_barrier
v_cvt_pk_bf16_f32 v22, v176, v177
v_cvt_pk_bf16_f32 v23, v178, v179
v_mfma_f32_16x16x32_bf16 v[212:215], v[72:75], v[104:107], v[212:215]
ds_read_b128 a[128:131], v2 offset:16384
v_cvt_pk_bf16_f32 v64, v140, v141
v_mfma_f32_16x16x32_bf16 v[212:215], v[76:79], v[108:111], v[212:215]
v_cvt_pk_bf16_f32 v65, v142, v143
v_cvt_pk_bf16_f32 v66, v156, v157
v_mfma_f32_16x16x32_bf16 v[208:211], v[76:79], v[100:103], v[208:211]
ds_read_b128 a[132:135], v2 offset:17408
v_cvt_pk_bf16_f32 v67, v158, v159
v_mfma_f32_16x16x32_bf16 v[208:211], v[72:75], v[96:99], v[208:211]
v_cvt_pk_bf16_f32 v68, v172, v173
v_cvt_pk_bf16_f32 v69, v174, v175
v_mfma_f32_16x16x32_bf16 v[224:227], v[80:83], v[96:99], v[224:227]
ds_read_b128 a[136:139], v2 offset:18432
v_cvt_pk_bf16_f32 v70, v188, v189
v_mfma_f32_16x16x32_bf16 v[224:227], v[84:87], v[100:103], v[224:227]
v_cvt_pk_bf16_f32 v71, v190, v191
v_mfma_f32_16x16x32_bf16 v[228:231], v[84:87], v[108:111], v[228:231]
ds_read_b128 a[140:143], v2 offset:19456
v_mfma_f32_16x16x32_bf16 v[228:231], v[80:83], v[104:107], v[228:231]
v_mfma_f32_16x16x32_bf16 v[232:235], v[80:83], v[112:115], v[232:235]
ds_read_b128 a[144:147], v2 offset:20480
v_cvt_pk_bf16_f32 v72, v204, v205
v_mfma_f32_16x16x32_bf16 v[232:235], v[84:87], v[116:119], v[232:235]
v_cvt_pk_bf16_f32 v73, v206, v207
v_cvt_pk_bf16_f32 v74, v220, v221
v_mfma_f32_16x16x32_bf16 v[236:239], v[84:87], v[124:127], v[236:239]
ds_read_b128 a[148:151], v2 offset:21504
v_cvt_pk_bf16_f32 v75, v222, v223
v_mfma_f32_16x16x32_bf16 v[236:239], v[80:83], v[120:123], v[236:239]
v_cvt_pk_bf16_f32 v56, v200, v201
v_cvt_pk_bf16_f32 v57, v202, v203
v_mfma_f32_16x16x32_bf16 v[252:255], v[88:91], v[120:123], v[252:255]
ds_read_b128 a[152:155], v2 offset:22528
v_cvt_pk_bf16_f32 v58, v216, v217
v_mfma_f32_16x16x32_bf16 v[252:255], v[92:95], v[124:127], v[252:255]
v_cvt_pk_bf16_f32 v59, v218, v219
v_cvt_pk_bf16_f32 v40, v196, v197
v_mfma_f32_16x16x32_bf16 v[248:251], v[92:95], v[116:119], v[248:251]
ds_read_b128 a[156:159], v2 offset:23552
v_cvt_pk_bf16_f32 v41, v198, v199
v_mfma_f32_16x16x32_bf16 v[248:251], v[88:91], v[112:115], v[248:251]
v_cvt_pk_bf16_f32 v42, v212, v213
v_cvt_pk_bf16_f32 v43, v214, v215
v_mfma_f32_16x16x32_bf16 v[244:247], v[88:91], v[104:107], v[244:247]
v_cvt_pk_bf16_f32 v24, v192, v193
v_cvt_pk_bf16_f32 v25, v194, v195
v_mfma_f32_16x16x32_bf16 v[244:247], v[92:95], v[108:111], v[244:247]
v_cvt_pk_bf16_f32 v26, v208, v209
v_cvt_pk_bf16_f32 v27, v210, v211
v_mfma_f32_16x16x32_bf16 v[240:243], v[92:95], v[100:103], v[240:243]
v_mfma_f32_16x16x32_bf16 v[240:243], v[88:91], v[96:99], v[240:243]
v_cvt_pk_bf16_f32 v76, v236, v237
v_cvt_pk_bf16_f32 v77, v238, v239
v_cvt_pk_bf16_f32 v78, v252, v253
v_cvt_pk_bf16_f32 v79, v254, v255
v_cvt_pk_bf16_f32 v60, v232, v233
v_cvt_pk_bf16_f32 v61, v234, v235
v_cvt_pk_bf16_f32 v62, v248, v249
v_cvt_pk_bf16_f32 v63, v250, v251
v_cvt_pk_bf16_f32 v44, v228, v229
v_cvt_pk_bf16_f32 v45, v230, v231
v_cvt_pk_bf16_f32 v46, v244, v245
v_cvt_pk_bf16_f32 v47, v246, v247
v_cvt_pk_bf16_f32 v28, v224, v225
v_cvt_pk_bf16_f32 v29, v226, v227
v_cvt_pk_bf16_f32 v30, v240, v241
v_cvt_pk_bf16_f32 v31, v242, v243
v_mov_b32 v124, 0xff800000
v_mov_b32 v125, 0xff800000
v_mov_b32 v126, 0xff800000
v_mov_b32 v127, 0xff800000
s_lshl_b32 s84, s60, 2
s_add_u32 s84, s84, s58
s_mov_b32 s86, 0
s_mov_b32 s53, 0
s_lshr_b32 s52, s66, 8
s_and_b32 s52, s52, 31
s_add_u32 s61, s65, s60
s_and_b32 s73, s60, 1
s_lshl_b32 s73, s73, 16
s_add_u32 s77, s73, s64
s_xor_b32 s73, s73, 0x10000
s_mov_b32 s92, s73
s_mul_i32 s62, s58, 4608
s_add_u32 s62, s62, 143104
s_add_u32 s73, s73, 49920
s_cmp_eq_u32 s58, 0
s_cselect_b32 s62, s73, s62
Lattn:
s_mov_b32 s82, 0x10000
s_waitcnt lgkmcnt(0)
v_mfma_f32_16x16x32_bf16 v[136:139], a[128:131], v[48:51], 0
ds_read_b128 a[160:163], v2 offset:24576
v_lshrrev_b32 v240, 4, v0
v_mfma_f32_16x16x32_bf16 v[136:139], a[132:135], v[52:55], v[136:139]
ds_read_b128 a[164:167], v2 offset:25600
v_and_b32 v241, 15, v0
v_mfma_f32_16x16x32_bf16 v[136:139], a[136:139], v[56:59], v[136:139]
ds_read_b128 a[168:171], v2 offset:26624
v_lshlrev_b32 v240, 2, v240
v_mfma_f32_16x16x32_bf16 v[136:139], a[140:143], v[60:63], v[136:139]
ds_read_b128 a[172:175], v2 offset:27648
v_sub_u32 v240, v241, v240
v_mfma_f32_16x16x32_bf16 v[140:143], a[140:143], v[76:79], 0
ds_read_b128 a[176:179], v2 offset:28672
v_mov_b32 v112, 0xff800000
v_mfma_f32_16x16x32_bf16 v[140:143], a[136:139], v[72:75], v[140:143]
ds_read_b128 a[180:183], v2 offset:29696
v_mov_b32 v113, 0xff800000
v_mfma_f32_16x16x32_bf16 v[140:143], a[132:135], v[68:71], v[140:143]
ds_read_b128 a[184:187], v2 offset:30720
v_mov_b32 v114, 0xff800000
v_mfma_f32_16x16x32_bf16 v[140:143], a[128:131], v[64:67], v[140:143]
ds_read_b128 a[188:191], v2 offset:31744
v_mov_b32 v115, 0xff800000
v_mfma_f32_16x16x32_bf16 v[156:159], a[144:147], v[64:67], 0
v_cmp_gt_i32 vcc, 0, v240
v_and_b32 v120, 3, v0
v_mfma_f32_16x16x32_bf16 v[156:159], a[148:151], v[68:71], v[156:159]
v_cndmask_b32 v116, 0, v112, vcc
v_cmp_gt_i32 vcc, 1, v240
v_mfma_f32_16x16x32_bf16 v[156:159], a[152:155], v[72:75], v[156:159]
v_subrev_u32 v120, 1, v120
v_cndmask_b32 v117, 0, v112, vcc
v_mfma_f32_16x16x32_bf16 v[156:159], a[156:159], v[76:79], v[156:159]
v_cmp_gt_i32 vcc, 2, v240
v_ashrrev_i32 v120, 31, v120
v_mfma_f32_16x16x32_bf16 v[152:155], a[156:159], v[60:63], 0
v_cndmask_b32 v118, 0, v112, vcc
v_cmp_gt_i32 vcc, 3, v240
v_mfma_f32_16x16x32_bf16 v[152:155], a[152:155], v[56:59], v[152:155]
v_and_b32 v120, 0x3f803f80, v120
v_cndmask_b32 v119, 0, v112, vcc
v_mfma_f32_16x16x32_bf16 v[152:155], a[148:151], v[52:55], v[152:155]
v_mov_b32 v228, 0
v_mov_b32 v229, 0
v_mfma_f32_16x16x32_bf16 v[152:155], a[144:147], v[48:51], v[152:155]
v_mov_b32 v230, 0
v_mov_b32 v231, 0
s_cmp_eq_u32 s84, 0
s_cbranch_scc1 Lta7
s_cmp_eq_u32 s84, 1
s_cbranch_scc1 Lnt8
v_mfma_f32_16x16x32_bf16 v[128:131], a[128:131], v[16:19], 0
v_mov_b32 v236, 0
v_mov_b32 v237, 0
v_mfma_f32_16x16x32_bf16 v[144:147], a[144:147], v[16:19], 0
v_mov_b32 v238, 0
v_mov_b32 v239, 0
s_branch Ljoin9
Lta7:
v_mfma_f32_16x16x32_bf16 v[128:131], a[128:131], v[16:19], v[116:119]
v_mov_b32 v236, 0
v_mov_b32 v237, 0
v_mfma_f32_16x16x32_bf16 v[144:147], a[144:147], v[16:19], v[112:115]
v_mov_b32 v238, 0
v_mov_b32 v239, 0
s_branch Ljoin9
Lnt8:
v_mfma_f32_16x16x32_bf16 v[128:131], a[128:131], v[16:19], 0
v_mov_b32 v236, 0
v_mov_b32 v237, 0
v_mfma_f32_16x16x32_bf16 v[144:147], a[144:147], v[16:19], v[116:119]
v_mov_b32 v238, 0
v_mov_b32 v239, 0
Ljoin9:
v_mfma_f32_16x16x32_bf16 v[128:131], a[132:135], v[20:23], v[128:131]
v_mov_b32 v121, v120
v_mov_b32 v122, v120
v_mfma_f32_16x16x32_bf16 v[128:131], a[136:139], v[24:27], v[128:131]
v_mov_b32 v123, v120
v_mfma_f32_16x16x32_bf16 v[128:131], a[140:143], v[28:31], v[128:131]
v_max3_f32 v240, v136, v137, v126
v_max3_f32 v242, v140, v141, v127
v_mfma_f32_16x16x32_bf16 v[132:135], a[140:143], v[44:47], 0
v_max3_f32 v240, v240, v138, v139
v_max3_f32 v242, v242, v142, v143
v_mfma_f32_16x16x32_bf16 v[132:135], a[136:139], v[40:43], v[132:135]
v_max3_f32 v240, v240, v152, v153
v_max3_f32 v242, v242, v156, v157
v_mfma_f32_16x16x32_bf16 v[132:135], a[132:135], v[36:39], v[132:135]
v_max3_f32 v240, v240, v154, v155
v_max3_f32 v242, v242, v158, v159
v_mfma_f32_16x16x32_bf16 v[132:135], a[128:131], v[32:35], v[132:135]
v_mov_b32 v241, v240
v_mov_b32 v243, v242
v_mfma_f32_16x16x32_bf16 v[148:151], a[144:147], v[32:35], 0
v_permlane16_swap_b32 v240, v241
v_permlane16_swap_b32 v242, v243
v_mfma_f32_16x16x32_bf16 v[148:151], a[148:151], v[36:39], v[148:151]
v_max_f32 v240, v240, v241
v_max_f32 v242, v242, v243
v_mfma_f32_16x16x32_bf16 v[148:151], a[152:155], v[40:43], v[148:151]
v_mov_b32 v241, v240
v_mov_b32 v243, v242
v_mfma_f32_16x16x32_bf16 v[148:151], a[156:159], v[44:47], v[148:151]
v_permlane32_swap_b32 v240, v241
v_permlane32_swap_b32 v242, v243
v_mfma_f32_16x16x32_bf16 v[144:147], a[156:159], v[28:31], v[144:147]
v_max_f32 v240, v240, v241
v_max_f32 v242, v242, v243
v_mfma_f32_16x16x32_bf16 v[144:147], a[152:155], v[24:27], v[144:147]
v_mfma_f32_16x16x32_bf16 v[144:147], a[148:151], v[20:23], v[144:147]
v_sub_f32 v88, 0, v240
v_sub_f32 v89, 0, v240
v_pk_add_f32 v[90:91], v[88:89], 0
v_pk_add_f32 v[104:105], v[116:117], v[88:89]
v_pk_add_f32 v[106:107], v[118:119], v[88:89]
v_pk_add_f32 v[136:137], v[136:137], v[88:89]
v_pk_add_f32 v[138:139], v[138:139], v[88:89]
v_pk_add_f32 v[152:153], v[152:153], v[88:89]
v_pk_add_f32 v[154:155], v[154:155], v[88:89]
v_sub_f32 v92, 0, v242
v_sub_f32 v93, 0, v242
v_pk_add_f32 v[94:95], v[92:93], 0
v_pk_add_f32 v[108:109], v[116:117], v[92:93]
v_pk_add_f32 v[110:111], v[118:119], v[92:93]
v_pk_add_f32 v[140:141], v[140:141], v[92:93]
v_pk_add_f32 v[142:143], v[142:143], v[92:93]
v_pk_add_f32 v[156:157], v[156:157], v[92:93]
v_pk_add_f32 v[158:159], v[158:159], v[92:93]
v_max3_f32 v240, v128, v129, v124
v_max3_f32 v242, v132, v133, v125
v_max3_f32 v240, v240, v130, v131
v_max3_f32 v242, v242, v134, v135
v_max3_f32 v240, v240, v144, v145
v_max3_f32 v242, v242, v148, v149
v_max3_f32 v240, v240, v146, v147
v_max3_f32 v242, v242, v150, v151
v_mov_b32 v241, v240
v_mov_b32 v243, v242
s_nop 0
v_permlane16_swap_b32 v240, v241
v_permlane16_swap_b32 v242, v243
v_max_f32 v240, v240, v241
v_max_f32 v242, v242, v243
v_mov_b32 v241, v240
v_mov_b32 v243, v242
s_nop 0
v_permlane32_swap_b32 v240, v241
v_permlane32_swap_b32 v242, v243
v_max_f32 v240, v240, v241
v_max_f32 v242, v242, v243
v_sub_f32 v80, 0, v240
v_sub_f32 v81, 0, v240
v_pk_add_f32 v[82:83], v[80:81], 0
v_pk_add_f32 v[96:97], v[116:117], v[80:81]
v_pk_add_f32 v[98:99], v[118:119], v[80:81]
v_pk_add_f32 v[128:129], v[128:129], v[80:81]
v_pk_add_f32 v[130:131], v[130:131], v[80:81]
v_pk_add_f32 v[144:145], v[144:145], v[80:81]
v_pk_add_f32 v[146:147], v[146:147], v[80:81]
v_sub_f32 v84, 0, v242
v_sub_f32 v85, 0, v242
v_pk_add_f32 v[86:87], v[84:85], 0
v_pk_add_f32 v[100:101], v[116:117], v[84:85]
v_pk_add_f32 v[102:103], v[118:119], v[84:85]
v_pk_add_f32 v[132:133], v[132:133], v[84:85]
v_pk_add_f32 v[134:135], v[134:135], v[84:85]
v_pk_add_f32 v[148:149], v[148:149], v[84:85]
v_pk_add_f32 v[150:151], v[150:151], v[84:85]
v_add_u32 v2, s82, v1
s_waitcnt vmcnt(13) lgkmcnt(0)
s_barrier
s_cmp_eq_u32 s60, 0
s_cbranch_scc1 LP0x
v_mfma_f32_16x16x32_bf16 v[164:167], a[160:163], v[32:35], v[84:87]
s_xor_b32 s74, s82, 0x10000
v_exp_f32 v128, v128
v_mfma_f32_16x16x32_bf16 v[164:167], a[164:167], v[36:39], v[164:167]
s_add_u32 s74, s74, s64
ds_read_b128 a[128:131], v2 offset:16384
ds_read_b128 a[132:135], v2 offset:17408
v_mfma_f32_16x16x32_bf16 v[164:167], a[168:171], v[40:43], v[164:167]
s_add_u32 s81, s81, 0x8000
v_exp_f32 v129, v129
v_mfma_f32_16x16x32_bf16 v[164:167], a[172:175], v[44:47], v[164:167]
s_add_u32 m0, s74, 16384
v_exp_f32 v130, v130
v_mfma_f32_16x16x32_bf16 v[172:175], a[172:175], v[76:79], v[92:95]
s_add_u32 s72, s81, 16384
v_exp_f32 v131, v131
v_mfma_f32_16x16x32_bf16 v[172:175], a[168:171], v[72:75], v[172:175]
v_exp_f32 v144, v144
v_mfma_f32_16x16x32_bf16 v[172:175], a[164:167], v[68:71], v[172:175]
s_nop 0
ds_read_b128 a[136:139], v2 offset:18432
ds_read_b128 a[140:143], v2 offset:19456
v_mfma_f32_16x16x32_bf16 v[172:175], a[160:163], v[64:67], v[172:175]
s_nop 0
ds_read_b128 a[144:147], v2 offset:20480
ds_read_b128 a[148:151], v2 offset:21504
v_mfma_f32_16x16x32_bf16 v[188:191], a[176:179], v[64:67], v[92:95]
s_nop 0
ds_read_b128 a[152:155], v2 offset:22528
ds_read_b128 a[156:159], v2 offset:23552
v_mfma_f32_16x16x32_bf16 v[188:191], a[180:183], v[68:71], v[188:191]
s_nop 0
ds_read_b128 a[192:195], v2 offset:0
ds_read_b128 a[196:199], v2 offset:1024
v_mfma_f32_16x16x32_bf16 v[188:191], a[184:187], v[72:75], v[188:191]
s_nop 0
ds_read_b128 a[200:203], v2 offset:2048
ds_read_b128 a[204:207], v2 offset:3072
v_mfma_f32_16x16x32_bf16 v[188:191], a[188:191], v[76:79], v[188:191]
s_nop 0
ds_read_b128 a[208:211], v2 offset:4096
ds_read_b128 a[212:215], v2 offset:5120
v_mfma_f32_16x16x32_bf16 v[180:183], a[188:191], v[44:47], v[84:87]
s_nop 0
ds_read_b128 a[216:219], v2 offset:6144
ds_read_b128 a[220:223], v2 offset:7168
v_mfma_f32_16x16x32_bf16 v[180:183], a[184:187], v[40:43], v[180:183]
v_cvt_pk_bf16_f32 v192, v128, v129
v_cvt_pk_bf16_f32 v193, v130, v131
v_mfma_f32_16x16x32_bf16 v[180:183], a[180:183], v[36:39], v[180:183]
buffer_load_dwordx4 v1, s[44:47], s72 offen sc1 lds
v_mfma_f32_16x16x32_bf16 v[180:183], a[176:179], v[32:35], v[180:183]
v_exp_f32 v145, v145
v_mfma_f32_16x16x32_bf16 v[160:163], a[160:163], v[16:19], v[80:83]
v_exp_f32 v146, v146
v_mfma_f32_16x16x32_bf16 v[160:163], a[164:167], v[20:23], v[160:163]
v_exp_f32 v147, v147
v_mfma_f32_16x16x32_bf16 v[160:163], a[168:171], v[24:27], v[160:163]
v_exp_f32 v136, v136
v_mfma_f32_16x16x32_bf16 v[160:163], a[172:175], v[28:31], v[160:163]
v_cvt_pk_bf16_f32 v194, v144, v145
v_cvt_pk_bf16_f32 v195, v146, v147
v_mfma_f32_16x16x32_bf16 v[168:171], a[172:175], v[60:63], v[88:91]
v_exp_f32 v137, v137
v_mfma_f32_16x16x32_bf16 v[168:171], a[168:171], v[56:59], v[168:171]
v_exp_f32 v138, v138
v_mfma_f32_16x16x32_bf16 v[168:171], a[164:167], v[52:55], v[168:171]
v_exp_f32 v139, v139
v_mfma_f32_16x16x32_bf16 v[168:171], a[160:163], v[48:51], v[168:171]
v_exp_f32 v152, v152
v_mfma_f32_16x16x32_bf16 v[184:187], a[176:179], v[48:51], v[88:91]
v_cvt_pk_bf16_f32 v200, v136, v137
v_cvt_pk_bf16_f32 v201, v138, v139
v_mfma_f32_16x16x32_bf16 v[184:187], a[180:183], v[52:55], v[184:187]
buffer_load_dwordx4 v1, s[44:47], s72 offen offset:1024 sc1 lds
v_mfma_f32_16x16x32_bf16 v[184:187], a[184:187], v[56:59], v[184:187]
v_exp_f32 v153, v153
v_mfma_f32_16x16x32_bf16 v[184:187], a[188:191], v[60:63], v[184:187]
v_exp_f32 v154, v154
v_mfma_f32_16x16x32_bf16 v[176:179], a[188:191], v[28:31], v[80:83]
v_exp_f32 v155, v155
v_mfma_f32_16x16x32_bf16 v[176:179], a[184:187], v[24:27], v[176:179]
buffer_load_dwordx4 v1, s[44:47], s72 offen offset:2048 sc1 lds
v_mfma_f32_16x16x32_bf16 v[176:179], a[180:183], v[20:23], v[176:179]
buffer_load_dwordx4 v1, s[44:47], s72 offen offset:3072 sc1 lds
v_mfma_f32_16x16x32_bf16 v[176:179], a[176:179], v[16:19], v[176:179]
s_waitcnt lgkmcnt(4)
v_exp_f32 v132, v132
v_cvt_pk_bf16_f32 v202, v152, v153
v_cvt_pk_bf16_f32 v203, v154, v155
v_exp_f32 v133, v133
v_exp_f32 v134, v134
v_cvt_pk_bf16_f32 v196, v132, v133
v_exp_f32 v135, v135
v_exp_f32 v148, v148
v_cvt_pk_bf16_f32 v197, v134, v135
v_exp_f32 v149, v149
v_exp_f32 v150, v150
v_cvt_pk_bf16_f32 v198, v148, v149
v_exp_f32 v151, v151
v_exp_f32 v140, v140
v_cvt_pk_bf16_f32 v199, v150, v151
v_exp_f32 v141, v141
v_exp_f32 v142, v142
v_cvt_pk_bf16_f32 v204, v140, v141
v_exp_f32 v143, v143
v_exp_f32 v156, v156
v_cvt_pk_bf16_f32 v205, v142, v143
v_exp_f32 v157, v157
v_exp_f32 v158, v158
v_cvt_pk_bf16_f32 v206, v156, v157
v_exp_f32 v159, v159
s_nop 0
v_cvt_pk_bf16_f32 v207, v158, v159
v_mfma_f32_16x16x32_bf16 v[224:227], v[120:123], v[192:195], 0
s_add_u32 s82, s82, 0x8000
ds_read_b128 a[160:163], v2 offset:24576
ds_read_b128 a[164:167], v2 offset:25600
v_mfma_f32_16x16x32_bf16 v[232:235], v[120:123], v[200:203], 0
s_and_b32 s82, s82, 0x1ffff
v_exp_f32 v164, v164
v_mfma_f32_16x16x32_bf16 a[0:3], a[192:195], v[192:195], 0
s_add_u32 m0, s74, 0
v_exp_f32 v165, v165
v_mfma_f32_16x16x32_bf16 a[64:67], a[192:195], v[200:203], 0
s_add_u32 s72, s81, 0
v_exp_f32 v166, v166
v_mfma_f32_16x16x32_bf16 a[68:71], a[196:199], v[200:203], 0
buffer_load_dwordx4 v1, s[44:47], s72 offen sc1 lds
v_mfma_f32_16x16x32_bf16 a[4:7], a[196:199], v[192:195], 0
v_exp_f32 v167, v167
v_mfma_f32_16x16x32_bf16 a[8:11], a[200:203], v[192:195], 0
ds_read_b128 a[168:171], v2 offset:26624
v_cvt_pk_bf16_f32 v212, v164, v165
v_mfma_f32_16x16x32_bf16 a[72:75], a[200:203], v[200:203], 0
v_exp_f32 v180, v180
v_mfma_f32_16x16x32_bf16 a[76:79], a[204:207], v[200:203], 0
v_exp_f32 v181, v181
v_mfma_f32_16x16x32_bf16 a[12:15], a[204:207], v[192:195], 0
s_waitcnt lgkmcnt(3)
ds_read_b128 a[172:175], v2 offset:27648
v_cvt_pk_bf16_f32 v213, v166, v167
v_mfma_f32_16x16x32_bf16 a[16:19], a[208:211], v[192:195], 0
v_exp_f32 v182, v182
v_mfma_f32_16x16x32_bf16 a[80:83], a[208:211], v[200:203], 0
buffer_load_dwordx4 v1, s[44:47], s72 offen offset:1024 sc1 lds
v_mfma_f32_16x16x32_bf16 a[84:87], a[212:215], v[200:203], 0
v_exp_f32 v183, v183
v_mfma_f32_16x16x32_bf16 a[20:23], a[212:215], v[192:195], 0
s_nop 0
ds_read_b128 a[176:179], v2 offset:28672
ds_read_b128 a[180:183], v2 offset:29696
v_mfma_f32_16x16x32_bf16 a[24:27], a[216:219], v[192:195], 0
v_exp_f32 v172, v172
v_mfma_f32_16x16x32_bf16 a[88:91], a[216:219], v[200:203], 0
s_nop 0
ds_read_b128 a[184:187], v2 offset:30720
ds_read_b128 a[188:191], v2 offset:31744
v_mfma_f32_16x16x32_bf16 a[92:95], a[220:223], v[200:203], 0
s_nop 0
ds_read_b128 a[224:227], v2 offset:8192
ds_read_b128 a[228:231], v2 offset:9216
v_mfma_f32_16x16x32_bf16 a[28:31], a[220:223], v[192:195], 0
s_nop 0
ds_read_b128 a[232:235], v2 offset:10240
ds_read_b128 a[236:239], v2 offset:11264
v_mfma_f32_16x16x32_bf16 v[128:131], a[128:131], v[16:19], v[80:83]
s_nop 0
ds_read_b128 a[240:243], v2 offset:12288
ds_read_b128 a[244:247], v2 offset:13312
v_mfma_f32_16x16x32_bf16 v[128:131], a[132:135], v[20:23], v[128:131]
s_nop 0
ds_read_b128 a[248:251], v2 offset:14336
ds_read_b128 a[252:255], v2 offset:15360
v_mfma_f32_16x16x32_bf16 v[128:131], a[136:139], v[24:27], v[128:131]
v_cvt_pk_bf16_f32 v214, v180, v181
v_cvt_pk_bf16_f32 v215, v182, v183
v_mfma_f32_16x16x32_bf16 v[128:131], a[140:143], v[28:31], v[128:131]
v_exp_f32 v173, v173
v_mfma_f32_16x16x32_bf16 v[136:139], a[140:143], v[60:63], v[88:91]
v_exp_f32 v174, v174
v_mfma_f32_16x16x32_bf16 v[136:139], a[136:139], v[56:59], v[136:139]
buffer_load_dwordx4 v1, s[44:47], s72 offen offset:2048 sc1 lds
v_mfma_f32_16x16x32_bf16 v[136:139], a[132:135], v[52:55], v[136:139]
v_exp_f32 v175, v175
v_mfma_f32_16x16x32_bf16 v[136:139], a[128:131], v[48:51], v[136:139]
v_exp_f32 v188, v188
v_mfma_f32_16x16x32_bf16 v[152:155], a[144:147], v[48:51], v[88:91]
v_cvt_pk_bf16_f32 v220, v172, v173
v_cvt_pk_bf16_f32 v221, v174, v175
v_mfma_f32_16x16x32_bf16 v[152:155], a[148:151], v[52:55], v[152:155]
v_exp_f32 v189, v189
v_mfma_f32_16x16x32_bf16 v[152:155], a[152:155], v[56:59], v[152:155]
v_exp_f32 v190, v190
v_mfma_f32_16x16x32_bf16 v[152:155], a[156:159], v[60:63], v[152:155]
buffer_load_dwordx4 v1, s[44:47], s72 offen offset:3072 sc1 lds
v_mfma_f32_16x16x32_bf16 v[144:147], a[156:159], v[28:31], v[80:83]
s_add_u32 s66, s58, 1
v_exp_f32 v191, v191
v_mfma_f32_16x16x32_bf16 v[144:147], a[152:155], v[24:27], v[144:147]
s_and_b32 s66, s66, 3
v_exp_f32 v160, v160
v_mfma_f32_16x16x32_bf16 v[144:147], a[148:151], v[20:23], v[144:147]
s_mul_i32 s66, s66, 4160
v_cvt_pk_bf16_f32 v222, v188, v189
v_cvt_pk_bf16_f32 v223, v190, v191
v_mfma_f32_16x16x32_bf16 v[144:147], a[144:147], v[16:19], v[144:147]
s_add_u32 m0, s66, 131104
v_exp_f32 v161, v161
v_mfma_f32_16x16x32_bf16 v[132:135], a[128:131], v[32:35], v[84:87]
s_add_u32 s72, s93, 0x2
buffer_load_dwordx4 v1, s[36:39], s72 offen lds
v_mfma_f32_16x16x32_bf16 v[132:135], a[132:135], v[36:39], v[132:135]
Lstub1:
s_cbranch_execz Lstub5
v_exp_f32 v162, v162
v_mfma_f32_16x16x32_bf16 v[132:135], a[136:139], v[40:43], v[132:135]
v_exp_f32 v163, v163
v_mfma_f32_16x16x32_bf16 v[132:135], a[140:143], v[44:47], v[132:135]
v_exp_f32 v176, v176
v_mfma_f32_16x16x32_bf16 v[140:143], a[140:143], v[76:79], v[92:95]
v_cvt_pk_bf16_f32 v208, v160, v161
v_cvt_pk_bf16_f32 v209, v162, v163
v_mfma_f32_16x16x32_bf16 v[140:143], a[136:139], v[72:75], v[140:143]
v_exp_f32 v177, v177
v_mfma_f32_16x16x32_bf16 v[140:143], a[132:135], v[68:71], v[140:143]
buffer_load_dwordx4 v1, s[36:39], s72 offen offset:1024 lds
v_mfma_f32_16x16x32_bf16 v[140:143], a[128:131], v[64:67], v[140:143]
v_exp_f32 v178, v178
v_mfma_f32_16x16x32_bf16 v[156:159], a[144:147], v[64:67], v[92:95]
v_exp_f32 v179, v179
v_mfma_f32_16x16x32_bf16 v[156:159], a[148:151], v[68:71], v[156:159]
v_exp_f32 v168, v168
v_mfma_f32_16x16x32_bf16 v[156:159], a[152:155], v[72:75], v[156:159]
v_cvt_pk_bf16_f32 v210, v176, v177
v_cvt_pk_bf16_f32 v211, v178, v179
v_mfma_f32_16x16x32_bf16 v[156:159], a[156:159], v[76:79], v[156:159]
v_exp_f32 v169, v169
v_mfma_f32_16x16x32_bf16 v[148:151], a[156:159], v[44:47], v[84:87]
buffer_load_dwordx4 v1, s[36:39], s72 offen offset:2048 lds
v_mfma_f32_16x16x32_bf16 v[148:151], a[152:155], v[40:43], v[148:151]
buffer_load_dwordx4 v1, s[36:39], s72 offen offset:3072 lds
v_mfma_f32_16x16x32_bf16 v[148:151], a[148:151], v[36:39], v[148:151]
s_waitcnt vmcnt(12) lgkmcnt(4)
v_exp_f32 v170, v170
v_mfma_f32_16x16x32_bf16 v[148:151], a[144:147], v[32:35], v[148:151]
s_barrier
v_exp_f32 v171, v171
v_add_u32 v2, s82, v1
v_cvt_pk_bf16_f32 v216, v168, v169
v_exp_f32 v184, v184
v_cvt_pk_bf16_f32 v217, v170, v171
v_exp_f32 v185, v185
v_exp_f32 v186, v186
v_cvt_pk_bf16_f32 v218, v184, v185
v_exp_f32 v187, v187
s_nop 0
v_cvt_pk_bf16_f32 v219, v186, v187
s_lshl_b32 s75, s59, 4
s_and_b32 s76, s84, 15
s_add_u32 s75, s75, s76
s_lshl_b32 s75, s75, 14
s_cmp_ge_u32 s60, 4
s_cselect_b32 s75, s75, 0x40001000
s_lshl_b32 s83, s60, 1
s_sub_u32 s83, 2, s83
s_cmp_eq_u32 s83, 0
s_cbranch_scc1 LLT1
.p2align 5
s_nop 0
s_nop 0
LloopI:
v_mfma_f32_16x16x32_bf16 v[228:231], v[120:123], v[196:199], v[228:231]
s_xor_b32 s74, s82, 0x10000
v_exp_f32 v128, v128
v_mfma_f32_16x16x32_bf16 v[228:231], v[120:123], v[212:215], v[228:231]
s_add_u32 s74, s74, s64
ds_read_b128 a[128:131], v2 offset:16384
v_add_u32 v15, s75, v3
v_mfma_f32_16x16x32_bf16 v[236:239], v[120:123], v[204:207], v[236:239]
s_add_u32 s81, s81, 0x8000
v_exp_f32 v129, v129
v_mfma_f32_16x16x32_bf16 v[236:239], v[120:123], v[220:223], v[236:239]
s_add_u32 m0, s74, 16384
v_exp_f32 v130, v130
v_mfma_f32_16x16x32_bf16 a[32:35], a[192:195], v[196:199], a[32:35]
s_add_u32 s72, s81, 16384
ds_read_b128 a[132:135], v2 offset:17408
v_cvt_pk_bf16_f32 v192, v128, v129
v_mfma_f32_16x16x32_bf16 a[32:35], a[224:227], v[212:215], a[32:35]
v_exp_f32 v131, v131
v_mfma_f32_16x16x32_bf16 a[96:99], a[224:227], v[220:223], a[96:99]
v_exp_f32 v144, v144
v_mfma_f32_16x16x32_bf16 a[96:99], a[192:195], v[204:207], a[96:99]
ds_read_b128 a[136:139], v2 offset:18432
v_cvt_pk_bf16_f32 v193, v130, v131
v_mfma_f32_16x16x32_bf16 a[100:103], a[196:199], v[204:207], a[100:103]
buffer_load_dwordx4 v1, s[44:47], s72 offen sc1 lds
v_mfma_f32_16x16x32_bf16 a[100:103], a[228:231], v[220:223], a[100:103]
v_exp_f32 v145, v145
v_mfma_f32_16x16x32_bf16 a[36:39], a[228:231], v[212:215], a[36:39]
v_exp_f32 v146, v146
v_mfma_f32_16x16x32_bf16 a[36:39], a[196:199], v[196:199], a[36:39]
ds_read_b128 a[140:143], v2 offset:19456
v_cvt_pk_bf16_f32 v194, v144, v145
v_mfma_f32_16x16x32_bf16 a[40:43], a[200:203], v[196:199], a[40:43]
v_exp_f32 v147, v147
v_mfma_f32_16x16x32_bf16 a[40:43], a[232:235], v[212:215], a[40:43]
v_exp_f32 v136, v136
v_mfma_f32_16x16x32_bf16 a[104:107], a[232:235], v[220:223], a[104:107]
ds_read_b128 a[144:147], v2 offset:20480
v_cvt_pk_bf16_f32 v195, v146, v147
v_mfma_f32_16x16x32_bf16 a[104:107], a[200:203], v[204:207], a[104:107]
v_exp_f32 v137, v137
v_mfma_f32_16x16x32_bf16 a[108:111], a[204:207], v[204:207], a[108:111]
v_exp_f32 v138, v138
v_mfma_f32_16x16x32_bf16 a[108:111], a[236:239], v[220:223], a[108:111]
ds_read_b128 a[148:151], v2 offset:21504
v_cvt_pk_bf16_f32 v200, v136, v137
v_mfma_f32_16x16x32_bf16 a[44:47], a[236:239], v[212:215], a[44:47]
v_exp_f32 v139, v139
v_mfma_f32_16x16x32_bf16 a[44:47], a[204:207], v[196:199], a[44:47]
v_exp_f32 v152, v152
v_mfma_f32_16x16x32_bf16 a[48:51], a[208:211], v[196:199], a[48:51]
s_waitcnt lgkmcnt(6)
ds_read_b128 a[152:155], v2 offset:22528
v_cvt_pk_bf16_f32 v201, v138, v139
v_mfma_f32_16x16x32_bf16 a[48:51], a[240:243], v[212:215], a[48:51]
buffer_load_dwordx4 v1, s[44:47], s72 offen offset:1024 sc1 lds
v_mfma_f32_16x16x32_bf16 a[112:115], a[240:243], v[220:223], a[112:115]
v_exp_f32 v153, v153
v_mfma_f32_16x16x32_bf16 a[112:115], a[208:211], v[204:207], a[112:115]
v_exp_f32 v154, v154
v_mfma_f32_16x16x32_bf16 a[116:119], a[212:215], v[204:207], a[116:119]
ds_read_b128 a[156:159], v2 offset:23552
v_cvt_pk_bf16_f32 v202, v152, v153
v_mfma_f32_16x16x32_bf16 a[116:119], a[244:247], v[220:223], a[116:119]
v_exp_f32 v155, v155
v_mfma_f32_16x16x32_bf16 a[52:55], a[244:247], v[212:215], a[52:55]
v_exp_f32 v132, v132
v_mfma_f32_16x16x32_bf16 a[52:55], a[212:215], v[196:199], a[52:55]
ds_read_b128 a[192:195], v2 offset:0
v_cvt_pk_bf16_f32 v203, v154, v155
v_mfma_f32_16x16x32_bf16 a[56:59], a[216:219], v[196:199], a[56:59]
v_exp_f32 v133, v133
v_mfma_f32_16x16x32_bf16 a[56:59], a[248:251], v[212:215], a[56:59]
v_exp_f32 v134, v134
v_mfma_f32_16x16x32_bf16 a[120:123], a[248:251], v[220:223], a[120:123]
ds_read_b128 a[196:199], v2 offset:1024
v_mfma_f32_16x16x32_bf16 a[120:123], a[216:219], v[204:207], a[120:123]
v_exp_f32 v135, v135
v_mfma_f32_16x16x32_bf16 a[124:127], a[220:223], v[204:207], a[124:127]
v_exp_f32 v148, v148
v_mfma_f32_16x16x32_bf16 a[124:127], a[252:255], v[220:223], a[124:127]
ds_read_b128 a[200:203], v2 offset:2048
v_mfma_f32_16x16x32_bf16 a[60:63], a[252:255], v[212:215], a[60:63]
buffer_load_dwordx4 v1, s[44:47], s72 offen offset:2048 sc1 lds
v_mfma_f32_16x16x32_bf16 a[60:63], a[220:223], v[196:199], a[60:63]
ds_read_b128 a[204:207], v2 offset:3072
v_cvt_pk_bf16_f32 v196, v132, v133
v_mfma_f32_16x16x32_bf16 v[164:167], a[160:163], v[32:35], v[84:87]
v_exp_f32 v149, v149
v_mfma_f32_16x16x32_bf16 v[164:167], a[164:167], v[36:39], v[164:167]
v_exp_f32 v150, v150
v_mfma_f32_16x16x32_bf16 v[164:167], a[168:171], v[40:43], v[164:167]
ds_read_b128 a[208:211], v2 offset:4096
v_cvt_pk_bf16_f32 v197, v134, v135
v_mfma_f32_16x16x32_bf16 v[164:167], a[172:175], v[44:47], v[164:167]
v_exp_f32 v151, v151
v_mfma_f32_16x16x32_bf16 v[172:175], a[172:175], v[76:79], v[92:95]
v_exp_f32 v140, v140
v_mfma_f32_16x16x32_bf16 v[172:175], a[168:171], v[72:75], v[172:175]
ds_read_b128 a[212:215], v2 offset:5120
v_cvt_pk_bf16_f32 v198, v148, v149
v_mfma_f32_16x16x32_bf16 v[172:175], a[164:167], v[68:71], v[172:175]
v_exp_f32 v141, v141
v_mfma_f32_16x16x32_bf16 v[172:175], a[160:163], v[64:67], v[172:175]
v_exp_f32 v142, v142
v_mfma_f32_16x16x32_bf16 v[188:191], a[176:179], v[64:67], v[92:95]
ds_read_b128 a[216:219], v2 offset:6144
v_cvt_pk_bf16_f32 v199, v150, v151
v_mfma_f32_16x16x32_bf16 v[188:191], a[180:183], v[68:71], v[188:191]
v_exp_f32 v143, v143
v_mfma_f32_16x16x32_bf16 v[188:191], a[184:187], v[72:75], v[188:191]
v_exp_f32 v156, v156
v_mfma_f32_16x16x32_bf16 v[188:191], a[188:191], v[76:79], v[188:191]
ds_read_b128 a[220:223], v2 offset:7168
v_cvt_pk_bf16_f32 v204, v140, v141
v_mfma_f32_16x16x32_bf16 v[180:183], a[188:191], v[44:47], v[84:87]
buffer_load_dwordx4 v1, s[44:47], s72 offen offset:3072 sc1 lds
v_mfma_f32_16x16x32_bf16 v[180:183], a[184:187], v[40:43], v[180:183]
v_exp_f32 v157, v157
v_mfma_f32_16x16x32_bf16 v[180:183], a[180:183], v[36:39], v[180:183]
v_exp_f32 v158, v158
v_mfma_f32_16x16x32_bf16 v[180:183], a[176:179], v[32:35], v[180:183]
v_cvt_pk_bf16_f32 v205, v142, v143
v_cvt_pk_bf16_f32 v206, v156, v157
v_mfma_f32_16x16x32_bf16 v[160:163], a[160:163], v[16:19], v[80:83]
v_exp_f32 v159, v159
v_mfma_f32_16x16x32_bf16 v[160:163], a[164:167], v[20:23], v[160:163]
v_cvt_pk_bf16_f32 v207, v158, v159
v_mfma_f32_16x16x32_bf16 v[160:163], a[168:171], v[24:27], v[160:163]
v_mfma_f32_16x16x32_bf16 v[160:163], a[172:175], v[28:31], v[160:163]
v_mfma_f32_16x16x32_bf16 v[168:171], a[172:175], v[60:63], v[88:91]
v_mfma_f32_16x16x32_bf16 v[168:171], a[168:171], v[56:59], v[168:171]
v_mfma_f32_16x16x32_bf16 v[168:171], a[164:167], v[52:55], v[168:171]
v_mfma_f32_16x16x32_bf16 v[168:171], a[160:163], v[48:51], v[168:171]
v_mfma_f32_16x16x32_bf16 v[184:187], a[176:179], v[48:51], v[88:91]
v_mfma_f32_16x16x32_bf16 v[184:187], a[180:183], v[52:55], v[184:187]
v_mfma_f32_16x16x32_bf16 v[184:187], a[184:187], v[56:59], v[184:187]
v_mfma_f32_16x16x32_bf16 v[184:187], a[188:191], v[60:63], v[184:187]
v_mfma_f32_16x16x32_bf16 v[176:179], a[188:191], v[28:31], v[80:83]
v_mfma_f32_16x16x32_bf16 v[176:179], a[184:187], v[24:27], v[176:179]
v_mfma_f32_16x16x32_bf16 v[176:179], a[180:183], v[20:23], v[176:179]
v_mfma_f32_16x16x32_bf16 v[176:179], a[176:179], v[16:19], v[176:179]
s_waitcnt lgkmcnt(4)
v_mfma_f32_16x16x32_bf16 v[224:227], v[120:123], v[208:211], v[224:227]
s_add_u32 s82, s82, 0x8000
ds_read_b128 a[160:163], v2 offset:24576
v_mfma_f32_16x16x32_bf16 v[224:227], v[120:123], v[192:195], v[224:227]
s_and_b32 s82, s82, 0x1ffff
v_exp_f32 v164, v164
v_mfma_f32_16x16x32_bf16 v[232:235], v[120:123], v[216:219], v[232:235]
s_add_u32 m0, s74, 0
v_exp_f32 v165, v165
v_mfma_f32_16x16x32_bf16 v[232:235], v[120:123], v[200:203], v[232:235]
s_add_u32 s72, s81, 0
ds_read_b128 a[164:167], v2 offset:25600
v_cvt_pk_bf16_f32 v212, v164, v165
v_mfma_f32_16x16x32_bf16 a[0:3], a[224:227], v[208:211], a[0:3]
v_exp_f32 v166, v166
v_mfma_f32_16x16x32_bf16 a[0:3], a[192:195], v[192:195], a[0:3]
v_exp_f32 v167, v167
v_mfma_f32_16x16x32_bf16 a[64:67], a[192:195], v[200:203], a[64:67]
buffer_load_dwordx4 v1, s[44:47], s72 offen sc1 lds
v_mfma_f32_16x16x32_bf16 a[64:67], a[224:227], v[216:219], a[64:67]
ds_read_b128 a[168:171], v2 offset:26624
v_cvt_pk_bf16_f32 v213, v166, v167
v_mfma_f32_16x16x32_bf16 a[68:71], a[228:231], v[216:219], a[68:71]
v_exp_f32 v180, v180
v_mfma_f32_16x16x32_bf16 a[68:71], a[196:199], v[200:203], a[68:71]
v_exp_f32 v181, v181
v_mfma_f32_16x16x32_bf16 a[4:7], a[196:199], v[192:195], a[4:7]
ds_read_b128 a[172:175], v2 offset:27648
v_cvt_pk_bf16_f32 v214, v180, v181
v_mfma_f32_16x16x32_bf16 a[4:7], a[228:231], v[208:211], a[4:7]
v_exp_f32 v182, v182
v_mfma_f32_16x16x32_bf16 a[8:11], a[232:235], v[208:211], a[8:11]
v_exp_f32 v183, v183
v_mfma_f32_16x16x32_bf16 a[8:11], a[200:203], v[192:195], a[8:11]
ds_read_b128 a[176:179], v2 offset:28672
v_cvt_pk_bf16_f32 v215, v182, v183
v_mfma_f32_16x16x32_bf16 a[72:75], a[200:203], v[200:203], a[72:75]
v_exp_f32 v172, v172
v_mfma_f32_16x16x32_bf16 a[72:75], a[232:235], v[216:219], a[72:75]
v_exp_f32 v173, v173
v_mfma_f32_16x16x32_bf16 a[76:79], a[236:239], v[216:219], a[76:79]
ds_read_b128 a[180:183], v2 offset:29696
v_cvt_pk_bf16_f32 v220, v172, v173
v_mfma_f32_16x16x32_bf16 a[76:79], a[204:207], v[200:203], a[76:79]
buffer_load_dwordx4 v1, s[44:47], s72 offen offset:1024 sc1 lds
v_mfma_f32_16x16x32_bf16 a[12:15], a[204:207], v[192:195], a[12:15]
v_exp_f32 v174, v174
v_mfma_f32_16x16x32_bf16 a[12:15], a[236:239], v[208:211], a[12:15]
v_exp_f32 v175, v175
v_mfma_f32_16x16x32_bf16 a[16:19], a[240:243], v[208:211], a[16:19]
s_waitcnt lgkmcnt(6)
ds_read_b128 a[184:187], v2 offset:30720
v_cvt_pk_bf16_f32 v221, v174, v175
v_mfma_f32_16x16x32_bf16 a[16:19], a[208:211], v[192:195], a[16:19]
v_exp_f32 v188, v188
v_mfma_f32_16x16x32_bf16 a[80:83], a[208:211], v[200:203], a[80:83]
v_exp_f32 v189, v189
v_mfma_f32_16x16x32_bf16 a[80:83], a[240:243], v[216:219], a[80:83]
ds_read_b128 a[188:191], v2 offset:31744
v_cvt_pk_bf16_f32 v222, v188, v189
v_mfma_f32_16x16x32_bf16 a[84:87], a[244:247], v[216:219], a[84:87]
v_exp_f32 v190, v190
v_mfma_f32_16x16x32_bf16 a[84:87], a[212:215], v[200:203], a[84:87]
v_exp_f32 v191, v191
v_mfma_f32_16x16x32_bf16 a[20:23], a[212:215], v[192:195], a[20:23]
ds_read_b128 a[224:227], v2 offset:8192
v_cvt_pk_bf16_f32 v223, v190, v191
v_mfma_f32_16x16x32_bf16 a[20:23], a[244:247], v[208:211], a[20:23]
v_exp_f32 v160, v160
v_mfma_f32_16x16x32_bf16 a[24:27], a[248:251], v[208:211], a[24:27]
buffer_load_dwordx4 v1, s[44:47], s72 offen offset:2048 sc1 lds
v_mfma_f32_16x16x32_bf16 a[24:27], a[216:219], v[192:195], a[24:27]
v_exp_f32 v161, v161
v_mfma_f32_16x16x32_bf16 a[88:91], a[216:219], v[200:203], a[88:91]
ds_read_b128 a[228:231], v2 offset:9216
v_mfma_f32_16x16x32_bf16 a[88:91], a[248:251], v[216:219], a[88:91]
v_exp_f32 v162, v162
v_mfma_f32_16x16x32_bf16 a[92:95], a[252:255], v[216:219], a[92:95]
v_exp_f32 v163, v163
v_mfma_f32_16x16x32_bf16 a[92:95], a[220:223], v[200:203], a[92:95]
ds_read_b128 a[232:235], v2 offset:10240
v_mfma_f32_16x16x32_bf16 a[28:31], a[220:223], v[192:195], a[28:31]
v_exp_f32 v176, v176
v_mfma_f32_16x16x32_bf16 a[28:31], a[252:255], v[208:211], a[28:31]
ds_read_b128 a[236:239], v2 offset:11264
v_cvt_pk_bf16_f32 v208, v160, v161
v_mfma_f32_16x16x32_bf16 v[128:131], a[128:131], v[16:19], v[80:83]
v_exp_f32 v177, v177
v_mfma_f32_16x16x32_bf16 v[128:131], a[132:135], v[20:23], v[128:131]
v_exp_f32 v178, v178
v_mfma_f32_16x16x32_bf16 v[128:131], a[136:139], v[24:27], v[128:131]
ds_read_b128 a[240:243], v2 offset:12288
v_cvt_pk_bf16_f32 v209, v162, v163
v_mfma_f32_16x16x32_bf16 v[128:131], a[140:143], v[28:31], v[128:131]
buffer_load_dwordx4 v1, s[44:47], s72 offen offset:3072 sc1 lds
v_mfma_f32_16x16x32_bf16 v[136:139], a[140:143], v[60:63], v[88:91]
s_add_u32 s75, s75, 0x1000
v_exp_f32 v179, v179
v_mfma_f32_16x16x32_bf16 v[136:139], a[136:139], v[56:59], v[136:139]
s_and_b32 s76, s75, 0x3000
v_exp_f32 v168, v168
v_mfma_f32_16x16x32_bf16 v[136:139], a[132:135], v[52:55], v[136:139]
s_cselect_b32 s75, s75, 0x40001000
ds_read_b128 a[244:247], v2 offset:13312
v_cvt_pk_bf16_f32 v210, v176, v177
v_mfma_f32_16x16x32_bf16 v[136:139], a[128:131], v[48:51], v[136:139]
v_exp_f32 v169, v169
v_mfma_f32_16x16x32_bf16 v[152:155], a[144:147], v[48:51], v[88:91]
v_exp_f32 v170, v170
v_mfma_f32_16x16x32_bf16 v[152:155], a[148:151], v[52:55], v[152:155]
ds_read_b128 a[248:251], v2 offset:14336
v_cvt_pk_bf16_f32 v211, v178, v179
v_mfma_f32_16x16x32_bf16 v[152:155], a[152:155], v[56:59], v[152:155]
v_exp_f32 v171, v171
v_mfma_f32_16x16x32_bf16 v[152:155], a[156:159], v[60:63], v[152:155]
v_exp_f32 v184, v184
v_mfma_f32_16x16x32_bf16 v[144:147], a[156:159], v[28:31], v[80:83]
ds_read_b128 a[252:255], v2 offset:15360
v_cvt_pk_bf16_f32 v216, v168, v169
v_mfma_f32_16x16x32_bf16 v[144:147], a[152:155], v[24:27], v[144:147]
buffer_load_dword v4, v15, s[24:27], 0 offen
v_mfma_f32_16x16x32_bf16 v[144:147], a[148:151], v[20:23], v[144:147]
v_exp_f32 v185, v185
v_mfma_f32_16x16x32_bf16 v[144:147], a[144:147], v[16:19], v[144:147]
v_exp_f32 v186, v186
v_mfma_f32_16x16x32_bf16 v[132:135], a[128:131], v[32:35], v[84:87]
v_cvt_pk_bf16_f32 v217, v170, v171
v_cvt_pk_bf16_f32 v218, v184, v185
v_mfma_f32_16x16x32_bf16 v[132:135], a[132:135], v[36:39], v[132:135]
v_exp_f32 v187, v187
v_mfma_f32_16x16x32_bf16 v[132:135], a[136:139], v[40:43], v[132:135]
v_cvt_pk_bf16_f32 v219, v186, v187
v_add_u32 v2, s82, v1
v_mfma_f32_16x16x32_bf16 v[132:135], a[140:143], v[44:47], v[132:135]
v_mfma_f32_16x16x32_bf16 v[140:143], a[140:143], v[76:79], v[92:95]
v_mfma_f32_16x16x32_bf16 v[140:143], a[136:139], v[72:75], v[140:143]
v_mfma_f32_16x16x32_bf16 v[140:143], a[132:135], v[68:71], v[140:143]
v_mfma_f32_16x16x32_bf16 v[140:143], a[128:131], v[64:67], v[140:143]
v_mfma_f32_16x16x32_bf16 v[156:159], a[144:147], v[64:67], v[92:95]
v_mfma_f32_16x16x32_bf16 v[156:159], a[148:151], v[68:71], v[156:159]
v_mfma_f32_16x16x32_bf16 v[156:159], a[152:155], v[72:75], v[156:159]
v_mfma_f32_16x16x32_bf16 v[156:159], a[156:159], v[76:79], v[156:159]
v_mfma_f32_16x16x32_bf16 v[148:151], a[156:159], v[44:47], v[84:87]
s_waitcnt vmcnt(9) lgkmcnt(4)
v_mfma_f32_16x16x32_bf16 v[148:151], a[152:155], v[40:43], v[148:151]
s_barrier
v_mfma_f32_16x16x32_bf16 v[148:151], a[148:151], v[36:39], v[148:151]
s_add_u32 s83, s83, 1
v_mfma_f32_16x16x32_bf16 v[148:151], a[144:147], v[32:35], v[148:151]
s_cbranch_scc0 LloopI
LLT1:
Lstub2:
s_cbranch_execz Lstub6
v_mfma_f32_16x16x32_bf16 v[228:231], v[120:123], v[196:199], v[228:231]
s_xor_b32 s74, s82, 0x10000
v_exp_f32 v128, v128
v_mfma_f32_16x16x32_bf16 v[228:231], v[120:123], v[212:215], v[228:231]
s_add_u32 s74, s74, s64
ds_read_b128 a[128:131], v2 offset:16384
v_mfma_f32_16x16x32_bf16 v[236:239], v[120:123], v[204:207], v[236:239]
s_add_u32 s81, s81, 0x8000
v_exp_f32 v129, v129
v_mfma_f32_16x16x32_bf16 v[236:239], v[120:123], v[220:223], v[236:239]
s_add_u32 m0, s74, 16384
v_exp_f32 v130, v130
v_mfma_f32_16x16x32_bf16 a[32:35], a[192:195], v[196:199], a[32:35]
s_add_u32 s72, s81, 16384
ds_read_b128 a[132:135], v2 offset:17408
v_cvt_pk_bf16_f32 v192, v128, v129
v_mfma_f32_16x16x32_bf16 a[32:35], a[224:227], v[212:215], a[32:35]
v_exp_f32 v131, v131
v_mfma_f32_16x16x32_bf16 a[96:99], a[224:227], v[220:223], a[96:99]
v_exp_f32 v144, v144
v_mfma_f32_16x16x32_bf16 a[96:99], a[192:195], v[204:207], a[96:99]
ds_read_b128 a[136:139], v2 offset:18432
v_cvt_pk_bf16_f32 v193, v130, v131
v_mfma_f32_16x16x32_bf16 a[100:103], a[196:199], v[204:207], a[100:103]
buffer_load_dwordx4 v1, s[44:47], s72 offen sc1 lds
v_mfma_f32_16x16x32_bf16 a[100:103], a[228:231], v[220:223], a[100:103]
v_exp_f32 v145, v145
v_mfma_f32_16x16x32_bf16 a[36:39], a[228:231], v[212:215], a[36:39]
v_exp_f32 v146, v146
v_mfma_f32_16x16x32_bf16 a[36:39], a[196:199], v[196:199], a[36:39]
ds_read_b128 a[140:143], v2 offset:19456
v_cvt_pk_bf16_f32 v194, v144, v145
v_mfma_f32_16x16x32_bf16 a[40:43], a[200:203], v[196:199], a[40:43]
v_exp_f32 v147, v147
v_mfma_f32_16x16x32_bf16 a[40:43], a[232:235], v[212:215], a[40:43]
v_exp_f32 v136, v136
v_mfma_f32_16x16x32_bf16 a[104:107], a[232:235], v[220:223], a[104:107]
ds_read_b128 a[144:147], v2 offset:20480
v_cvt_pk_bf16_f32 v195, v146, v147
v_mfma_f32_16x16x32_bf16 a[104:107], a[200:203], v[204:207], a[104:107]
v_exp_f32 v137, v137
v_mfma_f32_16x16x32_bf16 a[108:111], a[204:207], v[204:207], a[108:111]
v_exp_f32 v138, v138
v_mfma_f32_16x16x32_bf16 a[108:111], a[236:239], v[220:223], a[108:111]
ds_read_b128 a[148:151], v2 offset:21504
v_cvt_pk_bf16_f32 v200, v136, v137
v_mfma_f32_16x16x32_bf16 a[44:47], a[236:239], v[212:215], a[44:47]
v_exp_f32 v139, v139
v_mfma_f32_16x16x32_bf16 a[44:47], a[204:207], v[196:199], a[44:47]
v_exp_f32 v152, v152
v_mfma_f32_16x16x32_bf16 a[48:51], a[208:211], v[196:199], a[48:51]
s_waitcnt lgkmcnt(6)
ds_read_b128 a[152:155], v2 offset:22528
v_cvt_pk_bf16_f32 v201, v138, v139
v_mfma_f32_16x16x32_bf16 a[48:51], a[240:243], v[212:215], a[48:51]
buffer_load_dwordx4 v1, s[44:47], s72 offen offset:1024 sc1 lds
v_mfma_f32_16x16x32_bf16 a[112:115], a[240:243], v[220:223], a[112:115]
v_exp_f32 v153, v153
v_mfma_f32_16x16x32_bf16 a[112:115], a[208:211], v[204:207], a[112:115]
v_exp_f32 v154, v154
v_mfma_f32_16x16x32_bf16 a[116:119], a[212:215], v[204:207], a[116:119]
ds_read_b128 a[156:159], v2 offset:23552
v_cvt_pk_bf16_f32 v202, v152, v153
v_mfma_f32_16x16x32_bf16 a[116:119], a[244:247], v[220:223], a[116:119]
v_exp_f32 v155, v155
v_mfma_f32_16x16x32_bf16 a[52:55], a[244:247], v[212:215], a[52:55]
v_exp_f32 v132, v132
v_mfma_f32_16x16x32_bf16 a[52:55], a[212:215], v[196:199], a[52:55]
ds_read_b128 a[192:195], v2 offset:0
v_cvt_pk_bf16_f32 v203, v154, v155
v_mfma_f32_16x16x32_bf16 a[56:59], a[216:219], v[196:199], a[56:59]
v_exp_f32 v133, v133
v_mfma_f32_16x16x32_bf16 a[56:59], a[248:251], v[212:215], a[56:59]
v_exp_f32 v134, v134
v_mfma_f32_16x16x32_bf16 a[120:123], a[248:251], v[220:223], a[120:123]
ds_read_b128 a[196:199], v2 offset:1024
v_mfma_f32_16x16x32_bf16 a[120:123], a[216:219], v[204:207], a[120:123]
v_exp_f32 v135, v135
v_mfma_f32_16x16x32_bf16 a[124:127], a[220:223], v[204:207], a[124:127]
v_exp_f32 v148, v148
v_mfma_f32_16x16x32_bf16 a[124:127], a[252:255], v[220:223], a[124:127]
ds_read_b128 a[200:203], v2 offset:2048
v_mfma_f32_16x16x32_bf16 a[60:63], a[252:255], v[212:215], a[60:63]
buffer_load_dwordx4 v1, s[44:47], s72 offen offset:2048 sc1 lds
v_mfma_f32_16x16x32_bf16 a[60:63], a[220:223], v[196:199], a[60:63]
ds_read_b128 a[204:207], v2 offset:3072
v_cvt_pk_bf16_f32 v196, v132, v133
v_mfma_f32_16x16x32_bf16 v[164:167], a[160:163], v[32:35], v[84:87]
v_exp_f32 v149, v149
v_mfma_f32_16x16x32_bf16 v[164:167], a[164:167], v[36:39], v[164:167]
v_exp_f32 v150, v150
v_mfma_f32_16x16x32_bf16 v[164:167], a[168:171], v[40:43], v[164:167]
ds_read_b128 a[208:211], v2 offset:4096
v_cvt_pk_bf16_f32 v197, v134, v135
v_mfma_f32_16x16x32_bf16 v[164:167], a[172:175], v[44:47], v[164:167]
v_exp_f32 v151, v151
v_mfma_f32_16x16x32_bf16 v[172:175], a[172:175], v[76:79], v[92:95]
v_exp_f32 v140, v140
v_mfma_f32_16x16x32_bf16 v[172:175], a[168:171], v[72:75], v[172:175]
ds_read_b128 a[212:215], v2 offset:5120
v_cvt_pk_bf16_f32 v198, v148, v149
v_mfma_f32_16x16x32_bf16 v[172:175], a[164:167], v[68:71], v[172:175]
v_exp_f32 v141, v141
v_mfma_f32_16x16x32_bf16 v[172:175], a[160:163], v[64:67], v[172:175]
v_exp_f32 v142, v142
v_mfma_f32_16x16x32_bf16 v[188:191], a[176:179], v[64:67], v[92:95]
ds_read_b128 a[216:219], v2 offset:6144
v_cvt_pk_bf16_f32 v199, v150, v151
v_mfma_f32_16x16x32_bf16 v[188:191], a[180:183], v[68:71], v[188:191]
v_exp_f32 v143, v143
v_mfma_f32_16x16x32_bf16 v[188:191], a[184:187], v[72:75], v[188:191]
v_exp_f32 v156, v156
v_mfma_f32_16x16x32_bf16 v[188:191], a[188:191], v[76:79], v[188:191]
ds_read_b128 a[220:223], v2 offset:7168
v_cvt_pk_bf16_f32 v204, v140, v141
v_mfma_f32_16x16x32_bf16 v[180:183], a[188:191], v[44:47], v[84:87]
buffer_load_dwordx4 v1, s[44:47], s72 offen offset:3072 sc1 lds
v_mfma_f32_16x16x32_bf16 v[180:183], a[184:187], v[40:43], v[180:183]
v_exp_f32 v157, v157
v_mfma_f32_16x16x32_bf16 v[180:183], a[180:183], v[36:39], v[180:183]
v_exp_f32 v158, v158
v_mfma_f32_16x16x32_bf16 v[180:183], a[176:179], v[32:35], v[180:183]
v_cvt_pk_bf16_f32 v205, v142, v143
v_cvt_pk_bf16_f32 v206, v156, v157
v_mfma_f32_16x16x32_bf16 v[160:163], a[160:163], v[16:19], v[80:83]
v_exp_f32 v159, v159
v_mfma_f32_16x16x32_bf16 v[160:163], a[164:167], v[20:23], v[160:163]
v_cvt_pk_bf16_f32 v207, v158, v159
v_mfma_f32_16x16x32_bf16 v[160:163], a[168:171], v[24:27], v[160:163]
v_mfma_f32_16x16x32_bf16 v[160:163], a[172:175], v[28:31], v[160:163]
v_mfma_f32_16x16x32_bf16 v[168:171], a[172:175], v[60:63], v[88:91]
v_mfma_f32_16x16x32_bf16 v[168:171], a[168:171], v[56:59], v[168:171]
v_mfma_f32_16x16x32_bf16 v[168:171], a[164:167], v[52:55], v[168:171]
v_mfma_f32_16x16x32_bf16 v[168:171], a[160:163], v[48:51], v[168:171]
v_mfma_f32_16x16x32_bf16 v[184:187], a[176:179], v[48:51], v[88:91]
v_mfma_f32_16x16x32_bf16 v[184:187], a[180:183], v[52:55], v[184:187]
v_mfma_f32_16x16x32_bf16 v[184:187], a[184:187], v[56:59], v[184:187]
v_mfma_f32_16x16x32_bf16 v[184:187], a[188:191], v[60:63], v[184:187]
v_mfma_f32_16x16x32_bf16 v[176:179], a[188:191], v[28:31], v[80:83]
v_mfma_f32_16x16x32_bf16 v[176:179], a[184:187], v[24:27], v[176:179]
v_mfma_f32_16x16x32_bf16 v[176:179], a[180:183], v[20:23], v[176:179]
v_mfma_f32_16x16x32_bf16 v[176:179], a[176:179], v[16:19], v[176:179]
s_waitcnt lgkmcnt(4)
v_mfma_f32_16x16x32_bf16 v[224:227], v[120:123], v[208:211], v[224:227]
s_add_u32 s82, s82, 0x8000
ds_read_b128 a[160:163], v2 offset:24576
v_mfma_f32_16x16x32_bf16 v[224:227], v[120:123], v[192:195], v[224:227]
s_and_b32 s82, s82, 0x1ffff
v_exp_f32 v164, v164
v_mfma_f32_16x16x32_bf16 v[232:235], v[120:123], v[216:219], v[232:235]
s_add_u32 m0, s74, 0
v_exp_f32 v165, v165
v_mfma_f32_16x16x32_bf16 v[232:235], v[120:123], v[200:203], v[232:235]
s_add_u32 s72, s81, 0
ds_read_b128 a[164:167], v2 offset:25600
v_cvt_pk_bf16_f32 v212, v164, v165
v_mfma_f32_16x16x32_bf16 a[0:3], a[224:227], v[208:211], a[0:3]
v_exp_f32 v166, v166
v_mfma_f32_16x16x32_bf16 a[0:3], a[192:195], v[192:195], a[0:3]
v_exp_f32 v167, v167
v_mfma_f32_16x16x32_bf16 a[64:67], a[192:195], v[200:203], a[64:67]
ds_read_b128 a[168:171], v2 offset:26624
v_cvt_pk_bf16_f32 v213, v166, v167
v_mfma_f32_16x16x32_bf16 a[64:67], a[224:227], v[216:219], a[64:67]
v_exp_f32 v180, v180
v_mfma_f32_16x16x32_bf16 a[68:71], a[228:231], v[216:219], a[68:71]
buffer_load_dwordx4 v1, s[44:47], s72 offen sc1 lds
v_mfma_f32_16x16x32_bf16 a[68:71], a[196:199], v[200:203], a[68:71]
v_exp_f32 v181, v181
v_mfma_f32_16x16x32_bf16 a[4:7], a[196:199], v[192:195], a[4:7]
ds_read_b128 a[172:175], v2 offset:27648
v_cvt_pk_bf16_f32 v214, v180, v181
v_mfma_f32_16x16x32_bf16 a[4:7], a[228:231], v[208:211], a[4:7]
v_exp_f32 v182, v182
v_mfma_f32_16x16x32_bf16 a[8:11], a[232:235], v[208:211], a[8:11]
v_exp_f32 v183, v183
v_mfma_f32_16x16x32_bf16 a[8:11], a[200:203], v[192:195], a[8:11]
ds_read_b128 a[176:179], v2 offset:28672
v_cvt_pk_bf16_f32 v215, v182, v183
v_mfma_f32_16x16x32_bf16 a[72:75], a[200:203], v[200:203], a[72:75]
v_exp_f32 v172, v172
v_mfma_f32_16x16x32_bf16 a[72:75], a[232:235], v[216:219], a[72:75]
v_exp_f32 v173, v173
v_mfma_f32_16x16x32_bf16 a[76:79], a[236:239], v[216:219], a[76:79]
ds_read_b128 a[180:183], v2 offset:29696
v_cvt_pk_bf16_f32 v220, v172, v173
v_mfma_f32_16x16x32_bf16 a[76:79], a[204:207], v[200:203], a[76:79]
v_exp_f32 v174, v174
v_mfma_f32_16x16x32_bf16 a[12:15], a[204:207], v[192:195], a[12:15]
v_exp_f32 v175, v175
v_mfma_f32_16x16x32_bf16 a[12:15], a[236:239], v[208:211], a[12:15]
ds_read_b128 a[184:187], v2 offset:30720
v_cvt_pk_bf16_f32 v221, v174, v175
v_mfma_f32_16x16x32_bf16 a[16:19], a[240:243], v[208:211], a[16:19]
s_waitcnt lgkmcnt(7)
v_exp_f32 v188, v188
v_mfma_f32_16x16x32_bf16 a[16:19], a[208:211], v[192:195], a[16:19]
buffer_load_dwordx4 v1, s[44:47], s72 offen offset:1024 sc1 lds
v_mfma_f32_16x16x32_bf16 a[80:83], a[208:211], v[200:203], a[80:83]
v_exp_f32 v189, v189
v_mfma_f32_16x16x32_bf16 a[80:83], a[240:243], v[216:219], a[80:83]
ds_read_b128 a[188:191], v2 offset:31744
v_cvt_pk_bf16_f32 v222, v188, v189
v_mfma_f32_16x16x32_bf16 a[84:87], a[244:247], v[216:219], a[84:87]
v_exp_f32 v190, v190
v_mfma_f32_16x16x32_bf16 a[84:87], a[212:215], v[200:203], a[84:87]
v_exp_f32 v191, v191
v_mfma_f32_16x16x32_bf16 a[20:23], a[212:215], v[192:195], a[20:23]
ds_read_b128 a[224:227], v2 offset:8192
v_cvt_pk_bf16_f32 v223, v190, v191
v_mfma_f32_16x16x32_bf16 a[20:23], a[244:247], v[208:211], a[20:23]
v_exp_f32 v160, v160
v_mfma_f32_16x16x32_bf16 a[24:27], a[248:251], v[208:211], a[24:27]
v_exp_f32 v161, v161
v_mfma_f32_16x16x32_bf16 a[24:27], a[216:219], v[192:195], a[24:27]
ds_read_b128 a[228:231], v2 offset:9216
v_mfma_f32_16x16x32_bf16 a[88:91], a[216:219], v[200:203], a[88:91]
v_exp_f32 v162, v162
v_mfma_f32_16x16x32_bf16 a[88:91], a[248:251], v[216:219], a[88:91]
v_exp_f32 v163, v163
v_mfma_f32_16x16x32_bf16 a[92:95], a[252:255], v[216:219], a[92:95]
ds_read_b128 a[232:235], v2 offset:10240
v_mfma_f32_16x16x32_bf16 a[92:95], a[220:223], v[200:203], a[92:95]
v_exp_f32 v176, v176
v_mfma_f32_16x16x32_bf16 a[28:31], a[220:223], v[192:195], a[28:31]
buffer_load_dwordx4 v1, s[44:47], s72 offen offset:2048 sc1 lds
v_mfma_f32_16x16x32_bf16 a[28:31], a[252:255], v[208:211], a[28:31]
ds_read_b128 a[236:239], v2 offset:11264
v_cvt_pk_bf16_f32 v208, v160, v161
s_cmp_eq_u32 s58, 0
s_cbranch_scc1 Lta16
s_cmp_eq_u32 s58, 1
s_cbranch_scc1 Lnt17
v_mfma_f32_16x16x32_bf16 v[128:131], a[128:131], v[16:19], v[80:83]
v_exp_f32 v177, v177
v_mfma_f32_16x16x32_bf16 v[144:147], a[144:147], v[16:19], v[80:83]
v_exp_f32 v178, v178
s_branch Ljoin18
Lta16:
v_mfma_f32_16x16x32_bf16 v[128:131], a[128:131], v[16:19], v[96:99]
v_exp_f32 v177, v177
v_mfma_f32_16x16x32_bf16 v[144:147], a[144:147], v[16:19], v[112:115]
v_exp_f32 v178, v178
s_branch Ljoin18
Lnt17:
v_mfma_f32_16x16x32_bf16 v[128:131], a[128:131], v[16:19], v[80:83]
v_exp_f32 v177, v177
v_mfma_f32_16x16x32_bf16 v[144:147], a[144:147], v[16:19], v[96:99]
Lstub3:
s_cbranch_execz Lstub7
v_exp_f32 v178, v178
Ljoin18:
v_mfma_f32_16x16x32_bf16 v[128:131], a[132:135], v[20:23], v[128:131]
ds_read_b128 a[240:243], v2 offset:12288
v_cvt_pk_bf16_f32 v209, v162, v163
v_mfma_f32_16x16x32_bf16 v[128:131], a[136:139], v[24:27], v[128:131]
v_exp_f32 v179, v179
v_mfma_f32_16x16x32_bf16 v[128:131], a[140:143], v[28:31], v[128:131]
v_exp_f32 v168, v168
v_mfma_f32_16x16x32_bf16 v[136:139], a[140:143], v[60:63], v[88:91]
ds_read_b128 a[244:247], v2 offset:13312
v_cvt_pk_bf16_f32 v210, v176, v177
v_mfma_f32_16x16x32_bf16 v[136:139], a[136:139], v[56:59], v[136:139]
v_exp_f32 v169, v169
v_mfma_f32_16x16x32_bf16 v[136:139], a[132:135], v[52:55], v[136:139]
v_exp_f32 v170, v170
v_mfma_f32_16x16x32_bf16 v[136:139], a[128:131], v[48:51], v[136:139]
ds_read_b128 a[248:251], v2 offset:14336
v_cvt_pk_bf16_f32 v211, v178, v179
v_mfma_f32_16x16x32_bf16 v[152:155], a[144:147], v[48:51], v[88:91]
v_exp_f32 v171, v171
v_mfma_f32_16x16x32_bf16 v[152:155], a[148:151], v[52:55], v[152:155]
v_exp_f32 v184, v184
v_mfma_f32_16x16x32_bf16 v[152:155], a[152:155], v[56:59], v[152:155]
ds_read_b128 a[252:255], v2 offset:15360
v_cvt_pk_bf16_f32 v216, v168, v169
v_mfma_f32_16x16x32_bf16 v[152:155], a[156:159], v[60:63], v[152:155]
buffer_load_dwordx4 v1, s[44:47], s72 offen offset:3072 sc1 lds
v_mfma_f32_16x16x32_bf16 v[144:147], a[156:159], v[28:31], v[144:147]
v_exp_f32 v185, v185
v_mfma_f32_16x16x32_bf16 v[144:147], a[152:155], v[24:27], v[144:147]
v_exp_f32 v186, v186
v_mfma_f32_16x16x32_bf16 v[144:147], a[148:151], v[20:23], v[144:147]
v_cvt_pk_bf16_f32 v217, v170, v171
v_cvt_pk_bf16_f32 v218, v184, v185
v_mfma_f32_16x16x32_bf16 v[132:135], a[128:131], v[32:35], v[84:87]
v_exp_f32 v187, v187
v_mfma_f32_16x16x32_bf16 v[132:135], a[132:135], v[36:39], v[132:135]
v_cvt_pk_bf16_f32 v219, v186, v187
v_add_u32 v2, s82, v1
v_mfma_f32_16x16x32_bf16 v[132:135], a[136:139], v[40:43], v[132:135]
v_mfma_f32_16x16x32_bf16 v[132:135], a[140:143], v[44:47], v[132:135]
v_mfma_f32_16x16x32_bf16 v[140:143], a[140:143], v[76:79], v[92:95]
v_mfma_f32_16x16x32_bf16 v[140:143], a[136:139], v[72:75], v[140:143]
v_mfma_f32_16x16x32_bf16 v[140:143], a[132:135], v[68:71], v[140:143]
v_mfma_f32_16x16x32_bf16 v[140:143], a[128:131], v[64:67], v[140:143]
v_mfma_f32_16x16x32_bf16 v[156:159], a[144:147], v[64:67], v[92:95]
v_mfma_f32_16x16x32_bf16 v[156:159], a[148:151], v[68:71], v[156:159]
v_mfma_f32_16x16x32_bf16 v[156:159], a[152:155], v[72:75], v[156:159]
v_mfma_f32_16x16x32_bf16 v[156:159], a[156:159], v[76:79], v[156:159]
v_mfma_f32_16x16x32_bf16 v[148:151], a[156:159], v[44:47], v[84:87]
v_mfma_f32_16x16x32_bf16 v[148:151], a[152:155], v[40:43], v[148:151]
v_mfma_f32_16x16x32_bf16 v[148:151], a[148:151], v[36:39], v[148:151]
s_waitcnt vmcnt(8) lgkmcnt(4)
v_mfma_f32_16x16x32_bf16 v[148:151], a[144:147], v[32:35], v[148:151]
s_barrier
v_mfma_f32_16x16x32_bf16 v[228:231], v[120:123], v[196:199], v[228:231]
s_xor_b32 s74, s82, 0x10000
v_exp_f32 v128, v128
v_mfma_f32_16x16x32_bf16 v[228:231], v[120:123], v[212:215], v[228:231]
s_add_u32 s74, s74, s64
ds_read_b128 a[128:131], v2 offset:16384
v_mfma_f32_16x16x32_bf16 v[236:239], v[120:123], v[204:207], v[236:239]
s_add_u32 s81, s81, 0x8000
v_exp_f32 v129, v129
v_mfma_f32_16x16x32_bf16 v[236:239], v[120:123], v[220:223], v[236:239]
s_add_u32 m0, s74, 16384
v_exp_f32 v130, v130
v_mfma_f32_16x16x32_bf16 a[32:35], a[192:195], v[196:199], a[32:35]
s_add_u32 s72, s81, 16384
ds_read_b128 a[132:135], v2 offset:17408
v_cvt_pk_bf16_f32 v192, v128, v129
v_mfma_f32_16x16x32_bf16 a[32:35], a[224:227], v[212:215], a[32:35]
v_exp_f32 v131, v131
v_mfma_f32_16x16x32_bf16 a[96:99], a[224:227], v[220:223], a[96:99]
v_exp_f32 v144, v144
v_mfma_f32_16x16x32_bf16 a[96:99], a[192:195], v[204:207], a[96:99]
ds_read_b128 a[136:139], v2 offset:18432
v_cvt_pk_bf16_f32 v193, v130, v131
v_mfma_f32_16x16x32_bf16 a[100:103], a[196:199], v[204:207], a[100:103]
buffer_load_dwordx4 v1, s[44:47], s72 offen sc1 lds
v_mfma_f32_16x16x32_bf16 a[100:103], a[228:231], v[220:223], a[100:103]
v_exp_f32 v145, v145
v_mfma_f32_16x16x32_bf16 a[36:39], a[228:231], v[212:215], a[36:39]
v_exp_f32 v146, v146
v_mfma_f32_16x16x32_bf16 a[36:39], a[196:199], v[196:199], a[36:39]
ds_read_b128 a[140:143], v2 offset:19456
v_cvt_pk_bf16_f32 v194, v144, v145
v_mfma_f32_16x16x32_bf16 a[40:43], a[200:203], v[196:199], a[40:43]
v_exp_f32 v147, v147
v_mfma_f32_16x16x32_bf16 a[40:43], a[232:235], v[212:215], a[40:43]
v_exp_f32 v136, v136
v_mfma_f32_16x16x32_bf16 a[104:107], a[232:235], v[220:223], a[104:107]
ds_read_b128 a[144:147], v2 offset:20480
v_cvt_pk_bf16_f32 v195, v146, v147
v_mfma_f32_16x16x32_bf16 a[104:107], a[200:203], v[204:207], a[104:107]
v_exp_f32 v137, v137
v_mfma_f32_16x16x32_bf16 a[108:111], a[204:207], v[204:207], a[108:111]
v_exp_f32 v138, v138
v_mfma_f32_16x16x32_bf16 a[108:111], a[236:239], v[220:223], a[108:111]
ds_read_b128 a[148:151], v2 offset:21504
v_cvt_pk_bf16_f32 v200, v136, v137
v_mfma_f32_16x16x32_bf16 a[44:47], a[236:239], v[212:215], a[44:47]
v_exp_f32 v139, v139
v_mfma_f32_16x16x32_bf16 a[44:47], a[204:207], v[196:199], a[44:47]
v_exp_f32 v152, v152
v_mfma_f32_16x16x32_bf16 a[48:51], a[208:211], v[196:199], a[48:51]
s_waitcnt lgkmcnt(6)
ds_read_b128 a[152:155], v2 offset:22528
v_cvt_pk_bf16_f32 v201, v138, v139
v_mfma_f32_16x16x32_bf16 a[48:51], a[240:243], v[212:215], a[48:51]
buffer_load_dwordx4 v1, s[44:47], s72 offen offset:1024 sc1 lds
v_mfma_f32_16x16x32_bf16 a[112:115], a[240:243], v[220:223], a[112:115]
v_exp_f32 v153, v153
v_mfma_f32_16x16x32_bf16 a[112:115], a[208:211], v[204:207], a[112:115]
v_exp_f32 v154, v154
v_mfma_f32_16x16x32_bf16 a[116:119], a[212:215], v[204:207], a[116:119]
ds_read_b128 a[156:159], v2 offset:23552
v_cvt_pk_bf16_f32 v202, v152, v153
v_mfma_f32_16x16x32_bf16 a[116:119], a[244:247], v[220:223], a[116:119]
v_exp_f32 v155, v155
v_mfma_f32_16x16x32_bf16 a[52:55], a[244:247], v[212:215], a[52:55]
v_exp_f32 v132, v132
v_mfma_f32_16x16x32_bf16 a[52:55], a[212:215], v[196:199], a[52:55]
ds_read_b128 a[192:195], v2 offset:0
v_cvt_pk_bf16_f32 v203, v154, v155
v_mfma_f32_16x16x32_bf16 a[56:59], a[216:219], v[196:199], a[56:59]
v_exp_f32 v133, v133
v_mfma_f32_16x16x32_bf16 a[56:59], a[248:251], v[212:215], a[56:59]
v_exp_f32 v134, v134
v_mfma_f32_16x16x32_bf16 a[120:123], a[248:251], v[220:223], a[120:123]
ds_read_b128 a[196:199], v2 offset:1024
v_mfma_f32_16x16x32_bf16 a[120:123], a[216:219], v[204:207], a[120:123]
v_exp_f32 v135, v135
v_mfma_f32_16x16x32_bf16 a[124:127], a[220:223], v[204:207], a[124:127]
v_exp_f32 v148, v148
v_mfma_f32_16x16x32_bf16 a[124:127], a[252:255], v[220:223], a[124:127]
ds_read_b128 a[200:203], v2 offset:2048
v_mfma_f32_16x16x32_bf16 a[60:63], a[252:255], v[212:215], a[60:63]
buffer_load_dwordx4 v1, s[44:47], s72 offen offset:2048 sc1 lds
v_mfma_f32_16x16x32_bf16 a[60:63], a[220:223], v[196:199], a[60:63]
ds_read_b128 a[204:207], v2 offset:3072
v_cvt_pk_bf16_f32 v196, v132, v133
s_cmp_eq_u32 s58, 2
s_cbranch_scc1 Lta19
s_cmp_eq_u32 s58, 3
s_cbranch_scc1 Lnt20
v_mfma_f32_16x16x32_bf16 v[160:163], a[160:163], v[16:19], v[112:115]
v_exp_f32 v149, v149
v_mfma_f32_16x16x32_bf16 v[176:179], a[176:179], v[16:19], v[112:115]
v_exp_f32 v150, v150
s_branch Ljoin21
Lta19:
v_mfma_f32_16x16x32_bf16 v[160:163], a[160:163], v[16:19], v[96:99]
v_exp_f32 v149, v149
v_mfma_f32_16x16x32_bf16 v[176:179], a[176:179], v[16:19], v[112:115]
v_exp_f32 v150, v150
s_branch Ljoin21
Lnt20:
v_mfma_f32_16x16x32_bf16 v[160:163], a[160:163], v[16:19], v[80:83]
v_exp_f32 v149, v149
v_mfma_f32_16x16x32_bf16 v[176:179], a[176:179], v[16:19], v[96:99]
v_exp_f32 v150, v150
Ljoin21:
v_mfma_f32_16x16x32_bf16 v[164:167], a[160:163], v[32:35], v[84:87]
ds_read_b128 a[208:211], v2 offset:4096
v_cvt_pk_bf16_f32 v197, v134, v135
v_mfma_f32_16x16x32_bf16 v[164:167], a[164:167], v[36:39], v[164:167]
v_exp_f32 v151, v151
v_mfma_f32_16x16x32_bf16 v[164:167], a[168:171], v[40:43], v[164:167]
v_exp_f32 v140, v140
v_mfma_f32_16x16x32_bf16 v[164:167], a[172:175], v[44:47], v[164:167]
ds_read_b128 a[212:215], v2 offset:5120
v_cvt_pk_bf16_f32 v198, v148, v149
v_mfma_f32_16x16x32_bf16 v[172:175], a[172:175], v[76:79], v[92:95]
v_exp_f32 v141, v141
v_mfma_f32_16x16x32_bf16 v[172:175], a[168:171], v[72:75], v[172:175]
v_exp_f32 v142, v142
v_mfma_f32_16x16x32_bf16 v[172:175], a[164:167], v[68:71], v[172:175]
ds_read_b128 a[216:219], v2 offset:6144
v_cvt_pk_bf16_f32 v199, v150, v151
v_mfma_f32_16x16x32_bf16 v[172:175], a[160:163], v[64:67], v[172:175]
v_exp_f32 v143, v143
v_mfma_f32_16x16x32_bf16 v[188:191], a[176:179], v[64:67], v[92:95]
v_exp_f32 v156, v156
v_mfma_f32_16x16x32_bf16 v[188:191], a[180:183], v[68:71], v[188:191]
ds_read_b128 a[220:223], v2 offset:7168
v_cvt_pk_bf16_f32 v204, v140, v141
v_mfma_f32_16x16x32_bf16 v[188:191], a[184:187], v[72:75], v[188:191]
buffer_load_dwordx4 v1, s[44:47], s72 offen offset:3072 sc1 lds
v_mfma_f32_16x16x32_bf16 v[188:191], a[188:191], v[76:79], v[188:191]
v_exp_f32 v157, v157
v_mfma_f32_16x16x32_bf16 v[180:183], a[188:191], v[44:47], v[84:87]
v_exp_f32 v158, v158
v_mfma_f32_16x16x32_bf16 v[180:183], a[184:187], v[40:43], v[180:183]
v_cvt_pk_bf16_f32 v205, v142, v143
v_cvt_pk_bf16_f32 v206, v156, v157
v_mfma_f32_16x16x32_bf16 v[180:183], a[180:183], v[36:39], v[180:183]
v_exp_f32 v159, v159
v_mfma_f32_16x16x32_bf16 v[180:183], a[176:179], v[32:35], v[180:183]
v_cvt_pk_bf16_f32 v207, v158, v159
v_mfma_f32_16x16x32_bf16 v[160:163], a[164:167], v[20:23], v[160:163]
v_mfma_f32_16x16x32_bf16 v[160:163], a[168:171], v[24:27], v[160:163]
v_mfma_f32_16x16x32_bf16 v[160:163], a[172:175], v[28:31], v[160:163]
v_mfma_f32_16x16x32_bf16 v[168:171], a[172:175], v[60:63], v[88:91]
v_mfma_f32_16x16x32_bf16 v[168:171], a[168:171], v[56:59], v[168:171]
v_mfma_f32_16x16x32_bf16 v[168:171], a[164:167], v[52:55], v[168:171]
v_mfma_f32_16x16x32_bf16 v[168:171], a[160:163], v[48:51], v[168:171]
v_mfma_f32_16x16x32_bf16 v[184:187], a[176:179], v[48:51], v[88:91]
v_mfma_f32_16x16x32_bf16 v[184:187], a[180:183], v[52:55], v[184:187]
v_mfma_f32_16x16x32_bf16 v[184:187], a[184:187], v[56:59], v[184:187]
v_mfma_f32_16x16x32_bf16 v[184:187], a[188:191], v[60:63], v[184:187]
v_mfma_f32_16x16x32_bf16 v[176:179], a[188:191], v[28:31], v[176:179]
v_mfma_f32_16x16x32_bf16 v[176:179], a[184:187], v[24:27], v[176:179]
v_mfma_f32_16x16x32_bf16 v[176:179], a[180:183], v[20:23], v[176:179]
s_waitcnt lgkmcnt(4)
v_mfma_f32_16x16x32_bf16 v[224:227], v[120:123], v[208:211], v[224:227]
s_add_u32 s82, s82, 0x8000
ds_read_b128 a[160:163], v2 offset:24576
v_mfma_f32_16x16x32_bf16 v[224:227], v[120:123], v[192:195], v[224:227]
s_and_b32 s82, s82, 0x1ffff
v_exp_f32 v164, v164
v_mfma_f32_16x16x32_bf16 v[232:235], v[120:123], v[216:219], v[232:235]
s_add_u32 m0, s74, 0
v_exp_f32 v165, v165
v_mfma_f32_16x16x32_bf16 v[232:235], v[120:123], v[200:203], v[232:235]
s_add_u32 s72, s81, 0
ds_read_b128 a[164:167], v2 offset:25600
v_cvt_pk_bf16_f32 v212, v164, v165
v_mfma_f32_16x16x32_bf16 a[0:3], a[224:227], v[208:211], a[0:3]
v_exp_f32 v166, v166
v_mfma_f32_16x16x32_bf16 a[0:3], a[192:195], v[192:195], a[0:3]
v_exp_f32 v167, v167
v_mfma_f32_16x16x32_bf16 a[64:67], a[192:195], v[200:203], a[64:67]
ds_read_b128 a[168:171], v2 offset:26624
v_cvt_pk_bf16_f32 v213, v166, v167
v_mfma_f32_16x16x32_bf16 a[64:67], a[224:227], v[216:219], a[64:67]
v_exp_f32 v180, v180
v_mfma_f32_16x16x32_bf16 a[68:71], a[228:231], v[216:219], a[68:71]
buffer_load_dwordx4 v1, s[44:47], s72 offen sc1 lds
v_mfma_f32_16x16x32_bf16 a[68:71], a[196:199], v[200:203], a[68:71]
v_exp_f32 v181, v181
v_mfma_f32_16x16x32_bf16 a[4:7], a[196:199], v[192:195], a[4:7]
ds_read_b128 a[172:175], v2 offset:27648
v_cvt_pk_bf16_f32 v214, v180, v181
v_mfma_f32_16x16x32_bf16 a[4:7], a[228:231], v[208:211], a[4:7]
v_exp_f32 v182, v182
v_mfma_f32_16x16x32_bf16 a[8:11], a[232:235], v[208:211], a[8:11]
v_exp_f32 v183, v183
v_mfma_f32_16x16x32_bf16 a[8:11], a[200:203], v[192:195], a[8:11]
ds_read_b128 a[176:179], v2 offset:28672
v_cvt_pk_bf16_f32 v215, v182, v183
v_mfma_f32_16x16x32_bf16 a[72:75], a[200:203], v[200:203], a[72:75]
v_exp_f32 v172, v172
v_mfma_f32_16x16x32_bf16 a[72:75], a[232:235], v[216:219], a[72:75]
v_exp_f32 v173, v173
v_mfma_f32_16x16x32_bf16 a[76:79], a[236:239], v[216:219], a[76:79]
ds_read_b128 a[180:183], v2 offset:29696
v_cvt_pk_bf16_f32 v220, v172, v173
v_mfma_f32_16x16x32_bf16 a[76:79], a[204:207], v[200:203], a[76:79]
v_exp_f32 v174, v174
v_mfma_f32_16x16x32_bf16 a[12:15], a[204:207], v[192:195], a[12:15]
v_exp_f32 v175, v175
v_mfma_f32_16x16x32_bf16 a[12:15], a[236:239], v[208:211], a[12:15]
ds_read_b128 a[184:187], v2 offset:30720
v_cvt_pk_bf16_f32 v221, v174, v175
v_mfma_f32_16x16x32_bf16 a[16:19], a[240:243], v[208:211], a[16:19]
s_waitcnt lgkmcnt(7)
v_exp_f32 v188, v188
v_mfma_f32_16x16x32_bf16 a[16:19], a[208:211], v[192:195], a[16:19]
buffer_load_dwordx4 v1, s[44:47], s72 offen offset:1024 sc1 lds
v_mfma_f32_16x16x32_bf16 a[80:83], a[208:211], v[200:203], a[80:83]
v_exp_f32 v189, v189
v_mfma_f32_16x16x32_bf16 a[80:83], a[240:243], v[216:219], a[80:83]
ds_read_b128 a[188:191], v2 offset:31744
v_cvt_pk_bf16_f32 v222, v188, v189
v_mfma_f32_16x16x32_bf16 a[84:87], a[244:247], v[216:219], a[84:87]
v_exp_f32 v190, v190
v_mfma_f32_16x16x32_bf16 a[84:87], a[212:215], v[200:203], a[84:87]
v_exp_f32 v191, v191
v_mfma_f32_16x16x32_bf16 a[20:23], a[212:215], v[192:195], a[20:23]
ds_read_b128 a[224:227], v2 offset:8192
v_cvt_pk_bf16_f32 v223, v190, v191
v_mfma_f32_16x16x32_bf16 a[20:23], a[244:247], v[208:211], a[20:23]
v_exp_f32 v160, v160
v_mfma_f32_16x16x32_bf16 a[24:27], a[248:251], v[208:211], a[24:27]
v_exp_f32 v161, v161
v_mfma_f32_16x16x32_bf16 a[24:27], a[216:219], v[192:195], a[24:27]
ds_read_b128 a[228:231], v2 offset:9216
v_mfma_f32_16x16x32_bf16 a[88:91], a[216:219], v[200:203], a[88:91]
v_exp_f32 v162, v162
v_mfma_f32_16x16x32_bf16 a[88:91], a[248:251], v[216:219], a[88:91]
v_exp_f32 v163, v163
v_mfma_f32_16x16x32_bf16 a[92:95], a[252:255], v[216:219], a[92:95]
ds_read_b128 a[232:235], v2 offset:10240
v_mfma_f32_16x16x32_bf16 a[92:95], a[220:223], v[200:203], a[92:95]
v_exp_f32 v176, v176
v_mfma_f32_16x16x32_bf16 a[28:31], a[220:223], v[192:195], a[28:31]
buffer_load_dwordx4 v1, s[44:47], s72 offen offset:2048 sc1 lds
v_mfma_f32_16x16x32_bf16 a[28:31], a[252:255], v[208:211], a[28:31]
ds_read_b128 a[236:239], v2 offset:11264
v_cvt_pk_bf16_f32 v208, v160, v161
s_cmp_eq_u32 s58, 0
s_cbranch_scc1 Lta22
s_cmp_eq_u32 s58, 1
s_cbranch_scc1 Lnt23
v_mfma_f32_16x16x32_bf16 v[132:135], a[128:131], v[32:35], v[84:87]
v_exp_f32 v177, v177
v_mfma_f32_16x16x32_bf16 v[148:151], a[144:147], v[32:35], v[84:87]
v_exp_f32 v178, v178
s_branch Ljoin24
Lta22:
v_mfma_f32_16x16x32_bf16 v[132:135], a[128:131], v[32:35], v[100:103]
v_exp_f32 v177, v177
v_mfma_f32_16x16x32_bf16 v[148:151], a[144:147], v[32:35], v[112:115]
v_exp_f32 v178, v178
s_branch Ljoin24
Lnt23:
v_mfma_f32_16x16x32_bf16 v[132:135], a[128:131], v[32:35], v[84:87]
v_exp_f32 v177, v177
v_mfma_f32_16x16x32_bf16 v[148:151], a[144:147], v[32:35], v[100:103]
v_exp_f32 v178, v178
Ljoin24:
v_mfma_f32_16x16x32_bf16 v[136:139], a[128:131], v[48:51], v[88:91]
ds_read_b128 a[240:243], v2 offset:12288
v_cvt_pk_bf16_f32 v209, v162, v163
v_mfma_f32_16x16x32_bf16 v[136:139], a[132:135], v[52:55], v[136:139]
v_exp_f32 v179, v179
v_mfma_f32_16x16x32_bf16 v[136:139], a[136:139], v[56:59], v[136:139]
v_exp_f32 v168, v168
v_mfma_f32_16x16x32_bf16 v[136:139], a[140:143], v[60:63], v[136:139]
ds_read_b128 a[244:247], v2 offset:13312
v_cvt_pk_bf16_f32 v210, v176, v177
v_mfma_f32_16x16x32_bf16 v[152:155], a[156:159], v[60:63], v[88:91]
v_exp_f32 v169, v169
v_mfma_f32_16x16x32_bf16 v[152:155], a[152:155], v[56:59], v[152:155]
v_exp_f32 v170, v170
v_mfma_f32_16x16x32_bf16 v[152:155], a[148:151], v[52:55], v[152:155]
ds_read_b128 a[248:251], v2 offset:14336
v_cvt_pk_bf16_f32 v211, v178, v179
v_mfma_f32_16x16x32_bf16 v[152:155], a[144:147], v[48:51], v[152:155]
v_exp_f32 v171, v171
v_mfma_f32_16x16x32_bf16 v[132:135], a[132:135], v[36:39], v[132:135]
v_exp_f32 v184, v184
v_mfma_f32_16x16x32_bf16 v[132:135], a[136:139], v[40:43], v[132:135]
ds_read_b128 a[252:255], v2 offset:15360
v_cvt_pk_bf16_f32 v216, v168, v169
v_mfma_f32_16x16x32_bf16 v[132:135], a[140:143], v[44:47], v[132:135]
buffer_load_dwordx4 v1, s[44:47], s72 offen offset:3072 sc1 lds
v_mfma_f32_16x16x32_bf16 v[140:143], a[140:143], v[76:79], v[92:95]
v_exp_f32 v185, v185
v_mfma_f32_16x16x32_bf16 v[140:143], a[136:139], v[72:75], v[140:143]
v_exp_f32 v186, v186
v_mfma_f32_16x16x32_bf16 v[140:143], a[132:135], v[68:71], v[140:143]
v_cvt_pk_bf16_f32 v217, v170, v171
v_cvt_pk_bf16_f32 v218, v184, v185
v_mfma_f32_16x16x32_bf16 v[140:143], a[128:131], v[64:67], v[140:143]
v_exp_f32 v187, v187
v_mfma_f32_16x16x32_bf16 v[156:159], a[144:147], v[64:67], v[92:95]
v_cvt_pk_bf16_f32 v219, v186, v187
v_add_u32 v2, s82, v1
v_mfma_f32_16x16x32_bf16 v[156:159], a[148:151], v[68:71], v[156:159]
v_mfma_f32_16x16x32_bf16 v[156:159], a[152:155], v[72:75], v[156:159]
v_mfma_f32_16x16x32_bf16 v[156:159], a[156:159], v[76:79], v[156:159]
v_mfma_f32_16x16x32_bf16 v[148:151], a[156:159], v[44:47], v[148:151]
v_mfma_f32_16x16x32_bf16 v[148:151], a[152:155], v[40:43], v[148:151]
s_waitcnt vmcnt(8) lgkmcnt(4)
v_mfma_f32_16x16x32_bf16 v[148:151], a[148:151], v[36:39], v[148:151]
s_barrier
s_cmp_eq_u32 s60, 7
s_cbranch_scc1 LLT3x
LLT3:
Lstub4:
s_cbranch_execz Lstub8
v_mfma_f32_16x16x32_bf16 v[228:231], v[120:123], v[196:199], v[228:231]
s_xor_b32 s74, s82, 0x10000
v_exp_f32 v136, v136
v_mfma_f32_16x16x32_bf16 v[228:231], v[120:123], v[212:215], v[228:231]
s_add_u32 s74, s74, s64
ds_read_b128 a[128:131], v2 offset:16384
v_and_b32 v240, 15, v0
v_mfma_f32_16x16x32_bf16 v[236:239], v[120:123], v[204:207], v[236:239]
s_add_u32 s81, s81, 0x8000
v_exp_f32 v137, v137
v_mfma_f32_16x16x32_bf16 v[236:239], v[120:123], v[220:223], v[236:239]
s_add_u32 m0, s74, 16384
ds_read_b128 a[132:135], v2 offset:17408
v_cvt_pk_bf16_f32 v200, v136, v137
v_mfma_f32_16x16x32_bf16 a[32:35], a[192:195], v[196:199], a[32:35]
s_add_u32 s72, s81, 16384
buffer_load_dwordx4 v1, s[44:47], s72 offen sc1 lds
v_mfma_f32_16x16x32_bf16 a[32:35], a[224:227], v[212:215], a[32:35]
s_add_u32 s69, s93, 0x3e00000
v_exp_f32 v138, v138
v_mfma_f32_16x16x32_bf16 a[96:99], a[224:227], v[220:223], a[96:99]
v_exp_f32 v139, v139
v_mfma_f32_16x16x32_bf16 a[96:99], a[192:195], v[204:207], a[96:99]
ds_read_b128 a[136:139], v2 offset:18432
v_cvt_pk_bf16_f32 v201, v138, v139
v_mfma_f32_16x16x32_bf16 a[100:103], a[196:199], v[204:207], a[100:103]
v_exp_f32 v152, v152
v_mfma_f32_16x16x32_bf16 a[100:103], a[228:231], v[220:223], a[100:103]
ds_read_b128 a[140:143], v2 offset:19456
v_lshrrev_b32 v241, 4, v0
v_mfma_f32_16x16x32_bf16 a[36:39], a[228:231], v[212:215], a[36:39]
buffer_store_dwordx4 v[112:115], v1, s[44:47], s69 offen sc1
v_mfma_f32_16x16x32_bf16 a[36:39], a[196:199], v[196:199], a[36:39]
v_exp_f32 v153, v153
v_mfma_f32_16x16x32_bf16 a[40:43], a[200:203], v[196:199], a[40:43]
v_exp_f32 v154, v154
v_mfma_f32_16x16x32_bf16 a[40:43], a[232:235], v[212:215], a[40:43]
ds_read_b128 a[144:147], v2 offset:20480
v_cvt_pk_bf16_f32 v202, v152, v153
v_mfma_f32_16x16x32_bf16 a[104:107], a[232:235], v[220:223], a[104:107]
v_exp_f32 v155, v155
v_mfma_f32_16x16x32_bf16 a[104:107], a[200:203], v[204:207], a[104:107]
ds_read_b128 a[148:151], v2 offset:21504
v_cvt_pk_bf16_f32 v203, v154, v155
v_mfma_f32_16x16x32_bf16 a[108:111], a[204:207], v[204:207], a[108:111]
buffer_load_dwordx4 v1, s[44:47], s72 offen offset:1024 sc1 lds
v_mfma_f32_16x16x32_bf16 a[108:111], a[236:239], v[220:223], a[108:111]
v_exp_f32 v132, v132
v_mfma_f32_16x16x32_bf16 a[44:47], a[236:239], v[212:215], a[44:47]
v_exp_f32 v133, v133
v_mfma_f32_16x16x32_bf16 a[44:47], a[204:207], v[196:199], a[44:47]
ds_read_b128 a[152:155], v2 offset:22528
v_add_u32 v248, 1, v240
v_mfma_f32_16x16x32_bf16 a[48:51], a[208:211], v[196:199], a[48:51]
s_waitcnt lgkmcnt(7)
v_exp_f32 v134, v134
v_mfma_f32_16x16x32_bf16 a[48:51], a[240:243], v[212:215], a[48:51]
ds_read_b128 a[156:159], v2 offset:23552
v_and_b32 v249, 3, v248
v_mfma_f32_16x16x32_bf16 a[112:115], a[240:243], v[220:223], a[112:115]
buffer_store_dwordx4 v[112:115], v1, s[44:47], s69 offen offset:1024 sc1
v_mfma_f32_16x16x32_bf16 a[112:115], a[208:211], v[204:207], a[112:115]
v_exp_f32 v135, v135
v_mfma_f32_16x16x32_bf16 a[116:119], a[212:215], v[204:207], a[116:119]
v_exp_f32 v148, v148
v_mfma_f32_16x16x32_bf16 a[116:119], a[244:247], v[220:223], a[116:119]
ds_read_b128 a[192:195], v2 offset:0
v_lshrrev_b32 v248, 2, v248
v_mfma_f32_16x16x32_bf16 a[52:55], a[244:247], v[212:215], a[52:55]
v_exp_f32 v149, v149
v_mfma_f32_16x16x32_bf16 a[52:55], a[212:215], v[196:199], a[52:55]
ds_read_b128 a[196:199], v2 offset:1024
v_mov_b32 v250, 0x20000
v_mfma_f32_16x16x32_bf16 a[56:59], a[216:219], v[196:199], a[56:59]
buffer_load_dwordx4 v1, s[44:47], s72 offen offset:2048 sc1 lds
v_mfma_f32_16x16x32_bf16 a[56:59], a[248:251], v[212:215], a[56:59]
v_exp_f32 v150, v150
v_mfma_f32_16x16x32_bf16 a[120:123], a[248:251], v[220:223], a[120:123]
v_exp_f32 v151, v151
v_mfma_f32_16x16x32_bf16 a[120:123], a[216:219], v[204:207], a[120:123]
ds_read_b128 a[200:203], v2 offset:2048
v_mov_b32 v252, 0x20001
v_mfma_f32_16x16x32_bf16 a[124:127], a[220:223], v[204:207], a[124:127]
v_exp_f32 v140, v140
v_mfma_f32_16x16x32_bf16 a[124:127], a[252:255], v[220:223], a[124:127]
ds_read_b128 a[204:207], v2 offset:3072
v_lshlrev_b32 v6, 3, v249
v_mfma_f32_16x16x32_bf16 a[60:63], a[252:255], v[212:215], a[60:63]
buffer_store_dwordx4 v[112:115], v1, s[44:47], s69 offen offset:2048 sc1
v_mfma_f32_16x16x32_bf16 a[60:63], a[220:223], v[196:199], a[60:63]
ds_read_b128 a[208:211], v2 offset:4096
v_cvt_pk_bf16_f32 v196, v132, v133
s_cmp_eq_u32 s58, 2
s_cbranch_scc1 Lta25
s_cmp_eq_u32 s58, 3
s_cbranch_scc1 Lnt26
v_mfma_f32_16x16x32_bf16 v[164:167], a[160:163], v[32:35], v[112:115]
ds_read_b128 a[212:215], v2 offset:5120
v_cvt_pk_bf16_f32 v197, v134, v135
v_mfma_f32_16x16x32_bf16 v[180:183], a[176:179], v[32:35], v[112:115]
ds_read_b128 a[216:219], v2 offset:6144
v_cvt_pk_bf16_f32 v198, v148, v149
s_branch Ljoin27
Lta25:
v_mfma_f32_16x16x32_bf16 v[164:167], a[160:163], v[32:35], v[100:103]
ds_read_b128 a[212:215], v2 offset:5120
v_cvt_pk_bf16_f32 v197, v134, v135
v_mfma_f32_16x16x32_bf16 v[180:183], a[176:179], v[32:35], v[112:115]
ds_read_b128 a[216:219], v2 offset:6144
v_cvt_pk_bf16_f32 v198, v148, v149
s_branch Ljoin27
Lnt26:
v_mfma_f32_16x16x32_bf16 v[164:167], a[160:163], v[32:35], v[84:87]
ds_read_b128 a[212:215], v2 offset:5120
v_cvt_pk_bf16_f32 v197, v134, v135
v_mfma_f32_16x16x32_bf16 v[180:183], a[176:179], v[32:35], v[100:103]
ds_read_b128 a[216:219], v2 offset:6144
v_cvt_pk_bf16_f32 v198, v148, v149
Ljoin27:
v_mfma_f32_16x16x32_bf16 v[164:167], a[164:167], v[36:39], v[164:167]
v_exp_f32 v141, v141
v_mfma_f32_16x16x32_bf16 v[164:167], a[168:171], v[40:43], v[164:167]
v_exp_f32 v142, v142
v_mfma_f32_16x16x32_bf16 v[164:167], a[172:175], v[44:47], v[164:167]
ds_read_b128 a[220:223], v2 offset:7168
v_cvt_pk_bf16_f32 v199, v150, v151
v_mfma_f32_16x16x32_bf16 v[172:175], a[172:175], v[76:79], v[92:95]
v_exp_f32 v143, v143
v_mfma_f32_16x16x32_bf16 v[172:175], a[168:171], v[72:75], v[172:175]
buffer_load_dwordx4 v1, s[44:47], s72 offen offset:3072 sc1 lds
v_mfma_f32_16x16x32_bf16 v[172:175], a[164:167], v[68:71], v[172:175]
v_exp_f32 v156, v156
v_mfma_f32_16x16x32_bf16 v[172:175], a[160:163], v[64:67], v[172:175]
v_cvt_pk_bf16_f32 v204, v140, v141
v_cvt_pk_bf16_f32 v205, v142, v143
v_mfma_f32_16x16x32_bf16 v[188:191], a[176:179], v[64:67], v[92:95]
v_exp_f32 v157, v157
v_mfma_f32_16x16x32_bf16 v[188:191], a[180:183], v[68:71], v[188:191]
v_exp_f32 v158, v158
v_mfma_f32_16x16x32_bf16 v[188:191], a[184:187], v[72:75], v[188:191]
buffer_store_dwordx4 v[112:115], v1, s[44:47], s69 offen offset:3072 sc1
v_mfma_f32_16x16x32_bf16 v[188:191], a[188:191], v[76:79], v[188:191]
v_exp_f32 v159, v159
v_mfma_f32_16x16x32_bf16 v[180:183], a[188:191], v[44:47], v[180:183]
v_cvt_pk_bf16_f32 v206, v156, v157
v_cvt_pk_bf16_f32 v207, v158, v159
v_mfma_f32_16x16x32_bf16 v[180:183], a[184:187], v[40:43], v[180:183]
v_lshrrev_b32 v6, v6, v252
v_and_b32 v6, 3, v6
v_mfma_f32_16x16x32_bf16 v[180:183], a[180:183], v[36:39], v[180:183]
v_cmp_ne_u32 vcc, 1, v249
v_mul_u32_u24 v6, 16640, v6
v_mfma_f32_16x16x32_bf16 v[168:171], a[160:163], v[48:51], v[88:91]
v_add_u32 v6, s92, v6
v_cndmask_b32 v6, v250, v6, vcc
v_mfma_f32_16x16x32_bf16 v[168:171], a[164:167], v[52:55], v[168:171]
v_add_u32 v253, s58, v249
v_and_b32 v253, 3, v253
v_mfma_f32_16x16x32_bf16 v[168:171], a[168:171], v[56:59], v[168:171]
v_mul_u32_u24 v253, 4160, v253
v_add_u32 v6, v6, v253
v_mfma_f32_16x16x32_bf16 v[168:171], a[172:175], v[60:63], v[168:171]
v_bfe_u32 v251, v0, 2, 2
v_lshl_add_u32 v6, v248, 3, v6
v_mfma_f32_16x16x32_bf16 v[184:187], a[188:191], v[60:63], v[88:91]
v_lshl_add_u32 v6, v241, 4, v6
v_lshlrev_b32 v5, 3, v251
v_mfma_f32_16x16x32_bf16 v[184:187], a[184:187], v[56:59], v[184:187]
v_lshrrev_b32 v5, v5, v252
v_and_b32 v5, 3, v5
v_mfma_f32_16x16x32_bf16 v[184:187], a[180:183], v[52:55], v[184:187]
v_cmp_ne_u32 vcc, 1, v251
v_mul_u32_u24 v5, 16640, v5
v_mfma_f32_16x16x32_bf16 v[184:187], a[176:179], v[48:51], v[184:187]
s_waitcnt lgkmcnt(4)
v_mfma_f32_16x16x32_bf16 v[224:227], v[120:123], v[208:211], v[224:227]
s_add_u32 s82, s82, 0x8000
ds_read_b128 a[160:163], v2 offset:24576
ds_read_b128 a[164:167], v2 offset:25600
v_mfma_f32_16x16x32_bf16 v[232:235], v[120:123], v[216:219], v[232:235]
s_and_b32 s82, s82, 0x1ffff
v_exp_f32 v164, v164
v_mfma_f32_16x16x32_bf16 v[232:235], v[120:123], v[200:203], v[232:235]
s_add_u32 m0, s74, 0
v_exp_f32 v165, v165
v_mfma_f32_16x16x32_bf16 a[0:3], a[224:227], v[208:211], a[0:3]
s_add_u32 s72, s81, 0
v_exp_f32 v166, v166
v_mfma_f32_16x16x32_bf16 a[64:67], a[192:195], v[200:203], a[64:67]
ds_read_b128 a[168:171], v2 offset:26624
v_cvt_pk_bf16_f32 v212, v164, v165
v_mfma_f32_16x16x32_bf16 a[64:67], a[224:227], v[216:219], a[64:67]
v_exp_f32 v167, v167
v_mfma_f32_16x16x32_bf16 a[68:71], a[228:231], v[216:219], a[68:71]
buffer_load_dwordx4 v1, s[44:47], s72 offen sc1 lds
v_mfma_f32_16x16x32_bf16 a[68:71], a[196:199], v[200:203], a[68:71]
v_exp_f32 v180, v180
v_mfma_f32_16x16x32_bf16 a[4:7], a[228:231], v[208:211], a[4:7]
ds_read_b128 a[172:175], v2 offset:27648
v_cvt_pk_bf16_f32 v213, v166, v167
v_mfma_f32_16x16x32_bf16 a[8:11], a[232:235], v[208:211], a[8:11]
v_exp_f32 v181, v181
v_mfma_f32_16x16x32_bf16 a[72:75], a[200:203], v[200:203], a[72:75]
ds_read_b128 a[176:179], v2 offset:28672
v_cvt_pk_bf16_f32 v214, v180, v181
v_mfma_f32_16x16x32_bf16 a[72:75], a[232:235], v[216:219], a[72:75]
v_exp_f32 v182, v182
v_mfma_f32_16x16x32_bf16 a[76:79], a[236:239], v[216:219], a[76:79]
v_exp_f32 v183, v183
v_mfma_f32_16x16x32_bf16 a[76:79], a[204:207], v[200:203], a[76:79]
ds_read_b128 a[180:183], v2 offset:29696
v_cvt_pk_bf16_f32 v215, v182, v183
v_mfma_f32_16x16x32_bf16 a[12:15], a[236:239], v[208:211], a[12:15]
v_exp_f32 v172, v172
v_mfma_f32_16x16x32_bf16 a[16:19], a[240:243], v[208:211], a[16:19]
s_waitcnt lgkmcnt(6)
ds_read_b128 a[184:187], v2 offset:30720
ds_read_b128 a[188:191], v2 offset:31744
v_mfma_f32_16x16x32_bf16 a[80:83], a[208:211], v[200:203], a[80:83]
v_exp_f32 v173, v173
v_mfma_f32_16x16x32_bf16 a[80:83], a[240:243], v[216:219], a[80:83]
buffer_load_dwordx4 v1, s[44:47], s72 offen offset:1024 sc1 lds
v_mfma_f32_16x16x32_bf16 a[84:87], a[244:247], v[216:219], a[84:87]
v_exp_f32 v174, v174
v_mfma_f32_16x16x32_bf16 a[84:87], a[212:215], v[200:203], a[84:87]
v_exp_f32 v175, v175
v_mfma_f32_16x16x32_bf16 a[20:23], a[244:247], v[208:211], a[20:23]
ds_read_b128 a[224:227], v2 offset:8192
v_cvt_pk_bf16_f32 v220, v172, v173
v_mfma_f32_16x16x32_bf16 a[24:27], a[248:251], v[208:211], a[24:27]
v_exp_f32 v188, v188
v_mfma_f32_16x16x32_bf16 a[88:91], a[216:219], v[200:203], a[88:91]
v_exp_f32 v189, v189
v_mfma_f32_16x16x32_bf16 a[88:91], a[248:251], v[216:219], a[88:91]
ds_read_b128 a[228:231], v2 offset:9216
v_cvt_pk_bf16_f32 v221, v174, v175
v_mfma_f32_16x16x32_bf16 a[92:95], a[252:255], v[216:219], a[92:95]
v_exp_f32 v190, v190
v_mfma_f32_16x16x32_bf16 a[92:95], a[220:223], v[200:203], a[92:95]
Lstub5:
s_cbranch_execz Lstub9
ds_read_b128 a[232:235], v2 offset:10240
v_cvt_pk_bf16_f32 v222, v188, v189
v_mfma_f32_16x16x32_bf16 a[28:31], a[252:255], v[208:211], a[28:31]
v_exp_f32 v191, v191
v_mfma_f32_16x16x32_bf16 v[136:139], a[128:131], v[48:51], v[88:91]
buffer_load_dwordx4 v1, s[44:47], s72 offen offset:2048 sc1 lds
v_mfma_f32_16x16x32_bf16 v[136:139], a[132:135], v[52:55], v[136:139]
v_exp_f32 v168, v168
v_mfma_f32_16x16x32_bf16 v[136:139], a[136:139], v[56:59], v[136:139]
ds_read_b128 a[236:239], v2 offset:11264
v_cvt_pk_bf16_f32 v223, v190, v191
v_mfma_f32_16x16x32_bf16 v[136:139], a[140:143], v[60:63], v[136:139]
v_exp_f32 v169, v169
v_mfma_f32_16x16x32_bf16 v[152:155], a[156:159], v[60:63], v[88:91]
ds_read_b128 a[240:243], v2 offset:12288
v_cvt_pk_bf16_f32 v216, v168, v169
v_mfma_f32_16x16x32_bf16 v[152:155], a[152:155], v[56:59], v[152:155]
v_exp_f32 v170, v170
v_mfma_f32_16x16x32_bf16 v[152:155], a[148:151], v[52:55], v[152:155]
v_exp_f32 v171, v171
v_mfma_f32_16x16x32_bf16 v[152:155], a[144:147], v[48:51], v[152:155]
ds_read_b128 a[244:247], v2 offset:13312
v_cvt_pk_bf16_f32 v217, v170, v171
v_mfma_f32_16x16x32_bf16 v[140:143], a[128:131], v[64:67], v[92:95]
v_exp_f32 v184, v184
v_mfma_f32_16x16x32_bf16 v[140:143], a[132:135], v[68:71], v[140:143]
ds_read_b128 a[248:251], v2 offset:14336
v_mfma_f32_16x16x32_bf16 v[140:143], a[136:139], v[72:75], v[140:143]
v_exp_f32 v185, v185
v_mfma_f32_16x16x32_bf16 v[140:143], a[140:143], v[76:79], v[140:143]
buffer_load_dwordx4 v1, s[44:47], s72 offen offset:3072 sc1 lds
v_mfma_f32_16x16x32_bf16 v[156:159], a[156:159], v[76:79], v[92:95]
ds_read_b128 a[252:255], v2 offset:15360
v_cvt_pk_bf16_f32 v218, v184, v185
v_mfma_f32_16x16x32_bf16 v[156:159], a[152:155], v[72:75], v[156:159]
v_exp_f32 v186, v186
v_mfma_f32_16x16x32_bf16 v[156:159], a[148:151], v[68:71], v[156:159]
s_waitcnt vmcnt(12) lgkmcnt(4)
v_exp_f32 v187, v187
v_mfma_f32_16x16x32_bf16 v[156:159], a[144:147], v[64:67], v[156:159]
s_barrier
v_cvt_pk_bf16_f32 v219, v186, v187
v_add_u32 v2, s82, v1
v_mfma_f32_16x16x32_bf16 v[228:231], v[120:123], v[196:199], v[228:231]
s_xor_b32 s74, s82, 0x10000
v_exp_f32 v136, v136
v_mfma_f32_16x16x32_bf16 v[228:231], v[120:123], v[212:215], v[228:231]
s_add_u32 s74, s74, s64
ds_read_b128 a[128:131], v2 offset:16384
v_add_u32 v5, s92, v5
v_mfma_f32_16x16x32_bf16 v[236:239], v[120:123], v[204:207], v[236:239]
s_add_u32 s81, s81, 0x8000
v_exp_f32 v137, v137
v_mfma_f32_16x16x32_bf16 v[236:239], v[120:123], v[220:223], v[236:239]
s_add_u32 m0, s74, 16384
ds_read_b128 a[132:135], v2 offset:17408
v_cvt_pk_bf16_f32 v200, v136, v137
v_mfma_f32_16x16x32_bf16 a[32:35], a[192:195], v[196:199], a[32:35]
s_add_u32 s72, s81, 16384
buffer_load_dwordx4 v1, s[44:47], s72 offen sc1 lds
v_mfma_f32_16x16x32_bf16 a[32:35], a[224:227], v[212:215], a[32:35]
s_add_u32 s69, s93, 0x4200000
v_exp_f32 v138, v138
v_mfma_f32_16x16x32_bf16 a[96:99], a[224:227], v[220:223], a[96:99]
ds_read_b128 a[136:139], v2 offset:18432
v_cndmask_b32 v5, v250, v5, vcc
v_mfma_f32_16x16x32_bf16 a[96:99], a[192:195], v[204:207], a[96:99]
v_exp_f32 v139, v139
v_mfma_f32_16x16x32_bf16 a[100:103], a[196:199], v[204:207], a[100:103]
ds_read_b128 a[140:143], v2 offset:19456
v_cvt_pk_bf16_f32 v201, v138, v139
v_mfma_f32_16x16x32_bf16 a[100:103], a[228:231], v[220:223], a[100:103]
buffer_store_dwordx4 v[112:115], v1, s[44:47], s69 offen sc1
v_mfma_f32_16x16x32_bf16 a[36:39], a[228:231], v[212:215], a[36:39]
v_exp_f32 v152, v152
v_mfma_f32_16x16x32_bf16 a[36:39], a[196:199], v[196:199], a[36:39]
ds_read_b128 a[144:147], v2 offset:20480
v_add_u32 v253, s58, v251
v_mfma_f32_16x16x32_bf16 a[40:43], a[200:203], v[196:199], a[40:43]
v_exp_f32 v153, v153
v_mfma_f32_16x16x32_bf16 a[40:43], a[232:235], v[212:215], a[40:43]
ds_read_b128 a[148:151], v2 offset:21504
v_cvt_pk_bf16_f32 v202, v152, v153
v_mfma_f32_16x16x32_bf16 a[104:107], a[232:235], v[220:223], a[104:107]
buffer_load_dwordx4 v1, s[44:47], s72 offen offset:1024 sc1 lds
v_mfma_f32_16x16x32_bf16 a[104:107], a[200:203], v[204:207], a[104:107]
v_exp_f32 v154, v154
v_mfma_f32_16x16x32_bf16 a[108:111], a[204:207], v[204:207], a[108:111]
ds_read_b128 a[152:155], v2 offset:22528
v_and_b32 v253, 3, v253
v_mfma_f32_16x16x32_bf16 a[108:111], a[236:239], v[220:223], a[108:111]
v_exp_f32 v155, v155
v_mfma_f32_16x16x32_bf16 a[44:47], a[236:239], v[212:215], a[44:47]
ds_read_b128 a[156:159], v2 offset:23552
v_cvt_pk_bf16_f32 v203, v154, v155
v_mfma_f32_16x16x32_bf16 a[44:47], a[204:207], v[196:199], a[44:47]
buffer_store_dwordx4 v[112:115], v1, s[44:47], s69 offen offset:1024 sc1
v_mfma_f32_16x16x32_bf16 a[48:51], a[208:211], v[196:199], a[48:51]
s_waitcnt lgkmcnt(8)
v_exp_f32 v140, v140
v_mfma_f32_16x16x32_bf16 a[48:51], a[240:243], v[212:215], a[48:51]
ds_read_b128 a[192:195], v2 offset:0
v_mul_u32_u24 v253, 4160, v253
v_mfma_f32_16x16x32_bf16 a[112:115], a[240:243], v[220:223], a[112:115]
v_exp_f32 v141, v141
v_mfma_f32_16x16x32_bf16 a[112:115], a[208:211], v[204:207], a[112:115]
ds_read_b128 a[196:199], v2 offset:1024
v_add_u32 v5, v5, v253
v_mfma_f32_16x16x32_bf16 a[116:119], a[212:215], v[204:207], a[116:119]
s_add_u32 s73, s62, 480
buffer_load_dwordx4 v1, s[44:47], s72 offen offset:2048 sc1 lds
v_mfma_f32_16x16x32_bf16 a[116:119], a[244:247], v[220:223], a[116:119]
v_exp_f32 v142, v142
v_mfma_f32_16x16x32_bf16 a[52:55], a[244:247], v[212:215], a[52:55]
ds_read_b128 a[200:203], v2 offset:2048
v_lshlrev_b32 v248, 5, v240
v_mfma_f32_16x16x32_bf16 a[52:55], a[212:215], v[196:199], a[52:55]
v_exp_f32 v143, v143
v_mfma_f32_16x16x32_bf16 a[56:59], a[216:219], v[196:199], a[56:59]
ds_read_b128 a[204:207], v2 offset:3072
v_sub_u32 v248, s73, v248
v_mfma_f32_16x16x32_bf16 a[56:59], a[248:251], v[212:215], a[56:59]
buffer_store_dwordx4 v[112:115], v1, s[44:47], s69 offen offset:2048 sc1
v_mfma_f32_16x16x32_bf16 a[120:123], a[248:251], v[220:223], a[120:123]
v_exp_f32 v156, v156
v_mfma_f32_16x16x32_bf16 a[120:123], a[216:219], v[204:207], a[120:123]
ds_read_b128 a[208:211], v2 offset:4096
v_lshl_add_u32 v7, v241, 4, v248
v_mfma_f32_16x16x32_bf16 a[124:127], a[220:223], v[204:207], a[124:127]
s_and_b32 s73, s58, 1
v_exp_f32 v157, v157
v_mfma_f32_16x16x32_bf16 a[124:127], a[252:255], v[220:223], a[124:127]
s_lshl_b32 s73, s73, 4
ds_read_b128 a[212:215], v2 offset:5120
v_mfma_f32_16x16x32_bf16 a[60:63], a[252:255], v[212:215], a[60:63]
s_lshr_b32 s73, s90, s73
buffer_load_dwordx4 v1, s[44:47], s72 offen offset:3072 sc1 lds
v_mfma_f32_16x16x32_bf16 a[60:63], a[220:223], v[196:199], a[60:63]
s_and_b32 s73, s73, 0xffff
ds_read_b128 a[216:219], v2 offset:6144
v_cvt_pk_bf16_f32 v204, v140, v141
v_mfma_f32_16x16x32_bf16 v[172:175], a[160:163], v[64:67], v[92:95]
v_exp_f32 v158, v158
v_mfma_f32_16x16x32_bf16 v[172:175], a[164:167], v[68:71], v[172:175]
ds_read_b128 a[220:223], v2 offset:7168
v_cvt_pk_bf16_f32 v205, v142, v143
v_mfma_f32_16x16x32_bf16 v[172:175], a[168:171], v[72:75], v[172:175]
v_exp_f32 v159, v159
v_mfma_f32_16x16x32_bf16 v[172:175], a[172:175], v[76:79], v[172:175]
buffer_store_dwordx4 v[112:115], v1, s[44:47], s69 offen offset:3072 sc1
v_mfma_f32_16x16x32_bf16 v[188:191], a[188:191], v[76:79], v[92:95]
v_cvt_pk_bf16_f32 v206, v156, v157
v_cvt_pk_bf16_f32 v207, v158, v159
v_mfma_f32_16x16x32_bf16 v[188:191], a[184:187], v[72:75], v[188:191]
v_lshl_add_u32 v248, v241, 3, v240
v_sub_u32 v248, 15, v248
v_mfma_f32_16x16x32_bf16 v[188:191], a[180:183], v[68:71], v[188:191]
v_and_b32 v249, 1, v248
v_lshlrev_b32 v249, 4, v249
v_mfma_f32_16x16x32_bf16 v[188:191], a[176:179], v[64:67], v[188:191]
v_lshlrev_b32 v249, v249, s73
v_lshrrev_b32 v248, 1, v248
v_mfma_f32_16x16x32_bf16 v[168:171], a[160:163], v[48:51], v[88:91]
v_and_b32 v241, 3, v0
v_cmp_eq_u32 vcc, 0, v248
v_mfma_f32_16x16x32_bf16 v[168:171], a[164:167], v[52:55], v[168:171]
v_lshl_add_u32 v5, v241, 3, v5
v_cndmask_b32 v8, 0, v249, vcc
v_mfma_f32_16x16x32_bf16 v[168:171], a[168:171], v[56:59], v[168:171]
v_cmp_eq_u32 vcc, 1, v248
v_lshlrev_b32 v240, 4, v251
v_mfma_f32_16x16x32_bf16 v[168:171], a[172:175], v[60:63], v[168:171]
v_cndmask_b32 v9, 0, v249, vcc
v_cmp_eq_u32 vcc, 2, v248
v_mfma_f32_16x16x32_bf16 v[184:187], a[188:191], v[60:63], v[88:91]
v_sub_u32 v240, 48, v240
v_lshlrev_b64 v[12:13], 16, s[88:89]
v_mfma_f32_16x16x32_bf16 v[184:187], a[184:187], v[56:59], v[184:187]
v_cndmask_b32 v10, 0, v249, vcc
v_cmp_eq_u32 vcc, 3, v248
v_mfma_f32_16x16x32_bf16 v[184:187], a[180:183], v[52:55], v[184:187]
v_lshlrev_b64 v[12:13], v240, v[12:13]
v_cndmask_b32 v11, 0, v249, vcc
v_mfma_f32_16x16x32_bf16 v[184:187], a[176:179], v[48:51], v[184:187]
s_waitcnt lgkmcnt(4)
v_cmp_eq_u32 vcc, 3, v241
s_add_u32 s73, s62, 4096
v_lshl_add_u32 v14, v0, 3, s73
v_cndmask_b32 v12, 0, v12, vcc
v_cndmask_b32 v13, 0, v13, vcc
v_lshrrev_b32 v15, 4, v0
v_lshlrev_b32 v15, 1, v15
v_and_b32 v240, 7, v0
v_xor_b32 v15, v15, v240
v_lshlrev_b32 v15, 4, v15
v_lshrrev_b32 v240, 3, v0
v_lshl_add_u32 v15, v240, 11, v15
s_lshl_b32 s75, s59, 1
s_andn2_b32 s75, 8, s75
s_add_u32 s75, s75, s60
s_lshl_b32 s76, s65, 2
s_lshr_b32 s80, s59, 3
s_add_u32 s76, s76, s80
s_lshl_b32 s94, s58, 16
s_lshl_b32 s80, s76, 7
s_add_u32 s94, s94, s80
s_lshl_b32 s80, s75, 18
s_add_u32 s80, s80, s94
v_rcp_f32 v226, v224
v_rcp_f32 v230, v228
s_lshl_b32 s73, s52, 12
s_add_u32 s73, s73, 0x2000000
s_lshl_b32 s70, s67, 2
s_add_u32 s70, s70, s73
v_or_b32 v3, s53, v1
v_mov_b32 v227, v226
v_accvgpr_read_b32 v240, a0
v_accvgpr_read_b32 v241, a1
v_accvgpr_read_b32 v242, a2
v_accvgpr_read_b32 v243, a3
v_accvgpr_read_b32 v244, a4
v_accvgpr_read_b32 v245, a5
v_accvgpr_read_b32 v246, a6
v_accvgpr_read_b32 v247, a7
v_pk_mul_f32 v[240:241], v[240:241], v[226:227]
v_pk_mul_f32 v[242:243], v[242:243], v[226:227]
v_pk_mul_f32 v[244:245], v[244:245], v[226:227]
v_pk_mul_f32 v[246:247], v[246:247], v[226:227]
v_cvt_pk_bf16_f32 v128, v240, v241
v_cvt_pk_bf16_f32 v129, v242, v243
v_cvt_pk_bf16_f32 v130, v244, v245
v_cvt_pk_bf16_f32 v131, v246, v247
v_accvgpr_read_b32 v248, a8
v_accvgpr_read_b32 v249, a9
v_accvgpr_read_b32 v250, a10
v_accvgpr_read_b32 v251, a11
v_accvgpr_read_b32 v252, a12
v_accvgpr_read_b32 v253, a13
v_accvgpr_read_b32 v254, a14
v_accvgpr_read_b32 v255, a15
v_pk_mul_f32 v[248:249], v[248:249], v[226:227]
v_pk_mul_f32 v[250:251], v[250:251], v[226:227]
v_pk_mul_f32 v[252:253], v[252:253], v[226:227]
v_pk_mul_f32 v[254:255], v[254:255], v[226:227]
v_cvt_pk_bf16_f32 v144, v248, v249
v_cvt_pk_bf16_f32 v145, v250, v251
v_cvt_pk_bf16_f32 v146, v252, v253
v_cvt_pk_bf16_f32 v147, v254, v255
v_accvgpr_read_b32 v240, a16
v_accvgpr_read_b32 v241, a17
v_accvgpr_read_b32 v242, a18
v_accvgpr_read_b32 v243, a19
v_accvgpr_read_b32 v244, a20
v_accvgpr_read_b32 v245, a21
v_accvgpr_read_b32 v246, a22
v_accvgpr_read_b32 v247, a23
v_pk_mul_f32 v[240:241], v[240:241], v[226:227]
v_pk_mul_f32 v[242:243], v[242:243], v[226:227]
v_pk_mul_f32 v[244:245], v[244:245], v[226:227]
v_pk_mul_f32 v[246:247], v[246:247], v[226:227]
v_cvt_pk_bf16_f32 v160, v240, v241
v_cvt_pk_bf16_f32 v161, v242, v243
v_cvt_pk_bf16_f32 v162, v244, v245
v_cvt_pk_bf16_f32 v163, v246, v247
v_accvgpr_read_b32 v248, a24
v_accvgpr_read_b32 v249, a25
v_accvgpr_read_b32 v250, a26
v_accvgpr_read_b32 v251, a27
v_accvgpr_read_b32 v252, a28
v_accvgpr_read_b32 v253, a29
v_accvgpr_read_b32 v254, a30
v_accvgpr_read_b32 v255, a31
v_pk_mul_f32 v[248:249], v[248:249], v[226:227]
v_pk_mul_f32 v[250:251], v[250:251], v[226:227]
v_pk_mul_f32 v[252:253], v[252:253], v[226:227]
v_pk_mul_f32 v[254:255], v[254:255], v[226:227]
v_cvt_pk_bf16_f32 v176, v248, v249
v_cvt_pk_bf16_f32 v177, v250, v251
v_cvt_pk_bf16_f32 v178, v252, v253
v_cvt_pk_bf16_f32 v179, v254, v255
v_mov_b32 v231, v230
v_accvgpr_read_b32 v240, a32
v_accvgpr_read_b32 v241, a33
v_accvgpr_read_b32 v242, a34
v_accvgpr_read_b32 v243, a35
v_accvgpr_read_b32 v244, a36
v_accvgpr_read_b32 v245, a37
v_accvgpr_read_b32 v246, a38
v_accvgpr_read_b32 v247, a39
v_pk_mul_f32 v[240:241], v[240:241], v[230:231]
v_pk_mul_f32 v[242:243], v[242:243], v[230:231]
v_pk_mul_f32 v[244:245], v[244:245], v[230:231]
v_pk_mul_f32 v[246:247], v[246:247], v[230:231]
v_cvt_pk_bf16_f32 v132, v240, v241
v_cvt_pk_bf16_f32 v133, v242, v243
v_cvt_pk_bf16_f32 v134, v244, v245
v_cvt_pk_bf16_f32 v135, v246, v247
v_accvgpr_read_b32 v248, a40
v_accvgpr_read_b32 v249, a41
v_accvgpr_read_b32 v250, a42
v_accvgpr_read_b32 v251, a43
v_accvgpr_read_b32 v252, a44
v_accvgpr_read_b32 v253, a45
v_accvgpr_read_b32 v254, a46
v_accvgpr_read_b32 v255, a47
v_pk_mul_f32 v[248:249], v[248:249], v[230:231]
v_pk_mul_f32 v[250:251], v[250:251], v[230:231]
v_pk_mul_f32 v[252:253], v[252:253], v[230:231]
v_pk_mul_f32 v[254:255], v[254:255], v[230:231]
v_cvt_pk_bf16_f32 v148, v248, v249
v_cvt_pk_bf16_f32 v149, v250, v251
v_cvt_pk_bf16_f32 v150, v252, v253
v_cvt_pk_bf16_f32 v151, v254, v255
v_accvgpr_read_b32 v240, a48
v_accvgpr_read_b32 v241, a49
v_accvgpr_read_b32 v242, a50
v_accvgpr_read_b32 v243, a51
v_accvgpr_read_b32 v244, a52
v_accvgpr_read_b32 v245, a53
v_accvgpr_read_b32 v246, a54
v_accvgpr_read_b32 v247, a55
v_pk_mul_f32 v[240:241], v[240:241], v[230:231]
v_pk_mul_f32 v[242:243], v[242:243], v[230:231]
v_pk_mul_f32 v[244:245], v[244:245], v[230:231]
v_pk_mul_f32 v[246:247], v[246:247], v[230:231]
v_cvt_pk_bf16_f32 v164, v240, v241
v_cvt_pk_bf16_f32 v165, v242, v243
v_cvt_pk_bf16_f32 v166, v244, v245
v_cvt_pk_bf16_f32 v167, v246, v247
v_accvgpr_read_b32 v248, a56
v_accvgpr_read_b32 v249, a57
v_accvgpr_read_b32 v250, a58
v_accvgpr_read_b32 v251, a59
v_accvgpr_read_b32 v252, a60
v_accvgpr_read_b32 v253, a61
v_accvgpr_read_b32 v254, a62
v_accvgpr_read_b32 v255, a63
v_pk_mul_f32 v[248:249], v[248:249], v[230:231]
v_pk_mul_f32 v[250:251], v[250:251], v[230:231]
v_pk_mul_f32 v[252:253], v[252:253], v[230:231]
v_pk_mul_f32 v[254:255], v[254:255], v[230:231]
v_cvt_pk_bf16_f32 v180, v248, v249
v_cvt_pk_bf16_f32 v181, v250, v251
v_cvt_pk_bf16_f32 v182, v252, v253
v_cvt_pk_bf16_f32 v183, v254, v255
v_mfma_f32_16x16x32_bf16 v[232:235], v[120:123], v[216:219], v[232:235]
s_add_u32 s82, s82, 0x8000
ds_read_b128 a[160:163], v2 offset:24576
ds_read_b128 a[164:167], v2 offset:25600
v_mfma_f32_16x16x32_bf16 v[232:235], v[120:123], v[200:203], v[232:235]
s_and_b32 s82, s82, 0x1ffff
v_exp_f32 v172, v172
v_mfma_f32_16x16x32_bf16 a[64:67], a[224:227], v[216:219], a[64:67]
s_add_u32 m0, s74, 0
v_exp_f32 v173, v173
v_mfma_f32_16x16x32_bf16 a[64:67], a[192:195], v[200:203], a[64:67]
s_add_u32 s72, s81, 0
buffer_load_dwordx4 v1, s[44:47], s72 offen sc1 lds
v_mfma_f32_16x16x32_bf16 a[68:71], a[196:199], v[200:203], a[68:71]
ds_read_b128 a[168:171], v2 offset:26624
v_cvt_pk_bf16_f32 v220, v172, v173
v_mfma_f32_16x16x32_bf16 a[68:71], a[228:231], v[216:219], a[68:71]
v_exp_f32 v174, v174
v_mfma_f32_16x16x32_bf16 a[72:75], a[232:235], v[216:219], a[72:75]
s_nop 0
ds_read_b128 a[172:175], v2 offset:27648
ds_read_b128 a[176:179], v2 offset:28672
v_mfma_f32_16x16x32_bf16 a[72:75], a[200:203], v[200:203], a[72:75]
v_exp_f32 v175, v175
v_mfma_f32_16x16x32_bf16 a[76:79], a[204:207], v[200:203], a[76:79]
v_exp_f32 v188, v188
v_mfma_f32_16x16x32_bf16 a[76:79], a[236:239], v[216:219], a[76:79]
buffer_store_dwordx4 v[128:131], v3, s[44:47], s70 offen sc1
v_mfma_f32_16x16x32_bf16 a[80:83], a[240:243], v[216:219], a[80:83]
s_waitcnt lgkmcnt(5)
ds_read_b128 a[180:183], v2 offset:29696
v_cvt_pk_bf16_f32 v221, v174, v175
v_mfma_f32_16x16x32_bf16 a[80:83], a[208:211], v[200:203], a[80:83]
v_exp_f32 v189, v189
v_mfma_f32_16x16x32_bf16 a[84:87], a[212:215], v[200:203], a[84:87]
ds_read_b128 a[184:187], v2 offset:30720
v_cvt_pk_bf16_f32 v222, v188, v189
v_mfma_f32_16x16x32_bf16 a[84:87], a[244:247], v[216:219], a[84:87]
v_exp_f32 v190, v190
v_mfma_f32_16x16x32_bf16 a[88:91], a[248:251], v[216:219], a[88:91]
buffer_load_dwordx4 v1, s[44:47], s72 offen offset:1024 sc1 lds
v_mfma_f32_16x16x32_bf16 a[88:91], a[216:219], v[200:203], a[88:91]
s_nop 0
ds_read_b128 a[188:191], v2 offset:31744
ds_read_b128 a[224:227], v2 offset:8192
v_mfma_f32_16x16x32_bf16 a[92:95], a[220:223], v[200:203], a[92:95]
v_exp_f32 v191, v191
v_mfma_f32_16x16x32_bf16 a[92:95], a[252:255], v[216:219], a[92:95]
v_exp_f32 v168, v168
v_mfma_f32_16x16x32_bf16 v[136:139], a[128:131], v[48:51], v[88:91]
ds_read_b128 a[228:231], v2 offset:9216
v_cvt_pk_bf16_f32 v223, v190, v191
v_mfma_f32_16x16x32_bf16 v[136:139], a[132:135], v[52:55], v[136:139]
v_exp_f32 v169, v169
v_mfma_f32_16x16x32_bf16 v[136:139], a[136:139], v[56:59], v[136:139]
buffer_store_dwordx4 v[144:147], v3, s[44:47], s70 offen offset:1024 sc1
v_mfma_f32_16x16x32_bf16 v[136:139], a[140:143], v[60:63], v[136:139]
ds_read_b128 a[232:235], v2 offset:10240
v_cvt_pk_bf16_f32 v216, v168, v169
v_mfma_f32_16x16x32_bf16 v[152:155], a[156:159], v[60:63], v[88:91]
v_exp_f32 v170, v170
v_mfma_f32_16x16x32_bf16 v[152:155], a[152:155], v[56:59], v[152:155]
s_nop 0
ds_read_b128 a[236:239], v2 offset:11264
ds_read_b128 a[240:243], v2 offset:12288
v_mfma_f32_16x16x32_bf16 v[152:155], a[148:151], v[52:55], v[152:155]
v_exp_f32 v171, v171
v_mfma_f32_16x16x32_bf16 v[152:155], a[144:147], v[48:51], v[152:155]
buffer_load_dwordx4 v1, s[44:47], s72 offen offset:2048 sc1 lds
v_mfma_f32_16x16x32_bf16 v[140:143], a[128:131], v[64:67], v[92:95]
v_exp_f32 v184, v184
v_mfma_f32_16x16x32_bf16 v[140:143], a[132:135], v[68:71], v[140:143]
ds_read_b128 a[244:247], v2 offset:13312
v_cvt_pk_bf16_f32 v217, v170, v171
v_mfma_f32_16x16x32_bf16 v[140:143], a[136:139], v[72:75], v[140:143]
v_exp_f32 v185, v185
v_mfma_f32_16x16x32_bf16 v[140:143], a[140:143], v[76:79], v[140:143]
s_nop 0
ds_read_b128 a[248:251], v2 offset:14336
ds_read_b128 a[252:255], v2 offset:15360
v_mfma_f32_16x16x32_bf16 v[156:159], a[156:159], v[76:79], v[92:95]
v_exp_f32 v186, v186
v_mfma_f32_16x16x32_bf16 v[156:159], a[152:155], v[72:75], v[156:159]
buffer_load_dwordx4 v1, s[44:47], s72 offen offset:3072 sc1 lds
v_mfma_f32_16x16x32_bf16 v[156:159], a[148:151], v[68:71], v[156:159]
s_waitcnt vmcnt(14) lgkmcnt(4)
v_exp_f32 v187, v187
v_mfma_f32_16x16x32_bf16 v[156:159], a[144:147], v[64:67], v[156:159]
s_barrier
v_cvt_pk_bf16_f32 v218, v184, v185
v_cvt_pk_bf16_f32 v219, v186, v187
v_add_u32 v2, s82, v1
v_mfma_f32_16x16x32_bf16 v[236:239], v[120:123], v[204:207], v[236:239]
s_xor_b32 s74, s82, 0x10000
v_exp_f32 v136, v136
v_mfma_f32_16x16x32_bf16 v[236:239], v[120:123], v[220:223], v[236:239]
s_add_u32 s74, s74, s64
ds_read_b128 a[128:131], v2 offset:16384
ds_read_b128 a[132:135], v2 offset:17408
v_mfma_f32_16x16x32_bf16 a[96:99], a[192:195], v[204:207], a[96:99]
s_add_u32 s81, s81, 0x8000
v_exp_f32 v137, v137
v_mfma_f32_16x16x32_bf16 a[96:99], a[224:227], v[220:223], a[96:99]
s_add_u32 m0, s74, 16384
v_exp_f32 v138, v138
v_mfma_f32_16x16x32_bf16 a[100:103], a[228:231], v[220:223], a[100:103]
s_add_u32 s72, s81, 16384
buffer_load_dwordx4 v1, s[44:47], s72 offen sc1 lds
v_mfma_f32_16x16x32_bf16 a[100:103], a[196:199], v[204:207], a[100:103]
ds_read_b128 a[136:139], v2 offset:18432
v_cvt_pk_bf16_f32 v200, v136, v137
v_mfma_f32_16x16x32_bf16 a[104:107], a[200:203], v[204:207], a[104:107]
v_exp_f32 v139, v139
v_mfma_f32_16x16x32_bf16 a[104:107], a[232:235], v[220:223], a[104:107]
ds_read_b128 a[140:143], v2 offset:19456
v_cvt_pk_bf16_f32 v201, v138, v139
v_mfma_f32_16x16x32_bf16 a[108:111], a[236:239], v[220:223], a[108:111]
buffer_store_dwordx4 v[160:163], v3, s[44:47], s70 offen offset:2048 sc1
v_mfma_f32_16x16x32_bf16 a[108:111], a[204:207], v[204:207], a[108:111]
v_exp_f32 v152, v152
v_mfma_f32_16x16x32_bf16 a[112:115], a[208:211], v[204:207], a[112:115]
s_waitcnt lgkmcnt(4)
ds_read_b128 a[144:147], v2 offset:20480
ds_read_b128 a[148:151], v2 offset:21504
v_mfma_f32_16x16x32_bf16 a[112:115], a[240:243], v[220:223], a[112:115]
v_exp_f32 v153, v153
v_mfma_f32_16x16x32_bf16 a[116:119], a[244:247], v[220:223], a[116:119]
buffer_load_dwordx4 v1, s[44:47], s72 offen offset:1024 sc1 lds
v_mfma_f32_16x16x32_bf16 a[116:119], a[212:215], v[204:207], a[116:119]
v_exp_f32 v154, v154
v_mfma_f32_16x16x32_bf16 a[120:123], a[216:219], v[204:207], a[120:123]
ds_read_b128 a[152:155], v2 offset:22528
v_cvt_pk_bf16_f32 v202, v152, v153
v_mfma_f32_16x16x32_bf16 a[120:123], a[248:251], v[220:223], a[120:123]
v_exp_f32 v155, v155
v_mfma_f32_16x16x32_bf16 a[124:127], a[252:255], v[220:223], a[124:127]
ds_read_b128 a[156:159], v2 offset:23552
v_cvt_pk_bf16_f32 v203, v154, v155
v_mfma_f32_16x16x32_bf16 a[124:127], a[220:223], v[204:207], a[124:127]
v_exp_f32 v140, v140
v_mfma_f32_16x16x32_bf16 v[172:175], a[160:163], v[64:67], v[92:95]
s_nop 0
ds_read_b128 a[192:195], v2 offset:0
ds_read_b128 a[196:199], v2 offset:1024
v_mfma_f32_16x16x32_bf16 v[172:175], a[164:167], v[68:71], v[172:175]
buffer_store_dwordx4 v[176:179], v3, s[44:47], s70 offen offset:3072 sc1
v_mfma_f32_16x16x32_bf16 v[172:175], a[168:171], v[72:75], v[172:175]
v_exp_f32 v141, v141
v_mfma_f32_16x16x32_bf16 v[172:175], a[172:175], v[76:79], v[172:175]
v_exp_f32 v142, v142
v_mfma_f32_16x16x32_bf16 v[188:191], a[188:191], v[76:79], v[92:95]
s_nop 0
ds_read_b128 a[200:203], v2 offset:2048
ds_read_b128 a[204:207], v2 offset:3072
v_mfma_f32_16x16x32_bf16 v[188:191], a[184:187], v[72:75], v[188:191]
buffer_load_dwordx4 v1, s[44:47], s72 offen offset:2048 sc1 lds
v_mfma_f32_16x16x32_bf16 v[188:191], a[180:183], v[68:71], v[188:191]
s_add_u32 s70, s70, 0x80000
v_exp_f32 v143, v143
v_mfma_f32_16x16x32_bf16 v[188:191], a[176:179], v[64:67], v[188:191]
v_exp_f32 v156, v156
v_mfma_f32_16x16x32_bf16 v[168:171], a[160:163], v[48:51], v[88:91]
s_nop 0
ds_read_b128 a[208:211], v2 offset:4096
ds_read_b128 a[212:215], v2 offset:5120
v_mfma_f32_16x16x32_bf16 v[168:171], a[164:167], v[52:55], v[168:171]
s_nop 0
ds_read_b128 a[216:219], v2 offset:6144
ds_read_b128 a[220:223], v2 offset:7168
v_mfma_f32_16x16x32_bf16 v[168:171], a[168:171], v[56:59], v[168:171]
v_cvt_pk_bf16_f32 v204, v140, v141
v_cvt_pk_bf16_f32 v205, v142, v143
v_mfma_f32_16x16x32_bf16 v[168:171], a[172:175], v[60:63], v[168:171]
buffer_store_dwordx4 v[132:135], v3, s[44:47], s70 offen sc1
v_mfma_f32_16x16x32_bf16 v[184:187], a[188:191], v[60:63], v[88:91]
v_exp_f32 v157, v157
v_mfma_f32_16x16x32_bf16 v[184:187], a[184:187], v[56:59], v[184:187]
v_exp_f32 v158, v158
v_mfma_f32_16x16x32_bf16 v[184:187], a[180:183], v[52:55], v[184:187]
buffer_load_dwordx4 v1, s[44:47], s72 offen offset:3072 sc1 lds
v_mfma_f32_16x16x32_bf16 v[184:187], a[176:179], v[48:51], v[184:187]
s_waitcnt lgkmcnt(4)
v_exp_f32 v159, v159
v_cvt_pk_bf16_f32 v206, v156, v157
v_cvt_pk_bf16_f32 v207, v158, v159
v_mfma_f32_16x16x32_bf16 v[232:235], v[120:123], v[216:219], v[232:235]
s_add_u32 s82, s82, 0x8000
ds_read_b128 a[160:163], v2 offset:24576
ds_read_b128 a[164:167], v2 offset:25600
v_mfma_f32_16x16x32_bf16 v[232:235], v[120:123], v[200:203], v[232:235]
s_and_b32 s82, s82, 0x1ffff
v_exp_f32 v172, v172
v_mfma_f32_16x16x32_bf16 a[64:67], a[224:227], v[216:219], a[64:67]
s_add_u32 m0, s74, 0
v_exp_f32 v173, v173
v_mfma_f32_16x16x32_bf16 a[64:67], a[192:195], v[200:203], a[64:67]
s_add_u32 s72, s81, 0
buffer_load_dwordx4 v1, s[44:47], s72 offen sc1 lds
v_mfma_f32_16x16x32_bf16 a[68:71], a[196:199], v[200:203], a[68:71]
ds_read_b128 a[168:171], v2 offset:26624
v_cvt_pk_bf16_f32 v220, v172, v173
v_mfma_f32_16x16x32_bf16 a[68:71], a[228:231], v[216:219], a[68:71]
v_exp_f32 v174, v174
v_mfma_f32_16x16x32_bf16 a[72:75], a[232:235], v[216:219], a[72:75]
s_nop 0
ds_read_b128 a[172:175], v2 offset:27648
ds_read_b128 a[176:179], v2 offset:28672
v_mfma_f32_16x16x32_bf16 a[72:75], a[200:203], v[200:203], a[72:75]
v_exp_f32 v175, v175
v_mfma_f32_16x16x32_bf16 a[76:79], a[204:207], v[200:203], a[76:79]
buffer_store_dwordx4 v[148:151], v3, s[44:47], s70 offen offset:1024 sc1
v_mfma_f32_16x16x32_bf16 a[76:79], a[236:239], v[216:219], a[76:79]
v_exp_f32 v188, v188
v_mfma_f32_16x16x32_bf16 a[80:83], a[240:243], v[216:219], a[80:83]
s_waitcnt lgkmcnt(5)
ds_read_b128 a[180:183], v2 offset:29696
v_cvt_pk_bf16_f32 v221, v174, v175
v_mfma_f32_16x16x32_bf16 a[80:83], a[208:211], v[200:203], a[80:83]
v_exp_f32 v189, v189
v_mfma_f32_16x16x32_bf16 a[84:87], a[212:215], v[200:203], a[84:87]
buffer_load_dwordx4 v1, s[44:47], s72 offen offset:1024 sc1 lds
v_mfma_f32_16x16x32_bf16 a[84:87], a[244:247], v[216:219], a[84:87]
ds_read_b128 a[184:187], v2 offset:30720
v_cvt_pk_bf16_f32 v222, v188, v189
v_mfma_f32_16x16x32_bf16 a[88:91], a[248:251], v[216:219], a[88:91]
v_exp_f32 v190, v190
v_mfma_f32_16x16x32_bf16 a[88:91], a[216:219], v[200:203], a[88:91]
s_nop 0
ds_read_b128 a[188:191], v2 offset:31744
ds_read_b128 a[224:227], v2 offset:8192
v_mfma_f32_16x16x32_bf16 a[92:95], a[220:223], v[200:203], a[92:95]
v_exp_f32 v191, v191
v_mfma_f32_16x16x32_bf16 a[92:95], a[252:255], v[216:219], a[92:95]
buffer_store_dwordx4 v[164:167], v3, s[44:47], s70 offen offset:2048 sc1
v_mfma_f32_16x16x32_bf16 v[136:139], a[128:131], v[48:51], v[88:91]
v_exp_f32 v168, v168
v_mfma_f32_16x16x32_bf16 v[136:139], a[132:135], v[52:55], v[136:139]
ds_read_b128 a[228:231], v2 offset:9216
v_cvt_pk_bf16_f32 v223, v190, v191
v_mfma_f32_16x16x32_bf16 v[136:139], a[136:139], v[56:59], v[136:139]
Lstub6:
s_cbranch_execz Lstub10
v_exp_f32 v169, v169
v_mfma_f32_16x16x32_bf16 v[136:139], a[140:143], v[60:63], v[136:139]
s_nop 0
ds_read_b128 a[232:235], v2 offset:10240
ds_read_b128 a[236:239], v2 offset:11264
v_mfma_f32_16x16x32_bf16 v[152:155], a[156:159], v[60:63], v[88:91]
v_exp_f32 v170, v170
v_mfma_f32_16x16x32_bf16 v[152:155], a[152:155], v[56:59], v[152:155]
buffer_load_dwordx4 v1, s[44:47], s72 offen offset:2048 sc1 lds
v_mfma_f32_16x16x32_bf16 v[152:155], a[148:151], v[52:55], v[152:155]
v_exp_f32 v171, v171
v_mfma_f32_16x16x32_bf16 v[152:155], a[144:147], v[48:51], v[152:155]
s_nop 0
ds_read_b128 a[240:243], v2 offset:12288
ds_read_b128 a[244:247], v2 offset:13312
v_mfma_f32_16x16x32_bf16 v[140:143], a[128:131], v[64:67], v[92:95]
v_exp_f32 v184, v184
v_mfma_f32_16x16x32_bf16 v[140:143], a[132:135], v[68:71], v[140:143]
s_nop 0
ds_read_b128 a[248:251], v2 offset:14336
ds_read_b128 a[252:255], v2 offset:15360
v_mfma_f32_16x16x32_bf16 v[140:143], a[136:139], v[72:75], v[140:143]
v_cvt_pk_bf16_f32 v216, v168, v169
v_cvt_pk_bf16_f32 v217, v170, v171
v_mfma_f32_16x16x32_bf16 v[140:143], a[140:143], v[76:79], v[140:143]
buffer_store_dwordx4 v[180:183], v3, s[44:47], s70 offen offset:3072 sc1
v_mfma_f32_16x16x32_bf16 v[156:159], a[156:159], v[76:79], v[92:95]
v_exp_f32 v185, v185
v_mfma_f32_16x16x32_bf16 v[156:159], a[152:155], v[72:75], v[156:159]
buffer_load_dwordx4 v1, s[44:47], s72 offen offset:3072 sc1 lds
v_mfma_f32_16x16x32_bf16 v[156:159], a[148:151], v[68:71], v[156:159]
s_waitcnt vmcnt(14) lgkmcnt(4)
v_exp_f32 v186, v186
v_mfma_f32_16x16x32_bf16 v[156:159], a[144:147], v[64:67], v[156:159]
s_barrier
v_exp_f32 v187, v187
v_add_u32 v2, s82, v1
v_cvt_pk_bf16_f32 v218, v184, v185
v_cvt_pk_bf16_f32 v219, v186, v187
s_lshl_b32 s83, s60, 2
s_sub_u32 s83, s83, 25
.p2align 5
s_nop 0
s_nop 0
LloopII:
v_mfma_f32_16x16x32_bf16 v[236:239], v[120:123], v[204:207], v[236:239]
s_xor_b32 s74, s82, 0x10000
v_exp_f32 v136, v136
v_mfma_f32_16x16x32_bf16 v[236:239], v[120:123], v[220:223], v[236:239]
s_add_u32 s74, s74, s64
ds_read_b128 a[128:131], v2 offset:16384
ds_read_b128 a[132:135], v2 offset:17408
v_mfma_f32_16x16x32_bf16 a[96:99], a[192:195], v[204:207], a[96:99]
s_add_u32 s81, s81, 0x8000
v_exp_f32 v137, v137
v_mfma_f32_16x16x32_bf16 a[96:99], a[224:227], v[220:223], a[96:99]
s_add_u32 m0, s74, 16384
v_exp_f32 v138, v138
v_mfma_f32_16x16x32_bf16 a[100:103], a[228:231], v[220:223], a[100:103]
s_add_u32 s72, s81, 16384
ds_read_b128 a[136:139], v2 offset:18432
v_cvt_pk_bf16_f32 v200, v136, v137
v_mfma_f32_16x16x32_bf16 a[100:103], a[196:199], v[204:207], a[100:103]
buffer_load_dwordx4 v1, s[44:47], s72 offen sc1 lds
v_mfma_f32_16x16x32_bf16 a[104:107], a[200:203], v[204:207], a[104:107]
v_exp_f32 v139, v139
v_mfma_f32_16x16x32_bf16 a[104:107], a[232:235], v[220:223], a[104:107]
ds_read_b128 a[140:143], v2 offset:19456
v_cvt_pk_bf16_f32 v201, v138, v139
v_mfma_f32_16x16x32_bf16 a[108:111], a[236:239], v[220:223], a[108:111]
v_exp_f32 v152, v152
v_mfma_f32_16x16x32_bf16 a[108:111], a[204:207], v[204:207], a[108:111]
s_nop 0
ds_read_b128 a[144:147], v2 offset:20480
ds_read_b128 a[148:151], v2 offset:21504
v_mfma_f32_16x16x32_bf16 a[112:115], a[208:211], v[204:207], a[112:115]
s_waitcnt lgkmcnt(6)
v_exp_f32 v153, v153
v_mfma_f32_16x16x32_bf16 a[112:115], a[240:243], v[220:223], a[112:115]
v_exp_f32 v154, v154
v_mfma_f32_16x16x32_bf16 a[116:119], a[244:247], v[220:223], a[116:119]
ds_read_b128 a[152:155], v2 offset:22528
v_cvt_pk_bf16_f32 v202, v152, v153
v_mfma_f32_16x16x32_bf16 a[116:119], a[212:215], v[204:207], a[116:119]
buffer_load_dwordx4 v1, s[44:47], s72 offen offset:1024 sc1 lds
v_mfma_f32_16x16x32_bf16 a[120:123], a[216:219], v[204:207], a[120:123]
v_exp_f32 v155, v155
v_mfma_f32_16x16x32_bf16 a[120:123], a[248:251], v[220:223], a[120:123]
ds_read_b128 a[156:159], v2 offset:23552
v_cvt_pk_bf16_f32 v203, v154, v155
v_mfma_f32_16x16x32_bf16 a[124:127], a[252:255], v[220:223], a[124:127]
v_exp_f32 v140, v140
v_mfma_f32_16x16x32_bf16 a[124:127], a[220:223], v[204:207], a[124:127]
s_nop 0
ds_read_b128 a[192:195], v2 offset:0
ds_read_b128 a[196:199], v2 offset:1024
v_mfma_f32_16x16x32_bf16 v[172:175], a[160:163], v[64:67], v[92:95]
v_exp_f32 v141, v141
v_mfma_f32_16x16x32_bf16 v[172:175], a[164:167], v[68:71], v[172:175]
v_exp_f32 v142, v142
v_mfma_f32_16x16x32_bf16 v[172:175], a[168:171], v[72:75], v[172:175]
ds_read_b128 a[200:203], v2 offset:2048
v_cvt_pk_bf16_f32 v204, v140, v141
v_mfma_f32_16x16x32_bf16 v[172:175], a[172:175], v[76:79], v[172:175]
buffer_load_dwordx4 v1, s[44:47], s72 offen offset:2048 sc1 lds
v_mfma_f32_16x16x32_bf16 v[188:191], a[188:191], v[76:79], v[92:95]
v_exp_f32 v143, v143
v_mfma_f32_16x16x32_bf16 v[188:191], a[184:187], v[72:75], v[188:191]
ds_read_b128 a[204:207], v2 offset:3072
v_cvt_pk_bf16_f32 v205, v142, v143
v_mfma_f32_16x16x32_bf16 v[188:191], a[180:183], v[68:71], v[188:191]
v_exp_f32 v156, v156
v_mfma_f32_16x16x32_bf16 v[188:191], a[176:179], v[64:67], v[188:191]
ds_read_b128 a[208:211], v2 offset:4096
v_mfma_f32_16x16x32_bf16 v[168:171], a[160:163], v[48:51], v[88:91]
v_exp_f32 v157, v157
v_mfma_f32_16x16x32_bf16 v[168:171], a[164:167], v[52:55], v[168:171]
ds_read_b128 a[212:215], v2 offset:5120
v_cvt_pk_bf16_f32 v206, v156, v157
v_mfma_f32_16x16x32_bf16 v[168:171], a[168:171], v[56:59], v[168:171]
v_exp_f32 v158, v158
v_mfma_f32_16x16x32_bf16 v[168:171], a[172:175], v[60:63], v[168:171]
ds_read_b128 a[216:219], v2 offset:6144
v_mfma_f32_16x16x32_bf16 v[184:187], a[188:191], v[60:63], v[88:91]
buffer_load_dwordx4 v1, s[44:47], s72 offen offset:3072 sc1 lds
v_mfma_f32_16x16x32_bf16 v[184:187], a[184:187], v[56:59], v[184:187]
v_exp_f32 v159, v159
v_mfma_f32_16x16x32_bf16 v[184:187], a[180:183], v[52:55], v[184:187]
ds_read_b128 a[220:223], v2 offset:7168
v_cvt_pk_bf16_f32 v207, v158, v159
v_mfma_f32_16x16x32_bf16 v[184:187], a[176:179], v[48:51], v[184:187]
s_waitcnt lgkmcnt(4)
v_mfma_f32_16x16x32_bf16 v[232:235], v[120:123], v[216:219], v[232:235]
s_add_u32 s82, s82, 0x8000
ds_read_b128 a[160:163], v2 offset:24576
ds_read_b128 a[164:167], v2 offset:25600
v_mfma_f32_16x16x32_bf16 v[232:235], v[120:123], v[200:203], v[232:235]
s_and_b32 s82, s82, 0x1ffff
v_exp_f32 v172, v172
v_mfma_f32_16x16x32_bf16 a[64:67], a[224:227], v[216:219], a[64:67]
s_add_u32 m0, s74, 0
v_exp_f32 v173, v173
v_mfma_f32_16x16x32_bf16 a[64:67], a[192:195], v[200:203], a[64:67]
s_add_u32 s72, s81, 0
ds_read_b128 a[168:171], v2 offset:26624
v_cvt_pk_bf16_f32 v220, v172, v173
v_mfma_f32_16x16x32_bf16 a[68:71], a[196:199], v[200:203], a[68:71]
v_exp_f32 v174, v174
v_mfma_f32_16x16x32_bf16 a[68:71], a[228:231], v[216:219], a[68:71]
buffer_load_dwordx4 v1, s[44:47], s72 offen sc1 lds
v_mfma_f32_16x16x32_bf16 a[72:75], a[232:235], v[216:219], a[72:75]
s_nop 0
ds_read_b128 a[172:175], v2 offset:27648
ds_read_b128 a[176:179], v2 offset:28672
v_mfma_f32_16x16x32_bf16 a[72:75], a[200:203], v[200:203], a[72:75]
v_exp_f32 v175, v175
v_mfma_f32_16x16x32_bf16 a[76:79], a[204:207], v[200:203], a[76:79]
v_exp_f32 v188, v188
v_mfma_f32_16x16x32_bf16 a[76:79], a[236:239], v[216:219], a[76:79]
ds_read_b128 a[180:183], v2 offset:29696
v_cvt_pk_bf16_f32 v221, v174, v175
v_mfma_f32_16x16x32_bf16 a[80:83], a[240:243], v[216:219], a[80:83]
s_waitcnt lgkmcnt(6)
v_exp_f32 v189, v189
v_mfma_f32_16x16x32_bf16 a[80:83], a[208:211], v[200:203], a[80:83]
ds_read_b128 a[184:187], v2 offset:30720
v_cvt_pk_bf16_f32 v222, v188, v189
v_mfma_f32_16x16x32_bf16 a[84:87], a[212:215], v[200:203], a[84:87]
buffer_load_dwordx4 v1, s[44:47], s72 offen offset:1024 sc1 lds
v_mfma_f32_16x16x32_bf16 a[84:87], a[244:247], v[216:219], a[84:87]
v_exp_f32 v190, v190
v_mfma_f32_16x16x32_bf16 a[88:91], a[248:251], v[216:219], a[88:91]
s_nop 0
ds_read_b128 a[188:191], v2 offset:31744
ds_read_b128 a[224:227], v2 offset:8192
v_mfma_f32_16x16x32_bf16 a[88:91], a[216:219], v[200:203], a[88:91]
v_exp_f32 v191, v191
v_mfma_f32_16x16x32_bf16 a[92:95], a[220:223], v[200:203], a[92:95]
v_exp_f32 v168, v168
v_mfma_f32_16x16x32_bf16 a[92:95], a[252:255], v[216:219], a[92:95]
ds_read_b128 a[228:231], v2 offset:9216
v_cvt_pk_bf16_f32 v223, v190, v191
v_mfma_f32_16x16x32_bf16 v[136:139], a[128:131], v[48:51], v[88:91]
v_exp_f32 v169, v169
v_mfma_f32_16x16x32_bf16 v[136:139], a[132:135], v[52:55], v[136:139]
ds_read_b128 a[232:235], v2 offset:10240
v_cvt_pk_bf16_f32 v216, v168, v169
v_mfma_f32_16x16x32_bf16 v[136:139], a[136:139], v[56:59], v[136:139]
buffer_load_dwordx4 v1, s[44:47], s72 offen offset:2048 sc1 lds
v_mfma_f32_16x16x32_bf16 v[136:139], a[140:143], v[60:63], v[136:139]
v_exp_f32 v170, v170
v_mfma_f32_16x16x32_bf16 v[152:155], a[156:159], v[60:63], v[88:91]
s_nop 0
ds_read_b128 a[236:239], v2 offset:11264
ds_read_b128 a[240:243], v2 offset:12288
v_mfma_f32_16x16x32_bf16 v[152:155], a[152:155], v[56:59], v[152:155]
v_exp_f32 v171, v171
v_mfma_f32_16x16x32_bf16 v[152:155], a[148:151], v[52:55], v[152:155]
v_exp_f32 v184, v184
v_mfma_f32_16x16x32_bf16 v[152:155], a[144:147], v[48:51], v[152:155]
ds_read_b128 a[244:247], v2 offset:13312
v_cvt_pk_bf16_f32 v217, v170, v171
v_mfma_f32_16x16x32_bf16 v[140:143], a[128:131], v[64:67], v[92:95]
v_exp_f32 v185, v185
v_mfma_f32_16x16x32_bf16 v[140:143], a[132:135], v[68:71], v[140:143]
ds_read_b128 a[248:251], v2 offset:14336
v_cvt_pk_bf16_f32 v218, v184, v185
v_mfma_f32_16x16x32_bf16 v[140:143], a[136:139], v[72:75], v[140:143]
buffer_load_dwordx4 v1, s[44:47], s72 offen offset:3072 sc1 lds
v_mfma_f32_16x16x32_bf16 v[140:143], a[140:143], v[76:79], v[140:143]
ds_read_b128 a[252:255], v2 offset:15360
v_add_u32 v2, s82, v1
v_mfma_f32_16x16x32_bf16 v[156:159], a[156:159], v[76:79], v[92:95]
s_waitcnt vmcnt(8) lgkmcnt(4)
v_exp_f32 v186, v186
v_mfma_f32_16x16x32_bf16 v[156:159], a[152:155], v[72:75], v[156:159]
s_barrier
v_exp_f32 v187, v187
v_mfma_f32_16x16x32_bf16 v[156:159], a[148:151], v[68:71], v[156:159]
s_add_u32 s83, s83, 1
v_cvt_pk_bf16_f32 v219, v186, v187
v_mfma_f32_16x16x32_bf16 v[156:159], a[144:147], v[64:67], v[156:159]
s_cbranch_scc0 LloopII
v_mfma_f32_16x16x32_bf16 v[236:239], v[120:123], v[204:207], v[236:239]
s_xor_b32 s74, s82, 0x10000
ds_read_b128 a[128:131], v2 offset:16384
ds_read_b128 a[132:135], v2 offset:17408
v_mfma_f32_16x16x32_bf16 v[236:239], v[120:123], v[220:223], v[236:239]
s_add_u32 s74, s74, s64
v_exp_f32 v136, v136
v_mfma_f32_16x16x32_bf16 a[96:99], a[192:195], v[204:207], a[96:99]
s_add_u32 s81, s81, 0x8000
v_exp_f32 v137, v137
v_mfma_f32_16x16x32_bf16 a[96:99], a[224:227], v[220:223], a[96:99]
s_add_u32 m0, s74, 0
ds_read_b128 a[136:139], v2 offset:18432
v_cvt_pk_bf16_f32 v200, v136, v137
v_mfma_f32_16x16x32_bf16 a[100:103], a[228:231], v[220:223], a[100:103]
s_add_u32 s72, s81, 0
v_exp_f32 v138, v138
v_mfma_f32_16x16x32_bf16 a[100:103], a[196:199], v[204:207], a[100:103]
buffer_load_dwordx4 v1, s[44:47], s72 offen sc1 lds
v_mfma_f32_16x16x32_bf16 a[104:107], a[200:203], v[204:207], a[104:107]
s_nop 0
ds_read_b128 a[140:143], v2 offset:19456
ds_read_b128 a[144:147], v2 offset:20480
v_mfma_f32_16x16x32_bf16 a[104:107], a[232:235], v[220:223], a[104:107]
v_exp_f32 v139, v139
v_mfma_f32_16x16x32_bf16 a[108:111], a[236:239], v[220:223], a[108:111]
v_exp_f32 v152, v152
v_mfma_f32_16x16x32_bf16 a[108:111], a[204:207], v[204:207], a[108:111]
ds_read_b128 a[148:151], v2 offset:21504
v_cvt_pk_bf16_f32 v201, v138, v139
v_mfma_f32_16x16x32_bf16 a[112:115], a[208:211], v[204:207], a[112:115]
s_waitcnt lgkmcnt(6)
v_exp_f32 v153, v153
v_mfma_f32_16x16x32_bf16 a[112:115], a[240:243], v[220:223], a[112:115]
ds_read_b128 a[152:155], v2 offset:22528
v_cvt_pk_bf16_f32 v202, v152, v153
v_mfma_f32_16x16x32_bf16 a[116:119], a[244:247], v[220:223], a[116:119]
v_exp_f32 v154, v154
v_mfma_f32_16x16x32_bf16 a[116:119], a[212:215], v[204:207], a[116:119]
buffer_load_dwordx4 v1, s[44:47], s72 offen offset:1024 sc1 lds
v_mfma_f32_16x16x32_bf16 a[120:123], a[216:219], v[204:207], a[120:123]
s_nop 0
ds_read_b128 a[156:159], v2 offset:23552
ds_read_b128 a[192:195], v2 offset:0
v_mfma_f32_16x16x32_bf16 a[120:123], a[248:251], v[220:223], a[120:123]
v_exp_f32 v155, v155
v_mfma_f32_16x16x32_bf16 a[124:127], a[252:255], v[220:223], a[124:127]
v_exp_f32 v140, v140
v_mfma_f32_16x16x32_bf16 a[124:127], a[220:223], v[204:207], a[124:127]
ds_read_b128 a[196:199], v2 offset:1024
v_cvt_pk_bf16_f32 v203, v154, v155
v_mfma_f32_16x16x32_bf16 v[172:175], a[160:163], v[64:67], v[92:95]
v_exp_f32 v141, v141
v_mfma_f32_16x16x32_bf16 v[172:175], a[164:167], v[68:71], v[172:175]
ds_read_b128 a[200:203], v2 offset:2048
v_cvt_pk_bf16_f32 v204, v140, v141
v_mfma_f32_16x16x32_bf16 v[172:175], a[168:171], v[72:75], v[172:175]
v_exp_f32 v142, v142
v_mfma_f32_16x16x32_bf16 v[172:175], a[172:175], v[76:79], v[172:175]
buffer_load_dwordx4 v1, s[44:47], s72 offen offset:2048 sc1 lds
v_mfma_f32_16x16x32_bf16 v[188:191], a[188:191], v[76:79], v[92:95]
ds_read_b128 a[204:207], v2 offset:3072
v_mfma_f32_16x16x32_bf16 v[188:191], a[184:187], v[72:75], v[188:191]
v_exp_f32 v143, v143
v_mfma_f32_16x16x32_bf16 v[188:191], a[180:183], v[68:71], v[188:191]
ds_read_b128 a[208:211], v2 offset:4096
v_cvt_pk_bf16_f32 v205, v142, v143
v_mfma_f32_16x16x32_bf16 v[188:191], a[176:179], v[64:67], v[188:191]
v_exp_f32 v156, v156
v_mfma_f32_16x16x32_bf16 v[168:171], a[160:163], v[48:51], v[88:91]
ds_read_b128 a[212:215], v2 offset:5120
v_mfma_f32_16x16x32_bf16 v[168:171], a[164:167], v[52:55], v[168:171]
v_exp_f32 v157, v157
v_mfma_f32_16x16x32_bf16 v[168:171], a[168:171], v[56:59], v[168:171]
ds_read_b128 a[216:219], v2 offset:6144
v_cvt_pk_bf16_f32 v206, v156, v157
v_mfma_f32_16x16x32_bf16 v[168:171], a[172:175], v[60:63], v[168:171]
buffer_load_dwordx4 v1, s[44:47], s72 offen offset:3072 sc1 lds
v_mfma_f32_16x16x32_bf16 v[184:187], a[188:191], v[60:63], v[88:91]
v_exp_f32 v158, v158
v_mfma_f32_16x16x32_bf16 v[184:187], a[184:187], v[56:59], v[184:187]
ds_read_b128 a[220:223], v2 offset:7168
v_mfma_f32_16x16x32_bf16 v[184:187], a[180:183], v[52:55], v[184:187]
s_waitcnt lgkmcnt(4)
v_exp_f32 v159, v159
v_mfma_f32_16x16x32_bf16 v[184:187], a[176:179], v[48:51], v[184:187]
s_barrier
v_cvt_pk_bf16_f32 v207, v158, v159
s_lshr_b32 s69, s93, 4
s_and_b32 s69, s69, 0x7f00
s_add_u32 s69, s69, LHT4-Lpc0
v_lshrrev_b32 v3, 5, v0
v_lshlrev_b32 v3, 7, v3
v_add_u32 v3, s69, v3
v_min_u32 v3, Lcode_end-Lpc0, v3
global_load_dword v4, v3, s[98:99]
v_mfma_f32_16x16x32_bf16 v[232:235], v[120:123], v[216:219], v[232:235]
s_add_u32 s82, s82, 0x8000
ds_read_b128 a[160:163], v2 offset:24576
ds_read_b128 a[164:167], v2 offset:25600
v_mfma_f32_16x16x32_bf16 v[232:235], v[120:123], v[200:203], v[232:235]
s_and_b32 s82, s82, 0x1ffff
v_exp_f32 v172, v172
v_mfma_f32_16x16x32_bf16 a[64:67], a[224:227], v[216:219], a[64:67]
s_add_u32 s66, s58, 3
v_exp_f32 v173, v173
v_mfma_f32_16x16x32_bf16 a[64:67], a[192:195], v[200:203], a[64:67]
s_and_b32 s66, s66, 3
ds_read_b128 a[168:171], v2 offset:26624
v_cvt_pk_bf16_f32 v220, v172, v173
v_mfma_f32_16x16x32_bf16 a[68:71], a[196:199], v[200:203], a[68:71]
s_mul_i32 s66, s66, 4160
v_exp_f32 v174, v174
v_mfma_f32_16x16x32_bf16 a[68:71], a[228:231], v[216:219], a[68:71]
s_add_u32 s66, s66, s92
ds_read_b128 a[172:175], v2 offset:27648
ds_read_b128 a[176:179], v2 offset:28672
v_mfma_f32_16x16x32_bf16 a[72:75], a[232:235], v[216:219], a[72:75]
s_add_u32 m0, s66, 32
v_exp_f32 v175, v175
v_mfma_f32_16x16x32_bf16 a[72:75], a[200:203], v[200:203], a[72:75]
s_add_u32 s72, s93, 0x6
buffer_load_dwordx4 v1, s[36:39], s72 offen lds
v_mfma_f32_16x16x32_bf16 a[76:79], a[204:207], v[200:203], a[76:79]
v_exp_f32 v188, v188
v_mfma_f32_16x16x32_bf16 a[76:79], a[236:239], v[216:219], a[76:79]
ds_read_b128 a[180:183], v2 offset:29696
v_cvt_pk_bf16_f32 v221, v174, v175
v_mfma_f32_16x16x32_bf16 a[80:83], a[240:243], v[216:219], a[80:83]
s_waitcnt lgkmcnt(6)
v_exp_f32 v189, v189
v_mfma_f32_16x16x32_bf16 a[80:83], a[208:211], v[200:203], a[80:83]
ds_read_b128 a[184:187], v2 offset:30720
v_cvt_pk_bf16_f32 v222, v188, v189
v_mfma_f32_16x16x32_bf16 a[84:87], a[212:215], v[200:203], a[84:87]
v_exp_f32 v190, v190
v_mfma_f32_16x16x32_bf16 a[84:87], a[244:247], v[216:219], a[84:87]
buffer_load_dwordx4 v1, s[36:39], s72 offen offset:1024 lds
v_mfma_f32_16x16x32_bf16 a[88:91], a[248:251], v[216:219], a[88:91]
s_nop 0
ds_read_b128 a[188:191], v2 offset:31744
ds_read_b128 a[224:227], v2 offset:8192
v_mfma_f32_16x16x32_bf16 a[88:91], a[216:219], v[200:203], a[88:91]
v_exp_f32 v191, v191
v_mfma_f32_16x16x32_bf16 a[92:95], a[220:223], v[200:203], a[92:95]
v_exp_f32 v168, v168
v_mfma_f32_16x16x32_bf16 a[92:95], a[252:255], v[216:219], a[92:95]
ds_read_b128 a[228:231], v2 offset:9216
v_cvt_pk_bf16_f32 v223, v190, v191
s_cmp_eq_u32 s58, 0
s_cbranch_scc1 Lta28
s_cmp_eq_u32 s58, 1
s_cbranch_scc1 Lnt29
v_mfma_f32_16x16x32_bf16 v[136:139], a[128:131], v[48:51], v[88:91]
v_exp_f32 v169, v169
v_mfma_f32_16x16x32_bf16 v[152:155], a[144:147], v[48:51], v[88:91]
ds_read_b128 a[232:235], v2 offset:10240
v_cvt_pk_bf16_f32 v216, v168, v169
s_branch Ljoin30
Lta28:
v_mfma_f32_16x16x32_bf16 v[136:139], a[128:131], v[48:51], v[104:107]
v_exp_f32 v169, v169
v_mfma_f32_16x16x32_bf16 v[152:155], a[144:147], v[48:51], v[112:115]
ds_read_b128 a[232:235], v2 offset:10240
v_cvt_pk_bf16_f32 v216, v168, v169
s_branch Ljoin30
Lnt29:
v_mfma_f32_16x16x32_bf16 v[136:139], a[128:131], v[48:51], v[88:91]
v_exp_f32 v169, v169
v_mfma_f32_16x16x32_bf16 v[152:155], a[144:147], v[48:51], v[104:107]
ds_read_b128 a[232:235], v2 offset:10240
v_cvt_pk_bf16_f32 v216, v168, v169
Ljoin30:
v_mfma_f32_16x16x32_bf16 v[136:139], a[132:135], v[52:55], v[136:139]
v_exp_f32 v170, v170
v_mfma_f32_16x16x32_bf16 v[136:139], a[136:139], v[56:59], v[136:139]
buffer_load_dwordx4 v1, s[36:39], s72 offen offset:2048 lds
v_mfma_f32_16x16x32_bf16 v[136:139], a[140:143], v[60:63], v[136:139]
ds_read_b128 a[236:239], v2 offset:11264
v_mfma_f32_16x16x32_bf16 v[152:155], a[156:159], v[60:63], v[152:155]
v_exp_f32 v171, v171
v_mfma_f32_16x16x32_bf16 v[152:155], a[152:155], v[56:59], v[152:155]
ds_read_b128 a[240:243], v2 offset:12288
v_cvt_pk_bf16_f32 v217, v170, v171
v_mfma_f32_16x16x32_bf16 v[152:155], a[148:151], v[52:55], v[152:155]
v_exp_f32 v184, v184
v_mfma_f32_16x16x32_bf16 v[140:143], a[128:131], v[64:67], v[92:95]
ds_read_b128 a[244:247], v2 offset:13312
v_mfma_f32_16x16x32_bf16 v[140:143], a[132:135], v[68:71], v[140:143]
v_exp_f32 v185, v185
v_mfma_f32_16x16x32_bf16 v[140:143], a[136:139], v[72:75], v[140:143]
ds_read_b128 a[248:251], v2 offset:14336
v_cvt_pk_bf16_f32 v218, v184, v185
v_mfma_f32_16x16x32_bf16 v[140:143], a[140:143], v[76:79], v[140:143]
buffer_load_dwordx4 v1, s[36:39], s72 offen offset:3072 lds
v_mfma_f32_16x16x32_bf16 v[156:159], a[156:159], v[76:79], v[92:95]
v_exp_f32 v186, v186
v_mfma_f32_16x16x32_bf16 v[156:159], a[152:155], v[72:75], v[156:159]
ds_read_b128 a[252:255], v2 offset:15360
v_add_u32 v2, s82, v1
v_mfma_f32_16x16x32_bf16 v[156:159], a[148:151], v[68:71], v[156:159]
s_waitcnt vmcnt(9) lgkmcnt(0)
v_exp_f32 v187, v187
v_mfma_f32_16x16x32_bf16 v[156:159], a[144:147], v[64:67], v[156:159]
s_barrier
v_cvt_pk_bf16_f32 v219, v186, v187
v_mfma_f32_16x16x32_bf16 v[236:239], v[120:123], v[204:207], v[236:239]
s_mov_b32 m0, s62
v_exp_f32 v136, v136
v_mfma_f32_16x16x32_bf16 v[236:239], v[120:123], v[220:223], v[236:239]
s_add_u32 s72, s93, 0x3000000
ds_read_b128 a[128:131], v2 offset:16384
ds_read_b128 a[132:135], v2 offset:17408
v_mfma_f32_16x16x32_bf16 a[96:99], a[192:195], v[204:207], a[96:99]
s_add_u32 s78, s59, 8
v_exp_f32 v137, v137
v_mfma_f32_16x16x32_bf16 a[96:99], a[224:227], v[220:223], a[96:99]
s_and_b32 s78, s78, 24
buffer_load_dwordx4 v1, s[44:47], s72 offen sc1 lds
v_mfma_f32_16x16x32_bf16 a[100:103], a[228:231], v[220:223], a[100:103]
s_lshr_b32 s79, 0x67234501, s78
v_exp_f32 v138, v138
v_mfma_f32_16x16x32_bf16 a[100:103], a[196:199], v[204:207], a[100:103]
s_and_b32 s79, s79, 7
ds_read_b128 a[136:139], v2 offset:18432
v_cvt_pk_bf16_f32 v200, v136, v137
v_mfma_f32_16x16x32_bf16 a[104:107], a[200:203], v[204:207], a[104:107]
s_lshl_b32 s79, s79, 18
v_exp_f32 v139, v139
v_mfma_f32_16x16x32_bf16 a[104:107], a[232:235], v[220:223], a[104:107]
s_add_u32 s79, s79, s94
ds_read_b128 a[140:143], v2 offset:19456
v_cvt_pk_bf16_f32 v201, v138, v139
v_mfma_f32_16x16x32_bf16 a[108:111], a[236:239], v[220:223], a[108:111]
s_add_u32 s12, s61, 0
v_exp_f32 v152, v152
v_mfma_f32_16x16x32_bf16 a[108:111], a[204:207], v[204:207], a[108:111]
s_and_b32 s12, s12, 3
ds_read_b128 a[144:147], v2 offset:20480
ds_read_b128 a[148:151], v2 offset:21504
v_mfma_f32_16x16x32_bf16 a[112:115], a[208:211], v[204:207], a[112:115]
s_waitcnt lgkmcnt(6)
buffer_load_dwordx4 v1, s[44:47], s72 offen offset:1024 sc1 lds
v_mfma_f32_16x16x32_bf16 a[112:115], a[240:243], v[220:223], a[112:115]
s_lshl_b32 s12, s12, 21
v_exp_f32 v153, v153
v_mfma_f32_16x16x32_bf16 a[116:119], a[244:247], v[220:223], a[116:119]
s_add_u32 s12, s12, s79
v_exp_f32 v154, v154
v_mfma_f32_16x16x32_bf16 a[116:119], a[212:215], v[204:207], a[116:119]
s_add_u32 s13, s61, 1
ds_read_b128 a[152:155], v2 offset:22528
v_cvt_pk_bf16_f32 v202, v152, v153
v_mfma_f32_16x16x32_bf16 a[120:123], a[216:219], v[204:207], a[120:123]
s_and_b32 s13, s13, 3
buffer_load_dwordx4 v1, s[44:47], s72 offen offset:2048 sc1 lds
v_mfma_f32_16x16x32_bf16 a[120:123], a[248:251], v[220:223], a[120:123]
s_lshl_b32 s13, s13, 21
v_exp_f32 v155, v155
v_mfma_f32_16x16x32_bf16 a[124:127], a[252:255], v[220:223], a[124:127]
s_add_u32 s13, s13, s79
ds_read_b128 a[156:159], v2 offset:23552
v_cvt_pk_bf16_f32 v203, v154, v155
v_mfma_f32_16x16x32_bf16 a[124:127], a[220:223], v[204:207], a[124:127]
s_add_u32 s14, s61, 2
v_exp_f32 v140, v140
s_cmp_eq_u32 s58, 2
s_cbranch_scc1 Lta31
s_cmp_eq_u32 s58, 3
s_cbranch_scc1 Lnt32
v_mfma_f32_16x16x32_bf16 v[168:171], a[160:163], v[48:51], v[112:115]
s_and_b32 s14, s14, 3
ds_read_b128 a[192:195], v2 offset:0
ds_read_b128 a[196:199], v2 offset:1024
v_mfma_f32_16x16x32_bf16 v[184:187], a[176:179], v[48:51], v[112:115]
s_lshl_b32 s14, s14, 21
v_exp_f32 v141, v141
s_branch Ljoin33
Lta31:
v_mfma_f32_16x16x32_bf16 v[168:171], a[160:163], v[48:51], v[104:107]
s_and_b32 s14, s14, 3
ds_read_b128 a[192:195], v2 offset:0
ds_read_b128 a[196:199], v2 offset:1024
v_mfma_f32_16x16x32_bf16 v[184:187], a[176:179], v[48:51], v[112:115]
s_lshl_b32 s14, s14, 21
v_exp_f32 v141, v141
s_branch Ljoin33
Lnt32:
v_mfma_f32_16x16x32_bf16 v[168:171], a[160:163], v[48:51], v[88:91]
s_and_b32 s14, s14, 3
ds_read_b128 a[192:195], v2 offset:0
ds_read_b128 a[196:199], v2 offset:1024
v_mfma_f32_16x16x32_bf16 v[184:187], a[176:179], v[48:51], v[104:107]
s_lshl_b32 s14, s14, 21
v_exp_f32 v141, v141
Ljoin33:
v_mfma_f32_16x16x32_bf16 v[172:175], a[160:163], v[64:67], v[92:95]
s_add_u32 s14, s14, s79
buffer_load_dwordx4 v1, s[44:47], s72 offen offset:3072 sc1 lds
v_mfma_f32_16x16x32_bf16 v[172:175], a[164:167], v[68:71], v[172:175]
s_add_u32 s66, s58, 0
v_exp_f32 v142, v142
v_mfma_f32_16x16x32_bf16 v[172:175], a[168:171], v[72:75], v[172:175]
s_and_b32 s66, s66, 3
ds_read_b128 a[200:203], v2 offset:2048
v_cvt_pk_bf16_f32 v204, v140, v141
v_mfma_f32_16x16x32_bf16 v[172:175], a[172:175], v[76:79], v[172:175]
s_mul_i32 s66, s66, 4160
v_exp_f32 v143, v143
v_mfma_f32_16x16x32_bf16 v[188:191], a[188:191], v[76:79], v[92:95]
s_add_u32 s66, s66, s92
ds_read_b128 a[204:207], v2 offset:3072
v_cvt_pk_bf16_f32 v205, v142, v143
v_mfma_f32_16x16x32_bf16 v[188:191], a[184:187], v[72:75], v[188:191]
s_add_u32 m0, s66, 16672
v_exp_f32 v156, v156
v_mfma_f32_16x16x32_bf16 v[188:191], a[180:183], v[68:71], v[188:191]
s_add_u32 s72, s93, 0x0
ds_read_b128 a[208:211], v2 offset:4096
ds_read_b128 a[212:215], v2 offset:5120
v_mfma_f32_16x16x32_bf16 v[188:191], a[176:179], v[64:67], v[188:191]
s_add_u32 s15, s61, 3
buffer_load_dwordx4 v1, s[36:39], s72 offen lds
v_mfma_f32_16x16x32_bf16 v[168:171], a[164:167], v[52:55], v[168:171]
s_and_b32 s15, s15, 3
v_exp_f32 v157, v157
v_mfma_f32_16x16x32_bf16 v[168:171], a[168:171], v[56:59], v[168:171]
s_lshl_b32 s15, s15, 21
v_exp_f32 v158, v158
v_mfma_f32_16x16x32_bf16 v[168:171], a[172:175], v[60:63], v[168:171]
s_add_u32 s15, s15, s79
ds_read_b128 a[216:219], v2 offset:6144
ds_read_b128 a[220:223], v2 offset:7168
v_mfma_f32_16x16x32_bf16 v[184:187], a[188:191], v[60:63], v[184:187]
buffer_load_dwordx4 v1, s[36:39], s72 offen offset:1024 lds
v_mfma_f32_16x16x32_bf16 v[184:187], a[184:187], v[56:59], v[184:187]
v_exp_f32 v159, v159
v_mfma_f32_16x16x32_bf16 v[184:187], a[180:183], v[52:55], v[184:187]
s_waitcnt lgkmcnt(4)
v_cvt_pk_bf16_f32 v206, v156, v157
v_cvt_pk_bf16_f32 v207, v158, v159
v_mfma_f32_16x16x32_bf16 v[232:235], v[120:123], v[216:219], v[232:235]
s_add_u32 s82, s82, 0x8000
ds_read_b128 a[160:163], v2 offset:24576
ds_read_b128 a[164:167], v2 offset:25600
v_mfma_f32_16x16x32_bf16 v[232:235], v[120:123], v[200:203], v[232:235]
s_and_b32 s82, s82, 0x1ffff
v_exp_f32 v172, v172
v_mfma_f32_16x16x32_bf16 a[64:67], a[224:227], v[216:219], a[64:67]
v_exp_f32 v173, v173
v_mfma_f32_16x16x32_bf16 a[64:67], a[192:195], v[200:203], a[64:67]
s_nop 0
ds_read_b128 a[168:171], v2 offset:26624
ds_read_b128 a[172:175], v2 offset:27648
v_mfma_f32_16x16x32_bf16 a[68:71], a[196:199], v[200:203], a[68:71]
v_exp_f32 v174, v174
v_mfma_f32_16x16x32_bf16 a[68:71], a[228:231], v[216:219], a[68:71]
v_exp_f32 v175, v175
v_mfma_f32_16x16x32_bf16 a[72:75], a[232:235], v[216:219], a[72:75]
s_nop 0
ds_read_b128 a[176:179], v2 offset:28672
ds_read_b128 a[180:183], v2 offset:29696
v_mfma_f32_16x16x32_bf16 a[72:75], a[200:203], v[200:203], a[72:75]
v_exp_f32 v188, v188
v_mfma_f32_16x16x32_bf16 a[76:79], a[204:207], v[200:203], a[76:79]
s_nop 0
ds_read_b128 a[184:187], v2 offset:30720
ds_read_b128 a[188:191], v2 offset:31744
v_mfma_f32_16x16x32_bf16 a[76:79], a[236:239], v[216:219], a[76:79]
s_nop 0
ds_read_b128 a[224:227], v2 offset:8192
ds_read_b128 a[228:231], v2 offset:9216
v_mfma_f32_16x16x32_bf16 a[80:83], a[240:243], v[216:219], a[80:83]
s_waitcnt lgkmcnt(10)
ds_read_b128 a[232:235], v2 offset:10240
ds_read_b128 a[236:239], v2 offset:11264
v_mfma_f32_16x16x32_bf16 a[80:83], a[208:211], v[200:203], a[80:83]
ds_read_b128 a[240:243], v2 offset:12288
v_cvt_pk_bf16_f32 v220, v172, v173
v_mfma_f32_16x16x32_bf16 a[84:87], a[212:215], v[200:203], a[84:87]
buffer_load_dwordx4 v1, s[36:39], s72 offen offset:2048 lds
v_mfma_f32_16x16x32_bf16 a[84:87], a[244:247], v[216:219], a[84:87]
v_exp_f32 v189, v189
v_mfma_f32_16x16x32_bf16 a[88:91], a[248:251], v[216:219], a[88:91]
v_exp_f32 v190, v190
v_mfma_f32_16x16x32_bf16 a[88:91], a[216:219], v[200:203], a[88:91]
s_nop 0
ds_read_b128 a[244:247], v2 offset:13312
ds_read_b128 a[248:251], v2 offset:14336
v_mfma_f32_16x16x32_bf16 a[92:95], a[220:223], v[200:203], a[92:95]
v_cvt_pk_bf16_f32 v221, v174, v175
v_cvt_pk_bf16_f32 v222, v188, v189
v_mfma_f32_16x16x32_bf16 a[92:95], a[252:255], v[216:219], a[92:95]
Lstub7:
s_cbranch_execz Lstub11
v_exp_f32 v191, v191
s_cmp_eq_u32 s58, 0
s_cbranch_scc1 Lta34
s_cmp_eq_u32 s58, 1
s_cbranch_scc1 Lnt35
v_mfma_f32_16x16x32_bf16 v[140:143], a[128:131], v[64:67], v[92:95]
v_exp_f32 v168, v168
v_mfma_f32_16x16x32_bf16 v[156:159], a[144:147], v[64:67], v[92:95]
v_exp_f32 v169, v169
s_branch Ljoin36
Lta34:
v_mfma_f32_16x16x32_bf16 v[140:143], a[128:131], v[64:67], v[108:111]
v_exp_f32 v168, v168
v_mfma_f32_16x16x32_bf16 v[156:159], a[144:147], v[64:67], v[112:115]
v_exp_f32 v169, v169
s_branch Ljoin36
Lnt35:
v_mfma_f32_16x16x32_bf16 v[140:143], a[128:131], v[64:67], v[92:95]
v_exp_f32 v168, v168
v_mfma_f32_16x16x32_bf16 v[156:159], a[144:147], v[64:67], v[108:111]
v_exp_f32 v169, v169
Ljoin36:
v_mfma_f32_16x16x32_bf16 v[140:143], a[132:135], v[68:71], v[140:143]
v_exp_f32 v170, v170
v_mfma_f32_16x16x32_bf16 v[140:143], a[136:139], v[72:75], v[140:143]
ds_read_b128 a[252:255], v2 offset:15360
v_cvt_pk_bf16_f32 v223, v190, v191
v_mfma_f32_16x16x32_bf16 v[140:143], a[140:143], v[76:79], v[140:143]
v_exp_f32 v171, v171
v_mfma_f32_16x16x32_bf16 v[156:159], a[156:159], v[76:79], v[156:159]
buffer_load_dwordx4 v1, s[36:39], s72 offen offset:3072 lds
v_mfma_f32_16x16x32_bf16 v[156:159], a[152:155], v[72:75], v[156:159]
s_waitcnt vmcnt(13) lgkmcnt(4)
v_exp_f32 v184, v184
v_mfma_f32_16x16x32_bf16 v[156:159], a[148:151], v[68:71], v[156:159]
s_barrier
v_cvt_pk_bf16_f32 v216, v168, v169
v_cvt_pk_bf16_f32 v217, v170, v171
v_add_u32 v2, s82, v1
v_exp_f32 v185, v185
v_exp_f32 v186, v186
v_cvt_pk_bf16_f32 v218, v184, v185
v_exp_f32 v187, v187
s_nop 0
v_cvt_pk_bf16_f32 v219, v186, v187
v_mfma_f32_16x16x32_bf16 v[236:239], v[120:123], v[204:207], v[236:239]
s_add_u32 s66, s58, 2
v_exp_f32 v140, v140
v_mfma_f32_16x16x32_bf16 v[236:239], v[120:123], v[220:223], v[236:239]
s_and_b32 s66, s66, 3
v_exp_f32 v141, v141
v_mfma_f32_16x16x32_bf16 a[96:99], a[192:195], v[204:207], a[96:99]
s_mul_i32 s66, s66, 4160
ds_read_b128 a[192:195], v2 offset:0
v_mfma_f32_16x16x32_bf16 a[96:99], a[224:227], v[220:223], a[96:99]
s_add_u32 s66, s66, s92
v_exp_f32 v142, v142
v_mfma_f32_16x16x32_bf16 a[100:103], a[228:231], v[220:223], a[100:103]
s_add_u32 m0, s66, 33312
v_exp_f32 v143, v143
v_mfma_f32_16x16x32_bf16 a[100:103], a[196:199], v[204:207], a[100:103]
s_add_u32 s72, s93, 0x4
buffer_load_dwordx4 v1, s[36:39], s72 offen lds
v_mfma_f32_16x16x32_bf16 a[104:107], a[200:203], v[204:207], a[104:107]
ds_read_b128 a[196:199], v2 offset:1024
v_mfma_f32_16x16x32_bf16 a[104:107], a[232:235], v[220:223], a[104:107]
buffer_load_dwordx4 v1, s[36:39], s72 offen offset:1024 lds
v_mfma_f32_16x16x32_bf16 a[108:111], a[236:239], v[220:223], a[108:111]
ds_read_b128 a[200:203], v2 offset:2048
v_mfma_f32_16x16x32_bf16 a[108:111], a[204:207], v[204:207], a[108:111]
buffer_load_dwordx4 v1, s[36:39], s72 offen offset:2048 lds
v_mfma_f32_16x16x32_bf16 a[112:115], a[208:211], v[204:207], a[112:115]
s_waitcnt lgkmcnt(3)
ds_read_b128 a[204:207], v2 offset:3072
v_mfma_f32_16x16x32_bf16 a[112:115], a[240:243], v[220:223], a[112:115]
buffer_load_dwordx4 v1, s[36:39], s72 offen offset:3072 lds
v_mfma_f32_16x16x32_bf16 a[116:119], a[244:247], v[220:223], a[116:119]
v_exp_f32 v156, v156
v_mfma_f32_16x16x32_bf16 a[116:119], a[212:215], v[204:207], a[116:119]
ds_read_b128 a[208:211], v2 offset:4096
v_mfma_f32_16x16x32_bf16 a[120:123], a[216:219], v[204:207], a[120:123]
buffer_load_dwordx4 v[80:83], v15, s[4:7], s80 offen
v_mfma_f32_16x16x32_bf16 a[120:123], a[248:251], v[220:223], a[120:123]
s_add_u32 s80, s80, 0x4000
v_exp_f32 v157, v157
v_mfma_f32_16x16x32_bf16 a[124:127], a[252:255], v[220:223], a[124:127]
ds_read_b128 a[212:215], v2 offset:5120
v_mfma_f32_16x16x32_bf16 a[124:127], a[220:223], v[204:207], a[124:127]
ds_read_b128 a[216:219], v2 offset:6144
v_cvt_pk_bf16_f32 v204, v140, v141
s_cmp_eq_u32 s58, 2
s_cbranch_scc1 Lta37
s_cmp_eq_u32 s58, 3
s_cbranch_scc1 Lnt38
v_mfma_f32_16x16x32_bf16 v[172:175], a[160:163], v[64:67], v[112:115]
buffer_load_dwordx4 v[84:87], v15, s[4:7], s80 offen
v_mfma_f32_16x16x32_bf16 v[188:191], a[176:179], v[64:67], v[112:115]
s_add_u32 s80, s80, 0x4000
v_exp_f32 v158, v158
s_branch Ljoin39
Lta37:
v_mfma_f32_16x16x32_bf16 v[172:175], a[160:163], v[64:67], v[108:111]
buffer_load_dwordx4 v[84:87], v15, s[4:7], s80 offen
v_mfma_f32_16x16x32_bf16 v[188:191], a[176:179], v[64:67], v[112:115]
s_add_u32 s80, s80, 0x4000
v_exp_f32 v158, v158
s_branch Ljoin39
Lnt38:
v_mfma_f32_16x16x32_bf16 v[172:175], a[160:163], v[64:67], v[92:95]
buffer_load_dwordx4 v[84:87], v15, s[4:7], s80 offen
v_mfma_f32_16x16x32_bf16 v[188:191], a[176:179], v[64:67], v[108:111]
s_add_u32 s80, s80, 0x4000
v_exp_f32 v158, v158
Ljoin39:
v_mfma_f32_16x16x32_bf16 v[172:175], a[164:167], v[68:71], v[172:175]
ds_read_b128 a[220:223], v2 offset:7168
v_cvt_pk_bf16_f32 v205, v142, v143
v_mfma_f32_16x16x32_bf16 v[172:175], a[168:171], v[72:75], v[172:175]
buffer_load_dwordx4 v[96:99], v15, s[4:7], s80 offen
v_mfma_f32_16x16x32_bf16 v[172:175], a[172:175], v[76:79], v[172:175]
s_add_u32 s80, s80, 0x4000
v_exp_f32 v159, v159
v_mfma_f32_16x16x32_bf16 v[188:191], a[188:191], v[76:79], v[188:191]
buffer_load_dwordx4 v[100:103], v15, s[4:7], s80 offen
v_mfma_f32_16x16x32_bf16 v[188:191], a[184:187], v[72:75], v[188:191]
v_cvt_pk_bf16_f32 v206, v156, v157
v_cvt_pk_bf16_f32 v207, v158, v159
v_mfma_f32_16x16x32_bf16 v[188:191], a[180:183], v[68:71], v[188:191]
s_waitcnt lgkmcnt(4)
v_mfma_f32_16x16x32_bf16 v[232:235], v[120:123], v[216:219], v[232:235]
s_add_u32 s82, s82, 0x8000
v_exp_f32 v172, v172
v_mfma_f32_16x16x32_bf16 a[64:67], a[224:227], v[216:219], a[64:67]
s_and_b32 s82, s82, 0x1ffff
ds_read_b128 a[224:227], v2 offset:8192
v_mfma_f32_16x16x32_bf16 a[68:71], a[228:231], v[216:219], a[68:71]
ds_read_b128 a[228:231], v2 offset:9216
v_mfma_f32_16x16x32_bf16 a[72:75], a[232:235], v[216:219], a[72:75]
v_exp_f32 v173, v173
v_mfma_f32_16x16x32_bf16 a[76:79], a[236:239], v[216:219], a[76:79]
s_nop 0
ds_read_b128 a[232:235], v2 offset:10240
ds_read_b128 a[236:239], v2 offset:11264
v_mfma_f32_16x16x32_bf16 a[80:83], a[240:243], v[216:219], a[80:83]
ds_read_b128 a[240:243], v2 offset:12288
v_cvt_pk_bf16_f32 v220, v172, v173
v_mfma_f32_16x16x32_bf16 a[84:87], a[244:247], v[216:219], a[84:87]
ds_read_b128 a[244:247], v2 offset:13312
v_mfma_f32_16x16x32_bf16 a[88:91], a[248:251], v[216:219], a[88:91]
v_exp_f32 v174, v174
v_mfma_f32_16x16x32_bf16 a[92:95], a[252:255], v[216:219], a[92:95]
v_exp_f32 v175, v175
ds_read_b128 a[248:251], v2 offset:14336
ds_read_b128 a[252:255], v2 offset:15360
v_add_u32 v2, s82, v1
v_exp_f32 v188, v188
v_cvt_pk_bf16_f32 v221, v174, v175
v_exp_f32 v189, v189
v_exp_f32 v190, v190
v_cvt_pk_bf16_f32 v222, v188, v189
v_exp_f32 v191, v191
s_nop 0
v_cvt_pk_bf16_f32 v223, v190, v191
s_waitcnt vmcnt(4) lgkmcnt(0)
s_barrier
LHT4:
Lstub8:
s_cbranch_execz Lret
v_mfma_f32_16x16x32_bf16 v[236:239], v[120:123], v[204:207], v[236:239]
ds_write_b64 v5, v[12:13]
v_mov_b32 v240, 0
v_mfma_f32_16x16x32_bf16 v[236:239], v[120:123], v[220:223], v[236:239]
v_mov_b32 v241, 0
v_mfma_f32_16x16x32_bf16 a[96:99], a[192:195], v[204:207], a[96:99]
s_nop 0
ds_write_b64 v14, v[240:241]
ds_read_b64 a[128:129], v6 offset:0
v_mfma_f32_16x16x32_bf16 a[96:99], a[224:227], v[220:223], a[96:99]
s_nop 0
ds_read_b64 a[130:131], v6 offset:8
ds_read_b128 a[192:195], v7 offset:3584
v_mfma_f32_16x16x32_bf16 a[100:103], a[228:231], v[220:223], a[100:103]
s_nop 0
ds_read_b64 a[132:133], v6 offset:512
ds_read_b64 a[134:135], v6 offset:520
v_mfma_f32_16x16x32_bf16 a[100:103], a[196:199], v[204:207], a[100:103]
s_nop 0
ds_read_b128 a[196:199], v7 offset:3072
ds_read_b64 a[136:137], v6 offset:1024
v_mfma_f32_16x16x32_bf16 a[104:107], a[200:203], v[204:207], a[104:107]
s_nop 0
ds_read_b64 a[138:139], v6 offset:1032
ds_read_b128 a[200:203], v7 offset:2560
v_mfma_f32_16x16x32_bf16 a[104:107], a[232:235], v[220:223], a[104:107]
v_add_f32 v12, v224, v228
v_min_u32 v13, 1, v0
v_mfma_f32_16x16x32_bf16 a[108:111], a[236:239], v[220:223], a[108:111]
s_nop 0
ds_read_b64 a[140:141], v6 offset:1536
ds_read_b64 a[142:143], v6 offset:1544
v_mfma_f32_16x16x32_bf16 a[108:111], a[204:207], v[204:207], a[108:111]
s_nop 0
ds_read_b128 a[204:207], v7 offset:2048
ds_read_b64 a[144:145], v6 offset:2048
v_mfma_f32_16x16x32_bf16 a[112:115], a[208:211], v[204:207], a[112:115]
s_lshl_b32 s73, s52, 12
ds_read_b64 a[146:147], v6 offset:2056
ds_read_b128 a[208:211], v7 offset:1536
v_mfma_f32_16x16x32_bf16 a[112:115], a[240:243], v[220:223], a[112:115]
s_add_u32 s73, s73, 0x2000000
v_lshlrev_b32 v13, 30, v13
v_mov_b32 v14, 2
v_mfma_f32_16x16x32_bf16 a[116:119], a[244:247], v[220:223], a[116:119]
s_lshl_b32 s70, s68, 2
ds_read_b64 a[148:149], v6 offset:2560
ds_read_b64 a[150:151], v6 offset:2568
v_mfma_f32_16x16x32_bf16 a[116:119], a[212:215], v[204:207], a[116:119]
s_add_u32 s70, s70, s73
ds_read_b128 a[212:215], v7 offset:1024
ds_read_b64 a[152:153], v6 offset:3072
v_mfma_f32_16x16x32_bf16 a[120:123], a[216:219], v[204:207], a[120:123]
s_nop 0
ds_read_b64 a[154:155], v6 offset:3080
ds_read_b128 a[216:219], v7 offset:512
v_mfma_f32_16x16x32_bf16 a[120:123], a[248:251], v[220:223], a[120:123]
v_mfma_f32_16x16x32_bf16 a[124:127], a[252:255], v[220:223], a[124:127]
s_xor_b32 s71, s12, 0x80
ds_read_b64 a[156:157], v6 offset:3584
ds_read_b64 a[158:159], v6 offset:3592
v_mfma_f32_16x16x32_bf16 a[124:127], a[220:223], v[204:207], a[124:127]
s_add_u32 m0, s77, 0
ds_read_b128 a[220:223], v7 offset:0
s_waitcnt lgkmcnt(0)
v_mfma_f32_16x16x32_bf16 v[128:131], v[8:11], a[192:195], 0
s_add_u32 s72, s71, 0
buffer_load_dwordx4 v15, s[24:27], s72 offen lds
v_mfma_f32_16x16x32_bf16 v[128:131], a[128:131], a[192:195], v[128:131]
v_mfma_f32_16x16x32_bf16 v[132:135], v[8:11], a[196:199], 0
s_nop 0
ds_read_b128 a[224:227], v7 offset:3648
ds_read_b64 a[160:161], v6 offset:64
v_mfma_f32_16x16x32_bf16 v[132:135], a[128:131], a[196:199], v[132:135]
v_accvgpr_read_b32 v240, a64
v_accvgpr_read_b32 v241, a65
v_accvgpr_read_b32 v242, a66
v_mfma_f32_16x16x32_bf16 v[132:135], a[132:135], a[192:195], v[132:135]
s_add_u32 s72, s71, 15360
buffer_load_dwordx4 v15, s[24:27], s72 offen offset:1024 lds
v_accvgpr_read_b32 v243, a67
v_mfma_f32_16x16x32_bf16 v[136:139], v[8:11], a[200:203], 0
s_nop 0
ds_read_b64 a[162:163], v6 offset:72
ds_read_b128 a[228:231], v7 offset:3136
v_mfma_f32_16x16x32_bf16 v[136:139], a[128:131], a[200:203], v[136:139]
s_lshl_b32 s95, s75, 20
v_rcp_f32 v234, v232
v_mfma_f32_16x16x32_bf16 v[136:139], a[132:135], a[196:199], v[136:139]
s_lshl_b32 s74, s58, 18
v_rcp_f32 v238, v236
v_accvgpr_read_b32 v244, a68
v_mfma_f32_16x16x32_bf16 v[136:139], a[136:139], a[192:195], v[136:139]
s_add_u32 s95, s95, s74
ds_read_b64 a[164:165], v6 offset:576
ds_read_b64 a[166:167], v6 offset:584
v_accvgpr_read_b32 v245, a69
v_mfma_f32_16x16x32_bf16 v[140:143], v[8:11], a[204:207], 0
s_add_u32 s72, s71, 30720
buffer_load_dwordx4 v15, s[24:27], s72 offen offset:2048 lds
v_accvgpr_read_b32 v246, a70
v_mfma_f32_16x16x32_bf16 v[140:143], a[128:131], a[204:207], v[140:143]
s_add_u32 s95, s95, 0x2000000
v_accvgpr_read_b32 v247, a71
v_mul_f32 v240, v240, v234
v_mul_f32 v241, v241, v234
v_mfma_f32_16x16x32_bf16 v[140:143], a[132:135], a[200:203], v[140:143]
s_sub_u32 s74, 15, s75
ds_read_b128 a[232:235], v7 offset:2624
ds_read_b64 a[168:169], v6 offset:1088
v_mul_f32 v242, v242, v234
v_mfma_f32_16x16x32_bf16 v[140:143], a[136:139], a[196:199], v[140:143]
s_add_u32 s72, s71, 46080
buffer_load_dwordx4 v15, s[24:27], s72 offen offset:3072 lds
v_mul_f32 v243, v243, v234
v_mfma_f32_16x16x32_bf16 v[140:143], a[140:143], a[192:195], v[140:143]
s_min_u32 s74, s74, s75
v_mul_f32 v244, v244, v234
v_mul_f32 v245, v245, v234
v_mul_f32 v246, v246, v234
v_mfma_f32_16x16x32_bf16 v[144:147], v[8:11], a[208:211], 0
s_lshl_b32 s74, s74, 7
ds_read_b64 a[170:171], v6 offset:1096
ds_read_b128 a[236:239], v7 offset:2112
v_mul_f32 v247, v247, v234
v_mfma_f32_16x16x32_bf16 v[144:147], a[128:131], a[208:211], v[144:147]
s_add_u32 s74, s74, 0x3810000
v_cvt_pk_bf16_f32 v240, v240, v241
v_cvt_pk_bf16_f32 v241, v242, v243
v_cvt_pk_bf16_f32 v242, v244, v245
v_mfma_f32_16x16x32_bf16 v[144:147], a[132:135], a[204:207], v[144:147]
s_xor_b32 s85, s77, 0x10000
v_cvt_pk_bf16_f32 v243, v246, v247
v_mfma_f32_16x16x32_bf16 v[144:147], a[136:139], a[200:203], v[144:147]
s_nop 0
ds_read_b64 a[172:173], v6 offset:1600
ds_read_b64 a[174:175], v6 offset:1608
v_mfma_f32_16x16x32_bf16 v[144:147], a[140:143], a[196:199], v[144:147]
buffer_store_dwordx4 v[240:243], v1, s[44:47], s70 offen sc1
v_mfma_f32_16x16x32_bf16 v[144:147], a[144:147], a[192:195], v[144:147]
v_accvgpr_read_b32 v248, a72
v_accvgpr_read_b32 v249, a73
v_accvgpr_read_b32 v250, a74
v_mfma_f32_16x16x32_bf16 v[148:151], v[8:11], a[212:215], 0
s_nop 0
ds_read_b128 a[240:243], v7 offset:1600
ds_read_b64 a[176:177], v6 offset:2112
v_accvgpr_read_b32 v251, a75
v_mfma_f32_16x16x32_bf16 v[148:151], a[128:131], a[212:215], v[148:151]
v_accvgpr_read_b32 v252, a76
v_accvgpr_read_b32 v253, a77
v_accvgpr_read_b32 v254, a78
v_mfma_f32_16x16x32_bf16 v[148:151], a[132:135], a[208:211], v[148:151]
v_accvgpr_read_b32 v255, a79
v_mul_f32 v248, v248, v234
v_mul_f32 v249, v249, v234
v_mfma_f32_16x16x32_bf16 v[148:151], a[136:139], a[204:207], v[148:151]
s_nop 0
ds_read_b64 a[178:179], v6 offset:2120
ds_read_b128 a[244:247], v7 offset:1088
v_mul_f32 v250, v250, v234
v_mfma_f32_16x16x32_bf16 v[148:151], a[140:143], a[200:203], v[148:151]
v_cmp_ngt_f32 vcc, 0x6f800000, v12
s_or_b32 s83, vcc_lo, vcc_hi
s_cselect_b32 s83, s86, 1
s_lshl_b32 s53, s83, 30
s_xor_b32 s83, s53, 0x40000000
v_or_b32 v13, s83, v13
s_lshl_b32 s83, s58, 2
s_add_u32 s83, s83, s91
s_waitcnt vmcnt(5)
buffer_store_dword v14, v13, s[44:47], s83 offen offset:4 sc1
v_mfma_f32_16x16x32_bf16 v[148:151], a[144:147], a[196:199], v[148:151]
v_mul_f32 v251, v251, v234
v_mul_f32 v252, v252, v234
v_mul_f32 v253, v253, v234
v_mfma_f32_16x16x32_bf16 v[148:151], a[148:151], a[192:195], v[148:151]
s_nop 0
ds_read_b64 a[180:181], v6 offset:2624
ds_read_b64 a[182:183], v6 offset:2632
v_mul_f32 v254, v254, v234
v_mfma_f32_16x16x32_bf16 v[152:155], v[8:11], a[216:219], 0
v_mul_f32 v255, v255, v234
v_cvt_pk_bf16_f32 v248, v248, v249
v_cvt_pk_bf16_f32 v249, v250, v251
v_mfma_f32_16x16x32_bf16 v[152:155], a[128:131], a[216:219], v[152:155]
v_cvt_pk_bf16_f32 v250, v252, v253
v_cvt_pk_bf16_f32 v251, v254, v255
v_mfma_f32_16x16x32_bf16 v[152:155], a[132:135], a[212:215], v[152:155]
s_nop 0
ds_read_b128 a[248:251], v7 offset:576
ds_read_b64 a[184:185], v6 offset:3136
v_mfma_f32_16x16x32_bf16 v[152:155], a[136:139], a[208:211], v[152:155]
buffer_store_dwordx4 v[248:251], v1, s[44:47], s70 offen offset:1024 sc1
v_mfma_f32_16x16x32_bf16 v[152:155], a[140:143], a[204:207], v[152:155]
v_accvgpr_read_b32 v240, a80
v_accvgpr_read_b32 v241, a81
v_accvgpr_read_b32 v242, a82
v_mfma_f32_16x16x32_bf16 v[152:155], a[144:147], a[200:203], v[152:155]
s_nop 0
ds_read_b64 a[186:187], v6 offset:3144
ds_read_b128 a[252:255], v7 offset:64
v_accvgpr_read_b32 v243, a83
v_mfma_f32_16x16x32_bf16 v[152:155], a[148:151], a[196:199], v[152:155]
v_accvgpr_read_b32 v244, a84
v_accvgpr_read_b32 v245, a85
v_accvgpr_read_b32 v246, a86
v_mfma_f32_16x16x32_bf16 v[152:155], a[152:155], a[192:195], v[152:155]
v_accvgpr_read_b32 v247, a87
v_mul_f32 v240, v240, v234
v_mul_f32 v241, v241, v234
v_mfma_f32_16x16x32_bf16 v[156:159], v[8:11], a[220:223], 0
s_nop 0
ds_read_b64 a[188:189], v6 offset:3648
ds_read_b64 a[190:191], v6 offset:3656
v_mul_f32 v242, v242, v234
v_mfma_f32_16x16x32_bf16 v[156:159], a[128:131], a[220:223], v[156:159]
v_mul_f32 v243, v243, v234
v_mul_f32 v244, v244, v234
v_mul_f32 v245, v245, v234
v_mfma_f32_16x16x32_bf16 v[156:159], a[132:135], a[216:219], v[156:159]
v_mul_f32 v246, v246, v234
v_mul_f32 v247, v247, v234
v_cvt_pk_bf16_f32 v240, v240, v241
v_mfma_f32_16x16x32_bf16 v[156:159], a[136:139], a[212:215], v[156:159]
v_cvt_pk_bf16_f32 v241, v242, v243
v_cvt_pk_bf16_f32 v242, v244, v245
v_cvt_pk_bf16_f32 v243, v246, v247
v_mfma_f32_16x16x32_bf16 v[156:159], a[140:143], a[208:211], v[156:159]
buffer_store_dwordx4 v[240:243], v1, s[44:47], s70 offen offset:2048 sc1
v_mfma_f32_16x16x32_bf16 v[156:159], a[144:147], a[204:207], v[156:159]
v_accvgpr_read_b32 v248, a88
v_accvgpr_read_b32 v249, a89
v_accvgpr_read_b32 v250, a90
v_mfma_f32_16x16x32_bf16 v[156:159], a[148:151], a[200:203], v[156:159]
v_accvgpr_read_b32 v251, a91
v_accvgpr_read_b32 v252, a92
v_accvgpr_read_b32 v253, a93
v_mfma_f32_16x16x32_bf16 v[156:159], a[152:155], a[196:199], v[156:159]
v_accvgpr_read_b32 v254, a94
v_accvgpr_read_b32 v255, a95
v_mul_f32 v248, v248, v234
v_mfma_f32_16x16x32_bf16 v[156:159], a[156:159], a[192:195], v[156:159]
s_waitcnt lgkmcnt(0)
v_mul_f32 v249, v249, v234
v_mul_f32 v250, v250, v234
v_mul_f32 v251, v251, v234
v_mfma_f32_16x16x32_bf16 v[128:131], a[160:163], a[224:227], v[128:131]
s_nop 0
ds_read_b128 a[192:195], v7 offset:3712
ds_read_b64 a[128:129], v6 offset:128
v_mul_f32 v252, v252, v234
v_mfma_f32_16x16x32_bf16 v[132:135], a[164:167], a[224:227], v[132:135]
v_mul_f32 v253, v253, v234
v_mul_f32 v254, v254, v234
v_mul_f32 v255, v255, v234
v_mfma_f32_16x16x32_bf16 v[132:135], a[160:163], a[228:231], v[132:135]
s_nop 0
ds_read_b64 a[130:131], v6 offset:136
ds_read_b128 a[196:199], v7 offset:3200
v_cvt_pk_bf16_f32 v248, v248, v249
v_mfma_f32_16x16x32_bf16 v[136:139], a[160:163], a[232:235], v[136:139]
v_cvt_pk_bf16_f32 v249, v250, v251
v_cvt_pk_bf16_f32 v250, v252, v253
v_cvt_pk_bf16_f32 v251, v254, v255
v_mfma_f32_16x16x32_bf16 v[136:139], a[164:167], a[228:231], v[136:139]
buffer_store_dwordx4 v[248:251], v1, s[44:47], s70 offen offset:3072 sc1
v_mfma_f32_16x16x32_bf16 v[136:139], a[168:171], a[224:227], v[136:139]
s_add_u32 s70, s70, 0x80000
ds_read_b64 a[132:133], v6 offset:640
ds_read_b64 a[134:135], v6 offset:648
v_accvgpr_read_b32 v240, a96
v_mfma_f32_16x16x32_bf16 v[140:143], a[172:175], a[224:227], v[140:143]
v_accvgpr_read_b32 v241, a97
v_accvgpr_read_b32 v242, a98
v_accvgpr_read_b32 v243, a99
v_mfma_f32_16x16x32_bf16 v[140:143], a[168:171], a[228:231], v[140:143]
s_nop 0
ds_read_b128 a[200:203], v7 offset:2688
ds_read_b64 a[136:137], v6 offset:1152
v_accvgpr_read_b32 v244, a100
v_mfma_f32_16x16x32_bf16 v[140:143], a[164:167], a[232:235], v[140:143]
v_accvgpr_read_b32 v245, a101
v_accvgpr_read_b32 v246, a102
v_accvgpr_read_b32 v247, a103
v_mfma_f32_16x16x32_bf16 v[140:143], a[160:163], a[236:239], v[140:143]
v_mul_f32 v240, v240, v238
v_mul_f32 v241, v241, v238
v_mul_f32 v242, v242, v238
v_mfma_f32_16x16x32_bf16 v[144:147], a[160:163], a[240:243], v[144:147]
s_nop 0
ds_read_b64 a[138:139], v6 offset:1160
ds_read_b128 a[204:207], v7 offset:2176
v_mul_f32 v243, v243, v238
v_mfma_f32_16x16x32_bf16 v[144:147], a[164:167], a[236:239], v[144:147]
v_mul_f32 v244, v244, v238
v_mul_f32 v245, v245, v238
v_mul_f32 v246, v246, v238
v_mfma_f32_16x16x32_bf16 v[144:147], a[168:171], a[232:235], v[144:147]
s_nop 0
ds_read_b64 a[140:141], v6 offset:1664
ds_read_b64 a[142:143], v6 offset:1672
v_mul_f32 v247, v247, v238
v_mfma_f32_16x16x32_bf16 v[144:147], a[172:175], a[228:231], v[144:147]
v_cvt_pk_bf16_f32 v240, v240, v241
v_cvt_pk_bf16_f32 v241, v242, v243
v_cvt_pk_bf16_f32 v242, v244, v245
v_mfma_f32_16x16x32_bf16 v[144:147], a[176:179], a[224:227], v[144:147]
v_cvt_pk_bf16_f32 v243, v246, v247
v_mfma_f32_16x16x32_bf16 v[148:151], a[180:183], a[224:227], v[148:151]
s_nop 0
ds_read_b128 a[208:211], v7 offset:1664
ds_read_b64 a[144:145], v6 offset:2176
v_mfma_f32_16x16x32_bf16 v[148:151], a[176:179], a[228:231], v[148:151]
buffer_store_dwordx4 v[240:243], v1, s[44:47], s70 offen sc1
v_mfma_f32_16x16x32_bf16 v[148:151], a[172:175], a[232:235], v[148:151]
v_accvgpr_read_b32 v248, a104
v_accvgpr_read_b32 v249, a105
v_accvgpr_read_b32 v250, a106
v_mfma_f32_16x16x32_bf16 v[148:151], a[168:171], a[236:239], v[148:151]
s_nop 0
ds_read_b64 a[146:147], v6 offset:2184
ds_read_b128 a[212:215], v7 offset:1152
v_accvgpr_read_b32 v251, a107
v_mfma_f32_16x16x32_bf16 v[148:151], a[164:167], a[240:243], v[148:151]
v_accvgpr_read_b32 v252, a108
v_accvgpr_read_b32 v253, a109
v_accvgpr_read_b32 v254, a110
v_mfma_f32_16x16x32_bf16 v[148:151], a[160:163], a[244:247], v[148:151]
s_nop 0
ds_read_b64 a[148:149], v6 offset:2688
ds_read_b64 a[150:151], v6 offset:2696
v_accvgpr_read_b32 v255, a111
v_mfma_f32_16x16x32_bf16 v[152:155], a[160:163], a[248:251], v[152:155]
v_mul_f32 v248, v248, v238
v_mul_f32 v249, v249, v238
v_mul_f32 v250, v250, v238
v_mfma_f32_16x16x32_bf16 v[152:155], a[164:167], a[244:247], v[152:155]
v_mul_f32 v251, v251, v238
v_mul_f32 v252, v252, v238
v_mul_f32 v253, v253, v238
v_mfma_f32_16x16x32_bf16 v[152:155], a[168:171], a[240:243], v[152:155]
s_nop 0
ds_read_b128 a[216:219], v7 offset:640
ds_read_b64 a[152:153], v6 offset:3200
v_mul_f32 v254, v254, v238
v_mfma_f32_16x16x32_bf16 v[152:155], a[172:175], a[236:239], v[152:155]
v_mul_f32 v255, v255, v238
v_cvt_pk_bf16_f32 v248, v248, v249
v_cvt_pk_bf16_f32 v249, v250, v251
v_mfma_f32_16x16x32_bf16 v[152:155], a[176:179], a[232:235], v[152:155]
s_nop 0
ds_read_b64 a[154:155], v6 offset:3208
ds_read_b128 a[220:223], v7 offset:128
v_cvt_pk_bf16_f32 v250, v252, v253
v_mfma_f32_16x16x32_bf16 v[152:155], a[180:183], a[228:231], v[152:155]
v_cvt_pk_bf16_f32 v251, v254, v255
v_mfma_f32_16x16x32_bf16 v[152:155], a[184:187], a[224:227], v[152:155]
buffer_store_dwordx4 v[248:251], v1, s[44:47], s70 offen offset:1024 sc1
v_mfma_f32_16x16x32_bf16 v[156:159], a[188:191], a[224:227], v[156:159]
s_nop 0
ds_read_b64 a[156:157], v6 offset:3712
ds_read_b64 a[158:159], v6 offset:3720
v_accvgpr_read_b32 v240, a112
v_mfma_f32_16x16x32_bf16 v[156:159], a[184:187], a[228:231], v[156:159]
v_accvgpr_read_b32 v241, a113
v_accvgpr_read_b32 v242, a114
v_accvgpr_read_b32 v243, a115
v_mfma_f32_16x16x32_bf16 v[156:159], a[180:183], a[232:235], v[156:159]
v_accvgpr_read_b32 v244, a116
v_accvgpr_read_b32 v245, a117
v_accvgpr_read_b32 v246, a118
v_mfma_f32_16x16x32_bf16 v[156:159], a[176:179], a[236:239], v[156:159]
v_accvgpr_read_b32 v247, a119
v_mul_f32 v240, v240, v238
v_mul_f32 v241, v241, v238
v_mfma_f32_16x16x32_bf16 v[156:159], a[172:175], a[240:243], v[156:159]
v_mul_f32 v242, v242, v238
v_mul_f32 v243, v243, v238
v_mul_f32 v244, v244, v238
v_mfma_f32_16x16x32_bf16 v[156:159], a[168:171], a[244:247], v[156:159]
v_mul_f32 v245, v245, v238
v_mul_f32 v246, v246, v238
v_mul_f32 v247, v247, v238
v_mfma_f32_16x16x32_bf16 v[156:159], a[164:167], a[248:251], v[156:159]
v_cvt_pk_bf16_f32 v240, v240, v241
v_cvt_pk_bf16_f32 v241, v242, v243
v_cvt_pk_bf16_f32 v242, v244, v245
v_mfma_f32_16x16x32_bf16 v[156:159], a[160:163], a[252:255], v[156:159]
s_waitcnt lgkmcnt(0)
v_cvt_pk_bf16_f32 v243, v246, v247
v_mfma_f32_16x16x32_bf16 v[128:131], a[128:131], a[192:195], v[128:131]
s_nop 0
ds_read_b128 a[224:227], v7 offset:3776
ds_read_b64 a[160:161], v6 offset:192
v_mfma_f32_16x16x32_bf16 v[132:135], a[132:135], a[192:195], v[132:135]
buffer_store_dwordx4 v[240:243], v1, s[44:47], s70 offen offset:2048 sc1
v_mfma_f32_16x16x32_bf16 v[132:135], a[128:131], a[196:199], v[132:135]
s_nop 0
ds_read_b64 a[162:163], v6 offset:200
ds_read_b128 a[228:231], v7 offset:3264
v_accvgpr_read_b32 v248, a120
v_mfma_f32_16x16x32_bf16 v[136:139], a[128:131], a[200:203], v[136:139]
v_accvgpr_read_b32 v249, a121
v_accvgpr_read_b32 v250, a122
v_accvgpr_read_b32 v251, a123
v_mfma_f32_16x16x32_bf16 v[136:139], a[132:135], a[196:199], v[136:139]
v_accvgpr_read_b32 v252, a124
v_accvgpr_read_b32 v253, a125
v_accvgpr_read_b32 v254, a126
v_mfma_f32_16x16x32_bf16 v[136:139], a[136:139], a[192:195], v[136:139]
s_nop 0
ds_read_b64 a[164:165], v6 offset:704
ds_read_b64 a[166:167], v6 offset:712
v_accvgpr_read_b32 v255, a127
v_mfma_f32_16x16x32_bf16 v[140:143], a[140:143], a[192:195], v[140:143]
v_mul_f32 v248, v248, v238
v_mul_f32 v249, v249, v238
v_mul_f32 v250, v250, v238
v_mfma_f32_16x16x32_bf16 v[140:143], a[136:139], a[196:199], v[140:143]
s_nop 0
ds_read_b128 a[232:235], v7 offset:2752
ds_read_b64 a[168:169], v6 offset:1216
v_mul_f32 v251, v251, v238
v_mfma_f32_16x16x32_bf16 v[140:143], a[132:135], a[200:203], v[140:143]
v_mul_f32 v252, v252, v238
v_mul_f32 v253, v253, v238
v_mul_f32 v254, v254, v238
v_mfma_f32_16x16x32_bf16 v[140:143], a[128:131], a[204:207], v[140:143]
v_mul_f32 v255, v255, v238
v_cvt_pk_bf16_f32 v248, v248, v249
v_cvt_pk_bf16_f32 v249, v250, v251
v_mfma_f32_16x16x32_bf16 v[144:147], a[128:131], a[208:211], v[144:147]
s_nop 0
ds_read_b64 a[170:171], v6 offset:1224
ds_read_b128 a[236:239], v7 offset:2240
v_cvt_pk_bf16_f32 v250, v252, v253
v_mfma_f32_16x16x32_bf16 v[144:147], a[132:135], a[204:207], v[144:147]
v_cvt_pk_bf16_f32 v251, v254, v255
v_mfma_f32_16x16x32_bf16 v[144:147], a[136:139], a[200:203], v[144:147]
s_nop 0
ds_read_b64 a[172:173], v6 offset:1728
ds_read_b64 a[174:175], v6 offset:1736
v_mfma_f32_16x16x32_bf16 v[144:147], a[140:143], a[196:199], v[144:147]
buffer_store_dwordx4 v[248:251], v1, s[44:47], s70 offen offset:3072 sc1
v_mfma_f32_16x16x32_bf16 v[144:147], a[144:147], a[192:195], v[144:147]
s_mov_b32 s73, 0x6f800000
v_add_f32 v227, v224, v228
v_add_f32 v231, v232, v236
v_add_f32 v227, v227, v231
v_mfma_f32_16x16x32_bf16 v[148:151], a[148:151], a[192:195], v[148:151]
Lstub9:
s_cbranch_execz Lret
s_nop 0
ds_read_b128 a[240:243], v7 offset:1728
ds_read_b64 a[176:177], v6 offset:2240
v_cmp_nlt_f32 vcc, v227, s73
v_mfma_f32_16x16x32_bf16 v[148:151], a[144:147], a[196:199], v[148:151]
s_lshl_b32 s73, s58, 2
v_mfma_f32_16x16x32_bf16 v[148:151], a[140:143], a[200:203], v[148:151]
s_add_u32 s73, s73, 163328
v_mov_b32 v231, s73
v_mfma_f32_16x16x32_bf16 v[148:151], a[136:139], a[204:207], v[148:151]
s_or_b32 s73, vcc_lo, vcc_hi
ds_read_b64 a[178:179], v6 offset:2248
ds_read_b128 a[244:247], v7 offset:1216
v_mfma_f32_16x16x32_bf16 v[148:151], a[132:135], a[208:211], v[148:151]
s_min_u32 s73, s73, 1
v_mov_b32 v227, s73
v_mfma_f32_16x16x32_bf16 v[148:151], a[128:131], a[212:215], v[148:151]
s_nop 0
ds_read_b64 a[180:181], v6 offset:2752
ds_read_b64 a[182:183], v6 offset:2760
ds_write_b32 v231, v227
v_mfma_f32_16x16x32_bf16 v[152:155], a[128:131], a[216:219], v[152:155]
v_mfma_f32_16x16x32_bf16 v[152:155], a[132:135], a[212:215], v[152:155]
v_mfma_f32_16x16x32_bf16 v[152:155], a[136:139], a[208:211], v[152:155]
s_nop 0
ds_read_b128 a[248:251], v7 offset:704
ds_read_b64 a[184:185], v6 offset:3264
v_mfma_f32_16x16x32_bf16 v[152:155], a[140:143], a[204:207], v[152:155]
v_mfma_f32_16x16x32_bf16 v[152:155], a[144:147], a[200:203], v[152:155]
s_nop 0
ds_read_b64 a[186:187], v6 offset:3272
ds_read_b128 a[252:255], v7 offset:192
v_mfma_f32_16x16x32_bf16 v[152:155], a[148:151], a[196:199], v[152:155]
v_mfma_f32_16x16x32_bf16 v[152:155], a[152:155], a[192:195], v[152:155]
v_mfma_f32_16x16x32_bf16 v[156:159], a[156:159], a[192:195], v[156:159]
s_nop 0
ds_read_b64 a[188:189], v6 offset:3776
ds_read_b64 a[190:191], v6 offset:3784
v_mfma_f32_16x16x32_bf16 v[156:159], a[152:155], a[196:199], v[156:159]
v_mfma_f32_16x16x32_bf16 v[156:159], a[148:151], a[200:203], v[156:159]
v_mfma_f32_16x16x32_bf16 v[156:159], a[144:147], a[204:207], v[156:159]
v_mfma_f32_16x16x32_bf16 v[156:159], a[140:143], a[208:211], v[156:159]
v_mfma_f32_16x16x32_bf16 v[156:159], a[136:139], a[212:215], v[156:159]
v_mfma_f32_16x16x32_bf16 v[156:159], a[132:135], a[216:219], v[156:159]
v_mfma_f32_16x16x32_bf16 v[156:159], a[128:131], a[220:223], v[156:159]
s_waitcnt lgkmcnt(0)
v_mfma_f32_16x16x32_bf16 v[128:131], a[160:163], a[224:227], v[128:131]
s_nop 0
ds_read_b128 a[192:195], v7 offset:3840
ds_read_b64 a[128:129], v6 offset:256
v_mfma_f32_16x16x32_bf16 v[132:135], a[164:167], a[224:227], v[132:135]
v_mfma_f32_16x16x32_bf16 v[132:135], a[160:163], a[228:231], v[132:135]
s_nop 0
ds_read_b64 a[130:131], v6 offset:264
ds_read_b128 a[196:199], v7 offset:3328
v_mfma_f32_16x16x32_bf16 v[136:139], a[160:163], a[232:235], v[136:139]
v_mfma_f32_16x16x32_bf16 v[136:139], a[164:167], a[228:231], v[136:139]
v_mfma_f32_16x16x32_bf16 v[136:139], a[168:171], a[224:227], v[136:139]
s_nop 0
ds_read_b64 a[132:133], v6 offset:768
ds_read_b64 a[134:135], v6 offset:776
v_mfma_f32_16x16x32_bf16 v[140:143], a[172:175], a[224:227], v[140:143]
v_mfma_f32_16x16x32_bf16 v[140:143], a[168:171], a[228:231], v[140:143]
s_nop 0
ds_read_b128 a[200:203], v7 offset:2816
ds_read_b64 a[136:137], v6 offset:1280
v_mfma_f32_16x16x32_bf16 v[140:143], a[164:167], a[232:235], v[140:143]
v_mfma_f32_16x16x32_bf16 v[140:143], a[160:163], a[236:239], v[140:143]
v_mfma_f32_16x16x32_bf16 v[144:147], a[160:163], a[240:243], v[144:147]
s_nop 0
ds_read_b64 a[138:139], v6 offset:1288
ds_read_b128 a[204:207], v7 offset:2304
v_mfma_f32_16x16x32_bf16 v[144:147], a[164:167], a[236:239], v[144:147]
v_mfma_f32_16x16x32_bf16 v[144:147], a[168:171], a[232:235], v[144:147]
s_nop 0
ds_read_b64 a[140:141], v6 offset:1792
ds_read_b64 a[142:143], v6 offset:1800
v_mfma_f32_16x16x32_bf16 v[144:147], a[172:175], a[228:231], v[144:147]
v_mfma_f32_16x16x32_bf16 v[144:147], a[176:179], a[224:227], v[144:147]
s_xor_b32 s71, s12, 0x100
v_mfma_f32_16x16x32_bf16 v[148:151], a[180:183], a[224:227], v[148:151]
s_add_u32 m0, s77, 16384
ds_read_b128 a[208:211], v7 offset:1792
ds_read_b64 a[144:145], v6 offset:2304
v_mfma_f32_16x16x32_bf16 v[148:151], a[176:179], a[228:231], v[148:151]
s_add_u32 s72, s71, 0
buffer_load_dwordx4 v15, s[24:27], s72 offen lds
s_nop 3
s_mov_b64 exec, 0
s_cmp_eq_u32 s58, 0
s_cbranch_scc1 Lstube0
s_cmp_eq_u32 s58, 1
s_cbranch_scc1 Lstube1
s_cmp_eq_u32 s58, 2
s_cbranch_scc1 Lstube2
s_branch Lstube3
Lrete:
s_mov_b64 exec, -1
s_nop 3
v_mfma_f32_16x16x32_bf16 v[148:151], a[172:175], a[232:235], v[148:151]
s_waitcnt vmcnt(1) lgkmcnt(15)
v_mfma_f32_16x16x32_bf16 v[148:151], a[168:171], a[236:239], v[148:151]
s_barrier
ds_read_b64 a[146:147], v6 offset:2312
ds_read_b128 a[212:215], v7 offset:1280
v_mfma_f32_16x16x32_bf16 v[148:151], a[164:167], a[240:243], v[148:151]
s_add_u32 s72, s71, 15360
buffer_load_dwordx4 v15, s[24:27], s72 offen offset:1024 lds
v_mfma_f32_16x16x32_bf16 v[148:151], a[160:163], a[244:247], v[148:151]
s_nop 0
ds_read_b64 a[148:149], v6 offset:2816
ds_read_b64 a[150:151], v6 offset:2824
v_mfma_f32_16x16x32_bf16 v[152:155], a[160:163], a[248:251], v[152:155]
v_mov_b32 v244, 163328
v_mfma_f32_16x16x32_bf16 v[152:155], a[164:167], a[244:247], v[152:155]
ds_read_b128 v[240:243], v244
v_mfma_f32_16x16x32_bf16 v[152:155], a[168:171], a[240:243], v[152:155]
s_nop 0
ds_read_b128 a[216:219], v7 offset:768
ds_read_b64 a[152:153], v6 offset:3328
v_mfma_f32_16x16x32_bf16 v[152:155], a[172:175], a[236:239], v[152:155]
v_mfma_f32_16x16x32_bf16 v[152:155], a[176:179], a[232:235], v[152:155]
s_add_u32 s72, s71, 30720
ds_read_b64 a[154:155], v6 offset:3336
ds_read_b128 a[220:223], v7 offset:256
v_mfma_f32_16x16x32_bf16 v[152:155], a[180:183], a[228:231], v[152:155]
buffer_load_dwordx4 v15, s[24:27], s72 offen offset:2048 lds
v_mfma_f32_16x16x32_bf16 v[152:155], a[184:187], a[224:227], v[152:155]
s_waitcnt lgkmcnt(4)
v_or3_b32 v240, v240, v241, v242
v_or_b32 v240, v240, v243
v_mfma_f32_16x16x32_bf16 v[156:159], a[188:191], a[224:227], v[156:159]
s_nop 0
ds_read_b64 a[156:157], v6 offset:3840
ds_read_b64 a[158:159], v6 offset:3848
v_cmp_lt_u32 vcc, s86, v240
s_cbranch_vccnz Lslow
v_mfma_f32_16x16x32_bf16 v[156:159], a[184:187], a[228:231], v[156:159]
v_or_b32 v240, s58, v0
v_mov_b32 v241, 2
v_mfma_f32_16x16x32_bf16 v[156:159], a[180:183], a[232:235], v[156:159]
v_min_u32 v240, 1, v240
v_lshlrev_b32 v240, 30, v240
v_mfma_f32_16x16x32_bf16 v[156:159], a[176:179], a[236:239], v[156:159]
s_add_u32 s72, s71, 46080
buffer_load_dwordx4 v15, s[24:27], s72 offen offset:3072 lds
v_mfma_f32_16x16x32_bf16 v[156:159], a[172:175], a[240:243], v[156:159]
buffer_store_dword v241, v240, s[44:47], s91 offen sc1
v_mfma_f32_16x16x32_bf16 v[156:159], a[168:171], a[244:247], v[156:159]
s_add_u32 s80, s93, 0x3400000
v_and_b32 v166, 7, v0
v_lshlrev_b32 v166, 4, v166
v_mfma_f32_16x16x32_bf16 v[156:159], a[164:167], a[248:251], v[156:159]
s_and_b32 s81, s59, 4
v_and_b32 v3, 3, v0
v_add_u32 v3, 1, v3
v_mfma_f32_16x16x32_bf16 v[156:159], a[160:163], a[252:255], v[156:159]
s_waitcnt lgkmcnt(0)
v_mul_u32_u24 v3, s81, v3
v_lshrrev_b32 v2, 4, v0
v_mfma_f32_16x16x32_bf16 v[128:131], a[128:131], a[192:195], v[128:131]
s_nop 0
ds_read_b128 a[224:227], v7 offset:3904
ds_read_b64 a[160:161], v6 offset:320
v_mfma_f32_16x16x32_bf16 v[132:135], a[132:135], a[192:195], v[132:135]
s_xor_b32 s71, s12, 0x180
v_lshl_add_u32 v2, v2, 10, v3
v_bfe_u32 v112, v0, 3, 1
v_mfma_f32_16x16x32_bf16 v[132:135], a[128:131], a[196:199], v[132:135]
s_add_u32 m0, s77, 32768
ds_read_b64 a[162:163], v6 offset:328
ds_read_b128 a[228:231], v7 offset:3392
v_mfma_f32_16x16x32_bf16 v[136:139], a[128:131], a[200:203], v[136:139]
s_add_u32 s72, s71, 0
buffer_load_dwordx4 v15, s[24:27], s72 offen lds
v_mfma_f32_16x16x32_bf16 v[136:139], a[132:135], a[196:199], v[136:139]
s_xor_b32 s82, s78, 0
v_lshl_add_u32 v166, v112, 8, v166
v_bfe_u32 v112, v0, 4, 1
v_mfma_f32_16x16x32_bf16 v[136:139], a[136:139], a[192:195], v[136:139]
s_lshl_b32 s82, s82, 10
ds_read_b64 a[164:165], v6 offset:832
ds_read_b64 a[166:167], v6 offset:840
v_mfma_f32_16x16x32_bf16 v[140:143], a[140:143], a[192:195], v[140:143]
s_add_u32 s82, s82, s74
buffer_load_dword v3, v2, s[44:47], s82 offen sc1
v_mfma_f32_16x16x32_bf16 v[140:143], a[136:139], a[196:199], v[140:143]
s_add_u32 s72, s71, 15360
ds_read_b128 a[232:235], v7 offset:2880
ds_read_b64 a[168:169], v6 offset:1344
v_mfma_f32_16x16x32_bf16 v[140:143], a[132:135], a[200:203], v[140:143]
buffer_load_dwordx4 v15, s[24:27], s72 offen offset:1024 lds
v_mfma_f32_16x16x32_bf16 v[140:143], a[128:131], a[204:207], v[140:143]
v_lshl_add_u32 v166, v112, 7, v166
v_lshrrev_b32 v112, 5, v0
v_mfma_f32_16x16x32_bf16 v[144:147], a[128:131], a[208:211], v[144:147]
s_nop 0
ds_read_b64 a[170:171], v6 offset:1352
ds_read_b128 a[236:239], v7 offset:2368
v_mfma_f32_16x16x32_bf16 v[144:147], a[132:135], a[204:207], v[144:147]
v_lshl_add_u32 v166, v112, 9, v166
v_and_b32 v112, 15, v0
v_mfma_f32_16x16x32_bf16 v[144:147], a[136:139], a[200:203], v[144:147]
s_nop 0
ds_read_b64 a[172:173], v6 offset:1856
ds_read_b64 a[174:175], v6 offset:1864
v_mfma_f32_16x16x32_bf16 v[144:147], a[140:143], a[196:199], v[144:147]
s_add_u32 s72, s71, 30720
buffer_load_dwordx4 v15, s[24:27], s72 offen offset:2048 lds
v_mfma_f32_16x16x32_bf16 v[144:147], a[144:147], a[192:195], v[144:147]
v_lshrrev_b32 v113, 2, v0
v_bfe_u32 v114, v0, 3, 2
v_mfma_f32_16x16x32_bf16 v[148:151], a[148:151], a[192:195], v[148:151]
s_nop 0
ds_read_b128 a[240:243], v7 offset:1856
ds_read_b64 a[176:177], v6 offset:2368
v_mfma_f32_16x16x32_bf16 v[148:151], a[144:147], a[196:199], v[148:151]
v_and_b32 v115, 3, v0
v_lshlrev_b32 v8, 7, v113
v_mfma_f32_16x16x32_bf16 v[148:151], a[140:143], a[200:203], v[148:151]
v_lshl_add_u32 v8, v114, 5, v8
v_lshl_add_u32 v8, v115, 3, v8
v_mfma_f32_16x16x32_bf16 v[148:151], a[136:139], a[204:207], v[148:151]
s_nop 0
ds_read_b64 a[178:179], v6 offset:2376
ds_read_b128 a[244:247], v7 offset:1344
v_mfma_f32_16x16x32_bf16 v[148:151], a[132:135], a[208:211], v[148:151]
s_add_u32 s72, s71, 46080
buffer_load_dwordx4 v15, s[24:27], s72 offen offset:3072 lds
v_mfma_f32_16x16x32_bf16 v[148:151], a[128:131], a[212:215], v[148:151]
s_nop 0
ds_read_b64 a[180:181], v6 offset:2880
ds_read_b64 a[182:183], v6 offset:2888
v_mfma_f32_16x16x32_bf16 v[152:155], a[128:131], a[216:219], v[152:155]
v_add_u32 v8, s77, v8
v_subrev_u32 v8, s64, v8
v_mfma_f32_16x16x32_bf16 v[152:155], a[132:135], a[212:215], v[152:155]
v_xor_b32 v9, 32, v8
v_xor_b32 v10, 64, v8
v_mfma_f32_16x16x32_bf16 v[152:155], a[136:139], a[208:211], v[152:155]
s_nop 0
ds_read_b128 a[248:251], v7 offset:832
ds_read_b64 a[184:185], v6 offset:3392
v_mfma_f32_16x16x32_bf16 v[152:155], a[140:143], a[204:207], v[152:155]
v_xor_b32 v11, 0x60, v8
v_lshlrev_b32 v5, 8, v113
v_mfma_f32_16x16x32_bf16 v[152:155], a[144:147], a[200:203], v[152:155]
s_xor_b32 s71, s13, 0x80
ds_read_b64 a[186:187], v6 offset:3400
ds_read_b128 a[252:255], v7 offset:320
v_mfma_f32_16x16x32_bf16 v[152:155], a[148:151], a[196:199], v[152:155]
s_add_u32 m0, s77, 49152
v_and_b32 v114, 1, v0
v_lshl_add_u32 v5, v114, 7, v5
v_mfma_f32_16x16x32_bf16 v[152:155], a[152:155], a[192:195], v[152:155]
s_add_u32 s72, s71, 0
buffer_load_dwordx4 v15, s[24:27], s72 offen lds
v_mfma_f32_16x16x32_bf16 v[156:159], a[156:159], a[192:195], v[156:159]
s_nop 0
ds_read_b64 a[188:189], v6 offset:3904
ds_read_b64 a[190:191], v6 offset:3912
v_mfma_f32_16x16x32_bf16 v[156:159], a[152:155], a[196:199], v[156:159]
v_bfe_u32 v114, v0, 1, 1
v_lshl_add_u32 v5, v114, 3, v5
v_mfma_f32_16x16x32_bf16 v[156:159], a[148:151], a[200:203], v[156:159]
v_lshlrev_b32 v114, 1, s58
v_xor_b32 v114, v114, v113
v_mfma_f32_16x16x32_bf16 v[156:159], a[144:147], a[204:207], v[156:159]
s_add_u32 s72, s71, 15360
buffer_load_dwordx4 v15, s[24:27], s72 offen offset:1024 lds
v_mfma_f32_16x16x32_bf16 v[156:159], a[140:143], a[208:211], v[156:159]
v_and_b32 v114, 7, v114
v_lshl_add_u32 v5, v114, 4, v5
v_mfma_f32_16x16x32_bf16 v[156:159], a[136:139], a[212:215], v[156:159]
v_add_u32 v5, 147456, v5
v_bfe_u32 v114, v0, 1, 2
v_mfma_f32_16x16x32_bf16 v[156:159], a[132:135], a[216:219], v[156:159]
v_lshrrev_b32 v115, 4, v0
v_lshlrev_b32 v116, 7, v112
v_mfma_f32_16x16x32_bf16 v[156:159], a[128:131], a[220:223], v[156:159]
s_waitcnt lgkmcnt(0)
v_lshl_add_u32 v116, v114, 5, v116
v_lshl_add_u32 v116, v115, 3, v116
v_mfma_f32_16x16x32_bf16 v[128:131], a[160:163], a[224:227], v[128:131]
s_nop 0
ds_read_b128 a[192:195], v7 offset:3968
ds_read_b64 a[128:129], v6 offset:384
v_mfma_f32_16x16x32_bf16 v[132:135], a[164:167], a[224:227], v[132:135]
s_add_u32 s72, s71, 30720
buffer_load_dwordx4 v15, s[24:27], s72 offen offset:2048 lds
v_mfma_f32_16x16x32_bf16 v[132:135], a[160:163], a[228:231], v[132:135]
s_nop 0
ds_read_b64 a[130:131], v6 offset:392
ds_read_b128 a[196:199], v7 offset:3456
v_mfma_f32_16x16x32_bf16 v[136:139], a[160:163], a[232:235], v[136:139]
v_add_u32 v116, s64, v116
v_add_u32 v116, 131072, v116
v_mfma_f32_16x16x32_bf16 v[136:139], a[164:167], a[228:231], v[136:139]
v_xor_b32 v117, 32, v116
v_xor_b32 v118, 64, v116
v_mfma_f32_16x16x32_bf16 v[136:139], a[168:171], a[224:227], v[136:139]
s_nop 0
ds_read_b64 a[132:133], v6 offset:896
ds_read_b64 a[134:135], v6 offset:904
v_mfma_f32_16x16x32_bf16 v[140:143], a[172:175], a[224:227], v[140:143]
v_xor_b32 v119, 0x60, v116
v_mfma_f32_16x16x32_bf16 v[140:143], a[168:171], a[228:231], v[140:143]
s_add_u32 s72, s71, 46080
ds_read_b128 a[200:203], v7 offset:2944
ds_read_b64 a[136:137], v6 offset:1408
v_mfma_f32_16x16x32_bf16 v[140:143], a[164:167], a[232:235], v[140:143]
buffer_load_dwordx4 v15, s[24:27], s72 offen offset:3072 lds
v_mfma_f32_16x16x32_bf16 v[140:143], a[160:163], a[236:239], v[140:143]
v_mfma_f32_16x16x32_bf16 v[144:147], a[160:163], a[240:243], v[144:147]
s_nop 0
ds_read_b64 a[138:139], v6 offset:1416
ds_read_b128 a[204:207], v7 offset:2432
v_mfma_f32_16x16x32_bf16 v[144:147], a[164:167], a[236:239], v[144:147]
v_mfma_f32_16x16x32_bf16 v[144:147], a[168:171], a[232:235], v[144:147]
s_nop 0
ds_read_b64 a[140:141], v6 offset:1920
ds_read_b64 a[142:143], v6 offset:1928
v_mfma_f32_16x16x32_bf16 v[144:147], a[172:175], a[228:231], v[144:147]
v_mfma_f32_16x16x32_bf16 v[144:147], a[176:179], a[224:227], v[144:147]
v_mfma_f32_16x16x32_bf16 v[148:151], a[180:183], a[224:227], v[148:151]
s_nop 0
ds_read_b128 a[208:211], v7 offset:1920
ds_read_b64 a[144:145], v6 offset:2432
v_mfma_f32_16x16x32_bf16 v[148:151], a[176:179], a[228:231], v[148:151]
v_mfma_f32_16x16x32_bf16 v[148:151], a[172:175], a[232:235], v[148:151]
s_waitcnt vmcnt(7)
v_cmp_gt_u32 vcc, 2, v3
s_or_b32 s81, vcc_lo, vcc_hi
s_cselect_b32 s81, 0x40000000, 0
v_or_b32 v4, s81, v1
v_mfma_f32_16x16x32_bf16 v[148:151], a[168:171], a[236:239], v[148:151]
s_nop 0
ds_read_b64 a[146:147], v6 offset:2440
ds_read_b128 a[212:215], v7 offset:1408
v_mfma_f32_16x16x32_bf16 v[148:151], a[164:167], a[240:243], v[148:151]
v_mfma_f32_16x16x32_bf16 v[148:151], a[160:163], a[244:247], v[148:151]
s_nop 0
ds_read_b64 a[148:149], v6 offset:2944
ds_read_b64 a[150:151], v6 offset:2952
v_mfma_f32_16x16x32_bf16 v[152:155], a[160:163], a[248:251], v[152:155]
v_mfma_f32_16x16x32_bf16 v[152:155], a[164:167], a[244:247], v[152:155]
s_lshr_b32 s69, s12, 18
v_mfma_f32_16x16x32_bf16 v[152:155], a[168:171], a[240:243], v[152:155]
s_lshl_b32 s69, s69, 12
ds_read_b128 a[216:219], v7 offset:896
ds_read_b64 a[152:153], v6 offset:3456
v_mfma_f32_16x16x32_bf16 v[152:155], a[172:175], a[236:239], v[152:155]
s_add_u32 s69, s69, s95
buffer_load_dwordx4 a[0:3], v4, s[44:47], s69 offen sc1
v_mfma_f32_16x16x32_bf16 v[152:155], a[176:179], a[232:235], v[152:155]
s_nop 0
ds_read_b64 a[154:155], v6 offset:3464
ds_read_b128 a[220:223], v7 offset:384
v_mfma_f32_16x16x32_bf16 v[152:155], a[180:183], a[228:231], v[152:155]
v_mfma_f32_16x16x32_bf16 v[152:155], a[184:187], a[224:227], v[152:155]
v_mfma_f32_16x16x32_bf16 v[156:159], a[188:191], a[224:227], v[156:159]
s_nop 0
ds_read_b64 a[156:157], v6 offset:3968
ds_read_b64 a[158:159], v6 offset:3976
v_mfma_f32_16x16x32_bf16 v[156:159], a[184:187], a[228:231], v[156:159]
buffer_load_dwordx4 a[4:7], v4, s[44:47], s69 offen offset:1024 sc1
v_mfma_f32_16x16x32_bf16 v[156:159], a[180:183], a[232:235], v[156:159]
v_mfma_f32_16x16x32_bf16 v[156:159], a[176:179], a[236:239], v[156:159]
v_mfma_f32_16x16x32_bf16 v[156:159], a[172:175], a[240:243], v[156:159]
v_mfma_f32_16x16x32_bf16 v[156:159], a[168:171], a[244:247], v[156:159]
buffer_load_dwordx4 a[8:11], v4, s[44:47], s69 offen offset:2048 sc1
v_mfma_f32_16x16x32_bf16 v[156:159], a[164:167], a[248:251], v[156:159]
v_mfma_f32_16x16x32_bf16 v[156:159], a[160:163], a[252:255], v[156:159]
s_waitcnt lgkmcnt(0)
v_mfma_f32_16x16x32_bf16 v[128:131], a[128:131], a[192:195], v[128:131]
s_nop 0
ds_read_b128 a[224:227], v7 offset:4032
ds_read_b64 a[160:161], v6 offset:448
v_mfma_f32_16x16x32_bf16 v[132:135], a[132:135], a[192:195], v[132:135]
v_mfma_f32_16x16x32_bf16 v[132:135], a[128:131], a[196:199], v[132:135]
s_nop 0
ds_read_b64 a[162:163], v6 offset:456
ds_read_b128 a[228:231], v7 offset:3520
v_mfma_f32_16x16x32_bf16 v[136:139], a[128:131], a[200:203], v[136:139]
buffer_load_dwordx4 a[12:15], v4, s[44:47], s69 offen offset:3072 sc1
v_mfma_f32_16x16x32_bf16 v[136:139], a[132:135], a[196:199], v[136:139]
v_mfma_f32_16x16x32_bf16 v[136:139], a[136:139], a[192:195], v[136:139]
s_nop 0
ds_read_b64 a[164:165], v6 offset:960
ds_read_b64 a[166:167], v6 offset:968
v_mfma_f32_16x16x32_bf16 v[140:143], a[140:143], a[192:195], v[140:143]
v_mfma_f32_16x16x32_bf16 v[140:143], a[136:139], a[196:199], v[140:143]
s_nop 0
ds_read_b128 a[232:235], v7 offset:3008
ds_read_b64 a[168:169], v6 offset:1472
v_mfma_f32_16x16x32_bf16 v[140:143], a[132:135], a[200:203], v[140:143]
s_add_u32 s69, s69, 0x20000
buffer_load_dwordx4 a[16:19], v4, s[44:47], s69 offen sc1
v_mfma_f32_16x16x32_bf16 v[140:143], a[128:131], a[204:207], v[140:143]
v_mfma_f32_16x16x32_bf16 v[144:147], a[128:131], a[208:211], v[144:147]
s_nop 0
ds_read_b64 a[170:171], v6 offset:1480
ds_read_b128 a[236:239], v7 offset:2496
v_mfma_f32_16x16x32_bf16 v[144:147], a[132:135], a[204:207], v[144:147]
v_mfma_f32_16x16x32_bf16 v[144:147], a[136:139], a[200:203], v[144:147]
s_nop 0
ds_read_b64 a[172:173], v6 offset:1984
ds_read_b64 a[174:175], v6 offset:1992
v_mfma_f32_16x16x32_bf16 v[144:147], a[140:143], a[196:199], v[144:147]
buffer_load_dwordx4 a[20:23], v4, s[44:47], s69 offen offset:1024 sc1
v_mfma_f32_16x16x32_bf16 v[144:147], a[144:147], a[192:195], v[144:147]
v_mfma_f32_16x16x32_bf16 v[148:151], a[148:151], a[192:195], v[148:151]
s_nop 0
ds_read_b128 a[240:243], v7 offset:1984
ds_read_b64 a[176:177], v6 offset:2496
v_mfma_f32_16x16x32_bf16 v[148:151], a[144:147], a[196:199], v[148:151]
v_mfma_f32_16x16x32_bf16 v[148:151], a[140:143], a[200:203], v[148:151]
v_mfma_f32_16x16x32_bf16 v[148:151], a[136:139], a[204:207], v[148:151]
s_nop 0
ds_read_b64 a[178:179], v6 offset:2504
ds_read_b128 a[244:247], v7 offset:1472
v_mfma_f32_16x16x32_bf16 v[148:151], a[132:135], a[208:211], v[148:151]
buffer_load_dwordx4 a[24:27], v4, s[44:47], s69 offen offset:2048 sc1
v_mfma_f32_16x16x32_bf16 v[148:151], a[128:131], a[212:215], v[148:151]
s_nop 0
ds_read_b64 a[180:181], v6 offset:3008
ds_read_b64 a[182:183], v6 offset:3016
v_mfma_f32_16x16x32_bf16 v[152:155], a[128:131], a[216:219], v[152:155]
v_mfma_f32_16x16x32_bf16 v[152:155], a[132:135], a[212:215], v[152:155]
v_mfma_f32_16x16x32_bf16 v[152:155], a[136:139], a[208:211], v[152:155]
s_nop 0
ds_read_b128 a[248:251], v7 offset:960
ds_read_b64 a[184:185], v6 offset:3520
v_mfma_f32_16x16x32_bf16 v[152:155], a[140:143], a[204:207], v[152:155]
buffer_load_dwordx4 a[28:31], v4, s[44:47], s69 offen offset:3072 sc1
v_mfma_f32_16x16x32_bf16 v[152:155], a[144:147], a[200:203], v[152:155]
s_nop 0
ds_read_b64 a[186:187], v6 offset:3528
ds_read_b128 a[252:255], v7 offset:448
v_mfma_f32_16x16x32_bf16 v[152:155], a[148:151], a[196:199], v[152:155]
v_mfma_f32_16x16x32_bf16 v[152:155], a[152:155], a[192:195], v[152:155]
s_lshr_b32 s69, s13, 18
v_mfma_f32_16x16x32_bf16 v[156:159], a[156:159], a[192:195], v[156:159]
s_lshl_b32 s69, s69, 12
ds_read_b64 a[188:189], v6 offset:4032
ds_read_b64 a[190:191], v6 offset:4040
v_mfma_f32_16x16x32_bf16 v[156:159], a[152:155], a[196:199], v[156:159]
s_add_u32 s69, s69, s95
buffer_load_dwordx4 a[32:35], v4, s[44:47], s69 offen sc1
v_mfma_f32_16x16x32_bf16 v[156:159], a[148:151], a[200:203], v[156:159]
v_mfma_f32_16x16x32_bf16 v[156:159], a[144:147], a[204:207], v[156:159]
v_mfma_f32_16x16x32_bf16 v[156:159], a[140:143], a[208:211], v[156:159]
v_mfma_f32_16x16x32_bf16 v[156:159], a[136:139], a[212:215], v[156:159]
buffer_load_dwordx4 a[36:39], v4, s[44:47], s69 offen offset:1024 sc1
v_mfma_f32_16x16x32_bf16 v[156:159], a[132:135], a[216:219], v[156:159]
v_mfma_f32_16x16x32_bf16 v[156:159], a[128:131], a[220:223], v[156:159]
s_waitcnt lgkmcnt(0)
v_mfma_f32_16x16x32_bf16 v[128:131], a[160:163], a[224:227], v[128:131]
s_nop 0
ds_read_b64_tr_b16 v[192:193], v8 offset:0
ds_read_b64_tr_b16 v[194:195], v8 offset:2048
v_mfma_f32_16x16x32_bf16 v[132:135], a[164:167], a[224:227], v[132:135]
v_mfma_f32_16x16x32_bf16 v[132:135], a[160:163], a[228:231], v[132:135]
s_nop 0
ds_read_b64_tr_b16 v[196:197], v9 offset:0
ds_read_b64_tr_b16 v[198:199], v9 offset:2048
v_mfma_f32_16x16x32_bf16 v[136:139], a[160:163], a[232:235], v[136:139]
buffer_load_dwordx4 a[40:43], v4, s[44:47], s69 offen offset:2048 sc1
v_mfma_f32_16x16x32_bf16 v[136:139], a[164:167], a[228:231], v[136:139]
s_nop 0
ds_read_b64_tr_b16 v[200:201], v10 offset:0
ds_read_b64_tr_b16 v[202:203], v10 offset:2048
v_mfma_f32_16x16x32_bf16 v[136:139], a[168:171], a[224:227], v[136:139]
v_mfma_f32_16x16x32_bf16 v[140:143], a[172:175], a[224:227], v[140:143]
s_nop 0
ds_read_b64_tr_b16 v[204:205], v11 offset:0
ds_read_b64_tr_b16 v[206:207], v11 offset:2048
v_mfma_f32_16x16x32_bf16 v[140:143], a[168:171], a[228:231], v[140:143]
v_cvt_pk_bf16_f32 v128, v128, v129
v_cvt_pk_bf16_f32 v129, v130, v131
v_cvt_pk_bf16_f32 v130, v132, v133
v_mfma_f32_16x16x32_bf16 v[140:143], a[164:167], a[232:235], v[140:143]
s_nop 0
ds_read_b64_tr_b16 v[208:209], v8 offset:4096
ds_read_b64_tr_b16 v[210:211], v8 offset:6144
v_cvt_pk_bf16_f32 v131, v134, v135
v_mfma_f32_16x16x32_bf16 v[140:143], a[160:163], a[236:239], v[140:143]
s_nop 0
buffer_load_dwordx4 a[44:47], v4, s[44:47], s69 offen offset:3072 sc1
v_permlane32_swap_b32 v128, v130
v_mfma_f32_16x16x32_bf16 v[144:147], a[160:163], a[240:243], v[144:147]
s_nop 0
ds_read_b64_tr_b16 v[212:213], v9 offset:4096
ds_read_b64_tr_b16 v[214:215], v9 offset:6144
v_permlane32_swap_b32 v129, v131
v_mfma_f32_16x16x32_bf16 v[144:147], a[164:167], a[236:239], v[144:147]
buffer_store_dwordx4 v[128:131], v166, s[44:47], s80 offen sc1
v_mfma_f32_16x16x32_bf16 v[144:147], a[168:171], a[232:235], v[144:147]
s_nop 0
ds_read_b64_tr_b16 v[216:217], v10 offset:4096
ds_read_b64_tr_b16 v[218:219], v10 offset:6144
v_mfma_f32_16x16x32_bf16 v[144:147], a[172:175], a[228:231], v[144:147]
s_add_u32 s69, s69, 0x20000
buffer_load_dwordx4 a[48:51], v4, s[44:47], s69 offen sc1
v_mfma_f32_16x16x32_bf16 v[144:147], a[176:179], a[224:227], v[144:147]
s_nop 0
ds_read_b64_tr_b16 v[220:221], v11 offset:4096
ds_read_b64_tr_b16 v[222:223], v11 offset:6144
v_cvt_pk_bf16_f32 v136, v136, v137
v_mfma_f32_16x16x32_bf16 v[148:151], a[180:183], a[224:227], v[148:151]
v_cvt_pk_bf16_f32 v137, v138, v139
v_cvt_pk_bf16_f32 v138, v140, v141
v_cvt_pk_bf16_f32 v139, v142, v143
v_mfma_f32_16x16x32_bf16 v[148:151], a[176:179], a[228:231], v[148:151]
s_nop 0
ds_read_b64_tr_b16 v[224:225], v8 offset:8192
ds_read_b64_tr_b16 v[226:227], v8 offset:10240
v_permlane32_swap_b32 v136, v138
v_mfma_f32_16x16x32_bf16 v[148:151], a[172:175], a[232:235], v[148:151]
v_permlane32_swap_b32 v137, v139
v_mfma_f32_16x16x32_bf16 v[148:151], a[168:171], a[236:239], v[148:151]
s_nop 0
ds_read_b64_tr_b16 v[228:229], v9 offset:8192
ds_read_b64_tr_b16 v[230:231], v9 offset:10240
v_mfma_f32_16x16x32_bf16 v[148:151], a[164:167], a[240:243], v[148:151]
buffer_load_dwordx4 a[52:55], v4, s[44:47], s69 offen offset:1024 sc1
v_mfma_f32_16x16x32_bf16 v[148:151], a[160:163], a[244:247], v[148:151]
s_nop 0
ds_read_b64_tr_b16 v[232:233], v10 offset:8192
ds_read_b64_tr_b16 v[234:235], v10 offset:10240
v_mfma_f32_16x16x32_bf16 v[152:155], a[160:163], a[248:251], v[152:155]
buffer_store_dwordx4 v[136:139], v166, s[44:47], s80 offen offset:1024 sc1
v_mfma_f32_16x16x32_bf16 v[152:155], a[164:167], a[244:247], v[152:155]
s_nop 0
ds_read_b64_tr_b16 v[236:237], v11 offset:8192
ds_read_b64_tr_b16 v[238:239], v11 offset:10240
v_mfma_f32_16x16x32_bf16 v[152:155], a[168:171], a[240:243], v[152:155]
buffer_load_dwordx4 a[56:59], v4, s[44:47], s69 offen offset:2048 sc1
v_mfma_f32_16x16x32_bf16 v[152:155], a[172:175], a[236:239], v[152:155]
s_nop 0
ds_read_b64_tr_b16 v[240:241], v8 offset:12288
ds_read_b64_tr_b16 v[242:243], v8 offset:14336
v_mfma_f32_16x16x32_bf16 v[152:155], a[176:179], a[232:235], v[152:155]
v_cvt_pk_bf16_f32 v144, v144, v145
v_cvt_pk_bf16_f32 v145, v146, v147
v_cvt_pk_bf16_f32 v146, v148, v149
v_mfma_f32_16x16x32_bf16 v[152:155], a[180:183], a[228:231], v[152:155]
s_nop 0
ds_read_b64_tr_b16 v[244:245], v9 offset:12288
ds_read_b64_tr_b16 v[246:247], v9 offset:14336
v_cvt_pk_bf16_f32 v147, v150, v151
v_mfma_f32_16x16x32_bf16 v[152:155], a[184:187], a[224:227], v[152:155]
v_permlane32_swap_b32 v144, v146
v_permlane32_swap_b32 v145, v147
v_mfma_f32_16x16x32_bf16 v[156:159], a[188:191], a[224:227], v[156:159]
s_nop 0
ds_read_b64_tr_b16 v[248:249], v10 offset:12288
ds_read_b64_tr_b16 v[250:251], v10 offset:14336
v_mfma_f32_16x16x32_bf16 v[156:159], a[184:187], a[228:231], v[156:159]
buffer_load_dwordx4 a[60:63], v4, s[44:47], s69 offen offset:3072 sc1
v_mfma_f32_16x16x32_bf16 v[156:159], a[180:183], a[232:235], v[156:159]
s_nop 0
ds_read_b64_tr_b16 v[252:253], v11 offset:12288
ds_read_b64_tr_b16 v[254:255], v11 offset:14336
v_mfma_f32_16x16x32_bf16 v[156:159], a[176:179], a[236:239], v[156:159]
buffer_store_dwordx4 v[144:147], v166, s[44:47], s80 offen offset:2048 sc1
v_mfma_f32_16x16x32_bf16 v[156:159], a[172:175], a[240:243], v[156:159]
v_mfma_f32_16x16x32_bf16 v[156:159], a[168:171], a[244:247], v[156:159]
v_mfma_f32_16x16x32_bf16 v[156:159], a[164:167], a[248:251], v[156:159]
v_mfma_f32_16x16x32_bf16 v[156:159], a[160:163], a[252:255], v[156:159]
v_cvt_pk_bf16_f32 v152, v152, v153
v_cvt_pk_bf16_f32 v153, v154, v155
s_nop 5
v_cvt_pk_bf16_f32 v154, v156, v157
v_cvt_pk_bf16_f32 v155, v158, v159
s_nop 0
v_permlane32_swap_b32 v152, v154
v_permlane32_swap_b32 v153, v155
buffer_store_dwordx4 v[152:155], v166, s[44:47], s80 offen offset:3072 sc1
s_waitcnt vmcnt(12) lgkmcnt(0)
s_cmp_lg_u32 s81, 0
s_cbranch_scc1 Lredo0
Lredo0b:
s_barrier
LEe:
v_mfma_f32_16x16x32_bf16 v[16:19], v[192:195], a[0:3], 0
s_nop 0
ds_read_b64_tr_b16 v[128:129], v8 offset:16384
ds_read_b64_tr_b16 v[130:131], v8 offset:18432
Lstube0:
s_cbranch_execz Lstube4
v_mfma_f32_16x16x32_bf16 v[16:19], v[208:211], a[4:7], v[16:19]
s_xor_b32 s71, s13, 0x100
ds_read_b64_tr_b16 v[132:133], v9 offset:16384
ds_read_b64_tr_b16 v[134:135], v9 offset:18432
v_mfma_f32_16x16x32_bf16 v[16:19], v[224:227], a[8:11], v[16:19]
s_add_u32 m0, s85, 0
ds_read_b64_tr_b16 v[136:137], v10 offset:16384
ds_read_b64_tr_b16 v[138:139], v10 offset:18432
v_mfma_f32_16x16x32_bf16 v[16:19], v[240:243], a[12:15], v[16:19]
s_add_u32 s72, s71, 0
buffer_load_dwordx4 v15, s[24:27], s72 offen lds
v_mfma_f32_16x16x32_bf16 v[32:35], v[240:243], a[28:31], 0
s_lshr_b32 s69, s14, 18
ds_read_b64_tr_b16 v[140:141], v11 offset:16384
ds_read_b64_tr_b16 v[142:143], v11 offset:18432
v_mfma_f32_16x16x32_bf16 v[32:35], v[224:227], a[24:27], v[32:35]
s_lshl_b32 s69, s69, 12
v_add_u32 v4, s64, v1
v_add_u32 v4, 131072, v4
v_mfma_f32_16x16x32_bf16 v[32:35], v[208:211], a[20:23], v[32:35]
s_add_u32 s69, s69, s95
buffer_load_dwordx4 a[64:67], v1, s[44:47], s69 offen sc1
v_mfma_f32_16x16x32_bf16 v[32:35], v[192:195], a[16:19], v[32:35]
s_lshl_b32 s70, s75, 18
ds_read_b64_tr_b16 v[144:145], v8 offset:20480
ds_read_b64_tr_b16 v[146:147], v8 offset:22528
v_mfma_f32_16x16x32_bf16 v[36:39], v[196:199], a[16:19], 0
s_add_u32 s72, s71, 15360
buffer_load_dwordx4 v15, s[24:27], s72 offen offset:1024 lds
v_mfma_f32_16x16x32_bf16 v[36:39], v[212:215], a[20:23], v[36:39]
s_add_u32 s70, s70, s94
ds_read_b64_tr_b16 v[148:149], v9 offset:20480
ds_read_b64_tr_b16 v[150:151], v9 offset:22528
v_mfma_f32_16x16x32_bf16 v[36:39], v[228:231], a[24:27], v[36:39]
s_nop 0
ds_read_b64_tr_b16 v[152:153], v10 offset:20480
ds_read_b64_tr_b16 v[154:155], v10 offset:22528
v_mfma_f32_16x16x32_bf16 v[36:39], v[244:247], a[28:31], v[36:39]
s_nop 0
ds_read_b64_tr_b16 v[156:157], v11 offset:20480
ds_read_b64_tr_b16 v[158:159], v11 offset:22528
v_mfma_f32_16x16x32_bf16 v[20:23], v[244:247], a[12:15], 0
ds_write_b128 v4, v[80:83] offset:0
v_mfma_f32_16x16x32_bf16 v[20:23], v[228:231], a[8:11], v[20:23]
s_nop 0
ds_read_b64_tr_b16 v[160:161], v8 offset:24576
ds_read_b64_tr_b16 v[162:163], v8 offset:26624
v_mfma_f32_16x16x32_bf16 v[20:23], v[212:215], a[4:7], v[20:23]
s_add_u32 s72, s71, 30720
buffer_load_dwordx4 v15, s[24:27], s72 offen offset:2048 lds
v_mfma_f32_16x16x32_bf16 v[20:23], v[196:199], a[0:3], v[20:23]
buffer_load_dwordx4 a[68:71], v1, s[44:47], s69 offen offset:1024 sc1
v_mfma_f32_16x16x32_bf16 v[24:27], v[200:203], a[0:3], 0
s_nop 0
ds_read_b64_tr_b16 v[164:165], v9 offset:24576
ds_read_b64_tr_b16 v[166:167], v9 offset:26624
v_mfma_f32_16x16x32_bf16 v[24:27], v[216:219], a[4:7], v[24:27]
s_nop 0
ds_read_b64_tr_b16 v[168:169], v10 offset:24576
ds_read_b64_tr_b16 v[170:171], v10 offset:26624
v_mfma_f32_16x16x32_bf16 v[24:27], v[232:235], a[8:11], v[24:27]
s_nop 0
ds_read_b64_tr_b16 v[172:173], v11 offset:24576
ds_read_b64_tr_b16 v[174:175], v11 offset:26624
v_mfma_f32_16x16x32_bf16 v[24:27], v[248:251], a[12:15], v[24:27]
ds_write_b128 v4, v[84:87] offset:1024
v_mfma_f32_16x16x32_bf16 v[40:43], v[248:251], a[28:31], 0
s_add_u32 s72, s71, 46080
buffer_load_dwordx4 v15, s[24:27], s72 offen offset:3072 lds
v_mfma_f32_16x16x32_bf16 v[40:43], v[232:235], a[24:27], v[40:43]
s_nop 0
ds_read_b64_tr_b16 v[176:177], v8 offset:28672
ds_read_b64_tr_b16 v[178:179], v8 offset:30720
v_mfma_f32_16x16x32_bf16 v[40:43], v[216:219], a[20:23], v[40:43]
s_nop 0
ds_read_b64_tr_b16 v[180:181], v9 offset:28672
ds_read_b64_tr_b16 v[182:183], v9 offset:30720
v_mfma_f32_16x16x32_bf16 v[40:43], v[200:203], a[16:19], v[40:43]
s_nop 0
ds_read_b64_tr_b16 v[184:185], v10 offset:28672
ds_read_b64_tr_b16 v[186:187], v10 offset:30720
v_mfma_f32_16x16x32_bf16 v[44:47], v[204:207], a[16:19], 0
s_nop 0
ds_read_b64_tr_b16 v[188:189], v11 offset:28672
ds_read_b64_tr_b16 v[190:191], v11 offset:30720
v_mfma_f32_16x16x32_bf16 v[44:47], v[220:223], a[20:23], v[44:47]
buffer_load_dwordx4 a[72:75], v1, s[44:47], s69 offen offset:2048 sc1
v_mfma_f32_16x16x32_bf16 v[44:47], v[236:239], a[24:27], v[44:47]
ds_write_b128 v4, v[96:99] offset:2048
v_mfma_f32_16x16x32_bf16 v[44:47], v[252:255], a[28:31], v[44:47]
s_xor_b32 s71, s13, 0x180
v_mfma_f32_16x16x32_bf16 v[28:31], v[252:255], a[12:15], 0
s_add_u32 m0, s85, 16384
ds_write_b128 v4, v[100:103] offset:3072
v_mfma_f32_16x16x32_bf16 v[28:31], v[236:239], a[8:11], v[28:31]
s_add_u32 s72, s71, 0
v_mfma_f32_16x16x32_bf16 v[28:31], v[220:223], a[4:7], v[28:31]
s_waitcnt vmcnt(31) lgkmcnt(0)
buffer_load_dwordx4 v15, s[24:27], s72 offen lds
v_mfma_f32_16x16x32_bf16 v[28:31], v[204:207], a[0:3], v[28:31]
s_barrier
v_mfma_f32_16x16x32_bf16 v[48:51], v[128:131], a[0:3], 0
s_nop 0
ds_read_b64_tr_b16 v[192:193], v8 offset:32768
ds_read_b64_tr_b16 v[194:195], v8 offset:34816
v_mfma_f32_16x16x32_bf16 v[48:51], v[144:147], a[4:7], v[48:51]
s_nop 0
ds_read_b64_tr_b16 v[196:197], v9 offset:32768
ds_read_b64_tr_b16 v[198:199], v9 offset:34816
v_mfma_f32_16x16x32_bf16 v[48:51], v[160:163], a[8:11], v[48:51]
s_nop 0
ds_read_b64_tr_b16 v[200:201], v10 offset:32768
ds_read_b64_tr_b16 v[202:203], v10 offset:34816
v_mfma_f32_16x16x32_bf16 v[48:51], v[176:179], a[12:15], v[48:51]
s_add_u32 s72, s71, 15360
buffer_load_dwordx4 v15, s[24:27], s72 offen offset:1024 lds
v_mfma_f32_16x16x32_bf16 v[64:67], v[176:179], a[28:31], 0
buffer_load_dwordx4 a[76:79], v1, s[44:47], s69 offen offset:3072 sc1
v_mfma_f32_16x16x32_bf16 v[64:67], v[160:163], a[24:27], v[64:67]
s_nop 0
ds_read_b64_tr_b16 v[204:205], v11 offset:32768
ds_read_b64_tr_b16 v[206:207], v11 offset:34816
v_mfma_f32_16x16x32_bf16 v[64:67], v[144:147], a[20:23], v[64:67]
v_mfma_f32_16x16x32_bf16 v[64:67], v[128:131], a[16:19], v[64:67]
s_nop 0
ds_read_b64_tr_b16 v[208:209], v8 offset:36864
ds_read_b64_tr_b16 v[210:211], v8 offset:38912
v_mfma_f32_16x16x32_bf16 v[68:71], v[132:135], a[16:19], 0
s_nop 0
ds_read_b64_tr_b16 v[212:213], v9 offset:36864
ds_read_b64_tr_b16 v[214:215], v9 offset:38912
v_mfma_f32_16x16x32_bf16 v[68:71], v[148:151], a[20:23], v[68:71]
s_add_u32 s72, s71, 30720
buffer_load_dwordx4 v15, s[24:27], s72 offen offset:2048 lds
v_mfma_f32_16x16x32_bf16 v[68:71], v[164:167], a[24:27], v[68:71]
s_nop 0
ds_read_b64_tr_b16 v[216:217], v10 offset:36864
ds_read_b64_tr_b16 v[218:219], v10 offset:38912
v_mfma_f32_16x16x32_bf16 v[68:71], v[180:183], a[28:31], v[68:71]
s_nop 0
ds_read_b64_tr_b16 v[220:221], v11 offset:36864
ds_read_b64_tr_b16 v[222:223], v11 offset:38912
v_mfma_f32_16x16x32_bf16 v[52:55], v[180:183], a[12:15], 0
v_mfma_f32_16x16x32_bf16 v[52:55], v[164:167], a[8:11], v[52:55]
s_add_u32 s69, s69, 0x20000
buffer_load_dwordx4 a[80:83], v1, s[44:47], s69 offen sc1
v_mfma_f32_16x16x32_bf16 v[52:55], v[148:151], a[4:7], v[52:55]
s_nop 0
ds_read_b64_tr_b16 v[224:225], v8 offset:40960
ds_read_b64_tr_b16 v[226:227], v8 offset:43008
v_mfma_f32_16x16x32_bf16 v[52:55], v[132:135], a[0:3], v[52:55]
s_add_u32 s72, s71, 46080
buffer_load_dwordx4 v15, s[24:27], s72 offen offset:3072 lds
v_mfma_f32_16x16x32_bf16 v[56:59], v[136:139], a[0:3], 0
s_nop 0
ds_read_b64_tr_b16 v[228:229], v9 offset:40960
ds_read_b64_tr_b16 v[230:231], v9 offset:43008
v_mfma_f32_16x16x32_bf16 v[56:59], v[152:155], a[4:7], v[56:59]
s_nop 0
ds_read_b64_tr_b16 v[232:233], v10 offset:40960
ds_read_b64_tr_b16 v[234:235], v10 offset:43008
v_mfma_f32_16x16x32_bf16 v[56:59], v[168:171], a[8:11], v[56:59]
s_nop 0
ds_read_b64_tr_b16 v[236:237], v11 offset:40960
ds_read_b64_tr_b16 v[238:239], v11 offset:43008
v_mfma_f32_16x16x32_bf16 v[56:59], v[184:187], a[12:15], v[56:59]
v_mfma_f32_16x16x32_bf16 v[72:75], v[184:187], a[28:31], 0
s_nop 0
ds_read_b64_tr_b16 v[240:241], v8 offset:45056
ds_read_b64_tr_b16 v[242:243], v8 offset:47104
v_mfma_f32_16x16x32_bf16 v[72:75], v[168:171], a[24:27], v[72:75]
s_nop 0
ds_read_b64_tr_b16 v[244:245], v9 offset:45056
ds_read_b64_tr_b16 v[246:247], v9 offset:47104
v_mfma_f32_16x16x32_bf16 v[72:75], v[152:155], a[20:23], v[72:75]
s_nop 0
ds_read_b64_tr_b16 v[248:249], v10 offset:45056
ds_read_b64_tr_b16 v[250:251], v10 offset:47104
v_mfma_f32_16x16x32_bf16 v[72:75], v[136:139], a[16:19], v[72:75]
s_xor_b32 s71, s14, 0x80
buffer_load_dwordx4 a[84:87], v1, s[44:47], s69 offen offset:1024 sc1
v_mfma_f32_16x16x32_bf16 v[76:79], v[140:143], a[16:19], 0
s_add_u32 m0, s85, 32768
ds_read_b64_tr_b16 v[252:253], v11 offset:45056
ds_read_b64_tr_b16 v[254:255], v11 offset:47104
v_mfma_f32_16x16x32_bf16 v[76:79], v[156:159], a[20:23], v[76:79]
s_add_u32 s72, s71, 0
buffer_load_dwordx4 v15, s[24:27], s72 offen lds
v_mfma_f32_16x16x32_bf16 v[76:79], v[172:175], a[24:27], v[76:79]
v_mfma_f32_16x16x32_bf16 v[76:79], v[188:191], a[28:31], v[76:79]
v_mfma_f32_16x16x32_bf16 v[60:63], v[188:191], a[12:15], 0
v_mfma_f32_16x16x32_bf16 v[60:63], v[172:175], a[8:11], v[60:63]
s_add_u32 s72, s71, 15360
v_mfma_f32_16x16x32_bf16 v[60:63], v[156:159], a[4:7], v[60:63]
s_waitcnt vmcnt(35) lgkmcnt(0)
v_mfma_f32_16x16x32_bf16 v[60:63], v[140:143], a[0:3], v[60:63]
s_barrier
buffer_load_dwordx4 v15, s[24:27], s72 offen offset:1024 lds
v_mfma_f32_16x16x32_bf16 v[80:83], v[192:195], a[0:3], 0
s_nop 0
ds_read_b64_tr_b16 v[128:129], v8 offset:49152
ds_read_b64_tr_b16 v[130:131], v8 offset:51200
v_mfma_f32_16x16x32_bf16 v[80:83], v[208:211], a[4:7], v[80:83]
buffer_load_dwordx4 a[88:91], v1, s[44:47], s69 offen offset:2048 sc1
v_mfma_f32_16x16x32_bf16 v[80:83], v[224:227], a[8:11], v[80:83]
s_nop 0
ds_read_b64_tr_b16 v[132:133], v9 offset:49152
ds_read_b64_tr_b16 v[134:135], v9 offset:51200
v_mfma_f32_16x16x32_bf16 v[80:83], v[240:243], a[12:15], v[80:83]
s_nop 0
ds_read_b64_tr_b16 v[136:137], v10 offset:49152
ds_read_b64_tr_b16 v[138:139], v10 offset:51200
v_mfma_f32_16x16x32_bf16 v[96:99], v[240:243], a[28:31], 0
s_nop 0
ds_read_b64_tr_b16 v[140:141], v11 offset:49152
ds_read_b64_tr_b16 v[142:143], v11 offset:51200
v_mfma_f32_16x16x32_bf16 v[96:99], v[224:227], a[24:27], v[96:99]
s_add_u32 s72, s71, 30720
buffer_load_dwordx4 v15, s[24:27], s72 offen offset:2048 lds
v_mfma_f32_16x16x32_bf16 v[96:99], v[208:211], a[20:23], v[96:99]
v_mfma_f32_16x16x32_bf16 v[96:99], v[192:195], a[16:19], v[96:99]
s_nop 0
ds_read_b64_tr_b16 v[144:145], v8 offset:53248
ds_read_b64_tr_b16 v[146:147], v8 offset:55296
v_mfma_f32_16x16x32_bf16 v[100:103], v[196:199], a[16:19], 0
s_nop 0
ds_read_b64_tr_b16 v[148:149], v9 offset:53248
ds_read_b64_tr_b16 v[150:151], v9 offset:55296
v_mfma_f32_16x16x32_bf16 v[100:103], v[212:215], a[20:23], v[100:103]
s_nop 0
ds_read_b64_tr_b16 v[152:153], v10 offset:53248
ds_read_b64_tr_b16 v[154:155], v10 offset:55296
v_mfma_f32_16x16x32_bf16 v[100:103], v[228:231], a[24:27], v[100:103]
s_nop 0
ds_read_b64_tr_b16 v[156:157], v11 offset:53248
ds_read_b64_tr_b16 v[158:159], v11 offset:55296
v_mfma_f32_16x16x32_bf16 v[100:103], v[244:247], a[28:31], v[100:103]
s_add_u32 s72, s71, 46080
buffer_load_dwordx4 v15, s[24:27], s72 offen offset:3072 lds
v_mfma_f32_16x16x32_bf16 v[84:87], v[244:247], a[12:15], 0
buffer_load_dwordx4 a[92:95], v1, s[44:47], s69 offen offset:3072 sc1
v_mfma_f32_16x16x32_bf16 v[84:87], v[228:231], a[8:11], v[84:87]
v_mfma_f32_16x16x32_bf16 v[84:87], v[212:215], a[4:7], v[84:87]
s_nop 0
ds_read_b64_tr_b16 v[160:161], v8 offset:57344
ds_read_b64_tr_b16 v[162:163], v8 offset:59392
v_mfma_f32_16x16x32_bf16 v[84:87], v[196:199], a[0:3], v[84:87]
s_nop 0
ds_read_b64_tr_b16 v[164:165], v9 offset:57344
ds_read_b64_tr_b16 v[166:167], v9 offset:59392
v_mfma_f32_16x16x32_bf16 v[88:91], v[200:203], a[0:3], 0
s_nop 0
ds_read_b64_tr_b16 v[168:169], v10 offset:57344
ds_read_b64_tr_b16 v[170:171], v10 offset:59392
v_mfma_f32_16x16x32_bf16 v[88:91], v[216:219], a[4:7], v[88:91]
s_xor_b32 s82, s78, 4
ds_read_b64_tr_b16 v[172:173], v11 offset:57344
ds_read_b64_tr_b16 v[174:175], v11 offset:59392
v_mfma_f32_16x16x32_bf16 v[88:91], v[232:235], a[8:11], v[88:91]
s_lshl_b32 s82, s82, 10
v_mfma_f32_16x16x32_bf16 v[88:91], v[248:251], a[12:15], v[88:91]
s_xor_b32 s71, s14, 0x100
ds_read_b64_tr_b16 v[176:177], v8 offset:61440
ds_read_b64_tr_b16 v[178:179], v8 offset:63488
v_mfma_f32_16x16x32_bf16 v[104:107], v[248:251], a[28:31], 0
s_add_u32 m0, s85, 49152
ds_read_b64_tr_b16 v[180:181], v9 offset:61440
ds_read_b64_tr_b16 v[182:183], v9 offset:63488
v_mfma_f32_16x16x32_bf16 v[104:107], v[232:235], a[24:27], v[104:107]
s_add_u32 s72, s71, 0
buffer_load_dwordx4 v15, s[24:27], s72 offen lds
v_mfma_f32_16x16x32_bf16 v[104:107], v[216:219], a[20:23], v[104:107]
s_add_u32 s82, s82, s74
buffer_load_dword v3, v2, s[44:47], s82 offen sc1
v_mfma_f32_16x16x32_bf16 v[104:107], v[200:203], a[16:19], v[104:107]
s_nop 0
ds_read_b64_tr_b16 v[184:185], v10 offset:61440
ds_read_b64_tr_b16 v[186:187], v10 offset:63488
v_mfma_f32_16x16x32_bf16 v[108:111], v[204:207], a[16:19], 0
s_nop 0
ds_read_b64_tr_b16 v[188:189], v11 offset:61440
ds_read_b64_tr_b16 v[190:191], v11 offset:63488
v_mfma_f32_16x16x32_bf16 v[108:111], v[220:223], a[20:23], v[108:111]
v_mfma_f32_16x16x32_bf16 v[108:111], v[236:239], a[24:27], v[108:111]
s_add_u32 s72, s71, 15360
buffer_load_dwordx4 v15, s[24:27], s72 offen offset:1024 lds
v_mfma_f32_16x16x32_bf16 v[108:111], v[252:255], a[28:31], v[108:111]
s_lshr_b32 s69, s15, 18
v_mfma_f32_16x16x32_bf16 v[92:95], v[252:255], a[12:15], 0
s_lshl_b32 s69, s69, 12
v_xor_b32 v8, 0x10000, v8
v_mfma_f32_16x16x32_bf16 v[92:95], v[236:239], a[8:11], v[92:95]
s_add_u32 s69, s69, s95
v_xor_b32 v9, 0x10000, v9
v_mfma_f32_16x16x32_bf16 v[92:95], v[220:223], a[4:7], v[92:95]
s_waitcnt vmcnt(17) lgkmcnt(0)
v_xor_b32 v10, 0x10000, v10
v_mfma_f32_16x16x32_bf16 v[92:95], v[204:207], a[0:3], v[92:95]
s_barrier
buffer_load_dwordx4 a[96:99], v1, s[44:47], s69 offen sc1
v_xor_b32 v11, 0x10000, v11
v_mfma_f32_16x16x32_bf16 v[16:19], v[128:131], a[32:35], v[16:19]
s_add_u32 s72, s71, 30720
buffer_load_dwordx4 v15, s[24:27], s72 offen offset:2048 lds
v_mfma_f32_16x16x32_bf16 v[16:19], v[144:147], a[36:39], v[16:19]
s_nop 0
ds_read_b64_tr_b16 v[192:193], v8 offset:0
ds_read_b64_tr_b16 v[194:195], v8 offset:2048
v_mfma_f32_16x16x32_bf16 v[16:19], v[160:163], a[40:43], v[16:19]
s_nop 0
ds_read_b64_tr_b16 v[196:197], v9 offset:0
ds_read_b64_tr_b16 v[198:199], v9 offset:2048
v_mfma_f32_16x16x32_bf16 v[16:19], v[176:179], a[44:47], v[16:19]
s_nop 0
ds_read_b64_tr_b16 v[200:201], v10 offset:0
ds_read_b64_tr_b16 v[202:203], v10 offset:2048
v_mfma_f32_16x16x32_bf16 v[32:35], v[176:179], a[60:63], v[32:35]
s_nop 0
ds_read_b64_tr_b16 v[204:205], v11 offset:0
ds_read_b64_tr_b16 v[206:207], v11 offset:2048
v_mfma_f32_16x16x32_bf16 v[32:35], v[160:163], a[56:59], v[32:35]
v_or_b32 v112, s58, v0
v_mov_b32 v113, 3
v_mfma_f32_16x16x32_bf16 v[32:35], v[144:147], a[52:55], v[32:35]
s_add_u32 s72, s71, 46080
buffer_load_dwordx4 v15, s[24:27], s72 offen offset:3072 lds
v_mfma_f32_16x16x32_bf16 v[32:35], v[128:131], a[48:51], v[32:35]
s_nop 0
ds_read_b64_tr_b16 v[208:209], v8 offset:4096
ds_read_b64_tr_b16 v[210:211], v8 offset:6144
v_mfma_f32_16x16x32_bf16 v[36:39], v[132:135], a[48:51], v[36:39]
s_nop 0
ds_read_b64_tr_b16 v[212:213], v9 offset:4096
ds_read_b64_tr_b16 v[214:215], v9 offset:6144
v_mfma_f32_16x16x32_bf16 v[36:39], v[148:151], a[52:55], v[36:39]
buffer_load_dwordx4 a[100:103], v1, s[44:47], s69 offen offset:1024 sc1
v_mfma_f32_16x16x32_bf16 v[36:39], v[164:167], a[56:59], v[36:39]
s_nop 0
ds_read_b64_tr_b16 v[216:217], v10 offset:4096
ds_read_b64_tr_b16 v[218:219], v10 offset:6144
v_mfma_f32_16x16x32_bf16 v[36:39], v[180:183], a[60:63], v[36:39]
v_min_u32 v112, 1, v112
v_lshlrev_b32 v112, 30, v112
v_mfma_f32_16x16x32_bf16 v[20:23], v[180:183], a[44:47], v[20:23]
s_nop 0
ds_read_b64_tr_b16 v[220:221], v11 offset:4096
ds_read_b64_tr_b16 v[222:223], v11 offset:6144
v_mfma_f32_16x16x32_bf16 v[20:23], v[164:167], a[40:43], v[20:23]
s_nop 0
ds_read_b64_tr_b16 v[224:225], v8 offset:8192
ds_read_b64_tr_b16 v[226:227], v8 offset:10240
v_mfma_f32_16x16x32_bf16 v[20:23], v[148:151], a[36:39], v[20:23]
s_xor_b32 s71, s14, 0x180
ds_read_b64_tr_b16 v[228:229], v9 offset:8192
ds_read_b64_tr_b16 v[230:231], v9 offset:10240
v_mfma_f32_16x16x32_bf16 v[20:23], v[132:135], a[32:35], v[20:23]
s_add_u32 m0, s77, 0
buffer_store_dword v113, v112, s[44:47], s91 offen sc1
v_mfma_f32_16x16x32_bf16 v[24:27], v[136:139], a[32:35], v[24:27]
s_add_u32 s72, s71, 0
buffer_load_dwordx4 v15, s[24:27], s72 offen lds
v_mfma_f32_16x16x32_bf16 v[24:27], v[152:155], a[36:39], v[24:27]
s_nop 0
ds_read_b64_tr_b16 v[232:233], v10 offset:8192
ds_read_b64_tr_b16 v[234:235], v10 offset:10240
v_mfma_f32_16x16x32_bf16 v[24:27], v[168:171], a[40:43], v[24:27]
s_nop 0
ds_read_b64_tr_b16 v[236:237], v11 offset:8192
ds_read_b64_tr_b16 v[238:239], v11 offset:10240
v_mfma_f32_16x16x32_bf16 v[24:27], v[184:187], a[44:47], v[24:27]
buffer_load_dwordx4 a[104:107], v1, s[44:47], s69 offen offset:2048 sc1
v_mfma_f32_16x16x32_bf16 v[40:43], v[184:187], a[60:63], v[40:43]
s_nop 0
ds_read_b64_tr_b16 v[240:241], v8 offset:12288
ds_read_b64_tr_b16 v[242:243], v8 offset:14336
v_mfma_f32_16x16x32_bf16 v[40:43], v[168:171], a[56:59], v[40:43]
v_mfma_f32_16x16x32_bf16 v[40:43], v[152:155], a[52:55], v[40:43]
s_add_u32 s72, s71, 15360
buffer_load_dwordx4 v15, s[24:27], s72 offen offset:1024 lds
v_mfma_f32_16x16x32_bf16 v[40:43], v[136:139], a[48:51], v[40:43]
s_nop 0
ds_read_b64_tr_b16 v[244:245], v9 offset:12288
ds_read_b64_tr_b16 v[246:247], v9 offset:14336
v_mfma_f32_16x16x32_bf16 v[44:47], v[140:143], a[48:51], v[44:47]
s_nop 0
ds_read_b64_tr_b16 v[248:249], v10 offset:12288
ds_read_b64_tr_b16 v[250:251], v10 offset:14336
v_mfma_f32_16x16x32_bf16 v[44:47], v[156:159], a[52:55], v[44:47]
s_nop 0
ds_read_b64_tr_b16 v[252:253], v11 offset:12288
ds_read_b64_tr_b16 v[254:255], v11 offset:14336
v_mfma_f32_16x16x32_bf16 v[44:47], v[172:175], a[56:59], v[44:47]
v_mfma_f32_16x16x32_bf16 v[44:47], v[188:191], a[60:63], v[44:47]
v_mfma_f32_16x16x32_bf16 v[28:31], v[188:191], a[44:47], v[28:31]
s_add_u32 s72, s71, 30720
buffer_load_dwordx4 v15, s[24:27], s72 offen offset:2048 lds
v_mfma_f32_16x16x32_bf16 v[28:31], v[172:175], a[40:43], v[28:31]
buffer_load_dwordx4 a[108:111], v1, s[44:47], s69 offen offset:3072 sc1
v_mfma_f32_16x16x32_bf16 v[28:31], v[156:159], a[36:39], v[28:31]
s_waitcnt vmcnt(20) lgkmcnt(0)
v_mfma_f32_16x16x32_bf16 v[28:31], v[140:143], a[32:35], v[28:31]
s_barrier
v_mfma_f32_16x16x32_bf16 v[48:51], v[192:195], a[32:35], v[48:51]
s_nop 0
ds_read_b64_tr_b16 v[128:129], v8 offset:16384
ds_read_b64_tr_b16 v[130:131], v8 offset:18432
v_mfma_f32_16x16x32_bf16 v[48:51], v[208:211], a[36:39], v[48:51]
s_nop 0
ds_read_b64_tr_b16 v[132:133], v9 offset:16384
ds_read_b64_tr_b16 v[134:135], v9 offset:18432
v_mfma_f32_16x16x32_bf16 v[48:51], v[224:227], a[40:43], v[48:51]
s_add_u32 s72, s71, 46080
buffer_load_dwordx4 v15, s[24:27], s72 offen offset:3072 lds
v_mfma_f32_16x16x32_bf16 v[48:51], v[240:243], a[44:47], v[48:51]
s_nop 0
ds_read_b64_tr_b16 v[136:137], v10 offset:16384
ds_read_b64_tr_b16 v[138:139], v10 offset:18432
v_mfma_f32_16x16x32_bf16 v[64:67], v[240:243], a[60:63], v[64:67]
s_nop 0
ds_read_b64_tr_b16 v[140:141], v11 offset:16384
ds_read_b64_tr_b16 v[142:143], v11 offset:18432
v_mfma_f32_16x16x32_bf16 v[64:67], v[224:227], a[56:59], v[64:67]
v_and_b32 v120, 15, v0
v_lshrrev_b32 v121, 4, v0
v_mfma_f32_16x16x32_bf16 v[64:67], v[208:211], a[52:55], v[64:67]
s_nop 0
ds_read_b64_tr_b16 v[144:145], v8 offset:20480
ds_read_b64_tr_b16 v[146:147], v8 offset:22528
v_mfma_f32_16x16x32_bf16 v[64:67], v[192:195], a[48:51], v[64:67]
s_add_u32 s69, s69, 0x20000
buffer_load_dwordx4 a[112:115], v1, s[44:47], s69 offen sc1
v_mfma_f32_16x16x32_bf16 v[68:71], v[196:199], a[48:51], v[68:71]
s_nop 0
ds_read_b64_tr_b16 v[148:149], v9 offset:20480
ds_read_b64_tr_b16 v[150:151], v9 offset:22528
v_mfma_f32_16x16x32_bf16 v[68:71], v[212:215], a[52:55], v[68:71]
s_nop 0
ds_read_b64_tr_b16 v[152:153], v10 offset:20480
ds_read_b64_tr_b16 v[154:155], v10 offset:22528
v_mfma_f32_16x16x32_bf16 v[68:71], v[228:231], a[56:59], v[68:71]
s_xor_b32 s71, s15, 0x80
v_lshlrev_b32 v121, 2, v121
v_sub_u32 v120, v120, v121
v_mfma_f32_16x16x32_bf16 v[68:71], v[244:247], a[60:63], v[68:71]
s_add_u32 m0, s77, 16384
ds_read_b64_tr_b16 v[156:157], v11 offset:20480
ds_read_b64_tr_b16 v[158:159], v11 offset:22528
v_mfma_f32_16x16x32_bf16 v[52:55], v[244:247], a[44:47], v[52:55]
s_add_u32 s72, s71, 0
buffer_load_dwordx4 v15, s[24:27], s72 offen lds
v_mfma_f32_16x16x32_bf16 v[52:55], v[228:231], a[40:43], v[52:55]
s_nop 0
ds_read_b64_tr_b16 v[160:161], v8 offset:24576
ds_read_b64_tr_b16 v[162:163], v8 offset:26624
v_mfma_f32_16x16x32_bf16 v[52:55], v[212:215], a[36:39], v[52:55]
s_nop 0
ds_read_b64_tr_b16 v[164:165], v9 offset:24576
ds_read_b64_tr_b16 v[166:167], v9 offset:26624
v_mfma_f32_16x16x32_bf16 v[52:55], v[196:199], a[32:35], v[52:55]
v_min_u32 v120, 4, v120
v_lshlrev_b32 v120, 3, v120
v_mfma_f32_16x16x32_bf16 v[56:59], v[200:203], a[32:35], v[56:59]
s_nop 0
ds_read_b64_tr_b16 v[168:169], v10 offset:24576
ds_read_b64_tr_b16 v[170:171], v10 offset:26624
v_mfma_f32_16x16x32_bf16 v[56:59], v[216:219], a[36:39], v[56:59]
s_add_u32 s72, s71, 15360
buffer_load_dwordx4 v15, s[24:27], s72 offen offset:1024 lds
v_mfma_f32_16x16x32_bf16 v[56:59], v[232:235], a[40:43], v[56:59]
buffer_load_dwordx4 a[116:119], v1, s[44:47], s69 offen offset:1024 sc1
v_mfma_f32_16x16x32_bf16 v[56:59], v[248:251], a[44:47], v[56:59]
s_nop 0
ds_read_b64_tr_b16 v[172:173], v11 offset:24576
ds_read_b64_tr_b16 v[174:175], v11 offset:26624
v_mfma_f32_16x16x32_bf16 v[72:75], v[248:251], a[60:63], v[72:75]
s_nop 0
ds_read_b64_tr_b16 v[176:177], v8 offset:28672
ds_read_b64_tr_b16 v[178:179], v8 offset:30720
v_mfma_f32_16x16x32_bf16 v[72:75], v[232:235], a[56:59], v[72:75]
v_mov_b32 v122, 0x3f80
v_mov_b32 v123, 0
v_mfma_f32_16x16x32_bf16 v[72:75], v[216:219], a[52:55], v[72:75]
s_nop 0
ds_read_b64_tr_b16 v[180:181], v9 offset:28672
ds_read_b64_tr_b16 v[182:183], v9 offset:30720
v_mfma_f32_16x16x32_bf16 v[72:75], v[200:203], a[48:51], v[72:75]
s_add_u32 s72, s71, 30720
buffer_load_dwordx4 v15, s[24:27], s72 offen offset:2048 lds
v_mfma_f32_16x16x32_bf16 v[76:79], v[204:207], a[48:51], v[76:79]
s_nop 0
ds_read_b64_tr_b16 v[184:185], v10 offset:28672
ds_read_b64_tr_b16 v[186:187], v10 offset:30720
v_mfma_f32_16x16x32_bf16 v[76:79], v[220:223], a[52:55], v[76:79]
s_nop 0
ds_read_b64_tr_b16 v[188:189], v11 offset:28672
ds_read_b64_tr_b16 v[190:191], v11 offset:30720
v_mfma_f32_16x16x32_bf16 v[76:79], v[236:239], a[56:59], v[76:79]
v_lshlrev_b64 v[122:123], v120, v[122:123]
v_mov_b32 v126, 0
v_mfma_f32_16x16x32_bf16 v[76:79], v[252:255], a[60:63], v[76:79]
buffer_load_dwordx4 a[120:123], v1, s[44:47], s69 offen offset:2048 sc1
v_mfma_f32_16x16x32_bf16 v[60:63], v[252:255], a[44:47], v[60:63]
v_lshlrev_b64 v[122:123], v120, v[122:123]
v_mov_b32 v127, 0
v_mfma_f32_16x16x32_bf16 v[60:63], v[236:239], a[40:43], v[60:63]
s_add_u32 s72, s71, 46080
buffer_load_dwordx4 v15, s[24:27], s72 offen offset:3072 lds
v_mfma_f32_16x16x32_bf16 v[60:63], v[220:223], a[36:39], v[60:63]
s_waitcnt vmcnt(22) lgkmcnt(0)
v_mov_b32 v120, 0
v_mov_b32 v121, 0
v_mfma_f32_16x16x32_bf16 v[60:63], v[204:207], a[32:35], v[60:63]
s_barrier
v_mov_b32 v124, v122
v_mov_b32 v125, v123
v_mfma_f32_16x16x32_bf16 v[80:83], v[128:131], a[32:35], v[80:83]
s_nop 0
ds_read_b64_tr_b16 v[192:193], v8 offset:32768
ds_read_b64_tr_b16 v[194:195], v8 offset:34816
v_mfma_f32_16x16x32_bf16 v[80:83], v[144:147], a[36:39], v[80:83]
s_nop 0
ds_read_b64_tr_b16 v[196:197], v9 offset:32768
ds_read_b64_tr_b16 v[198:199], v9 offset:34816
v_mfma_f32_16x16x32_bf16 v[80:83], v[160:163], a[40:43], v[80:83]
s_nop 0
ds_read_b64_tr_b16 v[200:201], v10 offset:32768
ds_read_b64_tr_b16 v[202:203], v10 offset:34816
v_mfma_f32_16x16x32_bf16 v[80:83], v[176:179], a[44:47], v[80:83]
s_nop 0
ds_read_b64_tr_b16 v[204:205], v11 offset:32768
ds_read_b64_tr_b16 v[206:207], v11 offset:34816
v_mfma_f32_16x16x32_bf16 v[96:99], v[176:179], a[60:63], v[96:99]
v_mfma_f32_16x16x32_bf16 v[96:99], v[160:163], a[56:59], v[96:99]
s_xor_b32 s71, s15, 0x100
buffer_load_dwordx4 a[124:127], v1, s[44:47], s69 offen offset:3072 sc1
v_mfma_f32_16x16x32_bf16 v[96:99], v[144:147], a[52:55], v[96:99]
s_add_u32 m0, s77, 32768
ds_read_b64_tr_b16 v[208:209], v8 offset:36864
ds_read_b64_tr_b16 v[210:211], v8 offset:38912
v_mfma_f32_16x16x32_bf16 v[96:99], v[128:131], a[48:51], v[96:99]
s_add_u32 s72, s71, 0
buffer_load_dwordx4 v15, s[24:27], s72 offen lds
v_mfma_f32_16x16x32_bf16 v[100:103], v[132:135], a[48:51], v[100:103]
s_nop 0
ds_read_b64_tr_b16 v[212:213], v9 offset:36864
ds_read_b64_tr_b16 v[214:215], v9 offset:38912
v_mfma_f32_16x16x32_bf16 v[100:103], v[148:151], a[52:55], v[100:103]
s_nop 0
ds_read_b64_tr_b16 v[216:217], v10 offset:36864
ds_read_b64_tr_b16 v[218:219], v10 offset:38912
v_mfma_f32_16x16x32_bf16 v[100:103], v[164:167], a[56:59], v[100:103]
s_nop 0
ds_read_b64_tr_b16 v[220:221], v11 offset:36864
ds_read_b64_tr_b16 v[222:223], v11 offset:38912
v_mfma_f32_16x16x32_bf16 v[100:103], v[180:183], a[60:63], v[100:103]
v_mfma_f32_16x16x32_bf16 v[84:87], v[180:183], a[44:47], v[84:87]
s_nop 0
ds_read_b64_tr_b16 v[224:225], v8 offset:40960
ds_read_b64_tr_b16 v[226:227], v8 offset:43008
v_mfma_f32_16x16x32_bf16 v[84:87], v[164:167], a[40:43], v[84:87]
s_add_u32 s72, s71, 15360
buffer_load_dwordx4 v15, s[24:27], s72 offen offset:1024 lds
v_mfma_f32_16x16x32_bf16 v[84:87], v[148:151], a[36:39], v[84:87]
s_nop 0
ds_read_b64_tr_b16 v[228:229], v9 offset:40960
ds_read_b64_tr_b16 v[230:231], v9 offset:43008
v_mfma_f32_16x16x32_bf16 v[84:87], v[132:135], a[32:35], v[84:87]
s_waitcnt vmcnt(22)
v_cmp_gt_u32 vcc, 2, v3
s_cbranch_vccnz Lspin106
Lback107:
s_lshr_b32 s69, s12, 18
s_lshl_b32 s69, s69, 12
s_add_u32 s69, s69, s95
s_xor_b32 s69, s69, 0x1000
buffer_load_dwordx4 a[128:131], v1, s[44:47], s69 offen sc1
v_mfma_f32_16x16x32_bf16 v[88:91], v[136:139], a[32:35], v[88:91]
s_nop 0
Lstube1:
s_cbranch_execz Lstube5
ds_read_b64_tr_b16 v[232:233], v10 offset:40960
ds_read_b64_tr_b16 v[234:235], v10 offset:43008
v_mfma_f32_16x16x32_bf16 v[88:91], v[152:155], a[36:39], v[88:91]
s_nop 0
ds_read_b64_tr_b16 v[236:237], v11 offset:40960
ds_read_b64_tr_b16 v[238:239], v11 offset:43008
v_mfma_f32_16x16x32_bf16 v[88:91], v[168:171], a[40:43], v[88:91]
v_mfma_f32_16x16x32_bf16 v[88:91], v[184:187], a[44:47], v[88:91]
s_add_u32 s72, s71, 30720
buffer_load_dwordx4 v15, s[24:27], s72 offen offset:2048 lds
v_mfma_f32_16x16x32_bf16 v[104:107], v[184:187], a[60:63], v[104:107]
s_nop 0
ds_read_b64_tr_b16 v[240:241], v8 offset:45056
ds_read_b64_tr_b16 v[242:243], v8 offset:47104
v_mfma_f32_16x16x32_bf16 v[104:107], v[168:171], a[56:59], v[104:107]
s_nop 0
ds_read_b64_tr_b16 v[244:245], v9 offset:45056
ds_read_b64_tr_b16 v[246:247], v9 offset:47104
v_mfma_f32_16x16x32_bf16 v[104:107], v[152:155], a[52:55], v[104:107]
s_nop 0
ds_read_b64_tr_b16 v[248:249], v10 offset:45056
ds_read_b64_tr_b16 v[250:251], v10 offset:47104
v_mfma_f32_16x16x32_bf16 v[104:107], v[136:139], a[48:51], v[104:107]
s_nop 0
ds_read_b64_tr_b16 v[252:253], v11 offset:45056
ds_read_b64_tr_b16 v[254:255], v11 offset:47104
v_mfma_f32_16x16x32_bf16 v[108:111], v[140:143], a[48:51], v[108:111]
v_mfma_f32_16x16x32_bf16 v[108:111], v[156:159], a[52:55], v[108:111]
s_add_u32 s72, s71, 46080
buffer_load_dwordx4 v15, s[24:27], s72 offen offset:3072 lds
v_mfma_f32_16x16x32_bf16 v[108:111], v[172:175], a[56:59], v[108:111]
buffer_load_dwordx4 a[132:135], v1, s[44:47], s69 offen offset:1024 sc1
v_mfma_f32_16x16x32_bf16 v[108:111], v[188:191], a[60:63], v[108:111]
v_mfma_f32_16x16x32_bf16 v[92:95], v[188:191], a[44:47], v[92:95]
v_mfma_f32_16x16x32_bf16 v[92:95], v[172:175], a[40:43], v[92:95]
v_mfma_f32_16x16x32_bf16 v[92:95], v[156:159], a[36:39], v[92:95]
s_waitcnt vmcnt(22) lgkmcnt(0)
v_mfma_f32_16x16x32_bf16 v[92:95], v[140:143], a[32:35], v[92:95]
s_barrier
v_mfma_f32_16x16x32_bf16 v[16:19], v[192:195], a[64:67], v[16:19]
s_nop 0
ds_read_b64_tr_b16 v[128:129], v8 offset:49152
ds_read_b64_tr_b16 v[130:131], v8 offset:51200
v_mfma_f32_16x16x32_bf16 v[16:19], v[208:211], a[68:71], v[16:19]
s_xor_b32 s71, s15, 0x180
ds_read_b64_tr_b16 v[132:133], v9 offset:49152
ds_read_b64_tr_b16 v[134:135], v9 offset:51200
v_mfma_f32_16x16x32_bf16 v[16:19], v[224:227], a[72:75], v[16:19]
s_add_u32 m0, s77, 49152
ds_read_b64_tr_b16 v[136:137], v10 offset:49152
ds_read_b64_tr_b16 v[138:139], v10 offset:51200
v_mfma_f32_16x16x32_bf16 v[16:19], v[240:243], a[76:79], v[16:19]
s_add_u32 s72, s71, 0
buffer_load_dwordx4 v15, s[24:27], s72 offen lds
v_mfma_f32_16x16x32_bf16 v[32:35], v[240:243], a[92:95], v[32:35]
buffer_load_dwordx4 a[136:139], v1, s[44:47], s69 offen offset:2048 sc1
v_mfma_f32_16x16x32_bf16 v[32:35], v[224:227], a[88:91], v[32:35]
s_nop 0
ds_read_b64_tr_b16 v[140:141], v11 offset:49152
ds_read_b64_tr_b16 v[142:143], v11 offset:51200
v_mfma_f32_16x16x32_bf16 v[32:35], v[208:211], a[84:87], v[32:35]
v_mfma_f32_16x16x32_bf16 v[32:35], v[192:195], a[80:83], v[32:35]
s_nop 0
ds_read_b64_tr_b16 v[144:145], v8 offset:53248
ds_read_b64_tr_b16 v[146:147], v8 offset:55296
v_mfma_f32_16x16x32_bf16 v[36:39], v[196:199], a[80:83], v[36:39]
s_add_u32 s72, s71, 15360
buffer_load_dwordx4 v15, s[24:27], s72 offen offset:1024 lds
v_mfma_f32_16x16x32_bf16 v[36:39], v[212:215], a[84:87], v[36:39]
s_nop 0
ds_read_b64_tr_b16 v[148:149], v9 offset:53248
ds_read_b64_tr_b16 v[150:151], v9 offset:55296
v_mfma_f32_16x16x32_bf16 v[36:39], v[228:231], a[88:91], v[36:39]
s_nop 0
ds_read_b64_tr_b16 v[152:153], v10 offset:53248
ds_read_b64_tr_b16 v[154:155], v10 offset:55296
v_mfma_f32_16x16x32_bf16 v[36:39], v[244:247], a[92:95], v[36:39]
s_nop 0
ds_read_b64_tr_b16 v[156:157], v11 offset:53248
ds_read_b64_tr_b16 v[158:159], v11 offset:55296
v_mfma_f32_16x16x32_bf16 v[20:23], v[244:247], a[76:79], v[20:23]
v_mfma_f32_16x16x32_bf16 v[20:23], v[228:231], a[72:75], v[20:23]
buffer_load_dwordx4 a[140:143], v1, s[44:47], s69 offen offset:3072 sc1
v_mfma_f32_16x16x32_bf16 v[20:23], v[212:215], a[68:71], v[20:23]
s_add_u32 s72, s71, 30720
buffer_load_dwordx4 v15, s[24:27], s72 offen offset:2048 lds
v_mfma_f32_16x16x32_bf16 v[20:23], v[196:199], a[64:67], v[20:23]
s_nop 0
ds_read_b64_tr_b16 v[160:161], v8 offset:57344
ds_read_b64_tr_b16 v[162:163], v8 offset:59392
v_mfma_f32_16x16x32_bf16 v[24:27], v[200:203], a[64:67], v[24:27]
s_nop 0
ds_read_b64_tr_b16 v[164:165], v9 offset:57344
ds_read_b64_tr_b16 v[166:167], v9 offset:59392
v_mfma_f32_16x16x32_bf16 v[24:27], v[216:219], a[68:71], v[24:27]
s_nop 0
ds_read_b64_tr_b16 v[168:169], v10 offset:57344
ds_read_b64_tr_b16 v[170:171], v10 offset:59392
v_mfma_f32_16x16x32_bf16 v[24:27], v[232:235], a[72:75], v[24:27]
s_nop 0
ds_read_b64_tr_b16 v[172:173], v11 offset:57344
ds_read_b64_tr_b16 v[174:175], v11 offset:59392
v_mfma_f32_16x16x32_bf16 v[24:27], v[248:251], a[76:79], v[24:27]
v_mfma_f32_16x16x32_bf16 v[40:43], v[248:251], a[92:95], v[40:43]
s_add_u32 s72, s71, 46080
buffer_load_dwordx4 v15, s[24:27], s72 offen offset:3072 lds
v_mfma_f32_16x16x32_bf16 v[40:43], v[232:235], a[88:91], v[40:43]
s_nop 0
ds_read_b64_tr_b16 v[176:177], v8 offset:61440
ds_read_b64_tr_b16 v[178:179], v8 offset:63488
v_mfma_f32_16x16x32_bf16 v[40:43], v[216:219], a[84:87], v[40:43]
s_nop 0
ds_read_b64_tr_b16 v[180:181], v9 offset:61440
ds_read_b64_tr_b16 v[182:183], v9 offset:63488
v_mfma_f32_16x16x32_bf16 v[40:43], v[200:203], a[80:83], v[40:43]
s_add_u32 s69, s69, 0x20000
buffer_load_dwordx4 a[144:147], v1, s[44:47], s69 offen sc1
v_mfma_f32_16x16x32_bf16 v[44:47], v[204:207], a[80:83], v[44:47]
s_nop 0
ds_read_b64_tr_b16 v[184:185], v10 offset:61440
ds_read_b64_tr_b16 v[186:187], v10 offset:63488
v_mfma_f32_16x16x32_bf16 v[44:47], v[220:223], a[84:87], v[44:47]
s_nop 0
ds_read_b64_tr_b16 v[188:189], v11 offset:61440
ds_read_b64_tr_b16 v[190:191], v11 offset:63488
v_mfma_f32_16x16x32_bf16 v[44:47], v[236:239], a[88:91], v[44:47]
v_mfma_f32_16x16x32_bf16 v[44:47], v[252:255], a[92:95], v[44:47]
s_xor_b32 s71, s12, 0x40080
v_mfma_f32_16x16x32_bf16 v[28:31], v[252:255], a[76:79], v[28:31]
s_add_u32 m0, s85, 0
v_xor_b32 v8, 0x10000, v8
v_mfma_f32_16x16x32_bf16 v[28:31], v[236:239], a[72:75], v[28:31]
s_add_u32 s72, s71, 0
v_xor_b32 v9, 0x10000, v9
v_mfma_f32_16x16x32_bf16 v[28:31], v[220:223], a[68:71], v[28:31]
s_waitcnt vmcnt(21) lgkmcnt(0)
buffer_load_dwordx4 v15, s[24:27], s72 offen lds
v_xor_b32 v10, 0x10000, v10
v_mfma_f32_16x16x32_bf16 v[28:31], v[204:207], a[64:67], v[28:31]
s_barrier
v_xor_b32 v11, 0x10000, v11
v_mfma_f32_16x16x32_bf16 v[48:51], v[128:131], a[64:67], v[48:51]
s_nop 0
ds_read_b64_tr_b16 v[192:193], v8 offset:0
ds_read_b64_tr_b16 v[194:195], v8 offset:2048
v_mfma_f32_16x16x32_bf16 v[48:51], v[144:147], a[68:71], v[48:51]
buffer_load_dwordx4 a[148:151], v1, s[44:47], s69 offen offset:1024 sc1
v_mfma_f32_16x16x32_bf16 v[48:51], v[160:163], a[72:75], v[48:51]
s_nop 0
ds_read_b64_tr_b16 v[196:197], v9 offset:0
ds_read_b64_tr_b16 v[198:199], v9 offset:2048
v_mfma_f32_16x16x32_bf16 v[48:51], v[176:179], a[76:79], v[48:51]
s_add_u32 s72, s71, 15360
buffer_load_dwordx4 v15, s[24:27], s72 offen offset:1024 lds
v_mfma_f32_16x16x32_bf16 v[64:67], v[176:179], a[92:95], v[64:67]
s_nop 0
ds_read_b64_tr_b16 v[200:201], v10 offset:0
ds_read_b64_tr_b16 v[202:203], v10 offset:2048
v_mfma_f32_16x16x32_bf16 v[64:67], v[160:163], a[88:91], v[64:67]
s_nop 0
ds_read_b64_tr_b16 v[204:205], v11 offset:0
ds_read_b64_tr_b16 v[206:207], v11 offset:2048
v_mfma_f32_16x16x32_bf16 v[64:67], v[144:147], a[84:87], v[64:67]
v_mfma_f32_16x16x32_bf16 v[64:67], v[128:131], a[80:83], v[64:67]
s_nop 0
ds_read_b64_tr_b16 v[208:209], v8 offset:4096
ds_read_b64_tr_b16 v[210:211], v8 offset:6144
v_mfma_f32_16x16x32_bf16 v[68:71], v[132:135], a[80:83], v[68:71]
s_nop 0
ds_read_b64_tr_b16 v[212:213], v9 offset:4096
ds_read_b64_tr_b16 v[214:215], v9 offset:6144
v_mfma_f32_16x16x32_bf16 v[68:71], v[148:151], a[84:87], v[68:71]
s_add_u32 s72, s71, 30720
buffer_load_dwordx4 v15, s[24:27], s72 offen offset:2048 lds
v_mfma_f32_16x16x32_bf16 v[68:71], v[164:167], a[88:91], v[68:71]
s_nop 0
ds_read_b64_tr_b16 v[216:217], v10 offset:4096
ds_read_b64_tr_b16 v[218:219], v10 offset:6144
v_mfma_f32_16x16x32_bf16 v[68:71], v[180:183], a[92:95], v[68:71]
buffer_load_dwordx4 a[152:155], v1, s[44:47], s69 offen offset:2048 sc1
v_mfma_f32_16x16x32_bf16 v[52:55], v[180:183], a[76:79], v[52:55]
s_nop 0
ds_read_b64_tr_b16 v[220:221], v11 offset:4096
ds_read_b64_tr_b16 v[222:223], v11 offset:6144
v_mfma_f32_16x16x32_bf16 v[52:55], v[164:167], a[72:75], v[52:55]
v_mfma_f32_16x16x32_bf16 v[52:55], v[148:151], a[68:71], v[52:55]
s_nop 0
ds_read_b64_tr_b16 v[224:225], v8 offset:8192
ds_read_b64_tr_b16 v[226:227], v8 offset:10240
v_mfma_f32_16x16x32_bf16 v[52:55], v[132:135], a[64:67], v[52:55]
s_add_u32 s72, s71, 46080
buffer_load_dwordx4 v15, s[24:27], s72 offen offset:3072 lds
v_mfma_f32_16x16x32_bf16 v[56:59], v[136:139], a[64:67], v[56:59]
s_nop 0
ds_read_b64_tr_b16 v[228:229], v9 offset:8192
ds_read_b64_tr_b16 v[230:231], v9 offset:10240
v_mfma_f32_16x16x32_bf16 v[56:59], v[152:155], a[68:71], v[56:59]
s_nop 0
ds_read_b64_tr_b16 v[232:233], v10 offset:8192
ds_read_b64_tr_b16 v[234:235], v10 offset:10240
v_mfma_f32_16x16x32_bf16 v[56:59], v[168:171], a[72:75], v[56:59]
s_nop 0
ds_read_b64_tr_b16 v[236:237], v11 offset:8192
ds_read_b64_tr_b16 v[238:239], v11 offset:10240
v_mfma_f32_16x16x32_bf16 v[56:59], v[184:187], a[76:79], v[56:59]
v_mfma_f32_16x16x32_bf16 v[72:75], v[184:187], a[92:95], v[72:75]
s_nop 0
ds_read_b64_tr_b16 v[240:241], v8 offset:12288
ds_read_b64_tr_b16 v[242:243], v8 offset:14336
v_mfma_f32_16x16x32_bf16 v[72:75], v[168:171], a[88:91], v[72:75]
buffer_load_dwordx4 a[156:159], v1, s[44:47], s69 offen offset:3072 sc1
v_mfma_f32_16x16x32_bf16 v[72:75], v[152:155], a[84:87], v[72:75]
s_lshr_b32 s69, s13, 18
ds_read_b64_tr_b16 v[244:245], v9 offset:12288
ds_read_b64_tr_b16 v[246:247], v9 offset:14336
v_mfma_f32_16x16x32_bf16 v[72:75], v[136:139], a[80:83], v[72:75]
s_xor_b32 s71, s12, 0x40100
ds_read_b64_tr_b16 v[248:249], v10 offset:12288
ds_read_b64_tr_b16 v[250:251], v10 offset:14336
v_mfma_f32_16x16x32_bf16 v[76:79], v[140:143], a[80:83], v[76:79]
s_add_u32 m0, s85, 16384
ds_read_b64_tr_b16 v[252:253], v11 offset:12288
ds_read_b64_tr_b16 v[254:255], v11 offset:14336
v_mfma_f32_16x16x32_bf16 v[76:79], v[156:159], a[84:87], v[76:79]
s_add_u32 s72, s71, 0
buffer_load_dwordx4 v15, s[24:27], s72 offen lds
v_mfma_f32_16x16x32_bf16 v[76:79], v[172:175], a[88:91], v[76:79]
s_lshl_b32 s69, s69, 12
v_mfma_f32_16x16x32_bf16 v[76:79], v[188:191], a[92:95], v[76:79]
s_add_u32 s69, s69, s95
v_mfma_f32_16x16x32_bf16 v[60:63], v[188:191], a[76:79], v[60:63]
s_xor_b32 s69, s69, 0x1000
v_mfma_f32_16x16x32_bf16 v[60:63], v[172:175], a[72:75], v[60:63]
s_add_u32 s72, s71, 15360
v_mfma_f32_16x16x32_bf16 v[60:63], v[156:159], a[68:71], v[60:63]
s_waitcnt vmcnt(16) lgkmcnt(0)
buffer_load_dwordx4 a[160:163], v1, s[44:47], s69 offen sc1
v_mfma_f32_16x16x32_bf16 v[60:63], v[140:143], a[64:67], v[60:63]
s_barrier
buffer_load_dwordx4 v15, s[24:27], s72 offen offset:1024 lds
v_mfma_f32_16x16x32_bf16 v[80:83], v[192:195], a[64:67], v[80:83]
s_and_b32 s79, s91, 0xffff9fff
v_lshrrev_b32 v13, 4, v0
v_lshlrev_b32 v13, 13, v13
buffer_load_dword v14, v13, s[44:47], s79 offen sc1
v_mfma_f32_16x16x32_bf16 v[80:83], v[208:211], a[68:71], v[80:83]
s_nop 0
ds_read_b64_tr_b16 v[128:129], v8 offset:16384
ds_read_b64_tr_b16 v[130:131], v8 offset:18432
v_mfma_f32_16x16x32_bf16 v[80:83], v[224:227], a[72:75], v[80:83]
s_nop 0
ds_read_b64_tr_b16 v[132:133], v9 offset:16384
ds_read_b64_tr_b16 v[134:135], v9 offset:18432
v_mfma_f32_16x16x32_bf16 v[80:83], v[240:243], a[76:79], v[80:83]
s_nop 0
ds_read_b64_tr_b16 v[136:137], v10 offset:16384
ds_read_b64_tr_b16 v[138:139], v10 offset:18432
v_mfma_f32_16x16x32_bf16 v[96:99], v[240:243], a[92:95], v[96:99]
s_nop 0
ds_read_b64_tr_b16 v[140:141], v11 offset:16384
ds_read_b64_tr_b16 v[142:143], v11 offset:18432
v_mfma_f32_16x16x32_bf16 v[96:99], v[224:227], a[88:91], v[96:99]
s_add_u32 s72, s71, 30720
buffer_load_dwordx4 v15, s[24:27], s72 offen offset:2048 lds
v_mfma_f32_16x16x32_bf16 v[96:99], v[208:211], a[84:87], v[96:99]
v_mfma_f32_16x16x32_bf16 v[96:99], v[192:195], a[80:83], v[96:99]
s_nop 0
ds_read_b64_tr_b16 v[144:145], v8 offset:20480
ds_read_b64_tr_b16 v[146:147], v8 offset:22528
v_mfma_f32_16x16x32_bf16 v[100:103], v[196:199], a[80:83], v[100:103]
buffer_load_dwordx4 a[164:167], v1, s[44:47], s69 offen offset:1024 sc1
v_mfma_f32_16x16x32_bf16 v[100:103], v[212:215], a[84:87], v[100:103]
s_nop 0
ds_read_b64_tr_b16 v[148:149], v9 offset:20480
ds_read_b64_tr_b16 v[150:151], v9 offset:22528
v_mfma_f32_16x16x32_bf16 v[100:103], v[228:231], a[88:91], v[100:103]
s_nop 0
ds_read_b64_tr_b16 v[152:153], v10 offset:20480
ds_read_b64_tr_b16 v[154:155], v10 offset:22528
v_mfma_f32_16x16x32_bf16 v[100:103], v[244:247], a[92:95], v[100:103]
s_add_u32 s72, s71, 46080
buffer_load_dwordx4 v15, s[24:27], s72 offen offset:3072 lds
v_mfma_f32_16x16x32_bf16 v[84:87], v[244:247], a[76:79], v[84:87]
s_nop 0
ds_read_b64_tr_b16 v[156:157], v11 offset:20480
ds_read_b64_tr_b16 v[158:159], v11 offset:22528
v_mfma_f32_16x16x32_bf16 v[84:87], v[228:231], a[72:75], v[84:87]
v_mfma_f32_16x16x32_bf16 v[84:87], v[212:215], a[68:71], v[84:87]
s_nop 0
ds_read_b64_tr_b16 v[160:161], v8 offset:24576
ds_read_b64_tr_b16 v[162:163], v8 offset:26624
v_mfma_f32_16x16x32_bf16 v[84:87], v[196:199], a[64:67], v[84:87]
s_nop 0
ds_read_b64_tr_b16 v[164:165], v9 offset:24576
ds_read_b64_tr_b16 v[166:167], v9 offset:26624
v_mfma_f32_16x16x32_bf16 v[88:91], v[200:203], a[64:67], v[88:91]
s_nop 0
ds_read_b64_tr_b16 v[168:169], v10 offset:24576
ds_read_b64_tr_b16 v[170:171], v10 offset:26624
v_mfma_f32_16x16x32_bf16 v[88:91], v[216:219], a[68:71], v[88:91]
s_nop 0
ds_read_b64_tr_b16 v[172:173], v11 offset:24576
ds_read_b64_tr_b16 v[174:175], v11 offset:26624
v_mfma_f32_16x16x32_bf16 v[88:91], v[232:235], a[72:75], v[88:91]
buffer_load_dwordx4 a[168:171], v1, s[44:47], s69 offen offset:2048 sc1
v_mfma_f32_16x16x32_bf16 v[88:91], v[248:251], a[76:79], v[88:91]
s_xor_b32 s71, s12, 0x40180
v_mfma_f32_16x16x32_bf16 v[104:107], v[248:251], a[92:95], v[104:107]
s_add_u32 m0, s85, 32768
ds_read_b64_tr_b16 v[176:177], v8 offset:28672
ds_read_b64_tr_b16 v[178:179], v8 offset:30720
v_mfma_f32_16x16x32_bf16 v[104:107], v[232:235], a[88:91], v[104:107]
s_add_u32 s72, s71, 0
buffer_load_dwordx4 v15, s[24:27], s72 offen lds
v_mfma_f32_16x16x32_bf16 v[104:107], v[216:219], a[84:87], v[104:107]
s_nop 0
ds_read_b64_tr_b16 v[180:181], v9 offset:28672
ds_read_b64_tr_b16 v[182:183], v9 offset:30720
v_mfma_f32_16x16x32_bf16 v[104:107], v[200:203], a[80:83], v[104:107]
s_nop 0
ds_read_b64_tr_b16 v[184:185], v10 offset:28672
ds_read_b64_tr_b16 v[186:187], v10 offset:30720
v_mfma_f32_16x16x32_bf16 v[108:111], v[204:207], a[80:83], v[108:111]
s_nop 0
ds_read_b64_tr_b16 v[188:189], v11 offset:28672
ds_read_b64_tr_b16 v[190:191], v11 offset:30720
v_mfma_f32_16x16x32_bf16 v[108:111], v[220:223], a[84:87], v[108:111]
v_mfma_f32_16x16x32_bf16 v[108:111], v[236:239], a[88:91], v[108:111]
s_add_u32 s72, s71, 15360
buffer_load_dwordx4 v15, s[24:27], s72 offen offset:1024 lds
v_mfma_f32_16x16x32_bf16 v[108:111], v[252:255], a[92:95], v[108:111]
v_mfma_f32_16x16x32_bf16 v[92:95], v[252:255], a[76:79], v[92:95]
buffer_load_dwordx4 a[172:175], v1, s[44:47], s69 offen offset:3072 sc1
v_mfma_f32_16x16x32_bf16 v[92:95], v[236:239], a[72:75], v[92:95]
v_mfma_f32_16x16x32_bf16 v[92:95], v[220:223], a[68:71], v[92:95]
s_waitcnt vmcnt(31) lgkmcnt(0)
v_mfma_f32_16x16x32_bf16 v[92:95], v[204:207], a[64:67], v[92:95]
v_mfma_f32_16x16x32_bf16 v[16:19], v[128:131], a[96:99], v[16:19]
s_add_u32 s72, s71, 30720
buffer_load_dwordx4 v15, s[24:27], s72 offen offset:2048 lds
v_mfma_f32_16x16x32_bf16 v[16:19], v[144:147], a[100:103], v[16:19]
s_nop 0
ds_read_b64_tr_b16 v[192:193], v8 offset:32768
ds_read_b64_tr_b16 v[194:195], v8 offset:34816
v_mfma_f32_16x16x32_bf16 v[16:19], v[160:163], a[104:107], v[16:19]
s_nop 0
ds_read_b64_tr_b16 v[196:197], v9 offset:32768
ds_read_b64_tr_b16 v[198:199], v9 offset:34816
v_mfma_f32_16x16x32_bf16 v[16:19], v[176:179], a[108:111], v[16:19]
s_nop 0
ds_read_b64_tr_b16 v[200:201], v10 offset:32768
ds_read_b64_tr_b16 v[202:203], v10 offset:34816
v_mfma_f32_16x16x32_bf16 v[32:35], v[176:179], a[124:127], v[32:35]
s_nop 0
ds_read_b64_tr_b16 v[204:205], v11 offset:32768
ds_read_b64_tr_b16 v[206:207], v11 offset:34816
v_mfma_f32_16x16x32_bf16 v[32:35], v[160:163], a[120:123], v[32:35]
v_mfma_f32_16x16x32_bf16 v[32:35], v[144:147], a[116:119], v[32:35]
s_add_u32 s72, s71, 46080
buffer_load_dwordx4 v15, s[24:27], s72 offen offset:3072 lds
v_mfma_f32_16x16x32_bf16 v[32:35], v[128:131], a[112:115], v[32:35]
s_add_u32 s69, s69, 0x20000
buffer_load_dwordx4 a[176:179], v1, s[44:47], s69 offen sc1
v_mfma_f32_16x16x32_bf16 v[36:39], v[132:135], a[112:115], v[36:39]
s_nop 0
ds_read_b64_tr_b16 v[208:209], v8 offset:36864
ds_read_b64_tr_b16 v[210:211], v8 offset:38912
v_mfma_f32_16x16x32_bf16 v[36:39], v[148:151], a[116:119], v[36:39]
s_nop 0
ds_read_b64_tr_b16 v[212:213], v9 offset:36864
ds_read_b64_tr_b16 v[214:215], v9 offset:38912
v_mfma_f32_16x16x32_bf16 v[36:39], v[164:167], a[120:123], v[36:39]
s_nop 0
ds_read_b64_tr_b16 v[216:217], v10 offset:36864
ds_read_b64_tr_b16 v[218:219], v10 offset:38912
v_mfma_f32_16x16x32_bf16 v[36:39], v[180:183], a[124:127], v[36:39]
s_nop 0
ds_read_b64_tr_b16 v[220:221], v11 offset:36864
ds_read_b64_tr_b16 v[222:223], v11 offset:38912
v_mfma_f32_16x16x32_bf16 v[20:23], v[180:183], a[108:111], v[20:23]
v_mfma_f32_16x16x32_bf16 v[20:23], v[164:167], a[104:107], v[20:23]
s_nop 0
ds_read_b64_tr_b16 v[224:225], v8 offset:40960
ds_read_b64_tr_b16 v[226:227], v8 offset:43008
v_mfma_f32_16x16x32_bf16 v[20:23], v[148:151], a[100:103], v[20:23]
s_xor_b32 s71, s13, 0x40080
ds_read_b64_tr_b16 v[228:229], v9 offset:40960
ds_read_b64_tr_b16 v[230:231], v9 offset:43008
v_mfma_f32_16x16x32_bf16 v[20:23], v[132:135], a[96:99], v[20:23]
s_add_u32 m0, s85, 49152
ds_read_b64_tr_b16 v[232:233], v10 offset:40960
ds_read_b64_tr_b16 v[234:235], v10 offset:43008
v_mfma_f32_16x16x32_bf16 v[24:27], v[136:139], a[96:99], v[24:27]
s_add_u32 s72, s71, 0
buffer_load_dwordx4 v15, s[24:27], s72 offen lds
v_mfma_f32_16x16x32_bf16 v[24:27], v[152:155], a[100:103], v[24:27]
buffer_load_dwordx4 a[180:183], v1, s[44:47], s69 offen offset:1024 sc1
v_mfma_f32_16x16x32_bf16 v[24:27], v[168:171], a[104:107], v[24:27]
s_nop 0
ds_read_b64_tr_b16 v[236:237], v11 offset:40960
ds_read_b64_tr_b16 v[238:239], v11 offset:43008
v_mfma_f32_16x16x32_bf16 v[24:27], v[184:187], a[108:111], v[24:27]
v_mfma_f32_16x16x32_bf16 v[40:43], v[184:187], a[124:127], v[40:43]
s_nop 0
ds_read_b64_tr_b16 v[240:241], v8 offset:45056
ds_read_b64_tr_b16 v[242:243], v8 offset:47104
v_mfma_f32_16x16x32_bf16 v[40:43], v[168:171], a[120:123], v[40:43]
s_nop 0
ds_read_b64_tr_b16 v[244:245], v9 offset:45056
ds_read_b64_tr_b16 v[246:247], v9 offset:47104
v_mfma_f32_16x16x32_bf16 v[40:43], v[152:155], a[116:119], v[40:43]
s_add_u32 s72, s71, 15360
buffer_load_dwordx4 v15, s[24:27], s72 offen offset:1024 lds
v_mfma_f32_16x16x32_bf16 v[40:43], v[136:139], a[112:115], v[40:43]
s_nop 0
ds_read_b64_tr_b16 v[248:249], v10 offset:45056
ds_read_b64_tr_b16 v[250:251], v10 offset:47104
v_mfma_f32_16x16x32_bf16 v[44:47], v[140:143], a[112:115], v[44:47]
s_nop 0
ds_read_b64_tr_b16 v[252:253], v11 offset:45056
ds_read_b64_tr_b16 v[254:255], v11 offset:47104
v_mfma_f32_16x16x32_bf16 v[44:47], v[156:159], a[116:119], v[44:47]
v_mfma_f32_16x16x32_bf16 v[44:47], v[172:175], a[120:123], v[44:47]
buffer_load_dwordx4 a[184:187], v1, s[44:47], s69 offen offset:2048 sc1
v_mfma_f32_16x16x32_bf16 v[44:47], v[188:191], a[124:127], v[44:47]
v_mfma_f32_16x16x32_bf16 v[28:31], v[188:191], a[108:111], v[28:31]
s_add_u32 s72, s71, 30720
buffer_load_dwordx4 v15, s[24:27], s72 offen offset:2048 lds
v_mfma_f32_16x16x32_bf16 v[28:31], v[172:175], a[104:107], v[28:31]
v_mfma_f32_16x16x32_bf16 v[28:31], v[156:159], a[100:103], v[28:31]
s_waitcnt vmcnt(20) lgkmcnt(0)
v_mfma_f32_16x16x32_bf16 v[28:31], v[140:143], a[96:99], v[28:31]
s_barrier
v_mfma_f32_16x16x32_bf16 v[48:51], v[192:195], a[96:99], v[48:51]
s_nop 0
ds_read_b64_tr_b16 v[128:129], v8 offset:49152
ds_read_b64_tr_b16 v[130:131], v8 offset:51200
v_mfma_f32_16x16x32_bf16 v[48:51], v[208:211], a[100:103], v[48:51]
s_nop 0
ds_read_b64_tr_b16 v[132:133], v9 offset:49152
ds_read_b64_tr_b16 v[134:135], v9 offset:51200
v_mfma_f32_16x16x32_bf16 v[48:51], v[224:227], a[104:107], v[48:51]
s_add_u32 s72, s71, 46080
buffer_load_dwordx4 v15, s[24:27], s72 offen offset:3072 lds
v_mfma_f32_16x16x32_bf16 v[48:51], v[240:243], a[108:111], v[48:51]
s_nop 0
ds_read_b64_tr_b16 v[136:137], v10 offset:49152
ds_read_b64_tr_b16 v[138:139], v10 offset:51200
v_mfma_f32_16x16x32_bf16 v[64:67], v[240:243], a[124:127], v[64:67]
buffer_load_dwordx4 a[188:191], v1, s[44:47], s69 offen offset:3072 sc1
v_mfma_f32_16x16x32_bf16 v[64:67], v[224:227], a[120:123], v[64:67]
s_nop 0
ds_read_b64_tr_b16 v[140:141], v11 offset:49152
ds_read_b64_tr_b16 v[142:143], v11 offset:51200
v_mfma_f32_16x16x32_bf16 v[64:67], v[208:211], a[116:119], v[64:67]
s_nop 0
ds_read_b64_tr_b16 v[144:145], v8 offset:53248
ds_read_b64_tr_b16 v[146:147], v8 offset:55296
v_mfma_f32_16x16x32_bf16 v[64:67], v[192:195], a[112:115], v[64:67]
s_nop 0
ds_read_b64_tr_b16 v[148:149], v9 offset:53248
ds_read_b64_tr_b16 v[150:151], v9 offset:55296
v_mfma_f32_16x16x32_bf16 v[68:71], v[196:199], a[112:115], v[68:71]
s_lshr_b32 s69, s14, 18
v_mfma_f32_16x16x32_bf16 v[68:71], v[212:215], a[116:119], v[68:71]
s_lshl_b32 s69, s69, 12
ds_read_b64_tr_b16 v[152:153], v10 offset:53248
ds_read_b64_tr_b16 v[154:155], v10 offset:55296
v_mfma_f32_16x16x32_bf16 v[68:71], v[228:231], a[120:123], v[68:71]
s_xor_b32 s71, s14, 0x40080
ds_read_b64_tr_b16 v[156:157], v11 offset:53248
ds_read_b64_tr_b16 v[158:159], v11 offset:55296
v_mfma_f32_16x16x32_bf16 v[68:71], v[244:247], a[124:127], v[68:71]
s_add_u32 m0, s77, 0
ds_read_b64_tr_b16 v[160:161], v8 offset:57344
ds_read_b64_tr_b16 v[162:163], v8 offset:59392
v_mfma_f32_16x16x32_bf16 v[52:55], v[244:247], a[108:111], v[52:55]
s_add_u32 s72, s71, 0
buffer_load_dwordx4 v15, s[24:27], s72 offen lds
v_mfma_f32_16x16x32_bf16 v[52:55], v[228:231], a[104:107], v[52:55]
s_add_u32 s69, s69, s95
ds_read_b64_tr_b16 v[164:165], v9 offset:57344
ds_read_b64_tr_b16 v[166:167], v9 offset:59392
v_mfma_f32_16x16x32_bf16 v[52:55], v[212:215], a[100:103], v[52:55]
s_xor_b32 s69, s69, 0x1000
buffer_load_dwordx4 a[192:195], v1, s[44:47], s69 offen sc1
v_mfma_f32_16x16x32_bf16 v[52:55], v[196:199], a[96:99], v[52:55]
s_nop 0
ds_read_b64_tr_b16 v[168:169], v10 offset:57344
ds_read_b64_tr_b16 v[170:171], v10 offset:59392
v_mfma_f32_16x16x32_bf16 v[56:59], v[200:203], a[96:99], v[56:59]
s_waitcnt vmcnt(19)
v_cmp_gt_u32 vcc, 2, v14
s_cbranch_vccnz Lspin112
Lback113:
v_mfma_f32_16x16x32_bf16 v[56:59], v[216:219], a[100:103], v[56:59]
s_add_u32 s72, s71, 15360
buffer_load_dwordx4 v15, s[24:27], s72 offen offset:1024 lds
v_mfma_f32_16x16x32_bf16 v[56:59], v[232:235], a[104:107], v[56:59]
v_mfma_f32_16x16x32_bf16 v[56:59], v[248:251], a[108:111], v[56:59]
s_nop 0
ds_read_b64_tr_b16 v[172:173], v11 offset:57344
ds_read_b64_tr_b16 v[174:175], v11 offset:59392
v_mfma_f32_16x16x32_bf16 v[72:75], v[248:251], a[124:127], v[72:75]
s_nop 0
ds_read_b64_tr_b16 v[176:177], v8 offset:61440
ds_read_b64_tr_b16 v[178:179], v8 offset:63488
v_mfma_f32_16x16x32_bf16 v[72:75], v[232:235], a[120:123], v[72:75]
s_nop 0
ds_read_b64_tr_b16 v[180:181], v9 offset:61440
ds_read_b64_tr_b16 v[182:183], v9 offset:63488
v_mfma_f32_16x16x32_bf16 v[72:75], v[216:219], a[116:119], v[72:75]
s_nop 0
ds_read_b64_tr_b16 v[184:185], v10 offset:61440
ds_read_b64_tr_b16 v[186:187], v10 offset:63488
v_mfma_f32_16x16x32_bf16 v[72:75], v[200:203], a[112:115], v[72:75]
s_add_u32 s72, s71, 30720
buffer_load_dwordx4 v15, s[24:27], s72 offen offset:2048 lds
v_mfma_f32_16x16x32_bf16 v[76:79], v[204:207], a[112:115], v[76:79]
buffer_load_dwordx4 a[196:199], v1, s[44:47], s69 offen offset:1024 sc1
v_mfma_f32_16x16x32_bf16 v[76:79], v[220:223], a[116:119], v[76:79]
s_nop 0
ds_read_b64_tr_b16 v[188:189], v11 offset:61440
ds_read_b64_tr_b16 v[190:191], v11 offset:63488
v_mfma_f32_16x16x32_bf16 v[76:79], v[236:239], a[120:123], v[76:79]
v_mfma_f32_16x16x32_bf16 v[76:79], v[252:255], a[124:127], v[76:79]
v_mfma_f32_16x16x32_bf16 v[60:63], v[252:255], a[108:111], v[60:63]
v_xor_b32 v8, 0x10000, v8
v_mfma_f32_16x16x32_bf16 v[60:63], v[236:239], a[104:107], v[60:63]
s_add_u32 s72, s71, 46080
buffer_load_dwordx4 v15, s[24:27], s72 offen offset:3072 lds
v_xor_b32 v9, 0x10000, v9
v_mfma_f32_16x16x32_bf16 v[60:63], v[220:223], a[100:103], v[60:63]
s_waitcnt lgkmcnt(0)
v_xor_b32 v10, 0x10000, v10
v_mfma_f32_16x16x32_bf16 v[60:63], v[204:207], a[96:99], v[60:63]
v_xor_b32 v11, 0x10000, v11
v_mfma_f32_16x16x32_bf16 v[80:83], v[128:131], a[96:99], v[80:83]
s_lshl_b32 s84, s76, 11
ds_read_b64_tr_b16 v[192:193], v8 offset:0
ds_read_b64_tr_b16 v[194:195], v8 offset:2048
v_mfma_f32_16x16x32_bf16 v[80:83], v[144:147], a[100:103], v[80:83]
s_add_u32 s84, s84, 0x3810000
ds_read_b64_tr_b16 v[196:197], v9 offset:0
ds_read_b64_tr_b16 v[198:199], v9 offset:2048
v_mfma_f32_16x16x32_bf16 v[80:83], v[160:163], a[104:107], v[80:83]
buffer_load_dwordx4 a[200:203], v1, s[44:47], s69 offen offset:2048 sc1
v_mfma_f32_16x16x32_bf16 v[80:83], v[176:179], a[108:111], v[80:83]
s_nop 0
ds_read_b64_tr_b16 v[200:201], v10 offset:0
ds_read_b64_tr_b16 v[202:203], v10 offset:2048
v_mfma_f32_16x16x32_bf16 v[96:99], v[176:179], a[124:127], v[96:99]
s_nop 0
ds_read_b64_tr_b16 v[204:205], v11 offset:0
ds_read_b64_tr_b16 v[206:207], v11 offset:2048
v_mfma_f32_16x16x32_bf16 v[96:99], v[160:163], a[120:123], v[96:99]
s_xor_b32 s71, s15, 0x40080
v_lshrrev_b32 v115, 2, v0
v_lshlrev_b32 v115, 7, v115
v_mfma_f32_16x16x32_bf16 v[96:99], v[144:147], a[116:119], v[96:99]
s_add_u32 m0, s77, 16384
ds_read_b64_tr_b16 v[208:209], v8 offset:4096
ds_read_b64_tr_b16 v[210:211], v8 offset:6144
v_mfma_f32_16x16x32_bf16 v[96:99], v[128:131], a[112:115], v[96:99]
s_add_u32 s72, s71, 0
buffer_load_dwordx4 v15, s[24:27], s72 offen lds
v_mfma_f32_16x16x32_bf16 v[100:103], v[132:135], a[112:115], v[100:103]
Lstube2:
s_cbranch_execz Lrete
s_nop 0
ds_read_b64_tr_b16 v[212:213], v9 offset:4096
ds_read_b64_tr_b16 v[214:215], v9 offset:6144
v_mfma_f32_16x16x32_bf16 v[100:103], v[148:151], a[116:119], v[100:103]
s_nop 0
ds_read_b64_tr_b16 v[216:217], v10 offset:4096
ds_read_b64_tr_b16 v[218:219], v10 offset:6144
v_mfma_f32_16x16x32_bf16 v[100:103], v[164:167], a[120:123], v[100:103]
s_nop 0
ds_read_b64_tr_b16 v[220:221], v11 offset:4096
ds_read_b64_tr_b16 v[222:223], v11 offset:6144
v_mfma_f32_16x16x32_bf16 v[100:103], v[180:183], a[124:127], v[100:103]
buffer_load_dword v114, v115, s[44:47], s84 offen sc1
v_mfma_f32_16x16x32_bf16 v[84:87], v[180:183], a[108:111], v[84:87]
buffer_load_dwordx4 a[204:207], v1, s[44:47], s69 offen offset:3072 sc1
v_mfma_f32_16x16x32_bf16 v[84:87], v[164:167], a[104:107], v[84:87]
s_add_u32 s72, s71, 15360
buffer_load_dwordx4 v15, s[24:27], s72 offen offset:1024 lds
v_mfma_f32_16x16x32_bf16 v[84:87], v[148:151], a[100:103], v[84:87]
s_nop 0
ds_read_b64_tr_b16 v[224:225], v8 offset:8192
ds_read_b64_tr_b16 v[226:227], v8 offset:10240
v_mfma_f32_16x16x32_bf16 v[84:87], v[132:135], a[96:99], v[84:87]
s_nop 0
ds_read_b64_tr_b16 v[228:229], v9 offset:8192
ds_read_b64_tr_b16 v[230:231], v9 offset:10240
v_mfma_f32_16x16x32_bf16 v[88:91], v[136:139], a[96:99], v[88:91]
s_nop 0
ds_read_b64_tr_b16 v[232:233], v10 offset:8192
ds_read_b64_tr_b16 v[234:235], v10 offset:10240
v_mfma_f32_16x16x32_bf16 v[88:91], v[152:155], a[100:103], v[88:91]
s_nop 0
ds_read_b64_tr_b16 v[236:237], v11 offset:8192
ds_read_b64_tr_b16 v[238:239], v11 offset:10240
v_mfma_f32_16x16x32_bf16 v[88:91], v[168:171], a[104:107], v[88:91]
v_mfma_f32_16x16x32_bf16 v[88:91], v[184:187], a[108:111], v[88:91]
s_add_u32 s72, s71, 30720
buffer_load_dwordx4 v15, s[24:27], s72 offen offset:2048 lds
v_mfma_f32_16x16x32_bf16 v[104:107], v[184:187], a[124:127], v[104:107]
s_nop 0
ds_read_b64_tr_b16 v[240:241], v8 offset:12288
ds_read_b64_tr_b16 v[242:243], v8 offset:14336
v_mfma_f32_16x16x32_bf16 v[104:107], v[168:171], a[120:123], v[104:107]
s_nop 0
ds_read_b64_tr_b16 v[244:245], v9 offset:12288
ds_read_b64_tr_b16 v[246:247], v9 offset:14336
v_mfma_f32_16x16x32_bf16 v[104:107], v[152:155], a[116:119], v[104:107]
s_add_u32 s69, s69, 0x20000
buffer_load_dwordx4 a[208:211], v1, s[44:47], s69 offen sc1
v_mfma_f32_16x16x32_bf16 v[104:107], v[136:139], a[112:115], v[104:107]
s_nop 0
ds_read_b64_tr_b16 v[248:249], v10 offset:12288
ds_read_b64_tr_b16 v[250:251], v10 offset:14336
v_mfma_f32_16x16x32_bf16 v[108:111], v[140:143], a[112:115], v[108:111]
s_nop 0
ds_read_b64_tr_b16 v[252:253], v11 offset:12288
ds_read_b64_tr_b16 v[254:255], v11 offset:14336
v_mfma_f32_16x16x32_bf16 v[108:111], v[156:159], a[116:119], v[108:111]
s_add_u32 s72, s71, 46080
buffer_load_dwordx4 v15, s[24:27], s72 offen offset:3072 lds
v_mfma_f32_16x16x32_bf16 v[108:111], v[172:175], a[120:123], v[108:111]
v_mfma_f32_16x16x32_bf16 v[108:111], v[188:191], a[124:127], v[108:111]
v_mfma_f32_16x16x32_bf16 v[92:95], v[188:191], a[108:111], v[92:95]
v_mfma_f32_16x16x32_bf16 v[92:95], v[172:175], a[104:107], v[92:95]
v_mfma_f32_16x16x32_bf16 v[92:95], v[156:159], a[100:103], v[92:95]
s_waitcnt vmcnt(22) lgkmcnt(0)
v_mfma_f32_16x16x32_bf16 v[92:95], v[140:143], a[96:99], v[92:95]
s_barrier
v_mfma_f32_16x16x32_bf16 v[16:19], v[192:195], a[128:131], v[16:19]
buffer_load_dwordx4 a[212:215], v1, s[44:47], s69 offen offset:1024 sc1
v_mfma_f32_16x16x32_bf16 v[16:19], v[208:211], a[132:135], v[16:19]
s_xor_b32 s71, s13, 0x40100
ds_read_b64_tr_b16 v[128:129], v8 offset:16384
ds_read_b64_tr_b16 v[130:131], v8 offset:18432
v_mfma_f32_16x16x32_bf16 v[16:19], v[224:227], a[136:139], v[16:19]
s_add_u32 m0, s77, 32768
ds_read_b64_tr_b16 v[132:133], v9 offset:16384
ds_read_b64_tr_b16 v[134:135], v9 offset:18432
v_mfma_f32_16x16x32_bf16 v[16:19], v[240:243], a[140:143], v[16:19]
s_add_u32 s72, s71, 0
buffer_load_dwordx4 v15, s[24:27], s72 offen lds
v_mfma_f32_16x16x32_bf16 v[32:35], v[240:243], a[156:159], v[32:35]
s_nop 0
ds_read_b64_tr_b16 v[136:137], v10 offset:16384
ds_read_b64_tr_b16 v[138:139], v10 offset:18432
v_mfma_f32_16x16x32_bf16 v[32:35], v[224:227], a[152:155], v[32:35]
s_nop 0
ds_read_b64_tr_b16 v[140:141], v11 offset:16384
ds_read_b64_tr_b16 v[142:143], v11 offset:18432
v_mfma_f32_16x16x32_bf16 v[32:35], v[208:211], a[148:151], v[32:35]
v_mfma_f32_16x16x32_bf16 v[32:35], v[192:195], a[144:147], v[32:35]
s_nop 0
ds_read_b64_tr_b16 v[144:145], v8 offset:20480
ds_read_b64_tr_b16 v[146:147], v8 offset:22528
v_mfma_f32_16x16x32_bf16 v[36:39], v[196:199], a[144:147], v[36:39]
s_add_u32 s72, s71, 15360
buffer_load_dwordx4 v15, s[24:27], s72 offen offset:1024 lds
v_mfma_f32_16x16x32_bf16 v[36:39], v[212:215], a[148:151], v[36:39]
s_nop 0
ds_read_b64_tr_b16 v[148:149], v9 offset:20480
ds_read_b64_tr_b16 v[150:151], v9 offset:22528
v_mfma_f32_16x16x32_bf16 v[36:39], v[228:231], a[152:155], v[36:39]
buffer_load_dwordx4 a[216:219], v1, s[44:47], s69 offen offset:2048 sc1
v_mfma_f32_16x16x32_bf16 v[36:39], v[244:247], a[156:159], v[36:39]
s_nop 0
ds_read_b64_tr_b16 v[152:153], v10 offset:20480
ds_read_b64_tr_b16 v[154:155], v10 offset:22528
v_mfma_f32_16x16x32_bf16 v[20:23], v[244:247], a[140:143], v[20:23]
s_nop 0
ds_read_b64_tr_b16 v[156:157], v11 offset:20480
ds_read_b64_tr_b16 v[158:159], v11 offset:22528
v_mfma_f32_16x16x32_bf16 v[20:23], v[228:231], a[136:139], v[20:23]
v_mfma_f32_16x16x32_bf16 v[20:23], v[212:215], a[132:135], v[20:23]
s_add_u32 s72, s71, 30720
buffer_load_dwordx4 v15, s[24:27], s72 offen offset:2048 lds
v_mfma_f32_16x16x32_bf16 v[20:23], v[196:199], a[128:131], v[20:23]
s_nop 0
ds_read_b64_tr_b16 v[160:161], v8 offset:24576
ds_read_b64_tr_b16 v[162:163], v8 offset:26624
v_mfma_f32_16x16x32_bf16 v[24:27], v[200:203], a[128:131], v[24:27]
s_nop 0
ds_read_b64_tr_b16 v[164:165], v9 offset:24576
ds_read_b64_tr_b16 v[166:167], v9 offset:26624
v_mfma_f32_16x16x32_bf16 v[24:27], v[216:219], a[132:135], v[24:27]
s_nop 0
ds_read_b64_tr_b16 v[168:169], v10 offset:24576
ds_read_b64_tr_b16 v[170:171], v10 offset:26624
v_mfma_f32_16x16x32_bf16 v[24:27], v[232:235], a[136:139], v[24:27]
s_nop 0
ds_read_b64_tr_b16 v[172:173], v11 offset:24576
ds_read_b64_tr_b16 v[174:175], v11 offset:26624
v_mfma_f32_16x16x32_bf16 v[24:27], v[248:251], a[140:143], v[24:27]
v_mfma_f32_16x16x32_bf16 v[40:43], v[248:251], a[156:159], v[40:43]
s_add_u32 s72, s71, 46080
buffer_load_dwordx4 v15, s[24:27], s72 offen offset:3072 lds
v_mfma_f32_16x16x32_bf16 v[40:43], v[232:235], a[152:155], v[40:43]
buffer_load_dwordx4 a[220:223], v1, s[44:47], s69 offen offset:3072 sc1
v_mfma_f32_16x16x32_bf16 v[40:43], v[216:219], a[148:151], v[40:43]
s_nop 0
ds_read_b64_tr_b16 v[176:177], v8 offset:28672
ds_read_b64_tr_b16 v[178:179], v8 offset:30720
v_mfma_f32_16x16x32_bf16 v[40:43], v[200:203], a[144:147], v[40:43]
s_lshr_b32 s69, s15, 18
ds_read_b64_tr_b16 v[180:181], v9 offset:28672
ds_read_b64_tr_b16 v[182:183], v9 offset:30720
v_mfma_f32_16x16x32_bf16 v[44:47], v[204:207], a[144:147], v[44:47]
s_lshl_b32 s69, s69, 12
ds_read_b64_tr_b16 v[184:185], v10 offset:28672
ds_read_b64_tr_b16 v[186:187], v10 offset:30720
v_mfma_f32_16x16x32_bf16 v[44:47], v[220:223], a[148:151], v[44:47]
s_add_u32 s69, s69, s95
ds_read_b64_tr_b16 v[188:189], v11 offset:28672
ds_read_b64_tr_b16 v[190:191], v11 offset:30720
v_mfma_f32_16x16x32_bf16 v[44:47], v[236:239], a[152:155], v[44:47]
s_xor_b32 s69, s69, 0x1000
v_mfma_f32_16x16x32_bf16 v[44:47], v[252:255], a[156:159], v[44:47]
s_xor_b32 s71, s14, 0x40100
v_mfma_f32_16x16x32_bf16 v[28:31], v[252:255], a[140:143], v[28:31]
s_add_u32 m0, s77, 49152
v_mfma_f32_16x16x32_bf16 v[28:31], v[236:239], a[136:139], v[28:31]
s_add_u32 s72, s71, 0
v_mfma_f32_16x16x32_bf16 v[28:31], v[220:223], a[132:135], v[28:31]
s_waitcnt lgkmcnt(0)
buffer_load_dwordx4 v15, s[24:27], s72 offen lds
v_mfma_f32_16x16x32_bf16 v[28:31], v[204:207], a[128:131], v[28:31]
buffer_load_dwordx4 a[224:227], v1, s[44:47], s69 offen sc1
v_mfma_f32_16x16x32_bf16 v[48:51], v[128:131], a[128:131], v[48:51]
s_nop 0
ds_read_b64_tr_b16 v[192:193], v8 offset:32768
ds_read_b64_tr_b16 v[194:195], v8 offset:34816
v_mfma_f32_16x16x32_bf16 v[48:51], v[144:147], a[132:135], v[48:51]
s_nop 0
ds_read_b64_tr_b16 v[196:197], v9 offset:32768
ds_read_b64_tr_b16 v[198:199], v9 offset:34816
v_mfma_f32_16x16x32_bf16 v[48:51], v[160:163], a[136:139], v[48:51]
s_nop 0
ds_read_b64_tr_b16 v[200:201], v10 offset:32768
ds_read_b64_tr_b16 v[202:203], v10 offset:34816
v_mfma_f32_16x16x32_bf16 v[48:51], v[176:179], a[140:143], v[48:51]
s_add_u32 s72, s71, 15360
buffer_load_dwordx4 v15, s[24:27], s72 offen offset:1024 lds
v_mfma_f32_16x16x32_bf16 v[64:67], v[176:179], a[156:159], v[64:67]
s_nop 0
ds_read_b64_tr_b16 v[204:205], v11 offset:32768
ds_read_b64_tr_b16 v[206:207], v11 offset:34816
v_mfma_f32_16x16x32_bf16 v[64:67], v[160:163], a[152:155], v[64:67]
v_mfma_f32_16x16x32_bf16 v[64:67], v[144:147], a[148:151], v[64:67]
s_nop 0
ds_read_b64_tr_b16 v[208:209], v8 offset:36864
ds_read_b64_tr_b16 v[210:211], v8 offset:38912
v_mfma_f32_16x16x32_bf16 v[64:67], v[128:131], a[144:147], v[64:67]
s_nop 0
ds_read_b64_tr_b16 v[212:213], v9 offset:36864
ds_read_b64_tr_b16 v[214:215], v9 offset:38912
v_mfma_f32_16x16x32_bf16 v[68:71], v[132:135], a[144:147], v[68:71]
buffer_load_dwordx4 a[228:231], v1, s[44:47], s69 offen offset:1024 sc1
v_mfma_f32_16x16x32_bf16 v[68:71], v[148:151], a[148:151], v[68:71]
s_add_u32 s72, s71, 30720
buffer_load_dwordx4 v15, s[24:27], s72 offen offset:2048 lds
v_mfma_f32_16x16x32_bf16 v[68:71], v[164:167], a[152:155], v[68:71]
s_nop 0
ds_read_b64_tr_b16 v[216:217], v10 offset:36864
ds_read_b64_tr_b16 v[218:219], v10 offset:38912
v_mfma_f32_16x16x32_bf16 v[68:71], v[180:183], a[156:159], v[68:71]
v_mfma_f32_16x16x32_bf16 v[52:55], v[180:183], a[140:143], v[52:55]
s_nop 0
ds_read_b64_tr_b16 v[220:221], v11 offset:36864
ds_read_b64_tr_b16 v[222:223], v11 offset:38912
v_mfma_f32_16x16x32_bf16 v[52:55], v[164:167], a[136:139], v[52:55]
s_nop 0
ds_read_b64_tr_b16 v[224:225], v8 offset:40960
ds_read_b64_tr_b16 v[226:227], v8 offset:43008
v_mfma_f32_16x16x32_bf16 v[52:55], v[148:151], a[132:135], v[52:55]
s_nop 0
ds_read_b64_tr_b16 v[228:229], v9 offset:40960
ds_read_b64_tr_b16 v[230:231], v9 offset:43008
v_mfma_f32_16x16x32_bf16 v[52:55], v[132:135], a[128:131], v[52:55]
s_add_u32 s72, s71, 46080
buffer_load_dwordx4 v15, s[24:27], s72 offen offset:3072 lds
v_mfma_f32_16x16x32_bf16 v[56:59], v[136:139], a[128:131], v[56:59]
v_mfma_f32_16x16x32_bf16 v[56:59], v[152:155], a[132:135], v[56:59]
s_nop 0
ds_read_b64_tr_b16 v[232:233], v10 offset:40960
ds_read_b64_tr_b16 v[234:235], v10 offset:43008
v_mfma_f32_16x16x32_bf16 v[56:59], v[168:171], a[136:139], v[56:59]
buffer_load_dwordx4 a[232:235], v1, s[44:47], s69 offen offset:2048 sc1
v_mfma_f32_16x16x32_bf16 v[56:59], v[184:187], a[140:143], v[56:59]
s_nop 0
ds_read_b64_tr_b16 v[236:237], v11 offset:40960
ds_read_b64_tr_b16 v[238:239], v11 offset:43008
v_mfma_f32_16x16x32_bf16 v[72:75], v[184:187], a[156:159], v[72:75]
s_nop 0
ds_read_b64_tr_b16 v[240:241], v8 offset:45056
ds_read_b64_tr_b16 v[242:243], v8 offset:47104
v_mfma_f32_16x16x32_bf16 v[72:75], v[168:171], a[152:155], v[72:75]
v_mfma_f32_16x16x32_bf16 v[72:75], v[152:155], a[148:151], v[72:75]
s_nop 0
ds_read_b64_tr_b16 v[244:245], v9 offset:45056
ds_read_b64_tr_b16 v[246:247], v9 offset:47104
v_mfma_f32_16x16x32_bf16 v[72:75], v[136:139], a[144:147], v[72:75]
s_xor_b32 s71, s15, 0x40100
ds_read_b64_tr_b16 v[248:249], v10 offset:45056
ds_read_b64_tr_b16 v[250:251], v10 offset:47104
v_mfma_f32_16x16x32_bf16 v[76:79], v[140:143], a[144:147], v[76:79]
s_add_u32 m0, s85, 0
ds_read_b64_tr_b16 v[252:253], v11 offset:45056
ds_read_b64_tr_b16 v[254:255], v11 offset:47104
v_mfma_f32_16x16x32_bf16 v[76:79], v[156:159], a[148:151], v[76:79]
s_add_u32 s72, s71, 0
buffer_load_dwordx4 v15, s[24:27], s72 offen lds
v_mfma_f32_16x16x32_bf16 v[76:79], v[172:175], a[152:155], v[76:79]
v_mfma_f32_16x16x32_bf16 v[76:79], v[188:191], a[156:159], v[76:79]
v_mfma_f32_16x16x32_bf16 v[60:63], v[188:191], a[140:143], v[60:63]
buffer_load_dwordx4 a[236:239], v1, s[44:47], s69 offen offset:3072 sc1
v_mfma_f32_16x16x32_bf16 v[60:63], v[172:175], a[136:139], v[60:63]
s_add_u32 s72, s71, 15360
v_mfma_f32_16x16x32_bf16 v[60:63], v[156:159], a[132:135], v[60:63]
s_waitcnt vmcnt(24) lgkmcnt(0)
v_mfma_f32_16x16x32_bf16 v[60:63], v[140:143], a[128:131], v[60:63]
s_barrier
buffer_load_dwordx4 v15, s[24:27], s72 offen offset:1024 lds
v_mfma_f32_16x16x32_bf16 v[80:83], v[192:195], a[128:131], v[80:83]
s_nop 0
ds_read_b64_tr_b16 v[128:129], v8 offset:49152
ds_read_b64_tr_b16 v[130:131], v8 offset:51200
v_mfma_f32_16x16x32_bf16 v[80:83], v[208:211], a[132:135], v[80:83]
s_nop 0
ds_read_b64_tr_b16 v[132:133], v9 offset:49152
ds_read_b64_tr_b16 v[134:135], v9 offset:51200
v_mfma_f32_16x16x32_bf16 v[80:83], v[224:227], a[136:139], v[80:83]
s_nop 0
ds_read_b64_tr_b16 v[136:137], v10 offset:49152
ds_read_b64_tr_b16 v[138:139], v10 offset:51200
s_waitcnt vmcnt(22)
v_cmp_gt_u32 vcc, 3, v114
s_cbranch_vccnz Lspin109
Lback110:
v_mfma_f32_16x16x32_bf16 v[80:83], v[240:243], a[140:143], v[80:83]
s_lshl_b32 s73, s76, 18
ds_read_b64_tr_b16 v[140:141], v11 offset:49152
ds_read_b64_tr_b16 v[142:143], v11 offset:51200
v_mfma_f32_16x16x32_bf16 v[96:99], v[240:243], a[156:159], v[96:99]
s_lshl_b32 s84, s58, 16
v_mfma_f32_16x16x32_bf16 v[96:99], v[224:227], a[152:155], v[96:99]
s_add_u32 s72, s71, 30720
buffer_load_dwordx4 v15, s[24:27], s72 offen offset:2048 lds
v_mfma_f32_16x16x32_bf16 v[96:99], v[208:211], a[148:151], v[96:99]
s_add_u32 s69, s69, 0x20000
buffer_load_dwordx4 a[240:243], v1, s[44:47], s69 offen sc1
v_mfma_f32_16x16x32_bf16 v[96:99], v[192:195], a[144:147], v[96:99]
s_add_u32 s73, s73, s84
ds_read_b64_tr_b16 v[144:145], v8 offset:53248
ds_read_b64_tr_b16 v[146:147], v8 offset:55296
v_mfma_f32_16x16x32_bf16 v[100:103], v[196:199], a[144:147], v[100:103]
s_lshl_b32 s84, s75, 8
ds_read_b64_tr_b16 v[148:149], v9 offset:53248
ds_read_b64_tr_b16 v[150:151], v9 offset:55296
v_mfma_f32_16x16x32_bf16 v[100:103], v[212:215], a[148:151], v[100:103]
s_add_u32 s73, s73, s84
ds_read_b64_tr_b16 v[152:153], v10 offset:53248
ds_read_b64_tr_b16 v[154:155], v10 offset:55296
v_mfma_f32_16x16x32_bf16 v[100:103], v[228:231], a[152:155], v[100:103]
s_add_u32 s73, s73, 0x3400000
v_lshrrev_b32 v112, 4, v0
v_and_b32 v113, 15, v0
v_mfma_f32_16x16x32_bf16 v[100:103], v[244:247], a[156:159], v[100:103]
s_add_u32 s72, s71, 46080
buffer_load_dwordx4 v15, s[24:27], s72 offen offset:3072 lds
v_mfma_f32_16x16x32_bf16 v[84:87], v[244:247], a[140:143], v[84:87]
s_nop 0
ds_read_b64_tr_b16 v[156:157], v11 offset:53248
ds_read_b64_tr_b16 v[158:159], v11 offset:55296
v_mfma_f32_16x16x32_bf16 v[84:87], v[228:231], a[136:139], v[84:87]
s_nop 0
ds_read_b64_tr_b16 v[160:161], v8 offset:57344
ds_read_b64_tr_b16 v[162:163], v8 offset:59392
v_mfma_f32_16x16x32_bf16 v[84:87], v[212:215], a[132:135], v[84:87]
s_nop 0
ds_read_b64_tr_b16 v[164:165], v9 offset:57344
ds_read_b64_tr_b16 v[166:167], v9 offset:59392
v_mfma_f32_16x16x32_bf16 v[84:87], v[196:199], a[128:131], v[84:87]
v_xor_b32 v12, v113, v112
v_lshlrev_b32 v12, 4, v12
v_mfma_f32_16x16x32_bf16 v[88:91], v[200:203], a[128:131], v[88:91]
buffer_load_dwordx4 a[244:247], v1, s[44:47], s69 offen offset:1024 sc1
v_mfma_f32_16x16x32_bf16 v[88:91], v[216:219], a[132:135], v[88:91]
s_nop 0
ds_read_b64_tr_b16 v[168:169], v10 offset:57344
ds_read_b64_tr_b16 v[170:171], v10 offset:59392
v_mfma_f32_16x16x32_bf16 v[88:91], v[232:235], a[136:139], v[88:91]
s_nop 0
ds_read_b64_tr_b16 v[172:173], v11 offset:57344
ds_read_b64_tr_b16 v[174:175], v11 offset:59392
v_mfma_f32_16x16x32_bf16 v[88:91], v[248:251], a[140:143], v[88:91]
s_xor_b32 s71, s13, 0x40180
ds_read_b64_tr_b16 v[176:177], v8 offset:61440
ds_read_b64_tr_b16 v[178:179], v8 offset:63488
v_mfma_f32_16x16x32_bf16 v[104:107], v[248:251], a[156:159], v[104:107]
s_add_u32 m0, s85, 16384
v_lshl_add_u32 v112, v112, 12, v12
v_xor_b32 v12, 64, v112
v_mfma_f32_16x16x32_bf16 v[104:107], v[232:235], a[152:155], v[104:107]
s_add_u32 s72, s71, 0
buffer_load_dwordx4 v15, s[24:27], s72 offen lds
v_mfma_f32_16x16x32_bf16 v[104:107], v[216:219], a[148:151], v[104:107]
s_nop 0
ds_read_b64_tr_b16 v[180:181], v9 offset:61440
ds_read_b64_tr_b16 v[182:183], v9 offset:63488
v_mfma_f32_16x16x32_bf16 v[104:107], v[200:203], a[144:147], v[104:107]
s_nop 0
ds_read_b64_tr_b16 v[184:185], v10 offset:61440
ds_read_b64_tr_b16 v[186:187], v10 offset:63488
v_mfma_f32_16x16x32_bf16 v[108:111], v[204:207], a[144:147], v[108:111]
s_nop 0
ds_read_b64_tr_b16 v[188:189], v11 offset:61440
ds_read_b64_tr_b16 v[190:191], v11 offset:63488
v_mfma_f32_16x16x32_bf16 v[108:111], v[220:223], a[148:151], v[108:111]
v_lshlrev_b32 v113, 2, v113
v_mfma_f32_16x16x32_bf16 v[108:111], v[236:239], a[152:155], v[108:111]
s_add_u32 s72, s71, 15360
buffer_load_dwordx4 v15, s[24:27], s72 offen offset:1024 lds
v_mfma_f32_16x16x32_bf16 v[108:111], v[252:255], a[156:159], v[108:111]
buffer_load_dwordx4 a[248:251], v1, s[44:47], s69 offen offset:2048 sc1
v_mfma_f32_16x16x32_bf16 v[92:95], v[252:255], a[140:143], v[92:95]
v_xor_b32 v8, 0x10000, v8
v_mfma_f32_16x16x32_bf16 v[92:95], v[236:239], a[136:139], v[92:95]
v_xor_b32 v9, 0x10000, v9
v_mfma_f32_16x16x32_bf16 v[92:95], v[220:223], a[132:135], v[92:95]
s_waitcnt vmcnt(38) lgkmcnt(0)
v_xor_b32 v10, 0x10000, v10
v_mfma_f32_16x16x32_bf16 v[92:95], v[204:207], a[128:131], v[92:95]
v_xor_b32 v11, 0x10000, v11
v_mfma_f32_16x16x32_bf16 v[16:19], v[128:131], a[160:163], v[16:19]
s_add_u32 s72, s71, 30720
buffer_load_dwordx4 v15, s[24:27], s72 offen offset:2048 lds
v_mfma_f32_16x16x32_bf16 v[16:19], v[144:147], a[164:167], v[16:19]
s_nop 0
ds_read_b64_tr_b16 v[192:193], v8 offset:0
ds_read_b64_tr_b16 v[194:195], v8 offset:2048
v_mfma_f32_16x16x32_bf16 v[16:19], v[160:163], a[168:171], v[16:19]
s_nop 0
ds_read_b64_tr_b16 v[196:197], v9 offset:0
ds_read_b64_tr_b16 v[198:199], v9 offset:2048
v_mfma_f32_16x16x32_bf16 v[16:19], v[176:179], a[172:175], v[16:19]
s_nop 0
ds_read_b64_tr_b16 v[200:201], v10 offset:0
ds_read_b64_tr_b16 v[202:203], v10 offset:2048
v_mfma_f32_16x16x32_bf16 v[32:35], v[176:179], a[188:191], v[32:35]
buffer_load_dwordx4 a[252:255], v1, s[44:47], s69 offen offset:3072 sc1
v_mfma_f32_16x16x32_bf16 v[32:35], v[160:163], a[184:187], v[32:35]
v_mfma_f32_16x16x32_bf16 v[32:35], v[144:147], a[180:183], v[32:35]
s_add_u32 s72, s71, 46080
buffer_load_dwordx4 v15, s[24:27], s72 offen offset:3072 lds
v_mfma_f32_16x16x32_bf16 v[32:35], v[128:131], a[176:179], v[32:35]
s_nop 0
ds_read_b64_tr_b16 v[204:205], v11 offset:0
ds_read_b64_tr_b16 v[206:207], v11 offset:2048
v_mfma_f32_16x16x32_bf16 v[36:39], v[132:135], a[176:179], v[36:39]
s_nop 0
ds_read_b64_tr_b16 v[208:209], v8 offset:4096
ds_read_b64_tr_b16 v[210:211], v8 offset:6144
v_mfma_f32_16x16x32_bf16 v[36:39], v[148:151], a[180:183], v[36:39]
s_nop 0
ds_read_b64_tr_b16 v[212:213], v9 offset:4096
ds_read_b64_tr_b16 v[214:215], v9 offset:6144
v_mfma_f32_16x16x32_bf16 v[36:39], v[164:167], a[184:187], v[36:39]
v_mfma_f32_16x16x32_bf16 v[36:39], v[180:183], a[188:191], v[36:39]
s_nop 0
ds_read_b64_tr_b16 v[216:217], v10 offset:4096
ds_read_b64_tr_b16 v[218:219], v10 offset:6144
v_mfma_f32_16x16x32_bf16 v[20:23], v[180:183], a[172:175], v[20:23]
s_nop 0
ds_read_b64_tr_b16 v[220:221], v11 offset:4096
ds_read_b64_tr_b16 v[222:223], v11 offset:6144
v_mfma_f32_16x16x32_bf16 v[20:23], v[164:167], a[168:171], v[20:23]
v_mfma_f32_16x16x32_bf16 v[20:23], v[148:151], a[164:167], v[20:23]
s_xor_b32 s71, s14, 0x40180
ds_read_b64_tr_b16 v[224:225], v8 offset:8192
ds_read_b64_tr_b16 v[226:227], v8 offset:10240
v_mfma_f32_16x16x32_bf16 v[20:23], v[132:135], a[160:163], v[20:23]
s_add_u32 m0, s85, 32768
ds_read_b64_tr_b16 v[228:229], v9 offset:8192
ds_read_b64_tr_b16 v[230:231], v9 offset:10240
v_mfma_f32_16x16x32_bf16 v[24:27], v[136:139], a[160:163], v[24:27]
s_add_u32 s72, s71, 0
buffer_load_dwordx4 v15, s[24:27], s72 offen lds
v_mfma_f32_16x16x32_bf16 v[24:27], v[152:155], a[164:167], v[24:27]
s_nop 0
ds_read_b64_tr_b16 v[232:233], v10 offset:8192
ds_read_b64_tr_b16 v[234:235], v10 offset:10240
v_mfma_f32_16x16x32_bf16 v[24:27], v[168:171], a[168:171], v[24:27]
v_mfma_f32_16x16x32_bf16 v[24:27], v[184:187], a[172:175], v[24:27]
s_nop 0
ds_read_b64_tr_b16 v[236:237], v11 offset:8192
ds_read_b64_tr_b16 v[238:239], v11 offset:10240
v_mfma_f32_16x16x32_bf16 v[40:43], v[184:187], a[188:191], v[40:43]
s_nop 0
ds_read_b64_tr_b16 v[240:241], v8 offset:12288
ds_read_b64_tr_b16 v[242:243], v8 offset:14336
v_mfma_f32_16x16x32_bf16 v[40:43], v[168:171], a[184:187], v[40:43]
s_nop 0
ds_read_b64_tr_b16 v[244:245], v9 offset:12288
ds_read_b64_tr_b16 v[246:247], v9 offset:14336
v_mfma_f32_16x16x32_bf16 v[40:43], v[152:155], a[180:183], v[40:43]
s_add_u32 s72, s71, 15360
buffer_load_dwordx4 v15, s[24:27], s72 offen offset:1024 lds
v_mfma_f32_16x16x32_bf16 v[40:43], v[136:139], a[176:179], v[40:43]
v_mfma_f32_16x16x32_bf16 v[44:47], v[140:143], a[176:179], v[44:47]
s_nop 0
ds_read_b64_tr_b16 v[248:249], v10 offset:12288
ds_read_b64_tr_b16 v[250:251], v10 offset:14336
v_mfma_f32_16x16x32_bf16 v[44:47], v[156:159], a[180:183], v[44:47]
s_nop 0
ds_read_b64_tr_b16 v[252:253], v11 offset:12288
ds_read_b64_tr_b16 v[254:255], v11 offset:14336
v_mfma_f32_16x16x32_bf16 v[44:47], v[172:175], a[184:187], v[44:47]
v_mfma_f32_16x16x32_bf16 v[44:47], v[188:191], a[188:191], v[44:47]
v_mfma_f32_16x16x32_bf16 v[28:31], v[188:191], a[172:175], v[28:31]
s_add_u32 s72, s71, 30720
buffer_load_dwordx4 v15, s[24:27], s72 offen offset:2048 lds
v_mfma_f32_16x16x32_bf16 v[28:31], v[172:175], a[168:171], v[28:31]
v_mfma_f32_16x16x32_bf16 v[28:31], v[156:159], a[164:167], v[28:31]
s_waitcnt vmcnt(23) lgkmcnt(0)
v_mfma_f32_16x16x32_bf16 v[28:31], v[140:143], a[160:163], v[28:31]
s_barrier
v_mfma_f32_16x16x32_bf16 v[16:19], v[192:195], a[192:195], v[16:19]
s_nop 0
ds_read_b64_tr_b16 v[128:129], v8 offset:16384
ds_read_b64_tr_b16 v[130:131], v8 offset:18432
v_mfma_f32_16x16x32_bf16 v[16:19], v[208:211], a[196:199], v[16:19]
s_nop 0
ds_read_b64_tr_b16 v[132:133], v9 offset:16384
ds_read_b64_tr_b16 v[134:135], v9 offset:18432
v_mfma_f32_16x16x32_bf16 v[16:19], v[224:227], a[200:203], v[16:19]
s_add_u32 s72, s71, 46080
buffer_load_dwordx4 v15, s[24:27], s72 offen offset:3072 lds
v_mfma_f32_16x16x32_bf16 v[16:19], v[240:243], a[204:207], v[16:19]
s_nop 0
ds_read_b64_tr_b16 v[136:137], v10 offset:16384
ds_read_b64_tr_b16 v[138:139], v10 offset:18432
v_mfma_f32_16x16x32_bf16 v[32:35], v[240:243], a[220:223], v[32:35]
s_nop 0
ds_read_b64_tr_b16 v[140:141], v11 offset:16384
ds_read_b64_tr_b16 v[142:143], v11 offset:18432
v_mfma_f32_16x16x32_bf16 v[32:35], v[224:227], a[216:219], v[32:35]
v_mfma_f32_16x16x32_bf16 v[32:35], v[208:211], a[212:215], v[32:35]
s_nop 0
ds_read_b64_tr_b16 v[144:145], v8 offset:20480
ds_read_b64_tr_b16 v[146:147], v8 offset:22528
v_mfma_f32_16x16x32_bf16 v[32:35], v[192:195], a[208:211], v[32:35]
s_nop 0
ds_read_b64_tr_b16 v[148:149], v9 offset:20480
ds_read_b64_tr_b16 v[150:151], v9 offset:22528
v_mfma_f32_16x16x32_bf16 v[36:39], v[196:199], a[208:211], v[36:39]
s_nop 0
ds_read_b64_tr_b16 v[152:153], v10 offset:20480
ds_read_b64_tr_b16 v[154:155], v10 offset:22528
v_mfma_f32_16x16x32_bf16 v[36:39], v[212:215], a[212:215], v[36:39]
s_nop 0
ds_read_b64_tr_b16 v[156:157], v11 offset:20480
ds_read_b64_tr_b16 v[158:159], v11 offset:22528
v_mfma_f32_16x16x32_bf16 v[36:39], v[228:231], a[216:219], v[36:39]
v_mfma_f32_16x16x32_bf16 v[36:39], v[244:247], a[220:223], v[36:39]
s_add_u32 m0, s64, 147456
ds_read_b64_tr_b16 v[160:161], v8 offset:24576
ds_read_b64_tr_b16 v[162:163], v8 offset:26624
v_mfma_f32_16x16x32_bf16 v[20:23], v[244:247], a[204:207], v[20:23]
s_add_u32 s72, s73, 0
buffer_load_dwordx4 v112, s[44:47], s72 offen sc1 lds
v_mfma_f32_16x16x32_bf16 v[20:23], v[228:231], a[200:203], v[20:23]
s_nop 0
ds_read_b64_tr_b16 v[164:165], v9 offset:24576
ds_read_b64_tr_b16 v[166:167], v9 offset:26624
v_mfma_f32_16x16x32_bf16 v[20:23], v[212:215], a[196:199], v[20:23]
s_add_u32 s72, s73, 15360
buffer_load_dwordx4 v12, s[44:47], s72 offen offset:1024 sc1 lds
v_mfma_f32_16x16x32_bf16 v[20:23], v[196:199], a[192:195], v[20:23]
s_nop 0
ds_read_b64_tr_b16 v[168:169], v10 offset:24576
ds_read_b64_tr_b16 v[170:171], v10 offset:26624
v_mfma_f32_16x16x32_bf16 v[24:27], v[200:203], a[192:195], v[24:27]
s_nop 0
ds_read_b64_tr_b16 v[172:173], v11 offset:24576
ds_read_b64_tr_b16 v[174:175], v11 offset:26624
v_mfma_f32_16x16x32_bf16 v[24:27], v[216:219], a[196:199], v[24:27]
s_add_u32 s72, s73, 30720
buffer_load_dwordx4 v112, s[44:47], s72 offen offset:2048 sc1 lds
v_mfma_f32_16x16x32_bf16 v[24:27], v[232:235], a[200:203], v[24:27]
v_mfma_f32_16x16x32_bf16 v[24:27], v[248:251], a[204:207], v[24:27]
s_nop 0
ds_read_b64_tr_b16 v[176:177], v8 offset:28672
ds_read_b64_tr_b16 v[178:179], v8 offset:30720
v_mfma_f32_16x16x32_bf16 v[40:43], v[248:251], a[220:223], v[40:43]
s_add_u32 s72, s73, 46080
buffer_load_dwordx4 v12, s[44:47], s72 offen offset:3072 sc1 lds
v_mfma_f32_16x16x32_bf16 v[40:43], v[232:235], a[216:219], v[40:43]
s_xor_b32 s71, s15, 0x40180
ds_read_b64_tr_b16 v[180:181], v9 offset:28672
ds_read_b64_tr_b16 v[182:183], v9 offset:30720
v_mfma_f32_16x16x32_bf16 v[40:43], v[216:219], a[212:215], v[40:43]
s_add_u32 m0, s85, 49152
ds_read_b64_tr_b16 v[184:185], v10 offset:28672
ds_read_b64_tr_b16 v[186:187], v10 offset:30720
v_mfma_f32_16x16x32_bf16 v[40:43], v[200:203], a[208:211], v[40:43]
s_add_u32 s72, s71, 0
buffer_load_dwordx4 v15, s[24:27], s72 offen lds
v_mfma_f32_16x16x32_bf16 v[44:47], v[204:207], a[208:211], v[44:47]
s_nop 0
ds_read_b64_tr_b16 v[188:189], v11 offset:28672
ds_read_b64_tr_b16 v[190:191], v11 offset:30720
v_mfma_f32_16x16x32_bf16 v[44:47], v[220:223], a[212:215], v[44:47]
v_mfma_f32_16x16x32_bf16 v[44:47], v[236:239], a[216:219], v[44:47]
s_add_u32 s72, s71, 15360
buffer_load_dwordx4 v15, s[24:27], s72 offen offset:1024 lds
v_mfma_f32_16x16x32_bf16 v[44:47], v[252:255], a[220:223], v[44:47]
v_mfma_f32_16x16x32_bf16 v[28:31], v[252:255], a[204:207], v[28:31]
v_mfma_f32_16x16x32_bf16 v[28:31], v[236:239], a[200:203], v[28:31]
s_add_u32 s72, s71, 30720
buffer_load_dwordx4 v15, s[24:27], s72 offen offset:2048 lds
v_mfma_f32_16x16x32_bf16 v[28:31], v[220:223], a[196:199], v[28:31]
s_waitcnt vmcnt(12) lgkmcnt(0)
v_mfma_f32_16x16x32_bf16 v[28:31], v[204:207], a[192:195], v[28:31]
Lstube3:
s_cbranch_execz Lrete
v_mfma_f32_16x16x32_bf16 v[16:19], v[128:131], a[224:227], v[16:19]
s_add_u32 s72, s71, 46080
buffer_load_dwordx4 v15, s[24:27], s72 offen offset:3072 lds
v_mfma_f32_16x16x32_bf16 v[16:19], v[144:147], a[228:231], v[16:19]
s_lshl_b32 s73, s75, 9
ds_read_b64_tr_b16 v[192:193], v8 offset:32768
ds_read_b64_tr_b16 v[194:195], v8 offset:34816
v_mfma_f32_16x16x32_bf16 v[16:19], v[160:163], a[232:235], v[16:19]
s_lshl_b32 s84, s58, 7
ds_read_b64_tr_b16 v[196:197], v9 offset:32768
ds_read_b64_tr_b16 v[198:199], v9 offset:34816
v_mfma_f32_16x16x32_bf16 v[16:19], v[176:179], a[236:239], v[16:19]
s_add_u32 s73, s73, s84
ds_read_b64_tr_b16 v[200:201], v10 offset:32768
ds_read_b64_tr_b16 v[202:203], v10 offset:34816
v_mfma_f32_16x16x32_bf16 v[20:23], v[180:183], a[236:239], v[20:23]
s_add_u32 s73, s73, 0x3800000
ds_read_b64_tr_b16 v[204:205], v11 offset:32768
ds_read_b64_tr_b16 v[206:207], v11 offset:34816
v_mfma_f32_16x16x32_bf16 v[20:23], v[164:167], a[232:235], v[20:23]
s_xor_b32 s71, s12, 0x0
buffer_load_dword v6, v113, s[44:47], s73 offen sc1
v_mfma_f32_16x16x32_bf16 v[20:23], v[148:151], a[228:231], v[20:23]
s_add_u32 m0, s77, 0
ds_read_b64_tr_b16 v[208:209], v8 offset:36864
ds_read_b64_tr_b16 v[210:211], v8 offset:38912
v_mfma_f32_16x16x32_bf16 v[20:23], v[132:135], a[224:227], v[20:23]
s_add_u32 s72, s71, 0
buffer_load_dwordx4 v15, s[24:27], s72 offen lds
v_mfma_f32_16x16x32_bf16 v[24:27], v[136:139], a[224:227], v[24:27]
s_nop 0
ds_read_b64_tr_b16 v[212:213], v9 offset:36864
ds_read_b64_tr_b16 v[214:215], v9 offset:38912
v_mfma_f32_16x16x32_bf16 v[24:27], v[152:155], a[228:231], v[24:27]
s_nop 0
ds_read_b64_tr_b16 v[216:217], v10 offset:36864
ds_read_b64_tr_b16 v[218:219], v10 offset:38912
v_mfma_f32_16x16x32_bf16 v[24:27], v[168:171], a[232:235], v[24:27]
buffer_load_dword v7, v113, s[44:47], s73 offen offset:64 sc1
v_mfma_f32_16x16x32_bf16 v[24:27], v[184:187], a[236:239], v[24:27]
s_nop 0
ds_read_b64_tr_b16 v[220:221], v11 offset:36864
ds_read_b64_tr_b16 v[222:223], v11 offset:38912
v_cvt_pk_bf16_f32 v16, v16, v17
v_mfma_f32_16x16x32_bf16 v[28:31], v[188:191], a[236:239], v[28:31]
s_nop 0
ds_read_b64_tr_b16 v[224:225], v8 offset:40960
ds_read_b64_tr_b16 v[226:227], v8 offset:43008
v_cvt_pk_bf16_f32 v17, v18, v19
v_mfma_f32_16x16x32_bf16 v[28:31], v[172:175], a[232:235], v[28:31]
s_add_u32 s72, s71, 15360
buffer_load_dwordx4 v15, s[24:27], s72 offen offset:1024 lds
v_cvt_pk_bf16_f32 v18, v20, v21
v_mfma_f32_16x16x32_bf16 v[28:31], v[156:159], a[228:231], v[28:31]
s_nop 0
ds_read_b64_tr_b16 v[228:229], v9 offset:40960
ds_read_b64_tr_b16 v[230:231], v9 offset:43008
v_cvt_pk_bf16_f32 v19, v22, v23
v_mfma_f32_16x16x32_bf16 v[28:31], v[140:143], a[224:227], v[28:31]
v_mfma_f32_16x16x32_bf16 v[32:35], v[128:131], a[240:243], v[32:35]
s_xor_b32 s80, s93, 0x100000
ds_read_b64_tr_b16 v[232:233], v10 offset:40960
ds_read_b64_tr_b16 v[234:235], v10 offset:43008
v_mfma_f32_16x16x32_bf16 v[32:35], v[144:147], a[244:247], v[32:35]
s_add_u32 s80, s80, 0x3a00000
buffer_store_dwordx4 v[16:19], v1, s[44:47], s80 offen sc1
v_mfma_f32_16x16x32_bf16 v[32:35], v[160:163], a[248:251], v[32:35]
s_nop 0
ds_read_b64_tr_b16 v[236:237], v11 offset:40960
ds_read_b64_tr_b16 v[238:239], v11 offset:43008
v_mfma_f32_16x16x32_bf16 v[32:35], v[176:179], a[252:255], v[32:35]
s_add_u32 s72, s71, 30720
buffer_load_dwordx4 v15, s[24:27], s72 offen offset:2048 lds
v_cvt_pk_bf16_f32 v20, v24, v25
v_mfma_f32_16x16x32_bf16 v[36:39], v[180:183], a[252:255], v[36:39]
s_nop 0
ds_read_b64_tr_b16 v[240:241], v8 offset:45056
ds_read_b64_tr_b16 v[242:243], v8 offset:47104
v_cvt_pk_bf16_f32 v21, v26, v27
v_mfma_f32_16x16x32_bf16 v[36:39], v[164:167], a[248:251], v[36:39]
v_cvt_pk_bf16_f32 v22, v28, v29
v_cvt_pk_bf16_f32 v23, v30, v31
v_mfma_f32_16x16x32_bf16 v[36:39], v[148:151], a[244:247], v[36:39]
s_nop 0
ds_read_b64_tr_b16 v[244:245], v9 offset:45056
ds_read_b64_tr_b16 v[246:247], v9 offset:47104
v_mfma_f32_16x16x32_bf16 v[36:39], v[132:135], a[240:243], v[36:39]
s_nop 0
ds_read_b64_tr_b16 v[248:249], v10 offset:45056
ds_read_b64_tr_b16 v[250:251], v10 offset:47104
v_mfma_f32_16x16x32_bf16 v[40:43], v[136:139], a[240:243], v[40:43]
s_nop 0
ds_read_b64_tr_b16 v[252:253], v11 offset:45056
ds_read_b64_tr_b16 v[254:255], v11 offset:47104
v_mfma_f32_16x16x32_bf16 v[40:43], v[152:155], a[244:247], v[40:43]
s_add_u32 s72, s71, 46080
buffer_load_dwordx4 v15, s[24:27], s72 offen offset:3072 lds
v_mfma_f32_16x16x32_bf16 v[40:43], v[168:171], a[248:251], v[40:43]
v_mfma_f32_16x16x32_bf16 v[40:43], v[184:187], a[252:255], v[40:43]
v_cvt_pk_bf16_f32 v24, v32, v33
v_cvt_pk_bf16_f32 v25, v34, v35
v_cvt_pk_bf16_f32 v26, v36, v37
v_mfma_f32_16x16x32_bf16 v[44:47], v[188:191], a[252:255], v[44:47]
v_cvt_pk_bf16_f32 v27, v38, v39
v_mfma_f32_16x16x32_bf16 v[44:47], v[172:175], a[248:251], v[44:47]
v_mfma_f32_16x16x32_bf16 v[44:47], v[156:159], a[244:247], v[44:47]
s_waitcnt vmcnt(26) lgkmcnt(0)
v_mfma_f32_16x16x32_bf16 v[44:47], v[140:143], a[240:243], v[44:47]
s_barrier
v_mfma_f32_16x16x32_bf16 v[48:51], v[192:195], a[160:163], v[48:51]
s_nop 0
ds_read_b64_tr_b16 v[128:129], v8 offset:49152
ds_read_b64_tr_b16 v[130:131], v8 offset:51200
v_mfma_f32_16x16x32_bf16 v[48:51], v[208:211], a[164:167], v[48:51]
s_xor_b32 s71, s13, 0x0
buffer_store_dwordx4 v[20:23], v1, s[44:47], s80 offen offset:1024 sc1
v_mfma_f32_16x16x32_bf16 v[48:51], v[224:227], a[168:171], v[48:51]
s_add_u32 m0, s77, 16384
ds_read_b64_tr_b16 v[132:133], v9 offset:49152
ds_read_b64_tr_b16 v[134:135], v9 offset:51200
v_mfma_f32_16x16x32_bf16 v[48:51], v[240:243], a[172:175], v[48:51]
s_add_u32 s72, s71, 0
buffer_load_dwordx4 v15, s[24:27], s72 offen lds
v_cvt_pk_bf16_f32 v28, v40, v41
v_mfma_f32_16x16x32_bf16 v[64:67], v[240:243], a[188:191], v[64:67]
s_nop 0
ds_read_b64_tr_b16 v[136:137], v10 offset:49152
ds_read_b64_tr_b16 v[138:139], v10 offset:51200
v_cvt_pk_bf16_f32 v29, v42, v43
v_mfma_f32_16x16x32_bf16 v[64:67], v[224:227], a[184:187], v[64:67]
s_nop 0
ds_read_b64_tr_b16 v[140:141], v11 offset:49152
ds_read_b64_tr_b16 v[142:143], v11 offset:51200
v_cvt_pk_bf16_f32 v30, v44, v45
v_mfma_f32_16x16x32_bf16 v[64:67], v[208:211], a[180:183], v[64:67]
v_cvt_pk_bf16_f32 v31, v46, v47
v_mfma_f32_16x16x32_bf16 v[64:67], v[192:195], a[176:179], v[64:67]
s_nop 0
ds_read_b64_tr_b16 v[144:145], v8 offset:53248
ds_read_b64_tr_b16 v[146:147], v8 offset:55296
v_mfma_f32_16x16x32_bf16 v[68:71], v[196:199], a[176:179], v[68:71]
s_add_u32 s72, s71, 15360
buffer_load_dwordx4 v15, s[24:27], s72 offen offset:1024 lds
v_mfma_f32_16x16x32_bf16 v[68:71], v[212:215], a[180:183], v[68:71]
s_nop 0
ds_read_b64_tr_b16 v[148:149], v9 offset:53248
ds_read_b64_tr_b16 v[150:151], v9 offset:55296
v_mfma_f32_16x16x32_bf16 v[68:71], v[228:231], a[184:187], v[68:71]
s_nop 0
ds_read_b64_tr_b16 v[152:153], v10 offset:53248
ds_read_b64_tr_b16 v[154:155], v10 offset:55296
v_mfma_f32_16x16x32_bf16 v[68:71], v[244:247], a[188:191], v[68:71]
v_mfma_f32_16x16x32_bf16 v[52:55], v[244:247], a[172:175], v[52:55]
s_nop 0
ds_read_b64_tr_b16 v[156:157], v11 offset:53248
ds_read_b64_tr_b16 v[158:159], v11 offset:55296
v_mfma_f32_16x16x32_bf16 v[52:55], v[228:231], a[168:171], v[52:55]
s_nop 0
ds_read_b64_tr_b16 v[160:161], v8 offset:57344
ds_read_b64_tr_b16 v[162:163], v8 offset:59392
v_mfma_f32_16x16x32_bf16 v[52:55], v[212:215], a[164:167], v[52:55]
s_add_u32 s72, s71, 30720
buffer_load_dwordx4 v15, s[24:27], s72 offen offset:2048 lds
v_mfma_f32_16x16x32_bf16 v[52:55], v[196:199], a[160:163], v[52:55]
s_nop 0
ds_read_b64_tr_b16 v[164:165], v9 offset:57344
ds_read_b64_tr_b16 v[166:167], v9 offset:59392
v_mfma_f32_16x16x32_bf16 v[56:59], v[200:203], a[160:163], v[56:59]
v_mfma_f32_16x16x32_bf16 v[56:59], v[216:219], a[164:167], v[56:59]
buffer_store_dwordx4 v[24:27], v1, s[44:47], s80 offen offset:2048 sc1
v_mfma_f32_16x16x32_bf16 v[56:59], v[232:235], a[168:171], v[56:59]
s_nop 0
ds_read_b64_tr_b16 v[168:169], v10 offset:57344
ds_read_b64_tr_b16 v[170:171], v10 offset:59392
v_mfma_f32_16x16x32_bf16 v[56:59], v[248:251], a[172:175], v[56:59]
s_nop 0
ds_read_b64_tr_b16 v[172:173], v11 offset:57344
ds_read_b64_tr_b16 v[174:175], v11 offset:59392
v_mfma_f32_16x16x32_bf16 v[72:75], v[248:251], a[188:191], v[72:75]
s_add_u32 s72, s71, 46080
buffer_load_dwordx4 v15, s[24:27], s72 offen offset:3072 lds
v_mfma_f32_16x16x32_bf16 v[72:75], v[232:235], a[184:187], v[72:75]
s_nop 0
ds_read_b64_tr_b16 v[176:177], v8 offset:61440
ds_read_b64_tr_b16 v[178:179], v8 offset:63488
v_mfma_f32_16x16x32_bf16 v[72:75], v[216:219], a[180:183], v[72:75]
v_mfma_f32_16x16x32_bf16 v[72:75], v[200:203], a[176:179], v[72:75]
s_nop 0
ds_read_b64_tr_b16 v[180:181], v9 offset:61440
ds_read_b64_tr_b16 v[182:183], v9 offset:63488
v_mfma_f32_16x16x32_bf16 v[76:79], v[204:207], a[176:179], v[76:79]
s_nop 0
ds_read_b64_tr_b16 v[184:185], v10 offset:61440
ds_read_b64_tr_b16 v[186:187], v10 offset:63488
v_mfma_f32_16x16x32_bf16 v[76:79], v[220:223], a[180:183], v[76:79]
s_nop 0
ds_read_b64_tr_b16 v[188:189], v11 offset:61440
ds_read_b64_tr_b16 v[190:191], v11 offset:63488
v_mfma_f32_16x16x32_bf16 v[76:79], v[236:239], a[184:187], v[76:79]
v_mfma_f32_16x16x32_bf16 v[76:79], v[252:255], a[188:191], v[76:79]
s_xor_b32 s71, s14, 0x0
v_mfma_f32_16x16x32_bf16 v[60:63], v[252:255], a[172:175], v[60:63]
s_add_u32 m0, s77, 32768
v_xor_b32 v8, 0x10000, v8
v_mfma_f32_16x16x32_bf16 v[60:63], v[236:239], a[168:171], v[60:63]
s_add_u32 s72, s71, 0
v_xor_b32 v9, 0x10000, v9
v_mfma_f32_16x16x32_bf16 v[60:63], v[220:223], a[164:167], v[60:63]
s_waitcnt lgkmcnt(0)
buffer_load_dwordx4 v15, s[24:27], s72 offen lds
v_xor_b32 v10, 0x10000, v10
v_mfma_f32_16x16x32_bf16 v[60:63], v[204:207], a[160:163], v[60:63]
v_xor_b32 v11, 0x10000, v11
v_mfma_f32_16x16x32_bf16 v[48:51], v[128:131], a[192:195], v[48:51]
s_nop 0
ds_read_b64_tr_b16 v[192:193], v8 offset:0
ds_read_b64_tr_b16 v[194:195], v8 offset:2048
v_mfma_f32_16x16x32_bf16 v[48:51], v[144:147], a[196:199], v[48:51]
buffer_store_dwordx4 v[28:31], v1, s[44:47], s80 offen offset:3072 sc1
v_mfma_f32_16x16x32_bf16 v[48:51], v[160:163], a[200:203], v[48:51]
s_nop 0
ds_read_b64_tr_b16 v[196:197], v9 offset:0
ds_read_b64_tr_b16 v[198:199], v9 offset:2048
v_mfma_f32_16x16x32_bf16 v[48:51], v[176:179], a[204:207], v[48:51]
s_add_u32 s72, s71, 15360
buffer_load_dwordx4 v15, s[24:27], s72 offen offset:1024 lds
v_mfma_f32_16x16x32_bf16 v[64:67], v[176:179], a[220:223], v[64:67]
s_nop 0
ds_read_b64_tr_b16 v[200:201], v10 offset:0
ds_read_b64_tr_b16 v[202:203], v10 offset:2048
v_mfma_f32_16x16x32_bf16 v[64:67], v[160:163], a[216:219], v[64:67]
v_mfma_f32_16x16x32_bf16 v[64:67], v[144:147], a[212:215], v[64:67]
s_nop 0
ds_read_b64_tr_b16 v[204:205], v11 offset:0
ds_read_b64_tr_b16 v[206:207], v11 offset:2048
v_mfma_f32_16x16x32_bf16 v[64:67], v[128:131], a[208:211], v[64:67]
s_nop 0
ds_read_b64_tr_b16 v[208:209], v8 offset:4096
ds_read_b64_tr_b16 v[210:211], v8 offset:6144
v_mfma_f32_16x16x32_bf16 v[68:71], v[132:135], a[208:211], v[68:71]
v_mfma_f32_16x16x32_bf16 v[68:71], v[148:151], a[212:215], v[68:71]
s_add_u32 s72, s71, 30720
buffer_load_dwordx4 v15, s[24:27], s72 offen offset:2048 lds
v_mfma_f32_16x16x32_bf16 v[68:71], v[164:167], a[216:219], v[68:71]
s_nop 0
ds_read_b64_tr_b16 v[212:213], v9 offset:4096
ds_read_b64_tr_b16 v[214:215], v9 offset:6144
v_mfma_f32_16x16x32_bf16 v[68:71], v[180:183], a[220:223], v[68:71]
s_nop 0
ds_read_b64_tr_b16 v[216:217], v10 offset:4096
ds_read_b64_tr_b16 v[218:219], v10 offset:6144
v_mfma_f32_16x16x32_bf16 v[52:55], v[180:183], a[204:207], v[52:55]
v_mfma_f32_16x16x32_bf16 v[52:55], v[164:167], a[200:203], v[52:55]
s_nop 0
ds_read_b64_tr_b16 v[220:221], v11 offset:4096
ds_read_b64_tr_b16 v[222:223], v11 offset:6144
v_mfma_f32_16x16x32_bf16 v[52:55], v[148:151], a[196:199], v[52:55]
s_nop 0
ds_read_b64_tr_b16 v[224:225], v8 offset:8192
ds_read_b64_tr_b16 v[226:227], v8 offset:10240
v_mfma_f32_16x16x32_bf16 v[52:55], v[132:135], a[192:195], v[52:55]
s_add_u32 s72, s71, 46080
buffer_load_dwordx4 v15, s[24:27], s72 offen offset:3072 lds
v_mfma_f32_16x16x32_bf16 v[56:59], v[136:139], a[192:195], v[56:59]
s_nop 0
ds_read_b64_tr_b16 v[228:229], v9 offset:8192
ds_read_b64_tr_b16 v[230:231], v9 offset:10240
v_mfma_f32_16x16x32_bf16 v[56:59], v[152:155], a[196:199], v[56:59]
v_mfma_f32_16x16x32_bf16 v[56:59], v[168:171], a[200:203], v[56:59]
s_nop 0
ds_read_b64_tr_b16 v[232:233], v10 offset:8192
ds_read_b64_tr_b16 v[234:235], v10 offset:10240
v_mfma_f32_16x16x32_bf16 v[56:59], v[184:187], a[204:207], v[56:59]
s_nop 0
ds_read_b64_tr_b16 v[236:237], v11 offset:8192
ds_read_b64_tr_b16 v[238:239], v11 offset:10240
v_mfma_f32_16x16x32_bf16 v[72:75], v[184:187], a[220:223], v[72:75]
v_mfma_f32_16x16x32_bf16 v[72:75], v[168:171], a[216:219], v[72:75]
s_nop 0
ds_read_b64_tr_b16 v[240:241], v8 offset:12288
ds_read_b64_tr_b16 v[242:243], v8 offset:14336
v_mfma_f32_16x16x32_bf16 v[72:75], v[152:155], a[212:215], v[72:75]
s_nop 0
ds_read_b64_tr_b16 v[244:245], v9 offset:12288
ds_read_b64_tr_b16 v[246:247], v9 offset:14336
v_mfma_f32_16x16x32_bf16 v[72:75], v[136:139], a[208:211], v[72:75]
v_mfma_f32_16x16x32_bf16 v[76:79], v[140:143], a[208:211], v[76:79]
s_nop 0
ds_read_b64_tr_b16 v[248:249], v10 offset:12288
ds_read_b64_tr_b16 v[250:251], v10 offset:14336
v_mfma_f32_16x16x32_bf16 v[76:79], v[156:159], a[212:215], v[76:79]
s_nop 0
ds_read_b64_tr_b16 v[252:253], v11 offset:12288
ds_read_b64_tr_b16 v[254:255], v11 offset:14336
v_mfma_f32_16x16x32_bf16 v[76:79], v[172:175], a[216:219], v[76:79]
v_mfma_f32_16x16x32_bf16 v[76:79], v[188:191], a[220:223], v[76:79]
v_mfma_f32_16x16x32_bf16 v[60:63], v[188:191], a[204:207], v[60:63]
v_mfma_f32_16x16x32_bf16 v[60:63], v[172:175], a[200:203], v[60:63]
s_xor_b32 s71, s15, 0x0
v_mfma_f32_16x16x32_bf16 v[60:63], v[156:159], a[196:199], v[60:63]
s_waitcnt vmcnt(22) lgkmcnt(0)
v_mfma_f32_16x16x32_bf16 v[60:63], v[140:143], a[192:195], v[60:63]
s_barrier
v_mfma_f32_16x16x32_bf16 v[48:51], v[192:195], a[224:227], v[48:51]
s_add_u32 m0, s77, 49152
ds_read_b64_tr_b16 v[128:129], v8 offset:16384
ds_read_b64_tr_b16 v[130:131], v8 offset:18432
v_mfma_f32_16x16x32_bf16 v[48:51], v[208:211], a[228:231], v[48:51]
s_add_u32 s72, s71, 0
buffer_load_dwordx4 v15, s[24:27], s72 offen lds
v_mfma_f32_16x16x32_bf16 v[48:51], v[224:227], a[232:235], v[48:51]
s_nop 0
ds_read_b64_tr_b16 v[132:133], v9 offset:16384
ds_read_b64_tr_b16 v[134:135], v9 offset:18432
v_mfma_f32_16x16x32_bf16 v[48:51], v[240:243], a[236:239], v[48:51]
s_nop 0
ds_read_b64_tr_b16 v[136:137], v10 offset:16384
ds_read_b64_tr_b16 v[138:139], v10 offset:18432
v_mfma_f32_16x16x32_bf16 v[52:55], v[244:247], a[236:239], v[52:55]
s_nop 0
ds_read_b64_tr_b16 v[140:141], v11 offset:16384
ds_read_b64_tr_b16 v[142:143], v11 offset:18432
v_mfma_f32_16x16x32_bf16 v[52:55], v[228:231], a[232:235], v[52:55]
s_add_u32 s72, s71, 15360
buffer_load_dwordx4 v15, s[24:27], s72 offen offset:1024 lds
v_mfma_f32_16x16x32_bf16 v[52:55], v[212:215], a[228:231], v[52:55]
v_mfma_f32_16x16x32_bf16 v[52:55], v[196:199], a[224:227], v[52:55]
s_nop 0
ds_read_b64_tr_b16 v[144:145], v8 offset:20480
ds_read_b64_tr_b16 v[146:147], v8 offset:22528
v_mfma_f32_16x16x32_bf16 v[56:59], v[200:203], a[224:227], v[56:59]
s_nop 0
ds_read_b64_tr_b16 v[148:149], v9 offset:20480
ds_read_b64_tr_b16 v[150:151], v9 offset:22528
v_mfma_f32_16x16x32_bf16 v[56:59], v[216:219], a[228:231], v[56:59]
s_add_u32 s72, s71, 30720
buffer_load_dwordx4 v15, s[24:27], s72 offen offset:2048 lds
v_mfma_f32_16x16x32_bf16 v[56:59], v[232:235], a[232:235], v[56:59]
s_nop 0
ds_read_b64_tr_b16 v[152:153], v10 offset:20480
ds_read_b64_tr_b16 v[154:155], v10 offset:22528
v_mfma_f32_16x16x32_bf16 v[56:59], v[248:251], a[236:239], v[56:59]
s_nop 0
ds_read_b64_tr_b16 v[156:157], v11 offset:20480
ds_read_b64_tr_b16 v[158:159], v11 offset:22528
v_cvt_pk_bf16_f32 v48, v48, v49
v_mfma_f32_16x16x32_bf16 v[60:63], v[252:255], a[236:239], v[60:63]
v_cvt_pk_bf16_f32 v49, v50, v51
v_cvt_pk_bf16_f32 v50, v52, v53
v_cvt_pk_bf16_f32 v51, v54, v55
v_mfma_f32_16x16x32_bf16 v[60:63], v[236:239], a[232:235], v[60:63]
s_add_u32 s72, s71, 46080
buffer_load_dwordx4 v15, s[24:27], s72 offen offset:3072 lds
v_mfma_f32_16x16x32_bf16 v[60:63], v[220:223], a[228:231], v[60:63]
s_nop 0
ds_read_b64_tr_b16 v[160:161], v8 offset:24576
ds_read_b64_tr_b16 v[162:163], v8 offset:26624
v_mfma_f32_16x16x32_bf16 v[60:63], v[204:207], a[224:227], v[60:63]
s_nop 0
ds_read_b64_tr_b16 v[164:165], v9 offset:24576
ds_read_b64_tr_b16 v[166:167], v9 offset:26624
v_mfma_f32_16x16x32_bf16 v[64:67], v[192:195], a[240:243], v[64:67]
s_xor_b32 s80, s93, 0x200000
ds_read_b64_tr_b16 v[168:169], v10 offset:24576
ds_read_b64_tr_b16 v[170:171], v10 offset:26624
v_mfma_f32_16x16x32_bf16 v[64:67], v[208:211], a[244:247], v[64:67]
s_add_u32 s80, s80, 0x3e00000
buffer_store_dwordx4 v[48:51], v1, s[44:47], s80 offen sc1
v_mfma_f32_16x16x32_bf16 v[64:67], v[224:227], a[248:251], v[64:67]
s_nop 0
ds_read_b64_tr_b16 v[172:173], v11 offset:24576
ds_read_b64_tr_b16 v[174:175], v11 offset:26624
v_mfma_f32_16x16x32_bf16 v[64:67], v[240:243], a[252:255], v[64:67]
s_xor_b32 s71, s12, 0x40000
v_cvt_pk_bf16_f32 v52, v56, v57
v_cvt_pk_bf16_f32 v53, v58, v59
v_cvt_pk_bf16_f32 v54, v60, v61
v_mfma_f32_16x16x32_bf16 v[68:71], v[244:247], a[252:255], v[68:71]
s_add_u32 m0, s85, 0
ds_read_b64_tr_b16 v[176:177], v8 offset:28672
ds_read_b64_tr_b16 v[178:179], v8 offset:30720
v_cvt_pk_bf16_f32 v55, v62, v63
v_mfma_f32_16x16x32_bf16 v[68:71], v[228:231], a[248:251], v[68:71]
s_add_u32 s72, s71, 0
buffer_load_dwordx4 v15, s[24:27], s72 offen lds
v_mfma_f32_16x16x32_bf16 v[68:71], v[212:215], a[244:247], v[68:71]
s_nop 0
ds_read_b64_tr_b16 v[180:181], v9 offset:28672
ds_read_b64_tr_b16 v[182:183], v9 offset:30720
v_mfma_f32_16x16x32_bf16 v[68:71], v[196:199], a[240:243], v[68:71]
s_nop 0
ds_read_b64_tr_b16 v[184:185], v10 offset:28672
ds_read_b64_tr_b16 v[186:187], v10 offset:30720
v_mfma_f32_16x16x32_bf16 v[72:75], v[200:203], a[240:243], v[72:75]
s_nop 0
ds_read_b64_tr_b16 v[188:189], v11 offset:28672
ds_read_b64_tr_b16 v[190:191], v11 offset:30720
v_mfma_f32_16x16x32_bf16 v[72:75], v[216:219], a[244:247], v[72:75]
v_mfma_f32_16x16x32_bf16 v[72:75], v[232:235], a[248:251], v[72:75]
s_add_u32 s72, s71, 15360
buffer_load_dwordx4 v15, s[24:27], s72 offen offset:1024 lds
v_mfma_f32_16x16x32_bf16 v[72:75], v[248:251], a[252:255], v[72:75]
v_cvt_pk_bf16_f32 v56, v64, v65
v_cvt_pk_bf16_f32 v57, v66, v67
v_cvt_pk_bf16_f32 v58, v68, v69
v_mfma_f32_16x16x32_bf16 v[76:79], v[252:255], a[252:255], v[76:79]
v_cvt_pk_bf16_f32 v59, v70, v71
v_mfma_f32_16x16x32_bf16 v[76:79], v[236:239], a[248:251], v[76:79]
v_mfma_f32_16x16x32_bf16 v[76:79], v[220:223], a[244:247], v[76:79]
s_waitcnt lgkmcnt(0)
v_mfma_f32_16x16x32_bf16 v[76:79], v[204:207], a[240:243], v[76:79]
v_mfma_f32_16x16x32_bf16 v[80:83], v[128:131], a[160:163], v[80:83]
s_add_u32 s72, s71, 30720
buffer_load_dwordx4 v15, s[24:27], s72 offen offset:2048 lds
v_mfma_f32_16x16x32_bf16 v[80:83], v[144:147], a[164:167], v[80:83]
s_waitcnt vmcnt(23)
buffer_store_dwordx4 v[52:55], v1, s[44:47], s80 offen offset:1024 sc1
v_mfma_f32_16x16x32_bf16 v[80:83], v[160:163], a[168:171], v[80:83]
s_nop 0
ds_read_b64_tr_b16 v[192:193], v8 offset:32768
ds_read_b64_tr_b16 v[194:195], v8 offset:34816
v_mfma_f32_16x16x32_bf16 v[80:83], v[176:179], a[172:175], v[80:83]
s_nop 0
ds_read_b64_tr_b16 v[196:197], v9 offset:32768
ds_read_b64_tr_b16 v[198:199], v9 offset:34816
v_cvt_pk_bf16_f32 v60, v72, v73
v_mfma_f32_16x16x32_bf16 v[96:99], v[176:179], a[188:191], v[96:99]
s_nop 0
ds_read_b64_tr_b16 v[200:201], v10 offset:32768
ds_read_b64_tr_b16 v[202:203], v10 offset:34816
v_cvt_pk_bf16_f32 v61, v74, v75
v_mfma_f32_16x16x32_bf16 v[96:99], v[160:163], a[184:187], v[96:99]
v_cvt_pk_bf16_f32 v62, v76, v77
v_cvt_pk_bf16_f32 v63, v78, v79
v_mfma_f32_16x16x32_bf16 v[96:99], v[144:147], a[180:183], v[96:99]
s_add_u32 s72, s71, 46080
buffer_load_dwordx4 v15, s[24:27], s72 offen offset:3072 lds
v_mfma_f32_16x16x32_bf16 v[96:99], v[128:131], a[176:179], v[96:99]
s_nop 0
ds_read_b64_tr_b16 v[204:205], v11 offset:32768
ds_read_b64_tr_b16 v[206:207], v11 offset:34816
v_mfma_f32_16x16x32_bf16 v[100:103], v[132:135], a[176:179], v[100:103]
s_nop 0
ds_read_b64_tr_b16 v[208:209], v8 offset:36864
ds_read_b64_tr_b16 v[210:211], v8 offset:38912
v_mfma_f32_16x16x32_bf16 v[100:103], v[148:151], a[180:183], v[100:103]
v_sub_f32 v112, 1.0, v6
v_sub_f32 v113, 1.0, v7
v_mfma_f32_16x16x32_bf16 v[100:103], v[164:167], a[184:187], v[100:103]
s_nop 0
ds_read_b64_tr_b16 v[212:213], v9 offset:36864
ds_read_b64_tr_b16 v[214:215], v9 offset:38912
v_mfma_f32_16x16x32_bf16 v[100:103], v[180:183], a[188:191], v[100:103]
s_nop 0
ds_read_b64_tr_b16 v[216:217], v10 offset:36864
ds_read_b64_tr_b16 v[218:219], v10 offset:38912
v_mfma_f32_16x16x32_bf16 v[84:87], v[180:183], a[172:175], v[84:87]
v_mfma_f32_16x16x32_bf16 v[84:87], v[164:167], a[168:171], v[84:87]
s_nop 0
ds_read_b64_tr_b16 v[220:221], v11 offset:36864
ds_read_b64_tr_b16 v[222:223], v11 offset:38912
v_mfma_f32_16x16x32_bf16 v[84:87], v[148:151], a[164:167], v[84:87]
s_nop 0
ds_read_b64_tr_b16 v[224:225], v8 offset:40960
ds_read_b64_tr_b16 v[226:227], v8 offset:43008
v_mfma_f32_16x16x32_bf16 v[84:87], v[132:135], a[160:163], v[84:87]
s_nop 0
ds_read_b64_tr_b16 v[228:229], v9 offset:40960
ds_read_b64_tr_b16 v[230:231], v9 offset:43008
v_mfma_f32_16x16x32_bf16 v[88:91], v[136:139], a[160:163], v[88:91]
v_mfma_f32_16x16x32_bf16 v[88:91], v[152:155], a[164:167], v[88:91]
buffer_store_dwordx4 v[56:59], v1, s[44:47], s80 offen offset:2048 sc1
v_mfma_f32_16x16x32_bf16 v[88:91], v[168:171], a[168:171], v[88:91]
s_nop 0
ds_read_b64_tr_b16 v[232:233], v10 offset:40960
ds_read_b64_tr_b16 v[234:235], v10 offset:43008
v_mfma_f32_16x16x32_bf16 v[88:91], v[184:187], a[172:175], v[88:91]
s_nop 0
ds_read_b64_tr_b16 v[236:237], v11 offset:40960
ds_read_b64_tr_b16 v[238:239], v11 offset:43008
v_mfma_f32_16x16x32_bf16 v[104:107], v[184:187], a[188:191], v[104:107]
v_mfma_f32_16x16x32_bf16 v[104:107], v[168:171], a[184:187], v[104:107]
s_nop 0
ds_read_b64_tr_b16 v[240:241], v8 offset:45056
ds_read_b64_tr_b16 v[242:243], v8 offset:47104
v_mfma_f32_16x16x32_bf16 v[104:107], v[152:155], a[180:183], v[104:107]
s_nop 0
ds_read_b64_tr_b16 v[244:245], v9 offset:45056
ds_read_b64_tr_b16 v[246:247], v9 offset:47104
v_mfma_f32_16x16x32_bf16 v[104:107], v[136:139], a[176:179], v[104:107]
v_mfma_f32_16x16x32_bf16 v[108:111], v[140:143], a[176:179], v[108:111]
s_nop 0
ds_read_b64_tr_b16 v[248:249], v10 offset:45056
ds_read_b64_tr_b16 v[250:251], v10 offset:47104
v_mfma_f32_16x16x32_bf16 v[108:111], v[156:159], a[180:183], v[108:111]
s_nop 0
ds_read_b64_tr_b16 v[252:253], v11 offset:45056
ds_read_b64_tr_b16 v[254:255], v11 offset:47104
v_mfma_f32_16x16x32_bf16 v[108:111], v[172:175], a[184:187], v[108:111]
v_mfma_f32_16x16x32_bf16 v[108:111], v[188:191], a[188:191], v[108:111]
v_mfma_f32_16x16x32_bf16 v[92:95], v[188:191], a[172:175], v[92:95]
v_mfma_f32_16x16x32_bf16 v[92:95], v[172:175], a[168:171], v[92:95]
s_xor_b32 s71, s13, 0x40000
v_mfma_f32_16x16x32_bf16 v[92:95], v[156:159], a[164:167], v[92:95]
s_waitcnt vmcnt(22) lgkmcnt(0)
v_mfma_f32_16x16x32_bf16 v[92:95], v[140:143], a[160:163], v[92:95]
s_barrier
v_mfma_f32_16x16x32_bf16 v[80:83], v[192:195], a[192:195], v[80:83]
s_add_u32 m0, s85, 16384
ds_read_b64_tr_b16 v[128:129], v8 offset:49152
ds_read_b64_tr_b16 v[130:131], v8 offset:51200
v_mfma_f32_16x16x32_bf16 v[80:83], v[208:211], a[196:199], v[80:83]
s_add_u32 s72, s71, 0
buffer_load_dwordx4 v15, s[24:27], s72 offen lds
v_mfma_f32_16x16x32_bf16 v[80:83], v[224:227], a[200:203], v[80:83]
buffer_store_dwordx4 v[60:63], v1, s[44:47], s80 offen offset:3072 sc1
v_mfma_f32_16x16x32_bf16 v[80:83], v[240:243], a[204:207], v[80:83]
s_nop 0
ds_read_b64_tr_b16 v[132:133], v9 offset:49152
ds_read_b64_tr_b16 v[134:135], v9 offset:51200
v_mfma_f32_16x16x32_bf16 v[96:99], v[240:243], a[220:223], v[96:99]
s_add_u32 s72, s71, 15360
buffer_load_dwordx4 v15, s[24:27], s72 offen offset:1024 lds
v_mfma_f32_16x16x32_bf16 v[96:99], v[224:227], a[216:219], v[96:99]
s_nop 0
ds_read_b64_tr_b16 v[136:137], v10 offset:49152
ds_read_b64_tr_b16 v[138:139], v10 offset:51200
v_mfma_f32_16x16x32_bf16 v[96:99], v[208:211], a[212:215], v[96:99]
s_nop 0
ds_read_b64_tr_b16 v[140:141], v11 offset:49152
ds_read_b64_tr_b16 v[142:143], v11 offset:51200
v_mfma_f32_16x16x32_bf16 v[96:99], v[192:195], a[208:211], v[96:99]
s_add_u32 s72, s71, 30720
buffer_load_dwordx4 v15, s[24:27], s72 offen offset:2048 lds
v_mfma_f32_16x16x32_bf16 v[100:103], v[196:199], a[208:211], v[100:103]
s_nop 0
ds_read_b64_tr_b16 v[144:145], v8 offset:53248
ds_read_b64_tr_b16 v[146:147], v8 offset:55296
v_mfma_f32_16x16x32_bf16 v[100:103], v[212:215], a[212:215], v[100:103]
s_nop 0
ds_read_b64_tr_b16 v[148:149], v9 offset:53248
ds_read_b64_tr_b16 v[150:151], v9 offset:55296
v_mfma_f32_16x16x32_bf16 v[100:103], v[228:231], a[216:219], v[100:103]
s_add_u32 s72, s71, 46080
buffer_load_dwordx4 v15, s[24:27], s72 offen offset:3072 lds
v_mfma_f32_16x16x32_bf16 v[100:103], v[244:247], a[220:223], v[100:103]
s_xor_b32 s71, s14, 0x40000
ds_read_b64 v[48:49], v116 offset:0
ds_read_b64_tr_b16 v[64:65], v5 offset:0
v_mfma_f32_16x16x32_bf16 v[84:87], v[244:247], a[204:207], v[84:87]
s_add_u32 m0, s85, 32768
s_add_u32 s72, s71, 0
buffer_load_dwordx4 v15, s[24:27], s72 offen lds
v_mfma_f32_16x16x32_bf16 v[84:87], v[228:231], a[200:203], v[84:87]
s_nop 0
ds_read_b64_tr_b16 v[152:153], v10 offset:53248
ds_read_b64_tr_b16 v[154:155], v10 offset:55296
v_mfma_f32_16x16x32_bf16 v[84:87], v[212:215], a[196:199], v[84:87]
s_nop 0
ds_read_b64_tr_b16 v[156:157], v11 offset:53248
ds_read_b64_tr_b16 v[158:159], v11 offset:55296
v_mfma_f32_16x16x32_bf16 v[84:87], v[196:199], a[192:195], v[84:87]
s_nop 0
ds_read_b64_tr_b16 v[160:161], v8 offset:57344
ds_read_b64_tr_b16 v[162:163], v8 offset:59392
v_mfma_f32_16x16x32_bf16 v[88:91], v[200:203], a[192:195], v[88:91]
s_nop 0
ds_read_b64_tr_b16 v[164:165], v9 offset:57344
ds_read_b64_tr_b16 v[166:167], v9 offset:59392
Lstube4:
s_cbranch_execz Lrete
v_mfma_f32_16x16x32_bf16 v[88:91], v[216:219], a[196:199], v[88:91]
s_add_u32 s72, s71, 15360
buffer_load_dwordx4 v15, s[24:27], s72 offen offset:1024 lds
v_mfma_f32_16x16x32_bf16 v[88:91], v[232:235], a[200:203], v[88:91]
s_nop 0
ds_read_b64_tr_b16 v[168:169], v10 offset:57344
ds_read_b64_tr_b16 v[170:171], v10 offset:59392
v_mfma_f32_16x16x32_bf16 v[88:91], v[248:251], a[204:207], v[88:91]
s_nop 0
ds_read_b64 v[50:51], v117 offset:0
ds_read_b64_tr_b16 v[66:67], v5 offset:4096
v_mfma_f32_16x16x32_bf16 v[104:107], v[248:251], a[220:223], v[104:107]
s_nop 0
ds_read_b64_tr_b16 v[172:173], v11 offset:57344
ds_read_b64_tr_b16 v[174:175], v11 offset:59392
v_mfma_f32_16x16x32_bf16 v[104:107], v[232:235], a[216:219], v[104:107]
s_nop 0
ds_read_b64_tr_b16 v[176:177], v8 offset:61440
ds_read_b64_tr_b16 v[178:179], v8 offset:63488
v_mfma_f32_16x16x32_bf16 v[104:107], v[216:219], a[212:215], v[104:107]
s_nop 0
ds_read_b64_tr_b16 v[180:181], v9 offset:61440
ds_read_b64_tr_b16 v[182:183], v9 offset:63488
v_mfma_f32_16x16x32_bf16 v[104:107], v[200:203], a[208:211], v[104:107]
s_add_u32 s72, s71, 30720
buffer_load_dwordx4 v15, s[24:27], s72 offen offset:2048 lds
v_mfma_f32_16x16x32_bf16 v[108:111], v[204:207], a[208:211], v[108:111]
s_nop 0
ds_read_b64_tr_b16 v[184:185], v10 offset:61440
ds_read_b64_tr_b16 v[186:187], v10 offset:63488
v_mfma_f32_16x16x32_bf16 v[108:111], v[220:223], a[212:215], v[108:111]
s_nop 0
ds_read_b64_tr_b16 v[188:189], v11 offset:61440
ds_read_b64_tr_b16 v[190:191], v11 offset:63488
v_mfma_f32_16x16x32_bf16 v[108:111], v[236:239], a[216:219], v[108:111]
s_nop 0
ds_read_b64 v[52:53], v118 offset:0
ds_read_b64_tr_b16 v[68:69], v5 offset:8192
v_mfma_f32_16x16x32_bf16 v[108:111], v[252:255], a[220:223], v[108:111]
s_nop 0
ds_read_b64 v[54:55], v119 offset:0
ds_read_b64_tr_b16 v[70:71], v5 offset:12288
v_mfma_f32_16x16x32_bf16 v[92:95], v[252:255], a[204:207], v[92:95]
v_xor_b32 v8, 0x10000, v8
v_xor_b32 v5, 16, v5
v_mfma_f32_16x16x32_bf16 v[92:95], v[236:239], a[200:203], v[92:95]
s_add_u32 s72, s71, 46080
buffer_load_dwordx4 v15, s[24:27], s72 offen offset:3072 lds
v_xor_b32 v9, 0x10000, v9
v_mfma_f32_16x16x32_bf16 v[92:95], v[220:223], a[196:199], v[92:95]
s_waitcnt lgkmcnt(0)
ds_read_b64 v[56:57], v116 offset:2048
v_xor_b32 v10, 0x10000, v10
v_mfma_f32_16x16x32_bf16 v[92:95], v[204:207], a[192:195], v[92:95]
ds_read_b64_tr_b16 v[72:73], v5 offset:0
v_xor_b32 v11, 0x10000, v11
v_mfma_f32_16x16x32_bf16 v[80:83], v[128:131], a[224:227], v[80:83]
s_nop 0
ds_read_b64_tr_b16 v[192:193], v8 offset:0
ds_read_b64_tr_b16 v[194:195], v8 offset:2048
v_mfma_f32_16x16x32_bf16 v[80:83], v[144:147], a[228:231], v[80:83]
s_nop 0
ds_read_b64_tr_b16 v[196:197], v9 offset:0
ds_read_b64_tr_b16 v[198:199], v9 offset:2048
v_mfma_f32_16x16x32_bf16 v[80:83], v[160:163], a[232:235], v[80:83]
s_nop 0
ds_read_b64 v[58:59], v117 offset:2048
ds_read_b64_tr_b16 v[74:75], v5 offset:4096
v_mfma_f32_16x16x32_bf16 v[80:83], v[176:179], a[236:239], v[80:83]
s_nop 0
ds_read_b64_tr_b16 v[200:201], v10 offset:0
ds_read_b64_tr_b16 v[202:203], v10 offset:2048
v_mfma_f32_16x16x32_bf16 v[84:87], v[180:183], a[236:239], v[84:87]
s_nop 0
ds_read_b64_tr_b16 v[204:205], v11 offset:0
ds_read_b64_tr_b16 v[206:207], v11 offset:2048
v_mfma_f32_16x16x32_bf16 v[84:87], v[164:167], a[232:235], v[84:87]
s_nop 0
ds_read_b64 v[60:61], v118 offset:2048
ds_read_b64_tr_b16 v[76:77], v5 offset:8192
v_mfma_f32_16x16x32_bf16 v[84:87], v[148:151], a[228:231], v[84:87]
s_nop 0
ds_read_b64_tr_b16 v[208:209], v8 offset:4096
ds_read_b64_tr_b16 v[210:211], v8 offset:6144
v_mfma_f32_16x16x32_bf16 v[84:87], v[132:135], a[224:227], v[84:87]
s_nop 0
ds_read_b64 v[62:63], v119 offset:2048
ds_read_b64_tr_b16 v[78:79], v5 offset:12288
v_mfma_f32_16x16x32_bf16 v[88:91], v[136:139], a[224:227], v[88:91]
s_nop 0
ds_read_b64_tr_b16 v[212:213], v9 offset:4096
ds_read_b64_tr_b16 v[214:215], v9 offset:6144
v_mfma_f32_16x16x32_bf16 v[88:91], v[152:155], a[228:231], v[88:91]
s_nop 0
ds_read_b64_tr_b16 v[216:217], v10 offset:4096
ds_read_b64_tr_b16 v[218:219], v10 offset:6144
v_mfma_f32_16x16x32_bf16 v[88:91], v[168:171], a[232:235], v[88:91]
v_mfma_f32_16x16x32_bf16 v[88:91], v[184:187], a[236:239], v[88:91]
s_nop 0
ds_read_b64_tr_b16 v[220:221], v11 offset:4096
ds_read_b64_tr_b16 v[222:223], v11 offset:6144
v_cvt_pk_bf16_f32 v80, v80, v81
v_mfma_f32_16x16x32_bf16 v[92:95], v[188:191], a[236:239], v[92:95]
v_cvt_pk_bf16_f32 v81, v82, v83
v_cvt_pk_bf16_f32 v82, v84, v85
v_cvt_pk_bf16_f32 v83, v86, v87
v_mfma_f32_16x16x32_bf16 v[92:95], v[172:175], a[232:235], v[92:95]
s_waitcnt lgkmcnt(6)
ds_read_b64_tr_b16 v[224:225], v8 offset:8192
ds_read_b64_tr_b16 v[226:227], v8 offset:10240
v_mfma_f32_16x16x32_bf16 v[92:95], v[156:159], a[228:231], v[92:95]
s_nop 0
ds_read_b64_tr_b16 v[228:229], v9 offset:8192
ds_read_b64_tr_b16 v[230:231], v9 offset:10240
v_mfma_f32_16x16x32_bf16 v[92:95], v[140:143], a[224:227], v[92:95]
v_and_b32 v114, 0xffff0000, v48
v_lshlrev_b32 v115, 16, v64
v_mfma_f32_16x16x32_bf16 v[96:99], v[128:131], a[240:243], v[96:99]
s_xor_b32 s80, s93, 0x300000
ds_read_b64_tr_b16 v[232:233], v10 offset:8192
ds_read_b64_tr_b16 v[234:235], v10 offset:10240
v_mfma_f32_16x16x32_bf16 v[96:99], v[144:147], a[244:247], v[96:99]
s_add_u32 s80, s80, 0x4200000
buffer_store_dwordx4 v[80:83], v1, s[44:47], s80 offen sc1
v_mfma_f32_16x16x32_bf16 v[96:99], v[160:163], a[248:251], v[96:99]
s_nop 0
ds_read_b64_tr_b16 v[236:237], v11 offset:8192
ds_read_b64_tr_b16 v[238:239], v11 offset:10240
v_mfma_f32_16x16x32_bf16 v[96:99], v[176:179], a[252:255], v[96:99]
v_cvt_pk_bf16_f32 v84, v88, v89
v_cvt_pk_bf16_f32 v85, v90, v91
v_cvt_pk_bf16_f32 v86, v92, v93
v_mfma_f32_16x16x32_bf16 v[100:103], v[180:183], a[252:255], v[100:103]
s_nop 0
ds_read_b64_tr_b16 v[240:241], v8 offset:12288
ds_read_b64_tr_b16 v[242:243], v8 offset:14336
v_cvt_pk_bf16_f32 v87, v94, v95
v_mfma_f32_16x16x32_bf16 v[100:103], v[164:167], a[248:251], v[100:103]
v_lshlrev_b32 v48, 16, v48
v_and_b32 v64, 0xffff0000, v64
v_mfma_f32_16x16x32_bf16 v[100:103], v[148:151], a[244:247], v[100:103]
s_nop 0
ds_read_b64_tr_b16 v[244:245], v9 offset:12288
ds_read_b64_tr_b16 v[246:247], v9 offset:14336
v_mfma_f32_16x16x32_bf16 v[100:103], v[132:135], a[240:243], v[100:103]
s_nop 0
ds_read_b64_tr_b16 v[248:249], v10 offset:12288
ds_read_b64_tr_b16 v[250:251], v10 offset:14336
v_mfma_f32_16x16x32_bf16 v[104:107], v[136:139], a[240:243], v[104:107]
v_mul_f32 v48, v48, v112
v_mul_f32 v114, v114, v112
v_mfma_f32_16x16x32_bf16 v[104:107], v[152:155], a[244:247], v[104:107]
s_nop 0
ds_read_b64_tr_b16 v[252:253], v11 offset:12288
ds_read_b64_tr_b16 v[254:255], v11 offset:14336
v_mfma_f32_16x16x32_bf16 v[104:107], v[168:171], a[248:251], v[104:107]
v_mul_f32 v48, v48, v115
v_mul_f32 v64, v64, v114
v_mfma_f32_16x16x32_bf16 v[104:107], v[184:187], a[252:255], v[104:107]
v_cvt_pk_bf16_f32 v88, v96, v97
v_cvt_pk_bf16_f32 v89, v98, v99
v_cvt_pk_bf16_f32 v90, v100, v101
v_mfma_f32_16x16x32_bf16 v[108:111], v[188:191], a[252:255], v[108:111]
v_cvt_pk_bf16_f32 v91, v102, v103
v_and_b32 v114, 0xffff0000, v49
v_mfma_f32_16x16x32_bf16 v[108:111], v[172:175], a[248:251], v[108:111]
s_xor_b32 s71, s15, 0x40000
v_lshlrev_b32 v115, 16, v65
v_lshlrev_b32 v49, 16, v49
v_mfma_f32_16x16x32_bf16 v[108:111], v[156:159], a[244:247], v[108:111]
s_waitcnt vmcnt(21) lgkmcnt(0)
v_and_b32 v65, 0xffff0000, v65
v_mul_f32 v49, v49, v112
v_mfma_f32_16x16x32_bf16 v[108:111], v[140:143], a[240:243], v[108:111]
s_barrier
v_mul_f32 v114, v114, v112
v_mul_f32 v49, v49, v115
v_mfma_f32_16x16x32_bf16 v[16:19], v[192:195], a[0:3], 0
s_add_u32 m0, s85, 49152
ds_read_b64_tr_b16 v[128:129], v8 offset:16384
ds_read_b64_tr_b16 v[130:131], v8 offset:18432
v_mfma_f32_16x16x32_bf16 v[16:19], v[208:211], a[4:7], v[16:19]
s_add_u32 s72, s71, 0
buffer_load_dwordx4 v15, s[24:27], s72 offen lds
v_mfma_f32_16x16x32_bf16 v[16:19], v[224:227], a[8:11], v[16:19]
buffer_store_dwordx4 v[84:87], v1, s[44:47], s80 offen offset:1024 sc1
v_mfma_f32_16x16x32_bf16 v[16:19], v[240:243], a[12:15], v[16:19]
s_nop 0
ds_read_b64_tr_b16 v[132:133], v9 offset:16384
ds_read_b64_tr_b16 v[134:135], v9 offset:18432
v_cvt_pk_bf16_f32 v92, v104, v105
v_mfma_f32_16x16x32_bf16 v[32:35], v[240:243], a[28:31], 0
s_add_u32 s72, s71, 15360
buffer_load_dwordx4 v15, s[24:27], s72 offen offset:1024 lds
v_cvt_pk_bf16_f32 v93, v106, v107
v_mfma_f32_16x16x32_bf16 v[32:35], v[224:227], a[24:27], v[32:35]
s_nop 0
ds_read_b64_tr_b16 v[136:137], v10 offset:16384
ds_read_b64_tr_b16 v[138:139], v10 offset:18432
v_cvt_pk_bf16_f32 v94, v108, v109
v_mfma_f32_16x16x32_bf16 v[32:35], v[208:211], a[20:23], v[32:35]
s_nop 0
ds_read_b64_tr_b16 v[140:141], v11 offset:16384
ds_read_b64_tr_b16 v[142:143], v11 offset:18432
v_cvt_pk_bf16_f32 v95, v110, v111
v_mfma_f32_16x16x32_bf16 v[32:35], v[192:195], a[16:19], v[32:35]
s_add_u32 s72, s71, 30720
buffer_load_dwordx4 v15, s[24:27], s72 offen offset:2048 lds
v_mfma_f32_16x16x32_bf16 v[36:39], v[196:199], a[16:19], 0
v_mul_f32 v65, v65, v114
v_and_b32 v114, 0xffff0000, v50
v_mfma_f32_16x16x32_bf16 v[36:39], v[212:215], a[20:23], v[36:39]
s_nop 0
ds_read_b64_tr_b16 v[144:145], v8 offset:20480
ds_read_b64_tr_b16 v[146:147], v8 offset:22528
v_mfma_f32_16x16x32_bf16 v[36:39], v[228:231], a[24:27], v[36:39]
s_add_u32 s72, s71, 46080
buffer_load_dwordx4 v15, s[24:27], s72 offen offset:3072 lds
v_mfma_f32_16x16x32_bf16 v[36:39], v[244:247], a[28:31], v[36:39]
s_nop 0
ds_read_b64_tr_b16 v[148:149], v9 offset:20480
ds_read_b64_tr_b16 v[150:151], v9 offset:22528
v_mfma_f32_16x16x32_bf16 v[20:23], v[244:247], a[12:15], 0
s_nop 0
ds_read_b64_tr_b16 v[152:153], v10 offset:20480
ds_read_b64_tr_b16 v[154:155], v10 offset:22528
v_mfma_f32_16x16x32_bf16 v[20:23], v[228:231], a[8:11], v[20:23]
v_lshlrev_b32 v115, 16, v66
v_lshlrev_b32 v50, 16, v50
v_mfma_f32_16x16x32_bf16 v[20:23], v[212:215], a[4:7], v[20:23]
s_nop 0
ds_read_b64_tr_b16 v[156:157], v11 offset:20480
ds_read_b64_tr_b16 v[158:159], v11 offset:22528
v_mfma_f32_16x16x32_bf16 v[20:23], v[196:199], a[0:3], v[20:23]
s_nop 0
ds_read_b64_tr_b16 v[160:161], v8 offset:24576
ds_read_b64_tr_b16 v[162:163], v8 offset:26624
v_mfma_f32_16x16x32_bf16 v[24:27], v[200:203], a[0:3], 0
s_nop 0
ds_read_b64_tr_b16 v[164:165], v9 offset:24576
ds_read_b64_tr_b16 v[166:167], v9 offset:26624
v_mfma_f32_16x16x32_bf16 v[24:27], v[216:219], a[4:7], v[24:27]
v_and_b32 v66, 0xffff0000, v66
v_mul_f32 v50, v50, v112
v_mfma_f32_16x16x32_bf16 v[24:27], v[232:235], a[8:11], v[24:27]
buffer_store_dwordx4 v[88:91], v1, s[44:47], s80 offen offset:2048 sc1
v_mfma_f32_16x16x32_bf16 v[24:27], v[248:251], a[12:15], v[24:27]
s_nop 0
ds_read_b64_tr_b16 v[168:169], v10 offset:24576
ds_read_b64_tr_b16 v[170:171], v10 offset:26624
v_mfma_f32_16x16x32_bf16 v[40:43], v[248:251], a[28:31], 0
s_nop 0
ds_read_b64_tr_b16 v[172:173], v11 offset:24576
ds_read_b64_tr_b16 v[174:175], v11 offset:26624
v_mfma_f32_16x16x32_bf16 v[40:43], v[232:235], a[24:27], v[40:43]
s_nop 0
ds_read_b64_tr_b16 v[176:177], v8 offset:28672
ds_read_b64_tr_b16 v[178:179], v8 offset:30720
v_mfma_f32_16x16x32_bf16 v[40:43], v[216:219], a[20:23], v[40:43]
v_mul_f32 v114, v114, v112
v_mul_f32 v50, v50, v115
v_mfma_f32_16x16x32_bf16 v[40:43], v[200:203], a[16:19], v[40:43]
s_nop 0
ds_read_b64_tr_b16 v[180:181], v9 offset:28672
ds_read_b64_tr_b16 v[182:183], v9 offset:30720
v_mfma_f32_16x16x32_bf16 v[44:47], v[204:207], a[16:19], 0
s_nop 0
ds_read_b64_tr_b16 v[184:185], v10 offset:28672
ds_read_b64_tr_b16 v[186:187], v10 offset:30720
v_mfma_f32_16x16x32_bf16 v[44:47], v[220:223], a[20:23], v[44:47]
s_nop 0
ds_read_b64_tr_b16 v[188:189], v11 offset:28672
ds_read_b64_tr_b16 v[190:191], v11 offset:30720
v_mfma_f32_16x16x32_bf16 v[44:47], v[236:239], a[24:27], v[44:47]
v_mul_f32 v66, v66, v114
v_and_b32 v114, 0xffff0000, v51
v_mfma_f32_16x16x32_bf16 v[44:47], v[252:255], a[28:31], v[44:47]
v_lshlrev_b32 v115, 16, v67
v_lshlrev_b32 v51, 16, v51
v_mfma_f32_16x16x32_bf16 v[28:31], v[252:255], a[12:15], 0
v_and_b32 v67, 0xffff0000, v67
v_mul_f32 v51, v51, v112
v_mfma_f32_16x16x32_bf16 v[28:31], v[236:239], a[8:11], v[28:31]
v_mul_f32 v114, v114, v112
v_mul_f32 v51, v51, v115
v_mfma_f32_16x16x32_bf16 v[28:31], v[220:223], a[4:7], v[28:31]
s_waitcnt lgkmcnt(0)
v_mul_f32 v67, v67, v114
v_and_b32 v114, 0xffff0000, v52
v_mfma_f32_16x16x32_bf16 v[28:31], v[204:207], a[0:3], v[28:31]
v_lshlrev_b32 v115, 16, v68
v_lshlrev_b32 v52, 16, v52
v_mfma_f32_16x16x32_bf16 v[16:19], v[128:131], a[32:35], v[16:19]
s_nop 0
ds_read_b64_tr_b16 v[192:193], v8 offset:32768
ds_read_b64_tr_b16 v[194:195], v8 offset:34816
v_mfma_f32_16x16x32_bf16 v[16:19], v[144:147], a[36:39], v[16:19]
s_nop 0
ds_read_b64_tr_b16 v[196:197], v9 offset:32768
ds_read_b64_tr_b16 v[198:199], v9 offset:34816
v_mfma_f32_16x16x32_bf16 v[16:19], v[160:163], a[40:43], v[16:19]
buffer_store_dwordx4 v[92:95], v1, s[44:47], s80 offen offset:3072 sc1
v_mfma_f32_16x16x32_bf16 v[16:19], v[176:179], a[44:47], v[16:19]
v_and_b32 v68, 0xffff0000, v68
v_mul_f32 v52, v52, v112
v_mfma_f32_16x16x32_bf16 v[32:35], v[176:179], a[60:63], v[32:35]
s_nop 0
ds_read_b64_tr_b16 v[200:201], v10 offset:32768
ds_read_b64_tr_b16 v[202:203], v10 offset:34816
v_mfma_f32_16x16x32_bf16 v[32:35], v[160:163], a[56:59], v[32:35]
s_nop 0
ds_read_b64_tr_b16 v[204:205], v11 offset:32768
ds_read_b64_tr_b16 v[206:207], v11 offset:34816
v_mfma_f32_16x16x32_bf16 v[32:35], v[144:147], a[52:55], v[32:35]
v_mul_f32 v114, v114, v112
v_mul_f32 v52, v52, v115
v_mfma_f32_16x16x32_bf16 v[32:35], v[128:131], a[48:51], v[32:35]
s_nop 0
ds_read_b64_tr_b16 v[208:209], v8 offset:36864
ds_read_b64_tr_b16 v[210:211], v8 offset:38912
v_mfma_f32_16x16x32_bf16 v[36:39], v[132:135], a[48:51], v[36:39]
v_mul_f32 v68, v68, v114
v_and_b32 v114, 0xffff0000, v53
v_mfma_f32_16x16x32_bf16 v[36:39], v[148:151], a[52:55], v[36:39]
s_nop 0
ds_read_b64_tr_b16 v[212:213], v9 offset:36864
ds_read_b64_tr_b16 v[214:215], v9 offset:38912
v_mfma_f32_16x16x32_bf16 v[36:39], v[164:167], a[56:59], v[36:39]
s_nop 0
ds_read_b64_tr_b16 v[216:217], v10 offset:36864
ds_read_b64_tr_b16 v[218:219], v10 offset:38912
v_mfma_f32_16x16x32_bf16 v[36:39], v[180:183], a[60:63], v[36:39]
v_lshlrev_b32 v115, 16, v69
v_lshlrev_b32 v53, 16, v53
v_mfma_f32_16x16x32_bf16 v[20:23], v[180:183], a[44:47], v[20:23]
s_nop 0
ds_read_b64_tr_b16 v[220:221], v11 offset:36864
ds_read_b64_tr_b16 v[222:223], v11 offset:38912
v_mfma_f32_16x16x32_bf16 v[20:23], v[164:167], a[40:43], v[20:23]
v_and_b32 v69, 0xffff0000, v69
v_mul_f32 v53, v53, v112
v_mfma_f32_16x16x32_bf16 v[20:23], v[148:151], a[36:39], v[20:23]
s_nop 0
ds_read_b64_tr_b16 v[224:225], v8 offset:40960
ds_read_b64_tr_b16 v[226:227], v8 offset:43008
v_mfma_f32_16x16x32_bf16 v[20:23], v[132:135], a[32:35], v[20:23]
s_nop 0
ds_read_b64_tr_b16 v[228:229], v9 offset:40960
ds_read_b64_tr_b16 v[230:231], v9 offset:43008
v_mfma_f32_16x16x32_bf16 v[24:27], v[136:139], a[32:35], v[24:27]
v_mul_f32 v114, v114, v112
v_mul_f32 v53, v53, v115
v_mfma_f32_16x16x32_bf16 v[24:27], v[152:155], a[36:39], v[24:27]
s_nop 0
ds_read_b64_tr_b16 v[232:233], v10 offset:40960
ds_read_b64_tr_b16 v[234:235], v10 offset:43008
v_mfma_f32_16x16x32_bf16 v[24:27], v[168:171], a[40:43], v[24:27]
s_nop 0
ds_read_b64_tr_b16 v[236:237], v11 offset:40960
ds_read_b64_tr_b16 v[238:239], v11 offset:43008
v_mfma_f32_16x16x32_bf16 v[24:27], v[184:187], a[44:47], v[24:27]
v_mul_f32 v69, v69, v114
v_and_b32 v114, 0xffff0000, v54
v_mfma_f32_16x16x32_bf16 v[40:43], v[184:187], a[60:63], v[40:43]
s_nop 0
ds_read_b64_tr_b16 v[240:241], v8 offset:45056
ds_read_b64_tr_b16 v[242:243], v8 offset:47104
v_mfma_f32_16x16x32_bf16 v[40:43], v[168:171], a[56:59], v[40:43]
v_lshlrev_b32 v115, 16, v70
v_lshlrev_b32 v54, 16, v54
v_mfma_f32_16x16x32_bf16 v[40:43], v[152:155], a[52:55], v[40:43]
s_nop 0
ds_read_b64_tr_b16 v[244:245], v9 offset:45056
ds_read_b64_tr_b16 v[246:247], v9 offset:47104
v_mfma_f32_16x16x32_bf16 v[40:43], v[136:139], a[48:51], v[40:43]
s_nop 0
ds_read_b64_tr_b16 v[248:249], v10 offset:45056
ds_read_b64_tr_b16 v[250:251], v10 offset:47104
v_mfma_f32_16x16x32_bf16 v[44:47], v[140:143], a[48:51], v[44:47]
v_and_b32 v70, 0xffff0000, v70
v_mul_f32 v54, v54, v112
v_mfma_f32_16x16x32_bf16 v[44:47], v[156:159], a[52:55], v[44:47]
s_nop 0
ds_read_b64_tr_b16 v[252:253], v11 offset:45056
ds_read_b64_tr_b16 v[254:255], v11 offset:47104
v_mfma_f32_16x16x32_bf16 v[44:47], v[172:175], a[56:59], v[44:47]
v_mul_f32 v114, v114, v112
v_mul_f32 v54, v54, v115
v_mfma_f32_16x16x32_bf16 v[44:47], v[188:191], a[60:63], v[44:47]
v_mul_f32 v70, v70, v114
v_and_b32 v114, 0xffff0000, v55
v_mfma_f32_16x16x32_bf16 v[28:31], v[188:191], a[44:47], v[28:31]
v_lshlrev_b32 v115, 16, v71
v_lshlrev_b32 v55, 16, v55
v_mfma_f32_16x16x32_bf16 v[28:31], v[172:175], a[40:43], v[28:31]
s_add_u32 s79, s93, 0x3a00000
v_and_b32 v71, 0xffff0000, v71
v_mul_f32 v55, v55, v112
v_mfma_f32_16x16x32_bf16 v[28:31], v[156:159], a[36:39], v[28:31]
s_waitcnt vmcnt(18) lgkmcnt(0)
buffer_load_dwordx4 v[96:99], v1, s[44:47], s79 offen sc1
v_mfma_f32_16x16x32_bf16 v[28:31], v[140:143], a[32:35], v[28:31]
s_barrier
v_mul_f32 v114, v114, v112
v_mul_f32 v55, v55, v115
v_mfma_f32_16x16x32_bf16 v[16:19], v[192:195], a[64:67], v[16:19]
s_nop 0
ds_read_b64_tr_b16 v[128:129], v8 offset:49152
ds_read_b64_tr_b16 v[130:131], v8 offset:51200
v_mfma_f32_16x16x32_bf16 v[16:19], v[208:211], a[68:71], v[16:19]
s_nop 0
ds_read_b64_tr_b16 v[132:133], v9 offset:49152
ds_read_b64_tr_b16 v[134:135], v9 offset:51200
v_mfma_f32_16x16x32_bf16 v[16:19], v[224:227], a[72:75], v[16:19]
v_mul_f32 v71, v71, v114
v_and_b32 v114, 0xffff0000, v56
v_mfma_f32_16x16x32_bf16 v[16:19], v[240:243], a[76:79], v[16:19]
buffer_load_dwordx4 v[100:103], v1, s[44:47], s79 offen offset:1024 sc1
v_mfma_f32_16x16x32_bf16 v[32:35], v[240:243], a[92:95], v[32:35]
s_nop 0
ds_read_b64_tr_b16 v[136:137], v10 offset:49152
ds_read_b64_tr_b16 v[138:139], v10 offset:51200
v_mfma_f32_16x16x32_bf16 v[32:35], v[224:227], a[88:91], v[32:35]
s_nop 0
ds_read_b64_tr_b16 v[140:141], v11 offset:49152
ds_read_b64_tr_b16 v[142:143], v11 offset:51200
v_mfma_f32_16x16x32_bf16 v[32:35], v[208:211], a[84:87], v[32:35]
v_lshlrev_b32 v115, 16, v72
v_lshlrev_b32 v56, 16, v56
v_mfma_f32_16x16x32_bf16 v[32:35], v[192:195], a[80:83], v[32:35]
s_nop 0
ds_read_b64_tr_b16 v[144:145], v8 offset:53248
ds_read_b64_tr_b16 v[146:147], v8 offset:55296
v_mfma_f32_16x16x32_bf16 v[36:39], v[196:199], a[80:83], v[36:39]
buffer_load_dwordx4 v[104:107], v1, s[44:47], s79 offen offset:2048 sc1
v_mfma_f32_16x16x32_bf16 v[36:39], v[212:215], a[84:87], v[36:39]
s_nop 0
ds_read_b64_tr_b16 v[148:149], v9 offset:53248
ds_read_b64_tr_b16 v[150:151], v9 offset:55296
v_mfma_f32_16x16x32_bf16 v[36:39], v[228:231], a[88:91], v[36:39]
v_and_b32 v72, 0xffff0000, v72
v_mul_f32 v56, v56, v113
v_mfma_f32_16x16x32_bf16 v[36:39], v[244:247], a[92:95], v[36:39]
s_nop 0
ds_read_b64_tr_b16 v[152:153], v10 offset:53248
ds_read_b64_tr_b16 v[154:155], v10 offset:55296
v_mfma_f32_16x16x32_bf16 v[20:23], v[244:247], a[76:79], v[20:23]
s_nop 0
ds_read_b64_tr_b16 v[156:157], v11 offset:53248
ds_read_b64_tr_b16 v[158:159], v11 offset:55296
v_mfma_f32_16x16x32_bf16 v[20:23], v[228:231], a[72:75], v[20:23]
buffer_load_dwordx4 v[108:111], v1, s[44:47], s79 offen offset:3072 sc1
v_mfma_f32_16x16x32_bf16 v[20:23], v[212:215], a[68:71], v[20:23]
v_mul_f32 v114, v114, v113
v_mul_f32 v56, v56, v115
v_mfma_f32_16x16x32_bf16 v[20:23], v[196:199], a[64:67], v[20:23]
s_nop 0
ds_read_b64_tr_b16 v[160:161], v8 offset:57344
ds_read_b64_tr_b16 v[162:163], v8 offset:59392
v_mfma_f32_16x16x32_bf16 v[24:27], v[200:203], a[64:67], v[24:27]
s_nop 0
ds_read_b64_tr_b16 v[164:165], v9 offset:57344
ds_read_b64_tr_b16 v[166:167], v9 offset:59392
v_mfma_f32_16x16x32_bf16 v[24:27], v[216:219], a[68:71], v[24:27]
v_mul_f32 v72, v72, v114
v_and_b32 v114, 0xffff0000, v57
v_mfma_f32_16x16x32_bf16 v[24:27], v[232:235], a[72:75], v[24:27]
s_nop 0
ds_read_b64_tr_b16 v[168:169], v10 offset:57344
ds_read_b64_tr_b16 v[170:171], v10 offset:59392
v_mfma_f32_16x16x32_bf16 v[24:27], v[248:251], a[76:79], v[24:27]
s_nop 0
ds_read_b64_tr_b16 v[172:173], v11 offset:57344
ds_read_b64_tr_b16 v[174:175], v11 offset:59392
v_mfma_f32_16x16x32_bf16 v[40:43], v[248:251], a[92:95], v[40:43]
v_lshlrev_b32 v115, 16, v73
v_lshlrev_b32 v57, 16, v57
v_mfma_f32_16x16x32_bf16 v[40:43], v[232:235], a[88:91], v[40:43]
s_nop 0
ds_read_b64_tr_b16 v[176:177], v8 offset:61440
ds_read_b64_tr_b16 v[178:179], v8 offset:63488
v_mfma_f32_16x16x32_bf16 v[40:43], v[216:219], a[84:87], v[40:43]
s_nop 0
ds_read_b64_tr_b16 v[180:181], v9 offset:61440
ds_read_b64_tr_b16 v[182:183], v9 offset:63488
v_mfma_f32_16x16x32_bf16 v[40:43], v[200:203], a[80:83], v[40:43]
v_and_b32 v73, 0xffff0000, v73
v_mul_f32 v57, v57, v113
v_mfma_f32_16x16x32_bf16 v[44:47], v[204:207], a[80:83], v[44:47]
s_nop 0
ds_read_b64_tr_b16 v[184:185], v10 offset:61440
ds_read_b64_tr_b16 v[186:187], v10 offset:63488
v_mfma_f32_16x16x32_bf16 v[44:47], v[220:223], a[84:87], v[44:47]
s_nop 0
ds_read_b64_tr_b16 v[188:189], v11 offset:61440
ds_read_b64_tr_b16 v[190:191], v11 offset:63488
v_mfma_f32_16x16x32_bf16 v[44:47], v[236:239], a[88:91], v[44:47]
v_mul_f32 v114, v114, v113
v_mul_f32 v57, v57, v115
v_mfma_f32_16x16x32_bf16 v[44:47], v[252:255], a[92:95], v[44:47]
v_mul_f32 v73, v73, v114
v_and_b32 v114, 0xffff0000, v58
v_mfma_f32_16x16x32_bf16 v[28:31], v[252:255], a[76:79], v[28:31]
v_xor_b32 v8, 0x10000, v8
v_lshlrev_b32 v115, 16, v74
v_mfma_f32_16x16x32_bf16 v[28:31], v[236:239], a[72:75], v[28:31]
v_xor_b32 v9, 0x10000, v9
v_lshlrev_b32 v58, 16, v58
v_mfma_f32_16x16x32_bf16 v[28:31], v[220:223], a[68:71], v[28:31]
s_waitcnt lgkmcnt(0)
v_xor_b32 v10, 0x10000, v10
v_and_b32 v74, 0xffff0000, v74
v_mfma_f32_16x16x32_bf16 v[28:31], v[204:207], a[64:67], v[28:31]
v_xor_b32 v11, 0x10000, v11
v_mul_f32 v58, v58, v113
v_mfma_f32_16x16x32_bf16 v[16:19], v[128:131], a[96:99], v[16:19]
s_nop 0
ds_read_b64_tr_b16 v[192:193], v8 offset:0
ds_read_b64_tr_b16 v[194:195], v8 offset:2048
v_mfma_f32_16x16x32_bf16 v[16:19], v[144:147], a[100:103], v[16:19]
s_nop 0
ds_read_b64_tr_b16 v[196:197], v9 offset:0
ds_read_b64_tr_b16 v[198:199], v9 offset:2048
v_mfma_f32_16x16x32_bf16 v[16:19], v[160:163], a[104:107], v[16:19]
v_mul_f32 v114, v114, v113
v_mul_f32 v58, v58, v115
v_mfma_f32_16x16x32_bf16 v[16:19], v[176:179], a[108:111], v[16:19]
s_nop 0
ds_read_b64_tr_b16 v[200:201], v10 offset:0
ds_read_b64_tr_b16 v[202:203], v10 offset:2048
v_mfma_f32_16x16x32_bf16 v[32:35], v[176:179], a[124:127], v[32:35]
v_mul_f32 v74, v74, v114
v_and_b32 v114, 0xffff0000, v59
v_mfma_f32_16x16x32_bf16 v[32:35], v[160:163], a[120:123], v[32:35]
s_nop 0
ds_read_b64_tr_b16 v[204:205], v11 offset:0
ds_read_b64_tr_b16 v[206:207], v11 offset:2048
v_mfma_f32_16x16x32_bf16 v[32:35], v[144:147], a[116:119], v[32:35]
s_nop 0
ds_read_b64_tr_b16 v[208:209], v8 offset:4096
ds_read_b64_tr_b16 v[210:211], v8 offset:6144
v_mfma_f32_16x16x32_bf16 v[32:35], v[128:131], a[112:115], v[32:35]
v_lshlrev_b32 v115, 16, v75
v_lshlrev_b32 v59, 16, v59
v_mfma_f32_16x16x32_bf16 v[36:39], v[132:135], a[112:115], v[36:39]
s_nop 0
ds_read_b64_tr_b16 v[212:213], v9 offset:4096
ds_read_b64_tr_b16 v[214:215], v9 offset:6144
v_mfma_f32_16x16x32_bf16 v[36:39], v[148:151], a[116:119], v[36:39]
v_and_b32 v75, 0xffff0000, v75
v_mul_f32 v59, v59, v113
v_mfma_f32_16x16x32_bf16 v[36:39], v[164:167], a[120:123], v[36:39]
s_nop 0
ds_read_b64_tr_b16 v[216:217], v10 offset:4096
ds_read_b64_tr_b16 v[218:219], v10 offset:6144
v_mfma_f32_16x16x32_bf16 v[36:39], v[180:183], a[124:127], v[36:39]
s_nop 0
ds_read_b64_tr_b16 v[220:221], v11 offset:4096
ds_read_b64_tr_b16 v[222:223], v11 offset:6144
v_mfma_f32_16x16x32_bf16 v[20:23], v[180:183], a[108:111], v[20:23]
v_mul_f32 v114, v114, v113
v_mul_f32 v59, v59, v115
v_mfma_f32_16x16x32_bf16 v[20:23], v[164:167], a[104:107], v[20:23]
s_nop 0
ds_read_b64_tr_b16 v[224:225], v8 offset:8192
ds_read_b64_tr_b16 v[226:227], v8 offset:10240
v_mfma_f32_16x16x32_bf16 v[20:23], v[148:151], a[100:103], v[20:23]
v_mul_f32 v75, v75, v114
v_and_b32 v114, 0xffff0000, v60
v_mfma_f32_16x16x32_bf16 v[20:23], v[132:135], a[96:99], v[20:23]
s_nop 0
ds_read_b64_tr_b16 v[228:229], v9 offset:8192
ds_read_b64_tr_b16 v[230:231], v9 offset:10240
v_mfma_f32_16x16x32_bf16 v[24:27], v[136:139], a[96:99], v[24:27]
s_nop 0
ds_read_b64_tr_b16 v[232:233], v10 offset:8192
ds_read_b64_tr_b16 v[234:235], v10 offset:10240
v_mfma_f32_16x16x32_bf16 v[24:27], v[152:155], a[100:103], v[24:27]
v_lshlrev_b32 v115, 16, v76
v_lshlrev_b32 v60, 16, v60
v_mfma_f32_16x16x32_bf16 v[24:27], v[168:171], a[104:107], v[24:27]
s_nop 0
ds_read_b64_tr_b16 v[236:237], v11 offset:8192
ds_read_b64_tr_b16 v[238:239], v11 offset:10240
v_mfma_f32_16x16x32_bf16 v[24:27], v[184:187], a[108:111], v[24:27]
v_and_b32 v76, 0xffff0000, v76
v_mul_f32 v60, v60, v113
v_mfma_f32_16x16x32_bf16 v[40:43], v[184:187], a[124:127], v[40:43]
s_nop 0
ds_read_b64_tr_b16 v[240:241], v8 offset:12288
ds_read_b64_tr_b16 v[242:243], v8 offset:14336
v_mfma_f32_16x16x32_bf16 v[40:43], v[168:171], a[120:123], v[40:43]
s_nop 0
ds_read_b64_tr_b16 v[244:245], v9 offset:12288
ds_read_b64_tr_b16 v[246:247], v9 offset:14336
v_mfma_f32_16x16x32_bf16 v[40:43], v[152:155], a[116:119], v[40:43]
Lstube5:
s_cbranch_execz Lrete
v_mul_f32 v114, v114, v113
v_mul_f32 v60, v60, v115
v_mfma_f32_16x16x32_bf16 v[40:43], v[136:139], a[112:115], v[40:43]
s_nop 0
ds_read_b64_tr_b16 v[248:249], v10 offset:12288
ds_read_b64_tr_b16 v[250:251], v10 offset:14336
v_mfma_f32_16x16x32_bf16 v[44:47], v[140:143], a[112:115], v[44:47]
v_mul_f32 v76, v76, v114
v_and_b32 v114, 0xffff0000, v61
v_mfma_f32_16x16x32_bf16 v[44:47], v[156:159], a[116:119], v[44:47]
s_nop 0
ds_read_b64_tr_b16 v[252:253], v11 offset:12288
ds_read_b64_tr_b16 v[254:255], v11 offset:14336
v_mfma_f32_16x16x32_bf16 v[44:47], v[172:175], a[120:123], v[44:47]
v_lshlrev_b32 v115, 16, v77
v_lshlrev_b32 v61, 16, v61
v_mfma_f32_16x16x32_bf16 v[44:47], v[188:191], a[124:127], v[44:47]
s_waitcnt vmcnt(0)
v_max3_u32 v12, v96, v97, v98
v_max3_u32 v13, v99, v100, v101
v_mfma_f32_16x16x32_bf16 v[28:31], v[188:191], a[108:111], v[28:31]
v_max3_u32 v12, v12, v102, v103
v_max3_u32 v13, v13, v104, v105
v_mfma_f32_16x16x32_bf16 v[28:31], v[172:175], a[104:107], v[28:31]
v_max3_u32 v12, v12, v106, v107
v_max3_u32 v13, v13, v108, v109
v_mfma_f32_16x16x32_bf16 v[28:31], v[156:159], a[100:103], v[28:31]
s_waitcnt vmcnt(12) lgkmcnt(0)
v_max3_u32 v12, v12, v110, v111
v_and_b32 v77, 0xffff0000, v77
v_mfma_f32_16x16x32_bf16 v[28:31], v[140:143], a[96:99], v[28:31]
s_barrier
v_max_u32 v12, v12, v13
v_mul_f32 v61, v61, v113
v_mfma_f32_16x16x32_bf16 v[16:19], v[192:195], a[128:131], v[16:19]
v_cmp_le_u32 vcc, 0xff800000, v12
v_mul_f32 v114, v114, v113
v_mfma_f32_16x16x32_bf16 v[16:19], v[208:211], a[132:135], v[16:19]
s_nop 0
ds_read_b64_tr_b16 v[128:129], v8 offset:16384
ds_read_b64_tr_b16 v[130:131], v8 offset:18432
v_mfma_f32_16x16x32_bf16 v[16:19], v[224:227], a[136:139], v[16:19]
s_cbranch_vccnz Lxspin1
Lxback1:
ds_read_b64_tr_b16 v[132:133], v9 offset:16384
ds_read_b64_tr_b16 v[134:135], v9 offset:18432
v_mfma_f32_16x16x32_bf16 v[16:19], v[240:243], a[140:143], v[16:19]
v_mul_f32 v61, v61, v115
v_mul_f32 v77, v77, v114
v_mfma_f32_16x16x32_bf16 v[16:19], v[124:127], v[96:99], v[16:19]
s_nop 0
ds_read_b64_tr_b16 v[136:137], v10 offset:16384
ds_read_b64_tr_b16 v[138:139], v10 offset:18432
v_mfma_f32_16x16x32_bf16 v[32:35], v[240:243], a[156:159], v[32:35]
v_and_b32 v114, 0xffff0000, v62
v_lshlrev_b32 v115, 16, v78
v_mfma_f32_16x16x32_bf16 v[32:35], v[224:227], a[152:155], v[32:35]
s_add_u32 s82, s93, 0x3e00000
buffer_load_dwordx4 v[80:83], v1, s[44:47], s82 offen sc1
v_mfma_f32_16x16x32_bf16 v[32:35], v[208:211], a[148:151], v[32:35]
s_nop 0
ds_read_b64_tr_b16 v[140:141], v11 offset:16384
ds_read_b64_tr_b16 v[142:143], v11 offset:18432
v_mfma_f32_16x16x32_bf16 v[32:35], v[192:195], a[144:147], v[32:35]
v_lshlrev_b32 v62, 16, v62
v_and_b32 v78, 0xffff0000, v78
v_mfma_f32_16x16x32_bf16 v[32:35], v[124:127], v[104:107], v[32:35]
s_nop 0
ds_read_b64_tr_b16 v[144:145], v8 offset:20480
ds_read_b64_tr_b16 v[146:147], v8 offset:22528
v_mfma_f32_16x16x32_bf16 v[36:39], v[196:199], a[144:147], v[36:39]
v_mul_f32 v62, v62, v113
v_mul_f32 v114, v114, v113
v_mfma_f32_16x16x32_bf16 v[36:39], v[212:215], a[148:151], v[36:39]
buffer_load_dwordx4 v[84:87], v1, s[44:47], s82 offen offset:1024 sc1
v_mfma_f32_16x16x32_bf16 v[36:39], v[228:231], a[152:155], v[36:39]
s_nop 0
ds_read_b64_tr_b16 v[148:149], v9 offset:20480
ds_read_b64_tr_b16 v[150:151], v9 offset:22528
v_mfma_f32_16x16x32_bf16 v[36:39], v[244:247], a[156:159], v[36:39]
v_mul_f32 v62, v62, v115
v_mul_f32 v78, v78, v114
v_mfma_f32_16x16x32_bf16 v[36:39], v[120:123], v[104:107], v[36:39]
s_nop 0
ds_read_b64_tr_b16 v[152:153], v10 offset:20480
ds_read_b64_tr_b16 v[154:155], v10 offset:22528
v_mfma_f32_16x16x32_bf16 v[20:23], v[244:247], a[140:143], v[20:23]
v_and_b32 v114, 0xffff0000, v63
v_lshlrev_b32 v115, 16, v79
v_mfma_f32_16x16x32_bf16 v[20:23], v[228:231], a[136:139], v[20:23]
buffer_load_dwordx4 v[88:91], v1, s[44:47], s82 offen offset:2048 sc1
v_mfma_f32_16x16x32_bf16 v[20:23], v[212:215], a[132:135], v[20:23]
s_nop 0
ds_read_b64_tr_b16 v[156:157], v11 offset:20480
ds_read_b64_tr_b16 v[158:159], v11 offset:22528
v_mfma_f32_16x16x32_bf16 v[20:23], v[196:199], a[128:131], v[20:23]
v_lshlrev_b32 v63, 16, v63
v_and_b32 v79, 0xffff0000, v79
v_mfma_f32_16x16x32_bf16 v[20:23], v[120:123], v[96:99], v[20:23]
s_nop 0
ds_read_b64_tr_b16 v[160:161], v8 offset:24576
ds_read_b64_tr_b16 v[162:163], v8 offset:26624
v_mfma_f32_16x16x32_bf16 v[24:27], v[200:203], a[128:131], v[24:27]
s_nop 0
ds_read_b64_tr_b16 v[164:165], v9 offset:24576
ds_read_b64_tr_b16 v[166:167], v9 offset:26624
v_mfma_f32_16x16x32_bf16 v[24:27], v[216:219], a[132:135], v[24:27]
buffer_load_dwordx4 v[92:95], v1, s[44:47], s82 offen offset:3072 sc1
v_mfma_f32_16x16x32_bf16 v[24:27], v[232:235], a[136:139], v[24:27]
v_mul_f32 v63, v63, v113
v_mul_f32 v114, v114, v113
v_mfma_f32_16x16x32_bf16 v[24:27], v[248:251], a[140:143], v[24:27]
s_nop 0
ds_read_b64_tr_b16 v[168:169], v10 offset:24576
ds_read_b64_tr_b16 v[170:171], v10 offset:26624
v_mfma_f32_16x16x32_bf16 v[24:27], v[124:127], v[100:103], v[24:27]
v_mul_f32 v63, v63, v115
v_mul_f32 v79, v79, v114
v_mfma_f32_16x16x32_bf16 v[40:43], v[248:251], a[156:159], v[40:43]
s_nop 0
ds_read_b64_tr_b16 v[172:173], v11 offset:24576
ds_read_b64_tr_b16 v[174:175], v11 offset:26624
v_mfma_f32_16x16x32_bf16 v[40:43], v[232:235], a[152:155], v[40:43]
v_mfma_f32_16x16x32_bf16 v[40:43], v[216:219], a[148:151], v[40:43]
s_nop 0
ds_read_b64_tr_b16 v[176:177], v8 offset:28672
ds_read_b64_tr_b16 v[178:179], v8 offset:30720
v_mfma_f32_16x16x32_bf16 v[40:43], v[200:203], a[144:147], v[40:43]
v_mfma_f32_16x16x32_bf16 v[40:43], v[124:127], v[108:111], v[40:43]
s_nop 0
ds_read_b64_tr_b16 v[180:181], v9 offset:28672
ds_read_b64_tr_b16 v[182:183], v9 offset:30720
v_mfma_f32_16x16x32_bf16 v[44:47], v[204:207], a[144:147], v[44:47]
v_mfma_f32_16x16x32_bf16 v[44:47], v[220:223], a[148:151], v[44:47]
s_nop 0
ds_read_b64_tr_b16 v[184:185], v10 offset:28672
ds_read_b64_tr_b16 v[186:187], v10 offset:30720
v_mfma_f32_16x16x32_bf16 v[44:47], v[236:239], a[152:155], v[44:47]
v_mfma_f32_16x16x32_bf16 v[44:47], v[252:255], a[156:159], v[44:47]
s_nop 0
ds_read_b64_tr_b16 v[188:189], v11 offset:28672
ds_read_b64_tr_b16 v[190:191], v11 offset:30720
v_mfma_f32_16x16x32_bf16 v[44:47], v[120:123], v[108:111], v[44:47]
v_mfma_f32_16x16x32_bf16 v[28:31], v[252:255], a[140:143], v[28:31]
v_mfma_f32_16x16x32_bf16 v[28:31], v[236:239], a[136:139], v[28:31]
v_mfma_f32_16x16x32_bf16 v[28:31], v[220:223], a[132:135], v[28:31]
v_mfma_f32_16x16x32_bf16 v[28:31], v[204:207], a[128:131], v[28:31]
s_waitcnt lgkmcnt(0)
v_mfma_f32_16x16x32_bf16 v[28:31], v[120:123], v[100:103], v[28:31]
v_mfma_f32_16x16x32_bf16 v[16:19], v[128:131], a[160:163], v[16:19]
s_nop 0
ds_read_b64_tr_b16 v[192:193], v8 offset:32768
ds_read_b64_tr_b16 v[194:195], v8 offset:34816
v_mfma_f32_16x16x32_bf16 v[16:19], v[144:147], a[164:167], v[16:19]
s_nop 0
ds_read_b64_tr_b16 v[196:197], v9 offset:32768
ds_read_b64_tr_b16 v[198:199], v9 offset:34816
v_mfma_f32_16x16x32_bf16 v[16:19], v[160:163], a[168:171], v[16:19]
s_nop 0
ds_read_b64_tr_b16 v[200:201], v10 offset:32768
ds_read_b64_tr_b16 v[202:203], v10 offset:34816
v_mfma_f32_16x16x32_bf16 v[16:19], v[176:179], a[172:175], v[16:19]
v_mfma_f32_16x16x32_bf16 v[32:35], v[176:179], a[188:191], v[32:35]
s_nop 0
ds_read_b64_tr_b16 v[204:205], v11 offset:32768
ds_read_b64_tr_b16 v[206:207], v11 offset:34816
v_mfma_f32_16x16x32_bf16 v[32:35], v[160:163], a[184:187], v[32:35]
s_nop 0
ds_read_b64_tr_b16 v[208:209], v8 offset:36864
ds_read_b64_tr_b16 v[210:211], v8 offset:38912
v_mfma_f32_16x16x32_bf16 v[32:35], v[144:147], a[180:183], v[32:35]
s_add_u32 s81, s93, 0x4200000
buffer_load_dwordx4 v[96:99], v1, s[44:47], s81 offen sc1
v_mfma_f32_16x16x32_bf16 v[32:35], v[128:131], a[176:179], v[32:35]
v_mfma_f32_16x16x32_bf16 v[36:39], v[132:135], a[176:179], v[36:39]
s_nop 0
ds_read_b64_tr_b16 v[212:213], v9 offset:36864
ds_read_b64_tr_b16 v[214:215], v9 offset:38912
v_mfma_f32_16x16x32_bf16 v[36:39], v[148:151], a[180:183], v[36:39]
s_nop 0
ds_read_b64_tr_b16 v[216:217], v10 offset:36864
ds_read_b64_tr_b16 v[218:219], v10 offset:38912
v_mfma_f32_16x16x32_bf16 v[36:39], v[164:167], a[184:187], v[36:39]
v_mfma_f32_16x16x32_bf16 v[36:39], v[180:183], a[188:191], v[36:39]
buffer_load_dwordx4 v[100:103], v1, s[44:47], s81 offen offset:1024 sc1
v_mfma_f32_16x16x32_bf16 v[20:23], v[180:183], a[172:175], v[20:23]
s_nop 0
ds_read_b64_tr_b16 v[220:221], v11 offset:36864
ds_read_b64_tr_b16 v[222:223], v11 offset:38912
v_mfma_f32_16x16x32_bf16 v[20:23], v[164:167], a[168:171], v[20:23]
s_nop 0
ds_read_b64_tr_b16 v[224:225], v8 offset:40960
ds_read_b64_tr_b16 v[226:227], v8 offset:43008
v_mfma_f32_16x16x32_bf16 v[20:23], v[148:151], a[164:167], v[20:23]
s_nop 0
ds_read_b64_tr_b16 v[228:229], v9 offset:40960
ds_read_b64_tr_b16 v[230:231], v9 offset:43008
v_mfma_f32_16x16x32_bf16 v[20:23], v[132:135], a[160:163], v[20:23]
v_mfma_f32_16x16x32_bf16 v[24:27], v[136:139], a[160:163], v[24:27]
buffer_load_dwordx4 v[104:107], v1, s[44:47], s81 offen offset:2048 sc1
v_mfma_f32_16x16x32_bf16 v[24:27], v[152:155], a[164:167], v[24:27]
s_nop 0
ds_read_b64_tr_b16 v[232:233], v10 offset:40960
ds_read_b64_tr_b16 v[234:235], v10 offset:43008
v_mfma_f32_16x16x32_bf16 v[24:27], v[168:171], a[168:171], v[24:27]
s_nop 0
ds_read_b64_tr_b16 v[236:237], v11 offset:40960
ds_read_b64_tr_b16 v[238:239], v11 offset:43008
v_mfma_f32_16x16x32_bf16 v[24:27], v[184:187], a[172:175], v[24:27]
v_mfma_f32_16x16x32_bf16 v[40:43], v[184:187], a[188:191], v[40:43]
s_nop 0
ds_read_b64_tr_b16 v[240:241], v8 offset:45056
ds_read_b64_tr_b16 v[242:243], v8 offset:47104
v_mfma_f32_16x16x32_bf16 v[40:43], v[168:171], a[184:187], v[40:43]
buffer_load_dwordx4 v[108:111], v1, s[44:47], s81 offen offset:3072 sc1
v_mfma_f32_16x16x32_bf16 v[40:43], v[152:155], a[180:183], v[40:43]
s_nop 0
ds_read_b64_tr_b16 v[244:245], v9 offset:45056
ds_read_b64_tr_b16 v[246:247], v9 offset:47104
v_mfma_f32_16x16x32_bf16 v[40:43], v[136:139], a[176:179], v[40:43]
v_mfma_f32_16x16x32_bf16 v[44:47], v[140:143], a[176:179], v[44:47]
s_nop 0
ds_read_b64_tr_b16 v[248:249], v10 offset:45056
ds_read_b64_tr_b16 v[250:251], v10 offset:47104
v_mfma_f32_16x16x32_bf16 v[44:47], v[156:159], a[180:183], v[44:47]
s_nop 0
ds_read_b64_tr_b16 v[252:253], v11 offset:45056
ds_read_b64_tr_b16 v[254:255], v11 offset:47104
v_mfma_f32_16x16x32_bf16 v[44:47], v[172:175], a[184:187], v[44:47]
v_mfma_f32_16x16x32_bf16 v[44:47], v[188:191], a[188:191], v[44:47]
s_waitcnt vmcnt(4)
v_max3_u32 v12, v80, v81, v82
v_max3_u32 v13, v83, v84, v85
v_mfma_f32_16x16x32_bf16 v[28:31], v[188:191], a[172:175], v[28:31]
v_max3_u32 v12, v12, v86, v87
v_max3_u32 v13, v13, v88, v89
v_mfma_f32_16x16x32_bf16 v[28:31], v[172:175], a[168:171], v[28:31]
v_max3_u32 v12, v12, v90, v91
v_max3_u32 v13, v13, v92, v93
v_mfma_f32_16x16x32_bf16 v[28:31], v[156:159], a[164:167], v[28:31]
s_waitcnt vmcnt(14) lgkmcnt(0)
v_max3_u32 v12, v12, v94, v95
v_mfma_f32_16x16x32_bf16 v[28:31], v[140:143], a[160:163], v[28:31]
s_barrier
v_max_u32 v12, v12, v13
v_mfma_f32_16x16x32_bf16 v[16:19], v[192:195], a[192:195], v[16:19]
v_cmp_le_u32 vcc, 0xff800000, v12
v_mfma_f32_16x16x32_bf16 v[16:19], v[208:211], a[196:199], v[16:19]
s_nop 0
ds_read_b64_tr_b16 v[128:129], v8 offset:49152
ds_read_b64_tr_b16 v[130:131], v8 offset:51200
v_mfma_f32_16x16x32_bf16 v[16:19], v[224:227], a[200:203], v[16:19]
s_cbranch_vccnz Lxspin2
Lxback2:
v_mfma_f32_16x16x32_bf16 v[16:19], v[240:243], a[204:207], v[16:19]
s_nop 0
ds_read_b64_tr_b16 v[132:133], v9 offset:49152
ds_read_b64_tr_b16 v[134:135], v9 offset:51200
v_mfma_f32_16x16x32_bf16 v[16:19], v[124:127], v[80:83], v[16:19]
v_mfma_f32_16x16x32_bf16 v[32:35], v[240:243], a[220:223], v[32:35]
s_nop 0
ds_read_b64_tr_b16 v[136:137], v10 offset:49152
ds_read_b64_tr_b16 v[138:139], v10 offset:51200
v_mfma_f32_16x16x32_bf16 v[32:35], v[224:227], a[216:219], v[32:35]
v_mfma_f32_16x16x32_bf16 v[32:35], v[208:211], a[212:215], v[32:35]
s_nop 0
ds_read_b64_tr_b16 v[140:141], v11 offset:49152
ds_read_b64_tr_b16 v[142:143], v11 offset:51200
v_mfma_f32_16x16x32_bf16 v[32:35], v[192:195], a[208:211], v[32:35]
v_mfma_f32_16x16x32_bf16 v[32:35], v[124:127], v[88:91], v[32:35]
s_nop 0
ds_read_b64_tr_b16 v[144:145], v8 offset:53248
ds_read_b64_tr_b16 v[146:147], v8 offset:55296
v_mfma_f32_16x16x32_bf16 v[36:39], v[196:199], a[208:211], v[36:39]
v_mfma_f32_16x16x32_bf16 v[36:39], v[212:215], a[212:215], v[36:39]
s_nop 0
ds_read_b64_tr_b16 v[148:149], v9 offset:53248
ds_read_b64_tr_b16 v[150:151], v9 offset:55296
v_mfma_f32_16x16x32_bf16 v[36:39], v[228:231], a[216:219], v[36:39]
v_mfma_f32_16x16x32_bf16 v[36:39], v[244:247], a[220:223], v[36:39]
s_nop 0
ds_read_b64_tr_b16 v[152:153], v10 offset:53248
ds_read_b64_tr_b16 v[154:155], v10 offset:55296
v_mfma_f32_16x16x32_bf16 v[36:39], v[120:123], v[88:91], v[36:39]
v_mfma_f32_16x16x32_bf16 v[20:23], v[244:247], a[204:207], v[20:23]
s_nop 0
ds_read_b64_tr_b16 v[156:157], v11 offset:53248
ds_read_b64_tr_b16 v[158:159], v11 offset:55296
v_mfma_f32_16x16x32_bf16 v[20:23], v[228:231], a[200:203], v[20:23]
v_mfma_f32_16x16x32_bf16 v[20:23], v[212:215], a[196:199], v[20:23]
v_mfma_f32_16x16x32_bf16 v[20:23], v[196:199], a[192:195], v[20:23]
s_nop 0
ds_read_b64_tr_b16 v[160:161], v8 offset:57344
ds_read_b64_tr_b16 v[162:163], v8 offset:59392
v_mfma_f32_16x16x32_bf16 v[20:23], v[120:123], v[80:83], v[20:23]
v_mfma_f32_16x16x32_bf16 v[24:27], v[200:203], a[192:195], v[24:27]
s_nop 0
ds_read_b64_tr_b16 v[164:165], v9 offset:57344
ds_read_b64_tr_b16 v[166:167], v9 offset:59392
v_mfma_f32_16x16x32_bf16 v[24:27], v[216:219], a[196:199], v[24:27]
v_mfma_f32_16x16x32_bf16 v[24:27], v[232:235], a[200:203], v[24:27]
s_nop 0
ds_read_b64_tr_b16 v[168:169], v10 offset:57344
ds_read_b64_tr_b16 v[170:171], v10 offset:59392
v_mfma_f32_16x16x32_bf16 v[24:27], v[248:251], a[204:207], v[24:27]
v_mfma_f32_16x16x32_bf16 v[24:27], v[124:127], v[84:87], v[24:27]
s_nop 0
ds_read_b64_tr_b16 v[172:173], v11 offset:57344
ds_read_b64_tr_b16 v[174:175], v11 offset:59392
v_mfma_f32_16x16x32_bf16 v[40:43], v[248:251], a[220:223], v[40:43]
v_mfma_f32_16x16x32_bf16 v[40:43], v[232:235], a[216:219], v[40:43]
s_nop 0
ds_read_b64_tr_b16 v[176:177], v8 offset:61440
ds_read_b64_tr_b16 v[178:179], v8 offset:63488
v_mfma_f32_16x16x32_bf16 v[40:43], v[216:219], a[212:215], v[40:43]
v_mfma_f32_16x16x32_bf16 v[40:43], v[200:203], a[208:211], v[40:43]
s_nop 0
ds_read_b64_tr_b16 v[180:181], v9 offset:61440
ds_read_b64_tr_b16 v[182:183], v9 offset:63488
v_mfma_f32_16x16x32_bf16 v[40:43], v[124:127], v[92:95], v[40:43]
v_mfma_f32_16x16x32_bf16 v[44:47], v[204:207], a[208:211], v[44:47]
s_nop 0
ds_read_b64_tr_b16 v[184:185], v10 offset:61440
ds_read_b64_tr_b16 v[186:187], v10 offset:63488
v_mfma_f32_16x16x32_bf16 v[44:47], v[220:223], a[212:215], v[44:47]
v_mfma_f32_16x16x32_bf16 v[44:47], v[236:239], a[216:219], v[44:47]
s_nop 0
ds_read_b64_tr_b16 v[188:189], v11 offset:61440
ds_read_b64_tr_b16 v[190:191], v11 offset:63488
v_mfma_f32_16x16x32_bf16 v[44:47], v[252:255], a[220:223], v[44:47]
v_mfma_f32_16x16x32_bf16 v[44:47], v[120:123], v[92:95], v[44:47]
v_mfma_f32_16x16x32_bf16 v[28:31], v[252:255], a[204:207], v[28:31]
s_waitcnt vmcnt(0)
v_max3_u32 v12, v96, v97, v98
v_max3_u32 v13, v99, v100, v101
v_mfma_f32_16x16x32_bf16 v[28:31], v[236:239], a[200:203], v[28:31]
v_max3_u32 v12, v12, v102, v103
v_max3_u32 v13, v13, v104, v105
v_mfma_f32_16x16x32_bf16 v[28:31], v[220:223], a[196:199], v[28:31]
v_max3_u32 v12, v12, v106, v107
v_max3_u32 v13, v13, v108, v109
v_mfma_f32_16x16x32_bf16 v[28:31], v[204:207], a[192:195], v[28:31]
s_waitcnt lgkmcnt(0)
v_max3_u32 v12, v12, v110, v111
v_mfma_f32_16x16x32_bf16 v[28:31], v[120:123], v[84:87], v[28:31]
v_max_u32 v12, v12, v13
v_mfma_f32_16x16x32_bf16 v[16:19], v[128:131], a[224:227], v[16:19]
v_cmp_le_u32 vcc, 0xff800000, v12
v_mfma_f32_16x16x32_bf16 v[16:19], v[144:147], a[228:231], v[16:19]
v_mfma_f32_16x16x32_bf16 v[16:19], v[160:163], a[232:235], v[16:19]
s_cbranch_vccnz Lxspin3
Lxback3:
v_mfma_f32_16x16x32_bf16 v[16:19], v[176:179], a[236:239], v[16:19]
v_mfma_f32_16x16x32_bf16 v[16:19], v[124:127], v[96:99], v[16:19]
v_mfma_f32_16x16x32_bf16 v[20:23], v[180:183], a[236:239], v[20:23]
v_mfma_f32_16x16x32_bf16 v[20:23], v[164:167], a[232:235], v[20:23]
v_mfma_f32_16x16x32_bf16 v[20:23], v[148:151], a[228:231], v[20:23]
v_mfma_f32_16x16x32_bf16 v[20:23], v[132:135], a[224:227], v[20:23]
s_nop 3
v_fma_f32 v16, v16, v6, v48
v_fma_f32 v17, v17, v6, v64
v_mfma_f32_16x16x32_bf16 v[20:23], v[120:123], v[96:99], v[20:23]
v_fma_f32 v18, v18, v6, v49
v_fma_f32 v19, v19, v6, v65
v_mfma_f32_16x16x32_bf16 v[24:27], v[136:139], a[224:227], v[24:27]
v_cvt_pk_bf16_f32 v16, v16, v17
v_cvt_pk_bf16_f32 v17, v18, v19
v_mfma_f32_16x16x32_bf16 v[24:27], v[152:155], a[228:231], v[24:27]
ds_write_b64 v116, v[16:17] offset:0
v_mfma_f32_16x16x32_bf16 v[24:27], v[168:171], a[232:235], v[24:27]
v_mfma_f32_16x16x32_bf16 v[24:27], v[184:187], a[236:239], v[24:27]
v_fma_f32 v20, v20, v6, v50
v_fma_f32 v21, v21, v6, v66
v_mfma_f32_16x16x32_bf16 v[24:27], v[124:127], v[100:103], v[24:27]
v_fma_f32 v22, v22, v6, v51
v_fma_f32 v23, v23, v6, v67
v_mfma_f32_16x16x32_bf16 v[28:31], v[188:191], a[236:239], v[28:31]
v_cvt_pk_bf16_f32 v20, v20, v21
v_cvt_pk_bf16_f32 v21, v22, v23
v_mfma_f32_16x16x32_bf16 v[28:31], v[172:175], a[232:235], v[28:31]
ds_write_b64 v117, v[20:21] offset:0
v_mfma_f32_16x16x32_bf16 v[28:31], v[156:159], a[228:231], v[28:31]
v_mfma_f32_16x16x32_bf16 v[28:31], v[140:143], a[224:227], v[28:31]
v_fma_f32 v24, v24, v6, v52
v_fma_f32 v25, v25, v6, v68
v_mfma_f32_16x16x32_bf16 v[28:31], v[120:123], v[100:103], v[28:31]
v_fma_f32 v26, v26, v6, v53
v_fma_f32 v27, v27, v6, v69
v_mfma_f32_16x16x32_bf16 v[32:35], v[128:131], a[240:243], v[32:35]
v_cvt_pk_bf16_f32 v24, v24, v25
v_cvt_pk_bf16_f32 v25, v26, v27
v_mfma_f32_16x16x32_bf16 v[32:35], v[144:147], a[244:247], v[32:35]
ds_write_b64 v118, v[24:25] offset:0
v_mfma_f32_16x16x32_bf16 v[32:35], v[160:163], a[248:251], v[32:35]
v_mfma_f32_16x16x32_bf16 v[32:35], v[176:179], a[252:255], v[32:35]
v_fma_f32 v28, v28, v6, v54
v_fma_f32 v29, v29, v6, v70
v_mfma_f32_16x16x32_bf16 v[32:35], v[124:127], v[104:107], v[32:35]
v_fma_f32 v30, v30, v6, v55
v_fma_f32 v31, v31, v6, v71
v_mfma_f32_16x16x32_bf16 v[36:39], v[180:183], a[252:255], v[36:39]
v_cvt_pk_bf16_f32 v28, v28, v29
v_cvt_pk_bf16_f32 v29, v30, v31
v_mfma_f32_16x16x32_bf16 v[36:39], v[164:167], a[248:251], v[36:39]
s_nop 0
ds_write_b64 v119, v[28:29] offset:0
ds_read_b128 v[192:195], v4 offset:0
v_mfma_f32_16x16x32_bf16 v[36:39], v[148:151], a[244:247], v[36:39]
ds_read_b128 v[196:199], v4 offset:1024
v_mfma_f32_16x16x32_bf16 v[36:39], v[132:135], a[240:243], v[36:39]
v_fma_f32 v32, v32, v7, v56
v_fma_f32 v33, v33, v7, v72
v_mfma_f32_16x16x32_bf16 v[36:39], v[120:123], v[104:107], v[36:39]
v_fma_f32 v34, v34, v7, v57
v_fma_f32 v35, v35, v7, v73
v_mfma_f32_16x16x32_bf16 v[40:43], v[136:139], a[240:243], v[40:43]
v_cvt_pk_bf16_f32 v32, v32, v33
v_cvt_pk_bf16_f32 v33, v34, v35
v_mfma_f32_16x16x32_bf16 v[40:43], v[152:155], a[244:247], v[40:43]
ds_write_b64 v116, v[32:33] offset:2048
v_mfma_f32_16x16x32_bf16 v[40:43], v[168:171], a[248:251], v[40:43]
s_waitcnt lgkmcnt(2)
buffer_store_dwordx4 v[192:195], v15, s[40:43], s70 offen sc1
v_mfma_f32_16x16x32_bf16 v[40:43], v[184:187], a[252:255], v[40:43]
s_add_u32 s70, s70, 0x4000
v_mfma_f32_16x16x32_bf16 v[40:43], v[124:127], v[108:111], v[40:43]
v_fma_f32 v36, v36, v7, v58
v_fma_f32 v37, v37, v7, v74
v_mfma_f32_16x16x32_bf16 v[44:47], v[188:191], a[252:255], v[44:47]
v_fma_f32 v38, v38, v7, v59
v_fma_f32 v39, v39, v7, v75
v_mfma_f32_16x16x32_bf16 v[44:47], v[172:175], a[248:251], v[44:47]
v_cvt_pk_bf16_f32 v36, v36, v37
v_cvt_pk_bf16_f32 v37, v38, v39
v_mfma_f32_16x16x32_bf16 v[44:47], v[156:159], a[244:247], v[44:47]
ds_write_b64 v117, v[36:37] offset:2048
v_mfma_f32_16x16x32_bf16 v[44:47], v[140:143], a[240:243], v[44:47]
v_fma_f32 v40, v40, v7, v60
v_fma_f32 v41, v41, v7, v76
v_mfma_f32_16x16x32_bf16 v[44:47], v[120:123], v[108:111], v[44:47]
v_fma_f32 v42, v42, v7, v61
v_fma_f32 v43, v43, v7, v77
v_cvt_pk_bf16_f32 v40, v40, v41
v_cvt_pk_bf16_f32 v41, v42, v43
ds_write_b64 v118, v[40:41] offset:2048
s_waitcnt lgkmcnt(3)
buffer_store_dwordx4 v[196:199], v15, s[40:43], s70 offen sc1
s_add_u32 s70, s70, 0x4000
v_fma_f32 v44, v44, v7, v62
v_fma_f32 v45, v45, v7, v78
v_fma_f32 v46, v46, v7, v63
v_fma_f32 v47, v47, v7, v79
v_cvt_pk_bf16_f32 v44, v44, v45
v_cvt_pk_bf16_f32 v45, v46, v47
ds_write_b64 v119, v[44:45] offset:2048
ds_read_b128 v[200:203], v4 offset:2048
ds_read_b128 v[204:207], v4 offset:3072
s_waitcnt lgkmcnt(1)
buffer_store_dwordx4 v[200:203], v15, s[40:43], s70 offen sc1
s_add_u32 s70, s70, 0x4000
s_waitcnt lgkmcnt(0)
buffer_store_dwordx4 v[204:207], v15, s[40:43], s70 offen sc1
s_add_u32 s70, s70, 0x4000
Lend:
s_endpgm
Lspin1:
s_mov_b32 s83, 262144
Lsl3:
s_sleep 2
buffer_load_dword v3, v2, s[48:51], 0 offen sc1
s_sub_u32 s83, s83, 1
s_cmp_eq_u32 s83, 0
s_waitcnt vmcnt(0)
s_cbranch_scc1 Lback2
v_cmp_gt_u32 vcc, 8, v3
s_cbranch_vccnz Lsl3
s_branch Lback2
Lspin4:
s_mov_b32 s83, 262144
Lsl6:
s_sleep 2
buffer_load_dword v3, v2, s[44:47], s75 offen sc1
s_sub_u32 s83, s83, 1
s_cmp_eq_u32 s83, 0
s_waitcnt vmcnt(0)
s_cbranch_scc1 Lback5
v_cmp_gt_u32 vcc, 1, v3
s_cbranch_vccnz Lsl6
s_branch Lback5
.p2align 12
s_endpgm
.p2align 7
LP0x:
Lstub10:
s_cbranch_execz Lret
s_cmp_eq_u32 s58, 2
s_cbranch_scc1 Lta10
s_cmp_eq_u32 s58, 3
s_cbranch_scc1 Lnt11
v_mfma_f32_16x16x32_bf16 v[160:163], a[160:163], v[16:19], v[112:115]
s_xor_b32 s74, s82, 0x10000
v_exp_f32 v128, v128
v_mfma_f32_16x16x32_bf16 v[176:179], a[176:179], v[16:19], v[112:115]
s_add_u32 s74, s74, s64
ds_read_b128 a[128:131], v2 offset:16384
ds_read_b128 a[132:135], v2 offset:17408
s_branch Ljoin12
Lta10:
v_mfma_f32_16x16x32_bf16 v[160:163], a[160:163], v[16:19], v[96:99]
s_xor_b32 s74, s82, 0x10000
v_exp_f32 v128, v128
v_mfma_f32_16x16x32_bf16 v[176:179], a[176:179], v[16:19], v[112:115]
s_add_u32 s74, s74, s64
ds_read_b128 a[128:131], v2 offset:16384
ds_read_b128 a[132:135], v2 offset:17408
s_branch Ljoin12
Lnt11:
v_mfma_f32_16x16x32_bf16 v[160:163], a[160:163], v[16:19], v[80:83]
s_xor_b32 s74, s82, 0x10000
v_exp_f32 v128, v128
v_mfma_f32_16x16x32_bf16 v[176:179], a[176:179], v[16:19], v[96:99]
s_add_u32 s74, s74, s64
ds_read_b128 a[128:131], v2 offset:16384
ds_read_b128 a[132:135], v2 offset:17408
Ljoin12:
v_mfma_f32_16x16x32_bf16 v[164:167], a[160:163], v[32:35], v[84:87]
s_add_u32 s81, s81, 0x8000
v_exp_f32 v129, v129
v_mfma_f32_16x16x32_bf16 v[164:167], a[164:167], v[36:39], v[164:167]
s_add_u32 m0, s74, 16384
v_exp_f32 v130, v130
v_mfma_f32_16x16x32_bf16 v[164:167], a[168:171], v[40:43], v[164:167]
s_add_u32 s72, s81, 16384
v_exp_f32 v131, v131
v_mfma_f32_16x16x32_bf16 v[164:167], a[172:175], v[44:47], v[164:167]
v_exp_f32 v144, v144
v_mfma_f32_16x16x32_bf16 v[172:175], a[172:175], v[76:79], v[92:95]
s_nop 0
ds_read_b128 a[136:139], v2 offset:18432
ds_read_b128 a[140:143], v2 offset:19456
v_mfma_f32_16x16x32_bf16 v[172:175], a[168:171], v[72:75], v[172:175]
s_nop 0
ds_read_b128 a[144:147], v2 offset:20480
ds_read_b128 a[148:151], v2 offset:21504
v_mfma_f32_16x16x32_bf16 v[172:175], a[164:167], v[68:71], v[172:175]
s_nop 0
ds_read_b128 a[152:155], v2 offset:22528
ds_read_b128 a[156:159], v2 offset:23552
v_mfma_f32_16x16x32_bf16 v[172:175], a[160:163], v[64:67], v[172:175]
s_nop 0
ds_read_b128 a[192:195], v2 offset:0
ds_read_b128 a[196:199], v2 offset:1024
v_mfma_f32_16x16x32_bf16 v[188:191], a[176:179], v[64:67], v[92:95]
s_nop 0
ds_read_b128 a[200:203], v2 offset:2048
ds_read_b128 a[204:207], v2 offset:3072
v_mfma_f32_16x16x32_bf16 v[188:191], a[180:183], v[68:71], v[188:191]
s_nop 0
ds_read_b128 a[208:211], v2 offset:4096
ds_read_b128 a[212:215], v2 offset:5120
v_mfma_f32_16x16x32_bf16 v[188:191], a[184:187], v[72:75], v[188:191]
s_nop 0
ds_read_b128 a[216:219], v2 offset:6144
ds_read_b128 a[220:223], v2 offset:7168
v_mfma_f32_16x16x32_bf16 v[188:191], a[188:191], v[76:79], v[188:191]
v_cvt_pk_bf16_f32 v192, v128, v129
v_cvt_pk_bf16_f32 v193, v130, v131
v_mfma_f32_16x16x32_bf16 v[180:183], a[188:191], v[44:47], v[84:87]
buffer_load_dwordx4 v1, s[44:47], s72 offen sc1 lds
v_mfma_f32_16x16x32_bf16 v[180:183], a[184:187], v[40:43], v[180:183]
v_exp_f32 v145, v145
v_mfma_f32_16x16x32_bf16 v[180:183], a[180:183], v[36:39], v[180:183]
v_exp_f32 v146, v146
v_mfma_f32_16x16x32_bf16 v[180:183], a[176:179], v[32:35], v[180:183]
v_exp_f32 v147, v147
v_mfma_f32_16x16x32_bf16 v[160:163], a[164:167], v[20:23], v[160:163]
v_exp_f32 v136, v136
v_mfma_f32_16x16x32_bf16 v[160:163], a[168:171], v[24:27], v[160:163]
v_cvt_pk_bf16_f32 v194, v144, v145
v_cvt_pk_bf16_f32 v195, v146, v147
v_mfma_f32_16x16x32_bf16 v[160:163], a[172:175], v[28:31], v[160:163]
v_exp_f32 v137, v137
v_mfma_f32_16x16x32_bf16 v[168:171], a[172:175], v[60:63], v[88:91]
v_exp_f32 v138, v138
v_mfma_f32_16x16x32_bf16 v[168:171], a[168:171], v[56:59], v[168:171]
v_exp_f32 v139, v139
v_mfma_f32_16x16x32_bf16 v[168:171], a[164:167], v[52:55], v[168:171]
v_exp_f32 v152, v152
v_mfma_f32_16x16x32_bf16 v[168:171], a[160:163], v[48:51], v[168:171]
v_cvt_pk_bf16_f32 v200, v136, v137
v_cvt_pk_bf16_f32 v201, v138, v139
v_mfma_f32_16x16x32_bf16 v[184:187], a[176:179], v[48:51], v[88:91]
buffer_load_dwordx4 v1, s[44:47], s72 offen offset:1024 sc1 lds
v_mfma_f32_16x16x32_bf16 v[184:187], a[180:183], v[52:55], v[184:187]
v_exp_f32 v153, v153
v_mfma_f32_16x16x32_bf16 v[184:187], a[184:187], v[56:59], v[184:187]
v_exp_f32 v154, v154
v_mfma_f32_16x16x32_bf16 v[184:187], a[188:191], v[60:63], v[184:187]
v_exp_f32 v155, v155
v_mfma_f32_16x16x32_bf16 v[176:179], a[188:191], v[28:31], v[176:179]
buffer_load_dwordx4 v1, s[44:47], s72 offen offset:2048 sc1 lds
v_mfma_f32_16x16x32_bf16 v[176:179], a[184:187], v[24:27], v[176:179]
buffer_load_dwordx4 v1, s[44:47], s72 offen offset:3072 sc1 lds
v_mfma_f32_16x16x32_bf16 v[176:179], a[180:183], v[20:23], v[176:179]
s_waitcnt lgkmcnt(4)
v_exp_f32 v132, v132
v_cvt_pk_bf16_f32 v202, v152, v153
v_cvt_pk_bf16_f32 v203, v154, v155
v_exp_f32 v133, v133
v_exp_f32 v134, v134
v_cvt_pk_bf16_f32 v196, v132, v133
v_exp_f32 v135, v135
v_exp_f32 v148, v148
v_cvt_pk_bf16_f32 v197, v134, v135
v_exp_f32 v149, v149
v_exp_f32 v150, v150
v_cvt_pk_bf16_f32 v198, v148, v149
v_exp_f32 v151, v151
v_exp_f32 v140, v140
v_cvt_pk_bf16_f32 v199, v150, v151
v_exp_f32 v141, v141
v_exp_f32 v142, v142
v_cvt_pk_bf16_f32 v204, v140, v141
v_exp_f32 v143, v143
v_exp_f32 v156, v156
v_cvt_pk_bf16_f32 v205, v142, v143
v_exp_f32 v157, v157
v_exp_f32 v158, v158
v_cvt_pk_bf16_f32 v206, v156, v157
v_exp_f32 v159, v159
s_nop 0
v_cvt_pk_bf16_f32 v207, v158, v159
v_mfma_f32_16x16x32_bf16 v[224:227], v[120:123], v[192:195], 0
s_add_u32 s82, s82, 0x8000
ds_read_b128 a[160:163], v2 offset:24576
ds_read_b128 a[164:167], v2 offset:25600
v_mfma_f32_16x16x32_bf16 v[232:235], v[120:123], v[200:203], 0
s_and_b32 s82, s82, 0x1ffff
v_exp_f32 v164, v164
v_mfma_f32_16x16x32_bf16 a[0:3], a[192:195], v[192:195], 0
s_add_u32 m0, s74, 0
v_exp_f32 v165, v165
v_mfma_f32_16x16x32_bf16 a[64:67], a[192:195], v[200:203], 0
s_add_u32 s72, s81, 0
v_exp_f32 v166, v166
v_mfma_f32_16x16x32_bf16 a[68:71], a[196:199], v[200:203], 0
buffer_load_dwordx4 v1, s[44:47], s72 offen sc1 lds
v_mfma_f32_16x16x32_bf16 a[4:7], a[196:199], v[192:195], 0
v_exp_f32 v167, v167
v_mfma_f32_16x16x32_bf16 a[8:11], a[200:203], v[192:195], 0
s_nop 0
ds_read_b128 a[168:171], v2 offset:26624
ds_read_b128 a[172:175], v2 offset:27648
v_mfma_f32_16x16x32_bf16 a[72:75], a[200:203], v[200:203], 0
v_exp_f32 v180, v180
v_mfma_f32_16x16x32_bf16 a[76:79], a[204:207], v[200:203], 0
s_nop 0
ds_read_b128 a[176:179], v2 offset:28672
ds_read_b128 a[180:183], v2 offset:29696
v_mfma_f32_16x16x32_bf16 a[12:15], a[204:207], v[192:195], 0
s_waitcnt lgkmcnt(6)
ds_read_b128 a[184:187], v2 offset:30720
ds_read_b128 a[188:191], v2 offset:31744
v_mfma_f32_16x16x32_bf16 a[16:19], a[208:211], v[192:195], 0
s_nop 0
ds_read_b128 a[224:227], v2 offset:8192
ds_read_b128 a[228:231], v2 offset:9216
v_mfma_f32_16x16x32_bf16 a[80:83], a[208:211], v[200:203], 0
s_nop 0
ds_read_b128 a[232:235], v2 offset:10240
ds_read_b128 a[236:239], v2 offset:11264
v_mfma_f32_16x16x32_bf16 a[84:87], a[212:215], v[200:203], 0
s_nop 0
ds_read_b128 a[240:243], v2 offset:12288
ds_read_b128 a[244:247], v2 offset:13312
v_mfma_f32_16x16x32_bf16 a[20:23], a[212:215], v[192:195], 0
s_nop 0
ds_read_b128 a[248:251], v2 offset:14336
ds_read_b128 a[252:255], v2 offset:15360
v_mfma_f32_16x16x32_bf16 a[24:27], a[216:219], v[192:195], 0
v_cvt_pk_bf16_f32 v212, v164, v165
v_cvt_pk_bf16_f32 v213, v166, v167
v_mfma_f32_16x16x32_bf16 a[88:91], a[216:219], v[200:203], 0
v_exp_f32 v181, v181
v_mfma_f32_16x16x32_bf16 a[92:95], a[220:223], v[200:203], 0
v_exp_f32 v182, v182
v_mfma_f32_16x16x32_bf16 a[28:31], a[220:223], v[192:195], 0
buffer_load_dwordx4 v1, s[44:47], s72 offen offset:1024 sc1 lds
s_cmp_eq_u32 s58, 0
s_cbranch_scc1 Lta13
s_cmp_eq_u32 s58, 1
s_cbranch_scc1 Lnt14
v_mfma_f32_16x16x32_bf16 v[132:135], a[128:131], v[32:35], v[84:87]
v_exp_f32 v183, v183
v_mfma_f32_16x16x32_bf16 v[148:151], a[144:147], v[32:35], v[84:87]
v_exp_f32 v172, v172
s_branch Ljoin15
Lta13:
v_mfma_f32_16x16x32_bf16 v[132:135], a[128:131], v[32:35], v[100:103]
v_exp_f32 v183, v183
v_mfma_f32_16x16x32_bf16 v[148:151], a[144:147], v[32:35], v[112:115]
v_exp_f32 v172, v172
s_branch Ljoin15
Lnt14:
v_mfma_f32_16x16x32_bf16 v[132:135], a[128:131], v[32:35], v[84:87]
v_exp_f32 v183, v183
v_mfma_f32_16x16x32_bf16 v[148:151], a[144:147], v[32:35], v[100:103]
v_exp_f32 v172, v172
Ljoin15:
v_mfma_f32_16x16x32_bf16 v[136:139], a[128:131], v[48:51], v[88:91]
v_cvt_pk_bf16_f32 v214, v180, v181
v_cvt_pk_bf16_f32 v215, v182, v183
v_mfma_f32_16x16x32_bf16 v[136:139], a[132:135], v[52:55], v[136:139]
v_exp_f32 v173, v173
v_mfma_f32_16x16x32_bf16 v[136:139], a[136:139], v[56:59], v[136:139]
buffer_load_dwordx4 v1, s[44:47], s72 offen offset:2048 sc1 lds
v_mfma_f32_16x16x32_bf16 v[136:139], a[140:143], v[60:63], v[136:139]
v_exp_f32 v174, v174
v_mfma_f32_16x16x32_bf16 v[152:155], a[156:159], v[60:63], v[88:91]
v_exp_f32 v175, v175
v_mfma_f32_16x16x32_bf16 v[152:155], a[152:155], v[56:59], v[152:155]
v_exp_f32 v188, v188
v_mfma_f32_16x16x32_bf16 v[152:155], a[148:151], v[52:55], v[152:155]
v_cvt_pk_bf16_f32 v220, v172, v173
v_cvt_pk_bf16_f32 v221, v174, v175
v_mfma_f32_16x16x32_bf16 v[152:155], a[144:147], v[48:51], v[152:155]
v_exp_f32 v189, v189
v_mfma_f32_16x16x32_bf16 v[132:135], a[132:135], v[36:39], v[132:135]
buffer_load_dwordx4 v1, s[44:47], s72 offen offset:3072 sc1 lds
v_mfma_f32_16x16x32_bf16 v[132:135], a[136:139], v[40:43], v[132:135]
s_add_u32 s66, s58, 1
v_exp_f32 v190, v190
v_mfma_f32_16x16x32_bf16 v[132:135], a[140:143], v[44:47], v[132:135]
s_and_b32 s66, s66, 3
v_exp_f32 v191, v191
v_mfma_f32_16x16x32_bf16 v[140:143], a[140:143], v[76:79], v[92:95]
s_mul_i32 s66, s66, 4160
v_exp_f32 v160, v160
v_mfma_f32_16x16x32_bf16 v[140:143], a[136:139], v[72:75], v[140:143]
s_add_u32 m0, s66, 131104
v_cvt_pk_bf16_f32 v222, v188, v189
v_cvt_pk_bf16_f32 v223, v190, v191
v_mfma_f32_16x16x32_bf16 v[140:143], a[132:135], v[68:71], v[140:143]
s_add_u32 s72, s93, 0x2
v_exp_f32 v161, v161
v_mfma_f32_16x16x32_bf16 v[140:143], a[128:131], v[64:67], v[140:143]
buffer_load_dwordx4 v1, s[36:39], s72 offen lds
v_mfma_f32_16x16x32_bf16 v[156:159], a[144:147], v[64:67], v[92:95]
v_exp_f32 v162, v162
v_mfma_f32_16x16x32_bf16 v[156:159], a[148:151], v[68:71], v[156:159]
v_exp_f32 v163, v163
v_mfma_f32_16x16x32_bf16 v[156:159], a[152:155], v[72:75], v[156:159]
buffer_load_dwordx4 v1, s[36:39], s72 offen offset:1024 lds
v_mfma_f32_16x16x32_bf16 v[156:159], a[156:159], v[76:79], v[156:159]
buffer_load_dwordx4 v1, s[36:39], s72 offen offset:2048 lds
v_mfma_f32_16x16x32_bf16 v[148:151], a[156:159], v[44:47], v[148:151]
buffer_load_dwordx4 v1, s[36:39], s72 offen offset:3072 lds
v_mfma_f32_16x16x32_bf16 v[148:151], a[152:155], v[40:43], v[148:151]
s_waitcnt vmcnt(12) lgkmcnt(4)
v_exp_f32 v176, v176
v_mfma_f32_16x16x32_bf16 v[148:151], a[148:151], v[36:39], v[148:151]
s_barrier
v_cvt_pk_bf16_f32 v208, v160, v161
v_cvt_pk_bf16_f32 v209, v162, v163
v_add_u32 v2, s82, v1
v_exp_f32 v177, v177
v_exp_f32 v178, v178
v_cvt_pk_bf16_f32 v210, v176, v177
v_exp_f32 v179, v179
v_exp_f32 v168, v168
v_cvt_pk_bf16_f32 v211, v178, v179
v_exp_f32 v169, v169
v_exp_f32 v170, v170
v_cvt_pk_bf16_f32 v216, v168, v169
v_exp_f32 v171, v171
v_exp_f32 v184, v184
v_cvt_pk_bf16_f32 v217, v170, v171
v_exp_f32 v185, v185
v_exp_f32 v186, v186
v_cvt_pk_bf16_f32 v218, v184, v185
v_exp_f32 v187, v187
s_nop 0
v_cvt_pk_bf16_f32 v219, v186, v187
s_branch LLT3
.p2align 12
s_endpgm
.p2align 7
LLT3x:
Lstub11:
s_cbranch_execz Lret
v_mfma_f32_16x16x32_bf16 v[228:231], v[120:123], v[196:199], v[228:231]
s_xor_b32 s74, s82, 0x10000
ds_read_b128 a[128:131], v2 offset:16384
v_and_b32 v240, 15, v0
v_mfma_f32_16x16x32_bf16 v[228:231], v[120:123], v[212:215], v[228:231]
s_add_u32 s74, s74, s64
v_exp_f32 v136, v136
v_mfma_f32_16x16x32_bf16 v[236:239], v[120:123], v[204:207], v[236:239]
s_add_u32 s81, s81, 0x8000
v_exp_f32 v137, v137
v_mfma_f32_16x16x32_bf16 v[236:239], v[120:123], v[220:223], v[236:239]
s_add_u32 m0, s74, 0
ds_read_b128 a[132:135], v2 offset:17408
v_cvt_pk_bf16_f32 v200, v136, v137
v_mfma_f32_16x16x32_bf16 a[32:35], a[192:195], v[196:199], a[32:35]
s_add_u32 s72, s81, 0
buffer_load_dwordx4 v1, s[44:47], s72 offen sc1 lds
v_mfma_f32_16x16x32_bf16 a[32:35], a[224:227], v[212:215], a[32:35]
s_add_u32 s69, s93, 0x3e00000
v_exp_f32 v138, v138
v_mfma_f32_16x16x32_bf16 a[96:99], a[224:227], v[220:223], a[96:99]
ds_read_b128 a[136:139], v2 offset:18432
v_lshrrev_b32 v241, 4, v0
v_mfma_f32_16x16x32_bf16 a[96:99], a[192:195], v[204:207], a[96:99]
v_exp_f32 v139, v139
v_mfma_f32_16x16x32_bf16 a[100:103], a[196:199], v[204:207], a[100:103]
buffer_store_dwordx4 v[112:115], v1, s[44:47], s69 offen sc1
v_mfma_f32_16x16x32_bf16 a[100:103], a[228:231], v[220:223], a[100:103]
v_exp_f32 v152, v152
v_mfma_f32_16x16x32_bf16 a[36:39], a[228:231], v[212:215], a[36:39]
ds_read_b128 a[140:143], v2 offset:19456
v_cvt_pk_bf16_f32 v201, v138, v139
v_mfma_f32_16x16x32_bf16 a[36:39], a[196:199], v[196:199], a[36:39]
v_exp_f32 v153, v153
v_mfma_f32_16x16x32_bf16 a[40:43], a[200:203], v[196:199], a[40:43]
buffer_load_dwordx4 v1, s[44:47], s72 offen offset:1024 sc1 lds
v_mfma_f32_16x16x32_bf16 a[40:43], a[232:235], v[212:215], a[40:43]
ds_read_b128 a[144:147], v2 offset:20480
v_cvt_pk_bf16_f32 v202, v152, v153
v_mfma_f32_16x16x32_bf16 a[104:107], a[232:235], v[220:223], a[104:107]
v_exp_f32 v154, v154
v_mfma_f32_16x16x32_bf16 a[104:107], a[200:203], v[204:207], a[104:107]
v_exp_f32 v155, v155
v_mfma_f32_16x16x32_bf16 a[108:111], a[204:207], v[204:207], a[108:111]
buffer_store_dwordx4 v[112:115], v1, s[44:47], s69 offen offset:1024 sc1
v_mfma_f32_16x16x32_bf16 a[108:111], a[236:239], v[220:223], a[108:111]
ds_read_b128 a[148:151], v2 offset:21504
v_cvt_pk_bf16_f32 v203, v154, v155
v_mfma_f32_16x16x32_bf16 a[44:47], a[236:239], v[212:215], a[44:47]
v_exp_f32 v132, v132
v_mfma_f32_16x16x32_bf16 a[44:47], a[204:207], v[196:199], a[44:47]
ds_read_b128 a[152:155], v2 offset:22528
v_add_u32 v248, 1, v240
v_mfma_f32_16x16x32_bf16 a[48:51], a[208:211], v[196:199], a[48:51]
s_waitcnt lgkmcnt(7)
v_exp_f32 v133, v133
v_mfma_f32_16x16x32_bf16 a[48:51], a[240:243], v[212:215], a[48:51]
buffer_load_dwordx4 v1, s[44:47], s72 offen offset:2048 sc1 lds
v_mfma_f32_16x16x32_bf16 a[112:115], a[240:243], v[220:223], a[112:115]
v_exp_f32 v134, v134
v_mfma_f32_16x16x32_bf16 a[112:115], a[208:211], v[204:207], a[112:115]
ds_read_b128 a[156:159], v2 offset:23552
v_and_b32 v249, 3, v248
v_mfma_f32_16x16x32_bf16 a[116:119], a[212:215], v[204:207], a[116:119]
v_exp_f32 v135, v135
v_mfma_f32_16x16x32_bf16 a[116:119], a[244:247], v[220:223], a[116:119]
buffer_store_dwordx4 v[112:115], v1, s[44:47], s69 offen offset:2048 sc1
v_mfma_f32_16x16x32_bf16 a[52:55], a[244:247], v[212:215], a[52:55]
ds_read_b128 a[192:195], v2 offset:0
v_lshrrev_b32 v248, 2, v248
v_mfma_f32_16x16x32_bf16 a[52:55], a[212:215], v[196:199], a[52:55]
v_exp_f32 v148, v148
v_mfma_f32_16x16x32_bf16 a[56:59], a[216:219], v[196:199], a[56:59]
buffer_load_dwordx4 v1, s[44:47], s72 offen offset:3072 sc1 lds
v_mfma_f32_16x16x32_bf16 a[56:59], a[248:251], v[212:215], a[56:59]
v_exp_f32 v149, v149
v_mfma_f32_16x16x32_bf16 a[120:123], a[248:251], v[220:223], a[120:123]
ds_read_b128 a[196:199], v2 offset:1024
v_mov_b32 v250, 0x20000
v_mfma_f32_16x16x32_bf16 a[120:123], a[216:219], v[204:207], a[120:123]
v_exp_f32 v150, v150
v_mfma_f32_16x16x32_bf16 a[124:127], a[220:223], v[204:207], a[124:127]
ds_read_b128 a[200:203], v2 offset:2048
v_mov_b32 v252, 0x20001
v_mfma_f32_16x16x32_bf16 a[124:127], a[252:255], v[220:223], a[124:127]
buffer_store_dwordx4 v[112:115], v1, s[44:47], s69 offen offset:3072 sc1
v_mfma_f32_16x16x32_bf16 a[60:63], a[252:255], v[212:215], a[60:63]
s_add_u32 s69, s93, 0x4200000
v_exp_f32 v151, v151
v_mfma_f32_16x16x32_bf16 a[60:63], a[220:223], v[196:199], a[60:63]
ds_read_b128 a[204:207], v2 offset:3072
v_cvt_pk_bf16_f32 v196, v132, v133
s_cmp_eq_u32 s58, 2
s_cbranch_scc1 Lta40
s_cmp_eq_u32 s58, 3
s_cbranch_scc1 Lnt41
v_mfma_f32_16x16x32_bf16 v[164:167], a[160:163], v[32:35], v[112:115]
ds_read_b128 a[208:211], v2 offset:4096
v_cvt_pk_bf16_f32 v197, v134, v135
v_mfma_f32_16x16x32_bf16 v[180:183], a[176:179], v[32:35], v[112:115]
v_exp_f32 v140, v140
s_branch Ljoin42
Lta40:
v_mfma_f32_16x16x32_bf16 v[164:167], a[160:163], v[32:35], v[100:103]
ds_read_b128 a[208:211], v2 offset:4096
v_cvt_pk_bf16_f32 v197, v134, v135
v_mfma_f32_16x16x32_bf16 v[180:183], a[176:179], v[32:35], v[112:115]
v_exp_f32 v140, v140
s_branch Ljoin42
Lnt41:
v_mfma_f32_16x16x32_bf16 v[164:167], a[160:163], v[32:35], v[84:87]
ds_read_b128 a[208:211], v2 offset:4096
v_cvt_pk_bf16_f32 v197, v134, v135
v_mfma_f32_16x16x32_bf16 v[180:183], a[176:179], v[32:35], v[100:103]
v_exp_f32 v140, v140
Ljoin42:
v_mfma_f32_16x16x32_bf16 v[164:167], a[164:167], v[36:39], v[164:167]
ds_read_b128 a[212:215], v2 offset:5120
v_cvt_pk_bf16_f32 v198, v148, v149
v_mfma_f32_16x16x32_bf16 v[164:167], a[168:171], v[40:43], v[164:167]
buffer_store_dwordx4 v[112:115], v1, s[44:47], s69 offen sc1
v_mfma_f32_16x16x32_bf16 v[164:167], a[172:175], v[44:47], v[164:167]
v_exp_f32 v141, v141
v_mfma_f32_16x16x32_bf16 v[172:175], a[172:175], v[76:79], v[92:95]
v_exp_f32 v142, v142
v_mfma_f32_16x16x32_bf16 v[172:175], a[168:171], v[72:75], v[172:175]
ds_read_b128 a[216:219], v2 offset:6144
v_cvt_pk_bf16_f32 v199, v150, v151
v_mfma_f32_16x16x32_bf16 v[172:175], a[164:167], v[68:71], v[172:175]
buffer_store_dwordx4 v[112:115], v1, s[44:47], s69 offen offset:1024 sc1
v_mfma_f32_16x16x32_bf16 v[172:175], a[160:163], v[64:67], v[172:175]
v_exp_f32 v143, v143
v_mfma_f32_16x16x32_bf16 v[188:191], a[176:179], v[64:67], v[92:95]
v_exp_f32 v156, v156
v_mfma_f32_16x16x32_bf16 v[188:191], a[180:183], v[68:71], v[188:191]
ds_read_b128 a[220:223], v2 offset:7168
v_cvt_pk_bf16_f32 v204, v140, v141
v_mfma_f32_16x16x32_bf16 v[188:191], a[184:187], v[72:75], v[188:191]
buffer_store_dwordx4 v[112:115], v1, s[44:47], s69 offen offset:2048 sc1
v_mfma_f32_16x16x32_bf16 v[188:191], a[188:191], v[76:79], v[188:191]
v_exp_f32 v157, v157
v_mfma_f32_16x16x32_bf16 v[180:183], a[188:191], v[44:47], v[180:183]
v_exp_f32 v158, v158
v_mfma_f32_16x16x32_bf16 v[180:183], a[184:187], v[40:43], v[180:183]
v_cvt_pk_bf16_f32 v205, v142, v143
v_cvt_pk_bf16_f32 v206, v156, v157
v_mfma_f32_16x16x32_bf16 v[180:183], a[180:183], v[36:39], v[180:183]
buffer_store_dwordx4 v[112:115], v1, s[44:47], s69 offen offset:3072 sc1
v_mfma_f32_16x16x32_bf16 v[168:171], a[160:163], v[48:51], v[88:91]
v_exp_f32 v159, v159
v_mfma_f32_16x16x32_bf16 v[168:171], a[164:167], v[52:55], v[168:171]
v_cvt_pk_bf16_f32 v207, v158, v159
v_lshlrev_b32 v6, 3, v249
v_mfma_f32_16x16x32_bf16 v[168:171], a[168:171], v[56:59], v[168:171]
v_lshrrev_b32 v6, v6, v252
v_and_b32 v6, 3, v6
v_mfma_f32_16x16x32_bf16 v[168:171], a[172:175], v[60:63], v[168:171]
v_cmp_ne_u32 vcc, 1, v249
v_mul_u32_u24 v6, 16640, v6
v_mfma_f32_16x16x32_bf16 v[184:187], a[188:191], v[60:63], v[88:91]
v_add_u32 v6, s92, v6
v_cndmask_b32 v6, v250, v6, vcc
v_mfma_f32_16x16x32_bf16 v[184:187], a[184:187], v[56:59], v[184:187]
v_add_u32 v253, s58, v249
v_and_b32 v253, 3, v253
v_mfma_f32_16x16x32_bf16 v[184:187], a[180:183], v[52:55], v[184:187]
s_waitcnt lgkmcnt(4)
v_mfma_f32_16x16x32_bf16 v[184:187], a[176:179], v[48:51], v[184:187]
s_barrier
s_lshr_b32 s69, s93, 4
s_and_b32 s69, s69, 0x7f00
s_add_u32 s69, s69, LHT4-Lpc0
v_lshrrev_b32 v3, 5, v0
v_lshlrev_b32 v3, 7, v3
v_add_u32 v3, s69, v3
v_min_u32 v3, Lcode_end-Lpc0, v3
global_load_dword v4, v3, s[98:99]
v_mfma_f32_16x16x32_bf16 v[224:227], v[120:123], v[208:211], v[224:227]
s_add_u32 s82, s82, 0x8000
ds_read_b128 a[160:163], v2 offset:24576
ds_read_b128 a[164:167], v2 offset:25600
v_mfma_f32_16x16x32_bf16 v[232:235], v[120:123], v[216:219], v[232:235]
s_and_b32 s82, s82, 0x1ffff
v_exp_f32 v164, v164
v_mfma_f32_16x16x32_bf16 v[232:235], v[120:123], v[200:203], v[232:235]
s_add_u32 s66, s58, 3
v_exp_f32 v165, v165
v_mfma_f32_16x16x32_bf16 a[0:3], a[224:227], v[208:211], a[0:3]
s_and_b32 s66, s66, 3
v_exp_f32 v166, v166
v_mfma_f32_16x16x32_bf16 a[64:67], a[192:195], v[200:203], a[64:67]
s_mul_i32 s66, s66, 4160
ds_read_b128 a[168:171], v2 offset:26624
v_cvt_pk_bf16_f32 v212, v164, v165
v_mfma_f32_16x16x32_bf16 a[64:67], a[224:227], v[216:219], a[64:67]
s_add_u32 s66, s66, s92
v_exp_f32 v167, v167
v_mfma_f32_16x16x32_bf16 a[68:71], a[228:231], v[216:219], a[68:71]
s_add_u32 m0, s66, 32
v_exp_f32 v180, v180
v_mfma_f32_16x16x32_bf16 a[68:71], a[196:199], v[200:203], a[68:71]
s_add_u32 s72, s93, 0x6
buffer_load_dwordx4 v1, s[36:39], s72 offen lds
v_mfma_f32_16x16x32_bf16 a[4:7], a[228:231], v[208:211], a[4:7]
ds_read_b128 a[172:175], v2 offset:27648
v_cvt_pk_bf16_f32 v213, v166, v167
v_mfma_f32_16x16x32_bf16 a[8:11], a[232:235], v[208:211], a[8:11]
v_exp_f32 v181, v181
v_mfma_f32_16x16x32_bf16 a[72:75], a[200:203], v[200:203], a[72:75]
ds_read_b128 a[176:179], v2 offset:28672
v_cvt_pk_bf16_f32 v214, v180, v181
v_mfma_f32_16x16x32_bf16 a[72:75], a[232:235], v[216:219], a[72:75]
v_exp_f32 v182, v182
v_mfma_f32_16x16x32_bf16 a[76:79], a[236:239], v[216:219], a[76:79]
v_exp_f32 v183, v183
v_mfma_f32_16x16x32_bf16 a[76:79], a[204:207], v[200:203], a[76:79]
ds_read_b128 a[180:183], v2 offset:29696
v_cvt_pk_bf16_f32 v215, v182, v183
v_mfma_f32_16x16x32_bf16 a[12:15], a[236:239], v[208:211], a[12:15]
v_exp_f32 v172, v172
v_mfma_f32_16x16x32_bf16 a[16:19], a[240:243], v[208:211], a[16:19]
s_waitcnt lgkmcnt(6)
ds_read_b128 a[184:187], v2 offset:30720
ds_read_b128 a[188:191], v2 offset:31744
v_mfma_f32_16x16x32_bf16 a[80:83], a[208:211], v[200:203], a[80:83]
v_exp_f32 v173, v173
v_mfma_f32_16x16x32_bf16 a[80:83], a[240:243], v[216:219], a[80:83]
buffer_load_dwordx4 v1, s[36:39], s72 offen offset:1024 lds
v_mfma_f32_16x16x32_bf16 a[84:87], a[244:247], v[216:219], a[84:87]
v_exp_f32 v174, v174
v_mfma_f32_16x16x32_bf16 a[84:87], a[212:215], v[200:203], a[84:87]
v_exp_f32 v175, v175
v_mfma_f32_16x16x32_bf16 a[20:23], a[244:247], v[208:211], a[20:23]
ds_read_b128 a[224:227], v2 offset:8192
v_cvt_pk_bf16_f32 v220, v172, v173
v_mfma_f32_16x16x32_bf16 a[24:27], a[248:251], v[208:211], a[24:27]
v_exp_f32 v188, v188
v_mfma_f32_16x16x32_bf16 a[88:91], a[216:219], v[200:203], a[88:91]
v_exp_f32 v189, v189
v_mfma_f32_16x16x32_bf16 a[88:91], a[248:251], v[216:219], a[88:91]
ds_read_b128 a[228:231], v2 offset:9216
v_cvt_pk_bf16_f32 v221, v174, v175
v_mfma_f32_16x16x32_bf16 a[92:95], a[252:255], v[216:219], a[92:95]
v_exp_f32 v190, v190
v_mfma_f32_16x16x32_bf16 a[92:95], a[220:223], v[200:203], a[92:95]
ds_read_b128 a[232:235], v2 offset:10240
v_cvt_pk_bf16_f32 v222, v188, v189
v_mfma_f32_16x16x32_bf16 a[28:31], a[252:255], v[208:211], a[28:31]
v_exp_f32 v191, v191
s_cmp_eq_u32 s58, 0
s_cbranch_scc1 Lta43
s_cmp_eq_u32 s58, 1
s_cbranch_scc1 Lnt44
v_mfma_f32_16x16x32_bf16 v[136:139], a[128:131], v[48:51], v[88:91]
buffer_load_dwordx4 v1, s[36:39], s72 offen offset:2048 lds
v_mfma_f32_16x16x32_bf16 v[152:155], a[144:147], v[48:51], v[88:91]
v_exp_f32 v168, v168
s_branch Ljoin45
Lta43:
v_mfma_f32_16x16x32_bf16 v[136:139], a[128:131], v[48:51], v[104:107]
buffer_load_dwordx4 v1, s[36:39], s72 offen offset:2048 lds
v_mfma_f32_16x16x32_bf16 v[152:155], a[144:147], v[48:51], v[112:115]
v_exp_f32 v168, v168
s_branch Ljoin45
Lnt44:
v_mfma_f32_16x16x32_bf16 v[136:139], a[128:131], v[48:51], v[88:91]
buffer_load_dwordx4 v1, s[36:39], s72 offen offset:2048 lds
v_mfma_f32_16x16x32_bf16 v[152:155], a[144:147], v[48:51], v[104:107]
v_exp_f32 v168, v168
Ljoin45:
v_mfma_f32_16x16x32_bf16 v[136:139], a[132:135], v[52:55], v[136:139]
ds_read_b128 a[236:239], v2 offset:11264
v_cvt_pk_bf16_f32 v223, v190, v191
v_mfma_f32_16x16x32_bf16 v[136:139], a[136:139], v[56:59], v[136:139]
v_exp_f32 v169, v169
v_mfma_f32_16x16x32_bf16 v[136:139], a[140:143], v[60:63], v[136:139]
ds_read_b128 a[240:243], v2 offset:12288
v_cvt_pk_bf16_f32 v216, v168, v169
v_mfma_f32_16x16x32_bf16 v[152:155], a[156:159], v[60:63], v[152:155]
v_exp_f32 v170, v170
v_mfma_f32_16x16x32_bf16 v[152:155], a[152:155], v[56:59], v[152:155]
v_exp_f32 v171, v171
v_mfma_f32_16x16x32_bf16 v[152:155], a[148:151], v[52:55], v[152:155]
ds_read_b128 a[244:247], v2 offset:13312
v_cvt_pk_bf16_f32 v217, v170, v171
v_mfma_f32_16x16x32_bf16 v[140:143], a[128:131], v[64:67], v[92:95]
v_exp_f32 v184, v184
v_mfma_f32_16x16x32_bf16 v[140:143], a[132:135], v[68:71], v[140:143]
ds_read_b128 a[248:251], v2 offset:14336
v_mfma_f32_16x16x32_bf16 v[140:143], a[136:139], v[72:75], v[140:143]
v_exp_f32 v185, v185
v_mfma_f32_16x16x32_bf16 v[140:143], a[140:143], v[76:79], v[140:143]
buffer_load_dwordx4 v1, s[36:39], s72 offen offset:3072 lds
v_mfma_f32_16x16x32_bf16 v[156:159], a[156:159], v[76:79], v[92:95]
ds_read_b128 a[252:255], v2 offset:15360
v_cvt_pk_bf16_f32 v218, v184, v185
v_mfma_f32_16x16x32_bf16 v[156:159], a[152:155], v[72:75], v[156:159]
v_exp_f32 v186, v186
v_mfma_f32_16x16x32_bf16 v[156:159], a[148:151], v[68:71], v[156:159]
s_waitcnt vmcnt(17) lgkmcnt(0)
v_exp_f32 v187, v187
v_mfma_f32_16x16x32_bf16 v[156:159], a[144:147], v[64:67], v[156:159]
s_barrier
v_cvt_pk_bf16_f32 v219, v186, v187
v_add_u32 v2, s82, v1
v_mfma_f32_16x16x32_bf16 v[228:231], v[120:123], v[196:199], v[228:231]
s_mov_b32 m0, s62
v_exp_f32 v136, v136
v_mfma_f32_16x16x32_bf16 v[228:231], v[120:123], v[212:215], v[228:231]
s_add_u32 s72, s93, 0x3000000
ds_read_b128 a[128:131], v2 offset:16384
v_mul_u32_u24 v253, 4160, v253
v_mfma_f32_16x16x32_bf16 v[236:239], v[120:123], v[204:207], v[236:239]
buffer_load_dwordx4 v1, s[44:47], s72 offen sc1 lds
v_mfma_f32_16x16x32_bf16 v[236:239], v[120:123], v[220:223], v[236:239]
v_exp_f32 v137, v137
v_mfma_f32_16x16x32_bf16 a[32:35], a[192:195], v[196:199], a[32:35]
ds_read_b128 a[132:135], v2 offset:17408
v_cvt_pk_bf16_f32 v200, v136, v137
v_mfma_f32_16x16x32_bf16 a[32:35], a[224:227], v[212:215], a[32:35]
v_exp_f32 v138, v138
v_mfma_f32_16x16x32_bf16 a[96:99], a[224:227], v[220:223], a[96:99]
ds_read_b128 a[136:139], v2 offset:18432
v_add_u32 v6, v6, v253
v_mfma_f32_16x16x32_bf16 a[96:99], a[192:195], v[204:207], a[96:99]
buffer_load_dwordx4 v1, s[44:47], s72 offen offset:1024 sc1 lds
v_mfma_f32_16x16x32_bf16 a[100:103], a[196:199], v[204:207], a[100:103]
v_exp_f32 v139, v139
v_mfma_f32_16x16x32_bf16 a[100:103], a[228:231], v[220:223], a[100:103]
ds_read_b128 a[140:143], v2 offset:19456
v_cvt_pk_bf16_f32 v201, v138, v139
v_mfma_f32_16x16x32_bf16 a[36:39], a[228:231], v[212:215], a[36:39]
v_exp_f32 v152, v152
v_mfma_f32_16x16x32_bf16 a[36:39], a[196:199], v[196:199], a[36:39]
ds_read_b128 a[144:147], v2 offset:20480
v_bfe_u32 v251, v0, 2, 2
v_mfma_f32_16x16x32_bf16 a[40:43], a[200:203], v[196:199], a[40:43]
buffer_load_dwordx4 v1, s[44:47], s72 offen offset:2048 sc1 lds
v_mfma_f32_16x16x32_bf16 a[40:43], a[232:235], v[212:215], a[40:43]
v_exp_f32 v153, v153
v_mfma_f32_16x16x32_bf16 a[104:107], a[232:235], v[220:223], a[104:107]
ds_read_b128 a[148:151], v2 offset:21504
v_cvt_pk_bf16_f32 v202, v152, v153
v_mfma_f32_16x16x32_bf16 a[104:107], a[200:203], v[204:207], a[104:107]
buffer_load_dwordx4 v1, s[44:47], s72 offen offset:3072 sc1 lds
v_mfma_f32_16x16x32_bf16 a[108:111], a[204:207], v[204:207], a[108:111]
s_add_u32 s66, s58, 0
v_exp_f32 v154, v154
v_mfma_f32_16x16x32_bf16 a[108:111], a[236:239], v[220:223], a[108:111]
s_and_b32 s66, s66, 3
ds_read_b128 a[152:155], v2 offset:22528
v_lshl_add_u32 v6, v248, 3, v6
v_mfma_f32_16x16x32_bf16 a[44:47], a[236:239], v[212:215], a[44:47]
s_mul_i32 s66, s66, 4160
v_exp_f32 v155, v155
v_mfma_f32_16x16x32_bf16 a[44:47], a[204:207], v[196:199], a[44:47]
s_add_u32 s66, s66, s92
ds_read_b128 a[156:159], v2 offset:23552
v_cvt_pk_bf16_f32 v203, v154, v155
v_mfma_f32_16x16x32_bf16 a[48:51], a[208:211], v[196:199], a[48:51]
s_waitcnt lgkmcnt(8)
v_exp_f32 v140, v140
v_mfma_f32_16x16x32_bf16 a[48:51], a[240:243], v[212:215], a[48:51]
s_add_u32 m0, s66, 16672
ds_read_b128 a[192:195], v2 offset:0
v_lshl_add_u32 v6, v241, 4, v6
v_mfma_f32_16x16x32_bf16 a[112:115], a[240:243], v[220:223], a[112:115]
s_add_u32 s72, s93, 0x0
buffer_load_dwordx4 v1, s[36:39], s72 offen lds
v_mfma_f32_16x16x32_bf16 a[112:115], a[208:211], v[204:207], a[112:115]
buffer_load_dwordx4 v1, s[36:39], s72 offen offset:1024 lds
v_mfma_f32_16x16x32_bf16 a[116:119], a[212:215], v[204:207], a[116:119]
v_exp_f32 v141, v141
v_mfma_f32_16x16x32_bf16 a[116:119], a[244:247], v[220:223], a[116:119]
ds_read_b128 a[196:199], v2 offset:1024
v_lshlrev_b32 v5, 3, v251
v_mfma_f32_16x16x32_bf16 a[52:55], a[244:247], v[212:215], a[52:55]
v_exp_f32 v142, v142
v_mfma_f32_16x16x32_bf16 a[52:55], a[212:215], v[196:199], a[52:55]
ds_read_b128 a[200:203], v2 offset:2048
v_lshrrev_b32 v5, v5, v252
v_mfma_f32_16x16x32_bf16 a[56:59], a[216:219], v[196:199], a[56:59]
buffer_load_dwordx4 v1, s[36:39], s72 offen offset:2048 lds
v_mfma_f32_16x16x32_bf16 a[56:59], a[248:251], v[212:215], a[56:59]
v_exp_f32 v143, v143
v_mfma_f32_16x16x32_bf16 a[120:123], a[248:251], v[220:223], a[120:123]
ds_read_b128 a[204:207], v2 offset:3072
v_and_b32 v5, 3, v5
v_mfma_f32_16x16x32_bf16 a[120:123], a[216:219], v[204:207], a[120:123]
v_exp_f32 v156, v156
v_mfma_f32_16x16x32_bf16 a[124:127], a[220:223], v[204:207], a[124:127]
ds_read_b128 a[208:211], v2 offset:4096
v_cmp_ne_u32 vcc, 1, v251
v_mfma_f32_16x16x32_bf16 a[124:127], a[252:255], v[220:223], a[124:127]
buffer_load_dwordx4 v1, s[36:39], s72 offen offset:3072 lds
v_mfma_f32_16x16x32_bf16 a[60:63], a[252:255], v[212:215], a[60:63]
s_add_u32 s66, s58, 2
v_exp_f32 v157, v157
v_mfma_f32_16x16x32_bf16 a[60:63], a[220:223], v[196:199], a[60:63]
s_and_b32 s66, s66, 3
ds_read_b128 a[212:215], v2 offset:5120
v_cvt_pk_bf16_f32 v204, v140, v141
s_cmp_eq_u32 s58, 2
s_cbranch_scc1 Lta46
s_cmp_eq_u32 s58, 3
s_cbranch_scc1 Lnt47
v_mfma_f32_16x16x32_bf16 v[168:171], a[160:163], v[48:51], v[112:115]
s_mul_i32 s66, s66, 4160
v_exp_f32 v158, v158
v_mfma_f32_16x16x32_bf16 v[184:187], a[176:179], v[48:51], v[112:115]
s_add_u32 s66, s66, s92
ds_read_b128 a[216:219], v2 offset:6144
v_cvt_pk_bf16_f32 v205, v142, v143
s_branch Ljoin48
Lta46:
v_mfma_f32_16x16x32_bf16 v[168:171], a[160:163], v[48:51], v[104:107]
s_mul_i32 s66, s66, 4160
v_exp_f32 v158, v158
v_mfma_f32_16x16x32_bf16 v[184:187], a[176:179], v[48:51], v[112:115]
s_add_u32 s66, s66, s92
ds_read_b128 a[216:219], v2 offset:6144
v_cvt_pk_bf16_f32 v205, v142, v143
s_branch Ljoin48
Lnt47:
v_mfma_f32_16x16x32_bf16 v[168:171], a[160:163], v[48:51], v[88:91]
s_mul_i32 s66, s66, 4160
v_exp_f32 v158, v158
v_mfma_f32_16x16x32_bf16 v[184:187], a[176:179], v[48:51], v[104:107]
s_add_u32 s66, s66, s92
ds_read_b128 a[216:219], v2 offset:6144
v_cvt_pk_bf16_f32 v205, v142, v143
Ljoin48:
v_mfma_f32_16x16x32_bf16 v[172:175], a[160:163], v[64:67], v[92:95]
s_add_u32 m0, s66, 33312
v_exp_f32 v159, v159
v_mfma_f32_16x16x32_bf16 v[172:175], a[164:167], v[68:71], v[172:175]
s_add_u32 s72, s93, 0x4
buffer_load_dwordx4 v1, s[36:39], s72 offen lds
v_mfma_f32_16x16x32_bf16 v[172:175], a[168:171], v[72:75], v[172:175]
ds_read_b128 a[220:223], v2 offset:7168
v_cvt_pk_bf16_f32 v206, v156, v157
v_mfma_f32_16x16x32_bf16 v[172:175], a[172:175], v[76:79], v[172:175]
buffer_load_dwordx4 v1, s[36:39], s72 offen offset:1024 lds
v_mfma_f32_16x16x32_bf16 v[188:191], a[188:191], v[76:79], v[92:95]
v_cvt_pk_bf16_f32 v207, v158, v159
v_mul_u32_u24 v5, 16640, v5
v_mfma_f32_16x16x32_bf16 v[188:191], a[184:187], v[72:75], v[188:191]
v_add_u32 v5, s92, v5
v_cndmask_b32 v5, v250, v5, vcc
v_mfma_f32_16x16x32_bf16 v[188:191], a[180:183], v[68:71], v[188:191]
v_add_u32 v253, s58, v251
v_and_b32 v253, 3, v253
v_mfma_f32_16x16x32_bf16 v[188:191], a[176:179], v[64:67], v[188:191]
v_mul_u32_u24 v253, 4160, v253
v_add_u32 v5, v5, v253
v_mfma_f32_16x16x32_bf16 v[168:171], a[164:167], v[52:55], v[168:171]
s_add_u32 s73, s62, 480
v_lshlrev_b32 v248, 5, v240
v_sub_u32 v248, s73, v248
v_mfma_f32_16x16x32_bf16 v[168:171], a[168:171], v[56:59], v[168:171]
v_lshl_add_u32 v7, v241, 4, v248
v_mfma_f32_16x16x32_bf16 v[168:171], a[172:175], v[60:63], v[168:171]
s_and_b32 s73, s58, 1
v_mfma_f32_16x16x32_bf16 v[184:187], a[188:191], v[60:63], v[184:187]
s_lshl_b32 s73, s73, 4
v_mfma_f32_16x16x32_bf16 v[184:187], a[184:187], v[56:59], v[184:187]
s_lshr_b32 s73, s90, s73
v_mfma_f32_16x16x32_bf16 v[184:187], a[180:183], v[52:55], v[184:187]
s_waitcnt lgkmcnt(4)
s_and_b32 s73, s73, 0xffff
v_lshl_add_u32 v248, v241, 3, v240
v_sub_u32 v248, 15, v248
v_and_b32 v249, 1, v248
v_lshlrev_b32 v249, 4, v249
v_lshlrev_b32 v249, v249, s73
v_lshrrev_b32 v248, 1, v248
v_and_b32 v241, 3, v0
v_cmp_eq_u32 vcc, 0, v248
v_lshl_add_u32 v5, v241, 3, v5
s_nop 0
v_cndmask_b32 v8, 0, v249, vcc
v_cmp_eq_u32 vcc, 1, v248
v_lshlrev_b32 v240, 4, v251
s_nop 0
v_cndmask_b32 v9, 0, v249, vcc
v_cmp_eq_u32 vcc, 2, v248
v_sub_u32 v240, 48, v240
v_lshlrev_b64 v[12:13], 16, s[88:89]
v_cndmask_b32 v10, 0, v249, vcc
v_cmp_eq_u32 vcc, 3, v248
v_lshlrev_b64 v[12:13], v240, v[12:13]
s_nop 0
v_cndmask_b32 v11, 0, v249, vcc
v_cmp_eq_u32 vcc, 3, v241
s_add_u32 s73, s62, 4096
v_lshl_add_u32 v14, v0, 3, s73
v_cndmask_b32 v12, 0, v12, vcc
v_cndmask_b32 v13, 0, v13, vcc
v_lshrrev_b32 v15, 4, v0
v_lshlrev_b32 v15, 1, v15
v_and_b32 v240, 7, v0
v_xor_b32 v15, v15, v240
v_lshlrev_b32 v15, 4, v15
v_lshrrev_b32 v240, 3, v0
v_lshl_add_u32 v15, v240, 11, v15
s_lshl_b32 s75, s59, 1
s_andn2_b32 s75, 8, s75
s_add_u32 s75, s75, s60
s_lshl_b32 s76, s65, 2
s_lshr_b32 s80, s59, 3
s_add_u32 s76, s76, s80
s_lshl_b32 s94, s58, 16
s_lshl_b32 s80, s76, 7
s_add_u32 s94, s94, s80
s_lshl_b32 s80, s75, 18
s_add_u32 s80, s80, s94
v_rcp_f32 v226, v224
v_rcp_f32 v230, v228
s_lshl_b32 s73, s52, 12
s_add_u32 s73, s73, 0x2000000
s_lshl_b32 s70, s67, 2
s_add_u32 s70, s70, s73
v_or_b32 v3, s53, v1
v_mov_b32 v227, v226
v_accvgpr_read_b32 v240, a0
v_accvgpr_read_b32 v241, a1
v_accvgpr_read_b32 v242, a2
v_accvgpr_read_b32 v243, a3
v_accvgpr_read_b32 v244, a4
v_accvgpr_read_b32 v245, a5
v_accvgpr_read_b32 v246, a6
v_accvgpr_read_b32 v247, a7
v_pk_mul_f32 v[240:241], v[240:241], v[226:227]
v_pk_mul_f32 v[242:243], v[242:243], v[226:227]
v_pk_mul_f32 v[244:245], v[244:245], v[226:227]
buffer_load_dwordx4 v1, s[36:39], s72 offen offset:2048 lds
v_pk_mul_f32 v[246:247], v[246:247], v[226:227]
v_cvt_pk_bf16_f32 v128, v240, v241
v_cvt_pk_bf16_f32 v129, v242, v243
v_cvt_pk_bf16_f32 v130, v244, v245
v_cvt_pk_bf16_f32 v131, v246, v247
v_accvgpr_read_b32 v248, a8
v_accvgpr_read_b32 v249, a9
v_accvgpr_read_b32 v250, a10
v_accvgpr_read_b32 v251, a11
v_accvgpr_read_b32 v252, a12
v_accvgpr_read_b32 v253, a13
v_accvgpr_read_b32 v254, a14
v_accvgpr_read_b32 v255, a15
v_pk_mul_f32 v[248:249], v[248:249], v[226:227]
v_pk_mul_f32 v[250:251], v[250:251], v[226:227]
v_pk_mul_f32 v[252:253], v[252:253], v[226:227]
v_pk_mul_f32 v[254:255], v[254:255], v[226:227]
v_cvt_pk_bf16_f32 v144, v248, v249
buffer_load_dwordx4 v1, s[36:39], s72 offen offset:3072 lds
v_cvt_pk_bf16_f32 v145, v250, v251
v_cvt_pk_bf16_f32 v146, v252, v253
v_cvt_pk_bf16_f32 v147, v254, v255
v_accvgpr_read_b32 v240, a16
v_accvgpr_read_b32 v241, a17
v_accvgpr_read_b32 v242, a18
v_accvgpr_read_b32 v243, a19
v_accvgpr_read_b32 v244, a20
v_accvgpr_read_b32 v245, a21
v_accvgpr_read_b32 v246, a22
v_accvgpr_read_b32 v247, a23
v_pk_mul_f32 v[240:241], v[240:241], v[226:227]
v_pk_mul_f32 v[242:243], v[242:243], v[226:227]
v_pk_mul_f32 v[244:245], v[244:245], v[226:227]
v_pk_mul_f32 v[246:247], v[246:247], v[226:227]
v_cvt_pk_bf16_f32 v160, v240, v241
v_cvt_pk_bf16_f32 v161, v242, v243
v_cvt_pk_bf16_f32 v162, v244, v245
buffer_load_dwordx4 v[80:83], v15, s[4:7], s80 offen
v_cvt_pk_bf16_f32 v163, v246, v247
v_accvgpr_read_b32 v248, a24
v_accvgpr_read_b32 v249, a25
v_accvgpr_read_b32 v250, a26
v_accvgpr_read_b32 v251, a27
v_accvgpr_read_b32 v252, a28
v_accvgpr_read_b32 v253, a29
v_accvgpr_read_b32 v254, a30
v_accvgpr_read_b32 v255, a31
v_pk_mul_f32 v[248:249], v[248:249], v[226:227]
v_pk_mul_f32 v[250:251], v[250:251], v[226:227]
v_pk_mul_f32 v[252:253], v[252:253], v[226:227]
v_pk_mul_f32 v[254:255], v[254:255], v[226:227]
v_cvt_pk_bf16_f32 v176, v248, v249
v_cvt_pk_bf16_f32 v177, v250, v251
v_cvt_pk_bf16_f32 v178, v252, v253
v_cvt_pk_bf16_f32 v179, v254, v255
v_mov_b32 v231, v230
v_accvgpr_read_b32 v240, a32
s_add_u32 s80, s80, 0x4000
buffer_load_dwordx4 v[84:87], v15, s[4:7], s80 offen
v_accvgpr_read_b32 v241, a33
v_accvgpr_read_b32 v242, a34
v_accvgpr_read_b32 v243, a35
v_accvgpr_read_b32 v244, a36
v_accvgpr_read_b32 v245, a37
v_accvgpr_read_b32 v246, a38
v_accvgpr_read_b32 v247, a39
v_pk_mul_f32 v[240:241], v[240:241], v[230:231]
v_pk_mul_f32 v[242:243], v[242:243], v[230:231]
v_pk_mul_f32 v[244:245], v[244:245], v[230:231]
v_pk_mul_f32 v[246:247], v[246:247], v[230:231]
v_cvt_pk_bf16_f32 v132, v240, v241
v_cvt_pk_bf16_f32 v133, v242, v243
v_cvt_pk_bf16_f32 v134, v244, v245
v_cvt_pk_bf16_f32 v135, v246, v247
v_accvgpr_read_b32 v248, a40
v_accvgpr_read_b32 v249, a41
v_accvgpr_read_b32 v250, a42
s_add_u32 s80, s80, 0x4000
buffer_load_dwordx4 v[96:99], v15, s[4:7], s80 offen
v_accvgpr_read_b32 v251, a43
v_accvgpr_read_b32 v252, a44
v_accvgpr_read_b32 v253, a45
v_accvgpr_read_b32 v254, a46
v_accvgpr_read_b32 v255, a47
v_pk_mul_f32 v[248:249], v[248:249], v[230:231]
v_pk_mul_f32 v[250:251], v[250:251], v[230:231]
v_pk_mul_f32 v[252:253], v[252:253], v[230:231]
v_pk_mul_f32 v[254:255], v[254:255], v[230:231]
v_cvt_pk_bf16_f32 v148, v248, v249
v_cvt_pk_bf16_f32 v149, v250, v251
v_cvt_pk_bf16_f32 v150, v252, v253
v_cvt_pk_bf16_f32 v151, v254, v255
v_accvgpr_read_b32 v240, a48
v_accvgpr_read_b32 v241, a49
v_accvgpr_read_b32 v242, a50
v_accvgpr_read_b32 v243, a51
v_accvgpr_read_b32 v244, a52
s_add_u32 s80, s80, 0x4000
buffer_load_dwordx4 v[100:103], v15, s[4:7], s80 offen
v_accvgpr_read_b32 v245, a53
v_accvgpr_read_b32 v246, a54
v_accvgpr_read_b32 v247, a55
v_pk_mul_f32 v[240:241], v[240:241], v[230:231]
v_pk_mul_f32 v[242:243], v[242:243], v[230:231]
v_pk_mul_f32 v[244:245], v[244:245], v[230:231]
v_pk_mul_f32 v[246:247], v[246:247], v[230:231]
v_cvt_pk_bf16_f32 v164, v240, v241
v_cvt_pk_bf16_f32 v165, v242, v243
v_cvt_pk_bf16_f32 v166, v244, v245
v_cvt_pk_bf16_f32 v167, v246, v247
v_accvgpr_read_b32 v248, a56
v_accvgpr_read_b32 v249, a57
v_accvgpr_read_b32 v250, a58
v_accvgpr_read_b32 v251, a59
v_accvgpr_read_b32 v252, a60
v_accvgpr_read_b32 v253, a61
v_accvgpr_read_b32 v254, a62
v_accvgpr_read_b32 v255, a63
v_pk_mul_f32 v[248:249], v[248:249], v[230:231]
v_pk_mul_f32 v[250:251], v[250:251], v[230:231]
v_pk_mul_f32 v[252:253], v[252:253], v[230:231]
v_pk_mul_f32 v[254:255], v[254:255], v[230:231]
v_cvt_pk_bf16_f32 v180, v248, v249
v_cvt_pk_bf16_f32 v181, v250, v251
v_cvt_pk_bf16_f32 v182, v252, v253
v_cvt_pk_bf16_f32 v183, v254, v255
v_mfma_f32_16x16x32_bf16 v[232:235], v[120:123], v[216:219], v[232:235]
s_add_u32 s82, s82, 0x8000
ds_read_b128 a[160:163], v2 offset:24576
ds_read_b128 a[164:167], v2 offset:25600
v_mfma_f32_16x16x32_bf16 v[232:235], v[120:123], v[200:203], v[232:235]
s_and_b32 s82, s82, 0x1ffff
v_exp_f32 v172, v172
v_mfma_f32_16x16x32_bf16 a[64:67], a[224:227], v[216:219], a[64:67]
v_exp_f32 v173, v173
v_mfma_f32_16x16x32_bf16 a[64:67], a[192:195], v[200:203], a[64:67]
s_nop 0
ds_read_b128 a[168:171], v2 offset:26624
ds_read_b128 a[172:175], v2 offset:27648
v_mfma_f32_16x16x32_bf16 a[68:71], a[196:199], v[200:203], a[68:71]
v_exp_f32 v174, v174
v_mfma_f32_16x16x32_bf16 a[68:71], a[228:231], v[216:219], a[68:71]
v_exp_f32 v175, v175
v_mfma_f32_16x16x32_bf16 a[72:75], a[232:235], v[216:219], a[72:75]
buffer_store_dwordx4 v[128:131], v3, s[44:47], s70 offen sc1
v_mfma_f32_16x16x32_bf16 a[72:75], a[200:203], v[200:203], a[72:75]
s_nop 0
ds_read_b128 a[176:179], v2 offset:28672
ds_read_b128 a[180:183], v2 offset:29696
v_mfma_f32_16x16x32_bf16 a[76:79], a[204:207], v[200:203], a[76:79]
v_exp_f32 v188, v188
v_mfma_f32_16x16x32_bf16 a[76:79], a[236:239], v[216:219], a[76:79]
s_nop 0
ds_read_b128 a[184:187], v2 offset:30720
ds_read_b128 a[188:191], v2 offset:31744
v_mfma_f32_16x16x32_bf16 a[80:83], a[240:243], v[216:219], a[80:83]
s_waitcnt lgkmcnt(8)
ds_read_b128 a[224:227], v2 offset:8192
ds_read_b128 a[228:231], v2 offset:9216
v_mfma_f32_16x16x32_bf16 a[80:83], a[208:211], v[200:203], a[80:83]
s_nop 0
ds_read_b128 a[232:235], v2 offset:10240
ds_read_b128 a[236:239], v2 offset:11264
v_mfma_f32_16x16x32_bf16 a[84:87], a[212:215], v[200:203], a[84:87]
ds_read_b128 a[240:243], v2 offset:12288
v_cvt_pk_bf16_f32 v220, v172, v173
v_mfma_f32_16x16x32_bf16 a[84:87], a[244:247], v[216:219], a[84:87]
v_exp_f32 v189, v189
v_mfma_f32_16x16x32_bf16 a[88:91], a[248:251], v[216:219], a[88:91]
v_exp_f32 v190, v190
v_mfma_f32_16x16x32_bf16 a[88:91], a[216:219], v[200:203], a[88:91]
s_nop 0
ds_read_b128 a[244:247], v2 offset:13312
ds_read_b128 a[248:251], v2 offset:14336
v_mfma_f32_16x16x32_bf16 a[92:95], a[220:223], v[200:203], a[92:95]
v_cvt_pk_bf16_f32 v221, v174, v175
v_cvt_pk_bf16_f32 v222, v188, v189
v_mfma_f32_16x16x32_bf16 a[92:95], a[252:255], v[216:219], a[92:95]
v_exp_f32 v191, v191
s_cmp_eq_u32 s58, 0
s_cbranch_scc1 Lta49
s_cmp_eq_u32 s58, 1
s_cbranch_scc1 Lnt50
v_mfma_f32_16x16x32_bf16 v[140:143], a[128:131], v[64:67], v[92:95]
v_exp_f32 v168, v168
v_mfma_f32_16x16x32_bf16 v[156:159], a[144:147], v[64:67], v[92:95]
buffer_store_dwordx4 v[144:147], v3, s[44:47], s70 offen offset:1024 sc1
s_branch Ljoin51
Lta49:
v_mfma_f32_16x16x32_bf16 v[140:143], a[128:131], v[64:67], v[108:111]
v_exp_f32 v168, v168
v_mfma_f32_16x16x32_bf16 v[156:159], a[144:147], v[64:67], v[112:115]
buffer_store_dwordx4 v[144:147], v3, s[44:47], s70 offen offset:1024 sc1
s_branch Ljoin51
Lnt50:
v_mfma_f32_16x16x32_bf16 v[140:143], a[128:131], v[64:67], v[92:95]
v_exp_f32 v168, v168
v_mfma_f32_16x16x32_bf16 v[156:159], a[144:147], v[64:67], v[108:111]
buffer_store_dwordx4 v[144:147], v3, s[44:47], s70 offen offset:1024 sc1
Ljoin51:
v_mfma_f32_16x16x32_bf16 v[140:143], a[132:135], v[68:71], v[140:143]
v_exp_f32 v169, v169
v_mfma_f32_16x16x32_bf16 v[140:143], a[136:139], v[72:75], v[140:143]
v_exp_f32 v170, v170
v_mfma_f32_16x16x32_bf16 v[140:143], a[140:143], v[76:79], v[140:143]
buffer_store_dwordx4 v[160:163], v3, s[44:47], s70 offen offset:2048 sc1
v_mfma_f32_16x16x32_bf16 v[156:159], a[156:159], v[76:79], v[156:159]
ds_read_b128 a[252:255], v2 offset:15360
v_cvt_pk_bf16_f32 v223, v190, v191
v_mfma_f32_16x16x32_bf16 v[156:159], a[152:155], v[72:75], v[156:159]
s_waitcnt vmcnt(24) lgkmcnt(4)
v_exp_f32 v171, v171
v_mfma_f32_16x16x32_bf16 v[156:159], a[148:151], v[68:71], v[156:159]
s_barrier
v_exp_f32 v184, v184
v_add_u32 v2, s82, v1
v_cvt_pk_bf16_f32 v216, v168, v169
v_cvt_pk_bf16_f32 v217, v170, v171
v_exp_f32 v185, v185
v_exp_f32 v186, v186
v_cvt_pk_bf16_f32 v218, v184, v185
v_exp_f32 v187, v187
s_nop 0
v_cvt_pk_bf16_f32 v219, v186, v187
v_mfma_f32_16x16x32_bf16 v[236:239], v[120:123], v[204:207], v[236:239]
s_add_u32 s78, s59, 8
v_exp_f32 v140, v140
v_mfma_f32_16x16x32_bf16 v[236:239], v[120:123], v[220:223], v[236:239]
s_and_b32 s78, s78, 24
v_exp_f32 v141, v141
v_mfma_f32_16x16x32_bf16 a[96:99], a[192:195], v[204:207], a[96:99]
s_lshr_b32 s79, 0x67234501, s78
ds_read_b128 a[192:195], v2 offset:0
v_mfma_f32_16x16x32_bf16 a[96:99], a[224:227], v[220:223], a[96:99]
s_and_b32 s79, s79, 7
buffer_store_dwordx4 v[176:179], v3, s[44:47], s70 offen offset:3072 sc1
v_mfma_f32_16x16x32_bf16 a[100:103], a[228:231], v[220:223], a[100:103]
s_add_u32 s70, s70, 0x80000
v_exp_f32 v142, v142
v_mfma_f32_16x16x32_bf16 a[100:103], a[196:199], v[204:207], a[100:103]
s_lshl_b32 s79, s79, 18
ds_read_b128 a[196:199], v2 offset:1024
v_mfma_f32_16x16x32_bf16 a[104:107], a[200:203], v[204:207], a[104:107]
s_add_u32 s79, s79, s94
ds_read_b128 a[200:203], v2 offset:2048
v_mfma_f32_16x16x32_bf16 a[104:107], a[232:235], v[220:223], a[104:107]
s_add_u32 s12, s61, 0
v_exp_f32 v143, v143
v_mfma_f32_16x16x32_bf16 a[108:111], a[236:239], v[220:223], a[108:111]
s_and_b32 s12, s12, 3
v_exp_f32 v156, v156
v_mfma_f32_16x16x32_bf16 a[108:111], a[204:207], v[204:207], a[108:111]
s_lshl_b32 s12, s12, 21
ds_read_b128 a[204:207], v2 offset:3072
v_mfma_f32_16x16x32_bf16 a[112:115], a[208:211], v[204:207], a[112:115]
s_waitcnt lgkmcnt(4)
ds_read_b128 a[208:211], v2 offset:4096
v_mfma_f32_16x16x32_bf16 a[112:115], a[240:243], v[220:223], a[112:115]
s_add_u32 s12, s12, s79
buffer_store_dwordx4 v[132:135], v3, s[44:47], s70 offen sc1
v_mfma_f32_16x16x32_bf16 a[116:119], a[244:247], v[220:223], a[116:119]
s_add_u32 s13, s61, 1
v_exp_f32 v157, v157
v_mfma_f32_16x16x32_bf16 a[116:119], a[212:215], v[204:207], a[116:119]
s_and_b32 s13, s13, 3
ds_read_b128 a[212:215], v2 offset:5120
v_mfma_f32_16x16x32_bf16 a[120:123], a[216:219], v[204:207], a[120:123]
s_lshl_b32 s13, s13, 21
v_exp_f32 v158, v158
v_mfma_f32_16x16x32_bf16 a[120:123], a[248:251], v[220:223], a[120:123]
s_add_u32 s13, s13, s79
ds_read_b128 a[216:219], v2 offset:6144
v_mfma_f32_16x16x32_bf16 a[124:127], a[252:255], v[220:223], a[124:127]
s_add_u32 s14, s61, 2
buffer_store_dwordx4 v[148:151], v3, s[44:47], s70 offen offset:1024 sc1
v_mfma_f32_16x16x32_bf16 a[124:127], a[220:223], v[204:207], a[124:127]
s_and_b32 s14, s14, 3
ds_read_b128 a[220:223], v2 offset:7168
v_cvt_pk_bf16_f32 v204, v140, v141
s_cmp_eq_u32 s58, 2
s_cbranch_scc1 Lta52
s_cmp_eq_u32 s58, 3
s_cbranch_scc1 Lnt53
v_mfma_f32_16x16x32_bf16 v[172:175], a[160:163], v[64:67], v[112:115]
s_lshl_b32 s14, s14, 21
v_cvt_pk_bf16_f32 v205, v142, v143
v_cvt_pk_bf16_f32 v206, v156, v157
v_mfma_f32_16x16x32_bf16 v[188:191], a[176:179], v[64:67], v[112:115]
s_add_u32 s14, s14, s79
v_exp_f32 v159, v159
s_branch Ljoin54
Lta52:
v_mfma_f32_16x16x32_bf16 v[172:175], a[160:163], v[64:67], v[108:111]
s_lshl_b32 s14, s14, 21
v_cvt_pk_bf16_f32 v205, v142, v143
v_cvt_pk_bf16_f32 v206, v156, v157
v_mfma_f32_16x16x32_bf16 v[188:191], a[176:179], v[64:67], v[112:115]
s_add_u32 s14, s14, s79
v_exp_f32 v159, v159
s_branch Ljoin54
Lnt53:
v_mfma_f32_16x16x32_bf16 v[172:175], a[160:163], v[64:67], v[92:95]
s_lshl_b32 s14, s14, 21
v_cvt_pk_bf16_f32 v205, v142, v143
v_cvt_pk_bf16_f32 v206, v156, v157
v_mfma_f32_16x16x32_bf16 v[188:191], a[176:179], v[64:67], v[108:111]
s_add_u32 s14, s14, s79
v_exp_f32 v159, v159
Ljoin54:
v_mfma_f32_16x16x32_bf16 v[172:175], a[164:167], v[68:71], v[172:175]
s_add_u32 s15, s61, 3
v_cvt_pk_bf16_f32 v207, v158, v159
v_mfma_f32_16x16x32_bf16 v[172:175], a[168:171], v[72:75], v[172:175]
s_and_b32 s15, s15, 3
v_mfma_f32_16x16x32_bf16 v[172:175], a[172:175], v[76:79], v[172:175]
s_lshl_b32 s15, s15, 21
v_mfma_f32_16x16x32_bf16 v[188:191], a[188:191], v[76:79], v[188:191]
s_add_u32 s15, s15, s79
v_mfma_f32_16x16x32_bf16 v[188:191], a[184:187], v[72:75], v[188:191]
v_mfma_f32_16x16x32_bf16 v[188:191], a[180:183], v[68:71], v[188:191]
s_waitcnt lgkmcnt(4)
v_mfma_f32_16x16x32_bf16 v[232:235], v[120:123], v[216:219], v[232:235]
s_add_u32 s82, s82, 0x8000
v_exp_f32 v172, v172
v_mfma_f32_16x16x32_bf16 a[64:67], a[224:227], v[216:219], a[64:67]
s_and_b32 s82, s82, 0x1ffff
ds_read_b128 a[224:227], v2 offset:8192
v_mfma_f32_16x16x32_bf16 a[68:71], a[228:231], v[216:219], a[68:71]
ds_read_b128 a[228:231], v2 offset:9216
v_mfma_f32_16x16x32_bf16 a[72:75], a[232:235], v[216:219], a[72:75]
ds_read_b128 a[232:235], v2 offset:10240
v_mfma_f32_16x16x32_bf16 a[76:79], a[236:239], v[216:219], a[76:79]
buffer_store_dwordx4 v[164:167], v3, s[44:47], s70 offen offset:2048 sc1
v_mfma_f32_16x16x32_bf16 a[80:83], a[240:243], v[216:219], a[80:83]
s_nop 0
ds_read_b128 a[236:239], v2 offset:11264
ds_read_b128 a[240:243], v2 offset:12288
v_mfma_f32_16x16x32_bf16 a[84:87], a[244:247], v[216:219], a[84:87]
ds_read_b128 a[244:247], v2 offset:13312
v_mfma_f32_16x16x32_bf16 a[88:91], a[248:251], v[216:219], a[88:91]
v_exp_f32 v173, v173
v_mfma_f32_16x16x32_bf16 a[92:95], a[252:255], v[216:219], a[92:95]
v_exp_f32 v174, v174
ds_read_b128 a[248:251], v2 offset:14336
ds_read_b128 a[252:255], v2 offset:15360
v_add_u32 v2, s82, v1
buffer_store_dwordx4 v[180:183], v3, s[44:47], s70 offen offset:3072 sc1
v_cvt_pk_bf16_f32 v220, v172, v173
v_exp_f32 v175, v175
v_exp_f32 v188, v188
v_cvt_pk_bf16_f32 v221, v174, v175
v_exp_f32 v189, v189
v_exp_f32 v190, v190
v_cvt_pk_bf16_f32 v222, v188, v189
v_exp_f32 v191, v191
s_nop 0
v_cvt_pk_bf16_f32 v223, v190, v191
s_waitcnt vmcnt(8) lgkmcnt(0)
s_barrier
s_branch LHT4
Lslow:
s_waitcnt vmcnt(0) lgkmcnt(0)
s_barrier
s_mov_b32 s86, 1
s_lshl_b32 s81, s59, 20
s_add_u32 s81, s81, s64
s_sub_u32 s81, s81, 0x4000
s_mov_b32 s83, 0
s_lshl_b32 s75, s60, 3
s_sub_u32 s76, 128, s75
s_add_u32 s74, s75, s58
s_sub_u32 s75, s76, 8
s_add_u32 s75, s75, s58
v_mov_b32 v2, v1
v_lshrrev_b32 v240, 4, v0
v_and_b32 v241, 15, v0
v_lshlrev_b32 v240, 2, v240
v_sub_u32 v240, v241, v240
v_mov_b32 v112, 0xff800000
v_mov_b32 v113, 0xff800000
v_mov_b32 v114, 0xff800000
v_mov_b32 v115, 0xff800000
v_cmp_gt_i32 vcc, 0, v240
v_and_b32 v120, 3, v0
s_nop 0
v_cndmask_b32 v116, 0, v112, vcc
v_cmp_gt_i32 vcc, 1, v240
v_subrev_u32 v120, 1, v120
s_nop 0
v_cndmask_b32 v117, 0, v112, vcc
v_cmp_gt_i32 vcc, 2, v240
v_ashrrev_i32 v120, 31, v120
s_nop 0
v_cndmask_b32 v118, 0, v112, vcc
v_cmp_gt_i32 vcc, 3, v240
v_and_b32 v120, 0x3f803f80, v120
s_nop 0
v_cndmask_b32 v119, 0, v112, vcc
Lslow1:
s_add_u32 m0, s64, 16384
s_add_u32 s72, s81, 16384
buffer_load_dwordx4 v1, s[44:47], s72 offen sc1 lds
buffer_load_dwordx4 v1, s[44:47], s72 offen offset:1024 sc1 lds
buffer_load_dwordx4 v1, s[44:47], s72 offen offset:2048 sc1 lds
buffer_load_dwordx4 v1, s[44:47], s72 offen offset:3072 sc1 lds
s_add_u32 s81, s81, 0x8000
s_waitcnt vmcnt(0)
s_barrier
ds_read_b128 a[128:131], v2 offset:16384
ds_read_b128 a[132:135], v2 offset:17408
ds_read_b128 a[136:139], v2 offset:18432
ds_read_b128 a[140:143], v2 offset:19456
ds_read_b128 a[144:147], v2 offset:20480
ds_read_b128 a[148:151], v2 offset:21504
ds_read_b128 a[152:155], v2 offset:22528
ds_read_b128 a[156:159], v2 offset:23552
s_waitcnt lgkmcnt(0)
s_add_u32 s73, s74, 0
s_cmp_lt_u32 s73, s83
s_cbranch_scc1 Lsa55
s_cmp_eq_u32 s73, s83
s_cbranch_scc1 Lst56
v_mfma_f32_16x16x32_bf16 v[128:131], a[128:131], v[16:19], 0
s_branch Lsj57
Lst56:
v_mfma_f32_16x16x32_bf16 v[128:131], a[128:131], v[16:19], v[116:119]
Lsj57:
v_mfma_f32_16x16x32_bf16 v[128:131], a[132:135], v[20:23], v[128:131]
v_mfma_f32_16x16x32_bf16 v[128:131], a[136:139], v[24:27], v[128:131]
v_mfma_f32_16x16x32_bf16 v[128:131], a[140:143], v[28:31], v[128:131]
s_nop 7
v_max3_f32 v124, v124, v128, v129
v_max3_f32 v124, v124, v130, v131
Lsa55:
s_add_u32 s73, s74, 4
s_cmp_lt_u32 s73, s83
s_cbranch_scc1 Lsa58
s_cmp_eq_u32 s73, s83
s_cbranch_scc1 Lst59
v_mfma_f32_16x16x32_bf16 v[132:135], a[128:131], v[32:35], 0
s_branch Lsj60
Lst59:
v_mfma_f32_16x16x32_bf16 v[132:135], a[128:131], v[32:35], v[116:119]
Lsj60:
v_mfma_f32_16x16x32_bf16 v[132:135], a[132:135], v[36:39], v[132:135]
v_mfma_f32_16x16x32_bf16 v[132:135], a[136:139], v[40:43], v[132:135]
v_mfma_f32_16x16x32_bf16 v[132:135], a[140:143], v[44:47], v[132:135]
s_nop 7
v_max3_f32 v125, v125, v132, v133
v_max3_f32 v125, v125, v134, v135
Lsa58:
s_add_u32 s73, s75, 0
s_cmp_lt_u32 s73, s83
s_cbranch_scc1 Lsa61
s_cmp_eq_u32 s73, s83
s_cbranch_scc1 Lst62
v_mfma_f32_16x16x32_bf16 v[136:139], a[128:131], v[48:51], 0
s_branch Lsj63
Lst62:
v_mfma_f32_16x16x32_bf16 v[136:139], a[128:131], v[48:51], v[116:119]
Lsj63:
v_mfma_f32_16x16x32_bf16 v[136:139], a[132:135], v[52:55], v[136:139]
v_mfma_f32_16x16x32_bf16 v[136:139], a[136:139], v[56:59], v[136:139]
v_mfma_f32_16x16x32_bf16 v[136:139], a[140:143], v[60:63], v[136:139]
s_nop 7
v_max3_f32 v126, v126, v136, v137
v_max3_f32 v126, v126, v138, v139
Lsa61:
s_add_u32 s73, s75, 4
s_cmp_lt_u32 s73, s83
s_cbranch_scc1 Lsa64
s_cmp_eq_u32 s73, s83
s_cbranch_scc1 Lst65
v_mfma_f32_16x16x32_bf16 v[140:143], a[128:131], v[64:67], 0
s_branch Lsj66
Lst65:
v_mfma_f32_16x16x32_bf16 v[140:143], a[128:131], v[64:67], v[116:119]
Lsj66:
v_mfma_f32_16x16x32_bf16 v[140:143], a[132:135], v[68:71], v[140:143]
v_mfma_f32_16x16x32_bf16 v[140:143], a[136:139], v[72:75], v[140:143]
v_mfma_f32_16x16x32_bf16 v[140:143], a[140:143], v[76:79], v[140:143]
s_nop 7
v_max3_f32 v127, v127, v140, v141
v_max3_f32 v127, v127, v142, v143
Lsa64:
s_add_u32 s83, s83, 1
s_add_u32 s73, s74, 0
s_cmp_lt_u32 s73, s83
s_cbranch_scc1 Lsa67
s_cmp_eq_u32 s73, s83
s_cbranch_scc1 Lst68
v_mfma_f32_16x16x32_bf16 v[144:147], a[144:147], v[16:19], 0
s_branch Lsj69
Lst68:
v_mfma_f32_16x16x32_bf16 v[144:147], a[144:147], v[16:19], v[116:119]
Lsj69:
v_mfma_f32_16x16x32_bf16 v[144:147], a[148:151], v[20:23], v[144:147]
v_mfma_f32_16x16x32_bf16 v[144:147], a[152:155], v[24:27], v[144:147]
v_mfma_f32_16x16x32_bf16 v[144:147], a[156:159], v[28:31], v[144:147]
s_nop 7
v_max3_f32 v124, v124, v144, v145
v_max3_f32 v124, v124, v146, v147
Lsa67:
s_add_u32 s73, s74, 4
s_cmp_lt_u32 s73, s83
s_cbranch_scc1 Lsa70
s_cmp_eq_u32 s73, s83
s_cbranch_scc1 Lst71
v_mfma_f32_16x16x32_bf16 v[148:151], a[144:147], v[32:35], 0
s_branch Lsj72
Lst71:
v_mfma_f32_16x16x32_bf16 v[148:151], a[144:147], v[32:35], v[116:119]
Lsj72:
v_mfma_f32_16x16x32_bf16 v[148:151], a[148:151], v[36:39], v[148:151]
v_mfma_f32_16x16x32_bf16 v[148:151], a[152:155], v[40:43], v[148:151]
v_mfma_f32_16x16x32_bf16 v[148:151], a[156:159], v[44:47], v[148:151]
s_nop 7
v_max3_f32 v125, v125, v148, v149
v_max3_f32 v125, v125, v150, v151
Lsa70:
s_add_u32 s73, s75, 0
s_cmp_lt_u32 s73, s83
s_cbranch_scc1 Lsa73
s_cmp_eq_u32 s73, s83
s_cbranch_scc1 Lst74
v_mfma_f32_16x16x32_bf16 v[152:155], a[144:147], v[48:51], 0
s_branch Lsj75
Lst74:
v_mfma_f32_16x16x32_bf16 v[152:155], a[144:147], v[48:51], v[116:119]
Lsj75:
v_mfma_f32_16x16x32_bf16 v[152:155], a[148:151], v[52:55], v[152:155]
v_mfma_f32_16x16x32_bf16 v[152:155], a[152:155], v[56:59], v[152:155]
v_mfma_f32_16x16x32_bf16 v[152:155], a[156:159], v[60:63], v[152:155]
s_nop 7
v_max3_f32 v126, v126, v152, v153
v_max3_f32 v126, v126, v154, v155
Lsa73:
s_add_u32 s73, s75, 4
s_cmp_lt_u32 s73, s83
s_cbranch_scc1 Lsa76
s_cmp_eq_u32 s73, s83
s_cbranch_scc1 Lst77
v_mfma_f32_16x16x32_bf16 v[156:159], a[144:147], v[64:67], 0
s_branch Lsj78
Lst77:
v_mfma_f32_16x16x32_bf16 v[156:159], a[144:147], v[64:67], v[116:119]
Lsj78:
v_mfma_f32_16x16x32_bf16 v[156:159], a[148:151], v[68:71], v[156:159]
v_mfma_f32_16x16x32_bf16 v[156:159], a[152:155], v[72:75], v[156:159]
v_mfma_f32_16x16x32_bf16 v[156:159], a[156:159], v[76:79], v[156:159]
s_nop 7
v_max3_f32 v127, v127, v156, v157
v_max3_f32 v127, v127, v158, v159
Lsa76:
s_add_u32 s83, s83, 1
ds_read_b128 a[128:131], v2 offset:24576
ds_read_b128 a[132:135], v2 offset:25600
ds_read_b128 a[136:139], v2 offset:26624
ds_read_b128 a[140:143], v2 offset:27648
ds_read_b128 a[144:147], v2 offset:28672
ds_read_b128 a[148:151], v2 offset:29696
ds_read_b128 a[152:155], v2 offset:30720
ds_read_b128 a[156:159], v2 offset:31744
s_waitcnt lgkmcnt(0)
s_add_u32 s73, s74, 0
s_cmp_lt_u32 s73, s83
s_cbranch_scc1 Lsa79
s_cmp_eq_u32 s73, s83
s_cbranch_scc1 Lst80
v_mfma_f32_16x16x32_bf16 v[128:131], a[128:131], v[16:19], 0
s_branch Lsj81
Lst80:
v_mfma_f32_16x16x32_bf16 v[128:131], a[128:131], v[16:19], v[116:119]
Lsj81:
v_mfma_f32_16x16x32_bf16 v[128:131], a[132:135], v[20:23], v[128:131]
v_mfma_f32_16x16x32_bf16 v[128:131], a[136:139], v[24:27], v[128:131]
v_mfma_f32_16x16x32_bf16 v[128:131], a[140:143], v[28:31], v[128:131]
s_nop 7
v_max3_f32 v124, v124, v128, v129
v_max3_f32 v124, v124, v130, v131
Lsa79:
s_add_u32 s73, s74, 4
s_cmp_lt_u32 s73, s83
s_cbranch_scc1 Lsa82
s_cmp_eq_u32 s73, s83
s_cbranch_scc1 Lst83
v_mfma_f32_16x16x32_bf16 v[132:135], a[128:131], v[32:35], 0
s_branch Lsj84
Lst83:
v_mfma_f32_16x16x32_bf16 v[132:135], a[128:131], v[32:35], v[116:119]
Lsj84:
v_mfma_f32_16x16x32_bf16 v[132:135], a[132:135], v[36:39], v[132:135]
v_mfma_f32_16x16x32_bf16 v[132:135], a[136:139], v[40:43], v[132:135]
v_mfma_f32_16x16x32_bf16 v[132:135], a[140:143], v[44:47], v[132:135]
s_nop 7
v_max3_f32 v125, v125, v132, v133
v_max3_f32 v125, v125, v134, v135
Lsa82:
s_add_u32 s73, s75, 0
s_cmp_lt_u32 s73, s83
s_cbranch_scc1 Lsa85
s_cmp_eq_u32 s73, s83
s_cbranch_scc1 Lst86
v_mfma_f32_16x16x32_bf16 v[136:139], a[128:131], v[48:51], 0
s_branch Lsj87
Lst86:
v_mfma_f32_16x16x32_bf16 v[136:139], a[128:131], v[48:51], v[116:119]
Lsj87:
v_mfma_f32_16x16x32_bf16 v[136:139], a[132:135], v[52:55], v[136:139]
v_mfma_f32_16x16x32_bf16 v[136:139], a[136:139], v[56:59], v[136:139]
v_mfma_f32_16x16x32_bf16 v[136:139], a[140:143], v[60:63], v[136:139]
s_nop 7
v_max3_f32 v126, v126, v136, v137
v_max3_f32 v126, v126, v138, v139
Lsa85:
s_add_u32 s73, s75, 4
s_cmp_lt_u32 s73, s83
s_cbranch_scc1 Lsa88
s_cmp_eq_u32 s73, s83
s_cbranch_scc1 Lst89
v_mfma_f32_16x16x32_bf16 v[140:143], a[128:131], v[64:67], 0
s_branch Lsj90
Lst89:
v_mfma_f32_16x16x32_bf16 v[140:143], a[128:131], v[64:67], v[116:119]
Lsj90:
v_mfma_f32_16x16x32_bf16 v[140:143], a[132:135], v[68:71], v[140:143]
v_mfma_f32_16x16x32_bf16 v[140:143], a[136:139], v[72:75], v[140:143]
v_mfma_f32_16x16x32_bf16 v[140:143], a[140:143], v[76:79], v[140:143]
s_nop 7
v_max3_f32 v127, v127, v140, v141
v_max3_f32 v127, v127, v142, v143
Lsa88:
s_add_u32 s83, s83, 1
s_add_u32 s73, s74, 0
s_cmp_lt_u32 s73, s83
s_cbranch_scc1 Lsa91
s_cmp_eq_u32 s73, s83
s_cbranch_scc1 Lst92
v_mfma_f32_16x16x32_bf16 v[144:147], a[144:147], v[16:19], 0
s_branch Lsj93
Lst92:
v_mfma_f32_16x16x32_bf16 v[144:147], a[144:147], v[16:19], v[116:119]
Lsj93:
v_mfma_f32_16x16x32_bf16 v[144:147], a[148:151], v[20:23], v[144:147]
v_mfma_f32_16x16x32_bf16 v[144:147], a[152:155], v[24:27], v[144:147]
v_mfma_f32_16x16x32_bf16 v[144:147], a[156:159], v[28:31], v[144:147]
s_nop 7
v_max3_f32 v124, v124, v144, v145
v_max3_f32 v124, v124, v146, v147
Lsa91:
s_add_u32 s73, s74, 4
s_cmp_lt_u32 s73, s83
s_cbranch_scc1 Lsa94
s_cmp_eq_u32 s73, s83
s_cbranch_scc1 Lst95
v_mfma_f32_16x16x32_bf16 v[148:151], a[144:147], v[32:35], 0
s_branch Lsj96
Lst95:
v_mfma_f32_16x16x32_bf16 v[148:151], a[144:147], v[32:35], v[116:119]
Lsj96:
v_mfma_f32_16x16x32_bf16 v[148:151], a[148:151], v[36:39], v[148:151]
v_mfma_f32_16x16x32_bf16 v[148:151], a[152:155], v[40:43], v[148:151]
v_mfma_f32_16x16x32_bf16 v[148:151], a[156:159], v[44:47], v[148:151]
s_nop 7
v_max3_f32 v125, v125, v148, v149
v_max3_f32 v125, v125, v150, v151
Lsa94:
s_add_u32 s73, s75, 0
s_cmp_lt_u32 s73, s83
s_cbranch_scc1 Lsa97
s_cmp_eq_u32 s73, s83
s_cbranch_scc1 Lst98
v_mfma_f32_16x16x32_bf16 v[152:155], a[144:147], v[48:51], 0
s_branch Lsj99
Lst98:
v_mfma_f32_16x16x32_bf16 v[152:155], a[144:147], v[48:51], v[116:119]
Lsj99:
v_mfma_f32_16x16x32_bf16 v[152:155], a[148:151], v[52:55], v[152:155]
v_mfma_f32_16x16x32_bf16 v[152:155], a[152:155], v[56:59], v[152:155]
v_mfma_f32_16x16x32_bf16 v[152:155], a[156:159], v[60:63], v[152:155]
s_nop 7
v_max3_f32 v126, v126, v152, v153
v_max3_f32 v126, v126, v154, v155
Lsa97:
s_add_u32 s73, s75, 4
s_cmp_lt_u32 s73, s83
s_cbranch_scc1 Lsa100
s_cmp_eq_u32 s73, s83
s_cbranch_scc1 Lst101
v_mfma_f32_16x16x32_bf16 v[156:159], a[144:147], v[64:67], 0
s_branch Lsj102
Lst101:
v_mfma_f32_16x16x32_bf16 v[156:159], a[144:147], v[64:67], v[116:119]
Lsj102:
v_mfma_f32_16x16x32_bf16 v[156:159], a[148:151], v[68:71], v[156:159]
v_mfma_f32_16x16x32_bf16 v[156:159], a[152:155], v[72:75], v[156:159]
v_mfma_f32_16x16x32_bf16 v[156:159], a[156:159], v[76:79], v[156:159]
s_nop 7
v_max3_f32 v127, v127, v156, v157
v_max3_f32 v127, v127, v158, v159
Lsa100:
s_add_u32 s83, s83, 1
s_barrier
s_cmp_lt_u32 s83, s76
s_cbranch_scc1 Lslow1
s_lshl_b32 s81, s59, 20
s_add_u32 s81, s81, s64
s_sub_u32 s81, s81, 0x4000
s_add_u32 m0, s64, 49152
s_add_u32 s72, s81, 16384
buffer_load_dwordx4 v1, s[44:47], s72 offen sc1 lds
buffer_load_dwordx4 v1, s[44:47], s72 offen offset:1024 sc1 lds
buffer_load_dwordx4 v1, s[44:47], s72 offen offset:2048 sc1 lds
buffer_load_dwordx4 v1, s[44:47], s72 offen offset:3072 sc1 lds
s_add_u32 s81, s81, 0x8000
s_add_u32 m0, s64, 81920
s_add_u32 s72, s81, 16384
buffer_load_dwordx4 v1, s[44:47], s72 offen sc1 lds
buffer_load_dwordx4 v1, s[44:47], s72 offen offset:1024 sc1 lds
buffer_load_dwordx4 v1, s[44:47], s72 offen offset:2048 sc1 lds
buffer_load_dwordx4 v1, s[44:47], s72 offen offset:3072 sc1 lds
s_add_u32 m0, s64, 65536
s_add_u32 s72, s81, 0
buffer_load_dwordx4 v1, s[44:47], s72 offen sc1 lds
buffer_load_dwordx4 v1, s[44:47], s72 offen offset:1024 sc1 lds
buffer_load_dwordx4 v1, s[44:47], s72 offen offset:2048 sc1 lds
buffer_load_dwordx4 v1, s[44:47], s72 offen offset:3072 sc1 lds
s_add_u32 s81, s81, 0x8000
s_add_u32 m0, s64, 114688
s_add_u32 s72, s81, 16384
buffer_load_dwordx4 v1, s[44:47], s72 offen sc1 lds
buffer_load_dwordx4 v1, s[44:47], s72 offen offset:1024 sc1 lds
buffer_load_dwordx4 v1, s[44:47], s72 offen offset:2048 sc1 lds
buffer_load_dwordx4 v1, s[44:47], s72 offen offset:3072 sc1 lds
s_add_u32 m0, s64, 98304
s_add_u32 s72, s81, 0
buffer_load_dwordx4 v1, s[44:47], s72 offen sc1 lds
buffer_load_dwordx4 v1, s[44:47], s72 offen offset:1024 sc1 lds
buffer_load_dwordx4 v1, s[44:47], s72 offen offset:2048 sc1 lds
buffer_load_dwordx4 v1, s[44:47], s72 offen offset:3072 sc1 lds
v_add_u32 v2, 0x8000, v1
v_lshrrev_b32 v3, 1, v0
v_lshlrev_b32 v3, 7, v3
s_waitcnt vmcnt(0)
s_barrier
v_accvgpr_write_b32 a32, 0
v_accvgpr_write_b32 a33, 0
v_accvgpr_write_b32 a34, 0
v_accvgpr_write_b32 a35, 0
v_accvgpr_write_b32 a36, 0
v_accvgpr_write_b32 a37, 0
v_accvgpr_write_b32 a38, 0
v_accvgpr_write_b32 a39, 0
v_accvgpr_write_b32 a40, 0
v_accvgpr_write_b32 a41, 0
v_accvgpr_write_b32 a42, 0
v_accvgpr_write_b32 a43, 0
v_accvgpr_write_b32 a44, 0
v_accvgpr_write_b32 a45, 0
v_accvgpr_write_b32 a46, 0
v_accvgpr_write_b32 a47, 0
v_accvgpr_write_b32 a48, 0
v_accvgpr_write_b32 a49, 0
v_accvgpr_write_b32 a50, 0
v_accvgpr_write_b32 a51, 0
v_accvgpr_write_b32 a52, 0
v_accvgpr_write_b32 a53, 0
v_accvgpr_write_b32 a54, 0
v_accvgpr_write_b32 a55, 0
v_accvgpr_write_b32 a56, 0
v_accvgpr_write_b32 a57, 0
v_accvgpr_write_b32 a58, 0
v_accvgpr_write_b32 a59, 0
v_accvgpr_write_b32 a60, 0
v_accvgpr_write_b32 a61, 0
v_accvgpr_write_b32 a62, 0
v_accvgpr_write_b32 a63, 0
v_accvgpr_write_b32 a96, 0
v_accvgpr_write_b32 a97, 0
v_accvgpr_write_b32 a98, 0
v_accvgpr_write_b32 a99, 0
v_accvgpr_write_b32 a100, 0
v_accvgpr_write_b32 a101, 0
v_accvgpr_write_b32 a102, 0
v_accvgpr_write_b32 a103, 0
v_accvgpr_write_b32 a104, 0
v_accvgpr_write_b32 a105, 0
v_accvgpr_write_b32 a106, 0
v_accvgpr_write_b32 a107, 0
v_accvgpr_write_b32 a108, 0
v_accvgpr_write_b32 a109, 0
v_accvgpr_write_b32 a110, 0
v_accvgpr_write_b32 a111, 0
v_accvgpr_write_b32 a112, 0
v_accvgpr_write_b32 a113, 0
v_accvgpr_write_b32 a114, 0
v_accvgpr_write_b32 a115, 0
v_accvgpr_write_b32 a116, 0
v_accvgpr_write_b32 a117, 0
v_accvgpr_write_b32 a118, 0
v_accvgpr_write_b32 a119, 0
v_accvgpr_write_b32 a120, 0
v_accvgpr_write_b32 a121, 0
v_accvgpr_write_b32 a122, 0
v_accvgpr_write_b32 a123, 0
v_accvgpr_write_b32 a124, 0
v_accvgpr_write_b32 a125, 0
v_accvgpr_write_b32 a126, 0
v_accvgpr_write_b32 a127, 0
ds_read_b128 a[128:131], v2 offset:16384
ds_read_b128 a[132:135], v2 offset:17408
ds_read_b128 a[136:139], v2 offset:18432
ds_read_b128 a[140:143], v2 offset:19456
ds_read_b128 a[144:147], v2 offset:20480
ds_read_b128 a[148:151], v2 offset:21504
ds_read_b128 a[152:155], v2 offset:22528
ds_read_b128 a[156:159], v2 offset:23552
s_branch Lattn
Lspin103:
s_mov_b32 s83, 262144
Lsl105:
s_sleep 2
buffer_load_dword v3, v2, s[44:47], s82 offen sc1
s_sub_u32 s83, s83, 1
s_cmp_eq_u32 s83, 0
s_waitcnt vmcnt(0)
s_cbranch_scc1 Lback104
v_cmp_gt_u32 vcc, 2, v3
s_cbranch_vccnz Lsl105
s_branch Lback104
Lspin106:
s_mov_b32 s83, 262144
Lsl108:
s_sleep 2
buffer_load_dword v3, v2, s[44:47], s82 offen sc1
s_sub_u32 s83, s83, 1
s_cmp_eq_u32 s83, 0
s_waitcnt vmcnt(0)
s_cbranch_scc1 Lback107
v_cmp_gt_u32 vcc, 2, v3
s_cbranch_vccnz Lsl108
s_branch Lback107
Lredo0:
s_xor_b32 s82, s78, 0
s_lshl_b32 s82, s82, 10
s_add_u32 s82, s82, s74
buffer_load_dword v3, v2, s[44:47], s82 offen sc1
s_waitcnt vmcnt(0)
v_cmp_gt_u32 vcc, 2, v3
s_cbranch_vccnz Lspin103
Lback104:
s_lshr_b32 s69, s12, 18
s_lshl_b32 s69, s69, 12
s_add_u32 s69, s69, s95
buffer_load_dwordx4 a[0:3], v1, s[44:47], s69 offen sc1
buffer_load_dwordx4 a[4:7], v1, s[44:47], s69 offen offset:1024 sc1
buffer_load_dwordx4 a[8:11], v1, s[44:47], s69 offen offset:2048 sc1
buffer_load_dwordx4 a[12:15], v1, s[44:47], s69 offen offset:3072 sc1
s_add_u32 s69, s69, 0x20000
buffer_load_dwordx4 a[16:19], v1, s[44:47], s69 offen sc1
buffer_load_dwordx4 a[20:23], v1, s[44:47], s69 offen offset:1024 sc1
buffer_load_dwordx4 a[24:27], v1, s[44:47], s69 offen offset:2048 sc1
buffer_load_dwordx4 a[28:31], v1, s[44:47], s69 offen offset:3072 sc1
s_lshr_b32 s69, s13, 18
s_lshl_b32 s69, s69, 12
s_add_u32 s69, s69, s95
buffer_load_dwordx4 a[32:35], v1, s[44:47], s69 offen sc1
buffer_load_dwordx4 a[36:39], v1, s[44:47], s69 offen offset:1024 sc1
buffer_load_dwordx4 a[40:43], v1, s[44:47], s69 offen offset:2048 sc1
buffer_load_dwordx4 a[44:47], v1, s[44:47], s69 offen offset:3072 sc1
s_add_u32 s69, s69, 0x20000
buffer_load_dwordx4 a[48:51], v1, s[44:47], s69 offen sc1
buffer_load_dwordx4 a[52:55], v1, s[44:47], s69 offen offset:1024 sc1
buffer_load_dwordx4 a[56:59], v1, s[44:47], s69 offen offset:2048 sc1
buffer_load_dwordx4 a[60:63], v1, s[44:47], s69 offen offset:3072 sc1
s_waitcnt vmcnt(8)
s_branch Lredo0b
Lspin109:
s_mov_b32 s83, 262144
Lsl111:
s_sleep 2
buffer_load_dword v114, v115, s[44:47], s84 offen sc1
s_sub_u32 s83, s83, 1
s_cmp_eq_u32 s83, 0
s_waitcnt vmcnt(0)
s_cbranch_scc1 Lback110
v_cmp_gt_u32 vcc, 3, v114
s_cbranch_vccnz Lsl111
s_branch Lback110
Lspin112:
s_mov_b32 s83, 262144
Lsl114:
s_sleep 2
buffer_load_dword v14, v13, s[44:47], s79 offen sc1
s_sub_u32 s83, s83, 1
s_cmp_eq_u32 s83, 0
s_waitcnt vmcnt(0)
s_cbranch_scc1 Lback113
v_cmp_gt_u32 vcc, 2, v14
s_cbranch_vccnz Lsl114
s_branch Lback113
Lxspin1:
s_mov_b32 s83, 262144
Lxsl1:
buffer_load_dwordx4 v[96:99], v1, s[44:47], s79 offen sc1
buffer_load_dwordx4 v[100:103], v1, s[44:47], s79 offen offset:1024 sc1
buffer_load_dwordx4 v[104:107], v1, s[44:47], s79 offen offset:2048 sc1
buffer_load_dwordx4 v[108:111], v1, s[44:47], s79 offen offset:3072 sc1
s_sub_u32 s83, s83, 1
s_cmp_eq_u32 s83, 0
s_waitcnt vmcnt(0)
s_cbranch_scc1 Lxback1
v_max3_u32 v12, v96, v97, v98
v_max3_u32 v13, v99, v100, v101
v_max3_u32 v12, v12, v102, v103
v_max3_u32 v13, v13, v104, v105
v_max3_u32 v12, v12, v106, v107
v_max3_u32 v13, v13, v108, v109
v_max3_u32 v12, v12, v110, v111
v_max_u32 v12, v12, v13
v_cmp_le_u32 vcc, 0xff800000, v12
s_cbranch_vccnz Lxsl1
s_branch Lxback1
Lxspin2:
s_mov_b32 s83, 262144
Lxsl2:
buffer_load_dwordx4 v[80:83], v1, s[44:47], s82 offen sc1
buffer_load_dwordx4 v[84:87], v1, s[44:47], s82 offen offset:1024 sc1
buffer_load_dwordx4 v[88:91], v1, s[44:47], s82 offen offset:2048 sc1
buffer_load_dwordx4 v[92:95], v1, s[44:47], s82 offen offset:3072 sc1
s_sub_u32 s83, s83, 1
s_cmp_eq_u32 s83, 0
s_waitcnt vmcnt(0)
s_cbranch_scc1 Lxback2
v_max3_u32 v12, v80, v81, v82
v_max3_u32 v13, v83, v84, v85
v_max3_u32 v12, v12, v86, v87
v_max3_u32 v13, v13, v88, v89
v_max3_u32 v12, v12, v90, v91
v_max3_u32 v13, v13, v92, v93
v_max3_u32 v12, v12, v94, v95
v_max_u32 v12, v12, v13
v_cmp_le_u32 vcc, 0xff800000, v12
s_cbranch_vccnz Lxsl2
s_branch Lxback2
Lxspin3:
s_mov_b32 s83, 262144
Lxsl3:
buffer_load_dwordx4 v[96:99], v1, s[44:47], s81 offen sc1
buffer_load_dwordx4 v[100:103], v1, s[44:47], s81 offen offset:1024 sc1
buffer_load_dwordx4 v[104:107], v1, s[44:47], s81 offen offset:2048 sc1
buffer_load_dwordx4 v[108:111], v1, s[44:47], s81 offen offset:3072 sc1
s_sub_u32 s83, s83, 1
s_cmp_eq_u32 s83, 0
s_waitcnt vmcnt(0)
s_cbranch_scc1 Lxback3
v_max3_u32 v12, v96, v97, v98
v_max3_u32 v13, v99, v100, v101
v_max3_u32 v12, v12, v102, v103
v_max3_u32 v13, v13, v104, v105
v_max3_u32 v12, v12, v106, v107
v_max3_u32 v13, v13, v108, v109
v_max3_u32 v12, v12, v110, v111
v_max_u32 v12, v12, v13
v_cmp_le_u32 vcc, 0xff800000, v12
s_cbranch_vccnz Lxsl3
s_branch Lxback3
Lcode_end:
s_endpgm
.section .rodata,"a"
.p2align 6
.amdhsa_kernel gated_mix__compressed_kv_cla__ssm_conv_h3__prompt_kernel
  .amdhsa_next_free_vgpr 512
  .amdhsa_next_free_sgpr 102
  .amdhsa_accum_offset 256
  .amdhsa_group_segment_fixed_size 0
  .amdhsa_kernarg_size 128
  .amdhsa_user_sgpr_count 2
  .amdhsa_user_sgpr_kernarg_segment_ptr 1
  .amdhsa_system_sgpr_workgroup_id_x 1
  .amdhsa_float_denorm_mode_32 3
.end_amdhsa_kernel
```

```asm
; @launch grid=(256,1,1) block=(256,1,1) lds=163840
.amdgcn_target "amdgcn-amd-amdhsa--gfx950"
.text
.globl gated_mix__compressed_kv_cla__ssm_conv_h3__prompt_kernel
.p2align 8
.type gated_mix__compressed_kv_cla__ssm_conv_h3__prompt_kernel,@function
gated_mix__compressed_kv_cla__ssm_conv_h3__prompt_kernel:
s_cmp_ge_u32 s2, 256
s_cbranch_scc1 Lend
s_load_dwordx2 s[8:9], s[0:1], 8
s_load_dwordx2 s[16:17], s[0:1], 24
s_load_dwordx2 s[20:21], s[0:1], 32
s_lshr_b32 s75, s2, 3
v_mul_u32_u24 v31, 18, v0
s_getpc_b64 s[98:99]
Lpc0:
s_mul_i32 s74, s75, 4608
v_and_b32 v31, 0x1f80, v31
v_add_u32 v31, s74, v31
v_min_u32 v31, Lcode_end-Lpc0, v31
global_load_dword v31, v31, s[98:99]
v_lshrrev_b32 v26, 6, v0
v_and_b32 v0, 63, v0
s_lshr_b32 s65, s75, 3
v_readfirstlane_b32 s58, v26
s_and_b32 s60, s75, 7
s_lshl_b32 s61, s65, 1
s_lshl_b32 s63, s58, 13
s_lshl_b32 s67, s60, 18
s_lshl_b32 s76, s58, 16
s_add_u32 s84, s67, s76
v_lshrrev_b32 v26, 4, v0
v_and_b32 v27, 7, v0
v_xor_b32 v27, v27, v26
v_lshlrev_b32 v27, 4, v27
v_lshrrev_b32 v28, 3, v0
v_lshl_add_u32 v2, v28, 10, v27
v_xor_b32 v3, 64, v2
s_mov_b32 s66, 0
s_mov_b32 s10, 0x200000
s_mov_b32 s11, 0x20000
s_mov_b32 s18, 0x400000
s_mov_b32 s19, 0x20000
s_mov_b32 s22, 0x400000
s_mov_b32 s23, 0x20000
s_and_b32 s73, s2, 7
s_lshl_b32 s73, s73, 2
s_add_u32 s59, s73, s65
s_lshl_b32 s64, s58, 12
s_lshl_b32 s66, s58, 17
s_lshr_b32 s73, 0x67234501, s73
s_and_b32 s73, s73, 7
s_lshl_b32 s74, s65, 3
s_add_u32 s73, s73, s74
s_lshl_b32 s73, s73, 8
s_add_u32 s66, s66, s73
v_and_b32 v29, 15, v0
v_lshlrev_b32 v30, 1, v26
v_xor_b32 v30, v30, v29
v_lshlrev_b32 v30, 4, v30
v_lshl_add_u32 v6, v26, 13, v30
v_xor_b32 v7, 0x80, v6
s_and_b32 s73, s65, 1
s_xor_b32 s73, s73, 0
s_lshl_b32 s69, s73, 7
s_add_u32 s69, s69, s84
s_lshl_b32 s71, s73, 19
s_add_u32 s71, s71, s66
s_add_u32 m0, s63, 65536
s_add_u32 s72, s69, 0
s_waitcnt lgkmcnt(0)
buffer_load_dwordx4 v2, s[8:11], s72 offen lds
s_add_u32 s72, s69, 7168
buffer_load_dwordx4 v3, s[8:11], s72 offen offset:1024 lds
s_add_u32 s72, s69, 14336
buffer_load_dwordx4 v2, s[8:11], s72 offen offset:2048 lds
s_add_u32 s72, s69, 21504
buffer_load_dwordx4 v3, s[8:11], s72 offen offset:3072 lds
s_add_u32 m0, s64, 0
s_add_u32 s72, s71, 0
buffer_load_dwordx4 v6, s[16:19], s72 offen lds
s_add_u32 s72, s71, 31744
buffer_load_dwordx4 v6, s[16:19], s72 offen offset:1024 lds
s_add_u32 s72, s71, 63488
buffer_load_dwordx4 v7, s[16:19], s72 offen offset:2048 lds
s_add_u32 s72, s71, 95232
buffer_load_dwordx4 v7, s[16:19], s72 offen offset:3072 lds
s_add_u32 m0, s63, 69632
s_add_u32 s72, s69, 32768
buffer_load_dwordx4 v2, s[8:11], s72 offen lds
s_add_u32 s72, s69, 39936
buffer_load_dwordx4 v3, s[8:11], s72 offen offset:1024 lds
s_add_u32 s72, s69, 47104
buffer_load_dwordx4 v2, s[8:11], s72 offen offset:2048 lds
s_add_u32 s72, s69, 54272
buffer_load_dwordx4 v3, s[8:11], s72 offen offset:3072 lds
s_add_u32 m0, s64, 16384
s_add_u32 s72, s71, 0
buffer_load_dwordx4 v6, s[20:23], s72 offen lds
s_add_u32 s72, s71, 31744
buffer_load_dwordx4 v6, s[20:23], s72 offen offset:1024 lds
s_add_u32 s72, s71, 63488
buffer_load_dwordx4 v7, s[20:23], s72 offen offset:2048 lds
s_add_u32 s72, s71, 95232
buffer_load_dwordx4 v7, s[20:23], s72 offen offset:3072 lds
s_load_dwordx2 s[4:5], s[0:1], 0
s_load_dwordx2 s[12:13], s[0:1], 16
s_load_dwordx2 s[24:25], s[0:1], 40
s_load_dwordx2 s[28:29], s[0:1], 56
s_load_dwordx2 s[32:33], s[0:1], 64
s_load_dwordx2 s[52:53], s[0:1], 72
s_load_dwordx2 s[36:37], s[0:1], 80
s_load_dwordx2 s[54:55], s[0:1], 88
s_load_dwordx2 s[56:57], s[0:1], 96
s_load_dwordx2 s[40:41], s[0:1], 104
s_load_dwordx2 s[48:49], s[0:1], 112
s_load_dwordx2 s[44:45], s[0:1], 120
s_lshl_b32 s73, s2, 2
s_add_u32 s73, s73, s58
s_lshl_b32 s73, s73, 11
v_lshrrev_b32 v124, 2, v0
v_lshlrev_b32 v124, 7, v124
v_add_u32 v124, s73, v124
s_lshr_b32 s73, s2, 3
s_lshl_b32 s73, s73, 2
s_add_u32 s73, s73, s58
s_lshl_b32 s73, s73, 13
s_and_b32 s74, s66, 0x700
s_add_u32 s73, s73, s74
v_lshrrev_b32 v125, 4, v0
v_lshlrev_b32 v125, 11, v125
v_bfe_u32 v126, v0, 3, 1
v_lshl_add_u32 v125, v126, 7, v125
v_add_u32 v125, s73, v125
s_mov_b32 s80, 0x0
buffer_load_dword v126, v125, s[16:19], s80 offen
buffer_load_dword v126, v125, s[20:23], s80 offen
buffer_load_dword v126, v124, s[8:11], 0 offen
s_and_b32 s73, s65, 1
s_xor_b32 s73, s73, 1
s_lshl_b32 s69, s73, 7
s_add_u32 s69, s69, s84
s_lshl_b32 s71, s73, 19
s_add_u32 s71, s71, s66
s_add_u32 m0, s63, 98304
s_add_u32 s72, s69, 0
buffer_load_dwordx4 v2, s[8:11], s72 offen lds
s_add_u32 s72, s69, 7168
buffer_load_dwordx4 v3, s[8:11], s72 offen offset:1024 lds
s_add_u32 s72, s69, 14336
buffer_load_dwordx4 v2, s[8:11], s72 offen offset:2048 lds
s_add_u32 s72, s69, 21504
buffer_load_dwordx4 v3, s[8:11], s72 offen offset:3072 lds
s_lshl_b32 s91, s59, 3
s_add_u32 s91, s91, s60
s_lshl_b32 s93, s91, 2
s_add_u32 s93, s93, s58
s_lshl_b32 s75, s93, 1
s_and_b32 s75, s75, 0xffc
s_lshl_b32 s93, s93, 12
s_waitcnt lgkmcnt(0)
s_load_dwordx2 s[88:89], s[36:37], s93
s_load_dword s90, s[54:55], s75
v_lshrrev_b32 v16, 1, v29
v_xor_b32 v16, v16, v26
v_lshlrev_b32 v16, 4, v16
v_lshl_add_u32 v16, v29, 7, v16
s_lshr_b32 s73, s58, 1
s_lshl_b32 s74, s73, 14
s_add_u32 s74, s74, 0x10000
v_add_u32 v24, s74, v16
v_xor_b32 v25, 64, v24
v_lshrrev_b32 v8, 2, v29
v_and_b32 v9, 1, v26
v_lshl_add_u32 v9, v9, 2, v8
v_lshl_add_u32 v8, v26, 3, v8
v_lshlrev_b32 v8, 8, v8
v_lshl_add_u32 v8, v9, 5, v8
v_and_b32 v29, 3, v0
v_lshl_add_u32 v8, v29, 3, v8
s_and_b32 s74, s58, 1
s_lshl_b32 s75, s74, 7
v_xor_b32 v20, s75, v8
v_xor_b32 v21, 32, v20
v_xor_b32 v22, 64, v20
v_xor_b32 v23, 96, v20
s_waitcnt vmcnt(7) lgkmcnt(0)
s_barrier
ds_read_b64_tr_b16 v[224:225], v20 offset:0
ds_read_b64_tr_b16 v[226:227], v20 offset:1024
ds_read_b64_tr_b16 v[228:229], v20 offset:8192
ds_read_b64_tr_b16 v[230:231], v20 offset:9216
ds_read_b128 v[128:131], v24 offset:0
ds_read_b128 v[132:135], v25 offset:0
ds_read_b128 v[136:139], v24 offset:2048
ds_read_b128 v[140:143], v25 offset:2048
ds_read_b128 v[144:147], v24 offset:4096
ds_read_b128 v[148:151], v25 offset:4096
ds_read_b128 v[152:155], v24 offset:6144
ds_read_b128 v[156:159], v25 offset:6144
s_waitcnt lgkmcnt(6)
v_mfma_f32_16x16x32_bf16 a[0:3], v[224:227], v[128:131], 0
s_add_u32 m0, s64, 32768
ds_read_b128 v[160:163], v24 offset:8192
v_mfma_f32_16x16x32_bf16 a[0:3], v[228:231], v[132:135], a[0:3]
s_waitcnt lgkmcnt(5)
ds_read_b128 v[164:167], v25 offset:8192
v_mfma_f32_16x16x32_bf16 a[4:7], v[228:231], v[140:143], 0
s_add_u32 s72, s71, 0
ds_read_b128 v[168:171], v24 offset:10240
v_mfma_f32_16x16x32_bf16 a[4:7], v[224:227], v[136:139], a[4:7]
s_waitcnt lgkmcnt(5)
ds_read_b128 v[172:175], v25 offset:10240
v_mfma_f32_16x16x32_bf16 a[8:11], v[224:227], v[144:147], 0
s_mov_b32 s6, 0x400000
ds_read_b128 v[176:179], v24 offset:12288
v_mfma_f32_16x16x32_bf16 a[8:11], v[228:231], v[148:151], a[8:11]
s_waitcnt lgkmcnt(5)
ds_read_b128 v[180:183], v25 offset:12288
v_mfma_f32_16x16x32_bf16 a[12:15], v[228:231], v[156:159], 0
s_mov_b32 s7, 0x20000
ds_read_b128 v[184:187], v24 offset:14336
v_mfma_f32_16x16x32_bf16 a[12:15], v[224:227], v[152:155], a[12:15]
s_waitcnt lgkmcnt(5)
ds_read_b128 v[188:191], v25 offset:14336
v_mfma_f32_16x16x32_bf16 a[16:19], v[224:227], v[160:163], 0
s_mov_b32 s14, 0x800000
ds_read_b64_tr_b16 v[232:233], v21 offset:0
ds_read_b64_tr_b16 v[234:235], v21 offset:1024
v_mfma_f32_16x16x32_bf16 a[16:19], v[228:231], v[164:167], a[16:19]
s_waitcnt lgkmcnt(6)
ds_read_b64_tr_b16 v[236:237], v21 offset:8192
ds_read_b64_tr_b16 v[238:239], v21 offset:9216
v_mfma_f32_16x16x32_bf16 a[20:23], v[228:231], v[172:175], 0
s_mov_b32 s15, 0x20000
buffer_load_dwordx4 v6, s[16:19], s72 offen lds
v_mfma_f32_16x16x32_bf16 a[20:23], v[224:227], v[168:171], a[20:23]
s_waitcnt lgkmcnt(6)
ds_read_b64_tr_b16 v[240:241], v22 offset:0
ds_read_b64_tr_b16 v[242:243], v22 offset:1024
v_mfma_f32_16x16x32_bf16 a[24:27], v[224:227], v[176:179], 0
s_add_u32 s72, s71, 31744
buffer_load_dwordx4 v6, s[16:19], s72 offen offset:1024 lds
v_mfma_f32_16x16x32_bf16 a[24:27], v[228:231], v[180:183], a[24:27]
s_waitcnt lgkmcnt(6)
ds_read_b64_tr_b16 v[244:245], v22 offset:8192
ds_read_b64_tr_b16 v[246:247], v22 offset:9216
v_mfma_f32_16x16x32_bf16 a[28:31], v[228:231], v[188:191], 0
s_add_u32 s72, s71, 63488
buffer_load_dwordx4 v7, s[16:19], s72 offen offset:2048 lds
v_mfma_f32_16x16x32_bf16 a[28:31], v[224:227], v[184:187], a[28:31]
s_waitcnt lgkmcnt(4)
v_mfma_f32_16x16x32_bf16 a[60:63], v[232:235], v[184:187], 0
s_add_u32 s72, s71, 95232
buffer_load_dwordx4 v7, s[16:19], s72 offen offset:3072 lds
v_mfma_f32_16x16x32_bf16 a[60:63], v[236:239], v[188:191], a[60:63]
s_mov_b32 s26, 0x800000
ds_read_b64_tr_b16 v[248:249], v23 offset:0
v_mfma_f32_16x16x32_bf16 a[56:59], v[236:239], v[180:183], 0
s_mov_b32 s27, 0x20000
v_mfma_f32_16x16x32_bf16 a[56:59], v[232:235], v[176:179], a[56:59]
s_mov_b32 s30, 0x400000
ds_read_b64_tr_b16 v[250:251], v23 offset:1024
v_mfma_f32_16x16x32_bf16 a[52:55], v[232:235], v[168:171], 0
s_add_u32 m0, s63, 102400
v_mfma_f32_16x16x32_bf16 a[52:55], v[236:239], v[172:175], a[52:55]
s_add_u32 s72, s69, 32768
buffer_load_dwordx4 v2, s[8:11], s72 offen lds
v_mfma_f32_16x16x32_bf16 a[48:51], v[236:239], v[164:167], 0
s_mov_b32 s31, 0x20000
v_mfma_f32_16x16x32_bf16 a[48:51], v[232:235], v[160:163], a[48:51]
s_mov_b32 s34, 0x400000
ds_read_b64_tr_b16 v[252:253], v23 offset:8192
v_mfma_f32_16x16x32_bf16 a[44:47], v[232:235], v[152:155], 0
s_mov_b32 s35, 0x20000
v_mfma_f32_16x16x32_bf16 a[44:47], v[236:239], v[156:159], a[44:47]
s_add_u32 s72, s69, 39936
buffer_load_dwordx4 v3, s[8:11], s72 offen offset:1024 lds
v_mfma_f32_16x16x32_bf16 a[40:43], v[236:239], v[148:151], 0
s_mov_b32 s38, 0x400000
v_mfma_f32_16x16x32_bf16 a[40:43], v[232:235], v[144:147], a[40:43]
s_mov_b32 s39, 0x20000
ds_read_b64_tr_b16 v[254:255], v23 offset:9216
v_mfma_f32_16x16x32_bf16 a[36:39], v[232:235], v[136:139], 0
s_mov_b32 s42, 0x400000
v_mfma_f32_16x16x32_bf16 a[36:39], v[236:239], v[140:143], a[36:39]
s_mov_b32 s43, 0x20000
v_mfma_f32_16x16x32_bf16 a[32:35], v[236:239], v[132:135], 0
s_add_u32 s72, s69, 47104
buffer_load_dwordx4 v2, s[8:11], s72 offen offset:2048 lds
v_mfma_f32_16x16x32_bf16 a[32:35], v[232:235], v[128:131], a[32:35]
s_waitcnt lgkmcnt(4)
v_mfma_f32_16x16x32_bf16 a[64:67], v[240:243], v[128:131], 0
s_mov_b32 s46, 0x5800000
ds_read_b64_tr_b16 v[224:225], v20 offset:16384
v_mfma_f32_16x16x32_bf16 a[64:67], v[244:247], v[132:135], a[64:67]
s_mov_b32 s47, 0x20000
v_mfma_f32_16x16x32_bf16 a[68:71], v[244:247], v[140:143], 0
s_mov_b32 s50, 0x100
ds_read_b64_tr_b16 v[226:227], v20 offset:17408
v_mfma_f32_16x16x32_bf16 a[68:71], v[240:243], v[136:139], a[68:71]
s_add_u32 s72, s69, 54272
buffer_load_dwordx4 v3, s[8:11], s72 offen offset:3072 lds
v_mfma_f32_16x16x32_bf16 a[72:75], v[240:243], v[144:147], 0
s_mov_b32 s51, 0x20000
v_lshl_add_u32 v4, v28, 11, v27
v_xor_b32 v5, 64, v4
v_mfma_f32_16x16x32_bf16 a[72:75], v[244:247], v[148:151], a[72:75]
v_lshlrev_b32 v1, 4, v0
v_mfma_f32_16x16x32_bf16 a[76:79], v[244:247], v[156:159], 0
s_sub_u32 s74, 15, s60
ds_read_b64_tr_b16 v[228:229], v20 offset:24576
v_mfma_f32_16x16x32_bf16 a[76:79], v[240:243], v[152:155], a[76:79]
s_lshl_b32 s68, s74, 18
v_mfma_f32_16x16x32_bf16 a[80:83], v[240:243], v[160:163], 0
s_add_u32 m0, s64, 49152
v_mfma_f32_16x16x32_bf16 a[80:83], v[244:247], v[164:167], a[80:83]
s_add_u32 s72, s71, 0
buffer_load_dwordx4 v6, s[20:23], s72 offen lds
v_mfma_f32_16x16x32_bf16 a[84:87], v[244:247], v[172:175], 0
s_lshl_b32 s76, s58, 15
ds_read_b64_tr_b16 v[230:231], v20 offset:25600
v_mfma_f32_16x16x32_bf16 a[84:87], v[240:243], v[168:171], a[84:87]
s_add_u32 s68, s68, s76
v_mfma_f32_16x16x32_bf16 a[88:91], v[240:243], v[176:179], 0
s_add_u32 s67, s67, s76
v_mfma_f32_16x16x32_bf16 a[88:91], v[244:247], v[180:183], a[88:91]
s_add_u32 s72, s71, 31744
buffer_load_dwordx4 v6, s[20:23], s72 offen offset:1024 lds
v_mfma_f32_16x16x32_bf16 a[92:95], v[244:247], v[188:191], 0
s_and_b32 s62, s60, 3
v_mfma_f32_16x16x32_bf16 a[92:95], v[240:243], v[184:187], a[92:95]
s_waitcnt lgkmcnt(4)
v_mfma_f32_16x16x32_bf16 a[124:127], v[248:251], v[184:187], 0
s_sub_u32 s62, 16, s62
ds_read_b64_tr_b16 v[232:233], v21 offset:16384
v_mfma_f32_16x16x32_bf16 a[124:127], v[252:255], v[188:191], a[124:127]
s_lshl_b32 s91, s91, 7
v_mfma_f32_16x16x32_bf16 a[120:123], v[252:255], v[180:183], 0
s_add_u32 s72, s71, 63488
buffer_load_dwordx4 v7, s[20:23], s72 offen offset:2048 lds
v_mfma_f32_16x16x32_bf16 a[120:123], v[248:251], v[176:179], a[120:123]
s_add_u32 s91, s91, 0x3810000
ds_read_b64_tr_b16 v[234:235], v21 offset:17408
v_lshrrev_b32 v34, 3, v0
v_mfma_f32_16x16x32_bf16 a[116:119], v[248:251], v[168:171], 0
v_or_b32 v34, s58, v34
v_min_u32 v34, 1, v34
v_mfma_f32_16x16x32_bf16 a[116:119], v[252:255], v[172:175], a[116:119]
v_lshlrev_b32 v34, 28, v34
v_add_lshl_u32 v34, v34, v0, 2
v_mfma_f32_16x16x32_bf16 a[112:115], v[252:255], v[164:167], 0
ds_read_b64_tr_b16 v[236:237], v21 offset:24576
v_mov_b32 v35, 0
v_mfma_f32_16x16x32_bf16 a[112:115], v[248:251], v[160:163], a[112:115]
s_add_u32 s72, s71, 95232
buffer_load_dwordx4 v7, s[20:23], s72 offen offset:3072 lds
v_mfma_f32_16x16x32_bf16 a[108:111], v[248:251], v[152:155], 0
s_mov_b32 s80, 0x100000
buffer_load_dword v126, v125, s[16:19], s80 offen
v_mfma_f32_16x16x32_bf16 a[108:111], v[252:255], v[156:159], a[108:111]
buffer_load_dword v126, v125, s[20:23], s80 offen
v_mfma_f32_16x16x32_bf16 a[104:107], v[252:255], v[148:151], 0
buffer_store_dword v35, v34, s[44:47], s91 offen sc1
v_mfma_f32_16x16x32_bf16 a[104:107], v[248:251], v[144:147], a[104:107]
s_xor_b32 s83, s2, 5
ds_read_b64_tr_b16 v[238:239], v21 offset:25600
v_mfma_f32_16x16x32_bf16 a[100:103], v[248:251], v[136:139], 0
s_and_b32 s83, s83, 15
v_mfma_f32_16x16x32_bf16 a[100:103], v[252:255], v[140:143], a[100:103]
s_lshr_b32 s74, s2, 4
v_mfma_f32_16x16x32_bf16 a[96:99], v[252:255], v[132:135], 0
s_lshl_b32 s74, s74, 7
v_mfma_f32_16x16x32_bf16 a[96:99], v[248:251], v[128:131], a[96:99]
s_waitcnt lgkmcnt(4)
v_mfma_f32_16x16x32_bf16 a[128:131], v[128:131], v[224:227], 0
s_lshl_b32 s75, s58, 5
ds_read_b64_tr_b16 v[240:241], v22 offset:16384
v_mfma_f32_16x16x32_bf16 a[128:131], v[132:135], v[228:231], a[128:131]
s_add_u32 s74, s74, s75
v_mfma_f32_16x16x32_bf16 a[132:135], v[140:143], v[228:231], 0
s_mov_b32 s75, 131072
v_lshrrev_b32 v29, 5, v0
v_lshlrev_b32 v29, 4, v29
v_mfma_f32_16x16x32_bf16 a[132:135], v[136:139], v[224:227], a[132:135]
ds_read_b64_tr_b16 v[242:243], v22 offset:17408
v_add_u32 v29, s74, v29
v_mfma_f32_16x16x32_bf16 a[136:139], v[144:147], v[224:227], 0
v_and_b32 v30, 31, v0
v_mfma_f32_16x16x32_bf16 a[136:139], v[148:151], v[228:231], a[136:139]
s_lshl_b32 s83, s83, 5
v_add_u32 v30, s83, v30
v_lshlrev_b32 v26, 11, v29
v_mfma_f32_16x16x32_bf16 a[140:143], v[156:159], v[228:231], 0
v_lshl_add_u32 v26, v30, 2, v26
v_subrev_u32 v27, 0x1800, v26
v_mfma_f32_16x16x32_bf16 a[140:143], v[152:155], v[224:227], a[140:143]
s_lshl_b32 s82, s74, 11
ds_read_b64_tr_b16 v[244:245], v22 offset:24576
v_mfma_f32_16x16x32_bf16 a[144:147], v[160:163], v[224:227], 0
s_lshl_b32 s83, s83, 2
v_mfma_f32_16x16x32_bf16 a[144:147], v[164:167], v[228:231], a[144:147]
s_add_u32 s82, s82, s83
v_lshrrev_b32 v26, 3, v0
v_and_b32 v32, 7, v0
v_mfma_f32_16x16x32_bf16 a[148:151], v[172:175], v[228:231], 0
ds_read_b64_tr_b16 v[246:247], v22 offset:25600
v_lshlrev_b32 v32, 4, v32
v_mfma_f32_16x16x32_bf16 a[148:151], v[168:171], v[224:227], a[148:151]
v_lshl_add_u32 v26, v26, 11, v32
v_lshrrev_b32 v98, 5, v0
v_mfma_f32_16x16x32_bf16 a[152:155], v[176:179], v[224:227], 0
v_lshlrev_b32 v98, 11, v98
v_and_b32 v32, 31, v0
v_mfma_f32_16x16x32_bf16 a[152:155], v[180:183], v[228:231], a[152:155]
v_lshl_add_u32 v98, v32, 2, v98
v_add_u32 v98, s63, v98
v_mfma_f32_16x16x32_bf16 a[156:159], v[188:191], v[228:231], 0
v_add_u32 v98, s75, v98
v_and_b32 v29, 0x7f, v29
v_mfma_f32_16x16x32_bf16 a[156:159], v[184:187], v[224:227], a[156:159]
s_waitcnt lgkmcnt(4)
v_sub_u32 v29, 0x70, v29
v_lshlrev_b32 v29, 1, v29
v_mfma_f32_16x16x32_bf16 a[188:191], v[184:187], v[232:235], 0
ds_read_b64_tr_b16 v[248:249], v23 offset:16384
v_and_b32 v32, 7, v0
v_mfma_f32_16x16x32_bf16 a[188:191], v[188:191], v[236:239], a[188:191]
v_mul_u32_u24 v32, 544, v32
v_add3_u32 v28, v32, v29, s75
v_mfma_f32_16x16x32_bf16 a[184:187], v[180:183], v[236:239], 0
ds_read_b64_tr_b16 v[250:251], v23 offset:17408
v_bfe_u32 v32, v0, 3, 2
v_mfma_f32_16x16x32_bf16 a[184:187], v[176:179], v[232:235], a[184:187]
v_lshl_add_u32 v28, v32, 13, v28
v_lshlrev_b32 v30, 4, v30
v_mfma_f32_16x16x32_bf16 a[180:183], v[168:171], v[232:235], 0
s_lshl_b32 s83, s2, 14
ds_read_b64_tr_b16 v[252:253], v23 offset:24576
v_mfma_f32_16x16x32_bf16 a[180:183], v[172:175], v[236:239], a[180:183]
s_lshl_b32 s74, s58, 12
v_mfma_f32_16x16x32_bf16 a[176:179], v[164:167], v[236:239], 0
s_add_u32 s76, s83, s74
ds_read_b64_tr_b16 v[254:255], v23 offset:25600
v_mfma_f32_16x16x32_bf16 a[176:179], v[160:163], v[232:235], a[176:179]
s_and_b32 s73, s65, 1
v_add_u32 v16, s63, v16
v_add_u32 v16, 131072, v16
v_mfma_f32_16x16x32_bf16 a[172:175], v[152:155], v[232:235], 0
s_xor_b32 s73, s73, 2
v_xor_b32 v17, 64, v16
v_subrev_u32 v18, 0x10000, v16
v_mfma_f32_16x16x32_bf16 a[172:175], v[156:159], v[236:239], a[172:175]
s_lshl_b32 s69, s73, 7
v_subrev_u32 v19, 0x10000, v17
v_xor_b32 v9, 32, v8
v_mfma_f32_16x16x32_bf16 a[168:171], v[148:151], v[236:239], 0
s_add_u32 s69, s69, s84
v_xor_b32 v10, 64, v8
v_xor_b32 v11, 96, v8
v_mfma_f32_16x16x32_bf16 a[168:171], v[144:147], v[232:235], a[168:171]
s_lshl_b32 s71, s73, 19
v_xor_b32 v12, 128, v8
v_xor_b32 v13, 160, v8
v_mfma_f32_16x16x32_bf16 a[164:167], v[136:139], v[232:235], 0
s_add_u32 s71, s71, s66
v_xor_b32 v14, 192, v8
v_xor_b32 v15, 224, v8
s_branch Lmain
.p2align 12
Lmain:
v_mfma_f32_16x16x32_bf16 a[164:167], v[140:143], v[236:239], a[164:167]
s_add_u32 m0, s63, 65536
v_mfma_f32_16x16x32_bf16 a[160:163], v[132:135], v[236:239], 0
s_waitcnt vmcnt(3) lgkmcnt(0)
v_mfma_f32_16x16x32_bf16 a[160:163], v[128:131], v[232:235], a[160:163]
s_barrier
v_mfma_f32_16x16x32_bf16 a[192:195], v[128:131], v[240:243], 0
s_add_u32 s72, s69, 0
buffer_load_dwordx4 v2, s[8:11], s72 offen lds
v_mfma_f32_16x16x32_bf16 a[192:195], v[132:135], v[244:247], a[192:195]
s_lshl_b32 s77, s59, 20
ds_read_b64_tr_b16 v[224:225], v20 offset:32768
v_mfma_f32_16x16x32_bf16 a[196:199], v[140:143], v[244:247], 0
s_add_u32 s81, s77, s64
ds_read_b64_tr_b16 v[226:227], v20 offset:33792
v_mfma_f32_16x16x32_bf16 a[196:199], v[136:139], v[240:243], a[196:199]
s_sub_u32 s81, s81, 0x4000
ds_read_b64_tr_b16 v[228:229], v20 offset:40960
v_mfma_f32_16x16x32_bf16 a[200:203], v[144:147], v[240:243], 0
s_add_u32 s72, s69, 7168
buffer_load_dwordx4 v3, s[8:11], s72 offen offset:1024 lds
v_mfma_f32_16x16x32_bf16 a[200:203], v[148:151], v[244:247], a[200:203]
s_lshl_b32 s75, s60, 17
ds_read_b64_tr_b16 v[230:231], v20 offset:41984
v_mfma_f32_16x16x32_bf16 a[204:207], v[156:159], v[244:247], 0
s_add_u32 s77, s77, s75
ds_read_b128 v[192:195], v24 offset:32768
v_mfma_f32_16x16x32_bf16 a[204:207], v[152:155], v[240:243], a[204:207]
s_lshr_b32 s75, s58, 1
ds_read_b128 v[196:199], v25 offset:32768
v_mfma_f32_16x16x32_bf16 a[208:211], v[160:163], v[240:243], 0
s_add_u32 s72, s69, 14336
buffer_load_dwordx4 v2, s[8:11], s72 offen offset:2048 lds
v_mfma_f32_16x16x32_bf16 a[208:211], v[164:167], v[244:247], a[208:211]
s_lshl_b32 s75, s75, 16
ds_read_b128 v[200:203], v24 offset:34816
v_mfma_f32_16x16x32_bf16 a[212:215], v[172:175], v[244:247], 0
s_add_u32 s77, s77, s75
ds_read_b128 v[204:207], v25 offset:34816
v_mfma_f32_16x16x32_bf16 a[212:215], v[168:171], v[240:243], a[212:215]
s_and_b32 s74, s58, 1
ds_read_b128 v[208:211], v24 offset:36864
v_mfma_f32_16x16x32_bf16 a[216:219], v[176:179], v[240:243], 0
s_add_u32 s72, s69, 21504
buffer_load_dwordx4 v3, s[8:11], s72 offen offset:3072 lds
v_mfma_f32_16x16x32_bf16 a[216:219], v[180:183], v[244:247], a[216:219]
s_lshl_b32 s75, s74, 12
ds_read_b128 v[212:215], v25 offset:36864
v_mfma_f32_16x16x32_bf16 a[220:223], v[188:191], v[244:247], 0
s_add_u32 s78, s77, s75
ds_read_b128 v[216:219], v24 offset:38912
v_mfma_f32_16x16x32_bf16 a[220:223], v[184:187], v[240:243], a[220:223]
s_add_u32 s78, s78, 0x4000
ds_read_b128 v[220:223], v25 offset:38912
v_mfma_f32_16x16x32_bf16 a[252:255], v[184:187], v[248:251], 0
s_add_u32 m0, s64, 0
v_mfma_f32_16x16x32_bf16 a[252:255], v[188:191], v[252:255], a[252:255]
s_add_u32 s72, s71, 0
buffer_load_dwordx4 v6, s[16:19], s72 offen lds
v_mfma_f32_16x16x32_bf16 a[248:251], v[180:183], v[252:255], 0
s_lshl_b32 s75, s74, 11
ds_read_b128 v[184:187], v24 offset:40960
v_mfma_f32_16x16x32_bf16 a[248:251], v[176:179], v[248:251], a[248:251]
s_add_u32 s77, s77, s75
ds_read_b128 v[188:191], v25 offset:40960
v_mfma_f32_16x16x32_bf16 a[244:247], v[168:171], v[248:251], 0
s_mov_b32 s79, 0x3e0293ee
v_mfma_f32_16x16x32_bf16 a[244:247], v[172:175], v[252:255], a[244:247]
s_add_u32 s72, s71, 31744
buffer_load_dwordx4 v6, s[16:19], s72 offen offset:1024 lds
v_mfma_f32_16x16x32_bf16 a[240:243], v[164:167], v[252:255], 0
ds_read_b128 v[176:179], v24 offset:43008
v_mfma_f32_16x16x32_bf16 a[240:243], v[160:163], v[248:251], a[240:243]
ds_read_b128 v[180:183], v25 offset:43008
v_mfma_f32_16x16x32_bf16 a[236:239], v[152:155], v[248:251], 0
ds_read_b128 v[168:171], v24 offset:45056
v_mfma_f32_16x16x32_bf16 a[236:239], v[156:159], v[252:255], a[236:239]
s_add_u32 s72, s71, 63488
buffer_load_dwordx4 v7, s[16:19], s72 offen offset:2048 lds
v_mfma_f32_16x16x32_bf16 a[232:235], v[148:151], v[252:255], 0
ds_read_b128 v[172:175], v25 offset:45056
v_mfma_f32_16x16x32_bf16 a[232:235], v[144:147], v[248:251], a[232:235]
ds_read_b128 v[160:163], v24 offset:47104
v_mfma_f32_16x16x32_bf16 a[228:231], v[136:139], v[248:251], 0
ds_read_b128 v[164:167], v25 offset:47104
v_mfma_f32_16x16x32_bf16 a[228:231], v[140:143], v[252:255], a[228:231]
s_add_u32 s72, s71, 95232
buffer_load_dwordx4 v7, s[16:19], s72 offen offset:3072 lds
v_mfma_f32_16x16x32_bf16 a[224:227], v[132:135], v[252:255], 0
ds_read_b64_tr_b16 v[232:233], v21 offset:32768
v_mfma_f32_16x16x32_bf16 a[224:227], v[128:131], v[248:251], a[224:227]
s_waitcnt lgkmcnt(9)
ds_read_b64_tr_b16 v[234:235], v21 offset:33792
v_mfma_f32_16x16x32_bf16 a[0:3], v[224:227], v[192:195], a[0:3]
ds_read_b64_tr_b16 v[240:241], v22 offset:32768
v_mfma_f32_16x16x32_bf16 a[0:3], v[228:231], v[196:199], a[0:3]
s_add_u32 m0, s63, 69632
ds_read_b64_tr_b16 v[236:237], v21 offset:40960
v_mfma_f32_16x16x32_bf16 a[4:7], v[228:231], v[204:207], a[4:7]
s_add_u32 s72, s69, 32768
buffer_load_dwordx4 v2, s[8:11], s72 offen lds
v_mfma_f32_16x16x32_bf16 a[4:7], v[224:227], v[200:203], a[4:7]
v_mfma_f32_16x16x32_bf16 a[8:11], v[224:227], v[208:211], a[8:11]
ds_read_b64_tr_b16 v[238:239], v21 offset:41984
v_mfma_f32_16x16x32_bf16 a[8:11], v[228:231], v[212:215], a[8:11]
ds_read_b64_tr_b16 v[242:243], v22 offset:33792
v_mfma_f32_16x16x32_bf16 a[12:15], v[228:231], v[220:223], a[12:15]
s_add_u32 s72, s69, 39936
buffer_load_dwordx4 v3, s[8:11], s72 offen offset:1024 lds
v_mfma_f32_16x16x32_bf16 a[12:15], v[224:227], v[216:219], a[12:15]
s_waitcnt lgkmcnt(6)
v_mfma_f32_16x16x32_bf16 a[16:19], v[224:227], v[184:187], a[16:19]
ds_read_b64_tr_b16 v[244:245], v22 offset:40960
v_mfma_f32_16x16x32_bf16 a[16:19], v[228:231], v[188:191], a[16:19]
v_mfma_f32_16x16x32_bf16 a[20:23], v[228:231], v[180:183], a[20:23]
s_add_u32 s72, s69, 47104
buffer_load_dwordx4 v2, s[8:11], s72 offen offset:2048 lds
v_mfma_f32_16x16x32_bf16 a[20:23], v[224:227], v[176:179], a[20:23]
ds_read_b64_tr_b16 v[246:247], v22 offset:41984
v_mfma_f32_16x16x32_bf16 a[24:27], v[224:227], v[168:171], a[24:27]
v_mfma_f32_16x16x32_bf16 a[24:27], v[228:231], v[172:175], a[24:27]
v_mfma_f32_16x16x32_bf16 a[28:31], v[228:231], v[164:167], a[28:31]
s_add_u32 s72, s69, 54272
buffer_load_dwordx4 v3, s[8:11], s72 offen offset:3072 lds
v_mfma_f32_16x16x32_bf16 a[28:31], v[224:227], v[160:163], a[28:31]
s_waitcnt lgkmcnt(3)
v_mfma_f32_16x16x32_bf16 a[60:63], v[232:235], v[160:163], a[60:63]
ds_read_b64_tr_b16 v[248:249], v23 offset:32768
v_mfma_f32_16x16x32_bf16 a[60:63], v[236:239], v[164:167], a[60:63]
v_mfma_f32_16x16x32_bf16 a[56:59], v[236:239], v[172:175], a[56:59]
s_add_u32 m0, s64, 16384
ds_read_b64_tr_b16 v[250:251], v23 offset:33792
v_mfma_f32_16x16x32_bf16 a[56:59], v[232:235], v[168:171], a[56:59]
s_add_u32 s72, s71, 0
buffer_load_dwordx4 v6, s[20:23], s72 offen lds
v_mfma_f32_16x16x32_bf16 a[52:55], v[232:235], v[176:179], a[52:55]
v_mfma_f32_16x16x32_bf16 a[52:55], v[236:239], v[180:183], a[52:55]
v_mfma_f32_16x16x32_bf16 a[48:51], v[236:239], v[188:191], a[48:51]
ds_read_b64_tr_b16 v[252:253], v23 offset:40960
v_mfma_f32_16x16x32_bf16 a[48:51], v[232:235], v[184:187], a[48:51]
s_add_u32 s72, s71, 31744
buffer_load_dwordx4 v6, s[20:23], s72 offen offset:1024 lds
v_mfma_f32_16x16x32_bf16 a[44:47], v[232:235], v[216:219], a[44:47]
v_mfma_f32_16x16x32_bf16 a[44:47], v[236:239], v[220:223], a[44:47]
v_mfma_f32_16x16x32_bf16 a[40:43], v[236:239], v[212:215], a[40:43]
ds_read_b64_tr_b16 v[254:255], v23 offset:41984
v_mfma_f32_16x16x32_bf16 a[40:43], v[232:235], v[208:211], a[40:43]
s_add_u32 s72, s71, 63488
buffer_load_dwordx4 v7, s[20:23], s72 offen offset:2048 lds
v_mfma_f32_16x16x32_bf16 a[36:39], v[232:235], v[200:203], a[36:39]
v_mfma_f32_16x16x32_bf16 a[36:39], v[236:239], v[204:207], a[36:39]
v_mfma_f32_16x16x32_bf16 a[32:35], v[236:239], v[196:199], a[32:35]
s_add_u32 s72, s71, 95232
v_mfma_f32_16x16x32_bf16 a[32:35], v[232:235], v[192:195], a[32:35]
s_waitcnt lgkmcnt(4)
buffer_load_dwordx4 v7, s[20:23], s72 offen offset:3072 lds
v_mfma_f32_16x16x32_bf16 a[64:67], v[240:243], v[192:195], a[64:67]
ds_read_b64_tr_b16 v[224:225], v20 offset:49152
v_mfma_f32_16x16x32_bf16 a[64:67], v[244:247], v[196:199], a[64:67]
v_mfma_f32_16x16x32_bf16 a[68:71], v[244:247], v[204:207], a[68:71]
ds_read_b64_tr_b16 v[226:227], v20 offset:50176
v_mfma_f32_16x16x32_bf16 a[68:71], v[240:243], v[200:203], a[68:71]
s_mov_b32 s80, 0x200000
buffer_load_dword v126, v125, s[16:19], s80 offen
v_mfma_f32_16x16x32_bf16 a[72:75], v[240:243], v[208:211], a[72:75]
v_mfma_f32_16x16x32_bf16 a[72:75], v[244:247], v[212:215], a[72:75]
v_mfma_f32_16x16x32_bf16 a[76:79], v[244:247], v[220:223], a[76:79]
ds_read_b64_tr_b16 v[228:229], v20 offset:57344
v_mfma_f32_16x16x32_bf16 a[76:79], v[240:243], v[216:219], a[76:79]
buffer_load_dword v126, v125, s[20:23], s80 offen
v_mfma_f32_16x16x32_bf16 a[80:83], v[240:243], v[184:187], a[80:83]
v_mfma_f32_16x16x32_bf16 a[80:83], v[244:247], v[188:191], a[80:83]
v_mfma_f32_16x16x32_bf16 a[84:87], v[244:247], v[180:183], a[84:87]
ds_read_b64_tr_b16 v[230:231], v20 offset:58368
v_mfma_f32_16x16x32_bf16 a[84:87], v[240:243], v[176:179], a[84:87]
global_load_dwordx4 v[68:71], v30, s[52:53]
v_mfma_f32_16x16x32_bf16 a[88:91], v[240:243], v[168:171], a[88:91]
v_mfma_f32_16x16x32_bf16 a[88:91], v[244:247], v[172:175], a[88:91]
v_mfma_f32_16x16x32_bf16 a[92:95], v[244:247], v[164:167], a[92:95]
v_mfma_f32_16x16x32_bf16 a[92:95], v[240:243], v[160:163], a[92:95]
s_waitcnt lgkmcnt(4)
buffer_load_dword v33, v27, s[28:31], 0 offen nt
v_mfma_f32_16x16x32_bf16 a[124:127], v[248:251], v[160:163], a[124:127]
ds_read_b64_tr_b16 v[232:233], v21 offset:49152
v_mfma_f32_16x16x32_bf16 a[124:127], v[252:255], v[164:167], a[124:127]
v_mfma_f32_16x16x32_bf16 a[120:123], v[252:255], v[172:175], a[120:123]
ds_read_b64_tr_b16 v[234:235], v21 offset:50176
v_mfma_f32_16x16x32_bf16 a[120:123], v[248:251], v[168:171], a[120:123]
buffer_load_dword v34, v27, s[28:31], 0 offen offset:2048 nt
v_mfma_f32_16x16x32_bf16 a[116:119], v[248:251], v[176:179], a[116:119]
v_mfma_f32_16x16x32_bf16 a[116:119], v[252:255], v[180:183], a[116:119]
v_mfma_f32_16x16x32_bf16 a[112:115], v[252:255], v[188:191], a[112:115]
ds_read_b64_tr_b16 v[236:237], v21 offset:57344
v_mfma_f32_16x16x32_bf16 a[112:115], v[248:251], v[184:187], a[112:115]
v_add_u32 v27, 0x1000, v27
v_mfma_f32_16x16x32_bf16 a[108:111], v[248:251], v[216:219], a[108:111]
v_mfma_f32_16x16x32_bf16 a[108:111], v[252:255], v[220:223], a[108:111]
v_mfma_f32_16x16x32_bf16 a[104:107], v[252:255], v[212:215], a[104:107]
ds_read_b64_tr_b16 v[238:239], v21 offset:58368
v_mfma_f32_16x16x32_bf16 a[104:107], v[248:251], v[208:211], a[104:107]
buffer_load_dword v35, v27, s[28:31], 0 offen nt
v_mfma_f32_16x16x32_bf16 a[100:103], v[248:251], v[200:203], a[100:103]
v_mfma_f32_16x16x32_bf16 a[100:103], v[252:255], v[204:207], a[100:103]
v_mfma_f32_16x16x32_bf16 a[96:99], v[252:255], v[196:199], a[96:99]
v_mfma_f32_16x16x32_bf16 a[96:99], v[248:251], v[192:195], a[96:99]
s_waitcnt lgkmcnt(4)
v_mfma_f32_16x16x32_bf16 a[128:131], v[192:195], v[224:227], a[128:131]
s_add_u32 m0, s63, 131072
ds_read_b64_tr_b16 v[240:241], v22 offset:49152
v_mfma_f32_16x16x32_bf16 a[128:131], v[196:199], v[228:231], a[128:131]
s_add_u32 s80, s82, 0
buffer_load_dwordx4 v26, s[28:31], s80 offen nt lds
v_mfma_f32_16x16x32_bf16 a[132:135], v[204:207], v[228:231], a[132:135]
v_mfma_f32_16x16x32_bf16 a[132:135], v[200:203], v[224:227], a[132:135]
ds_read_b64_tr_b16 v[242:243], v22 offset:50176
v_mfma_f32_16x16x32_bf16 a[136:139], v[208:211], v[224:227], a[136:139]
v_mfma_f32_16x16x32_bf16 a[136:139], v[212:215], v[228:231], a[136:139]
s_add_u32 s80, s82, 15360
buffer_load_dwordx4 v26, s[28:31], s80 offen offset:1024 nt lds
v_mfma_f32_16x16x32_bf16 a[140:143], v[220:223], v[228:231], a[140:143]
v_mfma_f32_16x16x32_bf16 a[140:143], v[216:219], v[224:227], a[140:143]
ds_read_b64_tr_b16 v[244:245], v22 offset:57344
v_mfma_f32_16x16x32_bf16 a[144:147], v[184:187], v[224:227], a[144:147]
v_mfma_f32_16x16x32_bf16 a[144:147], v[188:191], v[228:231], a[144:147]
s_add_u32 s80, s82, 30720
buffer_load_dwordx4 v26, s[28:31], s80 offen offset:2048 nt lds
v_mfma_f32_16x16x32_bf16 a[148:151], v[180:183], v[228:231], a[148:151]
ds_read_b64_tr_b16 v[246:247], v22 offset:58368
v_mfma_f32_16x16x32_bf16 a[148:151], v[176:179], v[224:227], a[148:151]
v_mfma_f32_16x16x32_bf16 a[152:155], v[168:171], v[224:227], a[152:155]
v_mfma_f32_16x16x32_bf16 a[152:155], v[172:175], v[228:231], a[152:155]
s_add_u32 s80, s82, 46080
buffer_load_dwordx4 v26, s[28:31], s80 offen offset:3072 nt lds
v_mfma_f32_16x16x32_bf16 a[156:159], v[164:167], v[228:231], a[156:159]
v_mfma_f32_16x16x32_bf16 a[156:159], v[160:163], v[224:227], a[156:159]
s_waitcnt lgkmcnt(4)
v_mfma_f32_16x16x32_bf16 a[188:191], v[160:163], v[232:235], a[188:191]
ds_read_b64_tr_b16 v[248:249], v23 offset:49152
v_mfma_f32_16x16x32_bf16 a[188:191], v[164:167], v[236:239], a[188:191]
v_mfma_f32_16x16x32_bf16 a[184:187], v[172:175], v[236:239], a[184:187]
ds_read_b64_tr_b16 v[250:251], v23 offset:50176
v_mfma_f32_16x16x32_bf16 a[184:187], v[168:171], v[232:235], a[184:187]
v_mfma_f32_16x16x32_bf16 a[180:183], v[176:179], v[232:235], a[180:183]
ds_read_b64_tr_b16 v[252:253], v23 offset:57344
v_mfma_f32_16x16x32_bf16 a[180:183], v[180:183], v[236:239], a[180:183]
v_mfma_f32_16x16x32_bf16 a[176:179], v[188:191], v[236:239], a[176:179]
ds_read_b64_tr_b16 v[254:255], v23 offset:58368
v_mfma_f32_16x16x32_bf16 a[176:179], v[184:187], v[232:235], a[176:179]
s_and_b32 s73, s65, 1
v_mfma_f32_16x16x32_bf16 a[172:175], v[216:219], v[232:235], a[172:175]
s_xor_b32 s73, s73, 3
v_mfma_f32_16x16x32_bf16 a[172:175], v[220:223], v[236:239], a[172:175]
s_lshl_b32 s69, s73, 7
v_mfma_f32_16x16x32_bf16 a[168:171], v[212:215], v[236:239], a[168:171]
s_add_u32 s69, s69, s84
v_mfma_f32_16x16x32_bf16 a[168:171], v[208:211], v[232:235], a[168:171]
s_lshl_b32 s71, s73, 19
v_mfma_f32_16x16x32_bf16 a[164:167], v[200:203], v[232:235], a[164:167]
s_add_u32 s71, s71, s66
v_mfma_f32_16x16x32_bf16 a[164:167], v[204:207], v[236:239], a[164:167]
s_add_u32 m0, s63, 98304
v_mfma_f32_16x16x32_bf16 a[160:163], v[196:199], v[236:239], a[160:163]
s_waitcnt vmcnt(10) lgkmcnt(0)
v_mfma_f32_16x16x32_bf16 a[160:163], v[192:195], v[232:235], a[160:163]
s_barrier
v_mfma_f32_16x16x32_bf16 a[192:195], v[192:195], v[240:243], a[192:195]
s_add_u32 s72, s69, 0
buffer_load_dwordx4 v2, s[8:11], s72 offen lds
v_mfma_f32_16x16x32_bf16 a[192:195], v[196:199], v[244:247], a[192:195]
ds_read_b64_tr_b16 v[224:225], v20 offset:0
v_mfma_f32_16x16x32_bf16 a[196:199], v[204:207], v[244:247], a[196:199]
ds_read_b64_tr_b16 v[226:227], v20 offset:1024
v_mfma_f32_16x16x32_bf16 a[196:199], v[200:203], v[240:243], a[196:199]
ds_read_b64_tr_b16 v[228:229], v20 offset:8192
v_mfma_f32_16x16x32_bf16 a[200:203], v[208:211], v[240:243], a[200:203]
s_add_u32 s72, s69, 7168
buffer_load_dwordx4 v3, s[8:11], s72 offen offset:1024 lds
v_mfma_f32_16x16x32_bf16 a[200:203], v[212:215], v[244:247], a[200:203]
ds_read_b64_tr_b16 v[230:231], v20 offset:9216
v_mfma_f32_16x16x32_bf16 a[204:207], v[220:223], v[244:247], a[204:207]
ds_read_b128 v[128:131], v24 offset:0
v_mfma_f32_16x16x32_bf16 a[204:207], v[216:219], v[240:243], a[204:207]
ds_read_b128 v[132:135], v25 offset:0
v_mfma_f32_16x16x32_bf16 a[208:211], v[184:187], v[240:243], a[208:211]
s_add_u32 s72, s69, 14336
buffer_load_dwordx4 v2, s[8:11], s72 offen offset:2048 lds
v_mfma_f32_16x16x32_bf16 a[208:211], v[188:191], v[244:247], a[208:211]
ds_read_b128 v[136:139], v24 offset:2048
v_mfma_f32_16x16x32_bf16 a[212:215], v[180:183], v[244:247], a[212:215]
ds_read_b128 v[140:143], v25 offset:2048
v_mfma_f32_16x16x32_bf16 a[212:215], v[176:179], v[240:243], a[212:215]
ds_read_b128 v[144:147], v24 offset:4096
v_mfma_f32_16x16x32_bf16 a[216:219], v[168:171], v[240:243], a[216:219]
s_add_u32 s72, s69, 21504
buffer_load_dwordx4 v3, s[8:11], s72 offen offset:3072 lds
v_mfma_f32_16x16x32_bf16 a[216:219], v[172:175], v[244:247], a[216:219]
ds_read_b128 v[148:151], v25 offset:4096
v_mfma_f32_16x16x32_bf16 a[220:223], v[164:167], v[244:247], a[220:223]
ds_read_b128 v[152:155], v24 offset:6144
v_mfma_f32_16x16x32_bf16 a[220:223], v[160:163], v[240:243], a[220:223]
ds_read_b128 v[156:159], v25 offset:6144
v_mfma_f32_16x16x32_bf16 a[252:255], v[160:163], v[248:251], a[252:255]
s_add_u32 m0, s64, 32768
v_mfma_f32_16x16x32_bf16 a[252:255], v[164:167], v[252:255], a[252:255]
s_add_u32 s72, s71, 0
buffer_load_dwordx4 v6, s[16:19], s72 offen lds
v_mfma_f32_16x16x32_bf16 a[248:251], v[172:175], v[252:255], a[248:251]
ds_read_b128 v[160:163], v24 offset:8192
v_mfma_f32_16x16x32_bf16 a[248:251], v[168:171], v[248:251], a[248:251]
ds_read_b128 v[164:167], v25 offset:8192
v_mfma_f32_16x16x32_bf16 a[244:247], v[176:179], v[248:251], a[244:247]
v_mfma_f32_16x16x32_bf16 a[244:247], v[180:183], v[252:255], a[244:247]
s_add_u32 s72, s71, 31744
buffer_load_dwordx4 v6, s[16:19], s72 offen offset:1024 lds
v_mfma_f32_16x16x32_bf16 a[240:243], v[188:191], v[252:255], a[240:243]
ds_read_b128 v[168:171], v24 offset:10240
v_mfma_f32_16x16x32_bf16 a[240:243], v[184:187], v[248:251], a[240:243]
ds_read_b128 v[172:175], v25 offset:10240
v_mfma_f32_16x16x32_bf16 a[236:239], v[216:219], v[248:251], a[236:239]
ds_read_b128 v[176:179], v24 offset:12288
v_mfma_f32_16x16x32_bf16 a[236:239], v[220:223], v[252:255], a[236:239]
s_add_u32 s72, s71, 63488
buffer_load_dwordx4 v7, s[16:19], s72 offen offset:2048 lds
v_mfma_f32_16x16x32_bf16 a[232:235], v[212:215], v[252:255], a[232:235]
ds_read_b128 v[180:183], v25 offset:12288
v_mfma_f32_16x16x32_bf16 a[232:235], v[208:211], v[248:251], a[232:235]
ds_read_b128 v[184:187], v24 offset:14336
v_mfma_f32_16x16x32_bf16 a[228:231], v[200:203], v[248:251], a[228:231]
ds_read_b128 v[188:191], v25 offset:14336
v_mfma_f32_16x16x32_bf16 a[228:231], v[204:207], v[252:255], a[228:231]
s_add_u32 s72, s71, 95232
buffer_load_dwordx4 v7, s[16:19], s72 offen offset:3072 lds
v_mfma_f32_16x16x32_bf16 a[224:227], v[196:199], v[252:255], a[224:227]
ds_read_b64_tr_b16 v[232:233], v21 offset:0
v_mfma_f32_16x16x32_bf16 a[224:227], v[192:195], v[248:251], a[224:227]
s_waitcnt lgkmcnt(9)
ds_read_b64_tr_b16 v[234:235], v21 offset:1024
v_mfma_f32_16x16x32_bf16 a[0:3], v[224:227], v[128:131], a[0:3]
ds_read_b64_tr_b16 v[240:241], v22 offset:0
v_mfma_f32_16x16x32_bf16 a[0:3], v[228:231], v[132:135], a[0:3]
s_add_u32 m0, s63, 102400
ds_read_b64_tr_b16 v[236:237], v21 offset:8192
v_mfma_f32_16x16x32_bf16 a[4:7], v[228:231], v[140:143], a[4:7]
s_add_u32 s72, s69, 32768
buffer_load_dwordx4 v2, s[8:11], s72 offen lds
v_mfma_f32_16x16x32_bf16 a[4:7], v[224:227], v[136:139], a[4:7]
v_mfma_f32_16x16x32_bf16 a[8:11], v[224:227], v[144:147], a[8:11]
ds_read_b64_tr_b16 v[238:239], v21 offset:9216
v_mfma_f32_16x16x32_bf16 a[8:11], v[228:231], v[148:151], a[8:11]
ds_read_b64_tr_b16 v[242:243], v22 offset:1024
v_mfma_f32_16x16x32_bf16 a[12:15], v[228:231], v[156:159], a[12:15]
s_add_u32 s72, s69, 39936
buffer_load_dwordx4 v3, s[8:11], s72 offen offset:1024 lds
v_mfma_f32_16x16x32_bf16 a[12:15], v[224:227], v[152:155], a[12:15]
s_waitcnt lgkmcnt(6)
v_mfma_f32_16x16x32_bf16 a[16:19], v[224:227], v[160:163], a[16:19]
ds_read_b64_tr_b16 v[244:245], v22 offset:8192
v_mfma_f32_16x16x32_bf16 a[16:19], v[228:231], v[164:167], a[16:19]
v_mfma_f32_16x16x32_bf16 a[20:23], v[228:231], v[172:175], a[20:23]
s_add_u32 s72, s69, 47104
buffer_load_dwordx4 v2, s[8:11], s72 offen offset:2048 lds
v_mfma_f32_16x16x32_bf16 a[20:23], v[224:227], v[168:171], a[20:23]
ds_read_b64_tr_b16 v[246:247], v22 offset:9216
v_mfma_f32_16x16x32_bf16 a[24:27], v[224:227], v[176:179], a[24:27]
v_mfma_f32_16x16x32_bf16 a[24:27], v[228:231], v[180:183], a[24:27]
v_mfma_f32_16x16x32_bf16 a[28:31], v[228:231], v[188:191], a[28:31]
s_add_u32 s72, s69, 54272
buffer_load_dwordx4 v3, s[8:11], s72 offen offset:3072 lds
v_mfma_f32_16x16x32_bf16 a[28:31], v[224:227], v[184:187], a[28:31]
s_waitcnt lgkmcnt(3)
v_mfma_f32_16x16x32_bf16 a[60:63], v[232:235], v[184:187], a[60:63]
ds_read_b64_tr_b16 v[248:249], v23 offset:0
v_mfma_f32_16x16x32_bf16 a[60:63], v[236:239], v[188:191], a[60:63]
v_mfma_f32_16x16x32_bf16 a[56:59], v[236:239], v[180:183], a[56:59]
s_add_u32 m0, s64, 49152
ds_read_b64_tr_b16 v[250:251], v23 offset:1024
v_mfma_f32_16x16x32_bf16 a[56:59], v[232:235], v[176:179], a[56:59]
s_add_u32 s72, s71, 0
buffer_load_dwordx4 v6, s[20:23], s72 offen lds
v_mfma_f32_16x16x32_bf16 a[52:55], v[232:235], v[168:171], a[52:55]
v_mfma_f32_16x16x32_bf16 a[52:55], v[236:239], v[172:175], a[52:55]
v_mfma_f32_16x16x32_bf16 a[48:51], v[236:239], v[164:167], a[48:51]
ds_read_b64_tr_b16 v[252:253], v23 offset:8192
v_mfma_f32_16x16x32_bf16 a[48:51], v[232:235], v[160:163], a[48:51]
s_add_u32 s72, s71, 31744
buffer_load_dwordx4 v6, s[20:23], s72 offen offset:1024 lds
v_mfma_f32_16x16x32_bf16 a[44:47], v[232:235], v[152:155], a[44:47]
v_mfma_f32_16x16x32_bf16 a[44:47], v[236:239], v[156:159], a[44:47]
v_mfma_f32_16x16x32_bf16 a[40:43], v[236:239], v[148:151], a[40:43]
ds_read_b64_tr_b16 v[254:255], v23 offset:9216
v_mfma_f32_16x16x32_bf16 a[40:43], v[232:235], v[144:147], a[40:43]
s_add_u32 s72, s71, 63488
buffer_load_dwordx4 v7, s[20:23], s72 offen offset:2048 lds
v_mfma_f32_16x16x32_bf16 a[36:39], v[232:235], v[136:139], a[36:39]
v_mfma_f32_16x16x32_bf16 a[36:39], v[236:239], v[140:143], a[36:39]
v_mfma_f32_16x16x32_bf16 a[32:35], v[236:239], v[132:135], a[32:35]
s_add_u32 s72, s71, 95232
v_mfma_f32_16x16x32_bf16 a[32:35], v[232:235], v[128:131], a[32:35]
s_waitcnt lgkmcnt(4)
buffer_load_dwordx4 v7, s[20:23], s72 offen offset:3072 lds
v_mfma_f32_16x16x32_bf16 a[64:67], v[240:243], v[128:131], a[64:67]
ds_read_b64_tr_b16 v[224:225], v20 offset:16384
v_mfma_f32_16x16x32_bf16 a[64:67], v[244:247], v[132:135], a[64:67]
v_mfma_f32_16x16x32_bf16 a[68:71], v[244:247], v[140:143], a[68:71]
ds_read_b64_tr_b16 v[226:227], v20 offset:17408
v_mfma_f32_16x16x32_bf16 a[68:71], v[240:243], v[136:139], a[68:71]
s_mov_b32 s80, 0x300000
buffer_load_dword v126, v125, s[16:19], s80 offen
v_mfma_f32_16x16x32_bf16 a[72:75], v[240:243], v[144:147], a[72:75]
v_mfma_f32_16x16x32_bf16 a[72:75], v[244:247], v[148:151], a[72:75]
v_mfma_f32_16x16x32_bf16 a[76:79], v[244:247], v[156:159], a[76:79]
ds_read_b64_tr_b16 v[228:229], v20 offset:24576
v_mfma_f32_16x16x32_bf16 a[76:79], v[240:243], v[152:155], a[76:79]
buffer_load_dword v126, v125, s[20:23], s80 offen
v_mfma_f32_16x16x32_bf16 a[80:83], v[240:243], v[160:163], a[80:83]
v_mfma_f32_16x16x32_bf16 a[80:83], v[244:247], v[164:167], a[80:83]
v_mfma_f32_16x16x32_bf16 a[84:87], v[244:247], v[172:175], a[84:87]
ds_read_b64_tr_b16 v[230:231], v20 offset:25600
v_mfma_f32_16x16x32_bf16 a[84:87], v[240:243], v[168:171], a[84:87]
s_add_u32 m0, s63, 135168
v_mfma_f32_16x16x32_bf16 a[88:91], v[240:243], v[176:179], a[88:91]
s_add_u32 s80, s82, 0
buffer_load_dwordx4 v26, s[32:35], s80 offen nt lds
v_mfma_f32_16x16x32_bf16 a[88:91], v[244:247], v[180:183], a[88:91]
v_mfma_f32_16x16x32_bf16 a[92:95], v[244:247], v[188:191], a[92:95]
v_mfma_f32_16x16x32_bf16 a[92:95], v[240:243], v[184:187], a[92:95]
s_waitcnt lgkmcnt(4)
v_mfma_f32_16x16x32_bf16 a[124:127], v[248:251], v[184:187], a[124:127]
s_add_u32 s80, s82, 15360
buffer_load_dwordx4 v26, s[32:35], s80 offen offset:1024 nt lds
v_mfma_f32_16x16x32_bf16 a[124:127], v[252:255], v[188:191], a[124:127]
ds_read_b64_tr_b16 v[232:233], v21 offset:16384
v_mfma_f32_16x16x32_bf16 a[120:123], v[252:255], v[180:183], a[120:123]
v_mfma_f32_16x16x32_bf16 a[120:123], v[248:251], v[176:179], a[120:123]
ds_read_b64_tr_b16 v[234:235], v21 offset:17408
v_mfma_f32_16x16x32_bf16 a[116:119], v[248:251], v[168:171], a[116:119]
s_add_u32 s80, s82, 30720
buffer_load_dwordx4 v26, s[32:35], s80 offen offset:2048 nt lds
v_mfma_f32_16x16x32_bf16 a[116:119], v[252:255], v[172:175], a[116:119]
v_mfma_f32_16x16x32_bf16 a[112:115], v[252:255], v[164:167], a[112:115]
v_mfma_f32_16x16x32_bf16 a[112:115], v[248:251], v[160:163], a[112:115]
ds_read_b64_tr_b16 v[236:237], v21 offset:24576
v_mfma_f32_16x16x32_bf16 a[108:111], v[248:251], v[152:155], a[108:111]
s_add_u32 s80, s82, 46080
buffer_load_dwordx4 v26, s[32:35], s80 offen offset:3072 nt lds
v_mfma_f32_16x16x32_bf16 a[108:111], v[252:255], v[156:159], a[108:111]
v_mfma_f32_16x16x32_bf16 a[104:107], v[252:255], v[148:151], a[104:107]
v_mfma_f32_16x16x32_bf16 a[104:107], v[248:251], v[144:147], a[104:107]
ds_read_b64_tr_b16 v[238:239], v21 offset:25600
v_mfma_f32_16x16x32_bf16 a[100:103], v[248:251], v[136:139], a[100:103]
v_mfma_f32_16x16x32_bf16 a[100:103], v[252:255], v[140:143], a[100:103]
v_mfma_f32_16x16x32_bf16 a[96:99], v[252:255], v[132:135], a[96:99]
v_mfma_f32_16x16x32_bf16 a[96:99], v[248:251], v[128:131], a[96:99]
s_waitcnt lgkmcnt(4)
v_mfma_f32_16x16x32_bf16 a[128:131], v[128:131], v[224:227], a[128:131]
ds_read_b64_tr_b16 v[240:241], v22 offset:16384
v_mfma_f32_16x16x32_bf16 a[128:131], v[132:135], v[228:231], a[128:131]
v_mfma_f32_16x16x32_bf16 a[132:135], v[140:143], v[228:231], a[132:135]
v_mfma_f32_16x16x32_bf16 a[132:135], v[136:139], v[224:227], a[132:135]
ds_read_b64_tr_b16 v[242:243], v22 offset:17408
v_mfma_f32_16x16x32_bf16 a[136:139], v[144:147], v[224:227], a[136:139]
v_mfma_f32_16x16x32_bf16 a[136:139], v[148:151], v[228:231], a[136:139]
v_mfma_f32_16x16x32_bf16 a[140:143], v[156:159], v[228:231], a[140:143]
v_mfma_f32_16x16x32_bf16 a[140:143], v[152:155], v[224:227], a[140:143]
ds_read_b64_tr_b16 v[244:245], v22 offset:24576
v_mfma_f32_16x16x32_bf16 a[144:147], v[160:163], v[224:227], a[144:147]
v_mfma_f32_16x16x32_bf16 a[144:147], v[164:167], v[228:231], a[144:147]
v_mfma_f32_16x16x32_bf16 a[148:151], v[172:175], v[228:231], a[148:151]
ds_read_b64_tr_b16 v[246:247], v22 offset:25600
v_mfma_f32_16x16x32_bf16 a[148:151], v[168:171], v[224:227], a[148:151]
v_mfma_f32_16x16x32_bf16 a[152:155], v[176:179], v[224:227], a[152:155]
v_mfma_f32_16x16x32_bf16 a[152:155], v[180:183], v[228:231], a[152:155]
v_mfma_f32_16x16x32_bf16 a[156:159], v[188:191], v[228:231], a[156:159]
v_mfma_f32_16x16x32_bf16 a[156:159], v[184:187], v[224:227], a[156:159]
s_waitcnt lgkmcnt(4)
v_mfma_f32_16x16x32_bf16 a[188:191], v[184:187], v[232:235], a[188:191]
ds_read_b64_tr_b16 v[248:249], v23 offset:16384
v_mfma_f32_16x16x32_bf16 a[188:191], v[188:191], v[236:239], a[188:191]
v_mfma_f32_16x16x32_bf16 a[184:187], v[180:183], v[236:239], a[184:187]
ds_read_b64_tr_b16 v[250:251], v23 offset:17408
v_mfma_f32_16x16x32_bf16 a[184:187], v[176:179], v[232:235], a[184:187]
v_mfma_f32_16x16x32_bf16 a[180:183], v[168:171], v[232:235], a[180:183]
ds_read_b64_tr_b16 v[252:253], v23 offset:24576
v_mfma_f32_16x16x32_bf16 a[180:183], v[172:175], v[236:239], a[180:183]
v_mfma_f32_16x16x32_bf16 a[176:179], v[164:167], v[236:239], a[176:179]
ds_read_b64_tr_b16 v[254:255], v23 offset:25600
v_mfma_f32_16x16x32_bf16 a[176:179], v[160:163], v[232:235], a[176:179]
s_and_b32 s73, s65, 1
v_mfma_f32_16x16x32_bf16 a[172:175], v[152:155], v[232:235], a[172:175]
s_xor_b32 s73, s73, 4
v_mfma_f32_16x16x32_bf16 a[172:175], v[156:159], v[236:239], a[172:175]
s_lshl_b32 s69, s73, 7
v_mfma_f32_16x16x32_bf16 a[168:171], v[148:151], v[236:239], a[168:171]
s_add_u32 s69, s69, s84
v_mfma_f32_16x16x32_bf16 a[168:171], v[144:147], v[232:235], a[168:171]
s_lshl_b32 s71, s73, 19
v_mfma_f32_16x16x32_bf16 a[164:167], v[136:139], v[232:235], a[164:167]
s_add_u32 s71, s71, s66
v_mfma_f32_16x16x32_bf16 a[164:167], v[140:143], v[236:239], a[164:167]
s_add_u32 m0, s63, 65536
v_mfma_f32_16x16x32_bf16 a[160:163], v[132:135], v[236:239], a[160:163]
s_waitcnt vmcnt(6) lgkmcnt(0)
v_mfma_f32_16x16x32_bf16 a[160:163], v[128:131], v[232:235], a[160:163]
s_barrier
v_mfma_f32_16x16x32_bf16 a[192:195], v[128:131], v[240:243], a[192:195]
s_add_u32 s72, s69, 0
buffer_load_dwordx4 v2, s[8:11], s72 offen lds
v_mfma_f32_16x16x32_bf16 a[192:195], v[132:135], v[244:247], a[192:195]
ds_read_b64_tr_b16 v[224:225], v20 offset:32768
v_mfma_f32_16x16x32_bf16 a[196:199], v[140:143], v[244:247], a[196:199]
ds_read_b64_tr_b16 v[226:227], v20 offset:33792
v_mfma_f32_16x16x32_bf16 a[196:199], v[136:139], v[240:243], a[196:199]
ds_read_b64_tr_b16 v[228:229], v20 offset:40960
v_mfma_f32_16x16x32_bf16 a[200:203], v[144:147], v[240:243], a[200:203]
s_add_u32 s72, s69, 7168
buffer_load_dwordx4 v3, s[8:11], s72 offen offset:1024 lds
v_mfma_f32_16x16x32_bf16 a[200:203], v[148:151], v[244:247], a[200:203]
ds_read_b64_tr_b16 v[230:231], v20 offset:41984
v_mfma_f32_16x16x32_bf16 a[204:207], v[156:159], v[244:247], a[204:207]
ds_read_b128 v[192:195], v24 offset:32768
v_mfma_f32_16x16x32_bf16 a[204:207], v[152:155], v[240:243], a[204:207]
ds_read_b128 v[196:199], v25 offset:32768
v_mfma_f32_16x16x32_bf16 a[208:211], v[160:163], v[240:243], a[208:211]
s_add_u32 s72, s69, 14336
buffer_load_dwordx4 v2, s[8:11], s72 offen offset:2048 lds
v_mfma_f32_16x16x32_bf16 a[208:211], v[164:167], v[244:247], a[208:211]
ds_read_b128 v[200:203], v24 offset:34816
v_mfma_f32_16x16x32_bf16 a[212:215], v[172:175], v[244:247], a[212:215]
ds_read_b128 v[204:207], v25 offset:34816
v_mfma_f32_16x16x32_bf16 a[212:215], v[168:171], v[240:243], a[212:215]
ds_read_b128 v[208:211], v24 offset:36864
v_mfma_f32_16x16x32_bf16 a[216:219], v[176:179], v[240:243], a[216:219]
s_add_u32 s72, s69, 21504
buffer_load_dwordx4 v3, s[8:11], s72 offen offset:3072 lds
v_mfma_f32_16x16x32_bf16 a[216:219], v[180:183], v[244:247], a[216:219]
ds_read_b128 v[212:215], v25 offset:36864
v_mfma_f32_16x16x32_bf16 a[220:223], v[188:191], v[244:247], a[220:223]
ds_read_b128 v[216:219], v24 offset:38912
v_mfma_f32_16x16x32_bf16 a[220:223], v[184:187], v[240:243], a[220:223]
ds_read_b128 v[220:223], v25 offset:38912
v_mfma_f32_16x16x32_bf16 a[252:255], v[184:187], v[248:251], a[252:255]
s_add_u32 m0, s64, 0
v_mfma_f32_16x16x32_bf16 a[252:255], v[188:191], v[252:255], a[252:255]
s_add_u32 s72, s71, 0
buffer_load_dwordx4 v6, s[16:19], s72 offen lds
v_mfma_f32_16x16x32_bf16 a[248:251], v[180:183], v[252:255], a[248:251]
ds_read_b128 v[184:187], v24 offset:40960
v_mfma_f32_16x16x32_bf16 a[248:251], v[176:179], v[248:251], a[248:251]
ds_read_b128 v[188:191], v25 offset:40960
v_mfma_f32_16x16x32_bf16 a[244:247], v[168:171], v[248:251], a[244:247]
v_mfma_f32_16x16x32_bf16 a[244:247], v[172:175], v[252:255], a[244:247]
s_add_u32 s72, s71, 31744
buffer_load_dwordx4 v6, s[16:19], s72 offen offset:1024 lds
v_mfma_f32_16x16x32_bf16 a[240:243], v[164:167], v[252:255], a[240:243]
ds_read_b128 v[176:179], v24 offset:43008
v_mfma_f32_16x16x32_bf16 a[240:243], v[160:163], v[248:251], a[240:243]
ds_read_b128 v[180:183], v25 offset:43008
v_mfma_f32_16x16x32_bf16 a[236:239], v[152:155], v[248:251], a[236:239]
ds_read_b128 v[168:171], v24 offset:45056
v_mfma_f32_16x16x32_bf16 a[236:239], v[156:159], v[252:255], a[236:239]
s_add_u32 s72, s71, 63488
buffer_load_dwordx4 v7, s[16:19], s72 offen offset:2048 lds
v_mfma_f32_16x16x32_bf16 a[232:235], v[148:151], v[252:255], a[232:235]
ds_read_b128 v[172:175], v25 offset:45056
v_mfma_f32_16x16x32_bf16 a[232:235], v[144:147], v[248:251], a[232:235]
ds_read_b128 v[160:163], v24 offset:47104
v_mfma_f32_16x16x32_bf16 a[228:231], v[136:139], v[248:251], a[228:231]
ds_read_b128 v[164:167], v25 offset:47104
v_mfma_f32_16x16x32_bf16 a[228:231], v[140:143], v[252:255], a[228:231]
s_add_u32 s72, s71, 95232
buffer_load_dwordx4 v7, s[16:19], s72 offen offset:3072 lds
v_mfma_f32_16x16x32_bf16 a[224:227], v[132:135], v[252:255], a[224:227]
ds_read_b64_tr_b16 v[232:233], v21 offset:32768
v_mfma_f32_16x16x32_bf16 a[224:227], v[128:131], v[248:251], a[224:227]
s_waitcnt lgkmcnt(9)
ds_read_b64_tr_b16 v[234:235], v21 offset:33792
v_mfma_f32_16x16x32_bf16 a[0:3], v[224:227], v[192:195], a[0:3]
ds_read_b64_tr_b16 v[240:241], v22 offset:32768
v_mfma_f32_16x16x32_bf16 a[0:3], v[228:231], v[196:199], a[0:3]
s_add_u32 m0, s63, 69632
ds_read_b64_tr_b16 v[236:237], v21 offset:40960
v_mfma_f32_16x16x32_bf16 a[4:7], v[228:231], v[204:207], a[4:7]
s_add_u32 s72, s69, 32768
buffer_load_dwordx4 v2, s[8:11], s72 offen lds
v_mfma_f32_16x16x32_bf16 a[4:7], v[224:227], v[200:203], a[4:7]
v_mfma_f32_16x16x32_bf16 a[8:11], v[224:227], v[208:211], a[8:11]
ds_read_b64_tr_b16 v[238:239], v21 offset:41984
v_mfma_f32_16x16x32_bf16 a[8:11], v[228:231], v[212:215], a[8:11]
ds_read_b64_tr_b16 v[242:243], v22 offset:33792
v_mfma_f32_16x16x32_bf16 a[12:15], v[228:231], v[220:223], a[12:15]
s_add_u32 s72, s69, 39936
buffer_load_dwordx4 v3, s[8:11], s72 offen offset:1024 lds
v_mfma_f32_16x16x32_bf16 a[12:15], v[224:227], v[216:219], a[12:15]
s_waitcnt lgkmcnt(6)
v_mfma_f32_16x16x32_bf16 a[16:19], v[224:227], v[184:187], a[16:19]
ds_read_b64_tr_b16 v[244:245], v22 offset:40960
v_mfma_f32_16x16x32_bf16 a[16:19], v[228:231], v[188:191], a[16:19]
v_mfma_f32_16x16x32_bf16 a[20:23], v[228:231], v[180:183], a[20:23]
s_add_u32 s72, s69, 47104
buffer_load_dwordx4 v2, s[8:11], s72 offen offset:2048 lds
v_mfma_f32_16x16x32_bf16 a[20:23], v[224:227], v[176:179], a[20:23]
ds_read_b64_tr_b16 v[246:247], v22 offset:41984
v_mfma_f32_16x16x32_bf16 a[24:27], v[224:227], v[168:171], a[24:27]
v_mfma_f32_16x16x32_bf16 a[24:27], v[228:231], v[172:175], a[24:27]
v_mfma_f32_16x16x32_bf16 a[28:31], v[228:231], v[164:167], a[28:31]
s_add_u32 s72, s69, 54272
buffer_load_dwordx4 v3, s[8:11], s72 offen offset:3072 lds
v_mfma_f32_16x16x32_bf16 a[28:31], v[224:227], v[160:163], a[28:31]
s_waitcnt lgkmcnt(3)
v_mfma_f32_16x16x32_bf16 a[60:63], v[232:235], v[160:163], a[60:63]
ds_read_b64_tr_b16 v[248:249], v23 offset:32768
v_mfma_f32_16x16x32_bf16 a[60:63], v[236:239], v[164:167], a[60:63]
v_mfma_f32_16x16x32_bf16 a[56:59], v[236:239], v[172:175], a[56:59]
s_add_u32 m0, s64, 16384
ds_read_b64_tr_b16 v[250:251], v23 offset:33792
v_mfma_f32_16x16x32_bf16 a[56:59], v[232:235], v[168:171], a[56:59]
s_add_u32 s72, s71, 0
buffer_load_dwordx4 v6, s[20:23], s72 offen lds
v_mfma_f32_16x16x32_bf16 a[52:55], v[232:235], v[176:179], a[52:55]
v_mfma_f32_16x16x32_bf16 a[52:55], v[236:239], v[180:183], a[52:55]
v_mfma_f32_16x16x32_bf16 a[48:51], v[236:239], v[188:191], a[48:51]
ds_read_b64_tr_b16 v[252:253], v23 offset:40960
v_mfma_f32_16x16x32_bf16 a[48:51], v[232:235], v[184:187], a[48:51]
s_add_u32 s72, s71, 31744
buffer_load_dwordx4 v6, s[20:23], s72 offen offset:1024 lds
v_mfma_f32_16x16x32_bf16 a[44:47], v[232:235], v[216:219], a[44:47]
v_mfma_f32_16x16x32_bf16 a[44:47], v[236:239], v[220:223], a[44:47]
v_mfma_f32_16x16x32_bf16 a[40:43], v[236:239], v[212:215], a[40:43]
ds_read_b64_tr_b16 v[254:255], v23 offset:41984
v_mfma_f32_16x16x32_bf16 a[40:43], v[232:235], v[208:211], a[40:43]
s_add_u32 s72, s71, 63488
buffer_load_dwordx4 v7, s[20:23], s72 offen offset:2048 lds
v_mfma_f32_16x16x32_bf16 a[36:39], v[232:235], v[200:203], a[36:39]
v_mfma_f32_16x16x32_bf16 a[36:39], v[236:239], v[204:207], a[36:39]
v_mfma_f32_16x16x32_bf16 a[32:35], v[236:239], v[196:199], a[32:35]
s_add_u32 s72, s71, 95232
v_mfma_f32_16x16x32_bf16 a[32:35], v[232:235], v[192:195], a[32:35]
s_waitcnt lgkmcnt(4)
buffer_load_dwordx4 v7, s[20:23], s72 offen offset:3072 lds
v_mfma_f32_16x16x32_bf16 a[64:67], v[240:243], v[192:195], a[64:67]
ds_read_b64_tr_b16 v[224:225], v20 offset:49152
v_mfma_f32_16x16x32_bf16 a[64:67], v[244:247], v[196:199], a[64:67]
v_mfma_f32_16x16x32_bf16 a[68:71], v[244:247], v[204:207], a[68:71]
ds_read_b64_tr_b16 v[226:227], v20 offset:50176
v_mfma_f32_16x16x32_bf16 a[68:71], v[240:243], v[200:203], a[68:71]
buffer_load_dwordx4 v[108:111], v1, s[4:7], s76 offen
v_mfma_f32_16x16x32_bf16 a[72:75], v[240:243], v[208:211], a[72:75]
v_mfma_f32_16x16x32_bf16 a[72:75], v[244:247], v[212:215], a[72:75]
v_mfma_f32_16x16x32_bf16 a[76:79], v[244:247], v[220:223], a[76:79]
ds_read_b64_tr_b16 v[228:229], v20 offset:57344
v_mfma_f32_16x16x32_bf16 a[76:79], v[240:243], v[216:219], a[76:79]
buffer_load_dwordx4 v[112:115], v1, s[4:7], s76 offen offset:1024
v_mfma_f32_16x16x32_bf16 a[80:83], v[240:243], v[184:187], a[80:83]
v_mfma_f32_16x16x32_bf16 a[80:83], v[244:247], v[188:191], a[80:83]
v_mfma_f32_16x16x32_bf16 a[84:87], v[244:247], v[180:183], a[84:87]
ds_read_b64_tr_b16 v[230:231], v20 offset:58368
v_mfma_f32_16x16x32_bf16 a[84:87], v[240:243], v[176:179], a[84:87]
buffer_load_dwordx4 v[116:119], v1, s[4:7], s76 offen offset:2048
v_mfma_f32_16x16x32_bf16 a[88:91], v[240:243], v[168:171], a[88:91]
v_mfma_f32_16x16x32_bf16 a[88:91], v[244:247], v[172:175], a[88:91]
v_mfma_f32_16x16x32_bf16 a[92:95], v[244:247], v[164:167], a[92:95]
v_mfma_f32_16x16x32_bf16 a[92:95], v[240:243], v[160:163], a[92:95]
s_waitcnt lgkmcnt(4)
buffer_load_dwordx4 v[120:123], v1, s[4:7], s76 offen offset:3072
v_mfma_f32_16x16x32_bf16 a[124:127], v[248:251], v[160:163], a[124:127]
ds_read_b64_tr_b16 v[232:233], v21 offset:49152
v_mfma_f32_16x16x32_bf16 a[124:127], v[252:255], v[164:167], a[124:127]
v_mfma_f32_16x16x32_bf16 a[120:123], v[252:255], v[172:175], a[120:123]
v_mfma_f32_16x16x32_bf16 a[120:123], v[248:251], v[168:171], a[120:123]
ds_read_b64_tr_b16 v[234:235], v21 offset:50176
v_mfma_f32_16x16x32_bf16 a[116:119], v[248:251], v[176:179], a[116:119]
s_waitcnt vmcnt(20)
ds_read2_b32 v[36:37], v98 offset0:0 offset1:32
ds_read2_b32 v[38:39], v98 offset0:64 offset1:96
v_mfma_f32_16x16x32_bf16 a[116:119], v[252:255], v[180:183], a[116:119]
ds_read2_b32 v[40:41], v98 offset0:128 offset1:160
ds_read2_b32 v[42:43], v98 offset0:192 offset1:224
v_mfma_f32_16x16x32_bf16 a[112:115], v[252:255], v[188:191], a[112:115]
v_add_u32 v98, 1024, v98
v_mfma_f32_16x16x32_bf16 a[112:115], v[248:251], v[184:187], a[112:115]
ds_read_b64_tr_b16 v[236:237], v21 offset:57344
ds_read2_b32 v[44:45], v98 offset0:0 offset1:32
v_mfma_f32_16x16x32_bf16 a[108:111], v[248:251], v[216:219], a[108:111]
ds_read2_b32 v[46:47], v98 offset0:64 offset1:96
ds_read2_b32 v[48:49], v98 offset0:128 offset1:160
v_mfma_f32_16x16x32_bf16 a[108:111], v[252:255], v[220:223], a[108:111]
ds_read2_b32 v[50:51], v98 offset0:192 offset1:224
v_add_u32 v98, 3072, v98
v_mfma_f32_16x16x32_bf16 a[104:107], v[252:255], v[212:215], a[104:107]
ds_read_b64_tr_b16 v[238:239], v21 offset:58368
ds_read2_b32 v[52:53], v98 offset0:0 offset1:32
v_mfma_f32_16x16x32_bf16 a[104:107], v[248:251], v[208:211], a[104:107]
ds_read2_b32 v[54:55], v98 offset0:64 offset1:96
ds_read2_b32 v[56:57], v98 offset0:128 offset1:160
v_mfma_f32_16x16x32_bf16 a[100:103], v[248:251], v[200:203], a[100:103]
ds_read2_b32 v[58:59], v98 offset0:192 offset1:224
v_add_u32 v98, 1024, v98
v_mfma_f32_16x16x32_bf16 a[100:103], v[252:255], v[204:207], a[100:103]
ds_read2_b32 v[60:61], v98 offset0:0 offset1:32
ds_read2_b32 v[62:63], v98 offset0:64 offset1:96
v_mfma_f32_16x16x32_bf16 a[96:99], v[252:255], v[196:199], a[96:99]
ds_read2_b32 v[64:65], v98 offset0:128 offset1:160
ds_read2_b32 v[66:67], v98 offset0:192 offset1:224
v_mfma_f32_16x16x32_bf16 a[96:99], v[248:251], v[192:195], a[96:99]
s_waitcnt lgkmcnt(15)
v_mfma_f32_16x16x32_bf16 a[128:131], v[192:195], v[224:227], a[128:131]
ds_read_b64_tr_b16 v[240:241], v22 offset:49152
v_mfma_f32_16x16x32_bf16 a[128:131], v[196:199], v[228:231], a[128:131]
v_mfma_f32_16x16x32_bf16 a[132:135], v[204:207], v[228:231], a[132:135]
v_mfma_f32_16x16x32_bf16 a[132:135], v[200:203], v[224:227], a[132:135]
ds_read_b64_tr_b16 v[242:243], v22 offset:50176
v_mfma_f32_16x16x32_bf16 a[136:139], v[208:211], v[224:227], a[136:139]
v_mfma_f32_16x16x32_bf16 a[136:139], v[212:215], v[228:231], a[136:139]
v_mfma_f32_16x16x32_bf16 a[140:143], v[220:223], v[228:231], a[140:143]
v_mfma_f32_16x16x32_bf16 a[140:143], v[216:219], v[224:227], a[140:143]
ds_read_b64_tr_b16 v[244:245], v22 offset:57344
v_mfma_f32_16x16x32_bf16 a[144:147], v[184:187], v[224:227], a[144:147]
v_mfma_f32_16x16x32_bf16 a[144:147], v[188:191], v[228:231], a[144:147]
v_mfma_f32_16x16x32_bf16 a[148:151], v[180:183], v[228:231], a[148:151]
ds_read_b64_tr_b16 v[246:247], v22 offset:58368
v_mfma_f32_16x16x32_bf16 a[148:151], v[176:179], v[224:227], a[148:151]
v_mfma_f32_16x16x32_bf16 a[152:155], v[168:171], v[224:227], a[152:155]
v_mfma_f32_16x16x32_bf16 a[152:155], v[172:175], v[228:231], a[152:155]
v_mfma_f32_16x16x32_bf16 a[156:159], v[164:167], v[228:231], a[156:159]
v_mfma_f32_16x16x32_bf16 a[156:159], v[160:163], v[224:227], a[156:159]
s_waitcnt lgkmcnt(12)
v_mfma_f32_16x16x32_bf16 a[188:191], v[160:163], v[232:235], a[188:191]
ds_read_b64_tr_b16 v[248:249], v23 offset:49152
v_mfma_f32_16x16x32_bf16 a[188:191], v[164:167], v[236:239], a[188:191]
v_mfma_f32_16x16x32_bf16 a[184:187], v[172:175], v[236:239], a[184:187]
ds_read_b64_tr_b16 v[250:251], v23 offset:50176
v_mfma_f32_16x16x32_bf16 a[184:187], v[168:171], v[232:235], a[184:187]
v_mfma_f32_16x16x32_bf16 a[180:183], v[176:179], v[232:235], a[180:183]
ds_read_b64_tr_b16 v[252:253], v23 offset:57344
v_mfma_f32_16x16x32_bf16 a[180:183], v[180:183], v[236:239], a[180:183]
v_mfma_f32_16x16x32_bf16 a[176:179], v[188:191], v[236:239], a[176:179]
ds_read_b64_tr_b16 v[254:255], v23 offset:58368
v_mfma_f32_16x16x32_bf16 a[176:179], v[184:187], v[232:235], a[176:179]
s_and_b32 s73, s65, 1
v_mfma_f32_16x16x32_bf16 a[172:175], v[216:219], v[232:235], a[172:175]
s_xor_b32 s73, s73, 5
v_mfma_f32_16x16x32_bf16 a[172:175], v[220:223], v[236:239], a[172:175]
s_lshl_b32 s69, s73, 7
v_mfma_f32_16x16x32_bf16 a[168:171], v[212:215], v[236:239], a[168:171]
s_add_u32 s69, s69, s84
v_mfma_f32_16x16x32_bf16 a[168:171], v[208:211], v[232:235], a[168:171]
s_lshl_b32 s71, s73, 19
v_mfma_f32_16x16x32_bf16 a[164:167], v[200:203], v[232:235], a[164:167]
s_add_u32 s71, s71, s66
v_mfma_f32_16x16x32_bf16 a[164:167], v[204:207], v[236:239], a[164:167]
s_add_u32 m0, s63, 98304
v_mfma_f32_16x16x32_bf16 a[160:163], v[196:199], v[236:239], a[160:163]
s_waitcnt vmcnt(4) lgkmcnt(0)
v_mfma_f32_16x16x32_bf16 a[160:163], v[192:195], v[232:235], a[160:163]
s_barrier
v_mfma_f32_16x16x32_bf16 a[192:195], v[192:195], v[240:243], a[192:195]
s_add_u32 s72, s69, 0
buffer_load_dwordx4 v2, s[8:11], s72 offen lds
v_mfma_f32_16x16x32_bf16 a[192:195], v[196:199], v[244:247], a[192:195]
ds_read_b64_tr_b16 v[224:225], v20 offset:0
v_lshlrev_b32 v72, 16, v68
v_mfma_f32_16x16x32_bf16 a[196:199], v[204:207], v[244:247], a[196:199]
ds_read_b64_tr_b16 v[226:227], v20 offset:1024
v_and_b32 v73, 0xffff0000, v68
v_mfma_f32_16x16x32_bf16 a[196:199], v[200:203], v[240:243], a[196:199]
ds_read_b64_tr_b16 v[228:229], v20 offset:8192
v_lshlrev_b32 v74, 16, v69
v_mfma_f32_16x16x32_bf16 a[200:203], v[208:211], v[240:243], a[200:203]
s_add_u32 s72, s69, 7168
buffer_load_dwordx4 v3, s[8:11], s72 offen offset:1024 lds
v_mfma_f32_16x16x32_bf16 a[200:203], v[212:215], v[244:247], a[200:203]
ds_read_b64_tr_b16 v[230:231], v20 offset:9216
v_and_b32 v75, 0xffff0000, v69
v_mfma_f32_16x16x32_bf16 a[204:207], v[220:223], v[244:247], a[204:207]
ds_read_b128 v[128:131], v24 offset:0
v_lshlrev_b32 v76, 16, v33
v_mfma_f32_16x16x32_bf16 a[204:207], v[216:219], v[240:243], a[204:207]
ds_read_b128 v[132:135], v25 offset:0
v_lshlrev_b32 v77, 16, v34
v_mfma_f32_16x16x32_bf16 a[208:211], v[184:187], v[240:243], a[208:211]
s_add_u32 s72, s69, 14336
buffer_load_dwordx4 v2, s[8:11], s72 offen offset:2048 lds
v_mfma_f32_16x16x32_bf16 a[208:211], v[188:191], v[244:247], a[208:211]
ds_read_b128 v[136:139], v24 offset:2048
v_lshlrev_b32 v78, 16, v35
v_mfma_f32_16x16x32_bf16 a[212:215], v[180:183], v[244:247], a[212:215]
ds_read_b128 v[140:143], v25 offset:2048
v_lshlrev_b32 v79, 16, v36
v_mfma_f32_16x16x32_bf16 a[212:215], v[176:179], v[240:243], a[212:215]
ds_read_b128 v[144:147], v24 offset:4096
v_lshlrev_b32 v80, 16, v37
v_mfma_f32_16x16x32_bf16 a[216:219], v[168:171], v[240:243], a[216:219]
s_add_u32 s72, s69, 21504
buffer_load_dwordx4 v3, s[8:11], s72 offen offset:3072 lds
v_mfma_f32_16x16x32_bf16 a[216:219], v[172:175], v[244:247], a[216:219]
ds_read_b128 v[148:151], v25 offset:4096
v_lshlrev_b32 v81, 16, v38
v_mfma_f32_16x16x32_bf16 a[220:223], v[164:167], v[244:247], a[220:223]
ds_read_b128 v[152:155], v24 offset:6144
v_lshlrev_b32 v82, 16, v39
v_mfma_f32_16x16x32_bf16 a[220:223], v[160:163], v[240:243], a[220:223]
ds_read_b128 v[156:159], v25 offset:6144
v_lshlrev_b32 v83, 16, v40
v_mfma_f32_16x16x32_bf16 a[252:255], v[160:163], v[248:251], a[252:255]
s_add_u32 m0, s64, 32768
v_lshlrev_b32 v84, 16, v41
v_lshlrev_b32 v85, 16, v42
v_mfma_f32_16x16x32_bf16 a[252:255], v[164:167], v[252:255], a[252:255]
s_add_u32 s72, s71, 0
buffer_load_dwordx4 v6, s[16:19], s72 offen lds
v_mfma_f32_16x16x32_bf16 a[248:251], v[172:175], v[252:255], a[248:251]
ds_read_b128 v[160:163], v24 offset:8192
v_lshlrev_b32 v86, 16, v43
v_mfma_f32_16x16x32_bf16 a[248:251], v[168:171], v[248:251], a[248:251]
ds_read_b128 v[164:167], v25 offset:8192
v_lshlrev_b32 v87, 16, v44
v_mfma_f32_16x16x32_bf16 a[244:247], v[176:179], v[248:251], a[244:247]
v_lshlrev_b32 v88, 16, v45
v_lshlrev_b32 v89, 16, v46
v_mfma_f32_16x16x32_bf16 a[244:247], v[180:183], v[252:255], a[244:247]
s_add_u32 s72, s71, 31744
buffer_load_dwordx4 v6, s[16:19], s72 offen offset:1024 lds
v_mfma_f32_16x16x32_bf16 a[240:243], v[188:191], v[252:255], a[240:243]
ds_read_b128 v[168:171], v24 offset:10240
v_lshlrev_b32 v90, 16, v47
v_mfma_f32_16x16x32_bf16 a[240:243], v[184:187], v[248:251], a[240:243]
ds_read_b128 v[172:175], v25 offset:10240
v_lshlrev_b32 v91, 16, v48
v_mfma_f32_16x16x32_bf16 a[236:239], v[216:219], v[248:251], a[236:239]
ds_read_b128 v[176:179], v24 offset:12288
v_lshlrev_b32 v92, 16, v49
v_mfma_f32_16x16x32_bf16 a[236:239], v[220:223], v[252:255], a[236:239]
s_add_u32 s72, s71, 63488
buffer_load_dwordx4 v7, s[16:19], s72 offen offset:2048 lds
v_mfma_f32_16x16x32_bf16 a[232:235], v[212:215], v[252:255], a[232:235]
ds_read_b128 v[180:183], v25 offset:12288
v_lshlrev_b32 v93, 16, v50
v_mfma_f32_16x16x32_bf16 a[232:235], v[208:211], v[248:251], a[232:235]
ds_read_b128 v[184:187], v24 offset:14336
v_lshlrev_b32 v94, 16, v51
v_mfma_f32_16x16x32_bf16 a[228:231], v[200:203], v[248:251], a[228:231]
ds_read_b128 v[188:191], v25 offset:14336
v_mul_f32 v95, v75, v91
v_mfma_f32_16x16x32_bf16 a[228:231], v[204:207], v[252:255], a[228:231]
s_add_u32 s72, s71, 95232
buffer_load_dwordx4 v7, s[16:19], s72 offen offset:3072 lds
v_mfma_f32_16x16x32_bf16 a[224:227], v[196:199], v[252:255], a[224:227]
ds_read_b64_tr_b16 v[232:233], v21 offset:0
v_lshlrev_b32 v97, 16, v67
v_mfma_f32_16x16x32_bf16 a[224:227], v[192:195], v[248:251], a[224:227]
s_waitcnt lgkmcnt(9)
ds_read_b64_tr_b16 v[234:235], v21 offset:1024
v_fmac_f32 v95, v74, v92
v_mfma_f32_16x16x32_bf16 a[0:3], v[224:227], v[128:131], a[0:3]
ds_read_b64_tr_b16 v[240:241], v22 offset:0
v_fmac_f32 v95, v73, v93
v_mfma_f32_16x16x32_bf16 a[0:3], v[228:231], v[132:135], a[0:3]
s_add_u32 m0, s63, 102400
ds_read_b64_tr_b16 v[236:237], v21 offset:8192
v_fmac_f32 v95, v72, v94
v_mfma_f32_16x16x32_bf16 a[4:7], v[228:231], v[140:143], a[4:7]
s_add_u32 s72, s69, 32768
buffer_load_dwordx4 v2, s[8:11], s72 offen lds
v_mfma_f32_16x16x32_bf16 a[4:7], v[224:227], v[136:139], a[4:7]
v_mul_f32 v95, v95, v97
v_mul_f32 v96, v75, v90
v_mfma_f32_16x16x32_bf16 a[8:11], v[224:227], v[144:147], a[8:11]
ds_read_b64_tr_b16 v[238:239], v21 offset:9216
v_lshlrev_b32 v97, 16, v66
v_mfma_f32_16x16x32_bf16 a[8:11], v[228:231], v[148:151], a[8:11]
ds_read_b64_tr_b16 v[242:243], v22 offset:1024
v_fmac_f32 v96, v74, v91
v_mfma_f32_16x16x32_bf16 a[12:15], v[228:231], v[156:159], a[12:15]
s_add_u32 s72, s69, 39936
buffer_load_dwordx4 v3, s[8:11], s72 offen offset:1024 lds
v_mfma_f32_16x16x32_bf16 a[12:15], v[224:227], v[152:155], a[12:15]
s_waitcnt lgkmcnt(6)
v_fmac_f32 v96, v73, v92
v_fmac_f32 v96, v72, v93
v_mfma_f32_16x16x32_bf16 a[16:19], v[224:227], v[160:163], a[16:19]
ds_read_b64_tr_b16 v[244:245], v22 offset:8192
v_mul_f32 v96, v96, v97
v_mfma_f32_16x16x32_bf16 a[16:19], v[228:231], v[164:167], a[16:19]
v_cvt_pk_bf16_f32 v100, v95, v96
v_mul_f32 v95, v75, v89
v_mfma_f32_16x16x32_bf16 a[20:23], v[228:231], v[172:175], a[20:23]
s_add_u32 s72, s69, 47104
buffer_load_dwordx4 v2, s[8:11], s72 offen offset:2048 lds
v_mfma_f32_16x16x32_bf16 a[20:23], v[224:227], v[168:171], a[20:23]
ds_read_b64_tr_b16 v[246:247], v22 offset:9216
v_lshlrev_b32 v97, 16, v65
v_mfma_f32_16x16x32_bf16 a[24:27], v[224:227], v[176:179], a[24:27]
v_fmac_f32 v95, v74, v90
v_fmac_f32 v95, v73, v91
v_mfma_f32_16x16x32_bf16 a[24:27], v[228:231], v[180:183], a[24:27]
v_fmac_f32 v95, v72, v92
v_mul_f32 v95, v95, v97
v_mfma_f32_16x16x32_bf16 a[28:31], v[228:231], v[188:191], a[28:31]
s_add_u32 s72, s69, 54272
buffer_load_dwordx4 v3, s[8:11], s72 offen offset:3072 lds
v_mfma_f32_16x16x32_bf16 a[28:31], v[224:227], v[184:187], a[28:31]
s_waitcnt lgkmcnt(3)
v_mul_f32 v96, v75, v88
v_lshlrev_b32 v97, 16, v64
v_mfma_f32_16x16x32_bf16 a[60:63], v[232:235], v[184:187], a[60:63]
ds_read_b64_tr_b16 v[248:249], v23 offset:0
v_fmac_f32 v96, v74, v89
v_mfma_f32_16x16x32_bf16 a[60:63], v[236:239], v[188:191], a[60:63]
v_fmac_f32 v96, v73, v90
v_fmac_f32 v96, v72, v91
v_mfma_f32_16x16x32_bf16 a[56:59], v[236:239], v[180:183], a[56:59]
s_add_u32 m0, s64, 49152
ds_read_b64_tr_b16 v[250:251], v23 offset:1024
v_mul_f32 v96, v96, v97
v_mfma_f32_16x16x32_bf16 a[56:59], v[232:235], v[176:179], a[56:59]
s_add_u32 s72, s71, 0
buffer_load_dwordx4 v6, s[20:23], s72 offen lds
v_mfma_f32_16x16x32_bf16 a[52:55], v[232:235], v[168:171], a[52:55]
v_cvt_pk_bf16_f32 v101, v95, v96
v_mul_f32 v95, v75, v87
v_mfma_f32_16x16x32_bf16 a[52:55], v[236:239], v[172:175], a[52:55]
v_lshlrev_b32 v97, 16, v63
v_fmac_f32 v95, v74, v88
v_mfma_f32_16x16x32_bf16 a[48:51], v[236:239], v[164:167], a[48:51]
ds_read_b64_tr_b16 v[252:253], v23 offset:8192
v_fmac_f32 v95, v73, v89
v_mfma_f32_16x16x32_bf16 a[48:51], v[232:235], v[160:163], a[48:51]
s_add_u32 s72, s71, 31744
buffer_load_dwordx4 v6, s[20:23], s72 offen offset:1024 lds
v_mfma_f32_16x16x32_bf16 a[44:47], v[232:235], v[152:155], a[44:47]
v_fmac_f32 v95, v72, v90
v_mul_f32 v95, v95, v97
v_mfma_f32_16x16x32_bf16 a[44:47], v[236:239], v[156:159], a[44:47]
v_mul_f32 v96, v75, v86
v_lshlrev_b32 v97, 16, v62
v_mfma_f32_16x16x32_bf16 a[40:43], v[236:239], v[148:151], a[40:43]
ds_read_b64_tr_b16 v[254:255], v23 offset:9216
v_fmac_f32 v96, v74, v87
v_mfma_f32_16x16x32_bf16 a[40:43], v[232:235], v[144:147], a[40:43]
s_add_u32 s72, s71, 63488
buffer_load_dwordx4 v7, s[20:23], s72 offen offset:2048 lds
v_mfma_f32_16x16x32_bf16 a[36:39], v[232:235], v[136:139], a[36:39]
v_fmac_f32 v96, v73, v88
v_fmac_f32 v96, v72, v89
v_mfma_f32_16x16x32_bf16 a[36:39], v[236:239], v[140:143], a[36:39]
v_mul_f32 v96, v96, v97
v_cvt_pk_bf16_f32 v102, v95, v96
v_mfma_f32_16x16x32_bf16 a[32:35], v[236:239], v[132:135], a[32:35]
s_add_u32 s72, s71, 95232
v_mul_f32 v95, v75, v85
v_lshlrev_b32 v97, 16, v61
v_mfma_f32_16x16x32_bf16 a[32:35], v[232:235], v[128:131], a[32:35]
s_waitcnt lgkmcnt(4)
buffer_load_dwordx4 v7, s[20:23], s72 offen offset:3072 lds
v_mfma_f32_16x16x32_bf16 a[64:67], v[240:243], v[128:131], a[64:67]
ds_read_b64_tr_b16 v[224:225], v20 offset:16384
v_fmac_f32 v95, v74, v86
v_mfma_f32_16x16x32_bf16 a[64:67], v[244:247], v[132:135], a[64:67]
v_fmac_f32 v95, v73, v87
v_fmac_f32 v95, v72, v88
v_mfma_f32_16x16x32_bf16 a[68:71], v[244:247], v[140:143], a[68:71]
ds_read_b64_tr_b16 v[226:227], v20 offset:17408
v_mul_f32 v95, v95, v97
v_mfma_f32_16x16x32_bf16 a[68:71], v[240:243], v[136:139], a[68:71]
s_mov_b32 s80, 0x0
buffer_load_dword v126, v125, s[12:15], s80 offen
v_mfma_f32_16x16x32_bf16 a[72:75], v[240:243], v[144:147], a[72:75]
v_mul_f32 v96, v75, v84
v_lshlrev_b32 v97, 16, v60
v_mfma_f32_16x16x32_bf16 a[72:75], v[244:247], v[148:151], a[72:75]
v_fmac_f32 v96, v74, v85
v_fmac_f32 v96, v73, v86
v_mfma_f32_16x16x32_bf16 a[76:79], v[244:247], v[156:159], a[76:79]
ds_read_b64_tr_b16 v[228:229], v20 offset:24576
v_fmac_f32 v96, v72, v87
v_mfma_f32_16x16x32_bf16 a[76:79], v[240:243], v[152:155], a[76:79]
s_mov_b32 s80, 0x100000
buffer_load_dword v126, v125, s[12:15], s80 offen
v_mfma_f32_16x16x32_bf16 a[80:83], v[240:243], v[160:163], a[80:83]
v_mul_f32 v96, v96, v97
v_cvt_pk_bf16_f32 v103, v95, v96
v_mfma_f32_16x16x32_bf16 a[80:83], v[244:247], v[164:167], a[80:83]
ds_write_b128 v28, v[100:103] offset:0
v_mul_f32 v95, v75, v83
v_mfma_f32_16x16x32_bf16 a[84:87], v[244:247], v[172:175], a[84:87]
ds_read_b64_tr_b16 v[230:231], v20 offset:25600
v_lshlrev_b32 v97, 16, v59
v_mfma_f32_16x16x32_bf16 a[84:87], v[240:243], v[168:171], a[84:87]
s_mov_b32 s80, 0x200000
buffer_load_dword v126, v125, s[12:15], s80 offen
v_mfma_f32_16x16x32_bf16 a[88:91], v[240:243], v[176:179], a[88:91]
v_fmac_f32 v95, v74, v84
v_fmac_f32 v95, v73, v85
v_mfma_f32_16x16x32_bf16 a[88:91], v[244:247], v[180:183], a[88:91]
v_fmac_f32 v95, v72, v86
v_mul_f32 v95, v95, v97
v_mfma_f32_16x16x32_bf16 a[92:95], v[244:247], v[188:191], a[92:95]
v_mul_f32 v96, v75, v82
v_lshlrev_b32 v97, 16, v58
v_mfma_f32_16x16x32_bf16 a[92:95], v[240:243], v[184:187], a[92:95]
s_waitcnt lgkmcnt(5)
v_fmac_f32 v96, v74, v83
v_fmac_f32 v96, v73, v84
v_mfma_f32_16x16x32_bf16 a[124:127], v[248:251], v[184:187], a[124:127]
s_mov_b32 s80, 0x300000
buffer_load_dword v126, v125, s[12:15], s80 offen
v_mfma_f32_16x16x32_bf16 a[124:127], v[252:255], v[188:191], a[124:127]
ds_read_b64_tr_b16 v[232:233], v21 offset:16384
v_fmac_f32 v96, v72, v85
v_mfma_f32_16x16x32_bf16 a[120:123], v[252:255], v[180:183], a[120:123]
v_mul_f32 v96, v96, v97
v_cvt_pk_bf16_f32 v104, v95, v96
v_mfma_f32_16x16x32_bf16 a[120:123], v[248:251], v[176:179], a[120:123]
v_mul_f32 v95, v75, v81
v_lshlrev_b32 v97, 16, v57
v_mfma_f32_16x16x32_bf16 a[116:119], v[248:251], v[168:171], a[116:119]
ds_read_b64_tr_b16 v[234:235], v21 offset:17408
v_fmac_f32 v95, v74, v82
v_mfma_f32_16x16x32_bf16 a[116:119], v[252:255], v[172:175], a[116:119]
v_fmac_f32 v95, v73, v83
v_fmac_f32 v95, v72, v84
v_mfma_f32_16x16x32_bf16 a[112:115], v[252:255], v[164:167], a[112:115]
v_mul_f32 v95, v95, v97
v_mul_f32 v96, v75, v80
v_mfma_f32_16x16x32_bf16 a[112:115], v[248:251], v[160:163], a[112:115]
ds_read_b64_tr_b16 v[236:237], v21 offset:24576
v_lshlrev_b32 v97, 16, v56
v_mfma_f32_16x16x32_bf16 a[108:111], v[248:251], v[152:155], a[108:111]
v_fmac_f32 v96, v74, v81
v_fmac_f32 v96, v73, v82
v_mfma_f32_16x16x32_bf16 a[108:111], v[252:255], v[156:159], a[108:111]
v_fmac_f32 v96, v72, v83
v_mul_f32 v96, v96, v97
v_mfma_f32_16x16x32_bf16 a[104:107], v[252:255], v[148:151], a[104:107]
ds_read_b64_tr_b16 v[238:239], v21 offset:25600
v_cvt_pk_bf16_f32 v105, v95, v96
v_mfma_f32_16x16x32_bf16 a[104:107], v[248:251], v[144:147], a[104:107]
v_mul_f32 v95, v75, v79
v_lshlrev_b32 v97, 16, v55
v_mfma_f32_16x16x32_bf16 a[100:103], v[248:251], v[136:139], a[100:103]
v_fmac_f32 v95, v74, v80
v_fmac_f32 v95, v73, v81
v_mfma_f32_16x16x32_bf16 a[100:103], v[252:255], v[140:143], a[100:103]
v_fmac_f32 v95, v72, v82
v_mul_f32 v95, v95, v97
v_mfma_f32_16x16x32_bf16 a[96:99], v[252:255], v[132:135], a[96:99]
v_mul_f32 v96, v75, v78
v_lshlrev_b32 v97, 16, v54
v_mfma_f32_16x16x32_bf16 a[96:99], v[248:251], v[128:131], a[96:99]
s_waitcnt lgkmcnt(4)
v_fmac_f32 v96, v74, v79
v_fmac_f32 v96, v73, v80
v_mfma_f32_16x16x32_bf16 a[128:131], v[128:131], v[224:227], a[128:131]
ds_read_b64_tr_b16 v[240:241], v22 offset:16384
v_fmac_f32 v96, v72, v81
v_mfma_f32_16x16x32_bf16 a[128:131], v[132:135], v[228:231], a[128:131]
v_mul_f32 v96, v96, v97
v_cvt_pk_bf16_f32 v106, v95, v96
v_mfma_f32_16x16x32_bf16 a[132:135], v[140:143], v[228:231], a[132:135]
v_mul_f32 v95, v75, v77
v_lshlrev_b32 v97, 16, v53
v_mfma_f32_16x16x32_bf16 a[132:135], v[136:139], v[224:227], a[132:135]
ds_read_b64_tr_b16 v[242:243], v22 offset:17408
v_fmac_f32 v95, v74, v78
v_mfma_f32_16x16x32_bf16 a[136:139], v[144:147], v[224:227], a[136:139]
v_fmac_f32 v95, v73, v79
v_fmac_f32 v95, v72, v80
v_mfma_f32_16x16x32_bf16 a[136:139], v[148:151], v[228:231], a[136:139]
v_mul_f32 v95, v95, v97
v_mul_f32 v96, v75, v76
v_mfma_f32_16x16x32_bf16 a[140:143], v[156:159], v[228:231], a[140:143]
v_lshlrev_b32 v97, 16, v52
v_fmac_f32 v96, v74, v77
v_mfma_f32_16x16x32_bf16 a[140:143], v[152:155], v[224:227], a[140:143]
ds_read_b64_tr_b16 v[244:245], v22 offset:24576
v_fmac_f32 v96, v73, v78
v_mfma_f32_16x16x32_bf16 a[144:147], v[160:163], v[224:227], a[144:147]
v_fmac_f32 v96, v72, v79
v_mul_f32 v96, v96, v97
v_mfma_f32_16x16x32_bf16 a[144:147], v[164:167], v[228:231], a[144:147]
v_cvt_pk_bf16_f32 v107, v95, v96
v_mfma_f32_16x16x32_bf16 a[148:151], v[172:175], v[228:231], a[148:151]
ds_read_b64_tr_b16 v[246:247], v22 offset:25600
ds_write_b128 v28, v[104:107] offset:16
v_mfma_f32_16x16x32_bf16 a[148:151], v[168:171], v[224:227], a[148:151]
global_load_dwordx4 v[84:87], v1, s[56:57]
v_mfma_f32_16x16x32_bf16 a[152:155], v[176:179], v[224:227], a[152:155]
global_load_dwordx4 v[88:91], v1, s[56:57] offset:1024
v_mfma_f32_16x16x32_bf16 a[152:155], v[180:183], v[228:231], a[152:155]
v_lshlrev_b32 v72, 16, v70
v_and_b32 v73, 0xffff0000, v70
v_mfma_f32_16x16x32_bf16 a[156:159], v[188:191], v[228:231], a[156:159]
v_lshlrev_b32 v74, 16, v71
v_and_b32 v75, 0xffff0000, v71
v_mfma_f32_16x16x32_bf16 a[156:159], v[184:187], v[224:227], a[156:159]
s_waitcnt lgkmcnt(5)
v_and_b32 v33, 0xffff0000, v33
v_and_b32 v34, 0xffff0000, v34
v_mfma_f32_16x16x32_bf16 a[188:191], v[184:187], v[232:235], a[188:191]
ds_read_b64_tr_b16 v[248:249], v23 offset:16384
v_and_b32 v35, 0xffff0000, v35
v_mfma_f32_16x16x32_bf16 a[188:191], v[188:191], v[236:239], a[188:191]
v_and_b32 v36, 0xffff0000, v36
v_and_b32 v37, 0xffff0000, v37
v_mfma_f32_16x16x32_bf16 a[184:187], v[180:183], v[236:239], a[184:187]
ds_read_b64_tr_b16 v[250:251], v23 offset:17408
v_and_b32 v38, 0xffff0000, v38
v_mfma_f32_16x16x32_bf16 a[184:187], v[176:179], v[232:235], a[184:187]
v_and_b32 v39, 0xffff0000, v39
v_and_b32 v40, 0xffff0000, v40
v_mfma_f32_16x16x32_bf16 a[180:183], v[168:171], v[232:235], a[180:183]
ds_read_b64_tr_b16 v[252:253], v23 offset:24576
v_and_b32 v41, 0xffff0000, v41
v_mfma_f32_16x16x32_bf16 a[180:183], v[172:175], v[236:239], a[180:183]
v_and_b32 v42, 0xffff0000, v42
v_and_b32 v43, 0xffff0000, v43
v_mfma_f32_16x16x32_bf16 a[176:179], v[164:167], v[236:239], a[176:179]
ds_read_b64_tr_b16 v[254:255], v23 offset:25600
v_and_b32 v44, 0xffff0000, v44
v_mfma_f32_16x16x32_bf16 a[176:179], v[160:163], v[232:235], a[176:179]
s_and_b32 s73, s65, 1
v_and_b32 v45, 0xffff0000, v45
v_and_b32 v46, 0xffff0000, v46
v_mfma_f32_16x16x32_bf16 a[172:175], v[152:155], v[232:235], a[172:175]
s_xor_b32 s73, s73, 6
v_and_b32 v47, 0xffff0000, v47
v_and_b32 v48, 0xffff0000, v48
v_mfma_f32_16x16x32_bf16 a[172:175], v[156:159], v[236:239], a[172:175]
s_lshl_b32 s69, s73, 7
v_and_b32 v49, 0xffff0000, v49
v_and_b32 v50, 0xffff0000, v50
v_mfma_f32_16x16x32_bf16 a[168:171], v[148:151], v[236:239], a[168:171]
s_add_u32 s69, s69, s84
v_and_b32 v51, 0xffff0000, v51
v_mul_f32 v95, v75, v48
v_mfma_f32_16x16x32_bf16 a[168:171], v[144:147], v[232:235], a[168:171]
s_lshl_b32 s71, s73, 19
v_and_b32 v97, 0xffff0000, v67
v_fmac_f32 v95, v74, v49
v_mfma_f32_16x16x32_bf16 a[164:167], v[136:139], v[232:235], a[164:167]
s_add_u32 s71, s71, s66
v_fmac_f32 v95, v73, v50
v_fmac_f32 v95, v72, v51
v_mfma_f32_16x16x32_bf16 a[164:167], v[140:143], v[236:239], a[164:167]
s_add_u32 m0, s63, 65536
v_mul_f32 v95, v95, v97
v_mul_f32 v96, v75, v47
v_mfma_f32_16x16x32_bf16 a[160:163], v[132:135], v[236:239], a[160:163]
s_waitcnt vmcnt(6) lgkmcnt(0)
v_and_b32 v97, 0xffff0000, v66
v_fmac_f32 v96, v74, v48
v_mfma_f32_16x16x32_bf16 a[160:163], v[128:131], v[232:235], a[160:163]
s_barrier
v_fmac_f32 v96, v73, v49
v_fmac_f32 v96, v72, v50
v_mfma_f32_16x16x32_bf16 a[192:195], v[128:131], v[240:243], a[192:195]
s_add_u32 s72, s69, 0
buffer_load_dwordx4 v2, s[8:11], s72 offen lds
v_mfma_f32_16x16x32_bf16 a[192:195], v[132:135], v[244:247], a[192:195]
ds_read_b64_tr_b16 v[224:225], v20 offset:32768
v_mul_f32 v96, v96, v97
v_mfma_f32_16x16x32_bf16 a[196:199], v[140:143], v[244:247], a[196:199]
ds_read_b64_tr_b16 v[226:227], v20 offset:33792
v_cvt_pk_bf16_f32 v100, v95, v96
v_mfma_f32_16x16x32_bf16 a[196:199], v[136:139], v[240:243], a[196:199]
ds_read_b64_tr_b16 v[228:229], v20 offset:40960
v_mul_f32 v95, v75, v46
v_mfma_f32_16x16x32_bf16 a[200:203], v[144:147], v[240:243], a[200:203]
s_add_u32 s72, s69, 7168
buffer_load_dwordx4 v3, s[8:11], s72 offen offset:1024 lds
v_mfma_f32_16x16x32_bf16 a[200:203], v[148:151], v[244:247], a[200:203]
ds_read_b64_tr_b16 v[230:231], v20 offset:41984
v_and_b32 v97, 0xffff0000, v65
v_mfma_f32_16x16x32_bf16 a[204:207], v[156:159], v[244:247], a[204:207]
ds_read_b128 v[192:195], v24 offset:32768
v_fmac_f32 v95, v74, v47
v_mfma_f32_16x16x32_bf16 a[204:207], v[152:155], v[240:243], a[204:207]
ds_read_b128 v[196:199], v25 offset:32768
v_fmac_f32 v95, v73, v48
v_mfma_f32_16x16x32_bf16 a[208:211], v[160:163], v[240:243], a[208:211]
s_add_u32 s72, s69, 14336
buffer_load_dwordx4 v2, s[8:11], s72 offen offset:2048 lds
v_mfma_f32_16x16x32_bf16 a[208:211], v[164:167], v[244:247], a[208:211]
ds_read_b128 v[200:203], v24 offset:34816
v_fmac_f32 v95, v72, v49
v_mfma_f32_16x16x32_bf16 a[212:215], v[172:175], v[244:247], a[212:215]
ds_read_b128 v[204:207], v25 offset:34816
v_mul_f32 v95, v95, v97
v_mfma_f32_16x16x32_bf16 a[212:215], v[168:171], v[240:243], a[212:215]
ds_read_b128 v[208:211], v24 offset:36864
v_mul_f32 v96, v75, v45
v_mfma_f32_16x16x32_bf16 a[216:219], v[176:179], v[240:243], a[216:219]
s_add_u32 s72, s69, 21504
buffer_load_dwordx4 v3, s[8:11], s72 offen offset:3072 lds
v_mfma_f32_16x16x32_bf16 a[216:219], v[180:183], v[244:247], a[216:219]
ds_read_b128 v[212:215], v25 offset:36864
v_and_b32 v97, 0xffff0000, v64
v_mfma_f32_16x16x32_bf16 a[220:223], v[188:191], v[244:247], a[220:223]
ds_read_b128 v[216:219], v24 offset:38912
v_fmac_f32 v96, v74, v46
v_mfma_f32_16x16x32_bf16 a[220:223], v[184:187], v[240:243], a[220:223]
ds_read_b128 v[220:223], v25 offset:38912
v_fmac_f32 v96, v73, v47
v_mfma_f32_16x16x32_bf16 a[252:255], v[184:187], v[248:251], a[252:255]
s_add_u32 m0, s64, 0
v_fmac_f32 v96, v72, v48
v_mul_f32 v96, v96, v97
v_mfma_f32_16x16x32_bf16 a[252:255], v[188:191], v[252:255], a[252:255]
s_add_u32 s72, s71, 0
buffer_load_dwordx4 v6, s[16:19], s72 offen lds
v_mfma_f32_16x16x32_bf16 a[248:251], v[180:183], v[252:255], a[248:251]
ds_read_b128 v[184:187], v24 offset:40960
v_cvt_pk_bf16_f32 v101, v95, v96
v_mfma_f32_16x16x32_bf16 a[248:251], v[176:179], v[248:251], a[248:251]
ds_read_b128 v[188:191], v25 offset:40960
v_mul_f32 v95, v75, v44
v_mfma_f32_16x16x32_bf16 a[244:247], v[168:171], v[248:251], a[244:247]
v_and_b32 v97, 0xffff0000, v63
v_fmac_f32 v95, v74, v45
v_mfma_f32_16x16x32_bf16 a[244:247], v[172:175], v[252:255], a[244:247]
s_add_u32 s72, s71, 31744
buffer_load_dwordx4 v6, s[16:19], s72 offen offset:1024 lds
v_mfma_f32_16x16x32_bf16 a[240:243], v[164:167], v[252:255], a[240:243]
ds_read_b128 v[176:179], v24 offset:43008
v_fmac_f32 v95, v73, v46
v_mfma_f32_16x16x32_bf16 a[240:243], v[160:163], v[248:251], a[240:243]
ds_read_b128 v[180:183], v25 offset:43008
v_fmac_f32 v95, v72, v47
v_mfma_f32_16x16x32_bf16 a[236:239], v[152:155], v[248:251], a[236:239]
ds_read_b128 v[168:171], v24 offset:45056
v_mul_f32 v95, v95, v97
v_mfma_f32_16x16x32_bf16 a[236:239], v[156:159], v[252:255], a[236:239]
s_add_u32 s72, s71, 63488
buffer_load_dwordx4 v7, s[16:19], s72 offen offset:2048 lds
v_mfma_f32_16x16x32_bf16 a[232:235], v[148:151], v[252:255], a[232:235]
ds_read_b128 v[172:175], v25 offset:45056
v_mul_f32 v96, v75, v43
v_mfma_f32_16x16x32_bf16 a[232:235], v[144:147], v[248:251], a[232:235]
ds_read_b128 v[160:163], v24 offset:47104
v_and_b32 v97, 0xffff0000, v62
v_mfma_f32_16x16x32_bf16 a[228:231], v[136:139], v[248:251], a[228:231]
ds_read_b128 v[164:167], v25 offset:47104
v_fmac_f32 v96, v74, v44
v_mfma_f32_16x16x32_bf16 a[228:231], v[140:143], v[252:255], a[228:231]
s_add_u32 s72, s71, 95232
buffer_load_dwordx4 v7, s[16:19], s72 offen offset:3072 lds
v_mfma_f32_16x16x32_bf16 a[224:227], v[132:135], v[252:255], a[224:227]
ds_read_b64_tr_b16 v[232:233], v21 offset:32768
v_fmac_f32 v96, v73, v45
v_mfma_f32_16x16x32_bf16 a[224:227], v[128:131], v[248:251], a[224:227]
s_waitcnt lgkmcnt(9)
ds_read_b64_tr_b16 v[234:235], v21 offset:33792
v_fmac_f32 v96, v72, v46
v_mfma_f32_16x16x32_bf16 a[0:3], v[224:227], v[192:195], a[0:3]
ds_read_b64_tr_b16 v[240:241], v22 offset:32768
v_mul_f32 v96, v96, v97
v_mfma_f32_16x16x32_bf16 a[0:3], v[228:231], v[196:199], a[0:3]
s_add_u32 m0, s63, 69632
ds_read_b64_tr_b16 v[236:237], v21 offset:40960
v_cvt_pk_bf16_f32 v102, v95, v96
v_mfma_f32_16x16x32_bf16 a[4:7], v[228:231], v[204:207], a[4:7]
s_add_u32 s72, s69, 32768
buffer_load_dwordx4 v2, s[8:11], s72 offen lds
v_mfma_f32_16x16x32_bf16 a[4:7], v[224:227], v[200:203], a[4:7]
v_mul_f32 v95, v75, v42
v_and_b32 v97, 0xffff0000, v61
v_mfma_f32_16x16x32_bf16 a[8:11], v[224:227], v[208:211], a[8:11]
ds_read_b64_tr_b16 v[238:239], v21 offset:41984
v_fmac_f32 v95, v74, v43
v_mfma_f32_16x16x32_bf16 a[8:11], v[228:231], v[212:215], a[8:11]
ds_read_b64_tr_b16 v[242:243], v22 offset:33792
v_fmac_f32 v95, v73, v44
v_mfma_f32_16x16x32_bf16 a[12:15], v[228:231], v[220:223], a[12:15]
s_add_u32 s72, s69, 39936
buffer_load_dwordx4 v3, s[8:11], s72 offen offset:1024 lds
v_mfma_f32_16x16x32_bf16 a[12:15], v[224:227], v[216:219], a[12:15]
s_waitcnt lgkmcnt(6)
v_fmac_f32 v95, v72, v45
v_mul_f32 v95, v95, v97
v_mfma_f32_16x16x32_bf16 a[16:19], v[224:227], v[184:187], a[16:19]
ds_read_b64_tr_b16 v[244:245], v22 offset:40960
v_mul_f32 v96, v75, v41
v_mfma_f32_16x16x32_bf16 a[16:19], v[228:231], v[188:191], a[16:19]
v_and_b32 v97, 0xffff0000, v60
v_fmac_f32 v96, v74, v42
v_mfma_f32_16x16x32_bf16 a[20:23], v[228:231], v[180:183], a[20:23]
s_add_u32 s72, s69, 47104
buffer_load_dwordx4 v2, s[8:11], s72 offen offset:2048 lds
v_mfma_f32_16x16x32_bf16 a[20:23], v[224:227], v[176:179], a[20:23]
ds_read_b64_tr_b16 v[246:247], v22 offset:41984
v_fmac_f32 v96, v73, v43
v_mfma_f32_16x16x32_bf16 a[24:27], v[224:227], v[168:171], a[24:27]
v_fmac_f32 v96, v72, v44
v_mul_f32 v96, v96, v97
v_mfma_f32_16x16x32_bf16 a[24:27], v[228:231], v[172:175], a[24:27]
v_cvt_pk_bf16_f32 v103, v95, v96
v_mfma_f32_16x16x32_bf16 a[28:31], v[228:231], v[164:167], a[28:31]
s_add_u32 s72, s69, 54272
buffer_load_dwordx4 v3, s[8:11], s72 offen offset:3072 lds
v_mfma_f32_16x16x32_bf16 a[28:31], v[224:227], v[160:163], a[28:31]
s_waitcnt lgkmcnt(3)
ds_write_b128 v28, v[100:103] offset:272
v_mul_f32 v95, v75, v40
v_mfma_f32_16x16x32_bf16 a[60:63], v[232:235], v[160:163], a[60:63]
ds_read_b64_tr_b16 v[248:249], v23 offset:32768
v_and_b32 v97, 0xffff0000, v59
v_mfma_f32_16x16x32_bf16 a[60:63], v[236:239], v[164:167], a[60:63]
v_fmac_f32 v95, v74, v41
v_fmac_f32 v95, v73, v42
v_mfma_f32_16x16x32_bf16 a[56:59], v[236:239], v[172:175], a[56:59]
s_add_u32 m0, s64, 16384
ds_read_b64_tr_b16 v[250:251], v23 offset:33792
v_fmac_f32 v95, v72, v43
v_mfma_f32_16x16x32_bf16 a[56:59], v[232:235], v[168:171], a[56:59]
s_add_u32 s72, s71, 0
buffer_load_dwordx4 v6, s[20:23], s72 offen lds
v_mfma_f32_16x16x32_bf16 a[52:55], v[232:235], v[176:179], a[52:55]
v_mul_f32 v95, v95, v97
v_mul_f32 v96, v75, v39
v_mfma_f32_16x16x32_bf16 a[52:55], v[236:239], v[180:183], a[52:55]
v_and_b32 v97, 0xffff0000, v58
v_fmac_f32 v96, v74, v40
v_mfma_f32_16x16x32_bf16 a[48:51], v[236:239], v[188:191], a[48:51]
ds_read_b64_tr_b16 v[252:253], v23 offset:40960
v_fmac_f32 v96, v73, v41
v_mfma_f32_16x16x32_bf16 a[48:51], v[232:235], v[184:187], a[48:51]
s_add_u32 s72, s71, 31744
buffer_load_dwordx4 v6, s[20:23], s72 offen offset:1024 lds
v_mfma_f32_16x16x32_bf16 a[44:47], v[232:235], v[216:219], a[44:47]
v_fmac_f32 v96, v72, v42
v_mul_f32 v96, v96, v97
v_mfma_f32_16x16x32_bf16 a[44:47], v[236:239], v[220:223], a[44:47]
v_cvt_pk_bf16_f32 v104, v95, v96
v_mul_f32 v95, v75, v38
v_mfma_f32_16x16x32_bf16 a[40:43], v[236:239], v[212:215], a[40:43]
ds_read_b64_tr_b16 v[254:255], v23 offset:41984
v_and_b32 v97, 0xffff0000, v57
v_mfma_f32_16x16x32_bf16 a[40:43], v[232:235], v[208:211], a[40:43]
s_add_u32 s72, s71, 63488
buffer_load_dwordx4 v7, s[20:23], s72 offen offset:2048 lds
v_mfma_f32_16x16x32_bf16 a[36:39], v[232:235], v[200:203], a[36:39]
v_fmac_f32 v95, v74, v39
v_fmac_f32 v95, v73, v40
v_mfma_f32_16x16x32_bf16 a[36:39], v[236:239], v[204:207], a[36:39]
v_fmac_f32 v95, v72, v41
v_mul_f32 v95, v95, v97
v_mfma_f32_16x16x32_bf16 a[32:35], v[236:239], v[196:199], a[32:35]
s_add_u32 s72, s71, 95232
v_mul_f32 v96, v75, v37
v_and_b32 v97, 0xffff0000, v56
v_mfma_f32_16x16x32_bf16 a[32:35], v[232:235], v[192:195], a[32:35]
s_waitcnt lgkmcnt(5)
buffer_load_dwordx4 v7, s[20:23], s72 offen offset:3072 lds
v_mfma_f32_16x16x32_bf16 a[64:67], v[240:243], v[192:195], a[64:67]
ds_read_b64_tr_b16 v[224:225], v20 offset:49152
v_fmac_f32 v96, v74, v38
v_mfma_f32_16x16x32_bf16 a[64:67], v[244:247], v[196:199], a[64:67]
v_fmac_f32 v96, v73, v39
v_fmac_f32 v96, v72, v40
v_mfma_f32_16x16x32_bf16 a[68:71], v[244:247], v[204:207], a[68:71]
ds_read_b64_tr_b16 v[226:227], v20 offset:50176
v_mul_f32 v96, v96, v97
v_mfma_f32_16x16x32_bf16 a[68:71], v[240:243], v[200:203], a[68:71]
s_mov_b32 s80, 0x400000
buffer_load_dword v126, v125, s[12:15], s80 offen
v_mfma_f32_16x16x32_bf16 a[72:75], v[240:243], v[208:211], a[72:75]
v_cvt_pk_bf16_f32 v105, v95, v96
v_mul_f32 v95, v75, v36
v_mfma_f32_16x16x32_bf16 a[72:75], v[244:247], v[212:215], a[72:75]
v_and_b32 v97, 0xffff0000, v55
v_fmac_f32 v95, v74, v37
v_mfma_f32_16x16x32_bf16 a[76:79], v[244:247], v[220:223], a[76:79]
ds_read_b64_tr_b16 v[228:229], v20 offset:57344
v_fmac_f32 v95, v73, v38
v_mfma_f32_16x16x32_bf16 a[76:79], v[240:243], v[216:219], a[76:79]
s_mov_b32 s80, 0x500000
buffer_load_dword v126, v125, s[12:15], s80 offen
v_mfma_f32_16x16x32_bf16 a[80:83], v[240:243], v[184:187], a[80:83]
v_fmac_f32 v95, v72, v39
v_mul_f32 v95, v95, v97
v_mfma_f32_16x16x32_bf16 a[80:83], v[244:247], v[188:191], a[80:83]
v_mul_f32 v96, v75, v35
v_and_b32 v97, 0xffff0000, v54
v_mfma_f32_16x16x32_bf16 a[84:87], v[244:247], v[180:183], a[84:87]
ds_read_b64_tr_b16 v[230:231], v20 offset:58368
v_fmac_f32 v96, v74, v36
v_mfma_f32_16x16x32_bf16 a[84:87], v[240:243], v[176:179], a[84:87]
s_mov_b32 s80, 0x600000
buffer_load_dword v126, v125, s[12:15], s80 offen
v_mfma_f32_16x16x32_bf16 a[88:91], v[240:243], v[168:171], a[88:91]
v_fmac_f32 v96, v73, v37
v_fmac_f32 v96, v72, v38
v_mfma_f32_16x16x32_bf16 a[88:91], v[244:247], v[172:175], a[88:91]
v_mul_f32 v96, v96, v97
v_cvt_pk_bf16_f32 v106, v95, v96
v_mfma_f32_16x16x32_bf16 a[92:95], v[244:247], v[164:167], a[92:95]
v_mul_f32 v95, v75, v34
v_and_b32 v97, 0xffff0000, v53
v_mfma_f32_16x16x32_bf16 a[92:95], v[240:243], v[160:163], a[92:95]
s_waitcnt lgkmcnt(4)
v_fmac_f32 v95, v74, v35
v_fmac_f32 v95, v73, v36
v_mfma_f32_16x16x32_bf16 a[124:127], v[248:251], v[160:163], a[124:127]
s_mov_b32 s80, 0x700000
buffer_load_dword v126, v125, s[12:15], s80 offen
v_mfma_f32_16x16x32_bf16 a[124:127], v[252:255], v[164:167], a[124:127]
ds_read_b64_tr_b16 v[232:233], v21 offset:49152
v_fmac_f32 v95, v72, v37
v_mfma_f32_16x16x32_bf16 a[120:123], v[252:255], v[172:175], a[120:123]
v_mul_f32 v95, v95, v97
v_mul_f32 v96, v75, v33
v_mfma_f32_16x16x32_bf16 a[120:123], v[248:251], v[168:171], a[120:123]
v_and_b32 v97, 0xffff0000, v52
v_fmac_f32 v96, v74, v34
v_mfma_f32_16x16x32_bf16 a[116:119], v[248:251], v[176:179], a[116:119]
ds_read_b64_tr_b16 v[234:235], v21 offset:50176
v_fmac_f32 v96, v73, v35
v_mfma_f32_16x16x32_bf16 a[116:119], v[252:255], v[180:183], a[116:119]
v_fmac_f32 v96, v72, v36
v_mul_f32 v96, v96, v97
v_mfma_f32_16x16x32_bf16 a[112:115], v[252:255], v[188:191], a[112:115]
v_cvt_pk_bf16_f32 v107, v95, v96
v_mfma_f32_16x16x32_bf16 a[112:115], v[248:251], v[184:187], a[112:115]
ds_read_b64_tr_b16 v[236:237], v21 offset:57344
ds_write_b128 v28, v[104:107] offset:288
v_mfma_f32_16x16x32_bf16 a[108:111], v[248:251], v[216:219], a[108:111]
v_mfma_f32_16x16x32_bf16 a[108:111], v[252:255], v[220:223], a[108:111]
v_mfma_f32_16x16x32_bf16 a[104:107], v[252:255], v[212:215], a[104:107]
ds_read_b64_tr_b16 v[238:239], v21 offset:58368
v_mfma_f32_16x16x32_bf16 a[104:107], v[248:251], v[208:211], a[104:107]
v_mfma_f32_16x16x32_bf16 a[100:103], v[248:251], v[200:203], a[100:103]
v_mfma_f32_16x16x32_bf16 a[100:103], v[252:255], v[204:207], a[100:103]
v_mfma_f32_16x16x32_bf16 a[96:99], v[252:255], v[196:199], a[96:99]
v_mfma_f32_16x16x32_bf16 a[96:99], v[248:251], v[192:195], a[96:99]
s_waitcnt lgkmcnt(5)
v_mfma_f32_16x16x32_bf16 a[128:131], v[192:195], v[224:227], a[128:131]
ds_read_b64_tr_b16 v[240:241], v22 offset:49152
v_mfma_f32_16x16x32_bf16 a[128:131], v[196:199], v[228:231], a[128:131]
v_mfma_f32_16x16x32_bf16 a[132:135], v[204:207], v[228:231], a[132:135]
v_mfma_f32_16x16x32_bf16 a[132:135], v[200:203], v[224:227], a[132:135]
ds_read_b64_tr_b16 v[242:243], v22 offset:50176
v_mfma_f32_16x16x32_bf16 a[136:139], v[208:211], v[224:227], a[136:139]
v_mfma_f32_16x16x32_bf16 a[136:139], v[212:215], v[228:231], a[136:139]
v_mfma_f32_16x16x32_bf16 a[140:143], v[220:223], v[228:231], a[140:143]
v_mfma_f32_16x16x32_bf16 a[140:143], v[216:219], v[224:227], a[140:143]
ds_read_b64_tr_b16 v[244:245], v22 offset:57344
v_mfma_f32_16x16x32_bf16 a[144:147], v[184:187], v[224:227], a[144:147]
v_mfma_f32_16x16x32_bf16 a[144:147], v[188:191], v[228:231], a[144:147]
v_mfma_f32_16x16x32_bf16 a[148:151], v[180:183], v[228:231], a[148:151]
ds_read_b64_tr_b16 v[246:247], v22 offset:58368
v_mfma_f32_16x16x32_bf16 a[148:151], v[176:179], v[224:227], a[148:151]
v_mfma_f32_16x16x32_bf16 a[152:155], v[168:171], v[224:227], a[152:155]
v_mfma_f32_16x16x32_bf16 a[152:155], v[172:175], v[228:231], a[152:155]
v_mfma_f32_16x16x32_bf16 a[156:159], v[164:167], v[228:231], a[156:159]
v_mfma_f32_16x16x32_bf16 a[156:159], v[160:163], v[224:227], a[156:159]
s_waitcnt lgkmcnt(4)
v_mfma_f32_16x16x32_bf16 a[188:191], v[160:163], v[232:235], a[188:191]
ds_read_b64_tr_b16 v[248:249], v23 offset:49152
v_mfma_f32_16x16x32_bf16 a[188:191], v[164:167], v[236:239], a[188:191]
v_mfma_f32_16x16x32_bf16 a[184:187], v[172:175], v[236:239], a[184:187]
ds_read_b64_tr_b16 v[250:251], v23 offset:50176
v_mfma_f32_16x16x32_bf16 a[184:187], v[168:171], v[232:235], a[184:187]
v_mfma_f32_16x16x32_bf16 a[180:183], v[176:179], v[232:235], a[180:183]
ds_read_b64_tr_b16 v[252:253], v23 offset:57344
v_mfma_f32_16x16x32_bf16 a[180:183], v[180:183], v[236:239], a[180:183]
v_mfma_f32_16x16x32_bf16 a[176:179], v[188:191], v[236:239], a[176:179]
ds_read_b64_tr_b16 v[254:255], v23 offset:58368
v_mfma_f32_16x16x32_bf16 a[176:179], v[184:187], v[232:235], a[176:179]
s_and_b32 s73, s65, 1
v_mfma_f32_16x16x32_bf16 a[172:175], v[216:219], v[232:235], a[172:175]
s_xor_b32 s73, s73, 7
v_mfma_f32_16x16x32_bf16 a[172:175], v[220:223], v[236:239], a[172:175]
s_lshl_b32 s69, s73, 7
v_mfma_f32_16x16x32_bf16 a[168:171], v[212:215], v[236:239], a[168:171]
s_add_u32 s69, s69, s84
v_mfma_f32_16x16x32_bf16 a[168:171], v[208:211], v[232:235], a[168:171]
s_lshl_b32 s71, s73, 19
v_mfma_f32_16x16x32_bf16 a[164:167], v[200:203], v[232:235], a[164:167]
s_add_u32 s71, s71, s66
v_mfma_f32_16x16x32_bf16 a[164:167], v[204:207], v[236:239], a[164:167]
s_add_u32 m0, s63, 98304
v_mfma_f32_16x16x32_bf16 a[160:163], v[196:199], v[236:239], a[160:163]
s_waitcnt vmcnt(4) lgkmcnt(0)
v_mfma_f32_16x16x32_bf16 a[160:163], v[192:195], v[232:235], a[160:163]
s_barrier
v_mfma_f32_16x16x32_bf16 a[192:195], v[192:195], v[240:243], a[192:195]
s_add_u32 s72, s69, 0
buffer_load_dwordx4 v2, s[8:11], s72 offen lds
v_mfma_f32_16x16x32_bf16 a[192:195], v[196:199], v[244:247], a[192:195]
s_add_u32 s74, s63, 131072
ds_read_b64_tr_b16 v[224:225], v20 offset:0
v_lshrrev_b32 v26, 4, v0
v_mfma_f32_16x16x32_bf16 a[196:199], v[204:207], v[244:247], a[196:199]
ds_read_b64_tr_b16 v[226:227], v20 offset:1024
v_and_b32 v27, 15, v0
v_mfma_f32_16x16x32_bf16 a[196:199], v[200:203], v[240:243], a[196:199]
ds_read_b64_tr_b16 v[228:229], v20 offset:8192
v_lshlrev_b32 v27, 4, v27
v_mfma_f32_16x16x32_bf16 a[200:203], v[208:211], v[240:243], a[200:203]
s_add_u32 s72, s69, 7168
buffer_load_dwordx4 v3, s[8:11], s72 offen offset:1024 lds
v_mfma_f32_16x16x32_bf16 a[200:203], v[212:215], v[244:247], a[200:203]
ds_read_b64_tr_b16 v[230:231], v20 offset:9216
v_mul_u32_u24 v28, 272, v26
v_mfma_f32_16x16x32_bf16 a[204:207], v[220:223], v[244:247], a[204:207]
ds_read_b128 v[128:131], v24 offset:0
v_add3_u32 v28, v28, v27, s74
v_mfma_f32_16x16x32_bf16 a[204:207], v[216:219], v[240:243], a[204:207]
ds_read_b128 v[132:135], v25 offset:0
v_lshl_add_u32 v26, v26, 12, v27
v_mfma_f32_16x16x32_bf16 a[208:211], v[184:187], v[240:243], a[208:211]
s_add_u32 s72, s69, 14336
buffer_load_dwordx4 v2, s[8:11], s72 offen offset:2048 lds
v_mfma_f32_16x16x32_bf16 a[208:211], v[188:191], v[244:247], a[208:211]
ds_read_b128 v[136:139], v24 offset:2048
ds_read_b128 v[36:39], v28 offset:0
v_mfma_f32_16x16x32_bf16 a[212:215], v[180:183], v[244:247], a[212:215]
ds_read_b128 v[140:143], v25 offset:2048
ds_read_b128 v[40:43], v28 offset:1088
v_mfma_f32_16x16x32_bf16 a[212:215], v[176:179], v[240:243], a[212:215]
ds_read_b128 v[144:147], v24 offset:4096
ds_read_b128 v[44:47], v28 offset:2176
v_mfma_f32_16x16x32_bf16 a[216:219], v[168:171], v[240:243], a[216:219]
s_add_u32 s72, s69, 21504
buffer_load_dwordx4 v3, s[8:11], s72 offen offset:3072 lds
v_mfma_f32_16x16x32_bf16 a[216:219], v[172:175], v[244:247], a[216:219]
ds_read_b128 v[148:151], v25 offset:4096
ds_read_b128 v[48:51], v28 offset:3264
v_mfma_f32_16x16x32_bf16 a[220:223], v[164:167], v[244:247], a[220:223]
s_xor_b32 s74, s2, 5
ds_read_b128 v[152:155], v24 offset:6144
v_mfma_f32_16x16x32_bf16 a[220:223], v[160:163], v[240:243], a[220:223]
s_and_b32 s74, s74, 15
ds_read_b128 v[156:159], v25 offset:6144
v_mfma_f32_16x16x32_bf16 a[252:255], v[160:163], v[248:251], a[252:255]
s_add_u32 m0, s64, 32768
v_mfma_f32_16x16x32_bf16 a[252:255], v[164:167], v[252:255], a[252:255]
s_add_u32 s72, s71, 0
buffer_load_dwordx4 v6, s[16:19], s72 offen lds
v_mfma_f32_16x16x32_bf16 a[248:251], v[172:175], v[252:255], a[248:251]
s_lshl_b32 s74, s74, 2
ds_read_b128 v[160:163], v24 offset:8192
v_mfma_f32_16x16x32_bf16 a[248:251], v[168:171], v[248:251], a[248:251]
s_add_u32 s74, s74, s58
ds_read_b128 v[164:167], v25 offset:8192
v_mfma_f32_16x16x32_bf16 a[244:247], v[176:179], v[248:251], a[244:247]
s_lshl_b32 s74, s74, 16
v_mfma_f32_16x16x32_bf16 a[244:247], v[180:183], v[252:255], a[244:247]
s_add_u32 s72, s71, 31744
buffer_load_dwordx4 v6, s[16:19], s72 offen offset:1024 lds
v_mfma_f32_16x16x32_bf16 a[240:243], v[188:191], v[252:255], a[240:243]
s_lshr_b32 s75, s2, 4
ds_read_b128 v[168:171], v24 offset:10240
v_mfma_f32_16x16x32_bf16 a[240:243], v[184:187], v[248:251], a[240:243]
s_lshl_b32 s75, s75, 8
ds_read_b128 v[172:175], v25 offset:10240
v_mfma_f32_16x16x32_bf16 a[236:239], v[216:219], v[248:251], a[236:239]
s_sub_u32 s74, s74, s75
ds_read_b128 v[176:179], v24 offset:12288
v_mfma_f32_16x16x32_bf16 a[236:239], v[220:223], v[252:255], a[236:239]
s_add_u32 s72, s71, 63488
buffer_load_dwordx4 v7, s[16:19], s72 offen offset:2048 lds
v_mfma_f32_16x16x32_bf16 a[232:235], v[212:215], v[252:255], a[232:235]
s_add_u32 s74, s74, 0x3000f00
ds_read_b128 v[180:183], v25 offset:12288
v_mfma_f32_16x16x32_bf16 a[232:235], v[208:211], v[248:251], a[232:235]
s_waitcnt vmcnt(27)
ds_read_b128 v[184:187], v24 offset:14336
v_lshlrev_b32 v78, 16, v84
v_mfma_f32_16x16x32_bf16 a[228:231], v[200:203], v[248:251], a[228:231]
ds_read_b128 v[188:191], v25 offset:14336
v_lshlrev_b32 v79, 16, v108
v_mfma_f32_16x16x32_bf16 a[228:231], v[204:207], v[252:255], a[228:231]
s_add_u32 s72, s71, 95232
buffer_load_dwordx4 v7, s[16:19], s72 offen offset:3072 lds
v_mfma_f32_16x16x32_bf16 a[224:227], v[196:199], v[252:255], a[224:227]
ds_read_b64_tr_b16 v[232:233], v21 offset:0
v_mul_f32 v76, v78, v79
v_mfma_f32_16x16x32_bf16 a[224:227], v[192:195], v[248:251], a[224:227]
s_waitcnt lgkmcnt(9)
ds_read_b64_tr_b16 v[234:235], v21 offset:1024
v_lshlrev_b32 v80, 16, v116
v_mfma_f32_16x16x32_bf16 a[0:3], v[224:227], v[128:131], a[0:3]
ds_read_b64_tr_b16 v[240:241], v22 offset:0
v_mul_f32 v77, v78, v80
v_mfma_f32_16x16x32_bf16 a[0:3], v[228:231], v[132:135], a[0:3]
s_add_u32 m0, s63, 102400
ds_read_b64_tr_b16 v[236:237], v21 offset:8192
v_and_b32 v78, 0xffff0000, v84
v_mfma_f32_16x16x32_bf16 a[4:7], v[228:231], v[140:143], a[4:7]
s_add_u32 s72, s69, 32768
buffer_load_dwordx4 v2, s[8:11], s72 offen lds
v_mfma_f32_16x16x32_bf16 a[4:7], v[224:227], v[136:139], a[4:7]
v_and_b32 v79, 0xffff0000, v108
v_fmac_f32 v76, v78, v79
v_mfma_f32_16x16x32_bf16 a[8:11], v[224:227], v[144:147], a[8:11]
ds_read_b64_tr_b16 v[238:239], v21 offset:9216
v_and_b32 v80, 0xffff0000, v116
v_mfma_f32_16x16x32_bf16 a[8:11], v[228:231], v[148:151], a[8:11]
ds_read_b64_tr_b16 v[242:243], v22 offset:1024
v_fmac_f32 v77, v78, v80
v_mfma_f32_16x16x32_bf16 a[12:15], v[228:231], v[156:159], a[12:15]
s_add_u32 s72, s69, 39936
buffer_load_dwordx4 v3, s[8:11], s72 offen offset:1024 lds
v_mfma_f32_16x16x32_bf16 a[12:15], v[224:227], v[152:155], a[12:15]
s_waitcnt lgkmcnt(6)
v_lshlrev_b32 v78, 16, v85
v_lshlrev_b32 v79, 16, v109
v_mfma_f32_16x16x32_bf16 a[16:19], v[224:227], v[160:163], a[16:19]
ds_read_b64_tr_b16 v[244:245], v22 offset:8192
v_fmac_f32 v76, v78, v79
v_mfma_f32_16x16x32_bf16 a[16:19], v[228:231], v[164:167], a[16:19]
v_lshlrev_b32 v80, 16, v117
v_fmac_f32 v77, v78, v80
v_mfma_f32_16x16x32_bf16 a[20:23], v[228:231], v[172:175], a[20:23]
s_add_u32 s72, s69, 47104
buffer_load_dwordx4 v2, s[8:11], s72 offen offset:2048 lds
v_mfma_f32_16x16x32_bf16 a[20:23], v[224:227], v[168:171], a[20:23]
ds_read_b64_tr_b16 v[246:247], v22 offset:9216
v_and_b32 v78, 0xffff0000, v85
v_mfma_f32_16x16x32_bf16 a[24:27], v[224:227], v[176:179], a[24:27]
v_and_b32 v79, 0xffff0000, v109
v_fmac_f32 v76, v78, v79
v_mfma_f32_16x16x32_bf16 a[24:27], v[228:231], v[180:183], a[24:27]
v_and_b32 v80, 0xffff0000, v117
v_fmac_f32 v77, v78, v80
v_mfma_f32_16x16x32_bf16 a[28:31], v[228:231], v[188:191], a[28:31]
s_add_u32 s72, s69, 54272
buffer_load_dwordx4 v3, s[8:11], s72 offen offset:3072 lds
v_mfma_f32_16x16x32_bf16 a[28:31], v[224:227], v[184:187], a[28:31]
s_waitcnt lgkmcnt(3)
v_lshlrev_b32 v78, 16, v86
v_lshlrev_b32 v79, 16, v110
v_mfma_f32_16x16x32_bf16 a[60:63], v[232:235], v[184:187], a[60:63]
ds_read_b64_tr_b16 v[248:249], v23 offset:0
v_fmac_f32 v76, v78, v79
v_mfma_f32_16x16x32_bf16 a[60:63], v[236:239], v[188:191], a[60:63]
v_lshlrev_b32 v80, 16, v118
v_fmac_f32 v77, v78, v80
v_mfma_f32_16x16x32_bf16 a[56:59], v[236:239], v[180:183], a[56:59]
s_add_u32 m0, s64, 49152
ds_read_b64_tr_b16 v[250:251], v23 offset:1024
v_and_b32 v78, 0xffff0000, v86
v_mfma_f32_16x16x32_bf16 a[56:59], v[232:235], v[176:179], a[56:59]
s_add_u32 s72, s71, 0
buffer_load_dwordx4 v6, s[20:23], s72 offen lds
v_mfma_f32_16x16x32_bf16 a[52:55], v[232:235], v[168:171], a[52:55]
v_and_b32 v79, 0xffff0000, v110
v_fmac_f32 v76, v78, v79
v_mfma_f32_16x16x32_bf16 a[52:55], v[236:239], v[172:175], a[52:55]
v_and_b32 v80, 0xffff0000, v118
v_fmac_f32 v77, v78, v80
v_mfma_f32_16x16x32_bf16 a[48:51], v[236:239], v[164:167], a[48:51]
ds_read_b64_tr_b16 v[252:253], v23 offset:8192
v_lshlrev_b32 v78, 16, v87
v_mfma_f32_16x16x32_bf16 a[48:51], v[232:235], v[160:163], a[48:51]
s_add_u32 s72, s71, 31744
buffer_load_dwordx4 v6, s[20:23], s72 offen offset:1024 lds
v_mfma_f32_16x16x32_bf16 a[44:47], v[232:235], v[152:155], a[44:47]
v_lshlrev_b32 v79, 16, v111
v_fmac_f32 v76, v78, v79
v_mfma_f32_16x16x32_bf16 a[44:47], v[236:239], v[156:159], a[44:47]
v_lshlrev_b32 v80, 16, v119
v_fmac_f32 v77, v78, v80
v_mfma_f32_16x16x32_bf16 a[40:43], v[236:239], v[148:151], a[40:43]
ds_read_b64_tr_b16 v[254:255], v23 offset:9216
v_and_b32 v78, 0xffff0000, v87
v_mfma_f32_16x16x32_bf16 a[40:43], v[232:235], v[144:147], a[40:43]
s_add_u32 s72, s71, 63488
buffer_load_dwordx4 v7, s[20:23], s72 offen offset:2048 lds
v_mfma_f32_16x16x32_bf16 a[36:39], v[232:235], v[136:139], a[36:39]
v_and_b32 v79, 0xffff0000, v111
v_fmac_f32 v76, v78, v79
v_mfma_f32_16x16x32_bf16 a[36:39], v[236:239], v[140:143], a[36:39]
v_and_b32 v80, 0xffff0000, v119
v_fmac_f32 v77, v78, v80
v_mfma_f32_16x16x32_bf16 a[32:35], v[236:239], v[132:135], a[32:35]
s_add_u32 s72, s71, 95232
v_lshlrev_b32 v78, 16, v88
v_lshlrev_b32 v79, 16, v112
v_mfma_f32_16x16x32_bf16 a[32:35], v[232:235], v[128:131], a[32:35]
s_waitcnt lgkmcnt(4)
buffer_load_dwordx4 v7, s[20:23], s72 offen offset:3072 lds
v_mfma_f32_16x16x32_bf16 a[64:67], v[240:243], v[128:131], a[64:67]
s_waitcnt lgkmcnt(15)
ds_read_b64_tr_b16 v[224:225], v20 offset:16384
v_fmac_f32 v76, v78, v79
v_mfma_f32_16x16x32_bf16 a[64:67], v[244:247], v[132:135], a[64:67]
s_add_u32 s73, s62, 0
v_lshlrev_b32 v80, 16, v120
v_fmac_f32 v77, v78, v80
v_mfma_f32_16x16x32_bf16 a[68:71], v[244:247], v[140:143], a[68:71]
s_add_u32 s70, s73, s65
ds_read_b64_tr_b16 v[226:227], v20 offset:17408
v_and_b32 v78, 0xffff0000, v88
v_mfma_f32_16x16x32_bf16 a[68:71], v[240:243], v[136:139], a[68:71]
s_and_b32 s70, s70, 3
v_and_b32 v79, 0xffff0000, v112
v_fmac_f32 v76, v78, v79
v_mfma_f32_16x16x32_bf16 a[72:75], v[240:243], v[144:147], a[72:75]
s_and_b32 s73, s73, 12
v_and_b32 v80, 0xffff0000, v120
v_fmac_f32 v77, v78, v80
v_mfma_f32_16x16x32_bf16 a[72:75], v[244:247], v[148:151], a[72:75]
s_or_b32 s73, s73, s70
ds_read_b64_tr_b16 v[228:229], v20 offset:24576
v_lshlrev_b32 v78, 16, v89
v_mfma_f32_16x16x32_bf16 a[76:79], v[244:247], v[156:159], a[76:79]
s_lshl_b32 s73, s73, 7
v_lshlrev_b32 v79, 16, v113
v_fmac_f32 v76, v78, v79
v_mfma_f32_16x16x32_bf16 a[76:79], v[240:243], v[152:155], a[76:79]
s_add_u32 s69, s73, s67
ds_read_b64_tr_b16 v[230:231], v20 offset:25600
v_lshlrev_b32 v80, 16, v121
v_mfma_f32_16x16x32_bf16 a[80:83], v[240:243], v[160:163], a[80:83]
s_add_u32 s70, s73, s68
v_fmac_f32 v77, v78, v80
v_and_b32 v78, 0xffff0000, v89
v_mfma_f32_16x16x32_bf16 a[80:83], v[244:247], v[164:167], a[80:83]
s_add_u32 m0, s63, 131072
v_and_b32 v79, 0xffff0000, v113
v_fmac_f32 v76, v78, v79
v_mfma_f32_16x16x32_bf16 a[84:87], v[244:247], v[172:175], a[84:87]
s_add_u32 s72, s69, 0
buffer_load_dwordx4 v4, s[4:7], s72 offen lds
v_mfma_f32_16x16x32_bf16 a[84:87], v[240:243], v[168:171], a[84:87]
s_add_u32 s72, s69, 15360
buffer_load_dwordx4 v5, s[4:7], s72 offen offset:1024 lds
v_mfma_f32_16x16x32_bf16 a[88:91], v[240:243], v[176:179], a[88:91]
s_add_u32 s72, s69, 129024
buffer_load_dwordx4 v4, s[4:7], s72 offen offset:2048 lds
v_mfma_f32_16x16x32_bf16 a[88:91], v[244:247], v[180:183], a[88:91]
s_add_u32 s72, s69, 144384
buffer_load_dwordx4 v5, s[4:7], s72 offen offset:3072 lds
v_mfma_f32_16x16x32_bf16 a[92:95], v[244:247], v[188:191], a[92:95]
v_and_b32 v80, 0xffff0000, v121
v_fmac_f32 v77, v78, v80
v_mfma_f32_16x16x32_bf16 a[92:95], v[240:243], v[184:187], a[92:95]
s_waitcnt lgkmcnt(4)
v_lshlrev_b32 v78, 16, v90
v_lshlrev_b32 v79, 16, v114
v_mfma_f32_16x16x32_bf16 a[124:127], v[248:251], v[184:187], a[124:127]
ds_read_b64_tr_b16 v[232:233], v21 offset:16384
v_fmac_f32 v76, v78, v79
v_mfma_f32_16x16x32_bf16 a[124:127], v[252:255], v[188:191], a[124:127]
v_lshlrev_b32 v80, 16, v122
v_fmac_f32 v77, v78, v80
v_mfma_f32_16x16x32_bf16 a[120:123], v[252:255], v[180:183], a[120:123]
s_add_u32 m0, s63, 135168
ds_read_b64_tr_b16 v[234:235], v21 offset:17408
v_and_b32 v78, 0xffff0000, v90
v_mfma_f32_16x16x32_bf16 a[120:123], v[248:251], v[176:179], a[120:123]
s_add_u32 s72, s70, 0
buffer_load_dwordx4 v4, s[4:7], s72 offen lds
v_mfma_f32_16x16x32_bf16 a[116:119], v[248:251], v[168:171], a[116:119]
s_lshr_b32 s75, s93, 5
v_and_b32 v79, 0xffff0000, v114
v_fmac_f32 v76, v78, v79
v_mfma_f32_16x16x32_bf16 a[116:119], v[252:255], v[172:175], a[116:119]
s_and_b32 s75, s75, 0x3f80
ds_read_b64_tr_b16 v[236:237], v21 offset:24576
v_and_b32 v80, 0xffff0000, v122
v_mfma_f32_16x16x32_bf16 a[112:115], v[252:255], v[164:167], a[112:115]
s_add_u32 s75, s75, LcB0-Lpc0
v_lshrrev_b32 v2, 6, v0
v_lshlrev_b32 v2, 7, v2
v_mfma_f32_16x16x32_bf16 a[112:115], v[248:251], v[160:163], a[112:115]
s_add_u32 s72, s70, 15360
buffer_load_dwordx4 v5, s[4:7], s72 offen offset:1024 lds
v_mfma_f32_16x16x32_bf16 a[108:111], v[248:251], v[152:155], a[108:111]
v_add_u32 v2, s75, v2
v_min_u32 v2, Lcode_end-Lpc0, v2
v_mfma_f32_16x16x32_bf16 a[108:111], v[252:255], v[156:159], a[108:111]
global_load_dword v3, v2, s[98:99]
v_mfma_f32_16x16x32_bf16 a[104:107], v[252:255], v[148:151], a[104:107]
v_fmac_f32 v77, v78, v80
v_lshlrev_b32 v78, 16, v91
v_mfma_f32_16x16x32_bf16 a[104:107], v[248:251], v[144:147], a[104:107]
s_add_u32 s72, s70, 129024
buffer_load_dwordx4 v4, s[4:7], s72 offen offset:2048 lds
v_mfma_f32_16x16x32_bf16 a[100:103], v[248:251], v[136:139], a[100:103]
ds_read_b64_tr_b16 v[238:239], v21 offset:25600
v_lshlrev_b32 v79, 16, v115
v_mfma_f32_16x16x32_bf16 a[100:103], v[252:255], v[140:143], a[100:103]
v_fmac_f32 v76, v78, v79
v_lshlrev_b32 v80, 16, v123
v_mfma_f32_16x16x32_bf16 a[96:99], v[252:255], v[132:135], a[96:99]
v_fmac_f32 v77, v78, v80
v_and_b32 v78, 0xffff0000, v91
v_mfma_f32_16x16x32_bf16 a[96:99], v[248:251], v[128:131], a[96:99]
s_waitcnt lgkmcnt(4)
v_and_b32 v79, 0xffff0000, v115
v_fmac_f32 v76, v78, v79
v_mfma_f32_16x16x32_bf16 a[128:131], v[128:131], v[224:227], a[128:131]
s_add_u32 s72, s70, 144384
buffer_load_dwordx4 v5, s[4:7], s72 offen offset:3072 lds
v_mfma_f32_16x16x32_bf16 a[128:131], v[132:135], v[228:231], a[128:131]
ds_read_b64_tr_b16 v[240:241], v22 offset:16384
v_and_b32 v80, 0xffff0000, v123
v_mfma_f32_16x16x32_bf16 a[132:135], v[140:143], v[228:231], a[132:135]
v_fmac_f32 v77, v78, v80
v_add_f32_dpp v76, v76, v76 row_ror:8 row_mask:0xf bank_mask:0xf
v_mfma_f32_16x16x32_bf16 a[132:135], v[136:139], v[224:227], a[132:135]
v_add_f32_dpp v77, v77, v77 row_ror:8 row_mask:0xf bank_mask:0xf
v_add_f32_dpp v76, v76, v76 row_ror:4 row_mask:0xf bank_mask:0xf
v_mfma_f32_16x16x32_bf16 a[136:139], v[144:147], v[224:227], a[136:139]
ds_read_b64_tr_b16 v[242:243], v22 offset:17408
v_add_f32_dpp v77, v77, v77 row_ror:4 row_mask:0xf bank_mask:0xf
v_mfma_f32_16x16x32_bf16 a[136:139], v[148:151], v[228:231], a[136:139]
v_add_f32_dpp v76, v76, v76 row_ror:2 row_mask:0xf bank_mask:0xf
v_add_f32_dpp v77, v77, v77 row_ror:2 row_mask:0xf bank_mask:0xf
v_mfma_f32_16x16x32_bf16 a[140:143], v[156:159], v[228:231], a[140:143]
v_add_f32_dpp v76, v76, v76 row_ror:1 row_mask:0xf bank_mask:0xf
v_add_f32_dpp v77, v77, v77 row_ror:1 row_mask:0xf bank_mask:0xf
v_mfma_f32_16x16x32_bf16 a[140:143], v[152:155], v[224:227], a[140:143]
ds_read_b64_tr_b16 v[244:245], v22 offset:24576
v_mov_b32 v78, v76
v_mfma_f32_16x16x32_bf16 a[144:147], v[160:163], v[224:227], a[144:147]
v_mov_b32 v79, v77
v_permlane16_swap_b32 v76, v78
v_mfma_f32_16x16x32_bf16 a[144:147], v[164:167], v[228:231], a[144:147]
v_permlane16_swap_b32 v77, v79
v_add_f32 v76, v76, v78
v_mfma_f32_16x16x32_bf16 a[148:151], v[172:175], v[228:231], a[148:151]
ds_read_b64_tr_b16 v[246:247], v22 offset:25600
v_add_f32 v77, v77, v79
v_mfma_f32_16x16x32_bf16 a[148:151], v[168:171], v[224:227], a[148:151]
v_mov_b32 v78, v76
v_mov_b32 v79, v77
v_mfma_f32_16x16x32_bf16 a[152:155], v[176:179], v[224:227], a[152:155]
v_permlane32_swap_b32 v76, v78
v_permlane32_swap_b32 v77, v79
v_mfma_f32_16x16x32_bf16 a[152:155], v[180:183], v[228:231], a[152:155]
v_add_f32 v76, v76, v78
v_add_f32 v77, v77, v79
v_mfma_f32_16x16x32_bf16 a[156:159], v[188:191], v[228:231], a[156:159]
v_mul_f32 v76, 0xbfb8aa3b, v76
v_mul_f32 v77, 0xbfb8aa3b, v77
v_mfma_f32_16x16x32_bf16 a[156:159], v[184:187], v[224:227], a[156:159]
s_waitcnt lgkmcnt(4)
v_exp_f32 v76, v76
v_mfma_f32_16x16x32_bf16 a[188:191], v[184:187], v[232:235], a[188:191]
ds_read_b64_tr_b16 v[248:249], v23 offset:16384
v_mfma_f32_16x16x32_bf16 a[188:191], v[188:191], v[236:239], a[188:191]
v_exp_f32 v77, v77
v_mfma_f32_16x16x32_bf16 a[184:187], v[180:183], v[236:239], a[184:187]
ds_read_b64_tr_b16 v[250:251], v23 offset:17408
v_add_f32 v76, 1.0, v76
v_mfma_f32_16x16x32_bf16 a[184:187], v[176:179], v[232:235], a[184:187]
v_add_f32 v77, 1.0, v77
v_mfma_f32_16x16x32_bf16 a[180:183], v[168:171], v[232:235], a[180:183]
ds_read_b64_tr_b16 v[252:253], v23 offset:24576
v_mfma_f32_16x16x32_bf16 a[180:183], v[172:175], v[236:239], a[180:183]
v_rcp_f32 v76, v76
v_mfma_f32_16x16x32_bf16 a[176:179], v[164:167], v[236:239], a[176:179]
ds_read_b64_tr_b16 v[254:255], v23 offset:25600
v_mfma_f32_16x16x32_bf16 a[176:179], v[160:163], v[232:235], a[176:179]
v_rcp_f32 v77, v77
v_mfma_f32_16x16x32_bf16 a[172:175], v[152:155], v[232:235], a[172:175]
s_lshr_b32 s80, s76, 9
v_mfma_f32_16x16x32_bf16 a[172:175], v[156:159], v[236:239], a[172:175]
s_add_u32 s80, s80, 0x3800000
v_min_u32 v78, 1, v0
v_lshlrev_b32 v78, 30, v78
v_mfma_f32_16x16x32_bf16 a[168:171], v[148:151], v[236:239], a[168:171]
buffer_store_dwordx2 v[76:77], v78, s[44:47], s80 offen sc1
v_mfma_f32_16x16x32_bf16 a[168:171], v[144:147], v[232:235], a[168:171]
v_mfma_f32_16x16x32_bf16 a[164:167], v[136:139], v[232:235], a[164:167]
v_mfma_f32_16x16x32_bf16 a[164:167], v[140:143], v[236:239], a[164:167]
v_mfma_f32_16x16x32_bf16 a[160:163], v[132:135], v[236:239], a[160:163]
s_waitcnt vmcnt(10) lgkmcnt(0)
v_mfma_f32_16x16x32_bf16 a[160:163], v[128:131], v[232:235], a[160:163]
s_barrier
v_mfma_f32_16x16x32_bf16 a[192:195], v[128:131], v[240:243], a[192:195]
s_lshl_b32 s71, s73, 12
ds_read_b64_tr_b16 v[224:225], v20 offset:32768
v_mfma_f32_16x16x32_bf16 a[192:195], v[132:135], v[244:247], a[192:195]
s_add_u32 s71, s71, s66
ds_read_b64_tr_b16 v[226:227], v20 offset:33792
v_mfma_f32_16x16x32_bf16 a[196:199], v[140:143], v[244:247], a[196:199]
s_add_u32 m0, s64, 0
v_mov_b32 v100, v20
v_mov_b32 v101, v21
v_mfma_f32_16x16x32_bf16 a[196:199], v[136:139], v[240:243], a[196:199]
s_add_u32 s72, s71, 0
buffer_load_dwordx4 v6, s[12:15], s72 offen lds
v_mfma_f32_16x16x32_bf16 a[200:203], v[144:147], v[240:243], a[200:203]
v_mov_b32 v102, v22
v_mov_b32 v103, v23
v_mfma_f32_16x16x32_bf16 a[200:203], v[148:151], v[244:247], a[200:203]
ds_read_b64_tr_b16 v[228:229], v20 offset:40960
v_mfma_f32_16x16x32_bf16 a[204:207], v[156:159], v[244:247], a[204:207]
s_add_u32 s72, s71, 31744
buffer_load_dwordx4 v6, s[12:15], s72 offen offset:1024 lds
v_mfma_f32_16x16x32_bf16 a[204:207], v[152:155], v[240:243], a[204:207]
ds_read_b64_tr_b16 v[230:231], v20 offset:41984
v_mfma_f32_16x16x32_bf16 a[208:211], v[160:163], v[240:243], a[208:211]
s_waitcnt lgkmcnt(15)
buffer_store_dwordx4 v[36:39], v26, s[44:47], s74 offen sc1
v_mfma_f32_16x16x32_bf16 a[208:211], v[164:167], v[244:247], a[208:211]
ds_read_b128 v[192:195], v24 offset:32768
v_mfma_f32_16x16x32_bf16 a[212:215], v[172:175], v[244:247], a[212:215]
ds_read_b128 v[196:199], v25 offset:32768
v_mfma_f32_16x16x32_bf16 a[212:215], v[168:171], v[240:243], a[212:215]
ds_read_b128 v[200:203], v24 offset:34816
v_mfma_f32_16x16x32_bf16 a[216:219], v[176:179], v[240:243], a[216:219]
s_add_u32 s72, s71, 63488
buffer_load_dwordx4 v7, s[12:15], s72 offen offset:2048 lds
v_mfma_f32_16x16x32_bf16 a[216:219], v[180:183], v[244:247], a[216:219]
ds_read_b128 v[204:207], v25 offset:34816
v_mfma_f32_16x16x32_bf16 a[220:223], v[188:191], v[244:247], a[220:223]
ds_read_b128 v[208:211], v24 offset:36864
v_mfma_f32_16x16x32_bf16 a[220:223], v[184:187], v[240:243], a[220:223]
ds_read_b128 v[212:215], v25 offset:36864
v_mfma_f32_16x16x32_bf16 a[252:255], v[184:187], v[248:251], a[252:255]
ds_read_b128 v[216:219], v24 offset:38912
v_mfma_f32_16x16x32_bf16 a[252:255], v[188:191], v[252:255], a[252:255]
ds_read_b128 v[220:223], v25 offset:38912
v_mfma_f32_16x16x32_bf16 a[248:251], v[180:183], v[252:255], a[248:251]
s_add_u32 s72, s71, 95232
buffer_load_dwordx4 v7, s[12:15], s72 offen offset:3072 lds
v_mfma_f32_16x16x32_bf16 a[248:251], v[176:179], v[248:251], a[248:251]
ds_read_b128 v[184:187], v24 offset:40960
v_mfma_f32_16x16x32_bf16 a[244:247], v[168:171], v[248:251], a[244:247]
ds_read_b128 v[188:191], v25 offset:40960
v_mfma_f32_16x16x32_bf16 a[244:247], v[172:175], v[252:255], a[244:247]
ds_read_b128 v[176:179], v24 offset:43008
v_mfma_f32_16x16x32_bf16 a[240:243], v[164:167], v[252:255], a[240:243]
ds_read_b128 v[180:183], v25 offset:43008
v_mfma_f32_16x16x32_bf16 a[240:243], v[160:163], v[248:251], a[240:243]
v_mfma_f32_16x16x32_bf16 a[236:239], v[152:155], v[248:251], a[236:239]
s_add_u32 s74, s74, 0x4000
buffer_store_dwordx4 v[40:43], v26, s[44:47], s74 offen sc1
v_mfma_f32_16x16x32_bf16 a[236:239], v[156:159], v[252:255], a[236:239]
s_add_u32 s73, s62, 1
ds_read_b128 v[168:171], v24 offset:45056
v_mfma_f32_16x16x32_bf16 a[232:235], v[148:151], v[252:255], a[232:235]
s_add_u32 s70, s73, s65
ds_read_b128 v[172:175], v25 offset:45056
v_mfma_f32_16x16x32_bf16 a[232:235], v[144:147], v[248:251], a[232:235]
s_and_b32 s70, s70, 3
ds_read_b128 v[160:163], v24 offset:47104
v_mfma_f32_16x16x32_bf16 a[228:231], v[136:139], v[248:251], a[228:231]
s_and_b32 s73, s73, 12
ds_read_b128 v[164:167], v25 offset:47104
v_mfma_f32_16x16x32_bf16 a[228:231], v[140:143], v[252:255], a[228:231]
s_or_b32 s73, s73, s70
v_mfma_f32_16x16x32_bf16 a[224:227], v[132:135], v[252:255], a[224:227]
s_lshl_b32 s73, s73, 7
ds_read_b64_tr_b16 v[232:233], v101 offset:32768
v_mfma_f32_16x16x32_bf16 a[224:227], v[128:131], v[248:251], a[224:227]
s_waitcnt lgkmcnt(9)
ds_read_b64_tr_b16 v[234:235], v101 offset:33792
v_mfma_f32_16x16x32_bf16 a[0:3], v[224:227], v[192:195], a[0:3]
s_add_u32 s69, s73, s67
ds_read_b64_tr_b16 v[236:237], v101 offset:40960
v_mfma_f32_16x16x32_bf16 a[0:3], v[228:231], v[196:199], a[0:3]
s_add_u32 s70, s73, s68
ds_read_b64_tr_b16 v[238:239], v101 offset:41984
v_mfma_f32_16x16x32_bf16 a[4:7], v[228:231], v[204:207], a[4:7]
s_add_u32 m0, s63, 65536
ds_read_b64_tr_b16 v[240:241], v102 offset:32768
v_mfma_f32_16x16x32_bf16 a[4:7], v[224:227], v[200:203], a[4:7]
s_add_u32 s72, s69, 0
buffer_load_dwordx4 v4, s[4:7], s72 offen lds
v_mfma_f32_16x16x32_bf16 a[8:11], v[224:227], v[208:211], a[8:11]
s_add_u32 s72, s69, 15360
buffer_load_dwordx4 v5, s[4:7], s72 offen offset:1024 lds
v_mfma_f32_16x16x32_bf16 a[8:11], v[228:231], v[212:215], a[8:11]
s_add_u32 s72, s69, 129024
buffer_load_dwordx4 v4, s[4:7], s72 offen offset:2048 lds
v_mfma_f32_16x16x32_bf16 a[12:15], v[228:231], v[220:223], a[12:15]
ds_read_b64_tr_b16 v[242:243], v102 offset:33792
v_mfma_f32_16x16x32_bf16 a[12:15], v[224:227], v[216:219], a[12:15]
s_waitcnt lgkmcnt(6)
v_mfma_f32_16x16x32_bf16 a[16:19], v[224:227], v[184:187], a[16:19]
s_add_u32 s74, s74, 0x4000
buffer_store_dwordx4 v[44:47], v26, s[44:47], s74 offen sc1
v_mfma_f32_16x16x32_bf16 a[16:19], v[228:231], v[188:191], a[16:19]
ds_read_b64_tr_b16 v[244:245], v102 offset:40960
v_mfma_f32_16x16x32_bf16 a[20:23], v[228:231], v[180:183], a[20:23]
v_mfma_f32_16x16x32_bf16 a[20:23], v[224:227], v[176:179], a[20:23]
ds_read_b64_tr_b16 v[246:247], v102 offset:41984
v_mfma_f32_16x16x32_bf16 a[24:27], v[224:227], v[168:171], a[24:27]
s_add_u32 s72, s69, 144384
buffer_load_dwordx4 v5, s[4:7], s72 offen offset:3072 lds
v_mfma_f32_16x16x32_bf16 a[24:27], v[228:231], v[172:175], a[24:27]
v_mfma_f32_16x16x32_bf16 a[28:31], v[228:231], v[164:167], a[28:31]
v_mfma_f32_16x16x32_bf16 a[28:31], v[224:227], v[160:163], a[28:31]
s_waitcnt lgkmcnt(4)
v_mfma_f32_16x16x32_bf16 a[60:63], v[232:235], v[160:163], a[60:63]
ds_read_b64_tr_b16 v[248:249], v103 offset:32768
v_mfma_f32_16x16x32_bf16 a[60:63], v[236:239], v[164:167], a[60:63]
v_mfma_f32_16x16x32_bf16 a[56:59], v[236:239], v[172:175], a[56:59]
s_add_u32 m0, s63, 69632
ds_read_b64_tr_b16 v[250:251], v103 offset:33792
v_mfma_f32_16x16x32_bf16 a[56:59], v[232:235], v[168:171], a[56:59]
s_add_u32 s72, s70, 0
buffer_load_dwordx4 v4, s[4:7], s72 offen lds
v_mfma_f32_16x16x32_bf16 a[52:55], v[232:235], v[176:179], a[52:55]
v_mfma_f32_16x16x32_bf16 a[52:55], v[236:239], v[180:183], a[52:55]
v_mfma_f32_16x16x32_bf16 a[48:51], v[236:239], v[188:191], a[48:51]
ds_read_b64_tr_b16 v[252:253], v103 offset:40960
v_mfma_f32_16x16x32_bf16 a[48:51], v[232:235], v[184:187], a[48:51]
v_mfma_f32_16x16x32_bf16 a[44:47], v[232:235], v[216:219], a[44:47]
s_add_u32 s72, s70, 15360
buffer_load_dwordx4 v5, s[4:7], s72 offen offset:1024 lds
v_mfma_f32_16x16x32_bf16 a[44:47], v[236:239], v[220:223], a[44:47]
s_add_u32 s74, s74, 0x4000
buffer_store_dwordx4 v[48:51], v26, s[44:47], s74 offen sc1
v_mfma_f32_16x16x32_bf16 a[40:43], v[236:239], v[212:215], a[40:43]
v_mfma_f32_16x16x32_bf16 a[40:43], v[232:235], v[208:211], a[40:43]
ds_read_b64_tr_b16 v[254:255], v103 offset:41984
v_mfma_f32_16x16x32_bf16 a[36:39], v[232:235], v[200:203], a[36:39]
v_mfma_f32_16x16x32_bf16 a[36:39], v[236:239], v[204:207], a[36:39]
v_mfma_f32_16x16x32_bf16 a[32:35], v[236:239], v[196:199], a[32:35]
v_mfma_f32_16x16x32_bf16 a[32:35], v[232:235], v[192:195], a[32:35]
s_waitcnt lgkmcnt(4)
v_mfma_f32_16x16x32_bf16 a[64:67], v[240:243], v[192:195], a[64:67]
s_add_u32 s72, s70, 129024
buffer_load_dwordx4 v4, s[4:7], s72 offen offset:2048 lds
v_mfma_f32_16x16x32_bf16 a[64:67], v[244:247], v[196:199], a[64:67]
ds_read_b64_tr_b16 v[224:225], v100 offset:49152
v_mfma_f32_16x16x32_bf16 a[68:71], v[244:247], v[204:207], a[68:71]
v_mfma_f32_16x16x32_bf16 a[68:71], v[240:243], v[200:203], a[68:71]
v_mfma_f32_16x16x32_bf16 a[72:75], v[240:243], v[208:211], a[72:75]
ds_read_b64_tr_b16 v[226:227], v100 offset:50176
v_mfma_f32_16x16x32_bf16 a[72:75], v[244:247], v[212:215], a[72:75]
s_add_u32 s72, s70, 144384
buffer_load_dwordx4 v5, s[4:7], s72 offen offset:3072 lds
v_mfma_f32_16x16x32_bf16 a[76:79], v[244:247], v[220:223], a[76:79]
v_mfma_f32_16x16x32_bf16 a[76:79], v[240:243], v[216:219], a[76:79]
v_mfma_f32_16x16x32_bf16 a[80:83], v[240:243], v[184:187], a[80:83]
ds_read_b64_tr_b16 v[228:229], v100 offset:57344
v_mfma_f32_16x16x32_bf16 a[80:83], v[244:247], v[188:191], a[80:83]
v_mfma_f32_16x16x32_bf16 a[84:87], v[244:247], v[180:183], a[84:87]
v_accvgpr_read_b32 v20, a0
v_accvgpr_read_b32 v28, a1
v_mfma_f32_16x16x32_bf16 a[84:87], v[240:243], v[176:179], a[84:87]
s_lshl_b32 s71, s73, 12
ds_read_b64_tr_b16 v[230:231], v100 offset:58368
v_accvgpr_read_b32 v21, a2
v_mfma_f32_16x16x32_bf16 a[88:91], v[240:243], v[168:171], a[88:91]
s_add_u32 s71, s71, s66
v_accvgpr_read_b32 v29, a3
v_accvgpr_read_b32 v22, a32
v_mfma_f32_16x16x32_bf16 a[88:91], v[244:247], v[172:175], a[88:91]
s_add_u32 m0, s64, 16384
v_accvgpr_read_b32 v30, a33
v_accvgpr_read_b32 v23, a34
v_mfma_f32_16x16x32_bf16 a[92:95], v[244:247], v[164:167], a[92:95]
s_add_u32 s72, s71, 0
buffer_load_dwordx4 v6, s[12:15], s72 offen lds
v_mfma_f32_16x16x32_bf16 a[92:95], v[240:243], v[160:163], a[92:95]
s_waitcnt lgkmcnt(4)
v_accvgpr_read_b32 v31, a35
v_mul_f32 v20, s79, v20
v_mfma_f32_16x16x32_bf16 a[124:127], v[248:251], v[160:163], a[124:127]
ds_read_b64_tr_b16 v[232:233], v101 offset:49152
v_mul_f32 v28, s79, v28
v_mfma_f32_16x16x32_bf16 a[124:127], v[252:255], v[164:167], a[124:127]
v_mul_f32 v21, s79, v21
v_mul_f32 v29, s79, v29
v_mfma_f32_16x16x32_bf16 a[120:123], v[252:255], v[172:175], a[120:123]
s_add_u32 s72, s71, 31744
buffer_load_dwordx4 v6, s[12:15], s72 offen offset:1024 lds
v_mfma_f32_16x16x32_bf16 a[120:123], v[248:251], v[168:171], a[120:123]
v_mul_f32 v22, s79, v22
v_mul_f32 v30, s79, v30
v_mfma_f32_16x16x32_bf16 a[116:119], v[248:251], v[176:179], a[116:119]
ds_read_b64_tr_b16 v[234:235], v101 offset:50176
v_mul_f32 v23, s79, v23
v_mfma_f32_16x16x32_bf16 a[116:119], v[252:255], v[180:183], a[116:119]
v_mul_f32 v31, s79, v31
v_cvt_pk_bf16_f32 v20, v20, v28
v_mfma_f32_16x16x32_bf16 a[112:115], v[252:255], v[188:191], a[112:115]
v_cvt_pk_bf16_f32 v21, v21, v29
v_cvt_pk_bf16_f32 v22, v22, v30
v_mfma_f32_16x16x32_bf16 a[112:115], v[248:251], v[184:187], a[112:115]
ds_read_b64_tr_b16 v[236:237], v101 offset:57344
v_cvt_pk_bf16_f32 v23, v23, v31
v_mfma_f32_16x16x32_bf16 a[108:111], v[248:251], v[216:219], a[108:111]
s_add_u32 s72, s71, 63488
buffer_load_dwordx4 v7, s[12:15], s72 offen offset:2048 lds
v_mfma_f32_16x16x32_bf16 a[108:111], v[252:255], v[220:223], a[108:111]
s_add_u32 s80, s77, 0
buffer_store_dwordx4 v[20:23], v1, s[44:47], s80 offen sc1
v_mfma_f32_16x16x32_bf16 a[104:107], v[252:255], v[212:215], a[104:107]
v_mfma_f32_16x16x32_bf16 a[104:107], v[248:251], v[208:211], a[104:107]
ds_read_b64_tr_b16 v[238:239], v101 offset:58368
v_mfma_f32_16x16x32_bf16 a[100:103], v[248:251], v[200:203], a[100:103]
v_mfma_f32_16x16x32_bf16 a[100:103], v[252:255], v[204:207], a[100:103]
v_mfma_f32_16x16x32_bf16 a[96:99], v[252:255], v[196:199], a[96:99]
s_add_u32 s72, s71, 95232
buffer_load_dwordx4 v7, s[12:15], s72 offen offset:3072 lds
v_mfma_f32_16x16x32_bf16 a[96:99], v[248:251], v[192:195], a[96:99]
s_waitcnt lgkmcnt(4)
LcB0:
v_mfma_f32_16x16x32_bf16 a[128:131], v[192:195], v[224:227], a[128:131]
ds_read_b64_tr_b16 v[240:241], v102 offset:49152
v_accvgpr_read_b32 v24, a4
v_mfma_f32_16x16x32_bf16 a[128:131], v[196:199], v[228:231], a[128:131]
v_accvgpr_read_b32 v28, a5
v_accvgpr_read_b32 v25, a6
v_mfma_f32_16x16x32_bf16 a[132:135], v[204:207], v[228:231], a[132:135]
v_accvgpr_read_b32 v29, a7
v_accvgpr_read_b32 v26, a36
v_mfma_f32_16x16x32_bf16 a[132:135], v[200:203], v[224:227], a[132:135]
ds_read_b64_tr_b16 v[242:243], v102 offset:50176
v_accvgpr_read_b32 v30, a37
v_mfma_f32_16x16x32_bf16 a[136:139], v[208:211], v[224:227], a[136:139]
v_accvgpr_read_b32 v27, a38
v_accvgpr_read_b32 v31, a39
v_mfma_f32_16x16x32_bf16 a[136:139], v[212:215], v[228:231], a[136:139]
v_mul_f32 v24, s79, v24
v_mul_f32 v28, s79, v28
v_mfma_f32_16x16x32_bf16 a[140:143], v[220:223], v[228:231], a[140:143]
v_mul_f32 v25, s79, v25
v_mul_f32 v29, s79, v29
v_mfma_f32_16x16x32_bf16 a[140:143], v[216:219], v[224:227], a[140:143]
ds_read_b64_tr_b16 v[244:245], v102 offset:57344
v_mul_f32 v26, s79, v26
v_mfma_f32_16x16x32_bf16 a[144:147], v[184:187], v[224:227], a[144:147]
v_mul_f32 v30, s79, v30
v_mul_f32 v27, s79, v27
v_mfma_f32_16x16x32_bf16 a[144:147], v[188:191], v[228:231], a[144:147]
v_mul_f32 v31, s79, v31
v_cvt_pk_bf16_f32 v24, v24, v28
v_mfma_f32_16x16x32_bf16 a[148:151], v[180:183], v[228:231], a[148:151]
ds_read_b64_tr_b16 v[246:247], v102 offset:58368
v_cvt_pk_bf16_f32 v25, v25, v29
v_mfma_f32_16x16x32_bf16 a[148:151], v[176:179], v[224:227], a[148:151]
v_cvt_pk_bf16_f32 v26, v26, v30
v_cvt_pk_bf16_f32 v27, v27, v31
v_mfma_f32_16x16x32_bf16 a[152:155], v[168:171], v[224:227], a[152:155]
s_add_u32 s80, s77, 4096
buffer_store_dwordx4 v[24:27], v1, s[44:47], s80 offen sc1
v_mfma_f32_16x16x32_bf16 a[152:155], v[172:175], v[228:231], a[152:155]
v_mfma_f32_16x16x32_bf16 a[156:159], v[164:167], v[228:231], a[156:159]
v_mfma_f32_16x16x32_bf16 a[156:159], v[160:163], v[224:227], a[156:159]
s_waitcnt lgkmcnt(4)
v_mfma_f32_16x16x32_bf16 a[188:191], v[160:163], v[232:235], a[188:191]
ds_read_b64_tr_b16 v[248:249], v103 offset:49152
v_mfma_f32_16x16x32_bf16 a[188:191], v[164:167], v[236:239], a[188:191]
v_mfma_f32_16x16x32_bf16 a[184:187], v[172:175], v[236:239], a[184:187]
ds_read_b64_tr_b16 v[250:251], v103 offset:50176
v_mfma_f32_16x16x32_bf16 a[184:187], v[168:171], v[232:235], a[184:187]
v_mfma_f32_16x16x32_bf16 a[180:183], v[176:179], v[232:235], a[180:183]
ds_read_b64_tr_b16 v[252:253], v103 offset:57344
v_mfma_f32_16x16x32_bf16 a[180:183], v[180:183], v[236:239], a[180:183]
s_add_u32 s73, s62, 2
v_mfma_f32_16x16x32_bf16 a[176:179], v[188:191], v[236:239], a[176:179]
s_add_u32 s70, s73, s65
ds_read_b64_tr_b16 v[254:255], v103 offset:58368
v_accvgpr_read_b32 v20, a8
v_mfma_f32_16x16x32_bf16 a[176:179], v[184:187], v[232:235], a[176:179]
s_and_b32 s70, s70, 3
v_accvgpr_read_b32 v28, a9
v_accvgpr_read_b32 v21, a10
v_mfma_f32_16x16x32_bf16 a[172:175], v[216:219], v[232:235], a[172:175]
s_and_b32 s73, s73, 12
v_accvgpr_read_b32 v29, a11
v_accvgpr_read_b32 v22, a40
v_mfma_f32_16x16x32_bf16 a[172:175], v[220:223], v[236:239], a[172:175]
s_or_b32 s73, s73, s70
v_accvgpr_read_b32 v30, a41
v_accvgpr_read_b32 v23, a42
v_mfma_f32_16x16x32_bf16 a[168:171], v[212:215], v[236:239], a[168:171]
s_lshl_b32 s73, s73, 7
v_accvgpr_read_b32 v31, a43
v_mul_f32 v20, s79, v20
v_mfma_f32_16x16x32_bf16 a[168:171], v[208:211], v[232:235], a[168:171]
s_add_u32 s69, s73, s67
v_mul_f32 v28, s79, v28
v_mul_f32 v21, s79, v21
v_mfma_f32_16x16x32_bf16 a[164:167], v[200:203], v[232:235], a[164:167]
s_add_u32 s70, s73, s68
v_mul_f32 v29, s79, v29
v_mul_f32 v22, s79, v22
v_mfma_f32_16x16x32_bf16 a[164:167], v[204:207], v[236:239], a[164:167]
s_add_u32 m0, s63, 98304
v_mul_f32 v30, s79, v30
v_mul_f32 v23, s79, v23
v_mfma_f32_16x16x32_bf16 a[160:163], v[196:199], v[236:239], a[160:163]
s_waitcnt vmcnt(8) lgkmcnt(0)
v_mul_f32 v31, s79, v31
v_cvt_pk_bf16_f32 v20, v20, v28
v_mfma_f32_16x16x32_bf16 a[160:163], v[192:195], v[232:235], a[160:163]
s_barrier
v_cvt_pk_bf16_f32 v21, v21, v29
v_cvt_pk_bf16_f32 v22, v22, v30
v_mfma_f32_16x16x32_bf16 a[192:195], v[192:195], v[240:243], a[192:195]
s_add_u32 s72, s69, 0
buffer_load_dwordx4 v4, s[4:7], s72 offen lds
v_mfma_f32_16x16x32_bf16 a[192:195], v[196:199], v[244:247], a[192:195]
s_lshl_b32 s74, s59, 2
ds_read_b64_tr_b16 v[64:65], v8 offset:0
v_or_b32 v106, s58, v0
v_mfma_f32_16x16x32_bf16 a[196:199], v[204:207], v[244:247], a[196:199]
ds_read_b64_tr_b16 v[66:67], v8 offset:1024
v_mov_b32 v107, 1
v_mfma_f32_16x16x32_bf16 a[196:199], v[200:203], v[240:243], a[196:199]
ds_read_b64_tr_b16 v[68:69], v8 offset:8192
v_lshlrev_b32 v106, 8, v106
v_mfma_f32_16x16x32_bf16 a[200:203], v[208:211], v[240:243], a[200:203]
ds_read_b64_tr_b16 v[70:71], v8 offset:9216
v_cvt_pk_bf16_f32 v23, v23, v31
v_mfma_f32_16x16x32_bf16 a[200:203], v[212:215], v[244:247], a[200:203]
s_add_u32 s72, s69, 15360
buffer_load_dwordx4 v5, s[4:7], s72 offen offset:1024 lds
v_mfma_f32_16x16x32_bf16 a[204:207], v[220:223], v[244:247], a[204:207]
s_add_u32 s80, s77, 8192
ds_read_b128 v[32:35], v16 offset:0
v_mfma_f32_16x16x32_bf16 a[204:207], v[216:219], v[240:243], a[204:207]
buffer_atomic_add v107, v106, s[48:51], s74 offen sc1
v_mfma_f32_16x16x32_bf16 a[208:211], v[184:187], v[240:243], a[208:211]
ds_read_b128 v[36:39], v17 offset:0
v_mfma_f32_16x16x32_bf16 a[208:211], v[188:191], v[244:247], a[208:211]
ds_read_b128 v[40:43], v16 offset:2048
v_mfma_f32_16x16x32_bf16 a[212:215], v[180:183], v[244:247], a[212:215]
s_add_u32 s72, s69, 129024
buffer_load_dwordx4 v4, s[4:7], s72 offen offset:2048 lds
v_mfma_f32_16x16x32_bf16 a[212:215], v[176:179], v[240:243], a[212:215]
ds_read_b128 v[44:47], v17 offset:2048
v_mfma_f32_16x16x32_bf16 a[216:219], v[168:171], v[240:243], a[216:219]
ds_read_b128 v[48:51], v16 offset:4096
v_accvgpr_read_b32 v24, a128
v_mfma_f32_16x16x32_bf16 a[216:219], v[172:175], v[244:247], a[216:219]
ds_read_b128 v[52:55], v17 offset:4096
v_accvgpr_read_b32 v28, a129
v_mfma_f32_16x16x32_bf16 a[220:223], v[164:167], v[244:247], a[220:223]
buffer_store_dwordx4 v[20:23], v1, s[44:47], s80 offen sc1
v_mfma_f32_16x16x32_bf16 a[220:223], v[160:163], v[240:243], a[220:223]
s_add_u32 s72, s69, 144384
buffer_load_dwordx4 v5, s[4:7], s72 offen offset:3072 lds
v_mfma_f32_16x16x32_bf16 a[252:255], v[160:163], v[248:251], a[252:255]
ds_read_b128 v[56:59], v16 offset:6144
v_accvgpr_read_b32 v25, a130
v_mfma_f32_16x16x32_bf16 a[252:255], v[164:167], v[252:255], a[252:255]
ds_read_b128 v[60:63], v17 offset:6144
v_accvgpr_read_b32 v29, a131
v_mfma_f32_16x16x32_bf16 a[248:251], v[172:175], v[252:255], a[248:251]
ds_read_b64_tr_b16 v[72:73], v9 offset:0
v_accvgpr_read_b32 v26, a132
v_mfma_f32_16x16x32_bf16 a[248:251], v[168:171], v[248:251], a[248:251]
s_add_u32 m0, s63, 102400
ds_read_b64_tr_b16 v[74:75], v9 offset:1024
v_accvgpr_read_b32 v30, a133
v_mfma_f32_16x16x32_bf16 a[244:247], v[176:179], v[248:251], a[244:247]
s_add_u32 s72, s70, 0
buffer_load_dwordx4 v4, s[4:7], s72 offen lds
v_mfma_f32_16x16x32_bf16 a[244:247], v[180:183], v[252:255], a[244:247]
ds_read_b64_tr_b16 v[76:77], v9 offset:8192
v_accvgpr_read_b32 v27, a134
v_mfma_f32_16x16x32_bf16 a[240:243], v[188:191], v[252:255], a[240:243]
v_accvgpr_read_b32 v31, a135
v_cvt_pk_bf16_f32 v24, v24, v28
v_mfma_f32_16x16x32_bf16 a[240:243], v[184:187], v[248:251], a[240:243]
ds_read_b64_tr_b16 v[78:79], v9 offset:9216
v_cvt_pk_bf16_f32 v25, v25, v29
v_mfma_f32_16x16x32_bf16 a[236:239], v[216:219], v[248:251], a[236:239]
ds_read_b64_tr_b16 v[80:81], v10 offset:0
v_cvt_pk_bf16_f32 v26, v26, v30
v_mfma_f32_16x16x32_bf16 a[236:239], v[220:223], v[252:255], a[236:239]
s_add_u32 s72, s70, 15360
buffer_load_dwordx4 v5, s[4:7], s72 offen offset:1024 lds
v_mfma_f32_16x16x32_bf16 a[232:235], v[212:215], v[252:255], a[232:235]
ds_read_b64_tr_b16 v[82:83], v10 offset:1024
v_cvt_pk_bf16_f32 v27, v27, v31
v_mfma_f32_16x16x32_bf16 a[232:235], v[208:211], v[248:251], a[232:235]
s_add_u32 s80, s78, 0
ds_read_b64_tr_b16 v[84:85], v10 offset:8192
v_mfma_f32_16x16x32_bf16 a[228:231], v[200:203], v[248:251], a[228:231]
ds_read_b64_tr_b16 v[86:87], v10 offset:9216
v_mfma_f32_16x16x32_bf16 a[228:231], v[204:207], v[252:255], a[228:231]
buffer_store_dwordx4 v[24:27], v1, s[44:47], s80 offen sc1
v_mfma_f32_16x16x32_bf16 a[224:227], v[196:199], v[252:255], a[224:227]
s_add_u32 s72, s70, 129024
buffer_load_dwordx4 v4, s[4:7], s72 offen offset:2048 lds
v_mfma_f32_16x16x32_bf16 a[224:227], v[192:195], v[248:251], a[224:227]
s_waitcnt lgkmcnt(8)
v_mfma_f32_16x16x32_bf16 v[128:131], v[64:67], v[32:35], 0
ds_read_b64_tr_b16 v[88:89], v11 offset:0
v_mfma_f32_16x16x32_bf16 v[128:131], v[68:71], v[36:39], v[128:131]
ds_read_b64_tr_b16 v[90:91], v11 offset:1024
v_mfma_f32_16x16x32_bf16 v[132:135], v[68:71], v[44:47], 0
v_accvgpr_read_b32 v20, a12
v_accvgpr_read_b32 v28, a13
v_mfma_f32_16x16x32_bf16 v[132:135], v[64:67], v[40:43], v[132:135]
s_add_u32 s72, s70, 144384
buffer_load_dwordx4 v5, s[4:7], s72 offen offset:3072 lds
v_mfma_f32_16x16x32_bf16 v[136:139], v[64:67], v[48:51], 0
s_lshl_b32 s71, s73, 12
ds_read_b64_tr_b16 v[92:93], v11 offset:8192
v_accvgpr_read_b32 v21, a14
v_mfma_f32_16x16x32_bf16 v[136:139], v[68:71], v[52:55], v[136:139]
s_add_u32 s71, s71, s66
v_accvgpr_read_b32 v29, a15
v_accvgpr_read_b32 v22, a44
v_mfma_f32_16x16x32_bf16 v[140:143], v[68:71], v[60:63], 0
s_add_u32 m0, s64, 32768
ds_read_b64_tr_b16 v[94:95], v11 offset:9216
v_accvgpr_read_b32 v30, a45
v_mfma_f32_16x16x32_bf16 v[140:143], v[64:67], v[56:59], v[140:143]
s_waitcnt lgkmcnt(8)
v_accvgpr_read_b32 v23, a46
v_accvgpr_read_b32 v31, a47
v_mfma_f32_16x16x32_bf16 v[156:159], v[72:75], v[56:59], 0
s_add_u32 s72, s71, 0
buffer_load_dwordx4 v6, s[12:15], s72 offen lds
v_mfma_f32_16x16x32_bf16 v[156:159], v[76:79], v[60:63], v[156:159]
s_add_u32 s73, s62, 3
ds_read_b64_tr_b16 v[64:65], v12 offset:0
v_mul_f32 v20, s79, v20
v_mfma_f32_16x16x32_bf16 v[152:155], v[76:79], v[52:55], 0
s_add_u32 s70, s73, s65
ds_read_b64_tr_b16 v[66:67], v12 offset:1024
v_mul_f32 v28, s79, v28
v_mfma_f32_16x16x32_bf16 v[152:155], v[72:75], v[48:51], v[152:155]
s_add_u32 s72, s71, 31744
buffer_load_dwordx4 v6, s[12:15], s72 offen offset:1024 lds
v_mfma_f32_16x16x32_bf16 v[148:151], v[72:75], v[40:43], 0
s_and_b32 s70, s70, 3
v_mul_f32 v21, s79, v21
v_mul_f32 v29, s79, v29
v_mfma_f32_16x16x32_bf16 v[148:151], v[76:79], v[44:47], v[148:151]
s_and_b32 s73, s73, 12
ds_read_b64_tr_b16 v[68:69], v12 offset:8192
v_mul_f32 v22, s79, v22
v_mfma_f32_16x16x32_bf16 v[144:147], v[76:79], v[36:39], 0
s_or_b32 s73, s73, s70
ds_read_b64_tr_b16 v[70:71], v12 offset:9216
v_mul_f32 v30, s79, v30
v_mfma_f32_16x16x32_bf16 v[144:147], v[72:75], v[32:35], v[144:147]
s_waitcnt lgkmcnt(8)
v_mul_f32 v23, s79, v23
v_mul_f32 v31, s79, v31
v_mfma_f32_16x16x32_bf16 v[160:163], v[80:83], v[32:35], 0
s_lshl_b32 s73, s73, 7
ds_read_b64_tr_b16 v[72:73], v13 offset:0
v_cvt_pk_bf16_f32 v20, v20, v28
v_mfma_f32_16x16x32_bf16 v[160:163], v[84:87], v[36:39], v[160:163]
s_add_u32 s72, s71, 63488
buffer_load_dwordx4 v7, s[12:15], s72 offen offset:2048 lds
v_mfma_f32_16x16x32_bf16 v[164:167], v[84:87], v[44:47], 0
s_add_u32 s69, s73, s67
ds_read_b64_tr_b16 v[74:75], v13 offset:1024
v_cvt_pk_bf16_f32 v21, v21, v29
v_mfma_f32_16x16x32_bf16 v[164:167], v[80:83], v[40:43], v[164:167]
s_add_u32 s70, s73, s68
v_cvt_pk_bf16_f32 v22, v22, v30
v_cvt_pk_bf16_f32 v23, v23, v31
v_mfma_f32_16x16x32_bf16 v[168:171], v[80:83], v[48:51], 0
s_waitcnt vmcnt(20)
ds_read_b64_tr_b16 v[76:77], v13 offset:8192
v_mfma_f32_16x16x32_bf16 v[168:171], v[84:87], v[52:55], v[168:171]
s_add_u32 s80, s77, 12288
ds_read_b64_tr_b16 v[78:79], v13 offset:9216
v_mfma_f32_16x16x32_bf16 v[172:175], v[84:87], v[60:63], 0
s_add_u32 s72, s71, 95232
ds_read_b128 v[96:99], v18 offset:0
v_mfma_f32_16x16x32_bf16 v[172:175], v[80:83], v[56:59], v[172:175]
s_waitcnt lgkmcnt(9)
buffer_load_dwordx4 v7, s[12:15], s72 offen offset:3072 lds
v_mfma_f32_16x16x32_bf16 v[188:191], v[88:91], v[56:59], 0
ds_read_b64_tr_b16 v[80:81], v14 offset:0
v_accvgpr_read_b32 v24, a136
v_mfma_f32_16x16x32_bf16 v[188:191], v[92:95], v[60:63], v[188:191]
ds_read_b64_tr_b16 v[82:83], v14 offset:1024
v_accvgpr_read_b32 v28, a137
v_mfma_f32_16x16x32_bf16 v[184:187], v[92:95], v[52:55], 0
ds_read_b128 v[100:103], v19 offset:0
v_accvgpr_read_b32 v25, a138
v_mfma_f32_16x16x32_bf16 v[184:187], v[88:91], v[48:51], v[184:187]
ds_read_b64_tr_b16 v[84:85], v14 offset:8192
v_accvgpr_read_b32 v29, a139
v_mfma_f32_16x16x32_bf16 v[180:183], v[88:91], v[40:43], 0
buffer_store_dwordx4 v[20:23], v1, s[44:47], s80 offen sc1
v_mfma_f32_16x16x32_bf16 v[180:183], v[92:95], v[44:47], v[180:183]
s_add_u32 m0, s63, 131072
ds_read_b64_tr_b16 v[86:87], v14 offset:9216
v_accvgpr_read_b32 v26, a140
v_mfma_f32_16x16x32_bf16 v[176:179], v[92:95], v[36:39], 0
s_add_u32 s72, s69, 0
buffer_load_dwordx4 v4, s[4:7], s72 offen lds
v_mfma_f32_16x16x32_bf16 v[176:179], v[88:91], v[32:35], v[176:179]
s_waitcnt lgkmcnt(10)
ds_read_b128 v[104:107], v18 offset:2048
v_accvgpr_read_b32 v30, a141
v_mfma_f32_16x16x32_bf16 v[192:195], v[64:67], v[32:35], 0
ds_read_b64_tr_b16 v[88:89], v15 offset:0
v_accvgpr_read_b32 v27, a142
v_mfma_f32_16x16x32_bf16 v[192:195], v[68:71], v[36:39], v[192:195]
ds_read_b64_tr_b16 v[90:91], v15 offset:1024
v_accvgpr_read_b32 v31, a143
v_mfma_f32_16x16x32_bf16 v[196:199], v[68:71], v[44:47], 0
ds_read_b64_tr_b16 v[92:93], v15 offset:8192
v_cvt_pk_bf16_f32 v24, v24, v28
v_mfma_f32_16x16x32_bf16 v[196:199], v[64:67], v[40:43], v[196:199]
s_add_u32 s72, s69, 15360
buffer_load_dwordx4 v5, s[4:7], s72 offen offset:1024 lds
v_mfma_f32_16x16x32_bf16 v[200:203], v[64:67], v[48:51], 0
ds_read_b64_tr_b16 v[94:95], v15 offset:9216
v_cvt_pk_bf16_f32 v25, v25, v29
v_mfma_f32_16x16x32_bf16 v[200:203], v[68:71], v[52:55], v[200:203]
ds_read_b128 v[108:111], v19 offset:2048
v_cvt_pk_bf16_f32 v26, v26, v30
v_mfma_f32_16x16x32_bf16 v[204:207], v[68:71], v[60:63], 0
v_cvt_pk_bf16_f32 v27, v27, v31
v_mfma_f32_16x16x32_bf16 v[204:207], v[64:67], v[56:59], v[204:207]
s_waitcnt lgkmcnt(12)
ds_read_b128 v[112:115], v18 offset:4096
v_mfma_f32_16x16x32_bf16 v[220:223], v[72:75], v[56:59], 0
s_add_u32 s72, s69, 129024
buffer_load_dwordx4 v4, s[4:7], s72 offen offset:2048 lds
v_mfma_f32_16x16x32_bf16 v[220:223], v[76:79], v[60:63], v[220:223]
s_add_u32 s80, s78, 8192
buffer_store_dwordx4 v[24:27], v1, s[44:47], s80 offen sc1
v_mfma_f32_16x16x32_bf16 v[216:219], v[76:79], v[52:55], 0
s_waitcnt vmcnt(21) lgkmcnt(2)
ds_read_b128 v[116:119], v19 offset:4096
v_mfma_f32_16x16x32_bf16 v[216:219], v[72:75], v[48:51], v[216:219]
s_barrier
ds_read_b128 v[120:123], v18 offset:6144
v_mfma_f32_16x16x32_bf16 v[212:215], v[72:75], v[40:43], 0
ds_read_b64_tr_b16 v[64:65], v8 offset:16384
ds_read_b64_tr_b16 v[66:67], v8 offset:17408
v_mfma_f32_16x16x32_bf16 v[212:215], v[76:79], v[44:47], v[212:215]
ds_read_b64_tr_b16 v[68:69], v8 offset:24576
v_mfma_f32_16x16x32_bf16 v[208:211], v[76:79], v[36:39], 0
s_add_u32 s72, s69, 144384
buffer_load_dwordx4 v5, s[4:7], s72 offen offset:3072 lds
v_mfma_f32_16x16x32_bf16 v[208:211], v[72:75], v[32:35], v[208:211]
ds_read_b64_tr_b16 v[70:71], v8 offset:25600
v_accvgpr_read_b32 v20, a16
v_mfma_f32_16x16x32_bf16 v[224:227], v[80:83], v[32:35], 0
ds_read_b64_tr_b16 v[72:73], v9 offset:16384
v_accvgpr_read_b32 v28, a17
v_mfma_f32_16x16x32_bf16 v[224:227], v[84:87], v[36:39], v[224:227]
ds_read_b64_tr_b16 v[74:75], v9 offset:17408
v_accvgpr_read_b32 v21, a18
v_mfma_f32_16x16x32_bf16 v[228:231], v[84:87], v[44:47], 0
s_add_u32 m0, s63, 135168
v_accvgpr_read_b32 v29, a19
v_accvgpr_read_b32 v22, a48
v_mfma_f32_16x16x32_bf16 v[228:231], v[80:83], v[40:43], v[228:231]
s_add_u32 s72, s70, 0
buffer_load_dwordx4 v4, s[4:7], s72 offen lds
v_mfma_f32_16x16x32_bf16 v[232:235], v[80:83], v[48:51], 0
ds_read_b64_tr_b16 v[76:77], v9 offset:24576
v_accvgpr_read_b32 v30, a49
v_mfma_f32_16x16x32_bf16 v[232:235], v[84:87], v[52:55], v[232:235]
ds_read_b128 v[124:127], v19 offset:6144
v_accvgpr_read_b32 v23, a50
v_mfma_f32_16x16x32_bf16 v[236:239], v[84:87], v[60:63], 0
ds_read_b64_tr_b16 v[78:79], v9 offset:25600
v_accvgpr_read_b32 v31, a51
v_mfma_f32_16x16x32_bf16 v[236:239], v[80:83], v[56:59], v[236:239]
v_mul_f32 v20, s79, v20
v_mul_f32 v28, s79, v28
v_mfma_f32_16x16x32_bf16 v[252:255], v[88:91], v[56:59], 0
s_add_u32 s72, s70, 15360
buffer_load_dwordx4 v5, s[4:7], s72 offen offset:1024 lds
v_mfma_f32_16x16x32_bf16 v[252:255], v[92:95], v[60:63], v[252:255]
ds_read_b64_tr_b16 v[80:81], v10 offset:16384
v_mul_f32 v21, s79, v21
v_mfma_f32_16x16x32_bf16 v[248:251], v[92:95], v[52:55], 0
ds_read_b64_tr_b16 v[82:83], v10 offset:17408
v_mul_f32 v29, s79, v29
v_mfma_f32_16x16x32_bf16 v[248:251], v[88:91], v[48:51], v[248:251]
v_mul_f32 v22, s79, v22
v_mul_f32 v30, s79, v30
v_mfma_f32_16x16x32_bf16 v[244:247], v[88:91], v[40:43], 0
ds_read_b64_tr_b16 v[84:85], v10 offset:24576
v_mul_f32 v23, s79, v23
v_mfma_f32_16x16x32_bf16 v[244:247], v[92:95], v[44:47], v[244:247]
ds_read_b64_tr_b16 v[86:87], v10 offset:25600
v_mul_f32 v31, s79, v31
v_mfma_f32_16x16x32_bf16 v[240:243], v[92:95], v[36:39], 0
s_add_u32 s72, s70, 129024
buffer_load_dwordx4 v4, s[4:7], s72 offen offset:2048 lds
v_mfma_f32_16x16x32_bf16 v[240:243], v[88:91], v[32:35], v[240:243]
s_waitcnt lgkmcnt(5)
v_cvt_pk_bf16_f32 v20, v20, v28
v_cvt_pk_bf16_f32 v21, v21, v29
v_mfma_f32_16x16x32_bf16 v[128:131], v[64:67], v[96:99], v[128:131]
ds_read_b64_tr_b16 v[88:89], v11 offset:16384
v_cvt_pk_bf16_f32 v22, v22, v30
v_mfma_f32_16x16x32_bf16 v[128:131], v[68:71], v[100:103], v[128:131]
ds_read_b64_tr_b16 v[90:91], v11 offset:17408
v_cvt_pk_bf16_f32 v23, v23, v31
v_mfma_f32_16x16x32_bf16 v[132:135], v[68:71], v[108:111], v[132:135]
s_add_u32 s80, s77, 32768
buffer_store_dwordx4 v[20:23], v1, s[44:47], s80 offen sc1
v_mfma_f32_16x16x32_bf16 v[132:135], v[64:67], v[104:107], v[132:135]
s_add_u32 s72, s70, 144384
buffer_load_dwordx4 v5, s[4:7], s72 offen offset:3072 lds
v_mfma_f32_16x16x32_bf16 v[136:139], v[64:67], v[112:115], v[136:139]
ds_read_b64_tr_b16 v[92:93], v11 offset:24576
v_accvgpr_read_b32 v24, a144
v_mfma_f32_16x16x32_bf16 v[136:139], v[68:71], v[116:119], v[136:139]
s_lshl_b32 s71, s73, 12
v_accvgpr_read_b32 v28, a145
v_accvgpr_read_b32 v25, a146
v_mfma_f32_16x16x32_bf16 v[140:143], v[68:71], v[124:127], v[140:143]
s_add_u32 s71, s71, s66
ds_read_b64_tr_b16 v[94:95], v11 offset:25600
v_accvgpr_read_b32 v29, a147
v_mfma_f32_16x16x32_bf16 v[140:143], v[64:67], v[120:123], v[140:143]
s_waitcnt lgkmcnt(8)
v_accvgpr_read_b32 v26, a148
v_accvgpr_read_b32 v30, a149
v_mfma_f32_16x16x32_bf16 v[156:159], v[72:75], v[120:123], v[156:159]
s_add_u32 m0, s64, 0
ds_read_b64_tr_b16 v[64:65], v12 offset:16384
v_accvgpr_read_b32 v27, a150
v_mfma_f32_16x16x32_bf16 v[156:159], v[76:79], v[124:127], v[156:159]
s_add_u32 s72, s71, 0
buffer_load_dwordx4 v6, s[12:15], s72 offen lds
v_mfma_f32_16x16x32_bf16 v[152:155], v[76:79], v[116:119], v[152:155]
s_add_u32 s73, s62, 4
ds_read_b64_tr_b16 v[66:67], v12 offset:17408
v_accvgpr_read_b32 v31, a151
v_mfma_f32_16x16x32_bf16 v[152:155], v[72:75], v[112:115], v[152:155]
s_add_u32 s70, s73, s65
v_cvt_pk_bf16_f32 v24, v24, v28
v_cvt_pk_bf16_f32 v25, v25, v29
v_mfma_f32_16x16x32_bf16 v[148:151], v[72:75], v[104:107], v[148:151]
s_and_b32 s70, s70, 3
ds_read_b64_tr_b16 v[68:69], v12 offset:24576
v_cvt_pk_bf16_f32 v26, v26, v30
v_mfma_f32_16x16x32_bf16 v[148:151], v[76:79], v[108:111], v[148:151]
s_and_b32 s73, s73, 12
ds_read_b64_tr_b16 v[70:71], v12 offset:25600
v_cvt_pk_bf16_f32 v27, v27, v31
v_mfma_f32_16x16x32_bf16 v[144:147], v[76:79], v[100:103], v[144:147]
s_add_u32 s72, s71, 31744
buffer_load_dwordx4 v6, s[12:15], s72 offen offset:1024 lds
v_mfma_f32_16x16x32_bf16 v[144:147], v[72:75], v[96:99], v[144:147]
s_waitcnt lgkmcnt(8)
v_mfma_f32_16x16x32_bf16 v[160:163], v[80:83], v[96:99], v[160:163]
s_or_b32 s73, s73, s70
ds_read_b64_tr_b16 v[72:73], v13 offset:16384
v_mfma_f32_16x16x32_bf16 v[160:163], v[84:87], v[100:103], v[160:163]
s_lshl_b32 s73, s73, 7
ds_read_b64_tr_b16 v[74:75], v13 offset:17408
v_mfma_f32_16x16x32_bf16 v[164:167], v[84:87], v[108:111], v[164:167]
s_add_u32 s69, s73, s67
v_mfma_f32_16x16x32_bf16 v[164:167], v[80:83], v[104:107], v[164:167]
s_add_u32 s72, s71, 63488
buffer_load_dwordx4 v7, s[12:15], s72 offen offset:2048 lds
v_mfma_f32_16x16x32_bf16 v[168:171], v[80:83], v[112:115], v[168:171]
s_waitcnt vmcnt(18)
ds_read_b64_tr_b16 v[76:77], v13 offset:24576
v_mfma_f32_16x16x32_bf16 v[168:171], v[84:87], v[116:119], v[168:171]
s_add_u32 s70, s73, s68
ds_read_b128 v[32:35], v18 offset:32768
v_mfma_f32_16x16x32_bf16 v[172:175], v[84:87], v[124:127], v[172:175]
s_add_u32 s80, s78, 32768
ds_read_b64_tr_b16 v[78:79], v13 offset:25600
v_mfma_f32_16x16x32_bf16 v[172:175], v[80:83], v[120:123], v[172:175]
s_waitcnt lgkmcnt(9)
ds_read_b128 v[36:39], v19 offset:32768
v_mfma_f32_16x16x32_bf16 v[188:191], v[88:91], v[120:123], v[188:191]
s_add_u32 s72, s71, 95232
buffer_load_dwordx4 v7, s[12:15], s72 offen offset:3072 lds
v_mfma_f32_16x16x32_bf16 v[188:191], v[92:95], v[124:127], v[188:191]
ds_read_b64_tr_b16 v[80:81], v14 offset:16384
v_mfma_f32_16x16x32_bf16 v[184:187], v[92:95], v[116:119], v[184:187]
ds_read_b64_tr_b16 v[82:83], v14 offset:17408
v_mfma_f32_16x16x32_bf16 v[184:187], v[88:91], v[112:115], v[184:187]
buffer_store_dwordx4 v[24:27], v1, s[44:47], s80 offen sc1
v_mfma_f32_16x16x32_bf16 v[180:183], v[88:91], v[104:107], v[180:183]
ds_read_b64_tr_b16 v[84:85], v14 offset:24576
v_accvgpr_read_b32 v20, a20
v_mfma_f32_16x16x32_bf16 v[180:183], v[92:95], v[108:111], v[180:183]
s_add_u32 m0, s63, 65536
ds_read_b64_tr_b16 v[86:87], v14 offset:25600
v_accvgpr_read_b32 v28, a21
v_mfma_f32_16x16x32_bf16 v[176:179], v[92:95], v[100:103], v[176:179]
s_add_u32 s72, s69, 0
buffer_load_dwordx4 v4, s[4:7], s72 offen lds
v_mfma_f32_16x16x32_bf16 v[176:179], v[88:91], v[96:99], v[176:179]
s_waitcnt lgkmcnt(10)
ds_read_b128 v[40:43], v18 offset:34816
v_accvgpr_read_b32 v21, a22
v_mfma_f32_16x16x32_bf16 v[192:195], v[64:67], v[96:99], v[192:195]
ds_read_b64_tr_b16 v[88:89], v15 offset:16384
v_accvgpr_read_b32 v29, a23
v_mfma_f32_16x16x32_bf16 v[192:195], v[68:71], v[100:103], v[192:195]
ds_read_b64_tr_b16 v[90:91], v15 offset:17408
v_accvgpr_read_b32 v22, a52
v_mfma_f32_16x16x32_bf16 v[196:199], v[68:71], v[108:111], v[196:199]
ds_read_b64_tr_b16 v[92:93], v15 offset:24576
v_accvgpr_read_b32 v30, a53
v_mfma_f32_16x16x32_bf16 v[196:199], v[64:67], v[104:107], v[196:199]
s_add_u32 s72, s69, 15360
buffer_load_dwordx4 v5, s[4:7], s72 offen offset:1024 lds
v_mfma_f32_16x16x32_bf16 v[200:203], v[64:67], v[112:115], v[200:203]
ds_read_b64_tr_b16 v[94:95], v15 offset:25600
v_accvgpr_read_b32 v23, a54
v_mfma_f32_16x16x32_bf16 v[200:203], v[68:71], v[116:119], v[200:203]
ds_read_b128 v[44:47], v19 offset:34816
v_accvgpr_read_b32 v31, a55
v_mfma_f32_16x16x32_bf16 v[204:207], v[68:71], v[124:127], v[204:207]
v_mul_f32 v20, s79, v20
v_mul_f32 v28, s79, v28
v_mfma_f32_16x16x32_bf16 v[204:207], v[64:67], v[120:123], v[204:207]
s_waitcnt lgkmcnt(11)
ds_read_b128 v[48:51], v18 offset:36864
v_mul_f32 v21, s79, v21
v_mfma_f32_16x16x32_bf16 v[220:223], v[72:75], v[120:123], v[220:223]
s_add_u32 s72, s69, 129024
buffer_load_dwordx4 v4, s[4:7], s72 offen offset:2048 lds
v_mfma_f32_16x16x32_bf16 v[220:223], v[76:79], v[124:127], v[220:223]
v_mul_f32 v29, s79, v29
v_mul_f32 v22, s79, v22
v_mfma_f32_16x16x32_bf16 v[216:219], v[76:79], v[116:119], v[216:219]
s_waitcnt vmcnt(19) lgkmcnt(2)
ds_read_b128 v[52:55], v19 offset:36864
v_mul_f32 v30, s79, v30
v_mfma_f32_16x16x32_bf16 v[216:219], v[72:75], v[112:115], v[216:219]
s_barrier
ds_read_b128 v[56:59], v18 offset:38912
v_mul_f32 v23, s79, v23
v_mfma_f32_16x16x32_bf16 v[212:215], v[72:75], v[104:107], v[212:215]
ds_read_b64_tr_b16 v[64:65], v8 offset:32768
ds_read_b64_tr_b16 v[66:67], v8 offset:33792
v_mfma_f32_16x16x32_bf16 v[212:215], v[76:79], v[108:111], v[212:215]
ds_read_b64_tr_b16 v[68:69], v8 offset:40960
v_mul_f32 v31, s79, v31
v_mfma_f32_16x16x32_bf16 v[208:211], v[76:79], v[100:103], v[208:211]
s_add_u32 s72, s69, 144384
buffer_load_dwordx4 v5, s[4:7], s72 offen offset:3072 lds
v_mfma_f32_16x16x32_bf16 v[208:211], v[72:75], v[96:99], v[208:211]
ds_read_b64_tr_b16 v[70:71], v8 offset:41984
v_cvt_pk_bf16_f32 v20, v20, v28
v_mfma_f32_16x16x32_bf16 v[224:227], v[80:83], v[96:99], v[224:227]
ds_read_b64_tr_b16 v[72:73], v9 offset:32768
v_cvt_pk_bf16_f32 v21, v21, v29
v_mfma_f32_16x16x32_bf16 v[224:227], v[84:87], v[100:103], v[224:227]
ds_read_b64_tr_b16 v[74:75], v9 offset:33792
v_cvt_pk_bf16_f32 v22, v22, v30
v_mfma_f32_16x16x32_bf16 v[228:231], v[84:87], v[108:111], v[228:231]
s_add_u32 m0, s63, 69632
v_cvt_pk_bf16_f32 v23, v23, v31
v_accvgpr_read_b32 v24, a152
v_mfma_f32_16x16x32_bf16 v[228:231], v[80:83], v[104:107], v[228:231]
s_add_u32 s72, s70, 0
buffer_load_dwordx4 v4, s[4:7], s72 offen lds
v_mfma_f32_16x16x32_bf16 v[232:235], v[80:83], v[112:115], v[232:235]
s_add_u32 s80, s77, 36864
ds_read_b64_tr_b16 v[76:77], v9 offset:40960
v_accvgpr_read_b32 v28, a153
v_mfma_f32_16x16x32_bf16 v[232:235], v[84:87], v[116:119], v[232:235]
ds_read_b128 v[60:63], v19 offset:38912
v_accvgpr_read_b32 v25, a154
v_mfma_f32_16x16x32_bf16 v[236:239], v[84:87], v[124:127], v[236:239]
ds_read_b64_tr_b16 v[78:79], v9 offset:41984
v_accvgpr_read_b32 v29, a155
v_mfma_f32_16x16x32_bf16 v[236:239], v[80:83], v[120:123], v[236:239]
buffer_store_dwordx4 v[20:23], v1, s[44:47], s80 offen sc1
v_mfma_f32_16x16x32_bf16 v[252:255], v[88:91], v[120:123], v[252:255]
s_add_u32 s72, s70, 15360
buffer_load_dwordx4 v5, s[4:7], s72 offen offset:1024 lds
v_mfma_f32_16x16x32_bf16 v[252:255], v[92:95], v[124:127], v[252:255]
ds_read_b64_tr_b16 v[80:81], v10 offset:32768
v_accvgpr_read_b32 v26, a156
v_mfma_f32_16x16x32_bf16 v[248:251], v[92:95], v[116:119], v[248:251]
ds_read_b64_tr_b16 v[82:83], v10 offset:33792
v_accvgpr_read_b32 v30, a157
v_mfma_f32_16x16x32_bf16 v[248:251], v[88:91], v[112:115], v[248:251]
v_accvgpr_read_b32 v27, a158
v_accvgpr_read_b32 v31, a159
v_mfma_f32_16x16x32_bf16 v[244:247], v[88:91], v[104:107], v[244:247]
ds_read_b64_tr_b16 v[84:85], v10 offset:40960
v_cvt_pk_bf16_f32 v24, v24, v28
v_mfma_f32_16x16x32_bf16 v[244:247], v[92:95], v[108:111], v[244:247]
ds_read_b64_tr_b16 v[86:87], v10 offset:41984
v_cvt_pk_bf16_f32 v25, v25, v29
v_mfma_f32_16x16x32_bf16 v[240:243], v[92:95], v[100:103], v[240:243]
s_add_u32 s72, s70, 129024
buffer_load_dwordx4 v4, s[4:7], s72 offen offset:2048 lds
v_mfma_f32_16x16x32_bf16 v[240:243], v[88:91], v[96:99], v[240:243]
s_waitcnt lgkmcnt(5)
v_cvt_pk_bf16_f32 v26, v26, v30
v_cvt_pk_bf16_f32 v27, v27, v31
v_mfma_f32_16x16x32_bf16 v[128:131], v[64:67], v[32:35], v[128:131]
s_add_u32 s80, s78, 40960
ds_read_b64_tr_b16 v[88:89], v11 offset:32768
v_mfma_f32_16x16x32_bf16 v[128:131], v[68:71], v[36:39], v[128:131]
ds_read_b64_tr_b16 v[90:91], v11 offset:33792
v_mfma_f32_16x16x32_bf16 v[132:135], v[68:71], v[44:47], v[132:135]
buffer_store_dwordx4 v[24:27], v1, s[44:47], s80 offen sc1
v_mfma_f32_16x16x32_bf16 v[132:135], v[64:67], v[40:43], v[132:135]
s_add_u32 s72, s70, 144384
buffer_load_dwordx4 v5, s[4:7], s72 offen offset:3072 lds
v_mfma_f32_16x16x32_bf16 v[136:139], v[64:67], v[48:51], v[136:139]
ds_read_b64_tr_b16 v[92:93], v11 offset:40960
v_mfma_f32_16x16x32_bf16 v[136:139], v[68:71], v[52:55], v[136:139]
s_lshl_b32 s71, s73, 12
v_mfma_f32_16x16x32_bf16 v[140:143], v[68:71], v[60:63], v[140:143]
s_add_u32 s71, s71, s66
ds_read_b64_tr_b16 v[94:95], v11 offset:41984
v_mfma_f32_16x16x32_bf16 v[140:143], v[64:67], v[56:59], v[140:143]
s_waitcnt lgkmcnt(8)
v_accvgpr_read_b32 v20, a24
v_accvgpr_read_b32 v28, a25
v_mfma_f32_16x16x32_bf16 v[156:159], v[72:75], v[56:59], v[156:159]
s_add_u32 m0, s64, 16384
ds_read_b64_tr_b16 v[64:65], v12 offset:32768
v_accvgpr_read_b32 v21, a26
v_mfma_f32_16x16x32_bf16 v[156:159], v[76:79], v[60:63], v[156:159]
s_add_u32 s72, s71, 0
buffer_load_dwordx4 v6, s[12:15], s72 offen lds
v_mfma_f32_16x16x32_bf16 v[152:155], v[76:79], v[52:55], v[152:155]
s_add_u32 s73, s62, 5
ds_read_b64_tr_b16 v[66:67], v12 offset:33792
v_accvgpr_read_b32 v29, a27
v_mfma_f32_16x16x32_bf16 v[152:155], v[72:75], v[48:51], v[152:155]
s_add_u32 s70, s73, s65
v_accvgpr_read_b32 v22, a56
v_accvgpr_read_b32 v30, a57
v_mfma_f32_16x16x32_bf16 v[148:151], v[72:75], v[40:43], v[148:151]
s_and_b32 s70, s70, 3
ds_read_b64_tr_b16 v[68:69], v12 offset:40960
v_accvgpr_read_b32 v23, a58
v_mfma_f32_16x16x32_bf16 v[148:151], v[76:79], v[44:47], v[148:151]
s_and_b32 s73, s73, 12
ds_read_b64_tr_b16 v[70:71], v12 offset:41984
v_accvgpr_read_b32 v31, a59
v_mfma_f32_16x16x32_bf16 v[144:147], v[76:79], v[36:39], v[144:147]
s_add_u32 s72, s71, 31744
buffer_load_dwordx4 v6, s[12:15], s72 offen offset:1024 lds
v_mfma_f32_16x16x32_bf16 v[144:147], v[72:75], v[32:35], v[144:147]
s_waitcnt lgkmcnt(8)
v_mul_f32 v20, s79, v20
v_mul_f32 v28, s79, v28
v_mfma_f32_16x16x32_bf16 v[160:163], v[80:83], v[32:35], v[160:163]
s_or_b32 s73, s73, s70
ds_read_b64_tr_b16 v[72:73], v13 offset:32768
v_mul_f32 v21, s79, v21
v_mfma_f32_16x16x32_bf16 v[160:163], v[84:87], v[36:39], v[160:163]
s_lshl_b32 s73, s73, 7
ds_read_b64_tr_b16 v[74:75], v13 offset:33792
v_mul_f32 v29, s79, v29
v_mfma_f32_16x16x32_bf16 v[164:167], v[84:87], v[44:47], v[164:167]
s_add_u32 s69, s73, s67
v_mul_f32 v22, s79, v22
v_mul_f32 v30, s79, v30
v_mfma_f32_16x16x32_bf16 v[164:167], v[80:83], v[40:43], v[164:167]
s_add_u32 s72, s71, 63488
buffer_load_dwordx4 v7, s[12:15], s72 offen offset:2048 lds
v_mfma_f32_16x16x32_bf16 v[168:171], v[80:83], v[48:51], v[168:171]
s_waitcnt vmcnt(18)
ds_read_b64_tr_b16 v[76:77], v13 offset:40960
v_mul_f32 v23, s79, v23
v_mfma_f32_16x16x32_bf16 v[168:171], v[84:87], v[52:55], v[168:171]
s_add_u32 s70, s73, s68
ds_read_b128 v[96:99], v16 offset:0
v_mul_f32 v31, s79, v31
v_mfma_f32_16x16x32_bf16 v[172:175], v[84:87], v[60:63], v[172:175]
ds_read_b64_tr_b16 v[78:79], v13 offset:41984
v_cvt_pk_bf16_f32 v20, v20, v28
v_mfma_f32_16x16x32_bf16 v[172:175], v[80:83], v[56:59], v[172:175]
s_waitcnt lgkmcnt(9)
ds_read_b128 v[100:103], v17 offset:0
v_cvt_pk_bf16_f32 v21, v21, v29
v_mfma_f32_16x16x32_bf16 v[188:191], v[88:91], v[56:59], v[188:191]
s_add_u32 s72, s71, 95232
buffer_load_dwordx4 v7, s[12:15], s72 offen offset:3072 lds
v_mfma_f32_16x16x32_bf16 v[188:191], v[92:95], v[60:63], v[188:191]
ds_read_b64_tr_b16 v[80:81], v14 offset:32768
v_cvt_pk_bf16_f32 v22, v22, v30
v_mfma_f32_16x16x32_bf16 v[184:187], v[92:95], v[52:55], v[184:187]
ds_read_b64_tr_b16 v[82:83], v14 offset:33792
v_cvt_pk_bf16_f32 v23, v23, v31
v_mfma_f32_16x16x32_bf16 v[184:187], v[88:91], v[48:51], v[184:187]
s_add_u32 s80, s77, 40960
buffer_store_dwordx4 v[20:23], v1, s[44:47], s80 offen sc1
v_mfma_f32_16x16x32_bf16 v[180:183], v[88:91], v[40:43], v[180:183]
ds_read_b64_tr_b16 v[84:85], v14 offset:40960
v_mfma_f32_16x16x32_bf16 v[180:183], v[92:95], v[44:47], v[180:183]
s_add_u32 m0, s63, 98304
ds_read_b64_tr_b16 v[86:87], v14 offset:41984
v_accvgpr_read_b32 v24, a160
v_mfma_f32_16x16x32_bf16 v[176:179], v[92:95], v[36:39], v[176:179]
s_add_u32 s72, s69, 0
buffer_load_dwordx4 v4, s[4:7], s72 offen lds
v_mfma_f32_16x16x32_bf16 v[176:179], v[88:91], v[32:35], v[176:179]
s_waitcnt lgkmcnt(10)
ds_read_b128 v[104:107], v16 offset:2048
v_accvgpr_read_b32 v28, a161
v_mfma_f32_16x16x32_bf16 v[192:195], v[64:67], v[32:35], v[192:195]
ds_read_b64_tr_b16 v[88:89], v15 offset:32768
v_accvgpr_read_b32 v25, a162
v_mfma_f32_16x16x32_bf16 v[192:195], v[68:71], v[36:39], v[192:195]
ds_read_b64_tr_b16 v[90:91], v15 offset:33792
v_accvgpr_read_b32 v29, a163
v_mfma_f32_16x16x32_bf16 v[196:199], v[68:71], v[44:47], v[196:199]
ds_read_b64_tr_b16 v[92:93], v15 offset:40960
v_accvgpr_read_b32 v26, a164
v_mfma_f32_16x16x32_bf16 v[196:199], v[64:67], v[40:43], v[196:199]
s_add_u32 s72, s69, 15360
buffer_load_dwordx4 v5, s[4:7], s72 offen offset:1024 lds
v_mfma_f32_16x16x32_bf16 v[200:203], v[64:67], v[48:51], v[200:203]
ds_read_b64_tr_b16 v[94:95], v15 offset:41984
v_accvgpr_read_b32 v30, a165
v_mfma_f32_16x16x32_bf16 v[200:203], v[68:71], v[52:55], v[200:203]
ds_read_b128 v[108:111], v17 offset:2048
v_accvgpr_read_b32 v27, a166
v_mfma_f32_16x16x32_bf16 v[204:207], v[68:71], v[60:63], v[204:207]
v_accvgpr_read_b32 v31, a167
v_cvt_pk_bf16_f32 v24, v24, v28
v_mfma_f32_16x16x32_bf16 v[204:207], v[64:67], v[56:59], v[204:207]
s_waitcnt lgkmcnt(11)
ds_read_b128 v[112:115], v16 offset:4096
v_cvt_pk_bf16_f32 v25, v25, v29
v_mfma_f32_16x16x32_bf16 v[220:223], v[72:75], v[56:59], v[220:223]
s_add_u32 s72, s69, 129024
buffer_load_dwordx4 v4, s[4:7], s72 offen offset:2048 lds
v_mfma_f32_16x16x32_bf16 v[220:223], v[76:79], v[60:63], v[220:223]
v_cvt_pk_bf16_f32 v26, v26, v30
v_cvt_pk_bf16_f32 v27, v27, v31
v_mfma_f32_16x16x32_bf16 v[216:219], v[76:79], v[52:55], v[216:219]
s_waitcnt vmcnt(19) lgkmcnt(2)
ds_read_b128 v[116:119], v17 offset:4096
v_mfma_f32_16x16x32_bf16 v[216:219], v[72:75], v[48:51], v[216:219]
s_barrier
ds_read_b128 v[120:123], v16 offset:6144
v_mfma_f32_16x16x32_bf16 v[212:215], v[72:75], v[40:43], v[212:215]
s_add_u32 s80, s78, 1024
ds_read_b64_tr_b16 v[64:65], v8 offset:0
ds_read_b64_tr_b16 v[66:67], v8 offset:1024
v_mfma_f32_16x16x32_bf16 v[212:215], v[76:79], v[44:47], v[212:215]
ds_read_b64_tr_b16 v[68:69], v8 offset:8192
v_mfma_f32_16x16x32_bf16 v[208:211], v[76:79], v[36:39], v[208:211]
s_add_u32 s72, s69, 144384
buffer_load_dwordx4 v5, s[4:7], s72 offen offset:3072 lds
v_mfma_f32_16x16x32_bf16 v[208:211], v[72:75], v[32:35], v[208:211]
ds_read_b64_tr_b16 v[70:71], v8 offset:9216
v_mfma_f32_16x16x32_bf16 v[224:227], v[80:83], v[32:35], v[224:227]
ds_read_b64_tr_b16 v[72:73], v9 offset:0
v_mfma_f32_16x16x32_bf16 v[224:227], v[84:87], v[36:39], v[224:227]
ds_read_b64_tr_b16 v[74:75], v9 offset:1024
v_mfma_f32_16x16x32_bf16 v[228:231], v[84:87], v[44:47], v[228:231]
s_add_u32 m0, s63, 102400
buffer_store_dwordx4 v[24:27], v1, s[44:47], s80 offen sc1
v_mfma_f32_16x16x32_bf16 v[228:231], v[80:83], v[40:43], v[228:231]
s_add_u32 s72, s70, 0
buffer_load_dwordx4 v4, s[4:7], s72 offen lds
v_mfma_f32_16x16x32_bf16 v[232:235], v[80:83], v[48:51], v[232:235]
ds_read_b64_tr_b16 v[76:77], v9 offset:8192
v_accvgpr_read_b32 v20, a28
v_mfma_f32_16x16x32_bf16 v[232:235], v[84:87], v[52:55], v[232:235]
ds_read_b128 v[124:127], v17 offset:6144
v_accvgpr_read_b32 v28, a29
v_mfma_f32_16x16x32_bf16 v[236:239], v[84:87], v[60:63], v[236:239]
ds_read_b64_tr_b16 v[78:79], v9 offset:9216
v_accvgpr_read_b32 v21, a30
v_mfma_f32_16x16x32_bf16 v[236:239], v[80:83], v[56:59], v[236:239]
v_accvgpr_read_b32 v29, a31
v_accvgpr_read_b32 v22, a60
v_mfma_f32_16x16x32_bf16 v[252:255], v[88:91], v[56:59], v[252:255]
s_add_u32 s72, s70, 15360
buffer_load_dwordx4 v5, s[4:7], s72 offen offset:1024 lds
v_mfma_f32_16x16x32_bf16 v[252:255], v[92:95], v[60:63], v[252:255]
ds_read_b64_tr_b16 v[80:81], v10 offset:0
v_accvgpr_read_b32 v30, a61
v_mfma_f32_16x16x32_bf16 v[248:251], v[92:95], v[52:55], v[248:251]
ds_read_b64_tr_b16 v[82:83], v10 offset:1024
v_accvgpr_read_b32 v23, a62
v_mfma_f32_16x16x32_bf16 v[248:251], v[88:91], v[48:51], v[248:251]
v_accvgpr_read_b32 v31, a63
v_mul_f32 v20, s79, v20
v_mfma_f32_16x16x32_bf16 v[244:247], v[88:91], v[40:43], v[244:247]
ds_read_b64_tr_b16 v[84:85], v10 offset:8192
v_mul_f32 v28, s79, v28
v_mfma_f32_16x16x32_bf16 v[244:247], v[92:95], v[44:47], v[244:247]
ds_read_b64_tr_b16 v[86:87], v10 offset:9216
v_mul_f32 v21, s79, v21
v_mfma_f32_16x16x32_bf16 v[240:243], v[92:95], v[36:39], v[240:243]
s_add_u32 s72, s70, 129024
buffer_load_dwordx4 v4, s[4:7], s72 offen offset:2048 lds
v_mfma_f32_16x16x32_bf16 v[240:243], v[88:91], v[32:35], v[240:243]
s_waitcnt lgkmcnt(5)
v_mul_f32 v29, s79, v29
v_mul_f32 v22, s79, v22
v_mfma_f32_16x16x32_bf16 v[128:131], v[64:67], v[96:99], v[128:131]
ds_read_b64_tr_b16 v[88:89], v11 offset:0
v_mul_f32 v30, s79, v30
v_mfma_f32_16x16x32_bf16 v[128:131], v[68:71], v[100:103], v[128:131]
ds_read_b64_tr_b16 v[90:91], v11 offset:1024
v_mul_f32 v23, s79, v23
v_mfma_f32_16x16x32_bf16 v[132:135], v[68:71], v[108:111], v[132:135]
v_mul_f32 v31, s79, v31
v_cvt_pk_bf16_f32 v20, v20, v28
v_mfma_f32_16x16x32_bf16 v[132:135], v[64:67], v[104:107], v[132:135]
s_add_u32 s72, s70, 144384
buffer_load_dwordx4 v5, s[4:7], s72 offen offset:3072 lds
v_mfma_f32_16x16x32_bf16 v[136:139], v[64:67], v[112:115], v[136:139]
ds_read_b64_tr_b16 v[92:93], v11 offset:8192
v_cvt_pk_bf16_f32 v21, v21, v29
v_mfma_f32_16x16x32_bf16 v[136:139], v[68:71], v[116:119], v[136:139]
s_lshl_b32 s71, s73, 12
v_cvt_pk_bf16_f32 v22, v22, v30
v_cvt_pk_bf16_f32 v23, v23, v31
v_mfma_f32_16x16x32_bf16 v[140:143], v[68:71], v[124:127], v[140:143]
s_add_u32 s71, s71, s66
ds_read_b64_tr_b16 v[94:95], v11 offset:9216
v_mfma_f32_16x16x32_bf16 v[140:143], v[64:67], v[120:123], v[140:143]
s_waitcnt lgkmcnt(8)
v_mfma_f32_16x16x32_bf16 v[156:159], v[72:75], v[120:123], v[156:159]
s_add_u32 m0, s64, 32768
ds_read_b64_tr_b16 v[64:65], v12 offset:0
v_mfma_f32_16x16x32_bf16 v[156:159], v[76:79], v[124:127], v[156:159]
s_add_u32 s72, s71, 0
buffer_load_dwordx4 v6, s[12:15], s72 offen lds
v_mfma_f32_16x16x32_bf16 v[152:155], v[76:79], v[116:119], v[152:155]
s_add_u32 s73, s62, 6
ds_read_b64_tr_b16 v[66:67], v12 offset:1024
v_accvgpr_read_b32 v24, a168
v_mfma_f32_16x16x32_bf16 v[152:155], v[72:75], v[112:115], v[152:155]
s_add_u32 s70, s73, s65
v_accvgpr_read_b32 v28, a169
v_accvgpr_read_b32 v25, a170
v_mfma_f32_16x16x32_bf16 v[148:151], v[72:75], v[104:107], v[148:151]
s_and_b32 s70, s70, 3
ds_read_b64_tr_b16 v[68:69], v12 offset:8192
v_accvgpr_read_b32 v29, a171
v_mfma_f32_16x16x32_bf16 v[148:151], v[76:79], v[108:111], v[148:151]
s_and_b32 s73, s73, 12
ds_read_b64_tr_b16 v[70:71], v12 offset:9216
v_accvgpr_read_b32 v26, a172
v_mfma_f32_16x16x32_bf16 v[144:147], v[76:79], v[100:103], v[144:147]
s_add_u32 s72, s71, 31744
buffer_load_dwordx4 v6, s[12:15], s72 offen offset:1024 lds
v_mfma_f32_16x16x32_bf16 v[144:147], v[72:75], v[96:99], v[144:147]
s_waitcnt lgkmcnt(8)
v_accvgpr_read_b32 v30, a173
v_accvgpr_read_b32 v27, a174
v_mfma_f32_16x16x32_bf16 v[160:163], v[80:83], v[96:99], v[160:163]
s_or_b32 s73, s73, s70
ds_read_b64_tr_b16 v[72:73], v13 offset:0
v_accvgpr_read_b32 v31, a175
v_mfma_f32_16x16x32_bf16 v[160:163], v[84:87], v[100:103], v[160:163]
s_lshl_b32 s73, s73, 7
ds_read_b64_tr_b16 v[74:75], v13 offset:1024
v_cvt_pk_bf16_f32 v24, v24, v28
v_mfma_f32_16x16x32_bf16 v[164:167], v[84:87], v[108:111], v[164:167]
s_add_u32 s69, s73, s67
v_cvt_pk_bf16_f32 v25, v25, v29
v_cvt_pk_bf16_f32 v26, v26, v30
v_mfma_f32_16x16x32_bf16 v[164:167], v[80:83], v[104:107], v[164:167]
s_add_u32 s72, s71, 63488
buffer_load_dwordx4 v7, s[12:15], s72 offen offset:2048 lds
v_mfma_f32_16x16x32_bf16 v[168:171], v[80:83], v[112:115], v[168:171]
s_waitcnt vmcnt(17)
ds_read_b64_tr_b16 v[76:77], v13 offset:8192
v_cvt_pk_bf16_f32 v27, v27, v31
v_mfma_f32_16x16x32_bf16 v[168:171], v[84:87], v[116:119], v[168:171]
s_add_u32 s70, s73, s68
ds_read_b128 v[32:35], v18 offset:0
v_mfma_f32_16x16x32_bf16 v[172:175], v[84:87], v[124:127], v[172:175]
s_add_u32 s80, s77, 45056
ds_read_b64_tr_b16 v[78:79], v13 offset:9216
v_mfma_f32_16x16x32_bf16 v[172:175], v[80:83], v[120:123], v[172:175]
s_waitcnt lgkmcnt(9)
ds_read_b128 v[36:39], v19 offset:0
v_mfma_f32_16x16x32_bf16 v[188:191], v[88:91], v[120:123], v[188:191]
s_add_u32 s72, s71, 95232
buffer_load_dwordx4 v7, s[12:15], s72 offen offset:3072 lds
v_mfma_f32_16x16x32_bf16 v[188:191], v[92:95], v[124:127], v[188:191]
ds_read_b64_tr_b16 v[80:81], v14 offset:0
v_mfma_f32_16x16x32_bf16 v[184:187], v[92:95], v[116:119], v[184:187]
ds_read_b64_tr_b16 v[82:83], v14 offset:1024
v_mfma_f32_16x16x32_bf16 v[184:187], v[88:91], v[112:115], v[184:187]
buffer_store_dwordx4 v[20:23], v1, s[44:47], s80 offen sc1
v_mfma_f32_16x16x32_bf16 v[180:183], v[88:91], v[104:107], v[180:183]
s_add_u32 s80, s78, 9216
ds_read_b64_tr_b16 v[84:85], v14 offset:8192
v_mfma_f32_16x16x32_bf16 v[180:183], v[92:95], v[108:111], v[180:183]
s_add_u32 m0, s63, 131072
ds_read_b64_tr_b16 v[86:87], v14 offset:9216
v_mfma_f32_16x16x32_bf16 v[176:179], v[92:95], v[100:103], v[176:179]
s_add_u32 s72, s69, 0
buffer_load_dwordx4 v4, s[4:7], s72 offen lds
v_mfma_f32_16x16x32_bf16 v[176:179], v[88:91], v[96:99], v[176:179]
s_waitcnt lgkmcnt(10)
ds_read_b128 v[40:43], v18 offset:2048
v_accvgpr_read_b32 v20, a64
v_mfma_f32_16x16x32_bf16 v[192:195], v[64:67], v[96:99], v[192:195]
ds_read_b64_tr_b16 v[88:89], v15 offset:0
v_accvgpr_read_b32 v28, a65
v_mfma_f32_16x16x32_bf16 v[192:195], v[68:71], v[100:103], v[192:195]
ds_read_b64_tr_b16 v[90:91], v15 offset:1024
v_accvgpr_read_b32 v21, a66
v_mfma_f32_16x16x32_bf16 v[196:199], v[68:71], v[108:111], v[196:199]
ds_read_b64_tr_b16 v[92:93], v15 offset:8192
v_accvgpr_read_b32 v29, a67
v_mfma_f32_16x16x32_bf16 v[196:199], v[64:67], v[104:107], v[196:199]
s_add_u32 s72, s69, 15360
buffer_load_dwordx4 v5, s[4:7], s72 offen offset:1024 lds
v_mfma_f32_16x16x32_bf16 v[200:203], v[64:67], v[112:115], v[200:203]
ds_read_b64_tr_b16 v[94:95], v15 offset:9216
v_accvgpr_read_b32 v22, a96
v_mfma_f32_16x16x32_bf16 v[200:203], v[68:71], v[116:119], v[200:203]
ds_read_b128 v[44:47], v19 offset:2048
v_accvgpr_read_b32 v30, a97
v_mfma_f32_16x16x32_bf16 v[204:207], v[68:71], v[124:127], v[204:207]
buffer_store_dwordx4 v[24:27], v1, s[44:47], s80 offen sc1
v_mfma_f32_16x16x32_bf16 v[204:207], v[64:67], v[120:123], v[204:207]
s_waitcnt lgkmcnt(11)
ds_read_b128 v[48:51], v18 offset:4096
v_accvgpr_read_b32 v23, a98
v_mfma_f32_16x16x32_bf16 v[220:223], v[72:75], v[120:123], v[220:223]
s_add_u32 s72, s69, 129024
buffer_load_dwordx4 v4, s[4:7], s72 offen offset:2048 lds
v_mfma_f32_16x16x32_bf16 v[220:223], v[76:79], v[124:127], v[220:223]
v_accvgpr_read_b32 v31, a99
v_mul_f32 v20, s79, v20
v_mfma_f32_16x16x32_bf16 v[216:219], v[76:79], v[116:119], v[216:219]
s_waitcnt vmcnt(19) lgkmcnt(2)
ds_read_b128 v[52:55], v19 offset:4096
v_mul_f32 v28, s79, v28
v_mfma_f32_16x16x32_bf16 v[216:219], v[72:75], v[112:115], v[216:219]
s_barrier
ds_read_b128 v[56:59], v18 offset:6144
v_mul_f32 v21, s79, v21
v_mfma_f32_16x16x32_bf16 v[212:215], v[72:75], v[104:107], v[212:215]
ds_read_b64_tr_b16 v[64:65], v8 offset:16384
ds_read_b64_tr_b16 v[66:67], v8 offset:17408
v_mfma_f32_16x16x32_bf16 v[212:215], v[76:79], v[108:111], v[212:215]
ds_read_b64_tr_b16 v[68:69], v8 offset:24576
v_mul_f32 v29, s79, v29
v_mfma_f32_16x16x32_bf16 v[208:211], v[76:79], v[100:103], v[208:211]
s_add_u32 s72, s69, 144384
buffer_load_dwordx4 v5, s[4:7], s72 offen offset:3072 lds
v_mfma_f32_16x16x32_bf16 v[208:211], v[72:75], v[96:99], v[208:211]
ds_read_b64_tr_b16 v[70:71], v8 offset:25600
v_mul_f32 v22, s79, v22
v_mfma_f32_16x16x32_bf16 v[224:227], v[80:83], v[96:99], v[224:227]
ds_read_b64_tr_b16 v[72:73], v9 offset:16384
v_mul_f32 v30, s79, v30
v_mfma_f32_16x16x32_bf16 v[224:227], v[84:87], v[100:103], v[224:227]
ds_read_b64_tr_b16 v[74:75], v9 offset:17408
v_mul_f32 v23, s79, v23
v_mfma_f32_16x16x32_bf16 v[228:231], v[84:87], v[108:111], v[228:231]
s_add_u32 m0, s63, 135168
v_mul_f32 v31, s79, v31
v_cvt_pk_bf16_f32 v20, v20, v28
v_mfma_f32_16x16x32_bf16 v[228:231], v[80:83], v[104:107], v[228:231]
s_add_u32 s72, s70, 0
buffer_load_dwordx4 v4, s[4:7], s72 offen lds
v_mfma_f32_16x16x32_bf16 v[232:235], v[80:83], v[112:115], v[232:235]
ds_read_b64_tr_b16 v[76:77], v9 offset:24576
v_cvt_pk_bf16_f32 v21, v21, v29
v_mfma_f32_16x16x32_bf16 v[232:235], v[84:87], v[116:119], v[232:235]
ds_read_b128 v[60:63], v19 offset:6144
v_cvt_pk_bf16_f32 v22, v22, v30
v_mfma_f32_16x16x32_bf16 v[236:239], v[84:87], v[124:127], v[236:239]
ds_read_b64_tr_b16 v[78:79], v9 offset:25600
v_cvt_pk_bf16_f32 v23, v23, v31
v_mfma_f32_16x16x32_bf16 v[236:239], v[80:83], v[120:123], v[236:239]
s_add_u32 s80, s77, 1024
buffer_store_dwordx4 v[20:23], v1, s[44:47], s80 offen sc1
v_mfma_f32_16x16x32_bf16 v[252:255], v[88:91], v[120:123], v[252:255]
s_add_u32 s72, s70, 15360
buffer_load_dwordx4 v5, s[4:7], s72 offen offset:1024 lds
v_mfma_f32_16x16x32_bf16 v[252:255], v[92:95], v[124:127], v[252:255]
ds_read_b64_tr_b16 v[80:81], v10 offset:16384
v_accvgpr_read_b32 v24, a176
v_mfma_f32_16x16x32_bf16 v[248:251], v[92:95], v[116:119], v[248:251]
ds_read_b64_tr_b16 v[82:83], v10 offset:17408
v_accvgpr_read_b32 v28, a177
v_mfma_f32_16x16x32_bf16 v[248:251], v[88:91], v[112:115], v[248:251]
v_accvgpr_read_b32 v25, a178
v_accvgpr_read_b32 v29, a179
v_mfma_f32_16x16x32_bf16 v[244:247], v[88:91], v[104:107], v[244:247]
ds_read_b64_tr_b16 v[84:85], v10 offset:24576
v_accvgpr_read_b32 v26, a180
v_mfma_f32_16x16x32_bf16 v[244:247], v[92:95], v[108:111], v[244:247]
ds_read_b64_tr_b16 v[86:87], v10 offset:25600
v_accvgpr_read_b32 v30, a181
v_mfma_f32_16x16x32_bf16 v[240:243], v[92:95], v[100:103], v[240:243]
s_add_u32 s72, s70, 129024
buffer_load_dwordx4 v4, s[4:7], s72 offen offset:2048 lds
v_mfma_f32_16x16x32_bf16 v[240:243], v[88:91], v[96:99], v[240:243]
s_waitcnt lgkmcnt(5)
v_accvgpr_read_b32 v27, a182
v_accvgpr_read_b32 v31, a183
v_mfma_f32_16x16x32_bf16 v[128:131], v[64:67], v[32:35], v[128:131]
ds_read_b64_tr_b16 v[88:89], v11 offset:16384
v_cvt_pk_bf16_f32 v24, v24, v28
v_mfma_f32_16x16x32_bf16 v[128:131], v[68:71], v[36:39], v[128:131]
ds_read_b64_tr_b16 v[90:91], v11 offset:17408
v_cvt_pk_bf16_f32 v25, v25, v29
v_mfma_f32_16x16x32_bf16 v[132:135], v[68:71], v[44:47], v[132:135]
v_cvt_pk_bf16_f32 v26, v26, v30
v_cvt_pk_bf16_f32 v27, v27, v31
v_mfma_f32_16x16x32_bf16 v[132:135], v[64:67], v[40:43], v[132:135]
s_add_u32 s72, s70, 144384
buffer_load_dwordx4 v5, s[4:7], s72 offen offset:3072 lds
v_mfma_f32_16x16x32_bf16 v[136:139], v[64:67], v[48:51], v[136:139]
s_add_u32 s80, s78, 33792
ds_read_b64_tr_b16 v[92:93], v11 offset:24576
v_mfma_f32_16x16x32_bf16 v[136:139], v[68:71], v[52:55], v[136:139]
s_lshl_b32 s71, s73, 12
buffer_store_dwordx4 v[24:27], v1, s[44:47], s80 offen sc1
v_mfma_f32_16x16x32_bf16 v[140:143], v[68:71], v[60:63], v[140:143]
s_add_u32 s71, s71, s66
ds_read_b64_tr_b16 v[94:95], v11 offset:25600
v_mfma_f32_16x16x32_bf16 v[140:143], v[64:67], v[56:59], v[140:143]
s_waitcnt lgkmcnt(8)
v_mfma_f32_16x16x32_bf16 v[156:159], v[72:75], v[56:59], v[156:159]
s_add_u32 m0, s64, 0
ds_read_b64_tr_b16 v[64:65], v12 offset:16384
v_mfma_f32_16x16x32_bf16 v[156:159], v[76:79], v[60:63], v[156:159]
s_add_u32 s72, s71, 0
buffer_load_dwordx4 v6, s[12:15], s72 offen lds
v_mfma_f32_16x16x32_bf16 v[152:155], v[76:79], v[52:55], v[152:155]
s_add_u32 s73, s62, 7
ds_read_b64_tr_b16 v[66:67], v12 offset:17408
v_mfma_f32_16x16x32_bf16 v[152:155], v[72:75], v[48:51], v[152:155]
s_add_u32 s70, s73, s65
v_mfma_f32_16x16x32_bf16 v[148:151], v[72:75], v[40:43], v[148:151]
s_and_b32 s70, s70, 3
ds_read_b64_tr_b16 v[68:69], v12 offset:24576
v_accvgpr_read_b32 v20, a68
v_mfma_f32_16x16x32_bf16 v[148:151], v[76:79], v[44:47], v[148:151]
s_and_b32 s73, s73, 12
ds_read_b64_tr_b16 v[70:71], v12 offset:25600
v_accvgpr_read_b32 v28, a69
v_mfma_f32_16x16x32_bf16 v[144:147], v[76:79], v[36:39], v[144:147]
s_add_u32 s72, s71, 31744
buffer_load_dwordx4 v6, s[12:15], s72 offen offset:1024 lds
v_mfma_f32_16x16x32_bf16 v[144:147], v[72:75], v[32:35], v[144:147]
s_waitcnt lgkmcnt(8)
v_accvgpr_read_b32 v21, a70
v_accvgpr_read_b32 v29, a71
v_mfma_f32_16x16x32_bf16 v[160:163], v[80:83], v[32:35], v[160:163]
s_or_b32 s73, s73, s70
ds_read_b64_tr_b16 v[72:73], v13 offset:16384
v_accvgpr_read_b32 v22, a100
v_mfma_f32_16x16x32_bf16 v[160:163], v[84:87], v[36:39], v[160:163]
s_lshl_b32 s73, s73, 7
ds_read_b64_tr_b16 v[74:75], v13 offset:17408
v_accvgpr_read_b32 v30, a101
v_mfma_f32_16x16x32_bf16 v[164:167], v[84:87], v[44:47], v[164:167]
s_add_u32 s69, s73, s67
v_accvgpr_read_b32 v23, a102
v_accvgpr_read_b32 v31, a103
v_mfma_f32_16x16x32_bf16 v[164:167], v[80:83], v[40:43], v[164:167]
s_add_u32 s72, s71, 63488
buffer_load_dwordx4 v7, s[12:15], s72 offen offset:2048 lds
v_mfma_f32_16x16x32_bf16 v[168:171], v[80:83], v[48:51], v[168:171]
s_waitcnt vmcnt(19)
ds_read_b64_tr_b16 v[76:77], v13 offset:24576
v_mul_f32 v20, s79, v20
v_mfma_f32_16x16x32_bf16 v[168:171], v[84:87], v[52:55], v[168:171]
s_add_u32 s70, s73, s68
ds_read_b128 v[96:99], v18 offset:32768
v_mul_f32 v28, s79, v28
v_mfma_f32_16x16x32_bf16 v[172:175], v[84:87], v[60:63], v[172:175]
ds_read_b64_tr_b16 v[78:79], v13 offset:25600
v_mul_f32 v21, s79, v21
v_mfma_f32_16x16x32_bf16 v[172:175], v[80:83], v[56:59], v[172:175]
s_waitcnt lgkmcnt(9)
ds_read_b128 v[100:103], v19 offset:32768
v_mul_f32 v29, s79, v29
v_mfma_f32_16x16x32_bf16 v[188:191], v[88:91], v[56:59], v[188:191]
s_add_u32 s72, s71, 95232
buffer_load_dwordx4 v7, s[12:15], s72 offen offset:3072 lds
v_mfma_f32_16x16x32_bf16 v[188:191], v[92:95], v[60:63], v[188:191]
ds_read_b64_tr_b16 v[80:81], v14 offset:16384
v_mul_f32 v22, s79, v22
v_mfma_f32_16x16x32_bf16 v[184:187], v[92:95], v[52:55], v[184:187]
ds_read_b64_tr_b16 v[82:83], v14 offset:17408
v_mul_f32 v30, s79, v30
v_mfma_f32_16x16x32_bf16 v[184:187], v[88:91], v[48:51], v[184:187]
v_mul_f32 v23, s79, v23
v_mul_f32 v31, s79, v31
v_mfma_f32_16x16x32_bf16 v[180:183], v[88:91], v[40:43], v[180:183]
ds_read_b64_tr_b16 v[84:85], v14 offset:24576
v_cvt_pk_bf16_f32 v20, v20, v28
v_mfma_f32_16x16x32_bf16 v[180:183], v[92:95], v[44:47], v[180:183]
s_add_u32 m0, s63, 65536
ds_read_b64_tr_b16 v[86:87], v14 offset:25600
v_cvt_pk_bf16_f32 v21, v21, v29
v_mfma_f32_16x16x32_bf16 v[176:179], v[92:95], v[36:39], v[176:179]
s_add_u32 s72, s69, 0
buffer_load_dwordx4 v4, s[4:7], s72 offen lds
v_mfma_f32_16x16x32_bf16 v[176:179], v[88:91], v[32:35], v[176:179]
s_waitcnt lgkmcnt(10)
ds_read_b128 v[104:107], v18 offset:34816
v_cvt_pk_bf16_f32 v22, v22, v30
v_mfma_f32_16x16x32_bf16 v[192:195], v[64:67], v[32:35], v[192:195]
ds_read_b64_tr_b16 v[88:89], v15 offset:16384
v_cvt_pk_bf16_f32 v23, v23, v31
v_mfma_f32_16x16x32_bf16 v[192:195], v[68:71], v[36:39], v[192:195]
s_add_u32 s80, s77, 5120
ds_read_b64_tr_b16 v[90:91], v15 offset:17408
v_mfma_f32_16x16x32_bf16 v[196:199], v[68:71], v[44:47], v[196:199]
ds_read_b64_tr_b16 v[92:93], v15 offset:24576
v_accvgpr_read_b32 v24, a184
v_mfma_f32_16x16x32_bf16 v[196:199], v[64:67], v[40:43], v[196:199]
s_add_u32 s72, s69, 15360
buffer_load_dwordx4 v5, s[4:7], s72 offen offset:1024 lds
v_mfma_f32_16x16x32_bf16 v[200:203], v[64:67], v[48:51], v[200:203]
ds_read_b64_tr_b16 v[94:95], v15 offset:25600
v_accvgpr_read_b32 v28, a185
v_mfma_f32_16x16x32_bf16 v[200:203], v[68:71], v[52:55], v[200:203]
ds_read_b128 v[108:111], v19 offset:34816
v_accvgpr_read_b32 v25, a186
v_mfma_f32_16x16x32_bf16 v[204:207], v[68:71], v[60:63], v[204:207]
buffer_store_dwordx4 v[20:23], v1, s[44:47], s80 offen sc1
v_mfma_f32_16x16x32_bf16 v[204:207], v[64:67], v[56:59], v[204:207]
s_waitcnt lgkmcnt(11)
ds_read_b128 v[112:115], v18 offset:36864
v_accvgpr_read_b32 v29, a187
v_mfma_f32_16x16x32_bf16 v[220:223], v[72:75], v[56:59], v[220:223]
s_add_u32 s72, s69, 129024
buffer_load_dwordx4 v4, s[4:7], s72 offen offset:2048 lds
v_mfma_f32_16x16x32_bf16 v[220:223], v[76:79], v[60:63], v[220:223]
v_accvgpr_read_b32 v26, a188
v_accvgpr_read_b32 v30, a189
v_mfma_f32_16x16x32_bf16 v[216:219], v[76:79], v[52:55], v[216:219]
s_waitcnt vmcnt(20) lgkmcnt(2)
ds_read_b128 v[116:119], v19 offset:36864
v_accvgpr_read_b32 v27, a190
v_mfma_f32_16x16x32_bf16 v[216:219], v[72:75], v[48:51], v[216:219]
s_barrier
ds_read_b128 v[120:123], v18 offset:38912
v_accvgpr_read_b32 v31, a191
v_mfma_f32_16x16x32_bf16 v[212:215], v[72:75], v[40:43], v[212:215]
ds_read_b64_tr_b16 v[64:65], v8 offset:32768
ds_read_b64_tr_b16 v[66:67], v8 offset:33792
v_mfma_f32_16x16x32_bf16 v[212:215], v[76:79], v[44:47], v[212:215]
ds_read_b64_tr_b16 v[68:69], v8 offset:40960
v_cvt_pk_bf16_f32 v24, v24, v28
v_mfma_f32_16x16x32_bf16 v[208:211], v[76:79], v[36:39], v[208:211]
s_add_u32 s72, s69, 144384
buffer_load_dwordx4 v5, s[4:7], s72 offen offset:3072 lds
v_mfma_f32_16x16x32_bf16 v[208:211], v[72:75], v[32:35], v[208:211]
ds_read_b64_tr_b16 v[70:71], v8 offset:41984
v_cvt_pk_bf16_f32 v25, v25, v29
v_mfma_f32_16x16x32_bf16 v[224:227], v[80:83], v[32:35], v[224:227]
ds_read_b64_tr_b16 v[72:73], v9 offset:32768
v_cvt_pk_bf16_f32 v26, v26, v30
v_mfma_f32_16x16x32_bf16 v[224:227], v[84:87], v[36:39], v[224:227]
ds_read_b64_tr_b16 v[74:75], v9 offset:33792
v_cvt_pk_bf16_f32 v27, v27, v31
v_mfma_f32_16x16x32_bf16 v[228:231], v[84:87], v[44:47], v[228:231]
s_add_u32 m0, s63, 69632
v_mfma_f32_16x16x32_bf16 v[228:231], v[80:83], v[40:43], v[228:231]
s_add_u32 s72, s70, 0
buffer_load_dwordx4 v4, s[4:7], s72 offen lds
v_mfma_f32_16x16x32_bf16 v[232:235], v[80:83], v[48:51], v[232:235]
s_add_u32 s80, s78, 41984
ds_read_b64_tr_b16 v[76:77], v9 offset:40960
v_mfma_f32_16x16x32_bf16 v[232:235], v[84:87], v[52:55], v[232:235]
ds_read_b128 v[124:127], v19 offset:38912
v_mfma_f32_16x16x32_bf16 v[236:239], v[84:87], v[60:63], v[236:239]
ds_read_b64_tr_b16 v[78:79], v9 offset:41984
v_mfma_f32_16x16x32_bf16 v[236:239], v[80:83], v[56:59], v[236:239]
buffer_store_dwordx4 v[24:27], v1, s[44:47], s80 offen sc1
v_mfma_f32_16x16x32_bf16 v[252:255], v[88:91], v[56:59], v[252:255]
s_add_u32 s72, s70, 15360
buffer_load_dwordx4 v5, s[4:7], s72 offen offset:1024 lds
v_mfma_f32_16x16x32_bf16 v[252:255], v[92:95], v[60:63], v[252:255]
ds_read_b64_tr_b16 v[80:81], v10 offset:32768
v_accvgpr_read_b32 v20, a72
v_mfma_f32_16x16x32_bf16 v[248:251], v[92:95], v[52:55], v[248:251]
ds_read_b64_tr_b16 v[82:83], v10 offset:33792
v_accvgpr_read_b32 v28, a73
v_mfma_f32_16x16x32_bf16 v[248:251], v[88:91], v[48:51], v[248:251]
v_accvgpr_read_b32 v21, a74
v_accvgpr_read_b32 v29, a75
v_mfma_f32_16x16x32_bf16 v[244:247], v[88:91], v[40:43], v[244:247]
ds_read_b64_tr_b16 v[84:85], v10 offset:40960
v_accvgpr_read_b32 v22, a104
v_mfma_f32_16x16x32_bf16 v[244:247], v[92:95], v[44:47], v[244:247]
ds_read_b64_tr_b16 v[86:87], v10 offset:41984
v_accvgpr_read_b32 v30, a105
v_mfma_f32_16x16x32_bf16 v[240:243], v[92:95], v[36:39], v[240:243]
s_add_u32 s72, s70, 129024
buffer_load_dwordx4 v4, s[4:7], s72 offen offset:2048 lds
v_mfma_f32_16x16x32_bf16 v[240:243], v[88:91], v[32:35], v[240:243]
s_waitcnt lgkmcnt(5)
v_accvgpr_read_b32 v23, a106
v_accvgpr_read_b32 v31, a107
v_mfma_f32_16x16x32_bf16 v[128:131], v[64:67], v[96:99], v[128:131]
s_lshr_b32 s75, s93, 4
ds_read_b64_tr_b16 v[88:89], v11 offset:32768
v_mul_f32 v20, s79, v20
v_mfma_f32_16x16x32_bf16 v[128:131], v[68:71], v[100:103], v[128:131]
s_and_b32 s75, s75, 0x7f00
ds_read_b64_tr_b16 v[90:91], v11 offset:33792
v_mul_f32 v28, s79, v28
v_mfma_f32_16x16x32_bf16 v[132:135], v[68:71], v[108:111], v[132:135]
s_add_u32 s75, s75, LcB1-Lpc0
v_lshrrev_b32 v2, 5, v0
v_lshlrev_b32 v2, 7, v2
v_mfma_f32_16x16x32_bf16 v[132:135], v[64:67], v[104:107], v[132:135]
s_add_u32 s72, s70, 144384
buffer_load_dwordx4 v5, s[4:7], s72 offen offset:3072 lds
v_mfma_f32_16x16x32_bf16 v[136:139], v[64:67], v[112:115], v[136:139]
v_add_u32 v2, s75, v2
v_min_u32 v2, Lcode_end-Lpc0, v2
v_mfma_f32_16x16x32_bf16 v[136:139], v[68:71], v[116:119], v[136:139]
s_lshl_b32 s71, s73, 12
global_load_dword v3, v2, s[98:99]
v_mfma_f32_16x16x32_bf16 v[140:143], v[68:71], v[124:127], v[140:143]
s_add_u32 s71, s71, s66
ds_read_b64_tr_b16 v[92:93], v11 offset:40960
v_mul_f32 v21, s79, v21
v_mfma_f32_16x16x32_bf16 v[140:143], v[64:67], v[120:123], v[140:143]
s_waitcnt lgkmcnt(7)
ds_read_b64_tr_b16 v[94:95], v11 offset:41984
v_mul_f32 v29, s79, v29
v_mfma_f32_16x16x32_bf16 v[156:159], v[72:75], v[120:123], v[156:159]
s_add_u32 m0, s64, 16384
ds_read_b64_tr_b16 v[64:65], v12 offset:32768
v_mul_f32 v22, s79, v22
v_mfma_f32_16x16x32_bf16 v[156:159], v[76:79], v[124:127], v[156:159]
s_add_u32 s72, s71, 0
buffer_load_dwordx4 v6, s[12:15], s72 offen lds
v_mfma_f32_16x16x32_bf16 v[152:155], v[76:79], v[116:119], v[152:155]
s_add_u32 s73, s62, 8
ds_read_b64_tr_b16 v[66:67], v12 offset:33792
v_mul_f32 v30, s79, v30
v_mfma_f32_16x16x32_bf16 v[152:155], v[72:75], v[112:115], v[152:155]
s_add_u32 s70, s73, s65
v_mul_f32 v23, s79, v23
v_mul_f32 v31, s79, v31
v_mfma_f32_16x16x32_bf16 v[148:151], v[72:75], v[104:107], v[148:151]
s_and_b32 s70, s70, 3
ds_read_b64_tr_b16 v[68:69], v12 offset:40960
v_cvt_pk_bf16_f32 v20, v20, v28
v_mfma_f32_16x16x32_bf16 v[148:151], v[76:79], v[108:111], v[148:151]
s_and_b32 s73, s73, 12
ds_read_b64_tr_b16 v[70:71], v12 offset:41984
v_cvt_pk_bf16_f32 v21, v21, v29
v_mfma_f32_16x16x32_bf16 v[144:147], v[76:79], v[100:103], v[144:147]
s_add_u32 s72, s71, 31744
buffer_load_dwordx4 v6, s[12:15], s72 offen offset:1024 lds
v_mfma_f32_16x16x32_bf16 v[144:147], v[72:75], v[96:99], v[144:147]
s_waitcnt lgkmcnt(8)
v_cvt_pk_bf16_f32 v22, v22, v30
v_cvt_pk_bf16_f32 v23, v23, v31
v_mfma_f32_16x16x32_bf16 v[160:163], v[80:83], v[96:99], v[160:163]
s_or_b32 s73, s73, s70
ds_read_b64_tr_b16 v[72:73], v13 offset:32768
v_accvgpr_read_b32 v24, a192
v_mfma_f32_16x16x32_bf16 v[160:163], v[84:87], v[100:103], v[160:163]
s_lshl_b32 s73, s73, 7
ds_read_b64_tr_b16 v[74:75], v13 offset:33792
v_accvgpr_read_b32 v28, a193
v_mfma_f32_16x16x32_bf16 v[164:167], v[84:87], v[108:111], v[164:167]
s_add_u32 s69, s73, s67
v_accvgpr_read_b32 v25, a194
v_accvgpr_read_b32 v29, a195
v_mfma_f32_16x16x32_bf16 v[164:167], v[80:83], v[104:107], v[164:167]
s_add_u32 s72, s71, 63488
buffer_load_dwordx4 v7, s[12:15], s72 offen offset:2048 lds
v_mfma_f32_16x16x32_bf16 v[168:171], v[80:83], v[112:115], v[168:171]
s_waitcnt vmcnt(19)
ds_read_b64_tr_b16 v[76:77], v13 offset:40960
v_accvgpr_read_b32 v26, a196
v_mfma_f32_16x16x32_bf16 v[168:171], v[84:87], v[116:119], v[168:171]
s_add_u32 s70, s73, s68
ds_read_b128 v[32:35], v16 offset:0
v_accvgpr_read_b32 v30, a197
v_mfma_f32_16x16x32_bf16 v[172:175], v[84:87], v[124:127], v[172:175]
s_add_u32 s80, s77, 9216
ds_read_b64_tr_b16 v[78:79], v13 offset:41984
v_accvgpr_read_b32 v27, a198
v_mfma_f32_16x16x32_bf16 v[172:175], v[80:83], v[120:123], v[172:175]
s_waitcnt lgkmcnt(9)
ds_read_b128 v[36:39], v17 offset:0
v_accvgpr_read_b32 v31, a199
v_mfma_f32_16x16x32_bf16 v[188:191], v[88:91], v[120:123], v[188:191]
s_add_u32 s72, s71, 95232
buffer_load_dwordx4 v7, s[12:15], s72 offen offset:3072 lds
v_mfma_f32_16x16x32_bf16 v[188:191], v[92:95], v[124:127], v[188:191]
ds_read_b64_tr_b16 v[80:81], v14 offset:32768
v_cvt_pk_bf16_f32 v24, v24, v28
v_mfma_f32_16x16x32_bf16 v[184:187], v[92:95], v[116:119], v[184:187]
ds_read_b64_tr_b16 v[82:83], v14 offset:33792
v_cvt_pk_bf16_f32 v25, v25, v29
v_mfma_f32_16x16x32_bf16 v[184:187], v[88:91], v[112:115], v[184:187]
buffer_store_dwordx4 v[20:23], v1, s[44:47], s80 offen sc1
v_mfma_f32_16x16x32_bf16 v[180:183], v[88:91], v[104:107], v[180:183]
ds_read_b64_tr_b16 v[84:85], v14 offset:40960
v_cvt_pk_bf16_f32 v26, v26, v30
v_mfma_f32_16x16x32_bf16 v[180:183], v[92:95], v[108:111], v[180:183]
s_add_u32 m0, s63, 98304
ds_read_b64_tr_b16 v[86:87], v14 offset:41984
v_cvt_pk_bf16_f32 v27, v27, v31
v_mfma_f32_16x16x32_bf16 v[176:179], v[92:95], v[100:103], v[176:179]
s_add_u32 s72, s69, 0
buffer_load_dwordx4 v4, s[4:7], s72 offen lds
v_mfma_f32_16x16x32_bf16 v[176:179], v[88:91], v[96:99], v[176:179]
s_waitcnt lgkmcnt(10)
ds_read_b128 v[40:43], v16 offset:2048
v_mfma_f32_16x16x32_bf16 v[192:195], v[64:67], v[96:99], v[192:195]
s_add_u32 s80, s78, 2048
ds_read_b64_tr_b16 v[88:89], v15 offset:32768
v_mfma_f32_16x16x32_bf16 v[192:195], v[68:71], v[100:103], v[192:195]
ds_read_b64_tr_b16 v[90:91], v15 offset:33792
v_mfma_f32_16x16x32_bf16 v[196:199], v[68:71], v[108:111], v[196:199]
ds_read_b64_tr_b16 v[92:93], v15 offset:40960
v_mfma_f32_16x16x32_bf16 v[196:199], v[64:67], v[104:107], v[196:199]
s_add_u32 s72, s69, 15360
buffer_load_dwordx4 v5, s[4:7], s72 offen offset:1024 lds
v_mfma_f32_16x16x32_bf16 v[200:203], v[64:67], v[112:115], v[200:203]
ds_read_b64_tr_b16 v[94:95], v15 offset:41984
v_accvgpr_read_b32 v20, a76
v_mfma_f32_16x16x32_bf16 v[200:203], v[68:71], v[116:119], v[200:203]
ds_read_b128 v[44:47], v17 offset:2048
v_accvgpr_read_b32 v28, a77
v_mfma_f32_16x16x32_bf16 v[204:207], v[68:71], v[124:127], v[204:207]
buffer_store_dwordx4 v[24:27], v1, s[44:47], s80 offen sc1
v_mfma_f32_16x16x32_bf16 v[204:207], v[64:67], v[120:123], v[204:207]
s_waitcnt lgkmcnt(11)
ds_read_b128 v[48:51], v16 offset:4096
v_accvgpr_read_b32 v21, a78
v_mfma_f32_16x16x32_bf16 v[220:223], v[72:75], v[120:123], v[220:223]
s_add_u32 s72, s69, 129024
buffer_load_dwordx4 v4, s[4:7], s72 offen offset:2048 lds
v_mfma_f32_16x16x32_bf16 v[220:223], v[76:79], v[124:127], v[220:223]
v_accvgpr_read_b32 v29, a79
v_accvgpr_read_b32 v22, a108
v_mfma_f32_16x16x32_bf16 v[216:219], v[76:79], v[116:119], v[216:219]
s_waitcnt vmcnt(20) lgkmcnt(2)
ds_read_b128 v[52:55], v17 offset:4096
v_accvgpr_read_b32 v30, a109
v_mfma_f32_16x16x32_bf16 v[216:219], v[72:75], v[112:115], v[216:219]
s_barrier
ds_read_b128 v[56:59], v16 offset:6144
v_accvgpr_read_b32 v23, a110
v_mfma_f32_16x16x32_bf16 v[212:215], v[72:75], v[104:107], v[212:215]
ds_read_b64_tr_b16 v[64:65], v8 offset:0
ds_read_b64_tr_b16 v[66:67], v8 offset:1024
v_mfma_f32_16x16x32_bf16 v[212:215], v[76:79], v[108:111], v[212:215]
ds_read_b64_tr_b16 v[68:69], v8 offset:8192
v_accvgpr_read_b32 v31, a111
v_mfma_f32_16x16x32_bf16 v[208:211], v[76:79], v[100:103], v[208:211]
s_add_u32 s72, s69, 144384
buffer_load_dwordx4 v5, s[4:7], s72 offen offset:3072 lds
v_mfma_f32_16x16x32_bf16 v[208:211], v[72:75], v[96:99], v[208:211]
ds_read_b64_tr_b16 v[70:71], v8 offset:9216
v_mul_f32 v20, s79, v20
v_mfma_f32_16x16x32_bf16 v[224:227], v[80:83], v[96:99], v[224:227]
ds_read_b64_tr_b16 v[72:73], v9 offset:0
v_mul_f32 v28, s79, v28
v_mfma_f32_16x16x32_bf16 v[224:227], v[84:87], v[100:103], v[224:227]
ds_read_b64_tr_b16 v[74:75], v9 offset:1024
v_mul_f32 v21, s79, v21
v_mfma_f32_16x16x32_bf16 v[228:231], v[84:87], v[108:111], v[228:231]
s_add_u32 m0, s63, 102400
v_mul_f32 v29, s79, v29
v_mul_f32 v22, s79, v22
v_mfma_f32_16x16x32_bf16 v[228:231], v[80:83], v[104:107], v[228:231]
s_add_u32 s72, s70, 0
buffer_load_dwordx4 v4, s[4:7], s72 offen lds
v_mfma_f32_16x16x32_bf16 v[232:235], v[80:83], v[112:115], v[232:235]
ds_read_b64_tr_b16 v[76:77], v9 offset:8192
v_mul_f32 v30, s79, v30
v_mfma_f32_16x16x32_bf16 v[232:235], v[84:87], v[116:119], v[232:235]
ds_read_b128 v[60:63], v17 offset:6144
v_mul_f32 v23, s79, v23
v_mfma_f32_16x16x32_bf16 v[236:239], v[84:87], v[124:127], v[236:239]
ds_read_b64_tr_b16 v[78:79], v9 offset:9216
v_mul_f32 v31, s79, v31
v_mfma_f32_16x16x32_bf16 v[236:239], v[80:83], v[120:123], v[236:239]
v_cvt_pk_bf16_f32 v20, v20, v28
v_cvt_pk_bf16_f32 v21, v21, v29
v_mfma_f32_16x16x32_bf16 v[252:255], v[88:91], v[120:123], v[252:255]
s_add_u32 s72, s70, 15360
buffer_load_dwordx4 v5, s[4:7], s72 offen offset:1024 lds
v_mfma_f32_16x16x32_bf16 v[252:255], v[92:95], v[124:127], v[252:255]
ds_read_b64_tr_b16 v[80:81], v10 offset:0
v_cvt_pk_bf16_f32 v22, v22, v30
v_mfma_f32_16x16x32_bf16 v[248:251], v[92:95], v[116:119], v[248:251]
ds_read_b64_tr_b16 v[82:83], v10 offset:1024
v_cvt_pk_bf16_f32 v23, v23, v31
v_mfma_f32_16x16x32_bf16 v[248:251], v[88:91], v[112:115], v[248:251]
s_add_u32 s80, s77, 13312
buffer_store_dwordx4 v[20:23], v1, s[44:47], s80 offen sc1
v_mfma_f32_16x16x32_bf16 v[244:247], v[88:91], v[104:107], v[244:247]
ds_read_b64_tr_b16 v[84:85], v10 offset:8192
v_accvgpr_read_b32 v24, a200
v_mfma_f32_16x16x32_bf16 v[244:247], v[92:95], v[108:111], v[244:247]
ds_read_b64_tr_b16 v[86:87], v10 offset:9216
v_accvgpr_read_b32 v28, a201
v_mfma_f32_16x16x32_bf16 v[240:243], v[92:95], v[100:103], v[240:243]
s_add_u32 s72, s70, 129024
buffer_load_dwordx4 v4, s[4:7], s72 offen offset:2048 lds
v_mfma_f32_16x16x32_bf16 v[240:243], v[88:91], v[96:99], v[240:243]
s_waitcnt lgkmcnt(5)
v_accvgpr_read_b32 v25, a202
v_accvgpr_read_b32 v29, a203
v_mfma_f32_16x16x32_bf16 v[128:131], v[64:67], v[32:35], v[128:131]
ds_read_b64_tr_b16 v[88:89], v11 offset:0
v_accvgpr_read_b32 v26, a204
v_mfma_f32_16x16x32_bf16 v[128:131], v[68:71], v[36:39], v[128:131]
ds_read_b64_tr_b16 v[90:91], v11 offset:1024
v_accvgpr_read_b32 v30, a205
v_mfma_f32_16x16x32_bf16 v[132:135], v[68:71], v[44:47], v[132:135]
v_accvgpr_read_b32 v27, a206
v_accvgpr_read_b32 v31, a207
v_mfma_f32_16x16x32_bf16 v[132:135], v[64:67], v[40:43], v[132:135]
s_add_u32 s72, s70, 144384
buffer_load_dwordx4 v5, s[4:7], s72 offen offset:3072 lds
v_mfma_f32_16x16x32_bf16 v[136:139], v[64:67], v[48:51], v[136:139]
ds_read_b64_tr_b16 v[92:93], v11 offset:8192
v_cvt_pk_bf16_f32 v24, v24, v28
v_mfma_f32_16x16x32_bf16 v[136:139], v[68:71], v[52:55], v[136:139]
s_lshl_b32 s71, s73, 12
v_cvt_pk_bf16_f32 v25, v25, v29
v_cvt_pk_bf16_f32 v26, v26, v30
v_mfma_f32_16x16x32_bf16 v[140:143], v[68:71], v[60:63], v[140:143]
s_add_u32 s71, s71, s66
ds_read_b64_tr_b16 v[94:95], v11 offset:9216
v_cvt_pk_bf16_f32 v27, v27, v31
v_mfma_f32_16x16x32_bf16 v[140:143], v[64:67], v[56:59], v[140:143]
s_waitcnt lgkmcnt(8)
v_mfma_f32_16x16x32_bf16 v[156:159], v[72:75], v[56:59], v[156:159]
s_add_u32 m0, s64, 32768
ds_read_b64_tr_b16 v[64:65], v12 offset:0
v_mfma_f32_16x16x32_bf16 v[156:159], v[76:79], v[60:63], v[156:159]
s_add_u32 s72, s71, 0
buffer_load_dwordx4 v6, s[12:15], s72 offen lds
v_mfma_f32_16x16x32_bf16 v[152:155], v[76:79], v[52:55], v[152:155]
s_add_u32 s73, s62, 9
ds_read_b64_tr_b16 v[66:67], v12 offset:1024
v_mfma_f32_16x16x32_bf16 v[152:155], v[72:75], v[48:51], v[152:155]
s_add_u32 s70, s73, s65
v_mfma_f32_16x16x32_bf16 v[148:151], v[72:75], v[40:43], v[148:151]
s_and_b32 s70, s70, 3
ds_read_b64_tr_b16 v[68:69], v12 offset:8192
v_mfma_f32_16x16x32_bf16 v[148:151], v[76:79], v[44:47], v[148:151]
s_and_b32 s73, s73, 12
ds_read_b64_tr_b16 v[70:71], v12 offset:9216
v_mfma_f32_16x16x32_bf16 v[144:147], v[76:79], v[36:39], v[144:147]
s_add_u32 s72, s71, 31744
buffer_load_dwordx4 v6, s[12:15], s72 offen offset:1024 lds
v_mfma_f32_16x16x32_bf16 v[144:147], v[72:75], v[32:35], v[144:147]
s_waitcnt lgkmcnt(8)
v_mfma_f32_16x16x32_bf16 v[160:163], v[80:83], v[32:35], v[160:163]
s_or_b32 s73, s73, s70
ds_read_b64_tr_b16 v[72:73], v13 offset:0
v_accvgpr_read_b32 v20, a80
v_mfma_f32_16x16x32_bf16 v[160:163], v[84:87], v[36:39], v[160:163]
s_lshl_b32 s73, s73, 7
ds_read_b64_tr_b16 v[74:75], v13 offset:1024
v_accvgpr_read_b32 v28, a81
v_mfma_f32_16x16x32_bf16 v[164:167], v[84:87], v[44:47], v[164:167]
s_add_u32 s69, s73, s67
v_accvgpr_read_b32 v21, a82
v_accvgpr_read_b32 v29, a83
v_mfma_f32_16x16x32_bf16 v[164:167], v[80:83], v[40:43], v[164:167]
s_add_u32 s72, s71, 63488
buffer_load_dwordx4 v7, s[12:15], s72 offen offset:2048 lds
v_mfma_f32_16x16x32_bf16 v[168:171], v[80:83], v[48:51], v[168:171]
s_waitcnt vmcnt(19)
ds_read_b64_tr_b16 v[76:77], v13 offset:8192
v_accvgpr_read_b32 v22, a112
v_mfma_f32_16x16x32_bf16 v[168:171], v[84:87], v[52:55], v[168:171]
s_add_u32 s70, s73, s68
ds_read_b128 v[96:99], v18 offset:0
v_accvgpr_read_b32 v30, a113
v_mfma_f32_16x16x32_bf16 v[172:175], v[84:87], v[60:63], v[172:175]
s_add_u32 s80, s78, 10240
ds_read_b64_tr_b16 v[78:79], v13 offset:9216
v_accvgpr_read_b32 v23, a114
v_mfma_f32_16x16x32_bf16 v[172:175], v[80:83], v[56:59], v[172:175]
s_waitcnt lgkmcnt(9)
ds_read_b128 v[100:103], v19 offset:0
v_accvgpr_read_b32 v31, a115
v_mfma_f32_16x16x32_bf16 v[188:191], v[88:91], v[56:59], v[188:191]
s_add_u32 s72, s71, 95232
buffer_load_dwordx4 v7, s[12:15], s72 offen offset:3072 lds
v_mfma_f32_16x16x32_bf16 v[188:191], v[92:95], v[60:63], v[188:191]
ds_read_b64_tr_b16 v[80:81], v14 offset:0
v_mul_f32 v20, s79, v20
v_mfma_f32_16x16x32_bf16 v[184:187], v[92:95], v[52:55], v[184:187]
ds_read_b64_tr_b16 v[82:83], v14 offset:1024
v_mul_f32 v28, s79, v28
v_mfma_f32_16x16x32_bf16 v[184:187], v[88:91], v[48:51], v[184:187]
buffer_store_dwordx4 v[24:27], v1, s[44:47], s80 offen sc1
v_mfma_f32_16x16x32_bf16 v[180:183], v[88:91], v[40:43], v[180:183]
ds_read_b64_tr_b16 v[84:85], v14 offset:8192
v_mul_f32 v21, s79, v21
v_mfma_f32_16x16x32_bf16 v[180:183], v[92:95], v[44:47], v[180:183]
s_add_u32 m0, s63, 131072
ds_read_b64_tr_b16 v[86:87], v14 offset:9216
v_mul_f32 v29, s79, v29
v_mfma_f32_16x16x32_bf16 v[176:179], v[92:95], v[36:39], v[176:179]
s_add_u32 s72, s69, 0
buffer_load_dwordx4 v4, s[4:7], s72 offen lds
v_mfma_f32_16x16x32_bf16 v[176:179], v[88:91], v[32:35], v[176:179]
s_waitcnt lgkmcnt(10)
ds_read_b128 v[104:107], v18 offset:2048
v_mul_f32 v22, s79, v22
v_mfma_f32_16x16x32_bf16 v[192:195], v[64:67], v[32:35], v[192:195]
ds_read_b64_tr_b16 v[88:89], v15 offset:0
v_mul_f32 v30, s79, v30
v_mfma_f32_16x16x32_bf16 v[192:195], v[68:71], v[36:39], v[192:195]
ds_read_b64_tr_b16 v[90:91], v15 offset:1024
v_mul_f32 v23, s79, v23
v_mfma_f32_16x16x32_bf16 v[196:199], v[68:71], v[44:47], v[196:199]
ds_read_b64_tr_b16 v[92:93], v15 offset:8192
v_mul_f32 v31, s79, v31
v_mfma_f32_16x16x32_bf16 v[196:199], v[64:67], v[40:43], v[196:199]
s_add_u32 s72, s69, 15360
buffer_load_dwordx4 v5, s[4:7], s72 offen offset:1024 lds
v_mfma_f32_16x16x32_bf16 v[200:203], v[64:67], v[48:51], v[200:203]
ds_read_b64_tr_b16 v[94:95], v15 offset:9216
v_cvt_pk_bf16_f32 v20, v20, v28
v_mfma_f32_16x16x32_bf16 v[200:203], v[68:71], v[52:55], v[200:203]
ds_read_b128 v[108:111], v19 offset:2048
v_cvt_pk_bf16_f32 v21, v21, v29
v_mfma_f32_16x16x32_bf16 v[204:207], v[68:71], v[60:63], v[204:207]
v_cvt_pk_bf16_f32 v22, v22, v30
v_cvt_pk_bf16_f32 v23, v23, v31
v_mfma_f32_16x16x32_bf16 v[204:207], v[64:67], v[56:59], v[204:207]
s_waitcnt lgkmcnt(11)
ds_read_b128 v[112:115], v18 offset:4096
v_accvgpr_read_b32 v24, a208
v_mfma_f32_16x16x32_bf16 v[220:223], v[72:75], v[56:59], v[220:223]
s_add_u32 s72, s69, 129024
buffer_load_dwordx4 v4, s[4:7], s72 offen offset:2048 lds
v_mfma_f32_16x16x32_bf16 v[220:223], v[76:79], v[60:63], v[220:223]
s_add_u32 s80, s77, 33792
s_nop 3
s_mov_b64 exec, 0
s_cmp_eq_u32 s58, 0
s_cbranch_scc1 Lstub0
s_cmp_eq_u32 s58, 1
s_cbranch_scc1 Lstub1
s_cmp_eq_u32 s58, 2
s_cbranch_scc1 Lstub2
s_branch Lstub3
Lret:
s_mov_b64 exec, -1
s_nop 3
v_mfma_f32_16x16x32_bf16 v[216:219], v[76:79], v[52:55], v[216:219]
s_waitcnt vmcnt(19) lgkmcnt(2)
ds_read_b128 v[116:119], v19 offset:4096
v_accvgpr_read_b32 v28, a209
v_mfma_f32_16x16x32_bf16 v[216:219], v[72:75], v[48:51], v[216:219]
s_barrier
buffer_store_dwordx4 v[20:23], v1, s[44:47], s80 offen sc1
v_mfma_f32_16x16x32_bf16 v[212:215], v[72:75], v[40:43], v[212:215]
ds_read_b64_tr_b16 v[64:65], v8 offset:16384
ds_read_b64_tr_b16 v[66:67], v8 offset:17408
v_mfma_f32_16x16x32_bf16 v[212:215], v[76:79], v[44:47], v[212:215]
ds_read_b64_tr_b16 v[68:69], v8 offset:24576
v_accvgpr_read_b32 v25, a210
v_mfma_f32_16x16x32_bf16 v[208:211], v[76:79], v[36:39], v[208:211]
s_add_u32 s72, s69, 144384
buffer_load_dwordx4 v5, s[4:7], s72 offen offset:3072 lds
v_mfma_f32_16x16x32_bf16 v[208:211], v[72:75], v[32:35], v[208:211]
ds_read_b64_tr_b16 v[70:71], v8 offset:25600
v_accvgpr_read_b32 v29, a211
v_mfma_f32_16x16x32_bf16 v[224:227], v[80:83], v[32:35], v[224:227]
ds_read_b64_tr_b16 v[72:73], v9 offset:16384
v_accvgpr_read_b32 v26, a212
v_mfma_f32_16x16x32_bf16 v[224:227], v[84:87], v[36:39], v[224:227]
ds_read_b64_tr_b16 v[74:75], v9 offset:17408
v_accvgpr_read_b32 v30, a213
v_mfma_f32_16x16x32_bf16 v[228:231], v[84:87], v[44:47], v[228:231]
s_add_u32 m0, s63, 135168
ds_read_b128 v[120:123], v18 offset:6144
v_accvgpr_read_b32 v27, a214
v_mfma_f32_16x16x32_bf16 v[228:231], v[80:83], v[40:43], v[228:231]
s_add_u32 s72, s70, 0
buffer_load_dwordx4 v4, s[4:7], s72 offen lds
v_mfma_f32_16x16x32_bf16 v[232:235], v[80:83], v[48:51], v[232:235]
ds_read_b64_tr_b16 v[76:77], v9 offset:24576
v_accvgpr_read_b32 v31, a215
v_mfma_f32_16x16x32_bf16 v[232:235], v[84:87], v[52:55], v[232:235]
ds_read_b128 v[124:127], v19 offset:6144
v_cvt_pk_bf16_f32 v24, v24, v28
v_mfma_f32_16x16x32_bf16 v[236:239], v[84:87], v[60:63], v[236:239]
ds_read_b64_tr_b16 v[78:79], v9 offset:25600
v_cvt_pk_bf16_f32 v25, v25, v29
v_mfma_f32_16x16x32_bf16 v[236:239], v[80:83], v[56:59], v[236:239]
v_cvt_pk_bf16_f32 v26, v26, v30
v_cvt_pk_bf16_f32 v27, v27, v31
v_mfma_f32_16x16x32_bf16 v[252:255], v[88:91], v[56:59], v[252:255]
s_add_u32 s72, s70, 15360
buffer_load_dwordx4 v5, s[4:7], s72 offen offset:1024 lds
v_mfma_f32_16x16x32_bf16 v[252:255], v[92:95], v[60:63], v[252:255]
s_add_u32 s80, s78, 34816
ds_read_b64_tr_b16 v[80:81], v10 offset:16384
v_mfma_f32_16x16x32_bf16 v[248:251], v[92:95], v[52:55], v[248:251]
ds_read_b64_tr_b16 v[82:83], v10 offset:17408
v_mfma_f32_16x16x32_bf16 v[248:251], v[88:91], v[48:51], v[248:251]
buffer_store_dwordx4 v[24:27], v1, s[44:47], s80 offen sc1
v_mfma_f32_16x16x32_bf16 v[244:247], v[88:91], v[40:43], v[244:247]
ds_read_b64_tr_b16 v[84:85], v10 offset:24576
v_mfma_f32_16x16x32_bf16 v[244:247], v[92:95], v[44:47], v[244:247]
ds_read_b64_tr_b16 v[86:87], v10 offset:25600
v_accvgpr_read_b32 v20, a84
v_mfma_f32_16x16x32_bf16 v[240:243], v[92:95], v[36:39], v[240:243]
s_add_u32 s72, s70, 129024
buffer_load_dwordx4 v4, s[4:7], s72 offen offset:2048 lds
v_mfma_f32_16x16x32_bf16 v[240:243], v[88:91], v[32:35], v[240:243]
s_waitcnt lgkmcnt(5)
v_accvgpr_read_b32 v28, a85
v_accvgpr_read_b32 v21, a86
v_mfma_f32_16x16x32_bf16 v[128:131], v[64:67], v[96:99], v[128:131]
ds_read_b64_tr_b16 v[88:89], v11 offset:16384
v_accvgpr_read_b32 v29, a87
v_mfma_f32_16x16x32_bf16 v[128:131], v[68:71], v[100:103], v[128:131]
ds_read_b64_tr_b16 v[90:91], v11 offset:17408
v_accvgpr_read_b32 v22, a116
v_mfma_f32_16x16x32_bf16 v[132:135], v[68:71], v[108:111], v[132:135]
v_accvgpr_read_b32 v30, a117
v_accvgpr_read_b32 v23, a118
v_mfma_f32_16x16x32_bf16 v[132:135], v[64:67], v[104:107], v[132:135]
s_add_u32 s72, s70, 144384
buffer_load_dwordx4 v5, s[4:7], s72 offen offset:3072 lds
v_mfma_f32_16x16x32_bf16 v[136:139], v[64:67], v[112:115], v[136:139]
ds_read_b64_tr_b16 v[92:93], v11 offset:24576
v_accvgpr_read_b32 v31, a119
v_mfma_f32_16x16x32_bf16 v[136:139], v[68:71], v[116:119], v[136:139]
s_lshl_b32 s71, s73, 12
v_mul_f32 v20, s79, v20
v_mul_f32 v28, s79, v28
v_mfma_f32_16x16x32_bf16 v[140:143], v[68:71], v[124:127], v[140:143]
s_add_u32 s71, s71, s66
ds_read_b64_tr_b16 v[94:95], v11 offset:25600
v_mul_f32 v21, s79, v21
v_mfma_f32_16x16x32_bf16 v[140:143], v[64:67], v[120:123], v[140:143]
s_waitcnt lgkmcnt(8)
v_mul_f32 v29, s79, v29
v_mul_f32 v22, s79, v22
v_mfma_f32_16x16x32_bf16 v[156:159], v[72:75], v[120:123], v[156:159]
s_add_u32 m0, s64, 0
ds_read_b64_tr_b16 v[64:65], v12 offset:16384
v_mul_f32 v30, s79, v30
v_mfma_f32_16x16x32_bf16 v[156:159], v[76:79], v[124:127], v[156:159]
s_add_u32 s72, s71, 0
buffer_load_dwordx4 v6, s[12:15], s72 offen lds
v_mfma_f32_16x16x32_bf16 v[152:155], v[76:79], v[116:119], v[152:155]
s_add_u32 s73, s62, 10
ds_read_b64_tr_b16 v[66:67], v12 offset:17408
v_mul_f32 v23, s79, v23
v_mfma_f32_16x16x32_bf16 v[152:155], v[72:75], v[112:115], v[152:155]
s_add_u32 s70, s73, s65
v_mul_f32 v31, s79, v31
v_cvt_pk_bf16_f32 v20, v20, v28
v_mfma_f32_16x16x32_bf16 v[148:151], v[72:75], v[104:107], v[148:151]
s_and_b32 s70, s70, 3
ds_read_b64_tr_b16 v[68:69], v12 offset:24576
v_cvt_pk_bf16_f32 v21, v21, v29
v_mfma_f32_16x16x32_bf16 v[148:151], v[76:79], v[108:111], v[148:151]
s_and_b32 s73, s73, 12
ds_read_b64_tr_b16 v[70:71], v12 offset:25600
v_cvt_pk_bf16_f32 v22, v22, v30
v_mfma_f32_16x16x32_bf16 v[144:147], v[76:79], v[100:103], v[144:147]
s_add_u32 s72, s71, 31744
buffer_load_dwordx4 v6, s[12:15], s72 offen offset:1024 lds
v_mfma_f32_16x16x32_bf16 v[144:147], v[72:75], v[96:99], v[144:147]
s_waitcnt lgkmcnt(8)
v_cvt_pk_bf16_f32 v23, v23, v31
v_mfma_f32_16x16x32_bf16 v[160:163], v[80:83], v[96:99], v[160:163]
s_or_b32 s73, s73, s70
ds_read_b64_tr_b16 v[72:73], v13 offset:16384
v_mfma_f32_16x16x32_bf16 v[160:163], v[84:87], v[100:103], v[160:163]
s_lshl_b32 s73, s73, 7
ds_read_b64_tr_b16 v[74:75], v13 offset:17408
v_mfma_f32_16x16x32_bf16 v[164:167], v[84:87], v[108:111], v[164:167]
s_add_u32 s69, s73, s67
v_mfma_f32_16x16x32_bf16 v[164:167], v[80:83], v[104:107], v[164:167]
s_add_u32 s72, s71, 63488
buffer_load_dwordx4 v7, s[12:15], s72 offen offset:2048 lds
v_mfma_f32_16x16x32_bf16 v[168:171], v[80:83], v[112:115], v[168:171]
s_waitcnt vmcnt(18)
ds_read_b64_tr_b16 v[76:77], v13 offset:24576
v_accvgpr_read_b32 v24, a216
v_mfma_f32_16x16x32_bf16 v[168:171], v[84:87], v[116:119], v[168:171]
s_add_u32 s70, s73, s68
ds_read_b128 v[32:35], v18 offset:32768
v_accvgpr_read_b32 v28, a217
v_mfma_f32_16x16x32_bf16 v[172:175], v[84:87], v[124:127], v[172:175]
s_add_u32 s80, s77, 37888
ds_read_b64_tr_b16 v[78:79], v13 offset:25600
v_accvgpr_read_b32 v25, a218
v_mfma_f32_16x16x32_bf16 v[172:175], v[80:83], v[120:123], v[172:175]
s_waitcnt lgkmcnt(9)
ds_read_b128 v[36:39], v19 offset:32768
v_accvgpr_read_b32 v29, a219
v_mfma_f32_16x16x32_bf16 v[188:191], v[88:91], v[120:123], v[188:191]
s_add_u32 s72, s71, 95232
buffer_load_dwordx4 v7, s[12:15], s72 offen offset:3072 lds
v_mfma_f32_16x16x32_bf16 v[188:191], v[92:95], v[124:127], v[188:191]
ds_read_b64_tr_b16 v[80:81], v14 offset:16384
v_accvgpr_read_b32 v26, a220
v_mfma_f32_16x16x32_bf16 v[184:187], v[92:95], v[116:119], v[184:187]
ds_read_b64_tr_b16 v[82:83], v14 offset:17408
v_accvgpr_read_b32 v30, a221
v_mfma_f32_16x16x32_bf16 v[184:187], v[88:91], v[112:115], v[184:187]
buffer_store_dwordx4 v[20:23], v1, s[44:47], s80 offen sc1
v_mfma_f32_16x16x32_bf16 v[180:183], v[88:91], v[104:107], v[180:183]
ds_read_b64_tr_b16 v[84:85], v14 offset:24576
v_accvgpr_read_b32 v27, a222
v_mfma_f32_16x16x32_bf16 v[180:183], v[92:95], v[108:111], v[180:183]
s_add_u32 m0, s63, 65536
ds_read_b64_tr_b16 v[86:87], v14 offset:25600
v_accvgpr_read_b32 v31, a223
v_mfma_f32_16x16x32_bf16 v[176:179], v[92:95], v[100:103], v[176:179]
s_add_u32 s72, s69, 0
buffer_load_dwordx4 v4, s[4:7], s72 offen lds
v_mfma_f32_16x16x32_bf16 v[176:179], v[88:91], v[96:99], v[176:179]
s_waitcnt lgkmcnt(10)
ds_read_b128 v[40:43], v18 offset:34816
v_cvt_pk_bf16_f32 v24, v24, v28
v_mfma_f32_16x16x32_bf16 v[192:195], v[64:67], v[96:99], v[192:195]
ds_read_b64_tr_b16 v[88:89], v15 offset:16384
v_cvt_pk_bf16_f32 v25, v25, v29
v_mfma_f32_16x16x32_bf16 v[192:195], v[68:71], v[100:103], v[192:195]
ds_read_b64_tr_b16 v[90:91], v15 offset:17408
v_cvt_pk_bf16_f32 v26, v26, v30
v_mfma_f32_16x16x32_bf16 v[196:199], v[68:71], v[108:111], v[196:199]
ds_read_b64_tr_b16 v[92:93], v15 offset:24576
v_cvt_pk_bf16_f32 v27, v27, v31
v_mfma_f32_16x16x32_bf16 v[196:199], v[64:67], v[104:107], v[196:199]
s_add_u32 s72, s69, 15360
buffer_load_dwordx4 v5, s[4:7], s72 offen offset:1024 lds
v_mfma_f32_16x16x32_bf16 v[200:203], v[64:67], v[112:115], v[200:203]
s_add_u32 s80, s78, 43008
ds_read_b64_tr_b16 v[94:95], v15 offset:25600
v_mfma_f32_16x16x32_bf16 v[200:203], v[68:71], v[116:119], v[200:203]
ds_read_b128 v[44:47], v19 offset:34816
v_mfma_f32_16x16x32_bf16 v[204:207], v[68:71], v[124:127], v[204:207]
buffer_store_dwordx4 v[24:27], v1, s[44:47], s80 offen sc1
v_mfma_f32_16x16x32_bf16 v[204:207], v[64:67], v[120:123], v[204:207]
s_waitcnt lgkmcnt(11)
ds_read_b128 v[48:51], v18 offset:36864
v_mfma_f32_16x16x32_bf16 v[220:223], v[72:75], v[120:123], v[220:223]
s_add_u32 s72, s69, 129024
buffer_load_dwordx4 v4, s[4:7], s72 offen offset:2048 lds
v_mfma_f32_16x16x32_bf16 v[220:223], v[76:79], v[124:127], v[220:223]
v_accvgpr_read_b32 v20, a88
v_accvgpr_read_b32 v28, a89
v_mfma_f32_16x16x32_bf16 v[216:219], v[76:79], v[116:119], v[216:219]
s_waitcnt vmcnt(20) lgkmcnt(2)
ds_read_b128 v[52:55], v19 offset:36864
v_accvgpr_read_b32 v21, a90
v_mfma_f32_16x16x32_bf16 v[216:219], v[72:75], v[112:115], v[216:219]
s_barrier
ds_read_b128 v[56:59], v18 offset:38912
v_accvgpr_read_b32 v29, a91
v_mfma_f32_16x16x32_bf16 v[212:215], v[72:75], v[104:107], v[212:215]
ds_read_b64_tr_b16 v[64:65], v8 offset:32768
ds_read_b64_tr_b16 v[66:67], v8 offset:33792
v_mfma_f32_16x16x32_bf16 v[212:215], v[76:79], v[108:111], v[212:215]
ds_read_b64_tr_b16 v[68:69], v8 offset:40960
v_accvgpr_read_b32 v22, a120
v_mfma_f32_16x16x32_bf16 v[208:211], v[76:79], v[100:103], v[208:211]
s_add_u32 s72, s69, 144384
buffer_load_dwordx4 v5, s[4:7], s72 offen offset:3072 lds
v_mfma_f32_16x16x32_bf16 v[208:211], v[72:75], v[96:99], v[208:211]
ds_read_b64_tr_b16 v[70:71], v8 offset:41984
v_accvgpr_read_b32 v30, a121
v_mfma_f32_16x16x32_bf16 v[224:227], v[80:83], v[96:99], v[224:227]
ds_read_b64_tr_b16 v[72:73], v9 offset:32768
v_accvgpr_read_b32 v23, a122
v_mfma_f32_16x16x32_bf16 v[224:227], v[84:87], v[100:103], v[224:227]
ds_read_b64_tr_b16 v[74:75], v9 offset:33792
v_accvgpr_read_b32 v31, a123
v_mfma_f32_16x16x32_bf16 v[228:231], v[84:87], v[108:111], v[228:231]
s_add_u32 m0, s63, 69632
v_mul_f32 v20, s79, v20
v_mul_f32 v28, s79, v28
v_mfma_f32_16x16x32_bf16 v[228:231], v[80:83], v[104:107], v[228:231]
s_add_u32 s72, s70, 0
buffer_load_dwordx4 v4, s[4:7], s72 offen lds
v_mfma_f32_16x16x32_bf16 v[232:235], v[80:83], v[112:115], v[232:235]
ds_read_b64_tr_b16 v[76:77], v9 offset:40960
v_mul_f32 v21, s79, v21
v_mfma_f32_16x16x32_bf16 v[232:235], v[84:87], v[116:119], v[232:235]
ds_read_b128 v[60:63], v19 offset:38912
v_mul_f32 v29, s79, v29
v_mfma_f32_16x16x32_bf16 v[236:239], v[84:87], v[124:127], v[236:239]
ds_read_b64_tr_b16 v[78:79], v9 offset:41984
v_mul_f32 v22, s79, v22
v_mfma_f32_16x16x32_bf16 v[236:239], v[80:83], v[120:123], v[236:239]
v_mul_f32 v30, s79, v30
v_mul_f32 v23, s79, v23
v_mfma_f32_16x16x32_bf16 v[252:255], v[88:91], v[120:123], v[252:255]
s_add_u32 s72, s70, 15360
buffer_load_dwordx4 v5, s[4:7], s72 offen offset:1024 lds
v_mfma_f32_16x16x32_bf16 v[252:255], v[92:95], v[124:127], v[252:255]
ds_read_b64_tr_b16 v[80:81], v10 offset:32768
v_mul_f32 v31, s79, v31
v_mfma_f32_16x16x32_bf16 v[248:251], v[92:95], v[116:119], v[248:251]
ds_read_b64_tr_b16 v[82:83], v10 offset:33792
v_cvt_pk_bf16_f32 v20, v20, v28
v_mfma_f32_16x16x32_bf16 v[248:251], v[88:91], v[112:115], v[248:251]
v_cvt_pk_bf16_f32 v21, v21, v29
v_cvt_pk_bf16_f32 v22, v22, v30
v_mfma_f32_16x16x32_bf16 v[244:247], v[88:91], v[104:107], v[244:247]
ds_read_b64_tr_b16 v[84:85], v10 offset:40960
v_cvt_pk_bf16_f32 v23, v23, v31
v_mfma_f32_16x16x32_bf16 v[244:247], v[92:95], v[108:111], v[244:247]
s_add_u32 s80, s77, 41984
ds_read_b64_tr_b16 v[86:87], v10 offset:41984
v_mfma_f32_16x16x32_bf16 v[240:243], v[92:95], v[100:103], v[240:243]
s_add_u32 s72, s70, 129024
buffer_load_dwordx4 v4, s[4:7], s72 offen offset:2048 lds
v_mfma_f32_16x16x32_bf16 v[240:243], v[88:91], v[96:99], v[240:243]
s_waitcnt lgkmcnt(5)
buffer_store_dwordx4 v[20:23], v1, s[44:47], s80 offen sc1
LcB1:
v_mfma_f32_16x16x32_bf16 v[128:131], v[64:67], v[32:35], v[128:131]
ds_read_b64_tr_b16 v[88:89], v11 offset:32768
v_accvgpr_read_b32 v24, a224
v_mfma_f32_16x16x32_bf16 v[128:131], v[68:71], v[36:39], v[128:131]
ds_read_b64_tr_b16 v[90:91], v11 offset:33792
v_accvgpr_read_b32 v28, a225
v_mfma_f32_16x16x32_bf16 v[132:135], v[68:71], v[44:47], v[132:135]
v_accvgpr_read_b32 v25, a226
v_accvgpr_read_b32 v29, a227
v_mfma_f32_16x16x32_bf16 v[132:135], v[64:67], v[40:43], v[132:135]
s_add_u32 s72, s70, 144384
buffer_load_dwordx4 v5, s[4:7], s72 offen offset:3072 lds
v_mfma_f32_16x16x32_bf16 v[136:139], v[64:67], v[48:51], v[136:139]
ds_read_b64_tr_b16 v[92:93], v11 offset:40960
v_accvgpr_read_b32 v26, a228
v_mfma_f32_16x16x32_bf16 v[136:139], v[68:71], v[52:55], v[136:139]
s_lshl_b32 s71, s73, 12
v_accvgpr_read_b32 v30, a229
v_accvgpr_read_b32 v27, a230
v_mfma_f32_16x16x32_bf16 v[140:143], v[68:71], v[60:63], v[140:143]
s_add_u32 s71, s71, s66
ds_read_b64_tr_b16 v[94:95], v11 offset:41984
v_accvgpr_read_b32 v31, a231
v_mfma_f32_16x16x32_bf16 v[140:143], v[64:67], v[56:59], v[140:143]
s_waitcnt lgkmcnt(8)
v_cvt_pk_bf16_f32 v24, v24, v28
v_cvt_pk_bf16_f32 v25, v25, v29
v_mfma_f32_16x16x32_bf16 v[156:159], v[72:75], v[56:59], v[156:159]
s_add_u32 m0, s64, 16384
ds_read_b64_tr_b16 v[64:65], v12 offset:32768
v_cvt_pk_bf16_f32 v26, v26, v30
v_mfma_f32_16x16x32_bf16 v[156:159], v[76:79], v[60:63], v[156:159]
s_add_u32 s72, s71, 0
buffer_load_dwordx4 v6, s[12:15], s72 offen lds
v_mfma_f32_16x16x32_bf16 v[152:155], v[76:79], v[52:55], v[152:155]
s_add_u32 s73, s62, 11
ds_read_b64_tr_b16 v[66:67], v12 offset:33792
v_cvt_pk_bf16_f32 v27, v27, v31
v_mfma_f32_16x16x32_bf16 v[152:155], v[72:75], v[48:51], v[152:155]
s_add_u32 s70, s73, s65
v_mfma_f32_16x16x32_bf16 v[148:151], v[72:75], v[40:43], v[148:151]
s_and_b32 s70, s70, 3
ds_read_b64_tr_b16 v[68:69], v12 offset:40960
v_mfma_f32_16x16x32_bf16 v[148:151], v[76:79], v[44:47], v[148:151]
s_and_b32 s73, s73, 12
ds_read_b64_tr_b16 v[70:71], v12 offset:41984
v_mfma_f32_16x16x32_bf16 v[144:147], v[76:79], v[36:39], v[144:147]
s_add_u32 s72, s71, 31744
buffer_load_dwordx4 v6, s[12:15], s72 offen offset:1024 lds
v_mfma_f32_16x16x32_bf16 v[144:147], v[72:75], v[32:35], v[144:147]
s_waitcnt lgkmcnt(8)
v_mfma_f32_16x16x32_bf16 v[160:163], v[80:83], v[32:35], v[160:163]
s_or_b32 s73, s73, s70
ds_read_b64_tr_b16 v[72:73], v13 offset:32768
v_mfma_f32_16x16x32_bf16 v[160:163], v[84:87], v[36:39], v[160:163]
s_lshl_b32 s73, s73, 7
ds_read_b64_tr_b16 v[74:75], v13 offset:33792
v_mfma_f32_16x16x32_bf16 v[164:167], v[84:87], v[44:47], v[164:167]
s_add_u32 s69, s73, s67
v_mfma_f32_16x16x32_bf16 v[164:167], v[80:83], v[40:43], v[164:167]
s_add_u32 s72, s71, 63488
buffer_load_dwordx4 v7, s[12:15], s72 offen offset:2048 lds
v_mfma_f32_16x16x32_bf16 v[168:171], v[80:83], v[48:51], v[168:171]
s_waitcnt vmcnt(18)
ds_read_b64_tr_b16 v[76:77], v13 offset:40960
v_mfma_f32_16x16x32_bf16 v[168:171], v[84:87], v[52:55], v[168:171]
s_add_u32 s70, s73, s68
ds_read_b128 v[96:99], v16 offset:0
v_accvgpr_read_b32 v20, a92
v_mfma_f32_16x16x32_bf16 v[172:175], v[84:87], v[60:63], v[172:175]
s_add_u32 s80, s78, 3072
ds_read_b64_tr_b16 v[78:79], v13 offset:41984
v_accvgpr_read_b32 v28, a93
v_mfma_f32_16x16x32_bf16 v[172:175], v[80:83], v[56:59], v[172:175]
s_waitcnt lgkmcnt(9)
ds_read_b128 v[100:103], v17 offset:0
v_accvgpr_read_b32 v21, a94
v_mfma_f32_16x16x32_bf16 v[188:191], v[88:91], v[56:59], v[188:191]
s_add_u32 s72, s71, 95232
buffer_load_dwordx4 v7, s[12:15], s72 offen offset:3072 lds
v_mfma_f32_16x16x32_bf16 v[188:191], v[92:95], v[60:63], v[188:191]
ds_read_b64_tr_b16 v[80:81], v14 offset:32768
v_accvgpr_read_b32 v29, a95
v_mfma_f32_16x16x32_bf16 v[184:187], v[92:95], v[52:55], v[184:187]
ds_read_b64_tr_b16 v[82:83], v14 offset:33792
v_accvgpr_read_b32 v22, a124
v_mfma_f32_16x16x32_bf16 v[184:187], v[88:91], v[48:51], v[184:187]
buffer_store_dwordx4 v[24:27], v1, s[44:47], s80 offen sc1
v_mfma_f32_16x16x32_bf16 v[180:183], v[88:91], v[40:43], v[180:183]
ds_read_b64_tr_b16 v[84:85], v14 offset:40960
v_accvgpr_read_b32 v30, a125
v_mfma_f32_16x16x32_bf16 v[180:183], v[92:95], v[44:47], v[180:183]
s_add_u32 m0, s63, 98304
ds_read_b64_tr_b16 v[86:87], v14 offset:41984
v_accvgpr_read_b32 v23, a126
v_mfma_f32_16x16x32_bf16 v[176:179], v[92:95], v[36:39], v[176:179]
s_add_u32 s72, s69, 0
buffer_load_dwordx4 v4, s[4:7], s72 offen lds
v_mfma_f32_16x16x32_bf16 v[176:179], v[88:91], v[32:35], v[176:179]
s_waitcnt lgkmcnt(10)
ds_read_b128 v[104:107], v16 offset:2048
v_accvgpr_read_b32 v31, a127
v_mfma_f32_16x16x32_bf16 v[192:195], v[64:67], v[32:35], v[192:195]
ds_read_b64_tr_b16 v[88:89], v15 offset:32768
v_mul_f32 v20, s79, v20
v_mfma_f32_16x16x32_bf16 v[192:195], v[68:71], v[36:39], v[192:195]
ds_read_b64_tr_b16 v[90:91], v15 offset:33792
v_mul_f32 v28, s79, v28
v_mfma_f32_16x16x32_bf16 v[196:199], v[68:71], v[44:47], v[196:199]
ds_read_b64_tr_b16 v[92:93], v15 offset:40960
v_mul_f32 v21, s79, v21
v_mfma_f32_16x16x32_bf16 v[196:199], v[64:67], v[40:43], v[196:199]
s_add_u32 s72, s69, 15360
buffer_load_dwordx4 v5, s[4:7], s72 offen offset:1024 lds
v_mfma_f32_16x16x32_bf16 v[200:203], v[64:67], v[48:51], v[200:203]
ds_read_b64_tr_b16 v[94:95], v15 offset:41984
v_mul_f32 v29, s79, v29
v_mfma_f32_16x16x32_bf16 v[200:203], v[68:71], v[52:55], v[200:203]
ds_read_b128 v[108:111], v17 offset:2048
v_mul_f32 v22, s79, v22
v_mfma_f32_16x16x32_bf16 v[204:207], v[68:71], v[60:63], v[204:207]
v_mul_f32 v30, s79, v30
v_mul_f32 v23, s79, v23
v_mfma_f32_16x16x32_bf16 v[204:207], v[64:67], v[56:59], v[204:207]
s_waitcnt lgkmcnt(11)
ds_read_b128 v[112:115], v16 offset:4096
v_mul_f32 v31, s79, v31
v_mfma_f32_16x16x32_bf16 v[220:223], v[72:75], v[56:59], v[220:223]
s_add_u32 s72, s69, 129024
buffer_load_dwordx4 v4, s[4:7], s72 offen offset:2048 lds
v_mfma_f32_16x16x32_bf16 v[220:223], v[76:79], v[60:63], v[220:223]
v_cvt_pk_bf16_f32 v20, v20, v28
v_cvt_pk_bf16_f32 v21, v21, v29
v_mfma_f32_16x16x32_bf16 v[216:219], v[76:79], v[52:55], v[216:219]
s_waitcnt vmcnt(19) lgkmcnt(2)
ds_read_b128 v[116:119], v17 offset:4096
v_cvt_pk_bf16_f32 v22, v22, v30
v_mfma_f32_16x16x32_bf16 v[216:219], v[72:75], v[48:51], v[216:219]
s_barrier
ds_read_b128 v[120:123], v16 offset:6144
v_cvt_pk_bf16_f32 v23, v23, v31
v_mfma_f32_16x16x32_bf16 v[212:215], v[72:75], v[40:43], v[212:215]
s_add_u32 s80, s77, 46080
ds_read_b64_tr_b16 v[64:65], v8 offset:0
ds_read_b64_tr_b16 v[66:67], v8 offset:1024
v_mfma_f32_16x16x32_bf16 v[212:215], v[76:79], v[44:47], v[212:215]
ds_read_b64_tr_b16 v[68:69], v8 offset:8192
v_accvgpr_read_b32 v24, a232
v_mfma_f32_16x16x32_bf16 v[208:211], v[76:79], v[36:39], v[208:211]
s_add_u32 s72, s69, 144384
buffer_load_dwordx4 v5, s[4:7], s72 offen offset:3072 lds
v_mfma_f32_16x16x32_bf16 v[208:211], v[72:75], v[32:35], v[208:211]
ds_read_b64_tr_b16 v[70:71], v8 offset:9216
v_accvgpr_read_b32 v28, a233
v_mfma_f32_16x16x32_bf16 v[224:227], v[80:83], v[32:35], v[224:227]
ds_read_b64_tr_b16 v[72:73], v9 offset:0
v_accvgpr_read_b32 v25, a234
v_mfma_f32_16x16x32_bf16 v[224:227], v[84:87], v[36:39], v[224:227]
ds_read_b64_tr_b16 v[74:75], v9 offset:1024
v_accvgpr_read_b32 v29, a235
v_mfma_f32_16x16x32_bf16 v[228:231], v[84:87], v[44:47], v[228:231]
s_add_u32 m0, s63, 102400
buffer_store_dwordx4 v[20:23], v1, s[44:47], s80 offen sc1
v_mfma_f32_16x16x32_bf16 v[228:231], v[80:83], v[40:43], v[228:231]
s_add_u32 s72, s70, 0
buffer_load_dwordx4 v4, s[4:7], s72 offen lds
v_mfma_f32_16x16x32_bf16 v[232:235], v[80:83], v[48:51], v[232:235]
ds_read_b64_tr_b16 v[76:77], v9 offset:8192
v_accvgpr_read_b32 v26, a236
v_mfma_f32_16x16x32_bf16 v[232:235], v[84:87], v[52:55], v[232:235]
ds_read_b128 v[124:127], v17 offset:6144
v_accvgpr_read_b32 v30, a237
v_mfma_f32_16x16x32_bf16 v[236:239], v[84:87], v[60:63], v[236:239]
ds_read_b64_tr_b16 v[78:79], v9 offset:9216
v_accvgpr_read_b32 v27, a238
v_mfma_f32_16x16x32_bf16 v[236:239], v[80:83], v[56:59], v[236:239]
v_accvgpr_read_b32 v31, a239
v_cvt_pk_bf16_f32 v24, v24, v28
v_mfma_f32_16x16x32_bf16 v[252:255], v[88:91], v[56:59], v[252:255]
s_add_u32 s72, s70, 15360
buffer_load_dwordx4 v5, s[4:7], s72 offen offset:1024 lds
v_mfma_f32_16x16x32_bf16 v[252:255], v[92:95], v[60:63], v[252:255]
ds_read_b64_tr_b16 v[80:81], v10 offset:0
v_cvt_pk_bf16_f32 v25, v25, v29
v_mfma_f32_16x16x32_bf16 v[248:251], v[92:95], v[52:55], v[248:251]
ds_read_b64_tr_b16 v[82:83], v10 offset:1024
v_cvt_pk_bf16_f32 v26, v26, v30
v_mfma_f32_16x16x32_bf16 v[248:251], v[88:91], v[48:51], v[248:251]
v_cvt_pk_bf16_f32 v27, v27, v31
v_mfma_f32_16x16x32_bf16 v[244:247], v[88:91], v[40:43], v[244:247]
s_add_u32 s80, s78, 11264
ds_read_b64_tr_b16 v[84:85], v10 offset:8192
v_mfma_f32_16x16x32_bf16 v[244:247], v[92:95], v[44:47], v[244:247]
ds_read_b64_tr_b16 v[86:87], v10 offset:9216
v_mfma_f32_16x16x32_bf16 v[240:243], v[92:95], v[36:39], v[240:243]
s_add_u32 s72, s70, 129024
buffer_load_dwordx4 v4, s[4:7], s72 offen offset:2048 lds
v_mfma_f32_16x16x32_bf16 v[240:243], v[88:91], v[32:35], v[240:243]
s_waitcnt lgkmcnt(5)
buffer_store_dwordx4 v[24:27], v1, s[44:47], s80 offen sc1
v_mfma_f32_16x16x32_bf16 v[128:131], v[64:67], v[96:99], v[128:131]
ds_read_b64_tr_b16 v[88:89], v11 offset:0
v_mfma_f32_16x16x32_bf16 v[128:131], v[68:71], v[100:103], v[128:131]
ds_read_b64_tr_b16 v[90:91], v11 offset:1024
v_accvgpr_read_b32 v20, a240
v_mfma_f32_16x16x32_bf16 v[132:135], v[68:71], v[108:111], v[132:135]
v_accvgpr_read_b32 v28, a241
v_accvgpr_read_b32 v21, a242
v_mfma_f32_16x16x32_bf16 v[132:135], v[64:67], v[104:107], v[132:135]
s_add_u32 s72, s70, 144384
buffer_load_dwordx4 v5, s[4:7], s72 offen offset:3072 lds
v_mfma_f32_16x16x32_bf16 v[136:139], v[64:67], v[112:115], v[136:139]
ds_read_b64_tr_b16 v[92:93], v11 offset:8192
v_accvgpr_read_b32 v29, a243
v_mfma_f32_16x16x32_bf16 v[136:139], v[68:71], v[116:119], v[136:139]
s_lshl_b32 s71, s73, 12
v_accvgpr_read_b32 v22, a244
v_accvgpr_read_b32 v30, a245
v_mfma_f32_16x16x32_bf16 v[140:143], v[68:71], v[124:127], v[140:143]
s_add_u32 s71, s71, s66
ds_read_b64_tr_b16 v[94:95], v11 offset:9216
v_accvgpr_read_b32 v23, a246
v_mfma_f32_16x16x32_bf16 v[140:143], v[64:67], v[120:123], v[140:143]
s_waitcnt lgkmcnt(8)
v_accvgpr_read_b32 v31, a247
v_cvt_pk_bf16_f32 v20, v20, v28
v_mfma_f32_16x16x32_bf16 v[156:159], v[72:75], v[120:123], v[156:159]
s_add_u32 m0, s64, 32768
ds_read_b64_tr_b16 v[64:65], v12 offset:0
v_cvt_pk_bf16_f32 v21, v21, v29
v_mfma_f32_16x16x32_bf16 v[156:159], v[76:79], v[124:127], v[156:159]
s_add_u32 s72, s71, 0
buffer_load_dwordx4 v6, s[12:15], s72 offen lds
v_mfma_f32_16x16x32_bf16 v[152:155], v[76:79], v[116:119], v[152:155]
s_add_u32 s73, s62, 12
ds_read_b64_tr_b16 v[66:67], v12 offset:1024
v_cvt_pk_bf16_f32 v22, v22, v30
v_mfma_f32_16x16x32_bf16 v[152:155], v[72:75], v[112:115], v[152:155]
s_add_u32 s70, s73, s65
v_cvt_pk_bf16_f32 v23, v23, v31
v_mfma_f32_16x16x32_bf16 v[148:151], v[72:75], v[104:107], v[148:151]
s_and_b32 s70, s70, 3
ds_read_b64_tr_b16 v[68:69], v12 offset:8192
v_mfma_f32_16x16x32_bf16 v[148:151], v[76:79], v[108:111], v[148:151]
s_and_b32 s73, s73, 12
ds_read_b64_tr_b16 v[70:71], v12 offset:9216
v_mfma_f32_16x16x32_bf16 v[144:147], v[76:79], v[100:103], v[144:147]
s_add_u32 s72, s71, 31744
buffer_load_dwordx4 v6, s[12:15], s72 offen offset:1024 lds
v_mfma_f32_16x16x32_bf16 v[144:147], v[72:75], v[96:99], v[144:147]
s_waitcnt lgkmcnt(8)
v_mfma_f32_16x16x32_bf16 v[160:163], v[80:83], v[96:99], v[160:163]
s_or_b32 s73, s73, s70
ds_read_b64_tr_b16 v[72:73], v13 offset:0
v_mfma_f32_16x16x32_bf16 v[160:163], v[84:87], v[100:103], v[160:163]
s_lshl_b32 s73, s73, 7
ds_read_b64_tr_b16 v[74:75], v13 offset:1024
v_mfma_f32_16x16x32_bf16 v[164:167], v[84:87], v[108:111], v[164:167]
s_add_u32 s69, s73, s67
v_mfma_f32_16x16x32_bf16 v[164:167], v[80:83], v[104:107], v[164:167]
s_add_u32 s72, s71, 63488
buffer_load_dwordx4 v7, s[12:15], s72 offen offset:2048 lds
v_mfma_f32_16x16x32_bf16 v[168:171], v[80:83], v[112:115], v[168:171]
s_waitcnt vmcnt(18)
ds_read_b64_tr_b16 v[76:77], v13 offset:8192
v_mfma_f32_16x16x32_bf16 v[168:171], v[84:87], v[116:119], v[168:171]
s_add_u32 s70, s73, s68
ds_read_b128 v[32:35], v18 offset:0
v_mfma_f32_16x16x32_bf16 v[172:175], v[84:87], v[124:127], v[172:175]
s_add_u32 s80, s78, 35840
ds_read_b64_tr_b16 v[78:79], v13 offset:9216
v_mfma_f32_16x16x32_bf16 v[172:175], v[80:83], v[120:123], v[172:175]
s_waitcnt lgkmcnt(9)
ds_read_b128 v[36:39], v19 offset:0
v_accvgpr_read_b32 v24, a248
v_mfma_f32_16x16x32_bf16 v[188:191], v[88:91], v[120:123], v[188:191]
s_add_u32 s72, s71, 95232
buffer_load_dwordx4 v7, s[12:15], s72 offen offset:3072 lds
v_mfma_f32_16x16x32_bf16 v[188:191], v[92:95], v[124:127], v[188:191]
ds_read_b64_tr_b16 v[80:81], v14 offset:0
v_accvgpr_read_b32 v28, a249
v_mfma_f32_16x16x32_bf16 v[184:187], v[92:95], v[116:119], v[184:187]
ds_read_b64_tr_b16 v[82:83], v14 offset:1024
v_accvgpr_read_b32 v25, a250
v_mfma_f32_16x16x32_bf16 v[184:187], v[88:91], v[112:115], v[184:187]
buffer_store_dwordx4 v[20:23], v1, s[44:47], s80 offen sc1
v_mfma_f32_16x16x32_bf16 v[180:183], v[88:91], v[104:107], v[180:183]
ds_read_b64_tr_b16 v[84:85], v14 offset:8192
v_accvgpr_read_b32 v29, a251
v_mfma_f32_16x16x32_bf16 v[180:183], v[92:95], v[108:111], v[180:183]
s_add_u32 m0, s63, 131072
ds_read_b64_tr_b16 v[86:87], v14 offset:9216
v_accvgpr_read_b32 v26, a252
v_mfma_f32_16x16x32_bf16 v[176:179], v[92:95], v[100:103], v[176:179]
s_add_u32 s72, s69, 0
buffer_load_dwordx4 v4, s[4:7], s72 offen lds
v_mfma_f32_16x16x32_bf16 v[176:179], v[88:91], v[96:99], v[176:179]
s_waitcnt lgkmcnt(10)
ds_read_b128 v[40:43], v18 offset:2048
v_accvgpr_read_b32 v30, a253
v_mfma_f32_16x16x32_bf16 v[192:195], v[64:67], v[96:99], v[192:195]
ds_read_b64_tr_b16 v[88:89], v15 offset:0
v_accvgpr_read_b32 v27, a254
v_mfma_f32_16x16x32_bf16 v[192:195], v[68:71], v[100:103], v[192:195]
ds_read_b64_tr_b16 v[90:91], v15 offset:1024
v_accvgpr_read_b32 v31, a255
v_mfma_f32_16x16x32_bf16 v[196:199], v[68:71], v[108:111], v[196:199]
ds_read_b64_tr_b16 v[92:93], v15 offset:8192
v_cvt_pk_bf16_f32 v24, v24, v28
v_mfma_f32_16x16x32_bf16 v[196:199], v[64:67], v[104:107], v[196:199]
s_add_u32 s72, s69, 15360
buffer_load_dwordx4 v5, s[4:7], s72 offen offset:1024 lds
v_mfma_f32_16x16x32_bf16 v[200:203], v[64:67], v[112:115], v[200:203]
ds_read_b64_tr_b16 v[94:95], v15 offset:9216
v_cvt_pk_bf16_f32 v25, v25, v29
v_mfma_f32_16x16x32_bf16 v[200:203], v[68:71], v[116:119], v[200:203]
ds_read_b128 v[44:47], v19 offset:2048
v_cvt_pk_bf16_f32 v26, v26, v30
v_mfma_f32_16x16x32_bf16 v[204:207], v[68:71], v[124:127], v[204:207]
v_cvt_pk_bf16_f32 v27, v27, v31
v_mfma_f32_16x16x32_bf16 v[204:207], v[64:67], v[120:123], v[204:207]
s_waitcnt lgkmcnt(11)
ds_read_b128 v[48:51], v18 offset:4096
v_mfma_f32_16x16x32_bf16 v[220:223], v[72:75], v[120:123], v[220:223]
s_add_u32 s72, s69, 129024
buffer_load_dwordx4 v4, s[4:7], s72 offen offset:2048 lds
v_mfma_f32_16x16x32_bf16 v[220:223], v[76:79], v[124:127], v[220:223]
s_add_u32 s80, s78, 44032
ds_read_b128 v[52:55], v19 offset:4096
v_mfma_f32_16x16x32_bf16 v[216:219], v[76:79], v[116:119], v[216:219]
s_waitcnt vmcnt(19) lgkmcnt(3)
buffer_store_dwordx4 v[24:27], v1, s[44:47], s80 offen sc1
v_mfma_f32_16x16x32_bf16 v[216:219], v[72:75], v[112:115], v[216:219]
s_barrier
ds_read_b128 v[56:59], v18 offset:6144
v_mfma_f32_16x16x32_bf16 v[212:215], v[72:75], v[104:107], v[212:215]
ds_read_b64_tr_b16 v[64:65], v8 offset:16384
ds_read_b64_tr_b16 v[66:67], v8 offset:17408
v_mfma_f32_16x16x32_bf16 v[212:215], v[76:79], v[108:111], v[212:215]
ds_read_b64_tr_b16 v[68:69], v8 offset:24576
ds_read_b64_tr_b16 v[70:71], v8 offset:25600
v_mfma_f32_16x16x32_bf16 v[208:211], v[76:79], v[100:103], v[208:211]
s_add_u32 s72, s69, 144384
buffer_load_dwordx4 v5, s[4:7], s72 offen offset:3072 lds
v_mfma_f32_16x16x32_bf16 v[208:211], v[72:75], v[96:99], v[208:211]
v_and_b32 v2, 31, v0
v_lshlrev_b32 v2, 2, v2
v_mfma_f32_16x16x32_bf16 v[224:227], v[80:83], v[96:99], v[224:227]
buffer_load_dword v3, v2, s[48:51], 0 offen sc1
v_mfma_f32_16x16x32_bf16 v[224:227], v[84:87], v[100:103], v[224:227]
ds_read_b64_tr_b16 v[72:73], v9 offset:16384
v_mfma_f32_16x16x32_bf16 v[228:231], v[84:87], v[108:111], v[228:231]
s_add_u32 m0, s63, 135168
ds_read_b64_tr_b16 v[74:75], v9 offset:17408
v_mfma_f32_16x16x32_bf16 v[228:231], v[80:83], v[104:107], v[228:231]
s_add_u32 s72, s70, 0
buffer_load_dwordx4 v4, s[4:7], s72 offen lds
v_mfma_f32_16x16x32_bf16 v[232:235], v[80:83], v[112:115], v[232:235]
ds_read_b128 v[60:63], v19 offset:6144
v_mfma_f32_16x16x32_bf16 v[232:235], v[84:87], v[116:119], v[232:235]
ds_read_b64_tr_b16 v[76:77], v9 offset:24576
v_mfma_f32_16x16x32_bf16 v[236:239], v[84:87], v[124:127], v[236:239]
ds_read_b64_tr_b16 v[78:79], v9 offset:25600
v_mfma_f32_16x16x32_bf16 v[236:239], v[80:83], v[120:123], v[236:239]
v_mfma_f32_16x16x32_bf16 v[252:255], v[88:91], v[120:123], v[252:255]
s_add_u32 s72, s70, 15360
buffer_load_dwordx4 v5, s[4:7], s72 offen offset:1024 lds
v_mfma_f32_16x16x32_bf16 v[252:255], v[92:95], v[124:127], v[252:255]
ds_read_b64_tr_b16 v[80:81], v10 offset:16384
v_mfma_f32_16x16x32_bf16 v[248:251], v[92:95], v[116:119], v[248:251]
ds_read_b64_tr_b16 v[82:83], v10 offset:17408
v_mfma_f32_16x16x32_bf16 v[248:251], v[88:91], v[112:115], v[248:251]
v_mfma_f32_16x16x32_bf16 v[244:247], v[88:91], v[104:107], v[244:247]
ds_read_b64_tr_b16 v[84:85], v10 offset:24576
v_mfma_f32_16x16x32_bf16 v[244:247], v[92:95], v[108:111], v[244:247]
ds_read_b64_tr_b16 v[86:87], v10 offset:25600
v_mfma_f32_16x16x32_bf16 v[240:243], v[92:95], v[100:103], v[240:243]
s_add_u32 s72, s70, 129024
buffer_load_dwordx4 v4, s[4:7], s72 offen offset:2048 lds
v_mfma_f32_16x16x32_bf16 v[240:243], v[88:91], v[96:99], v[240:243]
s_waitcnt lgkmcnt(6)
v_mfma_f32_16x16x32_bf16 v[128:131], v[64:67], v[32:35], v[128:131]
ds_read_b64_tr_b16 v[88:89], v11 offset:16384
v_mfma_f32_16x16x32_bf16 v[128:131], v[68:71], v[36:39], v[128:131]
ds_read_b64_tr_b16 v[90:91], v11 offset:17408
v_mfma_f32_16x16x32_bf16 v[132:135], v[68:71], v[44:47], v[132:135]
v_mfma_f32_16x16x32_bf16 v[132:135], v[64:67], v[40:43], v[132:135]
s_add_u32 s72, s70, 144384
buffer_load_dwordx4 v5, s[4:7], s72 offen offset:3072 lds
v_mfma_f32_16x16x32_bf16 v[136:139], v[64:67], v[48:51], v[136:139]
ds_read_b64_tr_b16 v[92:93], v11 offset:24576
v_mfma_f32_16x16x32_bf16 v[136:139], v[68:71], v[52:55], v[136:139]
s_lshl_b32 s71, s73, 12
v_mfma_f32_16x16x32_bf16 v[140:143], v[68:71], v[60:63], v[140:143]
s_add_u32 s71, s71, s66
ds_read_b64_tr_b16 v[94:95], v11 offset:25600
v_mfma_f32_16x16x32_bf16 v[140:143], v[64:67], v[56:59], v[140:143]
s_waitcnt lgkmcnt(8)
v_mfma_f32_16x16x32_bf16 v[156:159], v[72:75], v[56:59], v[156:159]
s_add_u32 m0, s64, 0
ds_read_b64_tr_b16 v[64:65], v12 offset:16384
v_mfma_f32_16x16x32_bf16 v[156:159], v[76:79], v[60:63], v[156:159]
s_add_u32 s72, s71, 0
buffer_load_dwordx4 v6, s[12:15], s72 offen lds
v_mfma_f32_16x16x32_bf16 v[152:155], v[76:79], v[52:55], v[152:155]
s_add_u32 s73, s62, 13
ds_read_b64_tr_b16 v[66:67], v12 offset:17408
v_mfma_f32_16x16x32_bf16 v[152:155], v[72:75], v[48:51], v[152:155]
s_add_u32 s70, s73, s65
v_mfma_f32_16x16x32_bf16 v[148:151], v[72:75], v[40:43], v[148:151]
s_and_b32 s70, s70, 3
ds_read_b64_tr_b16 v[68:69], v12 offset:24576
v_mfma_f32_16x16x32_bf16 v[148:151], v[76:79], v[44:47], v[148:151]
s_and_b32 s73, s73, 12
ds_read_b64_tr_b16 v[70:71], v12 offset:25600
v_mfma_f32_16x16x32_bf16 v[144:147], v[76:79], v[36:39], v[144:147]
s_add_u32 s72, s71, 31744
buffer_load_dwordx4 v6, s[12:15], s72 offen offset:1024 lds
v_mfma_f32_16x16x32_bf16 v[144:147], v[72:75], v[32:35], v[144:147]
s_waitcnt lgkmcnt(8)
v_mfma_f32_16x16x32_bf16 v[160:163], v[80:83], v[32:35], v[160:163]
s_or_b32 s73, s73, s70
ds_read_b64_tr_b16 v[72:73], v13 offset:16384
v_mfma_f32_16x16x32_bf16 v[160:163], v[84:87], v[36:39], v[160:163]
s_lshl_b32 s73, s73, 7
ds_read_b64_tr_b16 v[74:75], v13 offset:17408
v_mfma_f32_16x16x32_bf16 v[164:167], v[84:87], v[44:47], v[164:167]
s_add_u32 s69, s73, s67
v_mfma_f32_16x16x32_bf16 v[164:167], v[80:83], v[40:43], v[164:167]
s_add_u32 s72, s71, 63488
buffer_load_dwordx4 v7, s[12:15], s72 offen offset:2048 lds
v_mfma_f32_16x16x32_bf16 v[168:171], v[80:83], v[48:51], v[168:171]
s_waitcnt vmcnt(18)
ds_read_b64_tr_b16 v[76:77], v13 offset:24576
v_mfma_f32_16x16x32_bf16 v[168:171], v[84:87], v[52:55], v[168:171]
s_add_u32 s70, s73, s68
ds_read_b128 v[96:99], v18 offset:32768
v_mfma_f32_16x16x32_bf16 v[172:175], v[84:87], v[60:63], v[172:175]
ds_read_b64_tr_b16 v[78:79], v13 offset:25600
v_mfma_f32_16x16x32_bf16 v[172:175], v[80:83], v[56:59], v[172:175]
s_waitcnt lgkmcnt(9)
ds_read_b128 v[100:103], v19 offset:32768
v_mfma_f32_16x16x32_bf16 v[188:191], v[88:91], v[56:59], v[188:191]
s_add_u32 s72, s71, 95232
buffer_load_dwordx4 v7, s[12:15], s72 offen offset:3072 lds
v_mfma_f32_16x16x32_bf16 v[188:191], v[92:95], v[60:63], v[188:191]
ds_read_b64_tr_b16 v[80:81], v14 offset:16384
v_mfma_f32_16x16x32_bf16 v[184:187], v[92:95], v[52:55], v[184:187]
ds_read_b64_tr_b16 v[82:83], v14 offset:17408
v_mfma_f32_16x16x32_bf16 v[184:187], v[88:91], v[48:51], v[184:187]
v_mfma_f32_16x16x32_bf16 v[180:183], v[88:91], v[40:43], v[180:183]
ds_read_b64_tr_b16 v[84:85], v14 offset:24576
v_mfma_f32_16x16x32_bf16 v[180:183], v[92:95], v[44:47], v[180:183]
s_add_u32 m0, s63, 65536
ds_read_b64_tr_b16 v[86:87], v14 offset:25600
v_mfma_f32_16x16x32_bf16 v[176:179], v[92:95], v[36:39], v[176:179]
s_add_u32 s72, s69, 0
buffer_load_dwordx4 v4, s[4:7], s72 offen lds
v_mfma_f32_16x16x32_bf16 v[176:179], v[88:91], v[32:35], v[176:179]
s_waitcnt lgkmcnt(10)
ds_read_b128 v[104:107], v18 offset:34816
v_mfma_f32_16x16x32_bf16 v[192:195], v[64:67], v[32:35], v[192:195]
ds_read_b64_tr_b16 v[88:89], v15 offset:16384
v_mfma_f32_16x16x32_bf16 v[192:195], v[68:71], v[36:39], v[192:195]
ds_read_b64_tr_b16 v[90:91], v15 offset:17408
v_mfma_f32_16x16x32_bf16 v[196:199], v[68:71], v[44:47], v[196:199]
ds_read_b64_tr_b16 v[92:93], v15 offset:24576
v_mfma_f32_16x16x32_bf16 v[196:199], v[64:67], v[40:43], v[196:199]
s_add_u32 s72, s69, 15360
buffer_load_dwordx4 v5, s[4:7], s72 offen offset:1024 lds
v_mfma_f32_16x16x32_bf16 v[200:203], v[64:67], v[48:51], v[200:203]
ds_read_b64_tr_b16 v[94:95], v15 offset:25600
v_mfma_f32_16x16x32_bf16 v[200:203], v[68:71], v[52:55], v[200:203]
ds_read_b128 v[108:111], v19 offset:34816
v_mfma_f32_16x16x32_bf16 v[204:207], v[68:71], v[60:63], v[204:207]
v_mfma_f32_16x16x32_bf16 v[204:207], v[64:67], v[56:59], v[204:207]
s_waitcnt lgkmcnt(11)
ds_read_b128 v[112:115], v18 offset:36864
v_mfma_f32_16x16x32_bf16 v[220:223], v[72:75], v[56:59], v[220:223]
s_add_u32 s72, s69, 129024
buffer_load_dwordx4 v4, s[4:7], s72 offen offset:2048 lds
v_mfma_f32_16x16x32_bf16 v[220:223], v[76:79], v[60:63], v[220:223]
v_mfma_f32_16x16x32_bf16 v[216:219], v[76:79], v[52:55], v[216:219]
s_waitcnt vmcnt(13) lgkmcnt(2)
ds_read_b128 v[116:119], v19 offset:36864
v_mfma_f32_16x16x32_bf16 v[216:219], v[72:75], v[48:51], v[216:219]
s_barrier
ds_read_b128 v[120:123], v18 offset:38912
v_mfma_f32_16x16x32_bf16 v[212:215], v[72:75], v[40:43], v[212:215]
ds_read_b64_tr_b16 v[64:65], v8 offset:32768
ds_read_b64_tr_b16 v[66:67], v8 offset:33792
v_mfma_f32_16x16x32_bf16 v[212:215], v[76:79], v[44:47], v[212:215]
ds_read_b64_tr_b16 v[68:69], v8 offset:40960
v_or_b32 v20, s58, v0
v_mfma_f32_16x16x32_bf16 v[208:211], v[76:79], v[36:39], v[208:211]
s_add_u32 s72, s69, 144384
buffer_load_dwordx4 v5, s[4:7], s72 offen offset:3072 lds
v_mfma_f32_16x16x32_bf16 v[208:211], v[72:75], v[32:35], v[208:211]
ds_read_b64_tr_b16 v[70:71], v8 offset:41984
v_mov_b32 v21, 1
v_mfma_f32_16x16x32_bf16 v[224:227], v[80:83], v[32:35], v[224:227]
ds_read_b64_tr_b16 v[72:73], v9 offset:32768
v_min_u32 v20, 1, v20
v_mfma_f32_16x16x32_bf16 v[224:227], v[84:87], v[36:39], v[224:227]
ds_read_b64_tr_b16 v[74:75], v9 offset:33792
v_lshlrev_b32 v20, 30, v20
v_mfma_f32_16x16x32_bf16 v[228:231], v[84:87], v[44:47], v[228:231]
s_add_u32 m0, s63, 69632
buffer_store_dword v21, v20, s[44:47], s91 offen sc1
v_mfma_f32_16x16x32_bf16 v[228:231], v[80:83], v[40:43], v[228:231]
s_add_u32 s72, s70, 0
buffer_load_dwordx4 v4, s[4:7], s72 offen lds
v_mfma_f32_16x16x32_bf16 v[232:235], v[80:83], v[48:51], v[232:235]
ds_read_b64_tr_b16 v[76:77], v9 offset:40960
v_accvgpr_write_b32 a32, 0
v_mfma_f32_16x16x32_bf16 v[232:235], v[84:87], v[52:55], v[232:235]
ds_read_b128 v[124:127], v19 offset:38912
v_accvgpr_write_b32 a33, 0
v_mfma_f32_16x16x32_bf16 v[236:239], v[84:87], v[60:63], v[236:239]
ds_read_b64_tr_b16 v[78:79], v9 offset:41984
v_accvgpr_write_b32 a34, 0
v_mfma_f32_16x16x32_bf16 v[236:239], v[80:83], v[56:59], v[236:239]
v_accvgpr_write_b32 a35, 0
v_accvgpr_write_b32 a36, 0
v_mfma_f32_16x16x32_bf16 v[252:255], v[88:91], v[56:59], v[252:255]
s_add_u32 s72, s70, 15360
buffer_load_dwordx4 v5, s[4:7], s72 offen offset:1024 lds
v_mfma_f32_16x16x32_bf16 v[252:255], v[92:95], v[60:63], v[252:255]
ds_read_b64_tr_b16 v[80:81], v10 offset:32768
v_accvgpr_write_b32 a37, 0
v_mfma_f32_16x16x32_bf16 v[248:251], v[92:95], v[52:55], v[248:251]
ds_read_b64_tr_b16 v[82:83], v10 offset:33792
v_accvgpr_write_b32 a38, 0
v_mfma_f32_16x16x32_bf16 v[248:251], v[88:91], v[48:51], v[248:251]
v_accvgpr_write_b32 a39, 0
v_accvgpr_write_b32 a40, 0
v_mfma_f32_16x16x32_bf16 v[244:247], v[88:91], v[40:43], v[244:247]
ds_read_b64_tr_b16 v[84:85], v10 offset:40960
v_accvgpr_write_b32 a41, 0
v_mfma_f32_16x16x32_bf16 v[244:247], v[92:95], v[44:47], v[244:247]
ds_read_b64_tr_b16 v[86:87], v10 offset:41984
v_accvgpr_write_b32 a42, 0
v_mfma_f32_16x16x32_bf16 v[240:243], v[92:95], v[36:39], v[240:243]
s_add_u32 s72, s70, 129024
buffer_load_dwordx4 v4, s[4:7], s72 offen offset:2048 lds
v_mfma_f32_16x16x32_bf16 v[240:243], v[88:91], v[32:35], v[240:243]
s_waitcnt lgkmcnt(5)
v_accvgpr_write_b32 a43, 0
v_accvgpr_write_b32 a44, 0
v_mfma_f32_16x16x32_bf16 v[128:131], v[64:67], v[96:99], v[128:131]
ds_read_b64_tr_b16 v[88:89], v11 offset:32768
v_accvgpr_write_b32 a45, 0
v_mfma_f32_16x16x32_bf16 v[128:131], v[68:71], v[100:103], v[128:131]
ds_read_b64_tr_b16 v[90:91], v11 offset:33792
v_accvgpr_write_b32 a46, 0
v_mfma_f32_16x16x32_bf16 v[132:135], v[68:71], v[108:111], v[132:135]
v_accvgpr_write_b32 a47, 0
v_accvgpr_write_b32 a48, 0
v_mfma_f32_16x16x32_bf16 v[132:135], v[64:67], v[104:107], v[132:135]
s_add_u32 s72, s70, 144384
buffer_load_dwordx4 v5, s[4:7], s72 offen offset:3072 lds
v_mfma_f32_16x16x32_bf16 v[136:139], v[64:67], v[112:115], v[136:139]
ds_read_b64_tr_b16 v[92:93], v11 offset:40960
v_accvgpr_write_b32 a49, 0
v_mfma_f32_16x16x32_bf16 v[136:139], v[68:71], v[116:119], v[136:139]
s_lshl_b32 s71, s73, 12
v_accvgpr_write_b32 a50, 0
v_accvgpr_write_b32 a51, 0
v_mfma_f32_16x16x32_bf16 v[140:143], v[68:71], v[124:127], v[140:143]
s_add_u32 s71, s71, s66
ds_read_b64_tr_b16 v[94:95], v11 offset:41984
v_accvgpr_write_b32 a52, 0
v_mfma_f32_16x16x32_bf16 v[140:143], v[64:67], v[120:123], v[140:143]
s_waitcnt lgkmcnt(8)
v_accvgpr_write_b32 a53, 0
v_accvgpr_write_b32 a54, 0
v_mfma_f32_16x16x32_bf16 v[156:159], v[72:75], v[120:123], v[156:159]
s_add_u32 m0, s64, 16384
ds_read_b64_tr_b16 v[64:65], v12 offset:32768
v_accvgpr_write_b32 a55, 0
v_mfma_f32_16x16x32_bf16 v[156:159], v[76:79], v[124:127], v[156:159]
s_add_u32 s72, s71, 0
buffer_load_dwordx4 v6, s[12:15], s72 offen lds
v_mfma_f32_16x16x32_bf16 v[152:155], v[76:79], v[116:119], v[152:155]
s_add_u32 s73, s62, 14
ds_read_b64_tr_b16 v[66:67], v12 offset:33792
v_accvgpr_write_b32 a56, 0
v_mfma_f32_16x16x32_bf16 v[152:155], v[72:75], v[112:115], v[152:155]
s_add_u32 s70, s73, s65
v_accvgpr_write_b32 a57, 0
v_accvgpr_write_b32 a58, 0
v_mfma_f32_16x16x32_bf16 v[148:151], v[72:75], v[104:107], v[148:151]
s_and_b32 s70, s70, 3
ds_read_b64_tr_b16 v[68:69], v12 offset:40960
v_accvgpr_write_b32 a59, 0
v_mfma_f32_16x16x32_bf16 v[148:151], v[76:79], v[108:111], v[148:151]
s_and_b32 s73, s73, 12
ds_read_b64_tr_b16 v[70:71], v12 offset:41984
v_accvgpr_write_b32 a60, 0
v_mfma_f32_16x16x32_bf16 v[144:147], v[76:79], v[100:103], v[144:147]
s_add_u32 s72, s71, 31744
buffer_load_dwordx4 v6, s[12:15], s72 offen offset:1024 lds
v_mfma_f32_16x16x32_bf16 v[144:147], v[72:75], v[96:99], v[144:147]
s_waitcnt lgkmcnt(8)
v_accvgpr_write_b32 a61, 0
v_accvgpr_write_b32 a62, 0
v_mfma_f32_16x16x32_bf16 v[160:163], v[80:83], v[96:99], v[160:163]
s_or_b32 s73, s73, s70
ds_read_b64_tr_b16 v[72:73], v13 offset:32768
v_accvgpr_write_b32 a63, 0
v_mfma_f32_16x16x32_bf16 v[160:163], v[84:87], v[100:103], v[160:163]
s_lshl_b32 s73, s73, 7
ds_read_b64_tr_b16 v[74:75], v13 offset:33792
v_accvgpr_write_b32 a96, 0
v_mfma_f32_16x16x32_bf16 v[164:167], v[84:87], v[108:111], v[164:167]
s_add_u32 s69, s73, s67
v_accvgpr_write_b32 a97, 0
v_accvgpr_write_b32 a98, 0
v_mfma_f32_16x16x32_bf16 v[164:167], v[80:83], v[104:107], v[164:167]
s_add_u32 s72, s71, 63488
buffer_load_dwordx4 v7, s[12:15], s72 offen offset:2048 lds
v_mfma_f32_16x16x32_bf16 v[168:171], v[80:83], v[112:115], v[168:171]
s_waitcnt vmcnt(16)
ds_read_b64_tr_b16 v[76:77], v13 offset:40960
v_accvgpr_write_b32 a99, 0
v_mfma_f32_16x16x32_bf16 v[168:171], v[84:87], v[116:119], v[168:171]
s_add_u32 s70, s73, s68
ds_read_b128 v[32:35], v16 offset:0
v_accvgpr_write_b32 a100, 0
v_mfma_f32_16x16x32_bf16 v[172:175], v[84:87], v[124:127], v[172:175]
ds_read_b64_tr_b16 v[78:79], v13 offset:41984
v_accvgpr_write_b32 a101, 0
v_mfma_f32_16x16x32_bf16 v[172:175], v[80:83], v[120:123], v[172:175]
s_waitcnt lgkmcnt(9)
ds_read_b128 v[36:39], v17 offset:0
v_accvgpr_write_b32 a102, 0
v_mfma_f32_16x16x32_bf16 v[188:191], v[88:91], v[120:123], v[188:191]
s_add_u32 s72, s71, 95232
buffer_load_dwordx4 v7, s[12:15], s72 offen offset:3072 lds
v_mfma_f32_16x16x32_bf16 v[188:191], v[92:95], v[124:127], v[188:191]
ds_read_b64_tr_b16 v[80:81], v14 offset:32768
v_accvgpr_write_b32 a103, 0
v_mfma_f32_16x16x32_bf16 v[184:187], v[92:95], v[116:119], v[184:187]
ds_read_b64_tr_b16 v[82:83], v14 offset:33792
v_accvgpr_write_b32 a104, 0
v_mfma_f32_16x16x32_bf16 v[184:187], v[88:91], v[112:115], v[184:187]
v_accvgpr_write_b32 a105, 0
v_accvgpr_write_b32 a106, 0
v_mfma_f32_16x16x32_bf16 v[180:183], v[88:91], v[104:107], v[180:183]
ds_read_b64_tr_b16 v[84:85], v14 offset:40960
v_accvgpr_write_b32 a107, 0
v_mfma_f32_16x16x32_bf16 v[180:183], v[92:95], v[108:111], v[180:183]
s_add_u32 m0, s63, 98304
ds_read_b64_tr_b16 v[86:87], v14 offset:41984
v_accvgpr_write_b32 a108, 0
v_mfma_f32_16x16x32_bf16 v[176:179], v[92:95], v[100:103], v[176:179]
s_add_u32 s72, s69, 0
buffer_load_dwordx4 v4, s[4:7], s72 offen lds
v_mfma_f32_16x16x32_bf16 v[176:179], v[88:91], v[96:99], v[176:179]
s_waitcnt lgkmcnt(10)
ds_read_b128 v[40:43], v16 offset:2048
v_accvgpr_write_b32 a109, 0
v_mfma_f32_16x16x32_bf16 v[192:195], v[64:67], v[96:99], v[192:195]
ds_read_b64_tr_b16 v[88:89], v15 offset:32768
v_accvgpr_write_b32 a110, 0
v_mfma_f32_16x16x32_bf16 v[192:195], v[68:71], v[100:103], v[192:195]
ds_read_b64_tr_b16 v[90:91], v15 offset:33792
v_accvgpr_write_b32 a111, 0
v_mfma_f32_16x16x32_bf16 v[196:199], v[68:71], v[108:111], v[196:199]
ds_read_b64_tr_b16 v[92:93], v15 offset:40960
v_accvgpr_write_b32 a112, 0
v_mfma_f32_16x16x32_bf16 v[196:199], v[64:67], v[104:107], v[196:199]
s_add_u32 s72, s69, 15360
buffer_load_dwordx4 v5, s[4:7], s72 offen offset:1024 lds
v_mfma_f32_16x16x32_bf16 v[200:203], v[64:67], v[112:115], v[200:203]
ds_read_b64_tr_b16 v[94:95], v15 offset:41984
v_accvgpr_write_b32 a113, 0
v_mfma_f32_16x16x32_bf16 v[200:203], v[68:71], v[116:119], v[200:203]
ds_read_b128 v[44:47], v17 offset:2048
v_accvgpr_write_b32 a114, 0
v_mfma_f32_16x16x32_bf16 v[204:207], v[68:71], v[124:127], v[204:207]
v_accvgpr_write_b32 a115, 0
v_accvgpr_write_b32 a116, 0
v_mfma_f32_16x16x32_bf16 v[204:207], v[64:67], v[120:123], v[204:207]
s_waitcnt lgkmcnt(11)
ds_read_b128 v[48:51], v16 offset:4096
v_accvgpr_write_b32 a117, 0
v_mfma_f32_16x16x32_bf16 v[220:223], v[72:75], v[120:123], v[220:223]
s_add_u32 s72, s69, 129024
buffer_load_dwordx4 v4, s[4:7], s72 offen offset:2048 lds
v_mfma_f32_16x16x32_bf16 v[220:223], v[76:79], v[124:127], v[220:223]
v_accvgpr_write_b32 a118, 0
v_accvgpr_write_b32 a119, 0
v_mfma_f32_16x16x32_bf16 v[216:219], v[76:79], v[116:119], v[216:219]
s_waitcnt vmcnt(16) lgkmcnt(2)
ds_read_b128 v[52:55], v17 offset:4096
v_accvgpr_write_b32 a120, 0
v_mfma_f32_16x16x32_bf16 v[216:219], v[72:75], v[112:115], v[216:219]
s_barrier
ds_read_b128 v[56:59], v16 offset:6144
v_accvgpr_write_b32 a121, 0
v_mfma_f32_16x16x32_bf16 v[212:215], v[72:75], v[104:107], v[212:215]
s_waitcnt vmcnt(24)
v_cmp_gt_u32 vcc, 8, v3
s_cbranch_vccnz Lspin1
Lback2:
v_mfma_f32_16x16x32_bf16 v[212:215], v[76:79], v[108:111], v[212:215]
ds_read_b64_tr_b16 v[64:65], v8 offset:0
ds_read_b64_tr_b16 v[66:67], v8 offset:1024
v_mfma_f32_16x16x32_bf16 v[208:211], v[76:79], v[100:103], v[208:211]
s_add_u32 s72, s69, 144384
buffer_load_dwordx4 v5, s[4:7], s72 offen offset:3072 lds
v_mfma_f32_16x16x32_bf16 v[208:211], v[72:75], v[96:99], v[208:211]
ds_read_b64_tr_b16 v[68:69], v8 offset:8192
ds_read_b64_tr_b16 v[70:71], v8 offset:9216
v_mfma_f32_16x16x32_bf16 v[224:227], v[80:83], v[96:99], v[224:227]
ds_read_b64_tr_b16 v[72:73], v9 offset:0
v_accvgpr_write_b32 a122, 0
v_mfma_f32_16x16x32_bf16 v[224:227], v[84:87], v[100:103], v[224:227]
ds_read_b64_tr_b16 v[74:75], v9 offset:1024
v_accvgpr_write_b32 a123, 0
v_mfma_f32_16x16x32_bf16 v[228:231], v[84:87], v[108:111], v[228:231]
s_add_u32 m0, s63, 102400
v_accvgpr_write_b32 a124, 0
v_accvgpr_write_b32 a125, 0
v_mfma_f32_16x16x32_bf16 v[228:231], v[80:83], v[104:107], v[228:231]
s_add_u32 s72, s70, 0
buffer_load_dwordx4 v4, s[4:7], s72 offen lds
v_mfma_f32_16x16x32_bf16 v[232:235], v[80:83], v[112:115], v[232:235]
ds_read_b64_tr_b16 v[76:77], v9 offset:8192
v_accvgpr_write_b32 a126, 0
v_mfma_f32_16x16x32_bf16 v[232:235], v[84:87], v[116:119], v[232:235]
ds_read_b128 v[60:63], v17 offset:6144
v_accvgpr_write_b32 a127, 0
v_mfma_f32_16x16x32_bf16 v[236:239], v[84:87], v[124:127], v[236:239]
ds_read_b64_tr_b16 v[78:79], v9 offset:9216
v_mfma_f32_16x16x32_bf16 v[236:239], v[80:83], v[120:123], v[236:239]
v_mfma_f32_16x16x32_bf16 v[252:255], v[88:91], v[120:123], v[252:255]
s_add_u32 s72, s70, 15360
buffer_load_dwordx4 v5, s[4:7], s72 offen offset:1024 lds
v_mfma_f32_16x16x32_bf16 v[252:255], v[92:95], v[124:127], v[252:255]
ds_read_b64_tr_b16 v[80:81], v10 offset:0
v_mfma_f32_16x16x32_bf16 v[248:251], v[92:95], v[116:119], v[248:251]
ds_read_b64_tr_b16 v[82:83], v10 offset:1024
v_mfma_f32_16x16x32_bf16 v[248:251], v[88:91], v[112:115], v[248:251]
v_mfma_f32_16x16x32_bf16 v[244:247], v[88:91], v[104:107], v[244:247]
ds_read_b64_tr_b16 v[84:85], v10 offset:8192
v_mfma_f32_16x16x32_bf16 v[244:247], v[92:95], v[108:111], v[244:247]
ds_read_b64_tr_b16 v[86:87], v10 offset:9216
v_mfma_f32_16x16x32_bf16 v[240:243], v[92:95], v[100:103], v[240:243]
s_add_u32 s72, s70, 129024
buffer_load_dwordx4 v4, s[4:7], s72 offen offset:2048 lds
v_mfma_f32_16x16x32_bf16 v[240:243], v[88:91], v[96:99], v[240:243]
s_waitcnt lgkmcnt(5)
v_mfma_f32_16x16x32_bf16 v[128:131], v[64:67], v[32:35], v[128:131]
ds_read_b64_tr_b16 v[88:89], v11 offset:0
v_mfma_f32_16x16x32_bf16 v[128:131], v[68:71], v[36:39], v[128:131]
ds_read_b64_tr_b16 v[90:91], v11 offset:1024
v_mfma_f32_16x16x32_bf16 v[132:135], v[68:71], v[44:47], v[132:135]
v_mfma_f32_16x16x32_bf16 v[132:135], v[64:67], v[40:43], v[132:135]
s_add_u32 s72, s70, 144384
buffer_load_dwordx4 v5, s[4:7], s72 offen offset:3072 lds
v_mfma_f32_16x16x32_bf16 v[136:139], v[64:67], v[48:51], v[136:139]
ds_read_b64_tr_b16 v[92:93], v11 offset:8192
v_mfma_f32_16x16x32_bf16 v[136:139], v[68:71], v[52:55], v[136:139]
s_lshl_b32 s71, s73, 12
v_mfma_f32_16x16x32_bf16 v[140:143], v[68:71], v[60:63], v[140:143]
s_add_u32 s71, s71, s66
ds_read_b64_tr_b16 v[94:95], v11 offset:9216
v_mfma_f32_16x16x32_bf16 v[140:143], v[64:67], v[56:59], v[140:143]
s_waitcnt lgkmcnt(8)
v_mfma_f32_16x16x32_bf16 v[156:159], v[72:75], v[56:59], v[156:159]
s_add_u32 m0, s64, 32768
ds_read_b64_tr_b16 v[64:65], v12 offset:0
v_mfma_f32_16x16x32_bf16 v[156:159], v[76:79], v[60:63], v[156:159]
s_add_u32 s72, s71, 0
buffer_load_dwordx4 v6, s[12:15], s72 offen lds
v_mfma_f32_16x16x32_bf16 v[152:155], v[76:79], v[52:55], v[152:155]
s_add_u32 s73, s62, 15
ds_read_b64_tr_b16 v[66:67], v12 offset:1024
v_mfma_f32_16x16x32_bf16 v[152:155], v[72:75], v[48:51], v[152:155]
s_add_u32 s70, s73, s65
v_mfma_f32_16x16x32_bf16 v[148:151], v[72:75], v[40:43], v[148:151]
s_and_b32 s70, s70, 3
ds_read_b64_tr_b16 v[68:69], v12 offset:8192
v_mfma_f32_16x16x32_bf16 v[148:151], v[76:79], v[44:47], v[148:151]
s_and_b32 s73, s73, 12
ds_read_b64_tr_b16 v[70:71], v12 offset:9216
v_mfma_f32_16x16x32_bf16 v[144:147], v[76:79], v[36:39], v[144:147]
s_add_u32 s72, s71, 31744
buffer_load_dwordx4 v6, s[12:15], s72 offen offset:1024 lds
v_mfma_f32_16x16x32_bf16 v[144:147], v[72:75], v[32:35], v[144:147]
s_waitcnt lgkmcnt(8)
v_mfma_f32_16x16x32_bf16 v[160:163], v[80:83], v[32:35], v[160:163]
s_or_b32 s73, s73, s70
ds_read_b64_tr_b16 v[72:73], v13 offset:0
v_mfma_f32_16x16x32_bf16 v[160:163], v[84:87], v[36:39], v[160:163]
s_lshl_b32 s73, s73, 7
ds_read_b64_tr_b16 v[74:75], v13 offset:1024
v_mfma_f32_16x16x32_bf16 v[164:167], v[84:87], v[44:47], v[164:167]
s_add_u32 s69, s73, s67
v_mfma_f32_16x16x32_bf16 v[164:167], v[80:83], v[40:43], v[164:167]
s_add_u32 s72, s71, 63488
buffer_load_dwordx4 v7, s[12:15], s72 offen offset:2048 lds
v_mfma_f32_16x16x32_bf16 v[168:171], v[80:83], v[48:51], v[168:171]
s_waitcnt vmcnt(15)
ds_read_b64_tr_b16 v[76:77], v13 offset:8192
v_mfma_f32_16x16x32_bf16 v[168:171], v[84:87], v[52:55], v[168:171]
s_add_u32 s70, s73, s68
ds_read_b128 v[96:99], v18 offset:0
v_mfma_f32_16x16x32_bf16 v[172:175], v[84:87], v[60:63], v[172:175]
ds_read_b64_tr_b16 v[78:79], v13 offset:9216
v_mfma_f32_16x16x32_bf16 v[172:175], v[80:83], v[56:59], v[172:175]
s_waitcnt lgkmcnt(9)
ds_read_b128 v[100:103], v19 offset:0
v_mfma_f32_16x16x32_bf16 v[188:191], v[88:91], v[56:59], v[188:191]
s_add_u32 s72, s71, 95232
buffer_load_dwordx4 v7, s[12:15], s72 offen offset:3072 lds
v_mfma_f32_16x16x32_bf16 v[188:191], v[92:95], v[60:63], v[188:191]
ds_read_b64_tr_b16 v[80:81], v14 offset:0
v_mfma_f32_16x16x32_bf16 v[184:187], v[92:95], v[52:55], v[184:187]
ds_read_b64_tr_b16 v[82:83], v14 offset:1024
v_mfma_f32_16x16x32_bf16 v[184:187], v[88:91], v[48:51], v[184:187]
v_mfma_f32_16x16x32_bf16 v[180:183], v[88:91], v[40:43], v[180:183]
ds_read_b64_tr_b16 v[84:85], v14 offset:8192
v_mfma_f32_16x16x32_bf16 v[180:183], v[92:95], v[44:47], v[180:183]
s_add_u32 m0, s63, 131072
ds_read_b64_tr_b16 v[86:87], v14 offset:9216
v_mfma_f32_16x16x32_bf16 v[176:179], v[92:95], v[36:39], v[176:179]
s_add_u32 s72, s69, 0
buffer_load_dwordx4 v4, s[4:7], s72 offen lds
v_mfma_f32_16x16x32_bf16 v[176:179], v[88:91], v[32:35], v[176:179]
s_waitcnt lgkmcnt(10)
ds_read_b128 v[104:107], v18 offset:2048
v_mfma_f32_16x16x32_bf16 v[192:195], v[64:67], v[32:35], v[192:195]
ds_read_b64_tr_b16 v[88:89], v15 offset:0
ds_read_b64_tr_b16 v[90:91], v15 offset:1024
v_mfma_f32_16x16x32_bf16 v[192:195], v[68:71], v[36:39], v[192:195]
ds_read_b64_tr_b16 v[92:93], v15 offset:8192
v_mfma_f32_16x16x32_bf16 v[196:199], v[68:71], v[44:47], v[196:199]
s_and_b32 s75, s91, 0xfffffc7f
v_lshrrev_b32 v2, 3, v0
v_lshlrev_b32 v2, 7, v2
v_mfma_f32_16x16x32_bf16 v[196:199], v[64:67], v[40:43], v[196:199]
s_add_u32 s72, s69, 15360
buffer_load_dwordx4 v5, s[4:7], s72 offen offset:1024 lds
v_mfma_f32_16x16x32_bf16 v[200:203], v[64:67], v[48:51], v[200:203]
buffer_load_dword v3, v2, s[44:47], s75 offen sc1
v_mfma_f32_16x16x32_bf16 v[200:203], v[68:71], v[52:55], v[200:203]
ds_read_b64_tr_b16 v[94:95], v15 offset:9216
v_mfma_f32_16x16x32_bf16 v[204:207], v[68:71], v[60:63], v[204:207]
ds_read_b128 v[108:111], v19 offset:2048
v_mfma_f32_16x16x32_bf16 v[204:207], v[64:67], v[56:59], v[204:207]
s_waitcnt lgkmcnt(11)
v_mfma_f32_16x16x32_bf16 v[220:223], v[72:75], v[56:59], v[220:223]
s_add_u32 s72, s69, 129024
buffer_load_dwordx4 v4, s[4:7], s72 offen offset:2048 lds
v_mfma_f32_16x16x32_bf16 v[220:223], v[76:79], v[60:63], v[220:223]
ds_read_b128 v[112:115], v18 offset:4096
v_mfma_f32_16x16x32_bf16 v[216:219], v[76:79], v[52:55], v[216:219]
s_waitcnt vmcnt(16) lgkmcnt(2)
ds_read_b128 v[116:119], v19 offset:4096
v_mfma_f32_16x16x32_bf16 v[216:219], v[72:75], v[48:51], v[216:219]
s_barrier
v_mfma_f32_16x16x32_bf16 v[212:215], v[72:75], v[40:43], v[212:215]
ds_read_b64_tr_b16 v[64:65], v8 offset:16384
ds_read_b64_tr_b16 v[66:67], v8 offset:17408
v_mfma_f32_16x16x32_bf16 v[212:215], v[76:79], v[44:47], v[212:215]
ds_read_b64_tr_b16 v[68:69], v8 offset:24576
v_mfma_f32_16x16x32_bf16 v[208:211], v[76:79], v[36:39], v[208:211]
s_add_u32 s72, s69, 144384
buffer_load_dwordx4 v5, s[4:7], s72 offen offset:3072 lds
v_mfma_f32_16x16x32_bf16 v[208:211], v[72:75], v[32:35], v[208:211]
ds_read_b64_tr_b16 v[70:71], v8 offset:25600
v_mfma_f32_16x16x32_bf16 v[224:227], v[80:83], v[32:35], v[224:227]
ds_read_b64_tr_b16 v[72:73], v9 offset:16384
v_mfma_f32_16x16x32_bf16 v[224:227], v[84:87], v[36:39], v[224:227]
ds_read_b64_tr_b16 v[74:75], v9 offset:17408
v_mfma_f32_16x16x32_bf16 v[228:231], v[84:87], v[44:47], v[228:231]
s_add_u32 m0, s63, 135168
ds_read_b128 v[120:123], v18 offset:6144
v_mfma_f32_16x16x32_bf16 v[228:231], v[80:83], v[40:43], v[228:231]
s_add_u32 s72, s70, 0
buffer_load_dwordx4 v4, s[4:7], s72 offen lds
v_mfma_f32_16x16x32_bf16 v[232:235], v[80:83], v[48:51], v[232:235]
ds_read_b64_tr_b16 v[76:77], v9 offset:24576
v_mfma_f32_16x16x32_bf16 v[232:235], v[84:87], v[52:55], v[232:235]
ds_read_b128 v[124:127], v19 offset:6144
v_mfma_f32_16x16x32_bf16 v[236:239], v[84:87], v[60:63], v[236:239]
ds_read_b64_tr_b16 v[78:79], v9 offset:25600
v_mfma_f32_16x16x32_bf16 v[236:239], v[80:83], v[56:59], v[236:239]
v_mfma_f32_16x16x32_bf16 v[252:255], v[88:91], v[56:59], v[252:255]
s_add_u32 s72, s70, 15360
buffer_load_dwordx4 v5, s[4:7], s72 offen offset:1024 lds
v_mfma_f32_16x16x32_bf16 v[252:255], v[92:95], v[60:63], v[252:255]
ds_read_b64_tr_b16 v[80:81], v10 offset:16384
v_mfma_f32_16x16x32_bf16 v[248:251], v[92:95], v[52:55], v[248:251]
ds_read_b64_tr_b16 v[82:83], v10 offset:17408
v_mfma_f32_16x16x32_bf16 v[248:251], v[88:91], v[48:51], v[248:251]
v_mfma_f32_16x16x32_bf16 v[244:247], v[88:91], v[40:43], v[244:247]
ds_read_b64_tr_b16 v[84:85], v10 offset:24576
v_mfma_f32_16x16x32_bf16 v[244:247], v[92:95], v[44:47], v[244:247]
ds_read_b64_tr_b16 v[86:87], v10 offset:25600
v_mfma_f32_16x16x32_bf16 v[240:243], v[92:95], v[36:39], v[240:243]
s_add_u32 s72, s70, 129024
buffer_load_dwordx4 v4, s[4:7], s72 offen offset:2048 lds
v_mfma_f32_16x16x32_bf16 v[240:243], v[88:91], v[32:35], v[240:243]
s_waitcnt lgkmcnt(5)
v_mfma_f32_16x16x32_bf16 v[128:131], v[64:67], v[96:99], v[128:131]
ds_read_b64_tr_b16 v[88:89], v11 offset:16384
v_mfma_f32_16x16x32_bf16 v[128:131], v[68:71], v[100:103], v[128:131]
ds_read_b64_tr_b16 v[90:91], v11 offset:17408
v_mfma_f32_16x16x32_bf16 v[132:135], v[68:71], v[108:111], v[132:135]
v_mfma_f32_16x16x32_bf16 v[132:135], v[64:67], v[104:107], v[132:135]
s_add_u32 s72, s70, 144384
buffer_load_dwordx4 v5, s[4:7], s72 offen offset:3072 lds
v_mfma_f32_16x16x32_bf16 v[136:139], v[64:67], v[112:115], v[136:139]
ds_read_b64_tr_b16 v[92:93], v11 offset:24576
v_mfma_f32_16x16x32_bf16 v[136:139], v[68:71], v[116:119], v[136:139]
s_lshl_b32 s71, s73, 12
v_mfma_f32_16x16x32_bf16 v[140:143], v[68:71], v[124:127], v[140:143]
s_add_u32 s71, s71, s66
ds_read_b64_tr_b16 v[94:95], v11 offset:25600
v_mfma_f32_16x16x32_bf16 v[140:143], v[64:67], v[120:123], v[140:143]
s_waitcnt lgkmcnt(8)
v_mfma_f32_16x16x32_bf16 v[156:159], v[72:75], v[120:123], v[156:159]
s_add_u32 m0, s64, 0
ds_read_b64_tr_b16 v[64:65], v12 offset:16384
v_mfma_f32_16x16x32_bf16 v[156:159], v[76:79], v[124:127], v[156:159]
s_add_u32 s72, s71, 0
buffer_load_dwordx4 v6, s[12:15], s72 offen lds
v_mfma_f32_16x16x32_bf16 v[152:155], v[76:79], v[116:119], v[152:155]
ds_read_b64_tr_b16 v[66:67], v12 offset:17408
v_mfma_f32_16x16x32_bf16 v[152:155], v[72:75], v[112:115], v[152:155]
v_mfma_f32_16x16x32_bf16 v[148:151], v[72:75], v[104:107], v[148:151]
ds_read_b64_tr_b16 v[68:69], v12 offset:24576
v_mfma_f32_16x16x32_bf16 v[148:151], v[76:79], v[108:111], v[148:151]
ds_read_b64_tr_b16 v[70:71], v12 offset:25600
v_mfma_f32_16x16x32_bf16 v[144:147], v[76:79], v[100:103], v[144:147]
s_add_u32 s72, s71, 31744
buffer_load_dwordx4 v6, s[12:15], s72 offen offset:1024 lds
v_mfma_f32_16x16x32_bf16 v[144:147], v[72:75], v[96:99], v[144:147]
s_waitcnt lgkmcnt(8)
v_mfma_f32_16x16x32_bf16 v[160:163], v[80:83], v[96:99], v[160:163]
ds_read_b64_tr_b16 v[72:73], v13 offset:16384
v_mfma_f32_16x16x32_bf16 v[160:163], v[84:87], v[100:103], v[160:163]
ds_read_b64_tr_b16 v[74:75], v13 offset:17408
v_mfma_f32_16x16x32_bf16 v[164:167], v[84:87], v[108:111], v[164:167]
v_mfma_f32_16x16x32_bf16 v[164:167], v[80:83], v[104:107], v[164:167]
s_add_u32 s72, s71, 63488
buffer_load_dwordx4 v7, s[12:15], s72 offen offset:2048 lds
v_mfma_f32_16x16x32_bf16 v[168:171], v[80:83], v[112:115], v[168:171]
s_waitcnt vmcnt(16)
ds_read_b64_tr_b16 v[76:77], v13 offset:24576
v_mfma_f32_16x16x32_bf16 v[168:171], v[84:87], v[116:119], v[168:171]
ds_read_b128 v[32:35], v18 offset:32768
v_mfma_f32_16x16x32_bf16 v[172:175], v[84:87], v[124:127], v[172:175]
ds_read_b64_tr_b16 v[78:79], v13 offset:25600
v_mfma_f32_16x16x32_bf16 v[172:175], v[80:83], v[120:123], v[172:175]
s_waitcnt lgkmcnt(9)
ds_read_b128 v[36:39], v19 offset:32768
v_mfma_f32_16x16x32_bf16 v[188:191], v[88:91], v[120:123], v[188:191]
s_add_u32 s72, s71, 95232
buffer_load_dwordx4 v7, s[12:15], s72 offen offset:3072 lds
v_mfma_f32_16x16x32_bf16 v[188:191], v[92:95], v[124:127], v[188:191]
v_accvgpr_write_b32 a0, -1
v_accvgpr_write_b32 a1, -1
v_mfma_f32_16x16x32_bf16 v[184:187], v[92:95], v[116:119], v[184:187]
v_accvgpr_write_b32 a2, -1
v_accvgpr_write_b32 a3, -1
v_mfma_f32_16x16x32_bf16 v[184:187], v[88:91], v[112:115], v[184:187]
s_add_u32 s80, s93, 0x3a00000
ds_read_b64_tr_b16 v[80:81], v14 offset:16384
v_mfma_f32_16x16x32_bf16 v[180:183], v[88:91], v[104:107], v[180:183]
ds_read_b64_tr_b16 v[82:83], v14 offset:17408
v_mfma_f32_16x16x32_bf16 v[180:183], v[92:95], v[108:111], v[180:183]
ds_read_b64_tr_b16 v[84:85], v14 offset:24576
v_mfma_f32_16x16x32_bf16 v[176:179], v[92:95], v[100:103], v[176:179]
ds_read_b64_tr_b16 v[86:87], v14 offset:25600
v_mfma_f32_16x16x32_bf16 v[176:179], v[88:91], v[96:99], v[176:179]
s_waitcnt lgkmcnt(10)
ds_read_b128 v[40:43], v18 offset:34816
v_mfma_f32_16x16x32_bf16 v[192:195], v[64:67], v[96:99], v[192:195]
s_waitcnt vmcnt(10)
v_cmp_gt_u32 vcc, 1, v3
s_cbranch_vccnz Lspin4
Lback5:
v_mfma_f32_16x16x32_bf16 v[192:195], v[68:71], v[100:103], v[192:195]
s_add_u32 m0, s64, 49152
ds_read_b64_tr_b16 v[88:89], v15 offset:16384
ds_read_b64_tr_b16 v[90:91], v15 offset:17408
v_mfma_f32_16x16x32_bf16 v[196:199], v[68:71], v[108:111], v[196:199]
s_add_u32 s72, s81, 16384
buffer_load_dwordx4 v1, s[44:47], s72 offen sc1 lds
v_mfma_f32_16x16x32_bf16 v[196:199], v[64:67], v[104:107], v[196:199]
ds_read_b64_tr_b16 v[92:93], v15 offset:24576
v_mfma_f32_16x16x32_bf16 v[200:203], v[64:67], v[112:115], v[200:203]
ds_read_b64_tr_b16 v[94:95], v15 offset:25600
v_mfma_f32_16x16x32_bf16 v[200:203], v[68:71], v[116:119], v[200:203]
buffer_load_dwordx4 v1, s[44:47], s72 offen offset:1024 sc1 lds
v_mfma_f32_16x16x32_bf16 v[204:207], v[68:71], v[124:127], v[204:207]
ds_read_b128 v[44:47], v19 offset:34816
v_mfma_f32_16x16x32_bf16 v[204:207], v[64:67], v[120:123], v[204:207]
s_waitcnt lgkmcnt(11)
v_mfma_f32_16x16x32_bf16 v[220:223], v[72:75], v[120:123], v[220:223]
ds_read_b128 v[48:51], v18 offset:36864
v_mfma_f32_16x16x32_bf16 v[220:223], v[76:79], v[124:127], v[220:223]
ds_read_b128 v[52:55], v19 offset:36864
v_mfma_f32_16x16x32_bf16 v[216:219], v[76:79], v[116:119], v[216:219]
s_waitcnt vmcnt(15) lgkmcnt(3)
buffer_load_dwordx4 v1, s[44:47], s72 offen offset:2048 sc1 lds
v_mfma_f32_16x16x32_bf16 v[216:219], v[72:75], v[112:115], v[216:219]
s_barrier
ds_read_b128 v[56:59], v18 offset:38912
v_mfma_f32_16x16x32_bf16 v[212:215], v[72:75], v[104:107], v[212:215]
ds_read_b64_tr_b16 v[64:65], v8 offset:32768
ds_read_b64_tr_b16 v[66:67], v8 offset:33792
v_mfma_f32_16x16x32_bf16 v[212:215], v[76:79], v[108:111], v[212:215]
ds_read_b64_tr_b16 v[68:69], v8 offset:40960
v_mfma_f32_16x16x32_bf16 v[208:211], v[76:79], v[100:103], v[208:211]
ds_read_b64_tr_b16 v[70:71], v8 offset:41984
v_mfma_f32_16x16x32_bf16 v[208:211], v[72:75], v[96:99], v[208:211]
buffer_load_dwordx4 v1, s[44:47], s72 offen offset:3072 sc1 lds
v_mfma_f32_16x16x32_bf16 v[224:227], v[80:83], v[96:99], v[224:227]
s_add_u32 s81, s81, 0x8000
ds_read_b64_tr_b16 v[72:73], v9 offset:32768
v_mfma_f32_16x16x32_bf16 v[224:227], v[84:87], v[100:103], v[224:227]
s_add_u32 m0, s64, 81920
ds_read_b64_tr_b16 v[74:75], v9 offset:33792
v_mfma_f32_16x16x32_bf16 v[228:231], v[84:87], v[108:111], v[228:231]
s_add_u32 s72, s81, 16384
buffer_load_dwordx4 v1, s[44:47], s72 offen sc1 lds
v_mfma_f32_16x16x32_bf16 v[228:231], v[80:83], v[104:107], v[228:231]
ds_read_b128 v[60:63], v19 offset:38912
v_mfma_f32_16x16x32_bf16 v[232:235], v[80:83], v[112:115], v[232:235]
buffer_load_dwordx4 v1, s[44:47], s72 offen offset:1024 sc1 lds
v_mfma_f32_16x16x32_bf16 v[232:235], v[84:87], v[116:119], v[232:235]
ds_read_b64_tr_b16 v[76:77], v9 offset:40960
v_mfma_f32_16x16x32_bf16 v[236:239], v[84:87], v[124:127], v[236:239]
ds_read_b64_tr_b16 v[78:79], v9 offset:41984
v_mfma_f32_16x16x32_bf16 v[236:239], v[80:83], v[120:123], v[236:239]
v_mfma_f32_16x16x32_bf16 v[252:255], v[88:91], v[120:123], v[252:255]
ds_read_b64_tr_b16 v[80:81], v10 offset:32768
v_mfma_f32_16x16x32_bf16 v[252:255], v[92:95], v[124:127], v[252:255]
buffer_load_dwordx4 v1, s[44:47], s72 offen offset:2048 sc1 lds
v_mfma_f32_16x16x32_bf16 v[248:251], v[92:95], v[116:119], v[248:251]
ds_read_b64_tr_b16 v[82:83], v10 offset:33792
v_mfma_f32_16x16x32_bf16 v[248:251], v[88:91], v[112:115], v[248:251]
v_mfma_f32_16x16x32_bf16 v[244:247], v[88:91], v[104:107], v[244:247]
ds_read_b64_tr_b16 v[84:85], v10 offset:40960
v_mfma_f32_16x16x32_bf16 v[244:247], v[92:95], v[108:111], v[244:247]
buffer_load_dwordx4 v1, s[44:47], s72 offen offset:3072 sc1 lds
v_mfma_f32_16x16x32_bf16 v[240:243], v[92:95], v[100:103], v[240:243]
ds_read_b64_tr_b16 v[86:87], v10 offset:41984
v_mfma_f32_16x16x32_bf16 v[240:243], v[88:91], v[96:99], v[240:243]
s_waitcnt lgkmcnt(6)
LcS:
v_mfma_f32_16x16x32_bf16 v[128:131], v[64:67], v[32:35], v[128:131]
ds_read_b64_tr_b16 v[88:89], v11 offset:32768
v_mfma_f32_16x16x32_bf16 v[128:131], v[68:71], v[36:39], v[128:131]
ds_read_b64_tr_b16 v[90:91], v11 offset:33792
v_mfma_f32_16x16x32_bf16 v[132:135], v[68:71], v[44:47], v[132:135]
s_add_u32 m0, s64, 65536
v_mfma_f32_16x16x32_bf16 v[132:135], v[64:67], v[40:43], v[132:135]
s_add_u32 s72, s81, 0
buffer_load_dwordx4 v1, s[44:47], s72 offen sc1 lds
v_mfma_f32_16x16x32_bf16 v[136:139], v[64:67], v[48:51], v[136:139]
ds_read_b64_tr_b16 v[92:93], v11 offset:40960
v_mfma_f32_16x16x32_bf16 v[136:139], v[68:71], v[52:55], v[136:139]
ds_read_b64_tr_b16 v[94:95], v11 offset:41984
v_mfma_f32_16x16x32_bf16 v[140:143], v[68:71], v[60:63], v[140:143]
v_mfma_f32_16x16x32_bf16 v[140:143], v[64:67], v[56:59], v[140:143]
s_waitcnt lgkmcnt(8)
buffer_load_dwordx4 v1, s[44:47], s72 offen offset:1024 sc1 lds
v_mfma_f32_16x16x32_bf16 v[156:159], v[72:75], v[56:59], v[156:159]
ds_read_b64_tr_b16 v[64:65], v12 offset:32768
v_mfma_f32_16x16x32_bf16 v[156:159], v[76:79], v[60:63], v[156:159]
ds_read_b64_tr_b16 v[66:67], v12 offset:33792
v_mfma_f32_16x16x32_bf16 v[152:155], v[76:79], v[52:55], v[152:155]
v_mfma_f32_16x16x32_bf16 v[152:155], v[72:75], v[48:51], v[152:155]
buffer_load_dwordx4 v1, s[44:47], s72 offen offset:2048 sc1 lds
v_mfma_f32_16x16x32_bf16 v[148:151], v[72:75], v[40:43], v[148:151]
ds_read_b64_tr_b16 v[68:69], v12 offset:40960
v_mfma_f32_16x16x32_bf16 v[148:151], v[76:79], v[44:47], v[148:151]
v_mfma_f32_16x16x32_bf16 v[144:147], v[76:79], v[36:39], v[144:147]
ds_read_b64_tr_b16 v[70:71], v12 offset:41984
v_mfma_f32_16x16x32_bf16 v[144:147], v[72:75], v[32:35], v[144:147]
s_waitcnt lgkmcnt(8)
v_mfma_f32_16x16x32_bf16 v[160:163], v[80:83], v[32:35], v[160:163]
buffer_load_dwordx4 v1, s[44:47], s72 offen offset:3072 sc1 lds
v_mfma_f32_16x16x32_bf16 v[160:163], v[84:87], v[36:39], v[160:163]
ds_read_b64_tr_b16 v[72:73], v13 offset:32768
v_mfma_f32_16x16x32_bf16 v[164:167], v[84:87], v[44:47], v[164:167]
ds_read_b64_tr_b16 v[74:75], v13 offset:33792
v_mfma_f32_16x16x32_bf16 v[164:167], v[80:83], v[40:43], v[164:167]
v_mfma_f32_16x16x32_bf16 v[168:171], v[80:83], v[48:51], v[168:171]
s_waitcnt vmcnt(16)
ds_read_b64_tr_b16 v[76:77], v13 offset:40960
v_mfma_f32_16x16x32_bf16 v[168:171], v[84:87], v[52:55], v[168:171]
ds_read_b128 v[96:99], v16 offset:0
v_mfma_f32_16x16x32_bf16 v[172:175], v[84:87], v[60:63], v[172:175]
ds_read_b64_tr_b16 v[78:79], v13 offset:41984
v_mfma_f32_16x16x32_bf16 v[172:175], v[80:83], v[56:59], v[172:175]
s_waitcnt lgkmcnt(9)
v_mfma_f32_16x16x32_bf16 v[188:191], v[88:91], v[56:59], v[188:191]
ds_read_b64_tr_b16 v[80:81], v14 offset:32768
v_mfma_f32_16x16x32_bf16 v[188:191], v[92:95], v[60:63], v[188:191]
ds_read_b128 v[100:103], v17 offset:0
v_mfma_f32_16x16x32_bf16 v[184:187], v[92:95], v[52:55], v[184:187]
ds_read_b64_tr_b16 v[82:83], v14 offset:33792
v_mfma_f32_16x16x32_bf16 v[184:187], v[88:91], v[48:51], v[184:187]
v_mfma_f32_16x16x32_bf16 v[180:183], v[88:91], v[40:43], v[180:183]
ds_read_b64_tr_b16 v[84:85], v14 offset:40960
v_mfma_f32_16x16x32_bf16 v[180:183], v[92:95], v[44:47], v[180:183]
ds_read_b128 v[104:107], v16 offset:2048
v_mfma_f32_16x16x32_bf16 v[176:179], v[92:95], v[36:39], v[176:179]
ds_read_b64_tr_b16 v[86:87], v14 offset:41984
v_mfma_f32_16x16x32_bf16 v[176:179], v[88:91], v[32:35], v[176:179]
s_waitcnt lgkmcnt(11)
v_mfma_f32_16x16x32_bf16 v[192:195], v[64:67], v[32:35], v[192:195]
ds_read_b64_tr_b16 v[88:89], v15 offset:32768
v_mfma_f32_16x16x32_bf16 v[192:195], v[68:71], v[36:39], v[192:195]
ds_read_b64_tr_b16 v[90:91], v15 offset:33792
v_mfma_f32_16x16x32_bf16 v[196:199], v[68:71], v[44:47], v[196:199]
ds_read_b128 v[108:111], v17 offset:2048
v_mfma_f32_16x16x32_bf16 v[196:199], v[64:67], v[40:43], v[196:199]
ds_read_b64_tr_b16 v[92:93], v15 offset:40960
v_mfma_f32_16x16x32_bf16 v[200:203], v[64:67], v[48:51], v[200:203]
ds_read_b64_tr_b16 v[94:95], v15 offset:41984
v_mfma_f32_16x16x32_bf16 v[200:203], v[68:71], v[52:55], v[200:203]
v_mfma_f32_16x16x32_bf16 v[204:207], v[68:71], v[60:63], v[204:207]
ds_read_b128 v[112:115], v16 offset:4096
v_mfma_f32_16x16x32_bf16 v[204:207], v[64:67], v[56:59], v[204:207]
s_waitcnt lgkmcnt(12)
v_mfma_f32_16x16x32_bf16 v[220:223], v[72:75], v[56:59], v[220:223]
ds_read_b128 v[116:119], v17 offset:4096
v_mfma_f32_16x16x32_bf16 v[220:223], v[76:79], v[60:63], v[220:223]
v_mfma_f32_16x16x32_bf16 v[216:219], v[76:79], v[52:55], v[216:219]
s_waitcnt vmcnt(12) lgkmcnt(2)
ds_read_b128 v[120:123], v16 offset:6144
v_mfma_f32_16x16x32_bf16 v[216:219], v[72:75], v[48:51], v[216:219]
s_barrier
v_mfma_f32_16x16x32_bf16 v[212:215], v[72:75], v[40:43], v[212:215]
s_add_u32 s81, s81, 0x8000
ds_read_b64_tr_b16 v[64:65], v8 offset:0
ds_read_b64_tr_b16 v[66:67], v8 offset:1024
v_mfma_f32_16x16x32_bf16 v[212:215], v[76:79], v[44:47], v[212:215]
s_add_u32 m0, s64, 114688
ds_read_b64_tr_b16 v[68:69], v8 offset:8192
v_mfma_f32_16x16x32_bf16 v[208:211], v[76:79], v[36:39], v[208:211]
s_add_u32 s72, s81, 16384
buffer_load_dwordx4 v1, s[44:47], s72 offen sc1 lds
v_mfma_f32_16x16x32_bf16 v[208:211], v[72:75], v[32:35], v[208:211]
ds_read_b64_tr_b16 v[70:71], v8 offset:9216
v_mfma_f32_16x16x32_bf16 v[224:227], v[80:83], v[32:35], v[224:227]
buffer_load_dwordx4 v1, s[44:47], s72 offen offset:1024 sc1 lds
v_mfma_f32_16x16x32_bf16 v[224:227], v[84:87], v[36:39], v[224:227]
ds_read_b64_tr_b16 v[72:73], v9 offset:0
v_mfma_f32_16x16x32_bf16 v[228:231], v[84:87], v[44:47], v[228:231]
ds_read_b64_tr_b16 v[74:75], v9 offset:1024
v_mfma_f32_16x16x32_bf16 v[228:231], v[80:83], v[40:43], v[228:231]
ds_read_b128 v[124:127], v17 offset:6144
v_mfma_f32_16x16x32_bf16 v[232:235], v[80:83], v[48:51], v[232:235]
ds_read_b64_tr_b16 v[76:77], v9 offset:8192
v_mfma_f32_16x16x32_bf16 v[232:235], v[84:87], v[52:55], v[232:235]
Lstub0:
s_cbranch_execz Lstub4
buffer_store_dwordx4 a[0:3], v1, s[44:47], s80 offen sc1
v_mfma_f32_16x16x32_bf16 v[236:239], v[84:87], v[60:63], v[236:239]
ds_read_b64_tr_b16 v[78:79], v9 offset:9216
v_mfma_f32_16x16x32_bf16 v[236:239], v[80:83], v[56:59], v[236:239]
v_mfma_f32_16x16x32_bf16 v[252:255], v[88:91], v[56:59], v[252:255]
ds_read_b64_tr_b16 v[80:81], v10 offset:0
v_mfma_f32_16x16x32_bf16 v[252:255], v[92:95], v[60:63], v[252:255]
ds_read_b64_tr_b16 v[82:83], v10 offset:1024
v_mfma_f32_16x16x32_bf16 v[248:251], v[92:95], v[52:55], v[248:251]
buffer_load_dwordx4 v1, s[44:47], s72 offen offset:2048 sc1 lds
v_mfma_f32_16x16x32_bf16 v[248:251], v[88:91], v[48:51], v[248:251]
v_mfma_f32_16x16x32_bf16 v[244:247], v[88:91], v[40:43], v[244:247]
ds_read_b64_tr_b16 v[84:85], v10 offset:8192
v_mfma_f32_16x16x32_bf16 v[244:247], v[92:95], v[44:47], v[244:247]
ds_read_b64_tr_b16 v[86:87], v10 offset:9216
v_mfma_f32_16x16x32_bf16 v[240:243], v[92:95], v[36:39], v[240:243]
buffer_load_dwordx4 v1, s[44:47], s72 offen offset:3072 sc1 lds
v_mfma_f32_16x16x32_bf16 v[240:243], v[88:91], v[32:35], v[240:243]
s_waitcnt lgkmcnt(6)
v_mfma_f32_16x16x32_bf16 v[128:131], v[64:67], v[96:99], v[128:131]
ds_read_b64_tr_b16 v[88:89], v11 offset:0
v_mfma_f32_16x16x32_bf16 v[128:131], v[68:71], v[100:103], v[128:131]
ds_read_b64_tr_b16 v[90:91], v11 offset:1024
v_mfma_f32_16x16x32_bf16 v[132:135], v[68:71], v[108:111], v[132:135]
v_mfma_f32_16x16x32_bf16 v[132:135], v[64:67], v[104:107], v[132:135]
buffer_store_dwordx4 a[0:3], v1, s[44:47], s80 offen offset:1024 sc1
v_mfma_f32_16x16x32_bf16 v[136:139], v[64:67], v[112:115], v[136:139]
ds_read_b64_tr_b16 v[92:93], v11 offset:8192
v_mfma_f32_16x16x32_bf16 v[136:139], v[68:71], v[116:119], v[136:139]
v_mfma_f32_16x16x32_bf16 v[140:143], v[68:71], v[124:127], v[140:143]
ds_read_b64_tr_b16 v[94:95], v11 offset:9216
v_mfma_f32_16x16x32_bf16 v[140:143], v[64:67], v[120:123], v[140:143]
s_waitcnt lgkmcnt(8)
v_mfma_f32_16x16x32_bf16 v[156:159], v[72:75], v[120:123], v[156:159]
s_add_u32 m0, s64, 98304
ds_read_b64_tr_b16 v[64:65], v12 offset:0
v_mfma_f32_16x16x32_bf16 v[156:159], v[76:79], v[124:127], v[156:159]
s_add_u32 s72, s81, 0
buffer_load_dwordx4 v1, s[44:47], s72 offen sc1 lds
v_mfma_f32_16x16x32_bf16 v[152:155], v[76:79], v[116:119], v[152:155]
ds_read_b64_tr_b16 v[66:67], v12 offset:1024
v_mfma_f32_16x16x32_bf16 v[152:155], v[72:75], v[112:115], v[152:155]
v_mfma_f32_16x16x32_bf16 v[148:151], v[72:75], v[104:107], v[148:151]
buffer_load_dwordx4 v1, s[44:47], s72 offen offset:1024 sc1 lds
v_mfma_f32_16x16x32_bf16 v[148:151], v[76:79], v[108:111], v[148:151]
ds_read_b64_tr_b16 v[68:69], v12 offset:8192
v_mfma_f32_16x16x32_bf16 v[144:147], v[76:79], v[100:103], v[144:147]
ds_read_b64_tr_b16 v[70:71], v12 offset:9216
v_mfma_f32_16x16x32_bf16 v[144:147], v[72:75], v[96:99], v[144:147]
s_waitcnt lgkmcnt(8)
v_mfma_f32_16x16x32_bf16 v[160:163], v[80:83], v[96:99], v[160:163]
ds_read_b64_tr_b16 v[72:73], v13 offset:0
v_mfma_f32_16x16x32_bf16 v[160:163], v[84:87], v[100:103], v[160:163]
buffer_store_dwordx4 a[0:3], v1, s[44:47], s80 offen offset:2048 sc1
v_mfma_f32_16x16x32_bf16 v[164:167], v[84:87], v[108:111], v[164:167]
ds_read_b64_tr_b16 v[74:75], v13 offset:1024
v_mfma_f32_16x16x32_bf16 v[164:167], v[80:83], v[104:107], v[164:167]
v_mfma_f32_16x16x32_bf16 v[168:171], v[80:83], v[112:115], v[168:171]
ds_read_b64_tr_b16 v[76:77], v13 offset:8192
v_cvt_pk_bf16_f32 v48, v136, v137
v_mfma_f32_16x16x32_bf16 v[168:171], v[84:87], v[116:119], v[168:171]
ds_read_b64_tr_b16 v[78:79], v13 offset:9216
v_cvt_pk_bf16_f32 v49, v138, v139
v_mfma_f32_16x16x32_bf16 v[172:175], v[84:87], v[124:127], v[172:175]
buffer_load_dwordx4 v1, s[44:47], s72 offen offset:2048 sc1 lds
v_mfma_f32_16x16x32_bf16 v[172:175], v[80:83], v[120:123], v[172:175]
s_waitcnt lgkmcnt(8)
v_cvt_pk_bf16_f32 v50, v152, v153
v_cvt_pk_bf16_f32 v51, v154, v155
v_mfma_f32_16x16x32_bf16 v[188:191], v[88:91], v[120:123], v[188:191]
v_add_u32 v2, 0x8000, v1
v_cvt_pk_bf16_f32 v32, v132, v133
v_mfma_f32_16x16x32_bf16 v[188:191], v[92:95], v[124:127], v[188:191]
ds_read_b64_tr_b16 v[80:81], v14 offset:0
v_cvt_pk_bf16_f32 v33, v134, v135
v_mfma_f32_16x16x32_bf16 v[184:187], v[92:95], v[116:119], v[184:187]
buffer_load_dwordx4 v1, s[44:47], s72 offen offset:3072 sc1 lds
v_mfma_f32_16x16x32_bf16 v[184:187], v[88:91], v[112:115], v[184:187]
ds_read_b64_tr_b16 v[82:83], v14 offset:1024
v_cvt_pk_bf16_f32 v34, v148, v149
v_mfma_f32_16x16x32_bf16 v[180:183], v[88:91], v[104:107], v[180:183]
ds_read_b64_tr_b16 v[84:85], v14 offset:8192
v_cvt_pk_bf16_f32 v35, v150, v151
v_mfma_f32_16x16x32_bf16 v[180:183], v[92:95], v[108:111], v[180:183]
ds_read_b64_tr_b16 v[86:87], v14 offset:9216
v_cvt_pk_bf16_f32 v16, v128, v129
v_mfma_f32_16x16x32_bf16 v[176:179], v[92:95], v[100:103], v[176:179]
v_cvt_pk_bf16_f32 v17, v130, v131
v_cvt_pk_bf16_f32 v18, v144, v145
v_mfma_f32_16x16x32_bf16 v[176:179], v[88:91], v[96:99], v[176:179]
s_waitcnt lgkmcnt(8)
buffer_store_dwordx4 a[0:3], v1, s[44:47], s80 offen offset:3072 sc1
v_mfma_f32_16x16x32_bf16 v[192:195], v[64:67], v[96:99], v[192:195]
ds_read_b64_tr_b16 v[88:89], v15 offset:0
v_cvt_pk_bf16_f32 v19, v146, v147
v_mfma_f32_16x16x32_bf16 v[192:195], v[68:71], v[100:103], v[192:195]
ds_read_b64_tr_b16 v[90:91], v15 offset:1024
v_mfma_f32_16x16x32_bf16 v[196:199], v[68:71], v[108:111], v[196:199]
ds_read_b64_tr_b16 v[92:93], v15 offset:8192
v_mfma_f32_16x16x32_bf16 v[196:199], v[64:67], v[104:107], v[196:199]
ds_read_b64_tr_b16 v[94:95], v15 offset:9216
v_mfma_f32_16x16x32_bf16 v[200:203], v[64:67], v[112:115], v[200:203]
v_lshrrev_b32 v3, 1, v0
v_lshlrev_b32 v3, 7, v3
v_mfma_f32_16x16x32_bf16 v[200:203], v[68:71], v[116:119], v[200:203]
buffer_load_dword v4, v3, s[36:39], s93 offen
v_mfma_f32_16x16x32_bf16 v[204:207], v[68:71], v[124:127], v[204:207]
v_cvt_pk_bf16_f32 v52, v168, v169
v_cvt_pk_bf16_f32 v53, v170, v171
v_mfma_f32_16x16x32_bf16 v[204:207], v[64:67], v[120:123], v[204:207]
s_waitcnt lgkmcnt(8)
v_cvt_pk_bf16_f32 v54, v184, v185
v_cvt_pk_bf16_f32 v55, v186, v187
v_mfma_f32_16x16x32_bf16 v[220:223], v[72:75], v[120:123], v[220:223]
v_cvt_pk_bf16_f32 v36, v164, v165
v_cvt_pk_bf16_f32 v37, v166, v167
v_mfma_f32_16x16x32_bf16 v[220:223], v[76:79], v[124:127], v[220:223]
v_cvt_pk_bf16_f32 v38, v180, v181
v_cvt_pk_bf16_f32 v39, v182, v183
v_mfma_f32_16x16x32_bf16 v[216:219], v[76:79], v[116:119], v[216:219]
s_waitcnt vmcnt(21) lgkmcnt(0)
v_cvt_pk_bf16_f32 v20, v160, v161
v_cvt_pk_bf16_f32 v21, v162, v163
v_mfma_f32_16x16x32_bf16 v[216:219], v[72:75], v[112:115], v[216:219]
s_barrier
v_cvt_pk_bf16_f32 v22, v176, v177
v_cvt_pk_bf16_f32 v23, v178, v179
v_mfma_f32_16x16x32_bf16 v[212:215], v[72:75], v[104:107], v[212:215]
ds_read_b128 a[128:131], v2 offset:16384
v_cvt_pk_bf16_f32 v64, v140, v141
v_mfma_f32_16x16x32_bf16 v[212:215], v[76:79], v[108:111], v[212:215]
v_cvt_pk_bf16_f32 v65, v142, v143
v_cvt_pk_bf16_f32 v66, v156, v157
v_mfma_f32_16x16x32_bf16 v[208:211], v[76:79], v[100:103], v[208:211]
ds_read_b128 a[132:135], v2 offset:17408
v_cvt_pk_bf16_f32 v67, v158, v159
v_mfma_f32_16x16x32_bf16 v[208:211], v[72:75], v[96:99], v[208:211]
v_cvt_pk_bf16_f32 v68, v172, v173
v_cvt_pk_bf16_f32 v69, v174, v175
v_mfma_f32_16x16x32_bf16 v[224:227], v[80:83], v[96:99], v[224:227]
ds_read_b128 a[136:139], v2 offset:18432
v_cvt_pk_bf16_f32 v70, v188, v189
v_mfma_f32_16x16x32_bf16 v[224:227], v[84:87], v[100:103], v[224:227]
v_cvt_pk_bf16_f32 v71, v190, v191
v_mfma_f32_16x16x32_bf16 v[228:231], v[84:87], v[108:111], v[228:231]
ds_read_b128 a[140:143], v2 offset:19456
v_mfma_f32_16x16x32_bf16 v[228:231], v[80:83], v[104:107], v[228:231]
v_mfma_f32_16x16x32_bf16 v[232:235], v[80:83], v[112:115], v[232:235]
ds_read_b128 a[144:147], v2 offset:20480
v_cvt_pk_bf16_f32 v72, v204, v205
v_mfma_f32_16x16x32_bf16 v[232:235], v[84:87], v[116:119], v[232:235]
v_cvt_pk_bf16_f32 v73, v206, v207
v_cvt_pk_bf16_f32 v74, v220, v221
v_mfma_f32_16x16x32_bf16 v[236:239], v[84:87], v[124:127], v[236:239]
ds_read_b128 a[148:151], v2 offset:21504
v_cvt_pk_bf16_f32 v75, v222, v223
v_mfma_f32_16x16x32_bf16 v[236:239], v[80:83], v[120:123], v[236:239]
v_cvt_pk_bf16_f32 v56, v200, v201
v_cvt_pk_bf16_f32 v57, v202, v203
v_mfma_f32_16x16x32_bf16 v[252:255], v[88:91], v[120:123], v[252:255]
ds_read_b128 a[152:155], v2 offset:22528
v_cvt_pk_bf16_f32 v58, v216, v217
v_mfma_f32_16x16x32_bf16 v[252:255], v[92:95], v[124:127], v[252:255]
v_cvt_pk_bf16_f32 v59, v218, v219
v_cvt_pk_bf16_f32 v40, v196, v197
v_mfma_f32_16x16x32_bf16 v[248:251], v[92:95], v[116:119], v[248:251]
ds_read_b128 a[156:159], v2 offset:23552
v_cvt_pk_bf16_f32 v41, v198, v199
v_mfma_f32_16x16x32_bf16 v[248:251], v[88:91], v[112:115], v[248:251]
v_cvt_pk_bf16_f32 v42, v212, v213
v_cvt_pk_bf16_f32 v43, v214, v215
v_mfma_f32_16x16x32_bf16 v[244:247], v[88:91], v[104:107], v[244:247]
v_cvt_pk_bf16_f32 v24, v192, v193
v_cvt_pk_bf16_f32 v25, v194, v195
v_mfma_f32_16x16x32_bf16 v[244:247], v[92:95], v[108:111], v[244:247]
v_cvt_pk_bf16_f32 v26, v208, v209
v_cvt_pk_bf16_f32 v27, v210, v211
v_mfma_f32_16x16x32_bf16 v[240:243], v[92:95], v[100:103], v[240:243]
v_mfma_f32_16x16x32_bf16 v[240:243], v[88:91], v[96:99], v[240:243]
v_cvt_pk_bf16_f32 v76, v236, v237
v_cvt_pk_bf16_f32 v77, v238, v239
v_cvt_pk_bf16_f32 v78, v252, v253
v_cvt_pk_bf16_f32 v79, v254, v255
v_cvt_pk_bf16_f32 v60, v232, v233
v_cvt_pk_bf16_f32 v61, v234, v235
v_cvt_pk_bf16_f32 v62, v248, v249
v_cvt_pk_bf16_f32 v63, v250, v251
v_cvt_pk_bf16_f32 v44, v228, v229
v_cvt_pk_bf16_f32 v45, v230, v231
v_cvt_pk_bf16_f32 v46, v244, v245
v_cvt_pk_bf16_f32 v47, v246, v247
v_cvt_pk_bf16_f32 v28, v224, v225
v_cvt_pk_bf16_f32 v29, v226, v227
v_cvt_pk_bf16_f32 v30, v240, v241
v_cvt_pk_bf16_f32 v31, v242, v243
v_mov_b32 v124, 0xff800000
v_mov_b32 v125, 0xff800000
v_mov_b32 v126, 0xff800000
v_mov_b32 v127, 0xff800000
s_lshl_b32 s84, s60, 2
s_add_u32 s84, s84, s58
s_mov_b32 s86, 0
s_mov_b32 s53, 0
s_lshr_b32 s52, s66, 8
s_and_b32 s52, s52, 31
s_add_u32 s61, s65, s60
s_and_b32 s73, s60, 1
s_lshl_b32 s73, s73, 16
s_add_u32 s77, s73, s64
s_xor_b32 s73, s73, 0x10000
s_mov_b32 s92, s73
s_mul_i32 s62, s58, 4608
s_add_u32 s62, s62, 143104
s_add_u32 s73, s73, 49920
s_cmp_eq_u32 s58, 0
s_cselect_b32 s62, s73, s62
Lattn:
s_mov_b32 s82, 0x10000
s_waitcnt lgkmcnt(0)
v_mfma_f32_16x16x32_bf16 v[136:139], a[128:131], v[48:51], 0
ds_read_b128 a[160:163], v2 offset:24576
v_lshrrev_b32 v240, 4, v0
v_mfma_f32_16x16x32_bf16 v[136:139], a[132:135], v[52:55], v[136:139]
ds_read_b128 a[164:167], v2 offset:25600
v_and_b32 v241, 15, v0
v_mfma_f32_16x16x32_bf16 v[136:139], a[136:139], v[56:59], v[136:139]
ds_read_b128 a[168:171], v2 offset:26624
v_lshlrev_b32 v240, 2, v240
v_mfma_f32_16x16x32_bf16 v[136:139], a[140:143], v[60:63], v[136:139]
ds_read_b128 a[172:175], v2 offset:27648
v_sub_u32 v240, v241, v240
v_mfma_f32_16x16x32_bf16 v[140:143], a[140:143], v[76:79], 0
ds_read_b128 a[176:179], v2 offset:28672
v_mov_b32 v112, 0xff800000
v_mfma_f32_16x16x32_bf16 v[140:143], a[136:139], v[72:75], v[140:143]
ds_read_b128 a[180:183], v2 offset:29696
v_mov_b32 v113, 0xff800000
v_mfma_f32_16x16x32_bf16 v[140:143], a[132:135], v[68:71], v[140:143]
ds_read_b128 a[184:187], v2 offset:30720
v_mov_b32 v114, 0xff800000
v_mfma_f32_16x16x32_bf16 v[140:143], a[128:131], v[64:67], v[140:143]
ds_read_b128 a[188:191], v2 offset:31744
v_mov_b32 v115, 0xff800000
v_mfma_f32_16x16x32_bf16 v[156:159], a[144:147], v[64:67], 0
v_cmp_gt_i32 vcc, 0, v240
v_and_b32 v120, 3, v0
v_mfma_f32_16x16x32_bf16 v[156:159], a[148:151], v[68:71], v[156:159]
v_cndmask_b32 v116, 0, v112, vcc
v_cmp_gt_i32 vcc, 1, v240
v_mfma_f32_16x16x32_bf16 v[156:159], a[152:155], v[72:75], v[156:159]
v_subrev_u32 v120, 1, v120
v_cndmask_b32 v117, 0, v112, vcc
v_mfma_f32_16x16x32_bf16 v[156:159], a[156:159], v[76:79], v[156:159]
v_cmp_gt_i32 vcc, 2, v240
v_ashrrev_i32 v120, 31, v120
v_mfma_f32_16x16x32_bf16 v[152:155], a[156:159], v[60:63], 0
v_cndmask_b32 v118, 0, v112, vcc
v_cmp_gt_i32 vcc, 3, v240
v_mfma_f32_16x16x32_bf16 v[152:155], a[152:155], v[56:59], v[152:155]
v_and_b32 v120, 0x3f803f80, v120
v_cndmask_b32 v119, 0, v112, vcc
v_mfma_f32_16x16x32_bf16 v[152:155], a[148:151], v[52:55], v[152:155]
v_mov_b32 v228, 0
v_mov_b32 v229, 0
v_mfma_f32_16x16x32_bf16 v[152:155], a[144:147], v[48:51], v[152:155]
v_mov_b32 v230, 0
v_mov_b32 v231, 0
s_cmp_eq_u32 s84, 0
s_cbranch_scc1 Lta7
s_cmp_eq_u32 s84, 1
s_cbranch_scc1 Lnt8
v_mfma_f32_16x16x32_bf16 v[128:131], a[128:131], v[16:19], 0
v_mov_b32 v236, 0
v_mov_b32 v237, 0
v_mfma_f32_16x16x32_bf16 v[144:147], a[144:147], v[16:19], 0
v_mov_b32 v238, 0
v_mov_b32 v239, 0
s_branch Ljoin9
Lta7:
v_mfma_f32_16x16x32_bf16 v[128:131], a[128:131], v[16:19], v[116:119]
v_mov_b32 v236, 0
v_mov_b32 v237, 0
v_mfma_f32_16x16x32_bf16 v[144:147], a[144:147], v[16:19], v[112:115]
v_mov_b32 v238, 0
v_mov_b32 v239, 0
s_branch Ljoin9
Lnt8:
v_mfma_f32_16x16x32_bf16 v[128:131], a[128:131], v[16:19], 0
v_mov_b32 v236, 0
v_mov_b32 v237, 0
v_mfma_f32_16x16x32_bf16 v[144:147], a[144:147], v[16:19], v[116:119]
v_mov_b32 v238, 0
v_mov_b32 v239, 0
Ljoin9:
v_mfma_f32_16x16x32_bf16 v[128:131], a[132:135], v[20:23], v[128:131]
v_mov_b32 v121, v120
v_mov_b32 v122, v120
v_mfma_f32_16x16x32_bf16 v[128:131], a[136:139], v[24:27], v[128:131]
v_mov_b32 v123, v120
v_mfma_f32_16x16x32_bf16 v[128:131], a[140:143], v[28:31], v[128:131]
v_max3_f32 v240, v136, v137, v126
v_max3_f32 v242, v140, v141, v127
v_mfma_f32_16x16x32_bf16 v[132:135], a[140:143], v[44:47], 0
v_max3_f32 v240, v240, v138, v139
v_max3_f32 v242, v242, v142, v143
v_mfma_f32_16x16x32_bf16 v[132:135], a[136:139], v[40:43], v[132:135]
v_max3_f32 v240, v240, v152, v153
v_max3_f32 v242, v242, v156, v157
v_mfma_f32_16x16x32_bf16 v[132:135], a[132:135], v[36:39], v[132:135]
v_max3_f32 v240, v240, v154, v155
v_max3_f32 v242, v242, v158, v159
v_mfma_f32_16x16x32_bf16 v[132:135], a[128:131], v[32:35], v[132:135]
v_mov_b32 v241, v240
v_mov_b32 v243, v242
v_mfma_f32_16x16x32_bf16 v[148:151], a[144:147], v[32:35], 0
v_permlane16_swap_b32 v240, v241
v_permlane16_swap_b32 v242, v243
v_mfma_f32_16x16x32_bf16 v[148:151], a[148:151], v[36:39], v[148:151]
v_max_f32 v240, v240, v241
v_max_f32 v242, v242, v243
v_mfma_f32_16x16x32_bf16 v[148:151], a[152:155], v[40:43], v[148:151]
v_mov_b32 v241, v240
v_mov_b32 v243, v242
v_mfma_f32_16x16x32_bf16 v[148:151], a[156:159], v[44:47], v[148:151]
v_permlane32_swap_b32 v240, v241
v_permlane32_swap_b32 v242, v243
v_mfma_f32_16x16x32_bf16 v[144:147], a[156:159], v[28:31], v[144:147]
v_max_f32 v240, v240, v241
v_max_f32 v242, v242, v243
v_mfma_f32_16x16x32_bf16 v[144:147], a[152:155], v[24:27], v[144:147]
v_mfma_f32_16x16x32_bf16 v[144:147], a[148:151], v[20:23], v[144:147]
v_sub_f32 v88, 0, v240
v_sub_f32 v89, 0, v240
v_pk_add_f32 v[90:91], v[88:89], 0
v_pk_add_f32 v[104:105], v[116:117], v[88:89]
v_pk_add_f32 v[106:107], v[118:119], v[88:89]
v_pk_add_f32 v[136:137], v[136:137], v[88:89]
v_pk_add_f32 v[138:139], v[138:139], v[88:89]
v_pk_add_f32 v[152:153], v[152:153], v[88:89]
v_pk_add_f32 v[154:155], v[154:155], v[88:89]
v_sub_f32 v92, 0, v242
v_sub_f32 v93, 0, v242
v_pk_add_f32 v[94:95], v[92:93], 0
v_pk_add_f32 v[108:109], v[116:117], v[92:93]
v_pk_add_f32 v[110:111], v[118:119], v[92:93]
v_pk_add_f32 v[140:141], v[140:141], v[92:93]
v_pk_add_f32 v[142:143], v[142:143], v[92:93]
v_pk_add_f32 v[156:157], v[156:157], v[92:93]
v_pk_add_f32 v[158:159], v[158:159], v[92:93]
v_max3_f32 v240, v128, v129, v124
v_max3_f32 v242, v132, v133, v125
v_max3_f32 v240, v240, v130, v131
v_max3_f32 v242, v242, v134, v135
v_max3_f32 v240, v240, v144, v145
v_max3_f32 v242, v242, v148, v149
v_max3_f32 v240, v240, v146, v147
v_max3_f32 v242, v242, v150, v151
v_mov_b32 v241, v240
v_mov_b32 v243, v242
s_nop 0
v_permlane16_swap_b32 v240, v241
v_permlane16_swap_b32 v242, v243
v_max_f32 v240, v240, v241
v_max_f32 v242, v242, v243
v_mov_b32 v241, v240
v_mov_b32 v243, v242
s_nop 0
v_permlane32_swap_b32 v240, v241
v_permlane32_swap_b32 v242, v243
v_max_f32 v240, v240, v241
v_max_f32 v242, v242, v243
v_sub_f32 v80, 0, v240
v_sub_f32 v81, 0, v240
v_pk_add_f32 v[82:83], v[80:81], 0
v_pk_add_f32 v[96:97], v[116:117], v[80:81]
v_pk_add_f32 v[98:99], v[118:119], v[80:81]
v_pk_add_f32 v[128:129], v[128:129], v[80:81]
v_pk_add_f32 v[130:131], v[130:131], v[80:81]
v_pk_add_f32 v[144:145], v[144:145], v[80:81]
v_pk_add_f32 v[146:147], v[146:147], v[80:81]
v_sub_f32 v84, 0, v242
v_sub_f32 v85, 0, v242
v_pk_add_f32 v[86:87], v[84:85], 0
v_pk_add_f32 v[100:101], v[116:117], v[84:85]
v_pk_add_f32 v[102:103], v[118:119], v[84:85]
v_pk_add_f32 v[132:133], v[132:133], v[84:85]
v_pk_add_f32 v[134:135], v[134:135], v[84:85]
v_pk_add_f32 v[148:149], v[148:149], v[84:85]
v_pk_add_f32 v[150:151], v[150:151], v[84:85]
v_add_u32 v2, s82, v1
s_waitcnt vmcnt(13) lgkmcnt(0)
s_barrier
s_cmp_eq_u32 s60, 0
s_cbranch_scc1 LP0x
v_mfma_f32_16x16x32_bf16 v[164:167], a[160:163], v[32:35], v[84:87]
s_xor_b32 s74, s82, 0x10000
v_exp_f32 v128, v128
v_mfma_f32_16x16x32_bf16 v[164:167], a[164:167], v[36:39], v[164:167]
s_add_u32 s74, s74, s64
ds_read_b128 a[128:131], v2 offset:16384
ds_read_b128 a[132:135], v2 offset:17408
v_mfma_f32_16x16x32_bf16 v[164:167], a[168:171], v[40:43], v[164:167]
s_add_u32 s81, s81, 0x8000
v_exp_f32 v129, v129
v_mfma_f32_16x16x32_bf16 v[164:167], a[172:175], v[44:47], v[164:167]
s_add_u32 m0, s74, 16384
v_exp_f32 v130, v130
v_mfma_f32_16x16x32_bf16 v[172:175], a[172:175], v[76:79], v[92:95]
s_add_u32 s72, s81, 16384
v_exp_f32 v131, v131
v_mfma_f32_16x16x32_bf16 v[172:175], a[168:171], v[72:75], v[172:175]
v_exp_f32 v144, v144
v_mfma_f32_16x16x32_bf16 v[172:175], a[164:167], v[68:71], v[172:175]
s_nop 0
ds_read_b128 a[136:139], v2 offset:18432
ds_read_b128 a[140:143], v2 offset:19456
v_mfma_f32_16x16x32_bf16 v[172:175], a[160:163], v[64:67], v[172:175]
s_nop 0
ds_read_b128 a[144:147], v2 offset:20480
ds_read_b128 a[148:151], v2 offset:21504
v_mfma_f32_16x16x32_bf16 v[188:191], a[176:179], v[64:67], v[92:95]
s_nop 0
ds_read_b128 a[152:155], v2 offset:22528
ds_read_b128 a[156:159], v2 offset:23552
v_mfma_f32_16x16x32_bf16 v[188:191], a[180:183], v[68:71], v[188:191]
s_nop 0
ds_read_b128 a[192:195], v2 offset:0
ds_read_b128 a[196:199], v2 offset:1024
v_mfma_f32_16x16x32_bf16 v[188:191], a[184:187], v[72:75], v[188:191]
s_nop 0
ds_read_b128 a[200:203], v2 offset:2048
ds_read_b128 a[204:207], v2 offset:3072
v_mfma_f32_16x16x32_bf16 v[188:191], a[188:191], v[76:79], v[188:191]
s_nop 0
ds_read_b128 a[208:211], v2 offset:4096
ds_read_b128 a[212:215], v2 offset:5120
v_mfma_f32_16x16x32_bf16 v[180:183], a[188:191], v[44:47], v[84:87]
s_nop 0
ds_read_b128 a[216:219], v2 offset:6144
ds_read_b128 a[220:223], v2 offset:7168
v_mfma_f32_16x16x32_bf16 v[180:183], a[184:187], v[40:43], v[180:183]
v_cvt_pk_bf16_f32 v192, v128, v129
v_cvt_pk_bf16_f32 v193, v130, v131
v_mfma_f32_16x16x32_bf16 v[180:183], a[180:183], v[36:39], v[180:183]
buffer_load_dwordx4 v1, s[44:47], s72 offen sc1 lds
v_mfma_f32_16x16x32_bf16 v[180:183], a[176:179], v[32:35], v[180:183]
v_exp_f32 v145, v145
v_mfma_f32_16x16x32_bf16 v[160:163], a[160:163], v[16:19], v[80:83]
v_exp_f32 v146, v146
v_mfma_f32_16x16x32_bf16 v[160:163], a[164:167], v[20:23], v[160:163]
v_exp_f32 v147, v147
v_mfma_f32_16x16x32_bf16 v[160:163], a[168:171], v[24:27], v[160:163]
v_exp_f32 v136, v136
v_mfma_f32_16x16x32_bf16 v[160:163], a[172:175], v[28:31], v[160:163]
v_cvt_pk_bf16_f32 v194, v144, v145
v_cvt_pk_bf16_f32 v195, v146, v147
v_mfma_f32_16x16x32_bf16 v[168:171], a[172:175], v[60:63], v[88:91]
v_exp_f32 v137, v137
v_mfma_f32_16x16x32_bf16 v[168:171], a[168:171], v[56:59], v[168:171]
v_exp_f32 v138, v138
v_mfma_f32_16x16x32_bf16 v[168:171], a[164:167], v[52:55], v[168:171]
v_exp_f32 v139, v139
v_mfma_f32_16x16x32_bf16 v[168:171], a[160:163], v[48:51], v[168:171]
v_exp_f32 v152, v152
v_mfma_f32_16x16x32_bf16 v[184:187], a[176:179], v[48:51], v[88:91]
v_cvt_pk_bf16_f32 v200, v136, v137
v_cvt_pk_bf16_f32 v201, v138, v139
v_mfma_f32_16x16x32_bf16 v[184:187], a[180:183], v[52:55], v[184:187]
buffer_load_dwordx4 v1, s[44:47], s72 offen offset:1024 sc1 lds
v_mfma_f32_16x16x32_bf16 v[184:187], a[184:187], v[56:59], v[184:187]
v_exp_f32 v153, v153
v_mfma_f32_16x16x32_bf16 v[184:187], a[188:191], v[60:63], v[184:187]
v_exp_f32 v154, v154
v_mfma_f32_16x16x32_bf16 v[176:179], a[188:191], v[28:31], v[80:83]
v_exp_f32 v155, v155
v_mfma_f32_16x16x32_bf16 v[176:179], a[184:187], v[24:27], v[176:179]
buffer_load_dwordx4 v1, s[44:47], s72 offen offset:2048 sc1 lds
v_mfma_f32_16x16x32_bf16 v[176:179], a[180:183], v[20:23], v[176:179]
buffer_load_dwordx4 v1, s[44:47], s72 offen offset:3072 sc1 lds
v_mfma_f32_16x16x32_bf16 v[176:179], a[176:179], v[16:19], v[176:179]
s_waitcnt lgkmcnt(4)
v_exp_f32 v132, v132
v_cvt_pk_bf16_f32 v202, v152, v153
v_cvt_pk_bf16_f32 v203, v154, v155
v_exp_f32 v133, v133
v_exp_f32 v134, v134
v_cvt_pk_bf16_f32 v196, v132, v133
v_exp_f32 v135, v135
v_exp_f32 v148, v148
v_cvt_pk_bf16_f32 v197, v134, v135
v_exp_f32 v149, v149
v_exp_f32 v150, v150
v_cvt_pk_bf16_f32 v198, v148, v149
v_exp_f32 v151, v151
v_exp_f32 v140, v140
v_cvt_pk_bf16_f32 v199, v150, v151
v_exp_f32 v141, v141
v_exp_f32 v142, v142
v_cvt_pk_bf16_f32 v204, v140, v141
v_exp_f32 v143, v143
v_exp_f32 v156, v156
v_cvt_pk_bf16_f32 v205, v142, v143
v_exp_f32 v157, v157
v_exp_f32 v158, v158
v_cvt_pk_bf16_f32 v206, v156, v157
v_exp_f32 v159, v159
s_nop 0
v_cvt_pk_bf16_f32 v207, v158, v159
v_mfma_f32_16x16x32_bf16 v[224:227], v[120:123], v[192:195], 0
s_add_u32 s82, s82, 0x8000
ds_read_b128 a[160:163], v2 offset:24576
ds_read_b128 a[164:167], v2 offset:25600
v_mfma_f32_16x16x32_bf16 v[232:235], v[120:123], v[200:203], 0
s_and_b32 s82, s82, 0x1ffff
v_exp_f32 v164, v164
v_mfma_f32_16x16x32_bf16 a[0:3], a[192:195], v[192:195], 0
s_add_u32 m0, s74, 0
v_exp_f32 v165, v165
v_mfma_f32_16x16x32_bf16 a[64:67], a[192:195], v[200:203], 0
s_add_u32 s72, s81, 0
v_exp_f32 v166, v166
v_mfma_f32_16x16x32_bf16 a[68:71], a[196:199], v[200:203], 0
buffer_load_dwordx4 v1, s[44:47], s72 offen sc1 lds
v_mfma_f32_16x16x32_bf16 a[4:7], a[196:199], v[192:195], 0
v_exp_f32 v167, v167
v_mfma_f32_16x16x32_bf16 a[8:11], a[200:203], v[192:195], 0
ds_read_b128 a[168:171], v2 offset:26624
v_cvt_pk_bf16_f32 v212, v164, v165
v_mfma_f32_16x16x32_bf16 a[72:75], a[200:203], v[200:203], 0
v_exp_f32 v180, v180
v_mfma_f32_16x16x32_bf16 a[76:79], a[204:207], v[200:203], 0
v_exp_f32 v181, v181
v_mfma_f32_16x16x32_bf16 a[12:15], a[204:207], v[192:195], 0
s_waitcnt lgkmcnt(3)
ds_read_b128 a[172:175], v2 offset:27648
v_cvt_pk_bf16_f32 v213, v166, v167
v_mfma_f32_16x16x32_bf16 a[16:19], a[208:211], v[192:195], 0
v_exp_f32 v182, v182
v_mfma_f32_16x16x32_bf16 a[80:83], a[208:211], v[200:203], 0
buffer_load_dwordx4 v1, s[44:47], s72 offen offset:1024 sc1 lds
v_mfma_f32_16x16x32_bf16 a[84:87], a[212:215], v[200:203], 0
v_exp_f32 v183, v183
v_mfma_f32_16x16x32_bf16 a[20:23], a[212:215], v[192:195], 0
s_nop 0
ds_read_b128 a[176:179], v2 offset:28672
ds_read_b128 a[180:183], v2 offset:29696
v_mfma_f32_16x16x32_bf16 a[24:27], a[216:219], v[192:195], 0
v_exp_f32 v172, v172
v_mfma_f32_16x16x32_bf16 a[88:91], a[216:219], v[200:203], 0
s_nop 0
ds_read_b128 a[184:187], v2 offset:30720
ds_read_b128 a[188:191], v2 offset:31744
v_mfma_f32_16x16x32_bf16 a[92:95], a[220:223], v[200:203], 0
s_nop 0
ds_read_b128 a[224:227], v2 offset:8192
ds_read_b128 a[228:231], v2 offset:9216
v_mfma_f32_16x16x32_bf16 a[28:31], a[220:223], v[192:195], 0
s_nop 0
ds_read_b128 a[232:235], v2 offset:10240
ds_read_b128 a[236:239], v2 offset:11264
v_mfma_f32_16x16x32_bf16 v[128:131], a[128:131], v[16:19], v[80:83]
s_nop 0
ds_read_b128 a[240:243], v2 offset:12288
ds_read_b128 a[244:247], v2 offset:13312
v_mfma_f32_16x16x32_bf16 v[128:131], a[132:135], v[20:23], v[128:131]
s_nop 0
ds_read_b128 a[248:251], v2 offset:14336
ds_read_b128 a[252:255], v2 offset:15360
v_mfma_f32_16x16x32_bf16 v[128:131], a[136:139], v[24:27], v[128:131]
v_cvt_pk_bf16_f32 v214, v180, v181
v_cvt_pk_bf16_f32 v215, v182, v183
v_mfma_f32_16x16x32_bf16 v[128:131], a[140:143], v[28:31], v[128:131]
v_exp_f32 v173, v173
v_mfma_f32_16x16x32_bf16 v[136:139], a[140:143], v[60:63], v[88:91]
v_exp_f32 v174, v174
v_mfma_f32_16x16x32_bf16 v[136:139], a[136:139], v[56:59], v[136:139]
buffer_load_dwordx4 v1, s[44:47], s72 offen offset:2048 sc1 lds
v_mfma_f32_16x16x32_bf16 v[136:139], a[132:135], v[52:55], v[136:139]
v_exp_f32 v175, v175
v_mfma_f32_16x16x32_bf16 v[136:139], a[128:131], v[48:51], v[136:139]
v_exp_f32 v188, v188
v_mfma_f32_16x16x32_bf16 v[152:155], a[144:147], v[48:51], v[88:91]
v_cvt_pk_bf16_f32 v220, v172, v173
v_cvt_pk_bf16_f32 v221, v174, v175
v_mfma_f32_16x16x32_bf16 v[152:155], a[148:151], v[52:55], v[152:155]
v_exp_f32 v189, v189
v_mfma_f32_16x16x32_bf16 v[152:155], a[152:155], v[56:59], v[152:155]
v_exp_f32 v190, v190
v_mfma_f32_16x16x32_bf16 v[152:155], a[156:159], v[60:63], v[152:155]
buffer_load_dwordx4 v1, s[44:47], s72 offen offset:3072 sc1 lds
v_mfma_f32_16x16x32_bf16 v[144:147], a[156:159], v[28:31], v[80:83]
s_add_u32 s66, s58, 1
v_exp_f32 v191, v191
v_mfma_f32_16x16x32_bf16 v[144:147], a[152:155], v[24:27], v[144:147]
s_and_b32 s66, s66, 3
v_exp_f32 v160, v160
v_mfma_f32_16x16x32_bf16 v[144:147], a[148:151], v[20:23], v[144:147]
s_mul_i32 s66, s66, 4160
v_cvt_pk_bf16_f32 v222, v188, v189
v_cvt_pk_bf16_f32 v223, v190, v191
v_mfma_f32_16x16x32_bf16 v[144:147], a[144:147], v[16:19], v[144:147]
s_add_u32 m0, s66, 131104
v_exp_f32 v161, v161
v_mfma_f32_16x16x32_bf16 v[132:135], a[128:131], v[32:35], v[84:87]
s_add_u32 s72, s93, 0x2
buffer_load_dwordx4 v1, s[36:39], s72 offen lds
v_mfma_f32_16x16x32_bf16 v[132:135], a[132:135], v[36:39], v[132:135]
Lstub1:
s_cbranch_execz Lstub5
v_exp_f32 v162, v162
v_mfma_f32_16x16x32_bf16 v[132:135], a[136:139], v[40:43], v[132:135]
v_exp_f32 v163, v163
v_mfma_f32_16x16x32_bf16 v[132:135], a[140:143], v[44:47], v[132:135]
v_exp_f32 v176, v176
v_mfma_f32_16x16x32_bf16 v[140:143], a[140:143], v[76:79], v[92:95]
v_cvt_pk_bf16_f32 v208, v160, v161
v_cvt_pk_bf16_f32 v209, v162, v163
v_mfma_f32_16x16x32_bf16 v[140:143], a[136:139], v[72:75], v[140:143]
v_exp_f32 v177, v177
v_mfma_f32_16x16x32_bf16 v[140:143], a[132:135], v[68:71], v[140:143]
buffer_load_dwordx4 v1, s[36:39], s72 offen offset:1024 lds
v_mfma_f32_16x16x32_bf16 v[140:143], a[128:131], v[64:67], v[140:143]
v_exp_f32 v178, v178
v_mfma_f32_16x16x32_bf16 v[156:159], a[144:147], v[64:67], v[92:95]
v_exp_f32 v179, v179
v_mfma_f32_16x16x32_bf16 v[156:159], a[148:151], v[68:71], v[156:159]
v_exp_f32 v168, v168
v_mfma_f32_16x16x32_bf16 v[156:159], a[152:155], v[72:75], v[156:159]
v_cvt_pk_bf16_f32 v210, v176, v177
v_cvt_pk_bf16_f32 v211, v178, v179
v_mfma_f32_16x16x32_bf16 v[156:159], a[156:159], v[76:79], v[156:159]
v_exp_f32 v169, v169
v_mfma_f32_16x16x32_bf16 v[148:151], a[156:159], v[44:47], v[84:87]
buffer_load_dwordx4 v1, s[36:39], s72 offen offset:2048 lds
v_mfma_f32_16x16x32_bf16 v[148:151], a[152:155], v[40:43], v[148:151]
buffer_load_dwordx4 v1, s[36:39], s72 offen offset:3072 lds
v_mfma_f32_16x16x32_bf16 v[148:151], a[148:151], v[36:39], v[148:151]
s_waitcnt vmcnt(12) lgkmcnt(4)
v_exp_f32 v170, v170
v_mfma_f32_16x16x32_bf16 v[148:151], a[144:147], v[32:35], v[148:151]
s_barrier
v_exp_f32 v171, v171
v_add_u32 v2, s82, v1
v_cvt_pk_bf16_f32 v216, v168, v169
v_exp_f32 v184, v184
v_cvt_pk_bf16_f32 v217, v170, v171
v_exp_f32 v185, v185
v_exp_f32 v186, v186
v_cvt_pk_bf16_f32 v218, v184, v185
v_exp_f32 v187, v187
s_nop 0
v_cvt_pk_bf16_f32 v219, v186, v187
s_lshl_b32 s75, s59, 4
s_and_b32 s76, s84, 15
s_add_u32 s75, s75, s76
s_lshl_b32 s75, s75, 14
s_cmp_ge_u32 s60, 4
s_cselect_b32 s75, s75, 0x40001000
s_lshl_b32 s83, s60, 1
s_sub_u32 s83, 2, s83
s_cmp_eq_u32 s83, 0
s_cbranch_scc1 LLT1
.p2align 5
s_nop 0
s_nop 0
LloopI:
v_mfma_f32_16x16x32_bf16 v[228:231], v[120:123], v[196:199], v[228:231]
s_xor_b32 s74, s82, 0x10000
v_exp_f32 v128, v128
v_mfma_f32_16x16x32_bf16 v[228:231], v[120:123], v[212:215], v[228:231]
s_add_u32 s74, s74, s64
ds_read_b128 a[128:131], v2 offset:16384
v_add_u32 v15, s75, v3
v_mfma_f32_16x16x32_bf16 v[236:239], v[120:123], v[204:207], v[236:239]
s_add_u32 s81, s81, 0x8000
v_exp_f32 v129, v129
v_mfma_f32_16x16x32_bf16 v[236:239], v[120:123], v[220:223], v[236:239]
s_add_u32 m0, s74, 16384
v_exp_f32 v130, v130
v_mfma_f32_16x16x32_bf16 a[32:35], a[192:195], v[196:199], a[32:35]
s_add_u32 s72, s81, 16384
ds_read_b128 a[132:135], v2 offset:17408
v_cvt_pk_bf16_f32 v192, v128, v129
v_mfma_f32_16x16x32_bf16 a[32:35], a[224:227], v[212:215], a[32:35]
v_exp_f32 v131, v131
v_mfma_f32_16x16x32_bf16 a[96:99], a[224:227], v[220:223], a[96:99]
v_exp_f32 v144, v144
v_mfma_f32_16x16x32_bf16 a[96:99], a[192:195], v[204:207], a[96:99]
ds_read_b128 a[136:139], v2 offset:18432
v_cvt_pk_bf16_f32 v193, v130, v131
v_mfma_f32_16x16x32_bf16 a[100:103], a[196:199], v[204:207], a[100:103]
buffer_load_dwordx4 v1, s[44:47], s72 offen sc1 lds
v_mfma_f32_16x16x32_bf16 a[100:103], a[228:231], v[220:223], a[100:103]
v_exp_f32 v145, v145
v_mfma_f32_16x16x32_bf16 a[36:39], a[228:231], v[212:215], a[36:39]
v_exp_f32 v146, v146
v_mfma_f32_16x16x32_bf16 a[36:39], a[196:199], v[196:199], a[36:39]
ds_read_b128 a[140:143], v2 offset:19456
v_cvt_pk_bf16_f32 v194, v144, v145
v_mfma_f32_16x16x32_bf16 a[40:43], a[200:203], v[196:199], a[40:43]
v_exp_f32 v147, v147
v_mfma_f32_16x16x32_bf16 a[40:43], a[232:235], v[212:215], a[40:43]
v_exp_f32 v136, v136
v_mfma_f32_16x16x32_bf16 a[104:107], a[232:235], v[220:223], a[104:107]
ds_read_b128 a[144:147], v2 offset:20480
v_cvt_pk_bf16_f32 v195, v146, v147
v_mfma_f32_16x16x32_bf16 a[104:107], a[200:203], v[204:207], a[104:107]
v_exp_f32 v137, v137
v_mfma_f32_16x16x32_bf16 a[108:111], a[204:207], v[204:207], a[108:111]
v_exp_f32 v138, v138
v_mfma_f32_16x16x32_bf16 a[108:111], a[236:239], v[220:223], a[108:111]
ds_read_b128 a[148:151], v2 offset:21504
v_cvt_pk_bf16_f32 v200, v136, v137
v_mfma_f32_16x16x32_bf16 a[44:47], a[236:239], v[212:215], a[44:47]
v_exp_f32 v139, v139
v_mfma_f32_16x16x32_bf16 a[44:47], a[204:207], v[196:199], a[44:47]
v_exp_f32 v152, v152
v_mfma_f32_16x16x32_bf16 a[48:51], a[208:211], v[196:199], a[48:51]
s_waitcnt lgkmcnt(6)
ds_read_b128 a[152:155], v2 offset:22528
v_cvt_pk_bf16_f32 v201, v138, v139
v_mfma_f32_16x16x32_bf16 a[48:51], a[240:243], v[212:215], a[48:51]
buffer_load_dwordx4 v1, s[44:47], s72 offen offset:1024 sc1 lds
v_mfma_f32_16x16x32_bf16 a[112:115], a[240:243], v[220:223], a[112:115]
v_exp_f32 v153, v153
v_mfma_f32_16x16x32_bf16 a[112:115], a[208:211], v[204:207], a[112:115]
v_exp_f32 v154, v154
v_mfma_f32_16x16x32_bf16 a[116:119], a[212:215], v[204:207], a[116:119]
ds_read_b128 a[156:159], v2 offset:23552
v_cvt_pk_bf16_f32 v202, v152, v153
v_mfma_f32_16x16x32_bf16 a[116:119], a[244:247], v[220:223], a[116:119]
v_exp_f32 v155, v155
v_mfma_f32_16x16x32_bf16 a[52:55], a[244:247], v[212:215], a[52:55]
v_exp_f32 v132, v132
v_mfma_f32_16x16x32_bf16 a[52:55], a[212:215], v[196:199], a[52:55]
ds_read_b128 a[192:195], v2 offset:0
v_cvt_pk_bf16_f32 v203, v154, v155
v_mfma_f32_16x16x32_bf16 a[56:59], a[216:219], v[196:199], a[56:59]
v_exp_f32 v133, v133
v_mfma_f32_16x16x32_bf16 a[56:59], a[248:251], v[212:215], a[56:59]
v_exp_f32 v134, v134
v_mfma_f32_16x16x32_bf16 a[120:123], a[248:251], v[220:223], a[120:123]
ds_read_b128 a[196:199], v2 offset:1024
v_mfma_f32_16x16x32_bf16 a[120:123], a[216:219], v[204:207], a[120:123]
v_exp_f32 v135, v135
v_mfma_f32_16x16x32_bf16 a[124:127], a[220:223], v[204:207], a[124:127]
v_exp_f32 v148, v148
v_mfma_f32_16x16x32_bf16 a[124:127], a[252:255], v[220:223], a[124:127]
ds_read_b128 a[200:203], v2 offset:2048
v_mfma_f32_16x16x32_bf16 a[60:63], a[252:255], v[212:215], a[60:63]
buffer_load_dwordx4 v1, s[44:47], s72 offen offset:2048 sc1 lds
v_mfma_f32_16x16x32_bf16 a[60:63], a[220:223], v[196:199], a[60:63]
ds_read_b128 a[204:207], v2 offset:3072
v_cvt_pk_bf16_f32 v196, v132, v133
v_mfma_f32_16x16x32_bf16 v[164:167], a[160:163], v[32:35], v[84:87]
v_exp_f32 v149, v149
v_mfma_f32_16x16x32_bf16 v[164:167], a[164:167], v[36:39], v[164:167]
v_exp_f32 v150, v150
v_mfma_f32_16x16x32_bf16 v[164:167], a[168:171], v[40:43], v[164:167]
ds_read_b128 a[208:211], v2 offset:4096
v_cvt_pk_bf16_f32 v197, v134, v135
v_mfma_f32_16x16x32_bf16 v[164:167], a[172:175], v[44:47], v[164:167]
v_exp_f32 v151, v151
v_mfma_f32_16x16x32_bf16 v[172:175], a[172:175], v[76:79], v[92:95]
v_exp_f32 v140, v140
v_mfma_f32_16x16x32_bf16 v[172:175], a[168:171], v[72:75], v[172:175]
ds_read_b128 a[212:215], v2 offset:5120
v_cvt_pk_bf16_f32 v198, v148, v149
v_mfma_f32_16x16x32_bf16 v[172:175], a[164:167], v[68:71], v[172:175]
v_exp_f32 v141, v141
v_mfma_f32_16x16x32_bf16 v[172:175], a[160:163], v[64:67], v[172:175]
v_exp_f32 v142, v142
v_mfma_f32_16x16x32_bf16 v[188:191], a[176:179], v[64:67], v[92:95]
ds_read_b128 a[216:219], v2 offset:6144
v_cvt_pk_bf16_f32 v199, v150, v151
v_mfma_f32_16x16x32_bf16 v[188:191], a[180:183], v[68:71], v[188:191]
v_exp_f32 v143, v143
v_mfma_f32_16x16x32_bf16 v[188:191], a[184:187], v[72:75], v[188:191]
v_exp_f32 v156, v156
v_mfma_f32_16x16x32_bf16 v[188:191], a[188:191], v[76:79], v[188:191]
ds_read_b128 a[220:223], v2 offset:7168
v_cvt_pk_bf16_f32 v204, v140, v141
v_mfma_f32_16x16x32_bf16 v[180:183], a[188:191], v[44:47], v[84:87]
buffer_load_dwordx4 v1, s[44:47], s72 offen offset:3072 sc1 lds
v_mfma_f32_16x16x32_bf16 v[180:183], a[184:187], v[40:43], v[180:183]
v_exp_f32 v157, v157
v_mfma_f32_16x16x32_bf16 v[180:183], a[180:183], v[36:39], v[180:183]
v_exp_f32 v158, v158
v_mfma_f32_16x16x32_bf16 v[180:183], a[176:179], v[32:35], v[180:183]
v_cvt_pk_bf16_f32 v205, v142, v143
v_cvt_pk_bf16_f32 v206, v156, v157
v_mfma_f32_16x16x32_bf16 v[160:163], a[160:163], v[16:19], v[80:83]
v_exp_f32 v159, v159
v_mfma_f32_16x16x32_bf16 v[160:163], a[164:167], v[20:23], v[160:163]
v_cvt_pk_bf16_f32 v207, v158, v159
v_mfma_f32_16x16x32_bf16 v[160:163], a[168:171], v[24:27], v[160:163]
v_mfma_f32_16x16x32_bf16 v[160:163], a[172:175], v[28:31], v[160:163]
v_mfma_f32_16x16x32_bf16 v[168:171], a[172:175], v[60:63], v[88:91]
v_mfma_f32_16x16x32_bf16 v[168:171], a[168:171], v[56:59], v[168:171]
v_mfma_f32_16x16x32_bf16 v[168:171], a[164:167], v[52:55], v[168:171]
v_mfma_f32_16x16x32_bf16 v[168:171], a[160:163], v[48:51], v[168:171]
v_mfma_f32_16x16x32_bf16 v[184:187], a[176:179], v[48:51], v[88:91]
v_mfma_f32_16x16x32_bf16 v[184:187], a[180:183], v[52:55], v[184:187]
v_mfma_f32_16x16x32_bf16 v[184:187], a[184:187], v[56:59], v[184:187]
v_mfma_f32_16x16x32_bf16 v[184:187], a[188:191], v[60:63], v[184:187]
v_mfma_f32_16x16x32_bf16 v[176:179], a[188:191], v[28:31], v[80:83]
v_mfma_f32_16x16x32_bf16 v[176:179], a[184:187], v[24:27], v[176:179]
v_mfma_f32_16x16x32_bf16 v[176:179], a[180:183], v[20:23], v[176:179]
v_mfma_f32_16x16x32_bf16 v[176:179], a[176:179], v[16:19], v[176:179]
s_waitcnt lgkmcnt(4)
v_mfma_f32_16x16x32_bf16 v[224:227], v[120:123], v[208:211], v[224:227]
s_add_u32 s82, s82, 0x8000
ds_read_b128 a[160:163], v2 offset:24576
v_mfma_f32_16x16x32_bf16 v[224:227], v[120:123], v[192:195], v[224:227]
s_and_b32 s82, s82, 0x1ffff
v_exp_f32 v164, v164
v_mfma_f32_16x16x32_bf16 v[232:235], v[120:123], v[216:219], v[232:235]
s_add_u32 m0, s74, 0
v_exp_f32 v165, v165
v_mfma_f32_16x16x32_bf16 v[232:235], v[120:123], v[200:203], v[232:235]
s_add_u32 s72, s81, 0
ds_read_b128 a[164:167], v2 offset:25600
v_cvt_pk_bf16_f32 v212, v164, v165
v_mfma_f32_16x16x32_bf16 a[0:3], a[224:227], v[208:211], a[0:3]
v_exp_f32 v166, v166
v_mfma_f32_16x16x32_bf16 a[0:3], a[192:195], v[192:195], a[0:3]
v_exp_f32 v167, v167
v_mfma_f32_16x16x32_bf16 a[64:67], a[192:195], v[200:203], a[64:67]
buffer_load_dwordx4 v1, s[44:47], s72 offen sc1 lds
v_mfma_f32_16x16x32_bf16 a[64:67], a[224:227], v[216:219], a[64:67]
ds_read_b128 a[168:171], v2 offset:26624
v_cvt_pk_bf16_f32 v213, v166, v167
v_mfma_f32_16x16x32_bf16 a[68:71], a[228:231], v[216:219], a[68:71]
v_exp_f32 v180, v180
v_mfma_f32_16x16x32_bf16 a[68:71], a[196:199], v[200:203], a[68:71]
v_exp_f32 v181, v181
v_mfma_f32_16x16x32_bf16 a[4:7], a[196:199], v[192:195], a[4:7]
ds_read_b128 a[172:175], v2 offset:27648
v_cvt_pk_bf16_f32 v214, v180, v181
v_mfma_f32_16x16x32_bf16 a[4:7], a[228:231], v[208:211], a[4:7]
v_exp_f32 v182, v182
v_mfma_f32_16x16x32_bf16 a[8:11], a[232:235], v[208:211], a[8:11]
v_exp_f32 v183, v183
v_mfma_f32_16x16x32_bf16 a[8:11], a[200:203], v[192:195], a[8:11]
ds_read_b128 a[176:179], v2 offset:28672
v_cvt_pk_bf16_f32 v215, v182, v183
v_mfma_f32_16x16x32_bf16 a[72:75], a[200:203], v[200:203], a[72:75]
v_exp_f32 v172, v172
v_mfma_f32_16x16x32_bf16 a[72:75], a[232:235], v[216:219], a[72:75]
v_exp_f32 v173, v173
v_mfma_f32_16x16x32_bf16 a[76:79], a[236:239], v[216:219], a[76:79]
ds_read_b128 a[180:183], v2 offset:29696
v_cvt_pk_bf16_f32 v220, v172, v173
v_mfma_f32_16x16x32_bf16 a[76:79], a[204:207], v[200:203], a[76:79]
buffer_load_dwordx4 v1, s[44:47], s72 offen offset:1024 sc1 lds
v_mfma_f32_16x16x32_bf16 a[12:15], a[204:207], v[192:195], a[12:15]
v_exp_f32 v174, v174
v_mfma_f32_16x16x32_bf16 a[12:15], a[236:239], v[208:211], a[12:15]
v_exp_f32 v175, v175
v_mfma_f32_16x16x32_bf16 a[16:19], a[240:243], v[208:211], a[16:19]
s_waitcnt lgkmcnt(6)
ds_read_b128 a[184:187], v2 offset:30720
v_cvt_pk_bf16_f32 v221, v174, v175
v_mfma_f32_16x16x32_bf16 a[16:19], a[208:211], v[192:195], a[16:19]
v_exp_f32 v188, v188
v_mfma_f32_16x16x32_bf16 a[80:83], a[208:211], v[200:203], a[80:83]
v_exp_f32 v189, v189
v_mfma_f32_16x16x32_bf16 a[80:83], a[240:243], v[216:219], a[80:83]
ds_read_b128 a[188:191], v2 offset:31744
v_cvt_pk_bf16_f32 v222, v188, v189
v_mfma_f32_16x16x32_bf16 a[84:87], a[244:247], v[216:219], a[84:87]
v_exp_f32 v190, v190
v_mfma_f32_16x16x32_bf16 a[84:87], a[212:215], v[200:203], a[84:87]
v_exp_f32 v191, v191
v_mfma_f32_16x16x32_bf16 a[20:23], a[212:215], v[192:195], a[20:23]
ds_read_b128 a[224:227], v2 offset:8192
v_cvt_pk_bf16_f32 v223, v190, v191
v_mfma_f32_16x16x32_bf16 a[20:23], a[244:247], v[208:211], a[20:23]
v_exp_f32 v160, v160
v_mfma_f32_16x16x32_bf16 a[24:27], a[248:251], v[208:211], a[24:27]
buffer_load_dwordx4 v1, s[44:47], s72 offen offset:2048 sc1 lds
v_mfma_f32_16x16x32_bf16 a[24:27], a[216:219], v[192:195], a[24:27]
v_exp_f32 v161, v161
v_mfma_f32_16x16x32_bf16 a[88:91], a[216:219], v[200:203], a[88:91]
ds_read_b128 a[228:231], v2 offset:9216
v_mfma_f32_16x16x32_bf16 a[88:91], a[248:251], v[216:219], a[88:91]
v_exp_f32 v162, v162
v_mfma_f32_16x16x32_bf16 a[92:95], a[252:255], v[216:219], a[92:95]
v_exp_f32 v163, v163
v_mfma_f32_16x16x32_bf16 a[92:95], a[220:223], v[200:203], a[92:95]
ds_read_b128 a[232:235], v2 offset:10240
v_mfma_f32_16x16x32_bf16 a[28:31], a[220:223], v[192:195], a[28:31]
v_exp_f32 v176, v176
v_mfma_f32_16x16x32_bf16 a[28:31], a[252:255], v[208:211], a[28:31]
ds_read_b128 a[236:239], v2 offset:11264
v_cvt_pk_bf16_f32 v208, v160, v161
v_mfma_f32_16x16x32_bf16 v[128:131], a[128:131], v[16:19], v[80:83]
v_exp_f32 v177, v177
v_mfma_f32_16x16x32_bf16 v[128:131], a[132:135], v[20:23], v[128:131]
v_exp_f32 v178, v178
v_mfma_f32_16x16x32_bf16 v[128:131], a[136:139], v[24:27], v[128:131]
ds_read_b128 a[240:243], v2 offset:12288
v_cvt_pk_bf16_f32 v209, v162, v163
v_mfma_f32_16x16x32_bf16 v[128:131], a[140:143], v[28:31], v[128:131]
buffer_load_dwordx4 v1, s[44:47], s72 offen offset:3072 sc1 lds
v_mfma_f32_16x16x32_bf16 v[136:139], a[140:143], v[60:63], v[88:91]
s_add_u32 s75, s75, 0x1000
v_exp_f32 v179, v179
v_mfma_f32_16x16x32_bf16 v[136:139], a[136:139], v[56:59], v[136:139]
s_and_b32 s76, s75, 0x3000
v_exp_f32 v168, v168
v_mfma_f32_16x16x32_bf16 v[136:139], a[132:135], v[52:55], v[136:139]
s_cselect_b32 s75, s75, 0x40001000
ds_read_b128 a[244:247], v2 offset:13312
v_cvt_pk_bf16_f32 v210, v176, v177
v_mfma_f32_16x16x32_bf16 v[136:139], a[128:131], v[48:51], v[136:139]
v_exp_f32 v169, v169
v_mfma_f32_16x16x32_bf16 v[152:155], a[144:147], v[48:51], v[88:91]
v_exp_f32 v170, v170
v_mfma_f32_16x16x32_bf16 v[152:155], a[148:151], v[52:55], v[152:155]
ds_read_b128 a[248:251], v2 offset:14336
v_cvt_pk_bf16_f32 v211, v178, v179
v_mfma_f32_16x16x32_bf16 v[152:155], a[152:155], v[56:59], v[152:155]
v_exp_f32 v171, v171
v_mfma_f32_16x16x32_bf16 v[152:155], a[156:159], v[60:63], v[152:155]
v_exp_f32 v184, v184
v_mfma_f32_16x16x32_bf16 v[144:147], a[156:159], v[28:31], v[80:83]
ds_read_b128 a[252:255], v2 offset:15360
v_cvt_pk_bf16_f32 v216, v168, v169
v_mfma_f32_16x16x32_bf16 v[144:147], a[152:155], v[24:27], v[144:147]
buffer_load_dword v4, v15, s[24:27], 0 offen
v_mfma_f32_16x16x32_bf16 v[144:147], a[148:151], v[20:23], v[144:147]
v_exp_f32 v185, v185
v_mfma_f32_16x16x32_bf16 v[144:147], a[144:147], v[16:19], v[144:147]
v_exp_f32 v186, v186
v_mfma_f32_16x16x32_bf16 v[132:135], a[128:131], v[32:35], v[84:87]
v_cvt_pk_bf16_f32 v217, v170, v171
v_cvt_pk_bf16_f32 v218, v184, v185
v_mfma_f32_16x16x32_bf16 v[132:135], a[132:135], v[36:39], v[132:135]
v_exp_f32 v187, v187
v_mfma_f32_16x16x32_bf16 v[132:135], a[136:139], v[40:43], v[132:135]
v_cvt_pk_bf16_f32 v219, v186, v187
v_add_u32 v2, s82, v1
v_mfma_f32_16x16x32_bf16 v[132:135], a[140:143], v[44:47], v[132:135]
v_mfma_f32_16x16x32_bf16 v[140:143], a[140:143], v[76:79], v[92:95]
v_mfma_f32_16x16x32_bf16 v[140:143], a[136:139], v[72:75], v[140:143]
v_mfma_f32_16x16x32_bf16 v[140:143], a[132:135], v[68:71], v[140:143]
v_mfma_f32_16x16x32_bf16 v[140:143], a[128:131], v[64:67], v[140:143]
v_mfma_f32_16x16x32_bf16 v[156:159], a[144:147], v[64:67], v[92:95]
v_mfma_f32_16x16x32_bf16 v[156:159], a[148:151], v[68:71], v[156:159]
v_mfma_f32_16x16x32_bf16 v[156:159], a[152:155], v[72:75], v[156:159]
v_mfma_f32_16x16x32_bf16 v[156:159], a[156:159], v[76:79], v[156:159]
v_mfma_f32_16x16x32_bf16 v[148:151], a[156:159], v[44:47], v[84:87]
s_waitcnt vmcnt(9) lgkmcnt(4)
v_mfma_f32_16x16x32_bf16 v[148:151], a[152:155], v[40:43], v[148:151]
s_barrier
v_mfma_f32_16x16x32_bf16 v[148:151], a[148:151], v[36:39], v[148:151]
s_add_u32 s83, s83, 1
v_mfma_f32_16x16x32_bf16 v[148:151], a[144:147], v[32:35], v[148:151]
s_cbranch_scc0 LloopI
LLT1:
Lstub2:
s_cbranch_execz Lstub6
v_mfma_f32_16x16x32_bf16 v[228:231], v[120:123], v[196:199], v[228:231]
s_xor_b32 s74, s82, 0x10000
v_exp_f32 v128, v128
v_mfma_f32_16x16x32_bf16 v[228:231], v[120:123], v[212:215], v[228:231]
s_add_u32 s74, s74, s64
ds_read_b128 a[128:131], v2 offset:16384
v_mfma_f32_16x16x32_bf16 v[236:239], v[120:123], v[204:207], v[236:239]
s_add_u32 s81, s81, 0x8000
v_exp_f32 v129, v129
v_mfma_f32_16x16x32_bf16 v[236:239], v[120:123], v[220:223], v[236:239]
s_add_u32 m0, s74, 16384
v_exp_f32 v130, v130
v_mfma_f32_16x16x32_bf16 a[32:35], a[192:195], v[196:199], a[32:35]
s_add_u32 s72, s81, 16384
ds_read_b128 a[132:135], v2 offset:17408
v_cvt_pk_bf16_f32 v192, v128, v129
v_mfma_f32_16x16x32_bf16 a[32:35], a[224:227], v[212:215], a[32:35]
v_exp_f32 v131, v131
v_mfma_f32_16x16x32_bf16 a[96:99], a[224:227], v[220:223], a[96:99]
v_exp_f32 v144, v144
v_mfma_f32_16x16x32_bf16 a[96:99], a[192:195], v[204:207], a[96:99]
ds_read_b128 a[136:139], v2 offset:18432
v_cvt_pk_bf16_f32 v193, v130, v131
v_mfma_f32_16x16x32_bf16 a[100:103], a[196:199], v[204:207], a[100:103]
buffer_load_dwordx4 v1, s[44:47], s72 offen sc1 lds
v_mfma_f32_16x16x32_bf16 a[100:103], a[228:231], v[220:223], a[100:103]
v_exp_f32 v145, v145
v_mfma_f32_16x16x32_bf16 a[36:39], a[228:231], v[212:215], a[36:39]
v_exp_f32 v146, v146
v_mfma_f32_16x16x32_bf16 a[36:39], a[196:199], v[196:199], a[36:39]
ds_read_b128 a[140:143], v2 offset:19456
v_cvt_pk_bf16_f32 v194, v144, v145
v_mfma_f32_16x16x32_bf16 a[40:43], a[200:203], v[196:199], a[40:43]
v_exp_f32 v147, v147
v_mfma_f32_16x16x32_bf16 a[40:43], a[232:235], v[212:215], a[40:43]
v_exp_f32 v136, v136
v_mfma_f32_16x16x32_bf16 a[104:107], a[232:235], v[220:223], a[104:107]
ds_read_b128 a[144:147], v2 offset:20480
v_cvt_pk_bf16_f32 v195, v146, v147
v_mfma_f32_16x16x32_bf16 a[104:107], a[200:203], v[204:207], a[104:107]
v_exp_f32 v137, v137
v_mfma_f32_16x16x32_bf16 a[108:111], a[204:207], v[204:207], a[108:111]
v_exp_f32 v138, v138
v_mfma_f32_16x16x32_bf16 a[108:111], a[236:239], v[220:223], a[108:111]
ds_read_b128 a[148:151], v2 offset:21504
v_cvt_pk_bf16_f32 v200, v136, v137
v_mfma_f32_16x16x32_bf16 a[44:47], a[236:239], v[212:215], a[44:47]
v_exp_f32 v139, v139
v_mfma_f32_16x16x32_bf16 a[44:47], a[204:207], v[196:199], a[44:47]
v_exp_f32 v152, v152
v_mfma_f32_16x16x32_bf16 a[48:51], a[208:211], v[196:199], a[48:51]
s_waitcnt lgkmcnt(6)
ds_read_b128 a[152:155], v2 offset:22528
v_cvt_pk_bf16_f32 v201, v138, v139
v_mfma_f32_16x16x32_bf16 a[48:51], a[240:243], v[212:215], a[48:51]
buffer_load_dwordx4 v1, s[44:47], s72 offen offset:1024 sc1 lds
v_mfma_f32_16x16x32_bf16 a[112:115], a[240:243], v[220:223], a[112:115]
v_exp_f32 v153, v153
v_mfma_f32_16x16x32_bf16 a[112:115], a[208:211], v[204:207], a[112:115]
v_exp_f32 v154, v154
v_mfma_f32_16x16x32_bf16 a[116:119], a[212:215], v[204:207], a[116:119]
ds_read_b128 a[156:159], v2 offset:23552
v_cvt_pk_bf16_f32 v202, v152, v153
v_mfma_f32_16x16x32_bf16 a[116:119], a[244:247], v[220:223], a[116:119]
v_exp_f32 v155, v155
v_mfma_f32_16x16x32_bf16 a[52:55], a[244:247], v[212:215], a[52:55]
v_exp_f32 v132, v132
v_mfma_f32_16x16x32_bf16 a[52:55], a[212:215], v[196:199], a[52:55]
ds_read_b128 a[192:195], v2 offset:0
v_cvt_pk_bf16_f32 v203, v154, v155
v_mfma_f32_16x16x32_bf16 a[56:59], a[216:219], v[196:199], a[56:59]
v_exp_f32 v133, v133
v_mfma_f32_16x16x32_bf16 a[56:59], a[248:251], v[212:215], a[56:59]
v_exp_f32 v134, v134
v_mfma_f32_16x16x32_bf16 a[120:123], a[248:251], v[220:223], a[120:123]
ds_read_b128 a[196:199], v2 offset:1024
v_mfma_f32_16x16x32_bf16 a[120:123], a[216:219], v[204:207], a[120:123]
v_exp_f32 v135, v135
v_mfma_f32_16x16x32_bf16 a[124:127], a[220:223], v[204:207], a[124:127]
v_exp_f32 v148, v148
v_mfma_f32_16x16x32_bf16 a[124:127], a[252:255], v[220:223], a[124:127]
ds_read_b128 a[200:203], v2 offset:2048
v_mfma_f32_16x16x32_bf16 a[60:63], a[252:255], v[212:215], a[60:63]
buffer_load_dwordx4 v1, s[44:47], s72 offen offset:2048 sc1 lds
v_mfma_f32_16x16x32_bf16 a[60:63], a[220:223], v[196:199], a[60:63]
ds_read_b128 a[204:207], v2 offset:3072
v_cvt_pk_bf16_f32 v196, v132, v133
v_mfma_f32_16x16x32_bf16 v[164:167], a[160:163], v[32:35], v[84:87]
v_exp_f32 v149, v149
v_mfma_f32_16x16x32_bf16 v[164:167], a[164:167], v[36:39], v[164:167]
v_exp_f32 v150, v150
v_mfma_f32_16x16x32_bf16 v[164:167], a[168:171], v[40:43], v[164:167]
ds_read_b128 a[208:211], v2 offset:4096
v_cvt_pk_bf16_f32 v197, v134, v135
v_mfma_f32_16x16x32_bf16 v[164:167], a[172:175], v[44:47], v[164:167]
v_exp_f32 v151, v151
v_mfma_f32_16x16x32_bf16 v[172:175], a[172:175], v[76:79], v[92:95]
v_exp_f32 v140, v140
v_mfma_f32_16x16x32_bf16 v[172:175], a[168:171], v[72:75], v[172:175]
ds_read_b128 a[212:215], v2 offset:5120
v_cvt_pk_bf16_f32 v198, v148, v149
v_mfma_f32_16x16x32_bf16 v[172:175], a[164:167], v[68:71], v[172:175]
v_exp_f32 v141, v141
v_mfma_f32_16x16x32_bf16 v[172:175], a[160:163], v[64:67], v[172:175]
v_exp_f32 v142, v142
v_mfma_f32_16x16x32_bf16 v[188:191], a[176:179], v[64:67], v[92:95]
ds_read_b128 a[216:219], v2 offset:6144
v_cvt_pk_bf16_f32 v199, v150, v151
v_mfma_f32_16x16x32_bf16 v[188:191], a[180:183], v[68:71], v[188:191]
v_exp_f32 v143, v143
v_mfma_f32_16x16x32_bf16 v[188:191], a[184:187], v[72:75], v[188:191]
v_exp_f32 v156, v156
v_mfma_f32_16x16x32_bf16 v[188:191], a[188:191], v[76:79], v[188:191]
ds_read_b128 a[220:223], v2 offset:7168
v_cvt_pk_bf16_f32 v204, v140, v141
v_mfma_f32_16x16x32_bf16 v[180:183], a[188:191], v[44:47], v[84:87]
buffer_load_dwordx4 v1, s[44:47], s72 offen offset:3072 sc1 lds
v_mfma_f32_16x16x32_bf16 v[180:183], a[184:187], v[40:43], v[180:183]
v_exp_f32 v157, v157
v_mfma_f32_16x16x32_bf16 v[180:183], a[180:183], v[36:39], v[180:183]
v_exp_f32 v158, v158
v_mfma_f32_16x16x32_bf16 v[180:183], a[176:179], v[32:35], v[180:183]
v_cvt_pk_bf16_f32 v205, v142, v143
v_cvt_pk_bf16_f32 v206, v156, v157
v_mfma_f32_16x16x32_bf16 v[160:163], a[160:163], v[16:19], v[80:83]
v_exp_f32 v159, v159
v_mfma_f32_16x16x32_bf16 v[160:163], a[164:167], v[20:23], v[160:163]
v_cvt_pk_bf16_f32 v207, v158, v159
v_mfma_f32_16x16x32_bf16 v[160:163], a[168:171], v[24:27], v[160:163]
v_mfma_f32_16x16x32_bf16 v[160:163], a[172:175], v[28:31], v[160:163]
v_mfma_f32_16x16x32_bf16 v[168:171], a[172:175], v[60:63], v[88:91]
v_mfma_f32_16x16x32_bf16 v[168:171], a[168:171], v[56:59], v[168:171]
v_mfma_f32_16x16x32_bf16 v[168:171], a[164:167], v[52:55], v[168:171]
v_mfma_f32_16x16x32_bf16 v[168:171], a[160:163], v[48:51], v[168:171]
v_mfma_f32_16x16x32_bf16 v[184:187], a[176:179], v[48:51], v[88:91]
v_mfma_f32_16x16x32_bf16 v[184:187], a[180:183], v[52:55], v[184:187]
v_mfma_f32_16x16x32_bf16 v[184:187], a[184:187], v[56:59], v[184:187]
v_mfma_f32_16x16x32_bf16 v[184:187], a[188:191], v[60:63], v[184:187]
v_mfma_f32_16x16x32_bf16 v[176:179], a[188:191], v[28:31], v[80:83]
v_mfma_f32_16x16x32_bf16 v[176:179], a[184:187], v[24:27], v[176:179]
v_mfma_f32_16x16x32_bf16 v[176:179], a[180:183], v[20:23], v[176:179]
v_mfma_f32_16x16x32_bf16 v[176:179], a[176:179], v[16:19], v[176:179]
s_waitcnt lgkmcnt(4)
v_mfma_f32_16x16x32_bf16 v[224:227], v[120:123], v[208:211], v[224:227]
s_add_u32 s82, s82, 0x8000
ds_read_b128 a[160:163], v2 offset:24576
v_mfma_f32_16x16x32_bf16 v[224:227], v[120:123], v[192:195], v[224:227]
s_and_b32 s82, s82, 0x1ffff
v_exp_f32 v164, v164
v_mfma_f32_16x16x32_bf16 v[232:235], v[120:123], v[216:219], v[232:235]
s_add_u32 m0, s74, 0
v_exp_f32 v165, v165
v_mfma_f32_16x16x32_bf16 v[232:235], v[120:123], v[200:203], v[232:235]
s_add_u32 s72, s81, 0
ds_read_b128 a[164:167], v2 offset:25600
v_cvt_pk_bf16_f32 v212, v164, v165
v_mfma_f32_16x16x32_bf16 a[0:3], a[224:227], v[208:211], a[0:3]
v_exp_f32 v166, v166
v_mfma_f32_16x16x32_bf16 a[0:3], a[192:195], v[192:195], a[0:3]
v_exp_f32 v167, v167
v_mfma_f32_16x16x32_bf16 a[64:67], a[192:195], v[200:203], a[64:67]
ds_read_b128 a[168:171], v2 offset:26624
v_cvt_pk_bf16_f32 v213, v166, v167
v_mfma_f32_16x16x32_bf16 a[64:67], a[224:227], v[216:219], a[64:67]
v_exp_f32 v180, v180
v_mfma_f32_16x16x32_bf16 a[68:71], a[228:231], v[216:219], a[68:71]
buffer_load_dwordx4 v1, s[44:47], s72 offen sc1 lds
v_mfma_f32_16x16x32_bf16 a[68:71], a[196:199], v[200:203], a[68:71]
v_exp_f32 v181, v181
v_mfma_f32_16x16x32_bf16 a[4:7], a[196:199], v[192:195], a[4:7]
ds_read_b128 a[172:175], v2 offset:27648
v_cvt_pk_bf16_f32 v214, v180, v181
v_mfma_f32_16x16x32_bf16 a[4:7], a[228:231], v[208:211], a[4:7]
v_exp_f32 v182, v182
v_mfma_f32_16x16x32_bf16 a[8:11], a[232:235], v[208:211], a[8:11]
v_exp_f32 v183, v183
v_mfma_f32_16x16x32_bf16 a[8:11], a[200:203], v[192:195], a[8:11]
ds_read_b128 a[176:179], v2 offset:28672
v_cvt_pk_bf16_f32 v215, v182, v183
v_mfma_f32_16x16x32_bf16 a[72:75], a[200:203], v[200:203], a[72:75]
v_exp_f32 v172, v172
v_mfma_f32_16x16x32_bf16 a[72:75], a[232:235], v[216:219], a[72:75]
v_exp_f32 v173, v173
v_mfma_f32_16x16x32_bf16 a[76:79], a[236:239], v[216:219], a[76:79]
ds_read_b128 a[180:183], v2 offset:29696
v_cvt_pk_bf16_f32 v220, v172, v173
v_mfma_f32_16x16x32_bf16 a[76:79], a[204:207], v[200:203], a[76:79]
v_exp_f32 v174, v174
v_mfma_f32_16x16x32_bf16 a[12:15], a[204:207], v[192:195], a[12:15]
v_exp_f32 v175, v175
v_mfma_f32_16x16x32_bf16 a[12:15], a[236:239], v[208:211], a[12:15]
ds_read_b128 a[184:187], v2 offset:30720
v_cvt_pk_bf16_f32 v221, v174, v175
v_mfma_f32_16x16x32_bf16 a[16:19], a[240:243], v[208:211], a[16:19]
s_waitcnt lgkmcnt(7)
v_exp_f32 v188, v188
v_mfma_f32_16x16x32_bf16 a[16:19], a[208:211], v[192:195], a[16:19]
buffer_load_dwordx4 v1, s[44:47], s72 offen offset:1024 sc1 lds
v_mfma_f32_16x16x32_bf16 a[80:83], a[208:211], v[200:203], a[80:83]
v_exp_f32 v189, v189
v_mfma_f32_16x16x32_bf16 a[80:83], a[240:243], v[216:219], a[80:83]
ds_read_b128 a[188:191], v2 offset:31744
v_cvt_pk_bf16_f32 v222, v188, v189
v_mfma_f32_16x16x32_bf16 a[84:87], a[244:247], v[216:219], a[84:87]
v_exp_f32 v190, v190
v_mfma_f32_16x16x32_bf16 a[84:87], a[212:215], v[200:203], a[84:87]
v_exp_f32 v191, v191
v_mfma_f32_16x16x32_bf16 a[20:23], a[212:215], v[192:195], a[20:23]
ds_read_b128 a[224:227], v2 offset:8192
v_cvt_pk_bf16_f32 v223, v190, v191
v_mfma_f32_16x16x32_bf16 a[20:23], a[244:247], v[208:211], a[20:23]
v_exp_f32 v160, v160
v_mfma_f32_16x16x32_bf16 a[24:27], a[248:251], v[208:211], a[24:27]
v_exp_f32 v161, v161
v_mfma_f32_16x16x32_bf16 a[24:27], a[216:219], v[192:195], a[24:27]
ds_read_b128 a[228:231], v2 offset:9216
v_mfma_f32_16x16x32_bf16 a[88:91], a[216:219], v[200:203], a[88:91]
v_exp_f32 v162, v162
v_mfma_f32_16x16x32_bf16 a[88:91], a[248:251], v[216:219], a[88:91]
v_exp_f32 v163, v163
v_mfma_f32_16x16x32_bf16 a[92:95], a[252:255], v[216:219], a[92:95]
ds_read_b128 a[232:235], v2 offset:10240
v_mfma_f32_16x16x32_bf16 a[92:95], a[220:223], v[200:203], a[92:95]
v_exp_f32 v176, v176
v_mfma_f32_16x16x32_bf16 a[28:31], a[220:223], v[192:195], a[28:31]
buffer_load_dwordx4 v1, s[44:47], s72 offen offset:2048 sc1 lds
v_mfma_f32_16x16x32_bf16 a[28:31], a[252:255], v[208:211], a[28:31]
ds_read_b128 a[236:239], v2 offset:11264
v_cvt_pk_bf16_f32 v208, v160, v161
s_cmp_eq_u32 s58, 0
s_cbranch_scc1 Lta16
s_cmp_eq_u32 s58, 1
s_cbranch_scc1 Lnt17
v_mfma_f32_16x16x32_bf16 v[128:131], a[128:131], v[16:19], v[80:83]
v_exp_f32 v177, v177
v_mfma_f32_16x16x32_bf16 v[144:147], a[144:147], v[16:19], v[80:83]
v_exp_f32 v178, v178
s_branch Ljoin18
Lta16:
v_mfma_f32_16x16x32_bf16 v[128:131], a[128:131], v[16:19], v[96:99]
v_exp_f32 v177, v177
v_mfma_f32_16x16x32_bf16 v[144:147], a[144:147], v[16:19], v[112:115]
v_exp_f32 v178, v178
s_branch Ljoin18
Lnt17:
v_mfma_f32_16x16x32_bf16 v[128:131], a[128:131], v[16:19], v[80:83]
v_exp_f32 v177, v177
v_mfma_f32_16x16x32_bf16 v[144:147], a[144:147], v[16:19], v[96:99]
Lstub3:
s_cbranch_execz Lstub7
v_exp_f32 v178, v178
Ljoin18:
v_mfma_f32_16x16x32_bf16 v[128:131], a[132:135], v[20:23], v[128:131]
ds_read_b128 a[240:243], v2 offset:12288
v_cvt_pk_bf16_f32 v209, v162, v163
v_mfma_f32_16x16x32_bf16 v[128:131], a[136:139], v[24:27], v[128:131]
v_exp_f32 v179, v179
v_mfma_f32_16x16x32_bf16 v[128:131], a[140:143], v[28:31], v[128:131]
v_exp_f32 v168, v168
v_mfma_f32_16x16x32_bf16 v[136:139], a[140:143], v[60:63], v[88:91]
ds_read_b128 a[244:247], v2 offset:13312
v_cvt_pk_bf16_f32 v210, v176, v177
v_mfma_f32_16x16x32_bf16 v[136:139], a[136:139], v[56:59], v[136:139]
v_exp_f32 v169, v169
v_mfma_f32_16x16x32_bf16 v[136:139], a[132:135], v[52:55], v[136:139]
v_exp_f32 v170, v170
v_mfma_f32_16x16x32_bf16 v[136:139], a[128:131], v[48:51], v[136:139]
ds_read_b128 a[248:251], v2 offset:14336
v_cvt_pk_bf16_f32 v211, v178, v179
v_mfma_f32_16x16x32_bf16 v[152:155], a[144:147], v[48:51], v[88:91]
v_exp_f32 v171, v171
v_mfma_f32_16x16x32_bf16 v[152:155], a[148:151], v[52:55], v[152:155]
v_exp_f32 v184, v184
v_mfma_f32_16x16x32_bf16 v[152:155], a[152:155], v[56:59], v[152:155]
ds_read_b128 a[252:255], v2 offset:15360
v_cvt_pk_bf16_f32 v216, v168, v169
v_mfma_f32_16x16x32_bf16 v[152:155], a[156:159], v[60:63], v[152:155]
buffer_load_dwordx4 v1, s[44:47], s72 offen offset:3072 sc1 lds
v_mfma_f32_16x16x32_bf16 v[144:147], a[156:159], v[28:31], v[144:147]
v_exp_f32 v185, v185
v_mfma_f32_16x16x32_bf16 v[144:147], a[152:155], v[24:27], v[144:147]
v_exp_f32 v186, v186
v_mfma_f32_16x16x32_bf16 v[144:147], a[148:151], v[20:23], v[144:147]
v_cvt_pk_bf16_f32 v217, v170, v171
v_cvt_pk_bf16_f32 v218, v184, v185
v_mfma_f32_16x16x32_bf16 v[132:135], a[128:131], v[32:35], v[84:87]
v_exp_f32 v187, v187
v_mfma_f32_16x16x32_bf16 v[132:135], a[132:135], v[36:39], v[132:135]
v_cvt_pk_bf16_f32 v219, v186, v187
v_add_u32 v2, s82, v1
v_mfma_f32_16x16x32_bf16 v[132:135], a[136:139], v[40:43], v[132:135]
v_mfma_f32_16x16x32_bf16 v[132:135], a[140:143], v[44:47], v[132:135]
v_mfma_f32_16x16x32_bf16 v[140:143], a[140:143], v[76:79], v[92:95]
v_mfma_f32_16x16x32_bf16 v[140:143], a[136:139], v[72:75], v[140:143]
v_mfma_f32_16x16x32_bf16 v[140:143], a[132:135], v[68:71], v[140:143]
v_mfma_f32_16x16x32_bf16 v[140:143], a[128:131], v[64:67], v[140:143]
v_mfma_f32_16x16x32_bf16 v[156:159], a[144:147], v[64:67], v[92:95]
v_mfma_f32_16x16x32_bf16 v[156:159], a[148:151], v[68:71], v[156:159]
v_mfma_f32_16x16x32_bf16 v[156:159], a[152:155], v[72:75], v[156:159]
v_mfma_f32_16x16x32_bf16 v[156:159], a[156:159], v[76:79], v[156:159]
v_mfma_f32_16x16x32_bf16 v[148:151], a[156:159], v[44:47], v[84:87]
v_mfma_f32_16x16x32_bf16 v[148:151], a[152:155], v[40:43], v[148:151]
v_mfma_f32_16x16x32_bf16 v[148:151], a[148:151], v[36:39], v[148:151]
s_waitcnt vmcnt(8) lgkmcnt(4)
v_mfma_f32_16x16x32_bf16 v[148:151], a[144:147], v[32:35], v[148:151]
s_barrier
v_mfma_f32_16x16x32_bf16 v[228:231], v[120:123], v[196:199], v[228:231]
s_xor_b32 s74, s82, 0x10000
v_exp_f32 v128, v128
v_mfma_f32_16x16x32_bf16 v[228:231], v[120:123], v[212:215], v[228:231]
s_add_u32 s74, s74, s64
ds_read_b128 a[128:131], v2 offset:16384
v_mfma_f32_16x16x32_bf16 v[236:239], v[120:123], v[204:207], v[236:239]
s_add_u32 s81, s81, 0x8000
v_exp_f32 v129, v129
v_mfma_f32_16x16x32_bf16 v[236:239], v[120:123], v[220:223], v[236:239]
s_add_u32 m0, s74, 16384
v_exp_f32 v130, v130
v_mfma_f32_16x16x32_bf16 a[32:35], a[192:195], v[196:199], a[32:35]
s_add_u32 s72, s81, 16384
ds_read_b128 a[132:135], v2 offset:17408
v_cvt_pk_bf16_f32 v192, v128, v129
v_mfma_f32_16x16x32_bf16 a[32:35], a[224:227], v[212:215], a[32:35]
v_exp_f32 v131, v131
v_mfma_f32_16x16x32_bf16 a[96:99], a[224:227], v[220:223], a[96:99]
v_exp_f32 v144, v144
v_mfma_f32_16x16x32_bf16 a[96:99], a[192:195], v[204:207], a[96:99]
ds_read_b128 a[136:139], v2 offset:18432
v_cvt_pk_bf16_f32 v193, v130, v131
v_mfma_f32_16x16x32_bf16 a[100:103], a[196:199], v[204:207], a[100:103]
buffer_load_dwordx4 v1, s[44:47], s72 offen sc1 lds
v_mfma_f32_16x16x32_bf16 a[100:103], a[228:231], v[220:223], a[100:103]
v_exp_f32 v145, v145
v_mfma_f32_16x16x32_bf16 a[36:39], a[228:231], v[212:215], a[36:39]
v_exp_f32 v146, v146
v_mfma_f32_16x16x32_bf16 a[36:39], a[196:199], v[196:199], a[36:39]
ds_read_b128 a[140:143], v2 offset:19456
v_cvt_pk_bf16_f32 v194, v144, v145
v_mfma_f32_16x16x32_bf16 a[40:43], a[200:203], v[196:199], a[40:43]
v_exp_f32 v147, v147
v_mfma_f32_16x16x32_bf16 a[40:43], a[232:235], v[212:215], a[40:43]
v_exp_f32 v136, v136
v_mfma_f32_16x16x32_bf16 a[104:107], a[232:235], v[220:223], a[104:107]
ds_read_b128 a[144:147], v2 offset:20480
v_cvt_pk_bf16_f32 v195, v146, v147
v_mfma_f32_16x16x32_bf16 a[104:107], a[200:203], v[204:207], a[104:107]
v_exp_f32 v137, v137
v_mfma_f32_16x16x32_bf16 a[108:111], a[204:207], v[204:207], a[108:111]
v_exp_f32 v138, v138
v_mfma_f32_16x16x32_bf16 a[108:111], a[236:239], v[220:223], a[108:111]
ds_read_b128 a[148:151], v2 offset:21504
v_cvt_pk_bf16_f32 v200, v136, v137
v_mfma_f32_16x16x32_bf16 a[44:47], a[236:239], v[212:215], a[44:47]
v_exp_f32 v139, v139
v_mfma_f32_16x16x32_bf16 a[44:47], a[204:207], v[196:199], a[44:47]
v_exp_f32 v152, v152
v_mfma_f32_16x16x32_bf16 a[48:51], a[208:211], v[196:199], a[48:51]
s_waitcnt lgkmcnt(6)
ds_read_b128 a[152:155], v2 offset:22528
v_cvt_pk_bf16_f32 v201, v138, v139
v_mfma_f32_16x16x32_bf16 a[48:51], a[240:243], v[212:215], a[48:51]
buffer_load_dwordx4 v1, s[44:47], s72 offen offset:1024 sc1 lds
v_mfma_f32_16x16x32_bf16 a[112:115], a[240:243], v[220:223], a[112:115]
v_exp_f32 v153, v153
v_mfma_f32_16x16x32_bf16 a[112:115], a[208:211], v[204:207], a[112:115]
v_exp_f32 v154, v154
v_mfma_f32_16x16x32_bf16 a[116:119], a[212:215], v[204:207], a[116:119]
ds_read_b128 a[156:159], v2 offset:23552
v_cvt_pk_bf16_f32 v202, v152, v153
v_mfma_f32_16x16x32_bf16 a[116:119], a[244:247], v[220:223], a[116:119]
v_exp_f32 v155, v155
v_mfma_f32_16x16x32_bf16 a[52:55], a[244:247], v[212:215], a[52:55]
v_exp_f32 v132, v132
v_mfma_f32_16x16x32_bf16 a[52:55], a[212:215], v[196:199], a[52:55]
ds_read_b128 a[192:195], v2 offset:0
v_cvt_pk_bf16_f32 v203, v154, v155
v_mfma_f32_16x16x32_bf16 a[56:59], a[216:219], v[196:199], a[56:59]
v_exp_f32 v133, v133
v_mfma_f32_16x16x32_bf16 a[56:59], a[248:251], v[212:215], a[56:59]
v_exp_f32 v134, v134
v_mfma_f32_16x16x32_bf16 a[120:123], a[248:251], v[220:223], a[120:123]
ds_read_b128 a[196:199], v2 offset:1024
v_mfma_f32_16x16x32_bf16 a[120:123], a[216:219], v[204:207], a[120:123]
v_exp_f32 v135, v135
v_mfma_f32_16x16x32_bf16 a[124:127], a[220:223], v[204:207], a[124:127]
v_exp_f32 v148, v148
v_mfma_f32_16x16x32_bf16 a[124:127], a[252:255], v[220:223], a[124:127]
ds_read_b128 a[200:203], v2 offset:2048
v_mfma_f32_16x16x32_bf16 a[60:63], a[252:255], v[212:215], a[60:63]
buffer_load_dwordx4 v1, s[44:47], s72 offen offset:2048 sc1 lds
v_mfma_f32_16x16x32_bf16 a[60:63], a[220:223], v[196:199], a[60:63]
ds_read_b128 a[204:207], v2 offset:3072
v_cvt_pk_bf16_f32 v196, v132, v133
s_cmp_eq_u32 s58, 2
s_cbranch_scc1 Lta19
s_cmp_eq_u32 s58, 3
s_cbranch_scc1 Lnt20
v_mfma_f32_16x16x32_bf16 v[160:163], a[160:163], v[16:19], v[112:115]
v_exp_f32 v149, v149
v_mfma_f32_16x16x32_bf16 v[176:179], a[176:179], v[16:19], v[112:115]
v_exp_f32 v150, v150
s_branch Ljoin21
Lta19:
v_mfma_f32_16x16x32_bf16 v[160:163], a[160:163], v[16:19], v[96:99]
v_exp_f32 v149, v149
v_mfma_f32_16x16x32_bf16 v[176:179], a[176:179], v[16:19], v[112:115]
v_exp_f32 v150, v150
s_branch Ljoin21
Lnt20:
v_mfma_f32_16x16x32_bf16 v[160:163], a[160:163], v[16:19], v[80:83]
v_exp_f32 v149, v149
v_mfma_f32_16x16x32_bf16 v[176:179], a[176:179], v[16:19], v[96:99]
v_exp_f32 v150, v150
Ljoin21:
v_mfma_f32_16x16x32_bf16 v[164:167], a[160:163], v[32:35], v[84:87]
ds_read_b128 a[208:211], v2 offset:4096
v_cvt_pk_bf16_f32 v197, v134, v135
v_mfma_f32_16x16x32_bf16 v[164:167], a[164:167], v[36:39], v[164:167]
v_exp_f32 v151, v151
v_mfma_f32_16x16x32_bf16 v[164:167], a[168:171], v[40:43], v[164:167]
v_exp_f32 v140, v140
v_mfma_f32_16x16x32_bf16 v[164:167], a[172:175], v[44:47], v[164:167]
ds_read_b128 a[212:215], v2 offset:5120
v_cvt_pk_bf16_f32 v198, v148, v149
v_mfma_f32_16x16x32_bf16 v[172:175], a[172:175], v[76:79], v[92:95]
v_exp_f32 v141, v141
v_mfma_f32_16x16x32_bf16 v[172:175], a[168:171], v[72:75], v[172:175]
v_exp_f32 v142, v142
v_mfma_f32_16x16x32_bf16 v[172:175], a[164:167], v[68:71], v[172:175]
ds_read_b128 a[216:219], v2 offset:6144
v_cvt_pk_bf16_f32 v199, v150, v151
v_mfma_f32_16x16x32_bf16 v[172:175], a[160:163], v[64:67], v[172:175]
v_exp_f32 v143, v143
v_mfma_f32_16x16x32_bf16 v[188:191], a[176:179], v[64:67], v[92:95]
v_exp_f32 v156, v156
v_mfma_f32_16x16x32_bf16 v[188:191], a[180:183], v[68:71], v[188:191]
ds_read_b128 a[220:223], v2 offset:7168
v_cvt_pk_bf16_f32 v204, v140, v141
v_mfma_f32_16x16x32_bf16 v[188:191], a[184:187], v[72:75], v[188:191]
buffer_load_dwordx4 v1, s[44:47], s72 offen offset:3072 sc1 lds
v_mfma_f32_16x16x32_bf16 v[188:191], a[188:191], v[76:79], v[188:191]
v_exp_f32 v157, v157
v_mfma_f32_16x16x32_bf16 v[180:183], a[188:191], v[44:47], v[84:87]
v_exp_f32 v158, v158
v_mfma_f32_16x16x32_bf16 v[180:183], a[184:187], v[40:43], v[180:183]
v_cvt_pk_bf16_f32 v205, v142, v143
v_cvt_pk_bf16_f32 v206, v156, v157
v_mfma_f32_16x16x32_bf16 v[180:183], a[180:183], v[36:39], v[180:183]
v_exp_f32 v159, v159
v_mfma_f32_16x16x32_bf16 v[180:183], a[176:179], v[32:35], v[180:183]
v_cvt_pk_bf16_f32 v207, v158, v159
v_mfma_f32_16x16x32_bf16 v[160:163], a[164:167], v[20:23], v[160:163]
v_mfma_f32_16x16x32_bf16 v[160:163], a[168:171], v[24:27], v[160:163]
v_mfma_f32_16x16x32_bf16 v[160:163], a[172:175], v[28:31], v[160:163]
v_mfma_f32_16x16x32_bf16 v[168:171], a[172:175], v[60:63], v[88:91]
v_mfma_f32_16x16x32_bf16 v[168:171], a[168:171], v[56:59], v[168:171]
v_mfma_f32_16x16x32_bf16 v[168:171], a[164:167], v[52:55], v[168:171]
v_mfma_f32_16x16x32_bf16 v[168:171], a[160:163], v[48:51], v[168:171]
v_mfma_f32_16x16x32_bf16 v[184:187], a[176:179], v[48:51], v[88:91]
v_mfma_f32_16x16x32_bf16 v[184:187], a[180:183], v[52:55], v[184:187]
v_mfma_f32_16x16x32_bf16 v[184:187], a[184:187], v[56:59], v[184:187]
v_mfma_f32_16x16x32_bf16 v[184:187], a[188:191], v[60:63], v[184:187]
v_mfma_f32_16x16x32_bf16 v[176:179], a[188:191], v[28:31], v[176:179]
v_mfma_f32_16x16x32_bf16 v[176:179], a[184:187], v[24:27], v[176:179]
v_mfma_f32_16x16x32_bf16 v[176:179], a[180:183], v[20:23], v[176:179]
s_waitcnt lgkmcnt(4)
v_mfma_f32_16x16x32_bf16 v[224:227], v[120:123], v[208:211], v[224:227]
s_add_u32 s82, s82, 0x8000
ds_read_b128 a[160:163], v2 offset:24576
v_mfma_f32_16x16x32_bf16 v[224:227], v[120:123], v[192:195], v[224:227]
s_and_b32 s82, s82, 0x1ffff
v_exp_f32 v164, v164
v_mfma_f32_16x16x32_bf16 v[232:235], v[120:123], v[216:219], v[232:235]
s_add_u32 m0, s74, 0
v_exp_f32 v165, v165
v_mfma_f32_16x16x32_bf16 v[232:235], v[120:123], v[200:203], v[232:235]
s_add_u32 s72, s81, 0
ds_read_b128 a[164:167], v2 offset:25600
v_cvt_pk_bf16_f32 v212, v164, v165
v_mfma_f32_16x16x32_bf16 a[0:3], a[224:227], v[208:211], a[0:3]
v_exp_f32 v166, v166
v_mfma_f32_16x16x32_bf16 a[0:3], a[192:195], v[192:195], a[0:3]
v_exp_f32 v167, v167
v_mfma_f32_16x16x32_bf16 a[64:67], a[192:195], v[200:203], a[64:67]
ds_read_b128 a[168:171], v2 offset:26624
v_cvt_pk_bf16_f32 v213, v166, v167
v_mfma_f32_16x16x32_bf16 a[64:67], a[224:227], v[216:219], a[64:67]
v_exp_f32 v180, v180
v_mfma_f32_16x16x32_bf16 a[68:71], a[228:231], v[216:219], a[68:71]
buffer_load_dwordx4 v1, s[44:47], s72 offen sc1 lds
v_mfma_f32_16x16x32_bf16 a[68:71], a[196:199], v[200:203], a[68:71]
v_exp_f32 v181, v181
v_mfma_f32_16x16x32_bf16 a[4:7], a[196:199], v[192:195], a[4:7]
ds_read_b128 a[172:175], v2 offset:27648
v_cvt_pk_bf16_f32 v214, v180, v181
v_mfma_f32_16x16x32_bf16 a[4:7], a[228:231], v[208:211], a[4:7]
v_exp_f32 v182, v182
v_mfma_f32_16x16x32_bf16 a[8:11], a[232:235], v[208:211], a[8:11]
v_exp_f32 v183, v183
v_mfma_f32_16x16x32_bf16 a[8:11], a[200:203], v[192:195], a[8:11]
ds_read_b128 a[176:179], v2 offset:28672
v_cvt_pk_bf16_f32 v215, v182, v183
v_mfma_f32_16x16x32_bf16 a[72:75], a[200:203], v[200:203], a[72:75]
v_exp_f32 v172, v172
v_mfma_f32_16x16x32_bf16 a[72:75], a[232:235], v[216:219], a[72:75]
v_exp_f32 v173, v173
v_mfma_f32_16x16x32_bf16 a[76:79], a[236:239], v[216:219], a[76:79]
ds_read_b128 a[180:183], v2 offset:29696
v_cvt_pk_bf16_f32 v220, v172, v173
v_mfma_f32_16x16x32_bf16 a[76:79], a[204:207], v[200:203], a[76:79]
v_exp_f32 v174, v174
v_mfma_f32_16x16x32_bf16 a[12:15], a[204:207], v[192:195], a[12:15]
v_exp_f32 v175, v175
v_mfma_f32_16x16x32_bf16 a[12:15], a[236:239], v[208:211], a[12:15]
ds_read_b128 a[184:187], v2 offset:30720
v_cvt_pk_bf16_f32 v221, v174, v175
v_mfma_f32_16x16x32_bf16 a[16:19], a[240:243], v[208:211], a[16:19]
s_waitcnt lgkmcnt(7)
v_exp_f32 v188, v188
v_mfma_f32_16x16x32_bf16 a[16:19], a[208:211], v[192:195], a[16:19]
buffer_load_dwordx4 v1, s[44:47], s72 offen offset:1024 sc1 lds
v_mfma_f32_16x16x32_bf16 a[80:83], a[208:211], v[200:203], a[80:83]
v_exp_f32 v189, v189
v_mfma_f32_16x16x32_bf16 a[80:83], a[240:243], v[216:219], a[80:83]
ds_read_b128 a[188:191], v2 offset:31744
v_cvt_pk_bf16_f32 v222, v188, v189
v_mfma_f32_16x16x32_bf16 a[84:87], a[244:247], v[216:219], a[84:87]
v_exp_f32 v190, v190
v_mfma_f32_16x16x32_bf16 a[84:87], a[212:215], v[200:203], a[84:87]
v_exp_f32 v191, v191
v_mfma_f32_16x16x32_bf16 a[20:23], a[212:215], v[192:195], a[20:23]
ds_read_b128 a[224:227], v2 offset:8192
v_cvt_pk_bf16_f32 v223, v190, v191
v_mfma_f32_16x16x32_bf16 a[20:23], a[244:247], v[208:211], a[20:23]
v_exp_f32 v160, v160
v_mfma_f32_16x16x32_bf16 a[24:27], a[248:251], v[208:211], a[24:27]
v_exp_f32 v161, v161
v_mfma_f32_16x16x32_bf16 a[24:27], a[216:219], v[192:195], a[24:27]
ds_read_b128 a[228:231], v2 offset:9216
v_mfma_f32_16x16x32_bf16 a[88:91], a[216:219], v[200:203], a[88:91]
v_exp_f32 v162, v162
v_mfma_f32_16x16x32_bf16 a[88:91], a[248:251], v[216:219], a[88:91]
v_exp_f32 v163, v163
v_mfma_f32_16x16x32_bf16 a[92:95], a[252:255], v[216:219], a[92:95]
ds_read_b128 a[232:235], v2 offset:10240
v_mfma_f32_16x16x32_bf16 a[92:95], a[220:223], v[200:203], a[92:95]
v_exp_f32 v176, v176
v_mfma_f32_16x16x32_bf16 a[28:31], a[220:223], v[192:195], a[28:31]
buffer_load_dwordx4 v1, s[44:47], s72 offen offset:2048 sc1 lds
v_mfma_f32_16x16x32_bf16 a[28:31], a[252:255], v[208:211], a[28:31]
ds_read_b128 a[236:239], v2 offset:11264
v_cvt_pk_bf16_f32 v208, v160, v161
s_cmp_eq_u32 s58, 0
s_cbranch_scc1 Lta22
s_cmp_eq_u32 s58, 1
s_cbranch_scc1 Lnt23
v_mfma_f32_16x16x32_bf16 v[132:135], a[128:131], v[32:35], v[84:87]
v_exp_f32 v177, v177
v_mfma_f32_16x16x32_bf16 v[148:151], a[144:147], v[32:35], v[84:87]
v_exp_f32 v178, v178
s_branch Ljoin24
Lta22:
v_mfma_f32_16x16x32_bf16 v[132:135], a[128:131], v[32:35], v[100:103]
v_exp_f32 v177, v177
v_mfma_f32_16x16x32_bf16 v[148:151], a[144:147], v[32:35], v[112:115]
v_exp_f32 v178, v178
s_branch Ljoin24
Lnt23:
v_mfma_f32_16x16x32_bf16 v[132:135], a[128:131], v[32:35], v[84:87]
v_exp_f32 v177, v177
v_mfma_f32_16x16x32_bf16 v[148:151], a[144:147], v[32:35], v[100:103]
v_exp_f32 v178, v178
Ljoin24:
v_mfma_f32_16x16x32_bf16 v[136:139], a[128:131], v[48:51], v[88:91]
ds_read_b128 a[240:243], v2 offset:12288
v_cvt_pk_bf16_f32 v209, v162, v163
v_mfma_f32_16x16x32_bf16 v[136:139], a[132:135], v[52:55], v[136:139]
v_exp_f32 v179, v179
v_mfma_f32_16x16x32_bf16 v[136:139], a[136:139], v[56:59], v[136:139]
v_exp_f32 v168, v168
v_mfma_f32_16x16x32_bf16 v[136:139], a[140:143], v[60:63], v[136:139]
ds_read_b128 a[244:247], v2 offset:13312
v_cvt_pk_bf16_f32 v210, v176, v177
v_mfma_f32_16x16x32_bf16 v[152:155], a[156:159], v[60:63], v[88:91]
v_exp_f32 v169, v169
v_mfma_f32_16x16x32_bf16 v[152:155], a[152:155], v[56:59], v[152:155]
v_exp_f32 v170, v170
v_mfma_f32_16x16x32_bf16 v[152:155], a[148:151], v[52:55], v[152:155]
ds_read_b128 a[248:251], v2 offset:14336
v_cvt_pk_bf16_f32 v211, v178, v179
v_mfma_f32_16x16x32_bf16 v[152:155], a[144:147], v[48:51], v[152:155]
v_exp_f32 v171, v171
v_mfma_f32_16x16x32_bf16 v[132:135], a[132:135], v[36:39], v[132:135]
v_exp_f32 v184, v184
v_mfma_f32_16x16x32_bf16 v[132:135], a[136:139], v[40:43], v[132:135]
ds_read_b128 a[252:255], v2 offset:15360
v_cvt_pk_bf16_f32 v216, v168, v169
v_mfma_f32_16x16x32_bf16 v[132:135], a[140:143], v[44:47], v[132:135]
buffer_load_dwordx4 v1, s[44:47], s72 offen offset:3072 sc1 lds
v_mfma_f32_16x16x32_bf16 v[140:143], a[140:143], v[76:79], v[92:95]
v_exp_f32 v185, v185
v_mfma_f32_16x16x32_bf16 v[140:143], a[136:139], v[72:75], v[140:143]
v_exp_f32 v186, v186
v_mfma_f32_16x16x32_bf16 v[140:143], a[132:135], v[68:71], v[140:143]
v_cvt_pk_bf16_f32 v217, v170, v171
v_cvt_pk_bf16_f32 v218, v184, v185
v_mfma_f32_16x16x32_bf16 v[140:143], a[128:131], v[64:67], v[140:143]
v_exp_f32 v187, v187
v_mfma_f32_16x16x32_bf16 v[156:159], a[144:147], v[64:67], v[92:95]
v_cvt_pk_bf16_f32 v219, v186, v187
v_add_u32 v2, s82, v1
v_mfma_f32_16x16x32_bf16 v[156:159], a[148:151], v[68:71], v[156:159]
v_mfma_f32_16x16x32_bf16 v[156:159], a[152:155], v[72:75], v[156:159]
v_mfma_f32_16x16x32_bf16 v[156:159], a[156:159], v[76:79], v[156:159]
v_mfma_f32_16x16x32_bf16 v[148:151], a[156:159], v[44:47], v[148:151]
v_mfma_f32_16x16x32_bf16 v[148:151], a[152:155], v[40:43], v[148:151]
s_waitcnt vmcnt(8) lgkmcnt(4)
v_mfma_f32_16x16x32_bf16 v[148:151], a[148:151], v[36:39], v[148:151]
s_barrier
s_cmp_eq_u32 s60, 7
s_cbranch_scc1 LLT3x
LLT3:
Lstub4:
s_cbranch_execz Lstub8
v_mfma_f32_16x16x32_bf16 v[228:231], v[120:123], v[196:199], v[228:231]
s_xor_b32 s74, s82, 0x10000
v_exp_f32 v136, v136
v_mfma_f32_16x16x32_bf16 v[228:231], v[120:123], v[212:215], v[228:231]
s_add_u32 s74, s74, s64
ds_read_b128 a[128:131], v2 offset:16384
v_and_b32 v240, 15, v0
v_mfma_f32_16x16x32_bf16 v[236:239], v[120:123], v[204:207], v[236:239]
s_add_u32 s81, s81, 0x8000
v_exp_f32 v137, v137
v_mfma_f32_16x16x32_bf16 v[236:239], v[120:123], v[220:223], v[236:239]
s_add_u32 m0, s74, 16384
ds_read_b128 a[132:135], v2 offset:17408
v_cvt_pk_bf16_f32 v200, v136, v137
v_mfma_f32_16x16x32_bf16 a[32:35], a[192:195], v[196:199], a[32:35]
s_add_u32 s72, s81, 16384
buffer_load_dwordx4 v1, s[44:47], s72 offen sc1 lds
v_mfma_f32_16x16x32_bf16 a[32:35], a[224:227], v[212:215], a[32:35]
s_add_u32 s69, s93, 0x3e00000
v_exp_f32 v138, v138
v_mfma_f32_16x16x32_bf16 a[96:99], a[224:227], v[220:223], a[96:99]
v_exp_f32 v139, v139
v_mfma_f32_16x16x32_bf16 a[96:99], a[192:195], v[204:207], a[96:99]
ds_read_b128 a[136:139], v2 offset:18432
v_cvt_pk_bf16_f32 v201, v138, v139
v_mfma_f32_16x16x32_bf16 a[100:103], a[196:199], v[204:207], a[100:103]
v_exp_f32 v152, v152
v_mfma_f32_16x16x32_bf16 a[100:103], a[228:231], v[220:223], a[100:103]
ds_read_b128 a[140:143], v2 offset:19456
v_lshrrev_b32 v241, 4, v0
v_mfma_f32_16x16x32_bf16 a[36:39], a[228:231], v[212:215], a[36:39]
buffer_store_dwordx4 v[112:115], v1, s[44:47], s69 offen sc1
v_mfma_f32_16x16x32_bf16 a[36:39], a[196:199], v[196:199], a[36:39]
v_exp_f32 v153, v153
v_mfma_f32_16x16x32_bf16 a[40:43], a[200:203], v[196:199], a[40:43]
v_exp_f32 v154, v154
v_mfma_f32_16x16x32_bf16 a[40:43], a[232:235], v[212:215], a[40:43]
ds_read_b128 a[144:147], v2 offset:20480
v_cvt_pk_bf16_f32 v202, v152, v153
v_mfma_f32_16x16x32_bf16 a[104:107], a[232:235], v[220:223], a[104:107]
v_exp_f32 v155, v155
v_mfma_f32_16x16x32_bf16 a[104:107], a[200:203], v[204:207], a[104:107]
ds_read_b128 a[148:151], v2 offset:21504
v_cvt_pk_bf16_f32 v203, v154, v155
v_mfma_f32_16x16x32_bf16 a[108:111], a[204:207], v[204:207], a[108:111]
buffer_load_dwordx4 v1, s[44:47], s72 offen offset:1024 sc1 lds
v_mfma_f32_16x16x32_bf16 a[108:111], a[236:239], v[220:223], a[108:111]
v_exp_f32 v132, v132
v_mfma_f32_16x16x32_bf16 a[44:47], a[236:239], v[212:215], a[44:47]
v_exp_f32 v133, v133
v_mfma_f32_16x16x32_bf16 a[44:47], a[204:207], v[196:199], a[44:47]
ds_read_b128 a[152:155], v2 offset:22528
v_add_u32 v248, 1, v240
v_mfma_f32_16x16x32_bf16 a[48:51], a[208:211], v[196:199], a[48:51]
s_waitcnt lgkmcnt(7)
v_exp_f32 v134, v134
v_mfma_f32_16x16x32_bf16 a[48:51], a[240:243], v[212:215], a[48:51]
ds_read_b128 a[156:159], v2 offset:23552
v_and_b32 v249, 3, v248
v_mfma_f32_16x16x32_bf16 a[112:115], a[240:243], v[220:223], a[112:115]
buffer_store_dwordx4 v[112:115], v1, s[44:47], s69 offen offset:1024 sc1
v_mfma_f32_16x16x32_bf16 a[112:115], a[208:211], v[204:207], a[112:115]
v_exp_f32 v135, v135
v_mfma_f32_16x16x32_bf16 a[116:119], a[212:215], v[204:207], a[116:119]
v_exp_f32 v148, v148
v_mfma_f32_16x16x32_bf16 a[116:119], a[244:247], v[220:223], a[116:119]
ds_read_b128 a[192:195], v2 offset:0
v_lshrrev_b32 v248, 2, v248
v_mfma_f32_16x16x32_bf16 a[52:55], a[244:247], v[212:215], a[52:55]
v_exp_f32 v149, v149
v_mfma_f32_16x16x32_bf16 a[52:55], a[212:215], v[196:199], a[52:55]
ds_read_b128 a[196:199], v2 offset:1024
v_mov_b32 v250, 0x20000
v_mfma_f32_16x16x32_bf16 a[56:59], a[216:219], v[196:199], a[56:59]
buffer_load_dwordx4 v1, s[44:47], s72 offen offset:2048 sc1 lds
v_mfma_f32_16x16x32_bf16 a[56:59], a[248:251], v[212:215], a[56:59]
v_exp_f32 v150, v150
v_mfma_f32_16x16x32_bf16 a[120:123], a[248:251], v[220:223], a[120:123]
v_exp_f32 v151, v151
v_mfma_f32_16x16x32_bf16 a[120:123], a[216:219], v[204:207], a[120:123]
ds_read_b128 a[200:203], v2 offset:2048
v_mov_b32 v252, 0x20001
v_mfma_f32_16x16x32_bf16 a[124:127], a[220:223], v[204:207], a[124:127]
v_exp_f32 v140, v140
v_mfma_f32_16x16x32_bf16 a[124:127], a[252:255], v[220:223], a[124:127]
ds_read_b128 a[204:207], v2 offset:3072
v_lshlrev_b32 v6, 3, v249
v_mfma_f32_16x16x32_bf16 a[60:63], a[252:255], v[212:215], a[60:63]
buffer_store_dwordx4 v[112:115], v1, s[44:47], s69 offen offset:2048 sc1
v_mfma_f32_16x16x32_bf16 a[60:63], a[220:223], v[196:199], a[60:63]
ds_read_b128 a[208:211], v2 offset:4096
v_cvt_pk_bf16_f32 v196, v132, v133
s_cmp_eq_u32 s58, 2
s_cbranch_scc1 Lta25
s_cmp_eq_u32 s58, 3
s_cbranch_scc1 Lnt26
v_mfma_f32_16x16x32_bf16 v[164:167], a[160:163], v[32:35], v[112:115]
ds_read_b128 a[212:215], v2 offset:5120
v_cvt_pk_bf16_f32 v197, v134, v135
v_mfma_f32_16x16x32_bf16 v[180:183], a[176:179], v[32:35], v[112:115]
ds_read_b128 a[216:219], v2 offset:6144
v_cvt_pk_bf16_f32 v198, v148, v149
s_branch Ljoin27
Lta25:
v_mfma_f32_16x16x32_bf16 v[164:167], a[160:163], v[32:35], v[100:103]
ds_read_b128 a[212:215], v2 offset:5120
v_cvt_pk_bf16_f32 v197, v134, v135
v_mfma_f32_16x16x32_bf16 v[180:183], a[176:179], v[32:35], v[112:115]
ds_read_b128 a[216:219], v2 offset:6144
v_cvt_pk_bf16_f32 v198, v148, v149
s_branch Ljoin27
Lnt26:
v_mfma_f32_16x16x32_bf16 v[164:167], a[160:163], v[32:35], v[84:87]
ds_read_b128 a[212:215], v2 offset:5120
v_cvt_pk_bf16_f32 v197, v134, v135
v_mfma_f32_16x16x32_bf16 v[180:183], a[176:179], v[32:35], v[100:103]
ds_read_b128 a[216:219], v2 offset:6144
v_cvt_pk_bf16_f32 v198, v148, v149
Ljoin27:
v_mfma_f32_16x16x32_bf16 v[164:167], a[164:167], v[36:39], v[164:167]
v_exp_f32 v141, v141
v_mfma_f32_16x16x32_bf16 v[164:167], a[168:171], v[40:43], v[164:167]
v_exp_f32 v142, v142
v_mfma_f32_16x16x32_bf16 v[164:167], a[172:175], v[44:47], v[164:167]
ds_read_b128 a[220:223], v2 offset:7168
v_cvt_pk_bf16_f32 v199, v150, v151
v_mfma_f32_16x16x32_bf16 v[172:175], a[172:175], v[76:79], v[92:95]
v_exp_f32 v143, v143
v_mfma_f32_16x16x32_bf16 v[172:175], a[168:171], v[72:75], v[172:175]
buffer_load_dwordx4 v1, s[44:47], s72 offen offset:3072 sc1 lds
v_mfma_f32_16x16x32_bf16 v[172:175], a[164:167], v[68:71], v[172:175]
v_exp_f32 v156, v156
v_mfma_f32_16x16x32_bf16 v[172:175], a[160:163], v[64:67], v[172:175]
v_cvt_pk_bf16_f32 v204, v140, v141
v_cvt_pk_bf16_f32 v205, v142, v143
v_mfma_f32_16x16x32_bf16 v[188:191], a[176:179], v[64:67], v[92:95]
v_exp_f32 v157, v157
v_mfma_f32_16x16x32_bf16 v[188:191], a[180:183], v[68:71], v[188:191]
v_exp_f32 v158, v158
v_mfma_f32_16x16x32_bf16 v[188:191], a[184:187], v[72:75], v[188:191]
buffer_store_dwordx4 v[112:115], v1, s[44:47], s69 offen offset:3072 sc1
v_mfma_f32_16x16x32_bf16 v[188:191], a[188:191], v[76:79], v[188:191]
v_exp_f32 v159, v159
v_mfma_f32_16x16x32_bf16 v[180:183], a[188:191], v[44:47], v[180:183]
v_cvt_pk_bf16_f32 v206, v156, v157
v_cvt_pk_bf16_f32 v207, v158, v159
v_mfma_f32_16x16x32_bf16 v[180:183], a[184:187], v[40:43], v[180:183]
v_lshrrev_b32 v6, v6, v252
v_and_b32 v6, 3, v6
v_mfma_f32_16x16x32_bf16 v[180:183], a[180:183], v[36:39], v[180:183]
v_cmp_ne_u32 vcc, 1, v249
v_mul_u32_u24 v6, 16640, v6
v_mfma_f32_16x16x32_bf16 v[168:171], a[160:163], v[48:51], v[88:91]
v_add_u32 v6, s92, v6
v_cndmask_b32 v6, v250, v6, vcc
v_mfma_f32_16x16x32_bf16 v[168:171], a[164:167], v[52:55], v[168:171]
v_add_u32 v253, s58, v249
v_and_b32 v253, 3, v253
v_mfma_f32_16x16x32_bf16 v[168:171], a[168:171], v[56:59], v[168:171]
v_mul_u32_u24 v253, 4160, v253
v_add_u32 v6, v6, v253
v_mfma_f32_16x16x32_bf16 v[168:171], a[172:175], v[60:63], v[168:171]
v_bfe_u32 v251, v0, 2, 2
v_lshl_add_u32 v6, v248, 3, v6
v_mfma_f32_16x16x32_bf16 v[184:187], a[188:191], v[60:63], v[88:91]
v_lshl_add_u32 v6, v241, 4, v6
v_lshlrev_b32 v5, 3, v251
v_mfma_f32_16x16x32_bf16 v[184:187], a[184:187], v[56:59], v[184:187]
v_lshrrev_b32 v5, v5, v252
v_and_b32 v5, 3, v5
v_mfma_f32_16x16x32_bf16 v[184:187], a[180:183], v[52:55], v[184:187]
v_cmp_ne_u32 vcc, 1, v251
v_mul_u32_u24 v5, 16640, v5
v_mfma_f32_16x16x32_bf16 v[184:187], a[176:179], v[48:51], v[184:187]
s_waitcnt lgkmcnt(4)
v_mfma_f32_16x16x32_bf16 v[224:227], v[120:123], v[208:211], v[224:227]
s_add_u32 s82, s82, 0x8000
ds_read_b128 a[160:163], v2 offset:24576
ds_read_b128 a[164:167], v2 offset:25600
v_mfma_f32_16x16x32_bf16 v[232:235], v[120:123], v[216:219], v[232:235]
s_and_b32 s82, s82, 0x1ffff
v_exp_f32 v164, v164
v_mfma_f32_16x16x32_bf16 v[232:235], v[120:123], v[200:203], v[232:235]
s_add_u32 m0, s74, 0
v_exp_f32 v165, v165
v_mfma_f32_16x16x32_bf16 a[0:3], a[224:227], v[208:211], a[0:3]
s_add_u32 s72, s81, 0
v_exp_f32 v166, v166
v_mfma_f32_16x16x32_bf16 a[64:67], a[192:195], v[200:203], a[64:67]
ds_read_b128 a[168:171], v2 offset:26624
v_cvt_pk_bf16_f32 v212, v164, v165
v_mfma_f32_16x16x32_bf16 a[64:67], a[224:227], v[216:219], a[64:67]
v_exp_f32 v167, v167
v_mfma_f32_16x16x32_bf16 a[68:71], a[228:231], v[216:219], a[68:71]
buffer_load_dwordx4 v1, s[44:47], s72 offen sc1 lds
v_mfma_f32_16x16x32_bf16 a[68:71], a[196:199], v[200:203], a[68:71]
v_exp_f32 v180, v180
v_mfma_f32_16x16x32_bf16 a[4:7], a[228:231], v[208:211], a[4:7]
ds_read_b128 a[172:175], v2 offset:27648
v_cvt_pk_bf16_f32 v213, v166, v167
v_mfma_f32_16x16x32_bf16 a[8:11], a[232:235], v[208:211], a[8:11]
v_exp_f32 v181, v181
v_mfma_f32_16x16x32_bf16 a[72:75], a[200:203], v[200:203], a[72:75]
ds_read_b128 a[176:179], v2 offset:28672
v_cvt_pk_bf16_f32 v214, v180, v181
v_mfma_f32_16x16x32_bf16 a[72:75], a[232:235], v[216:219], a[72:75]
v_exp_f32 v182, v182
v_mfma_f32_16x16x32_bf16 a[76:79], a[236:239], v[216:219], a[76:79]
v_exp_f32 v183, v183
v_mfma_f32_16x16x32_bf16 a[76:79], a[204:207], v[200:203], a[76:79]
ds_read_b128 a[180:183], v2 offset:29696
v_cvt_pk_bf16_f32 v215, v182, v183
v_mfma_f32_16x16x32_bf16 a[12:15], a[236:239], v[208:211], a[12:15]
v_exp_f32 v172, v172
v_mfma_f32_16x16x32_bf16 a[16:19], a[240:243], v[208:211], a[16:19]
s_waitcnt lgkmcnt(6)
ds_read_b128 a[184:187], v2 offset:30720
ds_read_b128 a[188:191], v2 offset:31744
v_mfma_f32_16x16x32_bf16 a[80:83], a[208:211], v[200:203], a[80:83]
v_exp_f32 v173, v173
v_mfma_f32_16x16x32_bf16 a[80:83], a[240:243], v[216:219], a[80:83]
buffer_load_dwordx4 v1, s[44:47], s72 offen offset:1024 sc1 lds
v_mfma_f32_16x16x32_bf16 a[84:87], a[244:247], v[216:219], a[84:87]
v_exp_f32 v174, v174
v_mfma_f32_16x16x32_bf16 a[84:87], a[212:215], v[200:203], a[84:87]
v_exp_f32 v175, v175
v_mfma_f32_16x16x32_bf16 a[20:23], a[244:247], v[208:211], a[20:23]
ds_read_b128 a[224:227], v2 offset:8192
v_cvt_pk_bf16_f32 v220, v172, v173
v_mfma_f32_16x16x32_bf16 a[24:27], a[248:251], v[208:211], a[24:27]
v_exp_f32 v188, v188
v_mfma_f32_16x16x32_bf16 a[88:91], a[216:219], v[200:203], a[88:91]
v_exp_f32 v189, v189
v_mfma_f32_16x16x32_bf16 a[88:91], a[248:251], v[216:219], a[88:91]
ds_read_b128 a[228:231], v2 offset:9216
v_cvt_pk_bf16_f32 v221, v174, v175
v_mfma_f32_16x16x32_bf16 a[92:95], a[252:255], v[216:219], a[92:95]
v_exp_f32 v190, v190
v_mfma_f32_16x16x32_bf16 a[92:95], a[220:223], v[200:203], a[92:95]
Lstub5:
s_cbranch_execz Lstub9
ds_read_b128 a[232:235], v2 offset:10240
v_cvt_pk_bf16_f32 v222, v188, v189
v_mfma_f32_16x16x32_bf16 a[28:31], a[252:255], v[208:211], a[28:31]
v_exp_f32 v191, v191
v_mfma_f32_16x16x32_bf16 v[136:139], a[128:131], v[48:51], v[88:91]
buffer_load_dwordx4 v1, s[44:47], s72 offen offset:2048 sc1 lds
v_mfma_f32_16x16x32_bf16 v[136:139], a[132:135], v[52:55], v[136:139]
v_exp_f32 v168, v168
v_mfma_f32_16x16x32_bf16 v[136:139], a[136:139], v[56:59], v[136:139]
ds_read_b128 a[236:239], v2 offset:11264
v_cvt_pk_bf16_f32 v223, v190, v191
v_mfma_f32_16x16x32_bf16 v[136:139], a[140:143], v[60:63], v[136:139]
v_exp_f32 v169, v169
v_mfma_f32_16x16x32_bf16 v[152:155], a[156:159], v[60:63], v[88:91]
ds_read_b128 a[240:243], v2 offset:12288
v_cvt_pk_bf16_f32 v216, v168, v169
v_mfma_f32_16x16x32_bf16 v[152:155], a[152:155], v[56:59], v[152:155]
v_exp_f32 v170, v170
v_mfma_f32_16x16x32_bf16 v[152:155], a[148:151], v[52:55], v[152:155]
v_exp_f32 v171, v171
v_mfma_f32_16x16x32_bf16 v[152:155], a[144:147], v[48:51], v[152:155]
ds_read_b128 a[244:247], v2 offset:13312
v_cvt_pk_bf16_f32 v217, v170, v171
v_mfma_f32_16x16x32_bf16 v[140:143], a[128:131], v[64:67], v[92:95]
v_exp_f32 v184, v184
v_mfma_f32_16x16x32_bf16 v[140:143], a[132:135], v[68:71], v[140:143]
ds_read_b128 a[248:251], v2 offset:14336
v_mfma_f32_16x16x32_bf16 v[140:143], a[136:139], v[72:75], v[140:143]
v_exp_f32 v185, v185
v_mfma_f32_16x16x32_bf16 v[140:143], a[140:143], v[76:79], v[140:143]
buffer_load_dwordx4 v1, s[44:47], s72 offen offset:3072 sc1 lds
v_mfma_f32_16x16x32_bf16 v[156:159], a[156:159], v[76:79], v[92:95]
ds_read_b128 a[252:255], v2 offset:15360
v_cvt_pk_bf16_f32 v218, v184, v185
v_mfma_f32_16x16x32_bf16 v[156:159], a[152:155], v[72:75], v[156:159]
v_exp_f32 v186, v186
v_mfma_f32_16x16x32_bf16 v[156:159], a[148:151], v[68:71], v[156:159]
s_waitcnt vmcnt(12) lgkmcnt(4)
v_exp_f32 v187, v187
v_mfma_f32_16x16x32_bf16 v[156:159], a[144:147], v[64:67], v[156:159]
s_barrier
v_cvt_pk_bf16_f32 v219, v186, v187
v_add_u32 v2, s82, v1
v_mfma_f32_16x16x32_bf16 v[228:231], v[120:123], v[196:199], v[228:231]
s_xor_b32 s74, s82, 0x10000
v_exp_f32 v136, v136
v_mfma_f32_16x16x32_bf16 v[228:231], v[120:123], v[212:215], v[228:231]
s_add_u32 s74, s74, s64
ds_read_b128 a[128:131], v2 offset:16384
v_add_u32 v5, s92, v5
v_mfma_f32_16x16x32_bf16 v[236:239], v[120:123], v[204:207], v[236:239]
s_add_u32 s81, s81, 0x8000
v_exp_f32 v137, v137
v_mfma_f32_16x16x32_bf16 v[236:239], v[120:123], v[220:223], v[236:239]
s_add_u32 m0, s74, 16384
ds_read_b128 a[132:135], v2 offset:17408
v_cvt_pk_bf16_f32 v200, v136, v137
v_mfma_f32_16x16x32_bf16 a[32:35], a[192:195], v[196:199], a[32:35]
s_add_u32 s72, s81, 16384
buffer_load_dwordx4 v1, s[44:47], s72 offen sc1 lds
v_mfma_f32_16x16x32_bf16 a[32:35], a[224:227], v[212:215], a[32:35]
s_add_u32 s69, s93, 0x4200000
v_exp_f32 v138, v138
v_mfma_f32_16x16x32_bf16 a[96:99], a[224:227], v[220:223], a[96:99]
ds_read_b128 a[136:139], v2 offset:18432
v_cndmask_b32 v5, v250, v5, vcc
v_mfma_f32_16x16x32_bf16 a[96:99], a[192:195], v[204:207], a[96:99]
v_exp_f32 v139, v139
v_mfma_f32_16x16x32_bf16 a[100:103], a[196:199], v[204:207], a[100:103]
ds_read_b128 a[140:143], v2 offset:19456
v_cvt_pk_bf16_f32 v201, v138, v139
v_mfma_f32_16x16x32_bf16 a[100:103], a[228:231], v[220:223], a[100:103]
buffer_store_dwordx4 v[112:115], v1, s[44:47], s69 offen sc1
v_mfma_f32_16x16x32_bf16 a[36:39], a[228:231], v[212:215], a[36:39]
v_exp_f32 v152, v152
v_mfma_f32_16x16x32_bf16 a[36:39], a[196:199], v[196:199], a[36:39]
ds_read_b128 a[144:147], v2 offset:20480
v_add_u32 v253, s58, v251
v_mfma_f32_16x16x32_bf16 a[40:43], a[200:203], v[196:199], a[40:43]
v_exp_f32 v153, v153
v_mfma_f32_16x16x32_bf16 a[40:43], a[232:235], v[212:215], a[40:43]
ds_read_b128 a[148:151], v2 offset:21504
v_cvt_pk_bf16_f32 v202, v152, v153
v_mfma_f32_16x16x32_bf16 a[104:107], a[232:235], v[220:223], a[104:107]
buffer_load_dwordx4 v1, s[44:47], s72 offen offset:1024 sc1 lds
v_mfma_f32_16x16x32_bf16 a[104:107], a[200:203], v[204:207], a[104:107]
v_exp_f32 v154, v154
v_mfma_f32_16x16x32_bf16 a[108:111], a[204:207], v[204:207], a[108:111]
ds_read_b128 a[152:155], v2 offset:22528
v_and_b32 v253, 3, v253
v_mfma_f32_16x16x32_bf16 a[108:111], a[236:239], v[220:223], a[108:111]
v_exp_f32 v155, v155
v_mfma_f32_16x16x32_bf16 a[44:47], a[236:239], v[212:215], a[44:47]
ds_read_b128 a[156:159], v2 offset:23552
v_cvt_pk_bf16_f32 v203, v154, v155
v_mfma_f32_16x16x32_bf16 a[44:47], a[204:207], v[196:199], a[44:47]
buffer_store_dwordx4 v[112:115], v1, s[44:47], s69 offen offset:1024 sc1
v_mfma_f32_16x16x32_bf16 a[48:51], a[208:211], v[196:199], a[48:51]
s_waitcnt lgkmcnt(8)
v_exp_f32 v140, v140
v_mfma_f32_16x16x32_bf16 a[48:51], a[240:243], v[212:215], a[48:51]
ds_read_b128 a[192:195], v2 offset:0
v_mul_u32_u24 v253, 4160, v253
v_mfma_f32_16x16x32_bf16 a[112:115], a[240:243], v[220:223], a[112:115]
v_exp_f32 v141, v141
v_mfma_f32_16x16x32_bf16 a[112:115], a[208:211], v[204:207], a[112:115]
ds_read_b128 a[196:199], v2 offset:1024
v_add_u32 v5, v5, v253
v_mfma_f32_16x16x32_bf16 a[116:119], a[212:215], v[204:207], a[116:119]
s_add_u32 s73, s62, 480
buffer_load_dwordx4 v1, s[44:47], s72 offen offset:2048 sc1 lds
v_mfma_f32_16x16x32_bf16 a[116:119], a[244:247], v[220:223], a[116:119]
v_exp_f32 v142, v142
v_mfma_f32_16x16x32_bf16 a[52:55], a[244:247], v[212:215], a[52:55]
ds_read_b128 a[200:203], v2 offset:2048
v_lshlrev_b32 v248, 5, v240
v_mfma_f32_16x16x32_bf16 a[52:55], a[212:215], v[196:199], a[52:55]
v_exp_f32 v143, v143
v_mfma_f32_16x16x32_bf16 a[56:59], a[216:219], v[196:199], a[56:59]
ds_read_b128 a[204:207], v2 offset:3072
v_sub_u32 v248, s73, v248
v_mfma_f32_16x16x32_bf16 a[56:59], a[248:251], v[212:215], a[56:59]
buffer_store_dwordx4 v[112:115], v1, s[44:47], s69 offen offset:2048 sc1
v_mfma_f32_16x16x32_bf16 a[120:123], a[248:251], v[220:223], a[120:123]
v_exp_f32 v156, v156
v_mfma_f32_16x16x32_bf16 a[120:123], a[216:219], v[204:207], a[120:123]
ds_read_b128 a[208:211], v2 offset:4096
v_lshl_add_u32 v7, v241, 4, v248
v_mfma_f32_16x16x32_bf16 a[124:127], a[220:223], v[204:207], a[124:127]
s_and_b32 s73, s58, 1
v_exp_f32 v157, v157
v_mfma_f32_16x16x32_bf16 a[124:127], a[252:255], v[220:223], a[124:127]
s_lshl_b32 s73, s73, 4
ds_read_b128 a[212:215], v2 offset:5120
v_mfma_f32_16x16x32_bf16 a[60:63], a[252:255], v[212:215], a[60:63]
s_lshr_b32 s73, s90, s73
buffer_load_dwordx4 v1, s[44:47], s72 offen offset:3072 sc1 lds
v_mfma_f32_16x16x32_bf16 a[60:63], a[220:223], v[196:199], a[60:63]
s_and_b32 s73, s73, 0xffff
ds_read_b128 a[216:219], v2 offset:6144
v_cvt_pk_bf16_f32 v204, v140, v141
v_mfma_f32_16x16x32_bf16 v[172:175], a[160:163], v[64:67], v[92:95]
v_exp_f32 v158, v158
v_mfma_f32_16x16x32_bf16 v[172:175], a[164:167], v[68:71], v[172:175]
ds_read_b128 a[220:223], v2 offset:7168
v_cvt_pk_bf16_f32 v205, v142, v143
v_mfma_f32_16x16x32_bf16 v[172:175], a[168:171], v[72:75], v[172:175]
v_exp_f32 v159, v159
v_mfma_f32_16x16x32_bf16 v[172:175], a[172:175], v[76:79], v[172:175]
buffer_store_dwordx4 v[112:115], v1, s[44:47], s69 offen offset:3072 sc1
v_mfma_f32_16x16x32_bf16 v[188:191], a[188:191], v[76:79], v[92:95]
v_cvt_pk_bf16_f32 v206, v156, v157
v_cvt_pk_bf16_f32 v207, v158, v159
v_mfma_f32_16x16x32_bf16 v[188:191], a[184:187], v[72:75], v[188:191]
v_lshl_add_u32 v248, v241, 3, v240
v_sub_u32 v248, 15, v248
v_mfma_f32_16x16x32_bf16 v[188:191], a[180:183], v[68:71], v[188:191]
v_and_b32 v249, 1, v248
v_lshlrev_b32 v249, 4, v249
v_mfma_f32_16x16x32_bf16 v[188:191], a[176:179], v[64:67], v[188:191]
v_lshlrev_b32 v249, v249, s73
v_lshrrev_b32 v248, 1, v248
v_mfma_f32_16x16x32_bf16 v[168:171], a[160:163], v[48:51], v[88:91]
v_and_b32 v241, 3, v0
v_cmp_eq_u32 vcc, 0, v248
v_mfma_f32_16x16x32_bf16 v[168:171], a[164:167], v[52:55], v[168:171]
v_lshl_add_u32 v5, v241, 3, v5
v_cndmask_b32 v8, 0, v249, vcc
v_mfma_f32_16x16x32_bf16 v[168:171], a[168:171], v[56:59], v[168:171]
v_cmp_eq_u32 vcc, 1, v248
v_lshlrev_b32 v240, 4, v251
v_mfma_f32_16x16x32_bf16 v[168:171], a[172:175], v[60:63], v[168:171]
v_cndmask_b32 v9, 0, v249, vcc
v_cmp_eq_u32 vcc, 2, v248
v_mfma_f32_16x16x32_bf16 v[184:187], a[188:191], v[60:63], v[88:91]
v_sub_u32 v240, 48, v240
v_lshlrev_b64 v[12:13], 16, s[88:89]
v_mfma_f32_16x16x32_bf16 v[184:187], a[184:187], v[56:59], v[184:187]
v_cndmask_b32 v10, 0, v249, vcc
v_cmp_eq_u32 vcc, 3, v248
v_mfma_f32_16x16x32_bf16 v[184:187], a[180:183], v[52:55], v[184:187]
v_lshlrev_b64 v[12:13], v240, v[12:13]
v_cndmask_b32 v11, 0, v249, vcc
v_mfma_f32_16x16x32_bf16 v[184:187], a[176:179], v[48:51], v[184:187]
s_waitcnt lgkmcnt(4)
v_cmp_eq_u32 vcc, 3, v241
s_add_u32 s73, s62, 4096
v_lshl_add_u32 v14, v0, 3, s73
v_cndmask_b32 v12, 0, v12, vcc
v_cndmask_b32 v13, 0, v13, vcc
v_lshrrev_b32 v15, 4, v0
v_lshlrev_b32 v15, 1, v15
v_and_b32 v240, 7, v0
v_xor_b32 v15, v15, v240
v_lshlrev_b32 v15, 4, v15
v_lshrrev_b32 v240, 3, v0
v_lshl_add_u32 v15, v240, 11, v15
s_lshl_b32 s75, s59, 1
s_andn2_b32 s75, 8, s75
s_add_u32 s75, s75, s60
s_lshl_b32 s76, s65, 2
s_lshr_b32 s80, s59, 3
s_add_u32 s76, s76, s80
s_lshl_b32 s94, s58, 16
s_lshl_b32 s80, s76, 7
s_add_u32 s94, s94, s80
s_lshl_b32 s80, s75, 18
s_add_u32 s80, s80, s94
v_rcp_f32 v226, v224
v_rcp_f32 v230, v228
s_lshl_b32 s73, s52, 12
s_add_u32 s73, s73, 0x2000000
s_lshl_b32 s70, s67, 2
s_add_u32 s70, s70, s73
v_or_b32 v3, s53, v1
v_mov_b32 v227, v226
v_accvgpr_read_b32 v240, a0
v_accvgpr_read_b32 v241, a1
v_accvgpr_read_b32 v242, a2
v_accvgpr_read_b32 v243, a3
v_accvgpr_read_b32 v244, a4
v_accvgpr_read_b32 v245, a5
v_accvgpr_read_b32 v246, a6
v_accvgpr_read_b32 v247, a7
v_pk_mul_f32 v[240:241], v[240:241], v[226:227]
v_pk_mul_f32 v[242:243], v[242:243], v[226:227]
v_pk_mul_f32 v[244:245], v[244:245], v[226:227]
v_pk_mul_f32 v[246:247], v[246:247], v[226:227]
v_cvt_pk_bf16_f32 v128, v240, v241
v_cvt_pk_bf16_f32 v129, v242, v243
v_cvt_pk_bf16_f32 v130, v244, v245
v_cvt_pk_bf16_f32 v131, v246, v247
v_accvgpr_read_b32 v248, a8
v_accvgpr_read_b32 v249, a9
v_accvgpr_read_b32 v250, a10
v_accvgpr_read_b32 v251, a11
v_accvgpr_read_b32 v252, a12
v_accvgpr_read_b32 v253, a13
v_accvgpr_read_b32 v254, a14
v_accvgpr_read_b32 v255, a15
v_pk_mul_f32 v[248:249], v[248:249], v[226:227]
v_pk_mul_f32 v[250:251], v[250:251], v[226:227]
v_pk_mul_f32 v[252:253], v[252:253], v[226:227]
v_pk_mul_f32 v[254:255], v[254:255], v[226:227]
v_cvt_pk_bf16_f32 v144, v248, v249
v_cvt_pk_bf16_f32 v145, v250, v251
v_cvt_pk_bf16_f32 v146, v252, v253
v_cvt_pk_bf16_f32 v147, v254, v255
v_accvgpr_read_b32 v240, a16
v_accvgpr_read_b32 v241, a17
v_accvgpr_read_b32 v242, a18
v_accvgpr_read_b32 v243, a19
v_accvgpr_read_b32 v244, a20
v_accvgpr_read_b32 v245, a21
v_accvgpr_read_b32 v246, a22
v_accvgpr_read_b32 v247, a23
v_pk_mul_f32 v[240:241], v[240:241], v[226:227]
v_pk_mul_f32 v[242:243], v[242:243], v[226:227]
v_pk_mul_f32 v[244:245], v[244:245], v[226:227]
v_pk_mul_f32 v[246:247], v[246:247], v[226:227]
v_cvt_pk_bf16_f32 v160, v240, v241
v_cvt_pk_bf16_f32 v161, v242, v243
v_cvt_pk_bf16_f32 v162, v244, v245
v_cvt_pk_bf16_f32 v163, v246, v247
v_accvgpr_read_b32 v248, a24
v_accvgpr_read_b32 v249, a25
v_accvgpr_read_b32 v250, a26
v_accvgpr_read_b32 v251, a27
v_accvgpr_read_b32 v252, a28
v_accvgpr_read_b32 v253, a29
v_accvgpr_read_b32 v254, a30
v_accvgpr_read_b32 v255, a31
v_pk_mul_f32 v[248:249], v[248:249], v[226:227]
v_pk_mul_f32 v[250:251], v[250:251], v[226:227]
v_pk_mul_f32 v[252:253], v[252:253], v[226:227]
v_pk_mul_f32 v[254:255], v[254:255], v[226:227]
v_cvt_pk_bf16_f32 v176, v248, v249
v_cvt_pk_bf16_f32 v177, v250, v251
v_cvt_pk_bf16_f32 v178, v252, v253
v_cvt_pk_bf16_f32 v179, v254, v255
v_mov_b32 v231, v230
v_accvgpr_read_b32 v240, a32
v_accvgpr_read_b32 v241, a33
v_accvgpr_read_b32 v242, a34
v_accvgpr_read_b32 v243, a35
v_accvgpr_read_b32 v244, a36
v_accvgpr_read_b32 v245, a37
v_accvgpr_read_b32 v246, a38
v_accvgpr_read_b32 v247, a39
v_pk_mul_f32 v[240:241], v[240:241], v[230:231]
v_pk_mul_f32 v[242:243], v[242:243], v[230:231]
v_pk_mul_f32 v[244:245], v[244:245], v[230:231]
v_pk_mul_f32 v[246:247], v[246:247], v[230:231]
v_cvt_pk_bf16_f32 v132, v240, v241
v_cvt_pk_bf16_f32 v133, v242, v243
v_cvt_pk_bf16_f32 v134, v244, v245
v_cvt_pk_bf16_f32 v135, v246, v247
v_accvgpr_read_b32 v248, a40
v_accvgpr_read_b32 v249, a41
v_accvgpr_read_b32 v250, a42
v_accvgpr_read_b32 v251, a43
v_accvgpr_read_b32 v252, a44
v_accvgpr_read_b32 v253, a45
v_accvgpr_read_b32 v254, a46
v_accvgpr_read_b32 v255, a47
v_pk_mul_f32 v[248:249], v[248:249], v[230:231]
v_pk_mul_f32 v[250:251], v[250:251], v[230:231]
v_pk_mul_f32 v[252:253], v[252:253], v[230:231]
v_pk_mul_f32 v[254:255], v[254:255], v[230:231]
v_cvt_pk_bf16_f32 v148, v248, v249
v_cvt_pk_bf16_f32 v149, v250, v251
v_cvt_pk_bf16_f32 v150, v252, v253
v_cvt_pk_bf16_f32 v151, v254, v255
v_accvgpr_read_b32 v240, a48
v_accvgpr_read_b32 v241, a49
v_accvgpr_read_b32 v242, a50
v_accvgpr_read_b32 v243, a51
v_accvgpr_read_b32 v244, a52
v_accvgpr_read_b32 v245, a53
v_accvgpr_read_b32 v246, a54
v_accvgpr_read_b32 v247, a55
v_pk_mul_f32 v[240:241], v[240:241], v[230:231]
v_pk_mul_f32 v[242:243], v[242:243], v[230:231]
v_pk_mul_f32 v[244:245], v[244:245], v[230:231]
v_pk_mul_f32 v[246:247], v[246:247], v[230:231]
v_cvt_pk_bf16_f32 v164, v240, v241
v_cvt_pk_bf16_f32 v165, v242, v243
v_cvt_pk_bf16_f32 v166, v244, v245
v_cvt_pk_bf16_f32 v167, v246, v247
v_accvgpr_read_b32 v248, a56
v_accvgpr_read_b32 v249, a57
v_accvgpr_read_b32 v250, a58
v_accvgpr_read_b32 v251, a59
v_accvgpr_read_b32 v252, a60
v_accvgpr_read_b32 v253, a61
v_accvgpr_read_b32 v254, a62
v_accvgpr_read_b32 v255, a63
v_pk_mul_f32 v[248:249], v[248:249], v[230:231]
v_pk_mul_f32 v[250:251], v[250:251], v[230:231]
v_pk_mul_f32 v[252:253], v[252:253], v[230:231]
v_pk_mul_f32 v[254:255], v[254:255], v[230:231]
v_cvt_pk_bf16_f32 v180, v248, v249
v_cvt_pk_bf16_f32 v181, v250, v251
v_cvt_pk_bf16_f32 v182, v252, v253
v_cvt_pk_bf16_f32 v183, v254, v255
v_mfma_f32_16x16x32_bf16 v[232:235], v[120:123], v[216:219], v[232:235]
s_add_u32 s82, s82, 0x8000
ds_read_b128 a[160:163], v2 offset:24576
ds_read_b128 a[164:167], v2 offset:25600
v_mfma_f32_16x16x32_bf16 v[232:235], v[120:123], v[200:203], v[232:235]
s_and_b32 s82, s82, 0x1ffff
v_exp_f32 v172, v172
v_mfma_f32_16x16x32_bf16 a[64:67], a[224:227], v[216:219], a[64:67]
s_add_u32 m0, s74, 0
v_exp_f32 v173, v173
v_mfma_f32_16x16x32_bf16 a[64:67], a[192:195], v[200:203], a[64:67]
s_add_u32 s72, s81, 0
buffer_load_dwordx4 v1, s[44:47], s72 offen sc1 lds
v_mfma_f32_16x16x32_bf16 a[68:71], a[196:199], v[200:203], a[68:71]
ds_read_b128 a[168:171], v2 offset:26624
v_cvt_pk_bf16_f32 v220, v172, v173
v_mfma_f32_16x16x32_bf16 a[68:71], a[228:231], v[216:219], a[68:71]
v_exp_f32 v174, v174
v_mfma_f32_16x16x32_bf16 a[72:75], a[232:235], v[216:219], a[72:75]
s_nop 0
ds_read_b128 a[172:175], v2 offset:27648
ds_read_b128 a[176:179], v2 offset:28672
v_mfma_f32_16x16x32_bf16 a[72:75], a[200:203], v[200:203], a[72:75]
v_exp_f32 v175, v175
v_mfma_f32_16x16x32_bf16 a[76:79], a[204:207], v[200:203], a[76:79]
v_exp_f32 v188, v188
v_mfma_f32_16x16x32_bf16 a[76:79], a[236:239], v[216:219], a[76:79]
buffer_store_dwordx4 v[128:131], v3, s[44:47], s70 offen sc1
v_mfma_f32_16x16x32_bf16 a[80:83], a[240:243], v[216:219], a[80:83]
s_waitcnt lgkmcnt(5)
ds_read_b128 a[180:183], v2 offset:29696
v_cvt_pk_bf16_f32 v221, v174, v175
v_mfma_f32_16x16x32_bf16 a[80:83], a[208:211], v[200:203], a[80:83]
v_exp_f32 v189, v189
v_mfma_f32_16x16x32_bf16 a[84:87], a[212:215], v[200:203], a[84:87]
ds_read_b128 a[184:187], v2 offset:30720
v_cvt_pk_bf16_f32 v222, v188, v189
v_mfma_f32_16x16x32_bf16 a[84:87], a[244:247], v[216:219], a[84:87]
v_exp_f32 v190, v190
v_mfma_f32_16x16x32_bf16 a[88:91], a[248:251], v[216:219], a[88:91]
buffer_load_dwordx4 v1, s[44:47], s72 offen offset:1024 sc1 lds
v_mfma_f32_16x16x32_bf16 a[88:91], a[216:219], v[200:203], a[88:91]
s_nop 0
ds_read_b128 a[188:191], v2 offset:31744
ds_read_b128 a[224:227], v2 offset:8192
v_mfma_f32_16x16x32_bf16 a[92:95], a[220:223], v[200:203], a[92:95]
v_exp_f32 v191, v191
v_mfma_f32_16x16x32_bf16 a[92:95], a[252:255], v[216:219], a[92:95]
v_exp_f32 v168, v168
v_mfma_f32_16x16x32_bf16 v[136:139], a[128:131], v[48:51], v[88:91]
ds_read_b128 a[228:231], v2 offset:9216
v_cvt_pk_bf16_f32 v223, v190, v191
v_mfma_f32_16x16x32_bf16 v[136:139], a[132:135], v[52:55], v[136:139]
v_exp_f32 v169, v169
v_mfma_f32_16x16x32_bf16 v[136:139], a[136:139], v[56:59], v[136:139]
buffer_store_dwordx4 v[144:147], v3, s[44:47], s70 offen offset:1024 sc1
v_mfma_f32_16x16x32_bf16 v[136:139], a[140:143], v[60:63], v[136:139]
ds_read_b128 a[232:235], v2 offset:10240
v_cvt_pk_bf16_f32 v216, v168, v169
v_mfma_f32_16x16x32_bf16 v[152:155], a[156:159], v[60:63], v[88:91]
v_exp_f32 v170, v170
v_mfma_f32_16x16x32_bf16 v[152:155], a[152:155], v[56:59], v[152:155]
s_nop 0
ds_read_b128 a[236:239], v2 offset:11264
ds_read_b128 a[240:243], v2 offset:12288
v_mfma_f32_16x16x32_bf16 v[152:155], a[148:151], v[52:55], v[152:155]
v_exp_f32 v171, v171
v_mfma_f32_16x16x32_bf16 v[152:155], a[144:147], v[48:51], v[152:155]
buffer_load_dwordx4 v1, s[44:47], s72 offen offset:2048 sc1 lds
v_mfma_f32_16x16x32_bf16 v[140:143], a[128:131], v[64:67], v[92:95]
v_exp_f32 v184, v184
v_mfma_f32_16x16x32_bf16 v[140:143], a[132:135], v[68:71], v[140:143]
ds_read_b128 a[244:247], v2 offset:13312
v_cvt_pk_bf16_f32 v217, v170, v171
v_mfma_f32_16x16x32_bf16 v[140:143], a[136:139], v[72:75], v[140:143]
v_exp_f32 v185, v185
v_mfma_f32_16x16x32_bf16 v[140:143], a[140:143], v[76:79], v[140:143]
s_nop 0
ds_read_b128 a[248:251], v2 offset:14336
ds_read_b128 a[252:255], v2 offset:15360
v_mfma_f32_16x16x32_bf16 v[156:159], a[156:159], v[76:79], v[92:95]
v_exp_f32 v186, v186
v_mfma_f32_16x16x32_bf16 v[156:159], a[152:155], v[72:75], v[156:159]
buffer_load_dwordx4 v1, s[44:47], s72 offen offset:3072 sc1 lds
v_mfma_f32_16x16x32_bf16 v[156:159], a[148:151], v[68:71], v[156:159]
s_waitcnt vmcnt(14) lgkmcnt(4)
v_exp_f32 v187, v187
v_mfma_f32_16x16x32_bf16 v[156:159], a[144:147], v[64:67], v[156:159]
s_barrier
v_cvt_pk_bf16_f32 v218, v184, v185
v_cvt_pk_bf16_f32 v219, v186, v187
v_add_u32 v2, s82, v1
v_mfma_f32_16x16x32_bf16 v[236:239], v[120:123], v[204:207], v[236:239]
s_xor_b32 s74, s82, 0x10000
v_exp_f32 v136, v136
v_mfma_f32_16x16x32_bf16 v[236:239], v[120:123], v[220:223], v[236:239]
s_add_u32 s74, s74, s64
ds_read_b128 a[128:131], v2 offset:16384
ds_read_b128 a[132:135], v2 offset:17408
v_mfma_f32_16x16x32_bf16 a[96:99], a[192:195], v[204:207], a[96:99]
s_add_u32 s81, s81, 0x8000
v_exp_f32 v137, v137
v_mfma_f32_16x16x32_bf16 a[96:99], a[224:227], v[220:223], a[96:99]
s_add_u32 m0, s74, 16384
v_exp_f32 v138, v138
v_mfma_f32_16x16x32_bf16 a[100:103], a[228:231], v[220:223], a[100:103]
s_add_u32 s72, s81, 16384
buffer_load_dwordx4 v1, s[44:47], s72 offen sc1 lds
v_mfma_f32_16x16x32_bf16 a[100:103], a[196:199], v[204:207], a[100:103]
ds_read_b128 a[136:139], v2 offset:18432
v_cvt_pk_bf16_f32 v200, v136, v137
v_mfma_f32_16x16x32_bf16 a[104:107], a[200:203], v[204:207], a[104:107]
v_exp_f32 v139, v139
v_mfma_f32_16x16x32_bf16 a[104:107], a[232:235], v[220:223], a[104:107]
ds_read_b128 a[140:143], v2 offset:19456
v_cvt_pk_bf16_f32 v201, v138, v139
v_mfma_f32_16x16x32_bf16 a[108:111], a[236:239], v[220:223], a[108:111]
buffer_store_dwordx4 v[160:163], v3, s[44:47], s70 offen offset:2048 sc1
v_mfma_f32_16x16x32_bf16 a[108:111], a[204:207], v[204:207], a[108:111]
v_exp_f32 v152, v152
v_mfma_f32_16x16x32_bf16 a[112:115], a[208:211], v[204:207], a[112:115]
s_waitcnt lgkmcnt(4)
ds_read_b128 a[144:147], v2 offset:20480
ds_read_b128 a[148:151], v2 offset:21504
v_mfma_f32_16x16x32_bf16 a[112:115], a[240:243], v[220:223], a[112:115]
v_exp_f32 v153, v153
v_mfma_f32_16x16x32_bf16 a[116:119], a[244:247], v[220:223], a[116:119]
buffer_load_dwordx4 v1, s[44:47], s72 offen offset:1024 sc1 lds
v_mfma_f32_16x16x32_bf16 a[116:119], a[212:215], v[204:207], a[116:119]
v_exp_f32 v154, v154
v_mfma_f32_16x16x32_bf16 a[120:123], a[216:219], v[204:207], a[120:123]
ds_read_b128 a[152:155], v2 offset:22528
v_cvt_pk_bf16_f32 v202, v152, v153
v_mfma_f32_16x16x32_bf16 a[120:123], a[248:251], v[220:223], a[120:123]
v_exp_f32 v155, v155
v_mfma_f32_16x16x32_bf16 a[124:127], a[252:255], v[220:223], a[124:127]
ds_read_b128 a[156:159], v2 offset:23552
v_cvt_pk_bf16_f32 v203, v154, v155
v_mfma_f32_16x16x32_bf16 a[124:127], a[220:223], v[204:207], a[124:127]
v_exp_f32 v140, v140
v_mfma_f32_16x16x32_bf16 v[172:175], a[160:163], v[64:67], v[92:95]
s_nop 0
ds_read_b128 a[192:195], v2 offset:0
ds_read_b128 a[196:199], v2 offset:1024
v_mfma_f32_16x16x32_bf16 v[172:175], a[164:167], v[68:71], v[172:175]
buffer_store_dwordx4 v[176:179], v3, s[44:47], s70 offen offset:3072 sc1
v_mfma_f32_16x16x32_bf16 v[172:175], a[168:171], v[72:75], v[172:175]
v_exp_f32 v141, v141
v_mfma_f32_16x16x32_bf16 v[172:175], a[172:175], v[76:79], v[172:175]
v_exp_f32 v142, v142
v_mfma_f32_16x16x32_bf16 v[188:191], a[188:191], v[76:79], v[92:95]
s_nop 0
ds_read_b128 a[200:203], v2 offset:2048
ds_read_b128 a[204:207], v2 offset:3072
v_mfma_f32_16x16x32_bf16 v[188:191], a[184:187], v[72:75], v[188:191]
buffer_load_dwordx4 v1, s[44:47], s72 offen offset:2048 sc1 lds
v_mfma_f32_16x16x32_bf16 v[188:191], a[180:183], v[68:71], v[188:191]
s_add_u32 s70, s70, 0x80000
v_exp_f32 v143, v143
v_mfma_f32_16x16x32_bf16 v[188:191], a[176:179], v[64:67], v[188:191]
v_exp_f32 v156, v156
v_mfma_f32_16x16x32_bf16 v[168:171], a[160:163], v[48:51], v[88:91]
s_nop 0
ds_read_b128 a[208:211], v2 offset:4096
ds_read_b128 a[212:215], v2 offset:5120
v_mfma_f32_16x16x32_bf16 v[168:171], a[164:167], v[52:55], v[168:171]
s_nop 0
ds_read_b128 a[216:219], v2 offset:6144
ds_read_b128 a[220:223], v2 offset:7168
v_mfma_f32_16x16x32_bf16 v[168:171], a[168:171], v[56:59], v[168:171]
v_cvt_pk_bf16_f32 v204, v140, v141
v_cvt_pk_bf16_f32 v205, v142, v143
v_mfma_f32_16x16x32_bf16 v[168:171], a[172:175], v[60:63], v[168:171]
buffer_store_dwordx4 v[132:135], v3, s[44:47], s70 offen sc1
v_mfma_f32_16x16x32_bf16 v[184:187], a[188:191], v[60:63], v[88:91]
v_exp_f32 v157, v157
v_mfma_f32_16x16x32_bf16 v[184:187], a[184:187], v[56:59], v[184:187]
v_exp_f32 v158, v158
v_mfma_f32_16x16x32_bf16 v[184:187], a[180:183], v[52:55], v[184:187]
buffer_load_dwordx4 v1, s[44:47], s72 offen offset:3072 sc1 lds
v_mfma_f32_16x16x32_bf16 v[184:187], a[176:179], v[48:51], v[184:187]
s_waitcnt lgkmcnt(4)
v_exp_f32 v159, v159
v_cvt_pk_bf16_f32 v206, v156, v157
v_cvt_pk_bf16_f32 v207, v158, v159
v_mfma_f32_16x16x32_bf16 v[232:235], v[120:123], v[216:219], v[232:235]
s_add_u32 s82, s82, 0x8000
ds_read_b128 a[160:163], v2 offset:24576
ds_read_b128 a[164:167], v2 offset:25600
v_mfma_f32_16x16x32_bf16 v[232:235], v[120:123], v[200:203], v[232:235]
s_and_b32 s82, s82, 0x1ffff
v_exp_f32 v172, v172
v_mfma_f32_16x16x32_bf16 a[64:67], a[224:227], v[216:219], a[64:67]
s_add_u32 m0, s74, 0
v_exp_f32 v173, v173
v_mfma_f32_16x16x32_bf16 a[64:67], a[192:195], v[200:203], a[64:67]
s_add_u32 s72, s81, 0
buffer_load_dwordx4 v1, s[44:47], s72 offen sc1 lds
v_mfma_f32_16x16x32_bf16 a[68:71], a[196:199], v[200:203], a[68:71]
ds_read_b128 a[168:171], v2 offset:26624
v_cvt_pk_bf16_f32 v220, v172, v173
v_mfma_f32_16x16x32_bf16 a[68:71], a[228:231], v[216:219], a[68:71]
v_exp_f32 v174, v174
v_mfma_f32_16x16x32_bf16 a[72:75], a[232:235], v[216:219], a[72:75]
s_nop 0
ds_read_b128 a[172:175], v2 offset:27648
ds_read_b128 a[176:179], v2 offset:28672
v_mfma_f32_16x16x32_bf16 a[72:75], a[200:203], v[200:203], a[72:75]
v_exp_f32 v175, v175
v_mfma_f32_16x16x32_bf16 a[76:79], a[204:207], v[200:203], a[76:79]
buffer_store_dwordx4 v[148:151], v3, s[44:47], s70 offen offset:1024 sc1
v_mfma_f32_16x16x32_bf16 a[76:79], a[236:239], v[216:219], a[76:79]
v_exp_f32 v188, v188
v_mfma_f32_16x16x32_bf16 a[80:83], a[240:243], v[216:219], a[80:83]
s_waitcnt lgkmcnt(5)
ds_read_b128 a[180:183], v2 offset:29696
v_cvt_pk_bf16_f32 v221, v174, v175
v_mfma_f32_16x16x32_bf16 a[80:83], a[208:211], v[200:203], a[80:83]
v_exp_f32 v189, v189
v_mfma_f32_16x16x32_bf16 a[84:87], a[212:215], v[200:203], a[84:87]
buffer_load_dwordx4 v1, s[44:47], s72 offen offset:1024 sc1 lds
v_mfma_f32_16x16x32_bf16 a[84:87], a[244:247], v[216:219], a[84:87]
ds_read_b128 a[184:187], v2 offset:30720
v_cvt_pk_bf16_f32 v222, v188, v189
v_mfma_f32_16x16x32_bf16 a[88:91], a[248:251], v[216:219], a[88:91]
v_exp_f32 v190, v190
v_mfma_f32_16x16x32_bf16 a[88:91], a[216:219], v[200:203], a[88:91]
s_nop 0
ds_read_b128 a[188:191], v2 offset:31744
ds_read_b128 a[224:227], v2 offset:8192
v_mfma_f32_16x16x32_bf16 a[92:95], a[220:223], v[200:203], a[92:95]
v_exp_f32 v191, v191
v_mfma_f32_16x16x32_bf16 a[92:95], a[252:255], v[216:219], a[92:95]
buffer_store_dwordx4 v[164:167], v3, s[44:47], s70 offen offset:2048 sc1
v_mfma_f32_16x16x32_bf16 v[136:139], a[128:131], v[48:51], v[88:91]
v_exp_f32 v168, v168
v_mfma_f32_16x16x32_bf16 v[136:139], a[132:135], v[52:55], v[136:139]
ds_read_b128 a[228:231], v2 offset:9216
v_cvt_pk_bf16_f32 v223, v190, v191
v_mfma_f32_16x16x32_bf16 v[136:139], a[136:139], v[56:59], v[136:139]
Lstub6:
s_cbranch_execz Lstub10
v_exp_f32 v169, v169
v_mfma_f32_16x16x32_bf16 v[136:139], a[140:143], v[60:63], v[136:139]
s_nop 0
ds_read_b128 a[232:235], v2 offset:10240
ds_read_b128 a[236:239], v2 offset:11264
v_mfma_f32_16x16x32_bf16 v[152:155], a[156:159], v[60:63], v[88:91]
v_exp_f32 v170, v170
v_mfma_f32_16x16x32_bf16 v[152:155], a[152:155], v[56:59], v[152:155]
buffer_load_dwordx4 v1, s[44:47], s72 offen offset:2048 sc1 lds
v_mfma_f32_16x16x32_bf16 v[152:155], a[148:151], v[52:55], v[152:155]
v_exp_f32 v171, v171
v_mfma_f32_16x16x32_bf16 v[152:155], a[144:147], v[48:51], v[152:155]
s_nop 0
ds_read_b128 a[240:243], v2 offset:12288
ds_read_b128 a[244:247], v2 offset:13312
v_mfma_f32_16x16x32_bf16 v[140:143], a[128:131], v[64:67], v[92:95]
v_exp_f32 v184, v184
v_mfma_f32_16x16x32_bf16 v[140:143], a[132:135], v[68:71], v[140:143]
s_nop 0
ds_read_b128 a[248:251], v2 offset:14336
ds_read_b128 a[252:255], v2 offset:15360
v_mfma_f32_16x16x32_bf16 v[140:143], a[136:139], v[72:75], v[140:143]
v_cvt_pk_bf16_f32 v216, v168, v169
v_cvt_pk_bf16_f32 v217, v170, v171
v_mfma_f32_16x16x32_bf16 v[140:143], a[140:143], v[76:79], v[140:143]
buffer_store_dwordx4 v[180:183], v3, s[44:47], s70 offen offset:3072 sc1
v_mfma_f32_16x16x32_bf16 v[156:159], a[156:159], v[76:79], v[92:95]
v_exp_f32 v185, v185
v_mfma_f32_16x16x32_bf16 v[156:159], a[152:155], v[72:75], v[156:159]
buffer_load_dwordx4 v1, s[44:47], s72 offen offset:3072 sc1 lds
v_mfma_f32_16x16x32_bf16 v[156:159], a[148:151], v[68:71], v[156:159]
s_waitcnt vmcnt(14) lgkmcnt(4)
v_exp_f32 v186, v186
v_mfma_f32_16x16x32_bf16 v[156:159], a[144:147], v[64:67], v[156:159]
s_barrier
v_exp_f32 v187, v187
v_add_u32 v2, s82, v1
v_cvt_pk_bf16_f32 v218, v184, v185
v_cvt_pk_bf16_f32 v219, v186, v187
s_lshl_b32 s83, s60, 2
s_sub_u32 s83, s83, 25
.p2align 5
s_nop 0
s_nop 0
LloopII:
v_mfma_f32_16x16x32_bf16 v[236:239], v[120:123], v[204:207], v[236:239]
s_xor_b32 s74, s82, 0x10000
v_exp_f32 v136, v136
v_mfma_f32_16x16x32_bf16 v[236:239], v[120:123], v[220:223], v[236:239]
s_add_u32 s74, s74, s64
ds_read_b128 a[128:131], v2 offset:16384
ds_read_b128 a[132:135], v2 offset:17408
v_mfma_f32_16x16x32_bf16 a[96:99], a[192:195], v[204:207], a[96:99]
s_add_u32 s81, s81, 0x8000
v_exp_f32 v137, v137
v_mfma_f32_16x16x32_bf16 a[96:99], a[224:227], v[220:223], a[96:99]
s_add_u32 m0, s74, 16384
v_exp_f32 v138, v138
v_mfma_f32_16x16x32_bf16 a[100:103], a[228:231], v[220:223], a[100:103]
s_add_u32 s72, s81, 16384
ds_read_b128 a[136:139], v2 offset:18432
v_cvt_pk_bf16_f32 v200, v136, v137
v_mfma_f32_16x16x32_bf16 a[100:103], a[196:199], v[204:207], a[100:103]
buffer_load_dwordx4 v1, s[44:47], s72 offen sc1 lds
v_mfma_f32_16x16x32_bf16 a[104:107], a[200:203], v[204:207], a[104:107]
v_exp_f32 v139, v139
v_mfma_f32_16x16x32_bf16 a[104:107], a[232:235], v[220:223], a[104:107]
ds_read_b128 a[140:143], v2 offset:19456
v_cvt_pk_bf16_f32 v201, v138, v139
v_mfma_f32_16x16x32_bf16 a[108:111], a[236:239], v[220:223], a[108:111]
v_exp_f32 v152, v152
v_mfma_f32_16x16x32_bf16 a[108:111], a[204:207], v[204:207], a[108:111]
s_nop 0
ds_read_b128 a[144:147], v2 offset:20480
ds_read_b128 a[148:151], v2 offset:21504
v_mfma_f32_16x16x32_bf16 a[112:115], a[208:211], v[204:207], a[112:115]
s_waitcnt lgkmcnt(6)
v_exp_f32 v153, v153
v_mfma_f32_16x16x32_bf16 a[112:115], a[240:243], v[220:223], a[112:115]
v_exp_f32 v154, v154
v_mfma_f32_16x16x32_bf16 a[116:119], a[244:247], v[220:223], a[116:119]
ds_read_b128 a[152:155], v2 offset:22528
v_cvt_pk_bf16_f32 v202, v152, v153
v_mfma_f32_16x16x32_bf16 a[116:119], a[212:215], v[204:207], a[116:119]
buffer_load_dwordx4 v1, s[44:47], s72 offen offset:1024 sc1 lds
v_mfma_f32_16x16x32_bf16 a[120:123], a[216:219], v[204:207], a[120:123]
v_exp_f32 v155, v155
v_mfma_f32_16x16x32_bf16 a[120:123], a[248:251], v[220:223], a[120:123]
ds_read_b128 a[156:159], v2 offset:23552
v_cvt_pk_bf16_f32 v203, v154, v155
v_mfma_f32_16x16x32_bf16 a[124:127], a[252:255], v[220:223], a[124:127]
v_exp_f32 v140, v140
v_mfma_f32_16x16x32_bf16 a[124:127], a[220:223], v[204:207], a[124:127]
s_nop 0
ds_read_b128 a[192:195], v2 offset:0
ds_read_b128 a[196:199], v2 offset:1024
v_mfma_f32_16x16x32_bf16 v[172:175], a[160:163], v[64:67], v[92:95]
v_exp_f32 v141, v141
v_mfma_f32_16x16x32_bf16 v[172:175], a[164:167], v[68:71], v[172:175]
v_exp_f32 v142, v142
v_mfma_f32_16x16x32_bf16 v[172:175], a[168:171], v[72:75], v[172:175]
ds_read_b128 a[200:203], v2 offset:2048
v_cvt_pk_bf16_f32 v204, v140, v141
v_mfma_f32_16x16x32_bf16 v[172:175], a[172:175], v[76:79], v[172:175]
buffer_load_dwordx4 v1, s[44:47], s72 offen offset:2048 sc1 lds
v_mfma_f32_16x16x32_bf16 v[188:191], a[188:191], v[76:79], v[92:95]
v_exp_f32 v143, v143
v_mfma_f32_16x16x32_bf16 v[188:191], a[184:187], v[72:75], v[188:191]
ds_read_b128 a[204:207], v2 offset:3072
v_cvt_pk_bf16_f32 v205, v142, v143
v_mfma_f32_16x16x32_bf16 v[188:191], a[180:183], v[68:71], v[188:191]
v_exp_f32 v156, v156
v_mfma_f32_16x16x32_bf16 v[188:191], a[176:179], v[64:67], v[188:191]
ds_read_b128 a[208:211], v2 offset:4096
v_mfma_f32_16x16x32_bf16 v[168:171], a[160:163], v[48:51], v[88:91]
v_exp_f32 v157, v157
v_mfma_f32_16x16x32_bf16 v[168:171], a[164:167], v[52:55], v[168:171]
ds_read_b128 a[212:215], v2 offset:5120
v_cvt_pk_bf16_f32 v206, v156, v157
v_mfma_f32_16x16x32_bf16 v[168:171], a[168:171], v[56:59], v[168:171]
v_exp_f32 v158, v158
v_mfma_f32_16x16x32_bf16 v[168:171], a[172:175], v[60:63], v[168:171]
ds_read_b128 a[216:219], v2 offset:6144
v_mfma_f32_16x16x32_bf16 v[184:187], a[188:191], v[60:63], v[88:91]
buffer_load_dwordx4 v1, s[44:47], s72 offen offset:3072 sc1 lds
v_mfma_f32_16x16x32_bf16 v[184:187], a[184:187], v[56:59], v[184:187]
v_exp_f32 v159, v159
v_mfma_f32_16x16x32_bf16 v[184:187], a[180:183], v[52:55], v[184:187]
ds_read_b128 a[220:223], v2 offset:7168
v_cvt_pk_bf16_f32 v207, v158, v159
v_mfma_f32_16x16x32_bf16 v[184:187], a[176:179], v[48:51], v[184:187]
s_waitcnt lgkmcnt(4)
v_mfma_f32_16x16x32_bf16 v[232:235], v[120:123], v[216:219], v[232:235]
s_add_u32 s82, s82, 0x8000
ds_read_b128 a[160:163], v2 offset:24576
ds_read_b128 a[164:167], v2 offset:25600
v_mfma_f32_16x16x32_bf16 v[232:235], v[120:123], v[200:203], v[232:235]
s_and_b32 s82, s82, 0x1ffff
v_exp_f32 v172, v172
v_mfma_f32_16x16x32_bf16 a[64:67], a[224:227], v[216:219], a[64:67]
s_add_u32 m0, s74, 0
v_exp_f32 v173, v173
v_mfma_f32_16x16x32_bf16 a[64:67], a[192:195], v[200:203], a[64:67]
s_add_u32 s72, s81, 0
ds_read_b128 a[168:171], v2 offset:26624
v_cvt_pk_bf16_f32 v220, v172, v173
v_mfma_f32_16x16x32_bf16 a[68:71], a[196:199], v[200:203], a[68:71]
v_exp_f32 v174, v174
v_mfma_f32_16x16x32_bf16 a[68:71], a[228:231], v[216:219], a[68:71]
buffer_load_dwordx4 v1, s[44:47], s72 offen sc1 lds
v_mfma_f32_16x16x32_bf16 a[72:75], a[232:235], v[216:219], a[72:75]
s_nop 0
ds_read_b128 a[172:175], v2 offset:27648
ds_read_b128 a[176:179], v2 offset:28672
v_mfma_f32_16x16x32_bf16 a[72:75], a[200:203], v[200:203], a[72:75]
v_exp_f32 v175, v175
v_mfma_f32_16x16x32_bf16 a[76:79], a[204:207], v[200:203], a[76:79]
v_exp_f32 v188, v188
v_mfma_f32_16x16x32_bf16 a[76:79], a[236:239], v[216:219], a[76:79]
ds_read_b128 a[180:183], v2 offset:29696
v_cvt_pk_bf16_f32 v221, v174, v175
v_mfma_f32_16x16x32_bf16 a[80:83], a[240:243], v[216:219], a[80:83]
s_waitcnt lgkmcnt(6)
v_exp_f32 v189, v189
v_mfma_f32_16x16x32_bf16 a[80:83], a[208:211], v[200:203], a[80:83]
ds_read_b128 a[184:187], v2 offset:30720
v_cvt_pk_bf16_f32 v222, v188, v189
v_mfma_f32_16x16x32_bf16 a[84:87], a[212:215], v[200:203], a[84:87]
buffer_load_dwordx4 v1, s[44:47], s72 offen offset:1024 sc1 lds
v_mfma_f32_16x16x32_bf16 a[84:87], a[244:247], v[216:219], a[84:87]
v_exp_f32 v190, v190
v_mfma_f32_16x16x32_bf16 a[88:91], a[248:251], v[216:219], a[88:91]
s_nop 0
ds_read_b128 a[188:191], v2 offset:31744
ds_read_b128 a[224:227], v2 offset:8192
v_mfma_f32_16x16x32_bf16 a[88:91], a[216:219], v[200:203], a[88:91]
v_exp_f32 v191, v191
v_mfma_f32_16x16x32_bf16 a[92:95], a[220:223], v[200:203], a[92:95]
v_exp_f32 v168, v168
v_mfma_f32_16x16x32_bf16 a[92:95], a[252:255], v[216:219], a[92:95]
ds_read_b128 a[228:231], v2 offset:9216
v_cvt_pk_bf16_f32 v223, v190, v191
v_mfma_f32_16x16x32_bf16 v[136:139], a[128:131], v[48:51], v[88:91]
v_exp_f32 v169, v169
v_mfma_f32_16x16x32_bf16 v[136:139], a[132:135], v[52:55], v[136:139]
ds_read_b128 a[232:235], v2 offset:10240
v_cvt_pk_bf16_f32 v216, v168, v169
v_mfma_f32_16x16x32_bf16 v[136:139], a[136:139], v[56:59], v[136:139]
buffer_load_dwordx4 v1, s[44:47], s72 offen offset:2048 sc1 lds
v_mfma_f32_16x16x32_bf16 v[136:139], a[140:143], v[60:63], v[136:139]
v_exp_f32 v170, v170
v_mfma_f32_16x16x32_bf16 v[152:155], a[156:159], v[60:63], v[88:91]
s_nop 0
ds_read_b128 a[236:239], v2 offset:11264
ds_read_b128 a[240:243], v2 offset:12288
v_mfma_f32_16x16x32_bf16 v[152:155], a[152:155], v[56:59], v[152:155]
v_exp_f32 v171, v171
v_mfma_f32_16x16x32_bf16 v[152:155], a[148:151], v[52:55], v[152:155]
v_exp_f32 v184, v184
v_mfma_f32_16x16x32_bf16 v[152:155], a[144:147], v[48:51], v[152:155]
ds_read_b128 a[244:247], v2 offset:13312
v_cvt_pk_bf16_f32 v217, v170, v171
v_mfma_f32_16x16x32_bf16 v[140:143], a[128:131], v[64:67], v[92:95]
v_exp_f32 v185, v185
v_mfma_f32_16x16x32_bf16 v[140:143], a[132:135], v[68:71], v[140:143]
ds_read_b128 a[248:251], v2 offset:14336
v_cvt_pk_bf16_f32 v218, v184, v185
v_mfma_f32_16x16x32_bf16 v[140:143], a[136:139], v[72:75], v[140:143]
buffer_load_dwordx4 v1, s[44:47], s72 offen offset:3072 sc1 lds
v_mfma_f32_16x16x32_bf16 v[140:143], a[140:143], v[76:79], v[140:143]
ds_read_b128 a[252:255], v2 offset:15360
v_add_u32 v2, s82, v1
v_mfma_f32_16x16x32_bf16 v[156:159], a[156:159], v[76:79], v[92:95]
s_waitcnt vmcnt(8) lgkmcnt(4)
v_exp_f32 v186, v186
v_mfma_f32_16x16x32_bf16 v[156:159], a[152:155], v[72:75], v[156:159]
s_barrier
v_exp_f32 v187, v187
v_mfma_f32_16x16x32_bf16 v[156:159], a[148:151], v[68:71], v[156:159]
s_add_u32 s83, s83, 1
v_cvt_pk_bf16_f32 v219, v186, v187
v_mfma_f32_16x16x32_bf16 v[156:159], a[144:147], v[64:67], v[156:159]
s_cbranch_scc0 LloopII
v_mfma_f32_16x16x32_bf16 v[236:239], v[120:123], v[204:207], v[236:239]
s_xor_b32 s74, s82, 0x10000
ds_read_b128 a[128:131], v2 offset:16384
ds_read_b128 a[132:135], v2 offset:17408
v_mfma_f32_16x16x32_bf16 v[236:239], v[120:123], v[220:223], v[236:239]
s_add_u32 s74, s74, s64
v_exp_f32 v136, v136
v_mfma_f32_16x16x32_bf16 a[96:99], a[192:195], v[204:207], a[96:99]
s_add_u32 s81, s81, 0x8000
v_exp_f32 v137, v137
v_mfma_f32_16x16x32_bf16 a[96:99], a[224:227], v[220:223], a[96:99]
s_add_u32 m0, s74, 0
ds_read_b128 a[136:139], v2 offset:18432
v_cvt_pk_bf16_f32 v200, v136, v137
v_mfma_f32_16x16x32_bf16 a[100:103], a[228:231], v[220:223], a[100:103]
s_add_u32 s72, s81, 0
v_exp_f32 v138, v138
v_mfma_f32_16x16x32_bf16 a[100:103], a[196:199], v[204:207], a[100:103]
buffer_load_dwordx4 v1, s[44:47], s72 offen sc1 lds
v_mfma_f32_16x16x32_bf16 a[104:107], a[200:203], v[204:207], a[104:107]
s_nop 0
ds_read_b128 a[140:143], v2 offset:19456
ds_read_b128 a[144:147], v2 offset:20480
v_mfma_f32_16x16x32_bf16 a[104:107], a[232:235], v[220:223], a[104:107]
v_exp_f32 v139, v139
v_mfma_f32_16x16x32_bf16 a[108:111], a[236:239], v[220:223], a[108:111]
v_exp_f32 v152, v152
v_mfma_f32_16x16x32_bf16 a[108:111], a[204:207], v[204:207], a[108:111]
ds_read_b128 a[148:151], v2 offset:21504
v_cvt_pk_bf16_f32 v201, v138, v139
v_mfma_f32_16x16x32_bf16 a[112:115], a[208:211], v[204:207], a[112:115]
s_waitcnt lgkmcnt(6)
v_exp_f32 v153, v153
v_mfma_f32_16x16x32_bf16 a[112:115], a[240:243], v[220:223], a[112:115]
ds_read_b128 a[152:155], v2 offset:22528
v_cvt_pk_bf16_f32 v202, v152, v153
v_mfma_f32_16x16x32_bf16 a[116:119], a[244:247], v[220:223], a[116:119]
v_exp_f32 v154, v154
v_mfma_f32_16x16x32_bf16 a[116:119], a[212:215], v[204:207], a[116:119]
buffer_load_dwordx4 v1, s[44:47], s72 offen offset:1024 sc1 lds
v_mfma_f32_16x16x32_bf16 a[120:123], a[216:219], v[204:207], a[120:123]
s_nop 0
ds_read_b128 a[156:159], v2 offset:23552
ds_read_b128 a[192:195], v2 offset:0
v_mfma_f32_16x16x32_bf16 a[120:123], a[248:251], v[220:223], a[120:123]
v_exp_f32 v155, v155
v_mfma_f32_16x16x32_bf16 a[124:127], a[252:255], v[220:223], a[124:127]
v_exp_f32 v140, v140
v_mfma_f32_16x16x32_bf16 a[124:127], a[220:223], v[204:207], a[124:127]
ds_read_b128 a[196:199], v2 offset:1024
v_cvt_pk_bf16_f32 v203, v154, v155
v_mfma_f32_16x16x32_bf16 v[172:175], a[160:163], v[64:67], v[92:95]
v_exp_f32 v141, v141
v_mfma_f32_16x16x32_bf16 v[172:175], a[164:167], v[68:71], v[172:175]
ds_read_b128 a[200:203], v2 offset:2048
v_cvt_pk_bf16_f32 v204, v140, v141
v_mfma_f32_16x16x32_bf16 v[172:175], a[168:171], v[72:75], v[172:175]
v_exp_f32 v142, v142
v_mfma_f32_16x16x32_bf16 v[172:175], a[172:175], v[76:79], v[172:175]
buffer_load_dwordx4 v1, s[44:47], s72 offen offset:2048 sc1 lds
v_mfma_f32_16x16x32_bf16 v[188:191], a[188:191], v[76:79], v[92:95]
ds_read_b128 a[204:207], v2 offset:3072
v_mfma_f32_16x16x32_bf16 v[188:191], a[184:187], v[72:75], v[188:191]
v_exp_f32 v143, v143
v_mfma_f32_16x16x32_bf16 v[188:191], a[180:183], v[68:71], v[188:191]
ds_read_b128 a[208:211], v2 offset:4096
v_cvt_pk_bf16_f32 v205, v142, v143
v_mfma_f32_16x16x32_bf16 v[188:191], a[176:179], v[64:67], v[188:191]
v_exp_f32 v156, v156
v_mfma_f32_16x16x32_bf16 v[168:171], a[160:163], v[48:51], v[88:91]
ds_read_b128 a[212:215], v2 offset:5120
v_mfma_f32_16x16x32_bf16 v[168:171], a[164:167], v[52:55], v[168:171]
v_exp_f32 v157, v157
v_mfma_f32_16x16x32_bf16 v[168:171], a[168:171], v[56:59], v[168:171]
ds_read_b128 a[216:219], v2 offset:6144
v_cvt_pk_bf16_f32 v206, v156, v157
v_mfma_f32_16x16x32_bf16 v[168:171], a[172:175], v[60:63], v[168:171]
buffer_load_dwordx4 v1, s[44:47], s72 offen offset:3072 sc1 lds
v_mfma_f32_16x16x32_bf16 v[184:187], a[188:191], v[60:63], v[88:91]
v_exp_f32 v158, v158
v_mfma_f32_16x16x32_bf16 v[184:187], a[184:187], v[56:59], v[184:187]
ds_read_b128 a[220:223], v2 offset:7168
v_mfma_f32_16x16x32_bf16 v[184:187], a[180:183], v[52:55], v[184:187]
s_waitcnt lgkmcnt(4)
v_exp_f32 v159, v159
v_mfma_f32_16x16x32_bf16 v[184:187], a[176:179], v[48:51], v[184:187]
s_barrier
v_cvt_pk_bf16_f32 v207, v158, v159
s_lshr_b32 s69, s93, 4
s_and_b32 s69, s69, 0x7f00
s_add_u32 s69, s69, LHT4-Lpc0
v_lshrrev_b32 v3, 5, v0
v_lshlrev_b32 v3, 7, v3
v_add_u32 v3, s69, v3
v_min_u32 v3, Lcode_end-Lpc0, v3
global_load_dword v4, v3, s[98:99]
v_mfma_f32_16x16x32_bf16 v[232:235], v[120:123], v[216:219], v[232:235]
s_add_u32 s82, s82, 0x8000
ds_read_b128 a[160:163], v2 offset:24576
ds_read_b128 a[164:167], v2 offset:25600
v_mfma_f32_16x16x32_bf16 v[232:235], v[120:123], v[200:203], v[232:235]
s_and_b32 s82, s82, 0x1ffff
v_exp_f32 v172, v172
v_mfma_f32_16x16x32_bf16 a[64:67], a[224:227], v[216:219], a[64:67]
s_add_u32 s66, s58, 3
v_exp_f32 v173, v173
v_mfma_f32_16x16x32_bf16 a[64:67], a[192:195], v[200:203], a[64:67]
s_and_b32 s66, s66, 3
ds_read_b128 a[168:171], v2 offset:26624
v_cvt_pk_bf16_f32 v220, v172, v173
v_mfma_f32_16x16x32_bf16 a[68:71], a[196:199], v[200:203], a[68:71]
s_mul_i32 s66, s66, 4160
v_exp_f32 v174, v174
v_mfma_f32_16x16x32_bf16 a[68:71], a[228:231], v[216:219], a[68:71]
s_add_u32 s66, s66, s92
ds_read_b128 a[172:175], v2 offset:27648
ds_read_b128 a[176:179], v2 offset:28672
v_mfma_f32_16x16x32_bf16 a[72:75], a[232:235], v[216:219], a[72:75]
s_add_u32 m0, s66, 32
v_exp_f32 v175, v175
v_mfma_f32_16x16x32_bf16 a[72:75], a[200:203], v[200:203], a[72:75]
s_add_u32 s72, s93, 0x6
buffer_load_dwordx4 v1, s[36:39], s72 offen lds
v_mfma_f32_16x16x32_bf16 a[76:79], a[204:207], v[200:203], a[76:79]
v_exp_f32 v188, v188
v_mfma_f32_16x16x32_bf16 a[76:79], a[236:239], v[216:219], a[76:79]
ds_read_b128 a[180:183], v2 offset:29696
v_cvt_pk_bf16_f32 v221, v174, v175
v_mfma_f32_16x16x32_bf16 a[80:83], a[240:243], v[216:219], a[80:83]
s_waitcnt lgkmcnt(6)
v_exp_f32 v189, v189
v_mfma_f32_16x16x32_bf16 a[80:83], a[208:211], v[200:203], a[80:83]
ds_read_b128 a[184:187], v2 offset:30720
v_cvt_pk_bf16_f32 v222, v188, v189
v_mfma_f32_16x16x32_bf16 a[84:87], a[212:215], v[200:203], a[84:87]
v_exp_f32 v190, v190
v_mfma_f32_16x16x32_bf16 a[84:87], a[244:247], v[216:219], a[84:87]
buffer_load_dwordx4 v1, s[36:39], s72 offen offset:1024 lds
v_mfma_f32_16x16x32_bf16 a[88:91], a[248:251], v[216:219], a[88:91]
s_nop 0
ds_read_b128 a[188:191], v2 offset:31744
ds_read_b128 a[224:227], v2 offset:8192
v_mfma_f32_16x16x32_bf16 a[88:91], a[216:219], v[200:203], a[88:91]
v_exp_f32 v191, v191
v_mfma_f32_16x16x32_bf16 a[92:95], a[220:223], v[200:203], a[92:95]
v_exp_f32 v168, v168
v_mfma_f32_16x16x32_bf16 a[92:95], a[252:255], v[216:219], a[92:95]
ds_read_b128 a[228:231], v2 offset:9216
v_cvt_pk_bf16_f32 v223, v190, v191
s_cmp_eq_u32 s58, 0
s_cbranch_scc1 Lta28
s_cmp_eq_u32 s58, 1
s_cbranch_scc1 Lnt29
v_mfma_f32_16x16x32_bf16 v[136:139], a[128:131], v[48:51], v[88:91]
v_exp_f32 v169, v169
v_mfma_f32_16x16x32_bf16 v[152:155], a[144:147], v[48:51], v[88:91]
ds_read_b128 a[232:235], v2 offset:10240
v_cvt_pk_bf16_f32 v216, v168, v169
s_branch Ljoin30
Lta28:
v_mfma_f32_16x16x32_bf16 v[136:139], a[128:131], v[48:51], v[104:107]
v_exp_f32 v169, v169
v_mfma_f32_16x16x32_bf16 v[152:155], a[144:147], v[48:51], v[112:115]
ds_read_b128 a[232:235], v2 offset:10240
v_cvt_pk_bf16_f32 v216, v168, v169
s_branch Ljoin30
Lnt29:
v_mfma_f32_16x16x32_bf16 v[136:139], a[128:131], v[48:51], v[88:91]
v_exp_f32 v169, v169
v_mfma_f32_16x16x32_bf16 v[152:155], a[144:147], v[48:51], v[104:107]
ds_read_b128 a[232:235], v2 offset:10240
v_cvt_pk_bf16_f32 v216, v168, v169
Ljoin30:
v_mfma_f32_16x16x32_bf16 v[136:139], a[132:135], v[52:55], v[136:139]
v_exp_f32 v170, v170
v_mfma_f32_16x16x32_bf16 v[136:139], a[136:139], v[56:59], v[136:139]
buffer_load_dwordx4 v1, s[36:39], s72 offen offset:2048 lds
v_mfma_f32_16x16x32_bf16 v[136:139], a[140:143], v[60:63], v[136:139]
ds_read_b128 a[236:239], v2 offset:11264
v_mfma_f32_16x16x32_bf16 v[152:155], a[156:159], v[60:63], v[152:155]
v_exp_f32 v171, v171
v_mfma_f32_16x16x32_bf16 v[152:155], a[152:155], v[56:59], v[152:155]
ds_read_b128 a[240:243], v2 offset:12288
v_cvt_pk_bf16_f32 v217, v170, v171
v_mfma_f32_16x16x32_bf16 v[152:155], a[148:151], v[52:55], v[152:155]
v_exp_f32 v184, v184
v_mfma_f32_16x16x32_bf16 v[140:143], a[128:131], v[64:67], v[92:95]
ds_read_b128 a[244:247], v2 offset:13312
v_mfma_f32_16x16x32_bf16 v[140:143], a[132:135], v[68:71], v[140:143]
v_exp_f32 v185, v185
v_mfma_f32_16x16x32_bf16 v[140:143], a[136:139], v[72:75], v[140:143]
ds_read_b128 a[248:251], v2 offset:14336
v_cvt_pk_bf16_f32 v218, v184, v185
v_mfma_f32_16x16x32_bf16 v[140:143], a[140:143], v[76:79], v[140:143]
buffer_load_dwordx4 v1, s[36:39], s72 offen offset:3072 lds
v_mfma_f32_16x16x32_bf16 v[156:159], a[156:159], v[76:79], v[92:95]
v_exp_f32 v186, v186
v_mfma_f32_16x16x32_bf16 v[156:159], a[152:155], v[72:75], v[156:159]
ds_read_b128 a[252:255], v2 offset:15360
v_add_u32 v2, s82, v1
v_mfma_f32_16x16x32_bf16 v[156:159], a[148:151], v[68:71], v[156:159]
s_waitcnt vmcnt(9) lgkmcnt(0)
v_exp_f32 v187, v187
v_mfma_f32_16x16x32_bf16 v[156:159], a[144:147], v[64:67], v[156:159]
s_barrier
v_cvt_pk_bf16_f32 v219, v186, v187
v_mfma_f32_16x16x32_bf16 v[236:239], v[120:123], v[204:207], v[236:239]
s_mov_b32 m0, s62
v_exp_f32 v136, v136
v_mfma_f32_16x16x32_bf16 v[236:239], v[120:123], v[220:223], v[236:239]
s_add_u32 s72, s93, 0x3000000
ds_read_b128 a[128:131], v2 offset:16384
ds_read_b128 a[132:135], v2 offset:17408
v_mfma_f32_16x16x32_bf16 a[96:99], a[192:195], v[204:207], a[96:99]
s_add_u32 s78, s59, 8
v_exp_f32 v137, v137
v_mfma_f32_16x16x32_bf16 a[96:99], a[224:227], v[220:223], a[96:99]
s_and_b32 s78, s78, 24
buffer_load_dwordx4 v1, s[44:47], s72 offen sc1 lds
v_mfma_f32_16x16x32_bf16 a[100:103], a[228:231], v[220:223], a[100:103]
s_lshr_b32 s79, 0x67234501, s78
v_exp_f32 v138, v138
v_mfma_f32_16x16x32_bf16 a[100:103], a[196:199], v[204:207], a[100:103]
s_and_b32 s79, s79, 7
ds_read_b128 a[136:139], v2 offset:18432
v_cvt_pk_bf16_f32 v200, v136, v137
v_mfma_f32_16x16x32_bf16 a[104:107], a[200:203], v[204:207], a[104:107]
s_lshl_b32 s79, s79, 18
v_exp_f32 v139, v139
v_mfma_f32_16x16x32_bf16 a[104:107], a[232:235], v[220:223], a[104:107]
s_add_u32 s79, s79, s94
ds_read_b128 a[140:143], v2 offset:19456
v_cvt_pk_bf16_f32 v201, v138, v139
v_mfma_f32_16x16x32_bf16 a[108:111], a[236:239], v[220:223], a[108:111]
s_add_u32 s12, s61, 0
v_exp_f32 v152, v152
v_mfma_f32_16x16x32_bf16 a[108:111], a[204:207], v[204:207], a[108:111]
s_and_b32 s12, s12, 3
ds_read_b128 a[144:147], v2 offset:20480
ds_read_b128 a[148:151], v2 offset:21504
v_mfma_f32_16x16x32_bf16 a[112:115], a[208:211], v[204:207], a[112:115]
s_waitcnt lgkmcnt(6)
buffer_load_dwordx4 v1, s[44:47], s72 offen offset:1024 sc1 lds
v_mfma_f32_16x16x32_bf16 a[112:115], a[240:243], v[220:223], a[112:115]
s_lshl_b32 s12, s12, 21
v_exp_f32 v153, v153
v_mfma_f32_16x16x32_bf16 a[116:119], a[244:247], v[220:223], a[116:119]
s_add_u32 s12, s12, s79
v_exp_f32 v154, v154
v_mfma_f32_16x16x32_bf16 a[116:119], a[212:215], v[204:207], a[116:119]
s_add_u32 s13, s61, 1
ds_read_b128 a[152:155], v2 offset:22528
v_cvt_pk_bf16_f32 v202, v152, v153
v_mfma_f32_16x16x32_bf16 a[120:123], a[216:219], v[204:207], a[120:123]
s_and_b32 s13, s13, 3
buffer_load_dwordx4 v1, s[44:47], s72 offen offset:2048 sc1 lds
v_mfma_f32_16x16x32_bf16 a[120:123], a[248:251], v[220:223], a[120:123]
s_lshl_b32 s13, s13, 21
v_exp_f32 v155, v155
v_mfma_f32_16x16x32_bf16 a[124:127], a[252:255], v[220:223], a[124:127]
s_add_u32 s13, s13, s79
ds_read_b128 a[156:159], v2 offset:23552
v_cvt_pk_bf16_f32 v203, v154, v155
v_mfma_f32_16x16x32_bf16 a[124:127], a[220:223], v[204:207], a[124:127]
s_add_u32 s14, s61, 2
v_exp_f32 v140, v140
s_cmp_eq_u32 s58, 2
s_cbranch_scc1 Lta31
s_cmp_eq_u32 s58, 3
s_cbranch_scc1 Lnt32
v_mfma_f32_16x16x32_bf16 v[168:171], a[160:163], v[48:51], v[112:115]
s_and_b32 s14, s14, 3
ds_read_b128 a[192:195], v2 offset:0
ds_read_b128 a[196:199], v2 offset:1024
v_mfma_f32_16x16x32_bf16 v[184:187], a[176:179], v[48:51], v[112:115]
s_lshl_b32 s14, s14, 21
v_exp_f32 v141, v141
s_branch Ljoin33
Lta31:
v_mfma_f32_16x16x32_bf16 v[168:171], a[160:163], v[48:51], v[104:107]
s_and_b32 s14, s14, 3
ds_read_b128 a[192:195], v2 offset:0
ds_read_b128 a[196:199], v2 offset:1024
v_mfma_f32_16x16x32_bf16 v[184:187], a[176:179], v[48:51], v[112:115]
s_lshl_b32 s14, s14, 21
v_exp_f32 v141, v141
s_branch Ljoin33
Lnt32:
v_mfma_f32_16x16x32_bf16 v[168:171], a[160:163], v[48:51], v[88:91]
s_and_b32 s14, s14, 3
ds_read_b128 a[192:195], v2 offset:0
ds_read_b128 a[196:199], v2 offset:1024
v_mfma_f32_16x16x32_bf16 v[184:187], a[176:179], v[48:51], v[104:107]
s_lshl_b32 s14, s14, 21
v_exp_f32 v141, v141
Ljoin33:
v_mfma_f32_16x16x32_bf16 v[172:175], a[160:163], v[64:67], v[92:95]
s_add_u32 s14, s14, s79
buffer_load_dwordx4 v1, s[44:47], s72 offen offset:3072 sc1 lds
v_mfma_f32_16x16x32_bf16 v[172:175], a[164:167], v[68:71], v[172:175]
s_add_u32 s66, s58, 0
v_exp_f32 v142, v142
v_mfma_f32_16x16x32_bf16 v[172:175], a[168:171], v[72:75], v[172:175]
s_and_b32 s66, s66, 3
ds_read_b128 a[200:203], v2 offset:2048
v_cvt_pk_bf16_f32 v204, v140, v141
v_mfma_f32_16x16x32_bf16 v[172:175], a[172:175], v[76:79], v[172:175]
s_mul_i32 s66, s66, 4160
v_exp_f32 v143, v143
v_mfma_f32_16x16x32_bf16 v[188:191], a[188:191], v[76:79], v[92:95]
s_add_u32 s66, s66, s92
ds_read_b128 a[204:207], v2 offset:3072
v_cvt_pk_bf16_f32 v205, v142, v143
v_mfma_f32_16x16x32_bf16 v[188:191], a[184:187], v[72:75], v[188:191]
s_add_u32 m0, s66, 16672
v_exp_f32 v156, v156
v_mfma_f32_16x16x32_bf16 v[188:191], a[180:183], v[68:71], v[188:191]
s_add_u32 s72, s93, 0x0
ds_read_b128 a[208:211], v2 offset:4096
ds_read_b128 a[212:215], v2 offset:5120
v_mfma_f32_16x16x32_bf16 v[188:191], a[176:179], v[64:67], v[188:191]
s_add_u32 s15, s61, 3
buffer_load_dwordx4 v1, s[36:39], s72 offen lds
v_mfma_f32_16x16x32_bf16 v[168:171], a[164:167], v[52:55], v[168:171]
s_and_b32 s15, s15, 3
v_exp_f32 v157, v157
v_mfma_f32_16x16x32_bf16 v[168:171], a[168:171], v[56:59], v[168:171]
s_lshl_b32 s15, s15, 21
v_exp_f32 v158, v158
v_mfma_f32_16x16x32_bf16 v[168:171], a[172:175], v[60:63], v[168:171]
s_add_u32 s15, s15, s79
ds_read_b128 a[216:219], v2 offset:6144
ds_read_b128 a[220:223], v2 offset:7168
v_mfma_f32_16x16x32_bf16 v[184:187], a[188:191], v[60:63], v[184:187]
buffer_load_dwordx4 v1, s[36:39], s72 offen offset:1024 lds
v_mfma_f32_16x16x32_bf16 v[184:187], a[184:187], v[56:59], v[184:187]
v_exp_f32 v159, v159
v_mfma_f32_16x16x32_bf16 v[184:187], a[180:183], v[52:55], v[184:187]
s_waitcnt lgkmcnt(4)
v_cvt_pk_bf16_f32 v206, v156, v157
v_cvt_pk_bf16_f32 v207, v158, v159
v_mfma_f32_16x16x32_bf16 v[232:235], v[120:123], v[216:219], v[232:235]
s_add_u32 s82, s82, 0x8000
ds_read_b128 a[160:163], v2 offset:24576
ds_read_b128 a[164:167], v2 offset:25600
v_mfma_f32_16x16x32_bf16 v[232:235], v[120:123], v[200:203], v[232:235]
s_and_b32 s82, s82, 0x1ffff
v_exp_f32 v172, v172
v_mfma_f32_16x16x32_bf16 a[64:67], a[224:227], v[216:219], a[64:67]
v_exp_f32 v173, v173
v_mfma_f32_16x16x32_bf16 a[64:67], a[192:195], v[200:203], a[64:67]
s_nop 0
ds_read_b128 a[168:171], v2 offset:26624
ds_read_b128 a[172:175], v2 offset:27648
v_mfma_f32_16x16x32_bf16 a[68:71], a[196:199], v[200:203], a[68:71]
v_exp_f32 v174, v174
v_mfma_f32_16x16x32_bf16 a[68:71], a[228:231], v[216:219], a[68:71]
v_exp_f32 v175, v175
v_mfma_f32_16x16x32_bf16 a[72:75], a[232:235], v[216:219], a[72:75]
s_nop 0
ds_read_b128 a[176:179], v2 offset:28672
ds_read_b128 a[180:183], v2 offset:29696
v_mfma_f32_16x16x32_bf16 a[72:75], a[200:203], v[200:203], a[72:75]
v_exp_f32 v188, v188
v_mfma_f32_16x16x32_bf16 a[76:79], a[204:207], v[200:203], a[76:79]
s_nop 0
ds_read_b128 a[184:187], v2 offset:30720
ds_read_b128 a[188:191], v2 offset:31744
v_mfma_f32_16x16x32_bf16 a[76:79], a[236:239], v[216:219], a[76:79]
s_nop 0
ds_read_b128 a[224:227], v2 offset:8192
ds_read_b128 a[228:231], v2 offset:9216
v_mfma_f32_16x16x32_bf16 a[80:83], a[240:243], v[216:219], a[80:83]
s_waitcnt lgkmcnt(10)
ds_read_b128 a[232:235], v2 offset:10240
ds_read_b128 a[236:239], v2 offset:11264
v_mfma_f32_16x16x32_bf16 a[80:83], a[208:211], v[200:203], a[80:83]
ds_read_b128 a[240:243], v2 offset:12288
v_cvt_pk_bf16_f32 v220, v172, v173
v_mfma_f32_16x16x32_bf16 a[84:87], a[212:215], v[200:203], a[84:87]
buffer_load_dwordx4 v1, s[36:39], s72 offen offset:2048 lds
v_mfma_f32_16x16x32_bf16 a[84:87], a[244:247], v[216:219], a[84:87]
v_exp_f32 v189, v189
v_mfma_f32_16x16x32_bf16 a[88:91], a[248:251], v[216:219], a[88:91]
v_exp_f32 v190, v190
v_mfma_f32_16x16x32_bf16 a[88:91], a[216:219], v[200:203], a[88:91]
s_nop 0
ds_read_b128 a[244:247], v2 offset:13312
ds_read_b128 a[248:251], v2 offset:14336
v_mfma_f32_16x16x32_bf16 a[92:95], a[220:223], v[200:203], a[92:95]
v_cvt_pk_bf16_f32 v221, v174, v175
v_cvt_pk_bf16_f32 v222, v188, v189
v_mfma_f32_16x16x32_bf16 a[92:95], a[252:255], v[216:219], a[92:95]
Lstub7:
s_cbranch_execz Lstub11
v_exp_f32 v191, v191
s_cmp_eq_u32 s58, 0
s_cbranch_scc1 Lta34
s_cmp_eq_u32 s58, 1
s_cbranch_scc1 Lnt35
v_mfma_f32_16x16x32_bf16 v[140:143], a[128:131], v[64:67], v[92:95]
v_exp_f32 v168, v168
v_mfma_f32_16x16x32_bf16 v[156:159], a[144:147], v[64:67], v[92:95]
v_exp_f32 v169, v169
s_branch Ljoin36
Lta34:
v_mfma_f32_16x16x32_bf16 v[140:143], a[128:131], v[64:67], v[108:111]
v_exp_f32 v168, v168
v_mfma_f32_16x16x32_bf16 v[156:159], a[144:147], v[64:67], v[112:115]
v_exp_f32 v169, v169
s_branch Ljoin36
Lnt35:
v_mfma_f32_16x16x32_bf16 v[140:143], a[128:131], v[64:67], v[92:95]
v_exp_f32 v168, v168
v_mfma_f32_16x16x32_bf16 v[156:159], a[144:147], v[64:67], v[108:111]
v_exp_f32 v169, v169
Ljoin36:
v_mfma_f32_16x16x32_bf16 v[140:143], a[132:135], v[68:71], v[140:143]
v_exp_f32 v170, v170
v_mfma_f32_16x16x32_bf16 v[140:143], a[136:139], v[72:75], v[140:143]
ds_read_b128 a[252:255], v2 offset:15360
v_cvt_pk_bf16_f32 v223, v190, v191
v_mfma_f32_16x16x32_bf16 v[140:143], a[140:143], v[76:79], v[140:143]
v_exp_f32 v171, v171
v_mfma_f32_16x16x32_bf16 v[156:159], a[156:159], v[76:79], v[156:159]
buffer_load_dwordx4 v1, s[36:39], s72 offen offset:3072 lds
v_mfma_f32_16x16x32_bf16 v[156:159], a[152:155], v[72:75], v[156:159]
s_waitcnt vmcnt(13) lgkmcnt(4)
v_exp_f32 v184, v184
v_mfma_f32_16x16x32_bf16 v[156:159], a[148:151], v[68:71], v[156:159]
s_barrier
v_cvt_pk_bf16_f32 v216, v168, v169
v_cvt_pk_bf16_f32 v217, v170, v171
v_add_u32 v2, s82, v1
v_exp_f32 v185, v185
v_exp_f32 v186, v186
v_cvt_pk_bf16_f32 v218, v184, v185
v_exp_f32 v187, v187
s_nop 0
v_cvt_pk_bf16_f32 v219, v186, v187
v_mfma_f32_16x16x32_bf16 v[236:239], v[120:123], v[204:207], v[236:239]
s_add_u32 s66, s58, 2
v_exp_f32 v140, v140
v_mfma_f32_16x16x32_bf16 v[236:239], v[120:123], v[220:223], v[236:239]
s_and_b32 s66, s66, 3
v_exp_f32 v141, v141
v_mfma_f32_16x16x32_bf16 a[96:99], a[192:195], v[204:207], a[96:99]
s_mul_i32 s66, s66, 4160
ds_read_b128 a[192:195], v2 offset:0
v_mfma_f32_16x16x32_bf16 a[96:99], a[224:227], v[220:223], a[96:99]
s_add_u32 s66, s66, s92
v_exp_f32 v142, v142
v_mfma_f32_16x16x32_bf16 a[100:103], a[228:231], v[220:223], a[100:103]
s_add_u32 m0, s66, 33312
v_exp_f32 v143, v143
v_mfma_f32_16x16x32_bf16 a[100:103], a[196:199], v[204:207], a[100:103]
s_add_u32 s72, s93, 0x4
buffer_load_dwordx4 v1, s[36:39], s72 offen lds
v_mfma_f32_16x16x32_bf16 a[104:107], a[200:203], v[204:207], a[104:107]
ds_read_b128 a[196:199], v2 offset:1024
v_mfma_f32_16x16x32_bf16 a[104:107], a[232:235], v[220:223], a[104:107]
buffer_load_dwordx4 v1, s[36:39], s72 offen offset:1024 lds
v_mfma_f32_16x16x32_bf16 a[108:111], a[236:239], v[220:223], a[108:111]
ds_read_b128 a[200:203], v2 offset:2048
v_mfma_f32_16x16x32_bf16 a[108:111], a[204:207], v[204:207], a[108:111]
buffer_load_dwordx4 v1, s[36:39], s72 offen offset:2048 lds
v_mfma_f32_16x16x32_bf16 a[112:115], a[208:211], v[204:207], a[112:115]
s_waitcnt lgkmcnt(3)
ds_read_b128 a[204:207], v2 offset:3072
v_mfma_f32_16x16x32_bf16 a[112:115], a[240:243], v[220:223], a[112:115]
buffer_load_dwordx4 v1, s[36:39], s72 offen offset:3072 lds
v_mfma_f32_16x16x32_bf16 a[116:119], a[244:247], v[220:223], a[116:119]
v_exp_f32 v156, v156
v_mfma_f32_16x16x32_bf16 a[116:119], a[212:215], v[204:207], a[116:119]
ds_read_b128 a[208:211], v2 offset:4096
v_mfma_f32_16x16x32_bf16 a[120:123], a[216:219], v[204:207], a[120:123]
buffer_load_dwordx4 v[80:83], v15, s[4:7], s80 offen
v_mfma_f32_16x16x32_bf16 a[120:123], a[248:251], v[220:223], a[120:123]
s_add_u32 s80, s80, 0x4000
v_exp_f32 v157, v157
v_mfma_f32_16x16x32_bf16 a[124:127], a[252:255], v[220:223], a[124:127]
ds_read_b128 a[212:215], v2 offset:5120
v_mfma_f32_16x16x32_bf16 a[124:127], a[220:223], v[204:207], a[124:127]
ds_read_b128 a[216:219], v2 offset:6144
v_cvt_pk_bf16_f32 v204, v140, v141
s_cmp_eq_u32 s58, 2
s_cbranch_scc1 Lta37
s_cmp_eq_u32 s58, 3
s_cbranch_scc1 Lnt38
v_mfma_f32_16x16x32_bf16 v[172:175], a[160:163], v[64:67], v[112:115]
buffer_load_dwordx4 v[84:87], v15, s[4:7], s80 offen
v_mfma_f32_16x16x32_bf16 v[188:191], a[176:179], v[64:67], v[112:115]
s_add_u32 s80, s80, 0x4000
v_exp_f32 v158, v158
s_branch Ljoin39
Lta37:
v_mfma_f32_16x16x32_bf16 v[172:175], a[160:163], v[64:67], v[108:111]
buffer_load_dwordx4 v[84:87], v15, s[4:7], s80 offen
v_mfma_f32_16x16x32_bf16 v[188:191], a[176:179], v[64:67], v[112:115]
s_add_u32 s80, s80, 0x4000
v_exp_f32 v158, v158
s_branch Ljoin39
Lnt38:
v_mfma_f32_16x16x32_bf16 v[172:175], a[160:163], v[64:67], v[92:95]
buffer_load_dwordx4 v[84:87], v15, s[4:7], s80 offen
v_mfma_f32_16x16x32_bf16 v[188:191], a[176:179], v[64:67], v[108:111]
s_add_u32 s80, s80, 0x4000
v_exp_f32 v158, v158
Ljoin39:
v_mfma_f32_16x16x32_bf16 v[172:175], a[164:167], v[68:71], v[172:175]
ds_read_b128 a[220:223], v2 offset:7168
v_cvt_pk_bf16_f32 v205, v142, v143
v_mfma_f32_16x16x32_bf16 v[172:175], a[168:171], v[72:75], v[172:175]
buffer_load_dwordx4 v[96:99], v15, s[4:7], s80 offen
v_mfma_f32_16x16x32_bf16 v[172:175], a[172:175], v[76:79], v[172:175]
s_add_u32 s80, s80, 0x4000
v_exp_f32 v159, v159
v_mfma_f32_16x16x32_bf16 v[188:191], a[188:191], v[76:79], v[188:191]
buffer_load_dwordx4 v[100:103], v15, s[4:7], s80 offen
v_mfma_f32_16x16x32_bf16 v[188:191], a[184:187], v[72:75], v[188:191]
v_cvt_pk_bf16_f32 v206, v156, v157
v_cvt_pk_bf16_f32 v207, v158, v159
v_mfma_f32_16x16x32_bf16 v[188:191], a[180:183], v[68:71], v[188:191]
s_waitcnt lgkmcnt(4)
v_mfma_f32_16x16x32_bf16 v[232:235], v[120:123], v[216:219], v[232:235]
s_add_u32 s82, s82, 0x8000
v_exp_f32 v172, v172
v_mfma_f32_16x16x32_bf16 a[64:67], a[224:227], v[216:219], a[64:67]
s_and_b32 s82, s82, 0x1ffff
ds_read_b128 a[224:227], v2 offset:8192
v_mfma_f32_16x16x32_bf16 a[68:71], a[228:231], v[216:219], a[68:71]
ds_read_b128 a[228:231], v2 offset:9216
v_mfma_f32_16x16x32_bf16 a[72:75], a[232:235], v[216:219], a[72:75]
v_exp_f32 v173, v173
v_mfma_f32_16x16x32_bf16 a[76:79], a[236:239], v[216:219], a[76:79]
s_nop 0
ds_read_b128 a[232:235], v2 offset:10240
ds_read_b128 a[236:239], v2 offset:11264
v_mfma_f32_16x16x32_bf16 a[80:83], a[240:243], v[216:219], a[80:83]
ds_read_b128 a[240:243], v2 offset:12288
v_cvt_pk_bf16_f32 v220, v172, v173
v_mfma_f32_16x16x32_bf16 a[84:87], a[244:247], v[216:219], a[84:87]
ds_read_b128 a[244:247], v2 offset:13312
v_mfma_f32_16x16x32_bf16 a[88:91], a[248:251], v[216:219], a[88:91]
v_exp_f32 v174, v174
v_mfma_f32_16x16x32_bf16 a[92:95], a[252:255], v[216:219], a[92:95]
v_exp_f32 v175, v175
ds_read_b128 a[248:251], v2 offset:14336
ds_read_b128 a[252:255], v2 offset:15360
v_add_u32 v2, s82, v1
v_exp_f32 v188, v188
v_cvt_pk_bf16_f32 v221, v174, v175
v_exp_f32 v189, v189
v_exp_f32 v190, v190
v_cvt_pk_bf16_f32 v222, v188, v189
v_exp_f32 v191, v191
s_nop 0
v_cvt_pk_bf16_f32 v223, v190, v191
s_waitcnt vmcnt(4) lgkmcnt(0)
s_barrier
LHT4:
Lstub8:
s_cbranch_execz Lret
v_mfma_f32_16x16x32_bf16 v[236:239], v[120:123], v[204:207], v[236:239]
ds_write_b64 v5, v[12:13]
v_mov_b32 v240, 0
v_mfma_f32_16x16x32_bf16 v[236:239], v[120:123], v[220:223], v[236:239]
v_mov_b32 v241, 0
v_mfma_f32_16x16x32_bf16 a[96:99], a[192:195], v[204:207], a[96:99]
s_nop 0
ds_write_b64 v14, v[240:241]
ds_read_b64 a[128:129], v6 offset:0
v_mfma_f32_16x16x32_bf16 a[96:99], a[224:227], v[220:223], a[96:99]
s_nop 0
ds_read_b64 a[130:131], v6 offset:8
ds_read_b128 a[192:195], v7 offset:3584
v_mfma_f32_16x16x32_bf16 a[100:103], a[228:231], v[220:223], a[100:103]
s_nop 0
ds_read_b64 a[132:133], v6 offset:512
ds_read_b64 a[134:135], v6 offset:520
v_mfma_f32_16x16x32_bf16 a[100:103], a[196:199], v[204:207], a[100:103]
s_nop 0
ds_read_b128 a[196:199], v7 offset:3072
ds_read_b64 a[136:137], v6 offset:1024
v_mfma_f32_16x16x32_bf16 a[104:107], a[200:203], v[204:207], a[104:107]
s_nop 0
ds_read_b64 a[138:139], v6 offset:1032
ds_read_b128 a[200:203], v7 offset:2560
v_mfma_f32_16x16x32_bf16 a[104:107], a[232:235], v[220:223], a[104:107]
v_add_f32 v12, v224, v228
v_min_u32 v13, 1, v0
v_mfma_f32_16x16x32_bf16 a[108:111], a[236:239], v[220:223], a[108:111]
s_nop 0
ds_read_b64 a[140:141], v6 offset:1536
ds_read_b64 a[142:143], v6 offset:1544
v_mfma_f32_16x16x32_bf16 a[108:111], a[204:207], v[204:207], a[108:111]
s_nop 0
ds_read_b128 a[204:207], v7 offset:2048
ds_read_b64 a[144:145], v6 offset:2048
v_mfma_f32_16x16x32_bf16 a[112:115], a[208:211], v[204:207], a[112:115]
s_lshl_b32 s73, s52, 12
ds_read_b64 a[146:147], v6 offset:2056
ds_read_b128 a[208:211], v7 offset:1536
v_mfma_f32_16x16x32_bf16 a[112:115], a[240:243], v[220:223], a[112:115]
s_add_u32 s73, s73, 0x2000000
v_lshlrev_b32 v13, 30, v13
v_mov_b32 v14, 2
v_mfma_f32_16x16x32_bf16 a[116:119], a[244:247], v[220:223], a[116:119]
s_lshl_b32 s70, s68, 2
ds_read_b64 a[148:149], v6 offset:2560
ds_read_b64 a[150:151], v6 offset:2568
v_mfma_f32_16x16x32_bf16 a[116:119], a[212:215], v[204:207], a[116:119]
s_add_u32 s70, s70, s73
ds_read_b128 a[212:215], v7 offset:1024
ds_read_b64 a[152:153], v6 offset:3072
v_mfma_f32_16x16x32_bf16 a[120:123], a[216:219], v[204:207], a[120:123]
s_nop 0
ds_read_b64 a[154:155], v6 offset:3080
ds_read_b128 a[216:219], v7 offset:512
v_mfma_f32_16x16x32_bf16 a[120:123], a[248:251], v[220:223], a[120:123]
v_mfma_f32_16x16x32_bf16 a[124:127], a[252:255], v[220:223], a[124:127]
s_xor_b32 s71, s12, 0x80
ds_read_b64 a[156:157], v6 offset:3584
ds_read_b64 a[158:159], v6 offset:3592
v_mfma_f32_16x16x32_bf16 a[124:127], a[220:223], v[204:207], a[124:127]
s_add_u32 m0, s77, 0
ds_read_b128 a[220:223], v7 offset:0
s_waitcnt lgkmcnt(0)
v_mfma_f32_16x16x32_bf16 v[128:131], v[8:11], a[192:195], 0
s_add_u32 s72, s71, 0
buffer_load_dwordx4 v15, s[24:27], s72 offen lds
v_mfma_f32_16x16x32_bf16 v[128:131], a[128:131], a[192:195], v[128:131]
v_mfma_f32_16x16x32_bf16 v[132:135], v[8:11], a[196:199], 0
s_nop 0
ds_read_b128 a[224:227], v7 offset:3648
ds_read_b64 a[160:161], v6 offset:64
v_mfma_f32_16x16x32_bf16 v[132:135], a[128:131], a[196:199], v[132:135]
v_accvgpr_read_b32 v240, a64
v_accvgpr_read_b32 v241, a65
v_accvgpr_read_b32 v242, a66
v_mfma_f32_16x16x32_bf16 v[132:135], a[132:135], a[192:195], v[132:135]
s_add_u32 s72, s71, 15360
buffer_load_dwordx4 v15, s[24:27], s72 offen offset:1024 lds
v_accvgpr_read_b32 v243, a67
v_mfma_f32_16x16x32_bf16 v[136:139], v[8:11], a[200:203], 0
s_nop 0
ds_read_b64 a[162:163], v6 offset:72
ds_read_b128 a[228:231], v7 offset:3136
v_mfma_f32_16x16x32_bf16 v[136:139], a[128:131], a[200:203], v[136:139]
s_lshl_b32 s95, s75, 20
v_rcp_f32 v234, v232
v_mfma_f32_16x16x32_bf16 v[136:139], a[132:135], a[196:199], v[136:139]
s_lshl_b32 s74, s58, 18
v_rcp_f32 v238, v236
v_accvgpr_read_b32 v244, a68
v_mfma_f32_16x16x32_bf16 v[136:139], a[136:139], a[192:195], v[136:139]
s_add_u32 s95, s95, s74
ds_read_b64 a[164:165], v6 offset:576
ds_read_b64 a[166:167], v6 offset:584
v_accvgpr_read_b32 v245, a69
v_mfma_f32_16x16x32_bf16 v[140:143], v[8:11], a[204:207], 0
s_add_u32 s72, s71, 30720
buffer_load_dwordx4 v15, s[24:27], s72 offen offset:2048 lds
v_accvgpr_read_b32 v246, a70
v_mfma_f32_16x16x32_bf16 v[140:143], a[128:131], a[204:207], v[140:143]
s_add_u32 s95, s95, 0x2000000
v_accvgpr_read_b32 v247, a71
v_mul_f32 v240, v240, v234
v_mul_f32 v241, v241, v234
v_mfma_f32_16x16x32_bf16 v[140:143], a[132:135], a[200:203], v[140:143]
s_sub_u32 s74, 15, s75
ds_read_b128 a[232:235], v7 offset:2624
ds_read_b64 a[168:169], v6 offset:1088
v_mul_f32 v242, v242, v234
v_mfma_f32_16x16x32_bf16 v[140:143], a[136:139], a[196:199], v[140:143]
s_add_u32 s72, s71, 46080
buffer_load_dwordx4 v15, s[24:27], s72 offen offset:3072 lds
v_mul_f32 v243, v243, v234
v_mfma_f32_16x16x32_bf16 v[140:143], a[140:143], a[192:195], v[140:143]
s_min_u32 s74, s74, s75
v_mul_f32 v244, v244, v234
v_mul_f32 v245, v245, v234
v_mul_f32 v246, v246, v234
v_mfma_f32_16x16x32_bf16 v[144:147], v[8:11], a[208:211], 0
s_lshl_b32 s74, s74, 7
ds_read_b64 a[170:171], v6 offset:1096
ds_read_b128 a[236:239], v7 offset:2112
v_mul_f32 v247, v247, v234
v_mfma_f32_16x16x32_bf16 v[144:147], a[128:131], a[208:211], v[144:147]
s_add_u32 s74, s74, 0x3810000
v_cvt_pk_bf16_f32 v240, v240, v241
v_cvt_pk_bf16_f32 v241, v242, v243
v_cvt_pk_bf16_f32 v242, v244, v245
v_mfma_f32_16x16x32_bf16 v[144:147], a[132:135], a[204:207], v[144:147]
s_xor_b32 s85, s77, 0x10000
v_cvt_pk_bf16_f32 v243, v246, v247
v_mfma_f32_16x16x32_bf16 v[144:147], a[136:139], a[200:203], v[144:147]
s_nop 0
ds_read_b64 a[172:173], v6 offset:1600
ds_read_b64 a[174:175], v6 offset:1608
v_mfma_f32_16x16x32_bf16 v[144:147], a[140:143], a[196:199], v[144:147]
buffer_store_dwordx4 v[240:243], v1, s[44:47], s70 offen sc1
v_mfma_f32_16x16x32_bf16 v[144:147], a[144:147], a[192:195], v[144:147]
v_accvgpr_read_b32 v248, a72
v_accvgpr_read_b32 v249, a73
v_accvgpr_read_b32 v250, a74
v_mfma_f32_16x16x32_bf16 v[148:151], v[8:11], a[212:215], 0
s_nop 0
ds_read_b128 a[240:243], v7 offset:1600
ds_read_b64 a[176:177], v6 offset:2112
v_accvgpr_read_b32 v251, a75
v_mfma_f32_16x16x32_bf16 v[148:151], a[128:131], a[212:215], v[148:151]
v_accvgpr_read_b32 v252, a76
v_accvgpr_read_b32 v253, a77
v_accvgpr_read_b32 v254, a78
v_mfma_f32_16x16x32_bf16 v[148:151], a[132:135], a[208:211], v[148:151]
v_accvgpr_read_b32 v255, a79
v_mul_f32 v248, v248, v234
v_mul_f32 v249, v249, v234
v_mfma_f32_16x16x32_bf16 v[148:151], a[136:139], a[204:207], v[148:151]
s_nop 0
ds_read_b64 a[178:179], v6 offset:2120
ds_read_b128 a[244:247], v7 offset:1088
v_mul_f32 v250, v250, v234
v_mfma_f32_16x16x32_bf16 v[148:151], a[140:143], a[200:203], v[148:151]
v_cmp_ngt_f32 vcc, 0x6f800000, v12
s_or_b32 s83, vcc_lo, vcc_hi
s_cselect_b32 s83, s86, 1
s_lshl_b32 s53, s83, 30
s_xor_b32 s83, s53, 0x40000000
v_or_b32 v13, s83, v13
s_lshl_b32 s83, s58, 2
s_add_u32 s83, s83, s91
s_waitcnt vmcnt(5)
buffer_store_dword v14, v13, s[44:47], s83 offen offset:4 sc1
v_mfma_f32_16x16x32_bf16 v[148:151], a[144:147], a[196:199], v[148:151]
v_mul_f32 v251, v251, v234
v_mul_f32 v252, v252, v234
v_mul_f32 v253, v253, v234
v_mfma_f32_16x16x32_bf16 v[148:151], a[148:151], a[192:195], v[148:151]
s_nop 0
ds_read_b64 a[180:181], v6 offset:2624
ds_read_b64 a[182:183], v6 offset:2632
v_mul_f32 v254, v254, v234
v_mfma_f32_16x16x32_bf16 v[152:155], v[8:11], a[216:219], 0
v_mul_f32 v255, v255, v234
v_cvt_pk_bf16_f32 v248, v248, v249
v_cvt_pk_bf16_f32 v249, v250, v251
v_mfma_f32_16x16x32_bf16 v[152:155], a[128:131], a[216:219], v[152:155]
v_cvt_pk_bf16_f32 v250, v252, v253
v_cvt_pk_bf16_f32 v251, v254, v255
v_mfma_f32_16x16x32_bf16 v[152:155], a[132:135], a[212:215], v[152:155]
s_nop 0
ds_read_b128 a[248:251], v7 offset:576
ds_read_b64 a[184:185], v6 offset:3136
v_mfma_f32_16x16x32_bf16 v[152:155], a[136:139], a[208:211], v[152:155]
buffer_store_dwordx4 v[248:251], v1, s[44:47], s70 offen offset:1024 sc1
v_mfma_f32_16x16x32_bf16 v[152:155], a[140:143], a[204:207], v[152:155]
v_accvgpr_read_b32 v240, a80
v_accvgpr_read_b32 v241, a81
v_accvgpr_read_b32 v242, a82
v_mfma_f32_16x16x32_bf16 v[152:155], a[144:147], a[200:203], v[152:155]
s_nop 0
ds_read_b64 a[186:187], v6 offset:3144
ds_read_b128 a[252:255], v7 offset:64
v_accvgpr_read_b32 v243, a83
v_mfma_f32_16x16x32_bf16 v[152:155], a[148:151], a[196:199], v[152:155]
v_accvgpr_read_b32 v244, a84
v_accvgpr_read_b32 v245, a85
v_accvgpr_read_b32 v246, a86
v_mfma_f32_16x16x32_bf16 v[152:155], a[152:155], a[192:195], v[152:155]
v_accvgpr_read_b32 v247, a87
v_mul_f32 v240, v240, v234
v_mul_f32 v241, v241, v234
v_mfma_f32_16x16x32_bf16 v[156:159], v[8:11], a[220:223], 0
s_nop 0
ds_read_b64 a[188:189], v6 offset:3648
ds_read_b64 a[190:191], v6 offset:3656
v_mul_f32 v242, v242, v234
v_mfma_f32_16x16x32_bf16 v[156:159], a[128:131], a[220:223], v[156:159]
v_mul_f32 v243, v243, v234
v_mul_f32 v244, v244, v234
v_mul_f32 v245, v245, v234
v_mfma_f32_16x16x32_bf16 v[156:159], a[132:135], a[216:219], v[156:159]
v_mul_f32 v246, v246, v234
v_mul_f32 v247, v247, v234
v_cvt_pk_bf16_f32 v240, v240, v241
v_mfma_f32_16x16x32_bf16 v[156:159], a[136:139], a[212:215], v[156:159]
v_cvt_pk_bf16_f32 v241, v242, v243
v_cvt_pk_bf16_f32 v242, v244, v245
v_cvt_pk_bf16_f32 v243, v246, v247
v_mfma_f32_16x16x32_bf16 v[156:159], a[140:143], a[208:211], v[156:159]
buffer_store_dwordx4 v[240:243], v1, s[44:47], s70 offen offset:2048 sc1
v_mfma_f32_16x16x32_bf16 v[156:159], a[144:147], a[204:207], v[156:159]
v_accvgpr_read_b32 v248, a88
v_accvgpr_read_b32 v249, a89
v_accvgpr_read_b32 v250, a90
v_mfma_f32_16x16x32_bf16 v[156:159], a[148:151], a[200:203], v[156:159]
v_accvgpr_read_b32 v251, a91
v_accvgpr_read_b32 v252, a92
v_accvgpr_read_b32 v253, a93
v_mfma_f32_16x16x32_bf16 v[156:159], a[152:155], a[196:199], v[156:159]
v_accvgpr_read_b32 v254, a94
v_accvgpr_read_b32 v255, a95
v_mul_f32 v248, v248, v234
v_mfma_f32_16x16x32_bf16 v[156:159], a[156:159], a[192:195], v[156:159]
s_waitcnt lgkmcnt(0)
v_mul_f32 v249, v249, v234
v_mul_f32 v250, v250, v234
v_mul_f32 v251, v251, v234
v_mfma_f32_16x16x32_bf16 v[128:131], a[160:163], a[224:227], v[128:131]
s_nop 0
ds_read_b128 a[192:195], v7 offset:3712
ds_read_b64 a[128:129], v6 offset:128
v_mul_f32 v252, v252, v234
v_mfma_f32_16x16x32_bf16 v[132:135], a[164:167], a[224:227], v[132:135]
v_mul_f32 v253, v253, v234
v_mul_f32 v254, v254, v234
v_mul_f32 v255, v255, v234
v_mfma_f32_16x16x32_bf16 v[132:135], a[160:163], a[228:231], v[132:135]
s_nop 0
ds_read_b64 a[130:131], v6 offset:136
ds_read_b128 a[196:199], v7 offset:3200
v_cvt_pk_bf16_f32 v248, v248, v249
v_mfma_f32_16x16x32_bf16 v[136:139], a[160:163], a[232:235], v[136:139]
v_cvt_pk_bf16_f32 v249, v250, v251
v_cvt_pk_bf16_f32 v250, v252, v253
v_cvt_pk_bf16_f32 v251, v254, v255
v_mfma_f32_16x16x32_bf16 v[136:139], a[164:167], a[228:231], v[136:139]
buffer_store_dwordx4 v[248:251], v1, s[44:47], s70 offen offset:3072 sc1
v_mfma_f32_16x16x32_bf16 v[136:139], a[168:171], a[224:227], v[136:139]
s_add_u32 s70, s70, 0x80000
ds_read_b64 a[132:133], v6 offset:640
ds_read_b64 a[134:135], v6 offset:648
v_accvgpr_read_b32 v240, a96
v_mfma_f32_16x16x32_bf16 v[140:143], a[172:175], a[224:227], v[140:143]
v_accvgpr_read_b32 v241, a97
v_accvgpr_read_b32 v242, a98
v_accvgpr_read_b32 v243, a99
v_mfma_f32_16x16x32_bf16 v[140:143], a[168:171], a[228:231], v[140:143]
s_nop 0
ds_read_b128 a[200:203], v7 offset:2688
ds_read_b64 a[136:137], v6 offset:1152
v_accvgpr_read_b32 v244, a100
v_mfma_f32_16x16x32_bf16 v[140:143], a[164:167], a[232:235], v[140:143]
v_accvgpr_read_b32 v245, a101
v_accvgpr_read_b32 v246, a102
v_accvgpr_read_b32 v247, a103
v_mfma_f32_16x16x32_bf16 v[140:143], a[160:163], a[236:239], v[140:143]
v_mul_f32 v240, v240, v238
v_mul_f32 v241, v241, v238
v_mul_f32 v242, v242, v238
v_mfma_f32_16x16x32_bf16 v[144:147], a[160:163], a[240:243], v[144:147]
s_nop 0
ds_read_b64 a[138:139], v6 offset:1160
ds_read_b128 a[204:207], v7 offset:2176
v_mul_f32 v243, v243, v238
v_mfma_f32_16x16x32_bf16 v[144:147], a[164:167], a[236:239], v[144:147]
v_mul_f32 v244, v244, v238
v_mul_f32 v245, v245, v238
v_mul_f32 v246, v246, v238
v_mfma_f32_16x16x32_bf16 v[144:147], a[168:171], a[232:235], v[144:147]
s_nop 0
ds_read_b64 a[140:141], v6 offset:1664
ds_read_b64 a[142:143], v6 offset:1672
v_mul_f32 v247, v247, v238
v_mfma_f32_16x16x32_bf16 v[144:147], a[172:175], a[228:231], v[144:147]
v_cvt_pk_bf16_f32 v240, v240, v241
v_cvt_pk_bf16_f32 v241, v242, v243
v_cvt_pk_bf16_f32 v242, v244, v245
v_mfma_f32_16x16x32_bf16 v[144:147], a[176:179], a[224:227], v[144:147]
v_cvt_pk_bf16_f32 v243, v246, v247
v_mfma_f32_16x16x32_bf16 v[148:151], a[180:183], a[224:227], v[148:151]
s_nop 0
ds_read_b128 a[208:211], v7 offset:1664
ds_read_b64 a[144:145], v6 offset:2176
v_mfma_f32_16x16x32_bf16 v[148:151], a[176:179], a[228:231], v[148:151]
buffer_store_dwordx4 v[240:243], v1, s[44:47], s70 offen sc1
v_mfma_f32_16x16x32_bf16 v[148:151], a[172:175], a[232:235], v[148:151]
v_accvgpr_read_b32 v248, a104
v_accvgpr_read_b32 v249, a105
v_accvgpr_read_b32 v250, a106
v_mfma_f32_16x16x32_bf16 v[148:151], a[168:171], a[236:239], v[148:151]
s_nop 0
ds_read_b64 a[146:147], v6 offset:2184
ds_read_b128 a[212:215], v7 offset:1152
v_accvgpr_read_b32 v251, a107
v_mfma_f32_16x16x32_bf16 v[148:151], a[164:167], a[240:243], v[148:151]
v_accvgpr_read_b32 v252, a108
v_accvgpr_read_b32 v253, a109
v_accvgpr_read_b32 v254, a110
v_mfma_f32_16x16x32_bf16 v[148:151], a[160:163], a[244:247], v[148:151]
s_nop 0
ds_read_b64 a[148:149], v6 offset:2688
ds_read_b64 a[150:151], v6 offset:2696
v_accvgpr_read_b32 v255, a111
v_mfma_f32_16x16x32_bf16 v[152:155], a[160:163], a[248:251], v[152:155]
v_mul_f32 v248, v248, v238
v_mul_f32 v249, v249, v238
v_mul_f32 v250, v250, v238
v_mfma_f32_16x16x32_bf16 v[152:155], a[164:167], a[244:247], v[152:155]
v_mul_f32 v251, v251, v238
v_mul_f32 v252, v252, v238
v_mul_f32 v253, v253, v238
v_mfma_f32_16x16x32_bf16 v[152:155], a[168:171], a[240:243], v[152:155]
s_nop 0
ds_read_b128 a[216:219], v7 offset:640
ds_read_b64 a[152:153], v6 offset:3200
v_mul_f32 v254, v254, v238
v_mfma_f32_16x16x32_bf16 v[152:155], a[172:175], a[236:239], v[152:155]
v_mul_f32 v255, v255, v238
v_cvt_pk_bf16_f32 v248, v248, v249
v_cvt_pk_bf16_f32 v249, v250, v251
v_mfma_f32_16x16x32_bf16 v[152:155], a[176:179], a[232:235], v[152:155]
s_nop 0
ds_read_b64 a[154:155], v6 offset:3208
ds_read_b128 a[220:223], v7 offset:128
v_cvt_pk_bf16_f32 v250, v252, v253
v_mfma_f32_16x16x32_bf16 v[152:155], a[180:183], a[228:231], v[152:155]
v_cvt_pk_bf16_f32 v251, v254, v255
v_mfma_f32_16x16x32_bf16 v[152:155], a[184:187], a[224:227], v[152:155]
buffer_store_dwordx4 v[248:251], v1, s[44:47], s70 offen offset:1024 sc1
v_mfma_f32_16x16x32_bf16 v[156:159], a[188:191], a[224:227], v[156:159]
s_nop 0
ds_read_b64 a[156:157], v6 offset:3712
ds_read_b64 a[158:159], v6 offset:3720
v_accvgpr_read_b32 v240, a112
v_mfma_f32_16x16x32_bf16 v[156:159], a[184:187], a[228:231], v[156:159]
v_accvgpr_read_b32 v241, a113
v_accvgpr_read_b32 v242, a114
v_accvgpr_read_b32 v243, a115
v_mfma_f32_16x16x32_bf16 v[156:159], a[180:183], a[232:235], v[156:159]
v_accvgpr_read_b32 v244, a116
v_accvgpr_read_b32 v245, a117
v_accvgpr_read_b32 v246, a118
v_mfma_f32_16x16x32_bf16 v[156:159], a[176:179], a[236:239], v[156:159]
v_accvgpr_read_b32 v247, a119
v_mul_f32 v240, v240, v238
v_mul_f32 v241, v241, v238
v_mfma_f32_16x16x32_bf16 v[156:159], a[172:175], a[240:243], v[156:159]
v_mul_f32 v242, v242, v238
v_mul_f32 v243, v243, v238
v_mul_f32 v244, v244, v238
v_mfma_f32_16x16x32_bf16 v[156:159], a[168:171], a[244:247], v[156:159]
v_mul_f32 v245, v245, v238
v_mul_f32 v246, v246, v238
v_mul_f32 v247, v247, v238
v_mfma_f32_16x16x32_bf16 v[156:159], a[164:167], a[248:251], v[156:159]
v_cvt_pk_bf16_f32 v240, v240, v241
v_cvt_pk_bf16_f32 v241, v242, v243
v_cvt_pk_bf16_f32 v242, v244, v245
v_mfma_f32_16x16x32_bf16 v[156:159], a[160:163], a[252:255], v[156:159]
s_waitcnt lgkmcnt(0)
v_cvt_pk_bf16_f32 v243, v246, v247
v_mfma_f32_16x16x32_bf16 v[128:131], a[128:131], a[192:195], v[128:131]
s_nop 0
ds_read_b128 a[224:227], v7 offset:3776
ds_read_b64 a[160:161], v6 offset:192
v_mfma_f32_16x16x32_bf16 v[132:135], a[132:135], a[192:195], v[132:135]
buffer_store_dwordx4 v[240:243], v1, s[44:47], s70 offen offset:2048 sc1
v_mfma_f32_16x16x32_bf16 v[132:135], a[128:131], a[196:199], v[132:135]
s_nop 0
ds_read_b64 a[162:163], v6 offset:200
ds_read_b128 a[228:231], v7 offset:3264
v_accvgpr_read_b32 v248, a120
v_mfma_f32_16x16x32_bf16 v[136:139], a[128:131], a[200:203], v[136:139]
v_accvgpr_read_b32 v249, a121
v_accvgpr_read_b32 v250, a122
v_accvgpr_read_b32 v251, a123
v_mfma_f32_16x16x32_bf16 v[136:139], a[132:135], a[196:199], v[136:139]
v_accvgpr_read_b32 v252, a124
v_accvgpr_read_b32 v253, a125
v_accvgpr_read_b32 v254, a126
v_mfma_f32_16x16x32_bf16 v[136:139], a[136:139], a[192:195], v[136:139]
s_nop 0
ds_read_b64 a[164:165], v6 offset:704
ds_read_b64 a[166:167], v6 offset:712
v_accvgpr_read_b32 v255, a127
v_mfma_f32_16x16x32_bf16 v[140:143], a[140:143], a[192:195], v[140:143]
v_mul_f32 v248, v248, v238
v_mul_f32 v249, v249, v238
v_mul_f32 v250, v250, v238
v_mfma_f32_16x16x32_bf16 v[140:143], a[136:139], a[196:199], v[140:143]
s_nop 0
ds_read_b128 a[232:235], v7 offset:2752
ds_read_b64 a[168:169], v6 offset:1216
v_mul_f32 v251, v251, v238
v_mfma_f32_16x16x32_bf16 v[140:143], a[132:135], a[200:203], v[140:143]
v_mul_f32 v252, v252, v238
v_mul_f32 v253, v253, v238
v_mul_f32 v254, v254, v238
v_mfma_f32_16x16x32_bf16 v[140:143], a[128:131], a[204:207], v[140:143]
v_mul_f32 v255, v255, v238
v_cvt_pk_bf16_f32 v248, v248, v249
v_cvt_pk_bf16_f32 v249, v250, v251
v_mfma_f32_16x16x32_bf16 v[144:147], a[128:131], a[208:211], v[144:147]
s_nop 0
ds_read_b64 a[170:171], v6 offset:1224
ds_read_b128 a[236:239], v7 offset:2240
v_cvt_pk_bf16_f32 v250, v252, v253
v_mfma_f32_16x16x32_bf16 v[144:147], a[132:135], a[204:207], v[144:147]
v_cvt_pk_bf16_f32 v251, v254, v255
v_mfma_f32_16x16x32_bf16 v[144:147], a[136:139], a[200:203], v[144:147]
s_nop 0
ds_read_b64 a[172:173], v6 offset:1728
ds_read_b64 a[174:175], v6 offset:1736
v_mfma_f32_16x16x32_bf16 v[144:147], a[140:143], a[196:199], v[144:147]
buffer_store_dwordx4 v[248:251], v1, s[44:47], s70 offen offset:3072 sc1
v_mfma_f32_16x16x32_bf16 v[144:147], a[144:147], a[192:195], v[144:147]
s_mov_b32 s73, 0x6f800000
v_add_f32 v227, v224, v228
v_add_f32 v231, v232, v236
v_add_f32 v227, v227, v231
v_mfma_f32_16x16x32_bf16 v[148:151], a[148:151], a[192:195], v[148:151]
Lstub9:
s_cbranch_execz Lret
s_nop 0
ds_read_b128 a[240:243], v7 offset:1728
ds_read_b64 a[176:177], v6 offset:2240
v_cmp_nlt_f32 vcc, v227, s73
v_mfma_f32_16x16x32_bf16 v[148:151], a[144:147], a[196:199], v[148:151]
s_lshl_b32 s73, s58, 2
v_mfma_f32_16x16x32_bf16 v[148:151], a[140:143], a[200:203], v[148:151]
s_add_u32 s73, s73, 163328
v_mov_b32 v231, s73
v_mfma_f32_16x16x32_bf16 v[148:151], a[136:139], a[204:207], v[148:151]
s_or_b32 s73, vcc_lo, vcc_hi
ds_read_b64 a[178:179], v6 offset:2248
ds_read_b128 a[244:247], v7 offset:1216
v_mfma_f32_16x16x32_bf16 v[148:151], a[132:135], a[208:211], v[148:151]
s_min_u32 s73, s73, 1
v_mov_b32 v227, s73
v_mfma_f32_16x16x32_bf16 v[148:151], a[128:131], a[212:215], v[148:151]
s_nop 0
ds_read_b64 a[180:181], v6 offset:2752
ds_read_b64 a[182:183], v6 offset:2760
ds_write_b32 v231, v227
v_mfma_f32_16x16x32_bf16 v[152:155], a[128:131], a[216:219], v[152:155]
v_mfma_f32_16x16x32_bf16 v[152:155], a[132:135], a[212:215], v[152:155]
v_mfma_f32_16x16x32_bf16 v[152:155], a[136:139], a[208:211], v[152:155]
s_nop 0
ds_read_b128 a[248:251], v7 offset:704
ds_read_b64 a[184:185], v6 offset:3264
v_mfma_f32_16x16x32_bf16 v[152:155], a[140:143], a[204:207], v[152:155]
v_mfma_f32_16x16x32_bf16 v[152:155], a[144:147], a[200:203], v[152:155]
s_nop 0
ds_read_b64 a[186:187], v6 offset:3272
ds_read_b128 a[252:255], v7 offset:192
v_mfma_f32_16x16x32_bf16 v[152:155], a[148:151], a[196:199], v[152:155]
v_mfma_f32_16x16x32_bf16 v[152:155], a[152:155], a[192:195], v[152:155]
v_mfma_f32_16x16x32_bf16 v[156:159], a[156:159], a[192:195], v[156:159]
s_nop 0
ds_read_b64 a[188:189], v6 offset:3776
ds_read_b64 a[190:191], v6 offset:3784
v_mfma_f32_16x16x32_bf16 v[156:159], a[152:155], a[196:199], v[156:159]
v_mfma_f32_16x16x32_bf16 v[156:159], a[148:151], a[200:203], v[156:159]
v_mfma_f32_16x16x32_bf16 v[156:159], a[144:147], a[204:207], v[156:159]
v_mfma_f32_16x16x32_bf16 v[156:159], a[140:143], a[208:211], v[156:159]
v_mfma_f32_16x16x32_bf16 v[156:159], a[136:139], a[212:215], v[156:159]
v_mfma_f32_16x16x32_bf16 v[156:159], a[132:135], a[216:219], v[156:159]
v_mfma_f32_16x16x32_bf16 v[156:159], a[128:131], a[220:223], v[156:159]
s_waitcnt lgkmcnt(0)
v_mfma_f32_16x16x32_bf16 v[128:131], a[160:163], a[224:227], v[128:131]
s_nop 0
ds_read_b128 a[192:195], v7 offset:3840
ds_read_b64 a[128:129], v6 offset:256
v_mfma_f32_16x16x32_bf16 v[132:135], a[164:167], a[224:227], v[132:135]
v_mfma_f32_16x16x32_bf16 v[132:135], a[160:163], a[228:231], v[132:135]
s_nop 0
ds_read_b64 a[130:131], v6 offset:264
ds_read_b128 a[196:199], v7 offset:3328
v_mfma_f32_16x16x32_bf16 v[136:139], a[160:163], a[232:235], v[136:139]
v_mfma_f32_16x16x32_bf16 v[136:139], a[164:167], a[228:231], v[136:139]
v_mfma_f32_16x16x32_bf16 v[136:139], a[168:171], a[224:227], v[136:139]
s_nop 0
ds_read_b64 a[132:133], v6 offset:768
ds_read_b64 a[134:135], v6 offset:776
v_mfma_f32_16x16x32_bf16 v[140:143], a[172:175], a[224:227], v[140:143]
v_mfma_f32_16x16x32_bf16 v[140:143], a[168:171], a[228:231], v[140:143]
s_nop 0
ds_read_b128 a[200:203], v7 offset:2816
ds_read_b64 a[136:137], v6 offset:1280
v_mfma_f32_16x16x32_bf16 v[140:143], a[164:167], a[232:235], v[140:143]
v_mfma_f32_16x16x32_bf16 v[140:143], a[160:163], a[236:239], v[140:143]
v_mfma_f32_16x16x32_bf16 v[144:147], a[160:163], a[240:243], v[144:147]
s_nop 0
ds_read_b64 a[138:139], v6 offset:1288
ds_read_b128 a[204:207], v7 offset:2304
v_mfma_f32_16x16x32_bf16 v[144:147], a[164:167], a[236:239], v[144:147]
v_mfma_f32_16x16x32_bf16 v[144:147], a[168:171], a[232:235], v[144:147]
s_nop 0
ds_read_b64 a[140:141], v6 offset:1792
ds_read_b64 a[142:143], v6 offset:1800
v_mfma_f32_16x16x32_bf16 v[144:147], a[172:175], a[228:231], v[144:147]
v_mfma_f32_16x16x32_bf16 v[144:147], a[176:179], a[224:227], v[144:147]
s_xor_b32 s71, s12, 0x100
v_mfma_f32_16x16x32_bf16 v[148:151], a[180:183], a[224:227], v[148:151]
s_add_u32 m0, s77, 16384
ds_read_b128 a[208:211], v7 offset:1792
ds_read_b64 a[144:145], v6 offset:2304
v_mfma_f32_16x16x32_bf16 v[148:151], a[176:179], a[228:231], v[148:151]
s_add_u32 s72, s71, 0
buffer_load_dwordx4 v15, s[24:27], s72 offen lds
s_nop 3
s_mov_b64 exec, 0
s_cmp_eq_u32 s58, 0
s_cbranch_scc1 Lstube0
s_cmp_eq_u32 s58, 1
s_cbranch_scc1 Lstube1
s_cmp_eq_u32 s58, 2
s_cbranch_scc1 Lstube2
s_branch Lstube3
Lrete:
s_mov_b64 exec, -1
s_nop 3
v_mfma_f32_16x16x32_bf16 v[148:151], a[172:175], a[232:235], v[148:151]
s_waitcnt vmcnt(1) lgkmcnt(15)
v_mfma_f32_16x16x32_bf16 v[148:151], a[168:171], a[236:239], v[148:151]
s_barrier
ds_read_b64 a[146:147], v6 offset:2312
ds_read_b128 a[212:215], v7 offset:1280
v_mfma_f32_16x16x32_bf16 v[148:151], a[164:167], a[240:243], v[148:151]
s_add_u32 s72, s71, 15360
buffer_load_dwordx4 v15, s[24:27], s72 offen offset:1024 lds
v_mfma_f32_16x16x32_bf16 v[148:151], a[160:163], a[244:247], v[148:151]
s_nop 0
ds_read_b64 a[148:149], v6 offset:2816
ds_read_b64 a[150:151], v6 offset:2824
v_mfma_f32_16x16x32_bf16 v[152:155], a[160:163], a[248:251], v[152:155]
v_mov_b32 v244, 163328
v_mfma_f32_16x16x32_bf16 v[152:155], a[164:167], a[244:247], v[152:155]
ds_read_b128 v[240:243], v244
v_mfma_f32_16x16x32_bf16 v[152:155], a[168:171], a[240:243], v[152:155]
s_nop 0
ds_read_b128 a[216:219], v7 offset:768
ds_read_b64 a[152:153], v6 offset:3328
v_mfma_f32_16x16x32_bf16 v[152:155], a[172:175], a[236:239], v[152:155]
v_mfma_f32_16x16x32_bf16 v[152:155], a[176:179], a[232:235], v[152:155]
s_add_u32 s72, s71, 30720
ds_read_b64 a[154:155], v6 offset:3336
ds_read_b128 a[220:223], v7 offset:256
v_mfma_f32_16x16x32_bf16 v[152:155], a[180:183], a[228:231], v[152:155]
buffer_load_dwordx4 v15, s[24:27], s72 offen offset:2048 lds
v_mfma_f32_16x16x32_bf16 v[152:155], a[184:187], a[224:227], v[152:155]
s_waitcnt lgkmcnt(4)
v_or3_b32 v240, v240, v241, v242
v_or_b32 v240, v240, v243
v_mfma_f32_16x16x32_bf16 v[156:159], a[188:191], a[224:227], v[156:159]
s_nop 0
ds_read_b64 a[156:157], v6 offset:3840
ds_read_b64 a[158:159], v6 offset:3848
v_cmp_lt_u32 vcc, s86, v240
s_cbranch_vccnz Lslow
v_mfma_f32_16x16x32_bf16 v[156:159], a[184:187], a[228:231], v[156:159]
v_or_b32 v240, s58, v0
v_mov_b32 v241, 2
v_mfma_f32_16x16x32_bf16 v[156:159], a[180:183], a[232:235], v[156:159]
v_min_u32 v240, 1, v240
v_lshlrev_b32 v240, 30, v240
v_mfma_f32_16x16x32_bf16 v[156:159], a[176:179], a[236:239], v[156:159]
s_add_u32 s72, s71, 46080
buffer_load_dwordx4 v15, s[24:27], s72 offen offset:3072 lds
v_mfma_f32_16x16x32_bf16 v[156:159], a[172:175], a[240:243], v[156:159]
buffer_store_dword v241, v240, s[44:47], s91 offen sc1
v_mfma_f32_16x16x32_bf16 v[156:159], a[168:171], a[244:247], v[156:159]
s_add_u32 s80, s93, 0x3400000
v_and_b32 v166, 7, v0
v_lshlrev_b32 v166, 4, v166
v_mfma_f32_16x16x32_bf16 v[156:159], a[164:167], a[248:251], v[156:159]
s_and_b32 s81, s59, 4
v_and_b32 v3, 3, v0
v_add_u32 v3, 1, v3
v_mfma_f32_16x16x32_bf16 v[156:159], a[160:163], a[252:255], v[156:159]
s_waitcnt lgkmcnt(0)
v_mul_u32_u24 v3, s81, v3
v_lshrrev_b32 v2, 4, v0
v_mfma_f32_16x16x32_bf16 v[128:131], a[128:131], a[192:195], v[128:131]
s_nop 0
ds_read_b128 a[224:227], v7 offset:3904
ds_read_b64 a[160:161], v6 offset:320
v_mfma_f32_16x16x32_bf16 v[132:135], a[132:135], a[192:195], v[132:135]
s_xor_b32 s71, s12, 0x180
v_lshl_add_u32 v2, v2, 10, v3
v_bfe_u32 v112, v0, 3, 1
v_mfma_f32_16x16x32_bf16 v[132:135], a[128:131], a[196:199], v[132:135]
s_add_u32 m0, s77, 32768
ds_read_b64 a[162:163], v6 offset:328
ds_read_b128 a[228:231], v7 offset:3392
v_mfma_f32_16x16x32_bf16 v[136:139], a[128:131], a[200:203], v[136:139]
s_add_u32 s72, s71, 0
buffer_load_dwordx4 v15, s[24:27], s72 offen lds
v_mfma_f32_16x16x32_bf16 v[136:139], a[132:135], a[196:199], v[136:139]
s_xor_b32 s82, s78, 0
v_lshl_add_u32 v166, v112, 8, v166
v_bfe_u32 v112, v0, 4, 1
v_mfma_f32_16x16x32_bf16 v[136:139], a[136:139], a[192:195], v[136:139]
s_lshl_b32 s82, s82, 10
ds_read_b64 a[164:165], v6 offset:832
ds_read_b64 a[166:167], v6 offset:840
v_mfma_f32_16x16x32_bf16 v[140:143], a[140:143], a[192:195], v[140:143]
s_add_u32 s82, s82, s74
buffer_load_dword v3, v2, s[44:47], s82 offen sc1
v_mfma_f32_16x16x32_bf16 v[140:143], a[136:139], a[196:199], v[140:143]
s_add_u32 s72, s71, 15360
ds_read_b128 a[232:235], v7 offset:2880
ds_read_b64 a[168:169], v6 offset:1344
v_mfma_f32_16x16x32_bf16 v[140:143], a[132:135], a[200:203], v[140:143]
buffer_load_dwordx4 v15, s[24:27], s72 offen offset:1024 lds
v_mfma_f32_16x16x32_bf16 v[140:143], a[128:131], a[204:207], v[140:143]
v_lshl_add_u32 v166, v112, 7, v166
v_lshrrev_b32 v112, 5, v0
v_mfma_f32_16x16x32_bf16 v[144:147], a[128:131], a[208:211], v[144:147]
s_nop 0
ds_read_b64 a[170:171], v6 offset:1352
ds_read_b128 a[236:239], v7 offset:2368
v_mfma_f32_16x16x32_bf16 v[144:147], a[132:135], a[204:207], v[144:147]
v_lshl_add_u32 v166, v112, 9, v166
v_and_b32 v112, 15, v0
v_mfma_f32_16x16x32_bf16 v[144:147], a[136:139], a[200:203], v[144:147]
s_nop 0
ds_read_b64 a[172:173], v6 offset:1856
ds_read_b64 a[174:175], v6 offset:1864
v_mfma_f32_16x16x32_bf16 v[144:147], a[140:143], a[196:199], v[144:147]
s_add_u32 s72, s71, 30720
buffer_load_dwordx4 v15, s[24:27], s72 offen offset:2048 lds
v_mfma_f32_16x16x32_bf16 v[144:147], a[144:147], a[192:195], v[144:147]
v_lshrrev_b32 v113, 2, v0
v_bfe_u32 v114, v0, 3, 2
v_mfma_f32_16x16x32_bf16 v[148:151], a[148:151], a[192:195], v[148:151]
s_nop 0
ds_read_b128 a[240:243], v7 offset:1856
ds_read_b64 a[176:177], v6 offset:2368
v_mfma_f32_16x16x32_bf16 v[148:151], a[144:147], a[196:199], v[148:151]
v_and_b32 v115, 3, v0
v_lshlrev_b32 v8, 7, v113
v_mfma_f32_16x16x32_bf16 v[148:151], a[140:143], a[200:203], v[148:151]
v_lshl_add_u32 v8, v114, 5, v8
v_lshl_add_u32 v8, v115, 3, v8
v_mfma_f32_16x16x32_bf16 v[148:151], a[136:139], a[204:207], v[148:151]
s_nop 0
ds_read_b64 a[178:179], v6 offset:2376
ds_read_b128 a[244:247], v7 offset:1344
v_mfma_f32_16x16x32_bf16 v[148:151], a[132:135], a[208:211], v[148:151]
s_add_u32 s72, s71, 46080
buffer_load_dwordx4 v15, s[24:27], s72 offen offset:3072 lds
v_mfma_f32_16x16x32_bf16 v[148:151], a[128:131], a[212:215], v[148:151]
s_nop 0
ds_read_b64 a[180:181], v6 offset:2880
ds_read_b64 a[182:183], v6 offset:2888
v_mfma_f32_16x16x32_bf16 v[152:155], a[128:131], a[216:219], v[152:155]
v_add_u32 v8, s77, v8
v_subrev_u32 v8, s64, v8
v_mfma_f32_16x16x32_bf16 v[152:155], a[132:135], a[212:215], v[152:155]
v_xor_b32 v9, 32, v8
v_xor_b32 v10, 64, v8
v_mfma_f32_16x16x32_bf16 v[152:155], a[136:139], a[208:211], v[152:155]
s_nop 0
ds_read_b128 a[248:251], v7 offset:832
ds_read_b64 a[184:185], v6 offset:3392
v_mfma_f32_16x16x32_bf16 v[152:155], a[140:143], a[204:207], v[152:155]
v_xor_b32 v11, 0x60, v8
v_lshlrev_b32 v5, 8, v113
v_mfma_f32_16x16x32_bf16 v[152:155], a[144:147], a[200:203], v[152:155]
s_xor_b32 s71, s13, 0x80
ds_read_b64 a[186:187], v6 offset:3400
ds_read_b128 a[252:255], v7 offset:320
v_mfma_f32_16x16x32_bf16 v[152:155], a[148:151], a[196:199], v[152:155]
s_add_u32 m0, s77, 49152
v_and_b32 v114, 1, v0
v_lshl_add_u32 v5, v114, 7, v5
v_mfma_f32_16x16x32_bf16 v[152:155], a[152:155], a[192:195], v[152:155]
s_add_u32 s72, s71, 0
buffer_load_dwordx4 v15, s[24:27], s72 offen lds
v_mfma_f32_16x16x32_bf16 v[156:159], a[156:159], a[192:195], v[156:159]
s_nop 0
ds_read_b64 a[188:189], v6 offset:3904
ds_read_b64 a[190:191], v6 offset:3912
v_mfma_f32_16x16x32_bf16 v[156:159], a[152:155], a[196:199], v[156:159]
v_bfe_u32 v114, v0, 1, 1
v_lshl_add_u32 v5, v114, 3, v5
v_mfma_f32_16x16x32_bf16 v[156:159], a[148:151], a[200:203], v[156:159]
v_lshlrev_b32 v114, 1, s58
v_xor_b32 v114, v114, v113
v_mfma_f32_16x16x32_bf16 v[156:159], a[144:147], a[204:207], v[156:159]
s_add_u32 s72, s71, 15360
buffer_load_dwordx4 v15, s[24:27], s72 offen offset:1024 lds
v_mfma_f32_16x16x32_bf16 v[156:159], a[140:143], a[208:211], v[156:159]
v_and_b32 v114, 7, v114
v_lshl_add_u32 v5, v114, 4, v5
v_mfma_f32_16x16x32_bf16 v[156:159], a[136:139], a[212:215], v[156:159]
v_add_u32 v5, 147456, v5
v_bfe_u32 v114, v0, 1, 2
v_mfma_f32_16x16x32_bf16 v[156:159], a[132:135], a[216:219], v[156:159]
v_lshrrev_b32 v115, 4, v0
v_lshlrev_b32 v116, 7, v112
v_mfma_f32_16x16x32_bf16 v[156:159], a[128:131], a[220:223], v[156:159]
s_waitcnt lgkmcnt(0)
v_lshl_add_u32 v116, v114, 5, v116
v_lshl_add_u32 v116, v115, 3, v116
v_mfma_f32_16x16x32_bf16 v[128:131], a[160:163], a[224:227], v[128:131]
s_nop 0
ds_read_b128 a[192:195], v7 offset:3968
ds_read_b64 a[128:129], v6 offset:384
v_mfma_f32_16x16x32_bf16 v[132:135], a[164:167], a[224:227], v[132:135]
s_add_u32 s72, s71, 30720
buffer_load_dwordx4 v15, s[24:27], s72 offen offset:2048 lds
v_mfma_f32_16x16x32_bf16 v[132:135], a[160:163], a[228:231], v[132:135]
s_nop 0
ds_read_b64 a[130:131], v6 offset:392
ds_read_b128 a[196:199], v7 offset:3456
v_mfma_f32_16x16x32_bf16 v[136:139], a[160:163], a[232:235], v[136:139]
v_add_u32 v116, s64, v116
v_add_u32 v116, 131072, v116
v_mfma_f32_16x16x32_bf16 v[136:139], a[164:167], a[228:231], v[136:139]
v_xor_b32 v117, 32, v116
v_xor_b32 v118, 64, v116
v_mfma_f32_16x16x32_bf16 v[136:139], a[168:171], a[224:227], v[136:139]
s_nop 0
ds_read_b64 a[132:133], v6 offset:896
ds_read_b64 a[134:135], v6 offset:904
v_mfma_f32_16x16x32_bf16 v[140:143], a[172:175], a[224:227], v[140:143]
v_xor_b32 v119, 0x60, v116
v_mfma_f32_16x16x32_bf16 v[140:143], a[168:171], a[228:231], v[140:143]
s_add_u32 s72, s71, 46080
ds_read_b128 a[200:203], v7 offset:2944
ds_read_b64 a[136:137], v6 offset:1408
v_mfma_f32_16x16x32_bf16 v[140:143], a[164:167], a[232:235], v[140:143]
buffer_load_dwordx4 v15, s[24:27], s72 offen offset:3072 lds
v_mfma_f32_16x16x32_bf16 v[140:143], a[160:163], a[236:239], v[140:143]
v_mfma_f32_16x16x32_bf16 v[144:147], a[160:163], a[240:243], v[144:147]
s_nop 0
ds_read_b64 a[138:139], v6 offset:1416
ds_read_b128 a[204:207], v7 offset:2432
v_mfma_f32_16x16x32_bf16 v[144:147], a[164:167], a[236:239], v[144:147]
v_mfma_f32_16x16x32_bf16 v[144:147], a[168:171], a[232:235], v[144:147]
s_nop 0
ds_read_b64 a[140:141], v6 offset:1920
ds_read_b64 a[142:143], v6 offset:1928
v_mfma_f32_16x16x32_bf16 v[144:147], a[172:175], a[228:231], v[144:147]
v_mfma_f32_16x16x32_bf16 v[144:147], a[176:179], a[224:227], v[144:147]
v_mfma_f32_16x16x32_bf16 v[148:151], a[180:183], a[224:227], v[148:151]
s_nop 0
ds_read_b128 a[208:211], v7 offset:1920
ds_read_b64 a[144:145], v6 offset:2432
v_mfma_f32_16x16x32_bf16 v[148:151], a[176:179], a[228:231], v[148:151]
v_mfma_f32_16x16x32_bf16 v[148:151], a[172:175], a[232:235], v[148:151]
s_waitcnt vmcnt(7)
v_cmp_gt_u32 vcc, 2, v3
s_or_b32 s81, vcc_lo, vcc_hi
s_cselect_b32 s81, 0x40000000, 0
v_or_b32 v4, s81, v1
v_mfma_f32_16x16x32_bf16 v[148:151], a[168:171], a[236:239], v[148:151]
s_nop 0
ds_read_b64 a[146:147], v6 offset:2440
ds_read_b128 a[212:215], v7 offset:1408
v_mfma_f32_16x16x32_bf16 v[148:151], a[164:167], a[240:243], v[148:151]
v_mfma_f32_16x16x32_bf16 v[148:151], a[160:163], a[244:247], v[148:151]
s_nop 0
ds_read_b64 a[148:149], v6 offset:2944
ds_read_b64 a[150:151], v6 offset:2952
v_mfma_f32_16x16x32_bf16 v[152:155], a[160:163], a[248:251], v[152:155]
v_mfma_f32_16x16x32_bf16 v[152:155], a[164:167], a[244:247], v[152:155]
s_lshr_b32 s69, s12, 18
v_mfma_f32_16x16x32_bf16 v[152:155], a[168:171], a[240:243], v[152:155]
s_lshl_b32 s69, s69, 12
ds_read_b128 a[216:219], v7 offset:896
ds_read_b64 a[152:153], v6 offset:3456
v_mfma_f32_16x16x32_bf16 v[152:155], a[172:175], a[236:239], v[152:155]
s_add_u32 s69, s69, s95
buffer_load_dwordx4 a[0:3], v4, s[44:47], s69 offen sc1
v_mfma_f32_16x16x32_bf16 v[152:155], a[176:179], a[232:235], v[152:155]
s_nop 0
ds_read_b64 a[154:155], v6 offset:3464
ds_read_b128 a[220:223], v7 offset:384
v_mfma_f32_16x16x32_bf16 v[152:155], a[180:183], a[228:231], v[152:155]
v_mfma_f32_16x16x32_bf16 v[152:155], a[184:187], a[224:227], v[152:155]
v_mfma_f32_16x16x32_bf16 v[156:159], a[188:191], a[224:227], v[156:159]
s_nop 0
ds_read_b64 a[156:157], v6 offset:3968
ds_read_b64 a[158:159], v6 offset:3976
v_mfma_f32_16x16x32_bf16 v[156:159], a[184:187], a[228:231], v[156:159]
buffer_load_dwordx4 a[4:7], v4, s[44:47], s69 offen offset:1024 sc1
v_mfma_f32_16x16x32_bf16 v[156:159], a[180:183], a[232:235], v[156:159]
v_mfma_f32_16x16x32_bf16 v[156:159], a[176:179], a[236:239], v[156:159]
v_mfma_f32_16x16x32_bf16 v[156:159], a[172:175], a[240:243], v[156:159]
v_mfma_f32_16x16x32_bf16 v[156:159], a[168:171], a[244:247], v[156:159]
buffer_load_dwordx4 a[8:11], v4, s[44:47], s69 offen offset:2048 sc1
v_mfma_f32_16x16x32_bf16 v[156:159], a[164:167], a[248:251], v[156:159]
v_mfma_f32_16x16x32_bf16 v[156:159], a[160:163], a[252:255], v[156:159]
s_waitcnt lgkmcnt(0)
v_mfma_f32_16x16x32_bf16 v[128:131], a[128:131], a[192:195], v[128:131]
s_nop 0
ds_read_b128 a[224:227], v7 offset:4032
ds_read_b64 a[160:161], v6 offset:448
v_mfma_f32_16x16x32_bf16 v[132:135], a[132:135], a[192:195], v[132:135]
v_mfma_f32_16x16x32_bf16 v[132:135], a[128:131], a[196:199], v[132:135]
s_nop 0
ds_read_b64 a[162:163], v6 offset:456
ds_read_b128 a[228:231], v7 offset:3520
v_mfma_f32_16x16x32_bf16 v[136:139], a[128:131], a[200:203], v[136:139]
buffer_load_dwordx4 a[12:15], v4, s[44:47], s69 offen offset:3072 sc1
v_mfma_f32_16x16x32_bf16 v[136:139], a[132:135], a[196:199], v[136:139]
v_mfma_f32_16x16x32_bf16 v[136:139], a[136:139], a[192:195], v[136:139]
s_nop 0
ds_read_b64 a[164:165], v6 offset:960
ds_read_b64 a[166:167], v6 offset:968
v_mfma_f32_16x16x32_bf16 v[140:143], a[140:143], a[192:195], v[140:143]
v_mfma_f32_16x16x32_bf16 v[140:143], a[136:139], a[196:199], v[140:143]
s_nop 0
ds_read_b128 a[232:235], v7 offset:3008
ds_read_b64 a[168:169], v6 offset:1472
v_mfma_f32_16x16x32_bf16 v[140:143], a[132:135], a[200:203], v[140:143]
s_add_u32 s69, s69, 0x20000
buffer_load_dwordx4 a[16:19], v4, s[44:47], s69 offen sc1
v_mfma_f32_16x16x32_bf16 v[140:143], a[128:131], a[204:207], v[140:143]
v_mfma_f32_16x16x32_bf16 v[144:147], a[128:131], a[208:211], v[144:147]
s_nop 0
ds_read_b64 a[170:171], v6 offset:1480
ds_read_b128 a[236:239], v7 offset:2496
v_mfma_f32_16x16x32_bf16 v[144:147], a[132:135], a[204:207], v[144:147]
v_mfma_f32_16x16x32_bf16 v[144:147], a[136:139], a[200:203], v[144:147]
s_nop 0
ds_read_b64 a[172:173], v6 offset:1984
ds_read_b64 a[174:175], v6 offset:1992
v_mfma_f32_16x16x32_bf16 v[144:147], a[140:143], a[196:199], v[144:147]
buffer_load_dwordx4 a[20:23], v4, s[44:47], s69 offen offset:1024 sc1
v_mfma_f32_16x16x32_bf16 v[144:147], a[144:147], a[192:195], v[144:147]
v_mfma_f32_16x16x32_bf16 v[148:151], a[148:151], a[192:195], v[148:151]
s_nop 0
ds_read_b128 a[240:243], v7 offset:1984
ds_read_b64 a[176:177], v6 offset:2496
v_mfma_f32_16x16x32_bf16 v[148:151], a[144:147], a[196:199], v[148:151]
v_mfma_f32_16x16x32_bf16 v[148:151], a[140:143], a[200:203], v[148:151]
v_mfma_f32_16x16x32_bf16 v[148:151], a[136:139], a[204:207], v[148:151]
s_nop 0
ds_read_b64 a[178:179], v6 offset:2504
ds_read_b128 a[244:247], v7 offset:1472
v_mfma_f32_16x16x32_bf16 v[148:151], a[132:135], a[208:211], v[148:151]
buffer_load_dwordx4 a[24:27], v4, s[44:47], s69 offen offset:2048 sc1
v_mfma_f32_16x16x32_bf16 v[148:151], a[128:131], a[212:215], v[148:151]
s_nop 0
ds_read_b64 a[180:181], v6 offset:3008
ds_read_b64 a[182:183], v6 offset:3016
v_mfma_f32_16x16x32_bf16 v[152:155], a[128:131], a[216:219], v[152:155]
v_mfma_f32_16x16x32_bf16 v[152:155], a[132:135], a[212:215], v[152:155]
v_mfma_f32_16x16x32_bf16 v[152:155], a[136:139], a[208:211], v[152:155]
s_nop 0
ds_read_b128 a[248:251], v7 offset:960
ds_read_b64 a[184:185], v6 offset:3520
v_mfma_f32_16x16x32_bf16 v[152:155], a[140:143], a[204:207], v[152:155]
buffer_load_dwordx4 a[28:31], v4, s[44:47], s69 offen offset:3072 sc1
v_mfma_f32_16x16x32_bf16 v[152:155], a[144:147], a[200:203], v[152:155]
s_nop 0
ds_read_b64 a[186:187], v6 offset:3528
ds_read_b128 a[252:255], v7 offset:448
v_mfma_f32_16x16x32_bf16 v[152:155], a[148:151], a[196:199], v[152:155]
v_mfma_f32_16x16x32_bf16 v[152:155], a[152:155], a[192:195], v[152:155]
s_lshr_b32 s69, s13, 18
v_mfma_f32_16x16x32_bf16 v[156:159], a[156:159], a[192:195], v[156:159]
s_lshl_b32 s69, s69, 12
ds_read_b64 a[188:189], v6 offset:4032
ds_read_b64 a[190:191], v6 offset:4040
v_mfma_f32_16x16x32_bf16 v[156:159], a[152:155], a[196:199], v[156:159]
s_add_u32 s69, s69, s95
buffer_load_dwordx4 a[32:35], v4, s[44:47], s69 offen sc1
v_mfma_f32_16x16x32_bf16 v[156:159], a[148:151], a[200:203], v[156:159]
v_mfma_f32_16x16x32_bf16 v[156:159], a[144:147], a[204:207], v[156:159]
v_mfma_f32_16x16x32_bf16 v[156:159], a[140:143], a[208:211], v[156:159]
v_mfma_f32_16x16x32_bf16 v[156:159], a[136:139], a[212:215], v[156:159]
buffer_load_dwordx4 a[36:39], v4, s[44:47], s69 offen offset:1024 sc1
v_mfma_f32_16x16x32_bf16 v[156:159], a[132:135], a[216:219], v[156:159]
v_mfma_f32_16x16x32_bf16 v[156:159], a[128:131], a[220:223], v[156:159]
s_waitcnt lgkmcnt(0)
v_mfma_f32_16x16x32_bf16 v[128:131], a[160:163], a[224:227], v[128:131]
s_nop 0
ds_read_b64_tr_b16 v[192:193], v8 offset:0
ds_read_b64_tr_b16 v[194:195], v8 offset:2048
v_mfma_f32_16x16x32_bf16 v[132:135], a[164:167], a[224:227], v[132:135]
v_mfma_f32_16x16x32_bf16 v[132:135], a[160:163], a[228:231], v[132:135]
s_nop 0
ds_read_b64_tr_b16 v[196:197], v9 offset:0
ds_read_b64_tr_b16 v[198:199], v9 offset:2048
v_mfma_f32_16x16x32_bf16 v[136:139], a[160:163], a[232:235], v[136:139]
buffer_load_dwordx4 a[40:43], v4, s[44:47], s69 offen offset:2048 sc1
v_mfma_f32_16x16x32_bf16 v[136:139], a[164:167], a[228:231], v[136:139]
s_nop 0
ds_read_b64_tr_b16 v[200:201], v10 offset:0
ds_read_b64_tr_b16 v[202:203], v10 offset:2048
v_mfma_f32_16x16x32_bf16 v[136:139], a[168:171], a[224:227], v[136:139]
v_mfma_f32_16x16x32_bf16 v[140:143], a[172:175], a[224:227], v[140:143]
s_nop 0
ds_read_b64_tr_b16 v[204:205], v11 offset:0
ds_read_b64_tr_b16 v[206:207], v11 offset:2048
v_mfma_f32_16x16x32_bf16 v[140:143], a[168:171], a[228:231], v[140:143]
v_cvt_pk_bf16_f32 v128, v128, v129
v_cvt_pk_bf16_f32 v129, v130, v131
v_cvt_pk_bf16_f32 v130, v132, v133
v_mfma_f32_16x16x32_bf16 v[140:143], a[164:167], a[232:235], v[140:143]
s_nop 0
ds_read_b64_tr_b16 v[208:209], v8 offset:4096
ds_read_b64_tr_b16 v[210:211], v8 offset:6144
v_cvt_pk_bf16_f32 v131, v134, v135
v_mfma_f32_16x16x32_bf16 v[140:143], a[160:163], a[236:239], v[140:143]
s_nop 0
buffer_load_dwordx4 a[44:47], v4, s[44:47], s69 offen offset:3072 sc1
v_permlane32_swap_b32 v128, v130
v_mfma_f32_16x16x32_bf16 v[144:147], a[160:163], a[240:243], v[144:147]
s_nop 0
ds_read_b64_tr_b16 v[212:213], v9 offset:4096
ds_read_b64_tr_b16 v[214:215], v9 offset:6144
v_permlane32_swap_b32 v129, v131
v_mfma_f32_16x16x32_bf16 v[144:147], a[164:167], a[236:239], v[144:147]
buffer_store_dwordx4 v[128:131], v166, s[44:47], s80 offen sc1
v_mfma_f32_16x16x32_bf16 v[144:147], a[168:171], a[232:235], v[144:147]
s_nop 0
ds_read_b64_tr_b16 v[216:217], v10 offset:4096
ds_read_b64_tr_b16 v[218:219], v10 offset:6144
v_mfma_f32_16x16x32_bf16 v[144:147], a[172:175], a[228:231], v[144:147]
s_add_u32 s69, s69, 0x20000
buffer_load_dwordx4 a[48:51], v4, s[44:47], s69 offen sc1
v_mfma_f32_16x16x32_bf16 v[144:147], a[176:179], a[224:227], v[144:147]
s_nop 0
ds_read_b64_tr_b16 v[220:221], v11 offset:4096
ds_read_b64_tr_b16 v[222:223], v11 offset:6144
v_cvt_pk_bf16_f32 v136, v136, v137
v_mfma_f32_16x16x32_bf16 v[148:151], a[180:183], a[224:227], v[148:151]
v_cvt_pk_bf16_f32 v137, v138, v139
v_cvt_pk_bf16_f32 v138, v140, v141
v_cvt_pk_bf16_f32 v139, v142, v143
v_mfma_f32_16x16x32_bf16 v[148:151], a[176:179], a[228:231], v[148:151]
s_nop 0
ds_read_b64_tr_b16 v[224:225], v8 offset:8192
ds_read_b64_tr_b16 v[226:227], v8 offset:10240
v_permlane32_swap_b32 v136, v138
v_mfma_f32_16x16x32_bf16 v[148:151], a[172:175], a[232:235], v[148:151]
v_permlane32_swap_b32 v137, v139
v_mfma_f32_16x16x32_bf16 v[148:151], a[168:171], a[236:239], v[148:151]
s_nop 0
ds_read_b64_tr_b16 v[228:229], v9 offset:8192
ds_read_b64_tr_b16 v[230:231], v9 offset:10240
v_mfma_f32_16x16x32_bf16 v[148:151], a[164:167], a[240:243], v[148:151]
buffer_load_dwordx4 a[52:55], v4, s[44:47], s69 offen offset:1024 sc1
v_mfma_f32_16x16x32_bf16 v[148:151], a[160:163], a[244:247], v[148:151]
s_nop 0
ds_read_b64_tr_b16 v[232:233], v10 offset:8192
ds_read_b64_tr_b16 v[234:235], v10 offset:10240
v_mfma_f32_16x16x32_bf16 v[152:155], a[160:163], a[248:251], v[152:155]
buffer_store_dwordx4 v[136:139], v166, s[44:47], s80 offen offset:1024 sc1
v_mfma_f32_16x16x32_bf16 v[152:155], a[164:167], a[244:247], v[152:155]
s_nop 0
ds_read_b64_tr_b16 v[236:237], v11 offset:8192
ds_read_b64_tr_b16 v[238:239], v11 offset:10240
v_mfma_f32_16x16x32_bf16 v[152:155], a[168:171], a[240:243], v[152:155]
buffer_load_dwordx4 a[56:59], v4, s[44:47], s69 offen offset:2048 sc1
v_mfma_f32_16x16x32_bf16 v[152:155], a[172:175], a[236:239], v[152:155]
s_nop 0
ds_read_b64_tr_b16 v[240:241], v8 offset:12288
ds_read_b64_tr_b16 v[242:243], v8 offset:14336
v_mfma_f32_16x16x32_bf16 v[152:155], a[176:179], a[232:235], v[152:155]
v_cvt_pk_bf16_f32 v144, v144, v145
v_cvt_pk_bf16_f32 v145, v146, v147
v_cvt_pk_bf16_f32 v146, v148, v149
v_mfma_f32_16x16x32_bf16 v[152:155], a[180:183], a[228:231], v[152:155]
s_nop 0
ds_read_b64_tr_b16 v[244:245], v9 offset:12288
ds_read_b64_tr_b16 v[246:247], v9 offset:14336
v_cvt_pk_bf16_f32 v147, v150, v151
v_mfma_f32_16x16x32_bf16 v[152:155], a[184:187], a[224:227], v[152:155]
v_permlane32_swap_b32 v144, v146
v_permlane32_swap_b32 v145, v147
v_mfma_f32_16x16x32_bf16 v[156:159], a[188:191], a[224:227], v[156:159]
s_nop 0
ds_read_b64_tr_b16 v[248:249], v10 offset:12288
ds_read_b64_tr_b16 v[250:251], v10 offset:14336
v_mfma_f32_16x16x32_bf16 v[156:159], a[184:187], a[228:231], v[156:159]
buffer_load_dwordx4 a[60:63], v4, s[44:47], s69 offen offset:3072 sc1
v_mfma_f32_16x16x32_bf16 v[156:159], a[180:183], a[232:235], v[156:159]
s_nop 0
ds_read_b64_tr_b16 v[252:253], v11 offset:12288
ds_read_b64_tr_b16 v[254:255], v11 offset:14336
v_mfma_f32_16x16x32_bf16 v[156:159], a[176:179], a[236:239], v[156:159]
buffer_store_dwordx4 v[144:147], v166, s[44:47], s80 offen offset:2048 sc1
v_mfma_f32_16x16x32_bf16 v[156:159], a[172:175], a[240:243], v[156:159]
v_mfma_f32_16x16x32_bf16 v[156:159], a[168:171], a[244:247], v[156:159]
v_mfma_f32_16x16x32_bf16 v[156:159], a[164:167], a[248:251], v[156:159]
v_mfma_f32_16x16x32_bf16 v[156:159], a[160:163], a[252:255], v[156:159]
v_cvt_pk_bf16_f32 v152, v152, v153
v_cvt_pk_bf16_f32 v153, v154, v155
s_nop 5
v_cvt_pk_bf16_f32 v154, v156, v157
v_cvt_pk_bf16_f32 v155, v158, v159
s_nop 0
v_permlane32_swap_b32 v152, v154
v_permlane32_swap_b32 v153, v155
buffer_store_dwordx4 v[152:155], v166, s[44:47], s80 offen offset:3072 sc1
s_waitcnt vmcnt(12) lgkmcnt(0)
s_cmp_lg_u32 s81, 0
s_cbranch_scc1 Lredo0
Lredo0b:
s_barrier
LEe:
v_mfma_f32_16x16x32_bf16 v[16:19], v[192:195], a[0:3], 0
s_nop 0
ds_read_b64_tr_b16 v[128:129], v8 offset:16384
ds_read_b64_tr_b16 v[130:131], v8 offset:18432
Lstube0:
s_cbranch_execz Lstube4
v_mfma_f32_16x16x32_bf16 v[16:19], v[208:211], a[4:7], v[16:19]
s_xor_b32 s71, s13, 0x100
ds_read_b64_tr_b16 v[132:133], v9 offset:16384
ds_read_b64_tr_b16 v[134:135], v9 offset:18432
v_mfma_f32_16x16x32_bf16 v[16:19], v[224:227], a[8:11], v[16:19]
s_add_u32 m0, s85, 0
ds_read_b64_tr_b16 v[136:137], v10 offset:16384
ds_read_b64_tr_b16 v[138:139], v10 offset:18432
v_mfma_f32_16x16x32_bf16 v[16:19], v[240:243], a[12:15], v[16:19]
s_add_u32 s72, s71, 0
buffer_load_dwordx4 v15, s[24:27], s72 offen lds
v_mfma_f32_16x16x32_bf16 v[32:35], v[240:243], a[28:31], 0
s_nop 0
ds_read_b64_tr_b16 v[140:141], v11 offset:16384
ds_read_b64_tr_b16 v[142:143], v11 offset:18432
v_mfma_f32_16x16x32_bf16 v[32:35], v[224:227], a[24:27], v[32:35]
s_lshr_b32 s69, s14, 18
v_add_u32 v4, s64, v1
v_add_u32 v4, 131072, v4
v_mfma_f32_16x16x32_bf16 v[32:35], v[208:211], a[20:23], v[32:35]
s_lshl_b32 s69, s69, 12
ds_read_b64_tr_b16 v[144:145], v8 offset:20480
ds_read_b64_tr_b16 v[146:147], v8 offset:22528
v_mfma_f32_16x16x32_bf16 v[32:35], v[192:195], a[16:19], v[32:35]
s_add_u32 s69, s69, s95
buffer_load_dwordx4 a[64:67], v1, s[44:47], s69 offen sc1
v_mfma_f32_16x16x32_bf16 v[36:39], v[196:199], a[16:19], 0
s_lshl_b32 s70, s75, 18
ds_read_b64_tr_b16 v[148:149], v9 offset:20480
ds_read_b64_tr_b16 v[150:151], v9 offset:22528
v_mfma_f32_16x16x32_bf16 v[36:39], v[212:215], a[20:23], v[36:39]
s_add_u32 s70, s70, s94
ds_read_b64_tr_b16 v[152:153], v10 offset:20480
ds_read_b64_tr_b16 v[154:155], v10 offset:22528
v_mfma_f32_16x16x32_bf16 v[36:39], v[228:231], a[24:27], v[36:39]
ds_write_b128 v4, v[80:83] offset:0
v_mfma_f32_16x16x32_bf16 v[36:39], v[244:247], a[28:31], v[36:39]
s_add_u32 s72, s71, 15360
buffer_load_dwordx4 v15, s[24:27], s72 offen offset:1024 lds
v_mfma_f32_16x16x32_bf16 v[20:23], v[244:247], a[12:15], 0
s_nop 0
ds_read_b64_tr_b16 v[156:157], v11 offset:20480
ds_read_b64_tr_b16 v[158:159], v11 offset:22528
v_mfma_f32_16x16x32_bf16 v[20:23], v[228:231], a[8:11], v[20:23]
s_nop 0
ds_read_b64_tr_b16 v[160:161], v8 offset:24576
ds_read_b64_tr_b16 v[162:163], v8 offset:26624
v_mfma_f32_16x16x32_bf16 v[20:23], v[212:215], a[4:7], v[20:23]
s_nop 0
ds_read_b64_tr_b16 v[164:165], v9 offset:24576
ds_read_b64_tr_b16 v[166:167], v9 offset:26624
v_mfma_f32_16x16x32_bf16 v[20:23], v[196:199], a[0:3], v[20:23]
buffer_load_dwordx4 a[68:71], v1, s[44:47], s69 offen offset:1024 sc1
v_mfma_f32_16x16x32_bf16 v[24:27], v[200:203], a[0:3], 0
ds_write_b128 v4, v[84:87] offset:1024
v_mfma_f32_16x16x32_bf16 v[24:27], v[216:219], a[4:7], v[24:27]
s_nop 0
ds_read_b64_tr_b16 v[168:169], v10 offset:24576
ds_read_b64_tr_b16 v[170:171], v10 offset:26624
v_mfma_f32_16x16x32_bf16 v[24:27], v[232:235], a[8:11], v[24:27]
s_nop 0
ds_read_b64_tr_b16 v[172:173], v11 offset:24576
ds_read_b64_tr_b16 v[174:175], v11 offset:26624
v_mfma_f32_16x16x32_bf16 v[24:27], v[248:251], a[12:15], v[24:27]
s_add_u32 s72, s71, 30720
buffer_load_dwordx4 v15, s[24:27], s72 offen offset:2048 lds
v_mfma_f32_16x16x32_bf16 v[40:43], v[248:251], a[28:31], 0
s_nop 0
ds_read_b64_tr_b16 v[176:177], v8 offset:28672
ds_read_b64_tr_b16 v[178:179], v8 offset:30720
v_mfma_f32_16x16x32_bf16 v[40:43], v[232:235], a[24:27], v[40:43]
ds_write_b128 v4, v[96:99] offset:2048
v_mfma_f32_16x16x32_bf16 v[40:43], v[216:219], a[20:23], v[40:43]
s_nop 0
ds_read_b64_tr_b16 v[180:181], v9 offset:28672
ds_read_b64_tr_b16 v[182:183], v9 offset:30720
v_mfma_f32_16x16x32_bf16 v[40:43], v[200:203], a[16:19], v[40:43]
s_nop 0
ds_read_b64_tr_b16 v[184:185], v10 offset:28672
ds_read_b64_tr_b16 v[186:187], v10 offset:30720
v_mfma_f32_16x16x32_bf16 v[44:47], v[204:207], a[16:19], 0
s_add_u32 s72, s71, 46080
buffer_load_dwordx4 v15, s[24:27], s72 offen offset:3072 lds
v_mfma_f32_16x16x32_bf16 v[44:47], v[220:223], a[20:23], v[44:47]
s_nop 0
ds_read_b64_tr_b16 v[188:189], v11 offset:28672
ds_read_b64_tr_b16 v[190:191], v11 offset:30720
v_mfma_f32_16x16x32_bf16 v[44:47], v[236:239], a[24:27], v[44:47]
ds_write_b128 v4, v[100:103] offset:3072
v_mfma_f32_16x16x32_bf16 v[44:47], v[252:255], a[28:31], v[44:47]
v_mfma_f32_16x16x32_bf16 v[28:31], v[252:255], a[12:15], 0
s_xor_b32 s71, s13, 0x180
buffer_load_dwordx4 a[72:75], v1, s[44:47], s69 offen offset:2048 sc1
v_mfma_f32_16x16x32_bf16 v[28:31], v[236:239], a[8:11], v[28:31]
s_add_u32 m0, s85, 16384
v_mfma_f32_16x16x32_bf16 v[28:31], v[220:223], a[4:7], v[28:31]
s_waitcnt vmcnt(31) lgkmcnt(0)
v_mfma_f32_16x16x32_bf16 v[28:31], v[204:207], a[0:3], v[28:31]
s_barrier
v_mfma_f32_16x16x32_bf16 v[48:51], v[128:131], a[0:3], 0
s_add_u32 s72, s71, 0
buffer_load_dwordx4 v15, s[24:27], s72 offen lds
v_mfma_f32_16x16x32_bf16 v[48:51], v[144:147], a[4:7], v[48:51]
s_nop 0
ds_read_b64_tr_b16 v[192:193], v8 offset:32768
ds_read_b64_tr_b16 v[194:195], v8 offset:34816
v_mfma_f32_16x16x32_bf16 v[48:51], v[160:163], a[8:11], v[48:51]
s_nop 0
ds_read_b64_tr_b16 v[196:197], v9 offset:32768
ds_read_b64_tr_b16 v[198:199], v9 offset:34816
v_mfma_f32_16x16x32_bf16 v[48:51], v[176:179], a[12:15], v[48:51]
s_nop 0
ds_read_b64_tr_b16 v[200:201], v10 offset:32768
ds_read_b64_tr_b16 v[202:203], v10 offset:34816
v_mfma_f32_16x16x32_bf16 v[64:67], v[176:179], a[28:31], 0
buffer_load_dwordx4 a[76:79], v1, s[44:47], s69 offen offset:3072 sc1
v_mfma_f32_16x16x32_bf16 v[64:67], v[160:163], a[24:27], v[64:67]
s_nop 0
ds_read_b64_tr_b16 v[204:205], v11 offset:32768
ds_read_b64_tr_b16 v[206:207], v11 offset:34816
v_mfma_f32_16x16x32_bf16 v[64:67], v[144:147], a[20:23], v[64:67]
v_mfma_f32_16x16x32_bf16 v[64:67], v[128:131], a[16:19], v[64:67]
s_nop 0
ds_read_b64_tr_b16 v[208:209], v8 offset:36864
ds_read_b64_tr_b16 v[210:211], v8 offset:38912
v_mfma_f32_16x16x32_bf16 v[68:71], v[132:135], a[16:19], 0
s_add_u32 s72, s71, 15360
buffer_load_dwordx4 v15, s[24:27], s72 offen offset:1024 lds
v_mfma_f32_16x16x32_bf16 v[68:71], v[148:151], a[20:23], v[68:71]
s_nop 0
ds_read_b64_tr_b16 v[212:213], v9 offset:36864
ds_read_b64_tr_b16 v[214:215], v9 offset:38912
v_mfma_f32_16x16x32_bf16 v[68:71], v[164:167], a[24:27], v[68:71]
s_nop 0
ds_read_b64_tr_b16 v[216:217], v10 offset:36864
ds_read_b64_tr_b16 v[218:219], v10 offset:38912
v_mfma_f32_16x16x32_bf16 v[68:71], v[180:183], a[28:31], v[68:71]
s_nop 0
ds_read_b64_tr_b16 v[220:221], v11 offset:36864
ds_read_b64_tr_b16 v[222:223], v11 offset:38912
v_mfma_f32_16x16x32_bf16 v[52:55], v[180:183], a[12:15], 0
v_mfma_f32_16x16x32_bf16 v[52:55], v[164:167], a[8:11], v[52:55]
s_add_u32 s69, s69, 0x20000
buffer_load_dwordx4 a[80:83], v1, s[44:47], s69 offen sc1
v_mfma_f32_16x16x32_bf16 v[52:55], v[148:151], a[4:7], v[52:55]
s_nop 0
ds_read_b64_tr_b16 v[224:225], v8 offset:40960
ds_read_b64_tr_b16 v[226:227], v8 offset:43008
v_mfma_f32_16x16x32_bf16 v[52:55], v[132:135], a[0:3], v[52:55]
s_nop 0
ds_read_b64_tr_b16 v[228:229], v9 offset:40960
ds_read_b64_tr_b16 v[230:231], v9 offset:43008
v_mfma_f32_16x16x32_bf16 v[56:59], v[136:139], a[0:3], 0
s_nop 0
ds_read_b64_tr_b16 v[232:233], v10 offset:40960
ds_read_b64_tr_b16 v[234:235], v10 offset:43008
v_mfma_f32_16x16x32_bf16 v[56:59], v[152:155], a[4:7], v[56:59]
s_add_u32 s72, s71, 30720
buffer_load_dwordx4 v15, s[24:27], s72 offen offset:2048 lds
v_mfma_f32_16x16x32_bf16 v[56:59], v[168:171], a[8:11], v[56:59]
s_nop 0
ds_read_b64_tr_b16 v[236:237], v11 offset:40960
ds_read_b64_tr_b16 v[238:239], v11 offset:43008
v_mfma_f32_16x16x32_bf16 v[56:59], v[184:187], a[12:15], v[56:59]
v_mfma_f32_16x16x32_bf16 v[72:75], v[184:187], a[28:31], 0
s_nop 0
ds_read_b64_tr_b16 v[240:241], v8 offset:45056
ds_read_b64_tr_b16 v[242:243], v8 offset:47104
v_mfma_f32_16x16x32_bf16 v[72:75], v[168:171], a[24:27], v[72:75]
s_nop 0
ds_read_b64_tr_b16 v[244:245], v9 offset:45056
ds_read_b64_tr_b16 v[246:247], v9 offset:47104
v_mfma_f32_16x16x32_bf16 v[72:75], v[152:155], a[20:23], v[72:75]
s_add_u32 s72, s71, 46080
buffer_load_dwordx4 v15, s[24:27], s72 offen offset:3072 lds
v_mfma_f32_16x16x32_bf16 v[72:75], v[136:139], a[16:19], v[72:75]
s_nop 0
ds_read_b64_tr_b16 v[248:249], v10 offset:45056
ds_read_b64_tr_b16 v[250:251], v10 offset:47104
v_mfma_f32_16x16x32_bf16 v[76:79], v[140:143], a[16:19], 0
s_nop 0
ds_read_b64_tr_b16 v[252:253], v11 offset:45056
ds_read_b64_tr_b16 v[254:255], v11 offset:47104
v_mfma_f32_16x16x32_bf16 v[76:79], v[156:159], a[20:23], v[76:79]
v_mfma_f32_16x16x32_bf16 v[76:79], v[172:175], a[24:27], v[76:79]
buffer_load_dwordx4 a[84:87], v1, s[44:47], s69 offen offset:1024 sc1
v_mfma_f32_16x16x32_bf16 v[76:79], v[188:191], a[28:31], v[76:79]
s_xor_b32 s71, s14, 0x80
v_mfma_f32_16x16x32_bf16 v[60:63], v[188:191], a[12:15], 0
s_add_u32 m0, s85, 32768
v_mfma_f32_16x16x32_bf16 v[60:63], v[172:175], a[8:11], v[60:63]
s_add_u32 s72, s71, 0
v_mfma_f32_16x16x32_bf16 v[60:63], v[156:159], a[4:7], v[60:63]
s_waitcnt vmcnt(34) lgkmcnt(0)
buffer_load_dwordx4 v15, s[24:27], s72 offen lds
v_mfma_f32_16x16x32_bf16 v[60:63], v[140:143], a[0:3], v[60:63]
s_barrier
v_mfma_f32_16x16x32_bf16 v[80:83], v[192:195], a[0:3], 0
s_nop 0
ds_read_b64_tr_b16 v[128:129], v8 offset:49152
ds_read_b64_tr_b16 v[130:131], v8 offset:51200
v_mfma_f32_16x16x32_bf16 v[80:83], v[208:211], a[4:7], v[80:83]
s_nop 0
ds_read_b64_tr_b16 v[132:133], v9 offset:49152
ds_read_b64_tr_b16 v[134:135], v9 offset:51200
v_mfma_f32_16x16x32_bf16 v[80:83], v[224:227], a[8:11], v[80:83]
buffer_load_dwordx4 a[88:91], v1, s[44:47], s69 offen offset:2048 sc1
v_mfma_f32_16x16x32_bf16 v[80:83], v[240:243], a[12:15], v[80:83]
s_nop 0
ds_read_b64_tr_b16 v[136:137], v10 offset:49152
ds_read_b64_tr_b16 v[138:139], v10 offset:51200
v_mfma_f32_16x16x32_bf16 v[96:99], v[240:243], a[28:31], 0
s_nop 0
ds_read_b64_tr_b16 v[140:141], v11 offset:49152
ds_read_b64_tr_b16 v[142:143], v11 offset:51200
v_mfma_f32_16x16x32_bf16 v[96:99], v[224:227], a[24:27], v[96:99]
v_mfma_f32_16x16x32_bf16 v[96:99], v[208:211], a[20:23], v[96:99]
s_add_u32 s72, s71, 15360
buffer_load_dwordx4 v15, s[24:27], s72 offen offset:1024 lds
v_mfma_f32_16x16x32_bf16 v[96:99], v[192:195], a[16:19], v[96:99]
s_nop 0
ds_read_b64_tr_b16 v[144:145], v8 offset:53248
ds_read_b64_tr_b16 v[146:147], v8 offset:55296
v_mfma_f32_16x16x32_bf16 v[100:103], v[196:199], a[16:19], 0
s_nop 0
ds_read_b64_tr_b16 v[148:149], v9 offset:53248
ds_read_b64_tr_b16 v[150:151], v9 offset:55296
v_mfma_f32_16x16x32_bf16 v[100:103], v[212:215], a[20:23], v[100:103]
s_nop 0
ds_read_b64_tr_b16 v[152:153], v10 offset:53248
ds_read_b64_tr_b16 v[154:155], v10 offset:55296
v_mfma_f32_16x16x32_bf16 v[100:103], v[228:231], a[24:27], v[100:103]
v_mfma_f32_16x16x32_bf16 v[100:103], v[244:247], a[28:31], v[100:103]
buffer_load_dwordx4 a[92:95], v1, s[44:47], s69 offen offset:3072 sc1
v_mfma_f32_16x16x32_bf16 v[84:87], v[244:247], a[12:15], 0
s_nop 0
ds_read_b64_tr_b16 v[156:157], v11 offset:53248
ds_read_b64_tr_b16 v[158:159], v11 offset:55296
v_mfma_f32_16x16x32_bf16 v[84:87], v[228:231], a[8:11], v[84:87]
s_nop 0
ds_read_b64_tr_b16 v[160:161], v8 offset:57344
ds_read_b64_tr_b16 v[162:163], v8 offset:59392
v_mfma_f32_16x16x32_bf16 v[84:87], v[212:215], a[4:7], v[84:87]
s_nop 0
ds_read_b64_tr_b16 v[164:165], v9 offset:57344
ds_read_b64_tr_b16 v[166:167], v9 offset:59392
v_mfma_f32_16x16x32_bf16 v[84:87], v[196:199], a[0:3], v[84:87]
s_add_u32 s72, s71, 30720
buffer_load_dwordx4 v15, s[24:27], s72 offen offset:2048 lds
v_mfma_f32_16x16x32_bf16 v[88:91], v[200:203], a[0:3], 0
v_mfma_f32_16x16x32_bf16 v[88:91], v[216:219], a[4:7], v[88:91]
s_nop 0
ds_read_b64_tr_b16 v[168:169], v10 offset:57344
ds_read_b64_tr_b16 v[170:171], v10 offset:59392
v_mfma_f32_16x16x32_bf16 v[88:91], v[232:235], a[8:11], v[88:91]
s_nop 0
ds_read_b64_tr_b16 v[172:173], v11 offset:57344
ds_read_b64_tr_b16 v[174:175], v11 offset:59392
v_mfma_f32_16x16x32_bf16 v[88:91], v[248:251], a[12:15], v[88:91]
s_nop 0
ds_read_b64_tr_b16 v[176:177], v8 offset:61440
ds_read_b64_tr_b16 v[178:179], v8 offset:63488
v_mfma_f32_16x16x32_bf16 v[104:107], v[248:251], a[28:31], 0
s_add_u32 s72, s71, 46080
buffer_load_dwordx4 v15, s[24:27], s72 offen offset:3072 lds
v_mfma_f32_16x16x32_bf16 v[104:107], v[232:235], a[24:27], v[104:107]
v_mfma_f32_16x16x32_bf16 v[104:107], v[216:219], a[20:23], v[104:107]
s_xor_b32 s82, s78, 4
ds_read_b64_tr_b16 v[180:181], v9 offset:61440
ds_read_b64_tr_b16 v[182:183], v9 offset:63488
v_mfma_f32_16x16x32_bf16 v[104:107], v[200:203], a[16:19], v[104:107]
s_lshl_b32 s82, s82, 10
ds_read_b64_tr_b16 v[184:185], v10 offset:61440
ds_read_b64_tr_b16 v[186:187], v10 offset:63488
v_mfma_f32_16x16x32_bf16 v[108:111], v[204:207], a[16:19], 0
s_add_u32 s82, s82, s74
buffer_load_dword v3, v2, s[44:47], s82 offen sc1
v_mfma_f32_16x16x32_bf16 v[108:111], v[220:223], a[20:23], v[108:111]
s_lshr_b32 s69, s15, 18
ds_read_b64_tr_b16 v[188:189], v11 offset:61440
ds_read_b64_tr_b16 v[190:191], v11 offset:63488
v_mfma_f32_16x16x32_bf16 v[108:111], v[236:239], a[24:27], v[108:111]
s_xor_b32 s71, s14, 0x100
v_mfma_f32_16x16x32_bf16 v[108:111], v[252:255], a[28:31], v[108:111]
s_add_u32 m0, s85, 49152
v_mfma_f32_16x16x32_bf16 v[92:95], v[252:255], a[12:15], 0
s_add_u32 s72, s71, 0
buffer_load_dwordx4 v15, s[24:27], s72 offen lds
v_xor_b32 v8, 0x10000, v8
v_mfma_f32_16x16x32_bf16 v[92:95], v[236:239], a[8:11], v[92:95]
s_lshl_b32 s69, s69, 12
v_xor_b32 v9, 0x10000, v9
v_mfma_f32_16x16x32_bf16 v[92:95], v[220:223], a[4:7], v[92:95]
s_waitcnt vmcnt(16) lgkmcnt(0)
v_xor_b32 v10, 0x10000, v10
v_mfma_f32_16x16x32_bf16 v[92:95], v[204:207], a[0:3], v[92:95]
s_barrier
v_xor_b32 v11, 0x10000, v11
v_mfma_f32_16x16x32_bf16 v[16:19], v[128:131], a[32:35], v[16:19]
s_add_u32 s69, s69, s95
buffer_load_dwordx4 a[96:99], v1, s[44:47], s69 offen sc1
v_mfma_f32_16x16x32_bf16 v[16:19], v[144:147], a[36:39], v[16:19]
s_nop 0
ds_read_b64_tr_b16 v[192:193], v8 offset:0
ds_read_b64_tr_b16 v[194:195], v8 offset:2048
v_mfma_f32_16x16x32_bf16 v[16:19], v[160:163], a[40:43], v[16:19]
s_nop 0
ds_read_b64_tr_b16 v[196:197], v9 offset:0
ds_read_b64_tr_b16 v[198:199], v9 offset:2048
v_mfma_f32_16x16x32_bf16 v[16:19], v[176:179], a[44:47], v[16:19]
s_nop 0
ds_read_b64_tr_b16 v[200:201], v10 offset:0
ds_read_b64_tr_b16 v[202:203], v10 offset:2048
v_mfma_f32_16x16x32_bf16 v[32:35], v[176:179], a[60:63], v[32:35]
s_add_u32 s72, s71, 15360
buffer_load_dwordx4 v15, s[24:27], s72 offen offset:1024 lds
v_mfma_f32_16x16x32_bf16 v[32:35], v[160:163], a[56:59], v[32:35]
s_nop 0
ds_read_b64_tr_b16 v[204:205], v11 offset:0
ds_read_b64_tr_b16 v[206:207], v11 offset:2048
v_mfma_f32_16x16x32_bf16 v[32:35], v[144:147], a[52:55], v[32:35]
v_or_b32 v112, s58, v0
v_mov_b32 v113, 3
v_mfma_f32_16x16x32_bf16 v[32:35], v[128:131], a[48:51], v[32:35]
s_nop 0
ds_read_b64_tr_b16 v[208:209], v8 offset:4096
ds_read_b64_tr_b16 v[210:211], v8 offset:6144
v_mfma_f32_16x16x32_bf16 v[36:39], v[132:135], a[48:51], v[36:39]
s_nop 0
ds_read_b64_tr_b16 v[212:213], v9 offset:4096
ds_read_b64_tr_b16 v[214:215], v9 offset:6144
v_mfma_f32_16x16x32_bf16 v[36:39], v[148:151], a[52:55], v[36:39]
buffer_load_dwordx4 a[100:103], v1, s[44:47], s69 offen offset:1024 sc1
v_mfma_f32_16x16x32_bf16 v[36:39], v[164:167], a[56:59], v[36:39]
s_nop 0
ds_read_b64_tr_b16 v[216:217], v10 offset:4096
ds_read_b64_tr_b16 v[218:219], v10 offset:6144
v_mfma_f32_16x16x32_bf16 v[36:39], v[180:183], a[60:63], v[36:39]
s_nop 0
ds_read_b64_tr_b16 v[220:221], v11 offset:4096
ds_read_b64_tr_b16 v[222:223], v11 offset:6144
v_mfma_f32_16x16x32_bf16 v[20:23], v[180:183], a[44:47], v[20:23]
v_min_u32 v112, 1, v112
v_lshlrev_b32 v112, 30, v112
v_mfma_f32_16x16x32_bf16 v[20:23], v[164:167], a[40:43], v[20:23]
s_add_u32 s72, s71, 30720
buffer_load_dwordx4 v15, s[24:27], s72 offen offset:2048 lds
v_mfma_f32_16x16x32_bf16 v[20:23], v[148:151], a[36:39], v[20:23]
s_nop 0
ds_read_b64_tr_b16 v[224:225], v8 offset:8192
ds_read_b64_tr_b16 v[226:227], v8 offset:10240
v_mfma_f32_16x16x32_bf16 v[20:23], v[132:135], a[32:35], v[20:23]
s_nop 0
ds_read_b64_tr_b16 v[228:229], v9 offset:8192
ds_read_b64_tr_b16 v[230:231], v9 offset:10240
v_mfma_f32_16x16x32_bf16 v[24:27], v[136:139], a[32:35], v[24:27]
s_nop 0
ds_read_b64_tr_b16 v[232:233], v10 offset:8192
ds_read_b64_tr_b16 v[234:235], v10 offset:10240
v_mfma_f32_16x16x32_bf16 v[24:27], v[152:155], a[36:39], v[24:27]
s_add_u32 s72, s71, 46080
buffer_load_dwordx4 v15, s[24:27], s72 offen offset:3072 lds
v_mfma_f32_16x16x32_bf16 v[24:27], v[168:171], a[40:43], v[24:27]
s_nop 0
ds_read_b64_tr_b16 v[236:237], v11 offset:8192
ds_read_b64_tr_b16 v[238:239], v11 offset:10240
v_mfma_f32_16x16x32_bf16 v[24:27], v[184:187], a[44:47], v[24:27]
buffer_store_dword v113, v112, s[44:47], s91 offen sc1
v_mfma_f32_16x16x32_bf16 v[40:43], v[184:187], a[60:63], v[40:43]
s_nop 0
ds_read_b64_tr_b16 v[240:241], v8 offset:12288
ds_read_b64_tr_b16 v[242:243], v8 offset:14336
v_mfma_f32_16x16x32_bf16 v[40:43], v[168:171], a[56:59], v[40:43]
buffer_load_dwordx4 a[104:107], v1, s[44:47], s69 offen offset:2048 sc1
v_mfma_f32_16x16x32_bf16 v[40:43], v[152:155], a[52:55], v[40:43]
s_nop 0
ds_read_b64_tr_b16 v[244:245], v9 offset:12288
ds_read_b64_tr_b16 v[246:247], v9 offset:14336
v_mfma_f32_16x16x32_bf16 v[40:43], v[136:139], a[48:51], v[40:43]
s_xor_b32 s71, s14, 0x180
ds_read_b64_tr_b16 v[248:249], v10 offset:12288
ds_read_b64_tr_b16 v[250:251], v10 offset:14336
v_mfma_f32_16x16x32_bf16 v[44:47], v[140:143], a[48:51], v[44:47]
s_add_u32 m0, s77, 0
ds_read_b64_tr_b16 v[252:253], v11 offset:12288
ds_read_b64_tr_b16 v[254:255], v11 offset:14336
v_mfma_f32_16x16x32_bf16 v[44:47], v[156:159], a[52:55], v[44:47]
s_add_u32 s72, s71, 0
buffer_load_dwordx4 v15, s[24:27], s72 offen lds
v_mfma_f32_16x16x32_bf16 v[44:47], v[172:175], a[56:59], v[44:47]
v_mfma_f32_16x16x32_bf16 v[44:47], v[188:191], a[60:63], v[44:47]
v_mfma_f32_16x16x32_bf16 v[28:31], v[188:191], a[44:47], v[28:31]
v_mfma_f32_16x16x32_bf16 v[28:31], v[172:175], a[40:43], v[28:31]
buffer_load_dwordx4 a[108:111], v1, s[44:47], s69 offen offset:3072 sc1
v_mfma_f32_16x16x32_bf16 v[28:31], v[156:159], a[36:39], v[28:31]
s_waitcnt vmcnt(18) lgkmcnt(0)
v_mfma_f32_16x16x32_bf16 v[28:31], v[140:143], a[32:35], v[28:31]
s_barrier
v_mfma_f32_16x16x32_bf16 v[48:51], v[192:195], a[32:35], v[48:51]
s_nop 0
ds_read_b64_tr_b16 v[128:129], v8 offset:16384
ds_read_b64_tr_b16 v[130:131], v8 offset:18432
v_mfma_f32_16x16x32_bf16 v[48:51], v[208:211], a[36:39], v[48:51]
s_add_u32 s72, s71, 15360
buffer_load_dwordx4 v15, s[24:27], s72 offen offset:1024 lds
v_mfma_f32_16x16x32_bf16 v[48:51], v[224:227], a[40:43], v[48:51]
s_nop 0
ds_read_b64_tr_b16 v[132:133], v9 offset:16384
ds_read_b64_tr_b16 v[134:135], v9 offset:18432
v_mfma_f32_16x16x32_bf16 v[48:51], v[240:243], a[44:47], v[48:51]
s_nop 0
ds_read_b64_tr_b16 v[136:137], v10 offset:16384
ds_read_b64_tr_b16 v[138:139], v10 offset:18432
v_mfma_f32_16x16x32_bf16 v[64:67], v[240:243], a[60:63], v[64:67]
s_nop 0
ds_read_b64_tr_b16 v[140:141], v11 offset:16384
ds_read_b64_tr_b16 v[142:143], v11 offset:18432
v_mfma_f32_16x16x32_bf16 v[64:67], v[224:227], a[56:59], v[64:67]
v_and_b32 v120, 15, v0
v_lshrrev_b32 v121, 4, v0
v_mfma_f32_16x16x32_bf16 v[64:67], v[208:211], a[52:55], v[64:67]
s_nop 0
ds_read_b64_tr_b16 v[144:145], v8 offset:20480
ds_read_b64_tr_b16 v[146:147], v8 offset:22528
v_mfma_f32_16x16x32_bf16 v[64:67], v[192:195], a[48:51], v[64:67]
s_add_u32 s69, s69, 0x20000
buffer_load_dwordx4 a[112:115], v1, s[44:47], s69 offen sc1
v_mfma_f32_16x16x32_bf16 v[68:71], v[196:199], a[48:51], v[68:71]
s_nop 0
ds_read_b64_tr_b16 v[148:149], v9 offset:20480
ds_read_b64_tr_b16 v[150:151], v9 offset:22528
v_mfma_f32_16x16x32_bf16 v[68:71], v[212:215], a[52:55], v[68:71]
s_nop 0
ds_read_b64_tr_b16 v[152:153], v10 offset:20480
ds_read_b64_tr_b16 v[154:155], v10 offset:22528
v_mfma_f32_16x16x32_bf16 v[68:71], v[228:231], a[56:59], v[68:71]
v_lshlrev_b32 v121, 2, v121
v_sub_u32 v120, v120, v121
v_mfma_f32_16x16x32_bf16 v[68:71], v[244:247], a[60:63], v[68:71]
s_add_u32 s72, s71, 30720
buffer_load_dwordx4 v15, s[24:27], s72 offen offset:2048 lds
v_mfma_f32_16x16x32_bf16 v[52:55], v[244:247], a[44:47], v[52:55]
s_nop 0
ds_read_b64_tr_b16 v[156:157], v11 offset:20480
ds_read_b64_tr_b16 v[158:159], v11 offset:22528
v_mfma_f32_16x16x32_bf16 v[52:55], v[228:231], a[40:43], v[52:55]
s_nop 0
ds_read_b64_tr_b16 v[160:161], v8 offset:24576
ds_read_b64_tr_b16 v[162:163], v8 offset:26624
v_mfma_f32_16x16x32_bf16 v[52:55], v[212:215], a[36:39], v[52:55]
s_nop 0
ds_read_b64_tr_b16 v[164:165], v9 offset:24576
ds_read_b64_tr_b16 v[166:167], v9 offset:26624
v_mfma_f32_16x16x32_bf16 v[52:55], v[196:199], a[32:35], v[52:55]
s_add_u32 s72, s71, 46080
buffer_load_dwordx4 v15, s[24:27], s72 offen offset:3072 lds
v_mfma_f32_16x16x32_bf16 v[56:59], v[200:203], a[32:35], v[56:59]
v_min_u32 v120, 4, v120
v_lshlrev_b32 v120, 3, v120
v_mfma_f32_16x16x32_bf16 v[56:59], v[216:219], a[36:39], v[56:59]
s_nop 0
ds_read_b64_tr_b16 v[168:169], v10 offset:24576
ds_read_b64_tr_b16 v[170:171], v10 offset:26624
v_mfma_f32_16x16x32_bf16 v[56:59], v[232:235], a[40:43], v[56:59]
s_nop 0
ds_read_b64_tr_b16 v[172:173], v11 offset:24576
ds_read_b64_tr_b16 v[174:175], v11 offset:26624
v_mfma_f32_16x16x32_bf16 v[56:59], v[248:251], a[44:47], v[56:59]
buffer_load_dwordx4 a[116:119], v1, s[44:47], s69 offen offset:1024 sc1
v_mfma_f32_16x16x32_bf16 v[72:75], v[248:251], a[60:63], v[72:75]
s_nop 0
ds_read_b64_tr_b16 v[176:177], v8 offset:28672
ds_read_b64_tr_b16 v[178:179], v8 offset:30720
v_mfma_f32_16x16x32_bf16 v[72:75], v[232:235], a[56:59], v[72:75]
s_xor_b32 s71, s15, 0x80
v_mov_b32 v122, 0x3f80
v_mov_b32 v123, 0
v_mfma_f32_16x16x32_bf16 v[72:75], v[216:219], a[52:55], v[72:75]
s_add_u32 m0, s77, 16384
ds_read_b64_tr_b16 v[180:181], v9 offset:28672
ds_read_b64_tr_b16 v[182:183], v9 offset:30720
v_mfma_f32_16x16x32_bf16 v[72:75], v[200:203], a[48:51], v[72:75]
s_add_u32 s72, s71, 0
buffer_load_dwordx4 v15, s[24:27], s72 offen lds
v_mfma_f32_16x16x32_bf16 v[76:79], v[204:207], a[48:51], v[76:79]
s_nop 0
ds_read_b64_tr_b16 v[184:185], v10 offset:28672
ds_read_b64_tr_b16 v[186:187], v10 offset:30720
v_mfma_f32_16x16x32_bf16 v[76:79], v[220:223], a[52:55], v[76:79]
s_nop 0
ds_read_b64_tr_b16 v[188:189], v11 offset:28672
ds_read_b64_tr_b16 v[190:191], v11 offset:30720
v_mfma_f32_16x16x32_bf16 v[76:79], v[236:239], a[56:59], v[76:79]
v_lshlrev_b64 v[122:123], v120, v[122:123]
v_mov_b32 v126, 0
v_mfma_f32_16x16x32_bf16 v[76:79], v[252:255], a[60:63], v[76:79]
buffer_load_dwordx4 a[120:123], v1, s[44:47], s69 offen offset:2048 sc1
v_mfma_f32_16x16x32_bf16 v[60:63], v[252:255], a[44:47], v[60:63]
v_lshlrev_b64 v[122:123], v120, v[122:123]
v_mov_b32 v127, 0
v_mfma_f32_16x16x32_bf16 v[60:63], v[236:239], a[40:43], v[60:63]
s_add_u32 s72, s71, 15360
v_mov_b32 v120, 0
v_mov_b32 v121, 0
v_mfma_f32_16x16x32_bf16 v[60:63], v[220:223], a[36:39], v[60:63]
s_waitcnt vmcnt(18) lgkmcnt(0)
v_mov_b32 v124, v122
v_mov_b32 v125, v123
v_mfma_f32_16x16x32_bf16 v[60:63], v[204:207], a[32:35], v[60:63]
s_barrier
buffer_load_dwordx4 v15, s[24:27], s72 offen offset:1024 lds
v_mfma_f32_16x16x32_bf16 v[80:83], v[128:131], a[32:35], v[80:83]
s_nop 0
ds_read_b64_tr_b16 v[192:193], v8 offset:32768
ds_read_b64_tr_b16 v[194:195], v8 offset:34816
v_mfma_f32_16x16x32_bf16 v[80:83], v[144:147], a[36:39], v[80:83]
s_nop 0
ds_read_b64_tr_b16 v[196:197], v9 offset:32768
ds_read_b64_tr_b16 v[198:199], v9 offset:34816
v_mfma_f32_16x16x32_bf16 v[80:83], v[160:163], a[40:43], v[80:83]
s_nop 0
ds_read_b64_tr_b16 v[200:201], v10 offset:32768
ds_read_b64_tr_b16 v[202:203], v10 offset:34816
v_mfma_f32_16x16x32_bf16 v[80:83], v[176:179], a[44:47], v[80:83]
s_nop 0
ds_read_b64_tr_b16 v[204:205], v11 offset:32768
ds_read_b64_tr_b16 v[206:207], v11 offset:34816
v_mfma_f32_16x16x32_bf16 v[96:99], v[176:179], a[60:63], v[96:99]
v_mfma_f32_16x16x32_bf16 v[96:99], v[160:163], a[56:59], v[96:99]
buffer_load_dwordx4 a[124:127], v1, s[44:47], s69 offen offset:3072 sc1
v_mfma_f32_16x16x32_bf16 v[96:99], v[144:147], a[52:55], v[96:99]
s_nop 0
ds_read_b64_tr_b16 v[208:209], v8 offset:36864
ds_read_b64_tr_b16 v[210:211], v8 offset:38912
v_mfma_f32_16x16x32_bf16 v[96:99], v[128:131], a[48:51], v[96:99]
s_nop 0
ds_read_b64_tr_b16 v[212:213], v9 offset:36864
ds_read_b64_tr_b16 v[214:215], v9 offset:38912
v_mfma_f32_16x16x32_bf16 v[100:103], v[132:135], a[48:51], v[100:103]
s_nop 0
ds_read_b64_tr_b16 v[216:217], v10 offset:36864
ds_read_b64_tr_b16 v[218:219], v10 offset:38912
v_mfma_f32_16x16x32_bf16 v[100:103], v[148:151], a[52:55], v[100:103]
s_add_u32 s72, s71, 30720
buffer_load_dwordx4 v15, s[24:27], s72 offen offset:2048 lds
v_mfma_f32_16x16x32_bf16 v[100:103], v[164:167], a[56:59], v[100:103]
v_mfma_f32_16x16x32_bf16 v[100:103], v[180:183], a[60:63], v[100:103]
s_nop 0
ds_read_b64_tr_b16 v[220:221], v11 offset:36864
ds_read_b64_tr_b16 v[222:223], v11 offset:38912
v_mfma_f32_16x16x32_bf16 v[84:87], v[180:183], a[44:47], v[84:87]
s_nop 0
ds_read_b64_tr_b16 v[224:225], v8 offset:40960
ds_read_b64_tr_b16 v[226:227], v8 offset:43008
v_mfma_f32_16x16x32_bf16 v[84:87], v[164:167], a[40:43], v[84:87]
s_add_u32 s72, s71, 46080
buffer_load_dwordx4 v15, s[24:27], s72 offen offset:3072 lds
v_mfma_f32_16x16x32_bf16 v[84:87], v[148:151], a[36:39], v[84:87]
s_nop 0
ds_read_b64_tr_b16 v[228:229], v9 offset:40960
ds_read_b64_tr_b16 v[230:231], v9 offset:43008
v_mfma_f32_16x16x32_bf16 v[84:87], v[132:135], a[32:35], v[84:87]
v_mfma_f32_16x16x32_bf16 v[88:91], v[136:139], a[32:35], v[88:91]
s_nop 0
ds_read_b64_tr_b16 v[232:233], v10 offset:40960
ds_read_b64_tr_b16 v[234:235], v10 offset:43008
v_mfma_f32_16x16x32_bf16 v[88:91], v[152:155], a[36:39], v[88:91]
s_waitcnt vmcnt(21)
v_cmp_gt_u32 vcc, 2, v3
s_cbranch_vccnz Lspin106
Lback107:
s_lshr_b32 s69, s12, 18
s_lshl_b32 s69, s69, 12
s_add_u32 s69, s69, s95
s_xor_b32 s69, s69, 0x1000
buffer_load_dwordx4 a[128:131], v1, s[44:47], s69 offen sc1
v_mfma_f32_16x16x32_bf16 v[88:91], v[168:171], a[40:43], v[88:91]
s_nop 0
ds_read_b64_tr_b16 v[236:237], v11 offset:40960
Lstube1:
s_cbranch_execz Lstube5
ds_read_b64_tr_b16 v[238:239], v11 offset:43008
v_mfma_f32_16x16x32_bf16 v[88:91], v[184:187], a[44:47], v[88:91]
s_xor_b32 s71, s15, 0x100
ds_read_b64_tr_b16 v[240:241], v8 offset:45056
ds_read_b64_tr_b16 v[242:243], v8 offset:47104
v_mfma_f32_16x16x32_bf16 v[104:107], v[184:187], a[60:63], v[104:107]
s_add_u32 m0, s77, 32768
v_mfma_f32_16x16x32_bf16 v[104:107], v[168:171], a[56:59], v[104:107]
s_add_u32 s72, s71, 0
buffer_load_dwordx4 v15, s[24:27], s72 offen lds
v_mfma_f32_16x16x32_bf16 v[104:107], v[152:155], a[52:55], v[104:107]
s_nop 0
ds_read_b64_tr_b16 v[244:245], v9 offset:45056
ds_read_b64_tr_b16 v[246:247], v9 offset:47104
v_mfma_f32_16x16x32_bf16 v[104:107], v[136:139], a[48:51], v[104:107]
s_nop 0
ds_read_b64_tr_b16 v[248:249], v10 offset:45056
ds_read_b64_tr_b16 v[250:251], v10 offset:47104
v_mfma_f32_16x16x32_bf16 v[108:111], v[140:143], a[48:51], v[108:111]
s_nop 0
ds_read_b64_tr_b16 v[252:253], v11 offset:45056
ds_read_b64_tr_b16 v[254:255], v11 offset:47104
v_mfma_f32_16x16x32_bf16 v[108:111], v[156:159], a[52:55], v[108:111]
buffer_load_dwordx4 a[132:135], v1, s[44:47], s69 offen offset:1024 sc1
v_mfma_f32_16x16x32_bf16 v[108:111], v[172:175], a[56:59], v[108:111]
v_mfma_f32_16x16x32_bf16 v[108:111], v[188:191], a[60:63], v[108:111]
v_mfma_f32_16x16x32_bf16 v[92:95], v[188:191], a[44:47], v[92:95]
v_mfma_f32_16x16x32_bf16 v[92:95], v[172:175], a[40:43], v[92:95]
s_add_u32 s72, s71, 15360
buffer_load_dwordx4 v15, s[24:27], s72 offen offset:1024 lds
v_mfma_f32_16x16x32_bf16 v[92:95], v[156:159], a[36:39], v[92:95]
s_waitcnt vmcnt(19) lgkmcnt(0)
v_mfma_f32_16x16x32_bf16 v[92:95], v[140:143], a[32:35], v[92:95]
s_barrier
v_mfma_f32_16x16x32_bf16 v[16:19], v[192:195], a[64:67], v[16:19]
s_nop 0
ds_read_b64_tr_b16 v[128:129], v8 offset:49152
ds_read_b64_tr_b16 v[130:131], v8 offset:51200
v_mfma_f32_16x16x32_bf16 v[16:19], v[208:211], a[68:71], v[16:19]
s_nop 0
ds_read_b64_tr_b16 v[132:133], v9 offset:49152
ds_read_b64_tr_b16 v[134:135], v9 offset:51200
v_mfma_f32_16x16x32_bf16 v[16:19], v[224:227], a[72:75], v[16:19]
s_nop 0
ds_read_b64_tr_b16 v[136:137], v10 offset:49152
ds_read_b64_tr_b16 v[138:139], v10 offset:51200
v_mfma_f32_16x16x32_bf16 v[16:19], v[240:243], a[76:79], v[16:19]
buffer_load_dwordx4 a[136:139], v1, s[44:47], s69 offen offset:2048 sc1
v_mfma_f32_16x16x32_bf16 v[32:35], v[240:243], a[92:95], v[32:35]
s_nop 0
ds_read_b64_tr_b16 v[140:141], v11 offset:49152
ds_read_b64_tr_b16 v[142:143], v11 offset:51200
v_mfma_f32_16x16x32_bf16 v[32:35], v[224:227], a[88:91], v[32:35]
v_mfma_f32_16x16x32_bf16 v[32:35], v[208:211], a[84:87], v[32:35]
s_nop 0
ds_read_b64_tr_b16 v[144:145], v8 offset:53248
ds_read_b64_tr_b16 v[146:147], v8 offset:55296
v_mfma_f32_16x16x32_bf16 v[32:35], v[192:195], a[80:83], v[32:35]
s_add_u32 s72, s71, 30720
buffer_load_dwordx4 v15, s[24:27], s72 offen offset:2048 lds
v_mfma_f32_16x16x32_bf16 v[36:39], v[196:199], a[80:83], v[36:39]
s_nop 0
ds_read_b64_tr_b16 v[148:149], v9 offset:53248
ds_read_b64_tr_b16 v[150:151], v9 offset:55296
v_mfma_f32_16x16x32_bf16 v[36:39], v[212:215], a[84:87], v[36:39]
s_nop 0
ds_read_b64_tr_b16 v[152:153], v10 offset:53248
ds_read_b64_tr_b16 v[154:155], v10 offset:55296
v_mfma_f32_16x16x32_bf16 v[36:39], v[228:231], a[88:91], v[36:39]
v_mfma_f32_16x16x32_bf16 v[36:39], v[244:247], a[92:95], v[36:39]
s_add_u32 s72, s71, 46080
buffer_load_dwordx4 v15, s[24:27], s72 offen offset:3072 lds
v_mfma_f32_16x16x32_bf16 v[20:23], v[244:247], a[76:79], v[20:23]
s_nop 0
ds_read_b64_tr_b16 v[156:157], v11 offset:53248
ds_read_b64_tr_b16 v[158:159], v11 offset:55296
v_mfma_f32_16x16x32_bf16 v[20:23], v[228:231], a[72:75], v[20:23]
s_nop 0
ds_read_b64_tr_b16 v[160:161], v8 offset:57344
ds_read_b64_tr_b16 v[162:163], v8 offset:59392
v_mfma_f32_16x16x32_bf16 v[20:23], v[212:215], a[68:71], v[20:23]
s_nop 0
ds_read_b64_tr_b16 v[164:165], v9 offset:57344
ds_read_b64_tr_b16 v[166:167], v9 offset:59392
v_mfma_f32_16x16x32_bf16 v[20:23], v[196:199], a[64:67], v[20:23]
buffer_load_dwordx4 a[140:143], v1, s[44:47], s69 offen offset:3072 sc1
v_mfma_f32_16x16x32_bf16 v[24:27], v[200:203], a[64:67], v[24:27]
v_mfma_f32_16x16x32_bf16 v[24:27], v[216:219], a[68:71], v[24:27]
s_xor_b32 s71, s15, 0x180
ds_read_b64_tr_b16 v[168:169], v10 offset:57344
ds_read_b64_tr_b16 v[170:171], v10 offset:59392
v_mfma_f32_16x16x32_bf16 v[24:27], v[232:235], a[72:75], v[24:27]
s_add_u32 m0, s77, 49152
ds_read_b64_tr_b16 v[172:173], v11 offset:57344
ds_read_b64_tr_b16 v[174:175], v11 offset:59392
v_mfma_f32_16x16x32_bf16 v[24:27], v[248:251], a[76:79], v[24:27]
s_add_u32 s72, s71, 0
buffer_load_dwordx4 v15, s[24:27], s72 offen lds
v_mfma_f32_16x16x32_bf16 v[40:43], v[248:251], a[92:95], v[40:43]
s_nop 0
ds_read_b64_tr_b16 v[176:177], v8 offset:61440
ds_read_b64_tr_b16 v[178:179], v8 offset:63488
v_mfma_f32_16x16x32_bf16 v[40:43], v[232:235], a[88:91], v[40:43]
v_mfma_f32_16x16x32_bf16 v[40:43], v[216:219], a[84:87], v[40:43]
s_nop 0
ds_read_b64_tr_b16 v[180:181], v9 offset:61440
ds_read_b64_tr_b16 v[182:183], v9 offset:63488
v_mfma_f32_16x16x32_bf16 v[40:43], v[200:203], a[80:83], v[40:43]
s_add_u32 s69, s69, 0x20000
buffer_load_dwordx4 a[144:147], v1, s[44:47], s69 offen sc1
v_mfma_f32_16x16x32_bf16 v[44:47], v[204:207], a[80:83], v[44:47]
s_nop 0
ds_read_b64_tr_b16 v[184:185], v10 offset:61440
ds_read_b64_tr_b16 v[186:187], v10 offset:63488
v_mfma_f32_16x16x32_bf16 v[44:47], v[220:223], a[84:87], v[44:47]
s_nop 0
ds_read_b64_tr_b16 v[188:189], v11 offset:61440
ds_read_b64_tr_b16 v[190:191], v11 offset:63488
v_mfma_f32_16x16x32_bf16 v[44:47], v[236:239], a[88:91], v[44:47]
v_mfma_f32_16x16x32_bf16 v[44:47], v[252:255], a[92:95], v[44:47]
s_add_u32 s72, s71, 15360
buffer_load_dwordx4 v15, s[24:27], s72 offen offset:1024 lds
v_mfma_f32_16x16x32_bf16 v[28:31], v[252:255], a[76:79], v[28:31]
v_xor_b32 v8, 0x10000, v8
v_mfma_f32_16x16x32_bf16 v[28:31], v[236:239], a[72:75], v[28:31]
v_xor_b32 v9, 0x10000, v9
v_mfma_f32_16x16x32_bf16 v[28:31], v[220:223], a[68:71], v[28:31]
s_waitcnt vmcnt(18) lgkmcnt(0)
v_xor_b32 v10, 0x10000, v10
v_mfma_f32_16x16x32_bf16 v[28:31], v[204:207], a[64:67], v[28:31]
s_barrier
v_xor_b32 v11, 0x10000, v11
v_mfma_f32_16x16x32_bf16 v[48:51], v[128:131], a[64:67], v[48:51]
s_nop 0
ds_read_b64_tr_b16 v[192:193], v8 offset:0
ds_read_b64_tr_b16 v[194:195], v8 offset:2048
v_mfma_f32_16x16x32_bf16 v[48:51], v[144:147], a[68:71], v[48:51]
s_add_u32 s72, s71, 30720
buffer_load_dwordx4 v15, s[24:27], s72 offen offset:2048 lds
v_mfma_f32_16x16x32_bf16 v[48:51], v[160:163], a[72:75], v[48:51]
s_nop 0
ds_read_b64_tr_b16 v[196:197], v9 offset:0
ds_read_b64_tr_b16 v[198:199], v9 offset:2048
v_mfma_f32_16x16x32_bf16 v[48:51], v[176:179], a[76:79], v[48:51]
s_nop 0
ds_read_b64_tr_b16 v[200:201], v10 offset:0
ds_read_b64_tr_b16 v[202:203], v10 offset:2048
v_mfma_f32_16x16x32_bf16 v[64:67], v[176:179], a[92:95], v[64:67]
s_nop 0
ds_read_b64_tr_b16 v[204:205], v11 offset:0
ds_read_b64_tr_b16 v[206:207], v11 offset:2048
v_mfma_f32_16x16x32_bf16 v[64:67], v[160:163], a[88:91], v[64:67]
buffer_load_dwordx4 a[148:151], v1, s[44:47], s69 offen offset:1024 sc1
v_mfma_f32_16x16x32_bf16 v[64:67], v[144:147], a[84:87], v[64:67]
v_mfma_f32_16x16x32_bf16 v[64:67], v[128:131], a[80:83], v[64:67]
s_nop 0
ds_read_b64_tr_b16 v[208:209], v8 offset:4096
ds_read_b64_tr_b16 v[210:211], v8 offset:6144
v_mfma_f32_16x16x32_bf16 v[68:71], v[132:135], a[80:83], v[68:71]
s_nop 0
ds_read_b64_tr_b16 v[212:213], v9 offset:4096
ds_read_b64_tr_b16 v[214:215], v9 offset:6144
v_mfma_f32_16x16x32_bf16 v[68:71], v[148:151], a[84:87], v[68:71]
s_add_u32 s72, s71, 46080
buffer_load_dwordx4 v15, s[24:27], s72 offen offset:3072 lds
v_mfma_f32_16x16x32_bf16 v[68:71], v[164:167], a[88:91], v[68:71]
s_nop 0
ds_read_b64_tr_b16 v[216:217], v10 offset:4096
ds_read_b64_tr_b16 v[218:219], v10 offset:6144
v_mfma_f32_16x16x32_bf16 v[68:71], v[180:183], a[92:95], v[68:71]
s_nop 0
ds_read_b64_tr_b16 v[220:221], v11 offset:4096
ds_read_b64_tr_b16 v[222:223], v11 offset:6144
v_mfma_f32_16x16x32_bf16 v[52:55], v[180:183], a[76:79], v[52:55]
v_mfma_f32_16x16x32_bf16 v[52:55], v[164:167], a[72:75], v[52:55]
buffer_load_dwordx4 a[152:155], v1, s[44:47], s69 offen offset:2048 sc1
v_mfma_f32_16x16x32_bf16 v[52:55], v[148:151], a[68:71], v[52:55]
s_nop 0
ds_read_b64_tr_b16 v[224:225], v8 offset:8192
ds_read_b64_tr_b16 v[226:227], v8 offset:10240
v_mfma_f32_16x16x32_bf16 v[52:55], v[132:135], a[64:67], v[52:55]
s_xor_b32 s71, s12, 0x40080
ds_read_b64_tr_b16 v[228:229], v9 offset:8192
ds_read_b64_tr_b16 v[230:231], v9 offset:10240
v_mfma_f32_16x16x32_bf16 v[56:59], v[136:139], a[64:67], v[56:59]
s_add_u32 m0, s85, 0
ds_read_b64_tr_b16 v[232:233], v10 offset:8192
ds_read_b64_tr_b16 v[234:235], v10 offset:10240
v_mfma_f32_16x16x32_bf16 v[56:59], v[152:155], a[68:71], v[56:59]
s_add_u32 s72, s71, 0
buffer_load_dwordx4 v15, s[24:27], s72 offen lds
v_mfma_f32_16x16x32_bf16 v[56:59], v[168:171], a[72:75], v[56:59]
s_nop 0
ds_read_b64_tr_b16 v[236:237], v11 offset:8192
ds_read_b64_tr_b16 v[238:239], v11 offset:10240
v_mfma_f32_16x16x32_bf16 v[56:59], v[184:187], a[76:79], v[56:59]
v_mfma_f32_16x16x32_bf16 v[72:75], v[184:187], a[92:95], v[72:75]
s_nop 0
ds_read_b64_tr_b16 v[240:241], v8 offset:12288
ds_read_b64_tr_b16 v[242:243], v8 offset:14336
v_mfma_f32_16x16x32_bf16 v[72:75], v[168:171], a[88:91], v[72:75]
buffer_load_dwordx4 a[156:159], v1, s[44:47], s69 offen offset:3072 sc1
v_mfma_f32_16x16x32_bf16 v[72:75], v[152:155], a[84:87], v[72:75]
s_nop 0
ds_read_b64_tr_b16 v[244:245], v9 offset:12288
ds_read_b64_tr_b16 v[246:247], v9 offset:14336
v_mfma_f32_16x16x32_bf16 v[72:75], v[136:139], a[80:83], v[72:75]
s_nop 0
ds_read_b64_tr_b16 v[248:249], v10 offset:12288
ds_read_b64_tr_b16 v[250:251], v10 offset:14336
v_mfma_f32_16x16x32_bf16 v[76:79], v[140:143], a[80:83], v[76:79]
s_nop 0
ds_read_b64_tr_b16 v[252:253], v11 offset:12288
ds_read_b64_tr_b16 v[254:255], v11 offset:14336
v_mfma_f32_16x16x32_bf16 v[76:79], v[156:159], a[84:87], v[76:79]
s_add_u32 s72, s71, 15360
buffer_load_dwordx4 v15, s[24:27], s72 offen offset:1024 lds
v_mfma_f32_16x16x32_bf16 v[76:79], v[172:175], a[88:91], v[76:79]
s_lshr_b32 s69, s13, 18
v_mfma_f32_16x16x32_bf16 v[76:79], v[188:191], a[92:95], v[76:79]
s_lshl_b32 s69, s69, 12
v_mfma_f32_16x16x32_bf16 v[60:63], v[188:191], a[76:79], v[60:63]
s_add_u32 s69, s69, s95
v_mfma_f32_16x16x32_bf16 v[60:63], v[172:175], a[72:75], v[60:63]
s_xor_b32 s69, s69, 0x1000
v_mfma_f32_16x16x32_bf16 v[60:63], v[156:159], a[68:71], v[60:63]
s_waitcnt vmcnt(11) lgkmcnt(0)
buffer_load_dwordx4 a[160:163], v1, s[44:47], s69 offen sc1
v_mfma_f32_16x16x32_bf16 v[60:63], v[140:143], a[64:67], v[60:63]
s_barrier
v_mfma_f32_16x16x32_bf16 v[80:83], v[192:195], a[64:67], v[80:83]
s_and_b32 s79, s91, 0xffff9fff
v_lshrrev_b32 v13, 4, v0
v_lshlrev_b32 v13, 13, v13
buffer_load_dword v14, v13, s[44:47], s79 offen sc1
v_mfma_f32_16x16x32_bf16 v[80:83], v[208:211], a[68:71], v[80:83]
s_nop 0
ds_read_b64_tr_b16 v[128:129], v8 offset:16384
ds_read_b64_tr_b16 v[130:131], v8 offset:18432
v_mfma_f32_16x16x32_bf16 v[80:83], v[224:227], a[72:75], v[80:83]
s_add_u32 s72, s71, 30720
buffer_load_dwordx4 v15, s[24:27], s72 offen offset:2048 lds
v_mfma_f32_16x16x32_bf16 v[80:83], v[240:243], a[76:79], v[80:83]
s_nop 0
ds_read_b64_tr_b16 v[132:133], v9 offset:16384
ds_read_b64_tr_b16 v[134:135], v9 offset:18432
v_mfma_f32_16x16x32_bf16 v[96:99], v[240:243], a[92:95], v[96:99]
s_nop 0
ds_read_b64_tr_b16 v[136:137], v10 offset:16384
ds_read_b64_tr_b16 v[138:139], v10 offset:18432
v_mfma_f32_16x16x32_bf16 v[96:99], v[224:227], a[88:91], v[96:99]
s_nop 0
ds_read_b64_tr_b16 v[140:141], v11 offset:16384
ds_read_b64_tr_b16 v[142:143], v11 offset:18432
v_mfma_f32_16x16x32_bf16 v[96:99], v[208:211], a[84:87], v[96:99]
s_add_u32 s72, s71, 46080
buffer_load_dwordx4 v15, s[24:27], s72 offen offset:3072 lds
v_mfma_f32_16x16x32_bf16 v[96:99], v[192:195], a[80:83], v[96:99]
v_mfma_f32_16x16x32_bf16 v[100:103], v[196:199], a[80:83], v[100:103]
s_nop 0
ds_read_b64_tr_b16 v[144:145], v8 offset:20480
ds_read_b64_tr_b16 v[146:147], v8 offset:22528
v_mfma_f32_16x16x32_bf16 v[100:103], v[212:215], a[84:87], v[100:103]
s_nop 0
ds_read_b64_tr_b16 v[148:149], v9 offset:20480
ds_read_b64_tr_b16 v[150:151], v9 offset:22528
v_mfma_f32_16x16x32_bf16 v[100:103], v[228:231], a[88:91], v[100:103]
buffer_load_dwordx4 a[164:167], v1, s[44:47], s69 offen offset:1024 sc1
v_mfma_f32_16x16x32_bf16 v[100:103], v[244:247], a[92:95], v[100:103]
s_nop 0
ds_read_b64_tr_b16 v[152:153], v10 offset:20480
ds_read_b64_tr_b16 v[154:155], v10 offset:22528
v_mfma_f32_16x16x32_bf16 v[84:87], v[244:247], a[76:79], v[84:87]
s_xor_b32 s71, s12, 0x40100
ds_read_b64_tr_b16 v[156:157], v11 offset:20480
ds_read_b64_tr_b16 v[158:159], v11 offset:22528
v_mfma_f32_16x16x32_bf16 v[84:87], v[228:231], a[72:75], v[84:87]
s_add_u32 m0, s85, 16384
v_mfma_f32_16x16x32_bf16 v[84:87], v[212:215], a[68:71], v[84:87]
s_add_u32 s72, s71, 0
buffer_load_dwordx4 v15, s[24:27], s72 offen lds
v_mfma_f32_16x16x32_bf16 v[84:87], v[196:199], a[64:67], v[84:87]
s_nop 0
ds_read_b64_tr_b16 v[160:161], v8 offset:24576
ds_read_b64_tr_b16 v[162:163], v8 offset:26624
v_mfma_f32_16x16x32_bf16 v[88:91], v[200:203], a[64:67], v[88:91]
s_nop 0
ds_read_b64_tr_b16 v[164:165], v9 offset:24576
ds_read_b64_tr_b16 v[166:167], v9 offset:26624
v_mfma_f32_16x16x32_bf16 v[88:91], v[216:219], a[68:71], v[88:91]
s_nop 0
ds_read_b64_tr_b16 v[168:169], v10 offset:24576
ds_read_b64_tr_b16 v[170:171], v10 offset:26624
v_mfma_f32_16x16x32_bf16 v[88:91], v[232:235], a[72:75], v[88:91]
buffer_load_dwordx4 a[168:171], v1, s[44:47], s69 offen offset:2048 sc1
v_mfma_f32_16x16x32_bf16 v[88:91], v[248:251], a[76:79], v[88:91]
s_nop 0
ds_read_b64_tr_b16 v[172:173], v11 offset:24576
ds_read_b64_tr_b16 v[174:175], v11 offset:26624
v_mfma_f32_16x16x32_bf16 v[104:107], v[248:251], a[92:95], v[104:107]
v_mfma_f32_16x16x32_bf16 v[104:107], v[232:235], a[88:91], v[104:107]
s_nop 0
ds_read_b64_tr_b16 v[176:177], v8 offset:28672
ds_read_b64_tr_b16 v[178:179], v8 offset:30720
v_mfma_f32_16x16x32_bf16 v[104:107], v[216:219], a[84:87], v[104:107]
s_add_u32 s72, s71, 15360
buffer_load_dwordx4 v15, s[24:27], s72 offen offset:1024 lds
v_mfma_f32_16x16x32_bf16 v[104:107], v[200:203], a[80:83], v[104:107]
s_nop 0
ds_read_b64_tr_b16 v[180:181], v9 offset:28672
ds_read_b64_tr_b16 v[182:183], v9 offset:30720
v_mfma_f32_16x16x32_bf16 v[108:111], v[204:207], a[80:83], v[108:111]
s_nop 0
ds_read_b64_tr_b16 v[184:185], v10 offset:28672
ds_read_b64_tr_b16 v[186:187], v10 offset:30720
v_mfma_f32_16x16x32_bf16 v[108:111], v[220:223], a[84:87], v[108:111]
s_nop 0
ds_read_b64_tr_b16 v[188:189], v11 offset:28672
ds_read_b64_tr_b16 v[190:191], v11 offset:30720
v_mfma_f32_16x16x32_bf16 v[108:111], v[236:239], a[88:91], v[108:111]
v_mfma_f32_16x16x32_bf16 v[108:111], v[252:255], a[92:95], v[108:111]
v_mfma_f32_16x16x32_bf16 v[92:95], v[252:255], a[76:79], v[92:95]
buffer_load_dwordx4 a[172:175], v1, s[44:47], s69 offen offset:3072 sc1
v_mfma_f32_16x16x32_bf16 v[92:95], v[236:239], a[72:75], v[92:95]
v_mfma_f32_16x16x32_bf16 v[92:95], v[220:223], a[68:71], v[92:95]
s_waitcnt vmcnt(29) lgkmcnt(0)
v_mfma_f32_16x16x32_bf16 v[92:95], v[204:207], a[64:67], v[92:95]
v_mfma_f32_16x16x32_bf16 v[16:19], v[128:131], a[96:99], v[16:19]
s_add_u32 s72, s71, 30720
buffer_load_dwordx4 v15, s[24:27], s72 offen offset:2048 lds
v_mfma_f32_16x16x32_bf16 v[16:19], v[144:147], a[100:103], v[16:19]
s_nop 0
ds_read_b64_tr_b16 v[192:193], v8 offset:32768
ds_read_b64_tr_b16 v[194:195], v8 offset:34816
v_mfma_f32_16x16x32_bf16 v[16:19], v[160:163], a[104:107], v[16:19]
s_nop 0
ds_read_b64_tr_b16 v[196:197], v9 offset:32768
ds_read_b64_tr_b16 v[198:199], v9 offset:34816
v_mfma_f32_16x16x32_bf16 v[16:19], v[176:179], a[108:111], v[16:19]
s_nop 0
ds_read_b64_tr_b16 v[200:201], v10 offset:32768
ds_read_b64_tr_b16 v[202:203], v10 offset:34816
v_mfma_f32_16x16x32_bf16 v[32:35], v[176:179], a[124:127], v[32:35]
s_add_u32 s72, s71, 46080
buffer_load_dwordx4 v15, s[24:27], s72 offen offset:3072 lds
v_mfma_f32_16x16x32_bf16 v[32:35], v[160:163], a[120:123], v[32:35]
s_nop 0
ds_read_b64_tr_b16 v[204:205], v11 offset:32768
ds_read_b64_tr_b16 v[206:207], v11 offset:34816
v_mfma_f32_16x16x32_bf16 v[32:35], v[144:147], a[116:119], v[32:35]
v_mfma_f32_16x16x32_bf16 v[32:35], v[128:131], a[112:115], v[32:35]
s_nop 0
ds_read_b64_tr_b16 v[208:209], v8 offset:36864
ds_read_b64_tr_b16 v[210:211], v8 offset:38912
v_mfma_f32_16x16x32_bf16 v[36:39], v[132:135], a[112:115], v[36:39]
s_add_u32 s69, s69, 0x20000
buffer_load_dwordx4 a[176:179], v1, s[44:47], s69 offen sc1
v_mfma_f32_16x16x32_bf16 v[36:39], v[148:151], a[116:119], v[36:39]
s_nop 0
ds_read_b64_tr_b16 v[212:213], v9 offset:36864
ds_read_b64_tr_b16 v[214:215], v9 offset:38912
v_mfma_f32_16x16x32_bf16 v[36:39], v[164:167], a[120:123], v[36:39]
s_xor_b32 s71, s12, 0x40180
ds_read_b64_tr_b16 v[216:217], v10 offset:36864
ds_read_b64_tr_b16 v[218:219], v10 offset:38912
v_mfma_f32_16x16x32_bf16 v[36:39], v[180:183], a[124:127], v[36:39]
s_add_u32 m0, s85, 32768
ds_read_b64_tr_b16 v[220:221], v11 offset:36864
ds_read_b64_tr_b16 v[222:223], v11 offset:38912
v_mfma_f32_16x16x32_bf16 v[20:23], v[180:183], a[108:111], v[20:23]
s_add_u32 s72, s71, 0
buffer_load_dwordx4 v15, s[24:27], s72 offen lds
v_mfma_f32_16x16x32_bf16 v[20:23], v[164:167], a[104:107], v[20:23]
v_mfma_f32_16x16x32_bf16 v[20:23], v[148:151], a[100:103], v[20:23]
s_nop 0
ds_read_b64_tr_b16 v[224:225], v8 offset:40960
ds_read_b64_tr_b16 v[226:227], v8 offset:43008
v_mfma_f32_16x16x32_bf16 v[20:23], v[132:135], a[96:99], v[20:23]
s_nop 0
ds_read_b64_tr_b16 v[228:229], v9 offset:40960
ds_read_b64_tr_b16 v[230:231], v9 offset:43008
v_mfma_f32_16x16x32_bf16 v[24:27], v[136:139], a[96:99], v[24:27]
buffer_load_dwordx4 a[180:183], v1, s[44:47], s69 offen offset:1024 sc1
v_mfma_f32_16x16x32_bf16 v[24:27], v[152:155], a[100:103], v[24:27]
s_nop 0
ds_read_b64_tr_b16 v[232:233], v10 offset:40960
ds_read_b64_tr_b16 v[234:235], v10 offset:43008
v_mfma_f32_16x16x32_bf16 v[24:27], v[168:171], a[104:107], v[24:27]
s_nop 0
ds_read_b64_tr_b16 v[236:237], v11 offset:40960
ds_read_b64_tr_b16 v[238:239], v11 offset:43008
v_mfma_f32_16x16x32_bf16 v[24:27], v[184:187], a[108:111], v[24:27]
v_mfma_f32_16x16x32_bf16 v[40:43], v[184:187], a[124:127], v[40:43]
s_add_u32 s72, s71, 15360
buffer_load_dwordx4 v15, s[24:27], s72 offen offset:1024 lds
v_mfma_f32_16x16x32_bf16 v[40:43], v[168:171], a[120:123], v[40:43]
s_nop 0
ds_read_b64_tr_b16 v[240:241], v8 offset:45056
ds_read_b64_tr_b16 v[242:243], v8 offset:47104
v_mfma_f32_16x16x32_bf16 v[40:43], v[152:155], a[116:119], v[40:43]
s_nop 0
ds_read_b64_tr_b16 v[244:245], v9 offset:45056
ds_read_b64_tr_b16 v[246:247], v9 offset:47104
v_mfma_f32_16x16x32_bf16 v[40:43], v[136:139], a[112:115], v[40:43]
s_nop 0
ds_read_b64_tr_b16 v[248:249], v10 offset:45056
ds_read_b64_tr_b16 v[250:251], v10 offset:47104
v_mfma_f32_16x16x32_bf16 v[44:47], v[140:143], a[112:115], v[44:47]
s_nop 0
ds_read_b64_tr_b16 v[252:253], v11 offset:45056
ds_read_b64_tr_b16 v[254:255], v11 offset:47104
v_mfma_f32_16x16x32_bf16 v[44:47], v[156:159], a[116:119], v[44:47]
v_mfma_f32_16x16x32_bf16 v[44:47], v[172:175], a[120:123], v[44:47]
s_add_u32 s72, s71, 30720
buffer_load_dwordx4 v15, s[24:27], s72 offen offset:2048 lds
v_mfma_f32_16x16x32_bf16 v[44:47], v[188:191], a[124:127], v[44:47]
v_mfma_f32_16x16x32_bf16 v[28:31], v[188:191], a[108:111], v[28:31]
v_mfma_f32_16x16x32_bf16 v[28:31], v[172:175], a[104:107], v[28:31]
v_mfma_f32_16x16x32_bf16 v[28:31], v[156:159], a[100:103], v[28:31]
s_waitcnt vmcnt(12) lgkmcnt(0)
buffer_load_dwordx4 a[184:187], v1, s[44:47], s69 offen offset:2048 sc1
v_mfma_f32_16x16x32_bf16 v[28:31], v[140:143], a[96:99], v[28:31]
s_barrier
v_mfma_f32_16x16x32_bf16 v[48:51], v[192:195], a[96:99], v[48:51]
s_nop 0
ds_read_b64_tr_b16 v[128:129], v8 offset:49152
ds_read_b64_tr_b16 v[130:131], v8 offset:51200
v_mfma_f32_16x16x32_bf16 v[48:51], v[208:211], a[100:103], v[48:51]
s_nop 0
ds_read_b64_tr_b16 v[132:133], v9 offset:49152
ds_read_b64_tr_b16 v[134:135], v9 offset:51200
v_mfma_f32_16x16x32_bf16 v[48:51], v[224:227], a[104:107], v[48:51]
s_add_u32 s72, s71, 46080
buffer_load_dwordx4 v15, s[24:27], s72 offen offset:3072 lds
v_mfma_f32_16x16x32_bf16 v[48:51], v[240:243], a[108:111], v[48:51]
s_nop 0
ds_read_b64_tr_b16 v[136:137], v10 offset:49152
ds_read_b64_tr_b16 v[138:139], v10 offset:51200
v_mfma_f32_16x16x32_bf16 v[64:67], v[240:243], a[124:127], v[64:67]
s_nop 0
ds_read_b64_tr_b16 v[140:141], v11 offset:49152
ds_read_b64_tr_b16 v[142:143], v11 offset:51200
v_mfma_f32_16x16x32_bf16 v[64:67], v[224:227], a[120:123], v[64:67]
v_mfma_f32_16x16x32_bf16 v[64:67], v[208:211], a[116:119], v[64:67]
buffer_load_dwordx4 a[188:191], v1, s[44:47], s69 offen offset:3072 sc1
v_mfma_f32_16x16x32_bf16 v[64:67], v[192:195], a[112:115], v[64:67]
s_nop 0
ds_read_b64_tr_b16 v[144:145], v8 offset:53248
ds_read_b64_tr_b16 v[146:147], v8 offset:55296
v_mfma_f32_16x16x32_bf16 v[68:71], v[196:199], a[112:115], v[68:71]
s_xor_b32 s71, s13, 0x40080
ds_read_b64_tr_b16 v[148:149], v9 offset:53248
ds_read_b64_tr_b16 v[150:151], v9 offset:55296
v_mfma_f32_16x16x32_bf16 v[68:71], v[212:215], a[116:119], v[68:71]
s_add_u32 m0, s85, 49152
ds_read_b64_tr_b16 v[152:153], v10 offset:53248
ds_read_b64_tr_b16 v[154:155], v10 offset:55296
v_mfma_f32_16x16x32_bf16 v[68:71], v[228:231], a[120:123], v[68:71]
s_add_u32 s72, s71, 0
buffer_load_dwordx4 v15, s[24:27], s72 offen lds
v_mfma_f32_16x16x32_bf16 v[68:71], v[244:247], a[124:127], v[68:71]
s_lshr_b32 s69, s14, 18
ds_read_b64_tr_b16 v[156:157], v11 offset:53248
ds_read_b64_tr_b16 v[158:159], v11 offset:55296
v_mfma_f32_16x16x32_bf16 v[52:55], v[244:247], a[108:111], v[52:55]
s_lshl_b32 s69, s69, 12
v_mfma_f32_16x16x32_bf16 v[52:55], v[228:231], a[104:107], v[52:55]
s_add_u32 s69, s69, s95
ds_read_b64_tr_b16 v[160:161], v8 offset:57344
ds_read_b64_tr_b16 v[162:163], v8 offset:59392
v_mfma_f32_16x16x32_bf16 v[52:55], v[212:215], a[100:103], v[52:55]
s_xor_b32 s69, s69, 0x1000
buffer_load_dwordx4 a[192:195], v1, s[44:47], s69 offen sc1
v_mfma_f32_16x16x32_bf16 v[52:55], v[196:199], a[96:99], v[52:55]
s_nop 0
ds_read_b64_tr_b16 v[164:165], v9 offset:57344
ds_read_b64_tr_b16 v[166:167], v9 offset:59392
v_mfma_f32_16x16x32_bf16 v[56:59], v[200:203], a[96:99], v[56:59]
s_waitcnt vmcnt(19)
v_cmp_gt_u32 vcc, 2, v14
s_cbranch_vccnz Lspin112
Lback113:
v_mfma_f32_16x16x32_bf16 v[56:59], v[216:219], a[100:103], v[56:59]
s_nop 0
ds_read_b64_tr_b16 v[168:169], v10 offset:57344
ds_read_b64_tr_b16 v[170:171], v10 offset:59392
v_mfma_f32_16x16x32_bf16 v[56:59], v[232:235], a[104:107], v[56:59]
s_add_u32 s72, s71, 15360
buffer_load_dwordx4 v15, s[24:27], s72 offen offset:1024 lds
v_mfma_f32_16x16x32_bf16 v[56:59], v[248:251], a[108:111], v[56:59]
s_nop 0
ds_read_b64_tr_b16 v[172:173], v11 offset:57344
ds_read_b64_tr_b16 v[174:175], v11 offset:59392
v_mfma_f32_16x16x32_bf16 v[72:75], v[248:251], a[124:127], v[72:75]
v_mfma_f32_16x16x32_bf16 v[72:75], v[232:235], a[120:123], v[72:75]
s_nop 0
ds_read_b64_tr_b16 v[176:177], v8 offset:61440
ds_read_b64_tr_b16 v[178:179], v8 offset:63488
v_mfma_f32_16x16x32_bf16 v[72:75], v[216:219], a[116:119], v[72:75]
s_nop 0
ds_read_b64_tr_b16 v[180:181], v9 offset:61440
ds_read_b64_tr_b16 v[182:183], v9 offset:63488
v_mfma_f32_16x16x32_bf16 v[72:75], v[200:203], a[112:115], v[72:75]
s_nop 0
ds_read_b64_tr_b16 v[184:185], v10 offset:61440
ds_read_b64_tr_b16 v[186:187], v10 offset:63488
v_mfma_f32_16x16x32_bf16 v[76:79], v[204:207], a[112:115], v[76:79]
s_add_u32 s72, s71, 30720
buffer_load_dwordx4 v15, s[24:27], s72 offen offset:2048 lds
v_mfma_f32_16x16x32_bf16 v[76:79], v[220:223], a[116:119], v[76:79]
s_nop 0
ds_read_b64_tr_b16 v[188:189], v11 offset:61440
ds_read_b64_tr_b16 v[190:191], v11 offset:63488
v_mfma_f32_16x16x32_bf16 v[76:79], v[236:239], a[120:123], v[76:79]
v_mfma_f32_16x16x32_bf16 v[76:79], v[252:255], a[124:127], v[76:79]
v_mfma_f32_16x16x32_bf16 v[60:63], v[252:255], a[108:111], v[60:63]
s_nop 0
buffer_load_dwordx4 a[196:199], v1, s[44:47], s69 offen offset:1024 sc1
v_xor_b32 v8, 0x10000, v8
v_mfma_f32_16x16x32_bf16 v[60:63], v[236:239], a[104:107], v[60:63]
v_xor_b32 v9, 0x10000, v9
v_mfma_f32_16x16x32_bf16 v[60:63], v[220:223], a[100:103], v[60:63]
s_waitcnt lgkmcnt(0)
v_xor_b32 v10, 0x10000, v10
v_mfma_f32_16x16x32_bf16 v[60:63], v[204:207], a[96:99], v[60:63]
v_xor_b32 v11, 0x10000, v11
v_mfma_f32_16x16x32_bf16 v[80:83], v[128:131], a[96:99], v[80:83]
s_add_u32 s72, s71, 46080
buffer_load_dwordx4 v15, s[24:27], s72 offen offset:3072 lds
v_mfma_f32_16x16x32_bf16 v[80:83], v[144:147], a[100:103], v[80:83]
s_lshl_b32 s84, s76, 11
ds_read_b64_tr_b16 v[192:193], v8 offset:0
ds_read_b64_tr_b16 v[194:195], v8 offset:2048
v_mfma_f32_16x16x32_bf16 v[80:83], v[160:163], a[104:107], v[80:83]
s_add_u32 s84, s84, 0x3810000
ds_read_b64_tr_b16 v[196:197], v9 offset:0
ds_read_b64_tr_b16 v[198:199], v9 offset:2048
v_mfma_f32_16x16x32_bf16 v[80:83], v[176:179], a[108:111], v[80:83]
s_nop 0
ds_read_b64_tr_b16 v[200:201], v10 offset:0
ds_read_b64_tr_b16 v[202:203], v10 offset:2048
v_mfma_f32_16x16x32_bf16 v[96:99], v[176:179], a[124:127], v[96:99]
buffer_load_dwordx4 a[200:203], v1, s[44:47], s69 offen offset:2048 sc1
v_mfma_f32_16x16x32_bf16 v[96:99], v[160:163], a[120:123], v[96:99]
s_nop 0
ds_read_b64_tr_b16 v[204:205], v11 offset:0
ds_read_b64_tr_b16 v[206:207], v11 offset:2048
v_mfma_f32_16x16x32_bf16 v[96:99], v[144:147], a[116:119], v[96:99]
s_xor_b32 s71, s14, 0x40080
v_lshrrev_b32 v115, 2, v0
v_lshlrev_b32 v115, 7, v115
v_mfma_f32_16x16x32_bf16 v[96:99], v[128:131], a[112:115], v[96:99]
s_add_u32 m0, s77, 0
ds_read_b64_tr_b16 v[208:209], v8 offset:4096
ds_read_b64_tr_b16 v[210:211], v8 offset:6144
v_mfma_f32_16x16x32_bf16 v[100:103], v[132:135], a[112:115], v[100:103]
s_add_u32 s72, s71, 0
buffer_load_dwordx4 v15, s[24:27], s72 offen lds
v_mfma_f32_16x16x32_bf16 v[100:103], v[148:151], a[116:119], v[100:103]
s_nop 0
ds_read_b64_tr_b16 v[212:213], v9 offset:4096
ds_read_b64_tr_b16 v[214:215], v9 offset:6144
v_mfma_f32_16x16x32_bf16 v[100:103], v[164:167], a[120:123], v[100:103]
s_nop 0
ds_read_b64_tr_b16 v[216:217], v10 offset:4096
ds_read_b64_tr_b16 v[218:219], v10 offset:6144
v_mfma_f32_16x16x32_bf16 v[100:103], v[180:183], a[124:127], v[100:103]
Lstube2:
s_cbranch_execz Lrete
s_nop 0
ds_read_b64_tr_b16 v[220:221], v11 offset:4096
ds_read_b64_tr_b16 v[222:223], v11 offset:6144
v_mfma_f32_16x16x32_bf16 v[84:87], v[180:183], a[108:111], v[84:87]
buffer_load_dwordx4 a[204:207], v1, s[44:47], s69 offen offset:3072 sc1
v_mfma_f32_16x16x32_bf16 v[84:87], v[164:167], a[104:107], v[84:87]
buffer_load_dword v114, v115, s[44:47], s84 offen sc1
v_mfma_f32_16x16x32_bf16 v[84:87], v[148:151], a[100:103], v[84:87]
s_nop 0
ds_read_b64_tr_b16 v[224:225], v8 offset:8192
ds_read_b64_tr_b16 v[226:227], v8 offset:10240
v_mfma_f32_16x16x32_bf16 v[84:87], v[132:135], a[96:99], v[84:87]
s_nop 0
ds_read_b64_tr_b16 v[228:229], v9 offset:8192
ds_read_b64_tr_b16 v[230:231], v9 offset:10240
v_mfma_f32_16x16x32_bf16 v[88:91], v[136:139], a[96:99], v[88:91]
s_add_u32 s72, s71, 15360
buffer_load_dwordx4 v15, s[24:27], s72 offen offset:1024 lds
v_mfma_f32_16x16x32_bf16 v[88:91], v[152:155], a[100:103], v[88:91]
s_nop 0
ds_read_b64_tr_b16 v[232:233], v10 offset:8192
ds_read_b64_tr_b16 v[234:235], v10 offset:10240
v_mfma_f32_16x16x32_bf16 v[88:91], v[168:171], a[104:107], v[88:91]
s_nop 0
ds_read_b64_tr_b16 v[236:237], v11 offset:8192
ds_read_b64_tr_b16 v[238:239], v11 offset:10240
v_mfma_f32_16x16x32_bf16 v[88:91], v[184:187], a[108:111], v[88:91]
v_mfma_f32_16x16x32_bf16 v[104:107], v[184:187], a[124:127], v[104:107]
s_nop 0
ds_read_b64_tr_b16 v[240:241], v8 offset:12288
ds_read_b64_tr_b16 v[242:243], v8 offset:14336
v_mfma_f32_16x16x32_bf16 v[104:107], v[168:171], a[120:123], v[104:107]
s_nop 0
ds_read_b64_tr_b16 v[244:245], v9 offset:12288
ds_read_b64_tr_b16 v[246:247], v9 offset:14336
v_mfma_f32_16x16x32_bf16 v[104:107], v[152:155], a[116:119], v[104:107]
s_add_u32 s72, s71, 30720
buffer_load_dwordx4 v15, s[24:27], s72 offen offset:2048 lds
v_mfma_f32_16x16x32_bf16 v[104:107], v[136:139], a[112:115], v[104:107]
s_nop 0
ds_read_b64_tr_b16 v[248:249], v10 offset:12288
ds_read_b64_tr_b16 v[250:251], v10 offset:14336
v_mfma_f32_16x16x32_bf16 v[108:111], v[140:143], a[112:115], v[108:111]
s_nop 0
ds_read_b64_tr_b16 v[252:253], v11 offset:12288
ds_read_b64_tr_b16 v[254:255], v11 offset:14336
v_mfma_f32_16x16x32_bf16 v[108:111], v[156:159], a[116:119], v[108:111]
v_mfma_f32_16x16x32_bf16 v[108:111], v[172:175], a[120:123], v[108:111]
s_add_u32 s69, s69, 0x20000
buffer_load_dwordx4 a[208:211], v1, s[44:47], s69 offen sc1
v_mfma_f32_16x16x32_bf16 v[108:111], v[188:191], a[124:127], v[108:111]
v_mfma_f32_16x16x32_bf16 v[92:95], v[188:191], a[108:111], v[92:95]
v_mfma_f32_16x16x32_bf16 v[92:95], v[172:175], a[104:107], v[92:95]
s_add_u32 s72, s71, 46080
v_mfma_f32_16x16x32_bf16 v[92:95], v[156:159], a[100:103], v[92:95]
s_waitcnt vmcnt(14) lgkmcnt(0)
buffer_load_dwordx4 v15, s[24:27], s72 offen offset:3072 lds
v_mfma_f32_16x16x32_bf16 v[92:95], v[140:143], a[96:99], v[92:95]
s_barrier
v_mfma_f32_16x16x32_bf16 v[16:19], v[192:195], a[128:131], v[16:19]
s_nop 0
ds_read_b64_tr_b16 v[128:129], v8 offset:16384
ds_read_b64_tr_b16 v[130:131], v8 offset:18432
v_mfma_f32_16x16x32_bf16 v[16:19], v[208:211], a[132:135], v[16:19]
s_nop 0
ds_read_b64_tr_b16 v[132:133], v9 offset:16384
ds_read_b64_tr_b16 v[134:135], v9 offset:18432
v_mfma_f32_16x16x32_bf16 v[16:19], v[224:227], a[136:139], v[16:19]
buffer_load_dwordx4 a[212:215], v1, s[44:47], s69 offen offset:1024 sc1
v_mfma_f32_16x16x32_bf16 v[16:19], v[240:243], a[140:143], v[16:19]
s_nop 0
ds_read_b64_tr_b16 v[136:137], v10 offset:16384
ds_read_b64_tr_b16 v[138:139], v10 offset:18432
v_mfma_f32_16x16x32_bf16 v[32:35], v[240:243], a[156:159], v[32:35]
s_xor_b32 s71, s15, 0x40080
ds_read_b64_tr_b16 v[140:141], v11 offset:16384
ds_read_b64_tr_b16 v[142:143], v11 offset:18432
v_mfma_f32_16x16x32_bf16 v[32:35], v[224:227], a[152:155], v[32:35]
s_add_u32 m0, s77, 16384
v_mfma_f32_16x16x32_bf16 v[32:35], v[208:211], a[148:151], v[32:35]
s_add_u32 s72, s71, 0
buffer_load_dwordx4 v15, s[24:27], s72 offen lds
v_mfma_f32_16x16x32_bf16 v[32:35], v[192:195], a[144:147], v[32:35]
s_nop 0
ds_read_b64_tr_b16 v[144:145], v8 offset:20480
ds_read_b64_tr_b16 v[146:147], v8 offset:22528
v_mfma_f32_16x16x32_bf16 v[36:39], v[196:199], a[144:147], v[36:39]
s_nop 0
ds_read_b64_tr_b16 v[148:149], v9 offset:20480
ds_read_b64_tr_b16 v[150:151], v9 offset:22528
v_mfma_f32_16x16x32_bf16 v[36:39], v[212:215], a[148:151], v[36:39]
s_nop 0
ds_read_b64_tr_b16 v[152:153], v10 offset:20480
ds_read_b64_tr_b16 v[154:155], v10 offset:22528
v_mfma_f32_16x16x32_bf16 v[36:39], v[228:231], a[152:155], v[36:39]
buffer_load_dwordx4 a[216:219], v1, s[44:47], s69 offen offset:2048 sc1
v_mfma_f32_16x16x32_bf16 v[36:39], v[244:247], a[156:159], v[36:39]
v_mfma_f32_16x16x32_bf16 v[20:23], v[244:247], a[140:143], v[20:23]
s_nop 0
ds_read_b64_tr_b16 v[156:157], v11 offset:20480
ds_read_b64_tr_b16 v[158:159], v11 offset:22528
v_mfma_f32_16x16x32_bf16 v[20:23], v[228:231], a[136:139], v[20:23]
s_nop 0
ds_read_b64_tr_b16 v[160:161], v8 offset:24576
ds_read_b64_tr_b16 v[162:163], v8 offset:26624
v_mfma_f32_16x16x32_bf16 v[20:23], v[212:215], a[132:135], v[20:23]
s_add_u32 s72, s71, 15360
buffer_load_dwordx4 v15, s[24:27], s72 offen offset:1024 lds
v_mfma_f32_16x16x32_bf16 v[20:23], v[196:199], a[128:131], v[20:23]
s_nop 0
ds_read_b64_tr_b16 v[164:165], v9 offset:24576
ds_read_b64_tr_b16 v[166:167], v9 offset:26624
v_mfma_f32_16x16x32_bf16 v[24:27], v[200:203], a[128:131], v[24:27]
v_mfma_f32_16x16x32_bf16 v[24:27], v[216:219], a[132:135], v[24:27]
s_nop 0
ds_read_b64_tr_b16 v[168:169], v10 offset:24576
ds_read_b64_tr_b16 v[170:171], v10 offset:26624
v_mfma_f32_16x16x32_bf16 v[24:27], v[232:235], a[136:139], v[24:27]
s_nop 0
ds_read_b64_tr_b16 v[172:173], v11 offset:24576
ds_read_b64_tr_b16 v[174:175], v11 offset:26624
v_mfma_f32_16x16x32_bf16 v[24:27], v[248:251], a[140:143], v[24:27]
s_nop 0
ds_read_b64_tr_b16 v[176:177], v8 offset:28672
ds_read_b64_tr_b16 v[178:179], v8 offset:30720
v_mfma_f32_16x16x32_bf16 v[40:43], v[248:251], a[156:159], v[40:43]
s_add_u32 s72, s71, 30720
buffer_load_dwordx4 v15, s[24:27], s72 offen offset:2048 lds
v_mfma_f32_16x16x32_bf16 v[40:43], v[232:235], a[152:155], v[40:43]
v_mfma_f32_16x16x32_bf16 v[40:43], v[216:219], a[148:151], v[40:43]
s_nop 0
ds_read_b64_tr_b16 v[180:181], v9 offset:28672
ds_read_b64_tr_b16 v[182:183], v9 offset:30720
v_mfma_f32_16x16x32_bf16 v[40:43], v[200:203], a[144:147], v[40:43]
s_nop 0
ds_read_b64_tr_b16 v[184:185], v10 offset:28672
ds_read_b64_tr_b16 v[186:187], v10 offset:30720
v_mfma_f32_16x16x32_bf16 v[44:47], v[204:207], a[144:147], v[44:47]
buffer_load_dwordx4 a[220:223], v1, s[44:47], s69 offen offset:3072 sc1
v_mfma_f32_16x16x32_bf16 v[44:47], v[220:223], a[148:151], v[44:47]
s_nop 0
ds_read_b64_tr_b16 v[188:189], v11 offset:28672
ds_read_b64_tr_b16 v[190:191], v11 offset:30720
v_mfma_f32_16x16x32_bf16 v[44:47], v[236:239], a[152:155], v[44:47]
s_lshr_b32 s69, s15, 18
v_mfma_f32_16x16x32_bf16 v[44:47], v[252:255], a[156:159], v[44:47]
s_lshl_b32 s69, s69, 12
v_mfma_f32_16x16x32_bf16 v[28:31], v[252:255], a[140:143], v[28:31]
s_add_u32 s72, s71, 46080
buffer_load_dwordx4 v15, s[24:27], s72 offen offset:3072 lds
v_mfma_f32_16x16x32_bf16 v[28:31], v[236:239], a[136:139], v[28:31]
s_add_u32 s69, s69, s95
v_mfma_f32_16x16x32_bf16 v[28:31], v[220:223], a[132:135], v[28:31]
s_waitcnt lgkmcnt(0)
v_mfma_f32_16x16x32_bf16 v[28:31], v[204:207], a[128:131], v[28:31]
v_mfma_f32_16x16x32_bf16 v[48:51], v[128:131], a[128:131], v[48:51]
s_xor_b32 s69, s69, 0x1000
buffer_load_dwordx4 a[224:227], v1, s[44:47], s69 offen sc1
v_mfma_f32_16x16x32_bf16 v[48:51], v[144:147], a[132:135], v[48:51]
s_nop 0
ds_read_b64_tr_b16 v[192:193], v8 offset:32768
ds_read_b64_tr_b16 v[194:195], v8 offset:34816
v_mfma_f32_16x16x32_bf16 v[48:51], v[160:163], a[136:139], v[48:51]
s_xor_b32 s71, s13, 0x40100
ds_read_b64_tr_b16 v[196:197], v9 offset:32768
ds_read_b64_tr_b16 v[198:199], v9 offset:34816
v_mfma_f32_16x16x32_bf16 v[48:51], v[176:179], a[140:143], v[48:51]
s_add_u32 m0, s77, 32768
ds_read_b64_tr_b16 v[200:201], v10 offset:32768
ds_read_b64_tr_b16 v[202:203], v10 offset:34816
v_mfma_f32_16x16x32_bf16 v[64:67], v[176:179], a[156:159], v[64:67]
s_add_u32 s72, s71, 0
buffer_load_dwordx4 v15, s[24:27], s72 offen lds
v_mfma_f32_16x16x32_bf16 v[64:67], v[160:163], a[152:155], v[64:67]
s_nop 0
ds_read_b64_tr_b16 v[204:205], v11 offset:32768
ds_read_b64_tr_b16 v[206:207], v11 offset:34816
v_mfma_f32_16x16x32_bf16 v[64:67], v[144:147], a[148:151], v[64:67]
v_mfma_f32_16x16x32_bf16 v[64:67], v[128:131], a[144:147], v[64:67]
s_nop 0
ds_read_b64_tr_b16 v[208:209], v8 offset:36864
ds_read_b64_tr_b16 v[210:211], v8 offset:38912
v_mfma_f32_16x16x32_bf16 v[68:71], v[132:135], a[144:147], v[68:71]
buffer_load_dwordx4 a[228:231], v1, s[44:47], s69 offen offset:1024 sc1
v_mfma_f32_16x16x32_bf16 v[68:71], v[148:151], a[148:151], v[68:71]
s_nop 0
ds_read_b64_tr_b16 v[212:213], v9 offset:36864
ds_read_b64_tr_b16 v[214:215], v9 offset:38912
v_mfma_f32_16x16x32_bf16 v[68:71], v[164:167], a[152:155], v[68:71]
s_nop 0
ds_read_b64_tr_b16 v[216:217], v10 offset:36864
ds_read_b64_tr_b16 v[218:219], v10 offset:38912
v_mfma_f32_16x16x32_bf16 v[68:71], v[180:183], a[156:159], v[68:71]
s_nop 0
ds_read_b64_tr_b16 v[220:221], v11 offset:36864
ds_read_b64_tr_b16 v[222:223], v11 offset:38912
v_mfma_f32_16x16x32_bf16 v[52:55], v[180:183], a[140:143], v[52:55]
s_add_u32 s72, s71, 15360
buffer_load_dwordx4 v15, s[24:27], s72 offen offset:1024 lds
v_mfma_f32_16x16x32_bf16 v[52:55], v[164:167], a[136:139], v[52:55]
v_mfma_f32_16x16x32_bf16 v[52:55], v[148:151], a[132:135], v[52:55]
s_nop 0
ds_read_b64_tr_b16 v[224:225], v8 offset:40960
ds_read_b64_tr_b16 v[226:227], v8 offset:43008
v_mfma_f32_16x16x32_bf16 v[52:55], v[132:135], a[128:131], v[52:55]
s_nop 0
ds_read_b64_tr_b16 v[228:229], v9 offset:40960
ds_read_b64_tr_b16 v[230:231], v9 offset:43008
v_mfma_f32_16x16x32_bf16 v[56:59], v[136:139], a[128:131], v[56:59]
s_nop 0
ds_read_b64_tr_b16 v[232:233], v10 offset:40960
ds_read_b64_tr_b16 v[234:235], v10 offset:43008
v_mfma_f32_16x16x32_bf16 v[56:59], v[152:155], a[132:135], v[56:59]
s_add_u32 s72, s71, 30720
buffer_load_dwordx4 v15, s[24:27], s72 offen offset:2048 lds
v_mfma_f32_16x16x32_bf16 v[56:59], v[168:171], a[136:139], v[56:59]
s_nop 0
ds_read_b64_tr_b16 v[236:237], v11 offset:40960
ds_read_b64_tr_b16 v[238:239], v11 offset:43008
v_mfma_f32_16x16x32_bf16 v[56:59], v[184:187], a[140:143], v[56:59]
v_mfma_f32_16x16x32_bf16 v[72:75], v[184:187], a[156:159], v[72:75]
s_nop 0
ds_read_b64_tr_b16 v[240:241], v8 offset:45056
ds_read_b64_tr_b16 v[242:243], v8 offset:47104
v_mfma_f32_16x16x32_bf16 v[72:75], v[168:171], a[152:155], v[72:75]
buffer_load_dwordx4 a[232:235], v1, s[44:47], s69 offen offset:2048 sc1
v_mfma_f32_16x16x32_bf16 v[72:75], v[152:155], a[148:151], v[72:75]
s_nop 0
ds_read_b64_tr_b16 v[244:245], v9 offset:45056
ds_read_b64_tr_b16 v[246:247], v9 offset:47104
v_mfma_f32_16x16x32_bf16 v[72:75], v[136:139], a[144:147], v[72:75]
s_nop 0
ds_read_b64_tr_b16 v[248:249], v10 offset:45056
ds_read_b64_tr_b16 v[250:251], v10 offset:47104
v_mfma_f32_16x16x32_bf16 v[76:79], v[140:143], a[144:147], v[76:79]
s_nop 0
ds_read_b64_tr_b16 v[252:253], v11 offset:45056
ds_read_b64_tr_b16 v[254:255], v11 offset:47104
v_mfma_f32_16x16x32_bf16 v[76:79], v[156:159], a[148:151], v[76:79]
s_add_u32 s72, s71, 46080
buffer_load_dwordx4 v15, s[24:27], s72 offen offset:3072 lds
v_mfma_f32_16x16x32_bf16 v[76:79], v[172:175], a[152:155], v[76:79]
v_mfma_f32_16x16x32_bf16 v[76:79], v[188:191], a[156:159], v[76:79]
v_mfma_f32_16x16x32_bf16 v[60:63], v[188:191], a[140:143], v[60:63]
v_mfma_f32_16x16x32_bf16 v[60:63], v[172:175], a[136:139], v[60:63]
s_xor_b32 s71, s14, 0x40100
buffer_load_dwordx4 a[236:239], v1, s[44:47], s69 offen offset:3072 sc1
v_mfma_f32_16x16x32_bf16 v[60:63], v[156:159], a[132:135], v[60:63]
s_waitcnt vmcnt(15) lgkmcnt(0)
v_mfma_f32_16x16x32_bf16 v[60:63], v[140:143], a[128:131], v[60:63]
s_barrier
v_mfma_f32_16x16x32_bf16 v[80:83], v[192:195], a[128:131], v[80:83]
s_add_u32 m0, s77, 49152
ds_read_b64_tr_b16 v[128:129], v8 offset:49152
ds_read_b64_tr_b16 v[130:131], v8 offset:51200
v_mfma_f32_16x16x32_bf16 v[80:83], v[208:211], a[132:135], v[80:83]
s_add_u32 s72, s71, 0
buffer_load_dwordx4 v15, s[24:27], s72 offen lds
v_mfma_f32_16x16x32_bf16 v[80:83], v[224:227], a[136:139], v[80:83]
s_nop 0
ds_read_b64_tr_b16 v[132:133], v9 offset:49152
ds_read_b64_tr_b16 v[134:135], v9 offset:51200
s_waitcnt vmcnt(20)
v_cmp_gt_u32 vcc, 3, v114
s_cbranch_vccnz Lspin109
Lback110:
v_mfma_f32_16x16x32_bf16 v[80:83], v[240:243], a[140:143], v[80:83]
s_lshl_b32 s73, s76, 18
ds_read_b64_tr_b16 v[136:137], v10 offset:49152
ds_read_b64_tr_b16 v[138:139], v10 offset:51200
v_mfma_f32_16x16x32_bf16 v[96:99], v[240:243], a[156:159], v[96:99]
s_lshl_b32 s84, s58, 16
ds_read_b64_tr_b16 v[140:141], v11 offset:49152
ds_read_b64_tr_b16 v[142:143], v11 offset:51200
v_mfma_f32_16x16x32_bf16 v[96:99], v[224:227], a[152:155], v[96:99]
s_add_u32 s73, s73, s84
v_mfma_f32_16x16x32_bf16 v[96:99], v[208:211], a[148:151], v[96:99]
s_add_u32 s69, s69, 0x20000
buffer_load_dwordx4 a[240:243], v1, s[44:47], s69 offen sc1
v_mfma_f32_16x16x32_bf16 v[96:99], v[192:195], a[144:147], v[96:99]
s_lshl_b32 s84, s75, 8
ds_read_b64_tr_b16 v[144:145], v8 offset:53248
ds_read_b64_tr_b16 v[146:147], v8 offset:55296
v_mfma_f32_16x16x32_bf16 v[100:103], v[196:199], a[144:147], v[100:103]
s_add_u32 s73, s73, s84
ds_read_b64_tr_b16 v[148:149], v9 offset:53248
ds_read_b64_tr_b16 v[150:151], v9 offset:55296
v_mfma_f32_16x16x32_bf16 v[100:103], v[212:215], a[148:151], v[100:103]
s_add_u32 s73, s73, 0x3400000
ds_read_b64_tr_b16 v[152:153], v10 offset:53248
ds_read_b64_tr_b16 v[154:155], v10 offset:55296
v_mfma_f32_16x16x32_bf16 v[100:103], v[228:231], a[152:155], v[100:103]
s_add_u32 s72, s71, 15360
buffer_load_dwordx4 v15, s[24:27], s72 offen offset:1024 lds
v_mfma_f32_16x16x32_bf16 v[100:103], v[244:247], a[156:159], v[100:103]
v_lshrrev_b32 v112, 4, v0
v_and_b32 v113, 15, v0
v_mfma_f32_16x16x32_bf16 v[84:87], v[244:247], a[140:143], v[84:87]
s_nop 0
ds_read_b64_tr_b16 v[156:157], v11 offset:53248
ds_read_b64_tr_b16 v[158:159], v11 offset:55296
v_mfma_f32_16x16x32_bf16 v[84:87], v[228:231], a[136:139], v[84:87]
s_nop 0
ds_read_b64_tr_b16 v[160:161], v8 offset:57344
ds_read_b64_tr_b16 v[162:163], v8 offset:59392
v_mfma_f32_16x16x32_bf16 v[84:87], v[212:215], a[132:135], v[84:87]
s_nop 0
ds_read_b64_tr_b16 v[164:165], v9 offset:57344
ds_read_b64_tr_b16 v[166:167], v9 offset:59392
v_mfma_f32_16x16x32_bf16 v[84:87], v[196:199], a[128:131], v[84:87]
s_add_u32 s72, s71, 30720
buffer_load_dwordx4 v15, s[24:27], s72 offen offset:2048 lds
v_mfma_f32_16x16x32_bf16 v[88:91], v[200:203], a[128:131], v[88:91]
v_xor_b32 v12, v113, v112
v_lshlrev_b32 v12, 4, v12
v_mfma_f32_16x16x32_bf16 v[88:91], v[216:219], a[132:135], v[88:91]
s_nop 0
ds_read_b64_tr_b16 v[168:169], v10 offset:57344
ds_read_b64_tr_b16 v[170:171], v10 offset:59392
v_mfma_f32_16x16x32_bf16 v[88:91], v[232:235], a[136:139], v[88:91]
s_nop 0
ds_read_b64_tr_b16 v[172:173], v11 offset:57344
ds_read_b64_tr_b16 v[174:175], v11 offset:59392
v_mfma_f32_16x16x32_bf16 v[88:91], v[248:251], a[140:143], v[88:91]
buffer_load_dwordx4 a[244:247], v1, s[44:47], s69 offen offset:1024 sc1
v_mfma_f32_16x16x32_bf16 v[104:107], v[248:251], a[156:159], v[104:107]
s_nop 0
ds_read_b64_tr_b16 v[176:177], v8 offset:61440
ds_read_b64_tr_b16 v[178:179], v8 offset:63488
v_mfma_f32_16x16x32_bf16 v[104:107], v[232:235], a[152:155], v[104:107]
v_lshl_add_u32 v112, v112, 12, v12
v_xor_b32 v12, 64, v112
v_mfma_f32_16x16x32_bf16 v[104:107], v[216:219], a[148:151], v[104:107]
s_nop 0
ds_read_b64_tr_b16 v[180:181], v9 offset:61440
ds_read_b64_tr_b16 v[182:183], v9 offset:63488
v_mfma_f32_16x16x32_bf16 v[104:107], v[200:203], a[144:147], v[104:107]
s_add_u32 s72, s71, 46080
buffer_load_dwordx4 v15, s[24:27], s72 offen offset:3072 lds
v_mfma_f32_16x16x32_bf16 v[108:111], v[204:207], a[144:147], v[108:111]
s_nop 0
ds_read_b64_tr_b16 v[184:185], v10 offset:61440
ds_read_b64_tr_b16 v[186:187], v10 offset:63488
v_mfma_f32_16x16x32_bf16 v[108:111], v[220:223], a[148:151], v[108:111]
s_nop 0
ds_read_b64_tr_b16 v[188:189], v11 offset:61440
ds_read_b64_tr_b16 v[190:191], v11 offset:63488
v_mfma_f32_16x16x32_bf16 v[108:111], v[236:239], a[152:155], v[108:111]
v_lshlrev_b32 v113, 2, v113
v_mfma_f32_16x16x32_bf16 v[108:111], v[252:255], a[156:159], v[108:111]
s_xor_b32 s71, s15, 0x40100
buffer_load_dwordx4 a[248:251], v1, s[44:47], s69 offen offset:2048 sc1
v_mfma_f32_16x16x32_bf16 v[92:95], v[252:255], a[140:143], v[92:95]
s_add_u32 m0, s85, 0
v_xor_b32 v8, 0x10000, v8
v_mfma_f32_16x16x32_bf16 v[92:95], v[236:239], a[136:139], v[92:95]
s_add_u32 s72, s71, 0
v_xor_b32 v9, 0x10000, v9
v_mfma_f32_16x16x32_bf16 v[92:95], v[220:223], a[132:135], v[92:95]
s_waitcnt vmcnt(36) lgkmcnt(0)
v_xor_b32 v10, 0x10000, v10
v_mfma_f32_16x16x32_bf16 v[92:95], v[204:207], a[128:131], v[92:95]
s_nop 0
buffer_load_dwordx4 v15, s[24:27], s72 offen lds
v_xor_b32 v11, 0x10000, v11
v_mfma_f32_16x16x32_bf16 v[16:19], v[128:131], a[160:163], v[16:19]
s_nop 0
ds_read_b64_tr_b16 v[192:193], v8 offset:0
ds_read_b64_tr_b16 v[194:195], v8 offset:2048
v_mfma_f32_16x16x32_bf16 v[16:19], v[144:147], a[164:167], v[16:19]
s_nop 0
ds_read_b64_tr_b16 v[196:197], v9 offset:0
ds_read_b64_tr_b16 v[198:199], v9 offset:2048
v_mfma_f32_16x16x32_bf16 v[16:19], v[160:163], a[168:171], v[16:19]
s_nop 0
ds_read_b64_tr_b16 v[200:201], v10 offset:0
ds_read_b64_tr_b16 v[202:203], v10 offset:2048
v_mfma_f32_16x16x32_bf16 v[16:19], v[176:179], a[172:175], v[16:19]
v_mfma_f32_16x16x32_bf16 v[32:35], v[176:179], a[188:191], v[32:35]
buffer_load_dwordx4 a[252:255], v1, s[44:47], s69 offen offset:3072 sc1
v_mfma_f32_16x16x32_bf16 v[32:35], v[160:163], a[184:187], v[32:35]
s_nop 0
ds_read_b64_tr_b16 v[204:205], v11 offset:0
ds_read_b64_tr_b16 v[206:207], v11 offset:2048
v_mfma_f32_16x16x32_bf16 v[32:35], v[144:147], a[180:183], v[32:35]
s_nop 0
ds_read_b64_tr_b16 v[208:209], v8 offset:4096
ds_read_b64_tr_b16 v[210:211], v8 offset:6144
v_mfma_f32_16x16x32_bf16 v[32:35], v[128:131], a[176:179], v[32:35]
v_mfma_f32_16x16x32_bf16 v[36:39], v[132:135], a[176:179], v[36:39]
s_add_u32 s72, s71, 15360
buffer_load_dwordx4 v15, s[24:27], s72 offen offset:1024 lds
v_mfma_f32_16x16x32_bf16 v[36:39], v[148:151], a[180:183], v[36:39]
s_nop 0
ds_read_b64_tr_b16 v[212:213], v9 offset:4096
ds_read_b64_tr_b16 v[214:215], v9 offset:6144
v_mfma_f32_16x16x32_bf16 v[36:39], v[164:167], a[184:187], v[36:39]
s_nop 0
ds_read_b64_tr_b16 v[216:217], v10 offset:4096
ds_read_b64_tr_b16 v[218:219], v10 offset:6144
v_mfma_f32_16x16x32_bf16 v[36:39], v[180:183], a[188:191], v[36:39]
v_mfma_f32_16x16x32_bf16 v[20:23], v[180:183], a[172:175], v[20:23]
s_nop 0
ds_read_b64_tr_b16 v[220:221], v11 offset:4096
ds_read_b64_tr_b16 v[222:223], v11 offset:6144
v_mfma_f32_16x16x32_bf16 v[20:23], v[164:167], a[168:171], v[20:23]
s_add_u32 s72, s71, 30720
buffer_load_dwordx4 v15, s[24:27], s72 offen offset:2048 lds
v_mfma_f32_16x16x32_bf16 v[20:23], v[148:151], a[164:167], v[20:23]
s_nop 0
ds_read_b64_tr_b16 v[224:225], v8 offset:8192
ds_read_b64_tr_b16 v[226:227], v8 offset:10240
v_mfma_f32_16x16x32_bf16 v[20:23], v[132:135], a[160:163], v[20:23]
s_nop 0
ds_read_b64_tr_b16 v[228:229], v9 offset:8192
ds_read_b64_tr_b16 v[230:231], v9 offset:10240
v_mfma_f32_16x16x32_bf16 v[24:27], v[136:139], a[160:163], v[24:27]
v_mfma_f32_16x16x32_bf16 v[24:27], v[152:155], a[164:167], v[24:27]
s_nop 0
ds_read_b64_tr_b16 v[232:233], v10 offset:8192
ds_read_b64_tr_b16 v[234:235], v10 offset:10240
v_mfma_f32_16x16x32_bf16 v[24:27], v[168:171], a[168:171], v[24:27]
s_nop 0
ds_read_b64_tr_b16 v[236:237], v11 offset:8192
ds_read_b64_tr_b16 v[238:239], v11 offset:10240
v_mfma_f32_16x16x32_bf16 v[24:27], v[184:187], a[172:175], v[24:27]
v_mfma_f32_16x16x32_bf16 v[40:43], v[184:187], a[188:191], v[40:43]
s_add_u32 s72, s71, 46080
buffer_load_dwordx4 v15, s[24:27], s72 offen offset:3072 lds
v_mfma_f32_16x16x32_bf16 v[40:43], v[168:171], a[184:187], v[40:43]
s_nop 0
ds_read_b64_tr_b16 v[240:241], v8 offset:12288
ds_read_b64_tr_b16 v[242:243], v8 offset:14336
v_mfma_f32_16x16x32_bf16 v[40:43], v[152:155], a[180:183], v[40:43]
s_nop 0
ds_read_b64_tr_b16 v[244:245], v9 offset:12288
ds_read_b64_tr_b16 v[246:247], v9 offset:14336
v_mfma_f32_16x16x32_bf16 v[40:43], v[136:139], a[176:179], v[40:43]
v_mfma_f32_16x16x32_bf16 v[44:47], v[140:143], a[176:179], v[44:47]
s_nop 0
ds_read_b64_tr_b16 v[248:249], v10 offset:12288
ds_read_b64_tr_b16 v[250:251], v10 offset:14336
v_mfma_f32_16x16x32_bf16 v[44:47], v[156:159], a[180:183], v[44:47]
s_nop 0
ds_read_b64_tr_b16 v[252:253], v11 offset:12288
ds_read_b64_tr_b16 v[254:255], v11 offset:14336
v_mfma_f32_16x16x32_bf16 v[44:47], v[172:175], a[184:187], v[44:47]
s_xor_b32 s71, s13, 0x40180
v_mfma_f32_16x16x32_bf16 v[44:47], v[188:191], a[188:191], v[44:47]
s_add_u32 m0, s85, 16384
v_mfma_f32_16x16x32_bf16 v[28:31], v[188:191], a[172:175], v[28:31]
s_add_u32 s72, s71, 0
buffer_load_dwordx4 v15, s[24:27], s72 offen lds
v_mfma_f32_16x16x32_bf16 v[28:31], v[172:175], a[168:171], v[28:31]
v_mfma_f32_16x16x32_bf16 v[28:31], v[156:159], a[164:167], v[28:31]
s_waitcnt vmcnt(14) lgkmcnt(0)
v_mfma_f32_16x16x32_bf16 v[28:31], v[140:143], a[160:163], v[28:31]
s_barrier
v_mfma_f32_16x16x32_bf16 v[16:19], v[192:195], a[192:195], v[16:19]
s_nop 0
ds_read_b64_tr_b16 v[128:129], v8 offset:16384
ds_read_b64_tr_b16 v[130:131], v8 offset:18432
v_mfma_f32_16x16x32_bf16 v[16:19], v[208:211], a[196:199], v[16:19]
s_nop 0
ds_read_b64_tr_b16 v[132:133], v9 offset:16384
ds_read_b64_tr_b16 v[134:135], v9 offset:18432
v_mfma_f32_16x16x32_bf16 v[16:19], v[224:227], a[200:203], v[16:19]
s_nop 0
ds_read_b64_tr_b16 v[136:137], v10 offset:16384
ds_read_b64_tr_b16 v[138:139], v10 offset:18432
v_mfma_f32_16x16x32_bf16 v[16:19], v[240:243], a[204:207], v[16:19]
s_add_u32 s72, s71, 15360
buffer_load_dwordx4 v15, s[24:27], s72 offen offset:1024 lds
v_mfma_f32_16x16x32_bf16 v[32:35], v[240:243], a[220:223], v[32:35]
v_mfma_f32_16x16x32_bf16 v[32:35], v[224:227], a[216:219], v[32:35]
s_nop 0
ds_read_b64_tr_b16 v[140:141], v11 offset:16384
ds_read_b64_tr_b16 v[142:143], v11 offset:18432
v_mfma_f32_16x16x32_bf16 v[32:35], v[208:211], a[212:215], v[32:35]
s_nop 0
ds_read_b64_tr_b16 v[144:145], v8 offset:20480
ds_read_b64_tr_b16 v[146:147], v8 offset:22528
v_mfma_f32_16x16x32_bf16 v[32:35], v[192:195], a[208:211], v[32:35]
v_mfma_f32_16x16x32_bf16 v[36:39], v[196:199], a[208:211], v[36:39]
s_nop 0
ds_read_b64_tr_b16 v[148:149], v9 offset:20480
ds_read_b64_tr_b16 v[150:151], v9 offset:22528
v_mfma_f32_16x16x32_bf16 v[36:39], v[212:215], a[212:215], v[36:39]
s_nop 0
ds_read_b64_tr_b16 v[152:153], v10 offset:20480
ds_read_b64_tr_b16 v[154:155], v10 offset:22528
v_mfma_f32_16x16x32_bf16 v[36:39], v[228:231], a[216:219], v[36:39]
s_add_u32 s72, s71, 30720
buffer_load_dwordx4 v15, s[24:27], s72 offen offset:2048 lds
v_mfma_f32_16x16x32_bf16 v[36:39], v[244:247], a[220:223], v[36:39]
v_mfma_f32_16x16x32_bf16 v[20:23], v[244:247], a[204:207], v[20:23]
s_nop 0
ds_read_b64_tr_b16 v[156:157], v11 offset:20480
ds_read_b64_tr_b16 v[158:159], v11 offset:22528
v_mfma_f32_16x16x32_bf16 v[20:23], v[228:231], a[200:203], v[20:23]
s_nop 0
ds_read_b64_tr_b16 v[160:161], v8 offset:24576
ds_read_b64_tr_b16 v[162:163], v8 offset:26624
v_mfma_f32_16x16x32_bf16 v[20:23], v[212:215], a[196:199], v[20:23]
s_nop 0
ds_read_b64_tr_b16 v[164:165], v9 offset:24576
ds_read_b64_tr_b16 v[166:167], v9 offset:26624
v_mfma_f32_16x16x32_bf16 v[20:23], v[196:199], a[192:195], v[20:23]
v_mfma_f32_16x16x32_bf16 v[24:27], v[200:203], a[192:195], v[24:27]
s_nop 0
ds_read_b64_tr_b16 v[168:169], v10 offset:24576
ds_read_b64_tr_b16 v[170:171], v10 offset:26624
v_mfma_f32_16x16x32_bf16 v[24:27], v[216:219], a[196:199], v[24:27]
s_add_u32 s72, s71, 46080
buffer_load_dwordx4 v15, s[24:27], s72 offen offset:3072 lds
v_mfma_f32_16x16x32_bf16 v[24:27], v[232:235], a[200:203], v[24:27]
s_nop 0
ds_read_b64_tr_b16 v[172:173], v11 offset:24576
ds_read_b64_tr_b16 v[174:175], v11 offset:26624
v_mfma_f32_16x16x32_bf16 v[24:27], v[248:251], a[204:207], v[24:27]
v_mfma_f32_16x16x32_bf16 v[40:43], v[248:251], a[220:223], v[40:43]
s_nop 0
ds_read_b64_tr_b16 v[176:177], v8 offset:28672
ds_read_b64_tr_b16 v[178:179], v8 offset:30720
v_mfma_f32_16x16x32_bf16 v[40:43], v[232:235], a[216:219], v[40:43]
s_nop 0
ds_read_b64_tr_b16 v[180:181], v9 offset:28672
ds_read_b64_tr_b16 v[182:183], v9 offset:30720
v_mfma_f32_16x16x32_bf16 v[40:43], v[216:219], a[212:215], v[40:43]
v_mfma_f32_16x16x32_bf16 v[40:43], v[200:203], a[208:211], v[40:43]
s_nop 0
ds_read_b64_tr_b16 v[184:185], v10 offset:28672
ds_read_b64_tr_b16 v[186:187], v10 offset:30720
v_mfma_f32_16x16x32_bf16 v[44:47], v[204:207], a[208:211], v[44:47]
s_add_u32 m0, s64, 147456
ds_read_b64_tr_b16 v[188:189], v11 offset:28672
ds_read_b64_tr_b16 v[190:191], v11 offset:30720
v_mfma_f32_16x16x32_bf16 v[44:47], v[220:223], a[212:215], v[44:47]
s_add_u32 s72, s73, 0
buffer_load_dwordx4 v112, s[44:47], s72 offen sc1 lds
v_mfma_f32_16x16x32_bf16 v[44:47], v[236:239], a[216:219], v[44:47]
v_mfma_f32_16x16x32_bf16 v[44:47], v[252:255], a[220:223], v[44:47]
v_mfma_f32_16x16x32_bf16 v[28:31], v[252:255], a[204:207], v[28:31]
v_mfma_f32_16x16x32_bf16 v[28:31], v[236:239], a[200:203], v[28:31]
s_add_u32 s72, s73, 15360
buffer_load_dwordx4 v12, s[44:47], s72 offen offset:1024 sc1 lds
v_mfma_f32_16x16x32_bf16 v[28:31], v[220:223], a[196:199], v[28:31]
s_waitcnt vmcnt(9) lgkmcnt(0)
v_mfma_f32_16x16x32_bf16 v[28:31], v[204:207], a[192:195], v[28:31]
v_mfma_f32_16x16x32_bf16 v[16:19], v[128:131], a[224:227], v[16:19]
s_nop 0
ds_read_b64_tr_b16 v[192:193], v8 offset:32768
ds_read_b64_tr_b16 v[194:195], v8 offset:34816
v_mfma_f32_16x16x32_bf16 v[16:19], v[144:147], a[228:231], v[16:19]
s_add_u32 s72, s73, 30720
buffer_load_dwordx4 v112, s[44:47], s72 offen offset:2048 sc1 lds
v_mfma_f32_16x16x32_bf16 v[16:19], v[160:163], a[232:235], v[16:19]
s_nop 0
ds_read_b64_tr_b16 v[196:197], v9 offset:32768
ds_read_b64_tr_b16 v[198:199], v9 offset:34816
v_mfma_f32_16x16x32_bf16 v[16:19], v[176:179], a[236:239], v[16:19]
s_nop 0
ds_read_b64_tr_b16 v[200:201], v10 offset:32768
ds_read_b64_tr_b16 v[202:203], v10 offset:34816
v_mfma_f32_16x16x32_bf16 v[20:23], v[180:183], a[236:239], v[20:23]
s_nop 0
ds_read_b64_tr_b16 v[204:205], v11 offset:32768
ds_read_b64_tr_b16 v[206:207], v11 offset:34816
v_mfma_f32_16x16x32_bf16 v[20:23], v[164:167], a[232:235], v[20:23]
s_add_u32 s72, s73, 46080
buffer_load_dwordx4 v12, s[44:47], s72 offen offset:3072 sc1 lds
Lstube3:
s_cbranch_execz Lrete
v_mfma_f32_16x16x32_bf16 v[20:23], v[148:151], a[228:231], v[20:23]
s_lshl_b32 s73, s75, 9
ds_read_b64_tr_b16 v[208:209], v8 offset:36864
ds_read_b64_tr_b16 v[210:211], v8 offset:38912
v_mfma_f32_16x16x32_bf16 v[20:23], v[132:135], a[224:227], v[20:23]
s_xor_b32 s71, s14, 0x40180
ds_read_b64_tr_b16 v[212:213], v9 offset:36864
ds_read_b64_tr_b16 v[214:215], v9 offset:38912
v_mfma_f32_16x16x32_bf16 v[24:27], v[136:139], a[224:227], v[24:27]
s_add_u32 m0, s85, 32768
v_mfma_f32_16x16x32_bf16 v[24:27], v[152:155], a[228:231], v[24:27]
s_add_u32 s72, s71, 0
buffer_load_dwordx4 v15, s[24:27], s72 offen lds
v_mfma_f32_16x16x32_bf16 v[24:27], v[168:171], a[232:235], v[24:27]
s_lshl_b32 s84, s58, 7
ds_read_b64_tr_b16 v[216:217], v10 offset:36864
ds_read_b64_tr_b16 v[218:219], v10 offset:38912
v_mfma_f32_16x16x32_bf16 v[24:27], v[184:187], a[236:239], v[24:27]
s_add_u32 s73, s73, s84
ds_read_b64_tr_b16 v[220:221], v11 offset:36864
ds_read_b64_tr_b16 v[222:223], v11 offset:38912
v_cvt_pk_bf16_f32 v16, v16, v17
v_mfma_f32_16x16x32_bf16 v[28:31], v[188:191], a[236:239], v[28:31]
s_add_u32 s73, s73, 0x3800000
ds_read_b64_tr_b16 v[224:225], v8 offset:40960
ds_read_b64_tr_b16 v[226:227], v8 offset:43008
v_cvt_pk_bf16_f32 v17, v18, v19
v_mfma_f32_16x16x32_bf16 v[28:31], v[172:175], a[232:235], v[28:31]
s_add_u32 s72, s71, 15360
buffer_load_dwordx4 v15, s[24:27], s72 offen offset:1024 lds
v_cvt_pk_bf16_f32 v18, v20, v21
v_mfma_f32_16x16x32_bf16 v[28:31], v[156:159], a[228:231], v[28:31]
s_nop 0
ds_read_b64_tr_b16 v[228:229], v9 offset:40960
ds_read_b64_tr_b16 v[230:231], v9 offset:43008
v_cvt_pk_bf16_f32 v19, v22, v23
v_mfma_f32_16x16x32_bf16 v[28:31], v[140:143], a[224:227], v[28:31]
s_nop 0
ds_read_b64_tr_b16 v[232:233], v10 offset:40960
ds_read_b64_tr_b16 v[234:235], v10 offset:43008
v_mfma_f32_16x16x32_bf16 v[32:35], v[128:131], a[240:243], v[32:35]
s_xor_b32 s80, s93, 0x100000
buffer_load_dword v6, v113, s[44:47], s73 offen sc1
v_mfma_f32_16x16x32_bf16 v[32:35], v[144:147], a[244:247], v[32:35]
s_add_u32 s72, s71, 30720
buffer_load_dwordx4 v15, s[24:27], s72 offen offset:2048 lds
v_mfma_f32_16x16x32_bf16 v[32:35], v[160:163], a[248:251], v[32:35]
s_add_u32 s80, s80, 0x3a00000
buffer_store_dwordx4 v[16:19], v1, s[44:47], s80 offen sc1
v_mfma_f32_16x16x32_bf16 v[32:35], v[176:179], a[252:255], v[32:35]
s_nop 0
ds_read_b64_tr_b16 v[236:237], v11 offset:40960
ds_read_b64_tr_b16 v[238:239], v11 offset:43008
v_cvt_pk_bf16_f32 v20, v24, v25
v_mfma_f32_16x16x32_bf16 v[36:39], v[180:183], a[252:255], v[36:39]
s_nop 0
ds_read_b64_tr_b16 v[240:241], v8 offset:45056
ds_read_b64_tr_b16 v[242:243], v8 offset:47104
v_cvt_pk_bf16_f32 v21, v26, v27
v_mfma_f32_16x16x32_bf16 v[36:39], v[164:167], a[248:251], v[36:39]
s_add_u32 s72, s71, 46080
buffer_load_dwordx4 v15, s[24:27], s72 offen offset:3072 lds
v_cvt_pk_bf16_f32 v22, v28, v29
v_mfma_f32_16x16x32_bf16 v[36:39], v[148:151], a[244:247], v[36:39]
s_nop 0
ds_read_b64_tr_b16 v[244:245], v9 offset:45056
ds_read_b64_tr_b16 v[246:247], v9 offset:47104
v_cvt_pk_bf16_f32 v23, v30, v31
v_mfma_f32_16x16x32_bf16 v[36:39], v[132:135], a[240:243], v[36:39]
s_xor_b32 s71, s15, 0x40180
ds_read_b64_tr_b16 v[248:249], v10 offset:45056
ds_read_b64_tr_b16 v[250:251], v10 offset:47104
v_mfma_f32_16x16x32_bf16 v[40:43], v[136:139], a[240:243], v[40:43]
s_add_u32 m0, s85, 49152
ds_read_b64_tr_b16 v[252:253], v11 offset:45056
ds_read_b64_tr_b16 v[254:255], v11 offset:47104
v_mfma_f32_16x16x32_bf16 v[40:43], v[152:155], a[244:247], v[40:43]
s_add_u32 s72, s71, 0
buffer_load_dwordx4 v15, s[24:27], s72 offen lds
v_mfma_f32_16x16x32_bf16 v[40:43], v[168:171], a[248:251], v[40:43]
buffer_load_dword v7, v113, s[44:47], s73 offen offset:64 sc1
v_mfma_f32_16x16x32_bf16 v[40:43], v[184:187], a[252:255], v[40:43]
v_cvt_pk_bf16_f32 v24, v32, v33
v_cvt_pk_bf16_f32 v25, v34, v35
v_cvt_pk_bf16_f32 v26, v36, v37
v_mfma_f32_16x16x32_bf16 v[44:47], v[188:191], a[252:255], v[44:47]
v_cvt_pk_bf16_f32 v27, v38, v39
v_mfma_f32_16x16x32_bf16 v[44:47], v[172:175], a[248:251], v[44:47]
s_add_u32 s72, s71, 15360
v_mfma_f32_16x16x32_bf16 v[44:47], v[156:159], a[244:247], v[44:47]
s_waitcnt vmcnt(16) lgkmcnt(0)
buffer_load_dwordx4 v15, s[24:27], s72 offen offset:1024 lds
v_mfma_f32_16x16x32_bf16 v[44:47], v[140:143], a[240:243], v[44:47]
s_barrier
v_mfma_f32_16x16x32_bf16 v[48:51], v[192:195], a[160:163], v[48:51]
s_nop 0
ds_read_b64_tr_b16 v[128:129], v8 offset:49152
ds_read_b64_tr_b16 v[130:131], v8 offset:51200
v_mfma_f32_16x16x32_bf16 v[48:51], v[208:211], a[164:167], v[48:51]
s_nop 0
ds_read_b64_tr_b16 v[132:133], v9 offset:49152
ds_read_b64_tr_b16 v[134:135], v9 offset:51200
v_mfma_f32_16x16x32_bf16 v[48:51], v[224:227], a[168:171], v[48:51]
buffer_store_dwordx4 v[20:23], v1, s[44:47], s80 offen offset:1024 sc1
v_mfma_f32_16x16x32_bf16 v[48:51], v[240:243], a[172:175], v[48:51]
s_nop 0
ds_read_b64_tr_b16 v[136:137], v10 offset:49152
ds_read_b64_tr_b16 v[138:139], v10 offset:51200
v_cvt_pk_bf16_f32 v28, v40, v41
v_mfma_f32_16x16x32_bf16 v[64:67], v[240:243], a[188:191], v[64:67]
v_cvt_pk_bf16_f32 v29, v42, v43
v_cvt_pk_bf16_f32 v30, v44, v45
v_cvt_pk_bf16_f32 v31, v46, v47
v_mfma_f32_16x16x32_bf16 v[64:67], v[224:227], a[184:187], v[64:67]
s_nop 0
ds_read_b64_tr_b16 v[140:141], v11 offset:49152
ds_read_b64_tr_b16 v[142:143], v11 offset:51200
v_mfma_f32_16x16x32_bf16 v[64:67], v[208:211], a[180:183], v[64:67]
s_add_u32 s72, s71, 30720
buffer_load_dwordx4 v15, s[24:27], s72 offen offset:2048 lds
v_mfma_f32_16x16x32_bf16 v[64:67], v[192:195], a[176:179], v[64:67]
s_nop 0
ds_read_b64_tr_b16 v[144:145], v8 offset:53248
ds_read_b64_tr_b16 v[146:147], v8 offset:55296
v_mfma_f32_16x16x32_bf16 v[68:71], v[196:199], a[176:179], v[68:71]
s_nop 0
ds_read_b64_tr_b16 v[148:149], v9 offset:53248
ds_read_b64_tr_b16 v[150:151], v9 offset:55296
v_mfma_f32_16x16x32_bf16 v[68:71], v[212:215], a[180:183], v[68:71]
v_mfma_f32_16x16x32_bf16 v[68:71], v[228:231], a[184:187], v[68:71]
s_nop 0
ds_read_b64_tr_b16 v[152:153], v10 offset:53248
ds_read_b64_tr_b16 v[154:155], v10 offset:55296
v_mfma_f32_16x16x32_bf16 v[68:71], v[244:247], a[188:191], v[68:71]
s_nop 0
ds_read_b64_tr_b16 v[156:157], v11 offset:53248
ds_read_b64_tr_b16 v[158:159], v11 offset:55296
v_mfma_f32_16x16x32_bf16 v[52:55], v[244:247], a[172:175], v[52:55]
v_mfma_f32_16x16x32_bf16 v[52:55], v[228:231], a[168:171], v[52:55]
s_add_u32 s72, s71, 46080
buffer_load_dwordx4 v15, s[24:27], s72 offen offset:3072 lds
v_mfma_f32_16x16x32_bf16 v[52:55], v[212:215], a[164:167], v[52:55]
s_nop 0
ds_read_b64_tr_b16 v[160:161], v8 offset:57344
ds_read_b64_tr_b16 v[162:163], v8 offset:59392
v_mfma_f32_16x16x32_bf16 v[52:55], v[196:199], a[160:163], v[52:55]
s_nop 0
ds_read_b64_tr_b16 v[164:165], v9 offset:57344
ds_read_b64_tr_b16 v[166:167], v9 offset:59392
v_mfma_f32_16x16x32_bf16 v[56:59], v[200:203], a[160:163], v[56:59]
s_nop 0
ds_read_b64_tr_b16 v[168:169], v10 offset:57344
ds_read_b64_tr_b16 v[170:171], v10 offset:59392
v_mfma_f32_16x16x32_bf16 v[56:59], v[216:219], a[164:167], v[56:59]
v_mfma_f32_16x16x32_bf16 v[56:59], v[232:235], a[168:171], v[56:59]
buffer_store_dwordx4 v[24:27], v1, s[44:47], s80 offen offset:2048 sc1
v_mfma_f32_16x16x32_bf16 v[56:59], v[248:251], a[172:175], v[56:59]
s_xor_b32 s71, s12, 0x0
ds_read_b64_tr_b16 v[172:173], v11 offset:57344
ds_read_b64_tr_b16 v[174:175], v11 offset:59392
v_mfma_f32_16x16x32_bf16 v[72:75], v[248:251], a[188:191], v[72:75]
s_add_u32 m0, s77, 0
ds_read_b64_tr_b16 v[176:177], v8 offset:61440
ds_read_b64_tr_b16 v[178:179], v8 offset:63488
v_mfma_f32_16x16x32_bf16 v[72:75], v[232:235], a[184:187], v[72:75]
s_add_u32 s72, s71, 0
buffer_load_dwordx4 v15, s[24:27], s72 offen lds
v_mfma_f32_16x16x32_bf16 v[72:75], v[216:219], a[180:183], v[72:75]
s_nop 0
ds_read_b64_tr_b16 v[180:181], v9 offset:61440
ds_read_b64_tr_b16 v[182:183], v9 offset:63488
v_mfma_f32_16x16x32_bf16 v[72:75], v[200:203], a[176:179], v[72:75]
v_mfma_f32_16x16x32_bf16 v[76:79], v[204:207], a[176:179], v[76:79]
s_nop 0
ds_read_b64_tr_b16 v[184:185], v10 offset:61440
ds_read_b64_tr_b16 v[186:187], v10 offset:63488
v_mfma_f32_16x16x32_bf16 v[76:79], v[220:223], a[180:183], v[76:79]
s_nop 0
ds_read_b64_tr_b16 v[188:189], v11 offset:61440
ds_read_b64_tr_b16 v[190:191], v11 offset:63488
v_mfma_f32_16x16x32_bf16 v[76:79], v[236:239], a[184:187], v[76:79]
v_mfma_f32_16x16x32_bf16 v[76:79], v[252:255], a[188:191], v[76:79]
v_mfma_f32_16x16x32_bf16 v[60:63], v[252:255], a[172:175], v[60:63]
s_add_u32 s72, s71, 15360
buffer_load_dwordx4 v15, s[24:27], s72 offen offset:1024 lds
v_xor_b32 v8, 0x10000, v8
v_mfma_f32_16x16x32_bf16 v[60:63], v[236:239], a[168:171], v[60:63]
v_xor_b32 v9, 0x10000, v9
v_mfma_f32_16x16x32_bf16 v[60:63], v[220:223], a[164:167], v[60:63]
s_waitcnt lgkmcnt(0)
v_xor_b32 v10, 0x10000, v10
v_mfma_f32_16x16x32_bf16 v[60:63], v[204:207], a[160:163], v[60:63]
v_xor_b32 v11, 0x10000, v11
v_mfma_f32_16x16x32_bf16 v[48:51], v[128:131], a[192:195], v[48:51]
s_nop 0
ds_read_b64_tr_b16 v[192:193], v8 offset:0
ds_read_b64_tr_b16 v[194:195], v8 offset:2048
v_mfma_f32_16x16x32_bf16 v[48:51], v[144:147], a[196:199], v[48:51]
s_nop 0
ds_read_b64_tr_b16 v[196:197], v9 offset:0
ds_read_b64_tr_b16 v[198:199], v9 offset:2048
v_mfma_f32_16x16x32_bf16 v[48:51], v[160:163], a[200:203], v[48:51]
s_nop 0
ds_read_b64_tr_b16 v[200:201], v10 offset:0
ds_read_b64_tr_b16 v[202:203], v10 offset:2048
v_mfma_f32_16x16x32_bf16 v[48:51], v[176:179], a[204:207], v[48:51]
v_mfma_f32_16x16x32_bf16 v[64:67], v[176:179], a[220:223], v[64:67]
s_add_u32 s72, s71, 30720
buffer_load_dwordx4 v15, s[24:27], s72 offen offset:2048 lds
v_mfma_f32_16x16x32_bf16 v[64:67], v[160:163], a[216:219], v[64:67]
s_nop 0
ds_read_b64_tr_b16 v[204:205], v11 offset:0
ds_read_b64_tr_b16 v[206:207], v11 offset:2048
v_mfma_f32_16x16x32_bf16 v[64:67], v[144:147], a[212:215], v[64:67]
s_nop 0
ds_read_b64_tr_b16 v[208:209], v8 offset:4096
ds_read_b64_tr_b16 v[210:211], v8 offset:6144
v_mfma_f32_16x16x32_bf16 v[64:67], v[128:131], a[208:211], v[64:67]
buffer_store_dwordx4 v[28:31], v1, s[44:47], s80 offen offset:3072 sc1
v_mfma_f32_16x16x32_bf16 v[68:71], v[132:135], a[208:211], v[68:71]
s_nop 0
ds_read_b64_tr_b16 v[212:213], v9 offset:4096
ds_read_b64_tr_b16 v[214:215], v9 offset:6144
v_mfma_f32_16x16x32_bf16 v[68:71], v[148:151], a[212:215], v[68:71]
v_mfma_f32_16x16x32_bf16 v[68:71], v[164:167], a[216:219], v[68:71]
s_nop 0
ds_read_b64_tr_b16 v[216:217], v10 offset:4096
ds_read_b64_tr_b16 v[218:219], v10 offset:6144
v_mfma_f32_16x16x32_bf16 v[68:71], v[180:183], a[220:223], v[68:71]
s_add_u32 s72, s71, 46080
buffer_load_dwordx4 v15, s[24:27], s72 offen offset:3072 lds
v_mfma_f32_16x16x32_bf16 v[52:55], v[180:183], a[204:207], v[52:55]
s_nop 0
ds_read_b64_tr_b16 v[220:221], v11 offset:4096
ds_read_b64_tr_b16 v[222:223], v11 offset:6144
v_mfma_f32_16x16x32_bf16 v[52:55], v[164:167], a[200:203], v[52:55]
v_mfma_f32_16x16x32_bf16 v[52:55], v[148:151], a[196:199], v[52:55]
s_nop 0
ds_read_b64_tr_b16 v[224:225], v8 offset:8192
ds_read_b64_tr_b16 v[226:227], v8 offset:10240
v_mfma_f32_16x16x32_bf16 v[52:55], v[132:135], a[192:195], v[52:55]
s_nop 0
ds_read_b64_tr_b16 v[228:229], v9 offset:8192
ds_read_b64_tr_b16 v[230:231], v9 offset:10240
v_mfma_f32_16x16x32_bf16 v[56:59], v[136:139], a[192:195], v[56:59]
s_nop 0
ds_read_b64_tr_b16 v[232:233], v10 offset:8192
ds_read_b64_tr_b16 v[234:235], v10 offset:10240
v_mfma_f32_16x16x32_bf16 v[56:59], v[152:155], a[196:199], v[56:59]
s_xor_b32 s71, s13, 0x0
v_mfma_f32_16x16x32_bf16 v[56:59], v[168:171], a[200:203], v[56:59]
s_add_u32 m0, s77, 16384
ds_read_b64_tr_b16 v[236:237], v11 offset:8192
ds_read_b64_tr_b16 v[238:239], v11 offset:10240
v_mfma_f32_16x16x32_bf16 v[56:59], v[184:187], a[204:207], v[56:59]
s_add_u32 s72, s71, 0
buffer_load_dwordx4 v15, s[24:27], s72 offen lds
v_mfma_f32_16x16x32_bf16 v[72:75], v[184:187], a[220:223], v[72:75]
s_nop 0
ds_read_b64_tr_b16 v[240:241], v8 offset:12288
ds_read_b64_tr_b16 v[242:243], v8 offset:14336
v_mfma_f32_16x16x32_bf16 v[72:75], v[168:171], a[216:219], v[72:75]
s_nop 0
ds_read_b64_tr_b16 v[244:245], v9 offset:12288
ds_read_b64_tr_b16 v[246:247], v9 offset:14336
v_mfma_f32_16x16x32_bf16 v[72:75], v[152:155], a[212:215], v[72:75]
v_mfma_f32_16x16x32_bf16 v[72:75], v[136:139], a[208:211], v[72:75]
s_nop 0
ds_read_b64_tr_b16 v[248:249], v10 offset:12288
ds_read_b64_tr_b16 v[250:251], v10 offset:14336
v_mfma_f32_16x16x32_bf16 v[76:79], v[140:143], a[208:211], v[76:79]
s_nop 0
ds_read_b64_tr_b16 v[252:253], v11 offset:12288
ds_read_b64_tr_b16 v[254:255], v11 offset:14336
v_mfma_f32_16x16x32_bf16 v[76:79], v[156:159], a[212:215], v[76:79]
v_mfma_f32_16x16x32_bf16 v[76:79], v[172:175], a[216:219], v[76:79]
s_add_u32 s72, s71, 15360
buffer_load_dwordx4 v15, s[24:27], s72 offen offset:1024 lds
v_mfma_f32_16x16x32_bf16 v[76:79], v[188:191], a[220:223], v[76:79]
v_mfma_f32_16x16x32_bf16 v[60:63], v[188:191], a[204:207], v[60:63]
v_mfma_f32_16x16x32_bf16 v[60:63], v[172:175], a[200:203], v[60:63]
v_mfma_f32_16x16x32_bf16 v[60:63], v[156:159], a[196:199], v[60:63]
s_waitcnt vmcnt(14) lgkmcnt(0)
v_mfma_f32_16x16x32_bf16 v[60:63], v[140:143], a[192:195], v[60:63]
s_barrier
v_mfma_f32_16x16x32_bf16 v[48:51], v[192:195], a[224:227], v[48:51]
s_nop 0
ds_read_b64_tr_b16 v[128:129], v8 offset:16384
ds_read_b64_tr_b16 v[130:131], v8 offset:18432
v_mfma_f32_16x16x32_bf16 v[48:51], v[208:211], a[228:231], v[48:51]
s_add_u32 s72, s71, 30720
buffer_load_dwordx4 v15, s[24:27], s72 offen offset:2048 lds
v_mfma_f32_16x16x32_bf16 v[48:51], v[224:227], a[232:235], v[48:51]
s_nop 0
ds_read_b64_tr_b16 v[132:133], v9 offset:16384
ds_read_b64_tr_b16 v[134:135], v9 offset:18432
v_mfma_f32_16x16x32_bf16 v[48:51], v[240:243], a[236:239], v[48:51]
s_nop 0
ds_read_b64_tr_b16 v[136:137], v10 offset:16384
ds_read_b64_tr_b16 v[138:139], v10 offset:18432
v_mfma_f32_16x16x32_bf16 v[52:55], v[244:247], a[236:239], v[52:55]
v_mfma_f32_16x16x32_bf16 v[52:55], v[228:231], a[232:235], v[52:55]
s_nop 0
ds_read_b64_tr_b16 v[140:141], v11 offset:16384
ds_read_b64_tr_b16 v[142:143], v11 offset:18432
v_mfma_f32_16x16x32_bf16 v[52:55], v[212:215], a[228:231], v[52:55]
s_nop 0
ds_read_b64_tr_b16 v[144:145], v8 offset:20480
ds_read_b64_tr_b16 v[146:147], v8 offset:22528
v_mfma_f32_16x16x32_bf16 v[52:55], v[196:199], a[224:227], v[52:55]
s_nop 0
ds_read_b64_tr_b16 v[148:149], v9 offset:20480
ds_read_b64_tr_b16 v[150:151], v9 offset:22528
v_mfma_f32_16x16x32_bf16 v[56:59], v[200:203], a[224:227], v[56:59]
s_add_u32 s72, s71, 46080
buffer_load_dwordx4 v15, s[24:27], s72 offen offset:3072 lds
v_mfma_f32_16x16x32_bf16 v[56:59], v[216:219], a[228:231], v[56:59]
v_mfma_f32_16x16x32_bf16 v[56:59], v[232:235], a[232:235], v[56:59]
s_nop 0
ds_read_b64_tr_b16 v[152:153], v10 offset:20480
ds_read_b64_tr_b16 v[154:155], v10 offset:22528
v_mfma_f32_16x16x32_bf16 v[56:59], v[248:251], a[236:239], v[56:59]
s_nop 0
ds_read_b64_tr_b16 v[156:157], v11 offset:20480
ds_read_b64_tr_b16 v[158:159], v11 offset:22528
v_cvt_pk_bf16_f32 v48, v48, v49
v_mfma_f32_16x16x32_bf16 v[60:63], v[252:255], a[236:239], v[60:63]
v_cvt_pk_bf16_f32 v49, v50, v51
v_cvt_pk_bf16_f32 v50, v52, v53
v_cvt_pk_bf16_f32 v51, v54, v55
v_mfma_f32_16x16x32_bf16 v[60:63], v[236:239], a[232:235], v[60:63]
s_nop 0
ds_read_b64_tr_b16 v[160:161], v8 offset:24576
ds_read_b64_tr_b16 v[162:163], v8 offset:26624
v_mfma_f32_16x16x32_bf16 v[60:63], v[220:223], a[228:231], v[60:63]
s_xor_b32 s71, s14, 0x0
ds_read_b64_tr_b16 v[164:165], v9 offset:24576
ds_read_b64_tr_b16 v[166:167], v9 offset:26624
v_mfma_f32_16x16x32_bf16 v[60:63], v[204:207], a[224:227], v[60:63]
s_add_u32 m0, s77, 32768
ds_read_b64_tr_b16 v[168:169], v10 offset:24576
ds_read_b64_tr_b16 v[170:171], v10 offset:26624
v_mfma_f32_16x16x32_bf16 v[64:67], v[192:195], a[240:243], v[64:67]
s_add_u32 s72, s71, 0
buffer_load_dwordx4 v15, s[24:27], s72 offen lds
v_mfma_f32_16x16x32_bf16 v[64:67], v[208:211], a[244:247], v[64:67]
v_mfma_f32_16x16x32_bf16 v[64:67], v[224:227], a[248:251], v[64:67]
s_xor_b32 s80, s93, 0x200000
ds_read_b64_tr_b16 v[172:173], v11 offset:24576
ds_read_b64_tr_b16 v[174:175], v11 offset:26624
v_mfma_f32_16x16x32_bf16 v[64:67], v[240:243], a[252:255], v[64:67]
s_add_u32 s80, s80, 0x3e00000
buffer_store_dwordx4 v[48:51], v1, s[44:47], s80 offen sc1
v_cvt_pk_bf16_f32 v52, v56, v57
v_mfma_f32_16x16x32_bf16 v[68:71], v[244:247], a[252:255], v[68:71]
s_nop 0
ds_read_b64_tr_b16 v[176:177], v8 offset:28672
ds_read_b64_tr_b16 v[178:179], v8 offset:30720
v_cvt_pk_bf16_f32 v53, v58, v59
v_mfma_f32_16x16x32_bf16 v[68:71], v[228:231], a[248:251], v[68:71]
s_nop 0
ds_read_b64_tr_b16 v[180:181], v9 offset:28672
ds_read_b64_tr_b16 v[182:183], v9 offset:30720
v_cvt_pk_bf16_f32 v54, v60, v61
v_mfma_f32_16x16x32_bf16 v[68:71], v[212:215], a[244:247], v[68:71]
v_cvt_pk_bf16_f32 v55, v62, v63
v_mfma_f32_16x16x32_bf16 v[68:71], v[196:199], a[240:243], v[68:71]
s_add_u32 s72, s71, 15360
buffer_load_dwordx4 v15, s[24:27], s72 offen offset:1024 lds
v_mfma_f32_16x16x32_bf16 v[72:75], v[200:203], a[240:243], v[72:75]
s_nop 0
ds_read_b64_tr_b16 v[184:185], v10 offset:28672
ds_read_b64_tr_b16 v[186:187], v10 offset:30720
v_mfma_f32_16x16x32_bf16 v[72:75], v[216:219], a[244:247], v[72:75]
s_nop 0
ds_read_b64_tr_b16 v[188:189], v11 offset:28672
ds_read_b64_tr_b16 v[190:191], v11 offset:30720
v_mfma_f32_16x16x32_bf16 v[72:75], v[232:235], a[248:251], v[72:75]
v_mfma_f32_16x16x32_bf16 v[72:75], v[248:251], a[252:255], v[72:75]
v_cvt_pk_bf16_f32 v56, v64, v65
v_cvt_pk_bf16_f32 v57, v66, v67
v_cvt_pk_bf16_f32 v58, v68, v69
v_mfma_f32_16x16x32_bf16 v[76:79], v[252:255], a[252:255], v[76:79]
v_cvt_pk_bf16_f32 v59, v70, v71
v_mfma_f32_16x16x32_bf16 v[76:79], v[236:239], a[248:251], v[76:79]
s_add_u32 s72, s71, 30720
v_mfma_f32_16x16x32_bf16 v[76:79], v[220:223], a[244:247], v[76:79]
s_waitcnt lgkmcnt(0)
v_mfma_f32_16x16x32_bf16 v[76:79], v[204:207], a[240:243], v[76:79]
buffer_load_dwordx4 v15, s[24:27], s72 offen offset:2048 lds
v_mfma_f32_16x16x32_bf16 v[80:83], v[128:131], a[160:163], v[80:83]
s_waitcnt vmcnt(18)
ds_read_b64_tr_b16 v[192:193], v8 offset:32768
ds_read_b64_tr_b16 v[194:195], v8 offset:34816
v_mfma_f32_16x16x32_bf16 v[80:83], v[144:147], a[164:167], v[80:83]
s_nop 0
ds_read_b64_tr_b16 v[196:197], v9 offset:32768
ds_read_b64_tr_b16 v[198:199], v9 offset:34816
v_mfma_f32_16x16x32_bf16 v[80:83], v[160:163], a[168:171], v[80:83]
s_nop 0
ds_read_b64_tr_b16 v[200:201], v10 offset:32768
ds_read_b64_tr_b16 v[202:203], v10 offset:34816
v_mfma_f32_16x16x32_bf16 v[80:83], v[176:179], a[172:175], v[80:83]
s_nop 0
buffer_store_dwordx4 v[52:55], v1, s[44:47], s80 offen offset:1024 sc1
v_cvt_pk_bf16_f32 v60, v72, v73
v_mfma_f32_16x16x32_bf16 v[96:99], v[176:179], a[188:191], v[96:99]
v_cvt_pk_bf16_f32 v61, v74, v75
v_cvt_pk_bf16_f32 v62, v76, v77
v_cvt_pk_bf16_f32 v63, v78, v79
v_mfma_f32_16x16x32_bf16 v[96:99], v[160:163], a[184:187], v[96:99]
s_nop 0
ds_read_b64_tr_b16 v[204:205], v11 offset:32768
ds_read_b64_tr_b16 v[206:207], v11 offset:34816
v_mfma_f32_16x16x32_bf16 v[96:99], v[144:147], a[180:183], v[96:99]
s_add_u32 s72, s71, 46080
buffer_load_dwordx4 v15, s[24:27], s72 offen offset:3072 lds
v_mfma_f32_16x16x32_bf16 v[96:99], v[128:131], a[176:179], v[96:99]
s_nop 0
ds_read_b64_tr_b16 v[208:209], v8 offset:36864
ds_read_b64_tr_b16 v[210:211], v8 offset:38912
v_mfma_f32_16x16x32_bf16 v[100:103], v[132:135], a[176:179], v[100:103]
s_nop 0
ds_read_b64_tr_b16 v[212:213], v9 offset:36864
ds_read_b64_tr_b16 v[214:215], v9 offset:38912
v_mfma_f32_16x16x32_bf16 v[100:103], v[148:151], a[180:183], v[100:103]
v_sub_f32 v112, 1.0, v6
v_sub_f32 v113, 1.0, v7
v_mfma_f32_16x16x32_bf16 v[100:103], v[164:167], a[184:187], v[100:103]
s_nop 0
ds_read_b64_tr_b16 v[216:217], v10 offset:36864
ds_read_b64_tr_b16 v[218:219], v10 offset:38912
v_mfma_f32_16x16x32_bf16 v[100:103], v[180:183], a[188:191], v[100:103]
s_nop 0
ds_read_b64_tr_b16 v[220:221], v11 offset:36864
ds_read_b64_tr_b16 v[222:223], v11 offset:38912
v_mfma_f32_16x16x32_bf16 v[84:87], v[180:183], a[172:175], v[84:87]
s_xor_b32 s71, s15, 0x0
v_mfma_f32_16x16x32_bf16 v[84:87], v[164:167], a[168:171], v[84:87]
s_add_u32 m0, s77, 49152
ds_read_b64_tr_b16 v[224:225], v8 offset:40960
ds_read_b64_tr_b16 v[226:227], v8 offset:43008
v_mfma_f32_16x16x32_bf16 v[84:87], v[148:151], a[164:167], v[84:87]
s_add_u32 s72, s71, 0
buffer_load_dwordx4 v15, s[24:27], s72 offen lds
v_mfma_f32_16x16x32_bf16 v[84:87], v[132:135], a[160:163], v[84:87]
s_nop 0
ds_read_b64_tr_b16 v[228:229], v9 offset:40960
ds_read_b64_tr_b16 v[230:231], v9 offset:43008
v_mfma_f32_16x16x32_bf16 v[88:91], v[136:139], a[160:163], v[88:91]
s_nop 0
ds_read_b64_tr_b16 v[232:233], v10 offset:40960
ds_read_b64_tr_b16 v[234:235], v10 offset:43008
v_mfma_f32_16x16x32_bf16 v[88:91], v[152:155], a[164:167], v[88:91]
v_mfma_f32_16x16x32_bf16 v[88:91], v[168:171], a[168:171], v[88:91]
s_nop 0
ds_read_b64_tr_b16 v[236:237], v11 offset:40960
ds_read_b64_tr_b16 v[238:239], v11 offset:43008
v_mfma_f32_16x16x32_bf16 v[88:91], v[184:187], a[172:175], v[88:91]
s_nop 0
ds_read_b64_tr_b16 v[240:241], v8 offset:45056
ds_read_b64_tr_b16 v[242:243], v8 offset:47104
v_mfma_f32_16x16x32_bf16 v[104:107], v[184:187], a[188:191], v[104:107]
s_nop 0
ds_read_b64_tr_b16 v[244:245], v9 offset:45056
ds_read_b64_tr_b16 v[246:247], v9 offset:47104
v_mfma_f32_16x16x32_bf16 v[104:107], v[168:171], a[184:187], v[104:107]
s_add_u32 s72, s71, 15360
buffer_load_dwordx4 v15, s[24:27], s72 offen offset:1024 lds
v_mfma_f32_16x16x32_bf16 v[104:107], v[152:155], a[180:183], v[104:107]
v_mfma_f32_16x16x32_bf16 v[104:107], v[136:139], a[176:179], v[104:107]
s_nop 0
ds_read_b64_tr_b16 v[248:249], v10 offset:45056
ds_read_b64_tr_b16 v[250:251], v10 offset:47104
v_mfma_f32_16x16x32_bf16 v[108:111], v[140:143], a[176:179], v[108:111]
buffer_store_dwordx4 v[56:59], v1, s[44:47], s80 offen offset:2048 sc1
v_mfma_f32_16x16x32_bf16 v[108:111], v[156:159], a[180:183], v[108:111]
s_nop 0
ds_read_b64_tr_b16 v[252:253], v11 offset:45056
ds_read_b64_tr_b16 v[254:255], v11 offset:47104
v_mfma_f32_16x16x32_bf16 v[108:111], v[172:175], a[184:187], v[108:111]
v_mfma_f32_16x16x32_bf16 v[108:111], v[188:191], a[188:191], v[108:111]
v_mfma_f32_16x16x32_bf16 v[92:95], v[188:191], a[172:175], v[92:95]
v_mfma_f32_16x16x32_bf16 v[92:95], v[172:175], a[168:171], v[92:95]
s_add_u32 s72, s71, 30720
buffer_load_dwordx4 v15, s[24:27], s72 offen offset:2048 lds
v_mfma_f32_16x16x32_bf16 v[92:95], v[156:159], a[164:167], v[92:95]
s_waitcnt vmcnt(14) lgkmcnt(0)
v_mfma_f32_16x16x32_bf16 v[92:95], v[140:143], a[160:163], v[92:95]
s_barrier
v_mfma_f32_16x16x32_bf16 v[80:83], v[192:195], a[192:195], v[80:83]
s_nop 0
ds_read_b64_tr_b16 v[128:129], v8 offset:49152
ds_read_b64_tr_b16 v[130:131], v8 offset:51200
v_mfma_f32_16x16x32_bf16 v[80:83], v[208:211], a[196:199], v[80:83]
s_nop 0
ds_read_b64_tr_b16 v[132:133], v9 offset:49152
ds_read_b64_tr_b16 v[134:135], v9 offset:51200
v_mfma_f32_16x16x32_bf16 v[80:83], v[224:227], a[200:203], v[80:83]
s_nop 0
ds_read_b64_tr_b16 v[136:137], v10 offset:49152
ds_read_b64_tr_b16 v[138:139], v10 offset:51200
v_mfma_f32_16x16x32_bf16 v[80:83], v[240:243], a[204:207], v[80:83]
v_mfma_f32_16x16x32_bf16 v[96:99], v[240:243], a[220:223], v[96:99]
s_add_u32 s72, s71, 46080
buffer_load_dwordx4 v15, s[24:27], s72 offen offset:3072 lds
v_mfma_f32_16x16x32_bf16 v[96:99], v[224:227], a[216:219], v[96:99]
s_nop 0
ds_read_b64_tr_b16 v[140:141], v11 offset:49152
ds_read_b64_tr_b16 v[142:143], v11 offset:51200
v_mfma_f32_16x16x32_bf16 v[96:99], v[208:211], a[212:215], v[96:99]
s_nop 0
ds_read_b64_tr_b16 v[144:145], v8 offset:53248
ds_read_b64_tr_b16 v[146:147], v8 offset:55296
v_mfma_f32_16x16x32_bf16 v[96:99], v[192:195], a[208:211], v[96:99]
s_nop 0
ds_read_b64_tr_b16 v[148:149], v9 offset:53248
ds_read_b64_tr_b16 v[150:151], v9 offset:55296
v_mfma_f32_16x16x32_bf16 v[100:103], v[196:199], a[208:211], v[100:103]
buffer_store_dwordx4 v[60:63], v1, s[44:47], s80 offen offset:3072 sc1
v_mfma_f32_16x16x32_bf16 v[100:103], v[212:215], a[212:215], v[100:103]
s_nop 0
ds_read_b64 v[48:49], v116 offset:0
ds_read_b64_tr_b16 v[64:65], v5 offset:0
v_mfma_f32_16x16x32_bf16 v[100:103], v[228:231], a[216:219], v[100:103]
s_xor_b32 s71, s12, 0x40000
ds_read_b64_tr_b16 v[152:153], v10 offset:53248
ds_read_b64_tr_b16 v[154:155], v10 offset:55296
v_mfma_f32_16x16x32_bf16 v[100:103], v[244:247], a[220:223], v[100:103]
s_add_u32 m0, s85, 0
ds_read_b64_tr_b16 v[156:157], v11 offset:53248
ds_read_b64_tr_b16 v[158:159], v11 offset:55296
v_mfma_f32_16x16x32_bf16 v[84:87], v[244:247], a[204:207], v[84:87]
s_add_u32 s72, s71, 0
buffer_load_dwordx4 v15, s[24:27], s72 offen lds
v_mfma_f32_16x16x32_bf16 v[84:87], v[228:231], a[200:203], v[84:87]
s_nop 0
ds_read_b64 v[50:51], v117 offset:0
ds_read_b64_tr_b16 v[66:67], v5 offset:4096
v_mfma_f32_16x16x32_bf16 v[84:87], v[212:215], a[196:199], v[84:87]
s_nop 0
ds_read_b64_tr_b16 v[160:161], v8 offset:57344
ds_read_b64_tr_b16 v[162:163], v8 offset:59392
v_mfma_f32_16x16x32_bf16 v[84:87], v[196:199], a[192:195], v[84:87]
s_nop 0
ds_read_b64_tr_b16 v[164:165], v9 offset:57344
ds_read_b64_tr_b16 v[166:167], v9 offset:59392
v_mfma_f32_16x16x32_bf16 v[88:91], v[200:203], a[192:195], v[88:91]
s_nop 0
ds_read_b64_tr_b16 v[168:169], v10 offset:57344
ds_read_b64_tr_b16 v[170:171], v10 offset:59392
v_mfma_f32_16x16x32_bf16 v[88:91], v[216:219], a[196:199], v[88:91]
s_nop 0
ds_read_b64 v[52:53], v118 offset:0
ds_read_b64_tr_b16 v[68:69], v5 offset:8192
v_mfma_f32_16x16x32_bf16 v[88:91], v[232:235], a[200:203], v[88:91]
s_nop 0
ds_read_b64_tr_b16 v[172:173], v11 offset:57344
ds_read_b64_tr_b16 v[174:175], v11 offset:59392
v_mfma_f32_16x16x32_bf16 v[88:91], v[248:251], a[204:207], v[88:91]
s_add_u32 s72, s71, 15360
buffer_load_dwordx4 v15, s[24:27], s72 offen offset:1024 lds
v_mfma_f32_16x16x32_bf16 v[104:107], v[248:251], a[220:223], v[104:107]
Lstube4:
s_cbranch_execz Lrete
s_nop 0
ds_read_b64_tr_b16 v[176:177], v8 offset:61440
ds_read_b64_tr_b16 v[178:179], v8 offset:63488
v_mfma_f32_16x16x32_bf16 v[104:107], v[232:235], a[216:219], v[104:107]
s_nop 0
ds_read_b64_tr_b16 v[180:181], v9 offset:61440
ds_read_b64_tr_b16 v[182:183], v9 offset:63488
v_mfma_f32_16x16x32_bf16 v[104:107], v[216:219], a[212:215], v[104:107]
s_nop 0
ds_read_b64 v[54:55], v119 offset:0
ds_read_b64_tr_b16 v[70:71], v5 offset:12288
v_mfma_f32_16x16x32_bf16 v[104:107], v[200:203], a[208:211], v[104:107]
s_nop 0
ds_read_b64_tr_b16 v[184:185], v10 offset:61440
ds_read_b64_tr_b16 v[186:187], v10 offset:63488
v_mfma_f32_16x16x32_bf16 v[108:111], v[204:207], a[208:211], v[108:111]
s_nop 0
ds_read_b64_tr_b16 v[188:189], v11 offset:61440
ds_read_b64_tr_b16 v[190:191], v11 offset:63488
v_mfma_f32_16x16x32_bf16 v[108:111], v[220:223], a[212:215], v[108:111]
v_xor_b32 v5, 16, v5
v_mfma_f32_16x16x32_bf16 v[108:111], v[236:239], a[216:219], v[108:111]
s_add_u32 s72, s71, 30720
buffer_load_dwordx4 v15, s[24:27], s72 offen offset:2048 lds
v_mfma_f32_16x16x32_bf16 v[108:111], v[252:255], a[220:223], v[108:111]
s_nop 0
ds_read_b64 v[56:57], v116 offset:2048
ds_read_b64_tr_b16 v[72:73], v5 offset:0
v_mfma_f32_16x16x32_bf16 v[92:95], v[252:255], a[204:207], v[92:95]
ds_read_b64 v[58:59], v117 offset:2048
v_xor_b32 v8, 0x10000, v8
v_mfma_f32_16x16x32_bf16 v[92:95], v[236:239], a[200:203], v[92:95]
ds_read_b64_tr_b16 v[74:75], v5 offset:4096
v_xor_b32 v9, 0x10000, v9
v_mfma_f32_16x16x32_bf16 v[92:95], v[220:223], a[196:199], v[92:95]
s_waitcnt lgkmcnt(0)
ds_read_b64 v[60:61], v118 offset:2048
v_xor_b32 v10, 0x10000, v10
v_mfma_f32_16x16x32_bf16 v[92:95], v[204:207], a[192:195], v[92:95]
ds_read_b64_tr_b16 v[76:77], v5 offset:8192
v_xor_b32 v11, 0x10000, v11
v_mfma_f32_16x16x32_bf16 v[80:83], v[128:131], a[224:227], v[80:83]
s_nop 0
ds_read_b64_tr_b16 v[192:193], v8 offset:0
ds_read_b64_tr_b16 v[194:195], v8 offset:2048
v_mfma_f32_16x16x32_bf16 v[80:83], v[144:147], a[228:231], v[80:83]
s_add_u32 s72, s71, 46080
buffer_load_dwordx4 v15, s[24:27], s72 offen offset:3072 lds
v_mfma_f32_16x16x32_bf16 v[80:83], v[160:163], a[232:235], v[80:83]
s_nop 0
ds_read_b64_tr_b16 v[196:197], v9 offset:0
ds_read_b64_tr_b16 v[198:199], v9 offset:2048
v_mfma_f32_16x16x32_bf16 v[80:83], v[176:179], a[236:239], v[80:83]
s_nop 0
ds_read_b64_tr_b16 v[200:201], v10 offset:0
ds_read_b64_tr_b16 v[202:203], v10 offset:2048
v_mfma_f32_16x16x32_bf16 v[84:87], v[180:183], a[236:239], v[84:87]
s_nop 0
ds_read_b64 v[62:63], v119 offset:2048
ds_read_b64_tr_b16 v[78:79], v5 offset:12288
v_mfma_f32_16x16x32_bf16 v[84:87], v[164:167], a[232:235], v[84:87]
s_nop 0
ds_read_b64_tr_b16 v[204:205], v11 offset:0
ds_read_b64_tr_b16 v[206:207], v11 offset:2048
v_mfma_f32_16x16x32_bf16 v[84:87], v[148:151], a[228:231], v[84:87]
s_nop 0
ds_read_b64_tr_b16 v[208:209], v8 offset:4096
ds_read_b64_tr_b16 v[210:211], v8 offset:6144
v_mfma_f32_16x16x32_bf16 v[84:87], v[132:135], a[224:227], v[84:87]
s_xor_b32 s71, s13, 0x40000
ds_read_b64_tr_b16 v[212:213], v9 offset:4096
ds_read_b64_tr_b16 v[214:215], v9 offset:6144
v_mfma_f32_16x16x32_bf16 v[88:91], v[136:139], a[224:227], v[88:91]
s_add_u32 m0, s85, 16384
v_mfma_f32_16x16x32_bf16 v[88:91], v[152:155], a[228:231], v[88:91]
s_add_u32 s72, s71, 0
buffer_load_dwordx4 v15, s[24:27], s72 offen lds
v_mfma_f32_16x16x32_bf16 v[88:91], v[168:171], a[232:235], v[88:91]
s_waitcnt lgkmcnt(6)
ds_read_b64_tr_b16 v[216:217], v10 offset:4096
ds_read_b64_tr_b16 v[218:219], v10 offset:6144
v_mfma_f32_16x16x32_bf16 v[88:91], v[184:187], a[236:239], v[88:91]
s_nop 0
ds_read_b64_tr_b16 v[220:221], v11 offset:4096
ds_read_b64_tr_b16 v[222:223], v11 offset:6144
v_cvt_pk_bf16_f32 v80, v80, v81
v_mfma_f32_16x16x32_bf16 v[92:95], v[188:191], a[236:239], v[92:95]
v_cvt_pk_bf16_f32 v81, v82, v83
v_cvt_pk_bf16_f32 v82, v84, v85
v_cvt_pk_bf16_f32 v83, v86, v87
v_mfma_f32_16x16x32_bf16 v[92:95], v[172:175], a[232:235], v[92:95]
s_nop 0
ds_read_b64_tr_b16 v[224:225], v8 offset:8192
ds_read_b64_tr_b16 v[226:227], v8 offset:10240
v_mfma_f32_16x16x32_bf16 v[92:95], v[156:159], a[228:231], v[92:95]
s_nop 0
ds_read_b64_tr_b16 v[228:229], v9 offset:8192
ds_read_b64_tr_b16 v[230:231], v9 offset:10240
v_mfma_f32_16x16x32_bf16 v[92:95], v[140:143], a[224:227], v[92:95]
s_nop 0
ds_read_b64_tr_b16 v[232:233], v10 offset:8192
ds_read_b64_tr_b16 v[234:235], v10 offset:10240
v_mfma_f32_16x16x32_bf16 v[96:99], v[128:131], a[240:243], v[96:99]
s_add_u32 s72, s71, 15360
buffer_load_dwordx4 v15, s[24:27], s72 offen offset:1024 lds
v_mfma_f32_16x16x32_bf16 v[96:99], v[144:147], a[244:247], v[96:99]
v_and_b32 v114, 0xffff0000, v48
v_lshlrev_b32 v115, 16, v64
v_mfma_f32_16x16x32_bf16 v[96:99], v[160:163], a[248:251], v[96:99]
s_xor_b32 s80, s93, 0x300000
ds_read_b64_tr_b16 v[236:237], v11 offset:8192
ds_read_b64_tr_b16 v[238:239], v11 offset:10240
v_mfma_f32_16x16x32_bf16 v[96:99], v[176:179], a[252:255], v[96:99]
s_add_u32 s80, s80, 0x4200000
buffer_store_dwordx4 v[80:83], v1, s[44:47], s80 offen sc1
v_cvt_pk_bf16_f32 v84, v88, v89
v_mfma_f32_16x16x32_bf16 v[100:103], v[180:183], a[252:255], v[100:103]
s_nop 0
ds_read_b64_tr_b16 v[240:241], v8 offset:12288
ds_read_b64_tr_b16 v[242:243], v8 offset:14336
v_cvt_pk_bf16_f32 v85, v90, v91
v_mfma_f32_16x16x32_bf16 v[100:103], v[164:167], a[248:251], v[100:103]
s_nop 0
ds_read_b64_tr_b16 v[244:245], v9 offset:12288
ds_read_b64_tr_b16 v[246:247], v9 offset:14336
v_cvt_pk_bf16_f32 v86, v92, v93
v_mfma_f32_16x16x32_bf16 v[100:103], v[148:151], a[244:247], v[100:103]
v_cvt_pk_bf16_f32 v87, v94, v95
v_lshlrev_b32 v48, 16, v48
v_mfma_f32_16x16x32_bf16 v[100:103], v[132:135], a[240:243], v[100:103]
s_nop 0
ds_read_b64_tr_b16 v[248:249], v10 offset:12288
ds_read_b64_tr_b16 v[250:251], v10 offset:14336
v_mfma_f32_16x16x32_bf16 v[104:107], v[136:139], a[240:243], v[104:107]
s_add_u32 s72, s71, 30720
buffer_load_dwordx4 v15, s[24:27], s72 offen offset:2048 lds
v_mfma_f32_16x16x32_bf16 v[104:107], v[152:155], a[244:247], v[104:107]
s_nop 0
ds_read_b64_tr_b16 v[252:253], v11 offset:12288
ds_read_b64_tr_b16 v[254:255], v11 offset:14336
v_mfma_f32_16x16x32_bf16 v[104:107], v[168:171], a[248:251], v[104:107]
v_and_b32 v64, 0xffff0000, v64
v_mul_f32 v48, v48, v112
v_mfma_f32_16x16x32_bf16 v[104:107], v[184:187], a[252:255], v[104:107]
v_cvt_pk_bf16_f32 v88, v96, v97
v_cvt_pk_bf16_f32 v89, v98, v99
v_cvt_pk_bf16_f32 v90, v100, v101
v_mfma_f32_16x16x32_bf16 v[108:111], v[188:191], a[252:255], v[108:111]
v_cvt_pk_bf16_f32 v91, v102, v103
v_mul_f32 v114, v114, v112
v_mfma_f32_16x16x32_bf16 v[108:111], v[172:175], a[248:251], v[108:111]
s_add_u32 s72, s71, 46080
v_mul_f32 v48, v48, v115
v_mul_f32 v64, v64, v114
v_mfma_f32_16x16x32_bf16 v[108:111], v[156:159], a[244:247], v[108:111]
s_waitcnt vmcnt(14) lgkmcnt(0)
v_and_b32 v114, 0xffff0000, v49
v_lshlrev_b32 v115, 16, v65
v_mfma_f32_16x16x32_bf16 v[108:111], v[140:143], a[240:243], v[108:111]
s_barrier
buffer_load_dwordx4 v15, s[24:27], s72 offen offset:3072 lds
v_mfma_f32_16x16x32_bf16 v[16:19], v[192:195], a[0:3], 0
s_nop 0
ds_read_b64_tr_b16 v[128:129], v8 offset:16384
ds_read_b64_tr_b16 v[130:131], v8 offset:18432
v_mfma_f32_16x16x32_bf16 v[16:19], v[208:211], a[4:7], v[16:19]
s_nop 0
ds_read_b64_tr_b16 v[132:133], v9 offset:16384
ds_read_b64_tr_b16 v[134:135], v9 offset:18432
v_mfma_f32_16x16x32_bf16 v[16:19], v[224:227], a[8:11], v[16:19]
s_nop 0
ds_read_b64_tr_b16 v[136:137], v10 offset:16384
ds_read_b64_tr_b16 v[138:139], v10 offset:18432
v_mfma_f32_16x16x32_bf16 v[16:19], v[240:243], a[12:15], v[16:19]
s_nop 0
buffer_store_dwordx4 v[84:87], v1, s[44:47], s80 offen offset:1024 sc1
v_cvt_pk_bf16_f32 v92, v104, v105
v_mfma_f32_16x16x32_bf16 v[32:35], v[240:243], a[28:31], 0
v_cvt_pk_bf16_f32 v93, v106, v107
v_cvt_pk_bf16_f32 v94, v108, v109
v_cvt_pk_bf16_f32 v95, v110, v111
v_mfma_f32_16x16x32_bf16 v[32:35], v[224:227], a[24:27], v[32:35]
s_xor_b32 s71, s14, 0x40000
ds_read_b64_tr_b16 v[140:141], v11 offset:16384
ds_read_b64_tr_b16 v[142:143], v11 offset:18432
v_mfma_f32_16x16x32_bf16 v[32:35], v[208:211], a[20:23], v[32:35]
s_add_u32 m0, s85, 32768
ds_read_b64_tr_b16 v[144:145], v8 offset:20480
ds_read_b64_tr_b16 v[146:147], v8 offset:22528
v_mfma_f32_16x16x32_bf16 v[32:35], v[192:195], a[16:19], v[32:35]
s_add_u32 s72, s71, 0
buffer_load_dwordx4 v15, s[24:27], s72 offen lds
v_mfma_f32_16x16x32_bf16 v[36:39], v[196:199], a[16:19], 0
s_nop 0
ds_read_b64_tr_b16 v[148:149], v9 offset:20480
ds_read_b64_tr_b16 v[150:151], v9 offset:22528
v_mfma_f32_16x16x32_bf16 v[36:39], v[212:215], a[20:23], v[36:39]
v_lshlrev_b32 v49, 16, v49
v_and_b32 v65, 0xffff0000, v65
v_mfma_f32_16x16x32_bf16 v[36:39], v[228:231], a[24:27], v[36:39]
s_nop 0
ds_read_b64_tr_b16 v[152:153], v10 offset:20480
ds_read_b64_tr_b16 v[154:155], v10 offset:22528
v_mfma_f32_16x16x32_bf16 v[36:39], v[244:247], a[28:31], v[36:39]
s_nop 0
ds_read_b64_tr_b16 v[156:157], v11 offset:20480
ds_read_b64_tr_b16 v[158:159], v11 offset:22528
v_mfma_f32_16x16x32_bf16 v[20:23], v[244:247], a[12:15], 0
v_mul_f32 v49, v49, v112
v_mul_f32 v114, v114, v112
v_mfma_f32_16x16x32_bf16 v[20:23], v[228:231], a[8:11], v[20:23]
s_nop 0
ds_read_b64_tr_b16 v[160:161], v8 offset:24576
ds_read_b64_tr_b16 v[162:163], v8 offset:26624
v_mfma_f32_16x16x32_bf16 v[20:23], v[212:215], a[4:7], v[20:23]
s_add_u32 s72, s71, 15360
buffer_load_dwordx4 v15, s[24:27], s72 offen offset:1024 lds
v_mfma_f32_16x16x32_bf16 v[20:23], v[196:199], a[0:3], v[20:23]
s_nop 0
ds_read_b64_tr_b16 v[164:165], v9 offset:24576
ds_read_b64_tr_b16 v[166:167], v9 offset:26624
v_mfma_f32_16x16x32_bf16 v[24:27], v[200:203], a[0:3], 0
s_nop 0
ds_read_b64_tr_b16 v[168:169], v10 offset:24576
ds_read_b64_tr_b16 v[170:171], v10 offset:26624
v_mfma_f32_16x16x32_bf16 v[24:27], v[216:219], a[4:7], v[24:27]
v_mul_f32 v49, v49, v115
v_mul_f32 v65, v65, v114
v_mfma_f32_16x16x32_bf16 v[24:27], v[232:235], a[8:11], v[24:27]
s_nop 0
ds_read_b64_tr_b16 v[172:173], v11 offset:24576
ds_read_b64_tr_b16 v[174:175], v11 offset:26624
v_mfma_f32_16x16x32_bf16 v[24:27], v[248:251], a[12:15], v[24:27]
buffer_store_dwordx4 v[88:91], v1, s[44:47], s80 offen offset:2048 sc1
v_mfma_f32_16x16x32_bf16 v[40:43], v[248:251], a[28:31], 0
s_nop 0
ds_read_b64_tr_b16 v[176:177], v8 offset:28672
ds_read_b64_tr_b16 v[178:179], v8 offset:30720
v_mfma_f32_16x16x32_bf16 v[40:43], v[232:235], a[24:27], v[40:43]
s_nop 0
ds_read_b64_tr_b16 v[180:181], v9 offset:28672
ds_read_b64_tr_b16 v[182:183], v9 offset:30720
v_mfma_f32_16x16x32_bf16 v[40:43], v[216:219], a[20:23], v[40:43]
s_add_u32 s72, s71, 30720
buffer_load_dwordx4 v15, s[24:27], s72 offen offset:2048 lds
v_mfma_f32_16x16x32_bf16 v[40:43], v[200:203], a[16:19], v[40:43]
v_and_b32 v114, 0xffff0000, v50
v_lshlrev_b32 v115, 16, v66
v_mfma_f32_16x16x32_bf16 v[44:47], v[204:207], a[16:19], 0
s_nop 0
ds_read_b64_tr_b16 v[184:185], v10 offset:28672
ds_read_b64_tr_b16 v[186:187], v10 offset:30720
v_mfma_f32_16x16x32_bf16 v[44:47], v[220:223], a[20:23], v[44:47]
s_nop 0
ds_read_b64_tr_b16 v[188:189], v11 offset:28672
ds_read_b64_tr_b16 v[190:191], v11 offset:30720
v_mfma_f32_16x16x32_bf16 v[44:47], v[236:239], a[24:27], v[44:47]
v_lshlrev_b32 v50, 16, v50
v_and_b32 v66, 0xffff0000, v66
v_mfma_f32_16x16x32_bf16 v[44:47], v[252:255], a[28:31], v[44:47]
v_mul_f32 v50, v50, v112
v_mul_f32 v114, v114, v112
v_mfma_f32_16x16x32_bf16 v[28:31], v[252:255], a[12:15], 0
v_mul_f32 v50, v50, v115
v_mul_f32 v66, v66, v114
v_mfma_f32_16x16x32_bf16 v[28:31], v[236:239], a[8:11], v[28:31]
s_add_u32 s72, s71, 46080
buffer_load_dwordx4 v15, s[24:27], s72 offen offset:3072 lds
v_mfma_f32_16x16x32_bf16 v[28:31], v[220:223], a[4:7], v[28:31]
s_waitcnt lgkmcnt(0)
v_and_b32 v114, 0xffff0000, v51
v_lshlrev_b32 v115, 16, v67
v_mfma_f32_16x16x32_bf16 v[28:31], v[204:207], a[0:3], v[28:31]
v_lshlrev_b32 v51, 16, v51
v_and_b32 v67, 0xffff0000, v67
v_mfma_f32_16x16x32_bf16 v[16:19], v[128:131], a[32:35], v[16:19]
s_nop 0
ds_read_b64_tr_b16 v[192:193], v8 offset:32768
ds_read_b64_tr_b16 v[194:195], v8 offset:34816
v_mfma_f32_16x16x32_bf16 v[16:19], v[144:147], a[36:39], v[16:19]
s_nop 0
ds_read_b64_tr_b16 v[196:197], v9 offset:32768
ds_read_b64_tr_b16 v[198:199], v9 offset:34816
v_mfma_f32_16x16x32_bf16 v[16:19], v[160:163], a[40:43], v[16:19]
s_nop 0
ds_read_b64_tr_b16 v[200:201], v10 offset:32768
ds_read_b64_tr_b16 v[202:203], v10 offset:34816
v_mfma_f32_16x16x32_bf16 v[16:19], v[176:179], a[44:47], v[16:19]
s_xor_b32 s71, s15, 0x40000
v_mul_f32 v51, v51, v112
v_mul_f32 v114, v114, v112
v_mfma_f32_16x16x32_bf16 v[32:35], v[176:179], a[60:63], v[32:35]
s_add_u32 m0, s85, 49152
ds_read_b64_tr_b16 v[204:205], v11 offset:32768
ds_read_b64_tr_b16 v[206:207], v11 offset:34816
v_mfma_f32_16x16x32_bf16 v[32:35], v[160:163], a[56:59], v[32:35]
s_add_u32 s72, s71, 0
buffer_load_dwordx4 v15, s[24:27], s72 offen lds
v_mfma_f32_16x16x32_bf16 v[32:35], v[144:147], a[52:55], v[32:35]
s_nop 0
ds_read_b64_tr_b16 v[208:209], v8 offset:36864
ds_read_b64_tr_b16 v[210:211], v8 offset:38912
v_mfma_f32_16x16x32_bf16 v[32:35], v[128:131], a[48:51], v[32:35]
v_mul_f32 v51, v51, v115
v_mul_f32 v67, v67, v114
v_mfma_f32_16x16x32_bf16 v[36:39], v[132:135], a[48:51], v[36:39]
buffer_store_dwordx4 v[92:95], v1, s[44:47], s80 offen offset:3072 sc1
v_mfma_f32_16x16x32_bf16 v[36:39], v[148:151], a[52:55], v[36:39]
s_nop 0
ds_read_b64_tr_b16 v[212:213], v9 offset:36864
ds_read_b64_tr_b16 v[214:215], v9 offset:38912
v_mfma_f32_16x16x32_bf16 v[36:39], v[164:167], a[56:59], v[36:39]
s_nop 0
ds_read_b64_tr_b16 v[216:217], v10 offset:36864
ds_read_b64_tr_b16 v[218:219], v10 offset:38912
v_mfma_f32_16x16x32_bf16 v[36:39], v[180:183], a[60:63], v[36:39]
v_and_b32 v114, 0xffff0000, v52
v_lshlrev_b32 v115, 16, v68
v_mfma_f32_16x16x32_bf16 v[20:23], v[180:183], a[44:47], v[20:23]
s_add_u32 s72, s71, 15360
buffer_load_dwordx4 v15, s[24:27], s72 offen offset:1024 lds
v_mfma_f32_16x16x32_bf16 v[20:23], v[164:167], a[40:43], v[20:23]
s_nop 0
ds_read_b64_tr_b16 v[220:221], v11 offset:36864
ds_read_b64_tr_b16 v[222:223], v11 offset:38912
v_mfma_f32_16x16x32_bf16 v[20:23], v[148:151], a[36:39], v[20:23]
s_nop 0
ds_read_b64_tr_b16 v[224:225], v8 offset:40960
ds_read_b64_tr_b16 v[226:227], v8 offset:43008
v_mfma_f32_16x16x32_bf16 v[20:23], v[132:135], a[32:35], v[20:23]
s_nop 0
ds_read_b64_tr_b16 v[228:229], v9 offset:40960
ds_read_b64_tr_b16 v[230:231], v9 offset:43008
v_mfma_f32_16x16x32_bf16 v[24:27], v[136:139], a[32:35], v[24:27]
v_lshlrev_b32 v52, 16, v52
v_and_b32 v68, 0xffff0000, v68
v_mfma_f32_16x16x32_bf16 v[24:27], v[152:155], a[36:39], v[24:27]
s_nop 0
ds_read_b64_tr_b16 v[232:233], v10 offset:40960
ds_read_b64_tr_b16 v[234:235], v10 offset:43008
v_mfma_f32_16x16x32_bf16 v[24:27], v[168:171], a[40:43], v[24:27]
s_nop 0
ds_read_b64_tr_b16 v[236:237], v11 offset:40960
ds_read_b64_tr_b16 v[238:239], v11 offset:43008
v_mfma_f32_16x16x32_bf16 v[24:27], v[184:187], a[44:47], v[24:27]
v_mul_f32 v52, v52, v112
v_mul_f32 v114, v114, v112
v_mfma_f32_16x16x32_bf16 v[40:43], v[184:187], a[60:63], v[40:43]
s_add_u32 s72, s71, 30720
buffer_load_dwordx4 v15, s[24:27], s72 offen offset:2048 lds
v_mfma_f32_16x16x32_bf16 v[40:43], v[168:171], a[56:59], v[40:43]
s_nop 0
ds_read_b64_tr_b16 v[240:241], v8 offset:45056
ds_read_b64_tr_b16 v[242:243], v8 offset:47104
v_mfma_f32_16x16x32_bf16 v[40:43], v[152:155], a[52:55], v[40:43]
s_nop 0
ds_read_b64_tr_b16 v[244:245], v9 offset:45056
ds_read_b64_tr_b16 v[246:247], v9 offset:47104
v_mfma_f32_16x16x32_bf16 v[40:43], v[136:139], a[48:51], v[40:43]
v_mul_f32 v52, v52, v115
v_mul_f32 v68, v68, v114
v_mfma_f32_16x16x32_bf16 v[44:47], v[140:143], a[48:51], v[44:47]
s_nop 0
ds_read_b64_tr_b16 v[248:249], v10 offset:45056
ds_read_b64_tr_b16 v[250:251], v10 offset:47104
v_mfma_f32_16x16x32_bf16 v[44:47], v[156:159], a[52:55], v[44:47]
s_nop 0
ds_read_b64_tr_b16 v[252:253], v11 offset:45056
ds_read_b64_tr_b16 v[254:255], v11 offset:47104
v_mfma_f32_16x16x32_bf16 v[44:47], v[172:175], a[56:59], v[44:47]
v_and_b32 v114, 0xffff0000, v53
v_lshlrev_b32 v115, 16, v69
v_mfma_f32_16x16x32_bf16 v[44:47], v[188:191], a[60:63], v[44:47]
s_add_u32 s72, s71, 46080
buffer_load_dwordx4 v15, s[24:27], s72 offen offset:3072 lds
v_mfma_f32_16x16x32_bf16 v[28:31], v[188:191], a[44:47], v[28:31]
v_lshlrev_b32 v53, 16, v53
v_and_b32 v69, 0xffff0000, v69
v_mfma_f32_16x16x32_bf16 v[28:31], v[172:175], a[40:43], v[28:31]
s_add_u32 s79, s93, 0x3a00000
v_mul_f32 v53, v53, v112
v_mul_f32 v114, v114, v112
v_mfma_f32_16x16x32_bf16 v[28:31], v[156:159], a[36:39], v[28:31]
s_waitcnt vmcnt(16) lgkmcnt(0)
buffer_load_dwordx4 v[96:99], v1, s[44:47], s79 offen sc1
v_mfma_f32_16x16x32_bf16 v[28:31], v[140:143], a[32:35], v[28:31]
s_barrier
v_mul_f32 v53, v53, v115
v_mul_f32 v69, v69, v114
v_mfma_f32_16x16x32_bf16 v[16:19], v[192:195], a[64:67], v[16:19]
s_nop 0
ds_read_b64_tr_b16 v[128:129], v8 offset:49152
ds_read_b64_tr_b16 v[130:131], v8 offset:51200
v_mfma_f32_16x16x32_bf16 v[16:19], v[208:211], a[68:71], v[16:19]
s_nop 0
ds_read_b64_tr_b16 v[132:133], v9 offset:49152
ds_read_b64_tr_b16 v[134:135], v9 offset:51200
v_mfma_f32_16x16x32_bf16 v[16:19], v[224:227], a[72:75], v[16:19]
v_and_b32 v114, 0xffff0000, v54
v_lshlrev_b32 v115, 16, v70
v_mfma_f32_16x16x32_bf16 v[16:19], v[240:243], a[76:79], v[16:19]
buffer_load_dwordx4 v[100:103], v1, s[44:47], s79 offen offset:1024 sc1
v_mfma_f32_16x16x32_bf16 v[32:35], v[240:243], a[92:95], v[32:35]
s_nop 0
ds_read_b64_tr_b16 v[136:137], v10 offset:49152
ds_read_b64_tr_b16 v[138:139], v10 offset:51200
v_mfma_f32_16x16x32_bf16 v[32:35], v[224:227], a[88:91], v[32:35]
s_nop 0
ds_read_b64_tr_b16 v[140:141], v11 offset:49152
ds_read_b64_tr_b16 v[142:143], v11 offset:51200
v_mfma_f32_16x16x32_bf16 v[32:35], v[208:211], a[84:87], v[32:35]
v_lshlrev_b32 v54, 16, v54
v_and_b32 v70, 0xffff0000, v70
v_mfma_f32_16x16x32_bf16 v[32:35], v[192:195], a[80:83], v[32:35]
s_nop 0
ds_read_b64_tr_b16 v[144:145], v8 offset:53248
ds_read_b64_tr_b16 v[146:147], v8 offset:55296
v_mfma_f32_16x16x32_bf16 v[36:39], v[196:199], a[80:83], v[36:39]
buffer_load_dwordx4 v[104:107], v1, s[44:47], s79 offen offset:2048 sc1
v_mfma_f32_16x16x32_bf16 v[36:39], v[212:215], a[84:87], v[36:39]
s_nop 0
ds_read_b64_tr_b16 v[148:149], v9 offset:53248
ds_read_b64_tr_b16 v[150:151], v9 offset:55296
v_mfma_f32_16x16x32_bf16 v[36:39], v[228:231], a[88:91], v[36:39]
v_mul_f32 v54, v54, v112
v_mul_f32 v114, v114, v112
v_mfma_f32_16x16x32_bf16 v[36:39], v[244:247], a[92:95], v[36:39]
s_nop 0
ds_read_b64_tr_b16 v[152:153], v10 offset:53248
ds_read_b64_tr_b16 v[154:155], v10 offset:55296
v_mfma_f32_16x16x32_bf16 v[20:23], v[244:247], a[76:79], v[20:23]
s_nop 0
ds_read_b64_tr_b16 v[156:157], v11 offset:53248
ds_read_b64_tr_b16 v[158:159], v11 offset:55296
v_mfma_f32_16x16x32_bf16 v[20:23], v[228:231], a[72:75], v[20:23]
buffer_load_dwordx4 v[108:111], v1, s[44:47], s79 offen offset:3072 sc1
v_mfma_f32_16x16x32_bf16 v[20:23], v[212:215], a[68:71], v[20:23]
v_mul_f32 v54, v54, v115
v_mul_f32 v70, v70, v114
v_mfma_f32_16x16x32_bf16 v[20:23], v[196:199], a[64:67], v[20:23]
s_nop 0
ds_read_b64_tr_b16 v[160:161], v8 offset:57344
ds_read_b64_tr_b16 v[162:163], v8 offset:59392
v_mfma_f32_16x16x32_bf16 v[24:27], v[200:203], a[64:67], v[24:27]
s_nop 0
ds_read_b64_tr_b16 v[164:165], v9 offset:57344
ds_read_b64_tr_b16 v[166:167], v9 offset:59392
v_mfma_f32_16x16x32_bf16 v[24:27], v[216:219], a[68:71], v[24:27]
v_and_b32 v114, 0xffff0000, v55
v_lshlrev_b32 v115, 16, v71
v_mfma_f32_16x16x32_bf16 v[24:27], v[232:235], a[72:75], v[24:27]
s_nop 0
ds_read_b64_tr_b16 v[168:169], v10 offset:57344
ds_read_b64_tr_b16 v[170:171], v10 offset:59392
v_mfma_f32_16x16x32_bf16 v[24:27], v[248:251], a[76:79], v[24:27]
s_nop 0
ds_read_b64_tr_b16 v[172:173], v11 offset:57344
ds_read_b64_tr_b16 v[174:175], v11 offset:59392
v_mfma_f32_16x16x32_bf16 v[40:43], v[248:251], a[92:95], v[40:43]
v_lshlrev_b32 v55, 16, v55
v_and_b32 v71, 0xffff0000, v71
v_mfma_f32_16x16x32_bf16 v[40:43], v[232:235], a[88:91], v[40:43]
s_nop 0
ds_read_b64_tr_b16 v[176:177], v8 offset:61440
ds_read_b64_tr_b16 v[178:179], v8 offset:63488
v_mfma_f32_16x16x32_bf16 v[40:43], v[216:219], a[84:87], v[40:43]
s_nop 0
ds_read_b64_tr_b16 v[180:181], v9 offset:61440
ds_read_b64_tr_b16 v[182:183], v9 offset:63488
v_mfma_f32_16x16x32_bf16 v[40:43], v[200:203], a[80:83], v[40:43]
v_mul_f32 v55, v55, v112
v_mul_f32 v114, v114, v112
v_mfma_f32_16x16x32_bf16 v[44:47], v[204:207], a[80:83], v[44:47]
s_nop 0
ds_read_b64_tr_b16 v[184:185], v10 offset:61440
ds_read_b64_tr_b16 v[186:187], v10 offset:63488
v_mfma_f32_16x16x32_bf16 v[44:47], v[220:223], a[84:87], v[44:47]
s_nop 0
ds_read_b64_tr_b16 v[188:189], v11 offset:61440
ds_read_b64_tr_b16 v[190:191], v11 offset:63488
v_mfma_f32_16x16x32_bf16 v[44:47], v[236:239], a[88:91], v[44:47]
v_mul_f32 v55, v55, v115
v_mul_f32 v71, v71, v114
v_mfma_f32_16x16x32_bf16 v[44:47], v[252:255], a[92:95], v[44:47]
v_and_b32 v114, 0xffff0000, v56
v_lshlrev_b32 v115, 16, v72
v_mfma_f32_16x16x32_bf16 v[28:31], v[252:255], a[76:79], v[28:31]
v_xor_b32 v8, 0x10000, v8
v_lshlrev_b32 v56, 16, v56
v_mfma_f32_16x16x32_bf16 v[28:31], v[236:239], a[72:75], v[28:31]
v_xor_b32 v9, 0x10000, v9
v_and_b32 v72, 0xffff0000, v72
v_mfma_f32_16x16x32_bf16 v[28:31], v[220:223], a[68:71], v[28:31]
s_waitcnt lgkmcnt(0)
v_xor_b32 v10, 0x10000, v10
v_mul_f32 v56, v56, v113
v_mfma_f32_16x16x32_bf16 v[28:31], v[204:207], a[64:67], v[28:31]
v_xor_b32 v11, 0x10000, v11
v_mul_f32 v114, v114, v113
v_mfma_f32_16x16x32_bf16 v[16:19], v[128:131], a[96:99], v[16:19]
s_nop 0
ds_read_b64_tr_b16 v[192:193], v8 offset:0
ds_read_b64_tr_b16 v[194:195], v8 offset:2048
v_mfma_f32_16x16x32_bf16 v[16:19], v[144:147], a[100:103], v[16:19]
s_nop 0
ds_read_b64_tr_b16 v[196:197], v9 offset:0
ds_read_b64_tr_b16 v[198:199], v9 offset:2048
v_mfma_f32_16x16x32_bf16 v[16:19], v[160:163], a[104:107], v[16:19]
v_mul_f32 v56, v56, v115
v_mul_f32 v72, v72, v114
v_mfma_f32_16x16x32_bf16 v[16:19], v[176:179], a[108:111], v[16:19]
s_nop 0
ds_read_b64_tr_b16 v[200:201], v10 offset:0
ds_read_b64_tr_b16 v[202:203], v10 offset:2048
v_mfma_f32_16x16x32_bf16 v[32:35], v[176:179], a[124:127], v[32:35]
v_and_b32 v114, 0xffff0000, v57
v_lshlrev_b32 v115, 16, v73
v_mfma_f32_16x16x32_bf16 v[32:35], v[160:163], a[120:123], v[32:35]
s_nop 0
ds_read_b64_tr_b16 v[204:205], v11 offset:0
ds_read_b64_tr_b16 v[206:207], v11 offset:2048
v_mfma_f32_16x16x32_bf16 v[32:35], v[144:147], a[116:119], v[32:35]
s_nop 0
ds_read_b64_tr_b16 v[208:209], v8 offset:4096
ds_read_b64_tr_b16 v[210:211], v8 offset:6144
v_mfma_f32_16x16x32_bf16 v[32:35], v[128:131], a[112:115], v[32:35]
v_lshlrev_b32 v57, 16, v57
v_and_b32 v73, 0xffff0000, v73
v_mfma_f32_16x16x32_bf16 v[36:39], v[132:135], a[112:115], v[36:39]
s_nop 0
ds_read_b64_tr_b16 v[212:213], v9 offset:4096
ds_read_b64_tr_b16 v[214:215], v9 offset:6144
v_mfma_f32_16x16x32_bf16 v[36:39], v[148:151], a[116:119], v[36:39]
v_mul_f32 v57, v57, v113
v_mul_f32 v114, v114, v113
v_mfma_f32_16x16x32_bf16 v[36:39], v[164:167], a[120:123], v[36:39]
s_nop 0
ds_read_b64_tr_b16 v[216:217], v10 offset:4096
ds_read_b64_tr_b16 v[218:219], v10 offset:6144
v_mfma_f32_16x16x32_bf16 v[36:39], v[180:183], a[124:127], v[36:39]
s_nop 0
ds_read_b64_tr_b16 v[220:221], v11 offset:4096
ds_read_b64_tr_b16 v[222:223], v11 offset:6144
v_mfma_f32_16x16x32_bf16 v[20:23], v[180:183], a[108:111], v[20:23]
v_mul_f32 v57, v57, v115
v_mul_f32 v73, v73, v114
v_mfma_f32_16x16x32_bf16 v[20:23], v[164:167], a[104:107], v[20:23]
s_nop 0
ds_read_b64_tr_b16 v[224:225], v8 offset:8192
ds_read_b64_tr_b16 v[226:227], v8 offset:10240
v_mfma_f32_16x16x32_bf16 v[20:23], v[148:151], a[100:103], v[20:23]
v_and_b32 v114, 0xffff0000, v58
v_lshlrev_b32 v115, 16, v74
v_mfma_f32_16x16x32_bf16 v[20:23], v[132:135], a[96:99], v[20:23]
s_nop 0
ds_read_b64_tr_b16 v[228:229], v9 offset:8192
ds_read_b64_tr_b16 v[230:231], v9 offset:10240
v_mfma_f32_16x16x32_bf16 v[24:27], v[136:139], a[96:99], v[24:27]
s_nop 0
ds_read_b64_tr_b16 v[232:233], v10 offset:8192
ds_read_b64_tr_b16 v[234:235], v10 offset:10240
v_mfma_f32_16x16x32_bf16 v[24:27], v[152:155], a[100:103], v[24:27]
v_lshlrev_b32 v58, 16, v58
v_and_b32 v74, 0xffff0000, v74
v_mfma_f32_16x16x32_bf16 v[24:27], v[168:171], a[104:107], v[24:27]
s_nop 0
ds_read_b64_tr_b16 v[236:237], v11 offset:8192
ds_read_b64_tr_b16 v[238:239], v11 offset:10240
v_mfma_f32_16x16x32_bf16 v[24:27], v[184:187], a[108:111], v[24:27]
v_mul_f32 v58, v58, v113
v_mul_f32 v114, v114, v113
v_mfma_f32_16x16x32_bf16 v[40:43], v[184:187], a[124:127], v[40:43]
s_nop 0
ds_read_b64_tr_b16 v[240:241], v8 offset:12288
ds_read_b64_tr_b16 v[242:243], v8 offset:14336
v_mfma_f32_16x16x32_bf16 v[40:43], v[168:171], a[120:123], v[40:43]
s_nop 0
ds_read_b64_tr_b16 v[244:245], v9 offset:12288
ds_read_b64_tr_b16 v[246:247], v9 offset:14336
v_mfma_f32_16x16x32_bf16 v[40:43], v[152:155], a[116:119], v[40:43]
v_mul_f32 v58, v58, v115
v_mul_f32 v74, v74, v114
v_mfma_f32_16x16x32_bf16 v[40:43], v[136:139], a[112:115], v[40:43]
s_nop 0
ds_read_b64_tr_b16 v[248:249], v10 offset:12288
ds_read_b64_tr_b16 v[250:251], v10 offset:14336
v_mfma_f32_16x16x32_bf16 v[44:47], v[140:143], a[112:115], v[44:47]
Lstube5:
s_cbranch_execz Lrete
v_and_b32 v114, 0xffff0000, v59
v_lshlrev_b32 v115, 16, v75
v_mfma_f32_16x16x32_bf16 v[44:47], v[156:159], a[116:119], v[44:47]
s_nop 0
ds_read_b64_tr_b16 v[252:253], v11 offset:12288
ds_read_b64_tr_b16 v[254:255], v11 offset:14336
v_mfma_f32_16x16x32_bf16 v[44:47], v[172:175], a[120:123], v[44:47]
v_lshlrev_b32 v59, 16, v59
v_and_b32 v75, 0xffff0000, v75
v_mfma_f32_16x16x32_bf16 v[44:47], v[188:191], a[124:127], v[44:47]
s_waitcnt vmcnt(0)
v_max3_u32 v12, v96, v97, v98
v_max3_u32 v13, v99, v100, v101
v_mfma_f32_16x16x32_bf16 v[28:31], v[188:191], a[108:111], v[28:31]
v_max3_u32 v12, v12, v102, v103
v_max3_u32 v13, v13, v104, v105
v_mfma_f32_16x16x32_bf16 v[28:31], v[172:175], a[104:107], v[28:31]
v_max3_u32 v12, v12, v106, v107
v_max3_u32 v13, v13, v108, v109
v_mfma_f32_16x16x32_bf16 v[28:31], v[156:159], a[100:103], v[28:31]
s_waitcnt vmcnt(9) lgkmcnt(0)
v_max3_u32 v12, v12, v110, v111
v_mul_f32 v59, v59, v113
v_mfma_f32_16x16x32_bf16 v[28:31], v[140:143], a[96:99], v[28:31]
s_barrier
v_max_u32 v12, v12, v13
v_mul_f32 v114, v114, v113
v_mfma_f32_16x16x32_bf16 v[16:19], v[192:195], a[128:131], v[16:19]
v_cmp_le_u32 vcc, 0xff800000, v12
v_mul_f32 v59, v59, v115
v_mfma_f32_16x16x32_bf16 v[16:19], v[208:211], a[132:135], v[16:19]
s_nop 0
ds_read_b64_tr_b16 v[128:129], v8 offset:16384
ds_read_b64_tr_b16 v[130:131], v8 offset:18432
v_mfma_f32_16x16x32_bf16 v[16:19], v[224:227], a[136:139], v[16:19]
s_cbranch_vccnz Lxspin1
Lxback1:
ds_read_b64_tr_b16 v[132:133], v9 offset:16384
ds_read_b64_tr_b16 v[134:135], v9 offset:18432
v_mfma_f32_16x16x32_bf16 v[16:19], v[240:243], a[140:143], v[16:19]
v_mul_f32 v75, v75, v114
v_and_b32 v114, 0xffff0000, v60
v_mfma_f32_16x16x32_bf16 v[16:19], v[124:127], v[96:99], v[16:19]
s_nop 0
ds_read_b64_tr_b16 v[136:137], v10 offset:16384
ds_read_b64_tr_b16 v[138:139], v10 offset:18432
v_mfma_f32_16x16x32_bf16 v[32:35], v[240:243], a[156:159], v[32:35]
v_lshlrev_b32 v115, 16, v76
v_lshlrev_b32 v60, 16, v60
v_mfma_f32_16x16x32_bf16 v[32:35], v[224:227], a[152:155], v[32:35]
s_add_u32 s82, s93, 0x3e00000
buffer_load_dwordx4 v[80:83], v1, s[44:47], s82 offen sc1
v_mfma_f32_16x16x32_bf16 v[32:35], v[208:211], a[148:151], v[32:35]
s_nop 0
ds_read_b64_tr_b16 v[140:141], v11 offset:16384
ds_read_b64_tr_b16 v[142:143], v11 offset:18432
v_mfma_f32_16x16x32_bf16 v[32:35], v[192:195], a[144:147], v[32:35]
v_and_b32 v76, 0xffff0000, v76
v_mul_f32 v60, v60, v113
v_mfma_f32_16x16x32_bf16 v[32:35], v[124:127], v[104:107], v[32:35]
s_nop 0
ds_read_b64_tr_b16 v[144:145], v8 offset:20480
ds_read_b64_tr_b16 v[146:147], v8 offset:22528
v_mfma_f32_16x16x32_bf16 v[36:39], v[196:199], a[144:147], v[36:39]
v_mul_f32 v114, v114, v113
v_mul_f32 v60, v60, v115
v_mfma_f32_16x16x32_bf16 v[36:39], v[212:215], a[148:151], v[36:39]
buffer_load_dwordx4 v[84:87], v1, s[44:47], s82 offen offset:1024 sc1
v_mfma_f32_16x16x32_bf16 v[36:39], v[228:231], a[152:155], v[36:39]
s_nop 0
ds_read_b64_tr_b16 v[148:149], v9 offset:20480
ds_read_b64_tr_b16 v[150:151], v9 offset:22528
v_mfma_f32_16x16x32_bf16 v[36:39], v[244:247], a[156:159], v[36:39]
v_mul_f32 v76, v76, v114
v_and_b32 v114, 0xffff0000, v61
v_mfma_f32_16x16x32_bf16 v[36:39], v[120:123], v[104:107], v[36:39]
s_nop 0
ds_read_b64_tr_b16 v[152:153], v10 offset:20480
ds_read_b64_tr_b16 v[154:155], v10 offset:22528
v_mfma_f32_16x16x32_bf16 v[20:23], v[244:247], a[140:143], v[20:23]
v_lshlrev_b32 v115, 16, v77
v_lshlrev_b32 v61, 16, v61
v_mfma_f32_16x16x32_bf16 v[20:23], v[228:231], a[136:139], v[20:23]
buffer_load_dwordx4 v[88:91], v1, s[44:47], s82 offen offset:2048 sc1
v_mfma_f32_16x16x32_bf16 v[20:23], v[212:215], a[132:135], v[20:23]
s_nop 0
ds_read_b64_tr_b16 v[156:157], v11 offset:20480
ds_read_b64_tr_b16 v[158:159], v11 offset:22528
v_mfma_f32_16x16x32_bf16 v[20:23], v[196:199], a[128:131], v[20:23]
v_and_b32 v77, 0xffff0000, v77
v_mul_f32 v61, v61, v113
v_mfma_f32_16x16x32_bf16 v[20:23], v[120:123], v[96:99], v[20:23]
s_nop 0
ds_read_b64_tr_b16 v[160:161], v8 offset:24576
ds_read_b64_tr_b16 v[162:163], v8 offset:26624
v_mfma_f32_16x16x32_bf16 v[24:27], v[200:203], a[128:131], v[24:27]
s_nop 0
ds_read_b64_tr_b16 v[164:165], v9 offset:24576
ds_read_b64_tr_b16 v[166:167], v9 offset:26624
v_mfma_f32_16x16x32_bf16 v[24:27], v[216:219], a[132:135], v[24:27]
buffer_load_dwordx4 v[92:95], v1, s[44:47], s82 offen offset:3072 sc1
v_mfma_f32_16x16x32_bf16 v[24:27], v[232:235], a[136:139], v[24:27]
v_mul_f32 v114, v114, v113
v_mul_f32 v61, v61, v115
v_mfma_f32_16x16x32_bf16 v[24:27], v[248:251], a[140:143], v[24:27]
s_nop 0
ds_read_b64_tr_b16 v[168:169], v10 offset:24576
ds_read_b64_tr_b16 v[170:171], v10 offset:26624
v_mfma_f32_16x16x32_bf16 v[24:27], v[124:127], v[100:103], v[24:27]
v_mul_f32 v77, v77, v114
v_and_b32 v114, 0xffff0000, v62
v_mfma_f32_16x16x32_bf16 v[40:43], v[248:251], a[156:159], v[40:43]
s_nop 0
ds_read_b64_tr_b16 v[172:173], v11 offset:24576
ds_read_b64_tr_b16 v[174:175], v11 offset:26624
v_mfma_f32_16x16x32_bf16 v[40:43], v[232:235], a[152:155], v[40:43]
v_lshlrev_b32 v115, 16, v78
v_lshlrev_b32 v62, 16, v62
v_mfma_f32_16x16x32_bf16 v[40:43], v[216:219], a[148:151], v[40:43]
s_nop 0
ds_read_b64_tr_b16 v[176:177], v8 offset:28672
ds_read_b64_tr_b16 v[178:179], v8 offset:30720
v_mfma_f32_16x16x32_bf16 v[40:43], v[200:203], a[144:147], v[40:43]
v_and_b32 v78, 0xffff0000, v78
v_mul_f32 v62, v62, v113
v_mfma_f32_16x16x32_bf16 v[40:43], v[124:127], v[108:111], v[40:43]
s_nop 0
ds_read_b64_tr_b16 v[180:181], v9 offset:28672
ds_read_b64_tr_b16 v[182:183], v9 offset:30720
v_mfma_f32_16x16x32_bf16 v[44:47], v[204:207], a[144:147], v[44:47]
v_mul_f32 v114, v114, v113
v_mul_f32 v62, v62, v115
v_mfma_f32_16x16x32_bf16 v[44:47], v[220:223], a[148:151], v[44:47]
s_nop 0
ds_read_b64_tr_b16 v[184:185], v10 offset:28672
ds_read_b64_tr_b16 v[186:187], v10 offset:30720
v_mfma_f32_16x16x32_bf16 v[44:47], v[236:239], a[152:155], v[44:47]
v_mul_f32 v78, v78, v114
v_and_b32 v114, 0xffff0000, v63
v_mfma_f32_16x16x32_bf16 v[44:47], v[252:255], a[156:159], v[44:47]
s_nop 0
ds_read_b64_tr_b16 v[188:189], v11 offset:28672
ds_read_b64_tr_b16 v[190:191], v11 offset:30720
v_mfma_f32_16x16x32_bf16 v[44:47], v[120:123], v[108:111], v[44:47]
v_lshlrev_b32 v115, 16, v79
v_lshlrev_b32 v63, 16, v63
v_mfma_f32_16x16x32_bf16 v[28:31], v[252:255], a[140:143], v[28:31]
v_and_b32 v79, 0xffff0000, v79
v_mul_f32 v63, v63, v113
v_mfma_f32_16x16x32_bf16 v[28:31], v[236:239], a[136:139], v[28:31]
v_mul_f32 v114, v114, v113
v_mul_f32 v63, v63, v115
v_mfma_f32_16x16x32_bf16 v[28:31], v[220:223], a[132:135], v[28:31]
v_mul_f32 v79, v79, v114
v_mfma_f32_16x16x32_bf16 v[28:31], v[204:207], a[128:131], v[28:31]
s_waitcnt lgkmcnt(0)
v_mfma_f32_16x16x32_bf16 v[28:31], v[120:123], v[100:103], v[28:31]
v_mfma_f32_16x16x32_bf16 v[16:19], v[128:131], a[160:163], v[16:19]
s_nop 0
ds_read_b64_tr_b16 v[192:193], v8 offset:32768
ds_read_b64_tr_b16 v[194:195], v8 offset:34816
v_mfma_f32_16x16x32_bf16 v[16:19], v[144:147], a[164:167], v[16:19]
s_nop 0
ds_read_b64_tr_b16 v[196:197], v9 offset:32768
ds_read_b64_tr_b16 v[198:199], v9 offset:34816
v_mfma_f32_16x16x32_bf16 v[16:19], v[160:163], a[168:171], v[16:19]
s_nop 0
ds_read_b64_tr_b16 v[200:201], v10 offset:32768
ds_read_b64_tr_b16 v[202:203], v10 offset:34816
v_mfma_f32_16x16x32_bf16 v[16:19], v[176:179], a[172:175], v[16:19]
v_mfma_f32_16x16x32_bf16 v[32:35], v[176:179], a[188:191], v[32:35]
s_nop 0
ds_read_b64_tr_b16 v[204:205], v11 offset:32768
ds_read_b64_tr_b16 v[206:207], v11 offset:34816
v_mfma_f32_16x16x32_bf16 v[32:35], v[160:163], a[184:187], v[32:35]
s_nop 0
ds_read_b64_tr_b16 v[208:209], v8 offset:36864
ds_read_b64_tr_b16 v[210:211], v8 offset:38912
v_mfma_f32_16x16x32_bf16 v[32:35], v[144:147], a[180:183], v[32:35]
s_add_u32 s81, s93, 0x4200000
buffer_load_dwordx4 v[96:99], v1, s[44:47], s81 offen sc1
v_mfma_f32_16x16x32_bf16 v[32:35], v[128:131], a[176:179], v[32:35]
v_mfma_f32_16x16x32_bf16 v[36:39], v[132:135], a[176:179], v[36:39]
s_nop 0
ds_read_b64_tr_b16 v[212:213], v9 offset:36864
ds_read_b64_tr_b16 v[214:215], v9 offset:38912
v_mfma_f32_16x16x32_bf16 v[36:39], v[148:151], a[180:183], v[36:39]
s_nop 0
ds_read_b64_tr_b16 v[216:217], v10 offset:36864
ds_read_b64_tr_b16 v[218:219], v10 offset:38912
v_mfma_f32_16x16x32_bf16 v[36:39], v[164:167], a[184:187], v[36:39]
v_mfma_f32_16x16x32_bf16 v[36:39], v[180:183], a[188:191], v[36:39]
buffer_load_dwordx4 v[100:103], v1, s[44:47], s81 offen offset:1024 sc1
v_mfma_f32_16x16x32_bf16 v[20:23], v[180:183], a[172:175], v[20:23]
s_nop 0
ds_read_b64_tr_b16 v[220:221], v11 offset:36864
ds_read_b64_tr_b16 v[222:223], v11 offset:38912
v_mfma_f32_16x16x32_bf16 v[20:23], v[164:167], a[168:171], v[20:23]
s_nop 0
ds_read_b64_tr_b16 v[224:225], v8 offset:40960
ds_read_b64_tr_b16 v[226:227], v8 offset:43008
v_mfma_f32_16x16x32_bf16 v[20:23], v[148:151], a[164:167], v[20:23]
s_nop 0
ds_read_b64_tr_b16 v[228:229], v9 offset:40960
ds_read_b64_tr_b16 v[230:231], v9 offset:43008
v_mfma_f32_16x16x32_bf16 v[20:23], v[132:135], a[160:163], v[20:23]
v_mfma_f32_16x16x32_bf16 v[24:27], v[136:139], a[160:163], v[24:27]
buffer_load_dwordx4 v[104:107], v1, s[44:47], s81 offen offset:2048 sc1
v_mfma_f32_16x16x32_bf16 v[24:27], v[152:155], a[164:167], v[24:27]
s_nop 0
ds_read_b64_tr_b16 v[232:233], v10 offset:40960
ds_read_b64_tr_b16 v[234:235], v10 offset:43008
v_mfma_f32_16x16x32_bf16 v[24:27], v[168:171], a[168:171], v[24:27]
s_nop 0
ds_read_b64_tr_b16 v[236:237], v11 offset:40960
ds_read_b64_tr_b16 v[238:239], v11 offset:43008
v_mfma_f32_16x16x32_bf16 v[24:27], v[184:187], a[172:175], v[24:27]
v_mfma_f32_16x16x32_bf16 v[40:43], v[184:187], a[188:191], v[40:43]
s_nop 0
ds_read_b64_tr_b16 v[240:241], v8 offset:45056
ds_read_b64_tr_b16 v[242:243], v8 offset:47104
v_mfma_f32_16x16x32_bf16 v[40:43], v[168:171], a[184:187], v[40:43]
buffer_load_dwordx4 v[108:111], v1, s[44:47], s81 offen offset:3072 sc1
v_mfma_f32_16x16x32_bf16 v[40:43], v[152:155], a[180:183], v[40:43]
s_nop 0
ds_read_b64_tr_b16 v[244:245], v9 offset:45056
ds_read_b64_tr_b16 v[246:247], v9 offset:47104
v_mfma_f32_16x16x32_bf16 v[40:43], v[136:139], a[176:179], v[40:43]
v_mfma_f32_16x16x32_bf16 v[44:47], v[140:143], a[176:179], v[44:47]
s_nop 0
ds_read_b64_tr_b16 v[248:249], v10 offset:45056
ds_read_b64_tr_b16 v[250:251], v10 offset:47104
v_mfma_f32_16x16x32_bf16 v[44:47], v[156:159], a[180:183], v[44:47]
s_nop 0
ds_read_b64_tr_b16 v[252:253], v11 offset:45056
ds_read_b64_tr_b16 v[254:255], v11 offset:47104
v_mfma_f32_16x16x32_bf16 v[44:47], v[172:175], a[184:187], v[44:47]
v_mfma_f32_16x16x32_bf16 v[44:47], v[188:191], a[188:191], v[44:47]
s_waitcnt vmcnt(4)
v_max3_u32 v12, v80, v81, v82
v_max3_u32 v13, v83, v84, v85
v_mfma_f32_16x16x32_bf16 v[28:31], v[188:191], a[172:175], v[28:31]
v_max3_u32 v12, v12, v86, v87
v_max3_u32 v13, v13, v88, v89
v_mfma_f32_16x16x32_bf16 v[28:31], v[172:175], a[168:171], v[28:31]
v_max3_u32 v12, v12, v90, v91
v_max3_u32 v13, v13, v92, v93
v_mfma_f32_16x16x32_bf16 v[28:31], v[156:159], a[164:167], v[28:31]
s_waitcnt vmcnt(12) lgkmcnt(0)
v_max3_u32 v12, v12, v94, v95
v_mfma_f32_16x16x32_bf16 v[28:31], v[140:143], a[160:163], v[28:31]
s_barrier
v_max_u32 v12, v12, v13
v_mfma_f32_16x16x32_bf16 v[16:19], v[192:195], a[192:195], v[16:19]
v_cmp_le_u32 vcc, 0xff800000, v12
v_mfma_f32_16x16x32_bf16 v[16:19], v[208:211], a[196:199], v[16:19]
s_nop 0
ds_read_b64_tr_b16 v[128:129], v8 offset:49152
ds_read_b64_tr_b16 v[130:131], v8 offset:51200
v_mfma_f32_16x16x32_bf16 v[16:19], v[224:227], a[200:203], v[16:19]
s_cbranch_vccnz Lxspin2
Lxback2:
v_mfma_f32_16x16x32_bf16 v[16:19], v[240:243], a[204:207], v[16:19]
s_nop 0
ds_read_b64_tr_b16 v[132:133], v9 offset:49152
ds_read_b64_tr_b16 v[134:135], v9 offset:51200
v_mfma_f32_16x16x32_bf16 v[16:19], v[124:127], v[80:83], v[16:19]
v_mfma_f32_16x16x32_bf16 v[32:35], v[240:243], a[220:223], v[32:35]
s_nop 0
ds_read_b64_tr_b16 v[136:137], v10 offset:49152
ds_read_b64_tr_b16 v[138:139], v10 offset:51200
v_mfma_f32_16x16x32_bf16 v[32:35], v[224:227], a[216:219], v[32:35]
v_mfma_f32_16x16x32_bf16 v[32:35], v[208:211], a[212:215], v[32:35]
s_nop 0
ds_read_b64_tr_b16 v[140:141], v11 offset:49152
ds_read_b64_tr_b16 v[142:143], v11 offset:51200
v_mfma_f32_16x16x32_bf16 v[32:35], v[192:195], a[208:211], v[32:35]
v_mfma_f32_16x16x32_bf16 v[32:35], v[124:127], v[88:91], v[32:35]
s_nop 0
ds_read_b64_tr_b16 v[144:145], v8 offset:53248
ds_read_b64_tr_b16 v[146:147], v8 offset:55296
v_mfma_f32_16x16x32_bf16 v[36:39], v[196:199], a[208:211], v[36:39]
v_mfma_f32_16x16x32_bf16 v[36:39], v[212:215], a[212:215], v[36:39]
s_nop 0
ds_read_b64_tr_b16 v[148:149], v9 offset:53248
ds_read_b64_tr_b16 v[150:151], v9 offset:55296
v_mfma_f32_16x16x32_bf16 v[36:39], v[228:231], a[216:219], v[36:39]
v_mfma_f32_16x16x32_bf16 v[36:39], v[244:247], a[220:223], v[36:39]
s_nop 0
ds_read_b64_tr_b16 v[152:153], v10 offset:53248
ds_read_b64_tr_b16 v[154:155], v10 offset:55296
v_mfma_f32_16x16x32_bf16 v[36:39], v[120:123], v[88:91], v[36:39]
v_mfma_f32_16x16x32_bf16 v[20:23], v[244:247], a[204:207], v[20:23]
s_nop 0
ds_read_b64_tr_b16 v[156:157], v11 offset:53248
ds_read_b64_tr_b16 v[158:159], v11 offset:55296
v_mfma_f32_16x16x32_bf16 v[20:23], v[228:231], a[200:203], v[20:23]
v_mfma_f32_16x16x32_bf16 v[20:23], v[212:215], a[196:199], v[20:23]
v_mfma_f32_16x16x32_bf16 v[20:23], v[196:199], a[192:195], v[20:23]
s_nop 0
ds_read_b64_tr_b16 v[160:161], v8 offset:57344
ds_read_b64_tr_b16 v[162:163], v8 offset:59392
v_mfma_f32_16x16x32_bf16 v[20:23], v[120:123], v[80:83], v[20:23]
v_mfma_f32_16x16x32_bf16 v[24:27], v[200:203], a[192:195], v[24:27]
s_nop 0
ds_read_b64_tr_b16 v[164:165], v9 offset:57344
ds_read_b64_tr_b16 v[166:167], v9 offset:59392
v_mfma_f32_16x16x32_bf16 v[24:27], v[216:219], a[196:199], v[24:27]
v_mfma_f32_16x16x32_bf16 v[24:27], v[232:235], a[200:203], v[24:27]
s_nop 0
ds_read_b64_tr_b16 v[168:169], v10 offset:57344
ds_read_b64_tr_b16 v[170:171], v10 offset:59392
v_mfma_f32_16x16x32_bf16 v[24:27], v[248:251], a[204:207], v[24:27]
v_mfma_f32_16x16x32_bf16 v[24:27], v[124:127], v[84:87], v[24:27]
s_nop 0
ds_read_b64_tr_b16 v[172:173], v11 offset:57344
ds_read_b64_tr_b16 v[174:175], v11 offset:59392
v_mfma_f32_16x16x32_bf16 v[40:43], v[248:251], a[220:223], v[40:43]
v_mfma_f32_16x16x32_bf16 v[40:43], v[232:235], a[216:219], v[40:43]
s_nop 0
ds_read_b64_tr_b16 v[176:177], v8 offset:61440
ds_read_b64_tr_b16 v[178:179], v8 offset:63488
v_mfma_f32_16x16x32_bf16 v[40:43], v[216:219], a[212:215], v[40:43]
v_mfma_f32_16x16x32_bf16 v[40:43], v[200:203], a[208:211], v[40:43]
s_nop 0
ds_read_b64_tr_b16 v[180:181], v9 offset:61440
ds_read_b64_tr_b16 v[182:183], v9 offset:63488
v_mfma_f32_16x16x32_bf16 v[40:43], v[124:127], v[92:95], v[40:43]
v_mfma_f32_16x16x32_bf16 v[44:47], v[204:207], a[208:211], v[44:47]
s_nop 0
ds_read_b64_tr_b16 v[184:185], v10 offset:61440
ds_read_b64_tr_b16 v[186:187], v10 offset:63488
v_mfma_f32_16x16x32_bf16 v[44:47], v[220:223], a[212:215], v[44:47]
v_mfma_f32_16x16x32_bf16 v[44:47], v[236:239], a[216:219], v[44:47]
s_nop 0
ds_read_b64_tr_b16 v[188:189], v11 offset:61440
ds_read_b64_tr_b16 v[190:191], v11 offset:63488
v_mfma_f32_16x16x32_bf16 v[44:47], v[252:255], a[220:223], v[44:47]
v_mfma_f32_16x16x32_bf16 v[44:47], v[120:123], v[92:95], v[44:47]
v_mfma_f32_16x16x32_bf16 v[28:31], v[252:255], a[204:207], v[28:31]
s_waitcnt vmcnt(0)
v_max3_u32 v12, v96, v97, v98
v_max3_u32 v13, v99, v100, v101
v_mfma_f32_16x16x32_bf16 v[28:31], v[236:239], a[200:203], v[28:31]
v_max3_u32 v12, v12, v102, v103
v_max3_u32 v13, v13, v104, v105
v_mfma_f32_16x16x32_bf16 v[28:31], v[220:223], a[196:199], v[28:31]
v_max3_u32 v12, v12, v106, v107
v_max3_u32 v13, v13, v108, v109
v_mfma_f32_16x16x32_bf16 v[28:31], v[204:207], a[192:195], v[28:31]
s_waitcnt lgkmcnt(0)
v_max3_u32 v12, v12, v110, v111
v_mfma_f32_16x16x32_bf16 v[28:31], v[120:123], v[84:87], v[28:31]
v_max_u32 v12, v12, v13
v_mfma_f32_16x16x32_bf16 v[16:19], v[128:131], a[224:227], v[16:19]
v_cmp_le_u32 vcc, 0xff800000, v12
v_mfma_f32_16x16x32_bf16 v[16:19], v[144:147], a[228:231], v[16:19]
v_mfma_f32_16x16x32_bf16 v[16:19], v[160:163], a[232:235], v[16:19]
s_cbranch_vccnz Lxspin3
Lxback3:
v_mfma_f32_16x16x32_bf16 v[16:19], v[176:179], a[236:239], v[16:19]
v_mfma_f32_16x16x32_bf16 v[16:19], v[124:127], v[96:99], v[16:19]
v_mfma_f32_16x16x32_bf16 v[20:23], v[180:183], a[236:239], v[20:23]
v_mfma_f32_16x16x32_bf16 v[20:23], v[164:167], a[232:235], v[20:23]
v_mfma_f32_16x16x32_bf16 v[20:23], v[148:151], a[228:231], v[20:23]
v_mfma_f32_16x16x32_bf16 v[20:23], v[132:135], a[224:227], v[20:23]
s_nop 3
v_fma_f32 v16, v16, v6, v48
v_fma_f32 v17, v17, v6, v64
v_mfma_f32_16x16x32_bf16 v[20:23], v[120:123], v[96:99], v[20:23]
v_fma_f32 v18, v18, v6, v49
v_fma_f32 v19, v19, v6, v65
v_mfma_f32_16x16x32_bf16 v[24:27], v[136:139], a[224:227], v[24:27]
v_cvt_pk_bf16_f32 v16, v16, v17
v_cvt_pk_bf16_f32 v17, v18, v19
v_mfma_f32_16x16x32_bf16 v[24:27], v[152:155], a[228:231], v[24:27]
ds_write_b64 v116, v[16:17] offset:0
v_mfma_f32_16x16x32_bf16 v[24:27], v[168:171], a[232:235], v[24:27]
v_mfma_f32_16x16x32_bf16 v[24:27], v[184:187], a[236:239], v[24:27]
v_fma_f32 v20, v20, v6, v50
v_fma_f32 v21, v21, v6, v66
v_mfma_f32_16x16x32_bf16 v[24:27], v[124:127], v[100:103], v[24:27]
v_fma_f32 v22, v22, v6, v51
v_fma_f32 v23, v23, v6, v67
v_mfma_f32_16x16x32_bf16 v[28:31], v[188:191], a[236:239], v[28:31]
v_cvt_pk_bf16_f32 v20, v20, v21
v_cvt_pk_bf16_f32 v21, v22, v23
v_mfma_f32_16x16x32_bf16 v[28:31], v[172:175], a[232:235], v[28:31]
ds_write_b64 v117, v[20:21] offset:0
v_mfma_f32_16x16x32_bf16 v[28:31], v[156:159], a[228:231], v[28:31]
v_mfma_f32_16x16x32_bf16 v[28:31], v[140:143], a[224:227], v[28:31]
v_fma_f32 v24, v24, v6, v52
v_fma_f32 v25, v25, v6, v68
v_mfma_f32_16x16x32_bf16 v[28:31], v[120:123], v[100:103], v[28:31]
v_fma_f32 v26, v26, v6, v53
v_fma_f32 v27, v27, v6, v69
v_mfma_f32_16x16x32_bf16 v[32:35], v[128:131], a[240:243], v[32:35]
v_cvt_pk_bf16_f32 v24, v24, v25
v_cvt_pk_bf16_f32 v25, v26, v27
v_mfma_f32_16x16x32_bf16 v[32:35], v[144:147], a[244:247], v[32:35]
ds_write_b64 v118, v[24:25] offset:0
v_mfma_f32_16x16x32_bf16 v[32:35], v[160:163], a[248:251], v[32:35]
v_mfma_f32_16x16x32_bf16 v[32:35], v[176:179], a[252:255], v[32:35]
v_fma_f32 v28, v28, v6, v54
v_fma_f32 v29, v29, v6, v70
v_mfma_f32_16x16x32_bf16 v[32:35], v[124:127], v[104:107], v[32:35]
v_fma_f32 v30, v30, v6, v55
v_fma_f32 v31, v31, v6, v71
v_mfma_f32_16x16x32_bf16 v[36:39], v[180:183], a[252:255], v[36:39]
v_cvt_pk_bf16_f32 v28, v28, v29
v_cvt_pk_bf16_f32 v29, v30, v31
v_mfma_f32_16x16x32_bf16 v[36:39], v[164:167], a[248:251], v[36:39]
s_nop 0
ds_write_b64 v119, v[28:29] offset:0
ds_read_b128 v[192:195], v4 offset:0
v_mfma_f32_16x16x32_bf16 v[36:39], v[148:151], a[244:247], v[36:39]
ds_read_b128 v[196:199], v4 offset:1024
v_mfma_f32_16x16x32_bf16 v[36:39], v[132:135], a[240:243], v[36:39]
v_fma_f32 v32, v32, v7, v56
v_fma_f32 v33, v33, v7, v72
v_mfma_f32_16x16x32_bf16 v[36:39], v[120:123], v[104:107], v[36:39]
v_fma_f32 v34, v34, v7, v57
v_fma_f32 v35, v35, v7, v73
v_mfma_f32_16x16x32_bf16 v[40:43], v[136:139], a[240:243], v[40:43]
v_cvt_pk_bf16_f32 v32, v32, v33
v_cvt_pk_bf16_f32 v33, v34, v35
v_mfma_f32_16x16x32_bf16 v[40:43], v[152:155], a[244:247], v[40:43]
ds_write_b64 v116, v[32:33] offset:2048
v_mfma_f32_16x16x32_bf16 v[40:43], v[168:171], a[248:251], v[40:43]
s_waitcnt lgkmcnt(2)
buffer_store_dwordx4 v[192:195], v15, s[40:43], s70 offen sc1
v_mfma_f32_16x16x32_bf16 v[40:43], v[184:187], a[252:255], v[40:43]
s_add_u32 s70, s70, 0x4000
v_mfma_f32_16x16x32_bf16 v[40:43], v[124:127], v[108:111], v[40:43]
v_fma_f32 v36, v36, v7, v58
v_fma_f32 v37, v37, v7, v74
v_mfma_f32_16x16x32_bf16 v[44:47], v[188:191], a[252:255], v[44:47]
v_fma_f32 v38, v38, v7, v59
v_fma_f32 v39, v39, v7, v75
v_mfma_f32_16x16x32_bf16 v[44:47], v[172:175], a[248:251], v[44:47]
v_cvt_pk_bf16_f32 v36, v36, v37
v_cvt_pk_bf16_f32 v37, v38, v39
v_mfma_f32_16x16x32_bf16 v[44:47], v[156:159], a[244:247], v[44:47]
ds_write_b64 v117, v[36:37] offset:2048
v_mfma_f32_16x16x32_bf16 v[44:47], v[140:143], a[240:243], v[44:47]
v_fma_f32 v40, v40, v7, v60
v_fma_f32 v41, v41, v7, v76
v_mfma_f32_16x16x32_bf16 v[44:47], v[120:123], v[108:111], v[44:47]
v_fma_f32 v42, v42, v7, v61
v_fma_f32 v43, v43, v7, v77
v_cvt_pk_bf16_f32 v40, v40, v41
v_cvt_pk_bf16_f32 v41, v42, v43
ds_write_b64 v118, v[40:41] offset:2048
s_waitcnt lgkmcnt(3)
buffer_store_dwordx4 v[196:199], v15, s[40:43], s70 offen sc1
s_add_u32 s70, s70, 0x4000
v_fma_f32 v44, v44, v7, v62
v_fma_f32 v45, v45, v7, v78
v_fma_f32 v46, v46, v7, v63
v_fma_f32 v47, v47, v7, v79
v_cvt_pk_bf16_f32 v44, v44, v45
v_cvt_pk_bf16_f32 v45, v46, v47
ds_write_b64 v119, v[44:45] offset:2048
ds_read_b128 v[200:203], v4 offset:2048
ds_read_b128 v[204:207], v4 offset:3072
s_waitcnt lgkmcnt(1)
buffer_store_dwordx4 v[200:203], v15, s[40:43], s70 offen sc1
s_add_u32 s70, s70, 0x4000
s_waitcnt lgkmcnt(0)
buffer_store_dwordx4 v[204:207], v15, s[40:43], s70 offen sc1
s_add_u32 s70, s70, 0x4000
Lend:
s_endpgm
Lspin1:
s_mov_b32 s83, 262144
Lsl3:
s_sleep 2
buffer_load_dword v3, v2, s[48:51], 0 offen sc1
s_sub_u32 s83, s83, 1
s_cmp_eq_u32 s83, 0
s_waitcnt vmcnt(0)
s_cbranch_scc1 Lback2
v_cmp_gt_u32 vcc, 8, v3
s_cbranch_vccnz Lsl3
s_branch Lback2
Lspin4:
s_mov_b32 s83, 262144
Lsl6:
s_sleep 2
buffer_load_dword v3, v2, s[44:47], s75 offen sc1
s_sub_u32 s83, s83, 1
s_cmp_eq_u32 s83, 0
s_waitcnt vmcnt(0)
s_cbranch_scc1 Lback5
v_cmp_gt_u32 vcc, 1, v3
s_cbranch_vccnz Lsl6
s_branch Lback5
.p2align 12
s_endpgm
.p2align 7
LP0x:
Lstub10:
s_cbranch_execz Lret
s_cmp_eq_u32 s58, 2
s_cbranch_scc1 Lta10
s_cmp_eq_u32 s58, 3
s_cbranch_scc1 Lnt11
v_mfma_f32_16x16x32_bf16 v[160:163], a[160:163], v[16:19], v[112:115]
s_xor_b32 s74, s82, 0x10000
v_exp_f32 v128, v128
v_mfma_f32_16x16x32_bf16 v[176:179], a[176:179], v[16:19], v[112:115]
s_add_u32 s74, s74, s64
ds_read_b128 a[128:131], v2 offset:16384
ds_read_b128 a[132:135], v2 offset:17408
s_branch Ljoin12
Lta10:
v_mfma_f32_16x16x32_bf16 v[160:163], a[160:163], v[16:19], v[96:99]
s_xor_b32 s74, s82, 0x10000
v_exp_f32 v128, v128
v_mfma_f32_16x16x32_bf16 v[176:179], a[176:179], v[16:19], v[112:115]
s_add_u32 s74, s74, s64
ds_read_b128 a[128:131], v2 offset:16384
ds_read_b128 a[132:135], v2 offset:17408
s_branch Ljoin12
Lnt11:
v_mfma_f32_16x16x32_bf16 v[160:163], a[160:163], v[16:19], v[80:83]
s_xor_b32 s74, s82, 0x10000
v_exp_f32 v128, v128
v_mfma_f32_16x16x32_bf16 v[176:179], a[176:179], v[16:19], v[96:99]
s_add_u32 s74, s74, s64
ds_read_b128 a[128:131], v2 offset:16384
ds_read_b128 a[132:135], v2 offset:17408
Ljoin12:
v_mfma_f32_16x16x32_bf16 v[164:167], a[160:163], v[32:35], v[84:87]
s_add_u32 s81, s81, 0x8000
v_exp_f32 v129, v129
v_mfma_f32_16x16x32_bf16 v[164:167], a[164:167], v[36:39], v[164:167]
s_add_u32 m0, s74, 16384
v_exp_f32 v130, v130
v_mfma_f32_16x16x32_bf16 v[164:167], a[168:171], v[40:43], v[164:167]
s_add_u32 s72, s81, 16384
v_exp_f32 v131, v131
v_mfma_f32_16x16x32_bf16 v[164:167], a[172:175], v[44:47], v[164:167]
v_exp_f32 v144, v144
v_mfma_f32_16x16x32_bf16 v[172:175], a[172:175], v[76:79], v[92:95]
s_nop 0
ds_read_b128 a[136:139], v2 offset:18432
ds_read_b128 a[140:143], v2 offset:19456
v_mfma_f32_16x16x32_bf16 v[172:175], a[168:171], v[72:75], v[172:175]
s_nop 0
ds_read_b128 a[144:147], v2 offset:20480
ds_read_b128 a[148:151], v2 offset:21504
v_mfma_f32_16x16x32_bf16 v[172:175], a[164:167], v[68:71], v[172:175]
s_nop 0
ds_read_b128 a[152:155], v2 offset:22528
ds_read_b128 a[156:159], v2 offset:23552
v_mfma_f32_16x16x32_bf16 v[172:175], a[160:163], v[64:67], v[172:175]
s_nop 0
ds_read_b128 a[192:195], v2 offset:0
ds_read_b128 a[196:199], v2 offset:1024
v_mfma_f32_16x16x32_bf16 v[188:191], a[176:179], v[64:67], v[92:95]
s_nop 0
ds_read_b128 a[200:203], v2 offset:2048
ds_read_b128 a[204:207], v2 offset:3072
v_mfma_f32_16x16x32_bf16 v[188:191], a[180:183], v[68:71], v[188:191]
s_nop 0
ds_read_b128 a[208:211], v2 offset:4096
ds_read_b128 a[212:215], v2 offset:5120
v_mfma_f32_16x16x32_bf16 v[188:191], a[184:187], v[72:75], v[188:191]
s_nop 0
ds_read_b128 a[216:219], v2 offset:6144
ds_read_b128 a[220:223], v2 offset:7168
v_mfma_f32_16x16x32_bf16 v[188:191], a[188:191], v[76:79], v[188:191]
v_cvt_pk_bf16_f32 v192, v128, v129
v_cvt_pk_bf16_f32 v193, v130, v131
v_mfma_f32_16x16x32_bf16 v[180:183], a[188:191], v[44:47], v[84:87]
buffer_load_dwordx4 v1, s[44:47], s72 offen sc1 lds
v_mfma_f32_16x16x32_bf16 v[180:183], a[184:187], v[40:43], v[180:183]
v_exp_f32 v145, v145
v_mfma_f32_16x16x32_bf16 v[180:183], a[180:183], v[36:39], v[180:183]
v_exp_f32 v146, v146
v_mfma_f32_16x16x32_bf16 v[180:183], a[176:179], v[32:35], v[180:183]
v_exp_f32 v147, v147
v_mfma_f32_16x16x32_bf16 v[160:163], a[164:167], v[20:23], v[160:163]
v_exp_f32 v136, v136
v_mfma_f32_16x16x32_bf16 v[160:163], a[168:171], v[24:27], v[160:163]
v_cvt_pk_bf16_f32 v194, v144, v145
v_cvt_pk_bf16_f32 v195, v146, v147
v_mfma_f32_16x16x32_bf16 v[160:163], a[172:175], v[28:31], v[160:163]
v_exp_f32 v137, v137
v_mfma_f32_16x16x32_bf16 v[168:171], a[172:175], v[60:63], v[88:91]
v_exp_f32 v138, v138
v_mfma_f32_16x16x32_bf16 v[168:171], a[168:171], v[56:59], v[168:171]
v_exp_f32 v139, v139
v_mfma_f32_16x16x32_bf16 v[168:171], a[164:167], v[52:55], v[168:171]
v_exp_f32 v152, v152
v_mfma_f32_16x16x32_bf16 v[168:171], a[160:163], v[48:51], v[168:171]
v_cvt_pk_bf16_f32 v200, v136, v137
v_cvt_pk_bf16_f32 v201, v138, v139
v_mfma_f32_16x16x32_bf16 v[184:187], a[176:179], v[48:51], v[88:91]
buffer_load_dwordx4 v1, s[44:47], s72 offen offset:1024 sc1 lds
v_mfma_f32_16x16x32_bf16 v[184:187], a[180:183], v[52:55], v[184:187]
v_exp_f32 v153, v153
v_mfma_f32_16x16x32_bf16 v[184:187], a[184:187], v[56:59], v[184:187]
v_exp_f32 v154, v154
v_mfma_f32_16x16x32_bf16 v[184:187], a[188:191], v[60:63], v[184:187]
v_exp_f32 v155, v155
v_mfma_f32_16x16x32_bf16 v[176:179], a[188:191], v[28:31], v[176:179]
buffer_load_dwordx4 v1, s[44:47], s72 offen offset:2048 sc1 lds
v_mfma_f32_16x16x32_bf16 v[176:179], a[184:187], v[24:27], v[176:179]
buffer_load_dwordx4 v1, s[44:47], s72 offen offset:3072 sc1 lds
v_mfma_f32_16x16x32_bf16 v[176:179], a[180:183], v[20:23], v[176:179]
s_waitcnt lgkmcnt(4)
v_exp_f32 v132, v132
v_cvt_pk_bf16_f32 v202, v152, v153
v_cvt_pk_bf16_f32 v203, v154, v155
v_exp_f32 v133, v133
v_exp_f32 v134, v134
v_cvt_pk_bf16_f32 v196, v132, v133
v_exp_f32 v135, v135
v_exp_f32 v148, v148
v_cvt_pk_bf16_f32 v197, v134, v135
v_exp_f32 v149, v149
v_exp_f32 v150, v150
v_cvt_pk_bf16_f32 v198, v148, v149
v_exp_f32 v151, v151
v_exp_f32 v140, v140
v_cvt_pk_bf16_f32 v199, v150, v151
v_exp_f32 v141, v141
v_exp_f32 v142, v142
v_cvt_pk_bf16_f32 v204, v140, v141
v_exp_f32 v143, v143
v_exp_f32 v156, v156
v_cvt_pk_bf16_f32 v205, v142, v143
v_exp_f32 v157, v157
v_exp_f32 v158, v158
v_cvt_pk_bf16_f32 v206, v156, v157
v_exp_f32 v159, v159
s_nop 0
v_cvt_pk_bf16_f32 v207, v158, v159
v_mfma_f32_16x16x32_bf16 v[224:227], v[120:123], v[192:195], 0
s_add_u32 s82, s82, 0x8000
ds_read_b128 a[160:163], v2 offset:24576
ds_read_b128 a[164:167], v2 offset:25600
v_mfma_f32_16x16x32_bf16 v[232:235], v[120:123], v[200:203], 0
s_and_b32 s82, s82, 0x1ffff
v_exp_f32 v164, v164
v_mfma_f32_16x16x32_bf16 a[0:3], a[192:195], v[192:195], 0
s_add_u32 m0, s74, 0
v_exp_f32 v165, v165
v_mfma_f32_16x16x32_bf16 a[64:67], a[192:195], v[200:203], 0
s_add_u32 s72, s81, 0
v_exp_f32 v166, v166
v_mfma_f32_16x16x32_bf16 a[68:71], a[196:199], v[200:203], 0
buffer_load_dwordx4 v1, s[44:47], s72 offen sc1 lds
v_mfma_f32_16x16x32_bf16 a[4:7], a[196:199], v[192:195], 0
v_exp_f32 v167, v167
v_mfma_f32_16x16x32_bf16 a[8:11], a[200:203], v[192:195], 0
s_nop 0
ds_read_b128 a[168:171], v2 offset:26624
ds_read_b128 a[172:175], v2 offset:27648
v_mfma_f32_16x16x32_bf16 a[72:75], a[200:203], v[200:203], 0
v_exp_f32 v180, v180
v_mfma_f32_16x16x32_bf16 a[76:79], a[204:207], v[200:203], 0
s_nop 0
ds_read_b128 a[176:179], v2 offset:28672
ds_read_b128 a[180:183], v2 offset:29696
v_mfma_f32_16x16x32_bf16 a[12:15], a[204:207], v[192:195], 0
s_waitcnt lgkmcnt(6)
ds_read_b128 a[184:187], v2 offset:30720
ds_read_b128 a[188:191], v2 offset:31744
v_mfma_f32_16x16x32_bf16 a[16:19], a[208:211], v[192:195], 0
s_nop 0
ds_read_b128 a[224:227], v2 offset:8192
ds_read_b128 a[228:231], v2 offset:9216
v_mfma_f32_16x16x32_bf16 a[80:83], a[208:211], v[200:203], 0
s_nop 0
ds_read_b128 a[232:235], v2 offset:10240
ds_read_b128 a[236:239], v2 offset:11264
v_mfma_f32_16x16x32_bf16 a[84:87], a[212:215], v[200:203], 0
s_nop 0
ds_read_b128 a[240:243], v2 offset:12288
ds_read_b128 a[244:247], v2 offset:13312
v_mfma_f32_16x16x32_bf16 a[20:23], a[212:215], v[192:195], 0
s_nop 0
ds_read_b128 a[248:251], v2 offset:14336
ds_read_b128 a[252:255], v2 offset:15360
v_mfma_f32_16x16x32_bf16 a[24:27], a[216:219], v[192:195], 0
v_cvt_pk_bf16_f32 v212, v164, v165
v_cvt_pk_bf16_f32 v213, v166, v167
v_mfma_f32_16x16x32_bf16 a[88:91], a[216:219], v[200:203], 0
v_exp_f32 v181, v181
v_mfma_f32_16x16x32_bf16 a[92:95], a[220:223], v[200:203], 0
v_exp_f32 v182, v182
v_mfma_f32_16x16x32_bf16 a[28:31], a[220:223], v[192:195], 0
buffer_load_dwordx4 v1, s[44:47], s72 offen offset:1024 sc1 lds
s_cmp_eq_u32 s58, 0
s_cbranch_scc1 Lta13
s_cmp_eq_u32 s58, 1
s_cbranch_scc1 Lnt14
v_mfma_f32_16x16x32_bf16 v[132:135], a[128:131], v[32:35], v[84:87]
v_exp_f32 v183, v183
v_mfma_f32_16x16x32_bf16 v[148:151], a[144:147], v[32:35], v[84:87]
v_exp_f32 v172, v172
s_branch Ljoin15
Lta13:
v_mfma_f32_16x16x32_bf16 v[132:135], a[128:131], v[32:35], v[100:103]
v_exp_f32 v183, v183
v_mfma_f32_16x16x32_bf16 v[148:151], a[144:147], v[32:35], v[112:115]
v_exp_f32 v172, v172
s_branch Ljoin15
Lnt14:
v_mfma_f32_16x16x32_bf16 v[132:135], a[128:131], v[32:35], v[84:87]
v_exp_f32 v183, v183
v_mfma_f32_16x16x32_bf16 v[148:151], a[144:147], v[32:35], v[100:103]
v_exp_f32 v172, v172
Ljoin15:
v_mfma_f32_16x16x32_bf16 v[136:139], a[128:131], v[48:51], v[88:91]
v_cvt_pk_bf16_f32 v214, v180, v181
v_cvt_pk_bf16_f32 v215, v182, v183
v_mfma_f32_16x16x32_bf16 v[136:139], a[132:135], v[52:55], v[136:139]
v_exp_f32 v173, v173
v_mfma_f32_16x16x32_bf16 v[136:139], a[136:139], v[56:59], v[136:139]
buffer_load_dwordx4 v1, s[44:47], s72 offen offset:2048 sc1 lds
v_mfma_f32_16x16x32_bf16 v[136:139], a[140:143], v[60:63], v[136:139]
v_exp_f32 v174, v174
v_mfma_f32_16x16x32_bf16 v[152:155], a[156:159], v[60:63], v[88:91]
v_exp_f32 v175, v175
v_mfma_f32_16x16x32_bf16 v[152:155], a[152:155], v[56:59], v[152:155]
v_exp_f32 v188, v188
v_mfma_f32_16x16x32_bf16 v[152:155], a[148:151], v[52:55], v[152:155]
v_cvt_pk_bf16_f32 v220, v172, v173
v_cvt_pk_bf16_f32 v221, v174, v175
v_mfma_f32_16x16x32_bf16 v[152:155], a[144:147], v[48:51], v[152:155]
v_exp_f32 v189, v189
v_mfma_f32_16x16x32_bf16 v[132:135], a[132:135], v[36:39], v[132:135]
buffer_load_dwordx4 v1, s[44:47], s72 offen offset:3072 sc1 lds
v_mfma_f32_16x16x32_bf16 v[132:135], a[136:139], v[40:43], v[132:135]
s_add_u32 s66, s58, 1
v_exp_f32 v190, v190
v_mfma_f32_16x16x32_bf16 v[132:135], a[140:143], v[44:47], v[132:135]
s_and_b32 s66, s66, 3
v_exp_f32 v191, v191
v_mfma_f32_16x16x32_bf16 v[140:143], a[140:143], v[76:79], v[92:95]
s_mul_i32 s66, s66, 4160
v_exp_f32 v160, v160
v_mfma_f32_16x16x32_bf16 v[140:143], a[136:139], v[72:75], v[140:143]
s_add_u32 m0, s66, 131104
v_cvt_pk_bf16_f32 v222, v188, v189
v_cvt_pk_bf16_f32 v223, v190, v191
v_mfma_f32_16x16x32_bf16 v[140:143], a[132:135], v[68:71], v[140:143]
s_add_u32 s72, s93, 0x2
v_exp_f32 v161, v161
v_mfma_f32_16x16x32_bf16 v[140:143], a[128:131], v[64:67], v[140:143]
buffer_load_dwordx4 v1, s[36:39], s72 offen lds
v_mfma_f32_16x16x32_bf16 v[156:159], a[144:147], v[64:67], v[92:95]
v_exp_f32 v162, v162
v_mfma_f32_16x16x32_bf16 v[156:159], a[148:151], v[68:71], v[156:159]
v_exp_f32 v163, v163
v_mfma_f32_16x16x32_bf16 v[156:159], a[152:155], v[72:75], v[156:159]
buffer_load_dwordx4 v1, s[36:39], s72 offen offset:1024 lds
v_mfma_f32_16x16x32_bf16 v[156:159], a[156:159], v[76:79], v[156:159]
buffer_load_dwordx4 v1, s[36:39], s72 offen offset:2048 lds
v_mfma_f32_16x16x32_bf16 v[148:151], a[156:159], v[44:47], v[148:151]
buffer_load_dwordx4 v1, s[36:39], s72 offen offset:3072 lds
v_mfma_f32_16x16x32_bf16 v[148:151], a[152:155], v[40:43], v[148:151]
s_waitcnt vmcnt(12) lgkmcnt(4)
v_exp_f32 v176, v176
v_mfma_f32_16x16x32_bf16 v[148:151], a[148:151], v[36:39], v[148:151]
s_barrier
v_cvt_pk_bf16_f32 v208, v160, v161
v_cvt_pk_bf16_f32 v209, v162, v163
v_add_u32 v2, s82, v1
v_exp_f32 v177, v177
v_exp_f32 v178, v178
v_cvt_pk_bf16_f32 v210, v176, v177
v_exp_f32 v179, v179
v_exp_f32 v168, v168
v_cvt_pk_bf16_f32 v211, v178, v179
v_exp_f32 v169, v169
v_exp_f32 v170, v170
v_cvt_pk_bf16_f32 v216, v168, v169
v_exp_f32 v171, v171
v_exp_f32 v184, v184
v_cvt_pk_bf16_f32 v217, v170, v171
v_exp_f32 v185, v185
v_exp_f32 v186, v186
v_cvt_pk_bf16_f32 v218, v184, v185
v_exp_f32 v187, v187
s_nop 0
v_cvt_pk_bf16_f32 v219, v186, v187
s_branch LLT3
.p2align 12
s_endpgm
.p2align 7
LLT3x:
Lstub11:
s_cbranch_execz Lret
v_mfma_f32_16x16x32_bf16 v[228:231], v[120:123], v[196:199], v[228:231]
s_xor_b32 s74, s82, 0x10000
ds_read_b128 a[128:131], v2 offset:16384
v_and_b32 v240, 15, v0
v_mfma_f32_16x16x32_bf16 v[228:231], v[120:123], v[212:215], v[228:231]
s_add_u32 s74, s74, s64
v_exp_f32 v136, v136
v_mfma_f32_16x16x32_bf16 v[236:239], v[120:123], v[204:207], v[236:239]
s_add_u32 s81, s81, 0x8000
v_exp_f32 v137, v137
v_mfma_f32_16x16x32_bf16 v[236:239], v[120:123], v[220:223], v[236:239]
s_add_u32 m0, s74, 0
ds_read_b128 a[132:135], v2 offset:17408
v_cvt_pk_bf16_f32 v200, v136, v137
v_mfma_f32_16x16x32_bf16 a[32:35], a[192:195], v[196:199], a[32:35]
s_add_u32 s72, s81, 0
buffer_load_dwordx4 v1, s[44:47], s72 offen sc1 lds
v_mfma_f32_16x16x32_bf16 a[32:35], a[224:227], v[212:215], a[32:35]
s_add_u32 s69, s93, 0x3e00000
v_exp_f32 v138, v138
v_mfma_f32_16x16x32_bf16 a[96:99], a[224:227], v[220:223], a[96:99]
ds_read_b128 a[136:139], v2 offset:18432
v_lshrrev_b32 v241, 4, v0
v_mfma_f32_16x16x32_bf16 a[96:99], a[192:195], v[204:207], a[96:99]
v_exp_f32 v139, v139
v_mfma_f32_16x16x32_bf16 a[100:103], a[196:199], v[204:207], a[100:103]
buffer_store_dwordx4 v[112:115], v1, s[44:47], s69 offen sc1
v_mfma_f32_16x16x32_bf16 a[100:103], a[228:231], v[220:223], a[100:103]
v_exp_f32 v152, v152
v_mfma_f32_16x16x32_bf16 a[36:39], a[228:231], v[212:215], a[36:39]
ds_read_b128 a[140:143], v2 offset:19456
v_cvt_pk_bf16_f32 v201, v138, v139
v_mfma_f32_16x16x32_bf16 a[36:39], a[196:199], v[196:199], a[36:39]
v_exp_f32 v153, v153
v_mfma_f32_16x16x32_bf16 a[40:43], a[200:203], v[196:199], a[40:43]
buffer_load_dwordx4 v1, s[44:47], s72 offen offset:1024 sc1 lds
v_mfma_f32_16x16x32_bf16 a[40:43], a[232:235], v[212:215], a[40:43]
ds_read_b128 a[144:147], v2 offset:20480
v_cvt_pk_bf16_f32 v202, v152, v153
v_mfma_f32_16x16x32_bf16 a[104:107], a[232:235], v[220:223], a[104:107]
v_exp_f32 v154, v154
v_mfma_f32_16x16x32_bf16 a[104:107], a[200:203], v[204:207], a[104:107]
v_exp_f32 v155, v155
v_mfma_f32_16x16x32_bf16 a[108:111], a[204:207], v[204:207], a[108:111]
buffer_store_dwordx4 v[112:115], v1, s[44:47], s69 offen offset:1024 sc1
v_mfma_f32_16x16x32_bf16 a[108:111], a[236:239], v[220:223], a[108:111]
ds_read_b128 a[148:151], v2 offset:21504
v_cvt_pk_bf16_f32 v203, v154, v155
v_mfma_f32_16x16x32_bf16 a[44:47], a[236:239], v[212:215], a[44:47]
v_exp_f32 v132, v132
v_mfma_f32_16x16x32_bf16 a[44:47], a[204:207], v[196:199], a[44:47]
ds_read_b128 a[152:155], v2 offset:22528
v_add_u32 v248, 1, v240
v_mfma_f32_16x16x32_bf16 a[48:51], a[208:211], v[196:199], a[48:51]
s_waitcnt lgkmcnt(7)
v_exp_f32 v133, v133
v_mfma_f32_16x16x32_bf16 a[48:51], a[240:243], v[212:215], a[48:51]
buffer_load_dwordx4 v1, s[44:47], s72 offen offset:2048 sc1 lds
v_mfma_f32_16x16x32_bf16 a[112:115], a[240:243], v[220:223], a[112:115]
v_exp_f32 v134, v134
v_mfma_f32_16x16x32_bf16 a[112:115], a[208:211], v[204:207], a[112:115]
ds_read_b128 a[156:159], v2 offset:23552
v_and_b32 v249, 3, v248
v_mfma_f32_16x16x32_bf16 a[116:119], a[212:215], v[204:207], a[116:119]
v_exp_f32 v135, v135
v_mfma_f32_16x16x32_bf16 a[116:119], a[244:247], v[220:223], a[116:119]
buffer_store_dwordx4 v[112:115], v1, s[44:47], s69 offen offset:2048 sc1
v_mfma_f32_16x16x32_bf16 a[52:55], a[244:247], v[212:215], a[52:55]
ds_read_b128 a[192:195], v2 offset:0
v_lshrrev_b32 v248, 2, v248
v_mfma_f32_16x16x32_bf16 a[52:55], a[212:215], v[196:199], a[52:55]
v_exp_f32 v148, v148
v_mfma_f32_16x16x32_bf16 a[56:59], a[216:219], v[196:199], a[56:59]
buffer_load_dwordx4 v1, s[44:47], s72 offen offset:3072 sc1 lds
v_mfma_f32_16x16x32_bf16 a[56:59], a[248:251], v[212:215], a[56:59]
v_exp_f32 v149, v149
v_mfma_f32_16x16x32_bf16 a[120:123], a[248:251], v[220:223], a[120:123]
ds_read_b128 a[196:199], v2 offset:1024
v_mov_b32 v250, 0x20000
v_mfma_f32_16x16x32_bf16 a[120:123], a[216:219], v[204:207], a[120:123]
v_exp_f32 v150, v150
v_mfma_f32_16x16x32_bf16 a[124:127], a[220:223], v[204:207], a[124:127]
ds_read_b128 a[200:203], v2 offset:2048
v_mov_b32 v252, 0x20001
v_mfma_f32_16x16x32_bf16 a[124:127], a[252:255], v[220:223], a[124:127]
buffer_store_dwordx4 v[112:115], v1, s[44:47], s69 offen offset:3072 sc1
v_mfma_f32_16x16x32_bf16 a[60:63], a[252:255], v[212:215], a[60:63]
s_add_u32 s69, s93, 0x4200000
v_exp_f32 v151, v151
v_mfma_f32_16x16x32_bf16 a[60:63], a[220:223], v[196:199], a[60:63]
ds_read_b128 a[204:207], v2 offset:3072
v_cvt_pk_bf16_f32 v196, v132, v133
s_cmp_eq_u32 s58, 2
s_cbranch_scc1 Lta40
s_cmp_eq_u32 s58, 3
s_cbranch_scc1 Lnt41
v_mfma_f32_16x16x32_bf16 v[164:167], a[160:163], v[32:35], v[112:115]
ds_read_b128 a[208:211], v2 offset:4096
v_cvt_pk_bf16_f32 v197, v134, v135
v_mfma_f32_16x16x32_bf16 v[180:183], a[176:179], v[32:35], v[112:115]
v_exp_f32 v140, v140
s_branch Ljoin42
Lta40:
v_mfma_f32_16x16x32_bf16 v[164:167], a[160:163], v[32:35], v[100:103]
ds_read_b128 a[208:211], v2 offset:4096
v_cvt_pk_bf16_f32 v197, v134, v135
v_mfma_f32_16x16x32_bf16 v[180:183], a[176:179], v[32:35], v[112:115]
v_exp_f32 v140, v140
s_branch Ljoin42
Lnt41:
v_mfma_f32_16x16x32_bf16 v[164:167], a[160:163], v[32:35], v[84:87]
ds_read_b128 a[208:211], v2 offset:4096
v_cvt_pk_bf16_f32 v197, v134, v135
v_mfma_f32_16x16x32_bf16 v[180:183], a[176:179], v[32:35], v[100:103]
v_exp_f32 v140, v140
Ljoin42:
v_mfma_f32_16x16x32_bf16 v[164:167], a[164:167], v[36:39], v[164:167]
ds_read_b128 a[212:215], v2 offset:5120
v_cvt_pk_bf16_f32 v198, v148, v149
v_mfma_f32_16x16x32_bf16 v[164:167], a[168:171], v[40:43], v[164:167]
buffer_store_dwordx4 v[112:115], v1, s[44:47], s69 offen sc1
v_mfma_f32_16x16x32_bf16 v[164:167], a[172:175], v[44:47], v[164:167]
v_exp_f32 v141, v141
v_mfma_f32_16x16x32_bf16 v[172:175], a[172:175], v[76:79], v[92:95]
v_exp_f32 v142, v142
v_mfma_f32_16x16x32_bf16 v[172:175], a[168:171], v[72:75], v[172:175]
ds_read_b128 a[216:219], v2 offset:6144
v_cvt_pk_bf16_f32 v199, v150, v151
v_mfma_f32_16x16x32_bf16 v[172:175], a[164:167], v[68:71], v[172:175]
buffer_store_dwordx4 v[112:115], v1, s[44:47], s69 offen offset:1024 sc1
v_mfma_f32_16x16x32_bf16 v[172:175], a[160:163], v[64:67], v[172:175]
v_exp_f32 v143, v143
v_mfma_f32_16x16x32_bf16 v[188:191], a[176:179], v[64:67], v[92:95]
v_exp_f32 v156, v156
v_mfma_f32_16x16x32_bf16 v[188:191], a[180:183], v[68:71], v[188:191]
ds_read_b128 a[220:223], v2 offset:7168
v_cvt_pk_bf16_f32 v204, v140, v141
v_mfma_f32_16x16x32_bf16 v[188:191], a[184:187], v[72:75], v[188:191]
buffer_store_dwordx4 v[112:115], v1, s[44:47], s69 offen offset:2048 sc1
v_mfma_f32_16x16x32_bf16 v[188:191], a[188:191], v[76:79], v[188:191]
v_exp_f32 v157, v157
v_mfma_f32_16x16x32_bf16 v[180:183], a[188:191], v[44:47], v[180:183]
v_exp_f32 v158, v158
v_mfma_f32_16x16x32_bf16 v[180:183], a[184:187], v[40:43], v[180:183]
v_cvt_pk_bf16_f32 v205, v142, v143
v_cvt_pk_bf16_f32 v206, v156, v157
v_mfma_f32_16x16x32_bf16 v[180:183], a[180:183], v[36:39], v[180:183]
buffer_store_dwordx4 v[112:115], v1, s[44:47], s69 offen offset:3072 sc1
v_mfma_f32_16x16x32_bf16 v[168:171], a[160:163], v[48:51], v[88:91]
v_exp_f32 v159, v159
v_mfma_f32_16x16x32_bf16 v[168:171], a[164:167], v[52:55], v[168:171]
v_cvt_pk_bf16_f32 v207, v158, v159
v_lshlrev_b32 v6, 3, v249
v_mfma_f32_16x16x32_bf16 v[168:171], a[168:171], v[56:59], v[168:171]
v_lshrrev_b32 v6, v6, v252
v_and_b32 v6, 3, v6
v_mfma_f32_16x16x32_bf16 v[168:171], a[172:175], v[60:63], v[168:171]
v_cmp_ne_u32 vcc, 1, v249
v_mul_u32_u24 v6, 16640, v6
v_mfma_f32_16x16x32_bf16 v[184:187], a[188:191], v[60:63], v[88:91]
v_add_u32 v6, s92, v6
v_cndmask_b32 v6, v250, v6, vcc
v_mfma_f32_16x16x32_bf16 v[184:187], a[184:187], v[56:59], v[184:187]
v_add_u32 v253, s58, v249
v_and_b32 v253, 3, v253
v_mfma_f32_16x16x32_bf16 v[184:187], a[180:183], v[52:55], v[184:187]
s_waitcnt lgkmcnt(4)
v_mfma_f32_16x16x32_bf16 v[184:187], a[176:179], v[48:51], v[184:187]
s_barrier
s_lshr_b32 s69, s93, 4
s_and_b32 s69, s69, 0x7f00
s_add_u32 s69, s69, LHT4-Lpc0
v_lshrrev_b32 v3, 5, v0
v_lshlrev_b32 v3, 7, v3
v_add_u32 v3, s69, v3
v_min_u32 v3, Lcode_end-Lpc0, v3
global_load_dword v4, v3, s[98:99]
v_mfma_f32_16x16x32_bf16 v[224:227], v[120:123], v[208:211], v[224:227]
s_add_u32 s82, s82, 0x8000
ds_read_b128 a[160:163], v2 offset:24576
ds_read_b128 a[164:167], v2 offset:25600
v_mfma_f32_16x16x32_bf16 v[232:235], v[120:123], v[216:219], v[232:235]
s_and_b32 s82, s82, 0x1ffff
v_exp_f32 v164, v164
v_mfma_f32_16x16x32_bf16 v[232:235], v[120:123], v[200:203], v[232:235]
s_add_u32 s66, s58, 3
v_exp_f32 v165, v165
v_mfma_f32_16x16x32_bf16 a[0:3], a[224:227], v[208:211], a[0:3]
s_and_b32 s66, s66, 3
v_exp_f32 v166, v166
v_mfma_f32_16x16x32_bf16 a[64:67], a[192:195], v[200:203], a[64:67]
s_mul_i32 s66, s66, 4160
ds_read_b128 a[168:171], v2 offset:26624
v_cvt_pk_bf16_f32 v212, v164, v165
v_mfma_f32_16x16x32_bf16 a[64:67], a[224:227], v[216:219], a[64:67]
s_add_u32 s66, s66, s92
v_exp_f32 v167, v167
v_mfma_f32_16x16x32_bf16 a[68:71], a[228:231], v[216:219], a[68:71]
s_add_u32 m0, s66, 32
v_exp_f32 v180, v180
v_mfma_f32_16x16x32_bf16 a[68:71], a[196:199], v[200:203], a[68:71]
s_add_u32 s72, s93, 0x6
buffer_load_dwordx4 v1, s[36:39], s72 offen lds
v_mfma_f32_16x16x32_bf16 a[4:7], a[228:231], v[208:211], a[4:7]
ds_read_b128 a[172:175], v2 offset:27648
v_cvt_pk_bf16_f32 v213, v166, v167
v_mfma_f32_16x16x32_bf16 a[8:11], a[232:235], v[208:211], a[8:11]
v_exp_f32 v181, v181
v_mfma_f32_16x16x32_bf16 a[72:75], a[200:203], v[200:203], a[72:75]
ds_read_b128 a[176:179], v2 offset:28672
v_cvt_pk_bf16_f32 v214, v180, v181
v_mfma_f32_16x16x32_bf16 a[72:75], a[232:235], v[216:219], a[72:75]
v_exp_f32 v182, v182
v_mfma_f32_16x16x32_bf16 a[76:79], a[236:239], v[216:219], a[76:79]
v_exp_f32 v183, v183
v_mfma_f32_16x16x32_bf16 a[76:79], a[204:207], v[200:203], a[76:79]
ds_read_b128 a[180:183], v2 offset:29696
v_cvt_pk_bf16_f32 v215, v182, v183
v_mfma_f32_16x16x32_bf16 a[12:15], a[236:239], v[208:211], a[12:15]
v_exp_f32 v172, v172
v_mfma_f32_16x16x32_bf16 a[16:19], a[240:243], v[208:211], a[16:19]
s_waitcnt lgkmcnt(6)
ds_read_b128 a[184:187], v2 offset:30720
ds_read_b128 a[188:191], v2 offset:31744
v_mfma_f32_16x16x32_bf16 a[80:83], a[208:211], v[200:203], a[80:83]
v_exp_f32 v173, v173
v_mfma_f32_16x16x32_bf16 a[80:83], a[240:243], v[216:219], a[80:83]
buffer_load_dwordx4 v1, s[36:39], s72 offen offset:1024 lds
v_mfma_f32_16x16x32_bf16 a[84:87], a[244:247], v[216:219], a[84:87]
v_exp_f32 v174, v174
v_mfma_f32_16x16x32_bf16 a[84:87], a[212:215], v[200:203], a[84:87]
v_exp_f32 v175, v175
v_mfma_f32_16x16x32_bf16 a[20:23], a[244:247], v[208:211], a[20:23]
ds_read_b128 a[224:227], v2 offset:8192
v_cvt_pk_bf16_f32 v220, v172, v173
v_mfma_f32_16x16x32_bf16 a[24:27], a[248:251], v[208:211], a[24:27]
v_exp_f32 v188, v188
v_mfma_f32_16x16x32_bf16 a[88:91], a[216:219], v[200:203], a[88:91]
v_exp_f32 v189, v189
v_mfma_f32_16x16x32_bf16 a[88:91], a[248:251], v[216:219], a[88:91]
ds_read_b128 a[228:231], v2 offset:9216
v_cvt_pk_bf16_f32 v221, v174, v175
v_mfma_f32_16x16x32_bf16 a[92:95], a[252:255], v[216:219], a[92:95]
v_exp_f32 v190, v190
v_mfma_f32_16x16x32_bf16 a[92:95], a[220:223], v[200:203], a[92:95]
ds_read_b128 a[232:235], v2 offset:10240
v_cvt_pk_bf16_f32 v222, v188, v189
v_mfma_f32_16x16x32_bf16 a[28:31], a[252:255], v[208:211], a[28:31]
v_exp_f32 v191, v191
s_cmp_eq_u32 s58, 0
s_cbranch_scc1 Lta43
s_cmp_eq_u32 s58, 1
s_cbranch_scc1 Lnt44
v_mfma_f32_16x16x32_bf16 v[136:139], a[128:131], v[48:51], v[88:91]
buffer_load_dwordx4 v1, s[36:39], s72 offen offset:2048 lds
v_mfma_f32_16x16x32_bf16 v[152:155], a[144:147], v[48:51], v[88:91]
v_exp_f32 v168, v168
s_branch Ljoin45
Lta43:
v_mfma_f32_16x16x32_bf16 v[136:139], a[128:131], v[48:51], v[104:107]
buffer_load_dwordx4 v1, s[36:39], s72 offen offset:2048 lds
v_mfma_f32_16x16x32_bf16 v[152:155], a[144:147], v[48:51], v[112:115]
v_exp_f32 v168, v168
s_branch Ljoin45
Lnt44:
v_mfma_f32_16x16x32_bf16 v[136:139], a[128:131], v[48:51], v[88:91]
buffer_load_dwordx4 v1, s[36:39], s72 offen offset:2048 lds
v_mfma_f32_16x16x32_bf16 v[152:155], a[144:147], v[48:51], v[104:107]
v_exp_f32 v168, v168
Ljoin45:
v_mfma_f32_16x16x32_bf16 v[136:139], a[132:135], v[52:55], v[136:139]
ds_read_b128 a[236:239], v2 offset:11264
v_cvt_pk_bf16_f32 v223, v190, v191
v_mfma_f32_16x16x32_bf16 v[136:139], a[136:139], v[56:59], v[136:139]
v_exp_f32 v169, v169
v_mfma_f32_16x16x32_bf16 v[136:139], a[140:143], v[60:63], v[136:139]
ds_read_b128 a[240:243], v2 offset:12288
v_cvt_pk_bf16_f32 v216, v168, v169
v_mfma_f32_16x16x32_bf16 v[152:155], a[156:159], v[60:63], v[152:155]
v_exp_f32 v170, v170
v_mfma_f32_16x16x32_bf16 v[152:155], a[152:155], v[56:59], v[152:155]
v_exp_f32 v171, v171
v_mfma_f32_16x16x32_bf16 v[152:155], a[148:151], v[52:55], v[152:155]
ds_read_b128 a[244:247], v2 offset:13312
v_cvt_pk_bf16_f32 v217, v170, v171
v_mfma_f32_16x16x32_bf16 v[140:143], a[128:131], v[64:67], v[92:95]
v_exp_f32 v184, v184
v_mfma_f32_16x16x32_bf16 v[140:143], a[132:135], v[68:71], v[140:143]
ds_read_b128 a[248:251], v2 offset:14336
v_mfma_f32_16x16x32_bf16 v[140:143], a[136:139], v[72:75], v[140:143]
v_exp_f32 v185, v185
v_mfma_f32_16x16x32_bf16 v[140:143], a[140:143], v[76:79], v[140:143]
buffer_load_dwordx4 v1, s[36:39], s72 offen offset:3072 lds
v_mfma_f32_16x16x32_bf16 v[156:159], a[156:159], v[76:79], v[92:95]
ds_read_b128 a[252:255], v2 offset:15360
v_cvt_pk_bf16_f32 v218, v184, v185
v_mfma_f32_16x16x32_bf16 v[156:159], a[152:155], v[72:75], v[156:159]
v_exp_f32 v186, v186
v_mfma_f32_16x16x32_bf16 v[156:159], a[148:151], v[68:71], v[156:159]
s_waitcnt vmcnt(17) lgkmcnt(0)
v_exp_f32 v187, v187
v_mfma_f32_16x16x32_bf16 v[156:159], a[144:147], v[64:67], v[156:159]
s_barrier
v_cvt_pk_bf16_f32 v219, v186, v187
v_add_u32 v2, s82, v1
v_mfma_f32_16x16x32_bf16 v[228:231], v[120:123], v[196:199], v[228:231]
s_mov_b32 m0, s62
v_exp_f32 v136, v136
v_mfma_f32_16x16x32_bf16 v[228:231], v[120:123], v[212:215], v[228:231]
s_add_u32 s72, s93, 0x3000000
ds_read_b128 a[128:131], v2 offset:16384
v_mul_u32_u24 v253, 4160, v253
v_mfma_f32_16x16x32_bf16 v[236:239], v[120:123], v[204:207], v[236:239]
buffer_load_dwordx4 v1, s[44:47], s72 offen sc1 lds
v_mfma_f32_16x16x32_bf16 v[236:239], v[120:123], v[220:223], v[236:239]
v_exp_f32 v137, v137
v_mfma_f32_16x16x32_bf16 a[32:35], a[192:195], v[196:199], a[32:35]
ds_read_b128 a[132:135], v2 offset:17408
v_cvt_pk_bf16_f32 v200, v136, v137
v_mfma_f32_16x16x32_bf16 a[32:35], a[224:227], v[212:215], a[32:35]
v_exp_f32 v138, v138
v_mfma_f32_16x16x32_bf16 a[96:99], a[224:227], v[220:223], a[96:99]
ds_read_b128 a[136:139], v2 offset:18432
v_add_u32 v6, v6, v253
v_mfma_f32_16x16x32_bf16 a[96:99], a[192:195], v[204:207], a[96:99]
buffer_load_dwordx4 v1, s[44:47], s72 offen offset:1024 sc1 lds
v_mfma_f32_16x16x32_bf16 a[100:103], a[196:199], v[204:207], a[100:103]
v_exp_f32 v139, v139
v_mfma_f32_16x16x32_bf16 a[100:103], a[228:231], v[220:223], a[100:103]
ds_read_b128 a[140:143], v2 offset:19456
v_cvt_pk_bf16_f32 v201, v138, v139
v_mfma_f32_16x16x32_bf16 a[36:39], a[228:231], v[212:215], a[36:39]
v_exp_f32 v152, v152
v_mfma_f32_16x16x32_bf16 a[36:39], a[196:199], v[196:199], a[36:39]
ds_read_b128 a[144:147], v2 offset:20480
v_bfe_u32 v251, v0, 2, 2
v_mfma_f32_16x16x32_bf16 a[40:43], a[200:203], v[196:199], a[40:43]
buffer_load_dwordx4 v1, s[44:47], s72 offen offset:2048 sc1 lds
v_mfma_f32_16x16x32_bf16 a[40:43], a[232:235], v[212:215], a[40:43]
v_exp_f32 v153, v153
v_mfma_f32_16x16x32_bf16 a[104:107], a[232:235], v[220:223], a[104:107]
ds_read_b128 a[148:151], v2 offset:21504
v_cvt_pk_bf16_f32 v202, v152, v153
v_mfma_f32_16x16x32_bf16 a[104:107], a[200:203], v[204:207], a[104:107]
buffer_load_dwordx4 v1, s[44:47], s72 offen offset:3072 sc1 lds
v_mfma_f32_16x16x32_bf16 a[108:111], a[204:207], v[204:207], a[108:111]
s_add_u32 s66, s58, 0
v_exp_f32 v154, v154
v_mfma_f32_16x16x32_bf16 a[108:111], a[236:239], v[220:223], a[108:111]
s_and_b32 s66, s66, 3
ds_read_b128 a[152:155], v2 offset:22528
v_lshl_add_u32 v6, v248, 3, v6
v_mfma_f32_16x16x32_bf16 a[44:47], a[236:239], v[212:215], a[44:47]
s_mul_i32 s66, s66, 4160
v_exp_f32 v155, v155
v_mfma_f32_16x16x32_bf16 a[44:47], a[204:207], v[196:199], a[44:47]
s_add_u32 s66, s66, s92
ds_read_b128 a[156:159], v2 offset:23552
v_cvt_pk_bf16_f32 v203, v154, v155
v_mfma_f32_16x16x32_bf16 a[48:51], a[208:211], v[196:199], a[48:51]
s_waitcnt lgkmcnt(8)
v_exp_f32 v140, v140
v_mfma_f32_16x16x32_bf16 a[48:51], a[240:243], v[212:215], a[48:51]
s_add_u32 m0, s66, 16672
ds_read_b128 a[192:195], v2 offset:0
v_lshl_add_u32 v6, v241, 4, v6
v_mfma_f32_16x16x32_bf16 a[112:115], a[240:243], v[220:223], a[112:115]
s_add_u32 s72, s93, 0x0
buffer_load_dwordx4 v1, s[36:39], s72 offen lds
v_mfma_f32_16x16x32_bf16 a[112:115], a[208:211], v[204:207], a[112:115]
buffer_load_dwordx4 v1, s[36:39], s72 offen offset:1024 lds
v_mfma_f32_16x16x32_bf16 a[116:119], a[212:215], v[204:207], a[116:119]
v_exp_f32 v141, v141
v_mfma_f32_16x16x32_bf16 a[116:119], a[244:247], v[220:223], a[116:119]
ds_read_b128 a[196:199], v2 offset:1024
v_lshlrev_b32 v5, 3, v251
v_mfma_f32_16x16x32_bf16 a[52:55], a[244:247], v[212:215], a[52:55]
v_exp_f32 v142, v142
v_mfma_f32_16x16x32_bf16 a[52:55], a[212:215], v[196:199], a[52:55]
ds_read_b128 a[200:203], v2 offset:2048
v_lshrrev_b32 v5, v5, v252
v_mfma_f32_16x16x32_bf16 a[56:59], a[216:219], v[196:199], a[56:59]
buffer_load_dwordx4 v1, s[36:39], s72 offen offset:2048 lds
v_mfma_f32_16x16x32_bf16 a[56:59], a[248:251], v[212:215], a[56:59]
v_exp_f32 v143, v143
v_mfma_f32_16x16x32_bf16 a[120:123], a[248:251], v[220:223], a[120:123]
ds_read_b128 a[204:207], v2 offset:3072
v_and_b32 v5, 3, v5
v_mfma_f32_16x16x32_bf16 a[120:123], a[216:219], v[204:207], a[120:123]
v_exp_f32 v156, v156
v_mfma_f32_16x16x32_bf16 a[124:127], a[220:223], v[204:207], a[124:127]
ds_read_b128 a[208:211], v2 offset:4096
v_cmp_ne_u32 vcc, 1, v251
v_mfma_f32_16x16x32_bf16 a[124:127], a[252:255], v[220:223], a[124:127]
buffer_load_dwordx4 v1, s[36:39], s72 offen offset:3072 lds
v_mfma_f32_16x16x32_bf16 a[60:63], a[252:255], v[212:215], a[60:63]
s_add_u32 s66, s58, 2
v_exp_f32 v157, v157
v_mfma_f32_16x16x32_bf16 a[60:63], a[220:223], v[196:199], a[60:63]
s_and_b32 s66, s66, 3
ds_read_b128 a[212:215], v2 offset:5120
v_cvt_pk_bf16_f32 v204, v140, v141
s_cmp_eq_u32 s58, 2
s_cbranch_scc1 Lta46
s_cmp_eq_u32 s58, 3
s_cbranch_scc1 Lnt47
v_mfma_f32_16x16x32_bf16 v[168:171], a[160:163], v[48:51], v[112:115]
s_mul_i32 s66, s66, 4160
v_exp_f32 v158, v158
v_mfma_f32_16x16x32_bf16 v[184:187], a[176:179], v[48:51], v[112:115]
s_add_u32 s66, s66, s92
ds_read_b128 a[216:219], v2 offset:6144
v_cvt_pk_bf16_f32 v205, v142, v143
s_branch Ljoin48
Lta46:
v_mfma_f32_16x16x32_bf16 v[168:171], a[160:163], v[48:51], v[104:107]
s_mul_i32 s66, s66, 4160
v_exp_f32 v158, v158
v_mfma_f32_16x16x32_bf16 v[184:187], a[176:179], v[48:51], v[112:115]
s_add_u32 s66, s66, s92
ds_read_b128 a[216:219], v2 offset:6144
v_cvt_pk_bf16_f32 v205, v142, v143
s_branch Ljoin48
Lnt47:
v_mfma_f32_16x16x32_bf16 v[168:171], a[160:163], v[48:51], v[88:91]
s_mul_i32 s66, s66, 4160
v_exp_f32 v158, v158
v_mfma_f32_16x16x32_bf16 v[184:187], a[176:179], v[48:51], v[104:107]
s_add_u32 s66, s66, s92
ds_read_b128 a[216:219], v2 offset:6144
v_cvt_pk_bf16_f32 v205, v142, v143
Ljoin48:
v_mfma_f32_16x16x32_bf16 v[172:175], a[160:163], v[64:67], v[92:95]
s_add_u32 m0, s66, 33312
v_exp_f32 v159, v159
v_mfma_f32_16x16x32_bf16 v[172:175], a[164:167], v[68:71], v[172:175]
s_add_u32 s72, s93, 0x4
buffer_load_dwordx4 v1, s[36:39], s72 offen lds
v_mfma_f32_16x16x32_bf16 v[172:175], a[168:171], v[72:75], v[172:175]
ds_read_b128 a[220:223], v2 offset:7168
v_cvt_pk_bf16_f32 v206, v156, v157
v_mfma_f32_16x16x32_bf16 v[172:175], a[172:175], v[76:79], v[172:175]
buffer_load_dwordx4 v1, s[36:39], s72 offen offset:1024 lds
v_mfma_f32_16x16x32_bf16 v[188:191], a[188:191], v[76:79], v[92:95]
v_cvt_pk_bf16_f32 v207, v158, v159
v_mul_u32_u24 v5, 16640, v5
v_mfma_f32_16x16x32_bf16 v[188:191], a[184:187], v[72:75], v[188:191]
v_add_u32 v5, s92, v5
v_cndmask_b32 v5, v250, v5, vcc
v_mfma_f32_16x16x32_bf16 v[188:191], a[180:183], v[68:71], v[188:191]
v_add_u32 v253, s58, v251
v_and_b32 v253, 3, v253
v_mfma_f32_16x16x32_bf16 v[188:191], a[176:179], v[64:67], v[188:191]
v_mul_u32_u24 v253, 4160, v253
v_add_u32 v5, v5, v253
v_mfma_f32_16x16x32_bf16 v[168:171], a[164:167], v[52:55], v[168:171]
s_add_u32 s73, s62, 480
v_lshlrev_b32 v248, 5, v240
v_sub_u32 v248, s73, v248
v_mfma_f32_16x16x32_bf16 v[168:171], a[168:171], v[56:59], v[168:171]
v_lshl_add_u32 v7, v241, 4, v248
v_mfma_f32_16x16x32_bf16 v[168:171], a[172:175], v[60:63], v[168:171]
s_and_b32 s73, s58, 1
v_mfma_f32_16x16x32_bf16 v[184:187], a[188:191], v[60:63], v[184:187]
s_lshl_b32 s73, s73, 4
v_mfma_f32_16x16x32_bf16 v[184:187], a[184:187], v[56:59], v[184:187]
s_lshr_b32 s73, s90, s73
v_mfma_f32_16x16x32_bf16 v[184:187], a[180:183], v[52:55], v[184:187]
s_waitcnt lgkmcnt(4)
s_and_b32 s73, s73, 0xffff
v_lshl_add_u32 v248, v241, 3, v240
v_sub_u32 v248, 15, v248
v_and_b32 v249, 1, v248
v_lshlrev_b32 v249, 4, v249
v_lshlrev_b32 v249, v249, s73
v_lshrrev_b32 v248, 1, v248
v_and_b32 v241, 3, v0
v_cmp_eq_u32 vcc, 0, v248
v_lshl_add_u32 v5, v241, 3, v5
s_nop 0
v_cndmask_b32 v8, 0, v249, vcc
v_cmp_eq_u32 vcc, 1, v248
v_lshlrev_b32 v240, 4, v251
s_nop 0
v_cndmask_b32 v9, 0, v249, vcc
v_cmp_eq_u32 vcc, 2, v248
v_sub_u32 v240, 48, v240
v_lshlrev_b64 v[12:13], 16, s[88:89]
v_cndmask_b32 v10, 0, v249, vcc
v_cmp_eq_u32 vcc, 3, v248
v_lshlrev_b64 v[12:13], v240, v[12:13]
s_nop 0
v_cndmask_b32 v11, 0, v249, vcc
v_cmp_eq_u32 vcc, 3, v241
s_add_u32 s73, s62, 4096
v_lshl_add_u32 v14, v0, 3, s73
v_cndmask_b32 v12, 0, v12, vcc
v_cndmask_b32 v13, 0, v13, vcc
v_lshrrev_b32 v15, 4, v0
v_lshlrev_b32 v15, 1, v15
v_and_b32 v240, 7, v0
v_xor_b32 v15, v15, v240
v_lshlrev_b32 v15, 4, v15
v_lshrrev_b32 v240, 3, v0
v_lshl_add_u32 v15, v240, 11, v15
s_lshl_b32 s75, s59, 1
s_andn2_b32 s75, 8, s75
s_add_u32 s75, s75, s60
s_lshl_b32 s76, s65, 2
s_lshr_b32 s80, s59, 3
s_add_u32 s76, s76, s80
s_lshl_b32 s94, s58, 16
s_lshl_b32 s80, s76, 7
s_add_u32 s94, s94, s80
s_lshl_b32 s80, s75, 18
s_add_u32 s80, s80, s94
v_rcp_f32 v226, v224
v_rcp_f32 v230, v228
s_lshl_b32 s73, s52, 12
s_add_u32 s73, s73, 0x2000000
s_lshl_b32 s70, s67, 2
s_add_u32 s70, s70, s73
v_or_b32 v3, s53, v1
v_mov_b32 v227, v226
v_accvgpr_read_b32 v240, a0
v_accvgpr_read_b32 v241, a1
v_accvgpr_read_b32 v242, a2
v_accvgpr_read_b32 v243, a3
v_accvgpr_read_b32 v244, a4
v_accvgpr_read_b32 v245, a5
v_accvgpr_read_b32 v246, a6
v_accvgpr_read_b32 v247, a7
v_pk_mul_f32 v[240:241], v[240:241], v[226:227]
v_pk_mul_f32 v[242:243], v[242:243], v[226:227]
v_pk_mul_f32 v[244:245], v[244:245], v[226:227]
buffer_load_dwordx4 v1, s[36:39], s72 offen offset:2048 lds
v_pk_mul_f32 v[246:247], v[246:247], v[226:227]
v_cvt_pk_bf16_f32 v128, v240, v241
v_cvt_pk_bf16_f32 v129, v242, v243
v_cvt_pk_bf16_f32 v130, v244, v245
v_cvt_pk_bf16_f32 v131, v246, v247
v_accvgpr_read_b32 v248, a8
v_accvgpr_read_b32 v249, a9
v_accvgpr_read_b32 v250, a10
v_accvgpr_read_b32 v251, a11
v_accvgpr_read_b32 v252, a12
v_accvgpr_read_b32 v253, a13
v_accvgpr_read_b32 v254, a14
v_accvgpr_read_b32 v255, a15
v_pk_mul_f32 v[248:249], v[248:249], v[226:227]
v_pk_mul_f32 v[250:251], v[250:251], v[226:227]
v_pk_mul_f32 v[252:253], v[252:253], v[226:227]
v_pk_mul_f32 v[254:255], v[254:255], v[226:227]
v_cvt_pk_bf16_f32 v144, v248, v249
buffer_load_dwordx4 v1, s[36:39], s72 offen offset:3072 lds
v_cvt_pk_bf16_f32 v145, v250, v251
v_cvt_pk_bf16_f32 v146, v252, v253
v_cvt_pk_bf16_f32 v147, v254, v255
v_accvgpr_read_b32 v240, a16
v_accvgpr_read_b32 v241, a17
v_accvgpr_read_b32 v242, a18
v_accvgpr_read_b32 v243, a19
v_accvgpr_read_b32 v244, a20
v_accvgpr_read_b32 v245, a21
v_accvgpr_read_b32 v246, a22
v_accvgpr_read_b32 v247, a23
v_pk_mul_f32 v[240:241], v[240:241], v[226:227]
v_pk_mul_f32 v[242:243], v[242:243], v[226:227]
v_pk_mul_f32 v[244:245], v[244:245], v[226:227]
v_pk_mul_f32 v[246:247], v[246:247], v[226:227]
v_cvt_pk_bf16_f32 v160, v240, v241
v_cvt_pk_bf16_f32 v161, v242, v243
v_cvt_pk_bf16_f32 v162, v244, v245
buffer_load_dwordx4 v[80:83], v15, s[4:7], s80 offen
v_cvt_pk_bf16_f32 v163, v246, v247
v_accvgpr_read_b32 v248, a24
v_accvgpr_read_b32 v249, a25
v_accvgpr_read_b32 v250, a26
v_accvgpr_read_b32 v251, a27
v_accvgpr_read_b32 v252, a28
v_accvgpr_read_b32 v253, a29
v_accvgpr_read_b32 v254, a30
v_accvgpr_read_b32 v255, a31
v_pk_mul_f32 v[248:249], v[248:249], v[226:227]
v_pk_mul_f32 v[250:251], v[250:251], v[226:227]
v_pk_mul_f32 v[252:253], v[252:253], v[226:227]
v_pk_mul_f32 v[254:255], v[254:255], v[226:227]
v_cvt_pk_bf16_f32 v176, v248, v249
v_cvt_pk_bf16_f32 v177, v250, v251
v_cvt_pk_bf16_f32 v178, v252, v253
v_cvt_pk_bf16_f32 v179, v254, v255
v_mov_b32 v231, v230
v_accvgpr_read_b32 v240, a32
s_add_u32 s80, s80, 0x4000
buffer_load_dwordx4 v[84:87], v15, s[4:7], s80 offen
v_accvgpr_read_b32 v241, a33
v_accvgpr_read_b32 v242, a34
v_accvgpr_read_b32 v243, a35
v_accvgpr_read_b32 v244, a36
v_accvgpr_read_b32 v245, a37
v_accvgpr_read_b32 v246, a38
v_accvgpr_read_b32 v247, a39
v_pk_mul_f32 v[240:241], v[240:241], v[230:231]
v_pk_mul_f32 v[242:243], v[242:243], v[230:231]
v_pk_mul_f32 v[244:245], v[244:245], v[230:231]
v_pk_mul_f32 v[246:247], v[246:247], v[230:231]
v_cvt_pk_bf16_f32 v132, v240, v241
v_cvt_pk_bf16_f32 v133, v242, v243
v_cvt_pk_bf16_f32 v134, v244, v245
v_cvt_pk_bf16_f32 v135, v246, v247
v_accvgpr_read_b32 v248, a40
v_accvgpr_read_b32 v249, a41
v_accvgpr_read_b32 v250, a42
s_add_u32 s80, s80, 0x4000
buffer_load_dwordx4 v[96:99], v15, s[4:7], s80 offen
v_accvgpr_read_b32 v251, a43
v_accvgpr_read_b32 v252, a44
v_accvgpr_read_b32 v253, a45
v_accvgpr_read_b32 v254, a46
v_accvgpr_read_b32 v255, a47
v_pk_mul_f32 v[248:249], v[248:249], v[230:231]
v_pk_mul_f32 v[250:251], v[250:251], v[230:231]
v_pk_mul_f32 v[252:253], v[252:253], v[230:231]
v_pk_mul_f32 v[254:255], v[254:255], v[230:231]
v_cvt_pk_bf16_f32 v148, v248, v249
v_cvt_pk_bf16_f32 v149, v250, v251
v_cvt_pk_bf16_f32 v150, v252, v253
v_cvt_pk_bf16_f32 v151, v254, v255
v_accvgpr_read_b32 v240, a48
v_accvgpr_read_b32 v241, a49
v_accvgpr_read_b32 v242, a50
v_accvgpr_read_b32 v243, a51
v_accvgpr_read_b32 v244, a52
s_add_u32 s80, s80, 0x4000
buffer_load_dwordx4 v[100:103], v15, s[4:7], s80 offen
v_accvgpr_read_b32 v245, a53
v_accvgpr_read_b32 v246, a54
v_accvgpr_read_b32 v247, a55
v_pk_mul_f32 v[240:241], v[240:241], v[230:231]
v_pk_mul_f32 v[242:243], v[242:243], v[230:231]
v_pk_mul_f32 v[244:245], v[244:245], v[230:231]
v_pk_mul_f32 v[246:247], v[246:247], v[230:231]
v_cvt_pk_bf16_f32 v164, v240, v241
v_cvt_pk_bf16_f32 v165, v242, v243
v_cvt_pk_bf16_f32 v166, v244, v245
v_cvt_pk_bf16_f32 v167, v246, v247
v_accvgpr_read_b32 v248, a56
v_accvgpr_read_b32 v249, a57
v_accvgpr_read_b32 v250, a58
v_accvgpr_read_b32 v251, a59
v_accvgpr_read_b32 v252, a60
v_accvgpr_read_b32 v253, a61
v_accvgpr_read_b32 v254, a62
v_accvgpr_read_b32 v255, a63
v_pk_mul_f32 v[248:249], v[248:249], v[230:231]
v_pk_mul_f32 v[250:251], v[250:251], v[230:231]
v_pk_mul_f32 v[252:253], v[252:253], v[230:231]
v_pk_mul_f32 v[254:255], v[254:255], v[230:231]
v_cvt_pk_bf16_f32 v180, v248, v249
v_cvt_pk_bf16_f32 v181, v250, v251
v_cvt_pk_bf16_f32 v182, v252, v253
v_cvt_pk_bf16_f32 v183, v254, v255
v_mfma_f32_16x16x32_bf16 v[232:235], v[120:123], v[216:219], v[232:235]
s_add_u32 s82, s82, 0x8000
ds_read_b128 a[160:163], v2 offset:24576
ds_read_b128 a[164:167], v2 offset:25600
v_mfma_f32_16x16x32_bf16 v[232:235], v[120:123], v[200:203], v[232:235]
s_and_b32 s82, s82, 0x1ffff
v_exp_f32 v172, v172
v_mfma_f32_16x16x32_bf16 a[64:67], a[224:227], v[216:219], a[64:67]
v_exp_f32 v173, v173
v_mfma_f32_16x16x32_bf16 a[64:67], a[192:195], v[200:203], a[64:67]
s_nop 0
ds_read_b128 a[168:171], v2 offset:26624
ds_read_b128 a[172:175], v2 offset:27648
v_mfma_f32_16x16x32_bf16 a[68:71], a[196:199], v[200:203], a[68:71]
v_exp_f32 v174, v174
v_mfma_f32_16x16x32_bf16 a[68:71], a[228:231], v[216:219], a[68:71]
v_exp_f32 v175, v175
v_mfma_f32_16x16x32_bf16 a[72:75], a[232:235], v[216:219], a[72:75]
buffer_store_dwordx4 v[128:131], v3, s[44:47], s70 offen sc1
v_mfma_f32_16x16x32_bf16 a[72:75], a[200:203], v[200:203], a[72:75]
s_nop 0
ds_read_b128 a[176:179], v2 offset:28672
ds_read_b128 a[180:183], v2 offset:29696
v_mfma_f32_16x16x32_bf16 a[76:79], a[204:207], v[200:203], a[76:79]
v_exp_f32 v188, v188
v_mfma_f32_16x16x32_bf16 a[76:79], a[236:239], v[216:219], a[76:79]
s_nop 0
ds_read_b128 a[184:187], v2 offset:30720
ds_read_b128 a[188:191], v2 offset:31744
v_mfma_f32_16x16x32_bf16 a[80:83], a[240:243], v[216:219], a[80:83]
s_waitcnt lgkmcnt(8)
ds_read_b128 a[224:227], v2 offset:8192
ds_read_b128 a[228:231], v2 offset:9216
v_mfma_f32_16x16x32_bf16 a[80:83], a[208:211], v[200:203], a[80:83]
s_nop 0
ds_read_b128 a[232:235], v2 offset:10240
ds_read_b128 a[236:239], v2 offset:11264
v_mfma_f32_16x16x32_bf16 a[84:87], a[212:215], v[200:203], a[84:87]
ds_read_b128 a[240:243], v2 offset:12288
v_cvt_pk_bf16_f32 v220, v172, v173
v_mfma_f32_16x16x32_bf16 a[84:87], a[244:247], v[216:219], a[84:87]
v_exp_f32 v189, v189
v_mfma_f32_16x16x32_bf16 a[88:91], a[248:251], v[216:219], a[88:91]
v_exp_f32 v190, v190
v_mfma_f32_16x16x32_bf16 a[88:91], a[216:219], v[200:203], a[88:91]
s_nop 0
ds_read_b128 a[244:247], v2 offset:13312
ds_read_b128 a[248:251], v2 offset:14336
v_mfma_f32_16x16x32_bf16 a[92:95], a[220:223], v[200:203], a[92:95]
v_cvt_pk_bf16_f32 v221, v174, v175
v_cvt_pk_bf16_f32 v222, v188, v189
v_mfma_f32_16x16x32_bf16 a[92:95], a[252:255], v[216:219], a[92:95]
v_exp_f32 v191, v191
s_cmp_eq_u32 s58, 0
s_cbranch_scc1 Lta49
s_cmp_eq_u32 s58, 1
s_cbranch_scc1 Lnt50
v_mfma_f32_16x16x32_bf16 v[140:143], a[128:131], v[64:67], v[92:95]
v_exp_f32 v168, v168
v_mfma_f32_16x16x32_bf16 v[156:159], a[144:147], v[64:67], v[92:95]
buffer_store_dwordx4 v[144:147], v3, s[44:47], s70 offen offset:1024 sc1
s_branch Ljoin51
Lta49:
v_mfma_f32_16x16x32_bf16 v[140:143], a[128:131], v[64:67], v[108:111]
v_exp_f32 v168, v168
v_mfma_f32_16x16x32_bf16 v[156:159], a[144:147], v[64:67], v[112:115]
buffer_store_dwordx4 v[144:147], v3, s[44:47], s70 offen offset:1024 sc1
s_branch Ljoin51
Lnt50:
v_mfma_f32_16x16x32_bf16 v[140:143], a[128:131], v[64:67], v[92:95]
v_exp_f32 v168, v168
v_mfma_f32_16x16x32_bf16 v[156:159], a[144:147], v[64:67], v[108:111]
buffer_store_dwordx4 v[144:147], v3, s[44:47], s70 offen offset:1024 sc1
Ljoin51:
v_mfma_f32_16x16x32_bf16 v[140:143], a[132:135], v[68:71], v[140:143]
v_exp_f32 v169, v169
v_mfma_f32_16x16x32_bf16 v[140:143], a[136:139], v[72:75], v[140:143]
v_exp_f32 v170, v170
v_mfma_f32_16x16x32_bf16 v[140:143], a[140:143], v[76:79], v[140:143]
buffer_store_dwordx4 v[160:163], v3, s[44:47], s70 offen offset:2048 sc1
v_mfma_f32_16x16x32_bf16 v[156:159], a[156:159], v[76:79], v[156:159]
ds_read_b128 a[252:255], v2 offset:15360
v_cvt_pk_bf16_f32 v223, v190, v191
v_mfma_f32_16x16x32_bf16 v[156:159], a[152:155], v[72:75], v[156:159]
s_waitcnt vmcnt(24) lgkmcnt(4)
v_exp_f32 v171, v171
v_mfma_f32_16x16x32_bf16 v[156:159], a[148:151], v[68:71], v[156:159]
s_barrier
v_exp_f32 v184, v184
v_add_u32 v2, s82, v1
v_cvt_pk_bf16_f32 v216, v168, v169
v_cvt_pk_bf16_f32 v217, v170, v171
v_exp_f32 v185, v185
v_exp_f32 v186, v186
v_cvt_pk_bf16_f32 v218, v184, v185
v_exp_f32 v187, v187
s_nop 0
v_cvt_pk_bf16_f32 v219, v186, v187
v_mfma_f32_16x16x32_bf16 v[236:239], v[120:123], v[204:207], v[236:239]
s_add_u32 s78, s59, 8
v_exp_f32 v140, v140
v_mfma_f32_16x16x32_bf16 v[236:239], v[120:123], v[220:223], v[236:239]
s_and_b32 s78, s78, 24
v_exp_f32 v141, v141
v_mfma_f32_16x16x32_bf16 a[96:99], a[192:195], v[204:207], a[96:99]
s_lshr_b32 s79, 0x67234501, s78
ds_read_b128 a[192:195], v2 offset:0
v_mfma_f32_16x16x32_bf16 a[96:99], a[224:227], v[220:223], a[96:99]
s_and_b32 s79, s79, 7
buffer_store_dwordx4 v[176:179], v3, s[44:47], s70 offen offset:3072 sc1
v_mfma_f32_16x16x32_bf16 a[100:103], a[228:231], v[220:223], a[100:103]
s_add_u32 s70, s70, 0x80000
v_exp_f32 v142, v142
v_mfma_f32_16x16x32_bf16 a[100:103], a[196:199], v[204:207], a[100:103]
s_lshl_b32 s79, s79, 18
ds_read_b128 a[196:199], v2 offset:1024
v_mfma_f32_16x16x32_bf16 a[104:107], a[200:203], v[204:207], a[104:107]
s_add_u32 s79, s79, s94
ds_read_b128 a[200:203], v2 offset:2048
v_mfma_f32_16x16x32_bf16 a[104:107], a[232:235], v[220:223], a[104:107]
s_add_u32 s12, s61, 0
v_exp_f32 v143, v143
v_mfma_f32_16x16x32_bf16 a[108:111], a[236:239], v[220:223], a[108:111]
s_and_b32 s12, s12, 3
v_exp_f32 v156, v156
v_mfma_f32_16x16x32_bf16 a[108:111], a[204:207], v[204:207], a[108:111]
s_lshl_b32 s12, s12, 21
ds_read_b128 a[204:207], v2 offset:3072
v_mfma_f32_16x16x32_bf16 a[112:115], a[208:211], v[204:207], a[112:115]
s_waitcnt lgkmcnt(4)
ds_read_b128 a[208:211], v2 offset:4096
v_mfma_f32_16x16x32_bf16 a[112:115], a[240:243], v[220:223], a[112:115]
s_add_u32 s12, s12, s79
buffer_store_dwordx4 v[132:135], v3, s[44:47], s70 offen sc1
v_mfma_f32_16x16x32_bf16 a[116:119], a[244:247], v[220:223], a[116:119]
s_add_u32 s13, s61, 1
v_exp_f32 v157, v157
v_mfma_f32_16x16x32_bf16 a[116:119], a[212:215], v[204:207], a[116:119]
s_and_b32 s13, s13, 3
ds_read_b128 a[212:215], v2 offset:5120
v_mfma_f32_16x16x32_bf16 a[120:123], a[216:219], v[204:207], a[120:123]
s_lshl_b32 s13, s13, 21
v_exp_f32 v158, v158
v_mfma_f32_16x16x32_bf16 a[120:123], a[248:251], v[220:223], a[120:123]
s_add_u32 s13, s13, s79
ds_read_b128 a[216:219], v2 offset:6144
v_mfma_f32_16x16x32_bf16 a[124:127], a[252:255], v[220:223], a[124:127]
s_add_u32 s14, s61, 2
buffer_store_dwordx4 v[148:151], v3, s[44:47], s70 offen offset:1024 sc1
v_mfma_f32_16x16x32_bf16 a[124:127], a[220:223], v[204:207], a[124:127]
s_and_b32 s14, s14, 3
ds_read_b128 a[220:223], v2 offset:7168
v_cvt_pk_bf16_f32 v204, v140, v141
s_cmp_eq_u32 s58, 2
s_cbranch_scc1 Lta52
s_cmp_eq_u32 s58, 3
s_cbranch_scc1 Lnt53
v_mfma_f32_16x16x32_bf16 v[172:175], a[160:163], v[64:67], v[112:115]
s_lshl_b32 s14, s14, 21
v_cvt_pk_bf16_f32 v205, v142, v143
v_cvt_pk_bf16_f32 v206, v156, v157
v_mfma_f32_16x16x32_bf16 v[188:191], a[176:179], v[64:67], v[112:115]
s_add_u32 s14, s14, s79
v_exp_f32 v159, v159
s_branch Ljoin54
Lta52:
v_mfma_f32_16x16x32_bf16 v[172:175], a[160:163], v[64:67], v[108:111]
s_lshl_b32 s14, s14, 21
v_cvt_pk_bf16_f32 v205, v142, v143
v_cvt_pk_bf16_f32 v206, v156, v157
v_mfma_f32_16x16x32_bf16 v[188:191], a[176:179], v[64:67], v[112:115]
s_add_u32 s14, s14, s79
v_exp_f32 v159, v159
s_branch Ljoin54
Lnt53:
v_mfma_f32_16x16x32_bf16 v[172:175], a[160:163], v[64:67], v[92:95]
s_lshl_b32 s14, s14, 21
v_cvt_pk_bf16_f32 v205, v142, v143
v_cvt_pk_bf16_f32 v206, v156, v157
v_mfma_f32_16x16x32_bf16 v[188:191], a[176:179], v[64:67], v[108:111]
s_add_u32 s14, s14, s79
v_exp_f32 v159, v159
Ljoin54:
v_mfma_f32_16x16x32_bf16 v[172:175], a[164:167], v[68:71], v[172:175]
s_add_u32 s15, s61, 3
v_cvt_pk_bf16_f32 v207, v158, v159
v_mfma_f32_16x16x32_bf16 v[172:175], a[168:171], v[72:75], v[172:175]
s_and_b32 s15, s15, 3
v_mfma_f32_16x16x32_bf16 v[172:175], a[172:175], v[76:79], v[172:175]
s_lshl_b32 s15, s15, 21
v_mfma_f32_16x16x32_bf16 v[188:191], a[188:191], v[76:79], v[188:191]
s_add_u32 s15, s15, s79
v_mfma_f32_16x16x32_bf16 v[188:191], a[184:187], v[72:75], v[188:191]
v_mfma_f32_16x16x32_bf16 v[188:191], a[180:183], v[68:71], v[188:191]
s_waitcnt lgkmcnt(4)
v_mfma_f32_16x16x32_bf16 v[232:235], v[120:123], v[216:219], v[232:235]
s_add_u32 s82, s82, 0x8000
v_exp_f32 v172, v172
v_mfma_f32_16x16x32_bf16 a[64:67], a[224:227], v[216:219], a[64:67]
s_and_b32 s82, s82, 0x1ffff
ds_read_b128 a[224:227], v2 offset:8192
v_mfma_f32_16x16x32_bf16 a[68:71], a[228:231], v[216:219], a[68:71]
ds_read_b128 a[228:231], v2 offset:9216
v_mfma_f32_16x16x32_bf16 a[72:75], a[232:235], v[216:219], a[72:75]
ds_read_b128 a[232:235], v2 offset:10240
v_mfma_f32_16x16x32_bf16 a[76:79], a[236:239], v[216:219], a[76:79]
buffer_store_dwordx4 v[164:167], v3, s[44:47], s70 offen offset:2048 sc1
v_mfma_f32_16x16x32_bf16 a[80:83], a[240:243], v[216:219], a[80:83]
s_nop 0
ds_read_b128 a[236:239], v2 offset:11264
ds_read_b128 a[240:243], v2 offset:12288
v_mfma_f32_16x16x32_bf16 a[84:87], a[244:247], v[216:219], a[84:87]
ds_read_b128 a[244:247], v2 offset:13312
v_mfma_f32_16x16x32_bf16 a[88:91], a[248:251], v[216:219], a[88:91]
v_exp_f32 v173, v173
v_mfma_f32_16x16x32_bf16 a[92:95], a[252:255], v[216:219], a[92:95]
v_exp_f32 v174, v174
ds_read_b128 a[248:251], v2 offset:14336
ds_read_b128 a[252:255], v2 offset:15360
v_add_u32 v2, s82, v1
buffer_store_dwordx4 v[180:183], v3, s[44:47], s70 offen offset:3072 sc1
v_cvt_pk_bf16_f32 v220, v172, v173
v_exp_f32 v175, v175
v_exp_f32 v188, v188
v_cvt_pk_bf16_f32 v221, v174, v175
v_exp_f32 v189, v189
v_exp_f32 v190, v190
v_cvt_pk_bf16_f32 v222, v188, v189
v_exp_f32 v191, v191
s_nop 0
v_cvt_pk_bf16_f32 v223, v190, v191
s_waitcnt vmcnt(8) lgkmcnt(0)
s_barrier
s_branch LHT4
Lslow:
s_waitcnt vmcnt(0) lgkmcnt(0)
s_barrier
s_mov_b32 s86, 1
s_lshl_b32 s81, s59, 20
s_add_u32 s81, s81, s64
s_sub_u32 s81, s81, 0x4000
s_mov_b32 s83, 0
s_lshl_b32 s75, s60, 3
s_sub_u32 s76, 128, s75
s_add_u32 s74, s75, s58
s_sub_u32 s75, s76, 8
s_add_u32 s75, s75, s58
v_mov_b32 v2, v1
v_lshrrev_b32 v240, 4, v0
v_and_b32 v241, 15, v0
v_lshlrev_b32 v240, 2, v240
v_sub_u32 v240, v241, v240
v_mov_b32 v112, 0xff800000
v_mov_b32 v113, 0xff800000
v_mov_b32 v114, 0xff800000
v_mov_b32 v115, 0xff800000
v_cmp_gt_i32 vcc, 0, v240
v_and_b32 v120, 3, v0
s_nop 0
v_cndmask_b32 v116, 0, v112, vcc
v_cmp_gt_i32 vcc, 1, v240
v_subrev_u32 v120, 1, v120
s_nop 0
v_cndmask_b32 v117, 0, v112, vcc
v_cmp_gt_i32 vcc, 2, v240
v_ashrrev_i32 v120, 31, v120
s_nop 0
v_cndmask_b32 v118, 0, v112, vcc
v_cmp_gt_i32 vcc, 3, v240
v_and_b32 v120, 0x3f803f80, v120
s_nop 0
v_cndmask_b32 v119, 0, v112, vcc
Lslow1:
s_add_u32 m0, s64, 16384
s_add_u32 s72, s81, 16384
buffer_load_dwordx4 v1, s[44:47], s72 offen sc1 lds
buffer_load_dwordx4 v1, s[44:47], s72 offen offset:1024 sc1 lds
buffer_load_dwordx4 v1, s[44:47], s72 offen offset:2048 sc1 lds
buffer_load_dwordx4 v1, s[44:47], s72 offen offset:3072 sc1 lds
s_add_u32 s81, s81, 0x8000
s_waitcnt vmcnt(0)
s_barrier
ds_read_b128 a[128:131], v2 offset:16384
ds_read_b128 a[132:135], v2 offset:17408
ds_read_b128 a[136:139], v2 offset:18432
ds_read_b128 a[140:143], v2 offset:19456
ds_read_b128 a[144:147], v2 offset:20480
ds_read_b128 a[148:151], v2 offset:21504
ds_read_b128 a[152:155], v2 offset:22528
ds_read_b128 a[156:159], v2 offset:23552
s_waitcnt lgkmcnt(0)
s_add_u32 s73, s74, 0
s_cmp_lt_u32 s73, s83
s_cbranch_scc1 Lsa55
s_cmp_eq_u32 s73, s83
s_cbranch_scc1 Lst56
v_mfma_f32_16x16x32_bf16 v[128:131], a[128:131], v[16:19], 0
s_branch Lsj57
Lst56:
v_mfma_f32_16x16x32_bf16 v[128:131], a[128:131], v[16:19], v[116:119]
Lsj57:
v_mfma_f32_16x16x32_bf16 v[128:131], a[132:135], v[20:23], v[128:131]
v_mfma_f32_16x16x32_bf16 v[128:131], a[136:139], v[24:27], v[128:131]
v_mfma_f32_16x16x32_bf16 v[128:131], a[140:143], v[28:31], v[128:131]
s_nop 7
v_max3_f32 v124, v124, v128, v129
v_max3_f32 v124, v124, v130, v131
Lsa55:
s_add_u32 s73, s74, 4
s_cmp_lt_u32 s73, s83
s_cbranch_scc1 Lsa58
s_cmp_eq_u32 s73, s83
s_cbranch_scc1 Lst59
v_mfma_f32_16x16x32_bf16 v[132:135], a[128:131], v[32:35], 0
s_branch Lsj60
Lst59:
v_mfma_f32_16x16x32_bf16 v[132:135], a[128:131], v[32:35], v[116:119]
Lsj60:
v_mfma_f32_16x16x32_bf16 v[132:135], a[132:135], v[36:39], v[132:135]
v_mfma_f32_16x16x32_bf16 v[132:135], a[136:139], v[40:43], v[132:135]
v_mfma_f32_16x16x32_bf16 v[132:135], a[140:143], v[44:47], v[132:135]
s_nop 7
v_max3_f32 v125, v125, v132, v133
v_max3_f32 v125, v125, v134, v135
Lsa58:
s_add_u32 s73, s75, 0
s_cmp_lt_u32 s73, s83
s_cbranch_scc1 Lsa61
s_cmp_eq_u32 s73, s83
s_cbranch_scc1 Lst62
v_mfma_f32_16x16x32_bf16 v[136:139], a[128:131], v[48:51], 0
s_branch Lsj63
Lst62:
v_mfma_f32_16x16x32_bf16 v[136:139], a[128:131], v[48:51], v[116:119]
Lsj63:
v_mfma_f32_16x16x32_bf16 v[136:139], a[132:135], v[52:55], v[136:139]
v_mfma_f32_16x16x32_bf16 v[136:139], a[136:139], v[56:59], v[136:139]
v_mfma_f32_16x16x32_bf16 v[136:139], a[140:143], v[60:63], v[136:139]
s_nop 7
v_max3_f32 v126, v126, v136, v137
v_max3_f32 v126, v126, v138, v139
Lsa61:
s_add_u32 s73, s75, 4
s_cmp_lt_u32 s73, s83
s_cbranch_scc1 Lsa64
s_cmp_eq_u32 s73, s83
s_cbranch_scc1 Lst65
v_mfma_f32_16x16x32_bf16 v[140:143], a[128:131], v[64:67], 0
s_branch Lsj66
Lst65:
v_mfma_f32_16x16x32_bf16 v[140:143], a[128:131], v[64:67], v[116:119]
Lsj66:
v_mfma_f32_16x16x32_bf16 v[140:143], a[132:135], v[68:71], v[140:143]
v_mfma_f32_16x16x32_bf16 v[140:143], a[136:139], v[72:75], v[140:143]
v_mfma_f32_16x16x32_bf16 v[140:143], a[140:143], v[76:79], v[140:143]
s_nop 7
v_max3_f32 v127, v127, v140, v141
v_max3_f32 v127, v127, v142, v143
Lsa64:
s_add_u32 s83, s83, 1
s_add_u32 s73, s74, 0
s_cmp_lt_u32 s73, s83
s_cbranch_scc1 Lsa67
s_cmp_eq_u32 s73, s83
s_cbranch_scc1 Lst68
v_mfma_f32_16x16x32_bf16 v[144:147], a[144:147], v[16:19], 0
s_branch Lsj69
Lst68:
v_mfma_f32_16x16x32_bf16 v[144:147], a[144:147], v[16:19], v[116:119]
Lsj69:
v_mfma_f32_16x16x32_bf16 v[144:147], a[148:151], v[20:23], v[144:147]
v_mfma_f32_16x16x32_bf16 v[144:147], a[152:155], v[24:27], v[144:147]
v_mfma_f32_16x16x32_bf16 v[144:147], a[156:159], v[28:31], v[144:147]
s_nop 7
v_max3_f32 v124, v124, v144, v145
v_max3_f32 v124, v124, v146, v147
Lsa67:
s_add_u32 s73, s74, 4
s_cmp_lt_u32 s73, s83
s_cbranch_scc1 Lsa70
s_cmp_eq_u32 s73, s83
s_cbranch_scc1 Lst71
v_mfma_f32_16x16x32_bf16 v[148:151], a[144:147], v[32:35], 0
s_branch Lsj72
Lst71:
v_mfma_f32_16x16x32_bf16 v[148:151], a[144:147], v[32:35], v[116:119]
Lsj72:
v_mfma_f32_16x16x32_bf16 v[148:151], a[148:151], v[36:39], v[148:151]
v_mfma_f32_16x16x32_bf16 v[148:151], a[152:155], v[40:43], v[148:151]
v_mfma_f32_16x16x32_bf16 v[148:151], a[156:159], v[44:47], v[148:151]
s_nop 7
v_max3_f32 v125, v125, v148, v149
v_max3_f32 v125, v125, v150, v151
Lsa70:
s_add_u32 s73, s75, 0
s_cmp_lt_u32 s73, s83
s_cbranch_scc1 Lsa73
s_cmp_eq_u32 s73, s83
s_cbranch_scc1 Lst74
v_mfma_f32_16x16x32_bf16 v[152:155], a[144:147], v[48:51], 0
s_branch Lsj75
Lst74:
v_mfma_f32_16x16x32_bf16 v[152:155], a[144:147], v[48:51], v[116:119]
Lsj75:
v_mfma_f32_16x16x32_bf16 v[152:155], a[148:151], v[52:55], v[152:155]
v_mfma_f32_16x16x32_bf16 v[152:155], a[152:155], v[56:59], v[152:155]
v_mfma_f32_16x16x32_bf16 v[152:155], a[156:159], v[60:63], v[152:155]
s_nop 7
v_max3_f32 v126, v126, v152, v153
v_max3_f32 v126, v126, v154, v155
Lsa73:
s_add_u32 s73, s75, 4
s_cmp_lt_u32 s73, s83
s_cbranch_scc1 Lsa76
s_cmp_eq_u32 s73, s83
s_cbranch_scc1 Lst77
v_mfma_f32_16x16x32_bf16 v[156:159], a[144:147], v[64:67], 0
s_branch Lsj78
Lst77:
v_mfma_f32_16x16x32_bf16 v[156:159], a[144:147], v[64:67], v[116:119]
Lsj78:
v_mfma_f32_16x16x32_bf16 v[156:159], a[148:151], v[68:71], v[156:159]
v_mfma_f32_16x16x32_bf16 v[156:159], a[152:155], v[72:75], v[156:159]
v_mfma_f32_16x16x32_bf16 v[156:159], a[156:159], v[76:79], v[156:159]
s_nop 7
v_max3_f32 v127, v127, v156, v157
v_max3_f32 v127, v127, v158, v159
Lsa76:
s_add_u32 s83, s83, 1
ds_read_b128 a[128:131], v2 offset:24576
ds_read_b128 a[132:135], v2 offset:25600
ds_read_b128 a[136:139], v2 offset:26624
ds_read_b128 a[140:143], v2 offset:27648
ds_read_b128 a[144:147], v2 offset:28672
ds_read_b128 a[148:151], v2 offset:29696
ds_read_b128 a[152:155], v2 offset:30720
ds_read_b128 a[156:159], v2 offset:31744
s_waitcnt lgkmcnt(0)
s_add_u32 s73, s74, 0
s_cmp_lt_u32 s73, s83
s_cbranch_scc1 Lsa79
s_cmp_eq_u32 s73, s83
s_cbranch_scc1 Lst80
v_mfma_f32_16x16x32_bf16 v[128:131], a[128:131], v[16:19], 0
s_branch Lsj81
Lst80:
v_mfma_f32_16x16x32_bf16 v[128:131], a[128:131], v[16:19], v[116:119]
Lsj81:
v_mfma_f32_16x16x32_bf16 v[128:131], a[132:135], v[20:23], v[128:131]
v_mfma_f32_16x16x32_bf16 v[128:131], a[136:139], v[24:27], v[128:131]
v_mfma_f32_16x16x32_bf16 v[128:131], a[140:143], v[28:31], v[128:131]
s_nop 7
v_max3_f32 v124, v124, v128, v129
v_max3_f32 v124, v124, v130, v131
Lsa79:
s_add_u32 s73, s74, 4
s_cmp_lt_u32 s73, s83
s_cbranch_scc1 Lsa82
s_cmp_eq_u32 s73, s83
s_cbranch_scc1 Lst83
v_mfma_f32_16x16x32_bf16 v[132:135], a[128:131], v[32:35], 0
s_branch Lsj84
Lst83:
v_mfma_f32_16x16x32_bf16 v[132:135], a[128:131], v[32:35], v[116:119]
Lsj84:
v_mfma_f32_16x16x32_bf16 v[132:135], a[132:135], v[36:39], v[132:135]
v_mfma_f32_16x16x32_bf16 v[132:135], a[136:139], v[40:43], v[132:135]
v_mfma_f32_16x16x32_bf16 v[132:135], a[140:143], v[44:47], v[132:135]
s_nop 7
v_max3_f32 v125, v125, v132, v133
v_max3_f32 v125, v125, v134, v135
Lsa82:
s_add_u32 s73, s75, 0
s_cmp_lt_u32 s73, s83
s_cbranch_scc1 Lsa85
s_cmp_eq_u32 s73, s83
s_cbranch_scc1 Lst86
v_mfma_f32_16x16x32_bf16 v[136:139], a[128:131], v[48:51], 0
s_branch Lsj87
Lst86:
v_mfma_f32_16x16x32_bf16 v[136:139], a[128:131], v[48:51], v[116:119]
Lsj87:
v_mfma_f32_16x16x32_bf16 v[136:139], a[132:135], v[52:55], v[136:139]
v_mfma_f32_16x16x32_bf16 v[136:139], a[136:139], v[56:59], v[136:139]
v_mfma_f32_16x16x32_bf16 v[136:139], a[140:143], v[60:63], v[136:139]
s_nop 7
v_max3_f32 v126, v126, v136, v137
v_max3_f32 v126, v126, v138, v139
Lsa85:
s_add_u32 s73, s75, 4
s_cmp_lt_u32 s73, s83
s_cbranch_scc1 Lsa88
s_cmp_eq_u32 s73, s83
s_cbranch_scc1 Lst89
v_mfma_f32_16x16x32_bf16 v[140:143], a[128:131], v[64:67], 0
s_branch Lsj90
Lst89:
v_mfma_f32_16x16x32_bf16 v[140:143], a[128:131], v[64:67], v[116:119]
Lsj90:
v_mfma_f32_16x16x32_bf16 v[140:143], a[132:135], v[68:71], v[140:143]
v_mfma_f32_16x16x32_bf16 v[140:143], a[136:139], v[72:75], v[140:143]
v_mfma_f32_16x16x32_bf16 v[140:143], a[140:143], v[76:79], v[140:143]
s_nop 7
v_max3_f32 v127, v127, v140, v141
v_max3_f32 v127, v127, v142, v143
Lsa88:
s_add_u32 s83, s83, 1
s_add_u32 s73, s74, 0
s_cmp_lt_u32 s73, s83
s_cbranch_scc1 Lsa91
s_cmp_eq_u32 s73, s83
s_cbranch_scc1 Lst92
v_mfma_f32_16x16x32_bf16 v[144:147], a[144:147], v[16:19], 0
s_branch Lsj93
Lst92:
v_mfma_f32_16x16x32_bf16 v[144:147], a[144:147], v[16:19], v[116:119]
Lsj93:
v_mfma_f32_16x16x32_bf16 v[144:147], a[148:151], v[20:23], v[144:147]
v_mfma_f32_16x16x32_bf16 v[144:147], a[152:155], v[24:27], v[144:147]
v_mfma_f32_16x16x32_bf16 v[144:147], a[156:159], v[28:31], v[144:147]
s_nop 7
v_max3_f32 v124, v124, v144, v145
v_max3_f32 v124, v124, v146, v147
Lsa91:
s_add_u32 s73, s74, 4
s_cmp_lt_u32 s73, s83
s_cbranch_scc1 Lsa94
s_cmp_eq_u32 s73, s83
s_cbranch_scc1 Lst95
v_mfma_f32_16x16x32_bf16 v[148:151], a[144:147], v[32:35], 0
s_branch Lsj96
Lst95:
v_mfma_f32_16x16x32_bf16 v[148:151], a[144:147], v[32:35], v[116:119]
Lsj96:
v_mfma_f32_16x16x32_bf16 v[148:151], a[148:151], v[36:39], v[148:151]
v_mfma_f32_16x16x32_bf16 v[148:151], a[152:155], v[40:43], v[148:151]
v_mfma_f32_16x16x32_bf16 v[148:151], a[156:159], v[44:47], v[148:151]
s_nop 7
v_max3_f32 v125, v125, v148, v149
v_max3_f32 v125, v125, v150, v151
Lsa94:
s_add_u32 s73, s75, 0
s_cmp_lt_u32 s73, s83
s_cbranch_scc1 Lsa97
s_cmp_eq_u32 s73, s83
s_cbranch_scc1 Lst98
v_mfma_f32_16x16x32_bf16 v[152:155], a[144:147], v[48:51], 0
s_branch Lsj99
Lst98:
v_mfma_f32_16x16x32_bf16 v[152:155], a[144:147], v[48:51], v[116:119]
Lsj99:
v_mfma_f32_16x16x32_bf16 v[152:155], a[148:151], v[52:55], v[152:155]
v_mfma_f32_16x16x32_bf16 v[152:155], a[152:155], v[56:59], v[152:155]
v_mfma_f32_16x16x32_bf16 v[152:155], a[156:159], v[60:63], v[152:155]
s_nop 7
v_max3_f32 v126, v126, v152, v153
v_max3_f32 v126, v126, v154, v155
Lsa97:
s_add_u32 s73, s75, 4
s_cmp_lt_u32 s73, s83
s_cbranch_scc1 Lsa100
s_cmp_eq_u32 s73, s83
s_cbranch_scc1 Lst101
v_mfma_f32_16x16x32_bf16 v[156:159], a[144:147], v[64:67], 0
s_branch Lsj102
Lst101:
v_mfma_f32_16x16x32_bf16 v[156:159], a[144:147], v[64:67], v[116:119]
Lsj102:
v_mfma_f32_16x16x32_bf16 v[156:159], a[148:151], v[68:71], v[156:159]
v_mfma_f32_16x16x32_bf16 v[156:159], a[152:155], v[72:75], v[156:159]
v_mfma_f32_16x16x32_bf16 v[156:159], a[156:159], v[76:79], v[156:159]
s_nop 7
v_max3_f32 v127, v127, v156, v157
v_max3_f32 v127, v127, v158, v159
Lsa100:
s_add_u32 s83, s83, 1
s_barrier
s_cmp_lt_u32 s83, s76
s_cbranch_scc1 Lslow1
s_lshl_b32 s81, s59, 20
s_add_u32 s81, s81, s64
s_sub_u32 s81, s81, 0x4000
s_add_u32 m0, s64, 49152
s_add_u32 s72, s81, 16384
buffer_load_dwordx4 v1, s[44:47], s72 offen sc1 lds
buffer_load_dwordx4 v1, s[44:47], s72 offen offset:1024 sc1 lds
buffer_load_dwordx4 v1, s[44:47], s72 offen offset:2048 sc1 lds
buffer_load_dwordx4 v1, s[44:47], s72 offen offset:3072 sc1 lds
s_add_u32 s81, s81, 0x8000
s_add_u32 m0, s64, 81920
s_add_u32 s72, s81, 16384
buffer_load_dwordx4 v1, s[44:47], s72 offen sc1 lds
buffer_load_dwordx4 v1, s[44:47], s72 offen offset:1024 sc1 lds
buffer_load_dwordx4 v1, s[44:47], s72 offen offset:2048 sc1 lds
buffer_load_dwordx4 v1, s[44:47], s72 offen offset:3072 sc1 lds
s_add_u32 m0, s64, 65536
s_add_u32 s72, s81, 0
buffer_load_dwordx4 v1, s[44:47], s72 offen sc1 lds
buffer_load_dwordx4 v1, s[44:47], s72 offen offset:1024 sc1 lds
buffer_load_dwordx4 v1, s[44:47], s72 offen offset:2048 sc1 lds
buffer_load_dwordx4 v1, s[44:47], s72 offen offset:3072 sc1 lds
s_add_u32 s81, s81, 0x8000
s_add_u32 m0, s64, 114688
s_add_u32 s72, s81, 16384
buffer_load_dwordx4 v1, s[44:47], s72 offen sc1 lds
buffer_load_dwordx4 v1, s[44:47], s72 offen offset:1024 sc1 lds
buffer_load_dwordx4 v1, s[44:47], s72 offen offset:2048 sc1 lds
buffer_load_dwordx4 v1, s[44:47], s72 offen offset:3072 sc1 lds
s_add_u32 m0, s64, 98304
s_add_u32 s72, s81, 0
buffer_load_dwordx4 v1, s[44:47], s72 offen sc1 lds
buffer_load_dwordx4 v1, s[44:47], s72 offen offset:1024 sc1 lds
buffer_load_dwordx4 v1, s[44:47], s72 offen offset:2048 sc1 lds
buffer_load_dwordx4 v1, s[44:47], s72 offen offset:3072 sc1 lds
v_add_u32 v2, 0x8000, v1
v_lshrrev_b32 v3, 1, v0
v_lshlrev_b32 v3, 7, v3
s_waitcnt vmcnt(0)
s_barrier
v_accvgpr_write_b32 a32, 0
v_accvgpr_write_b32 a33, 0
v_accvgpr_write_b32 a34, 0
v_accvgpr_write_b32 a35, 0
v_accvgpr_write_b32 a36, 0
v_accvgpr_write_b32 a37, 0
v_accvgpr_write_b32 a38, 0
v_accvgpr_write_b32 a39, 0
v_accvgpr_write_b32 a40, 0
v_accvgpr_write_b32 a41, 0
v_accvgpr_write_b32 a42, 0
v_accvgpr_write_b32 a43, 0
v_accvgpr_write_b32 a44, 0
v_accvgpr_write_b32 a45, 0
v_accvgpr_write_b32 a46, 0
v_accvgpr_write_b32 a47, 0
v_accvgpr_write_b32 a48, 0
v_accvgpr_write_b32 a49, 0
v_accvgpr_write_b32 a50, 0
v_accvgpr_write_b32 a51, 0
v_accvgpr_write_b32 a52, 0
v_accvgpr_write_b32 a53, 0
v_accvgpr_write_b32 a54, 0
v_accvgpr_write_b32 a55, 0
v_accvgpr_write_b32 a56, 0
v_accvgpr_write_b32 a57, 0
v_accvgpr_write_b32 a58, 0
v_accvgpr_write_b32 a59, 0
v_accvgpr_write_b32 a60, 0
v_accvgpr_write_b32 a61, 0
v_accvgpr_write_b32 a62, 0
v_accvgpr_write_b32 a63, 0
v_accvgpr_write_b32 a96, 0
v_accvgpr_write_b32 a97, 0
v_accvgpr_write_b32 a98, 0
v_accvgpr_write_b32 a99, 0
v_accvgpr_write_b32 a100, 0
v_accvgpr_write_b32 a101, 0
v_accvgpr_write_b32 a102, 0
v_accvgpr_write_b32 a103, 0
v_accvgpr_write_b32 a104, 0
v_accvgpr_write_b32 a105, 0
v_accvgpr_write_b32 a106, 0
v_accvgpr_write_b32 a107, 0
v_accvgpr_write_b32 a108, 0
v_accvgpr_write_b32 a109, 0
v_accvgpr_write_b32 a110, 0
v_accvgpr_write_b32 a111, 0
v_accvgpr_write_b32 a112, 0
v_accvgpr_write_b32 a113, 0
v_accvgpr_write_b32 a114, 0
v_accvgpr_write_b32 a115, 0
v_accvgpr_write_b32 a116, 0
v_accvgpr_write_b32 a117, 0
v_accvgpr_write_b32 a118, 0
v_accvgpr_write_b32 a119, 0
v_accvgpr_write_b32 a120, 0
v_accvgpr_write_b32 a121, 0
v_accvgpr_write_b32 a122, 0
v_accvgpr_write_b32 a123, 0
v_accvgpr_write_b32 a124, 0
v_accvgpr_write_b32 a125, 0
v_accvgpr_write_b32 a126, 0
v_accvgpr_write_b32 a127, 0
ds_read_b128 a[128:131], v2 offset:16384
ds_read_b128 a[132:135], v2 offset:17408
ds_read_b128 a[136:139], v2 offset:18432
ds_read_b128 a[140:143], v2 offset:19456
ds_read_b128 a[144:147], v2 offset:20480
ds_read_b128 a[148:151], v2 offset:21504
ds_read_b128 a[152:155], v2 offset:22528
ds_read_b128 a[156:159], v2 offset:23552
s_branch Lattn
Lspin103:
s_mov_b32 s83, 262144
Lsl105:
s_sleep 2
buffer_load_dword v3, v2, s[44:47], s82 offen sc1
s_sub_u32 s83, s83, 1
s_cmp_eq_u32 s83, 0
s_waitcnt vmcnt(0)
s_cbranch_scc1 Lback104
v_cmp_gt_u32 vcc, 2, v3
s_cbranch_vccnz Lsl105
s_branch Lback104
Lspin106:
s_mov_b32 s83, 262144
Lsl108:
s_sleep 2
buffer_load_dword v3, v2, s[44:47], s82 offen sc1
s_sub_u32 s83, s83, 1
s_cmp_eq_u32 s83, 0
s_waitcnt vmcnt(0)
s_cbranch_scc1 Lback107
v_cmp_gt_u32 vcc, 2, v3
s_cbranch_vccnz Lsl108
s_branch Lback107
Lredo0:
s_xor_b32 s82, s78, 0
s_lshl_b32 s82, s82, 10
s_add_u32 s82, s82, s74
buffer_load_dword v3, v2, s[44:47], s82 offen sc1
s_waitcnt vmcnt(0)
v_cmp_gt_u32 vcc, 2, v3
s_cbranch_vccnz Lspin103
Lback104:
s_lshr_b32 s69, s12, 18
s_lshl_b32 s69, s69, 12
s_add_u32 s69, s69, s95
buffer_load_dwordx4 a[0:3], v1, s[44:47], s69 offen sc1
buffer_load_dwordx4 a[4:7], v1, s[44:47], s69 offen offset:1024 sc1
buffer_load_dwordx4 a[8:11], v1, s[44:47], s69 offen offset:2048 sc1
buffer_load_dwordx4 a[12:15], v1, s[44:47], s69 offen offset:3072 sc1
s_add_u32 s69, s69, 0x20000
buffer_load_dwordx4 a[16:19], v1, s[44:47], s69 offen sc1
buffer_load_dwordx4 a[20:23], v1, s[44:47], s69 offen offset:1024 sc1
buffer_load_dwordx4 a[24:27], v1, s[44:47], s69 offen offset:2048 sc1
buffer_load_dwordx4 a[28:31], v1, s[44:47], s69 offen offset:3072 sc1
s_lshr_b32 s69, s13, 18
s_lshl_b32 s69, s69, 12
s_add_u32 s69, s69, s95
buffer_load_dwordx4 a[32:35], v1, s[44:47], s69 offen sc1
buffer_load_dwordx4 a[36:39], v1, s[44:47], s69 offen offset:1024 sc1
buffer_load_dwordx4 a[40:43], v1, s[44:47], s69 offen offset:2048 sc1
buffer_load_dwordx4 a[44:47], v1, s[44:47], s69 offen offset:3072 sc1
s_add_u32 s69, s69, 0x20000
buffer_load_dwordx4 a[48:51], v1, s[44:47], s69 offen sc1
buffer_load_dwordx4 a[52:55], v1, s[44:47], s69 offen offset:1024 sc1
buffer_load_dwordx4 a[56:59], v1, s[44:47], s69 offen offset:2048 sc1
buffer_load_dwordx4 a[60:63], v1, s[44:47], s69 offen offset:3072 sc1
s_waitcnt vmcnt(8)
s_branch Lredo0b
Lspin109:
s_mov_b32 s83, 262144
Lsl111:
s_sleep 2
buffer_load_dword v114, v115, s[44:47], s84 offen sc1
s_sub_u32 s83, s83, 1
s_cmp_eq_u32 s83, 0
s_waitcnt vmcnt(0)
s_cbranch_scc1 Lback110
v_cmp_gt_u32 vcc, 3, v114
s_cbranch_vccnz Lsl111
s_branch Lback110
Lspin112:
s_mov_b32 s83, 262144
Lsl114:
s_sleep 2
buffer_load_dword v14, v13, s[44:47], s79 offen sc1
s_sub_u32 s83, s83, 1
s_cmp_eq_u32 s83, 0
s_waitcnt vmcnt(0)
s_cbranch_scc1 Lback113
v_cmp_gt_u32 vcc, 2, v14
s_cbranch_vccnz Lsl114
s_branch Lback113
Lxspin1:
s_mov_b32 s83, 262144
Lxsl1:
buffer_load_dwordx4 v[96:99], v1, s[44:47], s79 offen sc1
buffer_load_dwordx4 v[100:103], v1, s[44:47], s79 offen offset:1024 sc1
buffer_load_dwordx4 v[104:107], v1, s[44:47], s79 offen offset:2048 sc1
buffer_load_dwordx4 v[108:111], v1, s[44:47], s79 offen offset:3072 sc1
s_sub_u32 s83, s83, 1
s_cmp_eq_u32 s83, 0
s_waitcnt vmcnt(0)
s_cbranch_scc1 Lxback1
v_max3_u32 v12, v96, v97, v98
v_max3_u32 v13, v99, v100, v101
v_max3_u32 v12, v12, v102, v103
v_max3_u32 v13, v13, v104, v105
v_max3_u32 v12, v12, v106, v107
v_max3_u32 v13, v13, v108, v109
v_max3_u32 v12, v12, v110, v111
v_max_u32 v12, v12, v13
v_cmp_le_u32 vcc, 0xff800000, v12
s_cbranch_vccnz Lxsl1
s_branch Lxback1
Lxspin2:
s_mov_b32 s83, 262144
Lxsl2:
buffer_load_dwordx4 v[80:83], v1, s[44:47], s82 offen sc1
buffer_load_dwordx4 v[84:87], v1, s[44:47], s82 offen offset:1024 sc1
buffer_load_dwordx4 v[88:91], v1, s[44:47], s82 offen offset:2048 sc1
buffer_load_dwordx4 v[92:95], v1, s[44:47], s82 offen offset:3072 sc1
s_sub_u32 s83, s83, 1
s_cmp_eq_u32 s83, 0
s_waitcnt vmcnt(0)
s_cbranch_scc1 Lxback2
v_max3_u32 v12, v80, v81, v82
v_max3_u32 v13, v83, v84, v85
v_max3_u32 v12, v12, v86, v87
v_max3_u32 v13, v13, v88, v89
v_max3_u32 v12, v12, v90, v91
v_max3_u32 v13, v13, v92, v93
v_max3_u32 v12, v12, v94, v95
v_max_u32 v12, v12, v13
v_cmp_le_u32 vcc, 0xff800000, v12
s_cbranch_vccnz Lxsl2
s_branch Lxback2
Lxspin3:
s_mov_b32 s83, 262144
Lxsl3:
buffer_load_dwordx4 v[96:99], v1, s[44:47], s81 offen sc1
buffer_load_dwordx4 v[100:103], v1, s[44:47], s81 offen offset:1024 sc1
buffer_load_dwordx4 v[104:107], v1, s[44:47], s81 offen offset:2048 sc1
buffer_load_dwordx4 v[108:111], v1, s[44:47], s81 offen offset:3072 sc1
s_sub_u32 s83, s83, 1
s_cmp_eq_u32 s83, 0
s_waitcnt vmcnt(0)
s_cbranch_scc1 Lxback3
v_max3_u32 v12, v96, v97, v98
v_max3_u32 v13, v99, v100, v101
v_max3_u32 v12, v12, v102, v103
v_max3_u32 v13, v13, v104, v105
v_max3_u32 v12, v12, v106, v107
v_max3_u32 v13, v13, v108, v109
v_max3_u32 v12, v12, v110, v111
v_max_u32 v12, v12, v13
v_cmp_le_u32 vcc, 0xff800000, v12
s_cbranch_vccnz Lxsl3
s_branch Lxback3
Lcode_end:
s_endpgm
.section .rodata,"a"
.p2align 6
.amdhsa_kernel gated_mix__compressed_kv_cla__ssm_conv_h3__prompt_kernel
  .amdhsa_next_free_vgpr 512
  .amdhsa_next_free_sgpr 102
  .amdhsa_accum_offset 256
  .amdhsa_group_segment_fixed_size 0
  .amdhsa_kernarg_size 128
  .amdhsa_user_sgpr_count 2
  .amdhsa_user_sgpr_kernarg_segment_ptr 1
  .amdhsa_system_sgpr_workgroup_id_x 1
  .amdhsa_float_denorm_mode_32 3
.end_amdhsa_kernel
```

```asm
; @launch grid=(256,1,1) block=(256,1,1) lds=163840
.amdgcn_target "amdgcn-amd-amdhsa--gfx950"
.text
.globl gated_mix__compressed_kv_cla__ssm_conv_h3__prompt_kernel
.p2align 8
.type gated_mix__compressed_kv_cla__ssm_conv_h3__prompt_kernel,@function
gated_mix__compressed_kv_cla__ssm_conv_h3__prompt_kernel:
s_cmp_ge_u32 s2, 256
s_cbranch_scc1 Lend
s_load_dwordx2 s[8:9], s[0:1], 8
s_load_dwordx2 s[16:17], s[0:1], 24
s_load_dwordx2 s[20:21], s[0:1], 32
s_lshr_b32 s75, s2, 3
v_mul_u32_u24 v31, 18, v0
s_getpc_b64 s[98:99]
Lpc0:
s_mul_i32 s74, s75, 4608
v_and_b32 v31, 0x1f80, v31
v_add_u32 v31, s74, v31
v_min_u32 v31, Lcode_end-Lpc0, v31
global_load_dword v31, v31, s[98:99]
v_lshrrev_b32 v26, 6, v0
v_and_b32 v0, 63, v0
s_lshr_b32 s65, s75, 3
v_readfirstlane_b32 s58, v26
s_and_b32 s60, s75, 7
s_and_b32 s61, s65, 1
s_lshl_b32 s63, s58, 13
s_lshl_b32 s67, s60, 18
s_lshl_b32 s76, s58, 16
s_add_u32 s84, s67, s76
v_lshrrev_b32 v26, 4, v0
v_and_b32 v27, 7, v0
v_xor_b32 v27, v27, v26
v_lshlrev_b32 v27, 4, v27
v_lshrrev_b32 v28, 3, v0
v_lshl_add_u32 v2, v28, 10, v27
v_xor_b32 v3, 64, v2
s_mov_b32 s66, 0
s_mov_b32 s10, 0x200000
s_mov_b32 s11, 0x20000
s_mov_b32 s18, 0x400000
s_mov_b32 s19, 0x20000
s_mov_b32 s22, 0x400000
s_mov_b32 s23, 0x20000
s_and_b32 s73, s2, 7
s_lshl_b32 s73, s73, 2
s_add_u32 s59, s73, s65
s_lshl_b32 s64, s58, 12
s_lshl_b32 s66, s58, 17
s_lshr_b32 s73, 0x67234501, s73
s_and_b32 s73, s73, 7
s_lshl_b32 s74, s65, 3
s_add_u32 s73, s73, s74
s_lshl_b32 s73, s73, 8
s_add_u32 s66, s66, s73
v_and_b32 v29, 15, v0
v_lshlrev_b32 v30, 1, v26
v_xor_b32 v30, v30, v29
v_lshlrev_b32 v30, 4, v30
v_lshl_add_u32 v6, v26, 13, v30
v_xor_b32 v7, 0x80, v6
s_xor_b32 s73, s61, 0
s_lshl_b32 s69, s73, 7
s_add_u32 s69, s69, s84
s_lshl_b32 s71, s73, 19
s_add_u32 s71, s71, s66
s_add_u32 m0, s63, 65536
s_add_u32 s72, s69, 0
s_waitcnt lgkmcnt(0)
buffer_load_dwordx4 v2, s[8:11], s72 offen lds
s_add_u32 s72, s69, 7168
buffer_load_dwordx4 v3, s[8:11], s72 offen offset:1024 lds
s_add_u32 s72, s69, 14336
buffer_load_dwordx4 v2, s[8:11], s72 offen offset:2048 lds
s_add_u32 s72, s69, 21504
buffer_load_dwordx4 v3, s[8:11], s72 offen offset:3072 lds
s_add_u32 m0, s64, 0
s_add_u32 s72, s71, 0
buffer_load_dwordx4 v6, s[16:19], s72 offen lds
s_add_u32 s72, s71, 31744
buffer_load_dwordx4 v6, s[16:19], s72 offen offset:1024 lds
s_add_u32 s72, s71, 63488
buffer_load_dwordx4 v7, s[16:19], s72 offen offset:2048 lds
s_add_u32 s72, s71, 95232
buffer_load_dwordx4 v7, s[16:19], s72 offen offset:3072 lds
s_add_u32 m0, s63, 69632
s_add_u32 s72, s69, 32768
buffer_load_dwordx4 v2, s[8:11], s72 offen lds
s_add_u32 s72, s69, 39936
buffer_load_dwordx4 v3, s[8:11], s72 offen offset:1024 lds
s_add_u32 s72, s69, 47104
buffer_load_dwordx4 v2, s[8:11], s72 offen offset:2048 lds
s_add_u32 s72, s69, 54272
buffer_load_dwordx4 v3, s[8:11], s72 offen offset:3072 lds
s_add_u32 m0, s64, 16384
s_add_u32 s72, s71, 0
buffer_load_dwordx4 v6, s[20:23], s72 offen lds
s_add_u32 s72, s71, 31744
buffer_load_dwordx4 v6, s[20:23], s72 offen offset:1024 lds
s_add_u32 s72, s71, 63488
buffer_load_dwordx4 v7, s[20:23], s72 offen offset:2048 lds
s_add_u32 s72, s71, 95232
buffer_load_dwordx4 v7, s[20:23], s72 offen offset:3072 lds
s_load_dwordx2 s[4:5], s[0:1], 0
s_load_dwordx2 s[12:13], s[0:1], 16
s_load_dwordx2 s[24:25], s[0:1], 40
s_load_dwordx2 s[28:29], s[0:1], 56
s_load_dwordx2 s[32:33], s[0:1], 64
s_load_dwordx2 s[52:53], s[0:1], 72
s_load_dwordx2 s[36:37], s[0:1], 80
s_load_dwordx2 s[54:55], s[0:1], 88
s_load_dwordx2 s[56:57], s[0:1], 96
s_load_dwordx2 s[40:41], s[0:1], 104
s_load_dwordx2 s[48:49], s[0:1], 112
s_load_dwordx2 s[44:45], s[0:1], 120
s_lshl_b32 s73, s2, 2
s_add_u32 s73, s73, s58
s_lshl_b32 s73, s73, 11
v_lshrrev_b32 v124, 2, v0
v_lshlrev_b32 v124, 7, v124
v_add_u32 v124, s73, v124
s_lshr_b32 s73, s2, 3
s_lshl_b32 s73, s73, 2
s_add_u32 s73, s73, s58
s_lshl_b32 s73, s73, 13
s_and_b32 s74, s66, 0x700
s_add_u32 s73, s73, s74
v_lshrrev_b32 v125, 4, v0
v_lshlrev_b32 v125, 11, v125
v_bfe_u32 v126, v0, 3, 1
v_lshl_add_u32 v125, v126, 7, v125
v_add_u32 v125, s73, v125
s_lshr_b32 s80, s61, 1
s_xor_b32 s80, s80, 0
s_lshl_b32 s80, s80, 20
buffer_load_dword v126, v125, s[16:19], s80 offen
buffer_load_dword v126, v125, s[20:23], s80 offen
buffer_load_dword v126, v124, s[8:11], 0 offen
s_xor_b32 s73, s61, 1
s_lshl_b32 s69, s73, 7
s_add_u32 s69, s69, s84
s_lshl_b32 s71, s73, 19
s_add_u32 s71, s71, s66
s_add_u32 m0, s63, 98304
s_add_u32 s72, s69, 0
buffer_load_dwordx4 v2, s[8:11], s72 offen lds
s_add_u32 s72, s69, 7168
buffer_load_dwordx4 v3, s[8:11], s72 offen offset:1024 lds
s_add_u32 s72, s69, 14336
buffer_load_dwordx4 v2, s[8:11], s72 offen offset:2048 lds
s_add_u32 s72, s69, 21504
buffer_load_dwordx4 v3, s[8:11], s72 offen offset:3072 lds
s_lshl_b32 s91, s59, 3
s_add_u32 s91, s91, s60
s_lshl_b32 s93, s91, 2
s_add_u32 s93, s93, s58
s_lshl_b32 s75, s93, 1
s_and_b32 s75, s75, 0xffc
s_lshl_b32 s93, s93, 12
s_waitcnt lgkmcnt(0)
s_load_dwordx2 s[88:89], s[36:37], s93
s_load_dword s90, s[54:55], s75
v_lshrrev_b32 v16, 1, v29
v_xor_b32 v16, v16, v26
v_lshlrev_b32 v16, 4, v16
v_lshl_add_u32 v16, v29, 7, v16
s_lshr_b32 s73, s58, 1
s_lshl_b32 s74, s73, 14
s_add_u32 s74, s74, 0x10000
v_add_u32 v24, s74, v16
v_xor_b32 v25, 64, v24
v_lshrrev_b32 v8, 2, v29
v_and_b32 v9, 1, v26
v_lshl_add_u32 v9, v9, 2, v8
v_lshl_add_u32 v8, v26, 3, v8
v_lshlrev_b32 v8, 8, v8
v_lshl_add_u32 v8, v9, 5, v8
v_and_b32 v29, 3, v0
v_lshl_add_u32 v8, v29, 3, v8
s_and_b32 s74, s58, 1
s_lshl_b32 s75, s74, 7
v_xor_b32 v20, s75, v8
v_xor_b32 v21, 32, v20
v_xor_b32 v22, 64, v20
v_xor_b32 v23, 96, v20
s_nop 3
s_mov_b64 exec, 0
s_cmp_eq_u32 s58, 0
s_cbranch_scc1 Lstuba0
s_cmp_eq_u32 s58, 1
s_cbranch_scc1 Lstuba1
s_cmp_eq_u32 s58, 2
s_cbranch_scc1 Lstuba2
s_branch Lstuba3
Lreta:
s_mov_b64 exec, -1
s_nop 3
s_waitcnt vmcnt(7) lgkmcnt(0)
s_barrier
ds_read_b64_tr_b16 v[224:225], v20 offset:0
ds_read_b64_tr_b16 v[226:227], v20 offset:1024
ds_read_b64_tr_b16 v[228:229], v20 offset:8192
ds_read_b64_tr_b16 v[230:231], v20 offset:9216
ds_read_b128 v[128:131], v24 offset:0
ds_read_b128 v[132:135], v25 offset:0
ds_read_b128 v[136:139], v24 offset:2048
ds_read_b128 v[140:143], v25 offset:2048
ds_read_b128 v[144:147], v24 offset:4096
ds_read_b128 v[148:151], v25 offset:4096
ds_read_b128 v[152:155], v24 offset:6144
ds_read_b128 v[156:159], v25 offset:6144
s_waitcnt lgkmcnt(6)
v_mfma_f32_16x16x32_bf16 a[0:3], v[224:227], v[128:131], 0
s_add_u32 m0, s64, 32768
ds_read_b128 v[160:163], v24 offset:8192
v_mfma_f32_16x16x32_bf16 a[0:3], v[228:231], v[132:135], a[0:3]
s_waitcnt lgkmcnt(5)
ds_read_b128 v[164:167], v25 offset:8192
v_mfma_f32_16x16x32_bf16 a[4:7], v[228:231], v[140:143], 0
s_add_u32 s72, s71, 0
ds_read_b128 v[168:171], v24 offset:10240
v_mfma_f32_16x16x32_bf16 a[4:7], v[224:227], v[136:139], a[4:7]
s_waitcnt lgkmcnt(5)
ds_read_b128 v[172:175], v25 offset:10240
v_mfma_f32_16x16x32_bf16 a[8:11], v[224:227], v[144:147], 0
s_mov_b32 s6, 0x400000
ds_read_b128 v[176:179], v24 offset:12288
v_mfma_f32_16x16x32_bf16 a[8:11], v[228:231], v[148:151], a[8:11]
s_waitcnt lgkmcnt(5)
ds_read_b128 v[180:183], v25 offset:12288
v_mfma_f32_16x16x32_bf16 a[12:15], v[228:231], v[156:159], 0
s_mov_b32 s7, 0x20000
ds_read_b128 v[184:187], v24 offset:14336
v_mfma_f32_16x16x32_bf16 a[12:15], v[224:227], v[152:155], a[12:15]
s_waitcnt lgkmcnt(5)
ds_read_b128 v[188:191], v25 offset:14336
v_mfma_f32_16x16x32_bf16 a[16:19], v[224:227], v[160:163], 0
s_mov_b32 s14, 0x800000
ds_read_b64_tr_b16 v[232:233], v21 offset:0
ds_read_b64_tr_b16 v[234:235], v21 offset:1024
v_mfma_f32_16x16x32_bf16 a[16:19], v[228:231], v[164:167], a[16:19]
s_waitcnt lgkmcnt(6)
ds_read_b64_tr_b16 v[236:237], v21 offset:8192
ds_read_b64_tr_b16 v[238:239], v21 offset:9216
v_mfma_f32_16x16x32_bf16 a[20:23], v[228:231], v[172:175], 0
s_mov_b32 s15, 0x20000
buffer_load_dwordx4 v6, s[16:19], s72 offen lds
v_mfma_f32_16x16x32_bf16 a[20:23], v[224:227], v[168:171], a[20:23]
s_waitcnt lgkmcnt(6)
ds_read_b64_tr_b16 v[240:241], v22 offset:0
ds_read_b64_tr_b16 v[242:243], v22 offset:1024
v_mfma_f32_16x16x32_bf16 a[24:27], v[224:227], v[176:179], 0
s_add_u32 s72, s71, 31744
buffer_load_dwordx4 v6, s[16:19], s72 offen offset:1024 lds
v_mfma_f32_16x16x32_bf16 a[24:27], v[228:231], v[180:183], a[24:27]
s_waitcnt lgkmcnt(6)
ds_read_b64_tr_b16 v[244:245], v22 offset:8192
ds_read_b64_tr_b16 v[246:247], v22 offset:9216
v_mfma_f32_16x16x32_bf16 a[28:31], v[228:231], v[188:191], 0
s_add_u32 s72, s71, 63488
buffer_load_dwordx4 v7, s[16:19], s72 offen offset:2048 lds
v_mfma_f32_16x16x32_bf16 a[28:31], v[224:227], v[184:187], a[28:31]
s_waitcnt lgkmcnt(4)
v_mfma_f32_16x16x32_bf16 a[60:63], v[232:235], v[184:187], 0
s_add_u32 s72, s71, 95232
buffer_load_dwordx4 v7, s[16:19], s72 offen offset:3072 lds
v_mfma_f32_16x16x32_bf16 a[60:63], v[236:239], v[188:191], a[60:63]
s_mov_b32 s26, 0x800000
ds_read_b64_tr_b16 v[248:249], v23 offset:0
v_mfma_f32_16x16x32_bf16 a[56:59], v[236:239], v[180:183], 0
s_mov_b32 s27, 0x20000
v_mfma_f32_16x16x32_bf16 a[56:59], v[232:235], v[176:179], a[56:59]
s_mov_b32 s30, 0x400000
ds_read_b64_tr_b16 v[250:251], v23 offset:1024
v_mfma_f32_16x16x32_bf16 a[52:55], v[232:235], v[168:171], 0
s_add_u32 m0, s63, 102400
v_mfma_f32_16x16x32_bf16 a[52:55], v[236:239], v[172:175], a[52:55]
s_add_u32 s72, s69, 32768
buffer_load_dwordx4 v2, s[8:11], s72 offen lds
v_mfma_f32_16x16x32_bf16 a[48:51], v[236:239], v[164:167], 0
s_mov_b32 s31, 0x20000
v_mfma_f32_16x16x32_bf16 a[48:51], v[232:235], v[160:163], a[48:51]
s_mov_b32 s34, 0x400000
ds_read_b64_tr_b16 v[252:253], v23 offset:8192
v_mfma_f32_16x16x32_bf16 a[44:47], v[232:235], v[152:155], 0
s_mov_b32 s35, 0x20000
v_mfma_f32_16x16x32_bf16 a[44:47], v[236:239], v[156:159], a[44:47]
s_add_u32 s72, s69, 39936
buffer_load_dwordx4 v3, s[8:11], s72 offen offset:1024 lds
v_mfma_f32_16x16x32_bf16 a[40:43], v[236:239], v[148:151], 0
s_mov_b32 s38, 0x400000
v_mfma_f32_16x16x32_bf16 a[40:43], v[232:235], v[144:147], a[40:43]
s_mov_b32 s39, 0x20000
ds_read_b64_tr_b16 v[254:255], v23 offset:9216
v_mfma_f32_16x16x32_bf16 a[36:39], v[232:235], v[136:139], 0
s_mov_b32 s42, 0x400000
v_mfma_f32_16x16x32_bf16 a[36:39], v[236:239], v[140:143], a[36:39]
s_mov_b32 s43, 0x20000
v_mfma_f32_16x16x32_bf16 a[32:35], v[236:239], v[132:135], 0
s_add_u32 s72, s69, 47104
buffer_load_dwordx4 v2, s[8:11], s72 offen offset:2048 lds
v_mfma_f32_16x16x32_bf16 a[32:35], v[232:235], v[128:131], a[32:35]
s_waitcnt lgkmcnt(4)
v_mfma_f32_16x16x32_bf16 a[64:67], v[240:243], v[128:131], 0
s_mov_b32 s46, 0x5800000
ds_read_b64_tr_b16 v[224:225], v20 offset:16384
v_mfma_f32_16x16x32_bf16 a[64:67], v[244:247], v[132:135], a[64:67]
s_mov_b32 s47, 0x20000
v_mfma_f32_16x16x32_bf16 a[68:71], v[244:247], v[140:143], 0
s_mov_b32 s50, 0x100
ds_read_b64_tr_b16 v[226:227], v20 offset:17408
v_mfma_f32_16x16x32_bf16 a[68:71], v[240:243], v[136:139], a[68:71]
s_add_u32 s72, s69, 54272
buffer_load_dwordx4 v3, s[8:11], s72 offen offset:3072 lds
v_mfma_f32_16x16x32_bf16 a[72:75], v[240:243], v[144:147], 0
s_mov_b32 s51, 0x20000
v_lshl_add_u32 v4, v28, 11, v27
v_xor_b32 v5, 64, v4
v_mfma_f32_16x16x32_bf16 a[72:75], v[244:247], v[148:151], a[72:75]
v_lshlrev_b32 v1, 4, v0
v_mfma_f32_16x16x32_bf16 a[76:79], v[244:247], v[156:159], 0
s_sub_u32 s74, 15, s60
ds_read_b64_tr_b16 v[228:229], v20 offset:24576
v_mfma_f32_16x16x32_bf16 a[76:79], v[240:243], v[152:155], a[76:79]
s_lshl_b32 s68, s74, 18
v_mfma_f32_16x16x32_bf16 a[80:83], v[240:243], v[160:163], 0
s_add_u32 m0, s64, 49152
v_mfma_f32_16x16x32_bf16 a[80:83], v[244:247], v[164:167], a[80:83]
s_add_u32 s72, s71, 0
buffer_load_dwordx4 v6, s[20:23], s72 offen lds
v_mfma_f32_16x16x32_bf16 a[84:87], v[244:247], v[172:175], 0
s_lshl_b32 s76, s58, 15
ds_read_b64_tr_b16 v[230:231], v20 offset:25600
v_mfma_f32_16x16x32_bf16 a[84:87], v[240:243], v[168:171], a[84:87]
s_add_u32 s68, s68, s76
v_mfma_f32_16x16x32_bf16 a[88:91], v[240:243], v[176:179], 0
s_add_u32 s67, s67, s76
v_mfma_f32_16x16x32_bf16 a[88:91], v[244:247], v[180:183], a[88:91]
s_add_u32 s72, s71, 31744
buffer_load_dwordx4 v6, s[20:23], s72 offen offset:1024 lds
v_mfma_f32_16x16x32_bf16 a[92:95], v[244:247], v[188:191], 0
s_and_b32 s62, s60, 3
v_mfma_f32_16x16x32_bf16 a[92:95], v[240:243], v[184:187], a[92:95]
s_waitcnt lgkmcnt(4)
v_mfma_f32_16x16x32_bf16 a[124:127], v[248:251], v[184:187], 0
s_sub_u32 s62, 16, s62
ds_read_b64_tr_b16 v[232:233], v21 offset:16384
v_mfma_f32_16x16x32_bf16 a[124:127], v[252:255], v[188:191], a[124:127]
s_lshl_b32 s91, s91, 7
v_mfma_f32_16x16x32_bf16 a[120:123], v[252:255], v[180:183], 0
s_add_u32 s72, s71, 63488
buffer_load_dwordx4 v7, s[20:23], s72 offen offset:2048 lds
v_mfma_f32_16x16x32_bf16 a[120:123], v[248:251], v[176:179], a[120:123]
s_add_u32 s91, s91, 0x3810000
ds_read_b64_tr_b16 v[234:235], v21 offset:17408
v_lshrrev_b32 v34, 3, v0
v_mfma_f32_16x16x32_bf16 a[116:119], v[248:251], v[168:171], 0
v_or_b32 v34, s58, v34
v_min_u32 v34, 1, v34
v_mfma_f32_16x16x32_bf16 a[116:119], v[252:255], v[172:175], a[116:119]
v_lshlrev_b32 v34, 28, v34
v_add_lshl_u32 v34, v34, v0, 2
v_mfma_f32_16x16x32_bf16 a[112:115], v[252:255], v[164:167], 0
ds_read_b64_tr_b16 v[236:237], v21 offset:24576
v_mov_b32 v35, 0
v_mfma_f32_16x16x32_bf16 a[112:115], v[248:251], v[160:163], a[112:115]
s_add_u32 s72, s71, 95232
buffer_load_dwordx4 v7, s[20:23], s72 offen offset:3072 lds
v_mfma_f32_16x16x32_bf16 a[108:111], v[248:251], v[152:155], 0
s_lshr_b32 s80, s61, 1
buffer_store_dword v35, v34, s[44:47], s91 offen sc1
v_mfma_f32_16x16x32_bf16 a[108:111], v[252:255], v[156:159], a[108:111]
s_xor_b32 s80, s80, 1
ds_read_b64_tr_b16 v[238:239], v21 offset:25600
v_mfma_f32_16x16x32_bf16 a[104:107], v[252:255], v[148:151], 0
s_lshl_b32 s80, s80, 20
buffer_load_dword v126, v125, s[16:19], s80 offen
v_mfma_f32_16x16x32_bf16 a[104:107], v[248:251], v[144:147], a[104:107]
s_xor_b32 s83, s2, 5
buffer_load_dword v126, v125, s[20:23], s80 offen
v_mfma_f32_16x16x32_bf16 a[100:103], v[248:251], v[136:139], 0
s_and_b32 s83, s83, 15
v_mfma_f32_16x16x32_bf16 a[100:103], v[252:255], v[140:143], a[100:103]
s_lshr_b32 s74, s2, 4
v_mfma_f32_16x16x32_bf16 a[96:99], v[252:255], v[132:135], 0
s_lshl_b32 s74, s74, 7
v_mfma_f32_16x16x32_bf16 a[96:99], v[248:251], v[128:131], a[96:99]
s_waitcnt lgkmcnt(4)
v_mfma_f32_16x16x32_bf16 a[128:131], v[128:131], v[224:227], 0
s_lshl_b32 s75, s58, 5
ds_read_b64_tr_b16 v[240:241], v22 offset:16384
v_mfma_f32_16x16x32_bf16 a[128:131], v[132:135], v[228:231], a[128:131]
s_add_u32 s74, s74, s75
v_mfma_f32_16x16x32_bf16 a[132:135], v[140:143], v[228:231], 0
s_mov_b32 s75, 131072
v_lshrrev_b32 v29, 5, v0
v_lshlrev_b32 v29, 4, v29
v_mfma_f32_16x16x32_bf16 a[132:135], v[136:139], v[224:227], a[132:135]
ds_read_b64_tr_b16 v[242:243], v22 offset:17408
v_add_u32 v29, s74, v29
v_mfma_f32_16x16x32_bf16 a[136:139], v[144:147], v[224:227], 0
v_and_b32 v30, 31, v0
v_mfma_f32_16x16x32_bf16 a[136:139], v[148:151], v[228:231], a[136:139]
s_lshl_b32 s83, s83, 5
v_add_u32 v30, s83, v30
v_lshlrev_b32 v26, 11, v29
v_mfma_f32_16x16x32_bf16 a[140:143], v[156:159], v[228:231], 0
v_lshl_add_u32 v26, v30, 2, v26
v_subrev_u32 v27, 0x1800, v26
v_mfma_f32_16x16x32_bf16 a[140:143], v[152:155], v[224:227], a[140:143]
s_lshl_b32 s82, s74, 11
ds_read_b64_tr_b16 v[244:245], v22 offset:24576
v_mfma_f32_16x16x32_bf16 a[144:147], v[160:163], v[224:227], 0
s_lshl_b32 s83, s83, 2
v_mfma_f32_16x16x32_bf16 a[144:147], v[164:167], v[228:231], a[144:147]
s_add_u32 s82, s82, s83
v_lshrrev_b32 v26, 3, v0
v_and_b32 v32, 7, v0
v_mfma_f32_16x16x32_bf16 a[148:151], v[172:175], v[228:231], 0
ds_read_b64_tr_b16 v[246:247], v22 offset:25600
v_lshlrev_b32 v32, 4, v32
v_mfma_f32_16x16x32_bf16 a[148:151], v[168:171], v[224:227], a[148:151]
v_lshl_add_u32 v26, v26, 11, v32
v_lshrrev_b32 v98, 5, v0
v_mfma_f32_16x16x32_bf16 a[152:155], v[176:179], v[224:227], 0
v_lshlrev_b32 v98, 11, v98
v_and_b32 v32, 31, v0
v_mfma_f32_16x16x32_bf16 a[152:155], v[180:183], v[228:231], a[152:155]
v_lshl_add_u32 v98, v32, 2, v98
v_add_u32 v98, s63, v98
v_mfma_f32_16x16x32_bf16 a[156:159], v[188:191], v[228:231], 0
v_add_u32 v98, s75, v98
v_and_b32 v29, 0x7f, v29
v_mfma_f32_16x16x32_bf16 a[156:159], v[184:187], v[224:227], a[156:159]
s_waitcnt lgkmcnt(4)
v_sub_u32 v29, 0x70, v29
v_lshlrev_b32 v29, 1, v29
v_mfma_f32_16x16x32_bf16 a[188:191], v[184:187], v[232:235], 0
ds_read_b64_tr_b16 v[248:249], v23 offset:16384
v_and_b32 v32, 7, v0
v_mfma_f32_16x16x32_bf16 a[188:191], v[188:191], v[236:239], a[188:191]
v_mul_u32_u24 v32, 544, v32
v_add3_u32 v28, v32, v29, s75
v_mfma_f32_16x16x32_bf16 a[184:187], v[180:183], v[236:239], 0
ds_read_b64_tr_b16 v[250:251], v23 offset:17408
v_bfe_u32 v32, v0, 3, 2
v_mfma_f32_16x16x32_bf16 a[184:187], v[176:179], v[232:235], a[184:187]
v_lshl_add_u32 v28, v32, 13, v28
v_lshlrev_b32 v30, 4, v30
v_mfma_f32_16x16x32_bf16 a[180:183], v[168:171], v[232:235], 0
s_lshl_b32 s83, s2, 14
ds_read_b64_tr_b16 v[252:253], v23 offset:24576
v_mfma_f32_16x16x32_bf16 a[180:183], v[172:175], v[236:239], a[180:183]
s_lshl_b32 s74, s58, 12
v_mfma_f32_16x16x32_bf16 a[176:179], v[164:167], v[236:239], 0
s_add_u32 s76, s83, s74
ds_read_b64_tr_b16 v[254:255], v23 offset:25600
v_mfma_f32_16x16x32_bf16 a[176:179], v[160:163], v[232:235], a[176:179]
v_add_u32 v16, s63, v16
v_add_u32 v16, 131072, v16
v_mfma_f32_16x16x32_bf16 a[172:175], v[152:155], v[232:235], 0
s_xor_b32 s73, s61, 2
v_xor_b32 v17, 64, v16
v_subrev_u32 v18, 0x10000, v16
v_mfma_f32_16x16x32_bf16 a[172:175], v[156:159], v[236:239], a[172:175]
s_lshl_b32 s69, s73, 7
v_subrev_u32 v19, 0x10000, v17
v_xor_b32 v9, 32, v8
v_mfma_f32_16x16x32_bf16 a[168:171], v[148:151], v[236:239], 0
s_add_u32 s69, s69, s84
v_xor_b32 v10, 64, v8
v_xor_b32 v11, 96, v8
v_mfma_f32_16x16x32_bf16 a[168:171], v[144:147], v[232:235], a[168:171]
s_lshl_b32 s71, s73, 19
v_xor_b32 v12, 128, v8
v_xor_b32 v13, 160, v8
v_mfma_f32_16x16x32_bf16 a[164:167], v[136:139], v[232:235], 0
s_add_u32 s71, s71, s66
v_xor_b32 v14, 192, v8
v_xor_b32 v15, 224, v8
s_branch Lmain
.p2align 12
Lmain:
v_mfma_f32_16x16x32_bf16 a[164:167], v[140:143], v[236:239], a[164:167]
s_add_u32 m0, s63, 65536
s_nop 3
s_mov_b64 exec, 0
s_cmp_eq_u32 s58, 0
s_cbranch_scc1 Lstub0
s_cmp_eq_u32 s58, 1
s_cbranch_scc1 Lstub1
s_cmp_eq_u32 s58, 2
s_cbranch_scc1 Lstub2
s_branch Lstub3
Lret:
s_mov_b64 exec, -1
Lstuba0:
s_cbranch_execz Lreta
s_nop 3
v_mfma_f32_16x16x32_bf16 a[160:163], v[132:135], v[236:239], 0
s_waitcnt vmcnt(3) lgkmcnt(0)
v_mfma_f32_16x16x32_bf16 a[160:163], v[128:131], v[232:235], a[160:163]
s_barrier
v_mfma_f32_16x16x32_bf16 a[192:195], v[128:131], v[240:243], 0
s_add_u32 s72, s69, 0
buffer_load_dwordx4 v2, s[8:11], s72 offen lds
v_mfma_f32_16x16x32_bf16 a[192:195], v[132:135], v[244:247], a[192:195]
s_lshl_b32 s77, s59, 20
ds_read_b64_tr_b16 v[224:225], v20 offset:32768
v_mfma_f32_16x16x32_bf16 a[196:199], v[140:143], v[244:247], 0
s_add_u32 s81, s77, s64
ds_read_b64_tr_b16 v[226:227], v20 offset:33792
v_mfma_f32_16x16x32_bf16 a[196:199], v[136:139], v[240:243], a[196:199]
s_sub_u32 s81, s81, 0x4000
ds_read_b64_tr_b16 v[228:229], v20 offset:40960
v_mfma_f32_16x16x32_bf16 a[200:203], v[144:147], v[240:243], 0
s_add_u32 s72, s69, 7168
buffer_load_dwordx4 v3, s[8:11], s72 offen offset:1024 lds
v_mfma_f32_16x16x32_bf16 a[200:203], v[148:151], v[244:247], a[200:203]
s_lshl_b32 s75, s60, 17
ds_read_b64_tr_b16 v[230:231], v20 offset:41984
v_mfma_f32_16x16x32_bf16 a[204:207], v[156:159], v[244:247], 0
s_add_u32 s77, s77, s75
ds_read_b128 v[192:195], v24 offset:32768
v_mfma_f32_16x16x32_bf16 a[204:207], v[152:155], v[240:243], a[204:207]
s_lshr_b32 s75, s58, 1
ds_read_b128 v[196:199], v25 offset:32768
v_mfma_f32_16x16x32_bf16 a[208:211], v[160:163], v[240:243], 0
s_add_u32 s72, s69, 14336
buffer_load_dwordx4 v2, s[8:11], s72 offen offset:2048 lds
v_mfma_f32_16x16x32_bf16 a[208:211], v[164:167], v[244:247], a[208:211]
s_lshl_b32 s75, s75, 16
ds_read_b128 v[200:203], v24 offset:34816
v_mfma_f32_16x16x32_bf16 a[212:215], v[172:175], v[244:247], 0
s_add_u32 s77, s77, s75
ds_read_b128 v[204:207], v25 offset:34816
v_mfma_f32_16x16x32_bf16 a[212:215], v[168:171], v[240:243], a[212:215]
s_and_b32 s74, s58, 1
ds_read_b128 v[208:211], v24 offset:36864
v_mfma_f32_16x16x32_bf16 a[216:219], v[176:179], v[240:243], 0
s_add_u32 s72, s69, 21504
buffer_load_dwordx4 v3, s[8:11], s72 offen offset:3072 lds
v_mfma_f32_16x16x32_bf16 a[216:219], v[180:183], v[244:247], a[216:219]
s_lshl_b32 s75, s74, 12
ds_read_b128 v[212:215], v25 offset:36864
v_mfma_f32_16x16x32_bf16 a[220:223], v[188:191], v[244:247], 0
s_add_u32 s78, s77, s75
ds_read_b128 v[216:219], v24 offset:38912
v_mfma_f32_16x16x32_bf16 a[220:223], v[184:187], v[240:243], a[220:223]
s_add_u32 s78, s78, 0x4000
ds_read_b128 v[220:223], v25 offset:38912
v_mfma_f32_16x16x32_bf16 a[252:255], v[184:187], v[248:251], 0
s_add_u32 m0, s64, 0
v_mfma_f32_16x16x32_bf16 a[252:255], v[188:191], v[252:255], a[252:255]
s_add_u32 s72, s71, 0
buffer_load_dwordx4 v6, s[16:19], s72 offen lds
v_mfma_f32_16x16x32_bf16 a[248:251], v[180:183], v[252:255], 0
s_lshl_b32 s75, s74, 11
ds_read_b128 v[184:187], v24 offset:40960
v_mfma_f32_16x16x32_bf16 a[248:251], v[176:179], v[248:251], a[248:251]
s_add_u32 s77, s77, s75
ds_read_b128 v[188:191], v25 offset:40960
v_mfma_f32_16x16x32_bf16 a[244:247], v[168:171], v[248:251], 0
s_mov_b32 s79, 0x3e0293ee
v_mfma_f32_16x16x32_bf16 a[244:247], v[172:175], v[252:255], a[244:247]
s_add_u32 s72, s71, 31744
buffer_load_dwordx4 v6, s[16:19], s72 offen offset:1024 lds
v_mfma_f32_16x16x32_bf16 a[240:243], v[164:167], v[252:255], 0
ds_read_b128 v[176:179], v24 offset:43008
v_mfma_f32_16x16x32_bf16 a[240:243], v[160:163], v[248:251], a[240:243]
ds_read_b128 v[180:183], v25 offset:43008
v_mfma_f32_16x16x32_bf16 a[236:239], v[152:155], v[248:251], 0
ds_read_b128 v[168:171], v24 offset:45056
v_mfma_f32_16x16x32_bf16 a[236:239], v[156:159], v[252:255], a[236:239]
s_add_u32 s72, s71, 63488
buffer_load_dwordx4 v7, s[16:19], s72 offen offset:2048 lds
v_mfma_f32_16x16x32_bf16 a[232:235], v[148:151], v[252:255], 0
ds_read_b128 v[172:175], v25 offset:45056
v_mfma_f32_16x16x32_bf16 a[232:235], v[144:147], v[248:251], a[232:235]
ds_read_b128 v[160:163], v24 offset:47104
v_mfma_f32_16x16x32_bf16 a[228:231], v[136:139], v[248:251], 0
ds_read_b128 v[164:167], v25 offset:47104
v_mfma_f32_16x16x32_bf16 a[228:231], v[140:143], v[252:255], a[228:231]
s_add_u32 s72, s71, 95232
buffer_load_dwordx4 v7, s[16:19], s72 offen offset:3072 lds
v_mfma_f32_16x16x32_bf16 a[224:227], v[132:135], v[252:255], 0
ds_read_b64_tr_b16 v[232:233], v21 offset:32768
v_mfma_f32_16x16x32_bf16 a[224:227], v[128:131], v[248:251], a[224:227]
s_waitcnt lgkmcnt(9)
ds_read_b64_tr_b16 v[234:235], v21 offset:33792
v_mfma_f32_16x16x32_bf16 a[0:3], v[224:227], v[192:195], a[0:3]
ds_read_b64_tr_b16 v[240:241], v22 offset:32768
v_mfma_f32_16x16x32_bf16 a[0:3], v[228:231], v[196:199], a[0:3]
s_add_u32 m0, s63, 69632
ds_read_b64_tr_b16 v[236:237], v21 offset:40960
v_mfma_f32_16x16x32_bf16 a[4:7], v[228:231], v[204:207], a[4:7]
s_add_u32 s72, s69, 32768
buffer_load_dwordx4 v2, s[8:11], s72 offen lds
v_mfma_f32_16x16x32_bf16 a[4:7], v[224:227], v[200:203], a[4:7]
v_mfma_f32_16x16x32_bf16 a[8:11], v[224:227], v[208:211], a[8:11]
ds_read_b64_tr_b16 v[238:239], v21 offset:41984
v_mfma_f32_16x16x32_bf16 a[8:11], v[228:231], v[212:215], a[8:11]
ds_read_b64_tr_b16 v[242:243], v22 offset:33792
v_mfma_f32_16x16x32_bf16 a[12:15], v[228:231], v[220:223], a[12:15]
s_add_u32 s72, s69, 39936
buffer_load_dwordx4 v3, s[8:11], s72 offen offset:1024 lds
v_mfma_f32_16x16x32_bf16 a[12:15], v[224:227], v[216:219], a[12:15]
s_waitcnt lgkmcnt(6)
v_mfma_f32_16x16x32_bf16 a[16:19], v[224:227], v[184:187], a[16:19]
ds_read_b64_tr_b16 v[244:245], v22 offset:40960
v_mfma_f32_16x16x32_bf16 a[16:19], v[228:231], v[188:191], a[16:19]
v_mfma_f32_16x16x32_bf16 a[20:23], v[228:231], v[180:183], a[20:23]
s_add_u32 s72, s69, 47104
buffer_load_dwordx4 v2, s[8:11], s72 offen offset:2048 lds
v_mfma_f32_16x16x32_bf16 a[20:23], v[224:227], v[176:179], a[20:23]
ds_read_b64_tr_b16 v[246:247], v22 offset:41984
v_mfma_f32_16x16x32_bf16 a[24:27], v[224:227], v[168:171], a[24:27]
v_mfma_f32_16x16x32_bf16 a[24:27], v[228:231], v[172:175], a[24:27]
v_mfma_f32_16x16x32_bf16 a[28:31], v[228:231], v[164:167], a[28:31]
s_add_u32 s72, s69, 54272
buffer_load_dwordx4 v3, s[8:11], s72 offen offset:3072 lds
v_mfma_f32_16x16x32_bf16 a[28:31], v[224:227], v[160:163], a[28:31]
s_waitcnt lgkmcnt(3)
v_mfma_f32_16x16x32_bf16 a[60:63], v[232:235], v[160:163], a[60:63]
ds_read_b64_tr_b16 v[248:249], v23 offset:32768
v_mfma_f32_16x16x32_bf16 a[60:63], v[236:239], v[164:167], a[60:63]
v_mfma_f32_16x16x32_bf16 a[56:59], v[236:239], v[172:175], a[56:59]
s_add_u32 m0, s64, 16384
ds_read_b64_tr_b16 v[250:251], v23 offset:33792
v_mfma_f32_16x16x32_bf16 a[56:59], v[232:235], v[168:171], a[56:59]
s_add_u32 s72, s71, 0
buffer_load_dwordx4 v6, s[20:23], s72 offen lds
v_mfma_f32_16x16x32_bf16 a[52:55], v[232:235], v[176:179], a[52:55]
v_mfma_f32_16x16x32_bf16 a[52:55], v[236:239], v[180:183], a[52:55]
v_mfma_f32_16x16x32_bf16 a[48:51], v[236:239], v[188:191], a[48:51]
ds_read_b64_tr_b16 v[252:253], v23 offset:40960
v_mfma_f32_16x16x32_bf16 a[48:51], v[232:235], v[184:187], a[48:51]
s_add_u32 s72, s71, 31744
buffer_load_dwordx4 v6, s[20:23], s72 offen offset:1024 lds
v_mfma_f32_16x16x32_bf16 a[44:47], v[232:235], v[216:219], a[44:47]
v_mfma_f32_16x16x32_bf16 a[44:47], v[236:239], v[220:223], a[44:47]
v_mfma_f32_16x16x32_bf16 a[40:43], v[236:239], v[212:215], a[40:43]
ds_read_b64_tr_b16 v[254:255], v23 offset:41984
v_mfma_f32_16x16x32_bf16 a[40:43], v[232:235], v[208:211], a[40:43]
s_add_u32 s72, s71, 63488
buffer_load_dwordx4 v7, s[20:23], s72 offen offset:2048 lds
v_mfma_f32_16x16x32_bf16 a[36:39], v[232:235], v[200:203], a[36:39]
v_mfma_f32_16x16x32_bf16 a[36:39], v[236:239], v[204:207], a[36:39]
v_mfma_f32_16x16x32_bf16 a[32:35], v[236:239], v[196:199], a[32:35]
s_add_u32 s72, s71, 95232
v_mfma_f32_16x16x32_bf16 a[32:35], v[232:235], v[192:195], a[32:35]
s_waitcnt lgkmcnt(4)
buffer_load_dwordx4 v7, s[20:23], s72 offen offset:3072 lds
v_mfma_f32_16x16x32_bf16 a[64:67], v[240:243], v[192:195], a[64:67]
ds_read_b64_tr_b16 v[224:225], v20 offset:49152
v_mfma_f32_16x16x32_bf16 a[64:67], v[244:247], v[196:199], a[64:67]
v_mfma_f32_16x16x32_bf16 a[68:71], v[244:247], v[204:207], a[68:71]
ds_read_b64_tr_b16 v[226:227], v20 offset:50176
v_mfma_f32_16x16x32_bf16 a[68:71], v[240:243], v[200:203], a[68:71]
s_lshr_b32 s80, s61, 1
v_mfma_f32_16x16x32_bf16 a[72:75], v[240:243], v[208:211], a[72:75]
s_xor_b32 s80, s80, 2
v_mfma_f32_16x16x32_bf16 a[72:75], v[244:247], v[212:215], a[72:75]
s_lshl_b32 s80, s80, 20
buffer_load_dword v126, v125, s[16:19], s80 offen
v_mfma_f32_16x16x32_bf16 a[76:79], v[244:247], v[220:223], a[76:79]
ds_read_b64_tr_b16 v[228:229], v20 offset:57344
v_mfma_f32_16x16x32_bf16 a[76:79], v[240:243], v[216:219], a[76:79]
v_mfma_f32_16x16x32_bf16 a[80:83], v[240:243], v[184:187], a[80:83]
v_mfma_f32_16x16x32_bf16 a[80:83], v[244:247], v[188:191], a[80:83]
buffer_load_dword v126, v125, s[20:23], s80 offen
v_mfma_f32_16x16x32_bf16 a[84:87], v[244:247], v[180:183], a[84:87]
ds_read_b64_tr_b16 v[230:231], v20 offset:58368
v_mfma_f32_16x16x32_bf16 a[84:87], v[240:243], v[176:179], a[84:87]
v_mfma_f32_16x16x32_bf16 a[88:91], v[240:243], v[168:171], a[88:91]
v_mfma_f32_16x16x32_bf16 a[88:91], v[244:247], v[172:175], a[88:91]
global_load_dwordx4 v[68:71], v30, s[52:53]
v_mfma_f32_16x16x32_bf16 a[92:95], v[244:247], v[164:167], a[92:95]
v_mfma_f32_16x16x32_bf16 a[92:95], v[240:243], v[160:163], a[92:95]
s_waitcnt lgkmcnt(4)
v_mfma_f32_16x16x32_bf16 a[124:127], v[248:251], v[160:163], a[124:127]
ds_read_b64_tr_b16 v[232:233], v21 offset:49152
v_mfma_f32_16x16x32_bf16 a[124:127], v[252:255], v[164:167], a[124:127]
buffer_load_dword v33, v27, s[28:31], 0 offen nt
v_mfma_f32_16x16x32_bf16 a[120:123], v[252:255], v[172:175], a[120:123]
v_mfma_f32_16x16x32_bf16 a[120:123], v[248:251], v[168:171], a[120:123]
ds_read_b64_tr_b16 v[234:235], v21 offset:50176
v_mfma_f32_16x16x32_bf16 a[116:119], v[248:251], v[176:179], a[116:119]
v_mfma_f32_16x16x32_bf16 a[116:119], v[252:255], v[180:183], a[116:119]
buffer_load_dword v34, v27, s[28:31], 0 offen offset:2048 nt
v_mfma_f32_16x16x32_bf16 a[112:115], v[252:255], v[188:191], a[112:115]
v_mfma_f32_16x16x32_bf16 a[112:115], v[248:251], v[184:187], a[112:115]
ds_read_b64_tr_b16 v[236:237], v21 offset:57344
v_mfma_f32_16x16x32_bf16 a[108:111], v[248:251], v[216:219], a[108:111]
v_mfma_f32_16x16x32_bf16 a[108:111], v[252:255], v[220:223], a[108:111]
v_add_u32 v27, 0x1000, v27
v_mfma_f32_16x16x32_bf16 a[104:107], v[252:255], v[212:215], a[104:107]
ds_read_b64_tr_b16 v[238:239], v21 offset:58368
v_mfma_f32_16x16x32_bf16 a[104:107], v[248:251], v[208:211], a[104:107]
v_mfma_f32_16x16x32_bf16 a[100:103], v[248:251], v[200:203], a[100:103]
v_mfma_f32_16x16x32_bf16 a[100:103], v[252:255], v[204:207], a[100:103]
buffer_load_dword v35, v27, s[28:31], 0 offen nt
v_mfma_f32_16x16x32_bf16 a[96:99], v[252:255], v[196:199], a[96:99]
v_mfma_f32_16x16x32_bf16 a[96:99], v[248:251], v[192:195], a[96:99]
s_waitcnt lgkmcnt(4)
v_mfma_f32_16x16x32_bf16 a[128:131], v[192:195], v[224:227], a[128:131]
ds_read_b64_tr_b16 v[240:241], v22 offset:49152
v_mfma_f32_16x16x32_bf16 a[128:131], v[196:199], v[228:231], a[128:131]
s_add_u32 m0, s63, 131072
v_mfma_f32_16x16x32_bf16 a[132:135], v[204:207], v[228:231], a[132:135]
s_add_u32 s80, s82, 0
buffer_load_dwordx4 v26, s[28:31], s80 offen nt lds
v_mfma_f32_16x16x32_bf16 a[132:135], v[200:203], v[224:227], a[132:135]
ds_read_b64_tr_b16 v[242:243], v22 offset:50176
v_mfma_f32_16x16x32_bf16 a[136:139], v[208:211], v[224:227], a[136:139]
v_mfma_f32_16x16x32_bf16 a[136:139], v[212:215], v[228:231], a[136:139]
v_mfma_f32_16x16x32_bf16 a[140:143], v[220:223], v[228:231], a[140:143]
s_add_u32 s80, s82, 15360
buffer_load_dwordx4 v26, s[28:31], s80 offen offset:1024 nt lds
v_mfma_f32_16x16x32_bf16 a[140:143], v[216:219], v[224:227], a[140:143]
ds_read_b64_tr_b16 v[244:245], v22 offset:57344
v_mfma_f32_16x16x32_bf16 a[144:147], v[184:187], v[224:227], a[144:147]
v_mfma_f32_16x16x32_bf16 a[144:147], v[188:191], v[228:231], a[144:147]
v_mfma_f32_16x16x32_bf16 a[148:151], v[180:183], v[228:231], a[148:151]
s_add_u32 s80, s82, 30720
buffer_load_dwordx4 v26, s[28:31], s80 offen offset:2048 nt lds
v_mfma_f32_16x16x32_bf16 a[148:151], v[176:179], v[224:227], a[148:151]
ds_read_b64_tr_b16 v[246:247], v22 offset:58368
v_mfma_f32_16x16x32_bf16 a[152:155], v[168:171], v[224:227], a[152:155]
v_mfma_f32_16x16x32_bf16 a[152:155], v[172:175], v[228:231], a[152:155]
v_mfma_f32_16x16x32_bf16 a[156:159], v[164:167], v[228:231], a[156:159]
s_add_u32 s80, s82, 46080
buffer_load_dwordx4 v26, s[28:31], s80 offen offset:3072 nt lds
v_mfma_f32_16x16x32_bf16 a[156:159], v[160:163], v[224:227], a[156:159]
s_waitcnt lgkmcnt(4)
v_mfma_f32_16x16x32_bf16 a[188:191], v[160:163], v[232:235], a[188:191]
ds_read_b64_tr_b16 v[248:249], v23 offset:49152
v_mfma_f32_16x16x32_bf16 a[188:191], v[164:167], v[236:239], a[188:191]
v_mfma_f32_16x16x32_bf16 a[184:187], v[172:175], v[236:239], a[184:187]
ds_read_b64_tr_b16 v[250:251], v23 offset:50176
v_mfma_f32_16x16x32_bf16 a[184:187], v[168:171], v[232:235], a[184:187]
v_mfma_f32_16x16x32_bf16 a[180:183], v[176:179], v[232:235], a[180:183]
ds_read_b64_tr_b16 v[252:253], v23 offset:57344
v_mfma_f32_16x16x32_bf16 a[180:183], v[180:183], v[236:239], a[180:183]
v_mfma_f32_16x16x32_bf16 a[176:179], v[188:191], v[236:239], a[176:179]
ds_read_b64_tr_b16 v[254:255], v23 offset:58368
v_mfma_f32_16x16x32_bf16 a[176:179], v[184:187], v[232:235], a[176:179]
v_mfma_f32_16x16x32_bf16 a[172:175], v[216:219], v[232:235], a[172:175]
s_xor_b32 s73, s61, 3
v_mfma_f32_16x16x32_bf16 a[172:175], v[220:223], v[236:239], a[172:175]
s_lshl_b32 s69, s73, 7
v_mfma_f32_16x16x32_bf16 a[168:171], v[212:215], v[236:239], a[168:171]
s_add_u32 s69, s69, s84
v_mfma_f32_16x16x32_bf16 a[168:171], v[208:211], v[232:235], a[168:171]
s_lshl_b32 s71, s73, 19
v_mfma_f32_16x16x32_bf16 a[164:167], v[200:203], v[232:235], a[164:167]
s_add_u32 s71, s71, s66
v_mfma_f32_16x16x32_bf16 a[164:167], v[204:207], v[236:239], a[164:167]
s_add_u32 m0, s63, 98304
v_mfma_f32_16x16x32_bf16 a[160:163], v[196:199], v[236:239], a[160:163]
s_waitcnt vmcnt(10) lgkmcnt(0)
v_mfma_f32_16x16x32_bf16 a[160:163], v[192:195], v[232:235], a[160:163]
s_barrier
v_mfma_f32_16x16x32_bf16 a[192:195], v[192:195], v[240:243], a[192:195]
s_add_u32 s72, s69, 0
buffer_load_dwordx4 v2, s[8:11], s72 offen lds
v_mfma_f32_16x16x32_bf16 a[192:195], v[196:199], v[244:247], a[192:195]
ds_read_b64_tr_b16 v[224:225], v20 offset:0
v_mfma_f32_16x16x32_bf16 a[196:199], v[204:207], v[244:247], a[196:199]
ds_read_b64_tr_b16 v[226:227], v20 offset:1024
v_mfma_f32_16x16x32_bf16 a[196:199], v[200:203], v[240:243], a[196:199]
ds_read_b64_tr_b16 v[228:229], v20 offset:8192
v_mfma_f32_16x16x32_bf16 a[200:203], v[208:211], v[240:243], a[200:203]
s_add_u32 s72, s69, 7168
buffer_load_dwordx4 v3, s[8:11], s72 offen offset:1024 lds
v_mfma_f32_16x16x32_bf16 a[200:203], v[212:215], v[244:247], a[200:203]
ds_read_b64_tr_b16 v[230:231], v20 offset:9216
v_mfma_f32_16x16x32_bf16 a[204:207], v[220:223], v[244:247], a[204:207]
ds_read_b128 v[128:131], v24 offset:0
v_mfma_f32_16x16x32_bf16 a[204:207], v[216:219], v[240:243], a[204:207]
ds_read_b128 v[132:135], v25 offset:0
v_mfma_f32_16x16x32_bf16 a[208:211], v[184:187], v[240:243], a[208:211]
s_add_u32 s72, s69, 14336
buffer_load_dwordx4 v2, s[8:11], s72 offen offset:2048 lds
v_mfma_f32_16x16x32_bf16 a[208:211], v[188:191], v[244:247], a[208:211]
ds_read_b128 v[136:139], v24 offset:2048
v_mfma_f32_16x16x32_bf16 a[212:215], v[180:183], v[244:247], a[212:215]
ds_read_b128 v[140:143], v25 offset:2048
v_mfma_f32_16x16x32_bf16 a[212:215], v[176:179], v[240:243], a[212:215]
ds_read_b128 v[144:147], v24 offset:4096
v_mfma_f32_16x16x32_bf16 a[216:219], v[168:171], v[240:243], a[216:219]
s_add_u32 s72, s69, 21504
buffer_load_dwordx4 v3, s[8:11], s72 offen offset:3072 lds
v_mfma_f32_16x16x32_bf16 a[216:219], v[172:175], v[244:247], a[216:219]
ds_read_b128 v[148:151], v25 offset:4096
v_mfma_f32_16x16x32_bf16 a[220:223], v[164:167], v[244:247], a[220:223]
ds_read_b128 v[152:155], v24 offset:6144
v_mfma_f32_16x16x32_bf16 a[220:223], v[160:163], v[240:243], a[220:223]
ds_read_b128 v[156:159], v25 offset:6144
v_mfma_f32_16x16x32_bf16 a[252:255], v[160:163], v[248:251], a[252:255]
s_add_u32 m0, s64, 32768
v_mfma_f32_16x16x32_bf16 a[252:255], v[164:167], v[252:255], a[252:255]
s_add_u32 s72, s71, 0
buffer_load_dwordx4 v6, s[16:19], s72 offen lds
v_mfma_f32_16x16x32_bf16 a[248:251], v[172:175], v[252:255], a[248:251]
ds_read_b128 v[160:163], v24 offset:8192
v_mfma_f32_16x16x32_bf16 a[248:251], v[168:171], v[248:251], a[248:251]
ds_read_b128 v[164:167], v25 offset:8192
v_mfma_f32_16x16x32_bf16 a[244:247], v[176:179], v[248:251], a[244:247]
v_mfma_f32_16x16x32_bf16 a[244:247], v[180:183], v[252:255], a[244:247]
s_add_u32 s72, s71, 31744
buffer_load_dwordx4 v6, s[16:19], s72 offen offset:1024 lds
v_mfma_f32_16x16x32_bf16 a[240:243], v[188:191], v[252:255], a[240:243]
ds_read_b128 v[168:171], v24 offset:10240
v_mfma_f32_16x16x32_bf16 a[240:243], v[184:187], v[248:251], a[240:243]
ds_read_b128 v[172:175], v25 offset:10240
v_mfma_f32_16x16x32_bf16 a[236:239], v[216:219], v[248:251], a[236:239]
ds_read_b128 v[176:179], v24 offset:12288
v_mfma_f32_16x16x32_bf16 a[236:239], v[220:223], v[252:255], a[236:239]
s_add_u32 s72, s71, 63488
buffer_load_dwordx4 v7, s[16:19], s72 offen offset:2048 lds
v_mfma_f32_16x16x32_bf16 a[232:235], v[212:215], v[252:255], a[232:235]
ds_read_b128 v[180:183], v25 offset:12288
v_mfma_f32_16x16x32_bf16 a[232:235], v[208:211], v[248:251], a[232:235]
ds_read_b128 v[184:187], v24 offset:14336
v_mfma_f32_16x16x32_bf16 a[228:231], v[200:203], v[248:251], a[228:231]
ds_read_b128 v[188:191], v25 offset:14336
v_mfma_f32_16x16x32_bf16 a[228:231], v[204:207], v[252:255], a[228:231]
s_add_u32 s72, s71, 95232
buffer_load_dwordx4 v7, s[16:19], s72 offen offset:3072 lds
v_mfma_f32_16x16x32_bf16 a[224:227], v[196:199], v[252:255], a[224:227]
ds_read_b64_tr_b16 v[232:233], v21 offset:0
v_mfma_f32_16x16x32_bf16 a[224:227], v[192:195], v[248:251], a[224:227]
s_waitcnt lgkmcnt(9)
ds_read_b64_tr_b16 v[234:235], v21 offset:1024
v_mfma_f32_16x16x32_bf16 a[0:3], v[224:227], v[128:131], a[0:3]
ds_read_b64_tr_b16 v[240:241], v22 offset:0
v_mfma_f32_16x16x32_bf16 a[0:3], v[228:231], v[132:135], a[0:3]
s_add_u32 m0, s63, 102400
ds_read_b64_tr_b16 v[236:237], v21 offset:8192
v_mfma_f32_16x16x32_bf16 a[4:7], v[228:231], v[140:143], a[4:7]
s_add_u32 s72, s69, 32768
buffer_load_dwordx4 v2, s[8:11], s72 offen lds
v_mfma_f32_16x16x32_bf16 a[4:7], v[224:227], v[136:139], a[4:7]
v_mfma_f32_16x16x32_bf16 a[8:11], v[224:227], v[144:147], a[8:11]
ds_read_b64_tr_b16 v[238:239], v21 offset:9216
v_mfma_f32_16x16x32_bf16 a[8:11], v[228:231], v[148:151], a[8:11]
ds_read_b64_tr_b16 v[242:243], v22 offset:1024
v_mfma_f32_16x16x32_bf16 a[12:15], v[228:231], v[156:159], a[12:15]
s_add_u32 s72, s69, 39936
buffer_load_dwordx4 v3, s[8:11], s72 offen offset:1024 lds
v_mfma_f32_16x16x32_bf16 a[12:15], v[224:227], v[152:155], a[12:15]
s_waitcnt lgkmcnt(6)
v_mfma_f32_16x16x32_bf16 a[16:19], v[224:227], v[160:163], a[16:19]
ds_read_b64_tr_b16 v[244:245], v22 offset:8192
v_mfma_f32_16x16x32_bf16 a[16:19], v[228:231], v[164:167], a[16:19]
v_mfma_f32_16x16x32_bf16 a[20:23], v[228:231], v[172:175], a[20:23]
s_add_u32 s72, s69, 47104
buffer_load_dwordx4 v2, s[8:11], s72 offen offset:2048 lds
v_mfma_f32_16x16x32_bf16 a[20:23], v[224:227], v[168:171], a[20:23]
ds_read_b64_tr_b16 v[246:247], v22 offset:9216
v_mfma_f32_16x16x32_bf16 a[24:27], v[224:227], v[176:179], a[24:27]
v_mfma_f32_16x16x32_bf16 a[24:27], v[228:231], v[180:183], a[24:27]
v_mfma_f32_16x16x32_bf16 a[28:31], v[228:231], v[188:191], a[28:31]
s_add_u32 s72, s69, 54272
buffer_load_dwordx4 v3, s[8:11], s72 offen offset:3072 lds
v_mfma_f32_16x16x32_bf16 a[28:31], v[224:227], v[184:187], a[28:31]
s_waitcnt lgkmcnt(3)
v_mfma_f32_16x16x32_bf16 a[60:63], v[232:235], v[184:187], a[60:63]
ds_read_b64_tr_b16 v[248:249], v23 offset:0
v_mfma_f32_16x16x32_bf16 a[60:63], v[236:239], v[188:191], a[60:63]
v_mfma_f32_16x16x32_bf16 a[56:59], v[236:239], v[180:183], a[56:59]
s_add_u32 m0, s64, 49152
ds_read_b64_tr_b16 v[250:251], v23 offset:1024
v_mfma_f32_16x16x32_bf16 a[56:59], v[232:235], v[176:179], a[56:59]
s_add_u32 s72, s71, 0
buffer_load_dwordx4 v6, s[20:23], s72 offen lds
v_mfma_f32_16x16x32_bf16 a[52:55], v[232:235], v[168:171], a[52:55]
v_mfma_f32_16x16x32_bf16 a[52:55], v[236:239], v[172:175], a[52:55]
v_mfma_f32_16x16x32_bf16 a[48:51], v[236:239], v[164:167], a[48:51]
ds_read_b64_tr_b16 v[252:253], v23 offset:8192
v_mfma_f32_16x16x32_bf16 a[48:51], v[232:235], v[160:163], a[48:51]
s_add_u32 s72, s71, 31744
buffer_load_dwordx4 v6, s[20:23], s72 offen offset:1024 lds
v_mfma_f32_16x16x32_bf16 a[44:47], v[232:235], v[152:155], a[44:47]
v_mfma_f32_16x16x32_bf16 a[44:47], v[236:239], v[156:159], a[44:47]
v_mfma_f32_16x16x32_bf16 a[40:43], v[236:239], v[148:151], a[40:43]
ds_read_b64_tr_b16 v[254:255], v23 offset:9216
v_mfma_f32_16x16x32_bf16 a[40:43], v[232:235], v[144:147], a[40:43]
s_add_u32 s72, s71, 63488
buffer_load_dwordx4 v7, s[20:23], s72 offen offset:2048 lds
v_mfma_f32_16x16x32_bf16 a[36:39], v[232:235], v[136:139], a[36:39]
v_mfma_f32_16x16x32_bf16 a[36:39], v[236:239], v[140:143], a[36:39]
v_mfma_f32_16x16x32_bf16 a[32:35], v[236:239], v[132:135], a[32:35]
s_add_u32 s72, s71, 95232
v_mfma_f32_16x16x32_bf16 a[32:35], v[232:235], v[128:131], a[32:35]
s_waitcnt lgkmcnt(4)
buffer_load_dwordx4 v7, s[20:23], s72 offen offset:3072 lds
v_mfma_f32_16x16x32_bf16 a[64:67], v[240:243], v[128:131], a[64:67]
ds_read_b64_tr_b16 v[224:225], v20 offset:16384
v_mfma_f32_16x16x32_bf16 a[64:67], v[244:247], v[132:135], a[64:67]
v_mfma_f32_16x16x32_bf16 a[68:71], v[244:247], v[140:143], a[68:71]
v_mfma_f32_16x16x32_bf16 a[68:71], v[240:243], v[136:139], a[68:71]
s_lshr_b32 s80, s61, 1
ds_read_b64_tr_b16 v[226:227], v20 offset:17408
v_mfma_f32_16x16x32_bf16 a[72:75], v[240:243], v[144:147], a[72:75]
s_xor_b32 s80, s80, 3
v_mfma_f32_16x16x32_bf16 a[72:75], v[244:247], v[148:151], a[72:75]
s_lshl_b32 s80, s80, 20
buffer_load_dword v126, v125, s[16:19], s80 offen
v_mfma_f32_16x16x32_bf16 a[76:79], v[244:247], v[156:159], a[76:79]
v_mfma_f32_16x16x32_bf16 a[76:79], v[240:243], v[152:155], a[76:79]
ds_read_b64_tr_b16 v[228:229], v20 offset:24576
v_mfma_f32_16x16x32_bf16 a[80:83], v[240:243], v[160:163], a[80:83]
v_mfma_f32_16x16x32_bf16 a[80:83], v[244:247], v[164:167], a[80:83]
buffer_load_dword v126, v125, s[20:23], s80 offen
v_mfma_f32_16x16x32_bf16 a[84:87], v[244:247], v[172:175], a[84:87]
v_mfma_f32_16x16x32_bf16 a[84:87], v[240:243], v[168:171], a[84:87]
ds_read_b64_tr_b16 v[230:231], v20 offset:25600
v_mfma_f32_16x16x32_bf16 a[88:91], v[240:243], v[176:179], a[88:91]
v_mfma_f32_16x16x32_bf16 a[88:91], v[244:247], v[180:183], a[88:91]
s_add_u32 m0, s63, 135168
v_mfma_f32_16x16x32_bf16 a[92:95], v[244:247], v[188:191], a[92:95]
s_add_u32 s80, s82, 0
buffer_load_dwordx4 v26, s[32:35], s80 offen nt lds
v_mfma_f32_16x16x32_bf16 a[92:95], v[240:243], v[184:187], a[92:95]
s_waitcnt lgkmcnt(4)
v_mfma_f32_16x16x32_bf16 a[124:127], v[248:251], v[184:187], a[124:127]
ds_read_b64_tr_b16 v[232:233], v21 offset:16384
v_mfma_f32_16x16x32_bf16 a[124:127], v[252:255], v[188:191], a[124:127]
v_mfma_f32_16x16x32_bf16 a[120:123], v[252:255], v[180:183], a[120:123]
s_add_u32 s80, s82, 15360
buffer_load_dwordx4 v26, s[32:35], s80 offen offset:1024 nt lds
v_mfma_f32_16x16x32_bf16 a[120:123], v[248:251], v[176:179], a[120:123]
ds_read_b64_tr_b16 v[234:235], v21 offset:17408
v_mfma_f32_16x16x32_bf16 a[116:119], v[248:251], v[168:171], a[116:119]
v_mfma_f32_16x16x32_bf16 a[116:119], v[252:255], v[172:175], a[116:119]
v_mfma_f32_16x16x32_bf16 a[112:115], v[252:255], v[164:167], a[112:115]
s_add_u32 s80, s82, 30720
buffer_load_dwordx4 v26, s[32:35], s80 offen offset:2048 nt lds
v_mfma_f32_16x16x32_bf16 a[112:115], v[248:251], v[160:163], a[112:115]
ds_read_b64_tr_b16 v[236:237], v21 offset:24576
v_mfma_f32_16x16x32_bf16 a[108:111], v[248:251], v[152:155], a[108:111]
v_mfma_f32_16x16x32_bf16 a[108:111], v[252:255], v[156:159], a[108:111]
v_mfma_f32_16x16x32_bf16 a[104:107], v[252:255], v[148:151], a[104:107]
s_add_u32 s80, s82, 46080
buffer_load_dwordx4 v26, s[32:35], s80 offen offset:3072 nt lds
v_mfma_f32_16x16x32_bf16 a[104:107], v[248:251], v[144:147], a[104:107]
ds_read_b64_tr_b16 v[238:239], v21 offset:25600
v_mfma_f32_16x16x32_bf16 a[100:103], v[248:251], v[136:139], a[100:103]
v_mfma_f32_16x16x32_bf16 a[100:103], v[252:255], v[140:143], a[100:103]
v_mfma_f32_16x16x32_bf16 a[96:99], v[252:255], v[132:135], a[96:99]
v_mfma_f32_16x16x32_bf16 a[96:99], v[248:251], v[128:131], a[96:99]
s_waitcnt lgkmcnt(4)
v_mfma_f32_16x16x32_bf16 a[128:131], v[128:131], v[224:227], a[128:131]
ds_read_b64_tr_b16 v[240:241], v22 offset:16384
v_mfma_f32_16x16x32_bf16 a[128:131], v[132:135], v[228:231], a[128:131]
v_mfma_f32_16x16x32_bf16 a[132:135], v[140:143], v[228:231], a[132:135]
v_mfma_f32_16x16x32_bf16 a[132:135], v[136:139], v[224:227], a[132:135]
ds_read_b64_tr_b16 v[242:243], v22 offset:17408
v_mfma_f32_16x16x32_bf16 a[136:139], v[144:147], v[224:227], a[136:139]
v_mfma_f32_16x16x32_bf16 a[136:139], v[148:151], v[228:231], a[136:139]
v_mfma_f32_16x16x32_bf16 a[140:143], v[156:159], v[228:231], a[140:143]
v_mfma_f32_16x16x32_bf16 a[140:143], v[152:155], v[224:227], a[140:143]
ds_read_b64_tr_b16 v[244:245], v22 offset:24576
v_mfma_f32_16x16x32_bf16 a[144:147], v[160:163], v[224:227], a[144:147]
v_mfma_f32_16x16x32_bf16 a[144:147], v[164:167], v[228:231], a[144:147]
v_mfma_f32_16x16x32_bf16 a[148:151], v[172:175], v[228:231], a[148:151]
ds_read_b64_tr_b16 v[246:247], v22 offset:25600
v_mfma_f32_16x16x32_bf16 a[148:151], v[168:171], v[224:227], a[148:151]
v_mfma_f32_16x16x32_bf16 a[152:155], v[176:179], v[224:227], a[152:155]
v_mfma_f32_16x16x32_bf16 a[152:155], v[180:183], v[228:231], a[152:155]
v_mfma_f32_16x16x32_bf16 a[156:159], v[188:191], v[228:231], a[156:159]
v_mfma_f32_16x16x32_bf16 a[156:159], v[184:187], v[224:227], a[156:159]
s_waitcnt lgkmcnt(4)
v_mfma_f32_16x16x32_bf16 a[188:191], v[184:187], v[232:235], a[188:191]
ds_read_b64_tr_b16 v[248:249], v23 offset:16384
v_mfma_f32_16x16x32_bf16 a[188:191], v[188:191], v[236:239], a[188:191]
v_mfma_f32_16x16x32_bf16 a[184:187], v[180:183], v[236:239], a[184:187]
ds_read_b64_tr_b16 v[250:251], v23 offset:17408
v_mfma_f32_16x16x32_bf16 a[184:187], v[176:179], v[232:235], a[184:187]
v_mfma_f32_16x16x32_bf16 a[180:183], v[168:171], v[232:235], a[180:183]
ds_read_b64_tr_b16 v[252:253], v23 offset:24576
v_mfma_f32_16x16x32_bf16 a[180:183], v[172:175], v[236:239], a[180:183]
v_mfma_f32_16x16x32_bf16 a[176:179], v[164:167], v[236:239], a[176:179]
ds_read_b64_tr_b16 v[254:255], v23 offset:25600
v_mfma_f32_16x16x32_bf16 a[176:179], v[160:163], v[232:235], a[176:179]
v_mfma_f32_16x16x32_bf16 a[172:175], v[152:155], v[232:235], a[172:175]
s_xor_b32 s73, s61, 4
v_mfma_f32_16x16x32_bf16 a[172:175], v[156:159], v[236:239], a[172:175]
s_lshl_b32 s69, s73, 7
v_mfma_f32_16x16x32_bf16 a[168:171], v[148:151], v[236:239], a[168:171]
s_add_u32 s69, s69, s84
v_mfma_f32_16x16x32_bf16 a[168:171], v[144:147], v[232:235], a[168:171]
s_lshl_b32 s71, s73, 19
v_mfma_f32_16x16x32_bf16 a[164:167], v[136:139], v[232:235], a[164:167]
s_add_u32 s71, s71, s66
v_mfma_f32_16x16x32_bf16 a[164:167], v[140:143], v[236:239], a[164:167]
s_add_u32 m0, s63, 65536
v_mfma_f32_16x16x32_bf16 a[160:163], v[132:135], v[236:239], a[160:163]
s_waitcnt vmcnt(6) lgkmcnt(0)
v_mfma_f32_16x16x32_bf16 a[160:163], v[128:131], v[232:235], a[160:163]
s_barrier
v_mfma_f32_16x16x32_bf16 a[192:195], v[128:131], v[240:243], a[192:195]
s_add_u32 s72, s69, 0
buffer_load_dwordx4 v2, s[8:11], s72 offen lds
v_mfma_f32_16x16x32_bf16 a[192:195], v[132:135], v[244:247], a[192:195]
ds_read_b64_tr_b16 v[224:225], v20 offset:32768
v_mfma_f32_16x16x32_bf16 a[196:199], v[140:143], v[244:247], a[196:199]
ds_read_b64_tr_b16 v[226:227], v20 offset:33792
v_mfma_f32_16x16x32_bf16 a[196:199], v[136:139], v[240:243], a[196:199]
ds_read_b64_tr_b16 v[228:229], v20 offset:40960
v_mfma_f32_16x16x32_bf16 a[200:203], v[144:147], v[240:243], a[200:203]
s_add_u32 s72, s69, 7168
buffer_load_dwordx4 v3, s[8:11], s72 offen offset:1024 lds
v_mfma_f32_16x16x32_bf16 a[200:203], v[148:151], v[244:247], a[200:203]
ds_read_b64_tr_b16 v[230:231], v20 offset:41984
v_mfma_f32_16x16x32_bf16 a[204:207], v[156:159], v[244:247], a[204:207]
ds_read_b128 v[192:195], v24 offset:32768
v_mfma_f32_16x16x32_bf16 a[204:207], v[152:155], v[240:243], a[204:207]
ds_read_b128 v[196:199], v25 offset:32768
v_mfma_f32_16x16x32_bf16 a[208:211], v[160:163], v[240:243], a[208:211]
s_add_u32 s72, s69, 14336
buffer_load_dwordx4 v2, s[8:11], s72 offen offset:2048 lds
v_mfma_f32_16x16x32_bf16 a[208:211], v[164:167], v[244:247], a[208:211]
ds_read_b128 v[200:203], v24 offset:34816
v_mfma_f32_16x16x32_bf16 a[212:215], v[172:175], v[244:247], a[212:215]
ds_read_b128 v[204:207], v25 offset:34816
v_mfma_f32_16x16x32_bf16 a[212:215], v[168:171], v[240:243], a[212:215]
ds_read_b128 v[208:211], v24 offset:36864
v_mfma_f32_16x16x32_bf16 a[216:219], v[176:179], v[240:243], a[216:219]
s_add_u32 s72, s69, 21504
buffer_load_dwordx4 v3, s[8:11], s72 offen offset:3072 lds
v_mfma_f32_16x16x32_bf16 a[216:219], v[180:183], v[244:247], a[216:219]
Lstuba1:
s_cbranch_execz Lreta
ds_read_b128 v[212:215], v25 offset:36864
v_mfma_f32_16x16x32_bf16 a[220:223], v[188:191], v[244:247], a[220:223]
ds_read_b128 v[216:219], v24 offset:38912
v_mfma_f32_16x16x32_bf16 a[220:223], v[184:187], v[240:243], a[220:223]
ds_read_b128 v[220:223], v25 offset:38912
v_mfma_f32_16x16x32_bf16 a[252:255], v[184:187], v[248:251], a[252:255]
s_add_u32 m0, s64, 0
v_mfma_f32_16x16x32_bf16 a[252:255], v[188:191], v[252:255], a[252:255]
s_add_u32 s72, s71, 0
buffer_load_dwordx4 v6, s[16:19], s72 offen lds
v_mfma_f32_16x16x32_bf16 a[248:251], v[180:183], v[252:255], a[248:251]
ds_read_b128 v[184:187], v24 offset:40960
v_mfma_f32_16x16x32_bf16 a[248:251], v[176:179], v[248:251], a[248:251]
ds_read_b128 v[188:191], v25 offset:40960
v_mfma_f32_16x16x32_bf16 a[244:247], v[168:171], v[248:251], a[244:247]
v_mfma_f32_16x16x32_bf16 a[244:247], v[172:175], v[252:255], a[244:247]
s_add_u32 s72, s71, 31744
buffer_load_dwordx4 v6, s[16:19], s72 offen offset:1024 lds
v_mfma_f32_16x16x32_bf16 a[240:243], v[164:167], v[252:255], a[240:243]
ds_read_b128 v[176:179], v24 offset:43008
v_mfma_f32_16x16x32_bf16 a[240:243], v[160:163], v[248:251], a[240:243]
ds_read_b128 v[180:183], v25 offset:43008
v_mfma_f32_16x16x32_bf16 a[236:239], v[152:155], v[248:251], a[236:239]
ds_read_b128 v[168:171], v24 offset:45056
v_mfma_f32_16x16x32_bf16 a[236:239], v[156:159], v[252:255], a[236:239]
s_add_u32 s72, s71, 63488
buffer_load_dwordx4 v7, s[16:19], s72 offen offset:2048 lds
v_mfma_f32_16x16x32_bf16 a[232:235], v[148:151], v[252:255], a[232:235]
ds_read_b128 v[172:175], v25 offset:45056
v_mfma_f32_16x16x32_bf16 a[232:235], v[144:147], v[248:251], a[232:235]
ds_read_b128 v[160:163], v24 offset:47104
v_mfma_f32_16x16x32_bf16 a[228:231], v[136:139], v[248:251], a[228:231]
ds_read_b128 v[164:167], v25 offset:47104
v_mfma_f32_16x16x32_bf16 a[228:231], v[140:143], v[252:255], a[228:231]
s_add_u32 s72, s71, 95232
buffer_load_dwordx4 v7, s[16:19], s72 offen offset:3072 lds
v_mfma_f32_16x16x32_bf16 a[224:227], v[132:135], v[252:255], a[224:227]
ds_read_b64_tr_b16 v[232:233], v21 offset:32768
v_mfma_f32_16x16x32_bf16 a[224:227], v[128:131], v[248:251], a[224:227]
s_waitcnt lgkmcnt(9)
ds_read_b64_tr_b16 v[234:235], v21 offset:33792
v_mfma_f32_16x16x32_bf16 a[0:3], v[224:227], v[192:195], a[0:3]
ds_read_b64_tr_b16 v[240:241], v22 offset:32768
v_mfma_f32_16x16x32_bf16 a[0:3], v[228:231], v[196:199], a[0:3]
s_add_u32 m0, s63, 69632
ds_read_b64_tr_b16 v[236:237], v21 offset:40960
v_mfma_f32_16x16x32_bf16 a[4:7], v[228:231], v[204:207], a[4:7]
s_add_u32 s72, s69, 32768
buffer_load_dwordx4 v2, s[8:11], s72 offen lds
v_mfma_f32_16x16x32_bf16 a[4:7], v[224:227], v[200:203], a[4:7]
v_mfma_f32_16x16x32_bf16 a[8:11], v[224:227], v[208:211], a[8:11]
ds_read_b64_tr_b16 v[238:239], v21 offset:41984
v_mfma_f32_16x16x32_bf16 a[8:11], v[228:231], v[212:215], a[8:11]
ds_read_b64_tr_b16 v[242:243], v22 offset:33792
v_mfma_f32_16x16x32_bf16 a[12:15], v[228:231], v[220:223], a[12:15]
s_add_u32 s72, s69, 39936
buffer_load_dwordx4 v3, s[8:11], s72 offen offset:1024 lds
v_mfma_f32_16x16x32_bf16 a[12:15], v[224:227], v[216:219], a[12:15]
s_waitcnt lgkmcnt(6)
v_mfma_f32_16x16x32_bf16 a[16:19], v[224:227], v[184:187], a[16:19]
ds_read_b64_tr_b16 v[244:245], v22 offset:40960
v_mfma_f32_16x16x32_bf16 a[16:19], v[228:231], v[188:191], a[16:19]
v_mfma_f32_16x16x32_bf16 a[20:23], v[228:231], v[180:183], a[20:23]
s_add_u32 s72, s69, 47104
buffer_load_dwordx4 v2, s[8:11], s72 offen offset:2048 lds
v_mfma_f32_16x16x32_bf16 a[20:23], v[224:227], v[176:179], a[20:23]
ds_read_b64_tr_b16 v[246:247], v22 offset:41984
v_mfma_f32_16x16x32_bf16 a[24:27], v[224:227], v[168:171], a[24:27]
v_mfma_f32_16x16x32_bf16 a[24:27], v[228:231], v[172:175], a[24:27]
v_mfma_f32_16x16x32_bf16 a[28:31], v[228:231], v[164:167], a[28:31]
s_add_u32 s72, s69, 54272
buffer_load_dwordx4 v3, s[8:11], s72 offen offset:3072 lds
v_mfma_f32_16x16x32_bf16 a[28:31], v[224:227], v[160:163], a[28:31]
s_waitcnt lgkmcnt(3)
v_mfma_f32_16x16x32_bf16 a[60:63], v[232:235], v[160:163], a[60:63]
ds_read_b64_tr_b16 v[248:249], v23 offset:32768
v_mfma_f32_16x16x32_bf16 a[60:63], v[236:239], v[164:167], a[60:63]
v_mfma_f32_16x16x32_bf16 a[56:59], v[236:239], v[172:175], a[56:59]
s_add_u32 m0, s64, 16384
ds_read_b64_tr_b16 v[250:251], v23 offset:33792
v_mfma_f32_16x16x32_bf16 a[56:59], v[232:235], v[168:171], a[56:59]
s_add_u32 s72, s71, 0
buffer_load_dwordx4 v6, s[20:23], s72 offen lds
v_mfma_f32_16x16x32_bf16 a[52:55], v[232:235], v[176:179], a[52:55]
v_mfma_f32_16x16x32_bf16 a[52:55], v[236:239], v[180:183], a[52:55]
v_mfma_f32_16x16x32_bf16 a[48:51], v[236:239], v[188:191], a[48:51]
ds_read_b64_tr_b16 v[252:253], v23 offset:40960
v_mfma_f32_16x16x32_bf16 a[48:51], v[232:235], v[184:187], a[48:51]
s_add_u32 s72, s71, 31744
buffer_load_dwordx4 v6, s[20:23], s72 offen offset:1024 lds
v_mfma_f32_16x16x32_bf16 a[44:47], v[232:235], v[216:219], a[44:47]
v_mfma_f32_16x16x32_bf16 a[44:47], v[236:239], v[220:223], a[44:47]
v_mfma_f32_16x16x32_bf16 a[40:43], v[236:239], v[212:215], a[40:43]
ds_read_b64_tr_b16 v[254:255], v23 offset:41984
v_mfma_f32_16x16x32_bf16 a[40:43], v[232:235], v[208:211], a[40:43]
s_add_u32 s72, s71, 63488
buffer_load_dwordx4 v7, s[20:23], s72 offen offset:2048 lds
v_mfma_f32_16x16x32_bf16 a[36:39], v[232:235], v[200:203], a[36:39]
v_mfma_f32_16x16x32_bf16 a[36:39], v[236:239], v[204:207], a[36:39]
v_mfma_f32_16x16x32_bf16 a[32:35], v[236:239], v[196:199], a[32:35]
s_add_u32 s72, s71, 95232
v_mfma_f32_16x16x32_bf16 a[32:35], v[232:235], v[192:195], a[32:35]
s_waitcnt lgkmcnt(4)
buffer_load_dwordx4 v7, s[20:23], s72 offen offset:3072 lds
v_mfma_f32_16x16x32_bf16 a[64:67], v[240:243], v[192:195], a[64:67]
ds_read_b64_tr_b16 v[224:225], v20 offset:49152
v_mfma_f32_16x16x32_bf16 a[64:67], v[244:247], v[196:199], a[64:67]
v_mfma_f32_16x16x32_bf16 a[68:71], v[244:247], v[204:207], a[68:71]
ds_read_b64_tr_b16 v[226:227], v20 offset:50176
v_mfma_f32_16x16x32_bf16 a[68:71], v[240:243], v[200:203], a[68:71]
buffer_load_dwordx4 v[108:111], v1, s[4:7], s76 offen
v_mfma_f32_16x16x32_bf16 a[72:75], v[240:243], v[208:211], a[72:75]
v_mfma_f32_16x16x32_bf16 a[72:75], v[244:247], v[212:215], a[72:75]
v_mfma_f32_16x16x32_bf16 a[76:79], v[244:247], v[220:223], a[76:79]
ds_read_b64_tr_b16 v[228:229], v20 offset:57344
v_mfma_f32_16x16x32_bf16 a[76:79], v[240:243], v[216:219], a[76:79]
buffer_load_dwordx4 v[112:115], v1, s[4:7], s76 offen offset:1024
v_mfma_f32_16x16x32_bf16 a[80:83], v[240:243], v[184:187], a[80:83]
v_mfma_f32_16x16x32_bf16 a[80:83], v[244:247], v[188:191], a[80:83]
v_mfma_f32_16x16x32_bf16 a[84:87], v[244:247], v[180:183], a[84:87]
ds_read_b64_tr_b16 v[230:231], v20 offset:58368
v_mfma_f32_16x16x32_bf16 a[84:87], v[240:243], v[176:179], a[84:87]
buffer_load_dwordx4 v[116:119], v1, s[4:7], s76 offen offset:2048
v_mfma_f32_16x16x32_bf16 a[88:91], v[240:243], v[168:171], a[88:91]
v_mfma_f32_16x16x32_bf16 a[88:91], v[244:247], v[172:175], a[88:91]
v_mfma_f32_16x16x32_bf16 a[92:95], v[244:247], v[164:167], a[92:95]
v_mfma_f32_16x16x32_bf16 a[92:95], v[240:243], v[160:163], a[92:95]
s_waitcnt lgkmcnt(4)
buffer_load_dwordx4 v[120:123], v1, s[4:7], s76 offen offset:3072
v_mfma_f32_16x16x32_bf16 a[124:127], v[248:251], v[160:163], a[124:127]
ds_read_b64_tr_b16 v[232:233], v21 offset:49152
v_mfma_f32_16x16x32_bf16 a[124:127], v[252:255], v[164:167], a[124:127]
v_mfma_f32_16x16x32_bf16 a[120:123], v[252:255], v[172:175], a[120:123]
v_mfma_f32_16x16x32_bf16 a[120:123], v[248:251], v[168:171], a[120:123]
ds_read_b64_tr_b16 v[234:235], v21 offset:50176
v_mfma_f32_16x16x32_bf16 a[116:119], v[248:251], v[176:179], a[116:119]
s_waitcnt vmcnt(20)
ds_read2_b32 v[36:37], v98 offset0:0 offset1:32
ds_read2_b32 v[38:39], v98 offset0:64 offset1:96
v_mfma_f32_16x16x32_bf16 a[116:119], v[252:255], v[180:183], a[116:119]
ds_read2_b32 v[40:41], v98 offset0:128 offset1:160
ds_read2_b32 v[42:43], v98 offset0:192 offset1:224
v_mfma_f32_16x16x32_bf16 a[112:115], v[252:255], v[188:191], a[112:115]
v_add_u32 v98, 1024, v98
v_mfma_f32_16x16x32_bf16 a[112:115], v[248:251], v[184:187], a[112:115]
ds_read_b64_tr_b16 v[236:237], v21 offset:57344
ds_read2_b32 v[44:45], v98 offset0:0 offset1:32
v_mfma_f32_16x16x32_bf16 a[108:111], v[248:251], v[216:219], a[108:111]
ds_read2_b32 v[46:47], v98 offset0:64 offset1:96
ds_read2_b32 v[48:49], v98 offset0:128 offset1:160
v_mfma_f32_16x16x32_bf16 a[108:111], v[252:255], v[220:223], a[108:111]
ds_read2_b32 v[50:51], v98 offset0:192 offset1:224
v_add_u32 v98, 3072, v98
v_mfma_f32_16x16x32_bf16 a[104:107], v[252:255], v[212:215], a[104:107]
ds_read_b64_tr_b16 v[238:239], v21 offset:58368
ds_read2_b32 v[52:53], v98 offset0:0 offset1:32
v_mfma_f32_16x16x32_bf16 a[104:107], v[248:251], v[208:211], a[104:107]
ds_read2_b32 v[54:55], v98 offset0:64 offset1:96
ds_read2_b32 v[56:57], v98 offset0:128 offset1:160
v_mfma_f32_16x16x32_bf16 a[100:103], v[248:251], v[200:203], a[100:103]
ds_read2_b32 v[58:59], v98 offset0:192 offset1:224
v_add_u32 v98, 1024, v98
v_mfma_f32_16x16x32_bf16 a[100:103], v[252:255], v[204:207], a[100:103]
ds_read2_b32 v[60:61], v98 offset0:0 offset1:32
ds_read2_b32 v[62:63], v98 offset0:64 offset1:96
v_mfma_f32_16x16x32_bf16 a[96:99], v[252:255], v[196:199], a[96:99]
ds_read2_b32 v[64:65], v98 offset0:128 offset1:160
ds_read2_b32 v[66:67], v98 offset0:192 offset1:224
v_mfma_f32_16x16x32_bf16 a[96:99], v[248:251], v[192:195], a[96:99]
s_waitcnt lgkmcnt(15)
v_mfma_f32_16x16x32_bf16 a[128:131], v[192:195], v[224:227], a[128:131]
ds_read_b64_tr_b16 v[240:241], v22 offset:49152
v_mfma_f32_16x16x32_bf16 a[128:131], v[196:199], v[228:231], a[128:131]
v_mfma_f32_16x16x32_bf16 a[132:135], v[204:207], v[228:231], a[132:135]
v_mfma_f32_16x16x32_bf16 a[132:135], v[200:203], v[224:227], a[132:135]
ds_read_b64_tr_b16 v[242:243], v22 offset:50176
v_mfma_f32_16x16x32_bf16 a[136:139], v[208:211], v[224:227], a[136:139]
v_mfma_f32_16x16x32_bf16 a[136:139], v[212:215], v[228:231], a[136:139]
v_mfma_f32_16x16x32_bf16 a[140:143], v[220:223], v[228:231], a[140:143]
v_mfma_f32_16x16x32_bf16 a[140:143], v[216:219], v[224:227], a[140:143]
ds_read_b64_tr_b16 v[244:245], v22 offset:57344
v_mfma_f32_16x16x32_bf16 a[144:147], v[184:187], v[224:227], a[144:147]
v_mfma_f32_16x16x32_bf16 a[144:147], v[188:191], v[228:231], a[144:147]
v_mfma_f32_16x16x32_bf16 a[148:151], v[180:183], v[228:231], a[148:151]
ds_read_b64_tr_b16 v[246:247], v22 offset:58368
v_mfma_f32_16x16x32_bf16 a[148:151], v[176:179], v[224:227], a[148:151]
v_mfma_f32_16x16x32_bf16 a[152:155], v[168:171], v[224:227], a[152:155]
v_mfma_f32_16x16x32_bf16 a[152:155], v[172:175], v[228:231], a[152:155]
v_mfma_f32_16x16x32_bf16 a[156:159], v[164:167], v[228:231], a[156:159]
v_mfma_f32_16x16x32_bf16 a[156:159], v[160:163], v[224:227], a[156:159]
s_waitcnt lgkmcnt(12)
v_mfma_f32_16x16x32_bf16 a[188:191], v[160:163], v[232:235], a[188:191]
ds_read_b64_tr_b16 v[248:249], v23 offset:49152
v_mfma_f32_16x16x32_bf16 a[188:191], v[164:167], v[236:239], a[188:191]
v_mfma_f32_16x16x32_bf16 a[184:187], v[172:175], v[236:239], a[184:187]
ds_read_b64_tr_b16 v[250:251], v23 offset:50176
v_mfma_f32_16x16x32_bf16 a[184:187], v[168:171], v[232:235], a[184:187]
v_mfma_f32_16x16x32_bf16 a[180:183], v[176:179], v[232:235], a[180:183]
ds_read_b64_tr_b16 v[252:253], v23 offset:57344
v_mfma_f32_16x16x32_bf16 a[180:183], v[180:183], v[236:239], a[180:183]
v_mfma_f32_16x16x32_bf16 a[176:179], v[188:191], v[236:239], a[176:179]
ds_read_b64_tr_b16 v[254:255], v23 offset:58368
v_mfma_f32_16x16x32_bf16 a[176:179], v[184:187], v[232:235], a[176:179]
v_mfma_f32_16x16x32_bf16 a[172:175], v[216:219], v[232:235], a[172:175]
s_xor_b32 s73, s61, 5
v_mfma_f32_16x16x32_bf16 a[172:175], v[220:223], v[236:239], a[172:175]
s_lshl_b32 s69, s73, 7
v_mfma_f32_16x16x32_bf16 a[168:171], v[212:215], v[236:239], a[168:171]
s_add_u32 s69, s69, s84
v_mfma_f32_16x16x32_bf16 a[168:171], v[208:211], v[232:235], a[168:171]
s_lshl_b32 s71, s73, 19
v_mfma_f32_16x16x32_bf16 a[164:167], v[200:203], v[232:235], a[164:167]
s_add_u32 s71, s71, s66
v_mfma_f32_16x16x32_bf16 a[164:167], v[204:207], v[236:239], a[164:167]
s_add_u32 m0, s63, 98304
v_mfma_f32_16x16x32_bf16 a[160:163], v[196:199], v[236:239], a[160:163]
s_waitcnt vmcnt(4) lgkmcnt(0)
v_mfma_f32_16x16x32_bf16 a[160:163], v[192:195], v[232:235], a[160:163]
s_barrier
v_mfma_f32_16x16x32_bf16 a[192:195], v[192:195], v[240:243], a[192:195]
s_add_u32 s72, s69, 0
buffer_load_dwordx4 v2, s[8:11], s72 offen lds
v_mfma_f32_16x16x32_bf16 a[192:195], v[196:199], v[244:247], a[192:195]
ds_read_b64_tr_b16 v[224:225], v20 offset:0
v_lshlrev_b32 v72, 16, v68
v_mfma_f32_16x16x32_bf16 a[196:199], v[204:207], v[244:247], a[196:199]
ds_read_b64_tr_b16 v[226:227], v20 offset:1024
v_and_b32 v73, 0xffff0000, v68
v_mfma_f32_16x16x32_bf16 a[196:199], v[200:203], v[240:243], a[196:199]
ds_read_b64_tr_b16 v[228:229], v20 offset:8192
v_lshlrev_b32 v74, 16, v69
v_mfma_f32_16x16x32_bf16 a[200:203], v[208:211], v[240:243], a[200:203]
s_add_u32 s72, s69, 7168
buffer_load_dwordx4 v3, s[8:11], s72 offen offset:1024 lds
v_mfma_f32_16x16x32_bf16 a[200:203], v[212:215], v[244:247], a[200:203]
ds_read_b64_tr_b16 v[230:231], v20 offset:9216
v_and_b32 v75, 0xffff0000, v69
v_mfma_f32_16x16x32_bf16 a[204:207], v[220:223], v[244:247], a[204:207]
ds_read_b128 v[128:131], v24 offset:0
v_lshlrev_b32 v76, 16, v33
v_mfma_f32_16x16x32_bf16 a[204:207], v[216:219], v[240:243], a[204:207]
ds_read_b128 v[132:135], v25 offset:0
v_lshlrev_b32 v77, 16, v34
v_mfma_f32_16x16x32_bf16 a[208:211], v[184:187], v[240:243], a[208:211]
s_add_u32 s72, s69, 14336
buffer_load_dwordx4 v2, s[8:11], s72 offen offset:2048 lds
v_mfma_f32_16x16x32_bf16 a[208:211], v[188:191], v[244:247], a[208:211]
ds_read_b128 v[136:139], v24 offset:2048
v_lshlrev_b32 v78, 16, v35
v_mfma_f32_16x16x32_bf16 a[212:215], v[180:183], v[244:247], a[212:215]
ds_read_b128 v[140:143], v25 offset:2048
v_lshlrev_b32 v79, 16, v36
v_mfma_f32_16x16x32_bf16 a[212:215], v[176:179], v[240:243], a[212:215]
ds_read_b128 v[144:147], v24 offset:4096
v_lshlrev_b32 v80, 16, v37
v_mfma_f32_16x16x32_bf16 a[216:219], v[168:171], v[240:243], a[216:219]
s_add_u32 s72, s69, 21504
buffer_load_dwordx4 v3, s[8:11], s72 offen offset:3072 lds
v_mfma_f32_16x16x32_bf16 a[216:219], v[172:175], v[244:247], a[216:219]
ds_read_b128 v[148:151], v25 offset:4096
v_lshlrev_b32 v81, 16, v38
v_mfma_f32_16x16x32_bf16 a[220:223], v[164:167], v[244:247], a[220:223]
ds_read_b128 v[152:155], v24 offset:6144
v_lshlrev_b32 v82, 16, v39
v_mfma_f32_16x16x32_bf16 a[220:223], v[160:163], v[240:243], a[220:223]
ds_read_b128 v[156:159], v25 offset:6144
v_lshlrev_b32 v83, 16, v40
v_mfma_f32_16x16x32_bf16 a[252:255], v[160:163], v[248:251], a[252:255]
s_add_u32 m0, s64, 32768
v_lshlrev_b32 v84, 16, v41
v_lshlrev_b32 v85, 16, v42
v_mfma_f32_16x16x32_bf16 a[252:255], v[164:167], v[252:255], a[252:255]
s_add_u32 s72, s71, 0
buffer_load_dwordx4 v6, s[16:19], s72 offen lds
v_mfma_f32_16x16x32_bf16 a[248:251], v[172:175], v[252:255], a[248:251]
ds_read_b128 v[160:163], v24 offset:8192
v_lshlrev_b32 v86, 16, v43
v_mfma_f32_16x16x32_bf16 a[248:251], v[168:171], v[248:251], a[248:251]
ds_read_b128 v[164:167], v25 offset:8192
v_lshlrev_b32 v87, 16, v44
v_mfma_f32_16x16x32_bf16 a[244:247], v[176:179], v[248:251], a[244:247]
v_lshlrev_b32 v88, 16, v45
v_lshlrev_b32 v89, 16, v46
v_mfma_f32_16x16x32_bf16 a[244:247], v[180:183], v[252:255], a[244:247]
s_add_u32 s72, s71, 31744
buffer_load_dwordx4 v6, s[16:19], s72 offen offset:1024 lds
v_mfma_f32_16x16x32_bf16 a[240:243], v[188:191], v[252:255], a[240:243]
ds_read_b128 v[168:171], v24 offset:10240
v_lshlrev_b32 v90, 16, v47
v_mfma_f32_16x16x32_bf16 a[240:243], v[184:187], v[248:251], a[240:243]
ds_read_b128 v[172:175], v25 offset:10240
v_lshlrev_b32 v91, 16, v48
v_mfma_f32_16x16x32_bf16 a[236:239], v[216:219], v[248:251], a[236:239]
ds_read_b128 v[176:179], v24 offset:12288
v_lshlrev_b32 v92, 16, v49
v_mfma_f32_16x16x32_bf16 a[236:239], v[220:223], v[252:255], a[236:239]
s_add_u32 s72, s71, 63488
buffer_load_dwordx4 v7, s[16:19], s72 offen offset:2048 lds
v_mfma_f32_16x16x32_bf16 a[232:235], v[212:215], v[252:255], a[232:235]
ds_read_b128 v[180:183], v25 offset:12288
v_lshlrev_b32 v93, 16, v50
v_mfma_f32_16x16x32_bf16 a[232:235], v[208:211], v[248:251], a[232:235]
ds_read_b128 v[184:187], v24 offset:14336
v_lshlrev_b32 v94, 16, v51
v_mfma_f32_16x16x32_bf16 a[228:231], v[200:203], v[248:251], a[228:231]
ds_read_b128 v[188:191], v25 offset:14336
v_mul_f32 v95, v75, v91
v_mfma_f32_16x16x32_bf16 a[228:231], v[204:207], v[252:255], a[228:231]
s_add_u32 s72, s71, 95232
buffer_load_dwordx4 v7, s[16:19], s72 offen offset:3072 lds
v_mfma_f32_16x16x32_bf16 a[224:227], v[196:199], v[252:255], a[224:227]
ds_read_b64_tr_b16 v[232:233], v21 offset:0
v_lshlrev_b32 v97, 16, v67
v_mfma_f32_16x16x32_bf16 a[224:227], v[192:195], v[248:251], a[224:227]
s_waitcnt lgkmcnt(9)
ds_read_b64_tr_b16 v[234:235], v21 offset:1024
v_fmac_f32 v95, v74, v92
v_mfma_f32_16x16x32_bf16 a[0:3], v[224:227], v[128:131], a[0:3]
ds_read_b64_tr_b16 v[240:241], v22 offset:0
v_fmac_f32 v95, v73, v93
v_mfma_f32_16x16x32_bf16 a[0:3], v[228:231], v[132:135], a[0:3]
s_add_u32 m0, s63, 102400
ds_read_b64_tr_b16 v[236:237], v21 offset:8192
v_fmac_f32 v95, v72, v94
v_mfma_f32_16x16x32_bf16 a[4:7], v[228:231], v[140:143], a[4:7]
s_add_u32 s72, s69, 32768
buffer_load_dwordx4 v2, s[8:11], s72 offen lds
v_mfma_f32_16x16x32_bf16 a[4:7], v[224:227], v[136:139], a[4:7]
v_mul_f32 v95, v95, v97
v_mul_f32 v96, v75, v90
v_mfma_f32_16x16x32_bf16 a[8:11], v[224:227], v[144:147], a[8:11]
ds_read_b64_tr_b16 v[238:239], v21 offset:9216
v_lshlrev_b32 v97, 16, v66
v_mfma_f32_16x16x32_bf16 a[8:11], v[228:231], v[148:151], a[8:11]
ds_read_b64_tr_b16 v[242:243], v22 offset:1024
v_fmac_f32 v96, v74, v91
v_mfma_f32_16x16x32_bf16 a[12:15], v[228:231], v[156:159], a[12:15]
s_add_u32 s72, s69, 39936
buffer_load_dwordx4 v3, s[8:11], s72 offen offset:1024 lds
v_mfma_f32_16x16x32_bf16 a[12:15], v[224:227], v[152:155], a[12:15]
s_waitcnt lgkmcnt(6)
v_fmac_f32 v96, v73, v92
v_fmac_f32 v96, v72, v93
v_mfma_f32_16x16x32_bf16 a[16:19], v[224:227], v[160:163], a[16:19]
ds_read_b64_tr_b16 v[244:245], v22 offset:8192
v_mul_f32 v96, v96, v97
v_mfma_f32_16x16x32_bf16 a[16:19], v[228:231], v[164:167], a[16:19]
v_cvt_pk_bf16_f32 v100, v95, v96
v_mul_f32 v95, v75, v89
v_mfma_f32_16x16x32_bf16 a[20:23], v[228:231], v[172:175], a[20:23]
s_add_u32 s72, s69, 47104
buffer_load_dwordx4 v2, s[8:11], s72 offen offset:2048 lds
v_mfma_f32_16x16x32_bf16 a[20:23], v[224:227], v[168:171], a[20:23]
ds_read_b64_tr_b16 v[246:247], v22 offset:9216
v_lshlrev_b32 v97, 16, v65
v_mfma_f32_16x16x32_bf16 a[24:27], v[224:227], v[176:179], a[24:27]
v_fmac_f32 v95, v74, v90
v_fmac_f32 v95, v73, v91
v_mfma_f32_16x16x32_bf16 a[24:27], v[228:231], v[180:183], a[24:27]
v_fmac_f32 v95, v72, v92
v_mul_f32 v95, v95, v97
v_mfma_f32_16x16x32_bf16 a[28:31], v[228:231], v[188:191], a[28:31]
s_add_u32 s72, s69, 54272
buffer_load_dwordx4 v3, s[8:11], s72 offen offset:3072 lds
v_mfma_f32_16x16x32_bf16 a[28:31], v[224:227], v[184:187], a[28:31]
s_waitcnt lgkmcnt(3)
v_mul_f32 v96, v75, v88
v_lshlrev_b32 v97, 16, v64
v_mfma_f32_16x16x32_bf16 a[60:63], v[232:235], v[184:187], a[60:63]
ds_read_b64_tr_b16 v[248:249], v23 offset:0
v_fmac_f32 v96, v74, v89
v_mfma_f32_16x16x32_bf16 a[60:63], v[236:239], v[188:191], a[60:63]
v_fmac_f32 v96, v73, v90
v_fmac_f32 v96, v72, v91
v_mfma_f32_16x16x32_bf16 a[56:59], v[236:239], v[180:183], a[56:59]
s_add_u32 m0, s64, 49152
ds_read_b64_tr_b16 v[250:251], v23 offset:1024
v_mul_f32 v96, v96, v97
v_mfma_f32_16x16x32_bf16 a[56:59], v[232:235], v[176:179], a[56:59]
s_add_u32 s72, s71, 0
buffer_load_dwordx4 v6, s[20:23], s72 offen lds
v_mfma_f32_16x16x32_bf16 a[52:55], v[232:235], v[168:171], a[52:55]
v_cvt_pk_bf16_f32 v101, v95, v96
v_mul_f32 v95, v75, v87
v_mfma_f32_16x16x32_bf16 a[52:55], v[236:239], v[172:175], a[52:55]
v_lshlrev_b32 v97, 16, v63
v_fmac_f32 v95, v74, v88
v_mfma_f32_16x16x32_bf16 a[48:51], v[236:239], v[164:167], a[48:51]
ds_read_b64_tr_b16 v[252:253], v23 offset:8192
v_fmac_f32 v95, v73, v89
v_mfma_f32_16x16x32_bf16 a[48:51], v[232:235], v[160:163], a[48:51]
s_add_u32 s72, s71, 31744
buffer_load_dwordx4 v6, s[20:23], s72 offen offset:1024 lds
v_mfma_f32_16x16x32_bf16 a[44:47], v[232:235], v[152:155], a[44:47]
v_fmac_f32 v95, v72, v90
v_mul_f32 v95, v95, v97
v_mfma_f32_16x16x32_bf16 a[44:47], v[236:239], v[156:159], a[44:47]
v_mul_f32 v96, v75, v86
v_lshlrev_b32 v97, 16, v62
v_mfma_f32_16x16x32_bf16 a[40:43], v[236:239], v[148:151], a[40:43]
ds_read_b64_tr_b16 v[254:255], v23 offset:9216
v_fmac_f32 v96, v74, v87
v_mfma_f32_16x16x32_bf16 a[40:43], v[232:235], v[144:147], a[40:43]
s_add_u32 s72, s71, 63488
buffer_load_dwordx4 v7, s[20:23], s72 offen offset:2048 lds
v_mfma_f32_16x16x32_bf16 a[36:39], v[232:235], v[136:139], a[36:39]
v_fmac_f32 v96, v73, v88
v_fmac_f32 v96, v72, v89
v_mfma_f32_16x16x32_bf16 a[36:39], v[236:239], v[140:143], a[36:39]
v_mul_f32 v96, v96, v97
v_cvt_pk_bf16_f32 v102, v95, v96
v_mfma_f32_16x16x32_bf16 a[32:35], v[236:239], v[132:135], a[32:35]
s_add_u32 s72, s71, 95232
v_mul_f32 v95, v75, v85
v_lshlrev_b32 v97, 16, v61
v_mfma_f32_16x16x32_bf16 a[32:35], v[232:235], v[128:131], a[32:35]
s_waitcnt lgkmcnt(4)
buffer_load_dwordx4 v7, s[20:23], s72 offen offset:3072 lds
v_mfma_f32_16x16x32_bf16 a[64:67], v[240:243], v[128:131], a[64:67]
ds_read_b64_tr_b16 v[224:225], v20 offset:16384
v_fmac_f32 v95, v74, v86
v_mfma_f32_16x16x32_bf16 a[64:67], v[244:247], v[132:135], a[64:67]
v_fmac_f32 v95, v73, v87
v_fmac_f32 v95, v72, v88
v_mfma_f32_16x16x32_bf16 a[68:71], v[244:247], v[140:143], a[68:71]
ds_read_b64_tr_b16 v[226:227], v20 offset:17408
v_mul_f32 v95, v95, v97
v_mfma_f32_16x16x32_bf16 a[68:71], v[240:243], v[136:139], a[68:71]
s_mov_b32 s80, 0x0
buffer_load_dword v126, v125, s[12:15], s80 offen
v_mfma_f32_16x16x32_bf16 a[72:75], v[240:243], v[144:147], a[72:75]
v_mul_f32 v96, v75, v84
v_lshlrev_b32 v97, 16, v60
v_mfma_f32_16x16x32_bf16 a[72:75], v[244:247], v[148:151], a[72:75]
v_fmac_f32 v96, v74, v85
v_fmac_f32 v96, v73, v86
v_mfma_f32_16x16x32_bf16 a[76:79], v[244:247], v[156:159], a[76:79]
ds_read_b64_tr_b16 v[228:229], v20 offset:24576
v_fmac_f32 v96, v72, v87
v_mfma_f32_16x16x32_bf16 a[76:79], v[240:243], v[152:155], a[76:79]
s_mov_b32 s80, 0x100000
buffer_load_dword v126, v125, s[12:15], s80 offen
v_mfma_f32_16x16x32_bf16 a[80:83], v[240:243], v[160:163], a[80:83]
v_mul_f32 v96, v96, v97
v_cvt_pk_bf16_f32 v103, v95, v96
v_mfma_f32_16x16x32_bf16 a[80:83], v[244:247], v[164:167], a[80:83]
ds_write_b128 v28, v[100:103] offset:0
v_mul_f32 v95, v75, v83
v_mfma_f32_16x16x32_bf16 a[84:87], v[244:247], v[172:175], a[84:87]
ds_read_b64_tr_b16 v[230:231], v20 offset:25600
v_lshlrev_b32 v97, 16, v59
v_mfma_f32_16x16x32_bf16 a[84:87], v[240:243], v[168:171], a[84:87]
s_mov_b32 s80, 0x200000
buffer_load_dword v126, v125, s[12:15], s80 offen
v_mfma_f32_16x16x32_bf16 a[88:91], v[240:243], v[176:179], a[88:91]
v_fmac_f32 v95, v74, v84
v_fmac_f32 v95, v73, v85
v_mfma_f32_16x16x32_bf16 a[88:91], v[244:247], v[180:183], a[88:91]
v_fmac_f32 v95, v72, v86
v_mul_f32 v95, v95, v97
v_mfma_f32_16x16x32_bf16 a[92:95], v[244:247], v[188:191], a[92:95]
v_mul_f32 v96, v75, v82
v_lshlrev_b32 v97, 16, v58
v_mfma_f32_16x16x32_bf16 a[92:95], v[240:243], v[184:187], a[92:95]
s_waitcnt lgkmcnt(5)
v_fmac_f32 v96, v74, v83
v_fmac_f32 v96, v73, v84
v_mfma_f32_16x16x32_bf16 a[124:127], v[248:251], v[184:187], a[124:127]
s_mov_b32 s80, 0x300000
buffer_load_dword v126, v125, s[12:15], s80 offen
v_mfma_f32_16x16x32_bf16 a[124:127], v[252:255], v[188:191], a[124:127]
ds_read_b64_tr_b16 v[232:233], v21 offset:16384
v_fmac_f32 v96, v72, v85
v_mfma_f32_16x16x32_bf16 a[120:123], v[252:255], v[180:183], a[120:123]
v_mul_f32 v96, v96, v97
v_cvt_pk_bf16_f32 v104, v95, v96
v_mfma_f32_16x16x32_bf16 a[120:123], v[248:251], v[176:179], a[120:123]
v_mul_f32 v95, v75, v81
v_lshlrev_b32 v97, 16, v57
v_mfma_f32_16x16x32_bf16 a[116:119], v[248:251], v[168:171], a[116:119]
ds_read_b64_tr_b16 v[234:235], v21 offset:17408
v_fmac_f32 v95, v74, v82
v_mfma_f32_16x16x32_bf16 a[116:119], v[252:255], v[172:175], a[116:119]
v_fmac_f32 v95, v73, v83
v_fmac_f32 v95, v72, v84
v_mfma_f32_16x16x32_bf16 a[112:115], v[252:255], v[164:167], a[112:115]
v_mul_f32 v95, v95, v97
v_mul_f32 v96, v75, v80
v_mfma_f32_16x16x32_bf16 a[112:115], v[248:251], v[160:163], a[112:115]
ds_read_b64_tr_b16 v[236:237], v21 offset:24576
v_lshlrev_b32 v97, 16, v56
v_mfma_f32_16x16x32_bf16 a[108:111], v[248:251], v[152:155], a[108:111]
v_fmac_f32 v96, v74, v81
v_fmac_f32 v96, v73, v82
v_mfma_f32_16x16x32_bf16 a[108:111], v[252:255], v[156:159], a[108:111]
v_fmac_f32 v96, v72, v83
v_mul_f32 v96, v96, v97
v_mfma_f32_16x16x32_bf16 a[104:107], v[252:255], v[148:151], a[104:107]
ds_read_b64_tr_b16 v[238:239], v21 offset:25600
v_cvt_pk_bf16_f32 v105, v95, v96
v_mfma_f32_16x16x32_bf16 a[104:107], v[248:251], v[144:147], a[104:107]
v_mul_f32 v95, v75, v79
v_lshlrev_b32 v97, 16, v55
v_mfma_f32_16x16x32_bf16 a[100:103], v[248:251], v[136:139], a[100:103]
v_fmac_f32 v95, v74, v80
v_fmac_f32 v95, v73, v81
v_mfma_f32_16x16x32_bf16 a[100:103], v[252:255], v[140:143], a[100:103]
v_fmac_f32 v95, v72, v82
v_mul_f32 v95, v95, v97
v_mfma_f32_16x16x32_bf16 a[96:99], v[252:255], v[132:135], a[96:99]
v_mul_f32 v96, v75, v78
v_lshlrev_b32 v97, 16, v54
v_mfma_f32_16x16x32_bf16 a[96:99], v[248:251], v[128:131], a[96:99]
s_waitcnt lgkmcnt(4)
v_fmac_f32 v96, v74, v79
v_fmac_f32 v96, v73, v80
v_mfma_f32_16x16x32_bf16 a[128:131], v[128:131], v[224:227], a[128:131]
ds_read_b64_tr_b16 v[240:241], v22 offset:16384
v_fmac_f32 v96, v72, v81
v_mfma_f32_16x16x32_bf16 a[128:131], v[132:135], v[228:231], a[128:131]
v_mul_f32 v96, v96, v97
v_cvt_pk_bf16_f32 v106, v95, v96
v_mfma_f32_16x16x32_bf16 a[132:135], v[140:143], v[228:231], a[132:135]
v_mul_f32 v95, v75, v77
v_lshlrev_b32 v97, 16, v53
v_mfma_f32_16x16x32_bf16 a[132:135], v[136:139], v[224:227], a[132:135]
ds_read_b64_tr_b16 v[242:243], v22 offset:17408
v_fmac_f32 v95, v74, v78
v_mfma_f32_16x16x32_bf16 a[136:139], v[144:147], v[224:227], a[136:139]
v_fmac_f32 v95, v73, v79
v_fmac_f32 v95, v72, v80
v_mfma_f32_16x16x32_bf16 a[136:139], v[148:151], v[228:231], a[136:139]
v_mul_f32 v95, v95, v97
v_mul_f32 v96, v75, v76
v_mfma_f32_16x16x32_bf16 a[140:143], v[156:159], v[228:231], a[140:143]
v_lshlrev_b32 v97, 16, v52
v_fmac_f32 v96, v74, v77
v_mfma_f32_16x16x32_bf16 a[140:143], v[152:155], v[224:227], a[140:143]
ds_read_b64_tr_b16 v[244:245], v22 offset:24576
v_fmac_f32 v96, v73, v78
v_mfma_f32_16x16x32_bf16 a[144:147], v[160:163], v[224:227], a[144:147]
v_fmac_f32 v96, v72, v79
v_mul_f32 v96, v96, v97
v_mfma_f32_16x16x32_bf16 a[144:147], v[164:167], v[228:231], a[144:147]
v_cvt_pk_bf16_f32 v107, v95, v96
v_mfma_f32_16x16x32_bf16 a[148:151], v[172:175], v[228:231], a[148:151]
ds_read_b64_tr_b16 v[246:247], v22 offset:25600
ds_write_b128 v28, v[104:107] offset:16
v_mfma_f32_16x16x32_bf16 a[148:151], v[168:171], v[224:227], a[148:151]
global_load_dwordx4 v[84:87], v1, s[56:57]
v_mfma_f32_16x16x32_bf16 a[152:155], v[176:179], v[224:227], a[152:155]
global_load_dwordx4 v[88:91], v1, s[56:57] offset:1024
v_mfma_f32_16x16x32_bf16 a[152:155], v[180:183], v[228:231], a[152:155]
v_lshlrev_b32 v72, 16, v70
v_and_b32 v73, 0xffff0000, v70
v_mfma_f32_16x16x32_bf16 a[156:159], v[188:191], v[228:231], a[156:159]
v_lshlrev_b32 v74, 16, v71
v_and_b32 v75, 0xffff0000, v71
v_mfma_f32_16x16x32_bf16 a[156:159], v[184:187], v[224:227], a[156:159]
s_waitcnt lgkmcnt(5)
v_and_b32 v33, 0xffff0000, v33
v_and_b32 v34, 0xffff0000, v34
v_mfma_f32_16x16x32_bf16 a[188:191], v[184:187], v[232:235], a[188:191]
ds_read_b64_tr_b16 v[248:249], v23 offset:16384
v_and_b32 v35, 0xffff0000, v35
v_mfma_f32_16x16x32_bf16 a[188:191], v[188:191], v[236:239], a[188:191]
v_and_b32 v36, 0xffff0000, v36
v_and_b32 v37, 0xffff0000, v37
v_mfma_f32_16x16x32_bf16 a[184:187], v[180:183], v[236:239], a[184:187]
ds_read_b64_tr_b16 v[250:251], v23 offset:17408
v_and_b32 v38, 0xffff0000, v38
v_mfma_f32_16x16x32_bf16 a[184:187], v[176:179], v[232:235], a[184:187]
v_and_b32 v39, 0xffff0000, v39
v_and_b32 v40, 0xffff0000, v40
v_mfma_f32_16x16x32_bf16 a[180:183], v[168:171], v[232:235], a[180:183]
ds_read_b64_tr_b16 v[252:253], v23 offset:24576
v_and_b32 v41, 0xffff0000, v41
v_mfma_f32_16x16x32_bf16 a[180:183], v[172:175], v[236:239], a[180:183]
v_and_b32 v42, 0xffff0000, v42
v_and_b32 v43, 0xffff0000, v43
v_mfma_f32_16x16x32_bf16 a[176:179], v[164:167], v[236:239], a[176:179]
ds_read_b64_tr_b16 v[254:255], v23 offset:25600
v_and_b32 v44, 0xffff0000, v44
v_mfma_f32_16x16x32_bf16 a[176:179], v[160:163], v[232:235], a[176:179]
Lstuba2:
s_cbranch_execz Lreta
v_and_b32 v45, 0xffff0000, v45
v_and_b32 v46, 0xffff0000, v46
v_mfma_f32_16x16x32_bf16 a[172:175], v[152:155], v[232:235], a[172:175]
s_xor_b32 s73, s61, 6
v_and_b32 v47, 0xffff0000, v47
v_and_b32 v48, 0xffff0000, v48
v_mfma_f32_16x16x32_bf16 a[172:175], v[156:159], v[236:239], a[172:175]
s_lshl_b32 s69, s73, 7
v_and_b32 v49, 0xffff0000, v49
v_and_b32 v50, 0xffff0000, v50
v_mfma_f32_16x16x32_bf16 a[168:171], v[148:151], v[236:239], a[168:171]
s_add_u32 s69, s69, s84
v_and_b32 v51, 0xffff0000, v51
v_mul_f32 v95, v75, v48
v_mfma_f32_16x16x32_bf16 a[168:171], v[144:147], v[232:235], a[168:171]
s_lshl_b32 s71, s73, 19
v_and_b32 v97, 0xffff0000, v67
v_fmac_f32 v95, v74, v49
v_mfma_f32_16x16x32_bf16 a[164:167], v[136:139], v[232:235], a[164:167]
s_add_u32 s71, s71, s66
v_fmac_f32 v95, v73, v50
v_fmac_f32 v95, v72, v51
v_mfma_f32_16x16x32_bf16 a[164:167], v[140:143], v[236:239], a[164:167]
s_add_u32 m0, s63, 65536
v_mul_f32 v95, v95, v97
v_mul_f32 v96, v75, v47
v_mfma_f32_16x16x32_bf16 a[160:163], v[132:135], v[236:239], a[160:163]
s_waitcnt vmcnt(6) lgkmcnt(0)
v_and_b32 v97, 0xffff0000, v66
v_fmac_f32 v96, v74, v48
v_mfma_f32_16x16x32_bf16 a[160:163], v[128:131], v[232:235], a[160:163]
s_barrier
v_fmac_f32 v96, v73, v49
v_fmac_f32 v96, v72, v50
v_mfma_f32_16x16x32_bf16 a[192:195], v[128:131], v[240:243], a[192:195]
s_add_u32 s72, s69, 0
buffer_load_dwordx4 v2, s[8:11], s72 offen lds
v_mfma_f32_16x16x32_bf16 a[192:195], v[132:135], v[244:247], a[192:195]
ds_read_b64_tr_b16 v[224:225], v20 offset:32768
v_mul_f32 v96, v96, v97
v_mfma_f32_16x16x32_bf16 a[196:199], v[140:143], v[244:247], a[196:199]
ds_read_b64_tr_b16 v[226:227], v20 offset:33792
v_cvt_pk_bf16_f32 v100, v95, v96
v_mfma_f32_16x16x32_bf16 a[196:199], v[136:139], v[240:243], a[196:199]
ds_read_b64_tr_b16 v[228:229], v20 offset:40960
v_mul_f32 v95, v75, v46
v_mfma_f32_16x16x32_bf16 a[200:203], v[144:147], v[240:243], a[200:203]
s_add_u32 s72, s69, 7168
buffer_load_dwordx4 v3, s[8:11], s72 offen offset:1024 lds
v_mfma_f32_16x16x32_bf16 a[200:203], v[148:151], v[244:247], a[200:203]
ds_read_b64_tr_b16 v[230:231], v20 offset:41984
v_and_b32 v97, 0xffff0000, v65
v_mfma_f32_16x16x32_bf16 a[204:207], v[156:159], v[244:247], a[204:207]
ds_read_b128 v[192:195], v24 offset:32768
v_fmac_f32 v95, v74, v47
v_mfma_f32_16x16x32_bf16 a[204:207], v[152:155], v[240:243], a[204:207]
ds_read_b128 v[196:199], v25 offset:32768
v_fmac_f32 v95, v73, v48
v_mfma_f32_16x16x32_bf16 a[208:211], v[160:163], v[240:243], a[208:211]
s_add_u32 s72, s69, 14336
buffer_load_dwordx4 v2, s[8:11], s72 offen offset:2048 lds
v_mfma_f32_16x16x32_bf16 a[208:211], v[164:167], v[244:247], a[208:211]
ds_read_b128 v[200:203], v24 offset:34816
v_fmac_f32 v95, v72, v49
v_mfma_f32_16x16x32_bf16 a[212:215], v[172:175], v[244:247], a[212:215]
ds_read_b128 v[204:207], v25 offset:34816
v_mul_f32 v95, v95, v97
v_mfma_f32_16x16x32_bf16 a[212:215], v[168:171], v[240:243], a[212:215]
ds_read_b128 v[208:211], v24 offset:36864
v_mul_f32 v96, v75, v45
v_mfma_f32_16x16x32_bf16 a[216:219], v[176:179], v[240:243], a[216:219]
s_add_u32 s72, s69, 21504
buffer_load_dwordx4 v3, s[8:11], s72 offen offset:3072 lds
v_mfma_f32_16x16x32_bf16 a[216:219], v[180:183], v[244:247], a[216:219]
ds_read_b128 v[212:215], v25 offset:36864
v_and_b32 v97, 0xffff0000, v64
v_mfma_f32_16x16x32_bf16 a[220:223], v[188:191], v[244:247], a[220:223]
ds_read_b128 v[216:219], v24 offset:38912
v_fmac_f32 v96, v74, v46
v_mfma_f32_16x16x32_bf16 a[220:223], v[184:187], v[240:243], a[220:223]
ds_read_b128 v[220:223], v25 offset:38912
v_fmac_f32 v96, v73, v47
v_mfma_f32_16x16x32_bf16 a[252:255], v[184:187], v[248:251], a[252:255]
s_add_u32 m0, s64, 0
v_fmac_f32 v96, v72, v48
v_mul_f32 v96, v96, v97
v_mfma_f32_16x16x32_bf16 a[252:255], v[188:191], v[252:255], a[252:255]
s_add_u32 s72, s71, 0
buffer_load_dwordx4 v6, s[16:19], s72 offen lds
v_mfma_f32_16x16x32_bf16 a[248:251], v[180:183], v[252:255], a[248:251]
ds_read_b128 v[184:187], v24 offset:40960
v_cvt_pk_bf16_f32 v101, v95, v96
v_mfma_f32_16x16x32_bf16 a[248:251], v[176:179], v[248:251], a[248:251]
ds_read_b128 v[188:191], v25 offset:40960
v_mul_f32 v95, v75, v44
v_mfma_f32_16x16x32_bf16 a[244:247], v[168:171], v[248:251], a[244:247]
v_and_b32 v97, 0xffff0000, v63
v_fmac_f32 v95, v74, v45
v_mfma_f32_16x16x32_bf16 a[244:247], v[172:175], v[252:255], a[244:247]
s_add_u32 s72, s71, 31744
buffer_load_dwordx4 v6, s[16:19], s72 offen offset:1024 lds
v_mfma_f32_16x16x32_bf16 a[240:243], v[164:167], v[252:255], a[240:243]
ds_read_b128 v[176:179], v24 offset:43008
v_fmac_f32 v95, v73, v46
v_mfma_f32_16x16x32_bf16 a[240:243], v[160:163], v[248:251], a[240:243]
ds_read_b128 v[180:183], v25 offset:43008
v_fmac_f32 v95, v72, v47
v_mfma_f32_16x16x32_bf16 a[236:239], v[152:155], v[248:251], a[236:239]
ds_read_b128 v[168:171], v24 offset:45056
v_mul_f32 v95, v95, v97
v_mfma_f32_16x16x32_bf16 a[236:239], v[156:159], v[252:255], a[236:239]
s_add_u32 s72, s71, 63488
buffer_load_dwordx4 v7, s[16:19], s72 offen offset:2048 lds
v_mfma_f32_16x16x32_bf16 a[232:235], v[148:151], v[252:255], a[232:235]
ds_read_b128 v[172:175], v25 offset:45056
v_mul_f32 v96, v75, v43
v_mfma_f32_16x16x32_bf16 a[232:235], v[144:147], v[248:251], a[232:235]
ds_read_b128 v[160:163], v24 offset:47104
v_and_b32 v97, 0xffff0000, v62
v_mfma_f32_16x16x32_bf16 a[228:231], v[136:139], v[248:251], a[228:231]
ds_read_b128 v[164:167], v25 offset:47104
v_fmac_f32 v96, v74, v44
v_mfma_f32_16x16x32_bf16 a[228:231], v[140:143], v[252:255], a[228:231]
s_add_u32 s72, s71, 95232
buffer_load_dwordx4 v7, s[16:19], s72 offen offset:3072 lds
v_mfma_f32_16x16x32_bf16 a[224:227], v[132:135], v[252:255], a[224:227]
ds_read_b64_tr_b16 v[232:233], v21 offset:32768
v_fmac_f32 v96, v73, v45
v_mfma_f32_16x16x32_bf16 a[224:227], v[128:131], v[248:251], a[224:227]
s_waitcnt lgkmcnt(9)
ds_read_b64_tr_b16 v[234:235], v21 offset:33792
v_fmac_f32 v96, v72, v46
v_mfma_f32_16x16x32_bf16 a[0:3], v[224:227], v[192:195], a[0:3]
ds_read_b64_tr_b16 v[240:241], v22 offset:32768
v_mul_f32 v96, v96, v97
v_mfma_f32_16x16x32_bf16 a[0:3], v[228:231], v[196:199], a[0:3]
s_add_u32 m0, s63, 69632
ds_read_b64_tr_b16 v[236:237], v21 offset:40960
v_cvt_pk_bf16_f32 v102, v95, v96
v_mfma_f32_16x16x32_bf16 a[4:7], v[228:231], v[204:207], a[4:7]
s_add_u32 s72, s69, 32768
buffer_load_dwordx4 v2, s[8:11], s72 offen lds
v_mfma_f32_16x16x32_bf16 a[4:7], v[224:227], v[200:203], a[4:7]
v_mul_f32 v95, v75, v42
v_and_b32 v97, 0xffff0000, v61
v_mfma_f32_16x16x32_bf16 a[8:11], v[224:227], v[208:211], a[8:11]
ds_read_b64_tr_b16 v[238:239], v21 offset:41984
v_fmac_f32 v95, v74, v43
v_mfma_f32_16x16x32_bf16 a[8:11], v[228:231], v[212:215], a[8:11]
ds_read_b64_tr_b16 v[242:243], v22 offset:33792
v_fmac_f32 v95, v73, v44
v_mfma_f32_16x16x32_bf16 a[12:15], v[228:231], v[220:223], a[12:15]
s_add_u32 s72, s69, 39936
buffer_load_dwordx4 v3, s[8:11], s72 offen offset:1024 lds
v_mfma_f32_16x16x32_bf16 a[12:15], v[224:227], v[216:219], a[12:15]
s_waitcnt lgkmcnt(6)
v_fmac_f32 v95, v72, v45
v_mul_f32 v95, v95, v97
v_mfma_f32_16x16x32_bf16 a[16:19], v[224:227], v[184:187], a[16:19]
ds_read_b64_tr_b16 v[244:245], v22 offset:40960
v_mul_f32 v96, v75, v41
v_mfma_f32_16x16x32_bf16 a[16:19], v[228:231], v[188:191], a[16:19]
v_and_b32 v97, 0xffff0000, v60
v_fmac_f32 v96, v74, v42
v_mfma_f32_16x16x32_bf16 a[20:23], v[228:231], v[180:183], a[20:23]
s_add_u32 s72, s69, 47104
buffer_load_dwordx4 v2, s[8:11], s72 offen offset:2048 lds
v_mfma_f32_16x16x32_bf16 a[20:23], v[224:227], v[176:179], a[20:23]
ds_read_b64_tr_b16 v[246:247], v22 offset:41984
v_fmac_f32 v96, v73, v43
v_mfma_f32_16x16x32_bf16 a[24:27], v[224:227], v[168:171], a[24:27]
v_fmac_f32 v96, v72, v44
v_mul_f32 v96, v96, v97
v_mfma_f32_16x16x32_bf16 a[24:27], v[228:231], v[172:175], a[24:27]
v_cvt_pk_bf16_f32 v103, v95, v96
v_mfma_f32_16x16x32_bf16 a[28:31], v[228:231], v[164:167], a[28:31]
s_add_u32 s72, s69, 54272
buffer_load_dwordx4 v3, s[8:11], s72 offen offset:3072 lds
v_mfma_f32_16x16x32_bf16 a[28:31], v[224:227], v[160:163], a[28:31]
s_waitcnt lgkmcnt(3)
ds_write_b128 v28, v[100:103] offset:272
v_mul_f32 v95, v75, v40
v_mfma_f32_16x16x32_bf16 a[60:63], v[232:235], v[160:163], a[60:63]
ds_read_b64_tr_b16 v[248:249], v23 offset:32768
v_and_b32 v97, 0xffff0000, v59
v_mfma_f32_16x16x32_bf16 a[60:63], v[236:239], v[164:167], a[60:63]
v_fmac_f32 v95, v74, v41
v_fmac_f32 v95, v73, v42
v_mfma_f32_16x16x32_bf16 a[56:59], v[236:239], v[172:175], a[56:59]
s_add_u32 m0, s64, 16384
ds_read_b64_tr_b16 v[250:251], v23 offset:33792
v_fmac_f32 v95, v72, v43
v_mfma_f32_16x16x32_bf16 a[56:59], v[232:235], v[168:171], a[56:59]
s_add_u32 s72, s71, 0
buffer_load_dwordx4 v6, s[20:23], s72 offen lds
v_mfma_f32_16x16x32_bf16 a[52:55], v[232:235], v[176:179], a[52:55]
v_mul_f32 v95, v95, v97
v_mul_f32 v96, v75, v39
v_mfma_f32_16x16x32_bf16 a[52:55], v[236:239], v[180:183], a[52:55]
v_and_b32 v97, 0xffff0000, v58
v_fmac_f32 v96, v74, v40
v_mfma_f32_16x16x32_bf16 a[48:51], v[236:239], v[188:191], a[48:51]
ds_read_b64_tr_b16 v[252:253], v23 offset:40960
v_fmac_f32 v96, v73, v41
v_mfma_f32_16x16x32_bf16 a[48:51], v[232:235], v[184:187], a[48:51]
s_add_u32 s72, s71, 31744
buffer_load_dwordx4 v6, s[20:23], s72 offen offset:1024 lds
v_mfma_f32_16x16x32_bf16 a[44:47], v[232:235], v[216:219], a[44:47]
v_fmac_f32 v96, v72, v42
v_mul_f32 v96, v96, v97
v_mfma_f32_16x16x32_bf16 a[44:47], v[236:239], v[220:223], a[44:47]
v_cvt_pk_bf16_f32 v104, v95, v96
v_mul_f32 v95, v75, v38
v_mfma_f32_16x16x32_bf16 a[40:43], v[236:239], v[212:215], a[40:43]
ds_read_b64_tr_b16 v[254:255], v23 offset:41984
v_and_b32 v97, 0xffff0000, v57
v_mfma_f32_16x16x32_bf16 a[40:43], v[232:235], v[208:211], a[40:43]
s_add_u32 s72, s71, 63488
buffer_load_dwordx4 v7, s[20:23], s72 offen offset:2048 lds
v_mfma_f32_16x16x32_bf16 a[36:39], v[232:235], v[200:203], a[36:39]
v_fmac_f32 v95, v74, v39
v_fmac_f32 v95, v73, v40
v_mfma_f32_16x16x32_bf16 a[36:39], v[236:239], v[204:207], a[36:39]
v_fmac_f32 v95, v72, v41
v_mul_f32 v95, v95, v97
v_mfma_f32_16x16x32_bf16 a[32:35], v[236:239], v[196:199], a[32:35]
s_add_u32 s72, s71, 95232
v_mul_f32 v96, v75, v37
v_and_b32 v97, 0xffff0000, v56
v_mfma_f32_16x16x32_bf16 a[32:35], v[232:235], v[192:195], a[32:35]
s_waitcnt lgkmcnt(5)
buffer_load_dwordx4 v7, s[20:23], s72 offen offset:3072 lds
v_mfma_f32_16x16x32_bf16 a[64:67], v[240:243], v[192:195], a[64:67]
ds_read_b64_tr_b16 v[224:225], v20 offset:49152
v_fmac_f32 v96, v74, v38
v_mfma_f32_16x16x32_bf16 a[64:67], v[244:247], v[196:199], a[64:67]
v_fmac_f32 v96, v73, v39
v_fmac_f32 v96, v72, v40
v_mfma_f32_16x16x32_bf16 a[68:71], v[244:247], v[204:207], a[68:71]
ds_read_b64_tr_b16 v[226:227], v20 offset:50176
v_mul_f32 v96, v96, v97
v_mfma_f32_16x16x32_bf16 a[68:71], v[240:243], v[200:203], a[68:71]
s_mov_b32 s80, 0x400000
buffer_load_dword v126, v125, s[12:15], s80 offen
v_mfma_f32_16x16x32_bf16 a[72:75], v[240:243], v[208:211], a[72:75]
v_cvt_pk_bf16_f32 v105, v95, v96
v_mul_f32 v95, v75, v36
v_mfma_f32_16x16x32_bf16 a[72:75], v[244:247], v[212:215], a[72:75]
v_and_b32 v97, 0xffff0000, v55
v_fmac_f32 v95, v74, v37
v_mfma_f32_16x16x32_bf16 a[76:79], v[244:247], v[220:223], a[76:79]
ds_read_b64_tr_b16 v[228:229], v20 offset:57344
v_fmac_f32 v95, v73, v38
v_mfma_f32_16x16x32_bf16 a[76:79], v[240:243], v[216:219], a[76:79]
s_mov_b32 s80, 0x500000
buffer_load_dword v126, v125, s[12:15], s80 offen
v_mfma_f32_16x16x32_bf16 a[80:83], v[240:243], v[184:187], a[80:83]
v_fmac_f32 v95, v72, v39
v_mul_f32 v95, v95, v97
v_mfma_f32_16x16x32_bf16 a[80:83], v[244:247], v[188:191], a[80:83]
v_mul_f32 v96, v75, v35
v_and_b32 v97, 0xffff0000, v54
v_mfma_f32_16x16x32_bf16 a[84:87], v[244:247], v[180:183], a[84:87]
ds_read_b64_tr_b16 v[230:231], v20 offset:58368
v_fmac_f32 v96, v74, v36
v_mfma_f32_16x16x32_bf16 a[84:87], v[240:243], v[176:179], a[84:87]
s_mov_b32 s80, 0x600000
buffer_load_dword v126, v125, s[12:15], s80 offen
v_mfma_f32_16x16x32_bf16 a[88:91], v[240:243], v[168:171], a[88:91]
v_fmac_f32 v96, v73, v37
v_fmac_f32 v96, v72, v38
v_mfma_f32_16x16x32_bf16 a[88:91], v[244:247], v[172:175], a[88:91]
v_mul_f32 v96, v96, v97
v_cvt_pk_bf16_f32 v106, v95, v96
v_mfma_f32_16x16x32_bf16 a[92:95], v[244:247], v[164:167], a[92:95]
v_mul_f32 v95, v75, v34
v_and_b32 v97, 0xffff0000, v53
v_mfma_f32_16x16x32_bf16 a[92:95], v[240:243], v[160:163], a[92:95]
s_waitcnt lgkmcnt(4)
v_fmac_f32 v95, v74, v35
v_fmac_f32 v95, v73, v36
v_mfma_f32_16x16x32_bf16 a[124:127], v[248:251], v[160:163], a[124:127]
s_mov_b32 s80, 0x700000
buffer_load_dword v126, v125, s[12:15], s80 offen
v_mfma_f32_16x16x32_bf16 a[124:127], v[252:255], v[164:167], a[124:127]
ds_read_b64_tr_b16 v[232:233], v21 offset:49152
v_fmac_f32 v95, v72, v37
v_mfma_f32_16x16x32_bf16 a[120:123], v[252:255], v[172:175], a[120:123]
v_mul_f32 v95, v95, v97
v_mul_f32 v96, v75, v33
v_mfma_f32_16x16x32_bf16 a[120:123], v[248:251], v[168:171], a[120:123]
v_and_b32 v97, 0xffff0000, v52
v_fmac_f32 v96, v74, v34
v_mfma_f32_16x16x32_bf16 a[116:119], v[248:251], v[176:179], a[116:119]
ds_read_b64_tr_b16 v[234:235], v21 offset:50176
v_fmac_f32 v96, v73, v35
v_mfma_f32_16x16x32_bf16 a[116:119], v[252:255], v[180:183], a[116:119]
v_fmac_f32 v96, v72, v36
v_mul_f32 v96, v96, v97
v_mfma_f32_16x16x32_bf16 a[112:115], v[252:255], v[188:191], a[112:115]
v_cvt_pk_bf16_f32 v107, v95, v96
v_mfma_f32_16x16x32_bf16 a[112:115], v[248:251], v[184:187], a[112:115]
ds_read_b64_tr_b16 v[236:237], v21 offset:57344
ds_write_b128 v28, v[104:107] offset:288
v_mfma_f32_16x16x32_bf16 a[108:111], v[248:251], v[216:219], a[108:111]
v_mfma_f32_16x16x32_bf16 a[108:111], v[252:255], v[220:223], a[108:111]
v_mfma_f32_16x16x32_bf16 a[104:107], v[252:255], v[212:215], a[104:107]
ds_read_b64_tr_b16 v[238:239], v21 offset:58368
v_mfma_f32_16x16x32_bf16 a[104:107], v[248:251], v[208:211], a[104:107]
v_mfma_f32_16x16x32_bf16 a[100:103], v[248:251], v[200:203], a[100:103]
v_mfma_f32_16x16x32_bf16 a[100:103], v[252:255], v[204:207], a[100:103]
v_mfma_f32_16x16x32_bf16 a[96:99], v[252:255], v[196:199], a[96:99]
v_mfma_f32_16x16x32_bf16 a[96:99], v[248:251], v[192:195], a[96:99]
s_waitcnt lgkmcnt(5)
v_mfma_f32_16x16x32_bf16 a[128:131], v[192:195], v[224:227], a[128:131]
ds_read_b64_tr_b16 v[240:241], v22 offset:49152
v_mfma_f32_16x16x32_bf16 a[128:131], v[196:199], v[228:231], a[128:131]
v_mfma_f32_16x16x32_bf16 a[132:135], v[204:207], v[228:231], a[132:135]
v_mfma_f32_16x16x32_bf16 a[132:135], v[200:203], v[224:227], a[132:135]
ds_read_b64_tr_b16 v[242:243], v22 offset:50176
v_mfma_f32_16x16x32_bf16 a[136:139], v[208:211], v[224:227], a[136:139]
v_mfma_f32_16x16x32_bf16 a[136:139], v[212:215], v[228:231], a[136:139]
v_mfma_f32_16x16x32_bf16 a[140:143], v[220:223], v[228:231], a[140:143]
v_mfma_f32_16x16x32_bf16 a[140:143], v[216:219], v[224:227], a[140:143]
ds_read_b64_tr_b16 v[244:245], v22 offset:57344
v_mfma_f32_16x16x32_bf16 a[144:147], v[184:187], v[224:227], a[144:147]
v_mfma_f32_16x16x32_bf16 a[144:147], v[188:191], v[228:231], a[144:147]
v_mfma_f32_16x16x32_bf16 a[148:151], v[180:183], v[228:231], a[148:151]
ds_read_b64_tr_b16 v[246:247], v22 offset:58368
v_mfma_f32_16x16x32_bf16 a[148:151], v[176:179], v[224:227], a[148:151]
v_mfma_f32_16x16x32_bf16 a[152:155], v[168:171], v[224:227], a[152:155]
v_mfma_f32_16x16x32_bf16 a[152:155], v[172:175], v[228:231], a[152:155]
v_mfma_f32_16x16x32_bf16 a[156:159], v[164:167], v[228:231], a[156:159]
v_mfma_f32_16x16x32_bf16 a[156:159], v[160:163], v[224:227], a[156:159]
s_waitcnt lgkmcnt(4)
v_mfma_f32_16x16x32_bf16 a[188:191], v[160:163], v[232:235], a[188:191]
ds_read_b64_tr_b16 v[248:249], v23 offset:49152
v_mfma_f32_16x16x32_bf16 a[188:191], v[164:167], v[236:239], a[188:191]
v_mfma_f32_16x16x32_bf16 a[184:187], v[172:175], v[236:239], a[184:187]
ds_read_b64_tr_b16 v[250:251], v23 offset:50176
v_mfma_f32_16x16x32_bf16 a[184:187], v[168:171], v[232:235], a[184:187]
v_mfma_f32_16x16x32_bf16 a[180:183], v[176:179], v[232:235], a[180:183]
ds_read_b64_tr_b16 v[252:253], v23 offset:57344
v_mfma_f32_16x16x32_bf16 a[180:183], v[180:183], v[236:239], a[180:183]
v_mfma_f32_16x16x32_bf16 a[176:179], v[188:191], v[236:239], a[176:179]
ds_read_b64_tr_b16 v[254:255], v23 offset:58368
v_mfma_f32_16x16x32_bf16 a[176:179], v[184:187], v[232:235], a[176:179]
v_mfma_f32_16x16x32_bf16 a[172:175], v[216:219], v[232:235], a[172:175]
s_xor_b32 s73, s61, 7
v_mfma_f32_16x16x32_bf16 a[172:175], v[220:223], v[236:239], a[172:175]
s_lshl_b32 s69, s73, 7
v_mfma_f32_16x16x32_bf16 a[168:171], v[212:215], v[236:239], a[168:171]
s_add_u32 s69, s69, s84
v_mfma_f32_16x16x32_bf16 a[168:171], v[208:211], v[232:235], a[168:171]
s_lshl_b32 s71, s73, 19
v_mfma_f32_16x16x32_bf16 a[164:167], v[200:203], v[232:235], a[164:167]
s_add_u32 s71, s71, s66
v_mfma_f32_16x16x32_bf16 a[164:167], v[204:207], v[236:239], a[164:167]
s_add_u32 m0, s63, 98304
v_mfma_f32_16x16x32_bf16 a[160:163], v[196:199], v[236:239], a[160:163]
s_waitcnt vmcnt(4) lgkmcnt(0)
v_mfma_f32_16x16x32_bf16 a[160:163], v[192:195], v[232:235], a[160:163]
s_barrier
v_mfma_f32_16x16x32_bf16 a[192:195], v[192:195], v[240:243], a[192:195]
s_add_u32 s72, s69, 0
buffer_load_dwordx4 v2, s[8:11], s72 offen lds
v_mfma_f32_16x16x32_bf16 a[192:195], v[196:199], v[244:247], a[192:195]
s_add_u32 s74, s63, 131072
ds_read_b64_tr_b16 v[224:225], v20 offset:0
v_lshrrev_b32 v26, 4, v0
v_mfma_f32_16x16x32_bf16 a[196:199], v[204:207], v[244:247], a[196:199]
ds_read_b64_tr_b16 v[226:227], v20 offset:1024
v_and_b32 v27, 15, v0
v_mfma_f32_16x16x32_bf16 a[196:199], v[200:203], v[240:243], a[196:199]
ds_read_b64_tr_b16 v[228:229], v20 offset:8192
v_lshlrev_b32 v27, 4, v27
v_mfma_f32_16x16x32_bf16 a[200:203], v[208:211], v[240:243], a[200:203]
s_add_u32 s72, s69, 7168
buffer_load_dwordx4 v3, s[8:11], s72 offen offset:1024 lds
v_mfma_f32_16x16x32_bf16 a[200:203], v[212:215], v[244:247], a[200:203]
ds_read_b64_tr_b16 v[230:231], v20 offset:9216
v_mul_u32_u24 v28, 272, v26
v_mfma_f32_16x16x32_bf16 a[204:207], v[220:223], v[244:247], a[204:207]
ds_read_b128 v[128:131], v24 offset:0
v_add3_u32 v28, v28, v27, s74
v_mfma_f32_16x16x32_bf16 a[204:207], v[216:219], v[240:243], a[204:207]
ds_read_b128 v[132:135], v25 offset:0
v_lshl_add_u32 v26, v26, 12, v27
v_mfma_f32_16x16x32_bf16 a[208:211], v[184:187], v[240:243], a[208:211]
s_add_u32 s72, s69, 14336
buffer_load_dwordx4 v2, s[8:11], s72 offen offset:2048 lds
v_mfma_f32_16x16x32_bf16 a[208:211], v[188:191], v[244:247], a[208:211]
ds_read_b128 v[136:139], v24 offset:2048
ds_read_b128 v[36:39], v28 offset:0
v_mfma_f32_16x16x32_bf16 a[212:215], v[180:183], v[244:247], a[212:215]
ds_read_b128 v[140:143], v25 offset:2048
ds_read_b128 v[40:43], v28 offset:1088
v_mfma_f32_16x16x32_bf16 a[212:215], v[176:179], v[240:243], a[212:215]
ds_read_b128 v[144:147], v24 offset:4096
ds_read_b128 v[44:47], v28 offset:2176
v_mfma_f32_16x16x32_bf16 a[216:219], v[168:171], v[240:243], a[216:219]
s_add_u32 s72, s69, 21504
buffer_load_dwordx4 v3, s[8:11], s72 offen offset:3072 lds
v_mfma_f32_16x16x32_bf16 a[216:219], v[172:175], v[244:247], a[216:219]
ds_read_b128 v[148:151], v25 offset:4096
ds_read_b128 v[48:51], v28 offset:3264
v_mfma_f32_16x16x32_bf16 a[220:223], v[164:167], v[244:247], a[220:223]
s_xor_b32 s74, s2, 5
ds_read_b128 v[152:155], v24 offset:6144
v_mfma_f32_16x16x32_bf16 a[220:223], v[160:163], v[240:243], a[220:223]
s_and_b32 s74, s74, 15
ds_read_b128 v[156:159], v25 offset:6144
v_mfma_f32_16x16x32_bf16 a[252:255], v[160:163], v[248:251], a[252:255]
s_add_u32 m0, s64, 32768
v_mfma_f32_16x16x32_bf16 a[252:255], v[164:167], v[252:255], a[252:255]
s_add_u32 s72, s71, 0
buffer_load_dwordx4 v6, s[16:19], s72 offen lds
v_mfma_f32_16x16x32_bf16 a[248:251], v[172:175], v[252:255], a[248:251]
s_lshl_b32 s74, s74, 2
ds_read_b128 v[160:163], v24 offset:8192
v_mfma_f32_16x16x32_bf16 a[248:251], v[168:171], v[248:251], a[248:251]
s_add_u32 s74, s74, s58
ds_read_b128 v[164:167], v25 offset:8192
v_mfma_f32_16x16x32_bf16 a[244:247], v[176:179], v[248:251], a[244:247]
s_lshl_b32 s74, s74, 16
v_mfma_f32_16x16x32_bf16 a[244:247], v[180:183], v[252:255], a[244:247]
s_add_u32 s72, s71, 31744
buffer_load_dwordx4 v6, s[16:19], s72 offen offset:1024 lds
v_mfma_f32_16x16x32_bf16 a[240:243], v[188:191], v[252:255], a[240:243]
s_lshr_b32 s75, s2, 4
ds_read_b128 v[168:171], v24 offset:10240
v_mfma_f32_16x16x32_bf16 a[240:243], v[184:187], v[248:251], a[240:243]
s_lshl_b32 s75, s75, 8
ds_read_b128 v[172:175], v25 offset:10240
v_mfma_f32_16x16x32_bf16 a[236:239], v[216:219], v[248:251], a[236:239]
s_sub_u32 s74, s74, s75
ds_read_b128 v[176:179], v24 offset:12288
v_mfma_f32_16x16x32_bf16 a[236:239], v[220:223], v[252:255], a[236:239]
s_add_u32 s72, s71, 63488
buffer_load_dwordx4 v7, s[16:19], s72 offen offset:2048 lds
v_mfma_f32_16x16x32_bf16 a[232:235], v[212:215], v[252:255], a[232:235]
s_add_u32 s74, s74, 0x3000f00
ds_read_b128 v[180:183], v25 offset:12288
v_mfma_f32_16x16x32_bf16 a[232:235], v[208:211], v[248:251], a[232:235]
s_waitcnt vmcnt(27)
ds_read_b128 v[184:187], v24 offset:14336
v_lshlrev_b32 v78, 16, v84
v_mfma_f32_16x16x32_bf16 a[228:231], v[200:203], v[248:251], a[228:231]
ds_read_b128 v[188:191], v25 offset:14336
v_lshlrev_b32 v79, 16, v108
v_mfma_f32_16x16x32_bf16 a[228:231], v[204:207], v[252:255], a[228:231]
s_add_u32 s72, s71, 95232
buffer_load_dwordx4 v7, s[16:19], s72 offen offset:3072 lds
v_mfma_f32_16x16x32_bf16 a[224:227], v[196:199], v[252:255], a[224:227]
ds_read_b64_tr_b16 v[232:233], v21 offset:0
v_mul_f32 v76, v78, v79
v_mfma_f32_16x16x32_bf16 a[224:227], v[192:195], v[248:251], a[224:227]
s_waitcnt lgkmcnt(9)
ds_read_b64_tr_b16 v[234:235], v21 offset:1024
v_lshlrev_b32 v80, 16, v116
v_mfma_f32_16x16x32_bf16 a[0:3], v[224:227], v[128:131], a[0:3]
ds_read_b64_tr_b16 v[240:241], v22 offset:0
v_mul_f32 v77, v78, v80
v_mfma_f32_16x16x32_bf16 a[0:3], v[228:231], v[132:135], a[0:3]
s_add_u32 m0, s63, 102400
ds_read_b64_tr_b16 v[236:237], v21 offset:8192
v_and_b32 v78, 0xffff0000, v84
v_mfma_f32_16x16x32_bf16 a[4:7], v[228:231], v[140:143], a[4:7]
s_add_u32 s72, s69, 32768
buffer_load_dwordx4 v2, s[8:11], s72 offen lds
v_mfma_f32_16x16x32_bf16 a[4:7], v[224:227], v[136:139], a[4:7]
v_and_b32 v79, 0xffff0000, v108
v_fmac_f32 v76, v78, v79
v_mfma_f32_16x16x32_bf16 a[8:11], v[224:227], v[144:147], a[8:11]
ds_read_b64_tr_b16 v[238:239], v21 offset:9216
v_and_b32 v80, 0xffff0000, v116
v_mfma_f32_16x16x32_bf16 a[8:11], v[228:231], v[148:151], a[8:11]
ds_read_b64_tr_b16 v[242:243], v22 offset:1024
v_fmac_f32 v77, v78, v80
v_mfma_f32_16x16x32_bf16 a[12:15], v[228:231], v[156:159], a[12:15]
s_add_u32 s72, s69, 39936
buffer_load_dwordx4 v3, s[8:11], s72 offen offset:1024 lds
v_mfma_f32_16x16x32_bf16 a[12:15], v[224:227], v[152:155], a[12:15]
s_waitcnt lgkmcnt(6)
v_lshlrev_b32 v78, 16, v85
v_lshlrev_b32 v79, 16, v109
v_mfma_f32_16x16x32_bf16 a[16:19], v[224:227], v[160:163], a[16:19]
ds_read_b64_tr_b16 v[244:245], v22 offset:8192
v_fmac_f32 v76, v78, v79
v_mfma_f32_16x16x32_bf16 a[16:19], v[228:231], v[164:167], a[16:19]
v_lshlrev_b32 v80, 16, v117
v_fmac_f32 v77, v78, v80
v_mfma_f32_16x16x32_bf16 a[20:23], v[228:231], v[172:175], a[20:23]
s_add_u32 s72, s69, 47104
buffer_load_dwordx4 v2, s[8:11], s72 offen offset:2048 lds
v_mfma_f32_16x16x32_bf16 a[20:23], v[224:227], v[168:171], a[20:23]
ds_read_b64_tr_b16 v[246:247], v22 offset:9216
v_and_b32 v78, 0xffff0000, v85
v_mfma_f32_16x16x32_bf16 a[24:27], v[224:227], v[176:179], a[24:27]
v_and_b32 v79, 0xffff0000, v109
v_fmac_f32 v76, v78, v79
v_mfma_f32_16x16x32_bf16 a[24:27], v[228:231], v[180:183], a[24:27]
v_and_b32 v80, 0xffff0000, v117
v_fmac_f32 v77, v78, v80
v_mfma_f32_16x16x32_bf16 a[28:31], v[228:231], v[188:191], a[28:31]
s_add_u32 s72, s69, 54272
buffer_load_dwordx4 v3, s[8:11], s72 offen offset:3072 lds
v_mfma_f32_16x16x32_bf16 a[28:31], v[224:227], v[184:187], a[28:31]
s_waitcnt lgkmcnt(3)
v_lshlrev_b32 v78, 16, v86
v_lshlrev_b32 v79, 16, v110
v_mfma_f32_16x16x32_bf16 a[60:63], v[232:235], v[184:187], a[60:63]
ds_read_b64_tr_b16 v[248:249], v23 offset:0
v_fmac_f32 v76, v78, v79
v_mfma_f32_16x16x32_bf16 a[60:63], v[236:239], v[188:191], a[60:63]
v_lshlrev_b32 v80, 16, v118
v_fmac_f32 v77, v78, v80
v_mfma_f32_16x16x32_bf16 a[56:59], v[236:239], v[180:183], a[56:59]
s_add_u32 m0, s64, 49152
ds_read_b64_tr_b16 v[250:251], v23 offset:1024
v_and_b32 v78, 0xffff0000, v86
v_mfma_f32_16x16x32_bf16 a[56:59], v[232:235], v[176:179], a[56:59]
s_add_u32 s72, s71, 0
buffer_load_dwordx4 v6, s[20:23], s72 offen lds
v_mfma_f32_16x16x32_bf16 a[52:55], v[232:235], v[168:171], a[52:55]
v_and_b32 v79, 0xffff0000, v110
v_fmac_f32 v76, v78, v79
v_mfma_f32_16x16x32_bf16 a[52:55], v[236:239], v[172:175], a[52:55]
v_and_b32 v80, 0xffff0000, v118
v_fmac_f32 v77, v78, v80
v_mfma_f32_16x16x32_bf16 a[48:51], v[236:239], v[164:167], a[48:51]
ds_read_b64_tr_b16 v[252:253], v23 offset:8192
v_lshlrev_b32 v78, 16, v87
v_mfma_f32_16x16x32_bf16 a[48:51], v[232:235], v[160:163], a[48:51]
s_add_u32 s72, s71, 31744
buffer_load_dwordx4 v6, s[20:23], s72 offen offset:1024 lds
v_mfma_f32_16x16x32_bf16 a[44:47], v[232:235], v[152:155], a[44:47]
v_lshlrev_b32 v79, 16, v111
v_fmac_f32 v76, v78, v79
v_mfma_f32_16x16x32_bf16 a[44:47], v[236:239], v[156:159], a[44:47]
v_lshlrev_b32 v80, 16, v119
v_fmac_f32 v77, v78, v80
v_mfma_f32_16x16x32_bf16 a[40:43], v[236:239], v[148:151], a[40:43]
ds_read_b64_tr_b16 v[254:255], v23 offset:9216
v_and_b32 v78, 0xffff0000, v87
v_mfma_f32_16x16x32_bf16 a[40:43], v[232:235], v[144:147], a[40:43]
s_add_u32 s72, s71, 63488
buffer_load_dwordx4 v7, s[20:23], s72 offen offset:2048 lds
v_mfma_f32_16x16x32_bf16 a[36:39], v[232:235], v[136:139], a[36:39]
v_and_b32 v79, 0xffff0000, v111
v_fmac_f32 v76, v78, v79
v_mfma_f32_16x16x32_bf16 a[36:39], v[236:239], v[140:143], a[36:39]
v_and_b32 v80, 0xffff0000, v119
v_fmac_f32 v77, v78, v80
v_mfma_f32_16x16x32_bf16 a[32:35], v[236:239], v[132:135], a[32:35]
s_add_u32 s72, s71, 95232
v_lshlrev_b32 v78, 16, v88
v_lshlrev_b32 v79, 16, v112
v_mfma_f32_16x16x32_bf16 a[32:35], v[232:235], v[128:131], a[32:35]
s_waitcnt lgkmcnt(4)
buffer_load_dwordx4 v7, s[20:23], s72 offen offset:3072 lds
v_mfma_f32_16x16x32_bf16 a[64:67], v[240:243], v[128:131], a[64:67]
s_waitcnt lgkmcnt(15)
ds_read_b64_tr_b16 v[224:225], v20 offset:16384
v_fmac_f32 v76, v78, v79
v_mfma_f32_16x16x32_bf16 a[64:67], v[244:247], v[132:135], a[64:67]
s_add_u32 s73, s62, 0
v_lshlrev_b32 v80, 16, v120
v_fmac_f32 v77, v78, v80
v_mfma_f32_16x16x32_bf16 a[68:71], v[244:247], v[140:143], a[68:71]
s_add_u32 s70, s73, s65
ds_read_b64_tr_b16 v[226:227], v20 offset:17408
v_and_b32 v78, 0xffff0000, v88
v_mfma_f32_16x16x32_bf16 a[68:71], v[240:243], v[136:139], a[68:71]
s_and_b32 s70, s70, 3
v_and_b32 v79, 0xffff0000, v112
v_fmac_f32 v76, v78, v79
v_mfma_f32_16x16x32_bf16 a[72:75], v[240:243], v[144:147], a[72:75]
s_and_b32 s73, s73, 12
v_and_b32 v80, 0xffff0000, v120
v_fmac_f32 v77, v78, v80
v_mfma_f32_16x16x32_bf16 a[72:75], v[244:247], v[148:151], a[72:75]
s_or_b32 s73, s73, s70
ds_read_b64_tr_b16 v[228:229], v20 offset:24576
v_lshlrev_b32 v78, 16, v89
v_mfma_f32_16x16x32_bf16 a[76:79], v[244:247], v[156:159], a[76:79]
s_lshl_b32 s73, s73, 7
v_lshlrev_b32 v79, 16, v113
v_fmac_f32 v76, v78, v79
v_mfma_f32_16x16x32_bf16 a[76:79], v[240:243], v[152:155], a[76:79]
s_add_u32 s69, s73, s67
ds_read_b64_tr_b16 v[230:231], v20 offset:25600
v_lshlrev_b32 v80, 16, v121
v_mfma_f32_16x16x32_bf16 a[80:83], v[240:243], v[160:163], a[80:83]
s_add_u32 s70, s73, s68
v_fmac_f32 v77, v78, v80
v_and_b32 v78, 0xffff0000, v89
v_mfma_f32_16x16x32_bf16 a[80:83], v[244:247], v[164:167], a[80:83]
s_add_u32 m0, s63, 131072
v_and_b32 v79, 0xffff0000, v113
v_fmac_f32 v76, v78, v79
v_mfma_f32_16x16x32_bf16 a[84:87], v[244:247], v[172:175], a[84:87]
s_add_u32 s72, s69, 0
buffer_load_dwordx4 v4, s[4:7], s72 offen lds
Lstuba3:
s_cbranch_execz Lreta
v_mfma_f32_16x16x32_bf16 a[84:87], v[240:243], v[168:171], a[84:87]
s_add_u32 s72, s69, 15360
buffer_load_dwordx4 v5, s[4:7], s72 offen offset:1024 lds
v_mfma_f32_16x16x32_bf16 a[88:91], v[240:243], v[176:179], a[88:91]
s_add_u32 s72, s69, 129024
buffer_load_dwordx4 v4, s[4:7], s72 offen offset:2048 lds
v_mfma_f32_16x16x32_bf16 a[88:91], v[244:247], v[180:183], a[88:91]
s_add_u32 s72, s69, 144384
buffer_load_dwordx4 v5, s[4:7], s72 offen offset:3072 lds
v_mfma_f32_16x16x32_bf16 a[92:95], v[244:247], v[188:191], a[92:95]
v_and_b32 v80, 0xffff0000, v121
v_fmac_f32 v77, v78, v80
v_mfma_f32_16x16x32_bf16 a[92:95], v[240:243], v[184:187], a[92:95]
s_waitcnt lgkmcnt(4)
v_lshlrev_b32 v78, 16, v90
v_lshlrev_b32 v79, 16, v114
v_mfma_f32_16x16x32_bf16 a[124:127], v[248:251], v[184:187], a[124:127]
ds_read_b64_tr_b16 v[232:233], v21 offset:16384
v_fmac_f32 v76, v78, v79
v_mfma_f32_16x16x32_bf16 a[124:127], v[252:255], v[188:191], a[124:127]
v_lshlrev_b32 v80, 16, v122
v_fmac_f32 v77, v78, v80
v_mfma_f32_16x16x32_bf16 a[120:123], v[252:255], v[180:183], a[120:123]
s_add_u32 m0, s63, 135168
ds_read_b64_tr_b16 v[234:235], v21 offset:17408
v_and_b32 v78, 0xffff0000, v90
v_mfma_f32_16x16x32_bf16 a[120:123], v[248:251], v[176:179], a[120:123]
s_add_u32 s72, s70, 0
buffer_load_dwordx4 v4, s[4:7], s72 offen lds
v_mfma_f32_16x16x32_bf16 a[116:119], v[248:251], v[168:171], a[116:119]
s_lshr_b32 s75, s93, 5
v_and_b32 v79, 0xffff0000, v114
v_fmac_f32 v76, v78, v79
v_mfma_f32_16x16x32_bf16 a[116:119], v[252:255], v[172:175], a[116:119]
s_and_b32 s75, s75, 0x3f80
ds_read_b64_tr_b16 v[236:237], v21 offset:24576
v_and_b32 v80, 0xffff0000, v122
v_mfma_f32_16x16x32_bf16 a[112:115], v[252:255], v[164:167], a[112:115]
s_add_u32 s75, s75, LcB0-Lpc0
v_lshrrev_b32 v2, 6, v0
v_lshlrev_b32 v2, 7, v2
v_mfma_f32_16x16x32_bf16 a[112:115], v[248:251], v[160:163], a[112:115]
s_add_u32 s72, s70, 15360
buffer_load_dwordx4 v5, s[4:7], s72 offen offset:1024 lds
v_mfma_f32_16x16x32_bf16 a[108:111], v[248:251], v[152:155], a[108:111]
v_add_u32 v2, s75, v2
v_min_u32 v2, Lcode_end-Lpc0, v2
v_mfma_f32_16x16x32_bf16 a[108:111], v[252:255], v[156:159], a[108:111]
global_load_dword v3, v2, s[98:99]
v_mfma_f32_16x16x32_bf16 a[104:107], v[252:255], v[148:151], a[104:107]
v_fmac_f32 v77, v78, v80
v_lshlrev_b32 v78, 16, v91
v_mfma_f32_16x16x32_bf16 a[104:107], v[248:251], v[144:147], a[104:107]
s_add_u32 s72, s70, 129024
buffer_load_dwordx4 v4, s[4:7], s72 offen offset:2048 lds
v_mfma_f32_16x16x32_bf16 a[100:103], v[248:251], v[136:139], a[100:103]
ds_read_b64_tr_b16 v[238:239], v21 offset:25600
v_lshlrev_b32 v79, 16, v115
v_mfma_f32_16x16x32_bf16 a[100:103], v[252:255], v[140:143], a[100:103]
v_fmac_f32 v76, v78, v79
v_lshlrev_b32 v80, 16, v123
v_mfma_f32_16x16x32_bf16 a[96:99], v[252:255], v[132:135], a[96:99]
v_fmac_f32 v77, v78, v80
v_and_b32 v78, 0xffff0000, v91
v_mfma_f32_16x16x32_bf16 a[96:99], v[248:251], v[128:131], a[96:99]
s_waitcnt lgkmcnt(4)
v_and_b32 v79, 0xffff0000, v115
v_fmac_f32 v76, v78, v79
v_mfma_f32_16x16x32_bf16 a[128:131], v[128:131], v[224:227], a[128:131]
s_add_u32 s72, s70, 144384
buffer_load_dwordx4 v5, s[4:7], s72 offen offset:3072 lds
v_mfma_f32_16x16x32_bf16 a[128:131], v[132:135], v[228:231], a[128:131]
ds_read_b64_tr_b16 v[240:241], v22 offset:16384
v_and_b32 v80, 0xffff0000, v123
v_mfma_f32_16x16x32_bf16 a[132:135], v[140:143], v[228:231], a[132:135]
v_fmac_f32 v77, v78, v80
v_add_f32_dpp v76, v76, v76 row_ror:8 row_mask:0xf bank_mask:0xf
v_mfma_f32_16x16x32_bf16 a[132:135], v[136:139], v[224:227], a[132:135]
v_add_f32_dpp v77, v77, v77 row_ror:8 row_mask:0xf bank_mask:0xf
v_add_f32_dpp v76, v76, v76 row_ror:4 row_mask:0xf bank_mask:0xf
v_mfma_f32_16x16x32_bf16 a[136:139], v[144:147], v[224:227], a[136:139]
ds_read_b64_tr_b16 v[242:243], v22 offset:17408
v_add_f32_dpp v77, v77, v77 row_ror:4 row_mask:0xf bank_mask:0xf
v_mfma_f32_16x16x32_bf16 a[136:139], v[148:151], v[228:231], a[136:139]
v_add_f32_dpp v76, v76, v76 row_ror:2 row_mask:0xf bank_mask:0xf
v_add_f32_dpp v77, v77, v77 row_ror:2 row_mask:0xf bank_mask:0xf
v_mfma_f32_16x16x32_bf16 a[140:143], v[156:159], v[228:231], a[140:143]
v_add_f32_dpp v76, v76, v76 row_ror:1 row_mask:0xf bank_mask:0xf
v_add_f32_dpp v77, v77, v77 row_ror:1 row_mask:0xf bank_mask:0xf
v_mfma_f32_16x16x32_bf16 a[140:143], v[152:155], v[224:227], a[140:143]
ds_read_b64_tr_b16 v[244:245], v22 offset:24576
v_mov_b32 v78, v76
v_mfma_f32_16x16x32_bf16 a[144:147], v[160:163], v[224:227], a[144:147]
v_mov_b32 v79, v77
v_permlane16_swap_b32 v76, v78
v_mfma_f32_16x16x32_bf16 a[144:147], v[164:167], v[228:231], a[144:147]
v_permlane16_swap_b32 v77, v79
v_add_f32 v76, v76, v78
v_mfma_f32_16x16x32_bf16 a[148:151], v[172:175], v[228:231], a[148:151]
ds_read_b64_tr_b16 v[246:247], v22 offset:25600
v_add_f32 v77, v77, v79
v_mfma_f32_16x16x32_bf16 a[148:151], v[168:171], v[224:227], a[148:151]
v_mov_b32 v78, v76
v_mov_b32 v79, v77
v_mfma_f32_16x16x32_bf16 a[152:155], v[176:179], v[224:227], a[152:155]
v_permlane32_swap_b32 v76, v78
v_permlane32_swap_b32 v77, v79
v_mfma_f32_16x16x32_bf16 a[152:155], v[180:183], v[228:231], a[152:155]
v_add_f32 v76, v76, v78
v_add_f32 v77, v77, v79
v_mfma_f32_16x16x32_bf16 a[156:159], v[188:191], v[228:231], a[156:159]
v_mul_f32 v76, 0xbfb8aa3b, v76
v_mul_f32 v77, 0xbfb8aa3b, v77
v_mfma_f32_16x16x32_bf16 a[156:159], v[184:187], v[224:227], a[156:159]
s_waitcnt lgkmcnt(4)
v_exp_f32 v76, v76
v_mfma_f32_16x16x32_bf16 a[188:191], v[184:187], v[232:235], a[188:191]
ds_read_b64_tr_b16 v[248:249], v23 offset:16384
v_mfma_f32_16x16x32_bf16 a[188:191], v[188:191], v[236:239], a[188:191]
v_exp_f32 v77, v77
v_mfma_f32_16x16x32_bf16 a[184:187], v[180:183], v[236:239], a[184:187]
ds_read_b64_tr_b16 v[250:251], v23 offset:17408
v_add_f32 v76, 1.0, v76
v_mfma_f32_16x16x32_bf16 a[184:187], v[176:179], v[232:235], a[184:187]
v_add_f32 v77, 1.0, v77
v_mfma_f32_16x16x32_bf16 a[180:183], v[168:171], v[232:235], a[180:183]
ds_read_b64_tr_b16 v[252:253], v23 offset:24576
v_mfma_f32_16x16x32_bf16 a[180:183], v[172:175], v[236:239], a[180:183]
v_rcp_f32 v76, v76
v_mfma_f32_16x16x32_bf16 a[176:179], v[164:167], v[236:239], a[176:179]
ds_read_b64_tr_b16 v[254:255], v23 offset:25600
v_mfma_f32_16x16x32_bf16 a[176:179], v[160:163], v[232:235], a[176:179]
v_rcp_f32 v77, v77
v_mfma_f32_16x16x32_bf16 a[172:175], v[152:155], v[232:235], a[172:175]
s_lshr_b32 s80, s76, 9
v_mfma_f32_16x16x32_bf16 a[172:175], v[156:159], v[236:239], a[172:175]
s_add_u32 s80, s80, 0x3800000
v_min_u32 v78, 1, v0
v_lshlrev_b32 v78, 30, v78
v_mfma_f32_16x16x32_bf16 a[168:171], v[148:151], v[236:239], a[168:171]
buffer_store_dwordx2 v[76:77], v78, s[44:47], s80 offen sc1
v_mfma_f32_16x16x32_bf16 a[168:171], v[144:147], v[232:235], a[168:171]
v_mfma_f32_16x16x32_bf16 a[164:167], v[136:139], v[232:235], a[164:167]
v_mfma_f32_16x16x32_bf16 a[164:167], v[140:143], v[236:239], a[164:167]
v_mfma_f32_16x16x32_bf16 a[160:163], v[132:135], v[236:239], a[160:163]
s_waitcnt vmcnt(10) lgkmcnt(0)
v_mfma_f32_16x16x32_bf16 a[160:163], v[128:131], v[232:235], a[160:163]
s_barrier
v_mfma_f32_16x16x32_bf16 a[192:195], v[128:131], v[240:243], a[192:195]
s_lshl_b32 s71, s73, 12
ds_read_b64_tr_b16 v[224:225], v20 offset:32768
v_mfma_f32_16x16x32_bf16 a[192:195], v[132:135], v[244:247], a[192:195]
s_add_u32 s71, s71, s66
ds_read_b64_tr_b16 v[226:227], v20 offset:33792
v_mfma_f32_16x16x32_bf16 a[196:199], v[140:143], v[244:247], a[196:199]
s_add_u32 m0, s64, 0
v_mov_b32 v100, v20
v_mov_b32 v101, v21
v_mfma_f32_16x16x32_bf16 a[196:199], v[136:139], v[240:243], a[196:199]
s_add_u32 s72, s71, 0
buffer_load_dwordx4 v6, s[12:15], s72 offen lds
v_mfma_f32_16x16x32_bf16 a[200:203], v[144:147], v[240:243], a[200:203]
v_mov_b32 v102, v22
v_mov_b32 v103, v23
v_mfma_f32_16x16x32_bf16 a[200:203], v[148:151], v[244:247], a[200:203]
ds_read_b64_tr_b16 v[228:229], v20 offset:40960
v_mfma_f32_16x16x32_bf16 a[204:207], v[156:159], v[244:247], a[204:207]
s_add_u32 s72, s71, 31744
buffer_load_dwordx4 v6, s[12:15], s72 offen offset:1024 lds
v_mfma_f32_16x16x32_bf16 a[204:207], v[152:155], v[240:243], a[204:207]
ds_read_b64_tr_b16 v[230:231], v20 offset:41984
v_mfma_f32_16x16x32_bf16 a[208:211], v[160:163], v[240:243], a[208:211]
s_waitcnt lgkmcnt(15)
buffer_store_dwordx4 v[36:39], v26, s[44:47], s74 offen sc1
v_mfma_f32_16x16x32_bf16 a[208:211], v[164:167], v[244:247], a[208:211]
ds_read_b128 v[192:195], v24 offset:32768
v_mfma_f32_16x16x32_bf16 a[212:215], v[172:175], v[244:247], a[212:215]
ds_read_b128 v[196:199], v25 offset:32768
v_mfma_f32_16x16x32_bf16 a[212:215], v[168:171], v[240:243], a[212:215]
ds_read_b128 v[200:203], v24 offset:34816
v_mfma_f32_16x16x32_bf16 a[216:219], v[176:179], v[240:243], a[216:219]
s_add_u32 s72, s71, 63488
buffer_load_dwordx4 v7, s[12:15], s72 offen offset:2048 lds
v_mfma_f32_16x16x32_bf16 a[216:219], v[180:183], v[244:247], a[216:219]
ds_read_b128 v[204:207], v25 offset:34816
v_mfma_f32_16x16x32_bf16 a[220:223], v[188:191], v[244:247], a[220:223]
ds_read_b128 v[208:211], v24 offset:36864
v_mfma_f32_16x16x32_bf16 a[220:223], v[184:187], v[240:243], a[220:223]
ds_read_b128 v[212:215], v25 offset:36864
v_mfma_f32_16x16x32_bf16 a[252:255], v[184:187], v[248:251], a[252:255]
ds_read_b128 v[216:219], v24 offset:38912
v_mfma_f32_16x16x32_bf16 a[252:255], v[188:191], v[252:255], a[252:255]
ds_read_b128 v[220:223], v25 offset:38912
v_mfma_f32_16x16x32_bf16 a[248:251], v[180:183], v[252:255], a[248:251]
s_add_u32 s72, s71, 95232
buffer_load_dwordx4 v7, s[12:15], s72 offen offset:3072 lds
v_mfma_f32_16x16x32_bf16 a[248:251], v[176:179], v[248:251], a[248:251]
ds_read_b128 v[184:187], v24 offset:40960
v_mfma_f32_16x16x32_bf16 a[244:247], v[168:171], v[248:251], a[244:247]
ds_read_b128 v[188:191], v25 offset:40960
v_mfma_f32_16x16x32_bf16 a[244:247], v[172:175], v[252:255], a[244:247]
ds_read_b128 v[176:179], v24 offset:43008
v_mfma_f32_16x16x32_bf16 a[240:243], v[164:167], v[252:255], a[240:243]
ds_read_b128 v[180:183], v25 offset:43008
v_mfma_f32_16x16x32_bf16 a[240:243], v[160:163], v[248:251], a[240:243]
v_mfma_f32_16x16x32_bf16 a[236:239], v[152:155], v[248:251], a[236:239]
s_add_u32 s74, s74, 0x4000
buffer_store_dwordx4 v[40:43], v26, s[44:47], s74 offen sc1
v_mfma_f32_16x16x32_bf16 a[236:239], v[156:159], v[252:255], a[236:239]
s_add_u32 s73, s62, 1
ds_read_b128 v[168:171], v24 offset:45056
v_mfma_f32_16x16x32_bf16 a[232:235], v[148:151], v[252:255], a[232:235]
s_add_u32 s70, s73, s65
ds_read_b128 v[172:175], v25 offset:45056
v_mfma_f32_16x16x32_bf16 a[232:235], v[144:147], v[248:251], a[232:235]
s_and_b32 s70, s70, 3
ds_read_b128 v[160:163], v24 offset:47104
v_mfma_f32_16x16x32_bf16 a[228:231], v[136:139], v[248:251], a[228:231]
s_and_b32 s73, s73, 12
ds_read_b128 v[164:167], v25 offset:47104
v_mfma_f32_16x16x32_bf16 a[228:231], v[140:143], v[252:255], a[228:231]
s_or_b32 s73, s73, s70
v_mfma_f32_16x16x32_bf16 a[224:227], v[132:135], v[252:255], a[224:227]
s_lshl_b32 s73, s73, 7
ds_read_b64_tr_b16 v[232:233], v101 offset:32768
v_mfma_f32_16x16x32_bf16 a[224:227], v[128:131], v[248:251], a[224:227]
s_waitcnt lgkmcnt(9)
ds_read_b64_tr_b16 v[234:235], v101 offset:33792
v_mfma_f32_16x16x32_bf16 a[0:3], v[224:227], v[192:195], a[0:3]
s_add_u32 s69, s73, s67
ds_read_b64_tr_b16 v[236:237], v101 offset:40960
v_mfma_f32_16x16x32_bf16 a[0:3], v[228:231], v[196:199], a[0:3]
s_add_u32 s70, s73, s68
ds_read_b64_tr_b16 v[238:239], v101 offset:41984
v_mfma_f32_16x16x32_bf16 a[4:7], v[228:231], v[204:207], a[4:7]
s_add_u32 m0, s63, 65536
ds_read_b64_tr_b16 v[240:241], v102 offset:32768
v_mfma_f32_16x16x32_bf16 a[4:7], v[224:227], v[200:203], a[4:7]
s_add_u32 s72, s69, 0
buffer_load_dwordx4 v4, s[4:7], s72 offen lds
v_mfma_f32_16x16x32_bf16 a[8:11], v[224:227], v[208:211], a[8:11]
s_add_u32 s72, s69, 15360
buffer_load_dwordx4 v5, s[4:7], s72 offen offset:1024 lds
v_mfma_f32_16x16x32_bf16 a[8:11], v[228:231], v[212:215], a[8:11]
s_add_u32 s72, s69, 129024
buffer_load_dwordx4 v4, s[4:7], s72 offen offset:2048 lds
v_mfma_f32_16x16x32_bf16 a[12:15], v[228:231], v[220:223], a[12:15]
ds_read_b64_tr_b16 v[242:243], v102 offset:33792
v_mfma_f32_16x16x32_bf16 a[12:15], v[224:227], v[216:219], a[12:15]
s_waitcnt lgkmcnt(6)
v_mfma_f32_16x16x32_bf16 a[16:19], v[224:227], v[184:187], a[16:19]
s_add_u32 s74, s74, 0x4000
buffer_store_dwordx4 v[44:47], v26, s[44:47], s74 offen sc1
v_mfma_f32_16x16x32_bf16 a[16:19], v[228:231], v[188:191], a[16:19]
ds_read_b64_tr_b16 v[244:245], v102 offset:40960
v_mfma_f32_16x16x32_bf16 a[20:23], v[228:231], v[180:183], a[20:23]
v_mfma_f32_16x16x32_bf16 a[20:23], v[224:227], v[176:179], a[20:23]
ds_read_b64_tr_b16 v[246:247], v102 offset:41984
v_mfma_f32_16x16x32_bf16 a[24:27], v[224:227], v[168:171], a[24:27]
s_add_u32 s72, s69, 144384
buffer_load_dwordx4 v5, s[4:7], s72 offen offset:3072 lds
v_mfma_f32_16x16x32_bf16 a[24:27], v[228:231], v[172:175], a[24:27]
v_mfma_f32_16x16x32_bf16 a[28:31], v[228:231], v[164:167], a[28:31]
v_mfma_f32_16x16x32_bf16 a[28:31], v[224:227], v[160:163], a[28:31]
s_waitcnt lgkmcnt(4)
v_mfma_f32_16x16x32_bf16 a[60:63], v[232:235], v[160:163], a[60:63]
ds_read_b64_tr_b16 v[248:249], v103 offset:32768
v_mfma_f32_16x16x32_bf16 a[60:63], v[236:239], v[164:167], a[60:63]
v_mfma_f32_16x16x32_bf16 a[56:59], v[236:239], v[172:175], a[56:59]
s_add_u32 m0, s63, 69632
ds_read_b64_tr_b16 v[250:251], v103 offset:33792
v_mfma_f32_16x16x32_bf16 a[56:59], v[232:235], v[168:171], a[56:59]
s_add_u32 s72, s70, 0
buffer_load_dwordx4 v4, s[4:7], s72 offen lds
v_mfma_f32_16x16x32_bf16 a[52:55], v[232:235], v[176:179], a[52:55]
v_mfma_f32_16x16x32_bf16 a[52:55], v[236:239], v[180:183], a[52:55]
v_mfma_f32_16x16x32_bf16 a[48:51], v[236:239], v[188:191], a[48:51]
ds_read_b64_tr_b16 v[252:253], v103 offset:40960
v_mfma_f32_16x16x32_bf16 a[48:51], v[232:235], v[184:187], a[48:51]
v_mfma_f32_16x16x32_bf16 a[44:47], v[232:235], v[216:219], a[44:47]
s_add_u32 s72, s70, 15360
buffer_load_dwordx4 v5, s[4:7], s72 offen offset:1024 lds
v_mfma_f32_16x16x32_bf16 a[44:47], v[236:239], v[220:223], a[44:47]
s_add_u32 s74, s74, 0x4000
buffer_store_dwordx4 v[48:51], v26, s[44:47], s74 offen sc1
v_mfma_f32_16x16x32_bf16 a[40:43], v[236:239], v[212:215], a[40:43]
v_mfma_f32_16x16x32_bf16 a[40:43], v[232:235], v[208:211], a[40:43]
ds_read_b64_tr_b16 v[254:255], v103 offset:41984
v_mfma_f32_16x16x32_bf16 a[36:39], v[232:235], v[200:203], a[36:39]
v_mfma_f32_16x16x32_bf16 a[36:39], v[236:239], v[204:207], a[36:39]
v_mfma_f32_16x16x32_bf16 a[32:35], v[236:239], v[196:199], a[32:35]
v_mfma_f32_16x16x32_bf16 a[32:35], v[232:235], v[192:195], a[32:35]
s_waitcnt lgkmcnt(4)
v_mfma_f32_16x16x32_bf16 a[64:67], v[240:243], v[192:195], a[64:67]
s_add_u32 s72, s70, 129024
buffer_load_dwordx4 v4, s[4:7], s72 offen offset:2048 lds
v_mfma_f32_16x16x32_bf16 a[64:67], v[244:247], v[196:199], a[64:67]
ds_read_b64_tr_b16 v[224:225], v100 offset:49152
v_mfma_f32_16x16x32_bf16 a[68:71], v[244:247], v[204:207], a[68:71]
v_mfma_f32_16x16x32_bf16 a[68:71], v[240:243], v[200:203], a[68:71]
v_mfma_f32_16x16x32_bf16 a[72:75], v[240:243], v[208:211], a[72:75]
ds_read_b64_tr_b16 v[226:227], v100 offset:50176
v_mfma_f32_16x16x32_bf16 a[72:75], v[244:247], v[212:215], a[72:75]
s_add_u32 s72, s70, 144384
buffer_load_dwordx4 v5, s[4:7], s72 offen offset:3072 lds
v_mfma_f32_16x16x32_bf16 a[76:79], v[244:247], v[220:223], a[76:79]
v_mfma_f32_16x16x32_bf16 a[76:79], v[240:243], v[216:219], a[76:79]
v_mfma_f32_16x16x32_bf16 a[80:83], v[240:243], v[184:187], a[80:83]
ds_read_b64_tr_b16 v[228:229], v100 offset:57344
v_mfma_f32_16x16x32_bf16 a[80:83], v[244:247], v[188:191], a[80:83]
v_mfma_f32_16x16x32_bf16 a[84:87], v[244:247], v[180:183], a[84:87]
v_accvgpr_read_b32 v20, a0
v_accvgpr_read_b32 v28, a1
v_mfma_f32_16x16x32_bf16 a[84:87], v[240:243], v[176:179], a[84:87]
s_lshl_b32 s71, s73, 12
ds_read_b64_tr_b16 v[230:231], v100 offset:58368
v_accvgpr_read_b32 v21, a2
v_mfma_f32_16x16x32_bf16 a[88:91], v[240:243], v[168:171], a[88:91]
s_add_u32 s71, s71, s66
v_accvgpr_read_b32 v29, a3
v_accvgpr_read_b32 v22, a32
v_mfma_f32_16x16x32_bf16 a[88:91], v[244:247], v[172:175], a[88:91]
s_add_u32 m0, s64, 16384
v_accvgpr_read_b32 v30, a33
v_accvgpr_read_b32 v23, a34
v_mfma_f32_16x16x32_bf16 a[92:95], v[244:247], v[164:167], a[92:95]
s_add_u32 s72, s71, 0
buffer_load_dwordx4 v6, s[12:15], s72 offen lds
v_mfma_f32_16x16x32_bf16 a[92:95], v[240:243], v[160:163], a[92:95]
s_waitcnt lgkmcnt(4)
v_accvgpr_read_b32 v31, a35
v_mul_f32 v20, s79, v20
v_mfma_f32_16x16x32_bf16 a[124:127], v[248:251], v[160:163], a[124:127]
ds_read_b64_tr_b16 v[232:233], v101 offset:49152
v_mul_f32 v28, s79, v28
v_mfma_f32_16x16x32_bf16 a[124:127], v[252:255], v[164:167], a[124:127]
v_mul_f32 v21, s79, v21
v_mul_f32 v29, s79, v29
v_mfma_f32_16x16x32_bf16 a[120:123], v[252:255], v[172:175], a[120:123]
s_add_u32 s72, s71, 31744
buffer_load_dwordx4 v6, s[12:15], s72 offen offset:1024 lds
v_mfma_f32_16x16x32_bf16 a[120:123], v[248:251], v[168:171], a[120:123]
v_mul_f32 v22, s79, v22
v_mul_f32 v30, s79, v30
v_mfma_f32_16x16x32_bf16 a[116:119], v[248:251], v[176:179], a[116:119]
ds_read_b64_tr_b16 v[234:235], v101 offset:50176
v_mul_f32 v23, s79, v23
v_mfma_f32_16x16x32_bf16 a[116:119], v[252:255], v[180:183], a[116:119]
v_mul_f32 v31, s79, v31
v_cvt_pk_bf16_f32 v20, v20, v28
v_mfma_f32_16x16x32_bf16 a[112:115], v[252:255], v[188:191], a[112:115]
v_cvt_pk_bf16_f32 v21, v21, v29
v_cvt_pk_bf16_f32 v22, v22, v30
v_mfma_f32_16x16x32_bf16 a[112:115], v[248:251], v[184:187], a[112:115]
ds_read_b64_tr_b16 v[236:237], v101 offset:57344
v_cvt_pk_bf16_f32 v23, v23, v31
v_mfma_f32_16x16x32_bf16 a[108:111], v[248:251], v[216:219], a[108:111]
s_add_u32 s72, s71, 63488
buffer_load_dwordx4 v7, s[12:15], s72 offen offset:2048 lds
v_mfma_f32_16x16x32_bf16 a[108:111], v[252:255], v[220:223], a[108:111]
s_add_u32 s80, s77, 0
buffer_store_dwordx4 v[20:23], v1, s[44:47], s80 offen sc1
v_mfma_f32_16x16x32_bf16 a[104:107], v[252:255], v[212:215], a[104:107]
v_mfma_f32_16x16x32_bf16 a[104:107], v[248:251], v[208:211], a[104:107]
ds_read_b64_tr_b16 v[238:239], v101 offset:58368
v_mfma_f32_16x16x32_bf16 a[100:103], v[248:251], v[200:203], a[100:103]
v_mfma_f32_16x16x32_bf16 a[100:103], v[252:255], v[204:207], a[100:103]
v_mfma_f32_16x16x32_bf16 a[96:99], v[252:255], v[196:199], a[96:99]
s_add_u32 s72, s71, 95232
buffer_load_dwordx4 v7, s[12:15], s72 offen offset:3072 lds
v_mfma_f32_16x16x32_bf16 a[96:99], v[248:251], v[192:195], a[96:99]
s_waitcnt lgkmcnt(4)
LcB0:
v_mfma_f32_16x16x32_bf16 a[128:131], v[192:195], v[224:227], a[128:131]
ds_read_b64_tr_b16 v[240:241], v102 offset:49152
v_accvgpr_read_b32 v24, a4
v_mfma_f32_16x16x32_bf16 a[128:131], v[196:199], v[228:231], a[128:131]
v_accvgpr_read_b32 v28, a5
v_accvgpr_read_b32 v25, a6
v_mfma_f32_16x16x32_bf16 a[132:135], v[204:207], v[228:231], a[132:135]
v_accvgpr_read_b32 v29, a7
v_accvgpr_read_b32 v26, a36
v_mfma_f32_16x16x32_bf16 a[132:135], v[200:203], v[224:227], a[132:135]
ds_read_b64_tr_b16 v[242:243], v102 offset:50176
v_accvgpr_read_b32 v30, a37
v_mfma_f32_16x16x32_bf16 a[136:139], v[208:211], v[224:227], a[136:139]
v_accvgpr_read_b32 v27, a38
v_accvgpr_read_b32 v31, a39
v_mfma_f32_16x16x32_bf16 a[136:139], v[212:215], v[228:231], a[136:139]
v_mul_f32 v24, s79, v24
v_mul_f32 v28, s79, v28
v_mfma_f32_16x16x32_bf16 a[140:143], v[220:223], v[228:231], a[140:143]
v_mul_f32 v25, s79, v25
v_mul_f32 v29, s79, v29
v_mfma_f32_16x16x32_bf16 a[140:143], v[216:219], v[224:227], a[140:143]
ds_read_b64_tr_b16 v[244:245], v102 offset:57344
v_mul_f32 v26, s79, v26
v_mfma_f32_16x16x32_bf16 a[144:147], v[184:187], v[224:227], a[144:147]
v_mul_f32 v30, s79, v30
v_mul_f32 v27, s79, v27
v_mfma_f32_16x16x32_bf16 a[144:147], v[188:191], v[228:231], a[144:147]
v_mul_f32 v31, s79, v31
v_cvt_pk_bf16_f32 v24, v24, v28
v_mfma_f32_16x16x32_bf16 a[148:151], v[180:183], v[228:231], a[148:151]
ds_read_b64_tr_b16 v[246:247], v102 offset:58368
v_cvt_pk_bf16_f32 v25, v25, v29
v_mfma_f32_16x16x32_bf16 a[148:151], v[176:179], v[224:227], a[148:151]
v_cvt_pk_bf16_f32 v26, v26, v30
v_cvt_pk_bf16_f32 v27, v27, v31
v_mfma_f32_16x16x32_bf16 a[152:155], v[168:171], v[224:227], a[152:155]
s_add_u32 s80, s77, 4096
buffer_store_dwordx4 v[24:27], v1, s[44:47], s80 offen sc1
v_mfma_f32_16x16x32_bf16 a[152:155], v[172:175], v[228:231], a[152:155]
v_mfma_f32_16x16x32_bf16 a[156:159], v[164:167], v[228:231], a[156:159]
v_mfma_f32_16x16x32_bf16 a[156:159], v[160:163], v[224:227], a[156:159]
s_waitcnt lgkmcnt(4)
v_mfma_f32_16x16x32_bf16 a[188:191], v[160:163], v[232:235], a[188:191]
ds_read_b64_tr_b16 v[248:249], v103 offset:49152
v_mfma_f32_16x16x32_bf16 a[188:191], v[164:167], v[236:239], a[188:191]
v_mfma_f32_16x16x32_bf16 a[184:187], v[172:175], v[236:239], a[184:187]
ds_read_b64_tr_b16 v[250:251], v103 offset:50176
v_mfma_f32_16x16x32_bf16 a[184:187], v[168:171], v[232:235], a[184:187]
v_mfma_f32_16x16x32_bf16 a[180:183], v[176:179], v[232:235], a[180:183]
ds_read_b64_tr_b16 v[252:253], v103 offset:57344
v_mfma_f32_16x16x32_bf16 a[180:183], v[180:183], v[236:239], a[180:183]
s_add_u32 s73, s62, 2
v_mfma_f32_16x16x32_bf16 a[176:179], v[188:191], v[236:239], a[176:179]
s_add_u32 s70, s73, s65
ds_read_b64_tr_b16 v[254:255], v103 offset:58368
v_accvgpr_read_b32 v20, a8
v_mfma_f32_16x16x32_bf16 a[176:179], v[184:187], v[232:235], a[176:179]
s_and_b32 s70, s70, 3
v_accvgpr_read_b32 v28, a9
v_accvgpr_read_b32 v21, a10
v_mfma_f32_16x16x32_bf16 a[172:175], v[216:219], v[232:235], a[172:175]
s_and_b32 s73, s73, 12
v_accvgpr_read_b32 v29, a11
v_accvgpr_read_b32 v22, a40
v_mfma_f32_16x16x32_bf16 a[172:175], v[220:223], v[236:239], a[172:175]
s_or_b32 s73, s73, s70
v_accvgpr_read_b32 v30, a41
v_accvgpr_read_b32 v23, a42
v_mfma_f32_16x16x32_bf16 a[168:171], v[212:215], v[236:239], a[168:171]
s_lshl_b32 s73, s73, 7
v_accvgpr_read_b32 v31, a43
v_mul_f32 v20, s79, v20
v_mfma_f32_16x16x32_bf16 a[168:171], v[208:211], v[232:235], a[168:171]
s_add_u32 s69, s73, s67
v_mul_f32 v28, s79, v28
v_mul_f32 v21, s79, v21
v_mfma_f32_16x16x32_bf16 a[164:167], v[200:203], v[232:235], a[164:167]
s_add_u32 s70, s73, s68
v_mul_f32 v29, s79, v29
v_mul_f32 v22, s79, v22
v_mfma_f32_16x16x32_bf16 a[164:167], v[204:207], v[236:239], a[164:167]
s_add_u32 m0, s63, 98304
v_mul_f32 v30, s79, v30
v_mul_f32 v23, s79, v23
v_mfma_f32_16x16x32_bf16 a[160:163], v[196:199], v[236:239], a[160:163]
s_waitcnt vmcnt(8) lgkmcnt(0)
v_mul_f32 v31, s79, v31
v_cvt_pk_bf16_f32 v20, v20, v28
v_mfma_f32_16x16x32_bf16 a[160:163], v[192:195], v[232:235], a[160:163]
s_barrier
v_cvt_pk_bf16_f32 v21, v21, v29
v_cvt_pk_bf16_f32 v22, v22, v30
v_mfma_f32_16x16x32_bf16 a[192:195], v[192:195], v[240:243], a[192:195]
s_add_u32 s72, s69, 0
buffer_load_dwordx4 v4, s[4:7], s72 offen lds
v_mfma_f32_16x16x32_bf16 a[192:195], v[196:199], v[244:247], a[192:195]
s_lshl_b32 s74, s59, 2
ds_read_b64_tr_b16 v[64:65], v8 offset:0
v_or_b32 v106, s58, v0
v_mfma_f32_16x16x32_bf16 a[196:199], v[204:207], v[244:247], a[196:199]
ds_read_b64_tr_b16 v[66:67], v8 offset:1024
v_mov_b32 v107, 1
v_mfma_f32_16x16x32_bf16 a[196:199], v[200:203], v[240:243], a[196:199]
ds_read_b64_tr_b16 v[68:69], v8 offset:8192
v_lshlrev_b32 v106, 8, v106
v_mfma_f32_16x16x32_bf16 a[200:203], v[208:211], v[240:243], a[200:203]
ds_read_b64_tr_b16 v[70:71], v8 offset:9216
v_cvt_pk_bf16_f32 v23, v23, v31
v_mfma_f32_16x16x32_bf16 a[200:203], v[212:215], v[244:247], a[200:203]
s_add_u32 s72, s69, 15360
buffer_load_dwordx4 v5, s[4:7], s72 offen offset:1024 lds
v_mfma_f32_16x16x32_bf16 a[204:207], v[220:223], v[244:247], a[204:207]
s_add_u32 s80, s77, 8192
ds_read_b128 v[32:35], v16 offset:0
v_mfma_f32_16x16x32_bf16 a[204:207], v[216:219], v[240:243], a[204:207]
buffer_atomic_add v107, v106, s[48:51], s74 offen sc1
v_mfma_f32_16x16x32_bf16 a[208:211], v[184:187], v[240:243], a[208:211]
ds_read_b128 v[36:39], v17 offset:0
v_mfma_f32_16x16x32_bf16 a[208:211], v[188:191], v[244:247], a[208:211]
ds_read_b128 v[40:43], v16 offset:2048
v_mfma_f32_16x16x32_bf16 a[212:215], v[180:183], v[244:247], a[212:215]
s_add_u32 s72, s69, 129024
buffer_load_dwordx4 v4, s[4:7], s72 offen offset:2048 lds
v_mfma_f32_16x16x32_bf16 a[212:215], v[176:179], v[240:243], a[212:215]
ds_read_b128 v[44:47], v17 offset:2048
v_mfma_f32_16x16x32_bf16 a[216:219], v[168:171], v[240:243], a[216:219]
ds_read_b128 v[48:51], v16 offset:4096
v_accvgpr_read_b32 v24, a128
v_mfma_f32_16x16x32_bf16 a[216:219], v[172:175], v[244:247], a[216:219]
ds_read_b128 v[52:55], v17 offset:4096
v_accvgpr_read_b32 v28, a129
v_mfma_f32_16x16x32_bf16 a[220:223], v[164:167], v[244:247], a[220:223]
buffer_store_dwordx4 v[20:23], v1, s[44:47], s80 offen sc1
v_mfma_f32_16x16x32_bf16 a[220:223], v[160:163], v[240:243], a[220:223]
s_add_u32 s72, s69, 144384
buffer_load_dwordx4 v5, s[4:7], s72 offen offset:3072 lds
v_mfma_f32_16x16x32_bf16 a[252:255], v[160:163], v[248:251], a[252:255]
ds_read_b128 v[56:59], v16 offset:6144
v_accvgpr_read_b32 v25, a130
v_mfma_f32_16x16x32_bf16 a[252:255], v[164:167], v[252:255], a[252:255]
ds_read_b128 v[60:63], v17 offset:6144
v_accvgpr_read_b32 v29, a131
v_mfma_f32_16x16x32_bf16 a[248:251], v[172:175], v[252:255], a[248:251]
ds_read_b64_tr_b16 v[72:73], v9 offset:0
v_accvgpr_read_b32 v26, a132
v_mfma_f32_16x16x32_bf16 a[248:251], v[168:171], v[248:251], a[248:251]
s_add_u32 m0, s63, 102400
ds_read_b64_tr_b16 v[74:75], v9 offset:1024
v_accvgpr_read_b32 v30, a133
v_mfma_f32_16x16x32_bf16 a[244:247], v[176:179], v[248:251], a[244:247]
s_add_u32 s72, s70, 0
buffer_load_dwordx4 v4, s[4:7], s72 offen lds
v_mfma_f32_16x16x32_bf16 a[244:247], v[180:183], v[252:255], a[244:247]
ds_read_b64_tr_b16 v[76:77], v9 offset:8192
v_accvgpr_read_b32 v27, a134
v_mfma_f32_16x16x32_bf16 a[240:243], v[188:191], v[252:255], a[240:243]
v_accvgpr_read_b32 v31, a135
v_cvt_pk_bf16_f32 v24, v24, v28
v_mfma_f32_16x16x32_bf16 a[240:243], v[184:187], v[248:251], a[240:243]
ds_read_b64_tr_b16 v[78:79], v9 offset:9216
v_cvt_pk_bf16_f32 v25, v25, v29
v_mfma_f32_16x16x32_bf16 a[236:239], v[216:219], v[248:251], a[236:239]
ds_read_b64_tr_b16 v[80:81], v10 offset:0
v_cvt_pk_bf16_f32 v26, v26, v30
v_mfma_f32_16x16x32_bf16 a[236:239], v[220:223], v[252:255], a[236:239]
s_add_u32 s72, s70, 15360
buffer_load_dwordx4 v5, s[4:7], s72 offen offset:1024 lds
v_mfma_f32_16x16x32_bf16 a[232:235], v[212:215], v[252:255], a[232:235]
ds_read_b64_tr_b16 v[82:83], v10 offset:1024
v_cvt_pk_bf16_f32 v27, v27, v31
v_mfma_f32_16x16x32_bf16 a[232:235], v[208:211], v[248:251], a[232:235]
s_add_u32 s80, s78, 0
ds_read_b64_tr_b16 v[84:85], v10 offset:8192
v_mfma_f32_16x16x32_bf16 a[228:231], v[200:203], v[248:251], a[228:231]
ds_read_b64_tr_b16 v[86:87], v10 offset:9216
v_mfma_f32_16x16x32_bf16 a[228:231], v[204:207], v[252:255], a[228:231]
buffer_store_dwordx4 v[24:27], v1, s[44:47], s80 offen sc1
v_mfma_f32_16x16x32_bf16 a[224:227], v[196:199], v[252:255], a[224:227]
s_add_u32 s72, s70, 129024
buffer_load_dwordx4 v4, s[4:7], s72 offen offset:2048 lds
v_mfma_f32_16x16x32_bf16 a[224:227], v[192:195], v[248:251], a[224:227]
s_waitcnt lgkmcnt(8)
v_mfma_f32_16x16x32_bf16 v[128:131], v[64:67], v[32:35], 0
ds_read_b64_tr_b16 v[88:89], v11 offset:0
v_mfma_f32_16x16x32_bf16 v[128:131], v[68:71], v[36:39], v[128:131]
ds_read_b64_tr_b16 v[90:91], v11 offset:1024
v_mfma_f32_16x16x32_bf16 v[132:135], v[68:71], v[44:47], 0
v_accvgpr_read_b32 v20, a12
v_accvgpr_read_b32 v28, a13
v_mfma_f32_16x16x32_bf16 v[132:135], v[64:67], v[40:43], v[132:135]
s_add_u32 s72, s70, 144384
buffer_load_dwordx4 v5, s[4:7], s72 offen offset:3072 lds
v_mfma_f32_16x16x32_bf16 v[136:139], v[64:67], v[48:51], 0
s_lshl_b32 s71, s73, 12
ds_read_b64_tr_b16 v[92:93], v11 offset:8192
v_accvgpr_read_b32 v21, a14
v_mfma_f32_16x16x32_bf16 v[136:139], v[68:71], v[52:55], v[136:139]
s_add_u32 s71, s71, s66
v_accvgpr_read_b32 v29, a15
v_accvgpr_read_b32 v22, a44
v_mfma_f32_16x16x32_bf16 v[140:143], v[68:71], v[60:63], 0
s_add_u32 m0, s64, 32768
ds_read_b64_tr_b16 v[94:95], v11 offset:9216
v_accvgpr_read_b32 v30, a45
v_mfma_f32_16x16x32_bf16 v[140:143], v[64:67], v[56:59], v[140:143]
s_waitcnt lgkmcnt(8)
v_accvgpr_read_b32 v23, a46
v_accvgpr_read_b32 v31, a47
v_mfma_f32_16x16x32_bf16 v[156:159], v[72:75], v[56:59], 0
s_add_u32 s72, s71, 0
buffer_load_dwordx4 v6, s[12:15], s72 offen lds
v_mfma_f32_16x16x32_bf16 v[156:159], v[76:79], v[60:63], v[156:159]
s_add_u32 s73, s62, 3
ds_read_b64_tr_b16 v[64:65], v12 offset:0
v_mul_f32 v20, s79, v20
v_mfma_f32_16x16x32_bf16 v[152:155], v[76:79], v[52:55], 0
s_add_u32 s70, s73, s65
ds_read_b64_tr_b16 v[66:67], v12 offset:1024
v_mul_f32 v28, s79, v28
v_mfma_f32_16x16x32_bf16 v[152:155], v[72:75], v[48:51], v[152:155]
s_add_u32 s72, s71, 31744
buffer_load_dwordx4 v6, s[12:15], s72 offen offset:1024 lds
v_mfma_f32_16x16x32_bf16 v[148:151], v[72:75], v[40:43], 0
s_and_b32 s70, s70, 3
v_mul_f32 v21, s79, v21
v_mul_f32 v29, s79, v29
v_mfma_f32_16x16x32_bf16 v[148:151], v[76:79], v[44:47], v[148:151]
s_and_b32 s73, s73, 12
ds_read_b64_tr_b16 v[68:69], v12 offset:8192
v_mul_f32 v22, s79, v22
v_mfma_f32_16x16x32_bf16 v[144:147], v[76:79], v[36:39], 0
s_or_b32 s73, s73, s70
ds_read_b64_tr_b16 v[70:71], v12 offset:9216
v_mul_f32 v30, s79, v30
v_mfma_f32_16x16x32_bf16 v[144:147], v[72:75], v[32:35], v[144:147]
s_waitcnt lgkmcnt(8)
v_mul_f32 v23, s79, v23
v_mul_f32 v31, s79, v31
v_mfma_f32_16x16x32_bf16 v[160:163], v[80:83], v[32:35], 0
s_lshl_b32 s73, s73, 7
ds_read_b64_tr_b16 v[72:73], v13 offset:0
v_cvt_pk_bf16_f32 v20, v20, v28
v_mfma_f32_16x16x32_bf16 v[160:163], v[84:87], v[36:39], v[160:163]
s_add_u32 s72, s71, 63488
buffer_load_dwordx4 v7, s[12:15], s72 offen offset:2048 lds
v_mfma_f32_16x16x32_bf16 v[164:167], v[84:87], v[44:47], 0
s_add_u32 s69, s73, s67
ds_read_b64_tr_b16 v[74:75], v13 offset:1024
v_cvt_pk_bf16_f32 v21, v21, v29
v_mfma_f32_16x16x32_bf16 v[164:167], v[80:83], v[40:43], v[164:167]
s_add_u32 s70, s73, s68
v_cvt_pk_bf16_f32 v22, v22, v30
v_cvt_pk_bf16_f32 v23, v23, v31
v_mfma_f32_16x16x32_bf16 v[168:171], v[80:83], v[48:51], 0
s_waitcnt vmcnt(20)
ds_read_b64_tr_b16 v[76:77], v13 offset:8192
v_mfma_f32_16x16x32_bf16 v[168:171], v[84:87], v[52:55], v[168:171]
s_add_u32 s80, s77, 12288
ds_read_b64_tr_b16 v[78:79], v13 offset:9216
v_mfma_f32_16x16x32_bf16 v[172:175], v[84:87], v[60:63], 0
s_add_u32 s72, s71, 95232
ds_read_b128 v[96:99], v18 offset:0
v_mfma_f32_16x16x32_bf16 v[172:175], v[80:83], v[56:59], v[172:175]
s_waitcnt lgkmcnt(9)
buffer_load_dwordx4 v7, s[12:15], s72 offen offset:3072 lds
v_mfma_f32_16x16x32_bf16 v[188:191], v[88:91], v[56:59], 0
ds_read_b64_tr_b16 v[80:81], v14 offset:0
v_accvgpr_read_b32 v24, a136
v_mfma_f32_16x16x32_bf16 v[188:191], v[92:95], v[60:63], v[188:191]
ds_read_b64_tr_b16 v[82:83], v14 offset:1024
v_accvgpr_read_b32 v28, a137
v_mfma_f32_16x16x32_bf16 v[184:187], v[92:95], v[52:55], 0
ds_read_b128 v[100:103], v19 offset:0
v_accvgpr_read_b32 v25, a138
v_mfma_f32_16x16x32_bf16 v[184:187], v[88:91], v[48:51], v[184:187]
ds_read_b64_tr_b16 v[84:85], v14 offset:8192
v_accvgpr_read_b32 v29, a139
v_mfma_f32_16x16x32_bf16 v[180:183], v[88:91], v[40:43], 0
buffer_store_dwordx4 v[20:23], v1, s[44:47], s80 offen sc1
v_mfma_f32_16x16x32_bf16 v[180:183], v[92:95], v[44:47], v[180:183]
s_add_u32 m0, s63, 131072
ds_read_b64_tr_b16 v[86:87], v14 offset:9216
v_accvgpr_read_b32 v26, a140
v_mfma_f32_16x16x32_bf16 v[176:179], v[92:95], v[36:39], 0
s_add_u32 s72, s69, 0
buffer_load_dwordx4 v4, s[4:7], s72 offen lds
v_mfma_f32_16x16x32_bf16 v[176:179], v[88:91], v[32:35], v[176:179]
s_waitcnt lgkmcnt(10)
ds_read_b128 v[104:107], v18 offset:2048
v_accvgpr_read_b32 v30, a141
v_mfma_f32_16x16x32_bf16 v[192:195], v[64:67], v[32:35], 0
ds_read_b64_tr_b16 v[88:89], v15 offset:0
v_accvgpr_read_b32 v27, a142
v_mfma_f32_16x16x32_bf16 v[192:195], v[68:71], v[36:39], v[192:195]
ds_read_b64_tr_b16 v[90:91], v15 offset:1024
v_accvgpr_read_b32 v31, a143
v_mfma_f32_16x16x32_bf16 v[196:199], v[68:71], v[44:47], 0
ds_read_b64_tr_b16 v[92:93], v15 offset:8192
v_cvt_pk_bf16_f32 v24, v24, v28
v_mfma_f32_16x16x32_bf16 v[196:199], v[64:67], v[40:43], v[196:199]
s_add_u32 s72, s69, 15360
buffer_load_dwordx4 v5, s[4:7], s72 offen offset:1024 lds
v_mfma_f32_16x16x32_bf16 v[200:203], v[64:67], v[48:51], 0
ds_read_b64_tr_b16 v[94:95], v15 offset:9216
v_cvt_pk_bf16_f32 v25, v25, v29
v_mfma_f32_16x16x32_bf16 v[200:203], v[68:71], v[52:55], v[200:203]
ds_read_b128 v[108:111], v19 offset:2048
v_cvt_pk_bf16_f32 v26, v26, v30
v_mfma_f32_16x16x32_bf16 v[204:207], v[68:71], v[60:63], 0
v_cvt_pk_bf16_f32 v27, v27, v31
v_mfma_f32_16x16x32_bf16 v[204:207], v[64:67], v[56:59], v[204:207]
s_waitcnt lgkmcnt(12)
ds_read_b128 v[112:115], v18 offset:4096
v_mfma_f32_16x16x32_bf16 v[220:223], v[72:75], v[56:59], 0
s_add_u32 s72, s69, 129024
buffer_load_dwordx4 v4, s[4:7], s72 offen offset:2048 lds
v_mfma_f32_16x16x32_bf16 v[220:223], v[76:79], v[60:63], v[220:223]
s_add_u32 s80, s78, 8192
buffer_store_dwordx4 v[24:27], v1, s[44:47], s80 offen sc1
v_mfma_f32_16x16x32_bf16 v[216:219], v[76:79], v[52:55], 0
s_waitcnt vmcnt(21) lgkmcnt(2)
ds_read_b128 v[116:119], v19 offset:4096
v_mfma_f32_16x16x32_bf16 v[216:219], v[72:75], v[48:51], v[216:219]
s_barrier
ds_read_b128 v[120:123], v18 offset:6144
v_mfma_f32_16x16x32_bf16 v[212:215], v[72:75], v[40:43], 0
ds_read_b64_tr_b16 v[64:65], v8 offset:16384
ds_read_b64_tr_b16 v[66:67], v8 offset:17408
v_mfma_f32_16x16x32_bf16 v[212:215], v[76:79], v[44:47], v[212:215]
ds_read_b64_tr_b16 v[68:69], v8 offset:24576
v_mfma_f32_16x16x32_bf16 v[208:211], v[76:79], v[36:39], 0
s_add_u32 s72, s69, 144384
buffer_load_dwordx4 v5, s[4:7], s72 offen offset:3072 lds
v_mfma_f32_16x16x32_bf16 v[208:211], v[72:75], v[32:35], v[208:211]
ds_read_b64_tr_b16 v[70:71], v8 offset:25600
v_accvgpr_read_b32 v20, a16
v_mfma_f32_16x16x32_bf16 v[224:227], v[80:83], v[32:35], 0
ds_read_b64_tr_b16 v[72:73], v9 offset:16384
v_accvgpr_read_b32 v28, a17
v_mfma_f32_16x16x32_bf16 v[224:227], v[84:87], v[36:39], v[224:227]
ds_read_b64_tr_b16 v[74:75], v9 offset:17408
v_accvgpr_read_b32 v21, a18
v_mfma_f32_16x16x32_bf16 v[228:231], v[84:87], v[44:47], 0
s_add_u32 m0, s63, 135168
v_accvgpr_read_b32 v29, a19
v_accvgpr_read_b32 v22, a48
v_mfma_f32_16x16x32_bf16 v[228:231], v[80:83], v[40:43], v[228:231]
s_add_u32 s72, s70, 0
buffer_load_dwordx4 v4, s[4:7], s72 offen lds
v_mfma_f32_16x16x32_bf16 v[232:235], v[80:83], v[48:51], 0
ds_read_b64_tr_b16 v[76:77], v9 offset:24576
v_accvgpr_read_b32 v30, a49
v_mfma_f32_16x16x32_bf16 v[232:235], v[84:87], v[52:55], v[232:235]
ds_read_b128 v[124:127], v19 offset:6144
v_accvgpr_read_b32 v23, a50
v_mfma_f32_16x16x32_bf16 v[236:239], v[84:87], v[60:63], 0
ds_read_b64_tr_b16 v[78:79], v9 offset:25600
v_accvgpr_read_b32 v31, a51
v_mfma_f32_16x16x32_bf16 v[236:239], v[80:83], v[56:59], v[236:239]
v_mul_f32 v20, s79, v20
v_mul_f32 v28, s79, v28
v_mfma_f32_16x16x32_bf16 v[252:255], v[88:91], v[56:59], 0
s_add_u32 s72, s70, 15360
buffer_load_dwordx4 v5, s[4:7], s72 offen offset:1024 lds
v_mfma_f32_16x16x32_bf16 v[252:255], v[92:95], v[60:63], v[252:255]
ds_read_b64_tr_b16 v[80:81], v10 offset:16384
v_mul_f32 v21, s79, v21
v_mfma_f32_16x16x32_bf16 v[248:251], v[92:95], v[52:55], 0
ds_read_b64_tr_b16 v[82:83], v10 offset:17408
v_mul_f32 v29, s79, v29
v_mfma_f32_16x16x32_bf16 v[248:251], v[88:91], v[48:51], v[248:251]
v_mul_f32 v22, s79, v22
v_mul_f32 v30, s79, v30
v_mfma_f32_16x16x32_bf16 v[244:247], v[88:91], v[40:43], 0
ds_read_b64_tr_b16 v[84:85], v10 offset:24576
v_mul_f32 v23, s79, v23
v_mfma_f32_16x16x32_bf16 v[244:247], v[92:95], v[44:47], v[244:247]
ds_read_b64_tr_b16 v[86:87], v10 offset:25600
v_mul_f32 v31, s79, v31
v_mfma_f32_16x16x32_bf16 v[240:243], v[92:95], v[36:39], 0
s_add_u32 s72, s70, 129024
buffer_load_dwordx4 v4, s[4:7], s72 offen offset:2048 lds
v_mfma_f32_16x16x32_bf16 v[240:243], v[88:91], v[32:35], v[240:243]
s_waitcnt lgkmcnt(5)
v_cvt_pk_bf16_f32 v20, v20, v28
v_cvt_pk_bf16_f32 v21, v21, v29
v_mfma_f32_16x16x32_bf16 v[128:131], v[64:67], v[96:99], v[128:131]
ds_read_b64_tr_b16 v[88:89], v11 offset:16384
v_cvt_pk_bf16_f32 v22, v22, v30
v_mfma_f32_16x16x32_bf16 v[128:131], v[68:71], v[100:103], v[128:131]
ds_read_b64_tr_b16 v[90:91], v11 offset:17408
v_cvt_pk_bf16_f32 v23, v23, v31
v_mfma_f32_16x16x32_bf16 v[132:135], v[68:71], v[108:111], v[132:135]
s_add_u32 s80, s77, 32768
buffer_store_dwordx4 v[20:23], v1, s[44:47], s80 offen sc1
v_mfma_f32_16x16x32_bf16 v[132:135], v[64:67], v[104:107], v[132:135]
s_add_u32 s72, s70, 144384
buffer_load_dwordx4 v5, s[4:7], s72 offen offset:3072 lds
v_mfma_f32_16x16x32_bf16 v[136:139], v[64:67], v[112:115], v[136:139]
ds_read_b64_tr_b16 v[92:93], v11 offset:24576
v_accvgpr_read_b32 v24, a144
v_mfma_f32_16x16x32_bf16 v[136:139], v[68:71], v[116:119], v[136:139]
s_lshl_b32 s71, s73, 12
v_accvgpr_read_b32 v28, a145
v_accvgpr_read_b32 v25, a146
v_mfma_f32_16x16x32_bf16 v[140:143], v[68:71], v[124:127], v[140:143]
s_add_u32 s71, s71, s66
ds_read_b64_tr_b16 v[94:95], v11 offset:25600
v_accvgpr_read_b32 v29, a147
v_mfma_f32_16x16x32_bf16 v[140:143], v[64:67], v[120:123], v[140:143]
s_waitcnt lgkmcnt(8)
v_accvgpr_read_b32 v26, a148
v_accvgpr_read_b32 v30, a149
v_mfma_f32_16x16x32_bf16 v[156:159], v[72:75], v[120:123], v[156:159]
s_add_u32 m0, s64, 0
ds_read_b64_tr_b16 v[64:65], v12 offset:16384
v_accvgpr_read_b32 v27, a150
v_mfma_f32_16x16x32_bf16 v[156:159], v[76:79], v[124:127], v[156:159]
s_add_u32 s72, s71, 0
buffer_load_dwordx4 v6, s[12:15], s72 offen lds
v_mfma_f32_16x16x32_bf16 v[152:155], v[76:79], v[116:119], v[152:155]
s_add_u32 s73, s62, 4
ds_read_b64_tr_b16 v[66:67], v12 offset:17408
v_accvgpr_read_b32 v31, a151
v_mfma_f32_16x16x32_bf16 v[152:155], v[72:75], v[112:115], v[152:155]
s_add_u32 s70, s73, s65
v_cvt_pk_bf16_f32 v24, v24, v28
v_cvt_pk_bf16_f32 v25, v25, v29
v_mfma_f32_16x16x32_bf16 v[148:151], v[72:75], v[104:107], v[148:151]
s_and_b32 s70, s70, 3
ds_read_b64_tr_b16 v[68:69], v12 offset:24576
v_cvt_pk_bf16_f32 v26, v26, v30
v_mfma_f32_16x16x32_bf16 v[148:151], v[76:79], v[108:111], v[148:151]
s_and_b32 s73, s73, 12
ds_read_b64_tr_b16 v[70:71], v12 offset:25600
v_cvt_pk_bf16_f32 v27, v27, v31
v_mfma_f32_16x16x32_bf16 v[144:147], v[76:79], v[100:103], v[144:147]
s_add_u32 s72, s71, 31744
buffer_load_dwordx4 v6, s[12:15], s72 offen offset:1024 lds
v_mfma_f32_16x16x32_bf16 v[144:147], v[72:75], v[96:99], v[144:147]
s_waitcnt lgkmcnt(8)
v_mfma_f32_16x16x32_bf16 v[160:163], v[80:83], v[96:99], v[160:163]
s_or_b32 s73, s73, s70
ds_read_b64_tr_b16 v[72:73], v13 offset:16384
v_mfma_f32_16x16x32_bf16 v[160:163], v[84:87], v[100:103], v[160:163]
s_lshl_b32 s73, s73, 7
ds_read_b64_tr_b16 v[74:75], v13 offset:17408
v_mfma_f32_16x16x32_bf16 v[164:167], v[84:87], v[108:111], v[164:167]
s_add_u32 s69, s73, s67
v_mfma_f32_16x16x32_bf16 v[164:167], v[80:83], v[104:107], v[164:167]
s_add_u32 s72, s71, 63488
buffer_load_dwordx4 v7, s[12:15], s72 offen offset:2048 lds
v_mfma_f32_16x16x32_bf16 v[168:171], v[80:83], v[112:115], v[168:171]
s_waitcnt vmcnt(18)
ds_read_b64_tr_b16 v[76:77], v13 offset:24576
v_mfma_f32_16x16x32_bf16 v[168:171], v[84:87], v[116:119], v[168:171]
s_add_u32 s70, s73, s68
ds_read_b128 v[32:35], v18 offset:32768
v_mfma_f32_16x16x32_bf16 v[172:175], v[84:87], v[124:127], v[172:175]
s_add_u32 s80, s78, 32768
ds_read_b64_tr_b16 v[78:79], v13 offset:25600
v_mfma_f32_16x16x32_bf16 v[172:175], v[80:83], v[120:123], v[172:175]
s_waitcnt lgkmcnt(9)
ds_read_b128 v[36:39], v19 offset:32768
v_mfma_f32_16x16x32_bf16 v[188:191], v[88:91], v[120:123], v[188:191]
s_add_u32 s72, s71, 95232
buffer_load_dwordx4 v7, s[12:15], s72 offen offset:3072 lds
v_mfma_f32_16x16x32_bf16 v[188:191], v[92:95], v[124:127], v[188:191]
ds_read_b64_tr_b16 v[80:81], v14 offset:16384
v_mfma_f32_16x16x32_bf16 v[184:187], v[92:95], v[116:119], v[184:187]
ds_read_b64_tr_b16 v[82:83], v14 offset:17408
v_mfma_f32_16x16x32_bf16 v[184:187], v[88:91], v[112:115], v[184:187]
buffer_store_dwordx4 v[24:27], v1, s[44:47], s80 offen sc1
v_mfma_f32_16x16x32_bf16 v[180:183], v[88:91], v[104:107], v[180:183]
ds_read_b64_tr_b16 v[84:85], v14 offset:24576
v_accvgpr_read_b32 v20, a20
v_mfma_f32_16x16x32_bf16 v[180:183], v[92:95], v[108:111], v[180:183]
s_add_u32 m0, s63, 65536
ds_read_b64_tr_b16 v[86:87], v14 offset:25600
v_accvgpr_read_b32 v28, a21
v_mfma_f32_16x16x32_bf16 v[176:179], v[92:95], v[100:103], v[176:179]
s_add_u32 s72, s69, 0
buffer_load_dwordx4 v4, s[4:7], s72 offen lds
v_mfma_f32_16x16x32_bf16 v[176:179], v[88:91], v[96:99], v[176:179]
s_waitcnt lgkmcnt(10)
ds_read_b128 v[40:43], v18 offset:34816
v_accvgpr_read_b32 v21, a22
v_mfma_f32_16x16x32_bf16 v[192:195], v[64:67], v[96:99], v[192:195]
ds_read_b64_tr_b16 v[88:89], v15 offset:16384
v_accvgpr_read_b32 v29, a23
v_mfma_f32_16x16x32_bf16 v[192:195], v[68:71], v[100:103], v[192:195]
ds_read_b64_tr_b16 v[90:91], v15 offset:17408
v_accvgpr_read_b32 v22, a52
v_mfma_f32_16x16x32_bf16 v[196:199], v[68:71], v[108:111], v[196:199]
ds_read_b64_tr_b16 v[92:93], v15 offset:24576
v_accvgpr_read_b32 v30, a53
v_mfma_f32_16x16x32_bf16 v[196:199], v[64:67], v[104:107], v[196:199]
s_add_u32 s72, s69, 15360
buffer_load_dwordx4 v5, s[4:7], s72 offen offset:1024 lds
v_mfma_f32_16x16x32_bf16 v[200:203], v[64:67], v[112:115], v[200:203]
ds_read_b64_tr_b16 v[94:95], v15 offset:25600
v_accvgpr_read_b32 v23, a54
v_mfma_f32_16x16x32_bf16 v[200:203], v[68:71], v[116:119], v[200:203]
ds_read_b128 v[44:47], v19 offset:34816
v_accvgpr_read_b32 v31, a55
v_mfma_f32_16x16x32_bf16 v[204:207], v[68:71], v[124:127], v[204:207]
v_mul_f32 v20, s79, v20
v_mul_f32 v28, s79, v28
v_mfma_f32_16x16x32_bf16 v[204:207], v[64:67], v[120:123], v[204:207]
s_waitcnt lgkmcnt(11)
ds_read_b128 v[48:51], v18 offset:36864
v_mul_f32 v21, s79, v21
v_mfma_f32_16x16x32_bf16 v[220:223], v[72:75], v[120:123], v[220:223]
s_add_u32 s72, s69, 129024
buffer_load_dwordx4 v4, s[4:7], s72 offen offset:2048 lds
v_mfma_f32_16x16x32_bf16 v[220:223], v[76:79], v[124:127], v[220:223]
v_mul_f32 v29, s79, v29
v_mul_f32 v22, s79, v22
v_mfma_f32_16x16x32_bf16 v[216:219], v[76:79], v[116:119], v[216:219]
s_waitcnt vmcnt(19) lgkmcnt(2)
ds_read_b128 v[52:55], v19 offset:36864
v_mul_f32 v30, s79, v30
v_mfma_f32_16x16x32_bf16 v[216:219], v[72:75], v[112:115], v[216:219]
s_barrier
ds_read_b128 v[56:59], v18 offset:38912
v_mul_f32 v23, s79, v23
v_mfma_f32_16x16x32_bf16 v[212:215], v[72:75], v[104:107], v[212:215]
ds_read_b64_tr_b16 v[64:65], v8 offset:32768
ds_read_b64_tr_b16 v[66:67], v8 offset:33792
v_mfma_f32_16x16x32_bf16 v[212:215], v[76:79], v[108:111], v[212:215]
ds_read_b64_tr_b16 v[68:69], v8 offset:40960
v_mul_f32 v31, s79, v31
v_mfma_f32_16x16x32_bf16 v[208:211], v[76:79], v[100:103], v[208:211]
s_add_u32 s72, s69, 144384
buffer_load_dwordx4 v5, s[4:7], s72 offen offset:3072 lds
v_mfma_f32_16x16x32_bf16 v[208:211], v[72:75], v[96:99], v[208:211]
ds_read_b64_tr_b16 v[70:71], v8 offset:41984
v_cvt_pk_bf16_f32 v20, v20, v28
v_mfma_f32_16x16x32_bf16 v[224:227], v[80:83], v[96:99], v[224:227]
ds_read_b64_tr_b16 v[72:73], v9 offset:32768
v_cvt_pk_bf16_f32 v21, v21, v29
v_mfma_f32_16x16x32_bf16 v[224:227], v[84:87], v[100:103], v[224:227]
ds_read_b64_tr_b16 v[74:75], v9 offset:33792
v_cvt_pk_bf16_f32 v22, v22, v30
v_mfma_f32_16x16x32_bf16 v[228:231], v[84:87], v[108:111], v[228:231]
s_add_u32 m0, s63, 69632
v_cvt_pk_bf16_f32 v23, v23, v31
v_accvgpr_read_b32 v24, a152
v_mfma_f32_16x16x32_bf16 v[228:231], v[80:83], v[104:107], v[228:231]
s_add_u32 s72, s70, 0
buffer_load_dwordx4 v4, s[4:7], s72 offen lds
v_mfma_f32_16x16x32_bf16 v[232:235], v[80:83], v[112:115], v[232:235]
s_add_u32 s80, s77, 36864
ds_read_b64_tr_b16 v[76:77], v9 offset:40960
v_accvgpr_read_b32 v28, a153
v_mfma_f32_16x16x32_bf16 v[232:235], v[84:87], v[116:119], v[232:235]
ds_read_b128 v[60:63], v19 offset:38912
v_accvgpr_read_b32 v25, a154
v_mfma_f32_16x16x32_bf16 v[236:239], v[84:87], v[124:127], v[236:239]
ds_read_b64_tr_b16 v[78:79], v9 offset:41984
v_accvgpr_read_b32 v29, a155
v_mfma_f32_16x16x32_bf16 v[236:239], v[80:83], v[120:123], v[236:239]
buffer_store_dwordx4 v[20:23], v1, s[44:47], s80 offen sc1
v_mfma_f32_16x16x32_bf16 v[252:255], v[88:91], v[120:123], v[252:255]
s_add_u32 s72, s70, 15360
buffer_load_dwordx4 v5, s[4:7], s72 offen offset:1024 lds
v_mfma_f32_16x16x32_bf16 v[252:255], v[92:95], v[124:127], v[252:255]
ds_read_b64_tr_b16 v[80:81], v10 offset:32768
v_accvgpr_read_b32 v26, a156
v_mfma_f32_16x16x32_bf16 v[248:251], v[92:95], v[116:119], v[248:251]
ds_read_b64_tr_b16 v[82:83], v10 offset:33792
v_accvgpr_read_b32 v30, a157
v_mfma_f32_16x16x32_bf16 v[248:251], v[88:91], v[112:115], v[248:251]
v_accvgpr_read_b32 v27, a158
v_accvgpr_read_b32 v31, a159
v_mfma_f32_16x16x32_bf16 v[244:247], v[88:91], v[104:107], v[244:247]
ds_read_b64_tr_b16 v[84:85], v10 offset:40960
v_cvt_pk_bf16_f32 v24, v24, v28
v_mfma_f32_16x16x32_bf16 v[244:247], v[92:95], v[108:111], v[244:247]
ds_read_b64_tr_b16 v[86:87], v10 offset:41984
v_cvt_pk_bf16_f32 v25, v25, v29
v_mfma_f32_16x16x32_bf16 v[240:243], v[92:95], v[100:103], v[240:243]
s_add_u32 s72, s70, 129024
buffer_load_dwordx4 v4, s[4:7], s72 offen offset:2048 lds
v_mfma_f32_16x16x32_bf16 v[240:243], v[88:91], v[96:99], v[240:243]
s_waitcnt lgkmcnt(5)
v_cvt_pk_bf16_f32 v26, v26, v30
v_cvt_pk_bf16_f32 v27, v27, v31
v_mfma_f32_16x16x32_bf16 v[128:131], v[64:67], v[32:35], v[128:131]
s_add_u32 s80, s78, 40960
ds_read_b64_tr_b16 v[88:89], v11 offset:32768
v_mfma_f32_16x16x32_bf16 v[128:131], v[68:71], v[36:39], v[128:131]
ds_read_b64_tr_b16 v[90:91], v11 offset:33792
v_mfma_f32_16x16x32_bf16 v[132:135], v[68:71], v[44:47], v[132:135]
buffer_store_dwordx4 v[24:27], v1, s[44:47], s80 offen sc1
v_mfma_f32_16x16x32_bf16 v[132:135], v[64:67], v[40:43], v[132:135]
s_add_u32 s72, s70, 144384
buffer_load_dwordx4 v5, s[4:7], s72 offen offset:3072 lds
v_mfma_f32_16x16x32_bf16 v[136:139], v[64:67], v[48:51], v[136:139]
ds_read_b64_tr_b16 v[92:93], v11 offset:40960
v_mfma_f32_16x16x32_bf16 v[136:139], v[68:71], v[52:55], v[136:139]
s_lshl_b32 s71, s73, 12
v_mfma_f32_16x16x32_bf16 v[140:143], v[68:71], v[60:63], v[140:143]
s_add_u32 s71, s71, s66
ds_read_b64_tr_b16 v[94:95], v11 offset:41984
v_mfma_f32_16x16x32_bf16 v[140:143], v[64:67], v[56:59], v[140:143]
s_waitcnt lgkmcnt(8)
v_accvgpr_read_b32 v20, a24
v_accvgpr_read_b32 v28, a25
v_mfma_f32_16x16x32_bf16 v[156:159], v[72:75], v[56:59], v[156:159]
s_add_u32 m0, s64, 16384
ds_read_b64_tr_b16 v[64:65], v12 offset:32768
v_accvgpr_read_b32 v21, a26
v_mfma_f32_16x16x32_bf16 v[156:159], v[76:79], v[60:63], v[156:159]
s_add_u32 s72, s71, 0
buffer_load_dwordx4 v6, s[12:15], s72 offen lds
v_mfma_f32_16x16x32_bf16 v[152:155], v[76:79], v[52:55], v[152:155]
s_add_u32 s73, s62, 5
ds_read_b64_tr_b16 v[66:67], v12 offset:33792
v_accvgpr_read_b32 v29, a27
v_mfma_f32_16x16x32_bf16 v[152:155], v[72:75], v[48:51], v[152:155]
s_add_u32 s70, s73, s65
v_accvgpr_read_b32 v22, a56
v_accvgpr_read_b32 v30, a57
v_mfma_f32_16x16x32_bf16 v[148:151], v[72:75], v[40:43], v[148:151]
s_and_b32 s70, s70, 3
ds_read_b64_tr_b16 v[68:69], v12 offset:40960
v_accvgpr_read_b32 v23, a58
v_mfma_f32_16x16x32_bf16 v[148:151], v[76:79], v[44:47], v[148:151]
s_and_b32 s73, s73, 12
ds_read_b64_tr_b16 v[70:71], v12 offset:41984
v_accvgpr_read_b32 v31, a59
v_mfma_f32_16x16x32_bf16 v[144:147], v[76:79], v[36:39], v[144:147]
s_add_u32 s72, s71, 31744
buffer_load_dwordx4 v6, s[12:15], s72 offen offset:1024 lds
v_mfma_f32_16x16x32_bf16 v[144:147], v[72:75], v[32:35], v[144:147]
s_waitcnt lgkmcnt(8)
v_mul_f32 v20, s79, v20
v_mul_f32 v28, s79, v28
v_mfma_f32_16x16x32_bf16 v[160:163], v[80:83], v[32:35], v[160:163]
s_or_b32 s73, s73, s70
ds_read_b64_tr_b16 v[72:73], v13 offset:32768
v_mul_f32 v21, s79, v21
v_mfma_f32_16x16x32_bf16 v[160:163], v[84:87], v[36:39], v[160:163]
s_lshl_b32 s73, s73, 7
ds_read_b64_tr_b16 v[74:75], v13 offset:33792
v_mul_f32 v29, s79, v29
v_mfma_f32_16x16x32_bf16 v[164:167], v[84:87], v[44:47], v[164:167]
s_add_u32 s69, s73, s67
v_mul_f32 v22, s79, v22
v_mul_f32 v30, s79, v30
v_mfma_f32_16x16x32_bf16 v[164:167], v[80:83], v[40:43], v[164:167]
s_add_u32 s72, s71, 63488
buffer_load_dwordx4 v7, s[12:15], s72 offen offset:2048 lds
v_mfma_f32_16x16x32_bf16 v[168:171], v[80:83], v[48:51], v[168:171]
s_waitcnt vmcnt(18)
ds_read_b64_tr_b16 v[76:77], v13 offset:40960
v_mul_f32 v23, s79, v23
v_mfma_f32_16x16x32_bf16 v[168:171], v[84:87], v[52:55], v[168:171]
s_add_u32 s70, s73, s68
ds_read_b128 v[96:99], v16 offset:0
v_mul_f32 v31, s79, v31
v_mfma_f32_16x16x32_bf16 v[172:175], v[84:87], v[60:63], v[172:175]
ds_read_b64_tr_b16 v[78:79], v13 offset:41984
v_cvt_pk_bf16_f32 v20, v20, v28
v_mfma_f32_16x16x32_bf16 v[172:175], v[80:83], v[56:59], v[172:175]
s_waitcnt lgkmcnt(9)
ds_read_b128 v[100:103], v17 offset:0
v_cvt_pk_bf16_f32 v21, v21, v29
v_mfma_f32_16x16x32_bf16 v[188:191], v[88:91], v[56:59], v[188:191]
s_add_u32 s72, s71, 95232
buffer_load_dwordx4 v7, s[12:15], s72 offen offset:3072 lds
v_mfma_f32_16x16x32_bf16 v[188:191], v[92:95], v[60:63], v[188:191]
ds_read_b64_tr_b16 v[80:81], v14 offset:32768
v_cvt_pk_bf16_f32 v22, v22, v30
v_mfma_f32_16x16x32_bf16 v[184:187], v[92:95], v[52:55], v[184:187]
ds_read_b64_tr_b16 v[82:83], v14 offset:33792
v_cvt_pk_bf16_f32 v23, v23, v31
v_mfma_f32_16x16x32_bf16 v[184:187], v[88:91], v[48:51], v[184:187]
s_add_u32 s80, s77, 40960
buffer_store_dwordx4 v[20:23], v1, s[44:47], s80 offen sc1
v_mfma_f32_16x16x32_bf16 v[180:183], v[88:91], v[40:43], v[180:183]
ds_read_b64_tr_b16 v[84:85], v14 offset:40960
v_mfma_f32_16x16x32_bf16 v[180:183], v[92:95], v[44:47], v[180:183]
s_add_u32 m0, s63, 98304
ds_read_b64_tr_b16 v[86:87], v14 offset:41984
v_accvgpr_read_b32 v24, a160
v_mfma_f32_16x16x32_bf16 v[176:179], v[92:95], v[36:39], v[176:179]
s_add_u32 s72, s69, 0
buffer_load_dwordx4 v4, s[4:7], s72 offen lds
v_mfma_f32_16x16x32_bf16 v[176:179], v[88:91], v[32:35], v[176:179]
s_waitcnt lgkmcnt(10)
ds_read_b128 v[104:107], v16 offset:2048
v_accvgpr_read_b32 v28, a161
v_mfma_f32_16x16x32_bf16 v[192:195], v[64:67], v[32:35], v[192:195]
ds_read_b64_tr_b16 v[88:89], v15 offset:32768
v_accvgpr_read_b32 v25, a162
v_mfma_f32_16x16x32_bf16 v[192:195], v[68:71], v[36:39], v[192:195]
ds_read_b64_tr_b16 v[90:91], v15 offset:33792
v_accvgpr_read_b32 v29, a163
v_mfma_f32_16x16x32_bf16 v[196:199], v[68:71], v[44:47], v[196:199]
ds_read_b64_tr_b16 v[92:93], v15 offset:40960
v_accvgpr_read_b32 v26, a164
v_mfma_f32_16x16x32_bf16 v[196:199], v[64:67], v[40:43], v[196:199]
s_add_u32 s72, s69, 15360
buffer_load_dwordx4 v5, s[4:7], s72 offen offset:1024 lds
v_mfma_f32_16x16x32_bf16 v[200:203], v[64:67], v[48:51], v[200:203]
ds_read_b64_tr_b16 v[94:95], v15 offset:41984
v_accvgpr_read_b32 v30, a165
v_mfma_f32_16x16x32_bf16 v[200:203], v[68:71], v[52:55], v[200:203]
ds_read_b128 v[108:111], v17 offset:2048
v_accvgpr_read_b32 v27, a166
v_mfma_f32_16x16x32_bf16 v[204:207], v[68:71], v[60:63], v[204:207]
v_accvgpr_read_b32 v31, a167
v_cvt_pk_bf16_f32 v24, v24, v28
v_mfma_f32_16x16x32_bf16 v[204:207], v[64:67], v[56:59], v[204:207]
s_waitcnt lgkmcnt(11)
ds_read_b128 v[112:115], v16 offset:4096
v_cvt_pk_bf16_f32 v25, v25, v29
v_mfma_f32_16x16x32_bf16 v[220:223], v[72:75], v[56:59], v[220:223]
s_add_u32 s72, s69, 129024
buffer_load_dwordx4 v4, s[4:7], s72 offen offset:2048 lds
v_mfma_f32_16x16x32_bf16 v[220:223], v[76:79], v[60:63], v[220:223]
v_cvt_pk_bf16_f32 v26, v26, v30
v_cvt_pk_bf16_f32 v27, v27, v31
v_mfma_f32_16x16x32_bf16 v[216:219], v[76:79], v[52:55], v[216:219]
s_waitcnt vmcnt(19) lgkmcnt(2)
ds_read_b128 v[116:119], v17 offset:4096
v_mfma_f32_16x16x32_bf16 v[216:219], v[72:75], v[48:51], v[216:219]
s_barrier
ds_read_b128 v[120:123], v16 offset:6144
v_mfma_f32_16x16x32_bf16 v[212:215], v[72:75], v[40:43], v[212:215]
s_add_u32 s80, s78, 1024
ds_read_b64_tr_b16 v[64:65], v8 offset:0
ds_read_b64_tr_b16 v[66:67], v8 offset:1024
v_mfma_f32_16x16x32_bf16 v[212:215], v[76:79], v[44:47], v[212:215]
ds_read_b64_tr_b16 v[68:69], v8 offset:8192
v_mfma_f32_16x16x32_bf16 v[208:211], v[76:79], v[36:39], v[208:211]
s_add_u32 s72, s69, 144384
buffer_load_dwordx4 v5, s[4:7], s72 offen offset:3072 lds
v_mfma_f32_16x16x32_bf16 v[208:211], v[72:75], v[32:35], v[208:211]
ds_read_b64_tr_b16 v[70:71], v8 offset:9216
v_mfma_f32_16x16x32_bf16 v[224:227], v[80:83], v[32:35], v[224:227]
ds_read_b64_tr_b16 v[72:73], v9 offset:0
v_mfma_f32_16x16x32_bf16 v[224:227], v[84:87], v[36:39], v[224:227]
ds_read_b64_tr_b16 v[74:75], v9 offset:1024
v_mfma_f32_16x16x32_bf16 v[228:231], v[84:87], v[44:47], v[228:231]
s_add_u32 m0, s63, 102400
buffer_store_dwordx4 v[24:27], v1, s[44:47], s80 offen sc1
v_mfma_f32_16x16x32_bf16 v[228:231], v[80:83], v[40:43], v[228:231]
s_add_u32 s72, s70, 0
buffer_load_dwordx4 v4, s[4:7], s72 offen lds
v_mfma_f32_16x16x32_bf16 v[232:235], v[80:83], v[48:51], v[232:235]
ds_read_b64_tr_b16 v[76:77], v9 offset:8192
v_accvgpr_read_b32 v20, a28
v_mfma_f32_16x16x32_bf16 v[232:235], v[84:87], v[52:55], v[232:235]
ds_read_b128 v[124:127], v17 offset:6144
v_accvgpr_read_b32 v28, a29
v_mfma_f32_16x16x32_bf16 v[236:239], v[84:87], v[60:63], v[236:239]
ds_read_b64_tr_b16 v[78:79], v9 offset:9216
v_accvgpr_read_b32 v21, a30
v_mfma_f32_16x16x32_bf16 v[236:239], v[80:83], v[56:59], v[236:239]
v_accvgpr_read_b32 v29, a31
v_accvgpr_read_b32 v22, a60
v_mfma_f32_16x16x32_bf16 v[252:255], v[88:91], v[56:59], v[252:255]
s_add_u32 s72, s70, 15360
buffer_load_dwordx4 v5, s[4:7], s72 offen offset:1024 lds
v_mfma_f32_16x16x32_bf16 v[252:255], v[92:95], v[60:63], v[252:255]
ds_read_b64_tr_b16 v[80:81], v10 offset:0
v_accvgpr_read_b32 v30, a61
v_mfma_f32_16x16x32_bf16 v[248:251], v[92:95], v[52:55], v[248:251]
ds_read_b64_tr_b16 v[82:83], v10 offset:1024
v_accvgpr_read_b32 v23, a62
v_mfma_f32_16x16x32_bf16 v[248:251], v[88:91], v[48:51], v[248:251]
v_accvgpr_read_b32 v31, a63
v_mul_f32 v20, s79, v20
v_mfma_f32_16x16x32_bf16 v[244:247], v[88:91], v[40:43], v[244:247]
ds_read_b64_tr_b16 v[84:85], v10 offset:8192
v_mul_f32 v28, s79, v28
v_mfma_f32_16x16x32_bf16 v[244:247], v[92:95], v[44:47], v[244:247]
ds_read_b64_tr_b16 v[86:87], v10 offset:9216
v_mul_f32 v21, s79, v21
v_mfma_f32_16x16x32_bf16 v[240:243], v[92:95], v[36:39], v[240:243]
s_add_u32 s72, s70, 129024
buffer_load_dwordx4 v4, s[4:7], s72 offen offset:2048 lds
v_mfma_f32_16x16x32_bf16 v[240:243], v[88:91], v[32:35], v[240:243]
s_waitcnt lgkmcnt(5)
v_mul_f32 v29, s79, v29
v_mul_f32 v22, s79, v22
v_mfma_f32_16x16x32_bf16 v[128:131], v[64:67], v[96:99], v[128:131]
ds_read_b64_tr_b16 v[88:89], v11 offset:0
v_mul_f32 v30, s79, v30
v_mfma_f32_16x16x32_bf16 v[128:131], v[68:71], v[100:103], v[128:131]
ds_read_b64_tr_b16 v[90:91], v11 offset:1024
v_mul_f32 v23, s79, v23
v_mfma_f32_16x16x32_bf16 v[132:135], v[68:71], v[108:111], v[132:135]
v_mul_f32 v31, s79, v31
v_cvt_pk_bf16_f32 v20, v20, v28
v_mfma_f32_16x16x32_bf16 v[132:135], v[64:67], v[104:107], v[132:135]
s_add_u32 s72, s70, 144384
buffer_load_dwordx4 v5, s[4:7], s72 offen offset:3072 lds
v_mfma_f32_16x16x32_bf16 v[136:139], v[64:67], v[112:115], v[136:139]
ds_read_b64_tr_b16 v[92:93], v11 offset:8192
v_cvt_pk_bf16_f32 v21, v21, v29
v_mfma_f32_16x16x32_bf16 v[136:139], v[68:71], v[116:119], v[136:139]
s_lshl_b32 s71, s73, 12
v_cvt_pk_bf16_f32 v22, v22, v30
v_cvt_pk_bf16_f32 v23, v23, v31
v_mfma_f32_16x16x32_bf16 v[140:143], v[68:71], v[124:127], v[140:143]
s_add_u32 s71, s71, s66
ds_read_b64_tr_b16 v[94:95], v11 offset:9216
v_mfma_f32_16x16x32_bf16 v[140:143], v[64:67], v[120:123], v[140:143]
s_waitcnt lgkmcnt(8)
v_mfma_f32_16x16x32_bf16 v[156:159], v[72:75], v[120:123], v[156:159]
s_add_u32 m0, s64, 32768
ds_read_b64_tr_b16 v[64:65], v12 offset:0
v_mfma_f32_16x16x32_bf16 v[156:159], v[76:79], v[124:127], v[156:159]
s_add_u32 s72, s71, 0
buffer_load_dwordx4 v6, s[12:15], s72 offen lds
v_mfma_f32_16x16x32_bf16 v[152:155], v[76:79], v[116:119], v[152:155]
s_add_u32 s73, s62, 6
ds_read_b64_tr_b16 v[66:67], v12 offset:1024
v_accvgpr_read_b32 v24, a168
v_mfma_f32_16x16x32_bf16 v[152:155], v[72:75], v[112:115], v[152:155]
s_add_u32 s70, s73, s65
v_accvgpr_read_b32 v28, a169
v_accvgpr_read_b32 v25, a170
v_mfma_f32_16x16x32_bf16 v[148:151], v[72:75], v[104:107], v[148:151]
s_and_b32 s70, s70, 3
ds_read_b64_tr_b16 v[68:69], v12 offset:8192
v_accvgpr_read_b32 v29, a171
v_mfma_f32_16x16x32_bf16 v[148:151], v[76:79], v[108:111], v[148:151]
s_and_b32 s73, s73, 12
ds_read_b64_tr_b16 v[70:71], v12 offset:9216
v_accvgpr_read_b32 v26, a172
v_mfma_f32_16x16x32_bf16 v[144:147], v[76:79], v[100:103], v[144:147]
s_add_u32 s72, s71, 31744
buffer_load_dwordx4 v6, s[12:15], s72 offen offset:1024 lds
v_mfma_f32_16x16x32_bf16 v[144:147], v[72:75], v[96:99], v[144:147]
s_waitcnt lgkmcnt(8)
v_accvgpr_read_b32 v30, a173
v_accvgpr_read_b32 v27, a174
v_mfma_f32_16x16x32_bf16 v[160:163], v[80:83], v[96:99], v[160:163]
s_or_b32 s73, s73, s70
ds_read_b64_tr_b16 v[72:73], v13 offset:0
v_accvgpr_read_b32 v31, a175
v_mfma_f32_16x16x32_bf16 v[160:163], v[84:87], v[100:103], v[160:163]
s_lshl_b32 s73, s73, 7
ds_read_b64_tr_b16 v[74:75], v13 offset:1024
v_cvt_pk_bf16_f32 v24, v24, v28
v_mfma_f32_16x16x32_bf16 v[164:167], v[84:87], v[108:111], v[164:167]
s_add_u32 s69, s73, s67
v_cvt_pk_bf16_f32 v25, v25, v29
v_cvt_pk_bf16_f32 v26, v26, v30
v_mfma_f32_16x16x32_bf16 v[164:167], v[80:83], v[104:107], v[164:167]
s_add_u32 s72, s71, 63488
buffer_load_dwordx4 v7, s[12:15], s72 offen offset:2048 lds
v_mfma_f32_16x16x32_bf16 v[168:171], v[80:83], v[112:115], v[168:171]
s_waitcnt vmcnt(17)
ds_read_b64_tr_b16 v[76:77], v13 offset:8192
v_cvt_pk_bf16_f32 v27, v27, v31
v_mfma_f32_16x16x32_bf16 v[168:171], v[84:87], v[116:119], v[168:171]
s_add_u32 s70, s73, s68
ds_read_b128 v[32:35], v18 offset:0
v_mfma_f32_16x16x32_bf16 v[172:175], v[84:87], v[124:127], v[172:175]
s_add_u32 s80, s77, 45056
ds_read_b64_tr_b16 v[78:79], v13 offset:9216
v_mfma_f32_16x16x32_bf16 v[172:175], v[80:83], v[120:123], v[172:175]
s_waitcnt lgkmcnt(9)
ds_read_b128 v[36:39], v19 offset:0
v_mfma_f32_16x16x32_bf16 v[188:191], v[88:91], v[120:123], v[188:191]
s_add_u32 s72, s71, 95232
buffer_load_dwordx4 v7, s[12:15], s72 offen offset:3072 lds
v_mfma_f32_16x16x32_bf16 v[188:191], v[92:95], v[124:127], v[188:191]
ds_read_b64_tr_b16 v[80:81], v14 offset:0
v_mfma_f32_16x16x32_bf16 v[184:187], v[92:95], v[116:119], v[184:187]
ds_read_b64_tr_b16 v[82:83], v14 offset:1024
v_mfma_f32_16x16x32_bf16 v[184:187], v[88:91], v[112:115], v[184:187]
buffer_store_dwordx4 v[20:23], v1, s[44:47], s80 offen sc1
v_mfma_f32_16x16x32_bf16 v[180:183], v[88:91], v[104:107], v[180:183]
s_add_u32 s80, s78, 9216
ds_read_b64_tr_b16 v[84:85], v14 offset:8192
v_mfma_f32_16x16x32_bf16 v[180:183], v[92:95], v[108:111], v[180:183]
s_add_u32 m0, s63, 131072
ds_read_b64_tr_b16 v[86:87], v14 offset:9216
v_mfma_f32_16x16x32_bf16 v[176:179], v[92:95], v[100:103], v[176:179]
s_add_u32 s72, s69, 0
buffer_load_dwordx4 v4, s[4:7], s72 offen lds
v_mfma_f32_16x16x32_bf16 v[176:179], v[88:91], v[96:99], v[176:179]
s_waitcnt lgkmcnt(10)
ds_read_b128 v[40:43], v18 offset:2048
v_accvgpr_read_b32 v20, a64
v_mfma_f32_16x16x32_bf16 v[192:195], v[64:67], v[96:99], v[192:195]
ds_read_b64_tr_b16 v[88:89], v15 offset:0
v_accvgpr_read_b32 v28, a65
v_mfma_f32_16x16x32_bf16 v[192:195], v[68:71], v[100:103], v[192:195]
ds_read_b64_tr_b16 v[90:91], v15 offset:1024
v_accvgpr_read_b32 v21, a66
v_mfma_f32_16x16x32_bf16 v[196:199], v[68:71], v[108:111], v[196:199]
ds_read_b64_tr_b16 v[92:93], v15 offset:8192
v_accvgpr_read_b32 v29, a67
v_mfma_f32_16x16x32_bf16 v[196:199], v[64:67], v[104:107], v[196:199]
s_add_u32 s72, s69, 15360
buffer_load_dwordx4 v5, s[4:7], s72 offen offset:1024 lds
v_mfma_f32_16x16x32_bf16 v[200:203], v[64:67], v[112:115], v[200:203]
ds_read_b64_tr_b16 v[94:95], v15 offset:9216
v_accvgpr_read_b32 v22, a96
v_mfma_f32_16x16x32_bf16 v[200:203], v[68:71], v[116:119], v[200:203]
ds_read_b128 v[44:47], v19 offset:2048
v_accvgpr_read_b32 v30, a97
v_mfma_f32_16x16x32_bf16 v[204:207], v[68:71], v[124:127], v[204:207]
buffer_store_dwordx4 v[24:27], v1, s[44:47], s80 offen sc1
v_mfma_f32_16x16x32_bf16 v[204:207], v[64:67], v[120:123], v[204:207]
s_waitcnt lgkmcnt(11)
ds_read_b128 v[48:51], v18 offset:4096
v_accvgpr_read_b32 v23, a98
v_mfma_f32_16x16x32_bf16 v[220:223], v[72:75], v[120:123], v[220:223]
s_add_u32 s72, s69, 129024
buffer_load_dwordx4 v4, s[4:7], s72 offen offset:2048 lds
v_mfma_f32_16x16x32_bf16 v[220:223], v[76:79], v[124:127], v[220:223]
v_accvgpr_read_b32 v31, a99
v_mul_f32 v20, s79, v20
v_mfma_f32_16x16x32_bf16 v[216:219], v[76:79], v[116:119], v[216:219]
s_waitcnt vmcnt(19) lgkmcnt(2)
ds_read_b128 v[52:55], v19 offset:4096
v_mul_f32 v28, s79, v28
v_mfma_f32_16x16x32_bf16 v[216:219], v[72:75], v[112:115], v[216:219]
s_barrier
ds_read_b128 v[56:59], v18 offset:6144
v_mul_f32 v21, s79, v21
v_mfma_f32_16x16x32_bf16 v[212:215], v[72:75], v[104:107], v[212:215]
ds_read_b64_tr_b16 v[64:65], v8 offset:16384
ds_read_b64_tr_b16 v[66:67], v8 offset:17408
v_mfma_f32_16x16x32_bf16 v[212:215], v[76:79], v[108:111], v[212:215]
ds_read_b64_tr_b16 v[68:69], v8 offset:24576
v_mul_f32 v29, s79, v29
v_mfma_f32_16x16x32_bf16 v[208:211], v[76:79], v[100:103], v[208:211]
s_add_u32 s72, s69, 144384
buffer_load_dwordx4 v5, s[4:7], s72 offen offset:3072 lds
v_mfma_f32_16x16x32_bf16 v[208:211], v[72:75], v[96:99], v[208:211]
ds_read_b64_tr_b16 v[70:71], v8 offset:25600
v_mul_f32 v22, s79, v22
v_mfma_f32_16x16x32_bf16 v[224:227], v[80:83], v[96:99], v[224:227]
ds_read_b64_tr_b16 v[72:73], v9 offset:16384
v_mul_f32 v30, s79, v30
v_mfma_f32_16x16x32_bf16 v[224:227], v[84:87], v[100:103], v[224:227]
ds_read_b64_tr_b16 v[74:75], v9 offset:17408
v_mul_f32 v23, s79, v23
v_mfma_f32_16x16x32_bf16 v[228:231], v[84:87], v[108:111], v[228:231]
s_add_u32 m0, s63, 135168
v_mul_f32 v31, s79, v31
v_cvt_pk_bf16_f32 v20, v20, v28
v_mfma_f32_16x16x32_bf16 v[228:231], v[80:83], v[104:107], v[228:231]
s_add_u32 s72, s70, 0
buffer_load_dwordx4 v4, s[4:7], s72 offen lds
v_mfma_f32_16x16x32_bf16 v[232:235], v[80:83], v[112:115], v[232:235]
ds_read_b64_tr_b16 v[76:77], v9 offset:24576
v_cvt_pk_bf16_f32 v21, v21, v29
v_mfma_f32_16x16x32_bf16 v[232:235], v[84:87], v[116:119], v[232:235]
ds_read_b128 v[60:63], v19 offset:6144
v_cvt_pk_bf16_f32 v22, v22, v30
v_mfma_f32_16x16x32_bf16 v[236:239], v[84:87], v[124:127], v[236:239]
ds_read_b64_tr_b16 v[78:79], v9 offset:25600
v_cvt_pk_bf16_f32 v23, v23, v31
v_mfma_f32_16x16x32_bf16 v[236:239], v[80:83], v[120:123], v[236:239]
s_add_u32 s80, s77, 1024
buffer_store_dwordx4 v[20:23], v1, s[44:47], s80 offen sc1
v_mfma_f32_16x16x32_bf16 v[252:255], v[88:91], v[120:123], v[252:255]
s_add_u32 s72, s70, 15360
buffer_load_dwordx4 v5, s[4:7], s72 offen offset:1024 lds
v_mfma_f32_16x16x32_bf16 v[252:255], v[92:95], v[124:127], v[252:255]
ds_read_b64_tr_b16 v[80:81], v10 offset:16384
v_accvgpr_read_b32 v24, a176
v_mfma_f32_16x16x32_bf16 v[248:251], v[92:95], v[116:119], v[248:251]
ds_read_b64_tr_b16 v[82:83], v10 offset:17408
v_accvgpr_read_b32 v28, a177
v_mfma_f32_16x16x32_bf16 v[248:251], v[88:91], v[112:115], v[248:251]
v_accvgpr_read_b32 v25, a178
v_accvgpr_read_b32 v29, a179
v_mfma_f32_16x16x32_bf16 v[244:247], v[88:91], v[104:107], v[244:247]
ds_read_b64_tr_b16 v[84:85], v10 offset:24576
v_accvgpr_read_b32 v26, a180
v_mfma_f32_16x16x32_bf16 v[244:247], v[92:95], v[108:111], v[244:247]
ds_read_b64_tr_b16 v[86:87], v10 offset:25600
v_accvgpr_read_b32 v30, a181
v_mfma_f32_16x16x32_bf16 v[240:243], v[92:95], v[100:103], v[240:243]
s_add_u32 s72, s70, 129024
buffer_load_dwordx4 v4, s[4:7], s72 offen offset:2048 lds
v_mfma_f32_16x16x32_bf16 v[240:243], v[88:91], v[96:99], v[240:243]
s_waitcnt lgkmcnt(5)
v_accvgpr_read_b32 v27, a182
v_accvgpr_read_b32 v31, a183
v_mfma_f32_16x16x32_bf16 v[128:131], v[64:67], v[32:35], v[128:131]
ds_read_b64_tr_b16 v[88:89], v11 offset:16384
v_cvt_pk_bf16_f32 v24, v24, v28
v_mfma_f32_16x16x32_bf16 v[128:131], v[68:71], v[36:39], v[128:131]
ds_read_b64_tr_b16 v[90:91], v11 offset:17408
v_cvt_pk_bf16_f32 v25, v25, v29
v_mfma_f32_16x16x32_bf16 v[132:135], v[68:71], v[44:47], v[132:135]
v_cvt_pk_bf16_f32 v26, v26, v30
v_cvt_pk_bf16_f32 v27, v27, v31
v_mfma_f32_16x16x32_bf16 v[132:135], v[64:67], v[40:43], v[132:135]
s_add_u32 s72, s70, 144384
buffer_load_dwordx4 v5, s[4:7], s72 offen offset:3072 lds
v_mfma_f32_16x16x32_bf16 v[136:139], v[64:67], v[48:51], v[136:139]
s_add_u32 s80, s78, 33792
ds_read_b64_tr_b16 v[92:93], v11 offset:24576
v_mfma_f32_16x16x32_bf16 v[136:139], v[68:71], v[52:55], v[136:139]
s_lshl_b32 s71, s73, 12
buffer_store_dwordx4 v[24:27], v1, s[44:47], s80 offen sc1
v_mfma_f32_16x16x32_bf16 v[140:143], v[68:71], v[60:63], v[140:143]
s_add_u32 s71, s71, s66
ds_read_b64_tr_b16 v[94:95], v11 offset:25600
v_mfma_f32_16x16x32_bf16 v[140:143], v[64:67], v[56:59], v[140:143]
s_waitcnt lgkmcnt(8)
v_mfma_f32_16x16x32_bf16 v[156:159], v[72:75], v[56:59], v[156:159]
s_add_u32 m0, s64, 0
ds_read_b64_tr_b16 v[64:65], v12 offset:16384
v_mfma_f32_16x16x32_bf16 v[156:159], v[76:79], v[60:63], v[156:159]
s_add_u32 s72, s71, 0
buffer_load_dwordx4 v6, s[12:15], s72 offen lds
v_mfma_f32_16x16x32_bf16 v[152:155], v[76:79], v[52:55], v[152:155]
s_add_u32 s73, s62, 7
ds_read_b64_tr_b16 v[66:67], v12 offset:17408
v_mfma_f32_16x16x32_bf16 v[152:155], v[72:75], v[48:51], v[152:155]
s_add_u32 s70, s73, s65
v_mfma_f32_16x16x32_bf16 v[148:151], v[72:75], v[40:43], v[148:151]
s_and_b32 s70, s70, 3
ds_read_b64_tr_b16 v[68:69], v12 offset:24576
v_accvgpr_read_b32 v20, a68
v_mfma_f32_16x16x32_bf16 v[148:151], v[76:79], v[44:47], v[148:151]
s_and_b32 s73, s73, 12
ds_read_b64_tr_b16 v[70:71], v12 offset:25600
v_accvgpr_read_b32 v28, a69
v_mfma_f32_16x16x32_bf16 v[144:147], v[76:79], v[36:39], v[144:147]
s_add_u32 s72, s71, 31744
buffer_load_dwordx4 v6, s[12:15], s72 offen offset:1024 lds
v_mfma_f32_16x16x32_bf16 v[144:147], v[72:75], v[32:35], v[144:147]
s_waitcnt lgkmcnt(8)
v_accvgpr_read_b32 v21, a70
v_accvgpr_read_b32 v29, a71
v_mfma_f32_16x16x32_bf16 v[160:163], v[80:83], v[32:35], v[160:163]
s_or_b32 s73, s73, s70
ds_read_b64_tr_b16 v[72:73], v13 offset:16384
v_accvgpr_read_b32 v22, a100
v_mfma_f32_16x16x32_bf16 v[160:163], v[84:87], v[36:39], v[160:163]
s_lshl_b32 s73, s73, 7
ds_read_b64_tr_b16 v[74:75], v13 offset:17408
v_accvgpr_read_b32 v30, a101
v_mfma_f32_16x16x32_bf16 v[164:167], v[84:87], v[44:47], v[164:167]
s_add_u32 s69, s73, s67
v_accvgpr_read_b32 v23, a102
v_accvgpr_read_b32 v31, a103
v_mfma_f32_16x16x32_bf16 v[164:167], v[80:83], v[40:43], v[164:167]
s_add_u32 s72, s71, 63488
buffer_load_dwordx4 v7, s[12:15], s72 offen offset:2048 lds
v_mfma_f32_16x16x32_bf16 v[168:171], v[80:83], v[48:51], v[168:171]
s_waitcnt vmcnt(19)
ds_read_b64_tr_b16 v[76:77], v13 offset:24576
v_mul_f32 v20, s79, v20
v_mfma_f32_16x16x32_bf16 v[168:171], v[84:87], v[52:55], v[168:171]
s_add_u32 s70, s73, s68
ds_read_b128 v[96:99], v18 offset:32768
v_mul_f32 v28, s79, v28
v_mfma_f32_16x16x32_bf16 v[172:175], v[84:87], v[60:63], v[172:175]
ds_read_b64_tr_b16 v[78:79], v13 offset:25600
v_mul_f32 v21, s79, v21
v_mfma_f32_16x16x32_bf16 v[172:175], v[80:83], v[56:59], v[172:175]
s_waitcnt lgkmcnt(9)
ds_read_b128 v[100:103], v19 offset:32768
v_mul_f32 v29, s79, v29
v_mfma_f32_16x16x32_bf16 v[188:191], v[88:91], v[56:59], v[188:191]
s_add_u32 s72, s71, 95232
buffer_load_dwordx4 v7, s[12:15], s72 offen offset:3072 lds
v_mfma_f32_16x16x32_bf16 v[188:191], v[92:95], v[60:63], v[188:191]
ds_read_b64_tr_b16 v[80:81], v14 offset:16384
v_mul_f32 v22, s79, v22
v_mfma_f32_16x16x32_bf16 v[184:187], v[92:95], v[52:55], v[184:187]
ds_read_b64_tr_b16 v[82:83], v14 offset:17408
v_mul_f32 v30, s79, v30
v_mfma_f32_16x16x32_bf16 v[184:187], v[88:91], v[48:51], v[184:187]
v_mul_f32 v23, s79, v23
v_mul_f32 v31, s79, v31
v_mfma_f32_16x16x32_bf16 v[180:183], v[88:91], v[40:43], v[180:183]
ds_read_b64_tr_b16 v[84:85], v14 offset:24576
v_cvt_pk_bf16_f32 v20, v20, v28
v_mfma_f32_16x16x32_bf16 v[180:183], v[92:95], v[44:47], v[180:183]
s_add_u32 m0, s63, 65536
ds_read_b64_tr_b16 v[86:87], v14 offset:25600
v_cvt_pk_bf16_f32 v21, v21, v29
v_mfma_f32_16x16x32_bf16 v[176:179], v[92:95], v[36:39], v[176:179]
s_add_u32 s72, s69, 0
buffer_load_dwordx4 v4, s[4:7], s72 offen lds
v_mfma_f32_16x16x32_bf16 v[176:179], v[88:91], v[32:35], v[176:179]
s_waitcnt lgkmcnt(10)
ds_read_b128 v[104:107], v18 offset:34816
v_cvt_pk_bf16_f32 v22, v22, v30
v_mfma_f32_16x16x32_bf16 v[192:195], v[64:67], v[32:35], v[192:195]
ds_read_b64_tr_b16 v[88:89], v15 offset:16384
v_cvt_pk_bf16_f32 v23, v23, v31
v_mfma_f32_16x16x32_bf16 v[192:195], v[68:71], v[36:39], v[192:195]
s_add_u32 s80, s77, 5120
ds_read_b64_tr_b16 v[90:91], v15 offset:17408
v_mfma_f32_16x16x32_bf16 v[196:199], v[68:71], v[44:47], v[196:199]
ds_read_b64_tr_b16 v[92:93], v15 offset:24576
v_accvgpr_read_b32 v24, a184
v_mfma_f32_16x16x32_bf16 v[196:199], v[64:67], v[40:43], v[196:199]
s_add_u32 s72, s69, 15360
buffer_load_dwordx4 v5, s[4:7], s72 offen offset:1024 lds
v_mfma_f32_16x16x32_bf16 v[200:203], v[64:67], v[48:51], v[200:203]
ds_read_b64_tr_b16 v[94:95], v15 offset:25600
v_accvgpr_read_b32 v28, a185
v_mfma_f32_16x16x32_bf16 v[200:203], v[68:71], v[52:55], v[200:203]
ds_read_b128 v[108:111], v19 offset:34816
v_accvgpr_read_b32 v25, a186
v_mfma_f32_16x16x32_bf16 v[204:207], v[68:71], v[60:63], v[204:207]
buffer_store_dwordx4 v[20:23], v1, s[44:47], s80 offen sc1
v_mfma_f32_16x16x32_bf16 v[204:207], v[64:67], v[56:59], v[204:207]
s_waitcnt lgkmcnt(11)
ds_read_b128 v[112:115], v18 offset:36864
v_accvgpr_read_b32 v29, a187
v_mfma_f32_16x16x32_bf16 v[220:223], v[72:75], v[56:59], v[220:223]
s_add_u32 s72, s69, 129024
buffer_load_dwordx4 v4, s[4:7], s72 offen offset:2048 lds
v_mfma_f32_16x16x32_bf16 v[220:223], v[76:79], v[60:63], v[220:223]
v_accvgpr_read_b32 v26, a188
v_accvgpr_read_b32 v30, a189
v_mfma_f32_16x16x32_bf16 v[216:219], v[76:79], v[52:55], v[216:219]
s_waitcnt vmcnt(20) lgkmcnt(2)
ds_read_b128 v[116:119], v19 offset:36864
v_accvgpr_read_b32 v27, a190
v_mfma_f32_16x16x32_bf16 v[216:219], v[72:75], v[48:51], v[216:219]
s_barrier
ds_read_b128 v[120:123], v18 offset:38912
v_accvgpr_read_b32 v31, a191
v_mfma_f32_16x16x32_bf16 v[212:215], v[72:75], v[40:43], v[212:215]
ds_read_b64_tr_b16 v[64:65], v8 offset:32768
ds_read_b64_tr_b16 v[66:67], v8 offset:33792
v_mfma_f32_16x16x32_bf16 v[212:215], v[76:79], v[44:47], v[212:215]
ds_read_b64_tr_b16 v[68:69], v8 offset:40960
v_cvt_pk_bf16_f32 v24, v24, v28
v_mfma_f32_16x16x32_bf16 v[208:211], v[76:79], v[36:39], v[208:211]
s_add_u32 s72, s69, 144384
buffer_load_dwordx4 v5, s[4:7], s72 offen offset:3072 lds
v_mfma_f32_16x16x32_bf16 v[208:211], v[72:75], v[32:35], v[208:211]
ds_read_b64_tr_b16 v[70:71], v8 offset:41984
v_cvt_pk_bf16_f32 v25, v25, v29
v_mfma_f32_16x16x32_bf16 v[224:227], v[80:83], v[32:35], v[224:227]
ds_read_b64_tr_b16 v[72:73], v9 offset:32768
v_cvt_pk_bf16_f32 v26, v26, v30
v_mfma_f32_16x16x32_bf16 v[224:227], v[84:87], v[36:39], v[224:227]
ds_read_b64_tr_b16 v[74:75], v9 offset:33792
v_cvt_pk_bf16_f32 v27, v27, v31
v_mfma_f32_16x16x32_bf16 v[228:231], v[84:87], v[44:47], v[228:231]
s_add_u32 m0, s63, 69632
v_mfma_f32_16x16x32_bf16 v[228:231], v[80:83], v[40:43], v[228:231]
s_add_u32 s72, s70, 0
buffer_load_dwordx4 v4, s[4:7], s72 offen lds
v_mfma_f32_16x16x32_bf16 v[232:235], v[80:83], v[48:51], v[232:235]
s_add_u32 s80, s78, 41984
ds_read_b64_tr_b16 v[76:77], v9 offset:40960
v_mfma_f32_16x16x32_bf16 v[232:235], v[84:87], v[52:55], v[232:235]
ds_read_b128 v[124:127], v19 offset:38912
v_mfma_f32_16x16x32_bf16 v[236:239], v[84:87], v[60:63], v[236:239]
ds_read_b64_tr_b16 v[78:79], v9 offset:41984
v_mfma_f32_16x16x32_bf16 v[236:239], v[80:83], v[56:59], v[236:239]
buffer_store_dwordx4 v[24:27], v1, s[44:47], s80 offen sc1
v_mfma_f32_16x16x32_bf16 v[252:255], v[88:91], v[56:59], v[252:255]
s_add_u32 s72, s70, 15360
buffer_load_dwordx4 v5, s[4:7], s72 offen offset:1024 lds
v_mfma_f32_16x16x32_bf16 v[252:255], v[92:95], v[60:63], v[252:255]
ds_read_b64_tr_b16 v[80:81], v10 offset:32768
v_accvgpr_read_b32 v20, a72
v_mfma_f32_16x16x32_bf16 v[248:251], v[92:95], v[52:55], v[248:251]
ds_read_b64_tr_b16 v[82:83], v10 offset:33792
v_accvgpr_read_b32 v28, a73
v_mfma_f32_16x16x32_bf16 v[248:251], v[88:91], v[48:51], v[248:251]
v_accvgpr_read_b32 v21, a74
v_accvgpr_read_b32 v29, a75
v_mfma_f32_16x16x32_bf16 v[244:247], v[88:91], v[40:43], v[244:247]
ds_read_b64_tr_b16 v[84:85], v10 offset:40960
v_accvgpr_read_b32 v22, a104
v_mfma_f32_16x16x32_bf16 v[244:247], v[92:95], v[44:47], v[244:247]
ds_read_b64_tr_b16 v[86:87], v10 offset:41984
v_accvgpr_read_b32 v30, a105
v_mfma_f32_16x16x32_bf16 v[240:243], v[92:95], v[36:39], v[240:243]
s_add_u32 s72, s70, 129024
buffer_load_dwordx4 v4, s[4:7], s72 offen offset:2048 lds
v_mfma_f32_16x16x32_bf16 v[240:243], v[88:91], v[32:35], v[240:243]
s_waitcnt lgkmcnt(5)
v_accvgpr_read_b32 v23, a106
v_accvgpr_read_b32 v31, a107
v_mfma_f32_16x16x32_bf16 v[128:131], v[64:67], v[96:99], v[128:131]
s_lshr_b32 s75, s93, 4
ds_read_b64_tr_b16 v[88:89], v11 offset:32768
v_mul_f32 v20, s79, v20
v_mfma_f32_16x16x32_bf16 v[128:131], v[68:71], v[100:103], v[128:131]
s_and_b32 s75, s75, 0x7f00
ds_read_b64_tr_b16 v[90:91], v11 offset:33792
v_mul_f32 v28, s79, v28
v_mfma_f32_16x16x32_bf16 v[132:135], v[68:71], v[108:111], v[132:135]
s_add_u32 s75, s75, LcB1-Lpc0
v_lshrrev_b32 v2, 5, v0
v_lshlrev_b32 v2, 7, v2
v_mfma_f32_16x16x32_bf16 v[132:135], v[64:67], v[104:107], v[132:135]
s_add_u32 s72, s70, 144384
buffer_load_dwordx4 v5, s[4:7], s72 offen offset:3072 lds
v_mfma_f32_16x16x32_bf16 v[136:139], v[64:67], v[112:115], v[136:139]
v_add_u32 v2, s75, v2
v_min_u32 v2, Lcode_end-Lpc0, v2
v_mfma_f32_16x16x32_bf16 v[136:139], v[68:71], v[116:119], v[136:139]
s_lshl_b32 s71, s73, 12
global_load_dword v3, v2, s[98:99]
v_mfma_f32_16x16x32_bf16 v[140:143], v[68:71], v[124:127], v[140:143]
s_add_u32 s71, s71, s66
ds_read_b64_tr_b16 v[92:93], v11 offset:40960
v_mul_f32 v21, s79, v21
v_mfma_f32_16x16x32_bf16 v[140:143], v[64:67], v[120:123], v[140:143]
s_waitcnt lgkmcnt(7)
ds_read_b64_tr_b16 v[94:95], v11 offset:41984
v_mul_f32 v29, s79, v29
v_mfma_f32_16x16x32_bf16 v[156:159], v[72:75], v[120:123], v[156:159]
s_add_u32 m0, s64, 16384
ds_read_b64_tr_b16 v[64:65], v12 offset:32768
v_mul_f32 v22, s79, v22
v_mfma_f32_16x16x32_bf16 v[156:159], v[76:79], v[124:127], v[156:159]
s_add_u32 s72, s71, 0
buffer_load_dwordx4 v6, s[12:15], s72 offen lds
v_mfma_f32_16x16x32_bf16 v[152:155], v[76:79], v[116:119], v[152:155]
s_add_u32 s73, s62, 8
ds_read_b64_tr_b16 v[66:67], v12 offset:33792
v_mul_f32 v30, s79, v30
v_mfma_f32_16x16x32_bf16 v[152:155], v[72:75], v[112:115], v[152:155]
s_add_u32 s70, s73, s65
v_mul_f32 v23, s79, v23
v_mul_f32 v31, s79, v31
v_mfma_f32_16x16x32_bf16 v[148:151], v[72:75], v[104:107], v[148:151]
s_and_b32 s70, s70, 3
ds_read_b64_tr_b16 v[68:69], v12 offset:40960
v_cvt_pk_bf16_f32 v20, v20, v28
v_mfma_f32_16x16x32_bf16 v[148:151], v[76:79], v[108:111], v[148:151]
s_and_b32 s73, s73, 12
ds_read_b64_tr_b16 v[70:71], v12 offset:41984
v_cvt_pk_bf16_f32 v21, v21, v29
v_mfma_f32_16x16x32_bf16 v[144:147], v[76:79], v[100:103], v[144:147]
s_add_u32 s72, s71, 31744
buffer_load_dwordx4 v6, s[12:15], s72 offen offset:1024 lds
v_mfma_f32_16x16x32_bf16 v[144:147], v[72:75], v[96:99], v[144:147]
s_waitcnt lgkmcnt(8)
v_cvt_pk_bf16_f32 v22, v22, v30
v_cvt_pk_bf16_f32 v23, v23, v31
v_mfma_f32_16x16x32_bf16 v[160:163], v[80:83], v[96:99], v[160:163]
s_or_b32 s73, s73, s70
ds_read_b64_tr_b16 v[72:73], v13 offset:32768
v_accvgpr_read_b32 v24, a192
v_mfma_f32_16x16x32_bf16 v[160:163], v[84:87], v[100:103], v[160:163]
s_lshl_b32 s73, s73, 7
ds_read_b64_tr_b16 v[74:75], v13 offset:33792
v_accvgpr_read_b32 v28, a193
v_mfma_f32_16x16x32_bf16 v[164:167], v[84:87], v[108:111], v[164:167]
s_add_u32 s69, s73, s67
v_accvgpr_read_b32 v25, a194
v_accvgpr_read_b32 v29, a195
v_mfma_f32_16x16x32_bf16 v[164:167], v[80:83], v[104:107], v[164:167]
s_add_u32 s72, s71, 63488
buffer_load_dwordx4 v7, s[12:15], s72 offen offset:2048 lds
v_mfma_f32_16x16x32_bf16 v[168:171], v[80:83], v[112:115], v[168:171]
s_waitcnt vmcnt(19)
ds_read_b64_tr_b16 v[76:77], v13 offset:40960
v_accvgpr_read_b32 v26, a196
v_mfma_f32_16x16x32_bf16 v[168:171], v[84:87], v[116:119], v[168:171]
s_add_u32 s70, s73, s68
ds_read_b128 v[32:35], v16 offset:0
v_accvgpr_read_b32 v30, a197
v_mfma_f32_16x16x32_bf16 v[172:175], v[84:87], v[124:127], v[172:175]
s_add_u32 s80, s77, 9216
ds_read_b64_tr_b16 v[78:79], v13 offset:41984
v_accvgpr_read_b32 v27, a198
v_mfma_f32_16x16x32_bf16 v[172:175], v[80:83], v[120:123], v[172:175]
s_waitcnt lgkmcnt(9)
ds_read_b128 v[36:39], v17 offset:0
v_accvgpr_read_b32 v31, a199
v_mfma_f32_16x16x32_bf16 v[188:191], v[88:91], v[120:123], v[188:191]
s_add_u32 s72, s71, 95232
buffer_load_dwordx4 v7, s[12:15], s72 offen offset:3072 lds
v_mfma_f32_16x16x32_bf16 v[188:191], v[92:95], v[124:127], v[188:191]
ds_read_b64_tr_b16 v[80:81], v14 offset:32768
v_cvt_pk_bf16_f32 v24, v24, v28
v_mfma_f32_16x16x32_bf16 v[184:187], v[92:95], v[116:119], v[184:187]
ds_read_b64_tr_b16 v[82:83], v14 offset:33792
v_cvt_pk_bf16_f32 v25, v25, v29
v_mfma_f32_16x16x32_bf16 v[184:187], v[88:91], v[112:115], v[184:187]
buffer_store_dwordx4 v[20:23], v1, s[44:47], s80 offen sc1
v_mfma_f32_16x16x32_bf16 v[180:183], v[88:91], v[104:107], v[180:183]
ds_read_b64_tr_b16 v[84:85], v14 offset:40960
v_cvt_pk_bf16_f32 v26, v26, v30
v_mfma_f32_16x16x32_bf16 v[180:183], v[92:95], v[108:111], v[180:183]
s_add_u32 m0, s63, 98304
ds_read_b64_tr_b16 v[86:87], v14 offset:41984
v_cvt_pk_bf16_f32 v27, v27, v31
v_mfma_f32_16x16x32_bf16 v[176:179], v[92:95], v[100:103], v[176:179]
s_add_u32 s72, s69, 0
buffer_load_dwordx4 v4, s[4:7], s72 offen lds
v_mfma_f32_16x16x32_bf16 v[176:179], v[88:91], v[96:99], v[176:179]
s_waitcnt lgkmcnt(10)
ds_read_b128 v[40:43], v16 offset:2048
v_mfma_f32_16x16x32_bf16 v[192:195], v[64:67], v[96:99], v[192:195]
s_add_u32 s80, s78, 2048
ds_read_b64_tr_b16 v[88:89], v15 offset:32768
v_mfma_f32_16x16x32_bf16 v[192:195], v[68:71], v[100:103], v[192:195]
ds_read_b64_tr_b16 v[90:91], v15 offset:33792
v_mfma_f32_16x16x32_bf16 v[196:199], v[68:71], v[108:111], v[196:199]
ds_read_b64_tr_b16 v[92:93], v15 offset:40960
v_mfma_f32_16x16x32_bf16 v[196:199], v[64:67], v[104:107], v[196:199]
s_add_u32 s72, s69, 15360
buffer_load_dwordx4 v5, s[4:7], s72 offen offset:1024 lds
v_mfma_f32_16x16x32_bf16 v[200:203], v[64:67], v[112:115], v[200:203]
ds_read_b64_tr_b16 v[94:95], v15 offset:41984
v_accvgpr_read_b32 v20, a76
v_mfma_f32_16x16x32_bf16 v[200:203], v[68:71], v[116:119], v[200:203]
ds_read_b128 v[44:47], v17 offset:2048
v_accvgpr_read_b32 v28, a77
v_mfma_f32_16x16x32_bf16 v[204:207], v[68:71], v[124:127], v[204:207]
buffer_store_dwordx4 v[24:27], v1, s[44:47], s80 offen sc1
v_mfma_f32_16x16x32_bf16 v[204:207], v[64:67], v[120:123], v[204:207]
s_waitcnt lgkmcnt(11)
ds_read_b128 v[48:51], v16 offset:4096
v_accvgpr_read_b32 v21, a78
v_mfma_f32_16x16x32_bf16 v[220:223], v[72:75], v[120:123], v[220:223]
s_add_u32 s72, s69, 129024
buffer_load_dwordx4 v4, s[4:7], s72 offen offset:2048 lds
v_mfma_f32_16x16x32_bf16 v[220:223], v[76:79], v[124:127], v[220:223]
v_accvgpr_read_b32 v29, a79
v_accvgpr_read_b32 v22, a108
v_mfma_f32_16x16x32_bf16 v[216:219], v[76:79], v[116:119], v[216:219]
s_waitcnt vmcnt(20) lgkmcnt(2)
ds_read_b128 v[52:55], v17 offset:4096
v_accvgpr_read_b32 v30, a109
v_mfma_f32_16x16x32_bf16 v[216:219], v[72:75], v[112:115], v[216:219]
s_barrier
ds_read_b128 v[56:59], v16 offset:6144
v_accvgpr_read_b32 v23, a110
v_mfma_f32_16x16x32_bf16 v[212:215], v[72:75], v[104:107], v[212:215]
ds_read_b64_tr_b16 v[64:65], v8 offset:0
ds_read_b64_tr_b16 v[66:67], v8 offset:1024
v_mfma_f32_16x16x32_bf16 v[212:215], v[76:79], v[108:111], v[212:215]
ds_read_b64_tr_b16 v[68:69], v8 offset:8192
v_accvgpr_read_b32 v31, a111
v_mfma_f32_16x16x32_bf16 v[208:211], v[76:79], v[100:103], v[208:211]
s_add_u32 s72, s69, 144384
buffer_load_dwordx4 v5, s[4:7], s72 offen offset:3072 lds
v_mfma_f32_16x16x32_bf16 v[208:211], v[72:75], v[96:99], v[208:211]
ds_read_b64_tr_b16 v[70:71], v8 offset:9216
v_mul_f32 v20, s79, v20
v_mfma_f32_16x16x32_bf16 v[224:227], v[80:83], v[96:99], v[224:227]
ds_read_b64_tr_b16 v[72:73], v9 offset:0
v_mul_f32 v28, s79, v28
v_mfma_f32_16x16x32_bf16 v[224:227], v[84:87], v[100:103], v[224:227]
ds_read_b64_tr_b16 v[74:75], v9 offset:1024
v_mul_f32 v21, s79, v21
v_mfma_f32_16x16x32_bf16 v[228:231], v[84:87], v[108:111], v[228:231]
s_add_u32 m0, s63, 102400
v_mul_f32 v29, s79, v29
v_mul_f32 v22, s79, v22
v_mfma_f32_16x16x32_bf16 v[228:231], v[80:83], v[104:107], v[228:231]
s_add_u32 s72, s70, 0
buffer_load_dwordx4 v4, s[4:7], s72 offen lds
v_mfma_f32_16x16x32_bf16 v[232:235], v[80:83], v[112:115], v[232:235]
ds_read_b64_tr_b16 v[76:77], v9 offset:8192
v_mul_f32 v30, s79, v30
v_mfma_f32_16x16x32_bf16 v[232:235], v[84:87], v[116:119], v[232:235]
ds_read_b128 v[60:63], v17 offset:6144
v_mul_f32 v23, s79, v23
v_mfma_f32_16x16x32_bf16 v[236:239], v[84:87], v[124:127], v[236:239]
ds_read_b64_tr_b16 v[78:79], v9 offset:9216
v_mul_f32 v31, s79, v31
v_mfma_f32_16x16x32_bf16 v[236:239], v[80:83], v[120:123], v[236:239]
v_cvt_pk_bf16_f32 v20, v20, v28
v_cvt_pk_bf16_f32 v21, v21, v29
v_mfma_f32_16x16x32_bf16 v[252:255], v[88:91], v[120:123], v[252:255]
s_add_u32 s72, s70, 15360
buffer_load_dwordx4 v5, s[4:7], s72 offen offset:1024 lds
v_mfma_f32_16x16x32_bf16 v[252:255], v[92:95], v[124:127], v[252:255]
ds_read_b64_tr_b16 v[80:81], v10 offset:0
v_cvt_pk_bf16_f32 v22, v22, v30
v_mfma_f32_16x16x32_bf16 v[248:251], v[92:95], v[116:119], v[248:251]
ds_read_b64_tr_b16 v[82:83], v10 offset:1024
v_cvt_pk_bf16_f32 v23, v23, v31
v_mfma_f32_16x16x32_bf16 v[248:251], v[88:91], v[112:115], v[248:251]
s_add_u32 s80, s77, 13312
buffer_store_dwordx4 v[20:23], v1, s[44:47], s80 offen sc1
v_mfma_f32_16x16x32_bf16 v[244:247], v[88:91], v[104:107], v[244:247]
ds_read_b64_tr_b16 v[84:85], v10 offset:8192
v_accvgpr_read_b32 v24, a200
v_mfma_f32_16x16x32_bf16 v[244:247], v[92:95], v[108:111], v[244:247]
ds_read_b64_tr_b16 v[86:87], v10 offset:9216
v_accvgpr_read_b32 v28, a201
v_mfma_f32_16x16x32_bf16 v[240:243], v[92:95], v[100:103], v[240:243]
s_add_u32 s72, s70, 129024
buffer_load_dwordx4 v4, s[4:7], s72 offen offset:2048 lds
v_mfma_f32_16x16x32_bf16 v[240:243], v[88:91], v[96:99], v[240:243]
s_waitcnt lgkmcnt(5)
v_accvgpr_read_b32 v25, a202
v_accvgpr_read_b32 v29, a203
v_mfma_f32_16x16x32_bf16 v[128:131], v[64:67], v[32:35], v[128:131]
ds_read_b64_tr_b16 v[88:89], v11 offset:0
v_accvgpr_read_b32 v26, a204
v_mfma_f32_16x16x32_bf16 v[128:131], v[68:71], v[36:39], v[128:131]
ds_read_b64_tr_b16 v[90:91], v11 offset:1024
v_accvgpr_read_b32 v30, a205
v_mfma_f32_16x16x32_bf16 v[132:135], v[68:71], v[44:47], v[132:135]
v_accvgpr_read_b32 v27, a206
v_accvgpr_read_b32 v31, a207
v_mfma_f32_16x16x32_bf16 v[132:135], v[64:67], v[40:43], v[132:135]
s_add_u32 s72, s70, 144384
buffer_load_dwordx4 v5, s[4:7], s72 offen offset:3072 lds
v_mfma_f32_16x16x32_bf16 v[136:139], v[64:67], v[48:51], v[136:139]
ds_read_b64_tr_b16 v[92:93], v11 offset:8192
v_cvt_pk_bf16_f32 v24, v24, v28
v_mfma_f32_16x16x32_bf16 v[136:139], v[68:71], v[52:55], v[136:139]
s_lshl_b32 s71, s73, 12
v_cvt_pk_bf16_f32 v25, v25, v29
v_cvt_pk_bf16_f32 v26, v26, v30
v_mfma_f32_16x16x32_bf16 v[140:143], v[68:71], v[60:63], v[140:143]
s_add_u32 s71, s71, s66
ds_read_b64_tr_b16 v[94:95], v11 offset:9216
v_cvt_pk_bf16_f32 v27, v27, v31
v_mfma_f32_16x16x32_bf16 v[140:143], v[64:67], v[56:59], v[140:143]
s_waitcnt lgkmcnt(8)
v_mfma_f32_16x16x32_bf16 v[156:159], v[72:75], v[56:59], v[156:159]
s_add_u32 m0, s64, 32768
ds_read_b64_tr_b16 v[64:65], v12 offset:0
v_mfma_f32_16x16x32_bf16 v[156:159], v[76:79], v[60:63], v[156:159]
s_add_u32 s72, s71, 0
buffer_load_dwordx4 v6, s[12:15], s72 offen lds
v_mfma_f32_16x16x32_bf16 v[152:155], v[76:79], v[52:55], v[152:155]
s_add_u32 s73, s62, 9
ds_read_b64_tr_b16 v[66:67], v12 offset:1024
v_mfma_f32_16x16x32_bf16 v[152:155], v[72:75], v[48:51], v[152:155]
s_add_u32 s70, s73, s65
v_mfma_f32_16x16x32_bf16 v[148:151], v[72:75], v[40:43], v[148:151]
s_and_b32 s70, s70, 3
ds_read_b64_tr_b16 v[68:69], v12 offset:8192
v_mfma_f32_16x16x32_bf16 v[148:151], v[76:79], v[44:47], v[148:151]
s_and_b32 s73, s73, 12
ds_read_b64_tr_b16 v[70:71], v12 offset:9216
v_mfma_f32_16x16x32_bf16 v[144:147], v[76:79], v[36:39], v[144:147]
s_add_u32 s72, s71, 31744
buffer_load_dwordx4 v6, s[12:15], s72 offen offset:1024 lds
v_mfma_f32_16x16x32_bf16 v[144:147], v[72:75], v[32:35], v[144:147]
s_waitcnt lgkmcnt(8)
v_mfma_f32_16x16x32_bf16 v[160:163], v[80:83], v[32:35], v[160:163]
s_or_b32 s73, s73, s70
ds_read_b64_tr_b16 v[72:73], v13 offset:0
v_accvgpr_read_b32 v20, a80
v_mfma_f32_16x16x32_bf16 v[160:163], v[84:87], v[36:39], v[160:163]
s_lshl_b32 s73, s73, 7
ds_read_b64_tr_b16 v[74:75], v13 offset:1024
v_accvgpr_read_b32 v28, a81
v_mfma_f32_16x16x32_bf16 v[164:167], v[84:87], v[44:47], v[164:167]
s_add_u32 s69, s73, s67
v_accvgpr_read_b32 v21, a82
v_accvgpr_read_b32 v29, a83
v_mfma_f32_16x16x32_bf16 v[164:167], v[80:83], v[40:43], v[164:167]
s_add_u32 s72, s71, 63488
buffer_load_dwordx4 v7, s[12:15], s72 offen offset:2048 lds
v_mfma_f32_16x16x32_bf16 v[168:171], v[80:83], v[48:51], v[168:171]
s_waitcnt vmcnt(19)
ds_read_b64_tr_b16 v[76:77], v13 offset:8192
v_accvgpr_read_b32 v22, a112
v_mfma_f32_16x16x32_bf16 v[168:171], v[84:87], v[52:55], v[168:171]
s_add_u32 s70, s73, s68
ds_read_b128 v[96:99], v18 offset:0
v_accvgpr_read_b32 v30, a113
v_mfma_f32_16x16x32_bf16 v[172:175], v[84:87], v[60:63], v[172:175]
s_add_u32 s80, s78, 10240
ds_read_b64_tr_b16 v[78:79], v13 offset:9216
v_accvgpr_read_b32 v23, a114
v_mfma_f32_16x16x32_bf16 v[172:175], v[80:83], v[56:59], v[172:175]
s_waitcnt lgkmcnt(9)
ds_read_b128 v[100:103], v19 offset:0
v_accvgpr_read_b32 v31, a115
v_mfma_f32_16x16x32_bf16 v[188:191], v[88:91], v[56:59], v[188:191]
s_add_u32 s72, s71, 95232
buffer_load_dwordx4 v7, s[12:15], s72 offen offset:3072 lds
v_mfma_f32_16x16x32_bf16 v[188:191], v[92:95], v[60:63], v[188:191]
ds_read_b64_tr_b16 v[80:81], v14 offset:0
v_mul_f32 v20, s79, v20
v_mfma_f32_16x16x32_bf16 v[184:187], v[92:95], v[52:55], v[184:187]
ds_read_b64_tr_b16 v[82:83], v14 offset:1024
v_mul_f32 v28, s79, v28
v_mfma_f32_16x16x32_bf16 v[184:187], v[88:91], v[48:51], v[184:187]
buffer_store_dwordx4 v[24:27], v1, s[44:47], s80 offen sc1
v_mfma_f32_16x16x32_bf16 v[180:183], v[88:91], v[40:43], v[180:183]
ds_read_b64_tr_b16 v[84:85], v14 offset:8192
v_mul_f32 v21, s79, v21
v_mfma_f32_16x16x32_bf16 v[180:183], v[92:95], v[44:47], v[180:183]
s_add_u32 m0, s63, 131072
ds_read_b64_tr_b16 v[86:87], v14 offset:9216
v_mul_f32 v29, s79, v29
v_mfma_f32_16x16x32_bf16 v[176:179], v[92:95], v[36:39], v[176:179]
s_add_u32 s72, s69, 0
buffer_load_dwordx4 v4, s[4:7], s72 offen lds
v_mfma_f32_16x16x32_bf16 v[176:179], v[88:91], v[32:35], v[176:179]
s_waitcnt lgkmcnt(10)
ds_read_b128 v[104:107], v18 offset:2048
v_mul_f32 v22, s79, v22
v_mfma_f32_16x16x32_bf16 v[192:195], v[64:67], v[32:35], v[192:195]
ds_read_b64_tr_b16 v[88:89], v15 offset:0
v_mul_f32 v30, s79, v30
v_mfma_f32_16x16x32_bf16 v[192:195], v[68:71], v[36:39], v[192:195]
ds_read_b64_tr_b16 v[90:91], v15 offset:1024
v_mul_f32 v23, s79, v23
v_mfma_f32_16x16x32_bf16 v[196:199], v[68:71], v[44:47], v[196:199]
ds_read_b64_tr_b16 v[92:93], v15 offset:8192
v_mul_f32 v31, s79, v31
v_mfma_f32_16x16x32_bf16 v[196:199], v[64:67], v[40:43], v[196:199]
s_add_u32 s72, s69, 15360
buffer_load_dwordx4 v5, s[4:7], s72 offen offset:1024 lds
v_mfma_f32_16x16x32_bf16 v[200:203], v[64:67], v[48:51], v[200:203]
ds_read_b64_tr_b16 v[94:95], v15 offset:9216
v_cvt_pk_bf16_f32 v20, v20, v28
v_mfma_f32_16x16x32_bf16 v[200:203], v[68:71], v[52:55], v[200:203]
ds_read_b128 v[108:111], v19 offset:2048
v_cvt_pk_bf16_f32 v21, v21, v29
v_mfma_f32_16x16x32_bf16 v[204:207], v[68:71], v[60:63], v[204:207]
v_cvt_pk_bf16_f32 v22, v22, v30
v_cvt_pk_bf16_f32 v23, v23, v31
v_mfma_f32_16x16x32_bf16 v[204:207], v[64:67], v[56:59], v[204:207]
s_waitcnt lgkmcnt(11)
ds_read_b128 v[112:115], v18 offset:4096
v_accvgpr_read_b32 v24, a208
v_mfma_f32_16x16x32_bf16 v[220:223], v[72:75], v[56:59], v[220:223]
s_add_u32 s72, s69, 129024
buffer_load_dwordx4 v4, s[4:7], s72 offen offset:2048 lds
v_mfma_f32_16x16x32_bf16 v[220:223], v[76:79], v[60:63], v[220:223]
s_add_u32 s80, s77, 33792
buffer_store_dwordx4 v[20:23], v1, s[44:47], s80 offen sc1
v_mfma_f32_16x16x32_bf16 v[216:219], v[76:79], v[52:55], v[216:219]
s_waitcnt vmcnt(20) lgkmcnt(2)
ds_read_b128 v[116:119], v19 offset:4096
v_accvgpr_read_b32 v28, a209
v_mfma_f32_16x16x32_bf16 v[216:219], v[72:75], v[48:51], v[216:219]
s_barrier
ds_read_b128 v[120:123], v18 offset:6144
v_accvgpr_read_b32 v25, a210
v_mfma_f32_16x16x32_bf16 v[212:215], v[72:75], v[40:43], v[212:215]
ds_read_b64_tr_b16 v[64:65], v8 offset:16384
ds_read_b64_tr_b16 v[66:67], v8 offset:17408
v_mfma_f32_16x16x32_bf16 v[212:215], v[76:79], v[44:47], v[212:215]
ds_read_b64_tr_b16 v[68:69], v8 offset:24576
v_accvgpr_read_b32 v29, a211
v_mfma_f32_16x16x32_bf16 v[208:211], v[76:79], v[36:39], v[208:211]
s_add_u32 s72, s69, 144384
buffer_load_dwordx4 v5, s[4:7], s72 offen offset:3072 lds
v_mfma_f32_16x16x32_bf16 v[208:211], v[72:75], v[32:35], v[208:211]
ds_read_b64_tr_b16 v[70:71], v8 offset:25600
v_accvgpr_read_b32 v26, a212
v_mfma_f32_16x16x32_bf16 v[224:227], v[80:83], v[32:35], v[224:227]
ds_read_b64_tr_b16 v[72:73], v9 offset:16384
v_accvgpr_read_b32 v30, a213
v_mfma_f32_16x16x32_bf16 v[224:227], v[84:87], v[36:39], v[224:227]
ds_read_b64_tr_b16 v[74:75], v9 offset:17408
v_accvgpr_read_b32 v27, a214
v_mfma_f32_16x16x32_bf16 v[228:231], v[84:87], v[44:47], v[228:231]
s_add_u32 m0, s63, 135168
v_accvgpr_read_b32 v31, a215
v_cvt_pk_bf16_f32 v24, v24, v28
v_mfma_f32_16x16x32_bf16 v[228:231], v[80:83], v[40:43], v[228:231]
s_add_u32 s72, s70, 0
buffer_load_dwordx4 v4, s[4:7], s72 offen lds
v_mfma_f32_16x16x32_bf16 v[232:235], v[80:83], v[48:51], v[232:235]
ds_read_b64_tr_b16 v[76:77], v9 offset:24576
v_cvt_pk_bf16_f32 v25, v25, v29
v_mfma_f32_16x16x32_bf16 v[232:235], v[84:87], v[52:55], v[232:235]
ds_read_b128 v[124:127], v19 offset:6144
v_cvt_pk_bf16_f32 v26, v26, v30
v_mfma_f32_16x16x32_bf16 v[236:239], v[84:87], v[60:63], v[236:239]
ds_read_b64_tr_b16 v[78:79], v9 offset:25600
v_cvt_pk_bf16_f32 v27, v27, v31
v_mfma_f32_16x16x32_bf16 v[236:239], v[80:83], v[56:59], v[236:239]
s_add_u32 s80, s78, 34816
buffer_store_dwordx4 v[24:27], v1, s[44:47], s80 offen sc1
v_mfma_f32_16x16x32_bf16 v[252:255], v[88:91], v[56:59], v[252:255]
s_add_u32 s72, s70, 15360
buffer_load_dwordx4 v5, s[4:7], s72 offen offset:1024 lds
v_mfma_f32_16x16x32_bf16 v[252:255], v[92:95], v[60:63], v[252:255]
ds_read_b64_tr_b16 v[80:81], v10 offset:16384
v_mfma_f32_16x16x32_bf16 v[248:251], v[92:95], v[52:55], v[248:251]
ds_read_b64_tr_b16 v[82:83], v10 offset:17408
v_mfma_f32_16x16x32_bf16 v[248:251], v[88:91], v[48:51], v[248:251]
v_mfma_f32_16x16x32_bf16 v[244:247], v[88:91], v[40:43], v[244:247]
ds_read_b64_tr_b16 v[84:85], v10 offset:24576
v_mfma_f32_16x16x32_bf16 v[244:247], v[92:95], v[44:47], v[244:247]
ds_read_b64_tr_b16 v[86:87], v10 offset:25600
v_accvgpr_read_b32 v20, a84
v_mfma_f32_16x16x32_bf16 v[240:243], v[92:95], v[36:39], v[240:243]
s_add_u32 s72, s70, 129024
buffer_load_dwordx4 v4, s[4:7], s72 offen offset:2048 lds
v_mfma_f32_16x16x32_bf16 v[240:243], v[88:91], v[32:35], v[240:243]
s_waitcnt lgkmcnt(5)
v_accvgpr_read_b32 v28, a85
v_accvgpr_read_b32 v21, a86
v_mfma_f32_16x16x32_bf16 v[128:131], v[64:67], v[96:99], v[128:131]
ds_read_b64_tr_b16 v[88:89], v11 offset:16384
v_accvgpr_read_b32 v29, a87
v_mfma_f32_16x16x32_bf16 v[128:131], v[68:71], v[100:103], v[128:131]
ds_read_b64_tr_b16 v[90:91], v11 offset:17408
v_accvgpr_read_b32 v22, a116
v_mfma_f32_16x16x32_bf16 v[132:135], v[68:71], v[108:111], v[132:135]
v_accvgpr_read_b32 v30, a117
v_accvgpr_read_b32 v23, a118
v_mfma_f32_16x16x32_bf16 v[132:135], v[64:67], v[104:107], v[132:135]
s_add_u32 s72, s70, 144384
buffer_load_dwordx4 v5, s[4:7], s72 offen offset:3072 lds
v_mfma_f32_16x16x32_bf16 v[136:139], v[64:67], v[112:115], v[136:139]
ds_read_b64_tr_b16 v[92:93], v11 offset:24576
v_accvgpr_read_b32 v31, a119
v_mfma_f32_16x16x32_bf16 v[136:139], v[68:71], v[116:119], v[136:139]
s_lshl_b32 s71, s73, 12
v_mul_f32 v20, s79, v20
v_mul_f32 v28, s79, v28
v_mfma_f32_16x16x32_bf16 v[140:143], v[68:71], v[124:127], v[140:143]
s_add_u32 s71, s71, s66
ds_read_b64_tr_b16 v[94:95], v11 offset:25600
v_mul_f32 v21, s79, v21
v_mfma_f32_16x16x32_bf16 v[140:143], v[64:67], v[120:123], v[140:143]
s_waitcnt lgkmcnt(8)
v_mul_f32 v29, s79, v29
v_mul_f32 v22, s79, v22
v_mfma_f32_16x16x32_bf16 v[156:159], v[72:75], v[120:123], v[156:159]
s_add_u32 m0, s64, 0
ds_read_b64_tr_b16 v[64:65], v12 offset:16384
v_mul_f32 v30, s79, v30
v_mfma_f32_16x16x32_bf16 v[156:159], v[76:79], v[124:127], v[156:159]
s_add_u32 s72, s71, 0
buffer_load_dwordx4 v6, s[12:15], s72 offen lds
v_mfma_f32_16x16x32_bf16 v[152:155], v[76:79], v[116:119], v[152:155]
s_add_u32 s73, s62, 10
ds_read_b64_tr_b16 v[66:67], v12 offset:17408
v_mul_f32 v23, s79, v23
v_mfma_f32_16x16x32_bf16 v[152:155], v[72:75], v[112:115], v[152:155]
s_add_u32 s70, s73, s65
v_mul_f32 v31, s79, v31
v_cvt_pk_bf16_f32 v20, v20, v28
v_mfma_f32_16x16x32_bf16 v[148:151], v[72:75], v[104:107], v[148:151]
s_and_b32 s70, s70, 3
ds_read_b64_tr_b16 v[68:69], v12 offset:24576
v_cvt_pk_bf16_f32 v21, v21, v29
v_mfma_f32_16x16x32_bf16 v[148:151], v[76:79], v[108:111], v[148:151]
s_and_b32 s73, s73, 12
ds_read_b64_tr_b16 v[70:71], v12 offset:25600
v_cvt_pk_bf16_f32 v22, v22, v30
v_mfma_f32_16x16x32_bf16 v[144:147], v[76:79], v[100:103], v[144:147]
s_add_u32 s72, s71, 31744
buffer_load_dwordx4 v6, s[12:15], s72 offen offset:1024 lds
v_mfma_f32_16x16x32_bf16 v[144:147], v[72:75], v[96:99], v[144:147]
s_waitcnt lgkmcnt(8)
v_cvt_pk_bf16_f32 v23, v23, v31
v_mfma_f32_16x16x32_bf16 v[160:163], v[80:83], v[96:99], v[160:163]
s_or_b32 s73, s73, s70
ds_read_b64_tr_b16 v[72:73], v13 offset:16384
v_mfma_f32_16x16x32_bf16 v[160:163], v[84:87], v[100:103], v[160:163]
s_lshl_b32 s73, s73, 7
ds_read_b64_tr_b16 v[74:75], v13 offset:17408
v_mfma_f32_16x16x32_bf16 v[164:167], v[84:87], v[108:111], v[164:167]
s_add_u32 s69, s73, s67
v_mfma_f32_16x16x32_bf16 v[164:167], v[80:83], v[104:107], v[164:167]
s_add_u32 s72, s71, 63488
buffer_load_dwordx4 v7, s[12:15], s72 offen offset:2048 lds
v_mfma_f32_16x16x32_bf16 v[168:171], v[80:83], v[112:115], v[168:171]
s_waitcnt vmcnt(18)
ds_read_b64_tr_b16 v[76:77], v13 offset:24576
v_accvgpr_read_b32 v24, a216
v_mfma_f32_16x16x32_bf16 v[168:171], v[84:87], v[116:119], v[168:171]
s_add_u32 s70, s73, s68
ds_read_b128 v[32:35], v18 offset:32768
v_accvgpr_read_b32 v28, a217
v_mfma_f32_16x16x32_bf16 v[172:175], v[84:87], v[124:127], v[172:175]
s_add_u32 s80, s77, 37888
ds_read_b64_tr_b16 v[78:79], v13 offset:25600
v_accvgpr_read_b32 v25, a218
v_mfma_f32_16x16x32_bf16 v[172:175], v[80:83], v[120:123], v[172:175]
s_waitcnt lgkmcnt(9)
ds_read_b128 v[36:39], v19 offset:32768
v_accvgpr_read_b32 v29, a219
v_mfma_f32_16x16x32_bf16 v[188:191], v[88:91], v[120:123], v[188:191]
s_add_u32 s72, s71, 95232
buffer_load_dwordx4 v7, s[12:15], s72 offen offset:3072 lds
v_mfma_f32_16x16x32_bf16 v[188:191], v[92:95], v[124:127], v[188:191]
ds_read_b64_tr_b16 v[80:81], v14 offset:16384
v_accvgpr_read_b32 v26, a220
v_mfma_f32_16x16x32_bf16 v[184:187], v[92:95], v[116:119], v[184:187]
ds_read_b64_tr_b16 v[82:83], v14 offset:17408
v_accvgpr_read_b32 v30, a221
v_mfma_f32_16x16x32_bf16 v[184:187], v[88:91], v[112:115], v[184:187]
buffer_store_dwordx4 v[20:23], v1, s[44:47], s80 offen sc1
v_mfma_f32_16x16x32_bf16 v[180:183], v[88:91], v[104:107], v[180:183]
ds_read_b64_tr_b16 v[84:85], v14 offset:24576
v_accvgpr_read_b32 v27, a222
v_mfma_f32_16x16x32_bf16 v[180:183], v[92:95], v[108:111], v[180:183]
s_add_u32 m0, s63, 65536
ds_read_b64_tr_b16 v[86:87], v14 offset:25600
v_accvgpr_read_b32 v31, a223
v_mfma_f32_16x16x32_bf16 v[176:179], v[92:95], v[100:103], v[176:179]
s_add_u32 s72, s69, 0
buffer_load_dwordx4 v4, s[4:7], s72 offen lds
v_mfma_f32_16x16x32_bf16 v[176:179], v[88:91], v[96:99], v[176:179]
s_waitcnt lgkmcnt(10)
ds_read_b128 v[40:43], v18 offset:34816
v_cvt_pk_bf16_f32 v24, v24, v28
v_mfma_f32_16x16x32_bf16 v[192:195], v[64:67], v[96:99], v[192:195]
ds_read_b64_tr_b16 v[88:89], v15 offset:16384
v_cvt_pk_bf16_f32 v25, v25, v29
v_mfma_f32_16x16x32_bf16 v[192:195], v[68:71], v[100:103], v[192:195]
ds_read_b64_tr_b16 v[90:91], v15 offset:17408
v_cvt_pk_bf16_f32 v26, v26, v30
v_mfma_f32_16x16x32_bf16 v[196:199], v[68:71], v[108:111], v[196:199]
ds_read_b64_tr_b16 v[92:93], v15 offset:24576
v_cvt_pk_bf16_f32 v27, v27, v31
v_mfma_f32_16x16x32_bf16 v[196:199], v[64:67], v[104:107], v[196:199]
s_add_u32 s72, s69, 15360
buffer_load_dwordx4 v5, s[4:7], s72 offen offset:1024 lds
v_mfma_f32_16x16x32_bf16 v[200:203], v[64:67], v[112:115], v[200:203]
s_add_u32 s80, s78, 43008
ds_read_b64_tr_b16 v[94:95], v15 offset:25600
v_mfma_f32_16x16x32_bf16 v[200:203], v[68:71], v[116:119], v[200:203]
ds_read_b128 v[44:47], v19 offset:34816
v_mfma_f32_16x16x32_bf16 v[204:207], v[68:71], v[124:127], v[204:207]
buffer_store_dwordx4 v[24:27], v1, s[44:47], s80 offen sc1
v_mfma_f32_16x16x32_bf16 v[204:207], v[64:67], v[120:123], v[204:207]
s_waitcnt lgkmcnt(11)
ds_read_b128 v[48:51], v18 offset:36864
v_mfma_f32_16x16x32_bf16 v[220:223], v[72:75], v[120:123], v[220:223]
s_add_u32 s72, s69, 129024
buffer_load_dwordx4 v4, s[4:7], s72 offen offset:2048 lds
v_mfma_f32_16x16x32_bf16 v[220:223], v[76:79], v[124:127], v[220:223]
v_accvgpr_read_b32 v20, a88
v_accvgpr_read_b32 v28, a89
v_mfma_f32_16x16x32_bf16 v[216:219], v[76:79], v[116:119], v[216:219]
s_waitcnt vmcnt(20) lgkmcnt(2)
ds_read_b128 v[52:55], v19 offset:36864
v_accvgpr_read_b32 v21, a90
v_mfma_f32_16x16x32_bf16 v[216:219], v[72:75], v[112:115], v[216:219]
s_barrier
ds_read_b128 v[56:59], v18 offset:38912
v_accvgpr_read_b32 v29, a91
v_mfma_f32_16x16x32_bf16 v[212:215], v[72:75], v[104:107], v[212:215]
ds_read_b64_tr_b16 v[64:65], v8 offset:32768
ds_read_b64_tr_b16 v[66:67], v8 offset:33792
v_mfma_f32_16x16x32_bf16 v[212:215], v[76:79], v[108:111], v[212:215]
ds_read_b64_tr_b16 v[68:69], v8 offset:40960
v_accvgpr_read_b32 v22, a120
v_mfma_f32_16x16x32_bf16 v[208:211], v[76:79], v[100:103], v[208:211]
s_add_u32 s72, s69, 144384
buffer_load_dwordx4 v5, s[4:7], s72 offen offset:3072 lds
v_mfma_f32_16x16x32_bf16 v[208:211], v[72:75], v[96:99], v[208:211]
ds_read_b64_tr_b16 v[70:71], v8 offset:41984
v_accvgpr_read_b32 v30, a121
v_mfma_f32_16x16x32_bf16 v[224:227], v[80:83], v[96:99], v[224:227]
ds_read_b64_tr_b16 v[72:73], v9 offset:32768
v_accvgpr_read_b32 v23, a122
v_mfma_f32_16x16x32_bf16 v[224:227], v[84:87], v[100:103], v[224:227]
ds_read_b64_tr_b16 v[74:75], v9 offset:33792
v_accvgpr_read_b32 v31, a123
v_mfma_f32_16x16x32_bf16 v[228:231], v[84:87], v[108:111], v[228:231]
s_add_u32 m0, s63, 69632
v_mul_f32 v20, s79, v20
v_mul_f32 v28, s79, v28
v_mfma_f32_16x16x32_bf16 v[228:231], v[80:83], v[104:107], v[228:231]
s_add_u32 s72, s70, 0
buffer_load_dwordx4 v4, s[4:7], s72 offen lds
v_mfma_f32_16x16x32_bf16 v[232:235], v[80:83], v[112:115], v[232:235]
ds_read_b64_tr_b16 v[76:77], v9 offset:40960
v_mul_f32 v21, s79, v21
v_mfma_f32_16x16x32_bf16 v[232:235], v[84:87], v[116:119], v[232:235]
ds_read_b128 v[60:63], v19 offset:38912
v_mul_f32 v29, s79, v29
v_mfma_f32_16x16x32_bf16 v[236:239], v[84:87], v[124:127], v[236:239]
ds_read_b64_tr_b16 v[78:79], v9 offset:41984
v_mul_f32 v22, s79, v22
v_mfma_f32_16x16x32_bf16 v[236:239], v[80:83], v[120:123], v[236:239]
v_mul_f32 v30, s79, v30
v_mul_f32 v23, s79, v23
v_mfma_f32_16x16x32_bf16 v[252:255], v[88:91], v[120:123], v[252:255]
s_add_u32 s72, s70, 15360
buffer_load_dwordx4 v5, s[4:7], s72 offen offset:1024 lds
v_mfma_f32_16x16x32_bf16 v[252:255], v[92:95], v[124:127], v[252:255]
ds_read_b64_tr_b16 v[80:81], v10 offset:32768
v_mul_f32 v31, s79, v31
v_mfma_f32_16x16x32_bf16 v[248:251], v[92:95], v[116:119], v[248:251]
ds_read_b64_tr_b16 v[82:83], v10 offset:33792
v_cvt_pk_bf16_f32 v20, v20, v28
v_mfma_f32_16x16x32_bf16 v[248:251], v[88:91], v[112:115], v[248:251]
v_cvt_pk_bf16_f32 v21, v21, v29
v_cvt_pk_bf16_f32 v22, v22, v30
v_mfma_f32_16x16x32_bf16 v[244:247], v[88:91], v[104:107], v[244:247]
ds_read_b64_tr_b16 v[84:85], v10 offset:40960
v_cvt_pk_bf16_f32 v23, v23, v31
v_mfma_f32_16x16x32_bf16 v[244:247], v[92:95], v[108:111], v[244:247]
s_add_u32 s80, s77, 41984
ds_read_b64_tr_b16 v[86:87], v10 offset:41984
v_mfma_f32_16x16x32_bf16 v[240:243], v[92:95], v[100:103], v[240:243]
s_add_u32 s72, s70, 129024
buffer_load_dwordx4 v4, s[4:7], s72 offen offset:2048 lds
v_mfma_f32_16x16x32_bf16 v[240:243], v[88:91], v[96:99], v[240:243]
s_waitcnt lgkmcnt(5)
buffer_store_dwordx4 v[20:23], v1, s[44:47], s80 offen sc1
LcB1:
v_mfma_f32_16x16x32_bf16 v[128:131], v[64:67], v[32:35], v[128:131]
ds_read_b64_tr_b16 v[88:89], v11 offset:32768
v_accvgpr_read_b32 v24, a224
v_mfma_f32_16x16x32_bf16 v[128:131], v[68:71], v[36:39], v[128:131]
ds_read_b64_tr_b16 v[90:91], v11 offset:33792
v_accvgpr_read_b32 v28, a225
v_mfma_f32_16x16x32_bf16 v[132:135], v[68:71], v[44:47], v[132:135]
v_accvgpr_read_b32 v25, a226
v_accvgpr_read_b32 v29, a227
v_mfma_f32_16x16x32_bf16 v[132:135], v[64:67], v[40:43], v[132:135]
s_add_u32 s72, s70, 144384
buffer_load_dwordx4 v5, s[4:7], s72 offen offset:3072 lds
v_mfma_f32_16x16x32_bf16 v[136:139], v[64:67], v[48:51], v[136:139]
ds_read_b64_tr_b16 v[92:93], v11 offset:40960
v_accvgpr_read_b32 v26, a228
v_mfma_f32_16x16x32_bf16 v[136:139], v[68:71], v[52:55], v[136:139]
s_lshl_b32 s71, s73, 12
v_accvgpr_read_b32 v30, a229
v_accvgpr_read_b32 v27, a230
v_mfma_f32_16x16x32_bf16 v[140:143], v[68:71], v[60:63], v[140:143]
s_add_u32 s71, s71, s66
ds_read_b64_tr_b16 v[94:95], v11 offset:41984
v_accvgpr_read_b32 v31, a231
v_mfma_f32_16x16x32_bf16 v[140:143], v[64:67], v[56:59], v[140:143]
s_waitcnt lgkmcnt(8)
v_cvt_pk_bf16_f32 v24, v24, v28
v_cvt_pk_bf16_f32 v25, v25, v29
v_mfma_f32_16x16x32_bf16 v[156:159], v[72:75], v[56:59], v[156:159]
s_add_u32 m0, s64, 16384
ds_read_b64_tr_b16 v[64:65], v12 offset:32768
v_cvt_pk_bf16_f32 v26, v26, v30
v_mfma_f32_16x16x32_bf16 v[156:159], v[76:79], v[60:63], v[156:159]
s_add_u32 s72, s71, 0
buffer_load_dwordx4 v6, s[12:15], s72 offen lds
v_mfma_f32_16x16x32_bf16 v[152:155], v[76:79], v[52:55], v[152:155]
s_add_u32 s73, s62, 11
ds_read_b64_tr_b16 v[66:67], v12 offset:33792
v_cvt_pk_bf16_f32 v27, v27, v31
v_mfma_f32_16x16x32_bf16 v[152:155], v[72:75], v[48:51], v[152:155]
s_add_u32 s70, s73, s65
v_mfma_f32_16x16x32_bf16 v[148:151], v[72:75], v[40:43], v[148:151]
s_and_b32 s70, s70, 3
ds_read_b64_tr_b16 v[68:69], v12 offset:40960
v_mfma_f32_16x16x32_bf16 v[148:151], v[76:79], v[44:47], v[148:151]
s_and_b32 s73, s73, 12
ds_read_b64_tr_b16 v[70:71], v12 offset:41984
v_mfma_f32_16x16x32_bf16 v[144:147], v[76:79], v[36:39], v[144:147]
s_add_u32 s72, s71, 31744
buffer_load_dwordx4 v6, s[12:15], s72 offen offset:1024 lds
v_mfma_f32_16x16x32_bf16 v[144:147], v[72:75], v[32:35], v[144:147]
s_waitcnt lgkmcnt(8)
v_mfma_f32_16x16x32_bf16 v[160:163], v[80:83], v[32:35], v[160:163]
s_or_b32 s73, s73, s70
ds_read_b64_tr_b16 v[72:73], v13 offset:32768
v_mfma_f32_16x16x32_bf16 v[160:163], v[84:87], v[36:39], v[160:163]
s_lshl_b32 s73, s73, 7
ds_read_b64_tr_b16 v[74:75], v13 offset:33792
v_mfma_f32_16x16x32_bf16 v[164:167], v[84:87], v[44:47], v[164:167]
s_add_u32 s69, s73, s67
v_mfma_f32_16x16x32_bf16 v[164:167], v[80:83], v[40:43], v[164:167]
s_add_u32 s72, s71, 63488
buffer_load_dwordx4 v7, s[12:15], s72 offen offset:2048 lds
v_mfma_f32_16x16x32_bf16 v[168:171], v[80:83], v[48:51], v[168:171]
s_waitcnt vmcnt(18)
ds_read_b64_tr_b16 v[76:77], v13 offset:40960
v_mfma_f32_16x16x32_bf16 v[168:171], v[84:87], v[52:55], v[168:171]
s_add_u32 s70, s73, s68
ds_read_b128 v[96:99], v16 offset:0
v_accvgpr_read_b32 v20, a92
v_mfma_f32_16x16x32_bf16 v[172:175], v[84:87], v[60:63], v[172:175]
s_add_u32 s80, s78, 3072
ds_read_b64_tr_b16 v[78:79], v13 offset:41984
v_accvgpr_read_b32 v28, a93
v_mfma_f32_16x16x32_bf16 v[172:175], v[80:83], v[56:59], v[172:175]
s_waitcnt lgkmcnt(9)
ds_read_b128 v[100:103], v17 offset:0
v_accvgpr_read_b32 v21, a94
v_mfma_f32_16x16x32_bf16 v[188:191], v[88:91], v[56:59], v[188:191]
s_add_u32 s72, s71, 95232
buffer_load_dwordx4 v7, s[12:15], s72 offen offset:3072 lds
v_mfma_f32_16x16x32_bf16 v[188:191], v[92:95], v[60:63], v[188:191]
ds_read_b64_tr_b16 v[80:81], v14 offset:32768
v_accvgpr_read_b32 v29, a95
v_mfma_f32_16x16x32_bf16 v[184:187], v[92:95], v[52:55], v[184:187]
ds_read_b64_tr_b16 v[82:83], v14 offset:33792
v_accvgpr_read_b32 v22, a124
v_mfma_f32_16x16x32_bf16 v[184:187], v[88:91], v[48:51], v[184:187]
buffer_store_dwordx4 v[24:27], v1, s[44:47], s80 offen sc1
v_mfma_f32_16x16x32_bf16 v[180:183], v[88:91], v[40:43], v[180:183]
ds_read_b64_tr_b16 v[84:85], v14 offset:40960
v_accvgpr_read_b32 v30, a125
v_mfma_f32_16x16x32_bf16 v[180:183], v[92:95], v[44:47], v[180:183]
s_add_u32 m0, s63, 98304
ds_read_b64_tr_b16 v[86:87], v14 offset:41984
v_accvgpr_read_b32 v23, a126
v_mfma_f32_16x16x32_bf16 v[176:179], v[92:95], v[36:39], v[176:179]
s_add_u32 s72, s69, 0
buffer_load_dwordx4 v4, s[4:7], s72 offen lds
v_mfma_f32_16x16x32_bf16 v[176:179], v[88:91], v[32:35], v[176:179]
s_waitcnt lgkmcnt(10)
ds_read_b128 v[104:107], v16 offset:2048
v_accvgpr_read_b32 v31, a127
v_mfma_f32_16x16x32_bf16 v[192:195], v[64:67], v[32:35], v[192:195]
ds_read_b64_tr_b16 v[88:89], v15 offset:32768
v_mul_f32 v20, s79, v20
v_mfma_f32_16x16x32_bf16 v[192:195], v[68:71], v[36:39], v[192:195]
ds_read_b64_tr_b16 v[90:91], v15 offset:33792
v_mul_f32 v28, s79, v28
v_mfma_f32_16x16x32_bf16 v[196:199], v[68:71], v[44:47], v[196:199]
ds_read_b64_tr_b16 v[92:93], v15 offset:40960
v_mul_f32 v21, s79, v21
v_mfma_f32_16x16x32_bf16 v[196:199], v[64:67], v[40:43], v[196:199]
s_add_u32 s72, s69, 15360
buffer_load_dwordx4 v5, s[4:7], s72 offen offset:1024 lds
v_mfma_f32_16x16x32_bf16 v[200:203], v[64:67], v[48:51], v[200:203]
ds_read_b64_tr_b16 v[94:95], v15 offset:41984
v_mul_f32 v29, s79, v29
v_mfma_f32_16x16x32_bf16 v[200:203], v[68:71], v[52:55], v[200:203]
ds_read_b128 v[108:111], v17 offset:2048
v_mul_f32 v22, s79, v22
v_mfma_f32_16x16x32_bf16 v[204:207], v[68:71], v[60:63], v[204:207]
v_mul_f32 v30, s79, v30
v_mul_f32 v23, s79, v23
v_mfma_f32_16x16x32_bf16 v[204:207], v[64:67], v[56:59], v[204:207]
s_waitcnt lgkmcnt(11)
ds_read_b128 v[112:115], v16 offset:4096
v_mul_f32 v31, s79, v31
v_mfma_f32_16x16x32_bf16 v[220:223], v[72:75], v[56:59], v[220:223]
s_add_u32 s72, s69, 129024
buffer_load_dwordx4 v4, s[4:7], s72 offen offset:2048 lds
v_mfma_f32_16x16x32_bf16 v[220:223], v[76:79], v[60:63], v[220:223]
v_cvt_pk_bf16_f32 v20, v20, v28
v_cvt_pk_bf16_f32 v21, v21, v29
v_mfma_f32_16x16x32_bf16 v[216:219], v[76:79], v[52:55], v[216:219]
s_waitcnt vmcnt(19) lgkmcnt(2)
ds_read_b128 v[116:119], v17 offset:4096
v_cvt_pk_bf16_f32 v22, v22, v30
v_mfma_f32_16x16x32_bf16 v[216:219], v[72:75], v[48:51], v[216:219]
s_barrier
ds_read_b128 v[120:123], v16 offset:6144
v_cvt_pk_bf16_f32 v23, v23, v31
v_mfma_f32_16x16x32_bf16 v[212:215], v[72:75], v[40:43], v[212:215]
s_add_u32 s80, s77, 46080
ds_read_b64_tr_b16 v[64:65], v8 offset:0
ds_read_b64_tr_b16 v[66:67], v8 offset:1024
v_mfma_f32_16x16x32_bf16 v[212:215], v[76:79], v[44:47], v[212:215]
ds_read_b64_tr_b16 v[68:69], v8 offset:8192
v_accvgpr_read_b32 v24, a232
v_mfma_f32_16x16x32_bf16 v[208:211], v[76:79], v[36:39], v[208:211]
s_add_u32 s72, s69, 144384
buffer_load_dwordx4 v5, s[4:7], s72 offen offset:3072 lds
v_mfma_f32_16x16x32_bf16 v[208:211], v[72:75], v[32:35], v[208:211]
ds_read_b64_tr_b16 v[70:71], v8 offset:9216
v_accvgpr_read_b32 v28, a233
v_mfma_f32_16x16x32_bf16 v[224:227], v[80:83], v[32:35], v[224:227]
ds_read_b64_tr_b16 v[72:73], v9 offset:0
v_accvgpr_read_b32 v25, a234
v_mfma_f32_16x16x32_bf16 v[224:227], v[84:87], v[36:39], v[224:227]
ds_read_b64_tr_b16 v[74:75], v9 offset:1024
v_accvgpr_read_b32 v29, a235
v_mfma_f32_16x16x32_bf16 v[228:231], v[84:87], v[44:47], v[228:231]
s_add_u32 m0, s63, 102400
buffer_store_dwordx4 v[20:23], v1, s[44:47], s80 offen sc1
v_mfma_f32_16x16x32_bf16 v[228:231], v[80:83], v[40:43], v[228:231]
s_add_u32 s72, s70, 0
buffer_load_dwordx4 v4, s[4:7], s72 offen lds
v_mfma_f32_16x16x32_bf16 v[232:235], v[80:83], v[48:51], v[232:235]
ds_read_b64_tr_b16 v[76:77], v9 offset:8192
v_accvgpr_read_b32 v26, a236
v_mfma_f32_16x16x32_bf16 v[232:235], v[84:87], v[52:55], v[232:235]
ds_read_b128 v[124:127], v17 offset:6144
v_accvgpr_read_b32 v30, a237
v_mfma_f32_16x16x32_bf16 v[236:239], v[84:87], v[60:63], v[236:239]
ds_read_b64_tr_b16 v[78:79], v9 offset:9216
v_accvgpr_read_b32 v27, a238
v_mfma_f32_16x16x32_bf16 v[236:239], v[80:83], v[56:59], v[236:239]
v_accvgpr_read_b32 v31, a239
v_cvt_pk_bf16_f32 v24, v24, v28
v_mfma_f32_16x16x32_bf16 v[252:255], v[88:91], v[56:59], v[252:255]
s_add_u32 s72, s70, 15360
buffer_load_dwordx4 v5, s[4:7], s72 offen offset:1024 lds
v_mfma_f32_16x16x32_bf16 v[252:255], v[92:95], v[60:63], v[252:255]
ds_read_b64_tr_b16 v[80:81], v10 offset:0
v_cvt_pk_bf16_f32 v25, v25, v29
v_mfma_f32_16x16x32_bf16 v[248:251], v[92:95], v[52:55], v[248:251]
ds_read_b64_tr_b16 v[82:83], v10 offset:1024
v_cvt_pk_bf16_f32 v26, v26, v30
v_mfma_f32_16x16x32_bf16 v[248:251], v[88:91], v[48:51], v[248:251]
v_cvt_pk_bf16_f32 v27, v27, v31
v_mfma_f32_16x16x32_bf16 v[244:247], v[88:91], v[40:43], v[244:247]
s_add_u32 s80, s78, 11264
ds_read_b64_tr_b16 v[84:85], v10 offset:8192
v_mfma_f32_16x16x32_bf16 v[244:247], v[92:95], v[44:47], v[244:247]
ds_read_b64_tr_b16 v[86:87], v10 offset:9216
v_mfma_f32_16x16x32_bf16 v[240:243], v[92:95], v[36:39], v[240:243]
s_add_u32 s72, s70, 129024
buffer_load_dwordx4 v4, s[4:7], s72 offen offset:2048 lds
v_mfma_f32_16x16x32_bf16 v[240:243], v[88:91], v[32:35], v[240:243]
s_waitcnt lgkmcnt(5)
buffer_store_dwordx4 v[24:27], v1, s[44:47], s80 offen sc1
v_mfma_f32_16x16x32_bf16 v[128:131], v[64:67], v[96:99], v[128:131]
ds_read_b64_tr_b16 v[88:89], v11 offset:0
v_mfma_f32_16x16x32_bf16 v[128:131], v[68:71], v[100:103], v[128:131]
ds_read_b64_tr_b16 v[90:91], v11 offset:1024
v_accvgpr_read_b32 v20, a240
v_mfma_f32_16x16x32_bf16 v[132:135], v[68:71], v[108:111], v[132:135]
v_accvgpr_read_b32 v28, a241
v_accvgpr_read_b32 v21, a242
v_mfma_f32_16x16x32_bf16 v[132:135], v[64:67], v[104:107], v[132:135]
s_add_u32 s72, s70, 144384
buffer_load_dwordx4 v5, s[4:7], s72 offen offset:3072 lds
v_mfma_f32_16x16x32_bf16 v[136:139], v[64:67], v[112:115], v[136:139]
ds_read_b64_tr_b16 v[92:93], v11 offset:8192
v_accvgpr_read_b32 v29, a243
v_mfma_f32_16x16x32_bf16 v[136:139], v[68:71], v[116:119], v[136:139]
s_lshl_b32 s71, s73, 12
v_accvgpr_read_b32 v22, a244
v_accvgpr_read_b32 v30, a245
v_mfma_f32_16x16x32_bf16 v[140:143], v[68:71], v[124:127], v[140:143]
s_add_u32 s71, s71, s66
ds_read_b64_tr_b16 v[94:95], v11 offset:9216
v_accvgpr_read_b32 v23, a246
v_mfma_f32_16x16x32_bf16 v[140:143], v[64:67], v[120:123], v[140:143]
s_waitcnt lgkmcnt(8)
v_accvgpr_read_b32 v31, a247
v_cvt_pk_bf16_f32 v20, v20, v28
v_mfma_f32_16x16x32_bf16 v[156:159], v[72:75], v[120:123], v[156:159]
s_add_u32 m0, s64, 32768
ds_read_b64_tr_b16 v[64:65], v12 offset:0
v_cvt_pk_bf16_f32 v21, v21, v29
v_mfma_f32_16x16x32_bf16 v[156:159], v[76:79], v[124:127], v[156:159]
s_add_u32 s72, s71, 0
buffer_load_dwordx4 v6, s[12:15], s72 offen lds
v_mfma_f32_16x16x32_bf16 v[152:155], v[76:79], v[116:119], v[152:155]
s_add_u32 s73, s62, 12
ds_read_b64_tr_b16 v[66:67], v12 offset:1024
v_cvt_pk_bf16_f32 v22, v22, v30
v_mfma_f32_16x16x32_bf16 v[152:155], v[72:75], v[112:115], v[152:155]
s_add_u32 s70, s73, s65
v_cvt_pk_bf16_f32 v23, v23, v31
v_mfma_f32_16x16x32_bf16 v[148:151], v[72:75], v[104:107], v[148:151]
s_and_b32 s70, s70, 3
ds_read_b64_tr_b16 v[68:69], v12 offset:8192
v_mfma_f32_16x16x32_bf16 v[148:151], v[76:79], v[108:111], v[148:151]
s_and_b32 s73, s73, 12
ds_read_b64_tr_b16 v[70:71], v12 offset:9216
v_mfma_f32_16x16x32_bf16 v[144:147], v[76:79], v[100:103], v[144:147]
s_add_u32 s72, s71, 31744
buffer_load_dwordx4 v6, s[12:15], s72 offen offset:1024 lds
v_mfma_f32_16x16x32_bf16 v[144:147], v[72:75], v[96:99], v[144:147]
s_waitcnt lgkmcnt(8)
v_mfma_f32_16x16x32_bf16 v[160:163], v[80:83], v[96:99], v[160:163]
s_or_b32 s73, s73, s70
ds_read_b64_tr_b16 v[72:73], v13 offset:0
v_mfma_f32_16x16x32_bf16 v[160:163], v[84:87], v[100:103], v[160:163]
s_lshl_b32 s73, s73, 7
ds_read_b64_tr_b16 v[74:75], v13 offset:1024
v_mfma_f32_16x16x32_bf16 v[164:167], v[84:87], v[108:111], v[164:167]
s_add_u32 s69, s73, s67
v_mfma_f32_16x16x32_bf16 v[164:167], v[80:83], v[104:107], v[164:167]
s_add_u32 s72, s71, 63488
buffer_load_dwordx4 v7, s[12:15], s72 offen offset:2048 lds
v_mfma_f32_16x16x32_bf16 v[168:171], v[80:83], v[112:115], v[168:171]
s_waitcnt vmcnt(18)
ds_read_b64_tr_b16 v[76:77], v13 offset:8192
v_mfma_f32_16x16x32_bf16 v[168:171], v[84:87], v[116:119], v[168:171]
s_add_u32 s70, s73, s68
ds_read_b128 v[32:35], v18 offset:0
v_mfma_f32_16x16x32_bf16 v[172:175], v[84:87], v[124:127], v[172:175]
s_add_u32 s80, s78, 35840
ds_read_b64_tr_b16 v[78:79], v13 offset:9216
v_mfma_f32_16x16x32_bf16 v[172:175], v[80:83], v[120:123], v[172:175]
s_waitcnt lgkmcnt(9)
ds_read_b128 v[36:39], v19 offset:0
v_accvgpr_read_b32 v24, a248
v_mfma_f32_16x16x32_bf16 v[188:191], v[88:91], v[120:123], v[188:191]
s_add_u32 s72, s71, 95232
buffer_load_dwordx4 v7, s[12:15], s72 offen offset:3072 lds
v_mfma_f32_16x16x32_bf16 v[188:191], v[92:95], v[124:127], v[188:191]
ds_read_b64_tr_b16 v[80:81], v14 offset:0
v_accvgpr_read_b32 v28, a249
v_mfma_f32_16x16x32_bf16 v[184:187], v[92:95], v[116:119], v[184:187]
ds_read_b64_tr_b16 v[82:83], v14 offset:1024
v_accvgpr_read_b32 v25, a250
v_mfma_f32_16x16x32_bf16 v[184:187], v[88:91], v[112:115], v[184:187]
buffer_store_dwordx4 v[20:23], v1, s[44:47], s80 offen sc1
v_mfma_f32_16x16x32_bf16 v[180:183], v[88:91], v[104:107], v[180:183]
ds_read_b64_tr_b16 v[84:85], v14 offset:8192
v_accvgpr_read_b32 v29, a251
v_mfma_f32_16x16x32_bf16 v[180:183], v[92:95], v[108:111], v[180:183]
s_add_u32 m0, s63, 131072
ds_read_b64_tr_b16 v[86:87], v14 offset:9216
v_accvgpr_read_b32 v26, a252
v_mfma_f32_16x16x32_bf16 v[176:179], v[92:95], v[100:103], v[176:179]
s_add_u32 s72, s69, 0
buffer_load_dwordx4 v4, s[4:7], s72 offen lds
v_mfma_f32_16x16x32_bf16 v[176:179], v[88:91], v[96:99], v[176:179]
s_waitcnt lgkmcnt(10)
ds_read_b128 v[40:43], v18 offset:2048
v_accvgpr_read_b32 v30, a253
v_mfma_f32_16x16x32_bf16 v[192:195], v[64:67], v[96:99], v[192:195]
ds_read_b64_tr_b16 v[88:89], v15 offset:0
v_accvgpr_read_b32 v27, a254
v_mfma_f32_16x16x32_bf16 v[192:195], v[68:71], v[100:103], v[192:195]
ds_read_b64_tr_b16 v[90:91], v15 offset:1024
v_accvgpr_read_b32 v31, a255
v_mfma_f32_16x16x32_bf16 v[196:199], v[68:71], v[108:111], v[196:199]
ds_read_b64_tr_b16 v[92:93], v15 offset:8192
v_cvt_pk_bf16_f32 v24, v24, v28
v_mfma_f32_16x16x32_bf16 v[196:199], v[64:67], v[104:107], v[196:199]
s_add_u32 s72, s69, 15360
buffer_load_dwordx4 v5, s[4:7], s72 offen offset:1024 lds
v_mfma_f32_16x16x32_bf16 v[200:203], v[64:67], v[112:115], v[200:203]
ds_read_b64_tr_b16 v[94:95], v15 offset:9216
v_cvt_pk_bf16_f32 v25, v25, v29
v_mfma_f32_16x16x32_bf16 v[200:203], v[68:71], v[116:119], v[200:203]
ds_read_b128 v[44:47], v19 offset:2048
v_cvt_pk_bf16_f32 v26, v26, v30
v_mfma_f32_16x16x32_bf16 v[204:207], v[68:71], v[124:127], v[204:207]
v_cvt_pk_bf16_f32 v27, v27, v31
v_mfma_f32_16x16x32_bf16 v[204:207], v[64:67], v[120:123], v[204:207]
s_waitcnt lgkmcnt(11)
ds_read_b128 v[48:51], v18 offset:4096
v_mfma_f32_16x16x32_bf16 v[220:223], v[72:75], v[120:123], v[220:223]
s_add_u32 s72, s69, 129024
buffer_load_dwordx4 v4, s[4:7], s72 offen offset:2048 lds
v_mfma_f32_16x16x32_bf16 v[220:223], v[76:79], v[124:127], v[220:223]
s_add_u32 s80, s78, 44032
ds_read_b128 v[52:55], v19 offset:4096
v_mfma_f32_16x16x32_bf16 v[216:219], v[76:79], v[116:119], v[216:219]
s_waitcnt vmcnt(19) lgkmcnt(3)
buffer_store_dwordx4 v[24:27], v1, s[44:47], s80 offen sc1
v_mfma_f32_16x16x32_bf16 v[216:219], v[72:75], v[112:115], v[216:219]
s_barrier
ds_read_b128 v[56:59], v18 offset:6144
v_mfma_f32_16x16x32_bf16 v[212:215], v[72:75], v[104:107], v[212:215]
ds_read_b64_tr_b16 v[64:65], v8 offset:16384
ds_read_b64_tr_b16 v[66:67], v8 offset:17408
v_mfma_f32_16x16x32_bf16 v[212:215], v[76:79], v[108:111], v[212:215]
ds_read_b64_tr_b16 v[68:69], v8 offset:24576
ds_read_b64_tr_b16 v[70:71], v8 offset:25600
v_mfma_f32_16x16x32_bf16 v[208:211], v[76:79], v[100:103], v[208:211]
s_add_u32 s72, s69, 144384
buffer_load_dwordx4 v5, s[4:7], s72 offen offset:3072 lds
v_mfma_f32_16x16x32_bf16 v[208:211], v[72:75], v[96:99], v[208:211]
v_and_b32 v2, 31, v0
v_lshlrev_b32 v2, 2, v2
v_mfma_f32_16x16x32_bf16 v[224:227], v[80:83], v[96:99], v[224:227]
buffer_load_dword v3, v2, s[48:51], 0 offen sc1
v_mfma_f32_16x16x32_bf16 v[224:227], v[84:87], v[100:103], v[224:227]
ds_read_b64_tr_b16 v[72:73], v9 offset:16384
v_mfma_f32_16x16x32_bf16 v[228:231], v[84:87], v[108:111], v[228:231]
s_add_u32 m0, s63, 135168
ds_read_b64_tr_b16 v[74:75], v9 offset:17408
v_mfma_f32_16x16x32_bf16 v[228:231], v[80:83], v[104:107], v[228:231]
s_add_u32 s72, s70, 0
buffer_load_dwordx4 v4, s[4:7], s72 offen lds
v_mfma_f32_16x16x32_bf16 v[232:235], v[80:83], v[112:115], v[232:235]
ds_read_b128 v[60:63], v19 offset:6144
v_mfma_f32_16x16x32_bf16 v[232:235], v[84:87], v[116:119], v[232:235]
ds_read_b64_tr_b16 v[76:77], v9 offset:24576
v_mfma_f32_16x16x32_bf16 v[236:239], v[84:87], v[124:127], v[236:239]
ds_read_b64_tr_b16 v[78:79], v9 offset:25600
v_mfma_f32_16x16x32_bf16 v[236:239], v[80:83], v[120:123], v[236:239]
v_mfma_f32_16x16x32_bf16 v[252:255], v[88:91], v[120:123], v[252:255]
s_add_u32 s72, s70, 15360
buffer_load_dwordx4 v5, s[4:7], s72 offen offset:1024 lds
v_mfma_f32_16x16x32_bf16 v[252:255], v[92:95], v[124:127], v[252:255]
ds_read_b64_tr_b16 v[80:81], v10 offset:16384
v_mfma_f32_16x16x32_bf16 v[248:251], v[92:95], v[116:119], v[248:251]
ds_read_b64_tr_b16 v[82:83], v10 offset:17408
v_mfma_f32_16x16x32_bf16 v[248:251], v[88:91], v[112:115], v[248:251]
v_mfma_f32_16x16x32_bf16 v[244:247], v[88:91], v[104:107], v[244:247]
ds_read_b64_tr_b16 v[84:85], v10 offset:24576
v_mfma_f32_16x16x32_bf16 v[244:247], v[92:95], v[108:111], v[244:247]
ds_read_b64_tr_b16 v[86:87], v10 offset:25600
v_mfma_f32_16x16x32_bf16 v[240:243], v[92:95], v[100:103], v[240:243]
s_add_u32 s72, s70, 129024
buffer_load_dwordx4 v4, s[4:7], s72 offen offset:2048 lds
v_mfma_f32_16x16x32_bf16 v[240:243], v[88:91], v[96:99], v[240:243]
s_waitcnt lgkmcnt(6)
v_mfma_f32_16x16x32_bf16 v[128:131], v[64:67], v[32:35], v[128:131]
ds_read_b64_tr_b16 v[88:89], v11 offset:16384
v_mfma_f32_16x16x32_bf16 v[128:131], v[68:71], v[36:39], v[128:131]
ds_read_b64_tr_b16 v[90:91], v11 offset:17408
v_mfma_f32_16x16x32_bf16 v[132:135], v[68:71], v[44:47], v[132:135]
v_mfma_f32_16x16x32_bf16 v[132:135], v[64:67], v[40:43], v[132:135]
s_add_u32 s72, s70, 144384
buffer_load_dwordx4 v5, s[4:7], s72 offen offset:3072 lds
v_mfma_f32_16x16x32_bf16 v[136:139], v[64:67], v[48:51], v[136:139]
ds_read_b64_tr_b16 v[92:93], v11 offset:24576
v_mfma_f32_16x16x32_bf16 v[136:139], v[68:71], v[52:55], v[136:139]
s_lshl_b32 s71, s73, 12
v_mfma_f32_16x16x32_bf16 v[140:143], v[68:71], v[60:63], v[140:143]
s_add_u32 s71, s71, s66
ds_read_b64_tr_b16 v[94:95], v11 offset:25600
v_mfma_f32_16x16x32_bf16 v[140:143], v[64:67], v[56:59], v[140:143]
s_waitcnt lgkmcnt(8)
v_mfma_f32_16x16x32_bf16 v[156:159], v[72:75], v[56:59], v[156:159]
s_add_u32 m0, s64, 0
ds_read_b64_tr_b16 v[64:65], v12 offset:16384
v_mfma_f32_16x16x32_bf16 v[156:159], v[76:79], v[60:63], v[156:159]
s_add_u32 s72, s71, 0
buffer_load_dwordx4 v6, s[12:15], s72 offen lds
v_mfma_f32_16x16x32_bf16 v[152:155], v[76:79], v[52:55], v[152:155]
s_add_u32 s73, s62, 13
ds_read_b64_tr_b16 v[66:67], v12 offset:17408
v_mfma_f32_16x16x32_bf16 v[152:155], v[72:75], v[48:51], v[152:155]
s_add_u32 s70, s73, s65
v_mfma_f32_16x16x32_bf16 v[148:151], v[72:75], v[40:43], v[148:151]
s_and_b32 s70, s70, 3
ds_read_b64_tr_b16 v[68:69], v12 offset:24576
v_mfma_f32_16x16x32_bf16 v[148:151], v[76:79], v[44:47], v[148:151]
s_and_b32 s73, s73, 12
ds_read_b64_tr_b16 v[70:71], v12 offset:25600
v_mfma_f32_16x16x32_bf16 v[144:147], v[76:79], v[36:39], v[144:147]
s_add_u32 s72, s71, 31744
buffer_load_dwordx4 v6, s[12:15], s72 offen offset:1024 lds
v_mfma_f32_16x16x32_bf16 v[144:147], v[72:75], v[32:35], v[144:147]
s_waitcnt lgkmcnt(8)
v_mfma_f32_16x16x32_bf16 v[160:163], v[80:83], v[32:35], v[160:163]
s_or_b32 s73, s73, s70
ds_read_b64_tr_b16 v[72:73], v13 offset:16384
v_mfma_f32_16x16x32_bf16 v[160:163], v[84:87], v[36:39], v[160:163]
s_lshl_b32 s73, s73, 7
ds_read_b64_tr_b16 v[74:75], v13 offset:17408
v_mfma_f32_16x16x32_bf16 v[164:167], v[84:87], v[44:47], v[164:167]
s_add_u32 s69, s73, s67
v_mfma_f32_16x16x32_bf16 v[164:167], v[80:83], v[40:43], v[164:167]
s_add_u32 s72, s71, 63488
buffer_load_dwordx4 v7, s[12:15], s72 offen offset:2048 lds
v_mfma_f32_16x16x32_bf16 v[168:171], v[80:83], v[48:51], v[168:171]
s_waitcnt vmcnt(18)
ds_read_b64_tr_b16 v[76:77], v13 offset:24576
v_mfma_f32_16x16x32_bf16 v[168:171], v[84:87], v[52:55], v[168:171]
s_add_u32 s70, s73, s68
ds_read_b128 v[96:99], v18 offset:32768
v_mfma_f32_16x16x32_bf16 v[172:175], v[84:87], v[60:63], v[172:175]
ds_read_b64_tr_b16 v[78:79], v13 offset:25600
v_mfma_f32_16x16x32_bf16 v[172:175], v[80:83], v[56:59], v[172:175]
s_waitcnt lgkmcnt(9)
ds_read_b128 v[100:103], v19 offset:32768
v_mfma_f32_16x16x32_bf16 v[188:191], v[88:91], v[56:59], v[188:191]
s_add_u32 s72, s71, 95232
buffer_load_dwordx4 v7, s[12:15], s72 offen offset:3072 lds
v_mfma_f32_16x16x32_bf16 v[188:191], v[92:95], v[60:63], v[188:191]
ds_read_b64_tr_b16 v[80:81], v14 offset:16384
v_mfma_f32_16x16x32_bf16 v[184:187], v[92:95], v[52:55], v[184:187]
ds_read_b64_tr_b16 v[82:83], v14 offset:17408
v_mfma_f32_16x16x32_bf16 v[184:187], v[88:91], v[48:51], v[184:187]
v_mfma_f32_16x16x32_bf16 v[180:183], v[88:91], v[40:43], v[180:183]
ds_read_b64_tr_b16 v[84:85], v14 offset:24576
v_mfma_f32_16x16x32_bf16 v[180:183], v[92:95], v[44:47], v[180:183]
s_add_u32 m0, s63, 65536
ds_read_b64_tr_b16 v[86:87], v14 offset:25600
v_mfma_f32_16x16x32_bf16 v[176:179], v[92:95], v[36:39], v[176:179]
s_add_u32 s72, s69, 0
buffer_load_dwordx4 v4, s[4:7], s72 offen lds
v_mfma_f32_16x16x32_bf16 v[176:179], v[88:91], v[32:35], v[176:179]
s_waitcnt lgkmcnt(10)
ds_read_b128 v[104:107], v18 offset:34816
v_mfma_f32_16x16x32_bf16 v[192:195], v[64:67], v[32:35], v[192:195]
ds_read_b64_tr_b16 v[88:89], v15 offset:16384
v_mfma_f32_16x16x32_bf16 v[192:195], v[68:71], v[36:39], v[192:195]
ds_read_b64_tr_b16 v[90:91], v15 offset:17408
v_mfma_f32_16x16x32_bf16 v[196:199], v[68:71], v[44:47], v[196:199]
ds_read_b64_tr_b16 v[92:93], v15 offset:24576
v_mfma_f32_16x16x32_bf16 v[196:199], v[64:67], v[40:43], v[196:199]
s_add_u32 s72, s69, 15360
buffer_load_dwordx4 v5, s[4:7], s72 offen offset:1024 lds
v_mfma_f32_16x16x32_bf16 v[200:203], v[64:67], v[48:51], v[200:203]
ds_read_b64_tr_b16 v[94:95], v15 offset:25600
v_mfma_f32_16x16x32_bf16 v[200:203], v[68:71], v[52:55], v[200:203]
ds_read_b128 v[108:111], v19 offset:34816
v_mfma_f32_16x16x32_bf16 v[204:207], v[68:71], v[60:63], v[204:207]
v_mfma_f32_16x16x32_bf16 v[204:207], v[64:67], v[56:59], v[204:207]
s_waitcnt lgkmcnt(11)
ds_read_b128 v[112:115], v18 offset:36864
v_mfma_f32_16x16x32_bf16 v[220:223], v[72:75], v[56:59], v[220:223]
s_add_u32 s72, s69, 129024
buffer_load_dwordx4 v4, s[4:7], s72 offen offset:2048 lds
v_mfma_f32_16x16x32_bf16 v[220:223], v[76:79], v[60:63], v[220:223]
v_mfma_f32_16x16x32_bf16 v[216:219], v[76:79], v[52:55], v[216:219]
s_waitcnt vmcnt(13) lgkmcnt(2)
ds_read_b128 v[116:119], v19 offset:36864
v_mfma_f32_16x16x32_bf16 v[216:219], v[72:75], v[48:51], v[216:219]
s_barrier
ds_read_b128 v[120:123], v18 offset:38912
v_mfma_f32_16x16x32_bf16 v[212:215], v[72:75], v[40:43], v[212:215]
ds_read_b64_tr_b16 v[64:65], v8 offset:32768
ds_read_b64_tr_b16 v[66:67], v8 offset:33792
v_mfma_f32_16x16x32_bf16 v[212:215], v[76:79], v[44:47], v[212:215]
ds_read_b64_tr_b16 v[68:69], v8 offset:40960
v_or_b32 v20, s58, v0
v_mfma_f32_16x16x32_bf16 v[208:211], v[76:79], v[36:39], v[208:211]
s_add_u32 s72, s69, 144384
buffer_load_dwordx4 v5, s[4:7], s72 offen offset:3072 lds
v_mfma_f32_16x16x32_bf16 v[208:211], v[72:75], v[32:35], v[208:211]
ds_read_b64_tr_b16 v[70:71], v8 offset:41984
v_mov_b32 v21, 1
v_mfma_f32_16x16x32_bf16 v[224:227], v[80:83], v[32:35], v[224:227]
ds_read_b64_tr_b16 v[72:73], v9 offset:32768
v_min_u32 v20, 1, v20
v_mfma_f32_16x16x32_bf16 v[224:227], v[84:87], v[36:39], v[224:227]
ds_read_b64_tr_b16 v[74:75], v9 offset:33792
v_lshlrev_b32 v20, 30, v20
v_mfma_f32_16x16x32_bf16 v[228:231], v[84:87], v[44:47], v[228:231]
s_add_u32 m0, s63, 69632
buffer_store_dword v21, v20, s[44:47], s91 offen sc1
v_mfma_f32_16x16x32_bf16 v[228:231], v[80:83], v[40:43], v[228:231]
s_add_u32 s72, s70, 0
buffer_load_dwordx4 v4, s[4:7], s72 offen lds
v_mfma_f32_16x16x32_bf16 v[232:235], v[80:83], v[48:51], v[232:235]
ds_read_b64_tr_b16 v[76:77], v9 offset:40960
v_accvgpr_write_b32 a32, 0
v_mfma_f32_16x16x32_bf16 v[232:235], v[84:87], v[52:55], v[232:235]
ds_read_b128 v[124:127], v19 offset:38912
v_accvgpr_write_b32 a33, 0
v_mfma_f32_16x16x32_bf16 v[236:239], v[84:87], v[60:63], v[236:239]
ds_read_b64_tr_b16 v[78:79], v9 offset:41984
v_accvgpr_write_b32 a34, 0
v_mfma_f32_16x16x32_bf16 v[236:239], v[80:83], v[56:59], v[236:239]
v_accvgpr_write_b32 a35, 0
v_accvgpr_write_b32 a36, 0
v_mfma_f32_16x16x32_bf16 v[252:255], v[88:91], v[56:59], v[252:255]
s_add_u32 s72, s70, 15360
buffer_load_dwordx4 v5, s[4:7], s72 offen offset:1024 lds
v_mfma_f32_16x16x32_bf16 v[252:255], v[92:95], v[60:63], v[252:255]
ds_read_b64_tr_b16 v[80:81], v10 offset:32768
v_accvgpr_write_b32 a37, 0
v_mfma_f32_16x16x32_bf16 v[248:251], v[92:95], v[52:55], v[248:251]
ds_read_b64_tr_b16 v[82:83], v10 offset:33792
v_accvgpr_write_b32 a38, 0
v_mfma_f32_16x16x32_bf16 v[248:251], v[88:91], v[48:51], v[248:251]
v_accvgpr_write_b32 a39, 0
v_accvgpr_write_b32 a40, 0
v_mfma_f32_16x16x32_bf16 v[244:247], v[88:91], v[40:43], v[244:247]
ds_read_b64_tr_b16 v[84:85], v10 offset:40960
v_accvgpr_write_b32 a41, 0
v_mfma_f32_16x16x32_bf16 v[244:247], v[92:95], v[44:47], v[244:247]
ds_read_b64_tr_b16 v[86:87], v10 offset:41984
v_accvgpr_write_b32 a42, 0
v_mfma_f32_16x16x32_bf16 v[240:243], v[92:95], v[36:39], v[240:243]
s_add_u32 s72, s70, 129024
buffer_load_dwordx4 v4, s[4:7], s72 offen offset:2048 lds
v_mfma_f32_16x16x32_bf16 v[240:243], v[88:91], v[32:35], v[240:243]
s_waitcnt lgkmcnt(5)
v_accvgpr_write_b32 a43, 0
v_accvgpr_write_b32 a44, 0
v_mfma_f32_16x16x32_bf16 v[128:131], v[64:67], v[96:99], v[128:131]
ds_read_b64_tr_b16 v[88:89], v11 offset:32768
v_accvgpr_write_b32 a45, 0
v_mfma_f32_16x16x32_bf16 v[128:131], v[68:71], v[100:103], v[128:131]
ds_read_b64_tr_b16 v[90:91], v11 offset:33792
v_accvgpr_write_b32 a46, 0
v_mfma_f32_16x16x32_bf16 v[132:135], v[68:71], v[108:111], v[132:135]
v_accvgpr_write_b32 a47, 0
v_accvgpr_write_b32 a48, 0
v_mfma_f32_16x16x32_bf16 v[132:135], v[64:67], v[104:107], v[132:135]
s_add_u32 s72, s70, 144384
buffer_load_dwordx4 v5, s[4:7], s72 offen offset:3072 lds
v_mfma_f32_16x16x32_bf16 v[136:139], v[64:67], v[112:115], v[136:139]
ds_read_b64_tr_b16 v[92:93], v11 offset:40960
v_accvgpr_write_b32 a49, 0
v_mfma_f32_16x16x32_bf16 v[136:139], v[68:71], v[116:119], v[136:139]
s_lshl_b32 s71, s73, 12
v_accvgpr_write_b32 a50, 0
v_accvgpr_write_b32 a51, 0
v_mfma_f32_16x16x32_bf16 v[140:143], v[68:71], v[124:127], v[140:143]
s_add_u32 s71, s71, s66
ds_read_b64_tr_b16 v[94:95], v11 offset:41984
v_accvgpr_write_b32 a52, 0
v_mfma_f32_16x16x32_bf16 v[140:143], v[64:67], v[120:123], v[140:143]
s_waitcnt lgkmcnt(8)
v_accvgpr_write_b32 a53, 0
v_accvgpr_write_b32 a54, 0
v_mfma_f32_16x16x32_bf16 v[156:159], v[72:75], v[120:123], v[156:159]
s_add_u32 m0, s64, 16384
ds_read_b64_tr_b16 v[64:65], v12 offset:32768
v_accvgpr_write_b32 a55, 0
v_mfma_f32_16x16x32_bf16 v[156:159], v[76:79], v[124:127], v[156:159]
s_add_u32 s72, s71, 0
buffer_load_dwordx4 v6, s[12:15], s72 offen lds
v_mfma_f32_16x16x32_bf16 v[152:155], v[76:79], v[116:119], v[152:155]
s_add_u32 s73, s62, 14
ds_read_b64_tr_b16 v[66:67], v12 offset:33792
v_accvgpr_write_b32 a56, 0
v_mfma_f32_16x16x32_bf16 v[152:155], v[72:75], v[112:115], v[152:155]
s_add_u32 s70, s73, s65
v_accvgpr_write_b32 a57, 0
v_accvgpr_write_b32 a58, 0
v_mfma_f32_16x16x32_bf16 v[148:151], v[72:75], v[104:107], v[148:151]
s_and_b32 s70, s70, 3
ds_read_b64_tr_b16 v[68:69], v12 offset:40960
v_accvgpr_write_b32 a59, 0
v_mfma_f32_16x16x32_bf16 v[148:151], v[76:79], v[108:111], v[148:151]
s_and_b32 s73, s73, 12
ds_read_b64_tr_b16 v[70:71], v12 offset:41984
v_accvgpr_write_b32 a60, 0
v_mfma_f32_16x16x32_bf16 v[144:147], v[76:79], v[100:103], v[144:147]
s_add_u32 s72, s71, 31744
buffer_load_dwordx4 v6, s[12:15], s72 offen offset:1024 lds
v_mfma_f32_16x16x32_bf16 v[144:147], v[72:75], v[96:99], v[144:147]
s_waitcnt lgkmcnt(8)
v_accvgpr_write_b32 a61, 0
v_accvgpr_write_b32 a62, 0
v_mfma_f32_16x16x32_bf16 v[160:163], v[80:83], v[96:99], v[160:163]
s_or_b32 s73, s73, s70
ds_read_b64_tr_b16 v[72:73], v13 offset:32768
v_accvgpr_write_b32 a63, 0
v_mfma_f32_16x16x32_bf16 v[160:163], v[84:87], v[100:103], v[160:163]
s_lshl_b32 s73, s73, 7
ds_read_b64_tr_b16 v[74:75], v13 offset:33792
v_accvgpr_write_b32 a96, 0
v_mfma_f32_16x16x32_bf16 v[164:167], v[84:87], v[108:111], v[164:167]
s_add_u32 s69, s73, s67
v_accvgpr_write_b32 a97, 0
v_accvgpr_write_b32 a98, 0
v_mfma_f32_16x16x32_bf16 v[164:167], v[80:83], v[104:107], v[164:167]
s_add_u32 s72, s71, 63488
buffer_load_dwordx4 v7, s[12:15], s72 offen offset:2048 lds
v_mfma_f32_16x16x32_bf16 v[168:171], v[80:83], v[112:115], v[168:171]
s_waitcnt vmcnt(16)
ds_read_b64_tr_b16 v[76:77], v13 offset:40960
v_accvgpr_write_b32 a99, 0
v_mfma_f32_16x16x32_bf16 v[168:171], v[84:87], v[116:119], v[168:171]
s_add_u32 s70, s73, s68
ds_read_b128 v[32:35], v16 offset:0
v_accvgpr_write_b32 a100, 0
v_mfma_f32_16x16x32_bf16 v[172:175], v[84:87], v[124:127], v[172:175]
ds_read_b64_tr_b16 v[78:79], v13 offset:41984
v_accvgpr_write_b32 a101, 0
v_mfma_f32_16x16x32_bf16 v[172:175], v[80:83], v[120:123], v[172:175]
s_waitcnt lgkmcnt(9)
ds_read_b128 v[36:39], v17 offset:0
v_accvgpr_write_b32 a102, 0
v_mfma_f32_16x16x32_bf16 v[188:191], v[88:91], v[120:123], v[188:191]
s_add_u32 s72, s71, 95232
buffer_load_dwordx4 v7, s[12:15], s72 offen offset:3072 lds
v_mfma_f32_16x16x32_bf16 v[188:191], v[92:95], v[124:127], v[188:191]
ds_read_b64_tr_b16 v[80:81], v14 offset:32768
v_accvgpr_write_b32 a103, 0
v_mfma_f32_16x16x32_bf16 v[184:187], v[92:95], v[116:119], v[184:187]
ds_read_b64_tr_b16 v[82:83], v14 offset:33792
v_accvgpr_write_b32 a104, 0
v_mfma_f32_16x16x32_bf16 v[184:187], v[88:91], v[112:115], v[184:187]
v_accvgpr_write_b32 a105, 0
v_accvgpr_write_b32 a106, 0
v_mfma_f32_16x16x32_bf16 v[180:183], v[88:91], v[104:107], v[180:183]
ds_read_b64_tr_b16 v[84:85], v14 offset:40960
v_accvgpr_write_b32 a107, 0
v_mfma_f32_16x16x32_bf16 v[180:183], v[92:95], v[108:111], v[180:183]
s_add_u32 m0, s63, 98304
ds_read_b64_tr_b16 v[86:87], v14 offset:41984
v_accvgpr_write_b32 a108, 0
v_mfma_f32_16x16x32_bf16 v[176:179], v[92:95], v[100:103], v[176:179]
s_add_u32 s72, s69, 0
buffer_load_dwordx4 v4, s[4:7], s72 offen lds
v_mfma_f32_16x16x32_bf16 v[176:179], v[88:91], v[96:99], v[176:179]
s_waitcnt lgkmcnt(10)
ds_read_b128 v[40:43], v16 offset:2048
v_accvgpr_write_b32 a109, 0
v_mfma_f32_16x16x32_bf16 v[192:195], v[64:67], v[96:99], v[192:195]
ds_read_b64_tr_b16 v[88:89], v15 offset:32768
v_accvgpr_write_b32 a110, 0
v_mfma_f32_16x16x32_bf16 v[192:195], v[68:71], v[100:103], v[192:195]
ds_read_b64_tr_b16 v[90:91], v15 offset:33792
v_accvgpr_write_b32 a111, 0
v_mfma_f32_16x16x32_bf16 v[196:199], v[68:71], v[108:111], v[196:199]
ds_read_b64_tr_b16 v[92:93], v15 offset:40960
v_accvgpr_write_b32 a112, 0
v_mfma_f32_16x16x32_bf16 v[196:199], v[64:67], v[104:107], v[196:199]
s_add_u32 s72, s69, 15360
buffer_load_dwordx4 v5, s[4:7], s72 offen offset:1024 lds
v_mfma_f32_16x16x32_bf16 v[200:203], v[64:67], v[112:115], v[200:203]
ds_read_b64_tr_b16 v[94:95], v15 offset:41984
v_accvgpr_write_b32 a113, 0
v_mfma_f32_16x16x32_bf16 v[200:203], v[68:71], v[116:119], v[200:203]
ds_read_b128 v[44:47], v17 offset:2048
v_accvgpr_write_b32 a114, 0
v_mfma_f32_16x16x32_bf16 v[204:207], v[68:71], v[124:127], v[204:207]
v_accvgpr_write_b32 a115, 0
v_accvgpr_write_b32 a116, 0
v_mfma_f32_16x16x32_bf16 v[204:207], v[64:67], v[120:123], v[204:207]
s_waitcnt lgkmcnt(11)
ds_read_b128 v[48:51], v16 offset:4096
v_accvgpr_write_b32 a117, 0
v_mfma_f32_16x16x32_bf16 v[220:223], v[72:75], v[120:123], v[220:223]
s_add_u32 s72, s69, 129024
buffer_load_dwordx4 v4, s[4:7], s72 offen offset:2048 lds
v_mfma_f32_16x16x32_bf16 v[220:223], v[76:79], v[124:127], v[220:223]
v_accvgpr_write_b32 a118, 0
v_accvgpr_write_b32 a119, 0
v_mfma_f32_16x16x32_bf16 v[216:219], v[76:79], v[116:119], v[216:219]
s_waitcnt vmcnt(16) lgkmcnt(2)
ds_read_b128 v[52:55], v17 offset:4096
v_accvgpr_write_b32 a120, 0
v_mfma_f32_16x16x32_bf16 v[216:219], v[72:75], v[112:115], v[216:219]
s_barrier
ds_read_b128 v[56:59], v16 offset:6144
v_accvgpr_write_b32 a121, 0
v_mfma_f32_16x16x32_bf16 v[212:215], v[72:75], v[104:107], v[212:215]
s_waitcnt vmcnt(24)
v_cmp_gt_u32 vcc, 8, v3
s_cbranch_vccnz Lspin1
Lback2:
v_mfma_f32_16x16x32_bf16 v[212:215], v[76:79], v[108:111], v[212:215]
ds_read_b64_tr_b16 v[64:65], v8 offset:0
ds_read_b64_tr_b16 v[66:67], v8 offset:1024
v_mfma_f32_16x16x32_bf16 v[208:211], v[76:79], v[100:103], v[208:211]
s_add_u32 s72, s69, 144384
buffer_load_dwordx4 v5, s[4:7], s72 offen offset:3072 lds
v_mfma_f32_16x16x32_bf16 v[208:211], v[72:75], v[96:99], v[208:211]
ds_read_b64_tr_b16 v[68:69], v8 offset:8192
ds_read_b64_tr_b16 v[70:71], v8 offset:9216
v_mfma_f32_16x16x32_bf16 v[224:227], v[80:83], v[96:99], v[224:227]
ds_read_b64_tr_b16 v[72:73], v9 offset:0
v_accvgpr_write_b32 a122, 0
v_mfma_f32_16x16x32_bf16 v[224:227], v[84:87], v[100:103], v[224:227]
ds_read_b64_tr_b16 v[74:75], v9 offset:1024
v_accvgpr_write_b32 a123, 0
v_mfma_f32_16x16x32_bf16 v[228:231], v[84:87], v[108:111], v[228:231]
s_add_u32 m0, s63, 102400
v_accvgpr_write_b32 a124, 0
v_accvgpr_write_b32 a125, 0
v_mfma_f32_16x16x32_bf16 v[228:231], v[80:83], v[104:107], v[228:231]
s_add_u32 s72, s70, 0
buffer_load_dwordx4 v4, s[4:7], s72 offen lds
v_mfma_f32_16x16x32_bf16 v[232:235], v[80:83], v[112:115], v[232:235]
ds_read_b64_tr_b16 v[76:77], v9 offset:8192
v_accvgpr_write_b32 a126, 0
v_mfma_f32_16x16x32_bf16 v[232:235], v[84:87], v[116:119], v[232:235]
ds_read_b128 v[60:63], v17 offset:6144
v_accvgpr_write_b32 a127, 0
v_mfma_f32_16x16x32_bf16 v[236:239], v[84:87], v[124:127], v[236:239]
ds_read_b64_tr_b16 v[78:79], v9 offset:9216
v_mfma_f32_16x16x32_bf16 v[236:239], v[80:83], v[120:123], v[236:239]
v_mfma_f32_16x16x32_bf16 v[252:255], v[88:91], v[120:123], v[252:255]
s_add_u32 s72, s70, 15360
buffer_load_dwordx4 v5, s[4:7], s72 offen offset:1024 lds
v_mfma_f32_16x16x32_bf16 v[252:255], v[92:95], v[124:127], v[252:255]
ds_read_b64_tr_b16 v[80:81], v10 offset:0
v_mfma_f32_16x16x32_bf16 v[248:251], v[92:95], v[116:119], v[248:251]
ds_read_b64_tr_b16 v[82:83], v10 offset:1024
v_mfma_f32_16x16x32_bf16 v[248:251], v[88:91], v[112:115], v[248:251]
v_mfma_f32_16x16x32_bf16 v[244:247], v[88:91], v[104:107], v[244:247]
ds_read_b64_tr_b16 v[84:85], v10 offset:8192
v_mfma_f32_16x16x32_bf16 v[244:247], v[92:95], v[108:111], v[244:247]
ds_read_b64_tr_b16 v[86:87], v10 offset:9216
v_mfma_f32_16x16x32_bf16 v[240:243], v[92:95], v[100:103], v[240:243]
s_add_u32 s72, s70, 129024
buffer_load_dwordx4 v4, s[4:7], s72 offen offset:2048 lds
v_mfma_f32_16x16x32_bf16 v[240:243], v[88:91], v[96:99], v[240:243]
s_waitcnt lgkmcnt(5)
v_mfma_f32_16x16x32_bf16 v[128:131], v[64:67], v[32:35], v[128:131]
ds_read_b64_tr_b16 v[88:89], v11 offset:0
v_mfma_f32_16x16x32_bf16 v[128:131], v[68:71], v[36:39], v[128:131]
ds_read_b64_tr_b16 v[90:91], v11 offset:1024
v_mfma_f32_16x16x32_bf16 v[132:135], v[68:71], v[44:47], v[132:135]
v_mfma_f32_16x16x32_bf16 v[132:135], v[64:67], v[40:43], v[132:135]
s_add_u32 s72, s70, 144384
buffer_load_dwordx4 v5, s[4:7], s72 offen offset:3072 lds
v_mfma_f32_16x16x32_bf16 v[136:139], v[64:67], v[48:51], v[136:139]
ds_read_b64_tr_b16 v[92:93], v11 offset:8192
v_mfma_f32_16x16x32_bf16 v[136:139], v[68:71], v[52:55], v[136:139]
s_lshl_b32 s71, s73, 12
v_mfma_f32_16x16x32_bf16 v[140:143], v[68:71], v[60:63], v[140:143]
s_add_u32 s71, s71, s66
ds_read_b64_tr_b16 v[94:95], v11 offset:9216
v_mfma_f32_16x16x32_bf16 v[140:143], v[64:67], v[56:59], v[140:143]
s_waitcnt lgkmcnt(8)
v_mfma_f32_16x16x32_bf16 v[156:159], v[72:75], v[56:59], v[156:159]
s_add_u32 m0, s64, 32768
ds_read_b64_tr_b16 v[64:65], v12 offset:0
v_mfma_f32_16x16x32_bf16 v[156:159], v[76:79], v[60:63], v[156:159]
s_add_u32 s72, s71, 0
buffer_load_dwordx4 v6, s[12:15], s72 offen lds
v_mfma_f32_16x16x32_bf16 v[152:155], v[76:79], v[52:55], v[152:155]
s_add_u32 s73, s62, 15
ds_read_b64_tr_b16 v[66:67], v12 offset:1024
v_mfma_f32_16x16x32_bf16 v[152:155], v[72:75], v[48:51], v[152:155]
s_add_u32 s70, s73, s65
v_mfma_f32_16x16x32_bf16 v[148:151], v[72:75], v[40:43], v[148:151]
s_and_b32 s70, s70, 3
ds_read_b64_tr_b16 v[68:69], v12 offset:8192
v_mfma_f32_16x16x32_bf16 v[148:151], v[76:79], v[44:47], v[148:151]
s_and_b32 s73, s73, 12
ds_read_b64_tr_b16 v[70:71], v12 offset:9216
v_mfma_f32_16x16x32_bf16 v[144:147], v[76:79], v[36:39], v[144:147]
s_add_u32 s72, s71, 31744
buffer_load_dwordx4 v6, s[12:15], s72 offen offset:1024 lds
v_mfma_f32_16x16x32_bf16 v[144:147], v[72:75], v[32:35], v[144:147]
s_waitcnt lgkmcnt(8)
v_mfma_f32_16x16x32_bf16 v[160:163], v[80:83], v[32:35], v[160:163]
s_or_b32 s73, s73, s70
ds_read_b64_tr_b16 v[72:73], v13 offset:0
v_mfma_f32_16x16x32_bf16 v[160:163], v[84:87], v[36:39], v[160:163]
s_lshl_b32 s73, s73, 7
ds_read_b64_tr_b16 v[74:75], v13 offset:1024
v_mfma_f32_16x16x32_bf16 v[164:167], v[84:87], v[44:47], v[164:167]
s_add_u32 s69, s73, s67
v_mfma_f32_16x16x32_bf16 v[164:167], v[80:83], v[40:43], v[164:167]
s_add_u32 s72, s71, 63488
buffer_load_dwordx4 v7, s[12:15], s72 offen offset:2048 lds
v_mfma_f32_16x16x32_bf16 v[168:171], v[80:83], v[48:51], v[168:171]
s_waitcnt vmcnt(15)
ds_read_b64_tr_b16 v[76:77], v13 offset:8192
v_mfma_f32_16x16x32_bf16 v[168:171], v[84:87], v[52:55], v[168:171]
s_add_u32 s70, s73, s68
ds_read_b128 v[96:99], v18 offset:0
v_mfma_f32_16x16x32_bf16 v[172:175], v[84:87], v[60:63], v[172:175]
ds_read_b64_tr_b16 v[78:79], v13 offset:9216
v_mfma_f32_16x16x32_bf16 v[172:175], v[80:83], v[56:59], v[172:175]
s_waitcnt lgkmcnt(9)
ds_read_b128 v[100:103], v19 offset:0
v_mfma_f32_16x16x32_bf16 v[188:191], v[88:91], v[56:59], v[188:191]
s_add_u32 s72, s71, 95232
buffer_load_dwordx4 v7, s[12:15], s72 offen offset:3072 lds
v_mfma_f32_16x16x32_bf16 v[188:191], v[92:95], v[60:63], v[188:191]
ds_read_b64_tr_b16 v[80:81], v14 offset:0
v_mfma_f32_16x16x32_bf16 v[184:187], v[92:95], v[52:55], v[184:187]
ds_read_b64_tr_b16 v[82:83], v14 offset:1024
v_mfma_f32_16x16x32_bf16 v[184:187], v[88:91], v[48:51], v[184:187]
v_mfma_f32_16x16x32_bf16 v[180:183], v[88:91], v[40:43], v[180:183]
ds_read_b64_tr_b16 v[84:85], v14 offset:8192
v_mfma_f32_16x16x32_bf16 v[180:183], v[92:95], v[44:47], v[180:183]
s_add_u32 m0, s63, 131072
ds_read_b64_tr_b16 v[86:87], v14 offset:9216
v_mfma_f32_16x16x32_bf16 v[176:179], v[92:95], v[36:39], v[176:179]
s_add_u32 s72, s69, 0
buffer_load_dwordx4 v4, s[4:7], s72 offen lds
v_mfma_f32_16x16x32_bf16 v[176:179], v[88:91], v[32:35], v[176:179]
s_waitcnt lgkmcnt(10)
ds_read_b128 v[104:107], v18 offset:2048
v_mfma_f32_16x16x32_bf16 v[192:195], v[64:67], v[32:35], v[192:195]
ds_read_b64_tr_b16 v[88:89], v15 offset:0
ds_read_b64_tr_b16 v[90:91], v15 offset:1024
v_mfma_f32_16x16x32_bf16 v[192:195], v[68:71], v[36:39], v[192:195]
ds_read_b64_tr_b16 v[92:93], v15 offset:8192
v_mfma_f32_16x16x32_bf16 v[196:199], v[68:71], v[44:47], v[196:199]
s_and_b32 s75, s91, 0xfffffc7f
v_lshrrev_b32 v2, 3, v0
v_lshlrev_b32 v2, 7, v2
v_mfma_f32_16x16x32_bf16 v[196:199], v[64:67], v[40:43], v[196:199]
s_add_u32 s72, s69, 15360
buffer_load_dwordx4 v5, s[4:7], s72 offen offset:1024 lds
v_mfma_f32_16x16x32_bf16 v[200:203], v[64:67], v[48:51], v[200:203]
buffer_load_dword v3, v2, s[44:47], s75 offen sc1
v_mfma_f32_16x16x32_bf16 v[200:203], v[68:71], v[52:55], v[200:203]
ds_read_b64_tr_b16 v[94:95], v15 offset:9216
v_mfma_f32_16x16x32_bf16 v[204:207], v[68:71], v[60:63], v[204:207]
ds_read_b128 v[108:111], v19 offset:2048
v_mfma_f32_16x16x32_bf16 v[204:207], v[64:67], v[56:59], v[204:207]
s_waitcnt lgkmcnt(11)
v_mfma_f32_16x16x32_bf16 v[220:223], v[72:75], v[56:59], v[220:223]
s_add_u32 s72, s69, 129024
buffer_load_dwordx4 v4, s[4:7], s72 offen offset:2048 lds
v_mfma_f32_16x16x32_bf16 v[220:223], v[76:79], v[60:63], v[220:223]
ds_read_b128 v[112:115], v18 offset:4096
v_mfma_f32_16x16x32_bf16 v[216:219], v[76:79], v[52:55], v[216:219]
s_waitcnt vmcnt(16) lgkmcnt(2)
ds_read_b128 v[116:119], v19 offset:4096
v_mfma_f32_16x16x32_bf16 v[216:219], v[72:75], v[48:51], v[216:219]
s_barrier
v_mfma_f32_16x16x32_bf16 v[212:215], v[72:75], v[40:43], v[212:215]
ds_read_b64_tr_b16 v[64:65], v8 offset:16384
ds_read_b64_tr_b16 v[66:67], v8 offset:17408
v_mfma_f32_16x16x32_bf16 v[212:215], v[76:79], v[44:47], v[212:215]
ds_read_b64_tr_b16 v[68:69], v8 offset:24576
v_mfma_f32_16x16x32_bf16 v[208:211], v[76:79], v[36:39], v[208:211]
s_add_u32 s72, s69, 144384
buffer_load_dwordx4 v5, s[4:7], s72 offen offset:3072 lds
v_mfma_f32_16x16x32_bf16 v[208:211], v[72:75], v[32:35], v[208:211]
ds_read_b64_tr_b16 v[70:71], v8 offset:25600
v_mfma_f32_16x16x32_bf16 v[224:227], v[80:83], v[32:35], v[224:227]
ds_read_b64_tr_b16 v[72:73], v9 offset:16384
v_mfma_f32_16x16x32_bf16 v[224:227], v[84:87], v[36:39], v[224:227]
ds_read_b64_tr_b16 v[74:75], v9 offset:17408
v_mfma_f32_16x16x32_bf16 v[228:231], v[84:87], v[44:47], v[228:231]
s_add_u32 m0, s63, 135168
ds_read_b128 v[120:123], v18 offset:6144
v_mfma_f32_16x16x32_bf16 v[228:231], v[80:83], v[40:43], v[228:231]
s_add_u32 s72, s70, 0
buffer_load_dwordx4 v4, s[4:7], s72 offen lds
v_mfma_f32_16x16x32_bf16 v[232:235], v[80:83], v[48:51], v[232:235]
ds_read_b64_tr_b16 v[76:77], v9 offset:24576
v_mfma_f32_16x16x32_bf16 v[232:235], v[84:87], v[52:55], v[232:235]
ds_read_b128 v[124:127], v19 offset:6144
v_mfma_f32_16x16x32_bf16 v[236:239], v[84:87], v[60:63], v[236:239]
ds_read_b64_tr_b16 v[78:79], v9 offset:25600
v_mfma_f32_16x16x32_bf16 v[236:239], v[80:83], v[56:59], v[236:239]
v_mfma_f32_16x16x32_bf16 v[252:255], v[88:91], v[56:59], v[252:255]
s_add_u32 s72, s70, 15360
buffer_load_dwordx4 v5, s[4:7], s72 offen offset:1024 lds
v_mfma_f32_16x16x32_bf16 v[252:255], v[92:95], v[60:63], v[252:255]
ds_read_b64_tr_b16 v[80:81], v10 offset:16384
v_mfma_f32_16x16x32_bf16 v[248:251], v[92:95], v[52:55], v[248:251]
ds_read_b64_tr_b16 v[82:83], v10 offset:17408
v_mfma_f32_16x16x32_bf16 v[248:251], v[88:91], v[48:51], v[248:251]
v_mfma_f32_16x16x32_bf16 v[244:247], v[88:91], v[40:43], v[244:247]
ds_read_b64_tr_b16 v[84:85], v10 offset:24576
v_mfma_f32_16x16x32_bf16 v[244:247], v[92:95], v[44:47], v[244:247]
ds_read_b64_tr_b16 v[86:87], v10 offset:25600
v_mfma_f32_16x16x32_bf16 v[240:243], v[92:95], v[36:39], v[240:243]
s_add_u32 s72, s70, 129024
buffer_load_dwordx4 v4, s[4:7], s72 offen offset:2048 lds
v_mfma_f32_16x16x32_bf16 v[240:243], v[88:91], v[32:35], v[240:243]
s_waitcnt lgkmcnt(5)
v_mfma_f32_16x16x32_bf16 v[128:131], v[64:67], v[96:99], v[128:131]
ds_read_b64_tr_b16 v[88:89], v11 offset:16384
v_mfma_f32_16x16x32_bf16 v[128:131], v[68:71], v[100:103], v[128:131]
ds_read_b64_tr_b16 v[90:91], v11 offset:17408
v_mfma_f32_16x16x32_bf16 v[132:135], v[68:71], v[108:111], v[132:135]
v_mfma_f32_16x16x32_bf16 v[132:135], v[64:67], v[104:107], v[132:135]
s_add_u32 s72, s70, 144384
buffer_load_dwordx4 v5, s[4:7], s72 offen offset:3072 lds
v_mfma_f32_16x16x32_bf16 v[136:139], v[64:67], v[112:115], v[136:139]
ds_read_b64_tr_b16 v[92:93], v11 offset:24576
v_mfma_f32_16x16x32_bf16 v[136:139], v[68:71], v[116:119], v[136:139]
s_lshl_b32 s71, s73, 12
v_mfma_f32_16x16x32_bf16 v[140:143], v[68:71], v[124:127], v[140:143]
s_add_u32 s71, s71, s66
ds_read_b64_tr_b16 v[94:95], v11 offset:25600
v_mfma_f32_16x16x32_bf16 v[140:143], v[64:67], v[120:123], v[140:143]
s_waitcnt lgkmcnt(8)
v_mfma_f32_16x16x32_bf16 v[156:159], v[72:75], v[120:123], v[156:159]
s_add_u32 m0, s64, 0
ds_read_b64_tr_b16 v[64:65], v12 offset:16384
v_mfma_f32_16x16x32_bf16 v[156:159], v[76:79], v[124:127], v[156:159]
s_add_u32 s72, s71, 0
buffer_load_dwordx4 v6, s[12:15], s72 offen lds
v_mfma_f32_16x16x32_bf16 v[152:155], v[76:79], v[116:119], v[152:155]
ds_read_b64_tr_b16 v[66:67], v12 offset:17408
v_mfma_f32_16x16x32_bf16 v[152:155], v[72:75], v[112:115], v[152:155]
v_mfma_f32_16x16x32_bf16 v[148:151], v[72:75], v[104:107], v[148:151]
ds_read_b64_tr_b16 v[68:69], v12 offset:24576
v_mfma_f32_16x16x32_bf16 v[148:151], v[76:79], v[108:111], v[148:151]
ds_read_b64_tr_b16 v[70:71], v12 offset:25600
v_mfma_f32_16x16x32_bf16 v[144:147], v[76:79], v[100:103], v[144:147]
s_add_u32 s72, s71, 31744
buffer_load_dwordx4 v6, s[12:15], s72 offen offset:1024 lds
v_mfma_f32_16x16x32_bf16 v[144:147], v[72:75], v[96:99], v[144:147]
s_waitcnt lgkmcnt(8)
v_mfma_f32_16x16x32_bf16 v[160:163], v[80:83], v[96:99], v[160:163]
ds_read_b64_tr_b16 v[72:73], v13 offset:16384
v_mfma_f32_16x16x32_bf16 v[160:163], v[84:87], v[100:103], v[160:163]
ds_read_b64_tr_b16 v[74:75], v13 offset:17408
v_mfma_f32_16x16x32_bf16 v[164:167], v[84:87], v[108:111], v[164:167]
v_mfma_f32_16x16x32_bf16 v[164:167], v[80:83], v[104:107], v[164:167]
s_add_u32 s72, s71, 63488
buffer_load_dwordx4 v7, s[12:15], s72 offen offset:2048 lds
v_mfma_f32_16x16x32_bf16 v[168:171], v[80:83], v[112:115], v[168:171]
s_waitcnt vmcnt(16)
ds_read_b64_tr_b16 v[76:77], v13 offset:24576
v_mfma_f32_16x16x32_bf16 v[168:171], v[84:87], v[116:119], v[168:171]
ds_read_b128 v[32:35], v18 offset:32768
v_mfma_f32_16x16x32_bf16 v[172:175], v[84:87], v[124:127], v[172:175]
ds_read_b64_tr_b16 v[78:79], v13 offset:25600
v_mfma_f32_16x16x32_bf16 v[172:175], v[80:83], v[120:123], v[172:175]
s_waitcnt lgkmcnt(9)
ds_read_b128 v[36:39], v19 offset:32768
v_mfma_f32_16x16x32_bf16 v[188:191], v[88:91], v[120:123], v[188:191]
s_add_u32 s72, s71, 95232
buffer_load_dwordx4 v7, s[12:15], s72 offen offset:3072 lds
v_mfma_f32_16x16x32_bf16 v[188:191], v[92:95], v[124:127], v[188:191]
v_accvgpr_write_b32 a0, -1
v_accvgpr_write_b32 a1, -1
v_mfma_f32_16x16x32_bf16 v[184:187], v[92:95], v[116:119], v[184:187]
v_accvgpr_write_b32 a2, -1
v_accvgpr_write_b32 a3, -1
v_mfma_f32_16x16x32_bf16 v[184:187], v[88:91], v[112:115], v[184:187]
s_add_u32 s80, s93, 0x3a00000
ds_read_b64_tr_b16 v[80:81], v14 offset:16384
v_mfma_f32_16x16x32_bf16 v[180:183], v[88:91], v[104:107], v[180:183]
ds_read_b64_tr_b16 v[82:83], v14 offset:17408
v_mfma_f32_16x16x32_bf16 v[180:183], v[92:95], v[108:111], v[180:183]
ds_read_b64_tr_b16 v[84:85], v14 offset:24576
v_mfma_f32_16x16x32_bf16 v[176:179], v[92:95], v[100:103], v[176:179]
ds_read_b64_tr_b16 v[86:87], v14 offset:25600
v_mfma_f32_16x16x32_bf16 v[176:179], v[88:91], v[96:99], v[176:179]
s_waitcnt lgkmcnt(10)
ds_read_b128 v[40:43], v18 offset:34816
v_mfma_f32_16x16x32_bf16 v[192:195], v[64:67], v[96:99], v[192:195]
s_waitcnt vmcnt(10)
v_cmp_gt_u32 vcc, 1, v3
s_cbranch_vccnz Lspin4
Lback5:
v_mfma_f32_16x16x32_bf16 v[192:195], v[68:71], v[100:103], v[192:195]
s_add_u32 m0, s64, 49152
ds_read_b64_tr_b16 v[88:89], v15 offset:16384
ds_read_b64_tr_b16 v[90:91], v15 offset:17408
v_mfma_f32_16x16x32_bf16 v[196:199], v[68:71], v[108:111], v[196:199]
s_add_u32 s72, s81, 16384
buffer_load_dwordx4 v1, s[44:47], s72 offen sc1 lds
v_mfma_f32_16x16x32_bf16 v[196:199], v[64:67], v[104:107], v[196:199]
ds_read_b64_tr_b16 v[92:93], v15 offset:24576
v_mfma_f32_16x16x32_bf16 v[200:203], v[64:67], v[112:115], v[200:203]
ds_read_b64_tr_b16 v[94:95], v15 offset:25600
v_mfma_f32_16x16x32_bf16 v[200:203], v[68:71], v[116:119], v[200:203]
buffer_load_dwordx4 v1, s[44:47], s72 offen offset:1024 sc1 lds
v_mfma_f32_16x16x32_bf16 v[204:207], v[68:71], v[124:127], v[204:207]
ds_read_b128 v[44:47], v19 offset:34816
v_mfma_f32_16x16x32_bf16 v[204:207], v[64:67], v[120:123], v[204:207]
s_waitcnt lgkmcnt(11)
v_mfma_f32_16x16x32_bf16 v[220:223], v[72:75], v[120:123], v[220:223]
ds_read_b128 v[48:51], v18 offset:36864
v_mfma_f32_16x16x32_bf16 v[220:223], v[76:79], v[124:127], v[220:223]
ds_read_b128 v[52:55], v19 offset:36864
v_mfma_f32_16x16x32_bf16 v[216:219], v[76:79], v[116:119], v[216:219]
s_waitcnt vmcnt(15) lgkmcnt(3)
buffer_load_dwordx4 v1, s[44:47], s72 offen offset:2048 sc1 lds
v_mfma_f32_16x16x32_bf16 v[216:219], v[72:75], v[112:115], v[216:219]
s_barrier
ds_read_b128 v[56:59], v18 offset:38912
v_mfma_f32_16x16x32_bf16 v[212:215], v[72:75], v[104:107], v[212:215]
ds_read_b64_tr_b16 v[64:65], v8 offset:32768
ds_read_b64_tr_b16 v[66:67], v8 offset:33792
v_mfma_f32_16x16x32_bf16 v[212:215], v[76:79], v[108:111], v[212:215]
ds_read_b64_tr_b16 v[68:69], v8 offset:40960
v_mfma_f32_16x16x32_bf16 v[208:211], v[76:79], v[100:103], v[208:211]
ds_read_b64_tr_b16 v[70:71], v8 offset:41984
v_mfma_f32_16x16x32_bf16 v[208:211], v[72:75], v[96:99], v[208:211]
buffer_load_dwordx4 v1, s[44:47], s72 offen offset:3072 sc1 lds
v_mfma_f32_16x16x32_bf16 v[224:227], v[80:83], v[96:99], v[224:227]
s_add_u32 s81, s81, 0x8000
ds_read_b64_tr_b16 v[72:73], v9 offset:32768
v_mfma_f32_16x16x32_bf16 v[224:227], v[84:87], v[100:103], v[224:227]
s_add_u32 m0, s64, 81920
ds_read_b64_tr_b16 v[74:75], v9 offset:33792
v_mfma_f32_16x16x32_bf16 v[228:231], v[84:87], v[108:111], v[228:231]
s_add_u32 s72, s81, 16384
buffer_load_dwordx4 v1, s[44:47], s72 offen sc1 lds
v_mfma_f32_16x16x32_bf16 v[228:231], v[80:83], v[104:107], v[228:231]
ds_read_b128 v[60:63], v19 offset:38912
v_mfma_f32_16x16x32_bf16 v[232:235], v[80:83], v[112:115], v[232:235]
buffer_load_dwordx4 v1, s[44:47], s72 offen offset:1024 sc1 lds
v_mfma_f32_16x16x32_bf16 v[232:235], v[84:87], v[116:119], v[232:235]
ds_read_b64_tr_b16 v[76:77], v9 offset:40960
v_mfma_f32_16x16x32_bf16 v[236:239], v[84:87], v[124:127], v[236:239]
ds_read_b64_tr_b16 v[78:79], v9 offset:41984
v_mfma_f32_16x16x32_bf16 v[236:239], v[80:83], v[120:123], v[236:239]
v_mfma_f32_16x16x32_bf16 v[252:255], v[88:91], v[120:123], v[252:255]
ds_read_b64_tr_b16 v[80:81], v10 offset:32768
v_mfma_f32_16x16x32_bf16 v[252:255], v[92:95], v[124:127], v[252:255]
buffer_load_dwordx4 v1, s[44:47], s72 offen offset:2048 sc1 lds
v_mfma_f32_16x16x32_bf16 v[248:251], v[92:95], v[116:119], v[248:251]
ds_read_b64_tr_b16 v[82:83], v10 offset:33792
v_mfma_f32_16x16x32_bf16 v[248:251], v[88:91], v[112:115], v[248:251]
v_mfma_f32_16x16x32_bf16 v[244:247], v[88:91], v[104:107], v[244:247]
ds_read_b64_tr_b16 v[84:85], v10 offset:40960
v_mfma_f32_16x16x32_bf16 v[244:247], v[92:95], v[108:111], v[244:247]
buffer_load_dwordx4 v1, s[44:47], s72 offen offset:3072 sc1 lds
v_mfma_f32_16x16x32_bf16 v[240:243], v[92:95], v[100:103], v[240:243]
ds_read_b64_tr_b16 v[86:87], v10 offset:41984
v_mfma_f32_16x16x32_bf16 v[240:243], v[88:91], v[96:99], v[240:243]
s_waitcnt lgkmcnt(6)
LcS:
v_mfma_f32_16x16x32_bf16 v[128:131], v[64:67], v[32:35], v[128:131]
ds_read_b64_tr_b16 v[88:89], v11 offset:32768
v_mfma_f32_16x16x32_bf16 v[128:131], v[68:71], v[36:39], v[128:131]
ds_read_b64_tr_b16 v[90:91], v11 offset:33792
v_mfma_f32_16x16x32_bf16 v[132:135], v[68:71], v[44:47], v[132:135]
s_add_u32 m0, s64, 65536
v_mfma_f32_16x16x32_bf16 v[132:135], v[64:67], v[40:43], v[132:135]
s_add_u32 s72, s81, 0
buffer_load_dwordx4 v1, s[44:47], s72 offen sc1 lds
v_mfma_f32_16x16x32_bf16 v[136:139], v[64:67], v[48:51], v[136:139]
ds_read_b64_tr_b16 v[92:93], v11 offset:40960
v_mfma_f32_16x16x32_bf16 v[136:139], v[68:71], v[52:55], v[136:139]
ds_read_b64_tr_b16 v[94:95], v11 offset:41984
v_mfma_f32_16x16x32_bf16 v[140:143], v[68:71], v[60:63], v[140:143]
v_mfma_f32_16x16x32_bf16 v[140:143], v[64:67], v[56:59], v[140:143]
s_waitcnt lgkmcnt(8)
buffer_load_dwordx4 v1, s[44:47], s72 offen offset:1024 sc1 lds
v_mfma_f32_16x16x32_bf16 v[156:159], v[72:75], v[56:59], v[156:159]
ds_read_b64_tr_b16 v[64:65], v12 offset:32768
v_mfma_f32_16x16x32_bf16 v[156:159], v[76:79], v[60:63], v[156:159]
ds_read_b64_tr_b16 v[66:67], v12 offset:33792
v_mfma_f32_16x16x32_bf16 v[152:155], v[76:79], v[52:55], v[152:155]
v_mfma_f32_16x16x32_bf16 v[152:155], v[72:75], v[48:51], v[152:155]
buffer_load_dwordx4 v1, s[44:47], s72 offen offset:2048 sc1 lds
v_mfma_f32_16x16x32_bf16 v[148:151], v[72:75], v[40:43], v[148:151]
ds_read_b64_tr_b16 v[68:69], v12 offset:40960
v_mfma_f32_16x16x32_bf16 v[148:151], v[76:79], v[44:47], v[148:151]
v_mfma_f32_16x16x32_bf16 v[144:147], v[76:79], v[36:39], v[144:147]
ds_read_b64_tr_b16 v[70:71], v12 offset:41984
v_mfma_f32_16x16x32_bf16 v[144:147], v[72:75], v[32:35], v[144:147]
s_waitcnt lgkmcnt(8)
v_mfma_f32_16x16x32_bf16 v[160:163], v[80:83], v[32:35], v[160:163]
buffer_load_dwordx4 v1, s[44:47], s72 offen offset:3072 sc1 lds
v_mfma_f32_16x16x32_bf16 v[160:163], v[84:87], v[36:39], v[160:163]
ds_read_b64_tr_b16 v[72:73], v13 offset:32768
v_mfma_f32_16x16x32_bf16 v[164:167], v[84:87], v[44:47], v[164:167]
ds_read_b64_tr_b16 v[74:75], v13 offset:33792
v_mfma_f32_16x16x32_bf16 v[164:167], v[80:83], v[40:43], v[164:167]
v_mfma_f32_16x16x32_bf16 v[168:171], v[80:83], v[48:51], v[168:171]
s_waitcnt vmcnt(16)
ds_read_b64_tr_b16 v[76:77], v13 offset:40960
v_mfma_f32_16x16x32_bf16 v[168:171], v[84:87], v[52:55], v[168:171]
ds_read_b128 v[96:99], v16 offset:0
v_mfma_f32_16x16x32_bf16 v[172:175], v[84:87], v[60:63], v[172:175]
ds_read_b64_tr_b16 v[78:79], v13 offset:41984
v_mfma_f32_16x16x32_bf16 v[172:175], v[80:83], v[56:59], v[172:175]
s_waitcnt lgkmcnt(9)
v_mfma_f32_16x16x32_bf16 v[188:191], v[88:91], v[56:59], v[188:191]
ds_read_b64_tr_b16 v[80:81], v14 offset:32768
v_mfma_f32_16x16x32_bf16 v[188:191], v[92:95], v[60:63], v[188:191]
ds_read_b128 v[100:103], v17 offset:0
v_mfma_f32_16x16x32_bf16 v[184:187], v[92:95], v[52:55], v[184:187]
ds_read_b64_tr_b16 v[82:83], v14 offset:33792
v_mfma_f32_16x16x32_bf16 v[184:187], v[88:91], v[48:51], v[184:187]
v_mfma_f32_16x16x32_bf16 v[180:183], v[88:91], v[40:43], v[180:183]
ds_read_b64_tr_b16 v[84:85], v14 offset:40960
v_mfma_f32_16x16x32_bf16 v[180:183], v[92:95], v[44:47], v[180:183]
ds_read_b128 v[104:107], v16 offset:2048
v_mfma_f32_16x16x32_bf16 v[176:179], v[92:95], v[36:39], v[176:179]
ds_read_b64_tr_b16 v[86:87], v14 offset:41984
v_mfma_f32_16x16x32_bf16 v[176:179], v[88:91], v[32:35], v[176:179]
s_waitcnt lgkmcnt(11)
v_mfma_f32_16x16x32_bf16 v[192:195], v[64:67], v[32:35], v[192:195]
ds_read_b64_tr_b16 v[88:89], v15 offset:32768
v_mfma_f32_16x16x32_bf16 v[192:195], v[68:71], v[36:39], v[192:195]
ds_read_b64_tr_b16 v[90:91], v15 offset:33792
v_mfma_f32_16x16x32_bf16 v[196:199], v[68:71], v[44:47], v[196:199]
ds_read_b128 v[108:111], v17 offset:2048
v_mfma_f32_16x16x32_bf16 v[196:199], v[64:67], v[40:43], v[196:199]
ds_read_b64_tr_b16 v[92:93], v15 offset:40960
v_mfma_f32_16x16x32_bf16 v[200:203], v[64:67], v[48:51], v[200:203]
ds_read_b64_tr_b16 v[94:95], v15 offset:41984
v_mfma_f32_16x16x32_bf16 v[200:203], v[68:71], v[52:55], v[200:203]
v_mfma_f32_16x16x32_bf16 v[204:207], v[68:71], v[60:63], v[204:207]
ds_read_b128 v[112:115], v16 offset:4096
v_mfma_f32_16x16x32_bf16 v[204:207], v[64:67], v[56:59], v[204:207]
s_waitcnt lgkmcnt(12)
v_mfma_f32_16x16x32_bf16 v[220:223], v[72:75], v[56:59], v[220:223]
ds_read_b128 v[116:119], v17 offset:4096
v_mfma_f32_16x16x32_bf16 v[220:223], v[76:79], v[60:63], v[220:223]
v_mfma_f32_16x16x32_bf16 v[216:219], v[76:79], v[52:55], v[216:219]
s_waitcnt vmcnt(12) lgkmcnt(2)
ds_read_b128 v[120:123], v16 offset:6144
v_mfma_f32_16x16x32_bf16 v[216:219], v[72:75], v[48:51], v[216:219]
s_barrier
v_mfma_f32_16x16x32_bf16 v[212:215], v[72:75], v[40:43], v[212:215]
s_add_u32 s81, s81, 0x8000
ds_read_b64_tr_b16 v[64:65], v8 offset:0
ds_read_b64_tr_b16 v[66:67], v8 offset:1024
v_mfma_f32_16x16x32_bf16 v[212:215], v[76:79], v[44:47], v[212:215]
s_add_u32 m0, s64, 114688
ds_read_b64_tr_b16 v[68:69], v8 offset:8192
v_mfma_f32_16x16x32_bf16 v[208:211], v[76:79], v[36:39], v[208:211]
s_add_u32 s72, s81, 16384
buffer_load_dwordx4 v1, s[44:47], s72 offen sc1 lds
v_mfma_f32_16x16x32_bf16 v[208:211], v[72:75], v[32:35], v[208:211]
ds_read_b64_tr_b16 v[70:71], v8 offset:9216
v_mfma_f32_16x16x32_bf16 v[224:227], v[80:83], v[32:35], v[224:227]
buffer_load_dwordx4 v1, s[44:47], s72 offen offset:1024 sc1 lds
v_mfma_f32_16x16x32_bf16 v[224:227], v[84:87], v[36:39], v[224:227]
ds_read_b64_tr_b16 v[72:73], v9 offset:0
v_mfma_f32_16x16x32_bf16 v[228:231], v[84:87], v[44:47], v[228:231]
ds_read_b64_tr_b16 v[74:75], v9 offset:1024
v_mfma_f32_16x16x32_bf16 v[228:231], v[80:83], v[40:43], v[228:231]
ds_read_b128 v[124:127], v17 offset:6144
v_mfma_f32_16x16x32_bf16 v[232:235], v[80:83], v[48:51], v[232:235]
ds_read_b64_tr_b16 v[76:77], v9 offset:8192
v_mfma_f32_16x16x32_bf16 v[232:235], v[84:87], v[52:55], v[232:235]
Lstub0:
s_cbranch_execz Lstub4
buffer_store_dwordx4 a[0:3], v1, s[44:47], s80 offen sc1
v_mfma_f32_16x16x32_bf16 v[236:239], v[84:87], v[60:63], v[236:239]
ds_read_b64_tr_b16 v[78:79], v9 offset:9216
v_mfma_f32_16x16x32_bf16 v[236:239], v[80:83], v[56:59], v[236:239]
v_mfma_f32_16x16x32_bf16 v[252:255], v[88:91], v[56:59], v[252:255]
ds_read_b64_tr_b16 v[80:81], v10 offset:0
v_mfma_f32_16x16x32_bf16 v[252:255], v[92:95], v[60:63], v[252:255]
ds_read_b64_tr_b16 v[82:83], v10 offset:1024
v_mfma_f32_16x16x32_bf16 v[248:251], v[92:95], v[52:55], v[248:251]
buffer_load_dwordx4 v1, s[44:47], s72 offen offset:2048 sc1 lds
v_mfma_f32_16x16x32_bf16 v[248:251], v[88:91], v[48:51], v[248:251]
v_mfma_f32_16x16x32_bf16 v[244:247], v[88:91], v[40:43], v[244:247]
ds_read_b64_tr_b16 v[84:85], v10 offset:8192
v_mfma_f32_16x16x32_bf16 v[244:247], v[92:95], v[44:47], v[244:247]
ds_read_b64_tr_b16 v[86:87], v10 offset:9216
v_mfma_f32_16x16x32_bf16 v[240:243], v[92:95], v[36:39], v[240:243]
buffer_load_dwordx4 v1, s[44:47], s72 offen offset:3072 sc1 lds
v_mfma_f32_16x16x32_bf16 v[240:243], v[88:91], v[32:35], v[240:243]
s_waitcnt lgkmcnt(6)
v_mfma_f32_16x16x32_bf16 v[128:131], v[64:67], v[96:99], v[128:131]
ds_read_b64_tr_b16 v[88:89], v11 offset:0
v_mfma_f32_16x16x32_bf16 v[128:131], v[68:71], v[100:103], v[128:131]
ds_read_b64_tr_b16 v[90:91], v11 offset:1024
v_mfma_f32_16x16x32_bf16 v[132:135], v[68:71], v[108:111], v[132:135]
v_mfma_f32_16x16x32_bf16 v[132:135], v[64:67], v[104:107], v[132:135]
buffer_store_dwordx4 a[0:3], v1, s[44:47], s80 offen offset:1024 sc1
v_mfma_f32_16x16x32_bf16 v[136:139], v[64:67], v[112:115], v[136:139]
ds_read_b64_tr_b16 v[92:93], v11 offset:8192
v_mfma_f32_16x16x32_bf16 v[136:139], v[68:71], v[116:119], v[136:139]
v_mfma_f32_16x16x32_bf16 v[140:143], v[68:71], v[124:127], v[140:143]
ds_read_b64_tr_b16 v[94:95], v11 offset:9216
v_mfma_f32_16x16x32_bf16 v[140:143], v[64:67], v[120:123], v[140:143]
s_waitcnt lgkmcnt(8)
v_mfma_f32_16x16x32_bf16 v[156:159], v[72:75], v[120:123], v[156:159]
s_add_u32 m0, s64, 98304
ds_read_b64_tr_b16 v[64:65], v12 offset:0
v_mfma_f32_16x16x32_bf16 v[156:159], v[76:79], v[124:127], v[156:159]
s_add_u32 s72, s81, 0
buffer_load_dwordx4 v1, s[44:47], s72 offen sc1 lds
v_mfma_f32_16x16x32_bf16 v[152:155], v[76:79], v[116:119], v[152:155]
ds_read_b64_tr_b16 v[66:67], v12 offset:1024
v_mfma_f32_16x16x32_bf16 v[152:155], v[72:75], v[112:115], v[152:155]
v_mfma_f32_16x16x32_bf16 v[148:151], v[72:75], v[104:107], v[148:151]
buffer_load_dwordx4 v1, s[44:47], s72 offen offset:1024 sc1 lds
v_mfma_f32_16x16x32_bf16 v[148:151], v[76:79], v[108:111], v[148:151]
ds_read_b64_tr_b16 v[68:69], v12 offset:8192
v_mfma_f32_16x16x32_bf16 v[144:147], v[76:79], v[100:103], v[144:147]
ds_read_b64_tr_b16 v[70:71], v12 offset:9216
v_mfma_f32_16x16x32_bf16 v[144:147], v[72:75], v[96:99], v[144:147]
s_waitcnt lgkmcnt(8)
v_mfma_f32_16x16x32_bf16 v[160:163], v[80:83], v[96:99], v[160:163]
ds_read_b64_tr_b16 v[72:73], v13 offset:0
v_mfma_f32_16x16x32_bf16 v[160:163], v[84:87], v[100:103], v[160:163]
buffer_store_dwordx4 a[0:3], v1, s[44:47], s80 offen offset:2048 sc1
v_mfma_f32_16x16x32_bf16 v[164:167], v[84:87], v[108:111], v[164:167]
ds_read_b64_tr_b16 v[74:75], v13 offset:1024
v_mfma_f32_16x16x32_bf16 v[164:167], v[80:83], v[104:107], v[164:167]
v_mfma_f32_16x16x32_bf16 v[168:171], v[80:83], v[112:115], v[168:171]
ds_read_b64_tr_b16 v[76:77], v13 offset:8192
v_cvt_pk_bf16_f32 v48, v136, v137
v_mfma_f32_16x16x32_bf16 v[168:171], v[84:87], v[116:119], v[168:171]
ds_read_b64_tr_b16 v[78:79], v13 offset:9216
v_cvt_pk_bf16_f32 v49, v138, v139
v_mfma_f32_16x16x32_bf16 v[172:175], v[84:87], v[124:127], v[172:175]
buffer_load_dwordx4 v1, s[44:47], s72 offen offset:2048 sc1 lds
v_mfma_f32_16x16x32_bf16 v[172:175], v[80:83], v[120:123], v[172:175]
s_waitcnt lgkmcnt(8)
v_cvt_pk_bf16_f32 v50, v152, v153
v_cvt_pk_bf16_f32 v51, v154, v155
v_mfma_f32_16x16x32_bf16 v[188:191], v[88:91], v[120:123], v[188:191]
v_add_u32 v2, 0x8000, v1
v_cvt_pk_bf16_f32 v32, v132, v133
v_mfma_f32_16x16x32_bf16 v[188:191], v[92:95], v[124:127], v[188:191]
ds_read_b64_tr_b16 v[80:81], v14 offset:0
v_cvt_pk_bf16_f32 v33, v134, v135
v_mfma_f32_16x16x32_bf16 v[184:187], v[92:95], v[116:119], v[184:187]
buffer_load_dwordx4 v1, s[44:47], s72 offen offset:3072 sc1 lds
v_mfma_f32_16x16x32_bf16 v[184:187], v[88:91], v[112:115], v[184:187]
ds_read_b64_tr_b16 v[82:83], v14 offset:1024
v_cvt_pk_bf16_f32 v34, v148, v149
v_mfma_f32_16x16x32_bf16 v[180:183], v[88:91], v[104:107], v[180:183]
ds_read_b64_tr_b16 v[84:85], v14 offset:8192
v_cvt_pk_bf16_f32 v35, v150, v151
v_mfma_f32_16x16x32_bf16 v[180:183], v[92:95], v[108:111], v[180:183]
ds_read_b64_tr_b16 v[86:87], v14 offset:9216
v_cvt_pk_bf16_f32 v16, v128, v129
v_mfma_f32_16x16x32_bf16 v[176:179], v[92:95], v[100:103], v[176:179]
v_cvt_pk_bf16_f32 v17, v130, v131
v_cvt_pk_bf16_f32 v18, v144, v145
v_mfma_f32_16x16x32_bf16 v[176:179], v[88:91], v[96:99], v[176:179]
s_waitcnt lgkmcnt(8)
buffer_store_dwordx4 a[0:3], v1, s[44:47], s80 offen offset:3072 sc1
v_mfma_f32_16x16x32_bf16 v[192:195], v[64:67], v[96:99], v[192:195]
ds_read_b64_tr_b16 v[88:89], v15 offset:0
v_cvt_pk_bf16_f32 v19, v146, v147
v_mfma_f32_16x16x32_bf16 v[192:195], v[68:71], v[100:103], v[192:195]
ds_read_b64_tr_b16 v[90:91], v15 offset:1024
v_mfma_f32_16x16x32_bf16 v[196:199], v[68:71], v[108:111], v[196:199]
ds_read_b64_tr_b16 v[92:93], v15 offset:8192
v_mfma_f32_16x16x32_bf16 v[196:199], v[64:67], v[104:107], v[196:199]
ds_read_b64_tr_b16 v[94:95], v15 offset:9216
v_mfma_f32_16x16x32_bf16 v[200:203], v[64:67], v[112:115], v[200:203]
v_lshrrev_b32 v3, 1, v0
v_lshlrev_b32 v3, 7, v3
v_mfma_f32_16x16x32_bf16 v[200:203], v[68:71], v[116:119], v[200:203]
buffer_load_dword v4, v3, s[36:39], s93 offen
v_mfma_f32_16x16x32_bf16 v[204:207], v[68:71], v[124:127], v[204:207]
v_cvt_pk_bf16_f32 v52, v168, v169
v_cvt_pk_bf16_f32 v53, v170, v171
v_mfma_f32_16x16x32_bf16 v[204:207], v[64:67], v[120:123], v[204:207]
s_waitcnt lgkmcnt(8)
v_cvt_pk_bf16_f32 v54, v184, v185
v_cvt_pk_bf16_f32 v55, v186, v187
v_mfma_f32_16x16x32_bf16 v[220:223], v[72:75], v[120:123], v[220:223]
v_cvt_pk_bf16_f32 v36, v164, v165
v_cvt_pk_bf16_f32 v37, v166, v167
v_mfma_f32_16x16x32_bf16 v[220:223], v[76:79], v[124:127], v[220:223]
v_cvt_pk_bf16_f32 v38, v180, v181
v_cvt_pk_bf16_f32 v39, v182, v183
v_mfma_f32_16x16x32_bf16 v[216:219], v[76:79], v[116:119], v[216:219]
s_waitcnt vmcnt(21) lgkmcnt(0)
v_cvt_pk_bf16_f32 v20, v160, v161
v_cvt_pk_bf16_f32 v21, v162, v163
v_mfma_f32_16x16x32_bf16 v[216:219], v[72:75], v[112:115], v[216:219]
s_barrier
v_cvt_pk_bf16_f32 v22, v176, v177
v_cvt_pk_bf16_f32 v23, v178, v179
v_mfma_f32_16x16x32_bf16 v[212:215], v[72:75], v[104:107], v[212:215]
ds_read_b128 a[128:131], v2 offset:16384
v_cvt_pk_bf16_f32 v64, v140, v141
v_mfma_f32_16x16x32_bf16 v[212:215], v[76:79], v[108:111], v[212:215]
v_cvt_pk_bf16_f32 v65, v142, v143
v_cvt_pk_bf16_f32 v66, v156, v157
v_mfma_f32_16x16x32_bf16 v[208:211], v[76:79], v[100:103], v[208:211]
ds_read_b128 a[132:135], v2 offset:17408
v_cvt_pk_bf16_f32 v67, v158, v159
v_mfma_f32_16x16x32_bf16 v[208:211], v[72:75], v[96:99], v[208:211]
v_cvt_pk_bf16_f32 v68, v172, v173
v_cvt_pk_bf16_f32 v69, v174, v175
v_mfma_f32_16x16x32_bf16 v[224:227], v[80:83], v[96:99], v[224:227]
ds_read_b128 a[136:139], v2 offset:18432
v_cvt_pk_bf16_f32 v70, v188, v189
v_mfma_f32_16x16x32_bf16 v[224:227], v[84:87], v[100:103], v[224:227]
v_cvt_pk_bf16_f32 v71, v190, v191
v_mfma_f32_16x16x32_bf16 v[228:231], v[84:87], v[108:111], v[228:231]
ds_read_b128 a[140:143], v2 offset:19456
v_mfma_f32_16x16x32_bf16 v[228:231], v[80:83], v[104:107], v[228:231]
v_mfma_f32_16x16x32_bf16 v[232:235], v[80:83], v[112:115], v[232:235]
ds_read_b128 a[144:147], v2 offset:20480
v_cvt_pk_bf16_f32 v72, v204, v205
v_mfma_f32_16x16x32_bf16 v[232:235], v[84:87], v[116:119], v[232:235]
v_cvt_pk_bf16_f32 v73, v206, v207
v_cvt_pk_bf16_f32 v74, v220, v221
v_mfma_f32_16x16x32_bf16 v[236:239], v[84:87], v[124:127], v[236:239]
ds_read_b128 a[148:151], v2 offset:21504
v_cvt_pk_bf16_f32 v75, v222, v223
v_mfma_f32_16x16x32_bf16 v[236:239], v[80:83], v[120:123], v[236:239]
v_cvt_pk_bf16_f32 v56, v200, v201
v_cvt_pk_bf16_f32 v57, v202, v203
v_mfma_f32_16x16x32_bf16 v[252:255], v[88:91], v[120:123], v[252:255]
ds_read_b128 a[152:155], v2 offset:22528
v_cvt_pk_bf16_f32 v58, v216, v217
v_mfma_f32_16x16x32_bf16 v[252:255], v[92:95], v[124:127], v[252:255]
v_cvt_pk_bf16_f32 v59, v218, v219
v_cvt_pk_bf16_f32 v40, v196, v197
v_mfma_f32_16x16x32_bf16 v[248:251], v[92:95], v[116:119], v[248:251]
ds_read_b128 a[156:159], v2 offset:23552
v_cvt_pk_bf16_f32 v41, v198, v199
v_mfma_f32_16x16x32_bf16 v[248:251], v[88:91], v[112:115], v[248:251]
v_cvt_pk_bf16_f32 v42, v212, v213
v_cvt_pk_bf16_f32 v43, v214, v215
v_mfma_f32_16x16x32_bf16 v[244:247], v[88:91], v[104:107], v[244:247]
v_cvt_pk_bf16_f32 v24, v192, v193
v_cvt_pk_bf16_f32 v25, v194, v195
v_mfma_f32_16x16x32_bf16 v[244:247], v[92:95], v[108:111], v[244:247]
v_cvt_pk_bf16_f32 v26, v208, v209
v_cvt_pk_bf16_f32 v27, v210, v211
v_mfma_f32_16x16x32_bf16 v[240:243], v[92:95], v[100:103], v[240:243]
v_mfma_f32_16x16x32_bf16 v[240:243], v[88:91], v[96:99], v[240:243]
v_cvt_pk_bf16_f32 v76, v236, v237
v_cvt_pk_bf16_f32 v77, v238, v239
v_cvt_pk_bf16_f32 v78, v252, v253
v_cvt_pk_bf16_f32 v79, v254, v255
v_cvt_pk_bf16_f32 v60, v232, v233
v_cvt_pk_bf16_f32 v61, v234, v235
v_cvt_pk_bf16_f32 v62, v248, v249
v_cvt_pk_bf16_f32 v63, v250, v251
v_cvt_pk_bf16_f32 v44, v228, v229
v_cvt_pk_bf16_f32 v45, v230, v231
v_cvt_pk_bf16_f32 v46, v244, v245
v_cvt_pk_bf16_f32 v47, v246, v247
v_cvt_pk_bf16_f32 v28, v224, v225
v_cvt_pk_bf16_f32 v29, v226, v227
v_cvt_pk_bf16_f32 v30, v240, v241
v_cvt_pk_bf16_f32 v31, v242, v243
v_mov_b32 v124, 0xff800000
v_mov_b32 v125, 0xff800000
v_mov_b32 v126, 0xff800000
v_mov_b32 v127, 0xff800000
s_lshl_b32 s84, s60, 2
s_add_u32 s84, s84, s58
s_mov_b32 s86, 0
s_mov_b32 s53, 0
s_lshr_b32 s52, s66, 8
s_and_b32 s52, s52, 31
s_add_u32 s61, s65, s60
s_and_b32 s73, s60, 1
s_lshl_b32 s73, s73, 16
s_add_u32 s77, s73, s64
s_xor_b32 s73, s73, 0x10000
s_mov_b32 s92, s73
s_mul_i32 s62, s58, 4608
s_add_u32 s62, s62, 143104
s_add_u32 s73, s73, 49920
s_cmp_eq_u32 s58, 0
s_cselect_b32 s62, s73, s62
Lattn:
s_mov_b32 s82, 0x10000
s_waitcnt lgkmcnt(0)
v_mfma_f32_16x16x32_bf16 v[136:139], a[128:131], v[48:51], 0
ds_read_b128 a[160:163], v2 offset:24576
v_lshrrev_b32 v240, 4, v0
v_mfma_f32_16x16x32_bf16 v[136:139], a[132:135], v[52:55], v[136:139]
ds_read_b128 a[164:167], v2 offset:25600
v_and_b32 v241, 15, v0
v_mfma_f32_16x16x32_bf16 v[136:139], a[136:139], v[56:59], v[136:139]
ds_read_b128 a[168:171], v2 offset:26624
v_lshlrev_b32 v240, 2, v240
v_mfma_f32_16x16x32_bf16 v[136:139], a[140:143], v[60:63], v[136:139]
ds_read_b128 a[172:175], v2 offset:27648
v_sub_u32 v240, v241, v240
v_mfma_f32_16x16x32_bf16 v[140:143], a[140:143], v[76:79], 0
ds_read_b128 a[176:179], v2 offset:28672
v_mov_b32 v112, 0xff800000
v_mfma_f32_16x16x32_bf16 v[140:143], a[136:139], v[72:75], v[140:143]
ds_read_b128 a[180:183], v2 offset:29696
v_mov_b32 v113, 0xff800000
v_mfma_f32_16x16x32_bf16 v[140:143], a[132:135], v[68:71], v[140:143]
ds_read_b128 a[184:187], v2 offset:30720
v_mov_b32 v114, 0xff800000
v_mfma_f32_16x16x32_bf16 v[140:143], a[128:131], v[64:67], v[140:143]
ds_read_b128 a[188:191], v2 offset:31744
v_mov_b32 v115, 0xff800000
v_mfma_f32_16x16x32_bf16 v[156:159], a[144:147], v[64:67], 0
v_cmp_gt_i32 vcc, 0, v240
v_and_b32 v120, 3, v0
v_mfma_f32_16x16x32_bf16 v[156:159], a[148:151], v[68:71], v[156:159]
v_cndmask_b32 v116, 0, v112, vcc
v_cmp_gt_i32 vcc, 1, v240
v_mfma_f32_16x16x32_bf16 v[156:159], a[152:155], v[72:75], v[156:159]
v_subrev_u32 v120, 1, v120
v_cndmask_b32 v117, 0, v112, vcc
v_mfma_f32_16x16x32_bf16 v[156:159], a[156:159], v[76:79], v[156:159]
v_cmp_gt_i32 vcc, 2, v240
v_ashrrev_i32 v120, 31, v120
v_mfma_f32_16x16x32_bf16 v[152:155], a[156:159], v[60:63], 0
v_cndmask_b32 v118, 0, v112, vcc
v_cmp_gt_i32 vcc, 3, v240
v_mfma_f32_16x16x32_bf16 v[152:155], a[152:155], v[56:59], v[152:155]
v_and_b32 v120, 0x3f803f80, v120
v_cndmask_b32 v119, 0, v112, vcc
v_mfma_f32_16x16x32_bf16 v[152:155], a[148:151], v[52:55], v[152:155]
v_mov_b32 v228, 0
v_mov_b32 v229, 0
v_mfma_f32_16x16x32_bf16 v[152:155], a[144:147], v[48:51], v[152:155]
v_mov_b32 v230, 0
v_mov_b32 v231, 0
s_cmp_eq_u32 s84, 0
s_cbranch_scc1 Lta7
s_cmp_eq_u32 s84, 1
s_cbranch_scc1 Lnt8
v_mfma_f32_16x16x32_bf16 v[128:131], a[128:131], v[16:19], 0
v_mov_b32 v236, 0
v_mov_b32 v237, 0
v_mfma_f32_16x16x32_bf16 v[144:147], a[144:147], v[16:19], 0
v_mov_b32 v238, 0
v_mov_b32 v239, 0
s_branch Ljoin9
Lta7:
v_mfma_f32_16x16x32_bf16 v[128:131], a[128:131], v[16:19], v[116:119]
v_mov_b32 v236, 0
v_mov_b32 v237, 0
v_mfma_f32_16x16x32_bf16 v[144:147], a[144:147], v[16:19], v[112:115]
v_mov_b32 v238, 0
v_mov_b32 v239, 0
s_branch Ljoin9
Lnt8:
v_mfma_f32_16x16x32_bf16 v[128:131], a[128:131], v[16:19], 0
v_mov_b32 v236, 0
v_mov_b32 v237, 0
v_mfma_f32_16x16x32_bf16 v[144:147], a[144:147], v[16:19], v[116:119]
v_mov_b32 v238, 0
v_mov_b32 v239, 0
Ljoin9:
v_mfma_f32_16x16x32_bf16 v[128:131], a[132:135], v[20:23], v[128:131]
v_mov_b32 v121, v120
v_mov_b32 v122, v120
v_mfma_f32_16x16x32_bf16 v[128:131], a[136:139], v[24:27], v[128:131]
v_mov_b32 v123, v120
v_mfma_f32_16x16x32_bf16 v[128:131], a[140:143], v[28:31], v[128:131]
v_max3_f32 v240, v136, v137, v126
v_max3_f32 v242, v140, v141, v127
v_mfma_f32_16x16x32_bf16 v[132:135], a[140:143], v[44:47], 0
v_max3_f32 v240, v240, v138, v139
v_max3_f32 v242, v242, v142, v143
v_mfma_f32_16x16x32_bf16 v[132:135], a[136:139], v[40:43], v[132:135]
v_max3_f32 v240, v240, v152, v153
v_max3_f32 v242, v242, v156, v157
v_mfma_f32_16x16x32_bf16 v[132:135], a[132:135], v[36:39], v[132:135]
v_max3_f32 v240, v240, v154, v155
v_max3_f32 v242, v242, v158, v159
v_mfma_f32_16x16x32_bf16 v[132:135], a[128:131], v[32:35], v[132:135]
v_mov_b32 v241, v240
v_mov_b32 v243, v242
v_mfma_f32_16x16x32_bf16 v[148:151], a[144:147], v[32:35], 0
v_permlane16_swap_b32 v240, v241
v_permlane16_swap_b32 v242, v243
v_mfma_f32_16x16x32_bf16 v[148:151], a[148:151], v[36:39], v[148:151]
v_max_f32 v240, v240, v241
v_max_f32 v242, v242, v243
v_mfma_f32_16x16x32_bf16 v[148:151], a[152:155], v[40:43], v[148:151]
v_mov_b32 v241, v240
v_mov_b32 v243, v242
v_mfma_f32_16x16x32_bf16 v[148:151], a[156:159], v[44:47], v[148:151]
v_permlane32_swap_b32 v240, v241
v_permlane32_swap_b32 v242, v243
v_mfma_f32_16x16x32_bf16 v[144:147], a[156:159], v[28:31], v[144:147]
v_max_f32 v240, v240, v241
v_max_f32 v242, v242, v243
v_mfma_f32_16x16x32_bf16 v[144:147], a[152:155], v[24:27], v[144:147]
v_mfma_f32_16x16x32_bf16 v[144:147], a[148:151], v[20:23], v[144:147]
v_sub_f32 v88, 0, v240
v_sub_f32 v89, 0, v240
v_pk_add_f32 v[90:91], v[88:89], 0
v_pk_add_f32 v[104:105], v[116:117], v[88:89]
v_pk_add_f32 v[106:107], v[118:119], v[88:89]
v_pk_add_f32 v[136:137], v[136:137], v[88:89]
v_pk_add_f32 v[138:139], v[138:139], v[88:89]
v_pk_add_f32 v[152:153], v[152:153], v[88:89]
v_pk_add_f32 v[154:155], v[154:155], v[88:89]
v_sub_f32 v92, 0, v242
v_sub_f32 v93, 0, v242
v_pk_add_f32 v[94:95], v[92:93], 0
v_pk_add_f32 v[108:109], v[116:117], v[92:93]
v_pk_add_f32 v[110:111], v[118:119], v[92:93]
v_pk_add_f32 v[140:141], v[140:141], v[92:93]
v_pk_add_f32 v[142:143], v[142:143], v[92:93]
v_pk_add_f32 v[156:157], v[156:157], v[92:93]
v_pk_add_f32 v[158:159], v[158:159], v[92:93]
v_max3_f32 v240, v128, v129, v124
v_max3_f32 v242, v132, v133, v125
v_max3_f32 v240, v240, v130, v131
v_max3_f32 v242, v242, v134, v135
v_max3_f32 v240, v240, v144, v145
v_max3_f32 v242, v242, v148, v149
v_max3_f32 v240, v240, v146, v147
v_max3_f32 v242, v242, v150, v151
v_mov_b32 v241, v240
v_mov_b32 v243, v242
s_nop 0
v_permlane16_swap_b32 v240, v241
v_permlane16_swap_b32 v242, v243
v_max_f32 v240, v240, v241
v_max_f32 v242, v242, v243
v_mov_b32 v241, v240
v_mov_b32 v243, v242
s_nop 0
v_permlane32_swap_b32 v240, v241
v_permlane32_swap_b32 v242, v243
v_max_f32 v240, v240, v241
v_max_f32 v242, v242, v243
v_sub_f32 v80, 0, v240
v_sub_f32 v81, 0, v240
v_pk_add_f32 v[82:83], v[80:81], 0
v_pk_add_f32 v[96:97], v[116:117], v[80:81]
v_pk_add_f32 v[98:99], v[118:119], v[80:81]
v_pk_add_f32 v[128:129], v[128:129], v[80:81]
v_pk_add_f32 v[130:131], v[130:131], v[80:81]
v_pk_add_f32 v[144:145], v[144:145], v[80:81]
v_pk_add_f32 v[146:147], v[146:147], v[80:81]
v_sub_f32 v84, 0, v242
v_sub_f32 v85, 0, v242
v_pk_add_f32 v[86:87], v[84:85], 0
v_pk_add_f32 v[100:101], v[116:117], v[84:85]
v_pk_add_f32 v[102:103], v[118:119], v[84:85]
v_pk_add_f32 v[132:133], v[132:133], v[84:85]
v_pk_add_f32 v[134:135], v[134:135], v[84:85]
v_pk_add_f32 v[148:149], v[148:149], v[84:85]
v_pk_add_f32 v[150:151], v[150:151], v[84:85]
v_add_u32 v2, s82, v1
s_waitcnt vmcnt(13) lgkmcnt(0)
s_barrier
s_cmp_eq_u32 s60, 0
s_cbranch_scc1 LP0x
v_mfma_f32_16x16x32_bf16 v[164:167], a[160:163], v[32:35], v[84:87]
s_xor_b32 s74, s82, 0x10000
v_exp_f32 v128, v128
v_mfma_f32_16x16x32_bf16 v[164:167], a[164:167], v[36:39], v[164:167]
s_add_u32 s74, s74, s64
ds_read_b128 a[128:131], v2 offset:16384
ds_read_b128 a[132:135], v2 offset:17408
v_mfma_f32_16x16x32_bf16 v[164:167], a[168:171], v[40:43], v[164:167]
s_add_u32 s81, s81, 0x8000
v_exp_f32 v129, v129
v_mfma_f32_16x16x32_bf16 v[164:167], a[172:175], v[44:47], v[164:167]
s_add_u32 m0, s74, 16384
v_exp_f32 v130, v130
v_mfma_f32_16x16x32_bf16 v[172:175], a[172:175], v[76:79], v[92:95]
s_add_u32 s72, s81, 16384
v_exp_f32 v131, v131
v_mfma_f32_16x16x32_bf16 v[172:175], a[168:171], v[72:75], v[172:175]
v_exp_f32 v144, v144
v_mfma_f32_16x16x32_bf16 v[172:175], a[164:167], v[68:71], v[172:175]
s_nop 0
ds_read_b128 a[136:139], v2 offset:18432
ds_read_b128 a[140:143], v2 offset:19456
v_mfma_f32_16x16x32_bf16 v[172:175], a[160:163], v[64:67], v[172:175]
s_nop 0
ds_read_b128 a[144:147], v2 offset:20480
ds_read_b128 a[148:151], v2 offset:21504
v_mfma_f32_16x16x32_bf16 v[188:191], a[176:179], v[64:67], v[92:95]
s_nop 0
ds_read_b128 a[152:155], v2 offset:22528
ds_read_b128 a[156:159], v2 offset:23552
v_mfma_f32_16x16x32_bf16 v[188:191], a[180:183], v[68:71], v[188:191]
s_nop 0
ds_read_b128 a[192:195], v2 offset:0
ds_read_b128 a[196:199], v2 offset:1024
v_mfma_f32_16x16x32_bf16 v[188:191], a[184:187], v[72:75], v[188:191]
s_nop 0
ds_read_b128 a[200:203], v2 offset:2048
ds_read_b128 a[204:207], v2 offset:3072
v_mfma_f32_16x16x32_bf16 v[188:191], a[188:191], v[76:79], v[188:191]
s_nop 0
ds_read_b128 a[208:211], v2 offset:4096
ds_read_b128 a[212:215], v2 offset:5120
v_mfma_f32_16x16x32_bf16 v[180:183], a[188:191], v[44:47], v[84:87]
s_nop 0
ds_read_b128 a[216:219], v2 offset:6144
ds_read_b128 a[220:223], v2 offset:7168
v_mfma_f32_16x16x32_bf16 v[180:183], a[184:187], v[40:43], v[180:183]
v_cvt_pk_bf16_f32 v192, v128, v129
v_cvt_pk_bf16_f32 v193, v130, v131
v_mfma_f32_16x16x32_bf16 v[180:183], a[180:183], v[36:39], v[180:183]
buffer_load_dwordx4 v1, s[44:47], s72 offen sc1 lds
v_mfma_f32_16x16x32_bf16 v[180:183], a[176:179], v[32:35], v[180:183]
v_exp_f32 v145, v145
v_mfma_f32_16x16x32_bf16 v[160:163], a[160:163], v[16:19], v[80:83]
v_exp_f32 v146, v146
v_mfma_f32_16x16x32_bf16 v[160:163], a[164:167], v[20:23], v[160:163]
v_exp_f32 v147, v147
v_mfma_f32_16x16x32_bf16 v[160:163], a[168:171], v[24:27], v[160:163]
v_exp_f32 v136, v136
v_mfma_f32_16x16x32_bf16 v[160:163], a[172:175], v[28:31], v[160:163]
v_cvt_pk_bf16_f32 v194, v144, v145
v_cvt_pk_bf16_f32 v195, v146, v147
v_mfma_f32_16x16x32_bf16 v[168:171], a[172:175], v[60:63], v[88:91]
v_exp_f32 v137, v137
v_mfma_f32_16x16x32_bf16 v[168:171], a[168:171], v[56:59], v[168:171]
v_exp_f32 v138, v138
v_mfma_f32_16x16x32_bf16 v[168:171], a[164:167], v[52:55], v[168:171]
v_exp_f32 v139, v139
v_mfma_f32_16x16x32_bf16 v[168:171], a[160:163], v[48:51], v[168:171]
v_exp_f32 v152, v152
v_mfma_f32_16x16x32_bf16 v[184:187], a[176:179], v[48:51], v[88:91]
v_cvt_pk_bf16_f32 v200, v136, v137
v_cvt_pk_bf16_f32 v201, v138, v139
v_mfma_f32_16x16x32_bf16 v[184:187], a[180:183], v[52:55], v[184:187]
buffer_load_dwordx4 v1, s[44:47], s72 offen offset:1024 sc1 lds
v_mfma_f32_16x16x32_bf16 v[184:187], a[184:187], v[56:59], v[184:187]
v_exp_f32 v153, v153
v_mfma_f32_16x16x32_bf16 v[184:187], a[188:191], v[60:63], v[184:187]
v_exp_f32 v154, v154
v_mfma_f32_16x16x32_bf16 v[176:179], a[188:191], v[28:31], v[80:83]
v_exp_f32 v155, v155
v_mfma_f32_16x16x32_bf16 v[176:179], a[184:187], v[24:27], v[176:179]
buffer_load_dwordx4 v1, s[44:47], s72 offen offset:2048 sc1 lds
v_mfma_f32_16x16x32_bf16 v[176:179], a[180:183], v[20:23], v[176:179]
buffer_load_dwordx4 v1, s[44:47], s72 offen offset:3072 sc1 lds
v_mfma_f32_16x16x32_bf16 v[176:179], a[176:179], v[16:19], v[176:179]
s_waitcnt lgkmcnt(4)
v_exp_f32 v132, v132
v_cvt_pk_bf16_f32 v202, v152, v153
v_cvt_pk_bf16_f32 v203, v154, v155
v_exp_f32 v133, v133
v_exp_f32 v134, v134
v_cvt_pk_bf16_f32 v196, v132, v133
v_exp_f32 v135, v135
v_exp_f32 v148, v148
v_cvt_pk_bf16_f32 v197, v134, v135
v_exp_f32 v149, v149
v_exp_f32 v150, v150
v_cvt_pk_bf16_f32 v198, v148, v149
v_exp_f32 v151, v151
v_exp_f32 v140, v140
v_cvt_pk_bf16_f32 v199, v150, v151
v_exp_f32 v141, v141
v_exp_f32 v142, v142
v_cvt_pk_bf16_f32 v204, v140, v141
v_exp_f32 v143, v143
v_exp_f32 v156, v156
v_cvt_pk_bf16_f32 v205, v142, v143
v_exp_f32 v157, v157
v_exp_f32 v158, v158
v_cvt_pk_bf16_f32 v206, v156, v157
v_exp_f32 v159, v159
s_nop 0
v_cvt_pk_bf16_f32 v207, v158, v159
v_mfma_f32_16x16x32_bf16 v[224:227], v[120:123], v[192:195], 0
s_add_u32 s82, s82, 0x8000
ds_read_b128 a[160:163], v2 offset:24576
ds_read_b128 a[164:167], v2 offset:25600
v_mfma_f32_16x16x32_bf16 v[232:235], v[120:123], v[200:203], 0
s_and_b32 s82, s82, 0x1ffff
v_exp_f32 v164, v164
v_mfma_f32_16x16x32_bf16 a[0:3], a[192:195], v[192:195], 0
s_add_u32 m0, s74, 0
v_exp_f32 v165, v165
v_mfma_f32_16x16x32_bf16 a[64:67], a[192:195], v[200:203], 0
s_add_u32 s72, s81, 0
v_exp_f32 v166, v166
v_mfma_f32_16x16x32_bf16 a[68:71], a[196:199], v[200:203], 0
buffer_load_dwordx4 v1, s[44:47], s72 offen sc1 lds
v_mfma_f32_16x16x32_bf16 a[4:7], a[196:199], v[192:195], 0
v_exp_f32 v167, v167
v_mfma_f32_16x16x32_bf16 a[8:11], a[200:203], v[192:195], 0
ds_read_b128 a[168:171], v2 offset:26624
v_cvt_pk_bf16_f32 v212, v164, v165
v_mfma_f32_16x16x32_bf16 a[72:75], a[200:203], v[200:203], 0
v_exp_f32 v180, v180
v_mfma_f32_16x16x32_bf16 a[76:79], a[204:207], v[200:203], 0
v_exp_f32 v181, v181
v_mfma_f32_16x16x32_bf16 a[12:15], a[204:207], v[192:195], 0
s_waitcnt lgkmcnt(3)
ds_read_b128 a[172:175], v2 offset:27648
v_cvt_pk_bf16_f32 v213, v166, v167
v_mfma_f32_16x16x32_bf16 a[16:19], a[208:211], v[192:195], 0
v_exp_f32 v182, v182
v_mfma_f32_16x16x32_bf16 a[80:83], a[208:211], v[200:203], 0
buffer_load_dwordx4 v1, s[44:47], s72 offen offset:1024 sc1 lds
v_mfma_f32_16x16x32_bf16 a[84:87], a[212:215], v[200:203], 0
v_exp_f32 v183, v183
v_mfma_f32_16x16x32_bf16 a[20:23], a[212:215], v[192:195], 0
s_nop 0
ds_read_b128 a[176:179], v2 offset:28672
ds_read_b128 a[180:183], v2 offset:29696
v_mfma_f32_16x16x32_bf16 a[24:27], a[216:219], v[192:195], 0
v_exp_f32 v172, v172
v_mfma_f32_16x16x32_bf16 a[88:91], a[216:219], v[200:203], 0
s_nop 0
ds_read_b128 a[184:187], v2 offset:30720
ds_read_b128 a[188:191], v2 offset:31744
v_mfma_f32_16x16x32_bf16 a[92:95], a[220:223], v[200:203], 0
s_nop 0
ds_read_b128 a[224:227], v2 offset:8192
ds_read_b128 a[228:231], v2 offset:9216
v_mfma_f32_16x16x32_bf16 a[28:31], a[220:223], v[192:195], 0
s_nop 0
ds_read_b128 a[232:235], v2 offset:10240
ds_read_b128 a[236:239], v2 offset:11264
v_mfma_f32_16x16x32_bf16 v[128:131], a[128:131], v[16:19], v[80:83]
s_nop 0
ds_read_b128 a[240:243], v2 offset:12288
ds_read_b128 a[244:247], v2 offset:13312
v_mfma_f32_16x16x32_bf16 v[128:131], a[132:135], v[20:23], v[128:131]
s_nop 0
ds_read_b128 a[248:251], v2 offset:14336
ds_read_b128 a[252:255], v2 offset:15360
v_mfma_f32_16x16x32_bf16 v[128:131], a[136:139], v[24:27], v[128:131]
v_cvt_pk_bf16_f32 v214, v180, v181
v_cvt_pk_bf16_f32 v215, v182, v183
v_mfma_f32_16x16x32_bf16 v[128:131], a[140:143], v[28:31], v[128:131]
v_exp_f32 v173, v173
v_mfma_f32_16x16x32_bf16 v[136:139], a[140:143], v[60:63], v[88:91]
v_exp_f32 v174, v174
v_mfma_f32_16x16x32_bf16 v[136:139], a[136:139], v[56:59], v[136:139]
buffer_load_dwordx4 v1, s[44:47], s72 offen offset:2048 sc1 lds
v_mfma_f32_16x16x32_bf16 v[136:139], a[132:135], v[52:55], v[136:139]
v_exp_f32 v175, v175
v_mfma_f32_16x16x32_bf16 v[136:139], a[128:131], v[48:51], v[136:139]
v_exp_f32 v188, v188
v_mfma_f32_16x16x32_bf16 v[152:155], a[144:147], v[48:51], v[88:91]
v_cvt_pk_bf16_f32 v220, v172, v173
v_cvt_pk_bf16_f32 v221, v174, v175
v_mfma_f32_16x16x32_bf16 v[152:155], a[148:151], v[52:55], v[152:155]
v_exp_f32 v189, v189
v_mfma_f32_16x16x32_bf16 v[152:155], a[152:155], v[56:59], v[152:155]
v_exp_f32 v190, v190
v_mfma_f32_16x16x32_bf16 v[152:155], a[156:159], v[60:63], v[152:155]
buffer_load_dwordx4 v1, s[44:47], s72 offen offset:3072 sc1 lds
v_mfma_f32_16x16x32_bf16 v[144:147], a[156:159], v[28:31], v[80:83]
s_add_u32 s66, s58, 1
v_exp_f32 v191, v191
v_mfma_f32_16x16x32_bf16 v[144:147], a[152:155], v[24:27], v[144:147]
s_and_b32 s66, s66, 3
v_exp_f32 v160, v160
v_mfma_f32_16x16x32_bf16 v[144:147], a[148:151], v[20:23], v[144:147]
s_mul_i32 s66, s66, 4160
v_cvt_pk_bf16_f32 v222, v188, v189
v_cvt_pk_bf16_f32 v223, v190, v191
v_mfma_f32_16x16x32_bf16 v[144:147], a[144:147], v[16:19], v[144:147]
s_add_u32 m0, s66, 131104
v_exp_f32 v161, v161
v_mfma_f32_16x16x32_bf16 v[132:135], a[128:131], v[32:35], v[84:87]
s_add_u32 s72, s93, 0x2
buffer_load_dwordx4 v1, s[36:39], s72 offen lds
v_mfma_f32_16x16x32_bf16 v[132:135], a[132:135], v[36:39], v[132:135]
Lstub1:
s_cbranch_execz Lstub5
v_exp_f32 v162, v162
v_mfma_f32_16x16x32_bf16 v[132:135], a[136:139], v[40:43], v[132:135]
v_exp_f32 v163, v163
v_mfma_f32_16x16x32_bf16 v[132:135], a[140:143], v[44:47], v[132:135]
v_exp_f32 v176, v176
v_mfma_f32_16x16x32_bf16 v[140:143], a[140:143], v[76:79], v[92:95]
v_cvt_pk_bf16_f32 v208, v160, v161
v_cvt_pk_bf16_f32 v209, v162, v163
v_mfma_f32_16x16x32_bf16 v[140:143], a[136:139], v[72:75], v[140:143]
v_exp_f32 v177, v177
v_mfma_f32_16x16x32_bf16 v[140:143], a[132:135], v[68:71], v[140:143]
buffer_load_dwordx4 v1, s[36:39], s72 offen offset:1024 lds
v_mfma_f32_16x16x32_bf16 v[140:143], a[128:131], v[64:67], v[140:143]
v_exp_f32 v178, v178
v_mfma_f32_16x16x32_bf16 v[156:159], a[144:147], v[64:67], v[92:95]
v_exp_f32 v179, v179
v_mfma_f32_16x16x32_bf16 v[156:159], a[148:151], v[68:71], v[156:159]
v_exp_f32 v168, v168
v_mfma_f32_16x16x32_bf16 v[156:159], a[152:155], v[72:75], v[156:159]
v_cvt_pk_bf16_f32 v210, v176, v177
v_cvt_pk_bf16_f32 v211, v178, v179
v_mfma_f32_16x16x32_bf16 v[156:159], a[156:159], v[76:79], v[156:159]
v_exp_f32 v169, v169
v_mfma_f32_16x16x32_bf16 v[148:151], a[156:159], v[44:47], v[84:87]
buffer_load_dwordx4 v1, s[36:39], s72 offen offset:2048 lds
v_mfma_f32_16x16x32_bf16 v[148:151], a[152:155], v[40:43], v[148:151]
buffer_load_dwordx4 v1, s[36:39], s72 offen offset:3072 lds
v_mfma_f32_16x16x32_bf16 v[148:151], a[148:151], v[36:39], v[148:151]
s_waitcnt vmcnt(12) lgkmcnt(4)
v_exp_f32 v170, v170
v_mfma_f32_16x16x32_bf16 v[148:151], a[144:147], v[32:35], v[148:151]
s_barrier
v_exp_f32 v171, v171
v_add_u32 v2, s82, v1
v_cvt_pk_bf16_f32 v216, v168, v169
v_exp_f32 v184, v184
v_cvt_pk_bf16_f32 v217, v170, v171
v_exp_f32 v185, v185
v_exp_f32 v186, v186
v_cvt_pk_bf16_f32 v218, v184, v185
v_exp_f32 v187, v187
s_nop 0
v_cvt_pk_bf16_f32 v219, v186, v187
s_lshl_b32 s75, s59, 4
s_and_b32 s76, s84, 15
s_add_u32 s75, s75, s76
s_lshl_b32 s75, s75, 14
s_cmp_ge_u32 s60, 4
s_cselect_b32 s75, s75, 0x40001000
s_lshl_b32 s83, s60, 1
s_sub_u32 s83, 2, s83
s_cmp_eq_u32 s83, 0
s_cbranch_scc1 LLT1
.p2align 5
s_nop 0
s_nop 0
LloopI:
v_mfma_f32_16x16x32_bf16 v[228:231], v[120:123], v[196:199], v[228:231]
s_xor_b32 s74, s82, 0x10000
v_exp_f32 v128, v128
v_mfma_f32_16x16x32_bf16 v[228:231], v[120:123], v[212:215], v[228:231]
s_add_u32 s74, s74, s64
ds_read_b128 a[128:131], v2 offset:16384
v_add_u32 v15, s75, v3
v_mfma_f32_16x16x32_bf16 v[236:239], v[120:123], v[204:207], v[236:239]
s_add_u32 s81, s81, 0x8000
v_exp_f32 v129, v129
v_mfma_f32_16x16x32_bf16 v[236:239], v[120:123], v[220:223], v[236:239]
s_add_u32 m0, s74, 16384
v_exp_f32 v130, v130
v_mfma_f32_16x16x32_bf16 a[32:35], a[192:195], v[196:199], a[32:35]
s_add_u32 s72, s81, 16384
ds_read_b128 a[132:135], v2 offset:17408
v_cvt_pk_bf16_f32 v192, v128, v129
v_mfma_f32_16x16x32_bf16 a[32:35], a[224:227], v[212:215], a[32:35]
v_exp_f32 v131, v131
v_mfma_f32_16x16x32_bf16 a[96:99], a[224:227], v[220:223], a[96:99]
v_exp_f32 v144, v144
v_mfma_f32_16x16x32_bf16 a[96:99], a[192:195], v[204:207], a[96:99]
ds_read_b128 a[136:139], v2 offset:18432
v_cvt_pk_bf16_f32 v193, v130, v131
v_mfma_f32_16x16x32_bf16 a[100:103], a[196:199], v[204:207], a[100:103]
buffer_load_dwordx4 v1, s[44:47], s72 offen sc1 lds
v_mfma_f32_16x16x32_bf16 a[100:103], a[228:231], v[220:223], a[100:103]
v_exp_f32 v145, v145
v_mfma_f32_16x16x32_bf16 a[36:39], a[228:231], v[212:215], a[36:39]
v_exp_f32 v146, v146
v_mfma_f32_16x16x32_bf16 a[36:39], a[196:199], v[196:199], a[36:39]
ds_read_b128 a[140:143], v2 offset:19456
v_cvt_pk_bf16_f32 v194, v144, v145
v_mfma_f32_16x16x32_bf16 a[40:43], a[200:203], v[196:199], a[40:43]
v_exp_f32 v147, v147
v_mfma_f32_16x16x32_bf16 a[40:43], a[232:235], v[212:215], a[40:43]
v_exp_f32 v136, v136
v_mfma_f32_16x16x32_bf16 a[104:107], a[232:235], v[220:223], a[104:107]
ds_read_b128 a[144:147], v2 offset:20480
v_cvt_pk_bf16_f32 v195, v146, v147
v_mfma_f32_16x16x32_bf16 a[104:107], a[200:203], v[204:207], a[104:107]
v_exp_f32 v137, v137
v_mfma_f32_16x16x32_bf16 a[108:111], a[204:207], v[204:207], a[108:111]
v_exp_f32 v138, v138
v_mfma_f32_16x16x32_bf16 a[108:111], a[236:239], v[220:223], a[108:111]
ds_read_b128 a[148:151], v2 offset:21504
v_cvt_pk_bf16_f32 v200, v136, v137
v_mfma_f32_16x16x32_bf16 a[44:47], a[236:239], v[212:215], a[44:47]
v_exp_f32 v139, v139
v_mfma_f32_16x16x32_bf16 a[44:47], a[204:207], v[196:199], a[44:47]
v_exp_f32 v152, v152
v_mfma_f32_16x16x32_bf16 a[48:51], a[208:211], v[196:199], a[48:51]
s_waitcnt lgkmcnt(6)
ds_read_b128 a[152:155], v2 offset:22528
v_cvt_pk_bf16_f32 v201, v138, v139
v_mfma_f32_16x16x32_bf16 a[48:51], a[240:243], v[212:215], a[48:51]
buffer_load_dwordx4 v1, s[44:47], s72 offen offset:1024 sc1 lds
v_mfma_f32_16x16x32_bf16 a[112:115], a[240:243], v[220:223], a[112:115]
v_exp_f32 v153, v153
v_mfma_f32_16x16x32_bf16 a[112:115], a[208:211], v[204:207], a[112:115]
v_exp_f32 v154, v154
v_mfma_f32_16x16x32_bf16 a[116:119], a[212:215], v[204:207], a[116:119]
ds_read_b128 a[156:159], v2 offset:23552
v_cvt_pk_bf16_f32 v202, v152, v153
v_mfma_f32_16x16x32_bf16 a[116:119], a[244:247], v[220:223], a[116:119]
v_exp_f32 v155, v155
v_mfma_f32_16x16x32_bf16 a[52:55], a[244:247], v[212:215], a[52:55]
v_exp_f32 v132, v132
v_mfma_f32_16x16x32_bf16 a[52:55], a[212:215], v[196:199], a[52:55]
ds_read_b128 a[192:195], v2 offset:0
v_cvt_pk_bf16_f32 v203, v154, v155
v_mfma_f32_16x16x32_bf16 a[56:59], a[216:219], v[196:199], a[56:59]
v_exp_f32 v133, v133
v_mfma_f32_16x16x32_bf16 a[56:59], a[248:251], v[212:215], a[56:59]
v_exp_f32 v134, v134
v_mfma_f32_16x16x32_bf16 a[120:123], a[248:251], v[220:223], a[120:123]
ds_read_b128 a[196:199], v2 offset:1024
v_mfma_f32_16x16x32_bf16 a[120:123], a[216:219], v[204:207], a[120:123]
v_exp_f32 v135, v135
v_mfma_f32_16x16x32_bf16 a[124:127], a[220:223], v[204:207], a[124:127]
v_exp_f32 v148, v148
v_mfma_f32_16x16x32_bf16 a[124:127], a[252:255], v[220:223], a[124:127]
ds_read_b128 a[200:203], v2 offset:2048
v_mfma_f32_16x16x32_bf16 a[60:63], a[252:255], v[212:215], a[60:63]
buffer_load_dwordx4 v1, s[44:47], s72 offen offset:2048 sc1 lds
v_mfma_f32_16x16x32_bf16 a[60:63], a[220:223], v[196:199], a[60:63]
ds_read_b128 a[204:207], v2 offset:3072
v_cvt_pk_bf16_f32 v196, v132, v133
v_mfma_f32_16x16x32_bf16 v[164:167], a[160:163], v[32:35], v[84:87]
v_exp_f32 v149, v149
v_mfma_f32_16x16x32_bf16 v[164:167], a[164:167], v[36:39], v[164:167]
v_exp_f32 v150, v150
v_mfma_f32_16x16x32_bf16 v[164:167], a[168:171], v[40:43], v[164:167]
ds_read_b128 a[208:211], v2 offset:4096
v_cvt_pk_bf16_f32 v197, v134, v135
v_mfma_f32_16x16x32_bf16 v[164:167], a[172:175], v[44:47], v[164:167]
v_exp_f32 v151, v151
v_mfma_f32_16x16x32_bf16 v[172:175], a[172:175], v[76:79], v[92:95]
v_exp_f32 v140, v140
v_mfma_f32_16x16x32_bf16 v[172:175], a[168:171], v[72:75], v[172:175]
ds_read_b128 a[212:215], v2 offset:5120
v_cvt_pk_bf16_f32 v198, v148, v149
v_mfma_f32_16x16x32_bf16 v[172:175], a[164:167], v[68:71], v[172:175]
v_exp_f32 v141, v141
v_mfma_f32_16x16x32_bf16 v[172:175], a[160:163], v[64:67], v[172:175]
v_exp_f32 v142, v142
v_mfma_f32_16x16x32_bf16 v[188:191], a[176:179], v[64:67], v[92:95]
ds_read_b128 a[216:219], v2 offset:6144
v_cvt_pk_bf16_f32 v199, v150, v151
v_mfma_f32_16x16x32_bf16 v[188:191], a[180:183], v[68:71], v[188:191]
v_exp_f32 v143, v143
v_mfma_f32_16x16x32_bf16 v[188:191], a[184:187], v[72:75], v[188:191]
v_exp_f32 v156, v156
v_mfma_f32_16x16x32_bf16 v[188:191], a[188:191], v[76:79], v[188:191]
ds_read_b128 a[220:223], v2 offset:7168
v_cvt_pk_bf16_f32 v204, v140, v141
v_mfma_f32_16x16x32_bf16 v[180:183], a[188:191], v[44:47], v[84:87]
buffer_load_dwordx4 v1, s[44:47], s72 offen offset:3072 sc1 lds
v_mfma_f32_16x16x32_bf16 v[180:183], a[184:187], v[40:43], v[180:183]
v_exp_f32 v157, v157
v_mfma_f32_16x16x32_bf16 v[180:183], a[180:183], v[36:39], v[180:183]
v_exp_f32 v158, v158
v_mfma_f32_16x16x32_bf16 v[180:183], a[176:179], v[32:35], v[180:183]
v_cvt_pk_bf16_f32 v205, v142, v143
v_cvt_pk_bf16_f32 v206, v156, v157
v_mfma_f32_16x16x32_bf16 v[160:163], a[160:163], v[16:19], v[80:83]
v_exp_f32 v159, v159
v_mfma_f32_16x16x32_bf16 v[160:163], a[164:167], v[20:23], v[160:163]
v_cvt_pk_bf16_f32 v207, v158, v159
v_mfma_f32_16x16x32_bf16 v[160:163], a[168:171], v[24:27], v[160:163]
v_mfma_f32_16x16x32_bf16 v[160:163], a[172:175], v[28:31], v[160:163]
v_mfma_f32_16x16x32_bf16 v[168:171], a[172:175], v[60:63], v[88:91]
v_mfma_f32_16x16x32_bf16 v[168:171], a[168:171], v[56:59], v[168:171]
v_mfma_f32_16x16x32_bf16 v[168:171], a[164:167], v[52:55], v[168:171]
v_mfma_f32_16x16x32_bf16 v[168:171], a[160:163], v[48:51], v[168:171]
v_mfma_f32_16x16x32_bf16 v[184:187], a[176:179], v[48:51], v[88:91]
v_mfma_f32_16x16x32_bf16 v[184:187], a[180:183], v[52:55], v[184:187]
v_mfma_f32_16x16x32_bf16 v[184:187], a[184:187], v[56:59], v[184:187]
v_mfma_f32_16x16x32_bf16 v[184:187], a[188:191], v[60:63], v[184:187]
v_mfma_f32_16x16x32_bf16 v[176:179], a[188:191], v[28:31], v[80:83]
v_mfma_f32_16x16x32_bf16 v[176:179], a[184:187], v[24:27], v[176:179]
v_mfma_f32_16x16x32_bf16 v[176:179], a[180:183], v[20:23], v[176:179]
v_mfma_f32_16x16x32_bf16 v[176:179], a[176:179], v[16:19], v[176:179]
s_waitcnt lgkmcnt(4)
v_mfma_f32_16x16x32_bf16 v[224:227], v[120:123], v[208:211], v[224:227]
s_add_u32 s82, s82, 0x8000
ds_read_b128 a[160:163], v2 offset:24576
v_mfma_f32_16x16x32_bf16 v[224:227], v[120:123], v[192:195], v[224:227]
s_and_b32 s82, s82, 0x1ffff
v_exp_f32 v164, v164
v_mfma_f32_16x16x32_bf16 v[232:235], v[120:123], v[216:219], v[232:235]
s_add_u32 m0, s74, 0
v_exp_f32 v165, v165
v_mfma_f32_16x16x32_bf16 v[232:235], v[120:123], v[200:203], v[232:235]
s_add_u32 s72, s81, 0
ds_read_b128 a[164:167], v2 offset:25600
v_cvt_pk_bf16_f32 v212, v164, v165
v_mfma_f32_16x16x32_bf16 a[0:3], a[224:227], v[208:211], a[0:3]
v_exp_f32 v166, v166
v_mfma_f32_16x16x32_bf16 a[0:3], a[192:195], v[192:195], a[0:3]
v_exp_f32 v167, v167
v_mfma_f32_16x16x32_bf16 a[64:67], a[192:195], v[200:203], a[64:67]
buffer_load_dwordx4 v1, s[44:47], s72 offen sc1 lds
v_mfma_f32_16x16x32_bf16 a[64:67], a[224:227], v[216:219], a[64:67]
ds_read_b128 a[168:171], v2 offset:26624
v_cvt_pk_bf16_f32 v213, v166, v167
v_mfma_f32_16x16x32_bf16 a[68:71], a[228:231], v[216:219], a[68:71]
v_exp_f32 v180, v180
v_mfma_f32_16x16x32_bf16 a[68:71], a[196:199], v[200:203], a[68:71]
v_exp_f32 v181, v181
v_mfma_f32_16x16x32_bf16 a[4:7], a[196:199], v[192:195], a[4:7]
ds_read_b128 a[172:175], v2 offset:27648
v_cvt_pk_bf16_f32 v214, v180, v181
v_mfma_f32_16x16x32_bf16 a[4:7], a[228:231], v[208:211], a[4:7]
v_exp_f32 v182, v182
v_mfma_f32_16x16x32_bf16 a[8:11], a[232:235], v[208:211], a[8:11]
v_exp_f32 v183, v183
v_mfma_f32_16x16x32_bf16 a[8:11], a[200:203], v[192:195], a[8:11]
ds_read_b128 a[176:179], v2 offset:28672
v_cvt_pk_bf16_f32 v215, v182, v183
v_mfma_f32_16x16x32_bf16 a[72:75], a[200:203], v[200:203], a[72:75]
v_exp_f32 v172, v172
v_mfma_f32_16x16x32_bf16 a[72:75], a[232:235], v[216:219], a[72:75]
v_exp_f32 v173, v173
v_mfma_f32_16x16x32_bf16 a[76:79], a[236:239], v[216:219], a[76:79]
ds_read_b128 a[180:183], v2 offset:29696
v_cvt_pk_bf16_f32 v220, v172, v173
v_mfma_f32_16x16x32_bf16 a[76:79], a[204:207], v[200:203], a[76:79]
buffer_load_dwordx4 v1, s[44:47], s72 offen offset:1024 sc1 lds
v_mfma_f32_16x16x32_bf16 a[12:15], a[204:207], v[192:195], a[12:15]
v_exp_f32 v174, v174
v_mfma_f32_16x16x32_bf16 a[12:15], a[236:239], v[208:211], a[12:15]
v_exp_f32 v175, v175
v_mfma_f32_16x16x32_bf16 a[16:19], a[240:243], v[208:211], a[16:19]
s_waitcnt lgkmcnt(6)
ds_read_b128 a[184:187], v2 offset:30720
v_cvt_pk_bf16_f32 v221, v174, v175
v_mfma_f32_16x16x32_bf16 a[16:19], a[208:211], v[192:195], a[16:19]
v_exp_f32 v188, v188
v_mfma_f32_16x16x32_bf16 a[80:83], a[208:211], v[200:203], a[80:83]
v_exp_f32 v189, v189
v_mfma_f32_16x16x32_bf16 a[80:83], a[240:243], v[216:219], a[80:83]
ds_read_b128 a[188:191], v2 offset:31744
v_cvt_pk_bf16_f32 v222, v188, v189
v_mfma_f32_16x16x32_bf16 a[84:87], a[244:247], v[216:219], a[84:87]
v_exp_f32 v190, v190
v_mfma_f32_16x16x32_bf16 a[84:87], a[212:215], v[200:203], a[84:87]
v_exp_f32 v191, v191
v_mfma_f32_16x16x32_bf16 a[20:23], a[212:215], v[192:195], a[20:23]
ds_read_b128 a[224:227], v2 offset:8192
v_cvt_pk_bf16_f32 v223, v190, v191
v_mfma_f32_16x16x32_bf16 a[20:23], a[244:247], v[208:211], a[20:23]
v_exp_f32 v160, v160
v_mfma_f32_16x16x32_bf16 a[24:27], a[248:251], v[208:211], a[24:27]
buffer_load_dwordx4 v1, s[44:47], s72 offen offset:2048 sc1 lds
v_mfma_f32_16x16x32_bf16 a[24:27], a[216:219], v[192:195], a[24:27]
v_exp_f32 v161, v161
v_mfma_f32_16x16x32_bf16 a[88:91], a[216:219], v[200:203], a[88:91]
ds_read_b128 a[228:231], v2 offset:9216
v_mfma_f32_16x16x32_bf16 a[88:91], a[248:251], v[216:219], a[88:91]
v_exp_f32 v162, v162
v_mfma_f32_16x16x32_bf16 a[92:95], a[252:255], v[216:219], a[92:95]
v_exp_f32 v163, v163
v_mfma_f32_16x16x32_bf16 a[92:95], a[220:223], v[200:203], a[92:95]
ds_read_b128 a[232:235], v2 offset:10240
v_mfma_f32_16x16x32_bf16 a[28:31], a[220:223], v[192:195], a[28:31]
v_exp_f32 v176, v176
v_mfma_f32_16x16x32_bf16 a[28:31], a[252:255], v[208:211], a[28:31]
ds_read_b128 a[236:239], v2 offset:11264
v_cvt_pk_bf16_f32 v208, v160, v161
v_mfma_f32_16x16x32_bf16 v[128:131], a[128:131], v[16:19], v[80:83]
v_exp_f32 v177, v177
v_mfma_f32_16x16x32_bf16 v[128:131], a[132:135], v[20:23], v[128:131]
v_exp_f32 v178, v178
v_mfma_f32_16x16x32_bf16 v[128:131], a[136:139], v[24:27], v[128:131]
ds_read_b128 a[240:243], v2 offset:12288
v_cvt_pk_bf16_f32 v209, v162, v163
v_mfma_f32_16x16x32_bf16 v[128:131], a[140:143], v[28:31], v[128:131]
buffer_load_dwordx4 v1, s[44:47], s72 offen offset:3072 sc1 lds
v_mfma_f32_16x16x32_bf16 v[136:139], a[140:143], v[60:63], v[88:91]
s_add_u32 s75, s75, 0x1000
v_exp_f32 v179, v179
v_mfma_f32_16x16x32_bf16 v[136:139], a[136:139], v[56:59], v[136:139]
s_and_b32 s76, s75, 0x3000
v_exp_f32 v168, v168
v_mfma_f32_16x16x32_bf16 v[136:139], a[132:135], v[52:55], v[136:139]
s_cselect_b32 s75, s75, 0x40001000
ds_read_b128 a[244:247], v2 offset:13312
v_cvt_pk_bf16_f32 v210, v176, v177
v_mfma_f32_16x16x32_bf16 v[136:139], a[128:131], v[48:51], v[136:139]
v_exp_f32 v169, v169
v_mfma_f32_16x16x32_bf16 v[152:155], a[144:147], v[48:51], v[88:91]
v_exp_f32 v170, v170
v_mfma_f32_16x16x32_bf16 v[152:155], a[148:151], v[52:55], v[152:155]
ds_read_b128 a[248:251], v2 offset:14336
v_cvt_pk_bf16_f32 v211, v178, v179
v_mfma_f32_16x16x32_bf16 v[152:155], a[152:155], v[56:59], v[152:155]
v_exp_f32 v171, v171
v_mfma_f32_16x16x32_bf16 v[152:155], a[156:159], v[60:63], v[152:155]
v_exp_f32 v184, v184
v_mfma_f32_16x16x32_bf16 v[144:147], a[156:159], v[28:31], v[80:83]
ds_read_b128 a[252:255], v2 offset:15360
v_cvt_pk_bf16_f32 v216, v168, v169
v_mfma_f32_16x16x32_bf16 v[144:147], a[152:155], v[24:27], v[144:147]
buffer_load_dword v4, v15, s[24:27], 0 offen
v_mfma_f32_16x16x32_bf16 v[144:147], a[148:151], v[20:23], v[144:147]
v_exp_f32 v185, v185
v_mfma_f32_16x16x32_bf16 v[144:147], a[144:147], v[16:19], v[144:147]
v_exp_f32 v186, v186
v_mfma_f32_16x16x32_bf16 v[132:135], a[128:131], v[32:35], v[84:87]
v_cvt_pk_bf16_f32 v217, v170, v171
v_cvt_pk_bf16_f32 v218, v184, v185
v_mfma_f32_16x16x32_bf16 v[132:135], a[132:135], v[36:39], v[132:135]
v_exp_f32 v187, v187
v_mfma_f32_16x16x32_bf16 v[132:135], a[136:139], v[40:43], v[132:135]
v_cvt_pk_bf16_f32 v219, v186, v187
v_add_u32 v2, s82, v1
v_mfma_f32_16x16x32_bf16 v[132:135], a[140:143], v[44:47], v[132:135]
v_mfma_f32_16x16x32_bf16 v[140:143], a[140:143], v[76:79], v[92:95]
v_mfma_f32_16x16x32_bf16 v[140:143], a[136:139], v[72:75], v[140:143]
v_mfma_f32_16x16x32_bf16 v[140:143], a[132:135], v[68:71], v[140:143]
v_mfma_f32_16x16x32_bf16 v[140:143], a[128:131], v[64:67], v[140:143]
v_mfma_f32_16x16x32_bf16 v[156:159], a[144:147], v[64:67], v[92:95]
v_mfma_f32_16x16x32_bf16 v[156:159], a[148:151], v[68:71], v[156:159]
v_mfma_f32_16x16x32_bf16 v[156:159], a[152:155], v[72:75], v[156:159]
v_mfma_f32_16x16x32_bf16 v[156:159], a[156:159], v[76:79], v[156:159]
v_mfma_f32_16x16x32_bf16 v[148:151], a[156:159], v[44:47], v[84:87]
s_waitcnt vmcnt(9) lgkmcnt(4)
v_mfma_f32_16x16x32_bf16 v[148:151], a[152:155], v[40:43], v[148:151]
s_barrier
v_mfma_f32_16x16x32_bf16 v[148:151], a[148:151], v[36:39], v[148:151]
s_add_u32 s83, s83, 1
v_mfma_f32_16x16x32_bf16 v[148:151], a[144:147], v[32:35], v[148:151]
s_cbranch_scc0 LloopI
LLT1:
Lstub2:
s_cbranch_execz Lstub6
v_mfma_f32_16x16x32_bf16 v[228:231], v[120:123], v[196:199], v[228:231]
s_xor_b32 s74, s82, 0x10000
v_exp_f32 v128, v128
v_mfma_f32_16x16x32_bf16 v[228:231], v[120:123], v[212:215], v[228:231]
s_add_u32 s74, s74, s64
ds_read_b128 a[128:131], v2 offset:16384
v_mfma_f32_16x16x32_bf16 v[236:239], v[120:123], v[204:207], v[236:239]
s_add_u32 s81, s81, 0x8000
v_exp_f32 v129, v129
v_mfma_f32_16x16x32_bf16 v[236:239], v[120:123], v[220:223], v[236:239]
s_add_u32 m0, s74, 16384
v_exp_f32 v130, v130
v_mfma_f32_16x16x32_bf16 a[32:35], a[192:195], v[196:199], a[32:35]
s_add_u32 s72, s81, 16384
ds_read_b128 a[132:135], v2 offset:17408
v_cvt_pk_bf16_f32 v192, v128, v129
v_mfma_f32_16x16x32_bf16 a[32:35], a[224:227], v[212:215], a[32:35]
v_exp_f32 v131, v131
v_mfma_f32_16x16x32_bf16 a[96:99], a[224:227], v[220:223], a[96:99]
v_exp_f32 v144, v144
v_mfma_f32_16x16x32_bf16 a[96:99], a[192:195], v[204:207], a[96:99]
ds_read_b128 a[136:139], v2 offset:18432
v_cvt_pk_bf16_f32 v193, v130, v131
v_mfma_f32_16x16x32_bf16 a[100:103], a[196:199], v[204:207], a[100:103]
buffer_load_dwordx4 v1, s[44:47], s72 offen sc1 lds
v_mfma_f32_16x16x32_bf16 a[100:103], a[228:231], v[220:223], a[100:103]
v_exp_f32 v145, v145
v_mfma_f32_16x16x32_bf16 a[36:39], a[228:231], v[212:215], a[36:39]
v_exp_f32 v146, v146
v_mfma_f32_16x16x32_bf16 a[36:39], a[196:199], v[196:199], a[36:39]
ds_read_b128 a[140:143], v2 offset:19456
v_cvt_pk_bf16_f32 v194, v144, v145
v_mfma_f32_16x16x32_bf16 a[40:43], a[200:203], v[196:199], a[40:43]
v_exp_f32 v147, v147
v_mfma_f32_16x16x32_bf16 a[40:43], a[232:235], v[212:215], a[40:43]
v_exp_f32 v136, v136
v_mfma_f32_16x16x32_bf16 a[104:107], a[232:235], v[220:223], a[104:107]
ds_read_b128 a[144:147], v2 offset:20480
v_cvt_pk_bf16_f32 v195, v146, v147
v_mfma_f32_16x16x32_bf16 a[104:107], a[200:203], v[204:207], a[104:107]
v_exp_f32 v137, v137
v_mfma_f32_16x16x32_bf16 a[108:111], a[204:207], v[204:207], a[108:111]
v_exp_f32 v138, v138
v_mfma_f32_16x16x32_bf16 a[108:111], a[236:239], v[220:223], a[108:111]
ds_read_b128 a[148:151], v2 offset:21504
v_cvt_pk_bf16_f32 v200, v136, v137
v_mfma_f32_16x16x32_bf16 a[44:47], a[236:239], v[212:215], a[44:47]
v_exp_f32 v139, v139
v_mfma_f32_16x16x32_bf16 a[44:47], a[204:207], v[196:199], a[44:47]
v_exp_f32 v152, v152
v_mfma_f32_16x16x32_bf16 a[48:51], a[208:211], v[196:199], a[48:51]
s_waitcnt lgkmcnt(6)
ds_read_b128 a[152:155], v2 offset:22528
v_cvt_pk_bf16_f32 v201, v138, v139
v_mfma_f32_16x16x32_bf16 a[48:51], a[240:243], v[212:215], a[48:51]
buffer_load_dwordx4 v1, s[44:47], s72 offen offset:1024 sc1 lds
v_mfma_f32_16x16x32_bf16 a[112:115], a[240:243], v[220:223], a[112:115]
v_exp_f32 v153, v153
v_mfma_f32_16x16x32_bf16 a[112:115], a[208:211], v[204:207], a[112:115]
v_exp_f32 v154, v154
v_mfma_f32_16x16x32_bf16 a[116:119], a[212:215], v[204:207], a[116:119]
ds_read_b128 a[156:159], v2 offset:23552
v_cvt_pk_bf16_f32 v202, v152, v153
v_mfma_f32_16x16x32_bf16 a[116:119], a[244:247], v[220:223], a[116:119]
v_exp_f32 v155, v155
v_mfma_f32_16x16x32_bf16 a[52:55], a[244:247], v[212:215], a[52:55]
v_exp_f32 v132, v132
v_mfma_f32_16x16x32_bf16 a[52:55], a[212:215], v[196:199], a[52:55]
ds_read_b128 a[192:195], v2 offset:0
v_cvt_pk_bf16_f32 v203, v154, v155
v_mfma_f32_16x16x32_bf16 a[56:59], a[216:219], v[196:199], a[56:59]
v_exp_f32 v133, v133
v_mfma_f32_16x16x32_bf16 a[56:59], a[248:251], v[212:215], a[56:59]
v_exp_f32 v134, v134
v_mfma_f32_16x16x32_bf16 a[120:123], a[248:251], v[220:223], a[120:123]
ds_read_b128 a[196:199], v2 offset:1024
v_mfma_f32_16x16x32_bf16 a[120:123], a[216:219], v[204:207], a[120:123]
v_exp_f32 v135, v135
v_mfma_f32_16x16x32_bf16 a[124:127], a[220:223], v[204:207], a[124:127]
v_exp_f32 v148, v148
v_mfma_f32_16x16x32_bf16 a[124:127], a[252:255], v[220:223], a[124:127]
ds_read_b128 a[200:203], v2 offset:2048
v_mfma_f32_16x16x32_bf16 a[60:63], a[252:255], v[212:215], a[60:63]
buffer_load_dwordx4 v1, s[44:47], s72 offen offset:2048 sc1 lds
v_mfma_f32_16x16x32_bf16 a[60:63], a[220:223], v[196:199], a[60:63]
ds_read_b128 a[204:207], v2 offset:3072
v_cvt_pk_bf16_f32 v196, v132, v133
v_mfma_f32_16x16x32_bf16 v[164:167], a[160:163], v[32:35], v[84:87]
v_exp_f32 v149, v149
v_mfma_f32_16x16x32_bf16 v[164:167], a[164:167], v[36:39], v[164:167]
v_exp_f32 v150, v150
v_mfma_f32_16x16x32_bf16 v[164:167], a[168:171], v[40:43], v[164:167]
ds_read_b128 a[208:211], v2 offset:4096
v_cvt_pk_bf16_f32 v197, v134, v135
v_mfma_f32_16x16x32_bf16 v[164:167], a[172:175], v[44:47], v[164:167]
v_exp_f32 v151, v151
v_mfma_f32_16x16x32_bf16 v[172:175], a[172:175], v[76:79], v[92:95]
v_exp_f32 v140, v140
v_mfma_f32_16x16x32_bf16 v[172:175], a[168:171], v[72:75], v[172:175]
ds_read_b128 a[212:215], v2 offset:5120
v_cvt_pk_bf16_f32 v198, v148, v149
v_mfma_f32_16x16x32_bf16 v[172:175], a[164:167], v[68:71], v[172:175]
v_exp_f32 v141, v141
v_mfma_f32_16x16x32_bf16 v[172:175], a[160:163], v[64:67], v[172:175]
v_exp_f32 v142, v142
v_mfma_f32_16x16x32_bf16 v[188:191], a[176:179], v[64:67], v[92:95]
ds_read_b128 a[216:219], v2 offset:6144
v_cvt_pk_bf16_f32 v199, v150, v151
v_mfma_f32_16x16x32_bf16 v[188:191], a[180:183], v[68:71], v[188:191]
v_exp_f32 v143, v143
v_mfma_f32_16x16x32_bf16 v[188:191], a[184:187], v[72:75], v[188:191]
v_exp_f32 v156, v156
v_mfma_f32_16x16x32_bf16 v[188:191], a[188:191], v[76:79], v[188:191]
ds_read_b128 a[220:223], v2 offset:7168
v_cvt_pk_bf16_f32 v204, v140, v141
v_mfma_f32_16x16x32_bf16 v[180:183], a[188:191], v[44:47], v[84:87]
buffer_load_dwordx4 v1, s[44:47], s72 offen offset:3072 sc1 lds
v_mfma_f32_16x16x32_bf16 v[180:183], a[184:187], v[40:43], v[180:183]
v_exp_f32 v157, v157
v_mfma_f32_16x16x32_bf16 v[180:183], a[180:183], v[36:39], v[180:183]
v_exp_f32 v158, v158
v_mfma_f32_16x16x32_bf16 v[180:183], a[176:179], v[32:35], v[180:183]
v_cvt_pk_bf16_f32 v205, v142, v143
v_cvt_pk_bf16_f32 v206, v156, v157
v_mfma_f32_16x16x32_bf16 v[160:163], a[160:163], v[16:19], v[80:83]
v_exp_f32 v159, v159
v_mfma_f32_16x16x32_bf16 v[160:163], a[164:167], v[20:23], v[160:163]
v_cvt_pk_bf16_f32 v207, v158, v159
v_mfma_f32_16x16x32_bf16 v[160:163], a[168:171], v[24:27], v[160:163]
v_mfma_f32_16x16x32_bf16 v[160:163], a[172:175], v[28:31], v[160:163]
v_mfma_f32_16x16x32_bf16 v[168:171], a[172:175], v[60:63], v[88:91]
v_mfma_f32_16x16x32_bf16 v[168:171], a[168:171], v[56:59], v[168:171]
v_mfma_f32_16x16x32_bf16 v[168:171], a[164:167], v[52:55], v[168:171]
v_mfma_f32_16x16x32_bf16 v[168:171], a[160:163], v[48:51], v[168:171]
v_mfma_f32_16x16x32_bf16 v[184:187], a[176:179], v[48:51], v[88:91]
v_mfma_f32_16x16x32_bf16 v[184:187], a[180:183], v[52:55], v[184:187]
v_mfma_f32_16x16x32_bf16 v[184:187], a[184:187], v[56:59], v[184:187]
v_mfma_f32_16x16x32_bf16 v[184:187], a[188:191], v[60:63], v[184:187]
v_mfma_f32_16x16x32_bf16 v[176:179], a[188:191], v[28:31], v[80:83]
v_mfma_f32_16x16x32_bf16 v[176:179], a[184:187], v[24:27], v[176:179]
v_mfma_f32_16x16x32_bf16 v[176:179], a[180:183], v[20:23], v[176:179]
v_mfma_f32_16x16x32_bf16 v[176:179], a[176:179], v[16:19], v[176:179]
s_waitcnt lgkmcnt(4)
v_mfma_f32_16x16x32_bf16 v[224:227], v[120:123], v[208:211], v[224:227]
s_add_u32 s82, s82, 0x8000
ds_read_b128 a[160:163], v2 offset:24576
v_mfma_f32_16x16x32_bf16 v[224:227], v[120:123], v[192:195], v[224:227]
s_and_b32 s82, s82, 0x1ffff
v_exp_f32 v164, v164
v_mfma_f32_16x16x32_bf16 v[232:235], v[120:123], v[216:219], v[232:235]
s_add_u32 m0, s74, 0
v_exp_f32 v165, v165
v_mfma_f32_16x16x32_bf16 v[232:235], v[120:123], v[200:203], v[232:235]
s_add_u32 s72, s81, 0
ds_read_b128 a[164:167], v2 offset:25600
v_cvt_pk_bf16_f32 v212, v164, v165
v_mfma_f32_16x16x32_bf16 a[0:3], a[224:227], v[208:211], a[0:3]
v_exp_f32 v166, v166
v_mfma_f32_16x16x32_bf16 a[0:3], a[192:195], v[192:195], a[0:3]
v_exp_f32 v167, v167
v_mfma_f32_16x16x32_bf16 a[64:67], a[192:195], v[200:203], a[64:67]
ds_read_b128 a[168:171], v2 offset:26624
v_cvt_pk_bf16_f32 v213, v166, v167
v_mfma_f32_16x16x32_bf16 a[64:67], a[224:227], v[216:219], a[64:67]
v_exp_f32 v180, v180
v_mfma_f32_16x16x32_bf16 a[68:71], a[228:231], v[216:219], a[68:71]
buffer_load_dwordx4 v1, s[44:47], s72 offen sc1 lds
v_mfma_f32_16x16x32_bf16 a[68:71], a[196:199], v[200:203], a[68:71]
v_exp_f32 v181, v181
v_mfma_f32_16x16x32_bf16 a[4:7], a[196:199], v[192:195], a[4:7]
ds_read_b128 a[172:175], v2 offset:27648
v_cvt_pk_bf16_f32 v214, v180, v181
v_mfma_f32_16x16x32_bf16 a[4:7], a[228:231], v[208:211], a[4:7]
v_exp_f32 v182, v182
v_mfma_f32_16x16x32_bf16 a[8:11], a[232:235], v[208:211], a[8:11]
v_exp_f32 v183, v183
v_mfma_f32_16x16x32_bf16 a[8:11], a[200:203], v[192:195], a[8:11]
ds_read_b128 a[176:179], v2 offset:28672
v_cvt_pk_bf16_f32 v215, v182, v183
v_mfma_f32_16x16x32_bf16 a[72:75], a[200:203], v[200:203], a[72:75]
v_exp_f32 v172, v172
v_mfma_f32_16x16x32_bf16 a[72:75], a[232:235], v[216:219], a[72:75]
v_exp_f32 v173, v173
v_mfma_f32_16x16x32_bf16 a[76:79], a[236:239], v[216:219], a[76:79]
ds_read_b128 a[180:183], v2 offset:29696
v_cvt_pk_bf16_f32 v220, v172, v173
v_mfma_f32_16x16x32_bf16 a[76:79], a[204:207], v[200:203], a[76:79]
v_exp_f32 v174, v174
v_mfma_f32_16x16x32_bf16 a[12:15], a[204:207], v[192:195], a[12:15]
v_exp_f32 v175, v175
v_mfma_f32_16x16x32_bf16 a[12:15], a[236:239], v[208:211], a[12:15]
ds_read_b128 a[184:187], v2 offset:30720
v_cvt_pk_bf16_f32 v221, v174, v175
v_mfma_f32_16x16x32_bf16 a[16:19], a[240:243], v[208:211], a[16:19]
s_waitcnt lgkmcnt(7)
v_exp_f32 v188, v188
v_mfma_f32_16x16x32_bf16 a[16:19], a[208:211], v[192:195], a[16:19]
buffer_load_dwordx4 v1, s[44:47], s72 offen offset:1024 sc1 lds
v_mfma_f32_16x16x32_bf16 a[80:83], a[208:211], v[200:203], a[80:83]
v_exp_f32 v189, v189
v_mfma_f32_16x16x32_bf16 a[80:83], a[240:243], v[216:219], a[80:83]
ds_read_b128 a[188:191], v2 offset:31744
v_cvt_pk_bf16_f32 v222, v188, v189
v_mfma_f32_16x16x32_bf16 a[84:87], a[244:247], v[216:219], a[84:87]
v_exp_f32 v190, v190
v_mfma_f32_16x16x32_bf16 a[84:87], a[212:215], v[200:203], a[84:87]
v_exp_f32 v191, v191
v_mfma_f32_16x16x32_bf16 a[20:23], a[212:215], v[192:195], a[20:23]
ds_read_b128 a[224:227], v2 offset:8192
v_cvt_pk_bf16_f32 v223, v190, v191
v_mfma_f32_16x16x32_bf16 a[20:23], a[244:247], v[208:211], a[20:23]
v_exp_f32 v160, v160
v_mfma_f32_16x16x32_bf16 a[24:27], a[248:251], v[208:211], a[24:27]
v_exp_f32 v161, v161
v_mfma_f32_16x16x32_bf16 a[24:27], a[216:219], v[192:195], a[24:27]
ds_read_b128 a[228:231], v2 offset:9216
v_mfma_f32_16x16x32_bf16 a[88:91], a[216:219], v[200:203], a[88:91]
v_exp_f32 v162, v162
v_mfma_f32_16x16x32_bf16 a[88:91], a[248:251], v[216:219], a[88:91]
v_exp_f32 v163, v163
v_mfma_f32_16x16x32_bf16 a[92:95], a[252:255], v[216:219], a[92:95]
ds_read_b128 a[232:235], v2 offset:10240
v_mfma_f32_16x16x32_bf16 a[92:95], a[220:223], v[200:203], a[92:95]
v_exp_f32 v176, v176
v_mfma_f32_16x16x32_bf16 a[28:31], a[220:223], v[192:195], a[28:31]
buffer_load_dwordx4 v1, s[44:47], s72 offen offset:2048 sc1 lds
v_mfma_f32_16x16x32_bf16 a[28:31], a[252:255], v[208:211], a[28:31]
ds_read_b128 a[236:239], v2 offset:11264
v_cvt_pk_bf16_f32 v208, v160, v161
s_cmp_eq_u32 s58, 0
s_cbranch_scc1 Lta16
s_cmp_eq_u32 s58, 1
s_cbranch_scc1 Lnt17
v_mfma_f32_16x16x32_bf16 v[128:131], a[128:131], v[16:19], v[80:83]
v_exp_f32 v177, v177
v_mfma_f32_16x16x32_bf16 v[144:147], a[144:147], v[16:19], v[80:83]
v_exp_f32 v178, v178
s_branch Ljoin18
Lta16:
v_mfma_f32_16x16x32_bf16 v[128:131], a[128:131], v[16:19], v[96:99]
v_exp_f32 v177, v177
v_mfma_f32_16x16x32_bf16 v[144:147], a[144:147], v[16:19], v[112:115]
Lstub3:
s_cbranch_execz Lstub7
v_exp_f32 v178, v178
s_branch Ljoin18
Lnt17:
v_mfma_f32_16x16x32_bf16 v[128:131], a[128:131], v[16:19], v[80:83]
v_exp_f32 v177, v177
v_mfma_f32_16x16x32_bf16 v[144:147], a[144:147], v[16:19], v[96:99]
v_exp_f32 v178, v178
Ljoin18:
v_mfma_f32_16x16x32_bf16 v[128:131], a[132:135], v[20:23], v[128:131]
ds_read_b128 a[240:243], v2 offset:12288
v_cvt_pk_bf16_f32 v209, v162, v163
v_mfma_f32_16x16x32_bf16 v[128:131], a[136:139], v[24:27], v[128:131]
v_exp_f32 v179, v179
v_mfma_f32_16x16x32_bf16 v[128:131], a[140:143], v[28:31], v[128:131]
v_exp_f32 v168, v168
v_mfma_f32_16x16x32_bf16 v[136:139], a[140:143], v[60:63], v[88:91]
ds_read_b128 a[244:247], v2 offset:13312
v_cvt_pk_bf16_f32 v210, v176, v177
v_mfma_f32_16x16x32_bf16 v[136:139], a[136:139], v[56:59], v[136:139]
v_exp_f32 v169, v169
v_mfma_f32_16x16x32_bf16 v[136:139], a[132:135], v[52:55], v[136:139]
v_exp_f32 v170, v170
v_mfma_f32_16x16x32_bf16 v[136:139], a[128:131], v[48:51], v[136:139]
ds_read_b128 a[248:251], v2 offset:14336
v_cvt_pk_bf16_f32 v211, v178, v179
v_mfma_f32_16x16x32_bf16 v[152:155], a[144:147], v[48:51], v[88:91]
v_exp_f32 v171, v171
v_mfma_f32_16x16x32_bf16 v[152:155], a[148:151], v[52:55], v[152:155]
v_exp_f32 v184, v184
v_mfma_f32_16x16x32_bf16 v[152:155], a[152:155], v[56:59], v[152:155]
ds_read_b128 a[252:255], v2 offset:15360
v_cvt_pk_bf16_f32 v216, v168, v169
v_mfma_f32_16x16x32_bf16 v[152:155], a[156:159], v[60:63], v[152:155]
buffer_load_dwordx4 v1, s[44:47], s72 offen offset:3072 sc1 lds
v_mfma_f32_16x16x32_bf16 v[144:147], a[156:159], v[28:31], v[144:147]
v_exp_f32 v185, v185
v_mfma_f32_16x16x32_bf16 v[144:147], a[152:155], v[24:27], v[144:147]
v_exp_f32 v186, v186
v_mfma_f32_16x16x32_bf16 v[144:147], a[148:151], v[20:23], v[144:147]
v_cvt_pk_bf16_f32 v217, v170, v171
v_cvt_pk_bf16_f32 v218, v184, v185
v_mfma_f32_16x16x32_bf16 v[132:135], a[128:131], v[32:35], v[84:87]
v_exp_f32 v187, v187
v_mfma_f32_16x16x32_bf16 v[132:135], a[132:135], v[36:39], v[132:135]
v_cvt_pk_bf16_f32 v219, v186, v187
v_add_u32 v2, s82, v1
v_mfma_f32_16x16x32_bf16 v[132:135], a[136:139], v[40:43], v[132:135]
v_mfma_f32_16x16x32_bf16 v[132:135], a[140:143], v[44:47], v[132:135]
v_mfma_f32_16x16x32_bf16 v[140:143], a[140:143], v[76:79], v[92:95]
v_mfma_f32_16x16x32_bf16 v[140:143], a[136:139], v[72:75], v[140:143]
v_mfma_f32_16x16x32_bf16 v[140:143], a[132:135], v[68:71], v[140:143]
v_mfma_f32_16x16x32_bf16 v[140:143], a[128:131], v[64:67], v[140:143]
v_mfma_f32_16x16x32_bf16 v[156:159], a[144:147], v[64:67], v[92:95]
v_mfma_f32_16x16x32_bf16 v[156:159], a[148:151], v[68:71], v[156:159]
v_mfma_f32_16x16x32_bf16 v[156:159], a[152:155], v[72:75], v[156:159]
v_mfma_f32_16x16x32_bf16 v[156:159], a[156:159], v[76:79], v[156:159]
v_mfma_f32_16x16x32_bf16 v[148:151], a[156:159], v[44:47], v[84:87]
v_mfma_f32_16x16x32_bf16 v[148:151], a[152:155], v[40:43], v[148:151]
v_mfma_f32_16x16x32_bf16 v[148:151], a[148:151], v[36:39], v[148:151]
s_waitcnt vmcnt(8) lgkmcnt(4)
v_mfma_f32_16x16x32_bf16 v[148:151], a[144:147], v[32:35], v[148:151]
s_barrier
v_mfma_f32_16x16x32_bf16 v[228:231], v[120:123], v[196:199], v[228:231]
s_xor_b32 s74, s82, 0x10000
v_exp_f32 v128, v128
v_mfma_f32_16x16x32_bf16 v[228:231], v[120:123], v[212:215], v[228:231]
s_add_u32 s74, s74, s64
ds_read_b128 a[128:131], v2 offset:16384
v_mfma_f32_16x16x32_bf16 v[236:239], v[120:123], v[204:207], v[236:239]
s_add_u32 s81, s81, 0x8000
v_exp_f32 v129, v129
v_mfma_f32_16x16x32_bf16 v[236:239], v[120:123], v[220:223], v[236:239]
s_add_u32 m0, s74, 16384
v_exp_f32 v130, v130
v_mfma_f32_16x16x32_bf16 a[32:35], a[192:195], v[196:199], a[32:35]
s_add_u32 s72, s81, 16384
ds_read_b128 a[132:135], v2 offset:17408
v_cvt_pk_bf16_f32 v192, v128, v129
v_mfma_f32_16x16x32_bf16 a[32:35], a[224:227], v[212:215], a[32:35]
v_exp_f32 v131, v131
v_mfma_f32_16x16x32_bf16 a[96:99], a[224:227], v[220:223], a[96:99]
v_exp_f32 v144, v144
v_mfma_f32_16x16x32_bf16 a[96:99], a[192:195], v[204:207], a[96:99]
ds_read_b128 a[136:139], v2 offset:18432
v_cvt_pk_bf16_f32 v193, v130, v131
v_mfma_f32_16x16x32_bf16 a[100:103], a[196:199], v[204:207], a[100:103]
buffer_load_dwordx4 v1, s[44:47], s72 offen sc1 lds
v_mfma_f32_16x16x32_bf16 a[100:103], a[228:231], v[220:223], a[100:103]
v_exp_f32 v145, v145
v_mfma_f32_16x16x32_bf16 a[36:39], a[228:231], v[212:215], a[36:39]
v_exp_f32 v146, v146
v_mfma_f32_16x16x32_bf16 a[36:39], a[196:199], v[196:199], a[36:39]
ds_read_b128 a[140:143], v2 offset:19456
v_cvt_pk_bf16_f32 v194, v144, v145
v_mfma_f32_16x16x32_bf16 a[40:43], a[200:203], v[196:199], a[40:43]
v_exp_f32 v147, v147
v_mfma_f32_16x16x32_bf16 a[40:43], a[232:235], v[212:215], a[40:43]
v_exp_f32 v136, v136
v_mfma_f32_16x16x32_bf16 a[104:107], a[232:235], v[220:223], a[104:107]
ds_read_b128 a[144:147], v2 offset:20480
v_cvt_pk_bf16_f32 v195, v146, v147
v_mfma_f32_16x16x32_bf16 a[104:107], a[200:203], v[204:207], a[104:107]
v_exp_f32 v137, v137
v_mfma_f32_16x16x32_bf16 a[108:111], a[204:207], v[204:207], a[108:111]
v_exp_f32 v138, v138
v_mfma_f32_16x16x32_bf16 a[108:111], a[236:239], v[220:223], a[108:111]
ds_read_b128 a[148:151], v2 offset:21504
v_cvt_pk_bf16_f32 v200, v136, v137
v_mfma_f32_16x16x32_bf16 a[44:47], a[236:239], v[212:215], a[44:47]
v_exp_f32 v139, v139
v_mfma_f32_16x16x32_bf16 a[44:47], a[204:207], v[196:199], a[44:47]
v_exp_f32 v152, v152
v_mfma_f32_16x16x32_bf16 a[48:51], a[208:211], v[196:199], a[48:51]
s_waitcnt lgkmcnt(6)
ds_read_b128 a[152:155], v2 offset:22528
v_cvt_pk_bf16_f32 v201, v138, v139
v_mfma_f32_16x16x32_bf16 a[48:51], a[240:243], v[212:215], a[48:51]
buffer_load_dwordx4 v1, s[44:47], s72 offen offset:1024 sc1 lds
v_mfma_f32_16x16x32_bf16 a[112:115], a[240:243], v[220:223], a[112:115]
v_exp_f32 v153, v153
v_mfma_f32_16x16x32_bf16 a[112:115], a[208:211], v[204:207], a[112:115]
v_exp_f32 v154, v154
v_mfma_f32_16x16x32_bf16 a[116:119], a[212:215], v[204:207], a[116:119]
ds_read_b128 a[156:159], v2 offset:23552
v_cvt_pk_bf16_f32 v202, v152, v153
v_mfma_f32_16x16x32_bf16 a[116:119], a[244:247], v[220:223], a[116:119]
v_exp_f32 v155, v155
v_mfma_f32_16x16x32_bf16 a[52:55], a[244:247], v[212:215], a[52:55]
v_exp_f32 v132, v132
v_mfma_f32_16x16x32_bf16 a[52:55], a[212:215], v[196:199], a[52:55]
ds_read_b128 a[192:195], v2 offset:0
v_cvt_pk_bf16_f32 v203, v154, v155
v_mfma_f32_16x16x32_bf16 a[56:59], a[216:219], v[196:199], a[56:59]
v_exp_f32 v133, v133
v_mfma_f32_16x16x32_bf16 a[56:59], a[248:251], v[212:215], a[56:59]
v_exp_f32 v134, v134
v_mfma_f32_16x16x32_bf16 a[120:123], a[248:251], v[220:223], a[120:123]
ds_read_b128 a[196:199], v2 offset:1024
v_mfma_f32_16x16x32_bf16 a[120:123], a[216:219], v[204:207], a[120:123]
v_exp_f32 v135, v135
v_mfma_f32_16x16x32_bf16 a[124:127], a[220:223], v[204:207], a[124:127]
v_exp_f32 v148, v148
v_mfma_f32_16x16x32_bf16 a[124:127], a[252:255], v[220:223], a[124:127]
ds_read_b128 a[200:203], v2 offset:2048
v_mfma_f32_16x16x32_bf16 a[60:63], a[252:255], v[212:215], a[60:63]
buffer_load_dwordx4 v1, s[44:47], s72 offen offset:2048 sc1 lds
v_mfma_f32_16x16x32_bf16 a[60:63], a[220:223], v[196:199], a[60:63]
ds_read_b128 a[204:207], v2 offset:3072
v_cvt_pk_bf16_f32 v196, v132, v133
s_cmp_eq_u32 s58, 2
s_cbranch_scc1 Lta19
s_cmp_eq_u32 s58, 3
s_cbranch_scc1 Lnt20
v_mfma_f32_16x16x32_bf16 v[160:163], a[160:163], v[16:19], v[112:115]
v_exp_f32 v149, v149
v_mfma_f32_16x16x32_bf16 v[176:179], a[176:179], v[16:19], v[112:115]
v_exp_f32 v150, v150
s_branch Ljoin21
Lta19:
v_mfma_f32_16x16x32_bf16 v[160:163], a[160:163], v[16:19], v[96:99]
v_exp_f32 v149, v149
v_mfma_f32_16x16x32_bf16 v[176:179], a[176:179], v[16:19], v[112:115]
v_exp_f32 v150, v150
s_branch Ljoin21
Lnt20:
v_mfma_f32_16x16x32_bf16 v[160:163], a[160:163], v[16:19], v[80:83]
v_exp_f32 v149, v149
v_mfma_f32_16x16x32_bf16 v[176:179], a[176:179], v[16:19], v[96:99]
v_exp_f32 v150, v150
Ljoin21:
v_mfma_f32_16x16x32_bf16 v[164:167], a[160:163], v[32:35], v[84:87]
ds_read_b128 a[208:211], v2 offset:4096
v_cvt_pk_bf16_f32 v197, v134, v135
v_mfma_f32_16x16x32_bf16 v[164:167], a[164:167], v[36:39], v[164:167]
v_exp_f32 v151, v151
v_mfma_f32_16x16x32_bf16 v[164:167], a[168:171], v[40:43], v[164:167]
v_exp_f32 v140, v140
v_mfma_f32_16x16x32_bf16 v[164:167], a[172:175], v[44:47], v[164:167]
ds_read_b128 a[212:215], v2 offset:5120
v_cvt_pk_bf16_f32 v198, v148, v149
v_mfma_f32_16x16x32_bf16 v[172:175], a[172:175], v[76:79], v[92:95]
v_exp_f32 v141, v141
v_mfma_f32_16x16x32_bf16 v[172:175], a[168:171], v[72:75], v[172:175]
v_exp_f32 v142, v142
v_mfma_f32_16x16x32_bf16 v[172:175], a[164:167], v[68:71], v[172:175]
ds_read_b128 a[216:219], v2 offset:6144
v_cvt_pk_bf16_f32 v199, v150, v151
v_mfma_f32_16x16x32_bf16 v[172:175], a[160:163], v[64:67], v[172:175]
v_exp_f32 v143, v143
v_mfma_f32_16x16x32_bf16 v[188:191], a[176:179], v[64:67], v[92:95]
v_exp_f32 v156, v156
v_mfma_f32_16x16x32_bf16 v[188:191], a[180:183], v[68:71], v[188:191]
ds_read_b128 a[220:223], v2 offset:7168
v_cvt_pk_bf16_f32 v204, v140, v141
v_mfma_f32_16x16x32_bf16 v[188:191], a[184:187], v[72:75], v[188:191]
buffer_load_dwordx4 v1, s[44:47], s72 offen offset:3072 sc1 lds
v_mfma_f32_16x16x32_bf16 v[188:191], a[188:191], v[76:79], v[188:191]
v_exp_f32 v157, v157
v_mfma_f32_16x16x32_bf16 v[180:183], a[188:191], v[44:47], v[84:87]
v_exp_f32 v158, v158
v_mfma_f32_16x16x32_bf16 v[180:183], a[184:187], v[40:43], v[180:183]
v_cvt_pk_bf16_f32 v205, v142, v143
v_cvt_pk_bf16_f32 v206, v156, v157
v_mfma_f32_16x16x32_bf16 v[180:183], a[180:183], v[36:39], v[180:183]
v_exp_f32 v159, v159
v_mfma_f32_16x16x32_bf16 v[180:183], a[176:179], v[32:35], v[180:183]
v_cvt_pk_bf16_f32 v207, v158, v159
v_mfma_f32_16x16x32_bf16 v[160:163], a[164:167], v[20:23], v[160:163]
v_mfma_f32_16x16x32_bf16 v[160:163], a[168:171], v[24:27], v[160:163]
v_mfma_f32_16x16x32_bf16 v[160:163], a[172:175], v[28:31], v[160:163]
v_mfma_f32_16x16x32_bf16 v[168:171], a[172:175], v[60:63], v[88:91]
v_mfma_f32_16x16x32_bf16 v[168:171], a[168:171], v[56:59], v[168:171]
v_mfma_f32_16x16x32_bf16 v[168:171], a[164:167], v[52:55], v[168:171]
v_mfma_f32_16x16x32_bf16 v[168:171], a[160:163], v[48:51], v[168:171]
v_mfma_f32_16x16x32_bf16 v[184:187], a[176:179], v[48:51], v[88:91]
v_mfma_f32_16x16x32_bf16 v[184:187], a[180:183], v[52:55], v[184:187]
v_mfma_f32_16x16x32_bf16 v[184:187], a[184:187], v[56:59], v[184:187]
v_mfma_f32_16x16x32_bf16 v[184:187], a[188:191], v[60:63], v[184:187]
v_mfma_f32_16x16x32_bf16 v[176:179], a[188:191], v[28:31], v[176:179]
v_mfma_f32_16x16x32_bf16 v[176:179], a[184:187], v[24:27], v[176:179]
v_mfma_f32_16x16x32_bf16 v[176:179], a[180:183], v[20:23], v[176:179]
s_waitcnt lgkmcnt(4)
v_mfma_f32_16x16x32_bf16 v[224:227], v[120:123], v[208:211], v[224:227]
s_add_u32 s82, s82, 0x8000
ds_read_b128 a[160:163], v2 offset:24576
v_mfma_f32_16x16x32_bf16 v[224:227], v[120:123], v[192:195], v[224:227]
s_and_b32 s82, s82, 0x1ffff
v_exp_f32 v164, v164
v_mfma_f32_16x16x32_bf16 v[232:235], v[120:123], v[216:219], v[232:235]
s_add_u32 m0, s74, 0
v_exp_f32 v165, v165
v_mfma_f32_16x16x32_bf16 v[232:235], v[120:123], v[200:203], v[232:235]
s_add_u32 s72, s81, 0
ds_read_b128 a[164:167], v2 offset:25600
v_cvt_pk_bf16_f32 v212, v164, v165
v_mfma_f32_16x16x32_bf16 a[0:3], a[224:227], v[208:211], a[0:3]
v_exp_f32 v166, v166
v_mfma_f32_16x16x32_bf16 a[0:3], a[192:195], v[192:195], a[0:3]
v_exp_f32 v167, v167
v_mfma_f32_16x16x32_bf16 a[64:67], a[192:195], v[200:203], a[64:67]
ds_read_b128 a[168:171], v2 offset:26624
v_cvt_pk_bf16_f32 v213, v166, v167
v_mfma_f32_16x16x32_bf16 a[64:67], a[224:227], v[216:219], a[64:67]
v_exp_f32 v180, v180
v_mfma_f32_16x16x32_bf16 a[68:71], a[228:231], v[216:219], a[68:71]
buffer_load_dwordx4 v1, s[44:47], s72 offen sc1 lds
v_mfma_f32_16x16x32_bf16 a[68:71], a[196:199], v[200:203], a[68:71]
v_exp_f32 v181, v181
v_mfma_f32_16x16x32_bf16 a[4:7], a[196:199], v[192:195], a[4:7]
ds_read_b128 a[172:175], v2 offset:27648
v_cvt_pk_bf16_f32 v214, v180, v181
v_mfma_f32_16x16x32_bf16 a[4:7], a[228:231], v[208:211], a[4:7]
v_exp_f32 v182, v182
v_mfma_f32_16x16x32_bf16 a[8:11], a[232:235], v[208:211], a[8:11]
v_exp_f32 v183, v183
v_mfma_f32_16x16x32_bf16 a[8:11], a[200:203], v[192:195], a[8:11]
ds_read_b128 a[176:179], v2 offset:28672
v_cvt_pk_bf16_f32 v215, v182, v183
v_mfma_f32_16x16x32_bf16 a[72:75], a[200:203], v[200:203], a[72:75]
v_exp_f32 v172, v172
v_mfma_f32_16x16x32_bf16 a[72:75], a[232:235], v[216:219], a[72:75]
v_exp_f32 v173, v173
v_mfma_f32_16x16x32_bf16 a[76:79], a[236:239], v[216:219], a[76:79]
ds_read_b128 a[180:183], v2 offset:29696
v_cvt_pk_bf16_f32 v220, v172, v173
v_mfma_f32_16x16x32_bf16 a[76:79], a[204:207], v[200:203], a[76:79]
v_exp_f32 v174, v174
v_mfma_f32_16x16x32_bf16 a[12:15], a[204:207], v[192:195], a[12:15]
v_exp_f32 v175, v175
v_mfma_f32_16x16x32_bf16 a[12:15], a[236:239], v[208:211], a[12:15]
ds_read_b128 a[184:187], v2 offset:30720
v_cvt_pk_bf16_f32 v221, v174, v175
v_mfma_f32_16x16x32_bf16 a[16:19], a[240:243], v[208:211], a[16:19]
s_waitcnt lgkmcnt(7)
v_exp_f32 v188, v188
v_mfma_f32_16x16x32_bf16 a[16:19], a[208:211], v[192:195], a[16:19]
buffer_load_dwordx4 v1, s[44:47], s72 offen offset:1024 sc1 lds
v_mfma_f32_16x16x32_bf16 a[80:83], a[208:211], v[200:203], a[80:83]
v_exp_f32 v189, v189
v_mfma_f32_16x16x32_bf16 a[80:83], a[240:243], v[216:219], a[80:83]
ds_read_b128 a[188:191], v2 offset:31744
v_cvt_pk_bf16_f32 v222, v188, v189
v_mfma_f32_16x16x32_bf16 a[84:87], a[244:247], v[216:219], a[84:87]
v_exp_f32 v190, v190
v_mfma_f32_16x16x32_bf16 a[84:87], a[212:215], v[200:203], a[84:87]
v_exp_f32 v191, v191
v_mfma_f32_16x16x32_bf16 a[20:23], a[212:215], v[192:195], a[20:23]
ds_read_b128 a[224:227], v2 offset:8192
v_cvt_pk_bf16_f32 v223, v190, v191
v_mfma_f32_16x16x32_bf16 a[20:23], a[244:247], v[208:211], a[20:23]
v_exp_f32 v160, v160
v_mfma_f32_16x16x32_bf16 a[24:27], a[248:251], v[208:211], a[24:27]
v_exp_f32 v161, v161
v_mfma_f32_16x16x32_bf16 a[24:27], a[216:219], v[192:195], a[24:27]
ds_read_b128 a[228:231], v2 offset:9216
v_mfma_f32_16x16x32_bf16 a[88:91], a[216:219], v[200:203], a[88:91]
v_exp_f32 v162, v162
v_mfma_f32_16x16x32_bf16 a[88:91], a[248:251], v[216:219], a[88:91]
v_exp_f32 v163, v163
v_mfma_f32_16x16x32_bf16 a[92:95], a[252:255], v[216:219], a[92:95]
ds_read_b128 a[232:235], v2 offset:10240
v_mfma_f32_16x16x32_bf16 a[92:95], a[220:223], v[200:203], a[92:95]
v_exp_f32 v176, v176
v_mfma_f32_16x16x32_bf16 a[28:31], a[220:223], v[192:195], a[28:31]
buffer_load_dwordx4 v1, s[44:47], s72 offen offset:2048 sc1 lds
v_mfma_f32_16x16x32_bf16 a[28:31], a[252:255], v[208:211], a[28:31]
ds_read_b128 a[236:239], v2 offset:11264
v_cvt_pk_bf16_f32 v208, v160, v161
s_cmp_eq_u32 s58, 0
s_cbranch_scc1 Lta22
s_cmp_eq_u32 s58, 1
s_cbranch_scc1 Lnt23
v_mfma_f32_16x16x32_bf16 v[132:135], a[128:131], v[32:35], v[84:87]
v_exp_f32 v177, v177
v_mfma_f32_16x16x32_bf16 v[148:151], a[144:147], v[32:35], v[84:87]
v_exp_f32 v178, v178
s_branch Ljoin24
Lta22:
v_mfma_f32_16x16x32_bf16 v[132:135], a[128:131], v[32:35], v[100:103]
v_exp_f32 v177, v177
v_mfma_f32_16x16x32_bf16 v[148:151], a[144:147], v[32:35], v[112:115]
v_exp_f32 v178, v178
s_branch Ljoin24
Lnt23:
v_mfma_f32_16x16x32_bf16 v[132:135], a[128:131], v[32:35], v[84:87]
v_exp_f32 v177, v177
v_mfma_f32_16x16x32_bf16 v[148:151], a[144:147], v[32:35], v[100:103]
v_exp_f32 v178, v178
Ljoin24:
v_mfma_f32_16x16x32_bf16 v[136:139], a[128:131], v[48:51], v[88:91]
ds_read_b128 a[240:243], v2 offset:12288
v_cvt_pk_bf16_f32 v209, v162, v163
v_mfma_f32_16x16x32_bf16 v[136:139], a[132:135], v[52:55], v[136:139]
v_exp_f32 v179, v179
v_mfma_f32_16x16x32_bf16 v[136:139], a[136:139], v[56:59], v[136:139]
v_exp_f32 v168, v168
v_mfma_f32_16x16x32_bf16 v[136:139], a[140:143], v[60:63], v[136:139]
ds_read_b128 a[244:247], v2 offset:13312
v_cvt_pk_bf16_f32 v210, v176, v177
v_mfma_f32_16x16x32_bf16 v[152:155], a[156:159], v[60:63], v[88:91]
v_exp_f32 v169, v169
v_mfma_f32_16x16x32_bf16 v[152:155], a[152:155], v[56:59], v[152:155]
v_exp_f32 v170, v170
v_mfma_f32_16x16x32_bf16 v[152:155], a[148:151], v[52:55], v[152:155]
ds_read_b128 a[248:251], v2 offset:14336
v_cvt_pk_bf16_f32 v211, v178, v179
v_mfma_f32_16x16x32_bf16 v[152:155], a[144:147], v[48:51], v[152:155]
v_exp_f32 v171, v171
v_mfma_f32_16x16x32_bf16 v[132:135], a[132:135], v[36:39], v[132:135]
v_exp_f32 v184, v184
v_mfma_f32_16x16x32_bf16 v[132:135], a[136:139], v[40:43], v[132:135]
ds_read_b128 a[252:255], v2 offset:15360
v_cvt_pk_bf16_f32 v216, v168, v169
v_mfma_f32_16x16x32_bf16 v[132:135], a[140:143], v[44:47], v[132:135]
buffer_load_dwordx4 v1, s[44:47], s72 offen offset:3072 sc1 lds
v_mfma_f32_16x16x32_bf16 v[140:143], a[140:143], v[76:79], v[92:95]
v_exp_f32 v185, v185
v_mfma_f32_16x16x32_bf16 v[140:143], a[136:139], v[72:75], v[140:143]
v_exp_f32 v186, v186
v_mfma_f32_16x16x32_bf16 v[140:143], a[132:135], v[68:71], v[140:143]
v_cvt_pk_bf16_f32 v217, v170, v171
v_cvt_pk_bf16_f32 v218, v184, v185
v_mfma_f32_16x16x32_bf16 v[140:143], a[128:131], v[64:67], v[140:143]
v_exp_f32 v187, v187
v_mfma_f32_16x16x32_bf16 v[156:159], a[144:147], v[64:67], v[92:95]
v_cvt_pk_bf16_f32 v219, v186, v187
v_add_u32 v2, s82, v1
v_mfma_f32_16x16x32_bf16 v[156:159], a[148:151], v[68:71], v[156:159]
v_mfma_f32_16x16x32_bf16 v[156:159], a[152:155], v[72:75], v[156:159]
v_mfma_f32_16x16x32_bf16 v[156:159], a[156:159], v[76:79], v[156:159]
v_mfma_f32_16x16x32_bf16 v[148:151], a[156:159], v[44:47], v[148:151]
v_mfma_f32_16x16x32_bf16 v[148:151], a[152:155], v[40:43], v[148:151]
s_waitcnt vmcnt(8) lgkmcnt(4)
v_mfma_f32_16x16x32_bf16 v[148:151], a[148:151], v[36:39], v[148:151]
s_barrier
s_cmp_eq_u32 s60, 7
s_cbranch_scc1 LLT3x
LLT3:
Lstub4:
s_cbranch_execz Lstub8
v_mfma_f32_16x16x32_bf16 v[228:231], v[120:123], v[196:199], v[228:231]
s_xor_b32 s74, s82, 0x10000
v_exp_f32 v136, v136
v_mfma_f32_16x16x32_bf16 v[228:231], v[120:123], v[212:215], v[228:231]
s_add_u32 s74, s74, s64
ds_read_b128 a[128:131], v2 offset:16384
v_and_b32 v240, 15, v0
v_mfma_f32_16x16x32_bf16 v[236:239], v[120:123], v[204:207], v[236:239]
s_add_u32 s81, s81, 0x8000
v_exp_f32 v137, v137
v_mfma_f32_16x16x32_bf16 v[236:239], v[120:123], v[220:223], v[236:239]
s_add_u32 m0, s74, 16384
ds_read_b128 a[132:135], v2 offset:17408
v_cvt_pk_bf16_f32 v200, v136, v137
v_mfma_f32_16x16x32_bf16 a[32:35], a[192:195], v[196:199], a[32:35]
s_add_u32 s72, s81, 16384
buffer_load_dwordx4 v1, s[44:47], s72 offen sc1 lds
v_mfma_f32_16x16x32_bf16 a[32:35], a[224:227], v[212:215], a[32:35]
s_add_u32 s69, s93, 0x3e00000
v_exp_f32 v138, v138
v_mfma_f32_16x16x32_bf16 a[96:99], a[224:227], v[220:223], a[96:99]
v_exp_f32 v139, v139
v_mfma_f32_16x16x32_bf16 a[96:99], a[192:195], v[204:207], a[96:99]
ds_read_b128 a[136:139], v2 offset:18432
v_cvt_pk_bf16_f32 v201, v138, v139
v_mfma_f32_16x16x32_bf16 a[100:103], a[196:199], v[204:207], a[100:103]
v_exp_f32 v152, v152
v_mfma_f32_16x16x32_bf16 a[100:103], a[228:231], v[220:223], a[100:103]
ds_read_b128 a[140:143], v2 offset:19456
v_lshrrev_b32 v241, 4, v0
v_mfma_f32_16x16x32_bf16 a[36:39], a[228:231], v[212:215], a[36:39]
buffer_store_dwordx4 v[112:115], v1, s[44:47], s69 offen sc1
v_mfma_f32_16x16x32_bf16 a[36:39], a[196:199], v[196:199], a[36:39]
v_exp_f32 v153, v153
v_mfma_f32_16x16x32_bf16 a[40:43], a[200:203], v[196:199], a[40:43]
v_exp_f32 v154, v154
v_mfma_f32_16x16x32_bf16 a[40:43], a[232:235], v[212:215], a[40:43]
ds_read_b128 a[144:147], v2 offset:20480
v_cvt_pk_bf16_f32 v202, v152, v153
v_mfma_f32_16x16x32_bf16 a[104:107], a[232:235], v[220:223], a[104:107]
v_exp_f32 v155, v155
v_mfma_f32_16x16x32_bf16 a[104:107], a[200:203], v[204:207], a[104:107]
ds_read_b128 a[148:151], v2 offset:21504
v_cvt_pk_bf16_f32 v203, v154, v155
v_mfma_f32_16x16x32_bf16 a[108:111], a[204:207], v[204:207], a[108:111]
buffer_load_dwordx4 v1, s[44:47], s72 offen offset:1024 sc1 lds
v_mfma_f32_16x16x32_bf16 a[108:111], a[236:239], v[220:223], a[108:111]
v_exp_f32 v132, v132
v_mfma_f32_16x16x32_bf16 a[44:47], a[236:239], v[212:215], a[44:47]
v_exp_f32 v133, v133
v_mfma_f32_16x16x32_bf16 a[44:47], a[204:207], v[196:199], a[44:47]
ds_read_b128 a[152:155], v2 offset:22528
v_add_u32 v248, 1, v240
v_mfma_f32_16x16x32_bf16 a[48:51], a[208:211], v[196:199], a[48:51]
s_waitcnt lgkmcnt(7)
v_exp_f32 v134, v134
v_mfma_f32_16x16x32_bf16 a[48:51], a[240:243], v[212:215], a[48:51]
ds_read_b128 a[156:159], v2 offset:23552
v_and_b32 v249, 3, v248
v_mfma_f32_16x16x32_bf16 a[112:115], a[240:243], v[220:223], a[112:115]
buffer_store_dwordx4 v[112:115], v1, s[44:47], s69 offen offset:1024 sc1
v_mfma_f32_16x16x32_bf16 a[112:115], a[208:211], v[204:207], a[112:115]
v_exp_f32 v135, v135
v_mfma_f32_16x16x32_bf16 a[116:119], a[212:215], v[204:207], a[116:119]
v_exp_f32 v148, v148
v_mfma_f32_16x16x32_bf16 a[116:119], a[244:247], v[220:223], a[116:119]
ds_read_b128 a[192:195], v2 offset:0
v_lshrrev_b32 v248, 2, v248
v_mfma_f32_16x16x32_bf16 a[52:55], a[244:247], v[212:215], a[52:55]
v_exp_f32 v149, v149
v_mfma_f32_16x16x32_bf16 a[52:55], a[212:215], v[196:199], a[52:55]
ds_read_b128 a[196:199], v2 offset:1024
v_mov_b32 v250, 0x20000
v_mfma_f32_16x16x32_bf16 a[56:59], a[216:219], v[196:199], a[56:59]
buffer_load_dwordx4 v1, s[44:47], s72 offen offset:2048 sc1 lds
v_mfma_f32_16x16x32_bf16 a[56:59], a[248:251], v[212:215], a[56:59]
v_exp_f32 v150, v150
v_mfma_f32_16x16x32_bf16 a[120:123], a[248:251], v[220:223], a[120:123]
v_exp_f32 v151, v151
v_mfma_f32_16x16x32_bf16 a[120:123], a[216:219], v[204:207], a[120:123]
ds_read_b128 a[200:203], v2 offset:2048
v_mov_b32 v252, 0x20001
v_mfma_f32_16x16x32_bf16 a[124:127], a[220:223], v[204:207], a[124:127]
v_exp_f32 v140, v140
v_mfma_f32_16x16x32_bf16 a[124:127], a[252:255], v[220:223], a[124:127]
ds_read_b128 a[204:207], v2 offset:3072
v_lshlrev_b32 v6, 3, v249
v_mfma_f32_16x16x32_bf16 a[60:63], a[252:255], v[212:215], a[60:63]
buffer_store_dwordx4 v[112:115], v1, s[44:47], s69 offen offset:2048 sc1
v_mfma_f32_16x16x32_bf16 a[60:63], a[220:223], v[196:199], a[60:63]
ds_read_b128 a[208:211], v2 offset:4096
v_cvt_pk_bf16_f32 v196, v132, v133
s_cmp_eq_u32 s58, 2
s_cbranch_scc1 Lta25
s_cmp_eq_u32 s58, 3
s_cbranch_scc1 Lnt26
v_mfma_f32_16x16x32_bf16 v[164:167], a[160:163], v[32:35], v[112:115]
ds_read_b128 a[212:215], v2 offset:5120
v_cvt_pk_bf16_f32 v197, v134, v135
v_mfma_f32_16x16x32_bf16 v[180:183], a[176:179], v[32:35], v[112:115]
ds_read_b128 a[216:219], v2 offset:6144
v_cvt_pk_bf16_f32 v198, v148, v149
s_branch Ljoin27
Lta25:
v_mfma_f32_16x16x32_bf16 v[164:167], a[160:163], v[32:35], v[100:103]
ds_read_b128 a[212:215], v2 offset:5120
v_cvt_pk_bf16_f32 v197, v134, v135
v_mfma_f32_16x16x32_bf16 v[180:183], a[176:179], v[32:35], v[112:115]
ds_read_b128 a[216:219], v2 offset:6144
v_cvt_pk_bf16_f32 v198, v148, v149
s_branch Ljoin27
Lnt26:
v_mfma_f32_16x16x32_bf16 v[164:167], a[160:163], v[32:35], v[84:87]
ds_read_b128 a[212:215], v2 offset:5120
v_cvt_pk_bf16_f32 v197, v134, v135
v_mfma_f32_16x16x32_bf16 v[180:183], a[176:179], v[32:35], v[100:103]
ds_read_b128 a[216:219], v2 offset:6144
v_cvt_pk_bf16_f32 v198, v148, v149
Ljoin27:
v_mfma_f32_16x16x32_bf16 v[164:167], a[164:167], v[36:39], v[164:167]
v_exp_f32 v141, v141
v_mfma_f32_16x16x32_bf16 v[164:167], a[168:171], v[40:43], v[164:167]
v_exp_f32 v142, v142
v_mfma_f32_16x16x32_bf16 v[164:167], a[172:175], v[44:47], v[164:167]
ds_read_b128 a[220:223], v2 offset:7168
v_cvt_pk_bf16_f32 v199, v150, v151
v_mfma_f32_16x16x32_bf16 v[172:175], a[172:175], v[76:79], v[92:95]
v_exp_f32 v143, v143
v_mfma_f32_16x16x32_bf16 v[172:175], a[168:171], v[72:75], v[172:175]
buffer_load_dwordx4 v1, s[44:47], s72 offen offset:3072 sc1 lds
v_mfma_f32_16x16x32_bf16 v[172:175], a[164:167], v[68:71], v[172:175]
v_exp_f32 v156, v156
v_mfma_f32_16x16x32_bf16 v[172:175], a[160:163], v[64:67], v[172:175]
v_cvt_pk_bf16_f32 v204, v140, v141
v_cvt_pk_bf16_f32 v205, v142, v143
v_mfma_f32_16x16x32_bf16 v[188:191], a[176:179], v[64:67], v[92:95]
v_exp_f32 v157, v157
v_mfma_f32_16x16x32_bf16 v[188:191], a[180:183], v[68:71], v[188:191]
v_exp_f32 v158, v158
v_mfma_f32_16x16x32_bf16 v[188:191], a[184:187], v[72:75], v[188:191]
buffer_store_dwordx4 v[112:115], v1, s[44:47], s69 offen offset:3072 sc1
v_mfma_f32_16x16x32_bf16 v[188:191], a[188:191], v[76:79], v[188:191]
v_exp_f32 v159, v159
v_mfma_f32_16x16x32_bf16 v[180:183], a[188:191], v[44:47], v[180:183]
v_cvt_pk_bf16_f32 v206, v156, v157
v_cvt_pk_bf16_f32 v207, v158, v159
v_mfma_f32_16x16x32_bf16 v[180:183], a[184:187], v[40:43], v[180:183]
v_lshrrev_b32 v6, v6, v252
v_and_b32 v6, 3, v6
v_mfma_f32_16x16x32_bf16 v[180:183], a[180:183], v[36:39], v[180:183]
v_cmp_ne_u32 vcc, 1, v249
v_mul_u32_u24 v6, 16640, v6
v_mfma_f32_16x16x32_bf16 v[168:171], a[160:163], v[48:51], v[88:91]
v_add_u32 v6, s92, v6
v_cndmask_b32 v6, v250, v6, vcc
v_mfma_f32_16x16x32_bf16 v[168:171], a[164:167], v[52:55], v[168:171]
v_add_u32 v253, s58, v249
v_and_b32 v253, 3, v253
v_mfma_f32_16x16x32_bf16 v[168:171], a[168:171], v[56:59], v[168:171]
v_mul_u32_u24 v253, 4160, v253
v_add_u32 v6, v6, v253
v_mfma_f32_16x16x32_bf16 v[168:171], a[172:175], v[60:63], v[168:171]
v_bfe_u32 v251, v0, 2, 2
v_lshl_add_u32 v6, v248, 3, v6
v_mfma_f32_16x16x32_bf16 v[184:187], a[188:191], v[60:63], v[88:91]
v_lshl_add_u32 v6, v241, 4, v6
v_lshlrev_b32 v5, 3, v251
v_mfma_f32_16x16x32_bf16 v[184:187], a[184:187], v[56:59], v[184:187]
v_lshrrev_b32 v5, v5, v252
v_and_b32 v5, 3, v5
v_mfma_f32_16x16x32_bf16 v[184:187], a[180:183], v[52:55], v[184:187]
v_cmp_ne_u32 vcc, 1, v251
v_mul_u32_u24 v5, 16640, v5
v_mfma_f32_16x16x32_bf16 v[184:187], a[176:179], v[48:51], v[184:187]
s_waitcnt lgkmcnt(4)
v_mfma_f32_16x16x32_bf16 v[224:227], v[120:123], v[208:211], v[224:227]
s_add_u32 s82, s82, 0x8000
ds_read_b128 a[160:163], v2 offset:24576
ds_read_b128 a[164:167], v2 offset:25600
v_mfma_f32_16x16x32_bf16 v[232:235], v[120:123], v[216:219], v[232:235]
s_and_b32 s82, s82, 0x1ffff
v_exp_f32 v164, v164
v_mfma_f32_16x16x32_bf16 v[232:235], v[120:123], v[200:203], v[232:235]
s_add_u32 m0, s74, 0
v_exp_f32 v165, v165
v_mfma_f32_16x16x32_bf16 a[0:3], a[224:227], v[208:211], a[0:3]
s_add_u32 s72, s81, 0
v_exp_f32 v166, v166
v_mfma_f32_16x16x32_bf16 a[64:67], a[192:195], v[200:203], a[64:67]
ds_read_b128 a[168:171], v2 offset:26624
v_cvt_pk_bf16_f32 v212, v164, v165
v_mfma_f32_16x16x32_bf16 a[64:67], a[224:227], v[216:219], a[64:67]
v_exp_f32 v167, v167
v_mfma_f32_16x16x32_bf16 a[68:71], a[228:231], v[216:219], a[68:71]
buffer_load_dwordx4 v1, s[44:47], s72 offen sc1 lds
v_mfma_f32_16x16x32_bf16 a[68:71], a[196:199], v[200:203], a[68:71]
v_exp_f32 v180, v180
v_mfma_f32_16x16x32_bf16 a[4:7], a[228:231], v[208:211], a[4:7]
ds_read_b128 a[172:175], v2 offset:27648
v_cvt_pk_bf16_f32 v213, v166, v167
v_mfma_f32_16x16x32_bf16 a[8:11], a[232:235], v[208:211], a[8:11]
v_exp_f32 v181, v181
v_mfma_f32_16x16x32_bf16 a[72:75], a[200:203], v[200:203], a[72:75]
ds_read_b128 a[176:179], v2 offset:28672
v_cvt_pk_bf16_f32 v214, v180, v181
v_mfma_f32_16x16x32_bf16 a[72:75], a[232:235], v[216:219], a[72:75]
v_exp_f32 v182, v182
v_mfma_f32_16x16x32_bf16 a[76:79], a[236:239], v[216:219], a[76:79]
v_exp_f32 v183, v183
v_mfma_f32_16x16x32_bf16 a[76:79], a[204:207], v[200:203], a[76:79]
ds_read_b128 a[180:183], v2 offset:29696
v_cvt_pk_bf16_f32 v215, v182, v183
v_mfma_f32_16x16x32_bf16 a[12:15], a[236:239], v[208:211], a[12:15]
v_exp_f32 v172, v172
v_mfma_f32_16x16x32_bf16 a[16:19], a[240:243], v[208:211], a[16:19]
s_waitcnt lgkmcnt(6)
ds_read_b128 a[184:187], v2 offset:30720
ds_read_b128 a[188:191], v2 offset:31744
v_mfma_f32_16x16x32_bf16 a[80:83], a[208:211], v[200:203], a[80:83]
v_exp_f32 v173, v173
v_mfma_f32_16x16x32_bf16 a[80:83], a[240:243], v[216:219], a[80:83]
buffer_load_dwordx4 v1, s[44:47], s72 offen offset:1024 sc1 lds
v_mfma_f32_16x16x32_bf16 a[84:87], a[244:247], v[216:219], a[84:87]
v_exp_f32 v174, v174
v_mfma_f32_16x16x32_bf16 a[84:87], a[212:215], v[200:203], a[84:87]
v_exp_f32 v175, v175
v_mfma_f32_16x16x32_bf16 a[20:23], a[244:247], v[208:211], a[20:23]
ds_read_b128 a[224:227], v2 offset:8192
v_cvt_pk_bf16_f32 v220, v172, v173
v_mfma_f32_16x16x32_bf16 a[24:27], a[248:251], v[208:211], a[24:27]
v_exp_f32 v188, v188
v_mfma_f32_16x16x32_bf16 a[88:91], a[216:219], v[200:203], a[88:91]
v_exp_f32 v189, v189
v_mfma_f32_16x16x32_bf16 a[88:91], a[248:251], v[216:219], a[88:91]
Lstub5:
s_cbranch_execz Lstub9
ds_read_b128 a[228:231], v2 offset:9216
v_cvt_pk_bf16_f32 v221, v174, v175
v_mfma_f32_16x16x32_bf16 a[92:95], a[252:255], v[216:219], a[92:95]
v_exp_f32 v190, v190
v_mfma_f32_16x16x32_bf16 a[92:95], a[220:223], v[200:203], a[92:95]
ds_read_b128 a[232:235], v2 offset:10240
v_cvt_pk_bf16_f32 v222, v188, v189
v_mfma_f32_16x16x32_bf16 a[28:31], a[252:255], v[208:211], a[28:31]
v_exp_f32 v191, v191
v_mfma_f32_16x16x32_bf16 v[136:139], a[128:131], v[48:51], v[88:91]
buffer_load_dwordx4 v1, s[44:47], s72 offen offset:2048 sc1 lds
v_mfma_f32_16x16x32_bf16 v[136:139], a[132:135], v[52:55], v[136:139]
v_exp_f32 v168, v168
v_mfma_f32_16x16x32_bf16 v[136:139], a[136:139], v[56:59], v[136:139]
ds_read_b128 a[236:239], v2 offset:11264
v_cvt_pk_bf16_f32 v223, v190, v191
v_mfma_f32_16x16x32_bf16 v[136:139], a[140:143], v[60:63], v[136:139]
v_exp_f32 v169, v169
v_mfma_f32_16x16x32_bf16 v[152:155], a[156:159], v[60:63], v[88:91]
ds_read_b128 a[240:243], v2 offset:12288
v_cvt_pk_bf16_f32 v216, v168, v169
v_mfma_f32_16x16x32_bf16 v[152:155], a[152:155], v[56:59], v[152:155]
v_exp_f32 v170, v170
v_mfma_f32_16x16x32_bf16 v[152:155], a[148:151], v[52:55], v[152:155]
v_exp_f32 v171, v171
v_mfma_f32_16x16x32_bf16 v[152:155], a[144:147], v[48:51], v[152:155]
ds_read_b128 a[244:247], v2 offset:13312
v_cvt_pk_bf16_f32 v217, v170, v171
v_mfma_f32_16x16x32_bf16 v[140:143], a[128:131], v[64:67], v[92:95]
v_exp_f32 v184, v184
v_mfma_f32_16x16x32_bf16 v[140:143], a[132:135], v[68:71], v[140:143]
ds_read_b128 a[248:251], v2 offset:14336
v_mfma_f32_16x16x32_bf16 v[140:143], a[136:139], v[72:75], v[140:143]
v_exp_f32 v185, v185
v_mfma_f32_16x16x32_bf16 v[140:143], a[140:143], v[76:79], v[140:143]
buffer_load_dwordx4 v1, s[44:47], s72 offen offset:3072 sc1 lds
v_mfma_f32_16x16x32_bf16 v[156:159], a[156:159], v[76:79], v[92:95]
ds_read_b128 a[252:255], v2 offset:15360
v_cvt_pk_bf16_f32 v218, v184, v185
v_mfma_f32_16x16x32_bf16 v[156:159], a[152:155], v[72:75], v[156:159]
v_exp_f32 v186, v186
v_mfma_f32_16x16x32_bf16 v[156:159], a[148:151], v[68:71], v[156:159]
s_waitcnt vmcnt(12) lgkmcnt(4)
v_exp_f32 v187, v187
v_mfma_f32_16x16x32_bf16 v[156:159], a[144:147], v[64:67], v[156:159]
s_barrier
v_cvt_pk_bf16_f32 v219, v186, v187
v_add_u32 v2, s82, v1
v_mfma_f32_16x16x32_bf16 v[228:231], v[120:123], v[196:199], v[228:231]
s_xor_b32 s74, s82, 0x10000
v_exp_f32 v136, v136
v_mfma_f32_16x16x32_bf16 v[228:231], v[120:123], v[212:215], v[228:231]
s_add_u32 s74, s74, s64
ds_read_b128 a[128:131], v2 offset:16384
v_add_u32 v5, s92, v5
v_mfma_f32_16x16x32_bf16 v[236:239], v[120:123], v[204:207], v[236:239]
s_add_u32 s81, s81, 0x8000
v_exp_f32 v137, v137
v_mfma_f32_16x16x32_bf16 v[236:239], v[120:123], v[220:223], v[236:239]
s_add_u32 m0, s74, 16384
ds_read_b128 a[132:135], v2 offset:17408
v_cvt_pk_bf16_f32 v200, v136, v137
v_mfma_f32_16x16x32_bf16 a[32:35], a[192:195], v[196:199], a[32:35]
s_add_u32 s72, s81, 16384
buffer_load_dwordx4 v1, s[44:47], s72 offen sc1 lds
v_mfma_f32_16x16x32_bf16 a[32:35], a[224:227], v[212:215], a[32:35]
s_add_u32 s69, s93, 0x4200000
v_exp_f32 v138, v138
v_mfma_f32_16x16x32_bf16 a[96:99], a[224:227], v[220:223], a[96:99]
ds_read_b128 a[136:139], v2 offset:18432
v_cndmask_b32 v5, v250, v5, vcc
v_mfma_f32_16x16x32_bf16 a[96:99], a[192:195], v[204:207], a[96:99]
v_exp_f32 v139, v139
v_mfma_f32_16x16x32_bf16 a[100:103], a[196:199], v[204:207], a[100:103]
ds_read_b128 a[140:143], v2 offset:19456
v_cvt_pk_bf16_f32 v201, v138, v139
v_mfma_f32_16x16x32_bf16 a[100:103], a[228:231], v[220:223], a[100:103]
buffer_store_dwordx4 v[112:115], v1, s[44:47], s69 offen sc1
v_mfma_f32_16x16x32_bf16 a[36:39], a[228:231], v[212:215], a[36:39]
v_exp_f32 v152, v152
v_mfma_f32_16x16x32_bf16 a[36:39], a[196:199], v[196:199], a[36:39]
ds_read_b128 a[144:147], v2 offset:20480
v_add_u32 v253, s58, v251
v_mfma_f32_16x16x32_bf16 a[40:43], a[200:203], v[196:199], a[40:43]
v_exp_f32 v153, v153
v_mfma_f32_16x16x32_bf16 a[40:43], a[232:235], v[212:215], a[40:43]
ds_read_b128 a[148:151], v2 offset:21504
v_cvt_pk_bf16_f32 v202, v152, v153
v_mfma_f32_16x16x32_bf16 a[104:107], a[232:235], v[220:223], a[104:107]
buffer_load_dwordx4 v1, s[44:47], s72 offen offset:1024 sc1 lds
v_mfma_f32_16x16x32_bf16 a[104:107], a[200:203], v[204:207], a[104:107]
v_exp_f32 v154, v154
v_mfma_f32_16x16x32_bf16 a[108:111], a[204:207], v[204:207], a[108:111]
ds_read_b128 a[152:155], v2 offset:22528
v_and_b32 v253, 3, v253
v_mfma_f32_16x16x32_bf16 a[108:111], a[236:239], v[220:223], a[108:111]
v_exp_f32 v155, v155
v_mfma_f32_16x16x32_bf16 a[44:47], a[236:239], v[212:215], a[44:47]
ds_read_b128 a[156:159], v2 offset:23552
v_cvt_pk_bf16_f32 v203, v154, v155
v_mfma_f32_16x16x32_bf16 a[44:47], a[204:207], v[196:199], a[44:47]
buffer_store_dwordx4 v[112:115], v1, s[44:47], s69 offen offset:1024 sc1
v_mfma_f32_16x16x32_bf16 a[48:51], a[208:211], v[196:199], a[48:51]
s_waitcnt lgkmcnt(8)
v_exp_f32 v140, v140
v_mfma_f32_16x16x32_bf16 a[48:51], a[240:243], v[212:215], a[48:51]
ds_read_b128 a[192:195], v2 offset:0
v_mul_u32_u24 v253, 4160, v253
v_mfma_f32_16x16x32_bf16 a[112:115], a[240:243], v[220:223], a[112:115]
v_exp_f32 v141, v141
v_mfma_f32_16x16x32_bf16 a[112:115], a[208:211], v[204:207], a[112:115]
ds_read_b128 a[196:199], v2 offset:1024
v_add_u32 v5, v5, v253
v_mfma_f32_16x16x32_bf16 a[116:119], a[212:215], v[204:207], a[116:119]
s_add_u32 s73, s62, 480
buffer_load_dwordx4 v1, s[44:47], s72 offen offset:2048 sc1 lds
v_mfma_f32_16x16x32_bf16 a[116:119], a[244:247], v[220:223], a[116:119]
v_exp_f32 v142, v142
v_mfma_f32_16x16x32_bf16 a[52:55], a[244:247], v[212:215], a[52:55]
ds_read_b128 a[200:203], v2 offset:2048
v_lshlrev_b32 v248, 5, v240
v_mfma_f32_16x16x32_bf16 a[52:55], a[212:215], v[196:199], a[52:55]
v_exp_f32 v143, v143
v_mfma_f32_16x16x32_bf16 a[56:59], a[216:219], v[196:199], a[56:59]
ds_read_b128 a[204:207], v2 offset:3072
v_sub_u32 v248, s73, v248
v_mfma_f32_16x16x32_bf16 a[56:59], a[248:251], v[212:215], a[56:59]
buffer_store_dwordx4 v[112:115], v1, s[44:47], s69 offen offset:2048 sc1
v_mfma_f32_16x16x32_bf16 a[120:123], a[248:251], v[220:223], a[120:123]
v_exp_f32 v156, v156
v_mfma_f32_16x16x32_bf16 a[120:123], a[216:219], v[204:207], a[120:123]
ds_read_b128 a[208:211], v2 offset:4096
v_lshl_add_u32 v7, v241, 4, v248
v_mfma_f32_16x16x32_bf16 a[124:127], a[220:223], v[204:207], a[124:127]
s_and_b32 s73, s58, 1
v_exp_f32 v157, v157
v_mfma_f32_16x16x32_bf16 a[124:127], a[252:255], v[220:223], a[124:127]
s_lshl_b32 s73, s73, 4
ds_read_b128 a[212:215], v2 offset:5120
v_mfma_f32_16x16x32_bf16 a[60:63], a[252:255], v[212:215], a[60:63]
s_lshr_b32 s73, s90, s73
buffer_load_dwordx4 v1, s[44:47], s72 offen offset:3072 sc1 lds
v_mfma_f32_16x16x32_bf16 a[60:63], a[220:223], v[196:199], a[60:63]
s_and_b32 s73, s73, 0xffff
ds_read_b128 a[216:219], v2 offset:6144
v_cvt_pk_bf16_f32 v204, v140, v141
v_mfma_f32_16x16x32_bf16 v[172:175], a[160:163], v[64:67], v[92:95]
v_exp_f32 v158, v158
v_mfma_f32_16x16x32_bf16 v[172:175], a[164:167], v[68:71], v[172:175]
ds_read_b128 a[220:223], v2 offset:7168
v_cvt_pk_bf16_f32 v205, v142, v143
v_mfma_f32_16x16x32_bf16 v[172:175], a[168:171], v[72:75], v[172:175]
v_exp_f32 v159, v159
v_mfma_f32_16x16x32_bf16 v[172:175], a[172:175], v[76:79], v[172:175]
buffer_store_dwordx4 v[112:115], v1, s[44:47], s69 offen offset:3072 sc1
v_mfma_f32_16x16x32_bf16 v[188:191], a[188:191], v[76:79], v[92:95]
v_cvt_pk_bf16_f32 v206, v156, v157
v_cvt_pk_bf16_f32 v207, v158, v159
v_mfma_f32_16x16x32_bf16 v[188:191], a[184:187], v[72:75], v[188:191]
v_lshl_add_u32 v248, v241, 3, v240
v_sub_u32 v248, 15, v248
v_mfma_f32_16x16x32_bf16 v[188:191], a[180:183], v[68:71], v[188:191]
v_and_b32 v249, 1, v248
v_lshlrev_b32 v249, 4, v249
v_mfma_f32_16x16x32_bf16 v[188:191], a[176:179], v[64:67], v[188:191]
v_lshlrev_b32 v249, v249, s73
v_lshrrev_b32 v248, 1, v248
v_mfma_f32_16x16x32_bf16 v[168:171], a[160:163], v[48:51], v[88:91]
v_and_b32 v241, 3, v0
v_cmp_eq_u32 vcc, 0, v248
v_mfma_f32_16x16x32_bf16 v[168:171], a[164:167], v[52:55], v[168:171]
v_lshl_add_u32 v5, v241, 3, v5
v_cndmask_b32 v8, 0, v249, vcc
v_mfma_f32_16x16x32_bf16 v[168:171], a[168:171], v[56:59], v[168:171]
v_cmp_eq_u32 vcc, 1, v248
v_lshlrev_b32 v240, 4, v251
v_mfma_f32_16x16x32_bf16 v[168:171], a[172:175], v[60:63], v[168:171]
v_cndmask_b32 v9, 0, v249, vcc
v_cmp_eq_u32 vcc, 2, v248
v_mfma_f32_16x16x32_bf16 v[184:187], a[188:191], v[60:63], v[88:91]
v_sub_u32 v240, 48, v240
v_lshlrev_b64 v[12:13], 16, s[88:89]
v_mfma_f32_16x16x32_bf16 v[184:187], a[184:187], v[56:59], v[184:187]
v_cndmask_b32 v10, 0, v249, vcc
v_cmp_eq_u32 vcc, 3, v248
v_mfma_f32_16x16x32_bf16 v[184:187], a[180:183], v[52:55], v[184:187]
v_lshlrev_b64 v[12:13], v240, v[12:13]
v_cndmask_b32 v11, 0, v249, vcc
v_mfma_f32_16x16x32_bf16 v[184:187], a[176:179], v[48:51], v[184:187]
s_waitcnt lgkmcnt(4)
v_cmp_eq_u32 vcc, 3, v241
s_add_u32 s73, s62, 4096
v_lshl_add_u32 v14, v0, 3, s73
v_cndmask_b32 v12, 0, v12, vcc
v_cndmask_b32 v13, 0, v13, vcc
v_lshrrev_b32 v15, 4, v0
v_lshlrev_b32 v15, 1, v15
v_and_b32 v240, 7, v0
v_xor_b32 v15, v15, v240
v_lshlrev_b32 v15, 4, v15
v_lshrrev_b32 v240, 3, v0
v_lshl_add_u32 v15, v240, 11, v15
s_lshl_b32 s75, s59, 1
s_andn2_b32 s75, 8, s75
s_add_u32 s75, s75, s60
s_lshl_b32 s76, s65, 2
s_lshr_b32 s80, s59, 3
s_add_u32 s76, s76, s80
s_lshl_b32 s94, s58, 16
s_lshl_b32 s80, s76, 7
s_add_u32 s94, s94, s80
s_lshl_b32 s80, s75, 18
s_add_u32 s80, s80, s94
v_rcp_f32 v226, v224
v_rcp_f32 v230, v228
s_lshl_b32 s73, s52, 12
s_add_u32 s73, s73, 0x2000000
s_lshl_b32 s70, s67, 2
s_add_u32 s70, s70, s73
v_or_b32 v3, s53, v1
v_mov_b32 v227, v226
v_accvgpr_read_b32 v240, a0
v_accvgpr_read_b32 v241, a1
v_accvgpr_read_b32 v242, a2
v_accvgpr_read_b32 v243, a3
v_accvgpr_read_b32 v244, a4
v_accvgpr_read_b32 v245, a5
v_accvgpr_read_b32 v246, a6
v_accvgpr_read_b32 v247, a7
v_pk_mul_f32 v[240:241], v[240:241], v[226:227]
v_pk_mul_f32 v[242:243], v[242:243], v[226:227]
v_pk_mul_f32 v[244:245], v[244:245], v[226:227]
v_pk_mul_f32 v[246:247], v[246:247], v[226:227]
v_cvt_pk_bf16_f32 v128, v240, v241
v_cvt_pk_bf16_f32 v129, v242, v243
v_cvt_pk_bf16_f32 v130, v244, v245
v_cvt_pk_bf16_f32 v131, v246, v247
v_accvgpr_read_b32 v248, a8
v_accvgpr_read_b32 v249, a9
v_accvgpr_read_b32 v250, a10
v_accvgpr_read_b32 v251, a11
v_accvgpr_read_b32 v252, a12
v_accvgpr_read_b32 v253, a13
v_accvgpr_read_b32 v254, a14
v_accvgpr_read_b32 v255, a15
v_pk_mul_f32 v[248:249], v[248:249], v[226:227]
v_pk_mul_f32 v[250:251], v[250:251], v[226:227]
v_pk_mul_f32 v[252:253], v[252:253], v[226:227]
v_pk_mul_f32 v[254:255], v[254:255], v[226:227]
v_cvt_pk_bf16_f32 v144, v248, v249
v_cvt_pk_bf16_f32 v145, v250, v251
v_cvt_pk_bf16_f32 v146, v252, v253
v_cvt_pk_bf16_f32 v147, v254, v255
v_accvgpr_read_b32 v240, a16
v_accvgpr_read_b32 v241, a17
v_accvgpr_read_b32 v242, a18
v_accvgpr_read_b32 v243, a19
v_accvgpr_read_b32 v244, a20
v_accvgpr_read_b32 v245, a21
v_accvgpr_read_b32 v246, a22
v_accvgpr_read_b32 v247, a23
v_pk_mul_f32 v[240:241], v[240:241], v[226:227]
v_pk_mul_f32 v[242:243], v[242:243], v[226:227]
v_pk_mul_f32 v[244:245], v[244:245], v[226:227]
v_pk_mul_f32 v[246:247], v[246:247], v[226:227]
v_cvt_pk_bf16_f32 v160, v240, v241
v_cvt_pk_bf16_f32 v161, v242, v243
v_cvt_pk_bf16_f32 v162, v244, v245
v_cvt_pk_bf16_f32 v163, v246, v247
v_accvgpr_read_b32 v248, a24
v_accvgpr_read_b32 v249, a25
v_accvgpr_read_b32 v250, a26
v_accvgpr_read_b32 v251, a27
v_accvgpr_read_b32 v252, a28
v_accvgpr_read_b32 v253, a29
v_accvgpr_read_b32 v254, a30
v_accvgpr_read_b32 v255, a31
v_pk_mul_f32 v[248:249], v[248:249], v[226:227]
v_pk_mul_f32 v[250:251], v[250:251], v[226:227]
v_pk_mul_f32 v[252:253], v[252:253], v[226:227]
v_pk_mul_f32 v[254:255], v[254:255], v[226:227]
v_cvt_pk_bf16_f32 v176, v248, v249
v_cvt_pk_bf16_f32 v177, v250, v251
v_cvt_pk_bf16_f32 v178, v252, v253
v_cvt_pk_bf16_f32 v179, v254, v255
v_mov_b32 v231, v230
v_accvgpr_read_b32 v240, a32
v_accvgpr_read_b32 v241, a33
v_accvgpr_read_b32 v242, a34
v_accvgpr_read_b32 v243, a35
v_accvgpr_read_b32 v244, a36
v_accvgpr_read_b32 v245, a37
v_accvgpr_read_b32 v246, a38
v_accvgpr_read_b32 v247, a39
v_pk_mul_f32 v[240:241], v[240:241], v[230:231]
v_pk_mul_f32 v[242:243], v[242:243], v[230:231]
v_pk_mul_f32 v[244:245], v[244:245], v[230:231]
v_pk_mul_f32 v[246:247], v[246:247], v[230:231]
v_cvt_pk_bf16_f32 v132, v240, v241
v_cvt_pk_bf16_f32 v133, v242, v243
v_cvt_pk_bf16_f32 v134, v244, v245
v_cvt_pk_bf16_f32 v135, v246, v247
v_accvgpr_read_b32 v248, a40
v_accvgpr_read_b32 v249, a41
v_accvgpr_read_b32 v250, a42
v_accvgpr_read_b32 v251, a43
v_accvgpr_read_b32 v252, a44
v_accvgpr_read_b32 v253, a45
v_accvgpr_read_b32 v254, a46
v_accvgpr_read_b32 v255, a47
v_pk_mul_f32 v[248:249], v[248:249], v[230:231]
v_pk_mul_f32 v[250:251], v[250:251], v[230:231]
v_pk_mul_f32 v[252:253], v[252:253], v[230:231]
v_pk_mul_f32 v[254:255], v[254:255], v[230:231]
v_cvt_pk_bf16_f32 v148, v248, v249
v_cvt_pk_bf16_f32 v149, v250, v251
v_cvt_pk_bf16_f32 v150, v252, v253
v_cvt_pk_bf16_f32 v151, v254, v255
v_accvgpr_read_b32 v240, a48
v_accvgpr_read_b32 v241, a49
v_accvgpr_read_b32 v242, a50
v_accvgpr_read_b32 v243, a51
v_accvgpr_read_b32 v244, a52
v_accvgpr_read_b32 v245, a53
v_accvgpr_read_b32 v246, a54
v_accvgpr_read_b32 v247, a55
v_pk_mul_f32 v[240:241], v[240:241], v[230:231]
v_pk_mul_f32 v[242:243], v[242:243], v[230:231]
v_pk_mul_f32 v[244:245], v[244:245], v[230:231]
v_pk_mul_f32 v[246:247], v[246:247], v[230:231]
v_cvt_pk_bf16_f32 v164, v240, v241
v_cvt_pk_bf16_f32 v165, v242, v243
v_cvt_pk_bf16_f32 v166, v244, v245
v_cvt_pk_bf16_f32 v167, v246, v247
v_accvgpr_read_b32 v248, a56
v_accvgpr_read_b32 v249, a57
v_accvgpr_read_b32 v250, a58
v_accvgpr_read_b32 v251, a59
v_accvgpr_read_b32 v252, a60
v_accvgpr_read_b32 v253, a61
v_accvgpr_read_b32 v254, a62
v_accvgpr_read_b32 v255, a63
v_pk_mul_f32 v[248:249], v[248:249], v[230:231]
v_pk_mul_f32 v[250:251], v[250:251], v[230:231]
v_pk_mul_f32 v[252:253], v[252:253], v[230:231]
v_pk_mul_f32 v[254:255], v[254:255], v[230:231]
v_cvt_pk_bf16_f32 v180, v248, v249
v_cvt_pk_bf16_f32 v181, v250, v251
v_cvt_pk_bf16_f32 v182, v252, v253
v_cvt_pk_bf16_f32 v183, v254, v255
v_mfma_f32_16x16x32_bf16 v[232:235], v[120:123], v[216:219], v[232:235]
s_add_u32 s82, s82, 0x8000
ds_read_b128 a[160:163], v2 offset:24576
ds_read_b128 a[164:167], v2 offset:25600
v_mfma_f32_16x16x32_bf16 v[232:235], v[120:123], v[200:203], v[232:235]
s_and_b32 s82, s82, 0x1ffff
v_exp_f32 v172, v172
v_mfma_f32_16x16x32_bf16 a[64:67], a[224:227], v[216:219], a[64:67]
s_add_u32 m0, s74, 0
v_exp_f32 v173, v173
v_mfma_f32_16x16x32_bf16 a[64:67], a[192:195], v[200:203], a[64:67]
s_add_u32 s72, s81, 0
buffer_load_dwordx4 v1, s[44:47], s72 offen sc1 lds
v_mfma_f32_16x16x32_bf16 a[68:71], a[196:199], v[200:203], a[68:71]
ds_read_b128 a[168:171], v2 offset:26624
v_cvt_pk_bf16_f32 v220, v172, v173
v_mfma_f32_16x16x32_bf16 a[68:71], a[228:231], v[216:219], a[68:71]
v_exp_f32 v174, v174
v_mfma_f32_16x16x32_bf16 a[72:75], a[232:235], v[216:219], a[72:75]
s_nop 0
ds_read_b128 a[172:175], v2 offset:27648
ds_read_b128 a[176:179], v2 offset:28672
v_mfma_f32_16x16x32_bf16 a[72:75], a[200:203], v[200:203], a[72:75]
v_exp_f32 v175, v175
v_mfma_f32_16x16x32_bf16 a[76:79], a[204:207], v[200:203], a[76:79]
v_exp_f32 v188, v188
v_mfma_f32_16x16x32_bf16 a[76:79], a[236:239], v[216:219], a[76:79]
buffer_store_dwordx4 v[128:131], v3, s[44:47], s70 offen sc1
v_mfma_f32_16x16x32_bf16 a[80:83], a[240:243], v[216:219], a[80:83]
s_waitcnt lgkmcnt(5)
ds_read_b128 a[180:183], v2 offset:29696
v_cvt_pk_bf16_f32 v221, v174, v175
v_mfma_f32_16x16x32_bf16 a[80:83], a[208:211], v[200:203], a[80:83]
v_exp_f32 v189, v189
v_mfma_f32_16x16x32_bf16 a[84:87], a[212:215], v[200:203], a[84:87]
ds_read_b128 a[184:187], v2 offset:30720
v_cvt_pk_bf16_f32 v222, v188, v189
v_mfma_f32_16x16x32_bf16 a[84:87], a[244:247], v[216:219], a[84:87]
v_exp_f32 v190, v190
v_mfma_f32_16x16x32_bf16 a[88:91], a[248:251], v[216:219], a[88:91]
buffer_load_dwordx4 v1, s[44:47], s72 offen offset:1024 sc1 lds
v_mfma_f32_16x16x32_bf16 a[88:91], a[216:219], v[200:203], a[88:91]
s_nop 0
ds_read_b128 a[188:191], v2 offset:31744
ds_read_b128 a[224:227], v2 offset:8192
v_mfma_f32_16x16x32_bf16 a[92:95], a[220:223], v[200:203], a[92:95]
v_exp_f32 v191, v191
v_mfma_f32_16x16x32_bf16 a[92:95], a[252:255], v[216:219], a[92:95]
v_exp_f32 v168, v168
v_mfma_f32_16x16x32_bf16 v[136:139], a[128:131], v[48:51], v[88:91]
ds_read_b128 a[228:231], v2 offset:9216
v_cvt_pk_bf16_f32 v223, v190, v191
v_mfma_f32_16x16x32_bf16 v[136:139], a[132:135], v[52:55], v[136:139]
v_exp_f32 v169, v169
v_mfma_f32_16x16x32_bf16 v[136:139], a[136:139], v[56:59], v[136:139]
buffer_store_dwordx4 v[144:147], v3, s[44:47], s70 offen offset:1024 sc1
v_mfma_f32_16x16x32_bf16 v[136:139], a[140:143], v[60:63], v[136:139]
ds_read_b128 a[232:235], v2 offset:10240
v_cvt_pk_bf16_f32 v216, v168, v169
v_mfma_f32_16x16x32_bf16 v[152:155], a[156:159], v[60:63], v[88:91]
v_exp_f32 v170, v170
v_mfma_f32_16x16x32_bf16 v[152:155], a[152:155], v[56:59], v[152:155]
s_nop 0
ds_read_b128 a[236:239], v2 offset:11264
ds_read_b128 a[240:243], v2 offset:12288
v_mfma_f32_16x16x32_bf16 v[152:155], a[148:151], v[52:55], v[152:155]
v_exp_f32 v171, v171
v_mfma_f32_16x16x32_bf16 v[152:155], a[144:147], v[48:51], v[152:155]
buffer_load_dwordx4 v1, s[44:47], s72 offen offset:2048 sc1 lds
v_mfma_f32_16x16x32_bf16 v[140:143], a[128:131], v[64:67], v[92:95]
v_exp_f32 v184, v184
v_mfma_f32_16x16x32_bf16 v[140:143], a[132:135], v[68:71], v[140:143]
ds_read_b128 a[244:247], v2 offset:13312
v_cvt_pk_bf16_f32 v217, v170, v171
v_mfma_f32_16x16x32_bf16 v[140:143], a[136:139], v[72:75], v[140:143]
v_exp_f32 v185, v185
v_mfma_f32_16x16x32_bf16 v[140:143], a[140:143], v[76:79], v[140:143]
s_nop 0
ds_read_b128 a[248:251], v2 offset:14336
ds_read_b128 a[252:255], v2 offset:15360
v_mfma_f32_16x16x32_bf16 v[156:159], a[156:159], v[76:79], v[92:95]
v_exp_f32 v186, v186
v_mfma_f32_16x16x32_bf16 v[156:159], a[152:155], v[72:75], v[156:159]
buffer_load_dwordx4 v1, s[44:47], s72 offen offset:3072 sc1 lds
v_mfma_f32_16x16x32_bf16 v[156:159], a[148:151], v[68:71], v[156:159]
s_waitcnt vmcnt(14) lgkmcnt(4)
v_exp_f32 v187, v187
v_mfma_f32_16x16x32_bf16 v[156:159], a[144:147], v[64:67], v[156:159]
s_barrier
v_cvt_pk_bf16_f32 v218, v184, v185
v_cvt_pk_bf16_f32 v219, v186, v187
v_add_u32 v2, s82, v1
v_mfma_f32_16x16x32_bf16 v[236:239], v[120:123], v[204:207], v[236:239]
s_xor_b32 s74, s82, 0x10000
v_exp_f32 v136, v136
v_mfma_f32_16x16x32_bf16 v[236:239], v[120:123], v[220:223], v[236:239]
s_add_u32 s74, s74, s64
ds_read_b128 a[128:131], v2 offset:16384
ds_read_b128 a[132:135], v2 offset:17408
v_mfma_f32_16x16x32_bf16 a[96:99], a[192:195], v[204:207], a[96:99]
s_add_u32 s81, s81, 0x8000
v_exp_f32 v137, v137
v_mfma_f32_16x16x32_bf16 a[96:99], a[224:227], v[220:223], a[96:99]
s_add_u32 m0, s74, 16384
v_exp_f32 v138, v138
v_mfma_f32_16x16x32_bf16 a[100:103], a[228:231], v[220:223], a[100:103]
s_add_u32 s72, s81, 16384
buffer_load_dwordx4 v1, s[44:47], s72 offen sc1 lds
v_mfma_f32_16x16x32_bf16 a[100:103], a[196:199], v[204:207], a[100:103]
ds_read_b128 a[136:139], v2 offset:18432
v_cvt_pk_bf16_f32 v200, v136, v137
v_mfma_f32_16x16x32_bf16 a[104:107], a[200:203], v[204:207], a[104:107]
v_exp_f32 v139, v139
v_mfma_f32_16x16x32_bf16 a[104:107], a[232:235], v[220:223], a[104:107]
ds_read_b128 a[140:143], v2 offset:19456
v_cvt_pk_bf16_f32 v201, v138, v139
v_mfma_f32_16x16x32_bf16 a[108:111], a[236:239], v[220:223], a[108:111]
buffer_store_dwordx4 v[160:163], v3, s[44:47], s70 offen offset:2048 sc1
v_mfma_f32_16x16x32_bf16 a[108:111], a[204:207], v[204:207], a[108:111]
v_exp_f32 v152, v152
v_mfma_f32_16x16x32_bf16 a[112:115], a[208:211], v[204:207], a[112:115]
s_waitcnt lgkmcnt(4)
ds_read_b128 a[144:147], v2 offset:20480
ds_read_b128 a[148:151], v2 offset:21504
v_mfma_f32_16x16x32_bf16 a[112:115], a[240:243], v[220:223], a[112:115]
v_exp_f32 v153, v153
v_mfma_f32_16x16x32_bf16 a[116:119], a[244:247], v[220:223], a[116:119]
buffer_load_dwordx4 v1, s[44:47], s72 offen offset:1024 sc1 lds
v_mfma_f32_16x16x32_bf16 a[116:119], a[212:215], v[204:207], a[116:119]
v_exp_f32 v154, v154
v_mfma_f32_16x16x32_bf16 a[120:123], a[216:219], v[204:207], a[120:123]
ds_read_b128 a[152:155], v2 offset:22528
v_cvt_pk_bf16_f32 v202, v152, v153
v_mfma_f32_16x16x32_bf16 a[120:123], a[248:251], v[220:223], a[120:123]
v_exp_f32 v155, v155
v_mfma_f32_16x16x32_bf16 a[124:127], a[252:255], v[220:223], a[124:127]
ds_read_b128 a[156:159], v2 offset:23552
v_cvt_pk_bf16_f32 v203, v154, v155
v_mfma_f32_16x16x32_bf16 a[124:127], a[220:223], v[204:207], a[124:127]
v_exp_f32 v140, v140
v_mfma_f32_16x16x32_bf16 v[172:175], a[160:163], v[64:67], v[92:95]
s_nop 0
ds_read_b128 a[192:195], v2 offset:0
ds_read_b128 a[196:199], v2 offset:1024
v_mfma_f32_16x16x32_bf16 v[172:175], a[164:167], v[68:71], v[172:175]
buffer_store_dwordx4 v[176:179], v3, s[44:47], s70 offen offset:3072 sc1
v_mfma_f32_16x16x32_bf16 v[172:175], a[168:171], v[72:75], v[172:175]
v_exp_f32 v141, v141
v_mfma_f32_16x16x32_bf16 v[172:175], a[172:175], v[76:79], v[172:175]
v_exp_f32 v142, v142
v_mfma_f32_16x16x32_bf16 v[188:191], a[188:191], v[76:79], v[92:95]
s_nop 0
ds_read_b128 a[200:203], v2 offset:2048
ds_read_b128 a[204:207], v2 offset:3072
v_mfma_f32_16x16x32_bf16 v[188:191], a[184:187], v[72:75], v[188:191]
buffer_load_dwordx4 v1, s[44:47], s72 offen offset:2048 sc1 lds
v_mfma_f32_16x16x32_bf16 v[188:191], a[180:183], v[68:71], v[188:191]
s_add_u32 s70, s70, 0x80000
v_exp_f32 v143, v143
v_mfma_f32_16x16x32_bf16 v[188:191], a[176:179], v[64:67], v[188:191]
v_exp_f32 v156, v156
v_mfma_f32_16x16x32_bf16 v[168:171], a[160:163], v[48:51], v[88:91]
s_nop 0
ds_read_b128 a[208:211], v2 offset:4096
ds_read_b128 a[212:215], v2 offset:5120
v_mfma_f32_16x16x32_bf16 v[168:171], a[164:167], v[52:55], v[168:171]
s_nop 0
ds_read_b128 a[216:219], v2 offset:6144
ds_read_b128 a[220:223], v2 offset:7168
v_mfma_f32_16x16x32_bf16 v[168:171], a[168:171], v[56:59], v[168:171]
v_cvt_pk_bf16_f32 v204, v140, v141
v_cvt_pk_bf16_f32 v205, v142, v143
v_mfma_f32_16x16x32_bf16 v[168:171], a[172:175], v[60:63], v[168:171]
buffer_store_dwordx4 v[132:135], v3, s[44:47], s70 offen sc1
v_mfma_f32_16x16x32_bf16 v[184:187], a[188:191], v[60:63], v[88:91]
v_exp_f32 v157, v157
v_mfma_f32_16x16x32_bf16 v[184:187], a[184:187], v[56:59], v[184:187]
v_exp_f32 v158, v158
v_mfma_f32_16x16x32_bf16 v[184:187], a[180:183], v[52:55], v[184:187]
buffer_load_dwordx4 v1, s[44:47], s72 offen offset:3072 sc1 lds
v_mfma_f32_16x16x32_bf16 v[184:187], a[176:179], v[48:51], v[184:187]
s_waitcnt lgkmcnt(4)
v_exp_f32 v159, v159
v_cvt_pk_bf16_f32 v206, v156, v157
v_cvt_pk_bf16_f32 v207, v158, v159
v_mfma_f32_16x16x32_bf16 v[232:235], v[120:123], v[216:219], v[232:235]
s_add_u32 s82, s82, 0x8000
ds_read_b128 a[160:163], v2 offset:24576
ds_read_b128 a[164:167], v2 offset:25600
v_mfma_f32_16x16x32_bf16 v[232:235], v[120:123], v[200:203], v[232:235]
s_and_b32 s82, s82, 0x1ffff
v_exp_f32 v172, v172
v_mfma_f32_16x16x32_bf16 a[64:67], a[224:227], v[216:219], a[64:67]
s_add_u32 m0, s74, 0
v_exp_f32 v173, v173
v_mfma_f32_16x16x32_bf16 a[64:67], a[192:195], v[200:203], a[64:67]
s_add_u32 s72, s81, 0
buffer_load_dwordx4 v1, s[44:47], s72 offen sc1 lds
v_mfma_f32_16x16x32_bf16 a[68:71], a[196:199], v[200:203], a[68:71]
ds_read_b128 a[168:171], v2 offset:26624
v_cvt_pk_bf16_f32 v220, v172, v173
v_mfma_f32_16x16x32_bf16 a[68:71], a[228:231], v[216:219], a[68:71]
v_exp_f32 v174, v174
v_mfma_f32_16x16x32_bf16 a[72:75], a[232:235], v[216:219], a[72:75]
s_nop 0
ds_read_b128 a[172:175], v2 offset:27648
ds_read_b128 a[176:179], v2 offset:28672
v_mfma_f32_16x16x32_bf16 a[72:75], a[200:203], v[200:203], a[72:75]
v_exp_f32 v175, v175
v_mfma_f32_16x16x32_bf16 a[76:79], a[204:207], v[200:203], a[76:79]
buffer_store_dwordx4 v[148:151], v3, s[44:47], s70 offen offset:1024 sc1
v_mfma_f32_16x16x32_bf16 a[76:79], a[236:239], v[216:219], a[76:79]
v_exp_f32 v188, v188
v_mfma_f32_16x16x32_bf16 a[80:83], a[240:243], v[216:219], a[80:83]
s_waitcnt lgkmcnt(5)
ds_read_b128 a[180:183], v2 offset:29696
v_cvt_pk_bf16_f32 v221, v174, v175
v_mfma_f32_16x16x32_bf16 a[80:83], a[208:211], v[200:203], a[80:83]
v_exp_f32 v189, v189
v_mfma_f32_16x16x32_bf16 a[84:87], a[212:215], v[200:203], a[84:87]
buffer_load_dwordx4 v1, s[44:47], s72 offen offset:1024 sc1 lds
v_mfma_f32_16x16x32_bf16 a[84:87], a[244:247], v[216:219], a[84:87]
ds_read_b128 a[184:187], v2 offset:30720
v_cvt_pk_bf16_f32 v222, v188, v189
v_mfma_f32_16x16x32_bf16 a[88:91], a[248:251], v[216:219], a[88:91]
v_exp_f32 v190, v190
v_mfma_f32_16x16x32_bf16 a[88:91], a[216:219], v[200:203], a[88:91]
s_nop 0
ds_read_b128 a[188:191], v2 offset:31744
ds_read_b128 a[224:227], v2 offset:8192
v_mfma_f32_16x16x32_bf16 a[92:95], a[220:223], v[200:203], a[92:95]
v_exp_f32 v191, v191
v_mfma_f32_16x16x32_bf16 a[92:95], a[252:255], v[216:219], a[92:95]
buffer_store_dwordx4 v[164:167], v3, s[44:47], s70 offen offset:2048 sc1
v_mfma_f32_16x16x32_bf16 v[136:139], a[128:131], v[48:51], v[88:91]
Lstub6:
s_cbranch_execz Lstub10
v_exp_f32 v168, v168
v_mfma_f32_16x16x32_bf16 v[136:139], a[132:135], v[52:55], v[136:139]
ds_read_b128 a[228:231], v2 offset:9216
v_cvt_pk_bf16_f32 v223, v190, v191
v_mfma_f32_16x16x32_bf16 v[136:139], a[136:139], v[56:59], v[136:139]
v_exp_f32 v169, v169
v_mfma_f32_16x16x32_bf16 v[136:139], a[140:143], v[60:63], v[136:139]
s_nop 0
ds_read_b128 a[232:235], v2 offset:10240
ds_read_b128 a[236:239], v2 offset:11264
v_mfma_f32_16x16x32_bf16 v[152:155], a[156:159], v[60:63], v[88:91]
v_exp_f32 v170, v170
v_mfma_f32_16x16x32_bf16 v[152:155], a[152:155], v[56:59], v[152:155]
buffer_load_dwordx4 v1, s[44:47], s72 offen offset:2048 sc1 lds
v_mfma_f32_16x16x32_bf16 v[152:155], a[148:151], v[52:55], v[152:155]
v_exp_f32 v171, v171
v_mfma_f32_16x16x32_bf16 v[152:155], a[144:147], v[48:51], v[152:155]
s_nop 0
ds_read_b128 a[240:243], v2 offset:12288
ds_read_b128 a[244:247], v2 offset:13312
v_mfma_f32_16x16x32_bf16 v[140:143], a[128:131], v[64:67], v[92:95]
v_exp_f32 v184, v184
v_mfma_f32_16x16x32_bf16 v[140:143], a[132:135], v[68:71], v[140:143]
s_nop 0
ds_read_b128 a[248:251], v2 offset:14336
ds_read_b128 a[252:255], v2 offset:15360
v_mfma_f32_16x16x32_bf16 v[140:143], a[136:139], v[72:75], v[140:143]
v_cvt_pk_bf16_f32 v216, v168, v169
v_cvt_pk_bf16_f32 v217, v170, v171
v_mfma_f32_16x16x32_bf16 v[140:143], a[140:143], v[76:79], v[140:143]
buffer_store_dwordx4 v[180:183], v3, s[44:47], s70 offen offset:3072 sc1
v_mfma_f32_16x16x32_bf16 v[156:159], a[156:159], v[76:79], v[92:95]
v_exp_f32 v185, v185
v_mfma_f32_16x16x32_bf16 v[156:159], a[152:155], v[72:75], v[156:159]
buffer_load_dwordx4 v1, s[44:47], s72 offen offset:3072 sc1 lds
v_mfma_f32_16x16x32_bf16 v[156:159], a[148:151], v[68:71], v[156:159]
s_waitcnt vmcnt(14) lgkmcnt(4)
v_exp_f32 v186, v186
v_mfma_f32_16x16x32_bf16 v[156:159], a[144:147], v[64:67], v[156:159]
s_barrier
v_exp_f32 v187, v187
v_add_u32 v2, s82, v1
v_cvt_pk_bf16_f32 v218, v184, v185
v_cvt_pk_bf16_f32 v219, v186, v187
s_lshl_b32 s83, s60, 2
s_sub_u32 s83, s83, 25
.p2align 5
s_nop 0
s_nop 0
LloopII:
v_mfma_f32_16x16x32_bf16 v[236:239], v[120:123], v[204:207], v[236:239]
s_xor_b32 s74, s82, 0x10000
v_exp_f32 v136, v136
v_mfma_f32_16x16x32_bf16 v[236:239], v[120:123], v[220:223], v[236:239]
s_add_u32 s74, s74, s64
ds_read_b128 a[128:131], v2 offset:16384
ds_read_b128 a[132:135], v2 offset:17408
v_mfma_f32_16x16x32_bf16 a[96:99], a[192:195], v[204:207], a[96:99]
s_add_u32 s81, s81, 0x8000
v_exp_f32 v137, v137
v_mfma_f32_16x16x32_bf16 a[96:99], a[224:227], v[220:223], a[96:99]
s_add_u32 m0, s74, 16384
v_exp_f32 v138, v138
v_mfma_f32_16x16x32_bf16 a[100:103], a[228:231], v[220:223], a[100:103]
s_add_u32 s72, s81, 16384
ds_read_b128 a[136:139], v2 offset:18432
v_cvt_pk_bf16_f32 v200, v136, v137
v_mfma_f32_16x16x32_bf16 a[100:103], a[196:199], v[204:207], a[100:103]
buffer_load_dwordx4 v1, s[44:47], s72 offen sc1 lds
v_mfma_f32_16x16x32_bf16 a[104:107], a[200:203], v[204:207], a[104:107]
v_exp_f32 v139, v139
v_mfma_f32_16x16x32_bf16 a[104:107], a[232:235], v[220:223], a[104:107]
ds_read_b128 a[140:143], v2 offset:19456
v_cvt_pk_bf16_f32 v201, v138, v139
v_mfma_f32_16x16x32_bf16 a[108:111], a[236:239], v[220:223], a[108:111]
v_exp_f32 v152, v152
v_mfma_f32_16x16x32_bf16 a[108:111], a[204:207], v[204:207], a[108:111]
s_nop 0
ds_read_b128 a[144:147], v2 offset:20480
ds_read_b128 a[148:151], v2 offset:21504
v_mfma_f32_16x16x32_bf16 a[112:115], a[208:211], v[204:207], a[112:115]
s_waitcnt lgkmcnt(6)
v_exp_f32 v153, v153
v_mfma_f32_16x16x32_bf16 a[112:115], a[240:243], v[220:223], a[112:115]
v_exp_f32 v154, v154
v_mfma_f32_16x16x32_bf16 a[116:119], a[244:247], v[220:223], a[116:119]
ds_read_b128 a[152:155], v2 offset:22528
v_cvt_pk_bf16_f32 v202, v152, v153
v_mfma_f32_16x16x32_bf16 a[116:119], a[212:215], v[204:207], a[116:119]
buffer_load_dwordx4 v1, s[44:47], s72 offen offset:1024 sc1 lds
v_mfma_f32_16x16x32_bf16 a[120:123], a[216:219], v[204:207], a[120:123]
v_exp_f32 v155, v155
v_mfma_f32_16x16x32_bf16 a[120:123], a[248:251], v[220:223], a[120:123]
ds_read_b128 a[156:159], v2 offset:23552
v_cvt_pk_bf16_f32 v203, v154, v155
v_mfma_f32_16x16x32_bf16 a[124:127], a[252:255], v[220:223], a[124:127]
v_exp_f32 v140, v140
v_mfma_f32_16x16x32_bf16 a[124:127], a[220:223], v[204:207], a[124:127]
s_nop 0
ds_read_b128 a[192:195], v2 offset:0
ds_read_b128 a[196:199], v2 offset:1024
v_mfma_f32_16x16x32_bf16 v[172:175], a[160:163], v[64:67], v[92:95]
v_exp_f32 v141, v141
v_mfma_f32_16x16x32_bf16 v[172:175], a[164:167], v[68:71], v[172:175]
v_exp_f32 v142, v142
v_mfma_f32_16x16x32_bf16 v[172:175], a[168:171], v[72:75], v[172:175]
ds_read_b128 a[200:203], v2 offset:2048
v_cvt_pk_bf16_f32 v204, v140, v141
v_mfma_f32_16x16x32_bf16 v[172:175], a[172:175], v[76:79], v[172:175]
buffer_load_dwordx4 v1, s[44:47], s72 offen offset:2048 sc1 lds
v_mfma_f32_16x16x32_bf16 v[188:191], a[188:191], v[76:79], v[92:95]
v_exp_f32 v143, v143
v_mfma_f32_16x16x32_bf16 v[188:191], a[184:187], v[72:75], v[188:191]
ds_read_b128 a[204:207], v2 offset:3072
v_cvt_pk_bf16_f32 v205, v142, v143
v_mfma_f32_16x16x32_bf16 v[188:191], a[180:183], v[68:71], v[188:191]
v_exp_f32 v156, v156
v_mfma_f32_16x16x32_bf16 v[188:191], a[176:179], v[64:67], v[188:191]
ds_read_b128 a[208:211], v2 offset:4096
v_mfma_f32_16x16x32_bf16 v[168:171], a[160:163], v[48:51], v[88:91]
v_exp_f32 v157, v157
v_mfma_f32_16x16x32_bf16 v[168:171], a[164:167], v[52:55], v[168:171]
ds_read_b128 a[212:215], v2 offset:5120
v_cvt_pk_bf16_f32 v206, v156, v157
v_mfma_f32_16x16x32_bf16 v[168:171], a[168:171], v[56:59], v[168:171]
v_exp_f32 v158, v158
v_mfma_f32_16x16x32_bf16 v[168:171], a[172:175], v[60:63], v[168:171]
ds_read_b128 a[216:219], v2 offset:6144
v_mfma_f32_16x16x32_bf16 v[184:187], a[188:191], v[60:63], v[88:91]
buffer_load_dwordx4 v1, s[44:47], s72 offen offset:3072 sc1 lds
v_mfma_f32_16x16x32_bf16 v[184:187], a[184:187], v[56:59], v[184:187]
v_exp_f32 v159, v159
v_mfma_f32_16x16x32_bf16 v[184:187], a[180:183], v[52:55], v[184:187]
ds_read_b128 a[220:223], v2 offset:7168
v_cvt_pk_bf16_f32 v207, v158, v159
v_mfma_f32_16x16x32_bf16 v[184:187], a[176:179], v[48:51], v[184:187]
s_waitcnt lgkmcnt(4)
v_mfma_f32_16x16x32_bf16 v[232:235], v[120:123], v[216:219], v[232:235]
s_add_u32 s82, s82, 0x8000
ds_read_b128 a[160:163], v2 offset:24576
ds_read_b128 a[164:167], v2 offset:25600
v_mfma_f32_16x16x32_bf16 v[232:235], v[120:123], v[200:203], v[232:235]
s_and_b32 s82, s82, 0x1ffff
v_exp_f32 v172, v172
v_mfma_f32_16x16x32_bf16 a[64:67], a[224:227], v[216:219], a[64:67]
s_add_u32 m0, s74, 0
v_exp_f32 v173, v173
v_mfma_f32_16x16x32_bf16 a[64:67], a[192:195], v[200:203], a[64:67]
s_add_u32 s72, s81, 0
ds_read_b128 a[168:171], v2 offset:26624
v_cvt_pk_bf16_f32 v220, v172, v173
v_mfma_f32_16x16x32_bf16 a[68:71], a[196:199], v[200:203], a[68:71]
v_exp_f32 v174, v174
v_mfma_f32_16x16x32_bf16 a[68:71], a[228:231], v[216:219], a[68:71]
buffer_load_dwordx4 v1, s[44:47], s72 offen sc1 lds
v_mfma_f32_16x16x32_bf16 a[72:75], a[232:235], v[216:219], a[72:75]
s_nop 0
ds_read_b128 a[172:175], v2 offset:27648
ds_read_b128 a[176:179], v2 offset:28672
v_mfma_f32_16x16x32_bf16 a[72:75], a[200:203], v[200:203], a[72:75]
v_exp_f32 v175, v175
v_mfma_f32_16x16x32_bf16 a[76:79], a[204:207], v[200:203], a[76:79]
v_exp_f32 v188, v188
v_mfma_f32_16x16x32_bf16 a[76:79], a[236:239], v[216:219], a[76:79]
ds_read_b128 a[180:183], v2 offset:29696
v_cvt_pk_bf16_f32 v221, v174, v175
v_mfma_f32_16x16x32_bf16 a[80:83], a[240:243], v[216:219], a[80:83]
s_waitcnt lgkmcnt(6)
v_exp_f32 v189, v189
v_mfma_f32_16x16x32_bf16 a[80:83], a[208:211], v[200:203], a[80:83]
ds_read_b128 a[184:187], v2 offset:30720
v_cvt_pk_bf16_f32 v222, v188, v189
v_mfma_f32_16x16x32_bf16 a[84:87], a[212:215], v[200:203], a[84:87]
buffer_load_dwordx4 v1, s[44:47], s72 offen offset:1024 sc1 lds
v_mfma_f32_16x16x32_bf16 a[84:87], a[244:247], v[216:219], a[84:87]
v_exp_f32 v190, v190
v_mfma_f32_16x16x32_bf16 a[88:91], a[248:251], v[216:219], a[88:91]
s_nop 0
ds_read_b128 a[188:191], v2 offset:31744
ds_read_b128 a[224:227], v2 offset:8192
v_mfma_f32_16x16x32_bf16 a[88:91], a[216:219], v[200:203], a[88:91]
v_exp_f32 v191, v191
v_mfma_f32_16x16x32_bf16 a[92:95], a[220:223], v[200:203], a[92:95]
v_exp_f32 v168, v168
v_mfma_f32_16x16x32_bf16 a[92:95], a[252:255], v[216:219], a[92:95]
ds_read_b128 a[228:231], v2 offset:9216
v_cvt_pk_bf16_f32 v223, v190, v191
v_mfma_f32_16x16x32_bf16 v[136:139], a[128:131], v[48:51], v[88:91]
v_exp_f32 v169, v169
v_mfma_f32_16x16x32_bf16 v[136:139], a[132:135], v[52:55], v[136:139]
ds_read_b128 a[232:235], v2 offset:10240
v_cvt_pk_bf16_f32 v216, v168, v169
v_mfma_f32_16x16x32_bf16 v[136:139], a[136:139], v[56:59], v[136:139]
buffer_load_dwordx4 v1, s[44:47], s72 offen offset:2048 sc1 lds
v_mfma_f32_16x16x32_bf16 v[136:139], a[140:143], v[60:63], v[136:139]
v_exp_f32 v170, v170
v_mfma_f32_16x16x32_bf16 v[152:155], a[156:159], v[60:63], v[88:91]
s_nop 0
ds_read_b128 a[236:239], v2 offset:11264
ds_read_b128 a[240:243], v2 offset:12288
v_mfma_f32_16x16x32_bf16 v[152:155], a[152:155], v[56:59], v[152:155]
v_exp_f32 v171, v171
v_mfma_f32_16x16x32_bf16 v[152:155], a[148:151], v[52:55], v[152:155]
v_exp_f32 v184, v184
v_mfma_f32_16x16x32_bf16 v[152:155], a[144:147], v[48:51], v[152:155]
ds_read_b128 a[244:247], v2 offset:13312
v_cvt_pk_bf16_f32 v217, v170, v171
v_mfma_f32_16x16x32_bf16 v[140:143], a[128:131], v[64:67], v[92:95]
v_exp_f32 v185, v185
v_mfma_f32_16x16x32_bf16 v[140:143], a[132:135], v[68:71], v[140:143]
ds_read_b128 a[248:251], v2 offset:14336
v_cvt_pk_bf16_f32 v218, v184, v185
v_mfma_f32_16x16x32_bf16 v[140:143], a[136:139], v[72:75], v[140:143]
buffer_load_dwordx4 v1, s[44:47], s72 offen offset:3072 sc1 lds
v_mfma_f32_16x16x32_bf16 v[140:143], a[140:143], v[76:79], v[140:143]
ds_read_b128 a[252:255], v2 offset:15360
v_add_u32 v2, s82, v1
v_mfma_f32_16x16x32_bf16 v[156:159], a[156:159], v[76:79], v[92:95]
s_waitcnt vmcnt(8) lgkmcnt(4)
v_exp_f32 v186, v186
v_mfma_f32_16x16x32_bf16 v[156:159], a[152:155], v[72:75], v[156:159]
s_barrier
v_exp_f32 v187, v187
v_mfma_f32_16x16x32_bf16 v[156:159], a[148:151], v[68:71], v[156:159]
s_add_u32 s83, s83, 1
v_cvt_pk_bf16_f32 v219, v186, v187
v_mfma_f32_16x16x32_bf16 v[156:159], a[144:147], v[64:67], v[156:159]
s_cbranch_scc0 LloopII
v_mfma_f32_16x16x32_bf16 v[236:239], v[120:123], v[204:207], v[236:239]
s_xor_b32 s74, s82, 0x10000
ds_read_b128 a[128:131], v2 offset:16384
ds_read_b128 a[132:135], v2 offset:17408
v_mfma_f32_16x16x32_bf16 v[236:239], v[120:123], v[220:223], v[236:239]
s_add_u32 s74, s74, s64
v_exp_f32 v136, v136
v_mfma_f32_16x16x32_bf16 a[96:99], a[192:195], v[204:207], a[96:99]
s_add_u32 s81, s81, 0x8000
v_exp_f32 v137, v137
v_mfma_f32_16x16x32_bf16 a[96:99], a[224:227], v[220:223], a[96:99]
s_add_u32 m0, s74, 0
ds_read_b128 a[136:139], v2 offset:18432
v_cvt_pk_bf16_f32 v200, v136, v137
v_mfma_f32_16x16x32_bf16 a[100:103], a[228:231], v[220:223], a[100:103]
s_add_u32 s72, s81, 0
v_exp_f32 v138, v138
v_mfma_f32_16x16x32_bf16 a[100:103], a[196:199], v[204:207], a[100:103]
buffer_load_dwordx4 v1, s[44:47], s72 offen sc1 lds
v_mfma_f32_16x16x32_bf16 a[104:107], a[200:203], v[204:207], a[104:107]
s_nop 0
ds_read_b128 a[140:143], v2 offset:19456
ds_read_b128 a[144:147], v2 offset:20480
v_mfma_f32_16x16x32_bf16 a[104:107], a[232:235], v[220:223], a[104:107]
v_exp_f32 v139, v139
v_mfma_f32_16x16x32_bf16 a[108:111], a[236:239], v[220:223], a[108:111]
v_exp_f32 v152, v152
v_mfma_f32_16x16x32_bf16 a[108:111], a[204:207], v[204:207], a[108:111]
ds_read_b128 a[148:151], v2 offset:21504
v_cvt_pk_bf16_f32 v201, v138, v139
v_mfma_f32_16x16x32_bf16 a[112:115], a[208:211], v[204:207], a[112:115]
s_waitcnt lgkmcnt(6)
v_exp_f32 v153, v153
v_mfma_f32_16x16x32_bf16 a[112:115], a[240:243], v[220:223], a[112:115]
ds_read_b128 a[152:155], v2 offset:22528
v_cvt_pk_bf16_f32 v202, v152, v153
v_mfma_f32_16x16x32_bf16 a[116:119], a[244:247], v[220:223], a[116:119]
v_exp_f32 v154, v154
v_mfma_f32_16x16x32_bf16 a[116:119], a[212:215], v[204:207], a[116:119]
buffer_load_dwordx4 v1, s[44:47], s72 offen offset:1024 sc1 lds
v_mfma_f32_16x16x32_bf16 a[120:123], a[216:219], v[204:207], a[120:123]
s_nop 0
ds_read_b128 a[156:159], v2 offset:23552
ds_read_b128 a[192:195], v2 offset:0
v_mfma_f32_16x16x32_bf16 a[120:123], a[248:251], v[220:223], a[120:123]
v_exp_f32 v155, v155
v_mfma_f32_16x16x32_bf16 a[124:127], a[252:255], v[220:223], a[124:127]
v_exp_f32 v140, v140
v_mfma_f32_16x16x32_bf16 a[124:127], a[220:223], v[204:207], a[124:127]
ds_read_b128 a[196:199], v2 offset:1024
v_cvt_pk_bf16_f32 v203, v154, v155
v_mfma_f32_16x16x32_bf16 v[172:175], a[160:163], v[64:67], v[92:95]
v_exp_f32 v141, v141
v_mfma_f32_16x16x32_bf16 v[172:175], a[164:167], v[68:71], v[172:175]
ds_read_b128 a[200:203], v2 offset:2048
v_cvt_pk_bf16_f32 v204, v140, v141
v_mfma_f32_16x16x32_bf16 v[172:175], a[168:171], v[72:75], v[172:175]
v_exp_f32 v142, v142
v_mfma_f32_16x16x32_bf16 v[172:175], a[172:175], v[76:79], v[172:175]
buffer_load_dwordx4 v1, s[44:47], s72 offen offset:2048 sc1 lds
v_mfma_f32_16x16x32_bf16 v[188:191], a[188:191], v[76:79], v[92:95]
ds_read_b128 a[204:207], v2 offset:3072
v_mfma_f32_16x16x32_bf16 v[188:191], a[184:187], v[72:75], v[188:191]
v_exp_f32 v143, v143
v_mfma_f32_16x16x32_bf16 v[188:191], a[180:183], v[68:71], v[188:191]
ds_read_b128 a[208:211], v2 offset:4096
v_cvt_pk_bf16_f32 v205, v142, v143
v_mfma_f32_16x16x32_bf16 v[188:191], a[176:179], v[64:67], v[188:191]
v_exp_f32 v156, v156
v_mfma_f32_16x16x32_bf16 v[168:171], a[160:163], v[48:51], v[88:91]
ds_read_b128 a[212:215], v2 offset:5120
v_mfma_f32_16x16x32_bf16 v[168:171], a[164:167], v[52:55], v[168:171]
v_exp_f32 v157, v157
v_mfma_f32_16x16x32_bf16 v[168:171], a[168:171], v[56:59], v[168:171]
ds_read_b128 a[216:219], v2 offset:6144
v_cvt_pk_bf16_f32 v206, v156, v157
v_mfma_f32_16x16x32_bf16 v[168:171], a[172:175], v[60:63], v[168:171]
buffer_load_dwordx4 v1, s[44:47], s72 offen offset:3072 sc1 lds
v_mfma_f32_16x16x32_bf16 v[184:187], a[188:191], v[60:63], v[88:91]
v_exp_f32 v158, v158
v_mfma_f32_16x16x32_bf16 v[184:187], a[184:187], v[56:59], v[184:187]
ds_read_b128 a[220:223], v2 offset:7168
v_mfma_f32_16x16x32_bf16 v[184:187], a[180:183], v[52:55], v[184:187]
s_waitcnt lgkmcnt(4)
v_exp_f32 v159, v159
v_mfma_f32_16x16x32_bf16 v[184:187], a[176:179], v[48:51], v[184:187]
s_barrier
v_cvt_pk_bf16_f32 v207, v158, v159
s_lshr_b32 s69, s93, 4
s_and_b32 s69, s69, 0x7f00
s_add_u32 s69, s69, LHT4-Lpc0
v_lshrrev_b32 v3, 5, v0
v_lshlrev_b32 v3, 7, v3
v_add_u32 v3, s69, v3
v_min_u32 v3, Lcode_end-Lpc0, v3
global_load_dword v4, v3, s[98:99]
v_mfma_f32_16x16x32_bf16 v[232:235], v[120:123], v[216:219], v[232:235]
s_add_u32 s82, s82, 0x8000
ds_read_b128 a[160:163], v2 offset:24576
ds_read_b128 a[164:167], v2 offset:25600
v_mfma_f32_16x16x32_bf16 v[232:235], v[120:123], v[200:203], v[232:235]
s_and_b32 s82, s82, 0x1ffff
v_exp_f32 v172, v172
v_mfma_f32_16x16x32_bf16 a[64:67], a[224:227], v[216:219], a[64:67]
s_add_u32 s66, s58, 3
v_exp_f32 v173, v173
v_mfma_f32_16x16x32_bf16 a[64:67], a[192:195], v[200:203], a[64:67]
s_and_b32 s66, s66, 3
ds_read_b128 a[168:171], v2 offset:26624
v_cvt_pk_bf16_f32 v220, v172, v173
v_mfma_f32_16x16x32_bf16 a[68:71], a[196:199], v[200:203], a[68:71]
s_mul_i32 s66, s66, 4160
v_exp_f32 v174, v174
v_mfma_f32_16x16x32_bf16 a[68:71], a[228:231], v[216:219], a[68:71]
s_add_u32 s66, s66, s92
ds_read_b128 a[172:175], v2 offset:27648
ds_read_b128 a[176:179], v2 offset:28672
v_mfma_f32_16x16x32_bf16 a[72:75], a[232:235], v[216:219], a[72:75]
s_add_u32 m0, s66, 32
v_exp_f32 v175, v175
v_mfma_f32_16x16x32_bf16 a[72:75], a[200:203], v[200:203], a[72:75]
s_add_u32 s72, s93, 0x6
buffer_load_dwordx4 v1, s[36:39], s72 offen lds
v_mfma_f32_16x16x32_bf16 a[76:79], a[204:207], v[200:203], a[76:79]
v_exp_f32 v188, v188
v_mfma_f32_16x16x32_bf16 a[76:79], a[236:239], v[216:219], a[76:79]
ds_read_b128 a[180:183], v2 offset:29696
v_cvt_pk_bf16_f32 v221, v174, v175
v_mfma_f32_16x16x32_bf16 a[80:83], a[240:243], v[216:219], a[80:83]
s_waitcnt lgkmcnt(6)
v_exp_f32 v189, v189
v_mfma_f32_16x16x32_bf16 a[80:83], a[208:211], v[200:203], a[80:83]
ds_read_b128 a[184:187], v2 offset:30720
v_cvt_pk_bf16_f32 v222, v188, v189
v_mfma_f32_16x16x32_bf16 a[84:87], a[212:215], v[200:203], a[84:87]
v_exp_f32 v190, v190
v_mfma_f32_16x16x32_bf16 a[84:87], a[244:247], v[216:219], a[84:87]
buffer_load_dwordx4 v1, s[36:39], s72 offen offset:1024 lds
v_mfma_f32_16x16x32_bf16 a[88:91], a[248:251], v[216:219], a[88:91]
s_nop 0
ds_read_b128 a[188:191], v2 offset:31744
ds_read_b128 a[224:227], v2 offset:8192
v_mfma_f32_16x16x32_bf16 a[88:91], a[216:219], v[200:203], a[88:91]
v_exp_f32 v191, v191
v_mfma_f32_16x16x32_bf16 a[92:95], a[220:223], v[200:203], a[92:95]
v_exp_f32 v168, v168
v_mfma_f32_16x16x32_bf16 a[92:95], a[252:255], v[216:219], a[92:95]
ds_read_b128 a[228:231], v2 offset:9216
v_cvt_pk_bf16_f32 v223, v190, v191
s_cmp_eq_u32 s58, 0
s_cbranch_scc1 Lta28
s_cmp_eq_u32 s58, 1
s_cbranch_scc1 Lnt29
v_mfma_f32_16x16x32_bf16 v[136:139], a[128:131], v[48:51], v[88:91]
v_exp_f32 v169, v169
v_mfma_f32_16x16x32_bf16 v[152:155], a[144:147], v[48:51], v[88:91]
ds_read_b128 a[232:235], v2 offset:10240
v_cvt_pk_bf16_f32 v216, v168, v169
s_branch Ljoin30
Lta28:
v_mfma_f32_16x16x32_bf16 v[136:139], a[128:131], v[48:51], v[104:107]
v_exp_f32 v169, v169
v_mfma_f32_16x16x32_bf16 v[152:155], a[144:147], v[48:51], v[112:115]
ds_read_b128 a[232:235], v2 offset:10240
v_cvt_pk_bf16_f32 v216, v168, v169
s_branch Ljoin30
Lnt29:
v_mfma_f32_16x16x32_bf16 v[136:139], a[128:131], v[48:51], v[88:91]
v_exp_f32 v169, v169
v_mfma_f32_16x16x32_bf16 v[152:155], a[144:147], v[48:51], v[104:107]
ds_read_b128 a[232:235], v2 offset:10240
v_cvt_pk_bf16_f32 v216, v168, v169
Ljoin30:
v_mfma_f32_16x16x32_bf16 v[136:139], a[132:135], v[52:55], v[136:139]
v_exp_f32 v170, v170
v_mfma_f32_16x16x32_bf16 v[136:139], a[136:139], v[56:59], v[136:139]
buffer_load_dwordx4 v1, s[36:39], s72 offen offset:2048 lds
v_mfma_f32_16x16x32_bf16 v[136:139], a[140:143], v[60:63], v[136:139]
ds_read_b128 a[236:239], v2 offset:11264
v_mfma_f32_16x16x32_bf16 v[152:155], a[156:159], v[60:63], v[152:155]
v_exp_f32 v171, v171
v_mfma_f32_16x16x32_bf16 v[152:155], a[152:155], v[56:59], v[152:155]
ds_read_b128 a[240:243], v2 offset:12288
v_cvt_pk_bf16_f32 v217, v170, v171
v_mfma_f32_16x16x32_bf16 v[152:155], a[148:151], v[52:55], v[152:155]
v_exp_f32 v184, v184
v_mfma_f32_16x16x32_bf16 v[140:143], a[128:131], v[64:67], v[92:95]
ds_read_b128 a[244:247], v2 offset:13312
v_mfma_f32_16x16x32_bf16 v[140:143], a[132:135], v[68:71], v[140:143]
v_exp_f32 v185, v185
v_mfma_f32_16x16x32_bf16 v[140:143], a[136:139], v[72:75], v[140:143]
ds_read_b128 a[248:251], v2 offset:14336
v_cvt_pk_bf16_f32 v218, v184, v185
v_mfma_f32_16x16x32_bf16 v[140:143], a[140:143], v[76:79], v[140:143]
buffer_load_dwordx4 v1, s[36:39], s72 offen offset:3072 lds
v_mfma_f32_16x16x32_bf16 v[156:159], a[156:159], v[76:79], v[92:95]
v_exp_f32 v186, v186
v_mfma_f32_16x16x32_bf16 v[156:159], a[152:155], v[72:75], v[156:159]
ds_read_b128 a[252:255], v2 offset:15360
v_add_u32 v2, s82, v1
v_mfma_f32_16x16x32_bf16 v[156:159], a[148:151], v[68:71], v[156:159]
s_waitcnt vmcnt(9) lgkmcnt(0)
v_exp_f32 v187, v187
v_mfma_f32_16x16x32_bf16 v[156:159], a[144:147], v[64:67], v[156:159]
s_barrier
v_cvt_pk_bf16_f32 v219, v186, v187
v_mfma_f32_16x16x32_bf16 v[236:239], v[120:123], v[204:207], v[236:239]
s_mov_b32 m0, s62
v_exp_f32 v136, v136
v_mfma_f32_16x16x32_bf16 v[236:239], v[120:123], v[220:223], v[236:239]
s_add_u32 s72, s93, 0x3000000
ds_read_b128 a[128:131], v2 offset:16384
ds_read_b128 a[132:135], v2 offset:17408
v_mfma_f32_16x16x32_bf16 a[96:99], a[192:195], v[204:207], a[96:99]
s_add_u32 s78, s59, 8
v_exp_f32 v137, v137
v_mfma_f32_16x16x32_bf16 a[96:99], a[224:227], v[220:223], a[96:99]
s_and_b32 s78, s78, 24
buffer_load_dwordx4 v1, s[44:47], s72 offen sc1 lds
v_mfma_f32_16x16x32_bf16 a[100:103], a[228:231], v[220:223], a[100:103]
s_lshr_b32 s79, 0x67234501, s78
v_exp_f32 v138, v138
v_mfma_f32_16x16x32_bf16 a[100:103], a[196:199], v[204:207], a[100:103]
s_and_b32 s79, s79, 7
ds_read_b128 a[136:139], v2 offset:18432
v_cvt_pk_bf16_f32 v200, v136, v137
v_mfma_f32_16x16x32_bf16 a[104:107], a[200:203], v[204:207], a[104:107]
s_lshl_b32 s79, s79, 18
v_exp_f32 v139, v139
v_mfma_f32_16x16x32_bf16 a[104:107], a[232:235], v[220:223], a[104:107]
s_add_u32 s79, s79, s94
ds_read_b128 a[140:143], v2 offset:19456
v_cvt_pk_bf16_f32 v201, v138, v139
v_mfma_f32_16x16x32_bf16 a[108:111], a[236:239], v[220:223], a[108:111]
s_add_u32 s12, s61, 0
v_exp_f32 v152, v152
v_mfma_f32_16x16x32_bf16 a[108:111], a[204:207], v[204:207], a[108:111]
s_and_b32 s12, s12, 3
ds_read_b128 a[144:147], v2 offset:20480
ds_read_b128 a[148:151], v2 offset:21504
v_mfma_f32_16x16x32_bf16 a[112:115], a[208:211], v[204:207], a[112:115]
s_waitcnt lgkmcnt(6)
buffer_load_dwordx4 v1, s[44:47], s72 offen offset:1024 sc1 lds
v_mfma_f32_16x16x32_bf16 a[112:115], a[240:243], v[220:223], a[112:115]
s_lshl_b32 s12, s12, 21
v_exp_f32 v153, v153
v_mfma_f32_16x16x32_bf16 a[116:119], a[244:247], v[220:223], a[116:119]
s_add_u32 s12, s12, s79
v_exp_f32 v154, v154
v_mfma_f32_16x16x32_bf16 a[116:119], a[212:215], v[204:207], a[116:119]
s_add_u32 s13, s61, 1
ds_read_b128 a[152:155], v2 offset:22528
v_cvt_pk_bf16_f32 v202, v152, v153
v_mfma_f32_16x16x32_bf16 a[120:123], a[216:219], v[204:207], a[120:123]
s_and_b32 s13, s13, 3
buffer_load_dwordx4 v1, s[44:47], s72 offen offset:2048 sc1 lds
v_mfma_f32_16x16x32_bf16 a[120:123], a[248:251], v[220:223], a[120:123]
s_lshl_b32 s13, s13, 21
v_exp_f32 v155, v155
v_mfma_f32_16x16x32_bf16 a[124:127], a[252:255], v[220:223], a[124:127]
s_add_u32 s13, s13, s79
ds_read_b128 a[156:159], v2 offset:23552
v_cvt_pk_bf16_f32 v203, v154, v155
v_mfma_f32_16x16x32_bf16 a[124:127], a[220:223], v[204:207], a[124:127]
s_add_u32 s14, s61, 2
v_exp_f32 v140, v140
s_cmp_eq_u32 s58, 2
s_cbranch_scc1 Lta31
s_cmp_eq_u32 s58, 3
s_cbranch_scc1 Lnt32
v_mfma_f32_16x16x32_bf16 v[168:171], a[160:163], v[48:51], v[112:115]
s_and_b32 s14, s14, 3
ds_read_b128 a[192:195], v2 offset:0
ds_read_b128 a[196:199], v2 offset:1024
v_mfma_f32_16x16x32_bf16 v[184:187], a[176:179], v[48:51], v[112:115]
s_lshl_b32 s14, s14, 21
v_exp_f32 v141, v141
s_branch Ljoin33
Lta31:
v_mfma_f32_16x16x32_bf16 v[168:171], a[160:163], v[48:51], v[104:107]
s_and_b32 s14, s14, 3
ds_read_b128 a[192:195], v2 offset:0
ds_read_b128 a[196:199], v2 offset:1024
v_mfma_f32_16x16x32_bf16 v[184:187], a[176:179], v[48:51], v[112:115]
s_lshl_b32 s14, s14, 21
v_exp_f32 v141, v141
s_branch Ljoin33
Lnt32:
v_mfma_f32_16x16x32_bf16 v[168:171], a[160:163], v[48:51], v[88:91]
s_and_b32 s14, s14, 3
ds_read_b128 a[192:195], v2 offset:0
ds_read_b128 a[196:199], v2 offset:1024
v_mfma_f32_16x16x32_bf16 v[184:187], a[176:179], v[48:51], v[104:107]
s_lshl_b32 s14, s14, 21
v_exp_f32 v141, v141
Ljoin33:
v_mfma_f32_16x16x32_bf16 v[172:175], a[160:163], v[64:67], v[92:95]
s_add_u32 s14, s14, s79
buffer_load_dwordx4 v1, s[44:47], s72 offen offset:3072 sc1 lds
v_mfma_f32_16x16x32_bf16 v[172:175], a[164:167], v[68:71], v[172:175]
s_add_u32 s66, s58, 0
v_exp_f32 v142, v142
v_mfma_f32_16x16x32_bf16 v[172:175], a[168:171], v[72:75], v[172:175]
s_and_b32 s66, s66, 3
ds_read_b128 a[200:203], v2 offset:2048
v_cvt_pk_bf16_f32 v204, v140, v141
v_mfma_f32_16x16x32_bf16 v[172:175], a[172:175], v[76:79], v[172:175]
s_mul_i32 s66, s66, 4160
v_exp_f32 v143, v143
v_mfma_f32_16x16x32_bf16 v[188:191], a[188:191], v[76:79], v[92:95]
s_add_u32 s66, s66, s92
ds_read_b128 a[204:207], v2 offset:3072
v_cvt_pk_bf16_f32 v205, v142, v143
v_mfma_f32_16x16x32_bf16 v[188:191], a[184:187], v[72:75], v[188:191]
s_add_u32 m0, s66, 16672
v_exp_f32 v156, v156
v_mfma_f32_16x16x32_bf16 v[188:191], a[180:183], v[68:71], v[188:191]
s_add_u32 s72, s93, 0x0
ds_read_b128 a[208:211], v2 offset:4096
ds_read_b128 a[212:215], v2 offset:5120
v_mfma_f32_16x16x32_bf16 v[188:191], a[176:179], v[64:67], v[188:191]
s_add_u32 s15, s61, 3
buffer_load_dwordx4 v1, s[36:39], s72 offen lds
v_mfma_f32_16x16x32_bf16 v[168:171], a[164:167], v[52:55], v[168:171]
s_and_b32 s15, s15, 3
v_exp_f32 v157, v157
v_mfma_f32_16x16x32_bf16 v[168:171], a[168:171], v[56:59], v[168:171]
s_lshl_b32 s15, s15, 21
v_exp_f32 v158, v158
v_mfma_f32_16x16x32_bf16 v[168:171], a[172:175], v[60:63], v[168:171]
s_add_u32 s15, s15, s79
ds_read_b128 a[216:219], v2 offset:6144
ds_read_b128 a[220:223], v2 offset:7168
v_mfma_f32_16x16x32_bf16 v[184:187], a[188:191], v[60:63], v[184:187]
buffer_load_dwordx4 v1, s[36:39], s72 offen offset:1024 lds
v_mfma_f32_16x16x32_bf16 v[184:187], a[184:187], v[56:59], v[184:187]
v_exp_f32 v159, v159
v_mfma_f32_16x16x32_bf16 v[184:187], a[180:183], v[52:55], v[184:187]
s_waitcnt lgkmcnt(4)
v_cvt_pk_bf16_f32 v206, v156, v157
v_cvt_pk_bf16_f32 v207, v158, v159
v_mfma_f32_16x16x32_bf16 v[232:235], v[120:123], v[216:219], v[232:235]
s_add_u32 s82, s82, 0x8000
ds_read_b128 a[160:163], v2 offset:24576
ds_read_b128 a[164:167], v2 offset:25600
v_mfma_f32_16x16x32_bf16 v[232:235], v[120:123], v[200:203], v[232:235]
s_and_b32 s82, s82, 0x1ffff
v_exp_f32 v172, v172
v_mfma_f32_16x16x32_bf16 a[64:67], a[224:227], v[216:219], a[64:67]
v_exp_f32 v173, v173
v_mfma_f32_16x16x32_bf16 a[64:67], a[192:195], v[200:203], a[64:67]
s_nop 0
ds_read_b128 a[168:171], v2 offset:26624
ds_read_b128 a[172:175], v2 offset:27648
v_mfma_f32_16x16x32_bf16 a[68:71], a[196:199], v[200:203], a[68:71]
v_exp_f32 v174, v174
v_mfma_f32_16x16x32_bf16 a[68:71], a[228:231], v[216:219], a[68:71]
v_exp_f32 v175, v175
v_mfma_f32_16x16x32_bf16 a[72:75], a[232:235], v[216:219], a[72:75]
s_nop 0
ds_read_b128 a[176:179], v2 offset:28672
ds_read_b128 a[180:183], v2 offset:29696
v_mfma_f32_16x16x32_bf16 a[72:75], a[200:203], v[200:203], a[72:75]
v_exp_f32 v188, v188
v_mfma_f32_16x16x32_bf16 a[76:79], a[204:207], v[200:203], a[76:79]
s_nop 0
ds_read_b128 a[184:187], v2 offset:30720
ds_read_b128 a[188:191], v2 offset:31744
v_mfma_f32_16x16x32_bf16 a[76:79], a[236:239], v[216:219], a[76:79]
s_nop 0
ds_read_b128 a[224:227], v2 offset:8192
ds_read_b128 a[228:231], v2 offset:9216
v_mfma_f32_16x16x32_bf16 a[80:83], a[240:243], v[216:219], a[80:83]
s_waitcnt lgkmcnt(10)
ds_read_b128 a[232:235], v2 offset:10240
ds_read_b128 a[236:239], v2 offset:11264
v_mfma_f32_16x16x32_bf16 a[80:83], a[208:211], v[200:203], a[80:83]
ds_read_b128 a[240:243], v2 offset:12288
v_cvt_pk_bf16_f32 v220, v172, v173
v_mfma_f32_16x16x32_bf16 a[84:87], a[212:215], v[200:203], a[84:87]
buffer_load_dwordx4 v1, s[36:39], s72 offen offset:2048 lds
v_mfma_f32_16x16x32_bf16 a[84:87], a[244:247], v[216:219], a[84:87]
v_exp_f32 v189, v189
v_mfma_f32_16x16x32_bf16 a[88:91], a[248:251], v[216:219], a[88:91]
v_exp_f32 v190, v190
v_mfma_f32_16x16x32_bf16 a[88:91], a[216:219], v[200:203], a[88:91]
s_nop 0
ds_read_b128 a[244:247], v2 offset:13312
ds_read_b128 a[248:251], v2 offset:14336
v_mfma_f32_16x16x32_bf16 a[92:95], a[220:223], v[200:203], a[92:95]
Lstub7:
s_cbranch_execz Lstub11
v_cvt_pk_bf16_f32 v221, v174, v175
v_cvt_pk_bf16_f32 v222, v188, v189
v_mfma_f32_16x16x32_bf16 a[92:95], a[252:255], v[216:219], a[92:95]
v_exp_f32 v191, v191
s_cmp_eq_u32 s58, 0
s_cbranch_scc1 Lta34
s_cmp_eq_u32 s58, 1
s_cbranch_scc1 Lnt35
v_mfma_f32_16x16x32_bf16 v[140:143], a[128:131], v[64:67], v[92:95]
v_exp_f32 v168, v168
v_mfma_f32_16x16x32_bf16 v[156:159], a[144:147], v[64:67], v[92:95]
v_exp_f32 v169, v169
s_branch Ljoin36
Lta34:
v_mfma_f32_16x16x32_bf16 v[140:143], a[128:131], v[64:67], v[108:111]
v_exp_f32 v168, v168
v_mfma_f32_16x16x32_bf16 v[156:159], a[144:147], v[64:67], v[112:115]
v_exp_f32 v169, v169
s_branch Ljoin36
Lnt35:
v_mfma_f32_16x16x32_bf16 v[140:143], a[128:131], v[64:67], v[92:95]
v_exp_f32 v168, v168
v_mfma_f32_16x16x32_bf16 v[156:159], a[144:147], v[64:67], v[108:111]
v_exp_f32 v169, v169
Ljoin36:
v_mfma_f32_16x16x32_bf16 v[140:143], a[132:135], v[68:71], v[140:143]
v_exp_f32 v170, v170
v_mfma_f32_16x16x32_bf16 v[140:143], a[136:139], v[72:75], v[140:143]
ds_read_b128 a[252:255], v2 offset:15360
v_cvt_pk_bf16_f32 v223, v190, v191
v_mfma_f32_16x16x32_bf16 v[140:143], a[140:143], v[76:79], v[140:143]
v_exp_f32 v171, v171
v_mfma_f32_16x16x32_bf16 v[156:159], a[156:159], v[76:79], v[156:159]
buffer_load_dwordx4 v1, s[36:39], s72 offen offset:3072 lds
v_mfma_f32_16x16x32_bf16 v[156:159], a[152:155], v[72:75], v[156:159]
s_waitcnt vmcnt(13) lgkmcnt(4)
v_exp_f32 v184, v184
v_mfma_f32_16x16x32_bf16 v[156:159], a[148:151], v[68:71], v[156:159]
s_barrier
v_cvt_pk_bf16_f32 v216, v168, v169
v_cvt_pk_bf16_f32 v217, v170, v171
v_add_u32 v2, s82, v1
v_exp_f32 v185, v185
v_exp_f32 v186, v186
v_cvt_pk_bf16_f32 v218, v184, v185
v_exp_f32 v187, v187
s_nop 0
v_cvt_pk_bf16_f32 v219, v186, v187
v_mfma_f32_16x16x32_bf16 v[236:239], v[120:123], v[204:207], v[236:239]
s_add_u32 s66, s58, 2
v_exp_f32 v140, v140
v_mfma_f32_16x16x32_bf16 v[236:239], v[120:123], v[220:223], v[236:239]
s_and_b32 s66, s66, 3
v_exp_f32 v141, v141
v_mfma_f32_16x16x32_bf16 a[96:99], a[192:195], v[204:207], a[96:99]
s_mul_i32 s66, s66, 4160
ds_read_b128 a[192:195], v2 offset:0
v_mfma_f32_16x16x32_bf16 a[96:99], a[224:227], v[220:223], a[96:99]
s_add_u32 s66, s66, s92
v_exp_f32 v142, v142
v_mfma_f32_16x16x32_bf16 a[100:103], a[228:231], v[220:223], a[100:103]
s_add_u32 m0, s66, 33312
v_exp_f32 v143, v143
v_mfma_f32_16x16x32_bf16 a[100:103], a[196:199], v[204:207], a[100:103]
s_add_u32 s72, s93, 0x4
buffer_load_dwordx4 v1, s[36:39], s72 offen lds
v_mfma_f32_16x16x32_bf16 a[104:107], a[200:203], v[204:207], a[104:107]
ds_read_b128 a[196:199], v2 offset:1024
v_mfma_f32_16x16x32_bf16 a[104:107], a[232:235], v[220:223], a[104:107]
buffer_load_dwordx4 v1, s[36:39], s72 offen offset:1024 lds
v_mfma_f32_16x16x32_bf16 a[108:111], a[236:239], v[220:223], a[108:111]
ds_read_b128 a[200:203], v2 offset:2048
v_mfma_f32_16x16x32_bf16 a[108:111], a[204:207], v[204:207], a[108:111]
buffer_load_dwordx4 v1, s[36:39], s72 offen offset:2048 lds
v_mfma_f32_16x16x32_bf16 a[112:115], a[208:211], v[204:207], a[112:115]
s_waitcnt lgkmcnt(3)
ds_read_b128 a[204:207], v2 offset:3072
v_mfma_f32_16x16x32_bf16 a[112:115], a[240:243], v[220:223], a[112:115]
buffer_load_dwordx4 v1, s[36:39], s72 offen offset:3072 lds
v_mfma_f32_16x16x32_bf16 a[116:119], a[244:247], v[220:223], a[116:119]
v_exp_f32 v156, v156
v_mfma_f32_16x16x32_bf16 a[116:119], a[212:215], v[204:207], a[116:119]
ds_read_b128 a[208:211], v2 offset:4096
v_mfma_f32_16x16x32_bf16 a[120:123], a[216:219], v[204:207], a[120:123]
buffer_load_dwordx4 v[80:83], v15, s[4:7], s80 offen
v_mfma_f32_16x16x32_bf16 a[120:123], a[248:251], v[220:223], a[120:123]
s_add_u32 s80, s80, 0x4000
v_exp_f32 v157, v157
v_mfma_f32_16x16x32_bf16 a[124:127], a[252:255], v[220:223], a[124:127]
ds_read_b128 a[212:215], v2 offset:5120
v_mfma_f32_16x16x32_bf16 a[124:127], a[220:223], v[204:207], a[124:127]
ds_read_b128 a[216:219], v2 offset:6144
v_cvt_pk_bf16_f32 v204, v140, v141
s_cmp_eq_u32 s58, 2
s_cbranch_scc1 Lta37
s_cmp_eq_u32 s58, 3
s_cbranch_scc1 Lnt38
v_mfma_f32_16x16x32_bf16 v[172:175], a[160:163], v[64:67], v[112:115]
buffer_load_dwordx4 v[84:87], v15, s[4:7], s80 offen
v_mfma_f32_16x16x32_bf16 v[188:191], a[176:179], v[64:67], v[112:115]
s_add_u32 s80, s80, 0x4000
v_exp_f32 v158, v158
s_branch Ljoin39
Lta37:
v_mfma_f32_16x16x32_bf16 v[172:175], a[160:163], v[64:67], v[108:111]
buffer_load_dwordx4 v[84:87], v15, s[4:7], s80 offen
v_mfma_f32_16x16x32_bf16 v[188:191], a[176:179], v[64:67], v[112:115]
s_add_u32 s80, s80, 0x4000
v_exp_f32 v158, v158
s_branch Ljoin39
Lnt38:
v_mfma_f32_16x16x32_bf16 v[172:175], a[160:163], v[64:67], v[92:95]
buffer_load_dwordx4 v[84:87], v15, s[4:7], s80 offen
v_mfma_f32_16x16x32_bf16 v[188:191], a[176:179], v[64:67], v[108:111]
s_add_u32 s80, s80, 0x4000
v_exp_f32 v158, v158
Ljoin39:
v_mfma_f32_16x16x32_bf16 v[172:175], a[164:167], v[68:71], v[172:175]
ds_read_b128 a[220:223], v2 offset:7168
v_cvt_pk_bf16_f32 v205, v142, v143
v_mfma_f32_16x16x32_bf16 v[172:175], a[168:171], v[72:75], v[172:175]
buffer_load_dwordx4 v[96:99], v15, s[4:7], s80 offen
v_mfma_f32_16x16x32_bf16 v[172:175], a[172:175], v[76:79], v[172:175]
s_add_u32 s80, s80, 0x4000
v_exp_f32 v159, v159
v_mfma_f32_16x16x32_bf16 v[188:191], a[188:191], v[76:79], v[188:191]
buffer_load_dwordx4 v[100:103], v15, s[4:7], s80 offen
v_mfma_f32_16x16x32_bf16 v[188:191], a[184:187], v[72:75], v[188:191]
v_cvt_pk_bf16_f32 v206, v156, v157
v_cvt_pk_bf16_f32 v207, v158, v159
v_mfma_f32_16x16x32_bf16 v[188:191], a[180:183], v[68:71], v[188:191]
s_waitcnt lgkmcnt(4)
v_mfma_f32_16x16x32_bf16 v[232:235], v[120:123], v[216:219], v[232:235]
s_add_u32 s82, s82, 0x8000
v_exp_f32 v172, v172
v_mfma_f32_16x16x32_bf16 a[64:67], a[224:227], v[216:219], a[64:67]
s_and_b32 s82, s82, 0x1ffff
ds_read_b128 a[224:227], v2 offset:8192
v_mfma_f32_16x16x32_bf16 a[68:71], a[228:231], v[216:219], a[68:71]
ds_read_b128 a[228:231], v2 offset:9216
v_mfma_f32_16x16x32_bf16 a[72:75], a[232:235], v[216:219], a[72:75]
v_exp_f32 v173, v173
v_mfma_f32_16x16x32_bf16 a[76:79], a[236:239], v[216:219], a[76:79]
s_nop 0
ds_read_b128 a[232:235], v2 offset:10240
ds_read_b128 a[236:239], v2 offset:11264
v_mfma_f32_16x16x32_bf16 a[80:83], a[240:243], v[216:219], a[80:83]
ds_read_b128 a[240:243], v2 offset:12288
v_cvt_pk_bf16_f32 v220, v172, v173
v_mfma_f32_16x16x32_bf16 a[84:87], a[244:247], v[216:219], a[84:87]
ds_read_b128 a[244:247], v2 offset:13312
v_mfma_f32_16x16x32_bf16 a[88:91], a[248:251], v[216:219], a[88:91]
v_exp_f32 v174, v174
v_mfma_f32_16x16x32_bf16 a[92:95], a[252:255], v[216:219], a[92:95]
v_exp_f32 v175, v175
ds_read_b128 a[248:251], v2 offset:14336
ds_read_b128 a[252:255], v2 offset:15360
v_add_u32 v2, s82, v1
v_exp_f32 v188, v188
v_cvt_pk_bf16_f32 v221, v174, v175
v_exp_f32 v189, v189
v_exp_f32 v190, v190
v_cvt_pk_bf16_f32 v222, v188, v189
v_exp_f32 v191, v191
s_nop 0
v_cvt_pk_bf16_f32 v223, v190, v191
s_waitcnt vmcnt(4) lgkmcnt(0)
s_barrier
LHT4:
Lstub8:
s_cbranch_execz Lstub12
v_mfma_f32_16x16x32_bf16 v[236:239], v[120:123], v[204:207], v[236:239]
ds_write_b64 v5, v[12:13]
v_mov_b32 v240, 0
v_mfma_f32_16x16x32_bf16 v[236:239], v[120:123], v[220:223], v[236:239]
v_mov_b32 v241, 0
v_mfma_f32_16x16x32_bf16 a[96:99], a[192:195], v[204:207], a[96:99]
s_nop 0
ds_write_b64 v14, v[240:241]
ds_read_b64 a[128:129], v6 offset:0
v_mfma_f32_16x16x32_bf16 a[96:99], a[224:227], v[220:223], a[96:99]
s_nop 0
ds_read_b64 a[130:131], v6 offset:8
ds_read_b128 a[192:195], v7 offset:3584
v_mfma_f32_16x16x32_bf16 a[100:103], a[228:231], v[220:223], a[100:103]
s_nop 0
ds_read_b64 a[132:133], v6 offset:512
ds_read_b64 a[134:135], v6 offset:520
v_mfma_f32_16x16x32_bf16 a[100:103], a[196:199], v[204:207], a[100:103]
s_nop 0
ds_read_b128 a[196:199], v7 offset:3072
ds_read_b64 a[136:137], v6 offset:1024
v_mfma_f32_16x16x32_bf16 a[104:107], a[200:203], v[204:207], a[104:107]
s_nop 0
ds_read_b64 a[138:139], v6 offset:1032
ds_read_b128 a[200:203], v7 offset:2560
v_mfma_f32_16x16x32_bf16 a[104:107], a[232:235], v[220:223], a[104:107]
v_add_f32 v12, v224, v228
v_min_u32 v13, 1, v0
v_mfma_f32_16x16x32_bf16 a[108:111], a[236:239], v[220:223], a[108:111]
s_nop 0
ds_read_b64 a[140:141], v6 offset:1536
ds_read_b64 a[142:143], v6 offset:1544
v_mfma_f32_16x16x32_bf16 a[108:111], a[204:207], v[204:207], a[108:111]
s_nop 0
ds_read_b128 a[204:207], v7 offset:2048
ds_read_b64 a[144:145], v6 offset:2048
v_mfma_f32_16x16x32_bf16 a[112:115], a[208:211], v[204:207], a[112:115]
s_lshl_b32 s73, s52, 12
ds_read_b64 a[146:147], v6 offset:2056
ds_read_b128 a[208:211], v7 offset:1536
v_mfma_f32_16x16x32_bf16 a[112:115], a[240:243], v[220:223], a[112:115]
s_add_u32 s73, s73, 0x2000000
v_lshlrev_b32 v13, 30, v13
v_mov_b32 v14, 2
v_mfma_f32_16x16x32_bf16 a[116:119], a[244:247], v[220:223], a[116:119]
s_lshl_b32 s70, s68, 2
ds_read_b64 a[148:149], v6 offset:2560
ds_read_b64 a[150:151], v6 offset:2568
v_mfma_f32_16x16x32_bf16 a[116:119], a[212:215], v[204:207], a[116:119]
s_add_u32 s70, s70, s73
ds_read_b128 a[212:215], v7 offset:1024
ds_read_b64 a[152:153], v6 offset:3072
v_mfma_f32_16x16x32_bf16 a[120:123], a[216:219], v[204:207], a[120:123]
s_nop 0
ds_read_b64 a[154:155], v6 offset:3080
ds_read_b128 a[216:219], v7 offset:512
v_mfma_f32_16x16x32_bf16 a[120:123], a[248:251], v[220:223], a[120:123]
v_mfma_f32_16x16x32_bf16 a[124:127], a[252:255], v[220:223], a[124:127]
s_xor_b32 s71, s12, 0x80
ds_read_b64 a[156:157], v6 offset:3584
ds_read_b64 a[158:159], v6 offset:3592
v_mfma_f32_16x16x32_bf16 a[124:127], a[220:223], v[204:207], a[124:127]
s_add_u32 m0, s77, 0
ds_read_b128 a[220:223], v7 offset:0
s_waitcnt lgkmcnt(0)
v_mfma_f32_16x16x32_bf16 v[128:131], v[8:11], a[192:195], 0
s_add_u32 s72, s71, 0
buffer_load_dwordx4 v15, s[24:27], s72 offen lds
v_mfma_f32_16x16x32_bf16 v[128:131], a[128:131], a[192:195], v[128:131]
v_mfma_f32_16x16x32_bf16 v[132:135], v[8:11], a[196:199], 0
s_nop 0
ds_read_b128 a[224:227], v7 offset:3648
ds_read_b64 a[160:161], v6 offset:64
v_mfma_f32_16x16x32_bf16 v[132:135], a[128:131], a[196:199], v[132:135]
v_accvgpr_read_b32 v240, a64
v_accvgpr_read_b32 v241, a65
v_accvgpr_read_b32 v242, a66
v_mfma_f32_16x16x32_bf16 v[132:135], a[132:135], a[192:195], v[132:135]
s_add_u32 s72, s71, 15360
buffer_load_dwordx4 v15, s[24:27], s72 offen offset:1024 lds
v_accvgpr_read_b32 v243, a67
v_mfma_f32_16x16x32_bf16 v[136:139], v[8:11], a[200:203], 0
s_nop 0
ds_read_b64 a[162:163], v6 offset:72
ds_read_b128 a[228:231], v7 offset:3136
v_mfma_f32_16x16x32_bf16 v[136:139], a[128:131], a[200:203], v[136:139]
s_lshl_b32 s95, s75, 20
v_rcp_f32 v234, v232
v_mfma_f32_16x16x32_bf16 v[136:139], a[132:135], a[196:199], v[136:139]
s_lshl_b32 s74, s58, 18
v_rcp_f32 v238, v236
v_accvgpr_read_b32 v244, a68
v_mfma_f32_16x16x32_bf16 v[136:139], a[136:139], a[192:195], v[136:139]
s_add_u32 s95, s95, s74
ds_read_b64 a[164:165], v6 offset:576
ds_read_b64 a[166:167], v6 offset:584
v_accvgpr_read_b32 v245, a69
v_mfma_f32_16x16x32_bf16 v[140:143], v[8:11], a[204:207], 0
s_add_u32 s72, s71, 30720
buffer_load_dwordx4 v15, s[24:27], s72 offen offset:2048 lds
v_accvgpr_read_b32 v246, a70
v_mfma_f32_16x16x32_bf16 v[140:143], a[128:131], a[204:207], v[140:143]
s_add_u32 s95, s95, 0x2000000
v_accvgpr_read_b32 v247, a71
v_mul_f32 v240, v240, v234
v_mul_f32 v241, v241, v234
v_mfma_f32_16x16x32_bf16 v[140:143], a[132:135], a[200:203], v[140:143]
s_sub_u32 s74, 15, s75
ds_read_b128 a[232:235], v7 offset:2624
ds_read_b64 a[168:169], v6 offset:1088
v_mul_f32 v242, v242, v234
v_mfma_f32_16x16x32_bf16 v[140:143], a[136:139], a[196:199], v[140:143]
s_add_u32 s72, s71, 46080
buffer_load_dwordx4 v15, s[24:27], s72 offen offset:3072 lds
v_mul_f32 v243, v243, v234
v_mfma_f32_16x16x32_bf16 v[140:143], a[140:143], a[192:195], v[140:143]
s_min_u32 s74, s74, s75
v_mul_f32 v244, v244, v234
v_mul_f32 v245, v245, v234
v_mul_f32 v246, v246, v234
v_mfma_f32_16x16x32_bf16 v[144:147], v[8:11], a[208:211], 0
s_lshl_b32 s74, s74, 7
ds_read_b64 a[170:171], v6 offset:1096
ds_read_b128 a[236:239], v7 offset:2112
v_mul_f32 v247, v247, v234
v_mfma_f32_16x16x32_bf16 v[144:147], a[128:131], a[208:211], v[144:147]
s_add_u32 s74, s74, 0x3810000
v_cvt_pk_bf16_f32 v240, v240, v241
v_cvt_pk_bf16_f32 v241, v242, v243
v_cvt_pk_bf16_f32 v242, v244, v245
v_mfma_f32_16x16x32_bf16 v[144:147], a[132:135], a[204:207], v[144:147]
s_xor_b32 s85, s77, 0x10000
v_cvt_pk_bf16_f32 v243, v246, v247
v_mfma_f32_16x16x32_bf16 v[144:147], a[136:139], a[200:203], v[144:147]
s_nop 0
ds_read_b64 a[172:173], v6 offset:1600
ds_read_b64 a[174:175], v6 offset:1608
v_mfma_f32_16x16x32_bf16 v[144:147], a[140:143], a[196:199], v[144:147]
buffer_store_dwordx4 v[240:243], v1, s[44:47], s70 offen sc1
v_mfma_f32_16x16x32_bf16 v[144:147], a[144:147], a[192:195], v[144:147]
v_accvgpr_read_b32 v248, a72
v_accvgpr_read_b32 v249, a73
v_accvgpr_read_b32 v250, a74
v_mfma_f32_16x16x32_bf16 v[148:151], v[8:11], a[212:215], 0
s_nop 0
ds_read_b128 a[240:243], v7 offset:1600
ds_read_b64 a[176:177], v6 offset:2112
v_accvgpr_read_b32 v251, a75
v_mfma_f32_16x16x32_bf16 v[148:151], a[128:131], a[212:215], v[148:151]
v_accvgpr_read_b32 v252, a76
v_accvgpr_read_b32 v253, a77
v_accvgpr_read_b32 v254, a78
v_mfma_f32_16x16x32_bf16 v[148:151], a[132:135], a[208:211], v[148:151]
v_accvgpr_read_b32 v255, a79
v_mul_f32 v248, v248, v234
v_mul_f32 v249, v249, v234
v_mfma_f32_16x16x32_bf16 v[148:151], a[136:139], a[204:207], v[148:151]
s_nop 0
ds_read_b64 a[178:179], v6 offset:2120
ds_read_b128 a[244:247], v7 offset:1088
v_mul_f32 v250, v250, v234
v_mfma_f32_16x16x32_bf16 v[148:151], a[140:143], a[200:203], v[148:151]
v_cmp_ngt_f32 vcc, 0x6f800000, v12
s_or_b32 s83, vcc_lo, vcc_hi
s_cselect_b32 s83, s86, 1
s_lshl_b32 s53, s83, 30
s_xor_b32 s83, s53, 0x40000000
v_or_b32 v13, s83, v13
s_lshl_b32 s83, s58, 2
s_add_u32 s83, s83, s91
s_waitcnt vmcnt(5)
buffer_store_dword v14, v13, s[44:47], s83 offen offset:4 sc1
v_mfma_f32_16x16x32_bf16 v[148:151], a[144:147], a[196:199], v[148:151]
v_mul_f32 v251, v251, v234
v_mul_f32 v252, v252, v234
v_mul_f32 v253, v253, v234
v_mfma_f32_16x16x32_bf16 v[148:151], a[148:151], a[192:195], v[148:151]
s_nop 0
ds_read_b64 a[180:181], v6 offset:2624
ds_read_b64 a[182:183], v6 offset:2632
v_mul_f32 v254, v254, v234
v_mfma_f32_16x16x32_bf16 v[152:155], v[8:11], a[216:219], 0
v_mul_f32 v255, v255, v234
v_cvt_pk_bf16_f32 v248, v248, v249
v_cvt_pk_bf16_f32 v249, v250, v251
v_mfma_f32_16x16x32_bf16 v[152:155], a[128:131], a[216:219], v[152:155]
v_cvt_pk_bf16_f32 v250, v252, v253
v_cvt_pk_bf16_f32 v251, v254, v255
v_mfma_f32_16x16x32_bf16 v[152:155], a[132:135], a[212:215], v[152:155]
s_nop 0
ds_read_b128 a[248:251], v7 offset:576
ds_read_b64 a[184:185], v6 offset:3136
v_mfma_f32_16x16x32_bf16 v[152:155], a[136:139], a[208:211], v[152:155]
buffer_store_dwordx4 v[248:251], v1, s[44:47], s70 offen offset:1024 sc1
v_mfma_f32_16x16x32_bf16 v[152:155], a[140:143], a[204:207], v[152:155]
v_accvgpr_read_b32 v240, a80
v_accvgpr_read_b32 v241, a81
v_accvgpr_read_b32 v242, a82
v_mfma_f32_16x16x32_bf16 v[152:155], a[144:147], a[200:203], v[152:155]
s_nop 0
ds_read_b64 a[186:187], v6 offset:3144
ds_read_b128 a[252:255], v7 offset:64
v_accvgpr_read_b32 v243, a83
v_mfma_f32_16x16x32_bf16 v[152:155], a[148:151], a[196:199], v[152:155]
v_accvgpr_read_b32 v244, a84
v_accvgpr_read_b32 v245, a85
v_accvgpr_read_b32 v246, a86
v_mfma_f32_16x16x32_bf16 v[152:155], a[152:155], a[192:195], v[152:155]
v_accvgpr_read_b32 v247, a87
v_mul_f32 v240, v240, v234
v_mul_f32 v241, v241, v234
v_mfma_f32_16x16x32_bf16 v[156:159], v[8:11], a[220:223], 0
s_nop 0
ds_read_b64 a[188:189], v6 offset:3648
ds_read_b64 a[190:191], v6 offset:3656
v_mul_f32 v242, v242, v234
v_mfma_f32_16x16x32_bf16 v[156:159], a[128:131], a[220:223], v[156:159]
v_mul_f32 v243, v243, v234
v_mul_f32 v244, v244, v234
v_mul_f32 v245, v245, v234
v_mfma_f32_16x16x32_bf16 v[156:159], a[132:135], a[216:219], v[156:159]
v_mul_f32 v246, v246, v234
v_mul_f32 v247, v247, v234
v_cvt_pk_bf16_f32 v240, v240, v241
v_mfma_f32_16x16x32_bf16 v[156:159], a[136:139], a[212:215], v[156:159]
v_cvt_pk_bf16_f32 v241, v242, v243
v_cvt_pk_bf16_f32 v242, v244, v245
v_cvt_pk_bf16_f32 v243, v246, v247
v_mfma_f32_16x16x32_bf16 v[156:159], a[140:143], a[208:211], v[156:159]
buffer_store_dwordx4 v[240:243], v1, s[44:47], s70 offen offset:2048 sc1
v_mfma_f32_16x16x32_bf16 v[156:159], a[144:147], a[204:207], v[156:159]
v_accvgpr_read_b32 v248, a88
v_accvgpr_read_b32 v249, a89
v_accvgpr_read_b32 v250, a90
v_mfma_f32_16x16x32_bf16 v[156:159], a[148:151], a[200:203], v[156:159]
v_accvgpr_read_b32 v251, a91
v_accvgpr_read_b32 v252, a92
v_accvgpr_read_b32 v253, a93
v_mfma_f32_16x16x32_bf16 v[156:159], a[152:155], a[196:199], v[156:159]
v_accvgpr_read_b32 v254, a94
v_accvgpr_read_b32 v255, a95
v_mul_f32 v248, v248, v234
v_mfma_f32_16x16x32_bf16 v[156:159], a[156:159], a[192:195], v[156:159]
s_waitcnt lgkmcnt(0)
v_mul_f32 v249, v249, v234
v_mul_f32 v250, v250, v234
v_mul_f32 v251, v251, v234
v_mfma_f32_16x16x32_bf16 v[128:131], a[160:163], a[224:227], v[128:131]
s_nop 0
ds_read_b128 a[192:195], v7 offset:3712
ds_read_b64 a[128:129], v6 offset:128
v_mul_f32 v252, v252, v234
v_mfma_f32_16x16x32_bf16 v[132:135], a[164:167], a[224:227], v[132:135]
v_mul_f32 v253, v253, v234
v_mul_f32 v254, v254, v234
v_mul_f32 v255, v255, v234
v_mfma_f32_16x16x32_bf16 v[132:135], a[160:163], a[228:231], v[132:135]
s_nop 0
ds_read_b64 a[130:131], v6 offset:136
ds_read_b128 a[196:199], v7 offset:3200
v_cvt_pk_bf16_f32 v248, v248, v249
v_mfma_f32_16x16x32_bf16 v[136:139], a[160:163], a[232:235], v[136:139]
v_cvt_pk_bf16_f32 v249, v250, v251
v_cvt_pk_bf16_f32 v250, v252, v253
v_cvt_pk_bf16_f32 v251, v254, v255
v_mfma_f32_16x16x32_bf16 v[136:139], a[164:167], a[228:231], v[136:139]
buffer_store_dwordx4 v[248:251], v1, s[44:47], s70 offen offset:3072 sc1
v_mfma_f32_16x16x32_bf16 v[136:139], a[168:171], a[224:227], v[136:139]
s_add_u32 s70, s70, 0x80000
ds_read_b64 a[132:133], v6 offset:640
ds_read_b64 a[134:135], v6 offset:648
v_accvgpr_read_b32 v240, a96
v_mfma_f32_16x16x32_bf16 v[140:143], a[172:175], a[224:227], v[140:143]
v_accvgpr_read_b32 v241, a97
v_accvgpr_read_b32 v242, a98
v_accvgpr_read_b32 v243, a99
v_mfma_f32_16x16x32_bf16 v[140:143], a[168:171], a[228:231], v[140:143]
s_nop 0
ds_read_b128 a[200:203], v7 offset:2688
ds_read_b64 a[136:137], v6 offset:1152
v_accvgpr_read_b32 v244, a100
v_mfma_f32_16x16x32_bf16 v[140:143], a[164:167], a[232:235], v[140:143]
v_accvgpr_read_b32 v245, a101
v_accvgpr_read_b32 v246, a102
v_accvgpr_read_b32 v247, a103
v_mfma_f32_16x16x32_bf16 v[140:143], a[160:163], a[236:239], v[140:143]
v_mul_f32 v240, v240, v238
v_mul_f32 v241, v241, v238
v_mul_f32 v242, v242, v238
v_mfma_f32_16x16x32_bf16 v[144:147], a[160:163], a[240:243], v[144:147]
s_nop 0
ds_read_b64 a[138:139], v6 offset:1160
ds_read_b128 a[204:207], v7 offset:2176
v_mul_f32 v243, v243, v238
v_mfma_f32_16x16x32_bf16 v[144:147], a[164:167], a[236:239], v[144:147]
v_mul_f32 v244, v244, v238
v_mul_f32 v245, v245, v238
v_mul_f32 v246, v246, v238
v_mfma_f32_16x16x32_bf16 v[144:147], a[168:171], a[232:235], v[144:147]
s_nop 0
ds_read_b64 a[140:141], v6 offset:1664
ds_read_b64 a[142:143], v6 offset:1672
v_mul_f32 v247, v247, v238
v_mfma_f32_16x16x32_bf16 v[144:147], a[172:175], a[228:231], v[144:147]
v_cvt_pk_bf16_f32 v240, v240, v241
v_cvt_pk_bf16_f32 v241, v242, v243
v_cvt_pk_bf16_f32 v242, v244, v245
v_mfma_f32_16x16x32_bf16 v[144:147], a[176:179], a[224:227], v[144:147]
v_cvt_pk_bf16_f32 v243, v246, v247
v_mfma_f32_16x16x32_bf16 v[148:151], a[180:183], a[224:227], v[148:151]
s_nop 0
ds_read_b128 a[208:211], v7 offset:1664
ds_read_b64 a[144:145], v6 offset:2176
v_mfma_f32_16x16x32_bf16 v[148:151], a[176:179], a[228:231], v[148:151]
buffer_store_dwordx4 v[240:243], v1, s[44:47], s70 offen sc1
v_mfma_f32_16x16x32_bf16 v[148:151], a[172:175], a[232:235], v[148:151]
v_accvgpr_read_b32 v248, a104
v_accvgpr_read_b32 v249, a105
v_accvgpr_read_b32 v250, a106
v_mfma_f32_16x16x32_bf16 v[148:151], a[168:171], a[236:239], v[148:151]
s_nop 0
ds_read_b64 a[146:147], v6 offset:2184
ds_read_b128 a[212:215], v7 offset:1152
v_accvgpr_read_b32 v251, a107
v_mfma_f32_16x16x32_bf16 v[148:151], a[164:167], a[240:243], v[148:151]
v_accvgpr_read_b32 v252, a108
v_accvgpr_read_b32 v253, a109
v_accvgpr_read_b32 v254, a110
v_mfma_f32_16x16x32_bf16 v[148:151], a[160:163], a[244:247], v[148:151]
s_nop 0
ds_read_b64 a[148:149], v6 offset:2688
ds_read_b64 a[150:151], v6 offset:2696
v_accvgpr_read_b32 v255, a111
v_mfma_f32_16x16x32_bf16 v[152:155], a[160:163], a[248:251], v[152:155]
v_mul_f32 v248, v248, v238
v_mul_f32 v249, v249, v238
v_mul_f32 v250, v250, v238
v_mfma_f32_16x16x32_bf16 v[152:155], a[164:167], a[244:247], v[152:155]
v_mul_f32 v251, v251, v238
v_mul_f32 v252, v252, v238
v_mul_f32 v253, v253, v238
v_mfma_f32_16x16x32_bf16 v[152:155], a[168:171], a[240:243], v[152:155]
s_nop 0
ds_read_b128 a[216:219], v7 offset:640
ds_read_b64 a[152:153], v6 offset:3200
v_mul_f32 v254, v254, v238
v_mfma_f32_16x16x32_bf16 v[152:155], a[172:175], a[236:239], v[152:155]
v_mul_f32 v255, v255, v238
v_cvt_pk_bf16_f32 v248, v248, v249
v_cvt_pk_bf16_f32 v249, v250, v251
v_mfma_f32_16x16x32_bf16 v[152:155], a[176:179], a[232:235], v[152:155]
s_nop 0
ds_read_b64 a[154:155], v6 offset:3208
ds_read_b128 a[220:223], v7 offset:128
v_cvt_pk_bf16_f32 v250, v252, v253
v_mfma_f32_16x16x32_bf16 v[152:155], a[180:183], a[228:231], v[152:155]
v_cvt_pk_bf16_f32 v251, v254, v255
v_mfma_f32_16x16x32_bf16 v[152:155], a[184:187], a[224:227], v[152:155]
buffer_store_dwordx4 v[248:251], v1, s[44:47], s70 offen offset:1024 sc1
v_mfma_f32_16x16x32_bf16 v[156:159], a[188:191], a[224:227], v[156:159]
s_nop 0
ds_read_b64 a[156:157], v6 offset:3712
ds_read_b64 a[158:159], v6 offset:3720
v_accvgpr_read_b32 v240, a112
v_mfma_f32_16x16x32_bf16 v[156:159], a[184:187], a[228:231], v[156:159]
v_accvgpr_read_b32 v241, a113
v_accvgpr_read_b32 v242, a114
v_accvgpr_read_b32 v243, a115
v_mfma_f32_16x16x32_bf16 v[156:159], a[180:183], a[232:235], v[156:159]
v_accvgpr_read_b32 v244, a116
v_accvgpr_read_b32 v245, a117
v_accvgpr_read_b32 v246, a118
v_mfma_f32_16x16x32_bf16 v[156:159], a[176:179], a[236:239], v[156:159]
v_accvgpr_read_b32 v247, a119
v_mul_f32 v240, v240, v238
v_mul_f32 v241, v241, v238
v_mfma_f32_16x16x32_bf16 v[156:159], a[172:175], a[240:243], v[156:159]
v_mul_f32 v242, v242, v238
v_mul_f32 v243, v243, v238
v_mul_f32 v244, v244, v238
v_mfma_f32_16x16x32_bf16 v[156:159], a[168:171], a[244:247], v[156:159]
v_mul_f32 v245, v245, v238
v_mul_f32 v246, v246, v238
v_mul_f32 v247, v247, v238
v_mfma_f32_16x16x32_bf16 v[156:159], a[164:167], a[248:251], v[156:159]
v_cvt_pk_bf16_f32 v240, v240, v241
v_cvt_pk_bf16_f32 v241, v242, v243
v_cvt_pk_bf16_f32 v242, v244, v245
v_mfma_f32_16x16x32_bf16 v[156:159], a[160:163], a[252:255], v[156:159]
s_waitcnt lgkmcnt(0)
v_cvt_pk_bf16_f32 v243, v246, v247
v_mfma_f32_16x16x32_bf16 v[128:131], a[128:131], a[192:195], v[128:131]
s_nop 0
ds_read_b128 a[224:227], v7 offset:3776
ds_read_b64 a[160:161], v6 offset:192
v_mfma_f32_16x16x32_bf16 v[132:135], a[132:135], a[192:195], v[132:135]
buffer_store_dwordx4 v[240:243], v1, s[44:47], s70 offen offset:2048 sc1
v_mfma_f32_16x16x32_bf16 v[132:135], a[128:131], a[196:199], v[132:135]
s_nop 0
ds_read_b64 a[162:163], v6 offset:200
ds_read_b128 a[228:231], v7 offset:3264
v_accvgpr_read_b32 v248, a120
v_mfma_f32_16x16x32_bf16 v[136:139], a[128:131], a[200:203], v[136:139]
v_accvgpr_read_b32 v249, a121
v_accvgpr_read_b32 v250, a122
v_accvgpr_read_b32 v251, a123
v_mfma_f32_16x16x32_bf16 v[136:139], a[132:135], a[196:199], v[136:139]
v_accvgpr_read_b32 v252, a124
v_accvgpr_read_b32 v253, a125
v_accvgpr_read_b32 v254, a126
v_mfma_f32_16x16x32_bf16 v[136:139], a[136:139], a[192:195], v[136:139]
s_nop 0
ds_read_b64 a[164:165], v6 offset:704
ds_read_b64 a[166:167], v6 offset:712
v_accvgpr_read_b32 v255, a127
v_mfma_f32_16x16x32_bf16 v[140:143], a[140:143], a[192:195], v[140:143]
v_mul_f32 v248, v248, v238
v_mul_f32 v249, v249, v238
v_mul_f32 v250, v250, v238
v_mfma_f32_16x16x32_bf16 v[140:143], a[136:139], a[196:199], v[140:143]
s_nop 0
ds_read_b128 a[232:235], v7 offset:2752
ds_read_b64 a[168:169], v6 offset:1216
v_mul_f32 v251, v251, v238
v_mfma_f32_16x16x32_bf16 v[140:143], a[132:135], a[200:203], v[140:143]
v_mul_f32 v252, v252, v238
v_mul_f32 v253, v253, v238
v_mul_f32 v254, v254, v238
v_mfma_f32_16x16x32_bf16 v[140:143], a[128:131], a[204:207], v[140:143]
v_mul_f32 v255, v255, v238
v_cvt_pk_bf16_f32 v248, v248, v249
v_cvt_pk_bf16_f32 v249, v250, v251
v_mfma_f32_16x16x32_bf16 v[144:147], a[128:131], a[208:211], v[144:147]
s_nop 0
ds_read_b64 a[170:171], v6 offset:1224
ds_read_b128 a[236:239], v7 offset:2240
v_cvt_pk_bf16_f32 v250, v252, v253
v_mfma_f32_16x16x32_bf16 v[144:147], a[132:135], a[204:207], v[144:147]
v_cvt_pk_bf16_f32 v251, v254, v255
v_mfma_f32_16x16x32_bf16 v[144:147], a[136:139], a[200:203], v[144:147]
s_nop 0
ds_read_b64 a[172:173], v6 offset:1728
ds_read_b64 a[174:175], v6 offset:1736
v_mfma_f32_16x16x32_bf16 v[144:147], a[140:143], a[196:199], v[144:147]
Lstub9:
s_cbranch_execz Lret
buffer_store_dwordx4 v[248:251], v1, s[44:47], s70 offen offset:3072 sc1
v_mfma_f32_16x16x32_bf16 v[144:147], a[144:147], a[192:195], v[144:147]
s_mov_b32 s73, 0x6f800000
v_add_f32 v227, v224, v228
v_add_f32 v231, v232, v236
v_add_f32 v227, v227, v231
v_mfma_f32_16x16x32_bf16 v[148:151], a[148:151], a[192:195], v[148:151]
s_nop 0
ds_read_b128 a[240:243], v7 offset:1728
ds_read_b64 a[176:177], v6 offset:2240
v_cmp_nlt_f32 vcc, v227, s73
v_mfma_f32_16x16x32_bf16 v[148:151], a[144:147], a[196:199], v[148:151]
s_lshl_b32 s73, s58, 2
v_mfma_f32_16x16x32_bf16 v[148:151], a[140:143], a[200:203], v[148:151]
s_add_u32 s73, s73, 163328
v_mov_b32 v231, s73
v_mfma_f32_16x16x32_bf16 v[148:151], a[136:139], a[204:207], v[148:151]
s_or_b32 s73, vcc_lo, vcc_hi
ds_read_b64 a[178:179], v6 offset:2248
ds_read_b128 a[244:247], v7 offset:1216
v_mfma_f32_16x16x32_bf16 v[148:151], a[132:135], a[208:211], v[148:151]
s_min_u32 s73, s73, 1
v_mov_b32 v227, s73
v_mfma_f32_16x16x32_bf16 v[148:151], a[128:131], a[212:215], v[148:151]
s_nop 0
ds_read_b64 a[180:181], v6 offset:2752
ds_read_b64 a[182:183], v6 offset:2760
ds_write_b32 v231, v227
v_mfma_f32_16x16x32_bf16 v[152:155], a[128:131], a[216:219], v[152:155]
v_mfma_f32_16x16x32_bf16 v[152:155], a[132:135], a[212:215], v[152:155]
v_mfma_f32_16x16x32_bf16 v[152:155], a[136:139], a[208:211], v[152:155]
s_nop 0
ds_read_b128 a[248:251], v7 offset:704
ds_read_b64 a[184:185], v6 offset:3264
v_mfma_f32_16x16x32_bf16 v[152:155], a[140:143], a[204:207], v[152:155]
v_mfma_f32_16x16x32_bf16 v[152:155], a[144:147], a[200:203], v[152:155]
s_nop 0
ds_read_b64 a[186:187], v6 offset:3272
ds_read_b128 a[252:255], v7 offset:192
v_mfma_f32_16x16x32_bf16 v[152:155], a[148:151], a[196:199], v[152:155]
v_mfma_f32_16x16x32_bf16 v[152:155], a[152:155], a[192:195], v[152:155]
v_mfma_f32_16x16x32_bf16 v[156:159], a[156:159], a[192:195], v[156:159]
s_nop 0
ds_read_b64 a[188:189], v6 offset:3776
ds_read_b64 a[190:191], v6 offset:3784
v_mfma_f32_16x16x32_bf16 v[156:159], a[152:155], a[196:199], v[156:159]
v_mfma_f32_16x16x32_bf16 v[156:159], a[148:151], a[200:203], v[156:159]
v_mfma_f32_16x16x32_bf16 v[156:159], a[144:147], a[204:207], v[156:159]
v_mfma_f32_16x16x32_bf16 v[156:159], a[140:143], a[208:211], v[156:159]
v_mfma_f32_16x16x32_bf16 v[156:159], a[136:139], a[212:215], v[156:159]
v_mfma_f32_16x16x32_bf16 v[156:159], a[132:135], a[216:219], v[156:159]
v_mfma_f32_16x16x32_bf16 v[156:159], a[128:131], a[220:223], v[156:159]
s_waitcnt lgkmcnt(0)
v_mfma_f32_16x16x32_bf16 v[128:131], a[160:163], a[224:227], v[128:131]
s_nop 0
ds_read_b128 a[192:195], v7 offset:3840
ds_read_b64 a[128:129], v6 offset:256
v_mfma_f32_16x16x32_bf16 v[132:135], a[164:167], a[224:227], v[132:135]
v_mfma_f32_16x16x32_bf16 v[132:135], a[160:163], a[228:231], v[132:135]
s_nop 0
ds_read_b64 a[130:131], v6 offset:264
ds_read_b128 a[196:199], v7 offset:3328
v_mfma_f32_16x16x32_bf16 v[136:139], a[160:163], a[232:235], v[136:139]
v_mfma_f32_16x16x32_bf16 v[136:139], a[164:167], a[228:231], v[136:139]
v_mfma_f32_16x16x32_bf16 v[136:139], a[168:171], a[224:227], v[136:139]
s_nop 0
ds_read_b64 a[132:133], v6 offset:768
ds_read_b64 a[134:135], v6 offset:776
v_mfma_f32_16x16x32_bf16 v[140:143], a[172:175], a[224:227], v[140:143]
v_mfma_f32_16x16x32_bf16 v[140:143], a[168:171], a[228:231], v[140:143]
s_nop 0
ds_read_b128 a[200:203], v7 offset:2816
ds_read_b64 a[136:137], v6 offset:1280
v_mfma_f32_16x16x32_bf16 v[140:143], a[164:167], a[232:235], v[140:143]
v_mfma_f32_16x16x32_bf16 v[140:143], a[160:163], a[236:239], v[140:143]
v_mfma_f32_16x16x32_bf16 v[144:147], a[160:163], a[240:243], v[144:147]
s_nop 0
ds_read_b64 a[138:139], v6 offset:1288
ds_read_b128 a[204:207], v7 offset:2304
v_mfma_f32_16x16x32_bf16 v[144:147], a[164:167], a[236:239], v[144:147]
v_mfma_f32_16x16x32_bf16 v[144:147], a[168:171], a[232:235], v[144:147]
s_nop 0
ds_read_b64 a[140:141], v6 offset:1792
ds_read_b64 a[142:143], v6 offset:1800
v_mfma_f32_16x16x32_bf16 v[144:147], a[172:175], a[228:231], v[144:147]
v_mfma_f32_16x16x32_bf16 v[144:147], a[176:179], a[224:227], v[144:147]
s_xor_b32 s71, s12, 0x100
v_mfma_f32_16x16x32_bf16 v[148:151], a[180:183], a[224:227], v[148:151]
s_add_u32 m0, s77, 16384
ds_read_b128 a[208:211], v7 offset:1792
ds_read_b64 a[144:145], v6 offset:2304
v_mfma_f32_16x16x32_bf16 v[148:151], a[176:179], a[228:231], v[148:151]
s_add_u32 s72, s71, 0
buffer_load_dwordx4 v15, s[24:27], s72 offen lds
s_nop 3
s_mov_b64 exec, 0
s_cmp_eq_u32 s58, 0
s_cbranch_scc1 Lstube0
s_cmp_eq_u32 s58, 1
s_cbranch_scc1 Lstube1
s_cmp_eq_u32 s58, 2
s_cbranch_scc1 Lstube2
s_branch Lstube3
Lrete:
s_mov_b64 exec, -1
s_nop 3
v_mfma_f32_16x16x32_bf16 v[148:151], a[172:175], a[232:235], v[148:151]
s_waitcnt vmcnt(1) lgkmcnt(15)
v_mfma_f32_16x16x32_bf16 v[148:151], a[168:171], a[236:239], v[148:151]
s_barrier
ds_read_b64 a[146:147], v6 offset:2312
ds_read_b128 a[212:215], v7 offset:1280
v_mfma_f32_16x16x32_bf16 v[148:151], a[164:167], a[240:243], v[148:151]
s_add_u32 s72, s71, 15360
buffer_load_dwordx4 v15, s[24:27], s72 offen offset:1024 lds
v_mfma_f32_16x16x32_bf16 v[148:151], a[160:163], a[244:247], v[148:151]
s_nop 0
ds_read_b64 a[148:149], v6 offset:2816
ds_read_b64 a[150:151], v6 offset:2824
v_mfma_f32_16x16x32_bf16 v[152:155], a[160:163], a[248:251], v[152:155]
v_mov_b32 v244, 163328
v_mfma_f32_16x16x32_bf16 v[152:155], a[164:167], a[244:247], v[152:155]
ds_read_b128 v[240:243], v244
v_mfma_f32_16x16x32_bf16 v[152:155], a[168:171], a[240:243], v[152:155]
s_nop 0
ds_read_b128 a[216:219], v7 offset:768
ds_read_b64 a[152:153], v6 offset:3328
v_mfma_f32_16x16x32_bf16 v[152:155], a[172:175], a[236:239], v[152:155]
v_mfma_f32_16x16x32_bf16 v[152:155], a[176:179], a[232:235], v[152:155]
s_add_u32 s72, s71, 30720
ds_read_b64 a[154:155], v6 offset:3336
ds_read_b128 a[220:223], v7 offset:256
v_mfma_f32_16x16x32_bf16 v[152:155], a[180:183], a[228:231], v[152:155]
buffer_load_dwordx4 v15, s[24:27], s72 offen offset:2048 lds
v_mfma_f32_16x16x32_bf16 v[152:155], a[184:187], a[224:227], v[152:155]
s_waitcnt lgkmcnt(4)
v_or3_b32 v240, v240, v241, v242
v_or_b32 v240, v240, v243
v_mfma_f32_16x16x32_bf16 v[156:159], a[188:191], a[224:227], v[156:159]
s_nop 0
ds_read_b64 a[156:157], v6 offset:3840
ds_read_b64 a[158:159], v6 offset:3848
v_cmp_lt_u32 vcc, s86, v240
s_cbranch_vccnz Lslow
v_mfma_f32_16x16x32_bf16 v[156:159], a[184:187], a[228:231], v[156:159]
v_or_b32 v240, s58, v0
v_mov_b32 v241, 2
v_mfma_f32_16x16x32_bf16 v[156:159], a[180:183], a[232:235], v[156:159]
v_min_u32 v240, 1, v240
v_lshlrev_b32 v240, 30, v240
v_mfma_f32_16x16x32_bf16 v[156:159], a[176:179], a[236:239], v[156:159]
s_add_u32 s72, s71, 46080
buffer_load_dwordx4 v15, s[24:27], s72 offen offset:3072 lds
v_mfma_f32_16x16x32_bf16 v[156:159], a[172:175], a[240:243], v[156:159]
buffer_store_dword v241, v240, s[44:47], s91 offen sc1
v_mfma_f32_16x16x32_bf16 v[156:159], a[168:171], a[244:247], v[156:159]
s_add_u32 s80, s93, 0x3400000
v_and_b32 v166, 7, v0
v_lshlrev_b32 v166, 4, v166
v_mfma_f32_16x16x32_bf16 v[156:159], a[164:167], a[248:251], v[156:159]
s_and_b32 s81, s59, 4
v_and_b32 v3, 3, v0
v_add_u32 v3, 1, v3
v_mfma_f32_16x16x32_bf16 v[156:159], a[160:163], a[252:255], v[156:159]
s_waitcnt lgkmcnt(0)
v_mul_u32_u24 v3, s81, v3
v_lshrrev_b32 v2, 4, v0
v_mfma_f32_16x16x32_bf16 v[128:131], a[128:131], a[192:195], v[128:131]
s_nop 0
ds_read_b128 a[224:227], v7 offset:3904
ds_read_b64 a[160:161], v6 offset:320
v_mfma_f32_16x16x32_bf16 v[132:135], a[132:135], a[192:195], v[132:135]
s_xor_b32 s71, s12, 0x180
v_lshl_add_u32 v2, v2, 10, v3
v_bfe_u32 v112, v0, 3, 1
v_mfma_f32_16x16x32_bf16 v[132:135], a[128:131], a[196:199], v[132:135]
s_add_u32 m0, s77, 32768
ds_read_b64 a[162:163], v6 offset:328
ds_read_b128 a[228:231], v7 offset:3392
v_mfma_f32_16x16x32_bf16 v[136:139], a[128:131], a[200:203], v[136:139]
s_add_u32 s72, s71, 0
buffer_load_dwordx4 v15, s[24:27], s72 offen lds
v_mfma_f32_16x16x32_bf16 v[136:139], a[132:135], a[196:199], v[136:139]
s_xor_b32 s82, s78, 0
v_lshl_add_u32 v166, v112, 8, v166
v_bfe_u32 v112, v0, 4, 1
v_mfma_f32_16x16x32_bf16 v[136:139], a[136:139], a[192:195], v[136:139]
s_lshl_b32 s82, s82, 10
ds_read_b64 a[164:165], v6 offset:832
ds_read_b64 a[166:167], v6 offset:840
v_mfma_f32_16x16x32_bf16 v[140:143], a[140:143], a[192:195], v[140:143]
s_add_u32 s82, s82, s74
buffer_load_dword v3, v2, s[44:47], s82 offen sc1
v_mfma_f32_16x16x32_bf16 v[140:143], a[136:139], a[196:199], v[140:143]
s_add_u32 s72, s71, 15360
ds_read_b128 a[232:235], v7 offset:2880
ds_read_b64 a[168:169], v6 offset:1344
v_mfma_f32_16x16x32_bf16 v[140:143], a[132:135], a[200:203], v[140:143]
buffer_load_dwordx4 v15, s[24:27], s72 offen offset:1024 lds
v_mfma_f32_16x16x32_bf16 v[140:143], a[128:131], a[204:207], v[140:143]
v_lshl_add_u32 v166, v112, 7, v166
v_lshrrev_b32 v112, 5, v0
v_mfma_f32_16x16x32_bf16 v[144:147], a[128:131], a[208:211], v[144:147]
s_nop 0
ds_read_b64 a[170:171], v6 offset:1352
ds_read_b128 a[236:239], v7 offset:2368
v_mfma_f32_16x16x32_bf16 v[144:147], a[132:135], a[204:207], v[144:147]
v_lshl_add_u32 v166, v112, 9, v166
v_and_b32 v112, 15, v0
v_mfma_f32_16x16x32_bf16 v[144:147], a[136:139], a[200:203], v[144:147]
s_nop 0
ds_read_b64 a[172:173], v6 offset:1856
ds_read_b64 a[174:175], v6 offset:1864
v_mfma_f32_16x16x32_bf16 v[144:147], a[140:143], a[196:199], v[144:147]
s_add_u32 s72, s71, 30720
buffer_load_dwordx4 v15, s[24:27], s72 offen offset:2048 lds
v_mfma_f32_16x16x32_bf16 v[144:147], a[144:147], a[192:195], v[144:147]
v_lshrrev_b32 v113, 2, v0
v_bfe_u32 v114, v0, 3, 2
v_mfma_f32_16x16x32_bf16 v[148:151], a[148:151], a[192:195], v[148:151]
s_nop 0
ds_read_b128 a[240:243], v7 offset:1856
ds_read_b64 a[176:177], v6 offset:2368
v_mfma_f32_16x16x32_bf16 v[148:151], a[144:147], a[196:199], v[148:151]
v_and_b32 v115, 3, v0
v_lshlrev_b32 v8, 7, v113
v_mfma_f32_16x16x32_bf16 v[148:151], a[140:143], a[200:203], v[148:151]
v_lshl_add_u32 v8, v114, 5, v8
v_lshl_add_u32 v8, v115, 3, v8
v_mfma_f32_16x16x32_bf16 v[148:151], a[136:139], a[204:207], v[148:151]
s_nop 0
ds_read_b64 a[178:179], v6 offset:2376
ds_read_b128 a[244:247], v7 offset:1344
v_mfma_f32_16x16x32_bf16 v[148:151], a[132:135], a[208:211], v[148:151]
s_add_u32 s72, s71, 46080
buffer_load_dwordx4 v15, s[24:27], s72 offen offset:3072 lds
v_mfma_f32_16x16x32_bf16 v[148:151], a[128:131], a[212:215], v[148:151]
s_nop 0
ds_read_b64 a[180:181], v6 offset:2880
ds_read_b64 a[182:183], v6 offset:2888
v_mfma_f32_16x16x32_bf16 v[152:155], a[128:131], a[216:219], v[152:155]
v_add_u32 v8, s77, v8
v_subrev_u32 v8, s64, v8
v_mfma_f32_16x16x32_bf16 v[152:155], a[132:135], a[212:215], v[152:155]
v_xor_b32 v9, 32, v8
v_xor_b32 v10, 64, v8
v_mfma_f32_16x16x32_bf16 v[152:155], a[136:139], a[208:211], v[152:155]
s_nop 0
ds_read_b128 a[248:251], v7 offset:832
ds_read_b64 a[184:185], v6 offset:3392
v_mfma_f32_16x16x32_bf16 v[152:155], a[140:143], a[204:207], v[152:155]
v_xor_b32 v11, 0x60, v8
v_lshlrev_b32 v5, 8, v113
v_mfma_f32_16x16x32_bf16 v[152:155], a[144:147], a[200:203], v[152:155]
s_xor_b32 s71, s13, 0x80
ds_read_b64 a[186:187], v6 offset:3400
ds_read_b128 a[252:255], v7 offset:320
v_mfma_f32_16x16x32_bf16 v[152:155], a[148:151], a[196:199], v[152:155]
s_add_u32 m0, s77, 49152
v_and_b32 v114, 1, v0
v_lshl_add_u32 v5, v114, 7, v5
v_mfma_f32_16x16x32_bf16 v[152:155], a[152:155], a[192:195], v[152:155]
s_add_u32 s72, s71, 0
buffer_load_dwordx4 v15, s[24:27], s72 offen lds
v_mfma_f32_16x16x32_bf16 v[156:159], a[156:159], a[192:195], v[156:159]
s_nop 0
ds_read_b64 a[188:189], v6 offset:3904
ds_read_b64 a[190:191], v6 offset:3912
v_mfma_f32_16x16x32_bf16 v[156:159], a[152:155], a[196:199], v[156:159]
v_bfe_u32 v114, v0, 1, 1
v_lshl_add_u32 v5, v114, 3, v5
v_mfma_f32_16x16x32_bf16 v[156:159], a[148:151], a[200:203], v[156:159]
v_lshlrev_b32 v114, 1, s58
v_xor_b32 v114, v114, v113
v_mfma_f32_16x16x32_bf16 v[156:159], a[144:147], a[204:207], v[156:159]
s_add_u32 s72, s71, 15360
buffer_load_dwordx4 v15, s[24:27], s72 offen offset:1024 lds
v_mfma_f32_16x16x32_bf16 v[156:159], a[140:143], a[208:211], v[156:159]
v_and_b32 v114, 7, v114
v_lshl_add_u32 v5, v114, 4, v5
v_mfma_f32_16x16x32_bf16 v[156:159], a[136:139], a[212:215], v[156:159]
v_add_u32 v5, 147456, v5
v_bfe_u32 v114, v0, 1, 2
v_mfma_f32_16x16x32_bf16 v[156:159], a[132:135], a[216:219], v[156:159]
v_lshrrev_b32 v115, 4, v0
v_lshlrev_b32 v116, 7, v112
v_mfma_f32_16x16x32_bf16 v[156:159], a[128:131], a[220:223], v[156:159]
s_waitcnt lgkmcnt(0)
v_lshl_add_u32 v116, v114, 5, v116
v_lshl_add_u32 v116, v115, 3, v116
v_mfma_f32_16x16x32_bf16 v[128:131], a[160:163], a[224:227], v[128:131]
s_nop 0
ds_read_b128 a[192:195], v7 offset:3968
ds_read_b64 a[128:129], v6 offset:384
v_mfma_f32_16x16x32_bf16 v[132:135], a[164:167], a[224:227], v[132:135]
s_add_u32 s72, s71, 30720
buffer_load_dwordx4 v15, s[24:27], s72 offen offset:2048 lds
v_mfma_f32_16x16x32_bf16 v[132:135], a[160:163], a[228:231], v[132:135]
s_nop 0
ds_read_b64 a[130:131], v6 offset:392
ds_read_b128 a[196:199], v7 offset:3456
v_mfma_f32_16x16x32_bf16 v[136:139], a[160:163], a[232:235], v[136:139]
v_add_u32 v116, s64, v116
v_add_u32 v116, 131072, v116
v_mfma_f32_16x16x32_bf16 v[136:139], a[164:167], a[228:231], v[136:139]
v_xor_b32 v117, 32, v116
v_xor_b32 v118, 64, v116
v_mfma_f32_16x16x32_bf16 v[136:139], a[168:171], a[224:227], v[136:139]
s_nop 0
ds_read_b64 a[132:133], v6 offset:896
ds_read_b64 a[134:135], v6 offset:904
v_mfma_f32_16x16x32_bf16 v[140:143], a[172:175], a[224:227], v[140:143]
v_xor_b32 v119, 0x60, v116
v_mfma_f32_16x16x32_bf16 v[140:143], a[168:171], a[228:231], v[140:143]
s_add_u32 s72, s71, 46080
ds_read_b128 a[200:203], v7 offset:2944
ds_read_b64 a[136:137], v6 offset:1408
v_mfma_f32_16x16x32_bf16 v[140:143], a[164:167], a[232:235], v[140:143]
buffer_load_dwordx4 v15, s[24:27], s72 offen offset:3072 lds
v_mfma_f32_16x16x32_bf16 v[140:143], a[160:163], a[236:239], v[140:143]
v_mfma_f32_16x16x32_bf16 v[144:147], a[160:163], a[240:243], v[144:147]
s_nop 0
ds_read_b64 a[138:139], v6 offset:1416
ds_read_b128 a[204:207], v7 offset:2432
v_mfma_f32_16x16x32_bf16 v[144:147], a[164:167], a[236:239], v[144:147]
v_mfma_f32_16x16x32_bf16 v[144:147], a[168:171], a[232:235], v[144:147]
s_nop 0
ds_read_b64 a[140:141], v6 offset:1920
ds_read_b64 a[142:143], v6 offset:1928
v_mfma_f32_16x16x32_bf16 v[144:147], a[172:175], a[228:231], v[144:147]
v_mfma_f32_16x16x32_bf16 v[144:147], a[176:179], a[224:227], v[144:147]
v_mfma_f32_16x16x32_bf16 v[148:151], a[180:183], a[224:227], v[148:151]
s_nop 0
ds_read_b128 a[208:211], v7 offset:1920
ds_read_b64 a[144:145], v6 offset:2432
v_mfma_f32_16x16x32_bf16 v[148:151], a[176:179], a[228:231], v[148:151]
v_mfma_f32_16x16x32_bf16 v[148:151], a[172:175], a[232:235], v[148:151]
s_waitcnt vmcnt(7)
v_cmp_gt_u32 vcc, 2, v3
s_or_b32 s81, vcc_lo, vcc_hi
s_cselect_b32 s81, 0x40000000, 0
v_or_b32 v4, s81, v1
v_mfma_f32_16x16x32_bf16 v[148:151], a[168:171], a[236:239], v[148:151]
s_nop 0
ds_read_b64 a[146:147], v6 offset:2440
ds_read_b128 a[212:215], v7 offset:1408
v_mfma_f32_16x16x32_bf16 v[148:151], a[164:167], a[240:243], v[148:151]
v_mfma_f32_16x16x32_bf16 v[148:151], a[160:163], a[244:247], v[148:151]
s_nop 0
ds_read_b64 a[148:149], v6 offset:2944
ds_read_b64 a[150:151], v6 offset:2952
v_mfma_f32_16x16x32_bf16 v[152:155], a[160:163], a[248:251], v[152:155]
v_mfma_f32_16x16x32_bf16 v[152:155], a[164:167], a[244:247], v[152:155]
s_lshr_b32 s69, s12, 18
v_mfma_f32_16x16x32_bf16 v[152:155], a[168:171], a[240:243], v[152:155]
s_lshl_b32 s69, s69, 12
ds_read_b128 a[216:219], v7 offset:896
ds_read_b64 a[152:153], v6 offset:3456
v_mfma_f32_16x16x32_bf16 v[152:155], a[172:175], a[236:239], v[152:155]
s_add_u32 s69, s69, s95
buffer_load_dwordx4 a[0:3], v4, s[44:47], s69 offen sc1
v_mfma_f32_16x16x32_bf16 v[152:155], a[176:179], a[232:235], v[152:155]
s_nop 0
ds_read_b64 a[154:155], v6 offset:3464
ds_read_b128 a[220:223], v7 offset:384
v_mfma_f32_16x16x32_bf16 v[152:155], a[180:183], a[228:231], v[152:155]
v_mfma_f32_16x16x32_bf16 v[152:155], a[184:187], a[224:227], v[152:155]
v_mfma_f32_16x16x32_bf16 v[156:159], a[188:191], a[224:227], v[156:159]
s_nop 0
ds_read_b64 a[156:157], v6 offset:3968
ds_read_b64 a[158:159], v6 offset:3976
v_mfma_f32_16x16x32_bf16 v[156:159], a[184:187], a[228:231], v[156:159]
buffer_load_dwordx4 a[4:7], v4, s[44:47], s69 offen offset:1024 sc1
v_mfma_f32_16x16x32_bf16 v[156:159], a[180:183], a[232:235], v[156:159]
v_mfma_f32_16x16x32_bf16 v[156:159], a[176:179], a[236:239], v[156:159]
v_mfma_f32_16x16x32_bf16 v[156:159], a[172:175], a[240:243], v[156:159]
v_mfma_f32_16x16x32_bf16 v[156:159], a[168:171], a[244:247], v[156:159]
buffer_load_dwordx4 a[8:11], v4, s[44:47], s69 offen offset:2048 sc1
v_mfma_f32_16x16x32_bf16 v[156:159], a[164:167], a[248:251], v[156:159]
v_mfma_f32_16x16x32_bf16 v[156:159], a[160:163], a[252:255], v[156:159]
s_waitcnt lgkmcnt(0)
v_mfma_f32_16x16x32_bf16 v[128:131], a[128:131], a[192:195], v[128:131]
s_nop 0
ds_read_b128 a[224:227], v7 offset:4032
ds_read_b64 a[160:161], v6 offset:448
v_mfma_f32_16x16x32_bf16 v[132:135], a[132:135], a[192:195], v[132:135]
v_mfma_f32_16x16x32_bf16 v[132:135], a[128:131], a[196:199], v[132:135]
s_nop 0
ds_read_b64 a[162:163], v6 offset:456
ds_read_b128 a[228:231], v7 offset:3520
v_mfma_f32_16x16x32_bf16 v[136:139], a[128:131], a[200:203], v[136:139]
buffer_load_dwordx4 a[12:15], v4, s[44:47], s69 offen offset:3072 sc1
v_mfma_f32_16x16x32_bf16 v[136:139], a[132:135], a[196:199], v[136:139]
v_mfma_f32_16x16x32_bf16 v[136:139], a[136:139], a[192:195], v[136:139]
s_nop 0
ds_read_b64 a[164:165], v6 offset:960
ds_read_b64 a[166:167], v6 offset:968
v_mfma_f32_16x16x32_bf16 v[140:143], a[140:143], a[192:195], v[140:143]
v_mfma_f32_16x16x32_bf16 v[140:143], a[136:139], a[196:199], v[140:143]
s_nop 0
ds_read_b128 a[232:235], v7 offset:3008
ds_read_b64 a[168:169], v6 offset:1472
v_mfma_f32_16x16x32_bf16 v[140:143], a[132:135], a[200:203], v[140:143]
s_add_u32 s69, s69, 0x20000
buffer_load_dwordx4 a[16:19], v4, s[44:47], s69 offen sc1
v_mfma_f32_16x16x32_bf16 v[140:143], a[128:131], a[204:207], v[140:143]
v_mfma_f32_16x16x32_bf16 v[144:147], a[128:131], a[208:211], v[144:147]
s_nop 0
ds_read_b64 a[170:171], v6 offset:1480
ds_read_b128 a[236:239], v7 offset:2496
v_mfma_f32_16x16x32_bf16 v[144:147], a[132:135], a[204:207], v[144:147]
v_mfma_f32_16x16x32_bf16 v[144:147], a[136:139], a[200:203], v[144:147]
s_nop 0
ds_read_b64 a[172:173], v6 offset:1984
ds_read_b64 a[174:175], v6 offset:1992
v_mfma_f32_16x16x32_bf16 v[144:147], a[140:143], a[196:199], v[144:147]
buffer_load_dwordx4 a[20:23], v4, s[44:47], s69 offen offset:1024 sc1
v_mfma_f32_16x16x32_bf16 v[144:147], a[144:147], a[192:195], v[144:147]
v_mfma_f32_16x16x32_bf16 v[148:151], a[148:151], a[192:195], v[148:151]
s_nop 0
ds_read_b128 a[240:243], v7 offset:1984
ds_read_b64 a[176:177], v6 offset:2496
v_mfma_f32_16x16x32_bf16 v[148:151], a[144:147], a[196:199], v[148:151]
v_mfma_f32_16x16x32_bf16 v[148:151], a[140:143], a[200:203], v[148:151]
v_mfma_f32_16x16x32_bf16 v[148:151], a[136:139], a[204:207], v[148:151]
s_nop 0
ds_read_b64 a[178:179], v6 offset:2504
ds_read_b128 a[244:247], v7 offset:1472
v_mfma_f32_16x16x32_bf16 v[148:151], a[132:135], a[208:211], v[148:151]
buffer_load_dwordx4 a[24:27], v4, s[44:47], s69 offen offset:2048 sc1
v_mfma_f32_16x16x32_bf16 v[148:151], a[128:131], a[212:215], v[148:151]
s_nop 0
ds_read_b64 a[180:181], v6 offset:3008
ds_read_b64 a[182:183], v6 offset:3016
v_mfma_f32_16x16x32_bf16 v[152:155], a[128:131], a[216:219], v[152:155]
v_mfma_f32_16x16x32_bf16 v[152:155], a[132:135], a[212:215], v[152:155]
v_mfma_f32_16x16x32_bf16 v[152:155], a[136:139], a[208:211], v[152:155]
s_nop 0
ds_read_b128 a[248:251], v7 offset:960
ds_read_b64 a[184:185], v6 offset:3520
v_mfma_f32_16x16x32_bf16 v[152:155], a[140:143], a[204:207], v[152:155]
buffer_load_dwordx4 a[28:31], v4, s[44:47], s69 offen offset:3072 sc1
v_mfma_f32_16x16x32_bf16 v[152:155], a[144:147], a[200:203], v[152:155]
s_nop 0
ds_read_b64 a[186:187], v6 offset:3528
ds_read_b128 a[252:255], v7 offset:448
v_mfma_f32_16x16x32_bf16 v[152:155], a[148:151], a[196:199], v[152:155]
v_mfma_f32_16x16x32_bf16 v[152:155], a[152:155], a[192:195], v[152:155]
s_lshr_b32 s69, s13, 18
v_mfma_f32_16x16x32_bf16 v[156:159], a[156:159], a[192:195], v[156:159]
s_lshl_b32 s69, s69, 12
ds_read_b64 a[188:189], v6 offset:4032
ds_read_b64 a[190:191], v6 offset:4040
v_mfma_f32_16x16x32_bf16 v[156:159], a[152:155], a[196:199], v[156:159]
s_add_u32 s69, s69, s95
buffer_load_dwordx4 a[32:35], v4, s[44:47], s69 offen sc1
v_mfma_f32_16x16x32_bf16 v[156:159], a[148:151], a[200:203], v[156:159]
v_mfma_f32_16x16x32_bf16 v[156:159], a[144:147], a[204:207], v[156:159]
v_mfma_f32_16x16x32_bf16 v[156:159], a[140:143], a[208:211], v[156:159]
v_mfma_f32_16x16x32_bf16 v[156:159], a[136:139], a[212:215], v[156:159]
buffer_load_dwordx4 a[36:39], v4, s[44:47], s69 offen offset:1024 sc1
v_mfma_f32_16x16x32_bf16 v[156:159], a[132:135], a[216:219], v[156:159]
v_mfma_f32_16x16x32_bf16 v[156:159], a[128:131], a[220:223], v[156:159]
s_waitcnt lgkmcnt(0)
v_mfma_f32_16x16x32_bf16 v[128:131], a[160:163], a[224:227], v[128:131]
s_nop 0
ds_read_b64_tr_b16 v[192:193], v8 offset:0
ds_read_b64_tr_b16 v[194:195], v8 offset:2048
v_mfma_f32_16x16x32_bf16 v[132:135], a[164:167], a[224:227], v[132:135]
v_mfma_f32_16x16x32_bf16 v[132:135], a[160:163], a[228:231], v[132:135]
s_nop 0
ds_read_b64_tr_b16 v[196:197], v9 offset:0
ds_read_b64_tr_b16 v[198:199], v9 offset:2048
v_mfma_f32_16x16x32_bf16 v[136:139], a[160:163], a[232:235], v[136:139]
buffer_load_dwordx4 a[40:43], v4, s[44:47], s69 offen offset:2048 sc1
v_mfma_f32_16x16x32_bf16 v[136:139], a[164:167], a[228:231], v[136:139]
s_nop 0
ds_read_b64_tr_b16 v[200:201], v10 offset:0
ds_read_b64_tr_b16 v[202:203], v10 offset:2048
v_mfma_f32_16x16x32_bf16 v[136:139], a[168:171], a[224:227], v[136:139]
v_mfma_f32_16x16x32_bf16 v[140:143], a[172:175], a[224:227], v[140:143]
s_nop 0
ds_read_b64_tr_b16 v[204:205], v11 offset:0
ds_read_b64_tr_b16 v[206:207], v11 offset:2048
v_mfma_f32_16x16x32_bf16 v[140:143], a[168:171], a[228:231], v[140:143]
v_cvt_pk_bf16_f32 v128, v128, v129
v_cvt_pk_bf16_f32 v129, v130, v131
v_cvt_pk_bf16_f32 v130, v132, v133
v_mfma_f32_16x16x32_bf16 v[140:143], a[164:167], a[232:235], v[140:143]
s_nop 0
ds_read_b64_tr_b16 v[208:209], v8 offset:4096
ds_read_b64_tr_b16 v[210:211], v8 offset:6144
v_cvt_pk_bf16_f32 v131, v134, v135
v_mfma_f32_16x16x32_bf16 v[140:143], a[160:163], a[236:239], v[140:143]
s_nop 0
buffer_load_dwordx4 a[44:47], v4, s[44:47], s69 offen offset:3072 sc1
v_permlane32_swap_b32 v128, v130
v_mfma_f32_16x16x32_bf16 v[144:147], a[160:163], a[240:243], v[144:147]
s_nop 0
ds_read_b64_tr_b16 v[212:213], v9 offset:4096
ds_read_b64_tr_b16 v[214:215], v9 offset:6144
v_permlane32_swap_b32 v129, v131
v_mfma_f32_16x16x32_bf16 v[144:147], a[164:167], a[236:239], v[144:147]
buffer_store_dwordx4 v[128:131], v166, s[44:47], s80 offen sc1
v_mfma_f32_16x16x32_bf16 v[144:147], a[168:171], a[232:235], v[144:147]
s_nop 0
ds_read_b64_tr_b16 v[216:217], v10 offset:4096
ds_read_b64_tr_b16 v[218:219], v10 offset:6144
v_mfma_f32_16x16x32_bf16 v[144:147], a[172:175], a[228:231], v[144:147]
s_add_u32 s69, s69, 0x20000
buffer_load_dwordx4 a[48:51], v4, s[44:47], s69 offen sc1
v_mfma_f32_16x16x32_bf16 v[144:147], a[176:179], a[224:227], v[144:147]
s_nop 0
ds_read_b64_tr_b16 v[220:221], v11 offset:4096
ds_read_b64_tr_b16 v[222:223], v11 offset:6144
v_cvt_pk_bf16_f32 v136, v136, v137
v_mfma_f32_16x16x32_bf16 v[148:151], a[180:183], a[224:227], v[148:151]
v_cvt_pk_bf16_f32 v137, v138, v139
v_cvt_pk_bf16_f32 v138, v140, v141
v_cvt_pk_bf16_f32 v139, v142, v143
v_mfma_f32_16x16x32_bf16 v[148:151], a[176:179], a[228:231], v[148:151]
s_nop 0
ds_read_b64_tr_b16 v[224:225], v8 offset:8192
ds_read_b64_tr_b16 v[226:227], v8 offset:10240
v_permlane32_swap_b32 v136, v138
v_mfma_f32_16x16x32_bf16 v[148:151], a[172:175], a[232:235], v[148:151]
v_permlane32_swap_b32 v137, v139
v_mfma_f32_16x16x32_bf16 v[148:151], a[168:171], a[236:239], v[148:151]
s_nop 0
ds_read_b64_tr_b16 v[228:229], v9 offset:8192
ds_read_b64_tr_b16 v[230:231], v9 offset:10240
v_mfma_f32_16x16x32_bf16 v[148:151], a[164:167], a[240:243], v[148:151]
buffer_load_dwordx4 a[52:55], v4, s[44:47], s69 offen offset:1024 sc1
v_mfma_f32_16x16x32_bf16 v[148:151], a[160:163], a[244:247], v[148:151]
s_nop 0
ds_read_b64_tr_b16 v[232:233], v10 offset:8192
ds_read_b64_tr_b16 v[234:235], v10 offset:10240
v_mfma_f32_16x16x32_bf16 v[152:155], a[160:163], a[248:251], v[152:155]
buffer_store_dwordx4 v[136:139], v166, s[44:47], s80 offen offset:1024 sc1
v_mfma_f32_16x16x32_bf16 v[152:155], a[164:167], a[244:247], v[152:155]
s_nop 0
ds_read_b64_tr_b16 v[236:237], v11 offset:8192
ds_read_b64_tr_b16 v[238:239], v11 offset:10240
v_mfma_f32_16x16x32_bf16 v[152:155], a[168:171], a[240:243], v[152:155]
buffer_load_dwordx4 a[56:59], v4, s[44:47], s69 offen offset:2048 sc1
v_mfma_f32_16x16x32_bf16 v[152:155], a[172:175], a[236:239], v[152:155]
s_nop 0
ds_read_b64_tr_b16 v[240:241], v8 offset:12288
ds_read_b64_tr_b16 v[242:243], v8 offset:14336
v_mfma_f32_16x16x32_bf16 v[152:155], a[176:179], a[232:235], v[152:155]
v_cvt_pk_bf16_f32 v144, v144, v145
v_cvt_pk_bf16_f32 v145, v146, v147
v_cvt_pk_bf16_f32 v146, v148, v149
v_mfma_f32_16x16x32_bf16 v[152:155], a[180:183], a[228:231], v[152:155]
s_nop 0
ds_read_b64_tr_b16 v[244:245], v9 offset:12288
ds_read_b64_tr_b16 v[246:247], v9 offset:14336
v_cvt_pk_bf16_f32 v147, v150, v151
v_mfma_f32_16x16x32_bf16 v[152:155], a[184:187], a[224:227], v[152:155]
v_permlane32_swap_b32 v144, v146
v_permlane32_swap_b32 v145, v147
v_mfma_f32_16x16x32_bf16 v[156:159], a[188:191], a[224:227], v[156:159]
s_nop 0
ds_read_b64_tr_b16 v[248:249], v10 offset:12288
ds_read_b64_tr_b16 v[250:251], v10 offset:14336
v_mfma_f32_16x16x32_bf16 v[156:159], a[184:187], a[228:231], v[156:159]
buffer_load_dwordx4 a[60:63], v4, s[44:47], s69 offen offset:3072 sc1
v_mfma_f32_16x16x32_bf16 v[156:159], a[180:183], a[232:235], v[156:159]
s_nop 0
ds_read_b64_tr_b16 v[252:253], v11 offset:12288
ds_read_b64_tr_b16 v[254:255], v11 offset:14336
v_mfma_f32_16x16x32_bf16 v[156:159], a[176:179], a[236:239], v[156:159]
buffer_store_dwordx4 v[144:147], v166, s[44:47], s80 offen offset:2048 sc1
v_mfma_f32_16x16x32_bf16 v[156:159], a[172:175], a[240:243], v[156:159]
v_mfma_f32_16x16x32_bf16 v[156:159], a[168:171], a[244:247], v[156:159]
v_mfma_f32_16x16x32_bf16 v[156:159], a[164:167], a[248:251], v[156:159]
v_mfma_f32_16x16x32_bf16 v[156:159], a[160:163], a[252:255], v[156:159]
v_cvt_pk_bf16_f32 v152, v152, v153
v_cvt_pk_bf16_f32 v153, v154, v155
s_nop 5
v_cvt_pk_bf16_f32 v154, v156, v157
v_cvt_pk_bf16_f32 v155, v158, v159
s_nop 0
v_permlane32_swap_b32 v152, v154
v_permlane32_swap_b32 v153, v155
buffer_store_dwordx4 v[152:155], v166, s[44:47], s80 offen offset:3072 sc1
s_waitcnt vmcnt(12) lgkmcnt(0)
s_cmp_lg_u32 s81, 0
Lstub10:
s_cbranch_execz Lret
s_cbranch_scc1 Lredo0
Lredo0b:
s_barrier
LEe:
v_mfma_f32_16x16x32_bf16 v[16:19], v[192:195], a[0:3], 0
s_nop 0
ds_read_b64_tr_b16 v[128:129], v8 offset:16384
ds_read_b64_tr_b16 v[130:131], v8 offset:18432
v_mfma_f32_16x16x32_bf16 v[16:19], v[208:211], a[4:7], v[16:19]
s_xor_b32 s71, s13, 0x100
ds_read_b64_tr_b16 v[132:133], v9 offset:16384
ds_read_b64_tr_b16 v[134:135], v9 offset:18432
v_mfma_f32_16x16x32_bf16 v[16:19], v[224:227], a[8:11], v[16:19]
s_add_u32 m0, s85, 0
ds_read_b64_tr_b16 v[136:137], v10 offset:16384
ds_read_b64_tr_b16 v[138:139], v10 offset:18432
v_mfma_f32_16x16x32_bf16 v[16:19], v[240:243], a[12:15], v[16:19]
s_add_u32 s72, s71, 0
buffer_load_dwordx4 v15, s[24:27], s72 offen lds
v_mfma_f32_16x16x32_bf16 v[32:35], v[240:243], a[28:31], 0
s_nop 0
ds_read_b64_tr_b16 v[140:141], v11 offset:16384
ds_read_b64_tr_b16 v[142:143], v11 offset:18432
v_mfma_f32_16x16x32_bf16 v[32:35], v[224:227], a[24:27], v[32:35]
s_lshr_b32 s69, s14, 18
v_add_u32 v4, s64, v1
v_add_u32 v4, 131072, v4
v_mfma_f32_16x16x32_bf16 v[32:35], v[208:211], a[20:23], v[32:35]
s_lshl_b32 s69, s69, 12
ds_read_b64_tr_b16 v[144:145], v8 offset:20480
ds_read_b64_tr_b16 v[146:147], v8 offset:22528
v_mfma_f32_16x16x32_bf16 v[32:35], v[192:195], a[16:19], v[32:35]
s_add_u32 s69, s69, s95
buffer_load_dwordx4 a[64:67], v1, s[44:47], s69 offen sc1
v_mfma_f32_16x16x32_bf16 v[36:39], v[196:199], a[16:19], 0
s_lshl_b32 s70, s75, 18
ds_read_b64_tr_b16 v[148:149], v9 offset:20480
ds_read_b64_tr_b16 v[150:151], v9 offset:22528
v_mfma_f32_16x16x32_bf16 v[36:39], v[212:215], a[20:23], v[36:39]
s_add_u32 s70, s70, s94
ds_read_b64_tr_b16 v[152:153], v10 offset:20480
ds_read_b64_tr_b16 v[154:155], v10 offset:22528
v_mfma_f32_16x16x32_bf16 v[36:39], v[228:231], a[24:27], v[36:39]
ds_write_b128 v4, v[80:83] offset:0
v_mfma_f32_16x16x32_bf16 v[36:39], v[244:247], a[28:31], v[36:39]
s_add_u32 s72, s71, 15360
buffer_load_dwordx4 v15, s[24:27], s72 offen offset:1024 lds
v_mfma_f32_16x16x32_bf16 v[20:23], v[244:247], a[12:15], 0
s_nop 0
ds_read_b64_tr_b16 v[156:157], v11 offset:20480
ds_read_b64_tr_b16 v[158:159], v11 offset:22528
v_mfma_f32_16x16x32_bf16 v[20:23], v[228:231], a[8:11], v[20:23]
s_nop 0
ds_read_b64_tr_b16 v[160:161], v8 offset:24576
ds_read_b64_tr_b16 v[162:163], v8 offset:26624
v_mfma_f32_16x16x32_bf16 v[20:23], v[212:215], a[4:7], v[20:23]
s_nop 0
ds_read_b64_tr_b16 v[164:165], v9 offset:24576
ds_read_b64_tr_b16 v[166:167], v9 offset:26624
v_mfma_f32_16x16x32_bf16 v[20:23], v[196:199], a[0:3], v[20:23]
buffer_load_dwordx4 a[68:71], v1, s[44:47], s69 offen offset:1024 sc1
v_mfma_f32_16x16x32_bf16 v[24:27], v[200:203], a[0:3], 0
ds_write_b128 v4, v[84:87] offset:1024
v_mfma_f32_16x16x32_bf16 v[24:27], v[216:219], a[4:7], v[24:27]
s_nop 0
ds_read_b64_tr_b16 v[168:169], v10 offset:24576
ds_read_b64_tr_b16 v[170:171], v10 offset:26624
v_mfma_f32_16x16x32_bf16 v[24:27], v[232:235], a[8:11], v[24:27]
s_nop 0
ds_read_b64_tr_b16 v[172:173], v11 offset:24576
ds_read_b64_tr_b16 v[174:175], v11 offset:26624
v_mfma_f32_16x16x32_bf16 v[24:27], v[248:251], a[12:15], v[24:27]
s_add_u32 s72, s71, 30720
buffer_load_dwordx4 v15, s[24:27], s72 offen offset:2048 lds
v_mfma_f32_16x16x32_bf16 v[40:43], v[248:251], a[28:31], 0
s_nop 0
ds_read_b64_tr_b16 v[176:177], v8 offset:28672
ds_read_b64_tr_b16 v[178:179], v8 offset:30720
v_mfma_f32_16x16x32_bf16 v[40:43], v[232:235], a[24:27], v[40:43]
ds_write_b128 v4, v[96:99] offset:2048
v_mfma_f32_16x16x32_bf16 v[40:43], v[216:219], a[20:23], v[40:43]
s_nop 0
ds_read_b64_tr_b16 v[180:181], v9 offset:28672
ds_read_b64_tr_b16 v[182:183], v9 offset:30720
v_mfma_f32_16x16x32_bf16 v[40:43], v[200:203], a[16:19], v[40:43]
s_nop 0
ds_read_b64_tr_b16 v[184:185], v10 offset:28672
ds_read_b64_tr_b16 v[186:187], v10 offset:30720
v_mfma_f32_16x16x32_bf16 v[44:47], v[204:207], a[16:19], 0
s_add_u32 s72, s71, 46080
buffer_load_dwordx4 v15, s[24:27], s72 offen offset:3072 lds
v_mfma_f32_16x16x32_bf16 v[44:47], v[220:223], a[20:23], v[44:47]
s_nop 0
ds_read_b64_tr_b16 v[188:189], v11 offset:28672
ds_read_b64_tr_b16 v[190:191], v11 offset:30720
v_mfma_f32_16x16x32_bf16 v[44:47], v[236:239], a[24:27], v[44:47]
ds_write_b128 v4, v[100:103] offset:3072
v_mfma_f32_16x16x32_bf16 v[44:47], v[252:255], a[28:31], v[44:47]
v_mfma_f32_16x16x32_bf16 v[28:31], v[252:255], a[12:15], 0
s_xor_b32 s71, s13, 0x180
buffer_load_dwordx4 a[72:75], v1, s[44:47], s69 offen offset:2048 sc1
v_mfma_f32_16x16x32_bf16 v[28:31], v[236:239], a[8:11], v[28:31]
s_add_u32 m0, s85, 16384
v_mfma_f32_16x16x32_bf16 v[28:31], v[220:223], a[4:7], v[28:31]
s_waitcnt vmcnt(31) lgkmcnt(0)
v_mfma_f32_16x16x32_bf16 v[28:31], v[204:207], a[0:3], v[28:31]
s_barrier
v_mfma_f32_16x16x32_bf16 v[48:51], v[128:131], a[0:3], 0
s_add_u32 s72, s71, 0
buffer_load_dwordx4 v15, s[24:27], s72 offen lds
v_mfma_f32_16x16x32_bf16 v[48:51], v[144:147], a[4:7], v[48:51]
s_nop 0
ds_read_b64_tr_b16 v[192:193], v8 offset:32768
ds_read_b64_tr_b16 v[194:195], v8 offset:34816
v_mfma_f32_16x16x32_bf16 v[48:51], v[160:163], a[8:11], v[48:51]
s_nop 0
ds_read_b64_tr_b16 v[196:197], v9 offset:32768
ds_read_b64_tr_b16 v[198:199], v9 offset:34816
v_mfma_f32_16x16x32_bf16 v[48:51], v[176:179], a[12:15], v[48:51]
s_nop 0
ds_read_b64_tr_b16 v[200:201], v10 offset:32768
ds_read_b64_tr_b16 v[202:203], v10 offset:34816
v_mfma_f32_16x16x32_bf16 v[64:67], v[176:179], a[28:31], 0
buffer_load_dwordx4 a[76:79], v1, s[44:47], s69 offen offset:3072 sc1
v_mfma_f32_16x16x32_bf16 v[64:67], v[160:163], a[24:27], v[64:67]
s_nop 0
ds_read_b64_tr_b16 v[204:205], v11 offset:32768
ds_read_b64_tr_b16 v[206:207], v11 offset:34816
v_mfma_f32_16x16x32_bf16 v[64:67], v[144:147], a[20:23], v[64:67]
v_mfma_f32_16x16x32_bf16 v[64:67], v[128:131], a[16:19], v[64:67]
s_nop 0
ds_read_b64_tr_b16 v[208:209], v8 offset:36864
ds_read_b64_tr_b16 v[210:211], v8 offset:38912
v_mfma_f32_16x16x32_bf16 v[68:71], v[132:135], a[16:19], 0
s_add_u32 s72, s71, 15360
buffer_load_dwordx4 v15, s[24:27], s72 offen offset:1024 lds
v_mfma_f32_16x16x32_bf16 v[68:71], v[148:151], a[20:23], v[68:71]
s_nop 0
ds_read_b64_tr_b16 v[212:213], v9 offset:36864
ds_read_b64_tr_b16 v[214:215], v9 offset:38912
v_mfma_f32_16x16x32_bf16 v[68:71], v[164:167], a[24:27], v[68:71]
s_nop 0
ds_read_b64_tr_b16 v[216:217], v10 offset:36864
ds_read_b64_tr_b16 v[218:219], v10 offset:38912
v_mfma_f32_16x16x32_bf16 v[68:71], v[180:183], a[28:31], v[68:71]
s_nop 0
ds_read_b64_tr_b16 v[220:221], v11 offset:36864
ds_read_b64_tr_b16 v[222:223], v11 offset:38912
v_mfma_f32_16x16x32_bf16 v[52:55], v[180:183], a[12:15], 0
v_mfma_f32_16x16x32_bf16 v[52:55], v[164:167], a[8:11], v[52:55]
s_add_u32 s69, s69, 0x20000
buffer_load_dwordx4 a[80:83], v1, s[44:47], s69 offen sc1
v_mfma_f32_16x16x32_bf16 v[52:55], v[148:151], a[4:7], v[52:55]
s_nop 0
ds_read_b64_tr_b16 v[224:225], v8 offset:40960
ds_read_b64_tr_b16 v[226:227], v8 offset:43008
v_mfma_f32_16x16x32_bf16 v[52:55], v[132:135], a[0:3], v[52:55]
s_nop 0
ds_read_b64_tr_b16 v[228:229], v9 offset:40960
ds_read_b64_tr_b16 v[230:231], v9 offset:43008
v_mfma_f32_16x16x32_bf16 v[56:59], v[136:139], a[0:3], 0
s_nop 0
ds_read_b64_tr_b16 v[232:233], v10 offset:40960
ds_read_b64_tr_b16 v[234:235], v10 offset:43008
v_mfma_f32_16x16x32_bf16 v[56:59], v[152:155], a[4:7], v[56:59]
s_add_u32 s72, s71, 30720
buffer_load_dwordx4 v15, s[24:27], s72 offen offset:2048 lds
v_mfma_f32_16x16x32_bf16 v[56:59], v[168:171], a[8:11], v[56:59]
s_nop 0
ds_read_b64_tr_b16 v[236:237], v11 offset:40960
ds_read_b64_tr_b16 v[238:239], v11 offset:43008
v_mfma_f32_16x16x32_bf16 v[56:59], v[184:187], a[12:15], v[56:59]
v_mfma_f32_16x16x32_bf16 v[72:75], v[184:187], a[28:31], 0
s_nop 0
ds_read_b64_tr_b16 v[240:241], v8 offset:45056
ds_read_b64_tr_b16 v[242:243], v8 offset:47104
v_mfma_f32_16x16x32_bf16 v[72:75], v[168:171], a[24:27], v[72:75]
s_nop 0
ds_read_b64_tr_b16 v[244:245], v9 offset:45056
ds_read_b64_tr_b16 v[246:247], v9 offset:47104
v_mfma_f32_16x16x32_bf16 v[72:75], v[152:155], a[20:23], v[72:75]
s_add_u32 s72, s71, 46080
buffer_load_dwordx4 v15, s[24:27], s72 offen offset:3072 lds
v_mfma_f32_16x16x32_bf16 v[72:75], v[136:139], a[16:19], v[72:75]
s_nop 0
ds_read_b64_tr_b16 v[248:249], v10 offset:45056
ds_read_b64_tr_b16 v[250:251], v10 offset:47104
v_mfma_f32_16x16x32_bf16 v[76:79], v[140:143], a[16:19], 0
s_nop 0
ds_read_b64_tr_b16 v[252:253], v11 offset:45056
ds_read_b64_tr_b16 v[254:255], v11 offset:47104
v_mfma_f32_16x16x32_bf16 v[76:79], v[156:159], a[20:23], v[76:79]
v_mfma_f32_16x16x32_bf16 v[76:79], v[172:175], a[24:27], v[76:79]
buffer_load_dwordx4 a[84:87], v1, s[44:47], s69 offen offset:1024 sc1
v_mfma_f32_16x16x32_bf16 v[76:79], v[188:191], a[28:31], v[76:79]
s_xor_b32 s71, s14, 0x80
v_mfma_f32_16x16x32_bf16 v[60:63], v[188:191], a[12:15], 0
s_add_u32 m0, s85, 32768
v_mfma_f32_16x16x32_bf16 v[60:63], v[172:175], a[8:11], v[60:63]
s_add_u32 s72, s71, 0
v_mfma_f32_16x16x32_bf16 v[60:63], v[156:159], a[4:7], v[60:63]
s_waitcnt vmcnt(34) lgkmcnt(0)
buffer_load_dwordx4 v15, s[24:27], s72 offen lds
v_mfma_f32_16x16x32_bf16 v[60:63], v[140:143], a[0:3], v[60:63]
s_barrier
v_mfma_f32_16x16x32_bf16 v[80:83], v[192:195], a[0:3], 0
s_nop 0
ds_read_b64_tr_b16 v[128:129], v8 offset:49152
ds_read_b64_tr_b16 v[130:131], v8 offset:51200
v_mfma_f32_16x16x32_bf16 v[80:83], v[208:211], a[4:7], v[80:83]
s_nop 0
ds_read_b64_tr_b16 v[132:133], v9 offset:49152
ds_read_b64_tr_b16 v[134:135], v9 offset:51200
v_mfma_f32_16x16x32_bf16 v[80:83], v[224:227], a[8:11], v[80:83]
buffer_load_dwordx4 a[88:91], v1, s[44:47], s69 offen offset:2048 sc1
v_mfma_f32_16x16x32_bf16 v[80:83], v[240:243], a[12:15], v[80:83]
s_nop 0
ds_read_b64_tr_b16 v[136:137], v10 offset:49152
ds_read_b64_tr_b16 v[138:139], v10 offset:51200
v_mfma_f32_16x16x32_bf16 v[96:99], v[240:243], a[28:31], 0
s_nop 0
ds_read_b64_tr_b16 v[140:141], v11 offset:49152
ds_read_b64_tr_b16 v[142:143], v11 offset:51200
v_mfma_f32_16x16x32_bf16 v[96:99], v[224:227], a[24:27], v[96:99]
v_mfma_f32_16x16x32_bf16 v[96:99], v[208:211], a[20:23], v[96:99]
s_add_u32 s72, s71, 15360
buffer_load_dwordx4 v15, s[24:27], s72 offen offset:1024 lds
v_mfma_f32_16x16x32_bf16 v[96:99], v[192:195], a[16:19], v[96:99]
s_nop 0
ds_read_b64_tr_b16 v[144:145], v8 offset:53248
ds_read_b64_tr_b16 v[146:147], v8 offset:55296
v_mfma_f32_16x16x32_bf16 v[100:103], v[196:199], a[16:19], 0
s_nop 0
ds_read_b64_tr_b16 v[148:149], v9 offset:53248
ds_read_b64_tr_b16 v[150:151], v9 offset:55296
v_mfma_f32_16x16x32_bf16 v[100:103], v[212:215], a[20:23], v[100:103]
s_nop 0
ds_read_b64_tr_b16 v[152:153], v10 offset:53248
ds_read_b64_tr_b16 v[154:155], v10 offset:55296
v_mfma_f32_16x16x32_bf16 v[100:103], v[228:231], a[24:27], v[100:103]
v_mfma_f32_16x16x32_bf16 v[100:103], v[244:247], a[28:31], v[100:103]
buffer_load_dwordx4 a[92:95], v1, s[44:47], s69 offen offset:3072 sc1
v_mfma_f32_16x16x32_bf16 v[84:87], v[244:247], a[12:15], 0
s_nop 0
ds_read_b64_tr_b16 v[156:157], v11 offset:53248
ds_read_b64_tr_b16 v[158:159], v11 offset:55296
v_mfma_f32_16x16x32_bf16 v[84:87], v[228:231], a[8:11], v[84:87]
s_nop 0
ds_read_b64_tr_b16 v[160:161], v8 offset:57344
ds_read_b64_tr_b16 v[162:163], v8 offset:59392
v_mfma_f32_16x16x32_bf16 v[84:87], v[212:215], a[4:7], v[84:87]
s_nop 0
ds_read_b64_tr_b16 v[164:165], v9 offset:57344
ds_read_b64_tr_b16 v[166:167], v9 offset:59392
v_mfma_f32_16x16x32_bf16 v[84:87], v[196:199], a[0:3], v[84:87]
s_add_u32 s72, s71, 30720
buffer_load_dwordx4 v15, s[24:27], s72 offen offset:2048 lds
v_mfma_f32_16x16x32_bf16 v[88:91], v[200:203], a[0:3], 0
v_mfma_f32_16x16x32_bf16 v[88:91], v[216:219], a[4:7], v[88:91]
s_nop 0
ds_read_b64_tr_b16 v[168:169], v10 offset:57344
ds_read_b64_tr_b16 v[170:171], v10 offset:59392
v_mfma_f32_16x16x32_bf16 v[88:91], v[232:235], a[8:11], v[88:91]
s_nop 0
ds_read_b64_tr_b16 v[172:173], v11 offset:57344
ds_read_b64_tr_b16 v[174:175], v11 offset:59392
v_mfma_f32_16x16x32_bf16 v[88:91], v[248:251], a[12:15], v[88:91]
s_nop 0
ds_read_b64_tr_b16 v[176:177], v8 offset:61440
ds_read_b64_tr_b16 v[178:179], v8 offset:63488
v_mfma_f32_16x16x32_bf16 v[104:107], v[248:251], a[28:31], 0
s_add_u32 s72, s71, 46080
buffer_load_dwordx4 v15, s[24:27], s72 offen offset:3072 lds
v_mfma_f32_16x16x32_bf16 v[104:107], v[232:235], a[24:27], v[104:107]
v_mfma_f32_16x16x32_bf16 v[104:107], v[216:219], a[20:23], v[104:107]
s_xor_b32 s82, s78, 4
ds_read_b64_tr_b16 v[180:181], v9 offset:61440
ds_read_b64_tr_b16 v[182:183], v9 offset:63488
v_mfma_f32_16x16x32_bf16 v[104:107], v[200:203], a[16:19], v[104:107]
s_lshl_b32 s82, s82, 10
ds_read_b64_tr_b16 v[184:185], v10 offset:61440
ds_read_b64_tr_b16 v[186:187], v10 offset:63488
v_mfma_f32_16x16x32_bf16 v[108:111], v[204:207], a[16:19], 0
s_add_u32 s82, s82, s74
buffer_load_dword v3, v2, s[44:47], s82 offen sc1
v_mfma_f32_16x16x32_bf16 v[108:111], v[220:223], a[20:23], v[108:111]
s_lshr_b32 s69, s15, 18
ds_read_b64_tr_b16 v[188:189], v11 offset:61440
ds_read_b64_tr_b16 v[190:191], v11 offset:63488
v_mfma_f32_16x16x32_bf16 v[108:111], v[236:239], a[24:27], v[108:111]
s_xor_b32 s71, s14, 0x100
v_mfma_f32_16x16x32_bf16 v[108:111], v[252:255], a[28:31], v[108:111]
s_add_u32 m0, s85, 49152
v_mfma_f32_16x16x32_bf16 v[92:95], v[252:255], a[12:15], 0
s_add_u32 s72, s71, 0
buffer_load_dwordx4 v15, s[24:27], s72 offen lds
v_xor_b32 v8, 0x10000, v8
v_mfma_f32_16x16x32_bf16 v[92:95], v[236:239], a[8:11], v[92:95]
s_lshl_b32 s69, s69, 12
v_xor_b32 v9, 0x10000, v9
v_mfma_f32_16x16x32_bf16 v[92:95], v[220:223], a[4:7], v[92:95]
s_waitcnt vmcnt(16) lgkmcnt(0)
v_xor_b32 v10, 0x10000, v10
v_mfma_f32_16x16x32_bf16 v[92:95], v[204:207], a[0:3], v[92:95]
s_barrier
v_xor_b32 v11, 0x10000, v11
v_mfma_f32_16x16x32_bf16 v[16:19], v[128:131], a[32:35], v[16:19]
s_add_u32 s69, s69, s95
buffer_load_dwordx4 a[96:99], v1, s[44:47], s69 offen sc1
v_mfma_f32_16x16x32_bf16 v[16:19], v[144:147], a[36:39], v[16:19]
s_nop 0
ds_read_b64_tr_b16 v[192:193], v8 offset:0
ds_read_b64_tr_b16 v[194:195], v8 offset:2048
v_mfma_f32_16x16x32_bf16 v[16:19], v[160:163], a[40:43], v[16:19]
s_nop 0
ds_read_b64_tr_b16 v[196:197], v9 offset:0
ds_read_b64_tr_b16 v[198:199], v9 offset:2048
v_mfma_f32_16x16x32_bf16 v[16:19], v[176:179], a[44:47], v[16:19]
s_nop 0
ds_read_b64_tr_b16 v[200:201], v10 offset:0
ds_read_b64_tr_b16 v[202:203], v10 offset:2048
v_mfma_f32_16x16x32_bf16 v[32:35], v[176:179], a[60:63], v[32:35]
s_add_u32 s72, s71, 15360
buffer_load_dwordx4 v15, s[24:27], s72 offen offset:1024 lds
v_mfma_f32_16x16x32_bf16 v[32:35], v[160:163], a[56:59], v[32:35]
s_nop 0
ds_read_b64_tr_b16 v[204:205], v11 offset:0
ds_read_b64_tr_b16 v[206:207], v11 offset:2048
v_mfma_f32_16x16x32_bf16 v[32:35], v[144:147], a[52:55], v[32:35]
v_or_b32 v112, s58, v0
v_mov_b32 v113, 3
v_mfma_f32_16x16x32_bf16 v[32:35], v[128:131], a[48:51], v[32:35]
s_nop 0
ds_read_b64_tr_b16 v[208:209], v8 offset:4096
ds_read_b64_tr_b16 v[210:211], v8 offset:6144
v_mfma_f32_16x16x32_bf16 v[36:39], v[132:135], a[48:51], v[36:39]
s_nop 0
ds_read_b64_tr_b16 v[212:213], v9 offset:4096
ds_read_b64_tr_b16 v[214:215], v9 offset:6144
v_mfma_f32_16x16x32_bf16 v[36:39], v[148:151], a[52:55], v[36:39]
buffer_load_dwordx4 a[100:103], v1, s[44:47], s69 offen offset:1024 sc1
v_mfma_f32_16x16x32_bf16 v[36:39], v[164:167], a[56:59], v[36:39]
s_nop 0
ds_read_b64_tr_b16 v[216:217], v10 offset:4096
ds_read_b64_tr_b16 v[218:219], v10 offset:6144
v_mfma_f32_16x16x32_bf16 v[36:39], v[180:183], a[60:63], v[36:39]
s_nop 0
ds_read_b64_tr_b16 v[220:221], v11 offset:4096
ds_read_b64_tr_b16 v[222:223], v11 offset:6144
v_mfma_f32_16x16x32_bf16 v[20:23], v[180:183], a[44:47], v[20:23]
v_min_u32 v112, 1, v112
v_lshlrev_b32 v112, 30, v112
v_mfma_f32_16x16x32_bf16 v[20:23], v[164:167], a[40:43], v[20:23]
s_add_u32 s72, s71, 30720
buffer_load_dwordx4 v15, s[24:27], s72 offen offset:2048 lds
v_mfma_f32_16x16x32_bf16 v[20:23], v[148:151], a[36:39], v[20:23]
s_nop 0
ds_read_b64_tr_b16 v[224:225], v8 offset:8192
ds_read_b64_tr_b16 v[226:227], v8 offset:10240
v_mfma_f32_16x16x32_bf16 v[20:23], v[132:135], a[32:35], v[20:23]
s_nop 0
ds_read_b64_tr_b16 v[228:229], v9 offset:8192
ds_read_b64_tr_b16 v[230:231], v9 offset:10240
v_mfma_f32_16x16x32_bf16 v[24:27], v[136:139], a[32:35], v[24:27]
s_nop 0
ds_read_b64_tr_b16 v[232:233], v10 offset:8192
ds_read_b64_tr_b16 v[234:235], v10 offset:10240
v_mfma_f32_16x16x32_bf16 v[24:27], v[152:155], a[36:39], v[24:27]
s_add_u32 s72, s71, 46080
buffer_load_dwordx4 v15, s[24:27], s72 offen offset:3072 lds
v_mfma_f32_16x16x32_bf16 v[24:27], v[168:171], a[40:43], v[24:27]
s_nop 0
ds_read_b64_tr_b16 v[236:237], v11 offset:8192
ds_read_b64_tr_b16 v[238:239], v11 offset:10240
v_mfma_f32_16x16x32_bf16 v[24:27], v[184:187], a[44:47], v[24:27]
buffer_store_dword v113, v112, s[44:47], s91 offen sc1
v_mfma_f32_16x16x32_bf16 v[40:43], v[184:187], a[60:63], v[40:43]
s_nop 0
ds_read_b64_tr_b16 v[240:241], v8 offset:12288
ds_read_b64_tr_b16 v[242:243], v8 offset:14336
v_mfma_f32_16x16x32_bf16 v[40:43], v[168:171], a[56:59], v[40:43]
buffer_load_dwordx4 a[104:107], v1, s[44:47], s69 offen offset:2048 sc1
v_mfma_f32_16x16x32_bf16 v[40:43], v[152:155], a[52:55], v[40:43]
s_nop 0
ds_read_b64_tr_b16 v[244:245], v9 offset:12288
ds_read_b64_tr_b16 v[246:247], v9 offset:14336
v_mfma_f32_16x16x32_bf16 v[40:43], v[136:139], a[48:51], v[40:43]
s_xor_b32 s71, s14, 0x180
ds_read_b64_tr_b16 v[248:249], v10 offset:12288
ds_read_b64_tr_b16 v[250:251], v10 offset:14336
v_mfma_f32_16x16x32_bf16 v[44:47], v[140:143], a[48:51], v[44:47]
s_add_u32 m0, s77, 0
ds_read_b64_tr_b16 v[252:253], v11 offset:12288
ds_read_b64_tr_b16 v[254:255], v11 offset:14336
v_mfma_f32_16x16x32_bf16 v[44:47], v[156:159], a[52:55], v[44:47]
s_add_u32 s72, s71, 0
buffer_load_dwordx4 v15, s[24:27], s72 offen lds
v_mfma_f32_16x16x32_bf16 v[44:47], v[172:175], a[56:59], v[44:47]
v_mfma_f32_16x16x32_bf16 v[44:47], v[188:191], a[60:63], v[44:47]
v_mfma_f32_16x16x32_bf16 v[28:31], v[188:191], a[44:47], v[28:31]
v_mfma_f32_16x16x32_bf16 v[28:31], v[172:175], a[40:43], v[28:31]
buffer_load_dwordx4 a[108:111], v1, s[44:47], s69 offen offset:3072 sc1
v_mfma_f32_16x16x32_bf16 v[28:31], v[156:159], a[36:39], v[28:31]
s_waitcnt vmcnt(18) lgkmcnt(0)
v_mfma_f32_16x16x32_bf16 v[28:31], v[140:143], a[32:35], v[28:31]
s_barrier
v_mfma_f32_16x16x32_bf16 v[48:51], v[192:195], a[32:35], v[48:51]
s_nop 0
ds_read_b64_tr_b16 v[128:129], v8 offset:16384
ds_read_b64_tr_b16 v[130:131], v8 offset:18432
v_mfma_f32_16x16x32_bf16 v[48:51], v[208:211], a[36:39], v[48:51]
s_add_u32 s72, s71, 15360
buffer_load_dwordx4 v15, s[24:27], s72 offen offset:1024 lds
v_mfma_f32_16x16x32_bf16 v[48:51], v[224:227], a[40:43], v[48:51]
s_nop 0
ds_read_b64_tr_b16 v[132:133], v9 offset:16384
ds_read_b64_tr_b16 v[134:135], v9 offset:18432
v_mfma_f32_16x16x32_bf16 v[48:51], v[240:243], a[44:47], v[48:51]
s_nop 0
ds_read_b64_tr_b16 v[136:137], v10 offset:16384
ds_read_b64_tr_b16 v[138:139], v10 offset:18432
v_mfma_f32_16x16x32_bf16 v[64:67], v[240:243], a[60:63], v[64:67]
s_nop 0
ds_read_b64_tr_b16 v[140:141], v11 offset:16384
ds_read_b64_tr_b16 v[142:143], v11 offset:18432
v_mfma_f32_16x16x32_bf16 v[64:67], v[224:227], a[56:59], v[64:67]
v_and_b32 v120, 15, v0
v_lshrrev_b32 v121, 4, v0
v_mfma_f32_16x16x32_bf16 v[64:67], v[208:211], a[52:55], v[64:67]
s_nop 0
ds_read_b64_tr_b16 v[144:145], v8 offset:20480
ds_read_b64_tr_b16 v[146:147], v8 offset:22528
v_mfma_f32_16x16x32_bf16 v[64:67], v[192:195], a[48:51], v[64:67]
s_add_u32 s69, s69, 0x20000
buffer_load_dwordx4 a[112:115], v1, s[44:47], s69 offen sc1
v_mfma_f32_16x16x32_bf16 v[68:71], v[196:199], a[48:51], v[68:71]
s_nop 0
ds_read_b64_tr_b16 v[148:149], v9 offset:20480
ds_read_b64_tr_b16 v[150:151], v9 offset:22528
v_mfma_f32_16x16x32_bf16 v[68:71], v[212:215], a[52:55], v[68:71]
s_nop 0
ds_read_b64_tr_b16 v[152:153], v10 offset:20480
ds_read_b64_tr_b16 v[154:155], v10 offset:22528
v_mfma_f32_16x16x32_bf16 v[68:71], v[228:231], a[56:59], v[68:71]
v_lshlrev_b32 v121, 2, v121
v_sub_u32 v120, v120, v121
v_mfma_f32_16x16x32_bf16 v[68:71], v[244:247], a[60:63], v[68:71]
s_add_u32 s72, s71, 30720
buffer_load_dwordx4 v15, s[24:27], s72 offen offset:2048 lds
v_mfma_f32_16x16x32_bf16 v[52:55], v[244:247], a[44:47], v[52:55]
s_nop 0
ds_read_b64_tr_b16 v[156:157], v11 offset:20480
ds_read_b64_tr_b16 v[158:159], v11 offset:22528
v_mfma_f32_16x16x32_bf16 v[52:55], v[228:231], a[40:43], v[52:55]
s_nop 0
ds_read_b64_tr_b16 v[160:161], v8 offset:24576
ds_read_b64_tr_b16 v[162:163], v8 offset:26624
v_mfma_f32_16x16x32_bf16 v[52:55], v[212:215], a[36:39], v[52:55]
s_nop 0
ds_read_b64_tr_b16 v[164:165], v9 offset:24576
ds_read_b64_tr_b16 v[166:167], v9 offset:26624
v_mfma_f32_16x16x32_bf16 v[52:55], v[196:199], a[32:35], v[52:55]
s_add_u32 s72, s71, 46080
buffer_load_dwordx4 v15, s[24:27], s72 offen offset:3072 lds
v_mfma_f32_16x16x32_bf16 v[56:59], v[200:203], a[32:35], v[56:59]
v_min_u32 v120, 4, v120
v_lshlrev_b32 v120, 3, v120
v_mfma_f32_16x16x32_bf16 v[56:59], v[216:219], a[36:39], v[56:59]
s_nop 0
ds_read_b64_tr_b16 v[168:169], v10 offset:24576
ds_read_b64_tr_b16 v[170:171], v10 offset:26624
v_mfma_f32_16x16x32_bf16 v[56:59], v[232:235], a[40:43], v[56:59]
s_nop 0
ds_read_b64_tr_b16 v[172:173], v11 offset:24576
ds_read_b64_tr_b16 v[174:175], v11 offset:26624
v_mfma_f32_16x16x32_bf16 v[56:59], v[248:251], a[44:47], v[56:59]
buffer_load_dwordx4 a[116:119], v1, s[44:47], s69 offen offset:1024 sc1
v_mfma_f32_16x16x32_bf16 v[72:75], v[248:251], a[60:63], v[72:75]
s_nop 0
ds_read_b64_tr_b16 v[176:177], v8 offset:28672
ds_read_b64_tr_b16 v[178:179], v8 offset:30720
v_mfma_f32_16x16x32_bf16 v[72:75], v[232:235], a[56:59], v[72:75]
s_xor_b32 s71, s15, 0x80
v_mov_b32 v122, 0x3f80
v_mov_b32 v123, 0
v_mfma_f32_16x16x32_bf16 v[72:75], v[216:219], a[52:55], v[72:75]
s_add_u32 m0, s77, 16384
ds_read_b64_tr_b16 v[180:181], v9 offset:28672
ds_read_b64_tr_b16 v[182:183], v9 offset:30720
v_mfma_f32_16x16x32_bf16 v[72:75], v[200:203], a[48:51], v[72:75]
s_add_u32 s72, s71, 0
buffer_load_dwordx4 v15, s[24:27], s72 offen lds
v_mfma_f32_16x16x32_bf16 v[76:79], v[204:207], a[48:51], v[76:79]
s_nop 0
ds_read_b64_tr_b16 v[184:185], v10 offset:28672
ds_read_b64_tr_b16 v[186:187], v10 offset:30720
v_mfma_f32_16x16x32_bf16 v[76:79], v[220:223], a[52:55], v[76:79]
s_nop 0
ds_read_b64_tr_b16 v[188:189], v11 offset:28672
ds_read_b64_tr_b16 v[190:191], v11 offset:30720
v_mfma_f32_16x16x32_bf16 v[76:79], v[236:239], a[56:59], v[76:79]
v_lshlrev_b64 v[122:123], v120, v[122:123]
v_mov_b32 v126, 0
v_mfma_f32_16x16x32_bf16 v[76:79], v[252:255], a[60:63], v[76:79]
buffer_load_dwordx4 a[120:123], v1, s[44:47], s69 offen offset:2048 sc1
v_mfma_f32_16x16x32_bf16 v[60:63], v[252:255], a[44:47], v[60:63]
v_lshlrev_b64 v[122:123], v120, v[122:123]
v_mov_b32 v127, 0
v_mfma_f32_16x16x32_bf16 v[60:63], v[236:239], a[40:43], v[60:63]
s_add_u32 s72, s71, 15360
v_mov_b32 v120, 0
v_mov_b32 v121, 0
v_mfma_f32_16x16x32_bf16 v[60:63], v[220:223], a[36:39], v[60:63]
s_waitcnt vmcnt(18) lgkmcnt(0)
v_mov_b32 v124, v122
v_mov_b32 v125, v123
v_mfma_f32_16x16x32_bf16 v[60:63], v[204:207], a[32:35], v[60:63]
s_barrier
buffer_load_dwordx4 v15, s[24:27], s72 offen offset:1024 lds
v_mfma_f32_16x16x32_bf16 v[80:83], v[128:131], a[32:35], v[80:83]
s_nop 0
ds_read_b64_tr_b16 v[192:193], v8 offset:32768
ds_read_b64_tr_b16 v[194:195], v8 offset:34816
v_mfma_f32_16x16x32_bf16 v[80:83], v[144:147], a[36:39], v[80:83]
s_nop 0
ds_read_b64_tr_b16 v[196:197], v9 offset:32768
ds_read_b64_tr_b16 v[198:199], v9 offset:34816
v_mfma_f32_16x16x32_bf16 v[80:83], v[160:163], a[40:43], v[80:83]
s_nop 0
ds_read_b64_tr_b16 v[200:201], v10 offset:32768
ds_read_b64_tr_b16 v[202:203], v10 offset:34816
v_mfma_f32_16x16x32_bf16 v[80:83], v[176:179], a[44:47], v[80:83]
s_nop 0
ds_read_b64_tr_b16 v[204:205], v11 offset:32768
ds_read_b64_tr_b16 v[206:207], v11 offset:34816
v_mfma_f32_16x16x32_bf16 v[96:99], v[176:179], a[60:63], v[96:99]
v_mfma_f32_16x16x32_bf16 v[96:99], v[160:163], a[56:59], v[96:99]
buffer_load_dwordx4 a[124:127], v1, s[44:47], s69 offen offset:3072 sc1
v_mfma_f32_16x16x32_bf16 v[96:99], v[144:147], a[52:55], v[96:99]
s_nop 0
ds_read_b64_tr_b16 v[208:209], v8 offset:36864
ds_read_b64_tr_b16 v[210:211], v8 offset:38912
v_mfma_f32_16x16x32_bf16 v[96:99], v[128:131], a[48:51], v[96:99]
s_nop 0
ds_read_b64_tr_b16 v[212:213], v9 offset:36864
ds_read_b64_tr_b16 v[214:215], v9 offset:38912
v_mfma_f32_16x16x32_bf16 v[100:103], v[132:135], a[48:51], v[100:103]
s_nop 0
ds_read_b64_tr_b16 v[216:217], v10 offset:36864
ds_read_b64_tr_b16 v[218:219], v10 offset:38912
v_mfma_f32_16x16x32_bf16 v[100:103], v[148:151], a[52:55], v[100:103]
s_add_u32 s72, s71, 30720
buffer_load_dwordx4 v15, s[24:27], s72 offen offset:2048 lds
v_mfma_f32_16x16x32_bf16 v[100:103], v[164:167], a[56:59], v[100:103]
v_mfma_f32_16x16x32_bf16 v[100:103], v[180:183], a[60:63], v[100:103]
s_nop 0
ds_read_b64_tr_b16 v[220:221], v11 offset:36864
ds_read_b64_tr_b16 v[222:223], v11 offset:38912
v_mfma_f32_16x16x32_bf16 v[84:87], v[180:183], a[44:47], v[84:87]
s_nop 0
ds_read_b64_tr_b16 v[224:225], v8 offset:40960
ds_read_b64_tr_b16 v[226:227], v8 offset:43008
v_mfma_f32_16x16x32_bf16 v[84:87], v[164:167], a[40:43], v[84:87]
s_add_u32 s72, s71, 46080
buffer_load_dwordx4 v15, s[24:27], s72 offen offset:3072 lds
v_mfma_f32_16x16x32_bf16 v[84:87], v[148:151], a[36:39], v[84:87]
s_nop 0
ds_read_b64_tr_b16 v[228:229], v9 offset:40960
ds_read_b64_tr_b16 v[230:231], v9 offset:43008
v_mfma_f32_16x16x32_bf16 v[84:87], v[132:135], a[32:35], v[84:87]
v_mfma_f32_16x16x32_bf16 v[88:91], v[136:139], a[32:35], v[88:91]
s_nop 0
ds_read_b64_tr_b16 v[232:233], v10 offset:40960
ds_read_b64_tr_b16 v[234:235], v10 offset:43008
v_mfma_f32_16x16x32_bf16 v[88:91], v[152:155], a[36:39], v[88:91]
s_waitcnt vmcnt(21)
v_cmp_gt_u32 vcc, 2, v3
s_cbranch_vccnz Lspin106
Lback107:
s_lshr_b32 s69, s12, 18
s_lshl_b32 s69, s69, 12
s_add_u32 s69, s69, s95
Lstube0:
s_cbranch_execz Lstube4
s_xor_b32 s69, s69, 0x1000
buffer_load_dwordx4 a[128:131], v1, s[44:47], s69 offen sc1
v_mfma_f32_16x16x32_bf16 v[88:91], v[168:171], a[40:43], v[88:91]
s_nop 0
ds_read_b64_tr_b16 v[236:237], v11 offset:40960
ds_read_b64_tr_b16 v[238:239], v11 offset:43008
v_mfma_f32_16x16x32_bf16 v[88:91], v[184:187], a[44:47], v[88:91]
s_xor_b32 s71, s15, 0x100
ds_read_b64_tr_b16 v[240:241], v8 offset:45056
ds_read_b64_tr_b16 v[242:243], v8 offset:47104
v_mfma_f32_16x16x32_bf16 v[104:107], v[184:187], a[60:63], v[104:107]
s_add_u32 m0, s77, 32768
v_mfma_f32_16x16x32_bf16 v[104:107], v[168:171], a[56:59], v[104:107]
s_add_u32 s72, s71, 0
buffer_load_dwordx4 v15, s[24:27], s72 offen lds
v_mfma_f32_16x16x32_bf16 v[104:107], v[152:155], a[52:55], v[104:107]
s_nop 0
ds_read_b64_tr_b16 v[244:245], v9 offset:45056
ds_read_b64_tr_b16 v[246:247], v9 offset:47104
v_mfma_f32_16x16x32_bf16 v[104:107], v[136:139], a[48:51], v[104:107]
s_nop 0
ds_read_b64_tr_b16 v[248:249], v10 offset:45056
ds_read_b64_tr_b16 v[250:251], v10 offset:47104
v_mfma_f32_16x16x32_bf16 v[108:111], v[140:143], a[48:51], v[108:111]
s_nop 0
ds_read_b64_tr_b16 v[252:253], v11 offset:45056
ds_read_b64_tr_b16 v[254:255], v11 offset:47104
v_mfma_f32_16x16x32_bf16 v[108:111], v[156:159], a[52:55], v[108:111]
buffer_load_dwordx4 a[132:135], v1, s[44:47], s69 offen offset:1024 sc1
v_mfma_f32_16x16x32_bf16 v[108:111], v[172:175], a[56:59], v[108:111]
v_mfma_f32_16x16x32_bf16 v[108:111], v[188:191], a[60:63], v[108:111]
v_mfma_f32_16x16x32_bf16 v[92:95], v[188:191], a[44:47], v[92:95]
v_mfma_f32_16x16x32_bf16 v[92:95], v[172:175], a[40:43], v[92:95]
s_add_u32 s72, s71, 15360
buffer_load_dwordx4 v15, s[24:27], s72 offen offset:1024 lds
v_mfma_f32_16x16x32_bf16 v[92:95], v[156:159], a[36:39], v[92:95]
s_waitcnt vmcnt(19) lgkmcnt(0)
v_mfma_f32_16x16x32_bf16 v[92:95], v[140:143], a[32:35], v[92:95]
s_barrier
v_mfma_f32_16x16x32_bf16 v[16:19], v[192:195], a[64:67], v[16:19]
s_nop 0
ds_read_b64_tr_b16 v[128:129], v8 offset:49152
ds_read_b64_tr_b16 v[130:131], v8 offset:51200
v_mfma_f32_16x16x32_bf16 v[16:19], v[208:211], a[68:71], v[16:19]
s_nop 0
ds_read_b64_tr_b16 v[132:133], v9 offset:49152
ds_read_b64_tr_b16 v[134:135], v9 offset:51200
v_mfma_f32_16x16x32_bf16 v[16:19], v[224:227], a[72:75], v[16:19]
s_nop 0
ds_read_b64_tr_b16 v[136:137], v10 offset:49152
ds_read_b64_tr_b16 v[138:139], v10 offset:51200
v_mfma_f32_16x16x32_bf16 v[16:19], v[240:243], a[76:79], v[16:19]
buffer_load_dwordx4 a[136:139], v1, s[44:47], s69 offen offset:2048 sc1
v_mfma_f32_16x16x32_bf16 v[32:35], v[240:243], a[92:95], v[32:35]
s_nop 0
ds_read_b64_tr_b16 v[140:141], v11 offset:49152
ds_read_b64_tr_b16 v[142:143], v11 offset:51200
v_mfma_f32_16x16x32_bf16 v[32:35], v[224:227], a[88:91], v[32:35]
v_mfma_f32_16x16x32_bf16 v[32:35], v[208:211], a[84:87], v[32:35]
s_nop 0
ds_read_b64_tr_b16 v[144:145], v8 offset:53248
ds_read_b64_tr_b16 v[146:147], v8 offset:55296
v_mfma_f32_16x16x32_bf16 v[32:35], v[192:195], a[80:83], v[32:35]
s_add_u32 s72, s71, 30720
buffer_load_dwordx4 v15, s[24:27], s72 offen offset:2048 lds
v_mfma_f32_16x16x32_bf16 v[36:39], v[196:199], a[80:83], v[36:39]
s_nop 0
ds_read_b64_tr_b16 v[148:149], v9 offset:53248
ds_read_b64_tr_b16 v[150:151], v9 offset:55296
v_mfma_f32_16x16x32_bf16 v[36:39], v[212:215], a[84:87], v[36:39]
s_nop 0
ds_read_b64_tr_b16 v[152:153], v10 offset:53248
ds_read_b64_tr_b16 v[154:155], v10 offset:55296
v_mfma_f32_16x16x32_bf16 v[36:39], v[228:231], a[88:91], v[36:39]
v_mfma_f32_16x16x32_bf16 v[36:39], v[244:247], a[92:95], v[36:39]
s_add_u32 s72, s71, 46080
buffer_load_dwordx4 v15, s[24:27], s72 offen offset:3072 lds
v_mfma_f32_16x16x32_bf16 v[20:23], v[244:247], a[76:79], v[20:23]
s_nop 0
ds_read_b64_tr_b16 v[156:157], v11 offset:53248
ds_read_b64_tr_b16 v[158:159], v11 offset:55296
v_mfma_f32_16x16x32_bf16 v[20:23], v[228:231], a[72:75], v[20:23]
s_nop 0
ds_read_b64_tr_b16 v[160:161], v8 offset:57344
ds_read_b64_tr_b16 v[162:163], v8 offset:59392
v_mfma_f32_16x16x32_bf16 v[20:23], v[212:215], a[68:71], v[20:23]
s_nop 0
ds_read_b64_tr_b16 v[164:165], v9 offset:57344
ds_read_b64_tr_b16 v[166:167], v9 offset:59392
v_mfma_f32_16x16x32_bf16 v[20:23], v[196:199], a[64:67], v[20:23]
buffer_load_dwordx4 a[140:143], v1, s[44:47], s69 offen offset:3072 sc1
v_mfma_f32_16x16x32_bf16 v[24:27], v[200:203], a[64:67], v[24:27]
v_mfma_f32_16x16x32_bf16 v[24:27], v[216:219], a[68:71], v[24:27]
s_xor_b32 s71, s15, 0x180
ds_read_b64_tr_b16 v[168:169], v10 offset:57344
ds_read_b64_tr_b16 v[170:171], v10 offset:59392
v_mfma_f32_16x16x32_bf16 v[24:27], v[232:235], a[72:75], v[24:27]
s_add_u32 m0, s77, 49152
ds_read_b64_tr_b16 v[172:173], v11 offset:57344
ds_read_b64_tr_b16 v[174:175], v11 offset:59392
v_mfma_f32_16x16x32_bf16 v[24:27], v[248:251], a[76:79], v[24:27]
s_add_u32 s72, s71, 0
buffer_load_dwordx4 v15, s[24:27], s72 offen lds
v_mfma_f32_16x16x32_bf16 v[40:43], v[248:251], a[92:95], v[40:43]
s_nop 0
ds_read_b64_tr_b16 v[176:177], v8 offset:61440
ds_read_b64_tr_b16 v[178:179], v8 offset:63488
v_mfma_f32_16x16x32_bf16 v[40:43], v[232:235], a[88:91], v[40:43]
v_mfma_f32_16x16x32_bf16 v[40:43], v[216:219], a[84:87], v[40:43]
s_nop 0
ds_read_b64_tr_b16 v[180:181], v9 offset:61440
ds_read_b64_tr_b16 v[182:183], v9 offset:63488
v_mfma_f32_16x16x32_bf16 v[40:43], v[200:203], a[80:83], v[40:43]
s_add_u32 s69, s69, 0x20000
buffer_load_dwordx4 a[144:147], v1, s[44:47], s69 offen sc1
v_mfma_f32_16x16x32_bf16 v[44:47], v[204:207], a[80:83], v[44:47]
s_nop 0
ds_read_b64_tr_b16 v[184:185], v10 offset:61440
ds_read_b64_tr_b16 v[186:187], v10 offset:63488
v_mfma_f32_16x16x32_bf16 v[44:47], v[220:223], a[84:87], v[44:47]
s_nop 0
ds_read_b64_tr_b16 v[188:189], v11 offset:61440
ds_read_b64_tr_b16 v[190:191], v11 offset:63488
v_mfma_f32_16x16x32_bf16 v[44:47], v[236:239], a[88:91], v[44:47]
v_mfma_f32_16x16x32_bf16 v[44:47], v[252:255], a[92:95], v[44:47]
s_add_u32 s72, s71, 15360
buffer_load_dwordx4 v15, s[24:27], s72 offen offset:1024 lds
v_mfma_f32_16x16x32_bf16 v[28:31], v[252:255], a[76:79], v[28:31]
v_xor_b32 v8, 0x10000, v8
v_mfma_f32_16x16x32_bf16 v[28:31], v[236:239], a[72:75], v[28:31]
v_xor_b32 v9, 0x10000, v9
v_mfma_f32_16x16x32_bf16 v[28:31], v[220:223], a[68:71], v[28:31]
s_waitcnt vmcnt(18) lgkmcnt(0)
v_xor_b32 v10, 0x10000, v10
v_mfma_f32_16x16x32_bf16 v[28:31], v[204:207], a[64:67], v[28:31]
s_barrier
v_xor_b32 v11, 0x10000, v11
v_mfma_f32_16x16x32_bf16 v[48:51], v[128:131], a[64:67], v[48:51]
s_nop 0
ds_read_b64_tr_b16 v[192:193], v8 offset:0
ds_read_b64_tr_b16 v[194:195], v8 offset:2048
v_mfma_f32_16x16x32_bf16 v[48:51], v[144:147], a[68:71], v[48:51]
s_add_u32 s72, s71, 30720
buffer_load_dwordx4 v15, s[24:27], s72 offen offset:2048 lds
v_mfma_f32_16x16x32_bf16 v[48:51], v[160:163], a[72:75], v[48:51]
s_nop 0
ds_read_b64_tr_b16 v[196:197], v9 offset:0
ds_read_b64_tr_b16 v[198:199], v9 offset:2048
v_mfma_f32_16x16x32_bf16 v[48:51], v[176:179], a[76:79], v[48:51]
s_nop 0
ds_read_b64_tr_b16 v[200:201], v10 offset:0
ds_read_b64_tr_b16 v[202:203], v10 offset:2048
v_mfma_f32_16x16x32_bf16 v[64:67], v[176:179], a[92:95], v[64:67]
s_nop 0
ds_read_b64_tr_b16 v[204:205], v11 offset:0
ds_read_b64_tr_b16 v[206:207], v11 offset:2048
v_mfma_f32_16x16x32_bf16 v[64:67], v[160:163], a[88:91], v[64:67]
buffer_load_dwordx4 a[148:151], v1, s[44:47], s69 offen offset:1024 sc1
v_mfma_f32_16x16x32_bf16 v[64:67], v[144:147], a[84:87], v[64:67]
v_mfma_f32_16x16x32_bf16 v[64:67], v[128:131], a[80:83], v[64:67]
s_nop 0
ds_read_b64_tr_b16 v[208:209], v8 offset:4096
ds_read_b64_tr_b16 v[210:211], v8 offset:6144
v_mfma_f32_16x16x32_bf16 v[68:71], v[132:135], a[80:83], v[68:71]
s_nop 0
ds_read_b64_tr_b16 v[212:213], v9 offset:4096
ds_read_b64_tr_b16 v[214:215], v9 offset:6144
v_mfma_f32_16x16x32_bf16 v[68:71], v[148:151], a[84:87], v[68:71]
s_add_u32 s72, s71, 46080
buffer_load_dwordx4 v15, s[24:27], s72 offen offset:3072 lds
v_mfma_f32_16x16x32_bf16 v[68:71], v[164:167], a[88:91], v[68:71]
s_nop 0
ds_read_b64_tr_b16 v[216:217], v10 offset:4096
ds_read_b64_tr_b16 v[218:219], v10 offset:6144
v_mfma_f32_16x16x32_bf16 v[68:71], v[180:183], a[92:95], v[68:71]
s_nop 0
ds_read_b64_tr_b16 v[220:221], v11 offset:4096
ds_read_b64_tr_b16 v[222:223], v11 offset:6144
v_mfma_f32_16x16x32_bf16 v[52:55], v[180:183], a[76:79], v[52:55]
v_mfma_f32_16x16x32_bf16 v[52:55], v[164:167], a[72:75], v[52:55]
buffer_load_dwordx4 a[152:155], v1, s[44:47], s69 offen offset:2048 sc1
v_mfma_f32_16x16x32_bf16 v[52:55], v[148:151], a[68:71], v[52:55]
s_nop 0
ds_read_b64_tr_b16 v[224:225], v8 offset:8192
ds_read_b64_tr_b16 v[226:227], v8 offset:10240
v_mfma_f32_16x16x32_bf16 v[52:55], v[132:135], a[64:67], v[52:55]
s_xor_b32 s71, s12, 0x40080
ds_read_b64_tr_b16 v[228:229], v9 offset:8192
ds_read_b64_tr_b16 v[230:231], v9 offset:10240
v_mfma_f32_16x16x32_bf16 v[56:59], v[136:139], a[64:67], v[56:59]
s_add_u32 m0, s85, 0
ds_read_b64_tr_b16 v[232:233], v10 offset:8192
ds_read_b64_tr_b16 v[234:235], v10 offset:10240
v_mfma_f32_16x16x32_bf16 v[56:59], v[152:155], a[68:71], v[56:59]
s_add_u32 s72, s71, 0
buffer_load_dwordx4 v15, s[24:27], s72 offen lds
v_mfma_f32_16x16x32_bf16 v[56:59], v[168:171], a[72:75], v[56:59]
s_nop 0
ds_read_b64_tr_b16 v[236:237], v11 offset:8192
ds_read_b64_tr_b16 v[238:239], v11 offset:10240
v_mfma_f32_16x16x32_bf16 v[56:59], v[184:187], a[76:79], v[56:59]
v_mfma_f32_16x16x32_bf16 v[72:75], v[184:187], a[92:95], v[72:75]
s_nop 0
ds_read_b64_tr_b16 v[240:241], v8 offset:12288
ds_read_b64_tr_b16 v[242:243], v8 offset:14336
v_mfma_f32_16x16x32_bf16 v[72:75], v[168:171], a[88:91], v[72:75]
buffer_load_dwordx4 a[156:159], v1, s[44:47], s69 offen offset:3072 sc1
v_mfma_f32_16x16x32_bf16 v[72:75], v[152:155], a[84:87], v[72:75]
s_nop 0
ds_read_b64_tr_b16 v[244:245], v9 offset:12288
ds_read_b64_tr_b16 v[246:247], v9 offset:14336
v_mfma_f32_16x16x32_bf16 v[72:75], v[136:139], a[80:83], v[72:75]
s_nop 0
ds_read_b64_tr_b16 v[248:249], v10 offset:12288
ds_read_b64_tr_b16 v[250:251], v10 offset:14336
v_mfma_f32_16x16x32_bf16 v[76:79], v[140:143], a[80:83], v[76:79]
s_nop 0
ds_read_b64_tr_b16 v[252:253], v11 offset:12288
ds_read_b64_tr_b16 v[254:255], v11 offset:14336
v_mfma_f32_16x16x32_bf16 v[76:79], v[156:159], a[84:87], v[76:79]
s_add_u32 s72, s71, 15360
buffer_load_dwordx4 v15, s[24:27], s72 offen offset:1024 lds
v_mfma_f32_16x16x32_bf16 v[76:79], v[172:175], a[88:91], v[76:79]
s_lshr_b32 s69, s13, 18
v_mfma_f32_16x16x32_bf16 v[76:79], v[188:191], a[92:95], v[76:79]
s_lshl_b32 s69, s69, 12
v_mfma_f32_16x16x32_bf16 v[60:63], v[188:191], a[76:79], v[60:63]
s_add_u32 s69, s69, s95
v_mfma_f32_16x16x32_bf16 v[60:63], v[172:175], a[72:75], v[60:63]
s_xor_b32 s69, s69, 0x1000
v_mfma_f32_16x16x32_bf16 v[60:63], v[156:159], a[68:71], v[60:63]
s_waitcnt vmcnt(11) lgkmcnt(0)
buffer_load_dwordx4 a[160:163], v1, s[44:47], s69 offen sc1
v_mfma_f32_16x16x32_bf16 v[60:63], v[140:143], a[64:67], v[60:63]
s_barrier
v_mfma_f32_16x16x32_bf16 v[80:83], v[192:195], a[64:67], v[80:83]
s_and_b32 s79, s91, 0xffff9fff
v_lshrrev_b32 v13, 4, v0
v_lshlrev_b32 v13, 13, v13
buffer_load_dword v14, v13, s[44:47], s79 offen sc1
v_mfma_f32_16x16x32_bf16 v[80:83], v[208:211], a[68:71], v[80:83]
s_nop 0
ds_read_b64_tr_b16 v[128:129], v8 offset:16384
ds_read_b64_tr_b16 v[130:131], v8 offset:18432
v_mfma_f32_16x16x32_bf16 v[80:83], v[224:227], a[72:75], v[80:83]
s_add_u32 s72, s71, 30720
buffer_load_dwordx4 v15, s[24:27], s72 offen offset:2048 lds
v_mfma_f32_16x16x32_bf16 v[80:83], v[240:243], a[76:79], v[80:83]
s_nop 0
ds_read_b64_tr_b16 v[132:133], v9 offset:16384
ds_read_b64_tr_b16 v[134:135], v9 offset:18432
v_mfma_f32_16x16x32_bf16 v[96:99], v[240:243], a[92:95], v[96:99]
s_nop 0
ds_read_b64_tr_b16 v[136:137], v10 offset:16384
ds_read_b64_tr_b16 v[138:139], v10 offset:18432
v_mfma_f32_16x16x32_bf16 v[96:99], v[224:227], a[88:91], v[96:99]
s_nop 0
ds_read_b64_tr_b16 v[140:141], v11 offset:16384
ds_read_b64_tr_b16 v[142:143], v11 offset:18432
v_mfma_f32_16x16x32_bf16 v[96:99], v[208:211], a[84:87], v[96:99]
s_add_u32 s72, s71, 46080
buffer_load_dwordx4 v15, s[24:27], s72 offen offset:3072 lds
v_mfma_f32_16x16x32_bf16 v[96:99], v[192:195], a[80:83], v[96:99]
v_mfma_f32_16x16x32_bf16 v[100:103], v[196:199], a[80:83], v[100:103]
s_nop 0
ds_read_b64_tr_b16 v[144:145], v8 offset:20480
ds_read_b64_tr_b16 v[146:147], v8 offset:22528
v_mfma_f32_16x16x32_bf16 v[100:103], v[212:215], a[84:87], v[100:103]
s_nop 0
ds_read_b64_tr_b16 v[148:149], v9 offset:20480
ds_read_b64_tr_b16 v[150:151], v9 offset:22528
v_mfma_f32_16x16x32_bf16 v[100:103], v[228:231], a[88:91], v[100:103]
buffer_load_dwordx4 a[164:167], v1, s[44:47], s69 offen offset:1024 sc1
v_mfma_f32_16x16x32_bf16 v[100:103], v[244:247], a[92:95], v[100:103]
s_nop 0
ds_read_b64_tr_b16 v[152:153], v10 offset:20480
ds_read_b64_tr_b16 v[154:155], v10 offset:22528
v_mfma_f32_16x16x32_bf16 v[84:87], v[244:247], a[76:79], v[84:87]
s_xor_b32 s71, s12, 0x40100
ds_read_b64_tr_b16 v[156:157], v11 offset:20480
ds_read_b64_tr_b16 v[158:159], v11 offset:22528
v_mfma_f32_16x16x32_bf16 v[84:87], v[228:231], a[72:75], v[84:87]
s_add_u32 m0, s85, 16384
v_mfma_f32_16x16x32_bf16 v[84:87], v[212:215], a[68:71], v[84:87]
s_add_u32 s72, s71, 0
buffer_load_dwordx4 v15, s[24:27], s72 offen lds
v_mfma_f32_16x16x32_bf16 v[84:87], v[196:199], a[64:67], v[84:87]
s_nop 0
ds_read_b64_tr_b16 v[160:161], v8 offset:24576
ds_read_b64_tr_b16 v[162:163], v8 offset:26624
v_mfma_f32_16x16x32_bf16 v[88:91], v[200:203], a[64:67], v[88:91]
s_nop 0
ds_read_b64_tr_b16 v[164:165], v9 offset:24576
ds_read_b64_tr_b16 v[166:167], v9 offset:26624
v_mfma_f32_16x16x32_bf16 v[88:91], v[216:219], a[68:71], v[88:91]
s_nop 0
ds_read_b64_tr_b16 v[168:169], v10 offset:24576
ds_read_b64_tr_b16 v[170:171], v10 offset:26624
v_mfma_f32_16x16x32_bf16 v[88:91], v[232:235], a[72:75], v[88:91]
buffer_load_dwordx4 a[168:171], v1, s[44:47], s69 offen offset:2048 sc1
v_mfma_f32_16x16x32_bf16 v[88:91], v[248:251], a[76:79], v[88:91]
s_nop 0
ds_read_b64_tr_b16 v[172:173], v11 offset:24576
ds_read_b64_tr_b16 v[174:175], v11 offset:26624
v_mfma_f32_16x16x32_bf16 v[104:107], v[248:251], a[92:95], v[104:107]
v_mfma_f32_16x16x32_bf16 v[104:107], v[232:235], a[88:91], v[104:107]
s_nop 0
ds_read_b64_tr_b16 v[176:177], v8 offset:28672
ds_read_b64_tr_b16 v[178:179], v8 offset:30720
v_mfma_f32_16x16x32_bf16 v[104:107], v[216:219], a[84:87], v[104:107]
s_add_u32 s72, s71, 15360
buffer_load_dwordx4 v15, s[24:27], s72 offen offset:1024 lds
v_mfma_f32_16x16x32_bf16 v[104:107], v[200:203], a[80:83], v[104:107]
s_nop 0
ds_read_b64_tr_b16 v[180:181], v9 offset:28672
ds_read_b64_tr_b16 v[182:183], v9 offset:30720
v_mfma_f32_16x16x32_bf16 v[108:111], v[204:207], a[80:83], v[108:111]
s_nop 0
ds_read_b64_tr_b16 v[184:185], v10 offset:28672
ds_read_b64_tr_b16 v[186:187], v10 offset:30720
v_mfma_f32_16x16x32_bf16 v[108:111], v[220:223], a[84:87], v[108:111]
s_nop 0
ds_read_b64_tr_b16 v[188:189], v11 offset:28672
ds_read_b64_tr_b16 v[190:191], v11 offset:30720
v_mfma_f32_16x16x32_bf16 v[108:111], v[236:239], a[88:91], v[108:111]
v_mfma_f32_16x16x32_bf16 v[108:111], v[252:255], a[92:95], v[108:111]
v_mfma_f32_16x16x32_bf16 v[92:95], v[252:255], a[76:79], v[92:95]
buffer_load_dwordx4 a[172:175], v1, s[44:47], s69 offen offset:3072 sc1
v_mfma_f32_16x16x32_bf16 v[92:95], v[236:239], a[72:75], v[92:95]
v_mfma_f32_16x16x32_bf16 v[92:95], v[220:223], a[68:71], v[92:95]
s_waitcnt vmcnt(29) lgkmcnt(0)
v_mfma_f32_16x16x32_bf16 v[92:95], v[204:207], a[64:67], v[92:95]
v_mfma_f32_16x16x32_bf16 v[16:19], v[128:131], a[96:99], v[16:19]
s_add_u32 s72, s71, 30720
buffer_load_dwordx4 v15, s[24:27], s72 offen offset:2048 lds
v_mfma_f32_16x16x32_bf16 v[16:19], v[144:147], a[100:103], v[16:19]
s_nop 0
ds_read_b64_tr_b16 v[192:193], v8 offset:32768
ds_read_b64_tr_b16 v[194:195], v8 offset:34816
v_mfma_f32_16x16x32_bf16 v[16:19], v[160:163], a[104:107], v[16:19]
s_nop 0
ds_read_b64_tr_b16 v[196:197], v9 offset:32768
ds_read_b64_tr_b16 v[198:199], v9 offset:34816
v_mfma_f32_16x16x32_bf16 v[16:19], v[176:179], a[108:111], v[16:19]
s_nop 0
ds_read_b64_tr_b16 v[200:201], v10 offset:32768
ds_read_b64_tr_b16 v[202:203], v10 offset:34816
v_mfma_f32_16x16x32_bf16 v[32:35], v[176:179], a[124:127], v[32:35]
s_add_u32 s72, s71, 46080
buffer_load_dwordx4 v15, s[24:27], s72 offen offset:3072 lds
v_mfma_f32_16x16x32_bf16 v[32:35], v[160:163], a[120:123], v[32:35]
s_nop 0
ds_read_b64_tr_b16 v[204:205], v11 offset:32768
ds_read_b64_tr_b16 v[206:207], v11 offset:34816
v_mfma_f32_16x16x32_bf16 v[32:35], v[144:147], a[116:119], v[32:35]
v_mfma_f32_16x16x32_bf16 v[32:35], v[128:131], a[112:115], v[32:35]
s_nop 0
ds_read_b64_tr_b16 v[208:209], v8 offset:36864
ds_read_b64_tr_b16 v[210:211], v8 offset:38912
v_mfma_f32_16x16x32_bf16 v[36:39], v[132:135], a[112:115], v[36:39]
s_add_u32 s69, s69, 0x20000
buffer_load_dwordx4 a[176:179], v1, s[44:47], s69 offen sc1
v_mfma_f32_16x16x32_bf16 v[36:39], v[148:151], a[116:119], v[36:39]
s_nop 0
ds_read_b64_tr_b16 v[212:213], v9 offset:36864
ds_read_b64_tr_b16 v[214:215], v9 offset:38912
v_mfma_f32_16x16x32_bf16 v[36:39], v[164:167], a[120:123], v[36:39]
s_xor_b32 s71, s12, 0x40180
ds_read_b64_tr_b16 v[216:217], v10 offset:36864
ds_read_b64_tr_b16 v[218:219], v10 offset:38912
v_mfma_f32_16x16x32_bf16 v[36:39], v[180:183], a[124:127], v[36:39]
s_add_u32 m0, s85, 32768
ds_read_b64_tr_b16 v[220:221], v11 offset:36864
ds_read_b64_tr_b16 v[222:223], v11 offset:38912
v_mfma_f32_16x16x32_bf16 v[20:23], v[180:183], a[108:111], v[20:23]
s_add_u32 s72, s71, 0
buffer_load_dwordx4 v15, s[24:27], s72 offen lds
v_mfma_f32_16x16x32_bf16 v[20:23], v[164:167], a[104:107], v[20:23]
v_mfma_f32_16x16x32_bf16 v[20:23], v[148:151], a[100:103], v[20:23]
s_nop 0
ds_read_b64_tr_b16 v[224:225], v8 offset:40960
ds_read_b64_tr_b16 v[226:227], v8 offset:43008
v_mfma_f32_16x16x32_bf16 v[20:23], v[132:135], a[96:99], v[20:23]
s_nop 0
ds_read_b64_tr_b16 v[228:229], v9 offset:40960
ds_read_b64_tr_b16 v[230:231], v9 offset:43008
v_mfma_f32_16x16x32_bf16 v[24:27], v[136:139], a[96:99], v[24:27]
buffer_load_dwordx4 a[180:183], v1, s[44:47], s69 offen offset:1024 sc1
v_mfma_f32_16x16x32_bf16 v[24:27], v[152:155], a[100:103], v[24:27]
s_nop 0
ds_read_b64_tr_b16 v[232:233], v10 offset:40960
ds_read_b64_tr_b16 v[234:235], v10 offset:43008
v_mfma_f32_16x16x32_bf16 v[24:27], v[168:171], a[104:107], v[24:27]
s_nop 0
ds_read_b64_tr_b16 v[236:237], v11 offset:40960
ds_read_b64_tr_b16 v[238:239], v11 offset:43008
v_mfma_f32_16x16x32_bf16 v[24:27], v[184:187], a[108:111], v[24:27]
v_mfma_f32_16x16x32_bf16 v[40:43], v[184:187], a[124:127], v[40:43]
s_add_u32 s72, s71, 15360
buffer_load_dwordx4 v15, s[24:27], s72 offen offset:1024 lds
v_mfma_f32_16x16x32_bf16 v[40:43], v[168:171], a[120:123], v[40:43]
s_nop 0
ds_read_b64_tr_b16 v[240:241], v8 offset:45056
ds_read_b64_tr_b16 v[242:243], v8 offset:47104
v_mfma_f32_16x16x32_bf16 v[40:43], v[152:155], a[116:119], v[40:43]
s_nop 0
ds_read_b64_tr_b16 v[244:245], v9 offset:45056
ds_read_b64_tr_b16 v[246:247], v9 offset:47104
v_mfma_f32_16x16x32_bf16 v[40:43], v[136:139], a[112:115], v[40:43]
s_nop 0
ds_read_b64_tr_b16 v[248:249], v10 offset:45056
ds_read_b64_tr_b16 v[250:251], v10 offset:47104
v_mfma_f32_16x16x32_bf16 v[44:47], v[140:143], a[112:115], v[44:47]
s_nop 0
ds_read_b64_tr_b16 v[252:253], v11 offset:45056
ds_read_b64_tr_b16 v[254:255], v11 offset:47104
v_mfma_f32_16x16x32_bf16 v[44:47], v[156:159], a[116:119], v[44:47]
v_mfma_f32_16x16x32_bf16 v[44:47], v[172:175], a[120:123], v[44:47]
s_add_u32 s72, s71, 30720
buffer_load_dwordx4 v15, s[24:27], s72 offen offset:2048 lds
v_mfma_f32_16x16x32_bf16 v[44:47], v[188:191], a[124:127], v[44:47]
v_mfma_f32_16x16x32_bf16 v[28:31], v[188:191], a[108:111], v[28:31]
v_mfma_f32_16x16x32_bf16 v[28:31], v[172:175], a[104:107], v[28:31]
v_mfma_f32_16x16x32_bf16 v[28:31], v[156:159], a[100:103], v[28:31]
s_waitcnt vmcnt(12) lgkmcnt(0)
buffer_load_dwordx4 a[184:187], v1, s[44:47], s69 offen offset:2048 sc1
v_mfma_f32_16x16x32_bf16 v[28:31], v[140:143], a[96:99], v[28:31]
s_barrier
v_mfma_f32_16x16x32_bf16 v[48:51], v[192:195], a[96:99], v[48:51]
s_nop 0
ds_read_b64_tr_b16 v[128:129], v8 offset:49152
ds_read_b64_tr_b16 v[130:131], v8 offset:51200
v_mfma_f32_16x16x32_bf16 v[48:51], v[208:211], a[100:103], v[48:51]
s_nop 0
ds_read_b64_tr_b16 v[132:133], v9 offset:49152
ds_read_b64_tr_b16 v[134:135], v9 offset:51200
v_mfma_f32_16x16x32_bf16 v[48:51], v[224:227], a[104:107], v[48:51]
s_add_u32 s72, s71, 46080
buffer_load_dwordx4 v15, s[24:27], s72 offen offset:3072 lds
v_mfma_f32_16x16x32_bf16 v[48:51], v[240:243], a[108:111], v[48:51]
s_nop 0
ds_read_b64_tr_b16 v[136:137], v10 offset:49152
ds_read_b64_tr_b16 v[138:139], v10 offset:51200
v_mfma_f32_16x16x32_bf16 v[64:67], v[240:243], a[124:127], v[64:67]
s_nop 0
ds_read_b64_tr_b16 v[140:141], v11 offset:49152
ds_read_b64_tr_b16 v[142:143], v11 offset:51200
v_mfma_f32_16x16x32_bf16 v[64:67], v[224:227], a[120:123], v[64:67]
v_mfma_f32_16x16x32_bf16 v[64:67], v[208:211], a[116:119], v[64:67]
buffer_load_dwordx4 a[188:191], v1, s[44:47], s69 offen offset:3072 sc1
v_mfma_f32_16x16x32_bf16 v[64:67], v[192:195], a[112:115], v[64:67]
s_nop 0
ds_read_b64_tr_b16 v[144:145], v8 offset:53248
ds_read_b64_tr_b16 v[146:147], v8 offset:55296
v_mfma_f32_16x16x32_bf16 v[68:71], v[196:199], a[112:115], v[68:71]
s_xor_b32 s71, s13, 0x40080
ds_read_b64_tr_b16 v[148:149], v9 offset:53248
ds_read_b64_tr_b16 v[150:151], v9 offset:55296
v_mfma_f32_16x16x32_bf16 v[68:71], v[212:215], a[116:119], v[68:71]
s_add_u32 m0, s85, 49152
ds_read_b64_tr_b16 v[152:153], v10 offset:53248
ds_read_b64_tr_b16 v[154:155], v10 offset:55296
v_mfma_f32_16x16x32_bf16 v[68:71], v[228:231], a[120:123], v[68:71]
s_add_u32 s72, s71, 0
buffer_load_dwordx4 v15, s[24:27], s72 offen lds
v_mfma_f32_16x16x32_bf16 v[68:71], v[244:247], a[124:127], v[68:71]
s_lshr_b32 s69, s14, 18
ds_read_b64_tr_b16 v[156:157], v11 offset:53248
ds_read_b64_tr_b16 v[158:159], v11 offset:55296
v_mfma_f32_16x16x32_bf16 v[52:55], v[244:247], a[108:111], v[52:55]
s_lshl_b32 s69, s69, 12
v_mfma_f32_16x16x32_bf16 v[52:55], v[228:231], a[104:107], v[52:55]
s_add_u32 s69, s69, s95
ds_read_b64_tr_b16 v[160:161], v8 offset:57344
ds_read_b64_tr_b16 v[162:163], v8 offset:59392
v_mfma_f32_16x16x32_bf16 v[52:55], v[212:215], a[100:103], v[52:55]
s_xor_b32 s69, s69, 0x1000
buffer_load_dwordx4 a[192:195], v1, s[44:47], s69 offen sc1
v_mfma_f32_16x16x32_bf16 v[52:55], v[196:199], a[96:99], v[52:55]
s_nop 0
ds_read_b64_tr_b16 v[164:165], v9 offset:57344
ds_read_b64_tr_b16 v[166:167], v9 offset:59392
v_mfma_f32_16x16x32_bf16 v[56:59], v[200:203], a[96:99], v[56:59]
s_waitcnt vmcnt(19)
v_cmp_gt_u32 vcc, 2, v14
s_cbranch_vccnz Lspin112
Lback113:
v_mfma_f32_16x16x32_bf16 v[56:59], v[216:219], a[100:103], v[56:59]
s_nop 0
ds_read_b64_tr_b16 v[168:169], v10 offset:57344
ds_read_b64_tr_b16 v[170:171], v10 offset:59392
v_mfma_f32_16x16x32_bf16 v[56:59], v[232:235], a[104:107], v[56:59]
s_add_u32 s72, s71, 15360
buffer_load_dwordx4 v15, s[24:27], s72 offen offset:1024 lds
v_mfma_f32_16x16x32_bf16 v[56:59], v[248:251], a[108:111], v[56:59]
s_nop 0
ds_read_b64_tr_b16 v[172:173], v11 offset:57344
ds_read_b64_tr_b16 v[174:175], v11 offset:59392
v_mfma_f32_16x16x32_bf16 v[72:75], v[248:251], a[124:127], v[72:75]
v_mfma_f32_16x16x32_bf16 v[72:75], v[232:235], a[120:123], v[72:75]
s_nop 0
ds_read_b64_tr_b16 v[176:177], v8 offset:61440
ds_read_b64_tr_b16 v[178:179], v8 offset:63488
v_mfma_f32_16x16x32_bf16 v[72:75], v[216:219], a[116:119], v[72:75]
s_nop 0
ds_read_b64_tr_b16 v[180:181], v9 offset:61440
ds_read_b64_tr_b16 v[182:183], v9 offset:63488
v_mfma_f32_16x16x32_bf16 v[72:75], v[200:203], a[112:115], v[72:75]
s_nop 0
ds_read_b64_tr_b16 v[184:185], v10 offset:61440
ds_read_b64_tr_b16 v[186:187], v10 offset:63488
v_mfma_f32_16x16x32_bf16 v[76:79], v[204:207], a[112:115], v[76:79]
s_add_u32 s72, s71, 30720
buffer_load_dwordx4 v15, s[24:27], s72 offen offset:2048 lds
v_mfma_f32_16x16x32_bf16 v[76:79], v[220:223], a[116:119], v[76:79]
s_nop 0
ds_read_b64_tr_b16 v[188:189], v11 offset:61440
ds_read_b64_tr_b16 v[190:191], v11 offset:63488
v_mfma_f32_16x16x32_bf16 v[76:79], v[236:239], a[120:123], v[76:79]
v_mfma_f32_16x16x32_bf16 v[76:79], v[252:255], a[124:127], v[76:79]
v_mfma_f32_16x16x32_bf16 v[60:63], v[252:255], a[108:111], v[60:63]
s_nop 0
buffer_load_dwordx4 a[196:199], v1, s[44:47], s69 offen offset:1024 sc1
v_xor_b32 v8, 0x10000, v8
v_mfma_f32_16x16x32_bf16 v[60:63], v[236:239], a[104:107], v[60:63]
v_xor_b32 v9, 0x10000, v9
v_mfma_f32_16x16x32_bf16 v[60:63], v[220:223], a[100:103], v[60:63]
s_waitcnt lgkmcnt(0)
v_xor_b32 v10, 0x10000, v10
v_mfma_f32_16x16x32_bf16 v[60:63], v[204:207], a[96:99], v[60:63]
v_xor_b32 v11, 0x10000, v11
v_mfma_f32_16x16x32_bf16 v[80:83], v[128:131], a[96:99], v[80:83]
s_add_u32 s72, s71, 46080
buffer_load_dwordx4 v15, s[24:27], s72 offen offset:3072 lds
v_mfma_f32_16x16x32_bf16 v[80:83], v[144:147], a[100:103], v[80:83]
s_lshl_b32 s84, s76, 11
ds_read_b64_tr_b16 v[192:193], v8 offset:0
ds_read_b64_tr_b16 v[194:195], v8 offset:2048
v_mfma_f32_16x16x32_bf16 v[80:83], v[160:163], a[104:107], v[80:83]
s_add_u32 s84, s84, 0x3810000
ds_read_b64_tr_b16 v[196:197], v9 offset:0
ds_read_b64_tr_b16 v[198:199], v9 offset:2048
v_mfma_f32_16x16x32_bf16 v[80:83], v[176:179], a[108:111], v[80:83]
s_nop 0
ds_read_b64_tr_b16 v[200:201], v10 offset:0
ds_read_b64_tr_b16 v[202:203], v10 offset:2048
v_mfma_f32_16x16x32_bf16 v[96:99], v[176:179], a[124:127], v[96:99]
buffer_load_dwordx4 a[200:203], v1, s[44:47], s69 offen offset:2048 sc1
v_mfma_f32_16x16x32_bf16 v[96:99], v[160:163], a[120:123], v[96:99]
s_nop 0
ds_read_b64_tr_b16 v[204:205], v11 offset:0
ds_read_b64_tr_b16 v[206:207], v11 offset:2048
v_mfma_f32_16x16x32_bf16 v[96:99], v[144:147], a[116:119], v[96:99]
s_xor_b32 s71, s14, 0x40080
v_lshrrev_b32 v115, 2, v0
v_lshlrev_b32 v115, 7, v115
v_mfma_f32_16x16x32_bf16 v[96:99], v[128:131], a[112:115], v[96:99]
s_add_u32 m0, s77, 0
ds_read_b64_tr_b16 v[208:209], v8 offset:4096
ds_read_b64_tr_b16 v[210:211], v8 offset:6144
v_mfma_f32_16x16x32_bf16 v[100:103], v[132:135], a[112:115], v[100:103]
s_add_u32 s72, s71, 0
buffer_load_dwordx4 v15, s[24:27], s72 offen lds
v_mfma_f32_16x16x32_bf16 v[100:103], v[148:151], a[116:119], v[100:103]
s_nop 0
ds_read_b64_tr_b16 v[212:213], v9 offset:4096
ds_read_b64_tr_b16 v[214:215], v9 offset:6144
v_mfma_f32_16x16x32_bf16 v[100:103], v[164:167], a[120:123], v[100:103]
Lstube1:
s_cbranch_execz Lrete
s_nop 0
ds_read_b64_tr_b16 v[216:217], v10 offset:4096
ds_read_b64_tr_b16 v[218:219], v10 offset:6144
v_mfma_f32_16x16x32_bf16 v[100:103], v[180:183], a[124:127], v[100:103]
s_nop 0
ds_read_b64_tr_b16 v[220:221], v11 offset:4096
ds_read_b64_tr_b16 v[222:223], v11 offset:6144
v_mfma_f32_16x16x32_bf16 v[84:87], v[180:183], a[108:111], v[84:87]
buffer_load_dwordx4 a[204:207], v1, s[44:47], s69 offen offset:3072 sc1
v_mfma_f32_16x16x32_bf16 v[84:87], v[164:167], a[104:107], v[84:87]
buffer_load_dword v114, v115, s[44:47], s84 offen sc1
v_mfma_f32_16x16x32_bf16 v[84:87], v[148:151], a[100:103], v[84:87]
s_nop 0
ds_read_b64_tr_b16 v[224:225], v8 offset:8192
ds_read_b64_tr_b16 v[226:227], v8 offset:10240
v_mfma_f32_16x16x32_bf16 v[84:87], v[132:135], a[96:99], v[84:87]
s_nop 0
ds_read_b64_tr_b16 v[228:229], v9 offset:8192
ds_read_b64_tr_b16 v[230:231], v9 offset:10240
v_mfma_f32_16x16x32_bf16 v[88:91], v[136:139], a[96:99], v[88:91]
s_add_u32 s72, s71, 15360
buffer_load_dwordx4 v15, s[24:27], s72 offen offset:1024 lds
v_mfma_f32_16x16x32_bf16 v[88:91], v[152:155], a[100:103], v[88:91]
s_nop 0
ds_read_b64_tr_b16 v[232:233], v10 offset:8192
ds_read_b64_tr_b16 v[234:235], v10 offset:10240
v_mfma_f32_16x16x32_bf16 v[88:91], v[168:171], a[104:107], v[88:91]
s_nop 0
ds_read_b64_tr_b16 v[236:237], v11 offset:8192
ds_read_b64_tr_b16 v[238:239], v11 offset:10240
v_mfma_f32_16x16x32_bf16 v[88:91], v[184:187], a[108:111], v[88:91]
v_mfma_f32_16x16x32_bf16 v[104:107], v[184:187], a[124:127], v[104:107]
s_nop 0
ds_read_b64_tr_b16 v[240:241], v8 offset:12288
ds_read_b64_tr_b16 v[242:243], v8 offset:14336
v_mfma_f32_16x16x32_bf16 v[104:107], v[168:171], a[120:123], v[104:107]
s_nop 0
ds_read_b64_tr_b16 v[244:245], v9 offset:12288
ds_read_b64_tr_b16 v[246:247], v9 offset:14336
v_mfma_f32_16x16x32_bf16 v[104:107], v[152:155], a[116:119], v[104:107]
s_add_u32 s72, s71, 30720
buffer_load_dwordx4 v15, s[24:27], s72 offen offset:2048 lds
v_mfma_f32_16x16x32_bf16 v[104:107], v[136:139], a[112:115], v[104:107]
s_nop 0
ds_read_b64_tr_b16 v[248:249], v10 offset:12288
ds_read_b64_tr_b16 v[250:251], v10 offset:14336
v_mfma_f32_16x16x32_bf16 v[108:111], v[140:143], a[112:115], v[108:111]
s_nop 0
ds_read_b64_tr_b16 v[252:253], v11 offset:12288
ds_read_b64_tr_b16 v[254:255], v11 offset:14336
v_mfma_f32_16x16x32_bf16 v[108:111], v[156:159], a[116:119], v[108:111]
v_mfma_f32_16x16x32_bf16 v[108:111], v[172:175], a[120:123], v[108:111]
s_add_u32 s69, s69, 0x20000
buffer_load_dwordx4 a[208:211], v1, s[44:47], s69 offen sc1
v_mfma_f32_16x16x32_bf16 v[108:111], v[188:191], a[124:127], v[108:111]
v_mfma_f32_16x16x32_bf16 v[92:95], v[188:191], a[108:111], v[92:95]
v_mfma_f32_16x16x32_bf16 v[92:95], v[172:175], a[104:107], v[92:95]
s_add_u32 s72, s71, 46080
v_mfma_f32_16x16x32_bf16 v[92:95], v[156:159], a[100:103], v[92:95]
s_waitcnt vmcnt(14) lgkmcnt(0)
buffer_load_dwordx4 v15, s[24:27], s72 offen offset:3072 lds
v_mfma_f32_16x16x32_bf16 v[92:95], v[140:143], a[96:99], v[92:95]
s_barrier
v_mfma_f32_16x16x32_bf16 v[16:19], v[192:195], a[128:131], v[16:19]
s_nop 0
ds_read_b64_tr_b16 v[128:129], v8 offset:16384
ds_read_b64_tr_b16 v[130:131], v8 offset:18432
v_mfma_f32_16x16x32_bf16 v[16:19], v[208:211], a[132:135], v[16:19]
s_nop 0
ds_read_b64_tr_b16 v[132:133], v9 offset:16384
ds_read_b64_tr_b16 v[134:135], v9 offset:18432
v_mfma_f32_16x16x32_bf16 v[16:19], v[224:227], a[136:139], v[16:19]
buffer_load_dwordx4 a[212:215], v1, s[44:47], s69 offen offset:1024 sc1
v_mfma_f32_16x16x32_bf16 v[16:19], v[240:243], a[140:143], v[16:19]
s_nop 0
ds_read_b64_tr_b16 v[136:137], v10 offset:16384
ds_read_b64_tr_b16 v[138:139], v10 offset:18432
v_mfma_f32_16x16x32_bf16 v[32:35], v[240:243], a[156:159], v[32:35]
s_xor_b32 s71, s15, 0x40080
ds_read_b64_tr_b16 v[140:141], v11 offset:16384
ds_read_b64_tr_b16 v[142:143], v11 offset:18432
v_mfma_f32_16x16x32_bf16 v[32:35], v[224:227], a[152:155], v[32:35]
s_add_u32 m0, s77, 16384
v_mfma_f32_16x16x32_bf16 v[32:35], v[208:211], a[148:151], v[32:35]
s_add_u32 s72, s71, 0
buffer_load_dwordx4 v15, s[24:27], s72 offen lds
v_mfma_f32_16x16x32_bf16 v[32:35], v[192:195], a[144:147], v[32:35]
s_nop 0
ds_read_b64_tr_b16 v[144:145], v8 offset:20480
ds_read_b64_tr_b16 v[146:147], v8 offset:22528
v_mfma_f32_16x16x32_bf16 v[36:39], v[196:199], a[144:147], v[36:39]
s_nop 0
ds_read_b64_tr_b16 v[148:149], v9 offset:20480
ds_read_b64_tr_b16 v[150:151], v9 offset:22528
v_mfma_f32_16x16x32_bf16 v[36:39], v[212:215], a[148:151], v[36:39]
s_nop 0
ds_read_b64_tr_b16 v[152:153], v10 offset:20480
ds_read_b64_tr_b16 v[154:155], v10 offset:22528
v_mfma_f32_16x16x32_bf16 v[36:39], v[228:231], a[152:155], v[36:39]
buffer_load_dwordx4 a[216:219], v1, s[44:47], s69 offen offset:2048 sc1
v_mfma_f32_16x16x32_bf16 v[36:39], v[244:247], a[156:159], v[36:39]
v_mfma_f32_16x16x32_bf16 v[20:23], v[244:247], a[140:143], v[20:23]
s_nop 0
ds_read_b64_tr_b16 v[156:157], v11 offset:20480
ds_read_b64_tr_b16 v[158:159], v11 offset:22528
v_mfma_f32_16x16x32_bf16 v[20:23], v[228:231], a[136:139], v[20:23]
s_nop 0
ds_read_b64_tr_b16 v[160:161], v8 offset:24576
ds_read_b64_tr_b16 v[162:163], v8 offset:26624
v_mfma_f32_16x16x32_bf16 v[20:23], v[212:215], a[132:135], v[20:23]
s_add_u32 s72, s71, 15360
buffer_load_dwordx4 v15, s[24:27], s72 offen offset:1024 lds
v_mfma_f32_16x16x32_bf16 v[20:23], v[196:199], a[128:131], v[20:23]
s_nop 0
ds_read_b64_tr_b16 v[164:165], v9 offset:24576
ds_read_b64_tr_b16 v[166:167], v9 offset:26624
v_mfma_f32_16x16x32_bf16 v[24:27], v[200:203], a[128:131], v[24:27]
v_mfma_f32_16x16x32_bf16 v[24:27], v[216:219], a[132:135], v[24:27]
s_nop 0
ds_read_b64_tr_b16 v[168:169], v10 offset:24576
ds_read_b64_tr_b16 v[170:171], v10 offset:26624
v_mfma_f32_16x16x32_bf16 v[24:27], v[232:235], a[136:139], v[24:27]
s_nop 0
ds_read_b64_tr_b16 v[172:173], v11 offset:24576
ds_read_b64_tr_b16 v[174:175], v11 offset:26624
v_mfma_f32_16x16x32_bf16 v[24:27], v[248:251], a[140:143], v[24:27]
s_nop 0
ds_read_b64_tr_b16 v[176:177], v8 offset:28672
ds_read_b64_tr_b16 v[178:179], v8 offset:30720
v_mfma_f32_16x16x32_bf16 v[40:43], v[248:251], a[156:159], v[40:43]
s_add_u32 s72, s71, 30720
buffer_load_dwordx4 v15, s[24:27], s72 offen offset:2048 lds
v_mfma_f32_16x16x32_bf16 v[40:43], v[232:235], a[152:155], v[40:43]
v_mfma_f32_16x16x32_bf16 v[40:43], v[216:219], a[148:151], v[40:43]
s_nop 0
ds_read_b64_tr_b16 v[180:181], v9 offset:28672
ds_read_b64_tr_b16 v[182:183], v9 offset:30720
v_mfma_f32_16x16x32_bf16 v[40:43], v[200:203], a[144:147], v[40:43]
s_nop 0
ds_read_b64_tr_b16 v[184:185], v10 offset:28672
ds_read_b64_tr_b16 v[186:187], v10 offset:30720
v_mfma_f32_16x16x32_bf16 v[44:47], v[204:207], a[144:147], v[44:47]
buffer_load_dwordx4 a[220:223], v1, s[44:47], s69 offen offset:3072 sc1
v_mfma_f32_16x16x32_bf16 v[44:47], v[220:223], a[148:151], v[44:47]
s_nop 0
ds_read_b64_tr_b16 v[188:189], v11 offset:28672
ds_read_b64_tr_b16 v[190:191], v11 offset:30720
v_mfma_f32_16x16x32_bf16 v[44:47], v[236:239], a[152:155], v[44:47]
s_lshr_b32 s69, s15, 18
v_mfma_f32_16x16x32_bf16 v[44:47], v[252:255], a[156:159], v[44:47]
s_lshl_b32 s69, s69, 12
v_mfma_f32_16x16x32_bf16 v[28:31], v[252:255], a[140:143], v[28:31]
s_add_u32 s72, s71, 46080
buffer_load_dwordx4 v15, s[24:27], s72 offen offset:3072 lds
v_mfma_f32_16x16x32_bf16 v[28:31], v[236:239], a[136:139], v[28:31]
s_add_u32 s69, s69, s95
v_mfma_f32_16x16x32_bf16 v[28:31], v[220:223], a[132:135], v[28:31]
s_waitcnt lgkmcnt(0)
v_mfma_f32_16x16x32_bf16 v[28:31], v[204:207], a[128:131], v[28:31]
v_mfma_f32_16x16x32_bf16 v[48:51], v[128:131], a[128:131], v[48:51]
s_xor_b32 s69, s69, 0x1000
buffer_load_dwordx4 a[224:227], v1, s[44:47], s69 offen sc1
v_mfma_f32_16x16x32_bf16 v[48:51], v[144:147], a[132:135], v[48:51]
s_nop 0
ds_read_b64_tr_b16 v[192:193], v8 offset:32768
ds_read_b64_tr_b16 v[194:195], v8 offset:34816
v_mfma_f32_16x16x32_bf16 v[48:51], v[160:163], a[136:139], v[48:51]
s_xor_b32 s71, s13, 0x40100
ds_read_b64_tr_b16 v[196:197], v9 offset:32768
ds_read_b64_tr_b16 v[198:199], v9 offset:34816
v_mfma_f32_16x16x32_bf16 v[48:51], v[176:179], a[140:143], v[48:51]
s_add_u32 m0, s77, 32768
ds_read_b64_tr_b16 v[200:201], v10 offset:32768
ds_read_b64_tr_b16 v[202:203], v10 offset:34816
v_mfma_f32_16x16x32_bf16 v[64:67], v[176:179], a[156:159], v[64:67]
s_add_u32 s72, s71, 0
buffer_load_dwordx4 v15, s[24:27], s72 offen lds
v_mfma_f32_16x16x32_bf16 v[64:67], v[160:163], a[152:155], v[64:67]
s_nop 0
ds_read_b64_tr_b16 v[204:205], v11 offset:32768
ds_read_b64_tr_b16 v[206:207], v11 offset:34816
v_mfma_f32_16x16x32_bf16 v[64:67], v[144:147], a[148:151], v[64:67]
v_mfma_f32_16x16x32_bf16 v[64:67], v[128:131], a[144:147], v[64:67]
s_nop 0
ds_read_b64_tr_b16 v[208:209], v8 offset:36864
ds_read_b64_tr_b16 v[210:211], v8 offset:38912
v_mfma_f32_16x16x32_bf16 v[68:71], v[132:135], a[144:147], v[68:71]
buffer_load_dwordx4 a[228:231], v1, s[44:47], s69 offen offset:1024 sc1
v_mfma_f32_16x16x32_bf16 v[68:71], v[148:151], a[148:151], v[68:71]
s_nop 0
ds_read_b64_tr_b16 v[212:213], v9 offset:36864
ds_read_b64_tr_b16 v[214:215], v9 offset:38912
v_mfma_f32_16x16x32_bf16 v[68:71], v[164:167], a[152:155], v[68:71]
s_nop 0
ds_read_b64_tr_b16 v[216:217], v10 offset:36864
ds_read_b64_tr_b16 v[218:219], v10 offset:38912
v_mfma_f32_16x16x32_bf16 v[68:71], v[180:183], a[156:159], v[68:71]
s_nop 0
ds_read_b64_tr_b16 v[220:221], v11 offset:36864
ds_read_b64_tr_b16 v[222:223], v11 offset:38912
v_mfma_f32_16x16x32_bf16 v[52:55], v[180:183], a[140:143], v[52:55]
s_add_u32 s72, s71, 15360
buffer_load_dwordx4 v15, s[24:27], s72 offen offset:1024 lds
v_mfma_f32_16x16x32_bf16 v[52:55], v[164:167], a[136:139], v[52:55]
v_mfma_f32_16x16x32_bf16 v[52:55], v[148:151], a[132:135], v[52:55]
s_nop 0
ds_read_b64_tr_b16 v[224:225], v8 offset:40960
ds_read_b64_tr_b16 v[226:227], v8 offset:43008
v_mfma_f32_16x16x32_bf16 v[52:55], v[132:135], a[128:131], v[52:55]
s_nop 0
ds_read_b64_tr_b16 v[228:229], v9 offset:40960
ds_read_b64_tr_b16 v[230:231], v9 offset:43008
v_mfma_f32_16x16x32_bf16 v[56:59], v[136:139], a[128:131], v[56:59]
s_nop 0
ds_read_b64_tr_b16 v[232:233], v10 offset:40960
ds_read_b64_tr_b16 v[234:235], v10 offset:43008
v_mfma_f32_16x16x32_bf16 v[56:59], v[152:155], a[132:135], v[56:59]
s_add_u32 s72, s71, 30720
buffer_load_dwordx4 v15, s[24:27], s72 offen offset:2048 lds
v_mfma_f32_16x16x32_bf16 v[56:59], v[168:171], a[136:139], v[56:59]
s_nop 0
ds_read_b64_tr_b16 v[236:237], v11 offset:40960
ds_read_b64_tr_b16 v[238:239], v11 offset:43008
v_mfma_f32_16x16x32_bf16 v[56:59], v[184:187], a[140:143], v[56:59]
v_mfma_f32_16x16x32_bf16 v[72:75], v[184:187], a[156:159], v[72:75]
s_nop 0
ds_read_b64_tr_b16 v[240:241], v8 offset:45056
ds_read_b64_tr_b16 v[242:243], v8 offset:47104
v_mfma_f32_16x16x32_bf16 v[72:75], v[168:171], a[152:155], v[72:75]
buffer_load_dwordx4 a[232:235], v1, s[44:47], s69 offen offset:2048 sc1
v_mfma_f32_16x16x32_bf16 v[72:75], v[152:155], a[148:151], v[72:75]
s_nop 0
ds_read_b64_tr_b16 v[244:245], v9 offset:45056
ds_read_b64_tr_b16 v[246:247], v9 offset:47104
v_mfma_f32_16x16x32_bf16 v[72:75], v[136:139], a[144:147], v[72:75]
s_nop 0
ds_read_b64_tr_b16 v[248:249], v10 offset:45056
ds_read_b64_tr_b16 v[250:251], v10 offset:47104
v_mfma_f32_16x16x32_bf16 v[76:79], v[140:143], a[144:147], v[76:79]
s_nop 0
ds_read_b64_tr_b16 v[252:253], v11 offset:45056
ds_read_b64_tr_b16 v[254:255], v11 offset:47104
v_mfma_f32_16x16x32_bf16 v[76:79], v[156:159], a[148:151], v[76:79]
s_add_u32 s72, s71, 46080
buffer_load_dwordx4 v15, s[24:27], s72 offen offset:3072 lds
v_mfma_f32_16x16x32_bf16 v[76:79], v[172:175], a[152:155], v[76:79]
v_mfma_f32_16x16x32_bf16 v[76:79], v[188:191], a[156:159], v[76:79]
v_mfma_f32_16x16x32_bf16 v[60:63], v[188:191], a[140:143], v[60:63]
v_mfma_f32_16x16x32_bf16 v[60:63], v[172:175], a[136:139], v[60:63]
s_xor_b32 s71, s14, 0x40100
buffer_load_dwordx4 a[236:239], v1, s[44:47], s69 offen offset:3072 sc1
v_mfma_f32_16x16x32_bf16 v[60:63], v[156:159], a[132:135], v[60:63]
s_waitcnt vmcnt(15) lgkmcnt(0)
v_mfma_f32_16x16x32_bf16 v[60:63], v[140:143], a[128:131], v[60:63]
s_barrier
v_mfma_f32_16x16x32_bf16 v[80:83], v[192:195], a[128:131], v[80:83]
s_add_u32 m0, s77, 49152
ds_read_b64_tr_b16 v[128:129], v8 offset:49152
ds_read_b64_tr_b16 v[130:131], v8 offset:51200
v_mfma_f32_16x16x32_bf16 v[80:83], v[208:211], a[132:135], v[80:83]
s_add_u32 s72, s71, 0
buffer_load_dwordx4 v15, s[24:27], s72 offen lds
v_mfma_f32_16x16x32_bf16 v[80:83], v[224:227], a[136:139], v[80:83]
s_nop 0
ds_read_b64_tr_b16 v[132:133], v9 offset:49152
ds_read_b64_tr_b16 v[134:135], v9 offset:51200
s_waitcnt vmcnt(20)
v_cmp_gt_u32 vcc, 3, v114
s_cbranch_vccnz Lspin109
Lback110:
v_mfma_f32_16x16x32_bf16 v[80:83], v[240:243], a[140:143], v[80:83]
s_lshl_b32 s73, s76, 18
ds_read_b64_tr_b16 v[136:137], v10 offset:49152
ds_read_b64_tr_b16 v[138:139], v10 offset:51200
v_mfma_f32_16x16x32_bf16 v[96:99], v[240:243], a[156:159], v[96:99]
s_lshl_b32 s84, s58, 16
ds_read_b64_tr_b16 v[140:141], v11 offset:49152
ds_read_b64_tr_b16 v[142:143], v11 offset:51200
v_mfma_f32_16x16x32_bf16 v[96:99], v[224:227], a[152:155], v[96:99]
s_add_u32 s73, s73, s84
v_mfma_f32_16x16x32_bf16 v[96:99], v[208:211], a[148:151], v[96:99]
s_add_u32 s69, s69, 0x20000
buffer_load_dwordx4 a[240:243], v1, s[44:47], s69 offen sc1
v_mfma_f32_16x16x32_bf16 v[96:99], v[192:195], a[144:147], v[96:99]
s_lshl_b32 s84, s75, 8
ds_read_b64_tr_b16 v[144:145], v8 offset:53248
ds_read_b64_tr_b16 v[146:147], v8 offset:55296
v_mfma_f32_16x16x32_bf16 v[100:103], v[196:199], a[144:147], v[100:103]
s_add_u32 s73, s73, s84
ds_read_b64_tr_b16 v[148:149], v9 offset:53248
ds_read_b64_tr_b16 v[150:151], v9 offset:55296
v_mfma_f32_16x16x32_bf16 v[100:103], v[212:215], a[148:151], v[100:103]
s_add_u32 s73, s73, 0x3400000
ds_read_b64_tr_b16 v[152:153], v10 offset:53248
ds_read_b64_tr_b16 v[154:155], v10 offset:55296
v_mfma_f32_16x16x32_bf16 v[100:103], v[228:231], a[152:155], v[100:103]
s_add_u32 s72, s71, 15360
buffer_load_dwordx4 v15, s[24:27], s72 offen offset:1024 lds
v_mfma_f32_16x16x32_bf16 v[100:103], v[244:247], a[156:159], v[100:103]
v_lshrrev_b32 v112, 4, v0
v_and_b32 v113, 15, v0
v_mfma_f32_16x16x32_bf16 v[84:87], v[244:247], a[140:143], v[84:87]
s_nop 0
ds_read_b64_tr_b16 v[156:157], v11 offset:53248
ds_read_b64_tr_b16 v[158:159], v11 offset:55296
v_mfma_f32_16x16x32_bf16 v[84:87], v[228:231], a[136:139], v[84:87]
s_nop 0
ds_read_b64_tr_b16 v[160:161], v8 offset:57344
ds_read_b64_tr_b16 v[162:163], v8 offset:59392
v_mfma_f32_16x16x32_bf16 v[84:87], v[212:215], a[132:135], v[84:87]
s_nop 0
ds_read_b64_tr_b16 v[164:165], v9 offset:57344
ds_read_b64_tr_b16 v[166:167], v9 offset:59392
v_mfma_f32_16x16x32_bf16 v[84:87], v[196:199], a[128:131], v[84:87]
s_add_u32 s72, s71, 30720
buffer_load_dwordx4 v15, s[24:27], s72 offen offset:2048 lds
v_mfma_f32_16x16x32_bf16 v[88:91], v[200:203], a[128:131], v[88:91]
v_xor_b32 v12, v113, v112
v_lshlrev_b32 v12, 4, v12
v_mfma_f32_16x16x32_bf16 v[88:91], v[216:219], a[132:135], v[88:91]
s_nop 0
ds_read_b64_tr_b16 v[168:169], v10 offset:57344
ds_read_b64_tr_b16 v[170:171], v10 offset:59392
v_mfma_f32_16x16x32_bf16 v[88:91], v[232:235], a[136:139], v[88:91]
s_nop 0
ds_read_b64_tr_b16 v[172:173], v11 offset:57344
ds_read_b64_tr_b16 v[174:175], v11 offset:59392
v_mfma_f32_16x16x32_bf16 v[88:91], v[248:251], a[140:143], v[88:91]
buffer_load_dwordx4 a[244:247], v1, s[44:47], s69 offen offset:1024 sc1
v_mfma_f32_16x16x32_bf16 v[104:107], v[248:251], a[156:159], v[104:107]
s_nop 0
ds_read_b64_tr_b16 v[176:177], v8 offset:61440
ds_read_b64_tr_b16 v[178:179], v8 offset:63488
v_mfma_f32_16x16x32_bf16 v[104:107], v[232:235], a[152:155], v[104:107]
v_lshl_add_u32 v112, v112, 12, v12
v_xor_b32 v12, 64, v112
v_mfma_f32_16x16x32_bf16 v[104:107], v[216:219], a[148:151], v[104:107]
s_nop 0
ds_read_b64_tr_b16 v[180:181], v9 offset:61440
ds_read_b64_tr_b16 v[182:183], v9 offset:63488
v_mfma_f32_16x16x32_bf16 v[104:107], v[200:203], a[144:147], v[104:107]
s_add_u32 s72, s71, 46080
buffer_load_dwordx4 v15, s[24:27], s72 offen offset:3072 lds
v_mfma_f32_16x16x32_bf16 v[108:111], v[204:207], a[144:147], v[108:111]
s_nop 0
ds_read_b64_tr_b16 v[184:185], v10 offset:61440
ds_read_b64_tr_b16 v[186:187], v10 offset:63488
v_mfma_f32_16x16x32_bf16 v[108:111], v[220:223], a[148:151], v[108:111]
s_nop 0
ds_read_b64_tr_b16 v[188:189], v11 offset:61440
ds_read_b64_tr_b16 v[190:191], v11 offset:63488
v_mfma_f32_16x16x32_bf16 v[108:111], v[236:239], a[152:155], v[108:111]
v_lshlrev_b32 v113, 2, v113
v_mfma_f32_16x16x32_bf16 v[108:111], v[252:255], a[156:159], v[108:111]
s_xor_b32 s71, s15, 0x40100
buffer_load_dwordx4 a[248:251], v1, s[44:47], s69 offen offset:2048 sc1
v_mfma_f32_16x16x32_bf16 v[92:95], v[252:255], a[140:143], v[92:95]
s_add_u32 m0, s85, 0
v_xor_b32 v8, 0x10000, v8
v_mfma_f32_16x16x32_bf16 v[92:95], v[236:239], a[136:139], v[92:95]
s_add_u32 s72, s71, 0
v_xor_b32 v9, 0x10000, v9
v_mfma_f32_16x16x32_bf16 v[92:95], v[220:223], a[132:135], v[92:95]
s_waitcnt vmcnt(36) lgkmcnt(0)
v_xor_b32 v10, 0x10000, v10
v_mfma_f32_16x16x32_bf16 v[92:95], v[204:207], a[128:131], v[92:95]
s_nop 0
buffer_load_dwordx4 v15, s[24:27], s72 offen lds
v_xor_b32 v11, 0x10000, v11
v_mfma_f32_16x16x32_bf16 v[16:19], v[128:131], a[160:163], v[16:19]
s_nop 0
ds_read_b64_tr_b16 v[192:193], v8 offset:0
ds_read_b64_tr_b16 v[194:195], v8 offset:2048
v_mfma_f32_16x16x32_bf16 v[16:19], v[144:147], a[164:167], v[16:19]
s_nop 0
ds_read_b64_tr_b16 v[196:197], v9 offset:0
ds_read_b64_tr_b16 v[198:199], v9 offset:2048
v_mfma_f32_16x16x32_bf16 v[16:19], v[160:163], a[168:171], v[16:19]
s_nop 0
ds_read_b64_tr_b16 v[200:201], v10 offset:0
ds_read_b64_tr_b16 v[202:203], v10 offset:2048
v_mfma_f32_16x16x32_bf16 v[16:19], v[176:179], a[172:175], v[16:19]
v_mfma_f32_16x16x32_bf16 v[32:35], v[176:179], a[188:191], v[32:35]
buffer_load_dwordx4 a[252:255], v1, s[44:47], s69 offen offset:3072 sc1
v_mfma_f32_16x16x32_bf16 v[32:35], v[160:163], a[184:187], v[32:35]
s_nop 0
ds_read_b64_tr_b16 v[204:205], v11 offset:0
ds_read_b64_tr_b16 v[206:207], v11 offset:2048
v_mfma_f32_16x16x32_bf16 v[32:35], v[144:147], a[180:183], v[32:35]
s_nop 0
ds_read_b64_tr_b16 v[208:209], v8 offset:4096
ds_read_b64_tr_b16 v[210:211], v8 offset:6144
v_mfma_f32_16x16x32_bf16 v[32:35], v[128:131], a[176:179], v[32:35]
v_mfma_f32_16x16x32_bf16 v[36:39], v[132:135], a[176:179], v[36:39]
s_add_u32 s72, s71, 15360
buffer_load_dwordx4 v15, s[24:27], s72 offen offset:1024 lds
v_mfma_f32_16x16x32_bf16 v[36:39], v[148:151], a[180:183], v[36:39]
s_nop 0
ds_read_b64_tr_b16 v[212:213], v9 offset:4096
ds_read_b64_tr_b16 v[214:215], v9 offset:6144
v_mfma_f32_16x16x32_bf16 v[36:39], v[164:167], a[184:187], v[36:39]
s_nop 0
ds_read_b64_tr_b16 v[216:217], v10 offset:4096
ds_read_b64_tr_b16 v[218:219], v10 offset:6144
v_mfma_f32_16x16x32_bf16 v[36:39], v[180:183], a[188:191], v[36:39]
v_mfma_f32_16x16x32_bf16 v[20:23], v[180:183], a[172:175], v[20:23]
s_nop 0
ds_read_b64_tr_b16 v[220:221], v11 offset:4096
ds_read_b64_tr_b16 v[222:223], v11 offset:6144
v_mfma_f32_16x16x32_bf16 v[20:23], v[164:167], a[168:171], v[20:23]
s_add_u32 s72, s71, 30720
buffer_load_dwordx4 v15, s[24:27], s72 offen offset:2048 lds
v_mfma_f32_16x16x32_bf16 v[20:23], v[148:151], a[164:167], v[20:23]
s_nop 0
ds_read_b64_tr_b16 v[224:225], v8 offset:8192
ds_read_b64_tr_b16 v[226:227], v8 offset:10240
v_mfma_f32_16x16x32_bf16 v[20:23], v[132:135], a[160:163], v[20:23]
s_nop 0
ds_read_b64_tr_b16 v[228:229], v9 offset:8192
ds_read_b64_tr_b16 v[230:231], v9 offset:10240
v_mfma_f32_16x16x32_bf16 v[24:27], v[136:139], a[160:163], v[24:27]
v_mfma_f32_16x16x32_bf16 v[24:27], v[152:155], a[164:167], v[24:27]
s_nop 0
ds_read_b64_tr_b16 v[232:233], v10 offset:8192
ds_read_b64_tr_b16 v[234:235], v10 offset:10240
v_mfma_f32_16x16x32_bf16 v[24:27], v[168:171], a[168:171], v[24:27]
s_nop 0
ds_read_b64_tr_b16 v[236:237], v11 offset:8192
ds_read_b64_tr_b16 v[238:239], v11 offset:10240
v_mfma_f32_16x16x32_bf16 v[24:27], v[184:187], a[172:175], v[24:27]
v_mfma_f32_16x16x32_bf16 v[40:43], v[184:187], a[188:191], v[40:43]
s_add_u32 s72, s71, 46080
buffer_load_dwordx4 v15, s[24:27], s72 offen offset:3072 lds
v_mfma_f32_16x16x32_bf16 v[40:43], v[168:171], a[184:187], v[40:43]
s_nop 0
ds_read_b64_tr_b16 v[240:241], v8 offset:12288
ds_read_b64_tr_b16 v[242:243], v8 offset:14336
v_mfma_f32_16x16x32_bf16 v[40:43], v[152:155], a[180:183], v[40:43]
s_nop 0
ds_read_b64_tr_b16 v[244:245], v9 offset:12288
ds_read_b64_tr_b16 v[246:247], v9 offset:14336
v_mfma_f32_16x16x32_bf16 v[40:43], v[136:139], a[176:179], v[40:43]
v_mfma_f32_16x16x32_bf16 v[44:47], v[140:143], a[176:179], v[44:47]
s_nop 0
ds_read_b64_tr_b16 v[248:249], v10 offset:12288
ds_read_b64_tr_b16 v[250:251], v10 offset:14336
v_mfma_f32_16x16x32_bf16 v[44:47], v[156:159], a[180:183], v[44:47]
s_nop 0
ds_read_b64_tr_b16 v[252:253], v11 offset:12288
ds_read_b64_tr_b16 v[254:255], v11 offset:14336
v_mfma_f32_16x16x32_bf16 v[44:47], v[172:175], a[184:187], v[44:47]
s_xor_b32 s71, s13, 0x40180
v_mfma_f32_16x16x32_bf16 v[44:47], v[188:191], a[188:191], v[44:47]
s_add_u32 m0, s85, 16384
v_mfma_f32_16x16x32_bf16 v[28:31], v[188:191], a[172:175], v[28:31]
s_add_u32 s72, s71, 0
buffer_load_dwordx4 v15, s[24:27], s72 offen lds
v_mfma_f32_16x16x32_bf16 v[28:31], v[172:175], a[168:171], v[28:31]
v_mfma_f32_16x16x32_bf16 v[28:31], v[156:159], a[164:167], v[28:31]
s_waitcnt vmcnt(14) lgkmcnt(0)
v_mfma_f32_16x16x32_bf16 v[28:31], v[140:143], a[160:163], v[28:31]
s_barrier
v_mfma_f32_16x16x32_bf16 v[16:19], v[192:195], a[192:195], v[16:19]
s_nop 0
ds_read_b64_tr_b16 v[128:129], v8 offset:16384
ds_read_b64_tr_b16 v[130:131], v8 offset:18432
v_mfma_f32_16x16x32_bf16 v[16:19], v[208:211], a[196:199], v[16:19]
s_nop 0
ds_read_b64_tr_b16 v[132:133], v9 offset:16384
ds_read_b64_tr_b16 v[134:135], v9 offset:18432
v_mfma_f32_16x16x32_bf16 v[16:19], v[224:227], a[200:203], v[16:19]
s_nop 0
ds_read_b64_tr_b16 v[136:137], v10 offset:16384
ds_read_b64_tr_b16 v[138:139], v10 offset:18432
v_mfma_f32_16x16x32_bf16 v[16:19], v[240:243], a[204:207], v[16:19]
s_add_u32 s72, s71, 15360
buffer_load_dwordx4 v15, s[24:27], s72 offen offset:1024 lds
v_mfma_f32_16x16x32_bf16 v[32:35], v[240:243], a[220:223], v[32:35]
v_mfma_f32_16x16x32_bf16 v[32:35], v[224:227], a[216:219], v[32:35]
s_nop 0
ds_read_b64_tr_b16 v[140:141], v11 offset:16384
ds_read_b64_tr_b16 v[142:143], v11 offset:18432
v_mfma_f32_16x16x32_bf16 v[32:35], v[208:211], a[212:215], v[32:35]
s_nop 0
ds_read_b64_tr_b16 v[144:145], v8 offset:20480
ds_read_b64_tr_b16 v[146:147], v8 offset:22528
v_mfma_f32_16x16x32_bf16 v[32:35], v[192:195], a[208:211], v[32:35]
v_mfma_f32_16x16x32_bf16 v[36:39], v[196:199], a[208:211], v[36:39]
s_nop 0
ds_read_b64_tr_b16 v[148:149], v9 offset:20480
ds_read_b64_tr_b16 v[150:151], v9 offset:22528
v_mfma_f32_16x16x32_bf16 v[36:39], v[212:215], a[212:215], v[36:39]
s_nop 0
ds_read_b64_tr_b16 v[152:153], v10 offset:20480
ds_read_b64_tr_b16 v[154:155], v10 offset:22528
v_mfma_f32_16x16x32_bf16 v[36:39], v[228:231], a[216:219], v[36:39]
s_add_u32 s72, s71, 30720
buffer_load_dwordx4 v15, s[24:27], s72 offen offset:2048 lds
v_mfma_f32_16x16x32_bf16 v[36:39], v[244:247], a[220:223], v[36:39]
v_mfma_f32_16x16x32_bf16 v[20:23], v[244:247], a[204:207], v[20:23]
s_nop 0
ds_read_b64_tr_b16 v[156:157], v11 offset:20480
ds_read_b64_tr_b16 v[158:159], v11 offset:22528
v_mfma_f32_16x16x32_bf16 v[20:23], v[228:231], a[200:203], v[20:23]
s_nop 0
ds_read_b64_tr_b16 v[160:161], v8 offset:24576
ds_read_b64_tr_b16 v[162:163], v8 offset:26624
v_mfma_f32_16x16x32_bf16 v[20:23], v[212:215], a[196:199], v[20:23]
s_nop 0
ds_read_b64_tr_b16 v[164:165], v9 offset:24576
ds_read_b64_tr_b16 v[166:167], v9 offset:26624
v_mfma_f32_16x16x32_bf16 v[20:23], v[196:199], a[192:195], v[20:23]
v_mfma_f32_16x16x32_bf16 v[24:27], v[200:203], a[192:195], v[24:27]
s_nop 0
ds_read_b64_tr_b16 v[168:169], v10 offset:24576
ds_read_b64_tr_b16 v[170:171], v10 offset:26624
v_mfma_f32_16x16x32_bf16 v[24:27], v[216:219], a[196:199], v[24:27]
s_add_u32 s72, s71, 46080
buffer_load_dwordx4 v15, s[24:27], s72 offen offset:3072 lds
v_mfma_f32_16x16x32_bf16 v[24:27], v[232:235], a[200:203], v[24:27]
s_nop 0
ds_read_b64_tr_b16 v[172:173], v11 offset:24576
ds_read_b64_tr_b16 v[174:175], v11 offset:26624
v_mfma_f32_16x16x32_bf16 v[24:27], v[248:251], a[204:207], v[24:27]
v_mfma_f32_16x16x32_bf16 v[40:43], v[248:251], a[220:223], v[40:43]
s_nop 0
ds_read_b64_tr_b16 v[176:177], v8 offset:28672
ds_read_b64_tr_b16 v[178:179], v8 offset:30720
v_mfma_f32_16x16x32_bf16 v[40:43], v[232:235], a[216:219], v[40:43]
s_nop 0
ds_read_b64_tr_b16 v[180:181], v9 offset:28672
ds_read_b64_tr_b16 v[182:183], v9 offset:30720
v_mfma_f32_16x16x32_bf16 v[40:43], v[216:219], a[212:215], v[40:43]
v_mfma_f32_16x16x32_bf16 v[40:43], v[200:203], a[208:211], v[40:43]
s_nop 0
ds_read_b64_tr_b16 v[184:185], v10 offset:28672
ds_read_b64_tr_b16 v[186:187], v10 offset:30720
v_mfma_f32_16x16x32_bf16 v[44:47], v[204:207], a[208:211], v[44:47]
s_add_u32 m0, s64, 147456
ds_read_b64_tr_b16 v[188:189], v11 offset:28672
ds_read_b64_tr_b16 v[190:191], v11 offset:30720
v_mfma_f32_16x16x32_bf16 v[44:47], v[220:223], a[212:215], v[44:47]
s_add_u32 s72, s73, 0
buffer_load_dwordx4 v112, s[44:47], s72 offen sc1 lds
v_mfma_f32_16x16x32_bf16 v[44:47], v[236:239], a[216:219], v[44:47]
v_mfma_f32_16x16x32_bf16 v[44:47], v[252:255], a[220:223], v[44:47]
v_mfma_f32_16x16x32_bf16 v[28:31], v[252:255], a[204:207], v[28:31]
v_mfma_f32_16x16x32_bf16 v[28:31], v[236:239], a[200:203], v[28:31]
s_add_u32 s72, s73, 15360
buffer_load_dwordx4 v12, s[44:47], s72 offen offset:1024 sc1 lds
v_mfma_f32_16x16x32_bf16 v[28:31], v[220:223], a[196:199], v[28:31]
s_waitcnt vmcnt(9) lgkmcnt(0)
v_mfma_f32_16x16x32_bf16 v[28:31], v[204:207], a[192:195], v[28:31]
v_mfma_f32_16x16x32_bf16 v[16:19], v[128:131], a[224:227], v[16:19]
s_nop 0
ds_read_b64_tr_b16 v[192:193], v8 offset:32768
ds_read_b64_tr_b16 v[194:195], v8 offset:34816
v_mfma_f32_16x16x32_bf16 v[16:19], v[144:147], a[228:231], v[16:19]
s_add_u32 s72, s73, 30720
buffer_load_dwordx4 v112, s[44:47], s72 offen offset:2048 sc1 lds
v_mfma_f32_16x16x32_bf16 v[16:19], v[160:163], a[232:235], v[16:19]
s_nop 0
ds_read_b64_tr_b16 v[196:197], v9 offset:32768
ds_read_b64_tr_b16 v[198:199], v9 offset:34816
v_mfma_f32_16x16x32_bf16 v[16:19], v[176:179], a[236:239], v[16:19]
s_nop 0
ds_read_b64_tr_b16 v[200:201], v10 offset:32768
ds_read_b64_tr_b16 v[202:203], v10 offset:34816
v_mfma_f32_16x16x32_bf16 v[20:23], v[180:183], a[236:239], v[20:23]
s_nop 0
ds_read_b64_tr_b16 v[204:205], v11 offset:32768
Lstube2:
s_cbranch_execz Lrete
ds_read_b64_tr_b16 v[206:207], v11 offset:34816
v_mfma_f32_16x16x32_bf16 v[20:23], v[164:167], a[232:235], v[20:23]
s_add_u32 s72, s73, 46080
buffer_load_dwordx4 v12, s[44:47], s72 offen offset:3072 sc1 lds
v_mfma_f32_16x16x32_bf16 v[20:23], v[148:151], a[228:231], v[20:23]
s_lshl_b32 s73, s75, 9
ds_read_b64_tr_b16 v[208:209], v8 offset:36864
ds_read_b64_tr_b16 v[210:211], v8 offset:38912
v_mfma_f32_16x16x32_bf16 v[20:23], v[132:135], a[224:227], v[20:23]
s_xor_b32 s71, s14, 0x40180
ds_read_b64_tr_b16 v[212:213], v9 offset:36864
ds_read_b64_tr_b16 v[214:215], v9 offset:38912
v_mfma_f32_16x16x32_bf16 v[24:27], v[136:139], a[224:227], v[24:27]
s_add_u32 m0, s85, 32768
v_mfma_f32_16x16x32_bf16 v[24:27], v[152:155], a[228:231], v[24:27]
s_add_u32 s72, s71, 0
buffer_load_dwordx4 v15, s[24:27], s72 offen lds
v_mfma_f32_16x16x32_bf16 v[24:27], v[168:171], a[232:235], v[24:27]
s_lshl_b32 s84, s58, 7
ds_read_b64_tr_b16 v[216:217], v10 offset:36864
ds_read_b64_tr_b16 v[218:219], v10 offset:38912
v_mfma_f32_16x16x32_bf16 v[24:27], v[184:187], a[236:239], v[24:27]
s_add_u32 s73, s73, s84
ds_read_b64_tr_b16 v[220:221], v11 offset:36864
ds_read_b64_tr_b16 v[222:223], v11 offset:38912
v_cvt_pk_bf16_f32 v16, v16, v17
v_mfma_f32_16x16x32_bf16 v[28:31], v[188:191], a[236:239], v[28:31]
s_add_u32 s73, s73, 0x3800000
ds_read_b64_tr_b16 v[224:225], v8 offset:40960
ds_read_b64_tr_b16 v[226:227], v8 offset:43008
v_cvt_pk_bf16_f32 v17, v18, v19
v_mfma_f32_16x16x32_bf16 v[28:31], v[172:175], a[232:235], v[28:31]
s_add_u32 s72, s71, 15360
buffer_load_dwordx4 v15, s[24:27], s72 offen offset:1024 lds
v_cvt_pk_bf16_f32 v18, v20, v21
v_mfma_f32_16x16x32_bf16 v[28:31], v[156:159], a[228:231], v[28:31]
s_nop 0
ds_read_b64_tr_b16 v[228:229], v9 offset:40960
ds_read_b64_tr_b16 v[230:231], v9 offset:43008
v_cvt_pk_bf16_f32 v19, v22, v23
v_mfma_f32_16x16x32_bf16 v[28:31], v[140:143], a[224:227], v[28:31]
s_nop 0
ds_read_b64_tr_b16 v[232:233], v10 offset:40960
ds_read_b64_tr_b16 v[234:235], v10 offset:43008
v_mfma_f32_16x16x32_bf16 v[32:35], v[128:131], a[240:243], v[32:35]
s_xor_b32 s80, s93, 0x100000
buffer_load_dword v6, v113, s[44:47], s73 offen sc1
v_mfma_f32_16x16x32_bf16 v[32:35], v[144:147], a[244:247], v[32:35]
s_add_u32 s72, s71, 30720
buffer_load_dwordx4 v15, s[24:27], s72 offen offset:2048 lds
v_mfma_f32_16x16x32_bf16 v[32:35], v[160:163], a[248:251], v[32:35]
s_add_u32 s80, s80, 0x3a00000
buffer_store_dwordx4 v[16:19], v1, s[44:47], s80 offen sc1
v_mfma_f32_16x16x32_bf16 v[32:35], v[176:179], a[252:255], v[32:35]
s_nop 0
ds_read_b64_tr_b16 v[236:237], v11 offset:40960
ds_read_b64_tr_b16 v[238:239], v11 offset:43008
v_cvt_pk_bf16_f32 v20, v24, v25
v_mfma_f32_16x16x32_bf16 v[36:39], v[180:183], a[252:255], v[36:39]
s_nop 0
ds_read_b64_tr_b16 v[240:241], v8 offset:45056
ds_read_b64_tr_b16 v[242:243], v8 offset:47104
v_cvt_pk_bf16_f32 v21, v26, v27
v_mfma_f32_16x16x32_bf16 v[36:39], v[164:167], a[248:251], v[36:39]
s_add_u32 s72, s71, 46080
buffer_load_dwordx4 v15, s[24:27], s72 offen offset:3072 lds
v_cvt_pk_bf16_f32 v22, v28, v29
v_mfma_f32_16x16x32_bf16 v[36:39], v[148:151], a[244:247], v[36:39]
s_nop 0
ds_read_b64_tr_b16 v[244:245], v9 offset:45056
ds_read_b64_tr_b16 v[246:247], v9 offset:47104
v_cvt_pk_bf16_f32 v23, v30, v31
v_mfma_f32_16x16x32_bf16 v[36:39], v[132:135], a[240:243], v[36:39]
s_xor_b32 s71, s15, 0x40180
ds_read_b64_tr_b16 v[248:249], v10 offset:45056
ds_read_b64_tr_b16 v[250:251], v10 offset:47104
v_mfma_f32_16x16x32_bf16 v[40:43], v[136:139], a[240:243], v[40:43]
s_add_u32 m0, s85, 49152
ds_read_b64_tr_b16 v[252:253], v11 offset:45056
ds_read_b64_tr_b16 v[254:255], v11 offset:47104
v_mfma_f32_16x16x32_bf16 v[40:43], v[152:155], a[244:247], v[40:43]
s_add_u32 s72, s71, 0
buffer_load_dwordx4 v15, s[24:27], s72 offen lds
v_mfma_f32_16x16x32_bf16 v[40:43], v[168:171], a[248:251], v[40:43]
buffer_load_dword v7, v113, s[44:47], s73 offen offset:64 sc1
v_mfma_f32_16x16x32_bf16 v[40:43], v[184:187], a[252:255], v[40:43]
v_cvt_pk_bf16_f32 v24, v32, v33
v_cvt_pk_bf16_f32 v25, v34, v35
v_cvt_pk_bf16_f32 v26, v36, v37
v_mfma_f32_16x16x32_bf16 v[44:47], v[188:191], a[252:255], v[44:47]
v_cvt_pk_bf16_f32 v27, v38, v39
v_mfma_f32_16x16x32_bf16 v[44:47], v[172:175], a[248:251], v[44:47]
s_add_u32 s72, s71, 15360
v_mfma_f32_16x16x32_bf16 v[44:47], v[156:159], a[244:247], v[44:47]
s_waitcnt vmcnt(16) lgkmcnt(0)
buffer_load_dwordx4 v15, s[24:27], s72 offen offset:1024 lds
v_mfma_f32_16x16x32_bf16 v[44:47], v[140:143], a[240:243], v[44:47]
s_barrier
v_mfma_f32_16x16x32_bf16 v[48:51], v[192:195], a[160:163], v[48:51]
s_nop 0
ds_read_b64_tr_b16 v[128:129], v8 offset:49152
ds_read_b64_tr_b16 v[130:131], v8 offset:51200
v_mfma_f32_16x16x32_bf16 v[48:51], v[208:211], a[164:167], v[48:51]
s_nop 0
ds_read_b64_tr_b16 v[132:133], v9 offset:49152
ds_read_b64_tr_b16 v[134:135], v9 offset:51200
v_mfma_f32_16x16x32_bf16 v[48:51], v[224:227], a[168:171], v[48:51]
buffer_store_dwordx4 v[20:23], v1, s[44:47], s80 offen offset:1024 sc1
v_mfma_f32_16x16x32_bf16 v[48:51], v[240:243], a[172:175], v[48:51]
s_nop 0
ds_read_b64_tr_b16 v[136:137], v10 offset:49152
ds_read_b64_tr_b16 v[138:139], v10 offset:51200
v_cvt_pk_bf16_f32 v28, v40, v41
v_mfma_f32_16x16x32_bf16 v[64:67], v[240:243], a[188:191], v[64:67]
v_cvt_pk_bf16_f32 v29, v42, v43
v_cvt_pk_bf16_f32 v30, v44, v45
v_cvt_pk_bf16_f32 v31, v46, v47
v_mfma_f32_16x16x32_bf16 v[64:67], v[224:227], a[184:187], v[64:67]
s_nop 0
ds_read_b64_tr_b16 v[140:141], v11 offset:49152
ds_read_b64_tr_b16 v[142:143], v11 offset:51200
v_mfma_f32_16x16x32_bf16 v[64:67], v[208:211], a[180:183], v[64:67]
s_add_u32 s72, s71, 30720
buffer_load_dwordx4 v15, s[24:27], s72 offen offset:2048 lds
v_mfma_f32_16x16x32_bf16 v[64:67], v[192:195], a[176:179], v[64:67]
s_nop 0
ds_read_b64_tr_b16 v[144:145], v8 offset:53248
ds_read_b64_tr_b16 v[146:147], v8 offset:55296
v_mfma_f32_16x16x32_bf16 v[68:71], v[196:199], a[176:179], v[68:71]
s_nop 0
ds_read_b64_tr_b16 v[148:149], v9 offset:53248
ds_read_b64_tr_b16 v[150:151], v9 offset:55296
v_mfma_f32_16x16x32_bf16 v[68:71], v[212:215], a[180:183], v[68:71]
v_mfma_f32_16x16x32_bf16 v[68:71], v[228:231], a[184:187], v[68:71]
s_nop 0
ds_read_b64_tr_b16 v[152:153], v10 offset:53248
ds_read_b64_tr_b16 v[154:155], v10 offset:55296
v_mfma_f32_16x16x32_bf16 v[68:71], v[244:247], a[188:191], v[68:71]
s_nop 0
ds_read_b64_tr_b16 v[156:157], v11 offset:53248
ds_read_b64_tr_b16 v[158:159], v11 offset:55296
v_mfma_f32_16x16x32_bf16 v[52:55], v[244:247], a[172:175], v[52:55]
v_mfma_f32_16x16x32_bf16 v[52:55], v[228:231], a[168:171], v[52:55]
s_add_u32 s72, s71, 46080
buffer_load_dwordx4 v15, s[24:27], s72 offen offset:3072 lds
v_mfma_f32_16x16x32_bf16 v[52:55], v[212:215], a[164:167], v[52:55]
s_nop 0
ds_read_b64_tr_b16 v[160:161], v8 offset:57344
ds_read_b64_tr_b16 v[162:163], v8 offset:59392
v_mfma_f32_16x16x32_bf16 v[52:55], v[196:199], a[160:163], v[52:55]
s_nop 0
ds_read_b64_tr_b16 v[164:165], v9 offset:57344
ds_read_b64_tr_b16 v[166:167], v9 offset:59392
v_mfma_f32_16x16x32_bf16 v[56:59], v[200:203], a[160:163], v[56:59]
s_nop 0
ds_read_b64_tr_b16 v[168:169], v10 offset:57344
ds_read_b64_tr_b16 v[170:171], v10 offset:59392
v_mfma_f32_16x16x32_bf16 v[56:59], v[216:219], a[164:167], v[56:59]
v_mfma_f32_16x16x32_bf16 v[56:59], v[232:235], a[168:171], v[56:59]
buffer_store_dwordx4 v[24:27], v1, s[44:47], s80 offen offset:2048 sc1
v_mfma_f32_16x16x32_bf16 v[56:59], v[248:251], a[172:175], v[56:59]
s_xor_b32 s71, s12, 0x0
ds_read_b64_tr_b16 v[172:173], v11 offset:57344
ds_read_b64_tr_b16 v[174:175], v11 offset:59392
v_mfma_f32_16x16x32_bf16 v[72:75], v[248:251], a[188:191], v[72:75]
s_add_u32 m0, s77, 0
ds_read_b64_tr_b16 v[176:177], v8 offset:61440
ds_read_b64_tr_b16 v[178:179], v8 offset:63488
v_mfma_f32_16x16x32_bf16 v[72:75], v[232:235], a[184:187], v[72:75]
s_add_u32 s72, s71, 0
buffer_load_dwordx4 v15, s[24:27], s72 offen lds
v_mfma_f32_16x16x32_bf16 v[72:75], v[216:219], a[180:183], v[72:75]
s_nop 0
ds_read_b64_tr_b16 v[180:181], v9 offset:61440
ds_read_b64_tr_b16 v[182:183], v9 offset:63488
v_mfma_f32_16x16x32_bf16 v[72:75], v[200:203], a[176:179], v[72:75]
v_mfma_f32_16x16x32_bf16 v[76:79], v[204:207], a[176:179], v[76:79]
s_nop 0
ds_read_b64_tr_b16 v[184:185], v10 offset:61440
ds_read_b64_tr_b16 v[186:187], v10 offset:63488
v_mfma_f32_16x16x32_bf16 v[76:79], v[220:223], a[180:183], v[76:79]
s_nop 0
ds_read_b64_tr_b16 v[188:189], v11 offset:61440
ds_read_b64_tr_b16 v[190:191], v11 offset:63488
v_mfma_f32_16x16x32_bf16 v[76:79], v[236:239], a[184:187], v[76:79]
v_mfma_f32_16x16x32_bf16 v[76:79], v[252:255], a[188:191], v[76:79]
v_mfma_f32_16x16x32_bf16 v[60:63], v[252:255], a[172:175], v[60:63]
s_add_u32 s72, s71, 15360
buffer_load_dwordx4 v15, s[24:27], s72 offen offset:1024 lds
v_xor_b32 v8, 0x10000, v8
v_mfma_f32_16x16x32_bf16 v[60:63], v[236:239], a[168:171], v[60:63]
v_xor_b32 v9, 0x10000, v9
v_mfma_f32_16x16x32_bf16 v[60:63], v[220:223], a[164:167], v[60:63]
s_waitcnt lgkmcnt(0)
v_xor_b32 v10, 0x10000, v10
v_mfma_f32_16x16x32_bf16 v[60:63], v[204:207], a[160:163], v[60:63]
v_xor_b32 v11, 0x10000, v11
v_mfma_f32_16x16x32_bf16 v[48:51], v[128:131], a[192:195], v[48:51]
s_nop 0
ds_read_b64_tr_b16 v[192:193], v8 offset:0
ds_read_b64_tr_b16 v[194:195], v8 offset:2048
v_mfma_f32_16x16x32_bf16 v[48:51], v[144:147], a[196:199], v[48:51]
s_nop 0
ds_read_b64_tr_b16 v[196:197], v9 offset:0
ds_read_b64_tr_b16 v[198:199], v9 offset:2048
v_mfma_f32_16x16x32_bf16 v[48:51], v[160:163], a[200:203], v[48:51]
s_nop 0
ds_read_b64_tr_b16 v[200:201], v10 offset:0
ds_read_b64_tr_b16 v[202:203], v10 offset:2048
v_mfma_f32_16x16x32_bf16 v[48:51], v[176:179], a[204:207], v[48:51]
v_mfma_f32_16x16x32_bf16 v[64:67], v[176:179], a[220:223], v[64:67]
s_add_u32 s72, s71, 30720
buffer_load_dwordx4 v15, s[24:27], s72 offen offset:2048 lds
v_mfma_f32_16x16x32_bf16 v[64:67], v[160:163], a[216:219], v[64:67]
s_nop 0
ds_read_b64_tr_b16 v[204:205], v11 offset:0
ds_read_b64_tr_b16 v[206:207], v11 offset:2048
v_mfma_f32_16x16x32_bf16 v[64:67], v[144:147], a[212:215], v[64:67]
s_nop 0
ds_read_b64_tr_b16 v[208:209], v8 offset:4096
ds_read_b64_tr_b16 v[210:211], v8 offset:6144
v_mfma_f32_16x16x32_bf16 v[64:67], v[128:131], a[208:211], v[64:67]
buffer_store_dwordx4 v[28:31], v1, s[44:47], s80 offen offset:3072 sc1
v_mfma_f32_16x16x32_bf16 v[68:71], v[132:135], a[208:211], v[68:71]
s_nop 0
ds_read_b64_tr_b16 v[212:213], v9 offset:4096
ds_read_b64_tr_b16 v[214:215], v9 offset:6144
v_mfma_f32_16x16x32_bf16 v[68:71], v[148:151], a[212:215], v[68:71]
v_mfma_f32_16x16x32_bf16 v[68:71], v[164:167], a[216:219], v[68:71]
s_nop 0
ds_read_b64_tr_b16 v[216:217], v10 offset:4096
ds_read_b64_tr_b16 v[218:219], v10 offset:6144
v_mfma_f32_16x16x32_bf16 v[68:71], v[180:183], a[220:223], v[68:71]
s_add_u32 s72, s71, 46080
buffer_load_dwordx4 v15, s[24:27], s72 offen offset:3072 lds
v_mfma_f32_16x16x32_bf16 v[52:55], v[180:183], a[204:207], v[52:55]
s_nop 0
ds_read_b64_tr_b16 v[220:221], v11 offset:4096
ds_read_b64_tr_b16 v[222:223], v11 offset:6144
v_mfma_f32_16x16x32_bf16 v[52:55], v[164:167], a[200:203], v[52:55]
v_mfma_f32_16x16x32_bf16 v[52:55], v[148:151], a[196:199], v[52:55]
s_nop 0
ds_read_b64_tr_b16 v[224:225], v8 offset:8192
ds_read_b64_tr_b16 v[226:227], v8 offset:10240
v_mfma_f32_16x16x32_bf16 v[52:55], v[132:135], a[192:195], v[52:55]
s_nop 0
ds_read_b64_tr_b16 v[228:229], v9 offset:8192
ds_read_b64_tr_b16 v[230:231], v9 offset:10240
v_mfma_f32_16x16x32_bf16 v[56:59], v[136:139], a[192:195], v[56:59]
s_nop 0
ds_read_b64_tr_b16 v[232:233], v10 offset:8192
ds_read_b64_tr_b16 v[234:235], v10 offset:10240
v_mfma_f32_16x16x32_bf16 v[56:59], v[152:155], a[196:199], v[56:59]
s_xor_b32 s71, s13, 0x0
v_mfma_f32_16x16x32_bf16 v[56:59], v[168:171], a[200:203], v[56:59]
s_add_u32 m0, s77, 16384
ds_read_b64_tr_b16 v[236:237], v11 offset:8192
ds_read_b64_tr_b16 v[238:239], v11 offset:10240
v_mfma_f32_16x16x32_bf16 v[56:59], v[184:187], a[204:207], v[56:59]
s_add_u32 s72, s71, 0
buffer_load_dwordx4 v15, s[24:27], s72 offen lds
v_mfma_f32_16x16x32_bf16 v[72:75], v[184:187], a[220:223], v[72:75]
s_nop 0
ds_read_b64_tr_b16 v[240:241], v8 offset:12288
ds_read_b64_tr_b16 v[242:243], v8 offset:14336
v_mfma_f32_16x16x32_bf16 v[72:75], v[168:171], a[216:219], v[72:75]
s_nop 0
ds_read_b64_tr_b16 v[244:245], v9 offset:12288
ds_read_b64_tr_b16 v[246:247], v9 offset:14336
v_mfma_f32_16x16x32_bf16 v[72:75], v[152:155], a[212:215], v[72:75]
v_mfma_f32_16x16x32_bf16 v[72:75], v[136:139], a[208:211], v[72:75]
s_nop 0
ds_read_b64_tr_b16 v[248:249], v10 offset:12288
ds_read_b64_tr_b16 v[250:251], v10 offset:14336
v_mfma_f32_16x16x32_bf16 v[76:79], v[140:143], a[208:211], v[76:79]
s_nop 0
ds_read_b64_tr_b16 v[252:253], v11 offset:12288
ds_read_b64_tr_b16 v[254:255], v11 offset:14336
v_mfma_f32_16x16x32_bf16 v[76:79], v[156:159], a[212:215], v[76:79]
v_mfma_f32_16x16x32_bf16 v[76:79], v[172:175], a[216:219], v[76:79]
s_add_u32 s72, s71, 15360
buffer_load_dwordx4 v15, s[24:27], s72 offen offset:1024 lds
v_mfma_f32_16x16x32_bf16 v[76:79], v[188:191], a[220:223], v[76:79]
v_mfma_f32_16x16x32_bf16 v[60:63], v[188:191], a[204:207], v[60:63]
v_mfma_f32_16x16x32_bf16 v[60:63], v[172:175], a[200:203], v[60:63]
v_mfma_f32_16x16x32_bf16 v[60:63], v[156:159], a[196:199], v[60:63]
s_waitcnt vmcnt(14) lgkmcnt(0)
v_mfma_f32_16x16x32_bf16 v[60:63], v[140:143], a[192:195], v[60:63]
s_barrier
v_mfma_f32_16x16x32_bf16 v[48:51], v[192:195], a[224:227], v[48:51]
s_nop 0
ds_read_b64_tr_b16 v[128:129], v8 offset:16384
ds_read_b64_tr_b16 v[130:131], v8 offset:18432
v_mfma_f32_16x16x32_bf16 v[48:51], v[208:211], a[228:231], v[48:51]
s_add_u32 s72, s71, 30720
buffer_load_dwordx4 v15, s[24:27], s72 offen offset:2048 lds
v_mfma_f32_16x16x32_bf16 v[48:51], v[224:227], a[232:235], v[48:51]
s_nop 0
ds_read_b64_tr_b16 v[132:133], v9 offset:16384
ds_read_b64_tr_b16 v[134:135], v9 offset:18432
v_mfma_f32_16x16x32_bf16 v[48:51], v[240:243], a[236:239], v[48:51]
s_nop 0
ds_read_b64_tr_b16 v[136:137], v10 offset:16384
ds_read_b64_tr_b16 v[138:139], v10 offset:18432
v_mfma_f32_16x16x32_bf16 v[52:55], v[244:247], a[236:239], v[52:55]
v_mfma_f32_16x16x32_bf16 v[52:55], v[228:231], a[232:235], v[52:55]
s_nop 0
ds_read_b64_tr_b16 v[140:141], v11 offset:16384
ds_read_b64_tr_b16 v[142:143], v11 offset:18432
v_mfma_f32_16x16x32_bf16 v[52:55], v[212:215], a[228:231], v[52:55]
s_nop 0
ds_read_b64_tr_b16 v[144:145], v8 offset:20480
ds_read_b64_tr_b16 v[146:147], v8 offset:22528
v_mfma_f32_16x16x32_bf16 v[52:55], v[196:199], a[224:227], v[52:55]
s_nop 0
ds_read_b64_tr_b16 v[148:149], v9 offset:20480
ds_read_b64_tr_b16 v[150:151], v9 offset:22528
v_mfma_f32_16x16x32_bf16 v[56:59], v[200:203], a[224:227], v[56:59]
s_add_u32 s72, s71, 46080
buffer_load_dwordx4 v15, s[24:27], s72 offen offset:3072 lds
v_mfma_f32_16x16x32_bf16 v[56:59], v[216:219], a[228:231], v[56:59]
v_mfma_f32_16x16x32_bf16 v[56:59], v[232:235], a[232:235], v[56:59]
s_nop 0
ds_read_b64_tr_b16 v[152:153], v10 offset:20480
ds_read_b64_tr_b16 v[154:155], v10 offset:22528
v_mfma_f32_16x16x32_bf16 v[56:59], v[248:251], a[236:239], v[56:59]
s_nop 0
ds_read_b64_tr_b16 v[156:157], v11 offset:20480
ds_read_b64_tr_b16 v[158:159], v11 offset:22528
v_cvt_pk_bf16_f32 v48, v48, v49
v_mfma_f32_16x16x32_bf16 v[60:63], v[252:255], a[236:239], v[60:63]
v_cvt_pk_bf16_f32 v49, v50, v51
v_cvt_pk_bf16_f32 v50, v52, v53
v_cvt_pk_bf16_f32 v51, v54, v55
v_mfma_f32_16x16x32_bf16 v[60:63], v[236:239], a[232:235], v[60:63]
s_nop 0
ds_read_b64_tr_b16 v[160:161], v8 offset:24576
ds_read_b64_tr_b16 v[162:163], v8 offset:26624
v_mfma_f32_16x16x32_bf16 v[60:63], v[220:223], a[228:231], v[60:63]
s_xor_b32 s71, s14, 0x0
ds_read_b64_tr_b16 v[164:165], v9 offset:24576
ds_read_b64_tr_b16 v[166:167], v9 offset:26624
v_mfma_f32_16x16x32_bf16 v[60:63], v[204:207], a[224:227], v[60:63]
s_add_u32 m0, s77, 32768
ds_read_b64_tr_b16 v[168:169], v10 offset:24576
ds_read_b64_tr_b16 v[170:171], v10 offset:26624
v_mfma_f32_16x16x32_bf16 v[64:67], v[192:195], a[240:243], v[64:67]
s_add_u32 s72, s71, 0
buffer_load_dwordx4 v15, s[24:27], s72 offen lds
v_mfma_f32_16x16x32_bf16 v[64:67], v[208:211], a[244:247], v[64:67]
v_mfma_f32_16x16x32_bf16 v[64:67], v[224:227], a[248:251], v[64:67]
s_xor_b32 s80, s93, 0x200000
ds_read_b64_tr_b16 v[172:173], v11 offset:24576
ds_read_b64_tr_b16 v[174:175], v11 offset:26624
v_mfma_f32_16x16x32_bf16 v[64:67], v[240:243], a[252:255], v[64:67]
s_add_u32 s80, s80, 0x3e00000
buffer_store_dwordx4 v[48:51], v1, s[44:47], s80 offen sc1
v_cvt_pk_bf16_f32 v52, v56, v57
v_mfma_f32_16x16x32_bf16 v[68:71], v[244:247], a[252:255], v[68:71]
s_nop 0
ds_read_b64_tr_b16 v[176:177], v8 offset:28672
ds_read_b64_tr_b16 v[178:179], v8 offset:30720
v_cvt_pk_bf16_f32 v53, v58, v59
v_mfma_f32_16x16x32_bf16 v[68:71], v[228:231], a[248:251], v[68:71]
s_nop 0
ds_read_b64_tr_b16 v[180:181], v9 offset:28672
ds_read_b64_tr_b16 v[182:183], v9 offset:30720
v_cvt_pk_bf16_f32 v54, v60, v61
v_mfma_f32_16x16x32_bf16 v[68:71], v[212:215], a[244:247], v[68:71]
v_cvt_pk_bf16_f32 v55, v62, v63
v_mfma_f32_16x16x32_bf16 v[68:71], v[196:199], a[240:243], v[68:71]
s_add_u32 s72, s71, 15360
buffer_load_dwordx4 v15, s[24:27], s72 offen offset:1024 lds
v_mfma_f32_16x16x32_bf16 v[72:75], v[200:203], a[240:243], v[72:75]
s_nop 0
ds_read_b64_tr_b16 v[184:185], v10 offset:28672
ds_read_b64_tr_b16 v[186:187], v10 offset:30720
v_mfma_f32_16x16x32_bf16 v[72:75], v[216:219], a[244:247], v[72:75]
s_nop 0
ds_read_b64_tr_b16 v[188:189], v11 offset:28672
ds_read_b64_tr_b16 v[190:191], v11 offset:30720
v_mfma_f32_16x16x32_bf16 v[72:75], v[232:235], a[248:251], v[72:75]
v_mfma_f32_16x16x32_bf16 v[72:75], v[248:251], a[252:255], v[72:75]
v_cvt_pk_bf16_f32 v56, v64, v65
v_cvt_pk_bf16_f32 v57, v66, v67
v_cvt_pk_bf16_f32 v58, v68, v69
v_mfma_f32_16x16x32_bf16 v[76:79], v[252:255], a[252:255], v[76:79]
v_cvt_pk_bf16_f32 v59, v70, v71
v_mfma_f32_16x16x32_bf16 v[76:79], v[236:239], a[248:251], v[76:79]
s_add_u32 s72, s71, 30720
v_mfma_f32_16x16x32_bf16 v[76:79], v[220:223], a[244:247], v[76:79]
s_waitcnt lgkmcnt(0)
v_mfma_f32_16x16x32_bf16 v[76:79], v[204:207], a[240:243], v[76:79]
buffer_load_dwordx4 v15, s[24:27], s72 offen offset:2048 lds
v_mfma_f32_16x16x32_bf16 v[80:83], v[128:131], a[160:163], v[80:83]
s_waitcnt vmcnt(18)
ds_read_b64_tr_b16 v[192:193], v8 offset:32768
ds_read_b64_tr_b16 v[194:195], v8 offset:34816
v_mfma_f32_16x16x32_bf16 v[80:83], v[144:147], a[164:167], v[80:83]
s_nop 0
ds_read_b64_tr_b16 v[196:197], v9 offset:32768
ds_read_b64_tr_b16 v[198:199], v9 offset:34816
v_mfma_f32_16x16x32_bf16 v[80:83], v[160:163], a[168:171], v[80:83]
s_nop 0
ds_read_b64_tr_b16 v[200:201], v10 offset:32768
ds_read_b64_tr_b16 v[202:203], v10 offset:34816
v_mfma_f32_16x16x32_bf16 v[80:83], v[176:179], a[172:175], v[80:83]
s_nop 0
buffer_store_dwordx4 v[52:55], v1, s[44:47], s80 offen offset:1024 sc1
v_cvt_pk_bf16_f32 v60, v72, v73
v_mfma_f32_16x16x32_bf16 v[96:99], v[176:179], a[188:191], v[96:99]
v_cvt_pk_bf16_f32 v61, v74, v75
v_cvt_pk_bf16_f32 v62, v76, v77
v_cvt_pk_bf16_f32 v63, v78, v79
v_mfma_f32_16x16x32_bf16 v[96:99], v[160:163], a[184:187], v[96:99]
s_nop 0
ds_read_b64_tr_b16 v[204:205], v11 offset:32768
ds_read_b64_tr_b16 v[206:207], v11 offset:34816
v_mfma_f32_16x16x32_bf16 v[96:99], v[144:147], a[180:183], v[96:99]
s_add_u32 s72, s71, 46080
buffer_load_dwordx4 v15, s[24:27], s72 offen offset:3072 lds
v_mfma_f32_16x16x32_bf16 v[96:99], v[128:131], a[176:179], v[96:99]
s_nop 0
ds_read_b64_tr_b16 v[208:209], v8 offset:36864
ds_read_b64_tr_b16 v[210:211], v8 offset:38912
v_mfma_f32_16x16x32_bf16 v[100:103], v[132:135], a[176:179], v[100:103]
s_nop 0
ds_read_b64_tr_b16 v[212:213], v9 offset:36864
ds_read_b64_tr_b16 v[214:215], v9 offset:38912
v_mfma_f32_16x16x32_bf16 v[100:103], v[148:151], a[180:183], v[100:103]
v_sub_f32 v112, 1.0, v6
v_sub_f32 v113, 1.0, v7
v_mfma_f32_16x16x32_bf16 v[100:103], v[164:167], a[184:187], v[100:103]
s_nop 0
ds_read_b64_tr_b16 v[216:217], v10 offset:36864
ds_read_b64_tr_b16 v[218:219], v10 offset:38912
v_mfma_f32_16x16x32_bf16 v[100:103], v[180:183], a[188:191], v[100:103]
s_nop 0
ds_read_b64_tr_b16 v[220:221], v11 offset:36864
ds_read_b64_tr_b16 v[222:223], v11 offset:38912
v_mfma_f32_16x16x32_bf16 v[84:87], v[180:183], a[172:175], v[84:87]
s_xor_b32 s71, s15, 0x0
v_mfma_f32_16x16x32_bf16 v[84:87], v[164:167], a[168:171], v[84:87]
s_add_u32 m0, s77, 49152
ds_read_b64_tr_b16 v[224:225], v8 offset:40960
ds_read_b64_tr_b16 v[226:227], v8 offset:43008
v_mfma_f32_16x16x32_bf16 v[84:87], v[148:151], a[164:167], v[84:87]
s_add_u32 s72, s71, 0
buffer_load_dwordx4 v15, s[24:27], s72 offen lds
v_mfma_f32_16x16x32_bf16 v[84:87], v[132:135], a[160:163], v[84:87]
s_nop 0
ds_read_b64_tr_b16 v[228:229], v9 offset:40960
ds_read_b64_tr_b16 v[230:231], v9 offset:43008
v_mfma_f32_16x16x32_bf16 v[88:91], v[136:139], a[160:163], v[88:91]
s_nop 0
ds_read_b64_tr_b16 v[232:233], v10 offset:40960
ds_read_b64_tr_b16 v[234:235], v10 offset:43008
v_mfma_f32_16x16x32_bf16 v[88:91], v[152:155], a[164:167], v[88:91]
v_mfma_f32_16x16x32_bf16 v[88:91], v[168:171], a[168:171], v[88:91]
s_nop 0
ds_read_b64_tr_b16 v[236:237], v11 offset:40960
ds_read_b64_tr_b16 v[238:239], v11 offset:43008
v_mfma_f32_16x16x32_bf16 v[88:91], v[184:187], a[172:175], v[88:91]
s_nop 0
ds_read_b64_tr_b16 v[240:241], v8 offset:45056
ds_read_b64_tr_b16 v[242:243], v8 offset:47104
v_mfma_f32_16x16x32_bf16 v[104:107], v[184:187], a[188:191], v[104:107]
s_nop 0
ds_read_b64_tr_b16 v[244:245], v9 offset:45056
ds_read_b64_tr_b16 v[246:247], v9 offset:47104
v_mfma_f32_16x16x32_bf16 v[104:107], v[168:171], a[184:187], v[104:107]
s_add_u32 s72, s71, 15360
buffer_load_dwordx4 v15, s[24:27], s72 offen offset:1024 lds
v_mfma_f32_16x16x32_bf16 v[104:107], v[152:155], a[180:183], v[104:107]
v_mfma_f32_16x16x32_bf16 v[104:107], v[136:139], a[176:179], v[104:107]
s_nop 0
ds_read_b64_tr_b16 v[248:249], v10 offset:45056
ds_read_b64_tr_b16 v[250:251], v10 offset:47104
v_mfma_f32_16x16x32_bf16 v[108:111], v[140:143], a[176:179], v[108:111]
buffer_store_dwordx4 v[56:59], v1, s[44:47], s80 offen offset:2048 sc1
v_mfma_f32_16x16x32_bf16 v[108:111], v[156:159], a[180:183], v[108:111]
s_nop 0
ds_read_b64_tr_b16 v[252:253], v11 offset:45056
ds_read_b64_tr_b16 v[254:255], v11 offset:47104
v_mfma_f32_16x16x32_bf16 v[108:111], v[172:175], a[184:187], v[108:111]
v_mfma_f32_16x16x32_bf16 v[108:111], v[188:191], a[188:191], v[108:111]
v_mfma_f32_16x16x32_bf16 v[92:95], v[188:191], a[172:175], v[92:95]
v_mfma_f32_16x16x32_bf16 v[92:95], v[172:175], a[168:171], v[92:95]
s_add_u32 s72, s71, 30720
buffer_load_dwordx4 v15, s[24:27], s72 offen offset:2048 lds
v_mfma_f32_16x16x32_bf16 v[92:95], v[156:159], a[164:167], v[92:95]
s_waitcnt vmcnt(14) lgkmcnt(0)
v_mfma_f32_16x16x32_bf16 v[92:95], v[140:143], a[160:163], v[92:95]
s_barrier
v_mfma_f32_16x16x32_bf16 v[80:83], v[192:195], a[192:195], v[80:83]
s_nop 0
ds_read_b64_tr_b16 v[128:129], v8 offset:49152
ds_read_b64_tr_b16 v[130:131], v8 offset:51200
v_mfma_f32_16x16x32_bf16 v[80:83], v[208:211], a[196:199], v[80:83]
s_nop 0
ds_read_b64_tr_b16 v[132:133], v9 offset:49152
ds_read_b64_tr_b16 v[134:135], v9 offset:51200
v_mfma_f32_16x16x32_bf16 v[80:83], v[224:227], a[200:203], v[80:83]
s_nop 0
ds_read_b64_tr_b16 v[136:137], v10 offset:49152
ds_read_b64_tr_b16 v[138:139], v10 offset:51200
v_mfma_f32_16x16x32_bf16 v[80:83], v[240:243], a[204:207], v[80:83]
v_mfma_f32_16x16x32_bf16 v[96:99], v[240:243], a[220:223], v[96:99]
s_add_u32 s72, s71, 46080
buffer_load_dwordx4 v15, s[24:27], s72 offen offset:3072 lds
v_mfma_f32_16x16x32_bf16 v[96:99], v[224:227], a[216:219], v[96:99]
s_nop 0
ds_read_b64_tr_b16 v[140:141], v11 offset:49152
ds_read_b64_tr_b16 v[142:143], v11 offset:51200
v_mfma_f32_16x16x32_bf16 v[96:99], v[208:211], a[212:215], v[96:99]
s_nop 0
ds_read_b64_tr_b16 v[144:145], v8 offset:53248
ds_read_b64_tr_b16 v[146:147], v8 offset:55296
v_mfma_f32_16x16x32_bf16 v[96:99], v[192:195], a[208:211], v[96:99]
s_nop 0
ds_read_b64_tr_b16 v[148:149], v9 offset:53248
ds_read_b64_tr_b16 v[150:151], v9 offset:55296
v_mfma_f32_16x16x32_bf16 v[100:103], v[196:199], a[208:211], v[100:103]
buffer_store_dwordx4 v[60:63], v1, s[44:47], s80 offen offset:3072 sc1
v_mfma_f32_16x16x32_bf16 v[100:103], v[212:215], a[212:215], v[100:103]
s_nop 0
ds_read_b64 v[48:49], v116 offset:0
ds_read_b64_tr_b16 v[64:65], v5 offset:0
v_mfma_f32_16x16x32_bf16 v[100:103], v[228:231], a[216:219], v[100:103]
s_xor_b32 s71, s12, 0x40000
ds_read_b64_tr_b16 v[152:153], v10 offset:53248
ds_read_b64_tr_b16 v[154:155], v10 offset:55296
v_mfma_f32_16x16x32_bf16 v[100:103], v[244:247], a[220:223], v[100:103]
s_add_u32 m0, s85, 0
ds_read_b64_tr_b16 v[156:157], v11 offset:53248
ds_read_b64_tr_b16 v[158:159], v11 offset:55296
v_mfma_f32_16x16x32_bf16 v[84:87], v[244:247], a[204:207], v[84:87]
s_add_u32 s72, s71, 0
buffer_load_dwordx4 v15, s[24:27], s72 offen lds
v_mfma_f32_16x16x32_bf16 v[84:87], v[228:231], a[200:203], v[84:87]
s_nop 0
ds_read_b64 v[50:51], v117 offset:0
ds_read_b64_tr_b16 v[66:67], v5 offset:4096
v_mfma_f32_16x16x32_bf16 v[84:87], v[212:215], a[196:199], v[84:87]
s_nop 0
ds_read_b64_tr_b16 v[160:161], v8 offset:57344
ds_read_b64_tr_b16 v[162:163], v8 offset:59392
v_mfma_f32_16x16x32_bf16 v[84:87], v[196:199], a[192:195], v[84:87]
s_nop 0
ds_read_b64_tr_b16 v[164:165], v9 offset:57344
ds_read_b64_tr_b16 v[166:167], v9 offset:59392
v_mfma_f32_16x16x32_bf16 v[88:91], v[200:203], a[192:195], v[88:91]
s_nop 0
ds_read_b64_tr_b16 v[168:169], v10 offset:57344
ds_read_b64_tr_b16 v[170:171], v10 offset:59392
v_mfma_f32_16x16x32_bf16 v[88:91], v[216:219], a[196:199], v[88:91]
s_nop 0
ds_read_b64 v[52:53], v118 offset:0
ds_read_b64_tr_b16 v[68:69], v5 offset:8192
v_mfma_f32_16x16x32_bf16 v[88:91], v[232:235], a[200:203], v[88:91]
s_nop 0
ds_read_b64_tr_b16 v[172:173], v11 offset:57344
ds_read_b64_tr_b16 v[174:175], v11 offset:59392
Lstube3:
s_cbranch_execz Lrete
v_mfma_f32_16x16x32_bf16 v[88:91], v[248:251], a[204:207], v[88:91]
s_add_u32 s72, s71, 15360
buffer_load_dwordx4 v15, s[24:27], s72 offen offset:1024 lds
v_mfma_f32_16x16x32_bf16 v[104:107], v[248:251], a[220:223], v[104:107]
s_nop 0
ds_read_b64_tr_b16 v[176:177], v8 offset:61440
ds_read_b64_tr_b16 v[178:179], v8 offset:63488
v_mfma_f32_16x16x32_bf16 v[104:107], v[232:235], a[216:219], v[104:107]
s_nop 0
ds_read_b64_tr_b16 v[180:181], v9 offset:61440
ds_read_b64_tr_b16 v[182:183], v9 offset:63488
v_mfma_f32_16x16x32_bf16 v[104:107], v[216:219], a[212:215], v[104:107]
s_nop 0
ds_read_b64 v[54:55], v119 offset:0
ds_read_b64_tr_b16 v[70:71], v5 offset:12288
v_mfma_f32_16x16x32_bf16 v[104:107], v[200:203], a[208:211], v[104:107]
s_nop 0
ds_read_b64_tr_b16 v[184:185], v10 offset:61440
ds_read_b64_tr_b16 v[186:187], v10 offset:63488
v_mfma_f32_16x16x32_bf16 v[108:111], v[204:207], a[208:211], v[108:111]
s_nop 0
ds_read_b64_tr_b16 v[188:189], v11 offset:61440
ds_read_b64_tr_b16 v[190:191], v11 offset:63488
v_mfma_f32_16x16x32_bf16 v[108:111], v[220:223], a[212:215], v[108:111]
v_xor_b32 v5, 16, v5
v_mfma_f32_16x16x32_bf16 v[108:111], v[236:239], a[216:219], v[108:111]
s_add_u32 s72, s71, 30720
buffer_load_dwordx4 v15, s[24:27], s72 offen offset:2048 lds
v_mfma_f32_16x16x32_bf16 v[108:111], v[252:255], a[220:223], v[108:111]
s_nop 0
ds_read_b64 v[56:57], v116 offset:2048
ds_read_b64_tr_b16 v[72:73], v5 offset:0
v_mfma_f32_16x16x32_bf16 v[92:95], v[252:255], a[204:207], v[92:95]
ds_read_b64 v[58:59], v117 offset:2048
v_xor_b32 v8, 0x10000, v8
v_mfma_f32_16x16x32_bf16 v[92:95], v[236:239], a[200:203], v[92:95]
ds_read_b64_tr_b16 v[74:75], v5 offset:4096
v_xor_b32 v9, 0x10000, v9
v_mfma_f32_16x16x32_bf16 v[92:95], v[220:223], a[196:199], v[92:95]
s_waitcnt lgkmcnt(0)
ds_read_b64 v[60:61], v118 offset:2048
v_xor_b32 v10, 0x10000, v10
v_mfma_f32_16x16x32_bf16 v[92:95], v[204:207], a[192:195], v[92:95]
ds_read_b64_tr_b16 v[76:77], v5 offset:8192
v_xor_b32 v11, 0x10000, v11
v_mfma_f32_16x16x32_bf16 v[80:83], v[128:131], a[224:227], v[80:83]
s_nop 0
ds_read_b64_tr_b16 v[192:193], v8 offset:0
ds_read_b64_tr_b16 v[194:195], v8 offset:2048
v_mfma_f32_16x16x32_bf16 v[80:83], v[144:147], a[228:231], v[80:83]
s_add_u32 s72, s71, 46080
buffer_load_dwordx4 v15, s[24:27], s72 offen offset:3072 lds
v_mfma_f32_16x16x32_bf16 v[80:83], v[160:163], a[232:235], v[80:83]
s_nop 0
ds_read_b64_tr_b16 v[196:197], v9 offset:0
ds_read_b64_tr_b16 v[198:199], v9 offset:2048
v_mfma_f32_16x16x32_bf16 v[80:83], v[176:179], a[236:239], v[80:83]
s_nop 0
ds_read_b64_tr_b16 v[200:201], v10 offset:0
ds_read_b64_tr_b16 v[202:203], v10 offset:2048
v_mfma_f32_16x16x32_bf16 v[84:87], v[180:183], a[236:239], v[84:87]
s_nop 0
ds_read_b64 v[62:63], v119 offset:2048
ds_read_b64_tr_b16 v[78:79], v5 offset:12288
v_mfma_f32_16x16x32_bf16 v[84:87], v[164:167], a[232:235], v[84:87]
s_nop 0
ds_read_b64_tr_b16 v[204:205], v11 offset:0
ds_read_b64_tr_b16 v[206:207], v11 offset:2048
v_mfma_f32_16x16x32_bf16 v[84:87], v[148:151], a[228:231], v[84:87]
s_nop 0
ds_read_b64_tr_b16 v[208:209], v8 offset:4096
ds_read_b64_tr_b16 v[210:211], v8 offset:6144
v_mfma_f32_16x16x32_bf16 v[84:87], v[132:135], a[224:227], v[84:87]
s_xor_b32 s71, s13, 0x40000
ds_read_b64_tr_b16 v[212:213], v9 offset:4096
ds_read_b64_tr_b16 v[214:215], v9 offset:6144
v_mfma_f32_16x16x32_bf16 v[88:91], v[136:139], a[224:227], v[88:91]
s_add_u32 m0, s85, 16384
v_mfma_f32_16x16x32_bf16 v[88:91], v[152:155], a[228:231], v[88:91]
s_add_u32 s72, s71, 0
buffer_load_dwordx4 v15, s[24:27], s72 offen lds
v_mfma_f32_16x16x32_bf16 v[88:91], v[168:171], a[232:235], v[88:91]
s_waitcnt lgkmcnt(6)
ds_read_b64_tr_b16 v[216:217], v10 offset:4096
ds_read_b64_tr_b16 v[218:219], v10 offset:6144
v_mfma_f32_16x16x32_bf16 v[88:91], v[184:187], a[236:239], v[88:91]
s_nop 0
ds_read_b64_tr_b16 v[220:221], v11 offset:4096
ds_read_b64_tr_b16 v[222:223], v11 offset:6144
v_cvt_pk_bf16_f32 v80, v80, v81
v_mfma_f32_16x16x32_bf16 v[92:95], v[188:191], a[236:239], v[92:95]
v_cvt_pk_bf16_f32 v81, v82, v83
v_cvt_pk_bf16_f32 v82, v84, v85
v_cvt_pk_bf16_f32 v83, v86, v87
v_mfma_f32_16x16x32_bf16 v[92:95], v[172:175], a[232:235], v[92:95]
s_nop 0
ds_read_b64_tr_b16 v[224:225], v8 offset:8192
ds_read_b64_tr_b16 v[226:227], v8 offset:10240
v_mfma_f32_16x16x32_bf16 v[92:95], v[156:159], a[228:231], v[92:95]
s_nop 0
ds_read_b64_tr_b16 v[228:229], v9 offset:8192
ds_read_b64_tr_b16 v[230:231], v9 offset:10240
v_mfma_f32_16x16x32_bf16 v[92:95], v[140:143], a[224:227], v[92:95]
s_nop 0
ds_read_b64_tr_b16 v[232:233], v10 offset:8192
ds_read_b64_tr_b16 v[234:235], v10 offset:10240
v_mfma_f32_16x16x32_bf16 v[96:99], v[128:131], a[240:243], v[96:99]
s_add_u32 s72, s71, 15360
buffer_load_dwordx4 v15, s[24:27], s72 offen offset:1024 lds
v_mfma_f32_16x16x32_bf16 v[96:99], v[144:147], a[244:247], v[96:99]
v_and_b32 v114, 0xffff0000, v48
v_lshlrev_b32 v115, 16, v64
v_mfma_f32_16x16x32_bf16 v[96:99], v[160:163], a[248:251], v[96:99]
s_xor_b32 s80, s93, 0x300000
ds_read_b64_tr_b16 v[236:237], v11 offset:8192
ds_read_b64_tr_b16 v[238:239], v11 offset:10240
v_mfma_f32_16x16x32_bf16 v[96:99], v[176:179], a[252:255], v[96:99]
s_add_u32 s80, s80, 0x4200000
buffer_store_dwordx4 v[80:83], v1, s[44:47], s80 offen sc1
v_cvt_pk_bf16_f32 v84, v88, v89
v_mfma_f32_16x16x32_bf16 v[100:103], v[180:183], a[252:255], v[100:103]
s_nop 0
ds_read_b64_tr_b16 v[240:241], v8 offset:12288
ds_read_b64_tr_b16 v[242:243], v8 offset:14336
v_cvt_pk_bf16_f32 v85, v90, v91
v_mfma_f32_16x16x32_bf16 v[100:103], v[164:167], a[248:251], v[100:103]
s_nop 0
ds_read_b64_tr_b16 v[244:245], v9 offset:12288
ds_read_b64_tr_b16 v[246:247], v9 offset:14336
v_cvt_pk_bf16_f32 v86, v92, v93
v_mfma_f32_16x16x32_bf16 v[100:103], v[148:151], a[244:247], v[100:103]
v_cvt_pk_bf16_f32 v87, v94, v95
v_lshlrev_b32 v48, 16, v48
v_mfma_f32_16x16x32_bf16 v[100:103], v[132:135], a[240:243], v[100:103]
s_nop 0
ds_read_b64_tr_b16 v[248:249], v10 offset:12288
ds_read_b64_tr_b16 v[250:251], v10 offset:14336
v_mfma_f32_16x16x32_bf16 v[104:107], v[136:139], a[240:243], v[104:107]
s_add_u32 s72, s71, 30720
buffer_load_dwordx4 v15, s[24:27], s72 offen offset:2048 lds
v_mfma_f32_16x16x32_bf16 v[104:107], v[152:155], a[244:247], v[104:107]
s_nop 0
ds_read_b64_tr_b16 v[252:253], v11 offset:12288
ds_read_b64_tr_b16 v[254:255], v11 offset:14336
v_mfma_f32_16x16x32_bf16 v[104:107], v[168:171], a[248:251], v[104:107]
v_and_b32 v64, 0xffff0000, v64
v_mul_f32 v48, v48, v112
v_mfma_f32_16x16x32_bf16 v[104:107], v[184:187], a[252:255], v[104:107]
v_cvt_pk_bf16_f32 v88, v96, v97
v_cvt_pk_bf16_f32 v89, v98, v99
v_cvt_pk_bf16_f32 v90, v100, v101
v_mfma_f32_16x16x32_bf16 v[108:111], v[188:191], a[252:255], v[108:111]
v_cvt_pk_bf16_f32 v91, v102, v103
v_mul_f32 v114, v114, v112
v_mfma_f32_16x16x32_bf16 v[108:111], v[172:175], a[248:251], v[108:111]
s_add_u32 s72, s71, 46080
v_mul_f32 v48, v48, v115
v_mul_f32 v64, v64, v114
v_mfma_f32_16x16x32_bf16 v[108:111], v[156:159], a[244:247], v[108:111]
s_waitcnt vmcnt(14) lgkmcnt(0)
v_and_b32 v114, 0xffff0000, v49
v_lshlrev_b32 v115, 16, v65
v_mfma_f32_16x16x32_bf16 v[108:111], v[140:143], a[240:243], v[108:111]
s_barrier
buffer_load_dwordx4 v15, s[24:27], s72 offen offset:3072 lds
v_mfma_f32_16x16x32_bf16 v[16:19], v[192:195], a[0:3], 0
s_nop 0
ds_read_b64_tr_b16 v[128:129], v8 offset:16384
ds_read_b64_tr_b16 v[130:131], v8 offset:18432
v_mfma_f32_16x16x32_bf16 v[16:19], v[208:211], a[4:7], v[16:19]
s_nop 0
ds_read_b64_tr_b16 v[132:133], v9 offset:16384
ds_read_b64_tr_b16 v[134:135], v9 offset:18432
v_mfma_f32_16x16x32_bf16 v[16:19], v[224:227], a[8:11], v[16:19]
s_nop 0
ds_read_b64_tr_b16 v[136:137], v10 offset:16384
ds_read_b64_tr_b16 v[138:139], v10 offset:18432
v_mfma_f32_16x16x32_bf16 v[16:19], v[240:243], a[12:15], v[16:19]
s_nop 0
buffer_store_dwordx4 v[84:87], v1, s[44:47], s80 offen offset:1024 sc1
v_cvt_pk_bf16_f32 v92, v104, v105
v_mfma_f32_16x16x32_bf16 v[32:35], v[240:243], a[28:31], 0
v_cvt_pk_bf16_f32 v93, v106, v107
v_cvt_pk_bf16_f32 v94, v108, v109
v_cvt_pk_bf16_f32 v95, v110, v111
v_mfma_f32_16x16x32_bf16 v[32:35], v[224:227], a[24:27], v[32:35]
s_xor_b32 s71, s14, 0x40000
ds_read_b64_tr_b16 v[140:141], v11 offset:16384
ds_read_b64_tr_b16 v[142:143], v11 offset:18432
v_mfma_f32_16x16x32_bf16 v[32:35], v[208:211], a[20:23], v[32:35]
s_add_u32 m0, s85, 32768
ds_read_b64_tr_b16 v[144:145], v8 offset:20480
ds_read_b64_tr_b16 v[146:147], v8 offset:22528
v_mfma_f32_16x16x32_bf16 v[32:35], v[192:195], a[16:19], v[32:35]
s_add_u32 s72, s71, 0
buffer_load_dwordx4 v15, s[24:27], s72 offen lds
v_mfma_f32_16x16x32_bf16 v[36:39], v[196:199], a[16:19], 0
s_nop 0
ds_read_b64_tr_b16 v[148:149], v9 offset:20480
ds_read_b64_tr_b16 v[150:151], v9 offset:22528
v_mfma_f32_16x16x32_bf16 v[36:39], v[212:215], a[20:23], v[36:39]
v_lshlrev_b32 v49, 16, v49
v_and_b32 v65, 0xffff0000, v65
v_mfma_f32_16x16x32_bf16 v[36:39], v[228:231], a[24:27], v[36:39]
s_nop 0
ds_read_b64_tr_b16 v[152:153], v10 offset:20480
ds_read_b64_tr_b16 v[154:155], v10 offset:22528
v_mfma_f32_16x16x32_bf16 v[36:39], v[244:247], a[28:31], v[36:39]
s_nop 0
ds_read_b64_tr_b16 v[156:157], v11 offset:20480
ds_read_b64_tr_b16 v[158:159], v11 offset:22528
v_mfma_f32_16x16x32_bf16 v[20:23], v[244:247], a[12:15], 0
v_mul_f32 v49, v49, v112
v_mul_f32 v114, v114, v112
v_mfma_f32_16x16x32_bf16 v[20:23], v[228:231], a[8:11], v[20:23]
s_nop 0
ds_read_b64_tr_b16 v[160:161], v8 offset:24576
ds_read_b64_tr_b16 v[162:163], v8 offset:26624
v_mfma_f32_16x16x32_bf16 v[20:23], v[212:215], a[4:7], v[20:23]
s_add_u32 s72, s71, 15360
buffer_load_dwordx4 v15, s[24:27], s72 offen offset:1024 lds
v_mfma_f32_16x16x32_bf16 v[20:23], v[196:199], a[0:3], v[20:23]
s_nop 0
ds_read_b64_tr_b16 v[164:165], v9 offset:24576
ds_read_b64_tr_b16 v[166:167], v9 offset:26624
v_mfma_f32_16x16x32_bf16 v[24:27], v[200:203], a[0:3], 0
s_nop 0
ds_read_b64_tr_b16 v[168:169], v10 offset:24576
ds_read_b64_tr_b16 v[170:171], v10 offset:26624
v_mfma_f32_16x16x32_bf16 v[24:27], v[216:219], a[4:7], v[24:27]
v_mul_f32 v49, v49, v115
v_mul_f32 v65, v65, v114
v_mfma_f32_16x16x32_bf16 v[24:27], v[232:235], a[8:11], v[24:27]
s_nop 0
ds_read_b64_tr_b16 v[172:173], v11 offset:24576
ds_read_b64_tr_b16 v[174:175], v11 offset:26624
v_mfma_f32_16x16x32_bf16 v[24:27], v[248:251], a[12:15], v[24:27]
buffer_store_dwordx4 v[88:91], v1, s[44:47], s80 offen offset:2048 sc1
v_mfma_f32_16x16x32_bf16 v[40:43], v[248:251], a[28:31], 0
s_nop 0
ds_read_b64_tr_b16 v[176:177], v8 offset:28672
ds_read_b64_tr_b16 v[178:179], v8 offset:30720
v_mfma_f32_16x16x32_bf16 v[40:43], v[232:235], a[24:27], v[40:43]
s_nop 0
ds_read_b64_tr_b16 v[180:181], v9 offset:28672
ds_read_b64_tr_b16 v[182:183], v9 offset:30720
v_mfma_f32_16x16x32_bf16 v[40:43], v[216:219], a[20:23], v[40:43]
s_add_u32 s72, s71, 30720
buffer_load_dwordx4 v15, s[24:27], s72 offen offset:2048 lds
v_mfma_f32_16x16x32_bf16 v[40:43], v[200:203], a[16:19], v[40:43]
v_and_b32 v114, 0xffff0000, v50
v_lshlrev_b32 v115, 16, v66
v_mfma_f32_16x16x32_bf16 v[44:47], v[204:207], a[16:19], 0
s_nop 0
ds_read_b64_tr_b16 v[184:185], v10 offset:28672
ds_read_b64_tr_b16 v[186:187], v10 offset:30720
v_mfma_f32_16x16x32_bf16 v[44:47], v[220:223], a[20:23], v[44:47]
s_nop 0
ds_read_b64_tr_b16 v[188:189], v11 offset:28672
ds_read_b64_tr_b16 v[190:191], v11 offset:30720
v_mfma_f32_16x16x32_bf16 v[44:47], v[236:239], a[24:27], v[44:47]
v_lshlrev_b32 v50, 16, v50
v_and_b32 v66, 0xffff0000, v66
v_mfma_f32_16x16x32_bf16 v[44:47], v[252:255], a[28:31], v[44:47]
v_mul_f32 v50, v50, v112
v_mul_f32 v114, v114, v112
v_mfma_f32_16x16x32_bf16 v[28:31], v[252:255], a[12:15], 0
v_mul_f32 v50, v50, v115
v_mul_f32 v66, v66, v114
v_mfma_f32_16x16x32_bf16 v[28:31], v[236:239], a[8:11], v[28:31]
s_add_u32 s72, s71, 46080
buffer_load_dwordx4 v15, s[24:27], s72 offen offset:3072 lds
v_mfma_f32_16x16x32_bf16 v[28:31], v[220:223], a[4:7], v[28:31]
s_waitcnt lgkmcnt(0)
v_and_b32 v114, 0xffff0000, v51
v_lshlrev_b32 v115, 16, v67
v_mfma_f32_16x16x32_bf16 v[28:31], v[204:207], a[0:3], v[28:31]
v_lshlrev_b32 v51, 16, v51
v_and_b32 v67, 0xffff0000, v67
v_mfma_f32_16x16x32_bf16 v[16:19], v[128:131], a[32:35], v[16:19]
s_nop 0
ds_read_b64_tr_b16 v[192:193], v8 offset:32768
ds_read_b64_tr_b16 v[194:195], v8 offset:34816
v_mfma_f32_16x16x32_bf16 v[16:19], v[144:147], a[36:39], v[16:19]
s_nop 0
ds_read_b64_tr_b16 v[196:197], v9 offset:32768
ds_read_b64_tr_b16 v[198:199], v9 offset:34816
v_mfma_f32_16x16x32_bf16 v[16:19], v[160:163], a[40:43], v[16:19]
s_nop 0
ds_read_b64_tr_b16 v[200:201], v10 offset:32768
ds_read_b64_tr_b16 v[202:203], v10 offset:34816
v_mfma_f32_16x16x32_bf16 v[16:19], v[176:179], a[44:47], v[16:19]
s_xor_b32 s71, s15, 0x40000
v_mul_f32 v51, v51, v112
v_mul_f32 v114, v114, v112
v_mfma_f32_16x16x32_bf16 v[32:35], v[176:179], a[60:63], v[32:35]
s_add_u32 m0, s85, 49152
ds_read_b64_tr_b16 v[204:205], v11 offset:32768
ds_read_b64_tr_b16 v[206:207], v11 offset:34816
v_mfma_f32_16x16x32_bf16 v[32:35], v[160:163], a[56:59], v[32:35]
s_add_u32 s72, s71, 0
buffer_load_dwordx4 v15, s[24:27], s72 offen lds
v_mfma_f32_16x16x32_bf16 v[32:35], v[144:147], a[52:55], v[32:35]
s_nop 0
ds_read_b64_tr_b16 v[208:209], v8 offset:36864
ds_read_b64_tr_b16 v[210:211], v8 offset:38912
v_mfma_f32_16x16x32_bf16 v[32:35], v[128:131], a[48:51], v[32:35]
v_mul_f32 v51, v51, v115
v_mul_f32 v67, v67, v114
v_mfma_f32_16x16x32_bf16 v[36:39], v[132:135], a[48:51], v[36:39]
buffer_store_dwordx4 v[92:95], v1, s[44:47], s80 offen offset:3072 sc1
v_mfma_f32_16x16x32_bf16 v[36:39], v[148:151], a[52:55], v[36:39]
s_nop 0
ds_read_b64_tr_b16 v[212:213], v9 offset:36864
ds_read_b64_tr_b16 v[214:215], v9 offset:38912
v_mfma_f32_16x16x32_bf16 v[36:39], v[164:167], a[56:59], v[36:39]
s_nop 0
ds_read_b64_tr_b16 v[216:217], v10 offset:36864
ds_read_b64_tr_b16 v[218:219], v10 offset:38912
v_mfma_f32_16x16x32_bf16 v[36:39], v[180:183], a[60:63], v[36:39]
v_and_b32 v114, 0xffff0000, v52
v_lshlrev_b32 v115, 16, v68
v_mfma_f32_16x16x32_bf16 v[20:23], v[180:183], a[44:47], v[20:23]
s_add_u32 s72, s71, 15360
buffer_load_dwordx4 v15, s[24:27], s72 offen offset:1024 lds
v_mfma_f32_16x16x32_bf16 v[20:23], v[164:167], a[40:43], v[20:23]
s_nop 0
ds_read_b64_tr_b16 v[220:221], v11 offset:36864
ds_read_b64_tr_b16 v[222:223], v11 offset:38912
v_mfma_f32_16x16x32_bf16 v[20:23], v[148:151], a[36:39], v[20:23]
s_nop 0
ds_read_b64_tr_b16 v[224:225], v8 offset:40960
ds_read_b64_tr_b16 v[226:227], v8 offset:43008
v_mfma_f32_16x16x32_bf16 v[20:23], v[132:135], a[32:35], v[20:23]
s_nop 0
ds_read_b64_tr_b16 v[228:229], v9 offset:40960
ds_read_b64_tr_b16 v[230:231], v9 offset:43008
v_mfma_f32_16x16x32_bf16 v[24:27], v[136:139], a[32:35], v[24:27]
v_lshlrev_b32 v52, 16, v52
v_and_b32 v68, 0xffff0000, v68
v_mfma_f32_16x16x32_bf16 v[24:27], v[152:155], a[36:39], v[24:27]
s_nop 0
ds_read_b64_tr_b16 v[232:233], v10 offset:40960
ds_read_b64_tr_b16 v[234:235], v10 offset:43008
v_mfma_f32_16x16x32_bf16 v[24:27], v[168:171], a[40:43], v[24:27]
s_nop 0
ds_read_b64_tr_b16 v[236:237], v11 offset:40960
ds_read_b64_tr_b16 v[238:239], v11 offset:43008
v_mfma_f32_16x16x32_bf16 v[24:27], v[184:187], a[44:47], v[24:27]
v_mul_f32 v52, v52, v112
v_mul_f32 v114, v114, v112
v_mfma_f32_16x16x32_bf16 v[40:43], v[184:187], a[60:63], v[40:43]
s_add_u32 s72, s71, 30720
buffer_load_dwordx4 v15, s[24:27], s72 offen offset:2048 lds
v_mfma_f32_16x16x32_bf16 v[40:43], v[168:171], a[56:59], v[40:43]
s_nop 0
ds_read_b64_tr_b16 v[240:241], v8 offset:45056
ds_read_b64_tr_b16 v[242:243], v8 offset:47104
v_mfma_f32_16x16x32_bf16 v[40:43], v[152:155], a[52:55], v[40:43]
s_nop 0
ds_read_b64_tr_b16 v[244:245], v9 offset:45056
ds_read_b64_tr_b16 v[246:247], v9 offset:47104
v_mfma_f32_16x16x32_bf16 v[40:43], v[136:139], a[48:51], v[40:43]
v_mul_f32 v52, v52, v115
v_mul_f32 v68, v68, v114
v_mfma_f32_16x16x32_bf16 v[44:47], v[140:143], a[48:51], v[44:47]
s_nop 0
ds_read_b64_tr_b16 v[248:249], v10 offset:45056
ds_read_b64_tr_b16 v[250:251], v10 offset:47104
v_mfma_f32_16x16x32_bf16 v[44:47], v[156:159], a[52:55], v[44:47]
s_nop 0
ds_read_b64_tr_b16 v[252:253], v11 offset:45056
ds_read_b64_tr_b16 v[254:255], v11 offset:47104
v_mfma_f32_16x16x32_bf16 v[44:47], v[172:175], a[56:59], v[44:47]
v_and_b32 v114, 0xffff0000, v53
v_lshlrev_b32 v115, 16, v69
v_mfma_f32_16x16x32_bf16 v[44:47], v[188:191], a[60:63], v[44:47]
s_add_u32 s72, s71, 46080
buffer_load_dwordx4 v15, s[24:27], s72 offen offset:3072 lds
v_mfma_f32_16x16x32_bf16 v[28:31], v[188:191], a[44:47], v[28:31]
v_lshlrev_b32 v53, 16, v53
v_and_b32 v69, 0xffff0000, v69
v_mfma_f32_16x16x32_bf16 v[28:31], v[172:175], a[40:43], v[28:31]
s_add_u32 s79, s93, 0x3a00000
v_mul_f32 v53, v53, v112
v_mul_f32 v114, v114, v112
v_mfma_f32_16x16x32_bf16 v[28:31], v[156:159], a[36:39], v[28:31]
s_waitcnt vmcnt(16) lgkmcnt(0)
buffer_load_dwordx4 v[96:99], v1, s[44:47], s79 offen sc1
v_mfma_f32_16x16x32_bf16 v[28:31], v[140:143], a[32:35], v[28:31]
s_barrier
v_mul_f32 v53, v53, v115
v_mul_f32 v69, v69, v114
v_mfma_f32_16x16x32_bf16 v[16:19], v[192:195], a[64:67], v[16:19]
s_nop 0
ds_read_b64_tr_b16 v[128:129], v8 offset:49152
ds_read_b64_tr_b16 v[130:131], v8 offset:51200
v_mfma_f32_16x16x32_bf16 v[16:19], v[208:211], a[68:71], v[16:19]
s_nop 0
ds_read_b64_tr_b16 v[132:133], v9 offset:49152
ds_read_b64_tr_b16 v[134:135], v9 offset:51200
v_mfma_f32_16x16x32_bf16 v[16:19], v[224:227], a[72:75], v[16:19]
v_and_b32 v114, 0xffff0000, v54
v_lshlrev_b32 v115, 16, v70
v_mfma_f32_16x16x32_bf16 v[16:19], v[240:243], a[76:79], v[16:19]
buffer_load_dwordx4 v[100:103], v1, s[44:47], s79 offen offset:1024 sc1
v_mfma_f32_16x16x32_bf16 v[32:35], v[240:243], a[92:95], v[32:35]
s_nop 0
ds_read_b64_tr_b16 v[136:137], v10 offset:49152
ds_read_b64_tr_b16 v[138:139], v10 offset:51200
v_mfma_f32_16x16x32_bf16 v[32:35], v[224:227], a[88:91], v[32:35]
s_nop 0
ds_read_b64_tr_b16 v[140:141], v11 offset:49152
ds_read_b64_tr_b16 v[142:143], v11 offset:51200
v_mfma_f32_16x16x32_bf16 v[32:35], v[208:211], a[84:87], v[32:35]
v_lshlrev_b32 v54, 16, v54
v_and_b32 v70, 0xffff0000, v70
v_mfma_f32_16x16x32_bf16 v[32:35], v[192:195], a[80:83], v[32:35]
s_nop 0
ds_read_b64_tr_b16 v[144:145], v8 offset:53248
ds_read_b64_tr_b16 v[146:147], v8 offset:55296
v_mfma_f32_16x16x32_bf16 v[36:39], v[196:199], a[80:83], v[36:39]
buffer_load_dwordx4 v[104:107], v1, s[44:47], s79 offen offset:2048 sc1
v_mfma_f32_16x16x32_bf16 v[36:39], v[212:215], a[84:87], v[36:39]
s_nop 0
ds_read_b64_tr_b16 v[148:149], v9 offset:53248
ds_read_b64_tr_b16 v[150:151], v9 offset:55296
v_mfma_f32_16x16x32_bf16 v[36:39], v[228:231], a[88:91], v[36:39]
v_mul_f32 v54, v54, v112
v_mul_f32 v114, v114, v112
v_mfma_f32_16x16x32_bf16 v[36:39], v[244:247], a[92:95], v[36:39]
s_nop 0
ds_read_b64_tr_b16 v[152:153], v10 offset:53248
ds_read_b64_tr_b16 v[154:155], v10 offset:55296
v_mfma_f32_16x16x32_bf16 v[20:23], v[244:247], a[76:79], v[20:23]
s_nop 0
ds_read_b64_tr_b16 v[156:157], v11 offset:53248
ds_read_b64_tr_b16 v[158:159], v11 offset:55296
v_mfma_f32_16x16x32_bf16 v[20:23], v[228:231], a[72:75], v[20:23]
buffer_load_dwordx4 v[108:111], v1, s[44:47], s79 offen offset:3072 sc1
v_mfma_f32_16x16x32_bf16 v[20:23], v[212:215], a[68:71], v[20:23]
v_mul_f32 v54, v54, v115
v_mul_f32 v70, v70, v114
v_mfma_f32_16x16x32_bf16 v[20:23], v[196:199], a[64:67], v[20:23]
s_nop 0
ds_read_b64_tr_b16 v[160:161], v8 offset:57344
ds_read_b64_tr_b16 v[162:163], v8 offset:59392
v_mfma_f32_16x16x32_bf16 v[24:27], v[200:203], a[64:67], v[24:27]
s_nop 0
ds_read_b64_tr_b16 v[164:165], v9 offset:57344
ds_read_b64_tr_b16 v[166:167], v9 offset:59392
v_mfma_f32_16x16x32_bf16 v[24:27], v[216:219], a[68:71], v[24:27]
v_and_b32 v114, 0xffff0000, v55
v_lshlrev_b32 v115, 16, v71
v_mfma_f32_16x16x32_bf16 v[24:27], v[232:235], a[72:75], v[24:27]
s_nop 0
ds_read_b64_tr_b16 v[168:169], v10 offset:57344
ds_read_b64_tr_b16 v[170:171], v10 offset:59392
v_mfma_f32_16x16x32_bf16 v[24:27], v[248:251], a[76:79], v[24:27]
s_nop 0
ds_read_b64_tr_b16 v[172:173], v11 offset:57344
ds_read_b64_tr_b16 v[174:175], v11 offset:59392
v_mfma_f32_16x16x32_bf16 v[40:43], v[248:251], a[92:95], v[40:43]
v_lshlrev_b32 v55, 16, v55
v_and_b32 v71, 0xffff0000, v71
v_mfma_f32_16x16x32_bf16 v[40:43], v[232:235], a[88:91], v[40:43]
s_nop 0
ds_read_b64_tr_b16 v[176:177], v8 offset:61440
ds_read_b64_tr_b16 v[178:179], v8 offset:63488
v_mfma_f32_16x16x32_bf16 v[40:43], v[216:219], a[84:87], v[40:43]
s_nop 0
ds_read_b64_tr_b16 v[180:181], v9 offset:61440
ds_read_b64_tr_b16 v[182:183], v9 offset:63488
v_mfma_f32_16x16x32_bf16 v[40:43], v[200:203], a[80:83], v[40:43]
v_mul_f32 v55, v55, v112
v_mul_f32 v114, v114, v112
v_mfma_f32_16x16x32_bf16 v[44:47], v[204:207], a[80:83], v[44:47]
s_nop 0
ds_read_b64_tr_b16 v[184:185], v10 offset:61440
ds_read_b64_tr_b16 v[186:187], v10 offset:63488
v_mfma_f32_16x16x32_bf16 v[44:47], v[220:223], a[84:87], v[44:47]
s_nop 0
ds_read_b64_tr_b16 v[188:189], v11 offset:61440
ds_read_b64_tr_b16 v[190:191], v11 offset:63488
v_mfma_f32_16x16x32_bf16 v[44:47], v[236:239], a[88:91], v[44:47]
v_mul_f32 v55, v55, v115
v_mul_f32 v71, v71, v114
v_mfma_f32_16x16x32_bf16 v[44:47], v[252:255], a[92:95], v[44:47]
v_and_b32 v114, 0xffff0000, v56
v_lshlrev_b32 v115, 16, v72
v_mfma_f32_16x16x32_bf16 v[28:31], v[252:255], a[76:79], v[28:31]
v_xor_b32 v8, 0x10000, v8
v_lshlrev_b32 v56, 16, v56
v_mfma_f32_16x16x32_bf16 v[28:31], v[236:239], a[72:75], v[28:31]
v_xor_b32 v9, 0x10000, v9
v_and_b32 v72, 0xffff0000, v72
v_mfma_f32_16x16x32_bf16 v[28:31], v[220:223], a[68:71], v[28:31]
s_waitcnt lgkmcnt(0)
v_xor_b32 v10, 0x10000, v10
v_mul_f32 v56, v56, v113
v_mfma_f32_16x16x32_bf16 v[28:31], v[204:207], a[64:67], v[28:31]
v_xor_b32 v11, 0x10000, v11
v_mul_f32 v114, v114, v113
v_mfma_f32_16x16x32_bf16 v[16:19], v[128:131], a[96:99], v[16:19]
s_nop 0
ds_read_b64_tr_b16 v[192:193], v8 offset:0
ds_read_b64_tr_b16 v[194:195], v8 offset:2048
v_mfma_f32_16x16x32_bf16 v[16:19], v[144:147], a[100:103], v[16:19]
s_nop 0
ds_read_b64_tr_b16 v[196:197], v9 offset:0
ds_read_b64_tr_b16 v[198:199], v9 offset:2048
v_mfma_f32_16x16x32_bf16 v[16:19], v[160:163], a[104:107], v[16:19]
v_mul_f32 v56, v56, v115
v_mul_f32 v72, v72, v114
v_mfma_f32_16x16x32_bf16 v[16:19], v[176:179], a[108:111], v[16:19]
s_nop 0
ds_read_b64_tr_b16 v[200:201], v10 offset:0
ds_read_b64_tr_b16 v[202:203], v10 offset:2048
v_mfma_f32_16x16x32_bf16 v[32:35], v[176:179], a[124:127], v[32:35]
v_and_b32 v114, 0xffff0000, v57
v_lshlrev_b32 v115, 16, v73
v_mfma_f32_16x16x32_bf16 v[32:35], v[160:163], a[120:123], v[32:35]
s_nop 0
ds_read_b64_tr_b16 v[204:205], v11 offset:0
ds_read_b64_tr_b16 v[206:207], v11 offset:2048
v_mfma_f32_16x16x32_bf16 v[32:35], v[144:147], a[116:119], v[32:35]
s_nop 0
ds_read_b64_tr_b16 v[208:209], v8 offset:4096
ds_read_b64_tr_b16 v[210:211], v8 offset:6144
v_mfma_f32_16x16x32_bf16 v[32:35], v[128:131], a[112:115], v[32:35]
v_lshlrev_b32 v57, 16, v57
v_and_b32 v73, 0xffff0000, v73
v_mfma_f32_16x16x32_bf16 v[36:39], v[132:135], a[112:115], v[36:39]
s_nop 0
ds_read_b64_tr_b16 v[212:213], v9 offset:4096
ds_read_b64_tr_b16 v[214:215], v9 offset:6144
v_mfma_f32_16x16x32_bf16 v[36:39], v[148:151], a[116:119], v[36:39]
v_mul_f32 v57, v57, v113
v_mul_f32 v114, v114, v113
v_mfma_f32_16x16x32_bf16 v[36:39], v[164:167], a[120:123], v[36:39]
s_nop 0
ds_read_b64_tr_b16 v[216:217], v10 offset:4096
ds_read_b64_tr_b16 v[218:219], v10 offset:6144
v_mfma_f32_16x16x32_bf16 v[36:39], v[180:183], a[124:127], v[36:39]
s_nop 0
ds_read_b64_tr_b16 v[220:221], v11 offset:4096
ds_read_b64_tr_b16 v[222:223], v11 offset:6144
v_mfma_f32_16x16x32_bf16 v[20:23], v[180:183], a[108:111], v[20:23]
v_mul_f32 v57, v57, v115
v_mul_f32 v73, v73, v114
v_mfma_f32_16x16x32_bf16 v[20:23], v[164:167], a[104:107], v[20:23]
s_nop 0
ds_read_b64_tr_b16 v[224:225], v8 offset:8192
ds_read_b64_tr_b16 v[226:227], v8 offset:10240
v_mfma_f32_16x16x32_bf16 v[20:23], v[148:151], a[100:103], v[20:23]
v_and_b32 v114, 0xffff0000, v58
v_lshlrev_b32 v115, 16, v74
v_mfma_f32_16x16x32_bf16 v[20:23], v[132:135], a[96:99], v[20:23]
s_nop 0
ds_read_b64_tr_b16 v[228:229], v9 offset:8192
ds_read_b64_tr_b16 v[230:231], v9 offset:10240
v_mfma_f32_16x16x32_bf16 v[24:27], v[136:139], a[96:99], v[24:27]
s_nop 0
ds_read_b64_tr_b16 v[232:233], v10 offset:8192
ds_read_b64_tr_b16 v[234:235], v10 offset:10240
v_mfma_f32_16x16x32_bf16 v[24:27], v[152:155], a[100:103], v[24:27]
v_lshlrev_b32 v58, 16, v58
v_and_b32 v74, 0xffff0000, v74
v_mfma_f32_16x16x32_bf16 v[24:27], v[168:171], a[104:107], v[24:27]
s_nop 0
ds_read_b64_tr_b16 v[236:237], v11 offset:8192
ds_read_b64_tr_b16 v[238:239], v11 offset:10240
v_mfma_f32_16x16x32_bf16 v[24:27], v[184:187], a[108:111], v[24:27]
v_mul_f32 v58, v58, v113
v_mul_f32 v114, v114, v113
v_mfma_f32_16x16x32_bf16 v[40:43], v[184:187], a[124:127], v[40:43]
s_nop 0
ds_read_b64_tr_b16 v[240:241], v8 offset:12288
ds_read_b64_tr_b16 v[242:243], v8 offset:14336
v_mfma_f32_16x16x32_bf16 v[40:43], v[168:171], a[120:123], v[40:43]
s_nop 0
ds_read_b64_tr_b16 v[244:245], v9 offset:12288
ds_read_b64_tr_b16 v[246:247], v9 offset:14336
v_mfma_f32_16x16x32_bf16 v[40:43], v[152:155], a[116:119], v[40:43]
Lstube4:
s_cbranch_execz Lrete
v_mul_f32 v58, v58, v115
v_mul_f32 v74, v74, v114
v_mfma_f32_16x16x32_bf16 v[40:43], v[136:139], a[112:115], v[40:43]
s_nop 0
ds_read_b64_tr_b16 v[248:249], v10 offset:12288
ds_read_b64_tr_b16 v[250:251], v10 offset:14336
v_mfma_f32_16x16x32_bf16 v[44:47], v[140:143], a[112:115], v[44:47]
v_and_b32 v114, 0xffff0000, v59
v_lshlrev_b32 v115, 16, v75
v_mfma_f32_16x16x32_bf16 v[44:47], v[156:159], a[116:119], v[44:47]
s_nop 0
ds_read_b64_tr_b16 v[252:253], v11 offset:12288
ds_read_b64_tr_b16 v[254:255], v11 offset:14336
v_mfma_f32_16x16x32_bf16 v[44:47], v[172:175], a[120:123], v[44:47]
v_lshlrev_b32 v59, 16, v59
v_and_b32 v75, 0xffff0000, v75
v_mfma_f32_16x16x32_bf16 v[44:47], v[188:191], a[124:127], v[44:47]
s_waitcnt vmcnt(0)
v_max3_u32 v12, v96, v97, v98
v_max3_u32 v13, v99, v100, v101
v_mfma_f32_16x16x32_bf16 v[28:31], v[188:191], a[108:111], v[28:31]
v_max3_u32 v12, v12, v102, v103
v_max3_u32 v13, v13, v104, v105
v_mfma_f32_16x16x32_bf16 v[28:31], v[172:175], a[104:107], v[28:31]
v_max3_u32 v12, v12, v106, v107
v_max3_u32 v13, v13, v108, v109
v_mfma_f32_16x16x32_bf16 v[28:31], v[156:159], a[100:103], v[28:31]
s_waitcnt vmcnt(9) lgkmcnt(0)
v_max3_u32 v12, v12, v110, v111
v_mul_f32 v59, v59, v113
v_mfma_f32_16x16x32_bf16 v[28:31], v[140:143], a[96:99], v[28:31]
s_barrier
v_max_u32 v12, v12, v13
v_mul_f32 v114, v114, v113
v_mfma_f32_16x16x32_bf16 v[16:19], v[192:195], a[128:131], v[16:19]
v_cmp_le_u32 vcc, 0xff800000, v12
v_mul_f32 v59, v59, v115
v_mfma_f32_16x16x32_bf16 v[16:19], v[208:211], a[132:135], v[16:19]
s_nop 0
ds_read_b64_tr_b16 v[128:129], v8 offset:16384
ds_read_b64_tr_b16 v[130:131], v8 offset:18432
v_mfma_f32_16x16x32_bf16 v[16:19], v[224:227], a[136:139], v[16:19]
s_cbranch_vccnz Lxspin1
Lxback1:
ds_read_b64_tr_b16 v[132:133], v9 offset:16384
ds_read_b64_tr_b16 v[134:135], v9 offset:18432
v_mfma_f32_16x16x32_bf16 v[16:19], v[240:243], a[140:143], v[16:19]
v_mul_f32 v75, v75, v114
v_and_b32 v114, 0xffff0000, v60
v_mfma_f32_16x16x32_bf16 v[16:19], v[124:127], v[96:99], v[16:19]
s_nop 0
ds_read_b64_tr_b16 v[136:137], v10 offset:16384
ds_read_b64_tr_b16 v[138:139], v10 offset:18432
v_mfma_f32_16x16x32_bf16 v[32:35], v[240:243], a[156:159], v[32:35]
v_lshlrev_b32 v115, 16, v76
v_lshlrev_b32 v60, 16, v60
v_mfma_f32_16x16x32_bf16 v[32:35], v[224:227], a[152:155], v[32:35]
s_add_u32 s82, s93, 0x3e00000
buffer_load_dwordx4 v[80:83], v1, s[44:47], s82 offen sc1
v_mfma_f32_16x16x32_bf16 v[32:35], v[208:211], a[148:151], v[32:35]
s_nop 0
ds_read_b64_tr_b16 v[140:141], v11 offset:16384
ds_read_b64_tr_b16 v[142:143], v11 offset:18432
v_mfma_f32_16x16x32_bf16 v[32:35], v[192:195], a[144:147], v[32:35]
v_and_b32 v76, 0xffff0000, v76
v_mul_f32 v60, v60, v113
v_mfma_f32_16x16x32_bf16 v[32:35], v[124:127], v[104:107], v[32:35]
s_nop 0
ds_read_b64_tr_b16 v[144:145], v8 offset:20480
ds_read_b64_tr_b16 v[146:147], v8 offset:22528
v_mfma_f32_16x16x32_bf16 v[36:39], v[196:199], a[144:147], v[36:39]
v_mul_f32 v114, v114, v113
v_mul_f32 v60, v60, v115
v_mfma_f32_16x16x32_bf16 v[36:39], v[212:215], a[148:151], v[36:39]
buffer_load_dwordx4 v[84:87], v1, s[44:47], s82 offen offset:1024 sc1
v_mfma_f32_16x16x32_bf16 v[36:39], v[228:231], a[152:155], v[36:39]
s_nop 0
ds_read_b64_tr_b16 v[148:149], v9 offset:20480
ds_read_b64_tr_b16 v[150:151], v9 offset:22528
v_mfma_f32_16x16x32_bf16 v[36:39], v[244:247], a[156:159], v[36:39]
v_mul_f32 v76, v76, v114
v_and_b32 v114, 0xffff0000, v61
v_mfma_f32_16x16x32_bf16 v[36:39], v[120:123], v[104:107], v[36:39]
s_nop 0
ds_read_b64_tr_b16 v[152:153], v10 offset:20480
ds_read_b64_tr_b16 v[154:155], v10 offset:22528
v_mfma_f32_16x16x32_bf16 v[20:23], v[244:247], a[140:143], v[20:23]
v_lshlrev_b32 v115, 16, v77
v_lshlrev_b32 v61, 16, v61
v_mfma_f32_16x16x32_bf16 v[20:23], v[228:231], a[136:139], v[20:23]
buffer_load_dwordx4 v[88:91], v1, s[44:47], s82 offen offset:2048 sc1
v_mfma_f32_16x16x32_bf16 v[20:23], v[212:215], a[132:135], v[20:23]
s_nop 0
ds_read_b64_tr_b16 v[156:157], v11 offset:20480
ds_read_b64_tr_b16 v[158:159], v11 offset:22528
v_mfma_f32_16x16x32_bf16 v[20:23], v[196:199], a[128:131], v[20:23]
v_and_b32 v77, 0xffff0000, v77
v_mul_f32 v61, v61, v113
v_mfma_f32_16x16x32_bf16 v[20:23], v[120:123], v[96:99], v[20:23]
s_nop 0
ds_read_b64_tr_b16 v[160:161], v8 offset:24576
ds_read_b64_tr_b16 v[162:163], v8 offset:26624
v_mfma_f32_16x16x32_bf16 v[24:27], v[200:203], a[128:131], v[24:27]
s_nop 0
ds_read_b64_tr_b16 v[164:165], v9 offset:24576
ds_read_b64_tr_b16 v[166:167], v9 offset:26624
v_mfma_f32_16x16x32_bf16 v[24:27], v[216:219], a[132:135], v[24:27]
buffer_load_dwordx4 v[92:95], v1, s[44:47], s82 offen offset:3072 sc1
v_mfma_f32_16x16x32_bf16 v[24:27], v[232:235], a[136:139], v[24:27]
v_mul_f32 v114, v114, v113
v_mul_f32 v61, v61, v115
v_mfma_f32_16x16x32_bf16 v[24:27], v[248:251], a[140:143], v[24:27]
s_nop 0
ds_read_b64_tr_b16 v[168:169], v10 offset:24576
ds_read_b64_tr_b16 v[170:171], v10 offset:26624
v_mfma_f32_16x16x32_bf16 v[24:27], v[124:127], v[100:103], v[24:27]
v_mul_f32 v77, v77, v114
v_and_b32 v114, 0xffff0000, v62
v_mfma_f32_16x16x32_bf16 v[40:43], v[248:251], a[156:159], v[40:43]
s_nop 0
ds_read_b64_tr_b16 v[172:173], v11 offset:24576
ds_read_b64_tr_b16 v[174:175], v11 offset:26624
v_mfma_f32_16x16x32_bf16 v[40:43], v[232:235], a[152:155], v[40:43]
v_lshlrev_b32 v115, 16, v78
v_lshlrev_b32 v62, 16, v62
v_mfma_f32_16x16x32_bf16 v[40:43], v[216:219], a[148:151], v[40:43]
s_nop 0
ds_read_b64_tr_b16 v[176:177], v8 offset:28672
ds_read_b64_tr_b16 v[178:179], v8 offset:30720
v_mfma_f32_16x16x32_bf16 v[40:43], v[200:203], a[144:147], v[40:43]
v_and_b32 v78, 0xffff0000, v78
v_mul_f32 v62, v62, v113
v_mfma_f32_16x16x32_bf16 v[40:43], v[124:127], v[108:111], v[40:43]
s_nop 0
ds_read_b64_tr_b16 v[180:181], v9 offset:28672
ds_read_b64_tr_b16 v[182:183], v9 offset:30720
v_mfma_f32_16x16x32_bf16 v[44:47], v[204:207], a[144:147], v[44:47]
v_mul_f32 v114, v114, v113
v_mul_f32 v62, v62, v115
v_mfma_f32_16x16x32_bf16 v[44:47], v[220:223], a[148:151], v[44:47]
s_nop 0
ds_read_b64_tr_b16 v[184:185], v10 offset:28672
ds_read_b64_tr_b16 v[186:187], v10 offset:30720
v_mfma_f32_16x16x32_bf16 v[44:47], v[236:239], a[152:155], v[44:47]
v_mul_f32 v78, v78, v114
v_and_b32 v114, 0xffff0000, v63
v_mfma_f32_16x16x32_bf16 v[44:47], v[252:255], a[156:159], v[44:47]
s_nop 0
ds_read_b64_tr_b16 v[188:189], v11 offset:28672
ds_read_b64_tr_b16 v[190:191], v11 offset:30720
v_mfma_f32_16x16x32_bf16 v[44:47], v[120:123], v[108:111], v[44:47]
v_lshlrev_b32 v115, 16, v79
v_lshlrev_b32 v63, 16, v63
v_mfma_f32_16x16x32_bf16 v[28:31], v[252:255], a[140:143], v[28:31]
v_and_b32 v79, 0xffff0000, v79
v_mul_f32 v63, v63, v113
v_mfma_f32_16x16x32_bf16 v[28:31], v[236:239], a[136:139], v[28:31]
v_mul_f32 v114, v114, v113
v_mul_f32 v63, v63, v115
v_mfma_f32_16x16x32_bf16 v[28:31], v[220:223], a[132:135], v[28:31]
v_mul_f32 v79, v79, v114
v_mfma_f32_16x16x32_bf16 v[28:31], v[204:207], a[128:131], v[28:31]
s_waitcnt lgkmcnt(0)
v_mfma_f32_16x16x32_bf16 v[28:31], v[120:123], v[100:103], v[28:31]
v_mfma_f32_16x16x32_bf16 v[16:19], v[128:131], a[160:163], v[16:19]
s_nop 0
ds_read_b64_tr_b16 v[192:193], v8 offset:32768
ds_read_b64_tr_b16 v[194:195], v8 offset:34816
v_mfma_f32_16x16x32_bf16 v[16:19], v[144:147], a[164:167], v[16:19]
s_nop 0
ds_read_b64_tr_b16 v[196:197], v9 offset:32768
ds_read_b64_tr_b16 v[198:199], v9 offset:34816
v_mfma_f32_16x16x32_bf16 v[16:19], v[160:163], a[168:171], v[16:19]
s_nop 0
ds_read_b64_tr_b16 v[200:201], v10 offset:32768
ds_read_b64_tr_b16 v[202:203], v10 offset:34816
v_mfma_f32_16x16x32_bf16 v[16:19], v[176:179], a[172:175], v[16:19]
v_mfma_f32_16x16x32_bf16 v[32:35], v[176:179], a[188:191], v[32:35]
s_nop 0
ds_read_b64_tr_b16 v[204:205], v11 offset:32768
ds_read_b64_tr_b16 v[206:207], v11 offset:34816
v_mfma_f32_16x16x32_bf16 v[32:35], v[160:163], a[184:187], v[32:35]
s_nop 0
ds_read_b64_tr_b16 v[208:209], v8 offset:36864
ds_read_b64_tr_b16 v[210:211], v8 offset:38912
v_mfma_f32_16x16x32_bf16 v[32:35], v[144:147], a[180:183], v[32:35]
s_add_u32 s81, s93, 0x4200000
buffer_load_dwordx4 v[96:99], v1, s[44:47], s81 offen sc1
v_mfma_f32_16x16x32_bf16 v[32:35], v[128:131], a[176:179], v[32:35]
v_mfma_f32_16x16x32_bf16 v[36:39], v[132:135], a[176:179], v[36:39]
s_nop 0
ds_read_b64_tr_b16 v[212:213], v9 offset:36864
ds_read_b64_tr_b16 v[214:215], v9 offset:38912
v_mfma_f32_16x16x32_bf16 v[36:39], v[148:151], a[180:183], v[36:39]
s_nop 0
ds_read_b64_tr_b16 v[216:217], v10 offset:36864
ds_read_b64_tr_b16 v[218:219], v10 offset:38912
v_mfma_f32_16x16x32_bf16 v[36:39], v[164:167], a[184:187], v[36:39]
v_mfma_f32_16x16x32_bf16 v[36:39], v[180:183], a[188:191], v[36:39]
buffer_load_dwordx4 v[100:103], v1, s[44:47], s81 offen offset:1024 sc1
v_mfma_f32_16x16x32_bf16 v[20:23], v[180:183], a[172:175], v[20:23]
s_nop 0
ds_read_b64_tr_b16 v[220:221], v11 offset:36864
ds_read_b64_tr_b16 v[222:223], v11 offset:38912
v_mfma_f32_16x16x32_bf16 v[20:23], v[164:167], a[168:171], v[20:23]
s_nop 0
ds_read_b64_tr_b16 v[224:225], v8 offset:40960
ds_read_b64_tr_b16 v[226:227], v8 offset:43008
v_mfma_f32_16x16x32_bf16 v[20:23], v[148:151], a[164:167], v[20:23]
s_nop 0
ds_read_b64_tr_b16 v[228:229], v9 offset:40960
ds_read_b64_tr_b16 v[230:231], v9 offset:43008
v_mfma_f32_16x16x32_bf16 v[20:23], v[132:135], a[160:163], v[20:23]
v_mfma_f32_16x16x32_bf16 v[24:27], v[136:139], a[160:163], v[24:27]
buffer_load_dwordx4 v[104:107], v1, s[44:47], s81 offen offset:2048 sc1
v_mfma_f32_16x16x32_bf16 v[24:27], v[152:155], a[164:167], v[24:27]
s_nop 0
ds_read_b64_tr_b16 v[232:233], v10 offset:40960
ds_read_b64_tr_b16 v[234:235], v10 offset:43008
v_mfma_f32_16x16x32_bf16 v[24:27], v[168:171], a[168:171], v[24:27]
s_nop 0
ds_read_b64_tr_b16 v[236:237], v11 offset:40960
ds_read_b64_tr_b16 v[238:239], v11 offset:43008
v_mfma_f32_16x16x32_bf16 v[24:27], v[184:187], a[172:175], v[24:27]
v_mfma_f32_16x16x32_bf16 v[40:43], v[184:187], a[188:191], v[40:43]
s_nop 0
ds_read_b64_tr_b16 v[240:241], v8 offset:45056
ds_read_b64_tr_b16 v[242:243], v8 offset:47104
v_mfma_f32_16x16x32_bf16 v[40:43], v[168:171], a[184:187], v[40:43]
buffer_load_dwordx4 v[108:111], v1, s[44:47], s81 offen offset:3072 sc1
v_mfma_f32_16x16x32_bf16 v[40:43], v[152:155], a[180:183], v[40:43]
s_nop 0
ds_read_b64_tr_b16 v[244:245], v9 offset:45056
ds_read_b64_tr_b16 v[246:247], v9 offset:47104
v_mfma_f32_16x16x32_bf16 v[40:43], v[136:139], a[176:179], v[40:43]
v_mfma_f32_16x16x32_bf16 v[44:47], v[140:143], a[176:179], v[44:47]
s_nop 0
ds_read_b64_tr_b16 v[248:249], v10 offset:45056
ds_read_b64_tr_b16 v[250:251], v10 offset:47104
v_mfma_f32_16x16x32_bf16 v[44:47], v[156:159], a[180:183], v[44:47]
s_nop 0
ds_read_b64_tr_b16 v[252:253], v11 offset:45056
ds_read_b64_tr_b16 v[254:255], v11 offset:47104
v_mfma_f32_16x16x32_bf16 v[44:47], v[172:175], a[184:187], v[44:47]
v_mfma_f32_16x16x32_bf16 v[44:47], v[188:191], a[188:191], v[44:47]
s_waitcnt vmcnt(4)
v_max3_u32 v12, v80, v81, v82
v_max3_u32 v13, v83, v84, v85
v_mfma_f32_16x16x32_bf16 v[28:31], v[188:191], a[172:175], v[28:31]
v_max3_u32 v12, v12, v86, v87
v_max3_u32 v13, v13, v88, v89
v_mfma_f32_16x16x32_bf16 v[28:31], v[172:175], a[168:171], v[28:31]
v_max3_u32 v12, v12, v90, v91
v_max3_u32 v13, v13, v92, v93
v_mfma_f32_16x16x32_bf16 v[28:31], v[156:159], a[164:167], v[28:31]
s_waitcnt vmcnt(12) lgkmcnt(0)
v_max3_u32 v12, v12, v94, v95
v_mfma_f32_16x16x32_bf16 v[28:31], v[140:143], a[160:163], v[28:31]
s_barrier
v_max_u32 v12, v12, v13
v_mfma_f32_16x16x32_bf16 v[16:19], v[192:195], a[192:195], v[16:19]
v_cmp_le_u32 vcc, 0xff800000, v12
v_mfma_f32_16x16x32_bf16 v[16:19], v[208:211], a[196:199], v[16:19]
s_nop 0
ds_read_b64_tr_b16 v[128:129], v8 offset:49152
ds_read_b64_tr_b16 v[130:131], v8 offset:51200
v_mfma_f32_16x16x32_bf16 v[16:19], v[224:227], a[200:203], v[16:19]
s_cbranch_vccnz Lxspin2
Lxback2:
v_mfma_f32_16x16x32_bf16 v[16:19], v[240:243], a[204:207], v[16:19]
s_nop 0
ds_read_b64_tr_b16 v[132:133], v9 offset:49152
ds_read_b64_tr_b16 v[134:135], v9 offset:51200
v_mfma_f32_16x16x32_bf16 v[16:19], v[124:127], v[80:83], v[16:19]
v_mfma_f32_16x16x32_bf16 v[32:35], v[240:243], a[220:223], v[32:35]
s_nop 0
ds_read_b64_tr_b16 v[136:137], v10 offset:49152
ds_read_b64_tr_b16 v[138:139], v10 offset:51200
v_mfma_f32_16x16x32_bf16 v[32:35], v[224:227], a[216:219], v[32:35]
v_mfma_f32_16x16x32_bf16 v[32:35], v[208:211], a[212:215], v[32:35]
s_nop 0
ds_read_b64_tr_b16 v[140:141], v11 offset:49152
ds_read_b64_tr_b16 v[142:143], v11 offset:51200
v_mfma_f32_16x16x32_bf16 v[32:35], v[192:195], a[208:211], v[32:35]
v_mfma_f32_16x16x32_bf16 v[32:35], v[124:127], v[88:91], v[32:35]
s_nop 0
ds_read_b64_tr_b16 v[144:145], v8 offset:53248
ds_read_b64_tr_b16 v[146:147], v8 offset:55296
v_mfma_f32_16x16x32_bf16 v[36:39], v[196:199], a[208:211], v[36:39]
v_mfma_f32_16x16x32_bf16 v[36:39], v[212:215], a[212:215], v[36:39]
s_nop 0
ds_read_b64_tr_b16 v[148:149], v9 offset:53248
ds_read_b64_tr_b16 v[150:151], v9 offset:55296
v_mfma_f32_16x16x32_bf16 v[36:39], v[228:231], a[216:219], v[36:39]
v_mfma_f32_16x16x32_bf16 v[36:39], v[244:247], a[220:223], v[36:39]
s_nop 0
ds_read_b64_tr_b16 v[152:153], v10 offset:53248
ds_read_b64_tr_b16 v[154:155], v10 offset:55296
v_mfma_f32_16x16x32_bf16 v[36:39], v[120:123], v[88:91], v[36:39]
v_mfma_f32_16x16x32_bf16 v[20:23], v[244:247], a[204:207], v[20:23]
s_nop 0
ds_read_b64_tr_b16 v[156:157], v11 offset:53248
ds_read_b64_tr_b16 v[158:159], v11 offset:55296
v_mfma_f32_16x16x32_bf16 v[20:23], v[228:231], a[200:203], v[20:23]
v_mfma_f32_16x16x32_bf16 v[20:23], v[212:215], a[196:199], v[20:23]
v_mfma_f32_16x16x32_bf16 v[20:23], v[196:199], a[192:195], v[20:23]
s_nop 0
ds_read_b64_tr_b16 v[160:161], v8 offset:57344
ds_read_b64_tr_b16 v[162:163], v8 offset:59392
v_mfma_f32_16x16x32_bf16 v[20:23], v[120:123], v[80:83], v[20:23]
v_mfma_f32_16x16x32_bf16 v[24:27], v[200:203], a[192:195], v[24:27]
s_nop 0
ds_read_b64_tr_b16 v[164:165], v9 offset:57344
ds_read_b64_tr_b16 v[166:167], v9 offset:59392
v_mfma_f32_16x16x32_bf16 v[24:27], v[216:219], a[196:199], v[24:27]
v_mfma_f32_16x16x32_bf16 v[24:27], v[232:235], a[200:203], v[24:27]
s_nop 0
ds_read_b64_tr_b16 v[168:169], v10 offset:57344
ds_read_b64_tr_b16 v[170:171], v10 offset:59392
v_mfma_f32_16x16x32_bf16 v[24:27], v[248:251], a[204:207], v[24:27]
v_mfma_f32_16x16x32_bf16 v[24:27], v[124:127], v[84:87], v[24:27]
s_nop 0
ds_read_b64_tr_b16 v[172:173], v11 offset:57344
ds_read_b64_tr_b16 v[174:175], v11 offset:59392
v_mfma_f32_16x16x32_bf16 v[40:43], v[248:251], a[220:223], v[40:43]
v_mfma_f32_16x16x32_bf16 v[40:43], v[232:235], a[216:219], v[40:43]
s_nop 0
ds_read_b64_tr_b16 v[176:177], v8 offset:61440
ds_read_b64_tr_b16 v[178:179], v8 offset:63488
v_mfma_f32_16x16x32_bf16 v[40:43], v[216:219], a[212:215], v[40:43]
v_mfma_f32_16x16x32_bf16 v[40:43], v[200:203], a[208:211], v[40:43]
s_nop 0
ds_read_b64_tr_b16 v[180:181], v9 offset:61440
ds_read_b64_tr_b16 v[182:183], v9 offset:63488
v_mfma_f32_16x16x32_bf16 v[40:43], v[124:127], v[92:95], v[40:43]
v_mfma_f32_16x16x32_bf16 v[44:47], v[204:207], a[208:211], v[44:47]
s_nop 0
ds_read_b64_tr_b16 v[184:185], v10 offset:61440
ds_read_b64_tr_b16 v[186:187], v10 offset:63488
v_mfma_f32_16x16x32_bf16 v[44:47], v[220:223], a[212:215], v[44:47]
v_mfma_f32_16x16x32_bf16 v[44:47], v[236:239], a[216:219], v[44:47]
s_nop 0
ds_read_b64_tr_b16 v[188:189], v11 offset:61440
ds_read_b64_tr_b16 v[190:191], v11 offset:63488
v_mfma_f32_16x16x32_bf16 v[44:47], v[252:255], a[220:223], v[44:47]
v_mfma_f32_16x16x32_bf16 v[44:47], v[120:123], v[92:95], v[44:47]
v_mfma_f32_16x16x32_bf16 v[28:31], v[252:255], a[204:207], v[28:31]
s_waitcnt vmcnt(0)
v_max3_u32 v12, v96, v97, v98
v_max3_u32 v13, v99, v100, v101
v_mfma_f32_16x16x32_bf16 v[28:31], v[236:239], a[200:203], v[28:31]
v_max3_u32 v12, v12, v102, v103
v_max3_u32 v13, v13, v104, v105
v_mfma_f32_16x16x32_bf16 v[28:31], v[220:223], a[196:199], v[28:31]
v_max3_u32 v12, v12, v106, v107
v_max3_u32 v13, v13, v108, v109
v_mfma_f32_16x16x32_bf16 v[28:31], v[204:207], a[192:195], v[28:31]
s_waitcnt lgkmcnt(0)
v_max3_u32 v12, v12, v110, v111
v_mfma_f32_16x16x32_bf16 v[28:31], v[120:123], v[84:87], v[28:31]
v_max_u32 v12, v12, v13
v_mfma_f32_16x16x32_bf16 v[16:19], v[128:131], a[224:227], v[16:19]
v_cmp_le_u32 vcc, 0xff800000, v12
v_mfma_f32_16x16x32_bf16 v[16:19], v[144:147], a[228:231], v[16:19]
v_mfma_f32_16x16x32_bf16 v[16:19], v[160:163], a[232:235], v[16:19]
s_cbranch_vccnz Lxspin3
Lxback3:
v_mfma_f32_16x16x32_bf16 v[16:19], v[176:179], a[236:239], v[16:19]
v_mfma_f32_16x16x32_bf16 v[16:19], v[124:127], v[96:99], v[16:19]
v_mfma_f32_16x16x32_bf16 v[20:23], v[180:183], a[236:239], v[20:23]
v_mfma_f32_16x16x32_bf16 v[20:23], v[164:167], a[232:235], v[20:23]
v_mfma_f32_16x16x32_bf16 v[20:23], v[148:151], a[228:231], v[20:23]
v_mfma_f32_16x16x32_bf16 v[20:23], v[132:135], a[224:227], v[20:23]
s_nop 3
v_fma_f32 v16, v16, v6, v48
v_fma_f32 v17, v17, v6, v64
v_mfma_f32_16x16x32_bf16 v[20:23], v[120:123], v[96:99], v[20:23]
v_fma_f32 v18, v18, v6, v49
v_fma_f32 v19, v19, v6, v65
v_mfma_f32_16x16x32_bf16 v[24:27], v[136:139], a[224:227], v[24:27]
v_cvt_pk_bf16_f32 v16, v16, v17
v_cvt_pk_bf16_f32 v17, v18, v19
v_mfma_f32_16x16x32_bf16 v[24:27], v[152:155], a[228:231], v[24:27]
ds_write_b64 v116, v[16:17] offset:0
v_mfma_f32_16x16x32_bf16 v[24:27], v[168:171], a[232:235], v[24:27]
v_mfma_f32_16x16x32_bf16 v[24:27], v[184:187], a[236:239], v[24:27]
v_fma_f32 v20, v20, v6, v50
v_fma_f32 v21, v21, v6, v66
v_mfma_f32_16x16x32_bf16 v[24:27], v[124:127], v[100:103], v[24:27]
v_fma_f32 v22, v22, v6, v51
v_fma_f32 v23, v23, v6, v67
v_mfma_f32_16x16x32_bf16 v[28:31], v[188:191], a[236:239], v[28:31]
v_cvt_pk_bf16_f32 v20, v20, v21
v_cvt_pk_bf16_f32 v21, v22, v23
v_mfma_f32_16x16x32_bf16 v[28:31], v[172:175], a[232:235], v[28:31]
ds_write_b64 v117, v[20:21] offset:0
v_mfma_f32_16x16x32_bf16 v[28:31], v[156:159], a[228:231], v[28:31]
v_mfma_f32_16x16x32_bf16 v[28:31], v[140:143], a[224:227], v[28:31]
v_fma_f32 v24, v24, v6, v52
v_fma_f32 v25, v25, v6, v68
v_mfma_f32_16x16x32_bf16 v[28:31], v[120:123], v[100:103], v[28:31]
v_fma_f32 v26, v26, v6, v53
v_fma_f32 v27, v27, v6, v69
v_mfma_f32_16x16x32_bf16 v[32:35], v[128:131], a[240:243], v[32:35]
v_cvt_pk_bf16_f32 v24, v24, v25
v_cvt_pk_bf16_f32 v25, v26, v27
v_mfma_f32_16x16x32_bf16 v[32:35], v[144:147], a[244:247], v[32:35]
ds_write_b64 v118, v[24:25] offset:0
v_mfma_f32_16x16x32_bf16 v[32:35], v[160:163], a[248:251], v[32:35]
v_mfma_f32_16x16x32_bf16 v[32:35], v[176:179], a[252:255], v[32:35]
v_fma_f32 v28, v28, v6, v54
v_fma_f32 v29, v29, v6, v70
v_mfma_f32_16x16x32_bf16 v[32:35], v[124:127], v[104:107], v[32:35]
v_fma_f32 v30, v30, v6, v55
v_fma_f32 v31, v31, v6, v71
v_mfma_f32_16x16x32_bf16 v[36:39], v[180:183], a[252:255], v[36:39]
v_cvt_pk_bf16_f32 v28, v28, v29
v_cvt_pk_bf16_f32 v29, v30, v31
v_mfma_f32_16x16x32_bf16 v[36:39], v[164:167], a[248:251], v[36:39]
s_nop 0
ds_write_b64 v119, v[28:29] offset:0
ds_read_b128 v[192:195], v4 offset:0
v_mfma_f32_16x16x32_bf16 v[36:39], v[148:151], a[244:247], v[36:39]
ds_read_b128 v[196:199], v4 offset:1024
v_mfma_f32_16x16x32_bf16 v[36:39], v[132:135], a[240:243], v[36:39]
v_fma_f32 v32, v32, v7, v56
v_fma_f32 v33, v33, v7, v72
v_mfma_f32_16x16x32_bf16 v[36:39], v[120:123], v[104:107], v[36:39]
v_fma_f32 v34, v34, v7, v57
v_fma_f32 v35, v35, v7, v73
v_mfma_f32_16x16x32_bf16 v[40:43], v[136:139], a[240:243], v[40:43]
v_cvt_pk_bf16_f32 v32, v32, v33
v_cvt_pk_bf16_f32 v33, v34, v35
v_mfma_f32_16x16x32_bf16 v[40:43], v[152:155], a[244:247], v[40:43]
ds_write_b64 v116, v[32:33] offset:2048
v_mfma_f32_16x16x32_bf16 v[40:43], v[168:171], a[248:251], v[40:43]
s_waitcnt lgkmcnt(2)
buffer_store_dwordx4 v[192:195], v15, s[40:43], s70 offen sc1
v_mfma_f32_16x16x32_bf16 v[40:43], v[184:187], a[252:255], v[40:43]
s_add_u32 s70, s70, 0x4000
v_mfma_f32_16x16x32_bf16 v[40:43], v[124:127], v[108:111], v[40:43]
v_fma_f32 v36, v36, v7, v58
v_fma_f32 v37, v37, v7, v74
v_mfma_f32_16x16x32_bf16 v[44:47], v[188:191], a[252:255], v[44:47]
v_fma_f32 v38, v38, v7, v59
v_fma_f32 v39, v39, v7, v75
v_mfma_f32_16x16x32_bf16 v[44:47], v[172:175], a[248:251], v[44:47]
v_cvt_pk_bf16_f32 v36, v36, v37
v_cvt_pk_bf16_f32 v37, v38, v39
v_mfma_f32_16x16x32_bf16 v[44:47], v[156:159], a[244:247], v[44:47]
ds_write_b64 v117, v[36:37] offset:2048
v_mfma_f32_16x16x32_bf16 v[44:47], v[140:143], a[240:243], v[44:47]
v_fma_f32 v40, v40, v7, v60
v_fma_f32 v41, v41, v7, v76
v_mfma_f32_16x16x32_bf16 v[44:47], v[120:123], v[108:111], v[44:47]
v_fma_f32 v42, v42, v7, v61
v_fma_f32 v43, v43, v7, v77
v_cvt_pk_bf16_f32 v40, v40, v41
v_cvt_pk_bf16_f32 v41, v42, v43
ds_write_b64 v118, v[40:41] offset:2048
s_waitcnt lgkmcnt(3)
buffer_store_dwordx4 v[196:199], v15, s[40:43], s70 offen sc1
s_add_u32 s70, s70, 0x4000
v_fma_f32 v44, v44, v7, v62
v_fma_f32 v45, v45, v7, v78
v_fma_f32 v46, v46, v7, v63
v_fma_f32 v47, v47, v7, v79
v_cvt_pk_bf16_f32 v44, v44, v45
v_cvt_pk_bf16_f32 v45, v46, v47
ds_write_b64 v119, v[44:45] offset:2048
ds_read_b128 v[200:203], v4 offset:2048
ds_read_b128 v[204:207], v4 offset:3072
s_waitcnt lgkmcnt(1)
buffer_store_dwordx4 v[200:203], v15, s[40:43], s70 offen sc1
s_add_u32 s70, s70, 0x4000
s_waitcnt lgkmcnt(0)
buffer_store_dwordx4 v[204:207], v15, s[40:43], s70 offen sc1
s_add_u32 s70, s70, 0x4000
Lend:
s_endpgm
Lspin1:
s_mov_b32 s83, 262144
Lsl3:
s_sleep 2
buffer_load_dword v3, v2, s[48:51], 0 offen sc1
s_sub_u32 s83, s83, 1
s_cmp_eq_u32 s83, 0
s_waitcnt vmcnt(0)
s_cbranch_scc1 Lback2
v_cmp_gt_u32 vcc, 8, v3
s_cbranch_vccnz Lsl3
s_branch Lback2
Lspin4:
s_mov_b32 s83, 262144
Lsl6:
s_sleep 2
buffer_load_dword v3, v2, s[44:47], s75 offen sc1
s_sub_u32 s83, s83, 1
s_cmp_eq_u32 s83, 0
s_waitcnt vmcnt(0)
s_cbranch_scc1 Lback5
v_cmp_gt_u32 vcc, 1, v3
s_cbranch_vccnz Lsl6
s_branch Lback5
.p2align 12
s_endpgm
.p2align 7
LP0x:
Lstub11:
s_cbranch_execz Lret
s_cmp_eq_u32 s58, 2
s_cbranch_scc1 Lta10
s_cmp_eq_u32 s58, 3
s_cbranch_scc1 Lnt11
v_mfma_f32_16x16x32_bf16 v[160:163], a[160:163], v[16:19], v[112:115]
s_xor_b32 s74, s82, 0x10000
v_exp_f32 v128, v128
v_mfma_f32_16x16x32_bf16 v[176:179], a[176:179], v[16:19], v[112:115]
s_add_u32 s74, s74, s64
ds_read_b128 a[128:131], v2 offset:16384
ds_read_b128 a[132:135], v2 offset:17408
s_branch Ljoin12
Lta10:
v_mfma_f32_16x16x32_bf16 v[160:163], a[160:163], v[16:19], v[96:99]
s_xor_b32 s74, s82, 0x10000
v_exp_f32 v128, v128
v_mfma_f32_16x16x32_bf16 v[176:179], a[176:179], v[16:19], v[112:115]
s_add_u32 s74, s74, s64
ds_read_b128 a[128:131], v2 offset:16384
ds_read_b128 a[132:135], v2 offset:17408
s_branch Ljoin12
Lnt11:
v_mfma_f32_16x16x32_bf16 v[160:163], a[160:163], v[16:19], v[80:83]
s_xor_b32 s74, s82, 0x10000
v_exp_f32 v128, v128
v_mfma_f32_16x16x32_bf16 v[176:179], a[176:179], v[16:19], v[96:99]
s_add_u32 s74, s74, s64
ds_read_b128 a[128:131], v2 offset:16384
ds_read_b128 a[132:135], v2 offset:17408
Ljoin12:
v_mfma_f32_16x16x32_bf16 v[164:167], a[160:163], v[32:35], v[84:87]
s_add_u32 s81, s81, 0x8000
v_exp_f32 v129, v129
v_mfma_f32_16x16x32_bf16 v[164:167], a[164:167], v[36:39], v[164:167]
s_add_u32 m0, s74, 16384
v_exp_f32 v130, v130
v_mfma_f32_16x16x32_bf16 v[164:167], a[168:171], v[40:43], v[164:167]
s_add_u32 s72, s81, 16384
v_exp_f32 v131, v131
v_mfma_f32_16x16x32_bf16 v[164:167], a[172:175], v[44:47], v[164:167]
v_exp_f32 v144, v144
v_mfma_f32_16x16x32_bf16 v[172:175], a[172:175], v[76:79], v[92:95]
s_nop 0
ds_read_b128 a[136:139], v2 offset:18432
ds_read_b128 a[140:143], v2 offset:19456
v_mfma_f32_16x16x32_bf16 v[172:175], a[168:171], v[72:75], v[172:175]
s_nop 0
ds_read_b128 a[144:147], v2 offset:20480
ds_read_b128 a[148:151], v2 offset:21504
v_mfma_f32_16x16x32_bf16 v[172:175], a[164:167], v[68:71], v[172:175]
s_nop 0
ds_read_b128 a[152:155], v2 offset:22528
ds_read_b128 a[156:159], v2 offset:23552
v_mfma_f32_16x16x32_bf16 v[172:175], a[160:163], v[64:67], v[172:175]
s_nop 0
ds_read_b128 a[192:195], v2 offset:0
ds_read_b128 a[196:199], v2 offset:1024
v_mfma_f32_16x16x32_bf16 v[188:191], a[176:179], v[64:67], v[92:95]
s_nop 0
ds_read_b128 a[200:203], v2 offset:2048
ds_read_b128 a[204:207], v2 offset:3072
v_mfma_f32_16x16x32_bf16 v[188:191], a[180:183], v[68:71], v[188:191]
s_nop 0
ds_read_b128 a[208:211], v2 offset:4096
ds_read_b128 a[212:215], v2 offset:5120
v_mfma_f32_16x16x32_bf16 v[188:191], a[184:187], v[72:75], v[188:191]
s_nop 0
ds_read_b128 a[216:219], v2 offset:6144
ds_read_b128 a[220:223], v2 offset:7168
v_mfma_f32_16x16x32_bf16 v[188:191], a[188:191], v[76:79], v[188:191]
v_cvt_pk_bf16_f32 v192, v128, v129
v_cvt_pk_bf16_f32 v193, v130, v131
v_mfma_f32_16x16x32_bf16 v[180:183], a[188:191], v[44:47], v[84:87]
buffer_load_dwordx4 v1, s[44:47], s72 offen sc1 lds
v_mfma_f32_16x16x32_bf16 v[180:183], a[184:187], v[40:43], v[180:183]
v_exp_f32 v145, v145
v_mfma_f32_16x16x32_bf16 v[180:183], a[180:183], v[36:39], v[180:183]
v_exp_f32 v146, v146
v_mfma_f32_16x16x32_bf16 v[180:183], a[176:179], v[32:35], v[180:183]
v_exp_f32 v147, v147
v_mfma_f32_16x16x32_bf16 v[160:163], a[164:167], v[20:23], v[160:163]
v_exp_f32 v136, v136
v_mfma_f32_16x16x32_bf16 v[160:163], a[168:171], v[24:27], v[160:163]
v_cvt_pk_bf16_f32 v194, v144, v145
v_cvt_pk_bf16_f32 v195, v146, v147
v_mfma_f32_16x16x32_bf16 v[160:163], a[172:175], v[28:31], v[160:163]
v_exp_f32 v137, v137
v_mfma_f32_16x16x32_bf16 v[168:171], a[172:175], v[60:63], v[88:91]
v_exp_f32 v138, v138
v_mfma_f32_16x16x32_bf16 v[168:171], a[168:171], v[56:59], v[168:171]
v_exp_f32 v139, v139
v_mfma_f32_16x16x32_bf16 v[168:171], a[164:167], v[52:55], v[168:171]
v_exp_f32 v152, v152
v_mfma_f32_16x16x32_bf16 v[168:171], a[160:163], v[48:51], v[168:171]
v_cvt_pk_bf16_f32 v200, v136, v137
v_cvt_pk_bf16_f32 v201, v138, v139
v_mfma_f32_16x16x32_bf16 v[184:187], a[176:179], v[48:51], v[88:91]
buffer_load_dwordx4 v1, s[44:47], s72 offen offset:1024 sc1 lds
v_mfma_f32_16x16x32_bf16 v[184:187], a[180:183], v[52:55], v[184:187]
v_exp_f32 v153, v153
v_mfma_f32_16x16x32_bf16 v[184:187], a[184:187], v[56:59], v[184:187]
v_exp_f32 v154, v154
v_mfma_f32_16x16x32_bf16 v[184:187], a[188:191], v[60:63], v[184:187]
v_exp_f32 v155, v155
v_mfma_f32_16x16x32_bf16 v[176:179], a[188:191], v[28:31], v[176:179]
buffer_load_dwordx4 v1, s[44:47], s72 offen offset:2048 sc1 lds
v_mfma_f32_16x16x32_bf16 v[176:179], a[184:187], v[24:27], v[176:179]
buffer_load_dwordx4 v1, s[44:47], s72 offen offset:3072 sc1 lds
v_mfma_f32_16x16x32_bf16 v[176:179], a[180:183], v[20:23], v[176:179]
s_waitcnt lgkmcnt(4)
v_exp_f32 v132, v132
v_cvt_pk_bf16_f32 v202, v152, v153
v_cvt_pk_bf16_f32 v203, v154, v155
v_exp_f32 v133, v133
v_exp_f32 v134, v134
v_cvt_pk_bf16_f32 v196, v132, v133
v_exp_f32 v135, v135
v_exp_f32 v148, v148
v_cvt_pk_bf16_f32 v197, v134, v135
v_exp_f32 v149, v149
v_exp_f32 v150, v150
v_cvt_pk_bf16_f32 v198, v148, v149
v_exp_f32 v151, v151
v_exp_f32 v140, v140
v_cvt_pk_bf16_f32 v199, v150, v151
v_exp_f32 v141, v141
v_exp_f32 v142, v142
v_cvt_pk_bf16_f32 v204, v140, v141
v_exp_f32 v143, v143
v_exp_f32 v156, v156
v_cvt_pk_bf16_f32 v205, v142, v143
v_exp_f32 v157, v157
v_exp_f32 v158, v158
v_cvt_pk_bf16_f32 v206, v156, v157
v_exp_f32 v159, v159
s_nop 0
v_cvt_pk_bf16_f32 v207, v158, v159
v_mfma_f32_16x16x32_bf16 v[224:227], v[120:123], v[192:195], 0
s_add_u32 s82, s82, 0x8000
ds_read_b128 a[160:163], v2 offset:24576
ds_read_b128 a[164:167], v2 offset:25600
v_mfma_f32_16x16x32_bf16 v[232:235], v[120:123], v[200:203], 0
s_and_b32 s82, s82, 0x1ffff
v_exp_f32 v164, v164
v_mfma_f32_16x16x32_bf16 a[0:3], a[192:195], v[192:195], 0
s_add_u32 m0, s74, 0
v_exp_f32 v165, v165
v_mfma_f32_16x16x32_bf16 a[64:67], a[192:195], v[200:203], 0
s_add_u32 s72, s81, 0
v_exp_f32 v166, v166
v_mfma_f32_16x16x32_bf16 a[68:71], a[196:199], v[200:203], 0
buffer_load_dwordx4 v1, s[44:47], s72 offen sc1 lds
v_mfma_f32_16x16x32_bf16 a[4:7], a[196:199], v[192:195], 0
v_exp_f32 v167, v167
v_mfma_f32_16x16x32_bf16 a[8:11], a[200:203], v[192:195], 0
s_nop 0
ds_read_b128 a[168:171], v2 offset:26624
ds_read_b128 a[172:175], v2 offset:27648
v_mfma_f32_16x16x32_bf16 a[72:75], a[200:203], v[200:203], 0
v_exp_f32 v180, v180
v_mfma_f32_16x16x32_bf16 a[76:79], a[204:207], v[200:203], 0
s_nop 0
ds_read_b128 a[176:179], v2 offset:28672
ds_read_b128 a[180:183], v2 offset:29696
v_mfma_f32_16x16x32_bf16 a[12:15], a[204:207], v[192:195], 0
s_waitcnt lgkmcnt(6)
ds_read_b128 a[184:187], v2 offset:30720
ds_read_b128 a[188:191], v2 offset:31744
v_mfma_f32_16x16x32_bf16 a[16:19], a[208:211], v[192:195], 0
s_nop 0
ds_read_b128 a[224:227], v2 offset:8192
ds_read_b128 a[228:231], v2 offset:9216
v_mfma_f32_16x16x32_bf16 a[80:83], a[208:211], v[200:203], 0
s_nop 0
ds_read_b128 a[232:235], v2 offset:10240
ds_read_b128 a[236:239], v2 offset:11264
v_mfma_f32_16x16x32_bf16 a[84:87], a[212:215], v[200:203], 0
s_nop 0
ds_read_b128 a[240:243], v2 offset:12288
ds_read_b128 a[244:247], v2 offset:13312
v_mfma_f32_16x16x32_bf16 a[20:23], a[212:215], v[192:195], 0
s_nop 0
ds_read_b128 a[248:251], v2 offset:14336
ds_read_b128 a[252:255], v2 offset:15360
v_mfma_f32_16x16x32_bf16 a[24:27], a[216:219], v[192:195], 0
v_cvt_pk_bf16_f32 v212, v164, v165
v_cvt_pk_bf16_f32 v213, v166, v167
v_mfma_f32_16x16x32_bf16 a[88:91], a[216:219], v[200:203], 0
v_exp_f32 v181, v181
v_mfma_f32_16x16x32_bf16 a[92:95], a[220:223], v[200:203], 0
v_exp_f32 v182, v182
v_mfma_f32_16x16x32_bf16 a[28:31], a[220:223], v[192:195], 0
buffer_load_dwordx4 v1, s[44:47], s72 offen offset:1024 sc1 lds
s_cmp_eq_u32 s58, 0
s_cbranch_scc1 Lta13
s_cmp_eq_u32 s58, 1
s_cbranch_scc1 Lnt14
v_mfma_f32_16x16x32_bf16 v[132:135], a[128:131], v[32:35], v[84:87]
v_exp_f32 v183, v183
v_mfma_f32_16x16x32_bf16 v[148:151], a[144:147], v[32:35], v[84:87]
v_exp_f32 v172, v172
s_branch Ljoin15
Lta13:
v_mfma_f32_16x16x32_bf16 v[132:135], a[128:131], v[32:35], v[100:103]
v_exp_f32 v183, v183
v_mfma_f32_16x16x32_bf16 v[148:151], a[144:147], v[32:35], v[112:115]
v_exp_f32 v172, v172
s_branch Ljoin15
Lnt14:
v_mfma_f32_16x16x32_bf16 v[132:135], a[128:131], v[32:35], v[84:87]
v_exp_f32 v183, v183
v_mfma_f32_16x16x32_bf16 v[148:151], a[144:147], v[32:35], v[100:103]
v_exp_f32 v172, v172
Ljoin15:
v_mfma_f32_16x16x32_bf16 v[136:139], a[128:131], v[48:51], v[88:91]
v_cvt_pk_bf16_f32 v214, v180, v181
v_cvt_pk_bf16_f32 v215, v182, v183
v_mfma_f32_16x16x32_bf16 v[136:139], a[132:135], v[52:55], v[136:139]
v_exp_f32 v173, v173
v_mfma_f32_16x16x32_bf16 v[136:139], a[136:139], v[56:59], v[136:139]
buffer_load_dwordx4 v1, s[44:47], s72 offen offset:2048 sc1 lds
v_mfma_f32_16x16x32_bf16 v[136:139], a[140:143], v[60:63], v[136:139]
v_exp_f32 v174, v174
v_mfma_f32_16x16x32_bf16 v[152:155], a[156:159], v[60:63], v[88:91]
v_exp_f32 v175, v175
v_mfma_f32_16x16x32_bf16 v[152:155], a[152:155], v[56:59], v[152:155]
v_exp_f32 v188, v188
v_mfma_f32_16x16x32_bf16 v[152:155], a[148:151], v[52:55], v[152:155]
v_cvt_pk_bf16_f32 v220, v172, v173
v_cvt_pk_bf16_f32 v221, v174, v175
v_mfma_f32_16x16x32_bf16 v[152:155], a[144:147], v[48:51], v[152:155]
v_exp_f32 v189, v189
v_mfma_f32_16x16x32_bf16 v[132:135], a[132:135], v[36:39], v[132:135]
buffer_load_dwordx4 v1, s[44:47], s72 offen offset:3072 sc1 lds
v_mfma_f32_16x16x32_bf16 v[132:135], a[136:139], v[40:43], v[132:135]
s_add_u32 s66, s58, 1
v_exp_f32 v190, v190
v_mfma_f32_16x16x32_bf16 v[132:135], a[140:143], v[44:47], v[132:135]
s_and_b32 s66, s66, 3
v_exp_f32 v191, v191
v_mfma_f32_16x16x32_bf16 v[140:143], a[140:143], v[76:79], v[92:95]
s_mul_i32 s66, s66, 4160
v_exp_f32 v160, v160
v_mfma_f32_16x16x32_bf16 v[140:143], a[136:139], v[72:75], v[140:143]
s_add_u32 m0, s66, 131104
v_cvt_pk_bf16_f32 v222, v188, v189
v_cvt_pk_bf16_f32 v223, v190, v191
v_mfma_f32_16x16x32_bf16 v[140:143], a[132:135], v[68:71], v[140:143]
s_add_u32 s72, s93, 0x2
v_exp_f32 v161, v161
v_mfma_f32_16x16x32_bf16 v[140:143], a[128:131], v[64:67], v[140:143]
buffer_load_dwordx4 v1, s[36:39], s72 offen lds
v_mfma_f32_16x16x32_bf16 v[156:159], a[144:147], v[64:67], v[92:95]
v_exp_f32 v162, v162
v_mfma_f32_16x16x32_bf16 v[156:159], a[148:151], v[68:71], v[156:159]
v_exp_f32 v163, v163
v_mfma_f32_16x16x32_bf16 v[156:159], a[152:155], v[72:75], v[156:159]
buffer_load_dwordx4 v1, s[36:39], s72 offen offset:1024 lds
v_mfma_f32_16x16x32_bf16 v[156:159], a[156:159], v[76:79], v[156:159]
buffer_load_dwordx4 v1, s[36:39], s72 offen offset:2048 lds
v_mfma_f32_16x16x32_bf16 v[148:151], a[156:159], v[44:47], v[148:151]
buffer_load_dwordx4 v1, s[36:39], s72 offen offset:3072 lds
v_mfma_f32_16x16x32_bf16 v[148:151], a[152:155], v[40:43], v[148:151]
s_waitcnt vmcnt(12) lgkmcnt(4)
v_exp_f32 v176, v176
v_mfma_f32_16x16x32_bf16 v[148:151], a[148:151], v[36:39], v[148:151]
s_barrier
v_cvt_pk_bf16_f32 v208, v160, v161
v_cvt_pk_bf16_f32 v209, v162, v163
v_add_u32 v2, s82, v1
v_exp_f32 v177, v177
v_exp_f32 v178, v178
v_cvt_pk_bf16_f32 v210, v176, v177
v_exp_f32 v179, v179
v_exp_f32 v168, v168
v_cvt_pk_bf16_f32 v211, v178, v179
v_exp_f32 v169, v169
v_exp_f32 v170, v170
v_cvt_pk_bf16_f32 v216, v168, v169
v_exp_f32 v171, v171
v_exp_f32 v184, v184
v_cvt_pk_bf16_f32 v217, v170, v171
v_exp_f32 v185, v185
v_exp_f32 v186, v186
v_cvt_pk_bf16_f32 v218, v184, v185
v_exp_f32 v187, v187
s_nop 0
v_cvt_pk_bf16_f32 v219, v186, v187
s_branch LLT3
.p2align 12
s_endpgm
.p2align 7
LLT3x:
Lstub12:
s_cbranch_execz Lret
v_mfma_f32_16x16x32_bf16 v[228:231], v[120:123], v[196:199], v[228:231]
s_xor_b32 s74, s82, 0x10000
ds_read_b128 a[128:131], v2 offset:16384
v_and_b32 v240, 15, v0
v_mfma_f32_16x16x32_bf16 v[228:231], v[120:123], v[212:215], v[228:231]
s_add_u32 s74, s74, s64
v_exp_f32 v136, v136
v_mfma_f32_16x16x32_bf16 v[236:239], v[120:123], v[204:207], v[236:239]
s_add_u32 s81, s81, 0x8000
v_exp_f32 v137, v137
v_mfma_f32_16x16x32_bf16 v[236:239], v[120:123], v[220:223], v[236:239]
s_add_u32 m0, s74, 0
ds_read_b128 a[132:135], v2 offset:17408
v_cvt_pk_bf16_f32 v200, v136, v137
v_mfma_f32_16x16x32_bf16 a[32:35], a[192:195], v[196:199], a[32:35]
s_add_u32 s72, s81, 0
buffer_load_dwordx4 v1, s[44:47], s72 offen sc1 lds
v_mfma_f32_16x16x32_bf16 a[32:35], a[224:227], v[212:215], a[32:35]
s_add_u32 s69, s93, 0x3e00000
v_exp_f32 v138, v138
v_mfma_f32_16x16x32_bf16 a[96:99], a[224:227], v[220:223], a[96:99]
ds_read_b128 a[136:139], v2 offset:18432
v_lshrrev_b32 v241, 4, v0
v_mfma_f32_16x16x32_bf16 a[96:99], a[192:195], v[204:207], a[96:99]
v_exp_f32 v139, v139
v_mfma_f32_16x16x32_bf16 a[100:103], a[196:199], v[204:207], a[100:103]
buffer_store_dwordx4 v[112:115], v1, s[44:47], s69 offen sc1
v_mfma_f32_16x16x32_bf16 a[100:103], a[228:231], v[220:223], a[100:103]
v_exp_f32 v152, v152
v_mfma_f32_16x16x32_bf16 a[36:39], a[228:231], v[212:215], a[36:39]
ds_read_b128 a[140:143], v2 offset:19456
v_cvt_pk_bf16_f32 v201, v138, v139
v_mfma_f32_16x16x32_bf16 a[36:39], a[196:199], v[196:199], a[36:39]
v_exp_f32 v153, v153
v_mfma_f32_16x16x32_bf16 a[40:43], a[200:203], v[196:199], a[40:43]
buffer_load_dwordx4 v1, s[44:47], s72 offen offset:1024 sc1 lds
v_mfma_f32_16x16x32_bf16 a[40:43], a[232:235], v[212:215], a[40:43]
ds_read_b128 a[144:147], v2 offset:20480
v_cvt_pk_bf16_f32 v202, v152, v153
v_mfma_f32_16x16x32_bf16 a[104:107], a[232:235], v[220:223], a[104:107]
v_exp_f32 v154, v154
v_mfma_f32_16x16x32_bf16 a[104:107], a[200:203], v[204:207], a[104:107]
v_exp_f32 v155, v155
v_mfma_f32_16x16x32_bf16 a[108:111], a[204:207], v[204:207], a[108:111]
buffer_store_dwordx4 v[112:115], v1, s[44:47], s69 offen offset:1024 sc1
v_mfma_f32_16x16x32_bf16 a[108:111], a[236:239], v[220:223], a[108:111]
ds_read_b128 a[148:151], v2 offset:21504
v_cvt_pk_bf16_f32 v203, v154, v155
v_mfma_f32_16x16x32_bf16 a[44:47], a[236:239], v[212:215], a[44:47]
v_exp_f32 v132, v132
v_mfma_f32_16x16x32_bf16 a[44:47], a[204:207], v[196:199], a[44:47]
ds_read_b128 a[152:155], v2 offset:22528
v_add_u32 v248, 1, v240
v_mfma_f32_16x16x32_bf16 a[48:51], a[208:211], v[196:199], a[48:51]
s_waitcnt lgkmcnt(7)
v_exp_f32 v133, v133
v_mfma_f32_16x16x32_bf16 a[48:51], a[240:243], v[212:215], a[48:51]
buffer_load_dwordx4 v1, s[44:47], s72 offen offset:2048 sc1 lds
v_mfma_f32_16x16x32_bf16 a[112:115], a[240:243], v[220:223], a[112:115]
v_exp_f32 v134, v134
v_mfma_f32_16x16x32_bf16 a[112:115], a[208:211], v[204:207], a[112:115]
ds_read_b128 a[156:159], v2 offset:23552
v_and_b32 v249, 3, v248
v_mfma_f32_16x16x32_bf16 a[116:119], a[212:215], v[204:207], a[116:119]
v_exp_f32 v135, v135
v_mfma_f32_16x16x32_bf16 a[116:119], a[244:247], v[220:223], a[116:119]
buffer_store_dwordx4 v[112:115], v1, s[44:47], s69 offen offset:2048 sc1
v_mfma_f32_16x16x32_bf16 a[52:55], a[244:247], v[212:215], a[52:55]
ds_read_b128 a[192:195], v2 offset:0
v_lshrrev_b32 v248, 2, v248
v_mfma_f32_16x16x32_bf16 a[52:55], a[212:215], v[196:199], a[52:55]
v_exp_f32 v148, v148
v_mfma_f32_16x16x32_bf16 a[56:59], a[216:219], v[196:199], a[56:59]
buffer_load_dwordx4 v1, s[44:47], s72 offen offset:3072 sc1 lds
v_mfma_f32_16x16x32_bf16 a[56:59], a[248:251], v[212:215], a[56:59]
v_exp_f32 v149, v149
v_mfma_f32_16x16x32_bf16 a[120:123], a[248:251], v[220:223], a[120:123]
ds_read_b128 a[196:199], v2 offset:1024
v_mov_b32 v250, 0x20000
v_mfma_f32_16x16x32_bf16 a[120:123], a[216:219], v[204:207], a[120:123]
v_exp_f32 v150, v150
v_mfma_f32_16x16x32_bf16 a[124:127], a[220:223], v[204:207], a[124:127]
ds_read_b128 a[200:203], v2 offset:2048
v_mov_b32 v252, 0x20001
v_mfma_f32_16x16x32_bf16 a[124:127], a[252:255], v[220:223], a[124:127]
buffer_store_dwordx4 v[112:115], v1, s[44:47], s69 offen offset:3072 sc1
v_mfma_f32_16x16x32_bf16 a[60:63], a[252:255], v[212:215], a[60:63]
s_add_u32 s69, s93, 0x4200000
v_exp_f32 v151, v151
v_mfma_f32_16x16x32_bf16 a[60:63], a[220:223], v[196:199], a[60:63]
ds_read_b128 a[204:207], v2 offset:3072
v_cvt_pk_bf16_f32 v196, v132, v133
s_cmp_eq_u32 s58, 2
s_cbranch_scc1 Lta40
s_cmp_eq_u32 s58, 3
s_cbranch_scc1 Lnt41
v_mfma_f32_16x16x32_bf16 v[164:167], a[160:163], v[32:35], v[112:115]
ds_read_b128 a[208:211], v2 offset:4096
v_cvt_pk_bf16_f32 v197, v134, v135
v_mfma_f32_16x16x32_bf16 v[180:183], a[176:179], v[32:35], v[112:115]
v_exp_f32 v140, v140
s_branch Ljoin42
Lta40:
v_mfma_f32_16x16x32_bf16 v[164:167], a[160:163], v[32:35], v[100:103]
ds_read_b128 a[208:211], v2 offset:4096
v_cvt_pk_bf16_f32 v197, v134, v135
v_mfma_f32_16x16x32_bf16 v[180:183], a[176:179], v[32:35], v[112:115]
v_exp_f32 v140, v140
s_branch Ljoin42
Lnt41:
v_mfma_f32_16x16x32_bf16 v[164:167], a[160:163], v[32:35], v[84:87]
ds_read_b128 a[208:211], v2 offset:4096
v_cvt_pk_bf16_f32 v197, v134, v135
v_mfma_f32_16x16x32_bf16 v[180:183], a[176:179], v[32:35], v[100:103]
v_exp_f32 v140, v140
Ljoin42:
v_mfma_f32_16x16x32_bf16 v[164:167], a[164:167], v[36:39], v[164:167]
ds_read_b128 a[212:215], v2 offset:5120
v_cvt_pk_bf16_f32 v198, v148, v149
v_mfma_f32_16x16x32_bf16 v[164:167], a[168:171], v[40:43], v[164:167]
buffer_store_dwordx4 v[112:115], v1, s[44:47], s69 offen sc1
v_mfma_f32_16x16x32_bf16 v[164:167], a[172:175], v[44:47], v[164:167]
v_exp_f32 v141, v141
v_mfma_f32_16x16x32_bf16 v[172:175], a[172:175], v[76:79], v[92:95]
v_exp_f32 v142, v142
v_mfma_f32_16x16x32_bf16 v[172:175], a[168:171], v[72:75], v[172:175]
ds_read_b128 a[216:219], v2 offset:6144
v_cvt_pk_bf16_f32 v199, v150, v151
v_mfma_f32_16x16x32_bf16 v[172:175], a[164:167], v[68:71], v[172:175]
buffer_store_dwordx4 v[112:115], v1, s[44:47], s69 offen offset:1024 sc1
v_mfma_f32_16x16x32_bf16 v[172:175], a[160:163], v[64:67], v[172:175]
v_exp_f32 v143, v143
v_mfma_f32_16x16x32_bf16 v[188:191], a[176:179], v[64:67], v[92:95]
v_exp_f32 v156, v156
v_mfma_f32_16x16x32_bf16 v[188:191], a[180:183], v[68:71], v[188:191]
ds_read_b128 a[220:223], v2 offset:7168
v_cvt_pk_bf16_f32 v204, v140, v141
v_mfma_f32_16x16x32_bf16 v[188:191], a[184:187], v[72:75], v[188:191]
buffer_store_dwordx4 v[112:115], v1, s[44:47], s69 offen offset:2048 sc1
v_mfma_f32_16x16x32_bf16 v[188:191], a[188:191], v[76:79], v[188:191]
v_exp_f32 v157, v157
v_mfma_f32_16x16x32_bf16 v[180:183], a[188:191], v[44:47], v[180:183]
v_exp_f32 v158, v158
v_mfma_f32_16x16x32_bf16 v[180:183], a[184:187], v[40:43], v[180:183]
v_cvt_pk_bf16_f32 v205, v142, v143
v_cvt_pk_bf16_f32 v206, v156, v157
v_mfma_f32_16x16x32_bf16 v[180:183], a[180:183], v[36:39], v[180:183]
buffer_store_dwordx4 v[112:115], v1, s[44:47], s69 offen offset:3072 sc1
v_mfma_f32_16x16x32_bf16 v[168:171], a[160:163], v[48:51], v[88:91]
v_exp_f32 v159, v159
v_mfma_f32_16x16x32_bf16 v[168:171], a[164:167], v[52:55], v[168:171]
v_cvt_pk_bf16_f32 v207, v158, v159
v_lshlrev_b32 v6, 3, v249
v_mfma_f32_16x16x32_bf16 v[168:171], a[168:171], v[56:59], v[168:171]
v_lshrrev_b32 v6, v6, v252
v_and_b32 v6, 3, v6
v_mfma_f32_16x16x32_bf16 v[168:171], a[172:175], v[60:63], v[168:171]
v_cmp_ne_u32 vcc, 1, v249
v_mul_u32_u24 v6, 16640, v6
v_mfma_f32_16x16x32_bf16 v[184:187], a[188:191], v[60:63], v[88:91]
v_add_u32 v6, s92, v6
v_cndmask_b32 v6, v250, v6, vcc
v_mfma_f32_16x16x32_bf16 v[184:187], a[184:187], v[56:59], v[184:187]
v_add_u32 v253, s58, v249
v_and_b32 v253, 3, v253
v_mfma_f32_16x16x32_bf16 v[184:187], a[180:183], v[52:55], v[184:187]
s_waitcnt lgkmcnt(4)
v_mfma_f32_16x16x32_bf16 v[184:187], a[176:179], v[48:51], v[184:187]
s_barrier
s_lshr_b32 s69, s93, 4
s_and_b32 s69, s69, 0x7f00
s_add_u32 s69, s69, LHT4-Lpc0
v_lshrrev_b32 v3, 5, v0
v_lshlrev_b32 v3, 7, v3
v_add_u32 v3, s69, v3
v_min_u32 v3, Lcode_end-Lpc0, v3
global_load_dword v4, v3, s[98:99]
v_mfma_f32_16x16x32_bf16 v[224:227], v[120:123], v[208:211], v[224:227]
s_add_u32 s82, s82, 0x8000
ds_read_b128 a[160:163], v2 offset:24576
ds_read_b128 a[164:167], v2 offset:25600
v_mfma_f32_16x16x32_bf16 v[232:235], v[120:123], v[216:219], v[232:235]
s_and_b32 s82, s82, 0x1ffff
v_exp_f32 v164, v164
v_mfma_f32_16x16x32_bf16 v[232:235], v[120:123], v[200:203], v[232:235]
s_add_u32 s66, s58, 3
v_exp_f32 v165, v165
v_mfma_f32_16x16x32_bf16 a[0:3], a[224:227], v[208:211], a[0:3]
s_and_b32 s66, s66, 3
v_exp_f32 v166, v166
v_mfma_f32_16x16x32_bf16 a[64:67], a[192:195], v[200:203], a[64:67]
s_mul_i32 s66, s66, 4160
ds_read_b128 a[168:171], v2 offset:26624
v_cvt_pk_bf16_f32 v212, v164, v165
v_mfma_f32_16x16x32_bf16 a[64:67], a[224:227], v[216:219], a[64:67]
s_add_u32 s66, s66, s92
v_exp_f32 v167, v167
v_mfma_f32_16x16x32_bf16 a[68:71], a[228:231], v[216:219], a[68:71]
s_add_u32 m0, s66, 32
v_exp_f32 v180, v180
v_mfma_f32_16x16x32_bf16 a[68:71], a[196:199], v[200:203], a[68:71]
s_add_u32 s72, s93, 0x6
buffer_load_dwordx4 v1, s[36:39], s72 offen lds
v_mfma_f32_16x16x32_bf16 a[4:7], a[228:231], v[208:211], a[4:7]
ds_read_b128 a[172:175], v2 offset:27648
v_cvt_pk_bf16_f32 v213, v166, v167
v_mfma_f32_16x16x32_bf16 a[8:11], a[232:235], v[208:211], a[8:11]
v_exp_f32 v181, v181
v_mfma_f32_16x16x32_bf16 a[72:75], a[200:203], v[200:203], a[72:75]
ds_read_b128 a[176:179], v2 offset:28672
v_cvt_pk_bf16_f32 v214, v180, v181
v_mfma_f32_16x16x32_bf16 a[72:75], a[232:235], v[216:219], a[72:75]
v_exp_f32 v182, v182
v_mfma_f32_16x16x32_bf16 a[76:79], a[236:239], v[216:219], a[76:79]
v_exp_f32 v183, v183
v_mfma_f32_16x16x32_bf16 a[76:79], a[204:207], v[200:203], a[76:79]
ds_read_b128 a[180:183], v2 offset:29696
v_cvt_pk_bf16_f32 v215, v182, v183
v_mfma_f32_16x16x32_bf16 a[12:15], a[236:239], v[208:211], a[12:15]
v_exp_f32 v172, v172
v_mfma_f32_16x16x32_bf16 a[16:19], a[240:243], v[208:211], a[16:19]
s_waitcnt lgkmcnt(6)
ds_read_b128 a[184:187], v2 offset:30720
ds_read_b128 a[188:191], v2 offset:31744
v_mfma_f32_16x16x32_bf16 a[80:83], a[208:211], v[200:203], a[80:83]
v_exp_f32 v173, v173
v_mfma_f32_16x16x32_bf16 a[80:83], a[240:243], v[216:219], a[80:83]
buffer_load_dwordx4 v1, s[36:39], s72 offen offset:1024 lds
v_mfma_f32_16x16x32_bf16 a[84:87], a[244:247], v[216:219], a[84:87]
v_exp_f32 v174, v174
v_mfma_f32_16x16x32_bf16 a[84:87], a[212:215], v[200:203], a[84:87]
v_exp_f32 v175, v175
v_mfma_f32_16x16x32_bf16 a[20:23], a[244:247], v[208:211], a[20:23]
ds_read_b128 a[224:227], v2 offset:8192
v_cvt_pk_bf16_f32 v220, v172, v173
v_mfma_f32_16x16x32_bf16 a[24:27], a[248:251], v[208:211], a[24:27]
v_exp_f32 v188, v188
v_mfma_f32_16x16x32_bf16 a[88:91], a[216:219], v[200:203], a[88:91]
v_exp_f32 v189, v189
v_mfma_f32_16x16x32_bf16 a[88:91], a[248:251], v[216:219], a[88:91]
ds_read_b128 a[228:231], v2 offset:9216
v_cvt_pk_bf16_f32 v221, v174, v175
v_mfma_f32_16x16x32_bf16 a[92:95], a[252:255], v[216:219], a[92:95]
v_exp_f32 v190, v190
v_mfma_f32_16x16x32_bf16 a[92:95], a[220:223], v[200:203], a[92:95]
ds_read_b128 a[232:235], v2 offset:10240
v_cvt_pk_bf16_f32 v222, v188, v189
v_mfma_f32_16x16x32_bf16 a[28:31], a[252:255], v[208:211], a[28:31]
v_exp_f32 v191, v191
s_cmp_eq_u32 s58, 0
s_cbranch_scc1 Lta43
s_cmp_eq_u32 s58, 1
s_cbranch_scc1 Lnt44
v_mfma_f32_16x16x32_bf16 v[136:139], a[128:131], v[48:51], v[88:91]
buffer_load_dwordx4 v1, s[36:39], s72 offen offset:2048 lds
v_mfma_f32_16x16x32_bf16 v[152:155], a[144:147], v[48:51], v[88:91]
v_exp_f32 v168, v168
s_branch Ljoin45
Lta43:
v_mfma_f32_16x16x32_bf16 v[136:139], a[128:131], v[48:51], v[104:107]
buffer_load_dwordx4 v1, s[36:39], s72 offen offset:2048 lds
v_mfma_f32_16x16x32_bf16 v[152:155], a[144:147], v[48:51], v[112:115]
v_exp_f32 v168, v168
s_branch Ljoin45
Lnt44:
v_mfma_f32_16x16x32_bf16 v[136:139], a[128:131], v[48:51], v[88:91]
buffer_load_dwordx4 v1, s[36:39], s72 offen offset:2048 lds
v_mfma_f32_16x16x32_bf16 v[152:155], a[144:147], v[48:51], v[104:107]
v_exp_f32 v168, v168
Ljoin45:
v_mfma_f32_16x16x32_bf16 v[136:139], a[132:135], v[52:55], v[136:139]
ds_read_b128 a[236:239], v2 offset:11264
v_cvt_pk_bf16_f32 v223, v190, v191
v_mfma_f32_16x16x32_bf16 v[136:139], a[136:139], v[56:59], v[136:139]
v_exp_f32 v169, v169
v_mfma_f32_16x16x32_bf16 v[136:139], a[140:143], v[60:63], v[136:139]
ds_read_b128 a[240:243], v2 offset:12288
v_cvt_pk_bf16_f32 v216, v168, v169
v_mfma_f32_16x16x32_bf16 v[152:155], a[156:159], v[60:63], v[152:155]
v_exp_f32 v170, v170
v_mfma_f32_16x16x32_bf16 v[152:155], a[152:155], v[56:59], v[152:155]
v_exp_f32 v171, v171
v_mfma_f32_16x16x32_bf16 v[152:155], a[148:151], v[52:55], v[152:155]
ds_read_b128 a[244:247], v2 offset:13312
v_cvt_pk_bf16_f32 v217, v170, v171
v_mfma_f32_16x16x32_bf16 v[140:143], a[128:131], v[64:67], v[92:95]
v_exp_f32 v184, v184
v_mfma_f32_16x16x32_bf16 v[140:143], a[132:135], v[68:71], v[140:143]
ds_read_b128 a[248:251], v2 offset:14336
v_mfma_f32_16x16x32_bf16 v[140:143], a[136:139], v[72:75], v[140:143]
v_exp_f32 v185, v185
v_mfma_f32_16x16x32_bf16 v[140:143], a[140:143], v[76:79], v[140:143]
buffer_load_dwordx4 v1, s[36:39], s72 offen offset:3072 lds
v_mfma_f32_16x16x32_bf16 v[156:159], a[156:159], v[76:79], v[92:95]
ds_read_b128 a[252:255], v2 offset:15360
v_cvt_pk_bf16_f32 v218, v184, v185
v_mfma_f32_16x16x32_bf16 v[156:159], a[152:155], v[72:75], v[156:159]
v_exp_f32 v186, v186
v_mfma_f32_16x16x32_bf16 v[156:159], a[148:151], v[68:71], v[156:159]
s_waitcnt vmcnt(17) lgkmcnt(0)
v_exp_f32 v187, v187
v_mfma_f32_16x16x32_bf16 v[156:159], a[144:147], v[64:67], v[156:159]
s_barrier
v_cvt_pk_bf16_f32 v219, v186, v187
v_add_u32 v2, s82, v1
v_mfma_f32_16x16x32_bf16 v[228:231], v[120:123], v[196:199], v[228:231]
s_mov_b32 m0, s62
v_exp_f32 v136, v136
v_mfma_f32_16x16x32_bf16 v[228:231], v[120:123], v[212:215], v[228:231]
s_add_u32 s72, s93, 0x3000000
ds_read_b128 a[128:131], v2 offset:16384
v_mul_u32_u24 v253, 4160, v253
v_mfma_f32_16x16x32_bf16 v[236:239], v[120:123], v[204:207], v[236:239]
buffer_load_dwordx4 v1, s[44:47], s72 offen sc1 lds
v_mfma_f32_16x16x32_bf16 v[236:239], v[120:123], v[220:223], v[236:239]
v_exp_f32 v137, v137
v_mfma_f32_16x16x32_bf16 a[32:35], a[192:195], v[196:199], a[32:35]
ds_read_b128 a[132:135], v2 offset:17408
v_cvt_pk_bf16_f32 v200, v136, v137
v_mfma_f32_16x16x32_bf16 a[32:35], a[224:227], v[212:215], a[32:35]
v_exp_f32 v138, v138
v_mfma_f32_16x16x32_bf16 a[96:99], a[224:227], v[220:223], a[96:99]
ds_read_b128 a[136:139], v2 offset:18432
v_add_u32 v6, v6, v253
v_mfma_f32_16x16x32_bf16 a[96:99], a[192:195], v[204:207], a[96:99]
buffer_load_dwordx4 v1, s[44:47], s72 offen offset:1024 sc1 lds
v_mfma_f32_16x16x32_bf16 a[100:103], a[196:199], v[204:207], a[100:103]
v_exp_f32 v139, v139
v_mfma_f32_16x16x32_bf16 a[100:103], a[228:231], v[220:223], a[100:103]
ds_read_b128 a[140:143], v2 offset:19456
v_cvt_pk_bf16_f32 v201, v138, v139
v_mfma_f32_16x16x32_bf16 a[36:39], a[228:231], v[212:215], a[36:39]
v_exp_f32 v152, v152
v_mfma_f32_16x16x32_bf16 a[36:39], a[196:199], v[196:199], a[36:39]
ds_read_b128 a[144:147], v2 offset:20480
v_bfe_u32 v251, v0, 2, 2
v_mfma_f32_16x16x32_bf16 a[40:43], a[200:203], v[196:199], a[40:43]
buffer_load_dwordx4 v1, s[44:47], s72 offen offset:2048 sc1 lds
v_mfma_f32_16x16x32_bf16 a[40:43], a[232:235], v[212:215], a[40:43]
v_exp_f32 v153, v153
v_mfma_f32_16x16x32_bf16 a[104:107], a[232:235], v[220:223], a[104:107]
ds_read_b128 a[148:151], v2 offset:21504
v_cvt_pk_bf16_f32 v202, v152, v153
v_mfma_f32_16x16x32_bf16 a[104:107], a[200:203], v[204:207], a[104:107]
buffer_load_dwordx4 v1, s[44:47], s72 offen offset:3072 sc1 lds
v_mfma_f32_16x16x32_bf16 a[108:111], a[204:207], v[204:207], a[108:111]
s_add_u32 s66, s58, 0
v_exp_f32 v154, v154
v_mfma_f32_16x16x32_bf16 a[108:111], a[236:239], v[220:223], a[108:111]
s_and_b32 s66, s66, 3
ds_read_b128 a[152:155], v2 offset:22528
v_lshl_add_u32 v6, v248, 3, v6
v_mfma_f32_16x16x32_bf16 a[44:47], a[236:239], v[212:215], a[44:47]
s_mul_i32 s66, s66, 4160
v_exp_f32 v155, v155
v_mfma_f32_16x16x32_bf16 a[44:47], a[204:207], v[196:199], a[44:47]
s_add_u32 s66, s66, s92
ds_read_b128 a[156:159], v2 offset:23552
v_cvt_pk_bf16_f32 v203, v154, v155
v_mfma_f32_16x16x32_bf16 a[48:51], a[208:211], v[196:199], a[48:51]
s_waitcnt lgkmcnt(8)
v_exp_f32 v140, v140
v_mfma_f32_16x16x32_bf16 a[48:51], a[240:243], v[212:215], a[48:51]
s_add_u32 m0, s66, 16672
ds_read_b128 a[192:195], v2 offset:0
v_lshl_add_u32 v6, v241, 4, v6
v_mfma_f32_16x16x32_bf16 a[112:115], a[240:243], v[220:223], a[112:115]
s_add_u32 s72, s93, 0x0
buffer_load_dwordx4 v1, s[36:39], s72 offen lds
v_mfma_f32_16x16x32_bf16 a[112:115], a[208:211], v[204:207], a[112:115]
buffer_load_dwordx4 v1, s[36:39], s72 offen offset:1024 lds
v_mfma_f32_16x16x32_bf16 a[116:119], a[212:215], v[204:207], a[116:119]
v_exp_f32 v141, v141
v_mfma_f32_16x16x32_bf16 a[116:119], a[244:247], v[220:223], a[116:119]
ds_read_b128 a[196:199], v2 offset:1024
v_lshlrev_b32 v5, 3, v251
v_mfma_f32_16x16x32_bf16 a[52:55], a[244:247], v[212:215], a[52:55]
v_exp_f32 v142, v142
v_mfma_f32_16x16x32_bf16 a[52:55], a[212:215], v[196:199], a[52:55]
ds_read_b128 a[200:203], v2 offset:2048
v_lshrrev_b32 v5, v5, v252
v_mfma_f32_16x16x32_bf16 a[56:59], a[216:219], v[196:199], a[56:59]
buffer_load_dwordx4 v1, s[36:39], s72 offen offset:2048 lds
v_mfma_f32_16x16x32_bf16 a[56:59], a[248:251], v[212:215], a[56:59]
v_exp_f32 v143, v143
v_mfma_f32_16x16x32_bf16 a[120:123], a[248:251], v[220:223], a[120:123]
ds_read_b128 a[204:207], v2 offset:3072
v_and_b32 v5, 3, v5
v_mfma_f32_16x16x32_bf16 a[120:123], a[216:219], v[204:207], a[120:123]
v_exp_f32 v156, v156
v_mfma_f32_16x16x32_bf16 a[124:127], a[220:223], v[204:207], a[124:127]
ds_read_b128 a[208:211], v2 offset:4096
v_cmp_ne_u32 vcc, 1, v251
v_mfma_f32_16x16x32_bf16 a[124:127], a[252:255], v[220:223], a[124:127]
buffer_load_dwordx4 v1, s[36:39], s72 offen offset:3072 lds
v_mfma_f32_16x16x32_bf16 a[60:63], a[252:255], v[212:215], a[60:63]
s_add_u32 s66, s58, 2
v_exp_f32 v157, v157
v_mfma_f32_16x16x32_bf16 a[60:63], a[220:223], v[196:199], a[60:63]
s_and_b32 s66, s66, 3
ds_read_b128 a[212:215], v2 offset:5120
v_cvt_pk_bf16_f32 v204, v140, v141
s_cmp_eq_u32 s58, 2
s_cbranch_scc1 Lta46
s_cmp_eq_u32 s58, 3
s_cbranch_scc1 Lnt47
v_mfma_f32_16x16x32_bf16 v[168:171], a[160:163], v[48:51], v[112:115]
s_mul_i32 s66, s66, 4160
v_exp_f32 v158, v158
v_mfma_f32_16x16x32_bf16 v[184:187], a[176:179], v[48:51], v[112:115]
s_add_u32 s66, s66, s92
ds_read_b128 a[216:219], v2 offset:6144
v_cvt_pk_bf16_f32 v205, v142, v143
s_branch Ljoin48
Lta46:
v_mfma_f32_16x16x32_bf16 v[168:171], a[160:163], v[48:51], v[104:107]
s_mul_i32 s66, s66, 4160
v_exp_f32 v158, v158
v_mfma_f32_16x16x32_bf16 v[184:187], a[176:179], v[48:51], v[112:115]
s_add_u32 s66, s66, s92
ds_read_b128 a[216:219], v2 offset:6144
v_cvt_pk_bf16_f32 v205, v142, v143
s_branch Ljoin48
Lnt47:
v_mfma_f32_16x16x32_bf16 v[168:171], a[160:163], v[48:51], v[88:91]
s_mul_i32 s66, s66, 4160
v_exp_f32 v158, v158
v_mfma_f32_16x16x32_bf16 v[184:187], a[176:179], v[48:51], v[104:107]
s_add_u32 s66, s66, s92
ds_read_b128 a[216:219], v2 offset:6144
v_cvt_pk_bf16_f32 v205, v142, v143
Ljoin48:
v_mfma_f32_16x16x32_bf16 v[172:175], a[160:163], v[64:67], v[92:95]
s_add_u32 m0, s66, 33312
v_exp_f32 v159, v159
v_mfma_f32_16x16x32_bf16 v[172:175], a[164:167], v[68:71], v[172:175]
s_add_u32 s72, s93, 0x4
buffer_load_dwordx4 v1, s[36:39], s72 offen lds
v_mfma_f32_16x16x32_bf16 v[172:175], a[168:171], v[72:75], v[172:175]
ds_read_b128 a[220:223], v2 offset:7168
v_cvt_pk_bf16_f32 v206, v156, v157
v_mfma_f32_16x16x32_bf16 v[172:175], a[172:175], v[76:79], v[172:175]
buffer_load_dwordx4 v1, s[36:39], s72 offen offset:1024 lds
v_mfma_f32_16x16x32_bf16 v[188:191], a[188:191], v[76:79], v[92:95]
v_cvt_pk_bf16_f32 v207, v158, v159
v_mul_u32_u24 v5, 16640, v5
v_mfma_f32_16x16x32_bf16 v[188:191], a[184:187], v[72:75], v[188:191]
v_add_u32 v5, s92, v5
v_cndmask_b32 v5, v250, v5, vcc
v_mfma_f32_16x16x32_bf16 v[188:191], a[180:183], v[68:71], v[188:191]
v_add_u32 v253, s58, v251
v_and_b32 v253, 3, v253
v_mfma_f32_16x16x32_bf16 v[188:191], a[176:179], v[64:67], v[188:191]
v_mul_u32_u24 v253, 4160, v253
v_add_u32 v5, v5, v253
v_mfma_f32_16x16x32_bf16 v[168:171], a[164:167], v[52:55], v[168:171]
s_add_u32 s73, s62, 480
v_lshlrev_b32 v248, 5, v240
v_sub_u32 v248, s73, v248
v_mfma_f32_16x16x32_bf16 v[168:171], a[168:171], v[56:59], v[168:171]
v_lshl_add_u32 v7, v241, 4, v248
v_mfma_f32_16x16x32_bf16 v[168:171], a[172:175], v[60:63], v[168:171]
s_and_b32 s73, s58, 1
v_mfma_f32_16x16x32_bf16 v[184:187], a[188:191], v[60:63], v[184:187]
s_lshl_b32 s73, s73, 4
v_mfma_f32_16x16x32_bf16 v[184:187], a[184:187], v[56:59], v[184:187]
s_lshr_b32 s73, s90, s73
v_mfma_f32_16x16x32_bf16 v[184:187], a[180:183], v[52:55], v[184:187]
s_waitcnt lgkmcnt(4)
s_and_b32 s73, s73, 0xffff
v_lshl_add_u32 v248, v241, 3, v240
v_sub_u32 v248, 15, v248
v_and_b32 v249, 1, v248
v_lshlrev_b32 v249, 4, v249
v_lshlrev_b32 v249, v249, s73
v_lshrrev_b32 v248, 1, v248
v_and_b32 v241, 3, v0
v_cmp_eq_u32 vcc, 0, v248
v_lshl_add_u32 v5, v241, 3, v5
s_nop 0
v_cndmask_b32 v8, 0, v249, vcc
v_cmp_eq_u32 vcc, 1, v248
v_lshlrev_b32 v240, 4, v251
s_nop 0
v_cndmask_b32 v9, 0, v249, vcc
v_cmp_eq_u32 vcc, 2, v248
v_sub_u32 v240, 48, v240
v_lshlrev_b64 v[12:13], 16, s[88:89]
v_cndmask_b32 v10, 0, v249, vcc
v_cmp_eq_u32 vcc, 3, v248
v_lshlrev_b64 v[12:13], v240, v[12:13]
s_nop 0
v_cndmask_b32 v11, 0, v249, vcc
v_cmp_eq_u32 vcc, 3, v241
s_add_u32 s73, s62, 4096
v_lshl_add_u32 v14, v0, 3, s73
v_cndmask_b32 v12, 0, v12, vcc
v_cndmask_b32 v13, 0, v13, vcc
v_lshrrev_b32 v15, 4, v0
v_lshlrev_b32 v15, 1, v15
v_and_b32 v240, 7, v0
v_xor_b32 v15, v15, v240
v_lshlrev_b32 v15, 4, v15
v_lshrrev_b32 v240, 3, v0
v_lshl_add_u32 v15, v240, 11, v15
s_lshl_b32 s75, s59, 1
s_andn2_b32 s75, 8, s75
s_add_u32 s75, s75, s60
s_lshl_b32 s76, s65, 2
s_lshr_b32 s80, s59, 3
s_add_u32 s76, s76, s80
s_lshl_b32 s94, s58, 16
s_lshl_b32 s80, s76, 7
s_add_u32 s94, s94, s80
s_lshl_b32 s80, s75, 18
s_add_u32 s80, s80, s94
v_rcp_f32 v226, v224
v_rcp_f32 v230, v228
s_lshl_b32 s73, s52, 12
s_add_u32 s73, s73, 0x2000000
s_lshl_b32 s70, s67, 2
s_add_u32 s70, s70, s73
v_or_b32 v3, s53, v1
v_mov_b32 v227, v226
v_accvgpr_read_b32 v240, a0
v_accvgpr_read_b32 v241, a1
v_accvgpr_read_b32 v242, a2
v_accvgpr_read_b32 v243, a3
v_accvgpr_read_b32 v244, a4
v_accvgpr_read_b32 v245, a5
v_accvgpr_read_b32 v246, a6
v_accvgpr_read_b32 v247, a7
v_pk_mul_f32 v[240:241], v[240:241], v[226:227]
v_pk_mul_f32 v[242:243], v[242:243], v[226:227]
v_pk_mul_f32 v[244:245], v[244:245], v[226:227]
buffer_load_dwordx4 v1, s[36:39], s72 offen offset:2048 lds
v_pk_mul_f32 v[246:247], v[246:247], v[226:227]
v_cvt_pk_bf16_f32 v128, v240, v241
v_cvt_pk_bf16_f32 v129, v242, v243
v_cvt_pk_bf16_f32 v130, v244, v245
v_cvt_pk_bf16_f32 v131, v246, v247
v_accvgpr_read_b32 v248, a8
v_accvgpr_read_b32 v249, a9
v_accvgpr_read_b32 v250, a10
v_accvgpr_read_b32 v251, a11
v_accvgpr_read_b32 v252, a12
v_accvgpr_read_b32 v253, a13
v_accvgpr_read_b32 v254, a14
v_accvgpr_read_b32 v255, a15
v_pk_mul_f32 v[248:249], v[248:249], v[226:227]
v_pk_mul_f32 v[250:251], v[250:251], v[226:227]
v_pk_mul_f32 v[252:253], v[252:253], v[226:227]
v_pk_mul_f32 v[254:255], v[254:255], v[226:227]
v_cvt_pk_bf16_f32 v144, v248, v249
buffer_load_dwordx4 v1, s[36:39], s72 offen offset:3072 lds
v_cvt_pk_bf16_f32 v145, v250, v251
v_cvt_pk_bf16_f32 v146, v252, v253
v_cvt_pk_bf16_f32 v147, v254, v255
v_accvgpr_read_b32 v240, a16
v_accvgpr_read_b32 v241, a17
v_accvgpr_read_b32 v242, a18
v_accvgpr_read_b32 v243, a19
v_accvgpr_read_b32 v244, a20
v_accvgpr_read_b32 v245, a21
v_accvgpr_read_b32 v246, a22
v_accvgpr_read_b32 v247, a23
v_pk_mul_f32 v[240:241], v[240:241], v[226:227]
v_pk_mul_f32 v[242:243], v[242:243], v[226:227]
v_pk_mul_f32 v[244:245], v[244:245], v[226:227]
v_pk_mul_f32 v[246:247], v[246:247], v[226:227]
v_cvt_pk_bf16_f32 v160, v240, v241
v_cvt_pk_bf16_f32 v161, v242, v243
v_cvt_pk_bf16_f32 v162, v244, v245
buffer_load_dwordx4 v[80:83], v15, s[4:7], s80 offen
v_cvt_pk_bf16_f32 v163, v246, v247
v_accvgpr_read_b32 v248, a24
v_accvgpr_read_b32 v249, a25
v_accvgpr_read_b32 v250, a26
v_accvgpr_read_b32 v251, a27
v_accvgpr_read_b32 v252, a28
v_accvgpr_read_b32 v253, a29
v_accvgpr_read_b32 v254, a30
v_accvgpr_read_b32 v255, a31
v_pk_mul_f32 v[248:249], v[248:249], v[226:227]
v_pk_mul_f32 v[250:251], v[250:251], v[226:227]
v_pk_mul_f32 v[252:253], v[252:253], v[226:227]
v_pk_mul_f32 v[254:255], v[254:255], v[226:227]
v_cvt_pk_bf16_f32 v176, v248, v249
v_cvt_pk_bf16_f32 v177, v250, v251
v_cvt_pk_bf16_f32 v178, v252, v253
v_cvt_pk_bf16_f32 v179, v254, v255
v_mov_b32 v231, v230
v_accvgpr_read_b32 v240, a32
s_add_u32 s80, s80, 0x4000
buffer_load_dwordx4 v[84:87], v15, s[4:7], s80 offen
v_accvgpr_read_b32 v241, a33
v_accvgpr_read_b32 v242, a34
v_accvgpr_read_b32 v243, a35
v_accvgpr_read_b32 v244, a36
v_accvgpr_read_b32 v245, a37
v_accvgpr_read_b32 v246, a38
v_accvgpr_read_b32 v247, a39
v_pk_mul_f32 v[240:241], v[240:241], v[230:231]
v_pk_mul_f32 v[242:243], v[242:243], v[230:231]
v_pk_mul_f32 v[244:245], v[244:245], v[230:231]
v_pk_mul_f32 v[246:247], v[246:247], v[230:231]
v_cvt_pk_bf16_f32 v132, v240, v241
v_cvt_pk_bf16_f32 v133, v242, v243
v_cvt_pk_bf16_f32 v134, v244, v245
v_cvt_pk_bf16_f32 v135, v246, v247
v_accvgpr_read_b32 v248, a40
v_accvgpr_read_b32 v249, a41
v_accvgpr_read_b32 v250, a42
s_add_u32 s80, s80, 0x4000
buffer_load_dwordx4 v[96:99], v15, s[4:7], s80 offen
v_accvgpr_read_b32 v251, a43
v_accvgpr_read_b32 v252, a44
v_accvgpr_read_b32 v253, a45
v_accvgpr_read_b32 v254, a46
v_accvgpr_read_b32 v255, a47
v_pk_mul_f32 v[248:249], v[248:249], v[230:231]
v_pk_mul_f32 v[250:251], v[250:251], v[230:231]
v_pk_mul_f32 v[252:253], v[252:253], v[230:231]
v_pk_mul_f32 v[254:255], v[254:255], v[230:231]
v_cvt_pk_bf16_f32 v148, v248, v249
v_cvt_pk_bf16_f32 v149, v250, v251
v_cvt_pk_bf16_f32 v150, v252, v253
v_cvt_pk_bf16_f32 v151, v254, v255
v_accvgpr_read_b32 v240, a48
v_accvgpr_read_b32 v241, a49
v_accvgpr_read_b32 v242, a50
v_accvgpr_read_b32 v243, a51
v_accvgpr_read_b32 v244, a52
s_add_u32 s80, s80, 0x4000
buffer_load_dwordx4 v[100:103], v15, s[4:7], s80 offen
v_accvgpr_read_b32 v245, a53
v_accvgpr_read_b32 v246, a54
v_accvgpr_read_b32 v247, a55
v_pk_mul_f32 v[240:241], v[240:241], v[230:231]
v_pk_mul_f32 v[242:243], v[242:243], v[230:231]
v_pk_mul_f32 v[244:245], v[244:245], v[230:231]
v_pk_mul_f32 v[246:247], v[246:247], v[230:231]
v_cvt_pk_bf16_f32 v164, v240, v241
v_cvt_pk_bf16_f32 v165, v242, v243
v_cvt_pk_bf16_f32 v166, v244, v245
v_cvt_pk_bf16_f32 v167, v246, v247
v_accvgpr_read_b32 v248, a56
v_accvgpr_read_b32 v249, a57
v_accvgpr_read_b32 v250, a58
v_accvgpr_read_b32 v251, a59
v_accvgpr_read_b32 v252, a60
v_accvgpr_read_b32 v253, a61
v_accvgpr_read_b32 v254, a62
v_accvgpr_read_b32 v255, a63
v_pk_mul_f32 v[248:249], v[248:249], v[230:231]
v_pk_mul_f32 v[250:251], v[250:251], v[230:231]
v_pk_mul_f32 v[252:253], v[252:253], v[230:231]
v_pk_mul_f32 v[254:255], v[254:255], v[230:231]
v_cvt_pk_bf16_f32 v180, v248, v249
v_cvt_pk_bf16_f32 v181, v250, v251
v_cvt_pk_bf16_f32 v182, v252, v253
v_cvt_pk_bf16_f32 v183, v254, v255
v_mfma_f32_16x16x32_bf16 v[232:235], v[120:123], v[216:219], v[232:235]
s_add_u32 s82, s82, 0x8000
ds_read_b128 a[160:163], v2 offset:24576
ds_read_b128 a[164:167], v2 offset:25600
v_mfma_f32_16x16x32_bf16 v[232:235], v[120:123], v[200:203], v[232:235]
s_and_b32 s82, s82, 0x1ffff
v_exp_f32 v172, v172
v_mfma_f32_16x16x32_bf16 a[64:67], a[224:227], v[216:219], a[64:67]
v_exp_f32 v173, v173
v_mfma_f32_16x16x32_bf16 a[64:67], a[192:195], v[200:203], a[64:67]
s_nop 0
ds_read_b128 a[168:171], v2 offset:26624
ds_read_b128 a[172:175], v2 offset:27648
v_mfma_f32_16x16x32_bf16 a[68:71], a[196:199], v[200:203], a[68:71]
v_exp_f32 v174, v174
v_mfma_f32_16x16x32_bf16 a[68:71], a[228:231], v[216:219], a[68:71]
v_exp_f32 v175, v175
v_mfma_f32_16x16x32_bf16 a[72:75], a[232:235], v[216:219], a[72:75]
buffer_store_dwordx4 v[128:131], v3, s[44:47], s70 offen sc1
v_mfma_f32_16x16x32_bf16 a[72:75], a[200:203], v[200:203], a[72:75]
s_nop 0
ds_read_b128 a[176:179], v2 offset:28672
ds_read_b128 a[180:183], v2 offset:29696
v_mfma_f32_16x16x32_bf16 a[76:79], a[204:207], v[200:203], a[76:79]
v_exp_f32 v188, v188
v_mfma_f32_16x16x32_bf16 a[76:79], a[236:239], v[216:219], a[76:79]
s_nop 0
ds_read_b128 a[184:187], v2 offset:30720
ds_read_b128 a[188:191], v2 offset:31744
v_mfma_f32_16x16x32_bf16 a[80:83], a[240:243], v[216:219], a[80:83]
s_waitcnt lgkmcnt(8)
ds_read_b128 a[224:227], v2 offset:8192
ds_read_b128 a[228:231], v2 offset:9216
v_mfma_f32_16x16x32_bf16 a[80:83], a[208:211], v[200:203], a[80:83]
s_nop 0
ds_read_b128 a[232:235], v2 offset:10240
ds_read_b128 a[236:239], v2 offset:11264
v_mfma_f32_16x16x32_bf16 a[84:87], a[212:215], v[200:203], a[84:87]
ds_read_b128 a[240:243], v2 offset:12288
v_cvt_pk_bf16_f32 v220, v172, v173
v_mfma_f32_16x16x32_bf16 a[84:87], a[244:247], v[216:219], a[84:87]
v_exp_f32 v189, v189
v_mfma_f32_16x16x32_bf16 a[88:91], a[248:251], v[216:219], a[88:91]
v_exp_f32 v190, v190
v_mfma_f32_16x16x32_bf16 a[88:91], a[216:219], v[200:203], a[88:91]
s_nop 0
ds_read_b128 a[244:247], v2 offset:13312
ds_read_b128 a[248:251], v2 offset:14336
v_mfma_f32_16x16x32_bf16 a[92:95], a[220:223], v[200:203], a[92:95]
v_cvt_pk_bf16_f32 v221, v174, v175
v_cvt_pk_bf16_f32 v222, v188, v189
v_mfma_f32_16x16x32_bf16 a[92:95], a[252:255], v[216:219], a[92:95]
v_exp_f32 v191, v191
s_cmp_eq_u32 s58, 0
s_cbranch_scc1 Lta49
s_cmp_eq_u32 s58, 1
s_cbranch_scc1 Lnt50
v_mfma_f32_16x16x32_bf16 v[140:143], a[128:131], v[64:67], v[92:95]
v_exp_f32 v168, v168
v_mfma_f32_16x16x32_bf16 v[156:159], a[144:147], v[64:67], v[92:95]
buffer_store_dwordx4 v[144:147], v3, s[44:47], s70 offen offset:1024 sc1
s_branch Ljoin51
Lta49:
v_mfma_f32_16x16x32_bf16 v[140:143], a[128:131], v[64:67], v[108:111]
v_exp_f32 v168, v168
v_mfma_f32_16x16x32_bf16 v[156:159], a[144:147], v[64:67], v[112:115]
buffer_store_dwordx4 v[144:147], v3, s[44:47], s70 offen offset:1024 sc1
s_branch Ljoin51
Lnt50:
v_mfma_f32_16x16x32_bf16 v[140:143], a[128:131], v[64:67], v[92:95]
v_exp_f32 v168, v168
v_mfma_f32_16x16x32_bf16 v[156:159], a[144:147], v[64:67], v[108:111]
buffer_store_dwordx4 v[144:147], v3, s[44:47], s70 offen offset:1024 sc1
Ljoin51:
v_mfma_f32_16x16x32_bf16 v[140:143], a[132:135], v[68:71], v[140:143]
v_exp_f32 v169, v169
v_mfma_f32_16x16x32_bf16 v[140:143], a[136:139], v[72:75], v[140:143]
v_exp_f32 v170, v170
v_mfma_f32_16x16x32_bf16 v[140:143], a[140:143], v[76:79], v[140:143]
buffer_store_dwordx4 v[160:163], v3, s[44:47], s70 offen offset:2048 sc1
v_mfma_f32_16x16x32_bf16 v[156:159], a[156:159], v[76:79], v[156:159]
ds_read_b128 a[252:255], v2 offset:15360
v_cvt_pk_bf16_f32 v223, v190, v191
v_mfma_f32_16x16x32_bf16 v[156:159], a[152:155], v[72:75], v[156:159]
s_waitcnt vmcnt(24) lgkmcnt(4)
v_exp_f32 v171, v171
v_mfma_f32_16x16x32_bf16 v[156:159], a[148:151], v[68:71], v[156:159]
s_barrier
v_exp_f32 v184, v184
v_add_u32 v2, s82, v1
v_cvt_pk_bf16_f32 v216, v168, v169
v_cvt_pk_bf16_f32 v217, v170, v171
v_exp_f32 v185, v185
v_exp_f32 v186, v186
v_cvt_pk_bf16_f32 v218, v184, v185
v_exp_f32 v187, v187
s_nop 0
v_cvt_pk_bf16_f32 v219, v186, v187
v_mfma_f32_16x16x32_bf16 v[236:239], v[120:123], v[204:207], v[236:239]
s_add_u32 s78, s59, 8
v_exp_f32 v140, v140
v_mfma_f32_16x16x32_bf16 v[236:239], v[120:123], v[220:223], v[236:239]
s_and_b32 s78, s78, 24
v_exp_f32 v141, v141
v_mfma_f32_16x16x32_bf16 a[96:99], a[192:195], v[204:207], a[96:99]
s_lshr_b32 s79, 0x67234501, s78
ds_read_b128 a[192:195], v2 offset:0
v_mfma_f32_16x16x32_bf16 a[96:99], a[224:227], v[220:223], a[96:99]
s_and_b32 s79, s79, 7
buffer_store_dwordx4 v[176:179], v3, s[44:47], s70 offen offset:3072 sc1
v_mfma_f32_16x16x32_bf16 a[100:103], a[228:231], v[220:223], a[100:103]
s_add_u32 s70, s70, 0x80000
v_exp_f32 v142, v142
v_mfma_f32_16x16x32_bf16 a[100:103], a[196:199], v[204:207], a[100:103]
s_lshl_b32 s79, s79, 18
ds_read_b128 a[196:199], v2 offset:1024
v_mfma_f32_16x16x32_bf16 a[104:107], a[200:203], v[204:207], a[104:107]
s_add_u32 s79, s79, s94
ds_read_b128 a[200:203], v2 offset:2048
v_mfma_f32_16x16x32_bf16 a[104:107], a[232:235], v[220:223], a[104:107]
s_add_u32 s12, s61, 0
v_exp_f32 v143, v143
v_mfma_f32_16x16x32_bf16 a[108:111], a[236:239], v[220:223], a[108:111]
s_and_b32 s12, s12, 3
v_exp_f32 v156, v156
v_mfma_f32_16x16x32_bf16 a[108:111], a[204:207], v[204:207], a[108:111]
s_lshl_b32 s12, s12, 21
ds_read_b128 a[204:207], v2 offset:3072
v_mfma_f32_16x16x32_bf16 a[112:115], a[208:211], v[204:207], a[112:115]
s_waitcnt lgkmcnt(4)
ds_read_b128 a[208:211], v2 offset:4096
v_mfma_f32_16x16x32_bf16 a[112:115], a[240:243], v[220:223], a[112:115]
s_add_u32 s12, s12, s79
buffer_store_dwordx4 v[132:135], v3, s[44:47], s70 offen sc1
v_mfma_f32_16x16x32_bf16 a[116:119], a[244:247], v[220:223], a[116:119]
s_add_u32 s13, s61, 1
v_exp_f32 v157, v157
v_mfma_f32_16x16x32_bf16 a[116:119], a[212:215], v[204:207], a[116:119]
s_and_b32 s13, s13, 3
ds_read_b128 a[212:215], v2 offset:5120
v_mfma_f32_16x16x32_bf16 a[120:123], a[216:219], v[204:207], a[120:123]
s_lshl_b32 s13, s13, 21
v_exp_f32 v158, v158
v_mfma_f32_16x16x32_bf16 a[120:123], a[248:251], v[220:223], a[120:123]
s_add_u32 s13, s13, s79
ds_read_b128 a[216:219], v2 offset:6144
v_mfma_f32_16x16x32_bf16 a[124:127], a[252:255], v[220:223], a[124:127]
s_add_u32 s14, s61, 2
buffer_store_dwordx4 v[148:151], v3, s[44:47], s70 offen offset:1024 sc1
v_mfma_f32_16x16x32_bf16 a[124:127], a[220:223], v[204:207], a[124:127]
s_and_b32 s14, s14, 3
ds_read_b128 a[220:223], v2 offset:7168
v_cvt_pk_bf16_f32 v204, v140, v141
s_cmp_eq_u32 s58, 2
s_cbranch_scc1 Lta52
s_cmp_eq_u32 s58, 3
s_cbranch_scc1 Lnt53
v_mfma_f32_16x16x32_bf16 v[172:175], a[160:163], v[64:67], v[112:115]
s_lshl_b32 s14, s14, 21
v_cvt_pk_bf16_f32 v205, v142, v143
v_cvt_pk_bf16_f32 v206, v156, v157
v_mfma_f32_16x16x32_bf16 v[188:191], a[176:179], v[64:67], v[112:115]
s_add_u32 s14, s14, s79
v_exp_f32 v159, v159
s_branch Ljoin54
Lta52:
v_mfma_f32_16x16x32_bf16 v[172:175], a[160:163], v[64:67], v[108:111]
s_lshl_b32 s14, s14, 21
v_cvt_pk_bf16_f32 v205, v142, v143
v_cvt_pk_bf16_f32 v206, v156, v157
v_mfma_f32_16x16x32_bf16 v[188:191], a[176:179], v[64:67], v[112:115]
s_add_u32 s14, s14, s79
v_exp_f32 v159, v159
s_branch Ljoin54
Lnt53:
v_mfma_f32_16x16x32_bf16 v[172:175], a[160:163], v[64:67], v[92:95]
s_lshl_b32 s14, s14, 21
v_cvt_pk_bf16_f32 v205, v142, v143
v_cvt_pk_bf16_f32 v206, v156, v157
v_mfma_f32_16x16x32_bf16 v[188:191], a[176:179], v[64:67], v[108:111]
s_add_u32 s14, s14, s79
v_exp_f32 v159, v159
Ljoin54:
v_mfma_f32_16x16x32_bf16 v[172:175], a[164:167], v[68:71], v[172:175]
s_add_u32 s15, s61, 3
v_cvt_pk_bf16_f32 v207, v158, v159
v_mfma_f32_16x16x32_bf16 v[172:175], a[168:171], v[72:75], v[172:175]
s_and_b32 s15, s15, 3
v_mfma_f32_16x16x32_bf16 v[172:175], a[172:175], v[76:79], v[172:175]
s_lshl_b32 s15, s15, 21
v_mfma_f32_16x16x32_bf16 v[188:191], a[188:191], v[76:79], v[188:191]
s_add_u32 s15, s15, s79
v_mfma_f32_16x16x32_bf16 v[188:191], a[184:187], v[72:75], v[188:191]
v_mfma_f32_16x16x32_bf16 v[188:191], a[180:183], v[68:71], v[188:191]
s_waitcnt lgkmcnt(4)
v_mfma_f32_16x16x32_bf16 v[232:235], v[120:123], v[216:219], v[232:235]
s_add_u32 s82, s82, 0x8000
v_exp_f32 v172, v172
v_mfma_f32_16x16x32_bf16 a[64:67], a[224:227], v[216:219], a[64:67]
s_and_b32 s82, s82, 0x1ffff
ds_read_b128 a[224:227], v2 offset:8192
v_mfma_f32_16x16x32_bf16 a[68:71], a[228:231], v[216:219], a[68:71]
ds_read_b128 a[228:231], v2 offset:9216
v_mfma_f32_16x16x32_bf16 a[72:75], a[232:235], v[216:219], a[72:75]
ds_read_b128 a[232:235], v2 offset:10240
v_mfma_f32_16x16x32_bf16 a[76:79], a[236:239], v[216:219], a[76:79]
buffer_store_dwordx4 v[164:167], v3, s[44:47], s70 offen offset:2048 sc1
v_mfma_f32_16x16x32_bf16 a[80:83], a[240:243], v[216:219], a[80:83]
s_nop 0
ds_read_b128 a[236:239], v2 offset:11264
ds_read_b128 a[240:243], v2 offset:12288
v_mfma_f32_16x16x32_bf16 a[84:87], a[244:247], v[216:219], a[84:87]
ds_read_b128 a[244:247], v2 offset:13312
v_mfma_f32_16x16x32_bf16 a[88:91], a[248:251], v[216:219], a[88:91]
v_exp_f32 v173, v173
v_mfma_f32_16x16x32_bf16 a[92:95], a[252:255], v[216:219], a[92:95]
v_exp_f32 v174, v174
ds_read_b128 a[248:251], v2 offset:14336
ds_read_b128 a[252:255], v2 offset:15360
v_add_u32 v2, s82, v1
buffer_store_dwordx4 v[180:183], v3, s[44:47], s70 offen offset:3072 sc1
v_cvt_pk_bf16_f32 v220, v172, v173
v_exp_f32 v175, v175
v_exp_f32 v188, v188
v_cvt_pk_bf16_f32 v221, v174, v175
v_exp_f32 v189, v189
v_exp_f32 v190, v190
v_cvt_pk_bf16_f32 v222, v188, v189
v_exp_f32 v191, v191
s_nop 0
v_cvt_pk_bf16_f32 v223, v190, v191
s_waitcnt vmcnt(8) lgkmcnt(0)
s_barrier
s_branch LHT4
Lslow:
s_waitcnt vmcnt(0) lgkmcnt(0)
s_barrier
s_mov_b32 s86, 1
s_lshl_b32 s81, s59, 20
s_add_u32 s81, s81, s64
s_sub_u32 s81, s81, 0x4000
s_mov_b32 s83, 0
s_lshl_b32 s75, s60, 3
s_sub_u32 s76, 128, s75
s_add_u32 s74, s75, s58
s_sub_u32 s75, s76, 8
s_add_u32 s75, s75, s58
v_mov_b32 v2, v1
v_lshrrev_b32 v240, 4, v0
v_and_b32 v241, 15, v0
v_lshlrev_b32 v240, 2, v240
v_sub_u32 v240, v241, v240
v_mov_b32 v112, 0xff800000
v_mov_b32 v113, 0xff800000
v_mov_b32 v114, 0xff800000
v_mov_b32 v115, 0xff800000
v_cmp_gt_i32 vcc, 0, v240
v_and_b32 v120, 3, v0
s_nop 0
v_cndmask_b32 v116, 0, v112, vcc
v_cmp_gt_i32 vcc, 1, v240
v_subrev_u32 v120, 1, v120
s_nop 0
v_cndmask_b32 v117, 0, v112, vcc
v_cmp_gt_i32 vcc, 2, v240
v_ashrrev_i32 v120, 31, v120
s_nop 0
v_cndmask_b32 v118, 0, v112, vcc
v_cmp_gt_i32 vcc, 3, v240
v_and_b32 v120, 0x3f803f80, v120
s_nop 0
v_cndmask_b32 v119, 0, v112, vcc
Lslow1:
s_add_u32 m0, s64, 16384
s_add_u32 s72, s81, 16384
buffer_load_dwordx4 v1, s[44:47], s72 offen sc1 lds
buffer_load_dwordx4 v1, s[44:47], s72 offen offset:1024 sc1 lds
buffer_load_dwordx4 v1, s[44:47], s72 offen offset:2048 sc1 lds
buffer_load_dwordx4 v1, s[44:47], s72 offen offset:3072 sc1 lds
s_add_u32 s81, s81, 0x8000
s_waitcnt vmcnt(0)
s_barrier
ds_read_b128 a[128:131], v2 offset:16384
ds_read_b128 a[132:135], v2 offset:17408
ds_read_b128 a[136:139], v2 offset:18432
ds_read_b128 a[140:143], v2 offset:19456
ds_read_b128 a[144:147], v2 offset:20480
ds_read_b128 a[148:151], v2 offset:21504
ds_read_b128 a[152:155], v2 offset:22528
ds_read_b128 a[156:159], v2 offset:23552
s_waitcnt lgkmcnt(0)
s_add_u32 s73, s74, 0
s_cmp_lt_u32 s73, s83
s_cbranch_scc1 Lsa55
s_cmp_eq_u32 s73, s83
s_cbranch_scc1 Lst56
v_mfma_f32_16x16x32_bf16 v[128:131], a[128:131], v[16:19], 0
s_branch Lsj57
Lst56:
v_mfma_f32_16x16x32_bf16 v[128:131], a[128:131], v[16:19], v[116:119]
Lsj57:
v_mfma_f32_16x16x32_bf16 v[128:131], a[132:135], v[20:23], v[128:131]
v_mfma_f32_16x16x32_bf16 v[128:131], a[136:139], v[24:27], v[128:131]
v_mfma_f32_16x16x32_bf16 v[128:131], a[140:143], v[28:31], v[128:131]
s_nop 7
v_max3_f32 v124, v124, v128, v129
v_max3_f32 v124, v124, v130, v131
Lsa55:
s_add_u32 s73, s74, 4
s_cmp_lt_u32 s73, s83
s_cbranch_scc1 Lsa58
s_cmp_eq_u32 s73, s83
s_cbranch_scc1 Lst59
v_mfma_f32_16x16x32_bf16 v[132:135], a[128:131], v[32:35], 0
s_branch Lsj60
Lst59:
v_mfma_f32_16x16x32_bf16 v[132:135], a[128:131], v[32:35], v[116:119]
Lsj60:
v_mfma_f32_16x16x32_bf16 v[132:135], a[132:135], v[36:39], v[132:135]
v_mfma_f32_16x16x32_bf16 v[132:135], a[136:139], v[40:43], v[132:135]
v_mfma_f32_16x16x32_bf16 v[132:135], a[140:143], v[44:47], v[132:135]
s_nop 7
v_max3_f32 v125, v125, v132, v133
v_max3_f32 v125, v125, v134, v135
Lsa58:
s_add_u32 s73, s75, 0
s_cmp_lt_u32 s73, s83
s_cbranch_scc1 Lsa61
s_cmp_eq_u32 s73, s83
s_cbranch_scc1 Lst62
v_mfma_f32_16x16x32_bf16 v[136:139], a[128:131], v[48:51], 0
s_branch Lsj63
Lst62:
v_mfma_f32_16x16x32_bf16 v[136:139], a[128:131], v[48:51], v[116:119]
Lsj63:
v_mfma_f32_16x16x32_bf16 v[136:139], a[132:135], v[52:55], v[136:139]
v_mfma_f32_16x16x32_bf16 v[136:139], a[136:139], v[56:59], v[136:139]
v_mfma_f32_16x16x32_bf16 v[136:139], a[140:143], v[60:63], v[136:139]
s_nop 7
v_max3_f32 v126, v126, v136, v137
v_max3_f32 v126, v126, v138, v139
Lsa61:
s_add_u32 s73, s75, 4
s_cmp_lt_u32 s73, s83
s_cbranch_scc1 Lsa64
s_cmp_eq_u32 s73, s83
s_cbranch_scc1 Lst65
v_mfma_f32_16x16x32_bf16 v[140:143], a[128:131], v[64:67], 0
s_branch Lsj66
Lst65:
v_mfma_f32_16x16x32_bf16 v[140:143], a[128:131], v[64:67], v[116:119]
Lsj66:
v_mfma_f32_16x16x32_bf16 v[140:143], a[132:135], v[68:71], v[140:143]
v_mfma_f32_16x16x32_bf16 v[140:143], a[136:139], v[72:75], v[140:143]
v_mfma_f32_16x16x32_bf16 v[140:143], a[140:143], v[76:79], v[140:143]
s_nop 7
v_max3_f32 v127, v127, v140, v141
v_max3_f32 v127, v127, v142, v143
Lsa64:
s_add_u32 s83, s83, 1
s_add_u32 s73, s74, 0
s_cmp_lt_u32 s73, s83
s_cbranch_scc1 Lsa67
s_cmp_eq_u32 s73, s83
s_cbranch_scc1 Lst68
v_mfma_f32_16x16x32_bf16 v[144:147], a[144:147], v[16:19], 0
s_branch Lsj69
Lst68:
v_mfma_f32_16x16x32_bf16 v[144:147], a[144:147], v[16:19], v[116:119]
Lsj69:
v_mfma_f32_16x16x32_bf16 v[144:147], a[148:151], v[20:23], v[144:147]
v_mfma_f32_16x16x32_bf16 v[144:147], a[152:155], v[24:27], v[144:147]
v_mfma_f32_16x16x32_bf16 v[144:147], a[156:159], v[28:31], v[144:147]
s_nop 7
v_max3_f32 v124, v124, v144, v145
v_max3_f32 v124, v124, v146, v147
Lsa67:
s_add_u32 s73, s74, 4
s_cmp_lt_u32 s73, s83
s_cbranch_scc1 Lsa70
s_cmp_eq_u32 s73, s83
s_cbranch_scc1 Lst71
v_mfma_f32_16x16x32_bf16 v[148:151], a[144:147], v[32:35], 0
s_branch Lsj72
Lst71:
v_mfma_f32_16x16x32_bf16 v[148:151], a[144:147], v[32:35], v[116:119]
Lsj72:
v_mfma_f32_16x16x32_bf16 v[148:151], a[148:151], v[36:39], v[148:151]
v_mfma_f32_16x16x32_bf16 v[148:151], a[152:155], v[40:43], v[148:151]
v_mfma_f32_16x16x32_bf16 v[148:151], a[156:159], v[44:47], v[148:151]
s_nop 7
v_max3_f32 v125, v125, v148, v149
v_max3_f32 v125, v125, v150, v151
Lsa70:
s_add_u32 s73, s75, 0
s_cmp_lt_u32 s73, s83
s_cbranch_scc1 Lsa73
s_cmp_eq_u32 s73, s83
s_cbranch_scc1 Lst74
v_mfma_f32_16x16x32_bf16 v[152:155], a[144:147], v[48:51], 0
s_branch Lsj75
Lst74:
v_mfma_f32_16x16x32_bf16 v[152:155], a[144:147], v[48:51], v[116:119]
Lsj75:
v_mfma_f32_16x16x32_bf16 v[152:155], a[148:151], v[52:55], v[152:155]
v_mfma_f32_16x16x32_bf16 v[152:155], a[152:155], v[56:59], v[152:155]
v_mfma_f32_16x16x32_bf16 v[152:155], a[156:159], v[60:63], v[152:155]
s_nop 7
v_max3_f32 v126, v126, v152, v153
v_max3_f32 v126, v126, v154, v155
Lsa73:
s_add_u32 s73, s75, 4
s_cmp_lt_u32 s73, s83
s_cbranch_scc1 Lsa76
s_cmp_eq_u32 s73, s83
s_cbranch_scc1 Lst77
v_mfma_f32_16x16x32_bf16 v[156:159], a[144:147], v[64:67], 0
s_branch Lsj78
Lst77:
v_mfma_f32_16x16x32_bf16 v[156:159], a[144:147], v[64:67], v[116:119]
Lsj78:
v_mfma_f32_16x16x32_bf16 v[156:159], a[148:151], v[68:71], v[156:159]
v_mfma_f32_16x16x32_bf16 v[156:159], a[152:155], v[72:75], v[156:159]
v_mfma_f32_16x16x32_bf16 v[156:159], a[156:159], v[76:79], v[156:159]
s_nop 7
v_max3_f32 v127, v127, v156, v157
v_max3_f32 v127, v127, v158, v159
Lsa76:
s_add_u32 s83, s83, 1
ds_read_b128 a[128:131], v2 offset:24576
ds_read_b128 a[132:135], v2 offset:25600
ds_read_b128 a[136:139], v2 offset:26624
ds_read_b128 a[140:143], v2 offset:27648
ds_read_b128 a[144:147], v2 offset:28672
ds_read_b128 a[148:151], v2 offset:29696
ds_read_b128 a[152:155], v2 offset:30720
ds_read_b128 a[156:159], v2 offset:31744
s_waitcnt lgkmcnt(0)
s_add_u32 s73, s74, 0
s_cmp_lt_u32 s73, s83
s_cbranch_scc1 Lsa79
s_cmp_eq_u32 s73, s83
s_cbranch_scc1 Lst80
v_mfma_f32_16x16x32_bf16 v[128:131], a[128:131], v[16:19], 0
s_branch Lsj81
Lst80:
v_mfma_f32_16x16x32_bf16 v[128:131], a[128:131], v[16:19], v[116:119]
Lsj81:
v_mfma_f32_16x16x32_bf16 v[128:131], a[132:135], v[20:23], v[128:131]
v_mfma_f32_16x16x32_bf16 v[128:131], a[136:139], v[24:27], v[128:131]
v_mfma_f32_16x16x32_bf16 v[128:131], a[140:143], v[28:31], v[128:131]
s_nop 7
v_max3_f32 v124, v124, v128, v129
v_max3_f32 v124, v124, v130, v131
Lsa79:
s_add_u32 s73, s74, 4
s_cmp_lt_u32 s73, s83
s_cbranch_scc1 Lsa82
s_cmp_eq_u32 s73, s83
s_cbranch_scc1 Lst83
v_mfma_f32_16x16x32_bf16 v[132:135], a[128:131], v[32:35], 0
s_branch Lsj84
Lst83:
v_mfma_f32_16x16x32_bf16 v[132:135], a[128:131], v[32:35], v[116:119]
Lsj84:
v_mfma_f32_16x16x32_bf16 v[132:135], a[132:135], v[36:39], v[132:135]
v_mfma_f32_16x16x32_bf16 v[132:135], a[136:139], v[40:43], v[132:135]
v_mfma_f32_16x16x32_bf16 v[132:135], a[140:143], v[44:47], v[132:135]
s_nop 7
v_max3_f32 v125, v125, v132, v133
v_max3_f32 v125, v125, v134, v135
Lsa82:
s_add_u32 s73, s75, 0
s_cmp_lt_u32 s73, s83
s_cbranch_scc1 Lsa85
s_cmp_eq_u32 s73, s83
s_cbranch_scc1 Lst86
v_mfma_f32_16x16x32_bf16 v[136:139], a[128:131], v[48:51], 0
s_branch Lsj87
Lst86:
v_mfma_f32_16x16x32_bf16 v[136:139], a[128:131], v[48:51], v[116:119]
Lsj87:
v_mfma_f32_16x16x32_bf16 v[136:139], a[132:135], v[52:55], v[136:139]
v_mfma_f32_16x16x32_bf16 v[136:139], a[136:139], v[56:59], v[136:139]
v_mfma_f32_16x16x32_bf16 v[136:139], a[140:143], v[60:63], v[136:139]
s_nop 7
v_max3_f32 v126, v126, v136, v137
v_max3_f32 v126, v126, v138, v139
Lsa85:
s_add_u32 s73, s75, 4
s_cmp_lt_u32 s73, s83
s_cbranch_scc1 Lsa88
s_cmp_eq_u32 s73, s83
s_cbranch_scc1 Lst89
v_mfma_f32_16x16x32_bf16 v[140:143], a[128:131], v[64:67], 0
s_branch Lsj90
Lst89:
v_mfma_f32_16x16x32_bf16 v[140:143], a[128:131], v[64:67], v[116:119]
Lsj90:
v_mfma_f32_16x16x32_bf16 v[140:143], a[132:135], v[68:71], v[140:143]
v_mfma_f32_16x16x32_bf16 v[140:143], a[136:139], v[72:75], v[140:143]
v_mfma_f32_16x16x32_bf16 v[140:143], a[140:143], v[76:79], v[140:143]
s_nop 7
v_max3_f32 v127, v127, v140, v141
v_max3_f32 v127, v127, v142, v143
Lsa88:
s_add_u32 s83, s83, 1
s_add_u32 s73, s74, 0
s_cmp_lt_u32 s73, s83
s_cbranch_scc1 Lsa91
s_cmp_eq_u32 s73, s83
s_cbranch_scc1 Lst92
v_mfma_f32_16x16x32_bf16 v[144:147], a[144:147], v[16:19], 0
s_branch Lsj93
Lst92:
v_mfma_f32_16x16x32_bf16 v[144:147], a[144:147], v[16:19], v[116:119]
Lsj93:
v_mfma_f32_16x16x32_bf16 v[144:147], a[148:151], v[20:23], v[144:147]
v_mfma_f32_16x16x32_bf16 v[144:147], a[152:155], v[24:27], v[144:147]
v_mfma_f32_16x16x32_bf16 v[144:147], a[156:159], v[28:31], v[144:147]
s_nop 7
v_max3_f32 v124, v124, v144, v145
v_max3_f32 v124, v124, v146, v147
Lsa91:
s_add_u32 s73, s74, 4
s_cmp_lt_u32 s73, s83
s_cbranch_scc1 Lsa94
s_cmp_eq_u32 s73, s83
s_cbranch_scc1 Lst95
v_mfma_f32_16x16x32_bf16 v[148:151], a[144:147], v[32:35], 0
s_branch Lsj96
Lst95:
v_mfma_f32_16x16x32_bf16 v[148:151], a[144:147], v[32:35], v[116:119]
Lsj96:
v_mfma_f32_16x16x32_bf16 v[148:151], a[148:151], v[36:39], v[148:151]
v_mfma_f32_16x16x32_bf16 v[148:151], a[152:155], v[40:43], v[148:151]
v_mfma_f32_16x16x32_bf16 v[148:151], a[156:159], v[44:47], v[148:151]
s_nop 7
v_max3_f32 v125, v125, v148, v149
v_max3_f32 v125, v125, v150, v151
Lsa94:
s_add_u32 s73, s75, 0
s_cmp_lt_u32 s73, s83
s_cbranch_scc1 Lsa97
s_cmp_eq_u32 s73, s83
s_cbranch_scc1 Lst98
v_mfma_f32_16x16x32_bf16 v[152:155], a[144:147], v[48:51], 0
s_branch Lsj99
Lst98:
v_mfma_f32_16x16x32_bf16 v[152:155], a[144:147], v[48:51], v[116:119]
Lsj99:
v_mfma_f32_16x16x32_bf16 v[152:155], a[148:151], v[52:55], v[152:155]
v_mfma_f32_16x16x32_bf16 v[152:155], a[152:155], v[56:59], v[152:155]
v_mfma_f32_16x16x32_bf16 v[152:155], a[156:159], v[60:63], v[152:155]
s_nop 7
v_max3_f32 v126, v126, v152, v153
v_max3_f32 v126, v126, v154, v155
Lsa97:
s_add_u32 s73, s75, 4
s_cmp_lt_u32 s73, s83
s_cbranch_scc1 Lsa100
s_cmp_eq_u32 s73, s83
s_cbranch_scc1 Lst101
v_mfma_f32_16x16x32_bf16 v[156:159], a[144:147], v[64:67], 0
s_branch Lsj102
Lst101:
v_mfma_f32_16x16x32_bf16 v[156:159], a[144:147], v[64:67], v[116:119]
Lsj102:
v_mfma_f32_16x16x32_bf16 v[156:159], a[148:151], v[68:71], v[156:159]
v_mfma_f32_16x16x32_bf16 v[156:159], a[152:155], v[72:75], v[156:159]
v_mfma_f32_16x16x32_bf16 v[156:159], a[156:159], v[76:79], v[156:159]
s_nop 7
v_max3_f32 v127, v127, v156, v157
v_max3_f32 v127, v127, v158, v159
Lsa100:
s_add_u32 s83, s83, 1
s_barrier
s_cmp_lt_u32 s83, s76
s_cbranch_scc1 Lslow1
s_lshl_b32 s81, s59, 20
s_add_u32 s81, s81, s64
s_sub_u32 s81, s81, 0x4000
s_add_u32 m0, s64, 49152
s_add_u32 s72, s81, 16384
buffer_load_dwordx4 v1, s[44:47], s72 offen sc1 lds
buffer_load_dwordx4 v1, s[44:47], s72 offen offset:1024 sc1 lds
buffer_load_dwordx4 v1, s[44:47], s72 offen offset:2048 sc1 lds
buffer_load_dwordx4 v1, s[44:47], s72 offen offset:3072 sc1 lds
s_add_u32 s81, s81, 0x8000
s_add_u32 m0, s64, 81920
s_add_u32 s72, s81, 16384
buffer_load_dwordx4 v1, s[44:47], s72 offen sc1 lds
buffer_load_dwordx4 v1, s[44:47], s72 offen offset:1024 sc1 lds
buffer_load_dwordx4 v1, s[44:47], s72 offen offset:2048 sc1 lds
buffer_load_dwordx4 v1, s[44:47], s72 offen offset:3072 sc1 lds
s_add_u32 m0, s64, 65536
s_add_u32 s72, s81, 0
buffer_load_dwordx4 v1, s[44:47], s72 offen sc1 lds
buffer_load_dwordx4 v1, s[44:47], s72 offen offset:1024 sc1 lds
buffer_load_dwordx4 v1, s[44:47], s72 offen offset:2048 sc1 lds
buffer_load_dwordx4 v1, s[44:47], s72 offen offset:3072 sc1 lds
s_add_u32 s81, s81, 0x8000
s_add_u32 m0, s64, 114688
s_add_u32 s72, s81, 16384
buffer_load_dwordx4 v1, s[44:47], s72 offen sc1 lds
buffer_load_dwordx4 v1, s[44:47], s72 offen offset:1024 sc1 lds
buffer_load_dwordx4 v1, s[44:47], s72 offen offset:2048 sc1 lds
buffer_load_dwordx4 v1, s[44:47], s72 offen offset:3072 sc1 lds
s_add_u32 m0, s64, 98304
s_add_u32 s72, s81, 0
buffer_load_dwordx4 v1, s[44:47], s72 offen sc1 lds
buffer_load_dwordx4 v1, s[44:47], s72 offen offset:1024 sc1 lds
buffer_load_dwordx4 v1, s[44:47], s72 offen offset:2048 sc1 lds
buffer_load_dwordx4 v1, s[44:47], s72 offen offset:3072 sc1 lds
v_add_u32 v2, 0x8000, v1
v_lshrrev_b32 v3, 1, v0
v_lshlrev_b32 v3, 7, v3
s_waitcnt vmcnt(0)
s_barrier
v_accvgpr_write_b32 a32, 0
v_accvgpr_write_b32 a33, 0
v_accvgpr_write_b32 a34, 0
v_accvgpr_write_b32 a35, 0
v_accvgpr_write_b32 a36, 0
v_accvgpr_write_b32 a37, 0
v_accvgpr_write_b32 a38, 0
v_accvgpr_write_b32 a39, 0
v_accvgpr_write_b32 a40, 0
v_accvgpr_write_b32 a41, 0
v_accvgpr_write_b32 a42, 0
v_accvgpr_write_b32 a43, 0
v_accvgpr_write_b32 a44, 0
v_accvgpr_write_b32 a45, 0
v_accvgpr_write_b32 a46, 0
v_accvgpr_write_b32 a47, 0
v_accvgpr_write_b32 a48, 0
v_accvgpr_write_b32 a49, 0
v_accvgpr_write_b32 a50, 0
v_accvgpr_write_b32 a51, 0
v_accvgpr_write_b32 a52, 0
v_accvgpr_write_b32 a53, 0
v_accvgpr_write_b32 a54, 0
v_accvgpr_write_b32 a55, 0
v_accvgpr_write_b32 a56, 0
v_accvgpr_write_b32 a57, 0
v_accvgpr_write_b32 a58, 0
v_accvgpr_write_b32 a59, 0
v_accvgpr_write_b32 a60, 0
v_accvgpr_write_b32 a61, 0
v_accvgpr_write_b32 a62, 0
v_accvgpr_write_b32 a63, 0
v_accvgpr_write_b32 a96, 0
v_accvgpr_write_b32 a97, 0
v_accvgpr_write_b32 a98, 0
v_accvgpr_write_b32 a99, 0
v_accvgpr_write_b32 a100, 0
v_accvgpr_write_b32 a101, 0
v_accvgpr_write_b32 a102, 0
v_accvgpr_write_b32 a103, 0
v_accvgpr_write_b32 a104, 0
v_accvgpr_write_b32 a105, 0
v_accvgpr_write_b32 a106, 0
v_accvgpr_write_b32 a107, 0
v_accvgpr_write_b32 a108, 0
v_accvgpr_write_b32 a109, 0
v_accvgpr_write_b32 a110, 0
v_accvgpr_write_b32 a111, 0
v_accvgpr_write_b32 a112, 0
v_accvgpr_write_b32 a113, 0
v_accvgpr_write_b32 a114, 0
v_accvgpr_write_b32 a115, 0
v_accvgpr_write_b32 a116, 0
v_accvgpr_write_b32 a117, 0
v_accvgpr_write_b32 a118, 0
v_accvgpr_write_b32 a119, 0
v_accvgpr_write_b32 a120, 0
v_accvgpr_write_b32 a121, 0
v_accvgpr_write_b32 a122, 0
v_accvgpr_write_b32 a123, 0
v_accvgpr_write_b32 a124, 0
v_accvgpr_write_b32 a125, 0
v_accvgpr_write_b32 a126, 0
v_accvgpr_write_b32 a127, 0
ds_read_b128 a[128:131], v2 offset:16384
ds_read_b128 a[132:135], v2 offset:17408
ds_read_b128 a[136:139], v2 offset:18432
ds_read_b128 a[140:143], v2 offset:19456
ds_read_b128 a[144:147], v2 offset:20480
ds_read_b128 a[148:151], v2 offset:21504
ds_read_b128 a[152:155], v2 offset:22528
ds_read_b128 a[156:159], v2 offset:23552
s_branch Lattn
Lspin103:
s_mov_b32 s83, 262144
Lsl105:
s_sleep 2
buffer_load_dword v3, v2, s[44:47], s82 offen sc1
s_sub_u32 s83, s83, 1
s_cmp_eq_u32 s83, 0
s_waitcnt vmcnt(0)
s_cbranch_scc1 Lback104
v_cmp_gt_u32 vcc, 2, v3
s_cbranch_vccnz Lsl105
s_branch Lback104
Lspin106:
s_mov_b32 s83, 262144
Lsl108:
s_sleep 2
buffer_load_dword v3, v2, s[44:47], s82 offen sc1
s_sub_u32 s83, s83, 1
s_cmp_eq_u32 s83, 0
s_waitcnt vmcnt(0)
s_cbranch_scc1 Lback107
v_cmp_gt_u32 vcc, 2, v3
s_cbranch_vccnz Lsl108
s_branch Lback107
Lredo0:
s_xor_b32 s82, s78, 0
s_lshl_b32 s82, s82, 10
s_add_u32 s82, s82, s74
buffer_load_dword v3, v2, s[44:47], s82 offen sc1
s_waitcnt vmcnt(0)
v_cmp_gt_u32 vcc, 2, v3
s_cbranch_vccnz Lspin103
Lback104:
s_lshr_b32 s69, s12, 18
s_lshl_b32 s69, s69, 12
s_add_u32 s69, s69, s95
buffer_load_dwordx4 a[0:3], v1, s[44:47], s69 offen sc1
buffer_load_dwordx4 a[4:7], v1, s[44:47], s69 offen offset:1024 sc1
buffer_load_dwordx4 a[8:11], v1, s[44:47], s69 offen offset:2048 sc1
buffer_load_dwordx4 a[12:15], v1, s[44:47], s69 offen offset:3072 sc1
s_add_u32 s69, s69, 0x20000
buffer_load_dwordx4 a[16:19], v1, s[44:47], s69 offen sc1
buffer_load_dwordx4 a[20:23], v1, s[44:47], s69 offen offset:1024 sc1
buffer_load_dwordx4 a[24:27], v1, s[44:47], s69 offen offset:2048 sc1
buffer_load_dwordx4 a[28:31], v1, s[44:47], s69 offen offset:3072 sc1
s_lshr_b32 s69, s13, 18
s_lshl_b32 s69, s69, 12
s_add_u32 s69, s69, s95
buffer_load_dwordx4 a[32:35], v1, s[44:47], s69 offen sc1
buffer_load_dwordx4 a[36:39], v1, s[44:47], s69 offen offset:1024 sc1
buffer_load_dwordx4 a[40:43], v1, s[44:47], s69 offen offset:2048 sc1
buffer_load_dwordx4 a[44:47], v1, s[44:47], s69 offen offset:3072 sc1
s_add_u32 s69, s69, 0x20000
buffer_load_dwordx4 a[48:51], v1, s[44:47], s69 offen sc1
buffer_load_dwordx4 a[52:55], v1, s[44:47], s69 offen offset:1024 sc1
buffer_load_dwordx4 a[56:59], v1, s[44:47], s69 offen offset:2048 sc1
buffer_load_dwordx4 a[60:63], v1, s[44:47], s69 offen offset:3072 sc1
s_waitcnt vmcnt(8)
s_branch Lredo0b
Lspin109:
s_mov_b32 s83, 262144
Lsl111:
s_sleep 2
buffer_load_dword v114, v115, s[44:47], s84 offen sc1
s_sub_u32 s83, s83, 1
s_cmp_eq_u32 s83, 0
s_waitcnt vmcnt(0)
s_cbranch_scc1 Lback110
v_cmp_gt_u32 vcc, 3, v114
s_cbranch_vccnz Lsl111
s_branch Lback110
Lspin112:
s_mov_b32 s83, 262144
Lsl114:
s_sleep 2
buffer_load_dword v14, v13, s[44:47], s79 offen sc1
s_sub_u32 s83, s83, 1
s_cmp_eq_u32 s83, 0
s_waitcnt vmcnt(0)
s_cbranch_scc1 Lback113
v_cmp_gt_u32 vcc, 2, v14
s_cbranch_vccnz Lsl114
s_branch Lback113
Lxspin1:
s_mov_b32 s83, 262144
Lxsl1:
buffer_load_dwordx4 v[96:99], v1, s[44:47], s79 offen sc1
buffer_load_dwordx4 v[100:103], v1, s[44:47], s79 offen offset:1024 sc1
buffer_load_dwordx4 v[104:107], v1, s[44:47], s79 offen offset:2048 sc1
buffer_load_dwordx4 v[108:111], v1, s[44:47], s79 offen offset:3072 sc1
s_sub_u32 s83, s83, 1
s_cmp_eq_u32 s83, 0
s_waitcnt vmcnt(0)
s_cbranch_scc1 Lxback1
v_max3_u32 v12, v96, v97, v98
v_max3_u32 v13, v99, v100, v101
v_max3_u32 v12, v12, v102, v103
v_max3_u32 v13, v13, v104, v105
v_max3_u32 v12, v12, v106, v107
v_max3_u32 v13, v13, v108, v109
v_max3_u32 v12, v12, v110, v111
v_max_u32 v12, v12, v13
v_cmp_le_u32 vcc, 0xff800000, v12
s_cbranch_vccnz Lxsl1
s_branch Lxback1
Lxspin2:
s_mov_b32 s83, 262144
Lxsl2:
buffer_load_dwordx4 v[80:83], v1, s[44:47], s82 offen sc1
buffer_load_dwordx4 v[84:87], v1, s[44:47], s82 offen offset:1024 sc1
buffer_load_dwordx4 v[88:91], v1, s[44:47], s82 offen offset:2048 sc1
buffer_load_dwordx4 v[92:95], v1, s[44:47], s82 offen offset:3072 sc1
s_sub_u32 s83, s83, 1
s_cmp_eq_u32 s83, 0
s_waitcnt vmcnt(0)
s_cbranch_scc1 Lxback2
v_max3_u32 v12, v80, v81, v82
v_max3_u32 v13, v83, v84, v85
v_max3_u32 v12, v12, v86, v87
v_max3_u32 v13, v13, v88, v89
v_max3_u32 v12, v12, v90, v91
v_max3_u32 v13, v13, v92, v93
v_max3_u32 v12, v12, v94, v95
v_max_u32 v12, v12, v13
v_cmp_le_u32 vcc, 0xff800000, v12
s_cbranch_vccnz Lxsl2
s_branch Lxback2
Lxspin3:
s_mov_b32 s83, 262144
Lxsl3:
buffer_load_dwordx4 v[96:99], v1, s[44:47], s81 offen sc1
buffer_load_dwordx4 v[100:103], v1, s[44:47], s81 offen offset:1024 sc1
buffer_load_dwordx4 v[104:107], v1, s[44:47], s81 offen offset:2048 sc1
buffer_load_dwordx4 v[108:111], v1, s[44:47], s81 offen offset:3072 sc1
s_sub_u32 s83, s83, 1
s_cmp_eq_u32 s83, 0
s_waitcnt vmcnt(0)
s_cbranch_scc1 Lxback3
v_max3_u32 v12, v96, v97, v98
v_max3_u32 v13, v99, v100, v101
v_max3_u32 v12, v12, v102, v103
v_max3_u32 v13, v13, v104, v105
v_max3_u32 v12, v12, v106, v107
v_max3_u32 v13, v13, v108, v109
v_max3_u32 v12, v12, v110, v111
v_max_u32 v12, v12, v13
v_cmp_le_u32 vcc, 0xff800000, v12
s_cbranch_vccnz Lxsl3
s_branch Lxback3
Lcode_end:
s_endpgm
.section .rodata,"a"
.p2align 6
.amdhsa_kernel gated_mix__compressed_kv_cla__ssm_conv_h3__prompt_kernel
  .amdhsa_next_free_vgpr 512
  .amdhsa_next_free_sgpr 102
  .amdhsa_accum_offset 256
  .amdhsa_group_segment_fixed_size 0
  .amdhsa_kernarg_size 128
  .amdhsa_user_sgpr_count 2
  .amdhsa_user_sgpr_kernarg_segment_ptr 1
  .amdhsa_system_sgpr_workgroup_id_x 1
  .amdhsa_float_denorm_mode_32 3
.end_amdhsa_kernel
```

```asm
; @launch grid=(256,1,1) block=(256,1,1) lds=163840
.amdgcn_target "amdgcn-amd-amdhsa--gfx950"
.text
.globl gated_mix__compressed_kv_cla__ssm_conv_h3__prompt_kernel
.p2align 8
.type gated_mix__compressed_kv_cla__ssm_conv_h3__prompt_kernel,@function
gated_mix__compressed_kv_cla__ssm_conv_h3__prompt_kernel:
s_cmp_ge_u32 s2, 256
s_cbranch_scc1 Lend
s_load_dwordx2 s[8:9], s[0:1], 8
s_load_dwordx2 s[16:17], s[0:1], 24
s_load_dwordx2 s[20:21], s[0:1], 32
s_lshr_b32 s75, s2, 3
v_mul_u32_u24 v31, 18, v0
s_getpc_b64 s[98:99]
Lpc0:
s_mul_i32 s74, s75, 4608
v_and_b32 v31, 0x1f80, v31
v_add_u32 v31, s74, v31
v_min_u32 v31, Lcode_end-Lpc0, v31
global_load_dword v31, v31, s[98:99]
v_lshrrev_b32 v26, 6, v0
v_and_b32 v0, 63, v0
s_lshr_b32 s65, s75, 3
v_readfirstlane_b32 s58, v26
s_and_b32 s60, s75, 7
s_and_b32 s61, s65, 1
s_lshl_b32 s63, s58, 13
s_lshl_b32 s67, s60, 18
s_lshl_b32 s76, s58, 16
s_add_u32 s84, s67, s76
v_lshrrev_b32 v26, 4, v0
v_and_b32 v27, 7, v0
v_xor_b32 v27, v27, v26
v_lshlrev_b32 v27, 4, v27
v_lshrrev_b32 v28, 3, v0
v_lshl_add_u32 v2, v28, 10, v27
v_xor_b32 v3, 64, v2
s_mov_b32 s66, 0
s_mov_b32 s10, 0x200000
s_mov_b32 s11, 0x20000
s_mov_b32 s18, 0x400000
s_mov_b32 s19, 0x20000
s_mov_b32 s22, 0x400000
s_mov_b32 s23, 0x20000
s_and_b32 s73, s2, 7
s_lshl_b32 s73, s73, 2
s_add_u32 s59, s73, s65
s_lshl_b32 s64, s58, 12
s_lshl_b32 s66, s58, 17
s_lshr_b32 s73, 0x67234501, s73
s_and_b32 s73, s73, 7
s_lshl_b32 s74, s65, 3
s_add_u32 s73, s73, s74
s_lshl_b32 s73, s73, 8
s_add_u32 s66, s66, s73
v_and_b32 v29, 15, v0
v_lshlrev_b32 v30, 1, v26
v_xor_b32 v30, v30, v29
v_lshlrev_b32 v30, 4, v30
v_lshl_add_u32 v6, v26, 13, v30
v_xor_b32 v7, 0x80, v6
s_bitcmp1_b32 s2, 0
s_cbranch_scc1 Lnoev
s_load_dwordx2 s[4:5], s[0:1], 0
s_load_dwordx2 s[28:29], s[0:1], 56
s_load_dwordx2 s[32:33], s[0:1], 64
s_lshr_b32 s73, s2, 4
s_lshl_b32 s73, s73, 18
s_add_u32 s73, s73, s76
s_xor_b32 s74, s2, 5
s_and_b32 s74, s74, 15
s_lshl_b32 s74, s74, 7
s_add_u32 s73, s73, s74
v_lshrrev_b32 v32, 1, v0
v_lshlrev_b32 v33, 7, v32
v_lshl_add_u32 v32, v32, 11, s73
s_lshl_b32 s73, s2, 14
s_add_u32 s73, s73, s64
v_add_u32 v33, s73, v33
s_waitcnt lgkmcnt(0)
global_load_dword v35, v32, s[28:29]
global_load_dword v35, v32, s[32:33]
global_load_dword v35, v33, s[4:5]
Lnoev:
s_xor_b32 s73, s61, 0
s_lshl_b32 s69, s73, 7
s_add_u32 s69, s69, s84
s_lshl_b32 s71, s73, 19
s_add_u32 s71, s71, s66
s_add_u32 m0, s63, 65536
s_add_u32 s72, s69, 0
s_waitcnt lgkmcnt(0)
buffer_load_dwordx4 v2, s[8:11], s72 offen lds
s_add_u32 s72, s69, 7168
buffer_load_dwordx4 v3, s[8:11], s72 offen offset:1024 lds
s_add_u32 s72, s69, 14336
buffer_load_dwordx4 v2, s[8:11], s72 offen offset:2048 lds
s_add_u32 s72, s69, 21504
buffer_load_dwordx4 v3, s[8:11], s72 offen offset:3072 lds
s_add_u32 m0, s64, 0
s_add_u32 s72, s71, 0
buffer_load_dwordx4 v6, s[16:19], s72 offen lds
s_add_u32 s72, s71, 31744
buffer_load_dwordx4 v6, s[16:19], s72 offen offset:1024 lds
s_add_u32 s72, s71, 63488
buffer_load_dwordx4 v7, s[16:19], s72 offen offset:2048 lds
s_add_u32 s72, s71, 95232
buffer_load_dwordx4 v7, s[16:19], s72 offen offset:3072 lds
s_add_u32 m0, s63, 69632
s_add_u32 s72, s69, 32768
buffer_load_dwordx4 v2, s[8:11], s72 offen lds
s_add_u32 s72, s69, 39936
buffer_load_dwordx4 v3, s[8:11], s72 offen offset:1024 lds
s_add_u32 s72, s69, 47104
buffer_load_dwordx4 v2, s[8:11], s72 offen offset:2048 lds
s_add_u32 s72, s69, 54272
buffer_load_dwordx4 v3, s[8:11], s72 offen offset:3072 lds
s_add_u32 m0, s64, 16384
s_add_u32 s72, s71, 0
buffer_load_dwordx4 v6, s[20:23], s72 offen lds
s_add_u32 s72, s71, 31744
buffer_load_dwordx4 v6, s[20:23], s72 offen offset:1024 lds
s_add_u32 s72, s71, 63488
buffer_load_dwordx4 v7, s[20:23], s72 offen offset:2048 lds
s_add_u32 s72, s71, 95232
buffer_load_dwordx4 v7, s[20:23], s72 offen offset:3072 lds
s_load_dwordx2 s[4:5], s[0:1], 0
s_load_dwordx2 s[12:13], s[0:1], 16
s_load_dwordx2 s[24:25], s[0:1], 40
s_load_dwordx2 s[28:29], s[0:1], 56
s_load_dwordx2 s[32:33], s[0:1], 64
s_load_dwordx2 s[52:53], s[0:1], 72
s_load_dwordx2 s[36:37], s[0:1], 80
s_load_dwordx2 s[54:55], s[0:1], 88
s_load_dwordx2 s[56:57], s[0:1], 96
s_load_dwordx2 s[40:41], s[0:1], 104
s_load_dwordx2 s[48:49], s[0:1], 112
s_load_dwordx2 s[44:45], s[0:1], 120
s_lshl_b32 s73, s2, 2
s_add_u32 s73, s73, s58
s_lshl_b32 s73, s73, 11
v_lshrrev_b32 v124, 2, v0
v_lshlrev_b32 v124, 7, v124
v_add_u32 v124, s73, v124
s_lshr_b32 s73, s2, 3
s_lshl_b32 s73, s73, 2
s_add_u32 s73, s73, s58
s_lshl_b32 s73, s73, 13
s_and_b32 s74, s66, 0x700
s_add_u32 s73, s73, s74
v_lshrrev_b32 v125, 4, v0
v_lshlrev_b32 v125, 11, v125
v_bfe_u32 v126, v0, 3, 1
v_lshl_add_u32 v125, v126, 7, v125
v_add_u32 v125, s73, v125
s_lshr_b32 s80, s61, 1
s_xor_b32 s80, s80, 0
s_lshl_b32 s80, s80, 20
buffer_load_dword v126, v125, s[16:19], s80 offen
buffer_load_dword v126, v125, s[20:23], s80 offen
buffer_load_dword v126, v124, s[8:11], 0 offen
s_xor_b32 s73, s61, 1
s_lshl_b32 s69, s73, 7
s_add_u32 s69, s69, s84
s_lshl_b32 s71, s73, 19
s_add_u32 s71, s71, s66
s_add_u32 m0, s63, 98304
s_add_u32 s72, s69, 0
buffer_load_dwordx4 v2, s[8:11], s72 offen lds
s_add_u32 s72, s69, 7168
buffer_load_dwordx4 v3, s[8:11], s72 offen offset:1024 lds
s_add_u32 s72, s69, 14336
buffer_load_dwordx4 v2, s[8:11], s72 offen offset:2048 lds
s_add_u32 s72, s69, 21504
buffer_load_dwordx4 v3, s[8:11], s72 offen offset:3072 lds
s_lshl_b32 s91, s59, 3
s_add_u32 s91, s91, s60
s_lshl_b32 s93, s91, 2
s_add_u32 s93, s93, s58
s_lshl_b32 s75, s93, 1
s_and_b32 s75, s75, 0xffc
s_lshl_b32 s93, s93, 12
s_waitcnt lgkmcnt(0)
s_load_dwordx2 s[88:89], s[36:37], s93
s_load_dword s90, s[54:55], s75
v_lshrrev_b32 v16, 1, v29
v_xor_b32 v16, v16, v26
v_lshlrev_b32 v16, 4, v16
v_lshl_add_u32 v16, v29, 7, v16
s_lshr_b32 s73, s58, 1
s_lshl_b32 s74, s73, 14
s_add_u32 s74, s74, 0x10000
v_add_u32 v24, s74, v16
v_xor_b32 v25, 64, v24
v_lshrrev_b32 v8, 2, v29
v_and_b32 v9, 1, v26
v_lshl_add_u32 v9, v9, 2, v8
v_lshl_add_u32 v8, v26, 3, v8
v_lshlrev_b32 v8, 8, v8
v_lshl_add_u32 v8, v9, 5, v8
v_and_b32 v29, 3, v0
v_lshl_add_u32 v8, v29, 3, v8
s_and_b32 s74, s58, 1
s_lshl_b32 s75, s74, 7
v_xor_b32 v20, s75, v8
v_xor_b32 v21, 32, v20
v_xor_b32 v22, 64, v20
v_xor_b32 v23, 96, v20
s_nop 3
s_mov_b64 exec, 0
s_cmp_eq_u32 s58, 0
s_cbranch_scc1 Lstuba0
s_cmp_eq_u32 s58, 1
s_cbranch_scc1 Lstuba1
s_cmp_eq_u32 s58, 2
s_cbranch_scc1 Lstuba2
s_branch Lstuba3
Lreta:
s_mov_b64 exec, -1
s_nop 3
s_waitcnt vmcnt(7) lgkmcnt(0)
s_barrier
ds_read_b64_tr_b16 v[224:225], v20 offset:0
ds_read_b64_tr_b16 v[226:227], v20 offset:1024
ds_read_b64_tr_b16 v[228:229], v20 offset:8192
ds_read_b64_tr_b16 v[230:231], v20 offset:9216
ds_read_b128 v[128:131], v24 offset:0
ds_read_b128 v[132:135], v25 offset:0
ds_read_b128 v[136:139], v24 offset:2048
ds_read_b128 v[140:143], v25 offset:2048
ds_read_b128 v[144:147], v24 offset:4096
ds_read_b128 v[148:151], v25 offset:4096
ds_read_b128 v[152:155], v24 offset:6144
ds_read_b128 v[156:159], v25 offset:6144
s_waitcnt lgkmcnt(6)
v_mfma_f32_16x16x32_bf16 a[0:3], v[224:227], v[128:131], 0
s_add_u32 m0, s64, 32768
ds_read_b128 v[160:163], v24 offset:8192
v_mfma_f32_16x16x32_bf16 a[0:3], v[228:231], v[132:135], a[0:3]
s_waitcnt lgkmcnt(5)
ds_read_b128 v[164:167], v25 offset:8192
v_mfma_f32_16x16x32_bf16 a[4:7], v[228:231], v[140:143], 0
s_add_u32 s72, s71, 0
ds_read_b128 v[168:171], v24 offset:10240
v_mfma_f32_16x16x32_bf16 a[4:7], v[224:227], v[136:139], a[4:7]
s_waitcnt lgkmcnt(5)
ds_read_b128 v[172:175], v25 offset:10240
v_mfma_f32_16x16x32_bf16 a[8:11], v[224:227], v[144:147], 0
s_mov_b32 s6, 0x400000
ds_read_b128 v[176:179], v24 offset:12288
v_mfma_f32_16x16x32_bf16 a[8:11], v[228:231], v[148:151], a[8:11]
s_waitcnt lgkmcnt(5)
ds_read_b128 v[180:183], v25 offset:12288
v_mfma_f32_16x16x32_bf16 a[12:15], v[228:231], v[156:159], 0
s_mov_b32 s7, 0x20000
ds_read_b128 v[184:187], v24 offset:14336
v_mfma_f32_16x16x32_bf16 a[12:15], v[224:227], v[152:155], a[12:15]
s_waitcnt lgkmcnt(5)
ds_read_b128 v[188:191], v25 offset:14336
v_mfma_f32_16x16x32_bf16 a[16:19], v[224:227], v[160:163], 0
s_mov_b32 s14, 0x800000
ds_read_b64_tr_b16 v[232:233], v21 offset:0
ds_read_b64_tr_b16 v[234:235], v21 offset:1024
v_mfma_f32_16x16x32_bf16 a[16:19], v[228:231], v[164:167], a[16:19]
s_waitcnt lgkmcnt(6)
ds_read_b64_tr_b16 v[236:237], v21 offset:8192
ds_read_b64_tr_b16 v[238:239], v21 offset:9216
v_mfma_f32_16x16x32_bf16 a[20:23], v[228:231], v[172:175], 0
s_mov_b32 s15, 0x20000
buffer_load_dwordx4 v6, s[16:19], s72 offen lds
v_mfma_f32_16x16x32_bf16 a[20:23], v[224:227], v[168:171], a[20:23]
s_waitcnt lgkmcnt(6)
ds_read_b64_tr_b16 v[240:241], v22 offset:0
ds_read_b64_tr_b16 v[242:243], v22 offset:1024
v_mfma_f32_16x16x32_bf16 a[24:27], v[224:227], v[176:179], 0
s_add_u32 s72, s71, 31744
buffer_load_dwordx4 v6, s[16:19], s72 offen offset:1024 lds
v_mfma_f32_16x16x32_bf16 a[24:27], v[228:231], v[180:183], a[24:27]
s_waitcnt lgkmcnt(6)
ds_read_b64_tr_b16 v[244:245], v22 offset:8192
ds_read_b64_tr_b16 v[246:247], v22 offset:9216
v_mfma_f32_16x16x32_bf16 a[28:31], v[228:231], v[188:191], 0
s_add_u32 s72, s71, 63488
buffer_load_dwordx4 v7, s[16:19], s72 offen offset:2048 lds
v_mfma_f32_16x16x32_bf16 a[28:31], v[224:227], v[184:187], a[28:31]
s_waitcnt lgkmcnt(4)
v_mfma_f32_16x16x32_bf16 a[60:63], v[232:235], v[184:187], 0
s_add_u32 s72, s71, 95232
buffer_load_dwordx4 v7, s[16:19], s72 offen offset:3072 lds
v_mfma_f32_16x16x32_bf16 a[60:63], v[236:239], v[188:191], a[60:63]
s_mov_b32 s26, 0x800000
ds_read_b64_tr_b16 v[248:249], v23 offset:0
v_mfma_f32_16x16x32_bf16 a[56:59], v[236:239], v[180:183], 0
s_mov_b32 s27, 0x20000
v_mfma_f32_16x16x32_bf16 a[56:59], v[232:235], v[176:179], a[56:59]
s_mov_b32 s30, 0x400000
ds_read_b64_tr_b16 v[250:251], v23 offset:1024
v_mfma_f32_16x16x32_bf16 a[52:55], v[232:235], v[168:171], 0
s_add_u32 m0, s63, 102400
v_mfma_f32_16x16x32_bf16 a[52:55], v[236:239], v[172:175], a[52:55]
s_add_u32 s72, s69, 32768
buffer_load_dwordx4 v2, s[8:11], s72 offen lds
v_mfma_f32_16x16x32_bf16 a[48:51], v[236:239], v[164:167], 0
s_mov_b32 s31, 0x20000
v_mfma_f32_16x16x32_bf16 a[48:51], v[232:235], v[160:163], a[48:51]
s_mov_b32 s34, 0x400000
ds_read_b64_tr_b16 v[252:253], v23 offset:8192
v_mfma_f32_16x16x32_bf16 a[44:47], v[232:235], v[152:155], 0
s_mov_b32 s35, 0x20000
v_mfma_f32_16x16x32_bf16 a[44:47], v[236:239], v[156:159], a[44:47]
s_add_u32 s72, s69, 39936
buffer_load_dwordx4 v3, s[8:11], s72 offen offset:1024 lds
v_mfma_f32_16x16x32_bf16 a[40:43], v[236:239], v[148:151], 0
s_mov_b32 s38, 0x400000
v_mfma_f32_16x16x32_bf16 a[40:43], v[232:235], v[144:147], a[40:43]
s_mov_b32 s39, 0x20000
ds_read_b64_tr_b16 v[254:255], v23 offset:9216
v_mfma_f32_16x16x32_bf16 a[36:39], v[232:235], v[136:139], 0
s_mov_b32 s42, 0x400000
v_mfma_f32_16x16x32_bf16 a[36:39], v[236:239], v[140:143], a[36:39]
s_mov_b32 s43, 0x20000
v_mfma_f32_16x16x32_bf16 a[32:35], v[236:239], v[132:135], 0
s_add_u32 s72, s69, 47104
buffer_load_dwordx4 v2, s[8:11], s72 offen offset:2048 lds
v_mfma_f32_16x16x32_bf16 a[32:35], v[232:235], v[128:131], a[32:35]
s_waitcnt lgkmcnt(4)
v_mfma_f32_16x16x32_bf16 a[64:67], v[240:243], v[128:131], 0
s_mov_b32 s46, 0x5800000
ds_read_b64_tr_b16 v[224:225], v20 offset:16384
v_mfma_f32_16x16x32_bf16 a[64:67], v[244:247], v[132:135], a[64:67]
s_mov_b32 s47, 0x20000
v_mfma_f32_16x16x32_bf16 a[68:71], v[244:247], v[140:143], 0
s_mov_b32 s50, 0x100
ds_read_b64_tr_b16 v[226:227], v20 offset:17408
v_mfma_f32_16x16x32_bf16 a[68:71], v[240:243], v[136:139], a[68:71]
s_add_u32 s72, s69, 54272
buffer_load_dwordx4 v3, s[8:11], s72 offen offset:3072 lds
v_mfma_f32_16x16x32_bf16 a[72:75], v[240:243], v[144:147], 0
s_mov_b32 s51, 0x20000
v_lshl_add_u32 v4, v28, 11, v27
v_xor_b32 v5, 64, v4
v_mfma_f32_16x16x32_bf16 a[72:75], v[244:247], v[148:151], a[72:75]
v_lshlrev_b32 v1, 4, v0
v_mfma_f32_16x16x32_bf16 a[76:79], v[244:247], v[156:159], 0
s_sub_u32 s74, 15, s60
ds_read_b64_tr_b16 v[228:229], v20 offset:24576
v_mfma_f32_16x16x32_bf16 a[76:79], v[240:243], v[152:155], a[76:79]
s_lshl_b32 s68, s74, 18
v_mfma_f32_16x16x32_bf16 a[80:83], v[240:243], v[160:163], 0
s_add_u32 m0, s64, 49152
v_mfma_f32_16x16x32_bf16 a[80:83], v[244:247], v[164:167], a[80:83]
s_add_u32 s72, s71, 0
buffer_load_dwordx4 v6, s[20:23], s72 offen lds
v_mfma_f32_16x16x32_bf16 a[84:87], v[244:247], v[172:175], 0
s_lshl_b32 s76, s58, 15
ds_read_b64_tr_b16 v[230:231], v20 offset:25600
v_mfma_f32_16x16x32_bf16 a[84:87], v[240:243], v[168:171], a[84:87]
s_add_u32 s68, s68, s76
v_mfma_f32_16x16x32_bf16 a[88:91], v[240:243], v[176:179], 0
s_add_u32 s67, s67, s76
v_mfma_f32_16x16x32_bf16 a[88:91], v[244:247], v[180:183], a[88:91]
s_add_u32 s72, s71, 31744
buffer_load_dwordx4 v6, s[20:23], s72 offen offset:1024 lds
v_mfma_f32_16x16x32_bf16 a[92:95], v[244:247], v[188:191], 0
s_and_b32 s62, s60, 3
v_mfma_f32_16x16x32_bf16 a[92:95], v[240:243], v[184:187], a[92:95]
s_waitcnt lgkmcnt(4)
v_mfma_f32_16x16x32_bf16 a[124:127], v[248:251], v[184:187], 0
s_sub_u32 s62, 16, s62
ds_read_b64_tr_b16 v[232:233], v21 offset:16384
v_mfma_f32_16x16x32_bf16 a[124:127], v[252:255], v[188:191], a[124:127]
s_lshl_b32 s91, s91, 7
v_mfma_f32_16x16x32_bf16 a[120:123], v[252:255], v[180:183], 0
s_add_u32 s72, s71, 63488
buffer_load_dwordx4 v7, s[20:23], s72 offen offset:2048 lds
v_mfma_f32_16x16x32_bf16 a[120:123], v[248:251], v[176:179], a[120:123]
s_add_u32 s91, s91, 0x3810000
ds_read_b64_tr_b16 v[234:235], v21 offset:17408
v_lshrrev_b32 v34, 3, v0
v_mfma_f32_16x16x32_bf16 a[116:119], v[248:251], v[168:171], 0
v_or_b32 v34, s58, v34
v_min_u32 v34, 1, v34
v_mfma_f32_16x16x32_bf16 a[116:119], v[252:255], v[172:175], a[116:119]
v_lshlrev_b32 v34, 28, v34
v_add_lshl_u32 v34, v34, v0, 2
v_mfma_f32_16x16x32_bf16 a[112:115], v[252:255], v[164:167], 0
ds_read_b64_tr_b16 v[236:237], v21 offset:24576
v_mov_b32 v35, 0
v_mfma_f32_16x16x32_bf16 a[112:115], v[248:251], v[160:163], a[112:115]
s_add_u32 s72, s71, 95232
buffer_load_dwordx4 v7, s[20:23], s72 offen offset:3072 lds
v_mfma_f32_16x16x32_bf16 a[108:111], v[248:251], v[152:155], 0
s_lshr_b32 s80, s61, 1
buffer_store_dword v35, v34, s[44:47], s91 offen sc1
v_mfma_f32_16x16x32_bf16 a[108:111], v[252:255], v[156:159], a[108:111]
s_xor_b32 s80, s80, 1
ds_read_b64_tr_b16 v[238:239], v21 offset:25600
v_mfma_f32_16x16x32_bf16 a[104:107], v[252:255], v[148:151], 0
s_lshl_b32 s80, s80, 20
buffer_load_dword v126, v125, s[16:19], s80 offen
v_mfma_f32_16x16x32_bf16 a[104:107], v[248:251], v[144:147], a[104:107]
s_xor_b32 s83, s2, 5
buffer_load_dword v126, v125, s[20:23], s80 offen
v_mfma_f32_16x16x32_bf16 a[100:103], v[248:251], v[136:139], 0
s_and_b32 s83, s83, 15
v_mfma_f32_16x16x32_bf16 a[100:103], v[252:255], v[140:143], a[100:103]
s_lshr_b32 s74, s2, 4
v_mfma_f32_16x16x32_bf16 a[96:99], v[252:255], v[132:135], 0
s_lshl_b32 s74, s74, 7
v_mfma_f32_16x16x32_bf16 a[96:99], v[248:251], v[128:131], a[96:99]
s_waitcnt lgkmcnt(4)
v_mfma_f32_16x16x32_bf16 a[128:131], v[128:131], v[224:227], 0
s_lshl_b32 s75, s58, 5
ds_read_b64_tr_b16 v[240:241], v22 offset:16384
v_mfma_f32_16x16x32_bf16 a[128:131], v[132:135], v[228:231], a[128:131]
s_add_u32 s74, s74, s75
v_mfma_f32_16x16x32_bf16 a[132:135], v[140:143], v[228:231], 0
s_mov_b32 s75, 131072
v_lshrrev_b32 v29, 5, v0
v_lshlrev_b32 v29, 4, v29
v_mfma_f32_16x16x32_bf16 a[132:135], v[136:139], v[224:227], a[132:135]
ds_read_b64_tr_b16 v[242:243], v22 offset:17408
v_add_u32 v29, s74, v29
v_mfma_f32_16x16x32_bf16 a[136:139], v[144:147], v[224:227], 0
v_and_b32 v30, 31, v0
v_mfma_f32_16x16x32_bf16 a[136:139], v[148:151], v[228:231], a[136:139]
s_lshl_b32 s83, s83, 5
v_add_u32 v30, s83, v30
v_lshlrev_b32 v26, 11, v29
v_mfma_f32_16x16x32_bf16 a[140:143], v[156:159], v[228:231], 0
v_lshl_add_u32 v26, v30, 2, v26
v_subrev_u32 v27, 0x1800, v26
v_mfma_f32_16x16x32_bf16 a[140:143], v[152:155], v[224:227], a[140:143]
s_lshl_b32 s82, s74, 11
ds_read_b64_tr_b16 v[244:245], v22 offset:24576
v_mfma_f32_16x16x32_bf16 a[144:147], v[160:163], v[224:227], 0
s_lshl_b32 s83, s83, 2
v_mfma_f32_16x16x32_bf16 a[144:147], v[164:167], v[228:231], a[144:147]
s_add_u32 s82, s82, s83
v_lshrrev_b32 v26, 3, v0
v_and_b32 v32, 7, v0
v_mfma_f32_16x16x32_bf16 a[148:151], v[172:175], v[228:231], 0
ds_read_b64_tr_b16 v[246:247], v22 offset:25600
v_lshlrev_b32 v32, 4, v32
v_mfma_f32_16x16x32_bf16 a[148:151], v[168:171], v[224:227], a[148:151]
v_lshl_add_u32 v26, v26, 11, v32
v_lshrrev_b32 v98, 5, v0
v_mfma_f32_16x16x32_bf16 a[152:155], v[176:179], v[224:227], 0
v_lshlrev_b32 v98, 11, v98
v_and_b32 v32, 31, v0
v_mfma_f32_16x16x32_bf16 a[152:155], v[180:183], v[228:231], a[152:155]
v_lshl_add_u32 v98, v32, 2, v98
v_add_u32 v98, s63, v98
v_mfma_f32_16x16x32_bf16 a[156:159], v[188:191], v[228:231], 0
v_add_u32 v98, s75, v98
v_and_b32 v29, 0x7f, v29
v_mfma_f32_16x16x32_bf16 a[156:159], v[184:187], v[224:227], a[156:159]
s_waitcnt lgkmcnt(4)
v_sub_u32 v29, 0x70, v29
v_lshlrev_b32 v29, 1, v29
v_mfma_f32_16x16x32_bf16 a[188:191], v[184:187], v[232:235], 0
ds_read_b64_tr_b16 v[248:249], v23 offset:16384
v_and_b32 v32, 7, v0
v_mfma_f32_16x16x32_bf16 a[188:191], v[188:191], v[236:239], a[188:191]
v_mul_u32_u24 v32, 544, v32
v_add3_u32 v28, v32, v29, s75
v_mfma_f32_16x16x32_bf16 a[184:187], v[180:183], v[236:239], 0
ds_read_b64_tr_b16 v[250:251], v23 offset:17408
v_bfe_u32 v32, v0, 3, 2
v_mfma_f32_16x16x32_bf16 a[184:187], v[176:179], v[232:235], a[184:187]
v_lshl_add_u32 v28, v32, 13, v28
v_lshlrev_b32 v30, 4, v30
v_mfma_f32_16x16x32_bf16 a[180:183], v[168:171], v[232:235], 0
s_lshl_b32 s83, s2, 14
ds_read_b64_tr_b16 v[252:253], v23 offset:24576
v_mfma_f32_16x16x32_bf16 a[180:183], v[172:175], v[236:239], a[180:183]
s_lshl_b32 s74, s58, 12
s_branch Lmain
.p2align 12
Lmain:
v_mfma_f32_16x16x32_bf16 a[176:179], v[164:167], v[236:239], 0
s_add_u32 s76, s83, s74
ds_read_b64_tr_b16 v[254:255], v23 offset:25600
v_mfma_f32_16x16x32_bf16 a[176:179], v[160:163], v[232:235], a[176:179]
Lstuba0:
s_cbranch_execz Lreta
v_add_u32 v16, s63, v16
v_add_u32 v16, 131072, v16
v_mfma_f32_16x16x32_bf16 a[172:175], v[152:155], v[232:235], 0
s_xor_b32 s73, s61, 2
v_xor_b32 v17, 64, v16
v_subrev_u32 v18, 0x10000, v16
v_mfma_f32_16x16x32_bf16 a[172:175], v[156:159], v[236:239], a[172:175]
s_lshl_b32 s69, s73, 7
v_subrev_u32 v19, 0x10000, v17
v_xor_b32 v9, 32, v8
v_mfma_f32_16x16x32_bf16 a[168:171], v[148:151], v[236:239], 0
s_add_u32 s69, s69, s84
v_xor_b32 v10, 64, v8
v_xor_b32 v11, 96, v8
v_mfma_f32_16x16x32_bf16 a[168:171], v[144:147], v[232:235], a[168:171]
s_lshl_b32 s71, s73, 19
v_xor_b32 v12, 128, v8
v_xor_b32 v13, 160, v8
v_mfma_f32_16x16x32_bf16 a[164:167], v[136:139], v[232:235], 0
s_add_u32 s71, s71, s66
v_xor_b32 v14, 192, v8
v_xor_b32 v15, 224, v8
v_mfma_f32_16x16x32_bf16 a[164:167], v[140:143], v[236:239], a[164:167]
s_add_u32 m0, s63, 65536
v_mfma_f32_16x16x32_bf16 a[160:163], v[132:135], v[236:239], 0
s_waitcnt vmcnt(3) lgkmcnt(0)
v_mfma_f32_16x16x32_bf16 a[160:163], v[128:131], v[232:235], a[160:163]
s_barrier
v_mfma_f32_16x16x32_bf16 a[192:195], v[128:131], v[240:243], 0
s_add_u32 s72, s69, 0
buffer_load_dwordx4 v2, s[8:11], s72 offen lds
v_mfma_f32_16x16x32_bf16 a[192:195], v[132:135], v[244:247], a[192:195]
s_lshl_b32 s77, s59, 20
ds_read_b64_tr_b16 v[224:225], v20 offset:32768
v_mfma_f32_16x16x32_bf16 a[196:199], v[140:143], v[244:247], 0
s_add_u32 s81, s77, s64
ds_read_b64_tr_b16 v[226:227], v20 offset:33792
v_mfma_f32_16x16x32_bf16 a[196:199], v[136:139], v[240:243], a[196:199]
s_sub_u32 s81, s81, 0x4000
ds_read_b64_tr_b16 v[228:229], v20 offset:40960
v_mfma_f32_16x16x32_bf16 a[200:203], v[144:147], v[240:243], 0
s_add_u32 s72, s69, 7168
buffer_load_dwordx4 v3, s[8:11], s72 offen offset:1024 lds
v_mfma_f32_16x16x32_bf16 a[200:203], v[148:151], v[244:247], a[200:203]
s_lshl_b32 s75, s60, 17
ds_read_b64_tr_b16 v[230:231], v20 offset:41984
v_mfma_f32_16x16x32_bf16 a[204:207], v[156:159], v[244:247], 0
s_add_u32 s77, s77, s75
ds_read_b128 v[192:195], v24 offset:32768
v_mfma_f32_16x16x32_bf16 a[204:207], v[152:155], v[240:243], a[204:207]
s_lshr_b32 s75, s58, 1
ds_read_b128 v[196:199], v25 offset:32768
v_mfma_f32_16x16x32_bf16 a[208:211], v[160:163], v[240:243], 0
s_add_u32 s72, s69, 14336
buffer_load_dwordx4 v2, s[8:11], s72 offen offset:2048 lds
v_mfma_f32_16x16x32_bf16 a[208:211], v[164:167], v[244:247], a[208:211]
s_lshl_b32 s75, s75, 16
ds_read_b128 v[200:203], v24 offset:34816
v_mfma_f32_16x16x32_bf16 a[212:215], v[172:175], v[244:247], 0
s_add_u32 s77, s77, s75
ds_read_b128 v[204:207], v25 offset:34816
v_mfma_f32_16x16x32_bf16 a[212:215], v[168:171], v[240:243], a[212:215]
s_and_b32 s74, s58, 1
ds_read_b128 v[208:211], v24 offset:36864
v_mfma_f32_16x16x32_bf16 a[216:219], v[176:179], v[240:243], 0
s_add_u32 s72, s69, 21504
buffer_load_dwordx4 v3, s[8:11], s72 offen offset:3072 lds
v_mfma_f32_16x16x32_bf16 a[216:219], v[180:183], v[244:247], a[216:219]
s_lshl_b32 s75, s74, 12
ds_read_b128 v[212:215], v25 offset:36864
v_mfma_f32_16x16x32_bf16 a[220:223], v[188:191], v[244:247], 0
s_add_u32 s78, s77, s75
ds_read_b128 v[216:219], v24 offset:38912
v_mfma_f32_16x16x32_bf16 a[220:223], v[184:187], v[240:243], a[220:223]
s_add_u32 s78, s78, 0x4000
ds_read_b128 v[220:223], v25 offset:38912
v_mfma_f32_16x16x32_bf16 a[252:255], v[184:187], v[248:251], 0
s_add_u32 m0, s64, 0
v_mfma_f32_16x16x32_bf16 a[252:255], v[188:191], v[252:255], a[252:255]
s_add_u32 s72, s71, 0
buffer_load_dwordx4 v6, s[16:19], s72 offen lds
v_mfma_f32_16x16x32_bf16 a[248:251], v[180:183], v[252:255], 0
s_lshl_b32 s75, s74, 11
ds_read_b128 v[184:187], v24 offset:40960
v_mfma_f32_16x16x32_bf16 a[248:251], v[176:179], v[248:251], a[248:251]
s_add_u32 s77, s77, s75
ds_read_b128 v[188:191], v25 offset:40960
v_mfma_f32_16x16x32_bf16 a[244:247], v[168:171], v[248:251], 0
s_mov_b32 s79, 0x3e0293ee
v_mfma_f32_16x16x32_bf16 a[244:247], v[172:175], v[252:255], a[244:247]
s_add_u32 s72, s71, 31744
buffer_load_dwordx4 v6, s[16:19], s72 offen offset:1024 lds
v_mfma_f32_16x16x32_bf16 a[240:243], v[164:167], v[252:255], 0
ds_read_b128 v[176:179], v24 offset:43008
v_mfma_f32_16x16x32_bf16 a[240:243], v[160:163], v[248:251], a[240:243]
ds_read_b128 v[180:183], v25 offset:43008
v_mfma_f32_16x16x32_bf16 a[236:239], v[152:155], v[248:251], 0
ds_read_b128 v[168:171], v24 offset:45056
v_mfma_f32_16x16x32_bf16 a[236:239], v[156:159], v[252:255], a[236:239]
s_add_u32 s72, s71, 63488
buffer_load_dwordx4 v7, s[16:19], s72 offen offset:2048 lds
v_mfma_f32_16x16x32_bf16 a[232:235], v[148:151], v[252:255], 0
ds_read_b128 v[172:175], v25 offset:45056
v_mfma_f32_16x16x32_bf16 a[232:235], v[144:147], v[248:251], a[232:235]
ds_read_b128 v[160:163], v24 offset:47104
v_mfma_f32_16x16x32_bf16 a[228:231], v[136:139], v[248:251], 0
ds_read_b128 v[164:167], v25 offset:47104
v_mfma_f32_16x16x32_bf16 a[228:231], v[140:143], v[252:255], a[228:231]
s_add_u32 s72, s71, 95232
buffer_load_dwordx4 v7, s[16:19], s72 offen offset:3072 lds
v_mfma_f32_16x16x32_bf16 a[224:227], v[132:135], v[252:255], 0
ds_read_b64_tr_b16 v[232:233], v21 offset:32768
v_mfma_f32_16x16x32_bf16 a[224:227], v[128:131], v[248:251], a[224:227]
s_waitcnt lgkmcnt(9)
ds_read_b64_tr_b16 v[234:235], v21 offset:33792
v_mfma_f32_16x16x32_bf16 a[0:3], v[224:227], v[192:195], a[0:3]
ds_read_b64_tr_b16 v[240:241], v22 offset:32768
v_mfma_f32_16x16x32_bf16 a[0:3], v[228:231], v[196:199], a[0:3]
s_add_u32 m0, s63, 69632
ds_read_b64_tr_b16 v[236:237], v21 offset:40960
v_mfma_f32_16x16x32_bf16 a[4:7], v[228:231], v[204:207], a[4:7]
s_add_u32 s72, s69, 32768
buffer_load_dwordx4 v2, s[8:11], s72 offen lds
v_mfma_f32_16x16x32_bf16 a[4:7], v[224:227], v[200:203], a[4:7]
v_mfma_f32_16x16x32_bf16 a[8:11], v[224:227], v[208:211], a[8:11]
ds_read_b64_tr_b16 v[238:239], v21 offset:41984
v_mfma_f32_16x16x32_bf16 a[8:11], v[228:231], v[212:215], a[8:11]
ds_read_b64_tr_b16 v[242:243], v22 offset:33792
v_mfma_f32_16x16x32_bf16 a[12:15], v[228:231], v[220:223], a[12:15]
s_add_u32 s72, s69, 39936
buffer_load_dwordx4 v3, s[8:11], s72 offen offset:1024 lds
v_mfma_f32_16x16x32_bf16 a[12:15], v[224:227], v[216:219], a[12:15]
s_waitcnt lgkmcnt(6)
v_mfma_f32_16x16x32_bf16 a[16:19], v[224:227], v[184:187], a[16:19]
ds_read_b64_tr_b16 v[244:245], v22 offset:40960
v_mfma_f32_16x16x32_bf16 a[16:19], v[228:231], v[188:191], a[16:19]
v_mfma_f32_16x16x32_bf16 a[20:23], v[228:231], v[180:183], a[20:23]
s_add_u32 s72, s69, 47104
buffer_load_dwordx4 v2, s[8:11], s72 offen offset:2048 lds
v_mfma_f32_16x16x32_bf16 a[20:23], v[224:227], v[176:179], a[20:23]
ds_read_b64_tr_b16 v[246:247], v22 offset:41984
v_mfma_f32_16x16x32_bf16 a[24:27], v[224:227], v[168:171], a[24:27]
v_mfma_f32_16x16x32_bf16 a[24:27], v[228:231], v[172:175], a[24:27]
v_mfma_f32_16x16x32_bf16 a[28:31], v[228:231], v[164:167], a[28:31]
s_add_u32 s72, s69, 54272
buffer_load_dwordx4 v3, s[8:11], s72 offen offset:3072 lds
v_mfma_f32_16x16x32_bf16 a[28:31], v[224:227], v[160:163], a[28:31]
s_waitcnt lgkmcnt(3)
v_mfma_f32_16x16x32_bf16 a[60:63], v[232:235], v[160:163], a[60:63]
ds_read_b64_tr_b16 v[248:249], v23 offset:32768
v_mfma_f32_16x16x32_bf16 a[60:63], v[236:239], v[164:167], a[60:63]
v_mfma_f32_16x16x32_bf16 a[56:59], v[236:239], v[172:175], a[56:59]
s_add_u32 m0, s64, 16384
ds_read_b64_tr_b16 v[250:251], v23 offset:33792
v_mfma_f32_16x16x32_bf16 a[56:59], v[232:235], v[168:171], a[56:59]
s_add_u32 s72, s71, 0
buffer_load_dwordx4 v6, s[20:23], s72 offen lds
v_mfma_f32_16x16x32_bf16 a[52:55], v[232:235], v[176:179], a[52:55]
v_mfma_f32_16x16x32_bf16 a[52:55], v[236:239], v[180:183], a[52:55]
v_mfma_f32_16x16x32_bf16 a[48:51], v[236:239], v[188:191], a[48:51]
ds_read_b64_tr_b16 v[252:253], v23 offset:40960
v_mfma_f32_16x16x32_bf16 a[48:51], v[232:235], v[184:187], a[48:51]
s_add_u32 s72, s71, 31744
buffer_load_dwordx4 v6, s[20:23], s72 offen offset:1024 lds
v_mfma_f32_16x16x32_bf16 a[44:47], v[232:235], v[216:219], a[44:47]
v_mfma_f32_16x16x32_bf16 a[44:47], v[236:239], v[220:223], a[44:47]
v_mfma_f32_16x16x32_bf16 a[40:43], v[236:239], v[212:215], a[40:43]
ds_read_b64_tr_b16 v[254:255], v23 offset:41984
v_mfma_f32_16x16x32_bf16 a[40:43], v[232:235], v[208:211], a[40:43]
s_add_u32 s72, s71, 63488
buffer_load_dwordx4 v7, s[20:23], s72 offen offset:2048 lds
v_mfma_f32_16x16x32_bf16 a[36:39], v[232:235], v[200:203], a[36:39]
v_mfma_f32_16x16x32_bf16 a[36:39], v[236:239], v[204:207], a[36:39]
v_mfma_f32_16x16x32_bf16 a[32:35], v[236:239], v[196:199], a[32:35]
s_add_u32 s72, s71, 95232
v_mfma_f32_16x16x32_bf16 a[32:35], v[232:235], v[192:195], a[32:35]
s_waitcnt lgkmcnt(4)
buffer_load_dwordx4 v7, s[20:23], s72 offen offset:3072 lds
v_mfma_f32_16x16x32_bf16 a[64:67], v[240:243], v[192:195], a[64:67]
ds_read_b64_tr_b16 v[224:225], v20 offset:49152
v_mfma_f32_16x16x32_bf16 a[64:67], v[244:247], v[196:199], a[64:67]
v_mfma_f32_16x16x32_bf16 a[68:71], v[244:247], v[204:207], a[68:71]
ds_read_b64_tr_b16 v[226:227], v20 offset:50176
v_mfma_f32_16x16x32_bf16 a[68:71], v[240:243], v[200:203], a[68:71]
s_lshr_b32 s80, s61, 1
v_mfma_f32_16x16x32_bf16 a[72:75], v[240:243], v[208:211], a[72:75]
s_xor_b32 s80, s80, 2
v_mfma_f32_16x16x32_bf16 a[72:75], v[244:247], v[212:215], a[72:75]
s_lshl_b32 s80, s80, 20
buffer_load_dword v126, v125, s[16:19], s80 offen
v_mfma_f32_16x16x32_bf16 a[76:79], v[244:247], v[220:223], a[76:79]
ds_read_b64_tr_b16 v[228:229], v20 offset:57344
v_mfma_f32_16x16x32_bf16 a[76:79], v[240:243], v[216:219], a[76:79]
v_mfma_f32_16x16x32_bf16 a[80:83], v[240:243], v[184:187], a[80:83]
v_mfma_f32_16x16x32_bf16 a[80:83], v[244:247], v[188:191], a[80:83]
buffer_load_dword v126, v125, s[20:23], s80 offen
v_mfma_f32_16x16x32_bf16 a[84:87], v[244:247], v[180:183], a[84:87]
ds_read_b64_tr_b16 v[230:231], v20 offset:58368
v_mfma_f32_16x16x32_bf16 a[84:87], v[240:243], v[176:179], a[84:87]
v_mfma_f32_16x16x32_bf16 a[88:91], v[240:243], v[168:171], a[88:91]
v_mfma_f32_16x16x32_bf16 a[88:91], v[244:247], v[172:175], a[88:91]
global_load_dwordx4 v[68:71], v30, s[52:53]
v_mfma_f32_16x16x32_bf16 a[92:95], v[244:247], v[164:167], a[92:95]
v_mfma_f32_16x16x32_bf16 a[92:95], v[240:243], v[160:163], a[92:95]
s_waitcnt lgkmcnt(4)
v_mfma_f32_16x16x32_bf16 a[124:127], v[248:251], v[160:163], a[124:127]
ds_read_b64_tr_b16 v[232:233], v21 offset:49152
v_mfma_f32_16x16x32_bf16 a[124:127], v[252:255], v[164:167], a[124:127]
buffer_load_dword v33, v27, s[28:31], 0 offen nt
v_mfma_f32_16x16x32_bf16 a[120:123], v[252:255], v[172:175], a[120:123]
v_mfma_f32_16x16x32_bf16 a[120:123], v[248:251], v[168:171], a[120:123]
ds_read_b64_tr_b16 v[234:235], v21 offset:50176
v_mfma_f32_16x16x32_bf16 a[116:119], v[248:251], v[176:179], a[116:119]
v_mfma_f32_16x16x32_bf16 a[116:119], v[252:255], v[180:183], a[116:119]
buffer_load_dword v34, v27, s[28:31], 0 offen offset:2048 nt
v_mfma_f32_16x16x32_bf16 a[112:115], v[252:255], v[188:191], a[112:115]
v_mfma_f32_16x16x32_bf16 a[112:115], v[248:251], v[184:187], a[112:115]
ds_read_b64_tr_b16 v[236:237], v21 offset:57344
v_mfma_f32_16x16x32_bf16 a[108:111], v[248:251], v[216:219], a[108:111]
v_mfma_f32_16x16x32_bf16 a[108:111], v[252:255], v[220:223], a[108:111]
v_add_u32 v27, 0x1000, v27
v_mfma_f32_16x16x32_bf16 a[104:107], v[252:255], v[212:215], a[104:107]
ds_read_b64_tr_b16 v[238:239], v21 offset:58368
v_mfma_f32_16x16x32_bf16 a[104:107], v[248:251], v[208:211], a[104:107]
v_mfma_f32_16x16x32_bf16 a[100:103], v[248:251], v[200:203], a[100:103]
v_mfma_f32_16x16x32_bf16 a[100:103], v[252:255], v[204:207], a[100:103]
buffer_load_dword v35, v27, s[28:31], 0 offen nt
v_mfma_f32_16x16x32_bf16 a[96:99], v[252:255], v[196:199], a[96:99]
v_mfma_f32_16x16x32_bf16 a[96:99], v[248:251], v[192:195], a[96:99]
s_waitcnt lgkmcnt(4)
v_mfma_f32_16x16x32_bf16 a[128:131], v[192:195], v[224:227], a[128:131]
ds_read_b64_tr_b16 v[240:241], v22 offset:49152
v_mfma_f32_16x16x32_bf16 a[128:131], v[196:199], v[228:231], a[128:131]
s_add_u32 m0, s63, 131072
v_mfma_f32_16x16x32_bf16 a[132:135], v[204:207], v[228:231], a[132:135]
s_add_u32 s80, s82, 0
buffer_load_dwordx4 v26, s[28:31], s80 offen nt lds
v_mfma_f32_16x16x32_bf16 a[132:135], v[200:203], v[224:227], a[132:135]
ds_read_b64_tr_b16 v[242:243], v22 offset:50176
v_mfma_f32_16x16x32_bf16 a[136:139], v[208:211], v[224:227], a[136:139]
v_mfma_f32_16x16x32_bf16 a[136:139], v[212:215], v[228:231], a[136:139]
v_mfma_f32_16x16x32_bf16 a[140:143], v[220:223], v[228:231], a[140:143]
s_add_u32 s80, s82, 15360
buffer_load_dwordx4 v26, s[28:31], s80 offen offset:1024 nt lds
v_mfma_f32_16x16x32_bf16 a[140:143], v[216:219], v[224:227], a[140:143]
ds_read_b64_tr_b16 v[244:245], v22 offset:57344
v_mfma_f32_16x16x32_bf16 a[144:147], v[184:187], v[224:227], a[144:147]
v_mfma_f32_16x16x32_bf16 a[144:147], v[188:191], v[228:231], a[144:147]
v_mfma_f32_16x16x32_bf16 a[148:151], v[180:183], v[228:231], a[148:151]
s_add_u32 s80, s82, 30720
buffer_load_dwordx4 v26, s[28:31], s80 offen offset:2048 nt lds
v_mfma_f32_16x16x32_bf16 a[148:151], v[176:179], v[224:227], a[148:151]
ds_read_b64_tr_b16 v[246:247], v22 offset:58368
v_mfma_f32_16x16x32_bf16 a[152:155], v[168:171], v[224:227], a[152:155]
v_mfma_f32_16x16x32_bf16 a[152:155], v[172:175], v[228:231], a[152:155]
v_mfma_f32_16x16x32_bf16 a[156:159], v[164:167], v[228:231], a[156:159]
s_add_u32 s80, s82, 46080
buffer_load_dwordx4 v26, s[28:31], s80 offen offset:3072 nt lds
v_mfma_f32_16x16x32_bf16 a[156:159], v[160:163], v[224:227], a[156:159]
s_waitcnt lgkmcnt(4)
v_mfma_f32_16x16x32_bf16 a[188:191], v[160:163], v[232:235], a[188:191]
ds_read_b64_tr_b16 v[248:249], v23 offset:49152
v_mfma_f32_16x16x32_bf16 a[188:191], v[164:167], v[236:239], a[188:191]
v_mfma_f32_16x16x32_bf16 a[184:187], v[172:175], v[236:239], a[184:187]
ds_read_b64_tr_b16 v[250:251], v23 offset:50176
v_mfma_f32_16x16x32_bf16 a[184:187], v[168:171], v[232:235], a[184:187]
v_mfma_f32_16x16x32_bf16 a[180:183], v[176:179], v[232:235], a[180:183]
ds_read_b64_tr_b16 v[252:253], v23 offset:57344
v_mfma_f32_16x16x32_bf16 a[180:183], v[180:183], v[236:239], a[180:183]
v_mfma_f32_16x16x32_bf16 a[176:179], v[188:191], v[236:239], a[176:179]
ds_read_b64_tr_b16 v[254:255], v23 offset:58368
v_mfma_f32_16x16x32_bf16 a[176:179], v[184:187], v[232:235], a[176:179]
v_mfma_f32_16x16x32_bf16 a[172:175], v[216:219], v[232:235], a[172:175]
s_xor_b32 s73, s61, 3
v_mfma_f32_16x16x32_bf16 a[172:175], v[220:223], v[236:239], a[172:175]
s_lshl_b32 s69, s73, 7
v_mfma_f32_16x16x32_bf16 a[168:171], v[212:215], v[236:239], a[168:171]
s_add_u32 s69, s69, s84
v_mfma_f32_16x16x32_bf16 a[168:171], v[208:211], v[232:235], a[168:171]
s_lshl_b32 s71, s73, 19
v_mfma_f32_16x16x32_bf16 a[164:167], v[200:203], v[232:235], a[164:167]
s_add_u32 s71, s71, s66
v_mfma_f32_16x16x32_bf16 a[164:167], v[204:207], v[236:239], a[164:167]
s_add_u32 m0, s63, 98304
v_mfma_f32_16x16x32_bf16 a[160:163], v[196:199], v[236:239], a[160:163]
s_waitcnt vmcnt(10) lgkmcnt(0)
v_mfma_f32_16x16x32_bf16 a[160:163], v[192:195], v[232:235], a[160:163]
s_barrier
v_mfma_f32_16x16x32_bf16 a[192:195], v[192:195], v[240:243], a[192:195]
s_add_u32 s72, s69, 0
buffer_load_dwordx4 v2, s[8:11], s72 offen lds
v_mfma_f32_16x16x32_bf16 a[192:195], v[196:199], v[244:247], a[192:195]
ds_read_b64_tr_b16 v[224:225], v20 offset:0
v_mfma_f32_16x16x32_bf16 a[196:199], v[204:207], v[244:247], a[196:199]
ds_read_b64_tr_b16 v[226:227], v20 offset:1024
v_mfma_f32_16x16x32_bf16 a[196:199], v[200:203], v[240:243], a[196:199]
ds_read_b64_tr_b16 v[228:229], v20 offset:8192
v_mfma_f32_16x16x32_bf16 a[200:203], v[208:211], v[240:243], a[200:203]
s_add_u32 s72, s69, 7168
buffer_load_dwordx4 v3, s[8:11], s72 offen offset:1024 lds
v_mfma_f32_16x16x32_bf16 a[200:203], v[212:215], v[244:247], a[200:203]
ds_read_b64_tr_b16 v[230:231], v20 offset:9216
v_mfma_f32_16x16x32_bf16 a[204:207], v[220:223], v[244:247], a[204:207]
ds_read_b128 v[128:131], v24 offset:0
v_mfma_f32_16x16x32_bf16 a[204:207], v[216:219], v[240:243], a[204:207]
ds_read_b128 v[132:135], v25 offset:0
v_mfma_f32_16x16x32_bf16 a[208:211], v[184:187], v[240:243], a[208:211]
s_add_u32 s72, s69, 14336
buffer_load_dwordx4 v2, s[8:11], s72 offen offset:2048 lds
v_mfma_f32_16x16x32_bf16 a[208:211], v[188:191], v[244:247], a[208:211]
ds_read_b128 v[136:139], v24 offset:2048
v_mfma_f32_16x16x32_bf16 a[212:215], v[180:183], v[244:247], a[212:215]
ds_read_b128 v[140:143], v25 offset:2048
v_mfma_f32_16x16x32_bf16 a[212:215], v[176:179], v[240:243], a[212:215]
ds_read_b128 v[144:147], v24 offset:4096
v_mfma_f32_16x16x32_bf16 a[216:219], v[168:171], v[240:243], a[216:219]
s_add_u32 s72, s69, 21504
buffer_load_dwordx4 v3, s[8:11], s72 offen offset:3072 lds
v_mfma_f32_16x16x32_bf16 a[216:219], v[172:175], v[244:247], a[216:219]
ds_read_b128 v[148:151], v25 offset:4096
v_mfma_f32_16x16x32_bf16 a[220:223], v[164:167], v[244:247], a[220:223]
ds_read_b128 v[152:155], v24 offset:6144
v_mfma_f32_16x16x32_bf16 a[220:223], v[160:163], v[240:243], a[220:223]
ds_read_b128 v[156:159], v25 offset:6144
v_mfma_f32_16x16x32_bf16 a[252:255], v[160:163], v[248:251], a[252:255]
s_add_u32 m0, s64, 32768
v_mfma_f32_16x16x32_bf16 a[252:255], v[164:167], v[252:255], a[252:255]
s_add_u32 s72, s71, 0
buffer_load_dwordx4 v6, s[16:19], s72 offen lds
v_mfma_f32_16x16x32_bf16 a[248:251], v[172:175], v[252:255], a[248:251]
ds_read_b128 v[160:163], v24 offset:8192
v_mfma_f32_16x16x32_bf16 a[248:251], v[168:171], v[248:251], a[248:251]
ds_read_b128 v[164:167], v25 offset:8192
v_mfma_f32_16x16x32_bf16 a[244:247], v[176:179], v[248:251], a[244:247]
v_mfma_f32_16x16x32_bf16 a[244:247], v[180:183], v[252:255], a[244:247]
s_add_u32 s72, s71, 31744
buffer_load_dwordx4 v6, s[16:19], s72 offen offset:1024 lds
v_mfma_f32_16x16x32_bf16 a[240:243], v[188:191], v[252:255], a[240:243]
ds_read_b128 v[168:171], v24 offset:10240
v_mfma_f32_16x16x32_bf16 a[240:243], v[184:187], v[248:251], a[240:243]
ds_read_b128 v[172:175], v25 offset:10240
v_mfma_f32_16x16x32_bf16 a[236:239], v[216:219], v[248:251], a[236:239]
ds_read_b128 v[176:179], v24 offset:12288
v_mfma_f32_16x16x32_bf16 a[236:239], v[220:223], v[252:255], a[236:239]
s_add_u32 s72, s71, 63488
buffer_load_dwordx4 v7, s[16:19], s72 offen offset:2048 lds
v_mfma_f32_16x16x32_bf16 a[232:235], v[212:215], v[252:255], a[232:235]
ds_read_b128 v[180:183], v25 offset:12288
v_mfma_f32_16x16x32_bf16 a[232:235], v[208:211], v[248:251], a[232:235]
ds_read_b128 v[184:187], v24 offset:14336
v_mfma_f32_16x16x32_bf16 a[228:231], v[200:203], v[248:251], a[228:231]
ds_read_b128 v[188:191], v25 offset:14336
v_mfma_f32_16x16x32_bf16 a[228:231], v[204:207], v[252:255], a[228:231]
s_add_u32 s72, s71, 95232
buffer_load_dwordx4 v7, s[16:19], s72 offen offset:3072 lds
v_mfma_f32_16x16x32_bf16 a[224:227], v[196:199], v[252:255], a[224:227]
ds_read_b64_tr_b16 v[232:233], v21 offset:0
v_mfma_f32_16x16x32_bf16 a[224:227], v[192:195], v[248:251], a[224:227]
s_waitcnt lgkmcnt(9)
ds_read_b64_tr_b16 v[234:235], v21 offset:1024
v_mfma_f32_16x16x32_bf16 a[0:3], v[224:227], v[128:131], a[0:3]
ds_read_b64_tr_b16 v[240:241], v22 offset:0
v_mfma_f32_16x16x32_bf16 a[0:3], v[228:231], v[132:135], a[0:3]
s_add_u32 m0, s63, 102400
ds_read_b64_tr_b16 v[236:237], v21 offset:8192
v_mfma_f32_16x16x32_bf16 a[4:7], v[228:231], v[140:143], a[4:7]
s_add_u32 s72, s69, 32768
buffer_load_dwordx4 v2, s[8:11], s72 offen lds
v_mfma_f32_16x16x32_bf16 a[4:7], v[224:227], v[136:139], a[4:7]
v_mfma_f32_16x16x32_bf16 a[8:11], v[224:227], v[144:147], a[8:11]
ds_read_b64_tr_b16 v[238:239], v21 offset:9216
v_mfma_f32_16x16x32_bf16 a[8:11], v[228:231], v[148:151], a[8:11]
ds_read_b64_tr_b16 v[242:243], v22 offset:1024
v_mfma_f32_16x16x32_bf16 a[12:15], v[228:231], v[156:159], a[12:15]
s_add_u32 s72, s69, 39936
buffer_load_dwordx4 v3, s[8:11], s72 offen offset:1024 lds
v_mfma_f32_16x16x32_bf16 a[12:15], v[224:227], v[152:155], a[12:15]
s_waitcnt lgkmcnt(6)
v_mfma_f32_16x16x32_bf16 a[16:19], v[224:227], v[160:163], a[16:19]
ds_read_b64_tr_b16 v[244:245], v22 offset:8192
v_mfma_f32_16x16x32_bf16 a[16:19], v[228:231], v[164:167], a[16:19]
v_mfma_f32_16x16x32_bf16 a[20:23], v[228:231], v[172:175], a[20:23]
s_add_u32 s72, s69, 47104
buffer_load_dwordx4 v2, s[8:11], s72 offen offset:2048 lds
v_mfma_f32_16x16x32_bf16 a[20:23], v[224:227], v[168:171], a[20:23]
ds_read_b64_tr_b16 v[246:247], v22 offset:9216
v_mfma_f32_16x16x32_bf16 a[24:27], v[224:227], v[176:179], a[24:27]
v_mfma_f32_16x16x32_bf16 a[24:27], v[228:231], v[180:183], a[24:27]
v_mfma_f32_16x16x32_bf16 a[28:31], v[228:231], v[188:191], a[28:31]
s_add_u32 s72, s69, 54272
buffer_load_dwordx4 v3, s[8:11], s72 offen offset:3072 lds
v_mfma_f32_16x16x32_bf16 a[28:31], v[224:227], v[184:187], a[28:31]
s_waitcnt lgkmcnt(3)
v_mfma_f32_16x16x32_bf16 a[60:63], v[232:235], v[184:187], a[60:63]
ds_read_b64_tr_b16 v[248:249], v23 offset:0
v_mfma_f32_16x16x32_bf16 a[60:63], v[236:239], v[188:191], a[60:63]
v_mfma_f32_16x16x32_bf16 a[56:59], v[236:239], v[180:183], a[56:59]
s_add_u32 m0, s64, 49152
ds_read_b64_tr_b16 v[250:251], v23 offset:1024
v_mfma_f32_16x16x32_bf16 a[56:59], v[232:235], v[176:179], a[56:59]
s_add_u32 s72, s71, 0
buffer_load_dwordx4 v6, s[20:23], s72 offen lds
v_mfma_f32_16x16x32_bf16 a[52:55], v[232:235], v[168:171], a[52:55]
v_mfma_f32_16x16x32_bf16 a[52:55], v[236:239], v[172:175], a[52:55]
v_mfma_f32_16x16x32_bf16 a[48:51], v[236:239], v[164:167], a[48:51]
ds_read_b64_tr_b16 v[252:253], v23 offset:8192
v_mfma_f32_16x16x32_bf16 a[48:51], v[232:235], v[160:163], a[48:51]
s_add_u32 s72, s71, 31744
buffer_load_dwordx4 v6, s[20:23], s72 offen offset:1024 lds
v_mfma_f32_16x16x32_bf16 a[44:47], v[232:235], v[152:155], a[44:47]
v_mfma_f32_16x16x32_bf16 a[44:47], v[236:239], v[156:159], a[44:47]
v_mfma_f32_16x16x32_bf16 a[40:43], v[236:239], v[148:151], a[40:43]
ds_read_b64_tr_b16 v[254:255], v23 offset:9216
v_mfma_f32_16x16x32_bf16 a[40:43], v[232:235], v[144:147], a[40:43]
s_add_u32 s72, s71, 63488
buffer_load_dwordx4 v7, s[20:23], s72 offen offset:2048 lds
v_mfma_f32_16x16x32_bf16 a[36:39], v[232:235], v[136:139], a[36:39]
v_mfma_f32_16x16x32_bf16 a[36:39], v[236:239], v[140:143], a[36:39]
v_mfma_f32_16x16x32_bf16 a[32:35], v[236:239], v[132:135], a[32:35]
s_add_u32 s72, s71, 95232
v_mfma_f32_16x16x32_bf16 a[32:35], v[232:235], v[128:131], a[32:35]
s_waitcnt lgkmcnt(4)
buffer_load_dwordx4 v7, s[20:23], s72 offen offset:3072 lds
v_mfma_f32_16x16x32_bf16 a[64:67], v[240:243], v[128:131], a[64:67]
ds_read_b64_tr_b16 v[224:225], v20 offset:16384
v_mfma_f32_16x16x32_bf16 a[64:67], v[244:247], v[132:135], a[64:67]
v_mfma_f32_16x16x32_bf16 a[68:71], v[244:247], v[140:143], a[68:71]
v_mfma_f32_16x16x32_bf16 a[68:71], v[240:243], v[136:139], a[68:71]
s_lshr_b32 s80, s61, 1
ds_read_b64_tr_b16 v[226:227], v20 offset:17408
v_mfma_f32_16x16x32_bf16 a[72:75], v[240:243], v[144:147], a[72:75]
s_xor_b32 s80, s80, 3
v_mfma_f32_16x16x32_bf16 a[72:75], v[244:247], v[148:151], a[72:75]
s_lshl_b32 s80, s80, 20
buffer_load_dword v126, v125, s[16:19], s80 offen
v_mfma_f32_16x16x32_bf16 a[76:79], v[244:247], v[156:159], a[76:79]
v_mfma_f32_16x16x32_bf16 a[76:79], v[240:243], v[152:155], a[76:79]
ds_read_b64_tr_b16 v[228:229], v20 offset:24576
v_mfma_f32_16x16x32_bf16 a[80:83], v[240:243], v[160:163], a[80:83]
v_mfma_f32_16x16x32_bf16 a[80:83], v[244:247], v[164:167], a[80:83]
buffer_load_dword v126, v125, s[20:23], s80 offen
v_mfma_f32_16x16x32_bf16 a[84:87], v[244:247], v[172:175], a[84:87]
v_mfma_f32_16x16x32_bf16 a[84:87], v[240:243], v[168:171], a[84:87]
ds_read_b64_tr_b16 v[230:231], v20 offset:25600
v_mfma_f32_16x16x32_bf16 a[88:91], v[240:243], v[176:179], a[88:91]
v_mfma_f32_16x16x32_bf16 a[88:91], v[244:247], v[180:183], a[88:91]
s_add_u32 m0, s63, 135168
v_mfma_f32_16x16x32_bf16 a[92:95], v[244:247], v[188:191], a[92:95]
s_add_u32 s80, s82, 0
buffer_load_dwordx4 v26, s[32:35], s80 offen nt lds
v_mfma_f32_16x16x32_bf16 a[92:95], v[240:243], v[184:187], a[92:95]
s_waitcnt lgkmcnt(4)
v_mfma_f32_16x16x32_bf16 a[124:127], v[248:251], v[184:187], a[124:127]
ds_read_b64_tr_b16 v[232:233], v21 offset:16384
v_mfma_f32_16x16x32_bf16 a[124:127], v[252:255], v[188:191], a[124:127]
v_mfma_f32_16x16x32_bf16 a[120:123], v[252:255], v[180:183], a[120:123]
s_add_u32 s80, s82, 15360
buffer_load_dwordx4 v26, s[32:35], s80 offen offset:1024 nt lds
v_mfma_f32_16x16x32_bf16 a[120:123], v[248:251], v[176:179], a[120:123]
ds_read_b64_tr_b16 v[234:235], v21 offset:17408
v_mfma_f32_16x16x32_bf16 a[116:119], v[248:251], v[168:171], a[116:119]
v_mfma_f32_16x16x32_bf16 a[116:119], v[252:255], v[172:175], a[116:119]
v_mfma_f32_16x16x32_bf16 a[112:115], v[252:255], v[164:167], a[112:115]
s_add_u32 s80, s82, 30720
buffer_load_dwordx4 v26, s[32:35], s80 offen offset:2048 nt lds
v_mfma_f32_16x16x32_bf16 a[112:115], v[248:251], v[160:163], a[112:115]
ds_read_b64_tr_b16 v[236:237], v21 offset:24576
v_mfma_f32_16x16x32_bf16 a[108:111], v[248:251], v[152:155], a[108:111]
v_mfma_f32_16x16x32_bf16 a[108:111], v[252:255], v[156:159], a[108:111]
v_mfma_f32_16x16x32_bf16 a[104:107], v[252:255], v[148:151], a[104:107]
s_add_u32 s80, s82, 46080
buffer_load_dwordx4 v26, s[32:35], s80 offen offset:3072 nt lds
v_mfma_f32_16x16x32_bf16 a[104:107], v[248:251], v[144:147], a[104:107]
ds_read_b64_tr_b16 v[238:239], v21 offset:25600
v_mfma_f32_16x16x32_bf16 a[100:103], v[248:251], v[136:139], a[100:103]
v_mfma_f32_16x16x32_bf16 a[100:103], v[252:255], v[140:143], a[100:103]
v_mfma_f32_16x16x32_bf16 a[96:99], v[252:255], v[132:135], a[96:99]
v_mfma_f32_16x16x32_bf16 a[96:99], v[248:251], v[128:131], a[96:99]
s_waitcnt lgkmcnt(4)
v_mfma_f32_16x16x32_bf16 a[128:131], v[128:131], v[224:227], a[128:131]
ds_read_b64_tr_b16 v[240:241], v22 offset:16384
v_mfma_f32_16x16x32_bf16 a[128:131], v[132:135], v[228:231], a[128:131]
v_mfma_f32_16x16x32_bf16 a[132:135], v[140:143], v[228:231], a[132:135]
v_mfma_f32_16x16x32_bf16 a[132:135], v[136:139], v[224:227], a[132:135]
ds_read_b64_tr_b16 v[242:243], v22 offset:17408
v_mfma_f32_16x16x32_bf16 a[136:139], v[144:147], v[224:227], a[136:139]
v_mfma_f32_16x16x32_bf16 a[136:139], v[148:151], v[228:231], a[136:139]
v_mfma_f32_16x16x32_bf16 a[140:143], v[156:159], v[228:231], a[140:143]
v_mfma_f32_16x16x32_bf16 a[140:143], v[152:155], v[224:227], a[140:143]
ds_read_b64_tr_b16 v[244:245], v22 offset:24576
v_mfma_f32_16x16x32_bf16 a[144:147], v[160:163], v[224:227], a[144:147]
v_mfma_f32_16x16x32_bf16 a[144:147], v[164:167], v[228:231], a[144:147]
v_mfma_f32_16x16x32_bf16 a[148:151], v[172:175], v[228:231], a[148:151]
ds_read_b64_tr_b16 v[246:247], v22 offset:25600
v_mfma_f32_16x16x32_bf16 a[148:151], v[168:171], v[224:227], a[148:151]
v_mfma_f32_16x16x32_bf16 a[152:155], v[176:179], v[224:227], a[152:155]
v_mfma_f32_16x16x32_bf16 a[152:155], v[180:183], v[228:231], a[152:155]
v_mfma_f32_16x16x32_bf16 a[156:159], v[188:191], v[228:231], a[156:159]
v_mfma_f32_16x16x32_bf16 a[156:159], v[184:187], v[224:227], a[156:159]
s_waitcnt lgkmcnt(4)
v_mfma_f32_16x16x32_bf16 a[188:191], v[184:187], v[232:235], a[188:191]
ds_read_b64_tr_b16 v[248:249], v23 offset:16384
v_mfma_f32_16x16x32_bf16 a[188:191], v[188:191], v[236:239], a[188:191]
v_mfma_f32_16x16x32_bf16 a[184:187], v[180:183], v[236:239], a[184:187]
ds_read_b64_tr_b16 v[250:251], v23 offset:17408
v_mfma_f32_16x16x32_bf16 a[184:187], v[176:179], v[232:235], a[184:187]
v_mfma_f32_16x16x32_bf16 a[180:183], v[168:171], v[232:235], a[180:183]
ds_read_b64_tr_b16 v[252:253], v23 offset:24576
v_mfma_f32_16x16x32_bf16 a[180:183], v[172:175], v[236:239], a[180:183]
v_mfma_f32_16x16x32_bf16 a[176:179], v[164:167], v[236:239], a[176:179]
ds_read_b64_tr_b16 v[254:255], v23 offset:25600
v_mfma_f32_16x16x32_bf16 a[176:179], v[160:163], v[232:235], a[176:179]
v_mfma_f32_16x16x32_bf16 a[172:175], v[152:155], v[232:235], a[172:175]
s_xor_b32 s73, s61, 4
v_mfma_f32_16x16x32_bf16 a[172:175], v[156:159], v[236:239], a[172:175]
s_lshl_b32 s69, s73, 7
v_mfma_f32_16x16x32_bf16 a[168:171], v[148:151], v[236:239], a[168:171]
s_add_u32 s69, s69, s84
v_mfma_f32_16x16x32_bf16 a[168:171], v[144:147], v[232:235], a[168:171]
s_lshl_b32 s71, s73, 19
v_mfma_f32_16x16x32_bf16 a[164:167], v[136:139], v[232:235], a[164:167]
s_add_u32 s71, s71, s66
v_mfma_f32_16x16x32_bf16 a[164:167], v[140:143], v[236:239], a[164:167]
s_add_u32 m0, s63, 65536
v_mfma_f32_16x16x32_bf16 a[160:163], v[132:135], v[236:239], a[160:163]
s_waitcnt vmcnt(6) lgkmcnt(0)
v_mfma_f32_16x16x32_bf16 a[160:163], v[128:131], v[232:235], a[160:163]
s_barrier
v_mfma_f32_16x16x32_bf16 a[192:195], v[128:131], v[240:243], a[192:195]
s_add_u32 s72, s69, 0
buffer_load_dwordx4 v2, s[8:11], s72 offen lds
v_mfma_f32_16x16x32_bf16 a[192:195], v[132:135], v[244:247], a[192:195]
ds_read_b64_tr_b16 v[224:225], v20 offset:32768
v_mfma_f32_16x16x32_bf16 a[196:199], v[140:143], v[244:247], a[196:199]
ds_read_b64_tr_b16 v[226:227], v20 offset:33792
v_mfma_f32_16x16x32_bf16 a[196:199], v[136:139], v[240:243], a[196:199]
ds_read_b64_tr_b16 v[228:229], v20 offset:40960
v_mfma_f32_16x16x32_bf16 a[200:203], v[144:147], v[240:243], a[200:203]
s_add_u32 s72, s69, 7168
buffer_load_dwordx4 v3, s[8:11], s72 offen offset:1024 lds
v_mfma_f32_16x16x32_bf16 a[200:203], v[148:151], v[244:247], a[200:203]
ds_read_b64_tr_b16 v[230:231], v20 offset:41984
v_mfma_f32_16x16x32_bf16 a[204:207], v[156:159], v[244:247], a[204:207]
Lstuba1:
s_cbranch_execz Lreta
ds_read_b128 v[192:195], v24 offset:32768
v_mfma_f32_16x16x32_bf16 a[204:207], v[152:155], v[240:243], a[204:207]
ds_read_b128 v[196:199], v25 offset:32768
v_mfma_f32_16x16x32_bf16 a[208:211], v[160:163], v[240:243], a[208:211]
s_add_u32 s72, s69, 14336
buffer_load_dwordx4 v2, s[8:11], s72 offen offset:2048 lds
v_mfma_f32_16x16x32_bf16 a[208:211], v[164:167], v[244:247], a[208:211]
ds_read_b128 v[200:203], v24 offset:34816
v_mfma_f32_16x16x32_bf16 a[212:215], v[172:175], v[244:247], a[212:215]
ds_read_b128 v[204:207], v25 offset:34816
v_mfma_f32_16x16x32_bf16 a[212:215], v[168:171], v[240:243], a[212:215]
ds_read_b128 v[208:211], v24 offset:36864
v_mfma_f32_16x16x32_bf16 a[216:219], v[176:179], v[240:243], a[216:219]
s_add_u32 s72, s69, 21504
buffer_load_dwordx4 v3, s[8:11], s72 offen offset:3072 lds
v_mfma_f32_16x16x32_bf16 a[216:219], v[180:183], v[244:247], a[216:219]
ds_read_b128 v[212:215], v25 offset:36864
v_mfma_f32_16x16x32_bf16 a[220:223], v[188:191], v[244:247], a[220:223]
ds_read_b128 v[216:219], v24 offset:38912
v_mfma_f32_16x16x32_bf16 a[220:223], v[184:187], v[240:243], a[220:223]
ds_read_b128 v[220:223], v25 offset:38912
v_mfma_f32_16x16x32_bf16 a[252:255], v[184:187], v[248:251], a[252:255]
s_add_u32 m0, s64, 0
v_mfma_f32_16x16x32_bf16 a[252:255], v[188:191], v[252:255], a[252:255]
s_add_u32 s72, s71, 0
buffer_load_dwordx4 v6, s[16:19], s72 offen lds
v_mfma_f32_16x16x32_bf16 a[248:251], v[180:183], v[252:255], a[248:251]
ds_read_b128 v[184:187], v24 offset:40960
v_mfma_f32_16x16x32_bf16 a[248:251], v[176:179], v[248:251], a[248:251]
ds_read_b128 v[188:191], v25 offset:40960
v_mfma_f32_16x16x32_bf16 a[244:247], v[168:171], v[248:251], a[244:247]
v_mfma_f32_16x16x32_bf16 a[244:247], v[172:175], v[252:255], a[244:247]
s_add_u32 s72, s71, 31744
buffer_load_dwordx4 v6, s[16:19], s72 offen offset:1024 lds
v_mfma_f32_16x16x32_bf16 a[240:243], v[164:167], v[252:255], a[240:243]
ds_read_b128 v[176:179], v24 offset:43008
v_mfma_f32_16x16x32_bf16 a[240:243], v[160:163], v[248:251], a[240:243]
ds_read_b128 v[180:183], v25 offset:43008
v_mfma_f32_16x16x32_bf16 a[236:239], v[152:155], v[248:251], a[236:239]
ds_read_b128 v[168:171], v24 offset:45056
v_mfma_f32_16x16x32_bf16 a[236:239], v[156:159], v[252:255], a[236:239]
s_add_u32 s72, s71, 63488
buffer_load_dwordx4 v7, s[16:19], s72 offen offset:2048 lds
v_mfma_f32_16x16x32_bf16 a[232:235], v[148:151], v[252:255], a[232:235]
ds_read_b128 v[172:175], v25 offset:45056
v_mfma_f32_16x16x32_bf16 a[232:235], v[144:147], v[248:251], a[232:235]
ds_read_b128 v[160:163], v24 offset:47104
v_mfma_f32_16x16x32_bf16 a[228:231], v[136:139], v[248:251], a[228:231]
ds_read_b128 v[164:167], v25 offset:47104
v_mfma_f32_16x16x32_bf16 a[228:231], v[140:143], v[252:255], a[228:231]
s_add_u32 s72, s71, 95232
buffer_load_dwordx4 v7, s[16:19], s72 offen offset:3072 lds
v_mfma_f32_16x16x32_bf16 a[224:227], v[132:135], v[252:255], a[224:227]
ds_read_b64_tr_b16 v[232:233], v21 offset:32768
v_mfma_f32_16x16x32_bf16 a[224:227], v[128:131], v[248:251], a[224:227]
s_waitcnt lgkmcnt(9)
ds_read_b64_tr_b16 v[234:235], v21 offset:33792
v_mfma_f32_16x16x32_bf16 a[0:3], v[224:227], v[192:195], a[0:3]
ds_read_b64_tr_b16 v[240:241], v22 offset:32768
v_mfma_f32_16x16x32_bf16 a[0:3], v[228:231], v[196:199], a[0:3]
s_add_u32 m0, s63, 69632
ds_read_b64_tr_b16 v[236:237], v21 offset:40960
v_mfma_f32_16x16x32_bf16 a[4:7], v[228:231], v[204:207], a[4:7]
s_add_u32 s72, s69, 32768
buffer_load_dwordx4 v2, s[8:11], s72 offen lds
v_mfma_f32_16x16x32_bf16 a[4:7], v[224:227], v[200:203], a[4:7]
v_mfma_f32_16x16x32_bf16 a[8:11], v[224:227], v[208:211], a[8:11]
ds_read_b64_tr_b16 v[238:239], v21 offset:41984
v_mfma_f32_16x16x32_bf16 a[8:11], v[228:231], v[212:215], a[8:11]
ds_read_b64_tr_b16 v[242:243], v22 offset:33792
v_mfma_f32_16x16x32_bf16 a[12:15], v[228:231], v[220:223], a[12:15]
s_add_u32 s72, s69, 39936
buffer_load_dwordx4 v3, s[8:11], s72 offen offset:1024 lds
v_mfma_f32_16x16x32_bf16 a[12:15], v[224:227], v[216:219], a[12:15]
s_waitcnt lgkmcnt(6)
v_mfma_f32_16x16x32_bf16 a[16:19], v[224:227], v[184:187], a[16:19]
ds_read_b64_tr_b16 v[244:245], v22 offset:40960
v_mfma_f32_16x16x32_bf16 a[16:19], v[228:231], v[188:191], a[16:19]
v_mfma_f32_16x16x32_bf16 a[20:23], v[228:231], v[180:183], a[20:23]
s_add_u32 s72, s69, 47104
buffer_load_dwordx4 v2, s[8:11], s72 offen offset:2048 lds
v_mfma_f32_16x16x32_bf16 a[20:23], v[224:227], v[176:179], a[20:23]
ds_read_b64_tr_b16 v[246:247], v22 offset:41984
v_mfma_f32_16x16x32_bf16 a[24:27], v[224:227], v[168:171], a[24:27]
v_mfma_f32_16x16x32_bf16 a[24:27], v[228:231], v[172:175], a[24:27]
v_mfma_f32_16x16x32_bf16 a[28:31], v[228:231], v[164:167], a[28:31]
s_add_u32 s72, s69, 54272
buffer_load_dwordx4 v3, s[8:11], s72 offen offset:3072 lds
v_mfma_f32_16x16x32_bf16 a[28:31], v[224:227], v[160:163], a[28:31]
s_waitcnt lgkmcnt(3)
v_mfma_f32_16x16x32_bf16 a[60:63], v[232:235], v[160:163], a[60:63]
ds_read_b64_tr_b16 v[248:249], v23 offset:32768
v_mfma_f32_16x16x32_bf16 a[60:63], v[236:239], v[164:167], a[60:63]
v_mfma_f32_16x16x32_bf16 a[56:59], v[236:239], v[172:175], a[56:59]
s_add_u32 m0, s64, 16384
ds_read_b64_tr_b16 v[250:251], v23 offset:33792
v_mfma_f32_16x16x32_bf16 a[56:59], v[232:235], v[168:171], a[56:59]
s_add_u32 s72, s71, 0
buffer_load_dwordx4 v6, s[20:23], s72 offen lds
v_mfma_f32_16x16x32_bf16 a[52:55], v[232:235], v[176:179], a[52:55]
v_mfma_f32_16x16x32_bf16 a[52:55], v[236:239], v[180:183], a[52:55]
v_mfma_f32_16x16x32_bf16 a[48:51], v[236:239], v[188:191], a[48:51]
ds_read_b64_tr_b16 v[252:253], v23 offset:40960
v_mfma_f32_16x16x32_bf16 a[48:51], v[232:235], v[184:187], a[48:51]
s_add_u32 s72, s71, 31744
buffer_load_dwordx4 v6, s[20:23], s72 offen offset:1024 lds
v_mfma_f32_16x16x32_bf16 a[44:47], v[232:235], v[216:219], a[44:47]
v_mfma_f32_16x16x32_bf16 a[44:47], v[236:239], v[220:223], a[44:47]
v_mfma_f32_16x16x32_bf16 a[40:43], v[236:239], v[212:215], a[40:43]
ds_read_b64_tr_b16 v[254:255], v23 offset:41984
v_mfma_f32_16x16x32_bf16 a[40:43], v[232:235], v[208:211], a[40:43]
s_add_u32 s72, s71, 63488
buffer_load_dwordx4 v7, s[20:23], s72 offen offset:2048 lds
v_mfma_f32_16x16x32_bf16 a[36:39], v[232:235], v[200:203], a[36:39]
v_mfma_f32_16x16x32_bf16 a[36:39], v[236:239], v[204:207], a[36:39]
v_mfma_f32_16x16x32_bf16 a[32:35], v[236:239], v[196:199], a[32:35]
s_add_u32 s72, s71, 95232
v_mfma_f32_16x16x32_bf16 a[32:35], v[232:235], v[192:195], a[32:35]
s_waitcnt lgkmcnt(4)
buffer_load_dwordx4 v7, s[20:23], s72 offen offset:3072 lds
v_mfma_f32_16x16x32_bf16 a[64:67], v[240:243], v[192:195], a[64:67]
ds_read_b64_tr_b16 v[224:225], v20 offset:49152
v_mfma_f32_16x16x32_bf16 a[64:67], v[244:247], v[196:199], a[64:67]
v_mfma_f32_16x16x32_bf16 a[68:71], v[244:247], v[204:207], a[68:71]
ds_read_b64_tr_b16 v[226:227], v20 offset:50176
v_mfma_f32_16x16x32_bf16 a[68:71], v[240:243], v[200:203], a[68:71]
buffer_load_dwordx4 v[108:111], v1, s[4:7], s76 offen
v_mfma_f32_16x16x32_bf16 a[72:75], v[240:243], v[208:211], a[72:75]
v_mfma_f32_16x16x32_bf16 a[72:75], v[244:247], v[212:215], a[72:75]
v_mfma_f32_16x16x32_bf16 a[76:79], v[244:247], v[220:223], a[76:79]
ds_read_b64_tr_b16 v[228:229], v20 offset:57344
v_mfma_f32_16x16x32_bf16 a[76:79], v[240:243], v[216:219], a[76:79]
buffer_load_dwordx4 v[112:115], v1, s[4:7], s76 offen offset:1024
v_mfma_f32_16x16x32_bf16 a[80:83], v[240:243], v[184:187], a[80:83]
v_mfma_f32_16x16x32_bf16 a[80:83], v[244:247], v[188:191], a[80:83]
v_mfma_f32_16x16x32_bf16 a[84:87], v[244:247], v[180:183], a[84:87]
ds_read_b64_tr_b16 v[230:231], v20 offset:58368
v_mfma_f32_16x16x32_bf16 a[84:87], v[240:243], v[176:179], a[84:87]
buffer_load_dwordx4 v[116:119], v1, s[4:7], s76 offen offset:2048
v_mfma_f32_16x16x32_bf16 a[88:91], v[240:243], v[168:171], a[88:91]
v_mfma_f32_16x16x32_bf16 a[88:91], v[244:247], v[172:175], a[88:91]
v_mfma_f32_16x16x32_bf16 a[92:95], v[244:247], v[164:167], a[92:95]
v_mfma_f32_16x16x32_bf16 a[92:95], v[240:243], v[160:163], a[92:95]
s_waitcnt lgkmcnt(4)
buffer_load_dwordx4 v[120:123], v1, s[4:7], s76 offen offset:3072
v_mfma_f32_16x16x32_bf16 a[124:127], v[248:251], v[160:163], a[124:127]
ds_read_b64_tr_b16 v[232:233], v21 offset:49152
v_mfma_f32_16x16x32_bf16 a[124:127], v[252:255], v[164:167], a[124:127]
v_mfma_f32_16x16x32_bf16 a[120:123], v[252:255], v[172:175], a[120:123]
v_mfma_f32_16x16x32_bf16 a[120:123], v[248:251], v[168:171], a[120:123]
ds_read_b64_tr_b16 v[234:235], v21 offset:50176
v_mfma_f32_16x16x32_bf16 a[116:119], v[248:251], v[176:179], a[116:119]
s_waitcnt vmcnt(20)
ds_read2_b32 v[36:37], v98 offset0:0 offset1:32
ds_read2_b32 v[38:39], v98 offset0:64 offset1:96
v_mfma_f32_16x16x32_bf16 a[116:119], v[252:255], v[180:183], a[116:119]
ds_read2_b32 v[40:41], v98 offset0:128 offset1:160
ds_read2_b32 v[42:43], v98 offset0:192 offset1:224
v_mfma_f32_16x16x32_bf16 a[112:115], v[252:255], v[188:191], a[112:115]
v_add_u32 v98, 1024, v98
v_mfma_f32_16x16x32_bf16 a[112:115], v[248:251], v[184:187], a[112:115]
ds_read_b64_tr_b16 v[236:237], v21 offset:57344
ds_read2_b32 v[44:45], v98 offset0:0 offset1:32
v_mfma_f32_16x16x32_bf16 a[108:111], v[248:251], v[216:219], a[108:111]
ds_read2_b32 v[46:47], v98 offset0:64 offset1:96
ds_read2_b32 v[48:49], v98 offset0:128 offset1:160
v_mfma_f32_16x16x32_bf16 a[108:111], v[252:255], v[220:223], a[108:111]
ds_read2_b32 v[50:51], v98 offset0:192 offset1:224
v_add_u32 v98, 3072, v98
v_mfma_f32_16x16x32_bf16 a[104:107], v[252:255], v[212:215], a[104:107]
ds_read_b64_tr_b16 v[238:239], v21 offset:58368
ds_read2_b32 v[52:53], v98 offset0:0 offset1:32
v_mfma_f32_16x16x32_bf16 a[104:107], v[248:251], v[208:211], a[104:107]
ds_read2_b32 v[54:55], v98 offset0:64 offset1:96
ds_read2_b32 v[56:57], v98 offset0:128 offset1:160
v_mfma_f32_16x16x32_bf16 a[100:103], v[248:251], v[200:203], a[100:103]
ds_read2_b32 v[58:59], v98 offset0:192 offset1:224
v_add_u32 v98, 1024, v98
v_mfma_f32_16x16x32_bf16 a[100:103], v[252:255], v[204:207], a[100:103]
ds_read2_b32 v[60:61], v98 offset0:0 offset1:32
ds_read2_b32 v[62:63], v98 offset0:64 offset1:96
v_mfma_f32_16x16x32_bf16 a[96:99], v[252:255], v[196:199], a[96:99]
ds_read2_b32 v[64:65], v98 offset0:128 offset1:160
ds_read2_b32 v[66:67], v98 offset0:192 offset1:224
v_mfma_f32_16x16x32_bf16 a[96:99], v[248:251], v[192:195], a[96:99]
s_waitcnt lgkmcnt(15)
v_mfma_f32_16x16x32_bf16 a[128:131], v[192:195], v[224:227], a[128:131]
ds_read_b64_tr_b16 v[240:241], v22 offset:49152
v_mfma_f32_16x16x32_bf16 a[128:131], v[196:199], v[228:231], a[128:131]
v_mfma_f32_16x16x32_bf16 a[132:135], v[204:207], v[228:231], a[132:135]
v_mfma_f32_16x16x32_bf16 a[132:135], v[200:203], v[224:227], a[132:135]
ds_read_b64_tr_b16 v[242:243], v22 offset:50176
v_mfma_f32_16x16x32_bf16 a[136:139], v[208:211], v[224:227], a[136:139]
v_mfma_f32_16x16x32_bf16 a[136:139], v[212:215], v[228:231], a[136:139]
v_mfma_f32_16x16x32_bf16 a[140:143], v[220:223], v[228:231], a[140:143]
v_mfma_f32_16x16x32_bf16 a[140:143], v[216:219], v[224:227], a[140:143]
ds_read_b64_tr_b16 v[244:245], v22 offset:57344
v_mfma_f32_16x16x32_bf16 a[144:147], v[184:187], v[224:227], a[144:147]
v_mfma_f32_16x16x32_bf16 a[144:147], v[188:191], v[228:231], a[144:147]
v_mfma_f32_16x16x32_bf16 a[148:151], v[180:183], v[228:231], a[148:151]
ds_read_b64_tr_b16 v[246:247], v22 offset:58368
v_mfma_f32_16x16x32_bf16 a[148:151], v[176:179], v[224:227], a[148:151]
v_mfma_f32_16x16x32_bf16 a[152:155], v[168:171], v[224:227], a[152:155]
v_mfma_f32_16x16x32_bf16 a[152:155], v[172:175], v[228:231], a[152:155]
v_mfma_f32_16x16x32_bf16 a[156:159], v[164:167], v[228:231], a[156:159]
v_mfma_f32_16x16x32_bf16 a[156:159], v[160:163], v[224:227], a[156:159]
s_waitcnt lgkmcnt(12)
v_mfma_f32_16x16x32_bf16 a[188:191], v[160:163], v[232:235], a[188:191]
ds_read_b64_tr_b16 v[248:249], v23 offset:49152
v_mfma_f32_16x16x32_bf16 a[188:191], v[164:167], v[236:239], a[188:191]
v_mfma_f32_16x16x32_bf16 a[184:187], v[172:175], v[236:239], a[184:187]
ds_read_b64_tr_b16 v[250:251], v23 offset:50176
v_mfma_f32_16x16x32_bf16 a[184:187], v[168:171], v[232:235], a[184:187]
v_mfma_f32_16x16x32_bf16 a[180:183], v[176:179], v[232:235], a[180:183]
ds_read_b64_tr_b16 v[252:253], v23 offset:57344
v_mfma_f32_16x16x32_bf16 a[180:183], v[180:183], v[236:239], a[180:183]
v_mfma_f32_16x16x32_bf16 a[176:179], v[188:191], v[236:239], a[176:179]
ds_read_b64_tr_b16 v[254:255], v23 offset:58368
v_mfma_f32_16x16x32_bf16 a[176:179], v[184:187], v[232:235], a[176:179]
v_mfma_f32_16x16x32_bf16 a[172:175], v[216:219], v[232:235], a[172:175]
s_xor_b32 s73, s61, 5
v_mfma_f32_16x16x32_bf16 a[172:175], v[220:223], v[236:239], a[172:175]
s_lshl_b32 s69, s73, 7
v_mfma_f32_16x16x32_bf16 a[168:171], v[212:215], v[236:239], a[168:171]
s_add_u32 s69, s69, s84
v_mfma_f32_16x16x32_bf16 a[168:171], v[208:211], v[232:235], a[168:171]
s_lshl_b32 s71, s73, 19
v_mfma_f32_16x16x32_bf16 a[164:167], v[200:203], v[232:235], a[164:167]
s_add_u32 s71, s71, s66
v_mfma_f32_16x16x32_bf16 a[164:167], v[204:207], v[236:239], a[164:167]
s_add_u32 m0, s63, 98304
v_mfma_f32_16x16x32_bf16 a[160:163], v[196:199], v[236:239], a[160:163]
s_waitcnt vmcnt(4) lgkmcnt(0)
v_mfma_f32_16x16x32_bf16 a[160:163], v[192:195], v[232:235], a[160:163]
s_barrier
v_mfma_f32_16x16x32_bf16 a[192:195], v[192:195], v[240:243], a[192:195]
s_add_u32 s72, s69, 0
buffer_load_dwordx4 v2, s[8:11], s72 offen lds
v_mfma_f32_16x16x32_bf16 a[192:195], v[196:199], v[244:247], a[192:195]
ds_read_b64_tr_b16 v[224:225], v20 offset:0
v_lshlrev_b32 v72, 16, v68
v_mfma_f32_16x16x32_bf16 a[196:199], v[204:207], v[244:247], a[196:199]
ds_read_b64_tr_b16 v[226:227], v20 offset:1024
v_and_b32 v73, 0xffff0000, v68
v_mfma_f32_16x16x32_bf16 a[196:199], v[200:203], v[240:243], a[196:199]
ds_read_b64_tr_b16 v[228:229], v20 offset:8192
v_lshlrev_b32 v74, 16, v69
v_mfma_f32_16x16x32_bf16 a[200:203], v[208:211], v[240:243], a[200:203]
s_add_u32 s72, s69, 7168
buffer_load_dwordx4 v3, s[8:11], s72 offen offset:1024 lds
v_mfma_f32_16x16x32_bf16 a[200:203], v[212:215], v[244:247], a[200:203]
ds_read_b64_tr_b16 v[230:231], v20 offset:9216
v_and_b32 v75, 0xffff0000, v69
v_mfma_f32_16x16x32_bf16 a[204:207], v[220:223], v[244:247], a[204:207]
ds_read_b128 v[128:131], v24 offset:0
v_lshlrev_b32 v76, 16, v33
v_mfma_f32_16x16x32_bf16 a[204:207], v[216:219], v[240:243], a[204:207]
ds_read_b128 v[132:135], v25 offset:0
v_lshlrev_b32 v77, 16, v34
v_mfma_f32_16x16x32_bf16 a[208:211], v[184:187], v[240:243], a[208:211]
s_add_u32 s72, s69, 14336
buffer_load_dwordx4 v2, s[8:11], s72 offen offset:2048 lds
v_mfma_f32_16x16x32_bf16 a[208:211], v[188:191], v[244:247], a[208:211]
ds_read_b128 v[136:139], v24 offset:2048
v_lshlrev_b32 v78, 16, v35
v_mfma_f32_16x16x32_bf16 a[212:215], v[180:183], v[244:247], a[212:215]
ds_read_b128 v[140:143], v25 offset:2048
v_lshlrev_b32 v79, 16, v36
v_mfma_f32_16x16x32_bf16 a[212:215], v[176:179], v[240:243], a[212:215]
ds_read_b128 v[144:147], v24 offset:4096
v_lshlrev_b32 v80, 16, v37
v_mfma_f32_16x16x32_bf16 a[216:219], v[168:171], v[240:243], a[216:219]
s_add_u32 s72, s69, 21504
buffer_load_dwordx4 v3, s[8:11], s72 offen offset:3072 lds
v_mfma_f32_16x16x32_bf16 a[216:219], v[172:175], v[244:247], a[216:219]
ds_read_b128 v[148:151], v25 offset:4096
v_lshlrev_b32 v81, 16, v38
v_mfma_f32_16x16x32_bf16 a[220:223], v[164:167], v[244:247], a[220:223]
ds_read_b128 v[152:155], v24 offset:6144
v_lshlrev_b32 v82, 16, v39
v_mfma_f32_16x16x32_bf16 a[220:223], v[160:163], v[240:243], a[220:223]
ds_read_b128 v[156:159], v25 offset:6144
v_lshlrev_b32 v83, 16, v40
v_mfma_f32_16x16x32_bf16 a[252:255], v[160:163], v[248:251], a[252:255]
s_add_u32 m0, s64, 32768
v_lshlrev_b32 v84, 16, v41
v_lshlrev_b32 v85, 16, v42
v_mfma_f32_16x16x32_bf16 a[252:255], v[164:167], v[252:255], a[252:255]
s_add_u32 s72, s71, 0
buffer_load_dwordx4 v6, s[16:19], s72 offen lds
v_mfma_f32_16x16x32_bf16 a[248:251], v[172:175], v[252:255], a[248:251]
ds_read_b128 v[160:163], v24 offset:8192
v_lshlrev_b32 v86, 16, v43
v_mfma_f32_16x16x32_bf16 a[248:251], v[168:171], v[248:251], a[248:251]
ds_read_b128 v[164:167], v25 offset:8192
v_lshlrev_b32 v87, 16, v44
v_mfma_f32_16x16x32_bf16 a[244:247], v[176:179], v[248:251], a[244:247]
v_lshlrev_b32 v88, 16, v45
v_lshlrev_b32 v89, 16, v46
v_mfma_f32_16x16x32_bf16 a[244:247], v[180:183], v[252:255], a[244:247]
s_add_u32 s72, s71, 31744
buffer_load_dwordx4 v6, s[16:19], s72 offen offset:1024 lds
v_mfma_f32_16x16x32_bf16 a[240:243], v[188:191], v[252:255], a[240:243]
ds_read_b128 v[168:171], v24 offset:10240
v_lshlrev_b32 v90, 16, v47
v_mfma_f32_16x16x32_bf16 a[240:243], v[184:187], v[248:251], a[240:243]
ds_read_b128 v[172:175], v25 offset:10240
v_lshlrev_b32 v91, 16, v48
v_mfma_f32_16x16x32_bf16 a[236:239], v[216:219], v[248:251], a[236:239]
ds_read_b128 v[176:179], v24 offset:12288
v_lshlrev_b32 v92, 16, v49
v_mfma_f32_16x16x32_bf16 a[236:239], v[220:223], v[252:255], a[236:239]
s_add_u32 s72, s71, 63488
buffer_load_dwordx4 v7, s[16:19], s72 offen offset:2048 lds
v_mfma_f32_16x16x32_bf16 a[232:235], v[212:215], v[252:255], a[232:235]
ds_read_b128 v[180:183], v25 offset:12288
v_lshlrev_b32 v93, 16, v50
v_mfma_f32_16x16x32_bf16 a[232:235], v[208:211], v[248:251], a[232:235]
ds_read_b128 v[184:187], v24 offset:14336
v_lshlrev_b32 v94, 16, v51
v_mfma_f32_16x16x32_bf16 a[228:231], v[200:203], v[248:251], a[228:231]
ds_read_b128 v[188:191], v25 offset:14336
v_mul_f32 v95, v75, v91
v_mfma_f32_16x16x32_bf16 a[228:231], v[204:207], v[252:255], a[228:231]
s_add_u32 s72, s71, 95232
buffer_load_dwordx4 v7, s[16:19], s72 offen offset:3072 lds
v_mfma_f32_16x16x32_bf16 a[224:227], v[196:199], v[252:255], a[224:227]
ds_read_b64_tr_b16 v[232:233], v21 offset:0
v_lshlrev_b32 v97, 16, v67
v_mfma_f32_16x16x32_bf16 a[224:227], v[192:195], v[248:251], a[224:227]
s_waitcnt lgkmcnt(9)
ds_read_b64_tr_b16 v[234:235], v21 offset:1024
v_fmac_f32 v95, v74, v92
v_mfma_f32_16x16x32_bf16 a[0:3], v[224:227], v[128:131], a[0:3]
ds_read_b64_tr_b16 v[240:241], v22 offset:0
v_fmac_f32 v95, v73, v93
v_mfma_f32_16x16x32_bf16 a[0:3], v[228:231], v[132:135], a[0:3]
s_add_u32 m0, s63, 102400
ds_read_b64_tr_b16 v[236:237], v21 offset:8192
v_fmac_f32 v95, v72, v94
v_mfma_f32_16x16x32_bf16 a[4:7], v[228:231], v[140:143], a[4:7]
s_add_u32 s72, s69, 32768
buffer_load_dwordx4 v2, s[8:11], s72 offen lds
v_mfma_f32_16x16x32_bf16 a[4:7], v[224:227], v[136:139], a[4:7]
v_mul_f32 v95, v95, v97
v_mul_f32 v96, v75, v90
v_mfma_f32_16x16x32_bf16 a[8:11], v[224:227], v[144:147], a[8:11]
ds_read_b64_tr_b16 v[238:239], v21 offset:9216
v_lshlrev_b32 v97, 16, v66
v_mfma_f32_16x16x32_bf16 a[8:11], v[228:231], v[148:151], a[8:11]
ds_read_b64_tr_b16 v[242:243], v22 offset:1024
v_fmac_f32 v96, v74, v91
v_mfma_f32_16x16x32_bf16 a[12:15], v[228:231], v[156:159], a[12:15]
s_add_u32 s72, s69, 39936
buffer_load_dwordx4 v3, s[8:11], s72 offen offset:1024 lds
v_mfma_f32_16x16x32_bf16 a[12:15], v[224:227], v[152:155], a[12:15]
s_waitcnt lgkmcnt(6)
v_fmac_f32 v96, v73, v92
v_fmac_f32 v96, v72, v93
v_mfma_f32_16x16x32_bf16 a[16:19], v[224:227], v[160:163], a[16:19]
ds_read_b64_tr_b16 v[244:245], v22 offset:8192
v_mul_f32 v96, v96, v97
v_mfma_f32_16x16x32_bf16 a[16:19], v[228:231], v[164:167], a[16:19]
v_cvt_pk_bf16_f32 v100, v95, v96
v_mul_f32 v95, v75, v89
v_mfma_f32_16x16x32_bf16 a[20:23], v[228:231], v[172:175], a[20:23]
s_add_u32 s72, s69, 47104
buffer_load_dwordx4 v2, s[8:11], s72 offen offset:2048 lds
v_mfma_f32_16x16x32_bf16 a[20:23], v[224:227], v[168:171], a[20:23]
ds_read_b64_tr_b16 v[246:247], v22 offset:9216
v_lshlrev_b32 v97, 16, v65
v_mfma_f32_16x16x32_bf16 a[24:27], v[224:227], v[176:179], a[24:27]
v_fmac_f32 v95, v74, v90
v_fmac_f32 v95, v73, v91
v_mfma_f32_16x16x32_bf16 a[24:27], v[228:231], v[180:183], a[24:27]
v_fmac_f32 v95, v72, v92
v_mul_f32 v95, v95, v97
v_mfma_f32_16x16x32_bf16 a[28:31], v[228:231], v[188:191], a[28:31]
s_add_u32 s72, s69, 54272
buffer_load_dwordx4 v3, s[8:11], s72 offen offset:3072 lds
v_mfma_f32_16x16x32_bf16 a[28:31], v[224:227], v[184:187], a[28:31]
s_waitcnt lgkmcnt(3)
v_mul_f32 v96, v75, v88
v_lshlrev_b32 v97, 16, v64
v_mfma_f32_16x16x32_bf16 a[60:63], v[232:235], v[184:187], a[60:63]
ds_read_b64_tr_b16 v[248:249], v23 offset:0
v_fmac_f32 v96, v74, v89
v_mfma_f32_16x16x32_bf16 a[60:63], v[236:239], v[188:191], a[60:63]
v_fmac_f32 v96, v73, v90
v_fmac_f32 v96, v72, v91
v_mfma_f32_16x16x32_bf16 a[56:59], v[236:239], v[180:183], a[56:59]
s_add_u32 m0, s64, 49152
ds_read_b64_tr_b16 v[250:251], v23 offset:1024
v_mul_f32 v96, v96, v97
v_mfma_f32_16x16x32_bf16 a[56:59], v[232:235], v[176:179], a[56:59]
s_add_u32 s72, s71, 0
buffer_load_dwordx4 v6, s[20:23], s72 offen lds
v_mfma_f32_16x16x32_bf16 a[52:55], v[232:235], v[168:171], a[52:55]
v_cvt_pk_bf16_f32 v101, v95, v96
v_mul_f32 v95, v75, v87
v_mfma_f32_16x16x32_bf16 a[52:55], v[236:239], v[172:175], a[52:55]
v_lshlrev_b32 v97, 16, v63
v_fmac_f32 v95, v74, v88
v_mfma_f32_16x16x32_bf16 a[48:51], v[236:239], v[164:167], a[48:51]
ds_read_b64_tr_b16 v[252:253], v23 offset:8192
v_fmac_f32 v95, v73, v89
v_mfma_f32_16x16x32_bf16 a[48:51], v[232:235], v[160:163], a[48:51]
s_add_u32 s72, s71, 31744
buffer_load_dwordx4 v6, s[20:23], s72 offen offset:1024 lds
v_mfma_f32_16x16x32_bf16 a[44:47], v[232:235], v[152:155], a[44:47]
v_fmac_f32 v95, v72, v90
v_mul_f32 v95, v95, v97
v_mfma_f32_16x16x32_bf16 a[44:47], v[236:239], v[156:159], a[44:47]
v_mul_f32 v96, v75, v86
v_lshlrev_b32 v97, 16, v62
v_mfma_f32_16x16x32_bf16 a[40:43], v[236:239], v[148:151], a[40:43]
ds_read_b64_tr_b16 v[254:255], v23 offset:9216
v_fmac_f32 v96, v74, v87
v_mfma_f32_16x16x32_bf16 a[40:43], v[232:235], v[144:147], a[40:43]
s_add_u32 s72, s71, 63488
buffer_load_dwordx4 v7, s[20:23], s72 offen offset:2048 lds
v_mfma_f32_16x16x32_bf16 a[36:39], v[232:235], v[136:139], a[36:39]
v_fmac_f32 v96, v73, v88
v_fmac_f32 v96, v72, v89
v_mfma_f32_16x16x32_bf16 a[36:39], v[236:239], v[140:143], a[36:39]
v_mul_f32 v96, v96, v97
v_cvt_pk_bf16_f32 v102, v95, v96
v_mfma_f32_16x16x32_bf16 a[32:35], v[236:239], v[132:135], a[32:35]
s_add_u32 s72, s71, 95232
v_mul_f32 v95, v75, v85
v_lshlrev_b32 v97, 16, v61
v_mfma_f32_16x16x32_bf16 a[32:35], v[232:235], v[128:131], a[32:35]
s_waitcnt lgkmcnt(4)
buffer_load_dwordx4 v7, s[20:23], s72 offen offset:3072 lds
v_mfma_f32_16x16x32_bf16 a[64:67], v[240:243], v[128:131], a[64:67]
ds_read_b64_tr_b16 v[224:225], v20 offset:16384
v_fmac_f32 v95, v74, v86
v_mfma_f32_16x16x32_bf16 a[64:67], v[244:247], v[132:135], a[64:67]
v_fmac_f32 v95, v73, v87
v_fmac_f32 v95, v72, v88
v_mfma_f32_16x16x32_bf16 a[68:71], v[244:247], v[140:143], a[68:71]
ds_read_b64_tr_b16 v[226:227], v20 offset:17408
v_mul_f32 v95, v95, v97
v_mfma_f32_16x16x32_bf16 a[68:71], v[240:243], v[136:139], a[68:71]
s_mov_b32 s80, 0x0
buffer_load_dword v126, v125, s[12:15], s80 offen
v_mfma_f32_16x16x32_bf16 a[72:75], v[240:243], v[144:147], a[72:75]
v_mul_f32 v96, v75, v84
v_lshlrev_b32 v97, 16, v60
v_mfma_f32_16x16x32_bf16 a[72:75], v[244:247], v[148:151], a[72:75]
v_fmac_f32 v96, v74, v85
v_fmac_f32 v96, v73, v86
v_mfma_f32_16x16x32_bf16 a[76:79], v[244:247], v[156:159], a[76:79]
ds_read_b64_tr_b16 v[228:229], v20 offset:24576
v_fmac_f32 v96, v72, v87
v_mfma_f32_16x16x32_bf16 a[76:79], v[240:243], v[152:155], a[76:79]
s_mov_b32 s80, 0x100000
buffer_load_dword v126, v125, s[12:15], s80 offen
v_mfma_f32_16x16x32_bf16 a[80:83], v[240:243], v[160:163], a[80:83]
v_mul_f32 v96, v96, v97
v_cvt_pk_bf16_f32 v103, v95, v96
v_mfma_f32_16x16x32_bf16 a[80:83], v[244:247], v[164:167], a[80:83]
ds_write_b128 v28, v[100:103] offset:0
v_mul_f32 v95, v75, v83
v_mfma_f32_16x16x32_bf16 a[84:87], v[244:247], v[172:175], a[84:87]
ds_read_b64_tr_b16 v[230:231], v20 offset:25600
v_lshlrev_b32 v97, 16, v59
v_mfma_f32_16x16x32_bf16 a[84:87], v[240:243], v[168:171], a[84:87]
s_mov_b32 s80, 0x200000
buffer_load_dword v126, v125, s[12:15], s80 offen
v_mfma_f32_16x16x32_bf16 a[88:91], v[240:243], v[176:179], a[88:91]
v_fmac_f32 v95, v74, v84
v_fmac_f32 v95, v73, v85
v_mfma_f32_16x16x32_bf16 a[88:91], v[244:247], v[180:183], a[88:91]
v_fmac_f32 v95, v72, v86
v_mul_f32 v95, v95, v97
v_mfma_f32_16x16x32_bf16 a[92:95], v[244:247], v[188:191], a[92:95]
v_mul_f32 v96, v75, v82
v_lshlrev_b32 v97, 16, v58
v_mfma_f32_16x16x32_bf16 a[92:95], v[240:243], v[184:187], a[92:95]
s_waitcnt lgkmcnt(5)
v_fmac_f32 v96, v74, v83
v_fmac_f32 v96, v73, v84
v_mfma_f32_16x16x32_bf16 a[124:127], v[248:251], v[184:187], a[124:127]
s_mov_b32 s80, 0x300000
buffer_load_dword v126, v125, s[12:15], s80 offen
v_mfma_f32_16x16x32_bf16 a[124:127], v[252:255], v[188:191], a[124:127]
ds_read_b64_tr_b16 v[232:233], v21 offset:16384
v_fmac_f32 v96, v72, v85
v_mfma_f32_16x16x32_bf16 a[120:123], v[252:255], v[180:183], a[120:123]
v_mul_f32 v96, v96, v97
v_cvt_pk_bf16_f32 v104, v95, v96
v_mfma_f32_16x16x32_bf16 a[120:123], v[248:251], v[176:179], a[120:123]
v_mul_f32 v95, v75, v81
v_lshlrev_b32 v97, 16, v57
v_mfma_f32_16x16x32_bf16 a[116:119], v[248:251], v[168:171], a[116:119]
ds_read_b64_tr_b16 v[234:235], v21 offset:17408
v_fmac_f32 v95, v74, v82
v_mfma_f32_16x16x32_bf16 a[116:119], v[252:255], v[172:175], a[116:119]
v_fmac_f32 v95, v73, v83
v_fmac_f32 v95, v72, v84
v_mfma_f32_16x16x32_bf16 a[112:115], v[252:255], v[164:167], a[112:115]
v_mul_f32 v95, v95, v97
v_mul_f32 v96, v75, v80
v_mfma_f32_16x16x32_bf16 a[112:115], v[248:251], v[160:163], a[112:115]
ds_read_b64_tr_b16 v[236:237], v21 offset:24576
v_lshlrev_b32 v97, 16, v56
v_mfma_f32_16x16x32_bf16 a[108:111], v[248:251], v[152:155], a[108:111]
v_fmac_f32 v96, v74, v81
v_fmac_f32 v96, v73, v82
v_mfma_f32_16x16x32_bf16 a[108:111], v[252:255], v[156:159], a[108:111]
v_fmac_f32 v96, v72, v83
v_mul_f32 v96, v96, v97
v_mfma_f32_16x16x32_bf16 a[104:107], v[252:255], v[148:151], a[104:107]
ds_read_b64_tr_b16 v[238:239], v21 offset:25600
v_cvt_pk_bf16_f32 v105, v95, v96
v_mfma_f32_16x16x32_bf16 a[104:107], v[248:251], v[144:147], a[104:107]
v_mul_f32 v95, v75, v79
v_lshlrev_b32 v97, 16, v55
v_mfma_f32_16x16x32_bf16 a[100:103], v[248:251], v[136:139], a[100:103]
v_fmac_f32 v95, v74, v80
v_fmac_f32 v95, v73, v81
v_mfma_f32_16x16x32_bf16 a[100:103], v[252:255], v[140:143], a[100:103]
v_fmac_f32 v95, v72, v82
v_mul_f32 v95, v95, v97
v_mfma_f32_16x16x32_bf16 a[96:99], v[252:255], v[132:135], a[96:99]
v_mul_f32 v96, v75, v78
v_lshlrev_b32 v97, 16, v54
v_mfma_f32_16x16x32_bf16 a[96:99], v[248:251], v[128:131], a[96:99]
s_waitcnt lgkmcnt(4)
v_fmac_f32 v96, v74, v79
v_fmac_f32 v96, v73, v80
v_mfma_f32_16x16x32_bf16 a[128:131], v[128:131], v[224:227], a[128:131]
ds_read_b64_tr_b16 v[240:241], v22 offset:16384
v_fmac_f32 v96, v72, v81
v_mfma_f32_16x16x32_bf16 a[128:131], v[132:135], v[228:231], a[128:131]
v_mul_f32 v96, v96, v97
v_cvt_pk_bf16_f32 v106, v95, v96
v_mfma_f32_16x16x32_bf16 a[132:135], v[140:143], v[228:231], a[132:135]
v_mul_f32 v95, v75, v77
v_lshlrev_b32 v97, 16, v53
v_mfma_f32_16x16x32_bf16 a[132:135], v[136:139], v[224:227], a[132:135]
ds_read_b64_tr_b16 v[242:243], v22 offset:17408
v_fmac_f32 v95, v74, v78
v_mfma_f32_16x16x32_bf16 a[136:139], v[144:147], v[224:227], a[136:139]
v_fmac_f32 v95, v73, v79
v_fmac_f32 v95, v72, v80
v_mfma_f32_16x16x32_bf16 a[136:139], v[148:151], v[228:231], a[136:139]
v_mul_f32 v95, v95, v97
v_mul_f32 v96, v75, v76
v_mfma_f32_16x16x32_bf16 a[140:143], v[156:159], v[228:231], a[140:143]
v_lshlrev_b32 v97, 16, v52
v_fmac_f32 v96, v74, v77
v_mfma_f32_16x16x32_bf16 a[140:143], v[152:155], v[224:227], a[140:143]
ds_read_b64_tr_b16 v[244:245], v22 offset:24576
v_fmac_f32 v96, v73, v78
v_mfma_f32_16x16x32_bf16 a[144:147], v[160:163], v[224:227], a[144:147]
v_fmac_f32 v96, v72, v79
v_mul_f32 v96, v96, v97
v_mfma_f32_16x16x32_bf16 a[144:147], v[164:167], v[228:231], a[144:147]
v_cvt_pk_bf16_f32 v107, v95, v96
v_mfma_f32_16x16x32_bf16 a[148:151], v[172:175], v[228:231], a[148:151]
ds_read_b64_tr_b16 v[246:247], v22 offset:25600
ds_write_b128 v28, v[104:107] offset:16
v_mfma_f32_16x16x32_bf16 a[148:151], v[168:171], v[224:227], a[148:151]
global_load_dwordx4 v[84:87], v1, s[56:57]
v_mfma_f32_16x16x32_bf16 a[152:155], v[176:179], v[224:227], a[152:155]
global_load_dwordx4 v[88:91], v1, s[56:57] offset:1024
v_mfma_f32_16x16x32_bf16 a[152:155], v[180:183], v[228:231], a[152:155]
v_lshlrev_b32 v72, 16, v70
v_and_b32 v73, 0xffff0000, v70
v_mfma_f32_16x16x32_bf16 a[156:159], v[188:191], v[228:231], a[156:159]
v_lshlrev_b32 v74, 16, v71
v_and_b32 v75, 0xffff0000, v71
v_mfma_f32_16x16x32_bf16 a[156:159], v[184:187], v[224:227], a[156:159]
s_waitcnt lgkmcnt(5)
v_and_b32 v33, 0xffff0000, v33
v_and_b32 v34, 0xffff0000, v34
v_mfma_f32_16x16x32_bf16 a[188:191], v[184:187], v[232:235], a[188:191]
ds_read_b64_tr_b16 v[248:249], v23 offset:16384
v_and_b32 v35, 0xffff0000, v35
v_mfma_f32_16x16x32_bf16 a[188:191], v[188:191], v[236:239], a[188:191]
v_and_b32 v36, 0xffff0000, v36
v_and_b32 v37, 0xffff0000, v37
v_mfma_f32_16x16x32_bf16 a[184:187], v[180:183], v[236:239], a[184:187]
Lstuba2:
s_cbranch_execz Lreta
ds_read_b64_tr_b16 v[250:251], v23 offset:17408
v_and_b32 v38, 0xffff0000, v38
v_mfma_f32_16x16x32_bf16 a[184:187], v[176:179], v[232:235], a[184:187]
v_and_b32 v39, 0xffff0000, v39
v_and_b32 v40, 0xffff0000, v40
v_mfma_f32_16x16x32_bf16 a[180:183], v[168:171], v[232:235], a[180:183]
ds_read_b64_tr_b16 v[252:253], v23 offset:24576
v_and_b32 v41, 0xffff0000, v41
v_mfma_f32_16x16x32_bf16 a[180:183], v[172:175], v[236:239], a[180:183]
v_and_b32 v42, 0xffff0000, v42
v_and_b32 v43, 0xffff0000, v43
v_mfma_f32_16x16x32_bf16 a[176:179], v[164:167], v[236:239], a[176:179]
ds_read_b64_tr_b16 v[254:255], v23 offset:25600
v_and_b32 v44, 0xffff0000, v44
v_mfma_f32_16x16x32_bf16 a[176:179], v[160:163], v[232:235], a[176:179]
v_and_b32 v45, 0xffff0000, v45
v_and_b32 v46, 0xffff0000, v46
v_mfma_f32_16x16x32_bf16 a[172:175], v[152:155], v[232:235], a[172:175]
s_xor_b32 s73, s61, 6
v_and_b32 v47, 0xffff0000, v47
v_and_b32 v48, 0xffff0000, v48
v_mfma_f32_16x16x32_bf16 a[172:175], v[156:159], v[236:239], a[172:175]
s_lshl_b32 s69, s73, 7
v_and_b32 v49, 0xffff0000, v49
v_and_b32 v50, 0xffff0000, v50
v_mfma_f32_16x16x32_bf16 a[168:171], v[148:151], v[236:239], a[168:171]
s_add_u32 s69, s69, s84
v_and_b32 v51, 0xffff0000, v51
v_mul_f32 v95, v75, v48
v_mfma_f32_16x16x32_bf16 a[168:171], v[144:147], v[232:235], a[168:171]
s_lshl_b32 s71, s73, 19
v_and_b32 v97, 0xffff0000, v67
v_fmac_f32 v95, v74, v49
v_mfma_f32_16x16x32_bf16 a[164:167], v[136:139], v[232:235], a[164:167]
s_add_u32 s71, s71, s66
v_fmac_f32 v95, v73, v50
v_fmac_f32 v95, v72, v51
v_mfma_f32_16x16x32_bf16 a[164:167], v[140:143], v[236:239], a[164:167]
s_add_u32 m0, s63, 65536
v_mul_f32 v95, v95, v97
v_mul_f32 v96, v75, v47
v_mfma_f32_16x16x32_bf16 a[160:163], v[132:135], v[236:239], a[160:163]
s_waitcnt vmcnt(6) lgkmcnt(0)
v_and_b32 v97, 0xffff0000, v66
v_fmac_f32 v96, v74, v48
v_mfma_f32_16x16x32_bf16 a[160:163], v[128:131], v[232:235], a[160:163]
s_barrier
v_fmac_f32 v96, v73, v49
v_fmac_f32 v96, v72, v50
v_mfma_f32_16x16x32_bf16 a[192:195], v[128:131], v[240:243], a[192:195]
s_add_u32 s72, s69, 0
buffer_load_dwordx4 v2, s[8:11], s72 offen lds
v_mfma_f32_16x16x32_bf16 a[192:195], v[132:135], v[244:247], a[192:195]
ds_read_b64_tr_b16 v[224:225], v20 offset:32768
v_mul_f32 v96, v96, v97
v_mfma_f32_16x16x32_bf16 a[196:199], v[140:143], v[244:247], a[196:199]
ds_read_b64_tr_b16 v[226:227], v20 offset:33792
v_cvt_pk_bf16_f32 v100, v95, v96
v_mfma_f32_16x16x32_bf16 a[196:199], v[136:139], v[240:243], a[196:199]
ds_read_b64_tr_b16 v[228:229], v20 offset:40960
v_mul_f32 v95, v75, v46
v_mfma_f32_16x16x32_bf16 a[200:203], v[144:147], v[240:243], a[200:203]
s_add_u32 s72, s69, 7168
buffer_load_dwordx4 v3, s[8:11], s72 offen offset:1024 lds
v_mfma_f32_16x16x32_bf16 a[200:203], v[148:151], v[244:247], a[200:203]
ds_read_b64_tr_b16 v[230:231], v20 offset:41984
v_and_b32 v97, 0xffff0000, v65
v_mfma_f32_16x16x32_bf16 a[204:207], v[156:159], v[244:247], a[204:207]
ds_read_b128 v[192:195], v24 offset:32768
v_fmac_f32 v95, v74, v47
v_mfma_f32_16x16x32_bf16 a[204:207], v[152:155], v[240:243], a[204:207]
ds_read_b128 v[196:199], v25 offset:32768
v_fmac_f32 v95, v73, v48
v_mfma_f32_16x16x32_bf16 a[208:211], v[160:163], v[240:243], a[208:211]
s_add_u32 s72, s69, 14336
buffer_load_dwordx4 v2, s[8:11], s72 offen offset:2048 lds
v_mfma_f32_16x16x32_bf16 a[208:211], v[164:167], v[244:247], a[208:211]
ds_read_b128 v[200:203], v24 offset:34816
v_fmac_f32 v95, v72, v49
v_mfma_f32_16x16x32_bf16 a[212:215], v[172:175], v[244:247], a[212:215]
ds_read_b128 v[204:207], v25 offset:34816
v_mul_f32 v95, v95, v97
v_mfma_f32_16x16x32_bf16 a[212:215], v[168:171], v[240:243], a[212:215]
ds_read_b128 v[208:211], v24 offset:36864
v_mul_f32 v96, v75, v45
v_mfma_f32_16x16x32_bf16 a[216:219], v[176:179], v[240:243], a[216:219]
s_add_u32 s72, s69, 21504
buffer_load_dwordx4 v3, s[8:11], s72 offen offset:3072 lds
v_mfma_f32_16x16x32_bf16 a[216:219], v[180:183], v[244:247], a[216:219]
ds_read_b128 v[212:215], v25 offset:36864
v_and_b32 v97, 0xffff0000, v64
v_mfma_f32_16x16x32_bf16 a[220:223], v[188:191], v[244:247], a[220:223]
ds_read_b128 v[216:219], v24 offset:38912
v_fmac_f32 v96, v74, v46
v_mfma_f32_16x16x32_bf16 a[220:223], v[184:187], v[240:243], a[220:223]
ds_read_b128 v[220:223], v25 offset:38912
v_fmac_f32 v96, v73, v47
v_mfma_f32_16x16x32_bf16 a[252:255], v[184:187], v[248:251], a[252:255]
s_add_u32 m0, s64, 0
v_fmac_f32 v96, v72, v48
v_mul_f32 v96, v96, v97
v_mfma_f32_16x16x32_bf16 a[252:255], v[188:191], v[252:255], a[252:255]
s_add_u32 s72, s71, 0
buffer_load_dwordx4 v6, s[16:19], s72 offen lds
v_mfma_f32_16x16x32_bf16 a[248:251], v[180:183], v[252:255], a[248:251]
ds_read_b128 v[184:187], v24 offset:40960
v_cvt_pk_bf16_f32 v101, v95, v96
v_mfma_f32_16x16x32_bf16 a[248:251], v[176:179], v[248:251], a[248:251]
ds_read_b128 v[188:191], v25 offset:40960
v_mul_f32 v95, v75, v44
v_mfma_f32_16x16x32_bf16 a[244:247], v[168:171], v[248:251], a[244:247]
v_and_b32 v97, 0xffff0000, v63
v_fmac_f32 v95, v74, v45
v_mfma_f32_16x16x32_bf16 a[244:247], v[172:175], v[252:255], a[244:247]
s_add_u32 s72, s71, 31744
buffer_load_dwordx4 v6, s[16:19], s72 offen offset:1024 lds
v_mfma_f32_16x16x32_bf16 a[240:243], v[164:167], v[252:255], a[240:243]
ds_read_b128 v[176:179], v24 offset:43008
v_fmac_f32 v95, v73, v46
v_mfma_f32_16x16x32_bf16 a[240:243], v[160:163], v[248:251], a[240:243]
ds_read_b128 v[180:183], v25 offset:43008
v_fmac_f32 v95, v72, v47
v_mfma_f32_16x16x32_bf16 a[236:239], v[152:155], v[248:251], a[236:239]
ds_read_b128 v[168:171], v24 offset:45056
v_mul_f32 v95, v95, v97
v_mfma_f32_16x16x32_bf16 a[236:239], v[156:159], v[252:255], a[236:239]
s_add_u32 s72, s71, 63488
buffer_load_dwordx4 v7, s[16:19], s72 offen offset:2048 lds
v_mfma_f32_16x16x32_bf16 a[232:235], v[148:151], v[252:255], a[232:235]
ds_read_b128 v[172:175], v25 offset:45056
v_mul_f32 v96, v75, v43
v_mfma_f32_16x16x32_bf16 a[232:235], v[144:147], v[248:251], a[232:235]
ds_read_b128 v[160:163], v24 offset:47104
v_and_b32 v97, 0xffff0000, v62
v_mfma_f32_16x16x32_bf16 a[228:231], v[136:139], v[248:251], a[228:231]
ds_read_b128 v[164:167], v25 offset:47104
v_fmac_f32 v96, v74, v44
v_mfma_f32_16x16x32_bf16 a[228:231], v[140:143], v[252:255], a[228:231]
s_add_u32 s72, s71, 95232
buffer_load_dwordx4 v7, s[16:19], s72 offen offset:3072 lds
v_mfma_f32_16x16x32_bf16 a[224:227], v[132:135], v[252:255], a[224:227]
ds_read_b64_tr_b16 v[232:233], v21 offset:32768
v_fmac_f32 v96, v73, v45
v_mfma_f32_16x16x32_bf16 a[224:227], v[128:131], v[248:251], a[224:227]
s_waitcnt lgkmcnt(9)
ds_read_b64_tr_b16 v[234:235], v21 offset:33792
v_fmac_f32 v96, v72, v46
v_mfma_f32_16x16x32_bf16 a[0:3], v[224:227], v[192:195], a[0:3]
ds_read_b64_tr_b16 v[240:241], v22 offset:32768
v_mul_f32 v96, v96, v97
v_mfma_f32_16x16x32_bf16 a[0:3], v[228:231], v[196:199], a[0:3]
s_add_u32 m0, s63, 69632
ds_read_b64_tr_b16 v[236:237], v21 offset:40960
v_cvt_pk_bf16_f32 v102, v95, v96
v_mfma_f32_16x16x32_bf16 a[4:7], v[228:231], v[204:207], a[4:7]
s_add_u32 s72, s69, 32768
buffer_load_dwordx4 v2, s[8:11], s72 offen lds
v_mfma_f32_16x16x32_bf16 a[4:7], v[224:227], v[200:203], a[4:7]
v_mul_f32 v95, v75, v42
v_and_b32 v97, 0xffff0000, v61
v_mfma_f32_16x16x32_bf16 a[8:11], v[224:227], v[208:211], a[8:11]
ds_read_b64_tr_b16 v[238:239], v21 offset:41984
v_fmac_f32 v95, v74, v43
v_mfma_f32_16x16x32_bf16 a[8:11], v[228:231], v[212:215], a[8:11]
ds_read_b64_tr_b16 v[242:243], v22 offset:33792
v_fmac_f32 v95, v73, v44
v_mfma_f32_16x16x32_bf16 a[12:15], v[228:231], v[220:223], a[12:15]
s_add_u32 s72, s69, 39936
buffer_load_dwordx4 v3, s[8:11], s72 offen offset:1024 lds
v_mfma_f32_16x16x32_bf16 a[12:15], v[224:227], v[216:219], a[12:15]
s_waitcnt lgkmcnt(6)
v_fmac_f32 v95, v72, v45
v_mul_f32 v95, v95, v97
v_mfma_f32_16x16x32_bf16 a[16:19], v[224:227], v[184:187], a[16:19]
ds_read_b64_tr_b16 v[244:245], v22 offset:40960
v_mul_f32 v96, v75, v41
v_mfma_f32_16x16x32_bf16 a[16:19], v[228:231], v[188:191], a[16:19]
v_and_b32 v97, 0xffff0000, v60
v_fmac_f32 v96, v74, v42
v_mfma_f32_16x16x32_bf16 a[20:23], v[228:231], v[180:183], a[20:23]
s_add_u32 s72, s69, 47104
buffer_load_dwordx4 v2, s[8:11], s72 offen offset:2048 lds
v_mfma_f32_16x16x32_bf16 a[20:23], v[224:227], v[176:179], a[20:23]
ds_read_b64_tr_b16 v[246:247], v22 offset:41984
v_fmac_f32 v96, v73, v43
v_mfma_f32_16x16x32_bf16 a[24:27], v[224:227], v[168:171], a[24:27]
v_fmac_f32 v96, v72, v44
v_mul_f32 v96, v96, v97
v_mfma_f32_16x16x32_bf16 a[24:27], v[228:231], v[172:175], a[24:27]
v_cvt_pk_bf16_f32 v103, v95, v96
v_mfma_f32_16x16x32_bf16 a[28:31], v[228:231], v[164:167], a[28:31]
s_add_u32 s72, s69, 54272
buffer_load_dwordx4 v3, s[8:11], s72 offen offset:3072 lds
v_mfma_f32_16x16x32_bf16 a[28:31], v[224:227], v[160:163], a[28:31]
s_waitcnt lgkmcnt(3)
ds_write_b128 v28, v[100:103] offset:272
v_mul_f32 v95, v75, v40
v_mfma_f32_16x16x32_bf16 a[60:63], v[232:235], v[160:163], a[60:63]
ds_read_b64_tr_b16 v[248:249], v23 offset:32768
v_and_b32 v97, 0xffff0000, v59
v_mfma_f32_16x16x32_bf16 a[60:63], v[236:239], v[164:167], a[60:63]
v_fmac_f32 v95, v74, v41
v_fmac_f32 v95, v73, v42
v_mfma_f32_16x16x32_bf16 a[56:59], v[236:239], v[172:175], a[56:59]
s_add_u32 m0, s64, 16384
ds_read_b64_tr_b16 v[250:251], v23 offset:33792
v_fmac_f32 v95, v72, v43
v_mfma_f32_16x16x32_bf16 a[56:59], v[232:235], v[168:171], a[56:59]
s_add_u32 s72, s71, 0
buffer_load_dwordx4 v6, s[20:23], s72 offen lds
v_mfma_f32_16x16x32_bf16 a[52:55], v[232:235], v[176:179], a[52:55]
v_mul_f32 v95, v95, v97
v_mul_f32 v96, v75, v39
v_mfma_f32_16x16x32_bf16 a[52:55], v[236:239], v[180:183], a[52:55]
v_and_b32 v97, 0xffff0000, v58
v_fmac_f32 v96, v74, v40
v_mfma_f32_16x16x32_bf16 a[48:51], v[236:239], v[188:191], a[48:51]
ds_read_b64_tr_b16 v[252:253], v23 offset:40960
v_fmac_f32 v96, v73, v41
v_mfma_f32_16x16x32_bf16 a[48:51], v[232:235], v[184:187], a[48:51]
s_add_u32 s72, s71, 31744
buffer_load_dwordx4 v6, s[20:23], s72 offen offset:1024 lds
v_mfma_f32_16x16x32_bf16 a[44:47], v[232:235], v[216:219], a[44:47]
v_fmac_f32 v96, v72, v42
v_mul_f32 v96, v96, v97
v_mfma_f32_16x16x32_bf16 a[44:47], v[236:239], v[220:223], a[44:47]
v_cvt_pk_bf16_f32 v104, v95, v96
v_mul_f32 v95, v75, v38
v_mfma_f32_16x16x32_bf16 a[40:43], v[236:239], v[212:215], a[40:43]
ds_read_b64_tr_b16 v[254:255], v23 offset:41984
v_and_b32 v97, 0xffff0000, v57
v_mfma_f32_16x16x32_bf16 a[40:43], v[232:235], v[208:211], a[40:43]
s_add_u32 s72, s71, 63488
buffer_load_dwordx4 v7, s[20:23], s72 offen offset:2048 lds
v_mfma_f32_16x16x32_bf16 a[36:39], v[232:235], v[200:203], a[36:39]
v_fmac_f32 v95, v74, v39
v_fmac_f32 v95, v73, v40
v_mfma_f32_16x16x32_bf16 a[36:39], v[236:239], v[204:207], a[36:39]
v_fmac_f32 v95, v72, v41
v_mul_f32 v95, v95, v97
v_mfma_f32_16x16x32_bf16 a[32:35], v[236:239], v[196:199], a[32:35]
s_add_u32 s72, s71, 95232
v_mul_f32 v96, v75, v37
v_and_b32 v97, 0xffff0000, v56
v_mfma_f32_16x16x32_bf16 a[32:35], v[232:235], v[192:195], a[32:35]
s_waitcnt lgkmcnt(5)
buffer_load_dwordx4 v7, s[20:23], s72 offen offset:3072 lds
v_mfma_f32_16x16x32_bf16 a[64:67], v[240:243], v[192:195], a[64:67]
ds_read_b64_tr_b16 v[224:225], v20 offset:49152
v_fmac_f32 v96, v74, v38
v_mfma_f32_16x16x32_bf16 a[64:67], v[244:247], v[196:199], a[64:67]
v_fmac_f32 v96, v73, v39
v_fmac_f32 v96, v72, v40
v_mfma_f32_16x16x32_bf16 a[68:71], v[244:247], v[204:207], a[68:71]
ds_read_b64_tr_b16 v[226:227], v20 offset:50176
v_mul_f32 v96, v96, v97
v_mfma_f32_16x16x32_bf16 a[68:71], v[240:243], v[200:203], a[68:71]
s_mov_b32 s80, 0x400000
buffer_load_dword v126, v125, s[12:15], s80 offen
v_mfma_f32_16x16x32_bf16 a[72:75], v[240:243], v[208:211], a[72:75]
v_cvt_pk_bf16_f32 v105, v95, v96
v_mul_f32 v95, v75, v36
v_mfma_f32_16x16x32_bf16 a[72:75], v[244:247], v[212:215], a[72:75]
v_and_b32 v97, 0xffff0000, v55
v_fmac_f32 v95, v74, v37
v_mfma_f32_16x16x32_bf16 a[76:79], v[244:247], v[220:223], a[76:79]
ds_read_b64_tr_b16 v[228:229], v20 offset:57344
v_fmac_f32 v95, v73, v38
v_mfma_f32_16x16x32_bf16 a[76:79], v[240:243], v[216:219], a[76:79]
s_mov_b32 s80, 0x500000
buffer_load_dword v126, v125, s[12:15], s80 offen
v_mfma_f32_16x16x32_bf16 a[80:83], v[240:243], v[184:187], a[80:83]
v_fmac_f32 v95, v72, v39
v_mul_f32 v95, v95, v97
v_mfma_f32_16x16x32_bf16 a[80:83], v[244:247], v[188:191], a[80:83]
v_mul_f32 v96, v75, v35
v_and_b32 v97, 0xffff0000, v54
v_mfma_f32_16x16x32_bf16 a[84:87], v[244:247], v[180:183], a[84:87]
ds_read_b64_tr_b16 v[230:231], v20 offset:58368
v_fmac_f32 v96, v74, v36
v_mfma_f32_16x16x32_bf16 a[84:87], v[240:243], v[176:179], a[84:87]
s_mov_b32 s80, 0x600000
buffer_load_dword v126, v125, s[12:15], s80 offen
v_mfma_f32_16x16x32_bf16 a[88:91], v[240:243], v[168:171], a[88:91]
v_fmac_f32 v96, v73, v37
v_fmac_f32 v96, v72, v38
v_mfma_f32_16x16x32_bf16 a[88:91], v[244:247], v[172:175], a[88:91]
v_mul_f32 v96, v96, v97
v_cvt_pk_bf16_f32 v106, v95, v96
v_mfma_f32_16x16x32_bf16 a[92:95], v[244:247], v[164:167], a[92:95]
v_mul_f32 v95, v75, v34
v_and_b32 v97, 0xffff0000, v53
v_mfma_f32_16x16x32_bf16 a[92:95], v[240:243], v[160:163], a[92:95]
s_waitcnt lgkmcnt(4)
v_fmac_f32 v95, v74, v35
v_fmac_f32 v95, v73, v36
v_mfma_f32_16x16x32_bf16 a[124:127], v[248:251], v[160:163], a[124:127]
s_mov_b32 s80, 0x700000
buffer_load_dword v126, v125, s[12:15], s80 offen
v_mfma_f32_16x16x32_bf16 a[124:127], v[252:255], v[164:167], a[124:127]
ds_read_b64_tr_b16 v[232:233], v21 offset:49152
v_fmac_f32 v95, v72, v37
v_mfma_f32_16x16x32_bf16 a[120:123], v[252:255], v[172:175], a[120:123]
v_mul_f32 v95, v95, v97
v_mul_f32 v96, v75, v33
v_mfma_f32_16x16x32_bf16 a[120:123], v[248:251], v[168:171], a[120:123]
v_and_b32 v97, 0xffff0000, v52
v_fmac_f32 v96, v74, v34
v_mfma_f32_16x16x32_bf16 a[116:119], v[248:251], v[176:179], a[116:119]
ds_read_b64_tr_b16 v[234:235], v21 offset:50176
v_fmac_f32 v96, v73, v35
v_mfma_f32_16x16x32_bf16 a[116:119], v[252:255], v[180:183], a[116:119]
v_fmac_f32 v96, v72, v36
v_mul_f32 v96, v96, v97
v_mfma_f32_16x16x32_bf16 a[112:115], v[252:255], v[188:191], a[112:115]
v_cvt_pk_bf16_f32 v107, v95, v96
v_mfma_f32_16x16x32_bf16 a[112:115], v[248:251], v[184:187], a[112:115]
ds_read_b64_tr_b16 v[236:237], v21 offset:57344
ds_write_b128 v28, v[104:107] offset:288
v_mfma_f32_16x16x32_bf16 a[108:111], v[248:251], v[216:219], a[108:111]
v_mfma_f32_16x16x32_bf16 a[108:111], v[252:255], v[220:223], a[108:111]
v_mfma_f32_16x16x32_bf16 a[104:107], v[252:255], v[212:215], a[104:107]
ds_read_b64_tr_b16 v[238:239], v21 offset:58368
v_mfma_f32_16x16x32_bf16 a[104:107], v[248:251], v[208:211], a[104:107]
v_mfma_f32_16x16x32_bf16 a[100:103], v[248:251], v[200:203], a[100:103]
v_mfma_f32_16x16x32_bf16 a[100:103], v[252:255], v[204:207], a[100:103]
v_mfma_f32_16x16x32_bf16 a[96:99], v[252:255], v[196:199], a[96:99]
v_mfma_f32_16x16x32_bf16 a[96:99], v[248:251], v[192:195], a[96:99]
s_waitcnt lgkmcnt(5)
v_mfma_f32_16x16x32_bf16 a[128:131], v[192:195], v[224:227], a[128:131]
ds_read_b64_tr_b16 v[240:241], v22 offset:49152
v_mfma_f32_16x16x32_bf16 a[128:131], v[196:199], v[228:231], a[128:131]
v_mfma_f32_16x16x32_bf16 a[132:135], v[204:207], v[228:231], a[132:135]
v_mfma_f32_16x16x32_bf16 a[132:135], v[200:203], v[224:227], a[132:135]
ds_read_b64_tr_b16 v[242:243], v22 offset:50176
v_mfma_f32_16x16x32_bf16 a[136:139], v[208:211], v[224:227], a[136:139]
v_mfma_f32_16x16x32_bf16 a[136:139], v[212:215], v[228:231], a[136:139]
v_mfma_f32_16x16x32_bf16 a[140:143], v[220:223], v[228:231], a[140:143]
v_mfma_f32_16x16x32_bf16 a[140:143], v[216:219], v[224:227], a[140:143]
ds_read_b64_tr_b16 v[244:245], v22 offset:57344
v_mfma_f32_16x16x32_bf16 a[144:147], v[184:187], v[224:227], a[144:147]
v_mfma_f32_16x16x32_bf16 a[144:147], v[188:191], v[228:231], a[144:147]
v_mfma_f32_16x16x32_bf16 a[148:151], v[180:183], v[228:231], a[148:151]
ds_read_b64_tr_b16 v[246:247], v22 offset:58368
v_mfma_f32_16x16x32_bf16 a[148:151], v[176:179], v[224:227], a[148:151]
v_mfma_f32_16x16x32_bf16 a[152:155], v[168:171], v[224:227], a[152:155]
v_mfma_f32_16x16x32_bf16 a[152:155], v[172:175], v[228:231], a[152:155]
v_mfma_f32_16x16x32_bf16 a[156:159], v[164:167], v[228:231], a[156:159]
v_mfma_f32_16x16x32_bf16 a[156:159], v[160:163], v[224:227], a[156:159]
s_waitcnt lgkmcnt(4)
v_mfma_f32_16x16x32_bf16 a[188:191], v[160:163], v[232:235], a[188:191]
ds_read_b64_tr_b16 v[248:249], v23 offset:49152
v_mfma_f32_16x16x32_bf16 a[188:191], v[164:167], v[236:239], a[188:191]
v_mfma_f32_16x16x32_bf16 a[184:187], v[172:175], v[236:239], a[184:187]
ds_read_b64_tr_b16 v[250:251], v23 offset:50176
v_mfma_f32_16x16x32_bf16 a[184:187], v[168:171], v[232:235], a[184:187]
v_mfma_f32_16x16x32_bf16 a[180:183], v[176:179], v[232:235], a[180:183]
ds_read_b64_tr_b16 v[252:253], v23 offset:57344
v_mfma_f32_16x16x32_bf16 a[180:183], v[180:183], v[236:239], a[180:183]
v_mfma_f32_16x16x32_bf16 a[176:179], v[188:191], v[236:239], a[176:179]
ds_read_b64_tr_b16 v[254:255], v23 offset:58368
v_mfma_f32_16x16x32_bf16 a[176:179], v[184:187], v[232:235], a[176:179]
v_mfma_f32_16x16x32_bf16 a[172:175], v[216:219], v[232:235], a[172:175]
s_xor_b32 s73, s61, 7
v_mfma_f32_16x16x32_bf16 a[172:175], v[220:223], v[236:239], a[172:175]
s_lshl_b32 s69, s73, 7
v_mfma_f32_16x16x32_bf16 a[168:171], v[212:215], v[236:239], a[168:171]
s_add_u32 s69, s69, s84
v_mfma_f32_16x16x32_bf16 a[168:171], v[208:211], v[232:235], a[168:171]
s_lshl_b32 s71, s73, 19
v_mfma_f32_16x16x32_bf16 a[164:167], v[200:203], v[232:235], a[164:167]
s_add_u32 s71, s71, s66
v_mfma_f32_16x16x32_bf16 a[164:167], v[204:207], v[236:239], a[164:167]
s_add_u32 m0, s63, 98304
v_mfma_f32_16x16x32_bf16 a[160:163], v[196:199], v[236:239], a[160:163]
s_waitcnt vmcnt(4) lgkmcnt(0)
v_mfma_f32_16x16x32_bf16 a[160:163], v[192:195], v[232:235], a[160:163]
s_barrier
v_mfma_f32_16x16x32_bf16 a[192:195], v[192:195], v[240:243], a[192:195]
s_add_u32 s72, s69, 0
buffer_load_dwordx4 v2, s[8:11], s72 offen lds
v_mfma_f32_16x16x32_bf16 a[192:195], v[196:199], v[244:247], a[192:195]
s_add_u32 s74, s63, 131072
ds_read_b64_tr_b16 v[224:225], v20 offset:0
v_lshrrev_b32 v26, 4, v0
v_mfma_f32_16x16x32_bf16 a[196:199], v[204:207], v[244:247], a[196:199]
ds_read_b64_tr_b16 v[226:227], v20 offset:1024
v_and_b32 v27, 15, v0
v_mfma_f32_16x16x32_bf16 a[196:199], v[200:203], v[240:243], a[196:199]
ds_read_b64_tr_b16 v[228:229], v20 offset:8192
v_lshlrev_b32 v27, 4, v27
v_mfma_f32_16x16x32_bf16 a[200:203], v[208:211], v[240:243], a[200:203]
s_add_u32 s72, s69, 7168
buffer_load_dwordx4 v3, s[8:11], s72 offen offset:1024 lds
v_mfma_f32_16x16x32_bf16 a[200:203], v[212:215], v[244:247], a[200:203]
ds_read_b64_tr_b16 v[230:231], v20 offset:9216
v_mul_u32_u24 v28, 272, v26
v_mfma_f32_16x16x32_bf16 a[204:207], v[220:223], v[244:247], a[204:207]
ds_read_b128 v[128:131], v24 offset:0
v_add3_u32 v28, v28, v27, s74
v_mfma_f32_16x16x32_bf16 a[204:207], v[216:219], v[240:243], a[204:207]
ds_read_b128 v[132:135], v25 offset:0
v_lshl_add_u32 v26, v26, 12, v27
v_mfma_f32_16x16x32_bf16 a[208:211], v[184:187], v[240:243], a[208:211]
s_add_u32 s72, s69, 14336
buffer_load_dwordx4 v2, s[8:11], s72 offen offset:2048 lds
v_mfma_f32_16x16x32_bf16 a[208:211], v[188:191], v[244:247], a[208:211]
ds_read_b128 v[136:139], v24 offset:2048
ds_read_b128 v[36:39], v28 offset:0
v_mfma_f32_16x16x32_bf16 a[212:215], v[180:183], v[244:247], a[212:215]
ds_read_b128 v[140:143], v25 offset:2048
ds_read_b128 v[40:43], v28 offset:1088
v_mfma_f32_16x16x32_bf16 a[212:215], v[176:179], v[240:243], a[212:215]
ds_read_b128 v[144:147], v24 offset:4096
ds_read_b128 v[44:47], v28 offset:2176
v_mfma_f32_16x16x32_bf16 a[216:219], v[168:171], v[240:243], a[216:219]
s_add_u32 s72, s69, 21504
buffer_load_dwordx4 v3, s[8:11], s72 offen offset:3072 lds
v_mfma_f32_16x16x32_bf16 a[216:219], v[172:175], v[244:247], a[216:219]
ds_read_b128 v[148:151], v25 offset:4096
ds_read_b128 v[48:51], v28 offset:3264
v_mfma_f32_16x16x32_bf16 a[220:223], v[164:167], v[244:247], a[220:223]
s_xor_b32 s74, s2, 5
ds_read_b128 v[152:155], v24 offset:6144
v_mfma_f32_16x16x32_bf16 a[220:223], v[160:163], v[240:243], a[220:223]
s_and_b32 s74, s74, 15
ds_read_b128 v[156:159], v25 offset:6144
v_mfma_f32_16x16x32_bf16 a[252:255], v[160:163], v[248:251], a[252:255]
s_add_u32 m0, s64, 32768
v_mfma_f32_16x16x32_bf16 a[252:255], v[164:167], v[252:255], a[252:255]
s_add_u32 s72, s71, 0
buffer_load_dwordx4 v6, s[16:19], s72 offen lds
v_mfma_f32_16x16x32_bf16 a[248:251], v[172:175], v[252:255], a[248:251]
s_lshl_b32 s74, s74, 2
ds_read_b128 v[160:163], v24 offset:8192
v_mfma_f32_16x16x32_bf16 a[248:251], v[168:171], v[248:251], a[248:251]
s_add_u32 s74, s74, s58
ds_read_b128 v[164:167], v25 offset:8192
v_mfma_f32_16x16x32_bf16 a[244:247], v[176:179], v[248:251], a[244:247]
s_lshl_b32 s74, s74, 16
v_mfma_f32_16x16x32_bf16 a[244:247], v[180:183], v[252:255], a[244:247]
s_add_u32 s72, s71, 31744
buffer_load_dwordx4 v6, s[16:19], s72 offen offset:1024 lds
v_mfma_f32_16x16x32_bf16 a[240:243], v[188:191], v[252:255], a[240:243]
s_lshr_b32 s75, s2, 4
ds_read_b128 v[168:171], v24 offset:10240
v_mfma_f32_16x16x32_bf16 a[240:243], v[184:187], v[248:251], a[240:243]
s_lshl_b32 s75, s75, 8
ds_read_b128 v[172:175], v25 offset:10240
v_mfma_f32_16x16x32_bf16 a[236:239], v[216:219], v[248:251], a[236:239]
s_sub_u32 s74, s74, s75
ds_read_b128 v[176:179], v24 offset:12288
v_mfma_f32_16x16x32_bf16 a[236:239], v[220:223], v[252:255], a[236:239]
s_add_u32 s72, s71, 63488
buffer_load_dwordx4 v7, s[16:19], s72 offen offset:2048 lds
v_mfma_f32_16x16x32_bf16 a[232:235], v[212:215], v[252:255], a[232:235]
s_add_u32 s74, s74, 0x3000f00
ds_read_b128 v[180:183], v25 offset:12288
v_mfma_f32_16x16x32_bf16 a[232:235], v[208:211], v[248:251], a[232:235]
s_waitcnt vmcnt(27)
ds_read_b128 v[184:187], v24 offset:14336
v_lshlrev_b32 v78, 16, v84
v_mfma_f32_16x16x32_bf16 a[228:231], v[200:203], v[248:251], a[228:231]
ds_read_b128 v[188:191], v25 offset:14336
v_lshlrev_b32 v79, 16, v108
v_mfma_f32_16x16x32_bf16 a[228:231], v[204:207], v[252:255], a[228:231]
s_add_u32 s72, s71, 95232
buffer_load_dwordx4 v7, s[16:19], s72 offen offset:3072 lds
v_mfma_f32_16x16x32_bf16 a[224:227], v[196:199], v[252:255], a[224:227]
ds_read_b64_tr_b16 v[232:233], v21 offset:0
v_mul_f32 v76, v78, v79
v_mfma_f32_16x16x32_bf16 a[224:227], v[192:195], v[248:251], a[224:227]
s_waitcnt lgkmcnt(9)
ds_read_b64_tr_b16 v[234:235], v21 offset:1024
v_lshlrev_b32 v80, 16, v116
v_mfma_f32_16x16x32_bf16 a[0:3], v[224:227], v[128:131], a[0:3]
ds_read_b64_tr_b16 v[240:241], v22 offset:0
v_mul_f32 v77, v78, v80
v_mfma_f32_16x16x32_bf16 a[0:3], v[228:231], v[132:135], a[0:3]
s_add_u32 m0, s63, 102400
ds_read_b64_tr_b16 v[236:237], v21 offset:8192
v_and_b32 v78, 0xffff0000, v84
v_mfma_f32_16x16x32_bf16 a[4:7], v[228:231], v[140:143], a[4:7]
s_add_u32 s72, s69, 32768
buffer_load_dwordx4 v2, s[8:11], s72 offen lds
v_mfma_f32_16x16x32_bf16 a[4:7], v[224:227], v[136:139], a[4:7]
v_and_b32 v79, 0xffff0000, v108
v_fmac_f32 v76, v78, v79
v_mfma_f32_16x16x32_bf16 a[8:11], v[224:227], v[144:147], a[8:11]
ds_read_b64_tr_b16 v[238:239], v21 offset:9216
v_and_b32 v80, 0xffff0000, v116
v_mfma_f32_16x16x32_bf16 a[8:11], v[228:231], v[148:151], a[8:11]
ds_read_b64_tr_b16 v[242:243], v22 offset:1024
v_fmac_f32 v77, v78, v80
v_mfma_f32_16x16x32_bf16 a[12:15], v[228:231], v[156:159], a[12:15]
s_add_u32 s72, s69, 39936
buffer_load_dwordx4 v3, s[8:11], s72 offen offset:1024 lds
v_mfma_f32_16x16x32_bf16 a[12:15], v[224:227], v[152:155], a[12:15]
s_waitcnt lgkmcnt(6)
v_lshlrev_b32 v78, 16, v85
v_lshlrev_b32 v79, 16, v109
v_mfma_f32_16x16x32_bf16 a[16:19], v[224:227], v[160:163], a[16:19]
ds_read_b64_tr_b16 v[244:245], v22 offset:8192
v_fmac_f32 v76, v78, v79
v_mfma_f32_16x16x32_bf16 a[16:19], v[228:231], v[164:167], a[16:19]
v_lshlrev_b32 v80, 16, v117
v_fmac_f32 v77, v78, v80
v_mfma_f32_16x16x32_bf16 a[20:23], v[228:231], v[172:175], a[20:23]
s_add_u32 s72, s69, 47104
buffer_load_dwordx4 v2, s[8:11], s72 offen offset:2048 lds
v_mfma_f32_16x16x32_bf16 a[20:23], v[224:227], v[168:171], a[20:23]
ds_read_b64_tr_b16 v[246:247], v22 offset:9216
v_and_b32 v78, 0xffff0000, v85
v_mfma_f32_16x16x32_bf16 a[24:27], v[224:227], v[176:179], a[24:27]
v_and_b32 v79, 0xffff0000, v109
v_fmac_f32 v76, v78, v79
v_mfma_f32_16x16x32_bf16 a[24:27], v[228:231], v[180:183], a[24:27]
v_and_b32 v80, 0xffff0000, v117
v_fmac_f32 v77, v78, v80
v_mfma_f32_16x16x32_bf16 a[28:31], v[228:231], v[188:191], a[28:31]
s_add_u32 s72, s69, 54272
buffer_load_dwordx4 v3, s[8:11], s72 offen offset:3072 lds
v_mfma_f32_16x16x32_bf16 a[28:31], v[224:227], v[184:187], a[28:31]
s_waitcnt lgkmcnt(3)
v_lshlrev_b32 v78, 16, v86
v_lshlrev_b32 v79, 16, v110
v_mfma_f32_16x16x32_bf16 a[60:63], v[232:235], v[184:187], a[60:63]
ds_read_b64_tr_b16 v[248:249], v23 offset:0
v_fmac_f32 v76, v78, v79
v_mfma_f32_16x16x32_bf16 a[60:63], v[236:239], v[188:191], a[60:63]
v_lshlrev_b32 v80, 16, v118
v_fmac_f32 v77, v78, v80
v_mfma_f32_16x16x32_bf16 a[56:59], v[236:239], v[180:183], a[56:59]
s_add_u32 m0, s64, 49152
ds_read_b64_tr_b16 v[250:251], v23 offset:1024
v_and_b32 v78, 0xffff0000, v86
v_mfma_f32_16x16x32_bf16 a[56:59], v[232:235], v[176:179], a[56:59]
s_add_u32 s72, s71, 0
buffer_load_dwordx4 v6, s[20:23], s72 offen lds
v_mfma_f32_16x16x32_bf16 a[52:55], v[232:235], v[168:171], a[52:55]
v_and_b32 v79, 0xffff0000, v110
v_fmac_f32 v76, v78, v79
v_mfma_f32_16x16x32_bf16 a[52:55], v[236:239], v[172:175], a[52:55]
v_and_b32 v80, 0xffff0000, v118
v_fmac_f32 v77, v78, v80
v_mfma_f32_16x16x32_bf16 a[48:51], v[236:239], v[164:167], a[48:51]
ds_read_b64_tr_b16 v[252:253], v23 offset:8192
v_lshlrev_b32 v78, 16, v87
v_mfma_f32_16x16x32_bf16 a[48:51], v[232:235], v[160:163], a[48:51]
s_add_u32 s72, s71, 31744
buffer_load_dwordx4 v6, s[20:23], s72 offen offset:1024 lds
v_mfma_f32_16x16x32_bf16 a[44:47], v[232:235], v[152:155], a[44:47]
v_lshlrev_b32 v79, 16, v111
v_fmac_f32 v76, v78, v79
v_mfma_f32_16x16x32_bf16 a[44:47], v[236:239], v[156:159], a[44:47]
v_lshlrev_b32 v80, 16, v119
v_fmac_f32 v77, v78, v80
v_mfma_f32_16x16x32_bf16 a[40:43], v[236:239], v[148:151], a[40:43]
ds_read_b64_tr_b16 v[254:255], v23 offset:9216
v_and_b32 v78, 0xffff0000, v87
v_mfma_f32_16x16x32_bf16 a[40:43], v[232:235], v[144:147], a[40:43]
s_add_u32 s72, s71, 63488
buffer_load_dwordx4 v7, s[20:23], s72 offen offset:2048 lds
v_mfma_f32_16x16x32_bf16 a[36:39], v[232:235], v[136:139], a[36:39]
v_and_b32 v79, 0xffff0000, v111
v_fmac_f32 v76, v78, v79
v_mfma_f32_16x16x32_bf16 a[36:39], v[236:239], v[140:143], a[36:39]
v_and_b32 v80, 0xffff0000, v119
v_fmac_f32 v77, v78, v80
v_mfma_f32_16x16x32_bf16 a[32:35], v[236:239], v[132:135], a[32:35]
s_add_u32 s72, s71, 95232
v_lshlrev_b32 v78, 16, v88
v_lshlrev_b32 v79, 16, v112
v_mfma_f32_16x16x32_bf16 a[32:35], v[232:235], v[128:131], a[32:35]
s_waitcnt lgkmcnt(4)
buffer_load_dwordx4 v7, s[20:23], s72 offen offset:3072 lds
v_mfma_f32_16x16x32_bf16 a[64:67], v[240:243], v[128:131], a[64:67]
s_waitcnt lgkmcnt(15)
ds_read_b64_tr_b16 v[224:225], v20 offset:16384
v_fmac_f32 v76, v78, v79
v_mfma_f32_16x16x32_bf16 a[64:67], v[244:247], v[132:135], a[64:67]
s_add_u32 s73, s62, 0
v_lshlrev_b32 v80, 16, v120
v_fmac_f32 v77, v78, v80
v_mfma_f32_16x16x32_bf16 a[68:71], v[244:247], v[140:143], a[68:71]
s_add_u32 s70, s73, s65
ds_read_b64_tr_b16 v[226:227], v20 offset:17408
v_and_b32 v78, 0xffff0000, v88
v_mfma_f32_16x16x32_bf16 a[68:71], v[240:243], v[136:139], a[68:71]
s_and_b32 s70, s70, 3
v_and_b32 v79, 0xffff0000, v112
v_fmac_f32 v76, v78, v79
v_mfma_f32_16x16x32_bf16 a[72:75], v[240:243], v[144:147], a[72:75]
s_and_b32 s73, s73, 12
v_and_b32 v80, 0xffff0000, v120
v_fmac_f32 v77, v78, v80
v_mfma_f32_16x16x32_bf16 a[72:75], v[244:247], v[148:151], a[72:75]
s_or_b32 s73, s73, s70
Lstuba3:
s_cbranch_execz Lreta
ds_read_b64_tr_b16 v[228:229], v20 offset:24576
v_lshlrev_b32 v78, 16, v89
v_mfma_f32_16x16x32_bf16 a[76:79], v[244:247], v[156:159], a[76:79]
s_lshl_b32 s73, s73, 7
v_lshlrev_b32 v79, 16, v113
v_fmac_f32 v76, v78, v79
v_mfma_f32_16x16x32_bf16 a[76:79], v[240:243], v[152:155], a[76:79]
s_add_u32 s69, s73, s67
ds_read_b64_tr_b16 v[230:231], v20 offset:25600
v_lshlrev_b32 v80, 16, v121
v_mfma_f32_16x16x32_bf16 a[80:83], v[240:243], v[160:163], a[80:83]
s_add_u32 s70, s73, s68
v_fmac_f32 v77, v78, v80
v_and_b32 v78, 0xffff0000, v89
v_mfma_f32_16x16x32_bf16 a[80:83], v[244:247], v[164:167], a[80:83]
s_add_u32 m0, s63, 131072
v_and_b32 v79, 0xffff0000, v113
v_fmac_f32 v76, v78, v79
v_mfma_f32_16x16x32_bf16 a[84:87], v[244:247], v[172:175], a[84:87]
s_add_u32 s72, s69, 0
buffer_load_dwordx4 v4, s[4:7], s72 offen lds
v_mfma_f32_16x16x32_bf16 a[84:87], v[240:243], v[168:171], a[84:87]
s_add_u32 s72, s69, 15360
buffer_load_dwordx4 v5, s[4:7], s72 offen offset:1024 lds
v_mfma_f32_16x16x32_bf16 a[88:91], v[240:243], v[176:179], a[88:91]
s_add_u32 s72, s69, 129024
buffer_load_dwordx4 v4, s[4:7], s72 offen offset:2048 lds
v_mfma_f32_16x16x32_bf16 a[88:91], v[244:247], v[180:183], a[88:91]
s_add_u32 s72, s69, 144384
buffer_load_dwordx4 v5, s[4:7], s72 offen offset:3072 lds
v_mfma_f32_16x16x32_bf16 a[92:95], v[244:247], v[188:191], a[92:95]
v_and_b32 v80, 0xffff0000, v121
v_fmac_f32 v77, v78, v80
v_mfma_f32_16x16x32_bf16 a[92:95], v[240:243], v[184:187], a[92:95]
s_waitcnt lgkmcnt(4)
v_lshlrev_b32 v78, 16, v90
v_lshlrev_b32 v79, 16, v114
v_mfma_f32_16x16x32_bf16 a[124:127], v[248:251], v[184:187], a[124:127]
ds_read_b64_tr_b16 v[232:233], v21 offset:16384
v_fmac_f32 v76, v78, v79
v_mfma_f32_16x16x32_bf16 a[124:127], v[252:255], v[188:191], a[124:127]
v_lshlrev_b32 v80, 16, v122
v_fmac_f32 v77, v78, v80
v_mfma_f32_16x16x32_bf16 a[120:123], v[252:255], v[180:183], a[120:123]
s_add_u32 m0, s63, 135168
ds_read_b64_tr_b16 v[234:235], v21 offset:17408
v_and_b32 v78, 0xffff0000, v90
v_mfma_f32_16x16x32_bf16 a[120:123], v[248:251], v[176:179], a[120:123]
s_add_u32 s72, s70, 0
buffer_load_dwordx4 v4, s[4:7], s72 offen lds
v_mfma_f32_16x16x32_bf16 a[116:119], v[248:251], v[168:171], a[116:119]
s_lshr_b32 s75, s93, 5
v_and_b32 v79, 0xffff0000, v114
v_fmac_f32 v76, v78, v79
v_mfma_f32_16x16x32_bf16 a[116:119], v[252:255], v[172:175], a[116:119]
s_and_b32 s75, s75, 0x3f80
ds_read_b64_tr_b16 v[236:237], v21 offset:24576
v_and_b32 v80, 0xffff0000, v122
v_mfma_f32_16x16x32_bf16 a[112:115], v[252:255], v[164:167], a[112:115]
s_add_u32 s75, s75, LcB0-Lpc0
v_lshrrev_b32 v2, 6, v0
v_lshlrev_b32 v2, 7, v2
v_mfma_f32_16x16x32_bf16 a[112:115], v[248:251], v[160:163], a[112:115]
s_add_u32 s72, s70, 15360
buffer_load_dwordx4 v5, s[4:7], s72 offen offset:1024 lds
v_mfma_f32_16x16x32_bf16 a[108:111], v[248:251], v[152:155], a[108:111]
v_add_u32 v2, s75, v2
v_min_u32 v2, Lcode_end-Lpc0, v2
v_mfma_f32_16x16x32_bf16 a[108:111], v[252:255], v[156:159], a[108:111]
global_load_dword v3, v2, s[98:99]
v_mfma_f32_16x16x32_bf16 a[104:107], v[252:255], v[148:151], a[104:107]
v_fmac_f32 v77, v78, v80
v_lshlrev_b32 v78, 16, v91
v_mfma_f32_16x16x32_bf16 a[104:107], v[248:251], v[144:147], a[104:107]
s_add_u32 s72, s70, 129024
buffer_load_dwordx4 v4, s[4:7], s72 offen offset:2048 lds
v_mfma_f32_16x16x32_bf16 a[100:103], v[248:251], v[136:139], a[100:103]
ds_read_b64_tr_b16 v[238:239], v21 offset:25600
v_lshlrev_b32 v79, 16, v115
v_mfma_f32_16x16x32_bf16 a[100:103], v[252:255], v[140:143], a[100:103]
v_fmac_f32 v76, v78, v79
v_lshlrev_b32 v80, 16, v123
v_mfma_f32_16x16x32_bf16 a[96:99], v[252:255], v[132:135], a[96:99]
v_fmac_f32 v77, v78, v80
v_and_b32 v78, 0xffff0000, v91
v_mfma_f32_16x16x32_bf16 a[96:99], v[248:251], v[128:131], a[96:99]
s_waitcnt lgkmcnt(4)
v_and_b32 v79, 0xffff0000, v115
v_fmac_f32 v76, v78, v79
v_mfma_f32_16x16x32_bf16 a[128:131], v[128:131], v[224:227], a[128:131]
s_add_u32 s72, s70, 144384
buffer_load_dwordx4 v5, s[4:7], s72 offen offset:3072 lds
v_mfma_f32_16x16x32_bf16 a[128:131], v[132:135], v[228:231], a[128:131]
ds_read_b64_tr_b16 v[240:241], v22 offset:16384
v_and_b32 v80, 0xffff0000, v123
v_mfma_f32_16x16x32_bf16 a[132:135], v[140:143], v[228:231], a[132:135]
v_fmac_f32 v77, v78, v80
v_add_f32_dpp v76, v76, v76 row_ror:8 row_mask:0xf bank_mask:0xf
v_mfma_f32_16x16x32_bf16 a[132:135], v[136:139], v[224:227], a[132:135]
v_add_f32_dpp v77, v77, v77 row_ror:8 row_mask:0xf bank_mask:0xf
v_add_f32_dpp v76, v76, v76 row_ror:4 row_mask:0xf bank_mask:0xf
v_mfma_f32_16x16x32_bf16 a[136:139], v[144:147], v[224:227], a[136:139]
ds_read_b64_tr_b16 v[242:243], v22 offset:17408
v_add_f32_dpp v77, v77, v77 row_ror:4 row_mask:0xf bank_mask:0xf
v_mfma_f32_16x16x32_bf16 a[136:139], v[148:151], v[228:231], a[136:139]
v_add_f32_dpp v76, v76, v76 row_ror:2 row_mask:0xf bank_mask:0xf
v_add_f32_dpp v77, v77, v77 row_ror:2 row_mask:0xf bank_mask:0xf
v_mfma_f32_16x16x32_bf16 a[140:143], v[156:159], v[228:231], a[140:143]
v_add_f32_dpp v76, v76, v76 row_ror:1 row_mask:0xf bank_mask:0xf
v_add_f32_dpp v77, v77, v77 row_ror:1 row_mask:0xf bank_mask:0xf
v_mfma_f32_16x16x32_bf16 a[140:143], v[152:155], v[224:227], a[140:143]
ds_read_b64_tr_b16 v[244:245], v22 offset:24576
v_mov_b32 v78, v76
v_mfma_f32_16x16x32_bf16 a[144:147], v[160:163], v[224:227], a[144:147]
v_mov_b32 v79, v77
v_permlane16_swap_b32 v76, v78
v_mfma_f32_16x16x32_bf16 a[144:147], v[164:167], v[228:231], a[144:147]
v_permlane16_swap_b32 v77, v79
v_add_f32 v76, v76, v78
v_mfma_f32_16x16x32_bf16 a[148:151], v[172:175], v[228:231], a[148:151]
ds_read_b64_tr_b16 v[246:247], v22 offset:25600
v_add_f32 v77, v77, v79
v_mfma_f32_16x16x32_bf16 a[148:151], v[168:171], v[224:227], a[148:151]
v_mov_b32 v78, v76
v_mov_b32 v79, v77
v_mfma_f32_16x16x32_bf16 a[152:155], v[176:179], v[224:227], a[152:155]
v_permlane32_swap_b32 v76, v78
v_permlane32_swap_b32 v77, v79
v_mfma_f32_16x16x32_bf16 a[152:155], v[180:183], v[228:231], a[152:155]
v_add_f32 v76, v76, v78
v_add_f32 v77, v77, v79
v_mfma_f32_16x16x32_bf16 a[156:159], v[188:191], v[228:231], a[156:159]
v_mul_f32 v76, 0xbfb8aa3b, v76
v_mul_f32 v77, 0xbfb8aa3b, v77
v_mfma_f32_16x16x32_bf16 a[156:159], v[184:187], v[224:227], a[156:159]
s_waitcnt lgkmcnt(4)
v_exp_f32 v76, v76
v_mfma_f32_16x16x32_bf16 a[188:191], v[184:187], v[232:235], a[188:191]
ds_read_b64_tr_b16 v[248:249], v23 offset:16384
v_mfma_f32_16x16x32_bf16 a[188:191], v[188:191], v[236:239], a[188:191]
v_exp_f32 v77, v77
v_mfma_f32_16x16x32_bf16 a[184:187], v[180:183], v[236:239], a[184:187]
ds_read_b64_tr_b16 v[250:251], v23 offset:17408
v_add_f32 v76, 1.0, v76
v_mfma_f32_16x16x32_bf16 a[184:187], v[176:179], v[232:235], a[184:187]
v_add_f32 v77, 1.0, v77
v_mfma_f32_16x16x32_bf16 a[180:183], v[168:171], v[232:235], a[180:183]
ds_read_b64_tr_b16 v[252:253], v23 offset:24576
v_mfma_f32_16x16x32_bf16 a[180:183], v[172:175], v[236:239], a[180:183]
v_rcp_f32 v76, v76
v_mfma_f32_16x16x32_bf16 a[176:179], v[164:167], v[236:239], a[176:179]
ds_read_b64_tr_b16 v[254:255], v23 offset:25600
v_mfma_f32_16x16x32_bf16 a[176:179], v[160:163], v[232:235], a[176:179]
v_rcp_f32 v77, v77
v_mfma_f32_16x16x32_bf16 a[172:175], v[152:155], v[232:235], a[172:175]
s_lshr_b32 s80, s76, 9
v_mfma_f32_16x16x32_bf16 a[172:175], v[156:159], v[236:239], a[172:175]
s_add_u32 s80, s80, 0x3800000
v_min_u32 v78, 1, v0
v_lshlrev_b32 v78, 30, v78
v_mfma_f32_16x16x32_bf16 a[168:171], v[148:151], v[236:239], a[168:171]
buffer_store_dwordx2 v[76:77], v78, s[44:47], s80 offen sc1
v_mfma_f32_16x16x32_bf16 a[168:171], v[144:147], v[232:235], a[168:171]
v_mfma_f32_16x16x32_bf16 a[164:167], v[136:139], v[232:235], a[164:167]
v_mfma_f32_16x16x32_bf16 a[164:167], v[140:143], v[236:239], a[164:167]
v_mfma_f32_16x16x32_bf16 a[160:163], v[132:135], v[236:239], a[160:163]
s_waitcnt vmcnt(10) lgkmcnt(0)
v_mfma_f32_16x16x32_bf16 a[160:163], v[128:131], v[232:235], a[160:163]
s_barrier
v_mfma_f32_16x16x32_bf16 a[192:195], v[128:131], v[240:243], a[192:195]
s_lshl_b32 s71, s73, 12
ds_read_b64_tr_b16 v[224:225], v20 offset:32768
v_mfma_f32_16x16x32_bf16 a[192:195], v[132:135], v[244:247], a[192:195]
s_add_u32 s71, s71, s66
ds_read_b64_tr_b16 v[226:227], v20 offset:33792
v_mfma_f32_16x16x32_bf16 a[196:199], v[140:143], v[244:247], a[196:199]
s_add_u32 m0, s64, 0
v_mov_b32 v100, v20
v_mov_b32 v101, v21
v_mfma_f32_16x16x32_bf16 a[196:199], v[136:139], v[240:243], a[196:199]
s_add_u32 s72, s71, 0
buffer_load_dwordx4 v6, s[12:15], s72 offen lds
v_mfma_f32_16x16x32_bf16 a[200:203], v[144:147], v[240:243], a[200:203]
v_mov_b32 v102, v22
v_mov_b32 v103, v23
v_mfma_f32_16x16x32_bf16 a[200:203], v[148:151], v[244:247], a[200:203]
ds_read_b64_tr_b16 v[228:229], v20 offset:40960
v_mfma_f32_16x16x32_bf16 a[204:207], v[156:159], v[244:247], a[204:207]
s_add_u32 s72, s71, 31744
buffer_load_dwordx4 v6, s[12:15], s72 offen offset:1024 lds
v_mfma_f32_16x16x32_bf16 a[204:207], v[152:155], v[240:243], a[204:207]
ds_read_b64_tr_b16 v[230:231], v20 offset:41984
v_mfma_f32_16x16x32_bf16 a[208:211], v[160:163], v[240:243], a[208:211]
s_waitcnt lgkmcnt(15)
buffer_store_dwordx4 v[36:39], v26, s[44:47], s74 offen sc1
v_mfma_f32_16x16x32_bf16 a[208:211], v[164:167], v[244:247], a[208:211]
ds_read_b128 v[192:195], v24 offset:32768
v_mfma_f32_16x16x32_bf16 a[212:215], v[172:175], v[244:247], a[212:215]
ds_read_b128 v[196:199], v25 offset:32768
v_mfma_f32_16x16x32_bf16 a[212:215], v[168:171], v[240:243], a[212:215]
ds_read_b128 v[200:203], v24 offset:34816
v_mfma_f32_16x16x32_bf16 a[216:219], v[176:179], v[240:243], a[216:219]
s_add_u32 s72, s71, 63488
buffer_load_dwordx4 v7, s[12:15], s72 offen offset:2048 lds
v_mfma_f32_16x16x32_bf16 a[216:219], v[180:183], v[244:247], a[216:219]
ds_read_b128 v[204:207], v25 offset:34816
v_mfma_f32_16x16x32_bf16 a[220:223], v[188:191], v[244:247], a[220:223]
ds_read_b128 v[208:211], v24 offset:36864
v_mfma_f32_16x16x32_bf16 a[220:223], v[184:187], v[240:243], a[220:223]
ds_read_b128 v[212:215], v25 offset:36864
v_mfma_f32_16x16x32_bf16 a[252:255], v[184:187], v[248:251], a[252:255]
ds_read_b128 v[216:219], v24 offset:38912
v_mfma_f32_16x16x32_bf16 a[252:255], v[188:191], v[252:255], a[252:255]
ds_read_b128 v[220:223], v25 offset:38912
v_mfma_f32_16x16x32_bf16 a[248:251], v[180:183], v[252:255], a[248:251]
s_add_u32 s72, s71, 95232
buffer_load_dwordx4 v7, s[12:15], s72 offen offset:3072 lds
v_mfma_f32_16x16x32_bf16 a[248:251], v[176:179], v[248:251], a[248:251]
ds_read_b128 v[184:187], v24 offset:40960
v_mfma_f32_16x16x32_bf16 a[244:247], v[168:171], v[248:251], a[244:247]
ds_read_b128 v[188:191], v25 offset:40960
v_mfma_f32_16x16x32_bf16 a[244:247], v[172:175], v[252:255], a[244:247]
ds_read_b128 v[176:179], v24 offset:43008
v_mfma_f32_16x16x32_bf16 a[240:243], v[164:167], v[252:255], a[240:243]
ds_read_b128 v[180:183], v25 offset:43008
v_mfma_f32_16x16x32_bf16 a[240:243], v[160:163], v[248:251], a[240:243]
v_mfma_f32_16x16x32_bf16 a[236:239], v[152:155], v[248:251], a[236:239]
s_add_u32 s74, s74, 0x4000
buffer_store_dwordx4 v[40:43], v26, s[44:47], s74 offen sc1
v_mfma_f32_16x16x32_bf16 a[236:239], v[156:159], v[252:255], a[236:239]
s_add_u32 s73, s62, 1
ds_read_b128 v[168:171], v24 offset:45056
v_mfma_f32_16x16x32_bf16 a[232:235], v[148:151], v[252:255], a[232:235]
s_add_u32 s70, s73, s65
ds_read_b128 v[172:175], v25 offset:45056
v_mfma_f32_16x16x32_bf16 a[232:235], v[144:147], v[248:251], a[232:235]
s_and_b32 s70, s70, 3
ds_read_b128 v[160:163], v24 offset:47104
v_mfma_f32_16x16x32_bf16 a[228:231], v[136:139], v[248:251], a[228:231]
s_and_b32 s73, s73, 12
ds_read_b128 v[164:167], v25 offset:47104
v_mfma_f32_16x16x32_bf16 a[228:231], v[140:143], v[252:255], a[228:231]
s_or_b32 s73, s73, s70
v_mfma_f32_16x16x32_bf16 a[224:227], v[132:135], v[252:255], a[224:227]
s_lshl_b32 s73, s73, 7
ds_read_b64_tr_b16 v[232:233], v101 offset:32768
v_mfma_f32_16x16x32_bf16 a[224:227], v[128:131], v[248:251], a[224:227]
s_waitcnt lgkmcnt(9)
ds_read_b64_tr_b16 v[234:235], v101 offset:33792
v_mfma_f32_16x16x32_bf16 a[0:3], v[224:227], v[192:195], a[0:3]
s_add_u32 s69, s73, s67
ds_read_b64_tr_b16 v[236:237], v101 offset:40960
v_mfma_f32_16x16x32_bf16 a[0:3], v[228:231], v[196:199], a[0:3]
s_add_u32 s70, s73, s68
ds_read_b64_tr_b16 v[238:239], v101 offset:41984
v_mfma_f32_16x16x32_bf16 a[4:7], v[228:231], v[204:207], a[4:7]
s_add_u32 m0, s63, 65536
ds_read_b64_tr_b16 v[240:241], v102 offset:32768
v_mfma_f32_16x16x32_bf16 a[4:7], v[224:227], v[200:203], a[4:7]
s_add_u32 s72, s69, 0
buffer_load_dwordx4 v4, s[4:7], s72 offen lds
v_mfma_f32_16x16x32_bf16 a[8:11], v[224:227], v[208:211], a[8:11]
s_add_u32 s72, s69, 15360
buffer_load_dwordx4 v5, s[4:7], s72 offen offset:1024 lds
v_mfma_f32_16x16x32_bf16 a[8:11], v[228:231], v[212:215], a[8:11]
s_add_u32 s72, s69, 129024
buffer_load_dwordx4 v4, s[4:7], s72 offen offset:2048 lds
v_mfma_f32_16x16x32_bf16 a[12:15], v[228:231], v[220:223], a[12:15]
ds_read_b64_tr_b16 v[242:243], v102 offset:33792
v_mfma_f32_16x16x32_bf16 a[12:15], v[224:227], v[216:219], a[12:15]
s_waitcnt lgkmcnt(6)
v_mfma_f32_16x16x32_bf16 a[16:19], v[224:227], v[184:187], a[16:19]
s_add_u32 s74, s74, 0x4000
buffer_store_dwordx4 v[44:47], v26, s[44:47], s74 offen sc1
v_mfma_f32_16x16x32_bf16 a[16:19], v[228:231], v[188:191], a[16:19]
ds_read_b64_tr_b16 v[244:245], v102 offset:40960
v_mfma_f32_16x16x32_bf16 a[20:23], v[228:231], v[180:183], a[20:23]
v_mfma_f32_16x16x32_bf16 a[20:23], v[224:227], v[176:179], a[20:23]
ds_read_b64_tr_b16 v[246:247], v102 offset:41984
v_mfma_f32_16x16x32_bf16 a[24:27], v[224:227], v[168:171], a[24:27]
s_add_u32 s72, s69, 144384
buffer_load_dwordx4 v5, s[4:7], s72 offen offset:3072 lds
v_mfma_f32_16x16x32_bf16 a[24:27], v[228:231], v[172:175], a[24:27]
v_mfma_f32_16x16x32_bf16 a[28:31], v[228:231], v[164:167], a[28:31]
v_mfma_f32_16x16x32_bf16 a[28:31], v[224:227], v[160:163], a[28:31]
s_waitcnt lgkmcnt(4)
v_mfma_f32_16x16x32_bf16 a[60:63], v[232:235], v[160:163], a[60:63]
ds_read_b64_tr_b16 v[248:249], v103 offset:32768
v_mfma_f32_16x16x32_bf16 a[60:63], v[236:239], v[164:167], a[60:63]
v_mfma_f32_16x16x32_bf16 a[56:59], v[236:239], v[172:175], a[56:59]
s_add_u32 m0, s63, 69632
ds_read_b64_tr_b16 v[250:251], v103 offset:33792
v_mfma_f32_16x16x32_bf16 a[56:59], v[232:235], v[168:171], a[56:59]
s_add_u32 s72, s70, 0
buffer_load_dwordx4 v4, s[4:7], s72 offen lds
v_mfma_f32_16x16x32_bf16 a[52:55], v[232:235], v[176:179], a[52:55]
v_mfma_f32_16x16x32_bf16 a[52:55], v[236:239], v[180:183], a[52:55]
v_mfma_f32_16x16x32_bf16 a[48:51], v[236:239], v[188:191], a[48:51]
ds_read_b64_tr_b16 v[252:253], v103 offset:40960
v_mfma_f32_16x16x32_bf16 a[48:51], v[232:235], v[184:187], a[48:51]
v_mfma_f32_16x16x32_bf16 a[44:47], v[232:235], v[216:219], a[44:47]
s_add_u32 s72, s70, 15360
buffer_load_dwordx4 v5, s[4:7], s72 offen offset:1024 lds
v_mfma_f32_16x16x32_bf16 a[44:47], v[236:239], v[220:223], a[44:47]
s_add_u32 s74, s74, 0x4000
buffer_store_dwordx4 v[48:51], v26, s[44:47], s74 offen sc1
v_mfma_f32_16x16x32_bf16 a[40:43], v[236:239], v[212:215], a[40:43]
v_mfma_f32_16x16x32_bf16 a[40:43], v[232:235], v[208:211], a[40:43]
ds_read_b64_tr_b16 v[254:255], v103 offset:41984
v_mfma_f32_16x16x32_bf16 a[36:39], v[232:235], v[200:203], a[36:39]
v_mfma_f32_16x16x32_bf16 a[36:39], v[236:239], v[204:207], a[36:39]
v_mfma_f32_16x16x32_bf16 a[32:35], v[236:239], v[196:199], a[32:35]
v_mfma_f32_16x16x32_bf16 a[32:35], v[232:235], v[192:195], a[32:35]
s_waitcnt lgkmcnt(4)
v_mfma_f32_16x16x32_bf16 a[64:67], v[240:243], v[192:195], a[64:67]
s_add_u32 s72, s70, 129024
buffer_load_dwordx4 v4, s[4:7], s72 offen offset:2048 lds
v_mfma_f32_16x16x32_bf16 a[64:67], v[244:247], v[196:199], a[64:67]
ds_read_b64_tr_b16 v[224:225], v100 offset:49152
v_mfma_f32_16x16x32_bf16 a[68:71], v[244:247], v[204:207], a[68:71]
v_mfma_f32_16x16x32_bf16 a[68:71], v[240:243], v[200:203], a[68:71]
v_mfma_f32_16x16x32_bf16 a[72:75], v[240:243], v[208:211], a[72:75]
ds_read_b64_tr_b16 v[226:227], v100 offset:50176
v_mfma_f32_16x16x32_bf16 a[72:75], v[244:247], v[212:215], a[72:75]
s_add_u32 s72, s70, 144384
buffer_load_dwordx4 v5, s[4:7], s72 offen offset:3072 lds
v_mfma_f32_16x16x32_bf16 a[76:79], v[244:247], v[220:223], a[76:79]
v_mfma_f32_16x16x32_bf16 a[76:79], v[240:243], v[216:219], a[76:79]
v_mfma_f32_16x16x32_bf16 a[80:83], v[240:243], v[184:187], a[80:83]
ds_read_b64_tr_b16 v[228:229], v100 offset:57344
v_mfma_f32_16x16x32_bf16 a[80:83], v[244:247], v[188:191], a[80:83]
v_mfma_f32_16x16x32_bf16 a[84:87], v[244:247], v[180:183], a[84:87]
v_accvgpr_read_b32 v20, a0
v_accvgpr_read_b32 v28, a1
v_mfma_f32_16x16x32_bf16 a[84:87], v[240:243], v[176:179], a[84:87]
s_lshl_b32 s71, s73, 12
ds_read_b64_tr_b16 v[230:231], v100 offset:58368
v_accvgpr_read_b32 v21, a2
v_mfma_f32_16x16x32_bf16 a[88:91], v[240:243], v[168:171], a[88:91]
s_add_u32 s71, s71, s66
v_accvgpr_read_b32 v29, a3
v_accvgpr_read_b32 v22, a32
v_mfma_f32_16x16x32_bf16 a[88:91], v[244:247], v[172:175], a[88:91]
s_add_u32 m0, s64, 16384
v_accvgpr_read_b32 v30, a33
v_accvgpr_read_b32 v23, a34
v_mfma_f32_16x16x32_bf16 a[92:95], v[244:247], v[164:167], a[92:95]
s_add_u32 s72, s71, 0
buffer_load_dwordx4 v6, s[12:15], s72 offen lds
v_mfma_f32_16x16x32_bf16 a[92:95], v[240:243], v[160:163], a[92:95]
s_waitcnt lgkmcnt(4)
v_accvgpr_read_b32 v31, a35
v_mul_f32 v20, s79, v20
v_mfma_f32_16x16x32_bf16 a[124:127], v[248:251], v[160:163], a[124:127]
ds_read_b64_tr_b16 v[232:233], v101 offset:49152
v_mul_f32 v28, s79, v28
v_mfma_f32_16x16x32_bf16 a[124:127], v[252:255], v[164:167], a[124:127]
v_mul_f32 v21, s79, v21
v_mul_f32 v29, s79, v29
v_mfma_f32_16x16x32_bf16 a[120:123], v[252:255], v[172:175], a[120:123]
s_add_u32 s72, s71, 31744
buffer_load_dwordx4 v6, s[12:15], s72 offen offset:1024 lds
v_mfma_f32_16x16x32_bf16 a[120:123], v[248:251], v[168:171], a[120:123]
v_mul_f32 v22, s79, v22
v_mul_f32 v30, s79, v30
v_mfma_f32_16x16x32_bf16 a[116:119], v[248:251], v[176:179], a[116:119]
ds_read_b64_tr_b16 v[234:235], v101 offset:50176
v_mul_f32 v23, s79, v23
v_mfma_f32_16x16x32_bf16 a[116:119], v[252:255], v[180:183], a[116:119]
v_mul_f32 v31, s79, v31
v_cvt_pk_bf16_f32 v20, v20, v28
v_mfma_f32_16x16x32_bf16 a[112:115], v[252:255], v[188:191], a[112:115]
v_cvt_pk_bf16_f32 v21, v21, v29
v_cvt_pk_bf16_f32 v22, v22, v30
v_mfma_f32_16x16x32_bf16 a[112:115], v[248:251], v[184:187], a[112:115]
ds_read_b64_tr_b16 v[236:237], v101 offset:57344
v_cvt_pk_bf16_f32 v23, v23, v31
v_mfma_f32_16x16x32_bf16 a[108:111], v[248:251], v[216:219], a[108:111]
s_add_u32 s72, s71, 63488
buffer_load_dwordx4 v7, s[12:15], s72 offen offset:2048 lds
v_mfma_f32_16x16x32_bf16 a[108:111], v[252:255], v[220:223], a[108:111]
s_add_u32 s80, s77, 0
buffer_store_dwordx4 v[20:23], v1, s[44:47], s80 offen sc1
v_mfma_f32_16x16x32_bf16 a[104:107], v[252:255], v[212:215], a[104:107]
v_mfma_f32_16x16x32_bf16 a[104:107], v[248:251], v[208:211], a[104:107]
ds_read_b64_tr_b16 v[238:239], v101 offset:58368
v_mfma_f32_16x16x32_bf16 a[100:103], v[248:251], v[200:203], a[100:103]
v_mfma_f32_16x16x32_bf16 a[100:103], v[252:255], v[204:207], a[100:103]
v_mfma_f32_16x16x32_bf16 a[96:99], v[252:255], v[196:199], a[96:99]
s_add_u32 s72, s71, 95232
buffer_load_dwordx4 v7, s[12:15], s72 offen offset:3072 lds
v_mfma_f32_16x16x32_bf16 a[96:99], v[248:251], v[192:195], a[96:99]
s_waitcnt lgkmcnt(4)
LcB0:
v_mfma_f32_16x16x32_bf16 a[128:131], v[192:195], v[224:227], a[128:131]
ds_read_b64_tr_b16 v[240:241], v102 offset:49152
v_accvgpr_read_b32 v24, a4
v_mfma_f32_16x16x32_bf16 a[128:131], v[196:199], v[228:231], a[128:131]
v_accvgpr_read_b32 v28, a5
v_accvgpr_read_b32 v25, a6
v_mfma_f32_16x16x32_bf16 a[132:135], v[204:207], v[228:231], a[132:135]
v_accvgpr_read_b32 v29, a7
v_accvgpr_read_b32 v26, a36
v_mfma_f32_16x16x32_bf16 a[132:135], v[200:203], v[224:227], a[132:135]
ds_read_b64_tr_b16 v[242:243], v102 offset:50176
v_accvgpr_read_b32 v30, a37
v_mfma_f32_16x16x32_bf16 a[136:139], v[208:211], v[224:227], a[136:139]
v_accvgpr_read_b32 v27, a38
v_accvgpr_read_b32 v31, a39
v_mfma_f32_16x16x32_bf16 a[136:139], v[212:215], v[228:231], a[136:139]
v_mul_f32 v24, s79, v24
v_mul_f32 v28, s79, v28
v_mfma_f32_16x16x32_bf16 a[140:143], v[220:223], v[228:231], a[140:143]
v_mul_f32 v25, s79, v25
v_mul_f32 v29, s79, v29
v_mfma_f32_16x16x32_bf16 a[140:143], v[216:219], v[224:227], a[140:143]
ds_read_b64_tr_b16 v[244:245], v102 offset:57344
v_mul_f32 v26, s79, v26
v_mfma_f32_16x16x32_bf16 a[144:147], v[184:187], v[224:227], a[144:147]
v_mul_f32 v30, s79, v30
v_mul_f32 v27, s79, v27
v_mfma_f32_16x16x32_bf16 a[144:147], v[188:191], v[228:231], a[144:147]
v_mul_f32 v31, s79, v31
v_cvt_pk_bf16_f32 v24, v24, v28
v_mfma_f32_16x16x32_bf16 a[148:151], v[180:183], v[228:231], a[148:151]
ds_read_b64_tr_b16 v[246:247], v102 offset:58368
v_cvt_pk_bf16_f32 v25, v25, v29
v_mfma_f32_16x16x32_bf16 a[148:151], v[176:179], v[224:227], a[148:151]
v_cvt_pk_bf16_f32 v26, v26, v30
v_cvt_pk_bf16_f32 v27, v27, v31
v_mfma_f32_16x16x32_bf16 a[152:155], v[168:171], v[224:227], a[152:155]
s_add_u32 s80, s77, 4096
buffer_store_dwordx4 v[24:27], v1, s[44:47], s80 offen sc1
v_mfma_f32_16x16x32_bf16 a[152:155], v[172:175], v[228:231], a[152:155]
v_mfma_f32_16x16x32_bf16 a[156:159], v[164:167], v[228:231], a[156:159]
v_mfma_f32_16x16x32_bf16 a[156:159], v[160:163], v[224:227], a[156:159]
s_waitcnt lgkmcnt(4)
v_mfma_f32_16x16x32_bf16 a[188:191], v[160:163], v[232:235], a[188:191]
ds_read_b64_tr_b16 v[248:249], v103 offset:49152
v_mfma_f32_16x16x32_bf16 a[188:191], v[164:167], v[236:239], a[188:191]
v_mfma_f32_16x16x32_bf16 a[184:187], v[172:175], v[236:239], a[184:187]
ds_read_b64_tr_b16 v[250:251], v103 offset:50176
v_mfma_f32_16x16x32_bf16 a[184:187], v[168:171], v[232:235], a[184:187]
v_mfma_f32_16x16x32_bf16 a[180:183], v[176:179], v[232:235], a[180:183]
ds_read_b64_tr_b16 v[252:253], v103 offset:57344
v_mfma_f32_16x16x32_bf16 a[180:183], v[180:183], v[236:239], a[180:183]
s_add_u32 s73, s62, 2
v_mfma_f32_16x16x32_bf16 a[176:179], v[188:191], v[236:239], a[176:179]
s_add_u32 s70, s73, s65
ds_read_b64_tr_b16 v[254:255], v103 offset:58368
v_accvgpr_read_b32 v20, a8
v_mfma_f32_16x16x32_bf16 a[176:179], v[184:187], v[232:235], a[176:179]
s_and_b32 s70, s70, 3
v_accvgpr_read_b32 v28, a9
v_accvgpr_read_b32 v21, a10
v_mfma_f32_16x16x32_bf16 a[172:175], v[216:219], v[232:235], a[172:175]
s_and_b32 s73, s73, 12
v_accvgpr_read_b32 v29, a11
v_accvgpr_read_b32 v22, a40
v_mfma_f32_16x16x32_bf16 a[172:175], v[220:223], v[236:239], a[172:175]
s_or_b32 s73, s73, s70
v_accvgpr_read_b32 v30, a41
v_accvgpr_read_b32 v23, a42
v_mfma_f32_16x16x32_bf16 a[168:171], v[212:215], v[236:239], a[168:171]
s_lshl_b32 s73, s73, 7
v_accvgpr_read_b32 v31, a43
v_mul_f32 v20, s79, v20
v_mfma_f32_16x16x32_bf16 a[168:171], v[208:211], v[232:235], a[168:171]
s_add_u32 s69, s73, s67
v_mul_f32 v28, s79, v28
v_mul_f32 v21, s79, v21
v_mfma_f32_16x16x32_bf16 a[164:167], v[200:203], v[232:235], a[164:167]
s_add_u32 s70, s73, s68
v_mul_f32 v29, s79, v29
v_mul_f32 v22, s79, v22
v_mfma_f32_16x16x32_bf16 a[164:167], v[204:207], v[236:239], a[164:167]
s_add_u32 m0, s63, 98304
v_mul_f32 v30, s79, v30
v_mul_f32 v23, s79, v23
v_mfma_f32_16x16x32_bf16 a[160:163], v[196:199], v[236:239], a[160:163]
s_waitcnt vmcnt(8) lgkmcnt(0)
v_mul_f32 v31, s79, v31
v_cvt_pk_bf16_f32 v20, v20, v28
v_mfma_f32_16x16x32_bf16 a[160:163], v[192:195], v[232:235], a[160:163]
s_barrier
v_cvt_pk_bf16_f32 v21, v21, v29
v_cvt_pk_bf16_f32 v22, v22, v30
v_mfma_f32_16x16x32_bf16 a[192:195], v[192:195], v[240:243], a[192:195]
s_add_u32 s72, s69, 0
buffer_load_dwordx4 v4, s[4:7], s72 offen lds
v_mfma_f32_16x16x32_bf16 a[192:195], v[196:199], v[244:247], a[192:195]
s_lshl_b32 s74, s59, 2
ds_read_b64_tr_b16 v[64:65], v8 offset:0
v_or_b32 v106, s58, v0
v_mfma_f32_16x16x32_bf16 a[196:199], v[204:207], v[244:247], a[196:199]
ds_read_b64_tr_b16 v[66:67], v8 offset:1024
v_mov_b32 v107, 1
v_mfma_f32_16x16x32_bf16 a[196:199], v[200:203], v[240:243], a[196:199]
ds_read_b64_tr_b16 v[68:69], v8 offset:8192
v_lshlrev_b32 v106, 8, v106
v_mfma_f32_16x16x32_bf16 a[200:203], v[208:211], v[240:243], a[200:203]
ds_read_b64_tr_b16 v[70:71], v8 offset:9216
v_cvt_pk_bf16_f32 v23, v23, v31
v_mfma_f32_16x16x32_bf16 a[200:203], v[212:215], v[244:247], a[200:203]
s_add_u32 s72, s69, 15360
buffer_load_dwordx4 v5, s[4:7], s72 offen offset:1024 lds
v_mfma_f32_16x16x32_bf16 a[204:207], v[220:223], v[244:247], a[204:207]
s_add_u32 s80, s77, 8192
ds_read_b128 v[32:35], v16 offset:0
v_mfma_f32_16x16x32_bf16 a[204:207], v[216:219], v[240:243], a[204:207]
buffer_atomic_add v107, v106, s[48:51], s74 offen sc1
v_mfma_f32_16x16x32_bf16 a[208:211], v[184:187], v[240:243], a[208:211]
ds_read_b128 v[36:39], v17 offset:0
v_mfma_f32_16x16x32_bf16 a[208:211], v[188:191], v[244:247], a[208:211]
ds_read_b128 v[40:43], v16 offset:2048
v_mfma_f32_16x16x32_bf16 a[212:215], v[180:183], v[244:247], a[212:215]
s_add_u32 s72, s69, 129024
buffer_load_dwordx4 v4, s[4:7], s72 offen offset:2048 lds
v_mfma_f32_16x16x32_bf16 a[212:215], v[176:179], v[240:243], a[212:215]
ds_read_b128 v[44:47], v17 offset:2048
v_mfma_f32_16x16x32_bf16 a[216:219], v[168:171], v[240:243], a[216:219]
ds_read_b128 v[48:51], v16 offset:4096
v_accvgpr_read_b32 v24, a128
v_mfma_f32_16x16x32_bf16 a[216:219], v[172:175], v[244:247], a[216:219]
ds_read_b128 v[52:55], v17 offset:4096
v_accvgpr_read_b32 v28, a129
v_mfma_f32_16x16x32_bf16 a[220:223], v[164:167], v[244:247], a[220:223]
buffer_store_dwordx4 v[20:23], v1, s[44:47], s80 offen sc1
v_mfma_f32_16x16x32_bf16 a[220:223], v[160:163], v[240:243], a[220:223]
s_add_u32 s72, s69, 144384
buffer_load_dwordx4 v5, s[4:7], s72 offen offset:3072 lds
v_mfma_f32_16x16x32_bf16 a[252:255], v[160:163], v[248:251], a[252:255]
ds_read_b128 v[56:59], v16 offset:6144
v_accvgpr_read_b32 v25, a130
v_mfma_f32_16x16x32_bf16 a[252:255], v[164:167], v[252:255], a[252:255]
ds_read_b128 v[60:63], v17 offset:6144
v_accvgpr_read_b32 v29, a131
v_mfma_f32_16x16x32_bf16 a[248:251], v[172:175], v[252:255], a[248:251]
ds_read_b64_tr_b16 v[72:73], v9 offset:0
v_accvgpr_read_b32 v26, a132
v_mfma_f32_16x16x32_bf16 a[248:251], v[168:171], v[248:251], a[248:251]
s_add_u32 m0, s63, 102400
ds_read_b64_tr_b16 v[74:75], v9 offset:1024
v_accvgpr_read_b32 v30, a133
v_mfma_f32_16x16x32_bf16 a[244:247], v[176:179], v[248:251], a[244:247]
s_add_u32 s72, s70, 0
buffer_load_dwordx4 v4, s[4:7], s72 offen lds
v_mfma_f32_16x16x32_bf16 a[244:247], v[180:183], v[252:255], a[244:247]
ds_read_b64_tr_b16 v[76:77], v9 offset:8192
v_accvgpr_read_b32 v27, a134
v_mfma_f32_16x16x32_bf16 a[240:243], v[188:191], v[252:255], a[240:243]
v_accvgpr_read_b32 v31, a135
v_cvt_pk_bf16_f32 v24, v24, v28
v_mfma_f32_16x16x32_bf16 a[240:243], v[184:187], v[248:251], a[240:243]
ds_read_b64_tr_b16 v[78:79], v9 offset:9216
v_cvt_pk_bf16_f32 v25, v25, v29
v_mfma_f32_16x16x32_bf16 a[236:239], v[216:219], v[248:251], a[236:239]
ds_read_b64_tr_b16 v[80:81], v10 offset:0
v_cvt_pk_bf16_f32 v26, v26, v30
v_mfma_f32_16x16x32_bf16 a[236:239], v[220:223], v[252:255], a[236:239]
s_add_u32 s72, s70, 15360
buffer_load_dwordx4 v5, s[4:7], s72 offen offset:1024 lds
v_mfma_f32_16x16x32_bf16 a[232:235], v[212:215], v[252:255], a[232:235]
ds_read_b64_tr_b16 v[82:83], v10 offset:1024
v_cvt_pk_bf16_f32 v27, v27, v31
v_mfma_f32_16x16x32_bf16 a[232:235], v[208:211], v[248:251], a[232:235]
s_add_u32 s80, s78, 0
ds_read_b64_tr_b16 v[84:85], v10 offset:8192
v_mfma_f32_16x16x32_bf16 a[228:231], v[200:203], v[248:251], a[228:231]
ds_read_b64_tr_b16 v[86:87], v10 offset:9216
v_mfma_f32_16x16x32_bf16 a[228:231], v[204:207], v[252:255], a[228:231]
buffer_store_dwordx4 v[24:27], v1, s[44:47], s80 offen sc1
v_mfma_f32_16x16x32_bf16 a[224:227], v[196:199], v[252:255], a[224:227]
s_add_u32 s72, s70, 129024
buffer_load_dwordx4 v4, s[4:7], s72 offen offset:2048 lds
v_mfma_f32_16x16x32_bf16 a[224:227], v[192:195], v[248:251], a[224:227]
s_waitcnt lgkmcnt(8)
v_mfma_f32_16x16x32_bf16 v[128:131], v[64:67], v[32:35], 0
ds_read_b64_tr_b16 v[88:89], v11 offset:0
v_mfma_f32_16x16x32_bf16 v[128:131], v[68:71], v[36:39], v[128:131]
ds_read_b64_tr_b16 v[90:91], v11 offset:1024
v_mfma_f32_16x16x32_bf16 v[132:135], v[68:71], v[44:47], 0
v_accvgpr_read_b32 v20, a12
v_accvgpr_read_b32 v28, a13
v_mfma_f32_16x16x32_bf16 v[132:135], v[64:67], v[40:43], v[132:135]
s_add_u32 s72, s70, 144384
buffer_load_dwordx4 v5, s[4:7], s72 offen offset:3072 lds
v_mfma_f32_16x16x32_bf16 v[136:139], v[64:67], v[48:51], 0
s_lshl_b32 s71, s73, 12
ds_read_b64_tr_b16 v[92:93], v11 offset:8192
v_accvgpr_read_b32 v21, a14
v_mfma_f32_16x16x32_bf16 v[136:139], v[68:71], v[52:55], v[136:139]
s_add_u32 s71, s71, s66
v_accvgpr_read_b32 v29, a15
v_accvgpr_read_b32 v22, a44
v_mfma_f32_16x16x32_bf16 v[140:143], v[68:71], v[60:63], 0
s_add_u32 m0, s64, 32768
ds_read_b64_tr_b16 v[94:95], v11 offset:9216
v_accvgpr_read_b32 v30, a45
v_mfma_f32_16x16x32_bf16 v[140:143], v[64:67], v[56:59], v[140:143]
s_waitcnt lgkmcnt(8)
v_accvgpr_read_b32 v23, a46
v_accvgpr_read_b32 v31, a47
v_mfma_f32_16x16x32_bf16 v[156:159], v[72:75], v[56:59], 0
s_add_u32 s72, s71, 0
buffer_load_dwordx4 v6, s[12:15], s72 offen lds
v_mfma_f32_16x16x32_bf16 v[156:159], v[76:79], v[60:63], v[156:159]
s_add_u32 s73, s62, 3
ds_read_b64_tr_b16 v[64:65], v12 offset:0
v_mul_f32 v20, s79, v20
v_mfma_f32_16x16x32_bf16 v[152:155], v[76:79], v[52:55], 0
s_add_u32 s70, s73, s65
ds_read_b64_tr_b16 v[66:67], v12 offset:1024
v_mul_f32 v28, s79, v28
v_mfma_f32_16x16x32_bf16 v[152:155], v[72:75], v[48:51], v[152:155]
s_add_u32 s72, s71, 31744
buffer_load_dwordx4 v6, s[12:15], s72 offen offset:1024 lds
v_mfma_f32_16x16x32_bf16 v[148:151], v[72:75], v[40:43], 0
s_and_b32 s70, s70, 3
v_mul_f32 v21, s79, v21
v_mul_f32 v29, s79, v29
v_mfma_f32_16x16x32_bf16 v[148:151], v[76:79], v[44:47], v[148:151]
s_and_b32 s73, s73, 12
ds_read_b64_tr_b16 v[68:69], v12 offset:8192
v_mul_f32 v22, s79, v22
v_mfma_f32_16x16x32_bf16 v[144:147], v[76:79], v[36:39], 0
s_or_b32 s73, s73, s70
ds_read_b64_tr_b16 v[70:71], v12 offset:9216
v_mul_f32 v30, s79, v30
v_mfma_f32_16x16x32_bf16 v[144:147], v[72:75], v[32:35], v[144:147]
s_waitcnt lgkmcnt(8)
v_mul_f32 v23, s79, v23
v_mul_f32 v31, s79, v31
v_mfma_f32_16x16x32_bf16 v[160:163], v[80:83], v[32:35], 0
s_lshl_b32 s73, s73, 7
ds_read_b64_tr_b16 v[72:73], v13 offset:0
v_cvt_pk_bf16_f32 v20, v20, v28
v_mfma_f32_16x16x32_bf16 v[160:163], v[84:87], v[36:39], v[160:163]
s_add_u32 s72, s71, 63488
buffer_load_dwordx4 v7, s[12:15], s72 offen offset:2048 lds
v_mfma_f32_16x16x32_bf16 v[164:167], v[84:87], v[44:47], 0
s_add_u32 s69, s73, s67
ds_read_b64_tr_b16 v[74:75], v13 offset:1024
v_cvt_pk_bf16_f32 v21, v21, v29
v_mfma_f32_16x16x32_bf16 v[164:167], v[80:83], v[40:43], v[164:167]
s_add_u32 s70, s73, s68
v_cvt_pk_bf16_f32 v22, v22, v30
v_cvt_pk_bf16_f32 v23, v23, v31
v_mfma_f32_16x16x32_bf16 v[168:171], v[80:83], v[48:51], 0
s_waitcnt vmcnt(20)
ds_read_b64_tr_b16 v[76:77], v13 offset:8192
v_mfma_f32_16x16x32_bf16 v[168:171], v[84:87], v[52:55], v[168:171]
s_add_u32 s80, s77, 12288
ds_read_b64_tr_b16 v[78:79], v13 offset:9216
v_mfma_f32_16x16x32_bf16 v[172:175], v[84:87], v[60:63], 0
s_add_u32 s72, s71, 95232
ds_read_b128 v[96:99], v18 offset:0
v_mfma_f32_16x16x32_bf16 v[172:175], v[80:83], v[56:59], v[172:175]
s_waitcnt lgkmcnt(9)
buffer_load_dwordx4 v7, s[12:15], s72 offen offset:3072 lds
v_mfma_f32_16x16x32_bf16 v[188:191], v[88:91], v[56:59], 0
ds_read_b64_tr_b16 v[80:81], v14 offset:0
v_accvgpr_read_b32 v24, a136
v_mfma_f32_16x16x32_bf16 v[188:191], v[92:95], v[60:63], v[188:191]
ds_read_b64_tr_b16 v[82:83], v14 offset:1024
v_accvgpr_read_b32 v28, a137
v_mfma_f32_16x16x32_bf16 v[184:187], v[92:95], v[52:55], 0
ds_read_b128 v[100:103], v19 offset:0
v_accvgpr_read_b32 v25, a138
v_mfma_f32_16x16x32_bf16 v[184:187], v[88:91], v[48:51], v[184:187]
ds_read_b64_tr_b16 v[84:85], v14 offset:8192
v_accvgpr_read_b32 v29, a139
v_mfma_f32_16x16x32_bf16 v[180:183], v[88:91], v[40:43], 0
buffer_store_dwordx4 v[20:23], v1, s[44:47], s80 offen sc1
v_mfma_f32_16x16x32_bf16 v[180:183], v[92:95], v[44:47], v[180:183]
s_add_u32 m0, s63, 131072
ds_read_b64_tr_b16 v[86:87], v14 offset:9216
v_accvgpr_read_b32 v26, a140
v_mfma_f32_16x16x32_bf16 v[176:179], v[92:95], v[36:39], 0
s_add_u32 s72, s69, 0
buffer_load_dwordx4 v4, s[4:7], s72 offen lds
v_mfma_f32_16x16x32_bf16 v[176:179], v[88:91], v[32:35], v[176:179]
s_waitcnt lgkmcnt(10)
ds_read_b128 v[104:107], v18 offset:2048
v_accvgpr_read_b32 v30, a141
v_mfma_f32_16x16x32_bf16 v[192:195], v[64:67], v[32:35], 0
ds_read_b64_tr_b16 v[88:89], v15 offset:0
v_accvgpr_read_b32 v27, a142
v_mfma_f32_16x16x32_bf16 v[192:195], v[68:71], v[36:39], v[192:195]
ds_read_b64_tr_b16 v[90:91], v15 offset:1024
v_accvgpr_read_b32 v31, a143
v_mfma_f32_16x16x32_bf16 v[196:199], v[68:71], v[44:47], 0
ds_read_b64_tr_b16 v[92:93], v15 offset:8192
v_cvt_pk_bf16_f32 v24, v24, v28
v_mfma_f32_16x16x32_bf16 v[196:199], v[64:67], v[40:43], v[196:199]
s_add_u32 s72, s69, 15360
buffer_load_dwordx4 v5, s[4:7], s72 offen offset:1024 lds
v_mfma_f32_16x16x32_bf16 v[200:203], v[64:67], v[48:51], 0
ds_read_b64_tr_b16 v[94:95], v15 offset:9216
v_cvt_pk_bf16_f32 v25, v25, v29
v_mfma_f32_16x16x32_bf16 v[200:203], v[68:71], v[52:55], v[200:203]
ds_read_b128 v[108:111], v19 offset:2048
v_cvt_pk_bf16_f32 v26, v26, v30
v_mfma_f32_16x16x32_bf16 v[204:207], v[68:71], v[60:63], 0
v_cvt_pk_bf16_f32 v27, v27, v31
v_mfma_f32_16x16x32_bf16 v[204:207], v[64:67], v[56:59], v[204:207]
s_waitcnt lgkmcnt(12)
ds_read_b128 v[112:115], v18 offset:4096
v_mfma_f32_16x16x32_bf16 v[220:223], v[72:75], v[56:59], 0
s_add_u32 s72, s69, 129024
buffer_load_dwordx4 v4, s[4:7], s72 offen offset:2048 lds
v_mfma_f32_16x16x32_bf16 v[220:223], v[76:79], v[60:63], v[220:223]
s_add_u32 s80, s78, 8192
buffer_store_dwordx4 v[24:27], v1, s[44:47], s80 offen sc1
v_mfma_f32_16x16x32_bf16 v[216:219], v[76:79], v[52:55], 0
s_waitcnt vmcnt(21) lgkmcnt(2)
ds_read_b128 v[116:119], v19 offset:4096
v_mfma_f32_16x16x32_bf16 v[216:219], v[72:75], v[48:51], v[216:219]
s_barrier
ds_read_b128 v[120:123], v18 offset:6144
v_mfma_f32_16x16x32_bf16 v[212:215], v[72:75], v[40:43], 0
ds_read_b64_tr_b16 v[64:65], v8 offset:16384
ds_read_b64_tr_b16 v[66:67], v8 offset:17408
v_mfma_f32_16x16x32_bf16 v[212:215], v[76:79], v[44:47], v[212:215]
ds_read_b64_tr_b16 v[68:69], v8 offset:24576
v_mfma_f32_16x16x32_bf16 v[208:211], v[76:79], v[36:39], 0
s_add_u32 s72, s69, 144384
buffer_load_dwordx4 v5, s[4:7], s72 offen offset:3072 lds
v_mfma_f32_16x16x32_bf16 v[208:211], v[72:75], v[32:35], v[208:211]
ds_read_b64_tr_b16 v[70:71], v8 offset:25600
v_accvgpr_read_b32 v20, a16
v_mfma_f32_16x16x32_bf16 v[224:227], v[80:83], v[32:35], 0
ds_read_b64_tr_b16 v[72:73], v9 offset:16384
v_accvgpr_read_b32 v28, a17
v_mfma_f32_16x16x32_bf16 v[224:227], v[84:87], v[36:39], v[224:227]
ds_read_b64_tr_b16 v[74:75], v9 offset:17408
v_accvgpr_read_b32 v21, a18
v_mfma_f32_16x16x32_bf16 v[228:231], v[84:87], v[44:47], 0
s_add_u32 m0, s63, 135168
v_accvgpr_read_b32 v29, a19
v_accvgpr_read_b32 v22, a48
v_mfma_f32_16x16x32_bf16 v[228:231], v[80:83], v[40:43], v[228:231]
s_add_u32 s72, s70, 0
buffer_load_dwordx4 v4, s[4:7], s72 offen lds
v_mfma_f32_16x16x32_bf16 v[232:235], v[80:83], v[48:51], 0
ds_read_b64_tr_b16 v[76:77], v9 offset:24576
v_accvgpr_read_b32 v30, a49
v_mfma_f32_16x16x32_bf16 v[232:235], v[84:87], v[52:55], v[232:235]
ds_read_b128 v[124:127], v19 offset:6144
v_accvgpr_read_b32 v23, a50
v_mfma_f32_16x16x32_bf16 v[236:239], v[84:87], v[60:63], 0
ds_read_b64_tr_b16 v[78:79], v9 offset:25600
v_accvgpr_read_b32 v31, a51
v_mfma_f32_16x16x32_bf16 v[236:239], v[80:83], v[56:59], v[236:239]
v_mul_f32 v20, s79, v20
v_mul_f32 v28, s79, v28
v_mfma_f32_16x16x32_bf16 v[252:255], v[88:91], v[56:59], 0
s_add_u32 s72, s70, 15360
buffer_load_dwordx4 v5, s[4:7], s72 offen offset:1024 lds
v_mfma_f32_16x16x32_bf16 v[252:255], v[92:95], v[60:63], v[252:255]
ds_read_b64_tr_b16 v[80:81], v10 offset:16384
v_mul_f32 v21, s79, v21
v_mfma_f32_16x16x32_bf16 v[248:251], v[92:95], v[52:55], 0
ds_read_b64_tr_b16 v[82:83], v10 offset:17408
v_mul_f32 v29, s79, v29
v_mfma_f32_16x16x32_bf16 v[248:251], v[88:91], v[48:51], v[248:251]
v_mul_f32 v22, s79, v22
v_mul_f32 v30, s79, v30
v_mfma_f32_16x16x32_bf16 v[244:247], v[88:91], v[40:43], 0
ds_read_b64_tr_b16 v[84:85], v10 offset:24576
v_mul_f32 v23, s79, v23
v_mfma_f32_16x16x32_bf16 v[244:247], v[92:95], v[44:47], v[244:247]
ds_read_b64_tr_b16 v[86:87], v10 offset:25600
v_mul_f32 v31, s79, v31
v_mfma_f32_16x16x32_bf16 v[240:243], v[92:95], v[36:39], 0
s_add_u32 s72, s70, 129024
buffer_load_dwordx4 v4, s[4:7], s72 offen offset:2048 lds
v_mfma_f32_16x16x32_bf16 v[240:243], v[88:91], v[32:35], v[240:243]
s_waitcnt lgkmcnt(5)
v_cvt_pk_bf16_f32 v20, v20, v28
v_cvt_pk_bf16_f32 v21, v21, v29
v_mfma_f32_16x16x32_bf16 v[128:131], v[64:67], v[96:99], v[128:131]
ds_read_b64_tr_b16 v[88:89], v11 offset:16384
v_cvt_pk_bf16_f32 v22, v22, v30
v_mfma_f32_16x16x32_bf16 v[128:131], v[68:71], v[100:103], v[128:131]
ds_read_b64_tr_b16 v[90:91], v11 offset:17408
v_cvt_pk_bf16_f32 v23, v23, v31
v_mfma_f32_16x16x32_bf16 v[132:135], v[68:71], v[108:111], v[132:135]
s_add_u32 s80, s77, 32768
buffer_store_dwordx4 v[20:23], v1, s[44:47], s80 offen sc1
v_mfma_f32_16x16x32_bf16 v[132:135], v[64:67], v[104:107], v[132:135]
s_add_u32 s72, s70, 144384
buffer_load_dwordx4 v5, s[4:7], s72 offen offset:3072 lds
v_mfma_f32_16x16x32_bf16 v[136:139], v[64:67], v[112:115], v[136:139]
ds_read_b64_tr_b16 v[92:93], v11 offset:24576
v_accvgpr_read_b32 v24, a144
v_mfma_f32_16x16x32_bf16 v[136:139], v[68:71], v[116:119], v[136:139]
s_lshl_b32 s71, s73, 12
v_accvgpr_read_b32 v28, a145
v_accvgpr_read_b32 v25, a146
v_mfma_f32_16x16x32_bf16 v[140:143], v[68:71], v[124:127], v[140:143]
s_add_u32 s71, s71, s66
ds_read_b64_tr_b16 v[94:95], v11 offset:25600
v_accvgpr_read_b32 v29, a147
v_mfma_f32_16x16x32_bf16 v[140:143], v[64:67], v[120:123], v[140:143]
s_waitcnt lgkmcnt(8)
v_accvgpr_read_b32 v26, a148
v_accvgpr_read_b32 v30, a149
v_mfma_f32_16x16x32_bf16 v[156:159], v[72:75], v[120:123], v[156:159]
s_add_u32 m0, s64, 0
ds_read_b64_tr_b16 v[64:65], v12 offset:16384
v_accvgpr_read_b32 v27, a150
v_mfma_f32_16x16x32_bf16 v[156:159], v[76:79], v[124:127], v[156:159]
s_add_u32 s72, s71, 0
buffer_load_dwordx4 v6, s[12:15], s72 offen lds
v_mfma_f32_16x16x32_bf16 v[152:155], v[76:79], v[116:119], v[152:155]
s_add_u32 s73, s62, 4
ds_read_b64_tr_b16 v[66:67], v12 offset:17408
v_accvgpr_read_b32 v31, a151
v_mfma_f32_16x16x32_bf16 v[152:155], v[72:75], v[112:115], v[152:155]
s_add_u32 s70, s73, s65
v_cvt_pk_bf16_f32 v24, v24, v28
v_cvt_pk_bf16_f32 v25, v25, v29
v_mfma_f32_16x16x32_bf16 v[148:151], v[72:75], v[104:107], v[148:151]
s_and_b32 s70, s70, 3
ds_read_b64_tr_b16 v[68:69], v12 offset:24576
v_cvt_pk_bf16_f32 v26, v26, v30
v_mfma_f32_16x16x32_bf16 v[148:151], v[76:79], v[108:111], v[148:151]
s_and_b32 s73, s73, 12
ds_read_b64_tr_b16 v[70:71], v12 offset:25600
v_cvt_pk_bf16_f32 v27, v27, v31
v_mfma_f32_16x16x32_bf16 v[144:147], v[76:79], v[100:103], v[144:147]
s_add_u32 s72, s71, 31744
buffer_load_dwordx4 v6, s[12:15], s72 offen offset:1024 lds
v_mfma_f32_16x16x32_bf16 v[144:147], v[72:75], v[96:99], v[144:147]
s_waitcnt lgkmcnt(8)
v_mfma_f32_16x16x32_bf16 v[160:163], v[80:83], v[96:99], v[160:163]
s_or_b32 s73, s73, s70
ds_read_b64_tr_b16 v[72:73], v13 offset:16384
v_mfma_f32_16x16x32_bf16 v[160:163], v[84:87], v[100:103], v[160:163]
s_lshl_b32 s73, s73, 7
ds_read_b64_tr_b16 v[74:75], v13 offset:17408
v_mfma_f32_16x16x32_bf16 v[164:167], v[84:87], v[108:111], v[164:167]
s_add_u32 s69, s73, s67
v_mfma_f32_16x16x32_bf16 v[164:167], v[80:83], v[104:107], v[164:167]
s_add_u32 s72, s71, 63488
buffer_load_dwordx4 v7, s[12:15], s72 offen offset:2048 lds
v_mfma_f32_16x16x32_bf16 v[168:171], v[80:83], v[112:115], v[168:171]
s_waitcnt vmcnt(18)
ds_read_b64_tr_b16 v[76:77], v13 offset:24576
v_mfma_f32_16x16x32_bf16 v[168:171], v[84:87], v[116:119], v[168:171]
s_add_u32 s70, s73, s68
ds_read_b128 v[32:35], v18 offset:32768
v_mfma_f32_16x16x32_bf16 v[172:175], v[84:87], v[124:127], v[172:175]
s_add_u32 s80, s78, 32768
ds_read_b64_tr_b16 v[78:79], v13 offset:25600
v_mfma_f32_16x16x32_bf16 v[172:175], v[80:83], v[120:123], v[172:175]
s_waitcnt lgkmcnt(9)
ds_read_b128 v[36:39], v19 offset:32768
v_mfma_f32_16x16x32_bf16 v[188:191], v[88:91], v[120:123], v[188:191]
s_add_u32 s72, s71, 95232
buffer_load_dwordx4 v7, s[12:15], s72 offen offset:3072 lds
v_mfma_f32_16x16x32_bf16 v[188:191], v[92:95], v[124:127], v[188:191]
ds_read_b64_tr_b16 v[80:81], v14 offset:16384
v_mfma_f32_16x16x32_bf16 v[184:187], v[92:95], v[116:119], v[184:187]
ds_read_b64_tr_b16 v[82:83], v14 offset:17408
v_mfma_f32_16x16x32_bf16 v[184:187], v[88:91], v[112:115], v[184:187]
buffer_store_dwordx4 v[24:27], v1, s[44:47], s80 offen sc1
v_mfma_f32_16x16x32_bf16 v[180:183], v[88:91], v[104:107], v[180:183]
ds_read_b64_tr_b16 v[84:85], v14 offset:24576
v_accvgpr_read_b32 v20, a20
v_mfma_f32_16x16x32_bf16 v[180:183], v[92:95], v[108:111], v[180:183]
s_add_u32 m0, s63, 65536
ds_read_b64_tr_b16 v[86:87], v14 offset:25600
v_accvgpr_read_b32 v28, a21
v_mfma_f32_16x16x32_bf16 v[176:179], v[92:95], v[100:103], v[176:179]
s_add_u32 s72, s69, 0
buffer_load_dwordx4 v4, s[4:7], s72 offen lds
v_mfma_f32_16x16x32_bf16 v[176:179], v[88:91], v[96:99], v[176:179]
s_waitcnt lgkmcnt(10)
ds_read_b128 v[40:43], v18 offset:34816
v_accvgpr_read_b32 v21, a22
v_mfma_f32_16x16x32_bf16 v[192:195], v[64:67], v[96:99], v[192:195]
ds_read_b64_tr_b16 v[88:89], v15 offset:16384
v_accvgpr_read_b32 v29, a23
v_mfma_f32_16x16x32_bf16 v[192:195], v[68:71], v[100:103], v[192:195]
ds_read_b64_tr_b16 v[90:91], v15 offset:17408
v_accvgpr_read_b32 v22, a52
v_mfma_f32_16x16x32_bf16 v[196:199], v[68:71], v[108:111], v[196:199]
ds_read_b64_tr_b16 v[92:93], v15 offset:24576
v_accvgpr_read_b32 v30, a53
v_mfma_f32_16x16x32_bf16 v[196:199], v[64:67], v[104:107], v[196:199]
s_add_u32 s72, s69, 15360
buffer_load_dwordx4 v5, s[4:7], s72 offen offset:1024 lds
v_mfma_f32_16x16x32_bf16 v[200:203], v[64:67], v[112:115], v[200:203]
ds_read_b64_tr_b16 v[94:95], v15 offset:25600
v_accvgpr_read_b32 v23, a54
v_mfma_f32_16x16x32_bf16 v[200:203], v[68:71], v[116:119], v[200:203]
ds_read_b128 v[44:47], v19 offset:34816
v_accvgpr_read_b32 v31, a55
v_mfma_f32_16x16x32_bf16 v[204:207], v[68:71], v[124:127], v[204:207]
v_mul_f32 v20, s79, v20
v_mul_f32 v28, s79, v28
v_mfma_f32_16x16x32_bf16 v[204:207], v[64:67], v[120:123], v[204:207]
s_waitcnt lgkmcnt(11)
ds_read_b128 v[48:51], v18 offset:36864
v_mul_f32 v21, s79, v21
v_mfma_f32_16x16x32_bf16 v[220:223], v[72:75], v[120:123], v[220:223]
s_add_u32 s72, s69, 129024
buffer_load_dwordx4 v4, s[4:7], s72 offen offset:2048 lds
v_mfma_f32_16x16x32_bf16 v[220:223], v[76:79], v[124:127], v[220:223]
v_mul_f32 v29, s79, v29
v_mul_f32 v22, s79, v22
v_mfma_f32_16x16x32_bf16 v[216:219], v[76:79], v[116:119], v[216:219]
s_waitcnt vmcnt(19) lgkmcnt(2)
ds_read_b128 v[52:55], v19 offset:36864
v_mul_f32 v30, s79, v30
v_mfma_f32_16x16x32_bf16 v[216:219], v[72:75], v[112:115], v[216:219]
s_barrier
ds_read_b128 v[56:59], v18 offset:38912
v_mul_f32 v23, s79, v23
v_mfma_f32_16x16x32_bf16 v[212:215], v[72:75], v[104:107], v[212:215]
ds_read_b64_tr_b16 v[64:65], v8 offset:32768
ds_read_b64_tr_b16 v[66:67], v8 offset:33792
v_mfma_f32_16x16x32_bf16 v[212:215], v[76:79], v[108:111], v[212:215]
ds_read_b64_tr_b16 v[68:69], v8 offset:40960
v_mul_f32 v31, s79, v31
v_mfma_f32_16x16x32_bf16 v[208:211], v[76:79], v[100:103], v[208:211]
s_add_u32 s72, s69, 144384
buffer_load_dwordx4 v5, s[4:7], s72 offen offset:3072 lds
v_mfma_f32_16x16x32_bf16 v[208:211], v[72:75], v[96:99], v[208:211]
ds_read_b64_tr_b16 v[70:71], v8 offset:41984
v_cvt_pk_bf16_f32 v20, v20, v28
v_mfma_f32_16x16x32_bf16 v[224:227], v[80:83], v[96:99], v[224:227]
ds_read_b64_tr_b16 v[72:73], v9 offset:32768
v_cvt_pk_bf16_f32 v21, v21, v29
v_mfma_f32_16x16x32_bf16 v[224:227], v[84:87], v[100:103], v[224:227]
ds_read_b64_tr_b16 v[74:75], v9 offset:33792
v_cvt_pk_bf16_f32 v22, v22, v30
v_mfma_f32_16x16x32_bf16 v[228:231], v[84:87], v[108:111], v[228:231]
s_add_u32 m0, s63, 69632
v_cvt_pk_bf16_f32 v23, v23, v31
v_accvgpr_read_b32 v24, a152
v_mfma_f32_16x16x32_bf16 v[228:231], v[80:83], v[104:107], v[228:231]
s_add_u32 s72, s70, 0
buffer_load_dwordx4 v4, s[4:7], s72 offen lds
v_mfma_f32_16x16x32_bf16 v[232:235], v[80:83], v[112:115], v[232:235]
s_add_u32 s80, s77, 36864
ds_read_b64_tr_b16 v[76:77], v9 offset:40960
v_accvgpr_read_b32 v28, a153
v_mfma_f32_16x16x32_bf16 v[232:235], v[84:87], v[116:119], v[232:235]
ds_read_b128 v[60:63], v19 offset:38912
v_accvgpr_read_b32 v25, a154
v_mfma_f32_16x16x32_bf16 v[236:239], v[84:87], v[124:127], v[236:239]
ds_read_b64_tr_b16 v[78:79], v9 offset:41984
v_accvgpr_read_b32 v29, a155
v_mfma_f32_16x16x32_bf16 v[236:239], v[80:83], v[120:123], v[236:239]
buffer_store_dwordx4 v[20:23], v1, s[44:47], s80 offen sc1
v_mfma_f32_16x16x32_bf16 v[252:255], v[88:91], v[120:123], v[252:255]
s_add_u32 s72, s70, 15360
buffer_load_dwordx4 v5, s[4:7], s72 offen offset:1024 lds
v_mfma_f32_16x16x32_bf16 v[252:255], v[92:95], v[124:127], v[252:255]
ds_read_b64_tr_b16 v[80:81], v10 offset:32768
v_accvgpr_read_b32 v26, a156
v_mfma_f32_16x16x32_bf16 v[248:251], v[92:95], v[116:119], v[248:251]
ds_read_b64_tr_b16 v[82:83], v10 offset:33792
v_accvgpr_read_b32 v30, a157
v_mfma_f32_16x16x32_bf16 v[248:251], v[88:91], v[112:115], v[248:251]
v_accvgpr_read_b32 v27, a158
v_accvgpr_read_b32 v31, a159
v_mfma_f32_16x16x32_bf16 v[244:247], v[88:91], v[104:107], v[244:247]
ds_read_b64_tr_b16 v[84:85], v10 offset:40960
v_cvt_pk_bf16_f32 v24, v24, v28
v_mfma_f32_16x16x32_bf16 v[244:247], v[92:95], v[108:111], v[244:247]
ds_read_b64_tr_b16 v[86:87], v10 offset:41984
v_cvt_pk_bf16_f32 v25, v25, v29
v_mfma_f32_16x16x32_bf16 v[240:243], v[92:95], v[100:103], v[240:243]
s_add_u32 s72, s70, 129024
buffer_load_dwordx4 v4, s[4:7], s72 offen offset:2048 lds
v_mfma_f32_16x16x32_bf16 v[240:243], v[88:91], v[96:99], v[240:243]
s_waitcnt lgkmcnt(5)
v_cvt_pk_bf16_f32 v26, v26, v30
v_cvt_pk_bf16_f32 v27, v27, v31
v_mfma_f32_16x16x32_bf16 v[128:131], v[64:67], v[32:35], v[128:131]
s_add_u32 s80, s78, 40960
ds_read_b64_tr_b16 v[88:89], v11 offset:32768
v_mfma_f32_16x16x32_bf16 v[128:131], v[68:71], v[36:39], v[128:131]
ds_read_b64_tr_b16 v[90:91], v11 offset:33792
v_mfma_f32_16x16x32_bf16 v[132:135], v[68:71], v[44:47], v[132:135]
buffer_store_dwordx4 v[24:27], v1, s[44:47], s80 offen sc1
v_mfma_f32_16x16x32_bf16 v[132:135], v[64:67], v[40:43], v[132:135]
s_add_u32 s72, s70, 144384
buffer_load_dwordx4 v5, s[4:7], s72 offen offset:3072 lds
v_mfma_f32_16x16x32_bf16 v[136:139], v[64:67], v[48:51], v[136:139]
ds_read_b64_tr_b16 v[92:93], v11 offset:40960
v_mfma_f32_16x16x32_bf16 v[136:139], v[68:71], v[52:55], v[136:139]
s_lshl_b32 s71, s73, 12
v_mfma_f32_16x16x32_bf16 v[140:143], v[68:71], v[60:63], v[140:143]
s_add_u32 s71, s71, s66
ds_read_b64_tr_b16 v[94:95], v11 offset:41984
v_mfma_f32_16x16x32_bf16 v[140:143], v[64:67], v[56:59], v[140:143]
s_waitcnt lgkmcnt(8)
v_accvgpr_read_b32 v20, a24
v_accvgpr_read_b32 v28, a25
v_mfma_f32_16x16x32_bf16 v[156:159], v[72:75], v[56:59], v[156:159]
s_add_u32 m0, s64, 16384
ds_read_b64_tr_b16 v[64:65], v12 offset:32768
v_accvgpr_read_b32 v21, a26
v_mfma_f32_16x16x32_bf16 v[156:159], v[76:79], v[60:63], v[156:159]
s_add_u32 s72, s71, 0
buffer_load_dwordx4 v6, s[12:15], s72 offen lds
v_mfma_f32_16x16x32_bf16 v[152:155], v[76:79], v[52:55], v[152:155]
s_add_u32 s73, s62, 5
ds_read_b64_tr_b16 v[66:67], v12 offset:33792
v_accvgpr_read_b32 v29, a27
v_mfma_f32_16x16x32_bf16 v[152:155], v[72:75], v[48:51], v[152:155]
s_add_u32 s70, s73, s65
v_accvgpr_read_b32 v22, a56
v_accvgpr_read_b32 v30, a57
v_mfma_f32_16x16x32_bf16 v[148:151], v[72:75], v[40:43], v[148:151]
s_and_b32 s70, s70, 3
ds_read_b64_tr_b16 v[68:69], v12 offset:40960
v_accvgpr_read_b32 v23, a58
v_mfma_f32_16x16x32_bf16 v[148:151], v[76:79], v[44:47], v[148:151]
s_and_b32 s73, s73, 12
ds_read_b64_tr_b16 v[70:71], v12 offset:41984
v_accvgpr_read_b32 v31, a59
v_mfma_f32_16x16x32_bf16 v[144:147], v[76:79], v[36:39], v[144:147]
s_add_u32 s72, s71, 31744
buffer_load_dwordx4 v6, s[12:15], s72 offen offset:1024 lds
v_mfma_f32_16x16x32_bf16 v[144:147], v[72:75], v[32:35], v[144:147]
s_waitcnt lgkmcnt(8)
v_mul_f32 v20, s79, v20
v_mul_f32 v28, s79, v28
v_mfma_f32_16x16x32_bf16 v[160:163], v[80:83], v[32:35], v[160:163]
s_or_b32 s73, s73, s70
ds_read_b64_tr_b16 v[72:73], v13 offset:32768
v_mul_f32 v21, s79, v21
v_mfma_f32_16x16x32_bf16 v[160:163], v[84:87], v[36:39], v[160:163]
s_lshl_b32 s73, s73, 7
ds_read_b64_tr_b16 v[74:75], v13 offset:33792
v_mul_f32 v29, s79, v29
v_mfma_f32_16x16x32_bf16 v[164:167], v[84:87], v[44:47], v[164:167]
s_add_u32 s69, s73, s67
v_mul_f32 v22, s79, v22
v_mul_f32 v30, s79, v30
v_mfma_f32_16x16x32_bf16 v[164:167], v[80:83], v[40:43], v[164:167]
s_add_u32 s72, s71, 63488
buffer_load_dwordx4 v7, s[12:15], s72 offen offset:2048 lds
v_mfma_f32_16x16x32_bf16 v[168:171], v[80:83], v[48:51], v[168:171]
s_waitcnt vmcnt(18)
ds_read_b64_tr_b16 v[76:77], v13 offset:40960
v_mul_f32 v23, s79, v23
v_mfma_f32_16x16x32_bf16 v[168:171], v[84:87], v[52:55], v[168:171]
s_add_u32 s70, s73, s68
ds_read_b128 v[96:99], v16 offset:0
v_mul_f32 v31, s79, v31
v_mfma_f32_16x16x32_bf16 v[172:175], v[84:87], v[60:63], v[172:175]
ds_read_b64_tr_b16 v[78:79], v13 offset:41984
v_cvt_pk_bf16_f32 v20, v20, v28
v_mfma_f32_16x16x32_bf16 v[172:175], v[80:83], v[56:59], v[172:175]
s_waitcnt lgkmcnt(9)
ds_read_b128 v[100:103], v17 offset:0
v_cvt_pk_bf16_f32 v21, v21, v29
v_mfma_f32_16x16x32_bf16 v[188:191], v[88:91], v[56:59], v[188:191]
s_add_u32 s72, s71, 95232
buffer_load_dwordx4 v7, s[12:15], s72 offen offset:3072 lds
v_mfma_f32_16x16x32_bf16 v[188:191], v[92:95], v[60:63], v[188:191]
ds_read_b64_tr_b16 v[80:81], v14 offset:32768
v_cvt_pk_bf16_f32 v22, v22, v30
v_mfma_f32_16x16x32_bf16 v[184:187], v[92:95], v[52:55], v[184:187]
ds_read_b64_tr_b16 v[82:83], v14 offset:33792
v_cvt_pk_bf16_f32 v23, v23, v31
v_mfma_f32_16x16x32_bf16 v[184:187], v[88:91], v[48:51], v[184:187]
s_add_u32 s80, s77, 40960
buffer_store_dwordx4 v[20:23], v1, s[44:47], s80 offen sc1
v_mfma_f32_16x16x32_bf16 v[180:183], v[88:91], v[40:43], v[180:183]
ds_read_b64_tr_b16 v[84:85], v14 offset:40960
v_mfma_f32_16x16x32_bf16 v[180:183], v[92:95], v[44:47], v[180:183]
s_add_u32 m0, s63, 98304
ds_read_b64_tr_b16 v[86:87], v14 offset:41984
v_accvgpr_read_b32 v24, a160
v_mfma_f32_16x16x32_bf16 v[176:179], v[92:95], v[36:39], v[176:179]
s_add_u32 s72, s69, 0
buffer_load_dwordx4 v4, s[4:7], s72 offen lds
v_mfma_f32_16x16x32_bf16 v[176:179], v[88:91], v[32:35], v[176:179]
s_waitcnt lgkmcnt(10)
ds_read_b128 v[104:107], v16 offset:2048
v_accvgpr_read_b32 v28, a161
v_mfma_f32_16x16x32_bf16 v[192:195], v[64:67], v[32:35], v[192:195]
ds_read_b64_tr_b16 v[88:89], v15 offset:32768
v_accvgpr_read_b32 v25, a162
v_mfma_f32_16x16x32_bf16 v[192:195], v[68:71], v[36:39], v[192:195]
ds_read_b64_tr_b16 v[90:91], v15 offset:33792
v_accvgpr_read_b32 v29, a163
v_mfma_f32_16x16x32_bf16 v[196:199], v[68:71], v[44:47], v[196:199]
ds_read_b64_tr_b16 v[92:93], v15 offset:40960
v_accvgpr_read_b32 v26, a164
v_mfma_f32_16x16x32_bf16 v[196:199], v[64:67], v[40:43], v[196:199]
s_add_u32 s72, s69, 15360
buffer_load_dwordx4 v5, s[4:7], s72 offen offset:1024 lds
v_mfma_f32_16x16x32_bf16 v[200:203], v[64:67], v[48:51], v[200:203]
ds_read_b64_tr_b16 v[94:95], v15 offset:41984
v_accvgpr_read_b32 v30, a165
v_mfma_f32_16x16x32_bf16 v[200:203], v[68:71], v[52:55], v[200:203]
ds_read_b128 v[108:111], v17 offset:2048
v_accvgpr_read_b32 v27, a166
v_mfma_f32_16x16x32_bf16 v[204:207], v[68:71], v[60:63], v[204:207]
v_accvgpr_read_b32 v31, a167
v_cvt_pk_bf16_f32 v24, v24, v28
v_mfma_f32_16x16x32_bf16 v[204:207], v[64:67], v[56:59], v[204:207]
s_waitcnt lgkmcnt(11)
ds_read_b128 v[112:115], v16 offset:4096
v_cvt_pk_bf16_f32 v25, v25, v29
v_mfma_f32_16x16x32_bf16 v[220:223], v[72:75], v[56:59], v[220:223]
s_add_u32 s72, s69, 129024
buffer_load_dwordx4 v4, s[4:7], s72 offen offset:2048 lds
v_mfma_f32_16x16x32_bf16 v[220:223], v[76:79], v[60:63], v[220:223]
v_cvt_pk_bf16_f32 v26, v26, v30
v_cvt_pk_bf16_f32 v27, v27, v31
v_mfma_f32_16x16x32_bf16 v[216:219], v[76:79], v[52:55], v[216:219]
s_waitcnt vmcnt(19) lgkmcnt(2)
ds_read_b128 v[116:119], v17 offset:4096
v_mfma_f32_16x16x32_bf16 v[216:219], v[72:75], v[48:51], v[216:219]
s_barrier
ds_read_b128 v[120:123], v16 offset:6144
v_mfma_f32_16x16x32_bf16 v[212:215], v[72:75], v[40:43], v[212:215]
s_add_u32 s80, s78, 1024
ds_read_b64_tr_b16 v[64:65], v8 offset:0
ds_read_b64_tr_b16 v[66:67], v8 offset:1024
v_mfma_f32_16x16x32_bf16 v[212:215], v[76:79], v[44:47], v[212:215]
ds_read_b64_tr_b16 v[68:69], v8 offset:8192
v_mfma_f32_16x16x32_bf16 v[208:211], v[76:79], v[36:39], v[208:211]
s_add_u32 s72, s69, 144384
buffer_load_dwordx4 v5, s[4:7], s72 offen offset:3072 lds
v_mfma_f32_16x16x32_bf16 v[208:211], v[72:75], v[32:35], v[208:211]
ds_read_b64_tr_b16 v[70:71], v8 offset:9216
v_mfma_f32_16x16x32_bf16 v[224:227], v[80:83], v[32:35], v[224:227]
ds_read_b64_tr_b16 v[72:73], v9 offset:0
v_mfma_f32_16x16x32_bf16 v[224:227], v[84:87], v[36:39], v[224:227]
ds_read_b64_tr_b16 v[74:75], v9 offset:1024
v_mfma_f32_16x16x32_bf16 v[228:231], v[84:87], v[44:47], v[228:231]
s_add_u32 m0, s63, 102400
buffer_store_dwordx4 v[24:27], v1, s[44:47], s80 offen sc1
v_mfma_f32_16x16x32_bf16 v[228:231], v[80:83], v[40:43], v[228:231]
s_add_u32 s72, s70, 0
buffer_load_dwordx4 v4, s[4:7], s72 offen lds
v_mfma_f32_16x16x32_bf16 v[232:235], v[80:83], v[48:51], v[232:235]
ds_read_b64_tr_b16 v[76:77], v9 offset:8192
v_accvgpr_read_b32 v20, a28
v_mfma_f32_16x16x32_bf16 v[232:235], v[84:87], v[52:55], v[232:235]
ds_read_b128 v[124:127], v17 offset:6144
v_accvgpr_read_b32 v28, a29
v_mfma_f32_16x16x32_bf16 v[236:239], v[84:87], v[60:63], v[236:239]
ds_read_b64_tr_b16 v[78:79], v9 offset:9216
v_accvgpr_read_b32 v21, a30
v_mfma_f32_16x16x32_bf16 v[236:239], v[80:83], v[56:59], v[236:239]
v_accvgpr_read_b32 v29, a31
v_accvgpr_read_b32 v22, a60
v_mfma_f32_16x16x32_bf16 v[252:255], v[88:91], v[56:59], v[252:255]
s_add_u32 s72, s70, 15360
buffer_load_dwordx4 v5, s[4:7], s72 offen offset:1024 lds
v_mfma_f32_16x16x32_bf16 v[252:255], v[92:95], v[60:63], v[252:255]
ds_read_b64_tr_b16 v[80:81], v10 offset:0
v_accvgpr_read_b32 v30, a61
v_mfma_f32_16x16x32_bf16 v[248:251], v[92:95], v[52:55], v[248:251]
ds_read_b64_tr_b16 v[82:83], v10 offset:1024
v_accvgpr_read_b32 v23, a62
v_mfma_f32_16x16x32_bf16 v[248:251], v[88:91], v[48:51], v[248:251]
v_accvgpr_read_b32 v31, a63
v_mul_f32 v20, s79, v20
v_mfma_f32_16x16x32_bf16 v[244:247], v[88:91], v[40:43], v[244:247]
ds_read_b64_tr_b16 v[84:85], v10 offset:8192
v_mul_f32 v28, s79, v28
v_mfma_f32_16x16x32_bf16 v[244:247], v[92:95], v[44:47], v[244:247]
ds_read_b64_tr_b16 v[86:87], v10 offset:9216
v_mul_f32 v21, s79, v21
v_mfma_f32_16x16x32_bf16 v[240:243], v[92:95], v[36:39], v[240:243]
s_add_u32 s72, s70, 129024
buffer_load_dwordx4 v4, s[4:7], s72 offen offset:2048 lds
v_mfma_f32_16x16x32_bf16 v[240:243], v[88:91], v[32:35], v[240:243]
s_waitcnt lgkmcnt(5)
v_mul_f32 v29, s79, v29
v_mul_f32 v22, s79, v22
v_mfma_f32_16x16x32_bf16 v[128:131], v[64:67], v[96:99], v[128:131]
ds_read_b64_tr_b16 v[88:89], v11 offset:0
v_mul_f32 v30, s79, v30
v_mfma_f32_16x16x32_bf16 v[128:131], v[68:71], v[100:103], v[128:131]
ds_read_b64_tr_b16 v[90:91], v11 offset:1024
v_mul_f32 v23, s79, v23
v_mfma_f32_16x16x32_bf16 v[132:135], v[68:71], v[108:111], v[132:135]
v_mul_f32 v31, s79, v31
v_cvt_pk_bf16_f32 v20, v20, v28
v_mfma_f32_16x16x32_bf16 v[132:135], v[64:67], v[104:107], v[132:135]
s_add_u32 s72, s70, 144384
buffer_load_dwordx4 v5, s[4:7], s72 offen offset:3072 lds
v_mfma_f32_16x16x32_bf16 v[136:139], v[64:67], v[112:115], v[136:139]
ds_read_b64_tr_b16 v[92:93], v11 offset:8192
v_cvt_pk_bf16_f32 v21, v21, v29
v_mfma_f32_16x16x32_bf16 v[136:139], v[68:71], v[116:119], v[136:139]
s_lshl_b32 s71, s73, 12
v_cvt_pk_bf16_f32 v22, v22, v30
v_cvt_pk_bf16_f32 v23, v23, v31
v_mfma_f32_16x16x32_bf16 v[140:143], v[68:71], v[124:127], v[140:143]
s_add_u32 s71, s71, s66
ds_read_b64_tr_b16 v[94:95], v11 offset:9216
v_mfma_f32_16x16x32_bf16 v[140:143], v[64:67], v[120:123], v[140:143]
s_waitcnt lgkmcnt(8)
v_mfma_f32_16x16x32_bf16 v[156:159], v[72:75], v[120:123], v[156:159]
s_add_u32 m0, s64, 32768
ds_read_b64_tr_b16 v[64:65], v12 offset:0
v_mfma_f32_16x16x32_bf16 v[156:159], v[76:79], v[124:127], v[156:159]
s_add_u32 s72, s71, 0
buffer_load_dwordx4 v6, s[12:15], s72 offen lds
v_mfma_f32_16x16x32_bf16 v[152:155], v[76:79], v[116:119], v[152:155]
s_add_u32 s73, s62, 6
ds_read_b64_tr_b16 v[66:67], v12 offset:1024
v_accvgpr_read_b32 v24, a168
v_mfma_f32_16x16x32_bf16 v[152:155], v[72:75], v[112:115], v[152:155]
s_add_u32 s70, s73, s65
v_accvgpr_read_b32 v28, a169
v_accvgpr_read_b32 v25, a170
v_mfma_f32_16x16x32_bf16 v[148:151], v[72:75], v[104:107], v[148:151]
s_and_b32 s70, s70, 3
ds_read_b64_tr_b16 v[68:69], v12 offset:8192
v_accvgpr_read_b32 v29, a171
v_mfma_f32_16x16x32_bf16 v[148:151], v[76:79], v[108:111], v[148:151]
s_and_b32 s73, s73, 12
ds_read_b64_tr_b16 v[70:71], v12 offset:9216
v_accvgpr_read_b32 v26, a172
v_mfma_f32_16x16x32_bf16 v[144:147], v[76:79], v[100:103], v[144:147]
s_add_u32 s72, s71, 31744
buffer_load_dwordx4 v6, s[12:15], s72 offen offset:1024 lds
v_mfma_f32_16x16x32_bf16 v[144:147], v[72:75], v[96:99], v[144:147]
s_waitcnt lgkmcnt(8)
v_accvgpr_read_b32 v30, a173
v_accvgpr_read_b32 v27, a174
v_mfma_f32_16x16x32_bf16 v[160:163], v[80:83], v[96:99], v[160:163]
s_or_b32 s73, s73, s70
ds_read_b64_tr_b16 v[72:73], v13 offset:0
v_accvgpr_read_b32 v31, a175
v_mfma_f32_16x16x32_bf16 v[160:163], v[84:87], v[100:103], v[160:163]
s_lshl_b32 s73, s73, 7
ds_read_b64_tr_b16 v[74:75], v13 offset:1024
v_cvt_pk_bf16_f32 v24, v24, v28
v_mfma_f32_16x16x32_bf16 v[164:167], v[84:87], v[108:111], v[164:167]
s_add_u32 s69, s73, s67
v_cvt_pk_bf16_f32 v25, v25, v29
v_cvt_pk_bf16_f32 v26, v26, v30
v_mfma_f32_16x16x32_bf16 v[164:167], v[80:83], v[104:107], v[164:167]
s_add_u32 s72, s71, 63488
buffer_load_dwordx4 v7, s[12:15], s72 offen offset:2048 lds
v_mfma_f32_16x16x32_bf16 v[168:171], v[80:83], v[112:115], v[168:171]
s_waitcnt vmcnt(17)
ds_read_b64_tr_b16 v[76:77], v13 offset:8192
v_cvt_pk_bf16_f32 v27, v27, v31
v_mfma_f32_16x16x32_bf16 v[168:171], v[84:87], v[116:119], v[168:171]
s_add_u32 s70, s73, s68
ds_read_b128 v[32:35], v18 offset:0
v_mfma_f32_16x16x32_bf16 v[172:175], v[84:87], v[124:127], v[172:175]
s_add_u32 s80, s77, 45056
ds_read_b64_tr_b16 v[78:79], v13 offset:9216
v_mfma_f32_16x16x32_bf16 v[172:175], v[80:83], v[120:123], v[172:175]
s_waitcnt lgkmcnt(9)
ds_read_b128 v[36:39], v19 offset:0
v_mfma_f32_16x16x32_bf16 v[188:191], v[88:91], v[120:123], v[188:191]
s_add_u32 s72, s71, 95232
buffer_load_dwordx4 v7, s[12:15], s72 offen offset:3072 lds
v_mfma_f32_16x16x32_bf16 v[188:191], v[92:95], v[124:127], v[188:191]
ds_read_b64_tr_b16 v[80:81], v14 offset:0
v_mfma_f32_16x16x32_bf16 v[184:187], v[92:95], v[116:119], v[184:187]
ds_read_b64_tr_b16 v[82:83], v14 offset:1024
v_mfma_f32_16x16x32_bf16 v[184:187], v[88:91], v[112:115], v[184:187]
buffer_store_dwordx4 v[20:23], v1, s[44:47], s80 offen sc1
v_mfma_f32_16x16x32_bf16 v[180:183], v[88:91], v[104:107], v[180:183]
s_add_u32 s80, s78, 9216
ds_read_b64_tr_b16 v[84:85], v14 offset:8192
v_mfma_f32_16x16x32_bf16 v[180:183], v[92:95], v[108:111], v[180:183]
s_add_u32 m0, s63, 131072
ds_read_b64_tr_b16 v[86:87], v14 offset:9216
v_mfma_f32_16x16x32_bf16 v[176:179], v[92:95], v[100:103], v[176:179]
s_add_u32 s72, s69, 0
buffer_load_dwordx4 v4, s[4:7], s72 offen lds
v_mfma_f32_16x16x32_bf16 v[176:179], v[88:91], v[96:99], v[176:179]
s_waitcnt lgkmcnt(10)
ds_read_b128 v[40:43], v18 offset:2048
v_accvgpr_read_b32 v20, a64
v_mfma_f32_16x16x32_bf16 v[192:195], v[64:67], v[96:99], v[192:195]
ds_read_b64_tr_b16 v[88:89], v15 offset:0
v_accvgpr_read_b32 v28, a65
v_mfma_f32_16x16x32_bf16 v[192:195], v[68:71], v[100:103], v[192:195]
ds_read_b64_tr_b16 v[90:91], v15 offset:1024
v_accvgpr_read_b32 v21, a66
v_mfma_f32_16x16x32_bf16 v[196:199], v[68:71], v[108:111], v[196:199]
ds_read_b64_tr_b16 v[92:93], v15 offset:8192
v_accvgpr_read_b32 v29, a67
v_mfma_f32_16x16x32_bf16 v[196:199], v[64:67], v[104:107], v[196:199]
s_add_u32 s72, s69, 15360
buffer_load_dwordx4 v5, s[4:7], s72 offen offset:1024 lds
v_mfma_f32_16x16x32_bf16 v[200:203], v[64:67], v[112:115], v[200:203]
ds_read_b64_tr_b16 v[94:95], v15 offset:9216
v_accvgpr_read_b32 v22, a96
v_mfma_f32_16x16x32_bf16 v[200:203], v[68:71], v[116:119], v[200:203]
ds_read_b128 v[44:47], v19 offset:2048
v_accvgpr_read_b32 v30, a97
v_mfma_f32_16x16x32_bf16 v[204:207], v[68:71], v[124:127], v[204:207]
buffer_store_dwordx4 v[24:27], v1, s[44:47], s80 offen sc1
v_mfma_f32_16x16x32_bf16 v[204:207], v[64:67], v[120:123], v[204:207]
s_waitcnt lgkmcnt(11)
ds_read_b128 v[48:51], v18 offset:4096
v_accvgpr_read_b32 v23, a98
v_mfma_f32_16x16x32_bf16 v[220:223], v[72:75], v[120:123], v[220:223]
s_add_u32 s72, s69, 129024
buffer_load_dwordx4 v4, s[4:7], s72 offen offset:2048 lds
v_mfma_f32_16x16x32_bf16 v[220:223], v[76:79], v[124:127], v[220:223]
v_accvgpr_read_b32 v31, a99
v_mul_f32 v20, s79, v20
v_mfma_f32_16x16x32_bf16 v[216:219], v[76:79], v[116:119], v[216:219]
s_waitcnt vmcnt(19) lgkmcnt(2)
ds_read_b128 v[52:55], v19 offset:4096
v_mul_f32 v28, s79, v28
v_mfma_f32_16x16x32_bf16 v[216:219], v[72:75], v[112:115], v[216:219]
s_barrier
ds_read_b128 v[56:59], v18 offset:6144
v_mul_f32 v21, s79, v21
v_mfma_f32_16x16x32_bf16 v[212:215], v[72:75], v[104:107], v[212:215]
ds_read_b64_tr_b16 v[64:65], v8 offset:16384
ds_read_b64_tr_b16 v[66:67], v8 offset:17408
v_mfma_f32_16x16x32_bf16 v[212:215], v[76:79], v[108:111], v[212:215]
ds_read_b64_tr_b16 v[68:69], v8 offset:24576
v_mul_f32 v29, s79, v29
v_mfma_f32_16x16x32_bf16 v[208:211], v[76:79], v[100:103], v[208:211]
s_add_u32 s72, s69, 144384
buffer_load_dwordx4 v5, s[4:7], s72 offen offset:3072 lds
v_mfma_f32_16x16x32_bf16 v[208:211], v[72:75], v[96:99], v[208:211]
ds_read_b64_tr_b16 v[70:71], v8 offset:25600
v_mul_f32 v22, s79, v22
v_mfma_f32_16x16x32_bf16 v[224:227], v[80:83], v[96:99], v[224:227]
ds_read_b64_tr_b16 v[72:73], v9 offset:16384
v_mul_f32 v30, s79, v30
v_mfma_f32_16x16x32_bf16 v[224:227], v[84:87], v[100:103], v[224:227]
ds_read_b64_tr_b16 v[74:75], v9 offset:17408
v_mul_f32 v23, s79, v23
v_mfma_f32_16x16x32_bf16 v[228:231], v[84:87], v[108:111], v[228:231]
s_add_u32 m0, s63, 135168
v_mul_f32 v31, s79, v31
v_cvt_pk_bf16_f32 v20, v20, v28
v_mfma_f32_16x16x32_bf16 v[228:231], v[80:83], v[104:107], v[228:231]
s_add_u32 s72, s70, 0
buffer_load_dwordx4 v4, s[4:7], s72 offen lds
v_mfma_f32_16x16x32_bf16 v[232:235], v[80:83], v[112:115], v[232:235]
ds_read_b64_tr_b16 v[76:77], v9 offset:24576
v_cvt_pk_bf16_f32 v21, v21, v29
v_mfma_f32_16x16x32_bf16 v[232:235], v[84:87], v[116:119], v[232:235]
ds_read_b128 v[60:63], v19 offset:6144
v_cvt_pk_bf16_f32 v22, v22, v30
v_mfma_f32_16x16x32_bf16 v[236:239], v[84:87], v[124:127], v[236:239]
ds_read_b64_tr_b16 v[78:79], v9 offset:25600
v_cvt_pk_bf16_f32 v23, v23, v31
v_mfma_f32_16x16x32_bf16 v[236:239], v[80:83], v[120:123], v[236:239]
s_add_u32 s80, s77, 1024
buffer_store_dwordx4 v[20:23], v1, s[44:47], s80 offen sc1
v_mfma_f32_16x16x32_bf16 v[252:255], v[88:91], v[120:123], v[252:255]
s_add_u32 s72, s70, 15360
buffer_load_dwordx4 v5, s[4:7], s72 offen offset:1024 lds
v_mfma_f32_16x16x32_bf16 v[252:255], v[92:95], v[124:127], v[252:255]
ds_read_b64_tr_b16 v[80:81], v10 offset:16384
v_accvgpr_read_b32 v24, a176
v_mfma_f32_16x16x32_bf16 v[248:251], v[92:95], v[116:119], v[248:251]
ds_read_b64_tr_b16 v[82:83], v10 offset:17408
v_accvgpr_read_b32 v28, a177
v_mfma_f32_16x16x32_bf16 v[248:251], v[88:91], v[112:115], v[248:251]
v_accvgpr_read_b32 v25, a178
v_accvgpr_read_b32 v29, a179
v_mfma_f32_16x16x32_bf16 v[244:247], v[88:91], v[104:107], v[244:247]
ds_read_b64_tr_b16 v[84:85], v10 offset:24576
v_accvgpr_read_b32 v26, a180
v_mfma_f32_16x16x32_bf16 v[244:247], v[92:95], v[108:111], v[244:247]
ds_read_b64_tr_b16 v[86:87], v10 offset:25600
v_accvgpr_read_b32 v30, a181
v_mfma_f32_16x16x32_bf16 v[240:243], v[92:95], v[100:103], v[240:243]
s_add_u32 s72, s70, 129024
buffer_load_dwordx4 v4, s[4:7], s72 offen offset:2048 lds
v_mfma_f32_16x16x32_bf16 v[240:243], v[88:91], v[96:99], v[240:243]
s_waitcnt lgkmcnt(5)
v_accvgpr_read_b32 v27, a182
v_accvgpr_read_b32 v31, a183
v_mfma_f32_16x16x32_bf16 v[128:131], v[64:67], v[32:35], v[128:131]
ds_read_b64_tr_b16 v[88:89], v11 offset:16384
v_cvt_pk_bf16_f32 v24, v24, v28
v_mfma_f32_16x16x32_bf16 v[128:131], v[68:71], v[36:39], v[128:131]
ds_read_b64_tr_b16 v[90:91], v11 offset:17408
v_cvt_pk_bf16_f32 v25, v25, v29
v_mfma_f32_16x16x32_bf16 v[132:135], v[68:71], v[44:47], v[132:135]
v_cvt_pk_bf16_f32 v26, v26, v30
v_cvt_pk_bf16_f32 v27, v27, v31
v_mfma_f32_16x16x32_bf16 v[132:135], v[64:67], v[40:43], v[132:135]
s_add_u32 s72, s70, 144384
buffer_load_dwordx4 v5, s[4:7], s72 offen offset:3072 lds
v_mfma_f32_16x16x32_bf16 v[136:139], v[64:67], v[48:51], v[136:139]
s_add_u32 s80, s78, 33792
ds_read_b64_tr_b16 v[92:93], v11 offset:24576
v_mfma_f32_16x16x32_bf16 v[136:139], v[68:71], v[52:55], v[136:139]
s_lshl_b32 s71, s73, 12
buffer_store_dwordx4 v[24:27], v1, s[44:47], s80 offen sc1
v_mfma_f32_16x16x32_bf16 v[140:143], v[68:71], v[60:63], v[140:143]
s_add_u32 s71, s71, s66
ds_read_b64_tr_b16 v[94:95], v11 offset:25600
v_mfma_f32_16x16x32_bf16 v[140:143], v[64:67], v[56:59], v[140:143]
s_waitcnt lgkmcnt(8)
v_mfma_f32_16x16x32_bf16 v[156:159], v[72:75], v[56:59], v[156:159]
s_add_u32 m0, s64, 0
ds_read_b64_tr_b16 v[64:65], v12 offset:16384
v_mfma_f32_16x16x32_bf16 v[156:159], v[76:79], v[60:63], v[156:159]
s_add_u32 s72, s71, 0
buffer_load_dwordx4 v6, s[12:15], s72 offen lds
v_mfma_f32_16x16x32_bf16 v[152:155], v[76:79], v[52:55], v[152:155]
s_add_u32 s73, s62, 7
ds_read_b64_tr_b16 v[66:67], v12 offset:17408
v_mfma_f32_16x16x32_bf16 v[152:155], v[72:75], v[48:51], v[152:155]
s_add_u32 s70, s73, s65
v_mfma_f32_16x16x32_bf16 v[148:151], v[72:75], v[40:43], v[148:151]
s_and_b32 s70, s70, 3
ds_read_b64_tr_b16 v[68:69], v12 offset:24576
v_accvgpr_read_b32 v20, a68
v_mfma_f32_16x16x32_bf16 v[148:151], v[76:79], v[44:47], v[148:151]
s_and_b32 s73, s73, 12
ds_read_b64_tr_b16 v[70:71], v12 offset:25600
v_accvgpr_read_b32 v28, a69
v_mfma_f32_16x16x32_bf16 v[144:147], v[76:79], v[36:39], v[144:147]
s_add_u32 s72, s71, 31744
buffer_load_dwordx4 v6, s[12:15], s72 offen offset:1024 lds
v_mfma_f32_16x16x32_bf16 v[144:147], v[72:75], v[32:35], v[144:147]
s_waitcnt lgkmcnt(8)
v_accvgpr_read_b32 v21, a70
v_accvgpr_read_b32 v29, a71
v_mfma_f32_16x16x32_bf16 v[160:163], v[80:83], v[32:35], v[160:163]
s_or_b32 s73, s73, s70
ds_read_b64_tr_b16 v[72:73], v13 offset:16384
v_accvgpr_read_b32 v22, a100
v_mfma_f32_16x16x32_bf16 v[160:163], v[84:87], v[36:39], v[160:163]
s_lshl_b32 s73, s73, 7
ds_read_b64_tr_b16 v[74:75], v13 offset:17408
v_accvgpr_read_b32 v30, a101
v_mfma_f32_16x16x32_bf16 v[164:167], v[84:87], v[44:47], v[164:167]
s_add_u32 s69, s73, s67
v_accvgpr_read_b32 v23, a102
v_accvgpr_read_b32 v31, a103
v_mfma_f32_16x16x32_bf16 v[164:167], v[80:83], v[40:43], v[164:167]
s_add_u32 s72, s71, 63488
buffer_load_dwordx4 v7, s[12:15], s72 offen offset:2048 lds
v_mfma_f32_16x16x32_bf16 v[168:171], v[80:83], v[48:51], v[168:171]
s_waitcnt vmcnt(19)
ds_read_b64_tr_b16 v[76:77], v13 offset:24576
v_mul_f32 v20, s79, v20
v_mfma_f32_16x16x32_bf16 v[168:171], v[84:87], v[52:55], v[168:171]
s_add_u32 s70, s73, s68
ds_read_b128 v[96:99], v18 offset:32768
v_mul_f32 v28, s79, v28
v_mfma_f32_16x16x32_bf16 v[172:175], v[84:87], v[60:63], v[172:175]
ds_read_b64_tr_b16 v[78:79], v13 offset:25600
v_mul_f32 v21, s79, v21
v_mfma_f32_16x16x32_bf16 v[172:175], v[80:83], v[56:59], v[172:175]
s_waitcnt lgkmcnt(9)
ds_read_b128 v[100:103], v19 offset:32768
v_mul_f32 v29, s79, v29
v_mfma_f32_16x16x32_bf16 v[188:191], v[88:91], v[56:59], v[188:191]
s_add_u32 s72, s71, 95232
buffer_load_dwordx4 v7, s[12:15], s72 offen offset:3072 lds
v_mfma_f32_16x16x32_bf16 v[188:191], v[92:95], v[60:63], v[188:191]
ds_read_b64_tr_b16 v[80:81], v14 offset:16384
v_mul_f32 v22, s79, v22
v_mfma_f32_16x16x32_bf16 v[184:187], v[92:95], v[52:55], v[184:187]
ds_read_b64_tr_b16 v[82:83], v14 offset:17408
v_mul_f32 v30, s79, v30
v_mfma_f32_16x16x32_bf16 v[184:187], v[88:91], v[48:51], v[184:187]
v_mul_f32 v23, s79, v23
v_mul_f32 v31, s79, v31
v_mfma_f32_16x16x32_bf16 v[180:183], v[88:91], v[40:43], v[180:183]
ds_read_b64_tr_b16 v[84:85], v14 offset:24576
v_cvt_pk_bf16_f32 v20, v20, v28
v_mfma_f32_16x16x32_bf16 v[180:183], v[92:95], v[44:47], v[180:183]
s_add_u32 m0, s63, 65536
ds_read_b64_tr_b16 v[86:87], v14 offset:25600
v_cvt_pk_bf16_f32 v21, v21, v29
v_mfma_f32_16x16x32_bf16 v[176:179], v[92:95], v[36:39], v[176:179]
s_add_u32 s72, s69, 0
buffer_load_dwordx4 v4, s[4:7], s72 offen lds
v_mfma_f32_16x16x32_bf16 v[176:179], v[88:91], v[32:35], v[176:179]
s_waitcnt lgkmcnt(10)
ds_read_b128 v[104:107], v18 offset:34816
v_cvt_pk_bf16_f32 v22, v22, v30
v_mfma_f32_16x16x32_bf16 v[192:195], v[64:67], v[32:35], v[192:195]
ds_read_b64_tr_b16 v[88:89], v15 offset:16384
v_cvt_pk_bf16_f32 v23, v23, v31
v_mfma_f32_16x16x32_bf16 v[192:195], v[68:71], v[36:39], v[192:195]
s_add_u32 s80, s77, 5120
ds_read_b64_tr_b16 v[90:91], v15 offset:17408
v_mfma_f32_16x16x32_bf16 v[196:199], v[68:71], v[44:47], v[196:199]
ds_read_b64_tr_b16 v[92:93], v15 offset:24576
v_accvgpr_read_b32 v24, a184
v_mfma_f32_16x16x32_bf16 v[196:199], v[64:67], v[40:43], v[196:199]
s_add_u32 s72, s69, 15360
buffer_load_dwordx4 v5, s[4:7], s72 offen offset:1024 lds
v_mfma_f32_16x16x32_bf16 v[200:203], v[64:67], v[48:51], v[200:203]
ds_read_b64_tr_b16 v[94:95], v15 offset:25600
v_accvgpr_read_b32 v28, a185
v_mfma_f32_16x16x32_bf16 v[200:203], v[68:71], v[52:55], v[200:203]
ds_read_b128 v[108:111], v19 offset:34816
v_accvgpr_read_b32 v25, a186
v_mfma_f32_16x16x32_bf16 v[204:207], v[68:71], v[60:63], v[204:207]
buffer_store_dwordx4 v[20:23], v1, s[44:47], s80 offen sc1
v_mfma_f32_16x16x32_bf16 v[204:207], v[64:67], v[56:59], v[204:207]
s_waitcnt lgkmcnt(11)
ds_read_b128 v[112:115], v18 offset:36864
v_accvgpr_read_b32 v29, a187
v_mfma_f32_16x16x32_bf16 v[220:223], v[72:75], v[56:59], v[220:223]
s_add_u32 s72, s69, 129024
buffer_load_dwordx4 v4, s[4:7], s72 offen offset:2048 lds
v_mfma_f32_16x16x32_bf16 v[220:223], v[76:79], v[60:63], v[220:223]
v_accvgpr_read_b32 v26, a188
v_accvgpr_read_b32 v30, a189
v_mfma_f32_16x16x32_bf16 v[216:219], v[76:79], v[52:55], v[216:219]
s_waitcnt vmcnt(20) lgkmcnt(2)
ds_read_b128 v[116:119], v19 offset:36864
v_accvgpr_read_b32 v27, a190
v_mfma_f32_16x16x32_bf16 v[216:219], v[72:75], v[48:51], v[216:219]
s_barrier
ds_read_b128 v[120:123], v18 offset:38912
v_accvgpr_read_b32 v31, a191
v_mfma_f32_16x16x32_bf16 v[212:215], v[72:75], v[40:43], v[212:215]
ds_read_b64_tr_b16 v[64:65], v8 offset:32768
ds_read_b64_tr_b16 v[66:67], v8 offset:33792
v_mfma_f32_16x16x32_bf16 v[212:215], v[76:79], v[44:47], v[212:215]
ds_read_b64_tr_b16 v[68:69], v8 offset:40960
v_cvt_pk_bf16_f32 v24, v24, v28
v_mfma_f32_16x16x32_bf16 v[208:211], v[76:79], v[36:39], v[208:211]
s_add_u32 s72, s69, 144384
buffer_load_dwordx4 v5, s[4:7], s72 offen offset:3072 lds
v_mfma_f32_16x16x32_bf16 v[208:211], v[72:75], v[32:35], v[208:211]
ds_read_b64_tr_b16 v[70:71], v8 offset:41984
v_cvt_pk_bf16_f32 v25, v25, v29
v_mfma_f32_16x16x32_bf16 v[224:227], v[80:83], v[32:35], v[224:227]
ds_read_b64_tr_b16 v[72:73], v9 offset:32768
v_cvt_pk_bf16_f32 v26, v26, v30
v_mfma_f32_16x16x32_bf16 v[224:227], v[84:87], v[36:39], v[224:227]
ds_read_b64_tr_b16 v[74:75], v9 offset:33792
v_cvt_pk_bf16_f32 v27, v27, v31
v_mfma_f32_16x16x32_bf16 v[228:231], v[84:87], v[44:47], v[228:231]
s_add_u32 m0, s63, 69632
v_mfma_f32_16x16x32_bf16 v[228:231], v[80:83], v[40:43], v[228:231]
s_add_u32 s72, s70, 0
buffer_load_dwordx4 v4, s[4:7], s72 offen lds
v_mfma_f32_16x16x32_bf16 v[232:235], v[80:83], v[48:51], v[232:235]
s_add_u32 s80, s78, 41984
ds_read_b64_tr_b16 v[76:77], v9 offset:40960
v_mfma_f32_16x16x32_bf16 v[232:235], v[84:87], v[52:55], v[232:235]
ds_read_b128 v[124:127], v19 offset:38912
v_mfma_f32_16x16x32_bf16 v[236:239], v[84:87], v[60:63], v[236:239]
ds_read_b64_tr_b16 v[78:79], v9 offset:41984
v_mfma_f32_16x16x32_bf16 v[236:239], v[80:83], v[56:59], v[236:239]
buffer_store_dwordx4 v[24:27], v1, s[44:47], s80 offen sc1
v_mfma_f32_16x16x32_bf16 v[252:255], v[88:91], v[56:59], v[252:255]
s_add_u32 s72, s70, 15360
buffer_load_dwordx4 v5, s[4:7], s72 offen offset:1024 lds
v_mfma_f32_16x16x32_bf16 v[252:255], v[92:95], v[60:63], v[252:255]
ds_read_b64_tr_b16 v[80:81], v10 offset:32768
v_accvgpr_read_b32 v20, a72
v_mfma_f32_16x16x32_bf16 v[248:251], v[92:95], v[52:55], v[248:251]
ds_read_b64_tr_b16 v[82:83], v10 offset:33792
v_accvgpr_read_b32 v28, a73
v_mfma_f32_16x16x32_bf16 v[248:251], v[88:91], v[48:51], v[248:251]
v_accvgpr_read_b32 v21, a74
v_accvgpr_read_b32 v29, a75
v_mfma_f32_16x16x32_bf16 v[244:247], v[88:91], v[40:43], v[244:247]
ds_read_b64_tr_b16 v[84:85], v10 offset:40960
v_accvgpr_read_b32 v22, a104
v_mfma_f32_16x16x32_bf16 v[244:247], v[92:95], v[44:47], v[244:247]
ds_read_b64_tr_b16 v[86:87], v10 offset:41984
v_accvgpr_read_b32 v30, a105
v_mfma_f32_16x16x32_bf16 v[240:243], v[92:95], v[36:39], v[240:243]
s_add_u32 s72, s70, 129024
buffer_load_dwordx4 v4, s[4:7], s72 offen offset:2048 lds
v_mfma_f32_16x16x32_bf16 v[240:243], v[88:91], v[32:35], v[240:243]
s_waitcnt lgkmcnt(5)
v_accvgpr_read_b32 v23, a106
v_accvgpr_read_b32 v31, a107
v_mfma_f32_16x16x32_bf16 v[128:131], v[64:67], v[96:99], v[128:131]
s_lshr_b32 s75, s93, 4
ds_read_b64_tr_b16 v[88:89], v11 offset:32768
v_mul_f32 v20, s79, v20
v_mfma_f32_16x16x32_bf16 v[128:131], v[68:71], v[100:103], v[128:131]
s_and_b32 s75, s75, 0x7f00
ds_read_b64_tr_b16 v[90:91], v11 offset:33792
v_mul_f32 v28, s79, v28
v_mfma_f32_16x16x32_bf16 v[132:135], v[68:71], v[108:111], v[132:135]
s_add_u32 s75, s75, LcB1-Lpc0
v_lshrrev_b32 v2, 5, v0
v_lshlrev_b32 v2, 7, v2
v_mfma_f32_16x16x32_bf16 v[132:135], v[64:67], v[104:107], v[132:135]
s_add_u32 s72, s70, 144384
buffer_load_dwordx4 v5, s[4:7], s72 offen offset:3072 lds
v_mfma_f32_16x16x32_bf16 v[136:139], v[64:67], v[112:115], v[136:139]
v_add_u32 v2, s75, v2
v_min_u32 v2, Lcode_end-Lpc0, v2
v_mfma_f32_16x16x32_bf16 v[136:139], v[68:71], v[116:119], v[136:139]
s_lshl_b32 s71, s73, 12
global_load_dword v3, v2, s[98:99]
v_mfma_f32_16x16x32_bf16 v[140:143], v[68:71], v[124:127], v[140:143]
s_add_u32 s71, s71, s66
ds_read_b64_tr_b16 v[92:93], v11 offset:40960
v_mul_f32 v21, s79, v21
v_mfma_f32_16x16x32_bf16 v[140:143], v[64:67], v[120:123], v[140:143]
s_waitcnt lgkmcnt(7)
ds_read_b64_tr_b16 v[94:95], v11 offset:41984
v_mul_f32 v29, s79, v29
v_mfma_f32_16x16x32_bf16 v[156:159], v[72:75], v[120:123], v[156:159]
s_add_u32 m0, s64, 16384
ds_read_b64_tr_b16 v[64:65], v12 offset:32768
v_mul_f32 v22, s79, v22
v_mfma_f32_16x16x32_bf16 v[156:159], v[76:79], v[124:127], v[156:159]
s_add_u32 s72, s71, 0
buffer_load_dwordx4 v6, s[12:15], s72 offen lds
v_mfma_f32_16x16x32_bf16 v[152:155], v[76:79], v[116:119], v[152:155]
s_add_u32 s73, s62, 8
ds_read_b64_tr_b16 v[66:67], v12 offset:33792
v_mul_f32 v30, s79, v30
v_mfma_f32_16x16x32_bf16 v[152:155], v[72:75], v[112:115], v[152:155]
s_add_u32 s70, s73, s65
v_mul_f32 v23, s79, v23
v_mul_f32 v31, s79, v31
v_mfma_f32_16x16x32_bf16 v[148:151], v[72:75], v[104:107], v[148:151]
s_and_b32 s70, s70, 3
ds_read_b64_tr_b16 v[68:69], v12 offset:40960
v_cvt_pk_bf16_f32 v20, v20, v28
v_mfma_f32_16x16x32_bf16 v[148:151], v[76:79], v[108:111], v[148:151]
s_and_b32 s73, s73, 12
ds_read_b64_tr_b16 v[70:71], v12 offset:41984
v_cvt_pk_bf16_f32 v21, v21, v29
v_mfma_f32_16x16x32_bf16 v[144:147], v[76:79], v[100:103], v[144:147]
s_add_u32 s72, s71, 31744
buffer_load_dwordx4 v6, s[12:15], s72 offen offset:1024 lds
v_mfma_f32_16x16x32_bf16 v[144:147], v[72:75], v[96:99], v[144:147]
s_waitcnt lgkmcnt(8)
v_cvt_pk_bf16_f32 v22, v22, v30
v_cvt_pk_bf16_f32 v23, v23, v31
v_mfma_f32_16x16x32_bf16 v[160:163], v[80:83], v[96:99], v[160:163]
s_or_b32 s73, s73, s70
ds_read_b64_tr_b16 v[72:73], v13 offset:32768
v_accvgpr_read_b32 v24, a192
v_mfma_f32_16x16x32_bf16 v[160:163], v[84:87], v[100:103], v[160:163]
s_lshl_b32 s73, s73, 7
ds_read_b64_tr_b16 v[74:75], v13 offset:33792
v_accvgpr_read_b32 v28, a193
v_mfma_f32_16x16x32_bf16 v[164:167], v[84:87], v[108:111], v[164:167]
s_add_u32 s69, s73, s67
v_accvgpr_read_b32 v25, a194
v_accvgpr_read_b32 v29, a195
v_mfma_f32_16x16x32_bf16 v[164:167], v[80:83], v[104:107], v[164:167]
s_add_u32 s72, s71, 63488
buffer_load_dwordx4 v7, s[12:15], s72 offen offset:2048 lds
v_mfma_f32_16x16x32_bf16 v[168:171], v[80:83], v[112:115], v[168:171]
s_waitcnt vmcnt(19)
ds_read_b64_tr_b16 v[76:77], v13 offset:40960
v_accvgpr_read_b32 v26, a196
v_mfma_f32_16x16x32_bf16 v[168:171], v[84:87], v[116:119], v[168:171]
s_add_u32 s70, s73, s68
ds_read_b128 v[32:35], v16 offset:0
v_accvgpr_read_b32 v30, a197
v_mfma_f32_16x16x32_bf16 v[172:175], v[84:87], v[124:127], v[172:175]
s_add_u32 s80, s77, 9216
ds_read_b64_tr_b16 v[78:79], v13 offset:41984
v_accvgpr_read_b32 v27, a198
v_mfma_f32_16x16x32_bf16 v[172:175], v[80:83], v[120:123], v[172:175]
s_waitcnt lgkmcnt(9)
ds_read_b128 v[36:39], v17 offset:0
v_accvgpr_read_b32 v31, a199
v_mfma_f32_16x16x32_bf16 v[188:191], v[88:91], v[120:123], v[188:191]
s_add_u32 s72, s71, 95232
buffer_load_dwordx4 v7, s[12:15], s72 offen offset:3072 lds
v_mfma_f32_16x16x32_bf16 v[188:191], v[92:95], v[124:127], v[188:191]
ds_read_b64_tr_b16 v[80:81], v14 offset:32768
v_cvt_pk_bf16_f32 v24, v24, v28
v_mfma_f32_16x16x32_bf16 v[184:187], v[92:95], v[116:119], v[184:187]
ds_read_b64_tr_b16 v[82:83], v14 offset:33792
v_cvt_pk_bf16_f32 v25, v25, v29
v_mfma_f32_16x16x32_bf16 v[184:187], v[88:91], v[112:115], v[184:187]
buffer_store_dwordx4 v[20:23], v1, s[44:47], s80 offen sc1
v_mfma_f32_16x16x32_bf16 v[180:183], v[88:91], v[104:107], v[180:183]
ds_read_b64_tr_b16 v[84:85], v14 offset:40960
v_cvt_pk_bf16_f32 v26, v26, v30
v_mfma_f32_16x16x32_bf16 v[180:183], v[92:95], v[108:111], v[180:183]
s_add_u32 m0, s63, 98304
ds_read_b64_tr_b16 v[86:87], v14 offset:41984
v_cvt_pk_bf16_f32 v27, v27, v31
v_mfma_f32_16x16x32_bf16 v[176:179], v[92:95], v[100:103], v[176:179]
s_add_u32 s72, s69, 0
buffer_load_dwordx4 v4, s[4:7], s72 offen lds
v_mfma_f32_16x16x32_bf16 v[176:179], v[88:91], v[96:99], v[176:179]
s_waitcnt lgkmcnt(10)
ds_read_b128 v[40:43], v16 offset:2048
v_mfma_f32_16x16x32_bf16 v[192:195], v[64:67], v[96:99], v[192:195]
s_add_u32 s80, s78, 2048
ds_read_b64_tr_b16 v[88:89], v15 offset:32768
v_mfma_f32_16x16x32_bf16 v[192:195], v[68:71], v[100:103], v[192:195]
ds_read_b64_tr_b16 v[90:91], v15 offset:33792
v_mfma_f32_16x16x32_bf16 v[196:199], v[68:71], v[108:111], v[196:199]
ds_read_b64_tr_b16 v[92:93], v15 offset:40960
v_mfma_f32_16x16x32_bf16 v[196:199], v[64:67], v[104:107], v[196:199]
s_add_u32 s72, s69, 15360
buffer_load_dwordx4 v5, s[4:7], s72 offen offset:1024 lds
v_mfma_f32_16x16x32_bf16 v[200:203], v[64:67], v[112:115], v[200:203]
ds_read_b64_tr_b16 v[94:95], v15 offset:41984
v_accvgpr_read_b32 v20, a76
v_mfma_f32_16x16x32_bf16 v[200:203], v[68:71], v[116:119], v[200:203]
ds_read_b128 v[44:47], v17 offset:2048
v_accvgpr_read_b32 v28, a77
v_mfma_f32_16x16x32_bf16 v[204:207], v[68:71], v[124:127], v[204:207]
buffer_store_dwordx4 v[24:27], v1, s[44:47], s80 offen sc1
v_mfma_f32_16x16x32_bf16 v[204:207], v[64:67], v[120:123], v[204:207]
s_waitcnt lgkmcnt(11)
ds_read_b128 v[48:51], v16 offset:4096
v_accvgpr_read_b32 v21, a78
v_mfma_f32_16x16x32_bf16 v[220:223], v[72:75], v[120:123], v[220:223]
s_add_u32 s72, s69, 129024
buffer_load_dwordx4 v4, s[4:7], s72 offen offset:2048 lds
v_mfma_f32_16x16x32_bf16 v[220:223], v[76:79], v[124:127], v[220:223]
v_accvgpr_read_b32 v29, a79
v_accvgpr_read_b32 v22, a108
v_mfma_f32_16x16x32_bf16 v[216:219], v[76:79], v[116:119], v[216:219]
s_waitcnt vmcnt(20) lgkmcnt(2)
ds_read_b128 v[52:55], v17 offset:4096
v_accvgpr_read_b32 v30, a109
v_mfma_f32_16x16x32_bf16 v[216:219], v[72:75], v[112:115], v[216:219]
s_barrier
ds_read_b128 v[56:59], v16 offset:6144
v_accvgpr_read_b32 v23, a110
v_mfma_f32_16x16x32_bf16 v[212:215], v[72:75], v[104:107], v[212:215]
ds_read_b64_tr_b16 v[64:65], v8 offset:0
ds_read_b64_tr_b16 v[66:67], v8 offset:1024
v_mfma_f32_16x16x32_bf16 v[212:215], v[76:79], v[108:111], v[212:215]
ds_read_b64_tr_b16 v[68:69], v8 offset:8192
v_accvgpr_read_b32 v31, a111
v_mfma_f32_16x16x32_bf16 v[208:211], v[76:79], v[100:103], v[208:211]
s_add_u32 s72, s69, 144384
buffer_load_dwordx4 v5, s[4:7], s72 offen offset:3072 lds
v_mfma_f32_16x16x32_bf16 v[208:211], v[72:75], v[96:99], v[208:211]
ds_read_b64_tr_b16 v[70:71], v8 offset:9216
v_mul_f32 v20, s79, v20
v_mfma_f32_16x16x32_bf16 v[224:227], v[80:83], v[96:99], v[224:227]
ds_read_b64_tr_b16 v[72:73], v9 offset:0
v_mul_f32 v28, s79, v28
v_mfma_f32_16x16x32_bf16 v[224:227], v[84:87], v[100:103], v[224:227]
ds_read_b64_tr_b16 v[74:75], v9 offset:1024
v_mul_f32 v21, s79, v21
v_mfma_f32_16x16x32_bf16 v[228:231], v[84:87], v[108:111], v[228:231]
s_add_u32 m0, s63, 102400
v_mul_f32 v29, s79, v29
v_mul_f32 v22, s79, v22
v_mfma_f32_16x16x32_bf16 v[228:231], v[80:83], v[104:107], v[228:231]
s_add_u32 s72, s70, 0
buffer_load_dwordx4 v4, s[4:7], s72 offen lds
v_mfma_f32_16x16x32_bf16 v[232:235], v[80:83], v[112:115], v[232:235]
ds_read_b64_tr_b16 v[76:77], v9 offset:8192
v_mul_f32 v30, s79, v30
v_mfma_f32_16x16x32_bf16 v[232:235], v[84:87], v[116:119], v[232:235]
ds_read_b128 v[60:63], v17 offset:6144
v_mul_f32 v23, s79, v23
v_mfma_f32_16x16x32_bf16 v[236:239], v[84:87], v[124:127], v[236:239]
ds_read_b64_tr_b16 v[78:79], v9 offset:9216
v_mul_f32 v31, s79, v31
v_mfma_f32_16x16x32_bf16 v[236:239], v[80:83], v[120:123], v[236:239]
v_cvt_pk_bf16_f32 v20, v20, v28
v_cvt_pk_bf16_f32 v21, v21, v29
v_mfma_f32_16x16x32_bf16 v[252:255], v[88:91], v[120:123], v[252:255]
s_add_u32 s72, s70, 15360
buffer_load_dwordx4 v5, s[4:7], s72 offen offset:1024 lds
v_mfma_f32_16x16x32_bf16 v[252:255], v[92:95], v[124:127], v[252:255]
ds_read_b64_tr_b16 v[80:81], v10 offset:0
v_cvt_pk_bf16_f32 v22, v22, v30
v_mfma_f32_16x16x32_bf16 v[248:251], v[92:95], v[116:119], v[248:251]
ds_read_b64_tr_b16 v[82:83], v10 offset:1024
v_cvt_pk_bf16_f32 v23, v23, v31
v_mfma_f32_16x16x32_bf16 v[248:251], v[88:91], v[112:115], v[248:251]
s_add_u32 s80, s77, 13312
buffer_store_dwordx4 v[20:23], v1, s[44:47], s80 offen sc1
v_mfma_f32_16x16x32_bf16 v[244:247], v[88:91], v[104:107], v[244:247]
ds_read_b64_tr_b16 v[84:85], v10 offset:8192
v_accvgpr_read_b32 v24, a200
v_mfma_f32_16x16x32_bf16 v[244:247], v[92:95], v[108:111], v[244:247]
ds_read_b64_tr_b16 v[86:87], v10 offset:9216
v_accvgpr_read_b32 v28, a201
v_mfma_f32_16x16x32_bf16 v[240:243], v[92:95], v[100:103], v[240:243]
s_add_u32 s72, s70, 129024
buffer_load_dwordx4 v4, s[4:7], s72 offen offset:2048 lds
v_mfma_f32_16x16x32_bf16 v[240:243], v[88:91], v[96:99], v[240:243]
s_waitcnt lgkmcnt(5)
v_accvgpr_read_b32 v25, a202
v_accvgpr_read_b32 v29, a203
v_mfma_f32_16x16x32_bf16 v[128:131], v[64:67], v[32:35], v[128:131]
ds_read_b64_tr_b16 v[88:89], v11 offset:0
v_accvgpr_read_b32 v26, a204
v_mfma_f32_16x16x32_bf16 v[128:131], v[68:71], v[36:39], v[128:131]
ds_read_b64_tr_b16 v[90:91], v11 offset:1024
v_accvgpr_read_b32 v30, a205
v_mfma_f32_16x16x32_bf16 v[132:135], v[68:71], v[44:47], v[132:135]
v_accvgpr_read_b32 v27, a206
v_accvgpr_read_b32 v31, a207
v_mfma_f32_16x16x32_bf16 v[132:135], v[64:67], v[40:43], v[132:135]
s_add_u32 s72, s70, 144384
buffer_load_dwordx4 v5, s[4:7], s72 offen offset:3072 lds
v_mfma_f32_16x16x32_bf16 v[136:139], v[64:67], v[48:51], v[136:139]
ds_read_b64_tr_b16 v[92:93], v11 offset:8192
v_cvt_pk_bf16_f32 v24, v24, v28
v_mfma_f32_16x16x32_bf16 v[136:139], v[68:71], v[52:55], v[136:139]
s_lshl_b32 s71, s73, 12
v_cvt_pk_bf16_f32 v25, v25, v29
v_cvt_pk_bf16_f32 v26, v26, v30
v_mfma_f32_16x16x32_bf16 v[140:143], v[68:71], v[60:63], v[140:143]
s_add_u32 s71, s71, s66
ds_read_b64_tr_b16 v[94:95], v11 offset:9216
v_cvt_pk_bf16_f32 v27, v27, v31
v_mfma_f32_16x16x32_bf16 v[140:143], v[64:67], v[56:59], v[140:143]
s_waitcnt lgkmcnt(8)
v_mfma_f32_16x16x32_bf16 v[156:159], v[72:75], v[56:59], v[156:159]
s_add_u32 m0, s64, 32768
ds_read_b64_tr_b16 v[64:65], v12 offset:0
v_mfma_f32_16x16x32_bf16 v[156:159], v[76:79], v[60:63], v[156:159]
s_add_u32 s72, s71, 0
buffer_load_dwordx4 v6, s[12:15], s72 offen lds
v_mfma_f32_16x16x32_bf16 v[152:155], v[76:79], v[52:55], v[152:155]
s_add_u32 s73, s62, 9
ds_read_b64_tr_b16 v[66:67], v12 offset:1024
v_mfma_f32_16x16x32_bf16 v[152:155], v[72:75], v[48:51], v[152:155]
s_add_u32 s70, s73, s65
v_mfma_f32_16x16x32_bf16 v[148:151], v[72:75], v[40:43], v[148:151]
s_and_b32 s70, s70, 3
ds_read_b64_tr_b16 v[68:69], v12 offset:8192
v_mfma_f32_16x16x32_bf16 v[148:151], v[76:79], v[44:47], v[148:151]
s_and_b32 s73, s73, 12
ds_read_b64_tr_b16 v[70:71], v12 offset:9216
v_mfma_f32_16x16x32_bf16 v[144:147], v[76:79], v[36:39], v[144:147]
s_add_u32 s72, s71, 31744
buffer_load_dwordx4 v6, s[12:15], s72 offen offset:1024 lds
v_mfma_f32_16x16x32_bf16 v[144:147], v[72:75], v[32:35], v[144:147]
s_waitcnt lgkmcnt(8)
v_mfma_f32_16x16x32_bf16 v[160:163], v[80:83], v[32:35], v[160:163]
s_or_b32 s73, s73, s70
ds_read_b64_tr_b16 v[72:73], v13 offset:0
v_accvgpr_read_b32 v20, a80
v_mfma_f32_16x16x32_bf16 v[160:163], v[84:87], v[36:39], v[160:163]
s_lshl_b32 s73, s73, 7
ds_read_b64_tr_b16 v[74:75], v13 offset:1024
v_accvgpr_read_b32 v28, a81
v_mfma_f32_16x16x32_bf16 v[164:167], v[84:87], v[44:47], v[164:167]
s_add_u32 s69, s73, s67
v_accvgpr_read_b32 v21, a82
v_accvgpr_read_b32 v29, a83
v_mfma_f32_16x16x32_bf16 v[164:167], v[80:83], v[40:43], v[164:167]
s_add_u32 s72, s71, 63488
buffer_load_dwordx4 v7, s[12:15], s72 offen offset:2048 lds
v_mfma_f32_16x16x32_bf16 v[168:171], v[80:83], v[48:51], v[168:171]
s_waitcnt vmcnt(19)
ds_read_b64_tr_b16 v[76:77], v13 offset:8192
v_accvgpr_read_b32 v22, a112
v_mfma_f32_16x16x32_bf16 v[168:171], v[84:87], v[52:55], v[168:171]
s_add_u32 s70, s73, s68
ds_read_b128 v[96:99], v18 offset:0
v_accvgpr_read_b32 v30, a113
v_mfma_f32_16x16x32_bf16 v[172:175], v[84:87], v[60:63], v[172:175]
s_add_u32 s80, s78, 10240
ds_read_b64_tr_b16 v[78:79], v13 offset:9216
v_accvgpr_read_b32 v23, a114
v_mfma_f32_16x16x32_bf16 v[172:175], v[80:83], v[56:59], v[172:175]
s_waitcnt lgkmcnt(9)
ds_read_b128 v[100:103], v19 offset:0
v_accvgpr_read_b32 v31, a115
v_mfma_f32_16x16x32_bf16 v[188:191], v[88:91], v[56:59], v[188:191]
s_add_u32 s72, s71, 95232
buffer_load_dwordx4 v7, s[12:15], s72 offen offset:3072 lds
v_mfma_f32_16x16x32_bf16 v[188:191], v[92:95], v[60:63], v[188:191]
ds_read_b64_tr_b16 v[80:81], v14 offset:0
v_mul_f32 v20, s79, v20
v_mfma_f32_16x16x32_bf16 v[184:187], v[92:95], v[52:55], v[184:187]
ds_read_b64_tr_b16 v[82:83], v14 offset:1024
v_mul_f32 v28, s79, v28
v_mfma_f32_16x16x32_bf16 v[184:187], v[88:91], v[48:51], v[184:187]
buffer_store_dwordx4 v[24:27], v1, s[44:47], s80 offen sc1
v_mfma_f32_16x16x32_bf16 v[180:183], v[88:91], v[40:43], v[180:183]
ds_read_b64_tr_b16 v[84:85], v14 offset:8192
v_mul_f32 v21, s79, v21
v_mfma_f32_16x16x32_bf16 v[180:183], v[92:95], v[44:47], v[180:183]
s_add_u32 m0, s63, 131072
ds_read_b64_tr_b16 v[86:87], v14 offset:9216
v_mul_f32 v29, s79, v29
v_mfma_f32_16x16x32_bf16 v[176:179], v[92:95], v[36:39], v[176:179]
s_add_u32 s72, s69, 0
buffer_load_dwordx4 v4, s[4:7], s72 offen lds
v_mfma_f32_16x16x32_bf16 v[176:179], v[88:91], v[32:35], v[176:179]
s_waitcnt lgkmcnt(10)
ds_read_b128 v[104:107], v18 offset:2048
v_mul_f32 v22, s79, v22
v_mfma_f32_16x16x32_bf16 v[192:195], v[64:67], v[32:35], v[192:195]
ds_read_b64_tr_b16 v[88:89], v15 offset:0
v_mul_f32 v30, s79, v30
v_mfma_f32_16x16x32_bf16 v[192:195], v[68:71], v[36:39], v[192:195]
ds_read_b64_tr_b16 v[90:91], v15 offset:1024
v_mul_f32 v23, s79, v23
v_mfma_f32_16x16x32_bf16 v[196:199], v[68:71], v[44:47], v[196:199]
ds_read_b64_tr_b16 v[92:93], v15 offset:8192
v_mul_f32 v31, s79, v31
v_mfma_f32_16x16x32_bf16 v[196:199], v[64:67], v[40:43], v[196:199]
s_add_u32 s72, s69, 15360
buffer_load_dwordx4 v5, s[4:7], s72 offen offset:1024 lds
v_mfma_f32_16x16x32_bf16 v[200:203], v[64:67], v[48:51], v[200:203]
ds_read_b64_tr_b16 v[94:95], v15 offset:9216
v_cvt_pk_bf16_f32 v20, v20, v28
v_mfma_f32_16x16x32_bf16 v[200:203], v[68:71], v[52:55], v[200:203]
ds_read_b128 v[108:111], v19 offset:2048
v_cvt_pk_bf16_f32 v21, v21, v29
v_mfma_f32_16x16x32_bf16 v[204:207], v[68:71], v[60:63], v[204:207]
v_cvt_pk_bf16_f32 v22, v22, v30
v_cvt_pk_bf16_f32 v23, v23, v31
v_mfma_f32_16x16x32_bf16 v[204:207], v[64:67], v[56:59], v[204:207]
s_waitcnt lgkmcnt(11)
ds_read_b128 v[112:115], v18 offset:4096
v_accvgpr_read_b32 v24, a208
v_mfma_f32_16x16x32_bf16 v[220:223], v[72:75], v[56:59], v[220:223]
s_add_u32 s72, s69, 129024
buffer_load_dwordx4 v4, s[4:7], s72 offen offset:2048 lds
v_mfma_f32_16x16x32_bf16 v[220:223], v[76:79], v[60:63], v[220:223]
s_add_u32 s80, s77, 33792
s_nop 3
s_mov_b64 exec, 0
s_cmp_eq_u32 s58, 0
s_cbranch_scc1 Lstub0
s_cmp_eq_u32 s58, 1
s_cbranch_scc1 Lstub1
s_cmp_eq_u32 s58, 2
s_cbranch_scc1 Lstub2
s_branch Lstub3
Lret:
s_mov_b64 exec, -1
s_nop 3
v_mfma_f32_16x16x32_bf16 v[216:219], v[76:79], v[52:55], v[216:219]
s_waitcnt vmcnt(19) lgkmcnt(2)
ds_read_b128 v[116:119], v19 offset:4096
v_accvgpr_read_b32 v28, a209
v_mfma_f32_16x16x32_bf16 v[216:219], v[72:75], v[48:51], v[216:219]
s_barrier
buffer_store_dwordx4 v[20:23], v1, s[44:47], s80 offen sc1
v_mfma_f32_16x16x32_bf16 v[212:215], v[72:75], v[40:43], v[212:215]
ds_read_b64_tr_b16 v[64:65], v8 offset:16384
ds_read_b64_tr_b16 v[66:67], v8 offset:17408
v_mfma_f32_16x16x32_bf16 v[212:215], v[76:79], v[44:47], v[212:215]
ds_read_b64_tr_b16 v[68:69], v8 offset:24576
v_accvgpr_read_b32 v25, a210
v_mfma_f32_16x16x32_bf16 v[208:211], v[76:79], v[36:39], v[208:211]
s_add_u32 s72, s69, 144384
buffer_load_dwordx4 v5, s[4:7], s72 offen offset:3072 lds
v_mfma_f32_16x16x32_bf16 v[208:211], v[72:75], v[32:35], v[208:211]
ds_read_b64_tr_b16 v[70:71], v8 offset:25600
v_accvgpr_read_b32 v29, a211
v_mfma_f32_16x16x32_bf16 v[224:227], v[80:83], v[32:35], v[224:227]
ds_read_b64_tr_b16 v[72:73], v9 offset:16384
v_accvgpr_read_b32 v26, a212
v_mfma_f32_16x16x32_bf16 v[224:227], v[84:87], v[36:39], v[224:227]
ds_read_b64_tr_b16 v[74:75], v9 offset:17408
v_accvgpr_read_b32 v30, a213
v_mfma_f32_16x16x32_bf16 v[228:231], v[84:87], v[44:47], v[228:231]
s_add_u32 m0, s63, 135168
ds_read_b128 v[120:123], v18 offset:6144
v_accvgpr_read_b32 v27, a214
v_mfma_f32_16x16x32_bf16 v[228:231], v[80:83], v[40:43], v[228:231]
s_add_u32 s72, s70, 0
buffer_load_dwordx4 v4, s[4:7], s72 offen lds
v_mfma_f32_16x16x32_bf16 v[232:235], v[80:83], v[48:51], v[232:235]
ds_read_b64_tr_b16 v[76:77], v9 offset:24576
v_accvgpr_read_b32 v31, a215
v_mfma_f32_16x16x32_bf16 v[232:235], v[84:87], v[52:55], v[232:235]
ds_read_b128 v[124:127], v19 offset:6144
v_cvt_pk_bf16_f32 v24, v24, v28
v_mfma_f32_16x16x32_bf16 v[236:239], v[84:87], v[60:63], v[236:239]
ds_read_b64_tr_b16 v[78:79], v9 offset:25600
v_cvt_pk_bf16_f32 v25, v25, v29
v_mfma_f32_16x16x32_bf16 v[236:239], v[80:83], v[56:59], v[236:239]
v_cvt_pk_bf16_f32 v26, v26, v30
v_cvt_pk_bf16_f32 v27, v27, v31
v_mfma_f32_16x16x32_bf16 v[252:255], v[88:91], v[56:59], v[252:255]
s_add_u32 s72, s70, 15360
buffer_load_dwordx4 v5, s[4:7], s72 offen offset:1024 lds
v_mfma_f32_16x16x32_bf16 v[252:255], v[92:95], v[60:63], v[252:255]
s_add_u32 s80, s78, 34816
ds_read_b64_tr_b16 v[80:81], v10 offset:16384
v_mfma_f32_16x16x32_bf16 v[248:251], v[92:95], v[52:55], v[248:251]
ds_read_b64_tr_b16 v[82:83], v10 offset:17408
v_mfma_f32_16x16x32_bf16 v[248:251], v[88:91], v[48:51], v[248:251]
buffer_store_dwordx4 v[24:27], v1, s[44:47], s80 offen sc1
v_mfma_f32_16x16x32_bf16 v[244:247], v[88:91], v[40:43], v[244:247]
ds_read_b64_tr_b16 v[84:85], v10 offset:24576
v_mfma_f32_16x16x32_bf16 v[244:247], v[92:95], v[44:47], v[244:247]
ds_read_b64_tr_b16 v[86:87], v10 offset:25600
v_accvgpr_read_b32 v20, a84
v_mfma_f32_16x16x32_bf16 v[240:243], v[92:95], v[36:39], v[240:243]
s_add_u32 s72, s70, 129024
buffer_load_dwordx4 v4, s[4:7], s72 offen offset:2048 lds
v_mfma_f32_16x16x32_bf16 v[240:243], v[88:91], v[32:35], v[240:243]
s_waitcnt lgkmcnt(5)
v_accvgpr_read_b32 v28, a85
v_accvgpr_read_b32 v21, a86
v_mfma_f32_16x16x32_bf16 v[128:131], v[64:67], v[96:99], v[128:131]
ds_read_b64_tr_b16 v[88:89], v11 offset:16384
v_accvgpr_read_b32 v29, a87
v_mfma_f32_16x16x32_bf16 v[128:131], v[68:71], v[100:103], v[128:131]
ds_read_b64_tr_b16 v[90:91], v11 offset:17408
v_accvgpr_read_b32 v22, a116
v_mfma_f32_16x16x32_bf16 v[132:135], v[68:71], v[108:111], v[132:135]
v_accvgpr_read_b32 v30, a117
v_accvgpr_read_b32 v23, a118
v_mfma_f32_16x16x32_bf16 v[132:135], v[64:67], v[104:107], v[132:135]
s_add_u32 s72, s70, 144384
buffer_load_dwordx4 v5, s[4:7], s72 offen offset:3072 lds
v_mfma_f32_16x16x32_bf16 v[136:139], v[64:67], v[112:115], v[136:139]
ds_read_b64_tr_b16 v[92:93], v11 offset:24576
v_accvgpr_read_b32 v31, a119
v_mfma_f32_16x16x32_bf16 v[136:139], v[68:71], v[116:119], v[136:139]
s_lshl_b32 s71, s73, 12
v_mul_f32 v20, s79, v20
v_mul_f32 v28, s79, v28
v_mfma_f32_16x16x32_bf16 v[140:143], v[68:71], v[124:127], v[140:143]
s_add_u32 s71, s71, s66
ds_read_b64_tr_b16 v[94:95], v11 offset:25600
v_mul_f32 v21, s79, v21
v_mfma_f32_16x16x32_bf16 v[140:143], v[64:67], v[120:123], v[140:143]
s_waitcnt lgkmcnt(8)
v_mul_f32 v29, s79, v29
v_mul_f32 v22, s79, v22
v_mfma_f32_16x16x32_bf16 v[156:159], v[72:75], v[120:123], v[156:159]
s_add_u32 m0, s64, 0
ds_read_b64_tr_b16 v[64:65], v12 offset:16384
v_mul_f32 v30, s79, v30
v_mfma_f32_16x16x32_bf16 v[156:159], v[76:79], v[124:127], v[156:159]
s_add_u32 s72, s71, 0
buffer_load_dwordx4 v6, s[12:15], s72 offen lds
v_mfma_f32_16x16x32_bf16 v[152:155], v[76:79], v[116:119], v[152:155]
s_add_u32 s73, s62, 10
ds_read_b64_tr_b16 v[66:67], v12 offset:17408
v_mul_f32 v23, s79, v23
v_mfma_f32_16x16x32_bf16 v[152:155], v[72:75], v[112:115], v[152:155]
s_add_u32 s70, s73, s65
v_mul_f32 v31, s79, v31
v_cvt_pk_bf16_f32 v20, v20, v28
v_mfma_f32_16x16x32_bf16 v[148:151], v[72:75], v[104:107], v[148:151]
s_and_b32 s70, s70, 3
ds_read_b64_tr_b16 v[68:69], v12 offset:24576
v_cvt_pk_bf16_f32 v21, v21, v29
v_mfma_f32_16x16x32_bf16 v[148:151], v[76:79], v[108:111], v[148:151]
s_and_b32 s73, s73, 12
ds_read_b64_tr_b16 v[70:71], v12 offset:25600
v_cvt_pk_bf16_f32 v22, v22, v30
v_mfma_f32_16x16x32_bf16 v[144:147], v[76:79], v[100:103], v[144:147]
s_add_u32 s72, s71, 31744
buffer_load_dwordx4 v6, s[12:15], s72 offen offset:1024 lds
v_mfma_f32_16x16x32_bf16 v[144:147], v[72:75], v[96:99], v[144:147]
s_waitcnt lgkmcnt(8)
v_cvt_pk_bf16_f32 v23, v23, v31
v_mfma_f32_16x16x32_bf16 v[160:163], v[80:83], v[96:99], v[160:163]
s_or_b32 s73, s73, s70
ds_read_b64_tr_b16 v[72:73], v13 offset:16384
v_mfma_f32_16x16x32_bf16 v[160:163], v[84:87], v[100:103], v[160:163]
s_lshl_b32 s73, s73, 7
ds_read_b64_tr_b16 v[74:75], v13 offset:17408
v_mfma_f32_16x16x32_bf16 v[164:167], v[84:87], v[108:111], v[164:167]
s_add_u32 s69, s73, s67
v_mfma_f32_16x16x32_bf16 v[164:167], v[80:83], v[104:107], v[164:167]
s_add_u32 s72, s71, 63488
buffer_load_dwordx4 v7, s[12:15], s72 offen offset:2048 lds
v_mfma_f32_16x16x32_bf16 v[168:171], v[80:83], v[112:115], v[168:171]
s_waitcnt vmcnt(18)
ds_read_b64_tr_b16 v[76:77], v13 offset:24576
v_accvgpr_read_b32 v24, a216
v_mfma_f32_16x16x32_bf16 v[168:171], v[84:87], v[116:119], v[168:171]
s_add_u32 s70, s73, s68
ds_read_b128 v[32:35], v18 offset:32768
v_accvgpr_read_b32 v28, a217
v_mfma_f32_16x16x32_bf16 v[172:175], v[84:87], v[124:127], v[172:175]
s_add_u32 s80, s77, 37888
ds_read_b64_tr_b16 v[78:79], v13 offset:25600
v_accvgpr_read_b32 v25, a218
v_mfma_f32_16x16x32_bf16 v[172:175], v[80:83], v[120:123], v[172:175]
s_waitcnt lgkmcnt(9)
ds_read_b128 v[36:39], v19 offset:32768
v_accvgpr_read_b32 v29, a219
v_mfma_f32_16x16x32_bf16 v[188:191], v[88:91], v[120:123], v[188:191]
s_add_u32 s72, s71, 95232
buffer_load_dwordx4 v7, s[12:15], s72 offen offset:3072 lds
v_mfma_f32_16x16x32_bf16 v[188:191], v[92:95], v[124:127], v[188:191]
ds_read_b64_tr_b16 v[80:81], v14 offset:16384
v_accvgpr_read_b32 v26, a220
v_mfma_f32_16x16x32_bf16 v[184:187], v[92:95], v[116:119], v[184:187]
ds_read_b64_tr_b16 v[82:83], v14 offset:17408
v_accvgpr_read_b32 v30, a221
v_mfma_f32_16x16x32_bf16 v[184:187], v[88:91], v[112:115], v[184:187]
buffer_store_dwordx4 v[20:23], v1, s[44:47], s80 offen sc1
v_mfma_f32_16x16x32_bf16 v[180:183], v[88:91], v[104:107], v[180:183]
ds_read_b64_tr_b16 v[84:85], v14 offset:24576
v_accvgpr_read_b32 v27, a222
v_mfma_f32_16x16x32_bf16 v[180:183], v[92:95], v[108:111], v[180:183]
s_add_u32 m0, s63, 65536
ds_read_b64_tr_b16 v[86:87], v14 offset:25600
v_accvgpr_read_b32 v31, a223
v_mfma_f32_16x16x32_bf16 v[176:179], v[92:95], v[100:103], v[176:179]
s_add_u32 s72, s69, 0
buffer_load_dwordx4 v4, s[4:7], s72 offen lds
v_mfma_f32_16x16x32_bf16 v[176:179], v[88:91], v[96:99], v[176:179]
s_waitcnt lgkmcnt(10)
ds_read_b128 v[40:43], v18 offset:34816
v_cvt_pk_bf16_f32 v24, v24, v28
v_mfma_f32_16x16x32_bf16 v[192:195], v[64:67], v[96:99], v[192:195]
ds_read_b64_tr_b16 v[88:89], v15 offset:16384
v_cvt_pk_bf16_f32 v25, v25, v29
v_mfma_f32_16x16x32_bf16 v[192:195], v[68:71], v[100:103], v[192:195]
ds_read_b64_tr_b16 v[90:91], v15 offset:17408
v_cvt_pk_bf16_f32 v26, v26, v30
v_mfma_f32_16x16x32_bf16 v[196:199], v[68:71], v[108:111], v[196:199]
ds_read_b64_tr_b16 v[92:93], v15 offset:24576
v_cvt_pk_bf16_f32 v27, v27, v31
v_mfma_f32_16x16x32_bf16 v[196:199], v[64:67], v[104:107], v[196:199]
s_add_u32 s72, s69, 15360
buffer_load_dwordx4 v5, s[4:7], s72 offen offset:1024 lds
v_mfma_f32_16x16x32_bf16 v[200:203], v[64:67], v[112:115], v[200:203]
s_add_u32 s80, s78, 43008
ds_read_b64_tr_b16 v[94:95], v15 offset:25600
v_mfma_f32_16x16x32_bf16 v[200:203], v[68:71], v[116:119], v[200:203]
ds_read_b128 v[44:47], v19 offset:34816
v_mfma_f32_16x16x32_bf16 v[204:207], v[68:71], v[124:127], v[204:207]
buffer_store_dwordx4 v[24:27], v1, s[44:47], s80 offen sc1
v_mfma_f32_16x16x32_bf16 v[204:207], v[64:67], v[120:123], v[204:207]
s_waitcnt lgkmcnt(11)
ds_read_b128 v[48:51], v18 offset:36864
v_mfma_f32_16x16x32_bf16 v[220:223], v[72:75], v[120:123], v[220:223]
s_add_u32 s72, s69, 129024
buffer_load_dwordx4 v4, s[4:7], s72 offen offset:2048 lds
v_mfma_f32_16x16x32_bf16 v[220:223], v[76:79], v[124:127], v[220:223]
v_accvgpr_read_b32 v20, a88
v_accvgpr_read_b32 v28, a89
v_mfma_f32_16x16x32_bf16 v[216:219], v[76:79], v[116:119], v[216:219]
s_waitcnt vmcnt(20) lgkmcnt(2)
ds_read_b128 v[52:55], v19 offset:36864
v_accvgpr_read_b32 v21, a90
v_mfma_f32_16x16x32_bf16 v[216:219], v[72:75], v[112:115], v[216:219]
s_barrier
ds_read_b128 v[56:59], v18 offset:38912
v_accvgpr_read_b32 v29, a91
v_mfma_f32_16x16x32_bf16 v[212:215], v[72:75], v[104:107], v[212:215]
ds_read_b64_tr_b16 v[64:65], v8 offset:32768
ds_read_b64_tr_b16 v[66:67], v8 offset:33792
v_mfma_f32_16x16x32_bf16 v[212:215], v[76:79], v[108:111], v[212:215]
ds_read_b64_tr_b16 v[68:69], v8 offset:40960
v_accvgpr_read_b32 v22, a120
v_mfma_f32_16x16x32_bf16 v[208:211], v[76:79], v[100:103], v[208:211]
s_add_u32 s72, s69, 144384
buffer_load_dwordx4 v5, s[4:7], s72 offen offset:3072 lds
v_mfma_f32_16x16x32_bf16 v[208:211], v[72:75], v[96:99], v[208:211]
ds_read_b64_tr_b16 v[70:71], v8 offset:41984
v_accvgpr_read_b32 v30, a121
v_mfma_f32_16x16x32_bf16 v[224:227], v[80:83], v[96:99], v[224:227]
ds_read_b64_tr_b16 v[72:73], v9 offset:32768
v_accvgpr_read_b32 v23, a122
v_mfma_f32_16x16x32_bf16 v[224:227], v[84:87], v[100:103], v[224:227]
ds_read_b64_tr_b16 v[74:75], v9 offset:33792
v_accvgpr_read_b32 v31, a123
v_mfma_f32_16x16x32_bf16 v[228:231], v[84:87], v[108:111], v[228:231]
s_add_u32 m0, s63, 69632
v_mul_f32 v20, s79, v20
v_mul_f32 v28, s79, v28
v_mfma_f32_16x16x32_bf16 v[228:231], v[80:83], v[104:107], v[228:231]
s_add_u32 s72, s70, 0
buffer_load_dwordx4 v4, s[4:7], s72 offen lds
v_mfma_f32_16x16x32_bf16 v[232:235], v[80:83], v[112:115], v[232:235]
ds_read_b64_tr_b16 v[76:77], v9 offset:40960
v_mul_f32 v21, s79, v21
v_mfma_f32_16x16x32_bf16 v[232:235], v[84:87], v[116:119], v[232:235]
ds_read_b128 v[60:63], v19 offset:38912
v_mul_f32 v29, s79, v29
v_mfma_f32_16x16x32_bf16 v[236:239], v[84:87], v[124:127], v[236:239]
ds_read_b64_tr_b16 v[78:79], v9 offset:41984
v_mul_f32 v22, s79, v22
v_mfma_f32_16x16x32_bf16 v[236:239], v[80:83], v[120:123], v[236:239]
v_mul_f32 v30, s79, v30
v_mul_f32 v23, s79, v23
v_mfma_f32_16x16x32_bf16 v[252:255], v[88:91], v[120:123], v[252:255]
s_add_u32 s72, s70, 15360
buffer_load_dwordx4 v5, s[4:7], s72 offen offset:1024 lds
v_mfma_f32_16x16x32_bf16 v[252:255], v[92:95], v[124:127], v[252:255]
ds_read_b64_tr_b16 v[80:81], v10 offset:32768
v_mul_f32 v31, s79, v31
v_mfma_f32_16x16x32_bf16 v[248:251], v[92:95], v[116:119], v[248:251]
ds_read_b64_tr_b16 v[82:83], v10 offset:33792
v_cvt_pk_bf16_f32 v20, v20, v28
v_mfma_f32_16x16x32_bf16 v[248:251], v[88:91], v[112:115], v[248:251]
v_cvt_pk_bf16_f32 v21, v21, v29
v_cvt_pk_bf16_f32 v22, v22, v30
v_mfma_f32_16x16x32_bf16 v[244:247], v[88:91], v[104:107], v[244:247]
ds_read_b64_tr_b16 v[84:85], v10 offset:40960
v_cvt_pk_bf16_f32 v23, v23, v31
v_mfma_f32_16x16x32_bf16 v[244:247], v[92:95], v[108:111], v[244:247]
s_add_u32 s80, s77, 41984
ds_read_b64_tr_b16 v[86:87], v10 offset:41984
v_mfma_f32_16x16x32_bf16 v[240:243], v[92:95], v[100:103], v[240:243]
s_add_u32 s72, s70, 129024
buffer_load_dwordx4 v4, s[4:7], s72 offen offset:2048 lds
v_mfma_f32_16x16x32_bf16 v[240:243], v[88:91], v[96:99], v[240:243]
s_waitcnt lgkmcnt(5)
buffer_store_dwordx4 v[20:23], v1, s[44:47], s80 offen sc1
LcB1:
v_mfma_f32_16x16x32_bf16 v[128:131], v[64:67], v[32:35], v[128:131]
ds_read_b64_tr_b16 v[88:89], v11 offset:32768
v_accvgpr_read_b32 v24, a224
v_mfma_f32_16x16x32_bf16 v[128:131], v[68:71], v[36:39], v[128:131]
ds_read_b64_tr_b16 v[90:91], v11 offset:33792
v_accvgpr_read_b32 v28, a225
v_mfma_f32_16x16x32_bf16 v[132:135], v[68:71], v[44:47], v[132:135]
v_accvgpr_read_b32 v25, a226
v_accvgpr_read_b32 v29, a227
v_mfma_f32_16x16x32_bf16 v[132:135], v[64:67], v[40:43], v[132:135]
s_add_u32 s72, s70, 144384
buffer_load_dwordx4 v5, s[4:7], s72 offen offset:3072 lds
v_mfma_f32_16x16x32_bf16 v[136:139], v[64:67], v[48:51], v[136:139]
ds_read_b64_tr_b16 v[92:93], v11 offset:40960
v_accvgpr_read_b32 v26, a228
v_mfma_f32_16x16x32_bf16 v[136:139], v[68:71], v[52:55], v[136:139]
s_lshl_b32 s71, s73, 12
v_accvgpr_read_b32 v30, a229
v_accvgpr_read_b32 v27, a230
v_mfma_f32_16x16x32_bf16 v[140:143], v[68:71], v[60:63], v[140:143]
s_add_u32 s71, s71, s66
ds_read_b64_tr_b16 v[94:95], v11 offset:41984
v_accvgpr_read_b32 v31, a231
v_mfma_f32_16x16x32_bf16 v[140:143], v[64:67], v[56:59], v[140:143]
s_waitcnt lgkmcnt(8)
v_cvt_pk_bf16_f32 v24, v24, v28
v_cvt_pk_bf16_f32 v25, v25, v29
v_mfma_f32_16x16x32_bf16 v[156:159], v[72:75], v[56:59], v[156:159]
s_add_u32 m0, s64, 16384
ds_read_b64_tr_b16 v[64:65], v12 offset:32768
v_cvt_pk_bf16_f32 v26, v26, v30
v_mfma_f32_16x16x32_bf16 v[156:159], v[76:79], v[60:63], v[156:159]
s_add_u32 s72, s71, 0
buffer_load_dwordx4 v6, s[12:15], s72 offen lds
v_mfma_f32_16x16x32_bf16 v[152:155], v[76:79], v[52:55], v[152:155]
s_add_u32 s73, s62, 11
ds_read_b64_tr_b16 v[66:67], v12 offset:33792
v_cvt_pk_bf16_f32 v27, v27, v31
v_mfma_f32_16x16x32_bf16 v[152:155], v[72:75], v[48:51], v[152:155]
s_add_u32 s70, s73, s65
v_mfma_f32_16x16x32_bf16 v[148:151], v[72:75], v[40:43], v[148:151]
s_and_b32 s70, s70, 3
ds_read_b64_tr_b16 v[68:69], v12 offset:40960
v_mfma_f32_16x16x32_bf16 v[148:151], v[76:79], v[44:47], v[148:151]
s_and_b32 s73, s73, 12
ds_read_b64_tr_b16 v[70:71], v12 offset:41984
v_mfma_f32_16x16x32_bf16 v[144:147], v[76:79], v[36:39], v[144:147]
s_add_u32 s72, s71, 31744
buffer_load_dwordx4 v6, s[12:15], s72 offen offset:1024 lds
v_mfma_f32_16x16x32_bf16 v[144:147], v[72:75], v[32:35], v[144:147]
s_waitcnt lgkmcnt(8)
v_mfma_f32_16x16x32_bf16 v[160:163], v[80:83], v[32:35], v[160:163]
s_or_b32 s73, s73, s70
ds_read_b64_tr_b16 v[72:73], v13 offset:32768
v_mfma_f32_16x16x32_bf16 v[160:163], v[84:87], v[36:39], v[160:163]
s_lshl_b32 s73, s73, 7
ds_read_b64_tr_b16 v[74:75], v13 offset:33792
v_mfma_f32_16x16x32_bf16 v[164:167], v[84:87], v[44:47], v[164:167]
s_add_u32 s69, s73, s67
v_mfma_f32_16x16x32_bf16 v[164:167], v[80:83], v[40:43], v[164:167]
s_add_u32 s72, s71, 63488
buffer_load_dwordx4 v7, s[12:15], s72 offen offset:2048 lds
v_mfma_f32_16x16x32_bf16 v[168:171], v[80:83], v[48:51], v[168:171]
s_waitcnt vmcnt(18)
ds_read_b64_tr_b16 v[76:77], v13 offset:40960
v_mfma_f32_16x16x32_bf16 v[168:171], v[84:87], v[52:55], v[168:171]
s_add_u32 s70, s73, s68
ds_read_b128 v[96:99], v16 offset:0
v_accvgpr_read_b32 v20, a92
v_mfma_f32_16x16x32_bf16 v[172:175], v[84:87], v[60:63], v[172:175]
s_add_u32 s80, s78, 3072
ds_read_b64_tr_b16 v[78:79], v13 offset:41984
v_accvgpr_read_b32 v28, a93
v_mfma_f32_16x16x32_bf16 v[172:175], v[80:83], v[56:59], v[172:175]
s_waitcnt lgkmcnt(9)
ds_read_b128 v[100:103], v17 offset:0
v_accvgpr_read_b32 v21, a94
v_mfma_f32_16x16x32_bf16 v[188:191], v[88:91], v[56:59], v[188:191]
s_add_u32 s72, s71, 95232
buffer_load_dwordx4 v7, s[12:15], s72 offen offset:3072 lds
v_mfma_f32_16x16x32_bf16 v[188:191], v[92:95], v[60:63], v[188:191]
ds_read_b64_tr_b16 v[80:81], v14 offset:32768
v_accvgpr_read_b32 v29, a95
v_mfma_f32_16x16x32_bf16 v[184:187], v[92:95], v[52:55], v[184:187]
ds_read_b64_tr_b16 v[82:83], v14 offset:33792
v_accvgpr_read_b32 v22, a124
v_mfma_f32_16x16x32_bf16 v[184:187], v[88:91], v[48:51], v[184:187]
buffer_store_dwordx4 v[24:27], v1, s[44:47], s80 offen sc1
v_mfma_f32_16x16x32_bf16 v[180:183], v[88:91], v[40:43], v[180:183]
ds_read_b64_tr_b16 v[84:85], v14 offset:40960
v_accvgpr_read_b32 v30, a125
v_mfma_f32_16x16x32_bf16 v[180:183], v[92:95], v[44:47], v[180:183]
s_add_u32 m0, s63, 98304
ds_read_b64_tr_b16 v[86:87], v14 offset:41984
v_accvgpr_read_b32 v23, a126
v_mfma_f32_16x16x32_bf16 v[176:179], v[92:95], v[36:39], v[176:179]
s_add_u32 s72, s69, 0
buffer_load_dwordx4 v4, s[4:7], s72 offen lds
v_mfma_f32_16x16x32_bf16 v[176:179], v[88:91], v[32:35], v[176:179]
s_waitcnt lgkmcnt(10)
ds_read_b128 v[104:107], v16 offset:2048
v_accvgpr_read_b32 v31, a127
v_mfma_f32_16x16x32_bf16 v[192:195], v[64:67], v[32:35], v[192:195]
ds_read_b64_tr_b16 v[88:89], v15 offset:32768
v_mul_f32 v20, s79, v20
v_mfma_f32_16x16x32_bf16 v[192:195], v[68:71], v[36:39], v[192:195]
ds_read_b64_tr_b16 v[90:91], v15 offset:33792
v_mul_f32 v28, s79, v28
v_mfma_f32_16x16x32_bf16 v[196:199], v[68:71], v[44:47], v[196:199]
ds_read_b64_tr_b16 v[92:93], v15 offset:40960
v_mul_f32 v21, s79, v21
v_mfma_f32_16x16x32_bf16 v[196:199], v[64:67], v[40:43], v[196:199]
s_add_u32 s72, s69, 15360
buffer_load_dwordx4 v5, s[4:7], s72 offen offset:1024 lds
v_mfma_f32_16x16x32_bf16 v[200:203], v[64:67], v[48:51], v[200:203]
ds_read_b64_tr_b16 v[94:95], v15 offset:41984
v_mul_f32 v29, s79, v29
v_mfma_f32_16x16x32_bf16 v[200:203], v[68:71], v[52:55], v[200:203]
ds_read_b128 v[108:111], v17 offset:2048
v_mul_f32 v22, s79, v22
v_mfma_f32_16x16x32_bf16 v[204:207], v[68:71], v[60:63], v[204:207]
v_mul_f32 v30, s79, v30
v_mul_f32 v23, s79, v23
v_mfma_f32_16x16x32_bf16 v[204:207], v[64:67], v[56:59], v[204:207]
s_waitcnt lgkmcnt(11)
ds_read_b128 v[112:115], v16 offset:4096
v_mul_f32 v31, s79, v31
v_mfma_f32_16x16x32_bf16 v[220:223], v[72:75], v[56:59], v[220:223]
s_add_u32 s72, s69, 129024
buffer_load_dwordx4 v4, s[4:7], s72 offen offset:2048 lds
v_mfma_f32_16x16x32_bf16 v[220:223], v[76:79], v[60:63], v[220:223]
v_cvt_pk_bf16_f32 v20, v20, v28
v_cvt_pk_bf16_f32 v21, v21, v29
v_mfma_f32_16x16x32_bf16 v[216:219], v[76:79], v[52:55], v[216:219]
s_waitcnt vmcnt(19) lgkmcnt(2)
ds_read_b128 v[116:119], v17 offset:4096
v_cvt_pk_bf16_f32 v22, v22, v30
v_mfma_f32_16x16x32_bf16 v[216:219], v[72:75], v[48:51], v[216:219]
s_barrier
ds_read_b128 v[120:123], v16 offset:6144
v_cvt_pk_bf16_f32 v23, v23, v31
v_mfma_f32_16x16x32_bf16 v[212:215], v[72:75], v[40:43], v[212:215]
s_add_u32 s80, s77, 46080
ds_read_b64_tr_b16 v[64:65], v8 offset:0
ds_read_b64_tr_b16 v[66:67], v8 offset:1024
v_mfma_f32_16x16x32_bf16 v[212:215], v[76:79], v[44:47], v[212:215]
ds_read_b64_tr_b16 v[68:69], v8 offset:8192
v_accvgpr_read_b32 v24, a232
v_mfma_f32_16x16x32_bf16 v[208:211], v[76:79], v[36:39], v[208:211]
s_add_u32 s72, s69, 144384
buffer_load_dwordx4 v5, s[4:7], s72 offen offset:3072 lds
v_mfma_f32_16x16x32_bf16 v[208:211], v[72:75], v[32:35], v[208:211]
ds_read_b64_tr_b16 v[70:71], v8 offset:9216
v_accvgpr_read_b32 v28, a233
v_mfma_f32_16x16x32_bf16 v[224:227], v[80:83], v[32:35], v[224:227]
ds_read_b64_tr_b16 v[72:73], v9 offset:0
v_accvgpr_read_b32 v25, a234
v_mfma_f32_16x16x32_bf16 v[224:227], v[84:87], v[36:39], v[224:227]
ds_read_b64_tr_b16 v[74:75], v9 offset:1024
v_accvgpr_read_b32 v29, a235
v_mfma_f32_16x16x32_bf16 v[228:231], v[84:87], v[44:47], v[228:231]
s_add_u32 m0, s63, 102400
buffer_store_dwordx4 v[20:23], v1, s[44:47], s80 offen sc1
v_mfma_f32_16x16x32_bf16 v[228:231], v[80:83], v[40:43], v[228:231]
s_add_u32 s72, s70, 0
buffer_load_dwordx4 v4, s[4:7], s72 offen lds
v_mfma_f32_16x16x32_bf16 v[232:235], v[80:83], v[48:51], v[232:235]
ds_read_b64_tr_b16 v[76:77], v9 offset:8192
v_accvgpr_read_b32 v26, a236
v_mfma_f32_16x16x32_bf16 v[232:235], v[84:87], v[52:55], v[232:235]
ds_read_b128 v[124:127], v17 offset:6144
v_accvgpr_read_b32 v30, a237
v_mfma_f32_16x16x32_bf16 v[236:239], v[84:87], v[60:63], v[236:239]
ds_read_b64_tr_b16 v[78:79], v9 offset:9216
v_accvgpr_read_b32 v27, a238
v_mfma_f32_16x16x32_bf16 v[236:239], v[80:83], v[56:59], v[236:239]
v_accvgpr_read_b32 v31, a239
v_cvt_pk_bf16_f32 v24, v24, v28
v_mfma_f32_16x16x32_bf16 v[252:255], v[88:91], v[56:59], v[252:255]
s_add_u32 s72, s70, 15360
buffer_load_dwordx4 v5, s[4:7], s72 offen offset:1024 lds
v_mfma_f32_16x16x32_bf16 v[252:255], v[92:95], v[60:63], v[252:255]
ds_read_b64_tr_b16 v[80:81], v10 offset:0
v_cvt_pk_bf16_f32 v25, v25, v29
v_mfma_f32_16x16x32_bf16 v[248:251], v[92:95], v[52:55], v[248:251]
ds_read_b64_tr_b16 v[82:83], v10 offset:1024
v_cvt_pk_bf16_f32 v26, v26, v30
v_mfma_f32_16x16x32_bf16 v[248:251], v[88:91], v[48:51], v[248:251]
v_cvt_pk_bf16_f32 v27, v27, v31
v_mfma_f32_16x16x32_bf16 v[244:247], v[88:91], v[40:43], v[244:247]
s_add_u32 s80, s78, 11264
ds_read_b64_tr_b16 v[84:85], v10 offset:8192
v_mfma_f32_16x16x32_bf16 v[244:247], v[92:95], v[44:47], v[244:247]
ds_read_b64_tr_b16 v[86:87], v10 offset:9216
v_mfma_f32_16x16x32_bf16 v[240:243], v[92:95], v[36:39], v[240:243]
s_add_u32 s72, s70, 129024
buffer_load_dwordx4 v4, s[4:7], s72 offen offset:2048 lds
v_mfma_f32_16x16x32_bf16 v[240:243], v[88:91], v[32:35], v[240:243]
s_waitcnt lgkmcnt(5)
buffer_store_dwordx4 v[24:27], v1, s[44:47], s80 offen sc1
v_mfma_f32_16x16x32_bf16 v[128:131], v[64:67], v[96:99], v[128:131]
ds_read_b64_tr_b16 v[88:89], v11 offset:0
v_mfma_f32_16x16x32_bf16 v[128:131], v[68:71], v[100:103], v[128:131]
ds_read_b64_tr_b16 v[90:91], v11 offset:1024
v_accvgpr_read_b32 v20, a240
v_mfma_f32_16x16x32_bf16 v[132:135], v[68:71], v[108:111], v[132:135]
v_accvgpr_read_b32 v28, a241
v_accvgpr_read_b32 v21, a242
v_mfma_f32_16x16x32_bf16 v[132:135], v[64:67], v[104:107], v[132:135]
s_add_u32 s72, s70, 144384
buffer_load_dwordx4 v5, s[4:7], s72 offen offset:3072 lds
v_mfma_f32_16x16x32_bf16 v[136:139], v[64:67], v[112:115], v[136:139]
ds_read_b64_tr_b16 v[92:93], v11 offset:8192
v_accvgpr_read_b32 v29, a243
v_mfma_f32_16x16x32_bf16 v[136:139], v[68:71], v[116:119], v[136:139]
s_lshl_b32 s71, s73, 12
v_accvgpr_read_b32 v22, a244
v_accvgpr_read_b32 v30, a245
v_mfma_f32_16x16x32_bf16 v[140:143], v[68:71], v[124:127], v[140:143]
s_add_u32 s71, s71, s66
ds_read_b64_tr_b16 v[94:95], v11 offset:9216
v_accvgpr_read_b32 v23, a246
v_mfma_f32_16x16x32_bf16 v[140:143], v[64:67], v[120:123], v[140:143]
s_waitcnt lgkmcnt(8)
v_accvgpr_read_b32 v31, a247
v_cvt_pk_bf16_f32 v20, v20, v28
v_mfma_f32_16x16x32_bf16 v[156:159], v[72:75], v[120:123], v[156:159]
s_add_u32 m0, s64, 32768
ds_read_b64_tr_b16 v[64:65], v12 offset:0
v_cvt_pk_bf16_f32 v21, v21, v29
v_mfma_f32_16x16x32_bf16 v[156:159], v[76:79], v[124:127], v[156:159]
s_add_u32 s72, s71, 0
buffer_load_dwordx4 v6, s[12:15], s72 offen lds
v_mfma_f32_16x16x32_bf16 v[152:155], v[76:79], v[116:119], v[152:155]
s_add_u32 s73, s62, 12
ds_read_b64_tr_b16 v[66:67], v12 offset:1024
v_cvt_pk_bf16_f32 v22, v22, v30
v_mfma_f32_16x16x32_bf16 v[152:155], v[72:75], v[112:115], v[152:155]
s_add_u32 s70, s73, s65
v_cvt_pk_bf16_f32 v23, v23, v31
v_mfma_f32_16x16x32_bf16 v[148:151], v[72:75], v[104:107], v[148:151]
s_and_b32 s70, s70, 3
ds_read_b64_tr_b16 v[68:69], v12 offset:8192
v_mfma_f32_16x16x32_bf16 v[148:151], v[76:79], v[108:111], v[148:151]
s_and_b32 s73, s73, 12
ds_read_b64_tr_b16 v[70:71], v12 offset:9216
v_mfma_f32_16x16x32_bf16 v[144:147], v[76:79], v[100:103], v[144:147]
s_add_u32 s72, s71, 31744
buffer_load_dwordx4 v6, s[12:15], s72 offen offset:1024 lds
v_mfma_f32_16x16x32_bf16 v[144:147], v[72:75], v[96:99], v[144:147]
s_waitcnt lgkmcnt(8)
v_mfma_f32_16x16x32_bf16 v[160:163], v[80:83], v[96:99], v[160:163]
s_or_b32 s73, s73, s70
ds_read_b64_tr_b16 v[72:73], v13 offset:0
v_mfma_f32_16x16x32_bf16 v[160:163], v[84:87], v[100:103], v[160:163]
s_lshl_b32 s73, s73, 7
ds_read_b64_tr_b16 v[74:75], v13 offset:1024
v_mfma_f32_16x16x32_bf16 v[164:167], v[84:87], v[108:111], v[164:167]
s_add_u32 s69, s73, s67
v_mfma_f32_16x16x32_bf16 v[164:167], v[80:83], v[104:107], v[164:167]
s_add_u32 s72, s71, 63488
buffer_load_dwordx4 v7, s[12:15], s72 offen offset:2048 lds
v_mfma_f32_16x16x32_bf16 v[168:171], v[80:83], v[112:115], v[168:171]
s_waitcnt vmcnt(18)
ds_read_b64_tr_b16 v[76:77], v13 offset:8192
v_mfma_f32_16x16x32_bf16 v[168:171], v[84:87], v[116:119], v[168:171]
s_add_u32 s70, s73, s68
ds_read_b128 v[32:35], v18 offset:0
v_mfma_f32_16x16x32_bf16 v[172:175], v[84:87], v[124:127], v[172:175]
s_add_u32 s80, s78, 35840
ds_read_b64_tr_b16 v[78:79], v13 offset:9216
v_mfma_f32_16x16x32_bf16 v[172:175], v[80:83], v[120:123], v[172:175]
s_waitcnt lgkmcnt(9)
ds_read_b128 v[36:39], v19 offset:0
v_accvgpr_read_b32 v24, a248
v_mfma_f32_16x16x32_bf16 v[188:191], v[88:91], v[120:123], v[188:191]
s_add_u32 s72, s71, 95232
buffer_load_dwordx4 v7, s[12:15], s72 offen offset:3072 lds
v_mfma_f32_16x16x32_bf16 v[188:191], v[92:95], v[124:127], v[188:191]
ds_read_b64_tr_b16 v[80:81], v14 offset:0
v_accvgpr_read_b32 v28, a249
v_mfma_f32_16x16x32_bf16 v[184:187], v[92:95], v[116:119], v[184:187]
ds_read_b64_tr_b16 v[82:83], v14 offset:1024
v_accvgpr_read_b32 v25, a250
v_mfma_f32_16x16x32_bf16 v[184:187], v[88:91], v[112:115], v[184:187]
buffer_store_dwordx4 v[20:23], v1, s[44:47], s80 offen sc1
v_mfma_f32_16x16x32_bf16 v[180:183], v[88:91], v[104:107], v[180:183]
ds_read_b64_tr_b16 v[84:85], v14 offset:8192
v_accvgpr_read_b32 v29, a251
v_mfma_f32_16x16x32_bf16 v[180:183], v[92:95], v[108:111], v[180:183]
s_add_u32 m0, s63, 131072
ds_read_b64_tr_b16 v[86:87], v14 offset:9216
v_accvgpr_read_b32 v26, a252
v_mfma_f32_16x16x32_bf16 v[176:179], v[92:95], v[100:103], v[176:179]
s_add_u32 s72, s69, 0
buffer_load_dwordx4 v4, s[4:7], s72 offen lds
v_mfma_f32_16x16x32_bf16 v[176:179], v[88:91], v[96:99], v[176:179]
s_waitcnt lgkmcnt(10)
ds_read_b128 v[40:43], v18 offset:2048
v_accvgpr_read_b32 v30, a253
v_mfma_f32_16x16x32_bf16 v[192:195], v[64:67], v[96:99], v[192:195]
ds_read_b64_tr_b16 v[88:89], v15 offset:0
v_accvgpr_read_b32 v27, a254
v_mfma_f32_16x16x32_bf16 v[192:195], v[68:71], v[100:103], v[192:195]
ds_read_b64_tr_b16 v[90:91], v15 offset:1024
v_accvgpr_read_b32 v31, a255
v_mfma_f32_16x16x32_bf16 v[196:199], v[68:71], v[108:111], v[196:199]
ds_read_b64_tr_b16 v[92:93], v15 offset:8192
v_cvt_pk_bf16_f32 v24, v24, v28
v_mfma_f32_16x16x32_bf16 v[196:199], v[64:67], v[104:107], v[196:199]
s_add_u32 s72, s69, 15360
buffer_load_dwordx4 v5, s[4:7], s72 offen offset:1024 lds
v_mfma_f32_16x16x32_bf16 v[200:203], v[64:67], v[112:115], v[200:203]
ds_read_b64_tr_b16 v[94:95], v15 offset:9216
v_cvt_pk_bf16_f32 v25, v25, v29
v_mfma_f32_16x16x32_bf16 v[200:203], v[68:71], v[116:119], v[200:203]
ds_read_b128 v[44:47], v19 offset:2048
v_cvt_pk_bf16_f32 v26, v26, v30
v_mfma_f32_16x16x32_bf16 v[204:207], v[68:71], v[124:127], v[204:207]
v_cvt_pk_bf16_f32 v27, v27, v31
v_mfma_f32_16x16x32_bf16 v[204:207], v[64:67], v[120:123], v[204:207]
s_waitcnt lgkmcnt(11)
ds_read_b128 v[48:51], v18 offset:4096
v_mfma_f32_16x16x32_bf16 v[220:223], v[72:75], v[120:123], v[220:223]
s_add_u32 s72, s69, 129024
buffer_load_dwordx4 v4, s[4:7], s72 offen offset:2048 lds
v_mfma_f32_16x16x32_bf16 v[220:223], v[76:79], v[124:127], v[220:223]
s_add_u32 s80, s78, 44032
ds_read_b128 v[52:55], v19 offset:4096
v_mfma_f32_16x16x32_bf16 v[216:219], v[76:79], v[116:119], v[216:219]
s_waitcnt vmcnt(19) lgkmcnt(3)
buffer_store_dwordx4 v[24:27], v1, s[44:47], s80 offen sc1
v_mfma_f32_16x16x32_bf16 v[216:219], v[72:75], v[112:115], v[216:219]
s_barrier
ds_read_b128 v[56:59], v18 offset:6144
v_mfma_f32_16x16x32_bf16 v[212:215], v[72:75], v[104:107], v[212:215]
ds_read_b64_tr_b16 v[64:65], v8 offset:16384
ds_read_b64_tr_b16 v[66:67], v8 offset:17408
v_mfma_f32_16x16x32_bf16 v[212:215], v[76:79], v[108:111], v[212:215]
ds_read_b64_tr_b16 v[68:69], v8 offset:24576
ds_read_b64_tr_b16 v[70:71], v8 offset:25600
v_mfma_f32_16x16x32_bf16 v[208:211], v[76:79], v[100:103], v[208:211]
s_add_u32 s72, s69, 144384
buffer_load_dwordx4 v5, s[4:7], s72 offen offset:3072 lds
v_mfma_f32_16x16x32_bf16 v[208:211], v[72:75], v[96:99], v[208:211]
v_and_b32 v2, 31, v0
v_lshlrev_b32 v2, 2, v2
v_mfma_f32_16x16x32_bf16 v[224:227], v[80:83], v[96:99], v[224:227]
buffer_load_dword v3, v2, s[48:51], 0 offen sc1
v_mfma_f32_16x16x32_bf16 v[224:227], v[84:87], v[100:103], v[224:227]
ds_read_b64_tr_b16 v[72:73], v9 offset:16384
v_mfma_f32_16x16x32_bf16 v[228:231], v[84:87], v[108:111], v[228:231]
s_add_u32 m0, s63, 135168
ds_read_b64_tr_b16 v[74:75], v9 offset:17408
v_mfma_f32_16x16x32_bf16 v[228:231], v[80:83], v[104:107], v[228:231]
s_add_u32 s72, s70, 0
buffer_load_dwordx4 v4, s[4:7], s72 offen lds
v_mfma_f32_16x16x32_bf16 v[232:235], v[80:83], v[112:115], v[232:235]
ds_read_b128 v[60:63], v19 offset:6144
v_mfma_f32_16x16x32_bf16 v[232:235], v[84:87], v[116:119], v[232:235]
ds_read_b64_tr_b16 v[76:77], v9 offset:24576
v_mfma_f32_16x16x32_bf16 v[236:239], v[84:87], v[124:127], v[236:239]
ds_read_b64_tr_b16 v[78:79], v9 offset:25600
v_mfma_f32_16x16x32_bf16 v[236:239], v[80:83], v[120:123], v[236:239]
v_mfma_f32_16x16x32_bf16 v[252:255], v[88:91], v[120:123], v[252:255]
s_add_u32 s72, s70, 15360
buffer_load_dwordx4 v5, s[4:7], s72 offen offset:1024 lds
v_mfma_f32_16x16x32_bf16 v[252:255], v[92:95], v[124:127], v[252:255]
ds_read_b64_tr_b16 v[80:81], v10 offset:16384
v_mfma_f32_16x16x32_bf16 v[248:251], v[92:95], v[116:119], v[248:251]
ds_read_b64_tr_b16 v[82:83], v10 offset:17408
v_mfma_f32_16x16x32_bf16 v[248:251], v[88:91], v[112:115], v[248:251]
v_mfma_f32_16x16x32_bf16 v[244:247], v[88:91], v[104:107], v[244:247]
ds_read_b64_tr_b16 v[84:85], v10 offset:24576
v_mfma_f32_16x16x32_bf16 v[244:247], v[92:95], v[108:111], v[244:247]
ds_read_b64_tr_b16 v[86:87], v10 offset:25600
v_mfma_f32_16x16x32_bf16 v[240:243], v[92:95], v[100:103], v[240:243]
s_add_u32 s72, s70, 129024
buffer_load_dwordx4 v4, s[4:7], s72 offen offset:2048 lds
v_mfma_f32_16x16x32_bf16 v[240:243], v[88:91], v[96:99], v[240:243]
s_waitcnt lgkmcnt(6)
v_mfma_f32_16x16x32_bf16 v[128:131], v[64:67], v[32:35], v[128:131]
ds_read_b64_tr_b16 v[88:89], v11 offset:16384
v_mfma_f32_16x16x32_bf16 v[128:131], v[68:71], v[36:39], v[128:131]
ds_read_b64_tr_b16 v[90:91], v11 offset:17408
v_mfma_f32_16x16x32_bf16 v[132:135], v[68:71], v[44:47], v[132:135]
v_mfma_f32_16x16x32_bf16 v[132:135], v[64:67], v[40:43], v[132:135]
s_add_u32 s72, s70, 144384
buffer_load_dwordx4 v5, s[4:7], s72 offen offset:3072 lds
v_mfma_f32_16x16x32_bf16 v[136:139], v[64:67], v[48:51], v[136:139]
ds_read_b64_tr_b16 v[92:93], v11 offset:24576
v_mfma_f32_16x16x32_bf16 v[136:139], v[68:71], v[52:55], v[136:139]
s_lshl_b32 s71, s73, 12
v_mfma_f32_16x16x32_bf16 v[140:143], v[68:71], v[60:63], v[140:143]
s_add_u32 s71, s71, s66
ds_read_b64_tr_b16 v[94:95], v11 offset:25600
v_mfma_f32_16x16x32_bf16 v[140:143], v[64:67], v[56:59], v[140:143]
s_waitcnt lgkmcnt(8)
v_mfma_f32_16x16x32_bf16 v[156:159], v[72:75], v[56:59], v[156:159]
s_add_u32 m0, s64, 0
ds_read_b64_tr_b16 v[64:65], v12 offset:16384
v_mfma_f32_16x16x32_bf16 v[156:159], v[76:79], v[60:63], v[156:159]
s_add_u32 s72, s71, 0
buffer_load_dwordx4 v6, s[12:15], s72 offen lds
v_mfma_f32_16x16x32_bf16 v[152:155], v[76:79], v[52:55], v[152:155]
s_add_u32 s73, s62, 13
ds_read_b64_tr_b16 v[66:67], v12 offset:17408
v_mfma_f32_16x16x32_bf16 v[152:155], v[72:75], v[48:51], v[152:155]
s_add_u32 s70, s73, s65
v_mfma_f32_16x16x32_bf16 v[148:151], v[72:75], v[40:43], v[148:151]
s_and_b32 s70, s70, 3
ds_read_b64_tr_b16 v[68:69], v12 offset:24576
v_mfma_f32_16x16x32_bf16 v[148:151], v[76:79], v[44:47], v[148:151]
s_and_b32 s73, s73, 12
ds_read_b64_tr_b16 v[70:71], v12 offset:25600
v_mfma_f32_16x16x32_bf16 v[144:147], v[76:79], v[36:39], v[144:147]
s_add_u32 s72, s71, 31744
buffer_load_dwordx4 v6, s[12:15], s72 offen offset:1024 lds
v_mfma_f32_16x16x32_bf16 v[144:147], v[72:75], v[32:35], v[144:147]
s_waitcnt lgkmcnt(8)
v_mfma_f32_16x16x32_bf16 v[160:163], v[80:83], v[32:35], v[160:163]
s_or_b32 s73, s73, s70
ds_read_b64_tr_b16 v[72:73], v13 offset:16384
v_mfma_f32_16x16x32_bf16 v[160:163], v[84:87], v[36:39], v[160:163]
s_lshl_b32 s73, s73, 7
ds_read_b64_tr_b16 v[74:75], v13 offset:17408
v_mfma_f32_16x16x32_bf16 v[164:167], v[84:87], v[44:47], v[164:167]
s_add_u32 s69, s73, s67
v_mfma_f32_16x16x32_bf16 v[164:167], v[80:83], v[40:43], v[164:167]
s_add_u32 s72, s71, 63488
buffer_load_dwordx4 v7, s[12:15], s72 offen offset:2048 lds
v_mfma_f32_16x16x32_bf16 v[168:171], v[80:83], v[48:51], v[168:171]
s_waitcnt vmcnt(18)
ds_read_b64_tr_b16 v[76:77], v13 offset:24576
v_mfma_f32_16x16x32_bf16 v[168:171], v[84:87], v[52:55], v[168:171]
s_add_u32 s70, s73, s68
ds_read_b128 v[96:99], v18 offset:32768
v_mfma_f32_16x16x32_bf16 v[172:175], v[84:87], v[60:63], v[172:175]
ds_read_b64_tr_b16 v[78:79], v13 offset:25600
v_mfma_f32_16x16x32_bf16 v[172:175], v[80:83], v[56:59], v[172:175]
s_waitcnt lgkmcnt(9)
ds_read_b128 v[100:103], v19 offset:32768
v_mfma_f32_16x16x32_bf16 v[188:191], v[88:91], v[56:59], v[188:191]
s_add_u32 s72, s71, 95232
buffer_load_dwordx4 v7, s[12:15], s72 offen offset:3072 lds
v_mfma_f32_16x16x32_bf16 v[188:191], v[92:95], v[60:63], v[188:191]
ds_read_b64_tr_b16 v[80:81], v14 offset:16384
v_mfma_f32_16x16x32_bf16 v[184:187], v[92:95], v[52:55], v[184:187]
ds_read_b64_tr_b16 v[82:83], v14 offset:17408
v_mfma_f32_16x16x32_bf16 v[184:187], v[88:91], v[48:51], v[184:187]
v_mfma_f32_16x16x32_bf16 v[180:183], v[88:91], v[40:43], v[180:183]
ds_read_b64_tr_b16 v[84:85], v14 offset:24576
v_mfma_f32_16x16x32_bf16 v[180:183], v[92:95], v[44:47], v[180:183]
s_add_u32 m0, s63, 65536
ds_read_b64_tr_b16 v[86:87], v14 offset:25600
v_mfma_f32_16x16x32_bf16 v[176:179], v[92:95], v[36:39], v[176:179]
s_add_u32 s72, s69, 0
buffer_load_dwordx4 v4, s[4:7], s72 offen lds
v_mfma_f32_16x16x32_bf16 v[176:179], v[88:91], v[32:35], v[176:179]
s_waitcnt lgkmcnt(10)
ds_read_b128 v[104:107], v18 offset:34816
v_mfma_f32_16x16x32_bf16 v[192:195], v[64:67], v[32:35], v[192:195]
ds_read_b64_tr_b16 v[88:89], v15 offset:16384
v_mfma_f32_16x16x32_bf16 v[192:195], v[68:71], v[36:39], v[192:195]
ds_read_b64_tr_b16 v[90:91], v15 offset:17408
v_mfma_f32_16x16x32_bf16 v[196:199], v[68:71], v[44:47], v[196:199]
ds_read_b64_tr_b16 v[92:93], v15 offset:24576
v_mfma_f32_16x16x32_bf16 v[196:199], v[64:67], v[40:43], v[196:199]
s_add_u32 s72, s69, 15360
buffer_load_dwordx4 v5, s[4:7], s72 offen offset:1024 lds
v_mfma_f32_16x16x32_bf16 v[200:203], v[64:67], v[48:51], v[200:203]
ds_read_b64_tr_b16 v[94:95], v15 offset:25600
v_mfma_f32_16x16x32_bf16 v[200:203], v[68:71], v[52:55], v[200:203]
ds_read_b128 v[108:111], v19 offset:34816
v_mfma_f32_16x16x32_bf16 v[204:207], v[68:71], v[60:63], v[204:207]
v_mfma_f32_16x16x32_bf16 v[204:207], v[64:67], v[56:59], v[204:207]
s_waitcnt lgkmcnt(11)
ds_read_b128 v[112:115], v18 offset:36864
v_mfma_f32_16x16x32_bf16 v[220:223], v[72:75], v[56:59], v[220:223]
s_add_u32 s72, s69, 129024
buffer_load_dwordx4 v4, s[4:7], s72 offen offset:2048 lds
v_mfma_f32_16x16x32_bf16 v[220:223], v[76:79], v[60:63], v[220:223]
v_mfma_f32_16x16x32_bf16 v[216:219], v[76:79], v[52:55], v[216:219]
s_waitcnt vmcnt(13) lgkmcnt(2)
ds_read_b128 v[116:119], v19 offset:36864
v_mfma_f32_16x16x32_bf16 v[216:219], v[72:75], v[48:51], v[216:219]
s_barrier
ds_read_b128 v[120:123], v18 offset:38912
v_mfma_f32_16x16x32_bf16 v[212:215], v[72:75], v[40:43], v[212:215]
ds_read_b64_tr_b16 v[64:65], v8 offset:32768
ds_read_b64_tr_b16 v[66:67], v8 offset:33792
v_mfma_f32_16x16x32_bf16 v[212:215], v[76:79], v[44:47], v[212:215]
ds_read_b64_tr_b16 v[68:69], v8 offset:40960
v_or_b32 v20, s58, v0
v_mfma_f32_16x16x32_bf16 v[208:211], v[76:79], v[36:39], v[208:211]
s_add_u32 s72, s69, 144384
buffer_load_dwordx4 v5, s[4:7], s72 offen offset:3072 lds
v_mfma_f32_16x16x32_bf16 v[208:211], v[72:75], v[32:35], v[208:211]
ds_read_b64_tr_b16 v[70:71], v8 offset:41984
v_mov_b32 v21, 1
v_mfma_f32_16x16x32_bf16 v[224:227], v[80:83], v[32:35], v[224:227]
ds_read_b64_tr_b16 v[72:73], v9 offset:32768
v_min_u32 v20, 1, v20
v_mfma_f32_16x16x32_bf16 v[224:227], v[84:87], v[36:39], v[224:227]
ds_read_b64_tr_b16 v[74:75], v9 offset:33792
v_lshlrev_b32 v20, 30, v20
v_mfma_f32_16x16x32_bf16 v[228:231], v[84:87], v[44:47], v[228:231]
s_add_u32 m0, s63, 69632
buffer_store_dword v21, v20, s[44:47], s91 offen sc1
v_mfma_f32_16x16x32_bf16 v[228:231], v[80:83], v[40:43], v[228:231]
s_add_u32 s72, s70, 0
buffer_load_dwordx4 v4, s[4:7], s72 offen lds
v_mfma_f32_16x16x32_bf16 v[232:235], v[80:83], v[48:51], v[232:235]
ds_read_b64_tr_b16 v[76:77], v9 offset:40960
v_accvgpr_write_b32 a32, 0
v_mfma_f32_16x16x32_bf16 v[232:235], v[84:87], v[52:55], v[232:235]
ds_read_b128 v[124:127], v19 offset:38912
v_accvgpr_write_b32 a33, 0
v_mfma_f32_16x16x32_bf16 v[236:239], v[84:87], v[60:63], v[236:239]
ds_read_b64_tr_b16 v[78:79], v9 offset:41984
v_accvgpr_write_b32 a34, 0
v_mfma_f32_16x16x32_bf16 v[236:239], v[80:83], v[56:59], v[236:239]
v_accvgpr_write_b32 a35, 0
v_accvgpr_write_b32 a36, 0
v_mfma_f32_16x16x32_bf16 v[252:255], v[88:91], v[56:59], v[252:255]
s_add_u32 s72, s70, 15360
buffer_load_dwordx4 v5, s[4:7], s72 offen offset:1024 lds
v_mfma_f32_16x16x32_bf16 v[252:255], v[92:95], v[60:63], v[252:255]
ds_read_b64_tr_b16 v[80:81], v10 offset:32768
v_accvgpr_write_b32 a37, 0
v_mfma_f32_16x16x32_bf16 v[248:251], v[92:95], v[52:55], v[248:251]
ds_read_b64_tr_b16 v[82:83], v10 offset:33792
v_accvgpr_write_b32 a38, 0
v_mfma_f32_16x16x32_bf16 v[248:251], v[88:91], v[48:51], v[248:251]
v_accvgpr_write_b32 a39, 0
v_accvgpr_write_b32 a40, 0
v_mfma_f32_16x16x32_bf16 v[244:247], v[88:91], v[40:43], v[244:247]
ds_read_b64_tr_b16 v[84:85], v10 offset:40960
v_accvgpr_write_b32 a41, 0
v_mfma_f32_16x16x32_bf16 v[244:247], v[92:95], v[44:47], v[244:247]
ds_read_b64_tr_b16 v[86:87], v10 offset:41984
v_accvgpr_write_b32 a42, 0
v_mfma_f32_16x16x32_bf16 v[240:243], v[92:95], v[36:39], v[240:243]
s_add_u32 s72, s70, 129024
buffer_load_dwordx4 v4, s[4:7], s72 offen offset:2048 lds
v_mfma_f32_16x16x32_bf16 v[240:243], v[88:91], v[32:35], v[240:243]
s_waitcnt lgkmcnt(5)
v_accvgpr_write_b32 a43, 0
v_accvgpr_write_b32 a44, 0
v_mfma_f32_16x16x32_bf16 v[128:131], v[64:67], v[96:99], v[128:131]
ds_read_b64_tr_b16 v[88:89], v11 offset:32768
v_accvgpr_write_b32 a45, 0
v_mfma_f32_16x16x32_bf16 v[128:131], v[68:71], v[100:103], v[128:131]
ds_read_b64_tr_b16 v[90:91], v11 offset:33792
v_accvgpr_write_b32 a46, 0
v_mfma_f32_16x16x32_bf16 v[132:135], v[68:71], v[108:111], v[132:135]
v_accvgpr_write_b32 a47, 0
v_accvgpr_write_b32 a48, 0
v_mfma_f32_16x16x32_bf16 v[132:135], v[64:67], v[104:107], v[132:135]
s_add_u32 s72, s70, 144384
buffer_load_dwordx4 v5, s[4:7], s72 offen offset:3072 lds
v_mfma_f32_16x16x32_bf16 v[136:139], v[64:67], v[112:115], v[136:139]
ds_read_b64_tr_b16 v[92:93], v11 offset:40960
v_accvgpr_write_b32 a49, 0
v_mfma_f32_16x16x32_bf16 v[136:139], v[68:71], v[116:119], v[136:139]
s_lshl_b32 s71, s73, 12
v_accvgpr_write_b32 a50, 0
v_accvgpr_write_b32 a51, 0
v_mfma_f32_16x16x32_bf16 v[140:143], v[68:71], v[124:127], v[140:143]
s_add_u32 s71, s71, s66
ds_read_b64_tr_b16 v[94:95], v11 offset:41984
v_accvgpr_write_b32 a52, 0
v_mfma_f32_16x16x32_bf16 v[140:143], v[64:67], v[120:123], v[140:143]
s_waitcnt lgkmcnt(8)
v_accvgpr_write_b32 a53, 0
v_accvgpr_write_b32 a54, 0
v_mfma_f32_16x16x32_bf16 v[156:159], v[72:75], v[120:123], v[156:159]
s_add_u32 m0, s64, 16384
ds_read_b64_tr_b16 v[64:65], v12 offset:32768
v_accvgpr_write_b32 a55, 0
v_mfma_f32_16x16x32_bf16 v[156:159], v[76:79], v[124:127], v[156:159]
s_add_u32 s72, s71, 0
buffer_load_dwordx4 v6, s[12:15], s72 offen lds
v_mfma_f32_16x16x32_bf16 v[152:155], v[76:79], v[116:119], v[152:155]
s_add_u32 s73, s62, 14
ds_read_b64_tr_b16 v[66:67], v12 offset:33792
v_accvgpr_write_b32 a56, 0
v_mfma_f32_16x16x32_bf16 v[152:155], v[72:75], v[112:115], v[152:155]
s_add_u32 s70, s73, s65
v_accvgpr_write_b32 a57, 0
v_accvgpr_write_b32 a58, 0
v_mfma_f32_16x16x32_bf16 v[148:151], v[72:75], v[104:107], v[148:151]
s_and_b32 s70, s70, 3
ds_read_b64_tr_b16 v[68:69], v12 offset:40960
v_accvgpr_write_b32 a59, 0
v_mfma_f32_16x16x32_bf16 v[148:151], v[76:79], v[108:111], v[148:151]
s_and_b32 s73, s73, 12
ds_read_b64_tr_b16 v[70:71], v12 offset:41984
v_accvgpr_write_b32 a60, 0
v_mfma_f32_16x16x32_bf16 v[144:147], v[76:79], v[100:103], v[144:147]
s_add_u32 s72, s71, 31744
buffer_load_dwordx4 v6, s[12:15], s72 offen offset:1024 lds
v_mfma_f32_16x16x32_bf16 v[144:147], v[72:75], v[96:99], v[144:147]
s_waitcnt lgkmcnt(8)
v_accvgpr_write_b32 a61, 0
v_accvgpr_write_b32 a62, 0
v_mfma_f32_16x16x32_bf16 v[160:163], v[80:83], v[96:99], v[160:163]
s_or_b32 s73, s73, s70
ds_read_b64_tr_b16 v[72:73], v13 offset:32768
v_accvgpr_write_b32 a63, 0
v_mfma_f32_16x16x32_bf16 v[160:163], v[84:87], v[100:103], v[160:163]
s_lshl_b32 s73, s73, 7
ds_read_b64_tr_b16 v[74:75], v13 offset:33792
v_accvgpr_write_b32 a96, 0
v_mfma_f32_16x16x32_bf16 v[164:167], v[84:87], v[108:111], v[164:167]
s_add_u32 s69, s73, s67
v_accvgpr_write_b32 a97, 0
v_accvgpr_write_b32 a98, 0
v_mfma_f32_16x16x32_bf16 v[164:167], v[80:83], v[104:107], v[164:167]
s_add_u32 s72, s71, 63488
buffer_load_dwordx4 v7, s[12:15], s72 offen offset:2048 lds
v_mfma_f32_16x16x32_bf16 v[168:171], v[80:83], v[112:115], v[168:171]
s_waitcnt vmcnt(16)
ds_read_b64_tr_b16 v[76:77], v13 offset:40960
v_accvgpr_write_b32 a99, 0
v_mfma_f32_16x16x32_bf16 v[168:171], v[84:87], v[116:119], v[168:171]
s_add_u32 s70, s73, s68
ds_read_b128 v[32:35], v16 offset:0
v_accvgpr_write_b32 a100, 0
v_mfma_f32_16x16x32_bf16 v[172:175], v[84:87], v[124:127], v[172:175]
ds_read_b64_tr_b16 v[78:79], v13 offset:41984
v_accvgpr_write_b32 a101, 0
v_mfma_f32_16x16x32_bf16 v[172:175], v[80:83], v[120:123], v[172:175]
s_waitcnt lgkmcnt(9)
ds_read_b128 v[36:39], v17 offset:0
v_accvgpr_write_b32 a102, 0
v_mfma_f32_16x16x32_bf16 v[188:191], v[88:91], v[120:123], v[188:191]
s_add_u32 s72, s71, 95232
buffer_load_dwordx4 v7, s[12:15], s72 offen offset:3072 lds
v_mfma_f32_16x16x32_bf16 v[188:191], v[92:95], v[124:127], v[188:191]
ds_read_b64_tr_b16 v[80:81], v14 offset:32768
v_accvgpr_write_b32 a103, 0
v_mfma_f32_16x16x32_bf16 v[184:187], v[92:95], v[116:119], v[184:187]
ds_read_b64_tr_b16 v[82:83], v14 offset:33792
v_accvgpr_write_b32 a104, 0
v_mfma_f32_16x16x32_bf16 v[184:187], v[88:91], v[112:115], v[184:187]
v_accvgpr_write_b32 a105, 0
v_accvgpr_write_b32 a106, 0
v_mfma_f32_16x16x32_bf16 v[180:183], v[88:91], v[104:107], v[180:183]
ds_read_b64_tr_b16 v[84:85], v14 offset:40960
v_accvgpr_write_b32 a107, 0
v_mfma_f32_16x16x32_bf16 v[180:183], v[92:95], v[108:111], v[180:183]
s_add_u32 m0, s63, 98304
ds_read_b64_tr_b16 v[86:87], v14 offset:41984
v_accvgpr_write_b32 a108, 0
v_mfma_f32_16x16x32_bf16 v[176:179], v[92:95], v[100:103], v[176:179]
s_add_u32 s72, s69, 0
buffer_load_dwordx4 v4, s[4:7], s72 offen lds
v_mfma_f32_16x16x32_bf16 v[176:179], v[88:91], v[96:99], v[176:179]
s_waitcnt lgkmcnt(10)
ds_read_b128 v[40:43], v16 offset:2048
v_accvgpr_write_b32 a109, 0
v_mfma_f32_16x16x32_bf16 v[192:195], v[64:67], v[96:99], v[192:195]
ds_read_b64_tr_b16 v[88:89], v15 offset:32768
v_accvgpr_write_b32 a110, 0
v_mfma_f32_16x16x32_bf16 v[192:195], v[68:71], v[100:103], v[192:195]
ds_read_b64_tr_b16 v[90:91], v15 offset:33792
v_accvgpr_write_b32 a111, 0
v_mfma_f32_16x16x32_bf16 v[196:199], v[68:71], v[108:111], v[196:199]
ds_read_b64_tr_b16 v[92:93], v15 offset:40960
v_accvgpr_write_b32 a112, 0
v_mfma_f32_16x16x32_bf16 v[196:199], v[64:67], v[104:107], v[196:199]
s_add_u32 s72, s69, 15360
buffer_load_dwordx4 v5, s[4:7], s72 offen offset:1024 lds
v_mfma_f32_16x16x32_bf16 v[200:203], v[64:67], v[112:115], v[200:203]
ds_read_b64_tr_b16 v[94:95], v15 offset:41984
v_accvgpr_write_b32 a113, 0
v_mfma_f32_16x16x32_bf16 v[200:203], v[68:71], v[116:119], v[200:203]
ds_read_b128 v[44:47], v17 offset:2048
v_accvgpr_write_b32 a114, 0
v_mfma_f32_16x16x32_bf16 v[204:207], v[68:71], v[124:127], v[204:207]
v_accvgpr_write_b32 a115, 0
v_accvgpr_write_b32 a116, 0
v_mfma_f32_16x16x32_bf16 v[204:207], v[64:67], v[120:123], v[204:207]
s_waitcnt lgkmcnt(11)
ds_read_b128 v[48:51], v16 offset:4096
v_accvgpr_write_b32 a117, 0
v_mfma_f32_16x16x32_bf16 v[220:223], v[72:75], v[120:123], v[220:223]
s_add_u32 s72, s69, 129024
buffer_load_dwordx4 v4, s[4:7], s72 offen offset:2048 lds
v_mfma_f32_16x16x32_bf16 v[220:223], v[76:79], v[124:127], v[220:223]
v_accvgpr_write_b32 a118, 0
v_accvgpr_write_b32 a119, 0
v_mfma_f32_16x16x32_bf16 v[216:219], v[76:79], v[116:119], v[216:219]
s_waitcnt vmcnt(16) lgkmcnt(2)
ds_read_b128 v[52:55], v17 offset:4096
v_accvgpr_write_b32 a120, 0
v_mfma_f32_16x16x32_bf16 v[216:219], v[72:75], v[112:115], v[216:219]
s_barrier
ds_read_b128 v[56:59], v16 offset:6144
v_accvgpr_write_b32 a121, 0
v_mfma_f32_16x16x32_bf16 v[212:215], v[72:75], v[104:107], v[212:215]
s_waitcnt vmcnt(24)
v_cmp_gt_u32 vcc, 8, v3
s_cbranch_vccnz Lspin1
Lback2:
v_mfma_f32_16x16x32_bf16 v[212:215], v[76:79], v[108:111], v[212:215]
ds_read_b64_tr_b16 v[64:65], v8 offset:0
ds_read_b64_tr_b16 v[66:67], v8 offset:1024
v_mfma_f32_16x16x32_bf16 v[208:211], v[76:79], v[100:103], v[208:211]
s_add_u32 s72, s69, 144384
buffer_load_dwordx4 v5, s[4:7], s72 offen offset:3072 lds
v_mfma_f32_16x16x32_bf16 v[208:211], v[72:75], v[96:99], v[208:211]
ds_read_b64_tr_b16 v[68:69], v8 offset:8192
ds_read_b64_tr_b16 v[70:71], v8 offset:9216
v_mfma_f32_16x16x32_bf16 v[224:227], v[80:83], v[96:99], v[224:227]
ds_read_b64_tr_b16 v[72:73], v9 offset:0
v_accvgpr_write_b32 a122, 0
v_mfma_f32_16x16x32_bf16 v[224:227], v[84:87], v[100:103], v[224:227]
ds_read_b64_tr_b16 v[74:75], v9 offset:1024
v_accvgpr_write_b32 a123, 0
v_mfma_f32_16x16x32_bf16 v[228:231], v[84:87], v[108:111], v[228:231]
s_add_u32 m0, s63, 102400
v_accvgpr_write_b32 a124, 0
v_accvgpr_write_b32 a125, 0
v_mfma_f32_16x16x32_bf16 v[228:231], v[80:83], v[104:107], v[228:231]
s_add_u32 s72, s70, 0
buffer_load_dwordx4 v4, s[4:7], s72 offen lds
v_mfma_f32_16x16x32_bf16 v[232:235], v[80:83], v[112:115], v[232:235]
ds_read_b64_tr_b16 v[76:77], v9 offset:8192
v_accvgpr_write_b32 a126, 0
v_mfma_f32_16x16x32_bf16 v[232:235], v[84:87], v[116:119], v[232:235]
ds_read_b128 v[60:63], v17 offset:6144
v_accvgpr_write_b32 a127, 0
v_mfma_f32_16x16x32_bf16 v[236:239], v[84:87], v[124:127], v[236:239]
ds_read_b64_tr_b16 v[78:79], v9 offset:9216
v_mfma_f32_16x16x32_bf16 v[236:239], v[80:83], v[120:123], v[236:239]
v_mfma_f32_16x16x32_bf16 v[252:255], v[88:91], v[120:123], v[252:255]
s_add_u32 s72, s70, 15360
buffer_load_dwordx4 v5, s[4:7], s72 offen offset:1024 lds
v_mfma_f32_16x16x32_bf16 v[252:255], v[92:95], v[124:127], v[252:255]
ds_read_b64_tr_b16 v[80:81], v10 offset:0
v_mfma_f32_16x16x32_bf16 v[248:251], v[92:95], v[116:119], v[248:251]
ds_read_b64_tr_b16 v[82:83], v10 offset:1024
v_mfma_f32_16x16x32_bf16 v[248:251], v[88:91], v[112:115], v[248:251]
v_mfma_f32_16x16x32_bf16 v[244:247], v[88:91], v[104:107], v[244:247]
ds_read_b64_tr_b16 v[84:85], v10 offset:8192
v_mfma_f32_16x16x32_bf16 v[244:247], v[92:95], v[108:111], v[244:247]
ds_read_b64_tr_b16 v[86:87], v10 offset:9216
v_mfma_f32_16x16x32_bf16 v[240:243], v[92:95], v[100:103], v[240:243]
s_add_u32 s72, s70, 129024
buffer_load_dwordx4 v4, s[4:7], s72 offen offset:2048 lds
v_mfma_f32_16x16x32_bf16 v[240:243], v[88:91], v[96:99], v[240:243]
s_waitcnt lgkmcnt(5)
v_mfma_f32_16x16x32_bf16 v[128:131], v[64:67], v[32:35], v[128:131]
ds_read_b64_tr_b16 v[88:89], v11 offset:0
v_mfma_f32_16x16x32_bf16 v[128:131], v[68:71], v[36:39], v[128:131]
ds_read_b64_tr_b16 v[90:91], v11 offset:1024
v_mfma_f32_16x16x32_bf16 v[132:135], v[68:71], v[44:47], v[132:135]
v_mfma_f32_16x16x32_bf16 v[132:135], v[64:67], v[40:43], v[132:135]
s_add_u32 s72, s70, 144384
buffer_load_dwordx4 v5, s[4:7], s72 offen offset:3072 lds
v_mfma_f32_16x16x32_bf16 v[136:139], v[64:67], v[48:51], v[136:139]
ds_read_b64_tr_b16 v[92:93], v11 offset:8192
v_mfma_f32_16x16x32_bf16 v[136:139], v[68:71], v[52:55], v[136:139]
s_lshl_b32 s71, s73, 12
v_mfma_f32_16x16x32_bf16 v[140:143], v[68:71], v[60:63], v[140:143]
s_add_u32 s71, s71, s66
ds_read_b64_tr_b16 v[94:95], v11 offset:9216
v_mfma_f32_16x16x32_bf16 v[140:143], v[64:67], v[56:59], v[140:143]
s_waitcnt lgkmcnt(8)
v_mfma_f32_16x16x32_bf16 v[156:159], v[72:75], v[56:59], v[156:159]
s_add_u32 m0, s64, 32768
ds_read_b64_tr_b16 v[64:65], v12 offset:0
v_mfma_f32_16x16x32_bf16 v[156:159], v[76:79], v[60:63], v[156:159]
s_add_u32 s72, s71, 0
buffer_load_dwordx4 v6, s[12:15], s72 offen lds
v_mfma_f32_16x16x32_bf16 v[152:155], v[76:79], v[52:55], v[152:155]
s_add_u32 s73, s62, 15
ds_read_b64_tr_b16 v[66:67], v12 offset:1024
v_mfma_f32_16x16x32_bf16 v[152:155], v[72:75], v[48:51], v[152:155]
s_add_u32 s70, s73, s65
v_mfma_f32_16x16x32_bf16 v[148:151], v[72:75], v[40:43], v[148:151]
s_and_b32 s70, s70, 3
ds_read_b64_tr_b16 v[68:69], v12 offset:8192
v_mfma_f32_16x16x32_bf16 v[148:151], v[76:79], v[44:47], v[148:151]
s_and_b32 s73, s73, 12
ds_read_b64_tr_b16 v[70:71], v12 offset:9216
v_mfma_f32_16x16x32_bf16 v[144:147], v[76:79], v[36:39], v[144:147]
s_add_u32 s72, s71, 31744
buffer_load_dwordx4 v6, s[12:15], s72 offen offset:1024 lds
v_mfma_f32_16x16x32_bf16 v[144:147], v[72:75], v[32:35], v[144:147]
s_waitcnt lgkmcnt(8)
v_mfma_f32_16x16x32_bf16 v[160:163], v[80:83], v[32:35], v[160:163]
s_or_b32 s73, s73, s70
ds_read_b64_tr_b16 v[72:73], v13 offset:0
v_mfma_f32_16x16x32_bf16 v[160:163], v[84:87], v[36:39], v[160:163]
s_lshl_b32 s73, s73, 7
ds_read_b64_tr_b16 v[74:75], v13 offset:1024
v_mfma_f32_16x16x32_bf16 v[164:167], v[84:87], v[44:47], v[164:167]
s_add_u32 s69, s73, s67
v_mfma_f32_16x16x32_bf16 v[164:167], v[80:83], v[40:43], v[164:167]
s_add_u32 s72, s71, 63488
buffer_load_dwordx4 v7, s[12:15], s72 offen offset:2048 lds
v_mfma_f32_16x16x32_bf16 v[168:171], v[80:83], v[48:51], v[168:171]
s_waitcnt vmcnt(15)
ds_read_b64_tr_b16 v[76:77], v13 offset:8192
v_mfma_f32_16x16x32_bf16 v[168:171], v[84:87], v[52:55], v[168:171]
s_add_u32 s70, s73, s68
ds_read_b128 v[96:99], v18 offset:0
v_mfma_f32_16x16x32_bf16 v[172:175], v[84:87], v[60:63], v[172:175]
ds_read_b64_tr_b16 v[78:79], v13 offset:9216
v_mfma_f32_16x16x32_bf16 v[172:175], v[80:83], v[56:59], v[172:175]
s_waitcnt lgkmcnt(9)
ds_read_b128 v[100:103], v19 offset:0
v_mfma_f32_16x16x32_bf16 v[188:191], v[88:91], v[56:59], v[188:191]
s_add_u32 s72, s71, 95232
buffer_load_dwordx4 v7, s[12:15], s72 offen offset:3072 lds
v_mfma_f32_16x16x32_bf16 v[188:191], v[92:95], v[60:63], v[188:191]
ds_read_b64_tr_b16 v[80:81], v14 offset:0
v_mfma_f32_16x16x32_bf16 v[184:187], v[92:95], v[52:55], v[184:187]
ds_read_b64_tr_b16 v[82:83], v14 offset:1024
v_mfma_f32_16x16x32_bf16 v[184:187], v[88:91], v[48:51], v[184:187]
v_mfma_f32_16x16x32_bf16 v[180:183], v[88:91], v[40:43], v[180:183]
ds_read_b64_tr_b16 v[84:85], v14 offset:8192
v_mfma_f32_16x16x32_bf16 v[180:183], v[92:95], v[44:47], v[180:183]
s_add_u32 m0, s63, 131072
ds_read_b64_tr_b16 v[86:87], v14 offset:9216
v_mfma_f32_16x16x32_bf16 v[176:179], v[92:95], v[36:39], v[176:179]
s_add_u32 s72, s69, 0
buffer_load_dwordx4 v4, s[4:7], s72 offen lds
v_mfma_f32_16x16x32_bf16 v[176:179], v[88:91], v[32:35], v[176:179]
s_waitcnt lgkmcnt(10)
ds_read_b128 v[104:107], v18 offset:2048
v_mfma_f32_16x16x32_bf16 v[192:195], v[64:67], v[32:35], v[192:195]
ds_read_b64_tr_b16 v[88:89], v15 offset:0
ds_read_b64_tr_b16 v[90:91], v15 offset:1024
v_mfma_f32_16x16x32_bf16 v[192:195], v[68:71], v[36:39], v[192:195]
ds_read_b64_tr_b16 v[92:93], v15 offset:8192
v_mfma_f32_16x16x32_bf16 v[196:199], v[68:71], v[44:47], v[196:199]
s_and_b32 s75, s91, 0xfffffc7f
v_lshrrev_b32 v2, 3, v0
v_lshlrev_b32 v2, 7, v2
v_mfma_f32_16x16x32_bf16 v[196:199], v[64:67], v[40:43], v[196:199]
s_add_u32 s72, s69, 15360
buffer_load_dwordx4 v5, s[4:7], s72 offen offset:1024 lds
v_mfma_f32_16x16x32_bf16 v[200:203], v[64:67], v[48:51], v[200:203]
buffer_load_dword v3, v2, s[44:47], s75 offen sc1
v_mfma_f32_16x16x32_bf16 v[200:203], v[68:71], v[52:55], v[200:203]
ds_read_b64_tr_b16 v[94:95], v15 offset:9216
v_mfma_f32_16x16x32_bf16 v[204:207], v[68:71], v[60:63], v[204:207]
ds_read_b128 v[108:111], v19 offset:2048
v_mfma_f32_16x16x32_bf16 v[204:207], v[64:67], v[56:59], v[204:207]
s_waitcnt lgkmcnt(11)
v_mfma_f32_16x16x32_bf16 v[220:223], v[72:75], v[56:59], v[220:223]
s_add_u32 s72, s69, 129024
buffer_load_dwordx4 v4, s[4:7], s72 offen offset:2048 lds
v_mfma_f32_16x16x32_bf16 v[220:223], v[76:79], v[60:63], v[220:223]
ds_read_b128 v[112:115], v18 offset:4096
v_mfma_f32_16x16x32_bf16 v[216:219], v[76:79], v[52:55], v[216:219]
s_waitcnt vmcnt(16) lgkmcnt(2)
ds_read_b128 v[116:119], v19 offset:4096
v_mfma_f32_16x16x32_bf16 v[216:219], v[72:75], v[48:51], v[216:219]
s_barrier
v_mfma_f32_16x16x32_bf16 v[212:215], v[72:75], v[40:43], v[212:215]
ds_read_b64_tr_b16 v[64:65], v8 offset:16384
ds_read_b64_tr_b16 v[66:67], v8 offset:17408
v_mfma_f32_16x16x32_bf16 v[212:215], v[76:79], v[44:47], v[212:215]
ds_read_b64_tr_b16 v[68:69], v8 offset:24576
v_mfma_f32_16x16x32_bf16 v[208:211], v[76:79], v[36:39], v[208:211]
s_add_u32 s72, s69, 144384
buffer_load_dwordx4 v5, s[4:7], s72 offen offset:3072 lds
v_mfma_f32_16x16x32_bf16 v[208:211], v[72:75], v[32:35], v[208:211]
ds_read_b64_tr_b16 v[70:71], v8 offset:25600
v_mfma_f32_16x16x32_bf16 v[224:227], v[80:83], v[32:35], v[224:227]
ds_read_b64_tr_b16 v[72:73], v9 offset:16384
v_mfma_f32_16x16x32_bf16 v[224:227], v[84:87], v[36:39], v[224:227]
ds_read_b64_tr_b16 v[74:75], v9 offset:17408
v_mfma_f32_16x16x32_bf16 v[228:231], v[84:87], v[44:47], v[228:231]
s_add_u32 m0, s63, 135168
ds_read_b128 v[120:123], v18 offset:6144
v_mfma_f32_16x16x32_bf16 v[228:231], v[80:83], v[40:43], v[228:231]
s_add_u32 s72, s70, 0
buffer_load_dwordx4 v4, s[4:7], s72 offen lds
v_mfma_f32_16x16x32_bf16 v[232:235], v[80:83], v[48:51], v[232:235]
ds_read_b64_tr_b16 v[76:77], v9 offset:24576
v_mfma_f32_16x16x32_bf16 v[232:235], v[84:87], v[52:55], v[232:235]
ds_read_b128 v[124:127], v19 offset:6144
v_mfma_f32_16x16x32_bf16 v[236:239], v[84:87], v[60:63], v[236:239]
ds_read_b64_tr_b16 v[78:79], v9 offset:25600
v_mfma_f32_16x16x32_bf16 v[236:239], v[80:83], v[56:59], v[236:239]
v_mfma_f32_16x16x32_bf16 v[252:255], v[88:91], v[56:59], v[252:255]
s_add_u32 s72, s70, 15360
buffer_load_dwordx4 v5, s[4:7], s72 offen offset:1024 lds
v_mfma_f32_16x16x32_bf16 v[252:255], v[92:95], v[60:63], v[252:255]
ds_read_b64_tr_b16 v[80:81], v10 offset:16384
v_mfma_f32_16x16x32_bf16 v[248:251], v[92:95], v[52:55], v[248:251]
ds_read_b64_tr_b16 v[82:83], v10 offset:17408
v_mfma_f32_16x16x32_bf16 v[248:251], v[88:91], v[48:51], v[248:251]
v_mfma_f32_16x16x32_bf16 v[244:247], v[88:91], v[40:43], v[244:247]
ds_read_b64_tr_b16 v[84:85], v10 offset:24576
v_mfma_f32_16x16x32_bf16 v[244:247], v[92:95], v[44:47], v[244:247]
ds_read_b64_tr_b16 v[86:87], v10 offset:25600
v_mfma_f32_16x16x32_bf16 v[240:243], v[92:95], v[36:39], v[240:243]
s_add_u32 s72, s70, 129024
buffer_load_dwordx4 v4, s[4:7], s72 offen offset:2048 lds
v_mfma_f32_16x16x32_bf16 v[240:243], v[88:91], v[32:35], v[240:243]
s_waitcnt lgkmcnt(5)
v_mfma_f32_16x16x32_bf16 v[128:131], v[64:67], v[96:99], v[128:131]
ds_read_b64_tr_b16 v[88:89], v11 offset:16384
v_mfma_f32_16x16x32_bf16 v[128:131], v[68:71], v[100:103], v[128:131]
ds_read_b64_tr_b16 v[90:91], v11 offset:17408
v_mfma_f32_16x16x32_bf16 v[132:135], v[68:71], v[108:111], v[132:135]
v_mfma_f32_16x16x32_bf16 v[132:135], v[64:67], v[104:107], v[132:135]
s_add_u32 s72, s70, 144384
buffer_load_dwordx4 v5, s[4:7], s72 offen offset:3072 lds
v_mfma_f32_16x16x32_bf16 v[136:139], v[64:67], v[112:115], v[136:139]
ds_read_b64_tr_b16 v[92:93], v11 offset:24576
v_mfma_f32_16x16x32_bf16 v[136:139], v[68:71], v[116:119], v[136:139]
s_lshl_b32 s71, s73, 12
v_mfma_f32_16x16x32_bf16 v[140:143], v[68:71], v[124:127], v[140:143]
s_add_u32 s71, s71, s66
ds_read_b64_tr_b16 v[94:95], v11 offset:25600
v_mfma_f32_16x16x32_bf16 v[140:143], v[64:67], v[120:123], v[140:143]
s_waitcnt lgkmcnt(8)
v_mfma_f32_16x16x32_bf16 v[156:159], v[72:75], v[120:123], v[156:159]
s_add_u32 m0, s64, 0
ds_read_b64_tr_b16 v[64:65], v12 offset:16384
v_mfma_f32_16x16x32_bf16 v[156:159], v[76:79], v[124:127], v[156:159]
s_add_u32 s72, s71, 0
buffer_load_dwordx4 v6, s[12:15], s72 offen lds
v_mfma_f32_16x16x32_bf16 v[152:155], v[76:79], v[116:119], v[152:155]
ds_read_b64_tr_b16 v[66:67], v12 offset:17408
v_mfma_f32_16x16x32_bf16 v[152:155], v[72:75], v[112:115], v[152:155]
v_mfma_f32_16x16x32_bf16 v[148:151], v[72:75], v[104:107], v[148:151]
ds_read_b64_tr_b16 v[68:69], v12 offset:24576
v_mfma_f32_16x16x32_bf16 v[148:151], v[76:79], v[108:111], v[148:151]
ds_read_b64_tr_b16 v[70:71], v12 offset:25600
v_mfma_f32_16x16x32_bf16 v[144:147], v[76:79], v[100:103], v[144:147]
s_add_u32 s72, s71, 31744
buffer_load_dwordx4 v6, s[12:15], s72 offen offset:1024 lds
v_mfma_f32_16x16x32_bf16 v[144:147], v[72:75], v[96:99], v[144:147]
s_waitcnt lgkmcnt(8)
v_mfma_f32_16x16x32_bf16 v[160:163], v[80:83], v[96:99], v[160:163]
ds_read_b64_tr_b16 v[72:73], v13 offset:16384
v_mfma_f32_16x16x32_bf16 v[160:163], v[84:87], v[100:103], v[160:163]
ds_read_b64_tr_b16 v[74:75], v13 offset:17408
v_mfma_f32_16x16x32_bf16 v[164:167], v[84:87], v[108:111], v[164:167]
v_mfma_f32_16x16x32_bf16 v[164:167], v[80:83], v[104:107], v[164:167]
s_add_u32 s72, s71, 63488
buffer_load_dwordx4 v7, s[12:15], s72 offen offset:2048 lds
v_mfma_f32_16x16x32_bf16 v[168:171], v[80:83], v[112:115], v[168:171]
s_waitcnt vmcnt(16)
ds_read_b64_tr_b16 v[76:77], v13 offset:24576
v_mfma_f32_16x16x32_bf16 v[168:171], v[84:87], v[116:119], v[168:171]
ds_read_b128 v[32:35], v18 offset:32768
v_mfma_f32_16x16x32_bf16 v[172:175], v[84:87], v[124:127], v[172:175]
ds_read_b64_tr_b16 v[78:79], v13 offset:25600
v_mfma_f32_16x16x32_bf16 v[172:175], v[80:83], v[120:123], v[172:175]
s_waitcnt lgkmcnt(9)
ds_read_b128 v[36:39], v19 offset:32768
v_mfma_f32_16x16x32_bf16 v[188:191], v[88:91], v[120:123], v[188:191]
s_add_u32 s72, s71, 95232
buffer_load_dwordx4 v7, s[12:15], s72 offen offset:3072 lds
v_mfma_f32_16x16x32_bf16 v[188:191], v[92:95], v[124:127], v[188:191]
v_accvgpr_write_b32 a0, -1
v_accvgpr_write_b32 a1, -1
v_mfma_f32_16x16x32_bf16 v[184:187], v[92:95], v[116:119], v[184:187]
v_accvgpr_write_b32 a2, -1
v_accvgpr_write_b32 a3, -1
v_mfma_f32_16x16x32_bf16 v[184:187], v[88:91], v[112:115], v[184:187]
s_add_u32 s80, s93, 0x3a00000
ds_read_b64_tr_b16 v[80:81], v14 offset:16384
v_mfma_f32_16x16x32_bf16 v[180:183], v[88:91], v[104:107], v[180:183]
ds_read_b64_tr_b16 v[82:83], v14 offset:17408
v_mfma_f32_16x16x32_bf16 v[180:183], v[92:95], v[108:111], v[180:183]
ds_read_b64_tr_b16 v[84:85], v14 offset:24576
v_mfma_f32_16x16x32_bf16 v[176:179], v[92:95], v[100:103], v[176:179]
ds_read_b64_tr_b16 v[86:87], v14 offset:25600
v_mfma_f32_16x16x32_bf16 v[176:179], v[88:91], v[96:99], v[176:179]
s_waitcnt lgkmcnt(10)
ds_read_b128 v[40:43], v18 offset:34816
v_mfma_f32_16x16x32_bf16 v[192:195], v[64:67], v[96:99], v[192:195]
s_waitcnt vmcnt(10)
v_cmp_gt_u32 vcc, 1, v3
s_cbranch_vccnz Lspin4
Lback5:
v_mfma_f32_16x16x32_bf16 v[192:195], v[68:71], v[100:103], v[192:195]
s_add_u32 m0, s64, 49152
ds_read_b64_tr_b16 v[88:89], v15 offset:16384
ds_read_b64_tr_b16 v[90:91], v15 offset:17408
v_mfma_f32_16x16x32_bf16 v[196:199], v[68:71], v[108:111], v[196:199]
s_add_u32 s72, s81, 16384
buffer_load_dwordx4 v1, s[44:47], s72 offen sc1 lds
v_mfma_f32_16x16x32_bf16 v[196:199], v[64:67], v[104:107], v[196:199]
ds_read_b64_tr_b16 v[92:93], v15 offset:24576
v_mfma_f32_16x16x32_bf16 v[200:203], v[64:67], v[112:115], v[200:203]
ds_read_b64_tr_b16 v[94:95], v15 offset:25600
v_mfma_f32_16x16x32_bf16 v[200:203], v[68:71], v[116:119], v[200:203]
buffer_load_dwordx4 v1, s[44:47], s72 offen offset:1024 sc1 lds
v_mfma_f32_16x16x32_bf16 v[204:207], v[68:71], v[124:127], v[204:207]
ds_read_b128 v[44:47], v19 offset:34816
v_mfma_f32_16x16x32_bf16 v[204:207], v[64:67], v[120:123], v[204:207]
s_waitcnt lgkmcnt(11)
v_mfma_f32_16x16x32_bf16 v[220:223], v[72:75], v[120:123], v[220:223]
ds_read_b128 v[48:51], v18 offset:36864
v_mfma_f32_16x16x32_bf16 v[220:223], v[76:79], v[124:127], v[220:223]
ds_read_b128 v[52:55], v19 offset:36864
v_mfma_f32_16x16x32_bf16 v[216:219], v[76:79], v[116:119], v[216:219]
s_waitcnt vmcnt(15) lgkmcnt(3)
buffer_load_dwordx4 v1, s[44:47], s72 offen offset:2048 sc1 lds
v_mfma_f32_16x16x32_bf16 v[216:219], v[72:75], v[112:115], v[216:219]
s_barrier
ds_read_b128 v[56:59], v18 offset:38912
v_mfma_f32_16x16x32_bf16 v[212:215], v[72:75], v[104:107], v[212:215]
ds_read_b64_tr_b16 v[64:65], v8 offset:32768
ds_read_b64_tr_b16 v[66:67], v8 offset:33792
v_mfma_f32_16x16x32_bf16 v[212:215], v[76:79], v[108:111], v[212:215]
ds_read_b64_tr_b16 v[68:69], v8 offset:40960
v_mfma_f32_16x16x32_bf16 v[208:211], v[76:79], v[100:103], v[208:211]
ds_read_b64_tr_b16 v[70:71], v8 offset:41984
v_mfma_f32_16x16x32_bf16 v[208:211], v[72:75], v[96:99], v[208:211]
buffer_load_dwordx4 v1, s[44:47], s72 offen offset:3072 sc1 lds
v_mfma_f32_16x16x32_bf16 v[224:227], v[80:83], v[96:99], v[224:227]
s_add_u32 s81, s81, 0x8000
ds_read_b64_tr_b16 v[72:73], v9 offset:32768
v_mfma_f32_16x16x32_bf16 v[224:227], v[84:87], v[100:103], v[224:227]
s_add_u32 m0, s64, 81920
ds_read_b64_tr_b16 v[74:75], v9 offset:33792
v_mfma_f32_16x16x32_bf16 v[228:231], v[84:87], v[108:111], v[228:231]
s_add_u32 s72, s81, 16384
buffer_load_dwordx4 v1, s[44:47], s72 offen sc1 lds
v_mfma_f32_16x16x32_bf16 v[228:231], v[80:83], v[104:107], v[228:231]
ds_read_b128 v[60:63], v19 offset:38912
v_mfma_f32_16x16x32_bf16 v[232:235], v[80:83], v[112:115], v[232:235]
buffer_load_dwordx4 v1, s[44:47], s72 offen offset:1024 sc1 lds
v_mfma_f32_16x16x32_bf16 v[232:235], v[84:87], v[116:119], v[232:235]
ds_read_b64_tr_b16 v[76:77], v9 offset:40960
v_mfma_f32_16x16x32_bf16 v[236:239], v[84:87], v[124:127], v[236:239]
ds_read_b64_tr_b16 v[78:79], v9 offset:41984
v_mfma_f32_16x16x32_bf16 v[236:239], v[80:83], v[120:123], v[236:239]
v_mfma_f32_16x16x32_bf16 v[252:255], v[88:91], v[120:123], v[252:255]
ds_read_b64_tr_b16 v[80:81], v10 offset:32768
v_mfma_f32_16x16x32_bf16 v[252:255], v[92:95], v[124:127], v[252:255]
buffer_load_dwordx4 v1, s[44:47], s72 offen offset:2048 sc1 lds
v_mfma_f32_16x16x32_bf16 v[248:251], v[92:95], v[116:119], v[248:251]
ds_read_b64_tr_b16 v[82:83], v10 offset:33792
v_mfma_f32_16x16x32_bf16 v[248:251], v[88:91], v[112:115], v[248:251]
v_mfma_f32_16x16x32_bf16 v[244:247], v[88:91], v[104:107], v[244:247]
ds_read_b64_tr_b16 v[84:85], v10 offset:40960
v_mfma_f32_16x16x32_bf16 v[244:247], v[92:95], v[108:111], v[244:247]
buffer_load_dwordx4 v1, s[44:47], s72 offen offset:3072 sc1 lds
v_mfma_f32_16x16x32_bf16 v[240:243], v[92:95], v[100:103], v[240:243]
ds_read_b64_tr_b16 v[86:87], v10 offset:41984
v_mfma_f32_16x16x32_bf16 v[240:243], v[88:91], v[96:99], v[240:243]
s_waitcnt lgkmcnt(6)
LcS:
v_mfma_f32_16x16x32_bf16 v[128:131], v[64:67], v[32:35], v[128:131]
ds_read_b64_tr_b16 v[88:89], v11 offset:32768
v_mfma_f32_16x16x32_bf16 v[128:131], v[68:71], v[36:39], v[128:131]
ds_read_b64_tr_b16 v[90:91], v11 offset:33792
v_mfma_f32_16x16x32_bf16 v[132:135], v[68:71], v[44:47], v[132:135]
s_add_u32 m0, s64, 65536
v_mfma_f32_16x16x32_bf16 v[132:135], v[64:67], v[40:43], v[132:135]
s_add_u32 s72, s81, 0
buffer_load_dwordx4 v1, s[44:47], s72 offen sc1 lds
v_mfma_f32_16x16x32_bf16 v[136:139], v[64:67], v[48:51], v[136:139]
ds_read_b64_tr_b16 v[92:93], v11 offset:40960
v_mfma_f32_16x16x32_bf16 v[136:139], v[68:71], v[52:55], v[136:139]
ds_read_b64_tr_b16 v[94:95], v11 offset:41984
v_mfma_f32_16x16x32_bf16 v[140:143], v[68:71], v[60:63], v[140:143]
v_mfma_f32_16x16x32_bf16 v[140:143], v[64:67], v[56:59], v[140:143]
s_waitcnt lgkmcnt(8)
buffer_load_dwordx4 v1, s[44:47], s72 offen offset:1024 sc1 lds
v_mfma_f32_16x16x32_bf16 v[156:159], v[72:75], v[56:59], v[156:159]
ds_read_b64_tr_b16 v[64:65], v12 offset:32768
v_mfma_f32_16x16x32_bf16 v[156:159], v[76:79], v[60:63], v[156:159]
ds_read_b64_tr_b16 v[66:67], v12 offset:33792
v_mfma_f32_16x16x32_bf16 v[152:155], v[76:79], v[52:55], v[152:155]
v_mfma_f32_16x16x32_bf16 v[152:155], v[72:75], v[48:51], v[152:155]
buffer_load_dwordx4 v1, s[44:47], s72 offen offset:2048 sc1 lds
v_mfma_f32_16x16x32_bf16 v[148:151], v[72:75], v[40:43], v[148:151]
ds_read_b64_tr_b16 v[68:69], v12 offset:40960
v_mfma_f32_16x16x32_bf16 v[148:151], v[76:79], v[44:47], v[148:151]
v_mfma_f32_16x16x32_bf16 v[144:147], v[76:79], v[36:39], v[144:147]
ds_read_b64_tr_b16 v[70:71], v12 offset:41984
v_mfma_f32_16x16x32_bf16 v[144:147], v[72:75], v[32:35], v[144:147]
s_waitcnt lgkmcnt(8)
v_mfma_f32_16x16x32_bf16 v[160:163], v[80:83], v[32:35], v[160:163]
buffer_load_dwordx4 v1, s[44:47], s72 offen offset:3072 sc1 lds
v_mfma_f32_16x16x32_bf16 v[160:163], v[84:87], v[36:39], v[160:163]
ds_read_b64_tr_b16 v[72:73], v13 offset:32768
v_mfma_f32_16x16x32_bf16 v[164:167], v[84:87], v[44:47], v[164:167]
ds_read_b64_tr_b16 v[74:75], v13 offset:33792
v_mfma_f32_16x16x32_bf16 v[164:167], v[80:83], v[40:43], v[164:167]
v_mfma_f32_16x16x32_bf16 v[168:171], v[80:83], v[48:51], v[168:171]
s_waitcnt vmcnt(16)
ds_read_b64_tr_b16 v[76:77], v13 offset:40960
v_mfma_f32_16x16x32_bf16 v[168:171], v[84:87], v[52:55], v[168:171]
ds_read_b128 v[96:99], v16 offset:0
v_mfma_f32_16x16x32_bf16 v[172:175], v[84:87], v[60:63], v[172:175]
ds_read_b64_tr_b16 v[78:79], v13 offset:41984
v_mfma_f32_16x16x32_bf16 v[172:175], v[80:83], v[56:59], v[172:175]
s_waitcnt lgkmcnt(9)
v_mfma_f32_16x16x32_bf16 v[188:191], v[88:91], v[56:59], v[188:191]
ds_read_b64_tr_b16 v[80:81], v14 offset:32768
v_mfma_f32_16x16x32_bf16 v[188:191], v[92:95], v[60:63], v[188:191]
ds_read_b128 v[100:103], v17 offset:0
v_mfma_f32_16x16x32_bf16 v[184:187], v[92:95], v[52:55], v[184:187]
ds_read_b64_tr_b16 v[82:83], v14 offset:33792
v_mfma_f32_16x16x32_bf16 v[184:187], v[88:91], v[48:51], v[184:187]
v_mfma_f32_16x16x32_bf16 v[180:183], v[88:91], v[40:43], v[180:183]
ds_read_b64_tr_b16 v[84:85], v14 offset:40960
v_mfma_f32_16x16x32_bf16 v[180:183], v[92:95], v[44:47], v[180:183]
ds_read_b128 v[104:107], v16 offset:2048
v_mfma_f32_16x16x32_bf16 v[176:179], v[92:95], v[36:39], v[176:179]
ds_read_b64_tr_b16 v[86:87], v14 offset:41984
v_mfma_f32_16x16x32_bf16 v[176:179], v[88:91], v[32:35], v[176:179]
s_waitcnt lgkmcnt(11)
v_mfma_f32_16x16x32_bf16 v[192:195], v[64:67], v[32:35], v[192:195]
ds_read_b64_tr_b16 v[88:89], v15 offset:32768
v_mfma_f32_16x16x32_bf16 v[192:195], v[68:71], v[36:39], v[192:195]
ds_read_b64_tr_b16 v[90:91], v15 offset:33792
v_mfma_f32_16x16x32_bf16 v[196:199], v[68:71], v[44:47], v[196:199]
ds_read_b128 v[108:111], v17 offset:2048
v_mfma_f32_16x16x32_bf16 v[196:199], v[64:67], v[40:43], v[196:199]
ds_read_b64_tr_b16 v[92:93], v15 offset:40960
v_mfma_f32_16x16x32_bf16 v[200:203], v[64:67], v[48:51], v[200:203]
ds_read_b64_tr_b16 v[94:95], v15 offset:41984
v_mfma_f32_16x16x32_bf16 v[200:203], v[68:71], v[52:55], v[200:203]
v_mfma_f32_16x16x32_bf16 v[204:207], v[68:71], v[60:63], v[204:207]
ds_read_b128 v[112:115], v16 offset:4096
v_mfma_f32_16x16x32_bf16 v[204:207], v[64:67], v[56:59], v[204:207]
s_waitcnt lgkmcnt(12)
v_mfma_f32_16x16x32_bf16 v[220:223], v[72:75], v[56:59], v[220:223]
ds_read_b128 v[116:119], v17 offset:4096
v_mfma_f32_16x16x32_bf16 v[220:223], v[76:79], v[60:63], v[220:223]
v_mfma_f32_16x16x32_bf16 v[216:219], v[76:79], v[52:55], v[216:219]
s_waitcnt vmcnt(12) lgkmcnt(2)
ds_read_b128 v[120:123], v16 offset:6144
v_mfma_f32_16x16x32_bf16 v[216:219], v[72:75], v[48:51], v[216:219]
s_barrier
v_mfma_f32_16x16x32_bf16 v[212:215], v[72:75], v[40:43], v[212:215]
s_add_u32 s81, s81, 0x8000
ds_read_b64_tr_b16 v[64:65], v8 offset:0
ds_read_b64_tr_b16 v[66:67], v8 offset:1024
v_mfma_f32_16x16x32_bf16 v[212:215], v[76:79], v[44:47], v[212:215]
s_add_u32 m0, s64, 114688
Lstub0:
s_cbranch_execz Lstub4
ds_read_b64_tr_b16 v[68:69], v8 offset:8192
v_mfma_f32_16x16x32_bf16 v[208:211], v[76:79], v[36:39], v[208:211]
s_add_u32 s72, s81, 16384
buffer_load_dwordx4 v1, s[44:47], s72 offen sc1 lds
v_mfma_f32_16x16x32_bf16 v[208:211], v[72:75], v[32:35], v[208:211]
ds_read_b64_tr_b16 v[70:71], v8 offset:9216
v_mfma_f32_16x16x32_bf16 v[224:227], v[80:83], v[32:35], v[224:227]
buffer_load_dwordx4 v1, s[44:47], s72 offen offset:1024 sc1 lds
v_mfma_f32_16x16x32_bf16 v[224:227], v[84:87], v[36:39], v[224:227]
ds_read_b64_tr_b16 v[72:73], v9 offset:0
v_mfma_f32_16x16x32_bf16 v[228:231], v[84:87], v[44:47], v[228:231]
ds_read_b64_tr_b16 v[74:75], v9 offset:1024
v_mfma_f32_16x16x32_bf16 v[228:231], v[80:83], v[40:43], v[228:231]
ds_read_b128 v[124:127], v17 offset:6144
v_mfma_f32_16x16x32_bf16 v[232:235], v[80:83], v[48:51], v[232:235]
ds_read_b64_tr_b16 v[76:77], v9 offset:8192
v_mfma_f32_16x16x32_bf16 v[232:235], v[84:87], v[52:55], v[232:235]
buffer_store_dwordx4 a[0:3], v1, s[44:47], s80 offen sc1
v_mfma_f32_16x16x32_bf16 v[236:239], v[84:87], v[60:63], v[236:239]
ds_read_b64_tr_b16 v[78:79], v9 offset:9216
v_mfma_f32_16x16x32_bf16 v[236:239], v[80:83], v[56:59], v[236:239]
v_mfma_f32_16x16x32_bf16 v[252:255], v[88:91], v[56:59], v[252:255]
ds_read_b64_tr_b16 v[80:81], v10 offset:0
v_mfma_f32_16x16x32_bf16 v[252:255], v[92:95], v[60:63], v[252:255]
ds_read_b64_tr_b16 v[82:83], v10 offset:1024
v_mfma_f32_16x16x32_bf16 v[248:251], v[92:95], v[52:55], v[248:251]
buffer_load_dwordx4 v1, s[44:47], s72 offen offset:2048 sc1 lds
v_mfma_f32_16x16x32_bf16 v[248:251], v[88:91], v[48:51], v[248:251]
v_mfma_f32_16x16x32_bf16 v[244:247], v[88:91], v[40:43], v[244:247]
ds_read_b64_tr_b16 v[84:85], v10 offset:8192
v_mfma_f32_16x16x32_bf16 v[244:247], v[92:95], v[44:47], v[244:247]
ds_read_b64_tr_b16 v[86:87], v10 offset:9216
v_mfma_f32_16x16x32_bf16 v[240:243], v[92:95], v[36:39], v[240:243]
buffer_load_dwordx4 v1, s[44:47], s72 offen offset:3072 sc1 lds
v_mfma_f32_16x16x32_bf16 v[240:243], v[88:91], v[32:35], v[240:243]
s_waitcnt lgkmcnt(6)
v_mfma_f32_16x16x32_bf16 v[128:131], v[64:67], v[96:99], v[128:131]
ds_read_b64_tr_b16 v[88:89], v11 offset:0
v_mfma_f32_16x16x32_bf16 v[128:131], v[68:71], v[100:103], v[128:131]
ds_read_b64_tr_b16 v[90:91], v11 offset:1024
v_mfma_f32_16x16x32_bf16 v[132:135], v[68:71], v[108:111], v[132:135]
v_mfma_f32_16x16x32_bf16 v[132:135], v[64:67], v[104:107], v[132:135]
buffer_store_dwordx4 a[0:3], v1, s[44:47], s80 offen offset:1024 sc1
v_mfma_f32_16x16x32_bf16 v[136:139], v[64:67], v[112:115], v[136:139]
ds_read_b64_tr_b16 v[92:93], v11 offset:8192
v_mfma_f32_16x16x32_bf16 v[136:139], v[68:71], v[116:119], v[136:139]
v_mfma_f32_16x16x32_bf16 v[140:143], v[68:71], v[124:127], v[140:143]
ds_read_b64_tr_b16 v[94:95], v11 offset:9216
v_mfma_f32_16x16x32_bf16 v[140:143], v[64:67], v[120:123], v[140:143]
s_waitcnt lgkmcnt(8)
v_mfma_f32_16x16x32_bf16 v[156:159], v[72:75], v[120:123], v[156:159]
s_add_u32 m0, s64, 98304
ds_read_b64_tr_b16 v[64:65], v12 offset:0
v_mfma_f32_16x16x32_bf16 v[156:159], v[76:79], v[124:127], v[156:159]
s_add_u32 s72, s81, 0
buffer_load_dwordx4 v1, s[44:47], s72 offen sc1 lds
v_mfma_f32_16x16x32_bf16 v[152:155], v[76:79], v[116:119], v[152:155]
ds_read_b64_tr_b16 v[66:67], v12 offset:1024
v_mfma_f32_16x16x32_bf16 v[152:155], v[72:75], v[112:115], v[152:155]
v_mfma_f32_16x16x32_bf16 v[148:151], v[72:75], v[104:107], v[148:151]
buffer_load_dwordx4 v1, s[44:47], s72 offen offset:1024 sc1 lds
v_mfma_f32_16x16x32_bf16 v[148:151], v[76:79], v[108:111], v[148:151]
ds_read_b64_tr_b16 v[68:69], v12 offset:8192
v_mfma_f32_16x16x32_bf16 v[144:147], v[76:79], v[100:103], v[144:147]
ds_read_b64_tr_b16 v[70:71], v12 offset:9216
v_mfma_f32_16x16x32_bf16 v[144:147], v[72:75], v[96:99], v[144:147]
s_waitcnt lgkmcnt(8)
v_mfma_f32_16x16x32_bf16 v[160:163], v[80:83], v[96:99], v[160:163]
ds_read_b64_tr_b16 v[72:73], v13 offset:0
v_mfma_f32_16x16x32_bf16 v[160:163], v[84:87], v[100:103], v[160:163]
buffer_store_dwordx4 a[0:3], v1, s[44:47], s80 offen offset:2048 sc1
v_mfma_f32_16x16x32_bf16 v[164:167], v[84:87], v[108:111], v[164:167]
ds_read_b64_tr_b16 v[74:75], v13 offset:1024
v_mfma_f32_16x16x32_bf16 v[164:167], v[80:83], v[104:107], v[164:167]
v_mfma_f32_16x16x32_bf16 v[168:171], v[80:83], v[112:115], v[168:171]
ds_read_b64_tr_b16 v[76:77], v13 offset:8192
v_cvt_pk_bf16_f32 v48, v136, v137
v_mfma_f32_16x16x32_bf16 v[168:171], v[84:87], v[116:119], v[168:171]
ds_read_b64_tr_b16 v[78:79], v13 offset:9216
v_cvt_pk_bf16_f32 v49, v138, v139
v_mfma_f32_16x16x32_bf16 v[172:175], v[84:87], v[124:127], v[172:175]
buffer_load_dwordx4 v1, s[44:47], s72 offen offset:2048 sc1 lds
v_mfma_f32_16x16x32_bf16 v[172:175], v[80:83], v[120:123], v[172:175]
s_waitcnt lgkmcnt(8)
v_cvt_pk_bf16_f32 v50, v152, v153
v_cvt_pk_bf16_f32 v51, v154, v155
v_mfma_f32_16x16x32_bf16 v[188:191], v[88:91], v[120:123], v[188:191]
v_add_u32 v2, 0x8000, v1
v_cvt_pk_bf16_f32 v32, v132, v133
v_mfma_f32_16x16x32_bf16 v[188:191], v[92:95], v[124:127], v[188:191]
ds_read_b64_tr_b16 v[80:81], v14 offset:0
v_cvt_pk_bf16_f32 v33, v134, v135
v_mfma_f32_16x16x32_bf16 v[184:187], v[92:95], v[116:119], v[184:187]
buffer_load_dwordx4 v1, s[44:47], s72 offen offset:3072 sc1 lds
v_mfma_f32_16x16x32_bf16 v[184:187], v[88:91], v[112:115], v[184:187]
ds_read_b64_tr_b16 v[82:83], v14 offset:1024
v_cvt_pk_bf16_f32 v34, v148, v149
v_mfma_f32_16x16x32_bf16 v[180:183], v[88:91], v[104:107], v[180:183]
ds_read_b64_tr_b16 v[84:85], v14 offset:8192
v_cvt_pk_bf16_f32 v35, v150, v151
v_mfma_f32_16x16x32_bf16 v[180:183], v[92:95], v[108:111], v[180:183]
ds_read_b64_tr_b16 v[86:87], v14 offset:9216
v_cvt_pk_bf16_f32 v16, v128, v129
v_mfma_f32_16x16x32_bf16 v[176:179], v[92:95], v[100:103], v[176:179]
v_cvt_pk_bf16_f32 v17, v130, v131
v_cvt_pk_bf16_f32 v18, v144, v145
v_mfma_f32_16x16x32_bf16 v[176:179], v[88:91], v[96:99], v[176:179]
s_waitcnt lgkmcnt(8)
buffer_store_dwordx4 a[0:3], v1, s[44:47], s80 offen offset:3072 sc1
v_mfma_f32_16x16x32_bf16 v[192:195], v[64:67], v[96:99], v[192:195]
ds_read_b64_tr_b16 v[88:89], v15 offset:0
v_cvt_pk_bf16_f32 v19, v146, v147
v_mfma_f32_16x16x32_bf16 v[192:195], v[68:71], v[100:103], v[192:195]
ds_read_b64_tr_b16 v[90:91], v15 offset:1024
v_mfma_f32_16x16x32_bf16 v[196:199], v[68:71], v[108:111], v[196:199]
ds_read_b64_tr_b16 v[92:93], v15 offset:8192
v_mfma_f32_16x16x32_bf16 v[196:199], v[64:67], v[104:107], v[196:199]
ds_read_b64_tr_b16 v[94:95], v15 offset:9216
v_mfma_f32_16x16x32_bf16 v[200:203], v[64:67], v[112:115], v[200:203]
v_lshrrev_b32 v3, 1, v0
v_lshlrev_b32 v3, 7, v3
v_mfma_f32_16x16x32_bf16 v[200:203], v[68:71], v[116:119], v[200:203]
buffer_load_dword v4, v3, s[36:39], s93 offen
v_mfma_f32_16x16x32_bf16 v[204:207], v[68:71], v[124:127], v[204:207]
v_cvt_pk_bf16_f32 v52, v168, v169
v_cvt_pk_bf16_f32 v53, v170, v171
v_mfma_f32_16x16x32_bf16 v[204:207], v[64:67], v[120:123], v[204:207]
s_waitcnt lgkmcnt(8)
v_cvt_pk_bf16_f32 v54, v184, v185
v_cvt_pk_bf16_f32 v55, v186, v187
v_mfma_f32_16x16x32_bf16 v[220:223], v[72:75], v[120:123], v[220:223]
v_cvt_pk_bf16_f32 v36, v164, v165
v_cvt_pk_bf16_f32 v37, v166, v167
v_mfma_f32_16x16x32_bf16 v[220:223], v[76:79], v[124:127], v[220:223]
v_cvt_pk_bf16_f32 v38, v180, v181
v_cvt_pk_bf16_f32 v39, v182, v183
v_mfma_f32_16x16x32_bf16 v[216:219], v[76:79], v[116:119], v[216:219]
s_waitcnt vmcnt(21) lgkmcnt(0)
v_cvt_pk_bf16_f32 v20, v160, v161
v_cvt_pk_bf16_f32 v21, v162, v163
v_mfma_f32_16x16x32_bf16 v[216:219], v[72:75], v[112:115], v[216:219]
s_barrier
v_cvt_pk_bf16_f32 v22, v176, v177
v_cvt_pk_bf16_f32 v23, v178, v179
v_mfma_f32_16x16x32_bf16 v[212:215], v[72:75], v[104:107], v[212:215]
ds_read_b128 a[128:131], v2 offset:16384
v_cvt_pk_bf16_f32 v64, v140, v141
v_mfma_f32_16x16x32_bf16 v[212:215], v[76:79], v[108:111], v[212:215]
v_cvt_pk_bf16_f32 v65, v142, v143
v_cvt_pk_bf16_f32 v66, v156, v157
v_mfma_f32_16x16x32_bf16 v[208:211], v[76:79], v[100:103], v[208:211]
ds_read_b128 a[132:135], v2 offset:17408
v_cvt_pk_bf16_f32 v67, v158, v159
v_mfma_f32_16x16x32_bf16 v[208:211], v[72:75], v[96:99], v[208:211]
v_cvt_pk_bf16_f32 v68, v172, v173
v_cvt_pk_bf16_f32 v69, v174, v175
v_mfma_f32_16x16x32_bf16 v[224:227], v[80:83], v[96:99], v[224:227]
ds_read_b128 a[136:139], v2 offset:18432
v_cvt_pk_bf16_f32 v70, v188, v189
v_mfma_f32_16x16x32_bf16 v[224:227], v[84:87], v[100:103], v[224:227]
v_cvt_pk_bf16_f32 v71, v190, v191
v_mfma_f32_16x16x32_bf16 v[228:231], v[84:87], v[108:111], v[228:231]
ds_read_b128 a[140:143], v2 offset:19456
v_mfma_f32_16x16x32_bf16 v[228:231], v[80:83], v[104:107], v[228:231]
v_mfma_f32_16x16x32_bf16 v[232:235], v[80:83], v[112:115], v[232:235]
ds_read_b128 a[144:147], v2 offset:20480
v_cvt_pk_bf16_f32 v72, v204, v205
v_mfma_f32_16x16x32_bf16 v[232:235], v[84:87], v[116:119], v[232:235]
v_cvt_pk_bf16_f32 v73, v206, v207
v_cvt_pk_bf16_f32 v74, v220, v221
v_mfma_f32_16x16x32_bf16 v[236:239], v[84:87], v[124:127], v[236:239]
ds_read_b128 a[148:151], v2 offset:21504
v_cvt_pk_bf16_f32 v75, v222, v223
v_mfma_f32_16x16x32_bf16 v[236:239], v[80:83], v[120:123], v[236:239]
v_cvt_pk_bf16_f32 v56, v200, v201
v_cvt_pk_bf16_f32 v57, v202, v203
v_mfma_f32_16x16x32_bf16 v[252:255], v[88:91], v[120:123], v[252:255]
ds_read_b128 a[152:155], v2 offset:22528
v_cvt_pk_bf16_f32 v58, v216, v217
v_mfma_f32_16x16x32_bf16 v[252:255], v[92:95], v[124:127], v[252:255]
v_cvt_pk_bf16_f32 v59, v218, v219
v_cvt_pk_bf16_f32 v40, v196, v197
v_mfma_f32_16x16x32_bf16 v[248:251], v[92:95], v[116:119], v[248:251]
ds_read_b128 a[156:159], v2 offset:23552
v_cvt_pk_bf16_f32 v41, v198, v199
v_mfma_f32_16x16x32_bf16 v[248:251], v[88:91], v[112:115], v[248:251]
v_cvt_pk_bf16_f32 v42, v212, v213
v_cvt_pk_bf16_f32 v43, v214, v215
v_mfma_f32_16x16x32_bf16 v[244:247], v[88:91], v[104:107], v[244:247]
v_cvt_pk_bf16_f32 v24, v192, v193
v_cvt_pk_bf16_f32 v25, v194, v195
v_mfma_f32_16x16x32_bf16 v[244:247], v[92:95], v[108:111], v[244:247]
v_cvt_pk_bf16_f32 v26, v208, v209
v_cvt_pk_bf16_f32 v27, v210, v211
v_mfma_f32_16x16x32_bf16 v[240:243], v[92:95], v[100:103], v[240:243]
v_mfma_f32_16x16x32_bf16 v[240:243], v[88:91], v[96:99], v[240:243]
v_cvt_pk_bf16_f32 v76, v236, v237
v_cvt_pk_bf16_f32 v77, v238, v239
v_cvt_pk_bf16_f32 v78, v252, v253
v_cvt_pk_bf16_f32 v79, v254, v255
v_cvt_pk_bf16_f32 v60, v232, v233
v_cvt_pk_bf16_f32 v61, v234, v235
v_cvt_pk_bf16_f32 v62, v248, v249
v_cvt_pk_bf16_f32 v63, v250, v251
v_cvt_pk_bf16_f32 v44, v228, v229
v_cvt_pk_bf16_f32 v45, v230, v231
v_cvt_pk_bf16_f32 v46, v244, v245
v_cvt_pk_bf16_f32 v47, v246, v247
v_cvt_pk_bf16_f32 v28, v224, v225
v_cvt_pk_bf16_f32 v29, v226, v227
v_cvt_pk_bf16_f32 v30, v240, v241
v_cvt_pk_bf16_f32 v31, v242, v243
v_mov_b32 v124, 0xff800000
v_mov_b32 v125, 0xff800000
v_mov_b32 v126, 0xff800000
v_mov_b32 v127, 0xff800000
s_lshl_b32 s84, s60, 2
s_add_u32 s84, s84, s58
s_mov_b32 s86, 0
s_mov_b32 s53, 0
s_lshr_b32 s52, s66, 8
s_and_b32 s52, s52, 31
s_add_u32 s61, s65, s60
s_and_b32 s73, s60, 1
s_lshl_b32 s73, s73, 16
s_add_u32 s77, s73, s64
s_xor_b32 s73, s73, 0x10000
s_mov_b32 s92, s73
s_mul_i32 s62, s58, 4608
s_add_u32 s62, s62, 143104
s_add_u32 s73, s73, 49920
s_cmp_eq_u32 s58, 0
s_cselect_b32 s62, s73, s62
Lattn:
s_mov_b32 s82, 0x10000
s_waitcnt lgkmcnt(0)
v_mfma_f32_16x16x32_bf16 v[136:139], a[128:131], v[48:51], 0
ds_read_b128 a[160:163], v2 offset:24576
v_lshrrev_b32 v240, 4, v0
v_mfma_f32_16x16x32_bf16 v[136:139], a[132:135], v[52:55], v[136:139]
ds_read_b128 a[164:167], v2 offset:25600
v_and_b32 v241, 15, v0
v_mfma_f32_16x16x32_bf16 v[136:139], a[136:139], v[56:59], v[136:139]
ds_read_b128 a[168:171], v2 offset:26624
v_lshlrev_b32 v240, 2, v240
v_mfma_f32_16x16x32_bf16 v[136:139], a[140:143], v[60:63], v[136:139]
ds_read_b128 a[172:175], v2 offset:27648
v_sub_u32 v240, v241, v240
v_mfma_f32_16x16x32_bf16 v[140:143], a[140:143], v[76:79], 0
ds_read_b128 a[176:179], v2 offset:28672
v_mov_b32 v112, 0xff800000
v_mfma_f32_16x16x32_bf16 v[140:143], a[136:139], v[72:75], v[140:143]
ds_read_b128 a[180:183], v2 offset:29696
v_mov_b32 v113, 0xff800000
v_mfma_f32_16x16x32_bf16 v[140:143], a[132:135], v[68:71], v[140:143]
ds_read_b128 a[184:187], v2 offset:30720
v_mov_b32 v114, 0xff800000
v_mfma_f32_16x16x32_bf16 v[140:143], a[128:131], v[64:67], v[140:143]
ds_read_b128 a[188:191], v2 offset:31744
v_mov_b32 v115, 0xff800000
v_mfma_f32_16x16x32_bf16 v[156:159], a[144:147], v[64:67], 0
v_cmp_gt_i32 vcc, 0, v240
v_and_b32 v120, 3, v0
v_mfma_f32_16x16x32_bf16 v[156:159], a[148:151], v[68:71], v[156:159]
v_cndmask_b32 v116, 0, v112, vcc
v_cmp_gt_i32 vcc, 1, v240
v_mfma_f32_16x16x32_bf16 v[156:159], a[152:155], v[72:75], v[156:159]
v_subrev_u32 v120, 1, v120
v_cndmask_b32 v117, 0, v112, vcc
v_mfma_f32_16x16x32_bf16 v[156:159], a[156:159], v[76:79], v[156:159]
v_cmp_gt_i32 vcc, 2, v240
v_ashrrev_i32 v120, 31, v120
v_mfma_f32_16x16x32_bf16 v[152:155], a[156:159], v[60:63], 0
v_cndmask_b32 v118, 0, v112, vcc
v_cmp_gt_i32 vcc, 3, v240
v_mfma_f32_16x16x32_bf16 v[152:155], a[152:155], v[56:59], v[152:155]
v_and_b32 v120, 0x3f803f80, v120
v_cndmask_b32 v119, 0, v112, vcc
v_mfma_f32_16x16x32_bf16 v[152:155], a[148:151], v[52:55], v[152:155]
v_mov_b32 v228, 0
v_mov_b32 v229, 0
v_mfma_f32_16x16x32_bf16 v[152:155], a[144:147], v[48:51], v[152:155]
v_mov_b32 v230, 0
v_mov_b32 v231, 0
s_cmp_eq_u32 s84, 0
s_cbranch_scc1 Lta7
s_cmp_eq_u32 s84, 1
s_cbranch_scc1 Lnt8
v_mfma_f32_16x16x32_bf16 v[128:131], a[128:131], v[16:19], 0
v_mov_b32 v236, 0
v_mov_b32 v237, 0
v_mfma_f32_16x16x32_bf16 v[144:147], a[144:147], v[16:19], 0
v_mov_b32 v238, 0
v_mov_b32 v239, 0
s_branch Ljoin9
Lta7:
v_mfma_f32_16x16x32_bf16 v[128:131], a[128:131], v[16:19], v[116:119]
v_mov_b32 v236, 0
v_mov_b32 v237, 0
v_mfma_f32_16x16x32_bf16 v[144:147], a[144:147], v[16:19], v[112:115]
v_mov_b32 v238, 0
v_mov_b32 v239, 0
s_branch Ljoin9
Lnt8:
v_mfma_f32_16x16x32_bf16 v[128:131], a[128:131], v[16:19], 0
v_mov_b32 v236, 0
v_mov_b32 v237, 0
v_mfma_f32_16x16x32_bf16 v[144:147], a[144:147], v[16:19], v[116:119]
v_mov_b32 v238, 0
v_mov_b32 v239, 0
Ljoin9:
v_mfma_f32_16x16x32_bf16 v[128:131], a[132:135], v[20:23], v[128:131]
v_mov_b32 v121, v120
v_mov_b32 v122, v120
v_mfma_f32_16x16x32_bf16 v[128:131], a[136:139], v[24:27], v[128:131]
v_mov_b32 v123, v120
v_mfma_f32_16x16x32_bf16 v[128:131], a[140:143], v[28:31], v[128:131]
v_max3_f32 v240, v136, v137, v126
v_max3_f32 v242, v140, v141, v127
v_mfma_f32_16x16x32_bf16 v[132:135], a[140:143], v[44:47], 0
v_max3_f32 v240, v240, v138, v139
v_max3_f32 v242, v242, v142, v143
v_mfma_f32_16x16x32_bf16 v[132:135], a[136:139], v[40:43], v[132:135]
v_max3_f32 v240, v240, v152, v153
v_max3_f32 v242, v242, v156, v157
v_mfma_f32_16x16x32_bf16 v[132:135], a[132:135], v[36:39], v[132:135]
v_max3_f32 v240, v240, v154, v155
v_max3_f32 v242, v242, v158, v159
v_mfma_f32_16x16x32_bf16 v[132:135], a[128:131], v[32:35], v[132:135]
v_mov_b32 v241, v240
v_mov_b32 v243, v242
v_mfma_f32_16x16x32_bf16 v[148:151], a[144:147], v[32:35], 0
v_permlane16_swap_b32 v240, v241
v_permlane16_swap_b32 v242, v243
v_mfma_f32_16x16x32_bf16 v[148:151], a[148:151], v[36:39], v[148:151]
v_max_f32 v240, v240, v241
v_max_f32 v242, v242, v243
v_mfma_f32_16x16x32_bf16 v[148:151], a[152:155], v[40:43], v[148:151]
v_mov_b32 v241, v240
v_mov_b32 v243, v242
v_mfma_f32_16x16x32_bf16 v[148:151], a[156:159], v[44:47], v[148:151]
v_permlane32_swap_b32 v240, v241
v_permlane32_swap_b32 v242, v243
v_mfma_f32_16x16x32_bf16 v[144:147], a[156:159], v[28:31], v[144:147]
v_max_f32 v240, v240, v241
v_max_f32 v242, v242, v243
v_mfma_f32_16x16x32_bf16 v[144:147], a[152:155], v[24:27], v[144:147]
v_mfma_f32_16x16x32_bf16 v[144:147], a[148:151], v[20:23], v[144:147]
v_sub_f32 v88, 0, v240
v_sub_f32 v89, 0, v240
v_pk_add_f32 v[90:91], v[88:89], 0
v_pk_add_f32 v[104:105], v[116:117], v[88:89]
v_pk_add_f32 v[106:107], v[118:119], v[88:89]
v_pk_add_f32 v[136:137], v[136:137], v[88:89]
v_pk_add_f32 v[138:139], v[138:139], v[88:89]
v_pk_add_f32 v[152:153], v[152:153], v[88:89]
v_pk_add_f32 v[154:155], v[154:155], v[88:89]
v_sub_f32 v92, 0, v242
v_sub_f32 v93, 0, v242
v_pk_add_f32 v[94:95], v[92:93], 0
v_pk_add_f32 v[108:109], v[116:117], v[92:93]
v_pk_add_f32 v[110:111], v[118:119], v[92:93]
v_pk_add_f32 v[140:141], v[140:141], v[92:93]
v_pk_add_f32 v[142:143], v[142:143], v[92:93]
v_pk_add_f32 v[156:157], v[156:157], v[92:93]
v_pk_add_f32 v[158:159], v[158:159], v[92:93]
v_max3_f32 v240, v128, v129, v124
v_max3_f32 v242, v132, v133, v125
v_max3_f32 v240, v240, v130, v131
v_max3_f32 v242, v242, v134, v135
v_max3_f32 v240, v240, v144, v145
v_max3_f32 v242, v242, v148, v149
v_max3_f32 v240, v240, v146, v147
v_max3_f32 v242, v242, v150, v151
v_mov_b32 v241, v240
v_mov_b32 v243, v242
s_nop 0
v_permlane16_swap_b32 v240, v241
v_permlane16_swap_b32 v242, v243
v_max_f32 v240, v240, v241
v_max_f32 v242, v242, v243
v_mov_b32 v241, v240
v_mov_b32 v243, v242
s_nop 0
v_permlane32_swap_b32 v240, v241
v_permlane32_swap_b32 v242, v243
v_max_f32 v240, v240, v241
v_max_f32 v242, v242, v243
v_sub_f32 v80, 0, v240
v_sub_f32 v81, 0, v240
v_pk_add_f32 v[82:83], v[80:81], 0
v_pk_add_f32 v[96:97], v[116:117], v[80:81]
v_pk_add_f32 v[98:99], v[118:119], v[80:81]
v_pk_add_f32 v[128:129], v[128:129], v[80:81]
v_pk_add_f32 v[130:131], v[130:131], v[80:81]
v_pk_add_f32 v[144:145], v[144:145], v[80:81]
v_pk_add_f32 v[146:147], v[146:147], v[80:81]
v_sub_f32 v84, 0, v242
v_sub_f32 v85, 0, v242
v_pk_add_f32 v[86:87], v[84:85], 0
v_pk_add_f32 v[100:101], v[116:117], v[84:85]
v_pk_add_f32 v[102:103], v[118:119], v[84:85]
v_pk_add_f32 v[132:133], v[132:133], v[84:85]
v_pk_add_f32 v[134:135], v[134:135], v[84:85]
v_pk_add_f32 v[148:149], v[148:149], v[84:85]
v_pk_add_f32 v[150:151], v[150:151], v[84:85]
v_add_u32 v2, s82, v1
s_waitcnt vmcnt(13) lgkmcnt(0)
s_barrier
s_cmp_eq_u32 s60, 0
s_cbranch_scc1 LP0x
v_mfma_f32_16x16x32_bf16 v[164:167], a[160:163], v[32:35], v[84:87]
s_xor_b32 s74, s82, 0x10000
v_exp_f32 v128, v128
v_mfma_f32_16x16x32_bf16 v[164:167], a[164:167], v[36:39], v[164:167]
s_add_u32 s74, s74, s64
ds_read_b128 a[128:131], v2 offset:16384
ds_read_b128 a[132:135], v2 offset:17408
v_mfma_f32_16x16x32_bf16 v[164:167], a[168:171], v[40:43], v[164:167]
s_add_u32 s81, s81, 0x8000
v_exp_f32 v129, v129
v_mfma_f32_16x16x32_bf16 v[164:167], a[172:175], v[44:47], v[164:167]
s_add_u32 m0, s74, 16384
v_exp_f32 v130, v130
v_mfma_f32_16x16x32_bf16 v[172:175], a[172:175], v[76:79], v[92:95]
s_add_u32 s72, s81, 16384
v_exp_f32 v131, v131
v_mfma_f32_16x16x32_bf16 v[172:175], a[168:171], v[72:75], v[172:175]
v_exp_f32 v144, v144
v_mfma_f32_16x16x32_bf16 v[172:175], a[164:167], v[68:71], v[172:175]
s_nop 0
ds_read_b128 a[136:139], v2 offset:18432
ds_read_b128 a[140:143], v2 offset:19456
v_mfma_f32_16x16x32_bf16 v[172:175], a[160:163], v[64:67], v[172:175]
s_nop 0
ds_read_b128 a[144:147], v2 offset:20480
ds_read_b128 a[148:151], v2 offset:21504
v_mfma_f32_16x16x32_bf16 v[188:191], a[176:179], v[64:67], v[92:95]
s_nop 0
ds_read_b128 a[152:155], v2 offset:22528
ds_read_b128 a[156:159], v2 offset:23552
v_mfma_f32_16x16x32_bf16 v[188:191], a[180:183], v[68:71], v[188:191]
s_nop 0
ds_read_b128 a[192:195], v2 offset:0
ds_read_b128 a[196:199], v2 offset:1024
v_mfma_f32_16x16x32_bf16 v[188:191], a[184:187], v[72:75], v[188:191]
s_nop 0
ds_read_b128 a[200:203], v2 offset:2048
ds_read_b128 a[204:207], v2 offset:3072
v_mfma_f32_16x16x32_bf16 v[188:191], a[188:191], v[76:79], v[188:191]
s_nop 0
ds_read_b128 a[208:211], v2 offset:4096
ds_read_b128 a[212:215], v2 offset:5120
v_mfma_f32_16x16x32_bf16 v[180:183], a[188:191], v[44:47], v[84:87]
s_nop 0
ds_read_b128 a[216:219], v2 offset:6144
ds_read_b128 a[220:223], v2 offset:7168
v_mfma_f32_16x16x32_bf16 v[180:183], a[184:187], v[40:43], v[180:183]
v_cvt_pk_bf16_f32 v192, v128, v129
v_cvt_pk_bf16_f32 v193, v130, v131
v_mfma_f32_16x16x32_bf16 v[180:183], a[180:183], v[36:39], v[180:183]
buffer_load_dwordx4 v1, s[44:47], s72 offen sc1 lds
v_mfma_f32_16x16x32_bf16 v[180:183], a[176:179], v[32:35], v[180:183]
v_exp_f32 v145, v145
v_mfma_f32_16x16x32_bf16 v[160:163], a[160:163], v[16:19], v[80:83]
v_exp_f32 v146, v146
v_mfma_f32_16x16x32_bf16 v[160:163], a[164:167], v[20:23], v[160:163]
v_exp_f32 v147, v147
v_mfma_f32_16x16x32_bf16 v[160:163], a[168:171], v[24:27], v[160:163]
v_exp_f32 v136, v136
v_mfma_f32_16x16x32_bf16 v[160:163], a[172:175], v[28:31], v[160:163]
v_cvt_pk_bf16_f32 v194, v144, v145
v_cvt_pk_bf16_f32 v195, v146, v147
v_mfma_f32_16x16x32_bf16 v[168:171], a[172:175], v[60:63], v[88:91]
v_exp_f32 v137, v137
v_mfma_f32_16x16x32_bf16 v[168:171], a[168:171], v[56:59], v[168:171]
v_exp_f32 v138, v138
v_mfma_f32_16x16x32_bf16 v[168:171], a[164:167], v[52:55], v[168:171]
v_exp_f32 v139, v139
v_mfma_f32_16x16x32_bf16 v[168:171], a[160:163], v[48:51], v[168:171]
v_exp_f32 v152, v152
v_mfma_f32_16x16x32_bf16 v[184:187], a[176:179], v[48:51], v[88:91]
v_cvt_pk_bf16_f32 v200, v136, v137
v_cvt_pk_bf16_f32 v201, v138, v139
v_mfma_f32_16x16x32_bf16 v[184:187], a[180:183], v[52:55], v[184:187]
buffer_load_dwordx4 v1, s[44:47], s72 offen offset:1024 sc1 lds
v_mfma_f32_16x16x32_bf16 v[184:187], a[184:187], v[56:59], v[184:187]
v_exp_f32 v153, v153
v_mfma_f32_16x16x32_bf16 v[184:187], a[188:191], v[60:63], v[184:187]
v_exp_f32 v154, v154
v_mfma_f32_16x16x32_bf16 v[176:179], a[188:191], v[28:31], v[80:83]
v_exp_f32 v155, v155
v_mfma_f32_16x16x32_bf16 v[176:179], a[184:187], v[24:27], v[176:179]
buffer_load_dwordx4 v1, s[44:47], s72 offen offset:2048 sc1 lds
v_mfma_f32_16x16x32_bf16 v[176:179], a[180:183], v[20:23], v[176:179]
buffer_load_dwordx4 v1, s[44:47], s72 offen offset:3072 sc1 lds
v_mfma_f32_16x16x32_bf16 v[176:179], a[176:179], v[16:19], v[176:179]
s_waitcnt lgkmcnt(4)
v_exp_f32 v132, v132
v_cvt_pk_bf16_f32 v202, v152, v153
v_cvt_pk_bf16_f32 v203, v154, v155
v_exp_f32 v133, v133
v_exp_f32 v134, v134
v_cvt_pk_bf16_f32 v196, v132, v133
v_exp_f32 v135, v135
v_exp_f32 v148, v148
v_cvt_pk_bf16_f32 v197, v134, v135
v_exp_f32 v149, v149
v_exp_f32 v150, v150
v_cvt_pk_bf16_f32 v198, v148, v149
v_exp_f32 v151, v151
v_exp_f32 v140, v140
v_cvt_pk_bf16_f32 v199, v150, v151
v_exp_f32 v141, v141
v_exp_f32 v142, v142
v_cvt_pk_bf16_f32 v204, v140, v141
v_exp_f32 v143, v143
v_exp_f32 v156, v156
v_cvt_pk_bf16_f32 v205, v142, v143
v_exp_f32 v157, v157
v_exp_f32 v158, v158
v_cvt_pk_bf16_f32 v206, v156, v157
v_exp_f32 v159, v159
s_nop 0
v_cvt_pk_bf16_f32 v207, v158, v159
v_mfma_f32_16x16x32_bf16 v[224:227], v[120:123], v[192:195], 0
s_add_u32 s82, s82, 0x8000
ds_read_b128 a[160:163], v2 offset:24576
ds_read_b128 a[164:167], v2 offset:25600
v_mfma_f32_16x16x32_bf16 v[232:235], v[120:123], v[200:203], 0
s_and_b32 s82, s82, 0x1ffff
v_exp_f32 v164, v164
v_mfma_f32_16x16x32_bf16 a[0:3], a[192:195], v[192:195], 0
s_add_u32 m0, s74, 0
v_exp_f32 v165, v165
v_mfma_f32_16x16x32_bf16 a[64:67], a[192:195], v[200:203], 0
s_add_u32 s72, s81, 0
v_exp_f32 v166, v166
v_mfma_f32_16x16x32_bf16 a[68:71], a[196:199], v[200:203], 0
buffer_load_dwordx4 v1, s[44:47], s72 offen sc1 lds
v_mfma_f32_16x16x32_bf16 a[4:7], a[196:199], v[192:195], 0
v_exp_f32 v167, v167
v_mfma_f32_16x16x32_bf16 a[8:11], a[200:203], v[192:195], 0
ds_read_b128 a[168:171], v2 offset:26624
v_cvt_pk_bf16_f32 v212, v164, v165
v_mfma_f32_16x16x32_bf16 a[72:75], a[200:203], v[200:203], 0
v_exp_f32 v180, v180
v_mfma_f32_16x16x32_bf16 a[76:79], a[204:207], v[200:203], 0
v_exp_f32 v181, v181
v_mfma_f32_16x16x32_bf16 a[12:15], a[204:207], v[192:195], 0
s_waitcnt lgkmcnt(3)
ds_read_b128 a[172:175], v2 offset:27648
v_cvt_pk_bf16_f32 v213, v166, v167
v_mfma_f32_16x16x32_bf16 a[16:19], a[208:211], v[192:195], 0
v_exp_f32 v182, v182
v_mfma_f32_16x16x32_bf16 a[80:83], a[208:211], v[200:203], 0
buffer_load_dwordx4 v1, s[44:47], s72 offen offset:1024 sc1 lds
v_mfma_f32_16x16x32_bf16 a[84:87], a[212:215], v[200:203], 0
v_exp_f32 v183, v183
v_mfma_f32_16x16x32_bf16 a[20:23], a[212:215], v[192:195], 0
s_nop 0
ds_read_b128 a[176:179], v2 offset:28672
ds_read_b128 a[180:183], v2 offset:29696
v_mfma_f32_16x16x32_bf16 a[24:27], a[216:219], v[192:195], 0
v_exp_f32 v172, v172
v_mfma_f32_16x16x32_bf16 a[88:91], a[216:219], v[200:203], 0
s_nop 0
ds_read_b128 a[184:187], v2 offset:30720
ds_read_b128 a[188:191], v2 offset:31744
v_mfma_f32_16x16x32_bf16 a[92:95], a[220:223], v[200:203], 0
s_nop 0
ds_read_b128 a[224:227], v2 offset:8192
ds_read_b128 a[228:231], v2 offset:9216
v_mfma_f32_16x16x32_bf16 a[28:31], a[220:223], v[192:195], 0
s_nop 0
ds_read_b128 a[232:235], v2 offset:10240
ds_read_b128 a[236:239], v2 offset:11264
v_mfma_f32_16x16x32_bf16 v[128:131], a[128:131], v[16:19], v[80:83]
s_nop 0
ds_read_b128 a[240:243], v2 offset:12288
ds_read_b128 a[244:247], v2 offset:13312
v_mfma_f32_16x16x32_bf16 v[128:131], a[132:135], v[20:23], v[128:131]
s_nop 0
ds_read_b128 a[248:251], v2 offset:14336
ds_read_b128 a[252:255], v2 offset:15360
v_mfma_f32_16x16x32_bf16 v[128:131], a[136:139], v[24:27], v[128:131]
v_cvt_pk_bf16_f32 v214, v180, v181
v_cvt_pk_bf16_f32 v215, v182, v183
v_mfma_f32_16x16x32_bf16 v[128:131], a[140:143], v[28:31], v[128:131]
v_exp_f32 v173, v173
v_mfma_f32_16x16x32_bf16 v[136:139], a[140:143], v[60:63], v[88:91]
v_exp_f32 v174, v174
v_mfma_f32_16x16x32_bf16 v[136:139], a[136:139], v[56:59], v[136:139]
buffer_load_dwordx4 v1, s[44:47], s72 offen offset:2048 sc1 lds
v_mfma_f32_16x16x32_bf16 v[136:139], a[132:135], v[52:55], v[136:139]
Lstub1:
s_cbranch_execz Lstub5
v_exp_f32 v175, v175
v_mfma_f32_16x16x32_bf16 v[136:139], a[128:131], v[48:51], v[136:139]
v_exp_f32 v188, v188
v_mfma_f32_16x16x32_bf16 v[152:155], a[144:147], v[48:51], v[88:91]
v_cvt_pk_bf16_f32 v220, v172, v173
v_cvt_pk_bf16_f32 v221, v174, v175
v_mfma_f32_16x16x32_bf16 v[152:155], a[148:151], v[52:55], v[152:155]
v_exp_f32 v189, v189
v_mfma_f32_16x16x32_bf16 v[152:155], a[152:155], v[56:59], v[152:155]
v_exp_f32 v190, v190
v_mfma_f32_16x16x32_bf16 v[152:155], a[156:159], v[60:63], v[152:155]
buffer_load_dwordx4 v1, s[44:47], s72 offen offset:3072 sc1 lds
v_mfma_f32_16x16x32_bf16 v[144:147], a[156:159], v[28:31], v[80:83]
s_add_u32 s66, s58, 1
v_exp_f32 v191, v191
v_mfma_f32_16x16x32_bf16 v[144:147], a[152:155], v[24:27], v[144:147]
s_and_b32 s66, s66, 3
v_exp_f32 v160, v160
v_mfma_f32_16x16x32_bf16 v[144:147], a[148:151], v[20:23], v[144:147]
s_mul_i32 s66, s66, 4160
v_cvt_pk_bf16_f32 v222, v188, v189
v_cvt_pk_bf16_f32 v223, v190, v191
v_mfma_f32_16x16x32_bf16 v[144:147], a[144:147], v[16:19], v[144:147]
s_add_u32 m0, s66, 131104
v_exp_f32 v161, v161
v_mfma_f32_16x16x32_bf16 v[132:135], a[128:131], v[32:35], v[84:87]
s_add_u32 s72, s93, 0x2
buffer_load_dwordx4 v1, s[36:39], s72 offen lds
v_mfma_f32_16x16x32_bf16 v[132:135], a[132:135], v[36:39], v[132:135]
v_exp_f32 v162, v162
v_mfma_f32_16x16x32_bf16 v[132:135], a[136:139], v[40:43], v[132:135]
v_exp_f32 v163, v163
v_mfma_f32_16x16x32_bf16 v[132:135], a[140:143], v[44:47], v[132:135]
v_exp_f32 v176, v176
v_mfma_f32_16x16x32_bf16 v[140:143], a[140:143], v[76:79], v[92:95]
v_cvt_pk_bf16_f32 v208, v160, v161
v_cvt_pk_bf16_f32 v209, v162, v163
v_mfma_f32_16x16x32_bf16 v[140:143], a[136:139], v[72:75], v[140:143]
v_exp_f32 v177, v177
v_mfma_f32_16x16x32_bf16 v[140:143], a[132:135], v[68:71], v[140:143]
buffer_load_dwordx4 v1, s[36:39], s72 offen offset:1024 lds
v_mfma_f32_16x16x32_bf16 v[140:143], a[128:131], v[64:67], v[140:143]
v_exp_f32 v178, v178
v_mfma_f32_16x16x32_bf16 v[156:159], a[144:147], v[64:67], v[92:95]
v_exp_f32 v179, v179
v_mfma_f32_16x16x32_bf16 v[156:159], a[148:151], v[68:71], v[156:159]
v_exp_f32 v168, v168
v_mfma_f32_16x16x32_bf16 v[156:159], a[152:155], v[72:75], v[156:159]
v_cvt_pk_bf16_f32 v210, v176, v177
v_cvt_pk_bf16_f32 v211, v178, v179
v_mfma_f32_16x16x32_bf16 v[156:159], a[156:159], v[76:79], v[156:159]
v_exp_f32 v169, v169
v_mfma_f32_16x16x32_bf16 v[148:151], a[156:159], v[44:47], v[84:87]
buffer_load_dwordx4 v1, s[36:39], s72 offen offset:2048 lds
v_mfma_f32_16x16x32_bf16 v[148:151], a[152:155], v[40:43], v[148:151]
buffer_load_dwordx4 v1, s[36:39], s72 offen offset:3072 lds
v_mfma_f32_16x16x32_bf16 v[148:151], a[148:151], v[36:39], v[148:151]
s_waitcnt vmcnt(12) lgkmcnt(4)
v_exp_f32 v170, v170
v_mfma_f32_16x16x32_bf16 v[148:151], a[144:147], v[32:35], v[148:151]
s_barrier
v_exp_f32 v171, v171
v_add_u32 v2, s82, v1
v_cvt_pk_bf16_f32 v216, v168, v169
v_exp_f32 v184, v184
v_cvt_pk_bf16_f32 v217, v170, v171
v_exp_f32 v185, v185
v_exp_f32 v186, v186
v_cvt_pk_bf16_f32 v218, v184, v185
v_exp_f32 v187, v187
s_nop 0
v_cvt_pk_bf16_f32 v219, v186, v187
s_lshl_b32 s75, s59, 4
s_and_b32 s76, s84, 15
s_add_u32 s75, s75, s76
s_lshl_b32 s75, s75, 14
s_cmp_ge_u32 s60, 4
s_cselect_b32 s75, s75, 0x40001000
s_lshl_b32 s83, s60, 1
s_sub_u32 s83, 2, s83
s_cmp_eq_u32 s83, 0
s_cbranch_scc1 LLT1
.p2align 5
s_nop 0
s_nop 0
LloopI:
v_mfma_f32_16x16x32_bf16 v[228:231], v[120:123], v[196:199], v[228:231]
s_xor_b32 s74, s82, 0x10000
v_exp_f32 v128, v128
v_mfma_f32_16x16x32_bf16 v[228:231], v[120:123], v[212:215], v[228:231]
s_add_u32 s74, s74, s64
ds_read_b128 a[128:131], v2 offset:16384
v_add_u32 v15, s75, v3
v_mfma_f32_16x16x32_bf16 v[236:239], v[120:123], v[204:207], v[236:239]
s_add_u32 s81, s81, 0x8000
v_exp_f32 v129, v129
v_mfma_f32_16x16x32_bf16 v[236:239], v[120:123], v[220:223], v[236:239]
s_add_u32 m0, s74, 16384
v_exp_f32 v130, v130
v_mfma_f32_16x16x32_bf16 a[32:35], a[192:195], v[196:199], a[32:35]
s_add_u32 s72, s81, 16384
ds_read_b128 a[132:135], v2 offset:17408
v_cvt_pk_bf16_f32 v192, v128, v129
v_mfma_f32_16x16x32_bf16 a[32:35], a[224:227], v[212:215], a[32:35]
v_exp_f32 v131, v131
v_mfma_f32_16x16x32_bf16 a[96:99], a[224:227], v[220:223], a[96:99]
v_exp_f32 v144, v144
v_mfma_f32_16x16x32_bf16 a[96:99], a[192:195], v[204:207], a[96:99]
ds_read_b128 a[136:139], v2 offset:18432
v_cvt_pk_bf16_f32 v193, v130, v131
v_mfma_f32_16x16x32_bf16 a[100:103], a[196:199], v[204:207], a[100:103]
buffer_load_dwordx4 v1, s[44:47], s72 offen sc1 lds
v_mfma_f32_16x16x32_bf16 a[100:103], a[228:231], v[220:223], a[100:103]
v_exp_f32 v145, v145
v_mfma_f32_16x16x32_bf16 a[36:39], a[228:231], v[212:215], a[36:39]
v_exp_f32 v146, v146
v_mfma_f32_16x16x32_bf16 a[36:39], a[196:199], v[196:199], a[36:39]
ds_read_b128 a[140:143], v2 offset:19456
v_cvt_pk_bf16_f32 v194, v144, v145
v_mfma_f32_16x16x32_bf16 a[40:43], a[200:203], v[196:199], a[40:43]
v_exp_f32 v147, v147
v_mfma_f32_16x16x32_bf16 a[40:43], a[232:235], v[212:215], a[40:43]
v_exp_f32 v136, v136
v_mfma_f32_16x16x32_bf16 a[104:107], a[232:235], v[220:223], a[104:107]
ds_read_b128 a[144:147], v2 offset:20480
v_cvt_pk_bf16_f32 v195, v146, v147
v_mfma_f32_16x16x32_bf16 a[104:107], a[200:203], v[204:207], a[104:107]
v_exp_f32 v137, v137
v_mfma_f32_16x16x32_bf16 a[108:111], a[204:207], v[204:207], a[108:111]
v_exp_f32 v138, v138
v_mfma_f32_16x16x32_bf16 a[108:111], a[236:239], v[220:223], a[108:111]
ds_read_b128 a[148:151], v2 offset:21504
v_cvt_pk_bf16_f32 v200, v136, v137
v_mfma_f32_16x16x32_bf16 a[44:47], a[236:239], v[212:215], a[44:47]
v_exp_f32 v139, v139
v_mfma_f32_16x16x32_bf16 a[44:47], a[204:207], v[196:199], a[44:47]
v_exp_f32 v152, v152
v_mfma_f32_16x16x32_bf16 a[48:51], a[208:211], v[196:199], a[48:51]
s_waitcnt lgkmcnt(6)
ds_read_b128 a[152:155], v2 offset:22528
v_cvt_pk_bf16_f32 v201, v138, v139
v_mfma_f32_16x16x32_bf16 a[48:51], a[240:243], v[212:215], a[48:51]
buffer_load_dwordx4 v1, s[44:47], s72 offen offset:1024 sc1 lds
v_mfma_f32_16x16x32_bf16 a[112:115], a[240:243], v[220:223], a[112:115]
v_exp_f32 v153, v153
v_mfma_f32_16x16x32_bf16 a[112:115], a[208:211], v[204:207], a[112:115]
v_exp_f32 v154, v154
v_mfma_f32_16x16x32_bf16 a[116:119], a[212:215], v[204:207], a[116:119]
ds_read_b128 a[156:159], v2 offset:23552
v_cvt_pk_bf16_f32 v202, v152, v153
v_mfma_f32_16x16x32_bf16 a[116:119], a[244:247], v[220:223], a[116:119]
v_exp_f32 v155, v155
v_mfma_f32_16x16x32_bf16 a[52:55], a[244:247], v[212:215], a[52:55]
v_exp_f32 v132, v132
v_mfma_f32_16x16x32_bf16 a[52:55], a[212:215], v[196:199], a[52:55]
ds_read_b128 a[192:195], v2 offset:0
v_cvt_pk_bf16_f32 v203, v154, v155
v_mfma_f32_16x16x32_bf16 a[56:59], a[216:219], v[196:199], a[56:59]
v_exp_f32 v133, v133
v_mfma_f32_16x16x32_bf16 a[56:59], a[248:251], v[212:215], a[56:59]
v_exp_f32 v134, v134
v_mfma_f32_16x16x32_bf16 a[120:123], a[248:251], v[220:223], a[120:123]
ds_read_b128 a[196:199], v2 offset:1024
v_mfma_f32_16x16x32_bf16 a[120:123], a[216:219], v[204:207], a[120:123]
v_exp_f32 v135, v135
v_mfma_f32_16x16x32_bf16 a[124:127], a[220:223], v[204:207], a[124:127]
v_exp_f32 v148, v148
v_mfma_f32_16x16x32_bf16 a[124:127], a[252:255], v[220:223], a[124:127]
ds_read_b128 a[200:203], v2 offset:2048
v_mfma_f32_16x16x32_bf16 a[60:63], a[252:255], v[212:215], a[60:63]
buffer_load_dwordx4 v1, s[44:47], s72 offen offset:2048 sc1 lds
v_mfma_f32_16x16x32_bf16 a[60:63], a[220:223], v[196:199], a[60:63]
ds_read_b128 a[204:207], v2 offset:3072
v_cvt_pk_bf16_f32 v196, v132, v133
v_mfma_f32_16x16x32_bf16 v[164:167], a[160:163], v[32:35], v[84:87]
v_exp_f32 v149, v149
v_mfma_f32_16x16x32_bf16 v[164:167], a[164:167], v[36:39], v[164:167]
v_exp_f32 v150, v150
v_mfma_f32_16x16x32_bf16 v[164:167], a[168:171], v[40:43], v[164:167]
ds_read_b128 a[208:211], v2 offset:4096
v_cvt_pk_bf16_f32 v197, v134, v135
v_mfma_f32_16x16x32_bf16 v[164:167], a[172:175], v[44:47], v[164:167]
v_exp_f32 v151, v151
v_mfma_f32_16x16x32_bf16 v[172:175], a[172:175], v[76:79], v[92:95]
v_exp_f32 v140, v140
v_mfma_f32_16x16x32_bf16 v[172:175], a[168:171], v[72:75], v[172:175]
ds_read_b128 a[212:215], v2 offset:5120
v_cvt_pk_bf16_f32 v198, v148, v149
v_mfma_f32_16x16x32_bf16 v[172:175], a[164:167], v[68:71], v[172:175]
v_exp_f32 v141, v141
v_mfma_f32_16x16x32_bf16 v[172:175], a[160:163], v[64:67], v[172:175]
v_exp_f32 v142, v142
v_mfma_f32_16x16x32_bf16 v[188:191], a[176:179], v[64:67], v[92:95]
ds_read_b128 a[216:219], v2 offset:6144
v_cvt_pk_bf16_f32 v199, v150, v151
v_mfma_f32_16x16x32_bf16 v[188:191], a[180:183], v[68:71], v[188:191]
v_exp_f32 v143, v143
v_mfma_f32_16x16x32_bf16 v[188:191], a[184:187], v[72:75], v[188:191]
v_exp_f32 v156, v156
v_mfma_f32_16x16x32_bf16 v[188:191], a[188:191], v[76:79], v[188:191]
ds_read_b128 a[220:223], v2 offset:7168
v_cvt_pk_bf16_f32 v204, v140, v141
v_mfma_f32_16x16x32_bf16 v[180:183], a[188:191], v[44:47], v[84:87]
buffer_load_dwordx4 v1, s[44:47], s72 offen offset:3072 sc1 lds
v_mfma_f32_16x16x32_bf16 v[180:183], a[184:187], v[40:43], v[180:183]
v_exp_f32 v157, v157
v_mfma_f32_16x16x32_bf16 v[180:183], a[180:183], v[36:39], v[180:183]
v_exp_f32 v158, v158
v_mfma_f32_16x16x32_bf16 v[180:183], a[176:179], v[32:35], v[180:183]
v_cvt_pk_bf16_f32 v205, v142, v143
v_cvt_pk_bf16_f32 v206, v156, v157
v_mfma_f32_16x16x32_bf16 v[160:163], a[160:163], v[16:19], v[80:83]
v_exp_f32 v159, v159
v_mfma_f32_16x16x32_bf16 v[160:163], a[164:167], v[20:23], v[160:163]
v_cvt_pk_bf16_f32 v207, v158, v159
v_mfma_f32_16x16x32_bf16 v[160:163], a[168:171], v[24:27], v[160:163]
v_mfma_f32_16x16x32_bf16 v[160:163], a[172:175], v[28:31], v[160:163]
v_mfma_f32_16x16x32_bf16 v[168:171], a[172:175], v[60:63], v[88:91]
v_mfma_f32_16x16x32_bf16 v[168:171], a[168:171], v[56:59], v[168:171]
v_mfma_f32_16x16x32_bf16 v[168:171], a[164:167], v[52:55], v[168:171]
v_mfma_f32_16x16x32_bf16 v[168:171], a[160:163], v[48:51], v[168:171]
v_mfma_f32_16x16x32_bf16 v[184:187], a[176:179], v[48:51], v[88:91]
v_mfma_f32_16x16x32_bf16 v[184:187], a[180:183], v[52:55], v[184:187]
v_mfma_f32_16x16x32_bf16 v[184:187], a[184:187], v[56:59], v[184:187]
v_mfma_f32_16x16x32_bf16 v[184:187], a[188:191], v[60:63], v[184:187]
v_mfma_f32_16x16x32_bf16 v[176:179], a[188:191], v[28:31], v[80:83]
v_mfma_f32_16x16x32_bf16 v[176:179], a[184:187], v[24:27], v[176:179]
v_mfma_f32_16x16x32_bf16 v[176:179], a[180:183], v[20:23], v[176:179]
v_mfma_f32_16x16x32_bf16 v[176:179], a[176:179], v[16:19], v[176:179]
s_waitcnt lgkmcnt(4)
v_mfma_f32_16x16x32_bf16 v[224:227], v[120:123], v[208:211], v[224:227]
s_add_u32 s82, s82, 0x8000
ds_read_b128 a[160:163], v2 offset:24576
v_mfma_f32_16x16x32_bf16 v[224:227], v[120:123], v[192:195], v[224:227]
s_and_b32 s82, s82, 0x1ffff
v_exp_f32 v164, v164
v_mfma_f32_16x16x32_bf16 v[232:235], v[120:123], v[216:219], v[232:235]
s_add_u32 m0, s74, 0
v_exp_f32 v165, v165
v_mfma_f32_16x16x32_bf16 v[232:235], v[120:123], v[200:203], v[232:235]
s_add_u32 s72, s81, 0
ds_read_b128 a[164:167], v2 offset:25600
v_cvt_pk_bf16_f32 v212, v164, v165
v_mfma_f32_16x16x32_bf16 a[0:3], a[224:227], v[208:211], a[0:3]
v_exp_f32 v166, v166
v_mfma_f32_16x16x32_bf16 a[0:3], a[192:195], v[192:195], a[0:3]
v_exp_f32 v167, v167
v_mfma_f32_16x16x32_bf16 a[64:67], a[192:195], v[200:203], a[64:67]
buffer_load_dwordx4 v1, s[44:47], s72 offen sc1 lds
v_mfma_f32_16x16x32_bf16 a[64:67], a[224:227], v[216:219], a[64:67]
ds_read_b128 a[168:171], v2 offset:26624
v_cvt_pk_bf16_f32 v213, v166, v167
v_mfma_f32_16x16x32_bf16 a[68:71], a[228:231], v[216:219], a[68:71]
v_exp_f32 v180, v180
v_mfma_f32_16x16x32_bf16 a[68:71], a[196:199], v[200:203], a[68:71]
v_exp_f32 v181, v181
v_mfma_f32_16x16x32_bf16 a[4:7], a[196:199], v[192:195], a[4:7]
ds_read_b128 a[172:175], v2 offset:27648
v_cvt_pk_bf16_f32 v214, v180, v181
v_mfma_f32_16x16x32_bf16 a[4:7], a[228:231], v[208:211], a[4:7]
v_exp_f32 v182, v182
v_mfma_f32_16x16x32_bf16 a[8:11], a[232:235], v[208:211], a[8:11]
v_exp_f32 v183, v183
v_mfma_f32_16x16x32_bf16 a[8:11], a[200:203], v[192:195], a[8:11]
ds_read_b128 a[176:179], v2 offset:28672
v_cvt_pk_bf16_f32 v215, v182, v183
v_mfma_f32_16x16x32_bf16 a[72:75], a[200:203], v[200:203], a[72:75]
v_exp_f32 v172, v172
v_mfma_f32_16x16x32_bf16 a[72:75], a[232:235], v[216:219], a[72:75]
v_exp_f32 v173, v173
v_mfma_f32_16x16x32_bf16 a[76:79], a[236:239], v[216:219], a[76:79]
ds_read_b128 a[180:183], v2 offset:29696
v_cvt_pk_bf16_f32 v220, v172, v173
v_mfma_f32_16x16x32_bf16 a[76:79], a[204:207], v[200:203], a[76:79]
buffer_load_dwordx4 v1, s[44:47], s72 offen offset:1024 sc1 lds
v_mfma_f32_16x16x32_bf16 a[12:15], a[204:207], v[192:195], a[12:15]
v_exp_f32 v174, v174
v_mfma_f32_16x16x32_bf16 a[12:15], a[236:239], v[208:211], a[12:15]
v_exp_f32 v175, v175
v_mfma_f32_16x16x32_bf16 a[16:19], a[240:243], v[208:211], a[16:19]
s_waitcnt lgkmcnt(6)
ds_read_b128 a[184:187], v2 offset:30720
v_cvt_pk_bf16_f32 v221, v174, v175
v_mfma_f32_16x16x32_bf16 a[16:19], a[208:211], v[192:195], a[16:19]
v_exp_f32 v188, v188
v_mfma_f32_16x16x32_bf16 a[80:83], a[208:211], v[200:203], a[80:83]
v_exp_f32 v189, v189
v_mfma_f32_16x16x32_bf16 a[80:83], a[240:243], v[216:219], a[80:83]
ds_read_b128 a[188:191], v2 offset:31744
v_cvt_pk_bf16_f32 v222, v188, v189
v_mfma_f32_16x16x32_bf16 a[84:87], a[244:247], v[216:219], a[84:87]
v_exp_f32 v190, v190
v_mfma_f32_16x16x32_bf16 a[84:87], a[212:215], v[200:203], a[84:87]
v_exp_f32 v191, v191
v_mfma_f32_16x16x32_bf16 a[20:23], a[212:215], v[192:195], a[20:23]
ds_read_b128 a[224:227], v2 offset:8192
v_cvt_pk_bf16_f32 v223, v190, v191
v_mfma_f32_16x16x32_bf16 a[20:23], a[244:247], v[208:211], a[20:23]
v_exp_f32 v160, v160
v_mfma_f32_16x16x32_bf16 a[24:27], a[248:251], v[208:211], a[24:27]
buffer_load_dwordx4 v1, s[44:47], s72 offen offset:2048 sc1 lds
v_mfma_f32_16x16x32_bf16 a[24:27], a[216:219], v[192:195], a[24:27]
v_exp_f32 v161, v161
v_mfma_f32_16x16x32_bf16 a[88:91], a[216:219], v[200:203], a[88:91]
ds_read_b128 a[228:231], v2 offset:9216
v_mfma_f32_16x16x32_bf16 a[88:91], a[248:251], v[216:219], a[88:91]
v_exp_f32 v162, v162
v_mfma_f32_16x16x32_bf16 a[92:95], a[252:255], v[216:219], a[92:95]
v_exp_f32 v163, v163
v_mfma_f32_16x16x32_bf16 a[92:95], a[220:223], v[200:203], a[92:95]
ds_read_b128 a[232:235], v2 offset:10240
v_mfma_f32_16x16x32_bf16 a[28:31], a[220:223], v[192:195], a[28:31]
v_exp_f32 v176, v176
v_mfma_f32_16x16x32_bf16 a[28:31], a[252:255], v[208:211], a[28:31]
ds_read_b128 a[236:239], v2 offset:11264
v_cvt_pk_bf16_f32 v208, v160, v161
v_mfma_f32_16x16x32_bf16 v[128:131], a[128:131], v[16:19], v[80:83]
v_exp_f32 v177, v177
v_mfma_f32_16x16x32_bf16 v[128:131], a[132:135], v[20:23], v[128:131]
v_exp_f32 v178, v178
v_mfma_f32_16x16x32_bf16 v[128:131], a[136:139], v[24:27], v[128:131]
ds_read_b128 a[240:243], v2 offset:12288
v_cvt_pk_bf16_f32 v209, v162, v163
v_mfma_f32_16x16x32_bf16 v[128:131], a[140:143], v[28:31], v[128:131]
buffer_load_dwordx4 v1, s[44:47], s72 offen offset:3072 sc1 lds
v_mfma_f32_16x16x32_bf16 v[136:139], a[140:143], v[60:63], v[88:91]
s_add_u32 s75, s75, 0x1000
v_exp_f32 v179, v179
v_mfma_f32_16x16x32_bf16 v[136:139], a[136:139], v[56:59], v[136:139]
s_and_b32 s76, s75, 0x3000
v_exp_f32 v168, v168
v_mfma_f32_16x16x32_bf16 v[136:139], a[132:135], v[52:55], v[136:139]
s_cselect_b32 s75, s75, 0x40001000
ds_read_b128 a[244:247], v2 offset:13312
v_cvt_pk_bf16_f32 v210, v176, v177
v_mfma_f32_16x16x32_bf16 v[136:139], a[128:131], v[48:51], v[136:139]
v_exp_f32 v169, v169
v_mfma_f32_16x16x32_bf16 v[152:155], a[144:147], v[48:51], v[88:91]
v_exp_f32 v170, v170
v_mfma_f32_16x16x32_bf16 v[152:155], a[148:151], v[52:55], v[152:155]
ds_read_b128 a[248:251], v2 offset:14336
v_cvt_pk_bf16_f32 v211, v178, v179
v_mfma_f32_16x16x32_bf16 v[152:155], a[152:155], v[56:59], v[152:155]
v_exp_f32 v171, v171
v_mfma_f32_16x16x32_bf16 v[152:155], a[156:159], v[60:63], v[152:155]
v_exp_f32 v184, v184
v_mfma_f32_16x16x32_bf16 v[144:147], a[156:159], v[28:31], v[80:83]
ds_read_b128 a[252:255], v2 offset:15360
v_cvt_pk_bf16_f32 v216, v168, v169
v_mfma_f32_16x16x32_bf16 v[144:147], a[152:155], v[24:27], v[144:147]
buffer_load_dword v4, v15, s[24:27], 0 offen
v_mfma_f32_16x16x32_bf16 v[144:147], a[148:151], v[20:23], v[144:147]
v_exp_f32 v185, v185
v_mfma_f32_16x16x32_bf16 v[144:147], a[144:147], v[16:19], v[144:147]
v_exp_f32 v186, v186
v_mfma_f32_16x16x32_bf16 v[132:135], a[128:131], v[32:35], v[84:87]
v_cvt_pk_bf16_f32 v217, v170, v171
v_cvt_pk_bf16_f32 v218, v184, v185
v_mfma_f32_16x16x32_bf16 v[132:135], a[132:135], v[36:39], v[132:135]
v_exp_f32 v187, v187
v_mfma_f32_16x16x32_bf16 v[132:135], a[136:139], v[40:43], v[132:135]
v_cvt_pk_bf16_f32 v219, v186, v187
v_add_u32 v2, s82, v1
v_mfma_f32_16x16x32_bf16 v[132:135], a[140:143], v[44:47], v[132:135]
v_mfma_f32_16x16x32_bf16 v[140:143], a[140:143], v[76:79], v[92:95]
v_mfma_f32_16x16x32_bf16 v[140:143], a[136:139], v[72:75], v[140:143]
v_mfma_f32_16x16x32_bf16 v[140:143], a[132:135], v[68:71], v[140:143]
v_mfma_f32_16x16x32_bf16 v[140:143], a[128:131], v[64:67], v[140:143]
v_mfma_f32_16x16x32_bf16 v[156:159], a[144:147], v[64:67], v[92:95]
v_mfma_f32_16x16x32_bf16 v[156:159], a[148:151], v[68:71], v[156:159]
v_mfma_f32_16x16x32_bf16 v[156:159], a[152:155], v[72:75], v[156:159]
v_mfma_f32_16x16x32_bf16 v[156:159], a[156:159], v[76:79], v[156:159]
v_mfma_f32_16x16x32_bf16 v[148:151], a[156:159], v[44:47], v[84:87]
s_waitcnt vmcnt(9) lgkmcnt(4)
v_mfma_f32_16x16x32_bf16 v[148:151], a[152:155], v[40:43], v[148:151]
s_barrier
v_mfma_f32_16x16x32_bf16 v[148:151], a[148:151], v[36:39], v[148:151]
s_add_u32 s83, s83, 1
v_mfma_f32_16x16x32_bf16 v[148:151], a[144:147], v[32:35], v[148:151]
s_cbranch_scc0 LloopI
LLT1:
Lstub2:
s_cbranch_execz Lstub6
v_mfma_f32_16x16x32_bf16 v[228:231], v[120:123], v[196:199], v[228:231]
s_xor_b32 s74, s82, 0x10000
v_exp_f32 v128, v128
v_mfma_f32_16x16x32_bf16 v[228:231], v[120:123], v[212:215], v[228:231]
s_add_u32 s74, s74, s64
ds_read_b128 a[128:131], v2 offset:16384
v_mfma_f32_16x16x32_bf16 v[236:239], v[120:123], v[204:207], v[236:239]
s_add_u32 s81, s81, 0x8000
v_exp_f32 v129, v129
v_mfma_f32_16x16x32_bf16 v[236:239], v[120:123], v[220:223], v[236:239]
s_add_u32 m0, s74, 16384
v_exp_f32 v130, v130
v_mfma_f32_16x16x32_bf16 a[32:35], a[192:195], v[196:199], a[32:35]
s_add_u32 s72, s81, 16384
ds_read_b128 a[132:135], v2 offset:17408
v_cvt_pk_bf16_f32 v192, v128, v129
v_mfma_f32_16x16x32_bf16 a[32:35], a[224:227], v[212:215], a[32:35]
v_exp_f32 v131, v131
v_mfma_f32_16x16x32_bf16 a[96:99], a[224:227], v[220:223], a[96:99]
v_exp_f32 v144, v144
v_mfma_f32_16x16x32_bf16 a[96:99], a[192:195], v[204:207], a[96:99]
ds_read_b128 a[136:139], v2 offset:18432
v_cvt_pk_bf16_f32 v193, v130, v131
v_mfma_f32_16x16x32_bf16 a[100:103], a[196:199], v[204:207], a[100:103]
buffer_load_dwordx4 v1, s[44:47], s72 offen sc1 lds
v_mfma_f32_16x16x32_bf16 a[100:103], a[228:231], v[220:223], a[100:103]
v_exp_f32 v145, v145
v_mfma_f32_16x16x32_bf16 a[36:39], a[228:231], v[212:215], a[36:39]
v_exp_f32 v146, v146
v_mfma_f32_16x16x32_bf16 a[36:39], a[196:199], v[196:199], a[36:39]
ds_read_b128 a[140:143], v2 offset:19456
v_cvt_pk_bf16_f32 v194, v144, v145
v_mfma_f32_16x16x32_bf16 a[40:43], a[200:203], v[196:199], a[40:43]
v_exp_f32 v147, v147
v_mfma_f32_16x16x32_bf16 a[40:43], a[232:235], v[212:215], a[40:43]
v_exp_f32 v136, v136
v_mfma_f32_16x16x32_bf16 a[104:107], a[232:235], v[220:223], a[104:107]
ds_read_b128 a[144:147], v2 offset:20480
v_cvt_pk_bf16_f32 v195, v146, v147
v_mfma_f32_16x16x32_bf16 a[104:107], a[200:203], v[204:207], a[104:107]
v_exp_f32 v137, v137
v_mfma_f32_16x16x32_bf16 a[108:111], a[204:207], v[204:207], a[108:111]
v_exp_f32 v138, v138
v_mfma_f32_16x16x32_bf16 a[108:111], a[236:239], v[220:223], a[108:111]
ds_read_b128 a[148:151], v2 offset:21504
v_cvt_pk_bf16_f32 v200, v136, v137
v_mfma_f32_16x16x32_bf16 a[44:47], a[236:239], v[212:215], a[44:47]
v_exp_f32 v139, v139
v_mfma_f32_16x16x32_bf16 a[44:47], a[204:207], v[196:199], a[44:47]
v_exp_f32 v152, v152
v_mfma_f32_16x16x32_bf16 a[48:51], a[208:211], v[196:199], a[48:51]
s_waitcnt lgkmcnt(6)
ds_read_b128 a[152:155], v2 offset:22528
v_cvt_pk_bf16_f32 v201, v138, v139
v_mfma_f32_16x16x32_bf16 a[48:51], a[240:243], v[212:215], a[48:51]
buffer_load_dwordx4 v1, s[44:47], s72 offen offset:1024 sc1 lds
v_mfma_f32_16x16x32_bf16 a[112:115], a[240:243], v[220:223], a[112:115]
v_exp_f32 v153, v153
v_mfma_f32_16x16x32_bf16 a[112:115], a[208:211], v[204:207], a[112:115]
v_exp_f32 v154, v154
v_mfma_f32_16x16x32_bf16 a[116:119], a[212:215], v[204:207], a[116:119]
ds_read_b128 a[156:159], v2 offset:23552
v_cvt_pk_bf16_f32 v202, v152, v153
v_mfma_f32_16x16x32_bf16 a[116:119], a[244:247], v[220:223], a[116:119]
v_exp_f32 v155, v155
v_mfma_f32_16x16x32_bf16 a[52:55], a[244:247], v[212:215], a[52:55]
v_exp_f32 v132, v132
v_mfma_f32_16x16x32_bf16 a[52:55], a[212:215], v[196:199], a[52:55]
ds_read_b128 a[192:195], v2 offset:0
v_cvt_pk_bf16_f32 v203, v154, v155
v_mfma_f32_16x16x32_bf16 a[56:59], a[216:219], v[196:199], a[56:59]
v_exp_f32 v133, v133
v_mfma_f32_16x16x32_bf16 a[56:59], a[248:251], v[212:215], a[56:59]
v_exp_f32 v134, v134
v_mfma_f32_16x16x32_bf16 a[120:123], a[248:251], v[220:223], a[120:123]
ds_read_b128 a[196:199], v2 offset:1024
v_mfma_f32_16x16x32_bf16 a[120:123], a[216:219], v[204:207], a[120:123]
v_exp_f32 v135, v135
v_mfma_f32_16x16x32_bf16 a[124:127], a[220:223], v[204:207], a[124:127]
v_exp_f32 v148, v148
v_mfma_f32_16x16x32_bf16 a[124:127], a[252:255], v[220:223], a[124:127]
ds_read_b128 a[200:203], v2 offset:2048
v_mfma_f32_16x16x32_bf16 a[60:63], a[252:255], v[212:215], a[60:63]
buffer_load_dwordx4 v1, s[44:47], s72 offen offset:2048 sc1 lds
v_mfma_f32_16x16x32_bf16 a[60:63], a[220:223], v[196:199], a[60:63]
ds_read_b128 a[204:207], v2 offset:3072
v_cvt_pk_bf16_f32 v196, v132, v133
v_mfma_f32_16x16x32_bf16 v[164:167], a[160:163], v[32:35], v[84:87]
v_exp_f32 v149, v149
v_mfma_f32_16x16x32_bf16 v[164:167], a[164:167], v[36:39], v[164:167]
v_exp_f32 v150, v150
v_mfma_f32_16x16x32_bf16 v[164:167], a[168:171], v[40:43], v[164:167]
ds_read_b128 a[208:211], v2 offset:4096
v_cvt_pk_bf16_f32 v197, v134, v135
v_mfma_f32_16x16x32_bf16 v[164:167], a[172:175], v[44:47], v[164:167]
v_exp_f32 v151, v151
v_mfma_f32_16x16x32_bf16 v[172:175], a[172:175], v[76:79], v[92:95]
v_exp_f32 v140, v140
v_mfma_f32_16x16x32_bf16 v[172:175], a[168:171], v[72:75], v[172:175]
ds_read_b128 a[212:215], v2 offset:5120
v_cvt_pk_bf16_f32 v198, v148, v149
v_mfma_f32_16x16x32_bf16 v[172:175], a[164:167], v[68:71], v[172:175]
v_exp_f32 v141, v141
v_mfma_f32_16x16x32_bf16 v[172:175], a[160:163], v[64:67], v[172:175]
v_exp_f32 v142, v142
v_mfma_f32_16x16x32_bf16 v[188:191], a[176:179], v[64:67], v[92:95]
ds_read_b128 a[216:219], v2 offset:6144
v_cvt_pk_bf16_f32 v199, v150, v151
v_mfma_f32_16x16x32_bf16 v[188:191], a[180:183], v[68:71], v[188:191]
v_exp_f32 v143, v143
v_mfma_f32_16x16x32_bf16 v[188:191], a[184:187], v[72:75], v[188:191]
v_exp_f32 v156, v156
v_mfma_f32_16x16x32_bf16 v[188:191], a[188:191], v[76:79], v[188:191]
ds_read_b128 a[220:223], v2 offset:7168
v_cvt_pk_bf16_f32 v204, v140, v141
v_mfma_f32_16x16x32_bf16 v[180:183], a[188:191], v[44:47], v[84:87]
buffer_load_dwordx4 v1, s[44:47], s72 offen offset:3072 sc1 lds
v_mfma_f32_16x16x32_bf16 v[180:183], a[184:187], v[40:43], v[180:183]
v_exp_f32 v157, v157
v_mfma_f32_16x16x32_bf16 v[180:183], a[180:183], v[36:39], v[180:183]
v_exp_f32 v158, v158
v_mfma_f32_16x16x32_bf16 v[180:183], a[176:179], v[32:35], v[180:183]
v_cvt_pk_bf16_f32 v205, v142, v143
v_cvt_pk_bf16_f32 v206, v156, v157
v_mfma_f32_16x16x32_bf16 v[160:163], a[160:163], v[16:19], v[80:83]
v_exp_f32 v159, v159
v_mfma_f32_16x16x32_bf16 v[160:163], a[164:167], v[20:23], v[160:163]
v_cvt_pk_bf16_f32 v207, v158, v159
v_mfma_f32_16x16x32_bf16 v[160:163], a[168:171], v[24:27], v[160:163]
v_mfma_f32_16x16x32_bf16 v[160:163], a[172:175], v[28:31], v[160:163]
v_mfma_f32_16x16x32_bf16 v[168:171], a[172:175], v[60:63], v[88:91]
v_mfma_f32_16x16x32_bf16 v[168:171], a[168:171], v[56:59], v[168:171]
v_mfma_f32_16x16x32_bf16 v[168:171], a[164:167], v[52:55], v[168:171]
v_mfma_f32_16x16x32_bf16 v[168:171], a[160:163], v[48:51], v[168:171]
v_mfma_f32_16x16x32_bf16 v[184:187], a[176:179], v[48:51], v[88:91]
v_mfma_f32_16x16x32_bf16 v[184:187], a[180:183], v[52:55], v[184:187]
v_mfma_f32_16x16x32_bf16 v[184:187], a[184:187], v[56:59], v[184:187]
v_mfma_f32_16x16x32_bf16 v[184:187], a[188:191], v[60:63], v[184:187]
v_mfma_f32_16x16x32_bf16 v[176:179], a[188:191], v[28:31], v[80:83]
v_mfma_f32_16x16x32_bf16 v[176:179], a[184:187], v[24:27], v[176:179]
v_mfma_f32_16x16x32_bf16 v[176:179], a[180:183], v[20:23], v[176:179]
v_mfma_f32_16x16x32_bf16 v[176:179], a[176:179], v[16:19], v[176:179]
s_waitcnt lgkmcnt(4)
v_mfma_f32_16x16x32_bf16 v[224:227], v[120:123], v[208:211], v[224:227]
s_add_u32 s82, s82, 0x8000
ds_read_b128 a[160:163], v2 offset:24576
v_mfma_f32_16x16x32_bf16 v[224:227], v[120:123], v[192:195], v[224:227]
s_and_b32 s82, s82, 0x1ffff
v_exp_f32 v164, v164
v_mfma_f32_16x16x32_bf16 v[232:235], v[120:123], v[216:219], v[232:235]
s_add_u32 m0, s74, 0
v_exp_f32 v165, v165
v_mfma_f32_16x16x32_bf16 v[232:235], v[120:123], v[200:203], v[232:235]
s_add_u32 s72, s81, 0
ds_read_b128 a[164:167], v2 offset:25600
v_cvt_pk_bf16_f32 v212, v164, v165
v_mfma_f32_16x16x32_bf16 a[0:3], a[224:227], v[208:211], a[0:3]
v_exp_f32 v166, v166
v_mfma_f32_16x16x32_bf16 a[0:3], a[192:195], v[192:195], a[0:3]
v_exp_f32 v167, v167
v_mfma_f32_16x16x32_bf16 a[64:67], a[192:195], v[200:203], a[64:67]
ds_read_b128 a[168:171], v2 offset:26624
v_cvt_pk_bf16_f32 v213, v166, v167
v_mfma_f32_16x16x32_bf16 a[64:67], a[224:227], v[216:219], a[64:67]
v_exp_f32 v180, v180
v_mfma_f32_16x16x32_bf16 a[68:71], a[228:231], v[216:219], a[68:71]
buffer_load_dwordx4 v1, s[44:47], s72 offen sc1 lds
v_mfma_f32_16x16x32_bf16 a[68:71], a[196:199], v[200:203], a[68:71]
v_exp_f32 v181, v181
v_mfma_f32_16x16x32_bf16 a[4:7], a[196:199], v[192:195], a[4:7]
ds_read_b128 a[172:175], v2 offset:27648
v_cvt_pk_bf16_f32 v214, v180, v181
v_mfma_f32_16x16x32_bf16 a[4:7], a[228:231], v[208:211], a[4:7]
v_exp_f32 v182, v182
v_mfma_f32_16x16x32_bf16 a[8:11], a[232:235], v[208:211], a[8:11]
v_exp_f32 v183, v183
v_mfma_f32_16x16x32_bf16 a[8:11], a[200:203], v[192:195], a[8:11]
ds_read_b128 a[176:179], v2 offset:28672
v_cvt_pk_bf16_f32 v215, v182, v183
v_mfma_f32_16x16x32_bf16 a[72:75], a[200:203], v[200:203], a[72:75]
v_exp_f32 v172, v172
v_mfma_f32_16x16x32_bf16 a[72:75], a[232:235], v[216:219], a[72:75]
v_exp_f32 v173, v173
v_mfma_f32_16x16x32_bf16 a[76:79], a[236:239], v[216:219], a[76:79]
ds_read_b128 a[180:183], v2 offset:29696
v_cvt_pk_bf16_f32 v220, v172, v173
v_mfma_f32_16x16x32_bf16 a[76:79], a[204:207], v[200:203], a[76:79]
v_exp_f32 v174, v174
v_mfma_f32_16x16x32_bf16 a[12:15], a[204:207], v[192:195], a[12:15]
v_exp_f32 v175, v175
v_mfma_f32_16x16x32_bf16 a[12:15], a[236:239], v[208:211], a[12:15]
ds_read_b128 a[184:187], v2 offset:30720
v_cvt_pk_bf16_f32 v221, v174, v175
v_mfma_f32_16x16x32_bf16 a[16:19], a[240:243], v[208:211], a[16:19]
s_waitcnt lgkmcnt(7)
v_exp_f32 v188, v188
v_mfma_f32_16x16x32_bf16 a[16:19], a[208:211], v[192:195], a[16:19]
buffer_load_dwordx4 v1, s[44:47], s72 offen offset:1024 sc1 lds
v_mfma_f32_16x16x32_bf16 a[80:83], a[208:211], v[200:203], a[80:83]
v_exp_f32 v189, v189
v_mfma_f32_16x16x32_bf16 a[80:83], a[240:243], v[216:219], a[80:83]
ds_read_b128 a[188:191], v2 offset:31744
v_cvt_pk_bf16_f32 v222, v188, v189
v_mfma_f32_16x16x32_bf16 a[84:87], a[244:247], v[216:219], a[84:87]
v_exp_f32 v190, v190
v_mfma_f32_16x16x32_bf16 a[84:87], a[212:215], v[200:203], a[84:87]
v_exp_f32 v191, v191
v_mfma_f32_16x16x32_bf16 a[20:23], a[212:215], v[192:195], a[20:23]
ds_read_b128 a[224:227], v2 offset:8192
v_cvt_pk_bf16_f32 v223, v190, v191
v_mfma_f32_16x16x32_bf16 a[20:23], a[244:247], v[208:211], a[20:23]
v_exp_f32 v160, v160
v_mfma_f32_16x16x32_bf16 a[24:27], a[248:251], v[208:211], a[24:27]
v_exp_f32 v161, v161
v_mfma_f32_16x16x32_bf16 a[24:27], a[216:219], v[192:195], a[24:27]
Lstub3:
s_cbranch_execz Lstub7
ds_read_b128 a[228:231], v2 offset:9216
v_mfma_f32_16x16x32_bf16 a[88:91], a[216:219], v[200:203], a[88:91]
v_exp_f32 v162, v162
v_mfma_f32_16x16x32_bf16 a[88:91], a[248:251], v[216:219], a[88:91]
v_exp_f32 v163, v163
v_mfma_f32_16x16x32_bf16 a[92:95], a[252:255], v[216:219], a[92:95]
ds_read_b128 a[232:235], v2 offset:10240
v_mfma_f32_16x16x32_bf16 a[92:95], a[220:223], v[200:203], a[92:95]
v_exp_f32 v176, v176
v_mfma_f32_16x16x32_bf16 a[28:31], a[220:223], v[192:195], a[28:31]
buffer_load_dwordx4 v1, s[44:47], s72 offen offset:2048 sc1 lds
v_mfma_f32_16x16x32_bf16 a[28:31], a[252:255], v[208:211], a[28:31]
ds_read_b128 a[236:239], v2 offset:11264
v_cvt_pk_bf16_f32 v208, v160, v161
s_cmp_eq_u32 s58, 0
s_cbranch_scc1 Lta16
s_cmp_eq_u32 s58, 1
s_cbranch_scc1 Lnt17
v_mfma_f32_16x16x32_bf16 v[128:131], a[128:131], v[16:19], v[80:83]
v_exp_f32 v177, v177
v_mfma_f32_16x16x32_bf16 v[144:147], a[144:147], v[16:19], v[80:83]
v_exp_f32 v178, v178
s_branch Ljoin18
Lta16:
v_mfma_f32_16x16x32_bf16 v[128:131], a[128:131], v[16:19], v[96:99]
v_exp_f32 v177, v177
v_mfma_f32_16x16x32_bf16 v[144:147], a[144:147], v[16:19], v[112:115]
v_exp_f32 v178, v178
s_branch Ljoin18
Lnt17:
v_mfma_f32_16x16x32_bf16 v[128:131], a[128:131], v[16:19], v[80:83]
v_exp_f32 v177, v177
v_mfma_f32_16x16x32_bf16 v[144:147], a[144:147], v[16:19], v[96:99]
v_exp_f32 v178, v178
Ljoin18:
v_mfma_f32_16x16x32_bf16 v[128:131], a[132:135], v[20:23], v[128:131]
ds_read_b128 a[240:243], v2 offset:12288
v_cvt_pk_bf16_f32 v209, v162, v163
v_mfma_f32_16x16x32_bf16 v[128:131], a[136:139], v[24:27], v[128:131]
v_exp_f32 v179, v179
v_mfma_f32_16x16x32_bf16 v[128:131], a[140:143], v[28:31], v[128:131]
v_exp_f32 v168, v168
v_mfma_f32_16x16x32_bf16 v[136:139], a[140:143], v[60:63], v[88:91]
ds_read_b128 a[244:247], v2 offset:13312
v_cvt_pk_bf16_f32 v210, v176, v177
v_mfma_f32_16x16x32_bf16 v[136:139], a[136:139], v[56:59], v[136:139]
v_exp_f32 v169, v169
v_mfma_f32_16x16x32_bf16 v[136:139], a[132:135], v[52:55], v[136:139]
v_exp_f32 v170, v170
v_mfma_f32_16x16x32_bf16 v[136:139], a[128:131], v[48:51], v[136:139]
ds_read_b128 a[248:251], v2 offset:14336
v_cvt_pk_bf16_f32 v211, v178, v179
v_mfma_f32_16x16x32_bf16 v[152:155], a[144:147], v[48:51], v[88:91]
v_exp_f32 v171, v171
v_mfma_f32_16x16x32_bf16 v[152:155], a[148:151], v[52:55], v[152:155]
v_exp_f32 v184, v184
v_mfma_f32_16x16x32_bf16 v[152:155], a[152:155], v[56:59], v[152:155]
ds_read_b128 a[252:255], v2 offset:15360
v_cvt_pk_bf16_f32 v216, v168, v169
v_mfma_f32_16x16x32_bf16 v[152:155], a[156:159], v[60:63], v[152:155]
buffer_load_dwordx4 v1, s[44:47], s72 offen offset:3072 sc1 lds
v_mfma_f32_16x16x32_bf16 v[144:147], a[156:159], v[28:31], v[144:147]
v_exp_f32 v185, v185
v_mfma_f32_16x16x32_bf16 v[144:147], a[152:155], v[24:27], v[144:147]
v_exp_f32 v186, v186
v_mfma_f32_16x16x32_bf16 v[144:147], a[148:151], v[20:23], v[144:147]
v_cvt_pk_bf16_f32 v217, v170, v171
v_cvt_pk_bf16_f32 v218, v184, v185
v_mfma_f32_16x16x32_bf16 v[132:135], a[128:131], v[32:35], v[84:87]
v_exp_f32 v187, v187
v_mfma_f32_16x16x32_bf16 v[132:135], a[132:135], v[36:39], v[132:135]
v_cvt_pk_bf16_f32 v219, v186, v187
v_add_u32 v2, s82, v1
v_mfma_f32_16x16x32_bf16 v[132:135], a[136:139], v[40:43], v[132:135]
v_mfma_f32_16x16x32_bf16 v[132:135], a[140:143], v[44:47], v[132:135]
v_mfma_f32_16x16x32_bf16 v[140:143], a[140:143], v[76:79], v[92:95]
v_mfma_f32_16x16x32_bf16 v[140:143], a[136:139], v[72:75], v[140:143]
v_mfma_f32_16x16x32_bf16 v[140:143], a[132:135], v[68:71], v[140:143]
v_mfma_f32_16x16x32_bf16 v[140:143], a[128:131], v[64:67], v[140:143]
v_mfma_f32_16x16x32_bf16 v[156:159], a[144:147], v[64:67], v[92:95]
v_mfma_f32_16x16x32_bf16 v[156:159], a[148:151], v[68:71], v[156:159]
v_mfma_f32_16x16x32_bf16 v[156:159], a[152:155], v[72:75], v[156:159]
v_mfma_f32_16x16x32_bf16 v[156:159], a[156:159], v[76:79], v[156:159]
v_mfma_f32_16x16x32_bf16 v[148:151], a[156:159], v[44:47], v[84:87]
v_mfma_f32_16x16x32_bf16 v[148:151], a[152:155], v[40:43], v[148:151]
v_mfma_f32_16x16x32_bf16 v[148:151], a[148:151], v[36:39], v[148:151]
s_waitcnt vmcnt(8) lgkmcnt(4)
v_mfma_f32_16x16x32_bf16 v[148:151], a[144:147], v[32:35], v[148:151]
s_barrier
v_mfma_f32_16x16x32_bf16 v[228:231], v[120:123], v[196:199], v[228:231]
s_xor_b32 s74, s82, 0x10000
v_exp_f32 v128, v128
v_mfma_f32_16x16x32_bf16 v[228:231], v[120:123], v[212:215], v[228:231]
s_add_u32 s74, s74, s64
ds_read_b128 a[128:131], v2 offset:16384
v_mfma_f32_16x16x32_bf16 v[236:239], v[120:123], v[204:207], v[236:239]
s_add_u32 s81, s81, 0x8000
v_exp_f32 v129, v129
v_mfma_f32_16x16x32_bf16 v[236:239], v[120:123], v[220:223], v[236:239]
s_add_u32 m0, s74, 16384
v_exp_f32 v130, v130
v_mfma_f32_16x16x32_bf16 a[32:35], a[192:195], v[196:199], a[32:35]
s_add_u32 s72, s81, 16384
ds_read_b128 a[132:135], v2 offset:17408
v_cvt_pk_bf16_f32 v192, v128, v129
v_mfma_f32_16x16x32_bf16 a[32:35], a[224:227], v[212:215], a[32:35]
v_exp_f32 v131, v131
v_mfma_f32_16x16x32_bf16 a[96:99], a[224:227], v[220:223], a[96:99]
v_exp_f32 v144, v144
v_mfma_f32_16x16x32_bf16 a[96:99], a[192:195], v[204:207], a[96:99]
ds_read_b128 a[136:139], v2 offset:18432
v_cvt_pk_bf16_f32 v193, v130, v131
v_mfma_f32_16x16x32_bf16 a[100:103], a[196:199], v[204:207], a[100:103]
buffer_load_dwordx4 v1, s[44:47], s72 offen sc1 lds
v_mfma_f32_16x16x32_bf16 a[100:103], a[228:231], v[220:223], a[100:103]
v_exp_f32 v145, v145
v_mfma_f32_16x16x32_bf16 a[36:39], a[228:231], v[212:215], a[36:39]
v_exp_f32 v146, v146
v_mfma_f32_16x16x32_bf16 a[36:39], a[196:199], v[196:199], a[36:39]
ds_read_b128 a[140:143], v2 offset:19456
v_cvt_pk_bf16_f32 v194, v144, v145
v_mfma_f32_16x16x32_bf16 a[40:43], a[200:203], v[196:199], a[40:43]
v_exp_f32 v147, v147
v_mfma_f32_16x16x32_bf16 a[40:43], a[232:235], v[212:215], a[40:43]
v_exp_f32 v136, v136
v_mfma_f32_16x16x32_bf16 a[104:107], a[232:235], v[220:223], a[104:107]
ds_read_b128 a[144:147], v2 offset:20480
v_cvt_pk_bf16_f32 v195, v146, v147
v_mfma_f32_16x16x32_bf16 a[104:107], a[200:203], v[204:207], a[104:107]
v_exp_f32 v137, v137
v_mfma_f32_16x16x32_bf16 a[108:111], a[204:207], v[204:207], a[108:111]
v_exp_f32 v138, v138
v_mfma_f32_16x16x32_bf16 a[108:111], a[236:239], v[220:223], a[108:111]
ds_read_b128 a[148:151], v2 offset:21504
v_cvt_pk_bf16_f32 v200, v136, v137
v_mfma_f32_16x16x32_bf16 a[44:47], a[236:239], v[212:215], a[44:47]
v_exp_f32 v139, v139
v_mfma_f32_16x16x32_bf16 a[44:47], a[204:207], v[196:199], a[44:47]
v_exp_f32 v152, v152
v_mfma_f32_16x16x32_bf16 a[48:51], a[208:211], v[196:199], a[48:51]
s_waitcnt lgkmcnt(6)
ds_read_b128 a[152:155], v2 offset:22528
v_cvt_pk_bf16_f32 v201, v138, v139
v_mfma_f32_16x16x32_bf16 a[48:51], a[240:243], v[212:215], a[48:51]
buffer_load_dwordx4 v1, s[44:47], s72 offen offset:1024 sc1 lds
v_mfma_f32_16x16x32_bf16 a[112:115], a[240:243], v[220:223], a[112:115]
v_exp_f32 v153, v153
v_mfma_f32_16x16x32_bf16 a[112:115], a[208:211], v[204:207], a[112:115]
v_exp_f32 v154, v154
v_mfma_f32_16x16x32_bf16 a[116:119], a[212:215], v[204:207], a[116:119]
ds_read_b128 a[156:159], v2 offset:23552
v_cvt_pk_bf16_f32 v202, v152, v153
v_mfma_f32_16x16x32_bf16 a[116:119], a[244:247], v[220:223], a[116:119]
v_exp_f32 v155, v155
v_mfma_f32_16x16x32_bf16 a[52:55], a[244:247], v[212:215], a[52:55]
v_exp_f32 v132, v132
v_mfma_f32_16x16x32_bf16 a[52:55], a[212:215], v[196:199], a[52:55]
ds_read_b128 a[192:195], v2 offset:0
v_cvt_pk_bf16_f32 v203, v154, v155
v_mfma_f32_16x16x32_bf16 a[56:59], a[216:219], v[196:199], a[56:59]
v_exp_f32 v133, v133
v_mfma_f32_16x16x32_bf16 a[56:59], a[248:251], v[212:215], a[56:59]
v_exp_f32 v134, v134
v_mfma_f32_16x16x32_bf16 a[120:123], a[248:251], v[220:223], a[120:123]
ds_read_b128 a[196:199], v2 offset:1024
v_mfma_f32_16x16x32_bf16 a[120:123], a[216:219], v[204:207], a[120:123]
v_exp_f32 v135, v135
v_mfma_f32_16x16x32_bf16 a[124:127], a[220:223], v[204:207], a[124:127]
v_exp_f32 v148, v148
v_mfma_f32_16x16x32_bf16 a[124:127], a[252:255], v[220:223], a[124:127]
ds_read_b128 a[200:203], v2 offset:2048
v_mfma_f32_16x16x32_bf16 a[60:63], a[252:255], v[212:215], a[60:63]
buffer_load_dwordx4 v1, s[44:47], s72 offen offset:2048 sc1 lds
v_mfma_f32_16x16x32_bf16 a[60:63], a[220:223], v[196:199], a[60:63]
ds_read_b128 a[204:207], v2 offset:3072
v_cvt_pk_bf16_f32 v196, v132, v133
s_cmp_eq_u32 s58, 2
s_cbranch_scc1 Lta19
s_cmp_eq_u32 s58, 3
s_cbranch_scc1 Lnt20
v_mfma_f32_16x16x32_bf16 v[160:163], a[160:163], v[16:19], v[112:115]
v_exp_f32 v149, v149
v_mfma_f32_16x16x32_bf16 v[176:179], a[176:179], v[16:19], v[112:115]
v_exp_f32 v150, v150
s_branch Ljoin21
Lta19:
v_mfma_f32_16x16x32_bf16 v[160:163], a[160:163], v[16:19], v[96:99]
v_exp_f32 v149, v149
v_mfma_f32_16x16x32_bf16 v[176:179], a[176:179], v[16:19], v[112:115]
v_exp_f32 v150, v150
s_branch Ljoin21
Lnt20:
v_mfma_f32_16x16x32_bf16 v[160:163], a[160:163], v[16:19], v[80:83]
v_exp_f32 v149, v149
v_mfma_f32_16x16x32_bf16 v[176:179], a[176:179], v[16:19], v[96:99]
v_exp_f32 v150, v150
Ljoin21:
v_mfma_f32_16x16x32_bf16 v[164:167], a[160:163], v[32:35], v[84:87]
ds_read_b128 a[208:211], v2 offset:4096
v_cvt_pk_bf16_f32 v197, v134, v135
v_mfma_f32_16x16x32_bf16 v[164:167], a[164:167], v[36:39], v[164:167]
v_exp_f32 v151, v151
v_mfma_f32_16x16x32_bf16 v[164:167], a[168:171], v[40:43], v[164:167]
v_exp_f32 v140, v140
v_mfma_f32_16x16x32_bf16 v[164:167], a[172:175], v[44:47], v[164:167]
ds_read_b128 a[212:215], v2 offset:5120
v_cvt_pk_bf16_f32 v198, v148, v149
v_mfma_f32_16x16x32_bf16 v[172:175], a[172:175], v[76:79], v[92:95]
v_exp_f32 v141, v141
v_mfma_f32_16x16x32_bf16 v[172:175], a[168:171], v[72:75], v[172:175]
v_exp_f32 v142, v142
v_mfma_f32_16x16x32_bf16 v[172:175], a[164:167], v[68:71], v[172:175]
ds_read_b128 a[216:219], v2 offset:6144
v_cvt_pk_bf16_f32 v199, v150, v151
v_mfma_f32_16x16x32_bf16 v[172:175], a[160:163], v[64:67], v[172:175]
v_exp_f32 v143, v143
v_mfma_f32_16x16x32_bf16 v[188:191], a[176:179], v[64:67], v[92:95]
v_exp_f32 v156, v156
v_mfma_f32_16x16x32_bf16 v[188:191], a[180:183], v[68:71], v[188:191]
ds_read_b128 a[220:223], v2 offset:7168
v_cvt_pk_bf16_f32 v204, v140, v141
v_mfma_f32_16x16x32_bf16 v[188:191], a[184:187], v[72:75], v[188:191]
buffer_load_dwordx4 v1, s[44:47], s72 offen offset:3072 sc1 lds
v_mfma_f32_16x16x32_bf16 v[188:191], a[188:191], v[76:79], v[188:191]
v_exp_f32 v157, v157
v_mfma_f32_16x16x32_bf16 v[180:183], a[188:191], v[44:47], v[84:87]
v_exp_f32 v158, v158
v_mfma_f32_16x16x32_bf16 v[180:183], a[184:187], v[40:43], v[180:183]
v_cvt_pk_bf16_f32 v205, v142, v143
v_cvt_pk_bf16_f32 v206, v156, v157
v_mfma_f32_16x16x32_bf16 v[180:183], a[180:183], v[36:39], v[180:183]
v_exp_f32 v159, v159
v_mfma_f32_16x16x32_bf16 v[180:183], a[176:179], v[32:35], v[180:183]
v_cvt_pk_bf16_f32 v207, v158, v159
v_mfma_f32_16x16x32_bf16 v[160:163], a[164:167], v[20:23], v[160:163]
v_mfma_f32_16x16x32_bf16 v[160:163], a[168:171], v[24:27], v[160:163]
v_mfma_f32_16x16x32_bf16 v[160:163], a[172:175], v[28:31], v[160:163]
v_mfma_f32_16x16x32_bf16 v[168:171], a[172:175], v[60:63], v[88:91]
v_mfma_f32_16x16x32_bf16 v[168:171], a[168:171], v[56:59], v[168:171]
v_mfma_f32_16x16x32_bf16 v[168:171], a[164:167], v[52:55], v[168:171]
v_mfma_f32_16x16x32_bf16 v[168:171], a[160:163], v[48:51], v[168:171]
v_mfma_f32_16x16x32_bf16 v[184:187], a[176:179], v[48:51], v[88:91]
v_mfma_f32_16x16x32_bf16 v[184:187], a[180:183], v[52:55], v[184:187]
v_mfma_f32_16x16x32_bf16 v[184:187], a[184:187], v[56:59], v[184:187]
v_mfma_f32_16x16x32_bf16 v[184:187], a[188:191], v[60:63], v[184:187]
v_mfma_f32_16x16x32_bf16 v[176:179], a[188:191], v[28:31], v[176:179]
v_mfma_f32_16x16x32_bf16 v[176:179], a[184:187], v[24:27], v[176:179]
v_mfma_f32_16x16x32_bf16 v[176:179], a[180:183], v[20:23], v[176:179]
s_waitcnt lgkmcnt(4)
v_mfma_f32_16x16x32_bf16 v[224:227], v[120:123], v[208:211], v[224:227]
s_add_u32 s82, s82, 0x8000
ds_read_b128 a[160:163], v2 offset:24576
v_mfma_f32_16x16x32_bf16 v[224:227], v[120:123], v[192:195], v[224:227]
s_and_b32 s82, s82, 0x1ffff
v_exp_f32 v164, v164
v_mfma_f32_16x16x32_bf16 v[232:235], v[120:123], v[216:219], v[232:235]
s_add_u32 m0, s74, 0
v_exp_f32 v165, v165
v_mfma_f32_16x16x32_bf16 v[232:235], v[120:123], v[200:203], v[232:235]
s_add_u32 s72, s81, 0
ds_read_b128 a[164:167], v2 offset:25600
v_cvt_pk_bf16_f32 v212, v164, v165
v_mfma_f32_16x16x32_bf16 a[0:3], a[224:227], v[208:211], a[0:3]
v_exp_f32 v166, v166
v_mfma_f32_16x16x32_bf16 a[0:3], a[192:195], v[192:195], a[0:3]
v_exp_f32 v167, v167
v_mfma_f32_16x16x32_bf16 a[64:67], a[192:195], v[200:203], a[64:67]
ds_read_b128 a[168:171], v2 offset:26624
v_cvt_pk_bf16_f32 v213, v166, v167
v_mfma_f32_16x16x32_bf16 a[64:67], a[224:227], v[216:219], a[64:67]
v_exp_f32 v180, v180
v_mfma_f32_16x16x32_bf16 a[68:71], a[228:231], v[216:219], a[68:71]
buffer_load_dwordx4 v1, s[44:47], s72 offen sc1 lds
v_mfma_f32_16x16x32_bf16 a[68:71], a[196:199], v[200:203], a[68:71]
v_exp_f32 v181, v181
v_mfma_f32_16x16x32_bf16 a[4:7], a[196:199], v[192:195], a[4:7]
ds_read_b128 a[172:175], v2 offset:27648
v_cvt_pk_bf16_f32 v214, v180, v181
v_mfma_f32_16x16x32_bf16 a[4:7], a[228:231], v[208:211], a[4:7]
v_exp_f32 v182, v182
v_mfma_f32_16x16x32_bf16 a[8:11], a[232:235], v[208:211], a[8:11]
v_exp_f32 v183, v183
v_mfma_f32_16x16x32_bf16 a[8:11], a[200:203], v[192:195], a[8:11]
ds_read_b128 a[176:179], v2 offset:28672
v_cvt_pk_bf16_f32 v215, v182, v183
v_mfma_f32_16x16x32_bf16 a[72:75], a[200:203], v[200:203], a[72:75]
v_exp_f32 v172, v172
v_mfma_f32_16x16x32_bf16 a[72:75], a[232:235], v[216:219], a[72:75]
v_exp_f32 v173, v173
v_mfma_f32_16x16x32_bf16 a[76:79], a[236:239], v[216:219], a[76:79]
ds_read_b128 a[180:183], v2 offset:29696
v_cvt_pk_bf16_f32 v220, v172, v173
v_mfma_f32_16x16x32_bf16 a[76:79], a[204:207], v[200:203], a[76:79]
v_exp_f32 v174, v174
v_mfma_f32_16x16x32_bf16 a[12:15], a[204:207], v[192:195], a[12:15]
v_exp_f32 v175, v175
v_mfma_f32_16x16x32_bf16 a[12:15], a[236:239], v[208:211], a[12:15]
ds_read_b128 a[184:187], v2 offset:30720
v_cvt_pk_bf16_f32 v221, v174, v175
v_mfma_f32_16x16x32_bf16 a[16:19], a[240:243], v[208:211], a[16:19]
s_waitcnt lgkmcnt(7)
v_exp_f32 v188, v188
v_mfma_f32_16x16x32_bf16 a[16:19], a[208:211], v[192:195], a[16:19]
buffer_load_dwordx4 v1, s[44:47], s72 offen offset:1024 sc1 lds
v_mfma_f32_16x16x32_bf16 a[80:83], a[208:211], v[200:203], a[80:83]
v_exp_f32 v189, v189
v_mfma_f32_16x16x32_bf16 a[80:83], a[240:243], v[216:219], a[80:83]
ds_read_b128 a[188:191], v2 offset:31744
v_cvt_pk_bf16_f32 v222, v188, v189
v_mfma_f32_16x16x32_bf16 a[84:87], a[244:247], v[216:219], a[84:87]
v_exp_f32 v190, v190
v_mfma_f32_16x16x32_bf16 a[84:87], a[212:215], v[200:203], a[84:87]
v_exp_f32 v191, v191
v_mfma_f32_16x16x32_bf16 a[20:23], a[212:215], v[192:195], a[20:23]
ds_read_b128 a[224:227], v2 offset:8192
v_cvt_pk_bf16_f32 v223, v190, v191
v_mfma_f32_16x16x32_bf16 a[20:23], a[244:247], v[208:211], a[20:23]
v_exp_f32 v160, v160
v_mfma_f32_16x16x32_bf16 a[24:27], a[248:251], v[208:211], a[24:27]
v_exp_f32 v161, v161
v_mfma_f32_16x16x32_bf16 a[24:27], a[216:219], v[192:195], a[24:27]
ds_read_b128 a[228:231], v2 offset:9216
v_mfma_f32_16x16x32_bf16 a[88:91], a[216:219], v[200:203], a[88:91]
v_exp_f32 v162, v162
v_mfma_f32_16x16x32_bf16 a[88:91], a[248:251], v[216:219], a[88:91]
v_exp_f32 v163, v163
v_mfma_f32_16x16x32_bf16 a[92:95], a[252:255], v[216:219], a[92:95]
ds_read_b128 a[232:235], v2 offset:10240
v_mfma_f32_16x16x32_bf16 a[92:95], a[220:223], v[200:203], a[92:95]
v_exp_f32 v176, v176
v_mfma_f32_16x16x32_bf16 a[28:31], a[220:223], v[192:195], a[28:31]
buffer_load_dwordx4 v1, s[44:47], s72 offen offset:2048 sc1 lds
v_mfma_f32_16x16x32_bf16 a[28:31], a[252:255], v[208:211], a[28:31]
ds_read_b128 a[236:239], v2 offset:11264
v_cvt_pk_bf16_f32 v208, v160, v161
s_cmp_eq_u32 s58, 0
s_cbranch_scc1 Lta22
s_cmp_eq_u32 s58, 1
s_cbranch_scc1 Lnt23
v_mfma_f32_16x16x32_bf16 v[132:135], a[128:131], v[32:35], v[84:87]
v_exp_f32 v177, v177
v_mfma_f32_16x16x32_bf16 v[148:151], a[144:147], v[32:35], v[84:87]
v_exp_f32 v178, v178
s_branch Ljoin24
Lta22:
v_mfma_f32_16x16x32_bf16 v[132:135], a[128:131], v[32:35], v[100:103]
v_exp_f32 v177, v177
v_mfma_f32_16x16x32_bf16 v[148:151], a[144:147], v[32:35], v[112:115]
v_exp_f32 v178, v178
s_branch Ljoin24
Lnt23:
v_mfma_f32_16x16x32_bf16 v[132:135], a[128:131], v[32:35], v[84:87]
v_exp_f32 v177, v177
v_mfma_f32_16x16x32_bf16 v[148:151], a[144:147], v[32:35], v[100:103]
v_exp_f32 v178, v178
Ljoin24:
v_mfma_f32_16x16x32_bf16 v[136:139], a[128:131], v[48:51], v[88:91]
ds_read_b128 a[240:243], v2 offset:12288
v_cvt_pk_bf16_f32 v209, v162, v163
v_mfma_f32_16x16x32_bf16 v[136:139], a[132:135], v[52:55], v[136:139]
v_exp_f32 v179, v179
v_mfma_f32_16x16x32_bf16 v[136:139], a[136:139], v[56:59], v[136:139]
v_exp_f32 v168, v168
v_mfma_f32_16x16x32_bf16 v[136:139], a[140:143], v[60:63], v[136:139]
ds_read_b128 a[244:247], v2 offset:13312
v_cvt_pk_bf16_f32 v210, v176, v177
v_mfma_f32_16x16x32_bf16 v[152:155], a[156:159], v[60:63], v[88:91]
v_exp_f32 v169, v169
v_mfma_f32_16x16x32_bf16 v[152:155], a[152:155], v[56:59], v[152:155]
v_exp_f32 v170, v170
v_mfma_f32_16x16x32_bf16 v[152:155], a[148:151], v[52:55], v[152:155]
ds_read_b128 a[248:251], v2 offset:14336
v_cvt_pk_bf16_f32 v211, v178, v179
v_mfma_f32_16x16x32_bf16 v[152:155], a[144:147], v[48:51], v[152:155]
v_exp_f32 v171, v171
v_mfma_f32_16x16x32_bf16 v[132:135], a[132:135], v[36:39], v[132:135]
v_exp_f32 v184, v184
v_mfma_f32_16x16x32_bf16 v[132:135], a[136:139], v[40:43], v[132:135]
ds_read_b128 a[252:255], v2 offset:15360
v_cvt_pk_bf16_f32 v216, v168, v169
v_mfma_f32_16x16x32_bf16 v[132:135], a[140:143], v[44:47], v[132:135]
buffer_load_dwordx4 v1, s[44:47], s72 offen offset:3072 sc1 lds
v_mfma_f32_16x16x32_bf16 v[140:143], a[140:143], v[76:79], v[92:95]
v_exp_f32 v185, v185
v_mfma_f32_16x16x32_bf16 v[140:143], a[136:139], v[72:75], v[140:143]
v_exp_f32 v186, v186
v_mfma_f32_16x16x32_bf16 v[140:143], a[132:135], v[68:71], v[140:143]
v_cvt_pk_bf16_f32 v217, v170, v171
v_cvt_pk_bf16_f32 v218, v184, v185
v_mfma_f32_16x16x32_bf16 v[140:143], a[128:131], v[64:67], v[140:143]
v_exp_f32 v187, v187
v_mfma_f32_16x16x32_bf16 v[156:159], a[144:147], v[64:67], v[92:95]
v_cvt_pk_bf16_f32 v219, v186, v187
v_add_u32 v2, s82, v1
v_mfma_f32_16x16x32_bf16 v[156:159], a[148:151], v[68:71], v[156:159]
v_mfma_f32_16x16x32_bf16 v[156:159], a[152:155], v[72:75], v[156:159]
v_mfma_f32_16x16x32_bf16 v[156:159], a[156:159], v[76:79], v[156:159]
v_mfma_f32_16x16x32_bf16 v[148:151], a[156:159], v[44:47], v[148:151]
v_mfma_f32_16x16x32_bf16 v[148:151], a[152:155], v[40:43], v[148:151]
s_waitcnt vmcnt(8) lgkmcnt(4)
v_mfma_f32_16x16x32_bf16 v[148:151], a[148:151], v[36:39], v[148:151]
s_barrier
s_cmp_eq_u32 s60, 7
s_cbranch_scc1 LLT3x
LLT3:
Lstub4:
s_cbranch_execz Lstub8
v_mfma_f32_16x16x32_bf16 v[228:231], v[120:123], v[196:199], v[228:231]
s_xor_b32 s74, s82, 0x10000
v_exp_f32 v136, v136
v_mfma_f32_16x16x32_bf16 v[228:231], v[120:123], v[212:215], v[228:231]
s_add_u32 s74, s74, s64
ds_read_b128 a[128:131], v2 offset:16384
v_and_b32 v240, 15, v0
v_mfma_f32_16x16x32_bf16 v[236:239], v[120:123], v[204:207], v[236:239]
s_add_u32 s81, s81, 0x8000
v_exp_f32 v137, v137
v_mfma_f32_16x16x32_bf16 v[236:239], v[120:123], v[220:223], v[236:239]
s_add_u32 m0, s74, 16384
ds_read_b128 a[132:135], v2 offset:17408
v_cvt_pk_bf16_f32 v200, v136, v137
v_mfma_f32_16x16x32_bf16 a[32:35], a[192:195], v[196:199], a[32:35]
s_add_u32 s72, s81, 16384
buffer_load_dwordx4 v1, s[44:47], s72 offen sc1 lds
v_mfma_f32_16x16x32_bf16 a[32:35], a[224:227], v[212:215], a[32:35]
s_add_u32 s69, s93, 0x3e00000
v_exp_f32 v138, v138
v_mfma_f32_16x16x32_bf16 a[96:99], a[224:227], v[220:223], a[96:99]
v_exp_f32 v139, v139
v_mfma_f32_16x16x32_bf16 a[96:99], a[192:195], v[204:207], a[96:99]
ds_read_b128 a[136:139], v2 offset:18432
v_cvt_pk_bf16_f32 v201, v138, v139
v_mfma_f32_16x16x32_bf16 a[100:103], a[196:199], v[204:207], a[100:103]
v_exp_f32 v152, v152
v_mfma_f32_16x16x32_bf16 a[100:103], a[228:231], v[220:223], a[100:103]
ds_read_b128 a[140:143], v2 offset:19456
v_lshrrev_b32 v241, 4, v0
v_mfma_f32_16x16x32_bf16 a[36:39], a[228:231], v[212:215], a[36:39]
buffer_store_dwordx4 v[112:115], v1, s[44:47], s69 offen sc1
v_mfma_f32_16x16x32_bf16 a[36:39], a[196:199], v[196:199], a[36:39]
v_exp_f32 v153, v153
v_mfma_f32_16x16x32_bf16 a[40:43], a[200:203], v[196:199], a[40:43]
v_exp_f32 v154, v154
v_mfma_f32_16x16x32_bf16 a[40:43], a[232:235], v[212:215], a[40:43]
ds_read_b128 a[144:147], v2 offset:20480
v_cvt_pk_bf16_f32 v202, v152, v153
v_mfma_f32_16x16x32_bf16 a[104:107], a[232:235], v[220:223], a[104:107]
v_exp_f32 v155, v155
v_mfma_f32_16x16x32_bf16 a[104:107], a[200:203], v[204:207], a[104:107]
ds_read_b128 a[148:151], v2 offset:21504
v_cvt_pk_bf16_f32 v203, v154, v155
v_mfma_f32_16x16x32_bf16 a[108:111], a[204:207], v[204:207], a[108:111]
buffer_load_dwordx4 v1, s[44:47], s72 offen offset:1024 sc1 lds
v_mfma_f32_16x16x32_bf16 a[108:111], a[236:239], v[220:223], a[108:111]
v_exp_f32 v132, v132
v_mfma_f32_16x16x32_bf16 a[44:47], a[236:239], v[212:215], a[44:47]
v_exp_f32 v133, v133
v_mfma_f32_16x16x32_bf16 a[44:47], a[204:207], v[196:199], a[44:47]
ds_read_b128 a[152:155], v2 offset:22528
v_add_u32 v248, 1, v240
v_mfma_f32_16x16x32_bf16 a[48:51], a[208:211], v[196:199], a[48:51]
s_waitcnt lgkmcnt(7)
v_exp_f32 v134, v134
v_mfma_f32_16x16x32_bf16 a[48:51], a[240:243], v[212:215], a[48:51]
ds_read_b128 a[156:159], v2 offset:23552
v_and_b32 v249, 3, v248
v_mfma_f32_16x16x32_bf16 a[112:115], a[240:243], v[220:223], a[112:115]
buffer_store_dwordx4 v[112:115], v1, s[44:47], s69 offen offset:1024 sc1
v_mfma_f32_16x16x32_bf16 a[112:115], a[208:211], v[204:207], a[112:115]
v_exp_f32 v135, v135
v_mfma_f32_16x16x32_bf16 a[116:119], a[212:215], v[204:207], a[116:119]
v_exp_f32 v148, v148
v_mfma_f32_16x16x32_bf16 a[116:119], a[244:247], v[220:223], a[116:119]
ds_read_b128 a[192:195], v2 offset:0
v_lshrrev_b32 v248, 2, v248
v_mfma_f32_16x16x32_bf16 a[52:55], a[244:247], v[212:215], a[52:55]
v_exp_f32 v149, v149
v_mfma_f32_16x16x32_bf16 a[52:55], a[212:215], v[196:199], a[52:55]
ds_read_b128 a[196:199], v2 offset:1024
v_mov_b32 v250, 0x20000
v_mfma_f32_16x16x32_bf16 a[56:59], a[216:219], v[196:199], a[56:59]
buffer_load_dwordx4 v1, s[44:47], s72 offen offset:2048 sc1 lds
v_mfma_f32_16x16x32_bf16 a[56:59], a[248:251], v[212:215], a[56:59]
v_exp_f32 v150, v150
v_mfma_f32_16x16x32_bf16 a[120:123], a[248:251], v[220:223], a[120:123]
v_exp_f32 v151, v151
v_mfma_f32_16x16x32_bf16 a[120:123], a[216:219], v[204:207], a[120:123]
ds_read_b128 a[200:203], v2 offset:2048
v_mov_b32 v252, 0x20001
v_mfma_f32_16x16x32_bf16 a[124:127], a[220:223], v[204:207], a[124:127]
v_exp_f32 v140, v140
v_mfma_f32_16x16x32_bf16 a[124:127], a[252:255], v[220:223], a[124:127]
ds_read_b128 a[204:207], v2 offset:3072
v_lshlrev_b32 v6, 3, v249
v_mfma_f32_16x16x32_bf16 a[60:63], a[252:255], v[212:215], a[60:63]
buffer_store_dwordx4 v[112:115], v1, s[44:47], s69 offen offset:2048 sc1
v_mfma_f32_16x16x32_bf16 a[60:63], a[220:223], v[196:199], a[60:63]
ds_read_b128 a[208:211], v2 offset:4096
v_cvt_pk_bf16_f32 v196, v132, v133
s_cmp_eq_u32 s58, 2
s_cbranch_scc1 Lta25
s_cmp_eq_u32 s58, 3
s_cbranch_scc1 Lnt26
v_mfma_f32_16x16x32_bf16 v[164:167], a[160:163], v[32:35], v[112:115]
ds_read_b128 a[212:215], v2 offset:5120
v_cvt_pk_bf16_f32 v197, v134, v135
v_mfma_f32_16x16x32_bf16 v[180:183], a[176:179], v[32:35], v[112:115]
ds_read_b128 a[216:219], v2 offset:6144
v_cvt_pk_bf16_f32 v198, v148, v149
s_branch Ljoin27
Lta25:
v_mfma_f32_16x16x32_bf16 v[164:167], a[160:163], v[32:35], v[100:103]
ds_read_b128 a[212:215], v2 offset:5120
v_cvt_pk_bf16_f32 v197, v134, v135
v_mfma_f32_16x16x32_bf16 v[180:183], a[176:179], v[32:35], v[112:115]
ds_read_b128 a[216:219], v2 offset:6144
v_cvt_pk_bf16_f32 v198, v148, v149
s_branch Ljoin27
Lnt26:
v_mfma_f32_16x16x32_bf16 v[164:167], a[160:163], v[32:35], v[84:87]
ds_read_b128 a[212:215], v2 offset:5120
v_cvt_pk_bf16_f32 v197, v134, v135
v_mfma_f32_16x16x32_bf16 v[180:183], a[176:179], v[32:35], v[100:103]
ds_read_b128 a[216:219], v2 offset:6144
v_cvt_pk_bf16_f32 v198, v148, v149
Ljoin27:
v_mfma_f32_16x16x32_bf16 v[164:167], a[164:167], v[36:39], v[164:167]
v_exp_f32 v141, v141
v_mfma_f32_16x16x32_bf16 v[164:167], a[168:171], v[40:43], v[164:167]
v_exp_f32 v142, v142
v_mfma_f32_16x16x32_bf16 v[164:167], a[172:175], v[44:47], v[164:167]
ds_read_b128 a[220:223], v2 offset:7168
v_cvt_pk_bf16_f32 v199, v150, v151
v_mfma_f32_16x16x32_bf16 v[172:175], a[172:175], v[76:79], v[92:95]
v_exp_f32 v143, v143
v_mfma_f32_16x16x32_bf16 v[172:175], a[168:171], v[72:75], v[172:175]
buffer_load_dwordx4 v1, s[44:47], s72 offen offset:3072 sc1 lds
v_mfma_f32_16x16x32_bf16 v[172:175], a[164:167], v[68:71], v[172:175]
v_exp_f32 v156, v156
v_mfma_f32_16x16x32_bf16 v[172:175], a[160:163], v[64:67], v[172:175]
v_cvt_pk_bf16_f32 v204, v140, v141
v_cvt_pk_bf16_f32 v205, v142, v143
v_mfma_f32_16x16x32_bf16 v[188:191], a[176:179], v[64:67], v[92:95]
v_exp_f32 v157, v157
v_mfma_f32_16x16x32_bf16 v[188:191], a[180:183], v[68:71], v[188:191]
v_exp_f32 v158, v158
v_mfma_f32_16x16x32_bf16 v[188:191], a[184:187], v[72:75], v[188:191]
buffer_store_dwordx4 v[112:115], v1, s[44:47], s69 offen offset:3072 sc1
v_mfma_f32_16x16x32_bf16 v[188:191], a[188:191], v[76:79], v[188:191]
v_exp_f32 v159, v159
v_mfma_f32_16x16x32_bf16 v[180:183], a[188:191], v[44:47], v[180:183]
v_cvt_pk_bf16_f32 v206, v156, v157
v_cvt_pk_bf16_f32 v207, v158, v159
v_mfma_f32_16x16x32_bf16 v[180:183], a[184:187], v[40:43], v[180:183]
v_lshrrev_b32 v6, v6, v252
v_and_b32 v6, 3, v6
v_mfma_f32_16x16x32_bf16 v[180:183], a[180:183], v[36:39], v[180:183]
v_cmp_ne_u32 vcc, 1, v249
v_mul_u32_u24 v6, 16640, v6
v_mfma_f32_16x16x32_bf16 v[168:171], a[160:163], v[48:51], v[88:91]
v_add_u32 v6, s92, v6
v_cndmask_b32 v6, v250, v6, vcc
v_mfma_f32_16x16x32_bf16 v[168:171], a[164:167], v[52:55], v[168:171]
v_add_u32 v253, s58, v249
v_and_b32 v253, 3, v253
v_mfma_f32_16x16x32_bf16 v[168:171], a[168:171], v[56:59], v[168:171]
v_mul_u32_u24 v253, 4160, v253
v_add_u32 v6, v6, v253
v_mfma_f32_16x16x32_bf16 v[168:171], a[172:175], v[60:63], v[168:171]
v_bfe_u32 v251, v0, 2, 2
v_lshl_add_u32 v6, v248, 3, v6
v_mfma_f32_16x16x32_bf16 v[184:187], a[188:191], v[60:63], v[88:91]
v_lshl_add_u32 v6, v241, 4, v6
v_lshlrev_b32 v5, 3, v251
v_mfma_f32_16x16x32_bf16 v[184:187], a[184:187], v[56:59], v[184:187]
v_lshrrev_b32 v5, v5, v252
v_and_b32 v5, 3, v5
v_mfma_f32_16x16x32_bf16 v[184:187], a[180:183], v[52:55], v[184:187]
v_cmp_ne_u32 vcc, 1, v251
v_mul_u32_u24 v5, 16640, v5
v_mfma_f32_16x16x32_bf16 v[184:187], a[176:179], v[48:51], v[184:187]
s_waitcnt lgkmcnt(4)
v_mfma_f32_16x16x32_bf16 v[224:227], v[120:123], v[208:211], v[224:227]
s_add_u32 s82, s82, 0x8000
ds_read_b128 a[160:163], v2 offset:24576
ds_read_b128 a[164:167], v2 offset:25600
v_mfma_f32_16x16x32_bf16 v[232:235], v[120:123], v[216:219], v[232:235]
s_and_b32 s82, s82, 0x1ffff
v_exp_f32 v164, v164
v_mfma_f32_16x16x32_bf16 v[232:235], v[120:123], v[200:203], v[232:235]
s_add_u32 m0, s74, 0
v_exp_f32 v165, v165
v_mfma_f32_16x16x32_bf16 a[0:3], a[224:227], v[208:211], a[0:3]
s_add_u32 s72, s81, 0
v_exp_f32 v166, v166
v_mfma_f32_16x16x32_bf16 a[64:67], a[192:195], v[200:203], a[64:67]
ds_read_b128 a[168:171], v2 offset:26624
v_cvt_pk_bf16_f32 v212, v164, v165
v_mfma_f32_16x16x32_bf16 a[64:67], a[224:227], v[216:219], a[64:67]
v_exp_f32 v167, v167
v_mfma_f32_16x16x32_bf16 a[68:71], a[228:231], v[216:219], a[68:71]
buffer_load_dwordx4 v1, s[44:47], s72 offen sc1 lds
v_mfma_f32_16x16x32_bf16 a[68:71], a[196:199], v[200:203], a[68:71]
v_exp_f32 v180, v180
v_mfma_f32_16x16x32_bf16 a[4:7], a[228:231], v[208:211], a[4:7]
ds_read_b128 a[172:175], v2 offset:27648
v_cvt_pk_bf16_f32 v213, v166, v167
v_mfma_f32_16x16x32_bf16 a[8:11], a[232:235], v[208:211], a[8:11]
v_exp_f32 v181, v181
v_mfma_f32_16x16x32_bf16 a[72:75], a[200:203], v[200:203], a[72:75]
ds_read_b128 a[176:179], v2 offset:28672
v_cvt_pk_bf16_f32 v214, v180, v181
v_mfma_f32_16x16x32_bf16 a[72:75], a[232:235], v[216:219], a[72:75]
v_exp_f32 v182, v182
v_mfma_f32_16x16x32_bf16 a[76:79], a[236:239], v[216:219], a[76:79]
v_exp_f32 v183, v183
v_mfma_f32_16x16x32_bf16 a[76:79], a[204:207], v[200:203], a[76:79]
Lstub5:
s_cbranch_execz Lstub9
ds_read_b128 a[180:183], v2 offset:29696
v_cvt_pk_bf16_f32 v215, v182, v183
v_mfma_f32_16x16x32_bf16 a[12:15], a[236:239], v[208:211], a[12:15]
v_exp_f32 v172, v172
v_mfma_f32_16x16x32_bf16 a[16:19], a[240:243], v[208:211], a[16:19]
s_waitcnt lgkmcnt(6)
ds_read_b128 a[184:187], v2 offset:30720
ds_read_b128 a[188:191], v2 offset:31744
v_mfma_f32_16x16x32_bf16 a[80:83], a[208:211], v[200:203], a[80:83]
v_exp_f32 v173, v173
v_mfma_f32_16x16x32_bf16 a[80:83], a[240:243], v[216:219], a[80:83]
buffer_load_dwordx4 v1, s[44:47], s72 offen offset:1024 sc1 lds
v_mfma_f32_16x16x32_bf16 a[84:87], a[244:247], v[216:219], a[84:87]
v_exp_f32 v174, v174
v_mfma_f32_16x16x32_bf16 a[84:87], a[212:215], v[200:203], a[84:87]
v_exp_f32 v175, v175
v_mfma_f32_16x16x32_bf16 a[20:23], a[244:247], v[208:211], a[20:23]
ds_read_b128 a[224:227], v2 offset:8192
v_cvt_pk_bf16_f32 v220, v172, v173
v_mfma_f32_16x16x32_bf16 a[24:27], a[248:251], v[208:211], a[24:27]
v_exp_f32 v188, v188
v_mfma_f32_16x16x32_bf16 a[88:91], a[216:219], v[200:203], a[88:91]
v_exp_f32 v189, v189
v_mfma_f32_16x16x32_bf16 a[88:91], a[248:251], v[216:219], a[88:91]
ds_read_b128 a[228:231], v2 offset:9216
v_cvt_pk_bf16_f32 v221, v174, v175
v_mfma_f32_16x16x32_bf16 a[92:95], a[252:255], v[216:219], a[92:95]
v_exp_f32 v190, v190
v_mfma_f32_16x16x32_bf16 a[92:95], a[220:223], v[200:203], a[92:95]
ds_read_b128 a[232:235], v2 offset:10240
v_cvt_pk_bf16_f32 v222, v188, v189
v_mfma_f32_16x16x32_bf16 a[28:31], a[252:255], v[208:211], a[28:31]
v_exp_f32 v191, v191
v_mfma_f32_16x16x32_bf16 v[136:139], a[128:131], v[48:51], v[88:91]
buffer_load_dwordx4 v1, s[44:47], s72 offen offset:2048 sc1 lds
v_mfma_f32_16x16x32_bf16 v[136:139], a[132:135], v[52:55], v[136:139]
v_exp_f32 v168, v168
v_mfma_f32_16x16x32_bf16 v[136:139], a[136:139], v[56:59], v[136:139]
ds_read_b128 a[236:239], v2 offset:11264
v_cvt_pk_bf16_f32 v223, v190, v191
v_mfma_f32_16x16x32_bf16 v[136:139], a[140:143], v[60:63], v[136:139]
v_exp_f32 v169, v169
v_mfma_f32_16x16x32_bf16 v[152:155], a[156:159], v[60:63], v[88:91]
ds_read_b128 a[240:243], v2 offset:12288
v_cvt_pk_bf16_f32 v216, v168, v169
v_mfma_f32_16x16x32_bf16 v[152:155], a[152:155], v[56:59], v[152:155]
v_exp_f32 v170, v170
v_mfma_f32_16x16x32_bf16 v[152:155], a[148:151], v[52:55], v[152:155]
v_exp_f32 v171, v171
v_mfma_f32_16x16x32_bf16 v[152:155], a[144:147], v[48:51], v[152:155]
ds_read_b128 a[244:247], v2 offset:13312
v_cvt_pk_bf16_f32 v217, v170, v171
v_mfma_f32_16x16x32_bf16 v[140:143], a[128:131], v[64:67], v[92:95]
v_exp_f32 v184, v184
v_mfma_f32_16x16x32_bf16 v[140:143], a[132:135], v[68:71], v[140:143]
ds_read_b128 a[248:251], v2 offset:14336
v_mfma_f32_16x16x32_bf16 v[140:143], a[136:139], v[72:75], v[140:143]
v_exp_f32 v185, v185
v_mfma_f32_16x16x32_bf16 v[140:143], a[140:143], v[76:79], v[140:143]
buffer_load_dwordx4 v1, s[44:47], s72 offen offset:3072 sc1 lds
v_mfma_f32_16x16x32_bf16 v[156:159], a[156:159], v[76:79], v[92:95]
ds_read_b128 a[252:255], v2 offset:15360
v_cvt_pk_bf16_f32 v218, v184, v185
v_mfma_f32_16x16x32_bf16 v[156:159], a[152:155], v[72:75], v[156:159]
v_exp_f32 v186, v186
v_mfma_f32_16x16x32_bf16 v[156:159], a[148:151], v[68:71], v[156:159]
s_waitcnt vmcnt(12) lgkmcnt(4)
v_exp_f32 v187, v187
v_mfma_f32_16x16x32_bf16 v[156:159], a[144:147], v[64:67], v[156:159]
s_barrier
v_cvt_pk_bf16_f32 v219, v186, v187
v_add_u32 v2, s82, v1
v_mfma_f32_16x16x32_bf16 v[228:231], v[120:123], v[196:199], v[228:231]
s_xor_b32 s74, s82, 0x10000
v_exp_f32 v136, v136
v_mfma_f32_16x16x32_bf16 v[228:231], v[120:123], v[212:215], v[228:231]
s_add_u32 s74, s74, s64
ds_read_b128 a[128:131], v2 offset:16384
v_add_u32 v5, s92, v5
v_mfma_f32_16x16x32_bf16 v[236:239], v[120:123], v[204:207], v[236:239]
s_add_u32 s81, s81, 0x8000
v_exp_f32 v137, v137
v_mfma_f32_16x16x32_bf16 v[236:239], v[120:123], v[220:223], v[236:239]
s_add_u32 m0, s74, 16384
ds_read_b128 a[132:135], v2 offset:17408
v_cvt_pk_bf16_f32 v200, v136, v137
v_mfma_f32_16x16x32_bf16 a[32:35], a[192:195], v[196:199], a[32:35]
s_add_u32 s72, s81, 16384
buffer_load_dwordx4 v1, s[44:47], s72 offen sc1 lds
v_mfma_f32_16x16x32_bf16 a[32:35], a[224:227], v[212:215], a[32:35]
s_add_u32 s69, s93, 0x4200000
v_exp_f32 v138, v138
v_mfma_f32_16x16x32_bf16 a[96:99], a[224:227], v[220:223], a[96:99]
ds_read_b128 a[136:139], v2 offset:18432
v_cndmask_b32 v5, v250, v5, vcc
v_mfma_f32_16x16x32_bf16 a[96:99], a[192:195], v[204:207], a[96:99]
v_exp_f32 v139, v139
v_mfma_f32_16x16x32_bf16 a[100:103], a[196:199], v[204:207], a[100:103]
ds_read_b128 a[140:143], v2 offset:19456
v_cvt_pk_bf16_f32 v201, v138, v139
v_mfma_f32_16x16x32_bf16 a[100:103], a[228:231], v[220:223], a[100:103]
buffer_store_dwordx4 v[112:115], v1, s[44:47], s69 offen sc1
v_mfma_f32_16x16x32_bf16 a[36:39], a[228:231], v[212:215], a[36:39]
v_exp_f32 v152, v152
v_mfma_f32_16x16x32_bf16 a[36:39], a[196:199], v[196:199], a[36:39]
ds_read_b128 a[144:147], v2 offset:20480
v_add_u32 v253, s58, v251
v_mfma_f32_16x16x32_bf16 a[40:43], a[200:203], v[196:199], a[40:43]
v_exp_f32 v153, v153
v_mfma_f32_16x16x32_bf16 a[40:43], a[232:235], v[212:215], a[40:43]
ds_read_b128 a[148:151], v2 offset:21504
v_cvt_pk_bf16_f32 v202, v152, v153
v_mfma_f32_16x16x32_bf16 a[104:107], a[232:235], v[220:223], a[104:107]
buffer_load_dwordx4 v1, s[44:47], s72 offen offset:1024 sc1 lds
v_mfma_f32_16x16x32_bf16 a[104:107], a[200:203], v[204:207], a[104:107]
v_exp_f32 v154, v154
v_mfma_f32_16x16x32_bf16 a[108:111], a[204:207], v[204:207], a[108:111]
ds_read_b128 a[152:155], v2 offset:22528
v_and_b32 v253, 3, v253
v_mfma_f32_16x16x32_bf16 a[108:111], a[236:239], v[220:223], a[108:111]
v_exp_f32 v155, v155
v_mfma_f32_16x16x32_bf16 a[44:47], a[236:239], v[212:215], a[44:47]
ds_read_b128 a[156:159], v2 offset:23552
v_cvt_pk_bf16_f32 v203, v154, v155
v_mfma_f32_16x16x32_bf16 a[44:47], a[204:207], v[196:199], a[44:47]
buffer_store_dwordx4 v[112:115], v1, s[44:47], s69 offen offset:1024 sc1
v_mfma_f32_16x16x32_bf16 a[48:51], a[208:211], v[196:199], a[48:51]
s_waitcnt lgkmcnt(8)
v_exp_f32 v140, v140
v_mfma_f32_16x16x32_bf16 a[48:51], a[240:243], v[212:215], a[48:51]
ds_read_b128 a[192:195], v2 offset:0
v_mul_u32_u24 v253, 4160, v253
v_mfma_f32_16x16x32_bf16 a[112:115], a[240:243], v[220:223], a[112:115]
v_exp_f32 v141, v141
v_mfma_f32_16x16x32_bf16 a[112:115], a[208:211], v[204:207], a[112:115]
ds_read_b128 a[196:199], v2 offset:1024
v_add_u32 v5, v5, v253
v_mfma_f32_16x16x32_bf16 a[116:119], a[212:215], v[204:207], a[116:119]
s_add_u32 s73, s62, 480
buffer_load_dwordx4 v1, s[44:47], s72 offen offset:2048 sc1 lds
v_mfma_f32_16x16x32_bf16 a[116:119], a[244:247], v[220:223], a[116:119]
v_exp_f32 v142, v142
v_mfma_f32_16x16x32_bf16 a[52:55], a[244:247], v[212:215], a[52:55]
ds_read_b128 a[200:203], v2 offset:2048
v_lshlrev_b32 v248, 5, v240
v_mfma_f32_16x16x32_bf16 a[52:55], a[212:215], v[196:199], a[52:55]
v_exp_f32 v143, v143
v_mfma_f32_16x16x32_bf16 a[56:59], a[216:219], v[196:199], a[56:59]
ds_read_b128 a[204:207], v2 offset:3072
v_sub_u32 v248, s73, v248
v_mfma_f32_16x16x32_bf16 a[56:59], a[248:251], v[212:215], a[56:59]
buffer_store_dwordx4 v[112:115], v1, s[44:47], s69 offen offset:2048 sc1
v_mfma_f32_16x16x32_bf16 a[120:123], a[248:251], v[220:223], a[120:123]
v_exp_f32 v156, v156
v_mfma_f32_16x16x32_bf16 a[120:123], a[216:219], v[204:207], a[120:123]
ds_read_b128 a[208:211], v2 offset:4096
v_lshl_add_u32 v7, v241, 4, v248
v_mfma_f32_16x16x32_bf16 a[124:127], a[220:223], v[204:207], a[124:127]
s_and_b32 s73, s58, 1
v_exp_f32 v157, v157
v_mfma_f32_16x16x32_bf16 a[124:127], a[252:255], v[220:223], a[124:127]
s_lshl_b32 s73, s73, 4
ds_read_b128 a[212:215], v2 offset:5120
v_mfma_f32_16x16x32_bf16 a[60:63], a[252:255], v[212:215], a[60:63]
s_lshr_b32 s73, s90, s73
buffer_load_dwordx4 v1, s[44:47], s72 offen offset:3072 sc1 lds
v_mfma_f32_16x16x32_bf16 a[60:63], a[220:223], v[196:199], a[60:63]
s_and_b32 s73, s73, 0xffff
ds_read_b128 a[216:219], v2 offset:6144
v_cvt_pk_bf16_f32 v204, v140, v141
v_mfma_f32_16x16x32_bf16 v[172:175], a[160:163], v[64:67], v[92:95]
v_exp_f32 v158, v158
v_mfma_f32_16x16x32_bf16 v[172:175], a[164:167], v[68:71], v[172:175]
ds_read_b128 a[220:223], v2 offset:7168
v_cvt_pk_bf16_f32 v205, v142, v143
v_mfma_f32_16x16x32_bf16 v[172:175], a[168:171], v[72:75], v[172:175]
v_exp_f32 v159, v159
v_mfma_f32_16x16x32_bf16 v[172:175], a[172:175], v[76:79], v[172:175]
buffer_store_dwordx4 v[112:115], v1, s[44:47], s69 offen offset:3072 sc1
v_mfma_f32_16x16x32_bf16 v[188:191], a[188:191], v[76:79], v[92:95]
v_cvt_pk_bf16_f32 v206, v156, v157
v_cvt_pk_bf16_f32 v207, v158, v159
v_mfma_f32_16x16x32_bf16 v[188:191], a[184:187], v[72:75], v[188:191]
v_lshl_add_u32 v248, v241, 3, v240
v_sub_u32 v248, 15, v248
v_mfma_f32_16x16x32_bf16 v[188:191], a[180:183], v[68:71], v[188:191]
v_and_b32 v249, 1, v248
v_lshlrev_b32 v249, 4, v249
v_mfma_f32_16x16x32_bf16 v[188:191], a[176:179], v[64:67], v[188:191]
v_lshlrev_b32 v249, v249, s73
v_lshrrev_b32 v248, 1, v248
v_mfma_f32_16x16x32_bf16 v[168:171], a[160:163], v[48:51], v[88:91]
v_and_b32 v241, 3, v0
v_cmp_eq_u32 vcc, 0, v248
v_mfma_f32_16x16x32_bf16 v[168:171], a[164:167], v[52:55], v[168:171]
v_lshl_add_u32 v5, v241, 3, v5
v_cndmask_b32 v8, 0, v249, vcc
v_mfma_f32_16x16x32_bf16 v[168:171], a[168:171], v[56:59], v[168:171]
v_cmp_eq_u32 vcc, 1, v248
v_lshlrev_b32 v240, 4, v251
v_mfma_f32_16x16x32_bf16 v[168:171], a[172:175], v[60:63], v[168:171]
v_cndmask_b32 v9, 0, v249, vcc
v_cmp_eq_u32 vcc, 2, v248
v_mfma_f32_16x16x32_bf16 v[184:187], a[188:191], v[60:63], v[88:91]
v_sub_u32 v240, 48, v240
v_lshlrev_b64 v[12:13], 16, s[88:89]
v_mfma_f32_16x16x32_bf16 v[184:187], a[184:187], v[56:59], v[184:187]
v_cndmask_b32 v10, 0, v249, vcc
v_cmp_eq_u32 vcc, 3, v248
v_mfma_f32_16x16x32_bf16 v[184:187], a[180:183], v[52:55], v[184:187]
v_lshlrev_b64 v[12:13], v240, v[12:13]
v_cndmask_b32 v11, 0, v249, vcc
v_mfma_f32_16x16x32_bf16 v[184:187], a[176:179], v[48:51], v[184:187]
s_waitcnt lgkmcnt(4)
v_cmp_eq_u32 vcc, 3, v241
s_add_u32 s73, s62, 4096
v_lshl_add_u32 v14, v0, 3, s73
v_cndmask_b32 v12, 0, v12, vcc
v_cndmask_b32 v13, 0, v13, vcc
v_lshrrev_b32 v15, 4, v0
v_lshlrev_b32 v15, 1, v15
v_and_b32 v240, 7, v0
v_xor_b32 v15, v15, v240
v_lshlrev_b32 v15, 4, v15
v_lshrrev_b32 v240, 3, v0
v_lshl_add_u32 v15, v240, 11, v15
s_lshl_b32 s75, s59, 1
s_andn2_b32 s75, 8, s75
s_add_u32 s75, s75, s60
s_lshl_b32 s76, s65, 2
s_lshr_b32 s80, s59, 3
s_add_u32 s76, s76, s80
s_lshl_b32 s94, s58, 16
s_lshl_b32 s80, s76, 7
s_add_u32 s94, s94, s80
s_lshl_b32 s80, s75, 18
s_add_u32 s80, s80, s94
v_rcp_f32 v226, v224
v_rcp_f32 v230, v228
s_lshl_b32 s73, s52, 12
s_add_u32 s73, s73, 0x2000000
s_lshl_b32 s70, s67, 2
s_add_u32 s70, s70, s73
v_or_b32 v3, s53, v1
v_mov_b32 v227, v226
v_accvgpr_read_b32 v240, a0
v_accvgpr_read_b32 v241, a1
v_accvgpr_read_b32 v242, a2
v_accvgpr_read_b32 v243, a3
v_accvgpr_read_b32 v244, a4
v_accvgpr_read_b32 v245, a5
v_accvgpr_read_b32 v246, a6
v_accvgpr_read_b32 v247, a7
v_pk_mul_f32 v[240:241], v[240:241], v[226:227]
v_pk_mul_f32 v[242:243], v[242:243], v[226:227]
v_pk_mul_f32 v[244:245], v[244:245], v[226:227]
v_pk_mul_f32 v[246:247], v[246:247], v[226:227]
v_cvt_pk_bf16_f32 v128, v240, v241
v_cvt_pk_bf16_f32 v129, v242, v243
v_cvt_pk_bf16_f32 v130, v244, v245
v_cvt_pk_bf16_f32 v131, v246, v247
v_accvgpr_read_b32 v248, a8
v_accvgpr_read_b32 v249, a9
v_accvgpr_read_b32 v250, a10
v_accvgpr_read_b32 v251, a11
v_accvgpr_read_b32 v252, a12
v_accvgpr_read_b32 v253, a13
v_accvgpr_read_b32 v254, a14
v_accvgpr_read_b32 v255, a15
v_pk_mul_f32 v[248:249], v[248:249], v[226:227]
v_pk_mul_f32 v[250:251], v[250:251], v[226:227]
v_pk_mul_f32 v[252:253], v[252:253], v[226:227]
v_pk_mul_f32 v[254:255], v[254:255], v[226:227]
v_cvt_pk_bf16_f32 v144, v248, v249
v_cvt_pk_bf16_f32 v145, v250, v251
v_cvt_pk_bf16_f32 v146, v252, v253
v_cvt_pk_bf16_f32 v147, v254, v255
v_accvgpr_read_b32 v240, a16
v_accvgpr_read_b32 v241, a17
v_accvgpr_read_b32 v242, a18
v_accvgpr_read_b32 v243, a19
v_accvgpr_read_b32 v244, a20
v_accvgpr_read_b32 v245, a21
v_accvgpr_read_b32 v246, a22
v_accvgpr_read_b32 v247, a23
v_pk_mul_f32 v[240:241], v[240:241], v[226:227]
v_pk_mul_f32 v[242:243], v[242:243], v[226:227]
v_pk_mul_f32 v[244:245], v[244:245], v[226:227]
v_pk_mul_f32 v[246:247], v[246:247], v[226:227]
v_cvt_pk_bf16_f32 v160, v240, v241
v_cvt_pk_bf16_f32 v161, v242, v243
v_cvt_pk_bf16_f32 v162, v244, v245
v_cvt_pk_bf16_f32 v163, v246, v247
v_accvgpr_read_b32 v248, a24
v_accvgpr_read_b32 v249, a25
v_accvgpr_read_b32 v250, a26
v_accvgpr_read_b32 v251, a27
v_accvgpr_read_b32 v252, a28
v_accvgpr_read_b32 v253, a29
v_accvgpr_read_b32 v254, a30
v_accvgpr_read_b32 v255, a31
v_pk_mul_f32 v[248:249], v[248:249], v[226:227]
v_pk_mul_f32 v[250:251], v[250:251], v[226:227]
v_pk_mul_f32 v[252:253], v[252:253], v[226:227]
v_pk_mul_f32 v[254:255], v[254:255], v[226:227]
v_cvt_pk_bf16_f32 v176, v248, v249
v_cvt_pk_bf16_f32 v177, v250, v251
v_cvt_pk_bf16_f32 v178, v252, v253
v_cvt_pk_bf16_f32 v179, v254, v255
v_mov_b32 v231, v230
v_accvgpr_read_b32 v240, a32
v_accvgpr_read_b32 v241, a33
v_accvgpr_read_b32 v242, a34
v_accvgpr_read_b32 v243, a35
v_accvgpr_read_b32 v244, a36
v_accvgpr_read_b32 v245, a37
v_accvgpr_read_b32 v246, a38
v_accvgpr_read_b32 v247, a39
v_pk_mul_f32 v[240:241], v[240:241], v[230:231]
v_pk_mul_f32 v[242:243], v[242:243], v[230:231]
v_pk_mul_f32 v[244:245], v[244:245], v[230:231]
v_pk_mul_f32 v[246:247], v[246:247], v[230:231]
v_cvt_pk_bf16_f32 v132, v240, v241
v_cvt_pk_bf16_f32 v133, v242, v243
v_cvt_pk_bf16_f32 v134, v244, v245
v_cvt_pk_bf16_f32 v135, v246, v247
v_accvgpr_read_b32 v248, a40
v_accvgpr_read_b32 v249, a41
v_accvgpr_read_b32 v250, a42
v_accvgpr_read_b32 v251, a43
v_accvgpr_read_b32 v252, a44
v_accvgpr_read_b32 v253, a45
v_accvgpr_read_b32 v254, a46
v_accvgpr_read_b32 v255, a47
v_pk_mul_f32 v[248:249], v[248:249], v[230:231]
v_pk_mul_f32 v[250:251], v[250:251], v[230:231]
v_pk_mul_f32 v[252:253], v[252:253], v[230:231]
v_pk_mul_f32 v[254:255], v[254:255], v[230:231]
v_cvt_pk_bf16_f32 v148, v248, v249
v_cvt_pk_bf16_f32 v149, v250, v251
v_cvt_pk_bf16_f32 v150, v252, v253
v_cvt_pk_bf16_f32 v151, v254, v255
v_accvgpr_read_b32 v240, a48
v_accvgpr_read_b32 v241, a49
v_accvgpr_read_b32 v242, a50
v_accvgpr_read_b32 v243, a51
v_accvgpr_read_b32 v244, a52
v_accvgpr_read_b32 v245, a53
v_accvgpr_read_b32 v246, a54
v_accvgpr_read_b32 v247, a55
v_pk_mul_f32 v[240:241], v[240:241], v[230:231]
v_pk_mul_f32 v[242:243], v[242:243], v[230:231]
v_pk_mul_f32 v[244:245], v[244:245], v[230:231]
v_pk_mul_f32 v[246:247], v[246:247], v[230:231]
v_cvt_pk_bf16_f32 v164, v240, v241
v_cvt_pk_bf16_f32 v165, v242, v243
v_cvt_pk_bf16_f32 v166, v244, v245
v_cvt_pk_bf16_f32 v167, v246, v247
v_accvgpr_read_b32 v248, a56
v_accvgpr_read_b32 v249, a57
v_accvgpr_read_b32 v250, a58
v_accvgpr_read_b32 v251, a59
v_accvgpr_read_b32 v252, a60
v_accvgpr_read_b32 v253, a61
v_accvgpr_read_b32 v254, a62
v_accvgpr_read_b32 v255, a63
v_pk_mul_f32 v[248:249], v[248:249], v[230:231]
v_pk_mul_f32 v[250:251], v[250:251], v[230:231]
v_pk_mul_f32 v[252:253], v[252:253], v[230:231]
v_pk_mul_f32 v[254:255], v[254:255], v[230:231]
v_cvt_pk_bf16_f32 v180, v248, v249
v_cvt_pk_bf16_f32 v181, v250, v251
v_cvt_pk_bf16_f32 v182, v252, v253
v_cvt_pk_bf16_f32 v183, v254, v255
v_mfma_f32_16x16x32_bf16 v[232:235], v[120:123], v[216:219], v[232:235]
s_add_u32 s82, s82, 0x8000
ds_read_b128 a[160:163], v2 offset:24576
ds_read_b128 a[164:167], v2 offset:25600
v_mfma_f32_16x16x32_bf16 v[232:235], v[120:123], v[200:203], v[232:235]
s_and_b32 s82, s82, 0x1ffff
v_exp_f32 v172, v172
v_mfma_f32_16x16x32_bf16 a[64:67], a[224:227], v[216:219], a[64:67]
s_add_u32 m0, s74, 0
v_exp_f32 v173, v173
v_mfma_f32_16x16x32_bf16 a[64:67], a[192:195], v[200:203], a[64:67]
s_add_u32 s72, s81, 0
buffer_load_dwordx4 v1, s[44:47], s72 offen sc1 lds
v_mfma_f32_16x16x32_bf16 a[68:71], a[196:199], v[200:203], a[68:71]
ds_read_b128 a[168:171], v2 offset:26624
v_cvt_pk_bf16_f32 v220, v172, v173
v_mfma_f32_16x16x32_bf16 a[68:71], a[228:231], v[216:219], a[68:71]
v_exp_f32 v174, v174
v_mfma_f32_16x16x32_bf16 a[72:75], a[232:235], v[216:219], a[72:75]
s_nop 0
ds_read_b128 a[172:175], v2 offset:27648
ds_read_b128 a[176:179], v2 offset:28672
v_mfma_f32_16x16x32_bf16 a[72:75], a[200:203], v[200:203], a[72:75]
v_exp_f32 v175, v175
v_mfma_f32_16x16x32_bf16 a[76:79], a[204:207], v[200:203], a[76:79]
v_exp_f32 v188, v188
v_mfma_f32_16x16x32_bf16 a[76:79], a[236:239], v[216:219], a[76:79]
buffer_store_dwordx4 v[128:131], v3, s[44:47], s70 offen sc1
v_mfma_f32_16x16x32_bf16 a[80:83], a[240:243], v[216:219], a[80:83]
s_waitcnt lgkmcnt(5)
ds_read_b128 a[180:183], v2 offset:29696
v_cvt_pk_bf16_f32 v221, v174, v175
v_mfma_f32_16x16x32_bf16 a[80:83], a[208:211], v[200:203], a[80:83]
v_exp_f32 v189, v189
v_mfma_f32_16x16x32_bf16 a[84:87], a[212:215], v[200:203], a[84:87]
ds_read_b128 a[184:187], v2 offset:30720
v_cvt_pk_bf16_f32 v222, v188, v189
v_mfma_f32_16x16x32_bf16 a[84:87], a[244:247], v[216:219], a[84:87]
v_exp_f32 v190, v190
v_mfma_f32_16x16x32_bf16 a[88:91], a[248:251], v[216:219], a[88:91]
buffer_load_dwordx4 v1, s[44:47], s72 offen offset:1024 sc1 lds
v_mfma_f32_16x16x32_bf16 a[88:91], a[216:219], v[200:203], a[88:91]
s_nop 0
ds_read_b128 a[188:191], v2 offset:31744
ds_read_b128 a[224:227], v2 offset:8192
v_mfma_f32_16x16x32_bf16 a[92:95], a[220:223], v[200:203], a[92:95]
v_exp_f32 v191, v191
v_mfma_f32_16x16x32_bf16 a[92:95], a[252:255], v[216:219], a[92:95]
v_exp_f32 v168, v168
v_mfma_f32_16x16x32_bf16 v[136:139], a[128:131], v[48:51], v[88:91]
ds_read_b128 a[228:231], v2 offset:9216
v_cvt_pk_bf16_f32 v223, v190, v191
v_mfma_f32_16x16x32_bf16 v[136:139], a[132:135], v[52:55], v[136:139]
v_exp_f32 v169, v169
v_mfma_f32_16x16x32_bf16 v[136:139], a[136:139], v[56:59], v[136:139]
buffer_store_dwordx4 v[144:147], v3, s[44:47], s70 offen offset:1024 sc1
v_mfma_f32_16x16x32_bf16 v[136:139], a[140:143], v[60:63], v[136:139]
ds_read_b128 a[232:235], v2 offset:10240
v_cvt_pk_bf16_f32 v216, v168, v169
v_mfma_f32_16x16x32_bf16 v[152:155], a[156:159], v[60:63], v[88:91]
v_exp_f32 v170, v170
v_mfma_f32_16x16x32_bf16 v[152:155], a[152:155], v[56:59], v[152:155]
s_nop 0
ds_read_b128 a[236:239], v2 offset:11264
ds_read_b128 a[240:243], v2 offset:12288
v_mfma_f32_16x16x32_bf16 v[152:155], a[148:151], v[52:55], v[152:155]
v_exp_f32 v171, v171
v_mfma_f32_16x16x32_bf16 v[152:155], a[144:147], v[48:51], v[152:155]
buffer_load_dwordx4 v1, s[44:47], s72 offen offset:2048 sc1 lds
v_mfma_f32_16x16x32_bf16 v[140:143], a[128:131], v[64:67], v[92:95]
v_exp_f32 v184, v184
v_mfma_f32_16x16x32_bf16 v[140:143], a[132:135], v[68:71], v[140:143]
ds_read_b128 a[244:247], v2 offset:13312
v_cvt_pk_bf16_f32 v217, v170, v171
v_mfma_f32_16x16x32_bf16 v[140:143], a[136:139], v[72:75], v[140:143]
v_exp_f32 v185, v185
v_mfma_f32_16x16x32_bf16 v[140:143], a[140:143], v[76:79], v[140:143]
s_nop 0
ds_read_b128 a[248:251], v2 offset:14336
ds_read_b128 a[252:255], v2 offset:15360
v_mfma_f32_16x16x32_bf16 v[156:159], a[156:159], v[76:79], v[92:95]
v_exp_f32 v186, v186
v_mfma_f32_16x16x32_bf16 v[156:159], a[152:155], v[72:75], v[156:159]
buffer_load_dwordx4 v1, s[44:47], s72 offen offset:3072 sc1 lds
v_mfma_f32_16x16x32_bf16 v[156:159], a[148:151], v[68:71], v[156:159]
s_waitcnt vmcnt(14) lgkmcnt(4)
v_exp_f32 v187, v187
v_mfma_f32_16x16x32_bf16 v[156:159], a[144:147], v[64:67], v[156:159]
s_barrier
v_cvt_pk_bf16_f32 v218, v184, v185
v_cvt_pk_bf16_f32 v219, v186, v187
v_add_u32 v2, s82, v1
v_mfma_f32_16x16x32_bf16 v[236:239], v[120:123], v[204:207], v[236:239]
s_xor_b32 s74, s82, 0x10000
v_exp_f32 v136, v136
v_mfma_f32_16x16x32_bf16 v[236:239], v[120:123], v[220:223], v[236:239]
s_add_u32 s74, s74, s64
ds_read_b128 a[128:131], v2 offset:16384
ds_read_b128 a[132:135], v2 offset:17408
v_mfma_f32_16x16x32_bf16 a[96:99], a[192:195], v[204:207], a[96:99]
s_add_u32 s81, s81, 0x8000
v_exp_f32 v137, v137
v_mfma_f32_16x16x32_bf16 a[96:99], a[224:227], v[220:223], a[96:99]
s_add_u32 m0, s74, 16384
v_exp_f32 v138, v138
v_mfma_f32_16x16x32_bf16 a[100:103], a[228:231], v[220:223], a[100:103]
s_add_u32 s72, s81, 16384
buffer_load_dwordx4 v1, s[44:47], s72 offen sc1 lds
v_mfma_f32_16x16x32_bf16 a[100:103], a[196:199], v[204:207], a[100:103]
ds_read_b128 a[136:139], v2 offset:18432
v_cvt_pk_bf16_f32 v200, v136, v137
v_mfma_f32_16x16x32_bf16 a[104:107], a[200:203], v[204:207], a[104:107]
v_exp_f32 v139, v139
v_mfma_f32_16x16x32_bf16 a[104:107], a[232:235], v[220:223], a[104:107]
ds_read_b128 a[140:143], v2 offset:19456
v_cvt_pk_bf16_f32 v201, v138, v139
v_mfma_f32_16x16x32_bf16 a[108:111], a[236:239], v[220:223], a[108:111]
buffer_store_dwordx4 v[160:163], v3, s[44:47], s70 offen offset:2048 sc1
v_mfma_f32_16x16x32_bf16 a[108:111], a[204:207], v[204:207], a[108:111]
v_exp_f32 v152, v152
v_mfma_f32_16x16x32_bf16 a[112:115], a[208:211], v[204:207], a[112:115]
s_waitcnt lgkmcnt(4)
ds_read_b128 a[144:147], v2 offset:20480
ds_read_b128 a[148:151], v2 offset:21504
v_mfma_f32_16x16x32_bf16 a[112:115], a[240:243], v[220:223], a[112:115]
v_exp_f32 v153, v153
v_mfma_f32_16x16x32_bf16 a[116:119], a[244:247], v[220:223], a[116:119]
buffer_load_dwordx4 v1, s[44:47], s72 offen offset:1024 sc1 lds
v_mfma_f32_16x16x32_bf16 a[116:119], a[212:215], v[204:207], a[116:119]
v_exp_f32 v154, v154
v_mfma_f32_16x16x32_bf16 a[120:123], a[216:219], v[204:207], a[120:123]
ds_read_b128 a[152:155], v2 offset:22528
v_cvt_pk_bf16_f32 v202, v152, v153
v_mfma_f32_16x16x32_bf16 a[120:123], a[248:251], v[220:223], a[120:123]
v_exp_f32 v155, v155
v_mfma_f32_16x16x32_bf16 a[124:127], a[252:255], v[220:223], a[124:127]
ds_read_b128 a[156:159], v2 offset:23552
v_cvt_pk_bf16_f32 v203, v154, v155
v_mfma_f32_16x16x32_bf16 a[124:127], a[220:223], v[204:207], a[124:127]
v_exp_f32 v140, v140
v_mfma_f32_16x16x32_bf16 v[172:175], a[160:163], v[64:67], v[92:95]
s_nop 0
ds_read_b128 a[192:195], v2 offset:0
ds_read_b128 a[196:199], v2 offset:1024
v_mfma_f32_16x16x32_bf16 v[172:175], a[164:167], v[68:71], v[172:175]
buffer_store_dwordx4 v[176:179], v3, s[44:47], s70 offen offset:3072 sc1
v_mfma_f32_16x16x32_bf16 v[172:175], a[168:171], v[72:75], v[172:175]
v_exp_f32 v141, v141
v_mfma_f32_16x16x32_bf16 v[172:175], a[172:175], v[76:79], v[172:175]
v_exp_f32 v142, v142
v_mfma_f32_16x16x32_bf16 v[188:191], a[188:191], v[76:79], v[92:95]
s_nop 0
ds_read_b128 a[200:203], v2 offset:2048
ds_read_b128 a[204:207], v2 offset:3072
v_mfma_f32_16x16x32_bf16 v[188:191], a[184:187], v[72:75], v[188:191]
buffer_load_dwordx4 v1, s[44:47], s72 offen offset:2048 sc1 lds
v_mfma_f32_16x16x32_bf16 v[188:191], a[180:183], v[68:71], v[188:191]
s_add_u32 s70, s70, 0x80000
v_exp_f32 v143, v143
v_mfma_f32_16x16x32_bf16 v[188:191], a[176:179], v[64:67], v[188:191]
v_exp_f32 v156, v156
v_mfma_f32_16x16x32_bf16 v[168:171], a[160:163], v[48:51], v[88:91]
s_nop 0
ds_read_b128 a[208:211], v2 offset:4096
ds_read_b128 a[212:215], v2 offset:5120
v_mfma_f32_16x16x32_bf16 v[168:171], a[164:167], v[52:55], v[168:171]
s_nop 0
ds_read_b128 a[216:219], v2 offset:6144
ds_read_b128 a[220:223], v2 offset:7168
v_mfma_f32_16x16x32_bf16 v[168:171], a[168:171], v[56:59], v[168:171]
v_cvt_pk_bf16_f32 v204, v140, v141
v_cvt_pk_bf16_f32 v205, v142, v143
v_mfma_f32_16x16x32_bf16 v[168:171], a[172:175], v[60:63], v[168:171]
buffer_store_dwordx4 v[132:135], v3, s[44:47], s70 offen sc1
v_mfma_f32_16x16x32_bf16 v[184:187], a[188:191], v[60:63], v[88:91]
v_exp_f32 v157, v157
v_mfma_f32_16x16x32_bf16 v[184:187], a[184:187], v[56:59], v[184:187]
v_exp_f32 v158, v158
v_mfma_f32_16x16x32_bf16 v[184:187], a[180:183], v[52:55], v[184:187]
buffer_load_dwordx4 v1, s[44:47], s72 offen offset:3072 sc1 lds
v_mfma_f32_16x16x32_bf16 v[184:187], a[176:179], v[48:51], v[184:187]
s_waitcnt lgkmcnt(4)
v_exp_f32 v159, v159
v_cvt_pk_bf16_f32 v206, v156, v157
v_cvt_pk_bf16_f32 v207, v158, v159
v_mfma_f32_16x16x32_bf16 v[232:235], v[120:123], v[216:219], v[232:235]
s_add_u32 s82, s82, 0x8000
ds_read_b128 a[160:163], v2 offset:24576
ds_read_b128 a[164:167], v2 offset:25600
v_mfma_f32_16x16x32_bf16 v[232:235], v[120:123], v[200:203], v[232:235]
s_and_b32 s82, s82, 0x1ffff
v_exp_f32 v172, v172
v_mfma_f32_16x16x32_bf16 a[64:67], a[224:227], v[216:219], a[64:67]
s_add_u32 m0, s74, 0
v_exp_f32 v173, v173
v_mfma_f32_16x16x32_bf16 a[64:67], a[192:195], v[200:203], a[64:67]
s_add_u32 s72, s81, 0
buffer_load_dwordx4 v1, s[44:47], s72 offen sc1 lds
v_mfma_f32_16x16x32_bf16 a[68:71], a[196:199], v[200:203], a[68:71]
ds_read_b128 a[168:171], v2 offset:26624
v_cvt_pk_bf16_f32 v220, v172, v173
v_mfma_f32_16x16x32_bf16 a[68:71], a[228:231], v[216:219], a[68:71]
v_exp_f32 v174, v174
v_mfma_f32_16x16x32_bf16 a[72:75], a[232:235], v[216:219], a[72:75]
s_nop 0
ds_read_b128 a[172:175], v2 offset:27648
ds_read_b128 a[176:179], v2 offset:28672
v_mfma_f32_16x16x32_bf16 a[72:75], a[200:203], v[200:203], a[72:75]
v_exp_f32 v175, v175
v_mfma_f32_16x16x32_bf16 a[76:79], a[204:207], v[200:203], a[76:79]
buffer_store_dwordx4 v[148:151], v3, s[44:47], s70 offen offset:1024 sc1
v_mfma_f32_16x16x32_bf16 a[76:79], a[236:239], v[216:219], a[76:79]
Lstub6:
s_cbranch_execz Lstub10
v_exp_f32 v188, v188
v_mfma_f32_16x16x32_bf16 a[80:83], a[240:243], v[216:219], a[80:83]
s_waitcnt lgkmcnt(5)
ds_read_b128 a[180:183], v2 offset:29696
v_cvt_pk_bf16_f32 v221, v174, v175
v_mfma_f32_16x16x32_bf16 a[80:83], a[208:211], v[200:203], a[80:83]
v_exp_f32 v189, v189
v_mfma_f32_16x16x32_bf16 a[84:87], a[212:215], v[200:203], a[84:87]
buffer_load_dwordx4 v1, s[44:47], s72 offen offset:1024 sc1 lds
v_mfma_f32_16x16x32_bf16 a[84:87], a[244:247], v[216:219], a[84:87]
ds_read_b128 a[184:187], v2 offset:30720
v_cvt_pk_bf16_f32 v222, v188, v189
v_mfma_f32_16x16x32_bf16 a[88:91], a[248:251], v[216:219], a[88:91]
v_exp_f32 v190, v190
v_mfma_f32_16x16x32_bf16 a[88:91], a[216:219], v[200:203], a[88:91]
s_nop 0
ds_read_b128 a[188:191], v2 offset:31744
ds_read_b128 a[224:227], v2 offset:8192
v_mfma_f32_16x16x32_bf16 a[92:95], a[220:223], v[200:203], a[92:95]
v_exp_f32 v191, v191
v_mfma_f32_16x16x32_bf16 a[92:95], a[252:255], v[216:219], a[92:95]
buffer_store_dwordx4 v[164:167], v3, s[44:47], s70 offen offset:2048 sc1
v_mfma_f32_16x16x32_bf16 v[136:139], a[128:131], v[48:51], v[88:91]
v_exp_f32 v168, v168
v_mfma_f32_16x16x32_bf16 v[136:139], a[132:135], v[52:55], v[136:139]
ds_read_b128 a[228:231], v2 offset:9216
v_cvt_pk_bf16_f32 v223, v190, v191
v_mfma_f32_16x16x32_bf16 v[136:139], a[136:139], v[56:59], v[136:139]
v_exp_f32 v169, v169
v_mfma_f32_16x16x32_bf16 v[136:139], a[140:143], v[60:63], v[136:139]
s_nop 0
ds_read_b128 a[232:235], v2 offset:10240
ds_read_b128 a[236:239], v2 offset:11264
v_mfma_f32_16x16x32_bf16 v[152:155], a[156:159], v[60:63], v[88:91]
v_exp_f32 v170, v170
v_mfma_f32_16x16x32_bf16 v[152:155], a[152:155], v[56:59], v[152:155]
buffer_load_dwordx4 v1, s[44:47], s72 offen offset:2048 sc1 lds
v_mfma_f32_16x16x32_bf16 v[152:155], a[148:151], v[52:55], v[152:155]
v_exp_f32 v171, v171
v_mfma_f32_16x16x32_bf16 v[152:155], a[144:147], v[48:51], v[152:155]
s_nop 0
ds_read_b128 a[240:243], v2 offset:12288
ds_read_b128 a[244:247], v2 offset:13312
v_mfma_f32_16x16x32_bf16 v[140:143], a[128:131], v[64:67], v[92:95]
v_exp_f32 v184, v184
v_mfma_f32_16x16x32_bf16 v[140:143], a[132:135], v[68:71], v[140:143]
s_nop 0
ds_read_b128 a[248:251], v2 offset:14336
ds_read_b128 a[252:255], v2 offset:15360
v_mfma_f32_16x16x32_bf16 v[140:143], a[136:139], v[72:75], v[140:143]
v_cvt_pk_bf16_f32 v216, v168, v169
v_cvt_pk_bf16_f32 v217, v170, v171
v_mfma_f32_16x16x32_bf16 v[140:143], a[140:143], v[76:79], v[140:143]
buffer_store_dwordx4 v[180:183], v3, s[44:47], s70 offen offset:3072 sc1
v_mfma_f32_16x16x32_bf16 v[156:159], a[156:159], v[76:79], v[92:95]
v_exp_f32 v185, v185
v_mfma_f32_16x16x32_bf16 v[156:159], a[152:155], v[72:75], v[156:159]
buffer_load_dwordx4 v1, s[44:47], s72 offen offset:3072 sc1 lds
v_mfma_f32_16x16x32_bf16 v[156:159], a[148:151], v[68:71], v[156:159]
s_waitcnt vmcnt(14) lgkmcnt(4)
v_exp_f32 v186, v186
v_mfma_f32_16x16x32_bf16 v[156:159], a[144:147], v[64:67], v[156:159]
s_barrier
v_exp_f32 v187, v187
v_add_u32 v2, s82, v1
v_cvt_pk_bf16_f32 v218, v184, v185
v_cvt_pk_bf16_f32 v219, v186, v187
s_lshl_b32 s83, s60, 2
s_sub_u32 s83, s83, 25
.p2align 5
s_nop 0
s_nop 0
LloopII:
v_mfma_f32_16x16x32_bf16 v[236:239], v[120:123], v[204:207], v[236:239]
s_xor_b32 s74, s82, 0x10000
v_exp_f32 v136, v136
v_mfma_f32_16x16x32_bf16 v[236:239], v[120:123], v[220:223], v[236:239]
s_add_u32 s74, s74, s64
ds_read_b128 a[128:131], v2 offset:16384
ds_read_b128 a[132:135], v2 offset:17408
v_mfma_f32_16x16x32_bf16 a[96:99], a[192:195], v[204:207], a[96:99]
s_add_u32 s81, s81, 0x8000
v_exp_f32 v137, v137
v_mfma_f32_16x16x32_bf16 a[96:99], a[224:227], v[220:223], a[96:99]
s_add_u32 m0, s74, 16384
v_exp_f32 v138, v138
v_mfma_f32_16x16x32_bf16 a[100:103], a[228:231], v[220:223], a[100:103]
s_add_u32 s72, s81, 16384
ds_read_b128 a[136:139], v2 offset:18432
v_cvt_pk_bf16_f32 v200, v136, v137
v_mfma_f32_16x16x32_bf16 a[100:103], a[196:199], v[204:207], a[100:103]
buffer_load_dwordx4 v1, s[44:47], s72 offen sc1 lds
v_mfma_f32_16x16x32_bf16 a[104:107], a[200:203], v[204:207], a[104:107]
v_exp_f32 v139, v139
v_mfma_f32_16x16x32_bf16 a[104:107], a[232:235], v[220:223], a[104:107]
ds_read_b128 a[140:143], v2 offset:19456
v_cvt_pk_bf16_f32 v201, v138, v139
v_mfma_f32_16x16x32_bf16 a[108:111], a[236:239], v[220:223], a[108:111]
v_exp_f32 v152, v152
v_mfma_f32_16x16x32_bf16 a[108:111], a[204:207], v[204:207], a[108:111]
s_nop 0
ds_read_b128 a[144:147], v2 offset:20480
ds_read_b128 a[148:151], v2 offset:21504
v_mfma_f32_16x16x32_bf16 a[112:115], a[208:211], v[204:207], a[112:115]
s_waitcnt lgkmcnt(6)
v_exp_f32 v153, v153
v_mfma_f32_16x16x32_bf16 a[112:115], a[240:243], v[220:223], a[112:115]
v_exp_f32 v154, v154
v_mfma_f32_16x16x32_bf16 a[116:119], a[244:247], v[220:223], a[116:119]
ds_read_b128 a[152:155], v2 offset:22528
v_cvt_pk_bf16_f32 v202, v152, v153
v_mfma_f32_16x16x32_bf16 a[116:119], a[212:215], v[204:207], a[116:119]
buffer_load_dwordx4 v1, s[44:47], s72 offen offset:1024 sc1 lds
v_mfma_f32_16x16x32_bf16 a[120:123], a[216:219], v[204:207], a[120:123]
v_exp_f32 v155, v155
v_mfma_f32_16x16x32_bf16 a[120:123], a[248:251], v[220:223], a[120:123]
ds_read_b128 a[156:159], v2 offset:23552
v_cvt_pk_bf16_f32 v203, v154, v155
v_mfma_f32_16x16x32_bf16 a[124:127], a[252:255], v[220:223], a[124:127]
v_exp_f32 v140, v140
v_mfma_f32_16x16x32_bf16 a[124:127], a[220:223], v[204:207], a[124:127]
s_nop 0
ds_read_b128 a[192:195], v2 offset:0
ds_read_b128 a[196:199], v2 offset:1024
v_mfma_f32_16x16x32_bf16 v[172:175], a[160:163], v[64:67], v[92:95]
v_exp_f32 v141, v141
v_mfma_f32_16x16x32_bf16 v[172:175], a[164:167], v[68:71], v[172:175]
v_exp_f32 v142, v142
v_mfma_f32_16x16x32_bf16 v[172:175], a[168:171], v[72:75], v[172:175]
ds_read_b128 a[200:203], v2 offset:2048
v_cvt_pk_bf16_f32 v204, v140, v141
v_mfma_f32_16x16x32_bf16 v[172:175], a[172:175], v[76:79], v[172:175]
buffer_load_dwordx4 v1, s[44:47], s72 offen offset:2048 sc1 lds
v_mfma_f32_16x16x32_bf16 v[188:191], a[188:191], v[76:79], v[92:95]
v_exp_f32 v143, v143
v_mfma_f32_16x16x32_bf16 v[188:191], a[184:187], v[72:75], v[188:191]
ds_read_b128 a[204:207], v2 offset:3072
v_cvt_pk_bf16_f32 v205, v142, v143
v_mfma_f32_16x16x32_bf16 v[188:191], a[180:183], v[68:71], v[188:191]
v_exp_f32 v156, v156
v_mfma_f32_16x16x32_bf16 v[188:191], a[176:179], v[64:67], v[188:191]
ds_read_b128 a[208:211], v2 offset:4096
v_mfma_f32_16x16x32_bf16 v[168:171], a[160:163], v[48:51], v[88:91]
v_exp_f32 v157, v157
v_mfma_f32_16x16x32_bf16 v[168:171], a[164:167], v[52:55], v[168:171]
ds_read_b128 a[212:215], v2 offset:5120
v_cvt_pk_bf16_f32 v206, v156, v157
v_mfma_f32_16x16x32_bf16 v[168:171], a[168:171], v[56:59], v[168:171]
v_exp_f32 v158, v158
v_mfma_f32_16x16x32_bf16 v[168:171], a[172:175], v[60:63], v[168:171]
ds_read_b128 a[216:219], v2 offset:6144
v_mfma_f32_16x16x32_bf16 v[184:187], a[188:191], v[60:63], v[88:91]
buffer_load_dwordx4 v1, s[44:47], s72 offen offset:3072 sc1 lds
v_mfma_f32_16x16x32_bf16 v[184:187], a[184:187], v[56:59], v[184:187]
v_exp_f32 v159, v159
v_mfma_f32_16x16x32_bf16 v[184:187], a[180:183], v[52:55], v[184:187]
ds_read_b128 a[220:223], v2 offset:7168
v_cvt_pk_bf16_f32 v207, v158, v159
v_mfma_f32_16x16x32_bf16 v[184:187], a[176:179], v[48:51], v[184:187]
s_waitcnt lgkmcnt(4)
v_mfma_f32_16x16x32_bf16 v[232:235], v[120:123], v[216:219], v[232:235]
s_add_u32 s82, s82, 0x8000
ds_read_b128 a[160:163], v2 offset:24576
ds_read_b128 a[164:167], v2 offset:25600
v_mfma_f32_16x16x32_bf16 v[232:235], v[120:123], v[200:203], v[232:235]
s_and_b32 s82, s82, 0x1ffff
v_exp_f32 v172, v172
v_mfma_f32_16x16x32_bf16 a[64:67], a[224:227], v[216:219], a[64:67]
s_add_u32 m0, s74, 0
v_exp_f32 v173, v173
v_mfma_f32_16x16x32_bf16 a[64:67], a[192:195], v[200:203], a[64:67]
s_add_u32 s72, s81, 0
ds_read_b128 a[168:171], v2 offset:26624
v_cvt_pk_bf16_f32 v220, v172, v173
v_mfma_f32_16x16x32_bf16 a[68:71], a[196:199], v[200:203], a[68:71]
v_exp_f32 v174, v174
v_mfma_f32_16x16x32_bf16 a[68:71], a[228:231], v[216:219], a[68:71]
buffer_load_dwordx4 v1, s[44:47], s72 offen sc1 lds
v_mfma_f32_16x16x32_bf16 a[72:75], a[232:235], v[216:219], a[72:75]
s_nop 0
ds_read_b128 a[172:175], v2 offset:27648
ds_read_b128 a[176:179], v2 offset:28672
v_mfma_f32_16x16x32_bf16 a[72:75], a[200:203], v[200:203], a[72:75]
v_exp_f32 v175, v175
v_mfma_f32_16x16x32_bf16 a[76:79], a[204:207], v[200:203], a[76:79]
v_exp_f32 v188, v188
v_mfma_f32_16x16x32_bf16 a[76:79], a[236:239], v[216:219], a[76:79]
ds_read_b128 a[180:183], v2 offset:29696
v_cvt_pk_bf16_f32 v221, v174, v175
v_mfma_f32_16x16x32_bf16 a[80:83], a[240:243], v[216:219], a[80:83]
s_waitcnt lgkmcnt(6)
v_exp_f32 v189, v189
v_mfma_f32_16x16x32_bf16 a[80:83], a[208:211], v[200:203], a[80:83]
ds_read_b128 a[184:187], v2 offset:30720
v_cvt_pk_bf16_f32 v222, v188, v189
v_mfma_f32_16x16x32_bf16 a[84:87], a[212:215], v[200:203], a[84:87]
buffer_load_dwordx4 v1, s[44:47], s72 offen offset:1024 sc1 lds
v_mfma_f32_16x16x32_bf16 a[84:87], a[244:247], v[216:219], a[84:87]
v_exp_f32 v190, v190
v_mfma_f32_16x16x32_bf16 a[88:91], a[248:251], v[216:219], a[88:91]
s_nop 0
ds_read_b128 a[188:191], v2 offset:31744
ds_read_b128 a[224:227], v2 offset:8192
v_mfma_f32_16x16x32_bf16 a[88:91], a[216:219], v[200:203], a[88:91]
v_exp_f32 v191, v191
v_mfma_f32_16x16x32_bf16 a[92:95], a[220:223], v[200:203], a[92:95]
v_exp_f32 v168, v168
v_mfma_f32_16x16x32_bf16 a[92:95], a[252:255], v[216:219], a[92:95]
ds_read_b128 a[228:231], v2 offset:9216
v_cvt_pk_bf16_f32 v223, v190, v191
v_mfma_f32_16x16x32_bf16 v[136:139], a[128:131], v[48:51], v[88:91]
v_exp_f32 v169, v169
v_mfma_f32_16x16x32_bf16 v[136:139], a[132:135], v[52:55], v[136:139]
ds_read_b128 a[232:235], v2 offset:10240
v_cvt_pk_bf16_f32 v216, v168, v169
v_mfma_f32_16x16x32_bf16 v[136:139], a[136:139], v[56:59], v[136:139]
buffer_load_dwordx4 v1, s[44:47], s72 offen offset:2048 sc1 lds
v_mfma_f32_16x16x32_bf16 v[136:139], a[140:143], v[60:63], v[136:139]
v_exp_f32 v170, v170
v_mfma_f32_16x16x32_bf16 v[152:155], a[156:159], v[60:63], v[88:91]
s_nop 0
ds_read_b128 a[236:239], v2 offset:11264
ds_read_b128 a[240:243], v2 offset:12288
v_mfma_f32_16x16x32_bf16 v[152:155], a[152:155], v[56:59], v[152:155]
v_exp_f32 v171, v171
v_mfma_f32_16x16x32_bf16 v[152:155], a[148:151], v[52:55], v[152:155]
v_exp_f32 v184, v184
v_mfma_f32_16x16x32_bf16 v[152:155], a[144:147], v[48:51], v[152:155]
ds_read_b128 a[244:247], v2 offset:13312
v_cvt_pk_bf16_f32 v217, v170, v171
v_mfma_f32_16x16x32_bf16 v[140:143], a[128:131], v[64:67], v[92:95]
v_exp_f32 v185, v185
v_mfma_f32_16x16x32_bf16 v[140:143], a[132:135], v[68:71], v[140:143]
ds_read_b128 a[248:251], v2 offset:14336
v_cvt_pk_bf16_f32 v218, v184, v185
v_mfma_f32_16x16x32_bf16 v[140:143], a[136:139], v[72:75], v[140:143]
buffer_load_dwordx4 v1, s[44:47], s72 offen offset:3072 sc1 lds
v_mfma_f32_16x16x32_bf16 v[140:143], a[140:143], v[76:79], v[140:143]
ds_read_b128 a[252:255], v2 offset:15360
v_add_u32 v2, s82, v1
v_mfma_f32_16x16x32_bf16 v[156:159], a[156:159], v[76:79], v[92:95]
s_waitcnt vmcnt(8) lgkmcnt(4)
v_exp_f32 v186, v186
v_mfma_f32_16x16x32_bf16 v[156:159], a[152:155], v[72:75], v[156:159]
s_barrier
v_exp_f32 v187, v187
v_mfma_f32_16x16x32_bf16 v[156:159], a[148:151], v[68:71], v[156:159]
s_add_u32 s83, s83, 1
v_cvt_pk_bf16_f32 v219, v186, v187
v_mfma_f32_16x16x32_bf16 v[156:159], a[144:147], v[64:67], v[156:159]
s_cbranch_scc0 LloopII
v_mfma_f32_16x16x32_bf16 v[236:239], v[120:123], v[204:207], v[236:239]
s_xor_b32 s74, s82, 0x10000
ds_read_b128 a[128:131], v2 offset:16384
ds_read_b128 a[132:135], v2 offset:17408
v_mfma_f32_16x16x32_bf16 v[236:239], v[120:123], v[220:223], v[236:239]
s_add_u32 s74, s74, s64
v_exp_f32 v136, v136
v_mfma_f32_16x16x32_bf16 a[96:99], a[192:195], v[204:207], a[96:99]
s_add_u32 s81, s81, 0x8000
v_exp_f32 v137, v137
v_mfma_f32_16x16x32_bf16 a[96:99], a[224:227], v[220:223], a[96:99]
s_add_u32 m0, s74, 0
ds_read_b128 a[136:139], v2 offset:18432
v_cvt_pk_bf16_f32 v200, v136, v137
v_mfma_f32_16x16x32_bf16 a[100:103], a[228:231], v[220:223], a[100:103]
s_add_u32 s72, s81, 0
v_exp_f32 v138, v138
v_mfma_f32_16x16x32_bf16 a[100:103], a[196:199], v[204:207], a[100:103]
buffer_load_dwordx4 v1, s[44:47], s72 offen sc1 lds
v_mfma_f32_16x16x32_bf16 a[104:107], a[200:203], v[204:207], a[104:107]
s_nop 0
ds_read_b128 a[140:143], v2 offset:19456
ds_read_b128 a[144:147], v2 offset:20480
v_mfma_f32_16x16x32_bf16 a[104:107], a[232:235], v[220:223], a[104:107]
v_exp_f32 v139, v139
v_mfma_f32_16x16x32_bf16 a[108:111], a[236:239], v[220:223], a[108:111]
v_exp_f32 v152, v152
v_mfma_f32_16x16x32_bf16 a[108:111], a[204:207], v[204:207], a[108:111]
ds_read_b128 a[148:151], v2 offset:21504
v_cvt_pk_bf16_f32 v201, v138, v139
v_mfma_f32_16x16x32_bf16 a[112:115], a[208:211], v[204:207], a[112:115]
s_waitcnt lgkmcnt(6)
v_exp_f32 v153, v153
v_mfma_f32_16x16x32_bf16 a[112:115], a[240:243], v[220:223], a[112:115]
ds_read_b128 a[152:155], v2 offset:22528
v_cvt_pk_bf16_f32 v202, v152, v153
v_mfma_f32_16x16x32_bf16 a[116:119], a[244:247], v[220:223], a[116:119]
v_exp_f32 v154, v154
v_mfma_f32_16x16x32_bf16 a[116:119], a[212:215], v[204:207], a[116:119]
buffer_load_dwordx4 v1, s[44:47], s72 offen offset:1024 sc1 lds
v_mfma_f32_16x16x32_bf16 a[120:123], a[216:219], v[204:207], a[120:123]
s_nop 0
ds_read_b128 a[156:159], v2 offset:23552
ds_read_b128 a[192:195], v2 offset:0
v_mfma_f32_16x16x32_bf16 a[120:123], a[248:251], v[220:223], a[120:123]
v_exp_f32 v155, v155
v_mfma_f32_16x16x32_bf16 a[124:127], a[252:255], v[220:223], a[124:127]
v_exp_f32 v140, v140
v_mfma_f32_16x16x32_bf16 a[124:127], a[220:223], v[204:207], a[124:127]
ds_read_b128 a[196:199], v2 offset:1024
v_cvt_pk_bf16_f32 v203, v154, v155
v_mfma_f32_16x16x32_bf16 v[172:175], a[160:163], v[64:67], v[92:95]
v_exp_f32 v141, v141
v_mfma_f32_16x16x32_bf16 v[172:175], a[164:167], v[68:71], v[172:175]
ds_read_b128 a[200:203], v2 offset:2048
v_cvt_pk_bf16_f32 v204, v140, v141
v_mfma_f32_16x16x32_bf16 v[172:175], a[168:171], v[72:75], v[172:175]
v_exp_f32 v142, v142
v_mfma_f32_16x16x32_bf16 v[172:175], a[172:175], v[76:79], v[172:175]
buffer_load_dwordx4 v1, s[44:47], s72 offen offset:2048 sc1 lds
v_mfma_f32_16x16x32_bf16 v[188:191], a[188:191], v[76:79], v[92:95]
ds_read_b128 a[204:207], v2 offset:3072
v_mfma_f32_16x16x32_bf16 v[188:191], a[184:187], v[72:75], v[188:191]
v_exp_f32 v143, v143
v_mfma_f32_16x16x32_bf16 v[188:191], a[180:183], v[68:71], v[188:191]
ds_read_b128 a[208:211], v2 offset:4096
v_cvt_pk_bf16_f32 v205, v142, v143
v_mfma_f32_16x16x32_bf16 v[188:191], a[176:179], v[64:67], v[188:191]
v_exp_f32 v156, v156
v_mfma_f32_16x16x32_bf16 v[168:171], a[160:163], v[48:51], v[88:91]
ds_read_b128 a[212:215], v2 offset:5120
v_mfma_f32_16x16x32_bf16 v[168:171], a[164:167], v[52:55], v[168:171]
v_exp_f32 v157, v157
v_mfma_f32_16x16x32_bf16 v[168:171], a[168:171], v[56:59], v[168:171]
ds_read_b128 a[216:219], v2 offset:6144
v_cvt_pk_bf16_f32 v206, v156, v157
v_mfma_f32_16x16x32_bf16 v[168:171], a[172:175], v[60:63], v[168:171]
buffer_load_dwordx4 v1, s[44:47], s72 offen offset:3072 sc1 lds
v_mfma_f32_16x16x32_bf16 v[184:187], a[188:191], v[60:63], v[88:91]
v_exp_f32 v158, v158
v_mfma_f32_16x16x32_bf16 v[184:187], a[184:187], v[56:59], v[184:187]
ds_read_b128 a[220:223], v2 offset:7168
v_mfma_f32_16x16x32_bf16 v[184:187], a[180:183], v[52:55], v[184:187]
s_waitcnt lgkmcnt(4)
v_exp_f32 v159, v159
v_mfma_f32_16x16x32_bf16 v[184:187], a[176:179], v[48:51], v[184:187]
s_barrier
v_cvt_pk_bf16_f32 v207, v158, v159
s_lshr_b32 s69, s93, 4
s_and_b32 s69, s69, 0x7f00
s_add_u32 s69, s69, LHT4-Lpc0
v_lshrrev_b32 v3, 5, v0
v_lshlrev_b32 v3, 7, v3
v_add_u32 v3, s69, v3
v_min_u32 v3, Lcode_end-Lpc0, v3
global_load_dword v4, v3, s[98:99]
v_mfma_f32_16x16x32_bf16 v[232:235], v[120:123], v[216:219], v[232:235]
s_add_u32 s82, s82, 0x8000
ds_read_b128 a[160:163], v2 offset:24576
ds_read_b128 a[164:167], v2 offset:25600
v_mfma_f32_16x16x32_bf16 v[232:235], v[120:123], v[200:203], v[232:235]
s_and_b32 s82, s82, 0x1ffff
v_exp_f32 v172, v172
v_mfma_f32_16x16x32_bf16 a[64:67], a[224:227], v[216:219], a[64:67]
s_add_u32 s66, s58, 3
v_exp_f32 v173, v173
v_mfma_f32_16x16x32_bf16 a[64:67], a[192:195], v[200:203], a[64:67]
s_and_b32 s66, s66, 3
ds_read_b128 a[168:171], v2 offset:26624
v_cvt_pk_bf16_f32 v220, v172, v173
v_mfma_f32_16x16x32_bf16 a[68:71], a[196:199], v[200:203], a[68:71]
s_mul_i32 s66, s66, 4160
v_exp_f32 v174, v174
v_mfma_f32_16x16x32_bf16 a[68:71], a[228:231], v[216:219], a[68:71]
s_add_u32 s66, s66, s92
ds_read_b128 a[172:175], v2 offset:27648
ds_read_b128 a[176:179], v2 offset:28672
v_mfma_f32_16x16x32_bf16 a[72:75], a[232:235], v[216:219], a[72:75]
s_add_u32 m0, s66, 32
v_exp_f32 v175, v175
v_mfma_f32_16x16x32_bf16 a[72:75], a[200:203], v[200:203], a[72:75]
s_add_u32 s72, s93, 0x6
buffer_load_dwordx4 v1, s[36:39], s72 offen lds
v_mfma_f32_16x16x32_bf16 a[76:79], a[204:207], v[200:203], a[76:79]
v_exp_f32 v188, v188
v_mfma_f32_16x16x32_bf16 a[76:79], a[236:239], v[216:219], a[76:79]
ds_read_b128 a[180:183], v2 offset:29696
v_cvt_pk_bf16_f32 v221, v174, v175
v_mfma_f32_16x16x32_bf16 a[80:83], a[240:243], v[216:219], a[80:83]
s_waitcnt lgkmcnt(6)
v_exp_f32 v189, v189
v_mfma_f32_16x16x32_bf16 a[80:83], a[208:211], v[200:203], a[80:83]
ds_read_b128 a[184:187], v2 offset:30720
v_cvt_pk_bf16_f32 v222, v188, v189
v_mfma_f32_16x16x32_bf16 a[84:87], a[212:215], v[200:203], a[84:87]
v_exp_f32 v190, v190
v_mfma_f32_16x16x32_bf16 a[84:87], a[244:247], v[216:219], a[84:87]
buffer_load_dwordx4 v1, s[36:39], s72 offen offset:1024 lds
v_mfma_f32_16x16x32_bf16 a[88:91], a[248:251], v[216:219], a[88:91]
s_nop 0
ds_read_b128 a[188:191], v2 offset:31744
ds_read_b128 a[224:227], v2 offset:8192
v_mfma_f32_16x16x32_bf16 a[88:91], a[216:219], v[200:203], a[88:91]
v_exp_f32 v191, v191
v_mfma_f32_16x16x32_bf16 a[92:95], a[220:223], v[200:203], a[92:95]
v_exp_f32 v168, v168
v_mfma_f32_16x16x32_bf16 a[92:95], a[252:255], v[216:219], a[92:95]
ds_read_b128 a[228:231], v2 offset:9216
v_cvt_pk_bf16_f32 v223, v190, v191
s_cmp_eq_u32 s58, 0
s_cbranch_scc1 Lta28
s_cmp_eq_u32 s58, 1
s_cbranch_scc1 Lnt29
v_mfma_f32_16x16x32_bf16 v[136:139], a[128:131], v[48:51], v[88:91]
v_exp_f32 v169, v169
v_mfma_f32_16x16x32_bf16 v[152:155], a[144:147], v[48:51], v[88:91]
ds_read_b128 a[232:235], v2 offset:10240
v_cvt_pk_bf16_f32 v216, v168, v169
s_branch Ljoin30
Lta28:
v_mfma_f32_16x16x32_bf16 v[136:139], a[128:131], v[48:51], v[104:107]
v_exp_f32 v169, v169
v_mfma_f32_16x16x32_bf16 v[152:155], a[144:147], v[48:51], v[112:115]
ds_read_b128 a[232:235], v2 offset:10240
v_cvt_pk_bf16_f32 v216, v168, v169
s_branch Ljoin30
Lnt29:
v_mfma_f32_16x16x32_bf16 v[136:139], a[128:131], v[48:51], v[88:91]
v_exp_f32 v169, v169
v_mfma_f32_16x16x32_bf16 v[152:155], a[144:147], v[48:51], v[104:107]
ds_read_b128 a[232:235], v2 offset:10240
v_cvt_pk_bf16_f32 v216, v168, v169
Ljoin30:
v_mfma_f32_16x16x32_bf16 v[136:139], a[132:135], v[52:55], v[136:139]
v_exp_f32 v170, v170
v_mfma_f32_16x16x32_bf16 v[136:139], a[136:139], v[56:59], v[136:139]
buffer_load_dwordx4 v1, s[36:39], s72 offen offset:2048 lds
v_mfma_f32_16x16x32_bf16 v[136:139], a[140:143], v[60:63], v[136:139]
ds_read_b128 a[236:239], v2 offset:11264
v_mfma_f32_16x16x32_bf16 v[152:155], a[156:159], v[60:63], v[152:155]
v_exp_f32 v171, v171
v_mfma_f32_16x16x32_bf16 v[152:155], a[152:155], v[56:59], v[152:155]
ds_read_b128 a[240:243], v2 offset:12288
v_cvt_pk_bf16_f32 v217, v170, v171
v_mfma_f32_16x16x32_bf16 v[152:155], a[148:151], v[52:55], v[152:155]
v_exp_f32 v184, v184
v_mfma_f32_16x16x32_bf16 v[140:143], a[128:131], v[64:67], v[92:95]
ds_read_b128 a[244:247], v2 offset:13312
v_mfma_f32_16x16x32_bf16 v[140:143], a[132:135], v[68:71], v[140:143]
v_exp_f32 v185, v185
v_mfma_f32_16x16x32_bf16 v[140:143], a[136:139], v[72:75], v[140:143]
ds_read_b128 a[248:251], v2 offset:14336
v_cvt_pk_bf16_f32 v218, v184, v185
v_mfma_f32_16x16x32_bf16 v[140:143], a[140:143], v[76:79], v[140:143]
buffer_load_dwordx4 v1, s[36:39], s72 offen offset:3072 lds
v_mfma_f32_16x16x32_bf16 v[156:159], a[156:159], v[76:79], v[92:95]
v_exp_f32 v186, v186
v_mfma_f32_16x16x32_bf16 v[156:159], a[152:155], v[72:75], v[156:159]
ds_read_b128 a[252:255], v2 offset:15360
v_add_u32 v2, s82, v1
v_mfma_f32_16x16x32_bf16 v[156:159], a[148:151], v[68:71], v[156:159]
s_waitcnt vmcnt(9) lgkmcnt(0)
v_exp_f32 v187, v187
v_mfma_f32_16x16x32_bf16 v[156:159], a[144:147], v[64:67], v[156:159]
s_barrier
v_cvt_pk_bf16_f32 v219, v186, v187
v_mfma_f32_16x16x32_bf16 v[236:239], v[120:123], v[204:207], v[236:239]
s_mov_b32 m0, s62
v_exp_f32 v136, v136
v_mfma_f32_16x16x32_bf16 v[236:239], v[120:123], v[220:223], v[236:239]
s_add_u32 s72, s93, 0x3000000
ds_read_b128 a[128:131], v2 offset:16384
ds_read_b128 a[132:135], v2 offset:17408
v_mfma_f32_16x16x32_bf16 a[96:99], a[192:195], v[204:207], a[96:99]
s_add_u32 s78, s59, 8
v_exp_f32 v137, v137
v_mfma_f32_16x16x32_bf16 a[96:99], a[224:227], v[220:223], a[96:99]
s_and_b32 s78, s78, 24
buffer_load_dwordx4 v1, s[44:47], s72 offen sc1 lds
v_mfma_f32_16x16x32_bf16 a[100:103], a[228:231], v[220:223], a[100:103]
s_lshr_b32 s79, 0x67234501, s78
v_exp_f32 v138, v138
v_mfma_f32_16x16x32_bf16 a[100:103], a[196:199], v[204:207], a[100:103]
s_and_b32 s79, s79, 7
ds_read_b128 a[136:139], v2 offset:18432
v_cvt_pk_bf16_f32 v200, v136, v137
v_mfma_f32_16x16x32_bf16 a[104:107], a[200:203], v[204:207], a[104:107]
s_lshl_b32 s79, s79, 18
v_exp_f32 v139, v139
v_mfma_f32_16x16x32_bf16 a[104:107], a[232:235], v[220:223], a[104:107]
s_add_u32 s79, s79, s94
ds_read_b128 a[140:143], v2 offset:19456
v_cvt_pk_bf16_f32 v201, v138, v139
v_mfma_f32_16x16x32_bf16 a[108:111], a[236:239], v[220:223], a[108:111]
s_add_u32 s12, s61, 0
v_exp_f32 v152, v152
v_mfma_f32_16x16x32_bf16 a[108:111], a[204:207], v[204:207], a[108:111]
s_and_b32 s12, s12, 3
ds_read_b128 a[144:147], v2 offset:20480
ds_read_b128 a[148:151], v2 offset:21504
v_mfma_f32_16x16x32_bf16 a[112:115], a[208:211], v[204:207], a[112:115]
s_waitcnt lgkmcnt(6)
buffer_load_dwordx4 v1, s[44:47], s72 offen offset:1024 sc1 lds
v_mfma_f32_16x16x32_bf16 a[112:115], a[240:243], v[220:223], a[112:115]
s_lshl_b32 s12, s12, 21
v_exp_f32 v153, v153
v_mfma_f32_16x16x32_bf16 a[116:119], a[244:247], v[220:223], a[116:119]
s_add_u32 s12, s12, s79
v_exp_f32 v154, v154
v_mfma_f32_16x16x32_bf16 a[116:119], a[212:215], v[204:207], a[116:119]
s_add_u32 s13, s61, 1
ds_read_b128 a[152:155], v2 offset:22528
v_cvt_pk_bf16_f32 v202, v152, v153
v_mfma_f32_16x16x32_bf16 a[120:123], a[216:219], v[204:207], a[120:123]
s_and_b32 s13, s13, 3
buffer_load_dwordx4 v1, s[44:47], s72 offen offset:2048 sc1 lds
v_mfma_f32_16x16x32_bf16 a[120:123], a[248:251], v[220:223], a[120:123]
s_lshl_b32 s13, s13, 21
v_exp_f32 v155, v155
v_mfma_f32_16x16x32_bf16 a[124:127], a[252:255], v[220:223], a[124:127]
s_add_u32 s13, s13, s79
ds_read_b128 a[156:159], v2 offset:23552
v_cvt_pk_bf16_f32 v203, v154, v155
v_mfma_f32_16x16x32_bf16 a[124:127], a[220:223], v[204:207], a[124:127]
s_add_u32 s14, s61, 2
v_exp_f32 v140, v140
s_cmp_eq_u32 s58, 2
s_cbranch_scc1 Lta31
s_cmp_eq_u32 s58, 3
s_cbranch_scc1 Lnt32
v_mfma_f32_16x16x32_bf16 v[168:171], a[160:163], v[48:51], v[112:115]
s_and_b32 s14, s14, 3
ds_read_b128 a[192:195], v2 offset:0
ds_read_b128 a[196:199], v2 offset:1024
v_mfma_f32_16x16x32_bf16 v[184:187], a[176:179], v[48:51], v[112:115]
s_lshl_b32 s14, s14, 21
v_exp_f32 v141, v141
s_branch Ljoin33
Lta31:
v_mfma_f32_16x16x32_bf16 v[168:171], a[160:163], v[48:51], v[104:107]
s_and_b32 s14, s14, 3
ds_read_b128 a[192:195], v2 offset:0
ds_read_b128 a[196:199], v2 offset:1024
v_mfma_f32_16x16x32_bf16 v[184:187], a[176:179], v[48:51], v[112:115]
s_lshl_b32 s14, s14, 21
v_exp_f32 v141, v141
s_branch Ljoin33
Lnt32:
v_mfma_f32_16x16x32_bf16 v[168:171], a[160:163], v[48:51], v[88:91]
s_and_b32 s14, s14, 3
ds_read_b128 a[192:195], v2 offset:0
ds_read_b128 a[196:199], v2 offset:1024
v_mfma_f32_16x16x32_bf16 v[184:187], a[176:179], v[48:51], v[104:107]
s_lshl_b32 s14, s14, 21
v_exp_f32 v141, v141
Ljoin33:
v_mfma_f32_16x16x32_bf16 v[172:175], a[160:163], v[64:67], v[92:95]
s_add_u32 s14, s14, s79
buffer_load_dwordx4 v1, s[44:47], s72 offen offset:3072 sc1 lds
v_mfma_f32_16x16x32_bf16 v[172:175], a[164:167], v[68:71], v[172:175]
s_add_u32 s66, s58, 0
v_exp_f32 v142, v142
v_mfma_f32_16x16x32_bf16 v[172:175], a[168:171], v[72:75], v[172:175]
s_and_b32 s66, s66, 3
ds_read_b128 a[200:203], v2 offset:2048
v_cvt_pk_bf16_f32 v204, v140, v141
v_mfma_f32_16x16x32_bf16 v[172:175], a[172:175], v[76:79], v[172:175]
s_mul_i32 s66, s66, 4160
v_exp_f32 v143, v143
v_mfma_f32_16x16x32_bf16 v[188:191], a[188:191], v[76:79], v[92:95]
s_add_u32 s66, s66, s92
ds_read_b128 a[204:207], v2 offset:3072
v_cvt_pk_bf16_f32 v205, v142, v143
v_mfma_f32_16x16x32_bf16 v[188:191], a[184:187], v[72:75], v[188:191]
s_add_u32 m0, s66, 16672
v_exp_f32 v156, v156
v_mfma_f32_16x16x32_bf16 v[188:191], a[180:183], v[68:71], v[188:191]
s_add_u32 s72, s93, 0x0
ds_read_b128 a[208:211], v2 offset:4096
ds_read_b128 a[212:215], v2 offset:5120
v_mfma_f32_16x16x32_bf16 v[188:191], a[176:179], v[64:67], v[188:191]
s_add_u32 s15, s61, 3
buffer_load_dwordx4 v1, s[36:39], s72 offen lds
v_mfma_f32_16x16x32_bf16 v[168:171], a[164:167], v[52:55], v[168:171]
s_and_b32 s15, s15, 3
v_exp_f32 v157, v157
v_mfma_f32_16x16x32_bf16 v[168:171], a[168:171], v[56:59], v[168:171]
s_lshl_b32 s15, s15, 21
v_exp_f32 v158, v158
v_mfma_f32_16x16x32_bf16 v[168:171], a[172:175], v[60:63], v[168:171]
s_add_u32 s15, s15, s79
ds_read_b128 a[216:219], v2 offset:6144
ds_read_b128 a[220:223], v2 offset:7168
v_mfma_f32_16x16x32_bf16 v[184:187], a[188:191], v[60:63], v[184:187]
buffer_load_dwordx4 v1, s[36:39], s72 offen offset:1024 lds
v_mfma_f32_16x16x32_bf16 v[184:187], a[184:187], v[56:59], v[184:187]
v_exp_f32 v159, v159
v_mfma_f32_16x16x32_bf16 v[184:187], a[180:183], v[52:55], v[184:187]
s_waitcnt lgkmcnt(4)
v_cvt_pk_bf16_f32 v206, v156, v157
v_cvt_pk_bf16_f32 v207, v158, v159
v_mfma_f32_16x16x32_bf16 v[232:235], v[120:123], v[216:219], v[232:235]
s_add_u32 s82, s82, 0x8000
ds_read_b128 a[160:163], v2 offset:24576
ds_read_b128 a[164:167], v2 offset:25600
v_mfma_f32_16x16x32_bf16 v[232:235], v[120:123], v[200:203], v[232:235]
s_and_b32 s82, s82, 0x1ffff
v_exp_f32 v172, v172
v_mfma_f32_16x16x32_bf16 a[64:67], a[224:227], v[216:219], a[64:67]
v_exp_f32 v173, v173
v_mfma_f32_16x16x32_bf16 a[64:67], a[192:195], v[200:203], a[64:67]
s_nop 0
ds_read_b128 a[168:171], v2 offset:26624
ds_read_b128 a[172:175], v2 offset:27648
v_mfma_f32_16x16x32_bf16 a[68:71], a[196:199], v[200:203], a[68:71]
v_exp_f32 v174, v174
v_mfma_f32_16x16x32_bf16 a[68:71], a[228:231], v[216:219], a[68:71]
v_exp_f32 v175, v175
v_mfma_f32_16x16x32_bf16 a[72:75], a[232:235], v[216:219], a[72:75]
s_nop 0
ds_read_b128 a[176:179], v2 offset:28672
ds_read_b128 a[180:183], v2 offset:29696
v_mfma_f32_16x16x32_bf16 a[72:75], a[200:203], v[200:203], a[72:75]
v_exp_f32 v188, v188
v_mfma_f32_16x16x32_bf16 a[76:79], a[204:207], v[200:203], a[76:79]
s_nop 0
ds_read_b128 a[184:187], v2 offset:30720
ds_read_b128 a[188:191], v2 offset:31744
v_mfma_f32_16x16x32_bf16 a[76:79], a[236:239], v[216:219], a[76:79]
s_nop 0
ds_read_b128 a[224:227], v2 offset:8192
ds_read_b128 a[228:231], v2 offset:9216
Lstub7:
s_cbranch_execz Lstub11
v_mfma_f32_16x16x32_bf16 a[80:83], a[240:243], v[216:219], a[80:83]
s_waitcnt lgkmcnt(10)
ds_read_b128 a[232:235], v2 offset:10240
ds_read_b128 a[236:239], v2 offset:11264
v_mfma_f32_16x16x32_bf16 a[80:83], a[208:211], v[200:203], a[80:83]
ds_read_b128 a[240:243], v2 offset:12288
v_cvt_pk_bf16_f32 v220, v172, v173
v_mfma_f32_16x16x32_bf16 a[84:87], a[212:215], v[200:203], a[84:87]
buffer_load_dwordx4 v1, s[36:39], s72 offen offset:2048 lds
v_mfma_f32_16x16x32_bf16 a[84:87], a[244:247], v[216:219], a[84:87]
v_exp_f32 v189, v189
v_mfma_f32_16x16x32_bf16 a[88:91], a[248:251], v[216:219], a[88:91]
v_exp_f32 v190, v190
v_mfma_f32_16x16x32_bf16 a[88:91], a[216:219], v[200:203], a[88:91]
s_nop 0
ds_read_b128 a[244:247], v2 offset:13312
ds_read_b128 a[248:251], v2 offset:14336
v_mfma_f32_16x16x32_bf16 a[92:95], a[220:223], v[200:203], a[92:95]
v_cvt_pk_bf16_f32 v221, v174, v175
v_cvt_pk_bf16_f32 v222, v188, v189
v_mfma_f32_16x16x32_bf16 a[92:95], a[252:255], v[216:219], a[92:95]
v_exp_f32 v191, v191
s_cmp_eq_u32 s58, 0
s_cbranch_scc1 Lta34
s_cmp_eq_u32 s58, 1
s_cbranch_scc1 Lnt35
v_mfma_f32_16x16x32_bf16 v[140:143], a[128:131], v[64:67], v[92:95]
v_exp_f32 v168, v168
v_mfma_f32_16x16x32_bf16 v[156:159], a[144:147], v[64:67], v[92:95]
v_exp_f32 v169, v169
s_branch Ljoin36
Lta34:
v_mfma_f32_16x16x32_bf16 v[140:143], a[128:131], v[64:67], v[108:111]
v_exp_f32 v168, v168
v_mfma_f32_16x16x32_bf16 v[156:159], a[144:147], v[64:67], v[112:115]
v_exp_f32 v169, v169
s_branch Ljoin36
Lnt35:
v_mfma_f32_16x16x32_bf16 v[140:143], a[128:131], v[64:67], v[92:95]
v_exp_f32 v168, v168
v_mfma_f32_16x16x32_bf16 v[156:159], a[144:147], v[64:67], v[108:111]
v_exp_f32 v169, v169
Ljoin36:
v_mfma_f32_16x16x32_bf16 v[140:143], a[132:135], v[68:71], v[140:143]
v_exp_f32 v170, v170
v_mfma_f32_16x16x32_bf16 v[140:143], a[136:139], v[72:75], v[140:143]
ds_read_b128 a[252:255], v2 offset:15360
v_cvt_pk_bf16_f32 v223, v190, v191
v_mfma_f32_16x16x32_bf16 v[140:143], a[140:143], v[76:79], v[140:143]
v_exp_f32 v171, v171
v_mfma_f32_16x16x32_bf16 v[156:159], a[156:159], v[76:79], v[156:159]
buffer_load_dwordx4 v1, s[36:39], s72 offen offset:3072 lds
v_mfma_f32_16x16x32_bf16 v[156:159], a[152:155], v[72:75], v[156:159]
s_waitcnt vmcnt(13) lgkmcnt(4)
v_exp_f32 v184, v184
v_mfma_f32_16x16x32_bf16 v[156:159], a[148:151], v[68:71], v[156:159]
s_barrier
v_cvt_pk_bf16_f32 v216, v168, v169
v_cvt_pk_bf16_f32 v217, v170, v171
v_add_u32 v2, s82, v1
v_exp_f32 v185, v185
v_exp_f32 v186, v186
v_cvt_pk_bf16_f32 v218, v184, v185
v_exp_f32 v187, v187
s_nop 0
v_cvt_pk_bf16_f32 v219, v186, v187
v_mfma_f32_16x16x32_bf16 v[236:239], v[120:123], v[204:207], v[236:239]
s_add_u32 s66, s58, 2
v_exp_f32 v140, v140
v_mfma_f32_16x16x32_bf16 v[236:239], v[120:123], v[220:223], v[236:239]
s_and_b32 s66, s66, 3
v_exp_f32 v141, v141
v_mfma_f32_16x16x32_bf16 a[96:99], a[192:195], v[204:207], a[96:99]
s_mul_i32 s66, s66, 4160
ds_read_b128 a[192:195], v2 offset:0
v_mfma_f32_16x16x32_bf16 a[96:99], a[224:227], v[220:223], a[96:99]
s_add_u32 s66, s66, s92
v_exp_f32 v142, v142
v_mfma_f32_16x16x32_bf16 a[100:103], a[228:231], v[220:223], a[100:103]
s_add_u32 m0, s66, 33312
v_exp_f32 v143, v143
v_mfma_f32_16x16x32_bf16 a[100:103], a[196:199], v[204:207], a[100:103]
s_add_u32 s72, s93, 0x4
buffer_load_dwordx4 v1, s[36:39], s72 offen lds
v_mfma_f32_16x16x32_bf16 a[104:107], a[200:203], v[204:207], a[104:107]
ds_read_b128 a[196:199], v2 offset:1024
v_mfma_f32_16x16x32_bf16 a[104:107], a[232:235], v[220:223], a[104:107]
buffer_load_dwordx4 v1, s[36:39], s72 offen offset:1024 lds
v_mfma_f32_16x16x32_bf16 a[108:111], a[236:239], v[220:223], a[108:111]
ds_read_b128 a[200:203], v2 offset:2048
v_mfma_f32_16x16x32_bf16 a[108:111], a[204:207], v[204:207], a[108:111]
buffer_load_dwordx4 v1, s[36:39], s72 offen offset:2048 lds
v_mfma_f32_16x16x32_bf16 a[112:115], a[208:211], v[204:207], a[112:115]
s_waitcnt lgkmcnt(3)
ds_read_b128 a[204:207], v2 offset:3072
v_mfma_f32_16x16x32_bf16 a[112:115], a[240:243], v[220:223], a[112:115]
buffer_load_dwordx4 v1, s[36:39], s72 offen offset:3072 lds
v_mfma_f32_16x16x32_bf16 a[116:119], a[244:247], v[220:223], a[116:119]
v_exp_f32 v156, v156
v_mfma_f32_16x16x32_bf16 a[116:119], a[212:215], v[204:207], a[116:119]
ds_read_b128 a[208:211], v2 offset:4096
v_mfma_f32_16x16x32_bf16 a[120:123], a[216:219], v[204:207], a[120:123]
buffer_load_dwordx4 v[80:83], v15, s[4:7], s80 offen
v_mfma_f32_16x16x32_bf16 a[120:123], a[248:251], v[220:223], a[120:123]
s_add_u32 s80, s80, 0x4000
v_exp_f32 v157, v157
v_mfma_f32_16x16x32_bf16 a[124:127], a[252:255], v[220:223], a[124:127]
ds_read_b128 a[212:215], v2 offset:5120
v_mfma_f32_16x16x32_bf16 a[124:127], a[220:223], v[204:207], a[124:127]
ds_read_b128 a[216:219], v2 offset:6144
v_cvt_pk_bf16_f32 v204, v140, v141
s_cmp_eq_u32 s58, 2
s_cbranch_scc1 Lta37
s_cmp_eq_u32 s58, 3
s_cbranch_scc1 Lnt38
v_mfma_f32_16x16x32_bf16 v[172:175], a[160:163], v[64:67], v[112:115]
buffer_load_dwordx4 v[84:87], v15, s[4:7], s80 offen
v_mfma_f32_16x16x32_bf16 v[188:191], a[176:179], v[64:67], v[112:115]
s_add_u32 s80, s80, 0x4000
v_exp_f32 v158, v158
s_branch Ljoin39
Lta37:
v_mfma_f32_16x16x32_bf16 v[172:175], a[160:163], v[64:67], v[108:111]
buffer_load_dwordx4 v[84:87], v15, s[4:7], s80 offen
v_mfma_f32_16x16x32_bf16 v[188:191], a[176:179], v[64:67], v[112:115]
s_add_u32 s80, s80, 0x4000
v_exp_f32 v158, v158
s_branch Ljoin39
Lnt38:
v_mfma_f32_16x16x32_bf16 v[172:175], a[160:163], v[64:67], v[92:95]
buffer_load_dwordx4 v[84:87], v15, s[4:7], s80 offen
v_mfma_f32_16x16x32_bf16 v[188:191], a[176:179], v[64:67], v[108:111]
s_add_u32 s80, s80, 0x4000
v_exp_f32 v158, v158
Ljoin39:
v_mfma_f32_16x16x32_bf16 v[172:175], a[164:167], v[68:71], v[172:175]
ds_read_b128 a[220:223], v2 offset:7168
v_cvt_pk_bf16_f32 v205, v142, v143
v_mfma_f32_16x16x32_bf16 v[172:175], a[168:171], v[72:75], v[172:175]
buffer_load_dwordx4 v[96:99], v15, s[4:7], s80 offen
v_mfma_f32_16x16x32_bf16 v[172:175], a[172:175], v[76:79], v[172:175]
s_add_u32 s80, s80, 0x4000
v_exp_f32 v159, v159
v_mfma_f32_16x16x32_bf16 v[188:191], a[188:191], v[76:79], v[188:191]
buffer_load_dwordx4 v[100:103], v15, s[4:7], s80 offen
v_mfma_f32_16x16x32_bf16 v[188:191], a[184:187], v[72:75], v[188:191]
v_cvt_pk_bf16_f32 v206, v156, v157
v_cvt_pk_bf16_f32 v207, v158, v159
v_mfma_f32_16x16x32_bf16 v[188:191], a[180:183], v[68:71], v[188:191]
s_waitcnt lgkmcnt(4)
v_mfma_f32_16x16x32_bf16 v[232:235], v[120:123], v[216:219], v[232:235]
s_add_u32 s82, s82, 0x8000
v_exp_f32 v172, v172
v_mfma_f32_16x16x32_bf16 a[64:67], a[224:227], v[216:219], a[64:67]
s_and_b32 s82, s82, 0x1ffff
ds_read_b128 a[224:227], v2 offset:8192
v_mfma_f32_16x16x32_bf16 a[68:71], a[228:231], v[216:219], a[68:71]
ds_read_b128 a[228:231], v2 offset:9216
v_mfma_f32_16x16x32_bf16 a[72:75], a[232:235], v[216:219], a[72:75]
v_exp_f32 v173, v173
v_mfma_f32_16x16x32_bf16 a[76:79], a[236:239], v[216:219], a[76:79]
s_nop 0
ds_read_b128 a[232:235], v2 offset:10240
ds_read_b128 a[236:239], v2 offset:11264
v_mfma_f32_16x16x32_bf16 a[80:83], a[240:243], v[216:219], a[80:83]
ds_read_b128 a[240:243], v2 offset:12288
v_cvt_pk_bf16_f32 v220, v172, v173
v_mfma_f32_16x16x32_bf16 a[84:87], a[244:247], v[216:219], a[84:87]
ds_read_b128 a[244:247], v2 offset:13312
v_mfma_f32_16x16x32_bf16 a[88:91], a[248:251], v[216:219], a[88:91]
v_exp_f32 v174, v174
v_mfma_f32_16x16x32_bf16 a[92:95], a[252:255], v[216:219], a[92:95]
v_exp_f32 v175, v175
ds_read_b128 a[248:251], v2 offset:14336
ds_read_b128 a[252:255], v2 offset:15360
v_add_u32 v2, s82, v1
v_exp_f32 v188, v188
v_cvt_pk_bf16_f32 v221, v174, v175
v_exp_f32 v189, v189
v_exp_f32 v190, v190
v_cvt_pk_bf16_f32 v222, v188, v189
v_exp_f32 v191, v191
s_nop 0
v_cvt_pk_bf16_f32 v223, v190, v191
s_waitcnt vmcnt(4) lgkmcnt(0)
s_barrier
LHT4:
Lstub8:
s_cbranch_execz Lstub12
v_mfma_f32_16x16x32_bf16 v[236:239], v[120:123], v[204:207], v[236:239]
ds_write_b64 v5, v[12:13]
v_mov_b32 v240, 0
v_mfma_f32_16x16x32_bf16 v[236:239], v[120:123], v[220:223], v[236:239]
v_mov_b32 v241, 0
v_mfma_f32_16x16x32_bf16 a[96:99], a[192:195], v[204:207], a[96:99]
s_nop 0
ds_write_b64 v14, v[240:241]
ds_read_b64 a[128:129], v6 offset:0
v_mfma_f32_16x16x32_bf16 a[96:99], a[224:227], v[220:223], a[96:99]
s_nop 0
ds_read_b64 a[130:131], v6 offset:8
ds_read_b128 a[192:195], v7 offset:3584
v_mfma_f32_16x16x32_bf16 a[100:103], a[228:231], v[220:223], a[100:103]
s_nop 0
ds_read_b64 a[132:133], v6 offset:512
ds_read_b64 a[134:135], v6 offset:520
v_mfma_f32_16x16x32_bf16 a[100:103], a[196:199], v[204:207], a[100:103]
s_nop 0
ds_read_b128 a[196:199], v7 offset:3072
ds_read_b64 a[136:137], v6 offset:1024
v_mfma_f32_16x16x32_bf16 a[104:107], a[200:203], v[204:207], a[104:107]
s_nop 0
ds_read_b64 a[138:139], v6 offset:1032
ds_read_b128 a[200:203], v7 offset:2560
v_mfma_f32_16x16x32_bf16 a[104:107], a[232:235], v[220:223], a[104:107]
v_add_f32 v12, v224, v228
v_min_u32 v13, 1, v0
v_mfma_f32_16x16x32_bf16 a[108:111], a[236:239], v[220:223], a[108:111]
s_nop 0
ds_read_b64 a[140:141], v6 offset:1536
ds_read_b64 a[142:143], v6 offset:1544
v_mfma_f32_16x16x32_bf16 a[108:111], a[204:207], v[204:207], a[108:111]
s_nop 0
ds_read_b128 a[204:207], v7 offset:2048
ds_read_b64 a[144:145], v6 offset:2048
v_mfma_f32_16x16x32_bf16 a[112:115], a[208:211], v[204:207], a[112:115]
s_lshl_b32 s73, s52, 12
ds_read_b64 a[146:147], v6 offset:2056
ds_read_b128 a[208:211], v7 offset:1536
v_mfma_f32_16x16x32_bf16 a[112:115], a[240:243], v[220:223], a[112:115]
s_add_u32 s73, s73, 0x2000000
v_lshlrev_b32 v13, 30, v13
v_mov_b32 v14, 2
v_mfma_f32_16x16x32_bf16 a[116:119], a[244:247], v[220:223], a[116:119]
s_lshl_b32 s70, s68, 2
ds_read_b64 a[148:149], v6 offset:2560
ds_read_b64 a[150:151], v6 offset:2568
v_mfma_f32_16x16x32_bf16 a[116:119], a[212:215], v[204:207], a[116:119]
s_add_u32 s70, s70, s73
ds_read_b128 a[212:215], v7 offset:1024
ds_read_b64 a[152:153], v6 offset:3072
v_mfma_f32_16x16x32_bf16 a[120:123], a[216:219], v[204:207], a[120:123]
s_nop 0
ds_read_b64 a[154:155], v6 offset:3080
ds_read_b128 a[216:219], v7 offset:512
v_mfma_f32_16x16x32_bf16 a[120:123], a[248:251], v[220:223], a[120:123]
v_mfma_f32_16x16x32_bf16 a[124:127], a[252:255], v[220:223], a[124:127]
s_xor_b32 s71, s12, 0x80
ds_read_b64 a[156:157], v6 offset:3584
ds_read_b64 a[158:159], v6 offset:3592
v_mfma_f32_16x16x32_bf16 a[124:127], a[220:223], v[204:207], a[124:127]
s_add_u32 m0, s77, 0
ds_read_b128 a[220:223], v7 offset:0
s_waitcnt lgkmcnt(0)
v_mfma_f32_16x16x32_bf16 v[128:131], v[8:11], a[192:195], 0
s_add_u32 s72, s71, 0
buffer_load_dwordx4 v15, s[24:27], s72 offen lds
v_mfma_f32_16x16x32_bf16 v[128:131], a[128:131], a[192:195], v[128:131]
v_mfma_f32_16x16x32_bf16 v[132:135], v[8:11], a[196:199], 0
s_nop 0
ds_read_b128 a[224:227], v7 offset:3648
ds_read_b64 a[160:161], v6 offset:64
v_mfma_f32_16x16x32_bf16 v[132:135], a[128:131], a[196:199], v[132:135]
v_accvgpr_read_b32 v240, a64
v_accvgpr_read_b32 v241, a65
v_accvgpr_read_b32 v242, a66
v_mfma_f32_16x16x32_bf16 v[132:135], a[132:135], a[192:195], v[132:135]
s_add_u32 s72, s71, 15360
buffer_load_dwordx4 v15, s[24:27], s72 offen offset:1024 lds
v_accvgpr_read_b32 v243, a67
v_mfma_f32_16x16x32_bf16 v[136:139], v[8:11], a[200:203], 0
s_nop 0
ds_read_b64 a[162:163], v6 offset:72
ds_read_b128 a[228:231], v7 offset:3136
v_mfma_f32_16x16x32_bf16 v[136:139], a[128:131], a[200:203], v[136:139]
s_lshl_b32 s95, s75, 20
v_rcp_f32 v234, v232
v_mfma_f32_16x16x32_bf16 v[136:139], a[132:135], a[196:199], v[136:139]
s_lshl_b32 s74, s58, 18
v_rcp_f32 v238, v236
v_accvgpr_read_b32 v244, a68
v_mfma_f32_16x16x32_bf16 v[136:139], a[136:139], a[192:195], v[136:139]
s_add_u32 s95, s95, s74
ds_read_b64 a[164:165], v6 offset:576
ds_read_b64 a[166:167], v6 offset:584
v_accvgpr_read_b32 v245, a69
v_mfma_f32_16x16x32_bf16 v[140:143], v[8:11], a[204:207], 0
s_add_u32 s72, s71, 30720
buffer_load_dwordx4 v15, s[24:27], s72 offen offset:2048 lds
v_accvgpr_read_b32 v246, a70
v_mfma_f32_16x16x32_bf16 v[140:143], a[128:131], a[204:207], v[140:143]
s_add_u32 s95, s95, 0x2000000
v_accvgpr_read_b32 v247, a71
v_mul_f32 v240, v240, v234
v_mul_f32 v241, v241, v234
v_mfma_f32_16x16x32_bf16 v[140:143], a[132:135], a[200:203], v[140:143]
s_sub_u32 s74, 15, s75
ds_read_b128 a[232:235], v7 offset:2624
ds_read_b64 a[168:169], v6 offset:1088
v_mul_f32 v242, v242, v234
v_mfma_f32_16x16x32_bf16 v[140:143], a[136:139], a[196:199], v[140:143]
s_add_u32 s72, s71, 46080
buffer_load_dwordx4 v15, s[24:27], s72 offen offset:3072 lds
v_mul_f32 v243, v243, v234
v_mfma_f32_16x16x32_bf16 v[140:143], a[140:143], a[192:195], v[140:143]
s_min_u32 s74, s74, s75
v_mul_f32 v244, v244, v234
v_mul_f32 v245, v245, v234
v_mul_f32 v246, v246, v234
v_mfma_f32_16x16x32_bf16 v[144:147], v[8:11], a[208:211], 0
s_lshl_b32 s74, s74, 7
ds_read_b64 a[170:171], v6 offset:1096
ds_read_b128 a[236:239], v7 offset:2112
v_mul_f32 v247, v247, v234
v_mfma_f32_16x16x32_bf16 v[144:147], a[128:131], a[208:211], v[144:147]
s_add_u32 s74, s74, 0x3810000
v_cvt_pk_bf16_f32 v240, v240, v241
v_cvt_pk_bf16_f32 v241, v242, v243
v_cvt_pk_bf16_f32 v242, v244, v245
v_mfma_f32_16x16x32_bf16 v[144:147], a[132:135], a[204:207], v[144:147]
s_xor_b32 s85, s77, 0x10000
v_cvt_pk_bf16_f32 v243, v246, v247
v_mfma_f32_16x16x32_bf16 v[144:147], a[136:139], a[200:203], v[144:147]
s_nop 0
ds_read_b64 a[172:173], v6 offset:1600
ds_read_b64 a[174:175], v6 offset:1608
v_mfma_f32_16x16x32_bf16 v[144:147], a[140:143], a[196:199], v[144:147]
buffer_store_dwordx4 v[240:243], v1, s[44:47], s70 offen sc1
v_mfma_f32_16x16x32_bf16 v[144:147], a[144:147], a[192:195], v[144:147]
v_accvgpr_read_b32 v248, a72
v_accvgpr_read_b32 v249, a73
v_accvgpr_read_b32 v250, a74
v_mfma_f32_16x16x32_bf16 v[148:151], v[8:11], a[212:215], 0
s_nop 0
ds_read_b128 a[240:243], v7 offset:1600
ds_read_b64 a[176:177], v6 offset:2112
v_accvgpr_read_b32 v251, a75
v_mfma_f32_16x16x32_bf16 v[148:151], a[128:131], a[212:215], v[148:151]
v_accvgpr_read_b32 v252, a76
v_accvgpr_read_b32 v253, a77
v_accvgpr_read_b32 v254, a78
v_mfma_f32_16x16x32_bf16 v[148:151], a[132:135], a[208:211], v[148:151]
v_accvgpr_read_b32 v255, a79
v_mul_f32 v248, v248, v234
v_mul_f32 v249, v249, v234
v_mfma_f32_16x16x32_bf16 v[148:151], a[136:139], a[204:207], v[148:151]
s_nop 0
ds_read_b64 a[178:179], v6 offset:2120
ds_read_b128 a[244:247], v7 offset:1088
v_mul_f32 v250, v250, v234
v_mfma_f32_16x16x32_bf16 v[148:151], a[140:143], a[200:203], v[148:151]
v_cmp_ngt_f32 vcc, 0x6f800000, v12
s_or_b32 s83, vcc_lo, vcc_hi
s_cselect_b32 s83, s86, 1
s_lshl_b32 s53, s83, 30
s_xor_b32 s83, s53, 0x40000000
v_or_b32 v13, s83, v13
s_lshl_b32 s83, s58, 2
s_add_u32 s83, s83, s91
s_waitcnt vmcnt(5)
buffer_store_dword v14, v13, s[44:47], s83 offen offset:4 sc1
v_mfma_f32_16x16x32_bf16 v[148:151], a[144:147], a[196:199], v[148:151]
v_mul_f32 v251, v251, v234
v_mul_f32 v252, v252, v234
v_mul_f32 v253, v253, v234
v_mfma_f32_16x16x32_bf16 v[148:151], a[148:151], a[192:195], v[148:151]
s_nop 0
ds_read_b64 a[180:181], v6 offset:2624
ds_read_b64 a[182:183], v6 offset:2632
v_mul_f32 v254, v254, v234
v_mfma_f32_16x16x32_bf16 v[152:155], v[8:11], a[216:219], 0
v_mul_f32 v255, v255, v234
v_cvt_pk_bf16_f32 v248, v248, v249
v_cvt_pk_bf16_f32 v249, v250, v251
v_mfma_f32_16x16x32_bf16 v[152:155], a[128:131], a[216:219], v[152:155]
v_cvt_pk_bf16_f32 v250, v252, v253
v_cvt_pk_bf16_f32 v251, v254, v255
v_mfma_f32_16x16x32_bf16 v[152:155], a[132:135], a[212:215], v[152:155]
s_nop 0
ds_read_b128 a[248:251], v7 offset:576
ds_read_b64 a[184:185], v6 offset:3136
v_mfma_f32_16x16x32_bf16 v[152:155], a[136:139], a[208:211], v[152:155]
buffer_store_dwordx4 v[248:251], v1, s[44:47], s70 offen offset:1024 sc1
v_mfma_f32_16x16x32_bf16 v[152:155], a[140:143], a[204:207], v[152:155]
v_accvgpr_read_b32 v240, a80
v_accvgpr_read_b32 v241, a81
v_accvgpr_read_b32 v242, a82
v_mfma_f32_16x16x32_bf16 v[152:155], a[144:147], a[200:203], v[152:155]
s_nop 0
ds_read_b64 a[186:187], v6 offset:3144
ds_read_b128 a[252:255], v7 offset:64
v_accvgpr_read_b32 v243, a83
v_mfma_f32_16x16x32_bf16 v[152:155], a[148:151], a[196:199], v[152:155]
v_accvgpr_read_b32 v244, a84
v_accvgpr_read_b32 v245, a85
v_accvgpr_read_b32 v246, a86
v_mfma_f32_16x16x32_bf16 v[152:155], a[152:155], a[192:195], v[152:155]
v_accvgpr_read_b32 v247, a87
v_mul_f32 v240, v240, v234
v_mul_f32 v241, v241, v234
v_mfma_f32_16x16x32_bf16 v[156:159], v[8:11], a[220:223], 0
s_nop 0
ds_read_b64 a[188:189], v6 offset:3648
ds_read_b64 a[190:191], v6 offset:3656
v_mul_f32 v242, v242, v234
v_mfma_f32_16x16x32_bf16 v[156:159], a[128:131], a[220:223], v[156:159]
v_mul_f32 v243, v243, v234
v_mul_f32 v244, v244, v234
v_mul_f32 v245, v245, v234
v_mfma_f32_16x16x32_bf16 v[156:159], a[132:135], a[216:219], v[156:159]
v_mul_f32 v246, v246, v234
v_mul_f32 v247, v247, v234
v_cvt_pk_bf16_f32 v240, v240, v241
v_mfma_f32_16x16x32_bf16 v[156:159], a[136:139], a[212:215], v[156:159]
v_cvt_pk_bf16_f32 v241, v242, v243
v_cvt_pk_bf16_f32 v242, v244, v245
v_cvt_pk_bf16_f32 v243, v246, v247
v_mfma_f32_16x16x32_bf16 v[156:159], a[140:143], a[208:211], v[156:159]
buffer_store_dwordx4 v[240:243], v1, s[44:47], s70 offen offset:2048 sc1
v_mfma_f32_16x16x32_bf16 v[156:159], a[144:147], a[204:207], v[156:159]
v_accvgpr_read_b32 v248, a88
v_accvgpr_read_b32 v249, a89
v_accvgpr_read_b32 v250, a90
v_mfma_f32_16x16x32_bf16 v[156:159], a[148:151], a[200:203], v[156:159]
v_accvgpr_read_b32 v251, a91
v_accvgpr_read_b32 v252, a92
v_accvgpr_read_b32 v253, a93
v_mfma_f32_16x16x32_bf16 v[156:159], a[152:155], a[196:199], v[156:159]
v_accvgpr_read_b32 v254, a94
v_accvgpr_read_b32 v255, a95
v_mul_f32 v248, v248, v234
v_mfma_f32_16x16x32_bf16 v[156:159], a[156:159], a[192:195], v[156:159]
s_waitcnt lgkmcnt(0)
v_mul_f32 v249, v249, v234
v_mul_f32 v250, v250, v234
v_mul_f32 v251, v251, v234
v_mfma_f32_16x16x32_bf16 v[128:131], a[160:163], a[224:227], v[128:131]
s_nop 0
ds_read_b128 a[192:195], v7 offset:3712
ds_read_b64 a[128:129], v6 offset:128
v_mul_f32 v252, v252, v234
v_mfma_f32_16x16x32_bf16 v[132:135], a[164:167], a[224:227], v[132:135]
v_mul_f32 v253, v253, v234
v_mul_f32 v254, v254, v234
v_mul_f32 v255, v255, v234
v_mfma_f32_16x16x32_bf16 v[132:135], a[160:163], a[228:231], v[132:135]
s_nop 0
ds_read_b64 a[130:131], v6 offset:136
ds_read_b128 a[196:199], v7 offset:3200
v_cvt_pk_bf16_f32 v248, v248, v249
v_mfma_f32_16x16x32_bf16 v[136:139], a[160:163], a[232:235], v[136:139]
v_cvt_pk_bf16_f32 v249, v250, v251
v_cvt_pk_bf16_f32 v250, v252, v253
v_cvt_pk_bf16_f32 v251, v254, v255
v_mfma_f32_16x16x32_bf16 v[136:139], a[164:167], a[228:231], v[136:139]
buffer_store_dwordx4 v[248:251], v1, s[44:47], s70 offen offset:3072 sc1
v_mfma_f32_16x16x32_bf16 v[136:139], a[168:171], a[224:227], v[136:139]
s_add_u32 s70, s70, 0x80000
ds_read_b64 a[132:133], v6 offset:640
ds_read_b64 a[134:135], v6 offset:648
v_accvgpr_read_b32 v240, a96
v_mfma_f32_16x16x32_bf16 v[140:143], a[172:175], a[224:227], v[140:143]
v_accvgpr_read_b32 v241, a97
v_accvgpr_read_b32 v242, a98
v_accvgpr_read_b32 v243, a99
v_mfma_f32_16x16x32_bf16 v[140:143], a[168:171], a[228:231], v[140:143]
s_nop 0
ds_read_b128 a[200:203], v7 offset:2688
ds_read_b64 a[136:137], v6 offset:1152
v_accvgpr_read_b32 v244, a100
v_mfma_f32_16x16x32_bf16 v[140:143], a[164:167], a[232:235], v[140:143]
v_accvgpr_read_b32 v245, a101
v_accvgpr_read_b32 v246, a102
v_accvgpr_read_b32 v247, a103
v_mfma_f32_16x16x32_bf16 v[140:143], a[160:163], a[236:239], v[140:143]
v_mul_f32 v240, v240, v238
v_mul_f32 v241, v241, v238
v_mul_f32 v242, v242, v238
v_mfma_f32_16x16x32_bf16 v[144:147], a[160:163], a[240:243], v[144:147]
s_nop 0
ds_read_b64 a[138:139], v6 offset:1160
ds_read_b128 a[204:207], v7 offset:2176
v_mul_f32 v243, v243, v238
v_mfma_f32_16x16x32_bf16 v[144:147], a[164:167], a[236:239], v[144:147]
v_mul_f32 v244, v244, v238
v_mul_f32 v245, v245, v238
v_mul_f32 v246, v246, v238
v_mfma_f32_16x16x32_bf16 v[144:147], a[168:171], a[232:235], v[144:147]
s_nop 0
ds_read_b64 a[140:141], v6 offset:1664
ds_read_b64 a[142:143], v6 offset:1672
v_mul_f32 v247, v247, v238
v_mfma_f32_16x16x32_bf16 v[144:147], a[172:175], a[228:231], v[144:147]
v_cvt_pk_bf16_f32 v240, v240, v241
v_cvt_pk_bf16_f32 v241, v242, v243
v_cvt_pk_bf16_f32 v242, v244, v245
v_mfma_f32_16x16x32_bf16 v[144:147], a[176:179], a[224:227], v[144:147]
v_cvt_pk_bf16_f32 v243, v246, v247
v_mfma_f32_16x16x32_bf16 v[148:151], a[180:183], a[224:227], v[148:151]
s_nop 0
ds_read_b128 a[208:211], v7 offset:1664
ds_read_b64 a[144:145], v6 offset:2176
v_mfma_f32_16x16x32_bf16 v[148:151], a[176:179], a[228:231], v[148:151]
buffer_store_dwordx4 v[240:243], v1, s[44:47], s70 offen sc1
v_mfma_f32_16x16x32_bf16 v[148:151], a[172:175], a[232:235], v[148:151]
v_accvgpr_read_b32 v248, a104
v_accvgpr_read_b32 v249, a105
v_accvgpr_read_b32 v250, a106
v_mfma_f32_16x16x32_bf16 v[148:151], a[168:171], a[236:239], v[148:151]
s_nop 0
ds_read_b64 a[146:147], v6 offset:2184
ds_read_b128 a[212:215], v7 offset:1152
v_accvgpr_read_b32 v251, a107
v_mfma_f32_16x16x32_bf16 v[148:151], a[164:167], a[240:243], v[148:151]
v_accvgpr_read_b32 v252, a108
v_accvgpr_read_b32 v253, a109
v_accvgpr_read_b32 v254, a110
v_mfma_f32_16x16x32_bf16 v[148:151], a[160:163], a[244:247], v[148:151]
s_nop 0
ds_read_b64 a[148:149], v6 offset:2688
ds_read_b64 a[150:151], v6 offset:2696
v_accvgpr_read_b32 v255, a111
v_mfma_f32_16x16x32_bf16 v[152:155], a[160:163], a[248:251], v[152:155]
v_mul_f32 v248, v248, v238
v_mul_f32 v249, v249, v238
v_mul_f32 v250, v250, v238
v_mfma_f32_16x16x32_bf16 v[152:155], a[164:167], a[244:247], v[152:155]
v_mul_f32 v251, v251, v238
v_mul_f32 v252, v252, v238
v_mul_f32 v253, v253, v238
v_mfma_f32_16x16x32_bf16 v[152:155], a[168:171], a[240:243], v[152:155]
s_nop 0
ds_read_b128 a[216:219], v7 offset:640
ds_read_b64 a[152:153], v6 offset:3200
v_mul_f32 v254, v254, v238
v_mfma_f32_16x16x32_bf16 v[152:155], a[172:175], a[236:239], v[152:155]
v_mul_f32 v255, v255, v238
v_cvt_pk_bf16_f32 v248, v248, v249
v_cvt_pk_bf16_f32 v249, v250, v251
v_mfma_f32_16x16x32_bf16 v[152:155], a[176:179], a[232:235], v[152:155]
s_nop 0
ds_read_b64 a[154:155], v6 offset:3208
ds_read_b128 a[220:223], v7 offset:128
v_cvt_pk_bf16_f32 v250, v252, v253
v_mfma_f32_16x16x32_bf16 v[152:155], a[180:183], a[228:231], v[152:155]
v_cvt_pk_bf16_f32 v251, v254, v255
v_mfma_f32_16x16x32_bf16 v[152:155], a[184:187], a[224:227], v[152:155]
buffer_store_dwordx4 v[248:251], v1, s[44:47], s70 offen offset:1024 sc1
v_mfma_f32_16x16x32_bf16 v[156:159], a[188:191], a[224:227], v[156:159]
s_nop 0
ds_read_b64 a[156:157], v6 offset:3712
ds_read_b64 a[158:159], v6 offset:3720
v_accvgpr_read_b32 v240, a112
v_mfma_f32_16x16x32_bf16 v[156:159], a[184:187], a[228:231], v[156:159]
v_accvgpr_read_b32 v241, a113
v_accvgpr_read_b32 v242, a114
v_accvgpr_read_b32 v243, a115
v_mfma_f32_16x16x32_bf16 v[156:159], a[180:183], a[232:235], v[156:159]
v_accvgpr_read_b32 v244, a116
v_accvgpr_read_b32 v245, a117
v_accvgpr_read_b32 v246, a118
v_mfma_f32_16x16x32_bf16 v[156:159], a[176:179], a[236:239], v[156:159]
v_accvgpr_read_b32 v247, a119
v_mul_f32 v240, v240, v238
v_mul_f32 v241, v241, v238
v_mfma_f32_16x16x32_bf16 v[156:159], a[172:175], a[240:243], v[156:159]
v_mul_f32 v242, v242, v238
v_mul_f32 v243, v243, v238
v_mul_f32 v244, v244, v238
v_mfma_f32_16x16x32_bf16 v[156:159], a[168:171], a[244:247], v[156:159]
v_mul_f32 v245, v245, v238
v_mul_f32 v246, v246, v238
v_mul_f32 v247, v247, v238
v_mfma_f32_16x16x32_bf16 v[156:159], a[164:167], a[248:251], v[156:159]
v_cvt_pk_bf16_f32 v240, v240, v241
v_cvt_pk_bf16_f32 v241, v242, v243
v_cvt_pk_bf16_f32 v242, v244, v245
v_mfma_f32_16x16x32_bf16 v[156:159], a[160:163], a[252:255], v[156:159]
s_waitcnt lgkmcnt(0)
v_cvt_pk_bf16_f32 v243, v246, v247
v_mfma_f32_16x16x32_bf16 v[128:131], a[128:131], a[192:195], v[128:131]
s_nop 0
ds_read_b128 a[224:227], v7 offset:3776
ds_read_b64 a[160:161], v6 offset:192
v_mfma_f32_16x16x32_bf16 v[132:135], a[132:135], a[192:195], v[132:135]
buffer_store_dwordx4 v[240:243], v1, s[44:47], s70 offen offset:2048 sc1
v_mfma_f32_16x16x32_bf16 v[132:135], a[128:131], a[196:199], v[132:135]
s_nop 0
ds_read_b64 a[162:163], v6 offset:200
ds_read_b128 a[228:231], v7 offset:3264
v_accvgpr_read_b32 v248, a120
v_mfma_f32_16x16x32_bf16 v[136:139], a[128:131], a[200:203], v[136:139]
v_accvgpr_read_b32 v249, a121
v_accvgpr_read_b32 v250, a122
v_accvgpr_read_b32 v251, a123
v_mfma_f32_16x16x32_bf16 v[136:139], a[132:135], a[196:199], v[136:139]
v_accvgpr_read_b32 v252, a124
v_accvgpr_read_b32 v253, a125
v_accvgpr_read_b32 v254, a126
v_mfma_f32_16x16x32_bf16 v[136:139], a[136:139], a[192:195], v[136:139]
s_nop 0
ds_read_b64 a[164:165], v6 offset:704
ds_read_b64 a[166:167], v6 offset:712
v_accvgpr_read_b32 v255, a127
v_mfma_f32_16x16x32_bf16 v[140:143], a[140:143], a[192:195], v[140:143]
Lstub9:
s_cbranch_execz Lret
v_mul_f32 v248, v248, v238
v_mul_f32 v249, v249, v238
v_mul_f32 v250, v250, v238
v_mfma_f32_16x16x32_bf16 v[140:143], a[136:139], a[196:199], v[140:143]
s_nop 0
ds_read_b128 a[232:235], v7 offset:2752
ds_read_b64 a[168:169], v6 offset:1216
v_mul_f32 v251, v251, v238
v_mfma_f32_16x16x32_bf16 v[140:143], a[132:135], a[200:203], v[140:143]
v_mul_f32 v252, v252, v238
v_mul_f32 v253, v253, v238
v_mul_f32 v254, v254, v238
v_mfma_f32_16x16x32_bf16 v[140:143], a[128:131], a[204:207], v[140:143]
v_mul_f32 v255, v255, v238
v_cvt_pk_bf16_f32 v248, v248, v249
v_cvt_pk_bf16_f32 v249, v250, v251
v_mfma_f32_16x16x32_bf16 v[144:147], a[128:131], a[208:211], v[144:147]
s_nop 0
ds_read_b64 a[170:171], v6 offset:1224
ds_read_b128 a[236:239], v7 offset:2240
v_cvt_pk_bf16_f32 v250, v252, v253
v_mfma_f32_16x16x32_bf16 v[144:147], a[132:135], a[204:207], v[144:147]
v_cvt_pk_bf16_f32 v251, v254, v255
v_mfma_f32_16x16x32_bf16 v[144:147], a[136:139], a[200:203], v[144:147]
s_nop 0
ds_read_b64 a[172:173], v6 offset:1728
ds_read_b64 a[174:175], v6 offset:1736
v_mfma_f32_16x16x32_bf16 v[144:147], a[140:143], a[196:199], v[144:147]
buffer_store_dwordx4 v[248:251], v1, s[44:47], s70 offen offset:3072 sc1
v_mfma_f32_16x16x32_bf16 v[144:147], a[144:147], a[192:195], v[144:147]
s_mov_b32 s73, 0x6f800000
v_add_f32 v227, v224, v228
v_add_f32 v231, v232, v236
v_add_f32 v227, v227, v231
v_mfma_f32_16x16x32_bf16 v[148:151], a[148:151], a[192:195], v[148:151]
s_nop 0
ds_read_b128 a[240:243], v7 offset:1728
ds_read_b64 a[176:177], v6 offset:2240
v_cmp_nlt_f32 vcc, v227, s73
v_mfma_f32_16x16x32_bf16 v[148:151], a[144:147], a[196:199], v[148:151]
s_lshl_b32 s73, s58, 2
v_mfma_f32_16x16x32_bf16 v[148:151], a[140:143], a[200:203], v[148:151]
s_add_u32 s73, s73, 163328
v_mov_b32 v231, s73
v_mfma_f32_16x16x32_bf16 v[148:151], a[136:139], a[204:207], v[148:151]
s_or_b32 s73, vcc_lo, vcc_hi
ds_read_b64 a[178:179], v6 offset:2248
ds_read_b128 a[244:247], v7 offset:1216
v_mfma_f32_16x16x32_bf16 v[148:151], a[132:135], a[208:211], v[148:151]
s_min_u32 s73, s73, 1
v_mov_b32 v227, s73
v_mfma_f32_16x16x32_bf16 v[148:151], a[128:131], a[212:215], v[148:151]
s_nop 0
ds_read_b64 a[180:181], v6 offset:2752
ds_read_b64 a[182:183], v6 offset:2760
ds_write_b32 v231, v227
v_mfma_f32_16x16x32_bf16 v[152:155], a[128:131], a[216:219], v[152:155]
v_mfma_f32_16x16x32_bf16 v[152:155], a[132:135], a[212:215], v[152:155]
v_mfma_f32_16x16x32_bf16 v[152:155], a[136:139], a[208:211], v[152:155]
s_nop 0
ds_read_b128 a[248:251], v7 offset:704
ds_read_b64 a[184:185], v6 offset:3264
v_mfma_f32_16x16x32_bf16 v[152:155], a[140:143], a[204:207], v[152:155]
v_mfma_f32_16x16x32_bf16 v[152:155], a[144:147], a[200:203], v[152:155]
s_nop 0
ds_read_b64 a[186:187], v6 offset:3272
ds_read_b128 a[252:255], v7 offset:192
v_mfma_f32_16x16x32_bf16 v[152:155], a[148:151], a[196:199], v[152:155]
v_mfma_f32_16x16x32_bf16 v[152:155], a[152:155], a[192:195], v[152:155]
v_mfma_f32_16x16x32_bf16 v[156:159], a[156:159], a[192:195], v[156:159]
s_nop 0
ds_read_b64 a[188:189], v6 offset:3776
ds_read_b64 a[190:191], v6 offset:3784
v_mfma_f32_16x16x32_bf16 v[156:159], a[152:155], a[196:199], v[156:159]
v_mfma_f32_16x16x32_bf16 v[156:159], a[148:151], a[200:203], v[156:159]
v_mfma_f32_16x16x32_bf16 v[156:159], a[144:147], a[204:207], v[156:159]
v_mfma_f32_16x16x32_bf16 v[156:159], a[140:143], a[208:211], v[156:159]
v_mfma_f32_16x16x32_bf16 v[156:159], a[136:139], a[212:215], v[156:159]
v_mfma_f32_16x16x32_bf16 v[156:159], a[132:135], a[216:219], v[156:159]
v_mfma_f32_16x16x32_bf16 v[156:159], a[128:131], a[220:223], v[156:159]
s_waitcnt lgkmcnt(0)
v_mfma_f32_16x16x32_bf16 v[128:131], a[160:163], a[224:227], v[128:131]
s_nop 0
ds_read_b128 a[192:195], v7 offset:3840
ds_read_b64 a[128:129], v6 offset:256
v_mfma_f32_16x16x32_bf16 v[132:135], a[164:167], a[224:227], v[132:135]
v_mfma_f32_16x16x32_bf16 v[132:135], a[160:163], a[228:231], v[132:135]
s_nop 0
ds_read_b64 a[130:131], v6 offset:264
ds_read_b128 a[196:199], v7 offset:3328
v_mfma_f32_16x16x32_bf16 v[136:139], a[160:163], a[232:235], v[136:139]
v_mfma_f32_16x16x32_bf16 v[136:139], a[164:167], a[228:231], v[136:139]
v_mfma_f32_16x16x32_bf16 v[136:139], a[168:171], a[224:227], v[136:139]
s_nop 0
ds_read_b64 a[132:133], v6 offset:768
ds_read_b64 a[134:135], v6 offset:776
v_mfma_f32_16x16x32_bf16 v[140:143], a[172:175], a[224:227], v[140:143]
v_mfma_f32_16x16x32_bf16 v[140:143], a[168:171], a[228:231], v[140:143]
s_nop 0
ds_read_b128 a[200:203], v7 offset:2816
ds_read_b64 a[136:137], v6 offset:1280
v_mfma_f32_16x16x32_bf16 v[140:143], a[164:167], a[232:235], v[140:143]
v_mfma_f32_16x16x32_bf16 v[140:143], a[160:163], a[236:239], v[140:143]
v_mfma_f32_16x16x32_bf16 v[144:147], a[160:163], a[240:243], v[144:147]
s_nop 0
ds_read_b64 a[138:139], v6 offset:1288
ds_read_b128 a[204:207], v7 offset:2304
v_mfma_f32_16x16x32_bf16 v[144:147], a[164:167], a[236:239], v[144:147]
v_mfma_f32_16x16x32_bf16 v[144:147], a[168:171], a[232:235], v[144:147]
s_nop 0
ds_read_b64 a[140:141], v6 offset:1792
ds_read_b64 a[142:143], v6 offset:1800
v_mfma_f32_16x16x32_bf16 v[144:147], a[172:175], a[228:231], v[144:147]
v_mfma_f32_16x16x32_bf16 v[144:147], a[176:179], a[224:227], v[144:147]
s_xor_b32 s71, s12, 0x100
v_mfma_f32_16x16x32_bf16 v[148:151], a[180:183], a[224:227], v[148:151]
s_add_u32 m0, s77, 16384
ds_read_b128 a[208:211], v7 offset:1792
ds_read_b64 a[144:145], v6 offset:2304
v_mfma_f32_16x16x32_bf16 v[148:151], a[176:179], a[228:231], v[148:151]
s_add_u32 s72, s71, 0
buffer_load_dwordx4 v15, s[24:27], s72 offen lds
s_nop 3
s_mov_b64 exec, 0
s_cmp_eq_u32 s58, 0
s_cbranch_scc1 Lstube0
s_cmp_eq_u32 s58, 1
s_cbranch_scc1 Lstube1
s_cmp_eq_u32 s58, 2
s_cbranch_scc1 Lstube2
s_branch Lstube3
Lrete:
s_mov_b64 exec, -1
s_nop 3
v_mfma_f32_16x16x32_bf16 v[148:151], a[172:175], a[232:235], v[148:151]
s_waitcnt vmcnt(1) lgkmcnt(15)
v_mfma_f32_16x16x32_bf16 v[148:151], a[168:171], a[236:239], v[148:151]
s_barrier
ds_read_b64 a[146:147], v6 offset:2312
ds_read_b128 a[212:215], v7 offset:1280
v_mfma_f32_16x16x32_bf16 v[148:151], a[164:167], a[240:243], v[148:151]
s_add_u32 s72, s71, 15360
buffer_load_dwordx4 v15, s[24:27], s72 offen offset:1024 lds
v_mfma_f32_16x16x32_bf16 v[148:151], a[160:163], a[244:247], v[148:151]
s_nop 0
ds_read_b64 a[148:149], v6 offset:2816
ds_read_b64 a[150:151], v6 offset:2824
v_mfma_f32_16x16x32_bf16 v[152:155], a[160:163], a[248:251], v[152:155]
v_mov_b32 v244, 163328
v_mfma_f32_16x16x32_bf16 v[152:155], a[164:167], a[244:247], v[152:155]
ds_read_b128 v[240:243], v244
v_mfma_f32_16x16x32_bf16 v[152:155], a[168:171], a[240:243], v[152:155]
s_nop 0
ds_read_b128 a[216:219], v7 offset:768
ds_read_b64 a[152:153], v6 offset:3328
v_mfma_f32_16x16x32_bf16 v[152:155], a[172:175], a[236:239], v[152:155]
v_mfma_f32_16x16x32_bf16 v[152:155], a[176:179], a[232:235], v[152:155]
s_add_u32 s72, s71, 30720
ds_read_b64 a[154:155], v6 offset:3336
ds_read_b128 a[220:223], v7 offset:256
v_mfma_f32_16x16x32_bf16 v[152:155], a[180:183], a[228:231], v[152:155]
buffer_load_dwordx4 v15, s[24:27], s72 offen offset:2048 lds
v_mfma_f32_16x16x32_bf16 v[152:155], a[184:187], a[224:227], v[152:155]
s_waitcnt lgkmcnt(4)
v_or3_b32 v240, v240, v241, v242
v_or_b32 v240, v240, v243
v_mfma_f32_16x16x32_bf16 v[156:159], a[188:191], a[224:227], v[156:159]
s_nop 0
ds_read_b64 a[156:157], v6 offset:3840
ds_read_b64 a[158:159], v6 offset:3848
v_cmp_lt_u32 vcc, s86, v240
s_cbranch_vccnz Lslow
v_mfma_f32_16x16x32_bf16 v[156:159], a[184:187], a[228:231], v[156:159]
v_or_b32 v240, s58, v0
v_mov_b32 v241, 2
v_mfma_f32_16x16x32_bf16 v[156:159], a[180:183], a[232:235], v[156:159]
v_min_u32 v240, 1, v240
v_lshlrev_b32 v240, 30, v240
v_mfma_f32_16x16x32_bf16 v[156:159], a[176:179], a[236:239], v[156:159]
s_add_u32 s72, s71, 46080
buffer_load_dwordx4 v15, s[24:27], s72 offen offset:3072 lds
v_mfma_f32_16x16x32_bf16 v[156:159], a[172:175], a[240:243], v[156:159]
buffer_store_dword v241, v240, s[44:47], s91 offen sc1
v_mfma_f32_16x16x32_bf16 v[156:159], a[168:171], a[244:247], v[156:159]
s_add_u32 s80, s93, 0x3400000
v_and_b32 v166, 7, v0
v_lshlrev_b32 v166, 4, v166
v_mfma_f32_16x16x32_bf16 v[156:159], a[164:167], a[248:251], v[156:159]
s_and_b32 s81, s59, 4
v_and_b32 v3, 3, v0
v_add_u32 v3, 1, v3
v_mfma_f32_16x16x32_bf16 v[156:159], a[160:163], a[252:255], v[156:159]
s_waitcnt lgkmcnt(0)
v_mul_u32_u24 v3, s81, v3
v_lshrrev_b32 v2, 4, v0
v_mfma_f32_16x16x32_bf16 v[128:131], a[128:131], a[192:195], v[128:131]
s_nop 0
ds_read_b128 a[224:227], v7 offset:3904
ds_read_b64 a[160:161], v6 offset:320
v_mfma_f32_16x16x32_bf16 v[132:135], a[132:135], a[192:195], v[132:135]
s_xor_b32 s71, s12, 0x180
v_lshl_add_u32 v2, v2, 10, v3
v_bfe_u32 v112, v0, 3, 1
v_mfma_f32_16x16x32_bf16 v[132:135], a[128:131], a[196:199], v[132:135]
s_add_u32 m0, s77, 32768
ds_read_b64 a[162:163], v6 offset:328
ds_read_b128 a[228:231], v7 offset:3392
v_mfma_f32_16x16x32_bf16 v[136:139], a[128:131], a[200:203], v[136:139]
s_add_u32 s72, s71, 0
buffer_load_dwordx4 v15, s[24:27], s72 offen lds
v_mfma_f32_16x16x32_bf16 v[136:139], a[132:135], a[196:199], v[136:139]
s_xor_b32 s82, s78, 0
v_lshl_add_u32 v166, v112, 8, v166
v_bfe_u32 v112, v0, 4, 1
v_mfma_f32_16x16x32_bf16 v[136:139], a[136:139], a[192:195], v[136:139]
s_lshl_b32 s82, s82, 10
ds_read_b64 a[164:165], v6 offset:832
ds_read_b64 a[166:167], v6 offset:840
v_mfma_f32_16x16x32_bf16 v[140:143], a[140:143], a[192:195], v[140:143]
s_add_u32 s82, s82, s74
buffer_load_dword v3, v2, s[44:47], s82 offen sc1
v_mfma_f32_16x16x32_bf16 v[140:143], a[136:139], a[196:199], v[140:143]
s_add_u32 s72, s71, 15360
ds_read_b128 a[232:235], v7 offset:2880
ds_read_b64 a[168:169], v6 offset:1344
v_mfma_f32_16x16x32_bf16 v[140:143], a[132:135], a[200:203], v[140:143]
buffer_load_dwordx4 v15, s[24:27], s72 offen offset:1024 lds
v_mfma_f32_16x16x32_bf16 v[140:143], a[128:131], a[204:207], v[140:143]
v_lshl_add_u32 v166, v112, 7, v166
v_lshrrev_b32 v112, 5, v0
v_mfma_f32_16x16x32_bf16 v[144:147], a[128:131], a[208:211], v[144:147]
s_nop 0
ds_read_b64 a[170:171], v6 offset:1352
ds_read_b128 a[236:239], v7 offset:2368
v_mfma_f32_16x16x32_bf16 v[144:147], a[132:135], a[204:207], v[144:147]
v_lshl_add_u32 v166, v112, 9, v166
v_and_b32 v112, 15, v0
v_mfma_f32_16x16x32_bf16 v[144:147], a[136:139], a[200:203], v[144:147]
s_nop 0
ds_read_b64 a[172:173], v6 offset:1856
ds_read_b64 a[174:175], v6 offset:1864
v_mfma_f32_16x16x32_bf16 v[144:147], a[140:143], a[196:199], v[144:147]
s_add_u32 s72, s71, 30720
buffer_load_dwordx4 v15, s[24:27], s72 offen offset:2048 lds
v_mfma_f32_16x16x32_bf16 v[144:147], a[144:147], a[192:195], v[144:147]
v_lshrrev_b32 v113, 2, v0
v_bfe_u32 v114, v0, 3, 2
v_mfma_f32_16x16x32_bf16 v[148:151], a[148:151], a[192:195], v[148:151]
s_nop 0
ds_read_b128 a[240:243], v7 offset:1856
ds_read_b64 a[176:177], v6 offset:2368
v_mfma_f32_16x16x32_bf16 v[148:151], a[144:147], a[196:199], v[148:151]
v_and_b32 v115, 3, v0
v_lshlrev_b32 v8, 7, v113
v_mfma_f32_16x16x32_bf16 v[148:151], a[140:143], a[200:203], v[148:151]
v_lshl_add_u32 v8, v114, 5, v8
v_lshl_add_u32 v8, v115, 3, v8
v_mfma_f32_16x16x32_bf16 v[148:151], a[136:139], a[204:207], v[148:151]
s_nop 0
ds_read_b64 a[178:179], v6 offset:2376
ds_read_b128 a[244:247], v7 offset:1344
v_mfma_f32_16x16x32_bf16 v[148:151], a[132:135], a[208:211], v[148:151]
s_add_u32 s72, s71, 46080
buffer_load_dwordx4 v15, s[24:27], s72 offen offset:3072 lds
v_mfma_f32_16x16x32_bf16 v[148:151], a[128:131], a[212:215], v[148:151]
s_nop 0
ds_read_b64 a[180:181], v6 offset:2880
ds_read_b64 a[182:183], v6 offset:2888
v_mfma_f32_16x16x32_bf16 v[152:155], a[128:131], a[216:219], v[152:155]
v_add_u32 v8, s77, v8
v_subrev_u32 v8, s64, v8
v_mfma_f32_16x16x32_bf16 v[152:155], a[132:135], a[212:215], v[152:155]
v_xor_b32 v9, 32, v8
v_xor_b32 v10, 64, v8
v_mfma_f32_16x16x32_bf16 v[152:155], a[136:139], a[208:211], v[152:155]
s_nop 0
ds_read_b128 a[248:251], v7 offset:832
ds_read_b64 a[184:185], v6 offset:3392
v_mfma_f32_16x16x32_bf16 v[152:155], a[140:143], a[204:207], v[152:155]
v_xor_b32 v11, 0x60, v8
v_lshlrev_b32 v5, 8, v113
v_mfma_f32_16x16x32_bf16 v[152:155], a[144:147], a[200:203], v[152:155]
s_xor_b32 s71, s13, 0x80
ds_read_b64 a[186:187], v6 offset:3400
ds_read_b128 a[252:255], v7 offset:320
v_mfma_f32_16x16x32_bf16 v[152:155], a[148:151], a[196:199], v[152:155]
s_add_u32 m0, s77, 49152
v_and_b32 v114, 1, v0
v_lshl_add_u32 v5, v114, 7, v5
v_mfma_f32_16x16x32_bf16 v[152:155], a[152:155], a[192:195], v[152:155]
s_add_u32 s72, s71, 0
buffer_load_dwordx4 v15, s[24:27], s72 offen lds
v_mfma_f32_16x16x32_bf16 v[156:159], a[156:159], a[192:195], v[156:159]
s_nop 0
ds_read_b64 a[188:189], v6 offset:3904
ds_read_b64 a[190:191], v6 offset:3912
v_mfma_f32_16x16x32_bf16 v[156:159], a[152:155], a[196:199], v[156:159]
v_bfe_u32 v114, v0, 1, 1
v_lshl_add_u32 v5, v114, 3, v5
v_mfma_f32_16x16x32_bf16 v[156:159], a[148:151], a[200:203], v[156:159]
v_lshlrev_b32 v114, 1, s58
v_xor_b32 v114, v114, v113
v_mfma_f32_16x16x32_bf16 v[156:159], a[144:147], a[204:207], v[156:159]
s_add_u32 s72, s71, 15360
buffer_load_dwordx4 v15, s[24:27], s72 offen offset:1024 lds
v_mfma_f32_16x16x32_bf16 v[156:159], a[140:143], a[208:211], v[156:159]
v_and_b32 v114, 7, v114
v_lshl_add_u32 v5, v114, 4, v5
v_mfma_f32_16x16x32_bf16 v[156:159], a[136:139], a[212:215], v[156:159]
v_add_u32 v5, 147456, v5
v_bfe_u32 v114, v0, 1, 2
v_mfma_f32_16x16x32_bf16 v[156:159], a[132:135], a[216:219], v[156:159]
v_lshrrev_b32 v115, 4, v0
v_lshlrev_b32 v116, 7, v112
v_mfma_f32_16x16x32_bf16 v[156:159], a[128:131], a[220:223], v[156:159]
s_waitcnt lgkmcnt(0)
v_lshl_add_u32 v116, v114, 5, v116
v_lshl_add_u32 v116, v115, 3, v116
v_mfma_f32_16x16x32_bf16 v[128:131], a[160:163], a[224:227], v[128:131]
s_nop 0
ds_read_b128 a[192:195], v7 offset:3968
ds_read_b64 a[128:129], v6 offset:384
v_mfma_f32_16x16x32_bf16 v[132:135], a[164:167], a[224:227], v[132:135]
s_add_u32 s72, s71, 30720
buffer_load_dwordx4 v15, s[24:27], s72 offen offset:2048 lds
v_mfma_f32_16x16x32_bf16 v[132:135], a[160:163], a[228:231], v[132:135]
s_nop 0
ds_read_b64 a[130:131], v6 offset:392
ds_read_b128 a[196:199], v7 offset:3456
v_mfma_f32_16x16x32_bf16 v[136:139], a[160:163], a[232:235], v[136:139]
v_add_u32 v116, s64, v116
v_add_u32 v116, 131072, v116
v_mfma_f32_16x16x32_bf16 v[136:139], a[164:167], a[228:231], v[136:139]
v_xor_b32 v117, 32, v116
v_xor_b32 v118, 64, v116
v_mfma_f32_16x16x32_bf16 v[136:139], a[168:171], a[224:227], v[136:139]
s_nop 0
ds_read_b64 a[132:133], v6 offset:896
ds_read_b64 a[134:135], v6 offset:904
v_mfma_f32_16x16x32_bf16 v[140:143], a[172:175], a[224:227], v[140:143]
v_xor_b32 v119, 0x60, v116
v_mfma_f32_16x16x32_bf16 v[140:143], a[168:171], a[228:231], v[140:143]
s_add_u32 s72, s71, 46080
ds_read_b128 a[200:203], v7 offset:2944
ds_read_b64 a[136:137], v6 offset:1408
v_mfma_f32_16x16x32_bf16 v[140:143], a[164:167], a[232:235], v[140:143]
buffer_load_dwordx4 v15, s[24:27], s72 offen offset:3072 lds
v_mfma_f32_16x16x32_bf16 v[140:143], a[160:163], a[236:239], v[140:143]
v_mfma_f32_16x16x32_bf16 v[144:147], a[160:163], a[240:243], v[144:147]
s_nop 0
ds_read_b64 a[138:139], v6 offset:1416
ds_read_b128 a[204:207], v7 offset:2432
v_mfma_f32_16x16x32_bf16 v[144:147], a[164:167], a[236:239], v[144:147]
v_mfma_f32_16x16x32_bf16 v[144:147], a[168:171], a[232:235], v[144:147]
s_nop 0
ds_read_b64 a[140:141], v6 offset:1920
ds_read_b64 a[142:143], v6 offset:1928
v_mfma_f32_16x16x32_bf16 v[144:147], a[172:175], a[228:231], v[144:147]
v_mfma_f32_16x16x32_bf16 v[144:147], a[176:179], a[224:227], v[144:147]
v_mfma_f32_16x16x32_bf16 v[148:151], a[180:183], a[224:227], v[148:151]
s_nop 0
ds_read_b128 a[208:211], v7 offset:1920
ds_read_b64 a[144:145], v6 offset:2432
v_mfma_f32_16x16x32_bf16 v[148:151], a[176:179], a[228:231], v[148:151]
v_mfma_f32_16x16x32_bf16 v[148:151], a[172:175], a[232:235], v[148:151]
s_waitcnt vmcnt(7)
v_cmp_gt_u32 vcc, 2, v3
s_or_b32 s81, vcc_lo, vcc_hi
s_cselect_b32 s81, 0x40000000, 0
v_or_b32 v4, s81, v1
v_mfma_f32_16x16x32_bf16 v[148:151], a[168:171], a[236:239], v[148:151]
s_nop 0
ds_read_b64 a[146:147], v6 offset:2440
ds_read_b128 a[212:215], v7 offset:1408
v_mfma_f32_16x16x32_bf16 v[148:151], a[164:167], a[240:243], v[148:151]
v_mfma_f32_16x16x32_bf16 v[148:151], a[160:163], a[244:247], v[148:151]
s_nop 0
ds_read_b64 a[148:149], v6 offset:2944
ds_read_b64 a[150:151], v6 offset:2952
v_mfma_f32_16x16x32_bf16 v[152:155], a[160:163], a[248:251], v[152:155]
v_mfma_f32_16x16x32_bf16 v[152:155], a[164:167], a[244:247], v[152:155]
s_lshr_b32 s69, s12, 18
v_mfma_f32_16x16x32_bf16 v[152:155], a[168:171], a[240:243], v[152:155]
s_lshl_b32 s69, s69, 12
ds_read_b128 a[216:219], v7 offset:896
ds_read_b64 a[152:153], v6 offset:3456
v_mfma_f32_16x16x32_bf16 v[152:155], a[172:175], a[236:239], v[152:155]
s_add_u32 s69, s69, s95
buffer_load_dwordx4 a[0:3], v4, s[44:47], s69 offen sc1
v_mfma_f32_16x16x32_bf16 v[152:155], a[176:179], a[232:235], v[152:155]
s_nop 0
ds_read_b64 a[154:155], v6 offset:3464
ds_read_b128 a[220:223], v7 offset:384
v_mfma_f32_16x16x32_bf16 v[152:155], a[180:183], a[228:231], v[152:155]
v_mfma_f32_16x16x32_bf16 v[152:155], a[184:187], a[224:227], v[152:155]
v_mfma_f32_16x16x32_bf16 v[156:159], a[188:191], a[224:227], v[156:159]
s_nop 0
ds_read_b64 a[156:157], v6 offset:3968
ds_read_b64 a[158:159], v6 offset:3976
v_mfma_f32_16x16x32_bf16 v[156:159], a[184:187], a[228:231], v[156:159]
buffer_load_dwordx4 a[4:7], v4, s[44:47], s69 offen offset:1024 sc1
v_mfma_f32_16x16x32_bf16 v[156:159], a[180:183], a[232:235], v[156:159]
v_mfma_f32_16x16x32_bf16 v[156:159], a[176:179], a[236:239], v[156:159]
v_mfma_f32_16x16x32_bf16 v[156:159], a[172:175], a[240:243], v[156:159]
v_mfma_f32_16x16x32_bf16 v[156:159], a[168:171], a[244:247], v[156:159]
buffer_load_dwordx4 a[8:11], v4, s[44:47], s69 offen offset:2048 sc1
v_mfma_f32_16x16x32_bf16 v[156:159], a[164:167], a[248:251], v[156:159]
v_mfma_f32_16x16x32_bf16 v[156:159], a[160:163], a[252:255], v[156:159]
s_waitcnt lgkmcnt(0)
v_mfma_f32_16x16x32_bf16 v[128:131], a[128:131], a[192:195], v[128:131]
s_nop 0
ds_read_b128 a[224:227], v7 offset:4032
ds_read_b64 a[160:161], v6 offset:448
v_mfma_f32_16x16x32_bf16 v[132:135], a[132:135], a[192:195], v[132:135]
v_mfma_f32_16x16x32_bf16 v[132:135], a[128:131], a[196:199], v[132:135]
s_nop 0
ds_read_b64 a[162:163], v6 offset:456
ds_read_b128 a[228:231], v7 offset:3520
v_mfma_f32_16x16x32_bf16 v[136:139], a[128:131], a[200:203], v[136:139]
buffer_load_dwordx4 a[12:15], v4, s[44:47], s69 offen offset:3072 sc1
v_mfma_f32_16x16x32_bf16 v[136:139], a[132:135], a[196:199], v[136:139]
v_mfma_f32_16x16x32_bf16 v[136:139], a[136:139], a[192:195], v[136:139]
s_nop 0
ds_read_b64 a[164:165], v6 offset:960
ds_read_b64 a[166:167], v6 offset:968
v_mfma_f32_16x16x32_bf16 v[140:143], a[140:143], a[192:195], v[140:143]
v_mfma_f32_16x16x32_bf16 v[140:143], a[136:139], a[196:199], v[140:143]
s_nop 0
ds_read_b128 a[232:235], v7 offset:3008
ds_read_b64 a[168:169], v6 offset:1472
v_mfma_f32_16x16x32_bf16 v[140:143], a[132:135], a[200:203], v[140:143]
s_add_u32 s69, s69, 0x20000
buffer_load_dwordx4 a[16:19], v4, s[44:47], s69 offen sc1
v_mfma_f32_16x16x32_bf16 v[140:143], a[128:131], a[204:207], v[140:143]
v_mfma_f32_16x16x32_bf16 v[144:147], a[128:131], a[208:211], v[144:147]
s_nop 0
ds_read_b64 a[170:171], v6 offset:1480
ds_read_b128 a[236:239], v7 offset:2496
v_mfma_f32_16x16x32_bf16 v[144:147], a[132:135], a[204:207], v[144:147]
v_mfma_f32_16x16x32_bf16 v[144:147], a[136:139], a[200:203], v[144:147]
s_nop 0
ds_read_b64 a[172:173], v6 offset:1984
ds_read_b64 a[174:175], v6 offset:1992
v_mfma_f32_16x16x32_bf16 v[144:147], a[140:143], a[196:199], v[144:147]
buffer_load_dwordx4 a[20:23], v4, s[44:47], s69 offen offset:1024 sc1
v_mfma_f32_16x16x32_bf16 v[144:147], a[144:147], a[192:195], v[144:147]
v_mfma_f32_16x16x32_bf16 v[148:151], a[148:151], a[192:195], v[148:151]
s_nop 0
ds_read_b128 a[240:243], v7 offset:1984
ds_read_b64 a[176:177], v6 offset:2496
v_mfma_f32_16x16x32_bf16 v[148:151], a[144:147], a[196:199], v[148:151]
v_mfma_f32_16x16x32_bf16 v[148:151], a[140:143], a[200:203], v[148:151]
v_mfma_f32_16x16x32_bf16 v[148:151], a[136:139], a[204:207], v[148:151]
s_nop 0
ds_read_b64 a[178:179], v6 offset:2504
ds_read_b128 a[244:247], v7 offset:1472
v_mfma_f32_16x16x32_bf16 v[148:151], a[132:135], a[208:211], v[148:151]
buffer_load_dwordx4 a[24:27], v4, s[44:47], s69 offen offset:2048 sc1
v_mfma_f32_16x16x32_bf16 v[148:151], a[128:131], a[212:215], v[148:151]
s_nop 0
ds_read_b64 a[180:181], v6 offset:3008
ds_read_b64 a[182:183], v6 offset:3016
v_mfma_f32_16x16x32_bf16 v[152:155], a[128:131], a[216:219], v[152:155]
v_mfma_f32_16x16x32_bf16 v[152:155], a[132:135], a[212:215], v[152:155]
v_mfma_f32_16x16x32_bf16 v[152:155], a[136:139], a[208:211], v[152:155]
s_nop 0
ds_read_b128 a[248:251], v7 offset:960
ds_read_b64 a[184:185], v6 offset:3520
v_mfma_f32_16x16x32_bf16 v[152:155], a[140:143], a[204:207], v[152:155]
buffer_load_dwordx4 a[28:31], v4, s[44:47], s69 offen offset:3072 sc1
v_mfma_f32_16x16x32_bf16 v[152:155], a[144:147], a[200:203], v[152:155]
s_nop 0
ds_read_b64 a[186:187], v6 offset:3528
ds_read_b128 a[252:255], v7 offset:448
v_mfma_f32_16x16x32_bf16 v[152:155], a[148:151], a[196:199], v[152:155]
v_mfma_f32_16x16x32_bf16 v[152:155], a[152:155], a[192:195], v[152:155]
s_lshr_b32 s69, s13, 18
v_mfma_f32_16x16x32_bf16 v[156:159], a[156:159], a[192:195], v[156:159]
s_lshl_b32 s69, s69, 12
ds_read_b64 a[188:189], v6 offset:4032
ds_read_b64 a[190:191], v6 offset:4040
v_mfma_f32_16x16x32_bf16 v[156:159], a[152:155], a[196:199], v[156:159]
s_add_u32 s69, s69, s95
buffer_load_dwordx4 a[32:35], v4, s[44:47], s69 offen sc1
v_mfma_f32_16x16x32_bf16 v[156:159], a[148:151], a[200:203], v[156:159]
v_mfma_f32_16x16x32_bf16 v[156:159], a[144:147], a[204:207], v[156:159]
v_mfma_f32_16x16x32_bf16 v[156:159], a[140:143], a[208:211], v[156:159]
v_mfma_f32_16x16x32_bf16 v[156:159], a[136:139], a[212:215], v[156:159]
buffer_load_dwordx4 a[36:39], v4, s[44:47], s69 offen offset:1024 sc1
v_mfma_f32_16x16x32_bf16 v[156:159], a[132:135], a[216:219], v[156:159]
v_mfma_f32_16x16x32_bf16 v[156:159], a[128:131], a[220:223], v[156:159]
s_waitcnt lgkmcnt(0)
v_mfma_f32_16x16x32_bf16 v[128:131], a[160:163], a[224:227], v[128:131]
s_nop 0
ds_read_b64_tr_b16 v[192:193], v8 offset:0
ds_read_b64_tr_b16 v[194:195], v8 offset:2048
v_mfma_f32_16x16x32_bf16 v[132:135], a[164:167], a[224:227], v[132:135]
v_mfma_f32_16x16x32_bf16 v[132:135], a[160:163], a[228:231], v[132:135]
s_nop 0
ds_read_b64_tr_b16 v[196:197], v9 offset:0
ds_read_b64_tr_b16 v[198:199], v9 offset:2048
v_mfma_f32_16x16x32_bf16 v[136:139], a[160:163], a[232:235], v[136:139]
buffer_load_dwordx4 a[40:43], v4, s[44:47], s69 offen offset:2048 sc1
v_mfma_f32_16x16x32_bf16 v[136:139], a[164:167], a[228:231], v[136:139]
s_nop 0
ds_read_b64_tr_b16 v[200:201], v10 offset:0
ds_read_b64_tr_b16 v[202:203], v10 offset:2048
v_mfma_f32_16x16x32_bf16 v[136:139], a[168:171], a[224:227], v[136:139]
v_mfma_f32_16x16x32_bf16 v[140:143], a[172:175], a[224:227], v[140:143]
s_nop 0
ds_read_b64_tr_b16 v[204:205], v11 offset:0
ds_read_b64_tr_b16 v[206:207], v11 offset:2048
v_mfma_f32_16x16x32_bf16 v[140:143], a[168:171], a[228:231], v[140:143]
v_cvt_pk_bf16_f32 v128, v128, v129
v_cvt_pk_bf16_f32 v129, v130, v131
v_cvt_pk_bf16_f32 v130, v132, v133
v_mfma_f32_16x16x32_bf16 v[140:143], a[164:167], a[232:235], v[140:143]
s_nop 0
ds_read_b64_tr_b16 v[208:209], v8 offset:4096
ds_read_b64_tr_b16 v[210:211], v8 offset:6144
v_cvt_pk_bf16_f32 v131, v134, v135
v_mfma_f32_16x16x32_bf16 v[140:143], a[160:163], a[236:239], v[140:143]
s_nop 0
buffer_load_dwordx4 a[44:47], v4, s[44:47], s69 offen offset:3072 sc1
v_permlane32_swap_b32 v128, v130
v_mfma_f32_16x16x32_bf16 v[144:147], a[160:163], a[240:243], v[144:147]
s_nop 0
ds_read_b64_tr_b16 v[212:213], v9 offset:4096
ds_read_b64_tr_b16 v[214:215], v9 offset:6144
v_permlane32_swap_b32 v129, v131
v_mfma_f32_16x16x32_bf16 v[144:147], a[164:167], a[236:239], v[144:147]
buffer_store_dwordx4 v[128:131], v166, s[44:47], s80 offen sc1
v_mfma_f32_16x16x32_bf16 v[144:147], a[168:171], a[232:235], v[144:147]
s_nop 0
ds_read_b64_tr_b16 v[216:217], v10 offset:4096
ds_read_b64_tr_b16 v[218:219], v10 offset:6144
v_mfma_f32_16x16x32_bf16 v[144:147], a[172:175], a[228:231], v[144:147]
s_add_u32 s69, s69, 0x20000
buffer_load_dwordx4 a[48:51], v4, s[44:47], s69 offen sc1
v_mfma_f32_16x16x32_bf16 v[144:147], a[176:179], a[224:227], v[144:147]
s_nop 0
ds_read_b64_tr_b16 v[220:221], v11 offset:4096
ds_read_b64_tr_b16 v[222:223], v11 offset:6144
v_cvt_pk_bf16_f32 v136, v136, v137
v_mfma_f32_16x16x32_bf16 v[148:151], a[180:183], a[224:227], v[148:151]
v_cvt_pk_bf16_f32 v137, v138, v139
v_cvt_pk_bf16_f32 v138, v140, v141
v_cvt_pk_bf16_f32 v139, v142, v143
v_mfma_f32_16x16x32_bf16 v[148:151], a[176:179], a[228:231], v[148:151]
s_nop 0
ds_read_b64_tr_b16 v[224:225], v8 offset:8192
ds_read_b64_tr_b16 v[226:227], v8 offset:10240
v_permlane32_swap_b32 v136, v138
v_mfma_f32_16x16x32_bf16 v[148:151], a[172:175], a[232:235], v[148:151]
v_permlane32_swap_b32 v137, v139
v_mfma_f32_16x16x32_bf16 v[148:151], a[168:171], a[236:239], v[148:151]
s_nop 0
ds_read_b64_tr_b16 v[228:229], v9 offset:8192
ds_read_b64_tr_b16 v[230:231], v9 offset:10240
v_mfma_f32_16x16x32_bf16 v[148:151], a[164:167], a[240:243], v[148:151]
buffer_load_dwordx4 a[52:55], v4, s[44:47], s69 offen offset:1024 sc1
v_mfma_f32_16x16x32_bf16 v[148:151], a[160:163], a[244:247], v[148:151]
s_nop 0
ds_read_b64_tr_b16 v[232:233], v10 offset:8192
ds_read_b64_tr_b16 v[234:235], v10 offset:10240
v_mfma_f32_16x16x32_bf16 v[152:155], a[160:163], a[248:251], v[152:155]
buffer_store_dwordx4 v[136:139], v166, s[44:47], s80 offen offset:1024 sc1
v_mfma_f32_16x16x32_bf16 v[152:155], a[164:167], a[244:247], v[152:155]
s_nop 0
ds_read_b64_tr_b16 v[236:237], v11 offset:8192
ds_read_b64_tr_b16 v[238:239], v11 offset:10240
v_mfma_f32_16x16x32_bf16 v[152:155], a[168:171], a[240:243], v[152:155]
buffer_load_dwordx4 a[56:59], v4, s[44:47], s69 offen offset:2048 sc1
v_mfma_f32_16x16x32_bf16 v[152:155], a[172:175], a[236:239], v[152:155]
s_nop 0
ds_read_b64_tr_b16 v[240:241], v8 offset:12288
ds_read_b64_tr_b16 v[242:243], v8 offset:14336
v_mfma_f32_16x16x32_bf16 v[152:155], a[176:179], a[232:235], v[152:155]
v_cvt_pk_bf16_f32 v144, v144, v145
v_cvt_pk_bf16_f32 v145, v146, v147
v_cvt_pk_bf16_f32 v146, v148, v149
v_mfma_f32_16x16x32_bf16 v[152:155], a[180:183], a[228:231], v[152:155]
s_nop 0
ds_read_b64_tr_b16 v[244:245], v9 offset:12288
ds_read_b64_tr_b16 v[246:247], v9 offset:14336
v_cvt_pk_bf16_f32 v147, v150, v151
v_mfma_f32_16x16x32_bf16 v[152:155], a[184:187], a[224:227], v[152:155]
Lstub10:
s_cbranch_execz Lret
v_permlane32_swap_b32 v144, v146
v_permlane32_swap_b32 v145, v147
v_mfma_f32_16x16x32_bf16 v[156:159], a[188:191], a[224:227], v[156:159]
s_nop 0
ds_read_b64_tr_b16 v[248:249], v10 offset:12288
ds_read_b64_tr_b16 v[250:251], v10 offset:14336
v_mfma_f32_16x16x32_bf16 v[156:159], a[184:187], a[228:231], v[156:159]
buffer_load_dwordx4 a[60:63], v4, s[44:47], s69 offen offset:3072 sc1
v_mfma_f32_16x16x32_bf16 v[156:159], a[180:183], a[232:235], v[156:159]
s_nop 0
ds_read_b64_tr_b16 v[252:253], v11 offset:12288
ds_read_b64_tr_b16 v[254:255], v11 offset:14336
v_mfma_f32_16x16x32_bf16 v[156:159], a[176:179], a[236:239], v[156:159]
buffer_store_dwordx4 v[144:147], v166, s[44:47], s80 offen offset:2048 sc1
v_mfma_f32_16x16x32_bf16 v[156:159], a[172:175], a[240:243], v[156:159]
v_mfma_f32_16x16x32_bf16 v[156:159], a[168:171], a[244:247], v[156:159]
v_mfma_f32_16x16x32_bf16 v[156:159], a[164:167], a[248:251], v[156:159]
v_mfma_f32_16x16x32_bf16 v[156:159], a[160:163], a[252:255], v[156:159]
v_cvt_pk_bf16_f32 v152, v152, v153
v_cvt_pk_bf16_f32 v153, v154, v155
s_nop 5
v_cvt_pk_bf16_f32 v154, v156, v157
v_cvt_pk_bf16_f32 v155, v158, v159
s_nop 0
v_permlane32_swap_b32 v152, v154
v_permlane32_swap_b32 v153, v155
buffer_store_dwordx4 v[152:155], v166, s[44:47], s80 offen offset:3072 sc1
s_waitcnt vmcnt(12) lgkmcnt(0)
s_cmp_lg_u32 s81, 0
s_cbranch_scc1 Lredo0
Lredo0b:
s_barrier
LEe:
v_mfma_f32_16x16x32_bf16 v[16:19], v[192:195], a[0:3], 0
s_nop 0
ds_read_b64_tr_b16 v[128:129], v8 offset:16384
ds_read_b64_tr_b16 v[130:131], v8 offset:18432
v_mfma_f32_16x16x32_bf16 v[16:19], v[208:211], a[4:7], v[16:19]
s_xor_b32 s71, s13, 0x100
ds_read_b64_tr_b16 v[132:133], v9 offset:16384
ds_read_b64_tr_b16 v[134:135], v9 offset:18432
v_mfma_f32_16x16x32_bf16 v[16:19], v[224:227], a[8:11], v[16:19]
s_add_u32 m0, s85, 0
ds_read_b64_tr_b16 v[136:137], v10 offset:16384
ds_read_b64_tr_b16 v[138:139], v10 offset:18432
v_mfma_f32_16x16x32_bf16 v[16:19], v[240:243], a[12:15], v[16:19]
s_add_u32 s72, s71, 0
buffer_load_dwordx4 v15, s[24:27], s72 offen lds
v_mfma_f32_16x16x32_bf16 v[32:35], v[240:243], a[28:31], 0
s_nop 0
ds_read_b64_tr_b16 v[140:141], v11 offset:16384
ds_read_b64_tr_b16 v[142:143], v11 offset:18432
v_mfma_f32_16x16x32_bf16 v[32:35], v[224:227], a[24:27], v[32:35]
s_lshr_b32 s69, s14, 18
v_add_u32 v4, s64, v1
v_add_u32 v4, 131072, v4
v_mfma_f32_16x16x32_bf16 v[32:35], v[208:211], a[20:23], v[32:35]
s_lshl_b32 s69, s69, 12
ds_read_b64_tr_b16 v[144:145], v8 offset:20480
ds_read_b64_tr_b16 v[146:147], v8 offset:22528
v_mfma_f32_16x16x32_bf16 v[32:35], v[192:195], a[16:19], v[32:35]
s_add_u32 s69, s69, s95
buffer_load_dwordx4 a[64:67], v1, s[44:47], s69 offen sc1
v_mfma_f32_16x16x32_bf16 v[36:39], v[196:199], a[16:19], 0
s_lshl_b32 s70, s75, 18
ds_read_b64_tr_b16 v[148:149], v9 offset:20480
ds_read_b64_tr_b16 v[150:151], v9 offset:22528
v_mfma_f32_16x16x32_bf16 v[36:39], v[212:215], a[20:23], v[36:39]
s_add_u32 s70, s70, s94
ds_read_b64_tr_b16 v[152:153], v10 offset:20480
ds_read_b64_tr_b16 v[154:155], v10 offset:22528
v_mfma_f32_16x16x32_bf16 v[36:39], v[228:231], a[24:27], v[36:39]
ds_write_b128 v4, v[80:83] offset:0
v_mfma_f32_16x16x32_bf16 v[36:39], v[244:247], a[28:31], v[36:39]
s_add_u32 s72, s71, 15360
buffer_load_dwordx4 v15, s[24:27], s72 offen offset:1024 lds
v_mfma_f32_16x16x32_bf16 v[20:23], v[244:247], a[12:15], 0
s_nop 0
ds_read_b64_tr_b16 v[156:157], v11 offset:20480
ds_read_b64_tr_b16 v[158:159], v11 offset:22528
v_mfma_f32_16x16x32_bf16 v[20:23], v[228:231], a[8:11], v[20:23]
s_nop 0
ds_read_b64_tr_b16 v[160:161], v8 offset:24576
ds_read_b64_tr_b16 v[162:163], v8 offset:26624
v_mfma_f32_16x16x32_bf16 v[20:23], v[212:215], a[4:7], v[20:23]
s_nop 0
ds_read_b64_tr_b16 v[164:165], v9 offset:24576
ds_read_b64_tr_b16 v[166:167], v9 offset:26624
v_mfma_f32_16x16x32_bf16 v[20:23], v[196:199], a[0:3], v[20:23]
buffer_load_dwordx4 a[68:71], v1, s[44:47], s69 offen offset:1024 sc1
v_mfma_f32_16x16x32_bf16 v[24:27], v[200:203], a[0:3], 0
ds_write_b128 v4, v[84:87] offset:1024
v_mfma_f32_16x16x32_bf16 v[24:27], v[216:219], a[4:7], v[24:27]
s_nop 0
ds_read_b64_tr_b16 v[168:169], v10 offset:24576
ds_read_b64_tr_b16 v[170:171], v10 offset:26624
v_mfma_f32_16x16x32_bf16 v[24:27], v[232:235], a[8:11], v[24:27]
s_nop 0
ds_read_b64_tr_b16 v[172:173], v11 offset:24576
ds_read_b64_tr_b16 v[174:175], v11 offset:26624
v_mfma_f32_16x16x32_bf16 v[24:27], v[248:251], a[12:15], v[24:27]
s_add_u32 s72, s71, 30720
buffer_load_dwordx4 v15, s[24:27], s72 offen offset:2048 lds
v_mfma_f32_16x16x32_bf16 v[40:43], v[248:251], a[28:31], 0
s_nop 0
ds_read_b64_tr_b16 v[176:177], v8 offset:28672
ds_read_b64_tr_b16 v[178:179], v8 offset:30720
v_mfma_f32_16x16x32_bf16 v[40:43], v[232:235], a[24:27], v[40:43]
ds_write_b128 v4, v[96:99] offset:2048
v_mfma_f32_16x16x32_bf16 v[40:43], v[216:219], a[20:23], v[40:43]
s_nop 0
ds_read_b64_tr_b16 v[180:181], v9 offset:28672
ds_read_b64_tr_b16 v[182:183], v9 offset:30720
v_mfma_f32_16x16x32_bf16 v[40:43], v[200:203], a[16:19], v[40:43]
s_nop 0
ds_read_b64_tr_b16 v[184:185], v10 offset:28672
ds_read_b64_tr_b16 v[186:187], v10 offset:30720
v_mfma_f32_16x16x32_bf16 v[44:47], v[204:207], a[16:19], 0
s_add_u32 s72, s71, 46080
buffer_load_dwordx4 v15, s[24:27], s72 offen offset:3072 lds
v_mfma_f32_16x16x32_bf16 v[44:47], v[220:223], a[20:23], v[44:47]
s_nop 0
ds_read_b64_tr_b16 v[188:189], v11 offset:28672
ds_read_b64_tr_b16 v[190:191], v11 offset:30720
v_mfma_f32_16x16x32_bf16 v[44:47], v[236:239], a[24:27], v[44:47]
ds_write_b128 v4, v[100:103] offset:3072
v_mfma_f32_16x16x32_bf16 v[44:47], v[252:255], a[28:31], v[44:47]
v_mfma_f32_16x16x32_bf16 v[28:31], v[252:255], a[12:15], 0
s_xor_b32 s71, s13, 0x180
buffer_load_dwordx4 a[72:75], v1, s[44:47], s69 offen offset:2048 sc1
v_mfma_f32_16x16x32_bf16 v[28:31], v[236:239], a[8:11], v[28:31]
s_add_u32 m0, s85, 16384
v_mfma_f32_16x16x32_bf16 v[28:31], v[220:223], a[4:7], v[28:31]
s_waitcnt vmcnt(31) lgkmcnt(0)
v_mfma_f32_16x16x32_bf16 v[28:31], v[204:207], a[0:3], v[28:31]
s_barrier
v_mfma_f32_16x16x32_bf16 v[48:51], v[128:131], a[0:3], 0
s_add_u32 s72, s71, 0
buffer_load_dwordx4 v15, s[24:27], s72 offen lds
v_mfma_f32_16x16x32_bf16 v[48:51], v[144:147], a[4:7], v[48:51]
s_nop 0
ds_read_b64_tr_b16 v[192:193], v8 offset:32768
ds_read_b64_tr_b16 v[194:195], v8 offset:34816
v_mfma_f32_16x16x32_bf16 v[48:51], v[160:163], a[8:11], v[48:51]
s_nop 0
ds_read_b64_tr_b16 v[196:197], v9 offset:32768
ds_read_b64_tr_b16 v[198:199], v9 offset:34816
v_mfma_f32_16x16x32_bf16 v[48:51], v[176:179], a[12:15], v[48:51]
s_nop 0
ds_read_b64_tr_b16 v[200:201], v10 offset:32768
ds_read_b64_tr_b16 v[202:203], v10 offset:34816
v_mfma_f32_16x16x32_bf16 v[64:67], v[176:179], a[28:31], 0
buffer_load_dwordx4 a[76:79], v1, s[44:47], s69 offen offset:3072 sc1
v_mfma_f32_16x16x32_bf16 v[64:67], v[160:163], a[24:27], v[64:67]
s_nop 0
ds_read_b64_tr_b16 v[204:205], v11 offset:32768
ds_read_b64_tr_b16 v[206:207], v11 offset:34816
v_mfma_f32_16x16x32_bf16 v[64:67], v[144:147], a[20:23], v[64:67]
v_mfma_f32_16x16x32_bf16 v[64:67], v[128:131], a[16:19], v[64:67]
s_nop 0
ds_read_b64_tr_b16 v[208:209], v8 offset:36864
ds_read_b64_tr_b16 v[210:211], v8 offset:38912
v_mfma_f32_16x16x32_bf16 v[68:71], v[132:135], a[16:19], 0
s_add_u32 s72, s71, 15360
buffer_load_dwordx4 v15, s[24:27], s72 offen offset:1024 lds
v_mfma_f32_16x16x32_bf16 v[68:71], v[148:151], a[20:23], v[68:71]
s_nop 0
ds_read_b64_tr_b16 v[212:213], v9 offset:36864
ds_read_b64_tr_b16 v[214:215], v9 offset:38912
v_mfma_f32_16x16x32_bf16 v[68:71], v[164:167], a[24:27], v[68:71]
s_nop 0
ds_read_b64_tr_b16 v[216:217], v10 offset:36864
ds_read_b64_tr_b16 v[218:219], v10 offset:38912
v_mfma_f32_16x16x32_bf16 v[68:71], v[180:183], a[28:31], v[68:71]
s_nop 0
ds_read_b64_tr_b16 v[220:221], v11 offset:36864
ds_read_b64_tr_b16 v[222:223], v11 offset:38912
v_mfma_f32_16x16x32_bf16 v[52:55], v[180:183], a[12:15], 0
v_mfma_f32_16x16x32_bf16 v[52:55], v[164:167], a[8:11], v[52:55]
s_add_u32 s69, s69, 0x20000
buffer_load_dwordx4 a[80:83], v1, s[44:47], s69 offen sc1
v_mfma_f32_16x16x32_bf16 v[52:55], v[148:151], a[4:7], v[52:55]
s_nop 0
ds_read_b64_tr_b16 v[224:225], v8 offset:40960
ds_read_b64_tr_b16 v[226:227], v8 offset:43008
v_mfma_f32_16x16x32_bf16 v[52:55], v[132:135], a[0:3], v[52:55]
s_nop 0
ds_read_b64_tr_b16 v[228:229], v9 offset:40960
ds_read_b64_tr_b16 v[230:231], v9 offset:43008
v_mfma_f32_16x16x32_bf16 v[56:59], v[136:139], a[0:3], 0
s_nop 0
ds_read_b64_tr_b16 v[232:233], v10 offset:40960
ds_read_b64_tr_b16 v[234:235], v10 offset:43008
v_mfma_f32_16x16x32_bf16 v[56:59], v[152:155], a[4:7], v[56:59]
s_add_u32 s72, s71, 30720
buffer_load_dwordx4 v15, s[24:27], s72 offen offset:2048 lds
v_mfma_f32_16x16x32_bf16 v[56:59], v[168:171], a[8:11], v[56:59]
s_nop 0
ds_read_b64_tr_b16 v[236:237], v11 offset:40960
ds_read_b64_tr_b16 v[238:239], v11 offset:43008
v_mfma_f32_16x16x32_bf16 v[56:59], v[184:187], a[12:15], v[56:59]
v_mfma_f32_16x16x32_bf16 v[72:75], v[184:187], a[28:31], 0
s_nop 0
ds_read_b64_tr_b16 v[240:241], v8 offset:45056
ds_read_b64_tr_b16 v[242:243], v8 offset:47104
v_mfma_f32_16x16x32_bf16 v[72:75], v[168:171], a[24:27], v[72:75]
s_nop 0
ds_read_b64_tr_b16 v[244:245], v9 offset:45056
ds_read_b64_tr_b16 v[246:247], v9 offset:47104
v_mfma_f32_16x16x32_bf16 v[72:75], v[152:155], a[20:23], v[72:75]
s_add_u32 s72, s71, 46080
buffer_load_dwordx4 v15, s[24:27], s72 offen offset:3072 lds
v_mfma_f32_16x16x32_bf16 v[72:75], v[136:139], a[16:19], v[72:75]
s_nop 0
ds_read_b64_tr_b16 v[248:249], v10 offset:45056
ds_read_b64_tr_b16 v[250:251], v10 offset:47104
v_mfma_f32_16x16x32_bf16 v[76:79], v[140:143], a[16:19], 0
s_nop 0
ds_read_b64_tr_b16 v[252:253], v11 offset:45056
ds_read_b64_tr_b16 v[254:255], v11 offset:47104
v_mfma_f32_16x16x32_bf16 v[76:79], v[156:159], a[20:23], v[76:79]
v_mfma_f32_16x16x32_bf16 v[76:79], v[172:175], a[24:27], v[76:79]
buffer_load_dwordx4 a[84:87], v1, s[44:47], s69 offen offset:1024 sc1
v_mfma_f32_16x16x32_bf16 v[76:79], v[188:191], a[28:31], v[76:79]
s_xor_b32 s71, s14, 0x80
v_mfma_f32_16x16x32_bf16 v[60:63], v[188:191], a[12:15], 0
s_add_u32 m0, s85, 32768
v_mfma_f32_16x16x32_bf16 v[60:63], v[172:175], a[8:11], v[60:63]
s_add_u32 s72, s71, 0
v_mfma_f32_16x16x32_bf16 v[60:63], v[156:159], a[4:7], v[60:63]
s_waitcnt vmcnt(34) lgkmcnt(0)
buffer_load_dwordx4 v15, s[24:27], s72 offen lds
v_mfma_f32_16x16x32_bf16 v[60:63], v[140:143], a[0:3], v[60:63]
s_barrier
v_mfma_f32_16x16x32_bf16 v[80:83], v[192:195], a[0:3], 0
s_nop 0
ds_read_b64_tr_b16 v[128:129], v8 offset:49152
ds_read_b64_tr_b16 v[130:131], v8 offset:51200
v_mfma_f32_16x16x32_bf16 v[80:83], v[208:211], a[4:7], v[80:83]
s_nop 0
ds_read_b64_tr_b16 v[132:133], v9 offset:49152
ds_read_b64_tr_b16 v[134:135], v9 offset:51200
v_mfma_f32_16x16x32_bf16 v[80:83], v[224:227], a[8:11], v[80:83]
buffer_load_dwordx4 a[88:91], v1, s[44:47], s69 offen offset:2048 sc1
v_mfma_f32_16x16x32_bf16 v[80:83], v[240:243], a[12:15], v[80:83]
s_nop 0
ds_read_b64_tr_b16 v[136:137], v10 offset:49152
ds_read_b64_tr_b16 v[138:139], v10 offset:51200
v_mfma_f32_16x16x32_bf16 v[96:99], v[240:243], a[28:31], 0
s_nop 0
ds_read_b64_tr_b16 v[140:141], v11 offset:49152
ds_read_b64_tr_b16 v[142:143], v11 offset:51200
v_mfma_f32_16x16x32_bf16 v[96:99], v[224:227], a[24:27], v[96:99]
v_mfma_f32_16x16x32_bf16 v[96:99], v[208:211], a[20:23], v[96:99]
s_add_u32 s72, s71, 15360
buffer_load_dwordx4 v15, s[24:27], s72 offen offset:1024 lds
v_mfma_f32_16x16x32_bf16 v[96:99], v[192:195], a[16:19], v[96:99]
s_nop 0
ds_read_b64_tr_b16 v[144:145], v8 offset:53248
ds_read_b64_tr_b16 v[146:147], v8 offset:55296
v_mfma_f32_16x16x32_bf16 v[100:103], v[196:199], a[16:19], 0
s_nop 0
ds_read_b64_tr_b16 v[148:149], v9 offset:53248
ds_read_b64_tr_b16 v[150:151], v9 offset:55296
v_mfma_f32_16x16x32_bf16 v[100:103], v[212:215], a[20:23], v[100:103]
s_nop 0
ds_read_b64_tr_b16 v[152:153], v10 offset:53248
ds_read_b64_tr_b16 v[154:155], v10 offset:55296
v_mfma_f32_16x16x32_bf16 v[100:103], v[228:231], a[24:27], v[100:103]
v_mfma_f32_16x16x32_bf16 v[100:103], v[244:247], a[28:31], v[100:103]
buffer_load_dwordx4 a[92:95], v1, s[44:47], s69 offen offset:3072 sc1
v_mfma_f32_16x16x32_bf16 v[84:87], v[244:247], a[12:15], 0
s_nop 0
ds_read_b64_tr_b16 v[156:157], v11 offset:53248
ds_read_b64_tr_b16 v[158:159], v11 offset:55296
v_mfma_f32_16x16x32_bf16 v[84:87], v[228:231], a[8:11], v[84:87]
s_nop 0
ds_read_b64_tr_b16 v[160:161], v8 offset:57344
ds_read_b64_tr_b16 v[162:163], v8 offset:59392
v_mfma_f32_16x16x32_bf16 v[84:87], v[212:215], a[4:7], v[84:87]
s_nop 0
ds_read_b64_tr_b16 v[164:165], v9 offset:57344
ds_read_b64_tr_b16 v[166:167], v9 offset:59392
v_mfma_f32_16x16x32_bf16 v[84:87], v[196:199], a[0:3], v[84:87]
s_add_u32 s72, s71, 30720
buffer_load_dwordx4 v15, s[24:27], s72 offen offset:2048 lds
v_mfma_f32_16x16x32_bf16 v[88:91], v[200:203], a[0:3], 0
v_mfma_f32_16x16x32_bf16 v[88:91], v[216:219], a[4:7], v[88:91]
s_nop 0
ds_read_b64_tr_b16 v[168:169], v10 offset:57344
ds_read_b64_tr_b16 v[170:171], v10 offset:59392
v_mfma_f32_16x16x32_bf16 v[88:91], v[232:235], a[8:11], v[88:91]
s_nop 0
ds_read_b64_tr_b16 v[172:173], v11 offset:57344
ds_read_b64_tr_b16 v[174:175], v11 offset:59392
v_mfma_f32_16x16x32_bf16 v[88:91], v[248:251], a[12:15], v[88:91]
s_nop 0
ds_read_b64_tr_b16 v[176:177], v8 offset:61440
ds_read_b64_tr_b16 v[178:179], v8 offset:63488
v_mfma_f32_16x16x32_bf16 v[104:107], v[248:251], a[28:31], 0
s_add_u32 s72, s71, 46080
buffer_load_dwordx4 v15, s[24:27], s72 offen offset:3072 lds
v_mfma_f32_16x16x32_bf16 v[104:107], v[232:235], a[24:27], v[104:107]
v_mfma_f32_16x16x32_bf16 v[104:107], v[216:219], a[20:23], v[104:107]
s_xor_b32 s82, s78, 4
ds_read_b64_tr_b16 v[180:181], v9 offset:61440
ds_read_b64_tr_b16 v[182:183], v9 offset:63488
v_mfma_f32_16x16x32_bf16 v[104:107], v[200:203], a[16:19], v[104:107]
s_lshl_b32 s82, s82, 10
ds_read_b64_tr_b16 v[184:185], v10 offset:61440
ds_read_b64_tr_b16 v[186:187], v10 offset:63488
v_mfma_f32_16x16x32_bf16 v[108:111], v[204:207], a[16:19], 0
s_add_u32 s82, s82, s74
buffer_load_dword v3, v2, s[44:47], s82 offen sc1
v_mfma_f32_16x16x32_bf16 v[108:111], v[220:223], a[20:23], v[108:111]
s_lshr_b32 s69, s15, 18
ds_read_b64_tr_b16 v[188:189], v11 offset:61440
ds_read_b64_tr_b16 v[190:191], v11 offset:63488
v_mfma_f32_16x16x32_bf16 v[108:111], v[236:239], a[24:27], v[108:111]
s_xor_b32 s71, s14, 0x100
v_mfma_f32_16x16x32_bf16 v[108:111], v[252:255], a[28:31], v[108:111]
s_add_u32 m0, s85, 49152
v_mfma_f32_16x16x32_bf16 v[92:95], v[252:255], a[12:15], 0
s_add_u32 s72, s71, 0
buffer_load_dwordx4 v15, s[24:27], s72 offen lds
v_xor_b32 v8, 0x10000, v8
v_mfma_f32_16x16x32_bf16 v[92:95], v[236:239], a[8:11], v[92:95]
s_lshl_b32 s69, s69, 12
v_xor_b32 v9, 0x10000, v9
v_mfma_f32_16x16x32_bf16 v[92:95], v[220:223], a[4:7], v[92:95]
s_waitcnt vmcnt(16) lgkmcnt(0)
v_xor_b32 v10, 0x10000, v10
v_mfma_f32_16x16x32_bf16 v[92:95], v[204:207], a[0:3], v[92:95]
s_barrier
v_xor_b32 v11, 0x10000, v11
v_mfma_f32_16x16x32_bf16 v[16:19], v[128:131], a[32:35], v[16:19]
s_add_u32 s69, s69, s95
buffer_load_dwordx4 a[96:99], v1, s[44:47], s69 offen sc1
v_mfma_f32_16x16x32_bf16 v[16:19], v[144:147], a[36:39], v[16:19]
s_nop 0
ds_read_b64_tr_b16 v[192:193], v8 offset:0
ds_read_b64_tr_b16 v[194:195], v8 offset:2048
v_mfma_f32_16x16x32_bf16 v[16:19], v[160:163], a[40:43], v[16:19]
s_nop 0
ds_read_b64_tr_b16 v[196:197], v9 offset:0
ds_read_b64_tr_b16 v[198:199], v9 offset:2048
v_mfma_f32_16x16x32_bf16 v[16:19], v[176:179], a[44:47], v[16:19]
s_nop 0
ds_read_b64_tr_b16 v[200:201], v10 offset:0
ds_read_b64_tr_b16 v[202:203], v10 offset:2048
v_mfma_f32_16x16x32_bf16 v[32:35], v[176:179], a[60:63], v[32:35]
s_add_u32 s72, s71, 15360
buffer_load_dwordx4 v15, s[24:27], s72 offen offset:1024 lds
v_mfma_f32_16x16x32_bf16 v[32:35], v[160:163], a[56:59], v[32:35]
s_nop 0
ds_read_b64_tr_b16 v[204:205], v11 offset:0
ds_read_b64_tr_b16 v[206:207], v11 offset:2048
v_mfma_f32_16x16x32_bf16 v[32:35], v[144:147], a[52:55], v[32:35]
v_or_b32 v112, s58, v0
v_mov_b32 v113, 3
v_mfma_f32_16x16x32_bf16 v[32:35], v[128:131], a[48:51], v[32:35]
s_nop 0
ds_read_b64_tr_b16 v[208:209], v8 offset:4096
ds_read_b64_tr_b16 v[210:211], v8 offset:6144
v_mfma_f32_16x16x32_bf16 v[36:39], v[132:135], a[48:51], v[36:39]
s_nop 0
ds_read_b64_tr_b16 v[212:213], v9 offset:4096
ds_read_b64_tr_b16 v[214:215], v9 offset:6144
v_mfma_f32_16x16x32_bf16 v[36:39], v[148:151], a[52:55], v[36:39]
buffer_load_dwordx4 a[100:103], v1, s[44:47], s69 offen offset:1024 sc1
v_mfma_f32_16x16x32_bf16 v[36:39], v[164:167], a[56:59], v[36:39]
s_nop 0
ds_read_b64_tr_b16 v[216:217], v10 offset:4096
ds_read_b64_tr_b16 v[218:219], v10 offset:6144
v_mfma_f32_16x16x32_bf16 v[36:39], v[180:183], a[60:63], v[36:39]
s_nop 0
ds_read_b64_tr_b16 v[220:221], v11 offset:4096
ds_read_b64_tr_b16 v[222:223], v11 offset:6144
v_mfma_f32_16x16x32_bf16 v[20:23], v[180:183], a[44:47], v[20:23]
v_min_u32 v112, 1, v112
v_lshlrev_b32 v112, 30, v112
v_mfma_f32_16x16x32_bf16 v[20:23], v[164:167], a[40:43], v[20:23]
s_add_u32 s72, s71, 30720
buffer_load_dwordx4 v15, s[24:27], s72 offen offset:2048 lds
v_mfma_f32_16x16x32_bf16 v[20:23], v[148:151], a[36:39], v[20:23]
s_nop 0
ds_read_b64_tr_b16 v[224:225], v8 offset:8192
ds_read_b64_tr_b16 v[226:227], v8 offset:10240
v_mfma_f32_16x16x32_bf16 v[20:23], v[132:135], a[32:35], v[20:23]
s_nop 0
ds_read_b64_tr_b16 v[228:229], v9 offset:8192
ds_read_b64_tr_b16 v[230:231], v9 offset:10240
v_mfma_f32_16x16x32_bf16 v[24:27], v[136:139], a[32:35], v[24:27]
s_nop 0
ds_read_b64_tr_b16 v[232:233], v10 offset:8192
ds_read_b64_tr_b16 v[234:235], v10 offset:10240
v_mfma_f32_16x16x32_bf16 v[24:27], v[152:155], a[36:39], v[24:27]
s_add_u32 s72, s71, 46080
buffer_load_dwordx4 v15, s[24:27], s72 offen offset:3072 lds
v_mfma_f32_16x16x32_bf16 v[24:27], v[168:171], a[40:43], v[24:27]
s_nop 0
ds_read_b64_tr_b16 v[236:237], v11 offset:8192
ds_read_b64_tr_b16 v[238:239], v11 offset:10240
v_mfma_f32_16x16x32_bf16 v[24:27], v[184:187], a[44:47], v[24:27]
buffer_store_dword v113, v112, s[44:47], s91 offen sc1
v_mfma_f32_16x16x32_bf16 v[40:43], v[184:187], a[60:63], v[40:43]
s_nop 0
ds_read_b64_tr_b16 v[240:241], v8 offset:12288
ds_read_b64_tr_b16 v[242:243], v8 offset:14336
v_mfma_f32_16x16x32_bf16 v[40:43], v[168:171], a[56:59], v[40:43]
buffer_load_dwordx4 a[104:107], v1, s[44:47], s69 offen offset:2048 sc1
v_mfma_f32_16x16x32_bf16 v[40:43], v[152:155], a[52:55], v[40:43]
s_nop 0
ds_read_b64_tr_b16 v[244:245], v9 offset:12288
ds_read_b64_tr_b16 v[246:247], v9 offset:14336
v_mfma_f32_16x16x32_bf16 v[40:43], v[136:139], a[48:51], v[40:43]
s_xor_b32 s71, s14, 0x180
ds_read_b64_tr_b16 v[248:249], v10 offset:12288
ds_read_b64_tr_b16 v[250:251], v10 offset:14336
v_mfma_f32_16x16x32_bf16 v[44:47], v[140:143], a[48:51], v[44:47]
s_add_u32 m0, s77, 0
ds_read_b64_tr_b16 v[252:253], v11 offset:12288
ds_read_b64_tr_b16 v[254:255], v11 offset:14336
v_mfma_f32_16x16x32_bf16 v[44:47], v[156:159], a[52:55], v[44:47]
s_add_u32 s72, s71, 0
buffer_load_dwordx4 v15, s[24:27], s72 offen lds
v_mfma_f32_16x16x32_bf16 v[44:47], v[172:175], a[56:59], v[44:47]
v_mfma_f32_16x16x32_bf16 v[44:47], v[188:191], a[60:63], v[44:47]
v_mfma_f32_16x16x32_bf16 v[28:31], v[188:191], a[44:47], v[28:31]
v_mfma_f32_16x16x32_bf16 v[28:31], v[172:175], a[40:43], v[28:31]
buffer_load_dwordx4 a[108:111], v1, s[44:47], s69 offen offset:3072 sc1
v_mfma_f32_16x16x32_bf16 v[28:31], v[156:159], a[36:39], v[28:31]
s_waitcnt vmcnt(18) lgkmcnt(0)
v_mfma_f32_16x16x32_bf16 v[28:31], v[140:143], a[32:35], v[28:31]
s_barrier
v_mfma_f32_16x16x32_bf16 v[48:51], v[192:195], a[32:35], v[48:51]
s_nop 0
ds_read_b64_tr_b16 v[128:129], v8 offset:16384
ds_read_b64_tr_b16 v[130:131], v8 offset:18432
v_mfma_f32_16x16x32_bf16 v[48:51], v[208:211], a[36:39], v[48:51]
s_add_u32 s72, s71, 15360
buffer_load_dwordx4 v15, s[24:27], s72 offen offset:1024 lds
v_mfma_f32_16x16x32_bf16 v[48:51], v[224:227], a[40:43], v[48:51]
s_nop 0
ds_read_b64_tr_b16 v[132:133], v9 offset:16384
ds_read_b64_tr_b16 v[134:135], v9 offset:18432
v_mfma_f32_16x16x32_bf16 v[48:51], v[240:243], a[44:47], v[48:51]
s_nop 0
ds_read_b64_tr_b16 v[136:137], v10 offset:16384
ds_read_b64_tr_b16 v[138:139], v10 offset:18432
v_mfma_f32_16x16x32_bf16 v[64:67], v[240:243], a[60:63], v[64:67]
s_nop 0
ds_read_b64_tr_b16 v[140:141], v11 offset:16384
ds_read_b64_tr_b16 v[142:143], v11 offset:18432
v_mfma_f32_16x16x32_bf16 v[64:67], v[224:227], a[56:59], v[64:67]
v_and_b32 v120, 15, v0
v_lshrrev_b32 v121, 4, v0
v_mfma_f32_16x16x32_bf16 v[64:67], v[208:211], a[52:55], v[64:67]
s_nop 0
ds_read_b64_tr_b16 v[144:145], v8 offset:20480
ds_read_b64_tr_b16 v[146:147], v8 offset:22528
v_mfma_f32_16x16x32_bf16 v[64:67], v[192:195], a[48:51], v[64:67]
s_add_u32 s69, s69, 0x20000
buffer_load_dwordx4 a[112:115], v1, s[44:47], s69 offen sc1
v_mfma_f32_16x16x32_bf16 v[68:71], v[196:199], a[48:51], v[68:71]
s_nop 0
ds_read_b64_tr_b16 v[148:149], v9 offset:20480
ds_read_b64_tr_b16 v[150:151], v9 offset:22528
v_mfma_f32_16x16x32_bf16 v[68:71], v[212:215], a[52:55], v[68:71]
s_nop 0
ds_read_b64_tr_b16 v[152:153], v10 offset:20480
ds_read_b64_tr_b16 v[154:155], v10 offset:22528
v_mfma_f32_16x16x32_bf16 v[68:71], v[228:231], a[56:59], v[68:71]
v_lshlrev_b32 v121, 2, v121
v_sub_u32 v120, v120, v121
v_mfma_f32_16x16x32_bf16 v[68:71], v[244:247], a[60:63], v[68:71]
s_add_u32 s72, s71, 30720
buffer_load_dwordx4 v15, s[24:27], s72 offen offset:2048 lds
v_mfma_f32_16x16x32_bf16 v[52:55], v[244:247], a[44:47], v[52:55]
s_nop 0
ds_read_b64_tr_b16 v[156:157], v11 offset:20480
ds_read_b64_tr_b16 v[158:159], v11 offset:22528
v_mfma_f32_16x16x32_bf16 v[52:55], v[228:231], a[40:43], v[52:55]
s_nop 0
ds_read_b64_tr_b16 v[160:161], v8 offset:24576
ds_read_b64_tr_b16 v[162:163], v8 offset:26624
v_mfma_f32_16x16x32_bf16 v[52:55], v[212:215], a[36:39], v[52:55]
s_nop 0
ds_read_b64_tr_b16 v[164:165], v9 offset:24576
ds_read_b64_tr_b16 v[166:167], v9 offset:26624
v_mfma_f32_16x16x32_bf16 v[52:55], v[196:199], a[32:35], v[52:55]
s_add_u32 s72, s71, 46080
buffer_load_dwordx4 v15, s[24:27], s72 offen offset:3072 lds
v_mfma_f32_16x16x32_bf16 v[56:59], v[200:203], a[32:35], v[56:59]
v_min_u32 v120, 4, v120
v_lshlrev_b32 v120, 3, v120
v_mfma_f32_16x16x32_bf16 v[56:59], v[216:219], a[36:39], v[56:59]
s_nop 0
ds_read_b64_tr_b16 v[168:169], v10 offset:24576
ds_read_b64_tr_b16 v[170:171], v10 offset:26624
v_mfma_f32_16x16x32_bf16 v[56:59], v[232:235], a[40:43], v[56:59]
s_nop 0
ds_read_b64_tr_b16 v[172:173], v11 offset:24576
ds_read_b64_tr_b16 v[174:175], v11 offset:26624
v_mfma_f32_16x16x32_bf16 v[56:59], v[248:251], a[44:47], v[56:59]
buffer_load_dwordx4 a[116:119], v1, s[44:47], s69 offen offset:1024 sc1
v_mfma_f32_16x16x32_bf16 v[72:75], v[248:251], a[60:63], v[72:75]
s_nop 0
ds_read_b64_tr_b16 v[176:177], v8 offset:28672
ds_read_b64_tr_b16 v[178:179], v8 offset:30720
v_mfma_f32_16x16x32_bf16 v[72:75], v[232:235], a[56:59], v[72:75]
s_xor_b32 s71, s15, 0x80
v_mov_b32 v122, 0x3f80
v_mov_b32 v123, 0
v_mfma_f32_16x16x32_bf16 v[72:75], v[216:219], a[52:55], v[72:75]
s_add_u32 m0, s77, 16384
ds_read_b64_tr_b16 v[180:181], v9 offset:28672
ds_read_b64_tr_b16 v[182:183], v9 offset:30720
v_mfma_f32_16x16x32_bf16 v[72:75], v[200:203], a[48:51], v[72:75]
s_add_u32 s72, s71, 0
buffer_load_dwordx4 v15, s[24:27], s72 offen lds
v_mfma_f32_16x16x32_bf16 v[76:79], v[204:207], a[48:51], v[76:79]
s_nop 0
ds_read_b64_tr_b16 v[184:185], v10 offset:28672
ds_read_b64_tr_b16 v[186:187], v10 offset:30720
v_mfma_f32_16x16x32_bf16 v[76:79], v[220:223], a[52:55], v[76:79]
s_nop 0
ds_read_b64_tr_b16 v[188:189], v11 offset:28672
ds_read_b64_tr_b16 v[190:191], v11 offset:30720
v_mfma_f32_16x16x32_bf16 v[76:79], v[236:239], a[56:59], v[76:79]
v_lshlrev_b64 v[122:123], v120, v[122:123]
v_mov_b32 v126, 0
v_mfma_f32_16x16x32_bf16 v[76:79], v[252:255], a[60:63], v[76:79]
buffer_load_dwordx4 a[120:123], v1, s[44:47], s69 offen offset:2048 sc1
v_mfma_f32_16x16x32_bf16 v[60:63], v[252:255], a[44:47], v[60:63]
v_lshlrev_b64 v[122:123], v120, v[122:123]
v_mov_b32 v127, 0
v_mfma_f32_16x16x32_bf16 v[60:63], v[236:239], a[40:43], v[60:63]
s_add_u32 s72, s71, 15360
v_mov_b32 v120, 0
v_mov_b32 v121, 0
v_mfma_f32_16x16x32_bf16 v[60:63], v[220:223], a[36:39], v[60:63]
s_waitcnt vmcnt(18) lgkmcnt(0)
v_mov_b32 v124, v122
v_mov_b32 v125, v123
v_mfma_f32_16x16x32_bf16 v[60:63], v[204:207], a[32:35], v[60:63]
s_barrier
buffer_load_dwordx4 v15, s[24:27], s72 offen offset:1024 lds
v_mfma_f32_16x16x32_bf16 v[80:83], v[128:131], a[32:35], v[80:83]
s_nop 0
ds_read_b64_tr_b16 v[192:193], v8 offset:32768
ds_read_b64_tr_b16 v[194:195], v8 offset:34816
v_mfma_f32_16x16x32_bf16 v[80:83], v[144:147], a[36:39], v[80:83]
s_nop 0
ds_read_b64_tr_b16 v[196:197], v9 offset:32768
ds_read_b64_tr_b16 v[198:199], v9 offset:34816
v_mfma_f32_16x16x32_bf16 v[80:83], v[160:163], a[40:43], v[80:83]
s_nop 0
ds_read_b64_tr_b16 v[200:201], v10 offset:32768
ds_read_b64_tr_b16 v[202:203], v10 offset:34816
v_mfma_f32_16x16x32_bf16 v[80:83], v[176:179], a[44:47], v[80:83]
s_nop 0
ds_read_b64_tr_b16 v[204:205], v11 offset:32768
ds_read_b64_tr_b16 v[206:207], v11 offset:34816
v_mfma_f32_16x16x32_bf16 v[96:99], v[176:179], a[60:63], v[96:99]
v_mfma_f32_16x16x32_bf16 v[96:99], v[160:163], a[56:59], v[96:99]
buffer_load_dwordx4 a[124:127], v1, s[44:47], s69 offen offset:3072 sc1
v_mfma_f32_16x16x32_bf16 v[96:99], v[144:147], a[52:55], v[96:99]
s_nop 0
ds_read_b64_tr_b16 v[208:209], v8 offset:36864
ds_read_b64_tr_b16 v[210:211], v8 offset:38912
v_mfma_f32_16x16x32_bf16 v[96:99], v[128:131], a[48:51], v[96:99]
s_nop 0
ds_read_b64_tr_b16 v[212:213], v9 offset:36864
ds_read_b64_tr_b16 v[214:215], v9 offset:38912
v_mfma_f32_16x16x32_bf16 v[100:103], v[132:135], a[48:51], v[100:103]
s_nop 0
ds_read_b64_tr_b16 v[216:217], v10 offset:36864
ds_read_b64_tr_b16 v[218:219], v10 offset:38912
v_mfma_f32_16x16x32_bf16 v[100:103], v[148:151], a[52:55], v[100:103]
s_add_u32 s72, s71, 30720
buffer_load_dwordx4 v15, s[24:27], s72 offen offset:2048 lds
v_mfma_f32_16x16x32_bf16 v[100:103], v[164:167], a[56:59], v[100:103]
Lstube0:
s_cbranch_execz Lstube4
v_mfma_f32_16x16x32_bf16 v[100:103], v[180:183], a[60:63], v[100:103]
s_nop 0
ds_read_b64_tr_b16 v[220:221], v11 offset:36864
ds_read_b64_tr_b16 v[222:223], v11 offset:38912
v_mfma_f32_16x16x32_bf16 v[84:87], v[180:183], a[44:47], v[84:87]
s_nop 0
ds_read_b64_tr_b16 v[224:225], v8 offset:40960
ds_read_b64_tr_b16 v[226:227], v8 offset:43008
v_mfma_f32_16x16x32_bf16 v[84:87], v[164:167], a[40:43], v[84:87]
s_add_u32 s72, s71, 46080
buffer_load_dwordx4 v15, s[24:27], s72 offen offset:3072 lds
v_mfma_f32_16x16x32_bf16 v[84:87], v[148:151], a[36:39], v[84:87]
s_nop 0
ds_read_b64_tr_b16 v[228:229], v9 offset:40960
ds_read_b64_tr_b16 v[230:231], v9 offset:43008
v_mfma_f32_16x16x32_bf16 v[84:87], v[132:135], a[32:35], v[84:87]
v_mfma_f32_16x16x32_bf16 v[88:91], v[136:139], a[32:35], v[88:91]
s_nop 0
ds_read_b64_tr_b16 v[232:233], v10 offset:40960
ds_read_b64_tr_b16 v[234:235], v10 offset:43008
v_mfma_f32_16x16x32_bf16 v[88:91], v[152:155], a[36:39], v[88:91]
s_waitcnt vmcnt(21)
v_cmp_gt_u32 vcc, 2, v3
s_cbranch_vccnz Lspin106
Lback107:
s_lshr_b32 s69, s12, 18
s_lshl_b32 s69, s69, 12
s_add_u32 s69, s69, s95
s_xor_b32 s69, s69, 0x1000
buffer_load_dwordx4 a[128:131], v1, s[44:47], s69 offen sc1
v_mfma_f32_16x16x32_bf16 v[88:91], v[168:171], a[40:43], v[88:91]
s_nop 0
ds_read_b64_tr_b16 v[236:237], v11 offset:40960
ds_read_b64_tr_b16 v[238:239], v11 offset:43008
v_mfma_f32_16x16x32_bf16 v[88:91], v[184:187], a[44:47], v[88:91]
s_xor_b32 s71, s15, 0x100
ds_read_b64_tr_b16 v[240:241], v8 offset:45056
ds_read_b64_tr_b16 v[242:243], v8 offset:47104
v_mfma_f32_16x16x32_bf16 v[104:107], v[184:187], a[60:63], v[104:107]
s_add_u32 m0, s77, 32768
v_mfma_f32_16x16x32_bf16 v[104:107], v[168:171], a[56:59], v[104:107]
s_add_u32 s72, s71, 0
buffer_load_dwordx4 v15, s[24:27], s72 offen lds
v_mfma_f32_16x16x32_bf16 v[104:107], v[152:155], a[52:55], v[104:107]
s_nop 0
ds_read_b64_tr_b16 v[244:245], v9 offset:45056
ds_read_b64_tr_b16 v[246:247], v9 offset:47104
v_mfma_f32_16x16x32_bf16 v[104:107], v[136:139], a[48:51], v[104:107]
s_nop 0
ds_read_b64_tr_b16 v[248:249], v10 offset:45056
ds_read_b64_tr_b16 v[250:251], v10 offset:47104
v_mfma_f32_16x16x32_bf16 v[108:111], v[140:143], a[48:51], v[108:111]
s_nop 0
ds_read_b64_tr_b16 v[252:253], v11 offset:45056
ds_read_b64_tr_b16 v[254:255], v11 offset:47104
v_mfma_f32_16x16x32_bf16 v[108:111], v[156:159], a[52:55], v[108:111]
buffer_load_dwordx4 a[132:135], v1, s[44:47], s69 offen offset:1024 sc1
v_mfma_f32_16x16x32_bf16 v[108:111], v[172:175], a[56:59], v[108:111]
v_mfma_f32_16x16x32_bf16 v[108:111], v[188:191], a[60:63], v[108:111]
v_mfma_f32_16x16x32_bf16 v[92:95], v[188:191], a[44:47], v[92:95]
v_mfma_f32_16x16x32_bf16 v[92:95], v[172:175], a[40:43], v[92:95]
s_add_u32 s72, s71, 15360
buffer_load_dwordx4 v15, s[24:27], s72 offen offset:1024 lds
v_mfma_f32_16x16x32_bf16 v[92:95], v[156:159], a[36:39], v[92:95]
s_waitcnt vmcnt(19) lgkmcnt(0)
v_mfma_f32_16x16x32_bf16 v[92:95], v[140:143], a[32:35], v[92:95]
s_barrier
v_mfma_f32_16x16x32_bf16 v[16:19], v[192:195], a[64:67], v[16:19]
s_nop 0
ds_read_b64_tr_b16 v[128:129], v8 offset:49152
ds_read_b64_tr_b16 v[130:131], v8 offset:51200
v_mfma_f32_16x16x32_bf16 v[16:19], v[208:211], a[68:71], v[16:19]
s_nop 0
ds_read_b64_tr_b16 v[132:133], v9 offset:49152
ds_read_b64_tr_b16 v[134:135], v9 offset:51200
v_mfma_f32_16x16x32_bf16 v[16:19], v[224:227], a[72:75], v[16:19]
s_nop 0
ds_read_b64_tr_b16 v[136:137], v10 offset:49152
ds_read_b64_tr_b16 v[138:139], v10 offset:51200
v_mfma_f32_16x16x32_bf16 v[16:19], v[240:243], a[76:79], v[16:19]
buffer_load_dwordx4 a[136:139], v1, s[44:47], s69 offen offset:2048 sc1
v_mfma_f32_16x16x32_bf16 v[32:35], v[240:243], a[92:95], v[32:35]
s_nop 0
ds_read_b64_tr_b16 v[140:141], v11 offset:49152
ds_read_b64_tr_b16 v[142:143], v11 offset:51200
v_mfma_f32_16x16x32_bf16 v[32:35], v[224:227], a[88:91], v[32:35]
v_mfma_f32_16x16x32_bf16 v[32:35], v[208:211], a[84:87], v[32:35]
s_nop 0
ds_read_b64_tr_b16 v[144:145], v8 offset:53248
ds_read_b64_tr_b16 v[146:147], v8 offset:55296
v_mfma_f32_16x16x32_bf16 v[32:35], v[192:195], a[80:83], v[32:35]
s_add_u32 s72, s71, 30720
buffer_load_dwordx4 v15, s[24:27], s72 offen offset:2048 lds
v_mfma_f32_16x16x32_bf16 v[36:39], v[196:199], a[80:83], v[36:39]
s_nop 0
ds_read_b64_tr_b16 v[148:149], v9 offset:53248
ds_read_b64_tr_b16 v[150:151], v9 offset:55296
v_mfma_f32_16x16x32_bf16 v[36:39], v[212:215], a[84:87], v[36:39]
s_nop 0
ds_read_b64_tr_b16 v[152:153], v10 offset:53248
ds_read_b64_tr_b16 v[154:155], v10 offset:55296
v_mfma_f32_16x16x32_bf16 v[36:39], v[228:231], a[88:91], v[36:39]
v_mfma_f32_16x16x32_bf16 v[36:39], v[244:247], a[92:95], v[36:39]
s_add_u32 s72, s71, 46080
buffer_load_dwordx4 v15, s[24:27], s72 offen offset:3072 lds
v_mfma_f32_16x16x32_bf16 v[20:23], v[244:247], a[76:79], v[20:23]
s_nop 0
ds_read_b64_tr_b16 v[156:157], v11 offset:53248
ds_read_b64_tr_b16 v[158:159], v11 offset:55296
v_mfma_f32_16x16x32_bf16 v[20:23], v[228:231], a[72:75], v[20:23]
s_nop 0
ds_read_b64_tr_b16 v[160:161], v8 offset:57344
ds_read_b64_tr_b16 v[162:163], v8 offset:59392
v_mfma_f32_16x16x32_bf16 v[20:23], v[212:215], a[68:71], v[20:23]
s_nop 0
ds_read_b64_tr_b16 v[164:165], v9 offset:57344
ds_read_b64_tr_b16 v[166:167], v9 offset:59392
v_mfma_f32_16x16x32_bf16 v[20:23], v[196:199], a[64:67], v[20:23]
buffer_load_dwordx4 a[140:143], v1, s[44:47], s69 offen offset:3072 sc1
v_mfma_f32_16x16x32_bf16 v[24:27], v[200:203], a[64:67], v[24:27]
v_mfma_f32_16x16x32_bf16 v[24:27], v[216:219], a[68:71], v[24:27]
s_xor_b32 s71, s15, 0x180
ds_read_b64_tr_b16 v[168:169], v10 offset:57344
ds_read_b64_tr_b16 v[170:171], v10 offset:59392
v_mfma_f32_16x16x32_bf16 v[24:27], v[232:235], a[72:75], v[24:27]
s_add_u32 m0, s77, 49152
ds_read_b64_tr_b16 v[172:173], v11 offset:57344
ds_read_b64_tr_b16 v[174:175], v11 offset:59392
v_mfma_f32_16x16x32_bf16 v[24:27], v[248:251], a[76:79], v[24:27]
s_add_u32 s72, s71, 0
buffer_load_dwordx4 v15, s[24:27], s72 offen lds
v_mfma_f32_16x16x32_bf16 v[40:43], v[248:251], a[92:95], v[40:43]
s_nop 0
ds_read_b64_tr_b16 v[176:177], v8 offset:61440
ds_read_b64_tr_b16 v[178:179], v8 offset:63488
v_mfma_f32_16x16x32_bf16 v[40:43], v[232:235], a[88:91], v[40:43]
v_mfma_f32_16x16x32_bf16 v[40:43], v[216:219], a[84:87], v[40:43]
s_nop 0
ds_read_b64_tr_b16 v[180:181], v9 offset:61440
ds_read_b64_tr_b16 v[182:183], v9 offset:63488
v_mfma_f32_16x16x32_bf16 v[40:43], v[200:203], a[80:83], v[40:43]
s_add_u32 s69, s69, 0x20000
buffer_load_dwordx4 a[144:147], v1, s[44:47], s69 offen sc1
v_mfma_f32_16x16x32_bf16 v[44:47], v[204:207], a[80:83], v[44:47]
s_nop 0
ds_read_b64_tr_b16 v[184:185], v10 offset:61440
ds_read_b64_tr_b16 v[186:187], v10 offset:63488
v_mfma_f32_16x16x32_bf16 v[44:47], v[220:223], a[84:87], v[44:47]
s_nop 0
ds_read_b64_tr_b16 v[188:189], v11 offset:61440
ds_read_b64_tr_b16 v[190:191], v11 offset:63488
v_mfma_f32_16x16x32_bf16 v[44:47], v[236:239], a[88:91], v[44:47]
v_mfma_f32_16x16x32_bf16 v[44:47], v[252:255], a[92:95], v[44:47]
s_add_u32 s72, s71, 15360
buffer_load_dwordx4 v15, s[24:27], s72 offen offset:1024 lds
v_mfma_f32_16x16x32_bf16 v[28:31], v[252:255], a[76:79], v[28:31]
v_xor_b32 v8, 0x10000, v8
v_mfma_f32_16x16x32_bf16 v[28:31], v[236:239], a[72:75], v[28:31]
v_xor_b32 v9, 0x10000, v9
v_mfma_f32_16x16x32_bf16 v[28:31], v[220:223], a[68:71], v[28:31]
s_waitcnt vmcnt(18) lgkmcnt(0)
v_xor_b32 v10, 0x10000, v10
v_mfma_f32_16x16x32_bf16 v[28:31], v[204:207], a[64:67], v[28:31]
s_barrier
v_xor_b32 v11, 0x10000, v11
v_mfma_f32_16x16x32_bf16 v[48:51], v[128:131], a[64:67], v[48:51]
s_nop 0
ds_read_b64_tr_b16 v[192:193], v8 offset:0
ds_read_b64_tr_b16 v[194:195], v8 offset:2048
v_mfma_f32_16x16x32_bf16 v[48:51], v[144:147], a[68:71], v[48:51]
s_add_u32 s72, s71, 30720
buffer_load_dwordx4 v15, s[24:27], s72 offen offset:2048 lds
v_mfma_f32_16x16x32_bf16 v[48:51], v[160:163], a[72:75], v[48:51]
s_nop 0
ds_read_b64_tr_b16 v[196:197], v9 offset:0
ds_read_b64_tr_b16 v[198:199], v9 offset:2048
v_mfma_f32_16x16x32_bf16 v[48:51], v[176:179], a[76:79], v[48:51]
s_nop 0
ds_read_b64_tr_b16 v[200:201], v10 offset:0
ds_read_b64_tr_b16 v[202:203], v10 offset:2048
v_mfma_f32_16x16x32_bf16 v[64:67], v[176:179], a[92:95], v[64:67]
s_nop 0
ds_read_b64_tr_b16 v[204:205], v11 offset:0
ds_read_b64_tr_b16 v[206:207], v11 offset:2048
v_mfma_f32_16x16x32_bf16 v[64:67], v[160:163], a[88:91], v[64:67]
buffer_load_dwordx4 a[148:151], v1, s[44:47], s69 offen offset:1024 sc1
v_mfma_f32_16x16x32_bf16 v[64:67], v[144:147], a[84:87], v[64:67]
v_mfma_f32_16x16x32_bf16 v[64:67], v[128:131], a[80:83], v[64:67]
s_nop 0
ds_read_b64_tr_b16 v[208:209], v8 offset:4096
ds_read_b64_tr_b16 v[210:211], v8 offset:6144
v_mfma_f32_16x16x32_bf16 v[68:71], v[132:135], a[80:83], v[68:71]
s_nop 0
ds_read_b64_tr_b16 v[212:213], v9 offset:4096
ds_read_b64_tr_b16 v[214:215], v9 offset:6144
v_mfma_f32_16x16x32_bf16 v[68:71], v[148:151], a[84:87], v[68:71]
s_add_u32 s72, s71, 46080
buffer_load_dwordx4 v15, s[24:27], s72 offen offset:3072 lds
v_mfma_f32_16x16x32_bf16 v[68:71], v[164:167], a[88:91], v[68:71]
s_nop 0
ds_read_b64_tr_b16 v[216:217], v10 offset:4096
ds_read_b64_tr_b16 v[218:219], v10 offset:6144
v_mfma_f32_16x16x32_bf16 v[68:71], v[180:183], a[92:95], v[68:71]
s_nop 0
ds_read_b64_tr_b16 v[220:221], v11 offset:4096
ds_read_b64_tr_b16 v[222:223], v11 offset:6144
v_mfma_f32_16x16x32_bf16 v[52:55], v[180:183], a[76:79], v[52:55]
v_mfma_f32_16x16x32_bf16 v[52:55], v[164:167], a[72:75], v[52:55]
buffer_load_dwordx4 a[152:155], v1, s[44:47], s69 offen offset:2048 sc1
v_mfma_f32_16x16x32_bf16 v[52:55], v[148:151], a[68:71], v[52:55]
s_nop 0
ds_read_b64_tr_b16 v[224:225], v8 offset:8192
ds_read_b64_tr_b16 v[226:227], v8 offset:10240
v_mfma_f32_16x16x32_bf16 v[52:55], v[132:135], a[64:67], v[52:55]
s_xor_b32 s71, s12, 0x40080
ds_read_b64_tr_b16 v[228:229], v9 offset:8192
ds_read_b64_tr_b16 v[230:231], v9 offset:10240
v_mfma_f32_16x16x32_bf16 v[56:59], v[136:139], a[64:67], v[56:59]
s_add_u32 m0, s85, 0
ds_read_b64_tr_b16 v[232:233], v10 offset:8192
ds_read_b64_tr_b16 v[234:235], v10 offset:10240
v_mfma_f32_16x16x32_bf16 v[56:59], v[152:155], a[68:71], v[56:59]
s_add_u32 s72, s71, 0
buffer_load_dwordx4 v15, s[24:27], s72 offen lds
v_mfma_f32_16x16x32_bf16 v[56:59], v[168:171], a[72:75], v[56:59]
s_nop 0
ds_read_b64_tr_b16 v[236:237], v11 offset:8192
ds_read_b64_tr_b16 v[238:239], v11 offset:10240
v_mfma_f32_16x16x32_bf16 v[56:59], v[184:187], a[76:79], v[56:59]
v_mfma_f32_16x16x32_bf16 v[72:75], v[184:187], a[92:95], v[72:75]
s_nop 0
ds_read_b64_tr_b16 v[240:241], v8 offset:12288
ds_read_b64_tr_b16 v[242:243], v8 offset:14336
v_mfma_f32_16x16x32_bf16 v[72:75], v[168:171], a[88:91], v[72:75]
buffer_load_dwordx4 a[156:159], v1, s[44:47], s69 offen offset:3072 sc1
v_mfma_f32_16x16x32_bf16 v[72:75], v[152:155], a[84:87], v[72:75]
s_nop 0
ds_read_b64_tr_b16 v[244:245], v9 offset:12288
ds_read_b64_tr_b16 v[246:247], v9 offset:14336
v_mfma_f32_16x16x32_bf16 v[72:75], v[136:139], a[80:83], v[72:75]
s_nop 0
ds_read_b64_tr_b16 v[248:249], v10 offset:12288
ds_read_b64_tr_b16 v[250:251], v10 offset:14336
v_mfma_f32_16x16x32_bf16 v[76:79], v[140:143], a[80:83], v[76:79]
s_nop 0
ds_read_b64_tr_b16 v[252:253], v11 offset:12288
ds_read_b64_tr_b16 v[254:255], v11 offset:14336
v_mfma_f32_16x16x32_bf16 v[76:79], v[156:159], a[84:87], v[76:79]
s_add_u32 s72, s71, 15360
buffer_load_dwordx4 v15, s[24:27], s72 offen offset:1024 lds
v_mfma_f32_16x16x32_bf16 v[76:79], v[172:175], a[88:91], v[76:79]
s_lshr_b32 s69, s13, 18
v_mfma_f32_16x16x32_bf16 v[76:79], v[188:191], a[92:95], v[76:79]
s_lshl_b32 s69, s69, 12
v_mfma_f32_16x16x32_bf16 v[60:63], v[188:191], a[76:79], v[60:63]
s_add_u32 s69, s69, s95
v_mfma_f32_16x16x32_bf16 v[60:63], v[172:175], a[72:75], v[60:63]
s_xor_b32 s69, s69, 0x1000
v_mfma_f32_16x16x32_bf16 v[60:63], v[156:159], a[68:71], v[60:63]
s_waitcnt vmcnt(11) lgkmcnt(0)
buffer_load_dwordx4 a[160:163], v1, s[44:47], s69 offen sc1
v_mfma_f32_16x16x32_bf16 v[60:63], v[140:143], a[64:67], v[60:63]
s_barrier
v_mfma_f32_16x16x32_bf16 v[80:83], v[192:195], a[64:67], v[80:83]
s_and_b32 s79, s91, 0xffff9fff
v_lshrrev_b32 v13, 4, v0
v_lshlrev_b32 v13, 13, v13
buffer_load_dword v14, v13, s[44:47], s79 offen sc1
v_mfma_f32_16x16x32_bf16 v[80:83], v[208:211], a[68:71], v[80:83]
s_nop 0
ds_read_b64_tr_b16 v[128:129], v8 offset:16384
ds_read_b64_tr_b16 v[130:131], v8 offset:18432
v_mfma_f32_16x16x32_bf16 v[80:83], v[224:227], a[72:75], v[80:83]
s_add_u32 s72, s71, 30720
buffer_load_dwordx4 v15, s[24:27], s72 offen offset:2048 lds
v_mfma_f32_16x16x32_bf16 v[80:83], v[240:243], a[76:79], v[80:83]
s_nop 0
ds_read_b64_tr_b16 v[132:133], v9 offset:16384
ds_read_b64_tr_b16 v[134:135], v9 offset:18432
v_mfma_f32_16x16x32_bf16 v[96:99], v[240:243], a[92:95], v[96:99]
s_nop 0
ds_read_b64_tr_b16 v[136:137], v10 offset:16384
ds_read_b64_tr_b16 v[138:139], v10 offset:18432
v_mfma_f32_16x16x32_bf16 v[96:99], v[224:227], a[88:91], v[96:99]
s_nop 0
ds_read_b64_tr_b16 v[140:141], v11 offset:16384
ds_read_b64_tr_b16 v[142:143], v11 offset:18432
v_mfma_f32_16x16x32_bf16 v[96:99], v[208:211], a[84:87], v[96:99]
s_add_u32 s72, s71, 46080
buffer_load_dwordx4 v15, s[24:27], s72 offen offset:3072 lds
v_mfma_f32_16x16x32_bf16 v[96:99], v[192:195], a[80:83], v[96:99]
v_mfma_f32_16x16x32_bf16 v[100:103], v[196:199], a[80:83], v[100:103]
s_nop 0
ds_read_b64_tr_b16 v[144:145], v8 offset:20480
ds_read_b64_tr_b16 v[146:147], v8 offset:22528
v_mfma_f32_16x16x32_bf16 v[100:103], v[212:215], a[84:87], v[100:103]
s_nop 0
ds_read_b64_tr_b16 v[148:149], v9 offset:20480
ds_read_b64_tr_b16 v[150:151], v9 offset:22528
v_mfma_f32_16x16x32_bf16 v[100:103], v[228:231], a[88:91], v[100:103]
buffer_load_dwordx4 a[164:167], v1, s[44:47], s69 offen offset:1024 sc1
v_mfma_f32_16x16x32_bf16 v[100:103], v[244:247], a[92:95], v[100:103]
s_nop 0
ds_read_b64_tr_b16 v[152:153], v10 offset:20480
ds_read_b64_tr_b16 v[154:155], v10 offset:22528
v_mfma_f32_16x16x32_bf16 v[84:87], v[244:247], a[76:79], v[84:87]
s_xor_b32 s71, s12, 0x40100
ds_read_b64_tr_b16 v[156:157], v11 offset:20480
ds_read_b64_tr_b16 v[158:159], v11 offset:22528
v_mfma_f32_16x16x32_bf16 v[84:87], v[228:231], a[72:75], v[84:87]
s_add_u32 m0, s85, 16384
v_mfma_f32_16x16x32_bf16 v[84:87], v[212:215], a[68:71], v[84:87]
s_add_u32 s72, s71, 0
buffer_load_dwordx4 v15, s[24:27], s72 offen lds
v_mfma_f32_16x16x32_bf16 v[84:87], v[196:199], a[64:67], v[84:87]
s_nop 0
ds_read_b64_tr_b16 v[160:161], v8 offset:24576
ds_read_b64_tr_b16 v[162:163], v8 offset:26624
v_mfma_f32_16x16x32_bf16 v[88:91], v[200:203], a[64:67], v[88:91]
s_nop 0
ds_read_b64_tr_b16 v[164:165], v9 offset:24576
ds_read_b64_tr_b16 v[166:167], v9 offset:26624
v_mfma_f32_16x16x32_bf16 v[88:91], v[216:219], a[68:71], v[88:91]
s_nop 0
ds_read_b64_tr_b16 v[168:169], v10 offset:24576
ds_read_b64_tr_b16 v[170:171], v10 offset:26624
v_mfma_f32_16x16x32_bf16 v[88:91], v[232:235], a[72:75], v[88:91]
buffer_load_dwordx4 a[168:171], v1, s[44:47], s69 offen offset:2048 sc1
v_mfma_f32_16x16x32_bf16 v[88:91], v[248:251], a[76:79], v[88:91]
s_nop 0
ds_read_b64_tr_b16 v[172:173], v11 offset:24576
ds_read_b64_tr_b16 v[174:175], v11 offset:26624
v_mfma_f32_16x16x32_bf16 v[104:107], v[248:251], a[92:95], v[104:107]
v_mfma_f32_16x16x32_bf16 v[104:107], v[232:235], a[88:91], v[104:107]
s_nop 0
ds_read_b64_tr_b16 v[176:177], v8 offset:28672
ds_read_b64_tr_b16 v[178:179], v8 offset:30720
v_mfma_f32_16x16x32_bf16 v[104:107], v[216:219], a[84:87], v[104:107]
s_add_u32 s72, s71, 15360
buffer_load_dwordx4 v15, s[24:27], s72 offen offset:1024 lds
v_mfma_f32_16x16x32_bf16 v[104:107], v[200:203], a[80:83], v[104:107]
s_nop 0
ds_read_b64_tr_b16 v[180:181], v9 offset:28672
ds_read_b64_tr_b16 v[182:183], v9 offset:30720
v_mfma_f32_16x16x32_bf16 v[108:111], v[204:207], a[80:83], v[108:111]
s_nop 0
ds_read_b64_tr_b16 v[184:185], v10 offset:28672
ds_read_b64_tr_b16 v[186:187], v10 offset:30720
v_mfma_f32_16x16x32_bf16 v[108:111], v[220:223], a[84:87], v[108:111]
s_nop 0
ds_read_b64_tr_b16 v[188:189], v11 offset:28672
ds_read_b64_tr_b16 v[190:191], v11 offset:30720
v_mfma_f32_16x16x32_bf16 v[108:111], v[236:239], a[88:91], v[108:111]
v_mfma_f32_16x16x32_bf16 v[108:111], v[252:255], a[92:95], v[108:111]
v_mfma_f32_16x16x32_bf16 v[92:95], v[252:255], a[76:79], v[92:95]
buffer_load_dwordx4 a[172:175], v1, s[44:47], s69 offen offset:3072 sc1
v_mfma_f32_16x16x32_bf16 v[92:95], v[236:239], a[72:75], v[92:95]
v_mfma_f32_16x16x32_bf16 v[92:95], v[220:223], a[68:71], v[92:95]
s_waitcnt vmcnt(29) lgkmcnt(0)
v_mfma_f32_16x16x32_bf16 v[92:95], v[204:207], a[64:67], v[92:95]
v_mfma_f32_16x16x32_bf16 v[16:19], v[128:131], a[96:99], v[16:19]
s_add_u32 s72, s71, 30720
buffer_load_dwordx4 v15, s[24:27], s72 offen offset:2048 lds
v_mfma_f32_16x16x32_bf16 v[16:19], v[144:147], a[100:103], v[16:19]
s_nop 0
ds_read_b64_tr_b16 v[192:193], v8 offset:32768
ds_read_b64_tr_b16 v[194:195], v8 offset:34816
v_mfma_f32_16x16x32_bf16 v[16:19], v[160:163], a[104:107], v[16:19]
s_nop 0
ds_read_b64_tr_b16 v[196:197], v9 offset:32768
ds_read_b64_tr_b16 v[198:199], v9 offset:34816
v_mfma_f32_16x16x32_bf16 v[16:19], v[176:179], a[108:111], v[16:19]
s_nop 0
ds_read_b64_tr_b16 v[200:201], v10 offset:32768
ds_read_b64_tr_b16 v[202:203], v10 offset:34816
v_mfma_f32_16x16x32_bf16 v[32:35], v[176:179], a[124:127], v[32:35]
s_add_u32 s72, s71, 46080
buffer_load_dwordx4 v15, s[24:27], s72 offen offset:3072 lds
v_mfma_f32_16x16x32_bf16 v[32:35], v[160:163], a[120:123], v[32:35]
s_nop 0
ds_read_b64_tr_b16 v[204:205], v11 offset:32768
ds_read_b64_tr_b16 v[206:207], v11 offset:34816
v_mfma_f32_16x16x32_bf16 v[32:35], v[144:147], a[116:119], v[32:35]
v_mfma_f32_16x16x32_bf16 v[32:35], v[128:131], a[112:115], v[32:35]
s_nop 0
ds_read_b64_tr_b16 v[208:209], v8 offset:36864
ds_read_b64_tr_b16 v[210:211], v8 offset:38912
v_mfma_f32_16x16x32_bf16 v[36:39], v[132:135], a[112:115], v[36:39]
s_add_u32 s69, s69, 0x20000
buffer_load_dwordx4 a[176:179], v1, s[44:47], s69 offen sc1
v_mfma_f32_16x16x32_bf16 v[36:39], v[148:151], a[116:119], v[36:39]
s_nop 0
ds_read_b64_tr_b16 v[212:213], v9 offset:36864
ds_read_b64_tr_b16 v[214:215], v9 offset:38912
v_mfma_f32_16x16x32_bf16 v[36:39], v[164:167], a[120:123], v[36:39]
s_xor_b32 s71, s12, 0x40180
ds_read_b64_tr_b16 v[216:217], v10 offset:36864
ds_read_b64_tr_b16 v[218:219], v10 offset:38912
v_mfma_f32_16x16x32_bf16 v[36:39], v[180:183], a[124:127], v[36:39]
s_add_u32 m0, s85, 32768
ds_read_b64_tr_b16 v[220:221], v11 offset:36864
ds_read_b64_tr_b16 v[222:223], v11 offset:38912
v_mfma_f32_16x16x32_bf16 v[20:23], v[180:183], a[108:111], v[20:23]
s_add_u32 s72, s71, 0
buffer_load_dwordx4 v15, s[24:27], s72 offen lds
v_mfma_f32_16x16x32_bf16 v[20:23], v[164:167], a[104:107], v[20:23]
v_mfma_f32_16x16x32_bf16 v[20:23], v[148:151], a[100:103], v[20:23]
s_nop 0
ds_read_b64_tr_b16 v[224:225], v8 offset:40960
ds_read_b64_tr_b16 v[226:227], v8 offset:43008
v_mfma_f32_16x16x32_bf16 v[20:23], v[132:135], a[96:99], v[20:23]
s_nop 0
ds_read_b64_tr_b16 v[228:229], v9 offset:40960
ds_read_b64_tr_b16 v[230:231], v9 offset:43008
v_mfma_f32_16x16x32_bf16 v[24:27], v[136:139], a[96:99], v[24:27]
buffer_load_dwordx4 a[180:183], v1, s[44:47], s69 offen offset:1024 sc1
v_mfma_f32_16x16x32_bf16 v[24:27], v[152:155], a[100:103], v[24:27]
s_nop 0
ds_read_b64_tr_b16 v[232:233], v10 offset:40960
ds_read_b64_tr_b16 v[234:235], v10 offset:43008
v_mfma_f32_16x16x32_bf16 v[24:27], v[168:171], a[104:107], v[24:27]
s_nop 0
ds_read_b64_tr_b16 v[236:237], v11 offset:40960
ds_read_b64_tr_b16 v[238:239], v11 offset:43008
v_mfma_f32_16x16x32_bf16 v[24:27], v[184:187], a[108:111], v[24:27]
v_mfma_f32_16x16x32_bf16 v[40:43], v[184:187], a[124:127], v[40:43]
s_add_u32 s72, s71, 15360
buffer_load_dwordx4 v15, s[24:27], s72 offen offset:1024 lds
v_mfma_f32_16x16x32_bf16 v[40:43], v[168:171], a[120:123], v[40:43]
s_nop 0
ds_read_b64_tr_b16 v[240:241], v8 offset:45056
ds_read_b64_tr_b16 v[242:243], v8 offset:47104
v_mfma_f32_16x16x32_bf16 v[40:43], v[152:155], a[116:119], v[40:43]
s_nop 0
ds_read_b64_tr_b16 v[244:245], v9 offset:45056
ds_read_b64_tr_b16 v[246:247], v9 offset:47104
v_mfma_f32_16x16x32_bf16 v[40:43], v[136:139], a[112:115], v[40:43]
s_nop 0
ds_read_b64_tr_b16 v[248:249], v10 offset:45056
ds_read_b64_tr_b16 v[250:251], v10 offset:47104
v_mfma_f32_16x16x32_bf16 v[44:47], v[140:143], a[112:115], v[44:47]
s_nop 0
ds_read_b64_tr_b16 v[252:253], v11 offset:45056
ds_read_b64_tr_b16 v[254:255], v11 offset:47104
v_mfma_f32_16x16x32_bf16 v[44:47], v[156:159], a[116:119], v[44:47]
v_mfma_f32_16x16x32_bf16 v[44:47], v[172:175], a[120:123], v[44:47]
s_add_u32 s72, s71, 30720
buffer_load_dwordx4 v15, s[24:27], s72 offen offset:2048 lds
v_mfma_f32_16x16x32_bf16 v[44:47], v[188:191], a[124:127], v[44:47]
v_mfma_f32_16x16x32_bf16 v[28:31], v[188:191], a[108:111], v[28:31]
v_mfma_f32_16x16x32_bf16 v[28:31], v[172:175], a[104:107], v[28:31]
v_mfma_f32_16x16x32_bf16 v[28:31], v[156:159], a[100:103], v[28:31]
s_waitcnt vmcnt(12) lgkmcnt(0)
buffer_load_dwordx4 a[184:187], v1, s[44:47], s69 offen offset:2048 sc1
v_mfma_f32_16x16x32_bf16 v[28:31], v[140:143], a[96:99], v[28:31]
s_barrier
v_mfma_f32_16x16x32_bf16 v[48:51], v[192:195], a[96:99], v[48:51]
s_nop 0
ds_read_b64_tr_b16 v[128:129], v8 offset:49152
ds_read_b64_tr_b16 v[130:131], v8 offset:51200
v_mfma_f32_16x16x32_bf16 v[48:51], v[208:211], a[100:103], v[48:51]
s_nop 0
ds_read_b64_tr_b16 v[132:133], v9 offset:49152
ds_read_b64_tr_b16 v[134:135], v9 offset:51200
v_mfma_f32_16x16x32_bf16 v[48:51], v[224:227], a[104:107], v[48:51]
s_add_u32 s72, s71, 46080
buffer_load_dwordx4 v15, s[24:27], s72 offen offset:3072 lds
v_mfma_f32_16x16x32_bf16 v[48:51], v[240:243], a[108:111], v[48:51]
s_nop 0
ds_read_b64_tr_b16 v[136:137], v10 offset:49152
ds_read_b64_tr_b16 v[138:139], v10 offset:51200
v_mfma_f32_16x16x32_bf16 v[64:67], v[240:243], a[124:127], v[64:67]
s_nop 0
ds_read_b64_tr_b16 v[140:141], v11 offset:49152
ds_read_b64_tr_b16 v[142:143], v11 offset:51200
v_mfma_f32_16x16x32_bf16 v[64:67], v[224:227], a[120:123], v[64:67]
v_mfma_f32_16x16x32_bf16 v[64:67], v[208:211], a[116:119], v[64:67]
buffer_load_dwordx4 a[188:191], v1, s[44:47], s69 offen offset:3072 sc1
v_mfma_f32_16x16x32_bf16 v[64:67], v[192:195], a[112:115], v[64:67]
s_nop 0
ds_read_b64_tr_b16 v[144:145], v8 offset:53248
ds_read_b64_tr_b16 v[146:147], v8 offset:55296
v_mfma_f32_16x16x32_bf16 v[68:71], v[196:199], a[112:115], v[68:71]
s_xor_b32 s71, s13, 0x40080
ds_read_b64_tr_b16 v[148:149], v9 offset:53248
ds_read_b64_tr_b16 v[150:151], v9 offset:55296
v_mfma_f32_16x16x32_bf16 v[68:71], v[212:215], a[116:119], v[68:71]
s_add_u32 m0, s85, 49152
ds_read_b64_tr_b16 v[152:153], v10 offset:53248
ds_read_b64_tr_b16 v[154:155], v10 offset:55296
v_mfma_f32_16x16x32_bf16 v[68:71], v[228:231], a[120:123], v[68:71]
s_add_u32 s72, s71, 0
buffer_load_dwordx4 v15, s[24:27], s72 offen lds
v_mfma_f32_16x16x32_bf16 v[68:71], v[244:247], a[124:127], v[68:71]
s_lshr_b32 s69, s14, 18
ds_read_b64_tr_b16 v[156:157], v11 offset:53248
ds_read_b64_tr_b16 v[158:159], v11 offset:55296
v_mfma_f32_16x16x32_bf16 v[52:55], v[244:247], a[108:111], v[52:55]
s_lshl_b32 s69, s69, 12
v_mfma_f32_16x16x32_bf16 v[52:55], v[228:231], a[104:107], v[52:55]
s_add_u32 s69, s69, s95
ds_read_b64_tr_b16 v[160:161], v8 offset:57344
ds_read_b64_tr_b16 v[162:163], v8 offset:59392
v_mfma_f32_16x16x32_bf16 v[52:55], v[212:215], a[100:103], v[52:55]
s_xor_b32 s69, s69, 0x1000
buffer_load_dwordx4 a[192:195], v1, s[44:47], s69 offen sc1
v_mfma_f32_16x16x32_bf16 v[52:55], v[196:199], a[96:99], v[52:55]
s_nop 0
ds_read_b64_tr_b16 v[164:165], v9 offset:57344
ds_read_b64_tr_b16 v[166:167], v9 offset:59392
v_mfma_f32_16x16x32_bf16 v[56:59], v[200:203], a[96:99], v[56:59]
s_waitcnt vmcnt(19)
v_cmp_gt_u32 vcc, 2, v14
s_cbranch_vccnz Lspin112
Lback113:
v_mfma_f32_16x16x32_bf16 v[56:59], v[216:219], a[100:103], v[56:59]
s_nop 0
ds_read_b64_tr_b16 v[168:169], v10 offset:57344
ds_read_b64_tr_b16 v[170:171], v10 offset:59392
v_mfma_f32_16x16x32_bf16 v[56:59], v[232:235], a[104:107], v[56:59]
s_add_u32 s72, s71, 15360
buffer_load_dwordx4 v15, s[24:27], s72 offen offset:1024 lds
v_mfma_f32_16x16x32_bf16 v[56:59], v[248:251], a[108:111], v[56:59]
s_nop 0
ds_read_b64_tr_b16 v[172:173], v11 offset:57344
ds_read_b64_tr_b16 v[174:175], v11 offset:59392
v_mfma_f32_16x16x32_bf16 v[72:75], v[248:251], a[124:127], v[72:75]
v_mfma_f32_16x16x32_bf16 v[72:75], v[232:235], a[120:123], v[72:75]
s_nop 0
ds_read_b64_tr_b16 v[176:177], v8 offset:61440
ds_read_b64_tr_b16 v[178:179], v8 offset:63488
v_mfma_f32_16x16x32_bf16 v[72:75], v[216:219], a[116:119], v[72:75]
s_nop 0
ds_read_b64_tr_b16 v[180:181], v9 offset:61440
ds_read_b64_tr_b16 v[182:183], v9 offset:63488
v_mfma_f32_16x16x32_bf16 v[72:75], v[200:203], a[112:115], v[72:75]
s_nop 0
ds_read_b64_tr_b16 v[184:185], v10 offset:61440
ds_read_b64_tr_b16 v[186:187], v10 offset:63488
v_mfma_f32_16x16x32_bf16 v[76:79], v[204:207], a[112:115], v[76:79]
s_add_u32 s72, s71, 30720
buffer_load_dwordx4 v15, s[24:27], s72 offen offset:2048 lds
v_mfma_f32_16x16x32_bf16 v[76:79], v[220:223], a[116:119], v[76:79]
s_nop 0
ds_read_b64_tr_b16 v[188:189], v11 offset:61440
ds_read_b64_tr_b16 v[190:191], v11 offset:63488
v_mfma_f32_16x16x32_bf16 v[76:79], v[236:239], a[120:123], v[76:79]
v_mfma_f32_16x16x32_bf16 v[76:79], v[252:255], a[124:127], v[76:79]
v_mfma_f32_16x16x32_bf16 v[60:63], v[252:255], a[108:111], v[60:63]
s_nop 0
buffer_load_dwordx4 a[196:199], v1, s[44:47], s69 offen offset:1024 sc1
v_xor_b32 v8, 0x10000, v8
v_mfma_f32_16x16x32_bf16 v[60:63], v[236:239], a[104:107], v[60:63]
v_xor_b32 v9, 0x10000, v9
v_mfma_f32_16x16x32_bf16 v[60:63], v[220:223], a[100:103], v[60:63]
s_waitcnt lgkmcnt(0)
v_xor_b32 v10, 0x10000, v10
v_mfma_f32_16x16x32_bf16 v[60:63], v[204:207], a[96:99], v[60:63]
v_xor_b32 v11, 0x10000, v11
v_mfma_f32_16x16x32_bf16 v[80:83], v[128:131], a[96:99], v[80:83]
s_add_u32 s72, s71, 46080
buffer_load_dwordx4 v15, s[24:27], s72 offen offset:3072 lds
v_mfma_f32_16x16x32_bf16 v[80:83], v[144:147], a[100:103], v[80:83]
s_lshl_b32 s84, s76, 11
ds_read_b64_tr_b16 v[192:193], v8 offset:0
ds_read_b64_tr_b16 v[194:195], v8 offset:2048
v_mfma_f32_16x16x32_bf16 v[80:83], v[160:163], a[104:107], v[80:83]
s_add_u32 s84, s84, 0x3810000
ds_read_b64_tr_b16 v[196:197], v9 offset:0
ds_read_b64_tr_b16 v[198:199], v9 offset:2048
v_mfma_f32_16x16x32_bf16 v[80:83], v[176:179], a[108:111], v[80:83]
s_nop 0
ds_read_b64_tr_b16 v[200:201], v10 offset:0
Lstube1:
s_cbranch_execz Lrete
ds_read_b64_tr_b16 v[202:203], v10 offset:2048
v_mfma_f32_16x16x32_bf16 v[96:99], v[176:179], a[124:127], v[96:99]
buffer_load_dwordx4 a[200:203], v1, s[44:47], s69 offen offset:2048 sc1
v_mfma_f32_16x16x32_bf16 v[96:99], v[160:163], a[120:123], v[96:99]
s_nop 0
ds_read_b64_tr_b16 v[204:205], v11 offset:0
ds_read_b64_tr_b16 v[206:207], v11 offset:2048
v_mfma_f32_16x16x32_bf16 v[96:99], v[144:147], a[116:119], v[96:99]
s_xor_b32 s71, s14, 0x40080
v_lshrrev_b32 v115, 2, v0
v_lshlrev_b32 v115, 7, v115
v_mfma_f32_16x16x32_bf16 v[96:99], v[128:131], a[112:115], v[96:99]
s_add_u32 m0, s77, 0
ds_read_b64_tr_b16 v[208:209], v8 offset:4096
ds_read_b64_tr_b16 v[210:211], v8 offset:6144
v_mfma_f32_16x16x32_bf16 v[100:103], v[132:135], a[112:115], v[100:103]
s_add_u32 s72, s71, 0
buffer_load_dwordx4 v15, s[24:27], s72 offen lds
v_mfma_f32_16x16x32_bf16 v[100:103], v[148:151], a[116:119], v[100:103]
s_nop 0
ds_read_b64_tr_b16 v[212:213], v9 offset:4096
ds_read_b64_tr_b16 v[214:215], v9 offset:6144
v_mfma_f32_16x16x32_bf16 v[100:103], v[164:167], a[120:123], v[100:103]
s_nop 0
ds_read_b64_tr_b16 v[216:217], v10 offset:4096
ds_read_b64_tr_b16 v[218:219], v10 offset:6144
v_mfma_f32_16x16x32_bf16 v[100:103], v[180:183], a[124:127], v[100:103]
s_nop 0
ds_read_b64_tr_b16 v[220:221], v11 offset:4096
ds_read_b64_tr_b16 v[222:223], v11 offset:6144
v_mfma_f32_16x16x32_bf16 v[84:87], v[180:183], a[108:111], v[84:87]
buffer_load_dwordx4 a[204:207], v1, s[44:47], s69 offen offset:3072 sc1
v_mfma_f32_16x16x32_bf16 v[84:87], v[164:167], a[104:107], v[84:87]
buffer_load_dword v114, v115, s[44:47], s84 offen sc1
v_mfma_f32_16x16x32_bf16 v[84:87], v[148:151], a[100:103], v[84:87]
s_nop 0
ds_read_b64_tr_b16 v[224:225], v8 offset:8192
ds_read_b64_tr_b16 v[226:227], v8 offset:10240
v_mfma_f32_16x16x32_bf16 v[84:87], v[132:135], a[96:99], v[84:87]
s_nop 0
ds_read_b64_tr_b16 v[228:229], v9 offset:8192
ds_read_b64_tr_b16 v[230:231], v9 offset:10240
v_mfma_f32_16x16x32_bf16 v[88:91], v[136:139], a[96:99], v[88:91]
s_add_u32 s72, s71, 15360
buffer_load_dwordx4 v15, s[24:27], s72 offen offset:1024 lds
v_mfma_f32_16x16x32_bf16 v[88:91], v[152:155], a[100:103], v[88:91]
s_nop 0
ds_read_b64_tr_b16 v[232:233], v10 offset:8192
ds_read_b64_tr_b16 v[234:235], v10 offset:10240
v_mfma_f32_16x16x32_bf16 v[88:91], v[168:171], a[104:107], v[88:91]
s_nop 0
ds_read_b64_tr_b16 v[236:237], v11 offset:8192
ds_read_b64_tr_b16 v[238:239], v11 offset:10240
v_mfma_f32_16x16x32_bf16 v[88:91], v[184:187], a[108:111], v[88:91]
v_mfma_f32_16x16x32_bf16 v[104:107], v[184:187], a[124:127], v[104:107]
s_nop 0
ds_read_b64_tr_b16 v[240:241], v8 offset:12288
ds_read_b64_tr_b16 v[242:243], v8 offset:14336
v_mfma_f32_16x16x32_bf16 v[104:107], v[168:171], a[120:123], v[104:107]
s_nop 0
ds_read_b64_tr_b16 v[244:245], v9 offset:12288
ds_read_b64_tr_b16 v[246:247], v9 offset:14336
v_mfma_f32_16x16x32_bf16 v[104:107], v[152:155], a[116:119], v[104:107]
s_add_u32 s72, s71, 30720
buffer_load_dwordx4 v15, s[24:27], s72 offen offset:2048 lds
v_mfma_f32_16x16x32_bf16 v[104:107], v[136:139], a[112:115], v[104:107]
s_nop 0
ds_read_b64_tr_b16 v[248:249], v10 offset:12288
ds_read_b64_tr_b16 v[250:251], v10 offset:14336
v_mfma_f32_16x16x32_bf16 v[108:111], v[140:143], a[112:115], v[108:111]
s_nop 0
ds_read_b64_tr_b16 v[252:253], v11 offset:12288
ds_read_b64_tr_b16 v[254:255], v11 offset:14336
v_mfma_f32_16x16x32_bf16 v[108:111], v[156:159], a[116:119], v[108:111]
v_mfma_f32_16x16x32_bf16 v[108:111], v[172:175], a[120:123], v[108:111]
s_add_u32 s69, s69, 0x20000
buffer_load_dwordx4 a[208:211], v1, s[44:47], s69 offen sc1
v_mfma_f32_16x16x32_bf16 v[108:111], v[188:191], a[124:127], v[108:111]
v_mfma_f32_16x16x32_bf16 v[92:95], v[188:191], a[108:111], v[92:95]
v_mfma_f32_16x16x32_bf16 v[92:95], v[172:175], a[104:107], v[92:95]
s_add_u32 s72, s71, 46080
v_mfma_f32_16x16x32_bf16 v[92:95], v[156:159], a[100:103], v[92:95]
s_waitcnt vmcnt(14) lgkmcnt(0)
buffer_load_dwordx4 v15, s[24:27], s72 offen offset:3072 lds
v_mfma_f32_16x16x32_bf16 v[92:95], v[140:143], a[96:99], v[92:95]
s_barrier
v_mfma_f32_16x16x32_bf16 v[16:19], v[192:195], a[128:131], v[16:19]
s_nop 0
ds_read_b64_tr_b16 v[128:129], v8 offset:16384
ds_read_b64_tr_b16 v[130:131], v8 offset:18432
v_mfma_f32_16x16x32_bf16 v[16:19], v[208:211], a[132:135], v[16:19]
s_nop 0
ds_read_b64_tr_b16 v[132:133], v9 offset:16384
ds_read_b64_tr_b16 v[134:135], v9 offset:18432
v_mfma_f32_16x16x32_bf16 v[16:19], v[224:227], a[136:139], v[16:19]
buffer_load_dwordx4 a[212:215], v1, s[44:47], s69 offen offset:1024 sc1
v_mfma_f32_16x16x32_bf16 v[16:19], v[240:243], a[140:143], v[16:19]
s_nop 0
ds_read_b64_tr_b16 v[136:137], v10 offset:16384
ds_read_b64_tr_b16 v[138:139], v10 offset:18432
v_mfma_f32_16x16x32_bf16 v[32:35], v[240:243], a[156:159], v[32:35]
s_xor_b32 s71, s15, 0x40080
ds_read_b64_tr_b16 v[140:141], v11 offset:16384
ds_read_b64_tr_b16 v[142:143], v11 offset:18432
v_mfma_f32_16x16x32_bf16 v[32:35], v[224:227], a[152:155], v[32:35]
s_add_u32 m0, s77, 16384
v_mfma_f32_16x16x32_bf16 v[32:35], v[208:211], a[148:151], v[32:35]
s_add_u32 s72, s71, 0
buffer_load_dwordx4 v15, s[24:27], s72 offen lds
v_mfma_f32_16x16x32_bf16 v[32:35], v[192:195], a[144:147], v[32:35]
s_nop 0
ds_read_b64_tr_b16 v[144:145], v8 offset:20480
ds_read_b64_tr_b16 v[146:147], v8 offset:22528
v_mfma_f32_16x16x32_bf16 v[36:39], v[196:199], a[144:147], v[36:39]
s_nop 0
ds_read_b64_tr_b16 v[148:149], v9 offset:20480
ds_read_b64_tr_b16 v[150:151], v9 offset:22528
v_mfma_f32_16x16x32_bf16 v[36:39], v[212:215], a[148:151], v[36:39]
s_nop 0
ds_read_b64_tr_b16 v[152:153], v10 offset:20480
ds_read_b64_tr_b16 v[154:155], v10 offset:22528
v_mfma_f32_16x16x32_bf16 v[36:39], v[228:231], a[152:155], v[36:39]
buffer_load_dwordx4 a[216:219], v1, s[44:47], s69 offen offset:2048 sc1
v_mfma_f32_16x16x32_bf16 v[36:39], v[244:247], a[156:159], v[36:39]
v_mfma_f32_16x16x32_bf16 v[20:23], v[244:247], a[140:143], v[20:23]
s_nop 0
ds_read_b64_tr_b16 v[156:157], v11 offset:20480
ds_read_b64_tr_b16 v[158:159], v11 offset:22528
v_mfma_f32_16x16x32_bf16 v[20:23], v[228:231], a[136:139], v[20:23]
s_nop 0
ds_read_b64_tr_b16 v[160:161], v8 offset:24576
ds_read_b64_tr_b16 v[162:163], v8 offset:26624
v_mfma_f32_16x16x32_bf16 v[20:23], v[212:215], a[132:135], v[20:23]
s_add_u32 s72, s71, 15360
buffer_load_dwordx4 v15, s[24:27], s72 offen offset:1024 lds
v_mfma_f32_16x16x32_bf16 v[20:23], v[196:199], a[128:131], v[20:23]
s_nop 0
ds_read_b64_tr_b16 v[164:165], v9 offset:24576
ds_read_b64_tr_b16 v[166:167], v9 offset:26624
v_mfma_f32_16x16x32_bf16 v[24:27], v[200:203], a[128:131], v[24:27]
v_mfma_f32_16x16x32_bf16 v[24:27], v[216:219], a[132:135], v[24:27]
s_nop 0
ds_read_b64_tr_b16 v[168:169], v10 offset:24576
ds_read_b64_tr_b16 v[170:171], v10 offset:26624
v_mfma_f32_16x16x32_bf16 v[24:27], v[232:235], a[136:139], v[24:27]
s_nop 0
ds_read_b64_tr_b16 v[172:173], v11 offset:24576
ds_read_b64_tr_b16 v[174:175], v11 offset:26624
v_mfma_f32_16x16x32_bf16 v[24:27], v[248:251], a[140:143], v[24:27]
s_nop 0
ds_read_b64_tr_b16 v[176:177], v8 offset:28672
ds_read_b64_tr_b16 v[178:179], v8 offset:30720
v_mfma_f32_16x16x32_bf16 v[40:43], v[248:251], a[156:159], v[40:43]
s_add_u32 s72, s71, 30720
buffer_load_dwordx4 v15, s[24:27], s72 offen offset:2048 lds
v_mfma_f32_16x16x32_bf16 v[40:43], v[232:235], a[152:155], v[40:43]
v_mfma_f32_16x16x32_bf16 v[40:43], v[216:219], a[148:151], v[40:43]
s_nop 0
ds_read_b64_tr_b16 v[180:181], v9 offset:28672
ds_read_b64_tr_b16 v[182:183], v9 offset:30720
v_mfma_f32_16x16x32_bf16 v[40:43], v[200:203], a[144:147], v[40:43]
s_nop 0
ds_read_b64_tr_b16 v[184:185], v10 offset:28672
ds_read_b64_tr_b16 v[186:187], v10 offset:30720
v_mfma_f32_16x16x32_bf16 v[44:47], v[204:207], a[144:147], v[44:47]
buffer_load_dwordx4 a[220:223], v1, s[44:47], s69 offen offset:3072 sc1
v_mfma_f32_16x16x32_bf16 v[44:47], v[220:223], a[148:151], v[44:47]
s_nop 0
ds_read_b64_tr_b16 v[188:189], v11 offset:28672
ds_read_b64_tr_b16 v[190:191], v11 offset:30720
v_mfma_f32_16x16x32_bf16 v[44:47], v[236:239], a[152:155], v[44:47]
s_lshr_b32 s69, s15, 18
v_mfma_f32_16x16x32_bf16 v[44:47], v[252:255], a[156:159], v[44:47]
s_lshl_b32 s69, s69, 12
v_mfma_f32_16x16x32_bf16 v[28:31], v[252:255], a[140:143], v[28:31]
s_add_u32 s72, s71, 46080
buffer_load_dwordx4 v15, s[24:27], s72 offen offset:3072 lds
v_mfma_f32_16x16x32_bf16 v[28:31], v[236:239], a[136:139], v[28:31]
s_add_u32 s69, s69, s95
v_mfma_f32_16x16x32_bf16 v[28:31], v[220:223], a[132:135], v[28:31]
s_waitcnt lgkmcnt(0)
v_mfma_f32_16x16x32_bf16 v[28:31], v[204:207], a[128:131], v[28:31]
v_mfma_f32_16x16x32_bf16 v[48:51], v[128:131], a[128:131], v[48:51]
s_xor_b32 s69, s69, 0x1000
buffer_load_dwordx4 a[224:227], v1, s[44:47], s69 offen sc1
v_mfma_f32_16x16x32_bf16 v[48:51], v[144:147], a[132:135], v[48:51]
s_nop 0
ds_read_b64_tr_b16 v[192:193], v8 offset:32768
ds_read_b64_tr_b16 v[194:195], v8 offset:34816
v_mfma_f32_16x16x32_bf16 v[48:51], v[160:163], a[136:139], v[48:51]
s_xor_b32 s71, s13, 0x40100
ds_read_b64_tr_b16 v[196:197], v9 offset:32768
ds_read_b64_tr_b16 v[198:199], v9 offset:34816
v_mfma_f32_16x16x32_bf16 v[48:51], v[176:179], a[140:143], v[48:51]
s_add_u32 m0, s77, 32768
ds_read_b64_tr_b16 v[200:201], v10 offset:32768
ds_read_b64_tr_b16 v[202:203], v10 offset:34816
v_mfma_f32_16x16x32_bf16 v[64:67], v[176:179], a[156:159], v[64:67]
s_add_u32 s72, s71, 0
buffer_load_dwordx4 v15, s[24:27], s72 offen lds
v_mfma_f32_16x16x32_bf16 v[64:67], v[160:163], a[152:155], v[64:67]
s_nop 0
ds_read_b64_tr_b16 v[204:205], v11 offset:32768
ds_read_b64_tr_b16 v[206:207], v11 offset:34816
v_mfma_f32_16x16x32_bf16 v[64:67], v[144:147], a[148:151], v[64:67]
v_mfma_f32_16x16x32_bf16 v[64:67], v[128:131], a[144:147], v[64:67]
s_nop 0
ds_read_b64_tr_b16 v[208:209], v8 offset:36864
ds_read_b64_tr_b16 v[210:211], v8 offset:38912
v_mfma_f32_16x16x32_bf16 v[68:71], v[132:135], a[144:147], v[68:71]
buffer_load_dwordx4 a[228:231], v1, s[44:47], s69 offen offset:1024 sc1
v_mfma_f32_16x16x32_bf16 v[68:71], v[148:151], a[148:151], v[68:71]
s_nop 0
ds_read_b64_tr_b16 v[212:213], v9 offset:36864
ds_read_b64_tr_b16 v[214:215], v9 offset:38912
v_mfma_f32_16x16x32_bf16 v[68:71], v[164:167], a[152:155], v[68:71]
s_nop 0
ds_read_b64_tr_b16 v[216:217], v10 offset:36864
ds_read_b64_tr_b16 v[218:219], v10 offset:38912
v_mfma_f32_16x16x32_bf16 v[68:71], v[180:183], a[156:159], v[68:71]
s_nop 0
ds_read_b64_tr_b16 v[220:221], v11 offset:36864
ds_read_b64_tr_b16 v[222:223], v11 offset:38912
v_mfma_f32_16x16x32_bf16 v[52:55], v[180:183], a[140:143], v[52:55]
s_add_u32 s72, s71, 15360
buffer_load_dwordx4 v15, s[24:27], s72 offen offset:1024 lds
v_mfma_f32_16x16x32_bf16 v[52:55], v[164:167], a[136:139], v[52:55]
v_mfma_f32_16x16x32_bf16 v[52:55], v[148:151], a[132:135], v[52:55]
s_nop 0
ds_read_b64_tr_b16 v[224:225], v8 offset:40960
ds_read_b64_tr_b16 v[226:227], v8 offset:43008
v_mfma_f32_16x16x32_bf16 v[52:55], v[132:135], a[128:131], v[52:55]
s_nop 0
ds_read_b64_tr_b16 v[228:229], v9 offset:40960
ds_read_b64_tr_b16 v[230:231], v9 offset:43008
v_mfma_f32_16x16x32_bf16 v[56:59], v[136:139], a[128:131], v[56:59]
s_nop 0
ds_read_b64_tr_b16 v[232:233], v10 offset:40960
ds_read_b64_tr_b16 v[234:235], v10 offset:43008
v_mfma_f32_16x16x32_bf16 v[56:59], v[152:155], a[132:135], v[56:59]
s_add_u32 s72, s71, 30720
buffer_load_dwordx4 v15, s[24:27], s72 offen offset:2048 lds
v_mfma_f32_16x16x32_bf16 v[56:59], v[168:171], a[136:139], v[56:59]
s_nop 0
ds_read_b64_tr_b16 v[236:237], v11 offset:40960
ds_read_b64_tr_b16 v[238:239], v11 offset:43008
v_mfma_f32_16x16x32_bf16 v[56:59], v[184:187], a[140:143], v[56:59]
v_mfma_f32_16x16x32_bf16 v[72:75], v[184:187], a[156:159], v[72:75]
s_nop 0
ds_read_b64_tr_b16 v[240:241], v8 offset:45056
ds_read_b64_tr_b16 v[242:243], v8 offset:47104
v_mfma_f32_16x16x32_bf16 v[72:75], v[168:171], a[152:155], v[72:75]
buffer_load_dwordx4 a[232:235], v1, s[44:47], s69 offen offset:2048 sc1
v_mfma_f32_16x16x32_bf16 v[72:75], v[152:155], a[148:151], v[72:75]
s_nop 0
ds_read_b64_tr_b16 v[244:245], v9 offset:45056
ds_read_b64_tr_b16 v[246:247], v9 offset:47104
v_mfma_f32_16x16x32_bf16 v[72:75], v[136:139], a[144:147], v[72:75]
s_nop 0
ds_read_b64_tr_b16 v[248:249], v10 offset:45056
ds_read_b64_tr_b16 v[250:251], v10 offset:47104
v_mfma_f32_16x16x32_bf16 v[76:79], v[140:143], a[144:147], v[76:79]
s_nop 0
ds_read_b64_tr_b16 v[252:253], v11 offset:45056
ds_read_b64_tr_b16 v[254:255], v11 offset:47104
v_mfma_f32_16x16x32_bf16 v[76:79], v[156:159], a[148:151], v[76:79]
s_add_u32 s72, s71, 46080
buffer_load_dwordx4 v15, s[24:27], s72 offen offset:3072 lds
v_mfma_f32_16x16x32_bf16 v[76:79], v[172:175], a[152:155], v[76:79]
v_mfma_f32_16x16x32_bf16 v[76:79], v[188:191], a[156:159], v[76:79]
v_mfma_f32_16x16x32_bf16 v[60:63], v[188:191], a[140:143], v[60:63]
v_mfma_f32_16x16x32_bf16 v[60:63], v[172:175], a[136:139], v[60:63]
s_xor_b32 s71, s14, 0x40100
buffer_load_dwordx4 a[236:239], v1, s[44:47], s69 offen offset:3072 sc1
v_mfma_f32_16x16x32_bf16 v[60:63], v[156:159], a[132:135], v[60:63]
s_waitcnt vmcnt(15) lgkmcnt(0)
v_mfma_f32_16x16x32_bf16 v[60:63], v[140:143], a[128:131], v[60:63]
s_barrier
v_mfma_f32_16x16x32_bf16 v[80:83], v[192:195], a[128:131], v[80:83]
s_add_u32 m0, s77, 49152
ds_read_b64_tr_b16 v[128:129], v8 offset:49152
ds_read_b64_tr_b16 v[130:131], v8 offset:51200
v_mfma_f32_16x16x32_bf16 v[80:83], v[208:211], a[132:135], v[80:83]
s_add_u32 s72, s71, 0
buffer_load_dwordx4 v15, s[24:27], s72 offen lds
v_mfma_f32_16x16x32_bf16 v[80:83], v[224:227], a[136:139], v[80:83]
s_nop 0
ds_read_b64_tr_b16 v[132:133], v9 offset:49152
ds_read_b64_tr_b16 v[134:135], v9 offset:51200
s_waitcnt vmcnt(20)
v_cmp_gt_u32 vcc, 3, v114
s_cbranch_vccnz Lspin109
Lback110:
v_mfma_f32_16x16x32_bf16 v[80:83], v[240:243], a[140:143], v[80:83]
s_lshl_b32 s73, s76, 18
ds_read_b64_tr_b16 v[136:137], v10 offset:49152
ds_read_b64_tr_b16 v[138:139], v10 offset:51200
v_mfma_f32_16x16x32_bf16 v[96:99], v[240:243], a[156:159], v[96:99]
s_lshl_b32 s84, s58, 16
ds_read_b64_tr_b16 v[140:141], v11 offset:49152
ds_read_b64_tr_b16 v[142:143], v11 offset:51200
v_mfma_f32_16x16x32_bf16 v[96:99], v[224:227], a[152:155], v[96:99]
s_add_u32 s73, s73, s84
v_mfma_f32_16x16x32_bf16 v[96:99], v[208:211], a[148:151], v[96:99]
s_add_u32 s69, s69, 0x20000
buffer_load_dwordx4 a[240:243], v1, s[44:47], s69 offen sc1
v_mfma_f32_16x16x32_bf16 v[96:99], v[192:195], a[144:147], v[96:99]
s_lshl_b32 s84, s75, 8
ds_read_b64_tr_b16 v[144:145], v8 offset:53248
ds_read_b64_tr_b16 v[146:147], v8 offset:55296
v_mfma_f32_16x16x32_bf16 v[100:103], v[196:199], a[144:147], v[100:103]
s_add_u32 s73, s73, s84
ds_read_b64_tr_b16 v[148:149], v9 offset:53248
ds_read_b64_tr_b16 v[150:151], v9 offset:55296
v_mfma_f32_16x16x32_bf16 v[100:103], v[212:215], a[148:151], v[100:103]
s_add_u32 s73, s73, 0x3400000
ds_read_b64_tr_b16 v[152:153], v10 offset:53248
ds_read_b64_tr_b16 v[154:155], v10 offset:55296
v_mfma_f32_16x16x32_bf16 v[100:103], v[228:231], a[152:155], v[100:103]
s_add_u32 s72, s71, 15360
buffer_load_dwordx4 v15, s[24:27], s72 offen offset:1024 lds
v_mfma_f32_16x16x32_bf16 v[100:103], v[244:247], a[156:159], v[100:103]
v_lshrrev_b32 v112, 4, v0
v_and_b32 v113, 15, v0
v_mfma_f32_16x16x32_bf16 v[84:87], v[244:247], a[140:143], v[84:87]
s_nop 0
ds_read_b64_tr_b16 v[156:157], v11 offset:53248
ds_read_b64_tr_b16 v[158:159], v11 offset:55296
v_mfma_f32_16x16x32_bf16 v[84:87], v[228:231], a[136:139], v[84:87]
s_nop 0
ds_read_b64_tr_b16 v[160:161], v8 offset:57344
ds_read_b64_tr_b16 v[162:163], v8 offset:59392
v_mfma_f32_16x16x32_bf16 v[84:87], v[212:215], a[132:135], v[84:87]
s_nop 0
ds_read_b64_tr_b16 v[164:165], v9 offset:57344
ds_read_b64_tr_b16 v[166:167], v9 offset:59392
v_mfma_f32_16x16x32_bf16 v[84:87], v[196:199], a[128:131], v[84:87]
s_add_u32 s72, s71, 30720
buffer_load_dwordx4 v15, s[24:27], s72 offen offset:2048 lds
v_mfma_f32_16x16x32_bf16 v[88:91], v[200:203], a[128:131], v[88:91]
v_xor_b32 v12, v113, v112
v_lshlrev_b32 v12, 4, v12
v_mfma_f32_16x16x32_bf16 v[88:91], v[216:219], a[132:135], v[88:91]
s_nop 0
ds_read_b64_tr_b16 v[168:169], v10 offset:57344
ds_read_b64_tr_b16 v[170:171], v10 offset:59392
v_mfma_f32_16x16x32_bf16 v[88:91], v[232:235], a[136:139], v[88:91]
s_nop 0
ds_read_b64_tr_b16 v[172:173], v11 offset:57344
ds_read_b64_tr_b16 v[174:175], v11 offset:59392
v_mfma_f32_16x16x32_bf16 v[88:91], v[248:251], a[140:143], v[88:91]
buffer_load_dwordx4 a[244:247], v1, s[44:47], s69 offen offset:1024 sc1
v_mfma_f32_16x16x32_bf16 v[104:107], v[248:251], a[156:159], v[104:107]
s_nop 0
ds_read_b64_tr_b16 v[176:177], v8 offset:61440
ds_read_b64_tr_b16 v[178:179], v8 offset:63488
v_mfma_f32_16x16x32_bf16 v[104:107], v[232:235], a[152:155], v[104:107]
v_lshl_add_u32 v112, v112, 12, v12
v_xor_b32 v12, 64, v112
v_mfma_f32_16x16x32_bf16 v[104:107], v[216:219], a[148:151], v[104:107]
s_nop 0
ds_read_b64_tr_b16 v[180:181], v9 offset:61440
ds_read_b64_tr_b16 v[182:183], v9 offset:63488
v_mfma_f32_16x16x32_bf16 v[104:107], v[200:203], a[144:147], v[104:107]
s_add_u32 s72, s71, 46080
buffer_load_dwordx4 v15, s[24:27], s72 offen offset:3072 lds
v_mfma_f32_16x16x32_bf16 v[108:111], v[204:207], a[144:147], v[108:111]
s_nop 0
ds_read_b64_tr_b16 v[184:185], v10 offset:61440
ds_read_b64_tr_b16 v[186:187], v10 offset:63488
v_mfma_f32_16x16x32_bf16 v[108:111], v[220:223], a[148:151], v[108:111]
s_nop 0
ds_read_b64_tr_b16 v[188:189], v11 offset:61440
ds_read_b64_tr_b16 v[190:191], v11 offset:63488
v_mfma_f32_16x16x32_bf16 v[108:111], v[236:239], a[152:155], v[108:111]
v_lshlrev_b32 v113, 2, v113
v_mfma_f32_16x16x32_bf16 v[108:111], v[252:255], a[156:159], v[108:111]
s_xor_b32 s71, s15, 0x40100
buffer_load_dwordx4 a[248:251], v1, s[44:47], s69 offen offset:2048 sc1
v_mfma_f32_16x16x32_bf16 v[92:95], v[252:255], a[140:143], v[92:95]
s_add_u32 m0, s85, 0
v_xor_b32 v8, 0x10000, v8
v_mfma_f32_16x16x32_bf16 v[92:95], v[236:239], a[136:139], v[92:95]
s_add_u32 s72, s71, 0
v_xor_b32 v9, 0x10000, v9
v_mfma_f32_16x16x32_bf16 v[92:95], v[220:223], a[132:135], v[92:95]
s_waitcnt vmcnt(36) lgkmcnt(0)
v_xor_b32 v10, 0x10000, v10
v_mfma_f32_16x16x32_bf16 v[92:95], v[204:207], a[128:131], v[92:95]
s_nop 0
buffer_load_dwordx4 v15, s[24:27], s72 offen lds
v_xor_b32 v11, 0x10000, v11
v_mfma_f32_16x16x32_bf16 v[16:19], v[128:131], a[160:163], v[16:19]
s_nop 0
ds_read_b64_tr_b16 v[192:193], v8 offset:0
ds_read_b64_tr_b16 v[194:195], v8 offset:2048
v_mfma_f32_16x16x32_bf16 v[16:19], v[144:147], a[164:167], v[16:19]
s_nop 0
ds_read_b64_tr_b16 v[196:197], v9 offset:0
ds_read_b64_tr_b16 v[198:199], v9 offset:2048
v_mfma_f32_16x16x32_bf16 v[16:19], v[160:163], a[168:171], v[16:19]
s_nop 0
ds_read_b64_tr_b16 v[200:201], v10 offset:0
ds_read_b64_tr_b16 v[202:203], v10 offset:2048
v_mfma_f32_16x16x32_bf16 v[16:19], v[176:179], a[172:175], v[16:19]
v_mfma_f32_16x16x32_bf16 v[32:35], v[176:179], a[188:191], v[32:35]
buffer_load_dwordx4 a[252:255], v1, s[44:47], s69 offen offset:3072 sc1
v_mfma_f32_16x16x32_bf16 v[32:35], v[160:163], a[184:187], v[32:35]
s_nop 0
ds_read_b64_tr_b16 v[204:205], v11 offset:0
ds_read_b64_tr_b16 v[206:207], v11 offset:2048
v_mfma_f32_16x16x32_bf16 v[32:35], v[144:147], a[180:183], v[32:35]
s_nop 0
ds_read_b64_tr_b16 v[208:209], v8 offset:4096
ds_read_b64_tr_b16 v[210:211], v8 offset:6144
v_mfma_f32_16x16x32_bf16 v[32:35], v[128:131], a[176:179], v[32:35]
v_mfma_f32_16x16x32_bf16 v[36:39], v[132:135], a[176:179], v[36:39]
s_add_u32 s72, s71, 15360
buffer_load_dwordx4 v15, s[24:27], s72 offen offset:1024 lds
v_mfma_f32_16x16x32_bf16 v[36:39], v[148:151], a[180:183], v[36:39]
s_nop 0
ds_read_b64_tr_b16 v[212:213], v9 offset:4096
ds_read_b64_tr_b16 v[214:215], v9 offset:6144
v_mfma_f32_16x16x32_bf16 v[36:39], v[164:167], a[184:187], v[36:39]
s_nop 0
ds_read_b64_tr_b16 v[216:217], v10 offset:4096
ds_read_b64_tr_b16 v[218:219], v10 offset:6144
v_mfma_f32_16x16x32_bf16 v[36:39], v[180:183], a[188:191], v[36:39]
v_mfma_f32_16x16x32_bf16 v[20:23], v[180:183], a[172:175], v[20:23]
s_nop 0
ds_read_b64_tr_b16 v[220:221], v11 offset:4096
ds_read_b64_tr_b16 v[222:223], v11 offset:6144
v_mfma_f32_16x16x32_bf16 v[20:23], v[164:167], a[168:171], v[20:23]
s_add_u32 s72, s71, 30720
buffer_load_dwordx4 v15, s[24:27], s72 offen offset:2048 lds
v_mfma_f32_16x16x32_bf16 v[20:23], v[148:151], a[164:167], v[20:23]
s_nop 0
ds_read_b64_tr_b16 v[224:225], v8 offset:8192
ds_read_b64_tr_b16 v[226:227], v8 offset:10240
v_mfma_f32_16x16x32_bf16 v[20:23], v[132:135], a[160:163], v[20:23]
s_nop 0
ds_read_b64_tr_b16 v[228:229], v9 offset:8192
ds_read_b64_tr_b16 v[230:231], v9 offset:10240
v_mfma_f32_16x16x32_bf16 v[24:27], v[136:139], a[160:163], v[24:27]
v_mfma_f32_16x16x32_bf16 v[24:27], v[152:155], a[164:167], v[24:27]
s_nop 0
ds_read_b64_tr_b16 v[232:233], v10 offset:8192
ds_read_b64_tr_b16 v[234:235], v10 offset:10240
v_mfma_f32_16x16x32_bf16 v[24:27], v[168:171], a[168:171], v[24:27]
s_nop 0
ds_read_b64_tr_b16 v[236:237], v11 offset:8192
ds_read_b64_tr_b16 v[238:239], v11 offset:10240
v_mfma_f32_16x16x32_bf16 v[24:27], v[184:187], a[172:175], v[24:27]
v_mfma_f32_16x16x32_bf16 v[40:43], v[184:187], a[188:191], v[40:43]
s_add_u32 s72, s71, 46080
buffer_load_dwordx4 v15, s[24:27], s72 offen offset:3072 lds
v_mfma_f32_16x16x32_bf16 v[40:43], v[168:171], a[184:187], v[40:43]
s_nop 0
ds_read_b64_tr_b16 v[240:241], v8 offset:12288
ds_read_b64_tr_b16 v[242:243], v8 offset:14336
v_mfma_f32_16x16x32_bf16 v[40:43], v[152:155], a[180:183], v[40:43]
s_nop 0
ds_read_b64_tr_b16 v[244:245], v9 offset:12288
ds_read_b64_tr_b16 v[246:247], v9 offset:14336
v_mfma_f32_16x16x32_bf16 v[40:43], v[136:139], a[176:179], v[40:43]
v_mfma_f32_16x16x32_bf16 v[44:47], v[140:143], a[176:179], v[44:47]
s_nop 0
ds_read_b64_tr_b16 v[248:249], v10 offset:12288
ds_read_b64_tr_b16 v[250:251], v10 offset:14336
v_mfma_f32_16x16x32_bf16 v[44:47], v[156:159], a[180:183], v[44:47]
s_nop 0
ds_read_b64_tr_b16 v[252:253], v11 offset:12288
ds_read_b64_tr_b16 v[254:255], v11 offset:14336
v_mfma_f32_16x16x32_bf16 v[44:47], v[172:175], a[184:187], v[44:47]
s_xor_b32 s71, s13, 0x40180
v_mfma_f32_16x16x32_bf16 v[44:47], v[188:191], a[188:191], v[44:47]
s_add_u32 m0, s85, 16384
v_mfma_f32_16x16x32_bf16 v[28:31], v[188:191], a[172:175], v[28:31]
s_add_u32 s72, s71, 0
buffer_load_dwordx4 v15, s[24:27], s72 offen lds
v_mfma_f32_16x16x32_bf16 v[28:31], v[172:175], a[168:171], v[28:31]
v_mfma_f32_16x16x32_bf16 v[28:31], v[156:159], a[164:167], v[28:31]
s_waitcnt vmcnt(14) lgkmcnt(0)
v_mfma_f32_16x16x32_bf16 v[28:31], v[140:143], a[160:163], v[28:31]
s_barrier
v_mfma_f32_16x16x32_bf16 v[16:19], v[192:195], a[192:195], v[16:19]
s_nop 0
ds_read_b64_tr_b16 v[128:129], v8 offset:16384
ds_read_b64_tr_b16 v[130:131], v8 offset:18432
v_mfma_f32_16x16x32_bf16 v[16:19], v[208:211], a[196:199], v[16:19]
s_nop 0
ds_read_b64_tr_b16 v[132:133], v9 offset:16384
ds_read_b64_tr_b16 v[134:135], v9 offset:18432
v_mfma_f32_16x16x32_bf16 v[16:19], v[224:227], a[200:203], v[16:19]
s_nop 0
ds_read_b64_tr_b16 v[136:137], v10 offset:16384
ds_read_b64_tr_b16 v[138:139], v10 offset:18432
v_mfma_f32_16x16x32_bf16 v[16:19], v[240:243], a[204:207], v[16:19]
s_add_u32 s72, s71, 15360
buffer_load_dwordx4 v15, s[24:27], s72 offen offset:1024 lds
v_mfma_f32_16x16x32_bf16 v[32:35], v[240:243], a[220:223], v[32:35]
v_mfma_f32_16x16x32_bf16 v[32:35], v[224:227], a[216:219], v[32:35]
s_nop 0
ds_read_b64_tr_b16 v[140:141], v11 offset:16384
ds_read_b64_tr_b16 v[142:143], v11 offset:18432
v_mfma_f32_16x16x32_bf16 v[32:35], v[208:211], a[212:215], v[32:35]
s_nop 0
ds_read_b64_tr_b16 v[144:145], v8 offset:20480
ds_read_b64_tr_b16 v[146:147], v8 offset:22528
v_mfma_f32_16x16x32_bf16 v[32:35], v[192:195], a[208:211], v[32:35]
v_mfma_f32_16x16x32_bf16 v[36:39], v[196:199], a[208:211], v[36:39]
s_nop 0
ds_read_b64_tr_b16 v[148:149], v9 offset:20480
ds_read_b64_tr_b16 v[150:151], v9 offset:22528
v_mfma_f32_16x16x32_bf16 v[36:39], v[212:215], a[212:215], v[36:39]
s_nop 0
ds_read_b64_tr_b16 v[152:153], v10 offset:20480
ds_read_b64_tr_b16 v[154:155], v10 offset:22528
v_mfma_f32_16x16x32_bf16 v[36:39], v[228:231], a[216:219], v[36:39]
s_add_u32 s72, s71, 30720
buffer_load_dwordx4 v15, s[24:27], s72 offen offset:2048 lds
v_mfma_f32_16x16x32_bf16 v[36:39], v[244:247], a[220:223], v[36:39]
v_mfma_f32_16x16x32_bf16 v[20:23], v[244:247], a[204:207], v[20:23]
s_nop 0
ds_read_b64_tr_b16 v[156:157], v11 offset:20480
ds_read_b64_tr_b16 v[158:159], v11 offset:22528
v_mfma_f32_16x16x32_bf16 v[20:23], v[228:231], a[200:203], v[20:23]
s_nop 0
ds_read_b64_tr_b16 v[160:161], v8 offset:24576
ds_read_b64_tr_b16 v[162:163], v8 offset:26624
v_mfma_f32_16x16x32_bf16 v[20:23], v[212:215], a[196:199], v[20:23]
s_nop 0
ds_read_b64_tr_b16 v[164:165], v9 offset:24576
ds_read_b64_tr_b16 v[166:167], v9 offset:26624
v_mfma_f32_16x16x32_bf16 v[20:23], v[196:199], a[192:195], v[20:23]
v_mfma_f32_16x16x32_bf16 v[24:27], v[200:203], a[192:195], v[24:27]
s_nop 0
ds_read_b64_tr_b16 v[168:169], v10 offset:24576
ds_read_b64_tr_b16 v[170:171], v10 offset:26624
v_mfma_f32_16x16x32_bf16 v[24:27], v[216:219], a[196:199], v[24:27]
s_add_u32 s72, s71, 46080
buffer_load_dwordx4 v15, s[24:27], s72 offen offset:3072 lds
v_mfma_f32_16x16x32_bf16 v[24:27], v[232:235], a[200:203], v[24:27]
s_nop 0
ds_read_b64_tr_b16 v[172:173], v11 offset:24576
ds_read_b64_tr_b16 v[174:175], v11 offset:26624
v_mfma_f32_16x16x32_bf16 v[24:27], v[248:251], a[204:207], v[24:27]
v_mfma_f32_16x16x32_bf16 v[40:43], v[248:251], a[220:223], v[40:43]
s_nop 0
ds_read_b64_tr_b16 v[176:177], v8 offset:28672
ds_read_b64_tr_b16 v[178:179], v8 offset:30720
v_mfma_f32_16x16x32_bf16 v[40:43], v[232:235], a[216:219], v[40:43]
s_nop 0
ds_read_b64_tr_b16 v[180:181], v9 offset:28672
ds_read_b64_tr_b16 v[182:183], v9 offset:30720
v_mfma_f32_16x16x32_bf16 v[40:43], v[216:219], a[212:215], v[40:43]
v_mfma_f32_16x16x32_bf16 v[40:43], v[200:203], a[208:211], v[40:43]
s_nop 0
ds_read_b64_tr_b16 v[184:185], v10 offset:28672
ds_read_b64_tr_b16 v[186:187], v10 offset:30720
v_mfma_f32_16x16x32_bf16 v[44:47], v[204:207], a[208:211], v[44:47]
s_add_u32 m0, s64, 147456
ds_read_b64_tr_b16 v[188:189], v11 offset:28672
ds_read_b64_tr_b16 v[190:191], v11 offset:30720
v_mfma_f32_16x16x32_bf16 v[44:47], v[220:223], a[212:215], v[44:47]
s_add_u32 s72, s73, 0
buffer_load_dwordx4 v112, s[44:47], s72 offen sc1 lds
v_mfma_f32_16x16x32_bf16 v[44:47], v[236:239], a[216:219], v[44:47]
Lstube2:
s_cbranch_execz Lrete
v_mfma_f32_16x16x32_bf16 v[44:47], v[252:255], a[220:223], v[44:47]
v_mfma_f32_16x16x32_bf16 v[28:31], v[252:255], a[204:207], v[28:31]
v_mfma_f32_16x16x32_bf16 v[28:31], v[236:239], a[200:203], v[28:31]
s_add_u32 s72, s73, 15360
buffer_load_dwordx4 v12, s[44:47], s72 offen offset:1024 sc1 lds
v_mfma_f32_16x16x32_bf16 v[28:31], v[220:223], a[196:199], v[28:31]
s_waitcnt vmcnt(9) lgkmcnt(0)
v_mfma_f32_16x16x32_bf16 v[28:31], v[204:207], a[192:195], v[28:31]
v_mfma_f32_16x16x32_bf16 v[16:19], v[128:131], a[224:227], v[16:19]
s_nop 0
ds_read_b64_tr_b16 v[192:193], v8 offset:32768
ds_read_b64_tr_b16 v[194:195], v8 offset:34816
v_mfma_f32_16x16x32_bf16 v[16:19], v[144:147], a[228:231], v[16:19]
s_add_u32 s72, s73, 30720
buffer_load_dwordx4 v112, s[44:47], s72 offen offset:2048 sc1 lds
v_mfma_f32_16x16x32_bf16 v[16:19], v[160:163], a[232:235], v[16:19]
s_nop 0
ds_read_b64_tr_b16 v[196:197], v9 offset:32768
ds_read_b64_tr_b16 v[198:199], v9 offset:34816
v_mfma_f32_16x16x32_bf16 v[16:19], v[176:179], a[236:239], v[16:19]
s_nop 0
ds_read_b64_tr_b16 v[200:201], v10 offset:32768
ds_read_b64_tr_b16 v[202:203], v10 offset:34816
v_mfma_f32_16x16x32_bf16 v[20:23], v[180:183], a[236:239], v[20:23]
s_nop 0
ds_read_b64_tr_b16 v[204:205], v11 offset:32768
ds_read_b64_tr_b16 v[206:207], v11 offset:34816
v_mfma_f32_16x16x32_bf16 v[20:23], v[164:167], a[232:235], v[20:23]
s_add_u32 s72, s73, 46080
buffer_load_dwordx4 v12, s[44:47], s72 offen offset:3072 sc1 lds
v_mfma_f32_16x16x32_bf16 v[20:23], v[148:151], a[228:231], v[20:23]
s_lshl_b32 s73, s75, 9
ds_read_b64_tr_b16 v[208:209], v8 offset:36864
ds_read_b64_tr_b16 v[210:211], v8 offset:38912
v_mfma_f32_16x16x32_bf16 v[20:23], v[132:135], a[224:227], v[20:23]
s_xor_b32 s71, s14, 0x40180
ds_read_b64_tr_b16 v[212:213], v9 offset:36864
ds_read_b64_tr_b16 v[214:215], v9 offset:38912
v_mfma_f32_16x16x32_bf16 v[24:27], v[136:139], a[224:227], v[24:27]
s_add_u32 m0, s85, 32768
v_mfma_f32_16x16x32_bf16 v[24:27], v[152:155], a[228:231], v[24:27]
s_add_u32 s72, s71, 0
buffer_load_dwordx4 v15, s[24:27], s72 offen lds
v_mfma_f32_16x16x32_bf16 v[24:27], v[168:171], a[232:235], v[24:27]
s_lshl_b32 s84, s58, 7
ds_read_b64_tr_b16 v[216:217], v10 offset:36864
ds_read_b64_tr_b16 v[218:219], v10 offset:38912
v_mfma_f32_16x16x32_bf16 v[24:27], v[184:187], a[236:239], v[24:27]
s_add_u32 s73, s73, s84
ds_read_b64_tr_b16 v[220:221], v11 offset:36864
ds_read_b64_tr_b16 v[222:223], v11 offset:38912
v_cvt_pk_bf16_f32 v16, v16, v17
v_mfma_f32_16x16x32_bf16 v[28:31], v[188:191], a[236:239], v[28:31]
s_add_u32 s73, s73, 0x3800000
ds_read_b64_tr_b16 v[224:225], v8 offset:40960
ds_read_b64_tr_b16 v[226:227], v8 offset:43008
v_cvt_pk_bf16_f32 v17, v18, v19
v_mfma_f32_16x16x32_bf16 v[28:31], v[172:175], a[232:235], v[28:31]
s_add_u32 s72, s71, 15360
buffer_load_dwordx4 v15, s[24:27], s72 offen offset:1024 lds
v_cvt_pk_bf16_f32 v18, v20, v21
v_mfma_f32_16x16x32_bf16 v[28:31], v[156:159], a[228:231], v[28:31]
s_nop 0
ds_read_b64_tr_b16 v[228:229], v9 offset:40960
ds_read_b64_tr_b16 v[230:231], v9 offset:43008
v_cvt_pk_bf16_f32 v19, v22, v23
v_mfma_f32_16x16x32_bf16 v[28:31], v[140:143], a[224:227], v[28:31]
s_nop 0
ds_read_b64_tr_b16 v[232:233], v10 offset:40960
ds_read_b64_tr_b16 v[234:235], v10 offset:43008
v_mfma_f32_16x16x32_bf16 v[32:35], v[128:131], a[240:243], v[32:35]
s_xor_b32 s80, s93, 0x100000
buffer_load_dword v6, v113, s[44:47], s73 offen sc1
v_mfma_f32_16x16x32_bf16 v[32:35], v[144:147], a[244:247], v[32:35]
s_add_u32 s72, s71, 30720
buffer_load_dwordx4 v15, s[24:27], s72 offen offset:2048 lds
v_mfma_f32_16x16x32_bf16 v[32:35], v[160:163], a[248:251], v[32:35]
s_add_u32 s80, s80, 0x3a00000
buffer_store_dwordx4 v[16:19], v1, s[44:47], s80 offen sc1
v_mfma_f32_16x16x32_bf16 v[32:35], v[176:179], a[252:255], v[32:35]
s_nop 0
ds_read_b64_tr_b16 v[236:237], v11 offset:40960
ds_read_b64_tr_b16 v[238:239], v11 offset:43008
v_cvt_pk_bf16_f32 v20, v24, v25
v_mfma_f32_16x16x32_bf16 v[36:39], v[180:183], a[252:255], v[36:39]
s_nop 0
ds_read_b64_tr_b16 v[240:241], v8 offset:45056
ds_read_b64_tr_b16 v[242:243], v8 offset:47104
v_cvt_pk_bf16_f32 v21, v26, v27
v_mfma_f32_16x16x32_bf16 v[36:39], v[164:167], a[248:251], v[36:39]
s_add_u32 s72, s71, 46080
buffer_load_dwordx4 v15, s[24:27], s72 offen offset:3072 lds
v_cvt_pk_bf16_f32 v22, v28, v29
v_mfma_f32_16x16x32_bf16 v[36:39], v[148:151], a[244:247], v[36:39]
s_nop 0
ds_read_b64_tr_b16 v[244:245], v9 offset:45056
ds_read_b64_tr_b16 v[246:247], v9 offset:47104
v_cvt_pk_bf16_f32 v23, v30, v31
v_mfma_f32_16x16x32_bf16 v[36:39], v[132:135], a[240:243], v[36:39]
s_xor_b32 s71, s15, 0x40180
ds_read_b64_tr_b16 v[248:249], v10 offset:45056
ds_read_b64_tr_b16 v[250:251], v10 offset:47104
v_mfma_f32_16x16x32_bf16 v[40:43], v[136:139], a[240:243], v[40:43]
s_add_u32 m0, s85, 49152
ds_read_b64_tr_b16 v[252:253], v11 offset:45056
ds_read_b64_tr_b16 v[254:255], v11 offset:47104
v_mfma_f32_16x16x32_bf16 v[40:43], v[152:155], a[244:247], v[40:43]
s_add_u32 s72, s71, 0
buffer_load_dwordx4 v15, s[24:27], s72 offen lds
v_mfma_f32_16x16x32_bf16 v[40:43], v[168:171], a[248:251], v[40:43]
buffer_load_dword v7, v113, s[44:47], s73 offen offset:64 sc1
v_mfma_f32_16x16x32_bf16 v[40:43], v[184:187], a[252:255], v[40:43]
v_cvt_pk_bf16_f32 v24, v32, v33
v_cvt_pk_bf16_f32 v25, v34, v35
v_cvt_pk_bf16_f32 v26, v36, v37
v_mfma_f32_16x16x32_bf16 v[44:47], v[188:191], a[252:255], v[44:47]
v_cvt_pk_bf16_f32 v27, v38, v39
v_mfma_f32_16x16x32_bf16 v[44:47], v[172:175], a[248:251], v[44:47]
s_add_u32 s72, s71, 15360
v_mfma_f32_16x16x32_bf16 v[44:47], v[156:159], a[244:247], v[44:47]
s_waitcnt vmcnt(16) lgkmcnt(0)
buffer_load_dwordx4 v15, s[24:27], s72 offen offset:1024 lds
v_mfma_f32_16x16x32_bf16 v[44:47], v[140:143], a[240:243], v[44:47]
s_barrier
v_mfma_f32_16x16x32_bf16 v[48:51], v[192:195], a[160:163], v[48:51]
s_nop 0
ds_read_b64_tr_b16 v[128:129], v8 offset:49152
ds_read_b64_tr_b16 v[130:131], v8 offset:51200
v_mfma_f32_16x16x32_bf16 v[48:51], v[208:211], a[164:167], v[48:51]
s_nop 0
ds_read_b64_tr_b16 v[132:133], v9 offset:49152
ds_read_b64_tr_b16 v[134:135], v9 offset:51200
v_mfma_f32_16x16x32_bf16 v[48:51], v[224:227], a[168:171], v[48:51]
buffer_store_dwordx4 v[20:23], v1, s[44:47], s80 offen offset:1024 sc1
v_mfma_f32_16x16x32_bf16 v[48:51], v[240:243], a[172:175], v[48:51]
s_nop 0
ds_read_b64_tr_b16 v[136:137], v10 offset:49152
ds_read_b64_tr_b16 v[138:139], v10 offset:51200
v_cvt_pk_bf16_f32 v28, v40, v41
v_mfma_f32_16x16x32_bf16 v[64:67], v[240:243], a[188:191], v[64:67]
v_cvt_pk_bf16_f32 v29, v42, v43
v_cvt_pk_bf16_f32 v30, v44, v45
v_cvt_pk_bf16_f32 v31, v46, v47
v_mfma_f32_16x16x32_bf16 v[64:67], v[224:227], a[184:187], v[64:67]
s_nop 0
ds_read_b64_tr_b16 v[140:141], v11 offset:49152
ds_read_b64_tr_b16 v[142:143], v11 offset:51200
v_mfma_f32_16x16x32_bf16 v[64:67], v[208:211], a[180:183], v[64:67]
s_add_u32 s72, s71, 30720
buffer_load_dwordx4 v15, s[24:27], s72 offen offset:2048 lds
v_mfma_f32_16x16x32_bf16 v[64:67], v[192:195], a[176:179], v[64:67]
s_nop 0
ds_read_b64_tr_b16 v[144:145], v8 offset:53248
ds_read_b64_tr_b16 v[146:147], v8 offset:55296
v_mfma_f32_16x16x32_bf16 v[68:71], v[196:199], a[176:179], v[68:71]
s_nop 0
ds_read_b64_tr_b16 v[148:149], v9 offset:53248
ds_read_b64_tr_b16 v[150:151], v9 offset:55296
v_mfma_f32_16x16x32_bf16 v[68:71], v[212:215], a[180:183], v[68:71]
v_mfma_f32_16x16x32_bf16 v[68:71], v[228:231], a[184:187], v[68:71]
s_nop 0
ds_read_b64_tr_b16 v[152:153], v10 offset:53248
ds_read_b64_tr_b16 v[154:155], v10 offset:55296
v_mfma_f32_16x16x32_bf16 v[68:71], v[244:247], a[188:191], v[68:71]
s_nop 0
ds_read_b64_tr_b16 v[156:157], v11 offset:53248
ds_read_b64_tr_b16 v[158:159], v11 offset:55296
v_mfma_f32_16x16x32_bf16 v[52:55], v[244:247], a[172:175], v[52:55]
v_mfma_f32_16x16x32_bf16 v[52:55], v[228:231], a[168:171], v[52:55]
s_add_u32 s72, s71, 46080
buffer_load_dwordx4 v15, s[24:27], s72 offen offset:3072 lds
v_mfma_f32_16x16x32_bf16 v[52:55], v[212:215], a[164:167], v[52:55]
s_nop 0
ds_read_b64_tr_b16 v[160:161], v8 offset:57344
ds_read_b64_tr_b16 v[162:163], v8 offset:59392
v_mfma_f32_16x16x32_bf16 v[52:55], v[196:199], a[160:163], v[52:55]
s_nop 0
ds_read_b64_tr_b16 v[164:165], v9 offset:57344
ds_read_b64_tr_b16 v[166:167], v9 offset:59392
v_mfma_f32_16x16x32_bf16 v[56:59], v[200:203], a[160:163], v[56:59]
s_nop 0
ds_read_b64_tr_b16 v[168:169], v10 offset:57344
ds_read_b64_tr_b16 v[170:171], v10 offset:59392
v_mfma_f32_16x16x32_bf16 v[56:59], v[216:219], a[164:167], v[56:59]
v_mfma_f32_16x16x32_bf16 v[56:59], v[232:235], a[168:171], v[56:59]
buffer_store_dwordx4 v[24:27], v1, s[44:47], s80 offen offset:2048 sc1
v_mfma_f32_16x16x32_bf16 v[56:59], v[248:251], a[172:175], v[56:59]
s_xor_b32 s71, s12, 0x0
ds_read_b64_tr_b16 v[172:173], v11 offset:57344
ds_read_b64_tr_b16 v[174:175], v11 offset:59392
v_mfma_f32_16x16x32_bf16 v[72:75], v[248:251], a[188:191], v[72:75]
s_add_u32 m0, s77, 0
ds_read_b64_tr_b16 v[176:177], v8 offset:61440
ds_read_b64_tr_b16 v[178:179], v8 offset:63488
v_mfma_f32_16x16x32_bf16 v[72:75], v[232:235], a[184:187], v[72:75]
s_add_u32 s72, s71, 0
buffer_load_dwordx4 v15, s[24:27], s72 offen lds
v_mfma_f32_16x16x32_bf16 v[72:75], v[216:219], a[180:183], v[72:75]
s_nop 0
ds_read_b64_tr_b16 v[180:181], v9 offset:61440
ds_read_b64_tr_b16 v[182:183], v9 offset:63488
v_mfma_f32_16x16x32_bf16 v[72:75], v[200:203], a[176:179], v[72:75]
v_mfma_f32_16x16x32_bf16 v[76:79], v[204:207], a[176:179], v[76:79]
s_nop 0
ds_read_b64_tr_b16 v[184:185], v10 offset:61440
ds_read_b64_tr_b16 v[186:187], v10 offset:63488
v_mfma_f32_16x16x32_bf16 v[76:79], v[220:223], a[180:183], v[76:79]
s_nop 0
ds_read_b64_tr_b16 v[188:189], v11 offset:61440
ds_read_b64_tr_b16 v[190:191], v11 offset:63488
v_mfma_f32_16x16x32_bf16 v[76:79], v[236:239], a[184:187], v[76:79]
v_mfma_f32_16x16x32_bf16 v[76:79], v[252:255], a[188:191], v[76:79]
v_mfma_f32_16x16x32_bf16 v[60:63], v[252:255], a[172:175], v[60:63]
s_add_u32 s72, s71, 15360
buffer_load_dwordx4 v15, s[24:27], s72 offen offset:1024 lds
v_xor_b32 v8, 0x10000, v8
v_mfma_f32_16x16x32_bf16 v[60:63], v[236:239], a[168:171], v[60:63]
v_xor_b32 v9, 0x10000, v9
v_mfma_f32_16x16x32_bf16 v[60:63], v[220:223], a[164:167], v[60:63]
s_waitcnt lgkmcnt(0)
v_xor_b32 v10, 0x10000, v10
v_mfma_f32_16x16x32_bf16 v[60:63], v[204:207], a[160:163], v[60:63]
v_xor_b32 v11, 0x10000, v11
v_mfma_f32_16x16x32_bf16 v[48:51], v[128:131], a[192:195], v[48:51]
s_nop 0
ds_read_b64_tr_b16 v[192:193], v8 offset:0
ds_read_b64_tr_b16 v[194:195], v8 offset:2048
v_mfma_f32_16x16x32_bf16 v[48:51], v[144:147], a[196:199], v[48:51]
s_nop 0
ds_read_b64_tr_b16 v[196:197], v9 offset:0
ds_read_b64_tr_b16 v[198:199], v9 offset:2048
v_mfma_f32_16x16x32_bf16 v[48:51], v[160:163], a[200:203], v[48:51]
s_nop 0
ds_read_b64_tr_b16 v[200:201], v10 offset:0
ds_read_b64_tr_b16 v[202:203], v10 offset:2048
v_mfma_f32_16x16x32_bf16 v[48:51], v[176:179], a[204:207], v[48:51]
v_mfma_f32_16x16x32_bf16 v[64:67], v[176:179], a[220:223], v[64:67]
s_add_u32 s72, s71, 30720
buffer_load_dwordx4 v15, s[24:27], s72 offen offset:2048 lds
v_mfma_f32_16x16x32_bf16 v[64:67], v[160:163], a[216:219], v[64:67]
s_nop 0
ds_read_b64_tr_b16 v[204:205], v11 offset:0
ds_read_b64_tr_b16 v[206:207], v11 offset:2048
v_mfma_f32_16x16x32_bf16 v[64:67], v[144:147], a[212:215], v[64:67]
s_nop 0
ds_read_b64_tr_b16 v[208:209], v8 offset:4096
ds_read_b64_tr_b16 v[210:211], v8 offset:6144
v_mfma_f32_16x16x32_bf16 v[64:67], v[128:131], a[208:211], v[64:67]
buffer_store_dwordx4 v[28:31], v1, s[44:47], s80 offen offset:3072 sc1
v_mfma_f32_16x16x32_bf16 v[68:71], v[132:135], a[208:211], v[68:71]
s_nop 0
ds_read_b64_tr_b16 v[212:213], v9 offset:4096
ds_read_b64_tr_b16 v[214:215], v9 offset:6144
v_mfma_f32_16x16x32_bf16 v[68:71], v[148:151], a[212:215], v[68:71]
v_mfma_f32_16x16x32_bf16 v[68:71], v[164:167], a[216:219], v[68:71]
s_nop 0
ds_read_b64_tr_b16 v[216:217], v10 offset:4096
ds_read_b64_tr_b16 v[218:219], v10 offset:6144
v_mfma_f32_16x16x32_bf16 v[68:71], v[180:183], a[220:223], v[68:71]
s_add_u32 s72, s71, 46080
buffer_load_dwordx4 v15, s[24:27], s72 offen offset:3072 lds
v_mfma_f32_16x16x32_bf16 v[52:55], v[180:183], a[204:207], v[52:55]
s_nop 0
ds_read_b64_tr_b16 v[220:221], v11 offset:4096
ds_read_b64_tr_b16 v[222:223], v11 offset:6144
v_mfma_f32_16x16x32_bf16 v[52:55], v[164:167], a[200:203], v[52:55]
v_mfma_f32_16x16x32_bf16 v[52:55], v[148:151], a[196:199], v[52:55]
s_nop 0
ds_read_b64_tr_b16 v[224:225], v8 offset:8192
ds_read_b64_tr_b16 v[226:227], v8 offset:10240
v_mfma_f32_16x16x32_bf16 v[52:55], v[132:135], a[192:195], v[52:55]
s_nop 0
ds_read_b64_tr_b16 v[228:229], v9 offset:8192
ds_read_b64_tr_b16 v[230:231], v9 offset:10240
v_mfma_f32_16x16x32_bf16 v[56:59], v[136:139], a[192:195], v[56:59]
s_nop 0
ds_read_b64_tr_b16 v[232:233], v10 offset:8192
ds_read_b64_tr_b16 v[234:235], v10 offset:10240
v_mfma_f32_16x16x32_bf16 v[56:59], v[152:155], a[196:199], v[56:59]
s_xor_b32 s71, s13, 0x0
v_mfma_f32_16x16x32_bf16 v[56:59], v[168:171], a[200:203], v[56:59]
s_add_u32 m0, s77, 16384
ds_read_b64_tr_b16 v[236:237], v11 offset:8192
ds_read_b64_tr_b16 v[238:239], v11 offset:10240
v_mfma_f32_16x16x32_bf16 v[56:59], v[184:187], a[204:207], v[56:59]
s_add_u32 s72, s71, 0
buffer_load_dwordx4 v15, s[24:27], s72 offen lds
v_mfma_f32_16x16x32_bf16 v[72:75], v[184:187], a[220:223], v[72:75]
s_nop 0
ds_read_b64_tr_b16 v[240:241], v8 offset:12288
ds_read_b64_tr_b16 v[242:243], v8 offset:14336
v_mfma_f32_16x16x32_bf16 v[72:75], v[168:171], a[216:219], v[72:75]
s_nop 0
ds_read_b64_tr_b16 v[244:245], v9 offset:12288
ds_read_b64_tr_b16 v[246:247], v9 offset:14336
v_mfma_f32_16x16x32_bf16 v[72:75], v[152:155], a[212:215], v[72:75]
v_mfma_f32_16x16x32_bf16 v[72:75], v[136:139], a[208:211], v[72:75]
s_nop 0
ds_read_b64_tr_b16 v[248:249], v10 offset:12288
ds_read_b64_tr_b16 v[250:251], v10 offset:14336
v_mfma_f32_16x16x32_bf16 v[76:79], v[140:143], a[208:211], v[76:79]
s_nop 0
ds_read_b64_tr_b16 v[252:253], v11 offset:12288
ds_read_b64_tr_b16 v[254:255], v11 offset:14336
v_mfma_f32_16x16x32_bf16 v[76:79], v[156:159], a[212:215], v[76:79]
v_mfma_f32_16x16x32_bf16 v[76:79], v[172:175], a[216:219], v[76:79]
s_add_u32 s72, s71, 15360
buffer_load_dwordx4 v15, s[24:27], s72 offen offset:1024 lds
v_mfma_f32_16x16x32_bf16 v[76:79], v[188:191], a[220:223], v[76:79]
v_mfma_f32_16x16x32_bf16 v[60:63], v[188:191], a[204:207], v[60:63]
v_mfma_f32_16x16x32_bf16 v[60:63], v[172:175], a[200:203], v[60:63]
v_mfma_f32_16x16x32_bf16 v[60:63], v[156:159], a[196:199], v[60:63]
s_waitcnt vmcnt(14) lgkmcnt(0)
v_mfma_f32_16x16x32_bf16 v[60:63], v[140:143], a[192:195], v[60:63]
s_barrier
v_mfma_f32_16x16x32_bf16 v[48:51], v[192:195], a[224:227], v[48:51]
s_nop 0
ds_read_b64_tr_b16 v[128:129], v8 offset:16384
ds_read_b64_tr_b16 v[130:131], v8 offset:18432
v_mfma_f32_16x16x32_bf16 v[48:51], v[208:211], a[228:231], v[48:51]
s_add_u32 s72, s71, 30720
buffer_load_dwordx4 v15, s[24:27], s72 offen offset:2048 lds
v_mfma_f32_16x16x32_bf16 v[48:51], v[224:227], a[232:235], v[48:51]
s_nop 0
ds_read_b64_tr_b16 v[132:133], v9 offset:16384
ds_read_b64_tr_b16 v[134:135], v9 offset:18432
v_mfma_f32_16x16x32_bf16 v[48:51], v[240:243], a[236:239], v[48:51]
s_nop 0
ds_read_b64_tr_b16 v[136:137], v10 offset:16384
ds_read_b64_tr_b16 v[138:139], v10 offset:18432
v_mfma_f32_16x16x32_bf16 v[52:55], v[244:247], a[236:239], v[52:55]
v_mfma_f32_16x16x32_bf16 v[52:55], v[228:231], a[232:235], v[52:55]
s_nop 0
ds_read_b64_tr_b16 v[140:141], v11 offset:16384
ds_read_b64_tr_b16 v[142:143], v11 offset:18432
v_mfma_f32_16x16x32_bf16 v[52:55], v[212:215], a[228:231], v[52:55]
s_nop 0
ds_read_b64_tr_b16 v[144:145], v8 offset:20480
ds_read_b64_tr_b16 v[146:147], v8 offset:22528
v_mfma_f32_16x16x32_bf16 v[52:55], v[196:199], a[224:227], v[52:55]
s_nop 0
ds_read_b64_tr_b16 v[148:149], v9 offset:20480
ds_read_b64_tr_b16 v[150:151], v9 offset:22528
v_mfma_f32_16x16x32_bf16 v[56:59], v[200:203], a[224:227], v[56:59]
s_add_u32 s72, s71, 46080
buffer_load_dwordx4 v15, s[24:27], s72 offen offset:3072 lds
v_mfma_f32_16x16x32_bf16 v[56:59], v[216:219], a[228:231], v[56:59]
v_mfma_f32_16x16x32_bf16 v[56:59], v[232:235], a[232:235], v[56:59]
s_nop 0
ds_read_b64_tr_b16 v[152:153], v10 offset:20480
ds_read_b64_tr_b16 v[154:155], v10 offset:22528
v_mfma_f32_16x16x32_bf16 v[56:59], v[248:251], a[236:239], v[56:59]
s_nop 0
ds_read_b64_tr_b16 v[156:157], v11 offset:20480
ds_read_b64_tr_b16 v[158:159], v11 offset:22528
v_cvt_pk_bf16_f32 v48, v48, v49
v_mfma_f32_16x16x32_bf16 v[60:63], v[252:255], a[236:239], v[60:63]
v_cvt_pk_bf16_f32 v49, v50, v51
v_cvt_pk_bf16_f32 v50, v52, v53
v_cvt_pk_bf16_f32 v51, v54, v55
v_mfma_f32_16x16x32_bf16 v[60:63], v[236:239], a[232:235], v[60:63]
s_nop 0
ds_read_b64_tr_b16 v[160:161], v8 offset:24576
ds_read_b64_tr_b16 v[162:163], v8 offset:26624
v_mfma_f32_16x16x32_bf16 v[60:63], v[220:223], a[228:231], v[60:63]
s_xor_b32 s71, s14, 0x0
ds_read_b64_tr_b16 v[164:165], v9 offset:24576
ds_read_b64_tr_b16 v[166:167], v9 offset:26624
v_mfma_f32_16x16x32_bf16 v[60:63], v[204:207], a[224:227], v[60:63]
s_add_u32 m0, s77, 32768
ds_read_b64_tr_b16 v[168:169], v10 offset:24576
ds_read_b64_tr_b16 v[170:171], v10 offset:26624
v_mfma_f32_16x16x32_bf16 v[64:67], v[192:195], a[240:243], v[64:67]
s_add_u32 s72, s71, 0
buffer_load_dwordx4 v15, s[24:27], s72 offen lds
v_mfma_f32_16x16x32_bf16 v[64:67], v[208:211], a[244:247], v[64:67]
v_mfma_f32_16x16x32_bf16 v[64:67], v[224:227], a[248:251], v[64:67]
s_xor_b32 s80, s93, 0x200000
ds_read_b64_tr_b16 v[172:173], v11 offset:24576
ds_read_b64_tr_b16 v[174:175], v11 offset:26624
v_mfma_f32_16x16x32_bf16 v[64:67], v[240:243], a[252:255], v[64:67]
s_add_u32 s80, s80, 0x3e00000
buffer_store_dwordx4 v[48:51], v1, s[44:47], s80 offen sc1
v_cvt_pk_bf16_f32 v52, v56, v57
v_mfma_f32_16x16x32_bf16 v[68:71], v[244:247], a[252:255], v[68:71]
s_nop 0
ds_read_b64_tr_b16 v[176:177], v8 offset:28672
ds_read_b64_tr_b16 v[178:179], v8 offset:30720
v_cvt_pk_bf16_f32 v53, v58, v59
v_mfma_f32_16x16x32_bf16 v[68:71], v[228:231], a[248:251], v[68:71]
s_nop 0
ds_read_b64_tr_b16 v[180:181], v9 offset:28672
ds_read_b64_tr_b16 v[182:183], v9 offset:30720
v_cvt_pk_bf16_f32 v54, v60, v61
v_mfma_f32_16x16x32_bf16 v[68:71], v[212:215], a[244:247], v[68:71]
v_cvt_pk_bf16_f32 v55, v62, v63
v_mfma_f32_16x16x32_bf16 v[68:71], v[196:199], a[240:243], v[68:71]
s_add_u32 s72, s71, 15360
buffer_load_dwordx4 v15, s[24:27], s72 offen offset:1024 lds
v_mfma_f32_16x16x32_bf16 v[72:75], v[200:203], a[240:243], v[72:75]
s_nop 0
ds_read_b64_tr_b16 v[184:185], v10 offset:28672
ds_read_b64_tr_b16 v[186:187], v10 offset:30720
v_mfma_f32_16x16x32_bf16 v[72:75], v[216:219], a[244:247], v[72:75]
s_nop 0
ds_read_b64_tr_b16 v[188:189], v11 offset:28672
ds_read_b64_tr_b16 v[190:191], v11 offset:30720
v_mfma_f32_16x16x32_bf16 v[72:75], v[232:235], a[248:251], v[72:75]
v_mfma_f32_16x16x32_bf16 v[72:75], v[248:251], a[252:255], v[72:75]
v_cvt_pk_bf16_f32 v56, v64, v65
v_cvt_pk_bf16_f32 v57, v66, v67
v_cvt_pk_bf16_f32 v58, v68, v69
v_mfma_f32_16x16x32_bf16 v[76:79], v[252:255], a[252:255], v[76:79]
v_cvt_pk_bf16_f32 v59, v70, v71
v_mfma_f32_16x16x32_bf16 v[76:79], v[236:239], a[248:251], v[76:79]
s_add_u32 s72, s71, 30720
v_mfma_f32_16x16x32_bf16 v[76:79], v[220:223], a[244:247], v[76:79]
s_waitcnt lgkmcnt(0)
v_mfma_f32_16x16x32_bf16 v[76:79], v[204:207], a[240:243], v[76:79]
buffer_load_dwordx4 v15, s[24:27], s72 offen offset:2048 lds
v_mfma_f32_16x16x32_bf16 v[80:83], v[128:131], a[160:163], v[80:83]
s_waitcnt vmcnt(18)
ds_read_b64_tr_b16 v[192:193], v8 offset:32768
ds_read_b64_tr_b16 v[194:195], v8 offset:34816
v_mfma_f32_16x16x32_bf16 v[80:83], v[144:147], a[164:167], v[80:83]
s_nop 0
ds_read_b64_tr_b16 v[196:197], v9 offset:32768
ds_read_b64_tr_b16 v[198:199], v9 offset:34816
v_mfma_f32_16x16x32_bf16 v[80:83], v[160:163], a[168:171], v[80:83]
s_nop 0
ds_read_b64_tr_b16 v[200:201], v10 offset:32768
ds_read_b64_tr_b16 v[202:203], v10 offset:34816
v_mfma_f32_16x16x32_bf16 v[80:83], v[176:179], a[172:175], v[80:83]
s_nop 0
buffer_store_dwordx4 v[52:55], v1, s[44:47], s80 offen offset:1024 sc1
v_cvt_pk_bf16_f32 v60, v72, v73
v_mfma_f32_16x16x32_bf16 v[96:99], v[176:179], a[188:191], v[96:99]
v_cvt_pk_bf16_f32 v61, v74, v75
v_cvt_pk_bf16_f32 v62, v76, v77
v_cvt_pk_bf16_f32 v63, v78, v79
v_mfma_f32_16x16x32_bf16 v[96:99], v[160:163], a[184:187], v[96:99]
s_nop 0
ds_read_b64_tr_b16 v[204:205], v11 offset:32768
ds_read_b64_tr_b16 v[206:207], v11 offset:34816
v_mfma_f32_16x16x32_bf16 v[96:99], v[144:147], a[180:183], v[96:99]
s_add_u32 s72, s71, 46080
buffer_load_dwordx4 v15, s[24:27], s72 offen offset:3072 lds
v_mfma_f32_16x16x32_bf16 v[96:99], v[128:131], a[176:179], v[96:99]
s_nop 0
ds_read_b64_tr_b16 v[208:209], v8 offset:36864
ds_read_b64_tr_b16 v[210:211], v8 offset:38912
v_mfma_f32_16x16x32_bf16 v[100:103], v[132:135], a[176:179], v[100:103]
s_nop 0
ds_read_b64_tr_b16 v[212:213], v9 offset:36864
ds_read_b64_tr_b16 v[214:215], v9 offset:38912
v_mfma_f32_16x16x32_bf16 v[100:103], v[148:151], a[180:183], v[100:103]
v_sub_f32 v112, 1.0, v6
v_sub_f32 v113, 1.0, v7
v_mfma_f32_16x16x32_bf16 v[100:103], v[164:167], a[184:187], v[100:103]
s_nop 0
ds_read_b64_tr_b16 v[216:217], v10 offset:36864
ds_read_b64_tr_b16 v[218:219], v10 offset:38912
v_mfma_f32_16x16x32_bf16 v[100:103], v[180:183], a[188:191], v[100:103]
s_nop 0
ds_read_b64_tr_b16 v[220:221], v11 offset:36864
ds_read_b64_tr_b16 v[222:223], v11 offset:38912
v_mfma_f32_16x16x32_bf16 v[84:87], v[180:183], a[172:175], v[84:87]
s_xor_b32 s71, s15, 0x0
v_mfma_f32_16x16x32_bf16 v[84:87], v[164:167], a[168:171], v[84:87]
s_add_u32 m0, s77, 49152
ds_read_b64_tr_b16 v[224:225], v8 offset:40960
ds_read_b64_tr_b16 v[226:227], v8 offset:43008
v_mfma_f32_16x16x32_bf16 v[84:87], v[148:151], a[164:167], v[84:87]
s_add_u32 s72, s71, 0
buffer_load_dwordx4 v15, s[24:27], s72 offen lds
v_mfma_f32_16x16x32_bf16 v[84:87], v[132:135], a[160:163], v[84:87]
s_nop 0
ds_read_b64_tr_b16 v[228:229], v9 offset:40960
ds_read_b64_tr_b16 v[230:231], v9 offset:43008
v_mfma_f32_16x16x32_bf16 v[88:91], v[136:139], a[160:163], v[88:91]
s_nop 0
ds_read_b64_tr_b16 v[232:233], v10 offset:40960
ds_read_b64_tr_b16 v[234:235], v10 offset:43008
v_mfma_f32_16x16x32_bf16 v[88:91], v[152:155], a[164:167], v[88:91]
v_mfma_f32_16x16x32_bf16 v[88:91], v[168:171], a[168:171], v[88:91]
s_nop 0
ds_read_b64_tr_b16 v[236:237], v11 offset:40960
ds_read_b64_tr_b16 v[238:239], v11 offset:43008
v_mfma_f32_16x16x32_bf16 v[88:91], v[184:187], a[172:175], v[88:91]
s_nop 0
ds_read_b64_tr_b16 v[240:241], v8 offset:45056
ds_read_b64_tr_b16 v[242:243], v8 offset:47104
v_mfma_f32_16x16x32_bf16 v[104:107], v[184:187], a[188:191], v[104:107]
s_nop 0
ds_read_b64_tr_b16 v[244:245], v9 offset:45056
ds_read_b64_tr_b16 v[246:247], v9 offset:47104
v_mfma_f32_16x16x32_bf16 v[104:107], v[168:171], a[184:187], v[104:107]
s_add_u32 s72, s71, 15360
buffer_load_dwordx4 v15, s[24:27], s72 offen offset:1024 lds
v_mfma_f32_16x16x32_bf16 v[104:107], v[152:155], a[180:183], v[104:107]
v_mfma_f32_16x16x32_bf16 v[104:107], v[136:139], a[176:179], v[104:107]
s_nop 0
ds_read_b64_tr_b16 v[248:249], v10 offset:45056
ds_read_b64_tr_b16 v[250:251], v10 offset:47104
v_mfma_f32_16x16x32_bf16 v[108:111], v[140:143], a[176:179], v[108:111]
buffer_store_dwordx4 v[56:59], v1, s[44:47], s80 offen offset:2048 sc1
v_mfma_f32_16x16x32_bf16 v[108:111], v[156:159], a[180:183], v[108:111]
s_nop 0
ds_read_b64_tr_b16 v[252:253], v11 offset:45056
ds_read_b64_tr_b16 v[254:255], v11 offset:47104
v_mfma_f32_16x16x32_bf16 v[108:111], v[172:175], a[184:187], v[108:111]
v_mfma_f32_16x16x32_bf16 v[108:111], v[188:191], a[188:191], v[108:111]
v_mfma_f32_16x16x32_bf16 v[92:95], v[188:191], a[172:175], v[92:95]
v_mfma_f32_16x16x32_bf16 v[92:95], v[172:175], a[168:171], v[92:95]
s_add_u32 s72, s71, 30720
buffer_load_dwordx4 v15, s[24:27], s72 offen offset:2048 lds
v_mfma_f32_16x16x32_bf16 v[92:95], v[156:159], a[164:167], v[92:95]
s_waitcnt vmcnt(14) lgkmcnt(0)
v_mfma_f32_16x16x32_bf16 v[92:95], v[140:143], a[160:163], v[92:95]
s_barrier
v_mfma_f32_16x16x32_bf16 v[80:83], v[192:195], a[192:195], v[80:83]
s_nop 0
ds_read_b64_tr_b16 v[128:129], v8 offset:49152
ds_read_b64_tr_b16 v[130:131], v8 offset:51200
v_mfma_f32_16x16x32_bf16 v[80:83], v[208:211], a[196:199], v[80:83]
s_nop 0
ds_read_b64_tr_b16 v[132:133], v9 offset:49152
ds_read_b64_tr_b16 v[134:135], v9 offset:51200
v_mfma_f32_16x16x32_bf16 v[80:83], v[224:227], a[200:203], v[80:83]
s_nop 0
ds_read_b64_tr_b16 v[136:137], v10 offset:49152
ds_read_b64_tr_b16 v[138:139], v10 offset:51200
v_mfma_f32_16x16x32_bf16 v[80:83], v[240:243], a[204:207], v[80:83]
v_mfma_f32_16x16x32_bf16 v[96:99], v[240:243], a[220:223], v[96:99]
s_add_u32 s72, s71, 46080
buffer_load_dwordx4 v15, s[24:27], s72 offen offset:3072 lds
v_mfma_f32_16x16x32_bf16 v[96:99], v[224:227], a[216:219], v[96:99]
s_nop 0
ds_read_b64_tr_b16 v[140:141], v11 offset:49152
ds_read_b64_tr_b16 v[142:143], v11 offset:51200
v_mfma_f32_16x16x32_bf16 v[96:99], v[208:211], a[212:215], v[96:99]
s_nop 0
ds_read_b64_tr_b16 v[144:145], v8 offset:53248
ds_read_b64_tr_b16 v[146:147], v8 offset:55296
v_mfma_f32_16x16x32_bf16 v[96:99], v[192:195], a[208:211], v[96:99]
s_nop 0
ds_read_b64_tr_b16 v[148:149], v9 offset:53248
ds_read_b64_tr_b16 v[150:151], v9 offset:55296
v_mfma_f32_16x16x32_bf16 v[100:103], v[196:199], a[208:211], v[100:103]
buffer_store_dwordx4 v[60:63], v1, s[44:47], s80 offen offset:3072 sc1
v_mfma_f32_16x16x32_bf16 v[100:103], v[212:215], a[212:215], v[100:103]
s_nop 0
ds_read_b64 v[48:49], v116 offset:0
ds_read_b64_tr_b16 v[64:65], v5 offset:0
v_mfma_f32_16x16x32_bf16 v[100:103], v[228:231], a[216:219], v[100:103]
s_xor_b32 s71, s12, 0x40000
ds_read_b64_tr_b16 v[152:153], v10 offset:53248
ds_read_b64_tr_b16 v[154:155], v10 offset:55296
v_mfma_f32_16x16x32_bf16 v[100:103], v[244:247], a[220:223], v[100:103]
s_add_u32 m0, s85, 0
ds_read_b64_tr_b16 v[156:157], v11 offset:53248
ds_read_b64_tr_b16 v[158:159], v11 offset:55296
v_mfma_f32_16x16x32_bf16 v[84:87], v[244:247], a[204:207], v[84:87]
s_add_u32 s72, s71, 0
buffer_load_dwordx4 v15, s[24:27], s72 offen lds
v_mfma_f32_16x16x32_bf16 v[84:87], v[228:231], a[200:203], v[84:87]
Lstube3:
s_cbranch_execz Lrete
s_nop 0
ds_read_b64 v[50:51], v117 offset:0
ds_read_b64_tr_b16 v[66:67], v5 offset:4096
v_mfma_f32_16x16x32_bf16 v[84:87], v[212:215], a[196:199], v[84:87]
s_nop 0
ds_read_b64_tr_b16 v[160:161], v8 offset:57344
ds_read_b64_tr_b16 v[162:163], v8 offset:59392
v_mfma_f32_16x16x32_bf16 v[84:87], v[196:199], a[192:195], v[84:87]
s_nop 0
ds_read_b64_tr_b16 v[164:165], v9 offset:57344
ds_read_b64_tr_b16 v[166:167], v9 offset:59392
v_mfma_f32_16x16x32_bf16 v[88:91], v[200:203], a[192:195], v[88:91]
s_nop 0
ds_read_b64_tr_b16 v[168:169], v10 offset:57344
ds_read_b64_tr_b16 v[170:171], v10 offset:59392
v_mfma_f32_16x16x32_bf16 v[88:91], v[216:219], a[196:199], v[88:91]
s_nop 0
ds_read_b64 v[52:53], v118 offset:0
ds_read_b64_tr_b16 v[68:69], v5 offset:8192
v_mfma_f32_16x16x32_bf16 v[88:91], v[232:235], a[200:203], v[88:91]
s_nop 0
ds_read_b64_tr_b16 v[172:173], v11 offset:57344
ds_read_b64_tr_b16 v[174:175], v11 offset:59392
v_mfma_f32_16x16x32_bf16 v[88:91], v[248:251], a[204:207], v[88:91]
s_add_u32 s72, s71, 15360
buffer_load_dwordx4 v15, s[24:27], s72 offen offset:1024 lds
v_mfma_f32_16x16x32_bf16 v[104:107], v[248:251], a[220:223], v[104:107]
s_nop 0
ds_read_b64_tr_b16 v[176:177], v8 offset:61440
ds_read_b64_tr_b16 v[178:179], v8 offset:63488
v_mfma_f32_16x16x32_bf16 v[104:107], v[232:235], a[216:219], v[104:107]
s_nop 0
ds_read_b64_tr_b16 v[180:181], v9 offset:61440
ds_read_b64_tr_b16 v[182:183], v9 offset:63488
v_mfma_f32_16x16x32_bf16 v[104:107], v[216:219], a[212:215], v[104:107]
s_nop 0
ds_read_b64 v[54:55], v119 offset:0
ds_read_b64_tr_b16 v[70:71], v5 offset:12288
v_mfma_f32_16x16x32_bf16 v[104:107], v[200:203], a[208:211], v[104:107]
s_nop 0
ds_read_b64_tr_b16 v[184:185], v10 offset:61440
ds_read_b64_tr_b16 v[186:187], v10 offset:63488
v_mfma_f32_16x16x32_bf16 v[108:111], v[204:207], a[208:211], v[108:111]
s_nop 0
ds_read_b64_tr_b16 v[188:189], v11 offset:61440
ds_read_b64_tr_b16 v[190:191], v11 offset:63488
v_mfma_f32_16x16x32_bf16 v[108:111], v[220:223], a[212:215], v[108:111]
v_xor_b32 v5, 16, v5
v_mfma_f32_16x16x32_bf16 v[108:111], v[236:239], a[216:219], v[108:111]
s_add_u32 s72, s71, 30720
buffer_load_dwordx4 v15, s[24:27], s72 offen offset:2048 lds
v_mfma_f32_16x16x32_bf16 v[108:111], v[252:255], a[220:223], v[108:111]
s_nop 0
ds_read_b64 v[56:57], v116 offset:2048
ds_read_b64_tr_b16 v[72:73], v5 offset:0
v_mfma_f32_16x16x32_bf16 v[92:95], v[252:255], a[204:207], v[92:95]
ds_read_b64 v[58:59], v117 offset:2048
v_xor_b32 v8, 0x10000, v8
v_mfma_f32_16x16x32_bf16 v[92:95], v[236:239], a[200:203], v[92:95]
ds_read_b64_tr_b16 v[74:75], v5 offset:4096
v_xor_b32 v9, 0x10000, v9
v_mfma_f32_16x16x32_bf16 v[92:95], v[220:223], a[196:199], v[92:95]
s_waitcnt lgkmcnt(0)
ds_read_b64 v[60:61], v118 offset:2048
v_xor_b32 v10, 0x10000, v10
v_mfma_f32_16x16x32_bf16 v[92:95], v[204:207], a[192:195], v[92:95]
ds_read_b64_tr_b16 v[76:77], v5 offset:8192
v_xor_b32 v11, 0x10000, v11
v_mfma_f32_16x16x32_bf16 v[80:83], v[128:131], a[224:227], v[80:83]
s_nop 0
ds_read_b64_tr_b16 v[192:193], v8 offset:0
ds_read_b64_tr_b16 v[194:195], v8 offset:2048
v_mfma_f32_16x16x32_bf16 v[80:83], v[144:147], a[228:231], v[80:83]
s_add_u32 s72, s71, 46080
buffer_load_dwordx4 v15, s[24:27], s72 offen offset:3072 lds
v_mfma_f32_16x16x32_bf16 v[80:83], v[160:163], a[232:235], v[80:83]
s_nop 0
ds_read_b64_tr_b16 v[196:197], v9 offset:0
ds_read_b64_tr_b16 v[198:199], v9 offset:2048
v_mfma_f32_16x16x32_bf16 v[80:83], v[176:179], a[236:239], v[80:83]
s_nop 0
ds_read_b64_tr_b16 v[200:201], v10 offset:0
ds_read_b64_tr_b16 v[202:203], v10 offset:2048
v_mfma_f32_16x16x32_bf16 v[84:87], v[180:183], a[236:239], v[84:87]
s_nop 0
ds_read_b64 v[62:63], v119 offset:2048
ds_read_b64_tr_b16 v[78:79], v5 offset:12288
v_mfma_f32_16x16x32_bf16 v[84:87], v[164:167], a[232:235], v[84:87]
s_nop 0
ds_read_b64_tr_b16 v[204:205], v11 offset:0
ds_read_b64_tr_b16 v[206:207], v11 offset:2048
v_mfma_f32_16x16x32_bf16 v[84:87], v[148:151], a[228:231], v[84:87]
s_nop 0
ds_read_b64_tr_b16 v[208:209], v8 offset:4096
ds_read_b64_tr_b16 v[210:211], v8 offset:6144
v_mfma_f32_16x16x32_bf16 v[84:87], v[132:135], a[224:227], v[84:87]
s_xor_b32 s71, s13, 0x40000
ds_read_b64_tr_b16 v[212:213], v9 offset:4096
ds_read_b64_tr_b16 v[214:215], v9 offset:6144
v_mfma_f32_16x16x32_bf16 v[88:91], v[136:139], a[224:227], v[88:91]
s_add_u32 m0, s85, 16384
v_mfma_f32_16x16x32_bf16 v[88:91], v[152:155], a[228:231], v[88:91]
s_add_u32 s72, s71, 0
buffer_load_dwordx4 v15, s[24:27], s72 offen lds
v_mfma_f32_16x16x32_bf16 v[88:91], v[168:171], a[232:235], v[88:91]
s_waitcnt lgkmcnt(6)
ds_read_b64_tr_b16 v[216:217], v10 offset:4096
ds_read_b64_tr_b16 v[218:219], v10 offset:6144
v_mfma_f32_16x16x32_bf16 v[88:91], v[184:187], a[236:239], v[88:91]
s_nop 0
ds_read_b64_tr_b16 v[220:221], v11 offset:4096
ds_read_b64_tr_b16 v[222:223], v11 offset:6144
v_cvt_pk_bf16_f32 v80, v80, v81
v_mfma_f32_16x16x32_bf16 v[92:95], v[188:191], a[236:239], v[92:95]
v_cvt_pk_bf16_f32 v81, v82, v83
v_cvt_pk_bf16_f32 v82, v84, v85
v_cvt_pk_bf16_f32 v83, v86, v87
v_mfma_f32_16x16x32_bf16 v[92:95], v[172:175], a[232:235], v[92:95]
s_nop 0
ds_read_b64_tr_b16 v[224:225], v8 offset:8192
ds_read_b64_tr_b16 v[226:227], v8 offset:10240
v_mfma_f32_16x16x32_bf16 v[92:95], v[156:159], a[228:231], v[92:95]
s_nop 0
ds_read_b64_tr_b16 v[228:229], v9 offset:8192
ds_read_b64_tr_b16 v[230:231], v9 offset:10240
v_mfma_f32_16x16x32_bf16 v[92:95], v[140:143], a[224:227], v[92:95]
s_nop 0
ds_read_b64_tr_b16 v[232:233], v10 offset:8192
ds_read_b64_tr_b16 v[234:235], v10 offset:10240
v_mfma_f32_16x16x32_bf16 v[96:99], v[128:131], a[240:243], v[96:99]
s_add_u32 s72, s71, 15360
buffer_load_dwordx4 v15, s[24:27], s72 offen offset:1024 lds
v_mfma_f32_16x16x32_bf16 v[96:99], v[144:147], a[244:247], v[96:99]
v_and_b32 v114, 0xffff0000, v48
v_lshlrev_b32 v115, 16, v64
v_mfma_f32_16x16x32_bf16 v[96:99], v[160:163], a[248:251], v[96:99]
s_xor_b32 s80, s93, 0x300000
ds_read_b64_tr_b16 v[236:237], v11 offset:8192
ds_read_b64_tr_b16 v[238:239], v11 offset:10240
v_mfma_f32_16x16x32_bf16 v[96:99], v[176:179], a[252:255], v[96:99]
s_add_u32 s80, s80, 0x4200000
buffer_store_dwordx4 v[80:83], v1, s[44:47], s80 offen sc1
v_cvt_pk_bf16_f32 v84, v88, v89
v_mfma_f32_16x16x32_bf16 v[100:103], v[180:183], a[252:255], v[100:103]
s_nop 0
ds_read_b64_tr_b16 v[240:241], v8 offset:12288
ds_read_b64_tr_b16 v[242:243], v8 offset:14336
v_cvt_pk_bf16_f32 v85, v90, v91
v_mfma_f32_16x16x32_bf16 v[100:103], v[164:167], a[248:251], v[100:103]
s_nop 0
ds_read_b64_tr_b16 v[244:245], v9 offset:12288
ds_read_b64_tr_b16 v[246:247], v9 offset:14336
v_cvt_pk_bf16_f32 v86, v92, v93
v_mfma_f32_16x16x32_bf16 v[100:103], v[148:151], a[244:247], v[100:103]
v_cvt_pk_bf16_f32 v87, v94, v95
v_lshlrev_b32 v48, 16, v48
v_mfma_f32_16x16x32_bf16 v[100:103], v[132:135], a[240:243], v[100:103]
s_nop 0
ds_read_b64_tr_b16 v[248:249], v10 offset:12288
ds_read_b64_tr_b16 v[250:251], v10 offset:14336
v_mfma_f32_16x16x32_bf16 v[104:107], v[136:139], a[240:243], v[104:107]
s_add_u32 s72, s71, 30720
buffer_load_dwordx4 v15, s[24:27], s72 offen offset:2048 lds
v_mfma_f32_16x16x32_bf16 v[104:107], v[152:155], a[244:247], v[104:107]
s_nop 0
ds_read_b64_tr_b16 v[252:253], v11 offset:12288
ds_read_b64_tr_b16 v[254:255], v11 offset:14336
v_mfma_f32_16x16x32_bf16 v[104:107], v[168:171], a[248:251], v[104:107]
v_and_b32 v64, 0xffff0000, v64
v_mul_f32 v48, v48, v112
v_mfma_f32_16x16x32_bf16 v[104:107], v[184:187], a[252:255], v[104:107]
v_cvt_pk_bf16_f32 v88, v96, v97
v_cvt_pk_bf16_f32 v89, v98, v99
v_cvt_pk_bf16_f32 v90, v100, v101
v_mfma_f32_16x16x32_bf16 v[108:111], v[188:191], a[252:255], v[108:111]
v_cvt_pk_bf16_f32 v91, v102, v103
v_mul_f32 v114, v114, v112
v_mfma_f32_16x16x32_bf16 v[108:111], v[172:175], a[248:251], v[108:111]
s_add_u32 s72, s71, 46080
v_mul_f32 v48, v48, v115
v_mul_f32 v64, v64, v114
v_mfma_f32_16x16x32_bf16 v[108:111], v[156:159], a[244:247], v[108:111]
s_waitcnt vmcnt(14) lgkmcnt(0)
v_and_b32 v114, 0xffff0000, v49
v_lshlrev_b32 v115, 16, v65
v_mfma_f32_16x16x32_bf16 v[108:111], v[140:143], a[240:243], v[108:111]
s_barrier
buffer_load_dwordx4 v15, s[24:27], s72 offen offset:3072 lds
v_mfma_f32_16x16x32_bf16 v[16:19], v[192:195], a[0:3], 0
s_nop 0
ds_read_b64_tr_b16 v[128:129], v8 offset:16384
ds_read_b64_tr_b16 v[130:131], v8 offset:18432
v_mfma_f32_16x16x32_bf16 v[16:19], v[208:211], a[4:7], v[16:19]
s_nop 0
ds_read_b64_tr_b16 v[132:133], v9 offset:16384
ds_read_b64_tr_b16 v[134:135], v9 offset:18432
v_mfma_f32_16x16x32_bf16 v[16:19], v[224:227], a[8:11], v[16:19]
s_nop 0
ds_read_b64_tr_b16 v[136:137], v10 offset:16384
ds_read_b64_tr_b16 v[138:139], v10 offset:18432
v_mfma_f32_16x16x32_bf16 v[16:19], v[240:243], a[12:15], v[16:19]
s_nop 0
buffer_store_dwordx4 v[84:87], v1, s[44:47], s80 offen offset:1024 sc1
v_cvt_pk_bf16_f32 v92, v104, v105
v_mfma_f32_16x16x32_bf16 v[32:35], v[240:243], a[28:31], 0
v_cvt_pk_bf16_f32 v93, v106, v107
v_cvt_pk_bf16_f32 v94, v108, v109
v_cvt_pk_bf16_f32 v95, v110, v111
v_mfma_f32_16x16x32_bf16 v[32:35], v[224:227], a[24:27], v[32:35]
s_xor_b32 s71, s14, 0x40000
ds_read_b64_tr_b16 v[140:141], v11 offset:16384
ds_read_b64_tr_b16 v[142:143], v11 offset:18432
v_mfma_f32_16x16x32_bf16 v[32:35], v[208:211], a[20:23], v[32:35]
s_add_u32 m0, s85, 32768
ds_read_b64_tr_b16 v[144:145], v8 offset:20480
ds_read_b64_tr_b16 v[146:147], v8 offset:22528
v_mfma_f32_16x16x32_bf16 v[32:35], v[192:195], a[16:19], v[32:35]
s_add_u32 s72, s71, 0
buffer_load_dwordx4 v15, s[24:27], s72 offen lds
v_mfma_f32_16x16x32_bf16 v[36:39], v[196:199], a[16:19], 0
s_nop 0
ds_read_b64_tr_b16 v[148:149], v9 offset:20480
ds_read_b64_tr_b16 v[150:151], v9 offset:22528
v_mfma_f32_16x16x32_bf16 v[36:39], v[212:215], a[20:23], v[36:39]
v_lshlrev_b32 v49, 16, v49
v_and_b32 v65, 0xffff0000, v65
v_mfma_f32_16x16x32_bf16 v[36:39], v[228:231], a[24:27], v[36:39]
s_nop 0
ds_read_b64_tr_b16 v[152:153], v10 offset:20480
ds_read_b64_tr_b16 v[154:155], v10 offset:22528
v_mfma_f32_16x16x32_bf16 v[36:39], v[244:247], a[28:31], v[36:39]
s_nop 0
ds_read_b64_tr_b16 v[156:157], v11 offset:20480
ds_read_b64_tr_b16 v[158:159], v11 offset:22528
v_mfma_f32_16x16x32_bf16 v[20:23], v[244:247], a[12:15], 0
v_mul_f32 v49, v49, v112
v_mul_f32 v114, v114, v112
v_mfma_f32_16x16x32_bf16 v[20:23], v[228:231], a[8:11], v[20:23]
s_nop 0
ds_read_b64_tr_b16 v[160:161], v8 offset:24576
ds_read_b64_tr_b16 v[162:163], v8 offset:26624
v_mfma_f32_16x16x32_bf16 v[20:23], v[212:215], a[4:7], v[20:23]
s_add_u32 s72, s71, 15360
buffer_load_dwordx4 v15, s[24:27], s72 offen offset:1024 lds
v_mfma_f32_16x16x32_bf16 v[20:23], v[196:199], a[0:3], v[20:23]
s_nop 0
ds_read_b64_tr_b16 v[164:165], v9 offset:24576
ds_read_b64_tr_b16 v[166:167], v9 offset:26624
v_mfma_f32_16x16x32_bf16 v[24:27], v[200:203], a[0:3], 0
s_nop 0
ds_read_b64_tr_b16 v[168:169], v10 offset:24576
ds_read_b64_tr_b16 v[170:171], v10 offset:26624
v_mfma_f32_16x16x32_bf16 v[24:27], v[216:219], a[4:7], v[24:27]
v_mul_f32 v49, v49, v115
v_mul_f32 v65, v65, v114
v_mfma_f32_16x16x32_bf16 v[24:27], v[232:235], a[8:11], v[24:27]
s_nop 0
ds_read_b64_tr_b16 v[172:173], v11 offset:24576
ds_read_b64_tr_b16 v[174:175], v11 offset:26624
v_mfma_f32_16x16x32_bf16 v[24:27], v[248:251], a[12:15], v[24:27]
buffer_store_dwordx4 v[88:91], v1, s[44:47], s80 offen offset:2048 sc1
v_mfma_f32_16x16x32_bf16 v[40:43], v[248:251], a[28:31], 0
s_nop 0
ds_read_b64_tr_b16 v[176:177], v8 offset:28672
ds_read_b64_tr_b16 v[178:179], v8 offset:30720
v_mfma_f32_16x16x32_bf16 v[40:43], v[232:235], a[24:27], v[40:43]
s_nop 0
ds_read_b64_tr_b16 v[180:181], v9 offset:28672
ds_read_b64_tr_b16 v[182:183], v9 offset:30720
v_mfma_f32_16x16x32_bf16 v[40:43], v[216:219], a[20:23], v[40:43]
s_add_u32 s72, s71, 30720
buffer_load_dwordx4 v15, s[24:27], s72 offen offset:2048 lds
v_mfma_f32_16x16x32_bf16 v[40:43], v[200:203], a[16:19], v[40:43]
v_and_b32 v114, 0xffff0000, v50
v_lshlrev_b32 v115, 16, v66
v_mfma_f32_16x16x32_bf16 v[44:47], v[204:207], a[16:19], 0
s_nop 0
ds_read_b64_tr_b16 v[184:185], v10 offset:28672
ds_read_b64_tr_b16 v[186:187], v10 offset:30720
v_mfma_f32_16x16x32_bf16 v[44:47], v[220:223], a[20:23], v[44:47]
s_nop 0
ds_read_b64_tr_b16 v[188:189], v11 offset:28672
ds_read_b64_tr_b16 v[190:191], v11 offset:30720
v_mfma_f32_16x16x32_bf16 v[44:47], v[236:239], a[24:27], v[44:47]
v_lshlrev_b32 v50, 16, v50
v_and_b32 v66, 0xffff0000, v66
v_mfma_f32_16x16x32_bf16 v[44:47], v[252:255], a[28:31], v[44:47]
v_mul_f32 v50, v50, v112
v_mul_f32 v114, v114, v112
v_mfma_f32_16x16x32_bf16 v[28:31], v[252:255], a[12:15], 0
v_mul_f32 v50, v50, v115
v_mul_f32 v66, v66, v114
v_mfma_f32_16x16x32_bf16 v[28:31], v[236:239], a[8:11], v[28:31]
s_add_u32 s72, s71, 46080
buffer_load_dwordx4 v15, s[24:27], s72 offen offset:3072 lds
v_mfma_f32_16x16x32_bf16 v[28:31], v[220:223], a[4:7], v[28:31]
s_waitcnt lgkmcnt(0)
v_and_b32 v114, 0xffff0000, v51
v_lshlrev_b32 v115, 16, v67
v_mfma_f32_16x16x32_bf16 v[28:31], v[204:207], a[0:3], v[28:31]
v_lshlrev_b32 v51, 16, v51
v_and_b32 v67, 0xffff0000, v67
v_mfma_f32_16x16x32_bf16 v[16:19], v[128:131], a[32:35], v[16:19]
s_nop 0
ds_read_b64_tr_b16 v[192:193], v8 offset:32768
ds_read_b64_tr_b16 v[194:195], v8 offset:34816
v_mfma_f32_16x16x32_bf16 v[16:19], v[144:147], a[36:39], v[16:19]
s_nop 0
ds_read_b64_tr_b16 v[196:197], v9 offset:32768
ds_read_b64_tr_b16 v[198:199], v9 offset:34816
v_mfma_f32_16x16x32_bf16 v[16:19], v[160:163], a[40:43], v[16:19]
s_nop 0
ds_read_b64_tr_b16 v[200:201], v10 offset:32768
ds_read_b64_tr_b16 v[202:203], v10 offset:34816
v_mfma_f32_16x16x32_bf16 v[16:19], v[176:179], a[44:47], v[16:19]
s_xor_b32 s71, s15, 0x40000
v_mul_f32 v51, v51, v112
v_mul_f32 v114, v114, v112
v_mfma_f32_16x16x32_bf16 v[32:35], v[176:179], a[60:63], v[32:35]
s_add_u32 m0, s85, 49152
ds_read_b64_tr_b16 v[204:205], v11 offset:32768
ds_read_b64_tr_b16 v[206:207], v11 offset:34816
v_mfma_f32_16x16x32_bf16 v[32:35], v[160:163], a[56:59], v[32:35]
s_add_u32 s72, s71, 0
buffer_load_dwordx4 v15, s[24:27], s72 offen lds
v_mfma_f32_16x16x32_bf16 v[32:35], v[144:147], a[52:55], v[32:35]
s_nop 0
ds_read_b64_tr_b16 v[208:209], v8 offset:36864
ds_read_b64_tr_b16 v[210:211], v8 offset:38912
v_mfma_f32_16x16x32_bf16 v[32:35], v[128:131], a[48:51], v[32:35]
v_mul_f32 v51, v51, v115
v_mul_f32 v67, v67, v114
v_mfma_f32_16x16x32_bf16 v[36:39], v[132:135], a[48:51], v[36:39]
buffer_store_dwordx4 v[92:95], v1, s[44:47], s80 offen offset:3072 sc1
v_mfma_f32_16x16x32_bf16 v[36:39], v[148:151], a[52:55], v[36:39]
s_nop 0
ds_read_b64_tr_b16 v[212:213], v9 offset:36864
ds_read_b64_tr_b16 v[214:215], v9 offset:38912
v_mfma_f32_16x16x32_bf16 v[36:39], v[164:167], a[56:59], v[36:39]
s_nop 0
ds_read_b64_tr_b16 v[216:217], v10 offset:36864
ds_read_b64_tr_b16 v[218:219], v10 offset:38912
v_mfma_f32_16x16x32_bf16 v[36:39], v[180:183], a[60:63], v[36:39]
v_and_b32 v114, 0xffff0000, v52
v_lshlrev_b32 v115, 16, v68
v_mfma_f32_16x16x32_bf16 v[20:23], v[180:183], a[44:47], v[20:23]
s_add_u32 s72, s71, 15360
buffer_load_dwordx4 v15, s[24:27], s72 offen offset:1024 lds
v_mfma_f32_16x16x32_bf16 v[20:23], v[164:167], a[40:43], v[20:23]
s_nop 0
ds_read_b64_tr_b16 v[220:221], v11 offset:36864
ds_read_b64_tr_b16 v[222:223], v11 offset:38912
v_mfma_f32_16x16x32_bf16 v[20:23], v[148:151], a[36:39], v[20:23]
s_nop 0
ds_read_b64_tr_b16 v[224:225], v8 offset:40960
ds_read_b64_tr_b16 v[226:227], v8 offset:43008
v_mfma_f32_16x16x32_bf16 v[20:23], v[132:135], a[32:35], v[20:23]
s_nop 0
ds_read_b64_tr_b16 v[228:229], v9 offset:40960
ds_read_b64_tr_b16 v[230:231], v9 offset:43008
v_mfma_f32_16x16x32_bf16 v[24:27], v[136:139], a[32:35], v[24:27]
v_lshlrev_b32 v52, 16, v52
v_and_b32 v68, 0xffff0000, v68
v_mfma_f32_16x16x32_bf16 v[24:27], v[152:155], a[36:39], v[24:27]
s_nop 0
ds_read_b64_tr_b16 v[232:233], v10 offset:40960
ds_read_b64_tr_b16 v[234:235], v10 offset:43008
v_mfma_f32_16x16x32_bf16 v[24:27], v[168:171], a[40:43], v[24:27]
s_nop 0
ds_read_b64_tr_b16 v[236:237], v11 offset:40960
ds_read_b64_tr_b16 v[238:239], v11 offset:43008
v_mfma_f32_16x16x32_bf16 v[24:27], v[184:187], a[44:47], v[24:27]
v_mul_f32 v52, v52, v112
v_mul_f32 v114, v114, v112
v_mfma_f32_16x16x32_bf16 v[40:43], v[184:187], a[60:63], v[40:43]
s_add_u32 s72, s71, 30720
buffer_load_dwordx4 v15, s[24:27], s72 offen offset:2048 lds
v_mfma_f32_16x16x32_bf16 v[40:43], v[168:171], a[56:59], v[40:43]
s_nop 0
ds_read_b64_tr_b16 v[240:241], v8 offset:45056
ds_read_b64_tr_b16 v[242:243], v8 offset:47104
v_mfma_f32_16x16x32_bf16 v[40:43], v[152:155], a[52:55], v[40:43]
s_nop 0
ds_read_b64_tr_b16 v[244:245], v9 offset:45056
ds_read_b64_tr_b16 v[246:247], v9 offset:47104
v_mfma_f32_16x16x32_bf16 v[40:43], v[136:139], a[48:51], v[40:43]
v_mul_f32 v52, v52, v115
v_mul_f32 v68, v68, v114
v_mfma_f32_16x16x32_bf16 v[44:47], v[140:143], a[48:51], v[44:47]
s_nop 0
ds_read_b64_tr_b16 v[248:249], v10 offset:45056
ds_read_b64_tr_b16 v[250:251], v10 offset:47104
v_mfma_f32_16x16x32_bf16 v[44:47], v[156:159], a[52:55], v[44:47]
s_nop 0
ds_read_b64_tr_b16 v[252:253], v11 offset:45056
ds_read_b64_tr_b16 v[254:255], v11 offset:47104
v_mfma_f32_16x16x32_bf16 v[44:47], v[172:175], a[56:59], v[44:47]
v_and_b32 v114, 0xffff0000, v53
v_lshlrev_b32 v115, 16, v69
v_mfma_f32_16x16x32_bf16 v[44:47], v[188:191], a[60:63], v[44:47]
s_add_u32 s72, s71, 46080
buffer_load_dwordx4 v15, s[24:27], s72 offen offset:3072 lds
v_mfma_f32_16x16x32_bf16 v[28:31], v[188:191], a[44:47], v[28:31]
v_lshlrev_b32 v53, 16, v53
v_and_b32 v69, 0xffff0000, v69
v_mfma_f32_16x16x32_bf16 v[28:31], v[172:175], a[40:43], v[28:31]
s_add_u32 s79, s93, 0x3a00000
v_mul_f32 v53, v53, v112
v_mul_f32 v114, v114, v112
v_mfma_f32_16x16x32_bf16 v[28:31], v[156:159], a[36:39], v[28:31]
s_waitcnt vmcnt(16) lgkmcnt(0)
buffer_load_dwordx4 v[96:99], v1, s[44:47], s79 offen sc1
v_mfma_f32_16x16x32_bf16 v[28:31], v[140:143], a[32:35], v[28:31]
s_barrier
v_mul_f32 v53, v53, v115
v_mul_f32 v69, v69, v114
v_mfma_f32_16x16x32_bf16 v[16:19], v[192:195], a[64:67], v[16:19]
s_nop 0
ds_read_b64_tr_b16 v[128:129], v8 offset:49152
ds_read_b64_tr_b16 v[130:131], v8 offset:51200
v_mfma_f32_16x16x32_bf16 v[16:19], v[208:211], a[68:71], v[16:19]
s_nop 0
ds_read_b64_tr_b16 v[132:133], v9 offset:49152
ds_read_b64_tr_b16 v[134:135], v9 offset:51200
v_mfma_f32_16x16x32_bf16 v[16:19], v[224:227], a[72:75], v[16:19]
v_and_b32 v114, 0xffff0000, v54
v_lshlrev_b32 v115, 16, v70
v_mfma_f32_16x16x32_bf16 v[16:19], v[240:243], a[76:79], v[16:19]
buffer_load_dwordx4 v[100:103], v1, s[44:47], s79 offen offset:1024 sc1
v_mfma_f32_16x16x32_bf16 v[32:35], v[240:243], a[92:95], v[32:35]
s_nop 0
ds_read_b64_tr_b16 v[136:137], v10 offset:49152
ds_read_b64_tr_b16 v[138:139], v10 offset:51200
v_mfma_f32_16x16x32_bf16 v[32:35], v[224:227], a[88:91], v[32:35]
s_nop 0
ds_read_b64_tr_b16 v[140:141], v11 offset:49152
ds_read_b64_tr_b16 v[142:143], v11 offset:51200
v_mfma_f32_16x16x32_bf16 v[32:35], v[208:211], a[84:87], v[32:35]
v_lshlrev_b32 v54, 16, v54
v_and_b32 v70, 0xffff0000, v70
v_mfma_f32_16x16x32_bf16 v[32:35], v[192:195], a[80:83], v[32:35]
s_nop 0
ds_read_b64_tr_b16 v[144:145], v8 offset:53248
ds_read_b64_tr_b16 v[146:147], v8 offset:55296
v_mfma_f32_16x16x32_bf16 v[36:39], v[196:199], a[80:83], v[36:39]
buffer_load_dwordx4 v[104:107], v1, s[44:47], s79 offen offset:2048 sc1
v_mfma_f32_16x16x32_bf16 v[36:39], v[212:215], a[84:87], v[36:39]
s_nop 0
ds_read_b64_tr_b16 v[148:149], v9 offset:53248
ds_read_b64_tr_b16 v[150:151], v9 offset:55296
v_mfma_f32_16x16x32_bf16 v[36:39], v[228:231], a[88:91], v[36:39]
v_mul_f32 v54, v54, v112
v_mul_f32 v114, v114, v112
v_mfma_f32_16x16x32_bf16 v[36:39], v[244:247], a[92:95], v[36:39]
s_nop 0
ds_read_b64_tr_b16 v[152:153], v10 offset:53248
ds_read_b64_tr_b16 v[154:155], v10 offset:55296
v_mfma_f32_16x16x32_bf16 v[20:23], v[244:247], a[76:79], v[20:23]
s_nop 0
ds_read_b64_tr_b16 v[156:157], v11 offset:53248
ds_read_b64_tr_b16 v[158:159], v11 offset:55296
v_mfma_f32_16x16x32_bf16 v[20:23], v[228:231], a[72:75], v[20:23]
buffer_load_dwordx4 v[108:111], v1, s[44:47], s79 offen offset:3072 sc1
v_mfma_f32_16x16x32_bf16 v[20:23], v[212:215], a[68:71], v[20:23]
v_mul_f32 v54, v54, v115
v_mul_f32 v70, v70, v114
v_mfma_f32_16x16x32_bf16 v[20:23], v[196:199], a[64:67], v[20:23]
s_nop 0
ds_read_b64_tr_b16 v[160:161], v8 offset:57344
ds_read_b64_tr_b16 v[162:163], v8 offset:59392
v_mfma_f32_16x16x32_bf16 v[24:27], v[200:203], a[64:67], v[24:27]
s_nop 0
ds_read_b64_tr_b16 v[164:165], v9 offset:57344
ds_read_b64_tr_b16 v[166:167], v9 offset:59392
v_mfma_f32_16x16x32_bf16 v[24:27], v[216:219], a[68:71], v[24:27]
v_and_b32 v114, 0xffff0000, v55
v_lshlrev_b32 v115, 16, v71
v_mfma_f32_16x16x32_bf16 v[24:27], v[232:235], a[72:75], v[24:27]
s_nop 0
ds_read_b64_tr_b16 v[168:169], v10 offset:57344
ds_read_b64_tr_b16 v[170:171], v10 offset:59392
v_mfma_f32_16x16x32_bf16 v[24:27], v[248:251], a[76:79], v[24:27]
s_nop 0
ds_read_b64_tr_b16 v[172:173], v11 offset:57344
ds_read_b64_tr_b16 v[174:175], v11 offset:59392
v_mfma_f32_16x16x32_bf16 v[40:43], v[248:251], a[92:95], v[40:43]
v_lshlrev_b32 v55, 16, v55
v_and_b32 v71, 0xffff0000, v71
v_mfma_f32_16x16x32_bf16 v[40:43], v[232:235], a[88:91], v[40:43]
s_nop 0
ds_read_b64_tr_b16 v[176:177], v8 offset:61440
ds_read_b64_tr_b16 v[178:179], v8 offset:63488
v_mfma_f32_16x16x32_bf16 v[40:43], v[216:219], a[84:87], v[40:43]
s_nop 0
ds_read_b64_tr_b16 v[180:181], v9 offset:61440
ds_read_b64_tr_b16 v[182:183], v9 offset:63488
v_mfma_f32_16x16x32_bf16 v[40:43], v[200:203], a[80:83], v[40:43]
v_mul_f32 v55, v55, v112
v_mul_f32 v114, v114, v112
v_mfma_f32_16x16x32_bf16 v[44:47], v[204:207], a[80:83], v[44:47]
s_nop 0
ds_read_b64_tr_b16 v[184:185], v10 offset:61440
ds_read_b64_tr_b16 v[186:187], v10 offset:63488
v_mfma_f32_16x16x32_bf16 v[44:47], v[220:223], a[84:87], v[44:47]
s_nop 0
ds_read_b64_tr_b16 v[188:189], v11 offset:61440
ds_read_b64_tr_b16 v[190:191], v11 offset:63488
v_mfma_f32_16x16x32_bf16 v[44:47], v[236:239], a[88:91], v[44:47]
v_mul_f32 v55, v55, v115
v_mul_f32 v71, v71, v114
v_mfma_f32_16x16x32_bf16 v[44:47], v[252:255], a[92:95], v[44:47]
v_and_b32 v114, 0xffff0000, v56
v_lshlrev_b32 v115, 16, v72
v_mfma_f32_16x16x32_bf16 v[28:31], v[252:255], a[76:79], v[28:31]
v_xor_b32 v8, 0x10000, v8
v_lshlrev_b32 v56, 16, v56
v_mfma_f32_16x16x32_bf16 v[28:31], v[236:239], a[72:75], v[28:31]
v_xor_b32 v9, 0x10000, v9
v_and_b32 v72, 0xffff0000, v72
v_mfma_f32_16x16x32_bf16 v[28:31], v[220:223], a[68:71], v[28:31]
s_waitcnt lgkmcnt(0)
v_xor_b32 v10, 0x10000, v10
v_mul_f32 v56, v56, v113
v_mfma_f32_16x16x32_bf16 v[28:31], v[204:207], a[64:67], v[28:31]
v_xor_b32 v11, 0x10000, v11
v_mul_f32 v114, v114, v113
v_mfma_f32_16x16x32_bf16 v[16:19], v[128:131], a[96:99], v[16:19]
s_nop 0
ds_read_b64_tr_b16 v[192:193], v8 offset:0
ds_read_b64_tr_b16 v[194:195], v8 offset:2048
v_mfma_f32_16x16x32_bf16 v[16:19], v[144:147], a[100:103], v[16:19]
s_nop 0
ds_read_b64_tr_b16 v[196:197], v9 offset:0
ds_read_b64_tr_b16 v[198:199], v9 offset:2048
v_mfma_f32_16x16x32_bf16 v[16:19], v[160:163], a[104:107], v[16:19]
v_mul_f32 v56, v56, v115
v_mul_f32 v72, v72, v114
v_mfma_f32_16x16x32_bf16 v[16:19], v[176:179], a[108:111], v[16:19]
s_nop 0
ds_read_b64_tr_b16 v[200:201], v10 offset:0
ds_read_b64_tr_b16 v[202:203], v10 offset:2048
v_mfma_f32_16x16x32_bf16 v[32:35], v[176:179], a[124:127], v[32:35]
v_and_b32 v114, 0xffff0000, v57
v_lshlrev_b32 v115, 16, v73
v_mfma_f32_16x16x32_bf16 v[32:35], v[160:163], a[120:123], v[32:35]
s_nop 0
ds_read_b64_tr_b16 v[204:205], v11 offset:0
ds_read_b64_tr_b16 v[206:207], v11 offset:2048
v_mfma_f32_16x16x32_bf16 v[32:35], v[144:147], a[116:119], v[32:35]
s_nop 0
ds_read_b64_tr_b16 v[208:209], v8 offset:4096
ds_read_b64_tr_b16 v[210:211], v8 offset:6144
v_mfma_f32_16x16x32_bf16 v[32:35], v[128:131], a[112:115], v[32:35]
v_lshlrev_b32 v57, 16, v57
v_and_b32 v73, 0xffff0000, v73
v_mfma_f32_16x16x32_bf16 v[36:39], v[132:135], a[112:115], v[36:39]
s_nop 0
ds_read_b64_tr_b16 v[212:213], v9 offset:4096
ds_read_b64_tr_b16 v[214:215], v9 offset:6144
v_mfma_f32_16x16x32_bf16 v[36:39], v[148:151], a[116:119], v[36:39]
v_mul_f32 v57, v57, v113
v_mul_f32 v114, v114, v113
v_mfma_f32_16x16x32_bf16 v[36:39], v[164:167], a[120:123], v[36:39]
s_nop 0
ds_read_b64_tr_b16 v[216:217], v10 offset:4096
ds_read_b64_tr_b16 v[218:219], v10 offset:6144
v_mfma_f32_16x16x32_bf16 v[36:39], v[180:183], a[124:127], v[36:39]
s_nop 0
ds_read_b64_tr_b16 v[220:221], v11 offset:4096
ds_read_b64_tr_b16 v[222:223], v11 offset:6144
v_mfma_f32_16x16x32_bf16 v[20:23], v[180:183], a[108:111], v[20:23]
v_mul_f32 v57, v57, v115
v_mul_f32 v73, v73, v114
v_mfma_f32_16x16x32_bf16 v[20:23], v[164:167], a[104:107], v[20:23]
s_nop 0
ds_read_b64_tr_b16 v[224:225], v8 offset:8192
ds_read_b64_tr_b16 v[226:227], v8 offset:10240
v_mfma_f32_16x16x32_bf16 v[20:23], v[148:151], a[100:103], v[20:23]
v_and_b32 v114, 0xffff0000, v58
v_lshlrev_b32 v115, 16, v74
v_mfma_f32_16x16x32_bf16 v[20:23], v[132:135], a[96:99], v[20:23]
s_nop 0
ds_read_b64_tr_b16 v[228:229], v9 offset:8192
ds_read_b64_tr_b16 v[230:231], v9 offset:10240
v_mfma_f32_16x16x32_bf16 v[24:27], v[136:139], a[96:99], v[24:27]
s_nop 0
ds_read_b64_tr_b16 v[232:233], v10 offset:8192
ds_read_b64_tr_b16 v[234:235], v10 offset:10240
v_mfma_f32_16x16x32_bf16 v[24:27], v[152:155], a[100:103], v[24:27]
Lstube4:
s_cbranch_execz Lrete
v_lshlrev_b32 v58, 16, v58
v_and_b32 v74, 0xffff0000, v74
v_mfma_f32_16x16x32_bf16 v[24:27], v[168:171], a[104:107], v[24:27]
s_nop 0
ds_read_b64_tr_b16 v[236:237], v11 offset:8192
ds_read_b64_tr_b16 v[238:239], v11 offset:10240
v_mfma_f32_16x16x32_bf16 v[24:27], v[184:187], a[108:111], v[24:27]
v_mul_f32 v58, v58, v113
v_mul_f32 v114, v114, v113
v_mfma_f32_16x16x32_bf16 v[40:43], v[184:187], a[124:127], v[40:43]
s_nop 0
ds_read_b64_tr_b16 v[240:241], v8 offset:12288
ds_read_b64_tr_b16 v[242:243], v8 offset:14336
v_mfma_f32_16x16x32_bf16 v[40:43], v[168:171], a[120:123], v[40:43]
s_nop 0
ds_read_b64_tr_b16 v[244:245], v9 offset:12288
ds_read_b64_tr_b16 v[246:247], v9 offset:14336
v_mfma_f32_16x16x32_bf16 v[40:43], v[152:155], a[116:119], v[40:43]
v_mul_f32 v58, v58, v115
v_mul_f32 v74, v74, v114
v_mfma_f32_16x16x32_bf16 v[40:43], v[136:139], a[112:115], v[40:43]
s_nop 0
ds_read_b64_tr_b16 v[248:249], v10 offset:12288
ds_read_b64_tr_b16 v[250:251], v10 offset:14336
v_mfma_f32_16x16x32_bf16 v[44:47], v[140:143], a[112:115], v[44:47]
v_and_b32 v114, 0xffff0000, v59
v_lshlrev_b32 v115, 16, v75
v_mfma_f32_16x16x32_bf16 v[44:47], v[156:159], a[116:119], v[44:47]
s_nop 0
ds_read_b64_tr_b16 v[252:253], v11 offset:12288
ds_read_b64_tr_b16 v[254:255], v11 offset:14336
v_mfma_f32_16x16x32_bf16 v[44:47], v[172:175], a[120:123], v[44:47]
v_lshlrev_b32 v59, 16, v59
v_and_b32 v75, 0xffff0000, v75
v_mfma_f32_16x16x32_bf16 v[44:47], v[188:191], a[124:127], v[44:47]
s_waitcnt vmcnt(0)
v_max3_u32 v12, v96, v97, v98
v_max3_u32 v13, v99, v100, v101
v_mfma_f32_16x16x32_bf16 v[28:31], v[188:191], a[108:111], v[28:31]
v_max3_u32 v12, v12, v102, v103
v_max3_u32 v13, v13, v104, v105
v_mfma_f32_16x16x32_bf16 v[28:31], v[172:175], a[104:107], v[28:31]
v_max3_u32 v12, v12, v106, v107
v_max3_u32 v13, v13, v108, v109
v_mfma_f32_16x16x32_bf16 v[28:31], v[156:159], a[100:103], v[28:31]
s_waitcnt vmcnt(9) lgkmcnt(0)
v_max3_u32 v12, v12, v110, v111
v_mul_f32 v59, v59, v113
v_mfma_f32_16x16x32_bf16 v[28:31], v[140:143], a[96:99], v[28:31]
s_barrier
v_max_u32 v12, v12, v13
v_mul_f32 v114, v114, v113
v_mfma_f32_16x16x32_bf16 v[16:19], v[192:195], a[128:131], v[16:19]
v_cmp_le_u32 vcc, 0xff800000, v12
v_mul_f32 v59, v59, v115
v_mfma_f32_16x16x32_bf16 v[16:19], v[208:211], a[132:135], v[16:19]
s_nop 0
ds_read_b64_tr_b16 v[128:129], v8 offset:16384
ds_read_b64_tr_b16 v[130:131], v8 offset:18432
v_mfma_f32_16x16x32_bf16 v[16:19], v[224:227], a[136:139], v[16:19]
s_cbranch_vccnz Lxspin1
Lxback1:
ds_read_b64_tr_b16 v[132:133], v9 offset:16384
ds_read_b64_tr_b16 v[134:135], v9 offset:18432
v_mfma_f32_16x16x32_bf16 v[16:19], v[240:243], a[140:143], v[16:19]
v_mul_f32 v75, v75, v114
v_and_b32 v114, 0xffff0000, v60
v_mfma_f32_16x16x32_bf16 v[16:19], v[124:127], v[96:99], v[16:19]
s_nop 0
ds_read_b64_tr_b16 v[136:137], v10 offset:16384
ds_read_b64_tr_b16 v[138:139], v10 offset:18432
v_mfma_f32_16x16x32_bf16 v[32:35], v[240:243], a[156:159], v[32:35]
v_lshlrev_b32 v115, 16, v76
v_lshlrev_b32 v60, 16, v60
v_mfma_f32_16x16x32_bf16 v[32:35], v[224:227], a[152:155], v[32:35]
s_add_u32 s82, s93, 0x3e00000
buffer_load_dwordx4 v[80:83], v1, s[44:47], s82 offen sc1
v_mfma_f32_16x16x32_bf16 v[32:35], v[208:211], a[148:151], v[32:35]
s_nop 0
ds_read_b64_tr_b16 v[140:141], v11 offset:16384
ds_read_b64_tr_b16 v[142:143], v11 offset:18432
v_mfma_f32_16x16x32_bf16 v[32:35], v[192:195], a[144:147], v[32:35]
v_and_b32 v76, 0xffff0000, v76
v_mul_f32 v60, v60, v113
v_mfma_f32_16x16x32_bf16 v[32:35], v[124:127], v[104:107], v[32:35]
s_nop 0
ds_read_b64_tr_b16 v[144:145], v8 offset:20480
ds_read_b64_tr_b16 v[146:147], v8 offset:22528
v_mfma_f32_16x16x32_bf16 v[36:39], v[196:199], a[144:147], v[36:39]
v_mul_f32 v114, v114, v113
v_mul_f32 v60, v60, v115
v_mfma_f32_16x16x32_bf16 v[36:39], v[212:215], a[148:151], v[36:39]
buffer_load_dwordx4 v[84:87], v1, s[44:47], s82 offen offset:1024 sc1
v_mfma_f32_16x16x32_bf16 v[36:39], v[228:231], a[152:155], v[36:39]
s_nop 0
ds_read_b64_tr_b16 v[148:149], v9 offset:20480
ds_read_b64_tr_b16 v[150:151], v9 offset:22528
v_mfma_f32_16x16x32_bf16 v[36:39], v[244:247], a[156:159], v[36:39]
v_mul_f32 v76, v76, v114
v_and_b32 v114, 0xffff0000, v61
v_mfma_f32_16x16x32_bf16 v[36:39], v[120:123], v[104:107], v[36:39]
s_nop 0
ds_read_b64_tr_b16 v[152:153], v10 offset:20480
ds_read_b64_tr_b16 v[154:155], v10 offset:22528
v_mfma_f32_16x16x32_bf16 v[20:23], v[244:247], a[140:143], v[20:23]
v_lshlrev_b32 v115, 16, v77
v_lshlrev_b32 v61, 16, v61
v_mfma_f32_16x16x32_bf16 v[20:23], v[228:231], a[136:139], v[20:23]
buffer_load_dwordx4 v[88:91], v1, s[44:47], s82 offen offset:2048 sc1
v_mfma_f32_16x16x32_bf16 v[20:23], v[212:215], a[132:135], v[20:23]
s_nop 0
ds_read_b64_tr_b16 v[156:157], v11 offset:20480
ds_read_b64_tr_b16 v[158:159], v11 offset:22528
v_mfma_f32_16x16x32_bf16 v[20:23], v[196:199], a[128:131], v[20:23]
v_and_b32 v77, 0xffff0000, v77
v_mul_f32 v61, v61, v113
v_mfma_f32_16x16x32_bf16 v[20:23], v[120:123], v[96:99], v[20:23]
s_nop 0
ds_read_b64_tr_b16 v[160:161], v8 offset:24576
ds_read_b64_tr_b16 v[162:163], v8 offset:26624
v_mfma_f32_16x16x32_bf16 v[24:27], v[200:203], a[128:131], v[24:27]
s_nop 0
ds_read_b64_tr_b16 v[164:165], v9 offset:24576
ds_read_b64_tr_b16 v[166:167], v9 offset:26624
v_mfma_f32_16x16x32_bf16 v[24:27], v[216:219], a[132:135], v[24:27]
buffer_load_dwordx4 v[92:95], v1, s[44:47], s82 offen offset:3072 sc1
v_mfma_f32_16x16x32_bf16 v[24:27], v[232:235], a[136:139], v[24:27]
v_mul_f32 v114, v114, v113
v_mul_f32 v61, v61, v115
v_mfma_f32_16x16x32_bf16 v[24:27], v[248:251], a[140:143], v[24:27]
s_nop 0
ds_read_b64_tr_b16 v[168:169], v10 offset:24576
ds_read_b64_tr_b16 v[170:171], v10 offset:26624
v_mfma_f32_16x16x32_bf16 v[24:27], v[124:127], v[100:103], v[24:27]
v_mul_f32 v77, v77, v114
v_and_b32 v114, 0xffff0000, v62
v_mfma_f32_16x16x32_bf16 v[40:43], v[248:251], a[156:159], v[40:43]
s_nop 0
ds_read_b64_tr_b16 v[172:173], v11 offset:24576
ds_read_b64_tr_b16 v[174:175], v11 offset:26624
v_mfma_f32_16x16x32_bf16 v[40:43], v[232:235], a[152:155], v[40:43]
v_lshlrev_b32 v115, 16, v78
v_lshlrev_b32 v62, 16, v62
v_mfma_f32_16x16x32_bf16 v[40:43], v[216:219], a[148:151], v[40:43]
s_nop 0
ds_read_b64_tr_b16 v[176:177], v8 offset:28672
ds_read_b64_tr_b16 v[178:179], v8 offset:30720
v_mfma_f32_16x16x32_bf16 v[40:43], v[200:203], a[144:147], v[40:43]
v_and_b32 v78, 0xffff0000, v78
v_mul_f32 v62, v62, v113
v_mfma_f32_16x16x32_bf16 v[40:43], v[124:127], v[108:111], v[40:43]
s_nop 0
ds_read_b64_tr_b16 v[180:181], v9 offset:28672
ds_read_b64_tr_b16 v[182:183], v9 offset:30720
v_mfma_f32_16x16x32_bf16 v[44:47], v[204:207], a[144:147], v[44:47]
v_mul_f32 v114, v114, v113
v_mul_f32 v62, v62, v115
v_mfma_f32_16x16x32_bf16 v[44:47], v[220:223], a[148:151], v[44:47]
s_nop 0
ds_read_b64_tr_b16 v[184:185], v10 offset:28672
ds_read_b64_tr_b16 v[186:187], v10 offset:30720
v_mfma_f32_16x16x32_bf16 v[44:47], v[236:239], a[152:155], v[44:47]
v_mul_f32 v78, v78, v114
v_and_b32 v114, 0xffff0000, v63
v_mfma_f32_16x16x32_bf16 v[44:47], v[252:255], a[156:159], v[44:47]
s_nop 0
ds_read_b64_tr_b16 v[188:189], v11 offset:28672
ds_read_b64_tr_b16 v[190:191], v11 offset:30720
v_mfma_f32_16x16x32_bf16 v[44:47], v[120:123], v[108:111], v[44:47]
v_lshlrev_b32 v115, 16, v79
v_lshlrev_b32 v63, 16, v63
v_mfma_f32_16x16x32_bf16 v[28:31], v[252:255], a[140:143], v[28:31]
v_and_b32 v79, 0xffff0000, v79
v_mul_f32 v63, v63, v113
v_mfma_f32_16x16x32_bf16 v[28:31], v[236:239], a[136:139], v[28:31]
v_mul_f32 v114, v114, v113
v_mul_f32 v63, v63, v115
v_mfma_f32_16x16x32_bf16 v[28:31], v[220:223], a[132:135], v[28:31]
v_mul_f32 v79, v79, v114
v_mfma_f32_16x16x32_bf16 v[28:31], v[204:207], a[128:131], v[28:31]
s_waitcnt lgkmcnt(0)
v_mfma_f32_16x16x32_bf16 v[28:31], v[120:123], v[100:103], v[28:31]
v_mfma_f32_16x16x32_bf16 v[16:19], v[128:131], a[160:163], v[16:19]
s_nop 0
ds_read_b64_tr_b16 v[192:193], v8 offset:32768
ds_read_b64_tr_b16 v[194:195], v8 offset:34816
v_mfma_f32_16x16x32_bf16 v[16:19], v[144:147], a[164:167], v[16:19]
s_nop 0
ds_read_b64_tr_b16 v[196:197], v9 offset:32768
ds_read_b64_tr_b16 v[198:199], v9 offset:34816
v_mfma_f32_16x16x32_bf16 v[16:19], v[160:163], a[168:171], v[16:19]
s_nop 0
ds_read_b64_tr_b16 v[200:201], v10 offset:32768
ds_read_b64_tr_b16 v[202:203], v10 offset:34816
v_mfma_f32_16x16x32_bf16 v[16:19], v[176:179], a[172:175], v[16:19]
v_mfma_f32_16x16x32_bf16 v[32:35], v[176:179], a[188:191], v[32:35]
s_nop 0
ds_read_b64_tr_b16 v[204:205], v11 offset:32768
ds_read_b64_tr_b16 v[206:207], v11 offset:34816
v_mfma_f32_16x16x32_bf16 v[32:35], v[160:163], a[184:187], v[32:35]
s_nop 0
ds_read_b64_tr_b16 v[208:209], v8 offset:36864
ds_read_b64_tr_b16 v[210:211], v8 offset:38912
v_mfma_f32_16x16x32_bf16 v[32:35], v[144:147], a[180:183], v[32:35]
s_add_u32 s81, s93, 0x4200000
buffer_load_dwordx4 v[96:99], v1, s[44:47], s81 offen sc1
v_mfma_f32_16x16x32_bf16 v[32:35], v[128:131], a[176:179], v[32:35]
v_mfma_f32_16x16x32_bf16 v[36:39], v[132:135], a[176:179], v[36:39]
s_nop 0
ds_read_b64_tr_b16 v[212:213], v9 offset:36864
ds_read_b64_tr_b16 v[214:215], v9 offset:38912
v_mfma_f32_16x16x32_bf16 v[36:39], v[148:151], a[180:183], v[36:39]
s_nop 0
ds_read_b64_tr_b16 v[216:217], v10 offset:36864
ds_read_b64_tr_b16 v[218:219], v10 offset:38912
v_mfma_f32_16x16x32_bf16 v[36:39], v[164:167], a[184:187], v[36:39]
v_mfma_f32_16x16x32_bf16 v[36:39], v[180:183], a[188:191], v[36:39]
buffer_load_dwordx4 v[100:103], v1, s[44:47], s81 offen offset:1024 sc1
v_mfma_f32_16x16x32_bf16 v[20:23], v[180:183], a[172:175], v[20:23]
s_nop 0
ds_read_b64_tr_b16 v[220:221], v11 offset:36864
ds_read_b64_tr_b16 v[222:223], v11 offset:38912
v_mfma_f32_16x16x32_bf16 v[20:23], v[164:167], a[168:171], v[20:23]
s_nop 0
ds_read_b64_tr_b16 v[224:225], v8 offset:40960
ds_read_b64_tr_b16 v[226:227], v8 offset:43008
v_mfma_f32_16x16x32_bf16 v[20:23], v[148:151], a[164:167], v[20:23]
s_nop 0
ds_read_b64_tr_b16 v[228:229], v9 offset:40960
ds_read_b64_tr_b16 v[230:231], v9 offset:43008
v_mfma_f32_16x16x32_bf16 v[20:23], v[132:135], a[160:163], v[20:23]
v_mfma_f32_16x16x32_bf16 v[24:27], v[136:139], a[160:163], v[24:27]
buffer_load_dwordx4 v[104:107], v1, s[44:47], s81 offen offset:2048 sc1
v_mfma_f32_16x16x32_bf16 v[24:27], v[152:155], a[164:167], v[24:27]
s_nop 0
ds_read_b64_tr_b16 v[232:233], v10 offset:40960
ds_read_b64_tr_b16 v[234:235], v10 offset:43008
v_mfma_f32_16x16x32_bf16 v[24:27], v[168:171], a[168:171], v[24:27]
s_nop 0
ds_read_b64_tr_b16 v[236:237], v11 offset:40960
ds_read_b64_tr_b16 v[238:239], v11 offset:43008
v_mfma_f32_16x16x32_bf16 v[24:27], v[184:187], a[172:175], v[24:27]
v_mfma_f32_16x16x32_bf16 v[40:43], v[184:187], a[188:191], v[40:43]
s_nop 0
ds_read_b64_tr_b16 v[240:241], v8 offset:45056
ds_read_b64_tr_b16 v[242:243], v8 offset:47104
v_mfma_f32_16x16x32_bf16 v[40:43], v[168:171], a[184:187], v[40:43]
buffer_load_dwordx4 v[108:111], v1, s[44:47], s81 offen offset:3072 sc1
v_mfma_f32_16x16x32_bf16 v[40:43], v[152:155], a[180:183], v[40:43]
s_nop 0
ds_read_b64_tr_b16 v[244:245], v9 offset:45056
ds_read_b64_tr_b16 v[246:247], v9 offset:47104
v_mfma_f32_16x16x32_bf16 v[40:43], v[136:139], a[176:179], v[40:43]
v_mfma_f32_16x16x32_bf16 v[44:47], v[140:143], a[176:179], v[44:47]
s_nop 0
ds_read_b64_tr_b16 v[248:249], v10 offset:45056
ds_read_b64_tr_b16 v[250:251], v10 offset:47104
v_mfma_f32_16x16x32_bf16 v[44:47], v[156:159], a[180:183], v[44:47]
s_nop 0
ds_read_b64_tr_b16 v[252:253], v11 offset:45056
ds_read_b64_tr_b16 v[254:255], v11 offset:47104
v_mfma_f32_16x16x32_bf16 v[44:47], v[172:175], a[184:187], v[44:47]
v_mfma_f32_16x16x32_bf16 v[44:47], v[188:191], a[188:191], v[44:47]
s_waitcnt vmcnt(4)
v_max3_u32 v12, v80, v81, v82
v_max3_u32 v13, v83, v84, v85
v_mfma_f32_16x16x32_bf16 v[28:31], v[188:191], a[172:175], v[28:31]
v_max3_u32 v12, v12, v86, v87
v_max3_u32 v13, v13, v88, v89
v_mfma_f32_16x16x32_bf16 v[28:31], v[172:175], a[168:171], v[28:31]
v_max3_u32 v12, v12, v90, v91
v_max3_u32 v13, v13, v92, v93
v_mfma_f32_16x16x32_bf16 v[28:31], v[156:159], a[164:167], v[28:31]
s_waitcnt vmcnt(12) lgkmcnt(0)
v_max3_u32 v12, v12, v94, v95
v_mfma_f32_16x16x32_bf16 v[28:31], v[140:143], a[160:163], v[28:31]
s_barrier
v_max_u32 v12, v12, v13
v_mfma_f32_16x16x32_bf16 v[16:19], v[192:195], a[192:195], v[16:19]
v_cmp_le_u32 vcc, 0xff800000, v12
v_mfma_f32_16x16x32_bf16 v[16:19], v[208:211], a[196:199], v[16:19]
s_nop 0
ds_read_b64_tr_b16 v[128:129], v8 offset:49152
ds_read_b64_tr_b16 v[130:131], v8 offset:51200
v_mfma_f32_16x16x32_bf16 v[16:19], v[224:227], a[200:203], v[16:19]
s_cbranch_vccnz Lxspin2
Lxback2:
v_mfma_f32_16x16x32_bf16 v[16:19], v[240:243], a[204:207], v[16:19]
s_nop 0
ds_read_b64_tr_b16 v[132:133], v9 offset:49152
ds_read_b64_tr_b16 v[134:135], v9 offset:51200
v_mfma_f32_16x16x32_bf16 v[16:19], v[124:127], v[80:83], v[16:19]
v_mfma_f32_16x16x32_bf16 v[32:35], v[240:243], a[220:223], v[32:35]
s_nop 0
ds_read_b64_tr_b16 v[136:137], v10 offset:49152
ds_read_b64_tr_b16 v[138:139], v10 offset:51200
v_mfma_f32_16x16x32_bf16 v[32:35], v[224:227], a[216:219], v[32:35]
v_mfma_f32_16x16x32_bf16 v[32:35], v[208:211], a[212:215], v[32:35]
s_nop 0
ds_read_b64_tr_b16 v[140:141], v11 offset:49152
ds_read_b64_tr_b16 v[142:143], v11 offset:51200
v_mfma_f32_16x16x32_bf16 v[32:35], v[192:195], a[208:211], v[32:35]
v_mfma_f32_16x16x32_bf16 v[32:35], v[124:127], v[88:91], v[32:35]
s_nop 0
ds_read_b64_tr_b16 v[144:145], v8 offset:53248
ds_read_b64_tr_b16 v[146:147], v8 offset:55296
v_mfma_f32_16x16x32_bf16 v[36:39], v[196:199], a[208:211], v[36:39]
v_mfma_f32_16x16x32_bf16 v[36:39], v[212:215], a[212:215], v[36:39]
s_nop 0
ds_read_b64_tr_b16 v[148:149], v9 offset:53248
ds_read_b64_tr_b16 v[150:151], v9 offset:55296
v_mfma_f32_16x16x32_bf16 v[36:39], v[228:231], a[216:219], v[36:39]
v_mfma_f32_16x16x32_bf16 v[36:39], v[244:247], a[220:223], v[36:39]
s_nop 0
ds_read_b64_tr_b16 v[152:153], v10 offset:53248
ds_read_b64_tr_b16 v[154:155], v10 offset:55296
v_mfma_f32_16x16x32_bf16 v[36:39], v[120:123], v[88:91], v[36:39]
v_mfma_f32_16x16x32_bf16 v[20:23], v[244:247], a[204:207], v[20:23]
s_nop 0
ds_read_b64_tr_b16 v[156:157], v11 offset:53248
ds_read_b64_tr_b16 v[158:159], v11 offset:55296
v_mfma_f32_16x16x32_bf16 v[20:23], v[228:231], a[200:203], v[20:23]
v_mfma_f32_16x16x32_bf16 v[20:23], v[212:215], a[196:199], v[20:23]
v_mfma_f32_16x16x32_bf16 v[20:23], v[196:199], a[192:195], v[20:23]
s_nop 0
ds_read_b64_tr_b16 v[160:161], v8 offset:57344
ds_read_b64_tr_b16 v[162:163], v8 offset:59392
v_mfma_f32_16x16x32_bf16 v[20:23], v[120:123], v[80:83], v[20:23]
v_mfma_f32_16x16x32_bf16 v[24:27], v[200:203], a[192:195], v[24:27]
s_nop 0
ds_read_b64_tr_b16 v[164:165], v9 offset:57344
ds_read_b64_tr_b16 v[166:167], v9 offset:59392
v_mfma_f32_16x16x32_bf16 v[24:27], v[216:219], a[196:199], v[24:27]
v_mfma_f32_16x16x32_bf16 v[24:27], v[232:235], a[200:203], v[24:27]
s_nop 0
ds_read_b64_tr_b16 v[168:169], v10 offset:57344
ds_read_b64_tr_b16 v[170:171], v10 offset:59392
v_mfma_f32_16x16x32_bf16 v[24:27], v[248:251], a[204:207], v[24:27]
v_mfma_f32_16x16x32_bf16 v[24:27], v[124:127], v[84:87], v[24:27]
s_nop 0
ds_read_b64_tr_b16 v[172:173], v11 offset:57344
ds_read_b64_tr_b16 v[174:175], v11 offset:59392
v_mfma_f32_16x16x32_bf16 v[40:43], v[248:251], a[220:223], v[40:43]
v_mfma_f32_16x16x32_bf16 v[40:43], v[232:235], a[216:219], v[40:43]
s_nop 0
ds_read_b64_tr_b16 v[176:177], v8 offset:61440
ds_read_b64_tr_b16 v[178:179], v8 offset:63488
v_mfma_f32_16x16x32_bf16 v[40:43], v[216:219], a[212:215], v[40:43]
v_mfma_f32_16x16x32_bf16 v[40:43], v[200:203], a[208:211], v[40:43]
s_nop 0
ds_read_b64_tr_b16 v[180:181], v9 offset:61440
ds_read_b64_tr_b16 v[182:183], v9 offset:63488
v_mfma_f32_16x16x32_bf16 v[40:43], v[124:127], v[92:95], v[40:43]
v_mfma_f32_16x16x32_bf16 v[44:47], v[204:207], a[208:211], v[44:47]
s_nop 0
ds_read_b64_tr_b16 v[184:185], v10 offset:61440
ds_read_b64_tr_b16 v[186:187], v10 offset:63488
v_mfma_f32_16x16x32_bf16 v[44:47], v[220:223], a[212:215], v[44:47]
v_mfma_f32_16x16x32_bf16 v[44:47], v[236:239], a[216:219], v[44:47]
s_nop 0
ds_read_b64_tr_b16 v[188:189], v11 offset:61440
ds_read_b64_tr_b16 v[190:191], v11 offset:63488
v_mfma_f32_16x16x32_bf16 v[44:47], v[252:255], a[220:223], v[44:47]
v_mfma_f32_16x16x32_bf16 v[44:47], v[120:123], v[92:95], v[44:47]
v_mfma_f32_16x16x32_bf16 v[28:31], v[252:255], a[204:207], v[28:31]
s_waitcnt vmcnt(0)
v_max3_u32 v12, v96, v97, v98
v_max3_u32 v13, v99, v100, v101
v_mfma_f32_16x16x32_bf16 v[28:31], v[236:239], a[200:203], v[28:31]
v_max3_u32 v12, v12, v102, v103
v_max3_u32 v13, v13, v104, v105
v_mfma_f32_16x16x32_bf16 v[28:31], v[220:223], a[196:199], v[28:31]
v_max3_u32 v12, v12, v106, v107
v_max3_u32 v13, v13, v108, v109
v_mfma_f32_16x16x32_bf16 v[28:31], v[204:207], a[192:195], v[28:31]
s_waitcnt lgkmcnt(0)
v_max3_u32 v12, v12, v110, v111
v_mfma_f32_16x16x32_bf16 v[28:31], v[120:123], v[84:87], v[28:31]
v_max_u32 v12, v12, v13
v_mfma_f32_16x16x32_bf16 v[16:19], v[128:131], a[224:227], v[16:19]
v_cmp_le_u32 vcc, 0xff800000, v12
v_mfma_f32_16x16x32_bf16 v[16:19], v[144:147], a[228:231], v[16:19]
v_mfma_f32_16x16x32_bf16 v[16:19], v[160:163], a[232:235], v[16:19]
s_cbranch_vccnz Lxspin3
Lxback3:
v_mfma_f32_16x16x32_bf16 v[16:19], v[176:179], a[236:239], v[16:19]
v_mfma_f32_16x16x32_bf16 v[16:19], v[124:127], v[96:99], v[16:19]
v_mfma_f32_16x16x32_bf16 v[20:23], v[180:183], a[236:239], v[20:23]
v_mfma_f32_16x16x32_bf16 v[20:23], v[164:167], a[232:235], v[20:23]
v_mfma_f32_16x16x32_bf16 v[20:23], v[148:151], a[228:231], v[20:23]
v_mfma_f32_16x16x32_bf16 v[20:23], v[132:135], a[224:227], v[20:23]
s_nop 3
v_fma_f32 v16, v16, v6, v48
v_fma_f32 v17, v17, v6, v64
v_mfma_f32_16x16x32_bf16 v[20:23], v[120:123], v[96:99], v[20:23]
v_fma_f32 v18, v18, v6, v49
v_fma_f32 v19, v19, v6, v65
v_mfma_f32_16x16x32_bf16 v[24:27], v[136:139], a[224:227], v[24:27]
v_cvt_pk_bf16_f32 v16, v16, v17
v_cvt_pk_bf16_f32 v17, v18, v19
v_mfma_f32_16x16x32_bf16 v[24:27], v[152:155], a[228:231], v[24:27]
ds_write_b64 v116, v[16:17] offset:0
v_mfma_f32_16x16x32_bf16 v[24:27], v[168:171], a[232:235], v[24:27]
v_mfma_f32_16x16x32_bf16 v[24:27], v[184:187], a[236:239], v[24:27]
v_fma_f32 v20, v20, v6, v50
v_fma_f32 v21, v21, v6, v66
v_mfma_f32_16x16x32_bf16 v[24:27], v[124:127], v[100:103], v[24:27]
v_fma_f32 v22, v22, v6, v51
v_fma_f32 v23, v23, v6, v67
v_mfma_f32_16x16x32_bf16 v[28:31], v[188:191], a[236:239], v[28:31]
v_cvt_pk_bf16_f32 v20, v20, v21
v_cvt_pk_bf16_f32 v21, v22, v23
v_mfma_f32_16x16x32_bf16 v[28:31], v[172:175], a[232:235], v[28:31]
ds_write_b64 v117, v[20:21] offset:0
v_mfma_f32_16x16x32_bf16 v[28:31], v[156:159], a[228:231], v[28:31]
v_mfma_f32_16x16x32_bf16 v[28:31], v[140:143], a[224:227], v[28:31]
v_fma_f32 v24, v24, v6, v52
v_fma_f32 v25, v25, v6, v68
v_mfma_f32_16x16x32_bf16 v[28:31], v[120:123], v[100:103], v[28:31]
v_fma_f32 v26, v26, v6, v53
v_fma_f32 v27, v27, v6, v69
v_mfma_f32_16x16x32_bf16 v[32:35], v[128:131], a[240:243], v[32:35]
v_cvt_pk_bf16_f32 v24, v24, v25
v_cvt_pk_bf16_f32 v25, v26, v27
v_mfma_f32_16x16x32_bf16 v[32:35], v[144:147], a[244:247], v[32:35]
ds_write_b64 v118, v[24:25] offset:0
v_mfma_f32_16x16x32_bf16 v[32:35], v[160:163], a[248:251], v[32:35]
v_mfma_f32_16x16x32_bf16 v[32:35], v[176:179], a[252:255], v[32:35]
v_fma_f32 v28, v28, v6, v54
v_fma_f32 v29, v29, v6, v70
v_mfma_f32_16x16x32_bf16 v[32:35], v[124:127], v[104:107], v[32:35]
v_fma_f32 v30, v30, v6, v55
v_fma_f32 v31, v31, v6, v71
v_mfma_f32_16x16x32_bf16 v[36:39], v[180:183], a[252:255], v[36:39]
v_cvt_pk_bf16_f32 v28, v28, v29
v_cvt_pk_bf16_f32 v29, v30, v31
v_mfma_f32_16x16x32_bf16 v[36:39], v[164:167], a[248:251], v[36:39]
s_nop 0
ds_write_b64 v119, v[28:29] offset:0
ds_read_b128 v[192:195], v4 offset:0
v_mfma_f32_16x16x32_bf16 v[36:39], v[148:151], a[244:247], v[36:39]
ds_read_b128 v[196:199], v4 offset:1024
v_mfma_f32_16x16x32_bf16 v[36:39], v[132:135], a[240:243], v[36:39]
v_fma_f32 v32, v32, v7, v56
v_fma_f32 v33, v33, v7, v72
v_mfma_f32_16x16x32_bf16 v[36:39], v[120:123], v[104:107], v[36:39]
v_fma_f32 v34, v34, v7, v57
v_fma_f32 v35, v35, v7, v73
v_mfma_f32_16x16x32_bf16 v[40:43], v[136:139], a[240:243], v[40:43]
v_cvt_pk_bf16_f32 v32, v32, v33
v_cvt_pk_bf16_f32 v33, v34, v35
v_mfma_f32_16x16x32_bf16 v[40:43], v[152:155], a[244:247], v[40:43]
ds_write_b64 v116, v[32:33] offset:2048
v_mfma_f32_16x16x32_bf16 v[40:43], v[168:171], a[248:251], v[40:43]
s_waitcnt lgkmcnt(2)
buffer_store_dwordx4 v[192:195], v15, s[40:43], s70 offen sc1
v_mfma_f32_16x16x32_bf16 v[40:43], v[184:187], a[252:255], v[40:43]
s_add_u32 s70, s70, 0x4000
v_mfma_f32_16x16x32_bf16 v[40:43], v[124:127], v[108:111], v[40:43]
v_fma_f32 v36, v36, v7, v58
v_fma_f32 v37, v37, v7, v74
v_mfma_f32_16x16x32_bf16 v[44:47], v[188:191], a[252:255], v[44:47]
v_fma_f32 v38, v38, v7, v59
v_fma_f32 v39, v39, v7, v75
v_mfma_f32_16x16x32_bf16 v[44:47], v[172:175], a[248:251], v[44:47]
v_cvt_pk_bf16_f32 v36, v36, v37
v_cvt_pk_bf16_f32 v37, v38, v39
v_mfma_f32_16x16x32_bf16 v[44:47], v[156:159], a[244:247], v[44:47]
ds_write_b64 v117, v[36:37] offset:2048
v_mfma_f32_16x16x32_bf16 v[44:47], v[140:143], a[240:243], v[44:47]
v_fma_f32 v40, v40, v7, v60
v_fma_f32 v41, v41, v7, v76
v_mfma_f32_16x16x32_bf16 v[44:47], v[120:123], v[108:111], v[44:47]
v_fma_f32 v42, v42, v7, v61
v_fma_f32 v43, v43, v7, v77
v_cvt_pk_bf16_f32 v40, v40, v41
v_cvt_pk_bf16_f32 v41, v42, v43
ds_write_b64 v118, v[40:41] offset:2048
s_waitcnt lgkmcnt(3)
buffer_store_dwordx4 v[196:199], v15, s[40:43], s70 offen sc1
s_add_u32 s70, s70, 0x4000
v_fma_f32 v44, v44, v7, v62
v_fma_f32 v45, v45, v7, v78
v_fma_f32 v46, v46, v7, v63
v_fma_f32 v47, v47, v7, v79
v_cvt_pk_bf16_f32 v44, v44, v45
v_cvt_pk_bf16_f32 v45, v46, v47
ds_write_b64 v119, v[44:45] offset:2048
ds_read_b128 v[200:203], v4 offset:2048
ds_read_b128 v[204:207], v4 offset:3072
s_waitcnt lgkmcnt(1)
buffer_store_dwordx4 v[200:203], v15, s[40:43], s70 offen sc1
s_add_u32 s70, s70, 0x4000
s_waitcnt lgkmcnt(0)
buffer_store_dwordx4 v[204:207], v15, s[40:43], s70 offen sc1
s_add_u32 s70, s70, 0x4000
Lend:
s_endpgm
Lspin1:
s_mov_b32 s83, 262144
Lsl3:
s_sleep 2
buffer_load_dword v3, v2, s[48:51], 0 offen sc1
s_sub_u32 s83, s83, 1
s_cmp_eq_u32 s83, 0
s_waitcnt vmcnt(0)
s_cbranch_scc1 Lback2
v_cmp_gt_u32 vcc, 8, v3
s_cbranch_vccnz Lsl3
s_branch Lback2
Lspin4:
s_mov_b32 s83, 262144
Lsl6:
s_sleep 2
buffer_load_dword v3, v2, s[44:47], s75 offen sc1
s_sub_u32 s83, s83, 1
s_cmp_eq_u32 s83, 0
s_waitcnt vmcnt(0)
s_cbranch_scc1 Lback5
v_cmp_gt_u32 vcc, 1, v3
s_cbranch_vccnz Lsl6
s_branch Lback5
.p2align 12
s_endpgm
.p2align 7
LP0x:
Lstub11:
s_cbranch_execz Lret
s_cmp_eq_u32 s58, 2
s_cbranch_scc1 Lta10
s_cmp_eq_u32 s58, 3
s_cbranch_scc1 Lnt11
v_mfma_f32_16x16x32_bf16 v[160:163], a[160:163], v[16:19], v[112:115]
s_xor_b32 s74, s82, 0x10000
v_exp_f32 v128, v128
v_mfma_f32_16x16x32_bf16 v[176:179], a[176:179], v[16:19], v[112:115]
s_add_u32 s74, s74, s64
ds_read_b128 a[128:131], v2 offset:16384
ds_read_b128 a[132:135], v2 offset:17408
s_branch Ljoin12
Lta10:
v_mfma_f32_16x16x32_bf16 v[160:163], a[160:163], v[16:19], v[96:99]
s_xor_b32 s74, s82, 0x10000
v_exp_f32 v128, v128
v_mfma_f32_16x16x32_bf16 v[176:179], a[176:179], v[16:19], v[112:115]
s_add_u32 s74, s74, s64
ds_read_b128 a[128:131], v2 offset:16384
ds_read_b128 a[132:135], v2 offset:17408
s_branch Ljoin12
Lnt11:
v_mfma_f32_16x16x32_bf16 v[160:163], a[160:163], v[16:19], v[80:83]
s_xor_b32 s74, s82, 0x10000
v_exp_f32 v128, v128
v_mfma_f32_16x16x32_bf16 v[176:179], a[176:179], v[16:19], v[96:99]
s_add_u32 s74, s74, s64
ds_read_b128 a[128:131], v2 offset:16384
ds_read_b128 a[132:135], v2 offset:17408
Ljoin12:
v_mfma_f32_16x16x32_bf16 v[164:167], a[160:163], v[32:35], v[84:87]
s_add_u32 s81, s81, 0x8000
v_exp_f32 v129, v129
v_mfma_f32_16x16x32_bf16 v[164:167], a[164:167], v[36:39], v[164:167]
s_add_u32 m0, s74, 16384
v_exp_f32 v130, v130
v_mfma_f32_16x16x32_bf16 v[164:167], a[168:171], v[40:43], v[164:167]
s_add_u32 s72, s81, 16384
v_exp_f32 v131, v131
v_mfma_f32_16x16x32_bf16 v[164:167], a[172:175], v[44:47], v[164:167]
v_exp_f32 v144, v144
v_mfma_f32_16x16x32_bf16 v[172:175], a[172:175], v[76:79], v[92:95]
s_nop 0
ds_read_b128 a[136:139], v2 offset:18432
ds_read_b128 a[140:143], v2 offset:19456
v_mfma_f32_16x16x32_bf16 v[172:175], a[168:171], v[72:75], v[172:175]
s_nop 0
ds_read_b128 a[144:147], v2 offset:20480
ds_read_b128 a[148:151], v2 offset:21504
v_mfma_f32_16x16x32_bf16 v[172:175], a[164:167], v[68:71], v[172:175]
s_nop 0
ds_read_b128 a[152:155], v2 offset:22528
ds_read_b128 a[156:159], v2 offset:23552
v_mfma_f32_16x16x32_bf16 v[172:175], a[160:163], v[64:67], v[172:175]
s_nop 0
ds_read_b128 a[192:195], v2 offset:0
ds_read_b128 a[196:199], v2 offset:1024
v_mfma_f32_16x16x32_bf16 v[188:191], a[176:179], v[64:67], v[92:95]
s_nop 0
ds_read_b128 a[200:203], v2 offset:2048
ds_read_b128 a[204:207], v2 offset:3072
v_mfma_f32_16x16x32_bf16 v[188:191], a[180:183], v[68:71], v[188:191]
s_nop 0
ds_read_b128 a[208:211], v2 offset:4096
ds_read_b128 a[212:215], v2 offset:5120
v_mfma_f32_16x16x32_bf16 v[188:191], a[184:187], v[72:75], v[188:191]
s_nop 0
ds_read_b128 a[216:219], v2 offset:6144
ds_read_b128 a[220:223], v2 offset:7168
v_mfma_f32_16x16x32_bf16 v[188:191], a[188:191], v[76:79], v[188:191]
v_cvt_pk_bf16_f32 v192, v128, v129
v_cvt_pk_bf16_f32 v193, v130, v131
v_mfma_f32_16x16x32_bf16 v[180:183], a[188:191], v[44:47], v[84:87]
buffer_load_dwordx4 v1, s[44:47], s72 offen sc1 lds
v_mfma_f32_16x16x32_bf16 v[180:183], a[184:187], v[40:43], v[180:183]
v_exp_f32 v145, v145
v_mfma_f32_16x16x32_bf16 v[180:183], a[180:183], v[36:39], v[180:183]
v_exp_f32 v146, v146
v_mfma_f32_16x16x32_bf16 v[180:183], a[176:179], v[32:35], v[180:183]
v_exp_f32 v147, v147
v_mfma_f32_16x16x32_bf16 v[160:163], a[164:167], v[20:23], v[160:163]
v_exp_f32 v136, v136
v_mfma_f32_16x16x32_bf16 v[160:163], a[168:171], v[24:27], v[160:163]
v_cvt_pk_bf16_f32 v194, v144, v145
v_cvt_pk_bf16_f32 v195, v146, v147
v_mfma_f32_16x16x32_bf16 v[160:163], a[172:175], v[28:31], v[160:163]
v_exp_f32 v137, v137
v_mfma_f32_16x16x32_bf16 v[168:171], a[172:175], v[60:63], v[88:91]
v_exp_f32 v138, v138
v_mfma_f32_16x16x32_bf16 v[168:171], a[168:171], v[56:59], v[168:171]
v_exp_f32 v139, v139
v_mfma_f32_16x16x32_bf16 v[168:171], a[164:167], v[52:55], v[168:171]
v_exp_f32 v152, v152
v_mfma_f32_16x16x32_bf16 v[168:171], a[160:163], v[48:51], v[168:171]
v_cvt_pk_bf16_f32 v200, v136, v137
v_cvt_pk_bf16_f32 v201, v138, v139
v_mfma_f32_16x16x32_bf16 v[184:187], a[176:179], v[48:51], v[88:91]
buffer_load_dwordx4 v1, s[44:47], s72 offen offset:1024 sc1 lds
v_mfma_f32_16x16x32_bf16 v[184:187], a[180:183], v[52:55], v[184:187]
v_exp_f32 v153, v153
v_mfma_f32_16x16x32_bf16 v[184:187], a[184:187], v[56:59], v[184:187]
v_exp_f32 v154, v154
v_mfma_f32_16x16x32_bf16 v[184:187], a[188:191], v[60:63], v[184:187]
v_exp_f32 v155, v155
v_mfma_f32_16x16x32_bf16 v[176:179], a[188:191], v[28:31], v[176:179]
buffer_load_dwordx4 v1, s[44:47], s72 offen offset:2048 sc1 lds
v_mfma_f32_16x16x32_bf16 v[176:179], a[184:187], v[24:27], v[176:179]
buffer_load_dwordx4 v1, s[44:47], s72 offen offset:3072 sc1 lds
v_mfma_f32_16x16x32_bf16 v[176:179], a[180:183], v[20:23], v[176:179]
s_waitcnt lgkmcnt(4)
v_exp_f32 v132, v132
v_cvt_pk_bf16_f32 v202, v152, v153
v_cvt_pk_bf16_f32 v203, v154, v155
v_exp_f32 v133, v133
v_exp_f32 v134, v134
v_cvt_pk_bf16_f32 v196, v132, v133
v_exp_f32 v135, v135
v_exp_f32 v148, v148
v_cvt_pk_bf16_f32 v197, v134, v135
v_exp_f32 v149, v149
v_exp_f32 v150, v150
v_cvt_pk_bf16_f32 v198, v148, v149
v_exp_f32 v151, v151
v_exp_f32 v140, v140
v_cvt_pk_bf16_f32 v199, v150, v151
v_exp_f32 v141, v141
v_exp_f32 v142, v142
v_cvt_pk_bf16_f32 v204, v140, v141
v_exp_f32 v143, v143
v_exp_f32 v156, v156
v_cvt_pk_bf16_f32 v205, v142, v143
v_exp_f32 v157, v157
v_exp_f32 v158, v158
v_cvt_pk_bf16_f32 v206, v156, v157
v_exp_f32 v159, v159
s_nop 0
v_cvt_pk_bf16_f32 v207, v158, v159
v_mfma_f32_16x16x32_bf16 v[224:227], v[120:123], v[192:195], 0
s_add_u32 s82, s82, 0x8000
ds_read_b128 a[160:163], v2 offset:24576
ds_read_b128 a[164:167], v2 offset:25600
v_mfma_f32_16x16x32_bf16 v[232:235], v[120:123], v[200:203], 0
s_and_b32 s82, s82, 0x1ffff
v_exp_f32 v164, v164
v_mfma_f32_16x16x32_bf16 a[0:3], a[192:195], v[192:195], 0
s_add_u32 m0, s74, 0
v_exp_f32 v165, v165
v_mfma_f32_16x16x32_bf16 a[64:67], a[192:195], v[200:203], 0
s_add_u32 s72, s81, 0
v_exp_f32 v166, v166
v_mfma_f32_16x16x32_bf16 a[68:71], a[196:199], v[200:203], 0
buffer_load_dwordx4 v1, s[44:47], s72 offen sc1 lds
v_mfma_f32_16x16x32_bf16 a[4:7], a[196:199], v[192:195], 0
v_exp_f32 v167, v167
v_mfma_f32_16x16x32_bf16 a[8:11], a[200:203], v[192:195], 0
s_nop 0
ds_read_b128 a[168:171], v2 offset:26624
ds_read_b128 a[172:175], v2 offset:27648
v_mfma_f32_16x16x32_bf16 a[72:75], a[200:203], v[200:203], 0
v_exp_f32 v180, v180
v_mfma_f32_16x16x32_bf16 a[76:79], a[204:207], v[200:203], 0
s_nop 0
ds_read_b128 a[176:179], v2 offset:28672
ds_read_b128 a[180:183], v2 offset:29696
v_mfma_f32_16x16x32_bf16 a[12:15], a[204:207], v[192:195], 0
s_waitcnt lgkmcnt(6)
ds_read_b128 a[184:187], v2 offset:30720
ds_read_b128 a[188:191], v2 offset:31744
v_mfma_f32_16x16x32_bf16 a[16:19], a[208:211], v[192:195], 0
s_nop 0
ds_read_b128 a[224:227], v2 offset:8192
ds_read_b128 a[228:231], v2 offset:9216
v_mfma_f32_16x16x32_bf16 a[80:83], a[208:211], v[200:203], 0
s_nop 0
ds_read_b128 a[232:235], v2 offset:10240
ds_read_b128 a[236:239], v2 offset:11264
v_mfma_f32_16x16x32_bf16 a[84:87], a[212:215], v[200:203], 0
s_nop 0
ds_read_b128 a[240:243], v2 offset:12288
ds_read_b128 a[244:247], v2 offset:13312
v_mfma_f32_16x16x32_bf16 a[20:23], a[212:215], v[192:195], 0
s_nop 0
ds_read_b128 a[248:251], v2 offset:14336
ds_read_b128 a[252:255], v2 offset:15360
v_mfma_f32_16x16x32_bf16 a[24:27], a[216:219], v[192:195], 0
v_cvt_pk_bf16_f32 v212, v164, v165
v_cvt_pk_bf16_f32 v213, v166, v167
v_mfma_f32_16x16x32_bf16 a[88:91], a[216:219], v[200:203], 0
v_exp_f32 v181, v181
v_mfma_f32_16x16x32_bf16 a[92:95], a[220:223], v[200:203], 0
v_exp_f32 v182, v182
v_mfma_f32_16x16x32_bf16 a[28:31], a[220:223], v[192:195], 0
buffer_load_dwordx4 v1, s[44:47], s72 offen offset:1024 sc1 lds
s_cmp_eq_u32 s58, 0
s_cbranch_scc1 Lta13
s_cmp_eq_u32 s58, 1
s_cbranch_scc1 Lnt14
v_mfma_f32_16x16x32_bf16 v[132:135], a[128:131], v[32:35], v[84:87]
v_exp_f32 v183, v183
v_mfma_f32_16x16x32_bf16 v[148:151], a[144:147], v[32:35], v[84:87]
v_exp_f32 v172, v172
s_branch Ljoin15
Lta13:
v_mfma_f32_16x16x32_bf16 v[132:135], a[128:131], v[32:35], v[100:103]
v_exp_f32 v183, v183
v_mfma_f32_16x16x32_bf16 v[148:151], a[144:147], v[32:35], v[112:115]
v_exp_f32 v172, v172
s_branch Ljoin15
Lnt14:
v_mfma_f32_16x16x32_bf16 v[132:135], a[128:131], v[32:35], v[84:87]
v_exp_f32 v183, v183
v_mfma_f32_16x16x32_bf16 v[148:151], a[144:147], v[32:35], v[100:103]
v_exp_f32 v172, v172
Ljoin15:
v_mfma_f32_16x16x32_bf16 v[136:139], a[128:131], v[48:51], v[88:91]
v_cvt_pk_bf16_f32 v214, v180, v181
v_cvt_pk_bf16_f32 v215, v182, v183
v_mfma_f32_16x16x32_bf16 v[136:139], a[132:135], v[52:55], v[136:139]
v_exp_f32 v173, v173
v_mfma_f32_16x16x32_bf16 v[136:139], a[136:139], v[56:59], v[136:139]
buffer_load_dwordx4 v1, s[44:47], s72 offen offset:2048 sc1 lds
v_mfma_f32_16x16x32_bf16 v[136:139], a[140:143], v[60:63], v[136:139]
v_exp_f32 v174, v174
v_mfma_f32_16x16x32_bf16 v[152:155], a[156:159], v[60:63], v[88:91]
v_exp_f32 v175, v175
v_mfma_f32_16x16x32_bf16 v[152:155], a[152:155], v[56:59], v[152:155]
v_exp_f32 v188, v188
v_mfma_f32_16x16x32_bf16 v[152:155], a[148:151], v[52:55], v[152:155]
v_cvt_pk_bf16_f32 v220, v172, v173
v_cvt_pk_bf16_f32 v221, v174, v175
v_mfma_f32_16x16x32_bf16 v[152:155], a[144:147], v[48:51], v[152:155]
v_exp_f32 v189, v189
v_mfma_f32_16x16x32_bf16 v[132:135], a[132:135], v[36:39], v[132:135]
buffer_load_dwordx4 v1, s[44:47], s72 offen offset:3072 sc1 lds
v_mfma_f32_16x16x32_bf16 v[132:135], a[136:139], v[40:43], v[132:135]
s_add_u32 s66, s58, 1
v_exp_f32 v190, v190
v_mfma_f32_16x16x32_bf16 v[132:135], a[140:143], v[44:47], v[132:135]
s_and_b32 s66, s66, 3
v_exp_f32 v191, v191
v_mfma_f32_16x16x32_bf16 v[140:143], a[140:143], v[76:79], v[92:95]
s_mul_i32 s66, s66, 4160
v_exp_f32 v160, v160
v_mfma_f32_16x16x32_bf16 v[140:143], a[136:139], v[72:75], v[140:143]
s_add_u32 m0, s66, 131104
v_cvt_pk_bf16_f32 v222, v188, v189
v_cvt_pk_bf16_f32 v223, v190, v191
v_mfma_f32_16x16x32_bf16 v[140:143], a[132:135], v[68:71], v[140:143]
s_add_u32 s72, s93, 0x2
v_exp_f32 v161, v161
v_mfma_f32_16x16x32_bf16 v[140:143], a[128:131], v[64:67], v[140:143]
buffer_load_dwordx4 v1, s[36:39], s72 offen lds
v_mfma_f32_16x16x32_bf16 v[156:159], a[144:147], v[64:67], v[92:95]
v_exp_f32 v162, v162
v_mfma_f32_16x16x32_bf16 v[156:159], a[148:151], v[68:71], v[156:159]
v_exp_f32 v163, v163
v_mfma_f32_16x16x32_bf16 v[156:159], a[152:155], v[72:75], v[156:159]
buffer_load_dwordx4 v1, s[36:39], s72 offen offset:1024 lds
v_mfma_f32_16x16x32_bf16 v[156:159], a[156:159], v[76:79], v[156:159]
buffer_load_dwordx4 v1, s[36:39], s72 offen offset:2048 lds
v_mfma_f32_16x16x32_bf16 v[148:151], a[156:159], v[44:47], v[148:151]
buffer_load_dwordx4 v1, s[36:39], s72 offen offset:3072 lds
v_mfma_f32_16x16x32_bf16 v[148:151], a[152:155], v[40:43], v[148:151]
s_waitcnt vmcnt(12) lgkmcnt(4)
v_exp_f32 v176, v176
v_mfma_f32_16x16x32_bf16 v[148:151], a[148:151], v[36:39], v[148:151]
s_barrier
v_cvt_pk_bf16_f32 v208, v160, v161
v_cvt_pk_bf16_f32 v209, v162, v163
v_add_u32 v2, s82, v1
v_exp_f32 v177, v177
v_exp_f32 v178, v178
v_cvt_pk_bf16_f32 v210, v176, v177
v_exp_f32 v179, v179
v_exp_f32 v168, v168
v_cvt_pk_bf16_f32 v211, v178, v179
v_exp_f32 v169, v169
v_exp_f32 v170, v170
v_cvt_pk_bf16_f32 v216, v168, v169
v_exp_f32 v171, v171
v_exp_f32 v184, v184
v_cvt_pk_bf16_f32 v217, v170, v171
v_exp_f32 v185, v185
v_exp_f32 v186, v186
v_cvt_pk_bf16_f32 v218, v184, v185
v_exp_f32 v187, v187
s_nop 0
v_cvt_pk_bf16_f32 v219, v186, v187
s_branch LLT3
.p2align 12
s_endpgm
.p2align 7
LLT3x:
Lstub12:
s_cbranch_execz Lret
v_mfma_f32_16x16x32_bf16 v[228:231], v[120:123], v[196:199], v[228:231]
s_xor_b32 s74, s82, 0x10000
ds_read_b128 a[128:131], v2 offset:16384
v_and_b32 v240, 15, v0
v_mfma_f32_16x16x32_bf16 v[228:231], v[120:123], v[212:215], v[228:231]
s_add_u32 s74, s74, s64
v_exp_f32 v136, v136
v_mfma_f32_16x16x32_bf16 v[236:239], v[120:123], v[204:207], v[236:239]
s_add_u32 s81, s81, 0x8000
v_exp_f32 v137, v137
v_mfma_f32_16x16x32_bf16 v[236:239], v[120:123], v[220:223], v[236:239]
s_add_u32 m0, s74, 0
ds_read_b128 a[132:135], v2 offset:17408
v_cvt_pk_bf16_f32 v200, v136, v137
v_mfma_f32_16x16x32_bf16 a[32:35], a[192:195], v[196:199], a[32:35]
s_add_u32 s72, s81, 0
buffer_load_dwordx4 v1, s[44:47], s72 offen sc1 lds
v_mfma_f32_16x16x32_bf16 a[32:35], a[224:227], v[212:215], a[32:35]
s_add_u32 s69, s93, 0x3e00000
v_exp_f32 v138, v138
v_mfma_f32_16x16x32_bf16 a[96:99], a[224:227], v[220:223], a[96:99]
ds_read_b128 a[136:139], v2 offset:18432
v_lshrrev_b32 v241, 4, v0
v_mfma_f32_16x16x32_bf16 a[96:99], a[192:195], v[204:207], a[96:99]
v_exp_f32 v139, v139
v_mfma_f32_16x16x32_bf16 a[100:103], a[196:199], v[204:207], a[100:103]
buffer_store_dwordx4 v[112:115], v1, s[44:47], s69 offen sc1
v_mfma_f32_16x16x32_bf16 a[100:103], a[228:231], v[220:223], a[100:103]
v_exp_f32 v152, v152
v_mfma_f32_16x16x32_bf16 a[36:39], a[228:231], v[212:215], a[36:39]
ds_read_b128 a[140:143], v2 offset:19456
v_cvt_pk_bf16_f32 v201, v138, v139
v_mfma_f32_16x16x32_bf16 a[36:39], a[196:199], v[196:199], a[36:39]
v_exp_f32 v153, v153
v_mfma_f32_16x16x32_bf16 a[40:43], a[200:203], v[196:199], a[40:43]
buffer_load_dwordx4 v1, s[44:47], s72 offen offset:1024 sc1 lds
v_mfma_f32_16x16x32_bf16 a[40:43], a[232:235], v[212:215], a[40:43]
ds_read_b128 a[144:147], v2 offset:20480
v_cvt_pk_bf16_f32 v202, v152, v153
v_mfma_f32_16x16x32_bf16 a[104:107], a[232:235], v[220:223], a[104:107]
v_exp_f32 v154, v154
v_mfma_f32_16x16x32_bf16 a[104:107], a[200:203], v[204:207], a[104:107]
v_exp_f32 v155, v155
v_mfma_f32_16x16x32_bf16 a[108:111], a[204:207], v[204:207], a[108:111]
buffer_store_dwordx4 v[112:115], v1, s[44:47], s69 offen offset:1024 sc1
v_mfma_f32_16x16x32_bf16 a[108:111], a[236:239], v[220:223], a[108:111]
ds_read_b128 a[148:151], v2 offset:21504
v_cvt_pk_bf16_f32 v203, v154, v155
v_mfma_f32_16x16x32_bf16 a[44:47], a[236:239], v[212:215], a[44:47]
v_exp_f32 v132, v132
v_mfma_f32_16x16x32_bf16 a[44:47], a[204:207], v[196:199], a[44:47]
ds_read_b128 a[152:155], v2 offset:22528
v_add_u32 v248, 1, v240
v_mfma_f32_16x16x32_bf16 a[48:51], a[208:211], v[196:199], a[48:51]
s_waitcnt lgkmcnt(7)
v_exp_f32 v133, v133
v_mfma_f32_16x16x32_bf16 a[48:51], a[240:243], v[212:215], a[48:51]
buffer_load_dwordx4 v1, s[44:47], s72 offen offset:2048 sc1 lds
v_mfma_f32_16x16x32_bf16 a[112:115], a[240:243], v[220:223], a[112:115]
v_exp_f32 v134, v134
v_mfma_f32_16x16x32_bf16 a[112:115], a[208:211], v[204:207], a[112:115]
ds_read_b128 a[156:159], v2 offset:23552
v_and_b32 v249, 3, v248
v_mfma_f32_16x16x32_bf16 a[116:119], a[212:215], v[204:207], a[116:119]
v_exp_f32 v135, v135
v_mfma_f32_16x16x32_bf16 a[116:119], a[244:247], v[220:223], a[116:119]
buffer_store_dwordx4 v[112:115], v1, s[44:47], s69 offen offset:2048 sc1
v_mfma_f32_16x16x32_bf16 a[52:55], a[244:247], v[212:215], a[52:55]
ds_read_b128 a[192:195], v2 offset:0
v_lshrrev_b32 v248, 2, v248
v_mfma_f32_16x16x32_bf16 a[52:55], a[212:215], v[196:199], a[52:55]
v_exp_f32 v148, v148
v_mfma_f32_16x16x32_bf16 a[56:59], a[216:219], v[196:199], a[56:59]
buffer_load_dwordx4 v1, s[44:47], s72 offen offset:3072 sc1 lds
v_mfma_f32_16x16x32_bf16 a[56:59], a[248:251], v[212:215], a[56:59]
v_exp_f32 v149, v149
v_mfma_f32_16x16x32_bf16 a[120:123], a[248:251], v[220:223], a[120:123]
ds_read_b128 a[196:199], v2 offset:1024
v_mov_b32 v250, 0x20000
v_mfma_f32_16x16x32_bf16 a[120:123], a[216:219], v[204:207], a[120:123]
v_exp_f32 v150, v150
v_mfma_f32_16x16x32_bf16 a[124:127], a[220:223], v[204:207], a[124:127]
ds_read_b128 a[200:203], v2 offset:2048
v_mov_b32 v252, 0x20001
v_mfma_f32_16x16x32_bf16 a[124:127], a[252:255], v[220:223], a[124:127]
buffer_store_dwordx4 v[112:115], v1, s[44:47], s69 offen offset:3072 sc1
v_mfma_f32_16x16x32_bf16 a[60:63], a[252:255], v[212:215], a[60:63]
s_add_u32 s69, s93, 0x4200000
v_exp_f32 v151, v151
v_mfma_f32_16x16x32_bf16 a[60:63], a[220:223], v[196:199], a[60:63]
ds_read_b128 a[204:207], v2 offset:3072
v_cvt_pk_bf16_f32 v196, v132, v133
s_cmp_eq_u32 s58, 2
s_cbranch_scc1 Lta40
s_cmp_eq_u32 s58, 3
s_cbranch_scc1 Lnt41
v_mfma_f32_16x16x32_bf16 v[164:167], a[160:163], v[32:35], v[112:115]
ds_read_b128 a[208:211], v2 offset:4096
v_cvt_pk_bf16_f32 v197, v134, v135
v_mfma_f32_16x16x32_bf16 v[180:183], a[176:179], v[32:35], v[112:115]
v_exp_f32 v140, v140
s_branch Ljoin42
Lta40:
v_mfma_f32_16x16x32_bf16 v[164:167], a[160:163], v[32:35], v[100:103]
ds_read_b128 a[208:211], v2 offset:4096
v_cvt_pk_bf16_f32 v197, v134, v135
v_mfma_f32_16x16x32_bf16 v[180:183], a[176:179], v[32:35], v[112:115]
v_exp_f32 v140, v140
s_branch Ljoin42
Lnt41:
v_mfma_f32_16x16x32_bf16 v[164:167], a[160:163], v[32:35], v[84:87]
ds_read_b128 a[208:211], v2 offset:4096
v_cvt_pk_bf16_f32 v197, v134, v135
v_mfma_f32_16x16x32_bf16 v[180:183], a[176:179], v[32:35], v[100:103]
v_exp_f32 v140, v140
Ljoin42:
v_mfma_f32_16x16x32_bf16 v[164:167], a[164:167], v[36:39], v[164:167]
ds_read_b128 a[212:215], v2 offset:5120
v_cvt_pk_bf16_f32 v198, v148, v149
v_mfma_f32_16x16x32_bf16 v[164:167], a[168:171], v[40:43], v[164:167]
buffer_store_dwordx4 v[112:115], v1, s[44:47], s69 offen sc1
v_mfma_f32_16x16x32_bf16 v[164:167], a[172:175], v[44:47], v[164:167]
v_exp_f32 v141, v141
v_mfma_f32_16x16x32_bf16 v[172:175], a[172:175], v[76:79], v[92:95]
v_exp_f32 v142, v142
v_mfma_f32_16x16x32_bf16 v[172:175], a[168:171], v[72:75], v[172:175]
ds_read_b128 a[216:219], v2 offset:6144
v_cvt_pk_bf16_f32 v199, v150, v151
v_mfma_f32_16x16x32_bf16 v[172:175], a[164:167], v[68:71], v[172:175]
buffer_store_dwordx4 v[112:115], v1, s[44:47], s69 offen offset:1024 sc1
v_mfma_f32_16x16x32_bf16 v[172:175], a[160:163], v[64:67], v[172:175]
v_exp_f32 v143, v143
v_mfma_f32_16x16x32_bf16 v[188:191], a[176:179], v[64:67], v[92:95]
v_exp_f32 v156, v156
v_mfma_f32_16x16x32_bf16 v[188:191], a[180:183], v[68:71], v[188:191]
ds_read_b128 a[220:223], v2 offset:7168
v_cvt_pk_bf16_f32 v204, v140, v141
v_mfma_f32_16x16x32_bf16 v[188:191], a[184:187], v[72:75], v[188:191]
buffer_store_dwordx4 v[112:115], v1, s[44:47], s69 offen offset:2048 sc1
v_mfma_f32_16x16x32_bf16 v[188:191], a[188:191], v[76:79], v[188:191]
v_exp_f32 v157, v157
v_mfma_f32_16x16x32_bf16 v[180:183], a[188:191], v[44:47], v[180:183]
v_exp_f32 v158, v158
v_mfma_f32_16x16x32_bf16 v[180:183], a[184:187], v[40:43], v[180:183]
v_cvt_pk_bf16_f32 v205, v142, v143
v_cvt_pk_bf16_f32 v206, v156, v157
v_mfma_f32_16x16x32_bf16 v[180:183], a[180:183], v[36:39], v[180:183]
buffer_store_dwordx4 v[112:115], v1, s[44:47], s69 offen offset:3072 sc1
v_mfma_f32_16x16x32_bf16 v[168:171], a[160:163], v[48:51], v[88:91]
v_exp_f32 v159, v159
v_mfma_f32_16x16x32_bf16 v[168:171], a[164:167], v[52:55], v[168:171]
v_cvt_pk_bf16_f32 v207, v158, v159
v_lshlrev_b32 v6, 3, v249
v_mfma_f32_16x16x32_bf16 v[168:171], a[168:171], v[56:59], v[168:171]
v_lshrrev_b32 v6, v6, v252
v_and_b32 v6, 3, v6
v_mfma_f32_16x16x32_bf16 v[168:171], a[172:175], v[60:63], v[168:171]
v_cmp_ne_u32 vcc, 1, v249
v_mul_u32_u24 v6, 16640, v6
v_mfma_f32_16x16x32_bf16 v[184:187], a[188:191], v[60:63], v[88:91]
v_add_u32 v6, s92, v6
v_cndmask_b32 v6, v250, v6, vcc
v_mfma_f32_16x16x32_bf16 v[184:187], a[184:187], v[56:59], v[184:187]
v_add_u32 v253, s58, v249
v_and_b32 v253, 3, v253
v_mfma_f32_16x16x32_bf16 v[184:187], a[180:183], v[52:55], v[184:187]
s_waitcnt lgkmcnt(4)
v_mfma_f32_16x16x32_bf16 v[184:187], a[176:179], v[48:51], v[184:187]
s_barrier
s_lshr_b32 s69, s93, 4
s_and_b32 s69, s69, 0x7f00
s_add_u32 s69, s69, LHT4-Lpc0
v_lshrrev_b32 v3, 5, v0
v_lshlrev_b32 v3, 7, v3
v_add_u32 v3, s69, v3
v_min_u32 v3, Lcode_end-Lpc0, v3
global_load_dword v4, v3, s[98:99]
v_mfma_f32_16x16x32_bf16 v[224:227], v[120:123], v[208:211], v[224:227]
s_add_u32 s82, s82, 0x8000
ds_read_b128 a[160:163], v2 offset:24576
ds_read_b128 a[164:167], v2 offset:25600
v_mfma_f32_16x16x32_bf16 v[232:235], v[120:123], v[216:219], v[232:235]
s_and_b32 s82, s82, 0x1ffff
v_exp_f32 v164, v164
v_mfma_f32_16x16x32_bf16 v[232:235], v[120:123], v[200:203], v[232:235]
s_add_u32 s66, s58, 3
v_exp_f32 v165, v165
v_mfma_f32_16x16x32_bf16 a[0:3], a[224:227], v[208:211], a[0:3]
s_and_b32 s66, s66, 3
v_exp_f32 v166, v166
v_mfma_f32_16x16x32_bf16 a[64:67], a[192:195], v[200:203], a[64:67]
s_mul_i32 s66, s66, 4160
ds_read_b128 a[168:171], v2 offset:26624
v_cvt_pk_bf16_f32 v212, v164, v165
v_mfma_f32_16x16x32_bf16 a[64:67], a[224:227], v[216:219], a[64:67]
s_add_u32 s66, s66, s92
v_exp_f32 v167, v167
v_mfma_f32_16x16x32_bf16 a[68:71], a[228:231], v[216:219], a[68:71]
s_add_u32 m0, s66, 32
v_exp_f32 v180, v180
v_mfma_f32_16x16x32_bf16 a[68:71], a[196:199], v[200:203], a[68:71]
s_add_u32 s72, s93, 0x6
buffer_load_dwordx4 v1, s[36:39], s72 offen lds
v_mfma_f32_16x16x32_bf16 a[4:7], a[228:231], v[208:211], a[4:7]
ds_read_b128 a[172:175], v2 offset:27648
v_cvt_pk_bf16_f32 v213, v166, v167
v_mfma_f32_16x16x32_bf16 a[8:11], a[232:235], v[208:211], a[8:11]
v_exp_f32 v181, v181
v_mfma_f32_16x16x32_bf16 a[72:75], a[200:203], v[200:203], a[72:75]
ds_read_b128 a[176:179], v2 offset:28672
v_cvt_pk_bf16_f32 v214, v180, v181
v_mfma_f32_16x16x32_bf16 a[72:75], a[232:235], v[216:219], a[72:75]
v_exp_f32 v182, v182
v_mfma_f32_16x16x32_bf16 a[76:79], a[236:239], v[216:219], a[76:79]
v_exp_f32 v183, v183
v_mfma_f32_16x16x32_bf16 a[76:79], a[204:207], v[200:203], a[76:79]
ds_read_b128 a[180:183], v2 offset:29696
v_cvt_pk_bf16_f32 v215, v182, v183
v_mfma_f32_16x16x32_bf16 a[12:15], a[236:239], v[208:211], a[12:15]
v_exp_f32 v172, v172
v_mfma_f32_16x16x32_bf16 a[16:19], a[240:243], v[208:211], a[16:19]
s_waitcnt lgkmcnt(6)
ds_read_b128 a[184:187], v2 offset:30720
ds_read_b128 a[188:191], v2 offset:31744
v_mfma_f32_16x16x32_bf16 a[80:83], a[208:211], v[200:203], a[80:83]
v_exp_f32 v173, v173
v_mfma_f32_16x16x32_bf16 a[80:83], a[240:243], v[216:219], a[80:83]
buffer_load_dwordx4 v1, s[36:39], s72 offen offset:1024 lds
v_mfma_f32_16x16x32_bf16 a[84:87], a[244:247], v[216:219], a[84:87]
v_exp_f32 v174, v174
v_mfma_f32_16x16x32_bf16 a[84:87], a[212:215], v[200:203], a[84:87]
v_exp_f32 v175, v175
v_mfma_f32_16x16x32_bf16 a[20:23], a[244:247], v[208:211], a[20:23]
ds_read_b128 a[224:227], v2 offset:8192
v_cvt_pk_bf16_f32 v220, v172, v173
v_mfma_f32_16x16x32_bf16 a[24:27], a[248:251], v[208:211], a[24:27]
v_exp_f32 v188, v188
v_mfma_f32_16x16x32_bf16 a[88:91], a[216:219], v[200:203], a[88:91]
v_exp_f32 v189, v189
v_mfma_f32_16x16x32_bf16 a[88:91], a[248:251], v[216:219], a[88:91]
ds_read_b128 a[228:231], v2 offset:9216
v_cvt_pk_bf16_f32 v221, v174, v175
v_mfma_f32_16x16x32_bf16 a[92:95], a[252:255], v[216:219], a[92:95]
v_exp_f32 v190, v190
v_mfma_f32_16x16x32_bf16 a[92:95], a[220:223], v[200:203], a[92:95]
ds_read_b128 a[232:235], v2 offset:10240
v_cvt_pk_bf16_f32 v222, v188, v189
v_mfma_f32_16x16x32_bf16 a[28:31], a[252:255], v[208:211], a[28:31]
v_exp_f32 v191, v191
s_cmp_eq_u32 s58, 0
s_cbranch_scc1 Lta43
s_cmp_eq_u32 s58, 1
s_cbranch_scc1 Lnt44
v_mfma_f32_16x16x32_bf16 v[136:139], a[128:131], v[48:51], v[88:91]
buffer_load_dwordx4 v1, s[36:39], s72 offen offset:2048 lds
v_mfma_f32_16x16x32_bf16 v[152:155], a[144:147], v[48:51], v[88:91]
v_exp_f32 v168, v168
s_branch Ljoin45
Lta43:
v_mfma_f32_16x16x32_bf16 v[136:139], a[128:131], v[48:51], v[104:107]
buffer_load_dwordx4 v1, s[36:39], s72 offen offset:2048 lds
v_mfma_f32_16x16x32_bf16 v[152:155], a[144:147], v[48:51], v[112:115]
v_exp_f32 v168, v168
s_branch Ljoin45
Lnt44:
v_mfma_f32_16x16x32_bf16 v[136:139], a[128:131], v[48:51], v[88:91]
buffer_load_dwordx4 v1, s[36:39], s72 offen offset:2048 lds
v_mfma_f32_16x16x32_bf16 v[152:155], a[144:147], v[48:51], v[104:107]
v_exp_f32 v168, v168
Ljoin45:
v_mfma_f32_16x16x32_bf16 v[136:139], a[132:135], v[52:55], v[136:139]
ds_read_b128 a[236:239], v2 offset:11264
v_cvt_pk_bf16_f32 v223, v190, v191
v_mfma_f32_16x16x32_bf16 v[136:139], a[136:139], v[56:59], v[136:139]
v_exp_f32 v169, v169
v_mfma_f32_16x16x32_bf16 v[136:139], a[140:143], v[60:63], v[136:139]
ds_read_b128 a[240:243], v2 offset:12288
v_cvt_pk_bf16_f32 v216, v168, v169
v_mfma_f32_16x16x32_bf16 v[152:155], a[156:159], v[60:63], v[152:155]
v_exp_f32 v170, v170
v_mfma_f32_16x16x32_bf16 v[152:155], a[152:155], v[56:59], v[152:155]
v_exp_f32 v171, v171
v_mfma_f32_16x16x32_bf16 v[152:155], a[148:151], v[52:55], v[152:155]
ds_read_b128 a[244:247], v2 offset:13312
v_cvt_pk_bf16_f32 v217, v170, v171
v_mfma_f32_16x16x32_bf16 v[140:143], a[128:131], v[64:67], v[92:95]
v_exp_f32 v184, v184
v_mfma_f32_16x16x32_bf16 v[140:143], a[132:135], v[68:71], v[140:143]
ds_read_b128 a[248:251], v2 offset:14336
v_mfma_f32_16x16x32_bf16 v[140:143], a[136:139], v[72:75], v[140:143]
v_exp_f32 v185, v185
v_mfma_f32_16x16x32_bf16 v[140:143], a[140:143], v[76:79], v[140:143]
buffer_load_dwordx4 v1, s[36:39], s72 offen offset:3072 lds
v_mfma_f32_16x16x32_bf16 v[156:159], a[156:159], v[76:79], v[92:95]
ds_read_b128 a[252:255], v2 offset:15360
v_cvt_pk_bf16_f32 v218, v184, v185
v_mfma_f32_16x16x32_bf16 v[156:159], a[152:155], v[72:75], v[156:159]
v_exp_f32 v186, v186
v_mfma_f32_16x16x32_bf16 v[156:159], a[148:151], v[68:71], v[156:159]
s_waitcnt vmcnt(17) lgkmcnt(0)
v_exp_f32 v187, v187
v_mfma_f32_16x16x32_bf16 v[156:159], a[144:147], v[64:67], v[156:159]
s_barrier
v_cvt_pk_bf16_f32 v219, v186, v187
v_add_u32 v2, s82, v1
v_mfma_f32_16x16x32_bf16 v[228:231], v[120:123], v[196:199], v[228:231]
s_mov_b32 m0, s62
v_exp_f32 v136, v136
v_mfma_f32_16x16x32_bf16 v[228:231], v[120:123], v[212:215], v[228:231]
s_add_u32 s72, s93, 0x3000000
ds_read_b128 a[128:131], v2 offset:16384
v_mul_u32_u24 v253, 4160, v253
v_mfma_f32_16x16x32_bf16 v[236:239], v[120:123], v[204:207], v[236:239]
buffer_load_dwordx4 v1, s[44:47], s72 offen sc1 lds
v_mfma_f32_16x16x32_bf16 v[236:239], v[120:123], v[220:223], v[236:239]
v_exp_f32 v137, v137
v_mfma_f32_16x16x32_bf16 a[32:35], a[192:195], v[196:199], a[32:35]
ds_read_b128 a[132:135], v2 offset:17408
v_cvt_pk_bf16_f32 v200, v136, v137
v_mfma_f32_16x16x32_bf16 a[32:35], a[224:227], v[212:215], a[32:35]
v_exp_f32 v138, v138
v_mfma_f32_16x16x32_bf16 a[96:99], a[224:227], v[220:223], a[96:99]
ds_read_b128 a[136:139], v2 offset:18432
v_add_u32 v6, v6, v253
v_mfma_f32_16x16x32_bf16 a[96:99], a[192:195], v[204:207], a[96:99]
buffer_load_dwordx4 v1, s[44:47], s72 offen offset:1024 sc1 lds
v_mfma_f32_16x16x32_bf16 a[100:103], a[196:199], v[204:207], a[100:103]
v_exp_f32 v139, v139
v_mfma_f32_16x16x32_bf16 a[100:103], a[228:231], v[220:223], a[100:103]
ds_read_b128 a[140:143], v2 offset:19456
v_cvt_pk_bf16_f32 v201, v138, v139
v_mfma_f32_16x16x32_bf16 a[36:39], a[228:231], v[212:215], a[36:39]
v_exp_f32 v152, v152
v_mfma_f32_16x16x32_bf16 a[36:39], a[196:199], v[196:199], a[36:39]
ds_read_b128 a[144:147], v2 offset:20480
v_bfe_u32 v251, v0, 2, 2
v_mfma_f32_16x16x32_bf16 a[40:43], a[200:203], v[196:199], a[40:43]
buffer_load_dwordx4 v1, s[44:47], s72 offen offset:2048 sc1 lds
v_mfma_f32_16x16x32_bf16 a[40:43], a[232:235], v[212:215], a[40:43]
v_exp_f32 v153, v153
v_mfma_f32_16x16x32_bf16 a[104:107], a[232:235], v[220:223], a[104:107]
ds_read_b128 a[148:151], v2 offset:21504
v_cvt_pk_bf16_f32 v202, v152, v153
v_mfma_f32_16x16x32_bf16 a[104:107], a[200:203], v[204:207], a[104:107]
buffer_load_dwordx4 v1, s[44:47], s72 offen offset:3072 sc1 lds
v_mfma_f32_16x16x32_bf16 a[108:111], a[204:207], v[204:207], a[108:111]
s_add_u32 s66, s58, 0
v_exp_f32 v154, v154
v_mfma_f32_16x16x32_bf16 a[108:111], a[236:239], v[220:223], a[108:111]
s_and_b32 s66, s66, 3
ds_read_b128 a[152:155], v2 offset:22528
v_lshl_add_u32 v6, v248, 3, v6
v_mfma_f32_16x16x32_bf16 a[44:47], a[236:239], v[212:215], a[44:47]
s_mul_i32 s66, s66, 4160
v_exp_f32 v155, v155
v_mfma_f32_16x16x32_bf16 a[44:47], a[204:207], v[196:199], a[44:47]
s_add_u32 s66, s66, s92
ds_read_b128 a[156:159], v2 offset:23552
v_cvt_pk_bf16_f32 v203, v154, v155
v_mfma_f32_16x16x32_bf16 a[48:51], a[208:211], v[196:199], a[48:51]
s_waitcnt lgkmcnt(8)
v_exp_f32 v140, v140
v_mfma_f32_16x16x32_bf16 a[48:51], a[240:243], v[212:215], a[48:51]
s_add_u32 m0, s66, 16672
ds_read_b128 a[192:195], v2 offset:0
v_lshl_add_u32 v6, v241, 4, v6
v_mfma_f32_16x16x32_bf16 a[112:115], a[240:243], v[220:223], a[112:115]
s_add_u32 s72, s93, 0x0
buffer_load_dwordx4 v1, s[36:39], s72 offen lds
v_mfma_f32_16x16x32_bf16 a[112:115], a[208:211], v[204:207], a[112:115]
buffer_load_dwordx4 v1, s[36:39], s72 offen offset:1024 lds
v_mfma_f32_16x16x32_bf16 a[116:119], a[212:215], v[204:207], a[116:119]
v_exp_f32 v141, v141
v_mfma_f32_16x16x32_bf16 a[116:119], a[244:247], v[220:223], a[116:119]
ds_read_b128 a[196:199], v2 offset:1024
v_lshlrev_b32 v5, 3, v251
v_mfma_f32_16x16x32_bf16 a[52:55], a[244:247], v[212:215], a[52:55]
v_exp_f32 v142, v142
v_mfma_f32_16x16x32_bf16 a[52:55], a[212:215], v[196:199], a[52:55]
ds_read_b128 a[200:203], v2 offset:2048
v_lshrrev_b32 v5, v5, v252
v_mfma_f32_16x16x32_bf16 a[56:59], a[216:219], v[196:199], a[56:59]
buffer_load_dwordx4 v1, s[36:39], s72 offen offset:2048 lds
v_mfma_f32_16x16x32_bf16 a[56:59], a[248:251], v[212:215], a[56:59]
v_exp_f32 v143, v143
v_mfma_f32_16x16x32_bf16 a[120:123], a[248:251], v[220:223], a[120:123]
ds_read_b128 a[204:207], v2 offset:3072
v_and_b32 v5, 3, v5
v_mfma_f32_16x16x32_bf16 a[120:123], a[216:219], v[204:207], a[120:123]
v_exp_f32 v156, v156
v_mfma_f32_16x16x32_bf16 a[124:127], a[220:223], v[204:207], a[124:127]
ds_read_b128 a[208:211], v2 offset:4096
v_cmp_ne_u32 vcc, 1, v251
v_mfma_f32_16x16x32_bf16 a[124:127], a[252:255], v[220:223], a[124:127]
buffer_load_dwordx4 v1, s[36:39], s72 offen offset:3072 lds
v_mfma_f32_16x16x32_bf16 a[60:63], a[252:255], v[212:215], a[60:63]
s_add_u32 s66, s58, 2
v_exp_f32 v157, v157
v_mfma_f32_16x16x32_bf16 a[60:63], a[220:223], v[196:199], a[60:63]
s_and_b32 s66, s66, 3
ds_read_b128 a[212:215], v2 offset:5120
v_cvt_pk_bf16_f32 v204, v140, v141
s_cmp_eq_u32 s58, 2
s_cbranch_scc1 Lta46
s_cmp_eq_u32 s58, 3
s_cbranch_scc1 Lnt47
v_mfma_f32_16x16x32_bf16 v[168:171], a[160:163], v[48:51], v[112:115]
s_mul_i32 s66, s66, 4160
v_exp_f32 v158, v158
v_mfma_f32_16x16x32_bf16 v[184:187], a[176:179], v[48:51], v[112:115]
s_add_u32 s66, s66, s92
ds_read_b128 a[216:219], v2 offset:6144
v_cvt_pk_bf16_f32 v205, v142, v143
s_branch Ljoin48
Lta46:
v_mfma_f32_16x16x32_bf16 v[168:171], a[160:163], v[48:51], v[104:107]
s_mul_i32 s66, s66, 4160
v_exp_f32 v158, v158
v_mfma_f32_16x16x32_bf16 v[184:187], a[176:179], v[48:51], v[112:115]
s_add_u32 s66, s66, s92
ds_read_b128 a[216:219], v2 offset:6144
v_cvt_pk_bf16_f32 v205, v142, v143
s_branch Ljoin48
Lnt47:
v_mfma_f32_16x16x32_bf16 v[168:171], a[160:163], v[48:51], v[88:91]
s_mul_i32 s66, s66, 4160
v_exp_f32 v158, v158
v_mfma_f32_16x16x32_bf16 v[184:187], a[176:179], v[48:51], v[104:107]
s_add_u32 s66, s66, s92
ds_read_b128 a[216:219], v2 offset:6144
v_cvt_pk_bf16_f32 v205, v142, v143
Ljoin48:
v_mfma_f32_16x16x32_bf16 v[172:175], a[160:163], v[64:67], v[92:95]
s_add_u32 m0, s66, 33312
v_exp_f32 v159, v159
v_mfma_f32_16x16x32_bf16 v[172:175], a[164:167], v[68:71], v[172:175]
s_add_u32 s72, s93, 0x4
buffer_load_dwordx4 v1, s[36:39], s72 offen lds
v_mfma_f32_16x16x32_bf16 v[172:175], a[168:171], v[72:75], v[172:175]
ds_read_b128 a[220:223], v2 offset:7168
v_cvt_pk_bf16_f32 v206, v156, v157
v_mfma_f32_16x16x32_bf16 v[172:175], a[172:175], v[76:79], v[172:175]
buffer_load_dwordx4 v1, s[36:39], s72 offen offset:1024 lds
v_mfma_f32_16x16x32_bf16 v[188:191], a[188:191], v[76:79], v[92:95]
v_cvt_pk_bf16_f32 v207, v158, v159
v_mul_u32_u24 v5, 16640, v5
v_mfma_f32_16x16x32_bf16 v[188:191], a[184:187], v[72:75], v[188:191]
v_add_u32 v5, s92, v5
v_cndmask_b32 v5, v250, v5, vcc
v_mfma_f32_16x16x32_bf16 v[188:191], a[180:183], v[68:71], v[188:191]
v_add_u32 v253, s58, v251
v_and_b32 v253, 3, v253
v_mfma_f32_16x16x32_bf16 v[188:191], a[176:179], v[64:67], v[188:191]
v_mul_u32_u24 v253, 4160, v253
v_add_u32 v5, v5, v253
v_mfma_f32_16x16x32_bf16 v[168:171], a[164:167], v[52:55], v[168:171]
s_add_u32 s73, s62, 480
v_lshlrev_b32 v248, 5, v240
v_sub_u32 v248, s73, v248
v_mfma_f32_16x16x32_bf16 v[168:171], a[168:171], v[56:59], v[168:171]
v_lshl_add_u32 v7, v241, 4, v248
v_mfma_f32_16x16x32_bf16 v[168:171], a[172:175], v[60:63], v[168:171]
s_and_b32 s73, s58, 1
v_mfma_f32_16x16x32_bf16 v[184:187], a[188:191], v[60:63], v[184:187]
s_lshl_b32 s73, s73, 4
v_mfma_f32_16x16x32_bf16 v[184:187], a[184:187], v[56:59], v[184:187]
s_lshr_b32 s73, s90, s73
v_mfma_f32_16x16x32_bf16 v[184:187], a[180:183], v[52:55], v[184:187]
s_waitcnt lgkmcnt(4)
s_and_b32 s73, s73, 0xffff
v_lshl_add_u32 v248, v241, 3, v240
v_sub_u32 v248, 15, v248
v_and_b32 v249, 1, v248
v_lshlrev_b32 v249, 4, v249
v_lshlrev_b32 v249, v249, s73
v_lshrrev_b32 v248, 1, v248
v_and_b32 v241, 3, v0
v_cmp_eq_u32 vcc, 0, v248
v_lshl_add_u32 v5, v241, 3, v5
s_nop 0
v_cndmask_b32 v8, 0, v249, vcc
v_cmp_eq_u32 vcc, 1, v248
v_lshlrev_b32 v240, 4, v251
s_nop 0
v_cndmask_b32 v9, 0, v249, vcc
v_cmp_eq_u32 vcc, 2, v248
v_sub_u32 v240, 48, v240
v_lshlrev_b64 v[12:13], 16, s[88:89]
v_cndmask_b32 v10, 0, v249, vcc
v_cmp_eq_u32 vcc, 3, v248
v_lshlrev_b64 v[12:13], v240, v[12:13]
s_nop 0
v_cndmask_b32 v11, 0, v249, vcc
v_cmp_eq_u32 vcc, 3, v241
s_add_u32 s73, s62, 4096
v_lshl_add_u32 v14, v0, 3, s73
v_cndmask_b32 v12, 0, v12, vcc
v_cndmask_b32 v13, 0, v13, vcc
v_lshrrev_b32 v15, 4, v0
v_lshlrev_b32 v15, 1, v15
v_and_b32 v240, 7, v0
v_xor_b32 v15, v15, v240
v_lshlrev_b32 v15, 4, v15
v_lshrrev_b32 v240, 3, v0
v_lshl_add_u32 v15, v240, 11, v15
s_lshl_b32 s75, s59, 1
s_andn2_b32 s75, 8, s75
s_add_u32 s75, s75, s60
s_lshl_b32 s76, s65, 2
s_lshr_b32 s80, s59, 3
s_add_u32 s76, s76, s80
s_lshl_b32 s94, s58, 16
s_lshl_b32 s80, s76, 7
s_add_u32 s94, s94, s80
s_lshl_b32 s80, s75, 18
s_add_u32 s80, s80, s94
v_rcp_f32 v226, v224
v_rcp_f32 v230, v228
s_lshl_b32 s73, s52, 12
s_add_u32 s73, s73, 0x2000000
s_lshl_b32 s70, s67, 2
s_add_u32 s70, s70, s73
v_or_b32 v3, s53, v1
v_mov_b32 v227, v226
v_accvgpr_read_b32 v240, a0
v_accvgpr_read_b32 v241, a1
v_accvgpr_read_b32 v242, a2
v_accvgpr_read_b32 v243, a3
v_accvgpr_read_b32 v244, a4
v_accvgpr_read_b32 v245, a5
v_accvgpr_read_b32 v246, a6
v_accvgpr_read_b32 v247, a7
v_pk_mul_f32 v[240:241], v[240:241], v[226:227]
v_pk_mul_f32 v[242:243], v[242:243], v[226:227]
v_pk_mul_f32 v[244:245], v[244:245], v[226:227]
buffer_load_dwordx4 v1, s[36:39], s72 offen offset:2048 lds
v_pk_mul_f32 v[246:247], v[246:247], v[226:227]
v_cvt_pk_bf16_f32 v128, v240, v241
v_cvt_pk_bf16_f32 v129, v242, v243
v_cvt_pk_bf16_f32 v130, v244, v245
v_cvt_pk_bf16_f32 v131, v246, v247
v_accvgpr_read_b32 v248, a8
v_accvgpr_read_b32 v249, a9
v_accvgpr_read_b32 v250, a10
v_accvgpr_read_b32 v251, a11
v_accvgpr_read_b32 v252, a12
v_accvgpr_read_b32 v253, a13
v_accvgpr_read_b32 v254, a14
v_accvgpr_read_b32 v255, a15
v_pk_mul_f32 v[248:249], v[248:249], v[226:227]
v_pk_mul_f32 v[250:251], v[250:251], v[226:227]
v_pk_mul_f32 v[252:253], v[252:253], v[226:227]
v_pk_mul_f32 v[254:255], v[254:255], v[226:227]
v_cvt_pk_bf16_f32 v144, v248, v249
buffer_load_dwordx4 v1, s[36:39], s72 offen offset:3072 lds
v_cvt_pk_bf16_f32 v145, v250, v251
v_cvt_pk_bf16_f32 v146, v252, v253
v_cvt_pk_bf16_f32 v147, v254, v255
v_accvgpr_read_b32 v240, a16
v_accvgpr_read_b32 v241, a17
v_accvgpr_read_b32 v242, a18
v_accvgpr_read_b32 v243, a19
v_accvgpr_read_b32 v244, a20
v_accvgpr_read_b32 v245, a21
v_accvgpr_read_b32 v246, a22
v_accvgpr_read_b32 v247, a23
v_pk_mul_f32 v[240:241], v[240:241], v[226:227]
v_pk_mul_f32 v[242:243], v[242:243], v[226:227]
v_pk_mul_f32 v[244:245], v[244:245], v[226:227]
v_pk_mul_f32 v[246:247], v[246:247], v[226:227]
v_cvt_pk_bf16_f32 v160, v240, v241
v_cvt_pk_bf16_f32 v161, v242, v243
v_cvt_pk_bf16_f32 v162, v244, v245
buffer_load_dwordx4 v[80:83], v15, s[4:7], s80 offen
v_cvt_pk_bf16_f32 v163, v246, v247
v_accvgpr_read_b32 v248, a24
v_accvgpr_read_b32 v249, a25
v_accvgpr_read_b32 v250, a26
v_accvgpr_read_b32 v251, a27
v_accvgpr_read_b32 v252, a28
v_accvgpr_read_b32 v253, a29
v_accvgpr_read_b32 v254, a30
v_accvgpr_read_b32 v255, a31
v_pk_mul_f32 v[248:249], v[248:249], v[226:227]
v_pk_mul_f32 v[250:251], v[250:251], v[226:227]
v_pk_mul_f32 v[252:253], v[252:253], v[226:227]
v_pk_mul_f32 v[254:255], v[254:255], v[226:227]
v_cvt_pk_bf16_f32 v176, v248, v249
v_cvt_pk_bf16_f32 v177, v250, v251
v_cvt_pk_bf16_f32 v178, v252, v253
v_cvt_pk_bf16_f32 v179, v254, v255
v_mov_b32 v231, v230
v_accvgpr_read_b32 v240, a32
s_add_u32 s80, s80, 0x4000
buffer_load_dwordx4 v[84:87], v15, s[4:7], s80 offen
v_accvgpr_read_b32 v241, a33
v_accvgpr_read_b32 v242, a34
v_accvgpr_read_b32 v243, a35
v_accvgpr_read_b32 v244, a36
v_accvgpr_read_b32 v245, a37
v_accvgpr_read_b32 v246, a38
v_accvgpr_read_b32 v247, a39
v_pk_mul_f32 v[240:241], v[240:241], v[230:231]
v_pk_mul_f32 v[242:243], v[242:243], v[230:231]
v_pk_mul_f32 v[244:245], v[244:245], v[230:231]
v_pk_mul_f32 v[246:247], v[246:247], v[230:231]
v_cvt_pk_bf16_f32 v132, v240, v241
v_cvt_pk_bf16_f32 v133, v242, v243
v_cvt_pk_bf16_f32 v134, v244, v245
v_cvt_pk_bf16_f32 v135, v246, v247
v_accvgpr_read_b32 v248, a40
v_accvgpr_read_b32 v249, a41
v_accvgpr_read_b32 v250, a42
s_add_u32 s80, s80, 0x4000
buffer_load_dwordx4 v[96:99], v15, s[4:7], s80 offen
v_accvgpr_read_b32 v251, a43
v_accvgpr_read_b32 v252, a44
v_accvgpr_read_b32 v253, a45
v_accvgpr_read_b32 v254, a46
v_accvgpr_read_b32 v255, a47
v_pk_mul_f32 v[248:249], v[248:249], v[230:231]
v_pk_mul_f32 v[250:251], v[250:251], v[230:231]
v_pk_mul_f32 v[252:253], v[252:253], v[230:231]
v_pk_mul_f32 v[254:255], v[254:255], v[230:231]
v_cvt_pk_bf16_f32 v148, v248, v249
v_cvt_pk_bf16_f32 v149, v250, v251
v_cvt_pk_bf16_f32 v150, v252, v253
v_cvt_pk_bf16_f32 v151, v254, v255
v_accvgpr_read_b32 v240, a48
v_accvgpr_read_b32 v241, a49
v_accvgpr_read_b32 v242, a50
v_accvgpr_read_b32 v243, a51
v_accvgpr_read_b32 v244, a52
s_add_u32 s80, s80, 0x4000
buffer_load_dwordx4 v[100:103], v15, s[4:7], s80 offen
v_accvgpr_read_b32 v245, a53
v_accvgpr_read_b32 v246, a54
v_accvgpr_read_b32 v247, a55
v_pk_mul_f32 v[240:241], v[240:241], v[230:231]
v_pk_mul_f32 v[242:243], v[242:243], v[230:231]
v_pk_mul_f32 v[244:245], v[244:245], v[230:231]
v_pk_mul_f32 v[246:247], v[246:247], v[230:231]
v_cvt_pk_bf16_f32 v164, v240, v241
v_cvt_pk_bf16_f32 v165, v242, v243
v_cvt_pk_bf16_f32 v166, v244, v245
v_cvt_pk_bf16_f32 v167, v246, v247
v_accvgpr_read_b32 v248, a56
v_accvgpr_read_b32 v249, a57
v_accvgpr_read_b32 v250, a58
v_accvgpr_read_b32 v251, a59
v_accvgpr_read_b32 v252, a60
v_accvgpr_read_b32 v253, a61
v_accvgpr_read_b32 v254, a62
v_accvgpr_read_b32 v255, a63
v_pk_mul_f32 v[248:249], v[248:249], v[230:231]
v_pk_mul_f32 v[250:251], v[250:251], v[230:231]
v_pk_mul_f32 v[252:253], v[252:253], v[230:231]
v_pk_mul_f32 v[254:255], v[254:255], v[230:231]
v_cvt_pk_bf16_f32 v180, v248, v249
v_cvt_pk_bf16_f32 v181, v250, v251
v_cvt_pk_bf16_f32 v182, v252, v253
v_cvt_pk_bf16_f32 v183, v254, v255
v_mfma_f32_16x16x32_bf16 v[232:235], v[120:123], v[216:219], v[232:235]
s_add_u32 s82, s82, 0x8000
ds_read_b128 a[160:163], v2 offset:24576
ds_read_b128 a[164:167], v2 offset:25600
v_mfma_f32_16x16x32_bf16 v[232:235], v[120:123], v[200:203], v[232:235]
s_and_b32 s82, s82, 0x1ffff
v_exp_f32 v172, v172
v_mfma_f32_16x16x32_bf16 a[64:67], a[224:227], v[216:219], a[64:67]
v_exp_f32 v173, v173
v_mfma_f32_16x16x32_bf16 a[64:67], a[192:195], v[200:203], a[64:67]
s_nop 0
ds_read_b128 a[168:171], v2 offset:26624
ds_read_b128 a[172:175], v2 offset:27648
v_mfma_f32_16x16x32_bf16 a[68:71], a[196:199], v[200:203], a[68:71]
v_exp_f32 v174, v174
v_mfma_f32_16x16x32_bf16 a[68:71], a[228:231], v[216:219], a[68:71]
v_exp_f32 v175, v175
v_mfma_f32_16x16x32_bf16 a[72:75], a[232:235], v[216:219], a[72:75]
buffer_store_dwordx4 v[128:131], v3, s[44:47], s70 offen sc1
v_mfma_f32_16x16x32_bf16 a[72:75], a[200:203], v[200:203], a[72:75]
s_nop 0
ds_read_b128 a[176:179], v2 offset:28672
ds_read_b128 a[180:183], v2 offset:29696
v_mfma_f32_16x16x32_bf16 a[76:79], a[204:207], v[200:203], a[76:79]
v_exp_f32 v188, v188
v_mfma_f32_16x16x32_bf16 a[76:79], a[236:239], v[216:219], a[76:79]
s_nop 0
ds_read_b128 a[184:187], v2 offset:30720
ds_read_b128 a[188:191], v2 offset:31744
v_mfma_f32_16x16x32_bf16 a[80:83], a[240:243], v[216:219], a[80:83]
s_waitcnt lgkmcnt(8)
ds_read_b128 a[224:227], v2 offset:8192
ds_read_b128 a[228:231], v2 offset:9216
v_mfma_f32_16x16x32_bf16 a[80:83], a[208:211], v[200:203], a[80:83]
s_nop 0
ds_read_b128 a[232:235], v2 offset:10240
ds_read_b128 a[236:239], v2 offset:11264
v_mfma_f32_16x16x32_bf16 a[84:87], a[212:215], v[200:203], a[84:87]
ds_read_b128 a[240:243], v2 offset:12288
v_cvt_pk_bf16_f32 v220, v172, v173
v_mfma_f32_16x16x32_bf16 a[84:87], a[244:247], v[216:219], a[84:87]
v_exp_f32 v189, v189
v_mfma_f32_16x16x32_bf16 a[88:91], a[248:251], v[216:219], a[88:91]
v_exp_f32 v190, v190
v_mfma_f32_16x16x32_bf16 a[88:91], a[216:219], v[200:203], a[88:91]
s_nop 0
ds_read_b128 a[244:247], v2 offset:13312
ds_read_b128 a[248:251], v2 offset:14336
v_mfma_f32_16x16x32_bf16 a[92:95], a[220:223], v[200:203], a[92:95]
v_cvt_pk_bf16_f32 v221, v174, v175
v_cvt_pk_bf16_f32 v222, v188, v189
v_mfma_f32_16x16x32_bf16 a[92:95], a[252:255], v[216:219], a[92:95]
v_exp_f32 v191, v191
s_cmp_eq_u32 s58, 0
s_cbranch_scc1 Lta49
s_cmp_eq_u32 s58, 1
s_cbranch_scc1 Lnt50
v_mfma_f32_16x16x32_bf16 v[140:143], a[128:131], v[64:67], v[92:95]
v_exp_f32 v168, v168
v_mfma_f32_16x16x32_bf16 v[156:159], a[144:147], v[64:67], v[92:95]
buffer_store_dwordx4 v[144:147], v3, s[44:47], s70 offen offset:1024 sc1
s_branch Ljoin51
Lta49:
v_mfma_f32_16x16x32_bf16 v[140:143], a[128:131], v[64:67], v[108:111]
v_exp_f32 v168, v168
v_mfma_f32_16x16x32_bf16 v[156:159], a[144:147], v[64:67], v[112:115]
buffer_store_dwordx4 v[144:147], v3, s[44:47], s70 offen offset:1024 sc1
s_branch Ljoin51
Lnt50:
v_mfma_f32_16x16x32_bf16 v[140:143], a[128:131], v[64:67], v[92:95]
v_exp_f32 v168, v168
v_mfma_f32_16x16x32_bf16 v[156:159], a[144:147], v[64:67], v[108:111]
buffer_store_dwordx4 v[144:147], v3, s[44:47], s70 offen offset:1024 sc1
Ljoin51:
v_mfma_f32_16x16x32_bf16 v[140:143], a[132:135], v[68:71], v[140:143]
v_exp_f32 v169, v169
v_mfma_f32_16x16x32_bf16 v[140:143], a[136:139], v[72:75], v[140:143]
v_exp_f32 v170, v170
v_mfma_f32_16x16x32_bf16 v[140:143], a[140:143], v[76:79], v[140:143]
buffer_store_dwordx4 v[160:163], v3, s[44:47], s70 offen offset:2048 sc1
v_mfma_f32_16x16x32_bf16 v[156:159], a[156:159], v[76:79], v[156:159]
ds_read_b128 a[252:255], v2 offset:15360
v_cvt_pk_bf16_f32 v223, v190, v191
v_mfma_f32_16x16x32_bf16 v[156:159], a[152:155], v[72:75], v[156:159]
s_waitcnt vmcnt(24) lgkmcnt(4)
v_exp_f32 v171, v171
v_mfma_f32_16x16x32_bf16 v[156:159], a[148:151], v[68:71], v[156:159]
s_barrier
v_exp_f32 v184, v184
v_add_u32 v2, s82, v1
v_cvt_pk_bf16_f32 v216, v168, v169
v_cvt_pk_bf16_f32 v217, v170, v171
v_exp_f32 v185, v185
v_exp_f32 v186, v186
v_cvt_pk_bf16_f32 v218, v184, v185
v_exp_f32 v187, v187
s_nop 0
v_cvt_pk_bf16_f32 v219, v186, v187
v_mfma_f32_16x16x32_bf16 v[236:239], v[120:123], v[204:207], v[236:239]
s_add_u32 s78, s59, 8
v_exp_f32 v140, v140
v_mfma_f32_16x16x32_bf16 v[236:239], v[120:123], v[220:223], v[236:239]
s_and_b32 s78, s78, 24
v_exp_f32 v141, v141
v_mfma_f32_16x16x32_bf16 a[96:99], a[192:195], v[204:207], a[96:99]
s_lshr_b32 s79, 0x67234501, s78
ds_read_b128 a[192:195], v2 offset:0
v_mfma_f32_16x16x32_bf16 a[96:99], a[224:227], v[220:223], a[96:99]
s_and_b32 s79, s79, 7
buffer_store_dwordx4 v[176:179], v3, s[44:47], s70 offen offset:3072 sc1
v_mfma_f32_16x16x32_bf16 a[100:103], a[228:231], v[220:223], a[100:103]
s_add_u32 s70, s70, 0x80000
v_exp_f32 v142, v142
v_mfma_f32_16x16x32_bf16 a[100:103], a[196:199], v[204:207], a[100:103]
s_lshl_b32 s79, s79, 18
ds_read_b128 a[196:199], v2 offset:1024
v_mfma_f32_16x16x32_bf16 a[104:107], a[200:203], v[204:207], a[104:107]
s_add_u32 s79, s79, s94
ds_read_b128 a[200:203], v2 offset:2048
v_mfma_f32_16x16x32_bf16 a[104:107], a[232:235], v[220:223], a[104:107]
s_add_u32 s12, s61, 0
v_exp_f32 v143, v143
v_mfma_f32_16x16x32_bf16 a[108:111], a[236:239], v[220:223], a[108:111]
s_and_b32 s12, s12, 3
v_exp_f32 v156, v156
v_mfma_f32_16x16x32_bf16 a[108:111], a[204:207], v[204:207], a[108:111]
s_lshl_b32 s12, s12, 21
ds_read_b128 a[204:207], v2 offset:3072
v_mfma_f32_16x16x32_bf16 a[112:115], a[208:211], v[204:207], a[112:115]
s_waitcnt lgkmcnt(4)
ds_read_b128 a[208:211], v2 offset:4096
v_mfma_f32_16x16x32_bf16 a[112:115], a[240:243], v[220:223], a[112:115]
s_add_u32 s12, s12, s79
buffer_store_dwordx4 v[132:135], v3, s[44:47], s70 offen sc1
v_mfma_f32_16x16x32_bf16 a[116:119], a[244:247], v[220:223], a[116:119]
s_add_u32 s13, s61, 1
v_exp_f32 v157, v157
v_mfma_f32_16x16x32_bf16 a[116:119], a[212:215], v[204:207], a[116:119]
s_and_b32 s13, s13, 3
ds_read_b128 a[212:215], v2 offset:5120
v_mfma_f32_16x16x32_bf16 a[120:123], a[216:219], v[204:207], a[120:123]
s_lshl_b32 s13, s13, 21
v_exp_f32 v158, v158
v_mfma_f32_16x16x32_bf16 a[120:123], a[248:251], v[220:223], a[120:123]
s_add_u32 s13, s13, s79
ds_read_b128 a[216:219], v2 offset:6144
v_mfma_f32_16x16x32_bf16 a[124:127], a[252:255], v[220:223], a[124:127]
s_add_u32 s14, s61, 2
buffer_store_dwordx4 v[148:151], v3, s[44:47], s70 offen offset:1024 sc1
v_mfma_f32_16x16x32_bf16 a[124:127], a[220:223], v[204:207], a[124:127]
s_and_b32 s14, s14, 3
ds_read_b128 a[220:223], v2 offset:7168
v_cvt_pk_bf16_f32 v204, v140, v141
s_cmp_eq_u32 s58, 2
s_cbranch_scc1 Lta52
s_cmp_eq_u32 s58, 3
s_cbranch_scc1 Lnt53
v_mfma_f32_16x16x32_bf16 v[172:175], a[160:163], v[64:67], v[112:115]
s_lshl_b32 s14, s14, 21
v_cvt_pk_bf16_f32 v205, v142, v143
v_cvt_pk_bf16_f32 v206, v156, v157
v_mfma_f32_16x16x32_bf16 v[188:191], a[176:179], v[64:67], v[112:115]
s_add_u32 s14, s14, s79
v_exp_f32 v159, v159
s_branch Ljoin54
Lta52:
v_mfma_f32_16x16x32_bf16 v[172:175], a[160:163], v[64:67], v[108:111]
s_lshl_b32 s14, s14, 21
v_cvt_pk_bf16_f32 v205, v142, v143
v_cvt_pk_bf16_f32 v206, v156, v157
v_mfma_f32_16x16x32_bf16 v[188:191], a[176:179], v[64:67], v[112:115]
s_add_u32 s14, s14, s79
v_exp_f32 v159, v159
s_branch Ljoin54
Lnt53:
v_mfma_f32_16x16x32_bf16 v[172:175], a[160:163], v[64:67], v[92:95]
s_lshl_b32 s14, s14, 21
v_cvt_pk_bf16_f32 v205, v142, v143
v_cvt_pk_bf16_f32 v206, v156, v157
v_mfma_f32_16x16x32_bf16 v[188:191], a[176:179], v[64:67], v[108:111]
s_add_u32 s14, s14, s79
v_exp_f32 v159, v159
Ljoin54:
v_mfma_f32_16x16x32_bf16 v[172:175], a[164:167], v[68:71], v[172:175]
s_add_u32 s15, s61, 3
v_cvt_pk_bf16_f32 v207, v158, v159
v_mfma_f32_16x16x32_bf16 v[172:175], a[168:171], v[72:75], v[172:175]
s_and_b32 s15, s15, 3
v_mfma_f32_16x16x32_bf16 v[172:175], a[172:175], v[76:79], v[172:175]
s_lshl_b32 s15, s15, 21
v_mfma_f32_16x16x32_bf16 v[188:191], a[188:191], v[76:79], v[188:191]
s_add_u32 s15, s15, s79
v_mfma_f32_16x16x32_bf16 v[188:191], a[184:187], v[72:75], v[188:191]
v_mfma_f32_16x16x32_bf16 v[188:191], a[180:183], v[68:71], v[188:191]
s_waitcnt lgkmcnt(4)
v_mfma_f32_16x16x32_bf16 v[232:235], v[120:123], v[216:219], v[232:235]
s_add_u32 s82, s82, 0x8000
v_exp_f32 v172, v172
v_mfma_f32_16x16x32_bf16 a[64:67], a[224:227], v[216:219], a[64:67]
s_and_b32 s82, s82, 0x1ffff
ds_read_b128 a[224:227], v2 offset:8192
v_mfma_f32_16x16x32_bf16 a[68:71], a[228:231], v[216:219], a[68:71]
ds_read_b128 a[228:231], v2 offset:9216
v_mfma_f32_16x16x32_bf16 a[72:75], a[232:235], v[216:219], a[72:75]
ds_read_b128 a[232:235], v2 offset:10240
v_mfma_f32_16x16x32_bf16 a[76:79], a[236:239], v[216:219], a[76:79]
buffer_store_dwordx4 v[164:167], v3, s[44:47], s70 offen offset:2048 sc1
v_mfma_f32_16x16x32_bf16 a[80:83], a[240:243], v[216:219], a[80:83]
s_nop 0
ds_read_b128 a[236:239], v2 offset:11264
ds_read_b128 a[240:243], v2 offset:12288
v_mfma_f32_16x16x32_bf16 a[84:87], a[244:247], v[216:219], a[84:87]
ds_read_b128 a[244:247], v2 offset:13312
v_mfma_f32_16x16x32_bf16 a[88:91], a[248:251], v[216:219], a[88:91]
v_exp_f32 v173, v173
v_mfma_f32_16x16x32_bf16 a[92:95], a[252:255], v[216:219], a[92:95]
v_exp_f32 v174, v174
ds_read_b128 a[248:251], v2 offset:14336
ds_read_b128 a[252:255], v2 offset:15360
v_add_u32 v2, s82, v1
buffer_store_dwordx4 v[180:183], v3, s[44:47], s70 offen offset:3072 sc1
v_cvt_pk_bf16_f32 v220, v172, v173
v_exp_f32 v175, v175
v_exp_f32 v188, v188
v_cvt_pk_bf16_f32 v221, v174, v175
v_exp_f32 v189, v189
v_exp_f32 v190, v190
v_cvt_pk_bf16_f32 v222, v188, v189
v_exp_f32 v191, v191
s_nop 0
v_cvt_pk_bf16_f32 v223, v190, v191
s_waitcnt vmcnt(8) lgkmcnt(0)
s_barrier
s_branch LHT4
Lslow:
s_waitcnt vmcnt(0) lgkmcnt(0)
s_barrier
s_mov_b32 s86, 1
s_lshl_b32 s81, s59, 20
s_add_u32 s81, s81, s64
s_sub_u32 s81, s81, 0x4000
s_mov_b32 s83, 0
s_lshl_b32 s75, s60, 3
s_sub_u32 s76, 128, s75
s_add_u32 s74, s75, s58
s_sub_u32 s75, s76, 8
s_add_u32 s75, s75, s58
v_mov_b32 v2, v1
v_lshrrev_b32 v240, 4, v0
v_and_b32 v241, 15, v0
v_lshlrev_b32 v240, 2, v240
v_sub_u32 v240, v241, v240
v_mov_b32 v112, 0xff800000
v_mov_b32 v113, 0xff800000
v_mov_b32 v114, 0xff800000
v_mov_b32 v115, 0xff800000
v_cmp_gt_i32 vcc, 0, v240
v_and_b32 v120, 3, v0
s_nop 0
v_cndmask_b32 v116, 0, v112, vcc
v_cmp_gt_i32 vcc, 1, v240
v_subrev_u32 v120, 1, v120
s_nop 0
v_cndmask_b32 v117, 0, v112, vcc
v_cmp_gt_i32 vcc, 2, v240
v_ashrrev_i32 v120, 31, v120
s_nop 0
v_cndmask_b32 v118, 0, v112, vcc
v_cmp_gt_i32 vcc, 3, v240
v_and_b32 v120, 0x3f803f80, v120
s_nop 0
v_cndmask_b32 v119, 0, v112, vcc
Lslow1:
s_add_u32 m0, s64, 16384
s_add_u32 s72, s81, 16384
buffer_load_dwordx4 v1, s[44:47], s72 offen sc1 lds
buffer_load_dwordx4 v1, s[44:47], s72 offen offset:1024 sc1 lds
buffer_load_dwordx4 v1, s[44:47], s72 offen offset:2048 sc1 lds
buffer_load_dwordx4 v1, s[44:47], s72 offen offset:3072 sc1 lds
s_add_u32 s81, s81, 0x8000
s_waitcnt vmcnt(0)
s_barrier
ds_read_b128 a[128:131], v2 offset:16384
ds_read_b128 a[132:135], v2 offset:17408
ds_read_b128 a[136:139], v2 offset:18432
ds_read_b128 a[140:143], v2 offset:19456
ds_read_b128 a[144:147], v2 offset:20480
ds_read_b128 a[148:151], v2 offset:21504
ds_read_b128 a[152:155], v2 offset:22528
ds_read_b128 a[156:159], v2 offset:23552
s_waitcnt lgkmcnt(0)
s_add_u32 s73, s74, 0
s_cmp_lt_u32 s73, s83
s_cbranch_scc1 Lsa55
s_cmp_eq_u32 s73, s83
s_cbranch_scc1 Lst56
v_mfma_f32_16x16x32_bf16 v[128:131], a[128:131], v[16:19], 0
s_branch Lsj57
Lst56:
v_mfma_f32_16x16x32_bf16 v[128:131], a[128:131], v[16:19], v[116:119]
Lsj57:
v_mfma_f32_16x16x32_bf16 v[128:131], a[132:135], v[20:23], v[128:131]
v_mfma_f32_16x16x32_bf16 v[128:131], a[136:139], v[24:27], v[128:131]
v_mfma_f32_16x16x32_bf16 v[128:131], a[140:143], v[28:31], v[128:131]
s_nop 7
v_max3_f32 v124, v124, v128, v129
v_max3_f32 v124, v124, v130, v131
Lsa55:
s_add_u32 s73, s74, 4
s_cmp_lt_u32 s73, s83
s_cbranch_scc1 Lsa58
s_cmp_eq_u32 s73, s83
s_cbranch_scc1 Lst59
v_mfma_f32_16x16x32_bf16 v[132:135], a[128:131], v[32:35], 0
s_branch Lsj60
Lst59:
v_mfma_f32_16x16x32_bf16 v[132:135], a[128:131], v[32:35], v[116:119]
Lsj60:
v_mfma_f32_16x16x32_bf16 v[132:135], a[132:135], v[36:39], v[132:135]
v_mfma_f32_16x16x32_bf16 v[132:135], a[136:139], v[40:43], v[132:135]
v_mfma_f32_16x16x32_bf16 v[132:135], a[140:143], v[44:47], v[132:135]
s_nop 7
v_max3_f32 v125, v125, v132, v133
v_max3_f32 v125, v125, v134, v135
Lsa58:
s_add_u32 s73, s75, 0
s_cmp_lt_u32 s73, s83
s_cbranch_scc1 Lsa61
s_cmp_eq_u32 s73, s83
s_cbranch_scc1 Lst62
v_mfma_f32_16x16x32_bf16 v[136:139], a[128:131], v[48:51], 0
s_branch Lsj63
Lst62:
v_mfma_f32_16x16x32_bf16 v[136:139], a[128:131], v[48:51], v[116:119]
Lsj63:
v_mfma_f32_16x16x32_bf16 v[136:139], a[132:135], v[52:55], v[136:139]
v_mfma_f32_16x16x32_bf16 v[136:139], a[136:139], v[56:59], v[136:139]
v_mfma_f32_16x16x32_bf16 v[136:139], a[140:143], v[60:63], v[136:139]
s_nop 7
v_max3_f32 v126, v126, v136, v137
v_max3_f32 v126, v126, v138, v139
Lsa61:
s_add_u32 s73, s75, 4
s_cmp_lt_u32 s73, s83
s_cbranch_scc1 Lsa64
s_cmp_eq_u32 s73, s83
s_cbranch_scc1 Lst65
v_mfma_f32_16x16x32_bf16 v[140:143], a[128:131], v[64:67], 0
s_branch Lsj66
Lst65:
v_mfma_f32_16x16x32_bf16 v[140:143], a[128:131], v[64:67], v[116:119]
Lsj66:
v_mfma_f32_16x16x32_bf16 v[140:143], a[132:135], v[68:71], v[140:143]
v_mfma_f32_16x16x32_bf16 v[140:143], a[136:139], v[72:75], v[140:143]
v_mfma_f32_16x16x32_bf16 v[140:143], a[140:143], v[76:79], v[140:143]
s_nop 7
v_max3_f32 v127, v127, v140, v141
v_max3_f32 v127, v127, v142, v143
Lsa64:
s_add_u32 s83, s83, 1
s_add_u32 s73, s74, 0
s_cmp_lt_u32 s73, s83
s_cbranch_scc1 Lsa67
s_cmp_eq_u32 s73, s83
s_cbranch_scc1 Lst68
v_mfma_f32_16x16x32_bf16 v[144:147], a[144:147], v[16:19], 0
s_branch Lsj69
Lst68:
v_mfma_f32_16x16x32_bf16 v[144:147], a[144:147], v[16:19], v[116:119]
Lsj69:
v_mfma_f32_16x16x32_bf16 v[144:147], a[148:151], v[20:23], v[144:147]
v_mfma_f32_16x16x32_bf16 v[144:147], a[152:155], v[24:27], v[144:147]
v_mfma_f32_16x16x32_bf16 v[144:147], a[156:159], v[28:31], v[144:147]
s_nop 7
v_max3_f32 v124, v124, v144, v145
v_max3_f32 v124, v124, v146, v147
Lsa67:
s_add_u32 s73, s74, 4
s_cmp_lt_u32 s73, s83
s_cbranch_scc1 Lsa70
s_cmp_eq_u32 s73, s83
s_cbranch_scc1 Lst71
v_mfma_f32_16x16x32_bf16 v[148:151], a[144:147], v[32:35], 0
s_branch Lsj72
Lst71:
v_mfma_f32_16x16x32_bf16 v[148:151], a[144:147], v[32:35], v[116:119]
Lsj72:
v_mfma_f32_16x16x32_bf16 v[148:151], a[148:151], v[36:39], v[148:151]
v_mfma_f32_16x16x32_bf16 v[148:151], a[152:155], v[40:43], v[148:151]
v_mfma_f32_16x16x32_bf16 v[148:151], a[156:159], v[44:47], v[148:151]
s_nop 7
v_max3_f32 v125, v125, v148, v149
v_max3_f32 v125, v125, v150, v151
Lsa70:
s_add_u32 s73, s75, 0
s_cmp_lt_u32 s73, s83
s_cbranch_scc1 Lsa73
s_cmp_eq_u32 s73, s83
s_cbranch_scc1 Lst74
v_mfma_f32_16x16x32_bf16 v[152:155], a[144:147], v[48:51], 0
s_branch Lsj75
Lst74:
v_mfma_f32_16x16x32_bf16 v[152:155], a[144:147], v[48:51], v[116:119]
Lsj75:
v_mfma_f32_16x16x32_bf16 v[152:155], a[148:151], v[52:55], v[152:155]
v_mfma_f32_16x16x32_bf16 v[152:155], a[152:155], v[56:59], v[152:155]
v_mfma_f32_16x16x32_bf16 v[152:155], a[156:159], v[60:63], v[152:155]
s_nop 7
v_max3_f32 v126, v126, v152, v153
v_max3_f32 v126, v126, v154, v155
Lsa73:
s_add_u32 s73, s75, 4
s_cmp_lt_u32 s73, s83
s_cbranch_scc1 Lsa76
s_cmp_eq_u32 s73, s83
s_cbranch_scc1 Lst77
v_mfma_f32_16x16x32_bf16 v[156:159], a[144:147], v[64:67], 0
s_branch Lsj78
Lst77:
v_mfma_f32_16x16x32_bf16 v[156:159], a[144:147], v[64:67], v[116:119]
Lsj78:
v_mfma_f32_16x16x32_bf16 v[156:159], a[148:151], v[68:71], v[156:159]
v_mfma_f32_16x16x32_bf16 v[156:159], a[152:155], v[72:75], v[156:159]
v_mfma_f32_16x16x32_bf16 v[156:159], a[156:159], v[76:79], v[156:159]
s_nop 7
v_max3_f32 v127, v127, v156, v157
v_max3_f32 v127, v127, v158, v159
Lsa76:
s_add_u32 s83, s83, 1
ds_read_b128 a[128:131], v2 offset:24576
ds_read_b128 a[132:135], v2 offset:25600
ds_read_b128 a[136:139], v2 offset:26624
ds_read_b128 a[140:143], v2 offset:27648
ds_read_b128 a[144:147], v2 offset:28672
ds_read_b128 a[148:151], v2 offset:29696
ds_read_b128 a[152:155], v2 offset:30720
ds_read_b128 a[156:159], v2 offset:31744
s_waitcnt lgkmcnt(0)
s_add_u32 s73, s74, 0
s_cmp_lt_u32 s73, s83
s_cbranch_scc1 Lsa79
s_cmp_eq_u32 s73, s83
s_cbranch_scc1 Lst80
v_mfma_f32_16x16x32_bf16 v[128:131], a[128:131], v[16:19], 0
s_branch Lsj81
Lst80:
v_mfma_f32_16x16x32_bf16 v[128:131], a[128:131], v[16:19], v[116:119]
Lsj81:
v_mfma_f32_16x16x32_bf16 v[128:131], a[132:135], v[20:23], v[128:131]
v_mfma_f32_16x16x32_bf16 v[128:131], a[136:139], v[24:27], v[128:131]
v_mfma_f32_16x16x32_bf16 v[128:131], a[140:143], v[28:31], v[128:131]
s_nop 7
v_max3_f32 v124, v124, v128, v129
v_max3_f32 v124, v124, v130, v131
Lsa79:
s_add_u32 s73, s74, 4
s_cmp_lt_u32 s73, s83
s_cbranch_scc1 Lsa82
s_cmp_eq_u32 s73, s83
s_cbranch_scc1 Lst83
v_mfma_f32_16x16x32_bf16 v[132:135], a[128:131], v[32:35], 0
s_branch Lsj84
Lst83:
v_mfma_f32_16x16x32_bf16 v[132:135], a[128:131], v[32:35], v[116:119]
Lsj84:
v_mfma_f32_16x16x32_bf16 v[132:135], a[132:135], v[36:39], v[132:135]
v_mfma_f32_16x16x32_bf16 v[132:135], a[136:139], v[40:43], v[132:135]
v_mfma_f32_16x16x32_bf16 v[132:135], a[140:143], v[44:47], v[132:135]
s_nop 7
v_max3_f32 v125, v125, v132, v133
v_max3_f32 v125, v125, v134, v135
Lsa82:
s_add_u32 s73, s75, 0
s_cmp_lt_u32 s73, s83
s_cbranch_scc1 Lsa85
s_cmp_eq_u32 s73, s83
s_cbranch_scc1 Lst86
v_mfma_f32_16x16x32_bf16 v[136:139], a[128:131], v[48:51], 0
s_branch Lsj87
Lst86:
v_mfma_f32_16x16x32_bf16 v[136:139], a[128:131], v[48:51], v[116:119]
Lsj87:
v_mfma_f32_16x16x32_bf16 v[136:139], a[132:135], v[52:55], v[136:139]
v_mfma_f32_16x16x32_bf16 v[136:139], a[136:139], v[56:59], v[136:139]
v_mfma_f32_16x16x32_bf16 v[136:139], a[140:143], v[60:63], v[136:139]
s_nop 7
v_max3_f32 v126, v126, v136, v137
v_max3_f32 v126, v126, v138, v139
Lsa85:
s_add_u32 s73, s75, 4
s_cmp_lt_u32 s73, s83
s_cbranch_scc1 Lsa88
s_cmp_eq_u32 s73, s83
s_cbranch_scc1 Lst89
v_mfma_f32_16x16x32_bf16 v[140:143], a[128:131], v[64:67], 0
s_branch Lsj90
Lst89:
v_mfma_f32_16x16x32_bf16 v[140:143], a[128:131], v[64:67], v[116:119]
Lsj90:
v_mfma_f32_16x16x32_bf16 v[140:143], a[132:135], v[68:71], v[140:143]
v_mfma_f32_16x16x32_bf16 v[140:143], a[136:139], v[72:75], v[140:143]
v_mfma_f32_16x16x32_bf16 v[140:143], a[140:143], v[76:79], v[140:143]
s_nop 7
v_max3_f32 v127, v127, v140, v141
v_max3_f32 v127, v127, v142, v143
Lsa88:
s_add_u32 s83, s83, 1
s_add_u32 s73, s74, 0
s_cmp_lt_u32 s73, s83
s_cbranch_scc1 Lsa91
s_cmp_eq_u32 s73, s83
s_cbranch_scc1 Lst92
v_mfma_f32_16x16x32_bf16 v[144:147], a[144:147], v[16:19], 0
s_branch Lsj93
Lst92:
v_mfma_f32_16x16x32_bf16 v[144:147], a[144:147], v[16:19], v[116:119]
Lsj93:
v_mfma_f32_16x16x32_bf16 v[144:147], a[148:151], v[20:23], v[144:147]
v_mfma_f32_16x16x32_bf16 v[144:147], a[152:155], v[24:27], v[144:147]
v_mfma_f32_16x16x32_bf16 v[144:147], a[156:159], v[28:31], v[144:147]
s_nop 7
v_max3_f32 v124, v124, v144, v145
v_max3_f32 v124, v124, v146, v147
Lsa91:
s_add_u32 s73, s74, 4
s_cmp_lt_u32 s73, s83
s_cbranch_scc1 Lsa94
s_cmp_eq_u32 s73, s83
s_cbranch_scc1 Lst95
v_mfma_f32_16x16x32_bf16 v[148:151], a[144:147], v[32:35], 0
s_branch Lsj96
Lst95:
v_mfma_f32_16x16x32_bf16 v[148:151], a[144:147], v[32:35], v[116:119]
Lsj96:
v_mfma_f32_16x16x32_bf16 v[148:151], a[148:151], v[36:39], v[148:151]
v_mfma_f32_16x16x32_bf16 v[148:151], a[152:155], v[40:43], v[148:151]
v_mfma_f32_16x16x32_bf16 v[148:151], a[156:159], v[44:47], v[148:151]
s_nop 7
v_max3_f32 v125, v125, v148, v149
v_max3_f32 v125, v125, v150, v151
Lsa94:
s_add_u32 s73, s75, 0
s_cmp_lt_u32 s73, s83
s_cbranch_scc1 Lsa97
s_cmp_eq_u32 s73, s83
s_cbranch_scc1 Lst98
v_mfma_f32_16x16x32_bf16 v[152:155], a[144:147], v[48:51], 0
s_branch Lsj99
Lst98:
v_mfma_f32_16x16x32_bf16 v[152:155], a[144:147], v[48:51], v[116:119]
Lsj99:
v_mfma_f32_16x16x32_bf16 v[152:155], a[148:151], v[52:55], v[152:155]
v_mfma_f32_16x16x32_bf16 v[152:155], a[152:155], v[56:59], v[152:155]
v_mfma_f32_16x16x32_bf16 v[152:155], a[156:159], v[60:63], v[152:155]
s_nop 7
v_max3_f32 v126, v126, v152, v153
v_max3_f32 v126, v126, v154, v155
Lsa97:
s_add_u32 s73, s75, 4
s_cmp_lt_u32 s73, s83
s_cbranch_scc1 Lsa100
s_cmp_eq_u32 s73, s83
s_cbranch_scc1 Lst101
v_mfma_f32_16x16x32_bf16 v[156:159], a[144:147], v[64:67], 0
s_branch Lsj102
Lst101:
v_mfma_f32_16x16x32_bf16 v[156:159], a[144:147], v[64:67], v[116:119]
Lsj102:
v_mfma_f32_16x16x32_bf16 v[156:159], a[148:151], v[68:71], v[156:159]
v_mfma_f32_16x16x32_bf16 v[156:159], a[152:155], v[72:75], v[156:159]
v_mfma_f32_16x16x32_bf16 v[156:159], a[156:159], v[76:79], v[156:159]
s_nop 7
v_max3_f32 v127, v127, v156, v157
v_max3_f32 v127, v127, v158, v159
Lsa100:
s_add_u32 s83, s83, 1
s_barrier
s_cmp_lt_u32 s83, s76
s_cbranch_scc1 Lslow1
s_lshl_b32 s81, s59, 20
s_add_u32 s81, s81, s64
s_sub_u32 s81, s81, 0x4000
s_add_u32 m0, s64, 49152
s_add_u32 s72, s81, 16384
buffer_load_dwordx4 v1, s[44:47], s72 offen sc1 lds
buffer_load_dwordx4 v1, s[44:47], s72 offen offset:1024 sc1 lds
buffer_load_dwordx4 v1, s[44:47], s72 offen offset:2048 sc1 lds
buffer_load_dwordx4 v1, s[44:47], s72 offen offset:3072 sc1 lds
s_add_u32 s81, s81, 0x8000
s_add_u32 m0, s64, 81920
s_add_u32 s72, s81, 16384
buffer_load_dwordx4 v1, s[44:47], s72 offen sc1 lds
buffer_load_dwordx4 v1, s[44:47], s72 offen offset:1024 sc1 lds
buffer_load_dwordx4 v1, s[44:47], s72 offen offset:2048 sc1 lds
buffer_load_dwordx4 v1, s[44:47], s72 offen offset:3072 sc1 lds
s_add_u32 m0, s64, 65536
s_add_u32 s72, s81, 0
buffer_load_dwordx4 v1, s[44:47], s72 offen sc1 lds
buffer_load_dwordx4 v1, s[44:47], s72 offen offset:1024 sc1 lds
buffer_load_dwordx4 v1, s[44:47], s72 offen offset:2048 sc1 lds
buffer_load_dwordx4 v1, s[44:47], s72 offen offset:3072 sc1 lds
s_add_u32 s81, s81, 0x8000
s_add_u32 m0, s64, 114688
s_add_u32 s72, s81, 16384
buffer_load_dwordx4 v1, s[44:47], s72 offen sc1 lds
buffer_load_dwordx4 v1, s[44:47], s72 offen offset:1024 sc1 lds
buffer_load_dwordx4 v1, s[44:47], s72 offen offset:2048 sc1 lds
buffer_load_dwordx4 v1, s[44:47], s72 offen offset:3072 sc1 lds
s_add_u32 m0, s64, 98304
s_add_u32 s72, s81, 0
buffer_load_dwordx4 v1, s[44:47], s72 offen sc1 lds
buffer_load_dwordx4 v1, s[44:47], s72 offen offset:1024 sc1 lds
buffer_load_dwordx4 v1, s[44:47], s72 offen offset:2048 sc1 lds
buffer_load_dwordx4 v1, s[44:47], s72 offen offset:3072 sc1 lds
v_add_u32 v2, 0x8000, v1
v_lshrrev_b32 v3, 1, v0
v_lshlrev_b32 v3, 7, v3
s_waitcnt vmcnt(0)
s_barrier
v_accvgpr_write_b32 a32, 0
v_accvgpr_write_b32 a33, 0
v_accvgpr_write_b32 a34, 0
v_accvgpr_write_b32 a35, 0
v_accvgpr_write_b32 a36, 0
v_accvgpr_write_b32 a37, 0
v_accvgpr_write_b32 a38, 0
v_accvgpr_write_b32 a39, 0
v_accvgpr_write_b32 a40, 0
v_accvgpr_write_b32 a41, 0
v_accvgpr_write_b32 a42, 0
v_accvgpr_write_b32 a43, 0
v_accvgpr_write_b32 a44, 0
v_accvgpr_write_b32 a45, 0
v_accvgpr_write_b32 a46, 0
v_accvgpr_write_b32 a47, 0
v_accvgpr_write_b32 a48, 0
v_accvgpr_write_b32 a49, 0
v_accvgpr_write_b32 a50, 0
v_accvgpr_write_b32 a51, 0
v_accvgpr_write_b32 a52, 0
v_accvgpr_write_b32 a53, 0
v_accvgpr_write_b32 a54, 0
v_accvgpr_write_b32 a55, 0
v_accvgpr_write_b32 a56, 0
v_accvgpr_write_b32 a57, 0
v_accvgpr_write_b32 a58, 0
v_accvgpr_write_b32 a59, 0
v_accvgpr_write_b32 a60, 0
v_accvgpr_write_b32 a61, 0
v_accvgpr_write_b32 a62, 0
v_accvgpr_write_b32 a63, 0
v_accvgpr_write_b32 a96, 0
v_accvgpr_write_b32 a97, 0
v_accvgpr_write_b32 a98, 0
v_accvgpr_write_b32 a99, 0
v_accvgpr_write_b32 a100, 0
v_accvgpr_write_b32 a101, 0
v_accvgpr_write_b32 a102, 0
v_accvgpr_write_b32 a103, 0
v_accvgpr_write_b32 a104, 0
v_accvgpr_write_b32 a105, 0
v_accvgpr_write_b32 a106, 0
v_accvgpr_write_b32 a107, 0
v_accvgpr_write_b32 a108, 0
v_accvgpr_write_b32 a109, 0
v_accvgpr_write_b32 a110, 0
v_accvgpr_write_b32 a111, 0
v_accvgpr_write_b32 a112, 0
v_accvgpr_write_b32 a113, 0
v_accvgpr_write_b32 a114, 0
v_accvgpr_write_b32 a115, 0
v_accvgpr_write_b32 a116, 0
v_accvgpr_write_b32 a117, 0
v_accvgpr_write_b32 a118, 0
v_accvgpr_write_b32 a119, 0
v_accvgpr_write_b32 a120, 0
v_accvgpr_write_b32 a121, 0
v_accvgpr_write_b32 a122, 0
v_accvgpr_write_b32 a123, 0
v_accvgpr_write_b32 a124, 0
v_accvgpr_write_b32 a125, 0
v_accvgpr_write_b32 a126, 0
v_accvgpr_write_b32 a127, 0
ds_read_b128 a[128:131], v2 offset:16384
ds_read_b128 a[132:135], v2 offset:17408
ds_read_b128 a[136:139], v2 offset:18432
ds_read_b128 a[140:143], v2 offset:19456
ds_read_b128 a[144:147], v2 offset:20480
ds_read_b128 a[148:151], v2 offset:21504
ds_read_b128 a[152:155], v2 offset:22528
ds_read_b128 a[156:159], v2 offset:23552
s_branch Lattn
Lspin103:
s_mov_b32 s83, 262144
Lsl105:
s_sleep 2
buffer_load_dword v3, v2, s[44:47], s82 offen sc1
s_sub_u32 s83, s83, 1
s_cmp_eq_u32 s83, 0
s_waitcnt vmcnt(0)
s_cbranch_scc1 Lback104
v_cmp_gt_u32 vcc, 2, v3
s_cbranch_vccnz Lsl105
s_branch Lback104
Lspin106:
s_mov_b32 s83, 262144
Lsl108:
s_sleep 2
buffer_load_dword v3, v2, s[44:47], s82 offen sc1
s_sub_u32 s83, s83, 1
s_cmp_eq_u32 s83, 0
s_waitcnt vmcnt(0)
s_cbranch_scc1 Lback107
v_cmp_gt_u32 vcc, 2, v3
s_cbranch_vccnz Lsl108
s_branch Lback107
Lredo0:
s_xor_b32 s82, s78, 0
s_lshl_b32 s82, s82, 10
s_add_u32 s82, s82, s74
buffer_load_dword v3, v2, s[44:47], s82 offen sc1
s_waitcnt vmcnt(0)
v_cmp_gt_u32 vcc, 2, v3
s_cbranch_vccnz Lspin103
Lback104:
s_lshr_b32 s69, s12, 18
s_lshl_b32 s69, s69, 12
s_add_u32 s69, s69, s95
buffer_load_dwordx4 a[0:3], v1, s[44:47], s69 offen sc1
buffer_load_dwordx4 a[4:7], v1, s[44:47], s69 offen offset:1024 sc1
buffer_load_dwordx4 a[8:11], v1, s[44:47], s69 offen offset:2048 sc1
buffer_load_dwordx4 a[12:15], v1, s[44:47], s69 offen offset:3072 sc1
s_add_u32 s69, s69, 0x20000
buffer_load_dwordx4 a[16:19], v1, s[44:47], s69 offen sc1
buffer_load_dwordx4 a[20:23], v1, s[44:47], s69 offen offset:1024 sc1
buffer_load_dwordx4 a[24:27], v1, s[44:47], s69 offen offset:2048 sc1
buffer_load_dwordx4 a[28:31], v1, s[44:47], s69 offen offset:3072 sc1
s_lshr_b32 s69, s13, 18
s_lshl_b32 s69, s69, 12
s_add_u32 s69, s69, s95
buffer_load_dwordx4 a[32:35], v1, s[44:47], s69 offen sc1
buffer_load_dwordx4 a[36:39], v1, s[44:47], s69 offen offset:1024 sc1
buffer_load_dwordx4 a[40:43], v1, s[44:47], s69 offen offset:2048 sc1
buffer_load_dwordx4 a[44:47], v1, s[44:47], s69 offen offset:3072 sc1
s_add_u32 s69, s69, 0x20000
buffer_load_dwordx4 a[48:51], v1, s[44:47], s69 offen sc1
buffer_load_dwordx4 a[52:55], v1, s[44:47], s69 offen offset:1024 sc1
buffer_load_dwordx4 a[56:59], v1, s[44:47], s69 offen offset:2048 sc1
buffer_load_dwordx4 a[60:63], v1, s[44:47], s69 offen offset:3072 sc1
s_waitcnt vmcnt(8)
s_branch Lredo0b
Lspin109:
s_mov_b32 s83, 262144
Lsl111:
s_sleep 2
buffer_load_dword v114, v115, s[44:47], s84 offen sc1
s_sub_u32 s83, s83, 1
s_cmp_eq_u32 s83, 0
s_waitcnt vmcnt(0)
s_cbranch_scc1 Lback110
v_cmp_gt_u32 vcc, 3, v114
s_cbranch_vccnz Lsl111
s_branch Lback110
Lspin112:
s_mov_b32 s83, 262144
Lsl114:
s_sleep 2
buffer_load_dword v14, v13, s[44:47], s79 offen sc1
s_sub_u32 s83, s83, 1
s_cmp_eq_u32 s83, 0
s_waitcnt vmcnt(0)
s_cbranch_scc1 Lback113
v_cmp_gt_u32 vcc, 2, v14
s_cbranch_vccnz Lsl114
s_branch Lback113
Lxspin1:
s_mov_b32 s83, 262144
Lxsl1:
buffer_load_dwordx4 v[96:99], v1, s[44:47], s79 offen sc1
buffer_load_dwordx4 v[100:103], v1, s[44:47], s79 offen offset:1024 sc1
buffer_load_dwordx4 v[104:107], v1, s[44:47], s79 offen offset:2048 sc1
buffer_load_dwordx4 v[108:111], v1, s[44:47], s79 offen offset:3072 sc1
s_sub_u32 s83, s83, 1
s_cmp_eq_u32 s83, 0
s_waitcnt vmcnt(0)
s_cbranch_scc1 Lxback1
v_max3_u32 v12, v96, v97, v98
v_max3_u32 v13, v99, v100, v101
v_max3_u32 v12, v12, v102, v103
v_max3_u32 v13, v13, v104, v105
v_max3_u32 v12, v12, v106, v107
v_max3_u32 v13, v13, v108, v109
v_max3_u32 v12, v12, v110, v111
v_max_u32 v12, v12, v13
v_cmp_le_u32 vcc, 0xff800000, v12
s_cbranch_vccnz Lxsl1
s_branch Lxback1
Lxspin2:
s_mov_b32 s83, 262144
Lxsl2:
buffer_load_dwordx4 v[80:83], v1, s[44:47], s82 offen sc1
buffer_load_dwordx4 v[84:87], v1, s[44:47], s82 offen offset:1024 sc1
buffer_load_dwordx4 v[88:91], v1, s[44:47], s82 offen offset:2048 sc1
buffer_load_dwordx4 v[92:95], v1, s[44:47], s82 offen offset:3072 sc1
s_sub_u32 s83, s83, 1
s_cmp_eq_u32 s83, 0
s_waitcnt vmcnt(0)
s_cbranch_scc1 Lxback2
v_max3_u32 v12, v80, v81, v82
v_max3_u32 v13, v83, v84, v85
v_max3_u32 v12, v12, v86, v87
v_max3_u32 v13, v13, v88, v89
v_max3_u32 v12, v12, v90, v91
v_max3_u32 v13, v13, v92, v93
v_max3_u32 v12, v12, v94, v95
v_max_u32 v12, v12, v13
v_cmp_le_u32 vcc, 0xff800000, v12
s_cbranch_vccnz Lxsl2
s_branch Lxback2
Lxspin3:
s_mov_b32 s83, 262144
Lxsl3:
buffer_load_dwordx4 v[96:99], v1, s[44:47], s81 offen sc1
buffer_load_dwordx4 v[100:103], v1, s[44:47], s81 offen offset:1024 sc1
buffer_load_dwordx4 v[104:107], v1, s[44:47], s81 offen offset:2048 sc1
buffer_load_dwordx4 v[108:111], v1, s[44:47], s81 offen offset:3072 sc1
s_sub_u32 s83, s83, 1
s_cmp_eq_u32 s83, 0
s_waitcnt vmcnt(0)
s_cbranch_scc1 Lxback3
v_max3_u32 v12, v96, v97, v98
v_max3_u32 v13, v99, v100, v101
v_max3_u32 v12, v12, v102, v103
v_max3_u32 v13, v13, v104, v105
v_max3_u32 v12, v12, v106, v107
v_max3_u32 v13, v13, v108, v109
v_max3_u32 v12, v12, v110, v111
v_max_u32 v12, v12, v13
v_cmp_le_u32 vcc, 0xff800000, v12
s_cbranch_vccnz Lxsl3
s_branch Lxback3
Lcode_end:
s_endpgm
.section .rodata,"a"
.p2align 6
.amdhsa_kernel gated_mix__compressed_kv_cla__ssm_conv_h3__prompt_kernel
  .amdhsa_next_free_vgpr 512
  .amdhsa_next_free_sgpr 102
  .amdhsa_accum_offset 256
  .amdhsa_group_segment_fixed_size 0
  .amdhsa_kernarg_size 128
  .amdhsa_user_sgpr_count 2
  .amdhsa_user_sgpr_kernarg_segment_ptr 1
  .amdhsa_system_sgpr_workgroup_id_x 1
  .amdhsa_float_denorm_mode_32 3
.end_amdhsa_kernel
```
